```python
import torch

def _softmax(x, axis=-1):
    return torch.softmax(x, dim=axis)

def _gelu(x):
    return torch.nn.functional.gelu(x, approximate='tanh')

def _silu(x):
    return torch.nn.functional.silu(x)

def _sigmoid(x):
    return torch.sigmoid(x)

def _layernorm(x, axis=-1, eps=1e-05):
    m = x.mean(dim=axis, keepdim=True)
    v = x.var(dim=axis, keepdim=True, unbiased=False)
    return (x - m) / torch.sqrt(v + eps)

def _scatter_add(tgt, idx, src, axis=0):
    return tgt.clone().index_add_(axis, idx, src)

def _segment_sum(src, seg, n):
    out = torch.zeros((n,) + src.shape[1:], dtype=src.dtype)
    return out.index_add_(0, seg, src)

def _pad(x, pw):
    flat = tuple((v for pair in reversed(pw) for v in pair))
    return torch.nn.functional.pad(x, flat)
kernel_name = 'concat_heads__memory_aug_recurrent_mem_tr__spectral_gfnet__prompt'

def setup_inputs():

    _w = lambda a: (lambda t: t.to(torch.bfloat16) if t.is_floating_point() else t)(torch.as_tensor(a))

    def _A_setup():
        B, S, Dm = (1, 2048, 1024)
        H, Dh = (32, 128)
        M, seg = (8, 32)
        seg = min(seg, S)
        S = S // seg * seg
        return {'x': _w((lambda *s: torch.randn(*s, dtype=torch.bfloat16) * 0.05)(B, S, Dm)), 'mem0': _w((lambda *s: torch.randn(*s, dtype=torch.bfloat16) * 0.4)(B, M, Dm)), 'Wq': _w((lambda *s: torch.randn(*s, dtype=torch.bfloat16) * 6.4)(Dm, H, Dh) * Dm ** (-0.5)), 'Wk': _w((lambda *s: torch.randn(*s, dtype=torch.bfloat16) * 6.4)(Dm, H, Dh) * Dm ** (-0.5)), 'Wv': _w((lambda *s: torch.randn(*s, dtype=torch.bfloat16) * 0.4)(Dm, H, Dh) * Dm ** (-0.5)), 'Wo': _w((lambda *s: torch.randn(*s, dtype=torch.bfloat16) * 0.4)(H, Dh, Dm) * (H * Dh) ** (-0.5)), 'seg_len': seg}
    _A_in = _A_setup()

    def _B_setup():
        B, S, D = (1, 2048, 1024)
        Df = D // 2 + 1
        return {'x': _w((lambda *s: torch.randn(*s, dtype=torch.bfloat16) * 0.05)(B, S, D)), 'w_r': _w((lambda *s: torch.randn(*s, dtype=torch.bfloat16) * 3.2)(S, Df) * 0.02), 'w_i': _w((lambda *s: torch.randn(*s, dtype=torch.bfloat16) * 3.2)(S, Df) * 0.02)}
    _B_in = _B_setup()
    return {'A_x': _A_in['x'], 'A_mem0': _A_in['mem0'], 'A_Wq': _A_in['Wq'], 'A_Wk': _A_in['Wk'], 'A_Wv': _A_in['Wv'], 'A_Wo': _A_in['Wo'], 'A_seg_len': _A_in['seg_len'], 'B_x': _B_in['x'], 'B_w_r': _B_in['w_r'], 'B_w_i': _B_in['w_i']}

def reference(A_x, A_mem0, A_Wq, A_Wk, A_Wv, A_Wo, A_seg_len, B_x, B_w_r, B_w_i):

    def _A_ref(x, mem0, Wq, Wk, Wv, Wo, seg_len):
        B, S, Dm = x.shape
        H, Dh = (Wq.shape[1], Wq.shape[2])
        M = mem0.shape[1]
        scale = Dh ** (-0.5)
        n_seg = S // seg_len
        L = M + seg_len
        idx = torch.arange(L)
        mask = (idx[:, None] < M) | (idx[:, None] >= idx[None, :])
        mem = mem0
        outs = []
        for s in range(n_seg):
            xs = x[:, s * seg_len:(s + 1) * seg_len, :].clone()
            h = torch.concatenate([mem, xs], axis=1)
            q = torch.einsum('btd,dhe->bhte', h, Wq)
            k = torch.einsum('btd,dhe->bhte', h, Wk)
            v = torch.einsum('btd,dhe->bhte', h, Wv)
            scores = torch.einsum('bhqe,bhke->bhqk', q, k) * scale
            scores = torch.where(mask[None, None], scores, -1000000000.0)
            p = _softmax(scores, axis=-1)
            o = torch.einsum('bhqk,bhke->bhqe', p, v)
            o = torch.einsum('bhte,hed->btd', o, Wo)
            mem = o[:, :M, :].clone()
            outs.append(o[:, M:, :])
        return torch.concatenate(outs, axis=1)

    def _B_ref(x, w_r, w_i):
        B, S, D = x.shape
        X = (lambda x, axes=(-2, -1): torch.fft.rfft2(x.float(), dim=axes))(x, axes=(-2, -1))
        W = w_r + 1j * w_i
        X = X * W
        y = (lambda x, s, axes=(-2, -1): torch.fft.irfft2(x, s=s, dim=axes).to(torch.bfloat16))(X, (S, D), axes=(-2, -1))
        return y
    a = _A_ref(A_x, A_mem0, A_Wq, A_Wk, A_Wv, A_Wo, A_seg_len)
    b = _B_ref(B_x, B_w_r, B_w_i)
    return torch.concatenate([a, b], axis=-1)
```

```asm
; @launch kernel=mega_kernel grid=(256,1,1) block=(256,1,1) lds=163840
.amdgcn_target "amdgcn-amd-amdhsa--gfx950"
.text
.globl mega_kernel
.p2align 8
.type mega_kernel,@function
mega_kernel:
    s_cmp_ge_u32 s2, 256
    s_cbranch_scc1 mega_kernel_exit
    s_load_dwordx2 s[84:85], s[0:1], 96
    s_load_dwordx2 s[72:73], s[0:1], 88
    s_getreg_b32 s90, hwreg(HW_REG_XCC_ID)
    s_and_b32 s90, s90, 7
    v_lshlrev_b32 v1, 4, v0
    v_mov_b32 v8, -1
    v_mov_b32 v9, -1
    v_mov_b32 v10, -1
    v_mov_b32 v11, -1
    s_lshl_b32 s91, s2, 12
    s_add_u32 s91, s91, 69206016
    s_waitcnt lgkmcnt(0)
    s_mov_b32 s86, 268435456
    s_mov_b32 s87, 0x00020000
    s_mov_b32 s74, 256
    s_mov_b32 s75, 0x00020000
    v_lshrrev_b32 v2, 6, v0
    s_nop 0
    v_readfirstlane_b32 s92, v2
    s_lshl_b32 s93, s2, 2
    s_add_u32 s93, s93, s92
    s_cmp_eq_u32 s93, 1
    s_cbranch_scc0 mega_kernel_nocal
    v_mov_b32 v2, 0
    s_mov_b32 s94, 150994944
    buffer_load_dword v3, v2, s[84:87], s94 offen offset:2048 sc1
    s_waitcnt vmcnt(0)
    s_mov_b32 s60, 0x7fffffff
    s_mov_b32 s61, 0x7fffffff
    s_mov_b32 s94, 150994944
    s_memtime s[62:63]
    s_waitcnt lgkmcnt(0)
    buffer_load_dword v3, v2, s[84:87], s94 offen sc1
    s_waitcnt vmcnt(0)
    s_memtime s[64:65]
    s_waitcnt lgkmcnt(0)
    s_sub_u32 s64, s64, s62
    s_min_u32 s60, s60, s64
    s_mov_b32 s94, 151003136
    s_memtime s[62:63]
    s_waitcnt lgkmcnt(0)
    buffer_load_dword v3, v2, s[84:87], s94 offen sc1
    s_waitcnt vmcnt(0)
    s_memtime s[64:65]
    s_waitcnt lgkmcnt(0)
    s_sub_u32 s64, s64, s62
    s_min_u32 s61, s61, s64
    s_mov_b32 s94, 151012352
    s_memtime s[62:63]
    s_waitcnt lgkmcnt(0)
    buffer_load_dword v3, v2, s[84:87], s94 offen sc1
    s_waitcnt vmcnt(0)
    s_memtime s[64:65]
    s_waitcnt lgkmcnt(0)
    s_sub_u32 s64, s64, s62
    s_min_u32 s60, s60, s64
    s_mov_b32 s94, 151020544
    s_memtime s[62:63]
    s_waitcnt lgkmcnt(0)
    buffer_load_dword v3, v2, s[84:87], s94 offen sc1
    s_waitcnt vmcnt(0)
    s_memtime s[64:65]
    s_waitcnt lgkmcnt(0)
    s_sub_u32 s64, s64, s62
    s_min_u32 s61, s61, s64
    s_mov_b32 s94, 151029760
    s_memtime s[62:63]
    s_waitcnt lgkmcnt(0)
    buffer_load_dword v3, v2, s[84:87], s94 offen sc1
    s_waitcnt vmcnt(0)
    s_memtime s[64:65]
    s_waitcnt lgkmcnt(0)
    s_sub_u32 s64, s64, s62
    s_min_u32 s60, s60, s64
    s_mov_b32 s94, 151037952
    s_memtime s[62:63]
    s_waitcnt lgkmcnt(0)
    buffer_load_dword v3, v2, s[84:87], s94 offen sc1
    s_waitcnt vmcnt(0)
    s_memtime s[64:65]
    s_waitcnt lgkmcnt(0)
    s_sub_u32 s64, s64, s62
    s_min_u32 s61, s61, s64
    s_mov_b32 s94, 151047168
    s_memtime s[62:63]
    s_waitcnt lgkmcnt(0)
    buffer_load_dword v3, v2, s[84:87], s94 offen sc1
    s_waitcnt vmcnt(0)
    s_memtime s[64:65]
    s_waitcnt lgkmcnt(0)
    s_sub_u32 s64, s64, s62
    s_min_u32 s60, s60, s64
    s_mov_b32 s94, 151055360
    s_memtime s[62:63]
    s_waitcnt lgkmcnt(0)
    buffer_load_dword v3, v2, s[84:87], s94 offen sc1
    s_waitcnt vmcnt(0)
    s_memtime s[64:65]
    s_waitcnt lgkmcnt(0)
    s_sub_u32 s64, s64, s62
    s_min_u32 s61, s61, s64
    s_cmp_lt_u32 s61, s60
    s_cselect_b32 s60, 1, 0
    s_lshr_b32 s61, s90, 2
    s_xor_b32 s60, s60, s61
    s_add_u32 s60, s60, 1
    v_mov_b32 v3, s60
    buffer_store_dword v3, v2, s[72:75], 0 offen offset:192 sc1
    mega_kernel_nocal:
    buffer_store_dwordx4 v[8:11], v1, s[84:87], s91 offen sc1
    s_add_u32 s91, s91, 1048576
    s_cmp_lt_u32 s2, 16
    s_cbranch_scc0 mega_kernel_pz
    buffer_store_dwordx4 v[8:11], v1, s[84:87], s91 offen sc1
    mega_kernel_pz:
    s_waitcnt vmcnt(0)
    s_barrier
    v_mov_b32 v1, 0
    v_mov_b32 v2, 1
    v_mov_b32 v3, 1
    s_lshl_b32 s91, s90, 4
    v_cmp_eq_u32 vcc, 0, v0
    s_and_saveexec_b64 s[88:89], vcc
    s_cbranch_execz mega_kernel_tkd
    buffer_atomic_add v2, v1, s[72:75], s91 offen sc0
    s_waitcnt vmcnt(0)
    buffer_atomic_add v3, v1, s[72:75], 0 offen offset:128 sc0
    s_waitcnt vmcnt(0)
    ds_write_b64 v1, v[2:3]
    s_waitcnt lgkmcnt(0)
    mega_kernel_tkw:
    buffer_load_dword v4, v1, s[72:75], 0 offen offset:128 sc1
    s_waitcnt vmcnt(0)
    v_cmp_ne_u32 vcc, 256, v4
    s_cbranch_vccnz mega_kernel_tkw
    mega_kernel_tkd:
    s_mov_b64 exec, s[88:89]
    s_barrier
    ds_read_b64 v[2:3], v1
    v_and_b32 v4, 7, v0
    v_lshlrev_b32 v4, 4, v4
    buffer_load_dword v5, v4, s[72:75], 0 offen sc1
    buffer_load_dword v6, v1, s[72:75], 0 offen offset:192 sc1
    s_waitcnt vmcnt(0) lgkmcnt(0)
    v_readfirstlane_b32 s96, v2
    v_readfirstlane_b32 s97, v3
    v_readfirstlane_b32 s98, v6
    v_cmp_ne_u32 vcc, 32, v5
    s_nop 3
    s_cmp_eq_u64 vcc, 0
    s_cselect_b32 s95, 1, 0
    s_sub_u32 s98, s98, 1
    s_and_b32 s98, s98, 1
    s_barrier
    s_cmp_eq_u32 s95, 1
    s_cbranch_scc0 mega_kernel_slowsel
    s_mov_b32 s30, s90
    s_mov_b32 s31, s96
    s_cmp_lt_u32 s90, 4
    s_cbranch_scc1 mega_kernel_recf
    s_sub_u32 s90, s90, 4
    s_lshl_b32 s90, s90, 5
    s_add_u32 s90, s90, s96
    s_branch mega_kernel_bulk
    mega_kernel_slowsel:
    s_lshr_b32 s30, s97, 5
    s_and_b32 s31, s97, 31
    s_cmp_lt_u32 s97, 128
    s_cbranch_scc1 mega_kernel_recs
    s_sub_u32 s90, s97, 128
    mega_kernel_bulk:
    s_lshr_b32 s91, s90, 5
    s_and_b32 s40, s90, 31
    s_and_b32 s92, s91, 1
    s_lshl_b32 s92, s92, 5
    s_add_u32 s92, s92, s40
    s_cmp_eq_u32 s91, 0
    s_cbranch_scc1 mega_kernel_rk
    s_cmp_eq_u32 s91, 1
    s_cbranch_scc1 mega_kernel_rv
    v_mov_b32 v8, -1
    v_mov_b32 v9, -1
    v_mov_b32 v10, -1
    v_mov_b32 v11, -1
    v_lshlrev_b32 v1, 4, v0
    v_add_u32 v2, 4096, v1
    s_lshr_b32 s60, s92, 3
    s_xor_b32 s60, s60, s98
    s_and_b32 s60, s60, 1
    s_lshl_b32 s60, s60, 13
    s_lshl_b32 s61, s92, 18
    s_add_u32 s60, s60, s61
    s_add_u32 s60, s60, 150994944
    buffer_store_dwordx4 v[8:11], v1, s[84:87], s60 offen sc1
    buffer_store_dwordx4 v[8:11], v2, s[84:87], s60 offen sc1
    s_add_u32 s60, s60, 16384
    buffer_store_dwordx4 v[8:11], v1, s[84:87], s60 offen sc1
    buffer_store_dwordx4 v[8:11], v2, s[84:87], s60 offen sc1
    s_add_u32 s60, s60, 16384
    buffer_store_dwordx4 v[8:11], v1, s[84:87], s60 offen sc1
    buffer_store_dwordx4 v[8:11], v2, s[84:87], s60 offen sc1
    s_add_u32 s60, s60, 16384
    buffer_store_dwordx4 v[8:11], v1, s[84:87], s60 offen sc1
    buffer_store_dwordx4 v[8:11], v2, s[84:87], s60 offen sc1
    s_add_u32 s60, s60, 16384
    buffer_store_dwordx4 v[8:11], v1, s[84:87], s60 offen sc1
    buffer_store_dwordx4 v[8:11], v2, s[84:87], s60 offen sc1
    s_add_u32 s60, s60, 16384
    buffer_store_dwordx4 v[8:11], v1, s[84:87], s60 offen sc1
    buffer_store_dwordx4 v[8:11], v2, s[84:87], s60 offen sc1
    s_add_u32 s60, s60, 16384
    buffer_store_dwordx4 v[8:11], v1, s[84:87], s60 offen sc1
    buffer_store_dwordx4 v[8:11], v2, s[84:87], s60 offen sc1
    s_add_u32 s60, s60, 16384
    buffer_store_dwordx4 v[8:11], v1, s[84:87], s60 offen sc1
    buffer_store_dwordx4 v[8:11], v2, s[84:87], s60 offen sc1
    s_add_u32 s60, s60, 16384
    buffer_store_dwordx4 v[8:11], v1, s[84:87], s60 offen sc1
    buffer_store_dwordx4 v[8:11], v2, s[84:87], s60 offen sc1
    s_add_u32 s60, s60, 16384
    buffer_store_dwordx4 v[8:11], v1, s[84:87], s60 offen sc1
    buffer_store_dwordx4 v[8:11], v2, s[84:87], s60 offen sc1
    s_add_u32 s60, s60, 16384
    buffer_store_dwordx4 v[8:11], v1, s[84:87], s60 offen sc1
    buffer_store_dwordx4 v[8:11], v2, s[84:87], s60 offen sc1
    s_add_u32 s60, s60, 16384
    buffer_store_dwordx4 v[8:11], v1, s[84:87], s60 offen sc1
    buffer_store_dwordx4 v[8:11], v2, s[84:87], s60 offen sc1
    s_add_u32 s60, s60, 16384
    buffer_store_dwordx4 v[8:11], v1, s[84:87], s60 offen sc1
    buffer_store_dwordx4 v[8:11], v2, s[84:87], s60 offen sc1
    s_add_u32 s60, s60, 16384
    buffer_store_dwordx4 v[8:11], v1, s[84:87], s60 offen sc1
    buffer_store_dwordx4 v[8:11], v2, s[84:87], s60 offen sc1
    s_add_u32 s60, s60, 16384
    buffer_store_dwordx4 v[8:11], v1, s[84:87], s60 offen sc1
    buffer_store_dwordx4 v[8:11], v2, s[84:87], s60 offen sc1
    s_add_u32 s60, s60, 16384
    buffer_store_dwordx4 v[8:11], v1, s[84:87], s60 offen sc1
    buffer_store_dwordx4 v[8:11], v2, s[84:87], s60 offen sc1
    s_add_u32 s60, s60, 16384
    s_waitcnt vmcnt(0)
    s_barrier
    v_mov_b32 v1, 0
    v_mov_b32 v2, 1
    v_cmp_eq_u32 vcc, 0, v0
    s_and_saveexec_b64 s[60:61], vcc
    s_cbranch_execz mega_kernel_xps
    buffer_atomic_add v2, v1, s[72:75], 0 offen offset:224 sc1
    mega_kernel_xps:
    s_mov_b64 exec, s[60:61]
    s_cmp_eq_u32 s91, 2
    s_cbranch_scc0 mega_kernel_ro
    s_load_dwordx2 s[4:5], s[0:1], 16
    s_load_dwordx2 s[8:9], s[0:1], 0
    v_lshrrev_b32 v2, 6, v0
    v_and_b32 v1, 63, v0
    v_readfirstlane_b32 s41, v2
    v_lshlrev_b32 v5, 4, v1
    s_mov_b32 s99, 0
    s_waitcnt lgkmcnt(0)
    s_mov_b32 s6, 8388608
    s_mov_b32 s7, 0x00020000
    s_mov_b32 s10, 4194304
    s_mov_b32 s11, 0x00020000
    s_lshl_b32 s43, s40, 8
    s_lshl_b32 s44, s41, 6
    s_add_u32 s48, s43, s44
    v_lshrrev_b32 v2, 2, v1
    v_and_b32 v3, 3, v1
    v_lshlrev_b32 v16, 13, v2
    v_lshl_add_u32 v16, v3, 4, v16
    v_add_u32 v16, s48, v16
    s_lshl_b32 s45, s41, 15
    v_bfe_u32 v17, v1, 2, 2
    v_lshrrev_b32 v18, 5, v1
    v_mul_u32_u24 v18, 8, v18
    v_add_u32 v17, v17, v18
    v_lshlrev_b32 v17, 6, v17
    v_bfe_u32 v18, v1, 4, 1
    v_lshl_add_u32 v17, v18, 5, v17
    v_and_b32 v18, 1, v1
    v_lshl_add_u32 v17, v18, 4, v17
    v_bfe_u32 v18, v1, 1, 1
    v_lshl_add_u32 v17, v18, 3, v17
    v_add_u32 v17, s45, v17
    s_add_u32 m0, s45, 0
    s_mov_b32 s44, 0
    buffer_load_dwordx4 v16, s[4:7], s44 offen lds
    s_add_u32 m0, s45, 1024
    s_mov_b32 s44, 131072
    buffer_load_dwordx4 v16, s[4:7], s44 offen lds
    s_add_u32 m0, s45, 2048
    s_mov_b32 s44, 262144
    buffer_load_dwordx4 v16, s[4:7], s44 offen lds
    s_add_u32 m0, s45, 3072
    s_mov_b32 s44, 393216
    buffer_load_dwordx4 v16, s[4:7], s44 offen lds
    s_add_u32 m0, s45, 4096
    s_mov_b32 s44, 524288
    buffer_load_dwordx4 v16, s[4:7], s44 offen lds
    s_add_u32 m0, s45, 5120
    s_mov_b32 s44, 655360
    buffer_load_dwordx4 v16, s[4:7], s44 offen lds
    s_add_u32 m0, s45, 6144
    s_mov_b32 s44, 786432
    buffer_load_dwordx4 v16, s[4:7], s44 offen lds
    s_add_u32 m0, s45, 7168
    s_mov_b32 s44, 917504
    buffer_load_dwordx4 v16, s[4:7], s44 offen lds
    s_add_u32 m0, s45, 8192
    s_mov_b32 s44, 1048576
    buffer_load_dwordx4 v16, s[4:7], s44 offen lds
    s_add_u32 m0, s45, 9216
    s_mov_b32 s44, 1179648
    buffer_load_dwordx4 v16, s[4:7], s44 offen lds
    s_add_u32 m0, s45, 10240
    s_mov_b32 s44, 1310720
    buffer_load_dwordx4 v16, s[4:7], s44 offen lds
    s_add_u32 m0, s45, 11264
    s_mov_b32 s44, 1441792
    buffer_load_dwordx4 v16, s[4:7], s44 offen lds
    s_add_u32 m0, s45, 12288
    s_mov_b32 s44, 1572864
    buffer_load_dwordx4 v16, s[4:7], s44 offen lds
    s_add_u32 m0, s45, 13312
    s_mov_b32 s44, 1703936
    buffer_load_dwordx4 v16, s[4:7], s44 offen lds
    s_add_u32 m0, s45, 14336
    s_mov_b32 s44, 1835008
    buffer_load_dwordx4 v16, s[4:7], s44 offen lds
    s_add_u32 m0, s45, 15360
    s_mov_b32 s44, 1966080
    buffer_load_dwordx4 v16, s[4:7], s44 offen lds
    s_add_u32 m0, s45, 16384
    s_mov_b32 s44, 2097152
    buffer_load_dwordx4 v16, s[4:7], s44 offen lds
    s_add_u32 m0, s45, 17408
    s_mov_b32 s44, 2228224
    buffer_load_dwordx4 v16, s[4:7], s44 offen lds
    s_add_u32 m0, s45, 18432
    s_mov_b32 s44, 2359296
    buffer_load_dwordx4 v16, s[4:7], s44 offen lds
    s_add_u32 m0, s45, 19456
    s_mov_b32 s44, 2490368
    buffer_load_dwordx4 v16, s[4:7], s44 offen lds
    s_add_u32 m0, s45, 20480
    s_mov_b32 s44, 2621440
    buffer_load_dwordx4 v16, s[4:7], s44 offen lds
    s_add_u32 m0, s45, 21504
    s_mov_b32 s44, 2752512
    buffer_load_dwordx4 v16, s[4:7], s44 offen lds
    s_add_u32 m0, s45, 22528
    s_mov_b32 s44, 2883584
    buffer_load_dwordx4 v16, s[4:7], s44 offen lds
    s_add_u32 m0, s45, 23552
    s_mov_b32 s44, 3014656
    buffer_load_dwordx4 v16, s[4:7], s44 offen lds
    s_add_u32 m0, s45, 24576
    s_mov_b32 s44, 3145728
    buffer_load_dwordx4 v16, s[4:7], s44 offen lds
    s_add_u32 m0, s45, 25600
    s_mov_b32 s44, 3276800
    buffer_load_dwordx4 v16, s[4:7], s44 offen lds
    s_add_u32 m0, s45, 26624
    s_mov_b32 s44, 3407872
    buffer_load_dwordx4 v16, s[4:7], s44 offen lds
    s_add_u32 m0, s45, 27648
    s_mov_b32 s44, 3538944
    buffer_load_dwordx4 v16, s[4:7], s44 offen lds
    s_add_u32 m0, s45, 28672
    s_mov_b32 s44, 3670016
    buffer_load_dwordx4 v16, s[4:7], s44 offen lds
    s_add_u32 m0, s45, 29696
    s_mov_b32 s44, 3801088
    buffer_load_dwordx4 v16, s[4:7], s44 offen lds
    s_add_u32 m0, s45, 30720
    s_mov_b32 s44, 3932160
    buffer_load_dwordx4 v16, s[4:7], s44 offen lds
    s_add_u32 m0, s45, 31744
    s_mov_b32 s44, 4063232
    buffer_load_dwordx4 v16, s[4:7], s44 offen lds
    s_waitcnt vmcnt(16)
    ds_read_b64_tr_b16 a[0:1], v17 offset:0
    ds_read_b64_tr_b16 a[2:3], v17 offset:256
    ds_read_b64_tr_b16 a[4:5], v17 offset:1024
    ds_read_b64_tr_b16 a[6:7], v17 offset:1280
    ds_read_b64_tr_b16 a[8:9], v17 offset:2048
    ds_read_b64_tr_b16 a[10:11], v17 offset:2304
    ds_read_b64_tr_b16 a[12:13], v17 offset:3072
    ds_read_b64_tr_b16 a[14:15], v17 offset:3328
    s_waitcnt lgkmcnt(0)
    ds_read_b64_tr_b16 a[16:17], v17 offset:4096
    ds_read_b64_tr_b16 a[18:19], v17 offset:4352
    ds_read_b64_tr_b16 a[20:21], v17 offset:5120
    ds_read_b64_tr_b16 a[22:23], v17 offset:5376
    ds_read_b64_tr_b16 a[24:25], v17 offset:6144
    ds_read_b64_tr_b16 a[26:27], v17 offset:6400
    ds_read_b64_tr_b16 a[28:29], v17 offset:7168
    ds_read_b64_tr_b16 a[30:31], v17 offset:7424
    s_waitcnt lgkmcnt(0)
    ds_read_b64_tr_b16 a[32:33], v17 offset:8192
    ds_read_b64_tr_b16 a[34:35], v17 offset:8448
    ds_read_b64_tr_b16 a[36:37], v17 offset:9216
    ds_read_b64_tr_b16 a[38:39], v17 offset:9472
    ds_read_b64_tr_b16 a[40:41], v17 offset:10240
    ds_read_b64_tr_b16 a[42:43], v17 offset:10496
    ds_read_b64_tr_b16 a[44:45], v17 offset:11264
    ds_read_b64_tr_b16 a[46:47], v17 offset:11520
    s_waitcnt lgkmcnt(0)
    ds_read_b64_tr_b16 a[48:49], v17 offset:12288
    ds_read_b64_tr_b16 a[50:51], v17 offset:12544
    ds_read_b64_tr_b16 a[52:53], v17 offset:13312
    ds_read_b64_tr_b16 a[54:55], v17 offset:13568
    ds_read_b64_tr_b16 a[56:57], v17 offset:14336
    ds_read_b64_tr_b16 a[58:59], v17 offset:14592
    ds_read_b64_tr_b16 a[60:61], v17 offset:15360
    ds_read_b64_tr_b16 a[62:63], v17 offset:15616
    s_waitcnt lgkmcnt(0)
    s_add_u32 m0, s45, 0
    s_mov_b32 s44, 4194304
    buffer_load_dwordx4 v16, s[4:7], s44 offen lds
    s_add_u32 m0, s45, 1024
    s_mov_b32 s44, 4325376
    buffer_load_dwordx4 v16, s[4:7], s44 offen lds
    s_add_u32 m0, s45, 2048
    s_mov_b32 s44, 4456448
    buffer_load_dwordx4 v16, s[4:7], s44 offen lds
    s_add_u32 m0, s45, 3072
    s_mov_b32 s44, 4587520
    buffer_load_dwordx4 v16, s[4:7], s44 offen lds
    s_add_u32 m0, s45, 4096
    s_mov_b32 s44, 4718592
    buffer_load_dwordx4 v16, s[4:7], s44 offen lds
    s_add_u32 m0, s45, 5120
    s_mov_b32 s44, 4849664
    buffer_load_dwordx4 v16, s[4:7], s44 offen lds
    s_add_u32 m0, s45, 6144
    s_mov_b32 s44, 4980736
    buffer_load_dwordx4 v16, s[4:7], s44 offen lds
    s_add_u32 m0, s45, 7168
    s_mov_b32 s44, 5111808
    buffer_load_dwordx4 v16, s[4:7], s44 offen lds
    s_add_u32 m0, s45, 8192
    s_mov_b32 s44, 5242880
    buffer_load_dwordx4 v16, s[4:7], s44 offen lds
    s_add_u32 m0, s45, 9216
    s_mov_b32 s44, 5373952
    buffer_load_dwordx4 v16, s[4:7], s44 offen lds
    s_add_u32 m0, s45, 10240
    s_mov_b32 s44, 5505024
    buffer_load_dwordx4 v16, s[4:7], s44 offen lds
    s_add_u32 m0, s45, 11264
    s_mov_b32 s44, 5636096
    buffer_load_dwordx4 v16, s[4:7], s44 offen lds
    s_add_u32 m0, s45, 12288
    s_mov_b32 s44, 5767168
    buffer_load_dwordx4 v16, s[4:7], s44 offen lds
    s_add_u32 m0, s45, 13312
    s_mov_b32 s44, 5898240
    buffer_load_dwordx4 v16, s[4:7], s44 offen lds
    s_add_u32 m0, s45, 14336
    s_mov_b32 s44, 6029312
    buffer_load_dwordx4 v16, s[4:7], s44 offen lds
    s_add_u32 m0, s45, 15360
    s_mov_b32 s44, 6160384
    buffer_load_dwordx4 v16, s[4:7], s44 offen lds
    s_waitcnt vmcnt(16)
    ds_read_b64_tr_b16 a[64:65], v17 offset:16384
    ds_read_b64_tr_b16 a[66:67], v17 offset:16640
    ds_read_b64_tr_b16 a[68:69], v17 offset:17408
    ds_read_b64_tr_b16 a[70:71], v17 offset:17664
    ds_read_b64_tr_b16 a[72:73], v17 offset:18432
    ds_read_b64_tr_b16 a[74:75], v17 offset:18688
    ds_read_b64_tr_b16 a[76:77], v17 offset:19456
    ds_read_b64_tr_b16 a[78:79], v17 offset:19712
    s_waitcnt lgkmcnt(0)
    ds_read_b64_tr_b16 a[80:81], v17 offset:20480
    ds_read_b64_tr_b16 a[82:83], v17 offset:20736
    ds_read_b64_tr_b16 a[84:85], v17 offset:21504
    ds_read_b64_tr_b16 a[86:87], v17 offset:21760
    ds_read_b64_tr_b16 a[88:89], v17 offset:22528
    ds_read_b64_tr_b16 a[90:91], v17 offset:22784
    ds_read_b64_tr_b16 a[92:93], v17 offset:23552
    ds_read_b64_tr_b16 a[94:95], v17 offset:23808
    s_waitcnt lgkmcnt(0)
    ds_read_b64_tr_b16 a[96:97], v17 offset:24576
    ds_read_b64_tr_b16 a[98:99], v17 offset:24832
    ds_read_b64_tr_b16 a[100:101], v17 offset:25600
    ds_read_b64_tr_b16 a[102:103], v17 offset:25856
    ds_read_b64_tr_b16 a[104:105], v17 offset:26624
    ds_read_b64_tr_b16 a[106:107], v17 offset:26880
    ds_read_b64_tr_b16 a[108:109], v17 offset:27648
    ds_read_b64_tr_b16 a[110:111], v17 offset:27904
    s_waitcnt lgkmcnt(0)
    ds_read_b64_tr_b16 a[112:113], v17 offset:28672
    ds_read_b64_tr_b16 a[114:115], v17 offset:28928
    ds_read_b64_tr_b16 a[116:117], v17 offset:29696
    ds_read_b64_tr_b16 a[118:119], v17 offset:29952
    ds_read_b64_tr_b16 a[120:121], v17 offset:30720
    ds_read_b64_tr_b16 a[122:123], v17 offset:30976
    ds_read_b64_tr_b16 a[124:125], v17 offset:31744
    ds_read_b64_tr_b16 a[126:127], v17 offset:32000
    s_waitcnt lgkmcnt(0)
    s_add_u32 m0, s45, 16384
    s_mov_b32 s44, 6291456
    buffer_load_dwordx4 v16, s[4:7], s44 offen lds
    s_add_u32 m0, s45, 17408
    s_mov_b32 s44, 6422528
    buffer_load_dwordx4 v16, s[4:7], s44 offen lds
    s_add_u32 m0, s45, 18432
    s_mov_b32 s44, 6553600
    buffer_load_dwordx4 v16, s[4:7], s44 offen lds
    s_add_u32 m0, s45, 19456
    s_mov_b32 s44, 6684672
    buffer_load_dwordx4 v16, s[4:7], s44 offen lds
    s_add_u32 m0, s45, 20480
    s_mov_b32 s44, 6815744
    buffer_load_dwordx4 v16, s[4:7], s44 offen lds
    s_add_u32 m0, s45, 21504
    s_mov_b32 s44, 6946816
    buffer_load_dwordx4 v16, s[4:7], s44 offen lds
    s_add_u32 m0, s45, 22528
    s_mov_b32 s44, 7077888
    buffer_load_dwordx4 v16, s[4:7], s44 offen lds
    s_add_u32 m0, s45, 23552
    s_mov_b32 s44, 7208960
    buffer_load_dwordx4 v16, s[4:7], s44 offen lds
    s_add_u32 m0, s45, 24576
    s_mov_b32 s44, 7340032
    buffer_load_dwordx4 v16, s[4:7], s44 offen lds
    s_add_u32 m0, s45, 25600
    s_mov_b32 s44, 7471104
    buffer_load_dwordx4 v16, s[4:7], s44 offen lds
    s_add_u32 m0, s45, 26624
    s_mov_b32 s44, 7602176
    buffer_load_dwordx4 v16, s[4:7], s44 offen lds
    s_add_u32 m0, s45, 27648
    s_mov_b32 s44, 7733248
    buffer_load_dwordx4 v16, s[4:7], s44 offen lds
    s_add_u32 m0, s45, 28672
    s_mov_b32 s44, 7864320
    buffer_load_dwordx4 v16, s[4:7], s44 offen lds
    s_add_u32 m0, s45, 29696
    s_mov_b32 s44, 7995392
    buffer_load_dwordx4 v16, s[4:7], s44 offen lds
    s_add_u32 m0, s45, 30720
    s_mov_b32 s44, 8126464
    buffer_load_dwordx4 v16, s[4:7], s44 offen lds
    s_add_u32 m0, s45, 31744
    s_mov_b32 s44, 8257536
    buffer_load_dwordx4 v16, s[4:7], s44 offen lds
    s_waitcnt vmcnt(16)
    ds_read_b64_tr_b16 a[128:129], v17 offset:0
    ds_read_b64_tr_b16 a[130:131], v17 offset:256
    ds_read_b64_tr_b16 a[132:133], v17 offset:1024
    ds_read_b64_tr_b16 a[134:135], v17 offset:1280
    ds_read_b64_tr_b16 a[136:137], v17 offset:2048
    ds_read_b64_tr_b16 a[138:139], v17 offset:2304
    ds_read_b64_tr_b16 a[140:141], v17 offset:3072
    ds_read_b64_tr_b16 a[142:143], v17 offset:3328
    s_waitcnt lgkmcnt(0)
    ds_read_b64_tr_b16 a[144:145], v17 offset:4096
    ds_read_b64_tr_b16 a[146:147], v17 offset:4352
    ds_read_b64_tr_b16 a[148:149], v17 offset:5120
    ds_read_b64_tr_b16 a[150:151], v17 offset:5376
    ds_read_b64_tr_b16 a[152:153], v17 offset:6144
    ds_read_b64_tr_b16 a[154:155], v17 offset:6400
    ds_read_b64_tr_b16 a[156:157], v17 offset:7168
    ds_read_b64_tr_b16 a[158:159], v17 offset:7424
    s_waitcnt lgkmcnt(0)
    ds_read_b64_tr_b16 a[160:161], v17 offset:8192
    ds_read_b64_tr_b16 a[162:163], v17 offset:8448
    ds_read_b64_tr_b16 a[164:165], v17 offset:9216
    ds_read_b64_tr_b16 a[166:167], v17 offset:9472
    ds_read_b64_tr_b16 a[168:169], v17 offset:10240
    ds_read_b64_tr_b16 a[170:171], v17 offset:10496
    ds_read_b64_tr_b16 a[172:173], v17 offset:11264
    ds_read_b64_tr_b16 a[174:175], v17 offset:11520
    s_waitcnt lgkmcnt(0)
    ds_read_b64_tr_b16 a[176:177], v17 offset:12288
    ds_read_b64_tr_b16 a[178:179], v17 offset:12544
    ds_read_b64_tr_b16 a[180:181], v17 offset:13312
    ds_read_b64_tr_b16 a[182:183], v17 offset:13568
    ds_read_b64_tr_b16 a[184:185], v17 offset:14336
    ds_read_b64_tr_b16 a[186:187], v17 offset:14592
    ds_read_b64_tr_b16 a[188:189], v17 offset:15360
    ds_read_b64_tr_b16 a[190:191], v17 offset:15616
    s_waitcnt lgkmcnt(0)
    s_waitcnt vmcnt(0)
    ds_read_b64_tr_b16 a[192:193], v17 offset:16384
    ds_read_b64_tr_b16 a[194:195], v17 offset:16640
    ds_read_b64_tr_b16 a[196:197], v17 offset:17408
    ds_read_b64_tr_b16 a[198:199], v17 offset:17664
    ds_read_b64_tr_b16 a[200:201], v17 offset:18432
    ds_read_b64_tr_b16 a[202:203], v17 offset:18688
    ds_read_b64_tr_b16 a[204:205], v17 offset:19456
    ds_read_b64_tr_b16 a[206:207], v17 offset:19712
    s_waitcnt lgkmcnt(0)
    ds_read_b64_tr_b16 a[208:209], v17 offset:20480
    ds_read_b64_tr_b16 a[210:211], v17 offset:20736
    ds_read_b64_tr_b16 a[212:213], v17 offset:21504
    ds_read_b64_tr_b16 a[214:215], v17 offset:21760
    ds_read_b64_tr_b16 a[216:217], v17 offset:22528
    ds_read_b64_tr_b16 a[218:219], v17 offset:22784
    ds_read_b64_tr_b16 a[220:221], v17 offset:23552
    ds_read_b64_tr_b16 a[222:223], v17 offset:23808
    s_waitcnt lgkmcnt(0)
    ds_read_b64_tr_b16 a[224:225], v17 offset:24576
    ds_read_b64_tr_b16 a[226:227], v17 offset:24832
    ds_read_b64_tr_b16 a[228:229], v17 offset:25600
    ds_read_b64_tr_b16 a[230:231], v17 offset:25856
    ds_read_b64_tr_b16 a[232:233], v17 offset:26624
    ds_read_b64_tr_b16 a[234:235], v17 offset:26880
    ds_read_b64_tr_b16 a[236:237], v17 offset:27648
    ds_read_b64_tr_b16 a[238:239], v17 offset:27904
    s_waitcnt lgkmcnt(0)
    ds_read_b64_tr_b16 a[240:241], v17 offset:28672
    ds_read_b64_tr_b16 a[242:243], v17 offset:28928
    ds_read_b64_tr_b16 a[244:245], v17 offset:29696
    ds_read_b64_tr_b16 a[246:247], v17 offset:29952
    ds_read_b64_tr_b16 a[248:249], v17 offset:30720
    ds_read_b64_tr_b16 a[250:251], v17 offset:30976
    ds_read_b64_tr_b16 a[252:253], v17 offset:31744
    ds_read_b64_tr_b16 a[254:255], v17 offset:32000
    s_waitcnt lgkmcnt(0)
    s_barrier
    v_lshrrev_b32 v2, 3, v1
    s_lshl_b32 s43, s41, 3
    v_add_u32 v2, s43, v2
    v_bfe_u32 v3, v2, 1, 3
    v_and_b32 v4, 7, v1
    v_xor_b32 v3, v3, v4
    v_lshlrev_b32 v6, 11, v2
    v_lshl_add_u32 v6, v3, 4, v6
    s_lshl_b32 s46, s41, 10
    v_and_b32 v2, 15, v1
    v_bfe_u32 v3, v2, 1, 3
    v_lshrrev_b32 v4, 4, v1
    v_xor_b32 v3, v3, v4
    v_lshlrev_b32 v8, 7, v2
    v_lshl_add_u32 v8, v3, 4, v8
    v_xor_b32 v9, 64, v8
    v_add_u32 v10, 0x10000, v8
    v_add_u32 v11, 0x10000, v9
    v_mov_b32 v7, v5
    v_and_b32 v2, 31, v1
    v_bfe_u32 v3, v2, 1, 3
    v_lshrrev_b32 v4, 5, v1
    v_xor_b32 v3, v3, v4
    v_lshlrev_b32 v8, 7, v2
    v_lshl_add_u32 v8, v3, 4, v8
    v_xor_b32 v9, 32, v8
    v_xor_b32 v10, 64, v8
    v_xor_b32 v11, 96, v8
    v_add_u32 v12, 0x10000, v8
    v_add_u32 v13, 0x10000, v9
    v_add_u32 v14, 0x10000, v10
    v_add_u32 v15, 0x10000, v11
    v_bfe_u32 v3, v1, 4, 1
    v_lshlrev_b32 v7, 10, v3
    v_lshl_add_u32 v7, v4, 8, v7
    v_and_b32 v3, 15, v1
    v_lshl_add_u32 v7, v3, 4, v7
    s_lshl_b32 s47, s40, 2
    s_add_u32 s47, s47, s41
    s_mov_b32 s42, 0
    v_lshrrev_b32 v92, 4, v1
    v_and_b32 v93, 15, v1
    s_and_b32 s52, s41, 1
    s_lshr_b32 s53, s41, 1
    s_mov_b32 s54, 0x3e0293ee
    s_mov_b32 s55, 0
    s_mov_b32 s56, 0
    v_mov_b32 v97, 0xff7fffff
    v_and_b32 v2, 7, v93
    v_lshlrev_b32 v94, 7, v92
    v_lshl_add_u32 v94, v2, 4, v94
    v_and_b32 v2, 31, v1
    v_lshlrev_b32 v95, 3, v2
    v_lshrrev_b32 v2, 1, v92
    v_lshlrev_b32 v96, 10, v2
    v_and_b32 v2, 1, v92
    v_lshl_add_u32 v96, v2, 9, v96
    v_lshl_add_u32 v96, v93, 4, v96
    s_lshl_b32 s43, s40, 13
    s_lshl_b32 s44, s53, 12
    s_add_u32 s43, s43, s44
    s_lshl_b32 s44, s52, 8
    s_add_u32 s43, s43, s44
    s_add_u32 s43, s43, 134217728
    v_add_u32 v96, s43, v96
    s_lshl_b32 s43, s52, 4
    v_add_u32 v98, s43, v93
    v_lshlrev_b32 v2, 2, v92
    v_sub_u32 v98, v98, v2
    s_mov_b32 s28, 0
    s_mov_b32 s29, -1
    s_xor_b32 s44, s98, 1
    s_lshl_b32 s44, s44, 13
    s_lshl_b32 s43, s40, 7
    s_add_u32 s43, s43, s44
    s_add_u32 s43, s43, 70254592
    v_and_b32 v2, 3, v1
    v_bfe_u32 v3, v1, 2, 1
    v_lshlrev_b32 v99, 12, v3
    v_lshl_add_u32 v99, v2, 2, v99
    v_add_u32 v99, s43, v99
    v_and_b32 v2, 7, v1
    v_lshlrev_b32 v100, 2, v2
    s_add_u32 s43, s43, 16384
    v_add_u32 v100, s43, v100
    s_lshl_b32 s49, s47, 2
    s_add_u32 s49, s49, 70287360
    s_lshl_b32 s43, s41, 11
    s_add_u32 s43, s43, 131072
    v_add_u32 v101, s43, v7
    s_lshl_b32 s43, s52, 10
    s_add_u32 s43, s43, 131072
    v_add_u32 v102, s43, v5
    v_mov_b32 v16, 0
    s_mov_b32 s50, 0
    v_mov_b32 v104, 0x3f803f80
    v_mov_b32 v105, 0x3f803f80
    v_mov_b32 v106, 0x3f803f80
    v_mov_b32 v107, 0x3f803f80
    v_cmp_gt_i32 s[12:13], 0, v98
    v_cmp_gt_i32 s[14:15], 1, v98
    v_cmp_gt_i32 s[16:17], 2, v98
    v_cmp_gt_i32 s[18:19], 3, v98
    v_cmp_gt_i32 s[20:21], 16, v98
    v_cmp_gt_i32 s[22:23], 17, v98
    v_cmp_gt_i32 s[24:25], 18, v98
    v_cmp_gt_i32 s[26:27], 19, v98
    s_lshr_b32 s44, s47, 3
    s_xor_b32 s44, s44, s98
    s_and_b32 s44, s44, 1
    s_lshl_b32 s44, s44, 13
    s_lshl_b32 s58, s47, 18
    s_add_u32 s58, s58, s44
    s_add_u32 s58, s58, 0
    s_lshr_b32 s44, s47, 4
    s_xor_b32 s44, s44, s98
    s_and_b32 s44, s44, 1
    s_lshl_b32 s44, s44, 13
    s_lshl_b32 s59, s47, 17
    s_add_u32 s59, s59, s44
    s_add_u32 s59, s59, 71303168
    s_lshl_b32 s60, s41, 11
    s_add_u32 s60, s60, 139264
    s_lshl_b32 s61, s41, 10
    s_add_u32 s61, s61, 155648
    v_add_u32 v94, 155648, v94
    s_lshl_b32 s43, s53, 11
    s_add_u32 s43, s43, 156160
    v_add_u32 v95, s43, v95
    v_add_u32 v103, 139264, v5
    s_lshl_b32 s43, s53, 12
    s_add_u32 s43, s43, 147456
    v_add_u32 v240, s43, v5
    s_add_u32 m0, s46, 0
    s_nop 0
    buffer_load_dwordx4 v6, s[8:11], s50 offen offset:0 lds
    s_add_u32 m0, s46, 3968
    s_nop 0
    buffer_load_dwordx4 v6, s[8:11], s50 offen offset:128 lds
    s_add_u32 m0, s46, 7936
    s_nop 0
    buffer_load_dwordx4 v6, s[8:11], s50 offen offset:256 lds
    s_add_u32 m0, s46, 11904
    s_nop 0
    buffer_load_dwordx4 v6, s[8:11], s50 offen offset:384 lds
    s_add_u32 m0, s46, 15872
    s_nop 0
    buffer_load_dwordx4 v6, s[8:11], s50 offen offset:512 lds
    s_add_u32 m0, s46, 19840
    s_nop 0
    buffer_load_dwordx4 v6, s[8:11], s50 offen offset:640 lds
    s_add_u32 m0, s46, 23808
    s_nop 0
    buffer_load_dwordx4 v6, s[8:11], s50 offen offset:768 lds
    s_add_u32 m0, s46, 27776
    s_nop 0
    buffer_load_dwordx4 v6, s[8:11], s50 offen offset:896 lds
    s_add_u32 m0, s46, 31744
    s_nop 0
    buffer_load_dwordx4 v6, s[8:11], s50 offen offset:1024 lds
    s_add_u32 m0, s46, 35712
    s_nop 0
    buffer_load_dwordx4 v6, s[8:11], s50 offen offset:1152 lds
    s_add_u32 m0, s46, 39680
    s_nop 0
    buffer_load_dwordx4 v6, s[8:11], s50 offen offset:1280 lds
    s_add_u32 m0, s46, 43648
    s_nop 0
    buffer_load_dwordx4 v6, s[8:11], s50 offen offset:1408 lds
    s_add_u32 m0, s46, 47616
    s_nop 0
    buffer_load_dwordx4 v6, s[8:11], s50 offen offset:1536 lds
    s_add_u32 m0, s46, 51584
    s_nop 0
    buffer_load_dwordx4 v6, s[8:11], s50 offen offset:1664 lds
    s_add_u32 m0, s46, 55552
    s_nop 0
    buffer_load_dwordx4 v6, s[8:11], s50 offen offset:1792 lds
    s_add_u32 m0, s46, 59520
    s_nop 0
    buffer_load_dwordx4 v6, s[8:11], s50 offen offset:1920 lds
    s_waitcnt vmcnt(0)
mega_kernel_q_loop:
    s_barrier
    s_cmp_gt_i32 s55, s42
    s_cbranch_scc1 mega_kernel_q_kv0k
    mega_kernel_q_kv0w:
    buffer_load_dword v2, v99, s[84:87], 0 offen sc1
    s_waitcnt vmcnt(0)
    v_min_i32_dpp v2, v2, v2 quad_perm:[1,0,3,2] row_mask:0xf bank_mask:0xf
    s_nop 1
    v_min_i32_dpp v2, v2, v2 quad_perm:[2,3,0,1] row_mask:0xf bank_mask:0xf
    s_nop 1
    v_min_i32_dpp v2, v2, v2 row_ror:4 row_mask:0xf bank_mask:0xf
    s_nop 0
    v_readfirstlane_b32 s55, v2
    s_cmp_gt_i32 s55, s42
    s_cbranch_scc1 mega_kernel_q_kv0k
    s_sleep 4
    s_branch mega_kernel_q_kv0w
    mega_kernel_q_kv0k:
    s_add_u32 s51, s47, s42
    s_bfe_u32 s57, s51, 0x40002
    s_lshl_b32 s57, s57, 14
    s_and_b32 s66, s51, 3
    s_lshl_b32 s66, s66, 11
    s_add_u32 s66, s66, s57
    s_add_u32 s66, s66, s58
    s_add_u32 s67, s66, 33554432
    s_bfe_u32 s57, s51, 0x30003
    s_lshl_b32 s57, s57, 14
    s_and_b32 s68, s51, 7
    s_lshl_b32 s68, s68, 10
    s_add_u32 s68, s68, s57
    s_add_u32 s68, s68, s59
    s_add_u32 s50, s42, 1
    s_min_u32 s50, s50, 63
    s_lshl_b32 s50, s50, 16
    s_cmp_gt_i32 s56, s42
    s_cselect_b32 s30, 1, 0
    ds_read_b128 v[20:23], v8 offset:0
    ds_read_b128 v[24:27], v9 offset:0
    ds_read_b128 v[28:31], v10 offset:0
    ds_read_b128 v[32:35], v11 offset:0
    ds_read_b128 v[36:39], v8 offset:4096
    ds_read_b128 v[40:43], v9 offset:4096
    s_add_u32 m0, s60, 0
    s_waitcnt lgkmcnt(4)
    v_mfma_f32_32x32x16_bf16 v[52:67], a[0:3], v[20:23], 0
    ds_read_b128 v[44:47], v10 offset:4096
    buffer_load_dwordx4 v5, s[84:87], s66 offen offset:0 sc1 lds
    v_mfma_f32_32x32x16_bf16 v[52:67], a[4:7], v[24:27], v[52:67]
    ds_read_b128 v[48:51], v11 offset:4096
    s_add_u32 m0, s60, 0
    s_waitcnt lgkmcnt(4)
    v_mfma_f32_32x32x16_bf16 v[52:67], a[8:11], v[28:31], v[52:67]
    ds_read_b128 v[20:23], v8 offset:8192
    buffer_load_dwordx4 v5, s[84:87], s66 offen offset:1024 sc1 lds
    v_mfma_f32_32x32x16_bf16 v[52:67], a[12:15], v[32:35], v[52:67]
    ds_read_b128 v[24:27], v9 offset:8192
    s_add_u32 m0, s60, 8192
    s_waitcnt lgkmcnt(4)
    v_mfma_f32_32x32x16_bf16 v[52:67], a[16:19], v[36:39], v[52:67]
    ds_read_b128 v[28:31], v10 offset:8192
    buffer_load_dwordx4 v5, s[84:87], s67 offen offset:0 sc1 lds
    v_mfma_f32_32x32x16_bf16 v[52:67], a[20:23], v[40:43], v[52:67]
    ds_read_b128 v[32:35], v11 offset:8192
    s_add_u32 m0, s60, 8192
    s_waitcnt lgkmcnt(4)
    v_mfma_f32_32x32x16_bf16 v[52:67], a[24:27], v[44:47], v[52:67]
    ds_read_b128 v[36:39], v8 offset:12288
    buffer_load_dwordx4 v5, s[84:87], s67 offen offset:1024 sc1 lds
    v_mfma_f32_32x32x16_bf16 v[52:67], a[28:31], v[48:51], v[52:67]
    ds_read_b128 v[40:43], v9 offset:12288
    s_waitcnt lgkmcnt(4)
    v_mfma_f32_32x32x16_bf16 v[52:67], a[32:35], v[20:23], v[52:67]
    ds_read_b128 v[44:47], v10 offset:12288
    s_cmp_eq_u32 s30, 1
    s_cbranch_scc0 mega_kernel_q_ke0
    s_mov_b32 m0, s61
    s_nop 0
    buffer_load_dwordx4 v5, s[84:87], s68 offen sc1 lds
    mega_kernel_q_ke0:
    v_mfma_f32_32x32x16_bf16 v[52:67], a[36:39], v[24:27], v[52:67]
    ds_read_b128 v[48:51], v11 offset:12288
    s_add_u32 m0, s46, 65536
    s_waitcnt lgkmcnt(4)
    v_mfma_f32_32x32x16_bf16 v[52:67], a[40:43], v[28:31], v[52:67]
    ds_read_b128 v[20:23], v8 offset:16384
    buffer_load_dwordx4 v6, s[8:11], s50 offen offset:0 lds
    v_mfma_f32_32x32x16_bf16 v[52:67], a[44:47], v[32:35], v[52:67]
    ds_read_b128 v[24:27], v9 offset:16384
    s_add_u32 m0, s46, 69504
    s_waitcnt lgkmcnt(4)
    v_mfma_f32_32x32x16_bf16 v[52:67], a[48:51], v[36:39], v[52:67]
    ds_read_b128 v[28:31], v10 offset:16384
    buffer_load_dwordx4 v6, s[8:11], s50 offen offset:128 lds
    v_mfma_f32_32x32x16_bf16 v[52:67], a[52:55], v[40:43], v[52:67]
    ds_read_b128 v[32:35], v11 offset:16384
    s_add_u32 m0, s46, 73472
    s_waitcnt lgkmcnt(4)
    v_mfma_f32_32x32x16_bf16 v[52:67], a[56:59], v[44:47], v[52:67]
    ds_read_b128 v[36:39], v8 offset:20480
    buffer_load_dwordx4 v6, s[8:11], s50 offen offset:256 lds
    v_mfma_f32_32x32x16_bf16 v[52:67], a[60:63], v[48:51], v[52:67]
    ds_read_b128 v[40:43], v9 offset:20480
    s_add_u32 m0, s46, 77440
    s_waitcnt lgkmcnt(4)
    v_mfma_f32_32x32x16_bf16 v[52:67], a[64:67], v[20:23], v[52:67]
    ds_read_b128 v[44:47], v10 offset:20480
    buffer_load_dwordx4 v6, s[8:11], s50 offen offset:384 lds
    v_mfma_f32_32x32x16_bf16 v[52:67], a[68:71], v[24:27], v[52:67]
    ds_read_b128 v[48:51], v11 offset:20480
    s_add_u32 m0, s46, 81408
    s_waitcnt lgkmcnt(4)
    v_mfma_f32_32x32x16_bf16 v[52:67], a[72:75], v[28:31], v[52:67]
    ds_read_b128 v[20:23], v8 offset:24576
    buffer_load_dwordx4 v6, s[8:11], s50 offen offset:512 lds
    v_mfma_f32_32x32x16_bf16 v[52:67], a[76:79], v[32:35], v[52:67]
    ds_read_b128 v[24:27], v9 offset:24576
    s_add_u32 m0, s46, 85376
    s_waitcnt lgkmcnt(4)
    v_mfma_f32_32x32x16_bf16 v[52:67], a[80:83], v[36:39], v[52:67]
    ds_read_b128 v[28:31], v10 offset:24576
    buffer_load_dwordx4 v6, s[8:11], s50 offen offset:640 lds
    v_mfma_f32_32x32x16_bf16 v[52:67], a[84:87], v[40:43], v[52:67]
    ds_read_b128 v[32:35], v11 offset:24576
    s_add_u32 m0, s46, 89344
    s_waitcnt lgkmcnt(4)
    v_mfma_f32_32x32x16_bf16 v[52:67], a[88:91], v[44:47], v[52:67]
    ds_read_b128 v[36:39], v8 offset:28672
    buffer_load_dwordx4 v6, s[8:11], s50 offen offset:768 lds
    v_mfma_f32_32x32x16_bf16 v[52:67], a[92:95], v[48:51], v[52:67]
    ds_read_b128 v[40:43], v9 offset:28672
    s_add_u32 m0, s46, 93312
    s_waitcnt lgkmcnt(4)
    v_mfma_f32_32x32x16_bf16 v[52:67], a[96:99], v[20:23], v[52:67]
    ds_read_b128 v[44:47], v10 offset:28672
    buffer_load_dwordx4 v6, s[8:11], s50 offen offset:896 lds
    v_mfma_f32_32x32x16_bf16 v[52:67], a[100:103], v[24:27], v[52:67]
    ds_read_b128 v[48:51], v11 offset:28672
    s_add_u32 m0, s46, 97280
    s_waitcnt lgkmcnt(4)
    v_mfma_f32_32x32x16_bf16 v[52:67], a[104:107], v[28:31], v[52:67]
    ds_read_b128 v[20:23], v8 offset:32768
    buffer_load_dwordx4 v6, s[8:11], s50 offen offset:1024 lds
    v_mfma_f32_32x32x16_bf16 v[52:67], a[108:111], v[32:35], v[52:67]
    ds_read_b128 v[24:27], v9 offset:32768
    s_add_u32 m0, s46, 101248
    s_waitcnt lgkmcnt(4)
    v_mfma_f32_32x32x16_bf16 v[52:67], a[112:115], v[36:39], v[52:67]
    ds_read_b128 v[28:31], v10 offset:32768
    buffer_load_dwordx4 v6, s[8:11], s50 offen offset:1152 lds
    v_mfma_f32_32x32x16_bf16 v[52:67], a[116:119], v[40:43], v[52:67]
    ds_read_b128 v[32:35], v11 offset:32768
    s_add_u32 m0, s46, 105216
    s_waitcnt lgkmcnt(4)
    v_mfma_f32_32x32x16_bf16 v[52:67], a[120:123], v[44:47], v[52:67]
    ds_read_b128 v[36:39], v8 offset:36864
    buffer_load_dwordx4 v6, s[8:11], s50 offen offset:1280 lds
    v_mfma_f32_32x32x16_bf16 v[52:67], a[124:127], v[48:51], v[52:67]
    ds_read_b128 v[40:43], v9 offset:36864
    s_add_u32 m0, s46, 109184
    s_waitcnt lgkmcnt(4)
    v_mfma_f32_32x32x16_bf16 v[52:67], a[128:131], v[20:23], v[52:67]
    ds_read_b128 v[44:47], v10 offset:36864
    buffer_load_dwordx4 v6, s[8:11], s50 offen offset:1408 lds
    v_mfma_f32_32x32x16_bf16 v[52:67], a[132:135], v[24:27], v[52:67]
    ds_read_b128 v[48:51], v11 offset:36864
    s_add_u32 m0, s46, 113152
    s_waitcnt lgkmcnt(4)
    v_mfma_f32_32x32x16_bf16 v[52:67], a[136:139], v[28:31], v[52:67]
    ds_read_b128 v[20:23], v8 offset:40960
    buffer_load_dwordx4 v6, s[8:11], s50 offen offset:1536 lds
    v_mfma_f32_32x32x16_bf16 v[52:67], a[140:143], v[32:35], v[52:67]
    ds_read_b128 v[24:27], v9 offset:40960
    s_add_u32 m0, s46, 117120
    s_waitcnt lgkmcnt(4)
    v_mfma_f32_32x32x16_bf16 v[52:67], a[144:147], v[36:39], v[52:67]
    ds_read_b128 v[28:31], v10 offset:40960
    buffer_load_dwordx4 v6, s[8:11], s50 offen offset:1664 lds
    v_mfma_f32_32x32x16_bf16 v[52:67], a[148:151], v[40:43], v[52:67]
    ds_read_b128 v[32:35], v11 offset:40960
    s_add_u32 m0, s46, 121088
    s_waitcnt lgkmcnt(4)
    v_mfma_f32_32x32x16_bf16 v[52:67], a[152:155], v[44:47], v[52:67]
    ds_read_b128 v[36:39], v8 offset:45056
    buffer_load_dwordx4 v6, s[8:11], s50 offen offset:1792 lds
    v_mfma_f32_32x32x16_bf16 v[52:67], a[156:159], v[48:51], v[52:67]
    ds_read_b128 v[40:43], v9 offset:45056
    s_add_u32 m0, s46, 125056
    s_waitcnt lgkmcnt(4)
    v_mfma_f32_32x32x16_bf16 v[52:67], a[160:163], v[20:23], v[52:67]
    ds_read_b128 v[44:47], v10 offset:45056
    buffer_load_dwordx4 v6, s[8:11], s50 offen offset:1920 lds
    v_mfma_f32_32x32x16_bf16 v[52:67], a[164:167], v[24:27], v[52:67]
    ds_read_b128 v[48:51], v11 offset:45056
    s_waitcnt lgkmcnt(4)
    v_mfma_f32_32x32x16_bf16 v[52:67], a[168:171], v[28:31], v[52:67]
    ds_read_b128 v[20:23], v8 offset:49152
    v_mfma_f32_32x32x16_bf16 v[52:67], a[172:175], v[32:35], v[52:67]
    ds_read_b128 v[24:27], v9 offset:49152
    s_waitcnt lgkmcnt(4)
    v_mfma_f32_32x32x16_bf16 v[52:67], a[176:179], v[36:39], v[52:67]
    ds_read_b128 v[28:31], v10 offset:49152
    s_waitcnt vmcnt(20)
    v_mov_b32 v17, s42
    s_mov_b64 exec, 1
    buffer_store_dword v17, v16, s[84:87], s49 offen sc1
    s_mov_b64 exec, -1
    v_mfma_f32_32x32x16_bf16 v[52:67], a[180:183], v[40:43], v[52:67]
    ds_read_b128 v[32:35], v11 offset:49152
    s_waitcnt lgkmcnt(4)
    v_mfma_f32_32x32x16_bf16 v[52:67], a[184:187], v[44:47], v[52:67]
    ds_read_b128 v[36:39], v8 offset:53248
    v_mfma_f32_32x32x16_bf16 v[52:67], a[188:191], v[48:51], v[52:67]
    ds_read_b128 v[40:43], v9 offset:53248
    s_waitcnt lgkmcnt(4)
    v_mfma_f32_32x32x16_bf16 v[52:67], a[192:195], v[20:23], v[52:67]
    ds_read_b128 v[44:47], v10 offset:53248
    v_mfma_f32_32x32x16_bf16 v[52:67], a[196:199], v[24:27], v[52:67]
    ds_read_b128 v[48:51], v11 offset:53248
    s_waitcnt lgkmcnt(4)
    v_mfma_f32_32x32x16_bf16 v[52:67], a[200:203], v[28:31], v[52:67]
    ds_read_b128 v[20:23], v8 offset:57344
    v_mfma_f32_32x32x16_bf16 v[52:67], a[204:207], v[32:35], v[52:67]
    ds_read_b128 v[24:27], v9 offset:57344
    s_waitcnt lgkmcnt(4)
    v_mfma_f32_32x32x16_bf16 v[52:67], a[208:211], v[36:39], v[52:67]
    ds_read_b128 v[28:31], v10 offset:57344
    v_mfma_f32_32x32x16_bf16 v[52:67], a[212:215], v[40:43], v[52:67]
    ds_read_b128 v[32:35], v11 offset:57344
    s_waitcnt lgkmcnt(4)
    v_mfma_f32_32x32x16_bf16 v[52:67], a[216:219], v[44:47], v[52:67]
    ds_read_b128 v[36:39], v8 offset:61440
    v_mfma_f32_32x32x16_bf16 v[52:67], a[220:223], v[48:51], v[52:67]
    ds_read_b128 v[40:43], v9 offset:61440
    s_waitcnt lgkmcnt(4)
    v_mfma_f32_32x32x16_bf16 v[52:67], a[224:227], v[20:23], v[52:67]
    ds_read_b128 v[44:47], v10 offset:61440
    v_mfma_f32_32x32x16_bf16 v[52:67], a[228:231], v[24:27], v[52:67]
    ds_read_b128 v[48:51], v11 offset:61440
    s_waitcnt lgkmcnt(5)
    v_mfma_f32_32x32x16_bf16 v[52:67], a[232:235], v[28:31], v[52:67]
    s_waitcnt lgkmcnt(4)
    v_mfma_f32_32x32x16_bf16 v[52:67], a[236:239], v[32:35], v[52:67]
    s_waitcnt lgkmcnt(3)
    v_mfma_f32_32x32x16_bf16 v[52:67], a[240:243], v[36:39], v[52:67]
    s_waitcnt lgkmcnt(2)
    v_mfma_f32_32x32x16_bf16 v[52:67], a[244:247], v[40:43], v[52:67]
    s_waitcnt lgkmcnt(1)
    v_mfma_f32_32x32x16_bf16 v[52:67], a[248:251], v[44:47], v[52:67]
    s_waitcnt lgkmcnt(0)
    v_mfma_f32_32x32x16_bf16 v[52:67], a[252:255], v[48:51], v[52:67]
    s_cmp_eq_u32 s30, 1
    s_cbranch_scc1 mega_kernel_q_kl0
    s_cmp_gt_i32 s56, s42
    s_cbranch_scc1 mega_kernel_q_km0k
    mega_kernel_q_km0w:
    buffer_load_dword v2, v100, s[84:87], 0 offen sc1
    s_waitcnt vmcnt(0)
    v_min_i32_dpp v2, v2, v2 quad_perm:[1,0,3,2] row_mask:0xf bank_mask:0xf
    s_nop 1
    v_min_i32_dpp v2, v2, v2 quad_perm:[2,3,0,1] row_mask:0xf bank_mask:0xf
    s_nop 1
    v_min_i32_dpp v2, v2, v2 row_ror:4 row_mask:0xf bank_mask:0xf
    s_nop 0
    v_readfirstlane_b32 s56, v2
    s_cmp_gt_i32 s56, s42
    s_cbranch_scc1 mega_kernel_q_km0k
    s_sleep 2
    s_branch mega_kernel_q_km0w
    mega_kernel_q_km0k:
    s_mov_b32 m0, s61
    s_nop 0
    buffer_load_dwordx4 v5, s[84:87], s68 offen sc1 lds
mega_kernel_q_kl0:
    s_nop 9
    v_cvt_pk_bf16_f32 v84, v52, v53
    v_cvt_pk_bf16_f32 v85, v54, v55
    v_cvt_pk_bf16_f32 v86, v56, v57
    v_cvt_pk_bf16_f32 v87, v58, v59
    v_cvt_pk_bf16_f32 v88, v60, v61
    v_cvt_pk_bf16_f32 v89, v62, v63
    v_cvt_pk_bf16_f32 v90, v64, v65
    v_cvt_pk_bf16_f32 v91, v66, v67
    ds_write_b128 v101, v[84:87]
    ds_write_b128 v101, v[88:91] offset:512
    s_waitcnt lgkmcnt(0) vmcnt(0)
    s_barrier
    ds_read_b128 v[184:187], v102 offset:0
    ds_read_b128 v[112:115], v103 offset:0
    ds_read_b128 v[128:131], v103 offset:1024
    ds_read_b128 v[188:191], v102 offset:2048
    ds_read_b128 v[116:119], v103 offset:2048
    ds_read_b128 v[132:135], v103 offset:3072
    ds_read_b128 v[192:195], v102 offset:4096
    ds_read_b128 v[120:123], v103 offset:4096
    ds_read_b128 v[136:139], v103 offset:5120
    ds_read_b128 v[196:199], v102 offset:6144
    ds_read_b128 v[124:127], v103 offset:6144
    ds_read_b128 v[140:143], v103 offset:7168
    s_waitcnt lgkmcnt(9)
    v_mfma_f32_16x16x32_bf16 v[200:203], v[112:115], v[184:187], 0
    v_mfma_f32_16x16x32_bf16 v[204:207], v[128:131], v[184:187], 0
    ds_read_b128 v[160:163], v94 offset:0
    s_waitcnt lgkmcnt(7)
    v_mfma_f32_16x16x32_bf16 v[200:203], v[116:119], v[188:191], v[200:203]
    v_mfma_f32_16x16x32_bf16 v[204:207], v[132:135], v[188:191], v[204:207]
    ds_read_b128 v[164:167], v94 offset:1024
    s_waitcnt lgkmcnt(5)
    v_mfma_f32_16x16x32_bf16 v[200:203], v[120:123], v[192:195], v[200:203]
    v_mfma_f32_16x16x32_bf16 v[204:207], v[136:139], v[192:195], v[204:207]
    ds_read_b128 v[168:171], v94 offset:2048
    s_waitcnt lgkmcnt(3)
    v_mfma_f32_16x16x32_bf16 v[200:203], v[124:127], v[196:199], v[200:203]
    v_mfma_f32_16x16x32_bf16 v[204:207], v[140:143], v[196:199], v[204:207]
    ds_read_b128 v[172:175], v94 offset:3072
    s_waitcnt lgkmcnt(3)
    v_mfma_f32_16x16x32_bf16 v[208:211], v[160:163], v[184:187], 0
    ds_read_b128 v[144:147], v240 offset:0
    ds_read_b64 v[176:177], v95 offset:0
    s_waitcnt lgkmcnt(4)
    v_mfma_f32_16x16x32_bf16 v[208:211], v[164:167], v[188:191], v[208:211]
    ds_read_b128 v[148:151], v240 offset:1024
    ds_read_b64 v[178:179], v95 offset:256
    s_waitcnt lgkmcnt(5)
    v_mfma_f32_16x16x32_bf16 v[208:211], v[168:171], v[192:195], v[208:211]
    ds_read_b128 v[152:155], v240 offset:2048
    ds_read_b64 v[180:181], v95 offset:1024
    s_waitcnt lgkmcnt(6)
    v_mfma_f32_16x16x32_bf16 v[208:211], v[172:175], v[196:199], v[208:211]
    ds_read_b128 v[156:159], v240 offset:3072
    ds_read_b64 v[182:183], v95 offset:1280
    s_nop 3
    v_cndmask_b32 v200, v200, v97, s[12:13]
    v_cndmask_b32 v201, v201, v97, s[14:15]
    v_cndmask_b32 v202, v202, v97, s[16:17]
    v_cndmask_b32 v203, v203, v97, s[18:19]
    v_cndmask_b32 v204, v204, v97, s[20:21]
    v_cndmask_b32 v205, v205, v97, s[22:23]
    v_cndmask_b32 v206, v206, v97, s[24:25]
    v_cndmask_b32 v207, v207, v97, s[26:27]
    v_cndmask_b32 v208, v208, v97, s[28:29]
    v_cndmask_b32 v209, v209, v97, s[28:29]
    v_cndmask_b32 v210, v210, v97, s[28:29]
    v_cndmask_b32 v211, v211, v97, s[28:29]
    v_max3_f32 v236, v200, v201, v202
    v_max3_f32 v236, v236, v203, v204
    v_max3_f32 v236, v236, v205, v206
    v_max3_f32 v236, v236, v207, v208
    v_max3_f32 v236, v236, v209, v210
    v_max_f32 v237, v236, v211
    v_max_f32 v236, v236, v211
    s_nop 1
    v_permlane16_swap_b32 v236, v237
    s_nop 0
    v_max_f32 v238, v236, v237
    v_max_f32 v239, v236, v237
    s_nop 1
    v_permlane32_swap_b32 v238, v239
    s_nop 0
    v_max_f32 v236, v238, v239
    v_mul_f32 v236, s54, v236
    v_fma_f32 v200, v200, s54, -v236
    v_fma_f32 v201, v201, s54, -v236
    v_fma_f32 v202, v202, s54, -v236
    v_fma_f32 v203, v203, s54, -v236
    v_fma_f32 v204, v204, s54, -v236
    v_fma_f32 v205, v205, s54, -v236
    v_fma_f32 v206, v206, s54, -v236
    v_fma_f32 v207, v207, s54, -v236
    v_fma_f32 v208, v208, s54, -v236
    v_fma_f32 v209, v209, s54, -v236
    v_fma_f32 v210, v210, s54, -v236
    v_fma_f32 v211, v211, s54, -v236
    v_exp_f32 v200, v200
    v_exp_f32 v201, v201
    v_exp_f32 v202, v202
    v_exp_f32 v203, v203
    v_exp_f32 v204, v204
    v_exp_f32 v205, v205
    v_exp_f32 v206, v206
    v_exp_f32 v207, v207
    v_exp_f32 v208, v208
    v_exp_f32 v209, v209
    v_exp_f32 v210, v210
    v_exp_f32 v211, v211
    s_nop 0
    v_cvt_pk_bf16_f32 v212, v200, v201
    v_cvt_pk_bf16_f32 v213, v202, v203
    v_cvt_pk_bf16_f32 v214, v204, v205
    v_cvt_pk_bf16_f32 v215, v206, v207
    v_cvt_pk_bf16_f32 v216, v208, v209
    v_cvt_pk_bf16_f32 v217, v210, v211
    s_waitcnt lgkmcnt(0)
    s_nop 0
    v_mfma_f32_16x16x32_bf16 v[108:111], v[104:107], v[212:215], 0
    v_mfma_f32_16x16x32_bf16 v[220:223], v[144:147], v[212:215], 0
    v_mfma_f32_16x16x32_bf16 v[224:227], v[148:151], v[212:215], 0
    v_mfma_f32_16x16x32_bf16 v[228:231], v[152:155], v[212:215], 0
    v_mfma_f32_16x16x32_bf16 v[232:235], v[156:159], v[212:215], 0
    v_mfma_f32_16x16x16_bf16 v[108:111], v[104:105], v[216:217], v[108:111]
    v_mfma_f32_16x16x16_bf16 v[220:223], v[176:177], v[216:217], v[220:223]
    v_mfma_f32_16x16x16_bf16 v[224:227], v[178:179], v[216:217], v[224:227]
    v_mfma_f32_16x16x16_bf16 v[228:231], v[180:181], v[216:217], v[228:231]
    v_mfma_f32_16x16x16_bf16 v[232:235], v[182:183], v[216:217], v[232:235]
    s_lshl_b32 s51, s42, 18
    s_nop 2
    v_rcp_f32 v238, v108
    v_rcp_f32 v239, v109
    s_nop 1
    v_pk_mul_f32 v[220:221], v[220:221], v[238:239]
    v_pk_mul_f32 v[222:223], v[222:223], v[238:239]
    v_pk_mul_f32 v[224:225], v[224:225], v[238:239]
    v_pk_mul_f32 v[226:227], v[226:227], v[238:239]
    v_pk_mul_f32 v[228:229], v[228:229], v[238:239]
    v_pk_mul_f32 v[230:231], v[230:231], v[238:239]
    v_pk_mul_f32 v[232:233], v[232:233], v[238:239]
    v_pk_mul_f32 v[234:235], v[234:235], v[238:239]
    v_cvt_pk_bf16_f32 v200, v220, v221
    v_cvt_pk_bf16_f32 v201, v222, v223
    v_cvt_pk_bf16_f32 v202, v224, v225
    v_cvt_pk_bf16_f32 v203, v226, v227
    v_cvt_pk_bf16_f32 v204, v228, v229
    v_cvt_pk_bf16_f32 v205, v230, v231
    v_cvt_pk_bf16_f32 v206, v232, v233
    v_cvt_pk_bf16_f32 v207, v234, v235
    buffer_store_dwordx4 v[200:203], v96, s[84:87], s51 offen sc1
    buffer_store_dwordx4 v[204:207], v96, s[84:87], s51 offen offset:2048 sc1
    s_add_u32 s42, s42, 1
    s_cmp_gt_i32 s56, s42
    s_cbranch_scc1 mega_kernel_q_nf0
    s_waitcnt vmcnt(0)
    v_mov_b32 v17, s42
    s_mov_b64 exec, 1
    buffer_store_dword v17, v16, s[84:87], s49 offen sc1
    s_mov_b64 exec, -1
mega_kernel_q_nf0:
    s_barrier
    s_cmp_gt_i32 s55, s42
    s_cbranch_scc1 mega_kernel_q_kv1k
    mega_kernel_q_kv1w:
    buffer_load_dword v2, v99, s[84:87], 0 offen sc1
    s_waitcnt vmcnt(0)
    v_min_i32_dpp v2, v2, v2 quad_perm:[1,0,3,2] row_mask:0xf bank_mask:0xf
    s_nop 1
    v_min_i32_dpp v2, v2, v2 quad_perm:[2,3,0,1] row_mask:0xf bank_mask:0xf
    s_nop 1
    v_min_i32_dpp v2, v2, v2 row_ror:4 row_mask:0xf bank_mask:0xf
    s_nop 0
    v_readfirstlane_b32 s55, v2
    s_cmp_gt_i32 s55, s42
    s_cbranch_scc1 mega_kernel_q_kv1k
    s_sleep 4
    s_branch mega_kernel_q_kv1w
    mega_kernel_q_kv1k:
    s_add_u32 s51, s47, s42
    s_bfe_u32 s57, s51, 0x40002
    s_lshl_b32 s57, s57, 14
    s_and_b32 s66, s51, 3
    s_lshl_b32 s66, s66, 11
    s_add_u32 s66, s66, s57
    s_add_u32 s66, s66, s58
    s_add_u32 s67, s66, 33554432
    s_bfe_u32 s57, s51, 0x30003
    s_lshl_b32 s57, s57, 14
    s_and_b32 s68, s51, 7
    s_lshl_b32 s68, s68, 10
    s_add_u32 s68, s68, s57
    s_add_u32 s68, s68, s59
    s_add_u32 s50, s42, 1
    s_min_u32 s50, s50, 63
    s_lshl_b32 s50, s50, 16
    s_cmp_gt_i32 s56, s42
    s_cselect_b32 s30, 1, 0
    ds_read_b128 v[20:23], v12 offset:0
    ds_read_b128 v[24:27], v13 offset:0
    ds_read_b128 v[28:31], v14 offset:0
    ds_read_b128 v[32:35], v15 offset:0
    ds_read_b128 v[36:39], v12 offset:4096
    ds_read_b128 v[40:43], v13 offset:4096
    s_add_u32 m0, s60, 0
    s_waitcnt lgkmcnt(4)
    v_mfma_f32_32x32x16_bf16 v[52:67], a[0:3], v[20:23], 0
    ds_read_b128 v[44:47], v14 offset:4096
    buffer_load_dwordx4 v5, s[84:87], s66 offen offset:0 sc1 lds
    v_mfma_f32_32x32x16_bf16 v[52:67], a[4:7], v[24:27], v[52:67]
    ds_read_b128 v[48:51], v15 offset:4096
    s_add_u32 m0, s60, 0
    s_waitcnt lgkmcnt(4)
    v_mfma_f32_32x32x16_bf16 v[52:67], a[8:11], v[28:31], v[52:67]
    ds_read_b128 v[20:23], v12 offset:8192
    buffer_load_dwordx4 v5, s[84:87], s66 offen offset:1024 sc1 lds
    v_mfma_f32_32x32x16_bf16 v[52:67], a[12:15], v[32:35], v[52:67]
    ds_read_b128 v[24:27], v13 offset:8192
    s_add_u32 m0, s60, 8192
    s_waitcnt lgkmcnt(4)
    v_mfma_f32_32x32x16_bf16 v[52:67], a[16:19], v[36:39], v[52:67]
    ds_read_b128 v[28:31], v14 offset:8192
    buffer_load_dwordx4 v5, s[84:87], s67 offen offset:0 sc1 lds
    v_mfma_f32_32x32x16_bf16 v[52:67], a[20:23], v[40:43], v[52:67]
    ds_read_b128 v[32:35], v15 offset:8192
    s_add_u32 m0, s60, 8192
    s_waitcnt lgkmcnt(4)
    v_mfma_f32_32x32x16_bf16 v[52:67], a[24:27], v[44:47], v[52:67]
    ds_read_b128 v[36:39], v12 offset:12288
    buffer_load_dwordx4 v5, s[84:87], s67 offen offset:1024 sc1 lds
    v_mfma_f32_32x32x16_bf16 v[52:67], a[28:31], v[48:51], v[52:67]
    ds_read_b128 v[40:43], v13 offset:12288
    s_waitcnt lgkmcnt(4)
    v_mfma_f32_32x32x16_bf16 v[52:67], a[32:35], v[20:23], v[52:67]
    ds_read_b128 v[44:47], v14 offset:12288
    s_cmp_eq_u32 s30, 1
    s_cbranch_scc0 mega_kernel_q_ke1
    s_mov_b32 m0, s61
    s_nop 0
    buffer_load_dwordx4 v5, s[84:87], s68 offen sc1 lds
    mega_kernel_q_ke1:
    v_mfma_f32_32x32x16_bf16 v[52:67], a[36:39], v[24:27], v[52:67]
    ds_read_b128 v[48:51], v15 offset:12288
    s_add_u32 m0, s46, 0
    s_waitcnt lgkmcnt(4)
    v_mfma_f32_32x32x16_bf16 v[52:67], a[40:43], v[28:31], v[52:67]
    ds_read_b128 v[20:23], v12 offset:16384
    buffer_load_dwordx4 v6, s[8:11], s50 offen offset:0 lds
    v_mfma_f32_32x32x16_bf16 v[52:67], a[44:47], v[32:35], v[52:67]
    ds_read_b128 v[24:27], v13 offset:16384
    s_add_u32 m0, s46, 3968
    s_waitcnt lgkmcnt(4)
    v_mfma_f32_32x32x16_bf16 v[52:67], a[48:51], v[36:39], v[52:67]
    ds_read_b128 v[28:31], v14 offset:16384
    buffer_load_dwordx4 v6, s[8:11], s50 offen offset:128 lds
    v_mfma_f32_32x32x16_bf16 v[52:67], a[52:55], v[40:43], v[52:67]
    ds_read_b128 v[32:35], v15 offset:16384
    s_add_u32 m0, s46, 7936
    s_waitcnt lgkmcnt(4)
    v_mfma_f32_32x32x16_bf16 v[52:67], a[56:59], v[44:47], v[52:67]
    ds_read_b128 v[36:39], v12 offset:20480
    buffer_load_dwordx4 v6, s[8:11], s50 offen offset:256 lds
    v_mfma_f32_32x32x16_bf16 v[52:67], a[60:63], v[48:51], v[52:67]
    ds_read_b128 v[40:43], v13 offset:20480
    s_add_u32 m0, s46, 11904
    s_waitcnt lgkmcnt(4)
    v_mfma_f32_32x32x16_bf16 v[52:67], a[64:67], v[20:23], v[52:67]
    ds_read_b128 v[44:47], v14 offset:20480
    buffer_load_dwordx4 v6, s[8:11], s50 offen offset:384 lds
    v_mfma_f32_32x32x16_bf16 v[52:67], a[68:71], v[24:27], v[52:67]
    ds_read_b128 v[48:51], v15 offset:20480
    s_add_u32 m0, s46, 15872
    s_waitcnt lgkmcnt(4)
    v_mfma_f32_32x32x16_bf16 v[52:67], a[72:75], v[28:31], v[52:67]
    ds_read_b128 v[20:23], v12 offset:24576
    buffer_load_dwordx4 v6, s[8:11], s50 offen offset:512 lds
    v_mfma_f32_32x32x16_bf16 v[52:67], a[76:79], v[32:35], v[52:67]
    ds_read_b128 v[24:27], v13 offset:24576
    s_add_u32 m0, s46, 19840
    s_waitcnt lgkmcnt(4)
    v_mfma_f32_32x32x16_bf16 v[52:67], a[80:83], v[36:39], v[52:67]
    ds_read_b128 v[28:31], v14 offset:24576
    buffer_load_dwordx4 v6, s[8:11], s50 offen offset:640 lds
    v_mfma_f32_32x32x16_bf16 v[52:67], a[84:87], v[40:43], v[52:67]
    ds_read_b128 v[32:35], v15 offset:24576
    s_add_u32 m0, s46, 23808
    s_waitcnt lgkmcnt(4)
    v_mfma_f32_32x32x16_bf16 v[52:67], a[88:91], v[44:47], v[52:67]
    ds_read_b128 v[36:39], v12 offset:28672
    buffer_load_dwordx4 v6, s[8:11], s50 offen offset:768 lds
    v_mfma_f32_32x32x16_bf16 v[52:67], a[92:95], v[48:51], v[52:67]
    ds_read_b128 v[40:43], v13 offset:28672
    s_add_u32 m0, s46, 27776
    s_waitcnt lgkmcnt(4)
    v_mfma_f32_32x32x16_bf16 v[52:67], a[96:99], v[20:23], v[52:67]
    ds_read_b128 v[44:47], v14 offset:28672
    buffer_load_dwordx4 v6, s[8:11], s50 offen offset:896 lds
    v_mfma_f32_32x32x16_bf16 v[52:67], a[100:103], v[24:27], v[52:67]
    ds_read_b128 v[48:51], v15 offset:28672
    s_add_u32 m0, s46, 31744
    s_waitcnt lgkmcnt(4)
    v_mfma_f32_32x32x16_bf16 v[52:67], a[104:107], v[28:31], v[52:67]
    ds_read_b128 v[20:23], v12 offset:32768
    buffer_load_dwordx4 v6, s[8:11], s50 offen offset:1024 lds
    v_mfma_f32_32x32x16_bf16 v[52:67], a[108:111], v[32:35], v[52:67]
    ds_read_b128 v[24:27], v13 offset:32768
    s_add_u32 m0, s46, 35712
    s_waitcnt lgkmcnt(4)
    v_mfma_f32_32x32x16_bf16 v[52:67], a[112:115], v[36:39], v[52:67]
    ds_read_b128 v[28:31], v14 offset:32768
    buffer_load_dwordx4 v6, s[8:11], s50 offen offset:1152 lds
    v_mfma_f32_32x32x16_bf16 v[52:67], a[116:119], v[40:43], v[52:67]
    ds_read_b128 v[32:35], v15 offset:32768
    s_add_u32 m0, s46, 39680
    s_waitcnt lgkmcnt(4)
    v_mfma_f32_32x32x16_bf16 v[52:67], a[120:123], v[44:47], v[52:67]
    ds_read_b128 v[36:39], v12 offset:36864
    buffer_load_dwordx4 v6, s[8:11], s50 offen offset:1280 lds
    v_mfma_f32_32x32x16_bf16 v[52:67], a[124:127], v[48:51], v[52:67]
    ds_read_b128 v[40:43], v13 offset:36864
    s_add_u32 m0, s46, 43648
    s_waitcnt lgkmcnt(4)
    v_mfma_f32_32x32x16_bf16 v[52:67], a[128:131], v[20:23], v[52:67]
    ds_read_b128 v[44:47], v14 offset:36864
    buffer_load_dwordx4 v6, s[8:11], s50 offen offset:1408 lds
    v_mfma_f32_32x32x16_bf16 v[52:67], a[132:135], v[24:27], v[52:67]
    ds_read_b128 v[48:51], v15 offset:36864
    s_add_u32 m0, s46, 47616
    s_waitcnt lgkmcnt(4)
    v_mfma_f32_32x32x16_bf16 v[52:67], a[136:139], v[28:31], v[52:67]
    ds_read_b128 v[20:23], v12 offset:40960
    buffer_load_dwordx4 v6, s[8:11], s50 offen offset:1536 lds
    v_mfma_f32_32x32x16_bf16 v[52:67], a[140:143], v[32:35], v[52:67]
    ds_read_b128 v[24:27], v13 offset:40960
    s_add_u32 m0, s46, 51584
    s_waitcnt lgkmcnt(4)
    v_mfma_f32_32x32x16_bf16 v[52:67], a[144:147], v[36:39], v[52:67]
    ds_read_b128 v[28:31], v14 offset:40960
    buffer_load_dwordx4 v6, s[8:11], s50 offen offset:1664 lds
    v_mfma_f32_32x32x16_bf16 v[52:67], a[148:151], v[40:43], v[52:67]
    ds_read_b128 v[32:35], v15 offset:40960
    s_add_u32 m0, s46, 55552
    s_waitcnt lgkmcnt(4)
    v_mfma_f32_32x32x16_bf16 v[52:67], a[152:155], v[44:47], v[52:67]
    ds_read_b128 v[36:39], v12 offset:45056
    buffer_load_dwordx4 v6, s[8:11], s50 offen offset:1792 lds
    v_mfma_f32_32x32x16_bf16 v[52:67], a[156:159], v[48:51], v[52:67]
    ds_read_b128 v[40:43], v13 offset:45056
    s_add_u32 m0, s46, 59520
    s_waitcnt lgkmcnt(4)
    v_mfma_f32_32x32x16_bf16 v[52:67], a[160:163], v[20:23], v[52:67]
    ds_read_b128 v[44:47], v14 offset:45056
    buffer_load_dwordx4 v6, s[8:11], s50 offen offset:1920 lds
    v_mfma_f32_32x32x16_bf16 v[52:67], a[164:167], v[24:27], v[52:67]
    ds_read_b128 v[48:51], v15 offset:45056
    s_waitcnt lgkmcnt(4)
    v_mfma_f32_32x32x16_bf16 v[52:67], a[168:171], v[28:31], v[52:67]
    ds_read_b128 v[20:23], v12 offset:49152
    v_mfma_f32_32x32x16_bf16 v[52:67], a[172:175], v[32:35], v[52:67]
    ds_read_b128 v[24:27], v13 offset:49152
    s_waitcnt lgkmcnt(4)
    v_mfma_f32_32x32x16_bf16 v[52:67], a[176:179], v[36:39], v[52:67]
    ds_read_b128 v[28:31], v14 offset:49152
    s_waitcnt vmcnt(20)
    v_mov_b32 v17, s42
    s_mov_b64 exec, 1
    buffer_store_dword v17, v16, s[84:87], s49 offen sc1
    s_mov_b64 exec, -1
    v_mfma_f32_32x32x16_bf16 v[52:67], a[180:183], v[40:43], v[52:67]
    ds_read_b128 v[32:35], v15 offset:49152
    s_waitcnt lgkmcnt(4)
    v_mfma_f32_32x32x16_bf16 v[52:67], a[184:187], v[44:47], v[52:67]
    ds_read_b128 v[36:39], v12 offset:53248
    v_mfma_f32_32x32x16_bf16 v[52:67], a[188:191], v[48:51], v[52:67]
    ds_read_b128 v[40:43], v13 offset:53248
    s_waitcnt lgkmcnt(4)
    v_mfma_f32_32x32x16_bf16 v[52:67], a[192:195], v[20:23], v[52:67]
    ds_read_b128 v[44:47], v14 offset:53248
    v_mfma_f32_32x32x16_bf16 v[52:67], a[196:199], v[24:27], v[52:67]
    ds_read_b128 v[48:51], v15 offset:53248
    s_waitcnt lgkmcnt(4)
    v_mfma_f32_32x32x16_bf16 v[52:67], a[200:203], v[28:31], v[52:67]
    ds_read_b128 v[20:23], v12 offset:57344
    v_mfma_f32_32x32x16_bf16 v[52:67], a[204:207], v[32:35], v[52:67]
    ds_read_b128 v[24:27], v13 offset:57344
    s_waitcnt lgkmcnt(4)
    v_mfma_f32_32x32x16_bf16 v[52:67], a[208:211], v[36:39], v[52:67]
    ds_read_b128 v[28:31], v14 offset:57344
    v_mfma_f32_32x32x16_bf16 v[52:67], a[212:215], v[40:43], v[52:67]
    ds_read_b128 v[32:35], v15 offset:57344
    s_waitcnt lgkmcnt(4)
    v_mfma_f32_32x32x16_bf16 v[52:67], a[216:219], v[44:47], v[52:67]
    ds_read_b128 v[36:39], v12 offset:61440
    v_mfma_f32_32x32x16_bf16 v[52:67], a[220:223], v[48:51], v[52:67]
    ds_read_b128 v[40:43], v13 offset:61440
    s_waitcnt lgkmcnt(4)
    v_mfma_f32_32x32x16_bf16 v[52:67], a[224:227], v[20:23], v[52:67]
    ds_read_b128 v[44:47], v14 offset:61440
    v_mfma_f32_32x32x16_bf16 v[52:67], a[228:231], v[24:27], v[52:67]
    ds_read_b128 v[48:51], v15 offset:61440
    s_waitcnt lgkmcnt(5)
    v_mfma_f32_32x32x16_bf16 v[52:67], a[232:235], v[28:31], v[52:67]
    s_waitcnt lgkmcnt(4)
    v_mfma_f32_32x32x16_bf16 v[52:67], a[236:239], v[32:35], v[52:67]
    s_waitcnt lgkmcnt(3)
    v_mfma_f32_32x32x16_bf16 v[52:67], a[240:243], v[36:39], v[52:67]
    s_waitcnt lgkmcnt(2)
    v_mfma_f32_32x32x16_bf16 v[52:67], a[244:247], v[40:43], v[52:67]
    s_waitcnt lgkmcnt(1)
    v_mfma_f32_32x32x16_bf16 v[52:67], a[248:251], v[44:47], v[52:67]
    s_waitcnt lgkmcnt(0)
    v_mfma_f32_32x32x16_bf16 v[52:67], a[252:255], v[48:51], v[52:67]
    s_cmp_eq_u32 s30, 1
    s_cbranch_scc1 mega_kernel_q_kl1
    s_cmp_gt_i32 s56, s42
    s_cbranch_scc1 mega_kernel_q_km1k
    mega_kernel_q_km1w:
    buffer_load_dword v2, v100, s[84:87], 0 offen sc1
    s_waitcnt vmcnt(0)
    v_min_i32_dpp v2, v2, v2 quad_perm:[1,0,3,2] row_mask:0xf bank_mask:0xf
    s_nop 1
    v_min_i32_dpp v2, v2, v2 quad_perm:[2,3,0,1] row_mask:0xf bank_mask:0xf
    s_nop 1
    v_min_i32_dpp v2, v2, v2 row_ror:4 row_mask:0xf bank_mask:0xf
    s_nop 0
    v_readfirstlane_b32 s56, v2
    s_cmp_gt_i32 s56, s42
    s_cbranch_scc1 mega_kernel_q_km1k
    s_sleep 2
    s_branch mega_kernel_q_km1w
    mega_kernel_q_km1k:
    s_mov_b32 m0, s61
    s_nop 0
    buffer_load_dwordx4 v5, s[84:87], s68 offen sc1 lds
mega_kernel_q_kl1:
    s_nop 9
    v_cvt_pk_bf16_f32 v84, v52, v53
    v_cvt_pk_bf16_f32 v85, v54, v55
    v_cvt_pk_bf16_f32 v86, v56, v57
    v_cvt_pk_bf16_f32 v87, v58, v59
    v_cvt_pk_bf16_f32 v88, v60, v61
    v_cvt_pk_bf16_f32 v89, v62, v63
    v_cvt_pk_bf16_f32 v90, v64, v65
    v_cvt_pk_bf16_f32 v91, v66, v67
    ds_write_b128 v101, v[84:87]
    ds_write_b128 v101, v[88:91] offset:512
    s_waitcnt lgkmcnt(0) vmcnt(0)
    s_barrier
    ds_read_b128 v[184:187], v102 offset:0
    ds_read_b128 v[112:115], v103 offset:0
    ds_read_b128 v[128:131], v103 offset:1024
    ds_read_b128 v[188:191], v102 offset:2048
    ds_read_b128 v[116:119], v103 offset:2048
    ds_read_b128 v[132:135], v103 offset:3072
    ds_read_b128 v[192:195], v102 offset:4096
    ds_read_b128 v[120:123], v103 offset:4096
    ds_read_b128 v[136:139], v103 offset:5120
    ds_read_b128 v[196:199], v102 offset:6144
    ds_read_b128 v[124:127], v103 offset:6144
    ds_read_b128 v[140:143], v103 offset:7168
    s_waitcnt lgkmcnt(9)
    v_mfma_f32_16x16x32_bf16 v[200:203], v[112:115], v[184:187], 0
    v_mfma_f32_16x16x32_bf16 v[204:207], v[128:131], v[184:187], 0
    ds_read_b128 v[160:163], v94 offset:0
    s_waitcnt lgkmcnt(7)
    v_mfma_f32_16x16x32_bf16 v[200:203], v[116:119], v[188:191], v[200:203]
    v_mfma_f32_16x16x32_bf16 v[204:207], v[132:135], v[188:191], v[204:207]
    ds_read_b128 v[164:167], v94 offset:1024
    s_waitcnt lgkmcnt(5)
    v_mfma_f32_16x16x32_bf16 v[200:203], v[120:123], v[192:195], v[200:203]
    v_mfma_f32_16x16x32_bf16 v[204:207], v[136:139], v[192:195], v[204:207]
    ds_read_b128 v[168:171], v94 offset:2048
    s_waitcnt lgkmcnt(3)
    v_mfma_f32_16x16x32_bf16 v[200:203], v[124:127], v[196:199], v[200:203]
    v_mfma_f32_16x16x32_bf16 v[204:207], v[140:143], v[196:199], v[204:207]
    ds_read_b128 v[172:175], v94 offset:3072
    s_waitcnt lgkmcnt(3)
    v_mfma_f32_16x16x32_bf16 v[208:211], v[160:163], v[184:187], 0
    ds_read_b128 v[144:147], v240 offset:0
    ds_read_b64 v[176:177], v95 offset:0
    s_waitcnt lgkmcnt(4)
    v_mfma_f32_16x16x32_bf16 v[208:211], v[164:167], v[188:191], v[208:211]
    ds_read_b128 v[148:151], v240 offset:1024
    ds_read_b64 v[178:179], v95 offset:256
    s_waitcnt lgkmcnt(5)
    v_mfma_f32_16x16x32_bf16 v[208:211], v[168:171], v[192:195], v[208:211]
    ds_read_b128 v[152:155], v240 offset:2048
    ds_read_b64 v[180:181], v95 offset:1024
    s_waitcnt lgkmcnt(6)
    v_mfma_f32_16x16x32_bf16 v[208:211], v[172:175], v[196:199], v[208:211]
    ds_read_b128 v[156:159], v240 offset:3072
    ds_read_b64 v[182:183], v95 offset:1280
    s_nop 3
    v_cndmask_b32 v200, v200, v97, s[12:13]
    v_cndmask_b32 v201, v201, v97, s[14:15]
    v_cndmask_b32 v202, v202, v97, s[16:17]
    v_cndmask_b32 v203, v203, v97, s[18:19]
    v_cndmask_b32 v204, v204, v97, s[20:21]
    v_cndmask_b32 v205, v205, v97, s[22:23]
    v_cndmask_b32 v206, v206, v97, s[24:25]
    v_cndmask_b32 v207, v207, v97, s[26:27]
    v_cndmask_b32 v208, v208, v97, s[28:29]
    v_cndmask_b32 v209, v209, v97, s[28:29]
    v_cndmask_b32 v210, v210, v97, s[28:29]
    v_cndmask_b32 v211, v211, v97, s[28:29]
    v_max3_f32 v236, v200, v201, v202
    v_max3_f32 v236, v236, v203, v204
    v_max3_f32 v236, v236, v205, v206
    v_max3_f32 v236, v236, v207, v208
    v_max3_f32 v236, v236, v209, v210
    v_max_f32 v237, v236, v211
    v_max_f32 v236, v236, v211
    s_nop 1
    v_permlane16_swap_b32 v236, v237
    s_nop 0
    v_max_f32 v238, v236, v237
    v_max_f32 v239, v236, v237
    s_nop 1
    v_permlane32_swap_b32 v238, v239
    s_nop 0
    v_max_f32 v236, v238, v239
    v_mul_f32 v236, s54, v236
    v_fma_f32 v200, v200, s54, -v236
    v_fma_f32 v201, v201, s54, -v236
    v_fma_f32 v202, v202, s54, -v236
    v_fma_f32 v203, v203, s54, -v236
    v_fma_f32 v204, v204, s54, -v236
    v_fma_f32 v205, v205, s54, -v236
    v_fma_f32 v206, v206, s54, -v236
    v_fma_f32 v207, v207, s54, -v236
    v_fma_f32 v208, v208, s54, -v236
    v_fma_f32 v209, v209, s54, -v236
    v_fma_f32 v210, v210, s54, -v236
    v_fma_f32 v211, v211, s54, -v236
    v_exp_f32 v200, v200
    v_exp_f32 v201, v201
    v_exp_f32 v202, v202
    v_exp_f32 v203, v203
    v_exp_f32 v204, v204
    v_exp_f32 v205, v205
    v_exp_f32 v206, v206
    v_exp_f32 v207, v207
    v_exp_f32 v208, v208
    v_exp_f32 v209, v209
    v_exp_f32 v210, v210
    v_exp_f32 v211, v211
    s_nop 0
    v_cvt_pk_bf16_f32 v212, v200, v201
    v_cvt_pk_bf16_f32 v213, v202, v203
    v_cvt_pk_bf16_f32 v214, v204, v205
    v_cvt_pk_bf16_f32 v215, v206, v207
    v_cvt_pk_bf16_f32 v216, v208, v209
    v_cvt_pk_bf16_f32 v217, v210, v211
    s_waitcnt lgkmcnt(0)
    s_nop 0
    v_mfma_f32_16x16x32_bf16 v[108:111], v[104:107], v[212:215], 0
    v_mfma_f32_16x16x32_bf16 v[220:223], v[144:147], v[212:215], 0
    v_mfma_f32_16x16x32_bf16 v[224:227], v[148:151], v[212:215], 0
    v_mfma_f32_16x16x32_bf16 v[228:231], v[152:155], v[212:215], 0
    v_mfma_f32_16x16x32_bf16 v[232:235], v[156:159], v[212:215], 0
    v_mfma_f32_16x16x16_bf16 v[108:111], v[104:105], v[216:217], v[108:111]
    v_mfma_f32_16x16x16_bf16 v[220:223], v[176:177], v[216:217], v[220:223]
    v_mfma_f32_16x16x16_bf16 v[224:227], v[178:179], v[216:217], v[224:227]
    v_mfma_f32_16x16x16_bf16 v[228:231], v[180:181], v[216:217], v[228:231]
    v_mfma_f32_16x16x16_bf16 v[232:235], v[182:183], v[216:217], v[232:235]
    s_lshl_b32 s51, s42, 18
    s_nop 2
    v_rcp_f32 v238, v108
    v_rcp_f32 v239, v109
    s_nop 1
    v_pk_mul_f32 v[220:221], v[220:221], v[238:239]
    v_pk_mul_f32 v[222:223], v[222:223], v[238:239]
    v_pk_mul_f32 v[224:225], v[224:225], v[238:239]
    v_pk_mul_f32 v[226:227], v[226:227], v[238:239]
    v_pk_mul_f32 v[228:229], v[228:229], v[238:239]
    v_pk_mul_f32 v[230:231], v[230:231], v[238:239]
    v_pk_mul_f32 v[232:233], v[232:233], v[238:239]
    v_pk_mul_f32 v[234:235], v[234:235], v[238:239]
    v_cvt_pk_bf16_f32 v200, v220, v221
    v_cvt_pk_bf16_f32 v201, v222, v223
    v_cvt_pk_bf16_f32 v202, v224, v225
    v_cvt_pk_bf16_f32 v203, v226, v227
    v_cvt_pk_bf16_f32 v204, v228, v229
    v_cvt_pk_bf16_f32 v205, v230, v231
    v_cvt_pk_bf16_f32 v206, v232, v233
    v_cvt_pk_bf16_f32 v207, v234, v235
    buffer_store_dwordx4 v[200:203], v96, s[84:87], s51 offen sc1
    buffer_store_dwordx4 v[204:207], v96, s[84:87], s51 offen offset:2048 sc1
    s_add_u32 s42, s42, 1
    s_cmp_gt_i32 s56, s42
    s_cbranch_scc1 mega_kernel_q_nf1
    s_waitcnt vmcnt(0)
    v_mov_b32 v17, s42
    s_mov_b64 exec, 1
    buffer_store_dword v17, v16, s[84:87], s49 offen sc1
    s_mov_b64 exec, -1
mega_kernel_q_nf1:
    s_cmp_lt_u32 s42, 64
    s_cbranch_scc1 mega_kernel_q_loop
mega_kernel_q_quit:
    s_endpgm
mega_kernel_ro:
    s_load_dwordx2 s[4:5], s[0:1], 40
    s_load_dwordx2 s[8:9], s[0:1], 80
    v_lshrrev_b32 v2, 6, v0
    v_and_b32 v1, 63, v0
    v_readfirstlane_b32 s41, v2
    v_lshlrev_b32 v5, 4, v1
    s_mov_b32 s99, 0
    s_waitcnt lgkmcnt(0)
    s_mov_b32 s6, 8388608
    s_mov_b32 s7, 0x00020000
    s_mov_b32 s10, 8388608
    s_mov_b32 s11, 0x00020000
    s_lshl_b32 s43, s41, 21
    s_lshl_b32 s44, s40, 6
    s_add_u32 s48, s43, s44
    s_and_b32 s56, s40, 7
    s_lshl_b32 s56, s56, 7
    v_lshrrev_b32 v2, 2, v1
    v_and_b32 v3, 3, v1
    v_lshlrev_b32 v16, 11, v2
    v_lshl_add_u32 v16, v3, 4, v16
    v_add_u32 v16, s48, v16
    s_lshl_b32 s45, s41, 15
    v_bfe_u32 v17, v1, 2, 2
    v_lshrrev_b32 v18, 5, v1
    v_mul_u32_u24 v18, 4, v18
    v_add_u32 v17, v17, v18
    v_lshlrev_b32 v17, 6, v17
    v_bfe_u32 v18, v1, 4, 1
    v_lshl_add_u32 v17, v18, 5, v17
    v_lshl_add_u32 v17, v3, 3, v17
    v_add_u32 v17, s45, v17
    s_add_u32 m0, s45, 0
    s_add_u32 s44, s56, 0
    s_and_b32 s44, s44, 1023
    s_lshl_b32 s44, s44, 11
    buffer_load_dwordx4 v16, s[4:7], s44 offen lds
    s_add_u32 m0, s45, 1024
    s_add_u32 s44, s56, 16
    s_and_b32 s44, s44, 1023
    s_lshl_b32 s44, s44, 11
    buffer_load_dwordx4 v16, s[4:7], s44 offen lds
    s_add_u32 m0, s45, 2048
    s_add_u32 s44, s56, 32
    s_and_b32 s44, s44, 1023
    s_lshl_b32 s44, s44, 11
    buffer_load_dwordx4 v16, s[4:7], s44 offen lds
    s_add_u32 m0, s45, 3072
    s_add_u32 s44, s56, 48
    s_and_b32 s44, s44, 1023
    s_lshl_b32 s44, s44, 11
    buffer_load_dwordx4 v16, s[4:7], s44 offen lds
    s_add_u32 m0, s45, 4096
    s_add_u32 s44, s56, 64
    s_and_b32 s44, s44, 1023
    s_lshl_b32 s44, s44, 11
    buffer_load_dwordx4 v16, s[4:7], s44 offen lds
    s_add_u32 m0, s45, 5120
    s_add_u32 s44, s56, 80
    s_and_b32 s44, s44, 1023
    s_lshl_b32 s44, s44, 11
    buffer_load_dwordx4 v16, s[4:7], s44 offen lds
    s_add_u32 m0, s45, 6144
    s_add_u32 s44, s56, 96
    s_and_b32 s44, s44, 1023
    s_lshl_b32 s44, s44, 11
    buffer_load_dwordx4 v16, s[4:7], s44 offen lds
    s_add_u32 m0, s45, 7168
    s_add_u32 s44, s56, 112
    s_and_b32 s44, s44, 1023
    s_lshl_b32 s44, s44, 11
    buffer_load_dwordx4 v16, s[4:7], s44 offen lds
    s_add_u32 m0, s45, 8192
    s_add_u32 s44, s56, 128
    s_and_b32 s44, s44, 1023
    s_lshl_b32 s44, s44, 11
    buffer_load_dwordx4 v16, s[4:7], s44 offen lds
    s_add_u32 m0, s45, 9216
    s_add_u32 s44, s56, 144
    s_and_b32 s44, s44, 1023
    s_lshl_b32 s44, s44, 11
    buffer_load_dwordx4 v16, s[4:7], s44 offen lds
    s_add_u32 m0, s45, 10240
    s_add_u32 s44, s56, 160
    s_and_b32 s44, s44, 1023
    s_lshl_b32 s44, s44, 11
    buffer_load_dwordx4 v16, s[4:7], s44 offen lds
    s_add_u32 m0, s45, 11264
    s_add_u32 s44, s56, 176
    s_and_b32 s44, s44, 1023
    s_lshl_b32 s44, s44, 11
    buffer_load_dwordx4 v16, s[4:7], s44 offen lds
    s_add_u32 m0, s45, 12288
    s_add_u32 s44, s56, 192
    s_and_b32 s44, s44, 1023
    s_lshl_b32 s44, s44, 11
    buffer_load_dwordx4 v16, s[4:7], s44 offen lds
    s_add_u32 m0, s45, 13312
    s_add_u32 s44, s56, 208
    s_and_b32 s44, s44, 1023
    s_lshl_b32 s44, s44, 11
    buffer_load_dwordx4 v16, s[4:7], s44 offen lds
    s_add_u32 m0, s45, 14336
    s_add_u32 s44, s56, 224
    s_and_b32 s44, s44, 1023
    s_lshl_b32 s44, s44, 11
    buffer_load_dwordx4 v16, s[4:7], s44 offen lds
    s_add_u32 m0, s45, 15360
    s_add_u32 s44, s56, 240
    s_and_b32 s44, s44, 1023
    s_lshl_b32 s44, s44, 11
    buffer_load_dwordx4 v16, s[4:7], s44 offen lds
    s_add_u32 m0, s45, 16384
    s_add_u32 s44, s56, 256
    s_and_b32 s44, s44, 1023
    s_lshl_b32 s44, s44, 11
    buffer_load_dwordx4 v16, s[4:7], s44 offen lds
    s_add_u32 m0, s45, 17408
    s_add_u32 s44, s56, 272
    s_and_b32 s44, s44, 1023
    s_lshl_b32 s44, s44, 11
    buffer_load_dwordx4 v16, s[4:7], s44 offen lds
    s_add_u32 m0, s45, 18432
    s_add_u32 s44, s56, 288
    s_and_b32 s44, s44, 1023
    s_lshl_b32 s44, s44, 11
    buffer_load_dwordx4 v16, s[4:7], s44 offen lds
    s_add_u32 m0, s45, 19456
    s_add_u32 s44, s56, 304
    s_and_b32 s44, s44, 1023
    s_lshl_b32 s44, s44, 11
    buffer_load_dwordx4 v16, s[4:7], s44 offen lds
    s_add_u32 m0, s45, 20480
    s_add_u32 s44, s56, 320
    s_and_b32 s44, s44, 1023
    s_lshl_b32 s44, s44, 11
    buffer_load_dwordx4 v16, s[4:7], s44 offen lds
    s_add_u32 m0, s45, 21504
    s_add_u32 s44, s56, 336
    s_and_b32 s44, s44, 1023
    s_lshl_b32 s44, s44, 11
    buffer_load_dwordx4 v16, s[4:7], s44 offen lds
    s_add_u32 m0, s45, 22528
    s_add_u32 s44, s56, 352
    s_and_b32 s44, s44, 1023
    s_lshl_b32 s44, s44, 11
    buffer_load_dwordx4 v16, s[4:7], s44 offen lds
    s_add_u32 m0, s45, 23552
    s_add_u32 s44, s56, 368
    s_and_b32 s44, s44, 1023
    s_lshl_b32 s44, s44, 11
    buffer_load_dwordx4 v16, s[4:7], s44 offen lds
    s_add_u32 m0, s45, 24576
    s_add_u32 s44, s56, 384
    s_and_b32 s44, s44, 1023
    s_lshl_b32 s44, s44, 11
    buffer_load_dwordx4 v16, s[4:7], s44 offen lds
    s_add_u32 m0, s45, 25600
    s_add_u32 s44, s56, 400
    s_and_b32 s44, s44, 1023
    s_lshl_b32 s44, s44, 11
    buffer_load_dwordx4 v16, s[4:7], s44 offen lds
    s_add_u32 m0, s45, 26624
    s_add_u32 s44, s56, 416
    s_and_b32 s44, s44, 1023
    s_lshl_b32 s44, s44, 11
    buffer_load_dwordx4 v16, s[4:7], s44 offen lds
    s_add_u32 m0, s45, 27648
    s_add_u32 s44, s56, 432
    s_and_b32 s44, s44, 1023
    s_lshl_b32 s44, s44, 11
    buffer_load_dwordx4 v16, s[4:7], s44 offen lds
    s_add_u32 m0, s45, 28672
    s_add_u32 s44, s56, 448
    s_and_b32 s44, s44, 1023
    s_lshl_b32 s44, s44, 11
    buffer_load_dwordx4 v16, s[4:7], s44 offen lds
    s_add_u32 m0, s45, 29696
    s_add_u32 s44, s56, 464
    s_and_b32 s44, s44, 1023
    s_lshl_b32 s44, s44, 11
    buffer_load_dwordx4 v16, s[4:7], s44 offen lds
    s_add_u32 m0, s45, 30720
    s_add_u32 s44, s56, 480
    s_and_b32 s44, s44, 1023
    s_lshl_b32 s44, s44, 11
    buffer_load_dwordx4 v16, s[4:7], s44 offen lds
    s_add_u32 m0, s45, 31744
    s_add_u32 s44, s56, 496
    s_and_b32 s44, s44, 1023
    s_lshl_b32 s44, s44, 11
    buffer_load_dwordx4 v16, s[4:7], s44 offen lds
    s_waitcnt vmcnt(16)
    ds_read_b64_tr_b16 a[0:1], v17 offset:0
    ds_read_b64_tr_b16 a[2:3], v17 offset:1024
    ds_read_b64_tr_b16 a[4:5], v17 offset:512
    ds_read_b64_tr_b16 a[6:7], v17 offset:1536
    ds_read_b64_tr_b16 a[8:9], v17 offset:2048
    ds_read_b64_tr_b16 a[10:11], v17 offset:3072
    ds_read_b64_tr_b16 a[12:13], v17 offset:2560
    ds_read_b64_tr_b16 a[14:15], v17 offset:3584
    s_waitcnt lgkmcnt(0)
    ds_read_b64_tr_b16 a[16:17], v17 offset:4096
    ds_read_b64_tr_b16 a[18:19], v17 offset:5120
    ds_read_b64_tr_b16 a[20:21], v17 offset:4608
    ds_read_b64_tr_b16 a[22:23], v17 offset:5632
    ds_read_b64_tr_b16 a[24:25], v17 offset:6144
    ds_read_b64_tr_b16 a[26:27], v17 offset:7168
    ds_read_b64_tr_b16 a[28:29], v17 offset:6656
    ds_read_b64_tr_b16 a[30:31], v17 offset:7680
    s_waitcnt lgkmcnt(0)
    ds_read_b64_tr_b16 a[32:33], v17 offset:8192
    ds_read_b64_tr_b16 a[34:35], v17 offset:9216
    ds_read_b64_tr_b16 a[36:37], v17 offset:8704
    ds_read_b64_tr_b16 a[38:39], v17 offset:9728
    ds_read_b64_tr_b16 a[40:41], v17 offset:10240
    ds_read_b64_tr_b16 a[42:43], v17 offset:11264
    ds_read_b64_tr_b16 a[44:45], v17 offset:10752
    ds_read_b64_tr_b16 a[46:47], v17 offset:11776
    s_waitcnt lgkmcnt(0)
    ds_read_b64_tr_b16 a[48:49], v17 offset:12288
    ds_read_b64_tr_b16 a[50:51], v17 offset:13312
    ds_read_b64_tr_b16 a[52:53], v17 offset:12800
    ds_read_b64_tr_b16 a[54:55], v17 offset:13824
    ds_read_b64_tr_b16 a[56:57], v17 offset:14336
    ds_read_b64_tr_b16 a[58:59], v17 offset:15360
    ds_read_b64_tr_b16 a[60:61], v17 offset:14848
    ds_read_b64_tr_b16 a[62:63], v17 offset:15872
    s_waitcnt lgkmcnt(0)
    s_add_u32 m0, s45, 0
    s_add_u32 s44, s56, 512
    s_and_b32 s44, s44, 1023
    s_lshl_b32 s44, s44, 11
    buffer_load_dwordx4 v16, s[4:7], s44 offen lds
    s_add_u32 m0, s45, 1024
    s_add_u32 s44, s56, 528
    s_and_b32 s44, s44, 1023
    s_lshl_b32 s44, s44, 11
    buffer_load_dwordx4 v16, s[4:7], s44 offen lds
    s_add_u32 m0, s45, 2048
    s_add_u32 s44, s56, 544
    s_and_b32 s44, s44, 1023
    s_lshl_b32 s44, s44, 11
    buffer_load_dwordx4 v16, s[4:7], s44 offen lds
    s_add_u32 m0, s45, 3072
    s_add_u32 s44, s56, 560
    s_and_b32 s44, s44, 1023
    s_lshl_b32 s44, s44, 11
    buffer_load_dwordx4 v16, s[4:7], s44 offen lds
    s_add_u32 m0, s45, 4096
    s_add_u32 s44, s56, 576
    s_and_b32 s44, s44, 1023
    s_lshl_b32 s44, s44, 11
    buffer_load_dwordx4 v16, s[4:7], s44 offen lds
    s_add_u32 m0, s45, 5120
    s_add_u32 s44, s56, 592
    s_and_b32 s44, s44, 1023
    s_lshl_b32 s44, s44, 11
    buffer_load_dwordx4 v16, s[4:7], s44 offen lds
    s_add_u32 m0, s45, 6144
    s_add_u32 s44, s56, 608
    s_and_b32 s44, s44, 1023
    s_lshl_b32 s44, s44, 11
    buffer_load_dwordx4 v16, s[4:7], s44 offen lds
    s_add_u32 m0, s45, 7168
    s_add_u32 s44, s56, 624
    s_and_b32 s44, s44, 1023
    s_lshl_b32 s44, s44, 11
    buffer_load_dwordx4 v16, s[4:7], s44 offen lds
    s_add_u32 m0, s45, 8192
    s_add_u32 s44, s56, 640
    s_and_b32 s44, s44, 1023
    s_lshl_b32 s44, s44, 11
    buffer_load_dwordx4 v16, s[4:7], s44 offen lds
    s_add_u32 m0, s45, 9216
    s_add_u32 s44, s56, 656
    s_and_b32 s44, s44, 1023
    s_lshl_b32 s44, s44, 11
    buffer_load_dwordx4 v16, s[4:7], s44 offen lds
    s_add_u32 m0, s45, 10240
    s_add_u32 s44, s56, 672
    s_and_b32 s44, s44, 1023
    s_lshl_b32 s44, s44, 11
    buffer_load_dwordx4 v16, s[4:7], s44 offen lds
    s_add_u32 m0, s45, 11264
    s_add_u32 s44, s56, 688
    s_and_b32 s44, s44, 1023
    s_lshl_b32 s44, s44, 11
    buffer_load_dwordx4 v16, s[4:7], s44 offen lds
    s_add_u32 m0, s45, 12288
    s_add_u32 s44, s56, 704
    s_and_b32 s44, s44, 1023
    s_lshl_b32 s44, s44, 11
    buffer_load_dwordx4 v16, s[4:7], s44 offen lds
    s_add_u32 m0, s45, 13312
    s_add_u32 s44, s56, 720
    s_and_b32 s44, s44, 1023
    s_lshl_b32 s44, s44, 11
    buffer_load_dwordx4 v16, s[4:7], s44 offen lds
    s_add_u32 m0, s45, 14336
    s_add_u32 s44, s56, 736
    s_and_b32 s44, s44, 1023
    s_lshl_b32 s44, s44, 11
    buffer_load_dwordx4 v16, s[4:7], s44 offen lds
    s_add_u32 m0, s45, 15360
    s_add_u32 s44, s56, 752
    s_and_b32 s44, s44, 1023
    s_lshl_b32 s44, s44, 11
    buffer_load_dwordx4 v16, s[4:7], s44 offen lds
    s_waitcnt vmcnt(16)
    ds_read_b64_tr_b16 a[64:65], v17 offset:16384
    ds_read_b64_tr_b16 a[66:67], v17 offset:17408
    ds_read_b64_tr_b16 a[68:69], v17 offset:16896
    ds_read_b64_tr_b16 a[70:71], v17 offset:17920
    ds_read_b64_tr_b16 a[72:73], v17 offset:18432
    ds_read_b64_tr_b16 a[74:75], v17 offset:19456
    ds_read_b64_tr_b16 a[76:77], v17 offset:18944
    ds_read_b64_tr_b16 a[78:79], v17 offset:19968
    s_waitcnt lgkmcnt(0)
    ds_read_b64_tr_b16 a[80:81], v17 offset:20480
    ds_read_b64_tr_b16 a[82:83], v17 offset:21504
    ds_read_b64_tr_b16 a[84:85], v17 offset:20992
    ds_read_b64_tr_b16 a[86:87], v17 offset:22016
    ds_read_b64_tr_b16 a[88:89], v17 offset:22528
    ds_read_b64_tr_b16 a[90:91], v17 offset:23552
    ds_read_b64_tr_b16 a[92:93], v17 offset:23040
    ds_read_b64_tr_b16 a[94:95], v17 offset:24064
    s_waitcnt lgkmcnt(0)
    ds_read_b64_tr_b16 a[96:97], v17 offset:24576
    ds_read_b64_tr_b16 a[98:99], v17 offset:25600
    ds_read_b64_tr_b16 a[100:101], v17 offset:25088
    ds_read_b64_tr_b16 a[102:103], v17 offset:26112
    ds_read_b64_tr_b16 a[104:105], v17 offset:26624
    ds_read_b64_tr_b16 a[106:107], v17 offset:27648
    ds_read_b64_tr_b16 a[108:109], v17 offset:27136
    ds_read_b64_tr_b16 a[110:111], v17 offset:28160
    s_waitcnt lgkmcnt(0)
    ds_read_b64_tr_b16 a[112:113], v17 offset:28672
    ds_read_b64_tr_b16 a[114:115], v17 offset:29696
    ds_read_b64_tr_b16 a[116:117], v17 offset:29184
    ds_read_b64_tr_b16 a[118:119], v17 offset:30208
    ds_read_b64_tr_b16 a[120:121], v17 offset:30720
    ds_read_b64_tr_b16 a[122:123], v17 offset:31744
    ds_read_b64_tr_b16 a[124:125], v17 offset:31232
    ds_read_b64_tr_b16 a[126:127], v17 offset:32256
    s_waitcnt lgkmcnt(0)
    s_add_u32 m0, s45, 16384
    s_add_u32 s44, s56, 768
    s_and_b32 s44, s44, 1023
    s_lshl_b32 s44, s44, 11
    buffer_load_dwordx4 v16, s[4:7], s44 offen lds
    s_add_u32 m0, s45, 17408
    s_add_u32 s44, s56, 784
    s_and_b32 s44, s44, 1023
    s_lshl_b32 s44, s44, 11
    buffer_load_dwordx4 v16, s[4:7], s44 offen lds
    s_add_u32 m0, s45, 18432
    s_add_u32 s44, s56, 800
    s_and_b32 s44, s44, 1023
    s_lshl_b32 s44, s44, 11
    buffer_load_dwordx4 v16, s[4:7], s44 offen lds
    s_add_u32 m0, s45, 19456
    s_add_u32 s44, s56, 816
    s_and_b32 s44, s44, 1023
    s_lshl_b32 s44, s44, 11
    buffer_load_dwordx4 v16, s[4:7], s44 offen lds
    s_add_u32 m0, s45, 20480
    s_add_u32 s44, s56, 832
    s_and_b32 s44, s44, 1023
    s_lshl_b32 s44, s44, 11
    buffer_load_dwordx4 v16, s[4:7], s44 offen lds
    s_add_u32 m0, s45, 21504
    s_add_u32 s44, s56, 848
    s_and_b32 s44, s44, 1023
    s_lshl_b32 s44, s44, 11
    buffer_load_dwordx4 v16, s[4:7], s44 offen lds
    s_add_u32 m0, s45, 22528
    s_add_u32 s44, s56, 864
    s_and_b32 s44, s44, 1023
    s_lshl_b32 s44, s44, 11
    buffer_load_dwordx4 v16, s[4:7], s44 offen lds
    s_add_u32 m0, s45, 23552
    s_add_u32 s44, s56, 880
    s_and_b32 s44, s44, 1023
    s_lshl_b32 s44, s44, 11
    buffer_load_dwordx4 v16, s[4:7], s44 offen lds
    s_add_u32 m0, s45, 24576
    s_add_u32 s44, s56, 896
    s_and_b32 s44, s44, 1023
    s_lshl_b32 s44, s44, 11
    buffer_load_dwordx4 v16, s[4:7], s44 offen lds
    s_add_u32 m0, s45, 25600
    s_add_u32 s44, s56, 912
    s_and_b32 s44, s44, 1023
    s_lshl_b32 s44, s44, 11
    buffer_load_dwordx4 v16, s[4:7], s44 offen lds
    s_add_u32 m0, s45, 26624
    s_add_u32 s44, s56, 928
    s_and_b32 s44, s44, 1023
    s_lshl_b32 s44, s44, 11
    buffer_load_dwordx4 v16, s[4:7], s44 offen lds
    s_add_u32 m0, s45, 27648
    s_add_u32 s44, s56, 944
    s_and_b32 s44, s44, 1023
    s_lshl_b32 s44, s44, 11
    buffer_load_dwordx4 v16, s[4:7], s44 offen lds
    s_add_u32 m0, s45, 28672
    s_add_u32 s44, s56, 960
    s_and_b32 s44, s44, 1023
    s_lshl_b32 s44, s44, 11
    buffer_load_dwordx4 v16, s[4:7], s44 offen lds
    s_add_u32 m0, s45, 29696
    s_add_u32 s44, s56, 976
    s_and_b32 s44, s44, 1023
    s_lshl_b32 s44, s44, 11
    buffer_load_dwordx4 v16, s[4:7], s44 offen lds
    s_add_u32 m0, s45, 30720
    s_add_u32 s44, s56, 992
    s_and_b32 s44, s44, 1023
    s_lshl_b32 s44, s44, 11
    buffer_load_dwordx4 v16, s[4:7], s44 offen lds
    s_add_u32 m0, s45, 31744
    s_add_u32 s44, s56, 1008
    s_and_b32 s44, s44, 1023
    s_lshl_b32 s44, s44, 11
    buffer_load_dwordx4 v16, s[4:7], s44 offen lds
    s_waitcnt vmcnt(16)
    ds_read_b64_tr_b16 a[128:129], v17 offset:0
    ds_read_b64_tr_b16 a[130:131], v17 offset:1024
    ds_read_b64_tr_b16 a[132:133], v17 offset:512
    ds_read_b64_tr_b16 a[134:135], v17 offset:1536
    ds_read_b64_tr_b16 a[136:137], v17 offset:2048
    ds_read_b64_tr_b16 a[138:139], v17 offset:3072
    ds_read_b64_tr_b16 a[140:141], v17 offset:2560
    ds_read_b64_tr_b16 a[142:143], v17 offset:3584
    s_waitcnt lgkmcnt(0)
    ds_read_b64_tr_b16 a[144:145], v17 offset:4096
    ds_read_b64_tr_b16 a[146:147], v17 offset:5120
    ds_read_b64_tr_b16 a[148:149], v17 offset:4608
    ds_read_b64_tr_b16 a[150:151], v17 offset:5632
    ds_read_b64_tr_b16 a[152:153], v17 offset:6144
    ds_read_b64_tr_b16 a[154:155], v17 offset:7168
    ds_read_b64_tr_b16 a[156:157], v17 offset:6656
    ds_read_b64_tr_b16 a[158:159], v17 offset:7680
    s_waitcnt lgkmcnt(0)
    ds_read_b64_tr_b16 a[160:161], v17 offset:8192
    ds_read_b64_tr_b16 a[162:163], v17 offset:9216
    ds_read_b64_tr_b16 a[164:165], v17 offset:8704
    ds_read_b64_tr_b16 a[166:167], v17 offset:9728
    ds_read_b64_tr_b16 a[168:169], v17 offset:10240
    ds_read_b64_tr_b16 a[170:171], v17 offset:11264
    ds_read_b64_tr_b16 a[172:173], v17 offset:10752
    ds_read_b64_tr_b16 a[174:175], v17 offset:11776
    s_waitcnt lgkmcnt(0)
    ds_read_b64_tr_b16 a[176:177], v17 offset:12288
    ds_read_b64_tr_b16 a[178:179], v17 offset:13312
    ds_read_b64_tr_b16 a[180:181], v17 offset:12800
    ds_read_b64_tr_b16 a[182:183], v17 offset:13824
    ds_read_b64_tr_b16 a[184:185], v17 offset:14336
    ds_read_b64_tr_b16 a[186:187], v17 offset:15360
    ds_read_b64_tr_b16 a[188:189], v17 offset:14848
    ds_read_b64_tr_b16 a[190:191], v17 offset:15872
    s_waitcnt lgkmcnt(0)
    s_waitcnt vmcnt(0)
    ds_read_b64_tr_b16 a[192:193], v17 offset:16384
    ds_read_b64_tr_b16 a[194:195], v17 offset:17408
    ds_read_b64_tr_b16 a[196:197], v17 offset:16896
    ds_read_b64_tr_b16 a[198:199], v17 offset:17920
    ds_read_b64_tr_b16 a[200:201], v17 offset:18432
    ds_read_b64_tr_b16 a[202:203], v17 offset:19456
    ds_read_b64_tr_b16 a[204:205], v17 offset:18944
    ds_read_b64_tr_b16 a[206:207], v17 offset:19968
    s_waitcnt lgkmcnt(0)
    ds_read_b64_tr_b16 a[208:209], v17 offset:20480
    ds_read_b64_tr_b16 a[210:211], v17 offset:21504
    ds_read_b64_tr_b16 a[212:213], v17 offset:20992
    ds_read_b64_tr_b16 a[214:215], v17 offset:22016
    ds_read_b64_tr_b16 a[216:217], v17 offset:22528
    ds_read_b64_tr_b16 a[218:219], v17 offset:23552
    ds_read_b64_tr_b16 a[220:221], v17 offset:23040
    ds_read_b64_tr_b16 a[222:223], v17 offset:24064
    s_waitcnt lgkmcnt(0)
    ds_read_b64_tr_b16 a[224:225], v17 offset:24576
    ds_read_b64_tr_b16 a[226:227], v17 offset:25600
    ds_read_b64_tr_b16 a[228:229], v17 offset:25088
    ds_read_b64_tr_b16 a[230:231], v17 offset:26112
    ds_read_b64_tr_b16 a[232:233], v17 offset:26624
    ds_read_b64_tr_b16 a[234:235], v17 offset:27648
    ds_read_b64_tr_b16 a[236:237], v17 offset:27136
    ds_read_b64_tr_b16 a[238:239], v17 offset:28160
    s_waitcnt lgkmcnt(0)
    ds_read_b64_tr_b16 a[240:241], v17 offset:28672
    ds_read_b64_tr_b16 a[242:243], v17 offset:29696
    ds_read_b64_tr_b16 a[244:245], v17 offset:29184
    ds_read_b64_tr_b16 a[246:247], v17 offset:30208
    ds_read_b64_tr_b16 a[248:249], v17 offset:30720
    ds_read_b64_tr_b16 a[250:251], v17 offset:31744
    ds_read_b64_tr_b16 a[252:253], v17 offset:31232
    ds_read_b64_tr_b16 a[254:255], v17 offset:32256
    s_waitcnt lgkmcnt(0)
    s_barrier
    s_lshl_b32 s56, s56, 6
    s_lshl_b32 s43, s41, 16
    s_add_u32 s43, s43, 134217728
    v_add_u32 v6, s43, v5
    v_and_b32 v2, 31, v1
    v_lshlrev_b32 v7, 2, v2
    s_lshl_b32 s43, s41, 7
    s_add_u32 s43, s43, 70287360
    v_add_u32 v7, s43, v7
    s_lshl_b32 s43, s41, 12
    v_add_u32 v8, s43, v5
    v_bfe_u32 v2, v1, 1, 2
    v_lshlrev_b32 v9, 10, v2
    v_and_b32 v2, 1, v1
    v_lshl_add_u32 v9, v2, 9, v9
    v_lshrrev_b32 v3, 3, v1
    v_lshl_add_u32 v9, v3, 4, v9
    s_lshl_b32 s43, s41, 7
    v_add_u32 v9, s43, v9
    s_lshl_b32 s43, s41, 15
    s_lshl_b32 s44, s40, 6
    s_add_u32 s43, s43, s44
    v_lshlrev_b32 v10, 12, v3
    v_and_b32 v2, 7, v1
    v_lshl_add_u32 v10, v2, 3, v10
    v_add_u32 v10, s43, v10
    s_mov_b32 s42, 0
    s_mov_b32 s52, 0
    s_mov_b32 s53, 0
mega_kernel_o_cold:
    s_cmp_gt_i32 s52, s42
    s_cbranch_scc1 mega_kernel_o_fk
mega_kernel_o_fw:
    buffer_load_dword v2, v7, s[84:87], 0 offen sc1
    s_waitcnt vmcnt(0)
    v_min_i32_dpp v2, v2, v2 quad_perm:[1,0,3,2] row_mask:0xf bank_mask:0xf
    s_nop 1
    v_min_i32_dpp v2, v2, v2 quad_perm:[2,3,0,1] row_mask:0xf bank_mask:0xf
    s_nop 1
    v_min_i32_dpp v2, v2, v2 row_ror:4 row_mask:0xf bank_mask:0xf
    s_nop 1
    v_min_i32_dpp v2, v2, v2 row_ror:8 row_mask:0xf bank_mask:0xf
    s_nop 0
    v_readlane_b32 s52, v2, 0
    v_readlane_b32 s43, v2, 16
    s_nop 1
    s_min_i32 s52, s52, s43
    s_cmp_gt_i32 s52, s42
    s_cbranch_scc1 mega_kernel_o_fk
    s_sleep 2
    s_branch mega_kernel_o_fw
mega_kernel_o_fk:
    s_lshl_b32 s50, s42, 18
    s_add_u32 s51, s56, 0
    s_and_b32 s51, s51, 0xffff
    s_add_u32 s51, s51, s50
    buffer_load_dwordx4 v[64:67], v6, s[84:87], s51 offen offset:0 sc1
    buffer_load_dwordx4 v[68:71], v6, s[84:87], s51 offen offset:1024 sc1
    buffer_load_dwordx4 v[72:75], v6, s[84:87], s51 offen offset:2048 sc1
    buffer_load_dwordx4 v[76:79], v6, s[84:87], s51 offen offset:3072 sc1
    s_add_u32 s51, s56, 4096
    s_and_b32 s51, s51, 0xffff
    s_add_u32 s51, s51, s50
    buffer_load_dwordx4 v[80:83], v6, s[84:87], s51 offen offset:0 sc1
    buffer_load_dwordx4 v[84:87], v6, s[84:87], s51 offen offset:1024 sc1
    buffer_load_dwordx4 v[88:91], v6, s[84:87], s51 offen offset:2048 sc1
    buffer_load_dwordx4 v[92:95], v6, s[84:87], s51 offen offset:3072 sc1
    s_add_u32 s51, s56, 8192
    s_and_b32 s51, s51, 0xffff
    s_add_u32 s51, s51, s50
    buffer_load_dwordx4 v[96:99], v6, s[84:87], s51 offen offset:0 sc1
    buffer_load_dwordx4 v[100:103], v6, s[84:87], s51 offen offset:1024 sc1
    buffer_load_dwordx4 v[104:107], v6, s[84:87], s51 offen offset:2048 sc1
    buffer_load_dwordx4 v[108:111], v6, s[84:87], s51 offen offset:3072 sc1
    s_add_u32 s51, s56, 12288
    s_and_b32 s51, s51, 0xffff
    s_add_u32 s51, s51, s50
    buffer_load_dwordx4 v[112:115], v6, s[84:87], s51 offen offset:0 sc1
    buffer_load_dwordx4 v[116:119], v6, s[84:87], s51 offen offset:1024 sc1
    buffer_load_dwordx4 v[120:123], v6, s[84:87], s51 offen offset:2048 sc1
    buffer_load_dwordx4 v[124:127], v6, s[84:87], s51 offen offset:3072 sc1
    s_add_u32 s51, s56, 16384
    s_and_b32 s51, s51, 0xffff
    s_add_u32 s51, s51, s50
    buffer_load_dwordx4 v[128:131], v6, s[84:87], s51 offen offset:0 sc1
    buffer_load_dwordx4 v[132:135], v6, s[84:87], s51 offen offset:1024 sc1
    buffer_load_dwordx4 v[136:139], v6, s[84:87], s51 offen offset:2048 sc1
    buffer_load_dwordx4 v[140:143], v6, s[84:87], s51 offen offset:3072 sc1
    s_add_u32 s51, s56, 20480
    s_and_b32 s51, s51, 0xffff
    s_add_u32 s51, s51, s50
    buffer_load_dwordx4 v[144:147], v6, s[84:87], s51 offen offset:0 sc1
    buffer_load_dwordx4 v[148:151], v6, s[84:87], s51 offen offset:1024 sc1
    buffer_load_dwordx4 v[152:155], v6, s[84:87], s51 offen offset:2048 sc1
    buffer_load_dwordx4 v[156:159], v6, s[84:87], s51 offen offset:3072 sc1
    s_add_u32 s51, s56, 24576
    s_and_b32 s51, s51, 0xffff
    s_add_u32 s51, s51, s50
    buffer_load_dwordx4 v[160:163], v6, s[84:87], s51 offen offset:0 sc1
    buffer_load_dwordx4 v[164:167], v6, s[84:87], s51 offen offset:1024 sc1
    buffer_load_dwordx4 v[168:171], v6, s[84:87], s51 offen offset:2048 sc1
    buffer_load_dwordx4 v[172:175], v6, s[84:87], s51 offen offset:3072 sc1
    s_add_u32 s51, s56, 28672
    s_and_b32 s51, s51, 0xffff
    s_add_u32 s51, s51, s50
    buffer_load_dwordx4 v[176:179], v6, s[84:87], s51 offen offset:0 sc1
    buffer_load_dwordx4 v[180:183], v6, s[84:87], s51 offen offset:1024 sc1
    buffer_load_dwordx4 v[184:187], v6, s[84:87], s51 offen offset:2048 sc1
    buffer_load_dwordx4 v[188:191], v6, s[84:87], s51 offen offset:3072 sc1
mega_kernel_o_warm:
    s_lshl_b32 s50, s42, 18
    s_waitcnt vmcnt(31)
    v_mfma_f32_32x32x16_bf16 v[20:35], a[0:3], v[64:67], 0
    s_add_u32 s51, s56, 32768
    s_and_b32 s51, s51, 0xffff
    s_add_u32 s51, s51, s50
    buffer_load_dwordx4 v[64:67], v6, s[84:87], s51 offen offset:0 sc1
    s_waitcnt vmcnt(31)
    v_mfma_f32_32x32x16_bf16 v[20:35], a[4:7], v[68:71], v[20:35]
    buffer_load_dwordx4 v[68:71], v6, s[84:87], s51 offen offset:1024 sc1
    s_waitcnt vmcnt(31)
    v_mfma_f32_32x32x16_bf16 v[20:35], a[8:11], v[72:75], v[20:35]
    buffer_load_dwordx4 v[72:75], v6, s[84:87], s51 offen offset:2048 sc1
    s_waitcnt vmcnt(31)
    v_mfma_f32_32x32x16_bf16 v[20:35], a[12:15], v[76:79], v[20:35]
    buffer_load_dwordx4 v[76:79], v6, s[84:87], s51 offen offset:3072 sc1
    s_waitcnt vmcnt(31)
    v_mfma_f32_32x32x16_bf16 v[20:35], a[16:19], v[80:83], v[20:35]
    s_add_u32 s51, s56, 36864
    s_and_b32 s51, s51, 0xffff
    s_add_u32 s51, s51, s50
    buffer_load_dwordx4 v[80:83], v6, s[84:87], s51 offen offset:0 sc1
    s_waitcnt vmcnt(31)
    v_mfma_f32_32x32x16_bf16 v[20:35], a[20:23], v[84:87], v[20:35]
    buffer_load_dwordx4 v[84:87], v6, s[84:87], s51 offen offset:1024 sc1
    s_waitcnt vmcnt(31)
    v_mfma_f32_32x32x16_bf16 v[20:35], a[24:27], v[88:91], v[20:35]
    buffer_load_dwordx4 v[88:91], v6, s[84:87], s51 offen offset:2048 sc1
    s_waitcnt vmcnt(31)
    v_mfma_f32_32x32x16_bf16 v[20:35], a[28:31], v[92:95], v[20:35]
    buffer_load_dwordx4 v[92:95], v6, s[84:87], s51 offen offset:3072 sc1
    s_waitcnt vmcnt(31)
    v_mfma_f32_32x32x16_bf16 v[20:35], a[32:35], v[96:99], v[20:35]
    s_add_u32 s51, s56, 40960
    s_and_b32 s51, s51, 0xffff
    s_add_u32 s51, s51, s50
    buffer_load_dwordx4 v[96:99], v6, s[84:87], s51 offen offset:0 sc1
    s_waitcnt vmcnt(31)
    v_mfma_f32_32x32x16_bf16 v[20:35], a[36:39], v[100:103], v[20:35]
    buffer_load_dwordx4 v[100:103], v6, s[84:87], s51 offen offset:1024 sc1
    s_waitcnt vmcnt(31)
    v_mfma_f32_32x32x16_bf16 v[20:35], a[40:43], v[104:107], v[20:35]
    buffer_load_dwordx4 v[104:107], v6, s[84:87], s51 offen offset:2048 sc1
    s_waitcnt vmcnt(31)
    v_mfma_f32_32x32x16_bf16 v[20:35], a[44:47], v[108:111], v[20:35]
    buffer_load_dwordx4 v[108:111], v6, s[84:87], s51 offen offset:3072 sc1
    s_waitcnt vmcnt(31)
    v_mfma_f32_32x32x16_bf16 v[20:35], a[48:51], v[112:115], v[20:35]
    s_add_u32 s51, s56, 45056
    s_and_b32 s51, s51, 0xffff
    s_add_u32 s51, s51, s50
    buffer_load_dwordx4 v[112:115], v6, s[84:87], s51 offen offset:0 sc1
    s_waitcnt vmcnt(31)
    v_mfma_f32_32x32x16_bf16 v[20:35], a[52:55], v[116:119], v[20:35]
    buffer_load_dwordx4 v[116:119], v6, s[84:87], s51 offen offset:1024 sc1
    s_waitcnt vmcnt(31)
    v_mfma_f32_32x32x16_bf16 v[20:35], a[56:59], v[120:123], v[20:35]
    buffer_load_dwordx4 v[120:123], v6, s[84:87], s51 offen offset:2048 sc1
    s_waitcnt vmcnt(31)
    v_mfma_f32_32x32x16_bf16 v[20:35], a[60:63], v[124:127], v[20:35]
    buffer_load_dwordx4 v[124:127], v6, s[84:87], s51 offen offset:3072 sc1
    s_waitcnt vmcnt(31)
    v_mfma_f32_32x32x16_bf16 v[20:35], a[64:67], v[128:131], v[20:35]
    s_add_u32 s51, s56, 49152
    s_and_b32 s51, s51, 0xffff
    s_add_u32 s51, s51, s50
    buffer_load_dwordx4 v[128:131], v6, s[84:87], s51 offen offset:0 sc1
    s_waitcnt vmcnt(31)
    v_mfma_f32_32x32x16_bf16 v[20:35], a[68:71], v[132:135], v[20:35]
    buffer_load_dwordx4 v[132:135], v6, s[84:87], s51 offen offset:1024 sc1
    s_waitcnt vmcnt(31)
    v_mfma_f32_32x32x16_bf16 v[20:35], a[72:75], v[136:139], v[20:35]
    buffer_load_dwordx4 v[136:139], v6, s[84:87], s51 offen offset:2048 sc1
    s_waitcnt vmcnt(31)
    v_mfma_f32_32x32x16_bf16 v[20:35], a[76:79], v[140:143], v[20:35]
    buffer_load_dwordx4 v[140:143], v6, s[84:87], s51 offen offset:3072 sc1
    s_waitcnt vmcnt(31)
    v_mfma_f32_32x32x16_bf16 v[20:35], a[80:83], v[144:147], v[20:35]
    s_add_u32 s51, s56, 53248
    s_and_b32 s51, s51, 0xffff
    s_add_u32 s51, s51, s50
    buffer_load_dwordx4 v[144:147], v6, s[84:87], s51 offen offset:0 sc1
    s_waitcnt vmcnt(31)
    v_mfma_f32_32x32x16_bf16 v[20:35], a[84:87], v[148:151], v[20:35]
    buffer_load_dwordx4 v[148:151], v6, s[84:87], s51 offen offset:1024 sc1
    s_waitcnt vmcnt(31)
    v_mfma_f32_32x32x16_bf16 v[20:35], a[88:91], v[152:155], v[20:35]
    buffer_load_dwordx4 v[152:155], v6, s[84:87], s51 offen offset:2048 sc1
    s_waitcnt vmcnt(31)
    v_mfma_f32_32x32x16_bf16 v[20:35], a[92:95], v[156:159], v[20:35]
    buffer_load_dwordx4 v[156:159], v6, s[84:87], s51 offen offset:3072 sc1
    s_waitcnt vmcnt(31)
    v_mfma_f32_32x32x16_bf16 v[20:35], a[96:99], v[160:163], v[20:35]
    s_add_u32 s51, s56, 57344
    s_and_b32 s51, s51, 0xffff
    s_add_u32 s51, s51, s50
    buffer_load_dwordx4 v[160:163], v6, s[84:87], s51 offen offset:0 sc1
    s_waitcnt vmcnt(31)
    v_mfma_f32_32x32x16_bf16 v[20:35], a[100:103], v[164:167], v[20:35]
    buffer_load_dwordx4 v[164:167], v6, s[84:87], s51 offen offset:1024 sc1
    s_waitcnt vmcnt(31)
    v_mfma_f32_32x32x16_bf16 v[20:35], a[104:107], v[168:171], v[20:35]
    buffer_load_dwordx4 v[168:171], v6, s[84:87], s51 offen offset:2048 sc1
    s_waitcnt vmcnt(31)
    v_mfma_f32_32x32x16_bf16 v[20:35], a[108:111], v[172:175], v[20:35]
    buffer_load_dwordx4 v[172:175], v6, s[84:87], s51 offen offset:3072 sc1
    s_waitcnt vmcnt(31)
    v_mfma_f32_32x32x16_bf16 v[20:35], a[112:115], v[176:179], v[20:35]
    s_add_u32 s51, s56, 61440
    s_and_b32 s51, s51, 0xffff
    s_add_u32 s51, s51, s50
    buffer_load_dwordx4 v[176:179], v6, s[84:87], s51 offen offset:0 sc1
    s_waitcnt vmcnt(31)
    v_mfma_f32_32x32x16_bf16 v[20:35], a[116:119], v[180:183], v[20:35]
    buffer_load_dwordx4 v[180:183], v6, s[84:87], s51 offen offset:1024 sc1
    s_waitcnt vmcnt(31)
    v_mfma_f32_32x32x16_bf16 v[20:35], a[120:123], v[184:187], v[20:35]
    buffer_load_dwordx4 v[184:187], v6, s[84:87], s51 offen offset:2048 sc1
    s_waitcnt vmcnt(31)
    v_mfma_f32_32x32x16_bf16 v[20:35], a[124:127], v[188:191], v[20:35]
    buffer_load_dwordx4 v[188:191], v6, s[84:87], s51 offen offset:3072 sc1
    s_add_u32 s54, s42, 1
    s_cmp_gt_i32 s52, s54
    s_cselect_b32 s55, 1, 0
    s_cbranch_scc1 mega_kernel_o_pre
    s_waitcnt vmcnt(31)
    v_mfma_f32_32x32x16_bf16 v[20:35], a[128:131], v[64:67], v[20:35]
    s_waitcnt vmcnt(30)
    v_mfma_f32_32x32x16_bf16 v[20:35], a[132:135], v[68:71], v[20:35]
    s_waitcnt vmcnt(29)
    v_mfma_f32_32x32x16_bf16 v[20:35], a[136:139], v[72:75], v[20:35]
    s_waitcnt vmcnt(28)
    v_mfma_f32_32x32x16_bf16 v[20:35], a[140:143], v[76:79], v[20:35]
    s_waitcnt vmcnt(27)
    v_mfma_f32_32x32x16_bf16 v[20:35], a[144:147], v[80:83], v[20:35]
    s_waitcnt vmcnt(26)
    v_mfma_f32_32x32x16_bf16 v[20:35], a[148:151], v[84:87], v[20:35]
    s_waitcnt vmcnt(25)
    v_mfma_f32_32x32x16_bf16 v[20:35], a[152:155], v[88:91], v[20:35]
    s_waitcnt vmcnt(24)
    v_mfma_f32_32x32x16_bf16 v[20:35], a[156:159], v[92:95], v[20:35]
    s_waitcnt vmcnt(23)
    v_mfma_f32_32x32x16_bf16 v[20:35], a[160:163], v[96:99], v[20:35]
    s_waitcnt vmcnt(22)
    v_mfma_f32_32x32x16_bf16 v[20:35], a[164:167], v[100:103], v[20:35]
    s_waitcnt vmcnt(21)
    v_mfma_f32_32x32x16_bf16 v[20:35], a[168:171], v[104:107], v[20:35]
    s_waitcnt vmcnt(20)
    v_mfma_f32_32x32x16_bf16 v[20:35], a[172:175], v[108:111], v[20:35]
    s_waitcnt vmcnt(19)
    v_mfma_f32_32x32x16_bf16 v[20:35], a[176:179], v[112:115], v[20:35]
    s_waitcnt vmcnt(18)
    v_mfma_f32_32x32x16_bf16 v[20:35], a[180:183], v[116:119], v[20:35]
    s_waitcnt vmcnt(17)
    v_mfma_f32_32x32x16_bf16 v[20:35], a[184:187], v[120:123], v[20:35]
    s_waitcnt vmcnt(16)
    v_mfma_f32_32x32x16_bf16 v[20:35], a[188:191], v[124:127], v[20:35]
    s_waitcnt vmcnt(15)
    v_mfma_f32_32x32x16_bf16 v[20:35], a[192:195], v[128:131], v[20:35]
    s_waitcnt vmcnt(14)
    v_mfma_f32_32x32x16_bf16 v[20:35], a[196:199], v[132:135], v[20:35]
    s_waitcnt vmcnt(13)
    v_mfma_f32_32x32x16_bf16 v[20:35], a[200:203], v[136:139], v[20:35]
    s_waitcnt vmcnt(12)
    v_mfma_f32_32x32x16_bf16 v[20:35], a[204:207], v[140:143], v[20:35]
    s_waitcnt vmcnt(11)
    v_mfma_f32_32x32x16_bf16 v[20:35], a[208:211], v[144:147], v[20:35]
    s_waitcnt vmcnt(10)
    v_mfma_f32_32x32x16_bf16 v[20:35], a[212:215], v[148:151], v[20:35]
    s_waitcnt vmcnt(9)
    v_mfma_f32_32x32x16_bf16 v[20:35], a[216:219], v[152:155], v[20:35]
    s_waitcnt vmcnt(8)
    v_mfma_f32_32x32x16_bf16 v[20:35], a[220:223], v[156:159], v[20:35]
    s_waitcnt vmcnt(7)
    v_mfma_f32_32x32x16_bf16 v[20:35], a[224:227], v[160:163], v[20:35]
    s_waitcnt vmcnt(6)
    v_mfma_f32_32x32x16_bf16 v[20:35], a[228:231], v[164:167], v[20:35]
    s_waitcnt vmcnt(5)
    v_mfma_f32_32x32x16_bf16 v[20:35], a[232:235], v[168:171], v[20:35]
    s_waitcnt vmcnt(4)
    v_mfma_f32_32x32x16_bf16 v[20:35], a[236:239], v[172:175], v[20:35]
    s_waitcnt vmcnt(3)
    v_mfma_f32_32x32x16_bf16 v[20:35], a[240:243], v[176:179], v[20:35]
    s_waitcnt vmcnt(2)
    v_mfma_f32_32x32x16_bf16 v[20:35], a[244:247], v[180:183], v[20:35]
    s_waitcnt vmcnt(1)
    v_mfma_f32_32x32x16_bf16 v[20:35], a[248:251], v[184:187], v[20:35]
    s_waitcnt vmcnt(0)
    v_mfma_f32_32x32x16_bf16 v[20:35], a[252:255], v[188:191], v[20:35]
    s_branch mega_kernel_o_epi
mega_kernel_o_pre:
    s_lshl_b32 s50, s54, 18
    s_waitcnt vmcnt(31)
    v_mfma_f32_32x32x16_bf16 v[20:35], a[128:131], v[64:67], v[20:35]
    s_add_u32 s51, s56, 0
    s_and_b32 s51, s51, 0xffff
    s_add_u32 s51, s51, s50
    buffer_load_dwordx4 v[64:67], v6, s[84:87], s51 offen offset:0 sc1
    s_waitcnt vmcnt(31)
    v_mfma_f32_32x32x16_bf16 v[20:35], a[132:135], v[68:71], v[20:35]
    buffer_load_dwordx4 v[68:71], v6, s[84:87], s51 offen offset:1024 sc1
    s_waitcnt vmcnt(31)
    v_mfma_f32_32x32x16_bf16 v[20:35], a[136:139], v[72:75], v[20:35]
    buffer_load_dwordx4 v[72:75], v6, s[84:87], s51 offen offset:2048 sc1
    s_waitcnt vmcnt(31)
    v_mfma_f32_32x32x16_bf16 v[20:35], a[140:143], v[76:79], v[20:35]
    buffer_load_dwordx4 v[76:79], v6, s[84:87], s51 offen offset:3072 sc1
    s_waitcnt vmcnt(31)
    v_mfma_f32_32x32x16_bf16 v[20:35], a[144:147], v[80:83], v[20:35]
    s_add_u32 s51, s56, 4096
    s_and_b32 s51, s51, 0xffff
    s_add_u32 s51, s51, s50
    buffer_load_dwordx4 v[80:83], v6, s[84:87], s51 offen offset:0 sc1
    s_waitcnt vmcnt(31)
    v_mfma_f32_32x32x16_bf16 v[20:35], a[148:151], v[84:87], v[20:35]
    buffer_load_dwordx4 v[84:87], v6, s[84:87], s51 offen offset:1024 sc1
    s_waitcnt vmcnt(31)
    v_mfma_f32_32x32x16_bf16 v[20:35], a[152:155], v[88:91], v[20:35]
    buffer_load_dwordx4 v[88:91], v6, s[84:87], s51 offen offset:2048 sc1
    s_waitcnt vmcnt(31)
    v_mfma_f32_32x32x16_bf16 v[20:35], a[156:159], v[92:95], v[20:35]
    buffer_load_dwordx4 v[92:95], v6, s[84:87], s51 offen offset:3072 sc1
    s_waitcnt vmcnt(31)
    v_mfma_f32_32x32x16_bf16 v[20:35], a[160:163], v[96:99], v[20:35]
    s_add_u32 s51, s56, 8192
    s_and_b32 s51, s51, 0xffff
    s_add_u32 s51, s51, s50
    buffer_load_dwordx4 v[96:99], v6, s[84:87], s51 offen offset:0 sc1
    s_waitcnt vmcnt(31)
    v_mfma_f32_32x32x16_bf16 v[20:35], a[164:167], v[100:103], v[20:35]
    buffer_load_dwordx4 v[100:103], v6, s[84:87], s51 offen offset:1024 sc1
    s_waitcnt vmcnt(31)
    v_mfma_f32_32x32x16_bf16 v[20:35], a[168:171], v[104:107], v[20:35]
    buffer_load_dwordx4 v[104:107], v6, s[84:87], s51 offen offset:2048 sc1
    s_waitcnt vmcnt(31)
    v_mfma_f32_32x32x16_bf16 v[20:35], a[172:175], v[108:111], v[20:35]
    buffer_load_dwordx4 v[108:111], v6, s[84:87], s51 offen offset:3072 sc1
    s_waitcnt vmcnt(31)
    v_mfma_f32_32x32x16_bf16 v[20:35], a[176:179], v[112:115], v[20:35]
    s_add_u32 s51, s56, 12288
    s_and_b32 s51, s51, 0xffff
    s_add_u32 s51, s51, s50
    buffer_load_dwordx4 v[112:115], v6, s[84:87], s51 offen offset:0 sc1
    s_waitcnt vmcnt(31)
    v_mfma_f32_32x32x16_bf16 v[20:35], a[180:183], v[116:119], v[20:35]
    buffer_load_dwordx4 v[116:119], v6, s[84:87], s51 offen offset:1024 sc1
    s_waitcnt vmcnt(31)
    v_mfma_f32_32x32x16_bf16 v[20:35], a[184:187], v[120:123], v[20:35]
    buffer_load_dwordx4 v[120:123], v6, s[84:87], s51 offen offset:2048 sc1
    s_waitcnt vmcnt(31)
    v_mfma_f32_32x32x16_bf16 v[20:35], a[188:191], v[124:127], v[20:35]
    buffer_load_dwordx4 v[124:127], v6, s[84:87], s51 offen offset:3072 sc1
    s_waitcnt vmcnt(31)
    v_mfma_f32_32x32x16_bf16 v[20:35], a[192:195], v[128:131], v[20:35]
    s_add_u32 s51, s56, 16384
    s_and_b32 s51, s51, 0xffff
    s_add_u32 s51, s51, s50
    buffer_load_dwordx4 v[128:131], v6, s[84:87], s51 offen offset:0 sc1
    s_waitcnt vmcnt(31)
    v_mfma_f32_32x32x16_bf16 v[20:35], a[196:199], v[132:135], v[20:35]
    buffer_load_dwordx4 v[132:135], v6, s[84:87], s51 offen offset:1024 sc1
    s_waitcnt vmcnt(31)
    v_mfma_f32_32x32x16_bf16 v[20:35], a[200:203], v[136:139], v[20:35]
    buffer_load_dwordx4 v[136:139], v6, s[84:87], s51 offen offset:2048 sc1
    s_waitcnt vmcnt(31)
    v_mfma_f32_32x32x16_bf16 v[20:35], a[204:207], v[140:143], v[20:35]
    buffer_load_dwordx4 v[140:143], v6, s[84:87], s51 offen offset:3072 sc1
    s_waitcnt vmcnt(31)
    v_mfma_f32_32x32x16_bf16 v[20:35], a[208:211], v[144:147], v[20:35]
    s_add_u32 s51, s56, 20480
    s_and_b32 s51, s51, 0xffff
    s_add_u32 s51, s51, s50
    buffer_load_dwordx4 v[144:147], v6, s[84:87], s51 offen offset:0 sc1
    s_waitcnt vmcnt(31)
    v_mfma_f32_32x32x16_bf16 v[20:35], a[212:215], v[148:151], v[20:35]
    buffer_load_dwordx4 v[148:151], v6, s[84:87], s51 offen offset:1024 sc1
    s_waitcnt vmcnt(31)
    v_mfma_f32_32x32x16_bf16 v[20:35], a[216:219], v[152:155], v[20:35]
    buffer_load_dwordx4 v[152:155], v6, s[84:87], s51 offen offset:2048 sc1
    s_waitcnt vmcnt(31)
    v_mfma_f32_32x32x16_bf16 v[20:35], a[220:223], v[156:159], v[20:35]
    buffer_load_dwordx4 v[156:159], v6, s[84:87], s51 offen offset:3072 sc1
    s_waitcnt vmcnt(31)
    v_mfma_f32_32x32x16_bf16 v[20:35], a[224:227], v[160:163], v[20:35]
    s_add_u32 s51, s56, 24576
    s_and_b32 s51, s51, 0xffff
    s_add_u32 s51, s51, s50
    buffer_load_dwordx4 v[160:163], v6, s[84:87], s51 offen offset:0 sc1
    s_waitcnt vmcnt(31)
    v_mfma_f32_32x32x16_bf16 v[20:35], a[228:231], v[164:167], v[20:35]
    buffer_load_dwordx4 v[164:167], v6, s[84:87], s51 offen offset:1024 sc1
    s_waitcnt vmcnt(31)
    v_mfma_f32_32x32x16_bf16 v[20:35], a[232:235], v[168:171], v[20:35]
    buffer_load_dwordx4 v[168:171], v6, s[84:87], s51 offen offset:2048 sc1
    s_waitcnt vmcnt(31)
    v_mfma_f32_32x32x16_bf16 v[20:35], a[236:239], v[172:175], v[20:35]
    buffer_load_dwordx4 v[172:175], v6, s[84:87], s51 offen offset:3072 sc1
    s_waitcnt vmcnt(31)
    v_mfma_f32_32x32x16_bf16 v[20:35], a[240:243], v[176:179], v[20:35]
    s_add_u32 s51, s56, 28672
    s_and_b32 s51, s51, 0xffff
    s_add_u32 s51, s51, s50
    buffer_load_dwordx4 v[176:179], v6, s[84:87], s51 offen offset:0 sc1
    s_waitcnt vmcnt(31)
    v_mfma_f32_32x32x16_bf16 v[20:35], a[244:247], v[180:183], v[20:35]
    buffer_load_dwordx4 v[180:183], v6, s[84:87], s51 offen offset:1024 sc1
    s_waitcnt vmcnt(31)
    v_mfma_f32_32x32x16_bf16 v[20:35], a[248:251], v[184:187], v[20:35]
    buffer_load_dwordx4 v[184:187], v6, s[84:87], s51 offen offset:2048 sc1
    s_waitcnt vmcnt(31)
    v_mfma_f32_32x32x16_bf16 v[20:35], a[252:255], v[188:191], v[20:35]
    buffer_load_dwordx4 v[188:191], v6, s[84:87], s51 offen offset:3072 sc1
mega_kernel_o_epi:
    v_add_u32 v2, s53, v8
    v_add_u32 v3, s53, v9
    s_nop 9
    ds_write_b128 v2, v[20:23] offset:0
    ds_write_b128 v2, v[24:27] offset:1024
    ds_write_b128 v2, v[28:31] offset:2048
    ds_write_b128 v2, v[32:35] offset:3072
    s_waitcnt lgkmcnt(0)
    s_barrier
    ds_read_b128 v[36:39], v3 offset:0
    ds_read_b128 v[40:43], v3 offset:4096
    ds_read_b128 v[44:47], v3 offset:8192
    ds_read_b128 v[48:51], v3 offset:12288
    s_lshl_b32 s51, s42, 17
    s_xor_b32 s53, s53, 16384
    s_waitcnt lgkmcnt(0)
    v_pk_add_f32 v[36:37], v[36:37], v[40:41]
    v_pk_add_f32 v[44:45], v[44:45], v[48:49]
    v_pk_add_f32 v[38:39], v[38:39], v[42:43]
    v_pk_add_f32 v[46:47], v[46:47], v[50:51]
    v_pk_add_f32 v[36:37], v[36:37], v[44:45]
    v_pk_add_f32 v[38:39], v[38:39], v[46:47]
    v_cvt_pk_bf16_f32 v52, v36, v37
    v_cvt_pk_bf16_f32 v53, v38, v39
    buffer_store_dwordx2 v[52:53], v10, s[8:11], s51 offen
    s_add_u32 s42, s42, 1
    s_cmp_eq_u32 s42, 64
    s_cbranch_scc1 mega_kernel_o_quit
    s_cmp_eq_u32 s55, 1
    s_cbranch_scc1 mega_kernel_o_warm
    s_branch mega_kernel_o_cold
mega_kernel_o_quit:
    s_endpgm
mega_kernel_rk:
    s_load_dwordx2 s[4:5], s[0:1], 24
    s_load_dwordx2 s[8:9], s[0:1], 0
    v_lshrrev_b32 v2, 6, v0
    v_and_b32 v1, 63, v0
    v_readfirstlane_b32 s41, v2
    v_lshlrev_b32 v5, 4, v1
    s_mov_b32 s99, 0
    s_waitcnt lgkmcnt(0)
    s_mov_b32 s6, 8388608
    s_mov_b32 s7, 0x00020000
    s_mov_b32 s10, 4194304
    s_mov_b32 s11, 0x00020000
    s_lshl_b32 s43, s40, 8
    s_lshl_b32 s44, s41, 6
    s_add_u32 s48, s43, s44
    v_lshrrev_b32 v2, 2, v1
    v_and_b32 v3, 3, v1
    v_lshlrev_b32 v16, 13, v2
    v_lshl_add_u32 v16, v3, 4, v16
    v_add_u32 v16, s48, v16
    s_lshl_b32 s45, s41, 15
    v_bfe_u32 v17, v1, 2, 2
    v_lshrrev_b32 v18, 5, v1
    v_mul_u32_u24 v18, 8, v18
    v_add_u32 v17, v17, v18
    v_lshlrev_b32 v17, 6, v17
    v_bfe_u32 v18, v1, 4, 1
    v_lshl_add_u32 v17, v18, 5, v17
    v_and_b32 v18, 1, v1
    v_lshl_add_u32 v17, v18, 4, v17
    v_bfe_u32 v18, v1, 1, 1
    v_lshl_add_u32 v17, v18, 3, v17
    v_add_u32 v17, s45, v17
    s_add_u32 m0, s45, 0
    s_mov_b32 s44, 0
    buffer_load_dwordx4 v16, s[4:7], s44 offen lds
    s_add_u32 m0, s45, 1024
    s_mov_b32 s44, 131072
    buffer_load_dwordx4 v16, s[4:7], s44 offen lds
    s_add_u32 m0, s45, 2048
    s_mov_b32 s44, 262144
    buffer_load_dwordx4 v16, s[4:7], s44 offen lds
    s_add_u32 m0, s45, 3072
    s_mov_b32 s44, 393216
    buffer_load_dwordx4 v16, s[4:7], s44 offen lds
    s_add_u32 m0, s45, 4096
    s_mov_b32 s44, 524288
    buffer_load_dwordx4 v16, s[4:7], s44 offen lds
    s_add_u32 m0, s45, 5120
    s_mov_b32 s44, 655360
    buffer_load_dwordx4 v16, s[4:7], s44 offen lds
    s_add_u32 m0, s45, 6144
    s_mov_b32 s44, 786432
    buffer_load_dwordx4 v16, s[4:7], s44 offen lds
    s_add_u32 m0, s45, 7168
    s_mov_b32 s44, 917504
    buffer_load_dwordx4 v16, s[4:7], s44 offen lds
    s_add_u32 m0, s45, 8192
    s_mov_b32 s44, 1048576
    buffer_load_dwordx4 v16, s[4:7], s44 offen lds
    s_add_u32 m0, s45, 9216
    s_mov_b32 s44, 1179648
    buffer_load_dwordx4 v16, s[4:7], s44 offen lds
    s_add_u32 m0, s45, 10240
    s_mov_b32 s44, 1310720
    buffer_load_dwordx4 v16, s[4:7], s44 offen lds
    s_add_u32 m0, s45, 11264
    s_mov_b32 s44, 1441792
    buffer_load_dwordx4 v16, s[4:7], s44 offen lds
    s_add_u32 m0, s45, 12288
    s_mov_b32 s44, 1572864
    buffer_load_dwordx4 v16, s[4:7], s44 offen lds
    s_add_u32 m0, s45, 13312
    s_mov_b32 s44, 1703936
    buffer_load_dwordx4 v16, s[4:7], s44 offen lds
    s_add_u32 m0, s45, 14336
    s_mov_b32 s44, 1835008
    buffer_load_dwordx4 v16, s[4:7], s44 offen lds
    s_add_u32 m0, s45, 15360
    s_mov_b32 s44, 1966080
    buffer_load_dwordx4 v16, s[4:7], s44 offen lds
    s_add_u32 m0, s45, 16384
    s_mov_b32 s44, 2097152
    buffer_load_dwordx4 v16, s[4:7], s44 offen lds
    s_add_u32 m0, s45, 17408
    s_mov_b32 s44, 2228224
    buffer_load_dwordx4 v16, s[4:7], s44 offen lds
    s_add_u32 m0, s45, 18432
    s_mov_b32 s44, 2359296
    buffer_load_dwordx4 v16, s[4:7], s44 offen lds
    s_add_u32 m0, s45, 19456
    s_mov_b32 s44, 2490368
    buffer_load_dwordx4 v16, s[4:7], s44 offen lds
    s_add_u32 m0, s45, 20480
    s_mov_b32 s44, 2621440
    buffer_load_dwordx4 v16, s[4:7], s44 offen lds
    s_add_u32 m0, s45, 21504
    s_mov_b32 s44, 2752512
    buffer_load_dwordx4 v16, s[4:7], s44 offen lds
    s_add_u32 m0, s45, 22528
    s_mov_b32 s44, 2883584
    buffer_load_dwordx4 v16, s[4:7], s44 offen lds
    s_add_u32 m0, s45, 23552
    s_mov_b32 s44, 3014656
    buffer_load_dwordx4 v16, s[4:7], s44 offen lds
    s_add_u32 m0, s45, 24576
    s_mov_b32 s44, 3145728
    buffer_load_dwordx4 v16, s[4:7], s44 offen lds
    s_add_u32 m0, s45, 25600
    s_mov_b32 s44, 3276800
    buffer_load_dwordx4 v16, s[4:7], s44 offen lds
    s_add_u32 m0, s45, 26624
    s_mov_b32 s44, 3407872
    buffer_load_dwordx4 v16, s[4:7], s44 offen lds
    s_add_u32 m0, s45, 27648
    s_mov_b32 s44, 3538944
    buffer_load_dwordx4 v16, s[4:7], s44 offen lds
    s_add_u32 m0, s45, 28672
    s_mov_b32 s44, 3670016
    buffer_load_dwordx4 v16, s[4:7], s44 offen lds
    s_add_u32 m0, s45, 29696
    s_mov_b32 s44, 3801088
    buffer_load_dwordx4 v16, s[4:7], s44 offen lds
    s_add_u32 m0, s45, 30720
    s_mov_b32 s44, 3932160
    buffer_load_dwordx4 v16, s[4:7], s44 offen lds
    s_add_u32 m0, s45, 31744
    s_mov_b32 s44, 4063232
    buffer_load_dwordx4 v16, s[4:7], s44 offen lds
    s_waitcnt vmcnt(16)
    ds_read_b64_tr_b16 a[0:1], v17 offset:0
    ds_read_b64_tr_b16 a[2:3], v17 offset:256
    ds_read_b64_tr_b16 a[4:5], v17 offset:1024
    ds_read_b64_tr_b16 a[6:7], v17 offset:1280
    ds_read_b64_tr_b16 a[8:9], v17 offset:2048
    ds_read_b64_tr_b16 a[10:11], v17 offset:2304
    ds_read_b64_tr_b16 a[12:13], v17 offset:3072
    ds_read_b64_tr_b16 a[14:15], v17 offset:3328
    s_waitcnt lgkmcnt(0)
    ds_read_b64_tr_b16 a[16:17], v17 offset:4096
    ds_read_b64_tr_b16 a[18:19], v17 offset:4352
    ds_read_b64_tr_b16 a[20:21], v17 offset:5120
    ds_read_b64_tr_b16 a[22:23], v17 offset:5376
    ds_read_b64_tr_b16 a[24:25], v17 offset:6144
    ds_read_b64_tr_b16 a[26:27], v17 offset:6400
    ds_read_b64_tr_b16 a[28:29], v17 offset:7168
    ds_read_b64_tr_b16 a[30:31], v17 offset:7424
    s_waitcnt lgkmcnt(0)
    ds_read_b64_tr_b16 a[32:33], v17 offset:8192
    ds_read_b64_tr_b16 a[34:35], v17 offset:8448
    ds_read_b64_tr_b16 a[36:37], v17 offset:9216
    ds_read_b64_tr_b16 a[38:39], v17 offset:9472
    ds_read_b64_tr_b16 a[40:41], v17 offset:10240
    ds_read_b64_tr_b16 a[42:43], v17 offset:10496
    ds_read_b64_tr_b16 a[44:45], v17 offset:11264
    ds_read_b64_tr_b16 a[46:47], v17 offset:11520
    s_waitcnt lgkmcnt(0)
    ds_read_b64_tr_b16 a[48:49], v17 offset:12288
    ds_read_b64_tr_b16 a[50:51], v17 offset:12544
    ds_read_b64_tr_b16 a[52:53], v17 offset:13312
    ds_read_b64_tr_b16 a[54:55], v17 offset:13568
    ds_read_b64_tr_b16 a[56:57], v17 offset:14336
    ds_read_b64_tr_b16 a[58:59], v17 offset:14592
    ds_read_b64_tr_b16 a[60:61], v17 offset:15360
    ds_read_b64_tr_b16 a[62:63], v17 offset:15616
    s_waitcnt lgkmcnt(0)
    s_add_u32 m0, s45, 0
    s_mov_b32 s44, 4194304
    buffer_load_dwordx4 v16, s[4:7], s44 offen lds
    s_add_u32 m0, s45, 1024
    s_mov_b32 s44, 4325376
    buffer_load_dwordx4 v16, s[4:7], s44 offen lds
    s_add_u32 m0, s45, 2048
    s_mov_b32 s44, 4456448
    buffer_load_dwordx4 v16, s[4:7], s44 offen lds
    s_add_u32 m0, s45, 3072
    s_mov_b32 s44, 4587520
    buffer_load_dwordx4 v16, s[4:7], s44 offen lds
    s_add_u32 m0, s45, 4096
    s_mov_b32 s44, 4718592
    buffer_load_dwordx4 v16, s[4:7], s44 offen lds
    s_add_u32 m0, s45, 5120
    s_mov_b32 s44, 4849664
    buffer_load_dwordx4 v16, s[4:7], s44 offen lds
    s_add_u32 m0, s45, 6144
    s_mov_b32 s44, 4980736
    buffer_load_dwordx4 v16, s[4:7], s44 offen lds
    s_add_u32 m0, s45, 7168
    s_mov_b32 s44, 5111808
    buffer_load_dwordx4 v16, s[4:7], s44 offen lds
    s_add_u32 m0, s45, 8192
    s_mov_b32 s44, 5242880
    buffer_load_dwordx4 v16, s[4:7], s44 offen lds
    s_add_u32 m0, s45, 9216
    s_mov_b32 s44, 5373952
    buffer_load_dwordx4 v16, s[4:7], s44 offen lds
    s_add_u32 m0, s45, 10240
    s_mov_b32 s44, 5505024
    buffer_load_dwordx4 v16, s[4:7], s44 offen lds
    s_add_u32 m0, s45, 11264
    s_mov_b32 s44, 5636096
    buffer_load_dwordx4 v16, s[4:7], s44 offen lds
    s_add_u32 m0, s45, 12288
    s_mov_b32 s44, 5767168
    buffer_load_dwordx4 v16, s[4:7], s44 offen lds
    s_add_u32 m0, s45, 13312
    s_mov_b32 s44, 5898240
    buffer_load_dwordx4 v16, s[4:7], s44 offen lds
    s_add_u32 m0, s45, 14336
    s_mov_b32 s44, 6029312
    buffer_load_dwordx4 v16, s[4:7], s44 offen lds
    s_add_u32 m0, s45, 15360
    s_mov_b32 s44, 6160384
    buffer_load_dwordx4 v16, s[4:7], s44 offen lds
    s_waitcnt vmcnt(16)
    ds_read_b64_tr_b16 a[64:65], v17 offset:16384
    ds_read_b64_tr_b16 a[66:67], v17 offset:16640
    ds_read_b64_tr_b16 a[68:69], v17 offset:17408
    ds_read_b64_tr_b16 a[70:71], v17 offset:17664
    ds_read_b64_tr_b16 a[72:73], v17 offset:18432
    ds_read_b64_tr_b16 a[74:75], v17 offset:18688
    ds_read_b64_tr_b16 a[76:77], v17 offset:19456
    ds_read_b64_tr_b16 a[78:79], v17 offset:19712
    s_waitcnt lgkmcnt(0)
    ds_read_b64_tr_b16 a[80:81], v17 offset:20480
    ds_read_b64_tr_b16 a[82:83], v17 offset:20736
    ds_read_b64_tr_b16 a[84:85], v17 offset:21504
    ds_read_b64_tr_b16 a[86:87], v17 offset:21760
    ds_read_b64_tr_b16 a[88:89], v17 offset:22528
    ds_read_b64_tr_b16 a[90:91], v17 offset:22784
    ds_read_b64_tr_b16 a[92:93], v17 offset:23552
    ds_read_b64_tr_b16 a[94:95], v17 offset:23808
    s_waitcnt lgkmcnt(0)
    ds_read_b64_tr_b16 a[96:97], v17 offset:24576
    ds_read_b64_tr_b16 a[98:99], v17 offset:24832
    ds_read_b64_tr_b16 a[100:101], v17 offset:25600
    ds_read_b64_tr_b16 a[102:103], v17 offset:25856
    ds_read_b64_tr_b16 a[104:105], v17 offset:26624
    ds_read_b64_tr_b16 a[106:107], v17 offset:26880
    ds_read_b64_tr_b16 a[108:109], v17 offset:27648
    ds_read_b64_tr_b16 a[110:111], v17 offset:27904
    s_waitcnt lgkmcnt(0)
    ds_read_b64_tr_b16 a[112:113], v17 offset:28672
    ds_read_b64_tr_b16 a[114:115], v17 offset:28928
    ds_read_b64_tr_b16 a[116:117], v17 offset:29696
    ds_read_b64_tr_b16 a[118:119], v17 offset:29952
    ds_read_b64_tr_b16 a[120:121], v17 offset:30720
    ds_read_b64_tr_b16 a[122:123], v17 offset:30976
    ds_read_b64_tr_b16 a[124:125], v17 offset:31744
    ds_read_b64_tr_b16 a[126:127], v17 offset:32000
    s_waitcnt lgkmcnt(0)
    s_add_u32 m0, s45, 16384
    s_mov_b32 s44, 6291456
    buffer_load_dwordx4 v16, s[4:7], s44 offen lds
    s_add_u32 m0, s45, 17408
    s_mov_b32 s44, 6422528
    buffer_load_dwordx4 v16, s[4:7], s44 offen lds
    s_add_u32 m0, s45, 18432
    s_mov_b32 s44, 6553600
    buffer_load_dwordx4 v16, s[4:7], s44 offen lds
    s_add_u32 m0, s45, 19456
    s_mov_b32 s44, 6684672
    buffer_load_dwordx4 v16, s[4:7], s44 offen lds
    s_add_u32 m0, s45, 20480
    s_mov_b32 s44, 6815744
    buffer_load_dwordx4 v16, s[4:7], s44 offen lds
    s_add_u32 m0, s45, 21504
    s_mov_b32 s44, 6946816
    buffer_load_dwordx4 v16, s[4:7], s44 offen lds
    s_add_u32 m0, s45, 22528
    s_mov_b32 s44, 7077888
    buffer_load_dwordx4 v16, s[4:7], s44 offen lds
    s_add_u32 m0, s45, 23552
    s_mov_b32 s44, 7208960
    buffer_load_dwordx4 v16, s[4:7], s44 offen lds
    s_add_u32 m0, s45, 24576
    s_mov_b32 s44, 7340032
    buffer_load_dwordx4 v16, s[4:7], s44 offen lds
    s_add_u32 m0, s45, 25600
    s_mov_b32 s44, 7471104
    buffer_load_dwordx4 v16, s[4:7], s44 offen lds
    s_add_u32 m0, s45, 26624
    s_mov_b32 s44, 7602176
    buffer_load_dwordx4 v16, s[4:7], s44 offen lds
    s_add_u32 m0, s45, 27648
    s_mov_b32 s44, 7733248
    buffer_load_dwordx4 v16, s[4:7], s44 offen lds
    s_add_u32 m0, s45, 28672
    s_mov_b32 s44, 7864320
    buffer_load_dwordx4 v16, s[4:7], s44 offen lds
    s_add_u32 m0, s45, 29696
    s_mov_b32 s44, 7995392
    buffer_load_dwordx4 v16, s[4:7], s44 offen lds
    s_add_u32 m0, s45, 30720
    s_mov_b32 s44, 8126464
    buffer_load_dwordx4 v16, s[4:7], s44 offen lds
    s_add_u32 m0, s45, 31744
    s_mov_b32 s44, 8257536
    buffer_load_dwordx4 v16, s[4:7], s44 offen lds
    s_waitcnt vmcnt(16)
    ds_read_b64_tr_b16 a[128:129], v17 offset:0
    ds_read_b64_tr_b16 a[130:131], v17 offset:256
    ds_read_b64_tr_b16 a[132:133], v17 offset:1024
    ds_read_b64_tr_b16 a[134:135], v17 offset:1280
    ds_read_b64_tr_b16 a[136:137], v17 offset:2048
    ds_read_b64_tr_b16 a[138:139], v17 offset:2304
    ds_read_b64_tr_b16 a[140:141], v17 offset:3072
    ds_read_b64_tr_b16 a[142:143], v17 offset:3328
    s_waitcnt lgkmcnt(0)
    ds_read_b64_tr_b16 a[144:145], v17 offset:4096
    ds_read_b64_tr_b16 a[146:147], v17 offset:4352
    ds_read_b64_tr_b16 a[148:149], v17 offset:5120
    ds_read_b64_tr_b16 a[150:151], v17 offset:5376
    ds_read_b64_tr_b16 a[152:153], v17 offset:6144
    ds_read_b64_tr_b16 a[154:155], v17 offset:6400
    ds_read_b64_tr_b16 a[156:157], v17 offset:7168
    ds_read_b64_tr_b16 a[158:159], v17 offset:7424
    s_waitcnt lgkmcnt(0)
    ds_read_b64_tr_b16 a[160:161], v17 offset:8192
    ds_read_b64_tr_b16 a[162:163], v17 offset:8448
    ds_read_b64_tr_b16 a[164:165], v17 offset:9216
    ds_read_b64_tr_b16 a[166:167], v17 offset:9472
    ds_read_b64_tr_b16 a[168:169], v17 offset:10240
    ds_read_b64_tr_b16 a[170:171], v17 offset:10496
    ds_read_b64_tr_b16 a[172:173], v17 offset:11264
    ds_read_b64_tr_b16 a[174:175], v17 offset:11520
    s_waitcnt lgkmcnt(0)
    ds_read_b64_tr_b16 a[176:177], v17 offset:12288
    ds_read_b64_tr_b16 a[178:179], v17 offset:12544
    ds_read_b64_tr_b16 a[180:181], v17 offset:13312
    ds_read_b64_tr_b16 a[182:183], v17 offset:13568
    ds_read_b64_tr_b16 a[184:185], v17 offset:14336
    ds_read_b64_tr_b16 a[186:187], v17 offset:14592
    ds_read_b64_tr_b16 a[188:189], v17 offset:15360
    ds_read_b64_tr_b16 a[190:191], v17 offset:15616
    s_waitcnt lgkmcnt(0)
    s_waitcnt vmcnt(0)
    ds_read_b64_tr_b16 a[192:193], v17 offset:16384
    ds_read_b64_tr_b16 a[194:195], v17 offset:16640
    ds_read_b64_tr_b16 a[196:197], v17 offset:17408
    ds_read_b64_tr_b16 a[198:199], v17 offset:17664
    ds_read_b64_tr_b16 a[200:201], v17 offset:18432
    ds_read_b64_tr_b16 a[202:203], v17 offset:18688
    ds_read_b64_tr_b16 a[204:205], v17 offset:19456
    ds_read_b64_tr_b16 a[206:207], v17 offset:19712
    s_waitcnt lgkmcnt(0)
    ds_read_b64_tr_b16 a[208:209], v17 offset:20480
    ds_read_b64_tr_b16 a[210:211], v17 offset:20736
    ds_read_b64_tr_b16 a[212:213], v17 offset:21504
    ds_read_b64_tr_b16 a[214:215], v17 offset:21760
    ds_read_b64_tr_b16 a[216:217], v17 offset:22528
    ds_read_b64_tr_b16 a[218:219], v17 offset:22784
    ds_read_b64_tr_b16 a[220:221], v17 offset:23552
    ds_read_b64_tr_b16 a[222:223], v17 offset:23808
    s_waitcnt lgkmcnt(0)
    ds_read_b64_tr_b16 a[224:225], v17 offset:24576
    ds_read_b64_tr_b16 a[226:227], v17 offset:24832
    ds_read_b64_tr_b16 a[228:229], v17 offset:25600
    ds_read_b64_tr_b16 a[230:231], v17 offset:25856
    ds_read_b64_tr_b16 a[232:233], v17 offset:26624
    ds_read_b64_tr_b16 a[234:235], v17 offset:26880
    ds_read_b64_tr_b16 a[236:237], v17 offset:27648
    ds_read_b64_tr_b16 a[238:239], v17 offset:27904
    s_waitcnt lgkmcnt(0)
    ds_read_b64_tr_b16 a[240:241], v17 offset:28672
    ds_read_b64_tr_b16 a[242:243], v17 offset:28928
    ds_read_b64_tr_b16 a[244:245], v17 offset:29696
    ds_read_b64_tr_b16 a[246:247], v17 offset:29952
    ds_read_b64_tr_b16 a[248:249], v17 offset:30720
    ds_read_b64_tr_b16 a[250:251], v17 offset:30976
    ds_read_b64_tr_b16 a[252:253], v17 offset:31744
    ds_read_b64_tr_b16 a[254:255], v17 offset:32000
    s_waitcnt lgkmcnt(0)
    s_barrier
    v_lshrrev_b32 v2, 3, v1
    s_lshl_b32 s43, s41, 3
    v_add_u32 v2, s43, v2
    v_bfe_u32 v3, v2, 1, 3
    v_and_b32 v4, 7, v1
    v_xor_b32 v3, v3, v4
    v_lshlrev_b32 v6, 11, v2
    v_lshl_add_u32 v6, v3, 4, v6
    s_lshl_b32 s46, s41, 10
    v_and_b32 v2, 15, v1
    v_bfe_u32 v3, v2, 1, 3
    v_lshrrev_b32 v4, 4, v1
    v_xor_b32 v3, v3, v4
    v_lshlrev_b32 v8, 7, v2
    v_lshl_add_u32 v8, v3, 4, v8
    v_xor_b32 v9, 64, v8
    v_add_u32 v10, 0x10000, v8
    v_add_u32 v11, 0x10000, v9
    v_mov_b32 v7, v5
    v_and_b32 v2, 31, v1
    v_bfe_u32 v3, v2, 1, 3
    v_lshrrev_b32 v4, 5, v1
    v_xor_b32 v3, v3, v4
    v_lshlrev_b32 v8, 7, v2
    v_lshl_add_u32 v8, v3, 4, v8
    v_xor_b32 v9, 32, v8
    v_xor_b32 v10, 64, v8
    v_xor_b32 v11, 96, v8
    v_add_u32 v12, 0x10000, v8
    v_add_u32 v13, 0x10000, v9
    v_add_u32 v14, 0x10000, v10
    v_add_u32 v15, 0x10000, v11
    v_bfe_u32 v3, v1, 4, 1
    v_lshlrev_b32 v7, 10, v3
    v_lshl_add_u32 v7, v4, 8, v7
    v_and_b32 v3, 15, v1
    v_lshl_add_u32 v7, v3, 4, v7
    s_lshl_b32 s47, s40, 2
    s_add_u32 s47, s47, s41
    s_mov_b32 s42, 0
    s_lshr_b32 s44, s47, 3
    s_xor_b32 s44, s44, s98
    s_and_b32 s44, s44, 1
    s_lshl_b32 s44, s44, 13
    s_lshl_b32 s48, s47, 18
    s_add_u32 s48, s48, s44
    s_add_u32 s48, s48, 0
    s_xor_b32 s44, s98, 1
    s_lshl_b32 s44, s44, 13
    s_lshl_b32 s49, s40, 7
    s_add_u32 s49, s49, s44
    s_lshl_b32 s44, s41, 2
    s_add_u32 s49, s49, s44
    s_add_u32 s49, s49, 70254592
    v_mov_b32 v16, 0
    s_mov_b32 s50, 0
    s_add_u32 m0, s46, 0
    s_nop 0
    buffer_load_dwordx4 v6, s[8:11], s50 offen offset:0 lds
    s_add_u32 m0, s46, 3968
    s_nop 0
    buffer_load_dwordx4 v6, s[8:11], s50 offen offset:128 lds
    s_add_u32 m0, s46, 7936
    s_nop 0
    buffer_load_dwordx4 v6, s[8:11], s50 offen offset:256 lds
    s_add_u32 m0, s46, 11904
    s_nop 0
    buffer_load_dwordx4 v6, s[8:11], s50 offen offset:384 lds
    s_add_u32 m0, s46, 15872
    s_nop 0
    buffer_load_dwordx4 v6, s[8:11], s50 offen offset:512 lds
    s_add_u32 m0, s46, 19840
    s_nop 0
    buffer_load_dwordx4 v6, s[8:11], s50 offen offset:640 lds
    s_add_u32 m0, s46, 23808
    s_nop 0
    buffer_load_dwordx4 v6, s[8:11], s50 offen offset:768 lds
    s_add_u32 m0, s46, 27776
    s_nop 0
    buffer_load_dwordx4 v6, s[8:11], s50 offen offset:896 lds
    s_add_u32 m0, s46, 31744
    s_nop 0
    buffer_load_dwordx4 v6, s[8:11], s50 offen offset:1024 lds
    s_add_u32 m0, s46, 35712
    s_nop 0
    buffer_load_dwordx4 v6, s[8:11], s50 offen offset:1152 lds
    s_add_u32 m0, s46, 39680
    s_nop 0
    buffer_load_dwordx4 v6, s[8:11], s50 offen offset:1280 lds
    s_add_u32 m0, s46, 43648
    s_nop 0
    buffer_load_dwordx4 v6, s[8:11], s50 offen offset:1408 lds
    s_add_u32 m0, s46, 47616
    s_nop 0
    buffer_load_dwordx4 v6, s[8:11], s50 offen offset:1536 lds
    s_add_u32 m0, s46, 51584
    s_nop 0
    buffer_load_dwordx4 v6, s[8:11], s50 offen offset:1664 lds
    s_add_u32 m0, s46, 55552
    s_nop 0
    buffer_load_dwordx4 v6, s[8:11], s50 offen offset:1792 lds
    s_add_u32 m0, s46, 59520
    s_nop 0
    buffer_load_dwordx4 v6, s[8:11], s50 offen offset:1920 lds
    s_and_b32 s53, s47, 31
    s_lshl_b32 s53, s53, 4
    v_add_u32 v19, s53, v1
    v_lshlrev_b32 v19, 7, v19
    s_waitcnt vmcnt(0)
    s_barrier
    s_add_u32 s50, s42, 1
    s_min_u32 s50, s50, 63
    s_lshl_b32 s50, s50, 16
    ds_read_b128 v[20:23], v8 offset:0
    ds_read_b128 v[24:27], v9 offset:0
    ds_read_b128 v[28:31], v10 offset:0
    ds_read_b128 v[32:35], v11 offset:0
    ds_read_b128 v[36:39], v8 offset:4096
    ds_read_b128 v[40:43], v9 offset:4096
    s_add_u32 m0, s46, 65536
    s_waitcnt lgkmcnt(4)
    v_mfma_f32_32x32x16_bf16 v[52:67], a[0:3], v[20:23], 0
    ds_read_b128 v[44:47], v10 offset:4096
    buffer_load_dwordx4 v6, s[8:11], s50 offen offset:0 lds
    v_mfma_f32_32x32x16_bf16 v[52:67], a[4:7], v[24:27], v[52:67]
    ds_read_b128 v[48:51], v11 offset:4096
    s_add_u32 m0, s46, 69504
    s_waitcnt lgkmcnt(4)
    v_mfma_f32_32x32x16_bf16 v[52:67], a[8:11], v[28:31], v[52:67]
    ds_read_b128 v[20:23], v8 offset:8192
    buffer_load_dwordx4 v6, s[8:11], s50 offen offset:128 lds
    v_mfma_f32_32x32x16_bf16 v[52:67], a[12:15], v[32:35], v[52:67]
    ds_read_b128 v[24:27], v9 offset:8192
    s_add_u32 m0, s46, 73472
    s_waitcnt lgkmcnt(4)
    v_mfma_f32_32x32x16_bf16 v[52:67], a[16:19], v[36:39], v[52:67]
    ds_read_b128 v[28:31], v10 offset:8192
    buffer_load_dwordx4 v6, s[8:11], s50 offen offset:256 lds
    v_mfma_f32_32x32x16_bf16 v[52:67], a[20:23], v[40:43], v[52:67]
    ds_read_b128 v[32:35], v11 offset:8192
    s_add_u32 m0, s46, 77440
    s_waitcnt lgkmcnt(4)
    v_mfma_f32_32x32x16_bf16 v[52:67], a[24:27], v[44:47], v[52:67]
    ds_read_b128 v[36:39], v8 offset:12288
    buffer_load_dwordx4 v6, s[8:11], s50 offen offset:384 lds
    v_mfma_f32_32x32x16_bf16 v[52:67], a[28:31], v[48:51], v[52:67]
    ds_read_b128 v[40:43], v9 offset:12288
    s_add_u32 m0, s46, 81408
    s_waitcnt lgkmcnt(4)
    v_mfma_f32_32x32x16_bf16 v[52:67], a[32:35], v[20:23], v[52:67]
    ds_read_b128 v[44:47], v10 offset:12288
    buffer_load_dwordx4 v6, s[8:11], s50 offen offset:512 lds
    v_mfma_f32_32x32x16_bf16 v[52:67], a[36:39], v[24:27], v[52:67]
    ds_read_b128 v[48:51], v11 offset:12288
    s_add_u32 m0, s46, 85376
    s_waitcnt lgkmcnt(4)
    v_mfma_f32_32x32x16_bf16 v[52:67], a[40:43], v[28:31], v[52:67]
    ds_read_b128 v[20:23], v8 offset:16384
    buffer_load_dwordx4 v6, s[8:11], s50 offen offset:640 lds
    v_mfma_f32_32x32x16_bf16 v[52:67], a[44:47], v[32:35], v[52:67]
    ds_read_b128 v[24:27], v9 offset:16384
    s_add_u32 m0, s46, 89344
    s_waitcnt lgkmcnt(4)
    v_mfma_f32_32x32x16_bf16 v[52:67], a[48:51], v[36:39], v[52:67]
    ds_read_b128 v[28:31], v10 offset:16384
    buffer_load_dwordx4 v6, s[8:11], s50 offen offset:768 lds
    v_mfma_f32_32x32x16_bf16 v[52:67], a[52:55], v[40:43], v[52:67]
    ds_read_b128 v[32:35], v11 offset:16384
    s_add_u32 m0, s46, 93312
    s_waitcnt lgkmcnt(4)
    v_mfma_f32_32x32x16_bf16 v[52:67], a[56:59], v[44:47], v[52:67]
    ds_read_b128 v[36:39], v8 offset:20480
    buffer_load_dwordx4 v6, s[8:11], s50 offen offset:896 lds
    v_mfma_f32_32x32x16_bf16 v[52:67], a[60:63], v[48:51], v[52:67]
    ds_read_b128 v[40:43], v9 offset:20480
    s_add_u32 m0, s46, 97280
    s_waitcnt lgkmcnt(4)
    v_mfma_f32_32x32x16_bf16 v[52:67], a[64:67], v[20:23], v[52:67]
    ds_read_b128 v[44:47], v10 offset:20480
    buffer_load_dwordx4 v6, s[8:11], s50 offen offset:1024 lds
    v_mfma_f32_32x32x16_bf16 v[52:67], a[68:71], v[24:27], v[52:67]
    ds_read_b128 v[48:51], v11 offset:20480
    s_add_u32 m0, s46, 101248
    s_waitcnt lgkmcnt(4)
    v_mfma_f32_32x32x16_bf16 v[52:67], a[72:75], v[28:31], v[52:67]
    ds_read_b128 v[20:23], v8 offset:24576
    buffer_load_dwordx4 v6, s[8:11], s50 offen offset:1152 lds
    v_mfma_f32_32x32x16_bf16 v[52:67], a[76:79], v[32:35], v[52:67]
    ds_read_b128 v[24:27], v9 offset:24576
    s_add_u32 m0, s46, 105216
    s_waitcnt lgkmcnt(4)
    v_mfma_f32_32x32x16_bf16 v[52:67], a[80:83], v[36:39], v[52:67]
    ds_read_b128 v[28:31], v10 offset:24576
    buffer_load_dwordx4 v6, s[8:11], s50 offen offset:1280 lds
    v_mfma_f32_32x32x16_bf16 v[52:67], a[84:87], v[40:43], v[52:67]
    ds_read_b128 v[32:35], v11 offset:24576
    s_add_u32 m0, s46, 109184
    s_waitcnt lgkmcnt(4)
    v_mfma_f32_32x32x16_bf16 v[52:67], a[88:91], v[44:47], v[52:67]
    ds_read_b128 v[36:39], v8 offset:28672
    buffer_load_dwordx4 v6, s[8:11], s50 offen offset:1408 lds
    v_mfma_f32_32x32x16_bf16 v[52:67], a[92:95], v[48:51], v[52:67]
    ds_read_b128 v[40:43], v9 offset:28672
    s_add_u32 m0, s46, 113152
    s_waitcnt lgkmcnt(4)
    v_mfma_f32_32x32x16_bf16 v[52:67], a[96:99], v[20:23], v[52:67]
    ds_read_b128 v[44:47], v10 offset:28672
    buffer_load_dwordx4 v6, s[8:11], s50 offen offset:1536 lds
    v_mfma_f32_32x32x16_bf16 v[52:67], a[100:103], v[24:27], v[52:67]
    ds_read_b128 v[48:51], v11 offset:28672
    s_add_u32 m0, s46, 117120
    s_waitcnt lgkmcnt(4)
    v_mfma_f32_32x32x16_bf16 v[52:67], a[104:107], v[28:31], v[52:67]
    ds_read_b128 v[20:23], v8 offset:32768
    buffer_load_dwordx4 v6, s[8:11], s50 offen offset:1664 lds
    v_mfma_f32_32x32x16_bf16 v[52:67], a[108:111], v[32:35], v[52:67]
    ds_read_b128 v[24:27], v9 offset:32768
    s_add_u32 m0, s46, 121088
    s_waitcnt lgkmcnt(4)
    v_mfma_f32_32x32x16_bf16 v[52:67], a[112:115], v[36:39], v[52:67]
    ds_read_b128 v[28:31], v10 offset:32768
    buffer_load_dwordx4 v6, s[8:11], s50 offen offset:1792 lds
    v_mfma_f32_32x32x16_bf16 v[52:67], a[116:119], v[40:43], v[52:67]
    ds_read_b128 v[32:35], v11 offset:32768
    s_add_u32 m0, s46, 125056
    s_waitcnt lgkmcnt(4)
    v_mfma_f32_32x32x16_bf16 v[52:67], a[120:123], v[44:47], v[52:67]
    ds_read_b128 v[36:39], v8 offset:36864
    buffer_load_dwordx4 v6, s[8:11], s50 offen offset:1920 lds
    v_mfma_f32_32x32x16_bf16 v[52:67], a[124:127], v[48:51], v[52:67]
    ds_read_b128 v[40:43], v9 offset:36864
    s_waitcnt lgkmcnt(4)
    v_mfma_f32_32x32x16_bf16 v[52:67], a[128:131], v[20:23], v[52:67]
    ds_read_b128 v[44:47], v10 offset:36864
    v_mfma_f32_32x32x16_bf16 v[52:67], a[132:135], v[24:27], v[52:67]
    ds_read_b128 v[48:51], v11 offset:36864
    s_waitcnt lgkmcnt(4)
    v_mfma_f32_32x32x16_bf16 v[52:67], a[136:139], v[28:31], v[52:67]
    ds_read_b128 v[20:23], v8 offset:40960
    v_mfma_f32_32x32x16_bf16 v[52:67], a[140:143], v[32:35], v[52:67]
    ds_read_b128 v[24:27], v9 offset:40960
    s_waitcnt lgkmcnt(4)
    v_mfma_f32_32x32x16_bf16 v[52:67], a[144:147], v[36:39], v[52:67]
    ds_read_b128 v[28:31], v10 offset:40960
    v_mfma_f32_32x32x16_bf16 v[52:67], a[148:151], v[40:43], v[52:67]
    ds_read_b128 v[32:35], v11 offset:40960
    s_waitcnt lgkmcnt(4)
    v_mfma_f32_32x32x16_bf16 v[52:67], a[152:155], v[44:47], v[52:67]
    ds_read_b128 v[36:39], v8 offset:45056
    v_mfma_f32_32x32x16_bf16 v[52:67], a[156:159], v[48:51], v[52:67]
    ds_read_b128 v[40:43], v9 offset:45056
    s_waitcnt lgkmcnt(4)
    v_mfma_f32_32x32x16_bf16 v[52:67], a[160:163], v[20:23], v[52:67]
    ds_read_b128 v[44:47], v10 offset:45056
    v_mfma_f32_32x32x16_bf16 v[52:67], a[164:167], v[24:27], v[52:67]
    ds_read_b128 v[48:51], v11 offset:45056
    s_waitcnt lgkmcnt(4)
    v_mfma_f32_32x32x16_bf16 v[52:67], a[168:171], v[28:31], v[52:67]
    ds_read_b128 v[20:23], v8 offset:49152
    v_mfma_f32_32x32x16_bf16 v[52:67], a[172:175], v[32:35], v[52:67]
    ds_read_b128 v[24:27], v9 offset:49152
    s_waitcnt lgkmcnt(4)
    v_mfma_f32_32x32x16_bf16 v[52:67], a[176:179], v[36:39], v[52:67]
    ds_read_b128 v[28:31], v10 offset:49152
    v_mfma_f32_32x32x16_bf16 v[52:67], a[180:183], v[40:43], v[52:67]
    ds_read_b128 v[32:35], v11 offset:49152
    s_waitcnt lgkmcnt(4)
    v_mfma_f32_32x32x16_bf16 v[52:67], a[184:187], v[44:47], v[52:67]
    ds_read_b128 v[36:39], v8 offset:53248
    v_mfma_f32_32x32x16_bf16 v[52:67], a[188:191], v[48:51], v[52:67]
    ds_read_b128 v[40:43], v9 offset:53248
    s_waitcnt lgkmcnt(4)
    v_mfma_f32_32x32x16_bf16 v[52:67], a[192:195], v[20:23], v[52:67]
    ds_read_b128 v[44:47], v10 offset:53248
    v_mfma_f32_32x32x16_bf16 v[52:67], a[196:199], v[24:27], v[52:67]
    ds_read_b128 v[48:51], v11 offset:53248
    s_waitcnt lgkmcnt(4)
    v_mfma_f32_32x32x16_bf16 v[52:67], a[200:203], v[28:31], v[52:67]
    ds_read_b128 v[20:23], v8 offset:57344
    v_mfma_f32_32x32x16_bf16 v[52:67], a[204:207], v[32:35], v[52:67]
    ds_read_b128 v[24:27], v9 offset:57344
    s_waitcnt lgkmcnt(4)
    v_mfma_f32_32x32x16_bf16 v[52:67], a[208:211], v[36:39], v[52:67]
    ds_read_b128 v[28:31], v10 offset:57344
    v_mfma_f32_32x32x16_bf16 v[52:67], a[212:215], v[40:43], v[52:67]
    ds_read_b128 v[32:35], v11 offset:57344
    s_waitcnt lgkmcnt(4)
    v_mfma_f32_32x32x16_bf16 v[52:67], a[216:219], v[44:47], v[52:67]
    ds_read_b128 v[36:39], v8 offset:61440
    v_mfma_f32_32x32x16_bf16 v[52:67], a[220:223], v[48:51], v[52:67]
    ds_read_b128 v[40:43], v9 offset:61440
    s_waitcnt lgkmcnt(4)
    v_mfma_f32_32x32x16_bf16 v[52:67], a[224:227], v[20:23], v[52:67]
    ds_read_b128 v[44:47], v10 offset:61440
    v_mfma_f32_32x32x16_bf16 v[52:67], a[228:231], v[24:27], v[52:67]
    ds_read_b128 v[48:51], v11 offset:61440
    s_waitcnt lgkmcnt(5)
    v_mfma_f32_32x32x16_bf16 v[52:67], a[232:235], v[28:31], v[52:67]
    s_waitcnt lgkmcnt(4)
    v_mfma_f32_32x32x16_bf16 v[52:67], a[236:239], v[32:35], v[52:67]
    s_waitcnt lgkmcnt(3)
    v_mfma_f32_32x32x16_bf16 v[52:67], a[240:243], v[36:39], v[52:67]
    s_waitcnt lgkmcnt(2)
    v_mfma_f32_32x32x16_bf16 v[52:67], a[244:247], v[40:43], v[52:67]
    s_waitcnt lgkmcnt(1)
    v_mfma_f32_32x32x16_bf16 v[52:67], a[248:251], v[44:47], v[52:67]
    s_waitcnt lgkmcnt(0)
    v_mfma_f32_32x32x16_bf16 v[52:67], a[252:255], v[48:51], v[52:67]
    s_add_u32 s42, s42, 1
    s_cmp_le_u32 s42, 4
    s_cbranch_scc0 mega_kernel_k_ne01
    s_nop 9
    v_cvt_pk_bf16_f32 v84, v52, v53
    v_cvt_pk_bf16_f32 v85, v54, v55
    v_cvt_pk_bf16_f32 v86, v56, v57
    v_cvt_pk_bf16_f32 v87, v58, v59
    v_cvt_pk_bf16_f32 v88, v60, v61
    v_cvt_pk_bf16_f32 v89, v62, v63
    v_cvt_pk_bf16_f32 v90, v64, v65
    v_cvt_pk_bf16_f32 v91, v66, v67
    s_add_u32 s51, s42, s47
    s_sub_u32 s51, s51, 1
    s_bfe_u32 s52, s51, 0x40002
    s_lshl_b32 s52, s52, 14
    s_and_b32 s51, s51, 3
    s_lshl_b32 s51, s51, 11
    s_add_u32 s51, s51, s52
    s_add_u32 s51, s51, s48
    buffer_store_dwordx4 v[84:87], v7, s[84:87], s51 offen sc1
    buffer_store_dwordx4 v[88:91], v7, s[84:87], s51 offen offset:512 sc1
    s_waitcnt vmcnt(0)
    v_mov_b32 v17, s42
    s_mov_b64 exec, 1
    buffer_store_dword v17, v16, s[84:87], s49 offen sc1
    s_mov_b64 exec, -1
mega_kernel_k_ne01:
    s_waitcnt vmcnt(0)
mega_kernel_k_loop:
    s_waitcnt vmcnt(4)
    s_barrier
    s_add_u32 s50, s42, 1
    s_min_u32 s50, s50, 63
    s_lshl_b32 s50, s50, 16
    ds_read_b128 v[20:23], v12 offset:0
    ds_read_b128 v[24:27], v13 offset:0
    ds_read_b128 v[28:31], v14 offset:0
    ds_read_b128 v[32:35], v15 offset:0
    ds_read_b128 v[36:39], v12 offset:4096
    ds_read_b128 v[40:43], v13 offset:4096
    s_add_u32 m0, s46, 0
    s_waitcnt lgkmcnt(4)
    v_mfma_f32_32x32x16_bf16 v[68:83], a[0:3], v[20:23], 0
    ds_read_b128 v[44:47], v14 offset:4096
    buffer_load_dwordx4 v6, s[8:11], s50 offen offset:0 lds
    v_mfma_f32_32x32x16_bf16 v[68:83], a[4:7], v[24:27], v[68:83]
    ds_read_b128 v[48:51], v15 offset:4096
    s_add_u32 m0, s46, 3968
    s_waitcnt lgkmcnt(4)
    v_mfma_f32_32x32x16_bf16 v[68:83], a[8:11], v[28:31], v[68:83]
    ds_read_b128 v[20:23], v12 offset:8192
    buffer_load_dwordx4 v6, s[8:11], s50 offen offset:128 lds
    v_mfma_f32_32x32x16_bf16 v[68:83], a[12:15], v[32:35], v[68:83]
    ds_read_b128 v[24:27], v13 offset:8192
    s_add_u32 m0, s46, 7936
    s_waitcnt lgkmcnt(4)
    v_mfma_f32_32x32x16_bf16 v[68:83], a[16:19], v[36:39], v[68:83]
    ds_read_b128 v[28:31], v14 offset:8192
    buffer_load_dwordx4 v6, s[8:11], s50 offen offset:256 lds
    v_mfma_f32_32x32x16_bf16 v[68:83], a[20:23], v[40:43], v[68:83]
    ds_read_b128 v[32:35], v15 offset:8192
    s_add_u32 m0, s46, 11904
    s_waitcnt lgkmcnt(4)
    v_mfma_f32_32x32x16_bf16 v[68:83], a[24:27], v[44:47], v[68:83]
    ds_read_b128 v[36:39], v12 offset:12288
    buffer_load_dwordx4 v6, s[8:11], s50 offen offset:384 lds
    v_mfma_f32_32x32x16_bf16 v[68:83], a[28:31], v[48:51], v[68:83]
    ds_read_b128 v[40:43], v13 offset:12288
    s_add_u32 m0, s46, 15872
    s_waitcnt lgkmcnt(4)
    v_mfma_f32_32x32x16_bf16 v[68:83], a[32:35], v[20:23], v[68:83]
    ds_read_b128 v[44:47], v14 offset:12288
    buffer_load_dwordx4 v6, s[8:11], s50 offen offset:512 lds
    v_mfma_f32_32x32x16_bf16 v[68:83], a[36:39], v[24:27], v[68:83]
    ds_read_b128 v[48:51], v15 offset:12288
    s_add_u32 m0, s46, 19840
    s_waitcnt lgkmcnt(4)
    v_mfma_f32_32x32x16_bf16 v[68:83], a[40:43], v[28:31], v[68:83]
    ds_read_b128 v[20:23], v12 offset:16384
    buffer_load_dwordx4 v6, s[8:11], s50 offen offset:640 lds
    v_mfma_f32_32x32x16_bf16 v[68:83], a[44:47], v[32:35], v[68:83]
    ds_read_b128 v[24:27], v13 offset:16384
    s_add_u32 m0, s46, 23808
    s_waitcnt lgkmcnt(4)
    v_mfma_f32_32x32x16_bf16 v[68:83], a[48:51], v[36:39], v[68:83]
    ds_read_b128 v[28:31], v14 offset:16384
    buffer_load_dwordx4 v6, s[8:11], s50 offen offset:768 lds
    v_mfma_f32_32x32x16_bf16 v[68:83], a[52:55], v[40:43], v[68:83]
    ds_read_b128 v[32:35], v15 offset:16384
    s_add_u32 m0, s46, 27776
    s_waitcnt lgkmcnt(4)
    v_mfma_f32_32x32x16_bf16 v[68:83], a[56:59], v[44:47], v[68:83]
    ds_read_b128 v[36:39], v12 offset:20480
    buffer_load_dwordx4 v6, s[8:11], s50 offen offset:896 lds
    v_mfma_f32_32x32x16_bf16 v[68:83], a[60:63], v[48:51], v[68:83]
    ds_read_b128 v[40:43], v13 offset:20480
    s_add_u32 m0, s46, 31744
    s_waitcnt lgkmcnt(4)
    v_mfma_f32_32x32x16_bf16 v[68:83], a[64:67], v[20:23], v[68:83]
    ds_read_b128 v[44:47], v14 offset:20480
    buffer_load_dwordx4 v6, s[8:11], s50 offen offset:1024 lds
    v_mfma_f32_32x32x16_bf16 v[68:83], a[68:71], v[24:27], v[68:83]
    ds_read_b128 v[48:51], v15 offset:20480
    s_add_u32 m0, s46, 35712
    s_waitcnt lgkmcnt(4)
    v_mfma_f32_32x32x16_bf16 v[68:83], a[72:75], v[28:31], v[68:83]
    ds_read_b128 v[20:23], v12 offset:24576
    buffer_load_dwordx4 v6, s[8:11], s50 offen offset:1152 lds
    v_mfma_f32_32x32x16_bf16 v[68:83], a[76:79], v[32:35], v[68:83]
    ds_read_b128 v[24:27], v13 offset:24576
    s_add_u32 m0, s46, 39680
    s_waitcnt lgkmcnt(4)
    v_mfma_f32_32x32x16_bf16 v[68:83], a[80:83], v[36:39], v[68:83]
    ds_read_b128 v[28:31], v14 offset:24576
    buffer_load_dwordx4 v6, s[8:11], s50 offen offset:1280 lds
    v_mfma_f32_32x32x16_bf16 v[68:83], a[84:87], v[40:43], v[68:83]
    ds_read_b128 v[32:35], v15 offset:24576
    s_add_u32 m0, s46, 43648
    s_waitcnt lgkmcnt(4)
    v_mfma_f32_32x32x16_bf16 v[68:83], a[88:91], v[44:47], v[68:83]
    ds_read_b128 v[36:39], v12 offset:28672
    buffer_load_dwordx4 v6, s[8:11], s50 offen offset:1408 lds
    v_mfma_f32_32x32x16_bf16 v[68:83], a[92:95], v[48:51], v[68:83]
    ds_read_b128 v[40:43], v13 offset:28672
    s_add_u32 m0, s46, 47616
    s_waitcnt lgkmcnt(4)
    v_mfma_f32_32x32x16_bf16 v[68:83], a[96:99], v[20:23], v[68:83]
    ds_read_b128 v[44:47], v14 offset:28672
    buffer_load_dwordx4 v6, s[8:11], s50 offen offset:1536 lds
    v_mfma_f32_32x32x16_bf16 v[68:83], a[100:103], v[24:27], v[68:83]
    ds_read_b128 v[48:51], v15 offset:28672
    s_add_u32 m0, s46, 51584
    s_waitcnt lgkmcnt(4)
    v_mfma_f32_32x32x16_bf16 v[68:83], a[104:107], v[28:31], v[68:83]
    ds_read_b128 v[20:23], v12 offset:32768
    buffer_load_dwordx4 v6, s[8:11], s50 offen offset:1664 lds
    v_mfma_f32_32x32x16_bf16 v[68:83], a[108:111], v[32:35], v[68:83]
    ds_read_b128 v[24:27], v13 offset:32768
    s_add_u32 m0, s46, 55552
    s_waitcnt lgkmcnt(4)
    v_mfma_f32_32x32x16_bf16 v[68:83], a[112:115], v[36:39], v[68:83]
    ds_read_b128 v[28:31], v14 offset:32768
    buffer_load_dwordx4 v6, s[8:11], s50 offen offset:1792 lds
    v_mfma_f32_32x32x16_bf16 v[68:83], a[116:119], v[40:43], v[68:83]
    ds_read_b128 v[32:35], v15 offset:32768
    s_add_u32 m0, s46, 59520
    s_waitcnt lgkmcnt(4)
    v_mfma_f32_32x32x16_bf16 v[68:83], a[120:123], v[44:47], v[68:83]
    ds_read_b128 v[36:39], v12 offset:36864
    buffer_load_dwordx4 v6, s[8:11], s50 offen offset:1920 lds
    v_mfma_f32_32x32x16_bf16 v[68:83], a[124:127], v[48:51], v[68:83]
    ds_read_b128 v[40:43], v13 offset:36864
    s_waitcnt lgkmcnt(4)
    v_mfma_f32_32x32x16_bf16 v[68:83], a[128:131], v[20:23], v[68:83]
    ds_read_b128 v[44:47], v14 offset:36864
    v_mfma_f32_32x32x16_bf16 v[68:83], a[132:135], v[24:27], v[68:83]
    ds_read_b128 v[48:51], v15 offset:36864
    s_waitcnt vmcnt(16)
    s_sub_u32 s53, s42, 1
    s_cmp_le_u32 s42, 4
    s_cselect_b32 s53, s42, s53
    v_mov_b32 v17, s53
    s_mov_b64 exec, 1
    buffer_store_dword v17, v16, s[84:87], s49 offen sc1
    s_mov_b64 exec, -1
    s_waitcnt lgkmcnt(4)
    v_mfma_f32_32x32x16_bf16 v[68:83], a[136:139], v[28:31], v[68:83]
    ds_read_b128 v[20:23], v12 offset:40960
    v_cvt_pk_bf16_f32 v84, v52, v53
    v_cvt_pk_bf16_f32 v85, v54, v55
    v_mfma_f32_32x32x16_bf16 v[68:83], a[140:143], v[32:35], v[68:83]
    ds_read_b128 v[24:27], v13 offset:40960
    v_cvt_pk_bf16_f32 v86, v56, v57
    v_cvt_pk_bf16_f32 v87, v58, v59
    s_waitcnt lgkmcnt(4)
    v_mfma_f32_32x32x16_bf16 v[68:83], a[144:147], v[36:39], v[68:83]
    ds_read_b128 v[28:31], v14 offset:40960
    v_cvt_pk_bf16_f32 v88, v60, v61
    v_cvt_pk_bf16_f32 v89, v62, v63
    v_mfma_f32_32x32x16_bf16 v[68:83], a[148:151], v[40:43], v[68:83]
    ds_read_b128 v[32:35], v15 offset:40960
    v_cvt_pk_bf16_f32 v90, v64, v65
    v_cvt_pk_bf16_f32 v91, v66, v67
    s_waitcnt lgkmcnt(4)
    v_mfma_f32_32x32x16_bf16 v[68:83], a[152:155], v[44:47], v[68:83]
    ds_read_b128 v[36:39], v12 offset:45056
    s_add_u32 s51, s42, s47
    s_sub_u32 s51, s51, 1
    s_bfe_u32 s52, s51, 0x40002
    s_lshl_b32 s52, s52, 14
    v_mfma_f32_32x32x16_bf16 v[68:83], a[156:159], v[48:51], v[68:83]
    ds_read_b128 v[40:43], v13 offset:45056
    s_and_b32 s51, s51, 3
    s_lshl_b32 s51, s51, 11
    s_add_u32 s51, s51, s52
    s_add_u32 s51, s51, s48
    buffer_store_dwordx4 v[84:87], v7, s[84:87], s51 offen sc1
    s_waitcnt lgkmcnt(4)
    v_mfma_f32_32x32x16_bf16 v[68:83], a[160:163], v[20:23], v[68:83]
    ds_read_b128 v[44:47], v14 offset:45056
    buffer_store_dwordx4 v[88:91], v7, s[84:87], s51 offen offset:512 sc1
    v_mfma_f32_32x32x16_bf16 v[68:83], a[164:167], v[24:27], v[68:83]
    ds_read_b128 v[48:51], v15 offset:45056
    s_add_u32 s53, s42, 3
    s_min_u32 s53, s53, 63
    s_lshl_b32 s53, s53, 16
    s_mov_b64 exec, 0xffff
    buffer_load_dword v18, v19, s[8:11], s53 offen
    s_mov_b64 exec, -1
    s_waitcnt lgkmcnt(4)
    v_mfma_f32_32x32x16_bf16 v[68:83], a[168:171], v[28:31], v[68:83]
    ds_read_b128 v[20:23], v12 offset:49152
    v_mfma_f32_32x32x16_bf16 v[68:83], a[172:175], v[32:35], v[68:83]
    ds_read_b128 v[24:27], v13 offset:49152
    s_waitcnt lgkmcnt(4)
    v_mfma_f32_32x32x16_bf16 v[68:83], a[176:179], v[36:39], v[68:83]
    ds_read_b128 v[28:31], v14 offset:49152
    v_mfma_f32_32x32x16_bf16 v[68:83], a[180:183], v[40:43], v[68:83]
    ds_read_b128 v[32:35], v15 offset:49152
    s_waitcnt lgkmcnt(4)
    v_mfma_f32_32x32x16_bf16 v[68:83], a[184:187], v[44:47], v[68:83]
    ds_read_b128 v[36:39], v12 offset:53248
    v_mfma_f32_32x32x16_bf16 v[68:83], a[188:191], v[48:51], v[68:83]
    ds_read_b128 v[40:43], v13 offset:53248
    s_waitcnt lgkmcnt(4)
    v_mfma_f32_32x32x16_bf16 v[68:83], a[192:195], v[20:23], v[68:83]
    ds_read_b128 v[44:47], v14 offset:53248
    v_mfma_f32_32x32x16_bf16 v[68:83], a[196:199], v[24:27], v[68:83]
    ds_read_b128 v[48:51], v15 offset:53248
    s_waitcnt lgkmcnt(4)
    v_mfma_f32_32x32x16_bf16 v[68:83], a[200:203], v[28:31], v[68:83]
    ds_read_b128 v[20:23], v12 offset:57344
    v_mfma_f32_32x32x16_bf16 v[68:83], a[204:207], v[32:35], v[68:83]
    ds_read_b128 v[24:27], v13 offset:57344
    s_waitcnt lgkmcnt(4)
    v_mfma_f32_32x32x16_bf16 v[68:83], a[208:211], v[36:39], v[68:83]
    ds_read_b128 v[28:31], v14 offset:57344
    v_mfma_f32_32x32x16_bf16 v[68:83], a[212:215], v[40:43], v[68:83]
    ds_read_b128 v[32:35], v15 offset:57344
    s_waitcnt lgkmcnt(4)
    v_mfma_f32_32x32x16_bf16 v[68:83], a[216:219], v[44:47], v[68:83]
    ds_read_b128 v[36:39], v12 offset:61440
    v_mfma_f32_32x32x16_bf16 v[68:83], a[220:223], v[48:51], v[68:83]
    ds_read_b128 v[40:43], v13 offset:61440
    s_waitcnt lgkmcnt(4)
    v_mfma_f32_32x32x16_bf16 v[68:83], a[224:227], v[20:23], v[68:83]
    ds_read_b128 v[44:47], v14 offset:61440
    v_mfma_f32_32x32x16_bf16 v[68:83], a[228:231], v[24:27], v[68:83]
    ds_read_b128 v[48:51], v15 offset:61440
    s_waitcnt lgkmcnt(5)
    v_mfma_f32_32x32x16_bf16 v[68:83], a[232:235], v[28:31], v[68:83]
    s_waitcnt lgkmcnt(4)
    v_mfma_f32_32x32x16_bf16 v[68:83], a[236:239], v[32:35], v[68:83]
    s_waitcnt lgkmcnt(3)
    v_mfma_f32_32x32x16_bf16 v[68:83], a[240:243], v[36:39], v[68:83]
    s_waitcnt lgkmcnt(2)
    v_mfma_f32_32x32x16_bf16 v[68:83], a[244:247], v[40:43], v[68:83]
    s_waitcnt lgkmcnt(1)
    v_mfma_f32_32x32x16_bf16 v[68:83], a[248:251], v[44:47], v[68:83]
    s_waitcnt lgkmcnt(0)
    v_mfma_f32_32x32x16_bf16 v[68:83], a[252:255], v[48:51], v[68:83]
    s_add_u32 s42, s42, 1
    s_cmp_le_u32 s42, 4
    s_cbranch_scc0 mega_kernel_k_ne10
    s_nop 9
    v_cvt_pk_bf16_f32 v84, v68, v69
    v_cvt_pk_bf16_f32 v85, v70, v71
    v_cvt_pk_bf16_f32 v86, v72, v73
    v_cvt_pk_bf16_f32 v87, v74, v75
    v_cvt_pk_bf16_f32 v88, v76, v77
    v_cvt_pk_bf16_f32 v89, v78, v79
    v_cvt_pk_bf16_f32 v90, v80, v81
    v_cvt_pk_bf16_f32 v91, v82, v83
    s_add_u32 s51, s42, s47
    s_sub_u32 s51, s51, 1
    s_bfe_u32 s52, s51, 0x40002
    s_lshl_b32 s52, s52, 14
    s_and_b32 s51, s51, 3
    s_lshl_b32 s51, s51, 11
    s_add_u32 s51, s51, s52
    s_add_u32 s51, s51, s48
    buffer_store_dwordx4 v[84:87], v7, s[84:87], s51 offen sc1
    buffer_store_dwordx4 v[88:91], v7, s[84:87], s51 offen offset:512 sc1
    s_waitcnt vmcnt(0)
    v_mov_b32 v17, s42
    s_mov_b64 exec, 1
    buffer_store_dword v17, v16, s[84:87], s49 offen sc1
    s_mov_b64 exec, -1
mega_kernel_k_ne10:
    s_cmp_eq_u32 s42, 64
    s_cbranch_scc1 mega_kernel_k_fin
    s_waitcnt vmcnt(4)
    s_barrier
    s_add_u32 s50, s42, 1
    s_min_u32 s50, s50, 63
    s_lshl_b32 s50, s50, 16
    ds_read_b128 v[20:23], v8 offset:0
    ds_read_b128 v[24:27], v9 offset:0
    ds_read_b128 v[28:31], v10 offset:0
    ds_read_b128 v[32:35], v11 offset:0
    ds_read_b128 v[36:39], v8 offset:4096
    ds_read_b128 v[40:43], v9 offset:4096
    s_add_u32 m0, s46, 65536
    s_waitcnt lgkmcnt(4)
    v_mfma_f32_32x32x16_bf16 v[52:67], a[0:3], v[20:23], 0
    ds_read_b128 v[44:47], v10 offset:4096
    buffer_load_dwordx4 v6, s[8:11], s50 offen offset:0 lds
    v_mfma_f32_32x32x16_bf16 v[52:67], a[4:7], v[24:27], v[52:67]
    ds_read_b128 v[48:51], v11 offset:4096
    s_add_u32 m0, s46, 69504
    s_waitcnt lgkmcnt(4)
    v_mfma_f32_32x32x16_bf16 v[52:67], a[8:11], v[28:31], v[52:67]
    ds_read_b128 v[20:23], v8 offset:8192
    buffer_load_dwordx4 v6, s[8:11], s50 offen offset:128 lds
    v_mfma_f32_32x32x16_bf16 v[52:67], a[12:15], v[32:35], v[52:67]
    ds_read_b128 v[24:27], v9 offset:8192
    s_add_u32 m0, s46, 73472
    s_waitcnt lgkmcnt(4)
    v_mfma_f32_32x32x16_bf16 v[52:67], a[16:19], v[36:39], v[52:67]
    ds_read_b128 v[28:31], v10 offset:8192
    buffer_load_dwordx4 v6, s[8:11], s50 offen offset:256 lds
    v_mfma_f32_32x32x16_bf16 v[52:67], a[20:23], v[40:43], v[52:67]
    ds_read_b128 v[32:35], v11 offset:8192
    s_add_u32 m0, s46, 77440
    s_waitcnt lgkmcnt(4)
    v_mfma_f32_32x32x16_bf16 v[52:67], a[24:27], v[44:47], v[52:67]
    ds_read_b128 v[36:39], v8 offset:12288
    buffer_load_dwordx4 v6, s[8:11], s50 offen offset:384 lds
    v_mfma_f32_32x32x16_bf16 v[52:67], a[28:31], v[48:51], v[52:67]
    ds_read_b128 v[40:43], v9 offset:12288
    s_add_u32 m0, s46, 81408
    s_waitcnt lgkmcnt(4)
    v_mfma_f32_32x32x16_bf16 v[52:67], a[32:35], v[20:23], v[52:67]
    ds_read_b128 v[44:47], v10 offset:12288
    buffer_load_dwordx4 v6, s[8:11], s50 offen offset:512 lds
    v_mfma_f32_32x32x16_bf16 v[52:67], a[36:39], v[24:27], v[52:67]
    ds_read_b128 v[48:51], v11 offset:12288
    s_add_u32 m0, s46, 85376
    s_waitcnt lgkmcnt(4)
    v_mfma_f32_32x32x16_bf16 v[52:67], a[40:43], v[28:31], v[52:67]
    ds_read_b128 v[20:23], v8 offset:16384
    buffer_load_dwordx4 v6, s[8:11], s50 offen offset:640 lds
    v_mfma_f32_32x32x16_bf16 v[52:67], a[44:47], v[32:35], v[52:67]
    ds_read_b128 v[24:27], v9 offset:16384
    s_add_u32 m0, s46, 89344
    s_waitcnt lgkmcnt(4)
    v_mfma_f32_32x32x16_bf16 v[52:67], a[48:51], v[36:39], v[52:67]
    ds_read_b128 v[28:31], v10 offset:16384
    buffer_load_dwordx4 v6, s[8:11], s50 offen offset:768 lds
    v_mfma_f32_32x32x16_bf16 v[52:67], a[52:55], v[40:43], v[52:67]
    ds_read_b128 v[32:35], v11 offset:16384
    s_add_u32 m0, s46, 93312
    s_waitcnt lgkmcnt(4)
    v_mfma_f32_32x32x16_bf16 v[52:67], a[56:59], v[44:47], v[52:67]
    ds_read_b128 v[36:39], v8 offset:20480
    buffer_load_dwordx4 v6, s[8:11], s50 offen offset:896 lds
    v_mfma_f32_32x32x16_bf16 v[52:67], a[60:63], v[48:51], v[52:67]
    ds_read_b128 v[40:43], v9 offset:20480
    s_add_u32 m0, s46, 97280
    s_waitcnt lgkmcnt(4)
    v_mfma_f32_32x32x16_bf16 v[52:67], a[64:67], v[20:23], v[52:67]
    ds_read_b128 v[44:47], v10 offset:20480
    buffer_load_dwordx4 v6, s[8:11], s50 offen offset:1024 lds
    v_mfma_f32_32x32x16_bf16 v[52:67], a[68:71], v[24:27], v[52:67]
    ds_read_b128 v[48:51], v11 offset:20480
    s_add_u32 m0, s46, 101248
    s_waitcnt lgkmcnt(4)
    v_mfma_f32_32x32x16_bf16 v[52:67], a[72:75], v[28:31], v[52:67]
    ds_read_b128 v[20:23], v8 offset:24576
    buffer_load_dwordx4 v6, s[8:11], s50 offen offset:1152 lds
    v_mfma_f32_32x32x16_bf16 v[52:67], a[76:79], v[32:35], v[52:67]
    ds_read_b128 v[24:27], v9 offset:24576
    s_add_u32 m0, s46, 105216
    s_waitcnt lgkmcnt(4)
    v_mfma_f32_32x32x16_bf16 v[52:67], a[80:83], v[36:39], v[52:67]
    ds_read_b128 v[28:31], v10 offset:24576
    buffer_load_dwordx4 v6, s[8:11], s50 offen offset:1280 lds
    v_mfma_f32_32x32x16_bf16 v[52:67], a[84:87], v[40:43], v[52:67]
    ds_read_b128 v[32:35], v11 offset:24576
    s_add_u32 m0, s46, 109184
    s_waitcnt lgkmcnt(4)
    v_mfma_f32_32x32x16_bf16 v[52:67], a[88:91], v[44:47], v[52:67]
    ds_read_b128 v[36:39], v8 offset:28672
    buffer_load_dwordx4 v6, s[8:11], s50 offen offset:1408 lds
    v_mfma_f32_32x32x16_bf16 v[52:67], a[92:95], v[48:51], v[52:67]
    ds_read_b128 v[40:43], v9 offset:28672
    s_add_u32 m0, s46, 113152
    s_waitcnt lgkmcnt(4)
    v_mfma_f32_32x32x16_bf16 v[52:67], a[96:99], v[20:23], v[52:67]
    ds_read_b128 v[44:47], v10 offset:28672
    buffer_load_dwordx4 v6, s[8:11], s50 offen offset:1536 lds
    v_mfma_f32_32x32x16_bf16 v[52:67], a[100:103], v[24:27], v[52:67]
    ds_read_b128 v[48:51], v11 offset:28672
    s_add_u32 m0, s46, 117120
    s_waitcnt lgkmcnt(4)
    v_mfma_f32_32x32x16_bf16 v[52:67], a[104:107], v[28:31], v[52:67]
    ds_read_b128 v[20:23], v8 offset:32768
    buffer_load_dwordx4 v6, s[8:11], s50 offen offset:1664 lds
    v_mfma_f32_32x32x16_bf16 v[52:67], a[108:111], v[32:35], v[52:67]
    ds_read_b128 v[24:27], v9 offset:32768
    s_add_u32 m0, s46, 121088
    s_waitcnt lgkmcnt(4)
    v_mfma_f32_32x32x16_bf16 v[52:67], a[112:115], v[36:39], v[52:67]
    ds_read_b128 v[28:31], v10 offset:32768
    buffer_load_dwordx4 v6, s[8:11], s50 offen offset:1792 lds
    v_mfma_f32_32x32x16_bf16 v[52:67], a[116:119], v[40:43], v[52:67]
    ds_read_b128 v[32:35], v11 offset:32768
    s_add_u32 m0, s46, 125056
    s_waitcnt lgkmcnt(4)
    v_mfma_f32_32x32x16_bf16 v[52:67], a[120:123], v[44:47], v[52:67]
    ds_read_b128 v[36:39], v8 offset:36864
    buffer_load_dwordx4 v6, s[8:11], s50 offen offset:1920 lds
    v_mfma_f32_32x32x16_bf16 v[52:67], a[124:127], v[48:51], v[52:67]
    ds_read_b128 v[40:43], v9 offset:36864
    s_waitcnt lgkmcnt(4)
    v_mfma_f32_32x32x16_bf16 v[52:67], a[128:131], v[20:23], v[52:67]
    ds_read_b128 v[44:47], v10 offset:36864
    v_mfma_f32_32x32x16_bf16 v[52:67], a[132:135], v[24:27], v[52:67]
    ds_read_b128 v[48:51], v11 offset:36864
    s_waitcnt vmcnt(16)
    s_sub_u32 s53, s42, 1
    s_cmp_le_u32 s42, 4
    s_cselect_b32 s53, s42, s53
    v_mov_b32 v17, s53
    s_mov_b64 exec, 1
    buffer_store_dword v17, v16, s[84:87], s49 offen sc1
    s_mov_b64 exec, -1
    s_waitcnt lgkmcnt(4)
    v_mfma_f32_32x32x16_bf16 v[52:67], a[136:139], v[28:31], v[52:67]
    ds_read_b128 v[20:23], v8 offset:40960
    v_cvt_pk_bf16_f32 v84, v68, v69
    v_cvt_pk_bf16_f32 v85, v70, v71
    v_mfma_f32_32x32x16_bf16 v[52:67], a[140:143], v[32:35], v[52:67]
    ds_read_b128 v[24:27], v9 offset:40960
    v_cvt_pk_bf16_f32 v86, v72, v73
    v_cvt_pk_bf16_f32 v87, v74, v75
    s_waitcnt lgkmcnt(4)
    v_mfma_f32_32x32x16_bf16 v[52:67], a[144:147], v[36:39], v[52:67]
    ds_read_b128 v[28:31], v10 offset:40960
    v_cvt_pk_bf16_f32 v88, v76, v77
    v_cvt_pk_bf16_f32 v89, v78, v79
    v_mfma_f32_32x32x16_bf16 v[52:67], a[148:151], v[40:43], v[52:67]
    ds_read_b128 v[32:35], v11 offset:40960
    v_cvt_pk_bf16_f32 v90, v80, v81
    v_cvt_pk_bf16_f32 v91, v82, v83
    s_waitcnt lgkmcnt(4)
    v_mfma_f32_32x32x16_bf16 v[52:67], a[152:155], v[44:47], v[52:67]
    ds_read_b128 v[36:39], v8 offset:45056
    s_add_u32 s51, s42, s47
    s_sub_u32 s51, s51, 1
    s_bfe_u32 s52, s51, 0x40002
    s_lshl_b32 s52, s52, 14
    v_mfma_f32_32x32x16_bf16 v[52:67], a[156:159], v[48:51], v[52:67]
    ds_read_b128 v[40:43], v9 offset:45056
    s_and_b32 s51, s51, 3
    s_lshl_b32 s51, s51, 11
    s_add_u32 s51, s51, s52
    s_add_u32 s51, s51, s48
    buffer_store_dwordx4 v[84:87], v7, s[84:87], s51 offen sc1
    s_waitcnt lgkmcnt(4)
    v_mfma_f32_32x32x16_bf16 v[52:67], a[160:163], v[20:23], v[52:67]
    ds_read_b128 v[44:47], v10 offset:45056
    buffer_store_dwordx4 v[88:91], v7, s[84:87], s51 offen offset:512 sc1
    v_mfma_f32_32x32x16_bf16 v[52:67], a[164:167], v[24:27], v[52:67]
    ds_read_b128 v[48:51], v11 offset:45056
    s_add_u32 s53, s42, 3
    s_min_u32 s53, s53, 63
    s_lshl_b32 s53, s53, 16
    s_mov_b64 exec, 0xffff
    buffer_load_dword v18, v19, s[8:11], s53 offen
    s_mov_b64 exec, -1
    s_waitcnt lgkmcnt(4)
    v_mfma_f32_32x32x16_bf16 v[52:67], a[168:171], v[28:31], v[52:67]
    ds_read_b128 v[20:23], v8 offset:49152
    v_mfma_f32_32x32x16_bf16 v[52:67], a[172:175], v[32:35], v[52:67]
    ds_read_b128 v[24:27], v9 offset:49152
    s_waitcnt lgkmcnt(4)
    v_mfma_f32_32x32x16_bf16 v[52:67], a[176:179], v[36:39], v[52:67]
    ds_read_b128 v[28:31], v10 offset:49152
    v_mfma_f32_32x32x16_bf16 v[52:67], a[180:183], v[40:43], v[52:67]
    ds_read_b128 v[32:35], v11 offset:49152
    s_waitcnt lgkmcnt(4)
    v_mfma_f32_32x32x16_bf16 v[52:67], a[184:187], v[44:47], v[52:67]
    ds_read_b128 v[36:39], v8 offset:53248
    v_mfma_f32_32x32x16_bf16 v[52:67], a[188:191], v[48:51], v[52:67]
    ds_read_b128 v[40:43], v9 offset:53248
    s_waitcnt lgkmcnt(4)
    v_mfma_f32_32x32x16_bf16 v[52:67], a[192:195], v[20:23], v[52:67]
    ds_read_b128 v[44:47], v10 offset:53248
    v_mfma_f32_32x32x16_bf16 v[52:67], a[196:199], v[24:27], v[52:67]
    ds_read_b128 v[48:51], v11 offset:53248
    s_waitcnt lgkmcnt(4)
    v_mfma_f32_32x32x16_bf16 v[52:67], a[200:203], v[28:31], v[52:67]
    ds_read_b128 v[20:23], v8 offset:57344
    v_mfma_f32_32x32x16_bf16 v[52:67], a[204:207], v[32:35], v[52:67]
    ds_read_b128 v[24:27], v9 offset:57344
    s_waitcnt lgkmcnt(4)
    v_mfma_f32_32x32x16_bf16 v[52:67], a[208:211], v[36:39], v[52:67]
    ds_read_b128 v[28:31], v10 offset:57344
    v_mfma_f32_32x32x16_bf16 v[52:67], a[212:215], v[40:43], v[52:67]
    ds_read_b128 v[32:35], v11 offset:57344
    s_waitcnt lgkmcnt(4)
    v_mfma_f32_32x32x16_bf16 v[52:67], a[216:219], v[44:47], v[52:67]
    ds_read_b128 v[36:39], v8 offset:61440
    v_mfma_f32_32x32x16_bf16 v[52:67], a[220:223], v[48:51], v[52:67]
    ds_read_b128 v[40:43], v9 offset:61440
    s_waitcnt lgkmcnt(4)
    v_mfma_f32_32x32x16_bf16 v[52:67], a[224:227], v[20:23], v[52:67]
    ds_read_b128 v[44:47], v10 offset:61440
    v_mfma_f32_32x32x16_bf16 v[52:67], a[228:231], v[24:27], v[52:67]
    ds_read_b128 v[48:51], v11 offset:61440
    s_waitcnt lgkmcnt(5)
    v_mfma_f32_32x32x16_bf16 v[52:67], a[232:235], v[28:31], v[52:67]
    s_waitcnt lgkmcnt(4)
    v_mfma_f32_32x32x16_bf16 v[52:67], a[236:239], v[32:35], v[52:67]
    s_waitcnt lgkmcnt(3)
    v_mfma_f32_32x32x16_bf16 v[52:67], a[240:243], v[36:39], v[52:67]
    s_waitcnt lgkmcnt(2)
    v_mfma_f32_32x32x16_bf16 v[52:67], a[244:247], v[40:43], v[52:67]
    s_waitcnt lgkmcnt(1)
    v_mfma_f32_32x32x16_bf16 v[52:67], a[248:251], v[44:47], v[52:67]
    s_waitcnt lgkmcnt(0)
    v_mfma_f32_32x32x16_bf16 v[52:67], a[252:255], v[48:51], v[52:67]
    s_add_u32 s42, s42, 1
    s_cmp_le_u32 s42, 4
    s_cbranch_scc0 mega_kernel_k_ne00
    s_nop 9
    v_cvt_pk_bf16_f32 v84, v52, v53
    v_cvt_pk_bf16_f32 v85, v54, v55
    v_cvt_pk_bf16_f32 v86, v56, v57
    v_cvt_pk_bf16_f32 v87, v58, v59
    v_cvt_pk_bf16_f32 v88, v60, v61
    v_cvt_pk_bf16_f32 v89, v62, v63
    v_cvt_pk_bf16_f32 v90, v64, v65
    v_cvt_pk_bf16_f32 v91, v66, v67
    s_add_u32 s51, s42, s47
    s_sub_u32 s51, s51, 1
    s_bfe_u32 s52, s51, 0x40002
    s_lshl_b32 s52, s52, 14
    s_and_b32 s51, s51, 3
    s_lshl_b32 s51, s51, 11
    s_add_u32 s51, s51, s52
    s_add_u32 s51, s51, s48
    buffer_store_dwordx4 v[84:87], v7, s[84:87], s51 offen sc1
    buffer_store_dwordx4 v[88:91], v7, s[84:87], s51 offen offset:512 sc1
    s_waitcnt vmcnt(0)
    v_mov_b32 v17, s42
    s_mov_b64 exec, 1
    buffer_store_dword v17, v16, s[84:87], s49 offen sc1
    s_mov_b64 exec, -1
mega_kernel_k_ne00:
    s_branch mega_kernel_k_loop
mega_kernel_k_fin:
    s_nop 11
    v_cvt_pk_bf16_f32 v84, v68, v69
    v_cvt_pk_bf16_f32 v85, v70, v71
    v_cvt_pk_bf16_f32 v86, v72, v73
    v_cvt_pk_bf16_f32 v87, v74, v75
    v_cvt_pk_bf16_f32 v88, v76, v77
    v_cvt_pk_bf16_f32 v89, v78, v79
    v_cvt_pk_bf16_f32 v90, v80, v81
    v_cvt_pk_bf16_f32 v91, v82, v83
    s_add_u32 s51, s42, s47
    s_sub_u32 s51, s51, 1
    s_bfe_u32 s52, s51, 0x40002
    s_lshl_b32 s52, s52, 14
    s_and_b32 s51, s51, 3
    s_lshl_b32 s51, s51, 11
    s_add_u32 s51, s51, s52
    s_add_u32 s51, s51, s48
    buffer_store_dwordx4 v[84:87], v7, s[84:87], s51 offen sc1
    buffer_store_dwordx4 v[88:91], v7, s[84:87], s51 offen offset:512 sc1
    s_waitcnt vmcnt(0)
    v_mov_b32 v17, s42
    s_mov_b64 exec, 1
    buffer_store_dword v17, v16, s[84:87], s49 offen sc1
    s_mov_b64 exec, -1
    s_waitcnt vmcnt(0)
    s_barrier
    s_branch mega_kernel_fft
mega_kernel_rv:
    s_load_dwordx2 s[4:5], s[0:1], 32
    s_load_dwordx2 s[8:9], s[0:1], 0
    v_lshrrev_b32 v2, 6, v0
    v_and_b32 v1, 63, v0
    v_readfirstlane_b32 s41, v2
    v_lshlrev_b32 v5, 4, v1
    s_mov_b32 s99, 0
    s_waitcnt lgkmcnt(0)
    s_mov_b32 s6, 8388608
    s_mov_b32 s7, 0x00020000
    s_mov_b32 s10, 4194304
    s_mov_b32 s11, 0x00020000
    s_lshl_b32 s43, s40, 8
    s_lshl_b32 s44, s41, 6
    s_add_u32 s48, s43, s44
    v_lshrrev_b32 v2, 2, v1
    v_and_b32 v3, 3, v1
    v_lshlrev_b32 v16, 13, v2
    v_lshl_add_u32 v16, v3, 4, v16
    v_add_u32 v16, s48, v16
    s_lshl_b32 s45, s41, 15
    v_bfe_u32 v17, v1, 2, 2
    v_lshrrev_b32 v18, 5, v1
    v_mul_u32_u24 v18, 8, v18
    v_add_u32 v17, v17, v18
    v_lshlrev_b32 v17, 6, v17
    v_bfe_u32 v18, v1, 4, 1
    v_lshl_add_u32 v17, v18, 5, v17
    v_lshl_add_u32 v17, v3, 3, v17
    v_add_u32 v17, s45, v17
    s_add_u32 m0, s45, 0
    s_mov_b32 s44, 0
    buffer_load_dwordx4 v16, s[4:7], s44 offen lds
    s_add_u32 m0, s45, 1024
    s_mov_b32 s44, 131072
    buffer_load_dwordx4 v16, s[4:7], s44 offen lds
    s_add_u32 m0, s45, 2048
    s_mov_b32 s44, 262144
    buffer_load_dwordx4 v16, s[4:7], s44 offen lds
    s_add_u32 m0, s45, 3072
    s_mov_b32 s44, 393216
    buffer_load_dwordx4 v16, s[4:7], s44 offen lds
    s_add_u32 m0, s45, 4096
    s_mov_b32 s44, 524288
    buffer_load_dwordx4 v16, s[4:7], s44 offen lds
    s_add_u32 m0, s45, 5120
    s_mov_b32 s44, 655360
    buffer_load_dwordx4 v16, s[4:7], s44 offen lds
    s_add_u32 m0, s45, 6144
    s_mov_b32 s44, 786432
    buffer_load_dwordx4 v16, s[4:7], s44 offen lds
    s_add_u32 m0, s45, 7168
    s_mov_b32 s44, 917504
    buffer_load_dwordx4 v16, s[4:7], s44 offen lds
    s_add_u32 m0, s45, 8192
    s_mov_b32 s44, 1048576
    buffer_load_dwordx4 v16, s[4:7], s44 offen lds
    s_add_u32 m0, s45, 9216
    s_mov_b32 s44, 1179648
    buffer_load_dwordx4 v16, s[4:7], s44 offen lds
    s_add_u32 m0, s45, 10240
    s_mov_b32 s44, 1310720
    buffer_load_dwordx4 v16, s[4:7], s44 offen lds
    s_add_u32 m0, s45, 11264
    s_mov_b32 s44, 1441792
    buffer_load_dwordx4 v16, s[4:7], s44 offen lds
    s_add_u32 m0, s45, 12288
    s_mov_b32 s44, 1572864
    buffer_load_dwordx4 v16, s[4:7], s44 offen lds
    s_add_u32 m0, s45, 13312
    s_mov_b32 s44, 1703936
    buffer_load_dwordx4 v16, s[4:7], s44 offen lds
    s_add_u32 m0, s45, 14336
    s_mov_b32 s44, 1835008
    buffer_load_dwordx4 v16, s[4:7], s44 offen lds
    s_add_u32 m0, s45, 15360
    s_mov_b32 s44, 1966080
    buffer_load_dwordx4 v16, s[4:7], s44 offen lds
    s_add_u32 m0, s45, 16384
    s_mov_b32 s44, 2097152
    buffer_load_dwordx4 v16, s[4:7], s44 offen lds
    s_add_u32 m0, s45, 17408
    s_mov_b32 s44, 2228224
    buffer_load_dwordx4 v16, s[4:7], s44 offen lds
    s_add_u32 m0, s45, 18432
    s_mov_b32 s44, 2359296
    buffer_load_dwordx4 v16, s[4:7], s44 offen lds
    s_add_u32 m0, s45, 19456
    s_mov_b32 s44, 2490368
    buffer_load_dwordx4 v16, s[4:7], s44 offen lds
    s_add_u32 m0, s45, 20480
    s_mov_b32 s44, 2621440
    buffer_load_dwordx4 v16, s[4:7], s44 offen lds
    s_add_u32 m0, s45, 21504
    s_mov_b32 s44, 2752512
    buffer_load_dwordx4 v16, s[4:7], s44 offen lds
    s_add_u32 m0, s45, 22528
    s_mov_b32 s44, 2883584
    buffer_load_dwordx4 v16, s[4:7], s44 offen lds
    s_add_u32 m0, s45, 23552
    s_mov_b32 s44, 3014656
    buffer_load_dwordx4 v16, s[4:7], s44 offen lds
    s_add_u32 m0, s45, 24576
    s_mov_b32 s44, 3145728
    buffer_load_dwordx4 v16, s[4:7], s44 offen lds
    s_add_u32 m0, s45, 25600
    s_mov_b32 s44, 3276800
    buffer_load_dwordx4 v16, s[4:7], s44 offen lds
    s_add_u32 m0, s45, 26624
    s_mov_b32 s44, 3407872
    buffer_load_dwordx4 v16, s[4:7], s44 offen lds
    s_add_u32 m0, s45, 27648
    s_mov_b32 s44, 3538944
    buffer_load_dwordx4 v16, s[4:7], s44 offen lds
    s_add_u32 m0, s45, 28672
    s_mov_b32 s44, 3670016
    buffer_load_dwordx4 v16, s[4:7], s44 offen lds
    s_add_u32 m0, s45, 29696
    s_mov_b32 s44, 3801088
    buffer_load_dwordx4 v16, s[4:7], s44 offen lds
    s_add_u32 m0, s45, 30720
    s_mov_b32 s44, 3932160
    buffer_load_dwordx4 v16, s[4:7], s44 offen lds
    s_add_u32 m0, s45, 31744
    s_mov_b32 s44, 4063232
    buffer_load_dwordx4 v16, s[4:7], s44 offen lds
    s_waitcnt vmcnt(16)
    ds_read_b64_tr_b16 a[0:1], v17 offset:0
    ds_read_b64_tr_b16 a[2:3], v17 offset:256
    ds_read_b64_tr_b16 a[4:5], v17 offset:1024
    ds_read_b64_tr_b16 a[6:7], v17 offset:1280
    ds_read_b64_tr_b16 a[8:9], v17 offset:2048
    ds_read_b64_tr_b16 a[10:11], v17 offset:2304
    ds_read_b64_tr_b16 a[12:13], v17 offset:3072
    ds_read_b64_tr_b16 a[14:15], v17 offset:3328
    s_waitcnt lgkmcnt(0)
    ds_read_b64_tr_b16 a[16:17], v17 offset:4096
    ds_read_b64_tr_b16 a[18:19], v17 offset:4352
    ds_read_b64_tr_b16 a[20:21], v17 offset:5120
    ds_read_b64_tr_b16 a[22:23], v17 offset:5376
    ds_read_b64_tr_b16 a[24:25], v17 offset:6144
    ds_read_b64_tr_b16 a[26:27], v17 offset:6400
    ds_read_b64_tr_b16 a[28:29], v17 offset:7168
    ds_read_b64_tr_b16 a[30:31], v17 offset:7424
    s_waitcnt lgkmcnt(0)
    ds_read_b64_tr_b16 a[32:33], v17 offset:8192
    ds_read_b64_tr_b16 a[34:35], v17 offset:8448
    ds_read_b64_tr_b16 a[36:37], v17 offset:9216
    ds_read_b64_tr_b16 a[38:39], v17 offset:9472
    ds_read_b64_tr_b16 a[40:41], v17 offset:10240
    ds_read_b64_tr_b16 a[42:43], v17 offset:10496
    ds_read_b64_tr_b16 a[44:45], v17 offset:11264
    ds_read_b64_tr_b16 a[46:47], v17 offset:11520
    s_waitcnt lgkmcnt(0)
    ds_read_b64_tr_b16 a[48:49], v17 offset:12288
    ds_read_b64_tr_b16 a[50:51], v17 offset:12544
    ds_read_b64_tr_b16 a[52:53], v17 offset:13312
    ds_read_b64_tr_b16 a[54:55], v17 offset:13568
    ds_read_b64_tr_b16 a[56:57], v17 offset:14336
    ds_read_b64_tr_b16 a[58:59], v17 offset:14592
    ds_read_b64_tr_b16 a[60:61], v17 offset:15360
    ds_read_b64_tr_b16 a[62:63], v17 offset:15616
    s_waitcnt lgkmcnt(0)
    s_add_u32 m0, s45, 0
    s_mov_b32 s44, 4194304
    buffer_load_dwordx4 v16, s[4:7], s44 offen lds
    s_add_u32 m0, s45, 1024
    s_mov_b32 s44, 4325376
    buffer_load_dwordx4 v16, s[4:7], s44 offen lds
    s_add_u32 m0, s45, 2048
    s_mov_b32 s44, 4456448
    buffer_load_dwordx4 v16, s[4:7], s44 offen lds
    s_add_u32 m0, s45, 3072
    s_mov_b32 s44, 4587520
    buffer_load_dwordx4 v16, s[4:7], s44 offen lds
    s_add_u32 m0, s45, 4096
    s_mov_b32 s44, 4718592
    buffer_load_dwordx4 v16, s[4:7], s44 offen lds
    s_add_u32 m0, s45, 5120
    s_mov_b32 s44, 4849664
    buffer_load_dwordx4 v16, s[4:7], s44 offen lds
    s_add_u32 m0, s45, 6144
    s_mov_b32 s44, 4980736
    buffer_load_dwordx4 v16, s[4:7], s44 offen lds
    s_add_u32 m0, s45, 7168
    s_mov_b32 s44, 5111808
    buffer_load_dwordx4 v16, s[4:7], s44 offen lds
    s_add_u32 m0, s45, 8192
    s_mov_b32 s44, 5242880
    buffer_load_dwordx4 v16, s[4:7], s44 offen lds
    s_add_u32 m0, s45, 9216
    s_mov_b32 s44, 5373952
    buffer_load_dwordx4 v16, s[4:7], s44 offen lds
    s_add_u32 m0, s45, 10240
    s_mov_b32 s44, 5505024
    buffer_load_dwordx4 v16, s[4:7], s44 offen lds
    s_add_u32 m0, s45, 11264
    s_mov_b32 s44, 5636096
    buffer_load_dwordx4 v16, s[4:7], s44 offen lds
    s_add_u32 m0, s45, 12288
    s_mov_b32 s44, 5767168
    buffer_load_dwordx4 v16, s[4:7], s44 offen lds
    s_add_u32 m0, s45, 13312
    s_mov_b32 s44, 5898240
    buffer_load_dwordx4 v16, s[4:7], s44 offen lds
    s_add_u32 m0, s45, 14336
    s_mov_b32 s44, 6029312
    buffer_load_dwordx4 v16, s[4:7], s44 offen lds
    s_add_u32 m0, s45, 15360
    s_mov_b32 s44, 6160384
    buffer_load_dwordx4 v16, s[4:7], s44 offen lds
    s_waitcnt vmcnt(16)
    ds_read_b64_tr_b16 a[64:65], v17 offset:16384
    ds_read_b64_tr_b16 a[66:67], v17 offset:16640
    ds_read_b64_tr_b16 a[68:69], v17 offset:17408
    ds_read_b64_tr_b16 a[70:71], v17 offset:17664
    ds_read_b64_tr_b16 a[72:73], v17 offset:18432
    ds_read_b64_tr_b16 a[74:75], v17 offset:18688
    ds_read_b64_tr_b16 a[76:77], v17 offset:19456
    ds_read_b64_tr_b16 a[78:79], v17 offset:19712
    s_waitcnt lgkmcnt(0)
    ds_read_b64_tr_b16 a[80:81], v17 offset:20480
    ds_read_b64_tr_b16 a[82:83], v17 offset:20736
    ds_read_b64_tr_b16 a[84:85], v17 offset:21504
    ds_read_b64_tr_b16 a[86:87], v17 offset:21760
    ds_read_b64_tr_b16 a[88:89], v17 offset:22528
    ds_read_b64_tr_b16 a[90:91], v17 offset:22784
    ds_read_b64_tr_b16 a[92:93], v17 offset:23552
    ds_read_b64_tr_b16 a[94:95], v17 offset:23808
    s_waitcnt lgkmcnt(0)
    ds_read_b64_tr_b16 a[96:97], v17 offset:24576
    ds_read_b64_tr_b16 a[98:99], v17 offset:24832
    ds_read_b64_tr_b16 a[100:101], v17 offset:25600
    ds_read_b64_tr_b16 a[102:103], v17 offset:25856
    ds_read_b64_tr_b16 a[104:105], v17 offset:26624
    ds_read_b64_tr_b16 a[106:107], v17 offset:26880
    ds_read_b64_tr_b16 a[108:109], v17 offset:27648
    ds_read_b64_tr_b16 a[110:111], v17 offset:27904
    s_waitcnt lgkmcnt(0)
    ds_read_b64_tr_b16 a[112:113], v17 offset:28672
    ds_read_b64_tr_b16 a[114:115], v17 offset:28928
    ds_read_b64_tr_b16 a[116:117], v17 offset:29696
    ds_read_b64_tr_b16 a[118:119], v17 offset:29952
    ds_read_b64_tr_b16 a[120:121], v17 offset:30720
    ds_read_b64_tr_b16 a[122:123], v17 offset:30976
    ds_read_b64_tr_b16 a[124:125], v17 offset:31744
    ds_read_b64_tr_b16 a[126:127], v17 offset:32000
    s_waitcnt lgkmcnt(0)
    s_add_u32 m0, s45, 16384
    s_mov_b32 s44, 6291456
    buffer_load_dwordx4 v16, s[4:7], s44 offen lds
    s_add_u32 m0, s45, 17408
    s_mov_b32 s44, 6422528
    buffer_load_dwordx4 v16, s[4:7], s44 offen lds
    s_add_u32 m0, s45, 18432
    s_mov_b32 s44, 6553600
    buffer_load_dwordx4 v16, s[4:7], s44 offen lds
    s_add_u32 m0, s45, 19456
    s_mov_b32 s44, 6684672
    buffer_load_dwordx4 v16, s[4:7], s44 offen lds
    s_add_u32 m0, s45, 20480
    s_mov_b32 s44, 6815744
    buffer_load_dwordx4 v16, s[4:7], s44 offen lds
    s_add_u32 m0, s45, 21504
    s_mov_b32 s44, 6946816
    buffer_load_dwordx4 v16, s[4:7], s44 offen lds
    s_add_u32 m0, s45, 22528
    s_mov_b32 s44, 7077888
    buffer_load_dwordx4 v16, s[4:7], s44 offen lds
    s_add_u32 m0, s45, 23552
    s_mov_b32 s44, 7208960
    buffer_load_dwordx4 v16, s[4:7], s44 offen lds
    s_add_u32 m0, s45, 24576
    s_mov_b32 s44, 7340032
    buffer_load_dwordx4 v16, s[4:7], s44 offen lds
    s_add_u32 m0, s45, 25600
    s_mov_b32 s44, 7471104
    buffer_load_dwordx4 v16, s[4:7], s44 offen lds
    s_add_u32 m0, s45, 26624
    s_mov_b32 s44, 7602176
    buffer_load_dwordx4 v16, s[4:7], s44 offen lds
    s_add_u32 m0, s45, 27648
    s_mov_b32 s44, 7733248
    buffer_load_dwordx4 v16, s[4:7], s44 offen lds
    s_add_u32 m0, s45, 28672
    s_mov_b32 s44, 7864320
    buffer_load_dwordx4 v16, s[4:7], s44 offen lds
    s_add_u32 m0, s45, 29696
    s_mov_b32 s44, 7995392
    buffer_load_dwordx4 v16, s[4:7], s44 offen lds
    s_add_u32 m0, s45, 30720
    s_mov_b32 s44, 8126464
    buffer_load_dwordx4 v16, s[4:7], s44 offen lds
    s_add_u32 m0, s45, 31744
    s_mov_b32 s44, 8257536
    buffer_load_dwordx4 v16, s[4:7], s44 offen lds
    s_waitcnt vmcnt(16)
    ds_read_b64_tr_b16 a[128:129], v17 offset:0
    ds_read_b64_tr_b16 a[130:131], v17 offset:256
    ds_read_b64_tr_b16 a[132:133], v17 offset:1024
    ds_read_b64_tr_b16 a[134:135], v17 offset:1280
    ds_read_b64_tr_b16 a[136:137], v17 offset:2048
    ds_read_b64_tr_b16 a[138:139], v17 offset:2304
    ds_read_b64_tr_b16 a[140:141], v17 offset:3072
    ds_read_b64_tr_b16 a[142:143], v17 offset:3328
    s_waitcnt lgkmcnt(0)
    ds_read_b64_tr_b16 a[144:145], v17 offset:4096
    ds_read_b64_tr_b16 a[146:147], v17 offset:4352
    ds_read_b64_tr_b16 a[148:149], v17 offset:5120
    ds_read_b64_tr_b16 a[150:151], v17 offset:5376
    ds_read_b64_tr_b16 a[152:153], v17 offset:6144
    ds_read_b64_tr_b16 a[154:155], v17 offset:6400
    ds_read_b64_tr_b16 a[156:157], v17 offset:7168
    ds_read_b64_tr_b16 a[158:159], v17 offset:7424
    s_waitcnt lgkmcnt(0)
    ds_read_b64_tr_b16 a[160:161], v17 offset:8192
    ds_read_b64_tr_b16 a[162:163], v17 offset:8448
    ds_read_b64_tr_b16 a[164:165], v17 offset:9216
    ds_read_b64_tr_b16 a[166:167], v17 offset:9472
    ds_read_b64_tr_b16 a[168:169], v17 offset:10240
    ds_read_b64_tr_b16 a[170:171], v17 offset:10496
    ds_read_b64_tr_b16 a[172:173], v17 offset:11264
    ds_read_b64_tr_b16 a[174:175], v17 offset:11520
    s_waitcnt lgkmcnt(0)
    ds_read_b64_tr_b16 a[176:177], v17 offset:12288
    ds_read_b64_tr_b16 a[178:179], v17 offset:12544
    ds_read_b64_tr_b16 a[180:181], v17 offset:13312
    ds_read_b64_tr_b16 a[182:183], v17 offset:13568
    ds_read_b64_tr_b16 a[184:185], v17 offset:14336
    ds_read_b64_tr_b16 a[186:187], v17 offset:14592
    ds_read_b64_tr_b16 a[188:189], v17 offset:15360
    ds_read_b64_tr_b16 a[190:191], v17 offset:15616
    s_waitcnt lgkmcnt(0)
    s_waitcnt vmcnt(0)
    ds_read_b64_tr_b16 a[192:193], v17 offset:16384
    ds_read_b64_tr_b16 a[194:195], v17 offset:16640
    ds_read_b64_tr_b16 a[196:197], v17 offset:17408
    ds_read_b64_tr_b16 a[198:199], v17 offset:17664
    ds_read_b64_tr_b16 a[200:201], v17 offset:18432
    ds_read_b64_tr_b16 a[202:203], v17 offset:18688
    ds_read_b64_tr_b16 a[204:205], v17 offset:19456
    ds_read_b64_tr_b16 a[206:207], v17 offset:19712
    s_waitcnt lgkmcnt(0)
    ds_read_b64_tr_b16 a[208:209], v17 offset:20480
    ds_read_b64_tr_b16 a[210:211], v17 offset:20736
    ds_read_b64_tr_b16 a[212:213], v17 offset:21504
    ds_read_b64_tr_b16 a[214:215], v17 offset:21760
    ds_read_b64_tr_b16 a[216:217], v17 offset:22528
    ds_read_b64_tr_b16 a[218:219], v17 offset:22784
    ds_read_b64_tr_b16 a[220:221], v17 offset:23552
    ds_read_b64_tr_b16 a[222:223], v17 offset:23808
    s_waitcnt lgkmcnt(0)
    ds_read_b64_tr_b16 a[224:225], v17 offset:24576
    ds_read_b64_tr_b16 a[226:227], v17 offset:24832
    ds_read_b64_tr_b16 a[228:229], v17 offset:25600
    ds_read_b64_tr_b16 a[230:231], v17 offset:25856
    ds_read_b64_tr_b16 a[232:233], v17 offset:26624
    ds_read_b64_tr_b16 a[234:235], v17 offset:26880
    ds_read_b64_tr_b16 a[236:237], v17 offset:27648
    ds_read_b64_tr_b16 a[238:239], v17 offset:27904
    s_waitcnt lgkmcnt(0)
    ds_read_b64_tr_b16 a[240:241], v17 offset:28672
    ds_read_b64_tr_b16 a[242:243], v17 offset:28928
    ds_read_b64_tr_b16 a[244:245], v17 offset:29696
    ds_read_b64_tr_b16 a[246:247], v17 offset:29952
    ds_read_b64_tr_b16 a[248:249], v17 offset:30720
    ds_read_b64_tr_b16 a[250:251], v17 offset:30976
    ds_read_b64_tr_b16 a[252:253], v17 offset:31744
    ds_read_b64_tr_b16 a[254:255], v17 offset:32000
    s_waitcnt lgkmcnt(0)
    s_barrier
    v_lshrrev_b32 v2, 3, v1
    s_lshl_b32 s43, s41, 3
    v_add_u32 v2, s43, v2
    v_bfe_u32 v3, v2, 1, 3
    v_and_b32 v4, 7, v1
    v_xor_b32 v3, v3, v4
    v_lshlrev_b32 v6, 11, v2
    v_lshl_add_u32 v6, v3, 4, v6
    s_lshl_b32 s46, s41, 10
    v_and_b32 v2, 15, v1
    v_bfe_u32 v3, v2, 1, 3
    v_lshrrev_b32 v4, 4, v1
    v_xor_b32 v3, v3, v4
    v_lshlrev_b32 v8, 7, v2
    v_lshl_add_u32 v8, v3, 4, v8
    v_xor_b32 v9, 64, v8
    v_add_u32 v10, 0x10000, v8
    v_add_u32 v11, 0x10000, v9
    v_mov_b32 v7, v5
    v_and_b32 v2, 31, v1
    v_bfe_u32 v3, v2, 1, 3
    v_lshrrev_b32 v4, 5, v1
    v_xor_b32 v3, v3, v4
    v_lshlrev_b32 v8, 7, v2
    v_lshl_add_u32 v8, v3, 4, v8
    v_xor_b32 v9, 32, v8
    v_xor_b32 v10, 64, v8
    v_xor_b32 v11, 96, v8
    v_add_u32 v12, 0x10000, v8
    v_add_u32 v13, 0x10000, v9
    v_add_u32 v14, 0x10000, v10
    v_add_u32 v15, 0x10000, v11
    v_bfe_u32 v3, v1, 4, 1
    v_lshlrev_b32 v7, 10, v3
    v_lshl_add_u32 v7, v4, 8, v7
    v_and_b32 v3, 15, v1
    v_lshl_add_u32 v7, v3, 4, v7
    s_lshl_b32 s47, s40, 2
    s_add_u32 s47, s47, s41
    s_mov_b32 s42, 0
    s_lshr_b32 s44, s47, 3
    s_xor_b32 s44, s44, s98
    s_and_b32 s44, s44, 1
    s_lshl_b32 s44, s44, 13
    s_lshl_b32 s48, s47, 18
    s_add_u32 s48, s48, s44
    s_add_u32 s48, s48, 33554432
    s_xor_b32 s44, s98, 1
    s_lshl_b32 s44, s44, 13
    s_lshl_b32 s49, s40, 7
    s_add_u32 s49, s49, s44
    s_lshl_b32 s44, s41, 2
    s_add_u32 s49, s49, s44
    s_add_u32 s49, s49, 70258688
    v_mov_b32 v16, 0
    s_mov_b32 s50, 0
    s_add_u32 m0, s46, 0
    s_nop 0
    buffer_load_dwordx4 v6, s[8:11], s50 offen offset:0 lds
    s_add_u32 m0, s46, 3968
    s_nop 0
    buffer_load_dwordx4 v6, s[8:11], s50 offen offset:128 lds
    s_add_u32 m0, s46, 7936
    s_nop 0
    buffer_load_dwordx4 v6, s[8:11], s50 offen offset:256 lds
    s_add_u32 m0, s46, 11904
    s_nop 0
    buffer_load_dwordx4 v6, s[8:11], s50 offen offset:384 lds
    s_add_u32 m0, s46, 15872
    s_nop 0
    buffer_load_dwordx4 v6, s[8:11], s50 offen offset:512 lds
    s_add_u32 m0, s46, 19840
    s_nop 0
    buffer_load_dwordx4 v6, s[8:11], s50 offen offset:640 lds
    s_add_u32 m0, s46, 23808
    s_nop 0
    buffer_load_dwordx4 v6, s[8:11], s50 offen offset:768 lds
    s_add_u32 m0, s46, 27776
    s_nop 0
    buffer_load_dwordx4 v6, s[8:11], s50 offen offset:896 lds
    s_add_u32 m0, s46, 31744
    s_nop 0
    buffer_load_dwordx4 v6, s[8:11], s50 offen offset:1024 lds
    s_add_u32 m0, s46, 35712
    s_nop 0
    buffer_load_dwordx4 v6, s[8:11], s50 offen offset:1152 lds
    s_add_u32 m0, s46, 39680
    s_nop 0
    buffer_load_dwordx4 v6, s[8:11], s50 offen offset:1280 lds
    s_add_u32 m0, s46, 43648
    s_nop 0
    buffer_load_dwordx4 v6, s[8:11], s50 offen offset:1408 lds
    s_add_u32 m0, s46, 47616
    s_nop 0
    buffer_load_dwordx4 v6, s[8:11], s50 offen offset:1536 lds
    s_add_u32 m0, s46, 51584
    s_nop 0
    buffer_load_dwordx4 v6, s[8:11], s50 offen offset:1664 lds
    s_add_u32 m0, s46, 55552
    s_nop 0
    buffer_load_dwordx4 v6, s[8:11], s50 offen offset:1792 lds
    s_add_u32 m0, s46, 59520
    s_nop 0
    buffer_load_dwordx4 v6, s[8:11], s50 offen offset:1920 lds
    s_and_b32 s53, s47, 31
    s_lshl_b32 s53, s53, 4
    v_add_u32 v19, s53, v1
    v_lshlrev_b32 v19, 7, v19
    s_waitcnt vmcnt(0)
    s_barrier
    s_add_u32 s50, s42, 1
    s_min_u32 s50, s50, 63
    s_lshl_b32 s50, s50, 16
    ds_read_b128 v[20:23], v8 offset:0
    ds_read_b128 v[24:27], v9 offset:0
    ds_read_b128 v[28:31], v10 offset:0
    ds_read_b128 v[32:35], v11 offset:0
    ds_read_b128 v[36:39], v8 offset:4096
    ds_read_b128 v[40:43], v9 offset:4096
    s_add_u32 m0, s46, 65536
    s_waitcnt lgkmcnt(4)
    v_mfma_f32_32x32x16_bf16 v[52:67], v[20:23], a[0:3], 0
    ds_read_b128 v[44:47], v10 offset:4096
    buffer_load_dwordx4 v6, s[8:11], s50 offen offset:0 lds
    v_mfma_f32_32x32x16_bf16 v[52:67], v[24:27], a[4:7], v[52:67]
    ds_read_b128 v[48:51], v11 offset:4096
    s_add_u32 m0, s46, 69504
    s_waitcnt lgkmcnt(4)
    v_mfma_f32_32x32x16_bf16 v[52:67], v[28:31], a[8:11], v[52:67]
    ds_read_b128 v[20:23], v8 offset:8192
    buffer_load_dwordx4 v6, s[8:11], s50 offen offset:128 lds
    v_mfma_f32_32x32x16_bf16 v[52:67], v[32:35], a[12:15], v[52:67]
    ds_read_b128 v[24:27], v9 offset:8192
    s_add_u32 m0, s46, 73472
    s_waitcnt lgkmcnt(4)
    v_mfma_f32_32x32x16_bf16 v[52:67], v[36:39], a[16:19], v[52:67]
    ds_read_b128 v[28:31], v10 offset:8192
    buffer_load_dwordx4 v6, s[8:11], s50 offen offset:256 lds
    v_mfma_f32_32x32x16_bf16 v[52:67], v[40:43], a[20:23], v[52:67]
    ds_read_b128 v[32:35], v11 offset:8192
    s_add_u32 m0, s46, 77440
    s_waitcnt lgkmcnt(4)
    v_mfma_f32_32x32x16_bf16 v[52:67], v[44:47], a[24:27], v[52:67]
    ds_read_b128 v[36:39], v8 offset:12288
    buffer_load_dwordx4 v6, s[8:11], s50 offen offset:384 lds
    v_mfma_f32_32x32x16_bf16 v[52:67], v[48:51], a[28:31], v[52:67]
    ds_read_b128 v[40:43], v9 offset:12288
    s_add_u32 m0, s46, 81408
    s_waitcnt lgkmcnt(4)
    v_mfma_f32_32x32x16_bf16 v[52:67], v[20:23], a[32:35], v[52:67]
    ds_read_b128 v[44:47], v10 offset:12288
    buffer_load_dwordx4 v6, s[8:11], s50 offen offset:512 lds
    v_mfma_f32_32x32x16_bf16 v[52:67], v[24:27], a[36:39], v[52:67]
    ds_read_b128 v[48:51], v11 offset:12288
    s_add_u32 m0, s46, 85376
    s_waitcnt lgkmcnt(4)
    v_mfma_f32_32x32x16_bf16 v[52:67], v[28:31], a[40:43], v[52:67]
    ds_read_b128 v[20:23], v8 offset:16384
    buffer_load_dwordx4 v6, s[8:11], s50 offen offset:640 lds
    v_mfma_f32_32x32x16_bf16 v[52:67], v[32:35], a[44:47], v[52:67]
    ds_read_b128 v[24:27], v9 offset:16384
    s_add_u32 m0, s46, 89344
    s_waitcnt lgkmcnt(4)
    v_mfma_f32_32x32x16_bf16 v[52:67], v[36:39], a[48:51], v[52:67]
    ds_read_b128 v[28:31], v10 offset:16384
    buffer_load_dwordx4 v6, s[8:11], s50 offen offset:768 lds
    v_mfma_f32_32x32x16_bf16 v[52:67], v[40:43], a[52:55], v[52:67]
    ds_read_b128 v[32:35], v11 offset:16384
    s_add_u32 m0, s46, 93312
    s_waitcnt lgkmcnt(4)
    v_mfma_f32_32x32x16_bf16 v[52:67], v[44:47], a[56:59], v[52:67]
    ds_read_b128 v[36:39], v8 offset:20480
    buffer_load_dwordx4 v6, s[8:11], s50 offen offset:896 lds
    v_mfma_f32_32x32x16_bf16 v[52:67], v[48:51], a[60:63], v[52:67]
    ds_read_b128 v[40:43], v9 offset:20480
    s_add_u32 m0, s46, 97280
    s_waitcnt lgkmcnt(4)
    v_mfma_f32_32x32x16_bf16 v[52:67], v[20:23], a[64:67], v[52:67]
    ds_read_b128 v[44:47], v10 offset:20480
    buffer_load_dwordx4 v6, s[8:11], s50 offen offset:1024 lds
    v_mfma_f32_32x32x16_bf16 v[52:67], v[24:27], a[68:71], v[52:67]
    ds_read_b128 v[48:51], v11 offset:20480
    s_add_u32 m0, s46, 101248
    s_waitcnt lgkmcnt(4)
    v_mfma_f32_32x32x16_bf16 v[52:67], v[28:31], a[72:75], v[52:67]
    ds_read_b128 v[20:23], v8 offset:24576
    buffer_load_dwordx4 v6, s[8:11], s50 offen offset:1152 lds
    v_mfma_f32_32x32x16_bf16 v[52:67], v[32:35], a[76:79], v[52:67]
    ds_read_b128 v[24:27], v9 offset:24576
    s_add_u32 m0, s46, 105216
    s_waitcnt lgkmcnt(4)
    v_mfma_f32_32x32x16_bf16 v[52:67], v[36:39], a[80:83], v[52:67]
    ds_read_b128 v[28:31], v10 offset:24576
    buffer_load_dwordx4 v6, s[8:11], s50 offen offset:1280 lds
    v_mfma_f32_32x32x16_bf16 v[52:67], v[40:43], a[84:87], v[52:67]
    ds_read_b128 v[32:35], v11 offset:24576
    s_add_u32 m0, s46, 109184
    s_waitcnt lgkmcnt(4)
    v_mfma_f32_32x32x16_bf16 v[52:67], v[44:47], a[88:91], v[52:67]
    ds_read_b128 v[36:39], v8 offset:28672
    buffer_load_dwordx4 v6, s[8:11], s50 offen offset:1408 lds
    v_mfma_f32_32x32x16_bf16 v[52:67], v[48:51], a[92:95], v[52:67]
    ds_read_b128 v[40:43], v9 offset:28672
    s_add_u32 m0, s46, 113152
    s_waitcnt lgkmcnt(4)
    v_mfma_f32_32x32x16_bf16 v[52:67], v[20:23], a[96:99], v[52:67]
    ds_read_b128 v[44:47], v10 offset:28672
    buffer_load_dwordx4 v6, s[8:11], s50 offen offset:1536 lds
    v_mfma_f32_32x32x16_bf16 v[52:67], v[24:27], a[100:103], v[52:67]
    ds_read_b128 v[48:51], v11 offset:28672
    s_add_u32 m0, s46, 117120
    s_waitcnt lgkmcnt(4)
    v_mfma_f32_32x32x16_bf16 v[52:67], v[28:31], a[104:107], v[52:67]
    ds_read_b128 v[20:23], v8 offset:32768
    buffer_load_dwordx4 v6, s[8:11], s50 offen offset:1664 lds
    v_mfma_f32_32x32x16_bf16 v[52:67], v[32:35], a[108:111], v[52:67]
    ds_read_b128 v[24:27], v9 offset:32768
    s_add_u32 m0, s46, 121088
    s_waitcnt lgkmcnt(4)
    v_mfma_f32_32x32x16_bf16 v[52:67], v[36:39], a[112:115], v[52:67]
    ds_read_b128 v[28:31], v10 offset:32768
    buffer_load_dwordx4 v6, s[8:11], s50 offen offset:1792 lds
    v_mfma_f32_32x32x16_bf16 v[52:67], v[40:43], a[116:119], v[52:67]
    ds_read_b128 v[32:35], v11 offset:32768
    s_add_u32 m0, s46, 125056
    s_waitcnt lgkmcnt(4)
    v_mfma_f32_32x32x16_bf16 v[52:67], v[44:47], a[120:123], v[52:67]
    ds_read_b128 v[36:39], v8 offset:36864
    buffer_load_dwordx4 v6, s[8:11], s50 offen offset:1920 lds
    v_mfma_f32_32x32x16_bf16 v[52:67], v[48:51], a[124:127], v[52:67]
    ds_read_b128 v[40:43], v9 offset:36864
    s_waitcnt lgkmcnt(4)
    v_mfma_f32_32x32x16_bf16 v[52:67], v[20:23], a[128:131], v[52:67]
    ds_read_b128 v[44:47], v10 offset:36864
    v_mfma_f32_32x32x16_bf16 v[52:67], v[24:27], a[132:135], v[52:67]
    ds_read_b128 v[48:51], v11 offset:36864
    s_waitcnt lgkmcnt(4)
    v_mfma_f32_32x32x16_bf16 v[52:67], v[28:31], a[136:139], v[52:67]
    ds_read_b128 v[20:23], v8 offset:40960
    v_mfma_f32_32x32x16_bf16 v[52:67], v[32:35], a[140:143], v[52:67]
    ds_read_b128 v[24:27], v9 offset:40960
    s_waitcnt lgkmcnt(4)
    v_mfma_f32_32x32x16_bf16 v[52:67], v[36:39], a[144:147], v[52:67]
    ds_read_b128 v[28:31], v10 offset:40960
    v_mfma_f32_32x32x16_bf16 v[52:67], v[40:43], a[148:151], v[52:67]
    ds_read_b128 v[32:35], v11 offset:40960
    s_waitcnt lgkmcnt(4)
    v_mfma_f32_32x32x16_bf16 v[52:67], v[44:47], a[152:155], v[52:67]
    ds_read_b128 v[36:39], v8 offset:45056
    v_mfma_f32_32x32x16_bf16 v[52:67], v[48:51], a[156:159], v[52:67]
    ds_read_b128 v[40:43], v9 offset:45056
    s_waitcnt lgkmcnt(4)
    v_mfma_f32_32x32x16_bf16 v[52:67], v[20:23], a[160:163], v[52:67]
    ds_read_b128 v[44:47], v10 offset:45056
    v_mfma_f32_32x32x16_bf16 v[52:67], v[24:27], a[164:167], v[52:67]
    ds_read_b128 v[48:51], v11 offset:45056
    s_waitcnt lgkmcnt(4)
    v_mfma_f32_32x32x16_bf16 v[52:67], v[28:31], a[168:171], v[52:67]
    ds_read_b128 v[20:23], v8 offset:49152
    v_mfma_f32_32x32x16_bf16 v[52:67], v[32:35], a[172:175], v[52:67]
    ds_read_b128 v[24:27], v9 offset:49152
    s_waitcnt lgkmcnt(4)
    v_mfma_f32_32x32x16_bf16 v[52:67], v[36:39], a[176:179], v[52:67]
    ds_read_b128 v[28:31], v10 offset:49152
    v_mfma_f32_32x32x16_bf16 v[52:67], v[40:43], a[180:183], v[52:67]
    ds_read_b128 v[32:35], v11 offset:49152
    s_waitcnt lgkmcnt(4)
    v_mfma_f32_32x32x16_bf16 v[52:67], v[44:47], a[184:187], v[52:67]
    ds_read_b128 v[36:39], v8 offset:53248
    v_mfma_f32_32x32x16_bf16 v[52:67], v[48:51], a[188:191], v[52:67]
    ds_read_b128 v[40:43], v9 offset:53248
    s_waitcnt lgkmcnt(4)
    v_mfma_f32_32x32x16_bf16 v[52:67], v[20:23], a[192:195], v[52:67]
    ds_read_b128 v[44:47], v10 offset:53248
    v_mfma_f32_32x32x16_bf16 v[52:67], v[24:27], a[196:199], v[52:67]
    ds_read_b128 v[48:51], v11 offset:53248
    s_waitcnt lgkmcnt(4)
    v_mfma_f32_32x32x16_bf16 v[52:67], v[28:31], a[200:203], v[52:67]
    ds_read_b128 v[20:23], v8 offset:57344
    v_mfma_f32_32x32x16_bf16 v[52:67], v[32:35], a[204:207], v[52:67]
    ds_read_b128 v[24:27], v9 offset:57344
    s_waitcnt lgkmcnt(4)
    v_mfma_f32_32x32x16_bf16 v[52:67], v[36:39], a[208:211], v[52:67]
    ds_read_b128 v[28:31], v10 offset:57344
    v_mfma_f32_32x32x16_bf16 v[52:67], v[40:43], a[212:215], v[52:67]
    ds_read_b128 v[32:35], v11 offset:57344
    s_waitcnt lgkmcnt(4)
    v_mfma_f32_32x32x16_bf16 v[52:67], v[44:47], a[216:219], v[52:67]
    ds_read_b128 v[36:39], v8 offset:61440
    v_mfma_f32_32x32x16_bf16 v[52:67], v[48:51], a[220:223], v[52:67]
    ds_read_b128 v[40:43], v9 offset:61440
    s_waitcnt lgkmcnt(4)
    v_mfma_f32_32x32x16_bf16 v[52:67], v[20:23], a[224:227], v[52:67]
    ds_read_b128 v[44:47], v10 offset:61440
    v_mfma_f32_32x32x16_bf16 v[52:67], v[24:27], a[228:231], v[52:67]
    ds_read_b128 v[48:51], v11 offset:61440
    s_waitcnt lgkmcnt(5)
    v_mfma_f32_32x32x16_bf16 v[52:67], v[28:31], a[232:235], v[52:67]
    s_waitcnt lgkmcnt(4)
    v_mfma_f32_32x32x16_bf16 v[52:67], v[32:35], a[236:239], v[52:67]
    s_waitcnt lgkmcnt(3)
    v_mfma_f32_32x32x16_bf16 v[52:67], v[36:39], a[240:243], v[52:67]
    s_waitcnt lgkmcnt(2)
    v_mfma_f32_32x32x16_bf16 v[52:67], v[40:43], a[244:247], v[52:67]
    s_waitcnt lgkmcnt(1)
    v_mfma_f32_32x32x16_bf16 v[52:67], v[44:47], a[248:251], v[52:67]
    s_waitcnt lgkmcnt(0)
    v_mfma_f32_32x32x16_bf16 v[52:67], v[48:51], a[252:255], v[52:67]
    s_add_u32 s42, s42, 1
    s_cmp_le_u32 s42, 4
    s_cbranch_scc0 mega_kernel_v_ne01
    s_nop 9
    v_cvt_pk_bf16_f32 v84, v52, v53
    v_cvt_pk_bf16_f32 v85, v54, v55
    v_cvt_pk_bf16_f32 v86, v60, v61
    v_cvt_pk_bf16_f32 v87, v62, v63
    v_cvt_pk_bf16_f32 v88, v56, v57
    v_cvt_pk_bf16_f32 v89, v58, v59
    v_cvt_pk_bf16_f32 v90, v64, v65
    v_cvt_pk_bf16_f32 v91, v66, v67
    s_add_u32 s51, s42, s47
    s_sub_u32 s51, s51, 1
    s_bfe_u32 s52, s51, 0x40002
    s_lshl_b32 s52, s52, 14
    s_and_b32 s51, s51, 3
    s_lshl_b32 s51, s51, 11
    s_add_u32 s51, s51, s52
    s_add_u32 s51, s51, s48
    buffer_store_dwordx4 v[84:87], v7, s[84:87], s51 offen sc1
    buffer_store_dwordx4 v[88:91], v7, s[84:87], s51 offen offset:512 sc1
    s_waitcnt vmcnt(0)
    v_mov_b32 v17, s42
    s_mov_b64 exec, 1
    buffer_store_dword v17, v16, s[84:87], s49 offen sc1
    s_mov_b64 exec, -1
mega_kernel_v_ne01:
    s_waitcnt vmcnt(0)
mega_kernel_v_loop:
    s_waitcnt vmcnt(4)
    s_barrier
    s_add_u32 s50, s42, 1
    s_min_u32 s50, s50, 63
    s_lshl_b32 s50, s50, 16
    ds_read_b128 v[20:23], v12 offset:0
    ds_read_b128 v[24:27], v13 offset:0
    ds_read_b128 v[28:31], v14 offset:0
    ds_read_b128 v[32:35], v15 offset:0
    ds_read_b128 v[36:39], v12 offset:4096
    ds_read_b128 v[40:43], v13 offset:4096
    s_add_u32 m0, s46, 0
    s_waitcnt lgkmcnt(4)
    v_mfma_f32_32x32x16_bf16 v[68:83], v[20:23], a[0:3], 0
    ds_read_b128 v[44:47], v14 offset:4096
    buffer_load_dwordx4 v6, s[8:11], s50 offen offset:0 lds
    v_mfma_f32_32x32x16_bf16 v[68:83], v[24:27], a[4:7], v[68:83]
    ds_read_b128 v[48:51], v15 offset:4096
    s_add_u32 m0, s46, 3968
    s_waitcnt lgkmcnt(4)
    v_mfma_f32_32x32x16_bf16 v[68:83], v[28:31], a[8:11], v[68:83]
    ds_read_b128 v[20:23], v12 offset:8192
    buffer_load_dwordx4 v6, s[8:11], s50 offen offset:128 lds
    v_mfma_f32_32x32x16_bf16 v[68:83], v[32:35], a[12:15], v[68:83]
    ds_read_b128 v[24:27], v13 offset:8192
    s_add_u32 m0, s46, 7936
    s_waitcnt lgkmcnt(4)
    v_mfma_f32_32x32x16_bf16 v[68:83], v[36:39], a[16:19], v[68:83]
    ds_read_b128 v[28:31], v14 offset:8192
    buffer_load_dwordx4 v6, s[8:11], s50 offen offset:256 lds
    v_mfma_f32_32x32x16_bf16 v[68:83], v[40:43], a[20:23], v[68:83]
    ds_read_b128 v[32:35], v15 offset:8192
    s_add_u32 m0, s46, 11904
    s_waitcnt lgkmcnt(4)
    v_mfma_f32_32x32x16_bf16 v[68:83], v[44:47], a[24:27], v[68:83]
    ds_read_b128 v[36:39], v12 offset:12288
    buffer_load_dwordx4 v6, s[8:11], s50 offen offset:384 lds
    v_mfma_f32_32x32x16_bf16 v[68:83], v[48:51], a[28:31], v[68:83]
    ds_read_b128 v[40:43], v13 offset:12288
    s_add_u32 m0, s46, 15872
    s_waitcnt lgkmcnt(4)
    v_mfma_f32_32x32x16_bf16 v[68:83], v[20:23], a[32:35], v[68:83]
    ds_read_b128 v[44:47], v14 offset:12288
    buffer_load_dwordx4 v6, s[8:11], s50 offen offset:512 lds
    v_mfma_f32_32x32x16_bf16 v[68:83], v[24:27], a[36:39], v[68:83]
    ds_read_b128 v[48:51], v15 offset:12288
    s_add_u32 m0, s46, 19840
    s_waitcnt lgkmcnt(4)
    v_mfma_f32_32x32x16_bf16 v[68:83], v[28:31], a[40:43], v[68:83]
    ds_read_b128 v[20:23], v12 offset:16384
    buffer_load_dwordx4 v6, s[8:11], s50 offen offset:640 lds
    v_mfma_f32_32x32x16_bf16 v[68:83], v[32:35], a[44:47], v[68:83]
    ds_read_b128 v[24:27], v13 offset:16384
    s_add_u32 m0, s46, 23808
    s_waitcnt lgkmcnt(4)
    v_mfma_f32_32x32x16_bf16 v[68:83], v[36:39], a[48:51], v[68:83]
    ds_read_b128 v[28:31], v14 offset:16384
    buffer_load_dwordx4 v6, s[8:11], s50 offen offset:768 lds
    v_mfma_f32_32x32x16_bf16 v[68:83], v[40:43], a[52:55], v[68:83]
    ds_read_b128 v[32:35], v15 offset:16384
    s_add_u32 m0, s46, 27776
    s_waitcnt lgkmcnt(4)
    v_mfma_f32_32x32x16_bf16 v[68:83], v[44:47], a[56:59], v[68:83]
    ds_read_b128 v[36:39], v12 offset:20480
    buffer_load_dwordx4 v6, s[8:11], s50 offen offset:896 lds
    v_mfma_f32_32x32x16_bf16 v[68:83], v[48:51], a[60:63], v[68:83]
    ds_read_b128 v[40:43], v13 offset:20480
    s_add_u32 m0, s46, 31744
    s_waitcnt lgkmcnt(4)
    v_mfma_f32_32x32x16_bf16 v[68:83], v[20:23], a[64:67], v[68:83]
    ds_read_b128 v[44:47], v14 offset:20480
    buffer_load_dwordx4 v6, s[8:11], s50 offen offset:1024 lds
    v_mfma_f32_32x32x16_bf16 v[68:83], v[24:27], a[68:71], v[68:83]
    ds_read_b128 v[48:51], v15 offset:20480
    s_add_u32 m0, s46, 35712
    s_waitcnt lgkmcnt(4)
    v_mfma_f32_32x32x16_bf16 v[68:83], v[28:31], a[72:75], v[68:83]
    ds_read_b128 v[20:23], v12 offset:24576
    buffer_load_dwordx4 v6, s[8:11], s50 offen offset:1152 lds
    v_mfma_f32_32x32x16_bf16 v[68:83], v[32:35], a[76:79], v[68:83]
    ds_read_b128 v[24:27], v13 offset:24576
    s_add_u32 m0, s46, 39680
    s_waitcnt lgkmcnt(4)
    v_mfma_f32_32x32x16_bf16 v[68:83], v[36:39], a[80:83], v[68:83]
    ds_read_b128 v[28:31], v14 offset:24576
    buffer_load_dwordx4 v6, s[8:11], s50 offen offset:1280 lds
    v_mfma_f32_32x32x16_bf16 v[68:83], v[40:43], a[84:87], v[68:83]
    ds_read_b128 v[32:35], v15 offset:24576
    s_add_u32 m0, s46, 43648
    s_waitcnt lgkmcnt(4)
    v_mfma_f32_32x32x16_bf16 v[68:83], v[44:47], a[88:91], v[68:83]
    ds_read_b128 v[36:39], v12 offset:28672
    buffer_load_dwordx4 v6, s[8:11], s50 offen offset:1408 lds
    v_mfma_f32_32x32x16_bf16 v[68:83], v[48:51], a[92:95], v[68:83]
    ds_read_b128 v[40:43], v13 offset:28672
    s_add_u32 m0, s46, 47616
    s_waitcnt lgkmcnt(4)
    v_mfma_f32_32x32x16_bf16 v[68:83], v[20:23], a[96:99], v[68:83]
    ds_read_b128 v[44:47], v14 offset:28672
    buffer_load_dwordx4 v6, s[8:11], s50 offen offset:1536 lds
    v_mfma_f32_32x32x16_bf16 v[68:83], v[24:27], a[100:103], v[68:83]
    ds_read_b128 v[48:51], v15 offset:28672
    s_add_u32 m0, s46, 51584
    s_waitcnt lgkmcnt(4)
    v_mfma_f32_32x32x16_bf16 v[68:83], v[28:31], a[104:107], v[68:83]
    ds_read_b128 v[20:23], v12 offset:32768
    buffer_load_dwordx4 v6, s[8:11], s50 offen offset:1664 lds
    v_mfma_f32_32x32x16_bf16 v[68:83], v[32:35], a[108:111], v[68:83]
    ds_read_b128 v[24:27], v13 offset:32768
    s_add_u32 m0, s46, 55552
    s_waitcnt lgkmcnt(4)
    v_mfma_f32_32x32x16_bf16 v[68:83], v[36:39], a[112:115], v[68:83]
    ds_read_b128 v[28:31], v14 offset:32768
    buffer_load_dwordx4 v6, s[8:11], s50 offen offset:1792 lds
    v_mfma_f32_32x32x16_bf16 v[68:83], v[40:43], a[116:119], v[68:83]
    ds_read_b128 v[32:35], v15 offset:32768
    s_add_u32 m0, s46, 59520
    s_waitcnt lgkmcnt(4)
    v_mfma_f32_32x32x16_bf16 v[68:83], v[44:47], a[120:123], v[68:83]
    ds_read_b128 v[36:39], v12 offset:36864
    buffer_load_dwordx4 v6, s[8:11], s50 offen offset:1920 lds
    v_mfma_f32_32x32x16_bf16 v[68:83], v[48:51], a[124:127], v[68:83]
    ds_read_b128 v[40:43], v13 offset:36864
    s_waitcnt lgkmcnt(4)
    v_mfma_f32_32x32x16_bf16 v[68:83], v[20:23], a[128:131], v[68:83]
    ds_read_b128 v[44:47], v14 offset:36864
    v_mfma_f32_32x32x16_bf16 v[68:83], v[24:27], a[132:135], v[68:83]
    ds_read_b128 v[48:51], v15 offset:36864
    s_waitcnt vmcnt(16)
    s_sub_u32 s53, s42, 1
    s_cmp_le_u32 s42, 4
    s_cselect_b32 s53, s42, s53
    v_mov_b32 v17, s53
    s_mov_b64 exec, 1
    buffer_store_dword v17, v16, s[84:87], s49 offen sc1
    s_mov_b64 exec, -1
    s_waitcnt lgkmcnt(4)
    v_mfma_f32_32x32x16_bf16 v[68:83], v[28:31], a[136:139], v[68:83]
    ds_read_b128 v[20:23], v12 offset:40960
    v_cvt_pk_bf16_f32 v84, v52, v53
    v_cvt_pk_bf16_f32 v85, v54, v55
    v_mfma_f32_32x32x16_bf16 v[68:83], v[32:35], a[140:143], v[68:83]
    ds_read_b128 v[24:27], v13 offset:40960
    v_cvt_pk_bf16_f32 v86, v60, v61
    v_cvt_pk_bf16_f32 v87, v62, v63
    s_waitcnt lgkmcnt(4)
    v_mfma_f32_32x32x16_bf16 v[68:83], v[36:39], a[144:147], v[68:83]
    ds_read_b128 v[28:31], v14 offset:40960
    v_cvt_pk_bf16_f32 v88, v56, v57
    v_cvt_pk_bf16_f32 v89, v58, v59
    v_mfma_f32_32x32x16_bf16 v[68:83], v[40:43], a[148:151], v[68:83]
    ds_read_b128 v[32:35], v15 offset:40960
    v_cvt_pk_bf16_f32 v90, v64, v65
    v_cvt_pk_bf16_f32 v91, v66, v67
    s_waitcnt lgkmcnt(4)
    v_mfma_f32_32x32x16_bf16 v[68:83], v[44:47], a[152:155], v[68:83]
    ds_read_b128 v[36:39], v12 offset:45056
    s_add_u32 s51, s42, s47
    s_sub_u32 s51, s51, 1
    s_bfe_u32 s52, s51, 0x40002
    s_lshl_b32 s52, s52, 14
    v_mfma_f32_32x32x16_bf16 v[68:83], v[48:51], a[156:159], v[68:83]
    ds_read_b128 v[40:43], v13 offset:45056
    s_and_b32 s51, s51, 3
    s_lshl_b32 s51, s51, 11
    s_add_u32 s51, s51, s52
    s_add_u32 s51, s51, s48
    buffer_store_dwordx4 v[84:87], v7, s[84:87], s51 offen sc1
    s_waitcnt lgkmcnt(4)
    v_mfma_f32_32x32x16_bf16 v[68:83], v[20:23], a[160:163], v[68:83]
    ds_read_b128 v[44:47], v14 offset:45056
    buffer_store_dwordx4 v[88:91], v7, s[84:87], s51 offen offset:512 sc1
    v_mfma_f32_32x32x16_bf16 v[68:83], v[24:27], a[164:167], v[68:83]
    ds_read_b128 v[48:51], v15 offset:45056
    s_add_u32 s53, s42, 3
    s_min_u32 s53, s53, 63
    s_lshl_b32 s53, s53, 16
    s_mov_b64 exec, 0xffff
    buffer_load_dword v18, v19, s[8:11], s53 offen
    s_mov_b64 exec, -1
    s_waitcnt lgkmcnt(4)
    v_mfma_f32_32x32x16_bf16 v[68:83], v[28:31], a[168:171], v[68:83]
    ds_read_b128 v[20:23], v12 offset:49152
    v_mfma_f32_32x32x16_bf16 v[68:83], v[32:35], a[172:175], v[68:83]
    ds_read_b128 v[24:27], v13 offset:49152
    s_waitcnt lgkmcnt(4)
    v_mfma_f32_32x32x16_bf16 v[68:83], v[36:39], a[176:179], v[68:83]
    ds_read_b128 v[28:31], v14 offset:49152
    v_mfma_f32_32x32x16_bf16 v[68:83], v[40:43], a[180:183], v[68:83]
    ds_read_b128 v[32:35], v15 offset:49152
    s_waitcnt lgkmcnt(4)
    v_mfma_f32_32x32x16_bf16 v[68:83], v[44:47], a[184:187], v[68:83]
    ds_read_b128 v[36:39], v12 offset:53248
    v_mfma_f32_32x32x16_bf16 v[68:83], v[48:51], a[188:191], v[68:83]
    ds_read_b128 v[40:43], v13 offset:53248
    s_waitcnt lgkmcnt(4)
    v_mfma_f32_32x32x16_bf16 v[68:83], v[20:23], a[192:195], v[68:83]
    ds_read_b128 v[44:47], v14 offset:53248
    v_mfma_f32_32x32x16_bf16 v[68:83], v[24:27], a[196:199], v[68:83]
    ds_read_b128 v[48:51], v15 offset:53248
    s_waitcnt lgkmcnt(4)
    v_mfma_f32_32x32x16_bf16 v[68:83], v[28:31], a[200:203], v[68:83]
    ds_read_b128 v[20:23], v12 offset:57344
    v_mfma_f32_32x32x16_bf16 v[68:83], v[32:35], a[204:207], v[68:83]
    ds_read_b128 v[24:27], v13 offset:57344
    s_waitcnt lgkmcnt(4)
    v_mfma_f32_32x32x16_bf16 v[68:83], v[36:39], a[208:211], v[68:83]
    ds_read_b128 v[28:31], v14 offset:57344
    v_mfma_f32_32x32x16_bf16 v[68:83], v[40:43], a[212:215], v[68:83]
    ds_read_b128 v[32:35], v15 offset:57344
    s_waitcnt lgkmcnt(4)
    v_mfma_f32_32x32x16_bf16 v[68:83], v[44:47], a[216:219], v[68:83]
    ds_read_b128 v[36:39], v12 offset:61440
    v_mfma_f32_32x32x16_bf16 v[68:83], v[48:51], a[220:223], v[68:83]
    ds_read_b128 v[40:43], v13 offset:61440
    s_waitcnt lgkmcnt(4)
    v_mfma_f32_32x32x16_bf16 v[68:83], v[20:23], a[224:227], v[68:83]
    ds_read_b128 v[44:47], v14 offset:61440
    v_mfma_f32_32x32x16_bf16 v[68:83], v[24:27], a[228:231], v[68:83]
    ds_read_b128 v[48:51], v15 offset:61440
    s_waitcnt lgkmcnt(5)
    v_mfma_f32_32x32x16_bf16 v[68:83], v[28:31], a[232:235], v[68:83]
    s_waitcnt lgkmcnt(4)
    v_mfma_f32_32x32x16_bf16 v[68:83], v[32:35], a[236:239], v[68:83]
    s_waitcnt lgkmcnt(3)
    v_mfma_f32_32x32x16_bf16 v[68:83], v[36:39], a[240:243], v[68:83]
    s_waitcnt lgkmcnt(2)
    v_mfma_f32_32x32x16_bf16 v[68:83], v[40:43], a[244:247], v[68:83]
    s_waitcnt lgkmcnt(1)
    v_mfma_f32_32x32x16_bf16 v[68:83], v[44:47], a[248:251], v[68:83]
    s_waitcnt lgkmcnt(0)
    v_mfma_f32_32x32x16_bf16 v[68:83], v[48:51], a[252:255], v[68:83]
    s_add_u32 s42, s42, 1
    s_cmp_le_u32 s42, 4
    s_cbranch_scc0 mega_kernel_v_ne10
    s_nop 9
    v_cvt_pk_bf16_f32 v84, v68, v69
    v_cvt_pk_bf16_f32 v85, v70, v71
    v_cvt_pk_bf16_f32 v86, v76, v77
    v_cvt_pk_bf16_f32 v87, v78, v79
    v_cvt_pk_bf16_f32 v88, v72, v73
    v_cvt_pk_bf16_f32 v89, v74, v75
    v_cvt_pk_bf16_f32 v90, v80, v81
    v_cvt_pk_bf16_f32 v91, v82, v83
    s_add_u32 s51, s42, s47
    s_sub_u32 s51, s51, 1
    s_bfe_u32 s52, s51, 0x40002
    s_lshl_b32 s52, s52, 14
    s_and_b32 s51, s51, 3
    s_lshl_b32 s51, s51, 11
    s_add_u32 s51, s51, s52
    s_add_u32 s51, s51, s48
    buffer_store_dwordx4 v[84:87], v7, s[84:87], s51 offen sc1
    buffer_store_dwordx4 v[88:91], v7, s[84:87], s51 offen offset:512 sc1
    s_waitcnt vmcnt(0)
    v_mov_b32 v17, s42
    s_mov_b64 exec, 1
    buffer_store_dword v17, v16, s[84:87], s49 offen sc1
    s_mov_b64 exec, -1
mega_kernel_v_ne10:
    s_cmp_eq_u32 s42, 64
    s_cbranch_scc1 mega_kernel_v_fin
    s_waitcnt vmcnt(4)
    s_barrier
    s_add_u32 s50, s42, 1
    s_min_u32 s50, s50, 63
    s_lshl_b32 s50, s50, 16
    ds_read_b128 v[20:23], v8 offset:0
    ds_read_b128 v[24:27], v9 offset:0
    ds_read_b128 v[28:31], v10 offset:0
    ds_read_b128 v[32:35], v11 offset:0
    ds_read_b128 v[36:39], v8 offset:4096
    ds_read_b128 v[40:43], v9 offset:4096
    s_add_u32 m0, s46, 65536
    s_waitcnt lgkmcnt(4)
    v_mfma_f32_32x32x16_bf16 v[52:67], v[20:23], a[0:3], 0
    ds_read_b128 v[44:47], v10 offset:4096
    buffer_load_dwordx4 v6, s[8:11], s50 offen offset:0 lds
    v_mfma_f32_32x32x16_bf16 v[52:67], v[24:27], a[4:7], v[52:67]
    ds_read_b128 v[48:51], v11 offset:4096
    s_add_u32 m0, s46, 69504
    s_waitcnt lgkmcnt(4)
    v_mfma_f32_32x32x16_bf16 v[52:67], v[28:31], a[8:11], v[52:67]
    ds_read_b128 v[20:23], v8 offset:8192
    buffer_load_dwordx4 v6, s[8:11], s50 offen offset:128 lds
    v_mfma_f32_32x32x16_bf16 v[52:67], v[32:35], a[12:15], v[52:67]
    ds_read_b128 v[24:27], v9 offset:8192
    s_add_u32 m0, s46, 73472
    s_waitcnt lgkmcnt(4)
    v_mfma_f32_32x32x16_bf16 v[52:67], v[36:39], a[16:19], v[52:67]
    ds_read_b128 v[28:31], v10 offset:8192
    buffer_load_dwordx4 v6, s[8:11], s50 offen offset:256 lds
    v_mfma_f32_32x32x16_bf16 v[52:67], v[40:43], a[20:23], v[52:67]
    ds_read_b128 v[32:35], v11 offset:8192
    s_add_u32 m0, s46, 77440
    s_waitcnt lgkmcnt(4)
    v_mfma_f32_32x32x16_bf16 v[52:67], v[44:47], a[24:27], v[52:67]
    ds_read_b128 v[36:39], v8 offset:12288
    buffer_load_dwordx4 v6, s[8:11], s50 offen offset:384 lds
    v_mfma_f32_32x32x16_bf16 v[52:67], v[48:51], a[28:31], v[52:67]
    ds_read_b128 v[40:43], v9 offset:12288
    s_add_u32 m0, s46, 81408
    s_waitcnt lgkmcnt(4)
    v_mfma_f32_32x32x16_bf16 v[52:67], v[20:23], a[32:35], v[52:67]
    ds_read_b128 v[44:47], v10 offset:12288
    buffer_load_dwordx4 v6, s[8:11], s50 offen offset:512 lds
    v_mfma_f32_32x32x16_bf16 v[52:67], v[24:27], a[36:39], v[52:67]
    ds_read_b128 v[48:51], v11 offset:12288
    s_add_u32 m0, s46, 85376
    s_waitcnt lgkmcnt(4)
    v_mfma_f32_32x32x16_bf16 v[52:67], v[28:31], a[40:43], v[52:67]
    ds_read_b128 v[20:23], v8 offset:16384
    buffer_load_dwordx4 v6, s[8:11], s50 offen offset:640 lds
    v_mfma_f32_32x32x16_bf16 v[52:67], v[32:35], a[44:47], v[52:67]
    ds_read_b128 v[24:27], v9 offset:16384
    s_add_u32 m0, s46, 89344
    s_waitcnt lgkmcnt(4)
    v_mfma_f32_32x32x16_bf16 v[52:67], v[36:39], a[48:51], v[52:67]
    ds_read_b128 v[28:31], v10 offset:16384
    buffer_load_dwordx4 v6, s[8:11], s50 offen offset:768 lds
    v_mfma_f32_32x32x16_bf16 v[52:67], v[40:43], a[52:55], v[52:67]
    ds_read_b128 v[32:35], v11 offset:16384
    s_add_u32 m0, s46, 93312
    s_waitcnt lgkmcnt(4)
    v_mfma_f32_32x32x16_bf16 v[52:67], v[44:47], a[56:59], v[52:67]
    ds_read_b128 v[36:39], v8 offset:20480
    buffer_load_dwordx4 v6, s[8:11], s50 offen offset:896 lds
    v_mfma_f32_32x32x16_bf16 v[52:67], v[48:51], a[60:63], v[52:67]
    ds_read_b128 v[40:43], v9 offset:20480
    s_add_u32 m0, s46, 97280
    s_waitcnt lgkmcnt(4)
    v_mfma_f32_32x32x16_bf16 v[52:67], v[20:23], a[64:67], v[52:67]
    ds_read_b128 v[44:47], v10 offset:20480
    buffer_load_dwordx4 v6, s[8:11], s50 offen offset:1024 lds
    v_mfma_f32_32x32x16_bf16 v[52:67], v[24:27], a[68:71], v[52:67]
    ds_read_b128 v[48:51], v11 offset:20480
    s_add_u32 m0, s46, 101248
    s_waitcnt lgkmcnt(4)
    v_mfma_f32_32x32x16_bf16 v[52:67], v[28:31], a[72:75], v[52:67]
    ds_read_b128 v[20:23], v8 offset:24576
    buffer_load_dwordx4 v6, s[8:11], s50 offen offset:1152 lds
    v_mfma_f32_32x32x16_bf16 v[52:67], v[32:35], a[76:79], v[52:67]
    ds_read_b128 v[24:27], v9 offset:24576
    s_add_u32 m0, s46, 105216
    s_waitcnt lgkmcnt(4)
    v_mfma_f32_32x32x16_bf16 v[52:67], v[36:39], a[80:83], v[52:67]
    ds_read_b128 v[28:31], v10 offset:24576
    buffer_load_dwordx4 v6, s[8:11], s50 offen offset:1280 lds
    v_mfma_f32_32x32x16_bf16 v[52:67], v[40:43], a[84:87], v[52:67]
    ds_read_b128 v[32:35], v11 offset:24576
    s_add_u32 m0, s46, 109184
    s_waitcnt lgkmcnt(4)
    v_mfma_f32_32x32x16_bf16 v[52:67], v[44:47], a[88:91], v[52:67]
    ds_read_b128 v[36:39], v8 offset:28672
    buffer_load_dwordx4 v6, s[8:11], s50 offen offset:1408 lds
    v_mfma_f32_32x32x16_bf16 v[52:67], v[48:51], a[92:95], v[52:67]
    ds_read_b128 v[40:43], v9 offset:28672
    s_add_u32 m0, s46, 113152
    s_waitcnt lgkmcnt(4)
    v_mfma_f32_32x32x16_bf16 v[52:67], v[20:23], a[96:99], v[52:67]
    ds_read_b128 v[44:47], v10 offset:28672
    buffer_load_dwordx4 v6, s[8:11], s50 offen offset:1536 lds
    v_mfma_f32_32x32x16_bf16 v[52:67], v[24:27], a[100:103], v[52:67]
    ds_read_b128 v[48:51], v11 offset:28672
    s_add_u32 m0, s46, 117120
    s_waitcnt lgkmcnt(4)
    v_mfma_f32_32x32x16_bf16 v[52:67], v[28:31], a[104:107], v[52:67]
    ds_read_b128 v[20:23], v8 offset:32768
    buffer_load_dwordx4 v6, s[8:11], s50 offen offset:1664 lds
    v_mfma_f32_32x32x16_bf16 v[52:67], v[32:35], a[108:111], v[52:67]
    ds_read_b128 v[24:27], v9 offset:32768
    s_add_u32 m0, s46, 121088
    s_waitcnt lgkmcnt(4)
    v_mfma_f32_32x32x16_bf16 v[52:67], v[36:39], a[112:115], v[52:67]
    ds_read_b128 v[28:31], v10 offset:32768
    buffer_load_dwordx4 v6, s[8:11], s50 offen offset:1792 lds
    v_mfma_f32_32x32x16_bf16 v[52:67], v[40:43], a[116:119], v[52:67]
    ds_read_b128 v[32:35], v11 offset:32768
    s_add_u32 m0, s46, 125056
    s_waitcnt lgkmcnt(4)
    v_mfma_f32_32x32x16_bf16 v[52:67], v[44:47], a[120:123], v[52:67]
    ds_read_b128 v[36:39], v8 offset:36864
    buffer_load_dwordx4 v6, s[8:11], s50 offen offset:1920 lds
    v_mfma_f32_32x32x16_bf16 v[52:67], v[48:51], a[124:127], v[52:67]
    ds_read_b128 v[40:43], v9 offset:36864
    s_waitcnt lgkmcnt(4)
    v_mfma_f32_32x32x16_bf16 v[52:67], v[20:23], a[128:131], v[52:67]
    ds_read_b128 v[44:47], v10 offset:36864
    v_mfma_f32_32x32x16_bf16 v[52:67], v[24:27], a[132:135], v[52:67]
    ds_read_b128 v[48:51], v11 offset:36864
    s_waitcnt vmcnt(16)
    s_sub_u32 s53, s42, 1
    s_cmp_le_u32 s42, 4
    s_cselect_b32 s53, s42, s53
    v_mov_b32 v17, s53
    s_mov_b64 exec, 1
    buffer_store_dword v17, v16, s[84:87], s49 offen sc1
    s_mov_b64 exec, -1
    s_waitcnt lgkmcnt(4)
    v_mfma_f32_32x32x16_bf16 v[52:67], v[28:31], a[136:139], v[52:67]
    ds_read_b128 v[20:23], v8 offset:40960
    v_cvt_pk_bf16_f32 v84, v68, v69
    v_cvt_pk_bf16_f32 v85, v70, v71
    v_mfma_f32_32x32x16_bf16 v[52:67], v[32:35], a[140:143], v[52:67]
    ds_read_b128 v[24:27], v9 offset:40960
    v_cvt_pk_bf16_f32 v86, v76, v77
    v_cvt_pk_bf16_f32 v87, v78, v79
    s_waitcnt lgkmcnt(4)
    v_mfma_f32_32x32x16_bf16 v[52:67], v[36:39], a[144:147], v[52:67]
    ds_read_b128 v[28:31], v10 offset:40960
    v_cvt_pk_bf16_f32 v88, v72, v73
    v_cvt_pk_bf16_f32 v89, v74, v75
    v_mfma_f32_32x32x16_bf16 v[52:67], v[40:43], a[148:151], v[52:67]
    ds_read_b128 v[32:35], v11 offset:40960
    v_cvt_pk_bf16_f32 v90, v80, v81
    v_cvt_pk_bf16_f32 v91, v82, v83
    s_waitcnt lgkmcnt(4)
    v_mfma_f32_32x32x16_bf16 v[52:67], v[44:47], a[152:155], v[52:67]
    ds_read_b128 v[36:39], v8 offset:45056
    s_add_u32 s51, s42, s47
    s_sub_u32 s51, s51, 1
    s_bfe_u32 s52, s51, 0x40002
    s_lshl_b32 s52, s52, 14
    v_mfma_f32_32x32x16_bf16 v[52:67], v[48:51], a[156:159], v[52:67]
    ds_read_b128 v[40:43], v9 offset:45056
    s_and_b32 s51, s51, 3
    s_lshl_b32 s51, s51, 11
    s_add_u32 s51, s51, s52
    s_add_u32 s51, s51, s48
    buffer_store_dwordx4 v[84:87], v7, s[84:87], s51 offen sc1
    s_waitcnt lgkmcnt(4)
    v_mfma_f32_32x32x16_bf16 v[52:67], v[20:23], a[160:163], v[52:67]
    ds_read_b128 v[44:47], v10 offset:45056
    buffer_store_dwordx4 v[88:91], v7, s[84:87], s51 offen offset:512 sc1
    v_mfma_f32_32x32x16_bf16 v[52:67], v[24:27], a[164:167], v[52:67]
    ds_read_b128 v[48:51], v11 offset:45056
    s_add_u32 s53, s42, 3
    s_min_u32 s53, s53, 63
    s_lshl_b32 s53, s53, 16
    s_mov_b64 exec, 0xffff
    buffer_load_dword v18, v19, s[8:11], s53 offen
    s_mov_b64 exec, -1
    s_waitcnt lgkmcnt(4)
    v_mfma_f32_32x32x16_bf16 v[52:67], v[28:31], a[168:171], v[52:67]
    ds_read_b128 v[20:23], v8 offset:49152
    v_mfma_f32_32x32x16_bf16 v[52:67], v[32:35], a[172:175], v[52:67]
    ds_read_b128 v[24:27], v9 offset:49152
    s_waitcnt lgkmcnt(4)
    v_mfma_f32_32x32x16_bf16 v[52:67], v[36:39], a[176:179], v[52:67]
    ds_read_b128 v[28:31], v10 offset:49152
    v_mfma_f32_32x32x16_bf16 v[52:67], v[40:43], a[180:183], v[52:67]
    ds_read_b128 v[32:35], v11 offset:49152
    s_waitcnt lgkmcnt(4)
    v_mfma_f32_32x32x16_bf16 v[52:67], v[44:47], a[184:187], v[52:67]
    ds_read_b128 v[36:39], v8 offset:53248
    v_mfma_f32_32x32x16_bf16 v[52:67], v[48:51], a[188:191], v[52:67]
    ds_read_b128 v[40:43], v9 offset:53248
    s_waitcnt lgkmcnt(4)
    v_mfma_f32_32x32x16_bf16 v[52:67], v[20:23], a[192:195], v[52:67]
    ds_read_b128 v[44:47], v10 offset:53248
    v_mfma_f32_32x32x16_bf16 v[52:67], v[24:27], a[196:199], v[52:67]
    ds_read_b128 v[48:51], v11 offset:53248
    s_waitcnt lgkmcnt(4)
    v_mfma_f32_32x32x16_bf16 v[52:67], v[28:31], a[200:203], v[52:67]
    ds_read_b128 v[20:23], v8 offset:57344
    v_mfma_f32_32x32x16_bf16 v[52:67], v[32:35], a[204:207], v[52:67]
    ds_read_b128 v[24:27], v9 offset:57344
    s_waitcnt lgkmcnt(4)
    v_mfma_f32_32x32x16_bf16 v[52:67], v[36:39], a[208:211], v[52:67]
    ds_read_b128 v[28:31], v10 offset:57344
    v_mfma_f32_32x32x16_bf16 v[52:67], v[40:43], a[212:215], v[52:67]
    ds_read_b128 v[32:35], v11 offset:57344
    s_waitcnt lgkmcnt(4)
    v_mfma_f32_32x32x16_bf16 v[52:67], v[44:47], a[216:219], v[52:67]
    ds_read_b128 v[36:39], v8 offset:61440
    v_mfma_f32_32x32x16_bf16 v[52:67], v[48:51], a[220:223], v[52:67]
    ds_read_b128 v[40:43], v9 offset:61440
    s_waitcnt lgkmcnt(4)
    v_mfma_f32_32x32x16_bf16 v[52:67], v[20:23], a[224:227], v[52:67]
    ds_read_b128 v[44:47], v10 offset:61440
    v_mfma_f32_32x32x16_bf16 v[52:67], v[24:27], a[228:231], v[52:67]
    ds_read_b128 v[48:51], v11 offset:61440
    s_waitcnt lgkmcnt(5)
    v_mfma_f32_32x32x16_bf16 v[52:67], v[28:31], a[232:235], v[52:67]
    s_waitcnt lgkmcnt(4)
    v_mfma_f32_32x32x16_bf16 v[52:67], v[32:35], a[236:239], v[52:67]
    s_waitcnt lgkmcnt(3)
    v_mfma_f32_32x32x16_bf16 v[52:67], v[36:39], a[240:243], v[52:67]
    s_waitcnt lgkmcnt(2)
    v_mfma_f32_32x32x16_bf16 v[52:67], v[40:43], a[244:247], v[52:67]
    s_waitcnt lgkmcnt(1)
    v_mfma_f32_32x32x16_bf16 v[52:67], v[44:47], a[248:251], v[52:67]
    s_waitcnt lgkmcnt(0)
    v_mfma_f32_32x32x16_bf16 v[52:67], v[48:51], a[252:255], v[52:67]
    s_add_u32 s42, s42, 1
    s_cmp_le_u32 s42, 4
    s_cbranch_scc0 mega_kernel_v_ne00
    s_nop 9
    v_cvt_pk_bf16_f32 v84, v52, v53
    v_cvt_pk_bf16_f32 v85, v54, v55
    v_cvt_pk_bf16_f32 v86, v60, v61
    v_cvt_pk_bf16_f32 v87, v62, v63
    v_cvt_pk_bf16_f32 v88, v56, v57
    v_cvt_pk_bf16_f32 v89, v58, v59
    v_cvt_pk_bf16_f32 v90, v64, v65
    v_cvt_pk_bf16_f32 v91, v66, v67
    s_add_u32 s51, s42, s47
    s_sub_u32 s51, s51, 1
    s_bfe_u32 s52, s51, 0x40002
    s_lshl_b32 s52, s52, 14
    s_and_b32 s51, s51, 3
    s_lshl_b32 s51, s51, 11
    s_add_u32 s51, s51, s52
    s_add_u32 s51, s51, s48
    buffer_store_dwordx4 v[84:87], v7, s[84:87], s51 offen sc1
    buffer_store_dwordx4 v[88:91], v7, s[84:87], s51 offen offset:512 sc1
    s_waitcnt vmcnt(0)
    v_mov_b32 v17, s42
    s_mov_b64 exec, 1
    buffer_store_dword v17, v16, s[84:87], s49 offen sc1
    s_mov_b64 exec, -1
mega_kernel_v_ne00:
    s_branch mega_kernel_v_loop
mega_kernel_v_fin:
    s_nop 11
    v_cvt_pk_bf16_f32 v84, v68, v69
    v_cvt_pk_bf16_f32 v85, v70, v71
    v_cvt_pk_bf16_f32 v86, v76, v77
    v_cvt_pk_bf16_f32 v87, v78, v79
    v_cvt_pk_bf16_f32 v88, v72, v73
    v_cvt_pk_bf16_f32 v89, v74, v75
    v_cvt_pk_bf16_f32 v90, v80, v81
    v_cvt_pk_bf16_f32 v91, v82, v83
    s_add_u32 s51, s42, s47
    s_sub_u32 s51, s51, 1
    s_bfe_u32 s52, s51, 0x40002
    s_lshl_b32 s52, s52, 14
    s_and_b32 s51, s51, 3
    s_lshl_b32 s51, s51, 11
    s_add_u32 s51, s51, s52
    s_add_u32 s51, s51, s48
    buffer_store_dwordx4 v[84:87], v7, s[84:87], s51 offen sc1
    buffer_store_dwordx4 v[88:91], v7, s[84:87], s51 offen offset:512 sc1
    s_waitcnt vmcnt(0)
    v_mov_b32 v17, s42
    s_mov_b64 exec, 1
    buffer_store_dword v17, v16, s[84:87], s49 offen sc1
    s_mov_b64 exec, -1
    s_waitcnt vmcnt(0)
    s_barrier
mega_kernel_fft:
    s_mov_b32 s93, s92
mega_kernel_f0l:
    s_barrier
    s_load_dwordx2 s[4:5], s[0:1], 64
    s_load_dwordx2 s[8:9], s[0:1], 72
    s_load_dwordx2 s[12:13], s[0:1], 96
    s_and_b32 s16, s93, 31
    s_lshr_b32 s17, s93, 5
    v_and_b32 v1, 63, v0
    v_lshrrev_b32 v2, 6, v0
    s_waitcnt lgkmcnt(0)
    s_mov_b32 s6, 2101248
    s_mov_b32 s7, 0x00020000
    s_mov_b32 s10, 2101248
    s_mov_b32 s11, 0x00020000
    s_add_u32 s12, s12, 121634816
    s_addc_u32 s13, s13, 0
    s_mov_b32 s14, 4202496
    s_mov_b32 s15, 0x00020000
    s_lshl_b32 s18, s16, 6
    v_add_u32 v3, s18, v2
    s_movk_i32 s19, 1026
    v_mul_lo_u32 v3, v3, s19
    s_lshl_b32 s18, s17, 7
    v_add_u32 v3, s18, v3
    v_lshl_add_u32 v3, v1, 1, v3
    s_mov_b32 s18, 0
    buffer_load_ushort v16, v3, s[4:7], s18 offen
    buffer_load_ushort v32, v3, s[8:11], s18 offen
    s_mov_b32 s18, 4104
    buffer_load_ushort v17, v3, s[4:7], s18 offen
    buffer_load_ushort v33, v3, s[8:11], s18 offen
    s_mov_b32 s18, 8208
    buffer_load_ushort v18, v3, s[4:7], s18 offen
    buffer_load_ushort v34, v3, s[8:11], s18 offen
    s_mov_b32 s18, 12312
    buffer_load_ushort v19, v3, s[4:7], s18 offen
    buffer_load_ushort v35, v3, s[8:11], s18 offen
    s_mov_b32 s18, 16416
    buffer_load_ushort v20, v3, s[4:7], s18 offen
    buffer_load_ushort v36, v3, s[8:11], s18 offen
    s_mov_b32 s18, 20520
    buffer_load_ushort v21, v3, s[4:7], s18 offen
    buffer_load_ushort v37, v3, s[8:11], s18 offen
    s_mov_b32 s18, 24624
    buffer_load_ushort v22, v3, s[4:7], s18 offen
    buffer_load_ushort v38, v3, s[8:11], s18 offen
    s_mov_b32 s18, 28728
    buffer_load_ushort v23, v3, s[4:7], s18 offen
    buffer_load_ushort v39, v3, s[8:11], s18 offen
    s_mov_b32 s18, 32832
    buffer_load_ushort v24, v3, s[4:7], s18 offen
    buffer_load_ushort v40, v3, s[8:11], s18 offen
    s_mov_b32 s18, 36936
    buffer_load_ushort v25, v3, s[4:7], s18 offen
    buffer_load_ushort v41, v3, s[8:11], s18 offen
    s_mov_b32 s18, 41040
    buffer_load_ushort v26, v3, s[4:7], s18 offen
    buffer_load_ushort v42, v3, s[8:11], s18 offen
    s_mov_b32 s18, 45144
    buffer_load_ushort v27, v3, s[4:7], s18 offen
    buffer_load_ushort v43, v3, s[8:11], s18 offen
    s_mov_b32 s18, 49248
    buffer_load_ushort v28, v3, s[4:7], s18 offen
    buffer_load_ushort v44, v3, s[8:11], s18 offen
    s_mov_b32 s18, 53352
    buffer_load_ushort v29, v3, s[4:7], s18 offen
    buffer_load_ushort v45, v3, s[8:11], s18 offen
    s_mov_b32 s18, 57456
    buffer_load_ushort v30, v3, s[4:7], s18 offen
    buffer_load_ushort v46, v3, s[8:11], s18 offen
    s_mov_b32 s18, 61560
    buffer_load_ushort v31, v3, s[4:7], s18 offen
    buffer_load_ushort v47, v3, s[8:11], s18 offen
    v_mul_u32_u24 v4, 65, v1
    v_add_u32 v4, v4, v2
    v_lshlrev_b32 v4, 2, v4
    s_waitcnt vmcnt(0)
    v_lshl_or_b32 v16, v32, 16, v16
    ds_write_b32 v4, v16 offset:0
    v_lshl_or_b32 v17, v33, 16, v17
    ds_write_b32 v4, v17 offset:16
    v_lshl_or_b32 v18, v34, 16, v18
    ds_write_b32 v4, v18 offset:32
    v_lshl_or_b32 v19, v35, 16, v19
    ds_write_b32 v4, v19 offset:48
    v_lshl_or_b32 v20, v36, 16, v20
    ds_write_b32 v4, v20 offset:64
    v_lshl_or_b32 v21, v37, 16, v21
    ds_write_b32 v4, v21 offset:80
    v_lshl_or_b32 v22, v38, 16, v22
    ds_write_b32 v4, v22 offset:96
    v_lshl_or_b32 v23, v39, 16, v23
    ds_write_b32 v4, v23 offset:112
    v_lshl_or_b32 v24, v40, 16, v24
    ds_write_b32 v4, v24 offset:128
    v_lshl_or_b32 v25, v41, 16, v25
    ds_write_b32 v4, v25 offset:144
    v_lshl_or_b32 v26, v42, 16, v26
    ds_write_b32 v4, v26 offset:160
    v_lshl_or_b32 v27, v43, 16, v27
    ds_write_b32 v4, v27 offset:176
    v_lshl_or_b32 v28, v44, 16, v28
    ds_write_b32 v4, v28 offset:192
    v_lshl_or_b32 v29, v45, 16, v29
    ds_write_b32 v4, v29 offset:208
    v_lshl_or_b32 v30, v46, 16, v30
    ds_write_b32 v4, v30 offset:224
    v_lshl_or_b32 v31, v47, 16, v31
    ds_write_b32 v4, v31 offset:240
    v_lshrrev_b32 v7, 4, v0
    v_and_b32 v8, 15, v0
    v_mul_u32_u24 v5, 65, v7
    v_lshl_add_u32 v5, v8, 2, v5
    v_lshlrev_b32 v5, 2, v5
    s_waitcnt lgkmcnt(0)
    s_barrier
    ds_read_b32 v16, v5 offset:0
    ds_read_b32 v17, v5 offset:4
    ds_read_b32 v18, v5 offset:8
    ds_read_b32 v19, v5 offset:12
    ds_read_b32 v20, v5 offset:4160
    ds_read_b32 v21, v5 offset:4164
    ds_read_b32 v22, v5 offset:4168
    ds_read_b32 v23, v5 offset:4172
    ds_read_b32 v24, v5 offset:8320
    ds_read_b32 v25, v5 offset:8324
    ds_read_b32 v26, v5 offset:8328
    ds_read_b32 v27, v5 offset:8332
    ds_read_b32 v28, v5 offset:12480
    ds_read_b32 v29, v5 offset:12484
    ds_read_b32 v30, v5 offset:12488
    ds_read_b32 v31, v5 offset:12492
    s_lshl_b32 s18, s17, 6
    v_add_u32 v6, s18, v7
    v_lshlrev_b32 v6, 13, v6
    s_lshl_b32 s18, s16, 8
    v_add_u32 v6, s18, v6
    v_lshl_add_u32 v6, v8, 4, v6
    s_waitcnt lgkmcnt(0)
    s_mov_b32 s18, 0
    buffer_store_dwordx4 v[16:19], v6, s[12:15], s18 offen sc1
    s_mov_b32 s18, 131072
    buffer_store_dwordx4 v[20:23], v6, s[12:15], s18 offen sc1
    s_mov_b32 s18, 262144
    buffer_store_dwordx4 v[24:27], v6, s[12:15], s18 offen sc1
    s_mov_b32 s18, 393216
    buffer_store_dwordx4 v[28:31], v6, s[12:15], s18 offen sc1
    s_add_u32 s93, s93, 64
    s_cmp_lt_u32 s93, 288
    s_cbranch_scc1 mega_kernel_f0l
    s_mov_b32 s93, s92
mega_kernel_f1l:
    s_barrier
    s_load_dwordx2 s[4:5], s[0:1], 56
    s_load_dwordx2 s[8:9], s[0:1], 96
    v_and_b32 v1, 31, v0
    v_lshrrev_b32 v2, 5, v0
    v_cvt_f32_u32 v3, v1
    s_waitcnt lgkmcnt(0)
    s_mov_b32 s6, 4194304
    s_mov_b32 s7, 0x00020000
    s_mov_b32 s10, 268435456
    s_mov_b32 s11, 0x00020000
    s_lshl_b32 s12, s93, 15
    v_lshlrev_b32 v6, 12, v2
    v_lshl_add_u32 v6, v1, 1, v6
    buffer_load_ushort v16, v6, s[4:7], s12 offen offset:0
    buffer_load_ushort v48, v6, s[4:7], s12 offen offset:2048
    buffer_load_ushort v17, v6, s[4:7], s12 offen offset:64
    buffer_load_ushort v49, v6, s[4:7], s12 offen offset:2112
    buffer_load_ushort v18, v6, s[4:7], s12 offen offset:128
    buffer_load_ushort v50, v6, s[4:7], s12 offen offset:2176
    buffer_load_ushort v19, v6, s[4:7], s12 offen offset:192
    buffer_load_ushort v51, v6, s[4:7], s12 offen offset:2240
    buffer_load_ushort v20, v6, s[4:7], s12 offen offset:256
    buffer_load_ushort v52, v6, s[4:7], s12 offen offset:2304
    buffer_load_ushort v21, v6, s[4:7], s12 offen offset:320
    buffer_load_ushort v53, v6, s[4:7], s12 offen offset:2368
    buffer_load_ushort v22, v6, s[4:7], s12 offen offset:384
    buffer_load_ushort v54, v6, s[4:7], s12 offen offset:2432
    buffer_load_ushort v23, v6, s[4:7], s12 offen offset:448
    buffer_load_ushort v55, v6, s[4:7], s12 offen offset:2496
    buffer_load_ushort v24, v6, s[4:7], s12 offen offset:512
    buffer_load_ushort v56, v6, s[4:7], s12 offen offset:2560
    buffer_load_ushort v25, v6, s[4:7], s12 offen offset:576
    buffer_load_ushort v57, v6, s[4:7], s12 offen offset:2624
    buffer_load_ushort v26, v6, s[4:7], s12 offen offset:640
    buffer_load_ushort v58, v6, s[4:7], s12 offen offset:2688
    buffer_load_ushort v27, v6, s[4:7], s12 offen offset:704
    buffer_load_ushort v59, v6, s[4:7], s12 offen offset:2752
    buffer_load_ushort v28, v6, s[4:7], s12 offen offset:768
    buffer_load_ushort v60, v6, s[4:7], s12 offen offset:2816
    buffer_load_ushort v29, v6, s[4:7], s12 offen offset:832
    buffer_load_ushort v61, v6, s[4:7], s12 offen offset:2880
    buffer_load_ushort v30, v6, s[4:7], s12 offen offset:896
    buffer_load_ushort v62, v6, s[4:7], s12 offen offset:2944
    buffer_load_ushort v31, v6, s[4:7], s12 offen offset:960
    buffer_load_ushort v63, v6, s[4:7], s12 offen offset:3008
    buffer_load_ushort v32, v6, s[4:7], s12 offen offset:1024
    buffer_load_ushort v64, v6, s[4:7], s12 offen offset:3072
    buffer_load_ushort v33, v6, s[4:7], s12 offen offset:1088
    buffer_load_ushort v65, v6, s[4:7], s12 offen offset:3136
    buffer_load_ushort v34, v6, s[4:7], s12 offen offset:1152
    buffer_load_ushort v66, v6, s[4:7], s12 offen offset:3200
    buffer_load_ushort v35, v6, s[4:7], s12 offen offset:1216
    buffer_load_ushort v67, v6, s[4:7], s12 offen offset:3264
    buffer_load_ushort v36, v6, s[4:7], s12 offen offset:1280
    buffer_load_ushort v68, v6, s[4:7], s12 offen offset:3328
    buffer_load_ushort v37, v6, s[4:7], s12 offen offset:1344
    buffer_load_ushort v69, v6, s[4:7], s12 offen offset:3392
    buffer_load_ushort v38, v6, s[4:7], s12 offen offset:1408
    buffer_load_ushort v70, v6, s[4:7], s12 offen offset:3456
    buffer_load_ushort v39, v6, s[4:7], s12 offen offset:1472
    buffer_load_ushort v71, v6, s[4:7], s12 offen offset:3520
    buffer_load_ushort v40, v6, s[4:7], s12 offen offset:1536
    buffer_load_ushort v72, v6, s[4:7], s12 offen offset:3584
    buffer_load_ushort v41, v6, s[4:7], s12 offen offset:1600
    buffer_load_ushort v73, v6, s[4:7], s12 offen offset:3648
    buffer_load_ushort v42, v6, s[4:7], s12 offen offset:1664
    buffer_load_ushort v74, v6, s[4:7], s12 offen offset:3712
    buffer_load_ushort v43, v6, s[4:7], s12 offen offset:1728
    buffer_load_ushort v75, v6, s[4:7], s12 offen offset:3776
    buffer_load_ushort v44, v6, s[4:7], s12 offen offset:1792
    buffer_load_ushort v76, v6, s[4:7], s12 offen offset:3840
    buffer_load_ushort v45, v6, s[4:7], s12 offen offset:1856
    buffer_load_ushort v77, v6, s[4:7], s12 offen offset:3904
    buffer_load_ushort v46, v6, s[4:7], s12 offen offset:1920
    buffer_load_ushort v78, v6, s[4:7], s12 offen offset:3968
    buffer_load_ushort v47, v6, s[4:7], s12 offen offset:1984
    buffer_load_ushort v79, v6, s[4:7], s12 offen offset:4032
    s_movk_i32 s13, 8448
    v_mul_lo_u32 v7, v2, s13
    v_lshl_add_u32 v4, v1, 3, v7
    s_movk_i32 s13, 264
    v_mul_lo_u32 v5, v1, s13
    v_add_u32 v5, v5, v7
    s_waitcnt vmcnt(0)
    v_lshlrev_b32 v16, 16, v16
    v_lshlrev_b32 v48, 16, v48
    v_lshlrev_b32 v17, 16, v17
    v_lshlrev_b32 v49, 16, v49
    v_lshlrev_b32 v18, 16, v18
    v_lshlrev_b32 v50, 16, v50
    v_lshlrev_b32 v19, 16, v19
    v_lshlrev_b32 v51, 16, v51
    v_lshlrev_b32 v20, 16, v20
    v_lshlrev_b32 v52, 16, v52
    v_lshlrev_b32 v21, 16, v21
    v_lshlrev_b32 v53, 16, v53
    v_lshlrev_b32 v22, 16, v22
    v_lshlrev_b32 v54, 16, v54
    v_lshlrev_b32 v23, 16, v23
    v_lshlrev_b32 v55, 16, v55
    v_lshlrev_b32 v24, 16, v24
    v_lshlrev_b32 v56, 16, v56
    v_lshlrev_b32 v25, 16, v25
    v_lshlrev_b32 v57, 16, v57
    v_lshlrev_b32 v26, 16, v26
    v_lshlrev_b32 v58, 16, v58
    v_lshlrev_b32 v27, 16, v27
    v_lshlrev_b32 v59, 16, v59
    v_lshlrev_b32 v28, 16, v28
    v_lshlrev_b32 v60, 16, v60
    v_lshlrev_b32 v29, 16, v29
    v_lshlrev_b32 v61, 16, v61
    v_lshlrev_b32 v30, 16, v30
    v_lshlrev_b32 v62, 16, v62
    v_lshlrev_b32 v31, 16, v31
    v_lshlrev_b32 v63, 16, v63
    v_lshlrev_b32 v32, 16, v32
    v_lshlrev_b32 v64, 16, v64
    v_lshlrev_b32 v33, 16, v33
    v_lshlrev_b32 v65, 16, v65
    v_lshlrev_b32 v34, 16, v34
    v_lshlrev_b32 v66, 16, v66
    v_lshlrev_b32 v35, 16, v35
    v_lshlrev_b32 v67, 16, v67
    v_lshlrev_b32 v36, 16, v36
    v_lshlrev_b32 v68, 16, v68
    v_lshlrev_b32 v37, 16, v37
    v_lshlrev_b32 v69, 16, v69
    v_lshlrev_b32 v38, 16, v38
    v_lshlrev_b32 v70, 16, v70
    v_lshlrev_b32 v39, 16, v39
    v_lshlrev_b32 v71, 16, v71
    v_lshlrev_b32 v40, 16, v40
    v_lshlrev_b32 v72, 16, v72
    v_lshlrev_b32 v41, 16, v41
    v_lshlrev_b32 v73, 16, v73
    v_lshlrev_b32 v42, 16, v42
    v_lshlrev_b32 v74, 16, v74
    v_lshlrev_b32 v43, 16, v43
    v_lshlrev_b32 v75, 16, v75
    v_lshlrev_b32 v44, 16, v44
    v_lshlrev_b32 v76, 16, v76
    v_lshlrev_b32 v45, 16, v45
    v_lshlrev_b32 v77, 16, v77
    v_lshlrev_b32 v46, 16, v46
    v_lshlrev_b32 v78, 16, v78
    v_lshlrev_b32 v47, 16, v47
    v_lshlrev_b32 v79, 16, v79
    v_sub_f32 v80, v16, v32
    v_sub_f32 v81, v48, v64
    v_add_f32 v16, v16, v32
    v_add_f32 v48, v48, v64
    v_sub_f32 v32, v17, v33
    v_sub_f32 v64, v49, v65
    v_add_f32 v17, v17, v33
    v_add_f32 v49, v49, v65
    v_mul_f32 v33, 0x3f7b14be, v32
    v_mul_f32 v65, 0xbe47c5c2, v32
    v_fmac_f32 v33, 0x3e47c5c2, v64
    v_fmac_f32 v65, 0x3f7b14be, v64
    v_sub_f32 v32, v18, v34
    v_sub_f32 v64, v50, v66
    v_add_f32 v18, v18, v34
    v_add_f32 v50, v50, v66
    v_mul_f32 v34, 0x3f6c835e, v32
    v_mul_f32 v66, 0xbec3ef15, v32
    v_fmac_f32 v34, 0x3ec3ef15, v64
    v_fmac_f32 v66, 0x3f6c835e, v64
    v_sub_f32 v32, v19, v35
    v_sub_f32 v64, v51, v67
    v_add_f32 v19, v19, v35
    v_add_f32 v51, v51, v67
    v_mul_f32 v35, 0x3f54db31, v32
    v_mul_f32 v67, 0xbf0e39da, v32
    v_fmac_f32 v35, 0x3f0e39da, v64
    v_fmac_f32 v67, 0x3f54db31, v64
    v_sub_f32 v32, v20, v36
    v_sub_f32 v64, v52, v68
    v_add_f32 v20, v20, v36
    v_add_f32 v52, v52, v68
    v_mul_f32 v36, 0x3f3504f3, v32
    v_mul_f32 v68, 0xbf3504f3, v32
    v_fmac_f32 v36, 0x3f3504f3, v64
    v_fmac_f32 v68, 0x3f3504f3, v64
    v_sub_f32 v32, v21, v37
    v_sub_f32 v64, v53, v69
    v_add_f32 v21, v21, v37
    v_add_f32 v53, v53, v69
    v_mul_f32 v37, 0x3f0e39da, v32
    v_mul_f32 v69, 0xbf54db31, v32
    v_fmac_f32 v37, 0x3f54db31, v64
    v_fmac_f32 v69, 0x3f0e39da, v64
    v_sub_f32 v32, v22, v38
    v_sub_f32 v64, v54, v70
    v_add_f32 v22, v22, v38
    v_add_f32 v54, v54, v70
    v_mul_f32 v38, 0x3ec3ef15, v32
    v_mul_f32 v70, 0xbf6c835e, v32
    v_fmac_f32 v38, 0x3f6c835e, v64
    v_fmac_f32 v70, 0x3ec3ef15, v64
    v_sub_f32 v32, v23, v39
    v_sub_f32 v64, v55, v71
    v_add_f32 v23, v23, v39
    v_add_f32 v55, v55, v71
    v_mul_f32 v39, 0x3e47c5c2, v32
    v_mul_f32 v71, 0xbf7b14be, v32
    v_fmac_f32 v39, 0x3f7b14be, v64
    v_fmac_f32 v71, 0x3e47c5c2, v64
    v_sub_f32 v32, v56, v72
    v_sub_f32 v64, v40, v24
    v_add_f32 v24, v24, v40
    v_add_f32 v56, v56, v72
    v_sub_f32 v40, v25, v41
    v_sub_f32 v72, v57, v73
    v_add_f32 v25, v25, v41
    v_add_f32 v57, v57, v73
    v_mul_f32 v41, 0xbe47c5c2, v40
    v_mul_f32 v73, 0xbf7b14be, v40
    v_fmac_f32 v41, 0x3f7b14be, v72
    v_fmac_f32 v73, 0xbe47c5c2, v72
    v_sub_f32 v40, v26, v42
    v_sub_f32 v72, v58, v74
    v_add_f32 v26, v26, v42
    v_add_f32 v58, v58, v74
    v_mul_f32 v42, 0xbec3ef15, v40
    v_mul_f32 v74, 0xbf6c835e, v40
    v_fmac_f32 v42, 0x3f6c835e, v72
    v_fmac_f32 v74, 0xbec3ef15, v72
    v_sub_f32 v40, v27, v43
    v_sub_f32 v72, v59, v75
    v_add_f32 v27, v27, v43
    v_add_f32 v59, v59, v75
    v_mul_f32 v43, 0xbf0e39da, v40
    v_mul_f32 v75, 0xbf54db31, v40
    v_fmac_f32 v43, 0x3f54db31, v72
    v_fmac_f32 v75, 0xbf0e39da, v72
    v_sub_f32 v40, v28, v44
    v_sub_f32 v72, v60, v76
    v_add_f32 v28, v28, v44
    v_add_f32 v60, v60, v76
    v_mul_f32 v44, 0xbf3504f3, v40
    v_mul_f32 v76, 0xbf3504f3, v40
    v_fmac_f32 v44, 0x3f3504f3, v72
    v_fmac_f32 v76, 0xbf3504f3, v72
    v_sub_f32 v40, v29, v45
    v_sub_f32 v72, v61, v77
    v_add_f32 v29, v29, v45
    v_add_f32 v61, v61, v77
    v_mul_f32 v45, 0xbf54db31, v40
    v_mul_f32 v77, 0xbf0e39da, v40
    v_fmac_f32 v45, 0x3f0e39da, v72
    v_fmac_f32 v77, 0xbf54db31, v72
    v_sub_f32 v40, v30, v46
    v_sub_f32 v72, v62, v78
    v_add_f32 v30, v30, v46
    v_add_f32 v62, v62, v78
    v_mul_f32 v46, 0xbf6c835e, v40
    v_mul_f32 v78, 0xbec3ef15, v40
    v_fmac_f32 v46, 0x3ec3ef15, v72
    v_fmac_f32 v78, 0xbf6c835e, v72
    v_sub_f32 v40, v31, v47
    v_sub_f32 v72, v63, v79
    v_add_f32 v31, v31, v47
    v_add_f32 v63, v63, v79
    v_mul_f32 v47, 0xbf7b14be, v40
    v_mul_f32 v79, 0xbe47c5c2, v40
    v_fmac_f32 v47, 0x3e47c5c2, v72
    v_fmac_f32 v79, 0xbf7b14be, v72
    v_sub_f32 v40, v16, v24
    v_sub_f32 v72, v48, v56
    v_add_f32 v16, v16, v24
    v_add_f32 v48, v48, v56
    v_sub_f32 v24, v17, v25
    v_sub_f32 v56, v49, v57
    v_add_f32 v17, v17, v25
    v_add_f32 v49, v49, v57
    v_mul_f32 v25, 0x3f6c835e, v24
    v_mul_f32 v57, 0xbec3ef15, v24
    v_fmac_f32 v25, 0x3ec3ef15, v56
    v_fmac_f32 v57, 0x3f6c835e, v56
    v_sub_f32 v24, v18, v26
    v_sub_f32 v56, v50, v58
    v_add_f32 v18, v18, v26
    v_add_f32 v50, v50, v58
    v_mul_f32 v26, 0x3f3504f3, v24
    v_mul_f32 v58, 0xbf3504f3, v24
    v_fmac_f32 v26, 0x3f3504f3, v56
    v_fmac_f32 v58, 0x3f3504f3, v56
    v_sub_f32 v24, v19, v27
    v_sub_f32 v56, v51, v59
    v_add_f32 v19, v19, v27
    v_add_f32 v51, v51, v59
    v_mul_f32 v27, 0x3ec3ef15, v24
    v_mul_f32 v59, 0xbf6c835e, v24
    v_fmac_f32 v27, 0x3f6c835e, v56
    v_fmac_f32 v59, 0x3ec3ef15, v56
    v_sub_f32 v24, v52, v60
    v_sub_f32 v56, v28, v20
    v_add_f32 v20, v20, v28
    v_add_f32 v52, v52, v60
    v_sub_f32 v28, v21, v29
    v_sub_f32 v60, v53, v61
    v_add_f32 v21, v21, v29
    v_add_f32 v53, v53, v61
    v_mul_f32 v29, 0xbec3ef15, v28
    v_mul_f32 v61, 0xbf6c835e, v28
    v_fmac_f32 v29, 0x3f6c835e, v60
    v_fmac_f32 v61, 0xbec3ef15, v60
    v_sub_f32 v28, v22, v30
    v_sub_f32 v60, v54, v62
    v_add_f32 v22, v22, v30
    v_add_f32 v54, v54, v62
    v_mul_f32 v30, 0xbf3504f3, v28
    v_mul_f32 v62, 0xbf3504f3, v28
    v_fmac_f32 v30, 0x3f3504f3, v60
    v_fmac_f32 v62, 0xbf3504f3, v60
    v_sub_f32 v28, v23, v31
    v_sub_f32 v60, v55, v63
    v_add_f32 v23, v23, v31
    v_add_f32 v55, v55, v63
    v_mul_f32 v31, 0xbf6c835e, v28
    v_mul_f32 v63, 0xbec3ef15, v28
    v_fmac_f32 v31, 0x3ec3ef15, v60
    v_fmac_f32 v63, 0xbf6c835e, v60
    v_sub_f32 v28, v80, v32
    v_sub_f32 v60, v81, v64
    v_add_f32 v80, v80, v32
    v_add_f32 v81, v81, v64
    v_sub_f32 v32, v33, v41
    v_sub_f32 v64, v65, v73
    v_add_f32 v33, v33, v41
    v_add_f32 v65, v65, v73
    v_mul_f32 v41, 0x3f6c835e, v32
    v_mul_f32 v73, 0xbec3ef15, v32
    v_fmac_f32 v41, 0x3ec3ef15, v64
    v_fmac_f32 v73, 0x3f6c835e, v64
    v_sub_f32 v32, v34, v42
    v_sub_f32 v64, v66, v74
    v_add_f32 v34, v34, v42
    v_add_f32 v66, v66, v74
    v_mul_f32 v42, 0x3f3504f3, v32
    v_mul_f32 v74, 0xbf3504f3, v32
    v_fmac_f32 v42, 0x3f3504f3, v64
    v_fmac_f32 v74, 0x3f3504f3, v64
    v_sub_f32 v32, v35, v43
    v_sub_f32 v64, v67, v75
    v_add_f32 v35, v35, v43
    v_add_f32 v67, v67, v75
    v_mul_f32 v43, 0x3ec3ef15, v32
    v_mul_f32 v75, 0xbf6c835e, v32
    v_fmac_f32 v43, 0x3f6c835e, v64
    v_fmac_f32 v75, 0x3ec3ef15, v64
    v_sub_f32 v32, v68, v76
    v_sub_f32 v64, v44, v36
    v_add_f32 v36, v36, v44
    v_add_f32 v68, v68, v76
    v_sub_f32 v44, v37, v45
    v_sub_f32 v76, v69, v77
    v_add_f32 v37, v37, v45
    v_add_f32 v69, v69, v77
    v_mul_f32 v45, 0xbec3ef15, v44
    v_mul_f32 v77, 0xbf6c835e, v44
    v_fmac_f32 v45, 0x3f6c835e, v76
    v_fmac_f32 v77, 0xbec3ef15, v76
    v_sub_f32 v44, v38, v46
    v_sub_f32 v76, v70, v78
    v_add_f32 v38, v38, v46
    v_add_f32 v70, v70, v78
    v_mul_f32 v46, 0xbf3504f3, v44
    v_mul_f32 v78, 0xbf3504f3, v44
    v_fmac_f32 v46, 0x3f3504f3, v76
    v_fmac_f32 v78, 0xbf3504f3, v76
    v_sub_f32 v44, v39, v47
    v_sub_f32 v76, v71, v79
    v_add_f32 v39, v39, v47
    v_add_f32 v71, v71, v79
    v_mul_f32 v47, 0xbf6c835e, v44
    v_mul_f32 v79, 0xbec3ef15, v44
    v_fmac_f32 v47, 0x3ec3ef15, v76
    v_fmac_f32 v79, 0xbf6c835e, v76
    v_sub_f32 v44, v16, v20
    v_sub_f32 v76, v48, v52
    v_add_f32 v16, v16, v20
    v_add_f32 v48, v48, v52
    v_sub_f32 v20, v17, v21
    v_sub_f32 v52, v49, v53
    v_add_f32 v17, v17, v21
    v_add_f32 v49, v49, v53
    v_mul_f32 v21, 0x3f3504f3, v20
    v_mul_f32 v53, 0xbf3504f3, v20
    v_fmac_f32 v21, 0x3f3504f3, v52
    v_fmac_f32 v53, 0x3f3504f3, v52
    v_sub_f32 v20, v50, v54
    v_sub_f32 v52, v22, v18
    v_add_f32 v18, v18, v22
    v_add_f32 v50, v50, v54
    v_sub_f32 v22, v19, v23
    v_sub_f32 v54, v51, v55
    v_add_f32 v19, v19, v23
    v_add_f32 v51, v51, v55
    v_mul_f32 v23, 0xbf3504f3, v22
    v_mul_f32 v55, 0xbf3504f3, v22
    v_fmac_f32 v23, 0x3f3504f3, v54
    v_fmac_f32 v55, 0xbf3504f3, v54
    v_sub_f32 v22, v40, v24
    v_sub_f32 v54, v72, v56
    v_add_f32 v40, v40, v24
    v_add_f32 v72, v72, v56
    v_sub_f32 v24, v25, v29
    v_sub_f32 v56, v57, v61
    v_add_f32 v25, v25, v29
    v_add_f32 v57, v57, v61
    v_mul_f32 v29, 0x3f3504f3, v24
    v_mul_f32 v61, 0xbf3504f3, v24
    v_fmac_f32 v29, 0x3f3504f3, v56
    v_fmac_f32 v61, 0x3f3504f3, v56
    v_sub_f32 v24, v58, v62
    v_sub_f32 v56, v30, v26
    v_add_f32 v26, v26, v30
    v_add_f32 v58, v58, v62
    v_sub_f32 v30, v27, v31
    v_sub_f32 v62, v59, v63
    v_add_f32 v27, v27, v31
    v_add_f32 v59, v59, v63
    v_mul_f32 v31, 0xbf3504f3, v30
    v_mul_f32 v63, 0xbf3504f3, v30
    v_fmac_f32 v31, 0x3f3504f3, v62
    v_fmac_f32 v63, 0xbf3504f3, v62
    v_sub_f32 v30, v80, v36
    v_sub_f32 v62, v81, v68
    v_add_f32 v80, v80, v36
    v_add_f32 v81, v81, v68
    v_sub_f32 v36, v33, v37
    v_sub_f32 v68, v65, v69
    v_add_f32 v33, v33, v37
    v_add_f32 v65, v65, v69
    v_mul_f32 v37, 0x3f3504f3, v36
    v_mul_f32 v69, 0xbf3504f3, v36
    v_fmac_f32 v37, 0x3f3504f3, v68
    v_fmac_f32 v69, 0x3f3504f3, v68
    v_sub_f32 v36, v66, v70
    v_sub_f32 v68, v38, v34
    v_add_f32 v34, v34, v38
    v_add_f32 v66, v66, v70
    v_sub_f32 v38, v35, v39
    v_sub_f32 v70, v67, v71
    v_add_f32 v35, v35, v39
    v_add_f32 v67, v67, v71
    v_mul_f32 v39, 0xbf3504f3, v38
    v_mul_f32 v71, 0xbf3504f3, v38
    v_fmac_f32 v39, 0x3f3504f3, v70
    v_fmac_f32 v71, 0xbf3504f3, v70
    v_sub_f32 v38, v28, v32
    v_sub_f32 v70, v60, v64
    v_add_f32 v28, v28, v32
    v_add_f32 v60, v60, v64
    v_sub_f32 v32, v41, v45
    v_sub_f32 v64, v73, v77
    v_add_f32 v41, v41, v45
    v_add_f32 v73, v73, v77
    v_mul_f32 v45, 0x3f3504f3, v32
    v_mul_f32 v77, 0xbf3504f3, v32
    v_fmac_f32 v45, 0x3f3504f3, v64
    v_fmac_f32 v77, 0x3f3504f3, v64
    v_sub_f32 v32, v74, v78
    v_sub_f32 v64, v46, v42
    v_add_f32 v42, v42, v46
    v_add_f32 v74, v74, v78
    v_sub_f32 v46, v43, v47
    v_sub_f32 v78, v75, v79
    v_add_f32 v43, v43, v47
    v_add_f32 v75, v75, v79
    v_mul_f32 v47, 0xbf3504f3, v46
    v_mul_f32 v79, 0xbf3504f3, v46
    v_fmac_f32 v47, 0x3f3504f3, v78
    v_fmac_f32 v79, 0xbf3504f3, v78
    v_sub_f32 v46, v16, v18
    v_sub_f32 v78, v48, v50
    v_add_f32 v16, v16, v18
    v_add_f32 v48, v48, v50
    v_sub_f32 v18, v49, v51
    v_sub_f32 v50, v19, v17
    v_add_f32 v17, v17, v19
    v_add_f32 v49, v49, v51
    v_sub_f32 v19, v44, v20
    v_sub_f32 v51, v76, v52
    v_add_f32 v44, v44, v20
    v_add_f32 v76, v76, v52
    v_sub_f32 v20, v53, v55
    v_sub_f32 v52, v23, v21
    v_add_f32 v21, v21, v23
    v_add_f32 v53, v53, v55
    v_sub_f32 v23, v40, v26
    v_sub_f32 v55, v72, v58
    v_add_f32 v40, v40, v26
    v_add_f32 v72, v72, v58
    v_sub_f32 v26, v57, v59
    v_sub_f32 v58, v27, v25
    v_add_f32 v25, v25, v27
    v_add_f32 v57, v57, v59
    v_sub_f32 v27, v22, v24
    v_sub_f32 v59, v54, v56
    v_add_f32 v22, v22, v24
    v_add_f32 v54, v54, v56
    v_sub_f32 v24, v61, v63
    v_sub_f32 v56, v31, v29
    v_add_f32 v29, v29, v31
    v_add_f32 v61, v61, v63
    v_sub_f32 v31, v80, v34
    v_sub_f32 v63, v81, v66
    v_add_f32 v80, v80, v34
    v_add_f32 v81, v81, v66
    v_sub_f32 v34, v65, v67
    v_sub_f32 v66, v35, v33
    v_add_f32 v33, v33, v35
    v_add_f32 v65, v65, v67
    v_sub_f32 v35, v30, v36
    v_sub_f32 v67, v62, v68
    v_add_f32 v30, v30, v36
    v_add_f32 v62, v62, v68
    v_sub_f32 v36, v69, v71
    v_sub_f32 v68, v39, v37
    v_add_f32 v37, v37, v39
    v_add_f32 v69, v69, v71
    v_sub_f32 v39, v28, v42
    v_sub_f32 v71, v60, v74
    v_add_f32 v28, v28, v42
    v_add_f32 v60, v60, v74
    v_sub_f32 v42, v73, v75
    v_sub_f32 v74, v43, v41
    v_add_f32 v41, v41, v43
    v_add_f32 v73, v73, v75
    v_sub_f32 v43, v38, v32
    v_sub_f32 v75, v70, v64
    v_add_f32 v38, v38, v32
    v_add_f32 v70, v70, v64
    v_sub_f32 v32, v77, v79
    v_sub_f32 v64, v47, v45
    v_add_f32 v45, v45, v47
    v_add_f32 v77, v77, v79
    v_sub_f32 v47, v16, v17
    v_sub_f32 v79, v48, v49
    v_add_f32 v16, v16, v17
    v_add_f32 v48, v48, v49
    v_sub_f32 v17, v46, v18
    v_sub_f32 v49, v78, v50
    v_add_f32 v46, v46, v18
    v_add_f32 v78, v78, v50
    v_sub_f32 v18, v44, v21
    v_sub_f32 v50, v76, v53
    v_add_f32 v44, v44, v21
    v_add_f32 v76, v76, v53
    v_sub_f32 v21, v19, v20
    v_sub_f32 v53, v51, v52
    v_add_f32 v19, v19, v20
    v_add_f32 v51, v51, v52
    v_sub_f32 v20, v40, v25
    v_sub_f32 v52, v72, v57
    v_add_f32 v40, v40, v25
    v_add_f32 v72, v72, v57
    v_sub_f32 v25, v23, v26
    v_sub_f32 v57, v55, v58
    v_add_f32 v23, v23, v26
    v_add_f32 v55, v55, v58
    v_sub_f32 v26, v22, v29
    v_sub_f32 v58, v54, v61
    v_add_f32 v22, v22, v29
    v_add_f32 v54, v54, v61
    v_sub_f32 v29, v27, v24
    v_sub_f32 v61, v59, v56
    v_add_f32 v27, v27, v24
    v_add_f32 v59, v59, v56
    v_sub_f32 v24, v80, v33
    v_sub_f32 v56, v81, v65
    v_add_f32 v80, v80, v33
    v_add_f32 v81, v81, v65
    v_sub_f32 v33, v31, v34
    v_sub_f32 v65, v63, v66
    v_add_f32 v31, v31, v34
    v_add_f32 v63, v63, v66
    v_sub_f32 v34, v30, v37
    v_sub_f32 v66, v62, v69
    v_add_f32 v30, v30, v37
    v_add_f32 v62, v62, v69
    v_sub_f32 v37, v35, v36
    v_sub_f32 v69, v67, v68
    v_add_f32 v35, v35, v36
    v_add_f32 v67, v67, v68
    v_sub_f32 v36, v28, v41
    v_sub_f32 v68, v60, v73
    v_add_f32 v28, v28, v41
    v_add_f32 v60, v60, v73
    v_sub_f32 v41, v39, v42
    v_sub_f32 v73, v71, v74
    v_add_f32 v39, v39, v42
    v_add_f32 v71, v71, v74
    v_sub_f32 v42, v38, v45
    v_sub_f32 v74, v70, v77
    v_add_f32 v38, v38, v45
    v_add_f32 v70, v70, v77
    v_sub_f32 v45, v43, v32
    v_sub_f32 v77, v75, v64
    v_add_f32 v43, v43, v32
    v_add_f32 v75, v75, v64
    v_mul_f32 v32, 0xba800000, v3
    v_cos_f32 v64, v32
    v_sin_f32 v82, v32
    s_nop 0
    v_mul_f32 v83, v80, v64
    v_fma_f32 v83, -v81, v82, v83
    v_mul_f32 v81, v81, v64
    v_fmac_f32 v81, v80, v82
    v_mul_f32 v32, 0xbb000000, v3
    v_cos_f32 v64, v32
    v_sin_f32 v82, v32
    s_nop 0
    v_mul_f32 v80, v40, v64
    v_fma_f32 v80, -v72, v82, v80
    v_mul_f32 v72, v72, v64
    v_fmac_f32 v72, v40, v82
    v_mul_f32 v32, 0xbb400000, v3
    v_cos_f32 v64, v32
    v_sin_f32 v82, v32
    s_nop 0
    v_mul_f32 v40, v28, v64
    v_fma_f32 v40, -v60, v82, v40
    v_mul_f32 v60, v60, v64
    v_fmac_f32 v60, v28, v82
    v_mul_f32 v32, 0xbb800000, v3
    v_cos_f32 v64, v32
    v_sin_f32 v82, v32
    s_nop 0
    v_mul_f32 v28, v44, v64
    v_fma_f32 v28, -v76, v82, v28
    v_mul_f32 v76, v76, v64
    v_fmac_f32 v76, v44, v82
    v_mul_f32 v32, 0xbba00000, v3
    v_cos_f32 v64, v32
    v_sin_f32 v82, v32
    s_nop 0
    v_mul_f32 v44, v30, v64
    v_fma_f32 v44, -v62, v82, v44
    v_mul_f32 v62, v62, v64
    v_fmac_f32 v62, v30, v82
    v_mul_f32 v32, 0xbbc00000, v3
    v_cos_f32 v64, v32
    v_sin_f32 v82, v32
    s_nop 0
    v_mul_f32 v30, v22, v64
    v_fma_f32 v30, -v54, v82, v30
    v_mul_f32 v54, v54, v64
    v_fmac_f32 v54, v22, v82
    v_mul_f32 v32, 0xbbe00000, v3
    v_cos_f32 v64, v32
    v_sin_f32 v82, v32
    s_nop 0
    v_mul_f32 v22, v38, v64
    v_fma_f32 v22, -v70, v82, v22
    v_mul_f32 v70, v70, v64
    v_fmac_f32 v70, v38, v82
    v_mul_f32 v32, 0xbc000000, v3
    v_cos_f32 v64, v32
    v_sin_f32 v82, v32
    s_nop 0
    v_mul_f32 v38, v46, v64
    v_fma_f32 v38, -v78, v82, v38
    v_mul_f32 v78, v78, v64
    v_fmac_f32 v78, v46, v82
    v_mul_f32 v32, 0xbc100000, v3
    v_cos_f32 v64, v32
    v_sin_f32 v82, v32
    s_nop 0
    v_mul_f32 v46, v31, v64
    v_fma_f32 v46, -v63, v82, v46
    v_mul_f32 v63, v63, v64
    v_fmac_f32 v63, v31, v82
    v_mul_f32 v32, 0xbc200000, v3
    v_cos_f32 v64, v32
    v_sin_f32 v82, v32
    s_nop 0
    v_mul_f32 v31, v23, v64
    v_fma_f32 v31, -v55, v82, v31
    v_mul_f32 v55, v55, v64
    v_fmac_f32 v55, v23, v82
    v_mul_f32 v32, 0xbc300000, v3
    v_cos_f32 v64, v32
    v_sin_f32 v82, v32
    s_nop 0
    v_mul_f32 v23, v39, v64
    v_fma_f32 v23, -v71, v82, v23
    v_mul_f32 v71, v71, v64
    v_fmac_f32 v71, v39, v82
    v_mul_f32 v32, 0xbc400000, v3
    v_cos_f32 v64, v32
    v_sin_f32 v82, v32
    s_nop 0
    v_mul_f32 v39, v19, v64
    v_fma_f32 v39, -v51, v82, v39
    v_mul_f32 v51, v51, v64
    v_fmac_f32 v51, v19, v82
    v_mul_f32 v32, 0xbc500000, v3
    v_cos_f32 v64, v32
    v_sin_f32 v82, v32
    s_nop 0
    v_mul_f32 v19, v35, v64
    v_fma_f32 v19, -v67, v82, v19
    v_mul_f32 v67, v67, v64
    v_fmac_f32 v67, v35, v82
    v_mul_f32 v32, 0xbc600000, v3
    v_cos_f32 v64, v32
    v_sin_f32 v82, v32
    s_nop 0
    v_mul_f32 v35, v27, v64
    v_fma_f32 v35, -v59, v82, v35
    v_mul_f32 v59, v59, v64
    v_fmac_f32 v59, v27, v82
    v_mul_f32 v32, 0xbc700000, v3
    v_cos_f32 v64, v32
    v_sin_f32 v82, v32
    s_nop 0
    v_mul_f32 v27, v43, v64
    v_fma_f32 v27, -v75, v82, v27
    v_mul_f32 v75, v75, v64
    v_fmac_f32 v75, v43, v82
    v_mul_f32 v32, 0xbc800000, v3
    v_cos_f32 v64, v32
    v_sin_f32 v82, v32
    s_nop 0
    v_mul_f32 v43, v47, v64
    v_fma_f32 v43, -v79, v82, v43
    v_mul_f32 v79, v79, v64
    v_fmac_f32 v79, v47, v82
    v_mul_f32 v32, 0xbc880000, v3
    v_cos_f32 v64, v32
    v_sin_f32 v82, v32
    s_nop 0
    v_mul_f32 v47, v24, v64
    v_fma_f32 v47, -v56, v82, v47
    v_mul_f32 v56, v56, v64
    v_fmac_f32 v56, v24, v82
    v_mul_f32 v32, 0xbc900000, v3
    v_cos_f32 v64, v32
    v_sin_f32 v82, v32
    s_nop 0
    v_mul_f32 v24, v20, v64
    v_fma_f32 v24, -v52, v82, v24
    v_mul_f32 v52, v52, v64
    v_fmac_f32 v52, v20, v82
    v_mul_f32 v32, 0xbc980000, v3
    v_cos_f32 v64, v32
    v_sin_f32 v82, v32
    s_nop 0
    v_mul_f32 v20, v36, v64
    v_fma_f32 v20, -v68, v82, v20
    v_mul_f32 v68, v68, v64
    v_fmac_f32 v68, v36, v82
    v_mul_f32 v32, 0xbca00000, v3
    v_cos_f32 v64, v32
    v_sin_f32 v82, v32
    s_nop 0
    v_mul_f32 v36, v18, v64
    v_fma_f32 v36, -v50, v82, v36
    v_mul_f32 v50, v50, v64
    v_fmac_f32 v50, v18, v82
    v_mul_f32 v32, 0xbca80000, v3
    v_cos_f32 v64, v32
    v_sin_f32 v82, v32
    s_nop 0
    v_mul_f32 v18, v34, v64
    v_fma_f32 v18, -v66, v82, v18
    v_mul_f32 v66, v66, v64
    v_fmac_f32 v66, v34, v82
    v_mul_f32 v32, 0xbcb00000, v3
    v_cos_f32 v64, v32
    v_sin_f32 v82, v32
    s_nop 0
    v_mul_f32 v34, v26, v64
    v_fma_f32 v34, -v58, v82, v34
    v_mul_f32 v58, v58, v64
    v_fmac_f32 v58, v26, v82
    v_mul_f32 v32, 0xbcb80000, v3
    v_cos_f32 v64, v32
    v_sin_f32 v82, v32
    s_nop 0
    v_mul_f32 v26, v42, v64
    v_fma_f32 v26, -v74, v82, v26
    v_mul_f32 v74, v74, v64
    v_fmac_f32 v74, v42, v82
    v_mul_f32 v32, 0xbcc00000, v3
    v_cos_f32 v64, v32
    v_sin_f32 v82, v32
    s_nop 0
    v_mul_f32 v42, v17, v64
    v_fma_f32 v42, -v49, v82, v42
    v_mul_f32 v49, v49, v64
    v_fmac_f32 v49, v17, v82
    v_mul_f32 v32, 0xbcc80000, v3
    v_cos_f32 v64, v32
    v_sin_f32 v82, v32
    s_nop 0
    v_mul_f32 v17, v33, v64
    v_fma_f32 v17, -v65, v82, v17
    v_mul_f32 v65, v65, v64
    v_fmac_f32 v65, v33, v82
    v_mul_f32 v32, 0xbcd00000, v3
    v_cos_f32 v64, v32
    v_sin_f32 v82, v32
    s_nop 0
    v_mul_f32 v33, v25, v64
    v_fma_f32 v33, -v57, v82, v33
    v_mul_f32 v57, v57, v64
    v_fmac_f32 v57, v25, v82
    v_mul_f32 v32, 0xbcd80000, v3
    v_cos_f32 v64, v32
    v_sin_f32 v82, v32
    s_nop 0
    v_mul_f32 v25, v41, v64
    v_fma_f32 v25, -v73, v82, v25
    v_mul_f32 v73, v73, v64
    v_fmac_f32 v73, v41, v82
    v_mul_f32 v32, 0xbce00000, v3
    v_cos_f32 v64, v32
    v_sin_f32 v82, v32
    s_nop 0
    v_mul_f32 v41, v21, v64
    v_fma_f32 v41, -v53, v82, v41
    v_mul_f32 v53, v53, v64
    v_fmac_f32 v53, v21, v82
    v_mul_f32 v32, 0xbce80000, v3
    v_cos_f32 v64, v32
    v_sin_f32 v82, v32
    s_nop 0
    v_mul_f32 v21, v37, v64
    v_fma_f32 v21, -v69, v82, v21
    v_mul_f32 v69, v69, v64
    v_fmac_f32 v69, v37, v82
    v_mul_f32 v32, 0xbcf00000, v3
    v_cos_f32 v64, v32
    v_sin_f32 v82, v32
    s_nop 0
    v_mul_f32 v37, v29, v64
    v_fma_f32 v37, -v61, v82, v37
    v_mul_f32 v61, v61, v64
    v_fmac_f32 v61, v29, v82
    v_mul_f32 v32, 0xbcf80000, v3
    v_cos_f32 v64, v32
    v_sin_f32 v82, v32
    s_nop 0
    v_mul_f32 v29, v45, v64
    v_fma_f32 v29, -v77, v82, v29
    v_mul_f32 v77, v77, v64
    v_fmac_f32 v77, v45, v82
    ds_write_b32 v4, v16 offset:0
    ds_write_b32 v4, v48 offset:4
    ds_write_b32 v4, v83 offset:264
    ds_write_b32 v4, v81 offset:268
    ds_write_b32 v4, v80 offset:528
    ds_write_b32 v4, v72 offset:532
    ds_write_b32 v4, v40 offset:792
    ds_write_b32 v4, v60 offset:796
    ds_write_b32 v4, v28 offset:1056
    ds_write_b32 v4, v76 offset:1060
    ds_write_b32 v4, v44 offset:1320
    ds_write_b32 v4, v62 offset:1324
    ds_write_b32 v4, v30 offset:1584
    ds_write_b32 v4, v54 offset:1588
    ds_write_b32 v4, v22 offset:1848
    ds_write_b32 v4, v70 offset:1852
    ds_write_b32 v4, v38 offset:2112
    ds_write_b32 v4, v78 offset:2116
    ds_write_b32 v4, v46 offset:2376
    ds_write_b32 v4, v63 offset:2380
    ds_write_b32 v4, v31 offset:2640
    ds_write_b32 v4, v55 offset:2644
    ds_write_b32 v4, v23 offset:2904
    ds_write_b32 v4, v71 offset:2908
    ds_write_b32 v4, v39 offset:3168
    ds_write_b32 v4, v51 offset:3172
    ds_write_b32 v4, v19 offset:3432
    ds_write_b32 v4, v67 offset:3436
    ds_write_b32 v4, v35 offset:3696
    ds_write_b32 v4, v59 offset:3700
    ds_write_b32 v4, v27 offset:3960
    ds_write_b32 v4, v75 offset:3964
    ds_write_b32 v4, v43 offset:4224
    ds_write_b32 v4, v79 offset:4228
    ds_write_b32 v4, v47 offset:4488
    ds_write_b32 v4, v56 offset:4492
    ds_write_b32 v4, v24 offset:4752
    ds_write_b32 v4, v52 offset:4756
    ds_write_b32 v4, v20 offset:5016
    ds_write_b32 v4, v68 offset:5020
    ds_write_b32 v4, v36 offset:5280
    ds_write_b32 v4, v50 offset:5284
    ds_write_b32 v4, v18 offset:5544
    ds_write_b32 v4, v66 offset:5548
    ds_write_b32 v4, v34 offset:5808
    ds_write_b32 v4, v58 offset:5812
    ds_write_b32 v4, v26 offset:6072
    ds_write_b32 v4, v74 offset:6076
    ds_write_b32 v4, v42 offset:6336
    ds_write_b32 v4, v49 offset:6340
    ds_write_b32 v4, v17 offset:6600
    ds_write_b32 v4, v65 offset:6604
    ds_write_b32 v4, v33 offset:6864
    ds_write_b32 v4, v57 offset:6868
    ds_write_b32 v4, v25 offset:7128
    ds_write_b32 v4, v73 offset:7132
    ds_write_b32 v4, v41 offset:7392
    ds_write_b32 v4, v53 offset:7396
    ds_write_b32 v4, v21 offset:7656
    ds_write_b32 v4, v69 offset:7660
    ds_write_b32 v4, v37 offset:7920
    ds_write_b32 v4, v61 offset:7924
    ds_write_b32 v4, v29 offset:8184
    ds_write_b32 v4, v77 offset:8188
    s_waitcnt lgkmcnt(0)
    ds_read_b32 v16, v5 offset:0
    ds_read_b32 v48, v5 offset:4
    ds_read_b32 v83, v5 offset:8
    ds_read_b32 v81, v5 offset:12
    ds_read_b32 v80, v5 offset:16
    ds_read_b32 v72, v5 offset:20
    ds_read_b32 v40, v5 offset:24
    ds_read_b32 v60, v5 offset:28
    ds_read_b32 v28, v5 offset:32
    ds_read_b32 v76, v5 offset:36
    ds_read_b32 v44, v5 offset:40
    ds_read_b32 v62, v5 offset:44
    ds_read_b32 v30, v5 offset:48
    ds_read_b32 v54, v5 offset:52
    s_waitcnt lgkmcnt(0)
    ds_read_b32 v22, v5 offset:56
    ds_read_b32 v70, v5 offset:60
    ds_read_b32 v38, v5 offset:64
    ds_read_b32 v78, v5 offset:68
    ds_read_b32 v46, v5 offset:72
    ds_read_b32 v63, v5 offset:76
    ds_read_b32 v31, v5 offset:80
    ds_read_b32 v55, v5 offset:84
    ds_read_b32 v23, v5 offset:88
    ds_read_b32 v71, v5 offset:92
    ds_read_b32 v39, v5 offset:96
    ds_read_b32 v51, v5 offset:100
    ds_read_b32 v19, v5 offset:104
    ds_read_b32 v67, v5 offset:108
    s_waitcnt lgkmcnt(0)
    ds_read_b32 v35, v5 offset:112
    ds_read_b32 v59, v5 offset:116
    ds_read_b32 v27, v5 offset:120
    ds_read_b32 v75, v5 offset:124
    ds_read_b32 v43, v5 offset:128
    ds_read_b32 v79, v5 offset:132
    ds_read_b32 v47, v5 offset:136
    ds_read_b32 v56, v5 offset:140
    ds_read_b32 v24, v5 offset:144
    ds_read_b32 v52, v5 offset:148
    ds_read_b32 v20, v5 offset:152
    ds_read_b32 v68, v5 offset:156
    ds_read_b32 v36, v5 offset:160
    ds_read_b32 v50, v5 offset:164
    s_waitcnt lgkmcnt(0)
    ds_read_b32 v18, v5 offset:168
    ds_read_b32 v66, v5 offset:172
    ds_read_b32 v34, v5 offset:176
    ds_read_b32 v58, v5 offset:180
    ds_read_b32 v26, v5 offset:184
    ds_read_b32 v74, v5 offset:188
    ds_read_b32 v42, v5 offset:192
    ds_read_b32 v49, v5 offset:196
    ds_read_b32 v17, v5 offset:200
    ds_read_b32 v65, v5 offset:204
    ds_read_b32 v33, v5 offset:208
    ds_read_b32 v57, v5 offset:212
    ds_read_b32 v25, v5 offset:216
    ds_read_b32 v73, v5 offset:220
    s_waitcnt lgkmcnt(0)
    ds_read_b32 v41, v5 offset:224
    ds_read_b32 v53, v5 offset:228
    ds_read_b32 v21, v5 offset:232
    ds_read_b32 v69, v5 offset:236
    ds_read_b32 v37, v5 offset:240
    ds_read_b32 v61, v5 offset:244
    ds_read_b32 v29, v5 offset:248
    ds_read_b32 v77, v5 offset:252
    s_waitcnt lgkmcnt(0)
    v_sub_f32 v32, v16, v43
    v_sub_f32 v64, v48, v79
    v_add_f32 v16, v16, v43
    v_add_f32 v48, v48, v79
    v_sub_f32 v43, v83, v47
    v_sub_f32 v79, v81, v56
    v_add_f32 v83, v83, v47
    v_add_f32 v81, v81, v56
    v_mul_f32 v47, 0x3f7b14be, v43
    v_mul_f32 v56, 0xbe47c5c2, v43
    v_fmac_f32 v47, 0x3e47c5c2, v79
    v_fmac_f32 v56, 0x3f7b14be, v79
    v_sub_f32 v43, v80, v24
    v_sub_f32 v79, v72, v52
    v_add_f32 v80, v80, v24
    v_add_f32 v72, v72, v52
    v_mul_f32 v24, 0x3f6c835e, v43
    v_mul_f32 v52, 0xbec3ef15, v43
    v_fmac_f32 v24, 0x3ec3ef15, v79
    v_fmac_f32 v52, 0x3f6c835e, v79
    v_sub_f32 v43, v40, v20
    v_sub_f32 v79, v60, v68
    v_add_f32 v40, v40, v20
    v_add_f32 v60, v60, v68
    v_mul_f32 v20, 0x3f54db31, v43
    v_mul_f32 v68, 0xbf0e39da, v43
    v_fmac_f32 v20, 0x3f0e39da, v79
    v_fmac_f32 v68, 0x3f54db31, v79
    v_sub_f32 v43, v28, v36
    v_sub_f32 v79, v76, v50
    v_add_f32 v28, v28, v36
    v_add_f32 v76, v76, v50
    v_mul_f32 v36, 0x3f3504f3, v43
    v_mul_f32 v50, 0xbf3504f3, v43
    v_fmac_f32 v36, 0x3f3504f3, v79
    v_fmac_f32 v50, 0x3f3504f3, v79
    v_sub_f32 v43, v44, v18
    v_sub_f32 v79, v62, v66
    v_add_f32 v44, v44, v18
    v_add_f32 v62, v62, v66
    v_mul_f32 v18, 0x3f0e39da, v43
    v_mul_f32 v66, 0xbf54db31, v43
    v_fmac_f32 v18, 0x3f54db31, v79
    v_fmac_f32 v66, 0x3f0e39da, v79
    v_sub_f32 v43, v30, v34
    v_sub_f32 v79, v54, v58
    v_add_f32 v30, v30, v34
    v_add_f32 v54, v54, v58
    v_mul_f32 v34, 0x3ec3ef15, v43
    v_mul_f32 v58, 0xbf6c835e, v43
    v_fmac_f32 v34, 0x3f6c835e, v79
    v_fmac_f32 v58, 0x3ec3ef15, v79
    v_sub_f32 v43, v22, v26
    v_sub_f32 v79, v70, v74
    v_add_f32 v22, v22, v26
    v_add_f32 v70, v70, v74
    v_mul_f32 v26, 0x3e47c5c2, v43
    v_mul_f32 v74, 0xbf7b14be, v43
    v_fmac_f32 v26, 0x3f7b14be, v79
    v_fmac_f32 v74, 0x3e47c5c2, v79
    v_sub_f32 v43, v78, v49
    v_sub_f32 v79, v42, v38
    v_add_f32 v38, v38, v42
    v_add_f32 v78, v78, v49
    v_sub_f32 v42, v46, v17
    v_sub_f32 v49, v63, v65
    v_add_f32 v46, v46, v17
    v_add_f32 v63, v63, v65
    v_mul_f32 v17, 0xbe47c5c2, v42
    v_mul_f32 v65, 0xbf7b14be, v42
    v_fmac_f32 v17, 0x3f7b14be, v49
    v_fmac_f32 v65, 0xbe47c5c2, v49
    v_sub_f32 v42, v31, v33
    v_sub_f32 v49, v55, v57
    v_add_f32 v31, v31, v33
    v_add_f32 v55, v55, v57
    v_mul_f32 v33, 0xbec3ef15, v42
    v_mul_f32 v57, 0xbf6c835e, v42
    v_fmac_f32 v33, 0x3f6c835e, v49
    v_fmac_f32 v57, 0xbec3ef15, v49
    v_sub_f32 v42, v23, v25
    v_sub_f32 v49, v71, v73
    v_add_f32 v23, v23, v25
    v_add_f32 v71, v71, v73
    v_mul_f32 v25, 0xbf0e39da, v42
    v_mul_f32 v73, 0xbf54db31, v42
    v_fmac_f32 v25, 0x3f54db31, v49
    v_fmac_f32 v73, 0xbf0e39da, v49
    v_sub_f32 v42, v39, v41
    v_sub_f32 v49, v51, v53
    v_add_f32 v39, v39, v41
    v_add_f32 v51, v51, v53
    v_mul_f32 v41, 0xbf3504f3, v42
    v_mul_f32 v53, 0xbf3504f3, v42
    v_fmac_f32 v41, 0x3f3504f3, v49
    v_fmac_f32 v53, 0xbf3504f3, v49
    v_sub_f32 v42, v19, v21
    v_sub_f32 v49, v67, v69
    v_add_f32 v19, v19, v21
    v_add_f32 v67, v67, v69
    v_mul_f32 v21, 0xbf54db31, v42
    v_mul_f32 v69, 0xbf0e39da, v42
    v_fmac_f32 v21, 0x3f0e39da, v49
    v_fmac_f32 v69, 0xbf54db31, v49
    v_sub_f32 v42, v35, v37
    v_sub_f32 v49, v59, v61
    v_add_f32 v35, v35, v37
    v_add_f32 v59, v59, v61
    v_mul_f32 v37, 0xbf6c835e, v42
    v_mul_f32 v61, 0xbec3ef15, v42
    v_fmac_f32 v37, 0x3ec3ef15, v49
    v_fmac_f32 v61, 0xbf6c835e, v49
    v_sub_f32 v42, v27, v29
    v_sub_f32 v49, v75, v77
    v_add_f32 v27, v27, v29
    v_add_f32 v75, v75, v77
    v_mul_f32 v29, 0xbf7b14be, v42
    v_mul_f32 v77, 0xbe47c5c2, v42
    v_fmac_f32 v29, 0x3e47c5c2, v49
    v_fmac_f32 v77, 0xbf7b14be, v49
    v_sub_f32 v42, v16, v38
    v_sub_f32 v49, v48, v78
    v_add_f32 v16, v16, v38
    v_add_f32 v48, v48, v78
    v_sub_f32 v38, v83, v46
    v_sub_f32 v78, v81, v63
    v_add_f32 v83, v83, v46
    v_add_f32 v81, v81, v63
    v_mul_f32 v46, 0x3f6c835e, v38
    v_mul_f32 v63, 0xbec3ef15, v38
    v_fmac_f32 v46, 0x3ec3ef15, v78
    v_fmac_f32 v63, 0x3f6c835e, v78
    v_sub_f32 v38, v80, v31
    v_sub_f32 v78, v72, v55
    v_add_f32 v80, v80, v31
    v_add_f32 v72, v72, v55
    v_mul_f32 v31, 0x3f3504f3, v38
    v_mul_f32 v55, 0xbf3504f3, v38
    v_fmac_f32 v31, 0x3f3504f3, v78
    v_fmac_f32 v55, 0x3f3504f3, v78
    v_sub_f32 v38, v40, v23
    v_sub_f32 v78, v60, v71
    v_add_f32 v40, v40, v23
    v_add_f32 v60, v60, v71
    v_mul_f32 v23, 0x3ec3ef15, v38
    v_mul_f32 v71, 0xbf6c835e, v38
    v_fmac_f32 v23, 0x3f6c835e, v78
    v_fmac_f32 v71, 0x3ec3ef15, v78
    v_sub_f32 v38, v76, v51
    v_sub_f32 v78, v39, v28
    v_add_f32 v28, v28, v39
    v_add_f32 v76, v76, v51
    v_sub_f32 v39, v44, v19
    v_sub_f32 v51, v62, v67
    v_add_f32 v44, v44, v19
    v_add_f32 v62, v62, v67
    v_mul_f32 v19, 0xbec3ef15, v39
    v_mul_f32 v67, 0xbf6c835e, v39
    v_fmac_f32 v19, 0x3f6c835e, v51
    v_fmac_f32 v67, 0xbec3ef15, v51
    v_sub_f32 v39, v30, v35
    v_sub_f32 v51, v54, v59
    v_add_f32 v30, v30, v35
    v_add_f32 v54, v54, v59
    v_mul_f32 v35, 0xbf3504f3, v39
    v_mul_f32 v59, 0xbf3504f3, v39
    v_fmac_f32 v35, 0x3f3504f3, v51
    v_fmac_f32 v59, 0xbf3504f3, v51
    v_sub_f32 v39, v22, v27
    v_sub_f32 v51, v70, v75
    v_add_f32 v22, v22, v27
    v_add_f32 v70, v70, v75
    v_mul_f32 v27, 0xbf6c835e, v39
    v_mul_f32 v75, 0xbec3ef15, v39
    v_fmac_f32 v27, 0x3ec3ef15, v51
    v_fmac_f32 v75, 0xbf6c835e, v51
    v_sub_f32 v39, v32, v43
    v_sub_f32 v51, v64, v79
    v_add_f32 v32, v32, v43
    v_add_f32 v64, v64, v79
    v_sub_f32 v43, v47, v17
    v_sub_f32 v79, v56, v65
    v_add_f32 v47, v47, v17
    v_add_f32 v56, v56, v65
    v_mul_f32 v17, 0x3f6c835e, v43
    v_mul_f32 v65, 0xbec3ef15, v43
    v_fmac_f32 v17, 0x3ec3ef15, v79
    v_fmac_f32 v65, 0x3f6c835e, v79
    v_sub_f32 v43, v24, v33
    v_sub_f32 v79, v52, v57
    v_add_f32 v24, v24, v33
    v_add_f32 v52, v52, v57
    v_mul_f32 v33, 0x3f3504f3, v43
    v_mul_f32 v57, 0xbf3504f3, v43
    v_fmac_f32 v33, 0x3f3504f3, v79
    v_fmac_f32 v57, 0x3f3504f3, v79
    v_sub_f32 v43, v20, v25
    v_sub_f32 v79, v68, v73
    v_add_f32 v20, v20, v25
    v_add_f32 v68, v68, v73
    v_mul_f32 v25, 0x3ec3ef15, v43
    v_mul_f32 v73, 0xbf6c835e, v43
    v_fmac_f32 v25, 0x3f6c835e, v79
    v_fmac_f32 v73, 0x3ec3ef15, v79
    v_sub_f32 v43, v50, v53
    v_sub_f32 v79, v41, v36
    v_add_f32 v36, v36, v41
    v_add_f32 v50, v50, v53
    v_sub_f32 v41, v18, v21
    v_sub_f32 v53, v66, v69
    v_add_f32 v18, v18, v21
    v_add_f32 v66, v66, v69
    v_mul_f32 v21, 0xbec3ef15, v41
    v_mul_f32 v69, 0xbf6c835e, v41
    v_fmac_f32 v21, 0x3f6c835e, v53
    v_fmac_f32 v69, 0xbec3ef15, v53
    v_sub_f32 v41, v34, v37
    v_sub_f32 v53, v58, v61
    v_add_f32 v34, v34, v37
    v_add_f32 v58, v58, v61
    v_mul_f32 v37, 0xbf3504f3, v41
    v_mul_f32 v61, 0xbf3504f3, v41
    v_fmac_f32 v37, 0x3f3504f3, v53
    v_fmac_f32 v61, 0xbf3504f3, v53
    v_sub_f32 v41, v26, v29
    v_sub_f32 v53, v74, v77
    v_add_f32 v26, v26, v29
    v_add_f32 v74, v74, v77
    v_mul_f32 v29, 0xbf6c835e, v41
    v_mul_f32 v77, 0xbec3ef15, v41
    v_fmac_f32 v29, 0x3ec3ef15, v53
    v_fmac_f32 v77, 0xbf6c835e, v53
    v_sub_f32 v41, v16, v28
    v_sub_f32 v53, v48, v76
    v_add_f32 v16, v16, v28
    v_add_f32 v48, v48, v76
    v_sub_f32 v28, v83, v44
    v_sub_f32 v76, v81, v62
    v_add_f32 v83, v83, v44
    v_add_f32 v81, v81, v62
    v_mul_f32 v44, 0x3f3504f3, v28
    v_mul_f32 v62, 0xbf3504f3, v28
    v_fmac_f32 v44, 0x3f3504f3, v76
    v_fmac_f32 v62, 0x3f3504f3, v76
    v_sub_f32 v28, v72, v54
    v_sub_f32 v76, v30, v80
    v_add_f32 v80, v80, v30
    v_add_f32 v72, v72, v54
    v_sub_f32 v30, v40, v22
    v_sub_f32 v54, v60, v70
    v_add_f32 v40, v40, v22
    v_add_f32 v60, v60, v70
    v_mul_f32 v22, 0xbf3504f3, v30
    v_mul_f32 v70, 0xbf3504f3, v30
    v_fmac_f32 v22, 0x3f3504f3, v54
    v_fmac_f32 v70, 0xbf3504f3, v54
    v_sub_f32 v30, v42, v38
    v_sub_f32 v54, v49, v78
    v_add_f32 v42, v42, v38
    v_add_f32 v49, v49, v78
    v_sub_f32 v38, v46, v19
    v_sub_f32 v78, v63, v67
    v_add_f32 v46, v46, v19
    v_add_f32 v63, v63, v67
    v_mul_f32 v19, 0x3f3504f3, v38
    v_mul_f32 v67, 0xbf3504f3, v38
    v_fmac_f32 v19, 0x3f3504f3, v78
    v_fmac_f32 v67, 0x3f3504f3, v78
    v_sub_f32 v38, v55, v59
    v_sub_f32 v78, v35, v31
    v_add_f32 v31, v31, v35
    v_add_f32 v55, v55, v59
    v_sub_f32 v35, v23, v27
    v_sub_f32 v59, v71, v75
    v_add_f32 v23, v23, v27
    v_add_f32 v71, v71, v75
    v_mul_f32 v27, 0xbf3504f3, v35
    v_mul_f32 v75, 0xbf3504f3, v35
    v_fmac_f32 v27, 0x3f3504f3, v59
    v_fmac_f32 v75, 0xbf3504f3, v59
    v_sub_f32 v35, v32, v36
    v_sub_f32 v59, v64, v50
    v_add_f32 v32, v32, v36
    v_add_f32 v64, v64, v50
    v_sub_f32 v36, v47, v18
    v_sub_f32 v50, v56, v66
    v_add_f32 v47, v47, v18
    v_add_f32 v56, v56, v66
    v_mul_f32 v18, 0x3f3504f3, v36
    v_mul_f32 v66, 0xbf3504f3, v36
    v_fmac_f32 v18, 0x3f3504f3, v50
    v_fmac_f32 v66, 0x3f3504f3, v50
    v_sub_f32 v36, v52, v58
    v_sub_f32 v50, v34, v24
    v_add_f32 v24, v24, v34
    v_add_f32 v52, v52, v58
    v_sub_f32 v34, v20, v26
    v_sub_f32 v58, v68, v74
    v_add_f32 v20, v20, v26
    v_add_f32 v68, v68, v74
    v_mul_f32 v26, 0xbf3504f3, v34
    v_mul_f32 v74, 0xbf3504f3, v34
    v_fmac_f32 v26, 0x3f3504f3, v58
    v_fmac_f32 v74, 0xbf3504f3, v58
    v_sub_f32 v34, v39, v43
    v_sub_f32 v58, v51, v79
    v_add_f32 v39, v39, v43
    v_add_f32 v51, v51, v79
    v_sub_f32 v43, v17, v21
    v_sub_f32 v79, v65, v69
    v_add_f32 v17, v17, v21
    v_add_f32 v65, v65, v69
    v_mul_f32 v21, 0x3f3504f3, v43
    v_mul_f32 v69, 0xbf3504f3, v43
    v_fmac_f32 v21, 0x3f3504f3, v79
    v_fmac_f32 v69, 0x3f3504f3, v79
    v_sub_f32 v43, v57, v61
    v_sub_f32 v79, v37, v33
    v_add_f32 v33, v33, v37
    v_add_f32 v57, v57, v61
    v_sub_f32 v37, v25, v29
    v_sub_f32 v61, v73, v77
    v_add_f32 v25, v25, v29
    v_add_f32 v73, v73, v77
    v_mul_f32 v29, 0xbf3504f3, v37
    v_mul_f32 v77, 0xbf3504f3, v37
    v_fmac_f32 v29, 0x3f3504f3, v61
    v_fmac_f32 v77, 0xbf3504f3, v61
    v_sub_f32 v37, v16, v80
    v_sub_f32 v61, v48, v72
    v_add_f32 v16, v16, v80
    v_add_f32 v48, v48, v72
    v_sub_f32 v80, v81, v60
    v_sub_f32 v72, v40, v83
    v_add_f32 v83, v83, v40
    v_add_f32 v81, v81, v60
    v_sub_f32 v40, v41, v28
    v_sub_f32 v60, v53, v76
    v_add_f32 v41, v41, v28
    v_add_f32 v53, v53, v76
    v_sub_f32 v28, v62, v70
    v_sub_f32 v76, v22, v44
    v_add_f32 v44, v44, v22
    v_add_f32 v62, v62, v70
    v_sub_f32 v22, v42, v31
    v_sub_f32 v70, v49, v55
    v_add_f32 v42, v42, v31
    v_add_f32 v49, v49, v55
    v_sub_f32 v31, v63, v71
    v_sub_f32 v55, v23, v46
    v_add_f32 v46, v46, v23
    v_add_f32 v63, v63, v71
    v_sub_f32 v23, v30, v38
    v_sub_f32 v71, v54, v78
    v_add_f32 v30, v30, v38
    v_add_f32 v54, v54, v78
    v_sub_f32 v38, v67, v75
    v_sub_f32 v78, v27, v19
    v_add_f32 v19, v19, v27
    v_add_f32 v67, v67, v75
    v_sub_f32 v27, v32, v24
    v_sub_f32 v75, v64, v52
    v_add_f32 v32, v32, v24
    v_add_f32 v64, v64, v52
    v_sub_f32 v24, v56, v68
    v_sub_f32 v52, v20, v47
    v_add_f32 v47, v47, v20
    v_add_f32 v56, v56, v68
    v_sub_f32 v20, v35, v36
    v_sub_f32 v68, v59, v50
    v_add_f32 v35, v35, v36
    v_add_f32 v59, v59, v50
    v_sub_f32 v36, v66, v74
    v_sub_f32 v50, v26, v18
    v_add_f32 v18, v18, v26
    v_add_f32 v66, v66, v74
    v_sub_f32 v26, v39, v33
    v_sub_f32 v74, v51, v57
    v_add_f32 v39, v39, v33
    v_add_f32 v51, v51, v57
    v_sub_f32 v33, v65, v73
    v_sub_f32 v57, v25, v17
    v_add_f32 v17, v17, v25
    v_add_f32 v65, v65, v73
    v_sub_f32 v25, v34, v43
    v_sub_f32 v73, v58, v79
    v_add_f32 v34, v34, v43
    v_add_f32 v58, v58, v79
    v_sub_f32 v43, v69, v77
    v_sub_f32 v79, v29, v21
    v_add_f32 v21, v21, v29
    v_add_f32 v69, v69, v77
    v_sub_f32 v29, v16, v83
    v_sub_f32 v77, v48, v81
    v_add_f32 v16, v16, v83
    v_add_f32 v48, v48, v81
    v_sub_f32 v83, v37, v80
    v_sub_f32 v81, v61, v72
    v_add_f32 v37, v37, v80
    v_add_f32 v61, v61, v72
    v_sub_f32 v80, v41, v44
    v_sub_f32 v72, v53, v62
    v_add_f32 v41, v41, v44
    v_add_f32 v53, v53, v62
    v_sub_f32 v44, v40, v28
    v_sub_f32 v62, v60, v76
    v_add_f32 v40, v40, v28
    v_add_f32 v60, v60, v76
    v_sub_f32 v28, v42, v46
    v_sub_f32 v76, v49, v63
    v_add_f32 v42, v42, v46
    v_add_f32 v49, v49, v63
    v_sub_f32 v46, v22, v31
    v_sub_f32 v63, v70, v55
    v_add_f32 v22, v22, v31
    v_add_f32 v70, v70, v55
    v_sub_f32 v31, v30, v19
    v_sub_f32 v55, v54, v67
    v_add_f32 v30, v30, v19
    v_add_f32 v54, v54, v67
    v_sub_f32 v19, v23, v38
    v_sub_f32 v67, v71, v78
    v_add_f32 v23, v23, v38
    v_add_f32 v71, v71, v78
    v_sub_f32 v38, v32, v47
    v_sub_f32 v78, v64, v56
    v_add_f32 v32, v32, v47
    v_add_f32 v64, v64, v56
    v_sub_f32 v47, v27, v24
    v_sub_f32 v56, v75, v52
    v_add_f32 v27, v27, v24
    v_add_f32 v75, v75, v52
    v_sub_f32 v24, v35, v18
    v_sub_f32 v52, v59, v66
    v_add_f32 v35, v35, v18
    v_add_f32 v59, v59, v66
    v_sub_f32 v18, v20, v36
    v_sub_f32 v66, v68, v50
    v_add_f32 v20, v20, v36
    v_add_f32 v68, v68, v50
    v_sub_f32 v36, v39, v17
    v_sub_f32 v50, v51, v65
    v_add_f32 v39, v39, v17
    v_add_f32 v51, v51, v65
    v_sub_f32 v17, v26, v33
    v_sub_f32 v65, v74, v57
    v_add_f32 v26, v26, v33
    v_add_f32 v74, v74, v57
    v_sub_f32 v33, v34, v21
    v_sub_f32 v57, v58, v69
    v_add_f32 v34, v34, v21
    v_add_f32 v58, v58, v69
    v_sub_f32 v21, v25, v43
    v_sub_f32 v69, v73, v79
    v_add_f32 v25, v25, v43
    v_add_f32 v73, v73, v79
    ds_write_b32 v4, v16 offset:0
    ds_write_b32 v4, v48 offset:4
    ds_write_b32 v4, v32 offset:256
    ds_write_b32 v4, v64 offset:260
    ds_write_b32 v4, v42 offset:512
    ds_write_b32 v4, v49 offset:516
    ds_write_b32 v4, v39 offset:768
    ds_write_b32 v4, v51 offset:772
    ds_write_b32 v4, v41 offset:1024
    ds_write_b32 v4, v53 offset:1028
    ds_write_b32 v4, v35 offset:1280
    ds_write_b32 v4, v59 offset:1284
    ds_write_b32 v4, v30 offset:1536
    ds_write_b32 v4, v54 offset:1540
    ds_write_b32 v4, v34 offset:1792
    ds_write_b32 v4, v58 offset:1796
    ds_write_b32 v4, v37 offset:2048
    ds_write_b32 v4, v61 offset:2052
    ds_write_b32 v4, v27 offset:2304
    ds_write_b32 v4, v75 offset:2308
    ds_write_b32 v4, v22 offset:2560
    ds_write_b32 v4, v70 offset:2564
    ds_write_b32 v4, v26 offset:2816
    ds_write_b32 v4, v74 offset:2820
    ds_write_b32 v4, v40 offset:3072
    ds_write_b32 v4, v60 offset:3076
    ds_write_b32 v4, v20 offset:3328
    ds_write_b32 v4, v68 offset:3332
    ds_write_b32 v4, v23 offset:3584
    ds_write_b32 v4, v71 offset:3588
    ds_write_b32 v4, v25 offset:3840
    ds_write_b32 v4, v73 offset:3844
    ds_write_b32 v4, v29 offset:4096
    ds_write_b32 v4, v77 offset:4100
    ds_write_b32 v4, v38 offset:4352
    ds_write_b32 v4, v78 offset:4356
    ds_write_b32 v4, v28 offset:4608
    ds_write_b32 v4, v76 offset:4612
    ds_write_b32 v4, v36 offset:4864
    ds_write_b32 v4, v50 offset:4868
    ds_write_b32 v4, v80 offset:5120
    ds_write_b32 v4, v72 offset:5124
    ds_write_b32 v4, v24 offset:5376
    ds_write_b32 v4, v52 offset:5380
    ds_write_b32 v4, v31 offset:5632
    ds_write_b32 v4, v55 offset:5636
    ds_write_b32 v4, v33 offset:5888
    ds_write_b32 v4, v57 offset:5892
    ds_write_b32 v4, v83 offset:6144
    ds_write_b32 v4, v81 offset:6148
    ds_write_b32 v4, v47 offset:6400
    ds_write_b32 v4, v56 offset:6404
    ds_write_b32 v4, v46 offset:6656
    ds_write_b32 v4, v63 offset:6660
    ds_write_b32 v4, v17 offset:6912
    ds_write_b32 v4, v65 offset:6916
    ds_write_b32 v4, v44 offset:7168
    ds_write_b32 v4, v62 offset:7172
    ds_write_b32 v4, v18 offset:7424
    ds_write_b32 v4, v66 offset:7428
    ds_write_b32 v4, v19 offset:7680
    ds_write_b32 v4, v67 offset:7684
    ds_write_b32 v4, v21 offset:7936
    ds_write_b32 v4, v69 offset:7940
    s_waitcnt lgkmcnt(0)
    s_barrier
    v_and_b32 v6, 7, v0
    v_lshrrev_b32 v7, 3, v0
    s_movk_i32 s13, 8448
    v_mul_lo_u32 v8, v6, s13
    v_lshl_add_u32 v4, v7, 3, v8
    v_lshlrev_b32 v5, 14, v7
    v_lshl_add_u32 v5, v6, 4, v5
    s_lshl_b32 s12, s93, 7
    s_add_u32 s12, s12, 96468992
    v_sub_u32 v6, 1024, v7
    v_and_b32 v6, 1023, v6
    v_lshl_add_u32 v6, v6, 3, v8
    ds_read_b64 v[16:17], v4 offset:0
    ds_read_b64 v[18:19], v6
    s_waitcnt lgkmcnt(0)
    v_add_f32 v20, v16, v18
    v_sub_f32 v21, v17, v19
    v_add_f32 v22, v17, v19
    v_sub_f32 v23, v18, v16
    s_mov_b32 s13, s12
    s_add_u32 s13, s12, 0
    buffer_store_dwordx4 v[20:23], v5, s[8:11], s13 offen sc1
    s_nop 1
    v_sub_u32 v6, 992, v7
    v_and_b32 v6, 1023, v6
    v_lshl_add_u32 v6, v6, 3, v8
    ds_read_b64 v[16:17], v4 offset:256
    ds_read_b64 v[18:19], v6
    s_waitcnt lgkmcnt(0)
    v_add_f32 v20, v16, v18
    v_sub_f32 v21, v17, v19
    v_add_f32 v22, v17, v19
    v_sub_f32 v23, v18, v16
    s_mov_b32 s13, s12
    s_add_u32 s13, s12, 524288
    buffer_store_dwordx4 v[20:23], v5, s[8:11], s13 offen sc1
    s_nop 1
    v_sub_u32 v6, 960, v7
    v_and_b32 v6, 1023, v6
    v_lshl_add_u32 v6, v6, 3, v8
    ds_read_b64 v[16:17], v4 offset:512
    ds_read_b64 v[18:19], v6
    s_waitcnt lgkmcnt(0)
    v_add_f32 v20, v16, v18
    v_sub_f32 v21, v17, v19
    v_add_f32 v22, v17, v19
    v_sub_f32 v23, v18, v16
    s_mov_b32 s13, s12
    s_add_u32 s13, s12, 1048576
    buffer_store_dwordx4 v[20:23], v5, s[8:11], s13 offen sc1
    s_nop 1
    v_sub_u32 v6, 928, v7
    v_and_b32 v6, 1023, v6
    v_lshl_add_u32 v6, v6, 3, v8
    ds_read_b64 v[16:17], v4 offset:768
    ds_read_b64 v[18:19], v6
    s_waitcnt lgkmcnt(0)
    v_add_f32 v20, v16, v18
    v_sub_f32 v21, v17, v19
    v_add_f32 v22, v17, v19
    v_sub_f32 v23, v18, v16
    s_mov_b32 s13, s12
    s_add_u32 s13, s12, 1572864
    buffer_store_dwordx4 v[20:23], v5, s[8:11], s13 offen sc1
    s_nop 1
    v_sub_u32 v6, 896, v7
    v_and_b32 v6, 1023, v6
    v_lshl_add_u32 v6, v6, 3, v8
    ds_read_b64 v[16:17], v4 offset:1024
    ds_read_b64 v[18:19], v6
    s_waitcnt lgkmcnt(0)
    v_add_f32 v20, v16, v18
    v_sub_f32 v21, v17, v19
    v_add_f32 v22, v17, v19
    v_sub_f32 v23, v18, v16
    s_mov_b32 s13, s12
    s_add_u32 s13, s12, 2097152
    buffer_store_dwordx4 v[20:23], v5, s[8:11], s13 offen sc1
    s_nop 1
    v_sub_u32 v6, 864, v7
    v_and_b32 v6, 1023, v6
    v_lshl_add_u32 v6, v6, 3, v8
    ds_read_b64 v[16:17], v4 offset:1280
    ds_read_b64 v[18:19], v6
    s_waitcnt lgkmcnt(0)
    v_add_f32 v20, v16, v18
    v_sub_f32 v21, v17, v19
    v_add_f32 v22, v17, v19
    v_sub_f32 v23, v18, v16
    s_mov_b32 s13, s12
    s_add_u32 s13, s12, 2621440
    buffer_store_dwordx4 v[20:23], v5, s[8:11], s13 offen sc1
    s_nop 1
    v_sub_u32 v6, 832, v7
    v_and_b32 v6, 1023, v6
    v_lshl_add_u32 v6, v6, 3, v8
    ds_read_b64 v[16:17], v4 offset:1536
    ds_read_b64 v[18:19], v6
    s_waitcnt lgkmcnt(0)
    v_add_f32 v20, v16, v18
    v_sub_f32 v21, v17, v19
    v_add_f32 v22, v17, v19
    v_sub_f32 v23, v18, v16
    s_mov_b32 s13, s12
    s_add_u32 s13, s12, 3145728
    buffer_store_dwordx4 v[20:23], v5, s[8:11], s13 offen sc1
    s_nop 1
    v_sub_u32 v6, 800, v7
    v_and_b32 v6, 1023, v6
    v_lshl_add_u32 v6, v6, 3, v8
    ds_read_b64 v[16:17], v4 offset:1792
    ds_read_b64 v[18:19], v6
    s_waitcnt lgkmcnt(0)
    v_add_f32 v20, v16, v18
    v_sub_f32 v21, v17, v19
    v_add_f32 v22, v17, v19
    v_sub_f32 v23, v18, v16
    s_mov_b32 s13, s12
    s_add_u32 s13, s12, 3670016
    buffer_store_dwordx4 v[20:23], v5, s[8:11], s13 offen sc1
    s_nop 1
    v_sub_u32 v6, 768, v7
    v_and_b32 v6, 1023, v6
    v_lshl_add_u32 v6, v6, 3, v8
    ds_read_b64 v[16:17], v4 offset:2048
    ds_read_b64 v[18:19], v6
    s_waitcnt lgkmcnt(0)
    v_add_f32 v20, v16, v18
    v_sub_f32 v21, v17, v19
    v_add_f32 v22, v17, v19
    v_sub_f32 v23, v18, v16
    s_mov_b32 s13, s12
    s_add_u32 s13, s12, 4194304
    buffer_store_dwordx4 v[20:23], v5, s[8:11], s13 offen sc1
    s_nop 1
    v_sub_u32 v6, 736, v7
    v_and_b32 v6, 1023, v6
    v_lshl_add_u32 v6, v6, 3, v8
    ds_read_b64 v[16:17], v4 offset:2304
    ds_read_b64 v[18:19], v6
    s_waitcnt lgkmcnt(0)
    v_add_f32 v20, v16, v18
    v_sub_f32 v21, v17, v19
    v_add_f32 v22, v17, v19
    v_sub_f32 v23, v18, v16
    s_mov_b32 s13, s12
    s_add_u32 s13, s12, 4718592
    buffer_store_dwordx4 v[20:23], v5, s[8:11], s13 offen sc1
    s_nop 1
    v_sub_u32 v6, 704, v7
    v_and_b32 v6, 1023, v6
    v_lshl_add_u32 v6, v6, 3, v8
    ds_read_b64 v[16:17], v4 offset:2560
    ds_read_b64 v[18:19], v6
    s_waitcnt lgkmcnt(0)
    v_add_f32 v20, v16, v18
    v_sub_f32 v21, v17, v19
    v_add_f32 v22, v17, v19
    v_sub_f32 v23, v18, v16
    s_mov_b32 s13, s12
    s_add_u32 s13, s12, 5242880
    buffer_store_dwordx4 v[20:23], v5, s[8:11], s13 offen sc1
    s_nop 1
    v_sub_u32 v6, 672, v7
    v_and_b32 v6, 1023, v6
    v_lshl_add_u32 v6, v6, 3, v8
    ds_read_b64 v[16:17], v4 offset:2816
    ds_read_b64 v[18:19], v6
    s_waitcnt lgkmcnt(0)
    v_add_f32 v20, v16, v18
    v_sub_f32 v21, v17, v19
    v_add_f32 v22, v17, v19
    v_sub_f32 v23, v18, v16
    s_mov_b32 s13, s12
    s_add_u32 s13, s12, 5767168
    buffer_store_dwordx4 v[20:23], v5, s[8:11], s13 offen sc1
    s_nop 1
    v_sub_u32 v6, 640, v7
    v_and_b32 v6, 1023, v6
    v_lshl_add_u32 v6, v6, 3, v8
    ds_read_b64 v[16:17], v4 offset:3072
    ds_read_b64 v[18:19], v6
    s_waitcnt lgkmcnt(0)
    v_add_f32 v20, v16, v18
    v_sub_f32 v21, v17, v19
    v_add_f32 v22, v17, v19
    v_sub_f32 v23, v18, v16
    s_mov_b32 s13, s12
    s_add_u32 s13, s12, 6291456
    buffer_store_dwordx4 v[20:23], v5, s[8:11], s13 offen sc1
    s_nop 1
    v_sub_u32 v6, 608, v7
    v_and_b32 v6, 1023, v6
    v_lshl_add_u32 v6, v6, 3, v8
    ds_read_b64 v[16:17], v4 offset:3328
    ds_read_b64 v[18:19], v6
    s_waitcnt lgkmcnt(0)
    v_add_f32 v20, v16, v18
    v_sub_f32 v21, v17, v19
    v_add_f32 v22, v17, v19
    v_sub_f32 v23, v18, v16
    s_mov_b32 s13, s12
    s_add_u32 s13, s12, 6815744
    buffer_store_dwordx4 v[20:23], v5, s[8:11], s13 offen sc1
    s_nop 1
    v_sub_u32 v6, 576, v7
    v_and_b32 v6, 1023, v6
    v_lshl_add_u32 v6, v6, 3, v8
    ds_read_b64 v[16:17], v4 offset:3584
    ds_read_b64 v[18:19], v6
    s_waitcnt lgkmcnt(0)
    v_add_f32 v20, v16, v18
    v_sub_f32 v21, v17, v19
    v_add_f32 v22, v17, v19
    v_sub_f32 v23, v18, v16
    s_mov_b32 s13, s12
    s_add_u32 s13, s12, 7340032
    buffer_store_dwordx4 v[20:23], v5, s[8:11], s13 offen sc1
    s_nop 1
    v_sub_u32 v6, 544, v7
    v_and_b32 v6, 1023, v6
    v_lshl_add_u32 v6, v6, 3, v8
    ds_read_b64 v[16:17], v4 offset:3840
    ds_read_b64 v[18:19], v6
    s_waitcnt lgkmcnt(0)
    v_add_f32 v20, v16, v18
    v_sub_f32 v21, v17, v19
    v_add_f32 v22, v17, v19
    v_sub_f32 v23, v18, v16
    s_mov_b32 s13, s12
    s_add_u32 s13, s12, 7864320
    buffer_store_dwordx4 v[20:23], v5, s[8:11], s13 offen sc1
    s_nop 1
    v_sub_u32 v6, 512, v7
    v_and_b32 v6, 1023, v6
    v_lshl_add_u32 v6, v6, 3, v8
    ds_read_b64 v[16:17], v4 offset:4096
    ds_read_b64 v[18:19], v6
    s_waitcnt lgkmcnt(0)
    v_add_f32 v20, v16, v18
    v_sub_f32 v21, v17, v19
    v_add_f32 v22, v17, v19
    v_sub_f32 v23, v18, v16
    s_mov_b32 s13, s12
    v_cmp_eq_u32 vcc, 0, v7
    s_and_saveexec_b64 s[14:15], vcc
    s_add_u32 s13, s12, 8388608
    buffer_store_dwordx4 v[20:23], v5, s[8:11], s13 offen sc1
    s_nop 1
    s_mov_b64 exec, -1
    s_add_u32 s93, s93, 64
    s_cmp_lt_u32 s93, 128
    s_cbranch_scc1 mega_kernel_f1l
    s_waitcnt vmcnt(0)
    s_barrier
    v_mov_b32 v1, 0
    v_mov_b32 v2, 1
    s_mov_b32 s82, 70291456
    v_cmp_eq_u32 vcc, 0, v0
    s_and_saveexec_b64 s[80:81], vcc
    s_cbranch_execz mega_kernel_sg0
    buffer_atomic_add v2, v1, s[84:87], s82 offen sc1
    mega_kernel_sg0:
    s_mov_b64 exec, s[80:81]
    v_mov_b32 v1, 0
    s_mov_b32 s82, 70291456
mega_kernel_w0:
    s_sleep 8
    buffer_load_dword v2, v1, s[84:87], s82 offen sc1
    s_waitcnt vmcnt(0)
    v_cmp_ne_u32 vcc, 63, v2
    s_cbranch_vccnz mega_kernel_w0
    s_mov_b32 s93, s92
mega_kernel_f2l:
    s_barrier
    s_load_dwordx2 s[8:9], s[0:1], 96
    v_lshrrev_b32 v5, 6, v0
    v_and_b32 v1, 63, v0
    v_readfirstlane_b32 s12, v5
    s_lshl_b32 s13, s93, 2
    s_add_u32 s13, s13, s12
    s_cmp_ge_u32 s13, 513
    s_cbranch_scc1 mega_kernel_f2_end
    v_cvt_f32_u32 v2, v1
    s_waitcnt lgkmcnt(0)
    s_mov_b32 s10, 268435456
    s_mov_b32 s11, 0x00020000
    s_lshl_b32 s14, s13, 14
    s_add_u32 s15, s14, 96468992
    v_lshlrev_b32 v5, 3, v1
    s_add_u32 s16, s15, 0
    buffer_load_dwordx2 v[16:17], v5, s[8:11], s16 offen
    s_add_u32 s16, s15, 512
    buffer_load_dwordx2 v[18:19], v5, s[8:11], s16 offen
    s_add_u32 s16, s15, 1024
    buffer_load_dwordx2 v[20:21], v5, s[8:11], s16 offen
    s_add_u32 s16, s15, 1536
    buffer_load_dwordx2 v[22:23], v5, s[8:11], s16 offen
    s_add_u32 s16, s15, 2048
    buffer_load_dwordx2 v[24:25], v5, s[8:11], s16 offen
    s_add_u32 s16, s15, 2560
    buffer_load_dwordx2 v[26:27], v5, s[8:11], s16 offen
    s_add_u32 s16, s15, 3072
    buffer_load_dwordx2 v[28:29], v5, s[8:11], s16 offen
    s_add_u32 s16, s15, 3584
    buffer_load_dwordx2 v[30:31], v5, s[8:11], s16 offen
    s_add_u32 s16, s15, 4096
    buffer_load_dwordx2 v[32:33], v5, s[8:11], s16 offen
    s_add_u32 s16, s15, 4608
    buffer_load_dwordx2 v[34:35], v5, s[8:11], s16 offen
    s_add_u32 s16, s15, 5120
    buffer_load_dwordx2 v[36:37], v5, s[8:11], s16 offen
    s_add_u32 s16, s15, 5632
    buffer_load_dwordx2 v[38:39], v5, s[8:11], s16 offen
    s_add_u32 s16, s15, 6144
    buffer_load_dwordx2 v[40:41], v5, s[8:11], s16 offen
    s_add_u32 s16, s15, 6656
    buffer_load_dwordx2 v[42:43], v5, s[8:11], s16 offen
    s_add_u32 s16, s15, 7168
    buffer_load_dwordx2 v[44:45], v5, s[8:11], s16 offen
    s_add_u32 s16, s15, 7680
    buffer_load_dwordx2 v[46:47], v5, s[8:11], s16 offen
    s_add_u32 s16, s15, 8192
    buffer_load_dwordx2 v[48:49], v5, s[8:11], s16 offen
    s_add_u32 s16, s15, 8704
    buffer_load_dwordx2 v[50:51], v5, s[8:11], s16 offen
    s_add_u32 s16, s15, 9216
    buffer_load_dwordx2 v[52:53], v5, s[8:11], s16 offen
    s_add_u32 s16, s15, 9728
    buffer_load_dwordx2 v[54:55], v5, s[8:11], s16 offen
    s_add_u32 s16, s15, 10240
    buffer_load_dwordx2 v[56:57], v5, s[8:11], s16 offen
    s_add_u32 s16, s15, 10752
    buffer_load_dwordx2 v[58:59], v5, s[8:11], s16 offen
    s_add_u32 s16, s15, 11264
    buffer_load_dwordx2 v[60:61], v5, s[8:11], s16 offen
    s_add_u32 s16, s15, 11776
    buffer_load_dwordx2 v[62:63], v5, s[8:11], s16 offen
    s_add_u32 s16, s15, 12288
    buffer_load_dwordx2 v[64:65], v5, s[8:11], s16 offen
    s_add_u32 s16, s15, 12800
    buffer_load_dwordx2 v[66:67], v5, s[8:11], s16 offen
    s_add_u32 s16, s15, 13312
    buffer_load_dwordx2 v[68:69], v5, s[8:11], s16 offen
    s_add_u32 s16, s15, 13824
    buffer_load_dwordx2 v[70:71], v5, s[8:11], s16 offen
    s_add_u32 s16, s15, 14336
    buffer_load_dwordx2 v[72:73], v5, s[8:11], s16 offen
    s_add_u32 s16, s15, 14848
    buffer_load_dwordx2 v[74:75], v5, s[8:11], s16 offen
    s_add_u32 s16, s15, 15360
    buffer_load_dwordx2 v[76:77], v5, s[8:11], s16 offen
    s_add_u32 s16, s15, 15872
    buffer_load_dwordx2 v[78:79], v5, s[8:11], s16 offen
    s_mul_i32 s17, s12, 16896
    v_lshlrev_b32 v3, 3, v1
    v_add_u32 v3, s17, v3
    v_and_b32 v7, 1, v1
    v_lshrrev_b32 v6, 1, v1
    v_cvt_f32_u32 v8, v6
    v_cvt_f32_u32 v10, v7
    s_movk_i32 s18, 528
    v_mul_lo_u32 v4, v6, s18
    v_lshl_add_u32 v4, v7, 3, v4
    v_add_u32 v4, s17, v4
    v_mov_b32 v9, 1.0
    v_fma_f32 v9, v10, -2.0, v9
    v_lshlrev_b32 v5, 12, v7
    v_lshl_add_u32 v11, v6, 2, v5
    s_lshl_b32 s19, s13, 13
    s_add_u32 s19, s19, 121634816
    s_waitcnt vmcnt(0)
    v_sub_f32 v80, v16, v48
    v_sub_f32 v81, v17, v49
    v_add_f32 v16, v16, v48
    v_add_f32 v17, v17, v49
    v_sub_f32 v48, v18, v50
    v_sub_f32 v49, v19, v51
    v_add_f32 v18, v18, v50
    v_add_f32 v19, v19, v51
    v_mul_f32 v50, 0x3f7b14be, v48
    v_mul_f32 v51, 0xbe47c5c2, v48
    v_fmac_f32 v50, 0x3e47c5c2, v49
    v_fmac_f32 v51, 0x3f7b14be, v49
    v_sub_f32 v48, v20, v52
    v_sub_f32 v49, v21, v53
    v_add_f32 v20, v20, v52
    v_add_f32 v21, v21, v53
    v_mul_f32 v52, 0x3f6c835e, v48
    v_mul_f32 v53, 0xbec3ef15, v48
    v_fmac_f32 v52, 0x3ec3ef15, v49
    v_fmac_f32 v53, 0x3f6c835e, v49
    v_sub_f32 v48, v22, v54
    v_sub_f32 v49, v23, v55
    v_add_f32 v22, v22, v54
    v_add_f32 v23, v23, v55
    v_mul_f32 v54, 0x3f54db31, v48
    v_mul_f32 v55, 0xbf0e39da, v48
    v_fmac_f32 v54, 0x3f0e39da, v49
    v_fmac_f32 v55, 0x3f54db31, v49
    v_sub_f32 v48, v24, v56
    v_sub_f32 v49, v25, v57
    v_add_f32 v24, v24, v56
    v_add_f32 v25, v25, v57
    v_mul_f32 v56, 0x3f3504f3, v48
    v_mul_f32 v57, 0xbf3504f3, v48
    v_fmac_f32 v56, 0x3f3504f3, v49
    v_fmac_f32 v57, 0x3f3504f3, v49
    v_sub_f32 v48, v26, v58
    v_sub_f32 v49, v27, v59
    v_add_f32 v26, v26, v58
    v_add_f32 v27, v27, v59
    v_mul_f32 v58, 0x3f0e39da, v48
    v_mul_f32 v59, 0xbf54db31, v48
    v_fmac_f32 v58, 0x3f54db31, v49
    v_fmac_f32 v59, 0x3f0e39da, v49
    v_sub_f32 v48, v28, v60
    v_sub_f32 v49, v29, v61
    v_add_f32 v28, v28, v60
    v_add_f32 v29, v29, v61
    v_mul_f32 v60, 0x3ec3ef15, v48
    v_mul_f32 v61, 0xbf6c835e, v48
    v_fmac_f32 v60, 0x3f6c835e, v49
    v_fmac_f32 v61, 0x3ec3ef15, v49
    v_sub_f32 v48, v30, v62
    v_sub_f32 v49, v31, v63
    v_add_f32 v30, v30, v62
    v_add_f32 v31, v31, v63
    v_mul_f32 v62, 0x3e47c5c2, v48
    v_mul_f32 v63, 0xbf7b14be, v48
    v_fmac_f32 v62, 0x3f7b14be, v49
    v_fmac_f32 v63, 0x3e47c5c2, v49
    v_sub_f32 v48, v33, v65
    v_sub_f32 v49, v64, v32
    v_add_f32 v32, v32, v64
    v_add_f32 v33, v33, v65
    v_sub_f32 v64, v34, v66
    v_sub_f32 v65, v35, v67
    v_add_f32 v34, v34, v66
    v_add_f32 v35, v35, v67
    v_mul_f32 v66, 0xbe47c5c2, v64
    v_mul_f32 v67, 0xbf7b14be, v64
    v_fmac_f32 v66, 0x3f7b14be, v65
    v_fmac_f32 v67, 0xbe47c5c2, v65
    v_sub_f32 v64, v36, v68
    v_sub_f32 v65, v37, v69
    v_add_f32 v36, v36, v68
    v_add_f32 v37, v37, v69
    v_mul_f32 v68, 0xbec3ef15, v64
    v_mul_f32 v69, 0xbf6c835e, v64
    v_fmac_f32 v68, 0x3f6c835e, v65
    v_fmac_f32 v69, 0xbec3ef15, v65
    v_sub_f32 v64, v38, v70
    v_sub_f32 v65, v39, v71
    v_add_f32 v38, v38, v70
    v_add_f32 v39, v39, v71
    v_mul_f32 v70, 0xbf0e39da, v64
    v_mul_f32 v71, 0xbf54db31, v64
    v_fmac_f32 v70, 0x3f54db31, v65
    v_fmac_f32 v71, 0xbf0e39da, v65
    v_sub_f32 v64, v40, v72
    v_sub_f32 v65, v41, v73
    v_add_f32 v40, v40, v72
    v_add_f32 v41, v41, v73
    v_mul_f32 v72, 0xbf3504f3, v64
    v_mul_f32 v73, 0xbf3504f3, v64
    v_fmac_f32 v72, 0x3f3504f3, v65
    v_fmac_f32 v73, 0xbf3504f3, v65
    v_sub_f32 v64, v42, v74
    v_sub_f32 v65, v43, v75
    v_add_f32 v42, v42, v74
    v_add_f32 v43, v43, v75
    v_mul_f32 v74, 0xbf54db31, v64
    v_mul_f32 v75, 0xbf0e39da, v64
    v_fmac_f32 v74, 0x3f0e39da, v65
    v_fmac_f32 v75, 0xbf54db31, v65
    v_sub_f32 v64, v44, v76
    v_sub_f32 v65, v45, v77
    v_add_f32 v44, v44, v76
    v_add_f32 v45, v45, v77
    v_mul_f32 v76, 0xbf6c835e, v64
    v_mul_f32 v77, 0xbec3ef15, v64
    v_fmac_f32 v76, 0x3ec3ef15, v65
    v_fmac_f32 v77, 0xbf6c835e, v65
    v_sub_f32 v64, v46, v78
    v_sub_f32 v65, v47, v79
    v_add_f32 v46, v46, v78
    v_add_f32 v47, v47, v79
    v_mul_f32 v78, 0xbf7b14be, v64
    v_mul_f32 v79, 0xbe47c5c2, v64
    v_fmac_f32 v78, 0x3e47c5c2, v65
    v_fmac_f32 v79, 0xbf7b14be, v65
    v_sub_f32 v64, v16, v32
    v_sub_f32 v65, v17, v33
    v_add_f32 v16, v16, v32
    v_add_f32 v17, v17, v33
    v_sub_f32 v32, v18, v34
    v_sub_f32 v33, v19, v35
    v_add_f32 v18, v18, v34
    v_add_f32 v19, v19, v35
    v_mul_f32 v34, 0x3f6c835e, v32
    v_mul_f32 v35, 0xbec3ef15, v32
    v_fmac_f32 v34, 0x3ec3ef15, v33
    v_fmac_f32 v35, 0x3f6c835e, v33
    v_sub_f32 v32, v20, v36
    v_sub_f32 v33, v21, v37
    v_add_f32 v20, v20, v36
    v_add_f32 v21, v21, v37
    v_mul_f32 v36, 0x3f3504f3, v32
    v_mul_f32 v37, 0xbf3504f3, v32
    v_fmac_f32 v36, 0x3f3504f3, v33
    v_fmac_f32 v37, 0x3f3504f3, v33
    v_sub_f32 v32, v22, v38
    v_sub_f32 v33, v23, v39
    v_add_f32 v22, v22, v38
    v_add_f32 v23, v23, v39
    v_mul_f32 v38, 0x3ec3ef15, v32
    v_mul_f32 v39, 0xbf6c835e, v32
    v_fmac_f32 v38, 0x3f6c835e, v33
    v_fmac_f32 v39, 0x3ec3ef15, v33
    v_sub_f32 v32, v25, v41
    v_sub_f32 v33, v40, v24
    v_add_f32 v24, v24, v40
    v_add_f32 v25, v25, v41
    v_sub_f32 v40, v26, v42
    v_sub_f32 v41, v27, v43
    v_add_f32 v26, v26, v42
    v_add_f32 v27, v27, v43
    v_mul_f32 v42, 0xbec3ef15, v40
    v_mul_f32 v43, 0xbf6c835e, v40
    v_fmac_f32 v42, 0x3f6c835e, v41
    v_fmac_f32 v43, 0xbec3ef15, v41
    v_sub_f32 v40, v28, v44
    v_sub_f32 v41, v29, v45
    v_add_f32 v28, v28, v44
    v_add_f32 v29, v29, v45
    v_mul_f32 v44, 0xbf3504f3, v40
    v_mul_f32 v45, 0xbf3504f3, v40
    v_fmac_f32 v44, 0x3f3504f3, v41
    v_fmac_f32 v45, 0xbf3504f3, v41
    v_sub_f32 v40, v30, v46
    v_sub_f32 v41, v31, v47
    v_add_f32 v30, v30, v46
    v_add_f32 v31, v31, v47
    v_mul_f32 v46, 0xbf6c835e, v40
    v_mul_f32 v47, 0xbec3ef15, v40
    v_fmac_f32 v46, 0x3ec3ef15, v41
    v_fmac_f32 v47, 0xbf6c835e, v41
    v_sub_f32 v40, v80, v48
    v_sub_f32 v41, v81, v49
    v_add_f32 v80, v80, v48
    v_add_f32 v81, v81, v49
    v_sub_f32 v48, v50, v66
    v_sub_f32 v49, v51, v67
    v_add_f32 v50, v50, v66
    v_add_f32 v51, v51, v67
    v_mul_f32 v66, 0x3f6c835e, v48
    v_mul_f32 v67, 0xbec3ef15, v48
    v_fmac_f32 v66, 0x3ec3ef15, v49
    v_fmac_f32 v67, 0x3f6c835e, v49
    v_sub_f32 v48, v52, v68
    v_sub_f32 v49, v53, v69
    v_add_f32 v52, v52, v68
    v_add_f32 v53, v53, v69
    v_mul_f32 v68, 0x3f3504f3, v48
    v_mul_f32 v69, 0xbf3504f3, v48
    v_fmac_f32 v68, 0x3f3504f3, v49
    v_fmac_f32 v69, 0x3f3504f3, v49
    v_sub_f32 v48, v54, v70
    v_sub_f32 v49, v55, v71
    v_add_f32 v54, v54, v70
    v_add_f32 v55, v55, v71
    v_mul_f32 v70, 0x3ec3ef15, v48
    v_mul_f32 v71, 0xbf6c835e, v48
    v_fmac_f32 v70, 0x3f6c835e, v49
    v_fmac_f32 v71, 0x3ec3ef15, v49
    v_sub_f32 v48, v57, v73
    v_sub_f32 v49, v72, v56
    v_add_f32 v56, v56, v72
    v_add_f32 v57, v57, v73
    v_sub_f32 v72, v58, v74
    v_sub_f32 v73, v59, v75
    v_add_f32 v58, v58, v74
    v_add_f32 v59, v59, v75
    v_mul_f32 v74, 0xbec3ef15, v72
    v_mul_f32 v75, 0xbf6c835e, v72
    v_fmac_f32 v74, 0x3f6c835e, v73
    v_fmac_f32 v75, 0xbec3ef15, v73
    v_sub_f32 v72, v60, v76
    v_sub_f32 v73, v61, v77
    v_add_f32 v60, v60, v76
    v_add_f32 v61, v61, v77
    v_mul_f32 v76, 0xbf3504f3, v72
    v_mul_f32 v77, 0xbf3504f3, v72
    v_fmac_f32 v76, 0x3f3504f3, v73
    v_fmac_f32 v77, 0xbf3504f3, v73
    v_sub_f32 v72, v62, v78
    v_sub_f32 v73, v63, v79
    v_add_f32 v62, v62, v78
    v_add_f32 v63, v63, v79
    v_mul_f32 v78, 0xbf6c835e, v72
    v_mul_f32 v79, 0xbec3ef15, v72
    v_fmac_f32 v78, 0x3ec3ef15, v73
    v_fmac_f32 v79, 0xbf6c835e, v73
    v_sub_f32 v72, v16, v24
    v_sub_f32 v73, v17, v25
    v_add_f32 v16, v16, v24
    v_add_f32 v17, v17, v25
    v_sub_f32 v24, v18, v26
    v_sub_f32 v25, v19, v27
    v_add_f32 v18, v18, v26
    v_add_f32 v19, v19, v27
    v_mul_f32 v26, 0x3f3504f3, v24
    v_mul_f32 v27, 0xbf3504f3, v24
    v_fmac_f32 v26, 0x3f3504f3, v25
    v_fmac_f32 v27, 0x3f3504f3, v25
    v_sub_f32 v24, v21, v29
    v_sub_f32 v25, v28, v20
    v_add_f32 v20, v20, v28
    v_add_f32 v21, v21, v29
    v_sub_f32 v28, v22, v30
    v_sub_f32 v29, v23, v31
    v_add_f32 v22, v22, v30
    v_add_f32 v23, v23, v31
    v_mul_f32 v30, 0xbf3504f3, v28
    v_mul_f32 v31, 0xbf3504f3, v28
    v_fmac_f32 v30, 0x3f3504f3, v29
    v_fmac_f32 v31, 0xbf3504f3, v29
    v_sub_f32 v28, v64, v32
    v_sub_f32 v29, v65, v33
    v_add_f32 v64, v64, v32
    v_add_f32 v65, v65, v33
    v_sub_f32 v32, v34, v42
    v_sub_f32 v33, v35, v43
    v_add_f32 v34, v34, v42
    v_add_f32 v35, v35, v43
    v_mul_f32 v42, 0x3f3504f3, v32
    v_mul_f32 v43, 0xbf3504f3, v32
    v_fmac_f32 v42, 0x3f3504f3, v33
    v_fmac_f32 v43, 0x3f3504f3, v33
    v_sub_f32 v32, v37, v45
    v_sub_f32 v33, v44, v36
    v_add_f32 v36, v36, v44
    v_add_f32 v37, v37, v45
    v_sub_f32 v44, v38, v46
    v_sub_f32 v45, v39, v47
    v_add_f32 v38, v38, v46
    v_add_f32 v39, v39, v47
    v_mul_f32 v46, 0xbf3504f3, v44
    v_mul_f32 v47, 0xbf3504f3, v44
    v_fmac_f32 v46, 0x3f3504f3, v45
    v_fmac_f32 v47, 0xbf3504f3, v45
    v_sub_f32 v44, v80, v56
    v_sub_f32 v45, v81, v57
    v_add_f32 v80, v80, v56
    v_add_f32 v81, v81, v57
    v_sub_f32 v56, v50, v58
    v_sub_f32 v57, v51, v59
    v_add_f32 v50, v50, v58
    v_add_f32 v51, v51, v59
    v_mul_f32 v58, 0x3f3504f3, v56
    v_mul_f32 v59, 0xbf3504f3, v56
    v_fmac_f32 v58, 0x3f3504f3, v57
    v_fmac_f32 v59, 0x3f3504f3, v57
    v_sub_f32 v56, v53, v61
    v_sub_f32 v57, v60, v52
    v_add_f32 v52, v52, v60
    v_add_f32 v53, v53, v61
    v_sub_f32 v60, v54, v62
    v_sub_f32 v61, v55, v63
    v_add_f32 v54, v54, v62
    v_add_f32 v55, v55, v63
    v_mul_f32 v62, 0xbf3504f3, v60
    v_mul_f32 v63, 0xbf3504f3, v60
    v_fmac_f32 v62, 0x3f3504f3, v61
    v_fmac_f32 v63, 0xbf3504f3, v61
    v_sub_f32 v60, v40, v48
    v_sub_f32 v61, v41, v49
    v_add_f32 v40, v40, v48
    v_add_f32 v41, v41, v49
    v_sub_f32 v48, v66, v74
    v_sub_f32 v49, v67, v75
    v_add_f32 v66, v66, v74
    v_add_f32 v67, v67, v75
    v_mul_f32 v74, 0x3f3504f3, v48
    v_mul_f32 v75, 0xbf3504f3, v48
    v_fmac_f32 v74, 0x3f3504f3, v49
    v_fmac_f32 v75, 0x3f3504f3, v49
    v_sub_f32 v48, v69, v77
    v_sub_f32 v49, v76, v68
    v_add_f32 v68, v68, v76
    v_add_f32 v69, v69, v77
    v_sub_f32 v76, v70, v78
    v_sub_f32 v77, v71, v79
    v_add_f32 v70, v70, v78
    v_add_f32 v71, v71, v79
    v_mul_f32 v78, 0xbf3504f3, v76
    v_mul_f32 v79, 0xbf3504f3, v76
    v_fmac_f32 v78, 0x3f3504f3, v77
    v_fmac_f32 v79, 0xbf3504f3, v77
    v_sub_f32 v76, v16, v20
    v_sub_f32 v77, v17, v21
    v_add_f32 v16, v16, v20
    v_add_f32 v17, v17, v21
    v_sub_f32 v20, v19, v23
    v_sub_f32 v21, v22, v18
    v_add_f32 v18, v18, v22
    v_add_f32 v19, v19, v23
    v_sub_f32 v22, v72, v24
    v_sub_f32 v23, v73, v25
    v_add_f32 v72, v72, v24
    v_add_f32 v73, v73, v25
    v_sub_f32 v24, v27, v31
    v_sub_f32 v25, v30, v26
    v_add_f32 v26, v26, v30
    v_add_f32 v27, v27, v31
    v_sub_f32 v30, v64, v36
    v_sub_f32 v31, v65, v37
    v_add_f32 v64, v64, v36
    v_add_f32 v65, v65, v37
    v_sub_f32 v36, v35, v39
    v_sub_f32 v37, v38, v34
    v_add_f32 v34, v34, v38
    v_add_f32 v35, v35, v39
    v_sub_f32 v38, v28, v32
    v_sub_f32 v39, v29, v33
    v_add_f32 v28, v28, v32
    v_add_f32 v29, v29, v33
    v_sub_f32 v32, v43, v47
    v_sub_f32 v33, v46, v42
    v_add_f32 v42, v42, v46
    v_add_f32 v43, v43, v47
    v_sub_f32 v46, v80, v52
    v_sub_f32 v47, v81, v53
    v_add_f32 v80, v80, v52
    v_add_f32 v81, v81, v53
    v_sub_f32 v52, v51, v55
    v_sub_f32 v53, v54, v50
    v_add_f32 v50, v50, v54
    v_add_f32 v51, v51, v55
    v_sub_f32 v54, v44, v56
    v_sub_f32 v55, v45, v57
    v_add_f32 v44, v44, v56
    v_add_f32 v45, v45, v57
    v_sub_f32 v56, v59, v63
    v_sub_f32 v57, v62, v58
    v_add_f32 v58, v58, v62
    v_add_f32 v59, v59, v63
    v_sub_f32 v62, v40, v68
    v_sub_f32 v63, v41, v69
    v_add_f32 v40, v40, v68
    v_add_f32 v41, v41, v69
    v_sub_f32 v68, v67, v71
    v_sub_f32 v69, v70, v66
    v_add_f32 v66, v66, v70
    v_add_f32 v67, v67, v71
    v_sub_f32 v70, v60, v48
    v_sub_f32 v71, v61, v49
    v_add_f32 v60, v60, v48
    v_add_f32 v61, v61, v49
    v_sub_f32 v48, v75, v79
    v_sub_f32 v49, v78, v74
    v_add_f32 v74, v74, v78
    v_add_f32 v75, v75, v79
    v_sub_f32 v78, v16, v18
    v_sub_f32 v79, v17, v19
    v_add_f32 v16, v16, v18
    v_add_f32 v17, v17, v19
    v_sub_f32 v18, v76, v20
    v_sub_f32 v19, v77, v21
    v_add_f32 v76, v76, v20
    v_add_f32 v77, v77, v21
    v_sub_f32 v20, v72, v26
    v_sub_f32 v21, v73, v27
    v_add_f32 v72, v72, v26
    v_add_f32 v73, v73, v27
    v_sub_f32 v26, v22, v24
    v_sub_f32 v27, v23, v25
    v_add_f32 v22, v22, v24
    v_add_f32 v23, v23, v25
    v_sub_f32 v24, v64, v34
    v_sub_f32 v25, v65, v35
    v_add_f32 v64, v64, v34
    v_add_f32 v65, v65, v35
    v_sub_f32 v34, v30, v36
    v_sub_f32 v35, v31, v37
    v_add_f32 v30, v30, v36
    v_add_f32 v31, v31, v37
    v_sub_f32 v36, v28, v42
    v_sub_f32 v37, v29, v43
    v_add_f32 v28, v28, v42
    v_add_f32 v29, v29, v43
    v_sub_f32 v42, v38, v32
    v_sub_f32 v43, v39, v33
    v_add_f32 v38, v38, v32
    v_add_f32 v39, v39, v33
    v_sub_f32 v32, v80, v50
    v_sub_f32 v33, v81, v51
    v_add_f32 v80, v80, v50
    v_add_f32 v81, v81, v51
    v_sub_f32 v50, v46, v52
    v_sub_f32 v51, v47, v53
    v_add_f32 v46, v46, v52
    v_add_f32 v47, v47, v53
    v_sub_f32 v52, v44, v58
    v_sub_f32 v53, v45, v59
    v_add_f32 v44, v44, v58
    v_add_f32 v45, v45, v59
    v_sub_f32 v58, v54, v56
    v_sub_f32 v59, v55, v57
    v_add_f32 v54, v54, v56
    v_add_f32 v55, v55, v57
    v_sub_f32 v56, v40, v66
    v_sub_f32 v57, v41, v67
    v_add_f32 v40, v40, v66
    v_add_f32 v41, v41, v67
    v_sub_f32 v66, v62, v68
    v_sub_f32 v67, v63, v69
    v_add_f32 v62, v62, v68
    v_add_f32 v63, v63, v69
    v_sub_f32 v68, v60, v74
    v_sub_f32 v69, v61, v75
    v_add_f32 v60, v60, v74
    v_add_f32 v61, v61, v75
    v_sub_f32 v74, v70, v48
    v_sub_f32 v75, v71, v49
    v_add_f32 v70, v70, v48
    v_add_f32 v71, v71, v49
    v_mul_f32 v48, 0xba000000, v2
    v_cos_f32 v49, v48
    v_sin_f32 v82, v48
    s_nop 0
    v_mul_f32 v83, v80, v49
    v_fma_f32 v83, -v81, v82, v83
    v_mul_f32 v81, v81, v49
    v_fmac_f32 v81, v80, v82
    v_mul_f32 v48, 0xba800000, v2
    v_cos_f32 v49, v48
    v_sin_f32 v82, v48
    s_nop 0
    v_mul_f32 v80, v64, v49
    v_fma_f32 v80, -v65, v82, v80
    v_mul_f32 v65, v65, v49
    v_fmac_f32 v65, v64, v82
    v_mul_f32 v48, 0xbac00000, v2
    v_cos_f32 v49, v48
    v_sin_f32 v82, v48
    s_nop 0
    v_mul_f32 v64, v40, v49
    v_fma_f32 v64, -v41, v82, v64
    v_mul_f32 v41, v41, v49
    v_fmac_f32 v41, v40, v82
    v_mul_f32 v48, 0xbb000000, v2
    v_cos_f32 v49, v48
    v_sin_f32 v82, v48
    s_nop 0
    v_mul_f32 v40, v72, v49
    v_fma_f32 v40, -v73, v82, v40
    v_mul_f32 v73, v73, v49
    v_fmac_f32 v73, v72, v82
    v_mul_f32 v48, 0xbb200000, v2
    v_cos_f32 v49, v48
    v_sin_f32 v82, v48
    s_nop 0
    v_mul_f32 v72, v44, v49
    v_fma_f32 v72, -v45, v82, v72
    v_mul_f32 v45, v45, v49
    v_fmac_f32 v45, v44, v82
    v_mul_f32 v48, 0xbb400000, v2
    v_cos_f32 v49, v48
    v_sin_f32 v82, v48
    s_nop 0
    v_mul_f32 v44, v28, v49
    v_fma_f32 v44, -v29, v82, v44
    v_mul_f32 v29, v29, v49
    v_fmac_f32 v29, v28, v82
    v_mul_f32 v48, 0xbb600000, v2
    v_cos_f32 v49, v48
    v_sin_f32 v82, v48
    s_nop 0
    v_mul_f32 v28, v60, v49
    v_fma_f32 v28, -v61, v82, v28
    v_mul_f32 v61, v61, v49
    v_fmac_f32 v61, v60, v82
    v_mul_f32 v48, 0xbb800000, v2
    v_cos_f32 v49, v48
    v_sin_f32 v82, v48
    s_nop 0
    v_mul_f32 v60, v76, v49
    v_fma_f32 v60, -v77, v82, v60
    v_mul_f32 v77, v77, v49
    v_fmac_f32 v77, v76, v82
    v_mul_f32 v48, 0xbb900000, v2
    v_cos_f32 v49, v48
    v_sin_f32 v82, v48
    s_nop 0
    v_mul_f32 v76, v46, v49
    v_fma_f32 v76, -v47, v82, v76
    v_mul_f32 v47, v47, v49
    v_fmac_f32 v47, v46, v82
    v_mul_f32 v48, 0xbba00000, v2
    v_cos_f32 v49, v48
    v_sin_f32 v82, v48
    s_nop 0
    v_mul_f32 v46, v30, v49
    v_fma_f32 v46, -v31, v82, v46
    v_mul_f32 v31, v31, v49
    v_fmac_f32 v31, v30, v82
    v_mul_f32 v48, 0xbbb00000, v2
    v_cos_f32 v49, v48
    v_sin_f32 v82, v48
    s_nop 0
    v_mul_f32 v30, v62, v49
    v_fma_f32 v30, -v63, v82, v30
    v_mul_f32 v63, v63, v49
    v_fmac_f32 v63, v62, v82
    v_mul_f32 v48, 0xbbc00000, v2
    v_cos_f32 v49, v48
    v_sin_f32 v82, v48
    s_nop 0
    v_mul_f32 v62, v22, v49
    v_fma_f32 v62, -v23, v82, v62
    v_mul_f32 v23, v23, v49
    v_fmac_f32 v23, v22, v82
    v_mul_f32 v48, 0xbbd00000, v2
    v_cos_f32 v49, v48
    v_sin_f32 v82, v48
    s_nop 0
    v_mul_f32 v22, v54, v49
    v_fma_f32 v22, -v55, v82, v22
    v_mul_f32 v55, v55, v49
    v_fmac_f32 v55, v54, v82
    v_mul_f32 v48, 0xbbe00000, v2
    v_cos_f32 v49, v48
    v_sin_f32 v82, v48
    s_nop 0
    v_mul_f32 v54, v38, v49
    v_fma_f32 v54, -v39, v82, v54
    v_mul_f32 v39, v39, v49
    v_fmac_f32 v39, v38, v82
    v_mul_f32 v48, 0xbbf00000, v2
    v_cos_f32 v49, v48
    v_sin_f32 v82, v48
    s_nop 0
    v_mul_f32 v38, v70, v49
    v_fma_f32 v38, -v71, v82, v38
    v_mul_f32 v71, v71, v49
    v_fmac_f32 v71, v70, v82
    v_mul_f32 v48, 0xbc000000, v2
    v_cos_f32 v49, v48
    v_sin_f32 v82, v48
    s_nop 0
    v_mul_f32 v70, v78, v49
    v_fma_f32 v70, -v79, v82, v70
    v_mul_f32 v79, v79, v49
    v_fmac_f32 v79, v78, v82
    v_mul_f32 v48, 0xbc080000, v2
    v_cos_f32 v49, v48
    v_sin_f32 v82, v48
    s_nop 0
    v_mul_f32 v78, v32, v49
    v_fma_f32 v78, -v33, v82, v78
    v_mul_f32 v33, v33, v49
    v_fmac_f32 v33, v32, v82
    v_mul_f32 v48, 0xbc100000, v2
    v_cos_f32 v49, v48
    v_sin_f32 v82, v48
    s_nop 0
    v_mul_f32 v32, v24, v49
    v_fma_f32 v32, -v25, v82, v32
    v_mul_f32 v25, v25, v49
    v_fmac_f32 v25, v24, v82
    v_mul_f32 v48, 0xbc180000, v2
    v_cos_f32 v49, v48
    v_sin_f32 v82, v48
    s_nop 0
    v_mul_f32 v24, v56, v49
    v_fma_f32 v24, -v57, v82, v24
    v_mul_f32 v57, v57, v49
    v_fmac_f32 v57, v56, v82
    v_mul_f32 v48, 0xbc200000, v2
    v_cos_f32 v49, v48
    v_sin_f32 v82, v48
    s_nop 0
    v_mul_f32 v56, v20, v49
    v_fma_f32 v56, -v21, v82, v56
    v_mul_f32 v21, v21, v49
    v_fmac_f32 v21, v20, v82
    v_mul_f32 v48, 0xbc280000, v2
    v_cos_f32 v49, v48
    v_sin_f32 v82, v48
    s_nop 0
    v_mul_f32 v20, v52, v49
    v_fma_f32 v20, -v53, v82, v20
    v_mul_f32 v53, v53, v49
    v_fmac_f32 v53, v52, v82
    v_mul_f32 v48, 0xbc300000, v2
    v_cos_f32 v49, v48
    v_sin_f32 v82, v48
    s_nop 0
    v_mul_f32 v52, v36, v49
    v_fma_f32 v52, -v37, v82, v52
    v_mul_f32 v37, v37, v49
    v_fmac_f32 v37, v36, v82
    v_mul_f32 v48, 0xbc380000, v2
    v_cos_f32 v49, v48
    v_sin_f32 v82, v48
    s_nop 0
    v_mul_f32 v36, v68, v49
    v_fma_f32 v36, -v69, v82, v36
    v_mul_f32 v69, v69, v49
    v_fmac_f32 v69, v68, v82
    v_mul_f32 v48, 0xbc400000, v2
    v_cos_f32 v49, v48
    v_sin_f32 v82, v48
    s_nop 0
    v_mul_f32 v68, v18, v49
    v_fma_f32 v68, -v19, v82, v68
    v_mul_f32 v19, v19, v49
    v_fmac_f32 v19, v18, v82
    v_mul_f32 v48, 0xbc480000, v2
    v_cos_f32 v49, v48
    v_sin_f32 v82, v48
    s_nop 0
    v_mul_f32 v18, v50, v49
    v_fma_f32 v18, -v51, v82, v18
    v_mul_f32 v51, v51, v49
    v_fmac_f32 v51, v50, v82
    v_mul_f32 v48, 0xbc500000, v2
    v_cos_f32 v49, v48
    v_sin_f32 v82, v48
    s_nop 0
    v_mul_f32 v50, v34, v49
    v_fma_f32 v50, -v35, v82, v50
    v_mul_f32 v35, v35, v49
    v_fmac_f32 v35, v34, v82
    v_mul_f32 v48, 0xbc580000, v2
    v_cos_f32 v49, v48
    v_sin_f32 v82, v48
    s_nop 0
    v_mul_f32 v34, v66, v49
    v_fma_f32 v34, -v67, v82, v34
    v_mul_f32 v67, v67, v49
    v_fmac_f32 v67, v66, v82
    v_mul_f32 v48, 0xbc600000, v2
    v_cos_f32 v49, v48
    v_sin_f32 v82, v48
    s_nop 0
    v_mul_f32 v66, v26, v49
    v_fma_f32 v66, -v27, v82, v66
    v_mul_f32 v27, v27, v49
    v_fmac_f32 v27, v26, v82
    v_mul_f32 v48, 0xbc680000, v2
    v_cos_f32 v49, v48
    v_sin_f32 v82, v48
    s_nop 0
    v_mul_f32 v26, v58, v49
    v_fma_f32 v26, -v59, v82, v26
    v_mul_f32 v59, v59, v49
    v_fmac_f32 v59, v58, v82
    v_mul_f32 v48, 0xbc700000, v2
    v_cos_f32 v49, v48
    v_sin_f32 v82, v48
    s_nop 0
    v_mul_f32 v58, v42, v49
    v_fma_f32 v58, -v43, v82, v58
    v_mul_f32 v43, v43, v49
    v_fmac_f32 v43, v42, v82
    v_mul_f32 v48, 0xbc780000, v2
    v_cos_f32 v49, v48
    v_sin_f32 v82, v48
    s_nop 0
    v_mul_f32 v42, v74, v49
    v_fma_f32 v42, -v75, v82, v42
    v_mul_f32 v75, v75, v49
    v_fmac_f32 v75, v74, v82
    ds_write_b32 v3, v16 offset:0
    ds_write_b32 v3, v17 offset:4
    ds_write_b32 v3, v83 offset:528
    ds_write_b32 v3, v81 offset:532
    ds_write_b32 v3, v80 offset:1056
    ds_write_b32 v3, v65 offset:1060
    ds_write_b32 v3, v64 offset:1584
    ds_write_b32 v3, v41 offset:1588
    ds_write_b32 v3, v40 offset:2112
    ds_write_b32 v3, v73 offset:2116
    ds_write_b32 v3, v72 offset:2640
    ds_write_b32 v3, v45 offset:2644
    ds_write_b32 v3, v44 offset:3168
    ds_write_b32 v3, v29 offset:3172
    ds_write_b32 v3, v28 offset:3696
    ds_write_b32 v3, v61 offset:3700
    ds_write_b32 v3, v60 offset:4224
    ds_write_b32 v3, v77 offset:4228
    ds_write_b32 v3, v76 offset:4752
    ds_write_b32 v3, v47 offset:4756
    ds_write_b32 v3, v46 offset:5280
    ds_write_b32 v3, v31 offset:5284
    ds_write_b32 v3, v30 offset:5808
    ds_write_b32 v3, v63 offset:5812
    ds_write_b32 v3, v62 offset:6336
    ds_write_b32 v3, v23 offset:6340
    ds_write_b32 v3, v22 offset:6864
    ds_write_b32 v3, v55 offset:6868
    ds_write_b32 v3, v54 offset:7392
    ds_write_b32 v3, v39 offset:7396
    ds_write_b32 v3, v38 offset:7920
    ds_write_b32 v3, v71 offset:7924
    ds_write_b32 v3, v70 offset:8448
    ds_write_b32 v3, v79 offset:8452
    ds_write_b32 v3, v78 offset:8976
    ds_write_b32 v3, v33 offset:8980
    ds_write_b32 v3, v32 offset:9504
    ds_write_b32 v3, v25 offset:9508
    ds_write_b32 v3, v24 offset:10032
    ds_write_b32 v3, v57 offset:10036
    ds_write_b32 v3, v56 offset:10560
    ds_write_b32 v3, v21 offset:10564
    ds_write_b32 v3, v20 offset:11088
    ds_write_b32 v3, v53 offset:11092
    ds_write_b32 v3, v52 offset:11616
    ds_write_b32 v3, v37 offset:11620
    ds_write_b32 v3, v36 offset:12144
    ds_write_b32 v3, v69 offset:12148
    ds_write_b32 v3, v68 offset:12672
    ds_write_b32 v3, v19 offset:12676
    ds_write_b32 v3, v18 offset:13200
    ds_write_b32 v3, v51 offset:13204
    ds_write_b32 v3, v50 offset:13728
    ds_write_b32 v3, v35 offset:13732
    ds_write_b32 v3, v34 offset:14256
    ds_write_b32 v3, v67 offset:14260
    ds_write_b32 v3, v66 offset:14784
    ds_write_b32 v3, v27 offset:14788
    ds_write_b32 v3, v26 offset:15312
    ds_write_b32 v3, v59 offset:15316
    ds_write_b32 v3, v58 offset:15840
    ds_write_b32 v3, v43 offset:15844
    ds_write_b32 v3, v42 offset:16368
    ds_write_b32 v3, v75 offset:16372
    s_waitcnt lgkmcnt(0)
    ds_read_b32 v16, v4 offset:0
    ds_read_b32 v17, v4 offset:4
    ds_read_b32 v83, v4 offset:16
    ds_read_b32 v81, v4 offset:20
    ds_read_b32 v80, v4 offset:32
    ds_read_b32 v65, v4 offset:36
    ds_read_b32 v64, v4 offset:48
    ds_read_b32 v41, v4 offset:52
    ds_read_b32 v40, v4 offset:64
    ds_read_b32 v73, v4 offset:68
    ds_read_b32 v72, v4 offset:80
    ds_read_b32 v45, v4 offset:84
    ds_read_b32 v44, v4 offset:96
    ds_read_b32 v29, v4 offset:100
    s_waitcnt lgkmcnt(0)
    ds_read_b32 v28, v4 offset:112
    ds_read_b32 v61, v4 offset:116
    ds_read_b32 v60, v4 offset:128
    ds_read_b32 v77, v4 offset:132
    ds_read_b32 v76, v4 offset:144
    ds_read_b32 v47, v4 offset:148
    ds_read_b32 v46, v4 offset:160
    ds_read_b32 v31, v4 offset:164
    ds_read_b32 v30, v4 offset:176
    ds_read_b32 v63, v4 offset:180
    ds_read_b32 v62, v4 offset:192
    ds_read_b32 v23, v4 offset:196
    ds_read_b32 v22, v4 offset:208
    ds_read_b32 v55, v4 offset:212
    s_waitcnt lgkmcnt(0)
    ds_read_b32 v54, v4 offset:224
    ds_read_b32 v39, v4 offset:228
    ds_read_b32 v38, v4 offset:240
    ds_read_b32 v71, v4 offset:244
    ds_read_b32 v70, v4 offset:256
    ds_read_b32 v79, v4 offset:260
    ds_read_b32 v78, v4 offset:272
    ds_read_b32 v33, v4 offset:276
    ds_read_b32 v32, v4 offset:288
    ds_read_b32 v25, v4 offset:292
    ds_read_b32 v24, v4 offset:304
    ds_read_b32 v57, v4 offset:308
    ds_read_b32 v56, v4 offset:320
    ds_read_b32 v21, v4 offset:324
    s_waitcnt lgkmcnt(0)
    ds_read_b32 v20, v4 offset:336
    ds_read_b32 v53, v4 offset:340
    ds_read_b32 v52, v4 offset:352
    ds_read_b32 v37, v4 offset:356
    ds_read_b32 v36, v4 offset:368
    ds_read_b32 v69, v4 offset:372
    ds_read_b32 v68, v4 offset:384
    ds_read_b32 v19, v4 offset:388
    ds_read_b32 v18, v4 offset:400
    ds_read_b32 v51, v4 offset:404
    ds_read_b32 v50, v4 offset:416
    ds_read_b32 v35, v4 offset:420
    ds_read_b32 v34, v4 offset:432
    ds_read_b32 v67, v4 offset:436
    s_waitcnt lgkmcnt(0)
    ds_read_b32 v66, v4 offset:448
    ds_read_b32 v27, v4 offset:452
    ds_read_b32 v26, v4 offset:464
    ds_read_b32 v59, v4 offset:468
    ds_read_b32 v58, v4 offset:480
    ds_read_b32 v43, v4 offset:484
    ds_read_b32 v42, v4 offset:496
    ds_read_b32 v75, v4 offset:500
    s_waitcnt lgkmcnt(0)
    buffer_load_dword v88, v11, s[8:11], s19 offen offset:0
    buffer_load_dword v89, v11, s[8:11], s19 offen offset:128
    buffer_load_dword v90, v11, s[8:11], s19 offen offset:256
    buffer_load_dword v91, v11, s[8:11], s19 offen offset:384
    buffer_load_dword v92, v11, s[8:11], s19 offen offset:512
    buffer_load_dword v93, v11, s[8:11], s19 offen offset:640
    buffer_load_dword v94, v11, s[8:11], s19 offen offset:768
    buffer_load_dword v95, v11, s[8:11], s19 offen offset:896
    buffer_load_dword v96, v11, s[8:11], s19 offen offset:1024
    buffer_load_dword v97, v11, s[8:11], s19 offen offset:1152
    buffer_load_dword v98, v11, s[8:11], s19 offen offset:1280
    buffer_load_dword v99, v11, s[8:11], s19 offen offset:1408
    buffer_load_dword v100, v11, s[8:11], s19 offen offset:1536
    buffer_load_dword v101, v11, s[8:11], s19 offen offset:1664
    buffer_load_dword v102, v11, s[8:11], s19 offen offset:1792
    buffer_load_dword v103, v11, s[8:11], s19 offen offset:1920
    buffer_load_dword v104, v11, s[8:11], s19 offen offset:2048
    buffer_load_dword v105, v11, s[8:11], s19 offen offset:2176
    buffer_load_dword v106, v11, s[8:11], s19 offen offset:2304
    buffer_load_dword v107, v11, s[8:11], s19 offen offset:2432
    buffer_load_dword v108, v11, s[8:11], s19 offen offset:2560
    buffer_load_dword v109, v11, s[8:11], s19 offen offset:2688
    buffer_load_dword v110, v11, s[8:11], s19 offen offset:2816
    buffer_load_dword v111, v11, s[8:11], s19 offen offset:2944
    buffer_load_dword v112, v11, s[8:11], s19 offen offset:3072
    buffer_load_dword v113, v11, s[8:11], s19 offen offset:3200
    buffer_load_dword v114, v11, s[8:11], s19 offen offset:3328
    buffer_load_dword v115, v11, s[8:11], s19 offen offset:3456
    buffer_load_dword v116, v11, s[8:11], s19 offen offset:3584
    buffer_load_dword v117, v11, s[8:11], s19 offen offset:3712
    buffer_load_dword v118, v11, s[8:11], s19 offen offset:3840
    buffer_load_dword v119, v11, s[8:11], s19 offen offset:3968
    v_sub_f32 v48, v16, v70
    v_sub_f32 v49, v17, v79
    v_add_f32 v16, v16, v70
    v_add_f32 v17, v17, v79
    v_sub_f32 v70, v83, v78
    v_sub_f32 v79, v81, v33
    v_add_f32 v83, v83, v78
    v_add_f32 v81, v81, v33
    v_mul_f32 v78, 0x3f7b14be, v70
    v_mul_f32 v33, 0xbe47c5c2, v70
    v_fmac_f32 v78, 0x3e47c5c2, v79
    v_fmac_f32 v33, 0x3f7b14be, v79
    v_sub_f32 v70, v80, v32
    v_sub_f32 v79, v65, v25
    v_add_f32 v80, v80, v32
    v_add_f32 v65, v65, v25
    v_mul_f32 v32, 0x3f6c835e, v70
    v_mul_f32 v25, 0xbec3ef15, v70
    v_fmac_f32 v32, 0x3ec3ef15, v79
    v_fmac_f32 v25, 0x3f6c835e, v79
    v_sub_f32 v70, v64, v24
    v_sub_f32 v79, v41, v57
    v_add_f32 v64, v64, v24
    v_add_f32 v41, v41, v57
    v_mul_f32 v24, 0x3f54db31, v70
    v_mul_f32 v57, 0xbf0e39da, v70
    v_fmac_f32 v24, 0x3f0e39da, v79
    v_fmac_f32 v57, 0x3f54db31, v79
    v_sub_f32 v70, v40, v56
    v_sub_f32 v79, v73, v21
    v_add_f32 v40, v40, v56
    v_add_f32 v73, v73, v21
    v_mul_f32 v56, 0x3f3504f3, v70
    v_mul_f32 v21, 0xbf3504f3, v70
    v_fmac_f32 v56, 0x3f3504f3, v79
    v_fmac_f32 v21, 0x3f3504f3, v79
    v_sub_f32 v70, v72, v20
    v_sub_f32 v79, v45, v53
    v_add_f32 v72, v72, v20
    v_add_f32 v45, v45, v53
    v_mul_f32 v20, 0x3f0e39da, v70
    v_mul_f32 v53, 0xbf54db31, v70
    v_fmac_f32 v20, 0x3f54db31, v79
    v_fmac_f32 v53, 0x3f0e39da, v79
    v_sub_f32 v70, v44, v52
    v_sub_f32 v79, v29, v37
    v_add_f32 v44, v44, v52
    v_add_f32 v29, v29, v37
    v_mul_f32 v52, 0x3ec3ef15, v70
    v_mul_f32 v37, 0xbf6c835e, v70
    v_fmac_f32 v52, 0x3f6c835e, v79
    v_fmac_f32 v37, 0x3ec3ef15, v79
    v_sub_f32 v70, v28, v36
    v_sub_f32 v79, v61, v69
    v_add_f32 v28, v28, v36
    v_add_f32 v61, v61, v69
    v_mul_f32 v36, 0x3e47c5c2, v70
    v_mul_f32 v69, 0xbf7b14be, v70
    v_fmac_f32 v36, 0x3f7b14be, v79
    v_fmac_f32 v69, 0x3e47c5c2, v79
    v_sub_f32 v70, v77, v19
    v_sub_f32 v79, v68, v60
    v_add_f32 v60, v60, v68
    v_add_f32 v77, v77, v19
    v_sub_f32 v68, v76, v18
    v_sub_f32 v19, v47, v51
    v_add_f32 v76, v76, v18
    v_add_f32 v47, v47, v51
    v_mul_f32 v18, 0xbe47c5c2, v68
    v_mul_f32 v51, 0xbf7b14be, v68
    v_fmac_f32 v18, 0x3f7b14be, v19
    v_fmac_f32 v51, 0xbe47c5c2, v19
    v_sub_f32 v68, v46, v50
    v_sub_f32 v19, v31, v35
    v_add_f32 v46, v46, v50
    v_add_f32 v31, v31, v35
    v_mul_f32 v50, 0xbec3ef15, v68
    v_mul_f32 v35, 0xbf6c835e, v68
    v_fmac_f32 v50, 0x3f6c835e, v19
    v_fmac_f32 v35, 0xbec3ef15, v19
    v_sub_f32 v68, v30, v34
    v_sub_f32 v19, v63, v67
    v_add_f32 v30, v30, v34
    v_add_f32 v63, v63, v67
    v_mul_f32 v34, 0xbf0e39da, v68
    v_mul_f32 v67, 0xbf54db31, v68
    v_fmac_f32 v34, 0x3f54db31, v19
    v_fmac_f32 v67, 0xbf0e39da, v19
    v_sub_f32 v68, v62, v66
    v_sub_f32 v19, v23, v27
    v_add_f32 v62, v62, v66
    v_add_f32 v23, v23, v27
    v_mul_f32 v66, 0xbf3504f3, v68
    v_mul_f32 v27, 0xbf3504f3, v68
    v_fmac_f32 v66, 0x3f3504f3, v19
    v_fmac_f32 v27, 0xbf3504f3, v19
    v_sub_f32 v68, v22, v26
    v_sub_f32 v19, v55, v59
    v_add_f32 v22, v22, v26
    v_add_f32 v55, v55, v59
    v_mul_f32 v26, 0xbf54db31, v68
    v_mul_f32 v59, 0xbf0e39da, v68
    v_fmac_f32 v26, 0x3f0e39da, v19
    v_fmac_f32 v59, 0xbf54db31, v19
    v_sub_f32 v68, v54, v58
    v_sub_f32 v19, v39, v43
    v_add_f32 v54, v54, v58
    v_add_f32 v39, v39, v43
    v_mul_f32 v58, 0xbf6c835e, v68
    v_mul_f32 v43, 0xbec3ef15, v68
    v_fmac_f32 v58, 0x3ec3ef15, v19
    v_fmac_f32 v43, 0xbf6c835e, v19
    v_sub_f32 v68, v38, v42
    v_sub_f32 v19, v71, v75
    v_add_f32 v38, v38, v42
    v_add_f32 v71, v71, v75
    v_mul_f32 v42, 0xbf7b14be, v68
    v_mul_f32 v75, 0xbe47c5c2, v68
    v_fmac_f32 v42, 0x3e47c5c2, v19
    v_fmac_f32 v75, 0xbf7b14be, v19
    v_sub_f32 v68, v16, v60
    v_sub_f32 v19, v17, v77
    v_add_f32 v16, v16, v60
    v_add_f32 v17, v17, v77
    v_sub_f32 v60, v83, v76
    v_sub_f32 v77, v81, v47
    v_add_f32 v83, v83, v76
    v_add_f32 v81, v81, v47
    v_mul_f32 v76, 0x3f6c835e, v60
    v_mul_f32 v47, 0xbec3ef15, v60
    v_fmac_f32 v76, 0x3ec3ef15, v77
    v_fmac_f32 v47, 0x3f6c835e, v77
    v_sub_f32 v60, v80, v46
    v_sub_f32 v77, v65, v31
    v_add_f32 v80, v80, v46
    v_add_f32 v65, v65, v31
    v_mul_f32 v46, 0x3f3504f3, v60
    v_mul_f32 v31, 0xbf3504f3, v60
    v_fmac_f32 v46, 0x3f3504f3, v77
    v_fmac_f32 v31, 0x3f3504f3, v77
    v_sub_f32 v60, v64, v30
    v_sub_f32 v77, v41, v63
    v_add_f32 v64, v64, v30
    v_add_f32 v41, v41, v63
    v_mul_f32 v30, 0x3ec3ef15, v60
    v_mul_f32 v63, 0xbf6c835e, v60
    v_fmac_f32 v30, 0x3f6c835e, v77
    v_fmac_f32 v63, 0x3ec3ef15, v77
    v_sub_f32 v60, v73, v23
    v_sub_f32 v77, v62, v40
    v_add_f32 v40, v40, v62
    v_add_f32 v73, v73, v23
    v_sub_f32 v62, v72, v22
    v_sub_f32 v23, v45, v55
    v_add_f32 v72, v72, v22
    v_add_f32 v45, v45, v55
    v_mul_f32 v22, 0xbec3ef15, v62
    v_mul_f32 v55, 0xbf6c835e, v62
    v_fmac_f32 v22, 0x3f6c835e, v23
    v_fmac_f32 v55, 0xbec3ef15, v23
    v_sub_f32 v62, v44, v54
    v_sub_f32 v23, v29, v39
    v_add_f32 v44, v44, v54
    v_add_f32 v29, v29, v39
    v_mul_f32 v54, 0xbf3504f3, v62
    v_mul_f32 v39, 0xbf3504f3, v62
    v_fmac_f32 v54, 0x3f3504f3, v23
    v_fmac_f32 v39, 0xbf3504f3, v23
    v_sub_f32 v62, v28, v38
    v_sub_f32 v23, v61, v71
    v_add_f32 v28, v28, v38
    v_add_f32 v61, v61, v71
    v_mul_f32 v38, 0xbf6c835e, v62
    v_mul_f32 v71, 0xbec3ef15, v62
    v_fmac_f32 v38, 0x3ec3ef15, v23
    v_fmac_f32 v71, 0xbf6c835e, v23
    v_sub_f32 v62, v48, v70
    v_sub_f32 v23, v49, v79
    v_add_f32 v48, v48, v70
    v_add_f32 v49, v49, v79
    v_sub_f32 v70, v78, v18
    v_sub_f32 v79, v33, v51
    v_add_f32 v78, v78, v18
    v_add_f32 v33, v33, v51
    v_mul_f32 v18, 0x3f6c835e, v70
    v_mul_f32 v51, 0xbec3ef15, v70
    v_fmac_f32 v18, 0x3ec3ef15, v79
    v_fmac_f32 v51, 0x3f6c835e, v79
    v_sub_f32 v70, v32, v50
    v_sub_f32 v79, v25, v35
    v_add_f32 v32, v32, v50
    v_add_f32 v25, v25, v35
    v_mul_f32 v50, 0x3f3504f3, v70
    v_mul_f32 v35, 0xbf3504f3, v70
    v_fmac_f32 v50, 0x3f3504f3, v79
    v_fmac_f32 v35, 0x3f3504f3, v79
    v_sub_f32 v70, v24, v34
    v_sub_f32 v79, v57, v67
    v_add_f32 v24, v24, v34
    v_add_f32 v57, v57, v67
    v_mul_f32 v34, 0x3ec3ef15, v70
    v_mul_f32 v67, 0xbf6c835e, v70
    v_fmac_f32 v34, 0x3f6c835e, v79
    v_fmac_f32 v67, 0x3ec3ef15, v79
    v_sub_f32 v70, v21, v27
    v_sub_f32 v79, v66, v56
    v_add_f32 v56, v56, v66
    v_add_f32 v21, v21, v27
    v_sub_f32 v66, v20, v26
    v_sub_f32 v27, v53, v59
    v_add_f32 v20, v20, v26
    v_add_f32 v53, v53, v59
    v_mul_f32 v26, 0xbec3ef15, v66
    v_mul_f32 v59, 0xbf6c835e, v66
    v_fmac_f32 v26, 0x3f6c835e, v27
    v_fmac_f32 v59, 0xbec3ef15, v27
    v_sub_f32 v66, v52, v58
    v_sub_f32 v27, v37, v43
    v_add_f32 v52, v52, v58
    v_add_f32 v37, v37, v43
    v_mul_f32 v58, 0xbf3504f3, v66
    v_mul_f32 v43, 0xbf3504f3, v66
    v_fmac_f32 v58, 0x3f3504f3, v27
    v_fmac_f32 v43, 0xbf3504f3, v27
    v_sub_f32 v66, v36, v42
    v_sub_f32 v27, v69, v75
    v_add_f32 v36, v36, v42
    v_add_f32 v69, v69, v75
    v_mul_f32 v42, 0xbf6c835e, v66
    v_mul_f32 v75, 0xbec3ef15, v66
    v_fmac_f32 v42, 0x3ec3ef15, v27
    v_fmac_f32 v75, 0xbf6c835e, v27
    v_sub_f32 v66, v16, v40
    v_sub_f32 v27, v17, v73
    v_add_f32 v16, v16, v40
    v_add_f32 v17, v17, v73
    v_sub_f32 v40, v83, v72
    v_sub_f32 v73, v81, v45
    v_add_f32 v83, v83, v72
    v_add_f32 v81, v81, v45
    v_mul_f32 v72, 0x3f3504f3, v40
    v_mul_f32 v45, 0xbf3504f3, v40
    v_fmac_f32 v72, 0x3f3504f3, v73
    v_fmac_f32 v45, 0x3f3504f3, v73
    v_sub_f32 v40, v65, v29
    v_sub_f32 v73, v44, v80
    v_add_f32 v80, v80, v44
    v_add_f32 v65, v65, v29
    v_sub_f32 v44, v64, v28
    v_sub_f32 v29, v41, v61
    v_add_f32 v64, v64, v28
    v_add_f32 v41, v41, v61
    v_mul_f32 v28, 0xbf3504f3, v44
    v_mul_f32 v61, 0xbf3504f3, v44
    v_fmac_f32 v28, 0x3f3504f3, v29
    v_fmac_f32 v61, 0xbf3504f3, v29
    v_sub_f32 v44, v68, v60
    v_sub_f32 v29, v19, v77
    v_add_f32 v68, v68, v60
    v_add_f32 v19, v19, v77
    v_sub_f32 v60, v76, v22
    v_sub_f32 v77, v47, v55
    v_add_f32 v76, v76, v22
    v_add_f32 v47, v47, v55
    v_mul_f32 v22, 0x3f3504f3, v60
    v_mul_f32 v55, 0xbf3504f3, v60
    v_fmac_f32 v22, 0x3f3504f3, v77
    v_fmac_f32 v55, 0x3f3504f3, v77
    v_sub_f32 v60, v31, v39
    v_sub_f32 v77, v54, v46
    v_add_f32 v46, v46, v54
    v_add_f32 v31, v31, v39
    v_sub_f32 v54, v30, v38
    v_sub_f32 v39, v63, v71
    v_add_f32 v30, v30, v38
    v_add_f32 v63, v63, v71
    v_mul_f32 v38, 0xbf3504f3, v54
    v_mul_f32 v71, 0xbf3504f3, v54
    v_fmac_f32 v38, 0x3f3504f3, v39
    v_fmac_f32 v71, 0xbf3504f3, v39
    v_sub_f32 v54, v48, v56
    v_sub_f32 v39, v49, v21
    v_add_f32 v48, v48, v56
    v_add_f32 v49, v49, v21
    v_sub_f32 v56, v78, v20
    v_sub_f32 v21, v33, v53
    v_add_f32 v78, v78, v20
    v_add_f32 v33, v33, v53
    v_mul_f32 v20, 0x3f3504f3, v56
    v_mul_f32 v53, 0xbf3504f3, v56
    v_fmac_f32 v20, 0x3f3504f3, v21
    v_fmac_f32 v53, 0x3f3504f3, v21
    v_sub_f32 v56, v25, v37
    v_sub_f32 v21, v52, v32
    v_add_f32 v32, v32, v52
    v_add_f32 v25, v25, v37
    v_sub_f32 v52, v24, v36
    v_sub_f32 v37, v57, v69
    v_add_f32 v24, v24, v36
    v_add_f32 v57, v57, v69
    v_mul_f32 v36, 0xbf3504f3, v52
    v_mul_f32 v69, 0xbf3504f3, v52
    v_fmac_f32 v36, 0x3f3504f3, v37
    v_fmac_f32 v69, 0xbf3504f3, v37
    v_sub_f32 v52, v62, v70
    v_sub_f32 v37, v23, v79
    v_add_f32 v62, v62, v70
    v_add_f32 v23, v23, v79
    v_sub_f32 v70, v18, v26
    v_sub_f32 v79, v51, v59
    v_add_f32 v18, v18, v26
    v_add_f32 v51, v51, v59
    v_mul_f32 v26, 0x3f3504f3, v70
    v_mul_f32 v59, 0xbf3504f3, v70
    v_fmac_f32 v26, 0x3f3504f3, v79
    v_fmac_f32 v59, 0x3f3504f3, v79
    v_sub_f32 v70, v35, v43
    v_sub_f32 v79, v58, v50
    v_add_f32 v50, v50, v58
    v_add_f32 v35, v35, v43
    v_sub_f32 v58, v34, v42
    v_sub_f32 v43, v67, v75
    v_add_f32 v34, v34, v42
    v_add_f32 v67, v67, v75
    v_mul_f32 v42, 0xbf3504f3, v58
    v_mul_f32 v75, 0xbf3504f3, v58
    v_fmac_f32 v42, 0x3f3504f3, v43
    v_fmac_f32 v75, 0xbf3504f3, v43
    v_sub_f32 v58, v16, v80
    v_sub_f32 v43, v17, v65
    v_add_f32 v16, v16, v80
    v_add_f32 v17, v17, v65
    v_sub_f32 v80, v81, v41
    v_sub_f32 v65, v64, v83
    v_add_f32 v83, v83, v64
    v_add_f32 v81, v81, v41
    v_sub_f32 v64, v66, v40
    v_sub_f32 v41, v27, v73
    v_add_f32 v66, v66, v40
    v_add_f32 v27, v27, v73
    v_sub_f32 v40, v45, v61
    v_sub_f32 v73, v28, v72
    v_add_f32 v72, v72, v28
    v_add_f32 v45, v45, v61
    v_sub_f32 v28, v68, v46
    v_sub_f32 v61, v19, v31
    v_add_f32 v68, v68, v46
    v_add_f32 v19, v19, v31
    v_sub_f32 v46, v47, v63
    v_sub_f32 v31, v30, v76
    v_add_f32 v76, v76, v30
    v_add_f32 v47, v47, v63
    v_sub_f32 v30, v44, v60
    v_sub_f32 v63, v29, v77
    v_add_f32 v44, v44, v60
    v_add_f32 v29, v29, v77
    v_sub_f32 v60, v55, v71
    v_sub_f32 v77, v38, v22
    v_add_f32 v22, v22, v38
    v_add_f32 v55, v55, v71
    v_sub_f32 v38, v48, v32
    v_sub_f32 v71, v49, v25
    v_add_f32 v48, v48, v32
    v_add_f32 v49, v49, v25
    v_sub_f32 v32, v33, v57
    v_sub_f32 v25, v24, v78
    v_add_f32 v78, v78, v24
    v_add_f32 v33, v33, v57
    v_sub_f32 v24, v54, v56
    v_sub_f32 v57, v39, v21
    v_add_f32 v54, v54, v56
    v_add_f32 v39, v39, v21
    v_sub_f32 v56, v53, v69
    v_sub_f32 v21, v36, v20
    v_add_f32 v20, v20, v36
    v_add_f32 v53, v53, v69
    v_sub_f32 v36, v62, v50
    v_sub_f32 v69, v23, v35
    v_add_f32 v62, v62, v50
    v_add_f32 v23, v23, v35
    v_sub_f32 v50, v51, v67
    v_sub_f32 v35, v34, v18
    v_add_f32 v18, v18, v34
    v_add_f32 v51, v51, v67
    v_sub_f32 v34, v52, v70
    v_sub_f32 v67, v37, v79
    v_add_f32 v52, v52, v70
    v_add_f32 v37, v37, v79
    v_sub_f32 v70, v59, v75
    v_sub_f32 v79, v42, v26
    v_add_f32 v26, v26, v42
    v_add_f32 v59, v59, v75
    v_sub_f32 v42, v16, v83
    v_sub_f32 v75, v17, v81
    v_add_f32 v16, v16, v83
    v_add_f32 v17, v17, v81
    v_sub_f32 v83, v58, v80
    v_sub_f32 v81, v43, v65
    v_add_f32 v58, v58, v80
    v_add_f32 v43, v43, v65
    v_sub_f32 v80, v66, v72
    v_sub_f32 v65, v27, v45
    v_add_f32 v66, v66, v72
    v_add_f32 v27, v27, v45
    v_sub_f32 v72, v64, v40
    v_sub_f32 v45, v41, v73
    v_add_f32 v64, v64, v40
    v_add_f32 v41, v41, v73
    v_sub_f32 v40, v68, v76
    v_sub_f32 v73, v19, v47
    v_add_f32 v68, v68, v76
    v_add_f32 v19, v19, v47
    v_sub_f32 v76, v28, v46
    v_sub_f32 v47, v61, v31
    v_add_f32 v28, v28, v46
    v_add_f32 v61, v61, v31
    v_sub_f32 v46, v44, v22
    v_sub_f32 v31, v29, v55
    v_add_f32 v44, v44, v22
    v_add_f32 v29, v29, v55
    v_sub_f32 v22, v30, v60
    v_sub_f32 v55, v63, v77
    v_add_f32 v30, v30, v60
    v_add_f32 v63, v63, v77
    v_sub_f32 v60, v48, v78
    v_sub_f32 v77, v49, v33
    v_add_f32 v48, v48, v78
    v_add_f32 v49, v49, v33
    v_sub_f32 v78, v38, v32
    v_sub_f32 v33, v71, v25
    v_add_f32 v38, v38, v32
    v_add_f32 v71, v71, v25
    v_sub_f32 v32, v54, v20
    v_sub_f32 v25, v39, v53
    v_add_f32 v54, v54, v20
    v_add_f32 v39, v39, v53
    v_sub_f32 v20, v24, v56
    v_sub_f32 v53, v57, v21
    v_add_f32 v24, v24, v56
    v_add_f32 v57, v57, v21
    v_sub_f32 v56, v62, v18
    v_sub_f32 v21, v23, v51
    v_add_f32 v62, v62, v18
    v_add_f32 v23, v23, v51
    v_sub_f32 v18, v36, v50
    v_sub_f32 v51, v69, v35
    v_add_f32 v36, v36, v50
    v_add_f32 v69, v69, v35
    v_sub_f32 v50, v52, v26
    v_sub_f32 v35, v37, v59
    v_add_f32 v52, v52, v26
    v_add_f32 v37, v37, v59
    v_sub_f32 v26, v34, v70
    v_sub_f32 v59, v67, v79
    v_add_f32 v34, v34, v70
    v_add_f32 v67, v67, v79
    v_mul_f32 v70, 0xbc800000, v10
    v_cos_f32 v79, v70
    v_sin_f32 v82, v70
    s_nop 0
    v_mul_f32 v74, v48, v79
    v_fma_f32 v74, -v49, v82, v74
    v_mul_f32 v49, v49, v79
    v_fmac_f32 v49, v48, v82
    v_mul_f32 v70, 0xbd000000, v10
    v_cos_f32 v79, v70
    v_sin_f32 v82, v70
    s_nop 0
    v_mul_f32 v48, v68, v79
    v_fma_f32 v48, -v19, v82, v48
    v_mul_f32 v19, v19, v79
    v_fmac_f32 v19, v68, v82
    v_mul_f32 v70, 0xbd400000, v10
    v_cos_f32 v79, v70
    v_sin_f32 v82, v70
    s_nop 0
    v_mul_f32 v68, v62, v79
    v_fma_f32 v68, -v23, v82, v68
    v_mul_f32 v23, v23, v79
    v_fmac_f32 v23, v62, v82
    v_mul_f32 v70, 0xbd800000, v10
    v_cos_f32 v79, v70
    v_sin_f32 v82, v70
    s_nop 0
    v_mul_f32 v62, v66, v79
    v_fma_f32 v62, -v27, v82, v62
    v_mul_f32 v27, v27, v79
    v_fmac_f32 v27, v66, v82
    v_mul_f32 v70, 0xbda00000, v10
    v_cos_f32 v79, v70
    v_sin_f32 v82, v70
    s_nop 0
    v_mul_f32 v66, v54, v79
    v_fma_f32 v66, -v39, v82, v66
    v_mul_f32 v39, v39, v79
    v_fmac_f32 v39, v54, v82
    v_mul_f32 v70, 0xbdc00000, v10
    v_cos_f32 v79, v70
    v_sin_f32 v82, v70
    s_nop 0
    v_mul_f32 v54, v44, v79
    v_fma_f32 v54, -v29, v82, v54
    v_mul_f32 v29, v29, v79
    v_fmac_f32 v29, v44, v82
    v_mul_f32 v70, 0xbde00000, v10
    v_cos_f32 v79, v70
    v_sin_f32 v82, v70
    s_nop 0
    v_mul_f32 v44, v52, v79
    v_fma_f32 v44, -v37, v82, v44
    v_mul_f32 v37, v37, v79
    v_fmac_f32 v37, v52, v82
    v_mul_f32 v70, 0xbe000000, v10
    v_cos_f32 v79, v70
    v_sin_f32 v82, v70
    s_nop 0
    v_mul_f32 v52, v58, v79
    v_fma_f32 v52, -v43, v82, v52
    v_mul_f32 v43, v43, v79
    v_fmac_f32 v43, v58, v82
    v_mul_f32 v70, 0xbe100000, v10
    v_cos_f32 v79, v70
    v_sin_f32 v82, v70
    s_nop 0
    v_mul_f32 v58, v38, v79
    v_fma_f32 v58, -v71, v82, v58
    v_mul_f32 v71, v71, v79
    v_fmac_f32 v71, v38, v82
    v_mul_f32 v70, 0xbe200000, v10
    v_cos_f32 v79, v70
    v_sin_f32 v82, v70
    s_nop 0
    v_mul_f32 v38, v28, v79
    v_fma_f32 v38, -v61, v82, v38
    v_mul_f32 v61, v61, v79
    v_fmac_f32 v61, v28, v82
    v_mul_f32 v70, 0xbe300000, v10
    v_cos_f32 v79, v70
    v_sin_f32 v82, v70
    s_nop 0
    v_mul_f32 v28, v36, v79
    v_fma_f32 v28, -v69, v82, v28
    v_mul_f32 v69, v69, v79
    v_fmac_f32 v69, v36, v82
    v_mul_f32 v70, 0xbe400000, v10
    v_cos_f32 v79, v70
    v_sin_f32 v82, v70
    s_nop 0
    v_mul_f32 v36, v64, v79
    v_fma_f32 v36, -v41, v82, v36
    v_mul_f32 v41, v41, v79
    v_fmac_f32 v41, v64, v82
    v_mul_f32 v70, 0xbe500000, v10
    v_cos_f32 v79, v70
    v_sin_f32 v82, v70
    s_nop 0
    v_mul_f32 v64, v24, v79
    v_fma_f32 v64, -v57, v82, v64
    v_mul_f32 v57, v57, v79
    v_fmac_f32 v57, v24, v82
    v_mul_f32 v70, 0xbe600000, v10
    v_cos_f32 v79, v70
    v_sin_f32 v82, v70
    s_nop 0
    v_mul_f32 v24, v30, v79
    v_fma_f32 v24, -v63, v82, v24
    v_mul_f32 v63, v63, v79
    v_fmac_f32 v63, v30, v82
    v_mul_f32 v70, 0xbe700000, v10
    v_cos_f32 v79, v70
    v_sin_f32 v82, v70
    s_nop 0
    v_mul_f32 v30, v34, v79
    v_fma_f32 v30, -v67, v82, v30
    v_mul_f32 v67, v67, v79
    v_fmac_f32 v67, v34, v82
    v_mul_f32 v70, 0xbe800000, v10
    v_cos_f32 v79, v70
    v_sin_f32 v82, v70
    s_nop 0
    v_mul_f32 v34, v42, v79
    v_fma_f32 v34, -v75, v82, v34
    v_mul_f32 v75, v75, v79
    v_fmac_f32 v75, v42, v82
    v_mul_f32 v70, 0xbe880000, v10
    v_cos_f32 v79, v70
    v_sin_f32 v82, v70
    s_nop 0
    v_mul_f32 v42, v60, v79
    v_fma_f32 v42, -v77, v82, v42
    v_mul_f32 v77, v77, v79
    v_fmac_f32 v77, v60, v82
    v_mul_f32 v70, 0xbe900000, v10
    v_cos_f32 v79, v70
    v_sin_f32 v82, v70
    s_nop 0
    v_mul_f32 v60, v40, v79
    v_fma_f32 v60, -v73, v82, v60
    v_mul_f32 v73, v73, v79
    v_fmac_f32 v73, v40, v82
    v_mul_f32 v70, 0xbe980000, v10
    v_cos_f32 v79, v70
    v_sin_f32 v82, v70
    s_nop 0
    v_mul_f32 v40, v56, v79
    v_fma_f32 v40, -v21, v82, v40
    v_mul_f32 v21, v21, v79
    v_fmac_f32 v21, v56, v82
    v_mul_f32 v70, 0xbea00000, v10
    v_cos_f32 v79, v70
    v_sin_f32 v82, v70
    s_nop 0
    v_mul_f32 v56, v80, v79
    v_fma_f32 v56, -v65, v82, v56
    v_mul_f32 v65, v65, v79
    v_fmac_f32 v65, v80, v82
    v_mul_f32 v70, 0xbea80000, v10
    v_cos_f32 v79, v70
    v_sin_f32 v82, v70
    s_nop 0
    v_mul_f32 v80, v32, v79
    v_fma_f32 v80, -v25, v82, v80
    v_mul_f32 v25, v25, v79
    v_fmac_f32 v25, v32, v82
    v_mul_f32 v70, 0xbeb00000, v10
    v_cos_f32 v79, v70
    v_sin_f32 v82, v70
    s_nop 0
    v_mul_f32 v32, v46, v79
    v_fma_f32 v32, -v31, v82, v32
    v_mul_f32 v31, v31, v79
    v_fmac_f32 v31, v46, v82
    v_mul_f32 v70, 0xbeb80000, v10
    v_cos_f32 v79, v70
    v_sin_f32 v82, v70
    s_nop 0
    v_mul_f32 v46, v50, v79
    v_fma_f32 v46, -v35, v82, v46
    v_mul_f32 v35, v35, v79
    v_fmac_f32 v35, v50, v82
    v_mul_f32 v70, 0xbec00000, v10
    v_cos_f32 v79, v70
    v_sin_f32 v82, v70
    s_nop 0
    v_mul_f32 v50, v83, v79
    v_fma_f32 v50, -v81, v82, v50
    v_mul_f32 v81, v81, v79
    v_fmac_f32 v81, v83, v82
    v_mul_f32 v70, 0xbec80000, v10
    v_cos_f32 v79, v70
    v_sin_f32 v82, v70
    s_nop 0
    v_mul_f32 v83, v78, v79
    v_fma_f32 v83, -v33, v82, v83
    v_mul_f32 v33, v33, v79
    v_fmac_f32 v33, v78, v82
    v_mul_f32 v70, 0xbed00000, v10
    v_cos_f32 v79, v70
    v_sin_f32 v82, v70
    s_nop 0
    v_mul_f32 v78, v76, v79
    v_fma_f32 v78, -v47, v82, v78
    v_mul_f32 v47, v47, v79
    v_fmac_f32 v47, v76, v82
    v_mul_f32 v70, 0xbed80000, v10
    v_cos_f32 v79, v70
    v_sin_f32 v82, v70
    s_nop 0
    v_mul_f32 v76, v18, v79
    v_fma_f32 v76, -v51, v82, v76
    v_mul_f32 v51, v51, v79
    v_fmac_f32 v51, v18, v82
    v_mul_f32 v70, 0xbee00000, v10
    v_cos_f32 v79, v70
    v_sin_f32 v82, v70
    s_nop 0
    v_mul_f32 v18, v72, v79
    v_fma_f32 v18, -v45, v82, v18
    v_mul_f32 v45, v45, v79
    v_fmac_f32 v45, v72, v82
    v_mul_f32 v70, 0xbee80000, v10
    v_cos_f32 v79, v70
    v_sin_f32 v82, v70
    s_nop 0
    v_mul_f32 v72, v20, v79
    v_fma_f32 v72, -v53, v82, v72
    v_mul_f32 v53, v53, v79
    v_fmac_f32 v53, v20, v82
    v_mul_f32 v70, 0xbef00000, v10
    v_cos_f32 v79, v70
    v_sin_f32 v82, v70
    s_nop 0
    v_mul_f32 v20, v22, v79
    v_fma_f32 v20, -v55, v82, v20
    v_mul_f32 v55, v55, v79
    v_fmac_f32 v55, v22, v82
    v_mul_f32 v70, 0xbef80000, v10
    v_cos_f32 v79, v70
    v_sin_f32 v82, v70
    s_nop 0
    v_mul_f32 v22, v26, v79
    v_fma_f32 v22, -v59, v82, v22
    v_mul_f32 v59, v59, v79
    v_fmac_f32 v59, v26, v82
    s_nop 1
    v_mov_b32_dpp v70, v16 quad_perm:[1,0,3,2] row_mask:0xf bank_mask:0xf
    v_fma_f32 v16, v16, v9, v70
    v_mov_b32_dpp v70, v17 quad_perm:[1,0,3,2] row_mask:0xf bank_mask:0xf
    v_fma_f32 v17, v17, v9, v70
    v_mov_b32_dpp v70, v74 quad_perm:[1,0,3,2] row_mask:0xf bank_mask:0xf
    v_fma_f32 v74, v74, v9, v70
    v_mov_b32_dpp v70, v49 quad_perm:[1,0,3,2] row_mask:0xf bank_mask:0xf
    v_fma_f32 v49, v49, v9, v70
    v_mov_b32_dpp v70, v48 quad_perm:[1,0,3,2] row_mask:0xf bank_mask:0xf
    v_fma_f32 v48, v48, v9, v70
    v_mov_b32_dpp v70, v19 quad_perm:[1,0,3,2] row_mask:0xf bank_mask:0xf
    v_fma_f32 v19, v19, v9, v70
    v_mov_b32_dpp v70, v68 quad_perm:[1,0,3,2] row_mask:0xf bank_mask:0xf
    v_fma_f32 v68, v68, v9, v70
    v_mov_b32_dpp v70, v23 quad_perm:[1,0,3,2] row_mask:0xf bank_mask:0xf
    v_fma_f32 v23, v23, v9, v70
    v_mov_b32_dpp v70, v62 quad_perm:[1,0,3,2] row_mask:0xf bank_mask:0xf
    v_fma_f32 v62, v62, v9, v70
    v_mov_b32_dpp v70, v27 quad_perm:[1,0,3,2] row_mask:0xf bank_mask:0xf
    v_fma_f32 v27, v27, v9, v70
    v_mov_b32_dpp v70, v66 quad_perm:[1,0,3,2] row_mask:0xf bank_mask:0xf
    v_fma_f32 v66, v66, v9, v70
    v_mov_b32_dpp v70, v39 quad_perm:[1,0,3,2] row_mask:0xf bank_mask:0xf
    v_fma_f32 v39, v39, v9, v70
    v_mov_b32_dpp v70, v54 quad_perm:[1,0,3,2] row_mask:0xf bank_mask:0xf
    v_fma_f32 v54, v54, v9, v70
    v_mov_b32_dpp v70, v29 quad_perm:[1,0,3,2] row_mask:0xf bank_mask:0xf
    v_fma_f32 v29, v29, v9, v70
    v_mov_b32_dpp v70, v44 quad_perm:[1,0,3,2] row_mask:0xf bank_mask:0xf
    v_fma_f32 v44, v44, v9, v70
    v_mov_b32_dpp v70, v37 quad_perm:[1,0,3,2] row_mask:0xf bank_mask:0xf
    v_fma_f32 v37, v37, v9, v70
    v_mov_b32_dpp v70, v52 quad_perm:[1,0,3,2] row_mask:0xf bank_mask:0xf
    v_fma_f32 v52, v52, v9, v70
    v_mov_b32_dpp v70, v43 quad_perm:[1,0,3,2] row_mask:0xf bank_mask:0xf
    v_fma_f32 v43, v43, v9, v70
    v_mov_b32_dpp v70, v58 quad_perm:[1,0,3,2] row_mask:0xf bank_mask:0xf
    v_fma_f32 v58, v58, v9, v70
    v_mov_b32_dpp v70, v71 quad_perm:[1,0,3,2] row_mask:0xf bank_mask:0xf
    v_fma_f32 v71, v71, v9, v70
    v_mov_b32_dpp v70, v38 quad_perm:[1,0,3,2] row_mask:0xf bank_mask:0xf
    v_fma_f32 v38, v38, v9, v70
    v_mov_b32_dpp v70, v61 quad_perm:[1,0,3,2] row_mask:0xf bank_mask:0xf
    v_fma_f32 v61, v61, v9, v70
    v_mov_b32_dpp v70, v28 quad_perm:[1,0,3,2] row_mask:0xf bank_mask:0xf
    v_fma_f32 v28, v28, v9, v70
    v_mov_b32_dpp v70, v69 quad_perm:[1,0,3,2] row_mask:0xf bank_mask:0xf
    v_fma_f32 v69, v69, v9, v70
    v_mov_b32_dpp v70, v36 quad_perm:[1,0,3,2] row_mask:0xf bank_mask:0xf
    v_fma_f32 v36, v36, v9, v70
    v_mov_b32_dpp v70, v41 quad_perm:[1,0,3,2] row_mask:0xf bank_mask:0xf
    v_fma_f32 v41, v41, v9, v70
    v_mov_b32_dpp v70, v64 quad_perm:[1,0,3,2] row_mask:0xf bank_mask:0xf
    v_fma_f32 v64, v64, v9, v70
    v_mov_b32_dpp v70, v57 quad_perm:[1,0,3,2] row_mask:0xf bank_mask:0xf
    v_fma_f32 v57, v57, v9, v70
    v_mov_b32_dpp v70, v24 quad_perm:[1,0,3,2] row_mask:0xf bank_mask:0xf
    v_fma_f32 v24, v24, v9, v70
    v_mov_b32_dpp v70, v63 quad_perm:[1,0,3,2] row_mask:0xf bank_mask:0xf
    v_fma_f32 v63, v63, v9, v70
    v_mov_b32_dpp v70, v30 quad_perm:[1,0,3,2] row_mask:0xf bank_mask:0xf
    v_fma_f32 v30, v30, v9, v70
    v_mov_b32_dpp v70, v67 quad_perm:[1,0,3,2] row_mask:0xf bank_mask:0xf
    v_fma_f32 v67, v67, v9, v70
    v_mov_b32_dpp v70, v34 quad_perm:[1,0,3,2] row_mask:0xf bank_mask:0xf
    v_fma_f32 v34, v34, v9, v70
    v_mov_b32_dpp v70, v75 quad_perm:[1,0,3,2] row_mask:0xf bank_mask:0xf
    v_fma_f32 v75, v75, v9, v70
    v_mov_b32_dpp v70, v42 quad_perm:[1,0,3,2] row_mask:0xf bank_mask:0xf
    v_fma_f32 v42, v42, v9, v70
    v_mov_b32_dpp v70, v77 quad_perm:[1,0,3,2] row_mask:0xf bank_mask:0xf
    v_fma_f32 v77, v77, v9, v70
    v_mov_b32_dpp v70, v60 quad_perm:[1,0,3,2] row_mask:0xf bank_mask:0xf
    v_fma_f32 v60, v60, v9, v70
    v_mov_b32_dpp v70, v73 quad_perm:[1,0,3,2] row_mask:0xf bank_mask:0xf
    v_fma_f32 v73, v73, v9, v70
    v_mov_b32_dpp v70, v40 quad_perm:[1,0,3,2] row_mask:0xf bank_mask:0xf
    v_fma_f32 v40, v40, v9, v70
    v_mov_b32_dpp v70, v21 quad_perm:[1,0,3,2] row_mask:0xf bank_mask:0xf
    v_fma_f32 v21, v21, v9, v70
    v_mov_b32_dpp v70, v56 quad_perm:[1,0,3,2] row_mask:0xf bank_mask:0xf
    v_fma_f32 v56, v56, v9, v70
    v_mov_b32_dpp v70, v65 quad_perm:[1,0,3,2] row_mask:0xf bank_mask:0xf
    v_fma_f32 v65, v65, v9, v70
    v_mov_b32_dpp v70, v80 quad_perm:[1,0,3,2] row_mask:0xf bank_mask:0xf
    v_fma_f32 v80, v80, v9, v70
    v_mov_b32_dpp v70, v25 quad_perm:[1,0,3,2] row_mask:0xf bank_mask:0xf
    v_fma_f32 v25, v25, v9, v70
    v_mov_b32_dpp v70, v32 quad_perm:[1,0,3,2] row_mask:0xf bank_mask:0xf
    v_fma_f32 v32, v32, v9, v70
    v_mov_b32_dpp v70, v31 quad_perm:[1,0,3,2] row_mask:0xf bank_mask:0xf
    v_fma_f32 v31, v31, v9, v70
    v_mov_b32_dpp v70, v46 quad_perm:[1,0,3,2] row_mask:0xf bank_mask:0xf
    v_fma_f32 v46, v46, v9, v70
    v_mov_b32_dpp v70, v35 quad_perm:[1,0,3,2] row_mask:0xf bank_mask:0xf
    v_fma_f32 v35, v35, v9, v70
    v_mov_b32_dpp v70, v50 quad_perm:[1,0,3,2] row_mask:0xf bank_mask:0xf
    v_fma_f32 v50, v50, v9, v70
    v_mov_b32_dpp v70, v81 quad_perm:[1,0,3,2] row_mask:0xf bank_mask:0xf
    v_fma_f32 v81, v81, v9, v70
    v_mov_b32_dpp v70, v83 quad_perm:[1,0,3,2] row_mask:0xf bank_mask:0xf
    v_fma_f32 v83, v83, v9, v70
    v_mov_b32_dpp v70, v33 quad_perm:[1,0,3,2] row_mask:0xf bank_mask:0xf
    v_fma_f32 v33, v33, v9, v70
    v_mov_b32_dpp v70, v78 quad_perm:[1,0,3,2] row_mask:0xf bank_mask:0xf
    v_fma_f32 v78, v78, v9, v70
    v_mov_b32_dpp v70, v47 quad_perm:[1,0,3,2] row_mask:0xf bank_mask:0xf
    v_fma_f32 v47, v47, v9, v70
    v_mov_b32_dpp v70, v76 quad_perm:[1,0,3,2] row_mask:0xf bank_mask:0xf
    v_fma_f32 v76, v76, v9, v70
    v_mov_b32_dpp v70, v51 quad_perm:[1,0,3,2] row_mask:0xf bank_mask:0xf
    v_fma_f32 v51, v51, v9, v70
    v_mov_b32_dpp v70, v18 quad_perm:[1,0,3,2] row_mask:0xf bank_mask:0xf
    v_fma_f32 v18, v18, v9, v70
    v_mov_b32_dpp v70, v45 quad_perm:[1,0,3,2] row_mask:0xf bank_mask:0xf
    v_fma_f32 v45, v45, v9, v70
    v_mov_b32_dpp v70, v72 quad_perm:[1,0,3,2] row_mask:0xf bank_mask:0xf
    v_fma_f32 v72, v72, v9, v70
    v_mov_b32_dpp v70, v53 quad_perm:[1,0,3,2] row_mask:0xf bank_mask:0xf
    v_fma_f32 v53, v53, v9, v70
    v_mov_b32_dpp v70, v20 quad_perm:[1,0,3,2] row_mask:0xf bank_mask:0xf
    v_fma_f32 v20, v20, v9, v70
    v_mov_b32_dpp v70, v55 quad_perm:[1,0,3,2] row_mask:0xf bank_mask:0xf
    v_fma_f32 v55, v55, v9, v70
    v_mov_b32_dpp v70, v22 quad_perm:[1,0,3,2] row_mask:0xf bank_mask:0xf
    v_fma_f32 v22, v22, v9, v70
    v_mov_b32_dpp v70, v59 quad_perm:[1,0,3,2] row_mask:0xf bank_mask:0xf
    v_fma_f32 v59, v59, v9, v70
    s_waitcnt vmcnt(0)
    s_mov_b32 s20, 0x34800000
    v_lshlrev_b32 v70, 16, v88
    v_and_b32 v79, 0xffff0000, v88
    v_mul_f32 v70, s20, v70
    v_mul_f32 v79, s20, v79
    v_mul_f32 v82, v16, v70
    v_fma_f32 v82, -v17, v79, v82
    v_mul_f32 v17, v17, v70
    v_fmac_f32 v17, v16, v79
    v_lshlrev_b32 v70, 16, v89
    v_and_b32 v79, 0xffff0000, v89
    v_mul_f32 v70, s20, v70
    v_mul_f32 v79, s20, v79
    v_mul_f32 v16, v74, v70
    v_fma_f32 v16, -v49, v79, v16
    v_mul_f32 v49, v49, v70
    v_fmac_f32 v49, v74, v79
    v_lshlrev_b32 v70, 16, v90
    v_and_b32 v79, 0xffff0000, v90
    v_mul_f32 v70, s20, v70
    v_mul_f32 v79, s20, v79
    v_mul_f32 v74, v48, v70
    v_fma_f32 v74, -v19, v79, v74
    v_mul_f32 v19, v19, v70
    v_fmac_f32 v19, v48, v79
    v_lshlrev_b32 v70, 16, v91
    v_and_b32 v79, 0xffff0000, v91
    v_mul_f32 v70, s20, v70
    v_mul_f32 v79, s20, v79
    v_mul_f32 v48, v68, v70
    v_fma_f32 v48, -v23, v79, v48
    v_mul_f32 v23, v23, v70
    v_fmac_f32 v23, v68, v79
    v_lshlrev_b32 v70, 16, v92
    v_and_b32 v79, 0xffff0000, v92
    v_mul_f32 v70, s20, v70
    v_mul_f32 v79, s20, v79
    v_mul_f32 v68, v62, v70
    v_fma_f32 v68, -v27, v79, v68
    v_mul_f32 v27, v27, v70
    v_fmac_f32 v27, v62, v79
    v_lshlrev_b32 v70, 16, v93
    v_and_b32 v79, 0xffff0000, v93
    v_mul_f32 v70, s20, v70
    v_mul_f32 v79, s20, v79
    v_mul_f32 v62, v66, v70
    v_fma_f32 v62, -v39, v79, v62
    v_mul_f32 v39, v39, v70
    v_fmac_f32 v39, v66, v79
    v_lshlrev_b32 v70, 16, v94
    v_and_b32 v79, 0xffff0000, v94
    v_mul_f32 v70, s20, v70
    v_mul_f32 v79, s20, v79
    v_mul_f32 v66, v54, v70
    v_fma_f32 v66, -v29, v79, v66
    v_mul_f32 v29, v29, v70
    v_fmac_f32 v29, v54, v79
    v_lshlrev_b32 v70, 16, v95
    v_and_b32 v79, 0xffff0000, v95
    v_mul_f32 v70, s20, v70
    v_mul_f32 v79, s20, v79
    v_mul_f32 v54, v44, v70
    v_fma_f32 v54, -v37, v79, v54
    v_mul_f32 v37, v37, v70
    v_fmac_f32 v37, v44, v79
    v_lshlrev_b32 v70, 16, v96
    v_and_b32 v79, 0xffff0000, v96
    v_mul_f32 v70, s20, v70
    v_mul_f32 v79, s20, v79
    v_mul_f32 v44, v52, v70
    v_fma_f32 v44, -v43, v79, v44
    v_mul_f32 v43, v43, v70
    v_fmac_f32 v43, v52, v79
    v_lshlrev_b32 v70, 16, v97
    v_and_b32 v79, 0xffff0000, v97
    v_mul_f32 v70, s20, v70
    v_mul_f32 v79, s20, v79
    v_mul_f32 v52, v58, v70
    v_fma_f32 v52, -v71, v79, v52
    v_mul_f32 v71, v71, v70
    v_fmac_f32 v71, v58, v79
    v_lshlrev_b32 v70, 16, v98
    v_and_b32 v79, 0xffff0000, v98
    v_mul_f32 v70, s20, v70
    v_mul_f32 v79, s20, v79
    v_mul_f32 v58, v38, v70
    v_fma_f32 v58, -v61, v79, v58
    v_mul_f32 v61, v61, v70
    v_fmac_f32 v61, v38, v79
    v_lshlrev_b32 v70, 16, v99
    v_and_b32 v79, 0xffff0000, v99
    v_mul_f32 v70, s20, v70
    v_mul_f32 v79, s20, v79
    v_mul_f32 v38, v28, v70
    v_fma_f32 v38, -v69, v79, v38
    v_mul_f32 v69, v69, v70
    v_fmac_f32 v69, v28, v79
    v_lshlrev_b32 v70, 16, v100
    v_and_b32 v79, 0xffff0000, v100
    v_mul_f32 v70, s20, v70
    v_mul_f32 v79, s20, v79
    v_mul_f32 v28, v36, v70
    v_fma_f32 v28, -v41, v79, v28
    v_mul_f32 v41, v41, v70
    v_fmac_f32 v41, v36, v79
    v_lshlrev_b32 v70, 16, v101
    v_and_b32 v79, 0xffff0000, v101
    v_mul_f32 v70, s20, v70
    v_mul_f32 v79, s20, v79
    v_mul_f32 v36, v64, v70
    v_fma_f32 v36, -v57, v79, v36
    v_mul_f32 v57, v57, v70
    v_fmac_f32 v57, v64, v79
    v_lshlrev_b32 v70, 16, v102
    v_and_b32 v79, 0xffff0000, v102
    v_mul_f32 v70, s20, v70
    v_mul_f32 v79, s20, v79
    v_mul_f32 v64, v24, v70
    v_fma_f32 v64, -v63, v79, v64
    v_mul_f32 v63, v63, v70
    v_fmac_f32 v63, v24, v79
    v_lshlrev_b32 v70, 16, v103
    v_and_b32 v79, 0xffff0000, v103
    v_mul_f32 v70, s20, v70
    v_mul_f32 v79, s20, v79
    v_mul_f32 v24, v30, v70
    v_fma_f32 v24, -v67, v79, v24
    v_mul_f32 v67, v67, v70
    v_fmac_f32 v67, v30, v79
    v_lshlrev_b32 v70, 16, v104
    v_and_b32 v79, 0xffff0000, v104
    v_mul_f32 v70, s20, v70
    v_mul_f32 v79, s20, v79
    v_mul_f32 v30, v34, v70
    v_fma_f32 v30, -v75, v79, v30
    v_mul_f32 v75, v75, v70
    v_fmac_f32 v75, v34, v79
    v_lshlrev_b32 v70, 16, v105
    v_and_b32 v79, 0xffff0000, v105
    v_mul_f32 v70, s20, v70
    v_mul_f32 v79, s20, v79
    v_mul_f32 v34, v42, v70
    v_fma_f32 v34, -v77, v79, v34
    v_mul_f32 v77, v77, v70
    v_fmac_f32 v77, v42, v79
    v_lshlrev_b32 v70, 16, v106
    v_and_b32 v79, 0xffff0000, v106
    v_mul_f32 v70, s20, v70
    v_mul_f32 v79, s20, v79
    v_mul_f32 v42, v60, v70
    v_fma_f32 v42, -v73, v79, v42
    v_mul_f32 v73, v73, v70
    v_fmac_f32 v73, v60, v79
    v_lshlrev_b32 v70, 16, v107
    v_and_b32 v79, 0xffff0000, v107
    v_mul_f32 v70, s20, v70
    v_mul_f32 v79, s20, v79
    v_mul_f32 v60, v40, v70
    v_fma_f32 v60, -v21, v79, v60
    v_mul_f32 v21, v21, v70
    v_fmac_f32 v21, v40, v79
    v_lshlrev_b32 v70, 16, v108
    v_and_b32 v79, 0xffff0000, v108
    v_mul_f32 v70, s20, v70
    v_mul_f32 v79, s20, v79
    v_mul_f32 v40, v56, v70
    v_fma_f32 v40, -v65, v79, v40
    v_mul_f32 v65, v65, v70
    v_fmac_f32 v65, v56, v79
    v_lshlrev_b32 v70, 16, v109
    v_and_b32 v79, 0xffff0000, v109
    v_mul_f32 v70, s20, v70
    v_mul_f32 v79, s20, v79
    v_mul_f32 v56, v80, v70
    v_fma_f32 v56, -v25, v79, v56
    v_mul_f32 v25, v25, v70
    v_fmac_f32 v25, v80, v79
    v_lshlrev_b32 v70, 16, v110
    v_and_b32 v79, 0xffff0000, v110
    v_mul_f32 v70, s20, v70
    v_mul_f32 v79, s20, v79
    v_mul_f32 v80, v32, v70
    v_fma_f32 v80, -v31, v79, v80
    v_mul_f32 v31, v31, v70
    v_fmac_f32 v31, v32, v79
    v_lshlrev_b32 v70, 16, v111
    v_and_b32 v79, 0xffff0000, v111
    v_mul_f32 v70, s20, v70
    v_mul_f32 v79, s20, v79
    v_mul_f32 v32, v46, v70
    v_fma_f32 v32, -v35, v79, v32
    v_mul_f32 v35, v35, v70
    v_fmac_f32 v35, v46, v79
    v_lshlrev_b32 v70, 16, v112
    v_and_b32 v79, 0xffff0000, v112
    v_mul_f32 v70, s20, v70
    v_mul_f32 v79, s20, v79
    v_mul_f32 v46, v50, v70
    v_fma_f32 v46, -v81, v79, v46
    v_mul_f32 v81, v81, v70
    v_fmac_f32 v81, v50, v79
    v_lshlrev_b32 v70, 16, v113
    v_and_b32 v79, 0xffff0000, v113
    v_mul_f32 v70, s20, v70
    v_mul_f32 v79, s20, v79
    v_mul_f32 v50, v83, v70
    v_fma_f32 v50, -v33, v79, v50
    v_mul_f32 v33, v33, v70
    v_fmac_f32 v33, v83, v79
    v_lshlrev_b32 v70, 16, v114
    v_and_b32 v79, 0xffff0000, v114
    v_mul_f32 v70, s20, v70
    v_mul_f32 v79, s20, v79
    v_mul_f32 v83, v78, v70
    v_fma_f32 v83, -v47, v79, v83
    v_mul_f32 v47, v47, v70
    v_fmac_f32 v47, v78, v79
    v_lshlrev_b32 v70, 16, v115
    v_and_b32 v79, 0xffff0000, v115
    v_mul_f32 v70, s20, v70
    v_mul_f32 v79, s20, v79
    v_mul_f32 v78, v76, v70
    v_fma_f32 v78, -v51, v79, v78
    v_mul_f32 v51, v51, v70
    v_fmac_f32 v51, v76, v79
    v_lshlrev_b32 v70, 16, v116
    v_and_b32 v79, 0xffff0000, v116
    v_mul_f32 v70, s20, v70
    v_mul_f32 v79, s20, v79
    v_mul_f32 v76, v18, v70
    v_fma_f32 v76, -v45, v79, v76
    v_mul_f32 v45, v45, v70
    v_fmac_f32 v45, v18, v79
    v_lshlrev_b32 v70, 16, v117
    v_and_b32 v79, 0xffff0000, v117
    v_mul_f32 v70, s20, v70
    v_mul_f32 v79, s20, v79
    v_mul_f32 v18, v72, v70
    v_fma_f32 v18, -v53, v79, v18
    v_mul_f32 v53, v53, v70
    v_fmac_f32 v53, v72, v79
    v_lshlrev_b32 v70, 16, v118
    v_and_b32 v79, 0xffff0000, v118
    v_mul_f32 v70, s20, v70
    v_mul_f32 v79, s20, v79
    v_mul_f32 v72, v20, v70
    v_fma_f32 v72, -v55, v79, v72
    v_mul_f32 v55, v55, v70
    v_fmac_f32 v55, v20, v79
    v_lshlrev_b32 v70, 16, v119
    v_and_b32 v79, 0xffff0000, v119
    v_mul_f32 v70, s20, v70
    v_mul_f32 v79, s20, v79
    v_mul_f32 v20, v22, v70
    v_fma_f32 v20, -v59, v79, v20
    v_mul_f32 v59, v59, v70
    v_fmac_f32 v59, v22, v79
    s_nop 1
    v_mov_b32_dpp v70, v82 quad_perm:[1,0,3,2] row_mask:0xf bank_mask:0xf
    v_fma_f32 v82, v82, v9, v70
    v_mov_b32_dpp v70, v17 quad_perm:[1,0,3,2] row_mask:0xf bank_mask:0xf
    v_fma_f32 v17, v17, v9, v70
    v_mov_b32_dpp v70, v16 quad_perm:[1,0,3,2] row_mask:0xf bank_mask:0xf
    v_fma_f32 v16, v16, v9, v70
    v_mov_b32_dpp v70, v49 quad_perm:[1,0,3,2] row_mask:0xf bank_mask:0xf
    v_fma_f32 v49, v49, v9, v70
    v_mov_b32_dpp v70, v74 quad_perm:[1,0,3,2] row_mask:0xf bank_mask:0xf
    v_fma_f32 v74, v74, v9, v70
    v_mov_b32_dpp v70, v19 quad_perm:[1,0,3,2] row_mask:0xf bank_mask:0xf
    v_fma_f32 v19, v19, v9, v70
    v_mov_b32_dpp v70, v48 quad_perm:[1,0,3,2] row_mask:0xf bank_mask:0xf
    v_fma_f32 v48, v48, v9, v70
    v_mov_b32_dpp v70, v23 quad_perm:[1,0,3,2] row_mask:0xf bank_mask:0xf
    v_fma_f32 v23, v23, v9, v70
    v_mov_b32_dpp v70, v68 quad_perm:[1,0,3,2] row_mask:0xf bank_mask:0xf
    v_fma_f32 v68, v68, v9, v70
    v_mov_b32_dpp v70, v27 quad_perm:[1,0,3,2] row_mask:0xf bank_mask:0xf
    v_fma_f32 v27, v27, v9, v70
    v_mov_b32_dpp v70, v62 quad_perm:[1,0,3,2] row_mask:0xf bank_mask:0xf
    v_fma_f32 v62, v62, v9, v70
    v_mov_b32_dpp v70, v39 quad_perm:[1,0,3,2] row_mask:0xf bank_mask:0xf
    v_fma_f32 v39, v39, v9, v70
    v_mov_b32_dpp v70, v66 quad_perm:[1,0,3,2] row_mask:0xf bank_mask:0xf
    v_fma_f32 v66, v66, v9, v70
    v_mov_b32_dpp v70, v29 quad_perm:[1,0,3,2] row_mask:0xf bank_mask:0xf
    v_fma_f32 v29, v29, v9, v70
    v_mov_b32_dpp v70, v54 quad_perm:[1,0,3,2] row_mask:0xf bank_mask:0xf
    v_fma_f32 v54, v54, v9, v70
    v_mov_b32_dpp v70, v37 quad_perm:[1,0,3,2] row_mask:0xf bank_mask:0xf
    v_fma_f32 v37, v37, v9, v70
    v_mov_b32_dpp v70, v44 quad_perm:[1,0,3,2] row_mask:0xf bank_mask:0xf
    v_fma_f32 v44, v44, v9, v70
    v_mov_b32_dpp v70, v43 quad_perm:[1,0,3,2] row_mask:0xf bank_mask:0xf
    v_fma_f32 v43, v43, v9, v70
    v_mov_b32_dpp v70, v52 quad_perm:[1,0,3,2] row_mask:0xf bank_mask:0xf
    v_fma_f32 v52, v52, v9, v70
    v_mov_b32_dpp v70, v71 quad_perm:[1,0,3,2] row_mask:0xf bank_mask:0xf
    v_fma_f32 v71, v71, v9, v70
    v_mov_b32_dpp v70, v58 quad_perm:[1,0,3,2] row_mask:0xf bank_mask:0xf
    v_fma_f32 v58, v58, v9, v70
    v_mov_b32_dpp v70, v61 quad_perm:[1,0,3,2] row_mask:0xf bank_mask:0xf
    v_fma_f32 v61, v61, v9, v70
    v_mov_b32_dpp v70, v38 quad_perm:[1,0,3,2] row_mask:0xf bank_mask:0xf
    v_fma_f32 v38, v38, v9, v70
    v_mov_b32_dpp v70, v69 quad_perm:[1,0,3,2] row_mask:0xf bank_mask:0xf
    v_fma_f32 v69, v69, v9, v70
    v_mov_b32_dpp v70, v28 quad_perm:[1,0,3,2] row_mask:0xf bank_mask:0xf
    v_fma_f32 v28, v28, v9, v70
    v_mov_b32_dpp v70, v41 quad_perm:[1,0,3,2] row_mask:0xf bank_mask:0xf
    v_fma_f32 v41, v41, v9, v70
    v_mov_b32_dpp v70, v36 quad_perm:[1,0,3,2] row_mask:0xf bank_mask:0xf
    v_fma_f32 v36, v36, v9, v70
    v_mov_b32_dpp v70, v57 quad_perm:[1,0,3,2] row_mask:0xf bank_mask:0xf
    v_fma_f32 v57, v57, v9, v70
    v_mov_b32_dpp v70, v64 quad_perm:[1,0,3,2] row_mask:0xf bank_mask:0xf
    v_fma_f32 v64, v64, v9, v70
    v_mov_b32_dpp v70, v63 quad_perm:[1,0,3,2] row_mask:0xf bank_mask:0xf
    v_fma_f32 v63, v63, v9, v70
    v_mov_b32_dpp v70, v24 quad_perm:[1,0,3,2] row_mask:0xf bank_mask:0xf
    v_fma_f32 v24, v24, v9, v70
    v_mov_b32_dpp v70, v67 quad_perm:[1,0,3,2] row_mask:0xf bank_mask:0xf
    v_fma_f32 v67, v67, v9, v70
    v_mov_b32_dpp v70, v30 quad_perm:[1,0,3,2] row_mask:0xf bank_mask:0xf
    v_fma_f32 v30, v30, v9, v70
    v_mov_b32_dpp v70, v75 quad_perm:[1,0,3,2] row_mask:0xf bank_mask:0xf
    v_fma_f32 v75, v75, v9, v70
    v_mov_b32_dpp v70, v34 quad_perm:[1,0,3,2] row_mask:0xf bank_mask:0xf
    v_fma_f32 v34, v34, v9, v70
    v_mov_b32_dpp v70, v77 quad_perm:[1,0,3,2] row_mask:0xf bank_mask:0xf
    v_fma_f32 v77, v77, v9, v70
    v_mov_b32_dpp v70, v42 quad_perm:[1,0,3,2] row_mask:0xf bank_mask:0xf
    v_fma_f32 v42, v42, v9, v70
    v_mov_b32_dpp v70, v73 quad_perm:[1,0,3,2] row_mask:0xf bank_mask:0xf
    v_fma_f32 v73, v73, v9, v70
    v_mov_b32_dpp v70, v60 quad_perm:[1,0,3,2] row_mask:0xf bank_mask:0xf
    v_fma_f32 v60, v60, v9, v70
    v_mov_b32_dpp v70, v21 quad_perm:[1,0,3,2] row_mask:0xf bank_mask:0xf
    v_fma_f32 v21, v21, v9, v70
    v_mov_b32_dpp v70, v40 quad_perm:[1,0,3,2] row_mask:0xf bank_mask:0xf
    v_fma_f32 v40, v40, v9, v70
    v_mov_b32_dpp v70, v65 quad_perm:[1,0,3,2] row_mask:0xf bank_mask:0xf
    v_fma_f32 v65, v65, v9, v70
    v_mov_b32_dpp v70, v56 quad_perm:[1,0,3,2] row_mask:0xf bank_mask:0xf
    v_fma_f32 v56, v56, v9, v70
    v_mov_b32_dpp v70, v25 quad_perm:[1,0,3,2] row_mask:0xf bank_mask:0xf
    v_fma_f32 v25, v25, v9, v70
    v_mov_b32_dpp v70, v80 quad_perm:[1,0,3,2] row_mask:0xf bank_mask:0xf
    v_fma_f32 v80, v80, v9, v70
    v_mov_b32_dpp v70, v31 quad_perm:[1,0,3,2] row_mask:0xf bank_mask:0xf
    v_fma_f32 v31, v31, v9, v70
    v_mov_b32_dpp v70, v32 quad_perm:[1,0,3,2] row_mask:0xf bank_mask:0xf
    v_fma_f32 v32, v32, v9, v70
    v_mov_b32_dpp v70, v35 quad_perm:[1,0,3,2] row_mask:0xf bank_mask:0xf
    v_fma_f32 v35, v35, v9, v70
    v_mov_b32_dpp v70, v46 quad_perm:[1,0,3,2] row_mask:0xf bank_mask:0xf
    v_fma_f32 v46, v46, v9, v70
    v_mov_b32_dpp v70, v81 quad_perm:[1,0,3,2] row_mask:0xf bank_mask:0xf
    v_fma_f32 v81, v81, v9, v70
    v_mov_b32_dpp v70, v50 quad_perm:[1,0,3,2] row_mask:0xf bank_mask:0xf
    v_fma_f32 v50, v50, v9, v70
    v_mov_b32_dpp v70, v33 quad_perm:[1,0,3,2] row_mask:0xf bank_mask:0xf
    v_fma_f32 v33, v33, v9, v70
    v_mov_b32_dpp v70, v83 quad_perm:[1,0,3,2] row_mask:0xf bank_mask:0xf
    v_fma_f32 v83, v83, v9, v70
    v_mov_b32_dpp v70, v47 quad_perm:[1,0,3,2] row_mask:0xf bank_mask:0xf
    v_fma_f32 v47, v47, v9, v70
    v_mov_b32_dpp v70, v78 quad_perm:[1,0,3,2] row_mask:0xf bank_mask:0xf
    v_fma_f32 v78, v78, v9, v70
    v_mov_b32_dpp v70, v51 quad_perm:[1,0,3,2] row_mask:0xf bank_mask:0xf
    v_fma_f32 v51, v51, v9, v70
    v_mov_b32_dpp v70, v76 quad_perm:[1,0,3,2] row_mask:0xf bank_mask:0xf
    v_fma_f32 v76, v76, v9, v70
    v_mov_b32_dpp v70, v45 quad_perm:[1,0,3,2] row_mask:0xf bank_mask:0xf
    v_fma_f32 v45, v45, v9, v70
    v_mov_b32_dpp v70, v18 quad_perm:[1,0,3,2] row_mask:0xf bank_mask:0xf
    v_fma_f32 v18, v18, v9, v70
    v_mov_b32_dpp v70, v53 quad_perm:[1,0,3,2] row_mask:0xf bank_mask:0xf
    v_fma_f32 v53, v53, v9, v70
    v_mov_b32_dpp v70, v72 quad_perm:[1,0,3,2] row_mask:0xf bank_mask:0xf
    v_fma_f32 v72, v72, v9, v70
    v_mov_b32_dpp v70, v55 quad_perm:[1,0,3,2] row_mask:0xf bank_mask:0xf
    v_fma_f32 v55, v55, v9, v70
    v_mov_b32_dpp v70, v20 quad_perm:[1,0,3,2] row_mask:0xf bank_mask:0xf
    v_fma_f32 v20, v20, v9, v70
    v_mov_b32_dpp v70, v59 quad_perm:[1,0,3,2] row_mask:0xf bank_mask:0xf
    v_fma_f32 v59, v59, v9, v70
    v_mul_f32 v70, 0x3c800000, v10
    v_cos_f32 v79, v70
    v_sin_f32 v22, v70
    s_nop 0
    v_mul_f32 v26, v16, v79
    v_fma_f32 v26, -v49, v22, v26
    v_mul_f32 v49, v49, v79
    v_fmac_f32 v49, v16, v22
    v_mul_f32 v70, 0x3d000000, v10
    v_cos_f32 v79, v70
    v_sin_f32 v22, v70
    s_nop 0
    v_mul_f32 v16, v74, v79
    v_fma_f32 v16, -v19, v22, v16
    v_mul_f32 v19, v19, v79
    v_fmac_f32 v19, v74, v22
    v_mul_f32 v70, 0x3d400000, v10
    v_cos_f32 v79, v70
    v_sin_f32 v22, v70
    s_nop 0
    v_mul_f32 v74, v48, v79
    v_fma_f32 v74, -v23, v22, v74
    v_mul_f32 v23, v23, v79
    v_fmac_f32 v23, v48, v22
    v_mul_f32 v70, 0x3d800000, v10
    v_cos_f32 v79, v70
    v_sin_f32 v22, v70
    s_nop 0
    v_mul_f32 v48, v68, v79
    v_fma_f32 v48, -v27, v22, v48
    v_mul_f32 v27, v27, v79
    v_fmac_f32 v27, v68, v22
    v_mul_f32 v70, 0x3da00000, v10
    v_cos_f32 v79, v70
    v_sin_f32 v22, v70
    s_nop 0
    v_mul_f32 v68, v62, v79
    v_fma_f32 v68, -v39, v22, v68
    v_mul_f32 v39, v39, v79
    v_fmac_f32 v39, v62, v22
    v_mul_f32 v70, 0x3dc00000, v10
    v_cos_f32 v79, v70
    v_sin_f32 v22, v70
    s_nop 0
    v_mul_f32 v62, v66, v79
    v_fma_f32 v62, -v29, v22, v62
    v_mul_f32 v29, v29, v79
    v_fmac_f32 v29, v66, v22
    v_mul_f32 v70, 0x3de00000, v10
    v_cos_f32 v79, v70
    v_sin_f32 v22, v70
    s_nop 0
    v_mul_f32 v66, v54, v79
    v_fma_f32 v66, -v37, v22, v66
    v_mul_f32 v37, v37, v79
    v_fmac_f32 v37, v54, v22
    v_mul_f32 v70, 0x3e000000, v10
    v_cos_f32 v79, v70
    v_sin_f32 v22, v70
    s_nop 0
    v_mul_f32 v54, v44, v79
    v_fma_f32 v54, -v43, v22, v54
    v_mul_f32 v43, v43, v79
    v_fmac_f32 v43, v44, v22
    v_mul_f32 v70, 0x3e100000, v10
    v_cos_f32 v79, v70
    v_sin_f32 v22, v70
    s_nop 0
    v_mul_f32 v44, v52, v79
    v_fma_f32 v44, -v71, v22, v44
    v_mul_f32 v71, v71, v79
    v_fmac_f32 v71, v52, v22
    v_mul_f32 v70, 0x3e200000, v10
    v_cos_f32 v79, v70
    v_sin_f32 v22, v70
    s_nop 0
    v_mul_f32 v52, v58, v79
    v_fma_f32 v52, -v61, v22, v52
    v_mul_f32 v61, v61, v79
    v_fmac_f32 v61, v58, v22
    v_mul_f32 v70, 0x3e300000, v10
    v_cos_f32 v79, v70
    v_sin_f32 v22, v70
    s_nop 0
    v_mul_f32 v58, v38, v79
    v_fma_f32 v58, -v69, v22, v58
    v_mul_f32 v69, v69, v79
    v_fmac_f32 v69, v38, v22
    v_mul_f32 v70, 0x3e400000, v10
    v_cos_f32 v79, v70
    v_sin_f32 v22, v70
    s_nop 0
    v_mul_f32 v38, v28, v79
    v_fma_f32 v38, -v41, v22, v38
    v_mul_f32 v41, v41, v79
    v_fmac_f32 v41, v28, v22
    v_mul_f32 v70, 0x3e500000, v10
    v_cos_f32 v79, v70
    v_sin_f32 v22, v70
    s_nop 0
    v_mul_f32 v28, v36, v79
    v_fma_f32 v28, -v57, v22, v28
    v_mul_f32 v57, v57, v79
    v_fmac_f32 v57, v36, v22
    v_mul_f32 v70, 0x3e600000, v10
    v_cos_f32 v79, v70
    v_sin_f32 v22, v70
    s_nop 0
    v_mul_f32 v36, v64, v79
    v_fma_f32 v36, -v63, v22, v36
    v_mul_f32 v63, v63, v79
    v_fmac_f32 v63, v64, v22
    v_mul_f32 v70, 0x3e700000, v10
    v_cos_f32 v79, v70
    v_sin_f32 v22, v70
    s_nop 0
    v_mul_f32 v64, v24, v79
    v_fma_f32 v64, -v67, v22, v64
    v_mul_f32 v67, v67, v79
    v_fmac_f32 v67, v24, v22
    v_mul_f32 v70, 0x3e800000, v10
    v_cos_f32 v79, v70
    v_sin_f32 v22, v70
    s_nop 0
    v_mul_f32 v24, v30, v79
    v_fma_f32 v24, -v75, v22, v24
    v_mul_f32 v75, v75, v79
    v_fmac_f32 v75, v30, v22
    v_mul_f32 v70, 0x3e880000, v10
    v_cos_f32 v79, v70
    v_sin_f32 v22, v70
    s_nop 0
    v_mul_f32 v30, v34, v79
    v_fma_f32 v30, -v77, v22, v30
    v_mul_f32 v77, v77, v79
    v_fmac_f32 v77, v34, v22
    v_mul_f32 v70, 0x3e900000, v10
    v_cos_f32 v79, v70
    v_sin_f32 v22, v70
    s_nop 0
    v_mul_f32 v34, v42, v79
    v_fma_f32 v34, -v73, v22, v34
    v_mul_f32 v73, v73, v79
    v_fmac_f32 v73, v42, v22
    v_mul_f32 v70, 0x3e980000, v10
    v_cos_f32 v79, v70
    v_sin_f32 v22, v70
    s_nop 0
    v_mul_f32 v42, v60, v79
    v_fma_f32 v42, -v21, v22, v42
    v_mul_f32 v21, v21, v79
    v_fmac_f32 v21, v60, v22
    v_mul_f32 v70, 0x3ea00000, v10
    v_cos_f32 v79, v70
    v_sin_f32 v22, v70
    s_nop 0
    v_mul_f32 v60, v40, v79
    v_fma_f32 v60, -v65, v22, v60
    v_mul_f32 v65, v65, v79
    v_fmac_f32 v65, v40, v22
    v_mul_f32 v70, 0x3ea80000, v10
    v_cos_f32 v79, v70
    v_sin_f32 v22, v70
    s_nop 0
    v_mul_f32 v40, v56, v79
    v_fma_f32 v40, -v25, v22, v40
    v_mul_f32 v25, v25, v79
    v_fmac_f32 v25, v56, v22
    v_mul_f32 v70, 0x3eb00000, v10
    v_cos_f32 v79, v70
    v_sin_f32 v22, v70
    s_nop 0
    v_mul_f32 v56, v80, v79
    v_fma_f32 v56, -v31, v22, v56
    v_mul_f32 v31, v31, v79
    v_fmac_f32 v31, v80, v22
    v_mul_f32 v70, 0x3eb80000, v10
    v_cos_f32 v79, v70
    v_sin_f32 v22, v70
    s_nop 0
    v_mul_f32 v80, v32, v79
    v_fma_f32 v80, -v35, v22, v80
    v_mul_f32 v35, v35, v79
    v_fmac_f32 v35, v32, v22
    v_mul_f32 v70, 0x3ec00000, v10
    v_cos_f32 v79, v70
    v_sin_f32 v22, v70
    s_nop 0
    v_mul_f32 v32, v46, v79
    v_fma_f32 v32, -v81, v22, v32
    v_mul_f32 v81, v81, v79
    v_fmac_f32 v81, v46, v22
    v_mul_f32 v70, 0x3ec80000, v10
    v_cos_f32 v79, v70
    v_sin_f32 v22, v70
    s_nop 0
    v_mul_f32 v46, v50, v79
    v_fma_f32 v46, -v33, v22, v46
    v_mul_f32 v33, v33, v79
    v_fmac_f32 v33, v50, v22
    v_mul_f32 v70, 0x3ed00000, v10
    v_cos_f32 v79, v70
    v_sin_f32 v22, v70
    s_nop 0
    v_mul_f32 v50, v83, v79
    v_fma_f32 v50, -v47, v22, v50
    v_mul_f32 v47, v47, v79
    v_fmac_f32 v47, v83, v22
    v_mul_f32 v70, 0x3ed80000, v10
    v_cos_f32 v79, v70
    v_sin_f32 v22, v70
    s_nop 0
    v_mul_f32 v83, v78, v79
    v_fma_f32 v83, -v51, v22, v83
    v_mul_f32 v51, v51, v79
    v_fmac_f32 v51, v78, v22
    v_mul_f32 v70, 0x3ee00000, v10
    v_cos_f32 v79, v70
    v_sin_f32 v22, v70
    s_nop 0
    v_mul_f32 v78, v76, v79
    v_fma_f32 v78, -v45, v22, v78
    v_mul_f32 v45, v45, v79
    v_fmac_f32 v45, v76, v22
    v_mul_f32 v70, 0x3ee80000, v10
    v_cos_f32 v79, v70
    v_sin_f32 v22, v70
    s_nop 0
    v_mul_f32 v76, v18, v79
    v_fma_f32 v76, -v53, v22, v76
    v_mul_f32 v53, v53, v79
    v_fmac_f32 v53, v18, v22
    v_mul_f32 v70, 0x3ef00000, v10
    v_cos_f32 v79, v70
    v_sin_f32 v22, v70
    s_nop 0
    v_mul_f32 v18, v72, v79
    v_fma_f32 v18, -v55, v22, v18
    v_mul_f32 v55, v55, v79
    v_fmac_f32 v55, v72, v22
    v_mul_f32 v70, 0x3ef80000, v10
    v_cos_f32 v79, v70
    v_sin_f32 v22, v70
    s_nop 0
    v_mul_f32 v72, v20, v79
    v_fma_f32 v72, -v59, v22, v72
    v_mul_f32 v59, v59, v79
    v_fmac_f32 v59, v20, v22
    v_sub_f32 v70, v82, v24
    v_sub_f32 v79, v17, v75
    v_add_f32 v82, v82, v24
    v_add_f32 v17, v17, v75
    v_sub_f32 v24, v26, v30
    v_sub_f32 v75, v49, v77
    v_add_f32 v26, v26, v30
    v_add_f32 v49, v49, v77
    v_mul_f32 v30, 0x3f7b14be, v24
    v_mul_f32 v77, 0x3e47c5c2, v24
    v_fmac_f32 v30, 0xbe47c5c2, v75
    v_fmac_f32 v77, 0x3f7b14be, v75
    v_sub_f32 v24, v16, v34
    v_sub_f32 v75, v19, v73
    v_add_f32 v16, v16, v34
    v_add_f32 v19, v19, v73
    v_mul_f32 v34, 0x3f6c835e, v24
    v_mul_f32 v73, 0x3ec3ef15, v24
    v_fmac_f32 v34, 0xbec3ef15, v75
    v_fmac_f32 v73, 0x3f6c835e, v75
    v_sub_f32 v24, v74, v42
    v_sub_f32 v75, v23, v21
    v_add_f32 v74, v74, v42
    v_add_f32 v23, v23, v21
    v_mul_f32 v42, 0x3f54db31, v24
    v_mul_f32 v21, 0x3f0e39da, v24
    v_fmac_f32 v42, 0xbf0e39da, v75
    v_fmac_f32 v21, 0x3f54db31, v75
    v_sub_f32 v24, v48, v60
    v_sub_f32 v75, v27, v65
    v_add_f32 v48, v48, v60
    v_add_f32 v27, v27, v65
    v_mul_f32 v60, 0x3f3504f3, v24
    v_mul_f32 v65, 0x3f3504f3, v24
    v_fmac_f32 v60, 0xbf3504f3, v75
    v_fmac_f32 v65, 0x3f3504f3, v75
    v_sub_f32 v24, v68, v40
    v_sub_f32 v75, v39, v25
    v_add_f32 v68, v68, v40
    v_add_f32 v39, v39, v25
    v_mul_f32 v40, 0x3f0e39da, v24
    v_mul_f32 v25, 0x3f54db31, v24
    v_fmac_f32 v40, 0xbf54db31, v75
    v_fmac_f32 v25, 0x3f0e39da, v75
    v_sub_f32 v24, v62, v56
    v_sub_f32 v75, v29, v31
    v_add_f32 v62, v62, v56
    v_add_f32 v29, v29, v31
    v_mul_f32 v56, 0x3ec3ef15, v24
    v_mul_f32 v31, 0x3f6c835e, v24
    v_fmac_f32 v56, 0xbf6c835e, v75
    v_fmac_f32 v31, 0x3ec3ef15, v75
    v_sub_f32 v24, v66, v80
    v_sub_f32 v75, v37, v35
    v_add_f32 v66, v66, v80
    v_add_f32 v37, v37, v35
    v_mul_f32 v80, 0x3e47c5c2, v24
    v_mul_f32 v35, 0x3f7b14be, v24
    v_fmac_f32 v80, 0xbf7b14be, v75
    v_fmac_f32 v35, 0x3e47c5c2, v75
    v_sub_f32 v24, v81, v43
    v_sub_f32 v75, v54, v32
    v_add_f32 v54, v54, v32
    v_add_f32 v43, v43, v81
    v_sub_f32 v32, v44, v46
    v_sub_f32 v81, v71, v33
    v_add_f32 v44, v44, v46
    v_add_f32 v71, v71, v33
    v_mul_f32 v46, 0xbe47c5c2, v32
    v_mul_f32 v33, 0x3f7b14be, v32
    v_fmac_f32 v46, 0xbf7b14be, v81
    v_fmac_f32 v33, 0xbe47c5c2, v81
    v_sub_f32 v32, v52, v50
    v_sub_f32 v81, v61, v47
    v_add_f32 v52, v52, v50
    v_add_f32 v61, v61, v47
    v_mul_f32 v50, 0xbec3ef15, v32
    v_mul_f32 v47, 0x3f6c835e, v32
    v_fmac_f32 v50, 0xbf6c835e, v81
    v_fmac_f32 v47, 0xbec3ef15, v81
    v_sub_f32 v32, v58, v83
    v_sub_f32 v81, v69, v51
    v_add_f32 v58, v58, v83
    v_add_f32 v69, v69, v51
    v_mul_f32 v83, 0xbf0e39da, v32
    v_mul_f32 v51, 0x3f54db31, v32
    v_fmac_f32 v83, 0xbf54db31, v81
    v_fmac_f32 v51, 0xbf0e39da, v81
    v_sub_f32 v32, v38, v78
    v_sub_f32 v81, v41, v45
    v_add_f32 v38, v38, v78
    v_add_f32 v41, v41, v45
    v_mul_f32 v78, 0xbf3504f3, v32
    v_mul_f32 v45, 0x3f3504f3, v32
    v_fmac_f32 v78, 0xbf3504f3, v81
    v_fmac_f32 v45, 0xbf3504f3, v81
    v_sub_f32 v32, v28, v76
    v_sub_f32 v81, v57, v53
    v_add_f32 v28, v28, v76
    v_add_f32 v57, v57, v53
    v_mul_f32 v76, 0xbf54db31, v32
    v_mul_f32 v53, 0x3f0e39da, v32
    v_fmac_f32 v76, 0xbf0e39da, v81
    v_fmac_f32 v53, 0xbf54db31, v81
    v_sub_f32 v32, v36, v18
    v_sub_f32 v81, v63, v55
    v_add_f32 v36, v36, v18
    v_add_f32 v63, v63, v55
    v_mul_f32 v18, 0xbf6c835e, v32
    v_mul_f32 v55, 0x3ec3ef15, v32
    v_fmac_f32 v18, 0xbec3ef15, v81
    v_fmac_f32 v55, 0xbf6c835e, v81
    v_sub_f32 v32, v64, v72
    v_sub_f32 v81, v67, v59
    v_add_f32 v64, v64, v72
    v_add_f32 v67, v67, v59
    v_mul_f32 v72, 0xbf7b14be, v32
    v_mul_f32 v59, 0x3e47c5c2, v32
    v_fmac_f32 v72, 0xbe47c5c2, v81
    v_fmac_f32 v59, 0xbf7b14be, v81
    v_sub_f32 v32, v82, v54
    v_sub_f32 v81, v17, v43
    v_add_f32 v82, v82, v54
    v_add_f32 v17, v17, v43
    v_sub_f32 v54, v26, v44
    v_sub_f32 v43, v49, v71
    v_add_f32 v26, v26, v44
    v_add_f32 v49, v49, v71
    v_mul_f32 v44, 0x3f6c835e, v54
    v_mul_f32 v71, 0x3ec3ef15, v54
    v_fmac_f32 v44, 0xbec3ef15, v43
    v_fmac_f32 v71, 0x3f6c835e, v43
    v_sub_f32 v54, v16, v52
    v_sub_f32 v43, v19, v61
    v_add_f32 v16, v16, v52
    v_add_f32 v19, v19, v61
    v_mul_f32 v52, 0x3f3504f3, v54
    v_mul_f32 v61, 0x3f3504f3, v54
    v_fmac_f32 v52, 0xbf3504f3, v43
    v_fmac_f32 v61, 0x3f3504f3, v43
    v_sub_f32 v54, v74, v58
    v_sub_f32 v43, v23, v69
    v_add_f32 v74, v74, v58
    v_add_f32 v23, v23, v69
    v_mul_f32 v58, 0x3ec3ef15, v54
    v_mul_f32 v69, 0x3f6c835e, v54
    v_fmac_f32 v58, 0xbf6c835e, v43
    v_fmac_f32 v69, 0x3ec3ef15, v43
    v_sub_f32 v54, v41, v27
    v_sub_f32 v43, v48, v38
    v_add_f32 v48, v48, v38
    v_add_f32 v27, v27, v41
    v_sub_f32 v38, v68, v28
    v_sub_f32 v41, v39, v57
    v_add_f32 v68, v68, v28
    v_add_f32 v39, v39, v57
    v_mul_f32 v28, 0xbec3ef15, v38
    v_mul_f32 v57, 0x3f6c835e, v38
    v_fmac_f32 v28, 0xbf6c835e, v41
    v_fmac_f32 v57, 0xbec3ef15, v41
    v_sub_f32 v38, v62, v36
    v_sub_f32 v41, v29, v63
    v_add_f32 v62, v62, v36
    v_add_f32 v29, v29, v63
    v_mul_f32 v36, 0xbf3504f3, v38
    v_mul_f32 v63, 0x3f3504f3, v38
    v_fmac_f32 v36, 0xbf3504f3, v41
    v_fmac_f32 v63, 0xbf3504f3, v41
    v_sub_f32 v38, v66, v64
    v_sub_f32 v41, v37, v67
    v_add_f32 v66, v66, v64
    v_add_f32 v37, v37, v67
    v_mul_f32 v64, 0xbf6c835e, v38
    v_mul_f32 v67, 0x3ec3ef15, v38
    v_fmac_f32 v64, 0xbec3ef15, v41
    v_fmac_f32 v67, 0xbf6c835e, v41
    v_sub_f32 v38, v70, v24
    v_sub_f32 v41, v79, v75
    v_add_f32 v70, v70, v24
    v_add_f32 v79, v79, v75
    v_sub_f32 v24, v30, v46
    v_sub_f32 v75, v77, v33
    v_add_f32 v30, v30, v46
    v_add_f32 v77, v77, v33
    v_mul_f32 v46, 0x3f6c835e, v24
    v_mul_f32 v33, 0x3ec3ef15, v24
    v_fmac_f32 v46, 0xbec3ef15, v75
    v_fmac_f32 v33, 0x3f6c835e, v75
    v_sub_f32 v24, v34, v50
    v_sub_f32 v75, v73, v47
    v_add_f32 v34, v34, v50
    v_add_f32 v73, v73, v47
    v_mul_f32 v50, 0x3f3504f3, v24
    v_mul_f32 v47, 0x3f3504f3, v24
    v_fmac_f32 v50, 0xbf3504f3, v75
    v_fmac_f32 v47, 0x3f3504f3, v75
    v_sub_f32 v24, v42, v83
    v_sub_f32 v75, v21, v51
    v_add_f32 v42, v42, v83
    v_add_f32 v21, v21, v51
    v_mul_f32 v83, 0x3ec3ef15, v24
    v_mul_f32 v51, 0x3f6c835e, v24
    v_fmac_f32 v83, 0xbf6c835e, v75
    v_fmac_f32 v51, 0x3ec3ef15, v75
    v_sub_f32 v24, v45, v65
    v_sub_f32 v75, v60, v78
    v_add_f32 v60, v60, v78
    v_add_f32 v65, v65, v45
    v_sub_f32 v78, v40, v76
    v_sub_f32 v45, v25, v53
    v_add_f32 v40, v40, v76
    v_add_f32 v25, v25, v53
    v_mul_f32 v76, 0xbec3ef15, v78
    v_mul_f32 v53, 0x3f6c835e, v78
    v_fmac_f32 v76, 0xbf6c835e, v45
    v_fmac_f32 v53, 0xbec3ef15, v45
    v_sub_f32 v78, v56, v18
    v_sub_f32 v45, v31, v55
    v_add_f32 v56, v56, v18
    v_add_f32 v31, v31, v55
    v_mul_f32 v18, 0xbf3504f3, v78
    v_mul_f32 v55, 0x3f3504f3, v78
    v_fmac_f32 v18, 0xbf3504f3, v45
    v_fmac_f32 v55, 0xbf3504f3, v45
    v_sub_f32 v78, v80, v72
    v_sub_f32 v45, v35, v59
    v_add_f32 v80, v80, v72
    v_add_f32 v35, v35, v59
    v_mul_f32 v72, 0xbf6c835e, v78
    v_mul_f32 v59, 0x3ec3ef15, v78
    v_fmac_f32 v72, 0xbec3ef15, v45
    v_fmac_f32 v59, 0xbf6c835e, v45
    v_sub_f32 v78, v82, v48
    v_sub_f32 v45, v17, v27
    v_add_f32 v82, v82, v48
    v_add_f32 v17, v17, v27
    v_sub_f32 v48, v26, v68
    v_sub_f32 v27, v49, v39
    v_add_f32 v26, v26, v68
    v_add_f32 v49, v49, v39
    v_mul_f32 v68, 0x3f3504f3, v48
    v_mul_f32 v39, 0x3f3504f3, v48
    v_fmac_f32 v68, 0xbf3504f3, v27
    v_fmac_f32 v39, 0x3f3504f3, v27
    v_sub_f32 v48, v29, v19
    v_sub_f32 v27, v16, v62
    v_add_f32 v16, v16, v62
    v_add_f32 v19, v19, v29
    v_sub_f32 v62, v74, v66
    v_sub_f32 v29, v23, v37
    v_add_f32 v74, v74, v66
    v_add_f32 v23, v23, v37
    v_mul_f32 v66, 0xbf3504f3, v62
    v_mul_f32 v37, 0x3f3504f3, v62
    v_fmac_f32 v66, 0xbf3504f3, v29
    v_fmac_f32 v37, 0xbf3504f3, v29
    v_sub_f32 v62, v32, v54
    v_sub_f32 v29, v81, v43
    v_add_f32 v32, v32, v54
    v_add_f32 v81, v81, v43
    v_sub_f32 v54, v44, v28
    v_sub_f32 v43, v71, v57
    v_add_f32 v44, v44, v28
    v_add_f32 v71, v71, v57
    v_mul_f32 v28, 0x3f3504f3, v54
    v_mul_f32 v57, 0x3f3504f3, v54
    v_fmac_f32 v28, 0xbf3504f3, v43
    v_fmac_f32 v57, 0x3f3504f3, v43
    v_sub_f32 v54, v63, v61
    v_sub_f32 v43, v52, v36
    v_add_f32 v52, v52, v36
    v_add_f32 v61, v61, v63
    v_sub_f32 v36, v58, v64
    v_sub_f32 v63, v69, v67
    v_add_f32 v58, v58, v64
    v_add_f32 v69, v69, v67
    v_mul_f32 v64, 0xbf3504f3, v36
    v_mul_f32 v67, 0x3f3504f3, v36
    v_fmac_f32 v64, 0xbf3504f3, v63
    v_fmac_f32 v67, 0xbf3504f3, v63
    v_sub_f32 v36, v70, v60
    v_sub_f32 v63, v79, v65
    v_add_f32 v70, v70, v60
    v_add_f32 v79, v79, v65
    v_sub_f32 v60, v30, v40
    v_sub_f32 v65, v77, v25
    v_add_f32 v30, v30, v40
    v_add_f32 v77, v77, v25
    v_mul_f32 v40, 0x3f3504f3, v60
    v_mul_f32 v25, 0x3f3504f3, v60
    v_fmac_f32 v40, 0xbf3504f3, v65
    v_fmac_f32 v25, 0x3f3504f3, v65
    v_sub_f32 v60, v31, v73
    v_sub_f32 v65, v34, v56
    v_add_f32 v34, v34, v56
    v_add_f32 v73, v73, v31
    v_sub_f32 v56, v42, v80
    v_sub_f32 v31, v21, v35
    v_add_f32 v42, v42, v80
    v_add_f32 v21, v21, v35
    v_mul_f32 v80, 0xbf3504f3, v56
    v_mul_f32 v35, 0x3f3504f3, v56
    v_fmac_f32 v80, 0xbf3504f3, v31
    v_fmac_f32 v35, 0xbf3504f3, v31
    v_sub_f32 v56, v38, v24
    v_sub_f32 v31, v41, v75
    v_add_f32 v38, v38, v24
    v_add_f32 v41, v41, v75
    v_sub_f32 v24, v46, v76
    v_sub_f32 v75, v33, v53
    v_add_f32 v46, v46, v76
    v_add_f32 v33, v33, v53
    v_mul_f32 v76, 0x3f3504f3, v24
    v_mul_f32 v53, 0x3f3504f3, v24
    v_fmac_f32 v76, 0xbf3504f3, v75
    v_fmac_f32 v53, 0x3f3504f3, v75
    v_sub_f32 v24, v55, v47
    v_sub_f32 v75, v50, v18
    v_add_f32 v50, v50, v18
    v_add_f32 v47, v47, v55
    v_sub_f32 v18, v83, v72
    v_sub_f32 v55, v51, v59
    v_add_f32 v83, v83, v72
    v_add_f32 v51, v51, v59
    v_mul_f32 v72, 0xbf3504f3, v18
    v_mul_f32 v59, 0x3f3504f3, v18
    v_fmac_f32 v72, 0xbf3504f3, v55
    v_fmac_f32 v59, 0xbf3504f3, v55
    v_sub_f32 v18, v82, v16
    v_sub_f32 v55, v17, v19
    v_add_f32 v82, v82, v16
    v_add_f32 v17, v17, v19
    v_sub_f32 v16, v23, v49
    v_sub_f32 v19, v26, v74
    v_add_f32 v26, v26, v74
    v_add_f32 v49, v49, v23
    v_sub_f32 v74, v78, v48
    v_sub_f32 v23, v45, v27
    v_add_f32 v78, v78, v48
    v_add_f32 v45, v45, v27
    v_sub_f32 v48, v37, v39
    v_sub_f32 v27, v68, v66
    v_add_f32 v68, v68, v66
    v_add_f32 v39, v39, v37
    v_sub_f32 v66, v32, v52
    v_sub_f32 v37, v81, v61
    v_add_f32 v32, v32, v52
    v_add_f32 v81, v81, v61
    v_sub_f32 v52, v69, v71
    v_sub_f32 v61, v44, v58
    v_add_f32 v44, v44, v58
    v_add_f32 v71, v71, v69
    v_sub_f32 v58, v62, v54
    v_sub_f32 v69, v29, v43
    v_add_f32 v62, v62, v54
    v_add_f32 v29, v29, v43
    v_sub_f32 v54, v67, v57
    v_sub_f32 v43, v28, v64
    v_add_f32 v28, v28, v64
    v_add_f32 v57, v57, v67
    v_sub_f32 v64, v70, v34
    v_sub_f32 v67, v79, v73
    v_add_f32 v70, v70, v34
    v_add_f32 v79, v79, v73
    v_sub_f32 v34, v21, v77
    v_sub_f32 v73, v30, v42
    v_add_f32 v30, v30, v42
    v_add_f32 v77, v77, v21
    v_sub_f32 v42, v36, v60
    v_sub_f32 v21, v63, v65
    v_add_f32 v36, v36, v60
    v_add_f32 v63, v63, v65
    v_sub_f32 v60, v35, v25
    v_sub_f32 v65, v40, v80
    v_add_f32 v40, v40, v80
    v_add_f32 v25, v25, v35
    v_sub_f32 v80, v38, v50
    v_sub_f32 v35, v41, v47
    v_add_f32 v38, v38, v50
    v_add_f32 v41, v41, v47
    v_sub_f32 v50, v51, v33
    v_sub_f32 v47, v46, v83
    v_add_f32 v46, v46, v83
    v_add_f32 v33, v33, v51
    v_sub_f32 v83, v56, v24
    v_sub_f32 v51, v31, v75
    v_add_f32 v56, v56, v24
    v_add_f32 v31, v31, v75
    v_sub_f32 v24, v59, v53
    v_sub_f32 v75, v76, v72
    v_add_f32 v76, v76, v72
    v_add_f32 v53, v53, v59
    v_sub_f32 v72, v82, v26
    v_sub_f32 v59, v17, v49
    v_add_f32 v82, v82, v26
    v_add_f32 v17, v17, v49
    v_sub_f32 v26, v18, v16
    v_sub_f32 v49, v55, v19
    v_add_f32 v18, v18, v16
    v_add_f32 v55, v55, v19
    v_sub_f32 v16, v78, v68
    v_sub_f32 v19, v45, v39
    v_add_f32 v78, v78, v68
    v_add_f32 v45, v45, v39
    v_sub_f32 v68, v74, v48
    v_sub_f32 v39, v23, v27
    v_add_f32 v74, v74, v48
    v_add_f32 v23, v23, v27
    v_sub_f32 v48, v32, v44
    v_sub_f32 v27, v81, v71
    v_add_f32 v32, v32, v44
    v_add_f32 v81, v81, v71
    v_sub_f32 v44, v66, v52
    v_sub_f32 v71, v37, v61
    v_add_f32 v66, v66, v52
    v_add_f32 v37, v37, v61
    v_sub_f32 v52, v62, v28
    v_sub_f32 v61, v29, v57
    v_add_f32 v62, v62, v28
    v_add_f32 v29, v29, v57
    v_sub_f32 v28, v58, v54
    v_sub_f32 v57, v69, v43
    v_add_f32 v58, v58, v54
    v_add_f32 v69, v69, v43
    v_sub_f32 v54, v70, v30
    v_sub_f32 v43, v79, v77
    v_add_f32 v70, v70, v30
    v_add_f32 v79, v79, v77
    v_sub_f32 v30, v64, v34
    v_sub_f32 v77, v67, v73
    v_add_f32 v64, v64, v34
    v_add_f32 v67, v67, v73
    v_sub_f32 v34, v36, v40
    v_sub_f32 v73, v63, v25
    v_add_f32 v36, v36, v40
    v_add_f32 v63, v63, v25
    v_sub_f32 v40, v42, v60
    v_sub_f32 v25, v21, v65
    v_add_f32 v42, v42, v60
    v_add_f32 v21, v21, v65
    v_sub_f32 v60, v38, v46
    v_sub_f32 v65, v41, v33
    v_add_f32 v38, v38, v46
    v_add_f32 v41, v41, v33
    v_sub_f32 v46, v80, v50
    v_sub_f32 v33, v35, v47
    v_add_f32 v80, v80, v50
    v_add_f32 v35, v35, v47
    v_sub_f32 v50, v56, v76
    v_sub_f32 v47, v31, v53
    v_add_f32 v56, v56, v76
    v_add_f32 v31, v31, v53
    v_sub_f32 v76, v83, v24
    v_sub_f32 v53, v51, v75
    v_add_f32 v83, v83, v24
    v_add_f32 v51, v51, v75
    v_mul_f32 v12, v10, v8
    v_mul_f32 v12, 0x3a000000, v12
    v_mov_b32 v24, v12
    v_fmac_f32 v24, 0x00000000, v8
    v_cos_f32 v75, v24
    v_sin_f32 v22, v24
    s_nop 0
    v_mul_f32 v20, v82, v75
    v_fma_f32 v20, -v17, v22, v20
    v_mul_f32 v17, v17, v75
    v_fmac_f32 v17, v82, v22
    v_mov_b32 v24, v12
    v_fmac_f32 v24, 0x3a800000, v8
    v_cos_f32 v75, v24
    v_sin_f32 v22, v24
    s_nop 0
    v_mul_f32 v82, v70, v75
    v_fma_f32 v82, -v79, v22, v82
    v_mul_f32 v79, v79, v75
    v_fmac_f32 v79, v70, v22
    v_mov_b32 v24, v12
    v_fmac_f32 v24, 0x3b000000, v8
    v_cos_f32 v75, v24
    v_sin_f32 v22, v24
    s_nop 0
    v_mul_f32 v70, v32, v75
    v_fma_f32 v70, -v81, v22, v70
    v_mul_f32 v81, v81, v75
    v_fmac_f32 v81, v32, v22
    v_mov_b32 v24, v12
    v_fmac_f32 v24, 0x3b400000, v8
    v_cos_f32 v75, v24
    v_sin_f32 v22, v24
    s_nop 0
    v_mul_f32 v32, v38, v75
    v_fma_f32 v32, -v41, v22, v32
    v_mul_f32 v41, v41, v75
    v_fmac_f32 v41, v38, v22
    v_mov_b32 v24, v12
    v_fmac_f32 v24, 0x3b800000, v8
    v_cos_f32 v75, v24
    v_sin_f32 v22, v24
    s_nop 0
    v_mul_f32 v38, v78, v75
    v_fma_f32 v38, -v45, v22, v38
    v_mul_f32 v45, v45, v75
    v_fmac_f32 v45, v78, v22
    v_mov_b32 v24, v12
    v_fmac_f32 v24, 0x3ba00000, v8
    v_cos_f32 v75, v24
    v_sin_f32 v22, v24
    s_nop 0
    v_mul_f32 v78, v36, v75
    v_fma_f32 v78, -v63, v22, v78
    v_mul_f32 v63, v63, v75
    v_fmac_f32 v63, v36, v22
    v_mov_b32 v24, v12
    v_fmac_f32 v24, 0x3bc00000, v8
    v_cos_f32 v75, v24
    v_sin_f32 v22, v24
    s_nop 0
    v_mul_f32 v36, v62, v75
    v_fma_f32 v36, -v29, v22, v36
    v_mul_f32 v29, v29, v75
    v_fmac_f32 v29, v62, v22
    v_mov_b32 v24, v12
    v_fmac_f32 v24, 0x3be00000, v8
    v_cos_f32 v75, v24
    v_sin_f32 v22, v24
    s_nop 0
    v_mul_f32 v62, v56, v75
    v_fma_f32 v62, -v31, v22, v62
    v_mul_f32 v31, v31, v75
    v_fmac_f32 v31, v56, v22
    v_mov_b32 v24, v12
    v_fmac_f32 v24, 0x3c000000, v8
    v_cos_f32 v75, v24
    v_sin_f32 v22, v24
    s_nop 0
    v_mul_f32 v56, v18, v75
    v_fma_f32 v56, -v55, v22, v56
    v_mul_f32 v55, v55, v75
    v_fmac_f32 v55, v18, v22
    v_mov_b32 v24, v12
    v_fmac_f32 v24, 0x3c100000, v8
    v_cos_f32 v75, v24
    v_sin_f32 v22, v24
    s_nop 0
    v_mul_f32 v18, v64, v75
    v_fma_f32 v18, -v67, v22, v18
    v_mul_f32 v67, v67, v75
    v_fmac_f32 v67, v64, v22
    v_mov_b32 v24, v12
    v_fmac_f32 v24, 0x3c200000, v8
    v_cos_f32 v75, v24
    v_sin_f32 v22, v24
    s_nop 0
    v_mul_f32 v64, v66, v75
    v_fma_f32 v64, -v37, v22, v64
    v_mul_f32 v37, v37, v75
    v_fmac_f32 v37, v66, v22
    v_mov_b32 v24, v12
    v_fmac_f32 v24, 0x3c300000, v8
    v_cos_f32 v75, v24
    v_sin_f32 v22, v24
    s_nop 0
    v_mul_f32 v66, v80, v75
    v_fma_f32 v66, -v35, v22, v66
    v_mul_f32 v35, v35, v75
    v_fmac_f32 v35, v80, v22
    v_mov_b32 v24, v12
    v_fmac_f32 v24, 0x3c400000, v8
    v_cos_f32 v75, v24
    v_sin_f32 v22, v24
    s_nop 0
    v_mul_f32 v80, v74, v75
    v_fma_f32 v80, -v23, v22, v80
    v_mul_f32 v23, v23, v75
    v_fmac_f32 v23, v74, v22
    v_mov_b32 v24, v12
    v_fmac_f32 v24, 0x3c500000, v8
    v_cos_f32 v75, v24
    v_sin_f32 v22, v24
    s_nop 0
    v_mul_f32 v74, v42, v75
    v_fma_f32 v74, -v21, v22, v74
    v_mul_f32 v21, v21, v75
    v_fmac_f32 v21, v42, v22
    v_mov_b32 v24, v12
    v_fmac_f32 v24, 0x3c600000, v8
    v_cos_f32 v75, v24
    v_sin_f32 v22, v24
    s_nop 0
    v_mul_f32 v42, v58, v75
    v_fma_f32 v42, -v69, v22, v42
    v_mul_f32 v69, v69, v75
    v_fmac_f32 v69, v58, v22
    v_mov_b32 v24, v12
    v_fmac_f32 v24, 0x3c700000, v8
    v_cos_f32 v75, v24
    v_sin_f32 v22, v24
    s_nop 0
    v_mul_f32 v58, v83, v75
    v_fma_f32 v58, -v51, v22, v58
    v_mul_f32 v51, v51, v75
    v_fmac_f32 v51, v83, v22
    v_mov_b32 v24, v12
    v_fmac_f32 v24, 0x3c800000, v8
    v_cos_f32 v75, v24
    v_sin_f32 v22, v24
    s_nop 0
    v_mul_f32 v83, v72, v75
    v_fma_f32 v83, -v59, v22, v83
    v_mul_f32 v59, v59, v75
    v_fmac_f32 v59, v72, v22
    v_mov_b32 v24, v12
    v_fmac_f32 v24, 0x3c880000, v8
    v_cos_f32 v75, v24
    v_sin_f32 v22, v24
    s_nop 0
    v_mul_f32 v72, v54, v75
    v_fma_f32 v72, -v43, v22, v72
    v_mul_f32 v43, v43, v75
    v_fmac_f32 v43, v54, v22
    v_mov_b32 v24, v12
    v_fmac_f32 v24, 0x3c900000, v8
    v_cos_f32 v75, v24
    v_sin_f32 v22, v24
    s_nop 0
    v_mul_f32 v54, v48, v75
    v_fma_f32 v54, -v27, v22, v54
    v_mul_f32 v27, v27, v75
    v_fmac_f32 v27, v48, v22
    v_mov_b32 v24, v12
    v_fmac_f32 v24, 0x3c980000, v8
    v_cos_f32 v75, v24
    v_sin_f32 v22, v24
    s_nop 0
    v_mul_f32 v48, v60, v75
    v_fma_f32 v48, -v65, v22, v48
    v_mul_f32 v65, v65, v75
    v_fmac_f32 v65, v60, v22
    v_mov_b32 v24, v12
    v_fmac_f32 v24, 0x3ca00000, v8
    v_cos_f32 v75, v24
    v_sin_f32 v22, v24
    s_nop 0
    v_mul_f32 v60, v16, v75
    v_fma_f32 v60, -v19, v22, v60
    v_mul_f32 v19, v19, v75
    v_fmac_f32 v19, v16, v22
    v_mov_b32 v24, v12
    v_fmac_f32 v24, 0x3ca80000, v8
    v_cos_f32 v75, v24
    v_sin_f32 v22, v24
    s_nop 0
    v_mul_f32 v16, v34, v75
    v_fma_f32 v16, -v73, v22, v16
    v_mul_f32 v73, v73, v75
    v_fmac_f32 v73, v34, v22
    v_mov_b32 v24, v12
    v_fmac_f32 v24, 0x3cb00000, v8
    v_cos_f32 v75, v24
    v_sin_f32 v22, v24
    s_nop 0
    v_mul_f32 v34, v52, v75
    v_fma_f32 v34, -v61, v22, v34
    v_mul_f32 v61, v61, v75
    v_fmac_f32 v61, v52, v22
    v_mov_b32 v24, v12
    v_fmac_f32 v24, 0x3cb80000, v8
    v_cos_f32 v75, v24
    v_sin_f32 v22, v24
    s_nop 0
    v_mul_f32 v52, v50, v75
    v_fma_f32 v52, -v47, v22, v52
    v_mul_f32 v47, v47, v75
    v_fmac_f32 v47, v50, v22
    v_mov_b32 v24, v12
    v_fmac_f32 v24, 0x3cc00000, v8
    v_cos_f32 v75, v24
    v_sin_f32 v22, v24
    s_nop 0
    v_mul_f32 v50, v26, v75
    v_fma_f32 v50, -v49, v22, v50
    v_mul_f32 v49, v49, v75
    v_fmac_f32 v49, v26, v22
    v_mov_b32 v24, v12
    v_fmac_f32 v24, 0x3cc80000, v8
    v_cos_f32 v75, v24
    v_sin_f32 v22, v24
    s_nop 0
    v_mul_f32 v26, v30, v75
    v_fma_f32 v26, -v77, v22, v26
    v_mul_f32 v77, v77, v75
    v_fmac_f32 v77, v30, v22
    v_mov_b32 v24, v12
    v_fmac_f32 v24, 0x3cd00000, v8
    v_cos_f32 v75, v24
    v_sin_f32 v22, v24
    s_nop 0
    v_mul_f32 v30, v44, v75
    v_fma_f32 v30, -v71, v22, v30
    v_mul_f32 v71, v71, v75
    v_fmac_f32 v71, v44, v22
    v_mov_b32 v24, v12
    v_fmac_f32 v24, 0x3cd80000, v8
    v_cos_f32 v75, v24
    v_sin_f32 v22, v24
    s_nop 0
    v_mul_f32 v44, v46, v75
    v_fma_f32 v44, -v33, v22, v44
    v_mul_f32 v33, v33, v75
    v_fmac_f32 v33, v46, v22
    v_mov_b32 v24, v12
    v_fmac_f32 v24, 0x3ce00000, v8
    v_cos_f32 v75, v24
    v_sin_f32 v22, v24
    s_nop 0
    v_mul_f32 v46, v68, v75
    v_fma_f32 v46, -v39, v22, v46
    v_mul_f32 v39, v39, v75
    v_fmac_f32 v39, v68, v22
    v_mov_b32 v24, v12
    v_fmac_f32 v24, 0x3ce80000, v8
    v_cos_f32 v75, v24
    v_sin_f32 v22, v24
    s_nop 0
    v_mul_f32 v68, v40, v75
    v_fma_f32 v68, -v25, v22, v68
    v_mul_f32 v25, v25, v75
    v_fmac_f32 v25, v40, v22
    v_mov_b32 v24, v12
    v_fmac_f32 v24, 0x3cf00000, v8
    v_cos_f32 v75, v24
    v_sin_f32 v22, v24
    s_nop 0
    v_mul_f32 v40, v28, v75
    v_fma_f32 v40, -v57, v22, v40
    v_mul_f32 v57, v57, v75
    v_fmac_f32 v57, v28, v22
    v_mov_b32 v24, v12
    v_fmac_f32 v24, 0x3cf80000, v8
    v_cos_f32 v75, v24
    v_sin_f32 v22, v24
    s_nop 0
    v_mul_f32 v28, v76, v75
    v_fma_f32 v28, -v53, v22, v28
    v_mul_f32 v53, v53, v75
    v_fmac_f32 v53, v76, v22
    ds_write_b32 v4, v20 offset:0
    ds_write_b32 v4, v17 offset:4
    ds_write_b32 v4, v82 offset:16
    ds_write_b32 v4, v79 offset:20
    ds_write_b32 v4, v70 offset:32
    ds_write_b32 v4, v81 offset:36
    ds_write_b32 v4, v32 offset:48
    ds_write_b32 v4, v41 offset:52
    ds_write_b32 v4, v38 offset:64
    ds_write_b32 v4, v45 offset:68
    ds_write_b32 v4, v78 offset:80
    ds_write_b32 v4, v63 offset:84
    ds_write_b32 v4, v36 offset:96
    ds_write_b32 v4, v29 offset:100
    ds_write_b32 v4, v62 offset:112
    ds_write_b32 v4, v31 offset:116
    ds_write_b32 v4, v56 offset:128
    ds_write_b32 v4, v55 offset:132
    ds_write_b32 v4, v18 offset:144
    ds_write_b32 v4, v67 offset:148
    ds_write_b32 v4, v64 offset:160
    ds_write_b32 v4, v37 offset:164
    ds_write_b32 v4, v66 offset:176
    ds_write_b32 v4, v35 offset:180
    ds_write_b32 v4, v80 offset:192
    ds_write_b32 v4, v23 offset:196
    ds_write_b32 v4, v74 offset:208
    ds_write_b32 v4, v21 offset:212
    ds_write_b32 v4, v42 offset:224
    ds_write_b32 v4, v69 offset:228
    ds_write_b32 v4, v58 offset:240
    ds_write_b32 v4, v51 offset:244
    ds_write_b32 v4, v83 offset:256
    ds_write_b32 v4, v59 offset:260
    ds_write_b32 v4, v72 offset:272
    ds_write_b32 v4, v43 offset:276
    ds_write_b32 v4, v54 offset:288
    ds_write_b32 v4, v27 offset:292
    ds_write_b32 v4, v48 offset:304
    ds_write_b32 v4, v65 offset:308
    ds_write_b32 v4, v60 offset:320
    ds_write_b32 v4, v19 offset:324
    ds_write_b32 v4, v16 offset:336
    ds_write_b32 v4, v73 offset:340
    ds_write_b32 v4, v34 offset:352
    ds_write_b32 v4, v61 offset:356
    ds_write_b32 v4, v52 offset:368
    ds_write_b32 v4, v47 offset:372
    ds_write_b32 v4, v50 offset:384
    ds_write_b32 v4, v49 offset:388
    ds_write_b32 v4, v26 offset:400
    ds_write_b32 v4, v77 offset:404
    ds_write_b32 v4, v30 offset:416
    ds_write_b32 v4, v71 offset:420
    ds_write_b32 v4, v44 offset:432
    ds_write_b32 v4, v33 offset:436
    ds_write_b32 v4, v46 offset:448
    ds_write_b32 v4, v39 offset:452
    ds_write_b32 v4, v68 offset:464
    ds_write_b32 v4, v25 offset:468
    ds_write_b32 v4, v40 offset:480
    ds_write_b32 v4, v57 offset:484
    ds_write_b32 v4, v28 offset:496
    ds_write_b32 v4, v53 offset:500
    s_waitcnt lgkmcnt(0)
    ds_read_b32 v20, v3 offset:0
    ds_read_b32 v17, v3 offset:4
    ds_read_b32 v82, v3 offset:528
    ds_read_b32 v79, v3 offset:532
    ds_read_b32 v70, v3 offset:1056
    ds_read_b32 v81, v3 offset:1060
    ds_read_b32 v32, v3 offset:1584
    ds_read_b32 v41, v3 offset:1588
    ds_read_b32 v38, v3 offset:2112
    ds_read_b32 v45, v3 offset:2116
    ds_read_b32 v78, v3 offset:2640
    ds_read_b32 v63, v3 offset:2644
    ds_read_b32 v36, v3 offset:3168
    ds_read_b32 v29, v3 offset:3172
    s_waitcnt lgkmcnt(0)
    ds_read_b32 v62, v3 offset:3696
    ds_read_b32 v31, v3 offset:3700
    ds_read_b32 v56, v3 offset:4224
    ds_read_b32 v55, v3 offset:4228
    ds_read_b32 v18, v3 offset:4752
    ds_read_b32 v67, v3 offset:4756
    ds_read_b32 v64, v3 offset:5280
    ds_read_b32 v37, v3 offset:5284
    ds_read_b32 v66, v3 offset:5808
    ds_read_b32 v35, v3 offset:5812
    ds_read_b32 v80, v3 offset:6336
    ds_read_b32 v23, v3 offset:6340
    ds_read_b32 v74, v3 offset:6864
    ds_read_b32 v21, v3 offset:6868
    s_waitcnt lgkmcnt(0)
    ds_read_b32 v42, v3 offset:7392
    ds_read_b32 v69, v3 offset:7396
    ds_read_b32 v58, v3 offset:7920
    ds_read_b32 v51, v3 offset:7924
    ds_read_b32 v83, v3 offset:8448
    ds_read_b32 v59, v3 offset:8452
    ds_read_b32 v72, v3 offset:8976
    ds_read_b32 v43, v3 offset:8980
    ds_read_b32 v54, v3 offset:9504
    ds_read_b32 v27, v3 offset:9508
    ds_read_b32 v48, v3 offset:10032
    ds_read_b32 v65, v3 offset:10036
    ds_read_b32 v60, v3 offset:10560
    ds_read_b32 v19, v3 offset:10564
    s_waitcnt lgkmcnt(0)
    ds_read_b32 v16, v3 offset:11088
    ds_read_b32 v73, v3 offset:11092
    ds_read_b32 v34, v3 offset:11616
    ds_read_b32 v61, v3 offset:11620
    ds_read_b32 v52, v3 offset:12144
    ds_read_b32 v47, v3 offset:12148
    ds_read_b32 v50, v3 offset:12672
    ds_read_b32 v49, v3 offset:12676
    ds_read_b32 v26, v3 offset:13200
    ds_read_b32 v77, v3 offset:13204
    ds_read_b32 v30, v3 offset:13728
    ds_read_b32 v71, v3 offset:13732
    ds_read_b32 v44, v3 offset:14256
    ds_read_b32 v33, v3 offset:14260
    s_waitcnt lgkmcnt(0)
    ds_read_b32 v46, v3 offset:14784
    ds_read_b32 v39, v3 offset:14788
    ds_read_b32 v68, v3 offset:15312
    ds_read_b32 v25, v3 offset:15316
    ds_read_b32 v40, v3 offset:15840
    ds_read_b32 v57, v3 offset:15844
    ds_read_b32 v28, v3 offset:16368
    ds_read_b32 v53, v3 offset:16372
    s_waitcnt lgkmcnt(0)
    v_sub_f32 v24, v20, v83
    v_sub_f32 v75, v17, v59
    v_add_f32 v20, v20, v83
    v_add_f32 v17, v17, v59
    v_sub_f32 v83, v82, v72
    v_sub_f32 v59, v79, v43
    v_add_f32 v82, v82, v72
    v_add_f32 v79, v79, v43
    v_mul_f32 v72, 0x3f7b14be, v83
    v_mul_f32 v43, 0x3e47c5c2, v83
    v_fmac_f32 v72, 0xbe47c5c2, v59
    v_fmac_f32 v43, 0x3f7b14be, v59
    v_sub_f32 v83, v70, v54
    v_sub_f32 v59, v81, v27
    v_add_f32 v70, v70, v54
    v_add_f32 v81, v81, v27
    v_mul_f32 v54, 0x3f6c835e, v83
    v_mul_f32 v27, 0x3ec3ef15, v83
    v_fmac_f32 v54, 0xbec3ef15, v59
    v_fmac_f32 v27, 0x3f6c835e, v59
    v_sub_f32 v83, v32, v48
    v_sub_f32 v59, v41, v65
    v_add_f32 v32, v32, v48
    v_add_f32 v41, v41, v65
    v_mul_f32 v48, 0x3f54db31, v83
    v_mul_f32 v65, 0x3f0e39da, v83
    v_fmac_f32 v48, 0xbf0e39da, v59
    v_fmac_f32 v65, 0x3f54db31, v59
    v_sub_f32 v83, v38, v60
    v_sub_f32 v59, v45, v19
    v_add_f32 v38, v38, v60
    v_add_f32 v45, v45, v19
    v_mul_f32 v60, 0x3f3504f3, v83
    v_mul_f32 v19, 0x3f3504f3, v83
    v_fmac_f32 v60, 0xbf3504f3, v59
    v_fmac_f32 v19, 0x3f3504f3, v59
    v_sub_f32 v83, v78, v16
    v_sub_f32 v59, v63, v73
    v_add_f32 v78, v78, v16
    v_add_f32 v63, v63, v73
    v_mul_f32 v16, 0x3f0e39da, v83
    v_mul_f32 v73, 0x3f54db31, v83
    v_fmac_f32 v16, 0xbf54db31, v59
    v_fmac_f32 v73, 0x3f0e39da, v59
    v_sub_f32 v83, v36, v34
    v_sub_f32 v59, v29, v61
    v_add_f32 v36, v36, v34
    v_add_f32 v29, v29, v61
    v_mul_f32 v34, 0x3ec3ef15, v83
    v_mul_f32 v61, 0x3f6c835e, v83
    v_fmac_f32 v34, 0xbf6c835e, v59
    v_fmac_f32 v61, 0x3ec3ef15, v59
    v_sub_f32 v83, v62, v52
    v_sub_f32 v59, v31, v47
    v_add_f32 v62, v62, v52
    v_add_f32 v31, v31, v47
    v_mul_f32 v52, 0x3e47c5c2, v83
    v_mul_f32 v47, 0x3f7b14be, v83
    v_fmac_f32 v52, 0xbf7b14be, v59
    v_fmac_f32 v47, 0x3e47c5c2, v59
    v_sub_f32 v83, v49, v55
    v_sub_f32 v59, v56, v50
    v_add_f32 v56, v56, v50
    v_add_f32 v55, v55, v49
    v_sub_f32 v50, v18, v26
    v_sub_f32 v49, v67, v77
    v_add_f32 v18, v18, v26
    v_add_f32 v67, v67, v77
    v_mul_f32 v26, 0xbe47c5c2, v50
    v_mul_f32 v77, 0x3f7b14be, v50
    v_fmac_f32 v26, 0xbf7b14be, v49
    v_fmac_f32 v77, 0xbe47c5c2, v49
    v_sub_f32 v50, v64, v30
    v_sub_f32 v49, v37, v71
    v_add_f32 v64, v64, v30
    v_add_f32 v37, v37, v71
    v_mul_f32 v30, 0xbec3ef15, v50
    v_mul_f32 v71, 0x3f6c835e, v50
    v_fmac_f32 v30, 0xbf6c835e, v49
    v_fmac_f32 v71, 0xbec3ef15, v49
    v_sub_f32 v50, v66, v44
    v_sub_f32 v49, v35, v33
    v_add_f32 v66, v66, v44
    v_add_f32 v35, v35, v33
    v_mul_f32 v44, 0xbf0e39da, v50
    v_mul_f32 v33, 0x3f54db31, v50
    v_fmac_f32 v44, 0xbf54db31, v49
    v_fmac_f32 v33, 0xbf0e39da, v49
    v_sub_f32 v50, v80, v46
    v_sub_f32 v49, v23, v39
    v_add_f32 v80, v80, v46
    v_add_f32 v23, v23, v39
    v_mul_f32 v46, 0xbf3504f3, v50
    v_mul_f32 v39, 0x3f3504f3, v50
    v_fmac_f32 v46, 0xbf3504f3, v49
    v_fmac_f32 v39, 0xbf3504f3, v49
    v_sub_f32 v50, v74, v68
    v_sub_f32 v49, v21, v25
    v_add_f32 v74, v74, v68
    v_add_f32 v21, v21, v25
    v_mul_f32 v68, 0xbf54db31, v50
    v_mul_f32 v25, 0x3f0e39da, v50
    v_fmac_f32 v68, 0xbf0e39da, v49
    v_fmac_f32 v25, 0xbf54db31, v49
    v_sub_f32 v50, v42, v40
    v_sub_f32 v49, v69, v57
    v_add_f32 v42, v42, v40
    v_add_f32 v69, v69, v57
    v_mul_f32 v40, 0xbf6c835e, v50
    v_mul_f32 v57, 0x3ec3ef15, v50
    v_fmac_f32 v40, 0xbec3ef15, v49
    v_fmac_f32 v57, 0xbf6c835e, v49
    v_sub_f32 v50, v58, v28
    v_sub_f32 v49, v51, v53
    v_add_f32 v58, v58, v28
    v_add_f32 v51, v51, v53
    v_mul_f32 v28, 0xbf7b14be, v50
    v_mul_f32 v53, 0x3e47c5c2, v50
    v_fmac_f32 v28, 0xbe47c5c2, v49
    v_fmac_f32 v53, 0xbf7b14be, v49
    v_sub_f32 v50, v20, v56
    v_sub_f32 v49, v17, v55
    v_add_f32 v20, v20, v56
    v_add_f32 v17, v17, v55
    v_sub_f32 v56, v82, v18
    v_sub_f32 v55, v79, v67
    v_add_f32 v82, v82, v18
    v_add_f32 v79, v79, v67
    v_mul_f32 v18, 0x3f6c835e, v56
    v_mul_f32 v67, 0x3ec3ef15, v56
    v_fmac_f32 v18, 0xbec3ef15, v55
    v_fmac_f32 v67, 0x3f6c835e, v55
    v_sub_f32 v56, v70, v64
    v_sub_f32 v55, v81, v37
    v_add_f32 v70, v70, v64
    v_add_f32 v81, v81, v37
    v_mul_f32 v64, 0x3f3504f3, v56
    v_mul_f32 v37, 0x3f3504f3, v56
    v_fmac_f32 v64, 0xbf3504f3, v55
    v_fmac_f32 v37, 0x3f3504f3, v55
    v_sub_f32 v56, v32, v66
    v_sub_f32 v55, v41, v35
    v_add_f32 v32, v32, v66
    v_add_f32 v41, v41, v35
    v_mul_f32 v66, 0x3ec3ef15, v56
    v_mul_f32 v35, 0x3f6c835e, v56
    v_fmac_f32 v66, 0xbf6c835e, v55
    v_fmac_f32 v35, 0x3ec3ef15, v55
    v_sub_f32 v56, v23, v45
    v_sub_f32 v55, v38, v80
    v_add_f32 v38, v38, v80
    v_add_f32 v45, v45, v23
    v_sub_f32 v80, v78, v74
    v_sub_f32 v23, v63, v21
    v_add_f32 v78, v78, v74
    v_add_f32 v63, v63, v21
    v_mul_f32 v74, 0xbec3ef15, v80
    v_mul_f32 v21, 0x3f6c835e, v80
    v_fmac_f32 v74, 0xbf6c835e, v23
    v_fmac_f32 v21, 0xbec3ef15, v23
    v_sub_f32 v80, v36, v42
    v_sub_f32 v23, v29, v69
    v_add_f32 v36, v36, v42
    v_add_f32 v29, v29, v69
    v_mul_f32 v42, 0xbf3504f3, v80
    v_mul_f32 v69, 0x3f3504f3, v80
    v_fmac_f32 v42, 0xbf3504f3, v23
    v_fmac_f32 v69, 0xbf3504f3, v23
    v_sub_f32 v80, v62, v58
    v_sub_f32 v23, v31, v51
    v_add_f32 v62, v62, v58
    v_add_f32 v31, v31, v51
    v_mul_f32 v58, 0xbf6c835e, v80
    v_mul_f32 v51, 0x3ec3ef15, v80
    v_fmac_f32 v58, 0xbec3ef15, v23
    v_fmac_f32 v51, 0xbf6c835e, v23
    v_sub_f32 v80, v24, v83
    v_sub_f32 v23, v75, v59
    v_add_f32 v24, v24, v83
    v_add_f32 v75, v75, v59
    v_sub_f32 v83, v72, v26
    v_sub_f32 v59, v43, v77
    v_add_f32 v72, v72, v26
    v_add_f32 v43, v43, v77
    v_mul_f32 v26, 0x3f6c835e, v83
    v_mul_f32 v77, 0x3ec3ef15, v83
    v_fmac_f32 v26, 0xbec3ef15, v59
    v_fmac_f32 v77, 0x3f6c835e, v59
    v_sub_f32 v83, v54, v30
    v_sub_f32 v59, v27, v71
    v_add_f32 v54, v54, v30
    v_add_f32 v27, v27, v71
    v_mul_f32 v30, 0x3f3504f3, v83
    v_mul_f32 v71, 0x3f3504f3, v83
    v_fmac_f32 v30, 0xbf3504f3, v59
    v_fmac_f32 v71, 0x3f3504f3, v59
    v_sub_f32 v83, v48, v44
    v_sub_f32 v59, v65, v33
    v_add_f32 v48, v48, v44
    v_add_f32 v65, v65, v33
    v_mul_f32 v44, 0x3ec3ef15, v83
    v_mul_f32 v33, 0x3f6c835e, v83
    v_fmac_f32 v44, 0xbf6c835e, v59
    v_fmac_f32 v33, 0x3ec3ef15, v59
    v_sub_f32 v83, v39, v19
    v_sub_f32 v59, v60, v46
    v_add_f32 v60, v60, v46
    v_add_f32 v19, v19, v39
    v_sub_f32 v46, v16, v68
    v_sub_f32 v39, v73, v25
    v_add_f32 v16, v16, v68
    v_add_f32 v73, v73, v25
    v_mul_f32 v68, 0xbec3ef15, v46
    v_mul_f32 v25, 0x3f6c835e, v46
    v_fmac_f32 v68, 0xbf6c835e, v39
    v_fmac_f32 v25, 0xbec3ef15, v39
    v_sub_f32 v46, v34, v40
    v_sub_f32 v39, v61, v57
    v_add_f32 v34, v34, v40
    v_add_f32 v61, v61, v57
    v_mul_f32 v40, 0xbf3504f3, v46
    v_mul_f32 v57, 0x3f3504f3, v46
    v_fmac_f32 v40, 0xbf3504f3, v39
    v_fmac_f32 v57, 0xbf3504f3, v39
    v_sub_f32 v46, v52, v28
    v_sub_f32 v39, v47, v53
    v_add_f32 v52, v52, v28
    v_add_f32 v47, v47, v53
    v_mul_f32 v28, 0xbf6c835e, v46
    v_mul_f32 v53, 0x3ec3ef15, v46
    v_fmac_f32 v28, 0xbec3ef15, v39
    v_fmac_f32 v53, 0xbf6c835e, v39
    v_sub_f32 v46, v20, v38
    v_sub_f32 v39, v17, v45
    v_add_f32 v20, v20, v38
    v_add_f32 v17, v17, v45
    v_sub_f32 v38, v82, v78
    v_sub_f32 v45, v79, v63
    v_add_f32 v82, v82, v78
    v_add_f32 v79, v79, v63
    v_mul_f32 v78, 0x3f3504f3, v38
    v_mul_f32 v63, 0x3f3504f3, v38
    v_fmac_f32 v78, 0xbf3504f3, v45
    v_fmac_f32 v63, 0x3f3504f3, v45
    v_sub_f32 v38, v29, v81
    v_sub_f32 v45, v70, v36
    v_add_f32 v70, v70, v36
    v_add_f32 v81, v81, v29
    v_sub_f32 v36, v32, v62
    v_sub_f32 v29, v41, v31
    v_add_f32 v32, v32, v62
    v_add_f32 v41, v41, v31
    v_mul_f32 v62, 0xbf3504f3, v36
    v_mul_f32 v31, 0x3f3504f3, v36
    v_fmac_f32 v62, 0xbf3504f3, v29
    v_fmac_f32 v31, 0xbf3504f3, v29
    v_sub_f32 v36, v50, v56
    v_sub_f32 v29, v49, v55
    v_add_f32 v50, v50, v56
    v_add_f32 v49, v49, v55
    v_sub_f32 v56, v18, v74
    v_sub_f32 v55, v67, v21
    v_add_f32 v18, v18, v74
    v_add_f32 v67, v67, v21
    v_mul_f32 v74, 0x3f3504f3, v56
    v_mul_f32 v21, 0x3f3504f3, v56
    v_fmac_f32 v74, 0xbf3504f3, v55
    v_fmac_f32 v21, 0x3f3504f3, v55
    v_sub_f32 v56, v69, v37
    v_sub_f32 v55, v64, v42
    v_add_f32 v64, v64, v42
    v_add_f32 v37, v37, v69
    v_sub_f32 v42, v66, v58
    v_sub_f32 v69, v35, v51
    v_add_f32 v66, v66, v58
    v_add_f32 v35, v35, v51
    v_mul_f32 v58, 0xbf3504f3, v42
    v_mul_f32 v51, 0x3f3504f3, v42
    v_fmac_f32 v58, 0xbf3504f3, v69
    v_fmac_f32 v51, 0xbf3504f3, v69
    v_sub_f32 v42, v24, v60
    v_sub_f32 v69, v75, v19
    v_add_f32 v24, v24, v60
    v_add_f32 v75, v75, v19
    v_sub_f32 v60, v72, v16
    v_sub_f32 v19, v43, v73
    v_add_f32 v72, v72, v16
    v_add_f32 v43, v43, v73
    v_mul_f32 v16, 0x3f3504f3, v60
    v_mul_f32 v73, 0x3f3504f3, v60
    v_fmac_f32 v16, 0xbf3504f3, v19
    v_fmac_f32 v73, 0x3f3504f3, v19
    v_sub_f32 v60, v61, v27
    v_sub_f32 v19, v54, v34
    v_add_f32 v54, v54, v34
    v_add_f32 v27, v27, v61
    v_sub_f32 v34, v48, v52
    v_sub_f32 v61, v65, v47
    v_add_f32 v48, v48, v52
    v_add_f32 v65, v65, v47
    v_mul_f32 v52, 0xbf3504f3, v34
    v_mul_f32 v47, 0x3f3504f3, v34
    v_fmac_f32 v52, 0xbf3504f3, v61
    v_fmac_f32 v47, 0xbf3504f3, v61
    v_sub_f32 v34, v80, v83
    v_sub_f32 v61, v23, v59
    v_add_f32 v80, v80, v83
    v_add_f32 v23, v23, v59
    v_sub_f32 v83, v26, v68
    v_sub_f32 v59, v77, v25
    v_add_f32 v26, v26, v68
    v_add_f32 v77, v77, v25
    v_mul_f32 v68, 0x3f3504f3, v83
    v_mul_f32 v25, 0x3f3504f3, v83
    v_fmac_f32 v68, 0xbf3504f3, v59
    v_fmac_f32 v25, 0x3f3504f3, v59
    v_sub_f32 v83, v57, v71
    v_sub_f32 v59, v30, v40
    v_add_f32 v30, v30, v40
    v_add_f32 v71, v71, v57
    v_sub_f32 v40, v44, v28
    v_sub_f32 v57, v33, v53
    v_add_f32 v44, v44, v28
    v_add_f32 v33, v33, v53
    v_mul_f32 v28, 0xbf3504f3, v40
    v_mul_f32 v53, 0x3f3504f3, v40
    v_fmac_f32 v28, 0xbf3504f3, v57
    v_fmac_f32 v53, 0xbf3504f3, v57
    v_sub_f32 v40, v20, v70
    v_sub_f32 v57, v17, v81
    v_add_f32 v20, v20, v70
    v_add_f32 v17, v17, v81
    v_sub_f32 v70, v41, v79
    v_sub_f32 v81, v82, v32
    v_add_f32 v82, v82, v32
    v_add_f32 v79, v79, v41
    v_sub_f32 v32, v46, v38
    v_sub_f32 v41, v39, v45
    v_add_f32 v46, v46, v38
    v_add_f32 v39, v39, v45
    v_sub_f32 v38, v31, v63
    v_sub_f32 v45, v78, v62
    v_add_f32 v78, v78, v62
    v_add_f32 v63, v63, v31
    v_sub_f32 v62, v50, v64
    v_sub_f32 v31, v49, v37
    v_add_f32 v50, v50, v64
    v_add_f32 v49, v49, v37
    v_sub_f32 v64, v35, v67
    v_sub_f32 v37, v18, v66
    v_add_f32 v18, v18, v66
    v_add_f32 v67, v67, v35
    v_sub_f32 v66, v36, v56
    v_sub_f32 v35, v29, v55
    v_add_f32 v36, v36, v56
    v_add_f32 v29, v29, v55
    v_sub_f32 v56, v51, v21
    v_sub_f32 v55, v74, v58
    v_add_f32 v74, v74, v58
    v_add_f32 v21, v21, v51
    v_sub_f32 v58, v24, v54
    v_sub_f32 v51, v75, v27
    v_add_f32 v24, v24, v54
    v_add_f32 v75, v75, v27
    v_sub_f32 v54, v65, v43
    v_sub_f32 v27, v72, v48
    v_add_f32 v72, v72, v48
    v_add_f32 v43, v43, v65
    v_sub_f32 v48, v42, v60
    v_sub_f32 v65, v69, v19
    v_add_f32 v42, v42, v60
    v_add_f32 v69, v69, v19
    v_sub_f32 v60, v47, v73
    v_sub_f32 v19, v16, v52
    v_add_f32 v16, v16, v52
    v_add_f32 v73, v73, v47
    v_sub_f32 v52, v80, v30
    v_sub_f32 v47, v23, v71
    v_add_f32 v80, v80, v30
    v_add_f32 v23, v23, v71
    v_sub_f32 v30, v33, v77
    v_sub_f32 v71, v26, v44
    v_add_f32 v26, v26, v44
    v_add_f32 v77, v77, v33
    v_sub_f32 v44, v34, v83
    v_sub_f32 v33, v61, v59
    v_add_f32 v34, v34, v83
    v_add_f32 v61, v61, v59
    v_sub_f32 v83, v53, v25
    v_sub_f32 v59, v68, v28
    v_add_f32 v68, v68, v28
    v_add_f32 v25, v25, v53
    v_sub_f32 v28, v20, v82
    v_sub_f32 v53, v17, v79
    v_add_f32 v20, v20, v82
    v_add_f32 v17, v17, v79
    v_sub_f32 v82, v40, v70
    v_sub_f32 v79, v57, v81
    v_add_f32 v40, v40, v70
    v_add_f32 v57, v57, v81
    v_sub_f32 v70, v46, v78
    v_sub_f32 v81, v39, v63
    v_add_f32 v46, v46, v78
    v_add_f32 v39, v39, v63
    v_sub_f32 v78, v32, v38
    v_sub_f32 v63, v41, v45
    v_add_f32 v32, v32, v38
    v_add_f32 v41, v41, v45
    v_sub_f32 v38, v50, v18
    v_sub_f32 v45, v49, v67
    v_add_f32 v50, v50, v18
    v_add_f32 v49, v49, v67
    v_sub_f32 v18, v62, v64
    v_sub_f32 v67, v31, v37
    v_add_f32 v62, v62, v64
    v_add_f32 v31, v31, v37
    v_sub_f32 v64, v36, v74
    v_sub_f32 v37, v29, v21
    v_add_f32 v36, v36, v74
    v_add_f32 v29, v29, v21
    v_sub_f32 v74, v66, v56
    v_sub_f32 v21, v35, v55
    v_add_f32 v66, v66, v56
    v_add_f32 v35, v35, v55
    v_sub_f32 v56, v24, v72
    v_sub_f32 v55, v75, v43
    v_add_f32 v24, v24, v72
    v_add_f32 v75, v75, v43
    v_sub_f32 v72, v58, v54
    v_sub_f32 v43, v51, v27
    v_add_f32 v58, v58, v54
    v_add_f32 v51, v51, v27
    v_sub_f32 v54, v42, v16
    v_sub_f32 v27, v69, v73
    v_add_f32 v42, v42, v16
    v_add_f32 v69, v69, v73
    v_sub_f32 v16, v48, v60
    v_sub_f32 v73, v65, v19
    v_add_f32 v48, v48, v60
    v_add_f32 v65, v65, v19
    v_sub_f32 v60, v80, v26
    v_sub_f32 v19, v23, v77
    v_add_f32 v80, v80, v26
    v_add_f32 v23, v23, v77
    v_sub_f32 v26, v52, v30
    v_sub_f32 v77, v47, v71
    v_add_f32 v52, v52, v30
    v_add_f32 v47, v47, v71
    v_sub_f32 v30, v34, v68
    v_sub_f32 v71, v61, v25
    v_add_f32 v34, v34, v68
    v_add_f32 v61, v61, v25
    v_sub_f32 v68, v44, v83
    v_sub_f32 v25, v33, v59
    v_add_f32 v44, v44, v83
    v_add_f32 v33, v33, v59
    s_add_u32 s15, s14, 109051904
    v_lshlrev_b32 v5, 3, v1
    s_add_u32 s16, s15, 0
    v_mov_b32 v88, v20
    v_mov_b32 v89, v17
    buffer_store_dwordx2 v[88:89], v5, s[8:11], s16 offen sc1
    s_add_u32 s16, s15, 512
    v_mov_b32 v90, v24
    v_mov_b32 v91, v75
    buffer_store_dwordx2 v[90:91], v5, s[8:11], s16 offen sc1
    s_add_u32 s16, s15, 1024
    v_mov_b32 v92, v50
    v_mov_b32 v93, v49
    buffer_store_dwordx2 v[92:93], v5, s[8:11], s16 offen sc1
    s_add_u32 s16, s15, 1536
    v_mov_b32 v94, v80
    v_mov_b32 v95, v23
    buffer_store_dwordx2 v[94:95], v5, s[8:11], s16 offen sc1
    s_add_u32 s16, s15, 2048
    v_mov_b32 v96, v46
    v_mov_b32 v97, v39
    buffer_store_dwordx2 v[96:97], v5, s[8:11], s16 offen sc1
    s_add_u32 s16, s15, 2560
    v_mov_b32 v98, v42
    v_mov_b32 v99, v69
    buffer_store_dwordx2 v[98:99], v5, s[8:11], s16 offen sc1
    s_add_u32 s16, s15, 3072
    v_mov_b32 v100, v36
    v_mov_b32 v101, v29
    buffer_store_dwordx2 v[100:101], v5, s[8:11], s16 offen sc1
    s_add_u32 s16, s15, 3584
    v_mov_b32 v102, v34
    v_mov_b32 v103, v61
    buffer_store_dwordx2 v[102:103], v5, s[8:11], s16 offen sc1
    s_add_u32 s16, s15, 4096
    v_mov_b32 v88, v40
    v_mov_b32 v89, v57
    buffer_store_dwordx2 v[88:89], v5, s[8:11], s16 offen sc1
    s_add_u32 s16, s15, 4608
    v_mov_b32 v90, v58
    v_mov_b32 v91, v51
    buffer_store_dwordx2 v[90:91], v5, s[8:11], s16 offen sc1
    s_add_u32 s16, s15, 5120
    v_mov_b32 v92, v62
    v_mov_b32 v93, v31
    buffer_store_dwordx2 v[92:93], v5, s[8:11], s16 offen sc1
    s_add_u32 s16, s15, 5632
    v_mov_b32 v94, v52
    v_mov_b32 v95, v47
    buffer_store_dwordx2 v[94:95], v5, s[8:11], s16 offen sc1
    s_add_u32 s16, s15, 6144
    v_mov_b32 v96, v32
    v_mov_b32 v97, v41
    buffer_store_dwordx2 v[96:97], v5, s[8:11], s16 offen sc1
    s_add_u32 s16, s15, 6656
    v_mov_b32 v98, v48
    v_mov_b32 v99, v65
    buffer_store_dwordx2 v[98:99], v5, s[8:11], s16 offen sc1
    s_add_u32 s16, s15, 7168
    v_mov_b32 v100, v66
    v_mov_b32 v101, v35
    buffer_store_dwordx2 v[100:101], v5, s[8:11], s16 offen sc1
    s_add_u32 s16, s15, 7680
    v_mov_b32 v102, v44
    v_mov_b32 v103, v33
    buffer_store_dwordx2 v[102:103], v5, s[8:11], s16 offen sc1
    s_add_u32 s16, s15, 8192
    v_mov_b32 v88, v28
    v_mov_b32 v89, v53
    buffer_store_dwordx2 v[88:89], v5, s[8:11], s16 offen sc1
    s_add_u32 s16, s15, 8704
    v_mov_b32 v90, v56
    v_mov_b32 v91, v55
    buffer_store_dwordx2 v[90:91], v5, s[8:11], s16 offen sc1
    s_add_u32 s16, s15, 9216
    v_mov_b32 v92, v38
    v_mov_b32 v93, v45
    buffer_store_dwordx2 v[92:93], v5, s[8:11], s16 offen sc1
    s_add_u32 s16, s15, 9728
    v_mov_b32 v94, v60
    v_mov_b32 v95, v19
    buffer_store_dwordx2 v[94:95], v5, s[8:11], s16 offen sc1
    s_add_u32 s16, s15, 10240
    v_mov_b32 v96, v70
    v_mov_b32 v97, v81
    buffer_store_dwordx2 v[96:97], v5, s[8:11], s16 offen sc1
    s_add_u32 s16, s15, 10752
    v_mov_b32 v98, v54
    v_mov_b32 v99, v27
    buffer_store_dwordx2 v[98:99], v5, s[8:11], s16 offen sc1
    s_add_u32 s16, s15, 11264
    v_mov_b32 v100, v64
    v_mov_b32 v101, v37
    buffer_store_dwordx2 v[100:101], v5, s[8:11], s16 offen sc1
    s_add_u32 s16, s15, 11776
    v_mov_b32 v102, v30
    v_mov_b32 v103, v71
    buffer_store_dwordx2 v[102:103], v5, s[8:11], s16 offen sc1
    s_add_u32 s16, s15, 12288
    v_mov_b32 v88, v82
    v_mov_b32 v89, v79
    buffer_store_dwordx2 v[88:89], v5, s[8:11], s16 offen sc1
    s_add_u32 s16, s15, 12800
    v_mov_b32 v90, v72
    v_mov_b32 v91, v43
    buffer_store_dwordx2 v[90:91], v5, s[8:11], s16 offen sc1
    s_add_u32 s16, s15, 13312
    v_mov_b32 v92, v18
    v_mov_b32 v93, v67
    buffer_store_dwordx2 v[92:93], v5, s[8:11], s16 offen sc1
    s_add_u32 s16, s15, 13824
    v_mov_b32 v94, v26
    v_mov_b32 v95, v77
    buffer_store_dwordx2 v[94:95], v5, s[8:11], s16 offen sc1
    s_add_u32 s16, s15, 14336
    v_mov_b32 v96, v78
    v_mov_b32 v97, v63
    buffer_store_dwordx2 v[96:97], v5, s[8:11], s16 offen sc1
    s_add_u32 s16, s15, 14848
    v_mov_b32 v98, v16
    v_mov_b32 v99, v73
    buffer_store_dwordx2 v[98:99], v5, s[8:11], s16 offen sc1
    s_add_u32 s16, s15, 15360
    v_mov_b32 v100, v74
    v_mov_b32 v101, v21
    buffer_store_dwordx2 v[100:101], v5, s[8:11], s16 offen sc1
    s_add_u32 s16, s15, 15872
    v_mov_b32 v102, v68
    v_mov_b32 v103, v25
    buffer_store_dwordx2 v[102:103], v5, s[8:11], s16 offen sc1
mega_kernel_f2_end:
    s_add_u32 s93, s93, 64
    s_cmp_lt_u32 s93, 129
    s_cbranch_scc1 mega_kernel_f2l
    s_waitcnt vmcnt(0)
    s_barrier
    v_mov_b32 v1, 0
    v_mov_b32 v2, 1
    s_mov_b32 s82, 70291584
    v_cmp_eq_u32 vcc, 0, v0
    s_and_saveexec_b64 s[80:81], vcc
    s_cbranch_execz mega_kernel_sg1
    buffer_atomic_add v2, v1, s[84:87], s82 offen sc1
    mega_kernel_sg1:
    s_mov_b64 exec, s[80:81]
    v_mov_b32 v1, 0
    s_mov_b32 s82, 70291584
mega_kernel_w1:
    s_sleep 8
    buffer_load_dword v2, v1, s[84:87], s82 offen sc1
    s_waitcnt vmcnt(0)
    v_cmp_ne_u32 vcc, 63, v2
    s_cbranch_vccnz mega_kernel_w1
    s_mov_b32 s93, s92
mega_kernel_f3l:
    s_barrier
    s_load_dwordx2 s[4:5], s[0:1], 80
    s_load_dwordx2 s[8:9], s[0:1], 96
    v_and_b32 v6, 7, v0
    v_lshrrev_b32 v7, 3, v0
    s_movk_i32 s13, 8448
    v_mul_lo_u32 v8, v6, s13
    v_lshl_add_u32 v4, v7, 3, v8
    v_lshlrev_b32 v5, 14, v7
    v_lshl_add_u32 v5, v6, 4, v5
    s_lshl_b32 s12, s93, 7
    s_add_u32 s12, s12, 109051904
    s_waitcnt lgkmcnt(0)
    s_mov_b32 s6, 8388608
    s_mov_b32 s7, 0x00020000
    s_mov_b32 s10, 268435456
    s_mov_b32 s11, 0x00020000
    s_add_u32 s13, s12, 0
    buffer_load_dwordx4 v[16:19], v5, s[8:11], s13 offen
    s_add_u32 s13, s12, 524288
    buffer_load_dwordx4 v[20:23], v5, s[8:11], s13 offen
    s_add_u32 s13, s12, 1048576
    buffer_load_dwordx4 v[24:27], v5, s[8:11], s13 offen
    s_add_u32 s13, s12, 1572864
    buffer_load_dwordx4 v[28:31], v5, s[8:11], s13 offen
    s_add_u32 s13, s12, 2097152
    buffer_load_dwordx4 v[32:35], v5, s[8:11], s13 offen
    s_add_u32 s13, s12, 2621440
    buffer_load_dwordx4 v[36:39], v5, s[8:11], s13 offen
    s_add_u32 s13, s12, 3145728
    buffer_load_dwordx4 v[40:43], v5, s[8:11], s13 offen
    s_add_u32 s13, s12, 3670016
    buffer_load_dwordx4 v[44:47], v5, s[8:11], s13 offen
    s_add_u32 s13, s12, 4194304
    buffer_load_dwordx4 v[48:51], v5, s[8:11], s13 offen
    s_add_u32 s13, s12, 4718592
    buffer_load_dwordx4 v[52:55], v5, s[8:11], s13 offen
    s_add_u32 s13, s12, 5242880
    buffer_load_dwordx4 v[56:59], v5, s[8:11], s13 offen
    s_add_u32 s13, s12, 5767168
    buffer_load_dwordx4 v[60:63], v5, s[8:11], s13 offen
    s_add_u32 s13, s12, 6291456
    buffer_load_dwordx4 v[64:67], v5, s[8:11], s13 offen
    s_add_u32 s13, s12, 6815744
    buffer_load_dwordx4 v[68:71], v5, s[8:11], s13 offen
    s_add_u32 s13, s12, 7340032
    buffer_load_dwordx4 v[72:75], v5, s[8:11], s13 offen
    s_add_u32 s13, s12, 7864320
    buffer_load_dwordx4 v[76:79], v5, s[8:11], s13 offen
    s_add_u32 s13, s12, 8388608
    buffer_load_dwordx4 v[80:83], v5, s[8:11], s13 offen
    s_waitcnt vmcnt(0)
    v_cmp_eq_u32 vcc, 0, v7
    s_nop 1
    v_mov_b32 v9, 0
    v_cndmask_b32 v17, v17, v9, vcc
    v_cndmask_b32 v19, v19, v9, vcc
    v_cndmask_b32 v81, v81, v9, vcc
    v_cndmask_b32 v83, v83, v9, vcc
    v_sub_u32 v6, 1024, v7
    v_and_b32 v6, 1023, v6
    v_lshl_add_u32 v6, v6, 3, v8
    v_sub_f32 v10, v16, v19
    v_add_f32 v11, v17, v18
    v_add_f32 v12, v16, v19
    v_sub_f32 v13, v18, v17
    ds_write_b64 v4, v[10:11] offset:0
    ds_write_b64 v6, v[12:13]
    v_sub_u32 v6, 992, v7
    v_and_b32 v6, 1023, v6
    v_lshl_add_u32 v6, v6, 3, v8
    v_sub_f32 v10, v20, v23
    v_add_f32 v11, v21, v22
    v_add_f32 v12, v20, v23
    v_sub_f32 v13, v22, v21
    ds_write_b64 v4, v[10:11] offset:256
    ds_write_b64 v6, v[12:13]
    v_sub_u32 v6, 960, v7
    v_and_b32 v6, 1023, v6
    v_lshl_add_u32 v6, v6, 3, v8
    v_sub_f32 v10, v24, v27
    v_add_f32 v11, v25, v26
    v_add_f32 v12, v24, v27
    v_sub_f32 v13, v26, v25
    ds_write_b64 v4, v[10:11] offset:512
    ds_write_b64 v6, v[12:13]
    v_sub_u32 v6, 928, v7
    v_and_b32 v6, 1023, v6
    v_lshl_add_u32 v6, v6, 3, v8
    v_sub_f32 v10, v28, v31
    v_add_f32 v11, v29, v30
    v_add_f32 v12, v28, v31
    v_sub_f32 v13, v30, v29
    ds_write_b64 v4, v[10:11] offset:768
    ds_write_b64 v6, v[12:13]
    v_sub_u32 v6, 896, v7
    v_and_b32 v6, 1023, v6
    v_lshl_add_u32 v6, v6, 3, v8
    v_sub_f32 v10, v32, v35
    v_add_f32 v11, v33, v34
    v_add_f32 v12, v32, v35
    v_sub_f32 v13, v34, v33
    ds_write_b64 v4, v[10:11] offset:1024
    ds_write_b64 v6, v[12:13]
    v_sub_u32 v6, 864, v7
    v_and_b32 v6, 1023, v6
    v_lshl_add_u32 v6, v6, 3, v8
    v_sub_f32 v10, v36, v39
    v_add_f32 v11, v37, v38
    v_add_f32 v12, v36, v39
    v_sub_f32 v13, v38, v37
    ds_write_b64 v4, v[10:11] offset:1280
    ds_write_b64 v6, v[12:13]
    v_sub_u32 v6, 832, v7
    v_and_b32 v6, 1023, v6
    v_lshl_add_u32 v6, v6, 3, v8
    v_sub_f32 v10, v40, v43
    v_add_f32 v11, v41, v42
    v_add_f32 v12, v40, v43
    v_sub_f32 v13, v42, v41
    ds_write_b64 v4, v[10:11] offset:1536
    ds_write_b64 v6, v[12:13]
    v_sub_u32 v6, 800, v7
    v_and_b32 v6, 1023, v6
    v_lshl_add_u32 v6, v6, 3, v8
    v_sub_f32 v10, v44, v47
    v_add_f32 v11, v45, v46
    v_add_f32 v12, v44, v47
    v_sub_f32 v13, v46, v45
    ds_write_b64 v4, v[10:11] offset:1792
    ds_write_b64 v6, v[12:13]
    v_sub_u32 v6, 768, v7
    v_and_b32 v6, 1023, v6
    v_lshl_add_u32 v6, v6, 3, v8
    v_sub_f32 v10, v48, v51
    v_add_f32 v11, v49, v50
    v_add_f32 v12, v48, v51
    v_sub_f32 v13, v50, v49
    ds_write_b64 v4, v[10:11] offset:2048
    ds_write_b64 v6, v[12:13]
    v_sub_u32 v6, 736, v7
    v_and_b32 v6, 1023, v6
    v_lshl_add_u32 v6, v6, 3, v8
    v_sub_f32 v10, v52, v55
    v_add_f32 v11, v53, v54
    v_add_f32 v12, v52, v55
    v_sub_f32 v13, v54, v53
    ds_write_b64 v4, v[10:11] offset:2304
    ds_write_b64 v6, v[12:13]
    v_sub_u32 v6, 704, v7
    v_and_b32 v6, 1023, v6
    v_lshl_add_u32 v6, v6, 3, v8
    v_sub_f32 v10, v56, v59
    v_add_f32 v11, v57, v58
    v_add_f32 v12, v56, v59
    v_sub_f32 v13, v58, v57
    ds_write_b64 v4, v[10:11] offset:2560
    ds_write_b64 v6, v[12:13]
    v_sub_u32 v6, 672, v7
    v_and_b32 v6, 1023, v6
    v_lshl_add_u32 v6, v6, 3, v8
    v_sub_f32 v10, v60, v63
    v_add_f32 v11, v61, v62
    v_add_f32 v12, v60, v63
    v_sub_f32 v13, v62, v61
    ds_write_b64 v4, v[10:11] offset:2816
    ds_write_b64 v6, v[12:13]
    v_sub_u32 v6, 640, v7
    v_and_b32 v6, 1023, v6
    v_lshl_add_u32 v6, v6, 3, v8
    v_sub_f32 v10, v64, v67
    v_add_f32 v11, v65, v66
    v_add_f32 v12, v64, v67
    v_sub_f32 v13, v66, v65
    ds_write_b64 v4, v[10:11] offset:3072
    ds_write_b64 v6, v[12:13]
    v_sub_u32 v6, 608, v7
    v_and_b32 v6, 1023, v6
    v_lshl_add_u32 v6, v6, 3, v8
    v_sub_f32 v10, v68, v71
    v_add_f32 v11, v69, v70
    v_add_f32 v12, v68, v71
    v_sub_f32 v13, v70, v69
    ds_write_b64 v4, v[10:11] offset:3328
    ds_write_b64 v6, v[12:13]
    v_sub_u32 v6, 576, v7
    v_and_b32 v6, 1023, v6
    v_lshl_add_u32 v6, v6, 3, v8
    v_sub_f32 v10, v72, v75
    v_add_f32 v11, v73, v74
    v_add_f32 v12, v72, v75
    v_sub_f32 v13, v74, v73
    ds_write_b64 v4, v[10:11] offset:3584
    ds_write_b64 v6, v[12:13]
    v_sub_u32 v6, 544, v7
    v_and_b32 v6, 1023, v6
    v_lshl_add_u32 v6, v6, 3, v8
    v_sub_f32 v10, v76, v79
    v_add_f32 v11, v77, v78
    v_add_f32 v12, v76, v79
    v_sub_f32 v13, v78, v77
    ds_write_b64 v4, v[10:11] offset:3840
    ds_write_b64 v6, v[12:13]
    s_and_saveexec_b64 s[14:15], vcc
    v_sub_u32 v6, 512, v7
    v_and_b32 v6, 1023, v6
    v_lshl_add_u32 v6, v6, 3, v8
    v_sub_f32 v10, v80, v83
    v_add_f32 v11, v81, v82
    v_add_f32 v12, v80, v83
    v_sub_f32 v13, v82, v81
    ds_write_b64 v4, v[10:11] offset:4096
    ds_write_b64 v6, v[12:13]
    s_mov_b64 exec, s[14:15]
    s_waitcnt lgkmcnt(0)
    s_barrier
    v_and_b32 v1, 31, v0
    v_lshrrev_b32 v2, 5, v0
    v_cvt_f32_u32 v3, v1
    s_movk_i32 s13, 8448
    v_mul_lo_u32 v7, v2, s13
    v_lshl_add_u32 v4, v1, 3, v7
    s_movk_i32 s13, 264
    v_mul_lo_u32 v5, v1, s13
    v_add_u32 v5, v5, v7
    ds_read_b32 v16, v4 offset:0
    ds_read_b32 v48, v4 offset:4
    ds_read_b32 v17, v4 offset:256
    ds_read_b32 v49, v4 offset:260
    ds_read_b32 v18, v4 offset:512
    ds_read_b32 v50, v4 offset:516
    ds_read_b32 v19, v4 offset:768
    ds_read_b32 v51, v4 offset:772
    ds_read_b32 v20, v4 offset:1024
    ds_read_b32 v52, v4 offset:1028
    ds_read_b32 v21, v4 offset:1280
    ds_read_b32 v53, v4 offset:1284
    ds_read_b32 v22, v4 offset:1536
    ds_read_b32 v54, v4 offset:1540
    s_waitcnt lgkmcnt(0)
    ds_read_b32 v23, v4 offset:1792
    ds_read_b32 v55, v4 offset:1796
    ds_read_b32 v24, v4 offset:2048
    ds_read_b32 v56, v4 offset:2052
    ds_read_b32 v25, v4 offset:2304
    ds_read_b32 v57, v4 offset:2308
    ds_read_b32 v26, v4 offset:2560
    ds_read_b32 v58, v4 offset:2564
    ds_read_b32 v27, v4 offset:2816
    ds_read_b32 v59, v4 offset:2820
    ds_read_b32 v28, v4 offset:3072
    ds_read_b32 v60, v4 offset:3076
    ds_read_b32 v29, v4 offset:3328
    ds_read_b32 v61, v4 offset:3332
    s_waitcnt lgkmcnt(0)
    ds_read_b32 v30, v4 offset:3584
    ds_read_b32 v62, v4 offset:3588
    ds_read_b32 v31, v4 offset:3840
    ds_read_b32 v63, v4 offset:3844
    ds_read_b32 v32, v4 offset:4096
    ds_read_b32 v64, v4 offset:4100
    ds_read_b32 v33, v4 offset:4352
    ds_read_b32 v65, v4 offset:4356
    ds_read_b32 v34, v4 offset:4608
    ds_read_b32 v66, v4 offset:4612
    ds_read_b32 v35, v4 offset:4864
    ds_read_b32 v67, v4 offset:4868
    ds_read_b32 v36, v4 offset:5120
    ds_read_b32 v68, v4 offset:5124
    s_waitcnt lgkmcnt(0)
    ds_read_b32 v37, v4 offset:5376
    ds_read_b32 v69, v4 offset:5380
    ds_read_b32 v38, v4 offset:5632
    ds_read_b32 v70, v4 offset:5636
    ds_read_b32 v39, v4 offset:5888
    ds_read_b32 v71, v4 offset:5892
    ds_read_b32 v40, v4 offset:6144
    ds_read_b32 v72, v4 offset:6148
    ds_read_b32 v41, v4 offset:6400
    ds_read_b32 v73, v4 offset:6404
    ds_read_b32 v42, v4 offset:6656
    ds_read_b32 v74, v4 offset:6660
    ds_read_b32 v43, v4 offset:6912
    ds_read_b32 v75, v4 offset:6916
    s_waitcnt lgkmcnt(0)
    ds_read_b32 v44, v4 offset:7168
    ds_read_b32 v76, v4 offset:7172
    ds_read_b32 v45, v4 offset:7424
    ds_read_b32 v77, v4 offset:7428
    ds_read_b32 v46, v4 offset:7680
    ds_read_b32 v78, v4 offset:7684
    ds_read_b32 v47, v4 offset:7936
    ds_read_b32 v79, v4 offset:7940
    s_waitcnt lgkmcnt(0)
    v_sub_f32 v80, v16, v32
    v_sub_f32 v81, v48, v64
    v_add_f32 v16, v16, v32
    v_add_f32 v48, v48, v64
    v_sub_f32 v32, v17, v33
    v_sub_f32 v64, v49, v65
    v_add_f32 v17, v17, v33
    v_add_f32 v49, v49, v65
    v_mul_f32 v33, 0x3f7b14be, v32
    v_mul_f32 v65, 0x3e47c5c2, v32
    v_fmac_f32 v33, 0xbe47c5c2, v64
    v_fmac_f32 v65, 0x3f7b14be, v64
    v_sub_f32 v32, v18, v34
    v_sub_f32 v64, v50, v66
    v_add_f32 v18, v18, v34
    v_add_f32 v50, v50, v66
    v_mul_f32 v34, 0x3f6c835e, v32
    v_mul_f32 v66, 0x3ec3ef15, v32
    v_fmac_f32 v34, 0xbec3ef15, v64
    v_fmac_f32 v66, 0x3f6c835e, v64
    v_sub_f32 v32, v19, v35
    v_sub_f32 v64, v51, v67
    v_add_f32 v19, v19, v35
    v_add_f32 v51, v51, v67
    v_mul_f32 v35, 0x3f54db31, v32
    v_mul_f32 v67, 0x3f0e39da, v32
    v_fmac_f32 v35, 0xbf0e39da, v64
    v_fmac_f32 v67, 0x3f54db31, v64
    v_sub_f32 v32, v20, v36
    v_sub_f32 v64, v52, v68
    v_add_f32 v20, v20, v36
    v_add_f32 v52, v52, v68
    v_mul_f32 v36, 0x3f3504f3, v32
    v_mul_f32 v68, 0x3f3504f3, v32
    v_fmac_f32 v36, 0xbf3504f3, v64
    v_fmac_f32 v68, 0x3f3504f3, v64
    v_sub_f32 v32, v21, v37
    v_sub_f32 v64, v53, v69
    v_add_f32 v21, v21, v37
    v_add_f32 v53, v53, v69
    v_mul_f32 v37, 0x3f0e39da, v32
    v_mul_f32 v69, 0x3f54db31, v32
    v_fmac_f32 v37, 0xbf54db31, v64
    v_fmac_f32 v69, 0x3f0e39da, v64
    v_sub_f32 v32, v22, v38
    v_sub_f32 v64, v54, v70
    v_add_f32 v22, v22, v38
    v_add_f32 v54, v54, v70
    v_mul_f32 v38, 0x3ec3ef15, v32
    v_mul_f32 v70, 0x3f6c835e, v32
    v_fmac_f32 v38, 0xbf6c835e, v64
    v_fmac_f32 v70, 0x3ec3ef15, v64
    v_sub_f32 v32, v23, v39
    v_sub_f32 v64, v55, v71
    v_add_f32 v23, v23, v39
    v_add_f32 v55, v55, v71
    v_mul_f32 v39, 0x3e47c5c2, v32
    v_mul_f32 v71, 0x3f7b14be, v32
    v_fmac_f32 v39, 0xbf7b14be, v64
    v_fmac_f32 v71, 0x3e47c5c2, v64
    v_sub_f32 v32, v72, v56
    v_sub_f32 v64, v24, v40
    v_add_f32 v24, v24, v40
    v_add_f32 v56, v56, v72
    v_sub_f32 v40, v25, v41
    v_sub_f32 v72, v57, v73
    v_add_f32 v25, v25, v41
    v_add_f32 v57, v57, v73
    v_mul_f32 v41, 0xbe47c5c2, v40
    v_mul_f32 v73, 0x3f7b14be, v40
    v_fmac_f32 v41, 0xbf7b14be, v72
    v_fmac_f32 v73, 0xbe47c5c2, v72
    v_sub_f32 v40, v26, v42
    v_sub_f32 v72, v58, v74
    v_add_f32 v26, v26, v42
    v_add_f32 v58, v58, v74
    v_mul_f32 v42, 0xbec3ef15, v40
    v_mul_f32 v74, 0x3f6c835e, v40
    v_fmac_f32 v42, 0xbf6c835e, v72
    v_fmac_f32 v74, 0xbec3ef15, v72
    v_sub_f32 v40, v27, v43
    v_sub_f32 v72, v59, v75
    v_add_f32 v27, v27, v43
    v_add_f32 v59, v59, v75
    v_mul_f32 v43, 0xbf0e39da, v40
    v_mul_f32 v75, 0x3f54db31, v40
    v_fmac_f32 v43, 0xbf54db31, v72
    v_fmac_f32 v75, 0xbf0e39da, v72
    v_sub_f32 v40, v28, v44
    v_sub_f32 v72, v60, v76
    v_add_f32 v28, v28, v44
    v_add_f32 v60, v60, v76
    v_mul_f32 v44, 0xbf3504f3, v40
    v_mul_f32 v76, 0x3f3504f3, v40
    v_fmac_f32 v44, 0xbf3504f3, v72
    v_fmac_f32 v76, 0xbf3504f3, v72
    v_sub_f32 v40, v29, v45
    v_sub_f32 v72, v61, v77
    v_add_f32 v29, v29, v45
    v_add_f32 v61, v61, v77
    v_mul_f32 v45, 0xbf54db31, v40
    v_mul_f32 v77, 0x3f0e39da, v40
    v_fmac_f32 v45, 0xbf0e39da, v72
    v_fmac_f32 v77, 0xbf54db31, v72
    v_sub_f32 v40, v30, v46
    v_sub_f32 v72, v62, v78
    v_add_f32 v30, v30, v46
    v_add_f32 v62, v62, v78
    v_mul_f32 v46, 0xbf6c835e, v40
    v_mul_f32 v78, 0x3ec3ef15, v40
    v_fmac_f32 v46, 0xbec3ef15, v72
    v_fmac_f32 v78, 0xbf6c835e, v72
    v_sub_f32 v40, v31, v47
    v_sub_f32 v72, v63, v79
    v_add_f32 v31, v31, v47
    v_add_f32 v63, v63, v79
    v_mul_f32 v47, 0xbf7b14be, v40
    v_mul_f32 v79, 0x3e47c5c2, v40
    v_fmac_f32 v47, 0xbe47c5c2, v72
    v_fmac_f32 v79, 0xbf7b14be, v72
    v_sub_f32 v40, v16, v24
    v_sub_f32 v72, v48, v56
    v_add_f32 v16, v16, v24
    v_add_f32 v48, v48, v56
    v_sub_f32 v24, v17, v25
    v_sub_f32 v56, v49, v57
    v_add_f32 v17, v17, v25
    v_add_f32 v49, v49, v57
    v_mul_f32 v25, 0x3f6c835e, v24
    v_mul_f32 v57, 0x3ec3ef15, v24
    v_fmac_f32 v25, 0xbec3ef15, v56
    v_fmac_f32 v57, 0x3f6c835e, v56
    v_sub_f32 v24, v18, v26
    v_sub_f32 v56, v50, v58
    v_add_f32 v18, v18, v26
    v_add_f32 v50, v50, v58
    v_mul_f32 v26, 0x3f3504f3, v24
    v_mul_f32 v58, 0x3f3504f3, v24
    v_fmac_f32 v26, 0xbf3504f3, v56
    v_fmac_f32 v58, 0x3f3504f3, v56
    v_sub_f32 v24, v19, v27
    v_sub_f32 v56, v51, v59
    v_add_f32 v19, v19, v27
    v_add_f32 v51, v51, v59
    v_mul_f32 v27, 0x3ec3ef15, v24
    v_mul_f32 v59, 0x3f6c835e, v24
    v_fmac_f32 v27, 0xbf6c835e, v56
    v_fmac_f32 v59, 0x3ec3ef15, v56
    v_sub_f32 v24, v60, v52
    v_sub_f32 v56, v20, v28
    v_add_f32 v20, v20, v28
    v_add_f32 v52, v52, v60
    v_sub_f32 v28, v21, v29
    v_sub_f32 v60, v53, v61
    v_add_f32 v21, v21, v29
    v_add_f32 v53, v53, v61
    v_mul_f32 v29, 0xbec3ef15, v28
    v_mul_f32 v61, 0x3f6c835e, v28
    v_fmac_f32 v29, 0xbf6c835e, v60
    v_fmac_f32 v61, 0xbec3ef15, v60
    v_sub_f32 v28, v22, v30
    v_sub_f32 v60, v54, v62
    v_add_f32 v22, v22, v30
    v_add_f32 v54, v54, v62
    v_mul_f32 v30, 0xbf3504f3, v28
    v_mul_f32 v62, 0x3f3504f3, v28
    v_fmac_f32 v30, 0xbf3504f3, v60
    v_fmac_f32 v62, 0xbf3504f3, v60
    v_sub_f32 v28, v23, v31
    v_sub_f32 v60, v55, v63
    v_add_f32 v23, v23, v31
    v_add_f32 v55, v55, v63
    v_mul_f32 v31, 0xbf6c835e, v28
    v_mul_f32 v63, 0x3ec3ef15, v28
    v_fmac_f32 v31, 0xbec3ef15, v60
    v_fmac_f32 v63, 0xbf6c835e, v60
    v_sub_f32 v28, v80, v32
    v_sub_f32 v60, v81, v64
    v_add_f32 v80, v80, v32
    v_add_f32 v81, v81, v64
    v_sub_f32 v32, v33, v41
    v_sub_f32 v64, v65, v73
    v_add_f32 v33, v33, v41
    v_add_f32 v65, v65, v73
    v_mul_f32 v41, 0x3f6c835e, v32
    v_mul_f32 v73, 0x3ec3ef15, v32
    v_fmac_f32 v41, 0xbec3ef15, v64
    v_fmac_f32 v73, 0x3f6c835e, v64
    v_sub_f32 v32, v34, v42
    v_sub_f32 v64, v66, v74
    v_add_f32 v34, v34, v42
    v_add_f32 v66, v66, v74
    v_mul_f32 v42, 0x3f3504f3, v32
    v_mul_f32 v74, 0x3f3504f3, v32
    v_fmac_f32 v42, 0xbf3504f3, v64
    v_fmac_f32 v74, 0x3f3504f3, v64
    v_sub_f32 v32, v35, v43
    v_sub_f32 v64, v67, v75
    v_add_f32 v35, v35, v43
    v_add_f32 v67, v67, v75
    v_mul_f32 v43, 0x3ec3ef15, v32
    v_mul_f32 v75, 0x3f6c835e, v32
    v_fmac_f32 v43, 0xbf6c835e, v64
    v_fmac_f32 v75, 0x3ec3ef15, v64
    v_sub_f32 v32, v76, v68
    v_sub_f32 v64, v36, v44
    v_add_f32 v36, v36, v44
    v_add_f32 v68, v68, v76
    v_sub_f32 v44, v37, v45
    v_sub_f32 v76, v69, v77
    v_add_f32 v37, v37, v45
    v_add_f32 v69, v69, v77
    v_mul_f32 v45, 0xbec3ef15, v44
    v_mul_f32 v77, 0x3f6c835e, v44
    v_fmac_f32 v45, 0xbf6c835e, v76
    v_fmac_f32 v77, 0xbec3ef15, v76
    v_sub_f32 v44, v38, v46
    v_sub_f32 v76, v70, v78
    v_add_f32 v38, v38, v46
    v_add_f32 v70, v70, v78
    v_mul_f32 v46, 0xbf3504f3, v44
    v_mul_f32 v78, 0x3f3504f3, v44
    v_fmac_f32 v46, 0xbf3504f3, v76
    v_fmac_f32 v78, 0xbf3504f3, v76
    v_sub_f32 v44, v39, v47
    v_sub_f32 v76, v71, v79
    v_add_f32 v39, v39, v47
    v_add_f32 v71, v71, v79
    v_mul_f32 v47, 0xbf6c835e, v44
    v_mul_f32 v79, 0x3ec3ef15, v44
    v_fmac_f32 v47, 0xbec3ef15, v76
    v_fmac_f32 v79, 0xbf6c835e, v76
    v_sub_f32 v44, v16, v20
    v_sub_f32 v76, v48, v52
    v_add_f32 v16, v16, v20
    v_add_f32 v48, v48, v52
    v_sub_f32 v20, v17, v21
    v_sub_f32 v52, v49, v53
    v_add_f32 v17, v17, v21
    v_add_f32 v49, v49, v53
    v_mul_f32 v21, 0x3f3504f3, v20
    v_mul_f32 v53, 0x3f3504f3, v20
    v_fmac_f32 v21, 0xbf3504f3, v52
    v_fmac_f32 v53, 0x3f3504f3, v52
    v_sub_f32 v20, v54, v50
    v_sub_f32 v52, v18, v22
    v_add_f32 v18, v18, v22
    v_add_f32 v50, v50, v54
    v_sub_f32 v22, v19, v23
    v_sub_f32 v54, v51, v55
    v_add_f32 v19, v19, v23
    v_add_f32 v51, v51, v55
    v_mul_f32 v23, 0xbf3504f3, v22
    v_mul_f32 v55, 0x3f3504f3, v22
    v_fmac_f32 v23, 0xbf3504f3, v54
    v_fmac_f32 v55, 0xbf3504f3, v54
    v_sub_f32 v22, v40, v24
    v_sub_f32 v54, v72, v56
    v_add_f32 v40, v40, v24
    v_add_f32 v72, v72, v56
    v_sub_f32 v24, v25, v29
    v_sub_f32 v56, v57, v61
    v_add_f32 v25, v25, v29
    v_add_f32 v57, v57, v61
    v_mul_f32 v29, 0x3f3504f3, v24
    v_mul_f32 v61, 0x3f3504f3, v24
    v_fmac_f32 v29, 0xbf3504f3, v56
    v_fmac_f32 v61, 0x3f3504f3, v56
    v_sub_f32 v24, v62, v58
    v_sub_f32 v56, v26, v30
    v_add_f32 v26, v26, v30
    v_add_f32 v58, v58, v62
    v_sub_f32 v30, v27, v31
    v_sub_f32 v62, v59, v63
    v_add_f32 v27, v27, v31
    v_add_f32 v59, v59, v63
    v_mul_f32 v31, 0xbf3504f3, v30
    v_mul_f32 v63, 0x3f3504f3, v30
    v_fmac_f32 v31, 0xbf3504f3, v62
    v_fmac_f32 v63, 0xbf3504f3, v62
    v_sub_f32 v30, v80, v36
    v_sub_f32 v62, v81, v68
    v_add_f32 v80, v80, v36
    v_add_f32 v81, v81, v68
    v_sub_f32 v36, v33, v37
    v_sub_f32 v68, v65, v69
    v_add_f32 v33, v33, v37
    v_add_f32 v65, v65, v69
    v_mul_f32 v37, 0x3f3504f3, v36
    v_mul_f32 v69, 0x3f3504f3, v36
    v_fmac_f32 v37, 0xbf3504f3, v68
    v_fmac_f32 v69, 0x3f3504f3, v68
    v_sub_f32 v36, v70, v66
    v_sub_f32 v68, v34, v38
    v_add_f32 v34, v34, v38
    v_add_f32 v66, v66, v70
    v_sub_f32 v38, v35, v39
    v_sub_f32 v70, v67, v71
    v_add_f32 v35, v35, v39
    v_add_f32 v67, v67, v71
    v_mul_f32 v39, 0xbf3504f3, v38
    v_mul_f32 v71, 0x3f3504f3, v38
    v_fmac_f32 v39, 0xbf3504f3, v70
    v_fmac_f32 v71, 0xbf3504f3, v70
    v_sub_f32 v38, v28, v32
    v_sub_f32 v70, v60, v64
    v_add_f32 v28, v28, v32
    v_add_f32 v60, v60, v64
    v_sub_f32 v32, v41, v45
    v_sub_f32 v64, v73, v77
    v_add_f32 v41, v41, v45
    v_add_f32 v73, v73, v77
    v_mul_f32 v45, 0x3f3504f3, v32
    v_mul_f32 v77, 0x3f3504f3, v32
    v_fmac_f32 v45, 0xbf3504f3, v64
    v_fmac_f32 v77, 0x3f3504f3, v64
    v_sub_f32 v32, v78, v74
    v_sub_f32 v64, v42, v46
    v_add_f32 v42, v42, v46
    v_add_f32 v74, v74, v78
    v_sub_f32 v46, v43, v47
    v_sub_f32 v78, v75, v79
    v_add_f32 v43, v43, v47
    v_add_f32 v75, v75, v79
    v_mul_f32 v47, 0xbf3504f3, v46
    v_mul_f32 v79, 0x3f3504f3, v46
    v_fmac_f32 v47, 0xbf3504f3, v78
    v_fmac_f32 v79, 0xbf3504f3, v78
    v_sub_f32 v46, v16, v18
    v_sub_f32 v78, v48, v50
    v_add_f32 v16, v16, v18
    v_add_f32 v48, v48, v50
    v_sub_f32 v18, v51, v49
    v_sub_f32 v50, v17, v19
    v_add_f32 v17, v17, v19
    v_add_f32 v49, v49, v51
    v_sub_f32 v19, v44, v20
    v_sub_f32 v51, v76, v52
    v_add_f32 v44, v44, v20
    v_add_f32 v76, v76, v52
    v_sub_f32 v20, v55, v53
    v_sub_f32 v52, v21, v23
    v_add_f32 v21, v21, v23
    v_add_f32 v53, v53, v55
    v_sub_f32 v23, v40, v26
    v_sub_f32 v55, v72, v58
    v_add_f32 v40, v40, v26
    v_add_f32 v72, v72, v58
    v_sub_f32 v26, v59, v57
    v_sub_f32 v58, v25, v27
    v_add_f32 v25, v25, v27
    v_add_f32 v57, v57, v59
    v_sub_f32 v27, v22, v24
    v_sub_f32 v59, v54, v56
    v_add_f32 v22, v22, v24
    v_add_f32 v54, v54, v56
    v_sub_f32 v24, v63, v61
    v_sub_f32 v56, v29, v31
    v_add_f32 v29, v29, v31
    v_add_f32 v61, v61, v63
    v_sub_f32 v31, v80, v34
    v_sub_f32 v63, v81, v66
    v_add_f32 v80, v80, v34
    v_add_f32 v81, v81, v66
    v_sub_f32 v34, v67, v65
    v_sub_f32 v66, v33, v35
    v_add_f32 v33, v33, v35
    v_add_f32 v65, v65, v67
    v_sub_f32 v35, v30, v36
    v_sub_f32 v67, v62, v68
    v_add_f32 v30, v30, v36
    v_add_f32 v62, v62, v68
    v_sub_f32 v36, v71, v69
    v_sub_f32 v68, v37, v39
    v_add_f32 v37, v37, v39
    v_add_f32 v69, v69, v71
    v_sub_f32 v39, v28, v42
    v_sub_f32 v71, v60, v74
    v_add_f32 v28, v28, v42
    v_add_f32 v60, v60, v74
    v_sub_f32 v42, v75, v73
    v_sub_f32 v74, v41, v43
    v_add_f32 v41, v41, v43
    v_add_f32 v73, v73, v75
    v_sub_f32 v43, v38, v32
    v_sub_f32 v75, v70, v64
    v_add_f32 v38, v38, v32
    v_add_f32 v70, v70, v64
    v_sub_f32 v32, v79, v77
    v_sub_f32 v64, v45, v47
    v_add_f32 v45, v45, v47
    v_add_f32 v77, v77, v79
    v_sub_f32 v47, v16, v17
    v_sub_f32 v79, v48, v49
    v_add_f32 v16, v16, v17
    v_add_f32 v48, v48, v49
    v_sub_f32 v17, v46, v18
    v_sub_f32 v49, v78, v50
    v_add_f32 v46, v46, v18
    v_add_f32 v78, v78, v50
    v_sub_f32 v18, v44, v21
    v_sub_f32 v50, v76, v53
    v_add_f32 v44, v44, v21
    v_add_f32 v76, v76, v53
    v_sub_f32 v21, v19, v20
    v_sub_f32 v53, v51, v52
    v_add_f32 v19, v19, v20
    v_add_f32 v51, v51, v52
    v_sub_f32 v20, v40, v25
    v_sub_f32 v52, v72, v57
    v_add_f32 v40, v40, v25
    v_add_f32 v72, v72, v57
    v_sub_f32 v25, v23, v26
    v_sub_f32 v57, v55, v58
    v_add_f32 v23, v23, v26
    v_add_f32 v55, v55, v58
    v_sub_f32 v26, v22, v29
    v_sub_f32 v58, v54, v61
    v_add_f32 v22, v22, v29
    v_add_f32 v54, v54, v61
    v_sub_f32 v29, v27, v24
    v_sub_f32 v61, v59, v56
    v_add_f32 v27, v27, v24
    v_add_f32 v59, v59, v56
    v_sub_f32 v24, v80, v33
    v_sub_f32 v56, v81, v65
    v_add_f32 v80, v80, v33
    v_add_f32 v81, v81, v65
    v_sub_f32 v33, v31, v34
    v_sub_f32 v65, v63, v66
    v_add_f32 v31, v31, v34
    v_add_f32 v63, v63, v66
    v_sub_f32 v34, v30, v37
    v_sub_f32 v66, v62, v69
    v_add_f32 v30, v30, v37
    v_add_f32 v62, v62, v69
    v_sub_f32 v37, v35, v36
    v_sub_f32 v69, v67, v68
    v_add_f32 v35, v35, v36
    v_add_f32 v67, v67, v68
    v_sub_f32 v36, v28, v41
    v_sub_f32 v68, v60, v73
    v_add_f32 v28, v28, v41
    v_add_f32 v60, v60, v73
    v_sub_f32 v41, v39, v42
    v_sub_f32 v73, v71, v74
    v_add_f32 v39, v39, v42
    v_add_f32 v71, v71, v74
    v_sub_f32 v42, v38, v45
    v_sub_f32 v74, v70, v77
    v_add_f32 v38, v38, v45
    v_add_f32 v70, v70, v77
    v_sub_f32 v45, v43, v32
    v_sub_f32 v77, v75, v64
    v_add_f32 v43, v43, v32
    v_add_f32 v75, v75, v64
    v_mul_f32 v32, 0x3a800000, v3
    v_cos_f32 v64, v32
    v_sin_f32 v82, v32
    s_nop 0
    v_mul_f32 v83, v80, v64
    v_fma_f32 v83, -v81, v82, v83
    v_mul_f32 v81, v81, v64
    v_fmac_f32 v81, v80, v82
    v_mul_f32 v32, 0x3b000000, v3
    v_cos_f32 v64, v32
    v_sin_f32 v82, v32
    s_nop 0
    v_mul_f32 v80, v40, v64
    v_fma_f32 v80, -v72, v82, v80
    v_mul_f32 v72, v72, v64
    v_fmac_f32 v72, v40, v82
    v_mul_f32 v32, 0x3b400000, v3
    v_cos_f32 v64, v32
    v_sin_f32 v82, v32
    s_nop 0
    v_mul_f32 v40, v28, v64
    v_fma_f32 v40, -v60, v82, v40
    v_mul_f32 v60, v60, v64
    v_fmac_f32 v60, v28, v82
    v_mul_f32 v32, 0x3b800000, v3
    v_cos_f32 v64, v32
    v_sin_f32 v82, v32
    s_nop 0
    v_mul_f32 v28, v44, v64
    v_fma_f32 v28, -v76, v82, v28
    v_mul_f32 v76, v76, v64
    v_fmac_f32 v76, v44, v82
    v_mul_f32 v32, 0x3ba00000, v3
    v_cos_f32 v64, v32
    v_sin_f32 v82, v32
    s_nop 0
    v_mul_f32 v44, v30, v64
    v_fma_f32 v44, -v62, v82, v44
    v_mul_f32 v62, v62, v64
    v_fmac_f32 v62, v30, v82
    v_mul_f32 v32, 0x3bc00000, v3
    v_cos_f32 v64, v32
    v_sin_f32 v82, v32
    s_nop 0
    v_mul_f32 v30, v22, v64
    v_fma_f32 v30, -v54, v82, v30
    v_mul_f32 v54, v54, v64
    v_fmac_f32 v54, v22, v82
    v_mul_f32 v32, 0x3be00000, v3
    v_cos_f32 v64, v32
    v_sin_f32 v82, v32
    s_nop 0
    v_mul_f32 v22, v38, v64
    v_fma_f32 v22, -v70, v82, v22
    v_mul_f32 v70, v70, v64
    v_fmac_f32 v70, v38, v82
    v_mul_f32 v32, 0x3c000000, v3
    v_cos_f32 v64, v32
    v_sin_f32 v82, v32
    s_nop 0
    v_mul_f32 v38, v46, v64
    v_fma_f32 v38, -v78, v82, v38
    v_mul_f32 v78, v78, v64
    v_fmac_f32 v78, v46, v82
    v_mul_f32 v32, 0x3c100000, v3
    v_cos_f32 v64, v32
    v_sin_f32 v82, v32
    s_nop 0
    v_mul_f32 v46, v31, v64
    v_fma_f32 v46, -v63, v82, v46
    v_mul_f32 v63, v63, v64
    v_fmac_f32 v63, v31, v82
    v_mul_f32 v32, 0x3c200000, v3
    v_cos_f32 v64, v32
    v_sin_f32 v82, v32
    s_nop 0
    v_mul_f32 v31, v23, v64
    v_fma_f32 v31, -v55, v82, v31
    v_mul_f32 v55, v55, v64
    v_fmac_f32 v55, v23, v82
    v_mul_f32 v32, 0x3c300000, v3
    v_cos_f32 v64, v32
    v_sin_f32 v82, v32
    s_nop 0
    v_mul_f32 v23, v39, v64
    v_fma_f32 v23, -v71, v82, v23
    v_mul_f32 v71, v71, v64
    v_fmac_f32 v71, v39, v82
    v_mul_f32 v32, 0x3c400000, v3
    v_cos_f32 v64, v32
    v_sin_f32 v82, v32
    s_nop 0
    v_mul_f32 v39, v19, v64
    v_fma_f32 v39, -v51, v82, v39
    v_mul_f32 v51, v51, v64
    v_fmac_f32 v51, v19, v82
    v_mul_f32 v32, 0x3c500000, v3
    v_cos_f32 v64, v32
    v_sin_f32 v82, v32
    s_nop 0
    v_mul_f32 v19, v35, v64
    v_fma_f32 v19, -v67, v82, v19
    v_mul_f32 v67, v67, v64
    v_fmac_f32 v67, v35, v82
    v_mul_f32 v32, 0x3c600000, v3
    v_cos_f32 v64, v32
    v_sin_f32 v82, v32
    s_nop 0
    v_mul_f32 v35, v27, v64
    v_fma_f32 v35, -v59, v82, v35
    v_mul_f32 v59, v59, v64
    v_fmac_f32 v59, v27, v82
    v_mul_f32 v32, 0x3c700000, v3
    v_cos_f32 v64, v32
    v_sin_f32 v82, v32
    s_nop 0
    v_mul_f32 v27, v43, v64
    v_fma_f32 v27, -v75, v82, v27
    v_mul_f32 v75, v75, v64
    v_fmac_f32 v75, v43, v82
    v_mul_f32 v32, 0x3c800000, v3
    v_cos_f32 v64, v32
    v_sin_f32 v82, v32
    s_nop 0
    v_mul_f32 v43, v47, v64
    v_fma_f32 v43, -v79, v82, v43
    v_mul_f32 v79, v79, v64
    v_fmac_f32 v79, v47, v82
    v_mul_f32 v32, 0x3c880000, v3
    v_cos_f32 v64, v32
    v_sin_f32 v82, v32
    s_nop 0
    v_mul_f32 v47, v24, v64
    v_fma_f32 v47, -v56, v82, v47
    v_mul_f32 v56, v56, v64
    v_fmac_f32 v56, v24, v82
    v_mul_f32 v32, 0x3c900000, v3
    v_cos_f32 v64, v32
    v_sin_f32 v82, v32
    s_nop 0
    v_mul_f32 v24, v20, v64
    v_fma_f32 v24, -v52, v82, v24
    v_mul_f32 v52, v52, v64
    v_fmac_f32 v52, v20, v82
    v_mul_f32 v32, 0x3c980000, v3
    v_cos_f32 v64, v32
    v_sin_f32 v82, v32
    s_nop 0
    v_mul_f32 v20, v36, v64
    v_fma_f32 v20, -v68, v82, v20
    v_mul_f32 v68, v68, v64
    v_fmac_f32 v68, v36, v82
    v_mul_f32 v32, 0x3ca00000, v3
    v_cos_f32 v64, v32
    v_sin_f32 v82, v32
    s_nop 0
    v_mul_f32 v36, v18, v64
    v_fma_f32 v36, -v50, v82, v36
    v_mul_f32 v50, v50, v64
    v_fmac_f32 v50, v18, v82
    v_mul_f32 v32, 0x3ca80000, v3
    v_cos_f32 v64, v32
    v_sin_f32 v82, v32
    s_nop 0
    v_mul_f32 v18, v34, v64
    v_fma_f32 v18, -v66, v82, v18
    v_mul_f32 v66, v66, v64
    v_fmac_f32 v66, v34, v82
    v_mul_f32 v32, 0x3cb00000, v3
    v_cos_f32 v64, v32
    v_sin_f32 v82, v32
    s_nop 0
    v_mul_f32 v34, v26, v64
    v_fma_f32 v34, -v58, v82, v34
    v_mul_f32 v58, v58, v64
    v_fmac_f32 v58, v26, v82
    v_mul_f32 v32, 0x3cb80000, v3
    v_cos_f32 v64, v32
    v_sin_f32 v82, v32
    s_nop 0
    v_mul_f32 v26, v42, v64
    v_fma_f32 v26, -v74, v82, v26
    v_mul_f32 v74, v74, v64
    v_fmac_f32 v74, v42, v82
    v_mul_f32 v32, 0x3cc00000, v3
    v_cos_f32 v64, v32
    v_sin_f32 v82, v32
    s_nop 0
    v_mul_f32 v42, v17, v64
    v_fma_f32 v42, -v49, v82, v42
    v_mul_f32 v49, v49, v64
    v_fmac_f32 v49, v17, v82
    v_mul_f32 v32, 0x3cc80000, v3
    v_cos_f32 v64, v32
    v_sin_f32 v82, v32
    s_nop 0
    v_mul_f32 v17, v33, v64
    v_fma_f32 v17, -v65, v82, v17
    v_mul_f32 v65, v65, v64
    v_fmac_f32 v65, v33, v82
    v_mul_f32 v32, 0x3cd00000, v3
    v_cos_f32 v64, v32
    v_sin_f32 v82, v32
    s_nop 0
    v_mul_f32 v33, v25, v64
    v_fma_f32 v33, -v57, v82, v33
    v_mul_f32 v57, v57, v64
    v_fmac_f32 v57, v25, v82
    v_mul_f32 v32, 0x3cd80000, v3
    v_cos_f32 v64, v32
    v_sin_f32 v82, v32
    s_nop 0
    v_mul_f32 v25, v41, v64
    v_fma_f32 v25, -v73, v82, v25
    v_mul_f32 v73, v73, v64
    v_fmac_f32 v73, v41, v82
    v_mul_f32 v32, 0x3ce00000, v3
    v_cos_f32 v64, v32
    v_sin_f32 v82, v32
    s_nop 0
    v_mul_f32 v41, v21, v64
    v_fma_f32 v41, -v53, v82, v41
    v_mul_f32 v53, v53, v64
    v_fmac_f32 v53, v21, v82
    v_mul_f32 v32, 0x3ce80000, v3
    v_cos_f32 v64, v32
    v_sin_f32 v82, v32
    s_nop 0
    v_mul_f32 v21, v37, v64
    v_fma_f32 v21, -v69, v82, v21
    v_mul_f32 v69, v69, v64
    v_fmac_f32 v69, v37, v82
    v_mul_f32 v32, 0x3cf00000, v3
    v_cos_f32 v64, v32
    v_sin_f32 v82, v32
    s_nop 0
    v_mul_f32 v37, v29, v64
    v_fma_f32 v37, -v61, v82, v37
    v_mul_f32 v61, v61, v64
    v_fmac_f32 v61, v29, v82
    v_mul_f32 v32, 0x3cf80000, v3
    v_cos_f32 v64, v32
    v_sin_f32 v82, v32
    s_nop 0
    v_mul_f32 v29, v45, v64
    v_fma_f32 v29, -v77, v82, v29
    v_mul_f32 v77, v77, v64
    v_fmac_f32 v77, v45, v82
    ds_write_b32 v4, v16 offset:0
    ds_write_b32 v4, v48 offset:4
    ds_write_b32 v4, v83 offset:264
    ds_write_b32 v4, v81 offset:268
    ds_write_b32 v4, v80 offset:528
    ds_write_b32 v4, v72 offset:532
    ds_write_b32 v4, v40 offset:792
    ds_write_b32 v4, v60 offset:796
    ds_write_b32 v4, v28 offset:1056
    ds_write_b32 v4, v76 offset:1060
    ds_write_b32 v4, v44 offset:1320
    ds_write_b32 v4, v62 offset:1324
    ds_write_b32 v4, v30 offset:1584
    ds_write_b32 v4, v54 offset:1588
    ds_write_b32 v4, v22 offset:1848
    ds_write_b32 v4, v70 offset:1852
    ds_write_b32 v4, v38 offset:2112
    ds_write_b32 v4, v78 offset:2116
    ds_write_b32 v4, v46 offset:2376
    ds_write_b32 v4, v63 offset:2380
    ds_write_b32 v4, v31 offset:2640
    ds_write_b32 v4, v55 offset:2644
    ds_write_b32 v4, v23 offset:2904
    ds_write_b32 v4, v71 offset:2908
    ds_write_b32 v4, v39 offset:3168
    ds_write_b32 v4, v51 offset:3172
    ds_write_b32 v4, v19 offset:3432
    ds_write_b32 v4, v67 offset:3436
    ds_write_b32 v4, v35 offset:3696
    ds_write_b32 v4, v59 offset:3700
    ds_write_b32 v4, v27 offset:3960
    ds_write_b32 v4, v75 offset:3964
    ds_write_b32 v4, v43 offset:4224
    ds_write_b32 v4, v79 offset:4228
    ds_write_b32 v4, v47 offset:4488
    ds_write_b32 v4, v56 offset:4492
    ds_write_b32 v4, v24 offset:4752
    ds_write_b32 v4, v52 offset:4756
    ds_write_b32 v4, v20 offset:5016
    ds_write_b32 v4, v68 offset:5020
    ds_write_b32 v4, v36 offset:5280
    ds_write_b32 v4, v50 offset:5284
    ds_write_b32 v4, v18 offset:5544
    ds_write_b32 v4, v66 offset:5548
    ds_write_b32 v4, v34 offset:5808
    ds_write_b32 v4, v58 offset:5812
    ds_write_b32 v4, v26 offset:6072
    ds_write_b32 v4, v74 offset:6076
    ds_write_b32 v4, v42 offset:6336
    ds_write_b32 v4, v49 offset:6340
    ds_write_b32 v4, v17 offset:6600
    ds_write_b32 v4, v65 offset:6604
    ds_write_b32 v4, v33 offset:6864
    ds_write_b32 v4, v57 offset:6868
    ds_write_b32 v4, v25 offset:7128
    ds_write_b32 v4, v73 offset:7132
    ds_write_b32 v4, v41 offset:7392
    ds_write_b32 v4, v53 offset:7396
    ds_write_b32 v4, v21 offset:7656
    ds_write_b32 v4, v69 offset:7660
    ds_write_b32 v4, v37 offset:7920
    ds_write_b32 v4, v61 offset:7924
    ds_write_b32 v4, v29 offset:8184
    ds_write_b32 v4, v77 offset:8188
    s_waitcnt lgkmcnt(0)
    ds_read_b32 v16, v5 offset:0
    ds_read_b32 v48, v5 offset:4
    ds_read_b32 v83, v5 offset:8
    ds_read_b32 v81, v5 offset:12
    ds_read_b32 v80, v5 offset:16
    ds_read_b32 v72, v5 offset:20
    ds_read_b32 v40, v5 offset:24
    ds_read_b32 v60, v5 offset:28
    ds_read_b32 v28, v5 offset:32
    ds_read_b32 v76, v5 offset:36
    ds_read_b32 v44, v5 offset:40
    ds_read_b32 v62, v5 offset:44
    ds_read_b32 v30, v5 offset:48
    ds_read_b32 v54, v5 offset:52
    s_waitcnt lgkmcnt(0)
    ds_read_b32 v22, v5 offset:56
    ds_read_b32 v70, v5 offset:60
    ds_read_b32 v38, v5 offset:64
    ds_read_b32 v78, v5 offset:68
    ds_read_b32 v46, v5 offset:72
    ds_read_b32 v63, v5 offset:76
    ds_read_b32 v31, v5 offset:80
    ds_read_b32 v55, v5 offset:84
    ds_read_b32 v23, v5 offset:88
    ds_read_b32 v71, v5 offset:92
    ds_read_b32 v39, v5 offset:96
    ds_read_b32 v51, v5 offset:100
    ds_read_b32 v19, v5 offset:104
    ds_read_b32 v67, v5 offset:108
    s_waitcnt lgkmcnt(0)
    ds_read_b32 v35, v5 offset:112
    ds_read_b32 v59, v5 offset:116
    ds_read_b32 v27, v5 offset:120
    ds_read_b32 v75, v5 offset:124
    ds_read_b32 v43, v5 offset:128
    ds_read_b32 v79, v5 offset:132
    ds_read_b32 v47, v5 offset:136
    ds_read_b32 v56, v5 offset:140
    ds_read_b32 v24, v5 offset:144
    ds_read_b32 v52, v5 offset:148
    ds_read_b32 v20, v5 offset:152
    ds_read_b32 v68, v5 offset:156
    ds_read_b32 v36, v5 offset:160
    ds_read_b32 v50, v5 offset:164
    s_waitcnt lgkmcnt(0)
    ds_read_b32 v18, v5 offset:168
    ds_read_b32 v66, v5 offset:172
    ds_read_b32 v34, v5 offset:176
    ds_read_b32 v58, v5 offset:180
    ds_read_b32 v26, v5 offset:184
    ds_read_b32 v74, v5 offset:188
    ds_read_b32 v42, v5 offset:192
    ds_read_b32 v49, v5 offset:196
    ds_read_b32 v17, v5 offset:200
    ds_read_b32 v65, v5 offset:204
    ds_read_b32 v33, v5 offset:208
    ds_read_b32 v57, v5 offset:212
    ds_read_b32 v25, v5 offset:216
    ds_read_b32 v73, v5 offset:220
    s_waitcnt lgkmcnt(0)
    ds_read_b32 v41, v5 offset:224
    ds_read_b32 v53, v5 offset:228
    ds_read_b32 v21, v5 offset:232
    ds_read_b32 v69, v5 offset:236
    ds_read_b32 v37, v5 offset:240
    ds_read_b32 v61, v5 offset:244
    ds_read_b32 v29, v5 offset:248
    ds_read_b32 v77, v5 offset:252
    s_waitcnt lgkmcnt(0)
    v_sub_f32 v32, v16, v43
    v_sub_f32 v64, v48, v79
    v_add_f32 v16, v16, v43
    v_add_f32 v48, v48, v79
    v_sub_f32 v43, v83, v47
    v_sub_f32 v79, v81, v56
    v_add_f32 v83, v83, v47
    v_add_f32 v81, v81, v56
    v_mul_f32 v47, 0x3f7b14be, v43
    v_mul_f32 v56, 0x3e47c5c2, v43
    v_fmac_f32 v47, 0xbe47c5c2, v79
    v_fmac_f32 v56, 0x3f7b14be, v79
    v_sub_f32 v43, v80, v24
    v_sub_f32 v79, v72, v52
    v_add_f32 v80, v80, v24
    v_add_f32 v72, v72, v52
    v_mul_f32 v24, 0x3f6c835e, v43
    v_mul_f32 v52, 0x3ec3ef15, v43
    v_fmac_f32 v24, 0xbec3ef15, v79
    v_fmac_f32 v52, 0x3f6c835e, v79
    v_sub_f32 v43, v40, v20
    v_sub_f32 v79, v60, v68
    v_add_f32 v40, v40, v20
    v_add_f32 v60, v60, v68
    v_mul_f32 v20, 0x3f54db31, v43
    v_mul_f32 v68, 0x3f0e39da, v43
    v_fmac_f32 v20, 0xbf0e39da, v79
    v_fmac_f32 v68, 0x3f54db31, v79
    v_sub_f32 v43, v28, v36
    v_sub_f32 v79, v76, v50
    v_add_f32 v28, v28, v36
    v_add_f32 v76, v76, v50
    v_mul_f32 v36, 0x3f3504f3, v43
    v_mul_f32 v50, 0x3f3504f3, v43
    v_fmac_f32 v36, 0xbf3504f3, v79
    v_fmac_f32 v50, 0x3f3504f3, v79
    v_sub_f32 v43, v44, v18
    v_sub_f32 v79, v62, v66
    v_add_f32 v44, v44, v18
    v_add_f32 v62, v62, v66
    v_mul_f32 v18, 0x3f0e39da, v43
    v_mul_f32 v66, 0x3f54db31, v43
    v_fmac_f32 v18, 0xbf54db31, v79
    v_fmac_f32 v66, 0x3f0e39da, v79
    v_sub_f32 v43, v30, v34
    v_sub_f32 v79, v54, v58
    v_add_f32 v30, v30, v34
    v_add_f32 v54, v54, v58
    v_mul_f32 v34, 0x3ec3ef15, v43
    v_mul_f32 v58, 0x3f6c835e, v43
    v_fmac_f32 v34, 0xbf6c835e, v79
    v_fmac_f32 v58, 0x3ec3ef15, v79
    v_sub_f32 v43, v22, v26
    v_sub_f32 v79, v70, v74
    v_add_f32 v22, v22, v26
    v_add_f32 v70, v70, v74
    v_mul_f32 v26, 0x3e47c5c2, v43
    v_mul_f32 v74, 0x3f7b14be, v43
    v_fmac_f32 v26, 0xbf7b14be, v79
    v_fmac_f32 v74, 0x3e47c5c2, v79
    v_sub_f32 v43, v49, v78
    v_sub_f32 v79, v38, v42
    v_add_f32 v38, v38, v42
    v_add_f32 v78, v78, v49
    v_sub_f32 v42, v46, v17
    v_sub_f32 v49, v63, v65
    v_add_f32 v46, v46, v17
    v_add_f32 v63, v63, v65
    v_mul_f32 v17, 0xbe47c5c2, v42
    v_mul_f32 v65, 0x3f7b14be, v42
    v_fmac_f32 v17, 0xbf7b14be, v49
    v_fmac_f32 v65, 0xbe47c5c2, v49
    v_sub_f32 v42, v31, v33
    v_sub_f32 v49, v55, v57
    v_add_f32 v31, v31, v33
    v_add_f32 v55, v55, v57
    v_mul_f32 v33, 0xbec3ef15, v42
    v_mul_f32 v57, 0x3f6c835e, v42
    v_fmac_f32 v33, 0xbf6c835e, v49
    v_fmac_f32 v57, 0xbec3ef15, v49
    v_sub_f32 v42, v23, v25
    v_sub_f32 v49, v71, v73
    v_add_f32 v23, v23, v25
    v_add_f32 v71, v71, v73
    v_mul_f32 v25, 0xbf0e39da, v42
    v_mul_f32 v73, 0x3f54db31, v42
    v_fmac_f32 v25, 0xbf54db31, v49
    v_fmac_f32 v73, 0xbf0e39da, v49
    v_sub_f32 v42, v39, v41
    v_sub_f32 v49, v51, v53
    v_add_f32 v39, v39, v41
    v_add_f32 v51, v51, v53
    v_mul_f32 v41, 0xbf3504f3, v42
    v_mul_f32 v53, 0x3f3504f3, v42
    v_fmac_f32 v41, 0xbf3504f3, v49
    v_fmac_f32 v53, 0xbf3504f3, v49
    v_sub_f32 v42, v19, v21
    v_sub_f32 v49, v67, v69
    v_add_f32 v19, v19, v21
    v_add_f32 v67, v67, v69
    v_mul_f32 v21, 0xbf54db31, v42
    v_mul_f32 v69, 0x3f0e39da, v42
    v_fmac_f32 v21, 0xbf0e39da, v49
    v_fmac_f32 v69, 0xbf54db31, v49
    v_sub_f32 v42, v35, v37
    v_sub_f32 v49, v59, v61
    v_add_f32 v35, v35, v37
    v_add_f32 v59, v59, v61
    v_mul_f32 v37, 0xbf6c835e, v42
    v_mul_f32 v61, 0x3ec3ef15, v42
    v_fmac_f32 v37, 0xbec3ef15, v49
    v_fmac_f32 v61, 0xbf6c835e, v49
    v_sub_f32 v42, v27, v29
    v_sub_f32 v49, v75, v77
    v_add_f32 v27, v27, v29
    v_add_f32 v75, v75, v77
    v_mul_f32 v29, 0xbf7b14be, v42
    v_mul_f32 v77, 0x3e47c5c2, v42
    v_fmac_f32 v29, 0xbe47c5c2, v49
    v_fmac_f32 v77, 0xbf7b14be, v49
    v_sub_f32 v42, v16, v38
    v_sub_f32 v49, v48, v78
    v_add_f32 v16, v16, v38
    v_add_f32 v48, v48, v78
    v_sub_f32 v38, v83, v46
    v_sub_f32 v78, v81, v63
    v_add_f32 v83, v83, v46
    v_add_f32 v81, v81, v63
    v_mul_f32 v46, 0x3f6c835e, v38
    v_mul_f32 v63, 0x3ec3ef15, v38
    v_fmac_f32 v46, 0xbec3ef15, v78
    v_fmac_f32 v63, 0x3f6c835e, v78
    v_sub_f32 v38, v80, v31
    v_sub_f32 v78, v72, v55
    v_add_f32 v80, v80, v31
    v_add_f32 v72, v72, v55
    v_mul_f32 v31, 0x3f3504f3, v38
    v_mul_f32 v55, 0x3f3504f3, v38
    v_fmac_f32 v31, 0xbf3504f3, v78
    v_fmac_f32 v55, 0x3f3504f3, v78
    v_sub_f32 v38, v40, v23
    v_sub_f32 v78, v60, v71
    v_add_f32 v40, v40, v23
    v_add_f32 v60, v60, v71
    v_mul_f32 v23, 0x3ec3ef15, v38
    v_mul_f32 v71, 0x3f6c835e, v38
    v_fmac_f32 v23, 0xbf6c835e, v78
    v_fmac_f32 v71, 0x3ec3ef15, v78
    v_sub_f32 v38, v51, v76
    v_sub_f32 v78, v28, v39
    v_add_f32 v28, v28, v39
    v_add_f32 v76, v76, v51
    v_sub_f32 v39, v44, v19
    v_sub_f32 v51, v62, v67
    v_add_f32 v44, v44, v19
    v_add_f32 v62, v62, v67
    v_mul_f32 v19, 0xbec3ef15, v39
    v_mul_f32 v67, 0x3f6c835e, v39
    v_fmac_f32 v19, 0xbf6c835e, v51
    v_fmac_f32 v67, 0xbec3ef15, v51
    v_sub_f32 v39, v30, v35
    v_sub_f32 v51, v54, v59
    v_add_f32 v30, v30, v35
    v_add_f32 v54, v54, v59
    v_mul_f32 v35, 0xbf3504f3, v39
    v_mul_f32 v59, 0x3f3504f3, v39
    v_fmac_f32 v35, 0xbf3504f3, v51
    v_fmac_f32 v59, 0xbf3504f3, v51
    v_sub_f32 v39, v22, v27
    v_sub_f32 v51, v70, v75
    v_add_f32 v22, v22, v27
    v_add_f32 v70, v70, v75
    v_mul_f32 v27, 0xbf6c835e, v39
    v_mul_f32 v75, 0x3ec3ef15, v39
    v_fmac_f32 v27, 0xbec3ef15, v51
    v_fmac_f32 v75, 0xbf6c835e, v51
    v_sub_f32 v39, v32, v43
    v_sub_f32 v51, v64, v79
    v_add_f32 v32, v32, v43
    v_add_f32 v64, v64, v79
    v_sub_f32 v43, v47, v17
    v_sub_f32 v79, v56, v65
    v_add_f32 v47, v47, v17
    v_add_f32 v56, v56, v65
    v_mul_f32 v17, 0x3f6c835e, v43
    v_mul_f32 v65, 0x3ec3ef15, v43
    v_fmac_f32 v17, 0xbec3ef15, v79
    v_fmac_f32 v65, 0x3f6c835e, v79
    v_sub_f32 v43, v24, v33
    v_sub_f32 v79, v52, v57
    v_add_f32 v24, v24, v33
    v_add_f32 v52, v52, v57
    v_mul_f32 v33, 0x3f3504f3, v43
    v_mul_f32 v57, 0x3f3504f3, v43
    v_fmac_f32 v33, 0xbf3504f3, v79
    v_fmac_f32 v57, 0x3f3504f3, v79
    v_sub_f32 v43, v20, v25
    v_sub_f32 v79, v68, v73
    v_add_f32 v20, v20, v25
    v_add_f32 v68, v68, v73
    v_mul_f32 v25, 0x3ec3ef15, v43
    v_mul_f32 v73, 0x3f6c835e, v43
    v_fmac_f32 v25, 0xbf6c835e, v79
    v_fmac_f32 v73, 0x3ec3ef15, v79
    v_sub_f32 v43, v53, v50
    v_sub_f32 v79, v36, v41
    v_add_f32 v36, v36, v41
    v_add_f32 v50, v50, v53
    v_sub_f32 v41, v18, v21
    v_sub_f32 v53, v66, v69
    v_add_f32 v18, v18, v21
    v_add_f32 v66, v66, v69
    v_mul_f32 v21, 0xbec3ef15, v41
    v_mul_f32 v69, 0x3f6c835e, v41
    v_fmac_f32 v21, 0xbf6c835e, v53
    v_fmac_f32 v69, 0xbec3ef15, v53
    v_sub_f32 v41, v34, v37
    v_sub_f32 v53, v58, v61
    v_add_f32 v34, v34, v37
    v_add_f32 v58, v58, v61
    v_mul_f32 v37, 0xbf3504f3, v41
    v_mul_f32 v61, 0x3f3504f3, v41
    v_fmac_f32 v37, 0xbf3504f3, v53
    v_fmac_f32 v61, 0xbf3504f3, v53
    v_sub_f32 v41, v26, v29
    v_sub_f32 v53, v74, v77
    v_add_f32 v26, v26, v29
    v_add_f32 v74, v74, v77
    v_mul_f32 v29, 0xbf6c835e, v41
    v_mul_f32 v77, 0x3ec3ef15, v41
    v_fmac_f32 v29, 0xbec3ef15, v53
    v_fmac_f32 v77, 0xbf6c835e, v53
    v_sub_f32 v41, v16, v28
    v_sub_f32 v53, v48, v76
    v_add_f32 v16, v16, v28
    v_add_f32 v48, v48, v76
    v_sub_f32 v28, v83, v44
    v_sub_f32 v76, v81, v62
    v_add_f32 v83, v83, v44
    v_add_f32 v81, v81, v62
    v_mul_f32 v44, 0x3f3504f3, v28
    v_mul_f32 v62, 0x3f3504f3, v28
    v_fmac_f32 v44, 0xbf3504f3, v76
    v_fmac_f32 v62, 0x3f3504f3, v76
    v_sub_f32 v28, v54, v72
    v_sub_f32 v76, v80, v30
    v_add_f32 v80, v80, v30
    v_add_f32 v72, v72, v54
    v_sub_f32 v30, v40, v22
    v_sub_f32 v54, v60, v70
    v_add_f32 v40, v40, v22
    v_add_f32 v60, v60, v70
    v_mul_f32 v22, 0xbf3504f3, v30
    v_mul_f32 v70, 0x3f3504f3, v30
    v_fmac_f32 v22, 0xbf3504f3, v54
    v_fmac_f32 v70, 0xbf3504f3, v54
    v_sub_f32 v30, v42, v38
    v_sub_f32 v54, v49, v78
    v_add_f32 v42, v42, v38
    v_add_f32 v49, v49, v78
    v_sub_f32 v38, v46, v19
    v_sub_f32 v78, v63, v67
    v_add_f32 v46, v46, v19
    v_add_f32 v63, v63, v67
    v_mul_f32 v19, 0x3f3504f3, v38
    v_mul_f32 v67, 0x3f3504f3, v38
    v_fmac_f32 v19, 0xbf3504f3, v78
    v_fmac_f32 v67, 0x3f3504f3, v78
    v_sub_f32 v38, v59, v55
    v_sub_f32 v78, v31, v35
    v_add_f32 v31, v31, v35
    v_add_f32 v55, v55, v59
    v_sub_f32 v35, v23, v27
    v_sub_f32 v59, v71, v75
    v_add_f32 v23, v23, v27
    v_add_f32 v71, v71, v75
    v_mul_f32 v27, 0xbf3504f3, v35
    v_mul_f32 v75, 0x3f3504f3, v35
    v_fmac_f32 v27, 0xbf3504f3, v59
    v_fmac_f32 v75, 0xbf3504f3, v59
    v_sub_f32 v35, v32, v36
    v_sub_f32 v59, v64, v50
    v_add_f32 v32, v32, v36
    v_add_f32 v64, v64, v50
    v_sub_f32 v36, v47, v18
    v_sub_f32 v50, v56, v66
    v_add_f32 v47, v47, v18
    v_add_f32 v56, v56, v66
    v_mul_f32 v18, 0x3f3504f3, v36
    v_mul_f32 v66, 0x3f3504f3, v36
    v_fmac_f32 v18, 0xbf3504f3, v50
    v_fmac_f32 v66, 0x3f3504f3, v50
    v_sub_f32 v36, v58, v52
    v_sub_f32 v50, v24, v34
    v_add_f32 v24, v24, v34
    v_add_f32 v52, v52, v58
    v_sub_f32 v34, v20, v26
    v_sub_f32 v58, v68, v74
    v_add_f32 v20, v20, v26
    v_add_f32 v68, v68, v74
    v_mul_f32 v26, 0xbf3504f3, v34
    v_mul_f32 v74, 0x3f3504f3, v34
    v_fmac_f32 v26, 0xbf3504f3, v58
    v_fmac_f32 v74, 0xbf3504f3, v58
    v_sub_f32 v34, v39, v43
    v_sub_f32 v58, v51, v79
    v_add_f32 v39, v39, v43
    v_add_f32 v51, v51, v79
    v_sub_f32 v43, v17, v21
    v_sub_f32 v79, v65, v69
    v_add_f32 v17, v17, v21
    v_add_f32 v65, v65, v69
    v_mul_f32 v21, 0x3f3504f3, v43
    v_mul_f32 v69, 0x3f3504f3, v43
    v_fmac_f32 v21, 0xbf3504f3, v79
    v_fmac_f32 v69, 0x3f3504f3, v79
    v_sub_f32 v43, v61, v57
    v_sub_f32 v79, v33, v37
    v_add_f32 v33, v33, v37
    v_add_f32 v57, v57, v61
    v_sub_f32 v37, v25, v29
    v_sub_f32 v61, v73, v77
    v_add_f32 v25, v25, v29
    v_add_f32 v73, v73, v77
    v_mul_f32 v29, 0xbf3504f3, v37
    v_mul_f32 v77, 0x3f3504f3, v37
    v_fmac_f32 v29, 0xbf3504f3, v61
    v_fmac_f32 v77, 0xbf3504f3, v61
    v_sub_f32 v37, v16, v80
    v_sub_f32 v61, v48, v72
    v_add_f32 v16, v16, v80
    v_add_f32 v48, v48, v72
    v_sub_f32 v80, v60, v81
    v_sub_f32 v72, v83, v40
    v_add_f32 v83, v83, v40
    v_add_f32 v81, v81, v60
    v_sub_f32 v40, v41, v28
    v_sub_f32 v60, v53, v76
    v_add_f32 v41, v41, v28
    v_add_f32 v53, v53, v76
    v_sub_f32 v28, v70, v62
    v_sub_f32 v76, v44, v22
    v_add_f32 v44, v44, v22
    v_add_f32 v62, v62, v70
    v_sub_f32 v22, v42, v31
    v_sub_f32 v70, v49, v55
    v_add_f32 v42, v42, v31
    v_add_f32 v49, v49, v55
    v_sub_f32 v31, v71, v63
    v_sub_f32 v55, v46, v23
    v_add_f32 v46, v46, v23
    v_add_f32 v63, v63, v71
    v_sub_f32 v23, v30, v38
    v_sub_f32 v71, v54, v78
    v_add_f32 v30, v30, v38
    v_add_f32 v54, v54, v78
    v_sub_f32 v38, v75, v67
    v_sub_f32 v78, v19, v27
    v_add_f32 v19, v19, v27
    v_add_f32 v67, v67, v75
    v_sub_f32 v27, v32, v24
    v_sub_f32 v75, v64, v52
    v_add_f32 v32, v32, v24
    v_add_f32 v64, v64, v52
    v_sub_f32 v24, v68, v56
    v_sub_f32 v52, v47, v20
    v_add_f32 v47, v47, v20
    v_add_f32 v56, v56, v68
    v_sub_f32 v20, v35, v36
    v_sub_f32 v68, v59, v50
    v_add_f32 v35, v35, v36
    v_add_f32 v59, v59, v50
    v_sub_f32 v36, v74, v66
    v_sub_f32 v50, v18, v26
    v_add_f32 v18, v18, v26
    v_add_f32 v66, v66, v74
    v_sub_f32 v26, v39, v33
    v_sub_f32 v74, v51, v57
    v_add_f32 v39, v39, v33
    v_add_f32 v51, v51, v57
    v_sub_f32 v33, v73, v65
    v_sub_f32 v57, v17, v25
    v_add_f32 v17, v17, v25
    v_add_f32 v65, v65, v73
    v_sub_f32 v25, v34, v43
    v_sub_f32 v73, v58, v79
    v_add_f32 v34, v34, v43
    v_add_f32 v58, v58, v79
    v_sub_f32 v43, v77, v69
    v_sub_f32 v79, v21, v29
    v_add_f32 v21, v21, v29
    v_add_f32 v69, v69, v77
    v_sub_f32 v29, v16, v83
    v_sub_f32 v77, v48, v81
    v_add_f32 v16, v16, v83
    v_add_f32 v48, v48, v81
    v_sub_f32 v83, v37, v80
    v_sub_f32 v81, v61, v72
    v_add_f32 v37, v37, v80
    v_add_f32 v61, v61, v72
    v_sub_f32 v80, v41, v44
    v_sub_f32 v72, v53, v62
    v_add_f32 v41, v41, v44
    v_add_f32 v53, v53, v62
    v_sub_f32 v44, v40, v28
    v_sub_f32 v62, v60, v76
    v_add_f32 v40, v40, v28
    v_add_f32 v60, v60, v76
    v_sub_f32 v28, v42, v46
    v_sub_f32 v76, v49, v63
    v_add_f32 v42, v42, v46
    v_add_f32 v49, v49, v63
    v_sub_f32 v46, v22, v31
    v_sub_f32 v63, v70, v55
    v_add_f32 v22, v22, v31
    v_add_f32 v70, v70, v55
    v_sub_f32 v31, v30, v19
    v_sub_f32 v55, v54, v67
    v_add_f32 v30, v30, v19
    v_add_f32 v54, v54, v67
    v_sub_f32 v19, v23, v38
    v_sub_f32 v67, v71, v78
    v_add_f32 v23, v23, v38
    v_add_f32 v71, v71, v78
    v_sub_f32 v38, v32, v47
    v_sub_f32 v78, v64, v56
    v_add_f32 v32, v32, v47
    v_add_f32 v64, v64, v56
    v_sub_f32 v47, v27, v24
    v_sub_f32 v56, v75, v52
    v_add_f32 v27, v27, v24
    v_add_f32 v75, v75, v52
    v_sub_f32 v24, v35, v18
    v_sub_f32 v52, v59, v66
    v_add_f32 v35, v35, v18
    v_add_f32 v59, v59, v66
    v_sub_f32 v18, v20, v36
    v_sub_f32 v66, v68, v50
    v_add_f32 v20, v20, v36
    v_add_f32 v68, v68, v50
    v_sub_f32 v36, v39, v17
    v_sub_f32 v50, v51, v65
    v_add_f32 v39, v39, v17
    v_add_f32 v51, v51, v65
    v_sub_f32 v17, v26, v33
    v_sub_f32 v65, v74, v57
    v_add_f32 v26, v26, v33
    v_add_f32 v74, v74, v57
    v_sub_f32 v33, v34, v21
    v_sub_f32 v57, v58, v69
    v_add_f32 v34, v34, v21
    v_add_f32 v58, v58, v69
    v_sub_f32 v21, v25, v43
    v_sub_f32 v69, v73, v79
    v_add_f32 v25, v25, v43
    v_add_f32 v73, v73, v79
    v_lshl_add_u32 v6, v1, 2, v7
    ds_write_b32 v6, v16 offset:0
    ds_write_b32 v6, v48 offset:4096
    ds_write_b32 v6, v32 offset:128
    ds_write_b32 v6, v64 offset:4224
    ds_write_b32 v6, v42 offset:256
    ds_write_b32 v6, v49 offset:4352
    ds_write_b32 v6, v39 offset:384
    ds_write_b32 v6, v51 offset:4480
    ds_write_b32 v6, v41 offset:512
    ds_write_b32 v6, v53 offset:4608
    ds_write_b32 v6, v35 offset:640
    ds_write_b32 v6, v59 offset:4736
    ds_write_b32 v6, v30 offset:768
    ds_write_b32 v6, v54 offset:4864
    ds_write_b32 v6, v34 offset:896
    ds_write_b32 v6, v58 offset:4992
    ds_write_b32 v6, v37 offset:1024
    ds_write_b32 v6, v61 offset:5120
    ds_write_b32 v6, v27 offset:1152
    ds_write_b32 v6, v75 offset:5248
    ds_write_b32 v6, v22 offset:1280
    ds_write_b32 v6, v70 offset:5376
    ds_write_b32 v6, v26 offset:1408
    ds_write_b32 v6, v74 offset:5504
    ds_write_b32 v6, v40 offset:1536
    ds_write_b32 v6, v60 offset:5632
    ds_write_b32 v6, v20 offset:1664
    ds_write_b32 v6, v68 offset:5760
    ds_write_b32 v6, v23 offset:1792
    ds_write_b32 v6, v71 offset:5888
    ds_write_b32 v6, v25 offset:1920
    ds_write_b32 v6, v73 offset:6016
    ds_write_b32 v6, v29 offset:2048
    ds_write_b32 v6, v77 offset:6144
    ds_write_b32 v6, v38 offset:2176
    ds_write_b32 v6, v78 offset:6272
    ds_write_b32 v6, v28 offset:2304
    ds_write_b32 v6, v76 offset:6400
    ds_write_b32 v6, v36 offset:2432
    ds_write_b32 v6, v50 offset:6528
    ds_write_b32 v6, v80 offset:2560
    ds_write_b32 v6, v72 offset:6656
    ds_write_b32 v6, v24 offset:2688
    ds_write_b32 v6, v52 offset:6784
    ds_write_b32 v6, v31 offset:2816
    ds_write_b32 v6, v55 offset:6912
    ds_write_b32 v6, v33 offset:2944
    ds_write_b32 v6, v57 offset:7040
    ds_write_b32 v6, v83 offset:3072
    ds_write_b32 v6, v81 offset:7168
    ds_write_b32 v6, v47 offset:3200
    ds_write_b32 v6, v56 offset:7296
    ds_write_b32 v6, v46 offset:3328
    ds_write_b32 v6, v63 offset:7424
    ds_write_b32 v6, v17 offset:3456
    ds_write_b32 v6, v65 offset:7552
    ds_write_b32 v6, v44 offset:3584
    ds_write_b32 v6, v62 offset:7680
    ds_write_b32 v6, v18 offset:3712
    ds_write_b32 v6, v66 offset:7808
    ds_write_b32 v6, v19 offset:3840
    ds_write_b32 v6, v67 offset:7936
    ds_write_b32 v6, v21 offset:3968
    ds_write_b32 v6, v69 offset:8064
    s_waitcnt lgkmcnt(0)
    s_barrier
    v_and_b32 v6, 127, v0
    v_lshrrev_b32 v7, 7, v0
    v_lshlrev_b32 v8, 5, v6
    v_lshl_add_u32 v8, v7, 12, v8
    v_lshlrev_b32 v5, 4, v6
    v_lshl_add_u32 v5, v7, 12, v5
    v_add_u32 v5, 2048, v5
    s_lshl_b32 s12, s93, 16
    ds_read_b128 v[16:19], v8 offset:0
    ds_read_b128 v[20:23], v8 offset:16
    s_waitcnt lgkmcnt(0)
    v_cvt_pk_bf16_f32 v24, v16, v17
    v_cvt_pk_bf16_f32 v25, v18, v19
    v_cvt_pk_bf16_f32 v26, v20, v21
    v_cvt_pk_bf16_f32 v27, v22, v23
    s_add_u32 s13, s12, 0
    buffer_store_dwordx4 v[24:27], v5, s[4:7], s13 offen
    s_nop 1
    ds_read_b128 v[16:19], v8 offset:8448
    ds_read_b128 v[20:23], v8 offset:8464
    s_waitcnt lgkmcnt(0)
    v_cvt_pk_bf16_f32 v24, v16, v17
    v_cvt_pk_bf16_f32 v25, v18, v19
    v_cvt_pk_bf16_f32 v26, v20, v21
    v_cvt_pk_bf16_f32 v27, v22, v23
    s_add_u32 s13, s12, 8192
    buffer_store_dwordx4 v[24:27], v5, s[4:7], s13 offen
    s_nop 1
    ds_read_b128 v[16:19], v8 offset:16896
    ds_read_b128 v[20:23], v8 offset:16912
    s_waitcnt lgkmcnt(0)
    v_cvt_pk_bf16_f32 v24, v16, v17
    v_cvt_pk_bf16_f32 v25, v18, v19
    v_cvt_pk_bf16_f32 v26, v20, v21
    v_cvt_pk_bf16_f32 v27, v22, v23
    s_add_u32 s13, s12, 16384
    buffer_store_dwordx4 v[24:27], v5, s[4:7], s13 offen
    s_nop 1
    ds_read_b128 v[16:19], v8 offset:25344
    ds_read_b128 v[20:23], v8 offset:25360
    s_waitcnt lgkmcnt(0)
    v_cvt_pk_bf16_f32 v24, v16, v17
    v_cvt_pk_bf16_f32 v25, v18, v19
    v_cvt_pk_bf16_f32 v26, v20, v21
    v_cvt_pk_bf16_f32 v27, v22, v23
    s_add_u32 s13, s12, 24576
    buffer_store_dwordx4 v[24:27], v5, s[4:7], s13 offen
    s_nop 1
    ds_read_b128 v[16:19], v8 offset:33792
    ds_read_b128 v[20:23], v8 offset:33808
    s_waitcnt lgkmcnt(0)
    v_cvt_pk_bf16_f32 v24, v16, v17
    v_cvt_pk_bf16_f32 v25, v18, v19
    v_cvt_pk_bf16_f32 v26, v20, v21
    v_cvt_pk_bf16_f32 v27, v22, v23
    s_add_u32 s13, s12, 32768
    buffer_store_dwordx4 v[24:27], v5, s[4:7], s13 offen
    s_nop 1
    ds_read_b128 v[16:19], v8 offset:42240
    ds_read_b128 v[20:23], v8 offset:42256
    s_waitcnt lgkmcnt(0)
    v_cvt_pk_bf16_f32 v24, v16, v17
    v_cvt_pk_bf16_f32 v25, v18, v19
    v_cvt_pk_bf16_f32 v26, v20, v21
    v_cvt_pk_bf16_f32 v27, v22, v23
    s_add_u32 s13, s12, 40960
    buffer_store_dwordx4 v[24:27], v5, s[4:7], s13 offen
    s_nop 1
    ds_read_b128 v[16:19], v8 offset:50688
    ds_read_b128 v[20:23], v8 offset:50704
    s_waitcnt lgkmcnt(0)
    v_cvt_pk_bf16_f32 v24, v16, v17
    v_cvt_pk_bf16_f32 v25, v18, v19
    v_cvt_pk_bf16_f32 v26, v20, v21
    v_cvt_pk_bf16_f32 v27, v22, v23
    s_add_u32 s13, s12, 49152
    buffer_store_dwordx4 v[24:27], v5, s[4:7], s13 offen
    s_nop 1
    ds_read_b128 v[16:19], v8 offset:59136
    ds_read_b128 v[20:23], v8 offset:59152
    s_waitcnt lgkmcnt(0)
    v_cvt_pk_bf16_f32 v24, v16, v17
    v_cvt_pk_bf16_f32 v25, v18, v19
    v_cvt_pk_bf16_f32 v26, v20, v21
    v_cvt_pk_bf16_f32 v27, v22, v23
    s_add_u32 s13, s12, 57344
    buffer_store_dwordx4 v[24:27], v5, s[4:7], s13 offen
    s_nop 1
    s_add_u32 s93, s93, 64
    s_cmp_lt_u32 s93, 128
    s_cbranch_scc1 mega_kernel_f3l
mega_kernel_exit:
    s_endpgm
mega_kernel_recf:
    s_load_dwordx2 s[20:21], s[0:1], 8
    s_load_dwordx2 s[16:17], s[0:1], 40
    s_load_dwordx2 s[4:5], s[0:1], 16
    s_load_dwordx2 s[8:9], s[0:1], 24
    s_load_dwordx2 s[12:13], s[0:1], 32
    v_lshrrev_b32 v4, 6, v0
    v_and_b32 v1, 63, v0
    v_readfirstlane_b32 s24, v4
    v_lshrrev_b32 v2, 4, v1
    v_and_b32 v3, 15, v1
    v_lshlrev_b32 v17, 4, v1
    s_lshr_b32 s28, s31, 2
    s_lshl_b32 s25, s30, 3
    s_add_u32 s25, s25, s28
    s_and_b32 s26, s31, 3
    s_waitcnt lgkmcnt(0)
    s_mov_b32 s22, 16384
    s_mov_b32 s23, 0x00020000
    s_mov_b32 s18, 8388608
    s_mov_b32 s19, 0x00020000
    s_mov_b32 s6, 8388608
    s_mov_b32 s7, 0x00020000
    s_mov_b32 s10, 8388608
    s_mov_b32 s11, 0x00020000
    s_mov_b32 s14, 8388608
    s_mov_b32 s15, 0x00020000
    s_lshl_b32 s28, s25, 8
    s_lshl_b32 s29, s26, 6
    s_add_u32 s28, s28, s29
    s_lshl_b32 s29, s24, 21
    s_add_u32 s28, s28, s29
    v_lshrrev_b32 v4, 2, v1
    v_and_b32 v5, 3, v1
    v_lshlrev_b32 v40, 13, v4
    v_lshl_add_u32 v40, v5, 4, v40
    v_add_u32 v40, s28, v40
    s_lshl_b32 s28, s30, 21
    s_lshl_b32 s29, s24, 19
    s_add_u32 s28, s28, s29
    s_lshl_b32 s29, s31, 6
    s_add_u32 s28, s28, s29
    v_lshlrev_b32 v41, 11, v4
    v_lshl_add_u32 v41, v5, 4, v41
    v_add_u32 v41, s28, v41
    s_lshl_b32 s47, s24, 15
    s_add_u32 s47, s47, 32768
    s_add_u32 m0, s47, 0
    s_mov_b32 s29, 0
    buffer_load_dwordx4 v40, s[4:7], s29 offen lds
    s_add_u32 m0, s47, 1024
    s_mov_b32 s29, 131072
    buffer_load_dwordx4 v40, s[4:7], s29 offen lds
    s_add_u32 m0, s47, 2048
    s_mov_b32 s29, 262144
    buffer_load_dwordx4 v40, s[4:7], s29 offen lds
    s_add_u32 m0, s47, 3072
    s_mov_b32 s29, 393216
    buffer_load_dwordx4 v40, s[4:7], s29 offen lds
    s_add_u32 m0, s47, 4096
    s_mov_b32 s29, 524288
    buffer_load_dwordx4 v40, s[4:7], s29 offen lds
    s_add_u32 m0, s47, 5120
    s_mov_b32 s29, 655360
    buffer_load_dwordx4 v40, s[4:7], s29 offen lds
    s_add_u32 m0, s47, 6144
    s_mov_b32 s29, 786432
    buffer_load_dwordx4 v40, s[4:7], s29 offen lds
    s_add_u32 m0, s47, 7168
    s_mov_b32 s29, 917504
    buffer_load_dwordx4 v40, s[4:7], s29 offen lds
    s_add_u32 m0, s47, 8192
    s_mov_b32 s29, 1048576
    buffer_load_dwordx4 v40, s[4:7], s29 offen lds
    s_add_u32 m0, s47, 9216
    s_mov_b32 s29, 1179648
    buffer_load_dwordx4 v40, s[4:7], s29 offen lds
    s_add_u32 m0, s47, 10240
    s_mov_b32 s29, 1310720
    buffer_load_dwordx4 v40, s[4:7], s29 offen lds
    s_add_u32 m0, s47, 11264
    s_mov_b32 s29, 1441792
    buffer_load_dwordx4 v40, s[4:7], s29 offen lds
    s_add_u32 m0, s47, 12288
    s_mov_b32 s29, 1572864
    buffer_load_dwordx4 v40, s[4:7], s29 offen lds
    s_add_u32 m0, s47, 13312
    s_mov_b32 s29, 1703936
    buffer_load_dwordx4 v40, s[4:7], s29 offen lds
    s_add_u32 m0, s47, 14336
    s_mov_b32 s29, 1835008
    buffer_load_dwordx4 v40, s[4:7], s29 offen lds
    s_add_u32 m0, s47, 15360
    s_mov_b32 s29, 1966080
    buffer_load_dwordx4 v40, s[4:7], s29 offen lds
    s_add_u32 m0, s47, 16384
    s_mov_b32 s29, 0
    buffer_load_dwordx4 v40, s[8:11], s29 offen lds
    s_add_u32 m0, s47, 17408
    s_mov_b32 s29, 131072
    buffer_load_dwordx4 v40, s[8:11], s29 offen lds
    s_add_u32 m0, s47, 18432
    s_mov_b32 s29, 262144
    buffer_load_dwordx4 v40, s[8:11], s29 offen lds
    s_add_u32 m0, s47, 19456
    s_mov_b32 s29, 393216
    buffer_load_dwordx4 v40, s[8:11], s29 offen lds
    s_add_u32 m0, s47, 20480
    s_mov_b32 s29, 524288
    buffer_load_dwordx4 v40, s[8:11], s29 offen lds
    s_add_u32 m0, s47, 21504
    s_mov_b32 s29, 655360
    buffer_load_dwordx4 v40, s[8:11], s29 offen lds
    s_add_u32 m0, s47, 22528
    s_mov_b32 s29, 786432
    buffer_load_dwordx4 v40, s[8:11], s29 offen lds
    s_add_u32 m0, s47, 23552
    s_mov_b32 s29, 917504
    buffer_load_dwordx4 v40, s[8:11], s29 offen lds
    s_add_u32 m0, s47, 24576
    s_mov_b32 s29, 1048576
    buffer_load_dwordx4 v40, s[8:11], s29 offen lds
    s_add_u32 m0, s47, 25600
    s_mov_b32 s29, 1179648
    buffer_load_dwordx4 v40, s[8:11], s29 offen lds
    s_add_u32 m0, s47, 26624
    s_mov_b32 s29, 1310720
    buffer_load_dwordx4 v40, s[8:11], s29 offen lds
    s_add_u32 m0, s47, 27648
    s_mov_b32 s29, 1441792
    buffer_load_dwordx4 v40, s[8:11], s29 offen lds
    s_add_u32 m0, s47, 28672
    s_mov_b32 s29, 1572864
    buffer_load_dwordx4 v40, s[8:11], s29 offen lds
    s_add_u32 m0, s47, 29696
    s_mov_b32 s29, 1703936
    buffer_load_dwordx4 v40, s[8:11], s29 offen lds
    s_add_u32 m0, s47, 30720
    s_mov_b32 s29, 1835008
    buffer_load_dwordx4 v40, s[8:11], s29 offen lds
    s_add_u32 m0, s47, 31744
    s_mov_b32 s29, 1966080
    buffer_load_dwordx4 v40, s[8:11], s29 offen lds
    s_mov_b32 s40, 0x00ff00ff
    s_mov_b32 s41, 0x00ff00ff
    s_mov_b32 s48, 0xff00ff00
    s_mov_b32 s49, 0xff00ff00
    s_mov_b32 s42, 0
    s_mov_b32 s43, 0x00ff00ff
    s_mov_b32 s32, 0x3e0293ee
    v_mov_b32 v23, 0xff7fffff
    v_mov_b32 v6, 0x4444
    v_mov_b32 v4, 0xeeee
    v_cndmask_b32 v6, v6, v4, s[48:49]
    v_mov_b32 v28, -1
    v_mov_b32 v29, -1
    v_mov_b32 v30, -1
    v_mov_b32 v31, -1
    s_lshl_b32 s28, s24, 12
    v_add_u32 v7, s28, v17
    v_and_b32 v4, 7, v1
    v_lshlrev_b32 v8, 11, v4
    v_lshrrev_b32 v5, 3, v1
    v_lshl_add_u32 v8, v5, 4, v8
    s_lshl_b32 s28, s24, 9
    v_add_u32 v8, s28, v8
    s_lshl_b32 s28, s31, 9
    v_lshlrev_b32 v9, 3, v1
    v_add_u32 v9, s28, v9
    v_and_b32 v4, 7, v3
    v_lshlrev_b32 v11, 7, v2
    v_lshl_add_u32 v11, v4, 4, v11
    v_add_u32 v22, 0, v11
    s_add_u32 s28, s28, 16384
    v_add_u32 v11, s28, v11
    v_and_b32 v5, 1, v2
    v_lshlrev_b32 v10, 7, v5
    v_lshl_add_u32 v10, v4, 4, v10
    v_add_u32 v10, 1024, v10
    s_xor_b32 s37, s31, 1
    s_lshl_b32 s37, s37, 11
    s_add_u32 s37, s37, 32768
    s_xor_b32 s38, s31, 2
    s_lshl_b32 s38, s38, 11
    s_add_u32 s38, s38, 32768
    s_xor_b32 s39, s31, 3
    s_lshl_b32 s39, s39, 11
    s_add_u32 s39, s39, 32768
    s_lshr_b32 s28, s31, 2
    s_xor_b32 s28, s28, s98
    s_and_b32 s28, s28, 1
    s_lshl_b32 s28, s28, 13
    s_lshl_b32 s29, s31, 19
    s_add_u32 s28, s28, s29
    s_lshl_b32 s29, s30, 10
    s_add_u32 s28, s28, s29
    s_add_u32 s28, s28, 150994944
    v_add_u32 v12, s28, v17
    v_xor_b32 v25, 1024, v12
    v_xor_b32 v26, 2048, v12
    v_xor_b32 v27, 3072, v12
    v_and_b32 v4, 1, v2
    v_mul_u32_u24 v14, 576, v4
    v_lshrrev_b32 v5, 1, v2
    v_lshl_add_u32 v5, v5, 4, v3
    v_lshl_add_u32 v14, v5, 2, v14
    s_mul_i32 s28, s24, 1152
    s_add_u32 s28, s28, 13312
    v_add_u32 v18, s28, v14
    s_mul_i32 s28, s24, 2304
    v_add_u32 v14, s28, v14
    v_add_u32 v15, 1152, v14
    v_mul_u32_u24 v16, 144, v3
    v_lshl_add_u32 v16, v2, 5, v16
    v_bfe_u32 v4, v1, 1, 3
    v_mul_u32_u24 v19, 144, v4
    v_lshl_add_u32 v19, v2, 5, v19
    v_and_b32 v4, 1, v1
    v_lshl_add_u32 v19, v4, 4, v19
    v_add_u32 v19, 13312, v19
    s_lshl_b32 s28, s24, 10
    s_add_u32 s28, s28, 9216
    v_add_u32 v20, s28, v17
    v_and_b32 v4, 31, v1
    v_lshlrev_b32 v21, 3, v4
    v_add_u32 v21, 17920, v21
    v_lshrrev_b32 v4, 2, v3
    v_and_b32 v42, 1, v4
    v_lshrrev_b32 v43, 1, v4
    v_lshrrev_b32 v44, 1, v2
    v_and_b32 v45, 1, v2
    v_lshl_add_u32 v46, v44, 4, v42
    v_lshl_add_u32 v46, v45, 2, v46
    v_lshl_add_u32 v46, v43, 3, v46
    v_lshl_add_u32 v47, v44, 3, v42
    v_lshl_add_u32 v47, v45, 4, v47
    v_lshl_add_u32 v47, v43, 2, v47
    v_and_b32 v5, 3, v3
    v_lshlrev_b32 v5, 3, v5
    v_lshl_add_u32 v46, v46, 6, v5
    v_lshl_add_u32 v47, v47, 6, v5
    v_add_u32 v46, s47, v46
    v_add_u32 v47, s47, v47
    s_waitcnt vmcnt(16)
    ds_read_b64_tr_b16 a[0:1], v46 offset:0
    ds_read_b64_tr_b16 a[2:3], v46 offset:128
    ds_read_b64_tr_b16 a[4:5], v46 offset:2048
    ds_read_b64_tr_b16 a[6:7], v46 offset:2176
    ds_read_b64_tr_b16 a[8:9], v46 offset:4096
    ds_read_b64_tr_b16 a[10:11], v46 offset:4224
    ds_read_b64_tr_b16 a[12:13], v46 offset:6144
    ds_read_b64_tr_b16 a[14:15], v46 offset:6272
    s_waitcnt lgkmcnt(0)
    ds_read_b64_tr_b16 a[16:17], v46 offset:8192
    ds_read_b64_tr_b16 a[18:19], v46 offset:8320
    ds_read_b64_tr_b16 a[20:21], v46 offset:10240
    ds_read_b64_tr_b16 a[22:23], v46 offset:10368
    ds_read_b64_tr_b16 a[24:25], v46 offset:12288
    ds_read_b64_tr_b16 a[26:27], v46 offset:12416
    ds_read_b64_tr_b16 a[28:29], v46 offset:14336
    ds_read_b64_tr_b16 a[30:31], v46 offset:14464
    s_waitcnt lgkmcnt(0)
    ds_read_b64_tr_b16 a[32:33], v46 offset:32
    ds_read_b64_tr_b16 a[34:35], v46 offset:160
    ds_read_b64_tr_b16 a[36:37], v46 offset:2080
    ds_read_b64_tr_b16 a[38:39], v46 offset:2208
    ds_read_b64_tr_b16 a[40:41], v46 offset:4128
    ds_read_b64_tr_b16 a[42:43], v46 offset:4256
    ds_read_b64_tr_b16 a[44:45], v46 offset:6176
    ds_read_b64_tr_b16 a[46:47], v46 offset:6304
    s_waitcnt lgkmcnt(0)
    ds_read_b64_tr_b16 a[48:49], v46 offset:8224
    ds_read_b64_tr_b16 a[50:51], v46 offset:8352
    ds_read_b64_tr_b16 a[52:53], v46 offset:10272
    ds_read_b64_tr_b16 a[54:55], v46 offset:10400
    ds_read_b64_tr_b16 a[56:57], v46 offset:12320
    ds_read_b64_tr_b16 a[58:59], v46 offset:12448
    ds_read_b64_tr_b16 a[60:61], v46 offset:14368
    ds_read_b64_tr_b16 a[62:63], v46 offset:14496
    s_waitcnt lgkmcnt(0)
    s_add_u32 m0, s47, 0
    s_mov_b32 s29, 0
    buffer_load_dwordx4 v40, s[12:15], s29 offen lds
    s_add_u32 m0, s47, 1024
    s_mov_b32 s29, 131072
    buffer_load_dwordx4 v40, s[12:15], s29 offen lds
    s_add_u32 m0, s47, 2048
    s_mov_b32 s29, 262144
    buffer_load_dwordx4 v40, s[12:15], s29 offen lds
    s_add_u32 m0, s47, 3072
    s_mov_b32 s29, 393216
    buffer_load_dwordx4 v40, s[12:15], s29 offen lds
    s_add_u32 m0, s47, 4096
    s_mov_b32 s29, 524288
    buffer_load_dwordx4 v40, s[12:15], s29 offen lds
    s_add_u32 m0, s47, 5120
    s_mov_b32 s29, 655360
    buffer_load_dwordx4 v40, s[12:15], s29 offen lds
    s_add_u32 m0, s47, 6144
    s_mov_b32 s29, 786432
    buffer_load_dwordx4 v40, s[12:15], s29 offen lds
    s_add_u32 m0, s47, 7168
    s_mov_b32 s29, 917504
    buffer_load_dwordx4 v40, s[12:15], s29 offen lds
    s_add_u32 m0, s47, 8192
    s_mov_b32 s29, 1048576
    buffer_load_dwordx4 v40, s[12:15], s29 offen lds
    s_add_u32 m0, s47, 9216
    s_mov_b32 s29, 1179648
    buffer_load_dwordx4 v40, s[12:15], s29 offen lds
    s_add_u32 m0, s47, 10240
    s_mov_b32 s29, 1310720
    buffer_load_dwordx4 v40, s[12:15], s29 offen lds
    s_add_u32 m0, s47, 11264
    s_mov_b32 s29, 1441792
    buffer_load_dwordx4 v40, s[12:15], s29 offen lds
    s_add_u32 m0, s47, 12288
    s_mov_b32 s29, 1572864
    buffer_load_dwordx4 v40, s[12:15], s29 offen lds
    s_add_u32 m0, s47, 13312
    s_mov_b32 s29, 1703936
    buffer_load_dwordx4 v40, s[12:15], s29 offen lds
    s_add_u32 m0, s47, 14336
    s_mov_b32 s29, 1835008
    buffer_load_dwordx4 v40, s[12:15], s29 offen lds
    s_add_u32 m0, s47, 15360
    s_mov_b32 s29, 1966080
    buffer_load_dwordx4 v40, s[12:15], s29 offen lds
    s_waitcnt vmcnt(16)
    ds_read_b64_tr_b16 a[64:65], v46 offset:16384
    ds_read_b64_tr_b16 a[66:67], v46 offset:16512
    ds_read_b64_tr_b16 a[68:69], v46 offset:18432
    ds_read_b64_tr_b16 a[70:71], v46 offset:18560
    ds_read_b64_tr_b16 a[72:73], v46 offset:20480
    ds_read_b64_tr_b16 a[74:75], v46 offset:20608
    ds_read_b64_tr_b16 a[76:77], v46 offset:22528
    ds_read_b64_tr_b16 a[78:79], v46 offset:22656
    s_waitcnt lgkmcnt(0)
    ds_read_b64_tr_b16 a[80:81], v46 offset:24576
    ds_read_b64_tr_b16 a[82:83], v46 offset:24704
    ds_read_b64_tr_b16 a[84:85], v46 offset:26624
    ds_read_b64_tr_b16 a[86:87], v46 offset:26752
    ds_read_b64_tr_b16 a[88:89], v46 offset:28672
    ds_read_b64_tr_b16 a[90:91], v46 offset:28800
    ds_read_b64_tr_b16 a[92:93], v46 offset:30720
    ds_read_b64_tr_b16 a[94:95], v46 offset:30848
    s_waitcnt lgkmcnt(0)
    ds_read_b64_tr_b16 a[96:97], v46 offset:16416
    ds_read_b64_tr_b16 a[98:99], v46 offset:16544
    ds_read_b64_tr_b16 a[100:101], v46 offset:18464
    ds_read_b64_tr_b16 a[102:103], v46 offset:18592
    ds_read_b64_tr_b16 a[104:105], v46 offset:20512
    ds_read_b64_tr_b16 a[106:107], v46 offset:20640
    ds_read_b64_tr_b16 a[108:109], v46 offset:22560
    ds_read_b64_tr_b16 a[110:111], v46 offset:22688
    s_waitcnt lgkmcnt(0)
    ds_read_b64_tr_b16 a[112:113], v46 offset:24608
    ds_read_b64_tr_b16 a[114:115], v46 offset:24736
    ds_read_b64_tr_b16 a[116:117], v46 offset:26656
    ds_read_b64_tr_b16 a[118:119], v46 offset:26784
    ds_read_b64_tr_b16 a[120:121], v46 offset:28704
    ds_read_b64_tr_b16 a[122:123], v46 offset:28832
    ds_read_b64_tr_b16 a[124:125], v46 offset:30752
    ds_read_b64_tr_b16 a[126:127], v46 offset:30880
    s_waitcnt lgkmcnt(0)
    s_add_u32 m0, s47, 16384
    s_mov_b32 s29, 0
    buffer_load_dwordx4 v41, s[16:19], s29 offen lds
    s_add_u32 m0, s47, 17408
    s_mov_b32 s29, 32768
    buffer_load_dwordx4 v41, s[16:19], s29 offen lds
    s_add_u32 m0, s47, 18432
    s_mov_b32 s29, 65536
    buffer_load_dwordx4 v41, s[16:19], s29 offen lds
    s_add_u32 m0, s47, 19456
    s_mov_b32 s29, 98304
    buffer_load_dwordx4 v41, s[16:19], s29 offen lds
    s_add_u32 m0, s47, 20480
    s_mov_b32 s29, 131072
    buffer_load_dwordx4 v41, s[16:19], s29 offen lds
    s_add_u32 m0, s47, 21504
    s_mov_b32 s29, 163840
    buffer_load_dwordx4 v41, s[16:19], s29 offen lds
    s_add_u32 m0, s47, 22528
    s_mov_b32 s29, 196608
    buffer_load_dwordx4 v41, s[16:19], s29 offen lds
    s_add_u32 m0, s47, 23552
    s_mov_b32 s29, 229376
    buffer_load_dwordx4 v41, s[16:19], s29 offen lds
    s_add_u32 m0, s47, 24576
    s_mov_b32 s29, 262144
    buffer_load_dwordx4 v41, s[16:19], s29 offen lds
    s_add_u32 m0, s47, 25600
    s_mov_b32 s29, 294912
    buffer_load_dwordx4 v41, s[16:19], s29 offen lds
    s_add_u32 m0, s47, 26624
    s_mov_b32 s29, 327680
    buffer_load_dwordx4 v41, s[16:19], s29 offen lds
    s_add_u32 m0, s47, 27648
    s_mov_b32 s29, 360448
    buffer_load_dwordx4 v41, s[16:19], s29 offen lds
    s_add_u32 m0, s47, 28672
    s_mov_b32 s29, 393216
    buffer_load_dwordx4 v41, s[16:19], s29 offen lds
    s_add_u32 m0, s47, 29696
    s_mov_b32 s29, 425984
    buffer_load_dwordx4 v41, s[16:19], s29 offen lds
    s_add_u32 m0, s47, 30720
    s_mov_b32 s29, 458752
    buffer_load_dwordx4 v41, s[16:19], s29 offen lds
    s_add_u32 m0, s47, 31744
    s_mov_b32 s29, 491520
    buffer_load_dwordx4 v41, s[16:19], s29 offen lds
    s_waitcnt vmcnt(16)
    ds_read_b64_tr_b16 a[128:129], v46 offset:0
    ds_read_b64_tr_b16 a[130:131], v46 offset:128
    ds_read_b64_tr_b16 a[132:133], v46 offset:2048
    ds_read_b64_tr_b16 a[134:135], v46 offset:2176
    ds_read_b64_tr_b16 a[136:137], v46 offset:4096
    ds_read_b64_tr_b16 a[138:139], v46 offset:4224
    ds_read_b64_tr_b16 a[140:141], v46 offset:6144
    ds_read_b64_tr_b16 a[142:143], v46 offset:6272
    s_waitcnt lgkmcnt(0)
    ds_read_b64_tr_b16 a[144:145], v46 offset:8192
    ds_read_b64_tr_b16 a[146:147], v46 offset:8320
    ds_read_b64_tr_b16 a[148:149], v46 offset:10240
    ds_read_b64_tr_b16 a[150:151], v46 offset:10368
    ds_read_b64_tr_b16 a[152:153], v46 offset:12288
    ds_read_b64_tr_b16 a[154:155], v46 offset:12416
    ds_read_b64_tr_b16 a[156:157], v46 offset:14336
    ds_read_b64_tr_b16 a[158:159], v46 offset:14464
    s_waitcnt lgkmcnt(0)
    ds_read_b64_tr_b16 a[160:161], v46 offset:32
    ds_read_b64_tr_b16 a[162:163], v46 offset:160
    ds_read_b64_tr_b16 a[164:165], v46 offset:2080
    ds_read_b64_tr_b16 a[166:167], v46 offset:2208
    ds_read_b64_tr_b16 a[168:169], v46 offset:4128
    ds_read_b64_tr_b16 a[170:171], v46 offset:4256
    ds_read_b64_tr_b16 a[172:173], v46 offset:6176
    ds_read_b64_tr_b16 a[174:175], v46 offset:6304
    s_waitcnt lgkmcnt(0)
    ds_read_b64_tr_b16 a[176:177], v46 offset:8224
    ds_read_b64_tr_b16 a[178:179], v46 offset:8352
    ds_read_b64_tr_b16 a[180:181], v46 offset:10272
    ds_read_b64_tr_b16 a[182:183], v46 offset:10400
    ds_read_b64_tr_b16 a[184:185], v46 offset:12320
    ds_read_b64_tr_b16 a[186:187], v46 offset:12448
    ds_read_b64_tr_b16 a[188:189], v46 offset:14368
    ds_read_b64_tr_b16 a[190:191], v46 offset:14496
    s_waitcnt lgkmcnt(0)
    s_waitcnt vmcnt(0)
    ds_read_b64_tr_b16 a[192:193], v47 offset:16384
    ds_read_b64_tr_b16 a[194:195], v47 offset:16512
    ds_read_b64_tr_b16 a[196:197], v47 offset:18432
    ds_read_b64_tr_b16 a[198:199], v47 offset:18560
    ds_read_b64_tr_b16 a[200:201], v47 offset:20480
    ds_read_b64_tr_b16 a[202:203], v47 offset:20608
    ds_read_b64_tr_b16 a[204:205], v47 offset:22528
    ds_read_b64_tr_b16 a[206:207], v47 offset:22656
    s_waitcnt lgkmcnt(0)
    ds_read_b64_tr_b16 a[208:209], v47 offset:24576
    ds_read_b64_tr_b16 a[210:211], v47 offset:24704
    ds_read_b64_tr_b16 a[212:213], v47 offset:26624
    ds_read_b64_tr_b16 a[214:215], v47 offset:26752
    ds_read_b64_tr_b16 a[216:217], v47 offset:28672
    ds_read_b64_tr_b16 a[218:219], v47 offset:28800
    ds_read_b64_tr_b16 a[220:221], v47 offset:30720
    ds_read_b64_tr_b16 a[222:223], v47 offset:30848
    s_waitcnt lgkmcnt(0)
    ds_read_b64_tr_b16 a[224:225], v47 offset:16416
    ds_read_b64_tr_b16 a[226:227], v47 offset:16544
    ds_read_b64_tr_b16 a[228:229], v47 offset:18464
    ds_read_b64_tr_b16 a[230:231], v47 offset:18592
    ds_read_b64_tr_b16 a[232:233], v47 offset:20512
    ds_read_b64_tr_b16 a[234:235], v47 offset:20640
    ds_read_b64_tr_b16 a[236:237], v47 offset:22560
    ds_read_b64_tr_b16 a[238:239], v47 offset:22688
    s_waitcnt lgkmcnt(0)
    ds_read_b64_tr_b16 a[240:241], v47 offset:24608
    ds_read_b64_tr_b16 a[242:243], v47 offset:24736
    ds_read_b64_tr_b16 a[244:245], v47 offset:26656
    ds_read_b64_tr_b16 a[246:247], v47 offset:26784
    ds_read_b64_tr_b16 a[248:249], v47 offset:28704
    ds_read_b64_tr_b16 a[250:251], v47 offset:28832
    ds_read_b64_tr_b16 a[252:253], v47 offset:30752
    ds_read_b64_tr_b16 a[254:255], v47 offset:30880
    s_waitcnt lgkmcnt(0)
    s_lshl_b32 s28, s25, 2
    s_add_u32 s28, s28, s26
    s_mov_b32 s82, s28
    s_lshr_b32 s29, s28, 3
    s_xor_b32 s29, s29, s98
    s_and_b32 s29, s29, 1
    s_lshl_b32 s29, s29, 13
    s_lshl_b32 s76, s28, 18
    s_add_u32 s76, s76, s29
    s_mov_b32 s83, s76
    v_add_u32 v240, s76, v17
    v_add_u32 v241, 33554432, v240
    s_lshr_b32 s29, s28, 4
    s_xor_b32 s29, s29, s98
    s_and_b32 s29, s29, 1
    s_lshl_b32 s29, s29, 13
    s_lshl_b32 s79, s28, 17
    s_add_u32 s79, s79, s29
    s_add_u32 s79, s79, 71303168
    s_xor_b32 s29, s98, 1
    s_lshl_b32 s29, s29, 13
    s_lshl_b32 s28, s25, 7
    s_add_u32 s28, s28, s29
    s_add_u32 s28, s28, 70254592
    v_and_b32 v4, 1, v1
    v_lshlrev_b32 v24, 12, v4
    v_add_u32 v24, s28, v24
    s_lshl_b32 s29, s26, 2
    v_add_u32 v24, s29, v24
    s_lshl_b32 s29, s26, 3
    s_add_u32 s81, s28, s29
    s_lshl_b32 s29, s24, 2
    s_add_u32 s81, s81, s29
    s_add_u32 s81, s81, 16380
    v_mov_b32 v220, 0x3f803f80
    v_mov_b32 v221, 0x3f803f80
    v_mov_b32 v222, 0x3f803f80
    v_mov_b32 v223, 0x3f803f80
    v_mov_b32 v228, 0
    s_mov_b32 s27, 0
    s_mov_b32 s46, 0
    s_mov_b32 s44, 18432
    s_mov_b32 s45, 18432
    s_cmp_eq_u32 s24, 3
    s_cbranch_scc0 mega_kernel_rf_pfi
    s_mov_b32 s76, 0
    s_cmp_gt_i32 s46, s76
    s_cbranch_scc1 mega_kernel_rf_pf0ok
    mega_kernel_rf_pf0w:
    buffer_load_dword v4, v24, s[84:87], 0 offen sc1
    s_waitcnt vmcnt(0)
    v_readlane_b32 s46, v4, 0
    v_readlane_b32 s28, v4, 1
    s_nop 1
    s_min_i32 s46, s46, s28
    s_cmp_gt_i32 s46, s76
    s_cbranch_scc0 mega_kernel_rf_pf0w
    mega_kernel_rf_pf0ok:
    s_add_u32 s77, s76, s82
    s_bfe_u32 s28, s77, 0x40002
    s_lshl_b32 s28, s28, 14
    s_and_b32 s77, s77, 3
    s_lshl_b32 s77, s77, 11
    s_add_u32 s28, s28, s77
    s_add_u32 m0, s45, 0
    s_nop 0
    buffer_load_dwordx4 v240, s[84:87], s28 offen offset:0 sc1 lds
    s_add_u32 m0, s45, 0
    s_nop 0
    buffer_load_dwordx4 v240, s[84:87], s28 offen offset:1024 sc1 lds
    s_add_u32 m0, s45, 2048
    s_nop 0
    buffer_load_dwordx4 v241, s[84:87], s28 offen offset:0 sc1 lds
    s_add_u32 m0, s45, 2048
    s_nop 0
    buffer_load_dwordx4 v241, s[84:87], s28 offen offset:1024 sc1 lds
    s_add_u32 s45, s45, 4096
    s_cmp_eq_u32 s45, 30720
    s_cselect_b32 s45, 18432, s45
    s_mov_b32 s76, 1
    s_cmp_gt_i32 s46, s76
    s_cbranch_scc1 mega_kernel_rf_pf1ok
    mega_kernel_rf_pf1w:
    buffer_load_dword v4, v24, s[84:87], 0 offen sc1
    s_waitcnt vmcnt(0)
    v_readlane_b32 s46, v4, 0
    v_readlane_b32 s28, v4, 1
    s_nop 1
    s_min_i32 s46, s46, s28
    s_cmp_gt_i32 s46, s76
    s_cbranch_scc0 mega_kernel_rf_pf1w
    mega_kernel_rf_pf1ok:
    s_add_u32 s77, s76, s82
    s_bfe_u32 s28, s77, 0x40002
    s_lshl_b32 s28, s28, 14
    s_and_b32 s77, s77, 3
    s_lshl_b32 s77, s77, 11
    s_add_u32 s28, s28, s77
    s_add_u32 m0, s45, 0
    s_nop 0
    buffer_load_dwordx4 v240, s[84:87], s28 offen offset:0 sc1 lds
    s_add_u32 m0, s45, 0
    s_nop 0
    buffer_load_dwordx4 v240, s[84:87], s28 offen offset:1024 sc1 lds
    s_add_u32 m0, s45, 2048
    s_nop 0
    buffer_load_dwordx4 v241, s[84:87], s28 offen offset:0 sc1 lds
    s_add_u32 m0, s45, 2048
    s_nop 0
    buffer_load_dwordx4 v241, s[84:87], s28 offen offset:1024 sc1 lds
    s_add_u32 s45, s45, 4096
    s_cmp_eq_u32 s45, 30720
    s_cselect_b32 s45, 18432, s45
    s_mov_b32 s76, 2
    s_cmp_gt_i32 s46, s76
    s_cbranch_scc1 mega_kernel_rf_pf2ok
    mega_kernel_rf_pf2w:
    buffer_load_dword v4, v24, s[84:87], 0 offen sc1
    s_waitcnt vmcnt(0)
    v_readlane_b32 s46, v4, 0
    v_readlane_b32 s28, v4, 1
    s_nop 1
    s_min_i32 s46, s46, s28
    s_cmp_gt_i32 s46, s76
    s_cbranch_scc0 mega_kernel_rf_pf2w
    mega_kernel_rf_pf2ok:
    s_add_u32 s77, s76, s82
    s_bfe_u32 s28, s77, 0x40002
    s_lshl_b32 s28, s28, 14
    s_and_b32 s77, s77, 3
    s_lshl_b32 s77, s77, 11
    s_add_u32 s28, s28, s77
    s_add_u32 s28, s28, s83
    s_buffer_load_dword s78, s[84:87], s28 offset:0
    s_buffer_load_dword s78, s[84:87], s28 offset:128
    s_buffer_load_dword s78, s[84:87], s28 offset:256
    s_buffer_load_dword s78, s[84:87], s28 offset:384
    s_buffer_load_dword s78, s[84:87], s28 offset:512
    s_buffer_load_dword s78, s[84:87], s28 offset:640
    s_buffer_load_dword s78, s[84:87], s28 offset:768
    s_buffer_load_dword s78, s[84:87], s28 offset:896
    s_buffer_load_dword s78, s[84:87], s28 offset:1024
    s_buffer_load_dword s78, s[84:87], s28 offset:1152
    s_buffer_load_dword s78, s[84:87], s28 offset:1280
    s_buffer_load_dword s78, s[84:87], s28 offset:1408
    s_buffer_load_dword s78, s[84:87], s28 offset:1536
    s_buffer_load_dword s78, s[84:87], s28 offset:1664
    s_buffer_load_dword s78, s[84:87], s28 offset:1792
    s_buffer_load_dword s78, s[84:87], s28 offset:1920
    s_add_u32 s77, s76, s82
    s_bfe_u32 s28, s77, 0x40002
    s_lshl_b32 s28, s28, 14
    s_and_b32 s77, s77, 3
    s_lshl_b32 s77, s77, 11
    s_add_u32 s28, s28, s77
    s_add_u32 s28, s28, s83
    s_add_u32 s28, s28, 33554432
    s_buffer_load_dword s78, s[84:87], s28 offset:0
    s_buffer_load_dword s78, s[84:87], s28 offset:128
    s_buffer_load_dword s78, s[84:87], s28 offset:256
    s_buffer_load_dword s78, s[84:87], s28 offset:384
    s_buffer_load_dword s78, s[84:87], s28 offset:512
    s_buffer_load_dword s78, s[84:87], s28 offset:640
    s_buffer_load_dword s78, s[84:87], s28 offset:768
    s_buffer_load_dword s78, s[84:87], s28 offset:896
    s_buffer_load_dword s78, s[84:87], s28 offset:1024
    s_buffer_load_dword s78, s[84:87], s28 offset:1152
    s_buffer_load_dword s78, s[84:87], s28 offset:1280
    s_buffer_load_dword s78, s[84:87], s28 offset:1408
    s_buffer_load_dword s78, s[84:87], s28 offset:1536
    s_buffer_load_dword s78, s[84:87], s28 offset:1664
    s_buffer_load_dword s78, s[84:87], s28 offset:1792
    s_buffer_load_dword s78, s[84:87], s28 offset:1920
    s_waitcnt vmcnt(0) lgkmcnt(0)
mega_kernel_rf_pfi:
    s_cmp_eq_u32 s24, 2
    s_cbranch_scc0 mega_kernel_rf_xpd
mega_kernel_rf_xpw:
    buffer_load_dword v4, v228, s[72:75], 0 offen offset:224 sc1
    s_waitcnt vmcnt(0)
    v_cmp_ne_u32 vcc, 64, v4
    s_cbranch_vccnz mega_kernel_rf_xpw
mega_kernel_rf_xpd:
    v_mov_b32 v96, 0
    v_mov_b32 v97, 0
    v_mov_b32 v98, 0
    v_mov_b32 v99, 0
    v_mov_b32 v100, 0
    v_mov_b32 v101, 0
    v_mov_b32 v102, 0
    v_mov_b32 v103, 0
    v_mov_b32 v104, 0
    v_mov_b32 v105, 0
    v_mov_b32 v106, 0
    v_mov_b32 v107, 0
    v_mov_b32 v108, 0
    v_mov_b32 v109, 0
    v_mov_b32 v110, 0
    v_mov_b32 v111, 0
    v_mov_b32 v112, 0
    v_mov_b32 v113, 0
    v_mov_b32 v114, 0
    v_mov_b32 v115, 0
    v_mov_b32 v116, 0
    v_mov_b32 v117, 0
    v_mov_b32 v118, 0
    v_mov_b32 v119, 0
    s_barrier
    s_and_b32 s29, s27, 1
    s_lshl_b32 s33, s29, 17
    s_lshl_b32 s28, s30, 18
    s_add_u32 s33, s33, s28
    s_add_u32 s33, s33, 69206016
    s_xor_b32 s34, s33, 131072
    s_add_u32 s28, s27, s31
    s_and_b32 s29, s28, 1
    s_lshl_b32 s35, s29, 12
    s_and_b32 s28, s28, 14
    s_and_b32 s29, s27, 48
    s_or_b32 s28, s28, s29
    s_lshl_b32 s28, s28, 13
    s_add_u32 s35, s35, s28
    s_branch mega_kernel_rf_first
mega_kernel_rf_loop:
    buffer_load_dwordx4 v[32:35], v7, s[84:87], s33 offen offset:0 sc1
    v_add_u32 v5, s44, v17
    ds_read_b128 v[156:159], v5 offset:0
    ds_read_b128 v[160:163], v5 offset:1024
    ds_read_b128 v[164:167], v5 offset:2048
    ds_read_b128 v[168:171], v5 offset:3072
    s_nop 4
    buffer_load_dwordx4 v[36:39], v7, s[84:87], s33 offen offset:1024 sc1
    s_nop 9
    buffer_load_dwordx4 v[40:43], v7, s[84:87], s33 offen offset:2048 sc1
    s_nop 9
    buffer_load_dwordx4 v[44:47], v7, s[84:87], s33 offen offset:3072 sc1
mega_kernel_rf_pa0:
    s_waitcnt vmcnt(3)
    v_max_u32 v4, v32, v34
    v_cmp_eq_u32 vcc, -1, v4
    s_cbranch_vccnz mega_kernel_rf_par0
mega_kernel_rf_pak0:
    v_smfmac_f32_16x16x64_bf16 v[96:99], v[32:35], a[0:7], v6
    v_smfmac_f32_16x16x64_bf16 v[100:103], v[32:35], a[32:39], v6
    v_smfmac_f32_16x16x64_bf16 v[104:107], v[32:35], a[64:71], v6
    v_smfmac_f32_16x16x64_bf16 v[108:111], v[32:35], a[96:103], v6
mega_kernel_rf_pa1:
    s_waitcnt vmcnt(2)
    v_max_u32 v4, v36, v38
    v_cmp_eq_u32 vcc, -1, v4
    s_cbranch_vccnz mega_kernel_rf_par1
mega_kernel_rf_pak1:
    v_smfmac_f32_16x16x64_bf16 v[96:99], v[36:39], a[8:15], v6
    v_smfmac_f32_16x16x64_bf16 v[100:103], v[36:39], a[40:47], v6
    v_smfmac_f32_16x16x64_bf16 v[104:107], v[36:39], a[72:79], v6
    v_smfmac_f32_16x16x64_bf16 v[108:111], v[36:39], a[104:111], v6
mega_kernel_rf_pa2:
    s_waitcnt vmcnt(1)
    v_max_u32 v4, v40, v42
    v_cmp_eq_u32 vcc, -1, v4
    s_cbranch_vccnz mega_kernel_rf_par2
mega_kernel_rf_pak2:
    v_smfmac_f32_16x16x64_bf16 v[96:99], v[40:43], a[16:23], v6
    v_smfmac_f32_16x16x64_bf16 v[100:103], v[40:43], a[48:55], v6
    v_smfmac_f32_16x16x64_bf16 v[104:107], v[40:43], a[80:87], v6
    v_smfmac_f32_16x16x64_bf16 v[108:111], v[40:43], a[112:119], v6
mega_kernel_rf_pa3:
    s_waitcnt vmcnt(0)
    v_max_u32 v4, v44, v46
    v_cmp_eq_u32 vcc, -1, v4
    s_cbranch_vccnz mega_kernel_rf_par3
mega_kernel_rf_pak3:
    v_smfmac_f32_16x16x64_bf16 v[96:99], v[44:47], a[24:31], v6
    v_smfmac_f32_16x16x64_bf16 v[100:103], v[44:47], a[56:63], v6
    v_smfmac_f32_16x16x64_bf16 v[104:107], v[44:47], a[88:95], v6
    v_smfmac_f32_16x16x64_bf16 v[108:111], v[44:47], a[120:127], v6
mega_kernel_rf_adone:
    s_nop 5
    v_permlane32_swap_b32 v96, v100
    v_permlane32_swap_b32 v97, v101
    v_permlane32_swap_b32 v98, v102
    v_permlane32_swap_b32 v99, v103
    v_pk_add_f32 v[96:97], v[96:97], v[100:101]
    v_pk_add_f32 v[98:99], v[98:99], v[102:103]
    ds_write2_b32 v14, v96, v97 offset0:0 offset1:36
    ds_write2_b32 v14, v98, v99 offset0:72 offset1:108
    v_permlane32_swap_b32 v104, v108
    v_permlane32_swap_b32 v105, v109
    v_permlane32_swap_b32 v106, v110
    v_permlane32_swap_b32 v107, v111
    v_pk_add_f32 v[104:105], v[104:105], v[108:109]
    v_pk_add_f32 v[106:107], v[106:107], v[110:111]
    ds_write2_b32 v15, v104, v105 offset0:0 offset1:36
    ds_write2_b32 v15, v106, v107 offset0:72 offset1:108
    v_smfmac_f32_16x16x64_bf16 v[112:115], v[32:35], a[128:135], v6
    v_smfmac_f32_16x16x64_bf16 v[116:119], v[32:35], a[160:167], v6
    v_smfmac_f32_16x16x64_bf16 v[112:115], v[36:39], a[136:143], v6
    v_smfmac_f32_16x16x64_bf16 v[116:119], v[36:39], a[168:175], v6
    s_waitcnt lgkmcnt(0)
    s_barrier
    s_cmp_lg_u32 s24, 0
    s_cbranch_scc1 mega_kernel_rf_side
    ds_read_b128 v[120:123], v16 offset:0
    ds_read_b128 v[124:127], v16 offset:16
    ds_read_b128 v[128:131], v16 offset:2304
    ds_read_b128 v[132:135], v16 offset:2320
    ds_read_b128 v[136:139], v16 offset:4608
    ds_read_b128 v[140:143], v16 offset:4624
    ds_read_b128 v[144:147], v16 offset:6912
    ds_read_b128 v[148:151], v16 offset:6928
    v_smfmac_f32_16x16x64_bf16 v[112:115], v[40:43], a[144:151], v6
    v_smfmac_f32_16x16x64_bf16 v[116:119], v[40:43], a[176:183], v6
    v_smfmac_f32_16x16x64_bf16 v[112:115], v[44:47], a[152:159], v6
    v_smfmac_f32_16x16x64_bf16 v[116:119], v[44:47], a[184:191], v6
    s_lshl_b32 s28, s31, 11
    s_add_u32 s28, s28, s33
    s_add_u32 s28, s28, 32768
    s_add_u32 s76, s37, s33
    s_add_u32 s77, s38, s33
    s_add_u32 s78, s39, s33
    s_waitcnt lgkmcnt(4)
    v_pk_add_f32 v[120:121], v[120:121], v[128:129]
    v_pk_add_f32 v[122:123], v[122:123], v[130:131]
    v_pk_add_f32 v[124:125], v[124:125], v[132:133]
    v_pk_add_f32 v[126:127], v[126:127], v[134:135]
    s_waitcnt lgkmcnt(0)
    v_pk_add_f32 v[136:137], v[136:137], v[144:145]
    v_pk_add_f32 v[138:139], v[138:139], v[146:147]
    v_pk_add_f32 v[140:141], v[140:141], v[148:149]
    v_pk_add_f32 v[142:143], v[142:143], v[150:151]
    v_pk_add_f32 v[120:121], v[120:121], v[136:137]
    v_pk_add_f32 v[122:123], v[122:123], v[138:139]
    v_pk_add_f32 v[124:125], v[124:125], v[140:141]
    v_pk_add_f32 v[126:127], v[126:127], v[142:143]
    v_cvt_pk_bf16_f32 v152, v120, v121
    v_cvt_pk_bf16_f32 v153, v122, v123
    v_cvt_pk_bf16_f32 v154, v124, v125
    v_cvt_pk_bf16_f32 v155, v126, v127
    s_nop 1
    v_mfma_f32_16x16x32_bf16 v[176:179], v[160:163], v[152:155], 0
    v_mfma_f32_16x16x32_bf16 v[172:175], v[156:159], v[152:155], 0
    v_mfma_f32_16x16x32_bf16 v[180:183], v[152:155], v[152:155], 0
    s_cmp_eq_u32 s27, 63
    s_cbranch_scc1 mega_kernel_rf_w0last
    s_nop 4
    v_mov_b32_dpp v172, v176 row_shr:8 row_mask:0xf bank_mask:0xc
    v_mov_b32_dpp v173, v177 row_shr:8 row_mask:0xf bank_mask:0xc
    v_mov_b32_dpp v174, v178 row_shr:8 row_mask:0xf bank_mask:0xc
    v_mov_b32_dpp v175, v179 row_shr:8 row_mask:0xf bank_mask:0xc
    v_min_u32 v180, -2, v180
    v_min_u32 v172, -2, v172
    s_mov_b64 exec, s[42:43]
    buffer_store_dwordx4 v[180:183], v10, s[84:87], s28 offen
    s_mov_b64 exec, -1
    buffer_store_dwordx4 v[172:175], v17, s[84:87], s28 offen
    v_permlane32_swap_b32 v112, v116
    v_permlane32_swap_b32 v113, v117
    v_permlane32_swap_b32 v114, v118
    v_permlane32_swap_b32 v115, v119
    v_pk_add_f32 v[112:113], v[112:113], v[116:117]
    v_pk_add_f32 v[114:115], v[114:115], v[118:119]
    ds_write_b128 v20, v[112:115]
    buffer_load_dwordx4 v[184:187], v17, s[84:87], s76 offen sc1
    buffer_load_dwordx4 v[188:191], v10, s[84:87], s76 offen sc1
    buffer_load_dwordx4 v[192:195], v17, s[84:87], s77 offen sc1
    buffer_load_dwordx4 v[196:199], v10, s[84:87], s77 offen sc1
    buffer_load_dwordx4 v[200:203], v17, s[84:87], s78 offen sc1
    buffer_load_dwordx4 v[204:207], v10, s[84:87], s78 offen sc1
    v_mov_b32 v96, 0
    v_mov_b32 v97, 0
    v_mov_b32 v98, 0
    v_mov_b32 v99, 0
    v_mov_b32 v100, 0
    v_mov_b32 v101, 0
    v_mov_b32 v102, 0
    v_mov_b32 v103, 0
    s_waitcnt lgkmcnt(0)
    s_barrier
    s_nop 7
    buffer_load_dwordx4 v[184:187], v17, s[84:87], s76 offen sc1
    buffer_load_dwordx4 v[188:191], v10, s[84:87], s76 offen sc1
    buffer_load_dwordx4 v[192:195], v17, s[84:87], s77 offen sc1
    buffer_load_dwordx4 v[196:199], v10, s[84:87], s77 offen sc1
    buffer_load_dwordx4 v[200:203], v17, s[84:87], s78 offen sc1
    buffer_load_dwordx4 v[204:207], v10, s[84:87], s78 offen sc1
mega_kernel_rf_p2:
    s_waitcnt vmcnt(6)
    v_max3_u32 v4, v184, v188, v192
    v_max3_u32 v5, v196, v200, v204
    v_max_u32 v4, v4, v5
    v_cmp_eq_u32 vcc, -1, v4
    s_cbranch_vccnz mega_kernel_rf_p2r
    v_pk_add_f32 v[180:181], v[180:181], v[188:189]
    v_pk_add_f32 v[124:125], v[196:197], v[204:205]
    v_pk_add_f32 v[182:183], v[182:183], v[190:191]
    v_pk_add_f32 v[126:127], v[198:199], v[206:207]
    v_pk_add_f32 v[172:173], v[172:173], v[184:185]
    v_pk_add_f32 v[120:121], v[192:193], v[200:201]
    v_pk_add_f32 v[174:175], v[174:175], v[186:187]
    v_pk_add_f32 v[122:123], v[194:195], v[202:203]
    v_pk_add_f32 v[180:181], v[180:181], v[124:125]
    v_pk_add_f32 v[182:183], v[182:183], v[126:127]
    v_pk_add_f32 v[172:173], v[172:173], v[120:121]
    v_pk_add_f32 v[174:175], v[174:175], v[122:123]
    v_cndmask_b32 v176, v23, v180, s[42:43]
    v_cndmask_b32 v177, v23, v181, s[42:43]
    v_cndmask_b32 v178, v23, v182, s[42:43]
    v_cndmask_b32 v179, v23, v183, s[42:43]
    v_max3_f32 v232, v172, v173, v174
    v_max3_f32 v233, v176, v177, v178
    v_max3_f32 v232, v232, v175, v179
    v_max_f32 v234, v232, v233
    s_barrier
    ds_read2_b64 v[208:211], v21 offset0:0 offset1:32
    v_max_f32_dpp v232, v234, v234 row_ror:8 row_mask:0xf bank_mask:0xf
    v_max_f32_dpp v233, v234, v234 row_ror:8 row_mask:0xf bank_mask:0xf
    s_nop 1
    v_permlane16_swap_b32 v232, v233
    s_nop 0
    v_max_f32 v234, v232, v233
    v_max_f32 v235, v232, v233
    s_nop 1
    v_permlane32_swap_b32 v234, v235
    s_nop 0
    v_max_f32 v232, v234, v235
    v_mul_f32 v232, s32, v232
    v_fma_f32 v176, v176, s32, -v232
    v_fma_f32 v177, v177, s32, -v232
    v_fma_f32 v178, v178, s32, -v232
    v_fma_f32 v179, v179, s32, -v232
    v_fma_f32 v172, v172, s32, -v232
    v_fma_f32 v173, v173, s32, -v232
    v_fma_f32 v174, v174, s32, -v232
    v_fma_f32 v175, v175, s32, -v232
    v_exp_f32 v176, v176
    v_exp_f32 v177, v177
    v_exp_f32 v178, v178
    v_exp_f32 v179, v179
    v_exp_f32 v172, v172
    v_cvt_pk_bf16_f32 v216, v176, v177
    v_cvt_pk_bf16_f32 v217, v178, v179
    v_exp_f32 v173, v173
    v_exp_f32 v174, v174
    v_mfma_f32_16x16x16_bf16 v[224:227], v[220:221], v[216:217], 0
    v_exp_f32 v175, v175
    v_cvt_pk_bf16_f32 v212, v172, v173
    s_waitcnt lgkmcnt(0)
    v_mfma_f32_16x16x16_bf16 v[120:123], v[208:209], v[216:217], 0
    v_cvt_pk_bf16_f32 v213, v174, v175
    v_mfma_f32_16x16x16_bf16 v[124:127], v[210:211], v[216:217], 0
    v_mov_b32_dpp v214, v212 row_ror:8 row_mask:0xf bank_mask:0xf
    v_mov_b32_dpp v215, v213 row_ror:8 row_mask:0xf bank_mask:0xf
    s_nop 1
    v_mfma_f32_16x16x32_bf16 v[224:227], v[220:223], v[212:215], v[224:227]
    v_mfma_f32_16x16x32_bf16 v[120:123], v[164:167], v[212:215], v[120:123]
    v_mfma_f32_16x16x32_bf16 v[124:127], v[168:171], v[212:215], v[124:127]
    s_add_u32 s29, s33, 16384
    s_nop 4
    v_rcp_f32 v234, v224
    v_rcp_f32 v235, v225
    s_nop 0
    v_pk_mul_f32 v[120:121], v[120:121], v[234:235]
    v_pk_mul_f32 v[122:123], v[122:123], v[234:235]
    v_pk_mul_f32 v[124:125], v[124:125], v[234:235]
    v_pk_mul_f32 v[126:127], v[126:127], v[234:235]
    v_cvt_pk_bf16_f32 v212, v120, v121
    v_cvt_pk_bf16_f32 v213, v122, v123
    v_cvt_pk_bf16_f32 v214, v124, v125
    v_cvt_pk_bf16_f32 v215, v126, v127
    v_min_u32 v212, -2, v212
    s_mov_b64 exec, s[40:41]
    buffer_store_dwordx4 v[212:215], v11, s[84:87], s33 offen
    s_mov_b64 exec, -1
mega_kernel_rf_b3:
    s_barrier
    buffer_load_dwordx4 v[32:35], v7, s[84:87], s29 offen offset:0 sc1
    s_nop 9
    buffer_load_dwordx4 v[36:39], v7, s[84:87], s29 offen offset:1024 sc1
    s_nop 9
    buffer_load_dwordx4 v[40:43], v7, s[84:87], s29 offen offset:2048 sc1
    s_nop 9
    buffer_load_dwordx4 v[44:47], v7, s[84:87], s29 offen offset:3072 sc1
mega_kernel_rf_pc0:
    s_waitcnt vmcnt(3)
    v_cmp_eq_u32 vcc, -1, v32
    s_cbranch_vccnz mega_kernel_rf_pcr0
mega_kernel_rf_pck0:
    v_smfmac_f32_16x16x64_bf16 v[96:99], v[32:35], a[192:199], v6
    v_smfmac_f32_16x16x64_bf16 v[100:103], v[32:35], a[224:231], v6
mega_kernel_rf_pc1:
    s_waitcnt vmcnt(2)
    v_cmp_eq_u32 vcc, -1, v36
    s_cbranch_vccnz mega_kernel_rf_pcr1
mega_kernel_rf_pck1:
    v_smfmac_f32_16x16x64_bf16 v[96:99], v[36:39], a[200:207], v6
    v_smfmac_f32_16x16x64_bf16 v[100:103], v[36:39], a[232:239], v6
mega_kernel_rf_pc2:
    s_waitcnt vmcnt(1)
    v_cmp_eq_u32 vcc, -1, v40
    s_cbranch_vccnz mega_kernel_rf_pcr2
mega_kernel_rf_pck2:
    v_smfmac_f32_16x16x64_bf16 v[96:99], v[40:43], a[208:215], v6
    v_smfmac_f32_16x16x64_bf16 v[100:103], v[40:43], a[240:247], v6
mega_kernel_rf_pc3:
    s_waitcnt vmcnt(0)
    v_cmp_eq_u32 vcc, -1, v44
    s_cbranch_vccnz mega_kernel_rf_pcr3
mega_kernel_rf_pck3:
    v_smfmac_f32_16x16x64_bf16 v[96:99], v[44:47], a[216:223], v6
    v_smfmac_f32_16x16x64_bf16 v[100:103], v[44:47], a[248:255], v6
    s_nop 7
    v_permlane32_swap_b32 v96, v100
    v_permlane32_swap_b32 v97, v101
    v_permlane32_swap_b32 v98, v102
    v_permlane32_swap_b32 v99, v103
    v_pk_add_f32 v[96:97], v[96:97], v[100:101]
    v_pk_add_f32 v[98:99], v[98:99], v[102:103]
    ds_write2_b32 v18, v96, v97 offset0:0 offset1:36
    ds_write2_b32 v18, v98, v99 offset0:72 offset1:108
    s_waitcnt lgkmcnt(0)
    s_barrier
    s_cmp_lg_u32 s24, 0
    s_cbranch_scc1 mega_kernel_rf_x1
    ds_read_b128 v[120:123], v19 offset:0
    ds_read_b128 v[124:127], v19 offset:1152
    ds_read_b128 v[128:131], v19 offset:2304
    ds_read_b128 v[132:135], v19 offset:3456
    v_mov_b32 v96, 0
    v_mov_b32 v97, 0
    v_mov_b32 v98, 0
    v_mov_b32 v99, 0
    v_mov_b32 v100, 0
    v_mov_b32 v101, 0
    v_mov_b32 v102, 0
    v_mov_b32 v103, 0
    v_mov_b32 v104, 0
    v_mov_b32 v105, 0
    v_mov_b32 v106, 0
    v_mov_b32 v107, 0
    v_mov_b32 v108, 0
    v_mov_b32 v109, 0
    v_mov_b32 v110, 0
    v_mov_b32 v111, 0
    v_mov_b32 v112, 0
    v_mov_b32 v113, 0
    v_mov_b32 v114, 0
    v_mov_b32 v115, 0
    v_mov_b32 v116, 0
    v_mov_b32 v117, 0
    v_mov_b32 v118, 0
    v_mov_b32 v119, 0
    s_waitcnt lgkmcnt(2)
    v_pk_add_f32 v[120:121], v[120:121], v[124:125]
    v_pk_add_f32 v[122:123], v[122:123], v[126:127]
    s_waitcnt lgkmcnt(0)
    v_pk_add_f32 v[128:129], v[128:129], v[132:133]
    v_pk_add_f32 v[130:131], v[130:131], v[134:135]
    v_pk_add_f32 v[120:121], v[120:121], v[128:129]
    v_pk_add_f32 v[122:123], v[122:123], v[130:131]
    v_min_u32 v120, -2, v120
    v_min_u32 v121, -2, v121
    v_min_u32 v122, -2, v122
    v_min_u32 v123, -2, v123
    buffer_store_dwordx4 v[120:123], v12, s[84:87], s35 offen sc1
    v_mov_b32 v48, -1
    v_mov_b32 v49, -1
    v_mov_b32 v50, -1
    v_mov_b32 v51, -1
    v_mov_b32 v52, -1
    v_mov_b32 v53, -1
    v_mov_b32 v54, -1
    v_mov_b32 v55, -1
    v_mov_b32 v56, -1
    v_mov_b32 v57, -1
    v_mov_b32 v58, -1
    v_mov_b32 v59, -1
    s_nop 15
    s_nop 7
mega_kernel_rf_p4:
    buffer_load_dwordx4 v[48:51], v25, s[84:87], s35 offen sc1
    buffer_load_dwordx4 v[52:55], v26, s[84:87], s35 offen sc1
    buffer_load_dwordx4 v[56:59], v27, s[84:87], s35 offen sc1
    s_waitcnt vmcnt(36)
    s_nop 1
    v_max3_u32 v4, v48, v49, v50
    v_max3_u32 v5, v54, v55, v56
    v_max3_u32 v4, v4, v51, v52
    v_max3_u32 v5, v5, v57, v58
    v_max_u32 v4, v4, v53
    v_max_u32 v5, v5, v59
    v_max_u32 v4, v4, v5
    v_cmp_eq_u32 vcc, -1, v4
    s_cbranch_vccz mega_kernel_rf_p4d
    s_branch mega_kernel_rf_p4
mega_kernel_rf_p4d:
    v_pk_add_f32 v[120:121], v[120:121], v[48:49]
    v_pk_add_f32 v[124:125], v[52:53], v[56:57]
    v_pk_add_f32 v[122:123], v[122:123], v[50:51]
    v_pk_add_f32 v[126:127], v[54:55], v[58:59]
    v_pk_add_f32 v[120:121], v[120:121], v[124:125]
    v_pk_add_f32 v[122:123], v[122:123], v[126:127]
    v_cvt_pk_bf16_f32 v212, v120, v121
    v_cvt_pk_bf16_f32 v213, v122, v123
    v_min_u32 v212, -2, v212
    buffer_store_dwordx2 v[212:213], v9, s[84:87], s34 offen
mega_kernel_rf_b5:
    s_add_u32 s27, s27, 1
    s_add_u32 s44, s44, 4096
    s_cmp_eq_u32 s44, 30720
    s_cselect_b32 s44, 18432, s44
    s_barrier
    s_and_b32 s29, s27, 1
    s_lshl_b32 s33, s29, 17
    s_lshl_b32 s28, s30, 18
    s_add_u32 s33, s33, s28
    s_add_u32 s33, s33, 69206016
    s_xor_b32 s34, s33, 131072
    s_add_u32 s28, s27, s31
    s_and_b32 s29, s28, 1
    s_lshl_b32 s35, s29, 12
    s_and_b32 s28, s28, 14
    s_and_b32 s29, s27, 48
    s_or_b32 s28, s28, s29
    s_lshl_b32 s28, s28, 13
    s_add_u32 s35, s35, s28
    s_branch mega_kernel_rf_loop
mega_kernel_rf_x1:
    s_cmp_eq_u32 s24, 3
    s_cbranch_scc0 mega_kernel_rf_x4
    buffer_store_dwordx2 v[28:29], v9, s[84:87], s33 offen
    s_lshl_b32 s28, s31, 11
    s_add_u32 s28, s28, s33
    s_add_u32 s28, s28, 32768
    buffer_store_dwordx4 v[28:31], v17, s[84:87], s28 offen
    buffer_store_dwordx4 v[28:31], v10, s[84:87], s28 offen
    s_add_u32 s76, s27, 3
    s_cmp_lt_u32 s76, 63
    s_cbranch_scc0 mega_kernel_rf_x4
    s_add_u32 s77, s76, s82
    s_bfe_u32 s28, s77, 0x40002
    s_lshl_b32 s28, s28, 14
    s_and_b32 s77, s77, 3
    s_lshl_b32 s77, s77, 11
    s_add_u32 s28, s28, s77
    s_add_u32 s28, s28, s83
    s_add_u32 s28, s28, 33554432
    s_buffer_load_dword s78, s[84:87], s28 offset:0
    s_buffer_load_dword s78, s[84:87], s28 offset:128
    s_buffer_load_dword s78, s[84:87], s28 offset:256
    s_buffer_load_dword s78, s[84:87], s28 offset:384
    s_buffer_load_dword s78, s[84:87], s28 offset:512
    s_buffer_load_dword s78, s[84:87], s28 offset:640
    s_buffer_load_dword s78, s[84:87], s28 offset:768
    s_buffer_load_dword s78, s[84:87], s28 offset:896
    s_buffer_load_dword s78, s[84:87], s28 offset:1024
    s_buffer_load_dword s78, s[84:87], s28 offset:1152
    s_buffer_load_dword s78, s[84:87], s28 offset:1280
    s_buffer_load_dword s78, s[84:87], s28 offset:1408
    s_buffer_load_dword s78, s[84:87], s28 offset:1536
    s_buffer_load_dword s78, s[84:87], s28 offset:1664
    s_buffer_load_dword s78, s[84:87], s28 offset:1792
    s_buffer_load_dword s78, s[84:87], s28 offset:1920
mega_kernel_rf_x4:
    v_mov_b32 v96, 0
    v_mov_b32 v97, 0
    v_mov_b32 v98, 0
    v_mov_b32 v99, 0
    v_mov_b32 v100, 0
    v_mov_b32 v101, 0
    v_mov_b32 v102, 0
    v_mov_b32 v103, 0
    v_mov_b32 v104, 0
    v_mov_b32 v105, 0
    v_mov_b32 v106, 0
    v_mov_b32 v107, 0
    v_mov_b32 v108, 0
    v_mov_b32 v109, 0
    v_mov_b32 v110, 0
    v_mov_b32 v111, 0
    v_mov_b32 v112, 0
    v_mov_b32 v113, 0
    v_mov_b32 v114, 0
    v_mov_b32 v115, 0
    v_mov_b32 v116, 0
    v_mov_b32 v117, 0
    v_mov_b32 v118, 0
    v_mov_b32 v119, 0
    s_branch mega_kernel_rf_b5
mega_kernel_rf_p2r:
    buffer_load_dwordx4 v[184:187], v17, s[84:87], s76 offen sc1
    buffer_load_dwordx4 v[188:191], v10, s[84:87], s76 offen sc1
    buffer_load_dwordx4 v[192:195], v17, s[84:87], s77 offen sc1
    buffer_load_dwordx4 v[196:199], v10, s[84:87], s77 offen sc1
    buffer_load_dwordx4 v[200:203], v17, s[84:87], s78 offen sc1
    buffer_load_dwordx4 v[204:207], v10, s[84:87], s78 offen sc1
    s_branch mega_kernel_rf_p2
mega_kernel_rf_par0:
    buffer_load_dwordx4 v[32:35], v7, s[84:87], s33 offen offset:0 sc1
    buffer_load_dwordx4 v[36:39], v7, s[84:87], s33 offen offset:1024 sc1
    buffer_load_dwordx4 v[40:43], v7, s[84:87], s33 offen offset:2048 sc1
    buffer_load_dwordx4 v[44:47], v7, s[84:87], s33 offen offset:3072 sc1
    s_branch mega_kernel_rf_pa0
mega_kernel_rf_par1:
    buffer_load_dwordx4 v[36:39], v7, s[84:87], s33 offen offset:1024 sc1
    buffer_load_dwordx4 v[40:43], v7, s[84:87], s33 offen offset:2048 sc1
    buffer_load_dwordx4 v[44:47], v7, s[84:87], s33 offen offset:3072 sc1
    s_branch mega_kernel_rf_pa1
mega_kernel_rf_par2:
    buffer_load_dwordx4 v[40:43], v7, s[84:87], s33 offen offset:2048 sc1
    buffer_load_dwordx4 v[44:47], v7, s[84:87], s33 offen offset:3072 sc1
    s_branch mega_kernel_rf_pa2
mega_kernel_rf_par3:
    buffer_load_dwordx4 v[44:47], v7, s[84:87], s33 offen offset:3072 sc1
    s_branch mega_kernel_rf_pa3
mega_kernel_rf_pcr0:
    buffer_load_dwordx4 v[32:35], v7, s[84:87], s29 offen offset:0 sc1
    buffer_load_dwordx4 v[36:39], v7, s[84:87], s29 offen offset:1024 sc1
    buffer_load_dwordx4 v[40:43], v7, s[84:87], s29 offen offset:2048 sc1
    buffer_load_dwordx4 v[44:47], v7, s[84:87], s29 offen offset:3072 sc1
    s_branch mega_kernel_rf_pc0
mega_kernel_rf_pcr1:
    buffer_load_dwordx4 v[36:39], v7, s[84:87], s29 offen offset:1024 sc1
    buffer_load_dwordx4 v[40:43], v7, s[84:87], s29 offen offset:2048 sc1
    buffer_load_dwordx4 v[44:47], v7, s[84:87], s29 offen offset:3072 sc1
    s_branch mega_kernel_rf_pc1
mega_kernel_rf_pcr2:
    buffer_load_dwordx4 v[40:43], v7, s[84:87], s29 offen offset:2048 sc1
    buffer_load_dwordx4 v[44:47], v7, s[84:87], s29 offen offset:3072 sc1
    s_branch mega_kernel_rf_pc2
mega_kernel_rf_pcr3:
    buffer_load_dwordx4 v[44:47], v7, s[84:87], s29 offen offset:3072 sc1
    s_branch mega_kernel_rf_pc3
mega_kernel_rf_w0last:
    s_nop 7
    v_permlane32_swap_b32 v112, v116
    v_permlane32_swap_b32 v113, v117
    v_permlane32_swap_b32 v114, v118
    v_permlane32_swap_b32 v115, v119
    v_pk_add_f32 v[112:113], v[112:113], v[116:117]
    v_pk_add_f32 v[114:115], v[114:115], v[118:119]
    ds_write_b128 v20, v[112:115]
    s_waitcnt lgkmcnt(0)
    s_barrier
    s_branch mega_kernel_rf_end
mega_kernel_rf_side:
    s_cmp_eq_u32 s24, 3
    s_cbranch_scc1 mega_kernel_rf_sd3
    s_cmp_eq_u32 s24, 2
    s_cbranch_scc0 mega_kernel_rf_sd4
    s_mov_b64 exec, s[40:41]
    buffer_store_dwordx4 v[28:31], v11, s[84:87], s34 offen
    s_mov_b64 exec, -1
    s_branch mega_kernel_rf_sd4
    mega_kernel_rf_sd3:
    s_add_u32 s76, s27, 2
    s_cmp_lt_u32 s76, 63
    s_cbranch_scc0 mega_kernel_rf_sd4
    s_add_u32 s77, s76, s82
    s_bfe_u32 s28, s77, 0x40002
    s_lshl_b32 s28, s28, 14
    s_and_b32 s77, s77, 3
    s_lshl_b32 s77, s77, 11
    s_add_u32 s28, s28, s77
    s_add_u32 m0, s45, 0
    s_nop 0
    buffer_load_dwordx4 v240, s[84:87], s28 offen offset:0 sc1 lds
    s_add_u32 m0, s45, 0
    s_nop 0
    buffer_load_dwordx4 v240, s[84:87], s28 offen offset:1024 sc1 lds
    s_add_u32 m0, s45, 2048
    s_nop 0
    buffer_load_dwordx4 v241, s[84:87], s28 offen offset:0 sc1 lds
    s_add_u32 m0, s45, 2048
    s_nop 0
    buffer_load_dwordx4 v241, s[84:87], s28 offen offset:1024 sc1 lds
    s_add_u32 s45, s45, 4096
    s_cmp_eq_u32 s45, 30720
    s_cselect_b32 s45, 18432, s45
mega_kernel_rf_sd4:
    v_smfmac_f32_16x16x64_bf16 v[112:115], v[40:43], a[144:151], v6
    v_smfmac_f32_16x16x64_bf16 v[116:119], v[40:43], a[176:183], v6
    v_smfmac_f32_16x16x64_bf16 v[112:115], v[44:47], a[152:159], v6
    v_smfmac_f32_16x16x64_bf16 v[116:119], v[44:47], a[184:191], v6
    s_nop 7
    v_permlane32_swap_b32 v112, v116
    v_permlane32_swap_b32 v113, v117
    v_permlane32_swap_b32 v114, v118
    v_permlane32_swap_b32 v115, v119
    v_pk_add_f32 v[112:113], v[112:113], v[116:117]
    v_pk_add_f32 v[114:115], v[114:115], v[118:119]
    ds_write_b128 v20, v[112:115]
    v_mov_b32 v96, 0
    v_mov_b32 v97, 0
    v_mov_b32 v98, 0
    v_mov_b32 v99, 0
    v_mov_b32 v100, 0
    v_mov_b32 v101, 0
    v_mov_b32 v102, 0
    v_mov_b32 v103, 0
    s_cmp_eq_u32 s24, 1
    s_cbranch_scc0 mega_kernel_rf_s1
    s_waitcnt lgkmcnt(0)
    ds_read_b128 v[120:123], v16 offset:0
    ds_read_b128 v[124:127], v16 offset:16
    ds_read_b128 v[128:131], v16 offset:2304
    ds_read_b128 v[132:135], v16 offset:2320
    ds_read_b128 v[136:139], v16 offset:4608
    ds_read_b128 v[140:143], v16 offset:4624
    ds_read_b128 v[144:147], v16 offset:6912
    ds_read_b128 v[148:151], v16 offset:6928
    s_waitcnt lgkmcnt(4)
    v_pk_add_f32 v[120:121], v[120:121], v[128:129]
    v_pk_add_f32 v[122:123], v[122:123], v[130:131]
    v_pk_add_f32 v[124:125], v[124:125], v[132:133]
    v_pk_add_f32 v[126:127], v[126:127], v[134:135]
    s_waitcnt lgkmcnt(0)
    v_pk_add_f32 v[136:137], v[136:137], v[144:145]
    v_pk_add_f32 v[138:139], v[138:139], v[146:147]
    v_pk_add_f32 v[140:141], v[140:141], v[148:149]
    v_pk_add_f32 v[142:143], v[142:143], v[150:151]
    v_pk_add_f32 v[120:121], v[120:121], v[136:137]
    v_pk_add_f32 v[122:123], v[122:123], v[138:139]
    v_pk_add_f32 v[124:125], v[124:125], v[140:141]
    v_pk_add_f32 v[126:127], v[126:127], v[142:143]
    v_cvt_pk_bf16_f32 v244, v120, v121
    v_cvt_pk_bf16_f32 v245, v122, v123
    v_cvt_pk_bf16_f32 v246, v124, v125
    v_cvt_pk_bf16_f32 v247, v126, v127
mega_kernel_rf_s1:
    v_add_u32 v5, 9216, v17
    s_waitcnt lgkmcnt(0)
    s_barrier
    s_cmp_eq_u32 s24, 2
    s_cbranch_scc0 mega_kernel_rf_s3
    ds_read_b128 v[120:123], v5 offset:0
    ds_read_b128 v[124:127], v5 offset:1024
    ds_read_b128 v[128:131], v5 offset:2048
    ds_read_b128 v[132:135], v5 offset:3072
    v_lshrrev_b32 v5, 1, v17
    s_waitcnt lgkmcnt(2)
    v_pk_add_f32 v[120:121], v[120:121], v[124:125]
    v_pk_add_f32 v[122:123], v[122:123], v[126:127]
    s_waitcnt lgkmcnt(0)
    v_pk_add_f32 v[128:129], v[128:129], v[132:133]
    v_pk_add_f32 v[130:131], v[130:131], v[134:135]
    v_pk_add_f32 v[120:121], v[120:121], v[128:129]
    v_pk_add_f32 v[122:123], v[122:123], v[130:131]
    v_cvt_pk_bf16_f32 v244, v120, v121
    v_cvt_pk_bf16_f32 v245, v122, v123
    ds_write_b64 v5, v[244:245] offset:17920
    s_waitcnt lgkmcnt(0)
mega_kernel_rf_s3:
    s_cmp_eq_u32 s27, 63
    s_cbranch_scc1 mega_kernel_rf_slast
    s_add_u32 s29, s33, 16384
    s_barrier
    s_cmp_eq_u32 s24, 3
    s_cbranch_scc1 mega_kernel_rf_y3
    s_add_u32 s77, s27, s82
    s_bfe_u32 s28, s77, 0x30003
    s_lshl_b32 s28, s28, 14
    s_and_b32 s77, s77, 7
    s_lshl_b32 s77, s77, 10
    s_add_u32 s28, s28, s77
    s_add_u32 s28, s28, s79
    s_cmp_eq_u32 s24, 2
    s_cbranch_scc1 mega_kernel_rf_kv2a
    s_mov_b64 exec, s[48:49]
    buffer_store_dwordx4 v[244:247], v22, s[84:87], s28 offen sc1
    s_mov_b64 exec, -1
    s_branch mega_kernel_rf_kvda
    mega_kernel_rf_kv2a:
    v_lshlrev_b32 v4, 3, v1
    buffer_store_dwordx2 v[244:245], v4, s[84:87], s28 offen offset:512 sc1
    mega_kernel_rf_kvda:
    s_and_b32 s76, s27, 3
    s_cmp_ge_u32 s27, 60
    s_cselect_b32 s76, 0, s76
    s_cmp_eq_u32 s76, 0
    s_cbranch_scc0 mega_kernel_rf_y4
    v_mov_b32 v5, s27
    s_mov_b64 exec, 1
    buffer_store_dword v5, v228, s[84:87], s81 offen sc1
    s_mov_b64 exec, -1
    s_branch mega_kernel_rf_y4
mega_kernel_rf_y3:
    s_add_u32 s76, s27, 3
    s_cmp_lt_u32 s76, 63
    s_cbranch_scc0 mega_kernel_rf_y4
    s_cmp_gt_i32 s46, s76
    s_cbranch_scc1 mega_kernel_rf_pf6ok
    mega_kernel_rf_pf6w:
    buffer_load_dword v4, v24, s[84:87], 0 offen sc1
    s_waitcnt vmcnt(0)
    v_readlane_b32 s46, v4, 0
    v_readlane_b32 s28, v4, 1
    s_nop 1
    s_min_i32 s46, s46, s28
    s_cmp_gt_i32 s46, s76
    s_cbranch_scc0 mega_kernel_rf_pf6w
    mega_kernel_rf_pf6ok:
    s_add_u32 s77, s76, s82
    s_bfe_u32 s28, s77, 0x40002
    s_lshl_b32 s28, s28, 14
    s_and_b32 s77, s77, 3
    s_lshl_b32 s77, s77, 11
    s_add_u32 s28, s28, s77
    s_add_u32 s28, s28, s83
    s_buffer_load_dword s78, s[84:87], s28 offset:0
    s_buffer_load_dword s78, s[84:87], s28 offset:128
    s_buffer_load_dword s78, s[84:87], s28 offset:256
    s_buffer_load_dword s78, s[84:87], s28 offset:384
    s_buffer_load_dword s78, s[84:87], s28 offset:512
    s_buffer_load_dword s78, s[84:87], s28 offset:640
    s_buffer_load_dword s78, s[84:87], s28 offset:768
    s_buffer_load_dword s78, s[84:87], s28 offset:896
    s_buffer_load_dword s78, s[84:87], s28 offset:1024
    s_buffer_load_dword s78, s[84:87], s28 offset:1152
    s_buffer_load_dword s78, s[84:87], s28 offset:1280
    s_buffer_load_dword s78, s[84:87], s28 offset:1408
    s_buffer_load_dword s78, s[84:87], s28 offset:1536
    s_buffer_load_dword s78, s[84:87], s28 offset:1664
    s_buffer_load_dword s78, s[84:87], s28 offset:1792
    s_buffer_load_dword s78, s[84:87], s28 offset:1920
mega_kernel_rf_y4:
    s_branch mega_kernel_rf_b3
mega_kernel_rf_first:
    buffer_load_dwordx4 v[32:35], v8, s[20:23], 0 offen offset:0
    buffer_load_dwordx4 v[36:39], v8, s[20:23], 0 offen offset:128
    buffer_load_dwordx4 v[40:43], v8, s[20:23], 0 offen offset:256
    buffer_load_dwordx4 v[44:47], v8, s[20:23], 0 offen offset:384
    v_add_u32 v5, s44, v17
    ds_read_b128 v[156:159], v5 offset:0
    ds_read_b128 v[160:163], v5 offset:1024
    ds_read_b128 v[164:167], v5 offset:2048
    ds_read_b128 v[168:171], v5 offset:3072
    s_waitcnt vmcnt(0)
    v_smfmac_f32_16x16x64_bf16 v[96:99], v[32:35], a[0:7], v6
    v_smfmac_f32_16x16x64_bf16 v[100:103], v[32:35], a[32:39], v6
    v_smfmac_f32_16x16x64_bf16 v[104:107], v[32:35], a[64:71], v6
    v_smfmac_f32_16x16x64_bf16 v[108:111], v[32:35], a[96:103], v6
    v_smfmac_f32_16x16x64_bf16 v[96:99], v[36:39], a[8:15], v6
    v_smfmac_f32_16x16x64_bf16 v[100:103], v[36:39], a[40:47], v6
    v_smfmac_f32_16x16x64_bf16 v[104:107], v[36:39], a[72:79], v6
    v_smfmac_f32_16x16x64_bf16 v[108:111], v[36:39], a[104:111], v6
    v_smfmac_f32_16x16x64_bf16 v[96:99], v[40:43], a[16:23], v6
    v_smfmac_f32_16x16x64_bf16 v[100:103], v[40:43], a[48:55], v6
    v_smfmac_f32_16x16x64_bf16 v[104:107], v[40:43], a[80:87], v6
    v_smfmac_f32_16x16x64_bf16 v[108:111], v[40:43], a[112:119], v6
    v_smfmac_f32_16x16x64_bf16 v[96:99], v[44:47], a[24:31], v6
    v_smfmac_f32_16x16x64_bf16 v[100:103], v[44:47], a[56:63], v6
    v_smfmac_f32_16x16x64_bf16 v[104:107], v[44:47], a[88:95], v6
    v_smfmac_f32_16x16x64_bf16 v[108:111], v[44:47], a[120:127], v6
    s_nop 1
    s_branch mega_kernel_rf_adone
mega_kernel_rf_slast:
    s_cmp_eq_u32 s24, 3
    s_cbranch_scc1 mega_kernel_rf_end
    s_add_u32 s77, s27, s82
    s_bfe_u32 s28, s77, 0x30003
    s_lshl_b32 s28, s28, 14
    s_and_b32 s77, s77, 7
    s_lshl_b32 s77, s77, 10
    s_add_u32 s28, s28, s77
    s_add_u32 s28, s28, s79
    s_cmp_eq_u32 s24, 2
    s_cbranch_scc1 mega_kernel_rf_kv2b
    s_mov_b64 exec, s[48:49]
    buffer_store_dwordx4 v[244:247], v22, s[84:87], s28 offen sc1
    s_mov_b64 exec, -1
    s_branch mega_kernel_rf_kvdb
    mega_kernel_rf_kv2b:
    v_lshlrev_b32 v4, 3, v1
    buffer_store_dwordx2 v[244:245], v4, s[84:87], s28 offen offset:512 sc1
    mega_kernel_rf_kvdb:
    s_waitcnt vmcnt(0)
    s_mov_b32 s76, 64
    v_mov_b32 v5, s76
    s_mov_b64 exec, 1
    buffer_store_dword v5, v228, s[84:87], s81 offen sc1
    s_mov_b64 exec, -1
mega_kernel_rf_end:
    s_endpgm
mega_kernel_recs:
    s_load_dwordx2 s[20:21], s[0:1], 8
    s_load_dwordx2 s[16:17], s[0:1], 40
    s_load_dwordx2 s[4:5], s[0:1], 16
    s_load_dwordx2 s[8:9], s[0:1], 24
    s_load_dwordx2 s[12:13], s[0:1], 32
    v_lshrrev_b32 v4, 6, v0
    v_and_b32 v1, 63, v0
    v_readfirstlane_b32 s24, v4
    v_lshrrev_b32 v2, 4, v1
    v_and_b32 v3, 15, v1
    v_lshlrev_b32 v17, 4, v1
    s_lshr_b32 s28, s31, 2
    s_lshl_b32 s25, s30, 3
    s_add_u32 s25, s25, s28
    s_and_b32 s26, s31, 3
    s_waitcnt lgkmcnt(0)
    s_mov_b32 s22, 16384
    s_mov_b32 s23, 0x00020000
    s_mov_b32 s18, 8388608
    s_mov_b32 s19, 0x00020000
    s_mov_b32 s6, 8388608
    s_mov_b32 s7, 0x00020000
    s_mov_b32 s10, 8388608
    s_mov_b32 s11, 0x00020000
    s_mov_b32 s14, 8388608
    s_mov_b32 s15, 0x00020000
    s_lshl_b32 s28, s25, 8
    s_lshl_b32 s29, s26, 6
    s_add_u32 s28, s28, s29
    s_lshl_b32 s29, s24, 21
    s_add_u32 s28, s28, s29
    v_lshrrev_b32 v4, 2, v1
    v_and_b32 v5, 3, v1
    v_lshlrev_b32 v40, 13, v4
    v_lshl_add_u32 v40, v5, 4, v40
    v_add_u32 v40, s28, v40
    s_lshl_b32 s28, s30, 21
    s_lshl_b32 s29, s24, 19
    s_add_u32 s28, s28, s29
    s_lshl_b32 s29, s31, 6
    s_add_u32 s28, s28, s29
    v_lshlrev_b32 v41, 11, v4
    v_lshl_add_u32 v41, v5, 4, v41
    v_add_u32 v41, s28, v41
    s_lshl_b32 s47, s24, 15
    s_add_u32 s47, s47, 32768
    s_add_u32 m0, s47, 0
    s_mov_b32 s29, 0
    buffer_load_dwordx4 v40, s[4:7], s29 offen lds
    s_add_u32 m0, s47, 1024
    s_mov_b32 s29, 131072
    buffer_load_dwordx4 v40, s[4:7], s29 offen lds
    s_add_u32 m0, s47, 2048
    s_mov_b32 s29, 262144
    buffer_load_dwordx4 v40, s[4:7], s29 offen lds
    s_add_u32 m0, s47, 3072
    s_mov_b32 s29, 393216
    buffer_load_dwordx4 v40, s[4:7], s29 offen lds
    s_add_u32 m0, s47, 4096
    s_mov_b32 s29, 524288
    buffer_load_dwordx4 v40, s[4:7], s29 offen lds
    s_add_u32 m0, s47, 5120
    s_mov_b32 s29, 655360
    buffer_load_dwordx4 v40, s[4:7], s29 offen lds
    s_add_u32 m0, s47, 6144
    s_mov_b32 s29, 786432
    buffer_load_dwordx4 v40, s[4:7], s29 offen lds
    s_add_u32 m0, s47, 7168
    s_mov_b32 s29, 917504
    buffer_load_dwordx4 v40, s[4:7], s29 offen lds
    s_add_u32 m0, s47, 8192
    s_mov_b32 s29, 1048576
    buffer_load_dwordx4 v40, s[4:7], s29 offen lds
    s_add_u32 m0, s47, 9216
    s_mov_b32 s29, 1179648
    buffer_load_dwordx4 v40, s[4:7], s29 offen lds
    s_add_u32 m0, s47, 10240
    s_mov_b32 s29, 1310720
    buffer_load_dwordx4 v40, s[4:7], s29 offen lds
    s_add_u32 m0, s47, 11264
    s_mov_b32 s29, 1441792
    buffer_load_dwordx4 v40, s[4:7], s29 offen lds
    s_add_u32 m0, s47, 12288
    s_mov_b32 s29, 1572864
    buffer_load_dwordx4 v40, s[4:7], s29 offen lds
    s_add_u32 m0, s47, 13312
    s_mov_b32 s29, 1703936
    buffer_load_dwordx4 v40, s[4:7], s29 offen lds
    s_add_u32 m0, s47, 14336
    s_mov_b32 s29, 1835008
    buffer_load_dwordx4 v40, s[4:7], s29 offen lds
    s_add_u32 m0, s47, 15360
    s_mov_b32 s29, 1966080
    buffer_load_dwordx4 v40, s[4:7], s29 offen lds
    s_add_u32 m0, s47, 16384
    s_mov_b32 s29, 0
    buffer_load_dwordx4 v40, s[8:11], s29 offen lds
    s_add_u32 m0, s47, 17408
    s_mov_b32 s29, 131072
    buffer_load_dwordx4 v40, s[8:11], s29 offen lds
    s_add_u32 m0, s47, 18432
    s_mov_b32 s29, 262144
    buffer_load_dwordx4 v40, s[8:11], s29 offen lds
    s_add_u32 m0, s47, 19456
    s_mov_b32 s29, 393216
    buffer_load_dwordx4 v40, s[8:11], s29 offen lds
    s_add_u32 m0, s47, 20480
    s_mov_b32 s29, 524288
    buffer_load_dwordx4 v40, s[8:11], s29 offen lds
    s_add_u32 m0, s47, 21504
    s_mov_b32 s29, 655360
    buffer_load_dwordx4 v40, s[8:11], s29 offen lds
    s_add_u32 m0, s47, 22528
    s_mov_b32 s29, 786432
    buffer_load_dwordx4 v40, s[8:11], s29 offen lds
    s_add_u32 m0, s47, 23552
    s_mov_b32 s29, 917504
    buffer_load_dwordx4 v40, s[8:11], s29 offen lds
    s_add_u32 m0, s47, 24576
    s_mov_b32 s29, 1048576
    buffer_load_dwordx4 v40, s[8:11], s29 offen lds
    s_add_u32 m0, s47, 25600
    s_mov_b32 s29, 1179648
    buffer_load_dwordx4 v40, s[8:11], s29 offen lds
    s_add_u32 m0, s47, 26624
    s_mov_b32 s29, 1310720
    buffer_load_dwordx4 v40, s[8:11], s29 offen lds
    s_add_u32 m0, s47, 27648
    s_mov_b32 s29, 1441792
    buffer_load_dwordx4 v40, s[8:11], s29 offen lds
    s_add_u32 m0, s47, 28672
    s_mov_b32 s29, 1572864
    buffer_load_dwordx4 v40, s[8:11], s29 offen lds
    s_add_u32 m0, s47, 29696
    s_mov_b32 s29, 1703936
    buffer_load_dwordx4 v40, s[8:11], s29 offen lds
    s_add_u32 m0, s47, 30720
    s_mov_b32 s29, 1835008
    buffer_load_dwordx4 v40, s[8:11], s29 offen lds
    s_add_u32 m0, s47, 31744
    s_mov_b32 s29, 1966080
    buffer_load_dwordx4 v40, s[8:11], s29 offen lds
    s_mov_b32 s40, 0x00ff00ff
    s_mov_b32 s41, 0x00ff00ff
    s_mov_b32 s48, 0xff00ff00
    s_mov_b32 s49, 0xff00ff00
    s_mov_b32 s42, 0
    s_mov_b32 s43, 0x00ff00ff
    s_mov_b32 s32, 0x3e0293ee
    v_mov_b32 v23, 0xff7fffff
    v_mov_b32 v6, 0x4444
    v_mov_b32 v4, 0xeeee
    v_cndmask_b32 v6, v6, v4, s[48:49]
    v_mov_b32 v28, -1
    v_mov_b32 v29, -1
    v_mov_b32 v30, -1
    v_mov_b32 v31, -1
    s_lshl_b32 s28, s24, 12
    v_add_u32 v7, s28, v17
    v_and_b32 v4, 7, v1
    v_lshlrev_b32 v8, 11, v4
    v_lshrrev_b32 v5, 3, v1
    v_lshl_add_u32 v8, v5, 4, v8
    s_lshl_b32 s28, s24, 9
    v_add_u32 v8, s28, v8
    s_lshl_b32 s28, s31, 9
    v_lshlrev_b32 v9, 3, v1
    v_add_u32 v9, s28, v9
    v_and_b32 v4, 7, v3
    v_lshlrev_b32 v11, 7, v2
    v_lshl_add_u32 v11, v4, 4, v11
    v_add_u32 v22, 0, v11
    s_add_u32 s28, s28, 16384
    v_add_u32 v11, s28, v11
    v_and_b32 v5, 1, v2
    v_lshlrev_b32 v10, 7, v5
    v_lshl_add_u32 v10, v4, 4, v10
    v_add_u32 v10, 1024, v10
    s_xor_b32 s37, s31, 1
    s_lshl_b32 s37, s37, 11
    s_add_u32 s37, s37, 32768
    s_xor_b32 s38, s31, 2
    s_lshl_b32 s38, s38, 11
    s_add_u32 s38, s38, 32768
    s_xor_b32 s39, s31, 3
    s_lshl_b32 s39, s39, 11
    s_add_u32 s39, s39, 32768
    s_lshr_b32 s28, s31, 2
    s_xor_b32 s28, s28, s98
    s_and_b32 s28, s28, 1
    s_lshl_b32 s28, s28, 13
    s_lshl_b32 s29, s31, 19
    s_add_u32 s28, s28, s29
    s_lshl_b32 s29, s30, 10
    s_add_u32 s28, s28, s29
    s_add_u32 s28, s28, 150994944
    v_add_u32 v12, s28, v17
    v_xor_b32 v25, 1024, v12
    v_xor_b32 v26, 2048, v12
    v_xor_b32 v27, 3072, v12
    v_and_b32 v4, 1, v2
    v_mul_u32_u24 v14, 576, v4
    v_lshrrev_b32 v5, 1, v2
    v_lshl_add_u32 v5, v5, 4, v3
    v_lshl_add_u32 v14, v5, 2, v14
    s_mul_i32 s28, s24, 1152
    s_add_u32 s28, s28, 13312
    v_add_u32 v18, s28, v14
    s_mul_i32 s28, s24, 2304
    v_add_u32 v14, s28, v14
    v_add_u32 v15, 1152, v14
    v_mul_u32_u24 v16, 144, v3
    v_lshl_add_u32 v16, v2, 5, v16
    v_bfe_u32 v4, v1, 1, 3
    v_mul_u32_u24 v19, 144, v4
    v_lshl_add_u32 v19, v2, 5, v19
    v_and_b32 v4, 1, v1
    v_lshl_add_u32 v19, v4, 4, v19
    v_add_u32 v19, 13312, v19
    s_lshl_b32 s28, s24, 10
    s_add_u32 s28, s28, 9216
    v_add_u32 v20, s28, v17
    v_and_b32 v4, 31, v1
    v_lshlrev_b32 v21, 3, v4
    v_add_u32 v21, 17920, v21
    v_lshrrev_b32 v4, 2, v3
    v_and_b32 v42, 1, v4
    v_lshrrev_b32 v43, 1, v4
    v_lshrrev_b32 v44, 1, v2
    v_and_b32 v45, 1, v2
    v_lshl_add_u32 v46, v44, 4, v42
    v_lshl_add_u32 v46, v45, 2, v46
    v_lshl_add_u32 v46, v43, 3, v46
    v_lshl_add_u32 v47, v44, 3, v42
    v_lshl_add_u32 v47, v45, 4, v47
    v_lshl_add_u32 v47, v43, 2, v47
    v_and_b32 v5, 3, v3
    v_lshlrev_b32 v5, 3, v5
    v_lshl_add_u32 v46, v46, 6, v5
    v_lshl_add_u32 v47, v47, 6, v5
    v_add_u32 v46, s47, v46
    v_add_u32 v47, s47, v47
    s_waitcnt vmcnt(16)
    ds_read_b64_tr_b16 a[0:1], v46 offset:0
    ds_read_b64_tr_b16 a[2:3], v46 offset:128
    ds_read_b64_tr_b16 a[4:5], v46 offset:2048
    ds_read_b64_tr_b16 a[6:7], v46 offset:2176
    ds_read_b64_tr_b16 a[8:9], v46 offset:4096
    ds_read_b64_tr_b16 a[10:11], v46 offset:4224
    ds_read_b64_tr_b16 a[12:13], v46 offset:6144
    ds_read_b64_tr_b16 a[14:15], v46 offset:6272
    s_waitcnt lgkmcnt(0)
    ds_read_b64_tr_b16 a[16:17], v46 offset:8192
    ds_read_b64_tr_b16 a[18:19], v46 offset:8320
    ds_read_b64_tr_b16 a[20:21], v46 offset:10240
    ds_read_b64_tr_b16 a[22:23], v46 offset:10368
    ds_read_b64_tr_b16 a[24:25], v46 offset:12288
    ds_read_b64_tr_b16 a[26:27], v46 offset:12416
    ds_read_b64_tr_b16 a[28:29], v46 offset:14336
    ds_read_b64_tr_b16 a[30:31], v46 offset:14464
    s_waitcnt lgkmcnt(0)
    ds_read_b64_tr_b16 a[32:33], v46 offset:32
    ds_read_b64_tr_b16 a[34:35], v46 offset:160
    ds_read_b64_tr_b16 a[36:37], v46 offset:2080
    ds_read_b64_tr_b16 a[38:39], v46 offset:2208
    ds_read_b64_tr_b16 a[40:41], v46 offset:4128
    ds_read_b64_tr_b16 a[42:43], v46 offset:4256
    ds_read_b64_tr_b16 a[44:45], v46 offset:6176
    ds_read_b64_tr_b16 a[46:47], v46 offset:6304
    s_waitcnt lgkmcnt(0)
    ds_read_b64_tr_b16 a[48:49], v46 offset:8224
    ds_read_b64_tr_b16 a[50:51], v46 offset:8352
    ds_read_b64_tr_b16 a[52:53], v46 offset:10272
    ds_read_b64_tr_b16 a[54:55], v46 offset:10400
    ds_read_b64_tr_b16 a[56:57], v46 offset:12320
    ds_read_b64_tr_b16 a[58:59], v46 offset:12448
    ds_read_b64_tr_b16 a[60:61], v46 offset:14368
    ds_read_b64_tr_b16 a[62:63], v46 offset:14496
    s_waitcnt lgkmcnt(0)
    s_add_u32 m0, s47, 0
    s_mov_b32 s29, 0
    buffer_load_dwordx4 v40, s[12:15], s29 offen lds
    s_add_u32 m0, s47, 1024
    s_mov_b32 s29, 131072
    buffer_load_dwordx4 v40, s[12:15], s29 offen lds
    s_add_u32 m0, s47, 2048
    s_mov_b32 s29, 262144
    buffer_load_dwordx4 v40, s[12:15], s29 offen lds
    s_add_u32 m0, s47, 3072
    s_mov_b32 s29, 393216
    buffer_load_dwordx4 v40, s[12:15], s29 offen lds
    s_add_u32 m0, s47, 4096
    s_mov_b32 s29, 524288
    buffer_load_dwordx4 v40, s[12:15], s29 offen lds
    s_add_u32 m0, s47, 5120
    s_mov_b32 s29, 655360
    buffer_load_dwordx4 v40, s[12:15], s29 offen lds
    s_add_u32 m0, s47, 6144
    s_mov_b32 s29, 786432
    buffer_load_dwordx4 v40, s[12:15], s29 offen lds
    s_add_u32 m0, s47, 7168
    s_mov_b32 s29, 917504
    buffer_load_dwordx4 v40, s[12:15], s29 offen lds
    s_add_u32 m0, s47, 8192
    s_mov_b32 s29, 1048576
    buffer_load_dwordx4 v40, s[12:15], s29 offen lds
    s_add_u32 m0, s47, 9216
    s_mov_b32 s29, 1179648
    buffer_load_dwordx4 v40, s[12:15], s29 offen lds
    s_add_u32 m0, s47, 10240
    s_mov_b32 s29, 1310720
    buffer_load_dwordx4 v40, s[12:15], s29 offen lds
    s_add_u32 m0, s47, 11264
    s_mov_b32 s29, 1441792
    buffer_load_dwordx4 v40, s[12:15], s29 offen lds
    s_add_u32 m0, s47, 12288
    s_mov_b32 s29, 1572864
    buffer_load_dwordx4 v40, s[12:15], s29 offen lds
    s_add_u32 m0, s47, 13312
    s_mov_b32 s29, 1703936
    buffer_load_dwordx4 v40, s[12:15], s29 offen lds
    s_add_u32 m0, s47, 14336
    s_mov_b32 s29, 1835008
    buffer_load_dwordx4 v40, s[12:15], s29 offen lds
    s_add_u32 m0, s47, 15360
    s_mov_b32 s29, 1966080
    buffer_load_dwordx4 v40, s[12:15], s29 offen lds
    s_waitcnt vmcnt(16)
    ds_read_b64_tr_b16 a[64:65], v46 offset:16384
    ds_read_b64_tr_b16 a[66:67], v46 offset:16512
    ds_read_b64_tr_b16 a[68:69], v46 offset:18432
    ds_read_b64_tr_b16 a[70:71], v46 offset:18560
    ds_read_b64_tr_b16 a[72:73], v46 offset:20480
    ds_read_b64_tr_b16 a[74:75], v46 offset:20608
    ds_read_b64_tr_b16 a[76:77], v46 offset:22528
    ds_read_b64_tr_b16 a[78:79], v46 offset:22656
    s_waitcnt lgkmcnt(0)
    ds_read_b64_tr_b16 a[80:81], v46 offset:24576
    ds_read_b64_tr_b16 a[82:83], v46 offset:24704
    ds_read_b64_tr_b16 a[84:85], v46 offset:26624
    ds_read_b64_tr_b16 a[86:87], v46 offset:26752
    ds_read_b64_tr_b16 a[88:89], v46 offset:28672
    ds_read_b64_tr_b16 a[90:91], v46 offset:28800
    ds_read_b64_tr_b16 a[92:93], v46 offset:30720
    ds_read_b64_tr_b16 a[94:95], v46 offset:30848
    s_waitcnt lgkmcnt(0)
    ds_read_b64_tr_b16 a[96:97], v46 offset:16416
    ds_read_b64_tr_b16 a[98:99], v46 offset:16544
    ds_read_b64_tr_b16 a[100:101], v46 offset:18464
    ds_read_b64_tr_b16 a[102:103], v46 offset:18592
    ds_read_b64_tr_b16 a[104:105], v46 offset:20512
    ds_read_b64_tr_b16 a[106:107], v46 offset:20640
    ds_read_b64_tr_b16 a[108:109], v46 offset:22560
    ds_read_b64_tr_b16 a[110:111], v46 offset:22688
    s_waitcnt lgkmcnt(0)
    ds_read_b64_tr_b16 a[112:113], v46 offset:24608
    ds_read_b64_tr_b16 a[114:115], v46 offset:24736
    ds_read_b64_tr_b16 a[116:117], v46 offset:26656
    ds_read_b64_tr_b16 a[118:119], v46 offset:26784
    ds_read_b64_tr_b16 a[120:121], v46 offset:28704
    ds_read_b64_tr_b16 a[122:123], v46 offset:28832
    ds_read_b64_tr_b16 a[124:125], v46 offset:30752
    ds_read_b64_tr_b16 a[126:127], v46 offset:30880
    s_waitcnt lgkmcnt(0)
    s_add_u32 m0, s47, 16384
    s_mov_b32 s29, 0
    buffer_load_dwordx4 v41, s[16:19], s29 offen lds
    s_add_u32 m0, s47, 17408
    s_mov_b32 s29, 32768
    buffer_load_dwordx4 v41, s[16:19], s29 offen lds
    s_add_u32 m0, s47, 18432
    s_mov_b32 s29, 65536
    buffer_load_dwordx4 v41, s[16:19], s29 offen lds
    s_add_u32 m0, s47, 19456
    s_mov_b32 s29, 98304
    buffer_load_dwordx4 v41, s[16:19], s29 offen lds
    s_add_u32 m0, s47, 20480
    s_mov_b32 s29, 131072
    buffer_load_dwordx4 v41, s[16:19], s29 offen lds
    s_add_u32 m0, s47, 21504
    s_mov_b32 s29, 163840
    buffer_load_dwordx4 v41, s[16:19], s29 offen lds
    s_add_u32 m0, s47, 22528
    s_mov_b32 s29, 196608
    buffer_load_dwordx4 v41, s[16:19], s29 offen lds
    s_add_u32 m0, s47, 23552
    s_mov_b32 s29, 229376
    buffer_load_dwordx4 v41, s[16:19], s29 offen lds
    s_add_u32 m0, s47, 24576
    s_mov_b32 s29, 262144
    buffer_load_dwordx4 v41, s[16:19], s29 offen lds
    s_add_u32 m0, s47, 25600
    s_mov_b32 s29, 294912
    buffer_load_dwordx4 v41, s[16:19], s29 offen lds
    s_add_u32 m0, s47, 26624
    s_mov_b32 s29, 327680
    buffer_load_dwordx4 v41, s[16:19], s29 offen lds
    s_add_u32 m0, s47, 27648
    s_mov_b32 s29, 360448
    buffer_load_dwordx4 v41, s[16:19], s29 offen lds
    s_add_u32 m0, s47, 28672
    s_mov_b32 s29, 393216
    buffer_load_dwordx4 v41, s[16:19], s29 offen lds
    s_add_u32 m0, s47, 29696
    s_mov_b32 s29, 425984
    buffer_load_dwordx4 v41, s[16:19], s29 offen lds
    s_add_u32 m0, s47, 30720
    s_mov_b32 s29, 458752
    buffer_load_dwordx4 v41, s[16:19], s29 offen lds
    s_add_u32 m0, s47, 31744
    s_mov_b32 s29, 491520
    buffer_load_dwordx4 v41, s[16:19], s29 offen lds
    s_waitcnt vmcnt(16)
    ds_read_b64_tr_b16 a[128:129], v46 offset:0
    ds_read_b64_tr_b16 a[130:131], v46 offset:128
    ds_read_b64_tr_b16 a[132:133], v46 offset:2048
    ds_read_b64_tr_b16 a[134:135], v46 offset:2176
    ds_read_b64_tr_b16 a[136:137], v46 offset:4096
    ds_read_b64_tr_b16 a[138:139], v46 offset:4224
    ds_read_b64_tr_b16 a[140:141], v46 offset:6144
    ds_read_b64_tr_b16 a[142:143], v46 offset:6272
    s_waitcnt lgkmcnt(0)
    ds_read_b64_tr_b16 a[144:145], v46 offset:8192
    ds_read_b64_tr_b16 a[146:147], v46 offset:8320
    ds_read_b64_tr_b16 a[148:149], v46 offset:10240
    ds_read_b64_tr_b16 a[150:151], v46 offset:10368
    ds_read_b64_tr_b16 a[152:153], v46 offset:12288
    ds_read_b64_tr_b16 a[154:155], v46 offset:12416
    ds_read_b64_tr_b16 a[156:157], v46 offset:14336
    ds_read_b64_tr_b16 a[158:159], v46 offset:14464
    s_waitcnt lgkmcnt(0)
    ds_read_b64_tr_b16 a[160:161], v46 offset:32
    ds_read_b64_tr_b16 a[162:163], v46 offset:160
    ds_read_b64_tr_b16 a[164:165], v46 offset:2080
    ds_read_b64_tr_b16 a[166:167], v46 offset:2208
    ds_read_b64_tr_b16 a[168:169], v46 offset:4128
    ds_read_b64_tr_b16 a[170:171], v46 offset:4256
    ds_read_b64_tr_b16 a[172:173], v46 offset:6176
    ds_read_b64_tr_b16 a[174:175], v46 offset:6304
    s_waitcnt lgkmcnt(0)
    ds_read_b64_tr_b16 a[176:177], v46 offset:8224
    ds_read_b64_tr_b16 a[178:179], v46 offset:8352
    ds_read_b64_tr_b16 a[180:181], v46 offset:10272
    ds_read_b64_tr_b16 a[182:183], v46 offset:10400
    ds_read_b64_tr_b16 a[184:185], v46 offset:12320
    ds_read_b64_tr_b16 a[186:187], v46 offset:12448
    ds_read_b64_tr_b16 a[188:189], v46 offset:14368
    ds_read_b64_tr_b16 a[190:191], v46 offset:14496
    s_waitcnt lgkmcnt(0)
    s_waitcnt vmcnt(0)
    ds_read_b64_tr_b16 a[192:193], v47 offset:16384
    ds_read_b64_tr_b16 a[194:195], v47 offset:16512
    ds_read_b64_tr_b16 a[196:197], v47 offset:18432
    ds_read_b64_tr_b16 a[198:199], v47 offset:18560
    ds_read_b64_tr_b16 a[200:201], v47 offset:20480
    ds_read_b64_tr_b16 a[202:203], v47 offset:20608
    ds_read_b64_tr_b16 a[204:205], v47 offset:22528
    ds_read_b64_tr_b16 a[206:207], v47 offset:22656
    s_waitcnt lgkmcnt(0)
    ds_read_b64_tr_b16 a[208:209], v47 offset:24576
    ds_read_b64_tr_b16 a[210:211], v47 offset:24704
    ds_read_b64_tr_b16 a[212:213], v47 offset:26624
    ds_read_b64_tr_b16 a[214:215], v47 offset:26752
    ds_read_b64_tr_b16 a[216:217], v47 offset:28672
    ds_read_b64_tr_b16 a[218:219], v47 offset:28800
    ds_read_b64_tr_b16 a[220:221], v47 offset:30720
    ds_read_b64_tr_b16 a[222:223], v47 offset:30848
    s_waitcnt lgkmcnt(0)
    ds_read_b64_tr_b16 a[224:225], v47 offset:16416
    ds_read_b64_tr_b16 a[226:227], v47 offset:16544
    ds_read_b64_tr_b16 a[228:229], v47 offset:18464
    ds_read_b64_tr_b16 a[230:231], v47 offset:18592
    ds_read_b64_tr_b16 a[232:233], v47 offset:20512
    ds_read_b64_tr_b16 a[234:235], v47 offset:20640
    ds_read_b64_tr_b16 a[236:237], v47 offset:22560
    ds_read_b64_tr_b16 a[238:239], v47 offset:22688
    s_waitcnt lgkmcnt(0)
    ds_read_b64_tr_b16 a[240:241], v47 offset:24608
    ds_read_b64_tr_b16 a[242:243], v47 offset:24736
    ds_read_b64_tr_b16 a[244:245], v47 offset:26656
    ds_read_b64_tr_b16 a[246:247], v47 offset:26784
    ds_read_b64_tr_b16 a[248:249], v47 offset:28704
    ds_read_b64_tr_b16 a[250:251], v47 offset:28832
    ds_read_b64_tr_b16 a[252:253], v47 offset:30752
    ds_read_b64_tr_b16 a[254:255], v47 offset:30880
    s_waitcnt lgkmcnt(0)
    s_lshl_b32 s28, s25, 2
    s_add_u32 s28, s28, s26
    s_mov_b32 s82, s28
    s_lshr_b32 s29, s28, 3
    s_xor_b32 s29, s29, s98
    s_and_b32 s29, s29, 1
    s_lshl_b32 s29, s29, 13
    s_lshl_b32 s76, s28, 18
    s_add_u32 s76, s76, s29
    s_mov_b32 s83, s76
    v_add_u32 v240, s76, v17
    v_add_u32 v241, 33554432, v240
    s_lshr_b32 s29, s28, 4
    s_xor_b32 s29, s29, s98
    s_and_b32 s29, s29, 1
    s_lshl_b32 s29, s29, 13
    s_lshl_b32 s79, s28, 17
    s_add_u32 s79, s79, s29
    s_add_u32 s79, s79, 71303168
    s_xor_b32 s29, s98, 1
    s_lshl_b32 s29, s29, 13
    s_lshl_b32 s28, s25, 7
    s_add_u32 s28, s28, s29
    s_add_u32 s28, s28, 70254592
    v_and_b32 v4, 1, v1
    v_lshlrev_b32 v24, 12, v4
    v_add_u32 v24, s28, v24
    s_lshl_b32 s29, s26, 2
    v_add_u32 v24, s29, v24
    s_lshl_b32 s29, s26, 3
    s_add_u32 s81, s28, s29
    s_lshl_b32 s29, s24, 2
    s_add_u32 s81, s81, s29
    s_add_u32 s81, s81, 16380
    v_mov_b32 v220, 0x3f803f80
    v_mov_b32 v221, 0x3f803f80
    v_mov_b32 v222, 0x3f803f80
    v_mov_b32 v223, 0x3f803f80
    v_mov_b32 v228, 0
    s_mov_b32 s27, 0
    s_mov_b32 s46, 0
    s_mov_b32 s44, 18432
    s_mov_b32 s45, 18432
    s_cmp_eq_u32 s24, 3
    s_cbranch_scc0 mega_kernel_rs_pfi
    s_mov_b32 s76, 0
    s_cmp_gt_i32 s46, s76
    s_cbranch_scc1 mega_kernel_rs_pf0ok
    mega_kernel_rs_pf0w:
    buffer_load_dword v4, v24, s[84:87], 0 offen sc1
    s_waitcnt vmcnt(0)
    v_readlane_b32 s46, v4, 0
    v_readlane_b32 s28, v4, 1
    s_nop 1
    s_min_i32 s46, s46, s28
    s_cmp_gt_i32 s46, s76
    s_cbranch_scc0 mega_kernel_rs_pf0w
    mega_kernel_rs_pf0ok:
    s_add_u32 s77, s76, s82
    s_bfe_u32 s28, s77, 0x40002
    s_lshl_b32 s28, s28, 14
    s_and_b32 s77, s77, 3
    s_lshl_b32 s77, s77, 11
    s_add_u32 s28, s28, s77
    s_add_u32 m0, s45, 0
    s_nop 0
    buffer_load_dwordx4 v240, s[84:87], s28 offen offset:0 sc1 lds
    s_add_u32 m0, s45, 0
    s_nop 0
    buffer_load_dwordx4 v240, s[84:87], s28 offen offset:1024 sc1 lds
    s_add_u32 m0, s45, 2048
    s_nop 0
    buffer_load_dwordx4 v241, s[84:87], s28 offen offset:0 sc1 lds
    s_add_u32 m0, s45, 2048
    s_nop 0
    buffer_load_dwordx4 v241, s[84:87], s28 offen offset:1024 sc1 lds
    s_add_u32 s45, s45, 4096
    s_cmp_eq_u32 s45, 30720
    s_cselect_b32 s45, 18432, s45
    s_mov_b32 s76, 1
    s_cmp_gt_i32 s46, s76
    s_cbranch_scc1 mega_kernel_rs_pf1ok
    mega_kernel_rs_pf1w:
    buffer_load_dword v4, v24, s[84:87], 0 offen sc1
    s_waitcnt vmcnt(0)
    v_readlane_b32 s46, v4, 0
    v_readlane_b32 s28, v4, 1
    s_nop 1
    s_min_i32 s46, s46, s28
    s_cmp_gt_i32 s46, s76
    s_cbranch_scc0 mega_kernel_rs_pf1w
    mega_kernel_rs_pf1ok:
    s_add_u32 s77, s76, s82
    s_bfe_u32 s28, s77, 0x40002
    s_lshl_b32 s28, s28, 14
    s_and_b32 s77, s77, 3
    s_lshl_b32 s77, s77, 11
    s_add_u32 s28, s28, s77
    s_add_u32 m0, s45, 0
    s_nop 0
    buffer_load_dwordx4 v240, s[84:87], s28 offen offset:0 sc1 lds
    s_add_u32 m0, s45, 0
    s_nop 0
    buffer_load_dwordx4 v240, s[84:87], s28 offen offset:1024 sc1 lds
    s_add_u32 m0, s45, 2048
    s_nop 0
    buffer_load_dwordx4 v241, s[84:87], s28 offen offset:0 sc1 lds
    s_add_u32 m0, s45, 2048
    s_nop 0
    buffer_load_dwordx4 v241, s[84:87], s28 offen offset:1024 sc1 lds
    s_add_u32 s45, s45, 4096
    s_cmp_eq_u32 s45, 30720
    s_cselect_b32 s45, 18432, s45
    s_mov_b32 s76, 2
    s_cmp_gt_i32 s46, s76
    s_cbranch_scc1 mega_kernel_rs_pf2ok
    mega_kernel_rs_pf2w:
    buffer_load_dword v4, v24, s[84:87], 0 offen sc1
    s_waitcnt vmcnt(0)
    v_readlane_b32 s46, v4, 0
    v_readlane_b32 s28, v4, 1
    s_nop 1
    s_min_i32 s46, s46, s28
    s_cmp_gt_i32 s46, s76
    s_cbranch_scc0 mega_kernel_rs_pf2w
    mega_kernel_rs_pf2ok:
    s_add_u32 s77, s76, s82
    s_bfe_u32 s28, s77, 0x40002
    s_lshl_b32 s28, s28, 14
    s_and_b32 s77, s77, 3
    s_lshl_b32 s77, s77, 11
    s_add_u32 s28, s28, s77
    s_add_u32 s28, s28, s83
    s_buffer_load_dword s78, s[84:87], s28 offset:0
    s_buffer_load_dword s78, s[84:87], s28 offset:128
    s_buffer_load_dword s78, s[84:87], s28 offset:256
    s_buffer_load_dword s78, s[84:87], s28 offset:384
    s_buffer_load_dword s78, s[84:87], s28 offset:512
    s_buffer_load_dword s78, s[84:87], s28 offset:640
    s_buffer_load_dword s78, s[84:87], s28 offset:768
    s_buffer_load_dword s78, s[84:87], s28 offset:896
    s_buffer_load_dword s78, s[84:87], s28 offset:1024
    s_buffer_load_dword s78, s[84:87], s28 offset:1152
    s_buffer_load_dword s78, s[84:87], s28 offset:1280
    s_buffer_load_dword s78, s[84:87], s28 offset:1408
    s_buffer_load_dword s78, s[84:87], s28 offset:1536
    s_buffer_load_dword s78, s[84:87], s28 offset:1664
    s_buffer_load_dword s78, s[84:87], s28 offset:1792
    s_buffer_load_dword s78, s[84:87], s28 offset:1920
    s_add_u32 s77, s76, s82
    s_bfe_u32 s28, s77, 0x40002
    s_lshl_b32 s28, s28, 14
    s_and_b32 s77, s77, 3
    s_lshl_b32 s77, s77, 11
    s_add_u32 s28, s28, s77
    s_add_u32 s28, s28, s83
    s_add_u32 s28, s28, 33554432
    s_buffer_load_dword s78, s[84:87], s28 offset:0
    s_buffer_load_dword s78, s[84:87], s28 offset:128
    s_buffer_load_dword s78, s[84:87], s28 offset:256
    s_buffer_load_dword s78, s[84:87], s28 offset:384
    s_buffer_load_dword s78, s[84:87], s28 offset:512
    s_buffer_load_dword s78, s[84:87], s28 offset:640
    s_buffer_load_dword s78, s[84:87], s28 offset:768
    s_buffer_load_dword s78, s[84:87], s28 offset:896
    s_buffer_load_dword s78, s[84:87], s28 offset:1024
    s_buffer_load_dword s78, s[84:87], s28 offset:1152
    s_buffer_load_dword s78, s[84:87], s28 offset:1280
    s_buffer_load_dword s78, s[84:87], s28 offset:1408
    s_buffer_load_dword s78, s[84:87], s28 offset:1536
    s_buffer_load_dword s78, s[84:87], s28 offset:1664
    s_buffer_load_dword s78, s[84:87], s28 offset:1792
    s_buffer_load_dword s78, s[84:87], s28 offset:1920
    s_waitcnt vmcnt(0) lgkmcnt(0)
mega_kernel_rs_pfi:
    s_cmp_eq_u32 s24, 2
    s_cbranch_scc0 mega_kernel_rs_xpd
mega_kernel_rs_xpw:
    buffer_load_dword v4, v228, s[72:75], 0 offen offset:224 sc1
    s_waitcnt vmcnt(0)
    v_cmp_ne_u32 vcc, 64, v4
    s_cbranch_vccnz mega_kernel_rs_xpw
mega_kernel_rs_xpd:
    v_mov_b32 v96, 0
    v_mov_b32 v97, 0
    v_mov_b32 v98, 0
    v_mov_b32 v99, 0
    v_mov_b32 v100, 0
    v_mov_b32 v101, 0
    v_mov_b32 v102, 0
    v_mov_b32 v103, 0
    v_mov_b32 v104, 0
    v_mov_b32 v105, 0
    v_mov_b32 v106, 0
    v_mov_b32 v107, 0
    v_mov_b32 v108, 0
    v_mov_b32 v109, 0
    v_mov_b32 v110, 0
    v_mov_b32 v111, 0
    v_mov_b32 v112, 0
    v_mov_b32 v113, 0
    v_mov_b32 v114, 0
    v_mov_b32 v115, 0
    v_mov_b32 v116, 0
    v_mov_b32 v117, 0
    v_mov_b32 v118, 0
    v_mov_b32 v119, 0
    s_barrier
    s_and_b32 s29, s27, 1
    s_lshl_b32 s33, s29, 17
    s_lshl_b32 s28, s30, 18
    s_add_u32 s33, s33, s28
    s_add_u32 s33, s33, 69206016
    s_xor_b32 s34, s33, 131072
    s_add_u32 s28, s27, s31
    s_and_b32 s29, s28, 1
    s_lshl_b32 s35, s29, 12
    s_and_b32 s28, s28, 14
    s_and_b32 s29, s27, 48
    s_or_b32 s28, s28, s29
    s_lshl_b32 s28, s28, 13
    s_add_u32 s35, s35, s28
    s_branch mega_kernel_rs_first
mega_kernel_rs_loop:
    buffer_load_dwordx4 v[32:35], v7, s[84:87], s33 offen offset:0 sc1
    v_add_u32 v5, s44, v17
    ds_read_b128 v[156:159], v5 offset:0
    ds_read_b128 v[160:163], v5 offset:1024
    ds_read_b128 v[164:167], v5 offset:2048
    ds_read_b128 v[168:171], v5 offset:3072
    s_nop 4
    buffer_load_dwordx4 v[36:39], v7, s[84:87], s33 offen offset:1024 sc1
    s_nop 9
    buffer_load_dwordx4 v[40:43], v7, s[84:87], s33 offen offset:2048 sc1
    s_nop 9
    buffer_load_dwordx4 v[44:47], v7, s[84:87], s33 offen offset:3072 sc1
mega_kernel_rs_pa0:
    s_waitcnt vmcnt(3)
    v_max_u32 v4, v32, v34
    v_cmp_eq_u32 vcc, -1, v4
    s_cbranch_vccnz mega_kernel_rs_par0
mega_kernel_rs_pak0:
    v_smfmac_f32_16x16x64_bf16 v[96:99], v[32:35], a[0:7], v6
    v_smfmac_f32_16x16x64_bf16 v[100:103], v[32:35], a[32:39], v6
    v_smfmac_f32_16x16x64_bf16 v[104:107], v[32:35], a[64:71], v6
    v_smfmac_f32_16x16x64_bf16 v[108:111], v[32:35], a[96:103], v6
mega_kernel_rs_pa1:
    s_waitcnt vmcnt(2)
    v_max_u32 v4, v36, v38
    v_cmp_eq_u32 vcc, -1, v4
    s_cbranch_vccnz mega_kernel_rs_par1
mega_kernel_rs_pak1:
    v_smfmac_f32_16x16x64_bf16 v[96:99], v[36:39], a[8:15], v6
    v_smfmac_f32_16x16x64_bf16 v[100:103], v[36:39], a[40:47], v6
    v_smfmac_f32_16x16x64_bf16 v[104:107], v[36:39], a[72:79], v6
    v_smfmac_f32_16x16x64_bf16 v[108:111], v[36:39], a[104:111], v6
mega_kernel_rs_pa2:
    s_waitcnt vmcnt(1)
    v_max_u32 v4, v40, v42
    v_cmp_eq_u32 vcc, -1, v4
    s_cbranch_vccnz mega_kernel_rs_par2
mega_kernel_rs_pak2:
    v_smfmac_f32_16x16x64_bf16 v[96:99], v[40:43], a[16:23], v6
    v_smfmac_f32_16x16x64_bf16 v[100:103], v[40:43], a[48:55], v6
    v_smfmac_f32_16x16x64_bf16 v[104:107], v[40:43], a[80:87], v6
    v_smfmac_f32_16x16x64_bf16 v[108:111], v[40:43], a[112:119], v6
mega_kernel_rs_pa3:
    s_waitcnt vmcnt(0)
    v_max_u32 v4, v44, v46
    v_cmp_eq_u32 vcc, -1, v4
    s_cbranch_vccnz mega_kernel_rs_par3
mega_kernel_rs_pak3:
    v_smfmac_f32_16x16x64_bf16 v[96:99], v[44:47], a[24:31], v6
    v_smfmac_f32_16x16x64_bf16 v[100:103], v[44:47], a[56:63], v6
    v_smfmac_f32_16x16x64_bf16 v[104:107], v[44:47], a[88:95], v6
    v_smfmac_f32_16x16x64_bf16 v[108:111], v[44:47], a[120:127], v6
mega_kernel_rs_adone:
    s_nop 5
    v_permlane32_swap_b32 v96, v100
    v_permlane32_swap_b32 v97, v101
    v_permlane32_swap_b32 v98, v102
    v_permlane32_swap_b32 v99, v103
    v_pk_add_f32 v[96:97], v[96:97], v[100:101]
    v_pk_add_f32 v[98:99], v[98:99], v[102:103]
    ds_write2_b32 v14, v96, v97 offset0:0 offset1:36
    ds_write2_b32 v14, v98, v99 offset0:72 offset1:108
    v_permlane32_swap_b32 v104, v108
    v_permlane32_swap_b32 v105, v109
    v_permlane32_swap_b32 v106, v110
    v_permlane32_swap_b32 v107, v111
    v_pk_add_f32 v[104:105], v[104:105], v[108:109]
    v_pk_add_f32 v[106:107], v[106:107], v[110:111]
    ds_write2_b32 v15, v104, v105 offset0:0 offset1:36
    ds_write2_b32 v15, v106, v107 offset0:72 offset1:108
    v_smfmac_f32_16x16x64_bf16 v[112:115], v[32:35], a[128:135], v6
    v_smfmac_f32_16x16x64_bf16 v[116:119], v[32:35], a[160:167], v6
    v_smfmac_f32_16x16x64_bf16 v[112:115], v[36:39], a[136:143], v6
    v_smfmac_f32_16x16x64_bf16 v[116:119], v[36:39], a[168:175], v6
    s_waitcnt lgkmcnt(0)
    s_barrier
    s_cmp_lg_u32 s24, 0
    s_cbranch_scc1 mega_kernel_rs_side
    ds_read_b128 v[120:123], v16 offset:0
    ds_read_b128 v[124:127], v16 offset:16
    ds_read_b128 v[128:131], v16 offset:2304
    ds_read_b128 v[132:135], v16 offset:2320
    ds_read_b128 v[136:139], v16 offset:4608
    ds_read_b128 v[140:143], v16 offset:4624
    ds_read_b128 v[144:147], v16 offset:6912
    ds_read_b128 v[148:151], v16 offset:6928
    v_smfmac_f32_16x16x64_bf16 v[112:115], v[40:43], a[144:151], v6
    v_smfmac_f32_16x16x64_bf16 v[116:119], v[40:43], a[176:183], v6
    v_smfmac_f32_16x16x64_bf16 v[112:115], v[44:47], a[152:159], v6
    v_smfmac_f32_16x16x64_bf16 v[116:119], v[44:47], a[184:191], v6
    s_lshl_b32 s28, s31, 11
    s_add_u32 s28, s28, s33
    s_add_u32 s28, s28, 32768
    s_add_u32 s76, s37, s33
    s_add_u32 s77, s38, s33
    s_add_u32 s78, s39, s33
    s_waitcnt lgkmcnt(4)
    v_pk_add_f32 v[120:121], v[120:121], v[128:129]
    v_pk_add_f32 v[122:123], v[122:123], v[130:131]
    v_pk_add_f32 v[124:125], v[124:125], v[132:133]
    v_pk_add_f32 v[126:127], v[126:127], v[134:135]
    s_waitcnt lgkmcnt(0)
    v_pk_add_f32 v[136:137], v[136:137], v[144:145]
    v_pk_add_f32 v[138:139], v[138:139], v[146:147]
    v_pk_add_f32 v[140:141], v[140:141], v[148:149]
    v_pk_add_f32 v[142:143], v[142:143], v[150:151]
    v_pk_add_f32 v[120:121], v[120:121], v[136:137]
    v_pk_add_f32 v[122:123], v[122:123], v[138:139]
    v_pk_add_f32 v[124:125], v[124:125], v[140:141]
    v_pk_add_f32 v[126:127], v[126:127], v[142:143]
    v_cvt_pk_bf16_f32 v152, v120, v121
    v_cvt_pk_bf16_f32 v153, v122, v123
    v_cvt_pk_bf16_f32 v154, v124, v125
    v_cvt_pk_bf16_f32 v155, v126, v127
    s_nop 1
    v_mfma_f32_16x16x32_bf16 v[176:179], v[160:163], v[152:155], 0
    v_mfma_f32_16x16x32_bf16 v[172:175], v[156:159], v[152:155], 0
    v_mfma_f32_16x16x32_bf16 v[180:183], v[152:155], v[152:155], 0
    s_cmp_eq_u32 s27, 63
    s_cbranch_scc1 mega_kernel_rs_w0last
    s_nop 4
    v_mov_b32_dpp v172, v176 row_shr:8 row_mask:0xf bank_mask:0xc
    v_mov_b32_dpp v173, v177 row_shr:8 row_mask:0xf bank_mask:0xc
    v_mov_b32_dpp v174, v178 row_shr:8 row_mask:0xf bank_mask:0xc
    v_mov_b32_dpp v175, v179 row_shr:8 row_mask:0xf bank_mask:0xc
    v_min_u32 v180, -2, v180
    v_min_u32 v172, -2, v172
    s_mov_b64 exec, s[42:43]
    buffer_store_dwordx4 v[180:183], v10, s[84:87], s28 offen sc1
    s_mov_b64 exec, -1
    buffer_store_dwordx4 v[172:175], v17, s[84:87], s28 offen sc1
    v_permlane32_swap_b32 v112, v116
    v_permlane32_swap_b32 v113, v117
    v_permlane32_swap_b32 v114, v118
    v_permlane32_swap_b32 v115, v119
    v_pk_add_f32 v[112:113], v[112:113], v[116:117]
    v_pk_add_f32 v[114:115], v[114:115], v[118:119]
    ds_write_b128 v20, v[112:115]
    buffer_load_dwordx4 v[184:187], v17, s[84:87], s76 offen sc1
    buffer_load_dwordx4 v[188:191], v10, s[84:87], s76 offen sc1
    buffer_load_dwordx4 v[192:195], v17, s[84:87], s77 offen sc1
    buffer_load_dwordx4 v[196:199], v10, s[84:87], s77 offen sc1
    buffer_load_dwordx4 v[200:203], v17, s[84:87], s78 offen sc1
    buffer_load_dwordx4 v[204:207], v10, s[84:87], s78 offen sc1
    v_mov_b32 v96, 0
    v_mov_b32 v97, 0
    v_mov_b32 v98, 0
    v_mov_b32 v99, 0
    v_mov_b32 v100, 0
    v_mov_b32 v101, 0
    v_mov_b32 v102, 0
    v_mov_b32 v103, 0
    s_waitcnt lgkmcnt(0)
    s_barrier
    s_nop 7
    buffer_load_dwordx4 v[184:187], v17, s[84:87], s76 offen sc1
    buffer_load_dwordx4 v[188:191], v10, s[84:87], s76 offen sc1
    buffer_load_dwordx4 v[192:195], v17, s[84:87], s77 offen sc1
    buffer_load_dwordx4 v[196:199], v10, s[84:87], s77 offen sc1
    buffer_load_dwordx4 v[200:203], v17, s[84:87], s78 offen sc1
    buffer_load_dwordx4 v[204:207], v10, s[84:87], s78 offen sc1
mega_kernel_rs_p2:
    s_waitcnt vmcnt(6)
    v_max3_u32 v4, v184, v188, v192
    v_max3_u32 v5, v196, v200, v204
    v_max_u32 v4, v4, v5
    v_cmp_eq_u32 vcc, -1, v4
    s_cbranch_vccnz mega_kernel_rs_p2r
    v_pk_add_f32 v[180:181], v[180:181], v[188:189]
    v_pk_add_f32 v[124:125], v[196:197], v[204:205]
    v_pk_add_f32 v[182:183], v[182:183], v[190:191]
    v_pk_add_f32 v[126:127], v[198:199], v[206:207]
    v_pk_add_f32 v[172:173], v[172:173], v[184:185]
    v_pk_add_f32 v[120:121], v[192:193], v[200:201]
    v_pk_add_f32 v[174:175], v[174:175], v[186:187]
    v_pk_add_f32 v[122:123], v[194:195], v[202:203]
    v_pk_add_f32 v[180:181], v[180:181], v[124:125]
    v_pk_add_f32 v[182:183], v[182:183], v[126:127]
    v_pk_add_f32 v[172:173], v[172:173], v[120:121]
    v_pk_add_f32 v[174:175], v[174:175], v[122:123]
    v_cndmask_b32 v176, v23, v180, s[42:43]
    v_cndmask_b32 v177, v23, v181, s[42:43]
    v_cndmask_b32 v178, v23, v182, s[42:43]
    v_cndmask_b32 v179, v23, v183, s[42:43]
    v_max3_f32 v232, v172, v173, v174
    v_max3_f32 v233, v176, v177, v178
    v_max3_f32 v232, v232, v175, v179
    v_max_f32 v234, v232, v233
    s_barrier
    ds_read2_b64 v[208:211], v21 offset0:0 offset1:32
    v_max_f32_dpp v232, v234, v234 row_ror:8 row_mask:0xf bank_mask:0xf
    v_max_f32_dpp v233, v234, v234 row_ror:8 row_mask:0xf bank_mask:0xf
    s_nop 1
    v_permlane16_swap_b32 v232, v233
    s_nop 0
    v_max_f32 v234, v232, v233
    v_max_f32 v235, v232, v233
    s_nop 1
    v_permlane32_swap_b32 v234, v235
    s_nop 0
    v_max_f32 v232, v234, v235
    v_mul_f32 v232, s32, v232
    v_fma_f32 v176, v176, s32, -v232
    v_fma_f32 v177, v177, s32, -v232
    v_fma_f32 v178, v178, s32, -v232
    v_fma_f32 v179, v179, s32, -v232
    v_fma_f32 v172, v172, s32, -v232
    v_fma_f32 v173, v173, s32, -v232
    v_fma_f32 v174, v174, s32, -v232
    v_fma_f32 v175, v175, s32, -v232
    v_exp_f32 v176, v176
    v_exp_f32 v177, v177
    v_exp_f32 v178, v178
    v_exp_f32 v179, v179
    v_exp_f32 v172, v172
    v_cvt_pk_bf16_f32 v216, v176, v177
    v_cvt_pk_bf16_f32 v217, v178, v179
    v_exp_f32 v173, v173
    v_exp_f32 v174, v174
    v_mfma_f32_16x16x16_bf16 v[224:227], v[220:221], v[216:217], 0
    v_exp_f32 v175, v175
    v_cvt_pk_bf16_f32 v212, v172, v173
    s_waitcnt lgkmcnt(0)
    v_mfma_f32_16x16x16_bf16 v[120:123], v[208:209], v[216:217], 0
    v_cvt_pk_bf16_f32 v213, v174, v175
    v_mfma_f32_16x16x16_bf16 v[124:127], v[210:211], v[216:217], 0
    v_mov_b32_dpp v214, v212 row_ror:8 row_mask:0xf bank_mask:0xf
    v_mov_b32_dpp v215, v213 row_ror:8 row_mask:0xf bank_mask:0xf
    s_nop 1
    v_mfma_f32_16x16x32_bf16 v[224:227], v[220:223], v[212:215], v[224:227]
    v_mfma_f32_16x16x32_bf16 v[120:123], v[164:167], v[212:215], v[120:123]
    v_mfma_f32_16x16x32_bf16 v[124:127], v[168:171], v[212:215], v[124:127]
    s_add_u32 s29, s33, 16384
    s_nop 4
    v_rcp_f32 v234, v224
    v_rcp_f32 v235, v225
    s_nop 0
    v_pk_mul_f32 v[120:121], v[120:121], v[234:235]
    v_pk_mul_f32 v[122:123], v[122:123], v[234:235]
    v_pk_mul_f32 v[124:125], v[124:125], v[234:235]
    v_pk_mul_f32 v[126:127], v[126:127], v[234:235]
    v_cvt_pk_bf16_f32 v212, v120, v121
    v_cvt_pk_bf16_f32 v213, v122, v123
    v_cvt_pk_bf16_f32 v214, v124, v125
    v_cvt_pk_bf16_f32 v215, v126, v127
    v_min_u32 v212, -2, v212
    s_mov_b64 exec, s[40:41]
    buffer_store_dwordx4 v[212:215], v11, s[84:87], s33 offen sc1
    s_mov_b64 exec, -1
mega_kernel_rs_b3:
    s_barrier
    buffer_load_dwordx4 v[32:35], v7, s[84:87], s29 offen offset:0 sc1
    s_nop 9
    buffer_load_dwordx4 v[36:39], v7, s[84:87], s29 offen offset:1024 sc1
    s_nop 9
    buffer_load_dwordx4 v[40:43], v7, s[84:87], s29 offen offset:2048 sc1
    s_nop 9
    buffer_load_dwordx4 v[44:47], v7, s[84:87], s29 offen offset:3072 sc1
mega_kernel_rs_pc0:
    s_waitcnt vmcnt(3)
    v_cmp_eq_u32 vcc, -1, v32
    s_cbranch_vccnz mega_kernel_rs_pcr0
mega_kernel_rs_pck0:
    v_smfmac_f32_16x16x64_bf16 v[96:99], v[32:35], a[192:199], v6
    v_smfmac_f32_16x16x64_bf16 v[100:103], v[32:35], a[224:231], v6
mega_kernel_rs_pc1:
    s_waitcnt vmcnt(2)
    v_cmp_eq_u32 vcc, -1, v36
    s_cbranch_vccnz mega_kernel_rs_pcr1
mega_kernel_rs_pck1:
    v_smfmac_f32_16x16x64_bf16 v[96:99], v[36:39], a[200:207], v6
    v_smfmac_f32_16x16x64_bf16 v[100:103], v[36:39], a[232:239], v6
mega_kernel_rs_pc2:
    s_waitcnt vmcnt(1)
    v_cmp_eq_u32 vcc, -1, v40
    s_cbranch_vccnz mega_kernel_rs_pcr2
mega_kernel_rs_pck2:
    v_smfmac_f32_16x16x64_bf16 v[96:99], v[40:43], a[208:215], v6
    v_smfmac_f32_16x16x64_bf16 v[100:103], v[40:43], a[240:247], v6
mega_kernel_rs_pc3:
    s_waitcnt vmcnt(0)
    v_cmp_eq_u32 vcc, -1, v44
    s_cbranch_vccnz mega_kernel_rs_pcr3
mega_kernel_rs_pck3:
    v_smfmac_f32_16x16x64_bf16 v[96:99], v[44:47], a[216:223], v6
    v_smfmac_f32_16x16x64_bf16 v[100:103], v[44:47], a[248:255], v6
    s_nop 7
    v_permlane32_swap_b32 v96, v100
    v_permlane32_swap_b32 v97, v101
    v_permlane32_swap_b32 v98, v102
    v_permlane32_swap_b32 v99, v103
    v_pk_add_f32 v[96:97], v[96:97], v[100:101]
    v_pk_add_f32 v[98:99], v[98:99], v[102:103]
    ds_write2_b32 v18, v96, v97 offset0:0 offset1:36
    ds_write2_b32 v18, v98, v99 offset0:72 offset1:108
    s_waitcnt lgkmcnt(0)
    s_barrier
    s_cmp_lg_u32 s24, 0
    s_cbranch_scc1 mega_kernel_rs_x1
    ds_read_b128 v[120:123], v19 offset:0
    ds_read_b128 v[124:127], v19 offset:1152
    ds_read_b128 v[128:131], v19 offset:2304
    ds_read_b128 v[132:135], v19 offset:3456
    v_mov_b32 v96, 0
    v_mov_b32 v97, 0
    v_mov_b32 v98, 0
    v_mov_b32 v99, 0
    v_mov_b32 v100, 0
    v_mov_b32 v101, 0
    v_mov_b32 v102, 0
    v_mov_b32 v103, 0
    v_mov_b32 v104, 0
    v_mov_b32 v105, 0
    v_mov_b32 v106, 0
    v_mov_b32 v107, 0
    v_mov_b32 v108, 0
    v_mov_b32 v109, 0
    v_mov_b32 v110, 0
    v_mov_b32 v111, 0
    v_mov_b32 v112, 0
    v_mov_b32 v113, 0
    v_mov_b32 v114, 0
    v_mov_b32 v115, 0
    v_mov_b32 v116, 0
    v_mov_b32 v117, 0
    v_mov_b32 v118, 0
    v_mov_b32 v119, 0
    s_waitcnt lgkmcnt(2)
    v_pk_add_f32 v[120:121], v[120:121], v[124:125]
    v_pk_add_f32 v[122:123], v[122:123], v[126:127]
    s_waitcnt lgkmcnt(0)
    v_pk_add_f32 v[128:129], v[128:129], v[132:133]
    v_pk_add_f32 v[130:131], v[130:131], v[134:135]
    v_pk_add_f32 v[120:121], v[120:121], v[128:129]
    v_pk_add_f32 v[122:123], v[122:123], v[130:131]
    v_min_u32 v120, -2, v120
    v_min_u32 v121, -2, v121
    v_min_u32 v122, -2, v122
    v_min_u32 v123, -2, v123
    buffer_store_dwordx4 v[120:123], v12, s[84:87], s35 offen sc1
    v_mov_b32 v48, -1
    v_mov_b32 v49, -1
    v_mov_b32 v50, -1
    v_mov_b32 v51, -1
    v_mov_b32 v52, -1
    v_mov_b32 v53, -1
    v_mov_b32 v54, -1
    v_mov_b32 v55, -1
    v_mov_b32 v56, -1
    v_mov_b32 v57, -1
    v_mov_b32 v58, -1
    v_mov_b32 v59, -1
    s_nop 15
    s_nop 7
mega_kernel_rs_p4:
    buffer_load_dwordx4 v[48:51], v25, s[84:87], s35 offen sc1
    buffer_load_dwordx4 v[52:55], v26, s[84:87], s35 offen sc1
    buffer_load_dwordx4 v[56:59], v27, s[84:87], s35 offen sc1
    s_waitcnt vmcnt(36)
    s_nop 1
    v_max3_u32 v4, v48, v49, v50
    v_max3_u32 v5, v54, v55, v56
    v_max3_u32 v4, v4, v51, v52
    v_max3_u32 v5, v5, v57, v58
    v_max_u32 v4, v4, v53
    v_max_u32 v5, v5, v59
    v_max_u32 v4, v4, v5
    v_cmp_eq_u32 vcc, -1, v4
    s_cbranch_vccz mega_kernel_rs_p4d
    s_branch mega_kernel_rs_p4
mega_kernel_rs_p4d:
    v_pk_add_f32 v[120:121], v[120:121], v[48:49]
    v_pk_add_f32 v[124:125], v[52:53], v[56:57]
    v_pk_add_f32 v[122:123], v[122:123], v[50:51]
    v_pk_add_f32 v[126:127], v[54:55], v[58:59]
    v_pk_add_f32 v[120:121], v[120:121], v[124:125]
    v_pk_add_f32 v[122:123], v[122:123], v[126:127]
    v_cvt_pk_bf16_f32 v212, v120, v121
    v_cvt_pk_bf16_f32 v213, v122, v123
    v_min_u32 v212, -2, v212
    buffer_store_dwordx2 v[212:213], v9, s[84:87], s34 offen sc1
mega_kernel_rs_b5:
    s_add_u32 s27, s27, 1
    s_add_u32 s44, s44, 4096
    s_cmp_eq_u32 s44, 30720
    s_cselect_b32 s44, 18432, s44
    s_barrier
    s_and_b32 s29, s27, 1
    s_lshl_b32 s33, s29, 17
    s_lshl_b32 s28, s30, 18
    s_add_u32 s33, s33, s28
    s_add_u32 s33, s33, 69206016
    s_xor_b32 s34, s33, 131072
    s_add_u32 s28, s27, s31
    s_and_b32 s29, s28, 1
    s_lshl_b32 s35, s29, 12
    s_and_b32 s28, s28, 14
    s_and_b32 s29, s27, 48
    s_or_b32 s28, s28, s29
    s_lshl_b32 s28, s28, 13
    s_add_u32 s35, s35, s28
    s_branch mega_kernel_rs_loop
mega_kernel_rs_x1:
    s_cmp_eq_u32 s24, 3
    s_cbranch_scc0 mega_kernel_rs_x4
    buffer_store_dwordx2 v[28:29], v9, s[84:87], s33 offen sc1
    s_lshl_b32 s28, s31, 11
    s_add_u32 s28, s28, s33
    s_add_u32 s28, s28, 32768
    buffer_store_dwordx4 v[28:31], v17, s[84:87], s28 offen sc1
    buffer_store_dwordx4 v[28:31], v10, s[84:87], s28 offen sc1
    s_add_u32 s76, s27, 3
    s_cmp_lt_u32 s76, 63
    s_cbranch_scc0 mega_kernel_rs_x4
    s_add_u32 s77, s76, s82
    s_bfe_u32 s28, s77, 0x40002
    s_lshl_b32 s28, s28, 14
    s_and_b32 s77, s77, 3
    s_lshl_b32 s77, s77, 11
    s_add_u32 s28, s28, s77
    s_add_u32 s28, s28, s83
    s_add_u32 s28, s28, 33554432
    s_buffer_load_dword s78, s[84:87], s28 offset:0
    s_buffer_load_dword s78, s[84:87], s28 offset:128
    s_buffer_load_dword s78, s[84:87], s28 offset:256
    s_buffer_load_dword s78, s[84:87], s28 offset:384
    s_buffer_load_dword s78, s[84:87], s28 offset:512
    s_buffer_load_dword s78, s[84:87], s28 offset:640
    s_buffer_load_dword s78, s[84:87], s28 offset:768
    s_buffer_load_dword s78, s[84:87], s28 offset:896
    s_buffer_load_dword s78, s[84:87], s28 offset:1024
    s_buffer_load_dword s78, s[84:87], s28 offset:1152
    s_buffer_load_dword s78, s[84:87], s28 offset:1280
    s_buffer_load_dword s78, s[84:87], s28 offset:1408
    s_buffer_load_dword s78, s[84:87], s28 offset:1536
    s_buffer_load_dword s78, s[84:87], s28 offset:1664
    s_buffer_load_dword s78, s[84:87], s28 offset:1792
    s_buffer_load_dword s78, s[84:87], s28 offset:1920
mega_kernel_rs_x4:
    v_mov_b32 v96, 0
    v_mov_b32 v97, 0
    v_mov_b32 v98, 0
    v_mov_b32 v99, 0
    v_mov_b32 v100, 0
    v_mov_b32 v101, 0
    v_mov_b32 v102, 0
    v_mov_b32 v103, 0
    v_mov_b32 v104, 0
    v_mov_b32 v105, 0
    v_mov_b32 v106, 0
    v_mov_b32 v107, 0
    v_mov_b32 v108, 0
    v_mov_b32 v109, 0
    v_mov_b32 v110, 0
    v_mov_b32 v111, 0
    v_mov_b32 v112, 0
    v_mov_b32 v113, 0
    v_mov_b32 v114, 0
    v_mov_b32 v115, 0
    v_mov_b32 v116, 0
    v_mov_b32 v117, 0
    v_mov_b32 v118, 0
    v_mov_b32 v119, 0
    s_branch mega_kernel_rs_b5
mega_kernel_rs_p2r:
    buffer_load_dwordx4 v[184:187], v17, s[84:87], s76 offen sc1
    buffer_load_dwordx4 v[188:191], v10, s[84:87], s76 offen sc1
    buffer_load_dwordx4 v[192:195], v17, s[84:87], s77 offen sc1
    buffer_load_dwordx4 v[196:199], v10, s[84:87], s77 offen sc1
    buffer_load_dwordx4 v[200:203], v17, s[84:87], s78 offen sc1
    buffer_load_dwordx4 v[204:207], v10, s[84:87], s78 offen sc1
    s_branch mega_kernel_rs_p2
mega_kernel_rs_par0:
    buffer_load_dwordx4 v[32:35], v7, s[84:87], s33 offen offset:0 sc1
    buffer_load_dwordx4 v[36:39], v7, s[84:87], s33 offen offset:1024 sc1
    buffer_load_dwordx4 v[40:43], v7, s[84:87], s33 offen offset:2048 sc1
    buffer_load_dwordx4 v[44:47], v7, s[84:87], s33 offen offset:3072 sc1
    s_branch mega_kernel_rs_pa0
mega_kernel_rs_par1:
    buffer_load_dwordx4 v[36:39], v7, s[84:87], s33 offen offset:1024 sc1
    buffer_load_dwordx4 v[40:43], v7, s[84:87], s33 offen offset:2048 sc1
    buffer_load_dwordx4 v[44:47], v7, s[84:87], s33 offen offset:3072 sc1
    s_branch mega_kernel_rs_pa1
mega_kernel_rs_par2:
    buffer_load_dwordx4 v[40:43], v7, s[84:87], s33 offen offset:2048 sc1
    buffer_load_dwordx4 v[44:47], v7, s[84:87], s33 offen offset:3072 sc1
    s_branch mega_kernel_rs_pa2
mega_kernel_rs_par3:
    buffer_load_dwordx4 v[44:47], v7, s[84:87], s33 offen offset:3072 sc1
    s_branch mega_kernel_rs_pa3
mega_kernel_rs_pcr0:
    buffer_load_dwordx4 v[32:35], v7, s[84:87], s29 offen offset:0 sc1
    buffer_load_dwordx4 v[36:39], v7, s[84:87], s29 offen offset:1024 sc1
    buffer_load_dwordx4 v[40:43], v7, s[84:87], s29 offen offset:2048 sc1
    buffer_load_dwordx4 v[44:47], v7, s[84:87], s29 offen offset:3072 sc1
    s_branch mega_kernel_rs_pc0
mega_kernel_rs_pcr1:
    buffer_load_dwordx4 v[36:39], v7, s[84:87], s29 offen offset:1024 sc1
    buffer_load_dwordx4 v[40:43], v7, s[84:87], s29 offen offset:2048 sc1
    buffer_load_dwordx4 v[44:47], v7, s[84:87], s29 offen offset:3072 sc1
    s_branch mega_kernel_rs_pc1
mega_kernel_rs_pcr2:
    buffer_load_dwordx4 v[40:43], v7, s[84:87], s29 offen offset:2048 sc1
    buffer_load_dwordx4 v[44:47], v7, s[84:87], s29 offen offset:3072 sc1
    s_branch mega_kernel_rs_pc2
mega_kernel_rs_pcr3:
    buffer_load_dwordx4 v[44:47], v7, s[84:87], s29 offen offset:3072 sc1
    s_branch mega_kernel_rs_pc3
mega_kernel_rs_w0last:
    s_nop 7
    v_permlane32_swap_b32 v112, v116
    v_permlane32_swap_b32 v113, v117
    v_permlane32_swap_b32 v114, v118
    v_permlane32_swap_b32 v115, v119
    v_pk_add_f32 v[112:113], v[112:113], v[116:117]
    v_pk_add_f32 v[114:115], v[114:115], v[118:119]
    ds_write_b128 v20, v[112:115]
    s_waitcnt lgkmcnt(0)
    s_barrier
    s_branch mega_kernel_rs_end
mega_kernel_rs_side:
    s_cmp_eq_u32 s24, 3
    s_cbranch_scc1 mega_kernel_rs_sd3
    s_cmp_eq_u32 s24, 2
    s_cbranch_scc0 mega_kernel_rs_sd4
    s_mov_b64 exec, s[40:41]
    buffer_store_dwordx4 v[28:31], v11, s[84:87], s34 offen sc1
    s_mov_b64 exec, -1
    s_branch mega_kernel_rs_sd4
    mega_kernel_rs_sd3:
    s_add_u32 s76, s27, 2
    s_cmp_lt_u32 s76, 63
    s_cbranch_scc0 mega_kernel_rs_sd4
    s_add_u32 s77, s76, s82
    s_bfe_u32 s28, s77, 0x40002
    s_lshl_b32 s28, s28, 14
    s_and_b32 s77, s77, 3
    s_lshl_b32 s77, s77, 11
    s_add_u32 s28, s28, s77
    s_add_u32 m0, s45, 0
    s_nop 0
    buffer_load_dwordx4 v240, s[84:87], s28 offen offset:0 sc1 lds
    s_add_u32 m0, s45, 0
    s_nop 0
    buffer_load_dwordx4 v240, s[84:87], s28 offen offset:1024 sc1 lds
    s_add_u32 m0, s45, 2048
    s_nop 0
    buffer_load_dwordx4 v241, s[84:87], s28 offen offset:0 sc1 lds
    s_add_u32 m0, s45, 2048
    s_nop 0
    buffer_load_dwordx4 v241, s[84:87], s28 offen offset:1024 sc1 lds
    s_add_u32 s45, s45, 4096
    s_cmp_eq_u32 s45, 30720
    s_cselect_b32 s45, 18432, s45
mega_kernel_rs_sd4:
    v_smfmac_f32_16x16x64_bf16 v[112:115], v[40:43], a[144:151], v6
    v_smfmac_f32_16x16x64_bf16 v[116:119], v[40:43], a[176:183], v6
    v_smfmac_f32_16x16x64_bf16 v[112:115], v[44:47], a[152:159], v6
    v_smfmac_f32_16x16x64_bf16 v[116:119], v[44:47], a[184:191], v6
    s_nop 7
    v_permlane32_swap_b32 v112, v116
    v_permlane32_swap_b32 v113, v117
    v_permlane32_swap_b32 v114, v118
    v_permlane32_swap_b32 v115, v119
    v_pk_add_f32 v[112:113], v[112:113], v[116:117]
    v_pk_add_f32 v[114:115], v[114:115], v[118:119]
    ds_write_b128 v20, v[112:115]
    v_mov_b32 v96, 0
    v_mov_b32 v97, 0
    v_mov_b32 v98, 0
    v_mov_b32 v99, 0
    v_mov_b32 v100, 0
    v_mov_b32 v101, 0
    v_mov_b32 v102, 0
    v_mov_b32 v103, 0
    s_cmp_eq_u32 s24, 1
    s_cbranch_scc0 mega_kernel_rs_s1
    s_waitcnt lgkmcnt(0)
    ds_read_b128 v[120:123], v16 offset:0
    ds_read_b128 v[124:127], v16 offset:16
    ds_read_b128 v[128:131], v16 offset:2304
    ds_read_b128 v[132:135], v16 offset:2320
    ds_read_b128 v[136:139], v16 offset:4608
    ds_read_b128 v[140:143], v16 offset:4624
    ds_read_b128 v[144:147], v16 offset:6912
    ds_read_b128 v[148:151], v16 offset:6928
    s_waitcnt lgkmcnt(4)
    v_pk_add_f32 v[120:121], v[120:121], v[128:129]
    v_pk_add_f32 v[122:123], v[122:123], v[130:131]
    v_pk_add_f32 v[124:125], v[124:125], v[132:133]
    v_pk_add_f32 v[126:127], v[126:127], v[134:135]
    s_waitcnt lgkmcnt(0)
    v_pk_add_f32 v[136:137], v[136:137], v[144:145]
    v_pk_add_f32 v[138:139], v[138:139], v[146:147]
    v_pk_add_f32 v[140:141], v[140:141], v[148:149]
    v_pk_add_f32 v[142:143], v[142:143], v[150:151]
    v_pk_add_f32 v[120:121], v[120:121], v[136:137]
    v_pk_add_f32 v[122:123], v[122:123], v[138:139]
    v_pk_add_f32 v[124:125], v[124:125], v[140:141]
    v_pk_add_f32 v[126:127], v[126:127], v[142:143]
    v_cvt_pk_bf16_f32 v244, v120, v121
    v_cvt_pk_bf16_f32 v245, v122, v123
    v_cvt_pk_bf16_f32 v246, v124, v125
    v_cvt_pk_bf16_f32 v247, v126, v127
mega_kernel_rs_s1:
    v_add_u32 v5, 9216, v17
    s_waitcnt lgkmcnt(0)
    s_barrier
    s_cmp_eq_u32 s24, 2
    s_cbranch_scc0 mega_kernel_rs_s3
    ds_read_b128 v[120:123], v5 offset:0
    ds_read_b128 v[124:127], v5 offset:1024
    ds_read_b128 v[128:131], v5 offset:2048
    ds_read_b128 v[132:135], v5 offset:3072
    v_lshrrev_b32 v5, 1, v17
    s_waitcnt lgkmcnt(2)
    v_pk_add_f32 v[120:121], v[120:121], v[124:125]
    v_pk_add_f32 v[122:123], v[122:123], v[126:127]
    s_waitcnt lgkmcnt(0)
    v_pk_add_f32 v[128:129], v[128:129], v[132:133]
    v_pk_add_f32 v[130:131], v[130:131], v[134:135]
    v_pk_add_f32 v[120:121], v[120:121], v[128:129]
    v_pk_add_f32 v[122:123], v[122:123], v[130:131]
    v_cvt_pk_bf16_f32 v244, v120, v121
    v_cvt_pk_bf16_f32 v245, v122, v123
    ds_write_b64 v5, v[244:245] offset:17920
    s_waitcnt lgkmcnt(0)
mega_kernel_rs_s3:
    s_cmp_eq_u32 s27, 63
    s_cbranch_scc1 mega_kernel_rs_slast
    s_add_u32 s29, s33, 16384
    s_barrier
    s_cmp_eq_u32 s24, 3
    s_cbranch_scc1 mega_kernel_rs_y3
    s_add_u32 s77, s27, s82
    s_bfe_u32 s28, s77, 0x30003
    s_lshl_b32 s28, s28, 14
    s_and_b32 s77, s77, 7
    s_lshl_b32 s77, s77, 10
    s_add_u32 s28, s28, s77
    s_add_u32 s28, s28, s79
    s_cmp_eq_u32 s24, 2
    s_cbranch_scc1 mega_kernel_rs_kv2a
    s_mov_b64 exec, s[48:49]
    buffer_store_dwordx4 v[244:247], v22, s[84:87], s28 offen sc1
    s_mov_b64 exec, -1
    s_branch mega_kernel_rs_kvda
    mega_kernel_rs_kv2a:
    v_lshlrev_b32 v4, 3, v1
    buffer_store_dwordx2 v[244:245], v4, s[84:87], s28 offen offset:512 sc1
    mega_kernel_rs_kvda:
    s_and_b32 s76, s27, 3
    s_cmp_ge_u32 s27, 60
    s_cselect_b32 s76, 0, s76
    s_cmp_eq_u32 s76, 0
    s_cbranch_scc0 mega_kernel_rs_y4
    v_mov_b32 v5, s27
    s_mov_b64 exec, 1
    buffer_store_dword v5, v228, s[84:87], s81 offen sc1
    s_mov_b64 exec, -1
    s_branch mega_kernel_rs_y4
mega_kernel_rs_y3:
    s_add_u32 s76, s27, 3
    s_cmp_lt_u32 s76, 63
    s_cbranch_scc0 mega_kernel_rs_y4
    s_cmp_gt_i32 s46, s76
    s_cbranch_scc1 mega_kernel_rs_pf6ok
    mega_kernel_rs_pf6w:
    buffer_load_dword v4, v24, s[84:87], 0 offen sc1
    s_waitcnt vmcnt(0)
    v_readlane_b32 s46, v4, 0
    v_readlane_b32 s28, v4, 1
    s_nop 1
    s_min_i32 s46, s46, s28
    s_cmp_gt_i32 s46, s76
    s_cbranch_scc0 mega_kernel_rs_pf6w
    mega_kernel_rs_pf6ok:
    s_add_u32 s77, s76, s82
    s_bfe_u32 s28, s77, 0x40002
    s_lshl_b32 s28, s28, 14
    s_and_b32 s77, s77, 3
    s_lshl_b32 s77, s77, 11
    s_add_u32 s28, s28, s77
    s_add_u32 s28, s28, s83
    s_buffer_load_dword s78, s[84:87], s28 offset:0
    s_buffer_load_dword s78, s[84:87], s28 offset:128
    s_buffer_load_dword s78, s[84:87], s28 offset:256
    s_buffer_load_dword s78, s[84:87], s28 offset:384
    s_buffer_load_dword s78, s[84:87], s28 offset:512
    s_buffer_load_dword s78, s[84:87], s28 offset:640
    s_buffer_load_dword s78, s[84:87], s28 offset:768
    s_buffer_load_dword s78, s[84:87], s28 offset:896
    s_buffer_load_dword s78, s[84:87], s28 offset:1024
    s_buffer_load_dword s78, s[84:87], s28 offset:1152
    s_buffer_load_dword s78, s[84:87], s28 offset:1280
    s_buffer_load_dword s78, s[84:87], s28 offset:1408
    s_buffer_load_dword s78, s[84:87], s28 offset:1536
    s_buffer_load_dword s78, s[84:87], s28 offset:1664
    s_buffer_load_dword s78, s[84:87], s28 offset:1792
    s_buffer_load_dword s78, s[84:87], s28 offset:1920
mega_kernel_rs_y4:
    s_branch mega_kernel_rs_b3
mega_kernel_rs_first:
    buffer_load_dwordx4 v[32:35], v8, s[20:23], 0 offen offset:0
    buffer_load_dwordx4 v[36:39], v8, s[20:23], 0 offen offset:128
    buffer_load_dwordx4 v[40:43], v8, s[20:23], 0 offen offset:256
    buffer_load_dwordx4 v[44:47], v8, s[20:23], 0 offen offset:384
    v_add_u32 v5, s44, v17
    ds_read_b128 v[156:159], v5 offset:0
    ds_read_b128 v[160:163], v5 offset:1024
    ds_read_b128 v[164:167], v5 offset:2048
    ds_read_b128 v[168:171], v5 offset:3072
    s_waitcnt vmcnt(0)
    v_smfmac_f32_16x16x64_bf16 v[96:99], v[32:35], a[0:7], v6
    v_smfmac_f32_16x16x64_bf16 v[100:103], v[32:35], a[32:39], v6
    v_smfmac_f32_16x16x64_bf16 v[104:107], v[32:35], a[64:71], v6
    v_smfmac_f32_16x16x64_bf16 v[108:111], v[32:35], a[96:103], v6
    v_smfmac_f32_16x16x64_bf16 v[96:99], v[36:39], a[8:15], v6
    v_smfmac_f32_16x16x64_bf16 v[100:103], v[36:39], a[40:47], v6
    v_smfmac_f32_16x16x64_bf16 v[104:107], v[36:39], a[72:79], v6
    v_smfmac_f32_16x16x64_bf16 v[108:111], v[36:39], a[104:111], v6
    v_smfmac_f32_16x16x64_bf16 v[96:99], v[40:43], a[16:23], v6
    v_smfmac_f32_16x16x64_bf16 v[100:103], v[40:43], a[48:55], v6
    v_smfmac_f32_16x16x64_bf16 v[104:107], v[40:43], a[80:87], v6
    v_smfmac_f32_16x16x64_bf16 v[108:111], v[40:43], a[112:119], v6
    v_smfmac_f32_16x16x64_bf16 v[96:99], v[44:47], a[24:31], v6
    v_smfmac_f32_16x16x64_bf16 v[100:103], v[44:47], a[56:63], v6
    v_smfmac_f32_16x16x64_bf16 v[104:107], v[44:47], a[88:95], v6
    v_smfmac_f32_16x16x64_bf16 v[108:111], v[44:47], a[120:127], v6
    s_nop 1
    s_branch mega_kernel_rs_adone
mega_kernel_rs_slast:
    s_cmp_eq_u32 s24, 3
    s_cbranch_scc1 mega_kernel_rs_end
    s_add_u32 s77, s27, s82
    s_bfe_u32 s28, s77, 0x30003
    s_lshl_b32 s28, s28, 14
    s_and_b32 s77, s77, 7
    s_lshl_b32 s77, s77, 10
    s_add_u32 s28, s28, s77
    s_add_u32 s28, s28, s79
    s_cmp_eq_u32 s24, 2
    s_cbranch_scc1 mega_kernel_rs_kv2b
    s_mov_b64 exec, s[48:49]
    buffer_store_dwordx4 v[244:247], v22, s[84:87], s28 offen sc1
    s_mov_b64 exec, -1
    s_branch mega_kernel_rs_kvdb
    mega_kernel_rs_kv2b:
    v_lshlrev_b32 v4, 3, v1
    buffer_store_dwordx2 v[244:245], v4, s[84:87], s28 offen offset:512 sc1
    mega_kernel_rs_kvdb:
    s_waitcnt vmcnt(0)
    s_mov_b32 s76, 64
    v_mov_b32 v5, s76
    s_mov_b64 exec, 1
    buffer_store_dword v5, v228, s[84:87], s81 offen sc1
    s_mov_b64 exec, -1
mega_kernel_rs_end:
    s_endpgm
.section .rodata,"a"
.p2align 6
.amdhsa_kernel mega_kernel
  .amdhsa_next_free_vgpr 512
  .amdhsa_next_free_sgpr 102
  .amdhsa_accum_offset 256
  .amdhsa_group_segment_fixed_size 0
  .amdhsa_kernarg_size 104
  .amdhsa_user_sgpr_count 2
  .amdhsa_user_sgpr_kernarg_segment_ptr 1
  .amdhsa_system_sgpr_workgroup_id_x 1
.end_amdhsa_kernel
```

```asm
; @launch kernel=mega_kernel grid=(256,1,1) block=(256,1,1) lds=163840
.amdgcn_target "amdgcn-amd-amdhsa--gfx950"
.text
.globl mega_kernel
.p2align 8
.type mega_kernel,@function
mega_kernel:
    s_cmp_ge_u32 s2, 256
    s_cbranch_scc1 mega_kernel_exit
    s_load_dwordx2 s[84:85], s[0:1], 96
    s_load_dwordx2 s[72:73], s[0:1], 88
    s_getreg_b32 s90, hwreg(HW_REG_XCC_ID)
    s_and_b32 s90, s90, 7
    v_mov_b32 v1, 0
    v_mov_b32 v2, 1
    s_lshl_b32 s91, s90, 4
    s_mov_b32 s95, 0
    s_mov_b32 s99, 0
    s_waitcnt lgkmcnt(0)
    s_mov_b32 s86, 268435456
    s_mov_b32 s87, 0x00020000
    s_mov_b32 s74, 256
    s_mov_b32 s75, 0x00020000
    v_cmp_eq_u32 vcc, 0, v0
    s_and_saveexec_b64 s[88:89], vcc
    s_cbranch_execz mega_kernel_tkd
    s_lshl_b32 s92, s2, 13
    s_add_u32 s92, s92, 167772160
    buffer_atomic_add v2, v1, s[72:75], s91 offen sc0
    buffer_load_dword v251, v1, s[84:87], s92 offen offset:2048 sc1
    s_waitcnt vmcnt(1)
    ds_write_b32 v1, v2
    s_waitcnt lgkmcnt(0)
    mega_kernel_tkd:
    s_mov_b64 exec, s[88:89]
    s_barrier
    ds_read_b32 v2, v1
    s_waitcnt lgkmcnt(0)
    v_readfirstlane_b32 s96, v2
    s_barrier
    s_cmp_lt_u32 s96, 32
    s_cbranch_scc1 mega_kernel_spec
    v_and_b32 v3, 15, v0
    v_lshlrev_b32 v3, 4, v3
    s_branch mega_kernel_syx
    mega_kernel_syxw:
    s_sleep 4
    mega_kernel_syx:
    buffer_load_dword v2, v3, s[72:75], 0 offen sc1
    s_waitcnt vmcnt(0)
    s_cmp_eq_u32 s95, 1
    s_cbranch_scc0 mega_kernel_syxf
    v_readlane_b32 s76, v2, 14
    s_mov_b32 s98, 0
    s_cmp_eq_u32 s76, 64
    s_cbranch_scc0 mega_kernel_syxw
    s_branch mega_kernel_syxd
    mega_kernel_syxf:
    s_mov_b32 s77, 0
    s_mov_b32 s78, 0
    v_readlane_b32 s76, v2, 0
    s_add_u32 s77, s77, s76
    s_xor_b32 s76, s76, 32
    s_or_b32 s78, s78, s76
    v_readlane_b32 s76, v2, 1
    s_add_u32 s77, s77, s76
    s_xor_b32 s76, s76, 32
    s_or_b32 s78, s78, s76
    v_readlane_b32 s76, v2, 2
    s_add_u32 s77, s77, s76
    s_xor_b32 s76, s76, 32
    s_or_b32 s78, s78, s76
    v_readlane_b32 s76, v2, 3
    s_add_u32 s77, s77, s76
    s_xor_b32 s76, s76, 32
    s_or_b32 s78, s78, s76
    v_readlane_b32 s76, v2, 4
    s_add_u32 s77, s77, s76
    s_xor_b32 s76, s76, 32
    s_or_b32 s78, s78, s76
    v_readlane_b32 s76, v2, 5
    s_add_u32 s77, s77, s76
    s_xor_b32 s76, s76, 32
    s_or_b32 s78, s78, s76
    v_readlane_b32 s76, v2, 6
    s_add_u32 s77, s77, s76
    s_xor_b32 s76, s76, 32
    s_or_b32 s78, s78, s76
    v_readlane_b32 s76, v2, 7
    s_add_u32 s77, s77, s76
    s_xor_b32 s76, s76, 32
    s_or_b32 s78, s78, s76
    s_cmp_eq_u32 s77, 256
    s_cbranch_scc0 mega_kernel_syxw
    v_mov_b32 v252, v2
    s_cmp_eq_u32 s78, 0
    s_cbranch_scc0 mega_kernel_slowent
    v_readlane_b32 s76, v2, 10
    v_readlane_b32 s77, v2, 8
    s_cmp_eq_u32 s76, 64
    s_cbranch_scc0 mega_kernel_syxw
    s_cmp_gt_u32 s77, 32
    s_cselect_b32 s98, 1, 0
    mega_kernel_syxd:
mega_kernel_slowent:
    s_mov_b64 exec, -1
    s_waitcnt vmcnt(0) lgkmcnt(0)
    s_barrier
    s_mov_b32 s97, s96
    v_readlane_b32 s76, v252, 0
    s_cmp_gt_u32 s90, 0
    s_cselect_b32 s76, s76, 0
    s_add_u32 s97, s97, s76
    v_readlane_b32 s76, v252, 1
    s_cmp_gt_u32 s90, 1
    s_cselect_b32 s76, s76, 0
    s_add_u32 s97, s97, s76
    v_readlane_b32 s76, v252, 2
    s_cmp_gt_u32 s90, 2
    s_cselect_b32 s76, s76, 0
    s_add_u32 s97, s97, s76
    v_readlane_b32 s76, v252, 3
    s_cmp_gt_u32 s90, 3
    s_cselect_b32 s76, s76, 0
    s_add_u32 s97, s97, s76
    v_readlane_b32 s76, v252, 4
    s_cmp_gt_u32 s90, 4
    s_cselect_b32 s76, s76, 0
    s_add_u32 s97, s97, s76
    v_readlane_b32 s76, v252, 5
    s_cmp_gt_u32 s90, 5
    s_cselect_b32 s76, s76, 0
    s_add_u32 s97, s97, s76
    v_readlane_b32 s76, v252, 6
    s_cmp_gt_u32 s90, 6
    s_cselect_b32 s76, s76, 0
    s_add_u32 s97, s97, s76
    v_mov_b32 v1, 0
    v_mov_b32 v2, 1
    v_cmp_eq_u32 vcc, 0, v0
    s_and_saveexec_b64 s[88:89], vcc
    s_cbranch_execz mega_kernel_sb1
    buffer_atomic_add v2, v1, s[72:75], 0 offen offset:192 sc1
    mega_kernel_sb1:
    s_mov_b64 exec, s[88:89]
    mega_kernel_sb2:
    s_sleep 4
    buffer_load_dword v2, v1, s[72:75], 0 offen offset:192 sc1
    s_waitcnt vmcnt(0)
    v_cmp_ne_u32 vcc, 256, v2
    s_cbranch_vccnz mega_kernel_sb2
    s_mov_b32 s95, 1
    s_lshr_b32 s30, s97, 5
    s_and_b32 s31, s97, 31
    s_cmp_lt_u32 s97, 128
    s_cbranch_scc1 mega_kernel_recs
    s_sub_u32 s94, s97, 128
    s_branch mega_kernel_bulk
    mega_kernel_spec:
    s_mov_b32 s30, s90
    s_mov_b32 s31, s96
    s_cmp_lt_u32 s90, 4
    s_cbranch_scc1 mega_kernel_recf
    s_sub_u32 s94, s90, 4
    s_lshl_b32 s94, s94, 5
    s_add_u32 s94, s94, s96
    mega_kernel_bulk:
    s_lshr_b32 s91, s94, 5
    s_and_b32 s40, s94, 31
    s_and_b32 s92, s91, 1
    s_lshl_b32 s92, s92, 5
    s_add_u32 s92, s92, s40
    s_cmp_eq_u32 s91, 0
    s_cbranch_scc1 mega_kernel_rk
    s_cmp_eq_u32 s91, 1
    s_cbranch_scc1 mega_kernel_rv
    v_mov_b32 v8, -1
    v_mov_b32 v9, -1
    v_mov_b32 v10, -1
    v_mov_b32 v11, -1
    v_lshlrev_b32 v1, 4, v0
    v_mov_b32 v2, 0
    v_cmp_gt_u32 vcc, 64, v0
    s_cbranch_vccz mega_kernel_nv
    s_cmp_eq_u32 s95, 0
    s_cbranch_scc0 mega_kernel_nv
    s_lshr_b32 s60, s2, 1
    s_lshl_b32 s60, s60, 14
    s_and_b32 s61, s92, 1
    s_lshl_b32 s66, s61, 13
    s_add_u32 s60, s60, s66
    s_and_b32 s66, s2, 1
    s_lshl_b32 s66, s66, 10
    s_add_u32 s60, s60, s66
    s_add_u32 s60, s60, 167772160
    s_mov_b32 s66, 0x7fffffff
    s_mov_b32 s67, 0x7fffffff
    s_waitcnt vmcnt(0)
    s_memtime s[62:63]
    s_waitcnt lgkmcnt(0)
    buffer_load_dword v3, v2, s[84:87], s60 offen offset:0 sc1
    s_waitcnt vmcnt(0)
    s_memtime s[64:65]
    s_xor_b32 s60, s60, 8192
    s_waitcnt lgkmcnt(0)
    s_sub_u32 s64, s64, s62
    s_min_u32 s66, s66, s64
    s_memtime s[62:63]
    s_waitcnt lgkmcnt(0)
    buffer_load_dword v3, v2, s[84:87], s60 offen offset:0 sc1
    s_waitcnt vmcnt(0)
    s_memtime s[64:65]
    s_xor_b32 s60, s60, 8192
    s_waitcnt lgkmcnt(0)
    s_sub_u32 s64, s64, s62
    s_min_u32 s67, s67, s64
    s_memtime s[62:63]
    s_waitcnt lgkmcnt(0)
    buffer_load_dword v3, v2, s[84:87], s60 offen offset:256 sc1
    s_waitcnt vmcnt(0)
    s_memtime s[64:65]
    s_xor_b32 s60, s60, 8192
    s_waitcnt lgkmcnt(0)
    s_sub_u32 s64, s64, s62
    s_min_u32 s66, s66, s64
    s_memtime s[62:63]
    s_waitcnt lgkmcnt(0)
    buffer_load_dword v3, v2, s[84:87], s60 offen offset:256 sc1
    s_waitcnt vmcnt(0)
    s_memtime s[64:65]
    s_xor_b32 s60, s60, 8192
    s_waitcnt lgkmcnt(0)
    s_sub_u32 s64, s64, s62
    s_min_u32 s67, s67, s64
    s_cmp_lt_u32 s67, s66
    s_cselect_b32 s60, 1, 0
    s_xor_b32 s60, s60, s61
    s_lshr_b32 s61, s90, 2
    s_xor_b32 s60, s60, s61
    v_mov_b32 v3, s60
    s_mov_b64 exec, 1
    buffer_atomic_add v3, v2, s[72:75], 0 offen offset:128 sc1
    s_mov_b64 exec, -1
    mega_kernel_nv:
    s_barrier
    s_lshl_b32 s60, s92, 12
    s_add_u32 s60, s60, 67108864
    buffer_store_dwordx4 v[8:11], v1, s[84:87], s60 offen sc1
    s_add_u32 s60, s60, 262144
    buffer_store_dwordx4 v[8:11], v1, s[84:87], s60 offen sc1
    s_add_u32 s60, s60, 262144
    buffer_store_dwordx4 v[8:11], v1, s[84:87], s60 offen sc1
    s_add_u32 s60, s60, 262144
    buffer_store_dwordx4 v[8:11], v1, s[84:87], s60 offen sc1
    s_add_u32 s60, s60, 262144
    buffer_store_dwordx4 v[8:11], v1, s[84:87], s60 offen sc1
    s_add_u32 s60, s60, 262144
    buffer_store_dwordx4 v[8:11], v1, s[84:87], s60 offen sc1
    s_add_u32 s60, s60, 262144
    buffer_store_dwordx4 v[8:11], v1, s[84:87], s60 offen sc1
    s_add_u32 s60, s60, 262144
    buffer_store_dwordx4 v[8:11], v1, s[84:87], s60 offen sc1
    s_add_u32 s60, s60, 262144
    s_cmp_lt_u32 s92, 16
    s_cbranch_scc0 mega_kernel_pz
    buffer_store_dwordx4 v[8:11], v1, s[84:87], s60 offen sc1
    mega_kernel_pz:
    s_waitcnt vmcnt(0)
    s_barrier
    v_mov_b32 v3, 1
    s_lshl_b32 s62, s95, 6
    v_cmp_eq_u32 vcc, 0, v0
    s_and_saveexec_b64 s[60:61], vcc
    s_cbranch_execz mega_kernel_xps
    buffer_atomic_add v3, v2, s[72:75], s62 offen offset:160 sc1
    mega_kernel_xps:
    s_mov_b64 exec, s[60:61]
    s_cmp_eq_u32 s91, 2
    s_cbranch_scc0 mega_kernel_rd
    v_and_b32 v3, 15, v0
    v_lshlrev_b32 v3, 4, v3
    s_branch mega_kernel_syc
    mega_kernel_sycw:
    s_sleep 4
    mega_kernel_syc:
    buffer_load_dword v2, v3, s[72:75], 0 offen sc1
    s_waitcnt vmcnt(0)
    s_cmp_eq_u32 s95, 1
    s_cbranch_scc0 mega_kernel_sycf
    v_readlane_b32 s76, v2, 14
    s_mov_b32 s98, 0
    s_cmp_eq_u32 s76, 64
    s_cbranch_scc0 mega_kernel_sycw
    s_branch mega_kernel_sycd
    mega_kernel_sycf:
    s_mov_b32 s77, 0
    s_mov_b32 s78, 0
    v_readlane_b32 s76, v2, 0
    s_add_u32 s77, s77, s76
    s_xor_b32 s76, s76, 32
    s_or_b32 s78, s78, s76
    v_readlane_b32 s76, v2, 1
    s_add_u32 s77, s77, s76
    s_xor_b32 s76, s76, 32
    s_or_b32 s78, s78, s76
    v_readlane_b32 s76, v2, 2
    s_add_u32 s77, s77, s76
    s_xor_b32 s76, s76, 32
    s_or_b32 s78, s78, s76
    v_readlane_b32 s76, v2, 3
    s_add_u32 s77, s77, s76
    s_xor_b32 s76, s76, 32
    s_or_b32 s78, s78, s76
    v_readlane_b32 s76, v2, 4
    s_add_u32 s77, s77, s76
    s_xor_b32 s76, s76, 32
    s_or_b32 s78, s78, s76
    v_readlane_b32 s76, v2, 5
    s_add_u32 s77, s77, s76
    s_xor_b32 s76, s76, 32
    s_or_b32 s78, s78, s76
    v_readlane_b32 s76, v2, 6
    s_add_u32 s77, s77, s76
    s_xor_b32 s76, s76, 32
    s_or_b32 s78, s78, s76
    v_readlane_b32 s76, v2, 7
    s_add_u32 s77, s77, s76
    s_xor_b32 s76, s76, 32
    s_or_b32 s78, s78, s76
    s_cmp_eq_u32 s77, 256
    s_cbranch_scc0 mega_kernel_sycw
    v_mov_b32 v252, v2
    s_cmp_eq_u32 s78, 0
    s_cbranch_scc0 mega_kernel_slowent
    v_readlane_b32 s76, v2, 10
    v_readlane_b32 s77, v2, 8
    s_cmp_eq_u32 s76, 64
    s_cbranch_scc0 mega_kernel_sycw
    s_cmp_gt_u32 s77, 32
    s_cselect_b32 s98, 1, 0
    mega_kernel_sycd:
    s_load_dwordx2 s[4:5], s[0:1], 16
    s_load_dwordx2 s[8:9], s[0:1], 0
    v_lshrrev_b32 v2, 6, v0
    v_and_b32 v1, 63, v0
    v_readfirstlane_b32 s41, v2
    v_lshlrev_b32 v5, 4, v1
    s_waitcnt lgkmcnt(0)
    s_mov_b32 s6, 8388608
    s_mov_b32 s7, 0x00020000
    s_mov_b32 s10, 4194304
    s_mov_b32 s11, 0x00020000
    s_lshl_b32 s43, s40, 8
    s_lshl_b32 s44, s41, 6
    s_add_u32 s48, s43, s44
    s_and_b32 s43, s48, 0x7ff
    v_add_u32 v19, s43, v1
    v_lshlrev_b32 v19, 7, v19
    buffer_load_dword v20, v19, s[8:11], 0 offen
    v_lshrrev_b32 v2, 2, v1
    v_and_b32 v3, 3, v1
    v_lshlrev_b32 v16, 13, v2
    v_lshl_add_u32 v16, v3, 4, v16
    v_add_u32 v16, s48, v16
    v_and_b32 v3, 3, v1
    s_lshl_b32 s45, s41, 15
    v_bfe_u32 v17, v1, 2, 2
    v_lshrrev_b32 v18, 5, v1
    v_mul_u32_u24 v18, 8, v18
    v_add_u32 v17, v17, v18
    v_lshlrev_b32 v17, 6, v17
    v_bfe_u32 v18, v1, 4, 1
    v_lshl_add_u32 v17, v18, 5, v17
    v_and_b32 v18, 1, v1
    v_lshl_add_u32 v17, v18, 4, v17
    v_bfe_u32 v18, v1, 1, 1
    v_lshl_add_u32 v17, v18, 3, v17
    v_add_u32 v17, s45, v17
    s_and_b32 s43, s40, 3
    s_lshl_b32 s43, s43, 2
    s_add_u32 s43, s43, s41
    s_lshl_b32 s43, s43, 4
    v_and_b32 v23, 15, v1
    v_add_u32 v23, s43, v23
    s_lshr_b32 s43, s40, 2
    s_lshl_b32 s43, s43, 10
    s_add_u32 s44, s43, 896
    s_add_u32 s43, s43, 384
    s_cmp_ge_u32 s40, 28
    s_cselect_b32 s44, s44, s43
    v_mov_b32 v24, s43
    v_mov_b32 v25, s44
    v_cmp_gt_u32 vcc, 32, v1
    s_nop 1
    v_cndmask_b32 v24, v25, v24, vcc
    v_lshl_add_u32 v23, v23, 13, v24
    s_mov_b32 s44, 0
    buffer_load_dword v22, v23, s[4:7], s44 offen
    s_add_u32 m0, s45, 0
    s_mov_b32 s44, 0
    buffer_load_dwordx4 v16, s[4:7], s44 offen lds
    s_add_u32 m0, s45, 1024
    s_mov_b32 s44, 131072
    buffer_load_dwordx4 v16, s[4:7], s44 offen lds
    s_add_u32 m0, s45, 2048
    s_mov_b32 s44, 262144
    buffer_load_dwordx4 v16, s[4:7], s44 offen lds
    s_add_u32 m0, s45, 3072
    s_mov_b32 s44, 393216
    buffer_load_dwordx4 v16, s[4:7], s44 offen lds
    s_add_u32 m0, s45, 4096
    s_mov_b32 s44, 524288
    buffer_load_dwordx4 v16, s[4:7], s44 offen lds
    s_add_u32 m0, s45, 5120
    s_mov_b32 s44, 655360
    buffer_load_dwordx4 v16, s[4:7], s44 offen lds
    s_add_u32 m0, s45, 6144
    s_mov_b32 s44, 786432
    buffer_load_dwordx4 v16, s[4:7], s44 offen lds
    s_add_u32 m0, s45, 7168
    s_mov_b32 s44, 917504
    buffer_load_dwordx4 v16, s[4:7], s44 offen lds
    s_add_u32 m0, s45, 8192
    s_mov_b32 s44, 1048576
    buffer_load_dwordx4 v16, s[4:7], s44 offen lds
    s_add_u32 m0, s45, 9216
    s_mov_b32 s44, 1179648
    buffer_load_dwordx4 v16, s[4:7], s44 offen lds
    s_add_u32 m0, s45, 10240
    s_mov_b32 s44, 1310720
    buffer_load_dwordx4 v16, s[4:7], s44 offen lds
    s_add_u32 m0, s45, 11264
    s_mov_b32 s44, 1441792
    buffer_load_dwordx4 v16, s[4:7], s44 offen lds
    s_add_u32 m0, s45, 12288
    s_mov_b32 s44, 1572864
    buffer_load_dwordx4 v16, s[4:7], s44 offen lds
    s_add_u32 m0, s45, 13312
    s_mov_b32 s44, 1703936
    buffer_load_dwordx4 v16, s[4:7], s44 offen lds
    s_add_u32 m0, s45, 14336
    s_mov_b32 s44, 1835008
    buffer_load_dwordx4 v16, s[4:7], s44 offen lds
    s_add_u32 m0, s45, 15360
    s_mov_b32 s44, 1966080
    buffer_load_dwordx4 v16, s[4:7], s44 offen lds
    s_mov_b32 s44, 2097152
    buffer_load_dword v22, v23, s[4:7], s44 offen
    s_add_u32 m0, s45, 16384
    s_mov_b32 s44, 2097152
    buffer_load_dwordx4 v16, s[4:7], s44 offen lds
    s_add_u32 m0, s45, 17408
    s_mov_b32 s44, 2228224
    buffer_load_dwordx4 v16, s[4:7], s44 offen lds
    s_add_u32 m0, s45, 18432
    s_mov_b32 s44, 2359296
    buffer_load_dwordx4 v16, s[4:7], s44 offen lds
    s_add_u32 m0, s45, 19456
    s_mov_b32 s44, 2490368
    buffer_load_dwordx4 v16, s[4:7], s44 offen lds
    s_add_u32 m0, s45, 20480
    s_mov_b32 s44, 2621440
    buffer_load_dwordx4 v16, s[4:7], s44 offen lds
    s_add_u32 m0, s45, 21504
    s_mov_b32 s44, 2752512
    buffer_load_dwordx4 v16, s[4:7], s44 offen lds
    s_add_u32 m0, s45, 22528
    s_mov_b32 s44, 2883584
    buffer_load_dwordx4 v16, s[4:7], s44 offen lds
    s_add_u32 m0, s45, 23552
    s_mov_b32 s44, 3014656
    buffer_load_dwordx4 v16, s[4:7], s44 offen lds
    s_add_u32 m0, s45, 24576
    s_mov_b32 s44, 3145728
    buffer_load_dwordx4 v16, s[4:7], s44 offen lds
    s_add_u32 m0, s45, 25600
    s_mov_b32 s44, 3276800
    buffer_load_dwordx4 v16, s[4:7], s44 offen lds
    s_add_u32 m0, s45, 26624
    s_mov_b32 s44, 3407872
    buffer_load_dwordx4 v16, s[4:7], s44 offen lds
    s_add_u32 m0, s45, 27648
    s_mov_b32 s44, 3538944
    buffer_load_dwordx4 v16, s[4:7], s44 offen lds
    s_add_u32 m0, s45, 28672
    s_mov_b32 s44, 3670016
    buffer_load_dwordx4 v16, s[4:7], s44 offen lds
    s_add_u32 m0, s45, 29696
    s_mov_b32 s44, 3801088
    buffer_load_dwordx4 v16, s[4:7], s44 offen lds
    s_add_u32 m0, s45, 30720
    s_mov_b32 s44, 3932160
    buffer_load_dwordx4 v16, s[4:7], s44 offen lds
    s_add_u32 m0, s45, 31744
    s_mov_b32 s44, 4063232
    buffer_load_dwordx4 v16, s[4:7], s44 offen lds
    s_waitcnt vmcnt(17)
    ds_read_b64_tr_b16 a[0:1], v17 offset:0
    ds_read_b64_tr_b16 a[2:3], v17 offset:256
    ds_read_b64_tr_b16 a[4:5], v17 offset:1024
    ds_read_b64_tr_b16 a[6:7], v17 offset:1280
    ds_read_b64_tr_b16 a[8:9], v17 offset:2048
    ds_read_b64_tr_b16 a[10:11], v17 offset:2304
    ds_read_b64_tr_b16 a[12:13], v17 offset:3072
    ds_read_b64_tr_b16 a[14:15], v17 offset:3328
    s_waitcnt lgkmcnt(0)
    ds_read_b64_tr_b16 a[16:17], v17 offset:4096
    ds_read_b64_tr_b16 a[18:19], v17 offset:4352
    ds_read_b64_tr_b16 a[20:21], v17 offset:5120
    ds_read_b64_tr_b16 a[22:23], v17 offset:5376
    ds_read_b64_tr_b16 a[24:25], v17 offset:6144
    ds_read_b64_tr_b16 a[26:27], v17 offset:6400
    ds_read_b64_tr_b16 a[28:29], v17 offset:7168
    ds_read_b64_tr_b16 a[30:31], v17 offset:7424
    s_waitcnt lgkmcnt(0)
    ds_read_b64_tr_b16 a[32:33], v17 offset:8192
    ds_read_b64_tr_b16 a[34:35], v17 offset:8448
    ds_read_b64_tr_b16 a[36:37], v17 offset:9216
    ds_read_b64_tr_b16 a[38:39], v17 offset:9472
    ds_read_b64_tr_b16 a[40:41], v17 offset:10240
    ds_read_b64_tr_b16 a[42:43], v17 offset:10496
    ds_read_b64_tr_b16 a[44:45], v17 offset:11264
    ds_read_b64_tr_b16 a[46:47], v17 offset:11520
    s_waitcnt lgkmcnt(0)
    ds_read_b64_tr_b16 a[48:49], v17 offset:12288
    ds_read_b64_tr_b16 a[50:51], v17 offset:12544
    ds_read_b64_tr_b16 a[52:53], v17 offset:13312
    ds_read_b64_tr_b16 a[54:55], v17 offset:13568
    ds_read_b64_tr_b16 a[56:57], v17 offset:14336
    ds_read_b64_tr_b16 a[58:59], v17 offset:14592
    ds_read_b64_tr_b16 a[60:61], v17 offset:15360
    ds_read_b64_tr_b16 a[62:63], v17 offset:15616
    s_waitcnt lgkmcnt(0)
    s_mov_b32 s44, 4194304
    buffer_load_dword v22, v23, s[4:7], s44 offen
    s_add_u32 m0, s45, 0
    s_mov_b32 s44, 4194304
    buffer_load_dwordx4 v16, s[4:7], s44 offen lds
    s_add_u32 m0, s45, 1024
    s_mov_b32 s44, 4325376
    buffer_load_dwordx4 v16, s[4:7], s44 offen lds
    s_add_u32 m0, s45, 2048
    s_mov_b32 s44, 4456448
    buffer_load_dwordx4 v16, s[4:7], s44 offen lds
    s_add_u32 m0, s45, 3072
    s_mov_b32 s44, 4587520
    buffer_load_dwordx4 v16, s[4:7], s44 offen lds
    s_add_u32 m0, s45, 4096
    s_mov_b32 s44, 4718592
    buffer_load_dwordx4 v16, s[4:7], s44 offen lds
    s_add_u32 m0, s45, 5120
    s_mov_b32 s44, 4849664
    buffer_load_dwordx4 v16, s[4:7], s44 offen lds
    s_add_u32 m0, s45, 6144
    s_mov_b32 s44, 4980736
    buffer_load_dwordx4 v16, s[4:7], s44 offen lds
    s_add_u32 m0, s45, 7168
    s_mov_b32 s44, 5111808
    buffer_load_dwordx4 v16, s[4:7], s44 offen lds
    s_add_u32 m0, s45, 8192
    s_mov_b32 s44, 5242880
    buffer_load_dwordx4 v16, s[4:7], s44 offen lds
    s_add_u32 m0, s45, 9216
    s_mov_b32 s44, 5373952
    buffer_load_dwordx4 v16, s[4:7], s44 offen lds
    s_add_u32 m0, s45, 10240
    s_mov_b32 s44, 5505024
    buffer_load_dwordx4 v16, s[4:7], s44 offen lds
    s_add_u32 m0, s45, 11264
    s_mov_b32 s44, 5636096
    buffer_load_dwordx4 v16, s[4:7], s44 offen lds
    s_add_u32 m0, s45, 12288
    s_mov_b32 s44, 5767168
    buffer_load_dwordx4 v16, s[4:7], s44 offen lds
    s_add_u32 m0, s45, 13312
    s_mov_b32 s44, 5898240
    buffer_load_dwordx4 v16, s[4:7], s44 offen lds
    s_add_u32 m0, s45, 14336
    s_mov_b32 s44, 6029312
    buffer_load_dwordx4 v16, s[4:7], s44 offen lds
    s_add_u32 m0, s45, 15360
    s_mov_b32 s44, 6160384
    buffer_load_dwordx4 v16, s[4:7], s44 offen lds
    s_waitcnt vmcnt(17)
    ds_read_b64_tr_b16 a[64:65], v17 offset:16384
    ds_read_b64_tr_b16 a[66:67], v17 offset:16640
    ds_read_b64_tr_b16 a[68:69], v17 offset:17408
    ds_read_b64_tr_b16 a[70:71], v17 offset:17664
    ds_read_b64_tr_b16 a[72:73], v17 offset:18432
    ds_read_b64_tr_b16 a[74:75], v17 offset:18688
    ds_read_b64_tr_b16 a[76:77], v17 offset:19456
    ds_read_b64_tr_b16 a[78:79], v17 offset:19712
    s_waitcnt lgkmcnt(0)
    ds_read_b64_tr_b16 a[80:81], v17 offset:20480
    ds_read_b64_tr_b16 a[82:83], v17 offset:20736
    ds_read_b64_tr_b16 a[84:85], v17 offset:21504
    ds_read_b64_tr_b16 a[86:87], v17 offset:21760
    ds_read_b64_tr_b16 a[88:89], v17 offset:22528
    ds_read_b64_tr_b16 a[90:91], v17 offset:22784
    ds_read_b64_tr_b16 a[92:93], v17 offset:23552
    ds_read_b64_tr_b16 a[94:95], v17 offset:23808
    s_waitcnt lgkmcnt(0)
    ds_read_b64_tr_b16 a[96:97], v17 offset:24576
    ds_read_b64_tr_b16 a[98:99], v17 offset:24832
    ds_read_b64_tr_b16 a[100:101], v17 offset:25600
    ds_read_b64_tr_b16 a[102:103], v17 offset:25856
    ds_read_b64_tr_b16 a[104:105], v17 offset:26624
    ds_read_b64_tr_b16 a[106:107], v17 offset:26880
    ds_read_b64_tr_b16 a[108:109], v17 offset:27648
    ds_read_b64_tr_b16 a[110:111], v17 offset:27904
    s_waitcnt lgkmcnt(0)
    ds_read_b64_tr_b16 a[112:113], v17 offset:28672
    ds_read_b64_tr_b16 a[114:115], v17 offset:28928
    ds_read_b64_tr_b16 a[116:117], v17 offset:29696
    ds_read_b64_tr_b16 a[118:119], v17 offset:29952
    ds_read_b64_tr_b16 a[120:121], v17 offset:30720
    ds_read_b64_tr_b16 a[122:123], v17 offset:30976
    ds_read_b64_tr_b16 a[124:125], v17 offset:31744
    ds_read_b64_tr_b16 a[126:127], v17 offset:32000
    s_waitcnt lgkmcnt(0)
    s_mov_b32 s44, 6291456
    buffer_load_dword v22, v23, s[4:7], s44 offen
    s_add_u32 m0, s45, 16384
    s_mov_b32 s44, 6291456
    buffer_load_dwordx4 v16, s[4:7], s44 offen lds
    s_add_u32 m0, s45, 17408
    s_mov_b32 s44, 6422528
    buffer_load_dwordx4 v16, s[4:7], s44 offen lds
    s_add_u32 m0, s45, 18432
    s_mov_b32 s44, 6553600
    buffer_load_dwordx4 v16, s[4:7], s44 offen lds
    s_add_u32 m0, s45, 19456
    s_mov_b32 s44, 6684672
    buffer_load_dwordx4 v16, s[4:7], s44 offen lds
    s_add_u32 m0, s45, 20480
    s_mov_b32 s44, 6815744
    buffer_load_dwordx4 v16, s[4:7], s44 offen lds
    s_add_u32 m0, s45, 21504
    s_mov_b32 s44, 6946816
    buffer_load_dwordx4 v16, s[4:7], s44 offen lds
    s_add_u32 m0, s45, 22528
    s_mov_b32 s44, 7077888
    buffer_load_dwordx4 v16, s[4:7], s44 offen lds
    s_add_u32 m0, s45, 23552
    s_mov_b32 s44, 7208960
    buffer_load_dwordx4 v16, s[4:7], s44 offen lds
    s_add_u32 m0, s45, 24576
    s_mov_b32 s44, 7340032
    buffer_load_dwordx4 v16, s[4:7], s44 offen lds
    s_add_u32 m0, s45, 25600
    s_mov_b32 s44, 7471104
    buffer_load_dwordx4 v16, s[4:7], s44 offen lds
    s_add_u32 m0, s45, 26624
    s_mov_b32 s44, 7602176
    buffer_load_dwordx4 v16, s[4:7], s44 offen lds
    s_add_u32 m0, s45, 27648
    s_mov_b32 s44, 7733248
    buffer_load_dwordx4 v16, s[4:7], s44 offen lds
    s_add_u32 m0, s45, 28672
    s_mov_b32 s44, 7864320
    buffer_load_dwordx4 v16, s[4:7], s44 offen lds
    s_add_u32 m0, s45, 29696
    s_mov_b32 s44, 7995392
    buffer_load_dwordx4 v16, s[4:7], s44 offen lds
    s_add_u32 m0, s45, 30720
    s_mov_b32 s44, 8126464
    buffer_load_dwordx4 v16, s[4:7], s44 offen lds
    s_add_u32 m0, s45, 31744
    s_mov_b32 s44, 8257536
    buffer_load_dwordx4 v16, s[4:7], s44 offen lds
    s_waitcnt vmcnt(16)
    ds_read_b64_tr_b16 a[128:129], v17 offset:0
    ds_read_b64_tr_b16 a[130:131], v17 offset:256
    ds_read_b64_tr_b16 a[132:133], v17 offset:1024
    ds_read_b64_tr_b16 a[134:135], v17 offset:1280
    ds_read_b64_tr_b16 a[136:137], v17 offset:2048
    ds_read_b64_tr_b16 a[138:139], v17 offset:2304
    ds_read_b64_tr_b16 a[140:141], v17 offset:3072
    ds_read_b64_tr_b16 a[142:143], v17 offset:3328
    s_waitcnt lgkmcnt(0)
    ds_read_b64_tr_b16 a[144:145], v17 offset:4096
    ds_read_b64_tr_b16 a[146:147], v17 offset:4352
    ds_read_b64_tr_b16 a[148:149], v17 offset:5120
    ds_read_b64_tr_b16 a[150:151], v17 offset:5376
    ds_read_b64_tr_b16 a[152:153], v17 offset:6144
    ds_read_b64_tr_b16 a[154:155], v17 offset:6400
    ds_read_b64_tr_b16 a[156:157], v17 offset:7168
    ds_read_b64_tr_b16 a[158:159], v17 offset:7424
    s_waitcnt lgkmcnt(0)
    ds_read_b64_tr_b16 a[160:161], v17 offset:8192
    ds_read_b64_tr_b16 a[162:163], v17 offset:8448
    ds_read_b64_tr_b16 a[164:165], v17 offset:9216
    ds_read_b64_tr_b16 a[166:167], v17 offset:9472
    ds_read_b64_tr_b16 a[168:169], v17 offset:10240
    ds_read_b64_tr_b16 a[170:171], v17 offset:10496
    ds_read_b64_tr_b16 a[172:173], v17 offset:11264
    ds_read_b64_tr_b16 a[174:175], v17 offset:11520
    s_waitcnt lgkmcnt(0)
    ds_read_b64_tr_b16 a[176:177], v17 offset:12288
    ds_read_b64_tr_b16 a[178:179], v17 offset:12544
    ds_read_b64_tr_b16 a[180:181], v17 offset:13312
    ds_read_b64_tr_b16 a[182:183], v17 offset:13568
    ds_read_b64_tr_b16 a[184:185], v17 offset:14336
    ds_read_b64_tr_b16 a[186:187], v17 offset:14592
    ds_read_b64_tr_b16 a[188:189], v17 offset:15360
    ds_read_b64_tr_b16 a[190:191], v17 offset:15616
    s_waitcnt lgkmcnt(0)
    s_waitcnt vmcnt(0)
    ds_read_b64_tr_b16 a[192:193], v17 offset:16384
    ds_read_b64_tr_b16 a[194:195], v17 offset:16640
    ds_read_b64_tr_b16 a[196:197], v17 offset:17408
    ds_read_b64_tr_b16 a[198:199], v17 offset:17664
    ds_read_b64_tr_b16 a[200:201], v17 offset:18432
    ds_read_b64_tr_b16 a[202:203], v17 offset:18688
    ds_read_b64_tr_b16 a[204:205], v17 offset:19456
    ds_read_b64_tr_b16 a[206:207], v17 offset:19712
    s_waitcnt lgkmcnt(0)
    ds_read_b64_tr_b16 a[208:209], v17 offset:20480
    ds_read_b64_tr_b16 a[210:211], v17 offset:20736
    ds_read_b64_tr_b16 a[212:213], v17 offset:21504
    ds_read_b64_tr_b16 a[214:215], v17 offset:21760
    ds_read_b64_tr_b16 a[216:217], v17 offset:22528
    ds_read_b64_tr_b16 a[218:219], v17 offset:22784
    ds_read_b64_tr_b16 a[220:221], v17 offset:23552
    ds_read_b64_tr_b16 a[222:223], v17 offset:23808
    s_waitcnt lgkmcnt(0)
    ds_read_b64_tr_b16 a[224:225], v17 offset:24576
    ds_read_b64_tr_b16 a[226:227], v17 offset:24832
    ds_read_b64_tr_b16 a[228:229], v17 offset:25600
    ds_read_b64_tr_b16 a[230:231], v17 offset:25856
    ds_read_b64_tr_b16 a[232:233], v17 offset:26624
    ds_read_b64_tr_b16 a[234:235], v17 offset:26880
    ds_read_b64_tr_b16 a[236:237], v17 offset:27648
    ds_read_b64_tr_b16 a[238:239], v17 offset:27904
    s_waitcnt lgkmcnt(0)
    ds_read_b64_tr_b16 a[240:241], v17 offset:28672
    ds_read_b64_tr_b16 a[242:243], v17 offset:28928
    ds_read_b64_tr_b16 a[244:245], v17 offset:29696
    ds_read_b64_tr_b16 a[246:247], v17 offset:29952
    ds_read_b64_tr_b16 a[248:249], v17 offset:30720
    ds_read_b64_tr_b16 a[250:251], v17 offset:30976
    ds_read_b64_tr_b16 a[252:253], v17 offset:31744
    ds_read_b64_tr_b16 a[254:255], v17 offset:32000
    s_waitcnt lgkmcnt(0)
    s_barrier
    v_lshrrev_b32 v2, 3, v1
    s_lshl_b32 s43, s41, 3
    v_add_u32 v2, s43, v2
    v_bfe_u32 v3, v2, 1, 3
    v_and_b32 v4, 7, v1
    v_xor_b32 v3, v3, v4
    v_lshlrev_b32 v6, 11, v2
    v_lshl_add_u32 v6, v3, 4, v6
    s_lshl_b32 s46, s41, 10
    v_and_b32 v2, 15, v1
    v_bfe_u32 v3, v2, 1, 3
    v_lshrrev_b32 v4, 4, v1
    v_xor_b32 v3, v3, v4
    v_lshlrev_b32 v8, 7, v2
    v_lshl_add_u32 v8, v3, 4, v8
    v_xor_b32 v9, 64, v8
    v_add_u32 v10, 0x10000, v8
    v_add_u32 v11, 0x10000, v9
    v_mov_b32 v7, v5
    v_and_b32 v2, 31, v1
    v_bfe_u32 v3, v2, 1, 3
    v_lshrrev_b32 v4, 5, v1
    v_xor_b32 v3, v3, v4
    v_lshlrev_b32 v8, 7, v2
    v_lshl_add_u32 v8, v3, 4, v8
    v_xor_b32 v9, 32, v8
    v_xor_b32 v10, 64, v8
    v_xor_b32 v11, 96, v8
    v_add_u32 v12, 0x10000, v8
    v_add_u32 v13, 0x10000, v9
    v_add_u32 v14, 0x10000, v10
    v_add_u32 v15, 0x10000, v11
    v_bfe_u32 v3, v1, 4, 1
    v_lshlrev_b32 v7, 10, v3
    v_lshl_add_u32 v7, v4, 8, v7
    v_and_b32 v3, 15, v1
    v_lshl_add_u32 v7, v3, 4, v7
    s_lshl_b32 s47, s40, 2
    s_add_u32 s47, s47, s41
    s_mov_b32 s42, 0
    v_lshrrev_b32 v92, 4, v1
    v_and_b32 v93, 15, v1
    s_and_b32 s52, s41, 1
    s_lshr_b32 s53, s41, 1
    s_mov_b32 s54, 0x3e0293ee
    s_mov_b32 s55, 0
    s_mov_b32 s56, 0
    v_mov_b32 v97, 0xff7fffff
    v_and_b32 v2, 7, v93
    v_lshlrev_b32 v94, 7, v92
    v_lshl_add_u32 v94, v2, 4, v94
    v_and_b32 v2, 31, v1
    v_lshlrev_b32 v95, 3, v2
    v_lshrrev_b32 v2, 1, v92
    v_lshlrev_b32 v96, 10, v2
    v_and_b32 v2, 1, v92
    v_lshl_add_u32 v96, v2, 9, v96
    v_lshl_add_u32 v96, v93, 4, v96
    s_lshl_b32 s43, s40, 13
    s_lshl_b32 s44, s53, 12
    s_add_u32 s43, s43, s44
    s_lshl_b32 s44, s52, 8
    s_add_u32 s43, s43, s44
    s_add_u32 s43, s43, 134217728
    v_add_u32 v96, s43, v96
    s_lshl_b32 s43, s52, 4
    v_add_u32 v98, s43, v93
    v_lshlrev_b32 v2, 2, v92
    v_sub_u32 v98, v98, v2
    s_mov_b32 s28, 0
    s_mov_b32 s29, -1
    s_xor_b32 s44, s98, 1
    s_lshl_b32 s44, s44, 13
    s_lshl_b32 s43, s40, 7
    s_add_u32 s43, s43, s44
    s_add_u32 s43, s43, 69206016
    v_and_b32 v2, 3, v1
    v_bfe_u32 v3, v1, 2, 1
    v_lshlrev_b32 v99, 12, v3
    v_lshl_add_u32 v99, v2, 2, v99
    v_add_u32 v99, s43, v99
    s_xor_b32 s62, s98, 1
    s_lshl_b32 s62, s62, 13
    s_lshr_b32 s44, s47, 6
    s_lshl_b32 s44, s44, 14
    s_add_u32 s62, s62, s44
    s_and_b32 s44, s47, 63
    s_lshl_b32 s44, s44, 7
    s_add_u32 s62, s62, s44
    s_add_u32 s62, s62, 69222400
    s_lshl_b32 s49, s47, 2
    s_add_u32 s49, s49, 69255168
    s_lshl_b32 s43, s41, 11
    s_add_u32 s43, s43, 131072
    v_add_u32 v101, s43, v7
    s_lshl_b32 s43, s52, 10
    s_add_u32 s43, s43, 131072
    v_add_u32 v102, s43, v5
    v_mov_b32 v16, 0
    s_mov_b32 s50, 0
    v_mov_b32 v104, 0x3f803f80
    v_mov_b32 v105, 0x3f803f80
    v_mov_b32 v106, 0x3f803f80
    v_mov_b32 v107, 0x3f803f80
    v_cmp_gt_i32 s[12:13], 0, v98
    v_cmp_gt_i32 s[14:15], 1, v98
    v_cmp_gt_i32 s[16:17], 2, v98
    v_cmp_gt_i32 s[18:19], 3, v98
    v_cmp_gt_i32 s[20:21], 16, v98
    v_cmp_gt_i32 s[22:23], 17, v98
    v_cmp_gt_i32 s[24:25], 18, v98
    v_cmp_gt_i32 s[26:27], 19, v98
    s_lshr_b32 s44, s47, 3
    s_xor_b32 s44, s44, s98
    s_and_b32 s44, s44, 1
    s_lshl_b32 s44, s44, 13
    s_lshl_b32 s58, s47, 18
    s_add_u32 s58, s58, s44
    s_add_u32 s58, s58, 0
    s_lshr_b32 s44, s47, 4
    s_xor_b32 s44, s44, s98
    s_and_b32 s44, s44, 1
    s_lshl_b32 s44, s44, 13
    s_lshl_b32 s59, s47, 17
    s_add_u32 s59, s59, s44
    s_add_u32 s59, s59, 71303168
    s_lshl_b32 s60, s41, 11
    s_add_u32 s60, s60, 139264
    s_lshl_b32 s61, s41, 10
    s_add_u32 s61, s61, 155648
    v_add_u32 v94, 155648, v94
    s_lshl_b32 s43, s53, 11
    s_add_u32 s43, s43, 156160
    v_add_u32 v95, s43, v95
    v_add_u32 v103, 139264, v5
    s_lshl_b32 s43, s53, 12
    s_add_u32 s43, s43, 147456
    v_add_u32 v240, s43, v5
    s_add_u32 m0, s46, 0
    s_nop 0
    buffer_load_dwordx4 v6, s[8:11], s50 offen offset:0 lds
    s_add_u32 m0, s46, 3968
    s_nop 0
    buffer_load_dwordx4 v6, s[8:11], s50 offen offset:128 lds
    s_add_u32 m0, s46, 7936
    s_nop 0
    buffer_load_dwordx4 v6, s[8:11], s50 offen offset:256 lds
    s_add_u32 m0, s46, 11904
    s_nop 0
    buffer_load_dwordx4 v6, s[8:11], s50 offen offset:384 lds
    s_add_u32 m0, s46, 15872
    s_nop 0
    buffer_load_dwordx4 v6, s[8:11], s50 offen offset:512 lds
    s_add_u32 m0, s46, 19840
    s_nop 0
    buffer_load_dwordx4 v6, s[8:11], s50 offen offset:640 lds
    s_add_u32 m0, s46, 23808
    s_nop 0
    buffer_load_dwordx4 v6, s[8:11], s50 offen offset:768 lds
    s_add_u32 m0, s46, 27776
    s_nop 0
    buffer_load_dwordx4 v6, s[8:11], s50 offen offset:896 lds
    s_add_u32 m0, s46, 31744
    s_nop 0
    buffer_load_dwordx4 v6, s[8:11], s50 offen offset:1024 lds
    s_add_u32 m0, s46, 35712
    s_nop 0
    buffer_load_dwordx4 v6, s[8:11], s50 offen offset:1152 lds
    s_add_u32 m0, s46, 39680
    s_nop 0
    buffer_load_dwordx4 v6, s[8:11], s50 offen offset:1280 lds
    s_add_u32 m0, s46, 43648
    s_nop 0
    buffer_load_dwordx4 v6, s[8:11], s50 offen offset:1408 lds
    s_add_u32 m0, s46, 47616
    s_nop 0
    buffer_load_dwordx4 v6, s[8:11], s50 offen offset:1536 lds
    s_add_u32 m0, s46, 51584
    s_nop 0
    buffer_load_dwordx4 v6, s[8:11], s50 offen offset:1664 lds
    s_add_u32 m0, s46, 55552
    s_nop 0
    buffer_load_dwordx4 v6, s[8:11], s50 offen offset:1792 lds
    s_add_u32 m0, s46, 59520
    s_nop 0
    buffer_load_dwordx4 v6, s[8:11], s50 offen offset:1920 lds
    s_waitcnt vmcnt(0)
mega_kernel_q_loop:
    s_barrier
    s_cmp_gt_i32 s55, s42
    s_cbranch_scc1 mega_kernel_q_kv0k
    mega_kernel_q_kv0w:
    buffer_load_dword v2, v99, s[84:87], 0 offen sc1
    s_waitcnt vmcnt(0)
    v_min_i32_dpp v2, v2, v2 quad_perm:[1,0,3,2] row_mask:0xf bank_mask:0xf
    s_nop 1
    v_min_i32_dpp v2, v2, v2 quad_perm:[2,3,0,1] row_mask:0xf bank_mask:0xf
    s_nop 1
    v_min_i32_dpp v2, v2, v2 row_ror:4 row_mask:0xf bank_mask:0xf
    s_nop 0
    v_readfirstlane_b32 s55, v2
    s_cmp_gt_i32 s55, s42
    s_cbranch_scc1 mega_kernel_q_kv0k
    s_sleep 4
    s_branch mega_kernel_q_kv0w
    mega_kernel_q_kv0k:
    s_add_u32 s51, s47, s42
    s_bfe_u32 s57, s51, 0x40002
    s_lshl_b32 s57, s57, 14
    s_and_b32 s66, s51, 3
    s_lshl_b32 s66, s66, 11
    s_add_u32 s66, s66, s57
    s_add_u32 s66, s66, s58
    s_add_u32 s67, s66, 33554432
    s_bfe_u32 s57, s51, 0x30003
    s_lshl_b32 s57, s57, 14
    s_and_b32 s68, s51, 7
    s_lshl_b32 s68, s68, 10
    s_add_u32 s68, s68, s57
    s_add_u32 s68, s68, s59
    s_add_u32 s50, s42, 1
    s_min_u32 s50, s50, 63
    s_lshl_b32 s50, s50, 16
    s_cmp_gt_i32 s56, s42
    s_cselect_b32 s30, 1, 0
    ds_read_b128 v[20:23], v8 offset:0
    ds_read_b128 v[24:27], v9 offset:0
    ds_read_b128 v[28:31], v10 offset:0
    ds_read_b128 v[32:35], v11 offset:0
    ds_read_b128 v[36:39], v8 offset:4096
    ds_read_b128 v[40:43], v9 offset:4096
    s_add_u32 m0, s60, 0
    s_waitcnt lgkmcnt(4)
    v_mfma_f32_32x32x16_bf16 v[52:67], a[0:3], v[20:23], 0
    ds_read_b128 v[44:47], v10 offset:4096
    buffer_load_dwordx4 v5, s[84:87], s66 offen offset:0 sc1 lds
    v_mfma_f32_32x32x16_bf16 v[52:67], a[4:7], v[24:27], v[52:67]
    ds_read_b128 v[48:51], v11 offset:4096
    s_add_u32 m0, s60, 0
    s_waitcnt lgkmcnt(4)
    v_mfma_f32_32x32x16_bf16 v[52:67], a[8:11], v[28:31], v[52:67]
    ds_read_b128 v[20:23], v8 offset:8192
    buffer_load_dwordx4 v5, s[84:87], s66 offen offset:1024 sc1 lds
    v_mfma_f32_32x32x16_bf16 v[52:67], a[12:15], v[32:35], v[52:67]
    ds_read_b128 v[24:27], v9 offset:8192
    s_add_u32 m0, s60, 8192
    s_waitcnt lgkmcnt(4)
    v_mfma_f32_32x32x16_bf16 v[52:67], a[16:19], v[36:39], v[52:67]
    ds_read_b128 v[28:31], v10 offset:8192
    buffer_load_dwordx4 v5, s[84:87], s67 offen offset:0 sc1 lds
    v_mfma_f32_32x32x16_bf16 v[52:67], a[20:23], v[40:43], v[52:67]
    ds_read_b128 v[32:35], v11 offset:8192
    s_add_u32 m0, s60, 8192
    s_waitcnt lgkmcnt(4)
    v_mfma_f32_32x32x16_bf16 v[52:67], a[24:27], v[44:47], v[52:67]
    ds_read_b128 v[36:39], v8 offset:12288
    buffer_load_dwordx4 v5, s[84:87], s67 offen offset:1024 sc1 lds
    v_mfma_f32_32x32x16_bf16 v[52:67], a[28:31], v[48:51], v[52:67]
    ds_read_b128 v[40:43], v9 offset:12288
    s_waitcnt lgkmcnt(4)
    v_mfma_f32_32x32x16_bf16 v[52:67], a[32:35], v[20:23], v[52:67]
    ds_read_b128 v[44:47], v10 offset:12288
    s_cmp_eq_u32 s30, 1
    s_cbranch_scc0 mega_kernel_q_ke0
    s_mov_b32 m0, s61
    s_nop 0
    buffer_load_dwordx4 v5, s[84:87], s68 offen sc1 lds
    mega_kernel_q_ke0:
    v_mfma_f32_32x32x16_bf16 v[52:67], a[36:39], v[24:27], v[52:67]
    ds_read_b128 v[48:51], v11 offset:12288
    s_add_u32 m0, s46, 65536
    s_waitcnt lgkmcnt(4)
    v_mfma_f32_32x32x16_bf16 v[52:67], a[40:43], v[28:31], v[52:67]
    ds_read_b128 v[20:23], v8 offset:16384
    buffer_load_dwordx4 v6, s[8:11], s50 offen offset:0 lds
    v_mfma_f32_32x32x16_bf16 v[52:67], a[44:47], v[32:35], v[52:67]
    ds_read_b128 v[24:27], v9 offset:16384
    s_add_u32 m0, s46, 69504
    s_waitcnt lgkmcnt(4)
    v_mfma_f32_32x32x16_bf16 v[52:67], a[48:51], v[36:39], v[52:67]
    ds_read_b128 v[28:31], v10 offset:16384
    buffer_load_dwordx4 v6, s[8:11], s50 offen offset:128 lds
    v_mfma_f32_32x32x16_bf16 v[52:67], a[52:55], v[40:43], v[52:67]
    ds_read_b128 v[32:35], v11 offset:16384
    s_add_u32 m0, s46, 73472
    s_waitcnt lgkmcnt(4)
    v_mfma_f32_32x32x16_bf16 v[52:67], a[56:59], v[44:47], v[52:67]
    ds_read_b128 v[36:39], v8 offset:20480
    buffer_load_dwordx4 v6, s[8:11], s50 offen offset:256 lds
    v_mfma_f32_32x32x16_bf16 v[52:67], a[60:63], v[48:51], v[52:67]
    ds_read_b128 v[40:43], v9 offset:20480
    s_add_u32 m0, s46, 77440
    s_waitcnt lgkmcnt(4)
    v_mfma_f32_32x32x16_bf16 v[52:67], a[64:67], v[20:23], v[52:67]
    ds_read_b128 v[44:47], v10 offset:20480
    buffer_load_dwordx4 v6, s[8:11], s50 offen offset:384 lds
    v_mfma_f32_32x32x16_bf16 v[52:67], a[68:71], v[24:27], v[52:67]
    ds_read_b128 v[48:51], v11 offset:20480
    s_add_u32 m0, s46, 81408
    s_waitcnt lgkmcnt(4)
    v_mfma_f32_32x32x16_bf16 v[52:67], a[72:75], v[28:31], v[52:67]
    ds_read_b128 v[20:23], v8 offset:24576
    buffer_load_dwordx4 v6, s[8:11], s50 offen offset:512 lds
    v_mfma_f32_32x32x16_bf16 v[52:67], a[76:79], v[32:35], v[52:67]
    ds_read_b128 v[24:27], v9 offset:24576
    s_add_u32 m0, s46, 85376
    s_waitcnt lgkmcnt(4)
    v_mfma_f32_32x32x16_bf16 v[52:67], a[80:83], v[36:39], v[52:67]
    ds_read_b128 v[28:31], v10 offset:24576
    buffer_load_dwordx4 v6, s[8:11], s50 offen offset:640 lds
    v_mfma_f32_32x32x16_bf16 v[52:67], a[84:87], v[40:43], v[52:67]
    ds_read_b128 v[32:35], v11 offset:24576
    s_add_u32 m0, s46, 89344
    s_waitcnt lgkmcnt(4)
    v_mfma_f32_32x32x16_bf16 v[52:67], a[88:91], v[44:47], v[52:67]
    ds_read_b128 v[36:39], v8 offset:28672
    buffer_load_dwordx4 v6, s[8:11], s50 offen offset:768 lds
    v_mfma_f32_32x32x16_bf16 v[52:67], a[92:95], v[48:51], v[52:67]
    ds_read_b128 v[40:43], v9 offset:28672
    s_add_u32 m0, s46, 93312
    s_waitcnt lgkmcnt(4)
    v_mfma_f32_32x32x16_bf16 v[52:67], a[96:99], v[20:23], v[52:67]
    ds_read_b128 v[44:47], v10 offset:28672
    buffer_load_dwordx4 v6, s[8:11], s50 offen offset:896 lds
    v_mfma_f32_32x32x16_bf16 v[52:67], a[100:103], v[24:27], v[52:67]
    ds_read_b128 v[48:51], v11 offset:28672
    s_add_u32 m0, s46, 97280
    s_waitcnt lgkmcnt(4)
    v_mfma_f32_32x32x16_bf16 v[52:67], a[104:107], v[28:31], v[52:67]
    ds_read_b128 v[20:23], v8 offset:32768
    buffer_load_dwordx4 v6, s[8:11], s50 offen offset:1024 lds
    v_mfma_f32_32x32x16_bf16 v[52:67], a[108:111], v[32:35], v[52:67]
    ds_read_b128 v[24:27], v9 offset:32768
    s_waitcnt vmcnt(13)
    v_mov_b32 v17, s42
    s_mov_b64 exec, 1
    buffer_store_dword v17, v16, s[84:87], s49 offen sc1
    s_mov_b64 exec, -1
    s_add_u32 m0, s46, 101248
    s_waitcnt lgkmcnt(4)
    v_mfma_f32_32x32x16_bf16 v[52:67], a[112:115], v[36:39], v[52:67]
    ds_read_b128 v[28:31], v10 offset:32768
    buffer_load_dwordx4 v6, s[8:11], s50 offen offset:1152 lds
    v_mfma_f32_32x32x16_bf16 v[52:67], a[116:119], v[40:43], v[52:67]
    ds_read_b128 v[32:35], v11 offset:32768
    v_mov_b32 v100, 0
    s_mov_b64 exec, 1
    buffer_atomic_add v100, v16, s[84:87], s62 offen sc0 sc1
    s_mov_b64 exec, -1
    s_add_u32 m0, s46, 105216
    s_waitcnt lgkmcnt(4)
    v_mfma_f32_32x32x16_bf16 v[52:67], a[120:123], v[44:47], v[52:67]
    ds_read_b128 v[36:39], v8 offset:36864
    buffer_load_dwordx4 v6, s[8:11], s50 offen offset:1280 lds
    v_mfma_f32_32x32x16_bf16 v[52:67], a[124:127], v[48:51], v[52:67]
    ds_read_b128 v[40:43], v9 offset:36864
    s_add_u32 m0, s46, 109184
    s_waitcnt lgkmcnt(4)
    v_mfma_f32_32x32x16_bf16 v[52:67], a[128:131], v[20:23], v[52:67]
    ds_read_b128 v[44:47], v10 offset:36864
    buffer_load_dwordx4 v6, s[8:11], s50 offen offset:1408 lds
    v_mfma_f32_32x32x16_bf16 v[52:67], a[132:135], v[24:27], v[52:67]
    ds_read_b128 v[48:51], v11 offset:36864
    s_add_u32 m0, s46, 113152
    s_waitcnt lgkmcnt(4)
    v_mfma_f32_32x32x16_bf16 v[52:67], a[136:139], v[28:31], v[52:67]
    ds_read_b128 v[20:23], v8 offset:40960
    buffer_load_dwordx4 v6, s[8:11], s50 offen offset:1536 lds
    v_mfma_f32_32x32x16_bf16 v[52:67], a[140:143], v[32:35], v[52:67]
    ds_read_b128 v[24:27], v9 offset:40960
    s_add_u32 m0, s46, 117120
    s_waitcnt lgkmcnt(4)
    v_mfma_f32_32x32x16_bf16 v[52:67], a[144:147], v[36:39], v[52:67]
    ds_read_b128 v[28:31], v10 offset:40960
    buffer_load_dwordx4 v6, s[8:11], s50 offen offset:1664 lds
    v_mfma_f32_32x32x16_bf16 v[52:67], a[148:151], v[40:43], v[52:67]
    ds_read_b128 v[32:35], v11 offset:40960
    s_add_u32 m0, s46, 121088
    s_waitcnt lgkmcnt(4)
    v_mfma_f32_32x32x16_bf16 v[52:67], a[152:155], v[44:47], v[52:67]
    ds_read_b128 v[36:39], v8 offset:45056
    buffer_load_dwordx4 v6, s[8:11], s50 offen offset:1792 lds
    v_mfma_f32_32x32x16_bf16 v[52:67], a[156:159], v[48:51], v[52:67]
    ds_read_b128 v[40:43], v9 offset:45056
    s_add_u32 m0, s46, 125056
    s_waitcnt lgkmcnt(4)
    v_mfma_f32_32x32x16_bf16 v[52:67], a[160:163], v[20:23], v[52:67]
    ds_read_b128 v[44:47], v10 offset:45056
    buffer_load_dwordx4 v6, s[8:11], s50 offen offset:1920 lds
    v_mfma_f32_32x32x16_bf16 v[52:67], a[164:167], v[24:27], v[52:67]
    ds_read_b128 v[48:51], v11 offset:45056
    s_waitcnt lgkmcnt(4)
    v_mfma_f32_32x32x16_bf16 v[52:67], a[168:171], v[28:31], v[52:67]
    ds_read_b128 v[20:23], v8 offset:49152
    v_mfma_f32_32x32x16_bf16 v[52:67], a[172:175], v[32:35], v[52:67]
    ds_read_b128 v[24:27], v9 offset:49152
    s_waitcnt lgkmcnt(4)
    v_mfma_f32_32x32x16_bf16 v[52:67], a[176:179], v[36:39], v[52:67]
    ds_read_b128 v[28:31], v10 offset:49152
    v_mfma_f32_32x32x16_bf16 v[52:67], a[180:183], v[40:43], v[52:67]
    ds_read_b128 v[32:35], v11 offset:49152
    s_waitcnt lgkmcnt(4)
    v_mfma_f32_32x32x16_bf16 v[52:67], a[184:187], v[44:47], v[52:67]
    ds_read_b128 v[36:39], v8 offset:53248
    v_mfma_f32_32x32x16_bf16 v[52:67], a[188:191], v[48:51], v[52:67]
    ds_read_b128 v[40:43], v9 offset:53248
    s_waitcnt lgkmcnt(4)
    v_mfma_f32_32x32x16_bf16 v[52:67], a[192:195], v[20:23], v[52:67]
    ds_read_b128 v[44:47], v10 offset:53248
    v_mfma_f32_32x32x16_bf16 v[52:67], a[196:199], v[24:27], v[52:67]
    ds_read_b128 v[48:51], v11 offset:53248
    s_waitcnt lgkmcnt(4)
    v_mfma_f32_32x32x16_bf16 v[52:67], a[200:203], v[28:31], v[52:67]
    ds_read_b128 v[20:23], v8 offset:57344
    v_mfma_f32_32x32x16_bf16 v[52:67], a[204:207], v[32:35], v[52:67]
    ds_read_b128 v[24:27], v9 offset:57344
    s_waitcnt lgkmcnt(4)
    v_mfma_f32_32x32x16_bf16 v[52:67], a[208:211], v[36:39], v[52:67]
    ds_read_b128 v[28:31], v10 offset:57344
    v_mfma_f32_32x32x16_bf16 v[52:67], a[212:215], v[40:43], v[52:67]
    ds_read_b128 v[32:35], v11 offset:57344
    s_waitcnt lgkmcnt(4)
    v_mfma_f32_32x32x16_bf16 v[52:67], a[216:219], v[44:47], v[52:67]
    ds_read_b128 v[36:39], v8 offset:61440
    v_mfma_f32_32x32x16_bf16 v[52:67], a[220:223], v[48:51], v[52:67]
    ds_read_b128 v[40:43], v9 offset:61440
    s_waitcnt lgkmcnt(4)
    v_mfma_f32_32x32x16_bf16 v[52:67], a[224:227], v[20:23], v[52:67]
    ds_read_b128 v[44:47], v10 offset:61440
    v_mfma_f32_32x32x16_bf16 v[52:67], a[228:231], v[24:27], v[52:67]
    ds_read_b128 v[48:51], v11 offset:61440
    s_waitcnt lgkmcnt(5)
    v_mfma_f32_32x32x16_bf16 v[52:67], a[232:235], v[28:31], v[52:67]
    s_waitcnt vmcnt(6)
    v_readfirstlane_b32 s56, v100
    s_cmp_eq_u32 s30, 1
    s_cbranch_scc1 mega_kernel_q_kf0
    s_cmp_gt_i32 s56, s42
    s_cbranch_scc0 mega_kernel_q_kf0
    s_mov_b32 s30, 1
    s_mov_b32 m0, s61
    s_nop 0
    buffer_load_dwordx4 v5, s[84:87], s68 offen sc1 lds
    mega_kernel_q_kf0:
    s_waitcnt lgkmcnt(4)
    v_mfma_f32_32x32x16_bf16 v[52:67], a[236:239], v[32:35], v[52:67]
    s_waitcnt lgkmcnt(3)
    v_mfma_f32_32x32x16_bf16 v[52:67], a[240:243], v[36:39], v[52:67]
    s_waitcnt lgkmcnt(2)
    v_mfma_f32_32x32x16_bf16 v[52:67], a[244:247], v[40:43], v[52:67]
    s_waitcnt lgkmcnt(1)
    v_mfma_f32_32x32x16_bf16 v[52:67], a[248:251], v[44:47], v[52:67]
    s_waitcnt lgkmcnt(0)
    v_mfma_f32_32x32x16_bf16 v[52:67], a[252:255], v[48:51], v[52:67]
    s_cmp_eq_u32 s30, 1
    s_cbranch_scc1 mega_kernel_q_kl0
mega_kernel_q_kw0:
    v_mov_b32 v100, 0
    s_mov_b64 exec, 1
    buffer_atomic_add v100, v16, s[84:87], s62 offen sc0 sc1
    s_mov_b64 exec, -1
    s_waitcnt vmcnt(0)
    v_readfirstlane_b32 s56, v100
    s_cmp_gt_i32 s56, s42
    s_cbranch_scc0 mega_kernel_q_kw0
    s_mov_b32 m0, s61
    s_nop 0
    buffer_load_dwordx4 v5, s[84:87], s68 offen sc1 lds
mega_kernel_q_kl0:
    s_nop 9
    v_cvt_pk_bf16_f32 v84, v52, v53
    v_cvt_pk_bf16_f32 v85, v54, v55
    v_cvt_pk_bf16_f32 v86, v56, v57
    v_cvt_pk_bf16_f32 v87, v58, v59
    v_cvt_pk_bf16_f32 v88, v60, v61
    v_cvt_pk_bf16_f32 v89, v62, v63
    v_cvt_pk_bf16_f32 v90, v64, v65
    v_cvt_pk_bf16_f32 v91, v66, v67
    ds_write_b128 v101, v[84:87]
    ds_write_b128 v101, v[88:91] offset:512
    s_waitcnt lgkmcnt(0) vmcnt(0)
    s_barrier
    ds_read_b128 v[184:187], v102 offset:0
    ds_read_b128 v[112:115], v103 offset:0
    ds_read_b128 v[128:131], v103 offset:1024
    ds_read_b128 v[188:191], v102 offset:2048
    ds_read_b128 v[116:119], v103 offset:2048
    ds_read_b128 v[132:135], v103 offset:3072
    ds_read_b128 v[192:195], v102 offset:4096
    ds_read_b128 v[120:123], v103 offset:4096
    ds_read_b128 v[136:139], v103 offset:5120
    ds_read_b128 v[196:199], v102 offset:6144
    ds_read_b128 v[124:127], v103 offset:6144
    ds_read_b128 v[140:143], v103 offset:7168
    s_waitcnt lgkmcnt(9)
    v_mfma_f32_16x16x32_bf16 v[200:203], v[112:115], v[184:187], 0
    v_mfma_f32_16x16x32_bf16 v[204:207], v[128:131], v[184:187], 0
    ds_read_b128 v[160:163], v94 offset:0
    s_waitcnt lgkmcnt(7)
    v_mfma_f32_16x16x32_bf16 v[200:203], v[116:119], v[188:191], v[200:203]
    v_mfma_f32_16x16x32_bf16 v[204:207], v[132:135], v[188:191], v[204:207]
    ds_read_b128 v[164:167], v94 offset:1024
    s_waitcnt lgkmcnt(5)
    v_mfma_f32_16x16x32_bf16 v[200:203], v[120:123], v[192:195], v[200:203]
    v_mfma_f32_16x16x32_bf16 v[204:207], v[136:139], v[192:195], v[204:207]
    ds_read_b128 v[168:171], v94 offset:2048
    s_waitcnt lgkmcnt(3)
    v_mfma_f32_16x16x32_bf16 v[200:203], v[124:127], v[196:199], v[200:203]
    v_mfma_f32_16x16x32_bf16 v[204:207], v[140:143], v[196:199], v[204:207]
    ds_read_b128 v[172:175], v94 offset:3072
    s_waitcnt lgkmcnt(3)
    v_mfma_f32_16x16x32_bf16 v[208:211], v[160:163], v[184:187], 0
    ds_read_b128 v[144:147], v240 offset:0
    ds_read_b64 v[176:177], v95 offset:0
    s_waitcnt lgkmcnt(4)
    v_mfma_f32_16x16x32_bf16 v[208:211], v[164:167], v[188:191], v[208:211]
    ds_read_b128 v[148:151], v240 offset:1024
    ds_read_b64 v[178:179], v95 offset:256
    s_waitcnt lgkmcnt(5)
    v_mfma_f32_16x16x32_bf16 v[208:211], v[168:171], v[192:195], v[208:211]
    ds_read_b128 v[152:155], v240 offset:2048
    ds_read_b64 v[180:181], v95 offset:1024
    s_waitcnt lgkmcnt(6)
    v_mfma_f32_16x16x32_bf16 v[208:211], v[172:175], v[196:199], v[208:211]
    ds_read_b128 v[156:159], v240 offset:3072
    ds_read_b64 v[182:183], v95 offset:1280
    s_nop 3
    v_cndmask_b32 v200, v200, v97, s[12:13]
    v_cndmask_b32 v201, v201, v97, s[14:15]
    v_cndmask_b32 v202, v202, v97, s[16:17]
    v_cndmask_b32 v203, v203, v97, s[18:19]
    v_cndmask_b32 v204, v204, v97, s[20:21]
    v_cndmask_b32 v205, v205, v97, s[22:23]
    v_cndmask_b32 v206, v206, v97, s[24:25]
    v_cndmask_b32 v207, v207, v97, s[26:27]
    v_cndmask_b32 v208, v208, v97, s[28:29]
    v_cndmask_b32 v209, v209, v97, s[28:29]
    v_cndmask_b32 v210, v210, v97, s[28:29]
    v_cndmask_b32 v211, v211, v97, s[28:29]
    v_max3_f32 v236, v200, v201, v202
    v_max3_f32 v236, v236, v203, v204
    v_max3_f32 v236, v236, v205, v206
    v_max3_f32 v236, v236, v207, v208
    v_max3_f32 v236, v236, v209, v210
    v_max_f32 v237, v236, v211
    v_max_f32 v236, v236, v211
    s_nop 1
    v_permlane16_swap_b32 v236, v237
    s_nop 0
    v_max_f32 v238, v236, v237
    v_max_f32 v239, v236, v237
    s_nop 1
    v_permlane32_swap_b32 v238, v239
    s_nop 0
    v_max_f32 v236, v238, v239
    v_mul_f32 v236, s54, v236
    v_fma_f32 v200, v200, s54, -v236
    v_fma_f32 v201, v201, s54, -v236
    v_fma_f32 v202, v202, s54, -v236
    v_fma_f32 v203, v203, s54, -v236
    v_fma_f32 v204, v204, s54, -v236
    v_fma_f32 v205, v205, s54, -v236
    v_fma_f32 v206, v206, s54, -v236
    v_fma_f32 v207, v207, s54, -v236
    v_fma_f32 v208, v208, s54, -v236
    v_fma_f32 v209, v209, s54, -v236
    v_fma_f32 v210, v210, s54, -v236
    v_fma_f32 v211, v211, s54, -v236
    v_exp_f32 v200, v200
    v_exp_f32 v201, v201
    v_exp_f32 v202, v202
    v_exp_f32 v203, v203
    v_exp_f32 v204, v204
    v_exp_f32 v205, v205
    v_exp_f32 v206, v206
    v_exp_f32 v207, v207
    v_exp_f32 v208, v208
    v_exp_f32 v209, v209
    v_exp_f32 v210, v210
    v_exp_f32 v211, v211
    s_nop 0
    v_cvt_pk_bf16_f32 v212, v200, v201
    v_cvt_pk_bf16_f32 v213, v202, v203
    v_cvt_pk_bf16_f32 v214, v204, v205
    v_cvt_pk_bf16_f32 v215, v206, v207
    v_cvt_pk_bf16_f32 v216, v208, v209
    v_cvt_pk_bf16_f32 v217, v210, v211
    s_waitcnt lgkmcnt(0)
    s_nop 0
    v_mfma_f32_16x16x32_bf16 v[108:111], v[104:107], v[212:215], 0
    v_mfma_f32_16x16x32_bf16 v[220:223], v[144:147], v[212:215], 0
    v_mfma_f32_16x16x32_bf16 v[224:227], v[148:151], v[212:215], 0
    v_mfma_f32_16x16x32_bf16 v[228:231], v[152:155], v[212:215], 0
    v_mfma_f32_16x16x32_bf16 v[232:235], v[156:159], v[212:215], 0
    v_mfma_f32_16x16x16_bf16 v[108:111], v[104:105], v[216:217], v[108:111]
    v_mfma_f32_16x16x16_bf16 v[220:223], v[176:177], v[216:217], v[220:223]
    v_mfma_f32_16x16x16_bf16 v[224:227], v[178:179], v[216:217], v[224:227]
    v_mfma_f32_16x16x16_bf16 v[228:231], v[180:181], v[216:217], v[228:231]
    v_mfma_f32_16x16x16_bf16 v[232:235], v[182:183], v[216:217], v[232:235]
    s_lshl_b32 s51, s42, 18
    s_nop 2
    v_rcp_f32 v238, v108
    v_rcp_f32 v239, v109
    s_nop 1
    v_pk_mul_f32 v[220:221], v[220:221], v[238:239]
    v_pk_mul_f32 v[222:223], v[222:223], v[238:239]
    v_pk_mul_f32 v[224:225], v[224:225], v[238:239]
    v_pk_mul_f32 v[226:227], v[226:227], v[238:239]
    v_pk_mul_f32 v[228:229], v[228:229], v[238:239]
    v_pk_mul_f32 v[230:231], v[230:231], v[238:239]
    v_pk_mul_f32 v[232:233], v[232:233], v[238:239]
    v_pk_mul_f32 v[234:235], v[234:235], v[238:239]
    v_cvt_pk_bf16_f32 v200, v220, v221
    v_cvt_pk_bf16_f32 v201, v222, v223
    v_cvt_pk_bf16_f32 v202, v224, v225
    v_cvt_pk_bf16_f32 v203, v226, v227
    v_cvt_pk_bf16_f32 v204, v228, v229
    v_cvt_pk_bf16_f32 v205, v230, v231
    v_cvt_pk_bf16_f32 v206, v232, v233
    v_cvt_pk_bf16_f32 v207, v234, v235
    buffer_store_dwordx4 v[200:203], v96, s[84:87], s51 offen sc1
    buffer_store_dwordx4 v[204:207], v96, s[84:87], s51 offen offset:2048 sc1
    s_add_u32 s42, s42, 1
    s_cmp_lt_u32 s42, 64
    s_cbranch_scc1 mega_kernel_q_nf0
    s_waitcnt vmcnt(0)
    v_mov_b32 v17, s42
    s_mov_b64 exec, 1
    buffer_store_dword v17, v16, s[84:87], s49 offen sc1
    s_mov_b64 exec, -1
mega_kernel_q_nf0:
    s_barrier
    s_cmp_gt_i32 s55, s42
    s_cbranch_scc1 mega_kernel_q_kv1k
    mega_kernel_q_kv1w:
    buffer_load_dword v2, v99, s[84:87], 0 offen sc1
    s_waitcnt vmcnt(0)
    v_min_i32_dpp v2, v2, v2 quad_perm:[1,0,3,2] row_mask:0xf bank_mask:0xf
    s_nop 1
    v_min_i32_dpp v2, v2, v2 quad_perm:[2,3,0,1] row_mask:0xf bank_mask:0xf
    s_nop 1
    v_min_i32_dpp v2, v2, v2 row_ror:4 row_mask:0xf bank_mask:0xf
    s_nop 0
    v_readfirstlane_b32 s55, v2
    s_cmp_gt_i32 s55, s42
    s_cbranch_scc1 mega_kernel_q_kv1k
    s_sleep 4
    s_branch mega_kernel_q_kv1w
    mega_kernel_q_kv1k:
    s_add_u32 s51, s47, s42
    s_bfe_u32 s57, s51, 0x40002
    s_lshl_b32 s57, s57, 14
    s_and_b32 s66, s51, 3
    s_lshl_b32 s66, s66, 11
    s_add_u32 s66, s66, s57
    s_add_u32 s66, s66, s58
    s_add_u32 s67, s66, 33554432
    s_bfe_u32 s57, s51, 0x30003
    s_lshl_b32 s57, s57, 14
    s_and_b32 s68, s51, 7
    s_lshl_b32 s68, s68, 10
    s_add_u32 s68, s68, s57
    s_add_u32 s68, s68, s59
    s_add_u32 s50, s42, 1
    s_min_u32 s50, s50, 63
    s_lshl_b32 s50, s50, 16
    s_cmp_gt_i32 s56, s42
    s_cselect_b32 s30, 1, 0
    ds_read_b128 v[20:23], v12 offset:0
    ds_read_b128 v[24:27], v13 offset:0
    ds_read_b128 v[28:31], v14 offset:0
    ds_read_b128 v[32:35], v15 offset:0
    ds_read_b128 v[36:39], v12 offset:4096
    ds_read_b128 v[40:43], v13 offset:4096
    s_add_u32 m0, s60, 0
    s_waitcnt lgkmcnt(4)
    v_mfma_f32_32x32x16_bf16 v[52:67], a[0:3], v[20:23], 0
    ds_read_b128 v[44:47], v14 offset:4096
    buffer_load_dwordx4 v5, s[84:87], s66 offen offset:0 sc1 lds
    v_mfma_f32_32x32x16_bf16 v[52:67], a[4:7], v[24:27], v[52:67]
    ds_read_b128 v[48:51], v15 offset:4096
    s_add_u32 m0, s60, 0
    s_waitcnt lgkmcnt(4)
    v_mfma_f32_32x32x16_bf16 v[52:67], a[8:11], v[28:31], v[52:67]
    ds_read_b128 v[20:23], v12 offset:8192
    buffer_load_dwordx4 v5, s[84:87], s66 offen offset:1024 sc1 lds
    v_mfma_f32_32x32x16_bf16 v[52:67], a[12:15], v[32:35], v[52:67]
    ds_read_b128 v[24:27], v13 offset:8192
    s_add_u32 m0, s60, 8192
    s_waitcnt lgkmcnt(4)
    v_mfma_f32_32x32x16_bf16 v[52:67], a[16:19], v[36:39], v[52:67]
    ds_read_b128 v[28:31], v14 offset:8192
    buffer_load_dwordx4 v5, s[84:87], s67 offen offset:0 sc1 lds
    v_mfma_f32_32x32x16_bf16 v[52:67], a[20:23], v[40:43], v[52:67]
    ds_read_b128 v[32:35], v15 offset:8192
    s_add_u32 m0, s60, 8192
    s_waitcnt lgkmcnt(4)
    v_mfma_f32_32x32x16_bf16 v[52:67], a[24:27], v[44:47], v[52:67]
    ds_read_b128 v[36:39], v12 offset:12288
    buffer_load_dwordx4 v5, s[84:87], s67 offen offset:1024 sc1 lds
    v_mfma_f32_32x32x16_bf16 v[52:67], a[28:31], v[48:51], v[52:67]
    ds_read_b128 v[40:43], v13 offset:12288
    s_waitcnt lgkmcnt(4)
    v_mfma_f32_32x32x16_bf16 v[52:67], a[32:35], v[20:23], v[52:67]
    ds_read_b128 v[44:47], v14 offset:12288
    s_cmp_eq_u32 s30, 1
    s_cbranch_scc0 mega_kernel_q_ke1
    s_mov_b32 m0, s61
    s_nop 0
    buffer_load_dwordx4 v5, s[84:87], s68 offen sc1 lds
    mega_kernel_q_ke1:
    v_mfma_f32_32x32x16_bf16 v[52:67], a[36:39], v[24:27], v[52:67]
    ds_read_b128 v[48:51], v15 offset:12288
    s_add_u32 m0, s46, 0
    s_waitcnt lgkmcnt(4)
    v_mfma_f32_32x32x16_bf16 v[52:67], a[40:43], v[28:31], v[52:67]
    ds_read_b128 v[20:23], v12 offset:16384
    buffer_load_dwordx4 v6, s[8:11], s50 offen offset:0 lds
    v_mfma_f32_32x32x16_bf16 v[52:67], a[44:47], v[32:35], v[52:67]
    ds_read_b128 v[24:27], v13 offset:16384
    s_add_u32 m0, s46, 3968
    s_waitcnt lgkmcnt(4)
    v_mfma_f32_32x32x16_bf16 v[52:67], a[48:51], v[36:39], v[52:67]
    ds_read_b128 v[28:31], v14 offset:16384
    buffer_load_dwordx4 v6, s[8:11], s50 offen offset:128 lds
    v_mfma_f32_32x32x16_bf16 v[52:67], a[52:55], v[40:43], v[52:67]
    ds_read_b128 v[32:35], v15 offset:16384
    s_add_u32 m0, s46, 7936
    s_waitcnt lgkmcnt(4)
    v_mfma_f32_32x32x16_bf16 v[52:67], a[56:59], v[44:47], v[52:67]
    ds_read_b128 v[36:39], v12 offset:20480
    buffer_load_dwordx4 v6, s[8:11], s50 offen offset:256 lds
    v_mfma_f32_32x32x16_bf16 v[52:67], a[60:63], v[48:51], v[52:67]
    ds_read_b128 v[40:43], v13 offset:20480
    s_add_u32 m0, s46, 11904
    s_waitcnt lgkmcnt(4)
    v_mfma_f32_32x32x16_bf16 v[52:67], a[64:67], v[20:23], v[52:67]
    ds_read_b128 v[44:47], v14 offset:20480
    buffer_load_dwordx4 v6, s[8:11], s50 offen offset:384 lds
    v_mfma_f32_32x32x16_bf16 v[52:67], a[68:71], v[24:27], v[52:67]
    ds_read_b128 v[48:51], v15 offset:20480
    s_add_u32 m0, s46, 15872
    s_waitcnt lgkmcnt(4)
    v_mfma_f32_32x32x16_bf16 v[52:67], a[72:75], v[28:31], v[52:67]
    ds_read_b128 v[20:23], v12 offset:24576
    buffer_load_dwordx4 v6, s[8:11], s50 offen offset:512 lds
    v_mfma_f32_32x32x16_bf16 v[52:67], a[76:79], v[32:35], v[52:67]
    ds_read_b128 v[24:27], v13 offset:24576
    s_add_u32 m0, s46, 19840
    s_waitcnt lgkmcnt(4)
    v_mfma_f32_32x32x16_bf16 v[52:67], a[80:83], v[36:39], v[52:67]
    ds_read_b128 v[28:31], v14 offset:24576
    buffer_load_dwordx4 v6, s[8:11], s50 offen offset:640 lds
    v_mfma_f32_32x32x16_bf16 v[52:67], a[84:87], v[40:43], v[52:67]
    ds_read_b128 v[32:35], v15 offset:24576
    s_add_u32 m0, s46, 23808
    s_waitcnt lgkmcnt(4)
    v_mfma_f32_32x32x16_bf16 v[52:67], a[88:91], v[44:47], v[52:67]
    ds_read_b128 v[36:39], v12 offset:28672
    buffer_load_dwordx4 v6, s[8:11], s50 offen offset:768 lds
    v_mfma_f32_32x32x16_bf16 v[52:67], a[92:95], v[48:51], v[52:67]
    ds_read_b128 v[40:43], v13 offset:28672
    s_add_u32 m0, s46, 27776
    s_waitcnt lgkmcnt(4)
    v_mfma_f32_32x32x16_bf16 v[52:67], a[96:99], v[20:23], v[52:67]
    ds_read_b128 v[44:47], v14 offset:28672
    buffer_load_dwordx4 v6, s[8:11], s50 offen offset:896 lds
    v_mfma_f32_32x32x16_bf16 v[52:67], a[100:103], v[24:27], v[52:67]
    ds_read_b128 v[48:51], v15 offset:28672
    s_add_u32 m0, s46, 31744
    s_waitcnt lgkmcnt(4)
    v_mfma_f32_32x32x16_bf16 v[52:67], a[104:107], v[28:31], v[52:67]
    ds_read_b128 v[20:23], v12 offset:32768
    buffer_load_dwordx4 v6, s[8:11], s50 offen offset:1024 lds
    v_mfma_f32_32x32x16_bf16 v[52:67], a[108:111], v[32:35], v[52:67]
    ds_read_b128 v[24:27], v13 offset:32768
    s_waitcnt vmcnt(13)
    v_mov_b32 v17, s42
    s_mov_b64 exec, 1
    buffer_store_dword v17, v16, s[84:87], s49 offen sc1
    s_mov_b64 exec, -1
    s_add_u32 m0, s46, 35712
    s_waitcnt lgkmcnt(4)
    v_mfma_f32_32x32x16_bf16 v[52:67], a[112:115], v[36:39], v[52:67]
    ds_read_b128 v[28:31], v14 offset:32768
    buffer_load_dwordx4 v6, s[8:11], s50 offen offset:1152 lds
    v_mfma_f32_32x32x16_bf16 v[52:67], a[116:119], v[40:43], v[52:67]
    ds_read_b128 v[32:35], v15 offset:32768
    v_mov_b32 v100, 0
    s_mov_b64 exec, 1
    buffer_atomic_add v100, v16, s[84:87], s62 offen sc0 sc1
    s_mov_b64 exec, -1
    s_add_u32 m0, s46, 39680
    s_waitcnt lgkmcnt(4)
    v_mfma_f32_32x32x16_bf16 v[52:67], a[120:123], v[44:47], v[52:67]
    ds_read_b128 v[36:39], v12 offset:36864
    buffer_load_dwordx4 v6, s[8:11], s50 offen offset:1280 lds
    v_mfma_f32_32x32x16_bf16 v[52:67], a[124:127], v[48:51], v[52:67]
    ds_read_b128 v[40:43], v13 offset:36864
    s_add_u32 m0, s46, 43648
    s_waitcnt lgkmcnt(4)
    v_mfma_f32_32x32x16_bf16 v[52:67], a[128:131], v[20:23], v[52:67]
    ds_read_b128 v[44:47], v14 offset:36864
    buffer_load_dwordx4 v6, s[8:11], s50 offen offset:1408 lds
    v_mfma_f32_32x32x16_bf16 v[52:67], a[132:135], v[24:27], v[52:67]
    ds_read_b128 v[48:51], v15 offset:36864
    s_add_u32 m0, s46, 47616
    s_waitcnt lgkmcnt(4)
    v_mfma_f32_32x32x16_bf16 v[52:67], a[136:139], v[28:31], v[52:67]
    ds_read_b128 v[20:23], v12 offset:40960
    buffer_load_dwordx4 v6, s[8:11], s50 offen offset:1536 lds
    v_mfma_f32_32x32x16_bf16 v[52:67], a[140:143], v[32:35], v[52:67]
    ds_read_b128 v[24:27], v13 offset:40960
    s_add_u32 m0, s46, 51584
    s_waitcnt lgkmcnt(4)
    v_mfma_f32_32x32x16_bf16 v[52:67], a[144:147], v[36:39], v[52:67]
    ds_read_b128 v[28:31], v14 offset:40960
    buffer_load_dwordx4 v6, s[8:11], s50 offen offset:1664 lds
    v_mfma_f32_32x32x16_bf16 v[52:67], a[148:151], v[40:43], v[52:67]
    ds_read_b128 v[32:35], v15 offset:40960
    s_add_u32 m0, s46, 55552
    s_waitcnt lgkmcnt(4)
    v_mfma_f32_32x32x16_bf16 v[52:67], a[152:155], v[44:47], v[52:67]
    ds_read_b128 v[36:39], v12 offset:45056
    buffer_load_dwordx4 v6, s[8:11], s50 offen offset:1792 lds
    v_mfma_f32_32x32x16_bf16 v[52:67], a[156:159], v[48:51], v[52:67]
    ds_read_b128 v[40:43], v13 offset:45056
    s_add_u32 m0, s46, 59520
    s_waitcnt lgkmcnt(4)
    v_mfma_f32_32x32x16_bf16 v[52:67], a[160:163], v[20:23], v[52:67]
    ds_read_b128 v[44:47], v14 offset:45056
    buffer_load_dwordx4 v6, s[8:11], s50 offen offset:1920 lds
    v_mfma_f32_32x32x16_bf16 v[52:67], a[164:167], v[24:27], v[52:67]
    ds_read_b128 v[48:51], v15 offset:45056
    s_waitcnt lgkmcnt(4)
    v_mfma_f32_32x32x16_bf16 v[52:67], a[168:171], v[28:31], v[52:67]
    ds_read_b128 v[20:23], v12 offset:49152
    v_mfma_f32_32x32x16_bf16 v[52:67], a[172:175], v[32:35], v[52:67]
    ds_read_b128 v[24:27], v13 offset:49152
    s_waitcnt lgkmcnt(4)
    v_mfma_f32_32x32x16_bf16 v[52:67], a[176:179], v[36:39], v[52:67]
    ds_read_b128 v[28:31], v14 offset:49152
    v_mfma_f32_32x32x16_bf16 v[52:67], a[180:183], v[40:43], v[52:67]
    ds_read_b128 v[32:35], v15 offset:49152
    s_waitcnt lgkmcnt(4)
    v_mfma_f32_32x32x16_bf16 v[52:67], a[184:187], v[44:47], v[52:67]
    ds_read_b128 v[36:39], v12 offset:53248
    v_mfma_f32_32x32x16_bf16 v[52:67], a[188:191], v[48:51], v[52:67]
    ds_read_b128 v[40:43], v13 offset:53248
    s_waitcnt lgkmcnt(4)
    v_mfma_f32_32x32x16_bf16 v[52:67], a[192:195], v[20:23], v[52:67]
    ds_read_b128 v[44:47], v14 offset:53248
    v_mfma_f32_32x32x16_bf16 v[52:67], a[196:199], v[24:27], v[52:67]
    ds_read_b128 v[48:51], v15 offset:53248
    s_waitcnt lgkmcnt(4)
    v_mfma_f32_32x32x16_bf16 v[52:67], a[200:203], v[28:31], v[52:67]
    ds_read_b128 v[20:23], v12 offset:57344
    v_mfma_f32_32x32x16_bf16 v[52:67], a[204:207], v[32:35], v[52:67]
    ds_read_b128 v[24:27], v13 offset:57344
    s_waitcnt lgkmcnt(4)
    v_mfma_f32_32x32x16_bf16 v[52:67], a[208:211], v[36:39], v[52:67]
    ds_read_b128 v[28:31], v14 offset:57344
    v_mfma_f32_32x32x16_bf16 v[52:67], a[212:215], v[40:43], v[52:67]
    ds_read_b128 v[32:35], v15 offset:57344
    s_waitcnt lgkmcnt(4)
    v_mfma_f32_32x32x16_bf16 v[52:67], a[216:219], v[44:47], v[52:67]
    ds_read_b128 v[36:39], v12 offset:61440
    v_mfma_f32_32x32x16_bf16 v[52:67], a[220:223], v[48:51], v[52:67]
    ds_read_b128 v[40:43], v13 offset:61440
    s_waitcnt lgkmcnt(4)
    v_mfma_f32_32x32x16_bf16 v[52:67], a[224:227], v[20:23], v[52:67]
    ds_read_b128 v[44:47], v14 offset:61440
    v_mfma_f32_32x32x16_bf16 v[52:67], a[228:231], v[24:27], v[52:67]
    ds_read_b128 v[48:51], v15 offset:61440
    s_waitcnt lgkmcnt(5)
    v_mfma_f32_32x32x16_bf16 v[52:67], a[232:235], v[28:31], v[52:67]
    s_waitcnt vmcnt(6)
    v_readfirstlane_b32 s56, v100
    s_cmp_eq_u32 s30, 1
    s_cbranch_scc1 mega_kernel_q_kf1
    s_cmp_gt_i32 s56, s42
    s_cbranch_scc0 mega_kernel_q_kf1
    s_mov_b32 s30, 1
    s_mov_b32 m0, s61
    s_nop 0
    buffer_load_dwordx4 v5, s[84:87], s68 offen sc1 lds
    mega_kernel_q_kf1:
    s_waitcnt lgkmcnt(4)
    v_mfma_f32_32x32x16_bf16 v[52:67], a[236:239], v[32:35], v[52:67]
    s_waitcnt lgkmcnt(3)
    v_mfma_f32_32x32x16_bf16 v[52:67], a[240:243], v[36:39], v[52:67]
    s_waitcnt lgkmcnt(2)
    v_mfma_f32_32x32x16_bf16 v[52:67], a[244:247], v[40:43], v[52:67]
    s_waitcnt lgkmcnt(1)
    v_mfma_f32_32x32x16_bf16 v[52:67], a[248:251], v[44:47], v[52:67]
    s_waitcnt lgkmcnt(0)
    v_mfma_f32_32x32x16_bf16 v[52:67], a[252:255], v[48:51], v[52:67]
    s_cmp_eq_u32 s30, 1
    s_cbranch_scc1 mega_kernel_q_kl1
mega_kernel_q_kw1:
    v_mov_b32 v100, 0
    s_mov_b64 exec, 1
    buffer_atomic_add v100, v16, s[84:87], s62 offen sc0 sc1
    s_mov_b64 exec, -1
    s_waitcnt vmcnt(0)
    v_readfirstlane_b32 s56, v100
    s_cmp_gt_i32 s56, s42
    s_cbranch_scc0 mega_kernel_q_kw1
    s_mov_b32 m0, s61
    s_nop 0
    buffer_load_dwordx4 v5, s[84:87], s68 offen sc1 lds
mega_kernel_q_kl1:
    s_nop 9
    v_cvt_pk_bf16_f32 v84, v52, v53
    v_cvt_pk_bf16_f32 v85, v54, v55
    v_cvt_pk_bf16_f32 v86, v56, v57
    v_cvt_pk_bf16_f32 v87, v58, v59
    v_cvt_pk_bf16_f32 v88, v60, v61
    v_cvt_pk_bf16_f32 v89, v62, v63
    v_cvt_pk_bf16_f32 v90, v64, v65
    v_cvt_pk_bf16_f32 v91, v66, v67
    ds_write_b128 v101, v[84:87]
    ds_write_b128 v101, v[88:91] offset:512
    s_waitcnt lgkmcnt(0) vmcnt(0)
    s_barrier
    ds_read_b128 v[184:187], v102 offset:0
    ds_read_b128 v[112:115], v103 offset:0
    ds_read_b128 v[128:131], v103 offset:1024
    ds_read_b128 v[188:191], v102 offset:2048
    ds_read_b128 v[116:119], v103 offset:2048
    ds_read_b128 v[132:135], v103 offset:3072
    ds_read_b128 v[192:195], v102 offset:4096
    ds_read_b128 v[120:123], v103 offset:4096
    ds_read_b128 v[136:139], v103 offset:5120
    ds_read_b128 v[196:199], v102 offset:6144
    ds_read_b128 v[124:127], v103 offset:6144
    ds_read_b128 v[140:143], v103 offset:7168
    s_waitcnt lgkmcnt(9)
    v_mfma_f32_16x16x32_bf16 v[200:203], v[112:115], v[184:187], 0
    v_mfma_f32_16x16x32_bf16 v[204:207], v[128:131], v[184:187], 0
    ds_read_b128 v[160:163], v94 offset:0
    s_waitcnt lgkmcnt(7)
    v_mfma_f32_16x16x32_bf16 v[200:203], v[116:119], v[188:191], v[200:203]
    v_mfma_f32_16x16x32_bf16 v[204:207], v[132:135], v[188:191], v[204:207]
    ds_read_b128 v[164:167], v94 offset:1024
    s_waitcnt lgkmcnt(5)
    v_mfma_f32_16x16x32_bf16 v[200:203], v[120:123], v[192:195], v[200:203]
    v_mfma_f32_16x16x32_bf16 v[204:207], v[136:139], v[192:195], v[204:207]
    ds_read_b128 v[168:171], v94 offset:2048
    s_waitcnt lgkmcnt(3)
    v_mfma_f32_16x16x32_bf16 v[200:203], v[124:127], v[196:199], v[200:203]
    v_mfma_f32_16x16x32_bf16 v[204:207], v[140:143], v[196:199], v[204:207]
    ds_read_b128 v[172:175], v94 offset:3072
    s_waitcnt lgkmcnt(3)
    v_mfma_f32_16x16x32_bf16 v[208:211], v[160:163], v[184:187], 0
    ds_read_b128 v[144:147], v240 offset:0
    ds_read_b64 v[176:177], v95 offset:0
    s_waitcnt lgkmcnt(4)
    v_mfma_f32_16x16x32_bf16 v[208:211], v[164:167], v[188:191], v[208:211]
    ds_read_b128 v[148:151], v240 offset:1024
    ds_read_b64 v[178:179], v95 offset:256
    s_waitcnt lgkmcnt(5)
    v_mfma_f32_16x16x32_bf16 v[208:211], v[168:171], v[192:195], v[208:211]
    ds_read_b128 v[152:155], v240 offset:2048
    ds_read_b64 v[180:181], v95 offset:1024
    s_waitcnt lgkmcnt(6)
    v_mfma_f32_16x16x32_bf16 v[208:211], v[172:175], v[196:199], v[208:211]
    ds_read_b128 v[156:159], v240 offset:3072
    ds_read_b64 v[182:183], v95 offset:1280
    s_nop 3
    v_cndmask_b32 v200, v200, v97, s[12:13]
    v_cndmask_b32 v201, v201, v97, s[14:15]
    v_cndmask_b32 v202, v202, v97, s[16:17]
    v_cndmask_b32 v203, v203, v97, s[18:19]
    v_cndmask_b32 v204, v204, v97, s[20:21]
    v_cndmask_b32 v205, v205, v97, s[22:23]
    v_cndmask_b32 v206, v206, v97, s[24:25]
    v_cndmask_b32 v207, v207, v97, s[26:27]
    v_cndmask_b32 v208, v208, v97, s[28:29]
    v_cndmask_b32 v209, v209, v97, s[28:29]
    v_cndmask_b32 v210, v210, v97, s[28:29]
    v_cndmask_b32 v211, v211, v97, s[28:29]
    v_max3_f32 v236, v200, v201, v202
    v_max3_f32 v236, v236, v203, v204
    v_max3_f32 v236, v236, v205, v206
    v_max3_f32 v236, v236, v207, v208
    v_max3_f32 v236, v236, v209, v210
    v_max_f32 v237, v236, v211
    v_max_f32 v236, v236, v211
    s_nop 1
    v_permlane16_swap_b32 v236, v237
    s_nop 0
    v_max_f32 v238, v236, v237
    v_max_f32 v239, v236, v237
    s_nop 1
    v_permlane32_swap_b32 v238, v239
    s_nop 0
    v_max_f32 v236, v238, v239
    v_mul_f32 v236, s54, v236
    v_fma_f32 v200, v200, s54, -v236
    v_fma_f32 v201, v201, s54, -v236
    v_fma_f32 v202, v202, s54, -v236
    v_fma_f32 v203, v203, s54, -v236
    v_fma_f32 v204, v204, s54, -v236
    v_fma_f32 v205, v205, s54, -v236
    v_fma_f32 v206, v206, s54, -v236
    v_fma_f32 v207, v207, s54, -v236
    v_fma_f32 v208, v208, s54, -v236
    v_fma_f32 v209, v209, s54, -v236
    v_fma_f32 v210, v210, s54, -v236
    v_fma_f32 v211, v211, s54, -v236
    v_exp_f32 v200, v200
    v_exp_f32 v201, v201
    v_exp_f32 v202, v202
    v_exp_f32 v203, v203
    v_exp_f32 v204, v204
    v_exp_f32 v205, v205
    v_exp_f32 v206, v206
    v_exp_f32 v207, v207
    v_exp_f32 v208, v208
    v_exp_f32 v209, v209
    v_exp_f32 v210, v210
    v_exp_f32 v211, v211
    s_nop 0
    v_cvt_pk_bf16_f32 v212, v200, v201
    v_cvt_pk_bf16_f32 v213, v202, v203
    v_cvt_pk_bf16_f32 v214, v204, v205
    v_cvt_pk_bf16_f32 v215, v206, v207
    v_cvt_pk_bf16_f32 v216, v208, v209
    v_cvt_pk_bf16_f32 v217, v210, v211
    s_waitcnt lgkmcnt(0)
    s_nop 0
    v_mfma_f32_16x16x32_bf16 v[108:111], v[104:107], v[212:215], 0
    v_mfma_f32_16x16x32_bf16 v[220:223], v[144:147], v[212:215], 0
    v_mfma_f32_16x16x32_bf16 v[224:227], v[148:151], v[212:215], 0
    v_mfma_f32_16x16x32_bf16 v[228:231], v[152:155], v[212:215], 0
    v_mfma_f32_16x16x32_bf16 v[232:235], v[156:159], v[212:215], 0
    v_mfma_f32_16x16x16_bf16 v[108:111], v[104:105], v[216:217], v[108:111]
    v_mfma_f32_16x16x16_bf16 v[220:223], v[176:177], v[216:217], v[220:223]
    v_mfma_f32_16x16x16_bf16 v[224:227], v[178:179], v[216:217], v[224:227]
    v_mfma_f32_16x16x16_bf16 v[228:231], v[180:181], v[216:217], v[228:231]
    v_mfma_f32_16x16x16_bf16 v[232:235], v[182:183], v[216:217], v[232:235]
    s_lshl_b32 s51, s42, 18
    s_nop 2
    v_rcp_f32 v238, v108
    v_rcp_f32 v239, v109
    s_nop 1
    v_pk_mul_f32 v[220:221], v[220:221], v[238:239]
    v_pk_mul_f32 v[222:223], v[222:223], v[238:239]
    v_pk_mul_f32 v[224:225], v[224:225], v[238:239]
    v_pk_mul_f32 v[226:227], v[226:227], v[238:239]
    v_pk_mul_f32 v[228:229], v[228:229], v[238:239]
    v_pk_mul_f32 v[230:231], v[230:231], v[238:239]
    v_pk_mul_f32 v[232:233], v[232:233], v[238:239]
    v_pk_mul_f32 v[234:235], v[234:235], v[238:239]
    v_cvt_pk_bf16_f32 v200, v220, v221
    v_cvt_pk_bf16_f32 v201, v222, v223
    v_cvt_pk_bf16_f32 v202, v224, v225
    v_cvt_pk_bf16_f32 v203, v226, v227
    v_cvt_pk_bf16_f32 v204, v228, v229
    v_cvt_pk_bf16_f32 v205, v230, v231
    v_cvt_pk_bf16_f32 v206, v232, v233
    v_cvt_pk_bf16_f32 v207, v234, v235
    buffer_store_dwordx4 v[200:203], v96, s[84:87], s51 offen sc1
    buffer_store_dwordx4 v[204:207], v96, s[84:87], s51 offen offset:2048 sc1
    s_add_u32 s42, s42, 1
    s_cmp_lt_u32 s42, 64
    s_cbranch_scc1 mega_kernel_q_nf1
    s_waitcnt vmcnt(0)
    v_mov_b32 v17, s42
    s_mov_b64 exec, 1
    buffer_store_dword v17, v16, s[84:87], s49 offen sc1
    s_mov_b64 exec, -1
mega_kernel_q_nf1:
    s_cmp_lt_u32 s42, 64
    s_cbranch_scc1 mega_kernel_q_loop
mega_kernel_q_quit:
    s_endpgm
mega_kernel_rd:
    s_add_u32 s93, s40, 0
    s_cmp_lt_u32 s93, 128
    s_cbranch_scc0 mega_kernel_f1e
mega_kernel_f1l:
    s_barrier
    s_load_dwordx2 s[4:5], s[0:1], 56
    s_load_dwordx2 s[8:9], s[0:1], 96
    v_and_b32 v1, 31, v0
    v_lshrrev_b32 v2, 5, v0
    v_cvt_f32_u32 v3, v1
    s_waitcnt lgkmcnt(0)
    s_mov_b32 s6, 4194304
    s_mov_b32 s7, 0x00020000
    s_mov_b32 s10, 268435456
    s_mov_b32 s11, 0x00020000
    s_lshl_b32 s12, s93, 15
    v_lshlrev_b32 v6, 12, v2
    v_lshl_add_u32 v6, v1, 1, v6
    buffer_load_ushort v16, v6, s[4:7], s12 offen offset:0
    buffer_load_ushort v48, v6, s[4:7], s12 offen offset:2048
    buffer_load_ushort v17, v6, s[4:7], s12 offen offset:64
    buffer_load_ushort v49, v6, s[4:7], s12 offen offset:2112
    buffer_load_ushort v18, v6, s[4:7], s12 offen offset:128
    buffer_load_ushort v50, v6, s[4:7], s12 offen offset:2176
    buffer_load_ushort v19, v6, s[4:7], s12 offen offset:192
    buffer_load_ushort v51, v6, s[4:7], s12 offen offset:2240
    buffer_load_ushort v20, v6, s[4:7], s12 offen offset:256
    buffer_load_ushort v52, v6, s[4:7], s12 offen offset:2304
    buffer_load_ushort v21, v6, s[4:7], s12 offen offset:320
    buffer_load_ushort v53, v6, s[4:7], s12 offen offset:2368
    buffer_load_ushort v22, v6, s[4:7], s12 offen offset:384
    buffer_load_ushort v54, v6, s[4:7], s12 offen offset:2432
    buffer_load_ushort v23, v6, s[4:7], s12 offen offset:448
    buffer_load_ushort v55, v6, s[4:7], s12 offen offset:2496
    buffer_load_ushort v24, v6, s[4:7], s12 offen offset:512
    buffer_load_ushort v56, v6, s[4:7], s12 offen offset:2560
    buffer_load_ushort v25, v6, s[4:7], s12 offen offset:576
    buffer_load_ushort v57, v6, s[4:7], s12 offen offset:2624
    buffer_load_ushort v26, v6, s[4:7], s12 offen offset:640
    buffer_load_ushort v58, v6, s[4:7], s12 offen offset:2688
    buffer_load_ushort v27, v6, s[4:7], s12 offen offset:704
    buffer_load_ushort v59, v6, s[4:7], s12 offen offset:2752
    buffer_load_ushort v28, v6, s[4:7], s12 offen offset:768
    buffer_load_ushort v60, v6, s[4:7], s12 offen offset:2816
    buffer_load_ushort v29, v6, s[4:7], s12 offen offset:832
    buffer_load_ushort v61, v6, s[4:7], s12 offen offset:2880
    buffer_load_ushort v30, v6, s[4:7], s12 offen offset:896
    buffer_load_ushort v62, v6, s[4:7], s12 offen offset:2944
    buffer_load_ushort v31, v6, s[4:7], s12 offen offset:960
    buffer_load_ushort v63, v6, s[4:7], s12 offen offset:3008
    buffer_load_ushort v32, v6, s[4:7], s12 offen offset:1024
    buffer_load_ushort v64, v6, s[4:7], s12 offen offset:3072
    buffer_load_ushort v33, v6, s[4:7], s12 offen offset:1088
    buffer_load_ushort v65, v6, s[4:7], s12 offen offset:3136
    buffer_load_ushort v34, v6, s[4:7], s12 offen offset:1152
    buffer_load_ushort v66, v6, s[4:7], s12 offen offset:3200
    buffer_load_ushort v35, v6, s[4:7], s12 offen offset:1216
    buffer_load_ushort v67, v6, s[4:7], s12 offen offset:3264
    buffer_load_ushort v36, v6, s[4:7], s12 offen offset:1280
    buffer_load_ushort v68, v6, s[4:7], s12 offen offset:3328
    buffer_load_ushort v37, v6, s[4:7], s12 offen offset:1344
    buffer_load_ushort v69, v6, s[4:7], s12 offen offset:3392
    buffer_load_ushort v38, v6, s[4:7], s12 offen offset:1408
    buffer_load_ushort v70, v6, s[4:7], s12 offen offset:3456
    buffer_load_ushort v39, v6, s[4:7], s12 offen offset:1472
    buffer_load_ushort v71, v6, s[4:7], s12 offen offset:3520
    buffer_load_ushort v40, v6, s[4:7], s12 offen offset:1536
    buffer_load_ushort v72, v6, s[4:7], s12 offen offset:3584
    buffer_load_ushort v41, v6, s[4:7], s12 offen offset:1600
    buffer_load_ushort v73, v6, s[4:7], s12 offen offset:3648
    buffer_load_ushort v42, v6, s[4:7], s12 offen offset:1664
    buffer_load_ushort v74, v6, s[4:7], s12 offen offset:3712
    buffer_load_ushort v43, v6, s[4:7], s12 offen offset:1728
    buffer_load_ushort v75, v6, s[4:7], s12 offen offset:3776
    buffer_load_ushort v44, v6, s[4:7], s12 offen offset:1792
    buffer_load_ushort v76, v6, s[4:7], s12 offen offset:3840
    buffer_load_ushort v45, v6, s[4:7], s12 offen offset:1856
    buffer_load_ushort v77, v6, s[4:7], s12 offen offset:3904
    buffer_load_ushort v46, v6, s[4:7], s12 offen offset:1920
    buffer_load_ushort v78, v6, s[4:7], s12 offen offset:3968
    buffer_load_ushort v47, v6, s[4:7], s12 offen offset:1984
    buffer_load_ushort v79, v6, s[4:7], s12 offen offset:4032
    s_movk_i32 s13, 8448
    v_mul_lo_u32 v7, v2, s13
    v_lshl_add_u32 v4, v1, 3, v7
    s_movk_i32 s13, 264
    v_mul_lo_u32 v5, v1, s13
    v_add_u32 v5, v5, v7
    s_waitcnt vmcnt(0)
    v_lshlrev_b32 v16, 16, v16
    v_lshlrev_b32 v48, 16, v48
    v_lshlrev_b32 v17, 16, v17
    v_lshlrev_b32 v49, 16, v49
    v_lshlrev_b32 v18, 16, v18
    v_lshlrev_b32 v50, 16, v50
    v_lshlrev_b32 v19, 16, v19
    v_lshlrev_b32 v51, 16, v51
    v_lshlrev_b32 v20, 16, v20
    v_lshlrev_b32 v52, 16, v52
    v_lshlrev_b32 v21, 16, v21
    v_lshlrev_b32 v53, 16, v53
    v_lshlrev_b32 v22, 16, v22
    v_lshlrev_b32 v54, 16, v54
    v_lshlrev_b32 v23, 16, v23
    v_lshlrev_b32 v55, 16, v55
    v_lshlrev_b32 v24, 16, v24
    v_lshlrev_b32 v56, 16, v56
    v_lshlrev_b32 v25, 16, v25
    v_lshlrev_b32 v57, 16, v57
    v_lshlrev_b32 v26, 16, v26
    v_lshlrev_b32 v58, 16, v58
    v_lshlrev_b32 v27, 16, v27
    v_lshlrev_b32 v59, 16, v59
    v_lshlrev_b32 v28, 16, v28
    v_lshlrev_b32 v60, 16, v60
    v_lshlrev_b32 v29, 16, v29
    v_lshlrev_b32 v61, 16, v61
    v_lshlrev_b32 v30, 16, v30
    v_lshlrev_b32 v62, 16, v62
    v_lshlrev_b32 v31, 16, v31
    v_lshlrev_b32 v63, 16, v63
    v_lshlrev_b32 v32, 16, v32
    v_lshlrev_b32 v64, 16, v64
    v_lshlrev_b32 v33, 16, v33
    v_lshlrev_b32 v65, 16, v65
    v_lshlrev_b32 v34, 16, v34
    v_lshlrev_b32 v66, 16, v66
    v_lshlrev_b32 v35, 16, v35
    v_lshlrev_b32 v67, 16, v67
    v_lshlrev_b32 v36, 16, v36
    v_lshlrev_b32 v68, 16, v68
    v_lshlrev_b32 v37, 16, v37
    v_lshlrev_b32 v69, 16, v69
    v_lshlrev_b32 v38, 16, v38
    v_lshlrev_b32 v70, 16, v70
    v_lshlrev_b32 v39, 16, v39
    v_lshlrev_b32 v71, 16, v71
    v_lshlrev_b32 v40, 16, v40
    v_lshlrev_b32 v72, 16, v72
    v_lshlrev_b32 v41, 16, v41
    v_lshlrev_b32 v73, 16, v73
    v_lshlrev_b32 v42, 16, v42
    v_lshlrev_b32 v74, 16, v74
    v_lshlrev_b32 v43, 16, v43
    v_lshlrev_b32 v75, 16, v75
    v_lshlrev_b32 v44, 16, v44
    v_lshlrev_b32 v76, 16, v76
    v_lshlrev_b32 v45, 16, v45
    v_lshlrev_b32 v77, 16, v77
    v_lshlrev_b32 v46, 16, v46
    v_lshlrev_b32 v78, 16, v78
    v_lshlrev_b32 v47, 16, v47
    v_lshlrev_b32 v79, 16, v79
    v_sub_f32 v80, v16, v32
    v_sub_f32 v81, v48, v64
    v_add_f32 v16, v16, v32
    v_add_f32 v48, v48, v64
    v_sub_f32 v32, v17, v33
    v_sub_f32 v64, v49, v65
    v_add_f32 v17, v17, v33
    v_add_f32 v49, v49, v65
    v_mul_f32 v33, 0x3f7b14be, v32
    v_mul_f32 v65, 0xbe47c5c2, v32
    v_fmac_f32 v33, 0x3e47c5c2, v64
    v_fmac_f32 v65, 0x3f7b14be, v64
    v_sub_f32 v32, v18, v34
    v_sub_f32 v64, v50, v66
    v_add_f32 v18, v18, v34
    v_add_f32 v50, v50, v66
    v_mul_f32 v34, 0x3f6c835e, v32
    v_mul_f32 v66, 0xbec3ef15, v32
    v_fmac_f32 v34, 0x3ec3ef15, v64
    v_fmac_f32 v66, 0x3f6c835e, v64
    v_sub_f32 v32, v19, v35
    v_sub_f32 v64, v51, v67
    v_add_f32 v19, v19, v35
    v_add_f32 v51, v51, v67
    v_mul_f32 v35, 0x3f54db31, v32
    v_mul_f32 v67, 0xbf0e39da, v32
    v_fmac_f32 v35, 0x3f0e39da, v64
    v_fmac_f32 v67, 0x3f54db31, v64
    v_sub_f32 v32, v20, v36
    v_sub_f32 v64, v52, v68
    v_add_f32 v20, v20, v36
    v_add_f32 v52, v52, v68
    v_mul_f32 v36, 0x3f3504f3, v32
    v_mul_f32 v68, 0xbf3504f3, v32
    v_fmac_f32 v36, 0x3f3504f3, v64
    v_fmac_f32 v68, 0x3f3504f3, v64
    v_sub_f32 v32, v21, v37
    v_sub_f32 v64, v53, v69
    v_add_f32 v21, v21, v37
    v_add_f32 v53, v53, v69
    v_mul_f32 v37, 0x3f0e39da, v32
    v_mul_f32 v69, 0xbf54db31, v32
    v_fmac_f32 v37, 0x3f54db31, v64
    v_fmac_f32 v69, 0x3f0e39da, v64
    v_sub_f32 v32, v22, v38
    v_sub_f32 v64, v54, v70
    v_add_f32 v22, v22, v38
    v_add_f32 v54, v54, v70
    v_mul_f32 v38, 0x3ec3ef15, v32
    v_mul_f32 v70, 0xbf6c835e, v32
    v_fmac_f32 v38, 0x3f6c835e, v64
    v_fmac_f32 v70, 0x3ec3ef15, v64
    v_sub_f32 v32, v23, v39
    v_sub_f32 v64, v55, v71
    v_add_f32 v23, v23, v39
    v_add_f32 v55, v55, v71
    v_mul_f32 v39, 0x3e47c5c2, v32
    v_mul_f32 v71, 0xbf7b14be, v32
    v_fmac_f32 v39, 0x3f7b14be, v64
    v_fmac_f32 v71, 0x3e47c5c2, v64
    v_sub_f32 v32, v56, v72
    v_sub_f32 v64, v40, v24
    v_add_f32 v24, v24, v40
    v_add_f32 v56, v56, v72
    v_sub_f32 v40, v25, v41
    v_sub_f32 v72, v57, v73
    v_add_f32 v25, v25, v41
    v_add_f32 v57, v57, v73
    v_mul_f32 v41, 0xbe47c5c2, v40
    v_mul_f32 v73, 0xbf7b14be, v40
    v_fmac_f32 v41, 0x3f7b14be, v72
    v_fmac_f32 v73, 0xbe47c5c2, v72
    v_sub_f32 v40, v26, v42
    v_sub_f32 v72, v58, v74
    v_add_f32 v26, v26, v42
    v_add_f32 v58, v58, v74
    v_mul_f32 v42, 0xbec3ef15, v40
    v_mul_f32 v74, 0xbf6c835e, v40
    v_fmac_f32 v42, 0x3f6c835e, v72
    v_fmac_f32 v74, 0xbec3ef15, v72
    v_sub_f32 v40, v27, v43
    v_sub_f32 v72, v59, v75
    v_add_f32 v27, v27, v43
    v_add_f32 v59, v59, v75
    v_mul_f32 v43, 0xbf0e39da, v40
    v_mul_f32 v75, 0xbf54db31, v40
    v_fmac_f32 v43, 0x3f54db31, v72
    v_fmac_f32 v75, 0xbf0e39da, v72
    v_sub_f32 v40, v28, v44
    v_sub_f32 v72, v60, v76
    v_add_f32 v28, v28, v44
    v_add_f32 v60, v60, v76
    v_mul_f32 v44, 0xbf3504f3, v40
    v_mul_f32 v76, 0xbf3504f3, v40
    v_fmac_f32 v44, 0x3f3504f3, v72
    v_fmac_f32 v76, 0xbf3504f3, v72
    v_sub_f32 v40, v29, v45
    v_sub_f32 v72, v61, v77
    v_add_f32 v29, v29, v45
    v_add_f32 v61, v61, v77
    v_mul_f32 v45, 0xbf54db31, v40
    v_mul_f32 v77, 0xbf0e39da, v40
    v_fmac_f32 v45, 0x3f0e39da, v72
    v_fmac_f32 v77, 0xbf54db31, v72
    v_sub_f32 v40, v30, v46
    v_sub_f32 v72, v62, v78
    v_add_f32 v30, v30, v46
    v_add_f32 v62, v62, v78
    v_mul_f32 v46, 0xbf6c835e, v40
    v_mul_f32 v78, 0xbec3ef15, v40
    v_fmac_f32 v46, 0x3ec3ef15, v72
    v_fmac_f32 v78, 0xbf6c835e, v72
    v_sub_f32 v40, v31, v47
    v_sub_f32 v72, v63, v79
    v_add_f32 v31, v31, v47
    v_add_f32 v63, v63, v79
    v_mul_f32 v47, 0xbf7b14be, v40
    v_mul_f32 v79, 0xbe47c5c2, v40
    v_fmac_f32 v47, 0x3e47c5c2, v72
    v_fmac_f32 v79, 0xbf7b14be, v72
    v_sub_f32 v40, v16, v24
    v_sub_f32 v72, v48, v56
    v_add_f32 v16, v16, v24
    v_add_f32 v48, v48, v56
    v_sub_f32 v24, v17, v25
    v_sub_f32 v56, v49, v57
    v_add_f32 v17, v17, v25
    v_add_f32 v49, v49, v57
    v_mul_f32 v25, 0x3f6c835e, v24
    v_mul_f32 v57, 0xbec3ef15, v24
    v_fmac_f32 v25, 0x3ec3ef15, v56
    v_fmac_f32 v57, 0x3f6c835e, v56
    v_sub_f32 v24, v18, v26
    v_sub_f32 v56, v50, v58
    v_add_f32 v18, v18, v26
    v_add_f32 v50, v50, v58
    v_mul_f32 v26, 0x3f3504f3, v24
    v_mul_f32 v58, 0xbf3504f3, v24
    v_fmac_f32 v26, 0x3f3504f3, v56
    v_fmac_f32 v58, 0x3f3504f3, v56
    v_sub_f32 v24, v19, v27
    v_sub_f32 v56, v51, v59
    v_add_f32 v19, v19, v27
    v_add_f32 v51, v51, v59
    v_mul_f32 v27, 0x3ec3ef15, v24
    v_mul_f32 v59, 0xbf6c835e, v24
    v_fmac_f32 v27, 0x3f6c835e, v56
    v_fmac_f32 v59, 0x3ec3ef15, v56
    v_sub_f32 v24, v52, v60
    v_sub_f32 v56, v28, v20
    v_add_f32 v20, v20, v28
    v_add_f32 v52, v52, v60
    v_sub_f32 v28, v21, v29
    v_sub_f32 v60, v53, v61
    v_add_f32 v21, v21, v29
    v_add_f32 v53, v53, v61
    v_mul_f32 v29, 0xbec3ef15, v28
    v_mul_f32 v61, 0xbf6c835e, v28
    v_fmac_f32 v29, 0x3f6c835e, v60
    v_fmac_f32 v61, 0xbec3ef15, v60
    v_sub_f32 v28, v22, v30
    v_sub_f32 v60, v54, v62
    v_add_f32 v22, v22, v30
    v_add_f32 v54, v54, v62
    v_mul_f32 v30, 0xbf3504f3, v28
    v_mul_f32 v62, 0xbf3504f3, v28
    v_fmac_f32 v30, 0x3f3504f3, v60
    v_fmac_f32 v62, 0xbf3504f3, v60
    v_sub_f32 v28, v23, v31
    v_sub_f32 v60, v55, v63
    v_add_f32 v23, v23, v31
    v_add_f32 v55, v55, v63
    v_mul_f32 v31, 0xbf6c835e, v28
    v_mul_f32 v63, 0xbec3ef15, v28
    v_fmac_f32 v31, 0x3ec3ef15, v60
    v_fmac_f32 v63, 0xbf6c835e, v60
    v_sub_f32 v28, v80, v32
    v_sub_f32 v60, v81, v64
    v_add_f32 v80, v80, v32
    v_add_f32 v81, v81, v64
    v_sub_f32 v32, v33, v41
    v_sub_f32 v64, v65, v73
    v_add_f32 v33, v33, v41
    v_add_f32 v65, v65, v73
    v_mul_f32 v41, 0x3f6c835e, v32
    v_mul_f32 v73, 0xbec3ef15, v32
    v_fmac_f32 v41, 0x3ec3ef15, v64
    v_fmac_f32 v73, 0x3f6c835e, v64
    v_sub_f32 v32, v34, v42
    v_sub_f32 v64, v66, v74
    v_add_f32 v34, v34, v42
    v_add_f32 v66, v66, v74
    v_mul_f32 v42, 0x3f3504f3, v32
    v_mul_f32 v74, 0xbf3504f3, v32
    v_fmac_f32 v42, 0x3f3504f3, v64
    v_fmac_f32 v74, 0x3f3504f3, v64
    v_sub_f32 v32, v35, v43
    v_sub_f32 v64, v67, v75
    v_add_f32 v35, v35, v43
    v_add_f32 v67, v67, v75
    v_mul_f32 v43, 0x3ec3ef15, v32
    v_mul_f32 v75, 0xbf6c835e, v32
    v_fmac_f32 v43, 0x3f6c835e, v64
    v_fmac_f32 v75, 0x3ec3ef15, v64
    v_sub_f32 v32, v68, v76
    v_sub_f32 v64, v44, v36
    v_add_f32 v36, v36, v44
    v_add_f32 v68, v68, v76
    v_sub_f32 v44, v37, v45
    v_sub_f32 v76, v69, v77
    v_add_f32 v37, v37, v45
    v_add_f32 v69, v69, v77
    v_mul_f32 v45, 0xbec3ef15, v44
    v_mul_f32 v77, 0xbf6c835e, v44
    v_fmac_f32 v45, 0x3f6c835e, v76
    v_fmac_f32 v77, 0xbec3ef15, v76
    v_sub_f32 v44, v38, v46
    v_sub_f32 v76, v70, v78
    v_add_f32 v38, v38, v46
    v_add_f32 v70, v70, v78
    v_mul_f32 v46, 0xbf3504f3, v44
    v_mul_f32 v78, 0xbf3504f3, v44
    v_fmac_f32 v46, 0x3f3504f3, v76
    v_fmac_f32 v78, 0xbf3504f3, v76
    v_sub_f32 v44, v39, v47
    v_sub_f32 v76, v71, v79
    v_add_f32 v39, v39, v47
    v_add_f32 v71, v71, v79
    v_mul_f32 v47, 0xbf6c835e, v44
    v_mul_f32 v79, 0xbec3ef15, v44
    v_fmac_f32 v47, 0x3ec3ef15, v76
    v_fmac_f32 v79, 0xbf6c835e, v76
    v_sub_f32 v44, v16, v20
    v_sub_f32 v76, v48, v52
    v_add_f32 v16, v16, v20
    v_add_f32 v48, v48, v52
    v_sub_f32 v20, v17, v21
    v_sub_f32 v52, v49, v53
    v_add_f32 v17, v17, v21
    v_add_f32 v49, v49, v53
    v_mul_f32 v21, 0x3f3504f3, v20
    v_mul_f32 v53, 0xbf3504f3, v20
    v_fmac_f32 v21, 0x3f3504f3, v52
    v_fmac_f32 v53, 0x3f3504f3, v52
    v_sub_f32 v20, v50, v54
    v_sub_f32 v52, v22, v18
    v_add_f32 v18, v18, v22
    v_add_f32 v50, v50, v54
    v_sub_f32 v22, v19, v23
    v_sub_f32 v54, v51, v55
    v_add_f32 v19, v19, v23
    v_add_f32 v51, v51, v55
    v_mul_f32 v23, 0xbf3504f3, v22
    v_mul_f32 v55, 0xbf3504f3, v22
    v_fmac_f32 v23, 0x3f3504f3, v54
    v_fmac_f32 v55, 0xbf3504f3, v54
    v_sub_f32 v22, v40, v24
    v_sub_f32 v54, v72, v56
    v_add_f32 v40, v40, v24
    v_add_f32 v72, v72, v56
    v_sub_f32 v24, v25, v29
    v_sub_f32 v56, v57, v61
    v_add_f32 v25, v25, v29
    v_add_f32 v57, v57, v61
    v_mul_f32 v29, 0x3f3504f3, v24
    v_mul_f32 v61, 0xbf3504f3, v24
    v_fmac_f32 v29, 0x3f3504f3, v56
    v_fmac_f32 v61, 0x3f3504f3, v56
    v_sub_f32 v24, v58, v62
    v_sub_f32 v56, v30, v26
    v_add_f32 v26, v26, v30
    v_add_f32 v58, v58, v62
    v_sub_f32 v30, v27, v31
    v_sub_f32 v62, v59, v63
    v_add_f32 v27, v27, v31
    v_add_f32 v59, v59, v63
    v_mul_f32 v31, 0xbf3504f3, v30
    v_mul_f32 v63, 0xbf3504f3, v30
    v_fmac_f32 v31, 0x3f3504f3, v62
    v_fmac_f32 v63, 0xbf3504f3, v62
    v_sub_f32 v30, v80, v36
    v_sub_f32 v62, v81, v68
    v_add_f32 v80, v80, v36
    v_add_f32 v81, v81, v68
    v_sub_f32 v36, v33, v37
    v_sub_f32 v68, v65, v69
    v_add_f32 v33, v33, v37
    v_add_f32 v65, v65, v69
    v_mul_f32 v37, 0x3f3504f3, v36
    v_mul_f32 v69, 0xbf3504f3, v36
    v_fmac_f32 v37, 0x3f3504f3, v68
    v_fmac_f32 v69, 0x3f3504f3, v68
    v_sub_f32 v36, v66, v70
    v_sub_f32 v68, v38, v34
    v_add_f32 v34, v34, v38
    v_add_f32 v66, v66, v70
    v_sub_f32 v38, v35, v39
    v_sub_f32 v70, v67, v71
    v_add_f32 v35, v35, v39
    v_add_f32 v67, v67, v71
    v_mul_f32 v39, 0xbf3504f3, v38
    v_mul_f32 v71, 0xbf3504f3, v38
    v_fmac_f32 v39, 0x3f3504f3, v70
    v_fmac_f32 v71, 0xbf3504f3, v70
    v_sub_f32 v38, v28, v32
    v_sub_f32 v70, v60, v64
    v_add_f32 v28, v28, v32
    v_add_f32 v60, v60, v64
    v_sub_f32 v32, v41, v45
    v_sub_f32 v64, v73, v77
    v_add_f32 v41, v41, v45
    v_add_f32 v73, v73, v77
    v_mul_f32 v45, 0x3f3504f3, v32
    v_mul_f32 v77, 0xbf3504f3, v32
    v_fmac_f32 v45, 0x3f3504f3, v64
    v_fmac_f32 v77, 0x3f3504f3, v64
    v_sub_f32 v32, v74, v78
    v_sub_f32 v64, v46, v42
    v_add_f32 v42, v42, v46
    v_add_f32 v74, v74, v78
    v_sub_f32 v46, v43, v47
    v_sub_f32 v78, v75, v79
    v_add_f32 v43, v43, v47
    v_add_f32 v75, v75, v79
    v_mul_f32 v47, 0xbf3504f3, v46
    v_mul_f32 v79, 0xbf3504f3, v46
    v_fmac_f32 v47, 0x3f3504f3, v78
    v_fmac_f32 v79, 0xbf3504f3, v78
    v_sub_f32 v46, v16, v18
    v_sub_f32 v78, v48, v50
    v_add_f32 v16, v16, v18
    v_add_f32 v48, v48, v50
    v_sub_f32 v18, v49, v51
    v_sub_f32 v50, v19, v17
    v_add_f32 v17, v17, v19
    v_add_f32 v49, v49, v51
    v_sub_f32 v19, v44, v20
    v_sub_f32 v51, v76, v52
    v_add_f32 v44, v44, v20
    v_add_f32 v76, v76, v52
    v_sub_f32 v20, v53, v55
    v_sub_f32 v52, v23, v21
    v_add_f32 v21, v21, v23
    v_add_f32 v53, v53, v55
    v_sub_f32 v23, v40, v26
    v_sub_f32 v55, v72, v58
    v_add_f32 v40, v40, v26
    v_add_f32 v72, v72, v58
    v_sub_f32 v26, v57, v59
    v_sub_f32 v58, v27, v25
    v_add_f32 v25, v25, v27
    v_add_f32 v57, v57, v59
    v_sub_f32 v27, v22, v24
    v_sub_f32 v59, v54, v56
    v_add_f32 v22, v22, v24
    v_add_f32 v54, v54, v56
    v_sub_f32 v24, v61, v63
    v_sub_f32 v56, v31, v29
    v_add_f32 v29, v29, v31
    v_add_f32 v61, v61, v63
    v_sub_f32 v31, v80, v34
    v_sub_f32 v63, v81, v66
    v_add_f32 v80, v80, v34
    v_add_f32 v81, v81, v66
    v_sub_f32 v34, v65, v67
    v_sub_f32 v66, v35, v33
    v_add_f32 v33, v33, v35
    v_add_f32 v65, v65, v67
    v_sub_f32 v35, v30, v36
    v_sub_f32 v67, v62, v68
    v_add_f32 v30, v30, v36
    v_add_f32 v62, v62, v68
    v_sub_f32 v36, v69, v71
    v_sub_f32 v68, v39, v37
    v_add_f32 v37, v37, v39
    v_add_f32 v69, v69, v71
    v_sub_f32 v39, v28, v42
    v_sub_f32 v71, v60, v74
    v_add_f32 v28, v28, v42
    v_add_f32 v60, v60, v74
    v_sub_f32 v42, v73, v75
    v_sub_f32 v74, v43, v41
    v_add_f32 v41, v41, v43
    v_add_f32 v73, v73, v75
    v_sub_f32 v43, v38, v32
    v_sub_f32 v75, v70, v64
    v_add_f32 v38, v38, v32
    v_add_f32 v70, v70, v64
    v_sub_f32 v32, v77, v79
    v_sub_f32 v64, v47, v45
    v_add_f32 v45, v45, v47
    v_add_f32 v77, v77, v79
    v_sub_f32 v47, v16, v17
    v_sub_f32 v79, v48, v49
    v_add_f32 v16, v16, v17
    v_add_f32 v48, v48, v49
    v_sub_f32 v17, v46, v18
    v_sub_f32 v49, v78, v50
    v_add_f32 v46, v46, v18
    v_add_f32 v78, v78, v50
    v_sub_f32 v18, v44, v21
    v_sub_f32 v50, v76, v53
    v_add_f32 v44, v44, v21
    v_add_f32 v76, v76, v53
    v_sub_f32 v21, v19, v20
    v_sub_f32 v53, v51, v52
    v_add_f32 v19, v19, v20
    v_add_f32 v51, v51, v52
    v_sub_f32 v20, v40, v25
    v_sub_f32 v52, v72, v57
    v_add_f32 v40, v40, v25
    v_add_f32 v72, v72, v57
    v_sub_f32 v25, v23, v26
    v_sub_f32 v57, v55, v58
    v_add_f32 v23, v23, v26
    v_add_f32 v55, v55, v58
    v_sub_f32 v26, v22, v29
    v_sub_f32 v58, v54, v61
    v_add_f32 v22, v22, v29
    v_add_f32 v54, v54, v61
    v_sub_f32 v29, v27, v24
    v_sub_f32 v61, v59, v56
    v_add_f32 v27, v27, v24
    v_add_f32 v59, v59, v56
    v_sub_f32 v24, v80, v33
    v_sub_f32 v56, v81, v65
    v_add_f32 v80, v80, v33
    v_add_f32 v81, v81, v65
    v_sub_f32 v33, v31, v34
    v_sub_f32 v65, v63, v66
    v_add_f32 v31, v31, v34
    v_add_f32 v63, v63, v66
    v_sub_f32 v34, v30, v37
    v_sub_f32 v66, v62, v69
    v_add_f32 v30, v30, v37
    v_add_f32 v62, v62, v69
    v_sub_f32 v37, v35, v36
    v_sub_f32 v69, v67, v68
    v_add_f32 v35, v35, v36
    v_add_f32 v67, v67, v68
    v_sub_f32 v36, v28, v41
    v_sub_f32 v68, v60, v73
    v_add_f32 v28, v28, v41
    v_add_f32 v60, v60, v73
    v_sub_f32 v41, v39, v42
    v_sub_f32 v73, v71, v74
    v_add_f32 v39, v39, v42
    v_add_f32 v71, v71, v74
    v_sub_f32 v42, v38, v45
    v_sub_f32 v74, v70, v77
    v_add_f32 v38, v38, v45
    v_add_f32 v70, v70, v77
    v_sub_f32 v45, v43, v32
    v_sub_f32 v77, v75, v64
    v_add_f32 v43, v43, v32
    v_add_f32 v75, v75, v64
    v_mul_f32 v32, 0xba800000, v3
    v_cos_f32 v64, v32
    v_sin_f32 v82, v32
    s_nop 0
    v_mul_f32 v83, v80, v64
    v_fma_f32 v83, -v81, v82, v83
    v_mul_f32 v81, v81, v64
    v_fmac_f32 v81, v80, v82
    v_mul_f32 v32, 0xbb000000, v3
    v_cos_f32 v64, v32
    v_sin_f32 v82, v32
    s_nop 0
    v_mul_f32 v80, v40, v64
    v_fma_f32 v80, -v72, v82, v80
    v_mul_f32 v72, v72, v64
    v_fmac_f32 v72, v40, v82
    v_mul_f32 v32, 0xbb400000, v3
    v_cos_f32 v64, v32
    v_sin_f32 v82, v32
    s_nop 0
    v_mul_f32 v40, v28, v64
    v_fma_f32 v40, -v60, v82, v40
    v_mul_f32 v60, v60, v64
    v_fmac_f32 v60, v28, v82
    v_mul_f32 v32, 0xbb800000, v3
    v_cos_f32 v64, v32
    v_sin_f32 v82, v32
    s_nop 0
    v_mul_f32 v28, v44, v64
    v_fma_f32 v28, -v76, v82, v28
    v_mul_f32 v76, v76, v64
    v_fmac_f32 v76, v44, v82
    v_mul_f32 v32, 0xbba00000, v3
    v_cos_f32 v64, v32
    v_sin_f32 v82, v32
    s_nop 0
    v_mul_f32 v44, v30, v64
    v_fma_f32 v44, -v62, v82, v44
    v_mul_f32 v62, v62, v64
    v_fmac_f32 v62, v30, v82
    v_mul_f32 v32, 0xbbc00000, v3
    v_cos_f32 v64, v32
    v_sin_f32 v82, v32
    s_nop 0
    v_mul_f32 v30, v22, v64
    v_fma_f32 v30, -v54, v82, v30
    v_mul_f32 v54, v54, v64
    v_fmac_f32 v54, v22, v82
    v_mul_f32 v32, 0xbbe00000, v3
    v_cos_f32 v64, v32
    v_sin_f32 v82, v32
    s_nop 0
    v_mul_f32 v22, v38, v64
    v_fma_f32 v22, -v70, v82, v22
    v_mul_f32 v70, v70, v64
    v_fmac_f32 v70, v38, v82
    v_mul_f32 v32, 0xbc000000, v3
    v_cos_f32 v64, v32
    v_sin_f32 v82, v32
    s_nop 0
    v_mul_f32 v38, v46, v64
    v_fma_f32 v38, -v78, v82, v38
    v_mul_f32 v78, v78, v64
    v_fmac_f32 v78, v46, v82
    v_mul_f32 v32, 0xbc100000, v3
    v_cos_f32 v64, v32
    v_sin_f32 v82, v32
    s_nop 0
    v_mul_f32 v46, v31, v64
    v_fma_f32 v46, -v63, v82, v46
    v_mul_f32 v63, v63, v64
    v_fmac_f32 v63, v31, v82
    v_mul_f32 v32, 0xbc200000, v3
    v_cos_f32 v64, v32
    v_sin_f32 v82, v32
    s_nop 0
    v_mul_f32 v31, v23, v64
    v_fma_f32 v31, -v55, v82, v31
    v_mul_f32 v55, v55, v64
    v_fmac_f32 v55, v23, v82
    v_mul_f32 v32, 0xbc300000, v3
    v_cos_f32 v64, v32
    v_sin_f32 v82, v32
    s_nop 0
    v_mul_f32 v23, v39, v64
    v_fma_f32 v23, -v71, v82, v23
    v_mul_f32 v71, v71, v64
    v_fmac_f32 v71, v39, v82
    v_mul_f32 v32, 0xbc400000, v3
    v_cos_f32 v64, v32
    v_sin_f32 v82, v32
    s_nop 0
    v_mul_f32 v39, v19, v64
    v_fma_f32 v39, -v51, v82, v39
    v_mul_f32 v51, v51, v64
    v_fmac_f32 v51, v19, v82
    v_mul_f32 v32, 0xbc500000, v3
    v_cos_f32 v64, v32
    v_sin_f32 v82, v32
    s_nop 0
    v_mul_f32 v19, v35, v64
    v_fma_f32 v19, -v67, v82, v19
    v_mul_f32 v67, v67, v64
    v_fmac_f32 v67, v35, v82
    v_mul_f32 v32, 0xbc600000, v3
    v_cos_f32 v64, v32
    v_sin_f32 v82, v32
    s_nop 0
    v_mul_f32 v35, v27, v64
    v_fma_f32 v35, -v59, v82, v35
    v_mul_f32 v59, v59, v64
    v_fmac_f32 v59, v27, v82
    v_mul_f32 v32, 0xbc700000, v3
    v_cos_f32 v64, v32
    v_sin_f32 v82, v32
    s_nop 0
    v_mul_f32 v27, v43, v64
    v_fma_f32 v27, -v75, v82, v27
    v_mul_f32 v75, v75, v64
    v_fmac_f32 v75, v43, v82
    v_mul_f32 v32, 0xbc800000, v3
    v_cos_f32 v64, v32
    v_sin_f32 v82, v32
    s_nop 0
    v_mul_f32 v43, v47, v64
    v_fma_f32 v43, -v79, v82, v43
    v_mul_f32 v79, v79, v64
    v_fmac_f32 v79, v47, v82
    v_mul_f32 v32, 0xbc880000, v3
    v_cos_f32 v64, v32
    v_sin_f32 v82, v32
    s_nop 0
    v_mul_f32 v47, v24, v64
    v_fma_f32 v47, -v56, v82, v47
    v_mul_f32 v56, v56, v64
    v_fmac_f32 v56, v24, v82
    v_mul_f32 v32, 0xbc900000, v3
    v_cos_f32 v64, v32
    v_sin_f32 v82, v32
    s_nop 0
    v_mul_f32 v24, v20, v64
    v_fma_f32 v24, -v52, v82, v24
    v_mul_f32 v52, v52, v64
    v_fmac_f32 v52, v20, v82
    v_mul_f32 v32, 0xbc980000, v3
    v_cos_f32 v64, v32
    v_sin_f32 v82, v32
    s_nop 0
    v_mul_f32 v20, v36, v64
    v_fma_f32 v20, -v68, v82, v20
    v_mul_f32 v68, v68, v64
    v_fmac_f32 v68, v36, v82
    v_mul_f32 v32, 0xbca00000, v3
    v_cos_f32 v64, v32
    v_sin_f32 v82, v32
    s_nop 0
    v_mul_f32 v36, v18, v64
    v_fma_f32 v36, -v50, v82, v36
    v_mul_f32 v50, v50, v64
    v_fmac_f32 v50, v18, v82
    v_mul_f32 v32, 0xbca80000, v3
    v_cos_f32 v64, v32
    v_sin_f32 v82, v32
    s_nop 0
    v_mul_f32 v18, v34, v64
    v_fma_f32 v18, -v66, v82, v18
    v_mul_f32 v66, v66, v64
    v_fmac_f32 v66, v34, v82
    v_mul_f32 v32, 0xbcb00000, v3
    v_cos_f32 v64, v32
    v_sin_f32 v82, v32
    s_nop 0
    v_mul_f32 v34, v26, v64
    v_fma_f32 v34, -v58, v82, v34
    v_mul_f32 v58, v58, v64
    v_fmac_f32 v58, v26, v82
    v_mul_f32 v32, 0xbcb80000, v3
    v_cos_f32 v64, v32
    v_sin_f32 v82, v32
    s_nop 0
    v_mul_f32 v26, v42, v64
    v_fma_f32 v26, -v74, v82, v26
    v_mul_f32 v74, v74, v64
    v_fmac_f32 v74, v42, v82
    v_mul_f32 v32, 0xbcc00000, v3
    v_cos_f32 v64, v32
    v_sin_f32 v82, v32
    s_nop 0
    v_mul_f32 v42, v17, v64
    v_fma_f32 v42, -v49, v82, v42
    v_mul_f32 v49, v49, v64
    v_fmac_f32 v49, v17, v82
    v_mul_f32 v32, 0xbcc80000, v3
    v_cos_f32 v64, v32
    v_sin_f32 v82, v32
    s_nop 0
    v_mul_f32 v17, v33, v64
    v_fma_f32 v17, -v65, v82, v17
    v_mul_f32 v65, v65, v64
    v_fmac_f32 v65, v33, v82
    v_mul_f32 v32, 0xbcd00000, v3
    v_cos_f32 v64, v32
    v_sin_f32 v82, v32
    s_nop 0
    v_mul_f32 v33, v25, v64
    v_fma_f32 v33, -v57, v82, v33
    v_mul_f32 v57, v57, v64
    v_fmac_f32 v57, v25, v82
    v_mul_f32 v32, 0xbcd80000, v3
    v_cos_f32 v64, v32
    v_sin_f32 v82, v32
    s_nop 0
    v_mul_f32 v25, v41, v64
    v_fma_f32 v25, -v73, v82, v25
    v_mul_f32 v73, v73, v64
    v_fmac_f32 v73, v41, v82
    v_mul_f32 v32, 0xbce00000, v3
    v_cos_f32 v64, v32
    v_sin_f32 v82, v32
    s_nop 0
    v_mul_f32 v41, v21, v64
    v_fma_f32 v41, -v53, v82, v41
    v_mul_f32 v53, v53, v64
    v_fmac_f32 v53, v21, v82
    v_mul_f32 v32, 0xbce80000, v3
    v_cos_f32 v64, v32
    v_sin_f32 v82, v32
    s_nop 0
    v_mul_f32 v21, v37, v64
    v_fma_f32 v21, -v69, v82, v21
    v_mul_f32 v69, v69, v64
    v_fmac_f32 v69, v37, v82
    v_mul_f32 v32, 0xbcf00000, v3
    v_cos_f32 v64, v32
    v_sin_f32 v82, v32
    s_nop 0
    v_mul_f32 v37, v29, v64
    v_fma_f32 v37, -v61, v82, v37
    v_mul_f32 v61, v61, v64
    v_fmac_f32 v61, v29, v82
    v_mul_f32 v32, 0xbcf80000, v3
    v_cos_f32 v64, v32
    v_sin_f32 v82, v32
    s_nop 0
    v_mul_f32 v29, v45, v64
    v_fma_f32 v29, -v77, v82, v29
    v_mul_f32 v77, v77, v64
    v_fmac_f32 v77, v45, v82
    ds_write_b32 v4, v16 offset:0
    ds_write_b32 v4, v48 offset:4
    ds_write_b32 v4, v83 offset:264
    ds_write_b32 v4, v81 offset:268
    ds_write_b32 v4, v80 offset:528
    ds_write_b32 v4, v72 offset:532
    ds_write_b32 v4, v40 offset:792
    ds_write_b32 v4, v60 offset:796
    ds_write_b32 v4, v28 offset:1056
    ds_write_b32 v4, v76 offset:1060
    ds_write_b32 v4, v44 offset:1320
    ds_write_b32 v4, v62 offset:1324
    ds_write_b32 v4, v30 offset:1584
    ds_write_b32 v4, v54 offset:1588
    ds_write_b32 v4, v22 offset:1848
    ds_write_b32 v4, v70 offset:1852
    ds_write_b32 v4, v38 offset:2112
    ds_write_b32 v4, v78 offset:2116
    ds_write_b32 v4, v46 offset:2376
    ds_write_b32 v4, v63 offset:2380
    ds_write_b32 v4, v31 offset:2640
    ds_write_b32 v4, v55 offset:2644
    ds_write_b32 v4, v23 offset:2904
    ds_write_b32 v4, v71 offset:2908
    ds_write_b32 v4, v39 offset:3168
    ds_write_b32 v4, v51 offset:3172
    ds_write_b32 v4, v19 offset:3432
    ds_write_b32 v4, v67 offset:3436
    ds_write_b32 v4, v35 offset:3696
    ds_write_b32 v4, v59 offset:3700
    ds_write_b32 v4, v27 offset:3960
    ds_write_b32 v4, v75 offset:3964
    ds_write_b32 v4, v43 offset:4224
    ds_write_b32 v4, v79 offset:4228
    ds_write_b32 v4, v47 offset:4488
    ds_write_b32 v4, v56 offset:4492
    ds_write_b32 v4, v24 offset:4752
    ds_write_b32 v4, v52 offset:4756
    ds_write_b32 v4, v20 offset:5016
    ds_write_b32 v4, v68 offset:5020
    ds_write_b32 v4, v36 offset:5280
    ds_write_b32 v4, v50 offset:5284
    ds_write_b32 v4, v18 offset:5544
    ds_write_b32 v4, v66 offset:5548
    ds_write_b32 v4, v34 offset:5808
    ds_write_b32 v4, v58 offset:5812
    ds_write_b32 v4, v26 offset:6072
    ds_write_b32 v4, v74 offset:6076
    ds_write_b32 v4, v42 offset:6336
    ds_write_b32 v4, v49 offset:6340
    ds_write_b32 v4, v17 offset:6600
    ds_write_b32 v4, v65 offset:6604
    ds_write_b32 v4, v33 offset:6864
    ds_write_b32 v4, v57 offset:6868
    ds_write_b32 v4, v25 offset:7128
    ds_write_b32 v4, v73 offset:7132
    ds_write_b32 v4, v41 offset:7392
    ds_write_b32 v4, v53 offset:7396
    ds_write_b32 v4, v21 offset:7656
    ds_write_b32 v4, v69 offset:7660
    ds_write_b32 v4, v37 offset:7920
    ds_write_b32 v4, v61 offset:7924
    ds_write_b32 v4, v29 offset:8184
    ds_write_b32 v4, v77 offset:8188
    s_waitcnt lgkmcnt(0)
    ds_read_b32 v16, v5 offset:0
    ds_read_b32 v48, v5 offset:4
    ds_read_b32 v83, v5 offset:8
    ds_read_b32 v81, v5 offset:12
    ds_read_b32 v80, v5 offset:16
    ds_read_b32 v72, v5 offset:20
    ds_read_b32 v40, v5 offset:24
    ds_read_b32 v60, v5 offset:28
    ds_read_b32 v28, v5 offset:32
    ds_read_b32 v76, v5 offset:36
    ds_read_b32 v44, v5 offset:40
    ds_read_b32 v62, v5 offset:44
    ds_read_b32 v30, v5 offset:48
    ds_read_b32 v54, v5 offset:52
    s_waitcnt lgkmcnt(0)
    ds_read_b32 v22, v5 offset:56
    ds_read_b32 v70, v5 offset:60
    ds_read_b32 v38, v5 offset:64
    ds_read_b32 v78, v5 offset:68
    ds_read_b32 v46, v5 offset:72
    ds_read_b32 v63, v5 offset:76
    ds_read_b32 v31, v5 offset:80
    ds_read_b32 v55, v5 offset:84
    ds_read_b32 v23, v5 offset:88
    ds_read_b32 v71, v5 offset:92
    ds_read_b32 v39, v5 offset:96
    ds_read_b32 v51, v5 offset:100
    ds_read_b32 v19, v5 offset:104
    ds_read_b32 v67, v5 offset:108
    s_waitcnt lgkmcnt(0)
    ds_read_b32 v35, v5 offset:112
    ds_read_b32 v59, v5 offset:116
    ds_read_b32 v27, v5 offset:120
    ds_read_b32 v75, v5 offset:124
    ds_read_b32 v43, v5 offset:128
    ds_read_b32 v79, v5 offset:132
    ds_read_b32 v47, v5 offset:136
    ds_read_b32 v56, v5 offset:140
    ds_read_b32 v24, v5 offset:144
    ds_read_b32 v52, v5 offset:148
    ds_read_b32 v20, v5 offset:152
    ds_read_b32 v68, v5 offset:156
    ds_read_b32 v36, v5 offset:160
    ds_read_b32 v50, v5 offset:164
    s_waitcnt lgkmcnt(0)
    ds_read_b32 v18, v5 offset:168
    ds_read_b32 v66, v5 offset:172
    ds_read_b32 v34, v5 offset:176
    ds_read_b32 v58, v5 offset:180
    ds_read_b32 v26, v5 offset:184
    ds_read_b32 v74, v5 offset:188
    ds_read_b32 v42, v5 offset:192
    ds_read_b32 v49, v5 offset:196
    ds_read_b32 v17, v5 offset:200
    ds_read_b32 v65, v5 offset:204
    ds_read_b32 v33, v5 offset:208
    ds_read_b32 v57, v5 offset:212
    ds_read_b32 v25, v5 offset:216
    ds_read_b32 v73, v5 offset:220
    s_waitcnt lgkmcnt(0)
    ds_read_b32 v41, v5 offset:224
    ds_read_b32 v53, v5 offset:228
    ds_read_b32 v21, v5 offset:232
    ds_read_b32 v69, v5 offset:236
    ds_read_b32 v37, v5 offset:240
    ds_read_b32 v61, v5 offset:244
    ds_read_b32 v29, v5 offset:248
    ds_read_b32 v77, v5 offset:252
    s_waitcnt lgkmcnt(0)
    v_sub_f32 v32, v16, v43
    v_sub_f32 v64, v48, v79
    v_add_f32 v16, v16, v43
    v_add_f32 v48, v48, v79
    v_sub_f32 v43, v83, v47
    v_sub_f32 v79, v81, v56
    v_add_f32 v83, v83, v47
    v_add_f32 v81, v81, v56
    v_mul_f32 v47, 0x3f7b14be, v43
    v_mul_f32 v56, 0xbe47c5c2, v43
    v_fmac_f32 v47, 0x3e47c5c2, v79
    v_fmac_f32 v56, 0x3f7b14be, v79
    v_sub_f32 v43, v80, v24
    v_sub_f32 v79, v72, v52
    v_add_f32 v80, v80, v24
    v_add_f32 v72, v72, v52
    v_mul_f32 v24, 0x3f6c835e, v43
    v_mul_f32 v52, 0xbec3ef15, v43
    v_fmac_f32 v24, 0x3ec3ef15, v79
    v_fmac_f32 v52, 0x3f6c835e, v79
    v_sub_f32 v43, v40, v20
    v_sub_f32 v79, v60, v68
    v_add_f32 v40, v40, v20
    v_add_f32 v60, v60, v68
    v_mul_f32 v20, 0x3f54db31, v43
    v_mul_f32 v68, 0xbf0e39da, v43
    v_fmac_f32 v20, 0x3f0e39da, v79
    v_fmac_f32 v68, 0x3f54db31, v79
    v_sub_f32 v43, v28, v36
    v_sub_f32 v79, v76, v50
    v_add_f32 v28, v28, v36
    v_add_f32 v76, v76, v50
    v_mul_f32 v36, 0x3f3504f3, v43
    v_mul_f32 v50, 0xbf3504f3, v43
    v_fmac_f32 v36, 0x3f3504f3, v79
    v_fmac_f32 v50, 0x3f3504f3, v79
    v_sub_f32 v43, v44, v18
    v_sub_f32 v79, v62, v66
    v_add_f32 v44, v44, v18
    v_add_f32 v62, v62, v66
    v_mul_f32 v18, 0x3f0e39da, v43
    v_mul_f32 v66, 0xbf54db31, v43
    v_fmac_f32 v18, 0x3f54db31, v79
    v_fmac_f32 v66, 0x3f0e39da, v79
    v_sub_f32 v43, v30, v34
    v_sub_f32 v79, v54, v58
    v_add_f32 v30, v30, v34
    v_add_f32 v54, v54, v58
    v_mul_f32 v34, 0x3ec3ef15, v43
    v_mul_f32 v58, 0xbf6c835e, v43
    v_fmac_f32 v34, 0x3f6c835e, v79
    v_fmac_f32 v58, 0x3ec3ef15, v79
    v_sub_f32 v43, v22, v26
    v_sub_f32 v79, v70, v74
    v_add_f32 v22, v22, v26
    v_add_f32 v70, v70, v74
    v_mul_f32 v26, 0x3e47c5c2, v43
    v_mul_f32 v74, 0xbf7b14be, v43
    v_fmac_f32 v26, 0x3f7b14be, v79
    v_fmac_f32 v74, 0x3e47c5c2, v79
    v_sub_f32 v43, v78, v49
    v_sub_f32 v79, v42, v38
    v_add_f32 v38, v38, v42
    v_add_f32 v78, v78, v49
    v_sub_f32 v42, v46, v17
    v_sub_f32 v49, v63, v65
    v_add_f32 v46, v46, v17
    v_add_f32 v63, v63, v65
    v_mul_f32 v17, 0xbe47c5c2, v42
    v_mul_f32 v65, 0xbf7b14be, v42
    v_fmac_f32 v17, 0x3f7b14be, v49
    v_fmac_f32 v65, 0xbe47c5c2, v49
    v_sub_f32 v42, v31, v33
    v_sub_f32 v49, v55, v57
    v_add_f32 v31, v31, v33
    v_add_f32 v55, v55, v57
    v_mul_f32 v33, 0xbec3ef15, v42
    v_mul_f32 v57, 0xbf6c835e, v42
    v_fmac_f32 v33, 0x3f6c835e, v49
    v_fmac_f32 v57, 0xbec3ef15, v49
    v_sub_f32 v42, v23, v25
    v_sub_f32 v49, v71, v73
    v_add_f32 v23, v23, v25
    v_add_f32 v71, v71, v73
    v_mul_f32 v25, 0xbf0e39da, v42
    v_mul_f32 v73, 0xbf54db31, v42
    v_fmac_f32 v25, 0x3f54db31, v49
    v_fmac_f32 v73, 0xbf0e39da, v49
    v_sub_f32 v42, v39, v41
    v_sub_f32 v49, v51, v53
    v_add_f32 v39, v39, v41
    v_add_f32 v51, v51, v53
    v_mul_f32 v41, 0xbf3504f3, v42
    v_mul_f32 v53, 0xbf3504f3, v42
    v_fmac_f32 v41, 0x3f3504f3, v49
    v_fmac_f32 v53, 0xbf3504f3, v49
    v_sub_f32 v42, v19, v21
    v_sub_f32 v49, v67, v69
    v_add_f32 v19, v19, v21
    v_add_f32 v67, v67, v69
    v_mul_f32 v21, 0xbf54db31, v42
    v_mul_f32 v69, 0xbf0e39da, v42
    v_fmac_f32 v21, 0x3f0e39da, v49
    v_fmac_f32 v69, 0xbf54db31, v49
    v_sub_f32 v42, v35, v37
    v_sub_f32 v49, v59, v61
    v_add_f32 v35, v35, v37
    v_add_f32 v59, v59, v61
    v_mul_f32 v37, 0xbf6c835e, v42
    v_mul_f32 v61, 0xbec3ef15, v42
    v_fmac_f32 v37, 0x3ec3ef15, v49
    v_fmac_f32 v61, 0xbf6c835e, v49
    v_sub_f32 v42, v27, v29
    v_sub_f32 v49, v75, v77
    v_add_f32 v27, v27, v29
    v_add_f32 v75, v75, v77
    v_mul_f32 v29, 0xbf7b14be, v42
    v_mul_f32 v77, 0xbe47c5c2, v42
    v_fmac_f32 v29, 0x3e47c5c2, v49
    v_fmac_f32 v77, 0xbf7b14be, v49
    v_sub_f32 v42, v16, v38
    v_sub_f32 v49, v48, v78
    v_add_f32 v16, v16, v38
    v_add_f32 v48, v48, v78
    v_sub_f32 v38, v83, v46
    v_sub_f32 v78, v81, v63
    v_add_f32 v83, v83, v46
    v_add_f32 v81, v81, v63
    v_mul_f32 v46, 0x3f6c835e, v38
    v_mul_f32 v63, 0xbec3ef15, v38
    v_fmac_f32 v46, 0x3ec3ef15, v78
    v_fmac_f32 v63, 0x3f6c835e, v78
    v_sub_f32 v38, v80, v31
    v_sub_f32 v78, v72, v55
    v_add_f32 v80, v80, v31
    v_add_f32 v72, v72, v55
    v_mul_f32 v31, 0x3f3504f3, v38
    v_mul_f32 v55, 0xbf3504f3, v38
    v_fmac_f32 v31, 0x3f3504f3, v78
    v_fmac_f32 v55, 0x3f3504f3, v78
    v_sub_f32 v38, v40, v23
    v_sub_f32 v78, v60, v71
    v_add_f32 v40, v40, v23
    v_add_f32 v60, v60, v71
    v_mul_f32 v23, 0x3ec3ef15, v38
    v_mul_f32 v71, 0xbf6c835e, v38
    v_fmac_f32 v23, 0x3f6c835e, v78
    v_fmac_f32 v71, 0x3ec3ef15, v78
    v_sub_f32 v38, v76, v51
    v_sub_f32 v78, v39, v28
    v_add_f32 v28, v28, v39
    v_add_f32 v76, v76, v51
    v_sub_f32 v39, v44, v19
    v_sub_f32 v51, v62, v67
    v_add_f32 v44, v44, v19
    v_add_f32 v62, v62, v67
    v_mul_f32 v19, 0xbec3ef15, v39
    v_mul_f32 v67, 0xbf6c835e, v39
    v_fmac_f32 v19, 0x3f6c835e, v51
    v_fmac_f32 v67, 0xbec3ef15, v51
    v_sub_f32 v39, v30, v35
    v_sub_f32 v51, v54, v59
    v_add_f32 v30, v30, v35
    v_add_f32 v54, v54, v59
    v_mul_f32 v35, 0xbf3504f3, v39
    v_mul_f32 v59, 0xbf3504f3, v39
    v_fmac_f32 v35, 0x3f3504f3, v51
    v_fmac_f32 v59, 0xbf3504f3, v51
    v_sub_f32 v39, v22, v27
    v_sub_f32 v51, v70, v75
    v_add_f32 v22, v22, v27
    v_add_f32 v70, v70, v75
    v_mul_f32 v27, 0xbf6c835e, v39
    v_mul_f32 v75, 0xbec3ef15, v39
    v_fmac_f32 v27, 0x3ec3ef15, v51
    v_fmac_f32 v75, 0xbf6c835e, v51
    v_sub_f32 v39, v32, v43
    v_sub_f32 v51, v64, v79
    v_add_f32 v32, v32, v43
    v_add_f32 v64, v64, v79
    v_sub_f32 v43, v47, v17
    v_sub_f32 v79, v56, v65
    v_add_f32 v47, v47, v17
    v_add_f32 v56, v56, v65
    v_mul_f32 v17, 0x3f6c835e, v43
    v_mul_f32 v65, 0xbec3ef15, v43
    v_fmac_f32 v17, 0x3ec3ef15, v79
    v_fmac_f32 v65, 0x3f6c835e, v79
    v_sub_f32 v43, v24, v33
    v_sub_f32 v79, v52, v57
    v_add_f32 v24, v24, v33
    v_add_f32 v52, v52, v57
    v_mul_f32 v33, 0x3f3504f3, v43
    v_mul_f32 v57, 0xbf3504f3, v43
    v_fmac_f32 v33, 0x3f3504f3, v79
    v_fmac_f32 v57, 0x3f3504f3, v79
    v_sub_f32 v43, v20, v25
    v_sub_f32 v79, v68, v73
    v_add_f32 v20, v20, v25
    v_add_f32 v68, v68, v73
    v_mul_f32 v25, 0x3ec3ef15, v43
    v_mul_f32 v73, 0xbf6c835e, v43
    v_fmac_f32 v25, 0x3f6c835e, v79
    v_fmac_f32 v73, 0x3ec3ef15, v79
    v_sub_f32 v43, v50, v53
    v_sub_f32 v79, v41, v36
    v_add_f32 v36, v36, v41
    v_add_f32 v50, v50, v53
    v_sub_f32 v41, v18, v21
    v_sub_f32 v53, v66, v69
    v_add_f32 v18, v18, v21
    v_add_f32 v66, v66, v69
    v_mul_f32 v21, 0xbec3ef15, v41
    v_mul_f32 v69, 0xbf6c835e, v41
    v_fmac_f32 v21, 0x3f6c835e, v53
    v_fmac_f32 v69, 0xbec3ef15, v53
    v_sub_f32 v41, v34, v37
    v_sub_f32 v53, v58, v61
    v_add_f32 v34, v34, v37
    v_add_f32 v58, v58, v61
    v_mul_f32 v37, 0xbf3504f3, v41
    v_mul_f32 v61, 0xbf3504f3, v41
    v_fmac_f32 v37, 0x3f3504f3, v53
    v_fmac_f32 v61, 0xbf3504f3, v53
    v_sub_f32 v41, v26, v29
    v_sub_f32 v53, v74, v77
    v_add_f32 v26, v26, v29
    v_add_f32 v74, v74, v77
    v_mul_f32 v29, 0xbf6c835e, v41
    v_mul_f32 v77, 0xbec3ef15, v41
    v_fmac_f32 v29, 0x3ec3ef15, v53
    v_fmac_f32 v77, 0xbf6c835e, v53
    v_sub_f32 v41, v16, v28
    v_sub_f32 v53, v48, v76
    v_add_f32 v16, v16, v28
    v_add_f32 v48, v48, v76
    v_sub_f32 v28, v83, v44
    v_sub_f32 v76, v81, v62
    v_add_f32 v83, v83, v44
    v_add_f32 v81, v81, v62
    v_mul_f32 v44, 0x3f3504f3, v28
    v_mul_f32 v62, 0xbf3504f3, v28
    v_fmac_f32 v44, 0x3f3504f3, v76
    v_fmac_f32 v62, 0x3f3504f3, v76
    v_sub_f32 v28, v72, v54
    v_sub_f32 v76, v30, v80
    v_add_f32 v80, v80, v30
    v_add_f32 v72, v72, v54
    v_sub_f32 v30, v40, v22
    v_sub_f32 v54, v60, v70
    v_add_f32 v40, v40, v22
    v_add_f32 v60, v60, v70
    v_mul_f32 v22, 0xbf3504f3, v30
    v_mul_f32 v70, 0xbf3504f3, v30
    v_fmac_f32 v22, 0x3f3504f3, v54
    v_fmac_f32 v70, 0xbf3504f3, v54
    v_sub_f32 v30, v42, v38
    v_sub_f32 v54, v49, v78
    v_add_f32 v42, v42, v38
    v_add_f32 v49, v49, v78
    v_sub_f32 v38, v46, v19
    v_sub_f32 v78, v63, v67
    v_add_f32 v46, v46, v19
    v_add_f32 v63, v63, v67
    v_mul_f32 v19, 0x3f3504f3, v38
    v_mul_f32 v67, 0xbf3504f3, v38
    v_fmac_f32 v19, 0x3f3504f3, v78
    v_fmac_f32 v67, 0x3f3504f3, v78
    v_sub_f32 v38, v55, v59
    v_sub_f32 v78, v35, v31
    v_add_f32 v31, v31, v35
    v_add_f32 v55, v55, v59
    v_sub_f32 v35, v23, v27
    v_sub_f32 v59, v71, v75
    v_add_f32 v23, v23, v27
    v_add_f32 v71, v71, v75
    v_mul_f32 v27, 0xbf3504f3, v35
    v_mul_f32 v75, 0xbf3504f3, v35
    v_fmac_f32 v27, 0x3f3504f3, v59
    v_fmac_f32 v75, 0xbf3504f3, v59
    v_sub_f32 v35, v32, v36
    v_sub_f32 v59, v64, v50
    v_add_f32 v32, v32, v36
    v_add_f32 v64, v64, v50
    v_sub_f32 v36, v47, v18
    v_sub_f32 v50, v56, v66
    v_add_f32 v47, v47, v18
    v_add_f32 v56, v56, v66
    v_mul_f32 v18, 0x3f3504f3, v36
    v_mul_f32 v66, 0xbf3504f3, v36
    v_fmac_f32 v18, 0x3f3504f3, v50
    v_fmac_f32 v66, 0x3f3504f3, v50
    v_sub_f32 v36, v52, v58
    v_sub_f32 v50, v34, v24
    v_add_f32 v24, v24, v34
    v_add_f32 v52, v52, v58
    v_sub_f32 v34, v20, v26
    v_sub_f32 v58, v68, v74
    v_add_f32 v20, v20, v26
    v_add_f32 v68, v68, v74
    v_mul_f32 v26, 0xbf3504f3, v34
    v_mul_f32 v74, 0xbf3504f3, v34
    v_fmac_f32 v26, 0x3f3504f3, v58
    v_fmac_f32 v74, 0xbf3504f3, v58
    v_sub_f32 v34, v39, v43
    v_sub_f32 v58, v51, v79
    v_add_f32 v39, v39, v43
    v_add_f32 v51, v51, v79
    v_sub_f32 v43, v17, v21
    v_sub_f32 v79, v65, v69
    v_add_f32 v17, v17, v21
    v_add_f32 v65, v65, v69
    v_mul_f32 v21, 0x3f3504f3, v43
    v_mul_f32 v69, 0xbf3504f3, v43
    v_fmac_f32 v21, 0x3f3504f3, v79
    v_fmac_f32 v69, 0x3f3504f3, v79
    v_sub_f32 v43, v57, v61
    v_sub_f32 v79, v37, v33
    v_add_f32 v33, v33, v37
    v_add_f32 v57, v57, v61
    v_sub_f32 v37, v25, v29
    v_sub_f32 v61, v73, v77
    v_add_f32 v25, v25, v29
    v_add_f32 v73, v73, v77
    v_mul_f32 v29, 0xbf3504f3, v37
    v_mul_f32 v77, 0xbf3504f3, v37
    v_fmac_f32 v29, 0x3f3504f3, v61
    v_fmac_f32 v77, 0xbf3504f3, v61
    v_sub_f32 v37, v16, v80
    v_sub_f32 v61, v48, v72
    v_add_f32 v16, v16, v80
    v_add_f32 v48, v48, v72
    v_sub_f32 v80, v81, v60
    v_sub_f32 v72, v40, v83
    v_add_f32 v83, v83, v40
    v_add_f32 v81, v81, v60
    v_sub_f32 v40, v41, v28
    v_sub_f32 v60, v53, v76
    v_add_f32 v41, v41, v28
    v_add_f32 v53, v53, v76
    v_sub_f32 v28, v62, v70
    v_sub_f32 v76, v22, v44
    v_add_f32 v44, v44, v22
    v_add_f32 v62, v62, v70
    v_sub_f32 v22, v42, v31
    v_sub_f32 v70, v49, v55
    v_add_f32 v42, v42, v31
    v_add_f32 v49, v49, v55
    v_sub_f32 v31, v63, v71
    v_sub_f32 v55, v23, v46
    v_add_f32 v46, v46, v23
    v_add_f32 v63, v63, v71
    v_sub_f32 v23, v30, v38
    v_sub_f32 v71, v54, v78
    v_add_f32 v30, v30, v38
    v_add_f32 v54, v54, v78
    v_sub_f32 v38, v67, v75
    v_sub_f32 v78, v27, v19
    v_add_f32 v19, v19, v27
    v_add_f32 v67, v67, v75
    v_sub_f32 v27, v32, v24
    v_sub_f32 v75, v64, v52
    v_add_f32 v32, v32, v24
    v_add_f32 v64, v64, v52
    v_sub_f32 v24, v56, v68
    v_sub_f32 v52, v20, v47
    v_add_f32 v47, v47, v20
    v_add_f32 v56, v56, v68
    v_sub_f32 v20, v35, v36
    v_sub_f32 v68, v59, v50
    v_add_f32 v35, v35, v36
    v_add_f32 v59, v59, v50
    v_sub_f32 v36, v66, v74
    v_sub_f32 v50, v26, v18
    v_add_f32 v18, v18, v26
    v_add_f32 v66, v66, v74
    v_sub_f32 v26, v39, v33
    v_sub_f32 v74, v51, v57
    v_add_f32 v39, v39, v33
    v_add_f32 v51, v51, v57
    v_sub_f32 v33, v65, v73
    v_sub_f32 v57, v25, v17
    v_add_f32 v17, v17, v25
    v_add_f32 v65, v65, v73
    v_sub_f32 v25, v34, v43
    v_sub_f32 v73, v58, v79
    v_add_f32 v34, v34, v43
    v_add_f32 v58, v58, v79
    v_sub_f32 v43, v69, v77
    v_sub_f32 v79, v29, v21
    v_add_f32 v21, v21, v29
    v_add_f32 v69, v69, v77
    v_sub_f32 v29, v16, v83
    v_sub_f32 v77, v48, v81
    v_add_f32 v16, v16, v83
    v_add_f32 v48, v48, v81
    v_sub_f32 v83, v37, v80
    v_sub_f32 v81, v61, v72
    v_add_f32 v37, v37, v80
    v_add_f32 v61, v61, v72
    v_sub_f32 v80, v41, v44
    v_sub_f32 v72, v53, v62
    v_add_f32 v41, v41, v44
    v_add_f32 v53, v53, v62
    v_sub_f32 v44, v40, v28
    v_sub_f32 v62, v60, v76
    v_add_f32 v40, v40, v28
    v_add_f32 v60, v60, v76
    v_sub_f32 v28, v42, v46
    v_sub_f32 v76, v49, v63
    v_add_f32 v42, v42, v46
    v_add_f32 v49, v49, v63
    v_sub_f32 v46, v22, v31
    v_sub_f32 v63, v70, v55
    v_add_f32 v22, v22, v31
    v_add_f32 v70, v70, v55
    v_sub_f32 v31, v30, v19
    v_sub_f32 v55, v54, v67
    v_add_f32 v30, v30, v19
    v_add_f32 v54, v54, v67
    v_sub_f32 v19, v23, v38
    v_sub_f32 v67, v71, v78
    v_add_f32 v23, v23, v38
    v_add_f32 v71, v71, v78
    v_sub_f32 v38, v32, v47
    v_sub_f32 v78, v64, v56
    v_add_f32 v32, v32, v47
    v_add_f32 v64, v64, v56
    v_sub_f32 v47, v27, v24
    v_sub_f32 v56, v75, v52
    v_add_f32 v27, v27, v24
    v_add_f32 v75, v75, v52
    v_sub_f32 v24, v35, v18
    v_sub_f32 v52, v59, v66
    v_add_f32 v35, v35, v18
    v_add_f32 v59, v59, v66
    v_sub_f32 v18, v20, v36
    v_sub_f32 v66, v68, v50
    v_add_f32 v20, v20, v36
    v_add_f32 v68, v68, v50
    v_sub_f32 v36, v39, v17
    v_sub_f32 v50, v51, v65
    v_add_f32 v39, v39, v17
    v_add_f32 v51, v51, v65
    v_sub_f32 v17, v26, v33
    v_sub_f32 v65, v74, v57
    v_add_f32 v26, v26, v33
    v_add_f32 v74, v74, v57
    v_sub_f32 v33, v34, v21
    v_sub_f32 v57, v58, v69
    v_add_f32 v34, v34, v21
    v_add_f32 v58, v58, v69
    v_sub_f32 v21, v25, v43
    v_sub_f32 v69, v73, v79
    v_add_f32 v25, v25, v43
    v_add_f32 v73, v73, v79
    ds_write_b32 v4, v16 offset:0
    ds_write_b32 v4, v48 offset:4
    ds_write_b32 v4, v32 offset:256
    ds_write_b32 v4, v64 offset:260
    ds_write_b32 v4, v42 offset:512
    ds_write_b32 v4, v49 offset:516
    ds_write_b32 v4, v39 offset:768
    ds_write_b32 v4, v51 offset:772
    ds_write_b32 v4, v41 offset:1024
    ds_write_b32 v4, v53 offset:1028
    ds_write_b32 v4, v35 offset:1280
    ds_write_b32 v4, v59 offset:1284
    ds_write_b32 v4, v30 offset:1536
    ds_write_b32 v4, v54 offset:1540
    ds_write_b32 v4, v34 offset:1792
    ds_write_b32 v4, v58 offset:1796
    ds_write_b32 v4, v37 offset:2048
    ds_write_b32 v4, v61 offset:2052
    ds_write_b32 v4, v27 offset:2304
    ds_write_b32 v4, v75 offset:2308
    ds_write_b32 v4, v22 offset:2560
    ds_write_b32 v4, v70 offset:2564
    ds_write_b32 v4, v26 offset:2816
    ds_write_b32 v4, v74 offset:2820
    ds_write_b32 v4, v40 offset:3072
    ds_write_b32 v4, v60 offset:3076
    ds_write_b32 v4, v20 offset:3328
    ds_write_b32 v4, v68 offset:3332
    ds_write_b32 v4, v23 offset:3584
    ds_write_b32 v4, v71 offset:3588
    ds_write_b32 v4, v25 offset:3840
    ds_write_b32 v4, v73 offset:3844
    ds_write_b32 v4, v29 offset:4096
    ds_write_b32 v4, v77 offset:4100
    ds_write_b32 v4, v38 offset:4352
    ds_write_b32 v4, v78 offset:4356
    ds_write_b32 v4, v28 offset:4608
    ds_write_b32 v4, v76 offset:4612
    ds_write_b32 v4, v36 offset:4864
    ds_write_b32 v4, v50 offset:4868
    ds_write_b32 v4, v80 offset:5120
    ds_write_b32 v4, v72 offset:5124
    ds_write_b32 v4, v24 offset:5376
    ds_write_b32 v4, v52 offset:5380
    ds_write_b32 v4, v31 offset:5632
    ds_write_b32 v4, v55 offset:5636
    ds_write_b32 v4, v33 offset:5888
    ds_write_b32 v4, v57 offset:5892
    ds_write_b32 v4, v83 offset:6144
    ds_write_b32 v4, v81 offset:6148
    ds_write_b32 v4, v47 offset:6400
    ds_write_b32 v4, v56 offset:6404
    ds_write_b32 v4, v46 offset:6656
    ds_write_b32 v4, v63 offset:6660
    ds_write_b32 v4, v17 offset:6912
    ds_write_b32 v4, v65 offset:6916
    ds_write_b32 v4, v44 offset:7168
    ds_write_b32 v4, v62 offset:7172
    ds_write_b32 v4, v18 offset:7424
    ds_write_b32 v4, v66 offset:7428
    ds_write_b32 v4, v19 offset:7680
    ds_write_b32 v4, v67 offset:7684
    ds_write_b32 v4, v21 offset:7936
    ds_write_b32 v4, v69 offset:7940
    s_waitcnt lgkmcnt(0)
    s_barrier
    v_and_b32 v6, 7, v0
    v_lshrrev_b32 v7, 3, v0
    s_movk_i32 s13, 8448
    v_mul_lo_u32 v8, v6, s13
    v_lshl_add_u32 v4, v7, 3, v8
    v_lshlrev_b32 v5, 14, v7
    v_lshl_add_u32 v5, v6, 4, v5
    s_lshl_b32 s12, s93, 7
    s_add_u32 s12, s12, 96468992
    v_sub_u32 v6, 1024, v7
    v_and_b32 v6, 1023, v6
    v_lshl_add_u32 v6, v6, 3, v8
    ds_read_b64 v[16:17], v4 offset:0
    ds_read_b64 v[18:19], v6
    s_waitcnt lgkmcnt(0)
    v_add_f32 v20, v16, v18
    v_sub_f32 v21, v17, v19
    v_add_f32 v22, v17, v19
    v_sub_f32 v23, v18, v16
    s_mov_b32 s13, s12
    s_add_u32 s13, s12, 0
    buffer_store_dwordx4 v[20:23], v5, s[8:11], s13 offen sc1
    s_nop 1
    v_sub_u32 v6, 992, v7
    v_and_b32 v6, 1023, v6
    v_lshl_add_u32 v6, v6, 3, v8
    ds_read_b64 v[16:17], v4 offset:256
    ds_read_b64 v[18:19], v6
    s_waitcnt lgkmcnt(0)
    v_add_f32 v20, v16, v18
    v_sub_f32 v21, v17, v19
    v_add_f32 v22, v17, v19
    v_sub_f32 v23, v18, v16
    s_mov_b32 s13, s12
    s_add_u32 s13, s12, 524288
    buffer_store_dwordx4 v[20:23], v5, s[8:11], s13 offen sc1
    s_nop 1
    v_sub_u32 v6, 960, v7
    v_and_b32 v6, 1023, v6
    v_lshl_add_u32 v6, v6, 3, v8
    ds_read_b64 v[16:17], v4 offset:512
    ds_read_b64 v[18:19], v6
    s_waitcnt lgkmcnt(0)
    v_add_f32 v20, v16, v18
    v_sub_f32 v21, v17, v19
    v_add_f32 v22, v17, v19
    v_sub_f32 v23, v18, v16
    s_mov_b32 s13, s12
    s_add_u32 s13, s12, 1048576
    buffer_store_dwordx4 v[20:23], v5, s[8:11], s13 offen sc1
    s_nop 1
    v_sub_u32 v6, 928, v7
    v_and_b32 v6, 1023, v6
    v_lshl_add_u32 v6, v6, 3, v8
    ds_read_b64 v[16:17], v4 offset:768
    ds_read_b64 v[18:19], v6
    s_waitcnt lgkmcnt(0)
    v_add_f32 v20, v16, v18
    v_sub_f32 v21, v17, v19
    v_add_f32 v22, v17, v19
    v_sub_f32 v23, v18, v16
    s_mov_b32 s13, s12
    s_add_u32 s13, s12, 1572864
    buffer_store_dwordx4 v[20:23], v5, s[8:11], s13 offen sc1
    s_nop 1
    v_sub_u32 v6, 896, v7
    v_and_b32 v6, 1023, v6
    v_lshl_add_u32 v6, v6, 3, v8
    ds_read_b64 v[16:17], v4 offset:1024
    ds_read_b64 v[18:19], v6
    s_waitcnt lgkmcnt(0)
    v_add_f32 v20, v16, v18
    v_sub_f32 v21, v17, v19
    v_add_f32 v22, v17, v19
    v_sub_f32 v23, v18, v16
    s_mov_b32 s13, s12
    s_add_u32 s13, s12, 2097152
    buffer_store_dwordx4 v[20:23], v5, s[8:11], s13 offen sc1
    s_nop 1
    v_sub_u32 v6, 864, v7
    v_and_b32 v6, 1023, v6
    v_lshl_add_u32 v6, v6, 3, v8
    ds_read_b64 v[16:17], v4 offset:1280
    ds_read_b64 v[18:19], v6
    s_waitcnt lgkmcnt(0)
    v_add_f32 v20, v16, v18
    v_sub_f32 v21, v17, v19
    v_add_f32 v22, v17, v19
    v_sub_f32 v23, v18, v16
    s_mov_b32 s13, s12
    s_add_u32 s13, s12, 2621440
    buffer_store_dwordx4 v[20:23], v5, s[8:11], s13 offen sc1
    s_nop 1
    v_sub_u32 v6, 832, v7
    v_and_b32 v6, 1023, v6
    v_lshl_add_u32 v6, v6, 3, v8
    ds_read_b64 v[16:17], v4 offset:1536
    ds_read_b64 v[18:19], v6
    s_waitcnt lgkmcnt(0)
    v_add_f32 v20, v16, v18
    v_sub_f32 v21, v17, v19
    v_add_f32 v22, v17, v19
    v_sub_f32 v23, v18, v16
    s_mov_b32 s13, s12
    s_add_u32 s13, s12, 3145728
    buffer_store_dwordx4 v[20:23], v5, s[8:11], s13 offen sc1
    s_nop 1
    v_sub_u32 v6, 800, v7
    v_and_b32 v6, 1023, v6
    v_lshl_add_u32 v6, v6, 3, v8
    ds_read_b64 v[16:17], v4 offset:1792
    ds_read_b64 v[18:19], v6
    s_waitcnt lgkmcnt(0)
    v_add_f32 v20, v16, v18
    v_sub_f32 v21, v17, v19
    v_add_f32 v22, v17, v19
    v_sub_f32 v23, v18, v16
    s_mov_b32 s13, s12
    s_add_u32 s13, s12, 3670016
    buffer_store_dwordx4 v[20:23], v5, s[8:11], s13 offen sc1
    s_nop 1
    v_sub_u32 v6, 768, v7
    v_and_b32 v6, 1023, v6
    v_lshl_add_u32 v6, v6, 3, v8
    ds_read_b64 v[16:17], v4 offset:2048
    ds_read_b64 v[18:19], v6
    s_waitcnt lgkmcnt(0)
    v_add_f32 v20, v16, v18
    v_sub_f32 v21, v17, v19
    v_add_f32 v22, v17, v19
    v_sub_f32 v23, v18, v16
    s_mov_b32 s13, s12
    s_add_u32 s13, s12, 4194304
    buffer_store_dwordx4 v[20:23], v5, s[8:11], s13 offen sc1
    s_nop 1
    v_sub_u32 v6, 736, v7
    v_and_b32 v6, 1023, v6
    v_lshl_add_u32 v6, v6, 3, v8
    ds_read_b64 v[16:17], v4 offset:2304
    ds_read_b64 v[18:19], v6
    s_waitcnt lgkmcnt(0)
    v_add_f32 v20, v16, v18
    v_sub_f32 v21, v17, v19
    v_add_f32 v22, v17, v19
    v_sub_f32 v23, v18, v16
    s_mov_b32 s13, s12
    s_add_u32 s13, s12, 4718592
    buffer_store_dwordx4 v[20:23], v5, s[8:11], s13 offen sc1
    s_nop 1
    v_sub_u32 v6, 704, v7
    v_and_b32 v6, 1023, v6
    v_lshl_add_u32 v6, v6, 3, v8
    ds_read_b64 v[16:17], v4 offset:2560
    ds_read_b64 v[18:19], v6
    s_waitcnt lgkmcnt(0)
    v_add_f32 v20, v16, v18
    v_sub_f32 v21, v17, v19
    v_add_f32 v22, v17, v19
    v_sub_f32 v23, v18, v16
    s_mov_b32 s13, s12
    s_add_u32 s13, s12, 5242880
    buffer_store_dwordx4 v[20:23], v5, s[8:11], s13 offen sc1
    s_nop 1
    v_sub_u32 v6, 672, v7
    v_and_b32 v6, 1023, v6
    v_lshl_add_u32 v6, v6, 3, v8
    ds_read_b64 v[16:17], v4 offset:2816
    ds_read_b64 v[18:19], v6
    s_waitcnt lgkmcnt(0)
    v_add_f32 v20, v16, v18
    v_sub_f32 v21, v17, v19
    v_add_f32 v22, v17, v19
    v_sub_f32 v23, v18, v16
    s_mov_b32 s13, s12
    s_add_u32 s13, s12, 5767168
    buffer_store_dwordx4 v[20:23], v5, s[8:11], s13 offen sc1
    s_nop 1
    v_sub_u32 v6, 640, v7
    v_and_b32 v6, 1023, v6
    v_lshl_add_u32 v6, v6, 3, v8
    ds_read_b64 v[16:17], v4 offset:3072
    ds_read_b64 v[18:19], v6
    s_waitcnt lgkmcnt(0)
    v_add_f32 v20, v16, v18
    v_sub_f32 v21, v17, v19
    v_add_f32 v22, v17, v19
    v_sub_f32 v23, v18, v16
    s_mov_b32 s13, s12
    s_add_u32 s13, s12, 6291456
    buffer_store_dwordx4 v[20:23], v5, s[8:11], s13 offen sc1
    s_nop 1
    v_sub_u32 v6, 608, v7
    v_and_b32 v6, 1023, v6
    v_lshl_add_u32 v6, v6, 3, v8
    ds_read_b64 v[16:17], v4 offset:3328
    ds_read_b64 v[18:19], v6
    s_waitcnt lgkmcnt(0)
    v_add_f32 v20, v16, v18
    v_sub_f32 v21, v17, v19
    v_add_f32 v22, v17, v19
    v_sub_f32 v23, v18, v16
    s_mov_b32 s13, s12
    s_add_u32 s13, s12, 6815744
    buffer_store_dwordx4 v[20:23], v5, s[8:11], s13 offen sc1
    s_nop 1
    v_sub_u32 v6, 576, v7
    v_and_b32 v6, 1023, v6
    v_lshl_add_u32 v6, v6, 3, v8
    ds_read_b64 v[16:17], v4 offset:3584
    ds_read_b64 v[18:19], v6
    s_waitcnt lgkmcnt(0)
    v_add_f32 v20, v16, v18
    v_sub_f32 v21, v17, v19
    v_add_f32 v22, v17, v19
    v_sub_f32 v23, v18, v16
    s_mov_b32 s13, s12
    s_add_u32 s13, s12, 7340032
    buffer_store_dwordx4 v[20:23], v5, s[8:11], s13 offen sc1
    s_nop 1
    v_sub_u32 v6, 544, v7
    v_and_b32 v6, 1023, v6
    v_lshl_add_u32 v6, v6, 3, v8
    ds_read_b64 v[16:17], v4 offset:3840
    ds_read_b64 v[18:19], v6
    s_waitcnt lgkmcnt(0)
    v_add_f32 v20, v16, v18
    v_sub_f32 v21, v17, v19
    v_add_f32 v22, v17, v19
    v_sub_f32 v23, v18, v16
    s_mov_b32 s13, s12
    s_add_u32 s13, s12, 7864320
    buffer_store_dwordx4 v[20:23], v5, s[8:11], s13 offen sc1
    s_nop 1
    v_sub_u32 v6, 512, v7
    v_and_b32 v6, 1023, v6
    v_lshl_add_u32 v6, v6, 3, v8
    ds_read_b64 v[16:17], v4 offset:4096
    ds_read_b64 v[18:19], v6
    s_waitcnt lgkmcnt(0)
    v_add_f32 v20, v16, v18
    v_sub_f32 v21, v17, v19
    v_add_f32 v22, v17, v19
    v_sub_f32 v23, v18, v16
    s_mov_b32 s13, s12
    v_cmp_eq_u32 vcc, 0, v7
    s_and_saveexec_b64 s[14:15], vcc
    s_add_u32 s13, s12, 8388608
    buffer_store_dwordx4 v[20:23], v5, s[8:11], s13 offen sc1
    s_nop 1
    s_mov_b64 exec, -1
    s_add_u32 s93, s93, 32
    s_cmp_lt_u32 s93, 128
    s_cbranch_scc1 mega_kernel_f1l
mega_kernel_f1e:
    s_add_u32 s93, s40, 0
    s_cmp_lt_u32 s93, 288
    s_cbranch_scc0 mega_kernel_f0e
mega_kernel_f0l:
    s_barrier
    s_load_dwordx2 s[4:5], s[0:1], 64
    s_load_dwordx2 s[8:9], s[0:1], 72
    s_load_dwordx2 s[12:13], s[0:1], 96
    s_and_b32 s16, s93, 31
    s_lshr_b32 s17, s93, 5
    v_and_b32 v1, 63, v0
    v_lshrrev_b32 v2, 6, v0
    s_waitcnt lgkmcnt(0)
    s_mov_b32 s6, 2101248
    s_mov_b32 s7, 0x00020000
    s_mov_b32 s10, 2101248
    s_mov_b32 s11, 0x00020000
    s_add_u32 s12, s12, 121634816
    s_addc_u32 s13, s13, 0
    s_mov_b32 s14, 4202496
    s_mov_b32 s15, 0x00020000
    s_lshl_b32 s18, s16, 6
    v_add_u32 v3, s18, v2
    s_movk_i32 s19, 1026
    v_mul_lo_u32 v3, v3, s19
    s_lshl_b32 s18, s17, 7
    v_add_u32 v3, s18, v3
    v_lshl_add_u32 v3, v1, 1, v3
    s_mov_b32 s18, 0
    buffer_load_ushort v16, v3, s[4:7], s18 offen
    buffer_load_ushort v32, v3, s[8:11], s18 offen
    s_mov_b32 s18, 4104
    buffer_load_ushort v17, v3, s[4:7], s18 offen
    buffer_load_ushort v33, v3, s[8:11], s18 offen
    s_mov_b32 s18, 8208
    buffer_load_ushort v18, v3, s[4:7], s18 offen
    buffer_load_ushort v34, v3, s[8:11], s18 offen
    s_mov_b32 s18, 12312
    buffer_load_ushort v19, v3, s[4:7], s18 offen
    buffer_load_ushort v35, v3, s[8:11], s18 offen
    s_mov_b32 s18, 16416
    buffer_load_ushort v20, v3, s[4:7], s18 offen
    buffer_load_ushort v36, v3, s[8:11], s18 offen
    s_mov_b32 s18, 20520
    buffer_load_ushort v21, v3, s[4:7], s18 offen
    buffer_load_ushort v37, v3, s[8:11], s18 offen
    s_mov_b32 s18, 24624
    buffer_load_ushort v22, v3, s[4:7], s18 offen
    buffer_load_ushort v38, v3, s[8:11], s18 offen
    s_mov_b32 s18, 28728
    buffer_load_ushort v23, v3, s[4:7], s18 offen
    buffer_load_ushort v39, v3, s[8:11], s18 offen
    s_mov_b32 s18, 32832
    buffer_load_ushort v24, v3, s[4:7], s18 offen
    buffer_load_ushort v40, v3, s[8:11], s18 offen
    s_mov_b32 s18, 36936
    buffer_load_ushort v25, v3, s[4:7], s18 offen
    buffer_load_ushort v41, v3, s[8:11], s18 offen
    s_mov_b32 s18, 41040
    buffer_load_ushort v26, v3, s[4:7], s18 offen
    buffer_load_ushort v42, v3, s[8:11], s18 offen
    s_mov_b32 s18, 45144
    buffer_load_ushort v27, v3, s[4:7], s18 offen
    buffer_load_ushort v43, v3, s[8:11], s18 offen
    s_mov_b32 s18, 49248
    buffer_load_ushort v28, v3, s[4:7], s18 offen
    buffer_load_ushort v44, v3, s[8:11], s18 offen
    s_mov_b32 s18, 53352
    buffer_load_ushort v29, v3, s[4:7], s18 offen
    buffer_load_ushort v45, v3, s[8:11], s18 offen
    s_mov_b32 s18, 57456
    buffer_load_ushort v30, v3, s[4:7], s18 offen
    buffer_load_ushort v46, v3, s[8:11], s18 offen
    s_mov_b32 s18, 61560
    buffer_load_ushort v31, v3, s[4:7], s18 offen
    buffer_load_ushort v47, v3, s[8:11], s18 offen
    v_mul_u32_u24 v4, 65, v1
    v_add_u32 v4, v4, v2
    v_lshlrev_b32 v4, 2, v4
    s_waitcnt vmcnt(0)
    v_lshl_or_b32 v16, v32, 16, v16
    ds_write_b32 v4, v16 offset:0
    v_lshl_or_b32 v17, v33, 16, v17
    ds_write_b32 v4, v17 offset:16
    v_lshl_or_b32 v18, v34, 16, v18
    ds_write_b32 v4, v18 offset:32
    v_lshl_or_b32 v19, v35, 16, v19
    ds_write_b32 v4, v19 offset:48
    v_lshl_or_b32 v20, v36, 16, v20
    ds_write_b32 v4, v20 offset:64
    v_lshl_or_b32 v21, v37, 16, v21
    ds_write_b32 v4, v21 offset:80
    v_lshl_or_b32 v22, v38, 16, v22
    ds_write_b32 v4, v22 offset:96
    v_lshl_or_b32 v23, v39, 16, v23
    ds_write_b32 v4, v23 offset:112
    v_lshl_or_b32 v24, v40, 16, v24
    ds_write_b32 v4, v24 offset:128
    v_lshl_or_b32 v25, v41, 16, v25
    ds_write_b32 v4, v25 offset:144
    v_lshl_or_b32 v26, v42, 16, v26
    ds_write_b32 v4, v26 offset:160
    v_lshl_or_b32 v27, v43, 16, v27
    ds_write_b32 v4, v27 offset:176
    v_lshl_or_b32 v28, v44, 16, v28
    ds_write_b32 v4, v28 offset:192
    v_lshl_or_b32 v29, v45, 16, v29
    ds_write_b32 v4, v29 offset:208
    v_lshl_or_b32 v30, v46, 16, v30
    ds_write_b32 v4, v30 offset:224
    v_lshl_or_b32 v31, v47, 16, v31
    ds_write_b32 v4, v31 offset:240
    v_lshrrev_b32 v7, 4, v0
    v_and_b32 v8, 15, v0
    v_mul_u32_u24 v5, 65, v7
    v_lshl_add_u32 v5, v8, 2, v5
    v_lshlrev_b32 v5, 2, v5
    s_waitcnt lgkmcnt(0)
    s_barrier
    ds_read_b32 v16, v5 offset:0
    ds_read_b32 v17, v5 offset:4
    ds_read_b32 v18, v5 offset:8
    ds_read_b32 v19, v5 offset:12
    ds_read_b32 v20, v5 offset:4160
    ds_read_b32 v21, v5 offset:4164
    ds_read_b32 v22, v5 offset:4168
    ds_read_b32 v23, v5 offset:4172
    ds_read_b32 v24, v5 offset:8320
    ds_read_b32 v25, v5 offset:8324
    ds_read_b32 v26, v5 offset:8328
    ds_read_b32 v27, v5 offset:8332
    ds_read_b32 v28, v5 offset:12480
    ds_read_b32 v29, v5 offset:12484
    ds_read_b32 v30, v5 offset:12488
    ds_read_b32 v31, v5 offset:12492
    s_lshl_b32 s18, s17, 6
    v_add_u32 v6, s18, v7
    v_lshlrev_b32 v6, 13, v6
    s_lshl_b32 s18, s16, 8
    v_add_u32 v6, s18, v6
    v_lshl_add_u32 v6, v8, 4, v6
    s_waitcnt lgkmcnt(0)
    s_mov_b32 s18, 0
    buffer_store_dwordx4 v[16:19], v6, s[12:15], s18 offen sc1
    s_mov_b32 s18, 131072
    buffer_store_dwordx4 v[20:23], v6, s[12:15], s18 offen sc1
    s_mov_b32 s18, 262144
    buffer_store_dwordx4 v[24:27], v6, s[12:15], s18 offen sc1
    s_mov_b32 s18, 393216
    buffer_store_dwordx4 v[28:31], v6, s[12:15], s18 offen sc1
    s_add_u32 s93, s93, 32
    s_cmp_lt_u32 s93, 288
    s_cbranch_scc1 mega_kernel_f0l
mega_kernel_f0e:
    v_and_b32 v3, 15, v0
    v_lshlrev_b32 v3, 4, v3
    s_branch mega_kernel_syd
    mega_kernel_sydw:
    s_sleep 4
    mega_kernel_syd:
    buffer_load_dword v2, v3, s[72:75], 0 offen sc1
    s_waitcnt vmcnt(0)
    s_cmp_eq_u32 s95, 1
    s_cbranch_scc0 mega_kernel_sydf
    v_readlane_b32 s76, v2, 14
    s_mov_b32 s98, 0
    s_cmp_eq_u32 s76, 64
    s_cbranch_scc0 mega_kernel_sydw
    s_branch mega_kernel_sydd
    mega_kernel_sydf:
    s_mov_b32 s77, 0
    s_mov_b32 s78, 0
    v_readlane_b32 s76, v2, 0
    s_add_u32 s77, s77, s76
    s_xor_b32 s76, s76, 32
    s_or_b32 s78, s78, s76
    v_readlane_b32 s76, v2, 1
    s_add_u32 s77, s77, s76
    s_xor_b32 s76, s76, 32
    s_or_b32 s78, s78, s76
    v_readlane_b32 s76, v2, 2
    s_add_u32 s77, s77, s76
    s_xor_b32 s76, s76, 32
    s_or_b32 s78, s78, s76
    v_readlane_b32 s76, v2, 3
    s_add_u32 s77, s77, s76
    s_xor_b32 s76, s76, 32
    s_or_b32 s78, s78, s76
    v_readlane_b32 s76, v2, 4
    s_add_u32 s77, s77, s76
    s_xor_b32 s76, s76, 32
    s_or_b32 s78, s78, s76
    v_readlane_b32 s76, v2, 5
    s_add_u32 s77, s77, s76
    s_xor_b32 s76, s76, 32
    s_or_b32 s78, s78, s76
    v_readlane_b32 s76, v2, 6
    s_add_u32 s77, s77, s76
    s_xor_b32 s76, s76, 32
    s_or_b32 s78, s78, s76
    v_readlane_b32 s76, v2, 7
    s_add_u32 s77, s77, s76
    s_xor_b32 s76, s76, 32
    s_or_b32 s78, s78, s76
    s_cmp_eq_u32 s77, 256
    s_cbranch_scc0 mega_kernel_sydw
    v_mov_b32 v252, v2
    s_cmp_eq_u32 s78, 0
    s_cbranch_scc0 mega_kernel_slowent
    v_readlane_b32 s76, v2, 10
    v_readlane_b32 s77, v2, 8
    s_cmp_eq_u32 s76, 64
    s_cbranch_scc0 mega_kernel_sydw
    s_cmp_gt_u32 s77, 32
    s_cselect_b32 s98, 1, 0
    mega_kernel_sydd:
    s_waitcnt vmcnt(0)
    s_barrier
    v_mov_b32 v1, 0
    v_mov_b32 v2, 1
    s_mov_b32 s82, 69259264
    v_cmp_eq_u32 vcc, 0, v0
    s_and_saveexec_b64 s[80:81], vcc
    s_cbranch_execz mega_kernel_sg0
    buffer_atomic_add v2, v1, s[84:87], s82 offen sc1
    mega_kernel_sg0:
    s_mov_b64 exec, s[80:81]
    s_add_u32 s38, s40, 128
    s_mov_b32 s39, 32
    s_mov_b32 s37, 129
    s_cmp_lt_u32 s38, 129
    s_cbranch_scc1 mega_kernel_f2s
    s_branch mega_kernel_f2e
mega_kernel_rk:
    s_load_dwordx2 s[4:5], s[0:1], 24
    s_load_dwordx2 s[8:9], s[0:1], 0
    v_lshrrev_b32 v2, 6, v0
    v_and_b32 v1, 63, v0
    v_readfirstlane_b32 s41, v2
    v_lshlrev_b32 v5, 4, v1
    s_waitcnt lgkmcnt(0)
    s_mov_b32 s6, 8388608
    s_mov_b32 s7, 0x00020000
    s_mov_b32 s10, 4194304
    s_mov_b32 s11, 0x00020000
    s_lshl_b32 s43, s40, 8
    s_lshl_b32 s44, s41, 6
    s_add_u32 s48, s43, s44
    s_and_b32 s43, s48, 0x7ff
    v_add_u32 v19, s43, v1
    v_lshlrev_b32 v19, 7, v19
    buffer_load_dword v20, v19, s[8:11], 0 offen
    v_lshrrev_b32 v2, 2, v1
    v_and_b32 v3, 3, v1
    v_lshlrev_b32 v16, 13, v2
    v_lshl_add_u32 v16, v3, 4, v16
    v_add_u32 v16, s48, v16
    v_and_b32 v3, 3, v1
    s_lshl_b32 s45, s41, 15
    v_bfe_u32 v17, v1, 2, 2
    v_lshrrev_b32 v18, 5, v1
    v_mul_u32_u24 v18, 8, v18
    v_add_u32 v17, v17, v18
    v_lshlrev_b32 v17, 6, v17
    v_bfe_u32 v18, v1, 4, 1
    v_lshl_add_u32 v17, v18, 5, v17
    v_and_b32 v18, 1, v1
    v_lshl_add_u32 v17, v18, 4, v17
    v_bfe_u32 v18, v1, 1, 1
    v_lshl_add_u32 v17, v18, 3, v17
    v_add_u32 v17, s45, v17
    s_and_b32 s43, s40, 3
    s_lshl_b32 s43, s43, 2
    s_add_u32 s43, s43, s41
    s_lshl_b32 s43, s43, 4
    v_and_b32 v23, 15, v1
    v_add_u32 v23, s43, v23
    s_lshr_b32 s43, s40, 2
    s_lshl_b32 s43, s43, 10
    s_add_u32 s44, s43, 896
    s_add_u32 s43, s43, 384
    s_cmp_ge_u32 s40, 28
    s_cselect_b32 s44, s44, s43
    v_mov_b32 v24, s43
    v_mov_b32 v25, s44
    v_cmp_gt_u32 vcc, 32, v1
    s_nop 1
    v_cndmask_b32 v24, v25, v24, vcc
    v_lshl_add_u32 v23, v23, 13, v24
    s_mov_b32 s44, 0
    buffer_load_dword v22, v23, s[4:7], s44 offen
    s_add_u32 m0, s45, 0
    s_mov_b32 s44, 0
    buffer_load_dwordx4 v16, s[4:7], s44 offen lds
    s_add_u32 m0, s45, 1024
    s_mov_b32 s44, 131072
    buffer_load_dwordx4 v16, s[4:7], s44 offen lds
    s_add_u32 m0, s45, 2048
    s_mov_b32 s44, 262144
    buffer_load_dwordx4 v16, s[4:7], s44 offen lds
    s_add_u32 m0, s45, 3072
    s_mov_b32 s44, 393216
    buffer_load_dwordx4 v16, s[4:7], s44 offen lds
    s_add_u32 m0, s45, 4096
    s_mov_b32 s44, 524288
    buffer_load_dwordx4 v16, s[4:7], s44 offen lds
    s_add_u32 m0, s45, 5120
    s_mov_b32 s44, 655360
    buffer_load_dwordx4 v16, s[4:7], s44 offen lds
    s_add_u32 m0, s45, 6144
    s_mov_b32 s44, 786432
    buffer_load_dwordx4 v16, s[4:7], s44 offen lds
    s_add_u32 m0, s45, 7168
    s_mov_b32 s44, 917504
    buffer_load_dwordx4 v16, s[4:7], s44 offen lds
    s_add_u32 m0, s45, 8192
    s_mov_b32 s44, 1048576
    buffer_load_dwordx4 v16, s[4:7], s44 offen lds
    s_add_u32 m0, s45, 9216
    s_mov_b32 s44, 1179648
    buffer_load_dwordx4 v16, s[4:7], s44 offen lds
    s_add_u32 m0, s45, 10240
    s_mov_b32 s44, 1310720
    buffer_load_dwordx4 v16, s[4:7], s44 offen lds
    s_add_u32 m0, s45, 11264
    s_mov_b32 s44, 1441792
    buffer_load_dwordx4 v16, s[4:7], s44 offen lds
    s_add_u32 m0, s45, 12288
    s_mov_b32 s44, 1572864
    buffer_load_dwordx4 v16, s[4:7], s44 offen lds
    s_add_u32 m0, s45, 13312
    s_mov_b32 s44, 1703936
    buffer_load_dwordx4 v16, s[4:7], s44 offen lds
    s_add_u32 m0, s45, 14336
    s_mov_b32 s44, 1835008
    buffer_load_dwordx4 v16, s[4:7], s44 offen lds
    s_add_u32 m0, s45, 15360
    s_mov_b32 s44, 1966080
    buffer_load_dwordx4 v16, s[4:7], s44 offen lds
    s_mov_b32 s44, 2097152
    buffer_load_dword v22, v23, s[4:7], s44 offen
    s_add_u32 m0, s45, 16384
    s_mov_b32 s44, 2097152
    buffer_load_dwordx4 v16, s[4:7], s44 offen lds
    s_add_u32 m0, s45, 17408
    s_mov_b32 s44, 2228224
    buffer_load_dwordx4 v16, s[4:7], s44 offen lds
    s_add_u32 m0, s45, 18432
    s_mov_b32 s44, 2359296
    buffer_load_dwordx4 v16, s[4:7], s44 offen lds
    s_add_u32 m0, s45, 19456
    s_mov_b32 s44, 2490368
    buffer_load_dwordx4 v16, s[4:7], s44 offen lds
    s_add_u32 m0, s45, 20480
    s_mov_b32 s44, 2621440
    buffer_load_dwordx4 v16, s[4:7], s44 offen lds
    s_add_u32 m0, s45, 21504
    s_mov_b32 s44, 2752512
    buffer_load_dwordx4 v16, s[4:7], s44 offen lds
    s_add_u32 m0, s45, 22528
    s_mov_b32 s44, 2883584
    buffer_load_dwordx4 v16, s[4:7], s44 offen lds
    s_add_u32 m0, s45, 23552
    s_mov_b32 s44, 3014656
    buffer_load_dwordx4 v16, s[4:7], s44 offen lds
    s_add_u32 m0, s45, 24576
    s_mov_b32 s44, 3145728
    buffer_load_dwordx4 v16, s[4:7], s44 offen lds
    s_add_u32 m0, s45, 25600
    s_mov_b32 s44, 3276800
    buffer_load_dwordx4 v16, s[4:7], s44 offen lds
    s_add_u32 m0, s45, 26624
    s_mov_b32 s44, 3407872
    buffer_load_dwordx4 v16, s[4:7], s44 offen lds
    s_add_u32 m0, s45, 27648
    s_mov_b32 s44, 3538944
    buffer_load_dwordx4 v16, s[4:7], s44 offen lds
    s_add_u32 m0, s45, 28672
    s_mov_b32 s44, 3670016
    buffer_load_dwordx4 v16, s[4:7], s44 offen lds
    s_add_u32 m0, s45, 29696
    s_mov_b32 s44, 3801088
    buffer_load_dwordx4 v16, s[4:7], s44 offen lds
    s_add_u32 m0, s45, 30720
    s_mov_b32 s44, 3932160
    buffer_load_dwordx4 v16, s[4:7], s44 offen lds
    s_add_u32 m0, s45, 31744
    s_mov_b32 s44, 4063232
    buffer_load_dwordx4 v16, s[4:7], s44 offen lds
    s_waitcnt vmcnt(17)
    ds_read_b64_tr_b16 a[0:1], v17 offset:0
    ds_read_b64_tr_b16 a[2:3], v17 offset:256
    ds_read_b64_tr_b16 a[4:5], v17 offset:1024
    ds_read_b64_tr_b16 a[6:7], v17 offset:1280
    ds_read_b64_tr_b16 a[8:9], v17 offset:2048
    ds_read_b64_tr_b16 a[10:11], v17 offset:2304
    ds_read_b64_tr_b16 a[12:13], v17 offset:3072
    ds_read_b64_tr_b16 a[14:15], v17 offset:3328
    s_waitcnt lgkmcnt(0)
    ds_read_b64_tr_b16 a[16:17], v17 offset:4096
    ds_read_b64_tr_b16 a[18:19], v17 offset:4352
    ds_read_b64_tr_b16 a[20:21], v17 offset:5120
    ds_read_b64_tr_b16 a[22:23], v17 offset:5376
    ds_read_b64_tr_b16 a[24:25], v17 offset:6144
    ds_read_b64_tr_b16 a[26:27], v17 offset:6400
    ds_read_b64_tr_b16 a[28:29], v17 offset:7168
    ds_read_b64_tr_b16 a[30:31], v17 offset:7424
    s_waitcnt lgkmcnt(0)
    ds_read_b64_tr_b16 a[32:33], v17 offset:8192
    ds_read_b64_tr_b16 a[34:35], v17 offset:8448
    ds_read_b64_tr_b16 a[36:37], v17 offset:9216
    ds_read_b64_tr_b16 a[38:39], v17 offset:9472
    ds_read_b64_tr_b16 a[40:41], v17 offset:10240
    ds_read_b64_tr_b16 a[42:43], v17 offset:10496
    ds_read_b64_tr_b16 a[44:45], v17 offset:11264
    ds_read_b64_tr_b16 a[46:47], v17 offset:11520
    s_waitcnt lgkmcnt(0)
    ds_read_b64_tr_b16 a[48:49], v17 offset:12288
    ds_read_b64_tr_b16 a[50:51], v17 offset:12544
    ds_read_b64_tr_b16 a[52:53], v17 offset:13312
    ds_read_b64_tr_b16 a[54:55], v17 offset:13568
    ds_read_b64_tr_b16 a[56:57], v17 offset:14336
    ds_read_b64_tr_b16 a[58:59], v17 offset:14592
    ds_read_b64_tr_b16 a[60:61], v17 offset:15360
    ds_read_b64_tr_b16 a[62:63], v17 offset:15616
    s_waitcnt lgkmcnt(0)
    s_mov_b32 s44, 4194304
    buffer_load_dword v22, v23, s[4:7], s44 offen
    s_add_u32 m0, s45, 0
    s_mov_b32 s44, 4194304
    buffer_load_dwordx4 v16, s[4:7], s44 offen lds
    s_add_u32 m0, s45, 1024
    s_mov_b32 s44, 4325376
    buffer_load_dwordx4 v16, s[4:7], s44 offen lds
    s_add_u32 m0, s45, 2048
    s_mov_b32 s44, 4456448
    buffer_load_dwordx4 v16, s[4:7], s44 offen lds
    s_add_u32 m0, s45, 3072
    s_mov_b32 s44, 4587520
    buffer_load_dwordx4 v16, s[4:7], s44 offen lds
    s_add_u32 m0, s45, 4096
    s_mov_b32 s44, 4718592
    buffer_load_dwordx4 v16, s[4:7], s44 offen lds
    s_add_u32 m0, s45, 5120
    s_mov_b32 s44, 4849664
    buffer_load_dwordx4 v16, s[4:7], s44 offen lds
    s_add_u32 m0, s45, 6144
    s_mov_b32 s44, 4980736
    buffer_load_dwordx4 v16, s[4:7], s44 offen lds
    s_add_u32 m0, s45, 7168
    s_mov_b32 s44, 5111808
    buffer_load_dwordx4 v16, s[4:7], s44 offen lds
    s_add_u32 m0, s45, 8192
    s_mov_b32 s44, 5242880
    buffer_load_dwordx4 v16, s[4:7], s44 offen lds
    s_add_u32 m0, s45, 9216
    s_mov_b32 s44, 5373952
    buffer_load_dwordx4 v16, s[4:7], s44 offen lds
    s_add_u32 m0, s45, 10240
    s_mov_b32 s44, 5505024
    buffer_load_dwordx4 v16, s[4:7], s44 offen lds
    s_add_u32 m0, s45, 11264
    s_mov_b32 s44, 5636096
    buffer_load_dwordx4 v16, s[4:7], s44 offen lds
    s_add_u32 m0, s45, 12288
    s_mov_b32 s44, 5767168
    buffer_load_dwordx4 v16, s[4:7], s44 offen lds
    s_add_u32 m0, s45, 13312
    s_mov_b32 s44, 5898240
    buffer_load_dwordx4 v16, s[4:7], s44 offen lds
    s_add_u32 m0, s45, 14336
    s_mov_b32 s44, 6029312
    buffer_load_dwordx4 v16, s[4:7], s44 offen lds
    s_add_u32 m0, s45, 15360
    s_mov_b32 s44, 6160384
    buffer_load_dwordx4 v16, s[4:7], s44 offen lds
    s_waitcnt vmcnt(17)
    ds_read_b64_tr_b16 a[64:65], v17 offset:16384
    ds_read_b64_tr_b16 a[66:67], v17 offset:16640
    ds_read_b64_tr_b16 a[68:69], v17 offset:17408
    ds_read_b64_tr_b16 a[70:71], v17 offset:17664
    ds_read_b64_tr_b16 a[72:73], v17 offset:18432
    ds_read_b64_tr_b16 a[74:75], v17 offset:18688
    ds_read_b64_tr_b16 a[76:77], v17 offset:19456
    ds_read_b64_tr_b16 a[78:79], v17 offset:19712
    s_waitcnt lgkmcnt(0)
    ds_read_b64_tr_b16 a[80:81], v17 offset:20480
    ds_read_b64_tr_b16 a[82:83], v17 offset:20736
    ds_read_b64_tr_b16 a[84:85], v17 offset:21504
    ds_read_b64_tr_b16 a[86:87], v17 offset:21760
    ds_read_b64_tr_b16 a[88:89], v17 offset:22528
    ds_read_b64_tr_b16 a[90:91], v17 offset:22784
    ds_read_b64_tr_b16 a[92:93], v17 offset:23552
    ds_read_b64_tr_b16 a[94:95], v17 offset:23808
    s_waitcnt lgkmcnt(0)
    ds_read_b64_tr_b16 a[96:97], v17 offset:24576
    ds_read_b64_tr_b16 a[98:99], v17 offset:24832
    ds_read_b64_tr_b16 a[100:101], v17 offset:25600
    ds_read_b64_tr_b16 a[102:103], v17 offset:25856
    ds_read_b64_tr_b16 a[104:105], v17 offset:26624
    ds_read_b64_tr_b16 a[106:107], v17 offset:26880
    ds_read_b64_tr_b16 a[108:109], v17 offset:27648
    ds_read_b64_tr_b16 a[110:111], v17 offset:27904
    s_waitcnt lgkmcnt(0)
    ds_read_b64_tr_b16 a[112:113], v17 offset:28672
    ds_read_b64_tr_b16 a[114:115], v17 offset:28928
    ds_read_b64_tr_b16 a[116:117], v17 offset:29696
    ds_read_b64_tr_b16 a[118:119], v17 offset:29952
    ds_read_b64_tr_b16 a[120:121], v17 offset:30720
    ds_read_b64_tr_b16 a[122:123], v17 offset:30976
    ds_read_b64_tr_b16 a[124:125], v17 offset:31744
    ds_read_b64_tr_b16 a[126:127], v17 offset:32000
    s_waitcnt lgkmcnt(0)
    s_mov_b32 s44, 6291456
    buffer_load_dword v22, v23, s[4:7], s44 offen
    s_add_u32 m0, s45, 16384
    s_mov_b32 s44, 6291456
    buffer_load_dwordx4 v16, s[4:7], s44 offen lds
    s_add_u32 m0, s45, 17408
    s_mov_b32 s44, 6422528
    buffer_load_dwordx4 v16, s[4:7], s44 offen lds
    s_add_u32 m0, s45, 18432
    s_mov_b32 s44, 6553600
    buffer_load_dwordx4 v16, s[4:7], s44 offen lds
    s_add_u32 m0, s45, 19456
    s_mov_b32 s44, 6684672
    buffer_load_dwordx4 v16, s[4:7], s44 offen lds
    s_add_u32 m0, s45, 20480
    s_mov_b32 s44, 6815744
    buffer_load_dwordx4 v16, s[4:7], s44 offen lds
    s_add_u32 m0, s45, 21504
    s_mov_b32 s44, 6946816
    buffer_load_dwordx4 v16, s[4:7], s44 offen lds
    s_add_u32 m0, s45, 22528
    s_mov_b32 s44, 7077888
    buffer_load_dwordx4 v16, s[4:7], s44 offen lds
    s_add_u32 m0, s45, 23552
    s_mov_b32 s44, 7208960
    buffer_load_dwordx4 v16, s[4:7], s44 offen lds
    s_add_u32 m0, s45, 24576
    s_mov_b32 s44, 7340032
    buffer_load_dwordx4 v16, s[4:7], s44 offen lds
    s_add_u32 m0, s45, 25600
    s_mov_b32 s44, 7471104
    buffer_load_dwordx4 v16, s[4:7], s44 offen lds
    s_add_u32 m0, s45, 26624
    s_mov_b32 s44, 7602176
    buffer_load_dwordx4 v16, s[4:7], s44 offen lds
    s_add_u32 m0, s45, 27648
    s_mov_b32 s44, 7733248
    buffer_load_dwordx4 v16, s[4:7], s44 offen lds
    s_add_u32 m0, s45, 28672
    s_mov_b32 s44, 7864320
    buffer_load_dwordx4 v16, s[4:7], s44 offen lds
    s_add_u32 m0, s45, 29696
    s_mov_b32 s44, 7995392
    buffer_load_dwordx4 v16, s[4:7], s44 offen lds
    s_add_u32 m0, s45, 30720
    s_mov_b32 s44, 8126464
    buffer_load_dwordx4 v16, s[4:7], s44 offen lds
    s_add_u32 m0, s45, 31744
    s_mov_b32 s44, 8257536
    buffer_load_dwordx4 v16, s[4:7], s44 offen lds
    s_waitcnt vmcnt(16)
    ds_read_b64_tr_b16 a[128:129], v17 offset:0
    ds_read_b64_tr_b16 a[130:131], v17 offset:256
    ds_read_b64_tr_b16 a[132:133], v17 offset:1024
    ds_read_b64_tr_b16 a[134:135], v17 offset:1280
    ds_read_b64_tr_b16 a[136:137], v17 offset:2048
    ds_read_b64_tr_b16 a[138:139], v17 offset:2304
    ds_read_b64_tr_b16 a[140:141], v17 offset:3072
    ds_read_b64_tr_b16 a[142:143], v17 offset:3328
    s_waitcnt lgkmcnt(0)
    ds_read_b64_tr_b16 a[144:145], v17 offset:4096
    ds_read_b64_tr_b16 a[146:147], v17 offset:4352
    ds_read_b64_tr_b16 a[148:149], v17 offset:5120
    ds_read_b64_tr_b16 a[150:151], v17 offset:5376
    ds_read_b64_tr_b16 a[152:153], v17 offset:6144
    ds_read_b64_tr_b16 a[154:155], v17 offset:6400
    ds_read_b64_tr_b16 a[156:157], v17 offset:7168
    ds_read_b64_tr_b16 a[158:159], v17 offset:7424
    s_waitcnt lgkmcnt(0)
    ds_read_b64_tr_b16 a[160:161], v17 offset:8192
    ds_read_b64_tr_b16 a[162:163], v17 offset:8448
    ds_read_b64_tr_b16 a[164:165], v17 offset:9216
    ds_read_b64_tr_b16 a[166:167], v17 offset:9472
    ds_read_b64_tr_b16 a[168:169], v17 offset:10240
    ds_read_b64_tr_b16 a[170:171], v17 offset:10496
    ds_read_b64_tr_b16 a[172:173], v17 offset:11264
    ds_read_b64_tr_b16 a[174:175], v17 offset:11520
    s_waitcnt lgkmcnt(0)
    ds_read_b64_tr_b16 a[176:177], v17 offset:12288
    ds_read_b64_tr_b16 a[178:179], v17 offset:12544
    ds_read_b64_tr_b16 a[180:181], v17 offset:13312
    ds_read_b64_tr_b16 a[182:183], v17 offset:13568
    ds_read_b64_tr_b16 a[184:185], v17 offset:14336
    ds_read_b64_tr_b16 a[186:187], v17 offset:14592
    ds_read_b64_tr_b16 a[188:189], v17 offset:15360
    ds_read_b64_tr_b16 a[190:191], v17 offset:15616
    s_waitcnt lgkmcnt(0)
    s_waitcnt vmcnt(0)
    ds_read_b64_tr_b16 a[192:193], v17 offset:16384
    ds_read_b64_tr_b16 a[194:195], v17 offset:16640
    ds_read_b64_tr_b16 a[196:197], v17 offset:17408
    ds_read_b64_tr_b16 a[198:199], v17 offset:17664
    ds_read_b64_tr_b16 a[200:201], v17 offset:18432
    ds_read_b64_tr_b16 a[202:203], v17 offset:18688
    ds_read_b64_tr_b16 a[204:205], v17 offset:19456
    ds_read_b64_tr_b16 a[206:207], v17 offset:19712
    s_waitcnt lgkmcnt(0)
    ds_read_b64_tr_b16 a[208:209], v17 offset:20480
    ds_read_b64_tr_b16 a[210:211], v17 offset:20736
    ds_read_b64_tr_b16 a[212:213], v17 offset:21504
    ds_read_b64_tr_b16 a[214:215], v17 offset:21760
    ds_read_b64_tr_b16 a[216:217], v17 offset:22528
    ds_read_b64_tr_b16 a[218:219], v17 offset:22784
    ds_read_b64_tr_b16 a[220:221], v17 offset:23552
    ds_read_b64_tr_b16 a[222:223], v17 offset:23808
    s_waitcnt lgkmcnt(0)
    ds_read_b64_tr_b16 a[224:225], v17 offset:24576
    ds_read_b64_tr_b16 a[226:227], v17 offset:24832
    ds_read_b64_tr_b16 a[228:229], v17 offset:25600
    ds_read_b64_tr_b16 a[230:231], v17 offset:25856
    ds_read_b64_tr_b16 a[232:233], v17 offset:26624
    ds_read_b64_tr_b16 a[234:235], v17 offset:26880
    ds_read_b64_tr_b16 a[236:237], v17 offset:27648
    ds_read_b64_tr_b16 a[238:239], v17 offset:27904
    s_waitcnt lgkmcnt(0)
    ds_read_b64_tr_b16 a[240:241], v17 offset:28672
    ds_read_b64_tr_b16 a[242:243], v17 offset:28928
    ds_read_b64_tr_b16 a[244:245], v17 offset:29696
    ds_read_b64_tr_b16 a[246:247], v17 offset:29952
    ds_read_b64_tr_b16 a[248:249], v17 offset:30720
    ds_read_b64_tr_b16 a[250:251], v17 offset:30976
    ds_read_b64_tr_b16 a[252:253], v17 offset:31744
    ds_read_b64_tr_b16 a[254:255], v17 offset:32000
    s_waitcnt lgkmcnt(0)
    s_barrier
    v_lshrrev_b32 v2, 3, v1
    s_lshl_b32 s43, s41, 3
    v_add_u32 v2, s43, v2
    v_bfe_u32 v3, v2, 1, 3
    v_and_b32 v4, 7, v1
    v_xor_b32 v3, v3, v4
    v_lshlrev_b32 v6, 11, v2
    v_lshl_add_u32 v6, v3, 4, v6
    s_lshl_b32 s46, s41, 10
    v_and_b32 v2, 15, v1
    v_bfe_u32 v3, v2, 1, 3
    v_lshrrev_b32 v4, 4, v1
    v_xor_b32 v3, v3, v4
    v_lshlrev_b32 v8, 7, v2
    v_lshl_add_u32 v8, v3, 4, v8
    v_xor_b32 v9, 64, v8
    v_add_u32 v10, 0x10000, v8
    v_add_u32 v11, 0x10000, v9
    v_mov_b32 v7, v5
    v_and_b32 v2, 31, v1
    v_bfe_u32 v3, v2, 1, 3
    v_lshrrev_b32 v4, 5, v1
    v_xor_b32 v3, v3, v4
    v_lshlrev_b32 v8, 7, v2
    v_lshl_add_u32 v8, v3, 4, v8
    v_xor_b32 v9, 32, v8
    v_xor_b32 v10, 64, v8
    v_xor_b32 v11, 96, v8
    v_add_u32 v12, 0x10000, v8
    v_add_u32 v13, 0x10000, v9
    v_add_u32 v14, 0x10000, v10
    v_add_u32 v15, 0x10000, v11
    v_bfe_u32 v3, v1, 4, 1
    v_lshlrev_b32 v7, 10, v3
    v_lshl_add_u32 v7, v4, 8, v7
    v_and_b32 v3, 15, v1
    v_lshl_add_u32 v7, v3, 4, v7
    s_lshl_b32 s47, s40, 2
    s_add_u32 s47, s47, s41
    s_mov_b32 s42, 0
    s_mov_b32 s50, 0
    s_add_u32 m0, s46, 0
    s_nop 0
    buffer_load_dwordx4 v6, s[8:11], s50 offen offset:0 lds
    s_add_u32 m0, s46, 3968
    s_nop 0
    buffer_load_dwordx4 v6, s[8:11], s50 offen offset:128 lds
    s_add_u32 m0, s46, 7936
    s_nop 0
    buffer_load_dwordx4 v6, s[8:11], s50 offen offset:256 lds
    s_add_u32 m0, s46, 11904
    s_nop 0
    buffer_load_dwordx4 v6, s[8:11], s50 offen offset:384 lds
    s_add_u32 m0, s46, 15872
    s_nop 0
    buffer_load_dwordx4 v6, s[8:11], s50 offen offset:512 lds
    s_add_u32 m0, s46, 19840
    s_nop 0
    buffer_load_dwordx4 v6, s[8:11], s50 offen offset:640 lds
    s_add_u32 m0, s46, 23808
    s_nop 0
    buffer_load_dwordx4 v6, s[8:11], s50 offen offset:768 lds
    s_add_u32 m0, s46, 27776
    s_nop 0
    buffer_load_dwordx4 v6, s[8:11], s50 offen offset:896 lds
    s_add_u32 m0, s46, 31744
    s_nop 0
    buffer_load_dwordx4 v6, s[8:11], s50 offen offset:1024 lds
    s_add_u32 m0, s46, 35712
    s_nop 0
    buffer_load_dwordx4 v6, s[8:11], s50 offen offset:1152 lds
    s_add_u32 m0, s46, 39680
    s_nop 0
    buffer_load_dwordx4 v6, s[8:11], s50 offen offset:1280 lds
    s_add_u32 m0, s46, 43648
    s_nop 0
    buffer_load_dwordx4 v6, s[8:11], s50 offen offset:1408 lds
    s_add_u32 m0, s46, 47616
    s_nop 0
    buffer_load_dwordx4 v6, s[8:11], s50 offen offset:1536 lds
    s_add_u32 m0, s46, 51584
    s_nop 0
    buffer_load_dwordx4 v6, s[8:11], s50 offen offset:1664 lds
    s_add_u32 m0, s46, 55552
    s_nop 0
    buffer_load_dwordx4 v6, s[8:11], s50 offen offset:1792 lds
    s_add_u32 m0, s46, 59520
    s_nop 0
    buffer_load_dwordx4 v6, s[8:11], s50 offen offset:1920 lds
    s_and_b32 s53, s47, 31
    s_lshl_b32 s53, s53, 4
    v_add_u32 v19, s53, v1
    v_lshlrev_b32 v19, 7, v19
    s_waitcnt vmcnt(0)
    s_barrier
    s_add_u32 s50, s42, 1
    s_min_u32 s50, s50, 63
    s_lshl_b32 s50, s50, 16
    ds_read_b128 v[20:23], v8 offset:0
    ds_read_b128 v[24:27], v9 offset:0
    ds_read_b128 v[28:31], v10 offset:0
    ds_read_b128 v[32:35], v11 offset:0
    ds_read_b128 v[36:39], v8 offset:4096
    ds_read_b128 v[40:43], v9 offset:4096
    s_waitcnt lgkmcnt(4)
    v_mfma_f32_32x32x16_bf16 v[52:67], a[0:3], v[20:23], 0
    ds_read_b128 v[44:47], v10 offset:4096
    v_mfma_f32_32x32x16_bf16 v[52:67], a[4:7], v[24:27], v[52:67]
    ds_read_b128 v[48:51], v11 offset:4096
    s_waitcnt lgkmcnt(4)
    v_mfma_f32_32x32x16_bf16 v[52:67], a[8:11], v[28:31], v[52:67]
    ds_read_b128 v[20:23], v8 offset:8192
    v_mfma_f32_32x32x16_bf16 v[52:67], a[12:15], v[32:35], v[52:67]
    ds_read_b128 v[24:27], v9 offset:8192
    s_waitcnt lgkmcnt(4)
    v_mfma_f32_32x32x16_bf16 v[52:67], a[16:19], v[36:39], v[52:67]
    ds_read_b128 v[28:31], v10 offset:8192
    v_mfma_f32_32x32x16_bf16 v[52:67], a[20:23], v[40:43], v[52:67]
    ds_read_b128 v[32:35], v11 offset:8192
    s_waitcnt lgkmcnt(4)
    v_mfma_f32_32x32x16_bf16 v[52:67], a[24:27], v[44:47], v[52:67]
    ds_read_b128 v[36:39], v8 offset:12288
    s_add_u32 m0, s46, 65536
    v_mfma_f32_32x32x16_bf16 v[52:67], a[28:31], v[48:51], v[52:67]
    ds_read_b128 v[40:43], v9 offset:12288
    buffer_load_dwordx4 v6, s[8:11], s50 offen offset:0 lds
    s_waitcnt lgkmcnt(4)
    v_mfma_f32_32x32x16_bf16 v[52:67], a[32:35], v[20:23], v[52:67]
    ds_read_b128 v[44:47], v10 offset:12288
    s_add_u32 m0, s46, 69504
    v_mfma_f32_32x32x16_bf16 v[52:67], a[36:39], v[24:27], v[52:67]
    ds_read_b128 v[48:51], v11 offset:12288
    buffer_load_dwordx4 v6, s[8:11], s50 offen offset:128 lds
    s_waitcnt lgkmcnt(4)
    v_mfma_f32_32x32x16_bf16 v[52:67], a[40:43], v[28:31], v[52:67]
    ds_read_b128 v[20:23], v8 offset:16384
    s_add_u32 m0, s46, 73472
    v_mfma_f32_32x32x16_bf16 v[52:67], a[44:47], v[32:35], v[52:67]
    ds_read_b128 v[24:27], v9 offset:16384
    buffer_load_dwordx4 v6, s[8:11], s50 offen offset:256 lds
    s_waitcnt lgkmcnt(4)
    v_mfma_f32_32x32x16_bf16 v[52:67], a[48:51], v[36:39], v[52:67]
    ds_read_b128 v[28:31], v10 offset:16384
    s_add_u32 m0, s46, 77440
    v_mfma_f32_32x32x16_bf16 v[52:67], a[52:55], v[40:43], v[52:67]
    ds_read_b128 v[32:35], v11 offset:16384
    buffer_load_dwordx4 v6, s[8:11], s50 offen offset:384 lds
    s_waitcnt lgkmcnt(4)
    v_mfma_f32_32x32x16_bf16 v[52:67], a[56:59], v[44:47], v[52:67]
    ds_read_b128 v[36:39], v8 offset:20480
    s_add_u32 m0, s46, 81408
    v_mfma_f32_32x32x16_bf16 v[52:67], a[60:63], v[48:51], v[52:67]
    ds_read_b128 v[40:43], v9 offset:20480
    buffer_load_dwordx4 v6, s[8:11], s50 offen offset:512 lds
    s_waitcnt lgkmcnt(4)
    v_mfma_f32_32x32x16_bf16 v[52:67], a[64:67], v[20:23], v[52:67]
    ds_read_b128 v[44:47], v10 offset:20480
    s_add_u32 m0, s46, 85376
    v_mfma_f32_32x32x16_bf16 v[52:67], a[68:71], v[24:27], v[52:67]
    ds_read_b128 v[48:51], v11 offset:20480
    buffer_load_dwordx4 v6, s[8:11], s50 offen offset:640 lds
    s_waitcnt lgkmcnt(4)
    v_mfma_f32_32x32x16_bf16 v[52:67], a[72:75], v[28:31], v[52:67]
    ds_read_b128 v[20:23], v8 offset:24576
    s_add_u32 m0, s46, 89344
    v_mfma_f32_32x32x16_bf16 v[52:67], a[76:79], v[32:35], v[52:67]
    ds_read_b128 v[24:27], v9 offset:24576
    buffer_load_dwordx4 v6, s[8:11], s50 offen offset:768 lds
    s_waitcnt lgkmcnt(4)
    v_mfma_f32_32x32x16_bf16 v[52:67], a[80:83], v[36:39], v[52:67]
    ds_read_b128 v[28:31], v10 offset:24576
    s_add_u32 m0, s46, 93312
    v_mfma_f32_32x32x16_bf16 v[52:67], a[84:87], v[40:43], v[52:67]
    ds_read_b128 v[32:35], v11 offset:24576
    buffer_load_dwordx4 v6, s[8:11], s50 offen offset:896 lds
    s_waitcnt lgkmcnt(4)
    v_mfma_f32_32x32x16_bf16 v[52:67], a[88:91], v[44:47], v[52:67]
    ds_read_b128 v[36:39], v8 offset:28672
    s_add_u32 m0, s46, 97280
    v_mfma_f32_32x32x16_bf16 v[52:67], a[92:95], v[48:51], v[52:67]
    ds_read_b128 v[40:43], v9 offset:28672
    buffer_load_dwordx4 v6, s[8:11], s50 offen offset:1024 lds
    s_waitcnt lgkmcnt(4)
    v_mfma_f32_32x32x16_bf16 v[52:67], a[96:99], v[20:23], v[52:67]
    ds_read_b128 v[44:47], v10 offset:28672
    s_add_u32 m0, s46, 101248
    v_mfma_f32_32x32x16_bf16 v[52:67], a[100:103], v[24:27], v[52:67]
    ds_read_b128 v[48:51], v11 offset:28672
    buffer_load_dwordx4 v6, s[8:11], s50 offen offset:1152 lds
    s_waitcnt lgkmcnt(4)
    v_mfma_f32_32x32x16_bf16 v[52:67], a[104:107], v[28:31], v[52:67]
    ds_read_b128 v[20:23], v8 offset:32768
    s_add_u32 m0, s46, 105216
    v_mfma_f32_32x32x16_bf16 v[52:67], a[108:111], v[32:35], v[52:67]
    ds_read_b128 v[24:27], v9 offset:32768
    buffer_load_dwordx4 v6, s[8:11], s50 offen offset:1280 lds
    s_waitcnt lgkmcnt(4)
    v_mfma_f32_32x32x16_bf16 v[52:67], a[112:115], v[36:39], v[52:67]
    ds_read_b128 v[28:31], v10 offset:32768
    s_add_u32 m0, s46, 109184
    v_mfma_f32_32x32x16_bf16 v[52:67], a[116:119], v[40:43], v[52:67]
    ds_read_b128 v[32:35], v11 offset:32768
    buffer_load_dwordx4 v6, s[8:11], s50 offen offset:1408 lds
    s_waitcnt lgkmcnt(4)
    v_mfma_f32_32x32x16_bf16 v[52:67], a[120:123], v[44:47], v[52:67]
    ds_read_b128 v[36:39], v8 offset:36864
    s_add_u32 m0, s46, 113152
    v_mfma_f32_32x32x16_bf16 v[52:67], a[124:127], v[48:51], v[52:67]
    ds_read_b128 v[40:43], v9 offset:36864
    buffer_load_dwordx4 v6, s[8:11], s50 offen offset:1536 lds
    s_waitcnt lgkmcnt(4)
    v_mfma_f32_32x32x16_bf16 v[52:67], a[128:131], v[20:23], v[52:67]
    ds_read_b128 v[44:47], v10 offset:36864
    s_add_u32 m0, s46, 117120
    v_mfma_f32_32x32x16_bf16 v[52:67], a[132:135], v[24:27], v[52:67]
    ds_read_b128 v[48:51], v11 offset:36864
    buffer_load_dwordx4 v6, s[8:11], s50 offen offset:1664 lds
    s_waitcnt lgkmcnt(4)
    v_mfma_f32_32x32x16_bf16 v[52:67], a[136:139], v[28:31], v[52:67]
    ds_read_b128 v[20:23], v8 offset:40960
    s_add_u32 m0, s46, 121088
    v_mfma_f32_32x32x16_bf16 v[52:67], a[140:143], v[32:35], v[52:67]
    ds_read_b128 v[24:27], v9 offset:40960
    buffer_load_dwordx4 v6, s[8:11], s50 offen offset:1792 lds
    s_waitcnt lgkmcnt(4)
    v_mfma_f32_32x32x16_bf16 v[52:67], a[144:147], v[36:39], v[52:67]
    ds_read_b128 v[28:31], v10 offset:40960
    s_add_u32 m0, s46, 125056
    v_mfma_f32_32x32x16_bf16 v[52:67], a[148:151], v[40:43], v[52:67]
    ds_read_b128 v[32:35], v11 offset:40960
    buffer_load_dwordx4 v6, s[8:11], s50 offen offset:1920 lds
    s_waitcnt lgkmcnt(4)
    v_mfma_f32_32x32x16_bf16 v[52:67], a[152:155], v[44:47], v[52:67]
    ds_read_b128 v[36:39], v8 offset:45056
    v_mfma_f32_32x32x16_bf16 v[52:67], a[156:159], v[48:51], v[52:67]
    ds_read_b128 v[40:43], v9 offset:45056
    s_waitcnt lgkmcnt(4)
    v_mfma_f32_32x32x16_bf16 v[52:67], a[160:163], v[20:23], v[52:67]
    ds_read_b128 v[44:47], v10 offset:45056
    v_mfma_f32_32x32x16_bf16 v[52:67], a[164:167], v[24:27], v[52:67]
    ds_read_b128 v[48:51], v11 offset:45056
    s_waitcnt lgkmcnt(4)
    v_mfma_f32_32x32x16_bf16 v[52:67], a[168:171], v[28:31], v[52:67]
    ds_read_b128 v[20:23], v8 offset:49152
    v_mfma_f32_32x32x16_bf16 v[52:67], a[172:175], v[32:35], v[52:67]
    ds_read_b128 v[24:27], v9 offset:49152
    s_waitcnt lgkmcnt(4)
    v_mfma_f32_32x32x16_bf16 v[52:67], a[176:179], v[36:39], v[52:67]
    ds_read_b128 v[28:31], v10 offset:49152
    s_add_u32 s53, s42, 3
    s_min_u32 s53, s53, 63
    s_lshl_b32 s53, s53, 16
    s_mov_b64 exec, 0xffff
    buffer_load_dword v18, v19, s[8:11], s53 offen
    s_mov_b64 exec, -1
    v_mfma_f32_32x32x16_bf16 v[52:67], a[180:183], v[40:43], v[52:67]
    ds_read_b128 v[32:35], v11 offset:49152
    s_waitcnt lgkmcnt(4)
    v_mfma_f32_32x32x16_bf16 v[52:67], a[184:187], v[44:47], v[52:67]
    ds_read_b128 v[36:39], v8 offset:53248
    v_mfma_f32_32x32x16_bf16 v[52:67], a[188:191], v[48:51], v[52:67]
    ds_read_b128 v[40:43], v9 offset:53248
    s_waitcnt lgkmcnt(4)
    v_mfma_f32_32x32x16_bf16 v[52:67], a[192:195], v[20:23], v[52:67]
    ds_read_b128 v[44:47], v10 offset:53248
    v_mfma_f32_32x32x16_bf16 v[52:67], a[196:199], v[24:27], v[52:67]
    ds_read_b128 v[48:51], v11 offset:53248
    s_waitcnt lgkmcnt(4)
    v_mfma_f32_32x32x16_bf16 v[52:67], a[200:203], v[28:31], v[52:67]
    ds_read_b128 v[20:23], v8 offset:57344
    v_mfma_f32_32x32x16_bf16 v[52:67], a[204:207], v[32:35], v[52:67]
    ds_read_b128 v[24:27], v9 offset:57344
    s_waitcnt lgkmcnt(4)
    v_mfma_f32_32x32x16_bf16 v[52:67], a[208:211], v[36:39], v[52:67]
    ds_read_b128 v[28:31], v10 offset:57344
    v_mfma_f32_32x32x16_bf16 v[52:67], a[212:215], v[40:43], v[52:67]
    ds_read_b128 v[32:35], v11 offset:57344
    s_waitcnt lgkmcnt(4)
    v_mfma_f32_32x32x16_bf16 v[52:67], a[216:219], v[44:47], v[52:67]
    ds_read_b128 v[36:39], v8 offset:61440
    v_mfma_f32_32x32x16_bf16 v[52:67], a[220:223], v[48:51], v[52:67]
    ds_read_b128 v[40:43], v9 offset:61440
    s_waitcnt lgkmcnt(4)
    v_mfma_f32_32x32x16_bf16 v[52:67], a[224:227], v[20:23], v[52:67]
    ds_read_b128 v[44:47], v10 offset:61440
    v_mfma_f32_32x32x16_bf16 v[52:67], a[228:231], v[24:27], v[52:67]
    ds_read_b128 v[48:51], v11 offset:61440
    s_waitcnt lgkmcnt(5)
    v_mfma_f32_32x32x16_bf16 v[52:67], a[232:235], v[28:31], v[52:67]
    s_waitcnt lgkmcnt(4)
    v_mfma_f32_32x32x16_bf16 v[52:67], a[236:239], v[32:35], v[52:67]
    s_waitcnt lgkmcnt(3)
    v_mfma_f32_32x32x16_bf16 v[52:67], a[240:243], v[36:39], v[52:67]
    s_waitcnt lgkmcnt(2)
    v_mfma_f32_32x32x16_bf16 v[52:67], a[244:247], v[40:43], v[52:67]
    s_waitcnt lgkmcnt(1)
    v_mfma_f32_32x32x16_bf16 v[52:67], a[248:251], v[44:47], v[52:67]
    s_waitcnt lgkmcnt(0)
    v_mfma_f32_32x32x16_bf16 v[52:67], a[252:255], v[48:51], v[52:67]
    s_add_u32 s42, s42, 1
    v_and_b32 v3, 15, v0
    v_lshlrev_b32 v3, 4, v3
    s_branch mega_kernel_syk
    mega_kernel_sykw:
    s_sleep 4
    mega_kernel_syk:
    buffer_load_dword v2, v3, s[72:75], 0 offen sc1
    s_waitcnt vmcnt(0)
    s_cmp_eq_u32 s95, 1
    s_cbranch_scc0 mega_kernel_sykf
    v_readlane_b32 s76, v2, 14
    s_mov_b32 s98, 0
    s_cmp_eq_u32 s76, 64
    s_cbranch_scc0 mega_kernel_sykw
    s_branch mega_kernel_sykd
    mega_kernel_sykf:
    s_mov_b32 s77, 0
    s_mov_b32 s78, 0
    v_readlane_b32 s76, v2, 0
    s_add_u32 s77, s77, s76
    s_xor_b32 s76, s76, 32
    s_or_b32 s78, s78, s76
    v_readlane_b32 s76, v2, 1
    s_add_u32 s77, s77, s76
    s_xor_b32 s76, s76, 32
    s_or_b32 s78, s78, s76
    v_readlane_b32 s76, v2, 2
    s_add_u32 s77, s77, s76
    s_xor_b32 s76, s76, 32
    s_or_b32 s78, s78, s76
    v_readlane_b32 s76, v2, 3
    s_add_u32 s77, s77, s76
    s_xor_b32 s76, s76, 32
    s_or_b32 s78, s78, s76
    v_readlane_b32 s76, v2, 4
    s_add_u32 s77, s77, s76
    s_xor_b32 s76, s76, 32
    s_or_b32 s78, s78, s76
    v_readlane_b32 s76, v2, 5
    s_add_u32 s77, s77, s76
    s_xor_b32 s76, s76, 32
    s_or_b32 s78, s78, s76
    v_readlane_b32 s76, v2, 6
    s_add_u32 s77, s77, s76
    s_xor_b32 s76, s76, 32
    s_or_b32 s78, s78, s76
    v_readlane_b32 s76, v2, 7
    s_add_u32 s77, s77, s76
    s_xor_b32 s76, s76, 32
    s_or_b32 s78, s78, s76
    s_cmp_eq_u32 s77, 256
    s_cbranch_scc0 mega_kernel_sykw
    v_mov_b32 v252, v2
    s_cmp_eq_u32 s78, 0
    s_cbranch_scc0 mega_kernel_slowent
    v_readlane_b32 s76, v2, 10
    v_readlane_b32 s77, v2, 8
    s_cmp_eq_u32 s76, 64
    s_cbranch_scc0 mega_kernel_sykw
    s_cmp_gt_u32 s77, 32
    s_cselect_b32 s98, 1, 0
    mega_kernel_sykd:
    s_lshr_b32 s44, s47, 3
    s_xor_b32 s44, s44, s98
    s_and_b32 s44, s44, 1
    s_lshl_b32 s44, s44, 13
    s_lshl_b32 s48, s47, 18
    s_add_u32 s48, s48, s44
    s_add_u32 s48, s48, 0
    s_xor_b32 s44, s98, 1
    s_lshl_b32 s44, s44, 13
    s_lshl_b32 s49, s40, 7
    s_add_u32 s49, s49, s44
    s_lshl_b32 s44, s41, 2
    s_add_u32 s49, s49, s44
    s_add_u32 s49, s49, 69206016
    v_mov_b32 v16, 0
    v_cvt_pk_bf16_f32 v84, v52, v53
    v_cvt_pk_bf16_f32 v85, v54, v55
    v_cvt_pk_bf16_f32 v86, v56, v57
    v_cvt_pk_bf16_f32 v87, v58, v59
    v_cvt_pk_bf16_f32 v88, v60, v61
    v_cvt_pk_bf16_f32 v89, v62, v63
    v_cvt_pk_bf16_f32 v90, v64, v65
    v_cvt_pk_bf16_f32 v91, v66, v67
    s_add_u32 s51, s42, s47
    s_sub_u32 s51, s51, 1
    s_bfe_u32 s52, s51, 0x40002
    s_lshl_b32 s52, s52, 14
    s_and_b32 s51, s51, 3
    s_lshl_b32 s51, s51, 11
    s_add_u32 s51, s51, s52
    s_add_u32 s51, s51, s48
    buffer_store_dwordx4 v[84:87], v7, s[84:87], s51 offen sc1
    buffer_store_dwordx4 v[88:91], v7, s[84:87], s51 offen offset:512 sc1
    s_waitcnt vmcnt(0)
    v_mov_b32 v17, s42
    s_mov_b64 exec, 1
    buffer_store_dword v17, v16, s[84:87], s49 offen sc1
    s_mov_b64 exec, -1
mega_kernel_k_loop:
    s_waitcnt vmcnt(2)
    s_barrier
    s_add_u32 s50, s42, 1
    s_min_u32 s50, s50, 63
    s_lshl_b32 s50, s50, 16
    ds_read_b128 v[20:23], v12 offset:0
    ds_read_b128 v[24:27], v13 offset:0
    ds_read_b128 v[28:31], v14 offset:0
    ds_read_b128 v[32:35], v15 offset:0
    ds_read_b128 v[36:39], v12 offset:4096
    ds_read_b128 v[40:43], v13 offset:4096
    s_waitcnt lgkmcnt(4)
    v_mfma_f32_32x32x16_bf16 v[68:83], a[0:3], v[20:23], 0
    ds_read_b128 v[44:47], v14 offset:4096
    v_cvt_pk_bf16_f32 v84, v52, v53
    v_cvt_pk_bf16_f32 v85, v54, v55
    v_cvt_pk_bf16_f32 v86, v56, v57
    v_mfma_f32_32x32x16_bf16 v[68:83], a[4:7], v[24:27], v[68:83]
    ds_read_b128 v[48:51], v15 offset:4096
    v_cvt_pk_bf16_f32 v87, v58, v59
    v_cvt_pk_bf16_f32 v88, v60, v61
    v_cvt_pk_bf16_f32 v89, v62, v63
    s_waitcnt lgkmcnt(4)
    v_mfma_f32_32x32x16_bf16 v[68:83], a[8:11], v[28:31], v[68:83]
    ds_read_b128 v[20:23], v12 offset:8192
    v_cvt_pk_bf16_f32 v90, v64, v65
    v_cvt_pk_bf16_f32 v91, v66, v67
    v_mfma_f32_32x32x16_bf16 v[68:83], a[12:15], v[32:35], v[68:83]
    ds_read_b128 v[24:27], v13 offset:8192
    s_add_u32 s51, s42, s47
    s_sub_u32 s51, s51, 1
    s_bfe_u32 s52, s51, 0x40002
    s_lshl_b32 s52, s52, 14
    s_waitcnt lgkmcnt(4)
    v_mfma_f32_32x32x16_bf16 v[68:83], a[16:19], v[36:39], v[68:83]
    ds_read_b128 v[28:31], v14 offset:8192
    s_and_b32 s51, s51, 3
    s_lshl_b32 s51, s51, 11
    s_add_u32 s51, s51, s52
    s_add_u32 s51, s51, s48
    buffer_store_dwordx4 v[84:87], v7, s[84:87], s51 offen sc1
    v_mfma_f32_32x32x16_bf16 v[68:83], a[20:23], v[40:43], v[68:83]
    ds_read_b128 v[32:35], v15 offset:8192
    buffer_store_dwordx4 v[88:91], v7, s[84:87], s51 offen offset:512 sc1
    s_waitcnt lgkmcnt(4)
    v_mfma_f32_32x32x16_bf16 v[68:83], a[24:27], v[44:47], v[68:83]
    ds_read_b128 v[36:39], v12 offset:12288
    s_add_u32 m0, s46, 0
    v_mfma_f32_32x32x16_bf16 v[68:83], a[28:31], v[48:51], v[68:83]
    ds_read_b128 v[40:43], v13 offset:12288
    buffer_load_dwordx4 v6, s[8:11], s50 offen offset:0 lds
    s_waitcnt lgkmcnt(4)
    v_mfma_f32_32x32x16_bf16 v[68:83], a[32:35], v[20:23], v[68:83]
    ds_read_b128 v[44:47], v14 offset:12288
    s_add_u32 m0, s46, 3968
    v_mfma_f32_32x32x16_bf16 v[68:83], a[36:39], v[24:27], v[68:83]
    ds_read_b128 v[48:51], v15 offset:12288
    buffer_load_dwordx4 v6, s[8:11], s50 offen offset:128 lds
    s_waitcnt lgkmcnt(4)
    v_mfma_f32_32x32x16_bf16 v[68:83], a[40:43], v[28:31], v[68:83]
    ds_read_b128 v[20:23], v12 offset:16384
    s_add_u32 m0, s46, 7936
    v_mfma_f32_32x32x16_bf16 v[68:83], a[44:47], v[32:35], v[68:83]
    ds_read_b128 v[24:27], v13 offset:16384
    buffer_load_dwordx4 v6, s[8:11], s50 offen offset:256 lds
    s_waitcnt lgkmcnt(4)
    v_mfma_f32_32x32x16_bf16 v[68:83], a[48:51], v[36:39], v[68:83]
    ds_read_b128 v[28:31], v14 offset:16384
    s_add_u32 m0, s46, 11904
    v_mfma_f32_32x32x16_bf16 v[68:83], a[52:55], v[40:43], v[68:83]
    ds_read_b128 v[32:35], v15 offset:16384
    buffer_load_dwordx4 v6, s[8:11], s50 offen offset:384 lds
    s_waitcnt lgkmcnt(4)
    v_mfma_f32_32x32x16_bf16 v[68:83], a[56:59], v[44:47], v[68:83]
    ds_read_b128 v[36:39], v12 offset:20480
    s_add_u32 m0, s46, 15872
    v_mfma_f32_32x32x16_bf16 v[68:83], a[60:63], v[48:51], v[68:83]
    ds_read_b128 v[40:43], v13 offset:20480
    buffer_load_dwordx4 v6, s[8:11], s50 offen offset:512 lds
    s_waitcnt lgkmcnt(4)
    v_mfma_f32_32x32x16_bf16 v[68:83], a[64:67], v[20:23], v[68:83]
    ds_read_b128 v[44:47], v14 offset:20480
    s_add_u32 m0, s46, 19840
    v_mfma_f32_32x32x16_bf16 v[68:83], a[68:71], v[24:27], v[68:83]
    ds_read_b128 v[48:51], v15 offset:20480
    buffer_load_dwordx4 v6, s[8:11], s50 offen offset:640 lds
    s_waitcnt lgkmcnt(4)
    v_mfma_f32_32x32x16_bf16 v[68:83], a[72:75], v[28:31], v[68:83]
    ds_read_b128 v[20:23], v12 offset:24576
    s_add_u32 m0, s46, 23808
    v_mfma_f32_32x32x16_bf16 v[68:83], a[76:79], v[32:35], v[68:83]
    ds_read_b128 v[24:27], v13 offset:24576
    buffer_load_dwordx4 v6, s[8:11], s50 offen offset:768 lds
    s_waitcnt lgkmcnt(4)
    v_mfma_f32_32x32x16_bf16 v[68:83], a[80:83], v[36:39], v[68:83]
    ds_read_b128 v[28:31], v14 offset:24576
    s_add_u32 m0, s46, 27776
    v_mfma_f32_32x32x16_bf16 v[68:83], a[84:87], v[40:43], v[68:83]
    ds_read_b128 v[32:35], v15 offset:24576
    buffer_load_dwordx4 v6, s[8:11], s50 offen offset:896 lds
    s_waitcnt lgkmcnt(4)
    v_mfma_f32_32x32x16_bf16 v[68:83], a[88:91], v[44:47], v[68:83]
    ds_read_b128 v[36:39], v12 offset:28672
    s_add_u32 m0, s46, 31744
    v_mfma_f32_32x32x16_bf16 v[68:83], a[92:95], v[48:51], v[68:83]
    ds_read_b128 v[40:43], v13 offset:28672
    buffer_load_dwordx4 v6, s[8:11], s50 offen offset:1024 lds
    s_waitcnt lgkmcnt(4)
    v_mfma_f32_32x32x16_bf16 v[68:83], a[96:99], v[20:23], v[68:83]
    ds_read_b128 v[44:47], v14 offset:28672
    s_add_u32 m0, s46, 35712
    v_mfma_f32_32x32x16_bf16 v[68:83], a[100:103], v[24:27], v[68:83]
    ds_read_b128 v[48:51], v15 offset:28672
    buffer_load_dwordx4 v6, s[8:11], s50 offen offset:1152 lds
    s_waitcnt lgkmcnt(4)
    v_mfma_f32_32x32x16_bf16 v[68:83], a[104:107], v[28:31], v[68:83]
    ds_read_b128 v[20:23], v12 offset:32768
    s_add_u32 m0, s46, 39680
    v_mfma_f32_32x32x16_bf16 v[68:83], a[108:111], v[32:35], v[68:83]
    ds_read_b128 v[24:27], v13 offset:32768
    buffer_load_dwordx4 v6, s[8:11], s50 offen offset:1280 lds
    s_waitcnt lgkmcnt(4)
    v_mfma_f32_32x32x16_bf16 v[68:83], a[112:115], v[36:39], v[68:83]
    ds_read_b128 v[28:31], v14 offset:32768
    s_add_u32 m0, s46, 43648
    v_mfma_f32_32x32x16_bf16 v[68:83], a[116:119], v[40:43], v[68:83]
    ds_read_b128 v[32:35], v15 offset:32768
    buffer_load_dwordx4 v6, s[8:11], s50 offen offset:1408 lds
    s_waitcnt lgkmcnt(4)
    v_mfma_f32_32x32x16_bf16 v[68:83], a[120:123], v[44:47], v[68:83]
    ds_read_b128 v[36:39], v12 offset:36864
    s_add_u32 m0, s46, 47616
    v_mfma_f32_32x32x16_bf16 v[68:83], a[124:127], v[48:51], v[68:83]
    ds_read_b128 v[40:43], v13 offset:36864
    buffer_load_dwordx4 v6, s[8:11], s50 offen offset:1536 lds
    s_waitcnt lgkmcnt(4)
    v_mfma_f32_32x32x16_bf16 v[68:83], a[128:131], v[20:23], v[68:83]
    ds_read_b128 v[44:47], v14 offset:36864
    s_add_u32 m0, s46, 51584
    v_mfma_f32_32x32x16_bf16 v[68:83], a[132:135], v[24:27], v[68:83]
    ds_read_b128 v[48:51], v15 offset:36864
    buffer_load_dwordx4 v6, s[8:11], s50 offen offset:1664 lds
    s_waitcnt lgkmcnt(4)
    v_mfma_f32_32x32x16_bf16 v[68:83], a[136:139], v[28:31], v[68:83]
    ds_read_b128 v[20:23], v12 offset:40960
    s_add_u32 m0, s46, 55552
    v_mfma_f32_32x32x16_bf16 v[68:83], a[140:143], v[32:35], v[68:83]
    ds_read_b128 v[24:27], v13 offset:40960
    buffer_load_dwordx4 v6, s[8:11], s50 offen offset:1792 lds
    s_waitcnt lgkmcnt(4)
    v_mfma_f32_32x32x16_bf16 v[68:83], a[144:147], v[36:39], v[68:83]
    ds_read_b128 v[28:31], v14 offset:40960
    s_add_u32 m0, s46, 59520
    v_mfma_f32_32x32x16_bf16 v[68:83], a[148:151], v[40:43], v[68:83]
    ds_read_b128 v[32:35], v15 offset:40960
    buffer_load_dwordx4 v6, s[8:11], s50 offen offset:1920 lds
    s_waitcnt lgkmcnt(4)
    v_mfma_f32_32x32x16_bf16 v[68:83], a[152:155], v[44:47], v[68:83]
    ds_read_b128 v[36:39], v12 offset:45056
    v_mfma_f32_32x32x16_bf16 v[68:83], a[156:159], v[48:51], v[68:83]
    ds_read_b128 v[40:43], v13 offset:45056
    s_waitcnt lgkmcnt(4)
    v_mfma_f32_32x32x16_bf16 v[68:83], a[160:163], v[20:23], v[68:83]
    ds_read_b128 v[44:47], v14 offset:45056
    v_mfma_f32_32x32x16_bf16 v[68:83], a[164:167], v[24:27], v[68:83]
    ds_read_b128 v[48:51], v15 offset:45056
    s_waitcnt lgkmcnt(4)
    v_mfma_f32_32x32x16_bf16 v[68:83], a[168:171], v[28:31], v[68:83]
    ds_read_b128 v[20:23], v12 offset:49152
    s_waitcnt vmcnt(16)
    v_mov_b32 v17, s42
    s_mov_b64 exec, 1
    buffer_store_dword v17, v16, s[84:87], s49 offen sc1
    s_mov_b64 exec, -1
    v_mfma_f32_32x32x16_bf16 v[68:83], a[172:175], v[32:35], v[68:83]
    ds_read_b128 v[24:27], v13 offset:49152
    s_waitcnt lgkmcnt(4)
    v_mfma_f32_32x32x16_bf16 v[68:83], a[176:179], v[36:39], v[68:83]
    ds_read_b128 v[28:31], v14 offset:49152
    s_add_u32 s53, s42, 3
    s_min_u32 s53, s53, 63
    s_lshl_b32 s53, s53, 16
    s_mov_b64 exec, 0xffff
    buffer_load_dword v18, v19, s[8:11], s53 offen
    s_mov_b64 exec, -1
    v_mfma_f32_32x32x16_bf16 v[68:83], a[180:183], v[40:43], v[68:83]
    ds_read_b128 v[32:35], v15 offset:49152
    s_waitcnt lgkmcnt(4)
    v_mfma_f32_32x32x16_bf16 v[68:83], a[184:187], v[44:47], v[68:83]
    ds_read_b128 v[36:39], v12 offset:53248
    v_mfma_f32_32x32x16_bf16 v[68:83], a[188:191], v[48:51], v[68:83]
    ds_read_b128 v[40:43], v13 offset:53248
    s_waitcnt lgkmcnt(4)
    v_mfma_f32_32x32x16_bf16 v[68:83], a[192:195], v[20:23], v[68:83]
    ds_read_b128 v[44:47], v14 offset:53248
    v_mfma_f32_32x32x16_bf16 v[68:83], a[196:199], v[24:27], v[68:83]
    ds_read_b128 v[48:51], v15 offset:53248
    s_waitcnt lgkmcnt(4)
    v_mfma_f32_32x32x16_bf16 v[68:83], a[200:203], v[28:31], v[68:83]
    ds_read_b128 v[20:23], v12 offset:57344
    v_mfma_f32_32x32x16_bf16 v[68:83], a[204:207], v[32:35], v[68:83]
    ds_read_b128 v[24:27], v13 offset:57344
    s_waitcnt lgkmcnt(4)
    v_mfma_f32_32x32x16_bf16 v[68:83], a[208:211], v[36:39], v[68:83]
    ds_read_b128 v[28:31], v14 offset:57344
    v_mfma_f32_32x32x16_bf16 v[68:83], a[212:215], v[40:43], v[68:83]
    ds_read_b128 v[32:35], v15 offset:57344
    s_waitcnt lgkmcnt(4)
    v_mfma_f32_32x32x16_bf16 v[68:83], a[216:219], v[44:47], v[68:83]
    ds_read_b128 v[36:39], v12 offset:61440
    v_mfma_f32_32x32x16_bf16 v[68:83], a[220:223], v[48:51], v[68:83]
    ds_read_b128 v[40:43], v13 offset:61440
    s_waitcnt lgkmcnt(4)
    v_mfma_f32_32x32x16_bf16 v[68:83], a[224:227], v[20:23], v[68:83]
    ds_read_b128 v[44:47], v14 offset:61440
    v_mfma_f32_32x32x16_bf16 v[68:83], a[228:231], v[24:27], v[68:83]
    ds_read_b128 v[48:51], v15 offset:61440
    s_waitcnt lgkmcnt(5)
    v_mfma_f32_32x32x16_bf16 v[68:83], a[232:235], v[28:31], v[68:83]
    s_waitcnt lgkmcnt(4)
    v_mfma_f32_32x32x16_bf16 v[68:83], a[236:239], v[32:35], v[68:83]
    s_waitcnt lgkmcnt(3)
    v_mfma_f32_32x32x16_bf16 v[68:83], a[240:243], v[36:39], v[68:83]
    s_waitcnt lgkmcnt(2)
    v_mfma_f32_32x32x16_bf16 v[68:83], a[244:247], v[40:43], v[68:83]
    s_waitcnt lgkmcnt(1)
    v_mfma_f32_32x32x16_bf16 v[68:83], a[248:251], v[44:47], v[68:83]
    s_waitcnt lgkmcnt(0)
    v_mfma_f32_32x32x16_bf16 v[68:83], a[252:255], v[48:51], v[68:83]
    s_add_u32 s42, s42, 1
    s_cmp_eq_u32 s42, 64
    s_cbranch_scc1 mega_kernel_k_fin
    s_waitcnt vmcnt(2)
    s_barrier
    s_add_u32 s50, s42, 1
    s_min_u32 s50, s50, 63
    s_lshl_b32 s50, s50, 16
    ds_read_b128 v[20:23], v8 offset:0
    ds_read_b128 v[24:27], v9 offset:0
    ds_read_b128 v[28:31], v10 offset:0
    ds_read_b128 v[32:35], v11 offset:0
    ds_read_b128 v[36:39], v8 offset:4096
    ds_read_b128 v[40:43], v9 offset:4096
    s_waitcnt lgkmcnt(4)
    v_mfma_f32_32x32x16_bf16 v[52:67], a[0:3], v[20:23], 0
    ds_read_b128 v[44:47], v10 offset:4096
    v_cvt_pk_bf16_f32 v84, v68, v69
    v_cvt_pk_bf16_f32 v85, v70, v71
    v_cvt_pk_bf16_f32 v86, v72, v73
    v_mfma_f32_32x32x16_bf16 v[52:67], a[4:7], v[24:27], v[52:67]
    ds_read_b128 v[48:51], v11 offset:4096
    v_cvt_pk_bf16_f32 v87, v74, v75
    v_cvt_pk_bf16_f32 v88, v76, v77
    v_cvt_pk_bf16_f32 v89, v78, v79
    s_waitcnt lgkmcnt(4)
    v_mfma_f32_32x32x16_bf16 v[52:67], a[8:11], v[28:31], v[52:67]
    ds_read_b128 v[20:23], v8 offset:8192
    v_cvt_pk_bf16_f32 v90, v80, v81
    v_cvt_pk_bf16_f32 v91, v82, v83
    v_mfma_f32_32x32x16_bf16 v[52:67], a[12:15], v[32:35], v[52:67]
    ds_read_b128 v[24:27], v9 offset:8192
    s_add_u32 s51, s42, s47
    s_sub_u32 s51, s51, 1
    s_bfe_u32 s52, s51, 0x40002
    s_lshl_b32 s52, s52, 14
    s_waitcnt lgkmcnt(4)
    v_mfma_f32_32x32x16_bf16 v[52:67], a[16:19], v[36:39], v[52:67]
    ds_read_b128 v[28:31], v10 offset:8192
    s_and_b32 s51, s51, 3
    s_lshl_b32 s51, s51, 11
    s_add_u32 s51, s51, s52
    s_add_u32 s51, s51, s48
    buffer_store_dwordx4 v[84:87], v7, s[84:87], s51 offen sc1
    v_mfma_f32_32x32x16_bf16 v[52:67], a[20:23], v[40:43], v[52:67]
    ds_read_b128 v[32:35], v11 offset:8192
    buffer_store_dwordx4 v[88:91], v7, s[84:87], s51 offen offset:512 sc1
    s_waitcnt lgkmcnt(4)
    v_mfma_f32_32x32x16_bf16 v[52:67], a[24:27], v[44:47], v[52:67]
    ds_read_b128 v[36:39], v8 offset:12288
    s_add_u32 m0, s46, 65536
    v_mfma_f32_32x32x16_bf16 v[52:67], a[28:31], v[48:51], v[52:67]
    ds_read_b128 v[40:43], v9 offset:12288
    buffer_load_dwordx4 v6, s[8:11], s50 offen offset:0 lds
    s_waitcnt lgkmcnt(4)
    v_mfma_f32_32x32x16_bf16 v[52:67], a[32:35], v[20:23], v[52:67]
    ds_read_b128 v[44:47], v10 offset:12288
    s_add_u32 m0, s46, 69504
    v_mfma_f32_32x32x16_bf16 v[52:67], a[36:39], v[24:27], v[52:67]
    ds_read_b128 v[48:51], v11 offset:12288
    buffer_load_dwordx4 v6, s[8:11], s50 offen offset:128 lds
    s_waitcnt lgkmcnt(4)
    v_mfma_f32_32x32x16_bf16 v[52:67], a[40:43], v[28:31], v[52:67]
    ds_read_b128 v[20:23], v8 offset:16384
    s_add_u32 m0, s46, 73472
    v_mfma_f32_32x32x16_bf16 v[52:67], a[44:47], v[32:35], v[52:67]
    ds_read_b128 v[24:27], v9 offset:16384
    buffer_load_dwordx4 v6, s[8:11], s50 offen offset:256 lds
    s_waitcnt lgkmcnt(4)
    v_mfma_f32_32x32x16_bf16 v[52:67], a[48:51], v[36:39], v[52:67]
    ds_read_b128 v[28:31], v10 offset:16384
    s_add_u32 m0, s46, 77440
    v_mfma_f32_32x32x16_bf16 v[52:67], a[52:55], v[40:43], v[52:67]
    ds_read_b128 v[32:35], v11 offset:16384
    buffer_load_dwordx4 v6, s[8:11], s50 offen offset:384 lds
    s_waitcnt lgkmcnt(4)
    v_mfma_f32_32x32x16_bf16 v[52:67], a[56:59], v[44:47], v[52:67]
    ds_read_b128 v[36:39], v8 offset:20480
    s_add_u32 m0, s46, 81408
    v_mfma_f32_32x32x16_bf16 v[52:67], a[60:63], v[48:51], v[52:67]
    ds_read_b128 v[40:43], v9 offset:20480
    buffer_load_dwordx4 v6, s[8:11], s50 offen offset:512 lds
    s_waitcnt lgkmcnt(4)
    v_mfma_f32_32x32x16_bf16 v[52:67], a[64:67], v[20:23], v[52:67]
    ds_read_b128 v[44:47], v10 offset:20480
    s_add_u32 m0, s46, 85376
    v_mfma_f32_32x32x16_bf16 v[52:67], a[68:71], v[24:27], v[52:67]
    ds_read_b128 v[48:51], v11 offset:20480
    buffer_load_dwordx4 v6, s[8:11], s50 offen offset:640 lds
    s_waitcnt lgkmcnt(4)
    v_mfma_f32_32x32x16_bf16 v[52:67], a[72:75], v[28:31], v[52:67]
    ds_read_b128 v[20:23], v8 offset:24576
    s_add_u32 m0, s46, 89344
    v_mfma_f32_32x32x16_bf16 v[52:67], a[76:79], v[32:35], v[52:67]
    ds_read_b128 v[24:27], v9 offset:24576
    buffer_load_dwordx4 v6, s[8:11], s50 offen offset:768 lds
    s_waitcnt lgkmcnt(4)
    v_mfma_f32_32x32x16_bf16 v[52:67], a[80:83], v[36:39], v[52:67]
    ds_read_b128 v[28:31], v10 offset:24576
    s_add_u32 m0, s46, 93312
    v_mfma_f32_32x32x16_bf16 v[52:67], a[84:87], v[40:43], v[52:67]
    ds_read_b128 v[32:35], v11 offset:24576
    buffer_load_dwordx4 v6, s[8:11], s50 offen offset:896 lds
    s_waitcnt lgkmcnt(4)
    v_mfma_f32_32x32x16_bf16 v[52:67], a[88:91], v[44:47], v[52:67]
    ds_read_b128 v[36:39], v8 offset:28672
    s_add_u32 m0, s46, 97280
    v_mfma_f32_32x32x16_bf16 v[52:67], a[92:95], v[48:51], v[52:67]
    ds_read_b128 v[40:43], v9 offset:28672
    buffer_load_dwordx4 v6, s[8:11], s50 offen offset:1024 lds
    s_waitcnt lgkmcnt(4)
    v_mfma_f32_32x32x16_bf16 v[52:67], a[96:99], v[20:23], v[52:67]
    ds_read_b128 v[44:47], v10 offset:28672
    s_add_u32 m0, s46, 101248
    v_mfma_f32_32x32x16_bf16 v[52:67], a[100:103], v[24:27], v[52:67]
    ds_read_b128 v[48:51], v11 offset:28672
    buffer_load_dwordx4 v6, s[8:11], s50 offen offset:1152 lds
    s_waitcnt lgkmcnt(4)
    v_mfma_f32_32x32x16_bf16 v[52:67], a[104:107], v[28:31], v[52:67]
    ds_read_b128 v[20:23], v8 offset:32768
    s_add_u32 m0, s46, 105216
    v_mfma_f32_32x32x16_bf16 v[52:67], a[108:111], v[32:35], v[52:67]
    ds_read_b128 v[24:27], v9 offset:32768
    buffer_load_dwordx4 v6, s[8:11], s50 offen offset:1280 lds
    s_waitcnt lgkmcnt(4)
    v_mfma_f32_32x32x16_bf16 v[52:67], a[112:115], v[36:39], v[52:67]
    ds_read_b128 v[28:31], v10 offset:32768
    s_add_u32 m0, s46, 109184
    v_mfma_f32_32x32x16_bf16 v[52:67], a[116:119], v[40:43], v[52:67]
    ds_read_b128 v[32:35], v11 offset:32768
    buffer_load_dwordx4 v6, s[8:11], s50 offen offset:1408 lds
    s_waitcnt lgkmcnt(4)
    v_mfma_f32_32x32x16_bf16 v[52:67], a[120:123], v[44:47], v[52:67]
    ds_read_b128 v[36:39], v8 offset:36864
    s_add_u32 m0, s46, 113152
    v_mfma_f32_32x32x16_bf16 v[52:67], a[124:127], v[48:51], v[52:67]
    ds_read_b128 v[40:43], v9 offset:36864
    buffer_load_dwordx4 v6, s[8:11], s50 offen offset:1536 lds
    s_waitcnt lgkmcnt(4)
    v_mfma_f32_32x32x16_bf16 v[52:67], a[128:131], v[20:23], v[52:67]
    ds_read_b128 v[44:47], v10 offset:36864
    s_add_u32 m0, s46, 117120
    v_mfma_f32_32x32x16_bf16 v[52:67], a[132:135], v[24:27], v[52:67]
    ds_read_b128 v[48:51], v11 offset:36864
    buffer_load_dwordx4 v6, s[8:11], s50 offen offset:1664 lds
    s_waitcnt lgkmcnt(4)
    v_mfma_f32_32x32x16_bf16 v[52:67], a[136:139], v[28:31], v[52:67]
    ds_read_b128 v[20:23], v8 offset:40960
    s_add_u32 m0, s46, 121088
    v_mfma_f32_32x32x16_bf16 v[52:67], a[140:143], v[32:35], v[52:67]
    ds_read_b128 v[24:27], v9 offset:40960
    buffer_load_dwordx4 v6, s[8:11], s50 offen offset:1792 lds
    s_waitcnt lgkmcnt(4)
    v_mfma_f32_32x32x16_bf16 v[52:67], a[144:147], v[36:39], v[52:67]
    ds_read_b128 v[28:31], v10 offset:40960
    s_add_u32 m0, s46, 125056
    v_mfma_f32_32x32x16_bf16 v[52:67], a[148:151], v[40:43], v[52:67]
    ds_read_b128 v[32:35], v11 offset:40960
    buffer_load_dwordx4 v6, s[8:11], s50 offen offset:1920 lds
    s_waitcnt lgkmcnt(4)
    v_mfma_f32_32x32x16_bf16 v[52:67], a[152:155], v[44:47], v[52:67]
    ds_read_b128 v[36:39], v8 offset:45056
    v_mfma_f32_32x32x16_bf16 v[52:67], a[156:159], v[48:51], v[52:67]
    ds_read_b128 v[40:43], v9 offset:45056
    s_waitcnt lgkmcnt(4)
    v_mfma_f32_32x32x16_bf16 v[52:67], a[160:163], v[20:23], v[52:67]
    ds_read_b128 v[44:47], v10 offset:45056
    v_mfma_f32_32x32x16_bf16 v[52:67], a[164:167], v[24:27], v[52:67]
    ds_read_b128 v[48:51], v11 offset:45056
    s_waitcnt lgkmcnt(4)
    v_mfma_f32_32x32x16_bf16 v[52:67], a[168:171], v[28:31], v[52:67]
    ds_read_b128 v[20:23], v8 offset:49152
    s_waitcnt vmcnt(16)
    v_mov_b32 v17, s42
    s_mov_b64 exec, 1
    buffer_store_dword v17, v16, s[84:87], s49 offen sc1
    s_mov_b64 exec, -1
    v_mfma_f32_32x32x16_bf16 v[52:67], a[172:175], v[32:35], v[52:67]
    ds_read_b128 v[24:27], v9 offset:49152
    s_waitcnt lgkmcnt(4)
    v_mfma_f32_32x32x16_bf16 v[52:67], a[176:179], v[36:39], v[52:67]
    ds_read_b128 v[28:31], v10 offset:49152
    s_add_u32 s53, s42, 3
    s_min_u32 s53, s53, 63
    s_lshl_b32 s53, s53, 16
    s_mov_b64 exec, 0xffff
    buffer_load_dword v18, v19, s[8:11], s53 offen
    s_mov_b64 exec, -1
    v_mfma_f32_32x32x16_bf16 v[52:67], a[180:183], v[40:43], v[52:67]
    ds_read_b128 v[32:35], v11 offset:49152
    s_waitcnt lgkmcnt(4)
    v_mfma_f32_32x32x16_bf16 v[52:67], a[184:187], v[44:47], v[52:67]
    ds_read_b128 v[36:39], v8 offset:53248
    v_mfma_f32_32x32x16_bf16 v[52:67], a[188:191], v[48:51], v[52:67]
    ds_read_b128 v[40:43], v9 offset:53248
    s_waitcnt lgkmcnt(4)
    v_mfma_f32_32x32x16_bf16 v[52:67], a[192:195], v[20:23], v[52:67]
    ds_read_b128 v[44:47], v10 offset:53248
    v_mfma_f32_32x32x16_bf16 v[52:67], a[196:199], v[24:27], v[52:67]
    ds_read_b128 v[48:51], v11 offset:53248
    s_waitcnt lgkmcnt(4)
    v_mfma_f32_32x32x16_bf16 v[52:67], a[200:203], v[28:31], v[52:67]
    ds_read_b128 v[20:23], v8 offset:57344
    v_mfma_f32_32x32x16_bf16 v[52:67], a[204:207], v[32:35], v[52:67]
    ds_read_b128 v[24:27], v9 offset:57344
    s_waitcnt lgkmcnt(4)
    v_mfma_f32_32x32x16_bf16 v[52:67], a[208:211], v[36:39], v[52:67]
    ds_read_b128 v[28:31], v10 offset:57344
    v_mfma_f32_32x32x16_bf16 v[52:67], a[212:215], v[40:43], v[52:67]
    ds_read_b128 v[32:35], v11 offset:57344
    s_waitcnt lgkmcnt(4)
    v_mfma_f32_32x32x16_bf16 v[52:67], a[216:219], v[44:47], v[52:67]
    ds_read_b128 v[36:39], v8 offset:61440
    v_mfma_f32_32x32x16_bf16 v[52:67], a[220:223], v[48:51], v[52:67]
    ds_read_b128 v[40:43], v9 offset:61440
    s_waitcnt lgkmcnt(4)
    v_mfma_f32_32x32x16_bf16 v[52:67], a[224:227], v[20:23], v[52:67]
    ds_read_b128 v[44:47], v10 offset:61440
    v_mfma_f32_32x32x16_bf16 v[52:67], a[228:231], v[24:27], v[52:67]
    ds_read_b128 v[48:51], v11 offset:61440
    s_waitcnt lgkmcnt(5)
    v_mfma_f32_32x32x16_bf16 v[52:67], a[232:235], v[28:31], v[52:67]
    s_waitcnt lgkmcnt(4)
    v_mfma_f32_32x32x16_bf16 v[52:67], a[236:239], v[32:35], v[52:67]
    s_waitcnt lgkmcnt(3)
    v_mfma_f32_32x32x16_bf16 v[52:67], a[240:243], v[36:39], v[52:67]
    s_waitcnt lgkmcnt(2)
    v_mfma_f32_32x32x16_bf16 v[52:67], a[244:247], v[40:43], v[52:67]
    s_waitcnt lgkmcnt(1)
    v_mfma_f32_32x32x16_bf16 v[52:67], a[248:251], v[44:47], v[52:67]
    s_waitcnt lgkmcnt(0)
    v_mfma_f32_32x32x16_bf16 v[52:67], a[252:255], v[48:51], v[52:67]
    s_add_u32 s42, s42, 1
    s_branch mega_kernel_k_loop
mega_kernel_k_fin:
    s_nop 11
    v_cvt_pk_bf16_f32 v84, v68, v69
    v_cvt_pk_bf16_f32 v85, v70, v71
    v_cvt_pk_bf16_f32 v86, v72, v73
    v_cvt_pk_bf16_f32 v87, v74, v75
    v_cvt_pk_bf16_f32 v88, v76, v77
    v_cvt_pk_bf16_f32 v89, v78, v79
    v_cvt_pk_bf16_f32 v90, v80, v81
    v_cvt_pk_bf16_f32 v91, v82, v83
    s_add_u32 s51, s42, s47
    s_sub_u32 s51, s51, 1
    s_bfe_u32 s52, s51, 0x40002
    s_lshl_b32 s52, s52, 14
    s_and_b32 s51, s51, 3
    s_lshl_b32 s51, s51, 11
    s_add_u32 s51, s51, s52
    s_add_u32 s51, s51, s48
    buffer_store_dwordx4 v[84:87], v7, s[84:87], s51 offen sc1
    buffer_store_dwordx4 v[88:91], v7, s[84:87], s51 offen offset:512 sc1
    s_waitcnt vmcnt(0)
    v_mov_b32 v17, s42
    s_mov_b64 exec, 1
    buffer_store_dword v17, v16, s[84:87], s49 offen sc1
    s_mov_b64 exec, -1
    s_waitcnt vmcnt(0)
    s_barrier
    s_branch mega_kernel_fft
mega_kernel_rv:
    s_load_dwordx2 s[4:5], s[0:1], 32
    s_load_dwordx2 s[8:9], s[0:1], 0
    v_lshrrev_b32 v2, 6, v0
    v_and_b32 v1, 63, v0
    v_readfirstlane_b32 s41, v2
    v_lshlrev_b32 v5, 4, v1
    s_waitcnt lgkmcnt(0)
    s_mov_b32 s6, 8388608
    s_mov_b32 s7, 0x00020000
    s_mov_b32 s10, 4194304
    s_mov_b32 s11, 0x00020000
    s_lshl_b32 s43, s40, 8
    s_lshl_b32 s44, s41, 6
    s_add_u32 s48, s43, s44
    s_and_b32 s43, s48, 0x7ff
    v_add_u32 v19, s43, v1
    v_lshlrev_b32 v19, 7, v19
    buffer_load_dword v20, v19, s[8:11], 0 offen
    v_lshrrev_b32 v2, 2, v1
    v_and_b32 v3, 3, v1
    v_lshlrev_b32 v16, 13, v2
    v_lshl_add_u32 v16, v3, 4, v16
    v_add_u32 v16, s48, v16
    v_and_b32 v3, 3, v1
    s_lshl_b32 s45, s41, 15
    v_bfe_u32 v17, v1, 2, 2
    v_lshrrev_b32 v18, 5, v1
    v_mul_u32_u24 v18, 8, v18
    v_add_u32 v17, v17, v18
    v_lshlrev_b32 v17, 6, v17
    v_bfe_u32 v18, v1, 4, 1
    v_lshl_add_u32 v17, v18, 5, v17
    v_lshl_add_u32 v17, v3, 3, v17
    v_add_u32 v17, s45, v17
    s_and_b32 s43, s40, 3
    s_lshl_b32 s43, s43, 2
    s_add_u32 s43, s43, s41
    s_lshl_b32 s43, s43, 4
    v_and_b32 v23, 15, v1
    v_add_u32 v23, s43, v23
    s_lshr_b32 s43, s40, 2
    s_lshl_b32 s43, s43, 10
    s_add_u32 s44, s43, 896
    s_add_u32 s43, s43, 384
    s_cmp_ge_u32 s40, 28
    s_cselect_b32 s44, s44, s43
    v_mov_b32 v24, s43
    v_mov_b32 v25, s44
    v_cmp_gt_u32 vcc, 32, v1
    s_nop 1
    v_cndmask_b32 v24, v25, v24, vcc
    v_lshl_add_u32 v23, v23, 13, v24
    s_mov_b32 s44, 0
    buffer_load_dword v22, v23, s[4:7], s44 offen
    s_add_u32 m0, s45, 0
    s_mov_b32 s44, 0
    buffer_load_dwordx4 v16, s[4:7], s44 offen lds
    s_add_u32 m0, s45, 1024
    s_mov_b32 s44, 131072
    buffer_load_dwordx4 v16, s[4:7], s44 offen lds
    s_add_u32 m0, s45, 2048
    s_mov_b32 s44, 262144
    buffer_load_dwordx4 v16, s[4:7], s44 offen lds
    s_add_u32 m0, s45, 3072
    s_mov_b32 s44, 393216
    buffer_load_dwordx4 v16, s[4:7], s44 offen lds
    s_add_u32 m0, s45, 4096
    s_mov_b32 s44, 524288
    buffer_load_dwordx4 v16, s[4:7], s44 offen lds
    s_add_u32 m0, s45, 5120
    s_mov_b32 s44, 655360
    buffer_load_dwordx4 v16, s[4:7], s44 offen lds
    s_add_u32 m0, s45, 6144
    s_mov_b32 s44, 786432
    buffer_load_dwordx4 v16, s[4:7], s44 offen lds
    s_add_u32 m0, s45, 7168
    s_mov_b32 s44, 917504
    buffer_load_dwordx4 v16, s[4:7], s44 offen lds
    s_add_u32 m0, s45, 8192
    s_mov_b32 s44, 1048576
    buffer_load_dwordx4 v16, s[4:7], s44 offen lds
    s_add_u32 m0, s45, 9216
    s_mov_b32 s44, 1179648
    buffer_load_dwordx4 v16, s[4:7], s44 offen lds
    s_add_u32 m0, s45, 10240
    s_mov_b32 s44, 1310720
    buffer_load_dwordx4 v16, s[4:7], s44 offen lds
    s_add_u32 m0, s45, 11264
    s_mov_b32 s44, 1441792
    buffer_load_dwordx4 v16, s[4:7], s44 offen lds
    s_add_u32 m0, s45, 12288
    s_mov_b32 s44, 1572864
    buffer_load_dwordx4 v16, s[4:7], s44 offen lds
    s_add_u32 m0, s45, 13312
    s_mov_b32 s44, 1703936
    buffer_load_dwordx4 v16, s[4:7], s44 offen lds
    s_add_u32 m0, s45, 14336
    s_mov_b32 s44, 1835008
    buffer_load_dwordx4 v16, s[4:7], s44 offen lds
    s_add_u32 m0, s45, 15360
    s_mov_b32 s44, 1966080
    buffer_load_dwordx4 v16, s[4:7], s44 offen lds
    s_mov_b32 s44, 2097152
    buffer_load_dword v22, v23, s[4:7], s44 offen
    s_add_u32 m0, s45, 16384
    s_mov_b32 s44, 2097152
    buffer_load_dwordx4 v16, s[4:7], s44 offen lds
    s_add_u32 m0, s45, 17408
    s_mov_b32 s44, 2228224
    buffer_load_dwordx4 v16, s[4:7], s44 offen lds
    s_add_u32 m0, s45, 18432
    s_mov_b32 s44, 2359296
    buffer_load_dwordx4 v16, s[4:7], s44 offen lds
    s_add_u32 m0, s45, 19456
    s_mov_b32 s44, 2490368
    buffer_load_dwordx4 v16, s[4:7], s44 offen lds
    s_add_u32 m0, s45, 20480
    s_mov_b32 s44, 2621440
    buffer_load_dwordx4 v16, s[4:7], s44 offen lds
    s_add_u32 m0, s45, 21504
    s_mov_b32 s44, 2752512
    buffer_load_dwordx4 v16, s[4:7], s44 offen lds
    s_add_u32 m0, s45, 22528
    s_mov_b32 s44, 2883584
    buffer_load_dwordx4 v16, s[4:7], s44 offen lds
    s_add_u32 m0, s45, 23552
    s_mov_b32 s44, 3014656
    buffer_load_dwordx4 v16, s[4:7], s44 offen lds
    s_add_u32 m0, s45, 24576
    s_mov_b32 s44, 3145728
    buffer_load_dwordx4 v16, s[4:7], s44 offen lds
    s_add_u32 m0, s45, 25600
    s_mov_b32 s44, 3276800
    buffer_load_dwordx4 v16, s[4:7], s44 offen lds
    s_add_u32 m0, s45, 26624
    s_mov_b32 s44, 3407872
    buffer_load_dwordx4 v16, s[4:7], s44 offen lds
    s_add_u32 m0, s45, 27648
    s_mov_b32 s44, 3538944
    buffer_load_dwordx4 v16, s[4:7], s44 offen lds
    s_add_u32 m0, s45, 28672
    s_mov_b32 s44, 3670016
    buffer_load_dwordx4 v16, s[4:7], s44 offen lds
    s_add_u32 m0, s45, 29696
    s_mov_b32 s44, 3801088
    buffer_load_dwordx4 v16, s[4:7], s44 offen lds
    s_add_u32 m0, s45, 30720
    s_mov_b32 s44, 3932160
    buffer_load_dwordx4 v16, s[4:7], s44 offen lds
    s_add_u32 m0, s45, 31744
    s_mov_b32 s44, 4063232
    buffer_load_dwordx4 v16, s[4:7], s44 offen lds
    s_waitcnt vmcnt(17)
    ds_read_b64_tr_b16 a[0:1], v17 offset:0
    ds_read_b64_tr_b16 a[2:3], v17 offset:256
    ds_read_b64_tr_b16 a[4:5], v17 offset:1024
    ds_read_b64_tr_b16 a[6:7], v17 offset:1280
    ds_read_b64_tr_b16 a[8:9], v17 offset:2048
    ds_read_b64_tr_b16 a[10:11], v17 offset:2304
    ds_read_b64_tr_b16 a[12:13], v17 offset:3072
    ds_read_b64_tr_b16 a[14:15], v17 offset:3328
    s_waitcnt lgkmcnt(0)
    ds_read_b64_tr_b16 a[16:17], v17 offset:4096
    ds_read_b64_tr_b16 a[18:19], v17 offset:4352
    ds_read_b64_tr_b16 a[20:21], v17 offset:5120
    ds_read_b64_tr_b16 a[22:23], v17 offset:5376
    ds_read_b64_tr_b16 a[24:25], v17 offset:6144
    ds_read_b64_tr_b16 a[26:27], v17 offset:6400
    ds_read_b64_tr_b16 a[28:29], v17 offset:7168
    ds_read_b64_tr_b16 a[30:31], v17 offset:7424
    s_waitcnt lgkmcnt(0)
    ds_read_b64_tr_b16 a[32:33], v17 offset:8192
    ds_read_b64_tr_b16 a[34:35], v17 offset:8448
    ds_read_b64_tr_b16 a[36:37], v17 offset:9216
    ds_read_b64_tr_b16 a[38:39], v17 offset:9472
    ds_read_b64_tr_b16 a[40:41], v17 offset:10240
    ds_read_b64_tr_b16 a[42:43], v17 offset:10496
    ds_read_b64_tr_b16 a[44:45], v17 offset:11264
    ds_read_b64_tr_b16 a[46:47], v17 offset:11520
    s_waitcnt lgkmcnt(0)
    ds_read_b64_tr_b16 a[48:49], v17 offset:12288
    ds_read_b64_tr_b16 a[50:51], v17 offset:12544
    ds_read_b64_tr_b16 a[52:53], v17 offset:13312
    ds_read_b64_tr_b16 a[54:55], v17 offset:13568
    ds_read_b64_tr_b16 a[56:57], v17 offset:14336
    ds_read_b64_tr_b16 a[58:59], v17 offset:14592
    ds_read_b64_tr_b16 a[60:61], v17 offset:15360
    ds_read_b64_tr_b16 a[62:63], v17 offset:15616
    s_waitcnt lgkmcnt(0)
    s_mov_b32 s44, 4194304
    buffer_load_dword v22, v23, s[4:7], s44 offen
    s_add_u32 m0, s45, 0
    s_mov_b32 s44, 4194304
    buffer_load_dwordx4 v16, s[4:7], s44 offen lds
    s_add_u32 m0, s45, 1024
    s_mov_b32 s44, 4325376
    buffer_load_dwordx4 v16, s[4:7], s44 offen lds
    s_add_u32 m0, s45, 2048
    s_mov_b32 s44, 4456448
    buffer_load_dwordx4 v16, s[4:7], s44 offen lds
    s_add_u32 m0, s45, 3072
    s_mov_b32 s44, 4587520
    buffer_load_dwordx4 v16, s[4:7], s44 offen lds
    s_add_u32 m0, s45, 4096
    s_mov_b32 s44, 4718592
    buffer_load_dwordx4 v16, s[4:7], s44 offen lds
    s_add_u32 m0, s45, 5120
    s_mov_b32 s44, 4849664
    buffer_load_dwordx4 v16, s[4:7], s44 offen lds
    s_add_u32 m0, s45, 6144
    s_mov_b32 s44, 4980736
    buffer_load_dwordx4 v16, s[4:7], s44 offen lds
    s_add_u32 m0, s45, 7168
    s_mov_b32 s44, 5111808
    buffer_load_dwordx4 v16, s[4:7], s44 offen lds
    s_add_u32 m0, s45, 8192
    s_mov_b32 s44, 5242880
    buffer_load_dwordx4 v16, s[4:7], s44 offen lds
    s_add_u32 m0, s45, 9216
    s_mov_b32 s44, 5373952
    buffer_load_dwordx4 v16, s[4:7], s44 offen lds
    s_add_u32 m0, s45, 10240
    s_mov_b32 s44, 5505024
    buffer_load_dwordx4 v16, s[4:7], s44 offen lds
    s_add_u32 m0, s45, 11264
    s_mov_b32 s44, 5636096
    buffer_load_dwordx4 v16, s[4:7], s44 offen lds
    s_add_u32 m0, s45, 12288
    s_mov_b32 s44, 5767168
    buffer_load_dwordx4 v16, s[4:7], s44 offen lds
    s_add_u32 m0, s45, 13312
    s_mov_b32 s44, 5898240
    buffer_load_dwordx4 v16, s[4:7], s44 offen lds
    s_add_u32 m0, s45, 14336
    s_mov_b32 s44, 6029312
    buffer_load_dwordx4 v16, s[4:7], s44 offen lds
    s_add_u32 m0, s45, 15360
    s_mov_b32 s44, 6160384
    buffer_load_dwordx4 v16, s[4:7], s44 offen lds
    s_waitcnt vmcnt(17)
    ds_read_b64_tr_b16 a[64:65], v17 offset:16384
    ds_read_b64_tr_b16 a[66:67], v17 offset:16640
    ds_read_b64_tr_b16 a[68:69], v17 offset:17408
    ds_read_b64_tr_b16 a[70:71], v17 offset:17664
    ds_read_b64_tr_b16 a[72:73], v17 offset:18432
    ds_read_b64_tr_b16 a[74:75], v17 offset:18688
    ds_read_b64_tr_b16 a[76:77], v17 offset:19456
    ds_read_b64_tr_b16 a[78:79], v17 offset:19712
    s_waitcnt lgkmcnt(0)
    ds_read_b64_tr_b16 a[80:81], v17 offset:20480
    ds_read_b64_tr_b16 a[82:83], v17 offset:20736
    ds_read_b64_tr_b16 a[84:85], v17 offset:21504
    ds_read_b64_tr_b16 a[86:87], v17 offset:21760
    ds_read_b64_tr_b16 a[88:89], v17 offset:22528
    ds_read_b64_tr_b16 a[90:91], v17 offset:22784
    ds_read_b64_tr_b16 a[92:93], v17 offset:23552
    ds_read_b64_tr_b16 a[94:95], v17 offset:23808
    s_waitcnt lgkmcnt(0)
    ds_read_b64_tr_b16 a[96:97], v17 offset:24576
    ds_read_b64_tr_b16 a[98:99], v17 offset:24832
    ds_read_b64_tr_b16 a[100:101], v17 offset:25600
    ds_read_b64_tr_b16 a[102:103], v17 offset:25856
    ds_read_b64_tr_b16 a[104:105], v17 offset:26624
    ds_read_b64_tr_b16 a[106:107], v17 offset:26880
    ds_read_b64_tr_b16 a[108:109], v17 offset:27648
    ds_read_b64_tr_b16 a[110:111], v17 offset:27904
    s_waitcnt lgkmcnt(0)
    ds_read_b64_tr_b16 a[112:113], v17 offset:28672
    ds_read_b64_tr_b16 a[114:115], v17 offset:28928
    ds_read_b64_tr_b16 a[116:117], v17 offset:29696
    ds_read_b64_tr_b16 a[118:119], v17 offset:29952
    ds_read_b64_tr_b16 a[120:121], v17 offset:30720
    ds_read_b64_tr_b16 a[122:123], v17 offset:30976
    ds_read_b64_tr_b16 a[124:125], v17 offset:31744
    ds_read_b64_tr_b16 a[126:127], v17 offset:32000
    s_waitcnt lgkmcnt(0)
    s_mov_b32 s44, 6291456
    buffer_load_dword v22, v23, s[4:7], s44 offen
    s_add_u32 m0, s45, 16384
    s_mov_b32 s44, 6291456
    buffer_load_dwordx4 v16, s[4:7], s44 offen lds
    s_add_u32 m0, s45, 17408
    s_mov_b32 s44, 6422528
    buffer_load_dwordx4 v16, s[4:7], s44 offen lds
    s_add_u32 m0, s45, 18432
    s_mov_b32 s44, 6553600
    buffer_load_dwordx4 v16, s[4:7], s44 offen lds
    s_add_u32 m0, s45, 19456
    s_mov_b32 s44, 6684672
    buffer_load_dwordx4 v16, s[4:7], s44 offen lds
    s_add_u32 m0, s45, 20480
    s_mov_b32 s44, 6815744
    buffer_load_dwordx4 v16, s[4:7], s44 offen lds
    s_add_u32 m0, s45, 21504
    s_mov_b32 s44, 6946816
    buffer_load_dwordx4 v16, s[4:7], s44 offen lds
    s_add_u32 m0, s45, 22528
    s_mov_b32 s44, 7077888
    buffer_load_dwordx4 v16, s[4:7], s44 offen lds
    s_add_u32 m0, s45, 23552
    s_mov_b32 s44, 7208960
    buffer_load_dwordx4 v16, s[4:7], s44 offen lds
    s_add_u32 m0, s45, 24576
    s_mov_b32 s44, 7340032
    buffer_load_dwordx4 v16, s[4:7], s44 offen lds
    s_add_u32 m0, s45, 25600
    s_mov_b32 s44, 7471104
    buffer_load_dwordx4 v16, s[4:7], s44 offen lds
    s_add_u32 m0, s45, 26624
    s_mov_b32 s44, 7602176
    buffer_load_dwordx4 v16, s[4:7], s44 offen lds
    s_add_u32 m0, s45, 27648
    s_mov_b32 s44, 7733248
    buffer_load_dwordx4 v16, s[4:7], s44 offen lds
    s_add_u32 m0, s45, 28672
    s_mov_b32 s44, 7864320
    buffer_load_dwordx4 v16, s[4:7], s44 offen lds
    s_add_u32 m0, s45, 29696
    s_mov_b32 s44, 7995392
    buffer_load_dwordx4 v16, s[4:7], s44 offen lds
    s_add_u32 m0, s45, 30720
    s_mov_b32 s44, 8126464
    buffer_load_dwordx4 v16, s[4:7], s44 offen lds
    s_add_u32 m0, s45, 31744
    s_mov_b32 s44, 8257536
    buffer_load_dwordx4 v16, s[4:7], s44 offen lds
    s_waitcnt vmcnt(16)
    ds_read_b64_tr_b16 a[128:129], v17 offset:0
    ds_read_b64_tr_b16 a[130:131], v17 offset:256
    ds_read_b64_tr_b16 a[132:133], v17 offset:1024
    ds_read_b64_tr_b16 a[134:135], v17 offset:1280
    ds_read_b64_tr_b16 a[136:137], v17 offset:2048
    ds_read_b64_tr_b16 a[138:139], v17 offset:2304
    ds_read_b64_tr_b16 a[140:141], v17 offset:3072
    ds_read_b64_tr_b16 a[142:143], v17 offset:3328
    s_waitcnt lgkmcnt(0)
    ds_read_b64_tr_b16 a[144:145], v17 offset:4096
    ds_read_b64_tr_b16 a[146:147], v17 offset:4352
    ds_read_b64_tr_b16 a[148:149], v17 offset:5120
    ds_read_b64_tr_b16 a[150:151], v17 offset:5376
    ds_read_b64_tr_b16 a[152:153], v17 offset:6144
    ds_read_b64_tr_b16 a[154:155], v17 offset:6400
    ds_read_b64_tr_b16 a[156:157], v17 offset:7168
    ds_read_b64_tr_b16 a[158:159], v17 offset:7424
    s_waitcnt lgkmcnt(0)
    ds_read_b64_tr_b16 a[160:161], v17 offset:8192
    ds_read_b64_tr_b16 a[162:163], v17 offset:8448
    ds_read_b64_tr_b16 a[164:165], v17 offset:9216
    ds_read_b64_tr_b16 a[166:167], v17 offset:9472
    ds_read_b64_tr_b16 a[168:169], v17 offset:10240
    ds_read_b64_tr_b16 a[170:171], v17 offset:10496
    ds_read_b64_tr_b16 a[172:173], v17 offset:11264
    ds_read_b64_tr_b16 a[174:175], v17 offset:11520
    s_waitcnt lgkmcnt(0)
    ds_read_b64_tr_b16 a[176:177], v17 offset:12288
    ds_read_b64_tr_b16 a[178:179], v17 offset:12544
    ds_read_b64_tr_b16 a[180:181], v17 offset:13312
    ds_read_b64_tr_b16 a[182:183], v17 offset:13568
    ds_read_b64_tr_b16 a[184:185], v17 offset:14336
    ds_read_b64_tr_b16 a[186:187], v17 offset:14592
    ds_read_b64_tr_b16 a[188:189], v17 offset:15360
    ds_read_b64_tr_b16 a[190:191], v17 offset:15616
    s_waitcnt lgkmcnt(0)
    s_waitcnt vmcnt(0)
    ds_read_b64_tr_b16 a[192:193], v17 offset:16384
    ds_read_b64_tr_b16 a[194:195], v17 offset:16640
    ds_read_b64_tr_b16 a[196:197], v17 offset:17408
    ds_read_b64_tr_b16 a[198:199], v17 offset:17664
    ds_read_b64_tr_b16 a[200:201], v17 offset:18432
    ds_read_b64_tr_b16 a[202:203], v17 offset:18688
    ds_read_b64_tr_b16 a[204:205], v17 offset:19456
    ds_read_b64_tr_b16 a[206:207], v17 offset:19712
    s_waitcnt lgkmcnt(0)
    ds_read_b64_tr_b16 a[208:209], v17 offset:20480
    ds_read_b64_tr_b16 a[210:211], v17 offset:20736
    ds_read_b64_tr_b16 a[212:213], v17 offset:21504
    ds_read_b64_tr_b16 a[214:215], v17 offset:21760
    ds_read_b64_tr_b16 a[216:217], v17 offset:22528
    ds_read_b64_tr_b16 a[218:219], v17 offset:22784
    ds_read_b64_tr_b16 a[220:221], v17 offset:23552
    ds_read_b64_tr_b16 a[222:223], v17 offset:23808
    s_waitcnt lgkmcnt(0)
    ds_read_b64_tr_b16 a[224:225], v17 offset:24576
    ds_read_b64_tr_b16 a[226:227], v17 offset:24832
    ds_read_b64_tr_b16 a[228:229], v17 offset:25600
    ds_read_b64_tr_b16 a[230:231], v17 offset:25856
    ds_read_b64_tr_b16 a[232:233], v17 offset:26624
    ds_read_b64_tr_b16 a[234:235], v17 offset:26880
    ds_read_b64_tr_b16 a[236:237], v17 offset:27648
    ds_read_b64_tr_b16 a[238:239], v17 offset:27904
    s_waitcnt lgkmcnt(0)
    ds_read_b64_tr_b16 a[240:241], v17 offset:28672
    ds_read_b64_tr_b16 a[242:243], v17 offset:28928
    ds_read_b64_tr_b16 a[244:245], v17 offset:29696
    ds_read_b64_tr_b16 a[246:247], v17 offset:29952
    ds_read_b64_tr_b16 a[248:249], v17 offset:30720
    ds_read_b64_tr_b16 a[250:251], v17 offset:30976
    ds_read_b64_tr_b16 a[252:253], v17 offset:31744
    ds_read_b64_tr_b16 a[254:255], v17 offset:32000
    s_waitcnt lgkmcnt(0)
    s_barrier
    v_lshrrev_b32 v2, 3, v1
    s_lshl_b32 s43, s41, 3
    v_add_u32 v2, s43, v2
    v_bfe_u32 v3, v2, 1, 3
    v_and_b32 v4, 7, v1
    v_xor_b32 v3, v3, v4
    v_lshlrev_b32 v6, 11, v2
    v_lshl_add_u32 v6, v3, 4, v6
    s_lshl_b32 s46, s41, 10
    v_and_b32 v2, 15, v1
    v_bfe_u32 v3, v2, 1, 3
    v_lshrrev_b32 v4, 4, v1
    v_xor_b32 v3, v3, v4
    v_lshlrev_b32 v8, 7, v2
    v_lshl_add_u32 v8, v3, 4, v8
    v_xor_b32 v9, 64, v8
    v_add_u32 v10, 0x10000, v8
    v_add_u32 v11, 0x10000, v9
    v_mov_b32 v7, v5
    v_and_b32 v2, 31, v1
    v_bfe_u32 v3, v2, 1, 3
    v_lshrrev_b32 v4, 5, v1
    v_xor_b32 v3, v3, v4
    v_lshlrev_b32 v8, 7, v2
    v_lshl_add_u32 v8, v3, 4, v8
    v_xor_b32 v9, 32, v8
    v_xor_b32 v10, 64, v8
    v_xor_b32 v11, 96, v8
    v_add_u32 v12, 0x10000, v8
    v_add_u32 v13, 0x10000, v9
    v_add_u32 v14, 0x10000, v10
    v_add_u32 v15, 0x10000, v11
    v_bfe_u32 v3, v1, 4, 1
    v_lshlrev_b32 v7, 10, v3
    v_lshl_add_u32 v7, v4, 8, v7
    v_and_b32 v3, 15, v1
    v_lshl_add_u32 v7, v3, 4, v7
    s_lshl_b32 s47, s40, 2
    s_add_u32 s47, s47, s41
    s_mov_b32 s42, 0
    s_mov_b32 s50, 0
    s_add_u32 m0, s46, 0
    s_nop 0
    buffer_load_dwordx4 v6, s[8:11], s50 offen offset:0 lds
    s_add_u32 m0, s46, 3968
    s_nop 0
    buffer_load_dwordx4 v6, s[8:11], s50 offen offset:128 lds
    s_add_u32 m0, s46, 7936
    s_nop 0
    buffer_load_dwordx4 v6, s[8:11], s50 offen offset:256 lds
    s_add_u32 m0, s46, 11904
    s_nop 0
    buffer_load_dwordx4 v6, s[8:11], s50 offen offset:384 lds
    s_add_u32 m0, s46, 15872
    s_nop 0
    buffer_load_dwordx4 v6, s[8:11], s50 offen offset:512 lds
    s_add_u32 m0, s46, 19840
    s_nop 0
    buffer_load_dwordx4 v6, s[8:11], s50 offen offset:640 lds
    s_add_u32 m0, s46, 23808
    s_nop 0
    buffer_load_dwordx4 v6, s[8:11], s50 offen offset:768 lds
    s_add_u32 m0, s46, 27776
    s_nop 0
    buffer_load_dwordx4 v6, s[8:11], s50 offen offset:896 lds
    s_add_u32 m0, s46, 31744
    s_nop 0
    buffer_load_dwordx4 v6, s[8:11], s50 offen offset:1024 lds
    s_add_u32 m0, s46, 35712
    s_nop 0
    buffer_load_dwordx4 v6, s[8:11], s50 offen offset:1152 lds
    s_add_u32 m0, s46, 39680
    s_nop 0
    buffer_load_dwordx4 v6, s[8:11], s50 offen offset:1280 lds
    s_add_u32 m0, s46, 43648
    s_nop 0
    buffer_load_dwordx4 v6, s[8:11], s50 offen offset:1408 lds
    s_add_u32 m0, s46, 47616
    s_nop 0
    buffer_load_dwordx4 v6, s[8:11], s50 offen offset:1536 lds
    s_add_u32 m0, s46, 51584
    s_nop 0
    buffer_load_dwordx4 v6, s[8:11], s50 offen offset:1664 lds
    s_add_u32 m0, s46, 55552
    s_nop 0
    buffer_load_dwordx4 v6, s[8:11], s50 offen offset:1792 lds
    s_add_u32 m0, s46, 59520
    s_nop 0
    buffer_load_dwordx4 v6, s[8:11], s50 offen offset:1920 lds
    s_and_b32 s53, s47, 31
    s_lshl_b32 s53, s53, 4
    v_add_u32 v19, s53, v1
    v_lshlrev_b32 v19, 7, v19
    s_waitcnt vmcnt(0)
    s_barrier
    s_add_u32 s50, s42, 1
    s_min_u32 s50, s50, 63
    s_lshl_b32 s50, s50, 16
    ds_read_b128 v[20:23], v8 offset:0
    ds_read_b128 v[24:27], v9 offset:0
    ds_read_b128 v[28:31], v10 offset:0
    ds_read_b128 v[32:35], v11 offset:0
    ds_read_b128 v[36:39], v8 offset:4096
    ds_read_b128 v[40:43], v9 offset:4096
    s_waitcnt lgkmcnt(4)
    v_mfma_f32_32x32x16_bf16 v[52:67], v[20:23], a[0:3], 0
    ds_read_b128 v[44:47], v10 offset:4096
    v_mfma_f32_32x32x16_bf16 v[52:67], v[24:27], a[4:7], v[52:67]
    ds_read_b128 v[48:51], v11 offset:4096
    s_waitcnt lgkmcnt(4)
    v_mfma_f32_32x32x16_bf16 v[52:67], v[28:31], a[8:11], v[52:67]
    ds_read_b128 v[20:23], v8 offset:8192
    v_mfma_f32_32x32x16_bf16 v[52:67], v[32:35], a[12:15], v[52:67]
    ds_read_b128 v[24:27], v9 offset:8192
    s_waitcnt lgkmcnt(4)
    v_mfma_f32_32x32x16_bf16 v[52:67], v[36:39], a[16:19], v[52:67]
    ds_read_b128 v[28:31], v10 offset:8192
    v_mfma_f32_32x32x16_bf16 v[52:67], v[40:43], a[20:23], v[52:67]
    ds_read_b128 v[32:35], v11 offset:8192
    s_waitcnt lgkmcnt(4)
    v_mfma_f32_32x32x16_bf16 v[52:67], v[44:47], a[24:27], v[52:67]
    ds_read_b128 v[36:39], v8 offset:12288
    s_add_u32 m0, s46, 65536
    v_mfma_f32_32x32x16_bf16 v[52:67], v[48:51], a[28:31], v[52:67]
    ds_read_b128 v[40:43], v9 offset:12288
    buffer_load_dwordx4 v6, s[8:11], s50 offen offset:0 lds
    s_waitcnt lgkmcnt(4)
    v_mfma_f32_32x32x16_bf16 v[52:67], v[20:23], a[32:35], v[52:67]
    ds_read_b128 v[44:47], v10 offset:12288
    s_add_u32 m0, s46, 69504
    v_mfma_f32_32x32x16_bf16 v[52:67], v[24:27], a[36:39], v[52:67]
    ds_read_b128 v[48:51], v11 offset:12288
    buffer_load_dwordx4 v6, s[8:11], s50 offen offset:128 lds
    s_waitcnt lgkmcnt(4)
    v_mfma_f32_32x32x16_bf16 v[52:67], v[28:31], a[40:43], v[52:67]
    ds_read_b128 v[20:23], v8 offset:16384
    s_add_u32 m0, s46, 73472
    v_mfma_f32_32x32x16_bf16 v[52:67], v[32:35], a[44:47], v[52:67]
    ds_read_b128 v[24:27], v9 offset:16384
    buffer_load_dwordx4 v6, s[8:11], s50 offen offset:256 lds
    s_waitcnt lgkmcnt(4)
    v_mfma_f32_32x32x16_bf16 v[52:67], v[36:39], a[48:51], v[52:67]
    ds_read_b128 v[28:31], v10 offset:16384
    s_add_u32 m0, s46, 77440
    v_mfma_f32_32x32x16_bf16 v[52:67], v[40:43], a[52:55], v[52:67]
    ds_read_b128 v[32:35], v11 offset:16384
    buffer_load_dwordx4 v6, s[8:11], s50 offen offset:384 lds
    s_waitcnt lgkmcnt(4)
    v_mfma_f32_32x32x16_bf16 v[52:67], v[44:47], a[56:59], v[52:67]
    ds_read_b128 v[36:39], v8 offset:20480
    s_add_u32 m0, s46, 81408
    v_mfma_f32_32x32x16_bf16 v[52:67], v[48:51], a[60:63], v[52:67]
    ds_read_b128 v[40:43], v9 offset:20480
    buffer_load_dwordx4 v6, s[8:11], s50 offen offset:512 lds
    s_waitcnt lgkmcnt(4)
    v_mfma_f32_32x32x16_bf16 v[52:67], v[20:23], a[64:67], v[52:67]
    ds_read_b128 v[44:47], v10 offset:20480
    s_add_u32 m0, s46, 85376
    v_mfma_f32_32x32x16_bf16 v[52:67], v[24:27], a[68:71], v[52:67]
    ds_read_b128 v[48:51], v11 offset:20480
    buffer_load_dwordx4 v6, s[8:11], s50 offen offset:640 lds
    s_waitcnt lgkmcnt(4)
    v_mfma_f32_32x32x16_bf16 v[52:67], v[28:31], a[72:75], v[52:67]
    ds_read_b128 v[20:23], v8 offset:24576
    s_add_u32 m0, s46, 89344
    v_mfma_f32_32x32x16_bf16 v[52:67], v[32:35], a[76:79], v[52:67]
    ds_read_b128 v[24:27], v9 offset:24576
    buffer_load_dwordx4 v6, s[8:11], s50 offen offset:768 lds
    s_waitcnt lgkmcnt(4)
    v_mfma_f32_32x32x16_bf16 v[52:67], v[36:39], a[80:83], v[52:67]
    ds_read_b128 v[28:31], v10 offset:24576
    s_add_u32 m0, s46, 93312
    v_mfma_f32_32x32x16_bf16 v[52:67], v[40:43], a[84:87], v[52:67]
    ds_read_b128 v[32:35], v11 offset:24576
    buffer_load_dwordx4 v6, s[8:11], s50 offen offset:896 lds
    s_waitcnt lgkmcnt(4)
    v_mfma_f32_32x32x16_bf16 v[52:67], v[44:47], a[88:91], v[52:67]
    ds_read_b128 v[36:39], v8 offset:28672
    s_add_u32 m0, s46, 97280
    v_mfma_f32_32x32x16_bf16 v[52:67], v[48:51], a[92:95], v[52:67]
    ds_read_b128 v[40:43], v9 offset:28672
    buffer_load_dwordx4 v6, s[8:11], s50 offen offset:1024 lds
    s_waitcnt lgkmcnt(4)
    v_mfma_f32_32x32x16_bf16 v[52:67], v[20:23], a[96:99], v[52:67]
    ds_read_b128 v[44:47], v10 offset:28672
    s_add_u32 m0, s46, 101248
    v_mfma_f32_32x32x16_bf16 v[52:67], v[24:27], a[100:103], v[52:67]
    ds_read_b128 v[48:51], v11 offset:28672
    buffer_load_dwordx4 v6, s[8:11], s50 offen offset:1152 lds
    s_waitcnt lgkmcnt(4)
    v_mfma_f32_32x32x16_bf16 v[52:67], v[28:31], a[104:107], v[52:67]
    ds_read_b128 v[20:23], v8 offset:32768
    s_add_u32 m0, s46, 105216
    v_mfma_f32_32x32x16_bf16 v[52:67], v[32:35], a[108:111], v[52:67]
    ds_read_b128 v[24:27], v9 offset:32768
    buffer_load_dwordx4 v6, s[8:11], s50 offen offset:1280 lds
    s_waitcnt lgkmcnt(4)
    v_mfma_f32_32x32x16_bf16 v[52:67], v[36:39], a[112:115], v[52:67]
    ds_read_b128 v[28:31], v10 offset:32768
    s_add_u32 m0, s46, 109184
    v_mfma_f32_32x32x16_bf16 v[52:67], v[40:43], a[116:119], v[52:67]
    ds_read_b128 v[32:35], v11 offset:32768
    buffer_load_dwordx4 v6, s[8:11], s50 offen offset:1408 lds
    s_waitcnt lgkmcnt(4)
    v_mfma_f32_32x32x16_bf16 v[52:67], v[44:47], a[120:123], v[52:67]
    ds_read_b128 v[36:39], v8 offset:36864
    s_add_u32 m0, s46, 113152
    v_mfma_f32_32x32x16_bf16 v[52:67], v[48:51], a[124:127], v[52:67]
    ds_read_b128 v[40:43], v9 offset:36864
    buffer_load_dwordx4 v6, s[8:11], s50 offen offset:1536 lds
    s_waitcnt lgkmcnt(4)
    v_mfma_f32_32x32x16_bf16 v[52:67], v[20:23], a[128:131], v[52:67]
    ds_read_b128 v[44:47], v10 offset:36864
    s_add_u32 m0, s46, 117120
    v_mfma_f32_32x32x16_bf16 v[52:67], v[24:27], a[132:135], v[52:67]
    ds_read_b128 v[48:51], v11 offset:36864
    buffer_load_dwordx4 v6, s[8:11], s50 offen offset:1664 lds
    s_waitcnt lgkmcnt(4)
    v_mfma_f32_32x32x16_bf16 v[52:67], v[28:31], a[136:139], v[52:67]
    ds_read_b128 v[20:23], v8 offset:40960
    s_add_u32 m0, s46, 121088
    v_mfma_f32_32x32x16_bf16 v[52:67], v[32:35], a[140:143], v[52:67]
    ds_read_b128 v[24:27], v9 offset:40960
    buffer_load_dwordx4 v6, s[8:11], s50 offen offset:1792 lds
    s_waitcnt lgkmcnt(4)
    v_mfma_f32_32x32x16_bf16 v[52:67], v[36:39], a[144:147], v[52:67]
    ds_read_b128 v[28:31], v10 offset:40960
    s_add_u32 m0, s46, 125056
    v_mfma_f32_32x32x16_bf16 v[52:67], v[40:43], a[148:151], v[52:67]
    ds_read_b128 v[32:35], v11 offset:40960
    buffer_load_dwordx4 v6, s[8:11], s50 offen offset:1920 lds
    s_waitcnt lgkmcnt(4)
    v_mfma_f32_32x32x16_bf16 v[52:67], v[44:47], a[152:155], v[52:67]
    ds_read_b128 v[36:39], v8 offset:45056
    v_mfma_f32_32x32x16_bf16 v[52:67], v[48:51], a[156:159], v[52:67]
    ds_read_b128 v[40:43], v9 offset:45056
    s_waitcnt lgkmcnt(4)
    v_mfma_f32_32x32x16_bf16 v[52:67], v[20:23], a[160:163], v[52:67]
    ds_read_b128 v[44:47], v10 offset:45056
    v_mfma_f32_32x32x16_bf16 v[52:67], v[24:27], a[164:167], v[52:67]
    ds_read_b128 v[48:51], v11 offset:45056
    s_waitcnt lgkmcnt(4)
    v_mfma_f32_32x32x16_bf16 v[52:67], v[28:31], a[168:171], v[52:67]
    ds_read_b128 v[20:23], v8 offset:49152
    v_mfma_f32_32x32x16_bf16 v[52:67], v[32:35], a[172:175], v[52:67]
    ds_read_b128 v[24:27], v9 offset:49152
    s_waitcnt lgkmcnt(4)
    v_mfma_f32_32x32x16_bf16 v[52:67], v[36:39], a[176:179], v[52:67]
    ds_read_b128 v[28:31], v10 offset:49152
    s_add_u32 s53, s42, 3
    s_min_u32 s53, s53, 63
    s_lshl_b32 s53, s53, 16
    s_mov_b64 exec, 0xffff
    buffer_load_dword v18, v19, s[8:11], s53 offen
    s_mov_b64 exec, -1
    v_mfma_f32_32x32x16_bf16 v[52:67], v[40:43], a[180:183], v[52:67]
    ds_read_b128 v[32:35], v11 offset:49152
    s_waitcnt lgkmcnt(4)
    v_mfma_f32_32x32x16_bf16 v[52:67], v[44:47], a[184:187], v[52:67]
    ds_read_b128 v[36:39], v8 offset:53248
    v_mfma_f32_32x32x16_bf16 v[52:67], v[48:51], a[188:191], v[52:67]
    ds_read_b128 v[40:43], v9 offset:53248
    s_waitcnt lgkmcnt(4)
    v_mfma_f32_32x32x16_bf16 v[52:67], v[20:23], a[192:195], v[52:67]
    ds_read_b128 v[44:47], v10 offset:53248
    v_mfma_f32_32x32x16_bf16 v[52:67], v[24:27], a[196:199], v[52:67]
    ds_read_b128 v[48:51], v11 offset:53248
    s_waitcnt lgkmcnt(4)
    v_mfma_f32_32x32x16_bf16 v[52:67], v[28:31], a[200:203], v[52:67]
    ds_read_b128 v[20:23], v8 offset:57344
    v_mfma_f32_32x32x16_bf16 v[52:67], v[32:35], a[204:207], v[52:67]
    ds_read_b128 v[24:27], v9 offset:57344
    s_waitcnt lgkmcnt(4)
    v_mfma_f32_32x32x16_bf16 v[52:67], v[36:39], a[208:211], v[52:67]
    ds_read_b128 v[28:31], v10 offset:57344
    v_mfma_f32_32x32x16_bf16 v[52:67], v[40:43], a[212:215], v[52:67]
    ds_read_b128 v[32:35], v11 offset:57344
    s_waitcnt lgkmcnt(4)
    v_mfma_f32_32x32x16_bf16 v[52:67], v[44:47], a[216:219], v[52:67]
    ds_read_b128 v[36:39], v8 offset:61440
    v_mfma_f32_32x32x16_bf16 v[52:67], v[48:51], a[220:223], v[52:67]
    ds_read_b128 v[40:43], v9 offset:61440
    s_waitcnt lgkmcnt(4)
    v_mfma_f32_32x32x16_bf16 v[52:67], v[20:23], a[224:227], v[52:67]
    ds_read_b128 v[44:47], v10 offset:61440
    v_mfma_f32_32x32x16_bf16 v[52:67], v[24:27], a[228:231], v[52:67]
    ds_read_b128 v[48:51], v11 offset:61440
    s_waitcnt lgkmcnt(5)
    v_mfma_f32_32x32x16_bf16 v[52:67], v[28:31], a[232:235], v[52:67]
    s_waitcnt lgkmcnt(4)
    v_mfma_f32_32x32x16_bf16 v[52:67], v[32:35], a[236:239], v[52:67]
    s_waitcnt lgkmcnt(3)
    v_mfma_f32_32x32x16_bf16 v[52:67], v[36:39], a[240:243], v[52:67]
    s_waitcnt lgkmcnt(2)
    v_mfma_f32_32x32x16_bf16 v[52:67], v[40:43], a[244:247], v[52:67]
    s_waitcnt lgkmcnt(1)
    v_mfma_f32_32x32x16_bf16 v[52:67], v[44:47], a[248:251], v[52:67]
    s_waitcnt lgkmcnt(0)
    v_mfma_f32_32x32x16_bf16 v[52:67], v[48:51], a[252:255], v[52:67]
    s_add_u32 s42, s42, 1
    v_and_b32 v3, 15, v0
    v_lshlrev_b32 v3, 4, v3
    s_branch mega_kernel_syv
    mega_kernel_syvw:
    s_sleep 4
    mega_kernel_syv:
    buffer_load_dword v2, v3, s[72:75], 0 offen sc1
    s_waitcnt vmcnt(0)
    s_cmp_eq_u32 s95, 1
    s_cbranch_scc0 mega_kernel_syvf
    v_readlane_b32 s76, v2, 14
    s_mov_b32 s98, 0
    s_cmp_eq_u32 s76, 64
    s_cbranch_scc0 mega_kernel_syvw
    s_branch mega_kernel_syvd
    mega_kernel_syvf:
    s_mov_b32 s77, 0
    s_mov_b32 s78, 0
    v_readlane_b32 s76, v2, 0
    s_add_u32 s77, s77, s76
    s_xor_b32 s76, s76, 32
    s_or_b32 s78, s78, s76
    v_readlane_b32 s76, v2, 1
    s_add_u32 s77, s77, s76
    s_xor_b32 s76, s76, 32
    s_or_b32 s78, s78, s76
    v_readlane_b32 s76, v2, 2
    s_add_u32 s77, s77, s76
    s_xor_b32 s76, s76, 32
    s_or_b32 s78, s78, s76
    v_readlane_b32 s76, v2, 3
    s_add_u32 s77, s77, s76
    s_xor_b32 s76, s76, 32
    s_or_b32 s78, s78, s76
    v_readlane_b32 s76, v2, 4
    s_add_u32 s77, s77, s76
    s_xor_b32 s76, s76, 32
    s_or_b32 s78, s78, s76
    v_readlane_b32 s76, v2, 5
    s_add_u32 s77, s77, s76
    s_xor_b32 s76, s76, 32
    s_or_b32 s78, s78, s76
    v_readlane_b32 s76, v2, 6
    s_add_u32 s77, s77, s76
    s_xor_b32 s76, s76, 32
    s_or_b32 s78, s78, s76
    v_readlane_b32 s76, v2, 7
    s_add_u32 s77, s77, s76
    s_xor_b32 s76, s76, 32
    s_or_b32 s78, s78, s76
    s_cmp_eq_u32 s77, 256
    s_cbranch_scc0 mega_kernel_syvw
    v_mov_b32 v252, v2
    s_cmp_eq_u32 s78, 0
    s_cbranch_scc0 mega_kernel_slowent
    v_readlane_b32 s76, v2, 10
    v_readlane_b32 s77, v2, 8
    s_cmp_eq_u32 s76, 64
    s_cbranch_scc0 mega_kernel_syvw
    s_cmp_gt_u32 s77, 32
    s_cselect_b32 s98, 1, 0
    mega_kernel_syvd:
    s_lshr_b32 s44, s47, 3
    s_xor_b32 s44, s44, s98
    s_and_b32 s44, s44, 1
    s_lshl_b32 s44, s44, 13
    s_lshl_b32 s48, s47, 18
    s_add_u32 s48, s48, s44
    s_add_u32 s48, s48, 33554432
    s_xor_b32 s44, s98, 1
    s_lshl_b32 s44, s44, 13
    s_lshl_b32 s49, s40, 7
    s_add_u32 s49, s49, s44
    s_lshl_b32 s44, s41, 2
    s_add_u32 s49, s49, s44
    s_add_u32 s49, s49, 69210112
    v_mov_b32 v16, 0
    v_cvt_pk_bf16_f32 v84, v52, v53
    v_cvt_pk_bf16_f32 v85, v54, v55
    v_cvt_pk_bf16_f32 v86, v60, v61
    v_cvt_pk_bf16_f32 v87, v62, v63
    v_cvt_pk_bf16_f32 v88, v56, v57
    v_cvt_pk_bf16_f32 v89, v58, v59
    v_cvt_pk_bf16_f32 v90, v64, v65
    v_cvt_pk_bf16_f32 v91, v66, v67
    s_add_u32 s51, s42, s47
    s_sub_u32 s51, s51, 1
    s_bfe_u32 s52, s51, 0x40002
    s_lshl_b32 s52, s52, 14
    s_and_b32 s51, s51, 3
    s_lshl_b32 s51, s51, 11
    s_add_u32 s51, s51, s52
    s_add_u32 s51, s51, s48
    buffer_store_dwordx4 v[84:87], v7, s[84:87], s51 offen sc1
    buffer_store_dwordx4 v[88:91], v7, s[84:87], s51 offen offset:512 sc1
    s_waitcnt vmcnt(0)
    v_mov_b32 v17, s42
    s_mov_b64 exec, 1
    buffer_store_dword v17, v16, s[84:87], s49 offen sc1
    s_mov_b64 exec, -1
mega_kernel_v_loop:
    s_waitcnt vmcnt(2)
    s_barrier
    s_add_u32 s50, s42, 1
    s_min_u32 s50, s50, 63
    s_lshl_b32 s50, s50, 16
    ds_read_b128 v[20:23], v12 offset:0
    ds_read_b128 v[24:27], v13 offset:0
    ds_read_b128 v[28:31], v14 offset:0
    ds_read_b128 v[32:35], v15 offset:0
    ds_read_b128 v[36:39], v12 offset:4096
    ds_read_b128 v[40:43], v13 offset:4096
    s_waitcnt lgkmcnt(4)
    v_mfma_f32_32x32x16_bf16 v[68:83], v[20:23], a[0:3], 0
    ds_read_b128 v[44:47], v14 offset:4096
    v_cvt_pk_bf16_f32 v84, v52, v53
    v_cvt_pk_bf16_f32 v85, v54, v55
    v_cvt_pk_bf16_f32 v86, v60, v61
    v_mfma_f32_32x32x16_bf16 v[68:83], v[24:27], a[4:7], v[68:83]
    ds_read_b128 v[48:51], v15 offset:4096
    v_cvt_pk_bf16_f32 v87, v62, v63
    v_cvt_pk_bf16_f32 v88, v56, v57
    v_cvt_pk_bf16_f32 v89, v58, v59
    s_waitcnt lgkmcnt(4)
    v_mfma_f32_32x32x16_bf16 v[68:83], v[28:31], a[8:11], v[68:83]
    ds_read_b128 v[20:23], v12 offset:8192
    v_cvt_pk_bf16_f32 v90, v64, v65
    v_cvt_pk_bf16_f32 v91, v66, v67
    v_mfma_f32_32x32x16_bf16 v[68:83], v[32:35], a[12:15], v[68:83]
    ds_read_b128 v[24:27], v13 offset:8192
    s_add_u32 s51, s42, s47
    s_sub_u32 s51, s51, 1
    s_bfe_u32 s52, s51, 0x40002
    s_lshl_b32 s52, s52, 14
    s_waitcnt lgkmcnt(4)
    v_mfma_f32_32x32x16_bf16 v[68:83], v[36:39], a[16:19], v[68:83]
    ds_read_b128 v[28:31], v14 offset:8192
    s_and_b32 s51, s51, 3
    s_lshl_b32 s51, s51, 11
    s_add_u32 s51, s51, s52
    s_add_u32 s51, s51, s48
    buffer_store_dwordx4 v[84:87], v7, s[84:87], s51 offen sc1
    v_mfma_f32_32x32x16_bf16 v[68:83], v[40:43], a[20:23], v[68:83]
    ds_read_b128 v[32:35], v15 offset:8192
    buffer_store_dwordx4 v[88:91], v7, s[84:87], s51 offen offset:512 sc1
    s_waitcnt lgkmcnt(4)
    v_mfma_f32_32x32x16_bf16 v[68:83], v[44:47], a[24:27], v[68:83]
    ds_read_b128 v[36:39], v12 offset:12288
    s_add_u32 m0, s46, 0
    v_mfma_f32_32x32x16_bf16 v[68:83], v[48:51], a[28:31], v[68:83]
    ds_read_b128 v[40:43], v13 offset:12288
    buffer_load_dwordx4 v6, s[8:11], s50 offen offset:0 lds
    s_waitcnt lgkmcnt(4)
    v_mfma_f32_32x32x16_bf16 v[68:83], v[20:23], a[32:35], v[68:83]
    ds_read_b128 v[44:47], v14 offset:12288
    s_add_u32 m0, s46, 3968
    v_mfma_f32_32x32x16_bf16 v[68:83], v[24:27], a[36:39], v[68:83]
    ds_read_b128 v[48:51], v15 offset:12288
    buffer_load_dwordx4 v6, s[8:11], s50 offen offset:128 lds
    s_waitcnt lgkmcnt(4)
    v_mfma_f32_32x32x16_bf16 v[68:83], v[28:31], a[40:43], v[68:83]
    ds_read_b128 v[20:23], v12 offset:16384
    s_add_u32 m0, s46, 7936
    v_mfma_f32_32x32x16_bf16 v[68:83], v[32:35], a[44:47], v[68:83]
    ds_read_b128 v[24:27], v13 offset:16384
    buffer_load_dwordx4 v6, s[8:11], s50 offen offset:256 lds
    s_waitcnt lgkmcnt(4)
    v_mfma_f32_32x32x16_bf16 v[68:83], v[36:39], a[48:51], v[68:83]
    ds_read_b128 v[28:31], v14 offset:16384
    s_add_u32 m0, s46, 11904
    v_mfma_f32_32x32x16_bf16 v[68:83], v[40:43], a[52:55], v[68:83]
    ds_read_b128 v[32:35], v15 offset:16384
    buffer_load_dwordx4 v6, s[8:11], s50 offen offset:384 lds
    s_waitcnt lgkmcnt(4)
    v_mfma_f32_32x32x16_bf16 v[68:83], v[44:47], a[56:59], v[68:83]
    ds_read_b128 v[36:39], v12 offset:20480
    s_add_u32 m0, s46, 15872
    v_mfma_f32_32x32x16_bf16 v[68:83], v[48:51], a[60:63], v[68:83]
    ds_read_b128 v[40:43], v13 offset:20480
    buffer_load_dwordx4 v6, s[8:11], s50 offen offset:512 lds
    s_waitcnt lgkmcnt(4)
    v_mfma_f32_32x32x16_bf16 v[68:83], v[20:23], a[64:67], v[68:83]
    ds_read_b128 v[44:47], v14 offset:20480
    s_add_u32 m0, s46, 19840
    v_mfma_f32_32x32x16_bf16 v[68:83], v[24:27], a[68:71], v[68:83]
    ds_read_b128 v[48:51], v15 offset:20480
    buffer_load_dwordx4 v6, s[8:11], s50 offen offset:640 lds
    s_waitcnt lgkmcnt(4)
    v_mfma_f32_32x32x16_bf16 v[68:83], v[28:31], a[72:75], v[68:83]
    ds_read_b128 v[20:23], v12 offset:24576
    s_add_u32 m0, s46, 23808
    v_mfma_f32_32x32x16_bf16 v[68:83], v[32:35], a[76:79], v[68:83]
    ds_read_b128 v[24:27], v13 offset:24576
    buffer_load_dwordx4 v6, s[8:11], s50 offen offset:768 lds
    s_waitcnt lgkmcnt(4)
    v_mfma_f32_32x32x16_bf16 v[68:83], v[36:39], a[80:83], v[68:83]
    ds_read_b128 v[28:31], v14 offset:24576
    s_add_u32 m0, s46, 27776
    v_mfma_f32_32x32x16_bf16 v[68:83], v[40:43], a[84:87], v[68:83]
    ds_read_b128 v[32:35], v15 offset:24576
    buffer_load_dwordx4 v6, s[8:11], s50 offen offset:896 lds
    s_waitcnt lgkmcnt(4)
    v_mfma_f32_32x32x16_bf16 v[68:83], v[44:47], a[88:91], v[68:83]
    ds_read_b128 v[36:39], v12 offset:28672
    s_add_u32 m0, s46, 31744
    v_mfma_f32_32x32x16_bf16 v[68:83], v[48:51], a[92:95], v[68:83]
    ds_read_b128 v[40:43], v13 offset:28672
    buffer_load_dwordx4 v6, s[8:11], s50 offen offset:1024 lds
    s_waitcnt lgkmcnt(4)
    v_mfma_f32_32x32x16_bf16 v[68:83], v[20:23], a[96:99], v[68:83]
    ds_read_b128 v[44:47], v14 offset:28672
    s_add_u32 m0, s46, 35712
    v_mfma_f32_32x32x16_bf16 v[68:83], v[24:27], a[100:103], v[68:83]
    ds_read_b128 v[48:51], v15 offset:28672
    buffer_load_dwordx4 v6, s[8:11], s50 offen offset:1152 lds
    s_waitcnt lgkmcnt(4)
    v_mfma_f32_32x32x16_bf16 v[68:83], v[28:31], a[104:107], v[68:83]
    ds_read_b128 v[20:23], v12 offset:32768
    s_add_u32 m0, s46, 39680
    v_mfma_f32_32x32x16_bf16 v[68:83], v[32:35], a[108:111], v[68:83]
    ds_read_b128 v[24:27], v13 offset:32768
    buffer_load_dwordx4 v6, s[8:11], s50 offen offset:1280 lds
    s_waitcnt lgkmcnt(4)
    v_mfma_f32_32x32x16_bf16 v[68:83], v[36:39], a[112:115], v[68:83]
    ds_read_b128 v[28:31], v14 offset:32768
    s_add_u32 m0, s46, 43648
    v_mfma_f32_32x32x16_bf16 v[68:83], v[40:43], a[116:119], v[68:83]
    ds_read_b128 v[32:35], v15 offset:32768
    buffer_load_dwordx4 v6, s[8:11], s50 offen offset:1408 lds
    s_waitcnt lgkmcnt(4)
    v_mfma_f32_32x32x16_bf16 v[68:83], v[44:47], a[120:123], v[68:83]
    ds_read_b128 v[36:39], v12 offset:36864
    s_add_u32 m0, s46, 47616
    v_mfma_f32_32x32x16_bf16 v[68:83], v[48:51], a[124:127], v[68:83]
    ds_read_b128 v[40:43], v13 offset:36864
    buffer_load_dwordx4 v6, s[8:11], s50 offen offset:1536 lds
    s_waitcnt lgkmcnt(4)
    v_mfma_f32_32x32x16_bf16 v[68:83], v[20:23], a[128:131], v[68:83]
    ds_read_b128 v[44:47], v14 offset:36864
    s_add_u32 m0, s46, 51584
    v_mfma_f32_32x32x16_bf16 v[68:83], v[24:27], a[132:135], v[68:83]
    ds_read_b128 v[48:51], v15 offset:36864
    buffer_load_dwordx4 v6, s[8:11], s50 offen offset:1664 lds
    s_waitcnt lgkmcnt(4)
    v_mfma_f32_32x32x16_bf16 v[68:83], v[28:31], a[136:139], v[68:83]
    ds_read_b128 v[20:23], v12 offset:40960
    s_add_u32 m0, s46, 55552
    v_mfma_f32_32x32x16_bf16 v[68:83], v[32:35], a[140:143], v[68:83]
    ds_read_b128 v[24:27], v13 offset:40960
    buffer_load_dwordx4 v6, s[8:11], s50 offen offset:1792 lds
    s_waitcnt lgkmcnt(4)
    v_mfma_f32_32x32x16_bf16 v[68:83], v[36:39], a[144:147], v[68:83]
    ds_read_b128 v[28:31], v14 offset:40960
    s_add_u32 m0, s46, 59520
    v_mfma_f32_32x32x16_bf16 v[68:83], v[40:43], a[148:151], v[68:83]
    ds_read_b128 v[32:35], v15 offset:40960
    buffer_load_dwordx4 v6, s[8:11], s50 offen offset:1920 lds
    s_waitcnt lgkmcnt(4)
    v_mfma_f32_32x32x16_bf16 v[68:83], v[44:47], a[152:155], v[68:83]
    ds_read_b128 v[36:39], v12 offset:45056
    v_mfma_f32_32x32x16_bf16 v[68:83], v[48:51], a[156:159], v[68:83]
    ds_read_b128 v[40:43], v13 offset:45056
    s_waitcnt lgkmcnt(4)
    v_mfma_f32_32x32x16_bf16 v[68:83], v[20:23], a[160:163], v[68:83]
    ds_read_b128 v[44:47], v14 offset:45056
    v_mfma_f32_32x32x16_bf16 v[68:83], v[24:27], a[164:167], v[68:83]
    ds_read_b128 v[48:51], v15 offset:45056
    s_waitcnt lgkmcnt(4)
    v_mfma_f32_32x32x16_bf16 v[68:83], v[28:31], a[168:171], v[68:83]
    ds_read_b128 v[20:23], v12 offset:49152
    s_waitcnt vmcnt(16)
    v_mov_b32 v17, s42
    s_mov_b64 exec, 1
    buffer_store_dword v17, v16, s[84:87], s49 offen sc1
    s_mov_b64 exec, -1
    v_mfma_f32_32x32x16_bf16 v[68:83], v[32:35], a[172:175], v[68:83]
    ds_read_b128 v[24:27], v13 offset:49152
    s_waitcnt lgkmcnt(4)
    v_mfma_f32_32x32x16_bf16 v[68:83], v[36:39], a[176:179], v[68:83]
    ds_read_b128 v[28:31], v14 offset:49152
    s_add_u32 s53, s42, 3
    s_min_u32 s53, s53, 63
    s_lshl_b32 s53, s53, 16
    s_mov_b64 exec, 0xffff
    buffer_load_dword v18, v19, s[8:11], s53 offen
    s_mov_b64 exec, -1
    v_mfma_f32_32x32x16_bf16 v[68:83], v[40:43], a[180:183], v[68:83]
    ds_read_b128 v[32:35], v15 offset:49152
    s_waitcnt lgkmcnt(4)
    v_mfma_f32_32x32x16_bf16 v[68:83], v[44:47], a[184:187], v[68:83]
    ds_read_b128 v[36:39], v12 offset:53248
    v_mfma_f32_32x32x16_bf16 v[68:83], v[48:51], a[188:191], v[68:83]
    ds_read_b128 v[40:43], v13 offset:53248
    s_waitcnt lgkmcnt(4)
    v_mfma_f32_32x32x16_bf16 v[68:83], v[20:23], a[192:195], v[68:83]
    ds_read_b128 v[44:47], v14 offset:53248
    v_mfma_f32_32x32x16_bf16 v[68:83], v[24:27], a[196:199], v[68:83]
    ds_read_b128 v[48:51], v15 offset:53248
    s_waitcnt lgkmcnt(4)
    v_mfma_f32_32x32x16_bf16 v[68:83], v[28:31], a[200:203], v[68:83]
    ds_read_b128 v[20:23], v12 offset:57344
    v_mfma_f32_32x32x16_bf16 v[68:83], v[32:35], a[204:207], v[68:83]
    ds_read_b128 v[24:27], v13 offset:57344
    s_waitcnt lgkmcnt(4)
    v_mfma_f32_32x32x16_bf16 v[68:83], v[36:39], a[208:211], v[68:83]
    ds_read_b128 v[28:31], v14 offset:57344
    v_mfma_f32_32x32x16_bf16 v[68:83], v[40:43], a[212:215], v[68:83]
    ds_read_b128 v[32:35], v15 offset:57344
    s_waitcnt lgkmcnt(4)
    v_mfma_f32_32x32x16_bf16 v[68:83], v[44:47], a[216:219], v[68:83]
    ds_read_b128 v[36:39], v12 offset:61440
    v_mfma_f32_32x32x16_bf16 v[68:83], v[48:51], a[220:223], v[68:83]
    ds_read_b128 v[40:43], v13 offset:61440
    s_waitcnt lgkmcnt(4)
    v_mfma_f32_32x32x16_bf16 v[68:83], v[20:23], a[224:227], v[68:83]
    ds_read_b128 v[44:47], v14 offset:61440
    v_mfma_f32_32x32x16_bf16 v[68:83], v[24:27], a[228:231], v[68:83]
    ds_read_b128 v[48:51], v15 offset:61440
    s_waitcnt lgkmcnt(5)
    v_mfma_f32_32x32x16_bf16 v[68:83], v[28:31], a[232:235], v[68:83]
    s_waitcnt lgkmcnt(4)
    v_mfma_f32_32x32x16_bf16 v[68:83], v[32:35], a[236:239], v[68:83]
    s_waitcnt lgkmcnt(3)
    v_mfma_f32_32x32x16_bf16 v[68:83], v[36:39], a[240:243], v[68:83]
    s_waitcnt lgkmcnt(2)
    v_mfma_f32_32x32x16_bf16 v[68:83], v[40:43], a[244:247], v[68:83]
    s_waitcnt lgkmcnt(1)
    v_mfma_f32_32x32x16_bf16 v[68:83], v[44:47], a[248:251], v[68:83]
    s_waitcnt lgkmcnt(0)
    v_mfma_f32_32x32x16_bf16 v[68:83], v[48:51], a[252:255], v[68:83]
    s_add_u32 s42, s42, 1
    s_cmp_eq_u32 s42, 64
    s_cbranch_scc1 mega_kernel_v_fin
    s_waitcnt vmcnt(2)
    s_barrier
    s_add_u32 s50, s42, 1
    s_min_u32 s50, s50, 63
    s_lshl_b32 s50, s50, 16
    ds_read_b128 v[20:23], v8 offset:0
    ds_read_b128 v[24:27], v9 offset:0
    ds_read_b128 v[28:31], v10 offset:0
    ds_read_b128 v[32:35], v11 offset:0
    ds_read_b128 v[36:39], v8 offset:4096
    ds_read_b128 v[40:43], v9 offset:4096
    s_waitcnt lgkmcnt(4)
    v_mfma_f32_32x32x16_bf16 v[52:67], v[20:23], a[0:3], 0
    ds_read_b128 v[44:47], v10 offset:4096
    v_cvt_pk_bf16_f32 v84, v68, v69
    v_cvt_pk_bf16_f32 v85, v70, v71
    v_cvt_pk_bf16_f32 v86, v76, v77
    v_mfma_f32_32x32x16_bf16 v[52:67], v[24:27], a[4:7], v[52:67]
    ds_read_b128 v[48:51], v11 offset:4096
    v_cvt_pk_bf16_f32 v87, v78, v79
    v_cvt_pk_bf16_f32 v88, v72, v73
    v_cvt_pk_bf16_f32 v89, v74, v75
    s_waitcnt lgkmcnt(4)
    v_mfma_f32_32x32x16_bf16 v[52:67], v[28:31], a[8:11], v[52:67]
    ds_read_b128 v[20:23], v8 offset:8192
    v_cvt_pk_bf16_f32 v90, v80, v81
    v_cvt_pk_bf16_f32 v91, v82, v83
    v_mfma_f32_32x32x16_bf16 v[52:67], v[32:35], a[12:15], v[52:67]
    ds_read_b128 v[24:27], v9 offset:8192
    s_add_u32 s51, s42, s47
    s_sub_u32 s51, s51, 1
    s_bfe_u32 s52, s51, 0x40002
    s_lshl_b32 s52, s52, 14
    s_waitcnt lgkmcnt(4)
    v_mfma_f32_32x32x16_bf16 v[52:67], v[36:39], a[16:19], v[52:67]
    ds_read_b128 v[28:31], v10 offset:8192
    s_and_b32 s51, s51, 3
    s_lshl_b32 s51, s51, 11
    s_add_u32 s51, s51, s52
    s_add_u32 s51, s51, s48
    buffer_store_dwordx4 v[84:87], v7, s[84:87], s51 offen sc1
    v_mfma_f32_32x32x16_bf16 v[52:67], v[40:43], a[20:23], v[52:67]
    ds_read_b128 v[32:35], v11 offset:8192
    buffer_store_dwordx4 v[88:91], v7, s[84:87], s51 offen offset:512 sc1
    s_waitcnt lgkmcnt(4)
    v_mfma_f32_32x32x16_bf16 v[52:67], v[44:47], a[24:27], v[52:67]
    ds_read_b128 v[36:39], v8 offset:12288
    s_add_u32 m0, s46, 65536
    v_mfma_f32_32x32x16_bf16 v[52:67], v[48:51], a[28:31], v[52:67]
    ds_read_b128 v[40:43], v9 offset:12288
    buffer_load_dwordx4 v6, s[8:11], s50 offen offset:0 lds
    s_waitcnt lgkmcnt(4)
    v_mfma_f32_32x32x16_bf16 v[52:67], v[20:23], a[32:35], v[52:67]
    ds_read_b128 v[44:47], v10 offset:12288
    s_add_u32 m0, s46, 69504
    v_mfma_f32_32x32x16_bf16 v[52:67], v[24:27], a[36:39], v[52:67]
    ds_read_b128 v[48:51], v11 offset:12288
    buffer_load_dwordx4 v6, s[8:11], s50 offen offset:128 lds
    s_waitcnt lgkmcnt(4)
    v_mfma_f32_32x32x16_bf16 v[52:67], v[28:31], a[40:43], v[52:67]
    ds_read_b128 v[20:23], v8 offset:16384
    s_add_u32 m0, s46, 73472
    v_mfma_f32_32x32x16_bf16 v[52:67], v[32:35], a[44:47], v[52:67]
    ds_read_b128 v[24:27], v9 offset:16384
    buffer_load_dwordx4 v6, s[8:11], s50 offen offset:256 lds
    s_waitcnt lgkmcnt(4)
    v_mfma_f32_32x32x16_bf16 v[52:67], v[36:39], a[48:51], v[52:67]
    ds_read_b128 v[28:31], v10 offset:16384
    s_add_u32 m0, s46, 77440
    v_mfma_f32_32x32x16_bf16 v[52:67], v[40:43], a[52:55], v[52:67]
    ds_read_b128 v[32:35], v11 offset:16384
    buffer_load_dwordx4 v6, s[8:11], s50 offen offset:384 lds
    s_waitcnt lgkmcnt(4)
    v_mfma_f32_32x32x16_bf16 v[52:67], v[44:47], a[56:59], v[52:67]
    ds_read_b128 v[36:39], v8 offset:20480
    s_add_u32 m0, s46, 81408
    v_mfma_f32_32x32x16_bf16 v[52:67], v[48:51], a[60:63], v[52:67]
    ds_read_b128 v[40:43], v9 offset:20480
    buffer_load_dwordx4 v6, s[8:11], s50 offen offset:512 lds
    s_waitcnt lgkmcnt(4)
    v_mfma_f32_32x32x16_bf16 v[52:67], v[20:23], a[64:67], v[52:67]
    ds_read_b128 v[44:47], v10 offset:20480
    s_add_u32 m0, s46, 85376
    v_mfma_f32_32x32x16_bf16 v[52:67], v[24:27], a[68:71], v[52:67]
    ds_read_b128 v[48:51], v11 offset:20480
    buffer_load_dwordx4 v6, s[8:11], s50 offen offset:640 lds
    s_waitcnt lgkmcnt(4)
    v_mfma_f32_32x32x16_bf16 v[52:67], v[28:31], a[72:75], v[52:67]
    ds_read_b128 v[20:23], v8 offset:24576
    s_add_u32 m0, s46, 89344
    v_mfma_f32_32x32x16_bf16 v[52:67], v[32:35], a[76:79], v[52:67]
    ds_read_b128 v[24:27], v9 offset:24576
    buffer_load_dwordx4 v6, s[8:11], s50 offen offset:768 lds
    s_waitcnt lgkmcnt(4)
    v_mfma_f32_32x32x16_bf16 v[52:67], v[36:39], a[80:83], v[52:67]
    ds_read_b128 v[28:31], v10 offset:24576
    s_add_u32 m0, s46, 93312
    v_mfma_f32_32x32x16_bf16 v[52:67], v[40:43], a[84:87], v[52:67]
    ds_read_b128 v[32:35], v11 offset:24576
    buffer_load_dwordx4 v6, s[8:11], s50 offen offset:896 lds
    s_waitcnt lgkmcnt(4)
    v_mfma_f32_32x32x16_bf16 v[52:67], v[44:47], a[88:91], v[52:67]
    ds_read_b128 v[36:39], v8 offset:28672
    s_add_u32 m0, s46, 97280
    v_mfma_f32_32x32x16_bf16 v[52:67], v[48:51], a[92:95], v[52:67]
    ds_read_b128 v[40:43], v9 offset:28672
    buffer_load_dwordx4 v6, s[8:11], s50 offen offset:1024 lds
    s_waitcnt lgkmcnt(4)
    v_mfma_f32_32x32x16_bf16 v[52:67], v[20:23], a[96:99], v[52:67]
    ds_read_b128 v[44:47], v10 offset:28672
    s_add_u32 m0, s46, 101248
    v_mfma_f32_32x32x16_bf16 v[52:67], v[24:27], a[100:103], v[52:67]
    ds_read_b128 v[48:51], v11 offset:28672
    buffer_load_dwordx4 v6, s[8:11], s50 offen offset:1152 lds
    s_waitcnt lgkmcnt(4)
    v_mfma_f32_32x32x16_bf16 v[52:67], v[28:31], a[104:107], v[52:67]
    ds_read_b128 v[20:23], v8 offset:32768
    s_add_u32 m0, s46, 105216
    v_mfma_f32_32x32x16_bf16 v[52:67], v[32:35], a[108:111], v[52:67]
    ds_read_b128 v[24:27], v9 offset:32768
    buffer_load_dwordx4 v6, s[8:11], s50 offen offset:1280 lds
    s_waitcnt lgkmcnt(4)
    v_mfma_f32_32x32x16_bf16 v[52:67], v[36:39], a[112:115], v[52:67]
    ds_read_b128 v[28:31], v10 offset:32768
    s_add_u32 m0, s46, 109184
    v_mfma_f32_32x32x16_bf16 v[52:67], v[40:43], a[116:119], v[52:67]
    ds_read_b128 v[32:35], v11 offset:32768
    buffer_load_dwordx4 v6, s[8:11], s50 offen offset:1408 lds
    s_waitcnt lgkmcnt(4)
    v_mfma_f32_32x32x16_bf16 v[52:67], v[44:47], a[120:123], v[52:67]
    ds_read_b128 v[36:39], v8 offset:36864
    s_add_u32 m0, s46, 113152
    v_mfma_f32_32x32x16_bf16 v[52:67], v[48:51], a[124:127], v[52:67]
    ds_read_b128 v[40:43], v9 offset:36864
    buffer_load_dwordx4 v6, s[8:11], s50 offen offset:1536 lds
    s_waitcnt lgkmcnt(4)
    v_mfma_f32_32x32x16_bf16 v[52:67], v[20:23], a[128:131], v[52:67]
    ds_read_b128 v[44:47], v10 offset:36864
    s_add_u32 m0, s46, 117120
    v_mfma_f32_32x32x16_bf16 v[52:67], v[24:27], a[132:135], v[52:67]
    ds_read_b128 v[48:51], v11 offset:36864
    buffer_load_dwordx4 v6, s[8:11], s50 offen offset:1664 lds
    s_waitcnt lgkmcnt(4)
    v_mfma_f32_32x32x16_bf16 v[52:67], v[28:31], a[136:139], v[52:67]
    ds_read_b128 v[20:23], v8 offset:40960
    s_add_u32 m0, s46, 121088
    v_mfma_f32_32x32x16_bf16 v[52:67], v[32:35], a[140:143], v[52:67]
    ds_read_b128 v[24:27], v9 offset:40960
    buffer_load_dwordx4 v6, s[8:11], s50 offen offset:1792 lds
    s_waitcnt lgkmcnt(4)
    v_mfma_f32_32x32x16_bf16 v[52:67], v[36:39], a[144:147], v[52:67]
    ds_read_b128 v[28:31], v10 offset:40960
    s_add_u32 m0, s46, 125056
    v_mfma_f32_32x32x16_bf16 v[52:67], v[40:43], a[148:151], v[52:67]
    ds_read_b128 v[32:35], v11 offset:40960
    buffer_load_dwordx4 v6, s[8:11], s50 offen offset:1920 lds
    s_waitcnt lgkmcnt(4)
    v_mfma_f32_32x32x16_bf16 v[52:67], v[44:47], a[152:155], v[52:67]
    ds_read_b128 v[36:39], v8 offset:45056
    v_mfma_f32_32x32x16_bf16 v[52:67], v[48:51], a[156:159], v[52:67]
    ds_read_b128 v[40:43], v9 offset:45056
    s_waitcnt lgkmcnt(4)
    v_mfma_f32_32x32x16_bf16 v[52:67], v[20:23], a[160:163], v[52:67]
    ds_read_b128 v[44:47], v10 offset:45056
    v_mfma_f32_32x32x16_bf16 v[52:67], v[24:27], a[164:167], v[52:67]
    ds_read_b128 v[48:51], v11 offset:45056
    s_waitcnt lgkmcnt(4)
    v_mfma_f32_32x32x16_bf16 v[52:67], v[28:31], a[168:171], v[52:67]
    ds_read_b128 v[20:23], v8 offset:49152
    s_waitcnt vmcnt(16)
    v_mov_b32 v17, s42
    s_mov_b64 exec, 1
    buffer_store_dword v17, v16, s[84:87], s49 offen sc1
    s_mov_b64 exec, -1
    v_mfma_f32_32x32x16_bf16 v[52:67], v[32:35], a[172:175], v[52:67]
    ds_read_b128 v[24:27], v9 offset:49152
    s_waitcnt lgkmcnt(4)
    v_mfma_f32_32x32x16_bf16 v[52:67], v[36:39], a[176:179], v[52:67]
    ds_read_b128 v[28:31], v10 offset:49152
    s_add_u32 s53, s42, 3
    s_min_u32 s53, s53, 63
    s_lshl_b32 s53, s53, 16
    s_mov_b64 exec, 0xffff
    buffer_load_dword v18, v19, s[8:11], s53 offen
    s_mov_b64 exec, -1
    v_mfma_f32_32x32x16_bf16 v[52:67], v[40:43], a[180:183], v[52:67]
    ds_read_b128 v[32:35], v11 offset:49152
    s_waitcnt lgkmcnt(4)
    v_mfma_f32_32x32x16_bf16 v[52:67], v[44:47], a[184:187], v[52:67]
    ds_read_b128 v[36:39], v8 offset:53248
    v_mfma_f32_32x32x16_bf16 v[52:67], v[48:51], a[188:191], v[52:67]
    ds_read_b128 v[40:43], v9 offset:53248
    s_waitcnt lgkmcnt(4)
    v_mfma_f32_32x32x16_bf16 v[52:67], v[20:23], a[192:195], v[52:67]
    ds_read_b128 v[44:47], v10 offset:53248
    v_mfma_f32_32x32x16_bf16 v[52:67], v[24:27], a[196:199], v[52:67]
    ds_read_b128 v[48:51], v11 offset:53248
    s_waitcnt lgkmcnt(4)
    v_mfma_f32_32x32x16_bf16 v[52:67], v[28:31], a[200:203], v[52:67]
    ds_read_b128 v[20:23], v8 offset:57344
    v_mfma_f32_32x32x16_bf16 v[52:67], v[32:35], a[204:207], v[52:67]
    ds_read_b128 v[24:27], v9 offset:57344
    s_waitcnt lgkmcnt(4)
    v_mfma_f32_32x32x16_bf16 v[52:67], v[36:39], a[208:211], v[52:67]
    ds_read_b128 v[28:31], v10 offset:57344
    v_mfma_f32_32x32x16_bf16 v[52:67], v[40:43], a[212:215], v[52:67]
    ds_read_b128 v[32:35], v11 offset:57344
    s_waitcnt lgkmcnt(4)
    v_mfma_f32_32x32x16_bf16 v[52:67], v[44:47], a[216:219], v[52:67]
    ds_read_b128 v[36:39], v8 offset:61440
    v_mfma_f32_32x32x16_bf16 v[52:67], v[48:51], a[220:223], v[52:67]
    ds_read_b128 v[40:43], v9 offset:61440
    s_waitcnt lgkmcnt(4)
    v_mfma_f32_32x32x16_bf16 v[52:67], v[20:23], a[224:227], v[52:67]
    ds_read_b128 v[44:47], v10 offset:61440
    v_mfma_f32_32x32x16_bf16 v[52:67], v[24:27], a[228:231], v[52:67]
    ds_read_b128 v[48:51], v11 offset:61440
    s_waitcnt lgkmcnt(5)
    v_mfma_f32_32x32x16_bf16 v[52:67], v[28:31], a[232:235], v[52:67]
    s_waitcnt lgkmcnt(4)
    v_mfma_f32_32x32x16_bf16 v[52:67], v[32:35], a[236:239], v[52:67]
    s_waitcnt lgkmcnt(3)
    v_mfma_f32_32x32x16_bf16 v[52:67], v[36:39], a[240:243], v[52:67]
    s_waitcnt lgkmcnt(2)
    v_mfma_f32_32x32x16_bf16 v[52:67], v[40:43], a[244:247], v[52:67]
    s_waitcnt lgkmcnt(1)
    v_mfma_f32_32x32x16_bf16 v[52:67], v[44:47], a[248:251], v[52:67]
    s_waitcnt lgkmcnt(0)
    v_mfma_f32_32x32x16_bf16 v[52:67], v[48:51], a[252:255], v[52:67]
    s_add_u32 s42, s42, 1
    s_branch mega_kernel_v_loop
mega_kernel_v_fin:
    s_nop 11
    v_cvt_pk_bf16_f32 v84, v68, v69
    v_cvt_pk_bf16_f32 v85, v70, v71
    v_cvt_pk_bf16_f32 v86, v76, v77
    v_cvt_pk_bf16_f32 v87, v78, v79
    v_cvt_pk_bf16_f32 v88, v72, v73
    v_cvt_pk_bf16_f32 v89, v74, v75
    v_cvt_pk_bf16_f32 v90, v80, v81
    v_cvt_pk_bf16_f32 v91, v82, v83
    s_add_u32 s51, s42, s47
    s_sub_u32 s51, s51, 1
    s_bfe_u32 s52, s51, 0x40002
    s_lshl_b32 s52, s52, 14
    s_and_b32 s51, s51, 3
    s_lshl_b32 s51, s51, 11
    s_add_u32 s51, s51, s52
    s_add_u32 s51, s51, s48
    buffer_store_dwordx4 v[84:87], v7, s[84:87], s51 offen sc1
    buffer_store_dwordx4 v[88:91], v7, s[84:87], s51 offen offset:512 sc1
    s_waitcnt vmcnt(0)
    v_mov_b32 v17, s42
    s_mov_b64 exec, 1
    buffer_store_dword v17, v16, s[84:87], s49 offen sc1
    s_mov_b64 exec, -1
    s_waitcnt vmcnt(0)
    s_barrier
mega_kernel_fft:
    s_mov_b32 s38, s92
    s_mov_b32 s39, 64
    s_mov_b32 s37, 128
mega_kernel_f2s:
    v_mov_b32 v1, 0
    s_mov_b32 s82, 69259264
mega_kernel_w0:
    s_sleep 8
    buffer_load_dword v2, v1, s[84:87], s82 offen sc1
    s_waitcnt vmcnt(0)
    v_cmp_ne_u32 vcc, 31, v2
    s_cbranch_vccnz mega_kernel_w0
    s_add_u32 s93, s38, 0
    s_cmp_lt_u32 s93, s37
    s_cbranch_scc0 mega_kernel_f2e
mega_kernel_f2l:
    s_barrier
    s_load_dwordx2 s[8:9], s[0:1], 96
    v_lshrrev_b32 v5, 6, v0
    v_and_b32 v1, 63, v0
    v_readfirstlane_b32 s12, v5
    s_lshl_b32 s13, s93, 2
    s_add_u32 s13, s13, s12
    s_cmp_ge_u32 s13, 513
    s_cbranch_scc1 mega_kernel_f2_end
    v_cvt_f32_u32 v2, v1
    s_waitcnt lgkmcnt(0)
    s_mov_b32 s10, 268435456
    s_mov_b32 s11, 0x00020000
    s_lshl_b32 s14, s13, 14
    s_add_u32 s15, s14, 96468992
    v_lshlrev_b32 v5, 3, v1
    s_add_u32 s16, s15, 0
    buffer_load_dwordx2 v[16:17], v5, s[8:11], s16 offen
    s_add_u32 s16, s15, 512
    buffer_load_dwordx2 v[18:19], v5, s[8:11], s16 offen
    s_add_u32 s16, s15, 1024
    buffer_load_dwordx2 v[20:21], v5, s[8:11], s16 offen
    s_add_u32 s16, s15, 1536
    buffer_load_dwordx2 v[22:23], v5, s[8:11], s16 offen
    s_add_u32 s16, s15, 2048
    buffer_load_dwordx2 v[24:25], v5, s[8:11], s16 offen
    s_add_u32 s16, s15, 2560
    buffer_load_dwordx2 v[26:27], v5, s[8:11], s16 offen
    s_add_u32 s16, s15, 3072
    buffer_load_dwordx2 v[28:29], v5, s[8:11], s16 offen
    s_add_u32 s16, s15, 3584
    buffer_load_dwordx2 v[30:31], v5, s[8:11], s16 offen
    s_add_u32 s16, s15, 4096
    buffer_load_dwordx2 v[32:33], v5, s[8:11], s16 offen
    s_add_u32 s16, s15, 4608
    buffer_load_dwordx2 v[34:35], v5, s[8:11], s16 offen
    s_add_u32 s16, s15, 5120
    buffer_load_dwordx2 v[36:37], v5, s[8:11], s16 offen
    s_add_u32 s16, s15, 5632
    buffer_load_dwordx2 v[38:39], v5, s[8:11], s16 offen
    s_add_u32 s16, s15, 6144
    buffer_load_dwordx2 v[40:41], v5, s[8:11], s16 offen
    s_add_u32 s16, s15, 6656
    buffer_load_dwordx2 v[42:43], v5, s[8:11], s16 offen
    s_add_u32 s16, s15, 7168
    buffer_load_dwordx2 v[44:45], v5, s[8:11], s16 offen
    s_add_u32 s16, s15, 7680
    buffer_load_dwordx2 v[46:47], v5, s[8:11], s16 offen
    s_add_u32 s16, s15, 8192
    buffer_load_dwordx2 v[48:49], v5, s[8:11], s16 offen
    s_add_u32 s16, s15, 8704
    buffer_load_dwordx2 v[50:51], v5, s[8:11], s16 offen
    s_add_u32 s16, s15, 9216
    buffer_load_dwordx2 v[52:53], v5, s[8:11], s16 offen
    s_add_u32 s16, s15, 9728
    buffer_load_dwordx2 v[54:55], v5, s[8:11], s16 offen
    s_add_u32 s16, s15, 10240
    buffer_load_dwordx2 v[56:57], v5, s[8:11], s16 offen
    s_add_u32 s16, s15, 10752
    buffer_load_dwordx2 v[58:59], v5, s[8:11], s16 offen
    s_add_u32 s16, s15, 11264
    buffer_load_dwordx2 v[60:61], v5, s[8:11], s16 offen
    s_add_u32 s16, s15, 11776
    buffer_load_dwordx2 v[62:63], v5, s[8:11], s16 offen
    s_add_u32 s16, s15, 12288
    buffer_load_dwordx2 v[64:65], v5, s[8:11], s16 offen
    s_add_u32 s16, s15, 12800
    buffer_load_dwordx2 v[66:67], v5, s[8:11], s16 offen
    s_add_u32 s16, s15, 13312
    buffer_load_dwordx2 v[68:69], v5, s[8:11], s16 offen
    s_add_u32 s16, s15, 13824
    buffer_load_dwordx2 v[70:71], v5, s[8:11], s16 offen
    s_add_u32 s16, s15, 14336
    buffer_load_dwordx2 v[72:73], v5, s[8:11], s16 offen
    s_add_u32 s16, s15, 14848
    buffer_load_dwordx2 v[74:75], v5, s[8:11], s16 offen
    s_add_u32 s16, s15, 15360
    buffer_load_dwordx2 v[76:77], v5, s[8:11], s16 offen
    s_add_u32 s16, s15, 15872
    buffer_load_dwordx2 v[78:79], v5, s[8:11], s16 offen
    s_mul_i32 s17, s12, 16896
    v_lshlrev_b32 v3, 3, v1
    v_add_u32 v3, s17, v3
    v_and_b32 v7, 1, v1
    v_lshrrev_b32 v6, 1, v1
    v_cvt_f32_u32 v8, v6
    v_cvt_f32_u32 v10, v7
    s_movk_i32 s18, 528
    v_mul_lo_u32 v4, v6, s18
    v_lshl_add_u32 v4, v7, 3, v4
    v_add_u32 v4, s17, v4
    v_mov_b32 v9, 1.0
    v_fma_f32 v9, v10, -2.0, v9
    v_lshlrev_b32 v5, 12, v7
    v_lshl_add_u32 v11, v6, 2, v5
    s_lshl_b32 s19, s13, 13
    s_add_u32 s19, s19, 121634816
    s_waitcnt vmcnt(0)
    v_sub_f32 v80, v16, v48
    v_sub_f32 v81, v17, v49
    v_add_f32 v16, v16, v48
    v_add_f32 v17, v17, v49
    v_sub_f32 v48, v18, v50
    v_sub_f32 v49, v19, v51
    v_add_f32 v18, v18, v50
    v_add_f32 v19, v19, v51
    v_mul_f32 v50, 0x3f7b14be, v48
    v_mul_f32 v51, 0xbe47c5c2, v48
    v_fmac_f32 v50, 0x3e47c5c2, v49
    v_fmac_f32 v51, 0x3f7b14be, v49
    v_sub_f32 v48, v20, v52
    v_sub_f32 v49, v21, v53
    v_add_f32 v20, v20, v52
    v_add_f32 v21, v21, v53
    v_mul_f32 v52, 0x3f6c835e, v48
    v_mul_f32 v53, 0xbec3ef15, v48
    v_fmac_f32 v52, 0x3ec3ef15, v49
    v_fmac_f32 v53, 0x3f6c835e, v49
    v_sub_f32 v48, v22, v54
    v_sub_f32 v49, v23, v55
    v_add_f32 v22, v22, v54
    v_add_f32 v23, v23, v55
    v_mul_f32 v54, 0x3f54db31, v48
    v_mul_f32 v55, 0xbf0e39da, v48
    v_fmac_f32 v54, 0x3f0e39da, v49
    v_fmac_f32 v55, 0x3f54db31, v49
    v_sub_f32 v48, v24, v56
    v_sub_f32 v49, v25, v57
    v_add_f32 v24, v24, v56
    v_add_f32 v25, v25, v57
    v_mul_f32 v56, 0x3f3504f3, v48
    v_mul_f32 v57, 0xbf3504f3, v48
    v_fmac_f32 v56, 0x3f3504f3, v49
    v_fmac_f32 v57, 0x3f3504f3, v49
    v_sub_f32 v48, v26, v58
    v_sub_f32 v49, v27, v59
    v_add_f32 v26, v26, v58
    v_add_f32 v27, v27, v59
    v_mul_f32 v58, 0x3f0e39da, v48
    v_mul_f32 v59, 0xbf54db31, v48
    v_fmac_f32 v58, 0x3f54db31, v49
    v_fmac_f32 v59, 0x3f0e39da, v49
    v_sub_f32 v48, v28, v60
    v_sub_f32 v49, v29, v61
    v_add_f32 v28, v28, v60
    v_add_f32 v29, v29, v61
    v_mul_f32 v60, 0x3ec3ef15, v48
    v_mul_f32 v61, 0xbf6c835e, v48
    v_fmac_f32 v60, 0x3f6c835e, v49
    v_fmac_f32 v61, 0x3ec3ef15, v49
    v_sub_f32 v48, v30, v62
    v_sub_f32 v49, v31, v63
    v_add_f32 v30, v30, v62
    v_add_f32 v31, v31, v63
    v_mul_f32 v62, 0x3e47c5c2, v48
    v_mul_f32 v63, 0xbf7b14be, v48
    v_fmac_f32 v62, 0x3f7b14be, v49
    v_fmac_f32 v63, 0x3e47c5c2, v49
    v_sub_f32 v48, v33, v65
    v_sub_f32 v49, v64, v32
    v_add_f32 v32, v32, v64
    v_add_f32 v33, v33, v65
    v_sub_f32 v64, v34, v66
    v_sub_f32 v65, v35, v67
    v_add_f32 v34, v34, v66
    v_add_f32 v35, v35, v67
    v_mul_f32 v66, 0xbe47c5c2, v64
    v_mul_f32 v67, 0xbf7b14be, v64
    v_fmac_f32 v66, 0x3f7b14be, v65
    v_fmac_f32 v67, 0xbe47c5c2, v65
    v_sub_f32 v64, v36, v68
    v_sub_f32 v65, v37, v69
    v_add_f32 v36, v36, v68
    v_add_f32 v37, v37, v69
    v_mul_f32 v68, 0xbec3ef15, v64
    v_mul_f32 v69, 0xbf6c835e, v64
    v_fmac_f32 v68, 0x3f6c835e, v65
    v_fmac_f32 v69, 0xbec3ef15, v65
    v_sub_f32 v64, v38, v70
    v_sub_f32 v65, v39, v71
    v_add_f32 v38, v38, v70
    v_add_f32 v39, v39, v71
    v_mul_f32 v70, 0xbf0e39da, v64
    v_mul_f32 v71, 0xbf54db31, v64
    v_fmac_f32 v70, 0x3f54db31, v65
    v_fmac_f32 v71, 0xbf0e39da, v65
    v_sub_f32 v64, v40, v72
    v_sub_f32 v65, v41, v73
    v_add_f32 v40, v40, v72
    v_add_f32 v41, v41, v73
    v_mul_f32 v72, 0xbf3504f3, v64
    v_mul_f32 v73, 0xbf3504f3, v64
    v_fmac_f32 v72, 0x3f3504f3, v65
    v_fmac_f32 v73, 0xbf3504f3, v65
    v_sub_f32 v64, v42, v74
    v_sub_f32 v65, v43, v75
    v_add_f32 v42, v42, v74
    v_add_f32 v43, v43, v75
    v_mul_f32 v74, 0xbf54db31, v64
    v_mul_f32 v75, 0xbf0e39da, v64
    v_fmac_f32 v74, 0x3f0e39da, v65
    v_fmac_f32 v75, 0xbf54db31, v65
    v_sub_f32 v64, v44, v76
    v_sub_f32 v65, v45, v77
    v_add_f32 v44, v44, v76
    v_add_f32 v45, v45, v77
    v_mul_f32 v76, 0xbf6c835e, v64
    v_mul_f32 v77, 0xbec3ef15, v64
    v_fmac_f32 v76, 0x3ec3ef15, v65
    v_fmac_f32 v77, 0xbf6c835e, v65
    v_sub_f32 v64, v46, v78
    v_sub_f32 v65, v47, v79
    v_add_f32 v46, v46, v78
    v_add_f32 v47, v47, v79
    v_mul_f32 v78, 0xbf7b14be, v64
    v_mul_f32 v79, 0xbe47c5c2, v64
    v_fmac_f32 v78, 0x3e47c5c2, v65
    v_fmac_f32 v79, 0xbf7b14be, v65
    v_sub_f32 v64, v16, v32
    v_sub_f32 v65, v17, v33
    v_add_f32 v16, v16, v32
    v_add_f32 v17, v17, v33
    v_sub_f32 v32, v18, v34
    v_sub_f32 v33, v19, v35
    v_add_f32 v18, v18, v34
    v_add_f32 v19, v19, v35
    v_mul_f32 v34, 0x3f6c835e, v32
    v_mul_f32 v35, 0xbec3ef15, v32
    v_fmac_f32 v34, 0x3ec3ef15, v33
    v_fmac_f32 v35, 0x3f6c835e, v33
    v_sub_f32 v32, v20, v36
    v_sub_f32 v33, v21, v37
    v_add_f32 v20, v20, v36
    v_add_f32 v21, v21, v37
    v_mul_f32 v36, 0x3f3504f3, v32
    v_mul_f32 v37, 0xbf3504f3, v32
    v_fmac_f32 v36, 0x3f3504f3, v33
    v_fmac_f32 v37, 0x3f3504f3, v33
    v_sub_f32 v32, v22, v38
    v_sub_f32 v33, v23, v39
    v_add_f32 v22, v22, v38
    v_add_f32 v23, v23, v39
    v_mul_f32 v38, 0x3ec3ef15, v32
    v_mul_f32 v39, 0xbf6c835e, v32
    v_fmac_f32 v38, 0x3f6c835e, v33
    v_fmac_f32 v39, 0x3ec3ef15, v33
    v_sub_f32 v32, v25, v41
    v_sub_f32 v33, v40, v24
    v_add_f32 v24, v24, v40
    v_add_f32 v25, v25, v41
    v_sub_f32 v40, v26, v42
    v_sub_f32 v41, v27, v43
    v_add_f32 v26, v26, v42
    v_add_f32 v27, v27, v43
    v_mul_f32 v42, 0xbec3ef15, v40
    v_mul_f32 v43, 0xbf6c835e, v40
    v_fmac_f32 v42, 0x3f6c835e, v41
    v_fmac_f32 v43, 0xbec3ef15, v41
    v_sub_f32 v40, v28, v44
    v_sub_f32 v41, v29, v45
    v_add_f32 v28, v28, v44
    v_add_f32 v29, v29, v45
    v_mul_f32 v44, 0xbf3504f3, v40
    v_mul_f32 v45, 0xbf3504f3, v40
    v_fmac_f32 v44, 0x3f3504f3, v41
    v_fmac_f32 v45, 0xbf3504f3, v41
    v_sub_f32 v40, v30, v46
    v_sub_f32 v41, v31, v47
    v_add_f32 v30, v30, v46
    v_add_f32 v31, v31, v47
    v_mul_f32 v46, 0xbf6c835e, v40
    v_mul_f32 v47, 0xbec3ef15, v40
    v_fmac_f32 v46, 0x3ec3ef15, v41
    v_fmac_f32 v47, 0xbf6c835e, v41
    v_sub_f32 v40, v80, v48
    v_sub_f32 v41, v81, v49
    v_add_f32 v80, v80, v48
    v_add_f32 v81, v81, v49
    v_sub_f32 v48, v50, v66
    v_sub_f32 v49, v51, v67
    v_add_f32 v50, v50, v66
    v_add_f32 v51, v51, v67
    v_mul_f32 v66, 0x3f6c835e, v48
    v_mul_f32 v67, 0xbec3ef15, v48
    v_fmac_f32 v66, 0x3ec3ef15, v49
    v_fmac_f32 v67, 0x3f6c835e, v49
    v_sub_f32 v48, v52, v68
    v_sub_f32 v49, v53, v69
    v_add_f32 v52, v52, v68
    v_add_f32 v53, v53, v69
    v_mul_f32 v68, 0x3f3504f3, v48
    v_mul_f32 v69, 0xbf3504f3, v48
    v_fmac_f32 v68, 0x3f3504f3, v49
    v_fmac_f32 v69, 0x3f3504f3, v49
    v_sub_f32 v48, v54, v70
    v_sub_f32 v49, v55, v71
    v_add_f32 v54, v54, v70
    v_add_f32 v55, v55, v71
    v_mul_f32 v70, 0x3ec3ef15, v48
    v_mul_f32 v71, 0xbf6c835e, v48
    v_fmac_f32 v70, 0x3f6c835e, v49
    v_fmac_f32 v71, 0x3ec3ef15, v49
    v_sub_f32 v48, v57, v73
    v_sub_f32 v49, v72, v56
    v_add_f32 v56, v56, v72
    v_add_f32 v57, v57, v73
    v_sub_f32 v72, v58, v74
    v_sub_f32 v73, v59, v75
    v_add_f32 v58, v58, v74
    v_add_f32 v59, v59, v75
    v_mul_f32 v74, 0xbec3ef15, v72
    v_mul_f32 v75, 0xbf6c835e, v72
    v_fmac_f32 v74, 0x3f6c835e, v73
    v_fmac_f32 v75, 0xbec3ef15, v73
    v_sub_f32 v72, v60, v76
    v_sub_f32 v73, v61, v77
    v_add_f32 v60, v60, v76
    v_add_f32 v61, v61, v77
    v_mul_f32 v76, 0xbf3504f3, v72
    v_mul_f32 v77, 0xbf3504f3, v72
    v_fmac_f32 v76, 0x3f3504f3, v73
    v_fmac_f32 v77, 0xbf3504f3, v73
    v_sub_f32 v72, v62, v78
    v_sub_f32 v73, v63, v79
    v_add_f32 v62, v62, v78
    v_add_f32 v63, v63, v79
    v_mul_f32 v78, 0xbf6c835e, v72
    v_mul_f32 v79, 0xbec3ef15, v72
    v_fmac_f32 v78, 0x3ec3ef15, v73
    v_fmac_f32 v79, 0xbf6c835e, v73
    v_sub_f32 v72, v16, v24
    v_sub_f32 v73, v17, v25
    v_add_f32 v16, v16, v24
    v_add_f32 v17, v17, v25
    v_sub_f32 v24, v18, v26
    v_sub_f32 v25, v19, v27
    v_add_f32 v18, v18, v26
    v_add_f32 v19, v19, v27
    v_mul_f32 v26, 0x3f3504f3, v24
    v_mul_f32 v27, 0xbf3504f3, v24
    v_fmac_f32 v26, 0x3f3504f3, v25
    v_fmac_f32 v27, 0x3f3504f3, v25
    v_sub_f32 v24, v21, v29
    v_sub_f32 v25, v28, v20
    v_add_f32 v20, v20, v28
    v_add_f32 v21, v21, v29
    v_sub_f32 v28, v22, v30
    v_sub_f32 v29, v23, v31
    v_add_f32 v22, v22, v30
    v_add_f32 v23, v23, v31
    v_mul_f32 v30, 0xbf3504f3, v28
    v_mul_f32 v31, 0xbf3504f3, v28
    v_fmac_f32 v30, 0x3f3504f3, v29
    v_fmac_f32 v31, 0xbf3504f3, v29
    v_sub_f32 v28, v64, v32
    v_sub_f32 v29, v65, v33
    v_add_f32 v64, v64, v32
    v_add_f32 v65, v65, v33
    v_sub_f32 v32, v34, v42
    v_sub_f32 v33, v35, v43
    v_add_f32 v34, v34, v42
    v_add_f32 v35, v35, v43
    v_mul_f32 v42, 0x3f3504f3, v32
    v_mul_f32 v43, 0xbf3504f3, v32
    v_fmac_f32 v42, 0x3f3504f3, v33
    v_fmac_f32 v43, 0x3f3504f3, v33
    v_sub_f32 v32, v37, v45
    v_sub_f32 v33, v44, v36
    v_add_f32 v36, v36, v44
    v_add_f32 v37, v37, v45
    v_sub_f32 v44, v38, v46
    v_sub_f32 v45, v39, v47
    v_add_f32 v38, v38, v46
    v_add_f32 v39, v39, v47
    v_mul_f32 v46, 0xbf3504f3, v44
    v_mul_f32 v47, 0xbf3504f3, v44
    v_fmac_f32 v46, 0x3f3504f3, v45
    v_fmac_f32 v47, 0xbf3504f3, v45
    v_sub_f32 v44, v80, v56
    v_sub_f32 v45, v81, v57
    v_add_f32 v80, v80, v56
    v_add_f32 v81, v81, v57
    v_sub_f32 v56, v50, v58
    v_sub_f32 v57, v51, v59
    v_add_f32 v50, v50, v58
    v_add_f32 v51, v51, v59
    v_mul_f32 v58, 0x3f3504f3, v56
    v_mul_f32 v59, 0xbf3504f3, v56
    v_fmac_f32 v58, 0x3f3504f3, v57
    v_fmac_f32 v59, 0x3f3504f3, v57
    v_sub_f32 v56, v53, v61
    v_sub_f32 v57, v60, v52
    v_add_f32 v52, v52, v60
    v_add_f32 v53, v53, v61
    v_sub_f32 v60, v54, v62
    v_sub_f32 v61, v55, v63
    v_add_f32 v54, v54, v62
    v_add_f32 v55, v55, v63
    v_mul_f32 v62, 0xbf3504f3, v60
    v_mul_f32 v63, 0xbf3504f3, v60
    v_fmac_f32 v62, 0x3f3504f3, v61
    v_fmac_f32 v63, 0xbf3504f3, v61
    v_sub_f32 v60, v40, v48
    v_sub_f32 v61, v41, v49
    v_add_f32 v40, v40, v48
    v_add_f32 v41, v41, v49
    v_sub_f32 v48, v66, v74
    v_sub_f32 v49, v67, v75
    v_add_f32 v66, v66, v74
    v_add_f32 v67, v67, v75
    v_mul_f32 v74, 0x3f3504f3, v48
    v_mul_f32 v75, 0xbf3504f3, v48
    v_fmac_f32 v74, 0x3f3504f3, v49
    v_fmac_f32 v75, 0x3f3504f3, v49
    v_sub_f32 v48, v69, v77
    v_sub_f32 v49, v76, v68
    v_add_f32 v68, v68, v76
    v_add_f32 v69, v69, v77
    v_sub_f32 v76, v70, v78
    v_sub_f32 v77, v71, v79
    v_add_f32 v70, v70, v78
    v_add_f32 v71, v71, v79
    v_mul_f32 v78, 0xbf3504f3, v76
    v_mul_f32 v79, 0xbf3504f3, v76
    v_fmac_f32 v78, 0x3f3504f3, v77
    v_fmac_f32 v79, 0xbf3504f3, v77
    v_sub_f32 v76, v16, v20
    v_sub_f32 v77, v17, v21
    v_add_f32 v16, v16, v20
    v_add_f32 v17, v17, v21
    v_sub_f32 v20, v19, v23
    v_sub_f32 v21, v22, v18
    v_add_f32 v18, v18, v22
    v_add_f32 v19, v19, v23
    v_sub_f32 v22, v72, v24
    v_sub_f32 v23, v73, v25
    v_add_f32 v72, v72, v24
    v_add_f32 v73, v73, v25
    v_sub_f32 v24, v27, v31
    v_sub_f32 v25, v30, v26
    v_add_f32 v26, v26, v30
    v_add_f32 v27, v27, v31
    v_sub_f32 v30, v64, v36
    v_sub_f32 v31, v65, v37
    v_add_f32 v64, v64, v36
    v_add_f32 v65, v65, v37
    v_sub_f32 v36, v35, v39
    v_sub_f32 v37, v38, v34
    v_add_f32 v34, v34, v38
    v_add_f32 v35, v35, v39
    v_sub_f32 v38, v28, v32
    v_sub_f32 v39, v29, v33
    v_add_f32 v28, v28, v32
    v_add_f32 v29, v29, v33
    v_sub_f32 v32, v43, v47
    v_sub_f32 v33, v46, v42
    v_add_f32 v42, v42, v46
    v_add_f32 v43, v43, v47
    v_sub_f32 v46, v80, v52
    v_sub_f32 v47, v81, v53
    v_add_f32 v80, v80, v52
    v_add_f32 v81, v81, v53
    v_sub_f32 v52, v51, v55
    v_sub_f32 v53, v54, v50
    v_add_f32 v50, v50, v54
    v_add_f32 v51, v51, v55
    v_sub_f32 v54, v44, v56
    v_sub_f32 v55, v45, v57
    v_add_f32 v44, v44, v56
    v_add_f32 v45, v45, v57
    v_sub_f32 v56, v59, v63
    v_sub_f32 v57, v62, v58
    v_add_f32 v58, v58, v62
    v_add_f32 v59, v59, v63
    v_sub_f32 v62, v40, v68
    v_sub_f32 v63, v41, v69
    v_add_f32 v40, v40, v68
    v_add_f32 v41, v41, v69
    v_sub_f32 v68, v67, v71
    v_sub_f32 v69, v70, v66
    v_add_f32 v66, v66, v70
    v_add_f32 v67, v67, v71
    v_sub_f32 v70, v60, v48
    v_sub_f32 v71, v61, v49
    v_add_f32 v60, v60, v48
    v_add_f32 v61, v61, v49
    v_sub_f32 v48, v75, v79
    v_sub_f32 v49, v78, v74
    v_add_f32 v74, v74, v78
    v_add_f32 v75, v75, v79
    v_sub_f32 v78, v16, v18
    v_sub_f32 v79, v17, v19
    v_add_f32 v16, v16, v18
    v_add_f32 v17, v17, v19
    v_sub_f32 v18, v76, v20
    v_sub_f32 v19, v77, v21
    v_add_f32 v76, v76, v20
    v_add_f32 v77, v77, v21
    v_sub_f32 v20, v72, v26
    v_sub_f32 v21, v73, v27
    v_add_f32 v72, v72, v26
    v_add_f32 v73, v73, v27
    v_sub_f32 v26, v22, v24
    v_sub_f32 v27, v23, v25
    v_add_f32 v22, v22, v24
    v_add_f32 v23, v23, v25
    v_sub_f32 v24, v64, v34
    v_sub_f32 v25, v65, v35
    v_add_f32 v64, v64, v34
    v_add_f32 v65, v65, v35
    v_sub_f32 v34, v30, v36
    v_sub_f32 v35, v31, v37
    v_add_f32 v30, v30, v36
    v_add_f32 v31, v31, v37
    v_sub_f32 v36, v28, v42
    v_sub_f32 v37, v29, v43
    v_add_f32 v28, v28, v42
    v_add_f32 v29, v29, v43
    v_sub_f32 v42, v38, v32
    v_sub_f32 v43, v39, v33
    v_add_f32 v38, v38, v32
    v_add_f32 v39, v39, v33
    v_sub_f32 v32, v80, v50
    v_sub_f32 v33, v81, v51
    v_add_f32 v80, v80, v50
    v_add_f32 v81, v81, v51
    v_sub_f32 v50, v46, v52
    v_sub_f32 v51, v47, v53
    v_add_f32 v46, v46, v52
    v_add_f32 v47, v47, v53
    v_sub_f32 v52, v44, v58
    v_sub_f32 v53, v45, v59
    v_add_f32 v44, v44, v58
    v_add_f32 v45, v45, v59
    v_sub_f32 v58, v54, v56
    v_sub_f32 v59, v55, v57
    v_add_f32 v54, v54, v56
    v_add_f32 v55, v55, v57
    v_sub_f32 v56, v40, v66
    v_sub_f32 v57, v41, v67
    v_add_f32 v40, v40, v66
    v_add_f32 v41, v41, v67
    v_sub_f32 v66, v62, v68
    v_sub_f32 v67, v63, v69
    v_add_f32 v62, v62, v68
    v_add_f32 v63, v63, v69
    v_sub_f32 v68, v60, v74
    v_sub_f32 v69, v61, v75
    v_add_f32 v60, v60, v74
    v_add_f32 v61, v61, v75
    v_sub_f32 v74, v70, v48
    v_sub_f32 v75, v71, v49
    v_add_f32 v70, v70, v48
    v_add_f32 v71, v71, v49
    v_mul_f32 v48, 0xba000000, v2
    v_cos_f32 v49, v48
    v_sin_f32 v82, v48
    s_nop 0
    v_mul_f32 v83, v80, v49
    v_fma_f32 v83, -v81, v82, v83
    v_mul_f32 v81, v81, v49
    v_fmac_f32 v81, v80, v82
    v_mul_f32 v48, 0xba800000, v2
    v_cos_f32 v49, v48
    v_sin_f32 v82, v48
    s_nop 0
    v_mul_f32 v80, v64, v49
    v_fma_f32 v80, -v65, v82, v80
    v_mul_f32 v65, v65, v49
    v_fmac_f32 v65, v64, v82
    v_mul_f32 v48, 0xbac00000, v2
    v_cos_f32 v49, v48
    v_sin_f32 v82, v48
    s_nop 0
    v_mul_f32 v64, v40, v49
    v_fma_f32 v64, -v41, v82, v64
    v_mul_f32 v41, v41, v49
    v_fmac_f32 v41, v40, v82
    v_mul_f32 v48, 0xbb000000, v2
    v_cos_f32 v49, v48
    v_sin_f32 v82, v48
    s_nop 0
    v_mul_f32 v40, v72, v49
    v_fma_f32 v40, -v73, v82, v40
    v_mul_f32 v73, v73, v49
    v_fmac_f32 v73, v72, v82
    v_mul_f32 v48, 0xbb200000, v2
    v_cos_f32 v49, v48
    v_sin_f32 v82, v48
    s_nop 0
    v_mul_f32 v72, v44, v49
    v_fma_f32 v72, -v45, v82, v72
    v_mul_f32 v45, v45, v49
    v_fmac_f32 v45, v44, v82
    v_mul_f32 v48, 0xbb400000, v2
    v_cos_f32 v49, v48
    v_sin_f32 v82, v48
    s_nop 0
    v_mul_f32 v44, v28, v49
    v_fma_f32 v44, -v29, v82, v44
    v_mul_f32 v29, v29, v49
    v_fmac_f32 v29, v28, v82
    v_mul_f32 v48, 0xbb600000, v2
    v_cos_f32 v49, v48
    v_sin_f32 v82, v48
    s_nop 0
    v_mul_f32 v28, v60, v49
    v_fma_f32 v28, -v61, v82, v28
    v_mul_f32 v61, v61, v49
    v_fmac_f32 v61, v60, v82
    v_mul_f32 v48, 0xbb800000, v2
    v_cos_f32 v49, v48
    v_sin_f32 v82, v48
    s_nop 0
    v_mul_f32 v60, v76, v49
    v_fma_f32 v60, -v77, v82, v60
    v_mul_f32 v77, v77, v49
    v_fmac_f32 v77, v76, v82
    v_mul_f32 v48, 0xbb900000, v2
    v_cos_f32 v49, v48
    v_sin_f32 v82, v48
    s_nop 0
    v_mul_f32 v76, v46, v49
    v_fma_f32 v76, -v47, v82, v76
    v_mul_f32 v47, v47, v49
    v_fmac_f32 v47, v46, v82
    v_mul_f32 v48, 0xbba00000, v2
    v_cos_f32 v49, v48
    v_sin_f32 v82, v48
    s_nop 0
    v_mul_f32 v46, v30, v49
    v_fma_f32 v46, -v31, v82, v46
    v_mul_f32 v31, v31, v49
    v_fmac_f32 v31, v30, v82
    v_mul_f32 v48, 0xbbb00000, v2
    v_cos_f32 v49, v48
    v_sin_f32 v82, v48
    s_nop 0
    v_mul_f32 v30, v62, v49
    v_fma_f32 v30, -v63, v82, v30
    v_mul_f32 v63, v63, v49
    v_fmac_f32 v63, v62, v82
    v_mul_f32 v48, 0xbbc00000, v2
    v_cos_f32 v49, v48
    v_sin_f32 v82, v48
    s_nop 0
    v_mul_f32 v62, v22, v49
    v_fma_f32 v62, -v23, v82, v62
    v_mul_f32 v23, v23, v49
    v_fmac_f32 v23, v22, v82
    v_mul_f32 v48, 0xbbd00000, v2
    v_cos_f32 v49, v48
    v_sin_f32 v82, v48
    s_nop 0
    v_mul_f32 v22, v54, v49
    v_fma_f32 v22, -v55, v82, v22
    v_mul_f32 v55, v55, v49
    v_fmac_f32 v55, v54, v82
    v_mul_f32 v48, 0xbbe00000, v2
    v_cos_f32 v49, v48
    v_sin_f32 v82, v48
    s_nop 0
    v_mul_f32 v54, v38, v49
    v_fma_f32 v54, -v39, v82, v54
    v_mul_f32 v39, v39, v49
    v_fmac_f32 v39, v38, v82
    v_mul_f32 v48, 0xbbf00000, v2
    v_cos_f32 v49, v48
    v_sin_f32 v82, v48
    s_nop 0
    v_mul_f32 v38, v70, v49
    v_fma_f32 v38, -v71, v82, v38
    v_mul_f32 v71, v71, v49
    v_fmac_f32 v71, v70, v82
    v_mul_f32 v48, 0xbc000000, v2
    v_cos_f32 v49, v48
    v_sin_f32 v82, v48
    s_nop 0
    v_mul_f32 v70, v78, v49
    v_fma_f32 v70, -v79, v82, v70
    v_mul_f32 v79, v79, v49
    v_fmac_f32 v79, v78, v82
    v_mul_f32 v48, 0xbc080000, v2
    v_cos_f32 v49, v48
    v_sin_f32 v82, v48
    s_nop 0
    v_mul_f32 v78, v32, v49
    v_fma_f32 v78, -v33, v82, v78
    v_mul_f32 v33, v33, v49
    v_fmac_f32 v33, v32, v82
    v_mul_f32 v48, 0xbc100000, v2
    v_cos_f32 v49, v48
    v_sin_f32 v82, v48
    s_nop 0
    v_mul_f32 v32, v24, v49
    v_fma_f32 v32, -v25, v82, v32
    v_mul_f32 v25, v25, v49
    v_fmac_f32 v25, v24, v82
    v_mul_f32 v48, 0xbc180000, v2
    v_cos_f32 v49, v48
    v_sin_f32 v82, v48
    s_nop 0
    v_mul_f32 v24, v56, v49
    v_fma_f32 v24, -v57, v82, v24
    v_mul_f32 v57, v57, v49
    v_fmac_f32 v57, v56, v82
    v_mul_f32 v48, 0xbc200000, v2
    v_cos_f32 v49, v48
    v_sin_f32 v82, v48
    s_nop 0
    v_mul_f32 v56, v20, v49
    v_fma_f32 v56, -v21, v82, v56
    v_mul_f32 v21, v21, v49
    v_fmac_f32 v21, v20, v82
    v_mul_f32 v48, 0xbc280000, v2
    v_cos_f32 v49, v48
    v_sin_f32 v82, v48
    s_nop 0
    v_mul_f32 v20, v52, v49
    v_fma_f32 v20, -v53, v82, v20
    v_mul_f32 v53, v53, v49
    v_fmac_f32 v53, v52, v82
    v_mul_f32 v48, 0xbc300000, v2
    v_cos_f32 v49, v48
    v_sin_f32 v82, v48
    s_nop 0
    v_mul_f32 v52, v36, v49
    v_fma_f32 v52, -v37, v82, v52
    v_mul_f32 v37, v37, v49
    v_fmac_f32 v37, v36, v82
    v_mul_f32 v48, 0xbc380000, v2
    v_cos_f32 v49, v48
    v_sin_f32 v82, v48
    s_nop 0
    v_mul_f32 v36, v68, v49
    v_fma_f32 v36, -v69, v82, v36
    v_mul_f32 v69, v69, v49
    v_fmac_f32 v69, v68, v82
    v_mul_f32 v48, 0xbc400000, v2
    v_cos_f32 v49, v48
    v_sin_f32 v82, v48
    s_nop 0
    v_mul_f32 v68, v18, v49
    v_fma_f32 v68, -v19, v82, v68
    v_mul_f32 v19, v19, v49
    v_fmac_f32 v19, v18, v82
    v_mul_f32 v48, 0xbc480000, v2
    v_cos_f32 v49, v48
    v_sin_f32 v82, v48
    s_nop 0
    v_mul_f32 v18, v50, v49
    v_fma_f32 v18, -v51, v82, v18
    v_mul_f32 v51, v51, v49
    v_fmac_f32 v51, v50, v82
    v_mul_f32 v48, 0xbc500000, v2
    v_cos_f32 v49, v48
    v_sin_f32 v82, v48
    s_nop 0
    v_mul_f32 v50, v34, v49
    v_fma_f32 v50, -v35, v82, v50
    v_mul_f32 v35, v35, v49
    v_fmac_f32 v35, v34, v82
    v_mul_f32 v48, 0xbc580000, v2
    v_cos_f32 v49, v48
    v_sin_f32 v82, v48
    s_nop 0
    v_mul_f32 v34, v66, v49
    v_fma_f32 v34, -v67, v82, v34
    v_mul_f32 v67, v67, v49
    v_fmac_f32 v67, v66, v82
    v_mul_f32 v48, 0xbc600000, v2
    v_cos_f32 v49, v48
    v_sin_f32 v82, v48
    s_nop 0
    v_mul_f32 v66, v26, v49
    v_fma_f32 v66, -v27, v82, v66
    v_mul_f32 v27, v27, v49
    v_fmac_f32 v27, v26, v82
    v_mul_f32 v48, 0xbc680000, v2
    v_cos_f32 v49, v48
    v_sin_f32 v82, v48
    s_nop 0
    v_mul_f32 v26, v58, v49
    v_fma_f32 v26, -v59, v82, v26
    v_mul_f32 v59, v59, v49
    v_fmac_f32 v59, v58, v82
    v_mul_f32 v48, 0xbc700000, v2
    v_cos_f32 v49, v48
    v_sin_f32 v82, v48
    s_nop 0
    v_mul_f32 v58, v42, v49
    v_fma_f32 v58, -v43, v82, v58
    v_mul_f32 v43, v43, v49
    v_fmac_f32 v43, v42, v82
    v_mul_f32 v48, 0xbc780000, v2
    v_cos_f32 v49, v48
    v_sin_f32 v82, v48
    s_nop 0
    v_mul_f32 v42, v74, v49
    v_fma_f32 v42, -v75, v82, v42
    v_mul_f32 v75, v75, v49
    v_fmac_f32 v75, v74, v82
    ds_write_b32 v3, v16 offset:0
    ds_write_b32 v3, v17 offset:4
    ds_write_b32 v3, v83 offset:528
    ds_write_b32 v3, v81 offset:532
    ds_write_b32 v3, v80 offset:1056
    ds_write_b32 v3, v65 offset:1060
    ds_write_b32 v3, v64 offset:1584
    ds_write_b32 v3, v41 offset:1588
    ds_write_b32 v3, v40 offset:2112
    ds_write_b32 v3, v73 offset:2116
    ds_write_b32 v3, v72 offset:2640
    ds_write_b32 v3, v45 offset:2644
    ds_write_b32 v3, v44 offset:3168
    ds_write_b32 v3, v29 offset:3172
    ds_write_b32 v3, v28 offset:3696
    ds_write_b32 v3, v61 offset:3700
    ds_write_b32 v3, v60 offset:4224
    ds_write_b32 v3, v77 offset:4228
    ds_write_b32 v3, v76 offset:4752
    ds_write_b32 v3, v47 offset:4756
    ds_write_b32 v3, v46 offset:5280
    ds_write_b32 v3, v31 offset:5284
    ds_write_b32 v3, v30 offset:5808
    ds_write_b32 v3, v63 offset:5812
    ds_write_b32 v3, v62 offset:6336
    ds_write_b32 v3, v23 offset:6340
    ds_write_b32 v3, v22 offset:6864
    ds_write_b32 v3, v55 offset:6868
    ds_write_b32 v3, v54 offset:7392
    ds_write_b32 v3, v39 offset:7396
    ds_write_b32 v3, v38 offset:7920
    ds_write_b32 v3, v71 offset:7924
    ds_write_b32 v3, v70 offset:8448
    ds_write_b32 v3, v79 offset:8452
    ds_write_b32 v3, v78 offset:8976
    ds_write_b32 v3, v33 offset:8980
    ds_write_b32 v3, v32 offset:9504
    ds_write_b32 v3, v25 offset:9508
    ds_write_b32 v3, v24 offset:10032
    ds_write_b32 v3, v57 offset:10036
    ds_write_b32 v3, v56 offset:10560
    ds_write_b32 v3, v21 offset:10564
    ds_write_b32 v3, v20 offset:11088
    ds_write_b32 v3, v53 offset:11092
    ds_write_b32 v3, v52 offset:11616
    ds_write_b32 v3, v37 offset:11620
    ds_write_b32 v3, v36 offset:12144
    ds_write_b32 v3, v69 offset:12148
    ds_write_b32 v3, v68 offset:12672
    ds_write_b32 v3, v19 offset:12676
    ds_write_b32 v3, v18 offset:13200
    ds_write_b32 v3, v51 offset:13204
    ds_write_b32 v3, v50 offset:13728
    ds_write_b32 v3, v35 offset:13732
    ds_write_b32 v3, v34 offset:14256
    ds_write_b32 v3, v67 offset:14260
    ds_write_b32 v3, v66 offset:14784
    ds_write_b32 v3, v27 offset:14788
    ds_write_b32 v3, v26 offset:15312
    ds_write_b32 v3, v59 offset:15316
    ds_write_b32 v3, v58 offset:15840
    ds_write_b32 v3, v43 offset:15844
    ds_write_b32 v3, v42 offset:16368
    ds_write_b32 v3, v75 offset:16372
    s_waitcnt lgkmcnt(0)
    ds_read_b32 v16, v4 offset:0
    ds_read_b32 v17, v4 offset:4
    ds_read_b32 v83, v4 offset:16
    ds_read_b32 v81, v4 offset:20
    ds_read_b32 v80, v4 offset:32
    ds_read_b32 v65, v4 offset:36
    ds_read_b32 v64, v4 offset:48
    ds_read_b32 v41, v4 offset:52
    ds_read_b32 v40, v4 offset:64
    ds_read_b32 v73, v4 offset:68
    ds_read_b32 v72, v4 offset:80
    ds_read_b32 v45, v4 offset:84
    ds_read_b32 v44, v4 offset:96
    ds_read_b32 v29, v4 offset:100
    s_waitcnt lgkmcnt(0)
    ds_read_b32 v28, v4 offset:112
    ds_read_b32 v61, v4 offset:116
    ds_read_b32 v60, v4 offset:128
    ds_read_b32 v77, v4 offset:132
    ds_read_b32 v76, v4 offset:144
    ds_read_b32 v47, v4 offset:148
    ds_read_b32 v46, v4 offset:160
    ds_read_b32 v31, v4 offset:164
    ds_read_b32 v30, v4 offset:176
    ds_read_b32 v63, v4 offset:180
    ds_read_b32 v62, v4 offset:192
    ds_read_b32 v23, v4 offset:196
    ds_read_b32 v22, v4 offset:208
    ds_read_b32 v55, v4 offset:212
    s_waitcnt lgkmcnt(0)
    ds_read_b32 v54, v4 offset:224
    ds_read_b32 v39, v4 offset:228
    ds_read_b32 v38, v4 offset:240
    ds_read_b32 v71, v4 offset:244
    ds_read_b32 v70, v4 offset:256
    ds_read_b32 v79, v4 offset:260
    ds_read_b32 v78, v4 offset:272
    ds_read_b32 v33, v4 offset:276
    ds_read_b32 v32, v4 offset:288
    ds_read_b32 v25, v4 offset:292
    ds_read_b32 v24, v4 offset:304
    ds_read_b32 v57, v4 offset:308
    ds_read_b32 v56, v4 offset:320
    ds_read_b32 v21, v4 offset:324
    s_waitcnt lgkmcnt(0)
    ds_read_b32 v20, v4 offset:336
    ds_read_b32 v53, v4 offset:340
    ds_read_b32 v52, v4 offset:352
    ds_read_b32 v37, v4 offset:356
    ds_read_b32 v36, v4 offset:368
    ds_read_b32 v69, v4 offset:372
    ds_read_b32 v68, v4 offset:384
    ds_read_b32 v19, v4 offset:388
    ds_read_b32 v18, v4 offset:400
    ds_read_b32 v51, v4 offset:404
    ds_read_b32 v50, v4 offset:416
    ds_read_b32 v35, v4 offset:420
    ds_read_b32 v34, v4 offset:432
    ds_read_b32 v67, v4 offset:436
    s_waitcnt lgkmcnt(0)
    ds_read_b32 v66, v4 offset:448
    ds_read_b32 v27, v4 offset:452
    ds_read_b32 v26, v4 offset:464
    ds_read_b32 v59, v4 offset:468
    ds_read_b32 v58, v4 offset:480
    ds_read_b32 v43, v4 offset:484
    ds_read_b32 v42, v4 offset:496
    ds_read_b32 v75, v4 offset:500
    s_waitcnt lgkmcnt(0)
    buffer_load_dword v88, v11, s[8:11], s19 offen offset:0
    buffer_load_dword v89, v11, s[8:11], s19 offen offset:128
    buffer_load_dword v90, v11, s[8:11], s19 offen offset:256
    buffer_load_dword v91, v11, s[8:11], s19 offen offset:384
    buffer_load_dword v92, v11, s[8:11], s19 offen offset:512
    buffer_load_dword v93, v11, s[8:11], s19 offen offset:640
    buffer_load_dword v94, v11, s[8:11], s19 offen offset:768
    buffer_load_dword v95, v11, s[8:11], s19 offen offset:896
    buffer_load_dword v96, v11, s[8:11], s19 offen offset:1024
    buffer_load_dword v97, v11, s[8:11], s19 offen offset:1152
    buffer_load_dword v98, v11, s[8:11], s19 offen offset:1280
    buffer_load_dword v99, v11, s[8:11], s19 offen offset:1408
    buffer_load_dword v100, v11, s[8:11], s19 offen offset:1536
    buffer_load_dword v101, v11, s[8:11], s19 offen offset:1664
    buffer_load_dword v102, v11, s[8:11], s19 offen offset:1792
    buffer_load_dword v103, v11, s[8:11], s19 offen offset:1920
    buffer_load_dword v104, v11, s[8:11], s19 offen offset:2048
    buffer_load_dword v105, v11, s[8:11], s19 offen offset:2176
    buffer_load_dword v106, v11, s[8:11], s19 offen offset:2304
    buffer_load_dword v107, v11, s[8:11], s19 offen offset:2432
    buffer_load_dword v108, v11, s[8:11], s19 offen offset:2560
    buffer_load_dword v109, v11, s[8:11], s19 offen offset:2688
    buffer_load_dword v110, v11, s[8:11], s19 offen offset:2816
    buffer_load_dword v111, v11, s[8:11], s19 offen offset:2944
    buffer_load_dword v112, v11, s[8:11], s19 offen offset:3072
    buffer_load_dword v113, v11, s[8:11], s19 offen offset:3200
    buffer_load_dword v114, v11, s[8:11], s19 offen offset:3328
    buffer_load_dword v115, v11, s[8:11], s19 offen offset:3456
    buffer_load_dword v116, v11, s[8:11], s19 offen offset:3584
    buffer_load_dword v117, v11, s[8:11], s19 offen offset:3712
    buffer_load_dword v118, v11, s[8:11], s19 offen offset:3840
    buffer_load_dword v119, v11, s[8:11], s19 offen offset:3968
    v_sub_f32 v48, v16, v70
    v_sub_f32 v49, v17, v79
    v_add_f32 v16, v16, v70
    v_add_f32 v17, v17, v79
    v_sub_f32 v70, v83, v78
    v_sub_f32 v79, v81, v33
    v_add_f32 v83, v83, v78
    v_add_f32 v81, v81, v33
    v_mul_f32 v78, 0x3f7b14be, v70
    v_mul_f32 v33, 0xbe47c5c2, v70
    v_fmac_f32 v78, 0x3e47c5c2, v79
    v_fmac_f32 v33, 0x3f7b14be, v79
    v_sub_f32 v70, v80, v32
    v_sub_f32 v79, v65, v25
    v_add_f32 v80, v80, v32
    v_add_f32 v65, v65, v25
    v_mul_f32 v32, 0x3f6c835e, v70
    v_mul_f32 v25, 0xbec3ef15, v70
    v_fmac_f32 v32, 0x3ec3ef15, v79
    v_fmac_f32 v25, 0x3f6c835e, v79
    v_sub_f32 v70, v64, v24
    v_sub_f32 v79, v41, v57
    v_add_f32 v64, v64, v24
    v_add_f32 v41, v41, v57
    v_mul_f32 v24, 0x3f54db31, v70
    v_mul_f32 v57, 0xbf0e39da, v70
    v_fmac_f32 v24, 0x3f0e39da, v79
    v_fmac_f32 v57, 0x3f54db31, v79
    v_sub_f32 v70, v40, v56
    v_sub_f32 v79, v73, v21
    v_add_f32 v40, v40, v56
    v_add_f32 v73, v73, v21
    v_mul_f32 v56, 0x3f3504f3, v70
    v_mul_f32 v21, 0xbf3504f3, v70
    v_fmac_f32 v56, 0x3f3504f3, v79
    v_fmac_f32 v21, 0x3f3504f3, v79
    v_sub_f32 v70, v72, v20
    v_sub_f32 v79, v45, v53
    v_add_f32 v72, v72, v20
    v_add_f32 v45, v45, v53
    v_mul_f32 v20, 0x3f0e39da, v70
    v_mul_f32 v53, 0xbf54db31, v70
    v_fmac_f32 v20, 0x3f54db31, v79
    v_fmac_f32 v53, 0x3f0e39da, v79
    v_sub_f32 v70, v44, v52
    v_sub_f32 v79, v29, v37
    v_add_f32 v44, v44, v52
    v_add_f32 v29, v29, v37
    v_mul_f32 v52, 0x3ec3ef15, v70
    v_mul_f32 v37, 0xbf6c835e, v70
    v_fmac_f32 v52, 0x3f6c835e, v79
    v_fmac_f32 v37, 0x3ec3ef15, v79
    v_sub_f32 v70, v28, v36
    v_sub_f32 v79, v61, v69
    v_add_f32 v28, v28, v36
    v_add_f32 v61, v61, v69
    v_mul_f32 v36, 0x3e47c5c2, v70
    v_mul_f32 v69, 0xbf7b14be, v70
    v_fmac_f32 v36, 0x3f7b14be, v79
    v_fmac_f32 v69, 0x3e47c5c2, v79
    v_sub_f32 v70, v77, v19
    v_sub_f32 v79, v68, v60
    v_add_f32 v60, v60, v68
    v_add_f32 v77, v77, v19
    v_sub_f32 v68, v76, v18
    v_sub_f32 v19, v47, v51
    v_add_f32 v76, v76, v18
    v_add_f32 v47, v47, v51
    v_mul_f32 v18, 0xbe47c5c2, v68
    v_mul_f32 v51, 0xbf7b14be, v68
    v_fmac_f32 v18, 0x3f7b14be, v19
    v_fmac_f32 v51, 0xbe47c5c2, v19
    v_sub_f32 v68, v46, v50
    v_sub_f32 v19, v31, v35
    v_add_f32 v46, v46, v50
    v_add_f32 v31, v31, v35
    v_mul_f32 v50, 0xbec3ef15, v68
    v_mul_f32 v35, 0xbf6c835e, v68
    v_fmac_f32 v50, 0x3f6c835e, v19
    v_fmac_f32 v35, 0xbec3ef15, v19
    v_sub_f32 v68, v30, v34
    v_sub_f32 v19, v63, v67
    v_add_f32 v30, v30, v34
    v_add_f32 v63, v63, v67
    v_mul_f32 v34, 0xbf0e39da, v68
    v_mul_f32 v67, 0xbf54db31, v68
    v_fmac_f32 v34, 0x3f54db31, v19
    v_fmac_f32 v67, 0xbf0e39da, v19
    v_sub_f32 v68, v62, v66
    v_sub_f32 v19, v23, v27
    v_add_f32 v62, v62, v66
    v_add_f32 v23, v23, v27
    v_mul_f32 v66, 0xbf3504f3, v68
    v_mul_f32 v27, 0xbf3504f3, v68
    v_fmac_f32 v66, 0x3f3504f3, v19
    v_fmac_f32 v27, 0xbf3504f3, v19
    v_sub_f32 v68, v22, v26
    v_sub_f32 v19, v55, v59
    v_add_f32 v22, v22, v26
    v_add_f32 v55, v55, v59
    v_mul_f32 v26, 0xbf54db31, v68
    v_mul_f32 v59, 0xbf0e39da, v68
    v_fmac_f32 v26, 0x3f0e39da, v19
    v_fmac_f32 v59, 0xbf54db31, v19
    v_sub_f32 v68, v54, v58
    v_sub_f32 v19, v39, v43
    v_add_f32 v54, v54, v58
    v_add_f32 v39, v39, v43
    v_mul_f32 v58, 0xbf6c835e, v68
    v_mul_f32 v43, 0xbec3ef15, v68
    v_fmac_f32 v58, 0x3ec3ef15, v19
    v_fmac_f32 v43, 0xbf6c835e, v19
    v_sub_f32 v68, v38, v42
    v_sub_f32 v19, v71, v75
    v_add_f32 v38, v38, v42
    v_add_f32 v71, v71, v75
    v_mul_f32 v42, 0xbf7b14be, v68
    v_mul_f32 v75, 0xbe47c5c2, v68
    v_fmac_f32 v42, 0x3e47c5c2, v19
    v_fmac_f32 v75, 0xbf7b14be, v19
    v_sub_f32 v68, v16, v60
    v_sub_f32 v19, v17, v77
    v_add_f32 v16, v16, v60
    v_add_f32 v17, v17, v77
    v_sub_f32 v60, v83, v76
    v_sub_f32 v77, v81, v47
    v_add_f32 v83, v83, v76
    v_add_f32 v81, v81, v47
    v_mul_f32 v76, 0x3f6c835e, v60
    v_mul_f32 v47, 0xbec3ef15, v60
    v_fmac_f32 v76, 0x3ec3ef15, v77
    v_fmac_f32 v47, 0x3f6c835e, v77
    v_sub_f32 v60, v80, v46
    v_sub_f32 v77, v65, v31
    v_add_f32 v80, v80, v46
    v_add_f32 v65, v65, v31
    v_mul_f32 v46, 0x3f3504f3, v60
    v_mul_f32 v31, 0xbf3504f3, v60
    v_fmac_f32 v46, 0x3f3504f3, v77
    v_fmac_f32 v31, 0x3f3504f3, v77
    v_sub_f32 v60, v64, v30
    v_sub_f32 v77, v41, v63
    v_add_f32 v64, v64, v30
    v_add_f32 v41, v41, v63
    v_mul_f32 v30, 0x3ec3ef15, v60
    v_mul_f32 v63, 0xbf6c835e, v60
    v_fmac_f32 v30, 0x3f6c835e, v77
    v_fmac_f32 v63, 0x3ec3ef15, v77
    v_sub_f32 v60, v73, v23
    v_sub_f32 v77, v62, v40
    v_add_f32 v40, v40, v62
    v_add_f32 v73, v73, v23
    v_sub_f32 v62, v72, v22
    v_sub_f32 v23, v45, v55
    v_add_f32 v72, v72, v22
    v_add_f32 v45, v45, v55
    v_mul_f32 v22, 0xbec3ef15, v62
    v_mul_f32 v55, 0xbf6c835e, v62
    v_fmac_f32 v22, 0x3f6c835e, v23
    v_fmac_f32 v55, 0xbec3ef15, v23
    v_sub_f32 v62, v44, v54
    v_sub_f32 v23, v29, v39
    v_add_f32 v44, v44, v54
    v_add_f32 v29, v29, v39
    v_mul_f32 v54, 0xbf3504f3, v62
    v_mul_f32 v39, 0xbf3504f3, v62
    v_fmac_f32 v54, 0x3f3504f3, v23
    v_fmac_f32 v39, 0xbf3504f3, v23
    v_sub_f32 v62, v28, v38
    v_sub_f32 v23, v61, v71
    v_add_f32 v28, v28, v38
    v_add_f32 v61, v61, v71
    v_mul_f32 v38, 0xbf6c835e, v62
    v_mul_f32 v71, 0xbec3ef15, v62
    v_fmac_f32 v38, 0x3ec3ef15, v23
    v_fmac_f32 v71, 0xbf6c835e, v23
    v_sub_f32 v62, v48, v70
    v_sub_f32 v23, v49, v79
    v_add_f32 v48, v48, v70
    v_add_f32 v49, v49, v79
    v_sub_f32 v70, v78, v18
    v_sub_f32 v79, v33, v51
    v_add_f32 v78, v78, v18
    v_add_f32 v33, v33, v51
    v_mul_f32 v18, 0x3f6c835e, v70
    v_mul_f32 v51, 0xbec3ef15, v70
    v_fmac_f32 v18, 0x3ec3ef15, v79
    v_fmac_f32 v51, 0x3f6c835e, v79
    v_sub_f32 v70, v32, v50
    v_sub_f32 v79, v25, v35
    v_add_f32 v32, v32, v50
    v_add_f32 v25, v25, v35
    v_mul_f32 v50, 0x3f3504f3, v70
    v_mul_f32 v35, 0xbf3504f3, v70
    v_fmac_f32 v50, 0x3f3504f3, v79
    v_fmac_f32 v35, 0x3f3504f3, v79
    v_sub_f32 v70, v24, v34
    v_sub_f32 v79, v57, v67
    v_add_f32 v24, v24, v34
    v_add_f32 v57, v57, v67
    v_mul_f32 v34, 0x3ec3ef15, v70
    v_mul_f32 v67, 0xbf6c835e, v70
    v_fmac_f32 v34, 0x3f6c835e, v79
    v_fmac_f32 v67, 0x3ec3ef15, v79
    v_sub_f32 v70, v21, v27
    v_sub_f32 v79, v66, v56
    v_add_f32 v56, v56, v66
    v_add_f32 v21, v21, v27
    v_sub_f32 v66, v20, v26
    v_sub_f32 v27, v53, v59
    v_add_f32 v20, v20, v26
    v_add_f32 v53, v53, v59
    v_mul_f32 v26, 0xbec3ef15, v66
    v_mul_f32 v59, 0xbf6c835e, v66
    v_fmac_f32 v26, 0x3f6c835e, v27
    v_fmac_f32 v59, 0xbec3ef15, v27
    v_sub_f32 v66, v52, v58
    v_sub_f32 v27, v37, v43
    v_add_f32 v52, v52, v58
    v_add_f32 v37, v37, v43
    v_mul_f32 v58, 0xbf3504f3, v66
    v_mul_f32 v43, 0xbf3504f3, v66
    v_fmac_f32 v58, 0x3f3504f3, v27
    v_fmac_f32 v43, 0xbf3504f3, v27
    v_sub_f32 v66, v36, v42
    v_sub_f32 v27, v69, v75
    v_add_f32 v36, v36, v42
    v_add_f32 v69, v69, v75
    v_mul_f32 v42, 0xbf6c835e, v66
    v_mul_f32 v75, 0xbec3ef15, v66
    v_fmac_f32 v42, 0x3ec3ef15, v27
    v_fmac_f32 v75, 0xbf6c835e, v27
    v_sub_f32 v66, v16, v40
    v_sub_f32 v27, v17, v73
    v_add_f32 v16, v16, v40
    v_add_f32 v17, v17, v73
    v_sub_f32 v40, v83, v72
    v_sub_f32 v73, v81, v45
    v_add_f32 v83, v83, v72
    v_add_f32 v81, v81, v45
    v_mul_f32 v72, 0x3f3504f3, v40
    v_mul_f32 v45, 0xbf3504f3, v40
    v_fmac_f32 v72, 0x3f3504f3, v73
    v_fmac_f32 v45, 0x3f3504f3, v73
    v_sub_f32 v40, v65, v29
    v_sub_f32 v73, v44, v80
    v_add_f32 v80, v80, v44
    v_add_f32 v65, v65, v29
    v_sub_f32 v44, v64, v28
    v_sub_f32 v29, v41, v61
    v_add_f32 v64, v64, v28
    v_add_f32 v41, v41, v61
    v_mul_f32 v28, 0xbf3504f3, v44
    v_mul_f32 v61, 0xbf3504f3, v44
    v_fmac_f32 v28, 0x3f3504f3, v29
    v_fmac_f32 v61, 0xbf3504f3, v29
    v_sub_f32 v44, v68, v60
    v_sub_f32 v29, v19, v77
    v_add_f32 v68, v68, v60
    v_add_f32 v19, v19, v77
    v_sub_f32 v60, v76, v22
    v_sub_f32 v77, v47, v55
    v_add_f32 v76, v76, v22
    v_add_f32 v47, v47, v55
    v_mul_f32 v22, 0x3f3504f3, v60
    v_mul_f32 v55, 0xbf3504f3, v60
    v_fmac_f32 v22, 0x3f3504f3, v77
    v_fmac_f32 v55, 0x3f3504f3, v77
    v_sub_f32 v60, v31, v39
    v_sub_f32 v77, v54, v46
    v_add_f32 v46, v46, v54
    v_add_f32 v31, v31, v39
    v_sub_f32 v54, v30, v38
    v_sub_f32 v39, v63, v71
    v_add_f32 v30, v30, v38
    v_add_f32 v63, v63, v71
    v_mul_f32 v38, 0xbf3504f3, v54
    v_mul_f32 v71, 0xbf3504f3, v54
    v_fmac_f32 v38, 0x3f3504f3, v39
    v_fmac_f32 v71, 0xbf3504f3, v39
    v_sub_f32 v54, v48, v56
    v_sub_f32 v39, v49, v21
    v_add_f32 v48, v48, v56
    v_add_f32 v49, v49, v21
    v_sub_f32 v56, v78, v20
    v_sub_f32 v21, v33, v53
    v_add_f32 v78, v78, v20
    v_add_f32 v33, v33, v53
    v_mul_f32 v20, 0x3f3504f3, v56
    v_mul_f32 v53, 0xbf3504f3, v56
    v_fmac_f32 v20, 0x3f3504f3, v21
    v_fmac_f32 v53, 0x3f3504f3, v21
    v_sub_f32 v56, v25, v37
    v_sub_f32 v21, v52, v32
    v_add_f32 v32, v32, v52
    v_add_f32 v25, v25, v37
    v_sub_f32 v52, v24, v36
    v_sub_f32 v37, v57, v69
    v_add_f32 v24, v24, v36
    v_add_f32 v57, v57, v69
    v_mul_f32 v36, 0xbf3504f3, v52
    v_mul_f32 v69, 0xbf3504f3, v52
    v_fmac_f32 v36, 0x3f3504f3, v37
    v_fmac_f32 v69, 0xbf3504f3, v37
    v_sub_f32 v52, v62, v70
    v_sub_f32 v37, v23, v79
    v_add_f32 v62, v62, v70
    v_add_f32 v23, v23, v79
    v_sub_f32 v70, v18, v26
    v_sub_f32 v79, v51, v59
    v_add_f32 v18, v18, v26
    v_add_f32 v51, v51, v59
    v_mul_f32 v26, 0x3f3504f3, v70
    v_mul_f32 v59, 0xbf3504f3, v70
    v_fmac_f32 v26, 0x3f3504f3, v79
    v_fmac_f32 v59, 0x3f3504f3, v79
    v_sub_f32 v70, v35, v43
    v_sub_f32 v79, v58, v50
    v_add_f32 v50, v50, v58
    v_add_f32 v35, v35, v43
    v_sub_f32 v58, v34, v42
    v_sub_f32 v43, v67, v75
    v_add_f32 v34, v34, v42
    v_add_f32 v67, v67, v75
    v_mul_f32 v42, 0xbf3504f3, v58
    v_mul_f32 v75, 0xbf3504f3, v58
    v_fmac_f32 v42, 0x3f3504f3, v43
    v_fmac_f32 v75, 0xbf3504f3, v43
    v_sub_f32 v58, v16, v80
    v_sub_f32 v43, v17, v65
    v_add_f32 v16, v16, v80
    v_add_f32 v17, v17, v65
    v_sub_f32 v80, v81, v41
    v_sub_f32 v65, v64, v83
    v_add_f32 v83, v83, v64
    v_add_f32 v81, v81, v41
    v_sub_f32 v64, v66, v40
    v_sub_f32 v41, v27, v73
    v_add_f32 v66, v66, v40
    v_add_f32 v27, v27, v73
    v_sub_f32 v40, v45, v61
    v_sub_f32 v73, v28, v72
    v_add_f32 v72, v72, v28
    v_add_f32 v45, v45, v61
    v_sub_f32 v28, v68, v46
    v_sub_f32 v61, v19, v31
    v_add_f32 v68, v68, v46
    v_add_f32 v19, v19, v31
    v_sub_f32 v46, v47, v63
    v_sub_f32 v31, v30, v76
    v_add_f32 v76, v76, v30
    v_add_f32 v47, v47, v63
    v_sub_f32 v30, v44, v60
    v_sub_f32 v63, v29, v77
    v_add_f32 v44, v44, v60
    v_add_f32 v29, v29, v77
    v_sub_f32 v60, v55, v71
    v_sub_f32 v77, v38, v22
    v_add_f32 v22, v22, v38
    v_add_f32 v55, v55, v71
    v_sub_f32 v38, v48, v32
    v_sub_f32 v71, v49, v25
    v_add_f32 v48, v48, v32
    v_add_f32 v49, v49, v25
    v_sub_f32 v32, v33, v57
    v_sub_f32 v25, v24, v78
    v_add_f32 v78, v78, v24
    v_add_f32 v33, v33, v57
    v_sub_f32 v24, v54, v56
    v_sub_f32 v57, v39, v21
    v_add_f32 v54, v54, v56
    v_add_f32 v39, v39, v21
    v_sub_f32 v56, v53, v69
    v_sub_f32 v21, v36, v20
    v_add_f32 v20, v20, v36
    v_add_f32 v53, v53, v69
    v_sub_f32 v36, v62, v50
    v_sub_f32 v69, v23, v35
    v_add_f32 v62, v62, v50
    v_add_f32 v23, v23, v35
    v_sub_f32 v50, v51, v67
    v_sub_f32 v35, v34, v18
    v_add_f32 v18, v18, v34
    v_add_f32 v51, v51, v67
    v_sub_f32 v34, v52, v70
    v_sub_f32 v67, v37, v79
    v_add_f32 v52, v52, v70
    v_add_f32 v37, v37, v79
    v_sub_f32 v70, v59, v75
    v_sub_f32 v79, v42, v26
    v_add_f32 v26, v26, v42
    v_add_f32 v59, v59, v75
    v_sub_f32 v42, v16, v83
    v_sub_f32 v75, v17, v81
    v_add_f32 v16, v16, v83
    v_add_f32 v17, v17, v81
    v_sub_f32 v83, v58, v80
    v_sub_f32 v81, v43, v65
    v_add_f32 v58, v58, v80
    v_add_f32 v43, v43, v65
    v_sub_f32 v80, v66, v72
    v_sub_f32 v65, v27, v45
    v_add_f32 v66, v66, v72
    v_add_f32 v27, v27, v45
    v_sub_f32 v72, v64, v40
    v_sub_f32 v45, v41, v73
    v_add_f32 v64, v64, v40
    v_add_f32 v41, v41, v73
    v_sub_f32 v40, v68, v76
    v_sub_f32 v73, v19, v47
    v_add_f32 v68, v68, v76
    v_add_f32 v19, v19, v47
    v_sub_f32 v76, v28, v46
    v_sub_f32 v47, v61, v31
    v_add_f32 v28, v28, v46
    v_add_f32 v61, v61, v31
    v_sub_f32 v46, v44, v22
    v_sub_f32 v31, v29, v55
    v_add_f32 v44, v44, v22
    v_add_f32 v29, v29, v55
    v_sub_f32 v22, v30, v60
    v_sub_f32 v55, v63, v77
    v_add_f32 v30, v30, v60
    v_add_f32 v63, v63, v77
    v_sub_f32 v60, v48, v78
    v_sub_f32 v77, v49, v33
    v_add_f32 v48, v48, v78
    v_add_f32 v49, v49, v33
    v_sub_f32 v78, v38, v32
    v_sub_f32 v33, v71, v25
    v_add_f32 v38, v38, v32
    v_add_f32 v71, v71, v25
    v_sub_f32 v32, v54, v20
    v_sub_f32 v25, v39, v53
    v_add_f32 v54, v54, v20
    v_add_f32 v39, v39, v53
    v_sub_f32 v20, v24, v56
    v_sub_f32 v53, v57, v21
    v_add_f32 v24, v24, v56
    v_add_f32 v57, v57, v21
    v_sub_f32 v56, v62, v18
    v_sub_f32 v21, v23, v51
    v_add_f32 v62, v62, v18
    v_add_f32 v23, v23, v51
    v_sub_f32 v18, v36, v50
    v_sub_f32 v51, v69, v35
    v_add_f32 v36, v36, v50
    v_add_f32 v69, v69, v35
    v_sub_f32 v50, v52, v26
    v_sub_f32 v35, v37, v59
    v_add_f32 v52, v52, v26
    v_add_f32 v37, v37, v59
    v_sub_f32 v26, v34, v70
    v_sub_f32 v59, v67, v79
    v_add_f32 v34, v34, v70
    v_add_f32 v67, v67, v79
    v_mul_f32 v70, 0xbc800000, v10
    v_cos_f32 v79, v70
    v_sin_f32 v82, v70
    s_nop 0
    v_mul_f32 v74, v48, v79
    v_fma_f32 v74, -v49, v82, v74
    v_mul_f32 v49, v49, v79
    v_fmac_f32 v49, v48, v82
    v_mul_f32 v70, 0xbd000000, v10
    v_cos_f32 v79, v70
    v_sin_f32 v82, v70
    s_nop 0
    v_mul_f32 v48, v68, v79
    v_fma_f32 v48, -v19, v82, v48
    v_mul_f32 v19, v19, v79
    v_fmac_f32 v19, v68, v82
    v_mul_f32 v70, 0xbd400000, v10
    v_cos_f32 v79, v70
    v_sin_f32 v82, v70
    s_nop 0
    v_mul_f32 v68, v62, v79
    v_fma_f32 v68, -v23, v82, v68
    v_mul_f32 v23, v23, v79
    v_fmac_f32 v23, v62, v82
    v_mul_f32 v70, 0xbd800000, v10
    v_cos_f32 v79, v70
    v_sin_f32 v82, v70
    s_nop 0
    v_mul_f32 v62, v66, v79
    v_fma_f32 v62, -v27, v82, v62
    v_mul_f32 v27, v27, v79
    v_fmac_f32 v27, v66, v82
    v_mul_f32 v70, 0xbda00000, v10
    v_cos_f32 v79, v70
    v_sin_f32 v82, v70
    s_nop 0
    v_mul_f32 v66, v54, v79
    v_fma_f32 v66, -v39, v82, v66
    v_mul_f32 v39, v39, v79
    v_fmac_f32 v39, v54, v82
    v_mul_f32 v70, 0xbdc00000, v10
    v_cos_f32 v79, v70
    v_sin_f32 v82, v70
    s_nop 0
    v_mul_f32 v54, v44, v79
    v_fma_f32 v54, -v29, v82, v54
    v_mul_f32 v29, v29, v79
    v_fmac_f32 v29, v44, v82
    v_mul_f32 v70, 0xbde00000, v10
    v_cos_f32 v79, v70
    v_sin_f32 v82, v70
    s_nop 0
    v_mul_f32 v44, v52, v79
    v_fma_f32 v44, -v37, v82, v44
    v_mul_f32 v37, v37, v79
    v_fmac_f32 v37, v52, v82
    v_mul_f32 v70, 0xbe000000, v10
    v_cos_f32 v79, v70
    v_sin_f32 v82, v70
    s_nop 0
    v_mul_f32 v52, v58, v79
    v_fma_f32 v52, -v43, v82, v52
    v_mul_f32 v43, v43, v79
    v_fmac_f32 v43, v58, v82
    v_mul_f32 v70, 0xbe100000, v10
    v_cos_f32 v79, v70
    v_sin_f32 v82, v70
    s_nop 0
    v_mul_f32 v58, v38, v79
    v_fma_f32 v58, -v71, v82, v58
    v_mul_f32 v71, v71, v79
    v_fmac_f32 v71, v38, v82
    v_mul_f32 v70, 0xbe200000, v10
    v_cos_f32 v79, v70
    v_sin_f32 v82, v70
    s_nop 0
    v_mul_f32 v38, v28, v79
    v_fma_f32 v38, -v61, v82, v38
    v_mul_f32 v61, v61, v79
    v_fmac_f32 v61, v28, v82
    v_mul_f32 v70, 0xbe300000, v10
    v_cos_f32 v79, v70
    v_sin_f32 v82, v70
    s_nop 0
    v_mul_f32 v28, v36, v79
    v_fma_f32 v28, -v69, v82, v28
    v_mul_f32 v69, v69, v79
    v_fmac_f32 v69, v36, v82
    v_mul_f32 v70, 0xbe400000, v10
    v_cos_f32 v79, v70
    v_sin_f32 v82, v70
    s_nop 0
    v_mul_f32 v36, v64, v79
    v_fma_f32 v36, -v41, v82, v36
    v_mul_f32 v41, v41, v79
    v_fmac_f32 v41, v64, v82
    v_mul_f32 v70, 0xbe500000, v10
    v_cos_f32 v79, v70
    v_sin_f32 v82, v70
    s_nop 0
    v_mul_f32 v64, v24, v79
    v_fma_f32 v64, -v57, v82, v64
    v_mul_f32 v57, v57, v79
    v_fmac_f32 v57, v24, v82
    v_mul_f32 v70, 0xbe600000, v10
    v_cos_f32 v79, v70
    v_sin_f32 v82, v70
    s_nop 0
    v_mul_f32 v24, v30, v79
    v_fma_f32 v24, -v63, v82, v24
    v_mul_f32 v63, v63, v79
    v_fmac_f32 v63, v30, v82
    v_mul_f32 v70, 0xbe700000, v10
    v_cos_f32 v79, v70
    v_sin_f32 v82, v70
    s_nop 0
    v_mul_f32 v30, v34, v79
    v_fma_f32 v30, -v67, v82, v30
    v_mul_f32 v67, v67, v79
    v_fmac_f32 v67, v34, v82
    v_mul_f32 v70, 0xbe800000, v10
    v_cos_f32 v79, v70
    v_sin_f32 v82, v70
    s_nop 0
    v_mul_f32 v34, v42, v79
    v_fma_f32 v34, -v75, v82, v34
    v_mul_f32 v75, v75, v79
    v_fmac_f32 v75, v42, v82
    v_mul_f32 v70, 0xbe880000, v10
    v_cos_f32 v79, v70
    v_sin_f32 v82, v70
    s_nop 0
    v_mul_f32 v42, v60, v79
    v_fma_f32 v42, -v77, v82, v42
    v_mul_f32 v77, v77, v79
    v_fmac_f32 v77, v60, v82
    v_mul_f32 v70, 0xbe900000, v10
    v_cos_f32 v79, v70
    v_sin_f32 v82, v70
    s_nop 0
    v_mul_f32 v60, v40, v79
    v_fma_f32 v60, -v73, v82, v60
    v_mul_f32 v73, v73, v79
    v_fmac_f32 v73, v40, v82
    v_mul_f32 v70, 0xbe980000, v10
    v_cos_f32 v79, v70
    v_sin_f32 v82, v70
    s_nop 0
    v_mul_f32 v40, v56, v79
    v_fma_f32 v40, -v21, v82, v40
    v_mul_f32 v21, v21, v79
    v_fmac_f32 v21, v56, v82
    v_mul_f32 v70, 0xbea00000, v10
    v_cos_f32 v79, v70
    v_sin_f32 v82, v70
    s_nop 0
    v_mul_f32 v56, v80, v79
    v_fma_f32 v56, -v65, v82, v56
    v_mul_f32 v65, v65, v79
    v_fmac_f32 v65, v80, v82
    v_mul_f32 v70, 0xbea80000, v10
    v_cos_f32 v79, v70
    v_sin_f32 v82, v70
    s_nop 0
    v_mul_f32 v80, v32, v79
    v_fma_f32 v80, -v25, v82, v80
    v_mul_f32 v25, v25, v79
    v_fmac_f32 v25, v32, v82
    v_mul_f32 v70, 0xbeb00000, v10
    v_cos_f32 v79, v70
    v_sin_f32 v82, v70
    s_nop 0
    v_mul_f32 v32, v46, v79
    v_fma_f32 v32, -v31, v82, v32
    v_mul_f32 v31, v31, v79
    v_fmac_f32 v31, v46, v82
    v_mul_f32 v70, 0xbeb80000, v10
    v_cos_f32 v79, v70
    v_sin_f32 v82, v70
    s_nop 0
    v_mul_f32 v46, v50, v79
    v_fma_f32 v46, -v35, v82, v46
    v_mul_f32 v35, v35, v79
    v_fmac_f32 v35, v50, v82
    v_mul_f32 v70, 0xbec00000, v10
    v_cos_f32 v79, v70
    v_sin_f32 v82, v70
    s_nop 0
    v_mul_f32 v50, v83, v79
    v_fma_f32 v50, -v81, v82, v50
    v_mul_f32 v81, v81, v79
    v_fmac_f32 v81, v83, v82
    v_mul_f32 v70, 0xbec80000, v10
    v_cos_f32 v79, v70
    v_sin_f32 v82, v70
    s_nop 0
    v_mul_f32 v83, v78, v79
    v_fma_f32 v83, -v33, v82, v83
    v_mul_f32 v33, v33, v79
    v_fmac_f32 v33, v78, v82
    v_mul_f32 v70, 0xbed00000, v10
    v_cos_f32 v79, v70
    v_sin_f32 v82, v70
    s_nop 0
    v_mul_f32 v78, v76, v79
    v_fma_f32 v78, -v47, v82, v78
    v_mul_f32 v47, v47, v79
    v_fmac_f32 v47, v76, v82
    v_mul_f32 v70, 0xbed80000, v10
    v_cos_f32 v79, v70
    v_sin_f32 v82, v70
    s_nop 0
    v_mul_f32 v76, v18, v79
    v_fma_f32 v76, -v51, v82, v76
    v_mul_f32 v51, v51, v79
    v_fmac_f32 v51, v18, v82
    v_mul_f32 v70, 0xbee00000, v10
    v_cos_f32 v79, v70
    v_sin_f32 v82, v70
    s_nop 0
    v_mul_f32 v18, v72, v79
    v_fma_f32 v18, -v45, v82, v18
    v_mul_f32 v45, v45, v79
    v_fmac_f32 v45, v72, v82
    v_mul_f32 v70, 0xbee80000, v10
    v_cos_f32 v79, v70
    v_sin_f32 v82, v70
    s_nop 0
    v_mul_f32 v72, v20, v79
    v_fma_f32 v72, -v53, v82, v72
    v_mul_f32 v53, v53, v79
    v_fmac_f32 v53, v20, v82
    v_mul_f32 v70, 0xbef00000, v10
    v_cos_f32 v79, v70
    v_sin_f32 v82, v70
    s_nop 0
    v_mul_f32 v20, v22, v79
    v_fma_f32 v20, -v55, v82, v20
    v_mul_f32 v55, v55, v79
    v_fmac_f32 v55, v22, v82
    v_mul_f32 v70, 0xbef80000, v10
    v_cos_f32 v79, v70
    v_sin_f32 v82, v70
    s_nop 0
    v_mul_f32 v22, v26, v79
    v_fma_f32 v22, -v59, v82, v22
    v_mul_f32 v59, v59, v79
    v_fmac_f32 v59, v26, v82
    s_nop 1
    v_mov_b32_dpp v70, v16 quad_perm:[1,0,3,2] row_mask:0xf bank_mask:0xf
    v_fma_f32 v16, v16, v9, v70
    v_mov_b32_dpp v70, v17 quad_perm:[1,0,3,2] row_mask:0xf bank_mask:0xf
    v_fma_f32 v17, v17, v9, v70
    v_mov_b32_dpp v70, v74 quad_perm:[1,0,3,2] row_mask:0xf bank_mask:0xf
    v_fma_f32 v74, v74, v9, v70
    v_mov_b32_dpp v70, v49 quad_perm:[1,0,3,2] row_mask:0xf bank_mask:0xf
    v_fma_f32 v49, v49, v9, v70
    v_mov_b32_dpp v70, v48 quad_perm:[1,0,3,2] row_mask:0xf bank_mask:0xf
    v_fma_f32 v48, v48, v9, v70
    v_mov_b32_dpp v70, v19 quad_perm:[1,0,3,2] row_mask:0xf bank_mask:0xf
    v_fma_f32 v19, v19, v9, v70
    v_mov_b32_dpp v70, v68 quad_perm:[1,0,3,2] row_mask:0xf bank_mask:0xf
    v_fma_f32 v68, v68, v9, v70
    v_mov_b32_dpp v70, v23 quad_perm:[1,0,3,2] row_mask:0xf bank_mask:0xf
    v_fma_f32 v23, v23, v9, v70
    v_mov_b32_dpp v70, v62 quad_perm:[1,0,3,2] row_mask:0xf bank_mask:0xf
    v_fma_f32 v62, v62, v9, v70
    v_mov_b32_dpp v70, v27 quad_perm:[1,0,3,2] row_mask:0xf bank_mask:0xf
    v_fma_f32 v27, v27, v9, v70
    v_mov_b32_dpp v70, v66 quad_perm:[1,0,3,2] row_mask:0xf bank_mask:0xf
    v_fma_f32 v66, v66, v9, v70
    v_mov_b32_dpp v70, v39 quad_perm:[1,0,3,2] row_mask:0xf bank_mask:0xf
    v_fma_f32 v39, v39, v9, v70
    v_mov_b32_dpp v70, v54 quad_perm:[1,0,3,2] row_mask:0xf bank_mask:0xf
    v_fma_f32 v54, v54, v9, v70
    v_mov_b32_dpp v70, v29 quad_perm:[1,0,3,2] row_mask:0xf bank_mask:0xf
    v_fma_f32 v29, v29, v9, v70
    v_mov_b32_dpp v70, v44 quad_perm:[1,0,3,2] row_mask:0xf bank_mask:0xf
    v_fma_f32 v44, v44, v9, v70
    v_mov_b32_dpp v70, v37 quad_perm:[1,0,3,2] row_mask:0xf bank_mask:0xf
    v_fma_f32 v37, v37, v9, v70
    v_mov_b32_dpp v70, v52 quad_perm:[1,0,3,2] row_mask:0xf bank_mask:0xf
    v_fma_f32 v52, v52, v9, v70
    v_mov_b32_dpp v70, v43 quad_perm:[1,0,3,2] row_mask:0xf bank_mask:0xf
    v_fma_f32 v43, v43, v9, v70
    v_mov_b32_dpp v70, v58 quad_perm:[1,0,3,2] row_mask:0xf bank_mask:0xf
    v_fma_f32 v58, v58, v9, v70
    v_mov_b32_dpp v70, v71 quad_perm:[1,0,3,2] row_mask:0xf bank_mask:0xf
    v_fma_f32 v71, v71, v9, v70
    v_mov_b32_dpp v70, v38 quad_perm:[1,0,3,2] row_mask:0xf bank_mask:0xf
    v_fma_f32 v38, v38, v9, v70
    v_mov_b32_dpp v70, v61 quad_perm:[1,0,3,2] row_mask:0xf bank_mask:0xf
    v_fma_f32 v61, v61, v9, v70
    v_mov_b32_dpp v70, v28 quad_perm:[1,0,3,2] row_mask:0xf bank_mask:0xf
    v_fma_f32 v28, v28, v9, v70
    v_mov_b32_dpp v70, v69 quad_perm:[1,0,3,2] row_mask:0xf bank_mask:0xf
    v_fma_f32 v69, v69, v9, v70
    v_mov_b32_dpp v70, v36 quad_perm:[1,0,3,2] row_mask:0xf bank_mask:0xf
    v_fma_f32 v36, v36, v9, v70
    v_mov_b32_dpp v70, v41 quad_perm:[1,0,3,2] row_mask:0xf bank_mask:0xf
    v_fma_f32 v41, v41, v9, v70
    v_mov_b32_dpp v70, v64 quad_perm:[1,0,3,2] row_mask:0xf bank_mask:0xf
    v_fma_f32 v64, v64, v9, v70
    v_mov_b32_dpp v70, v57 quad_perm:[1,0,3,2] row_mask:0xf bank_mask:0xf
    v_fma_f32 v57, v57, v9, v70
    v_mov_b32_dpp v70, v24 quad_perm:[1,0,3,2] row_mask:0xf bank_mask:0xf
    v_fma_f32 v24, v24, v9, v70
    v_mov_b32_dpp v70, v63 quad_perm:[1,0,3,2] row_mask:0xf bank_mask:0xf
    v_fma_f32 v63, v63, v9, v70
    v_mov_b32_dpp v70, v30 quad_perm:[1,0,3,2] row_mask:0xf bank_mask:0xf
    v_fma_f32 v30, v30, v9, v70
    v_mov_b32_dpp v70, v67 quad_perm:[1,0,3,2] row_mask:0xf bank_mask:0xf
    v_fma_f32 v67, v67, v9, v70
    v_mov_b32_dpp v70, v34 quad_perm:[1,0,3,2] row_mask:0xf bank_mask:0xf
    v_fma_f32 v34, v34, v9, v70
    v_mov_b32_dpp v70, v75 quad_perm:[1,0,3,2] row_mask:0xf bank_mask:0xf
    v_fma_f32 v75, v75, v9, v70
    v_mov_b32_dpp v70, v42 quad_perm:[1,0,3,2] row_mask:0xf bank_mask:0xf
    v_fma_f32 v42, v42, v9, v70
    v_mov_b32_dpp v70, v77 quad_perm:[1,0,3,2] row_mask:0xf bank_mask:0xf
    v_fma_f32 v77, v77, v9, v70
    v_mov_b32_dpp v70, v60 quad_perm:[1,0,3,2] row_mask:0xf bank_mask:0xf
    v_fma_f32 v60, v60, v9, v70
    v_mov_b32_dpp v70, v73 quad_perm:[1,0,3,2] row_mask:0xf bank_mask:0xf
    v_fma_f32 v73, v73, v9, v70
    v_mov_b32_dpp v70, v40 quad_perm:[1,0,3,2] row_mask:0xf bank_mask:0xf
    v_fma_f32 v40, v40, v9, v70
    v_mov_b32_dpp v70, v21 quad_perm:[1,0,3,2] row_mask:0xf bank_mask:0xf
    v_fma_f32 v21, v21, v9, v70
    v_mov_b32_dpp v70, v56 quad_perm:[1,0,3,2] row_mask:0xf bank_mask:0xf
    v_fma_f32 v56, v56, v9, v70
    v_mov_b32_dpp v70, v65 quad_perm:[1,0,3,2] row_mask:0xf bank_mask:0xf
    v_fma_f32 v65, v65, v9, v70
    v_mov_b32_dpp v70, v80 quad_perm:[1,0,3,2] row_mask:0xf bank_mask:0xf
    v_fma_f32 v80, v80, v9, v70
    v_mov_b32_dpp v70, v25 quad_perm:[1,0,3,2] row_mask:0xf bank_mask:0xf
    v_fma_f32 v25, v25, v9, v70
    v_mov_b32_dpp v70, v32 quad_perm:[1,0,3,2] row_mask:0xf bank_mask:0xf
    v_fma_f32 v32, v32, v9, v70
    v_mov_b32_dpp v70, v31 quad_perm:[1,0,3,2] row_mask:0xf bank_mask:0xf
    v_fma_f32 v31, v31, v9, v70
    v_mov_b32_dpp v70, v46 quad_perm:[1,0,3,2] row_mask:0xf bank_mask:0xf
    v_fma_f32 v46, v46, v9, v70
    v_mov_b32_dpp v70, v35 quad_perm:[1,0,3,2] row_mask:0xf bank_mask:0xf
    v_fma_f32 v35, v35, v9, v70
    v_mov_b32_dpp v70, v50 quad_perm:[1,0,3,2] row_mask:0xf bank_mask:0xf
    v_fma_f32 v50, v50, v9, v70
    v_mov_b32_dpp v70, v81 quad_perm:[1,0,3,2] row_mask:0xf bank_mask:0xf
    v_fma_f32 v81, v81, v9, v70
    v_mov_b32_dpp v70, v83 quad_perm:[1,0,3,2] row_mask:0xf bank_mask:0xf
    v_fma_f32 v83, v83, v9, v70
    v_mov_b32_dpp v70, v33 quad_perm:[1,0,3,2] row_mask:0xf bank_mask:0xf
    v_fma_f32 v33, v33, v9, v70
    v_mov_b32_dpp v70, v78 quad_perm:[1,0,3,2] row_mask:0xf bank_mask:0xf
    v_fma_f32 v78, v78, v9, v70
    v_mov_b32_dpp v70, v47 quad_perm:[1,0,3,2] row_mask:0xf bank_mask:0xf
    v_fma_f32 v47, v47, v9, v70
    v_mov_b32_dpp v70, v76 quad_perm:[1,0,3,2] row_mask:0xf bank_mask:0xf
    v_fma_f32 v76, v76, v9, v70
    v_mov_b32_dpp v70, v51 quad_perm:[1,0,3,2] row_mask:0xf bank_mask:0xf
    v_fma_f32 v51, v51, v9, v70
    v_mov_b32_dpp v70, v18 quad_perm:[1,0,3,2] row_mask:0xf bank_mask:0xf
    v_fma_f32 v18, v18, v9, v70
    v_mov_b32_dpp v70, v45 quad_perm:[1,0,3,2] row_mask:0xf bank_mask:0xf
    v_fma_f32 v45, v45, v9, v70
    v_mov_b32_dpp v70, v72 quad_perm:[1,0,3,2] row_mask:0xf bank_mask:0xf
    v_fma_f32 v72, v72, v9, v70
    v_mov_b32_dpp v70, v53 quad_perm:[1,0,3,2] row_mask:0xf bank_mask:0xf
    v_fma_f32 v53, v53, v9, v70
    v_mov_b32_dpp v70, v20 quad_perm:[1,0,3,2] row_mask:0xf bank_mask:0xf
    v_fma_f32 v20, v20, v9, v70
    v_mov_b32_dpp v70, v55 quad_perm:[1,0,3,2] row_mask:0xf bank_mask:0xf
    v_fma_f32 v55, v55, v9, v70
    v_mov_b32_dpp v70, v22 quad_perm:[1,0,3,2] row_mask:0xf bank_mask:0xf
    v_fma_f32 v22, v22, v9, v70
    v_mov_b32_dpp v70, v59 quad_perm:[1,0,3,2] row_mask:0xf bank_mask:0xf
    v_fma_f32 v59, v59, v9, v70
    s_waitcnt vmcnt(0)
    s_mov_b32 s20, 0x34800000
    v_lshlrev_b32 v70, 16, v88
    v_and_b32 v79, 0xffff0000, v88
    v_mul_f32 v70, s20, v70
    v_mul_f32 v79, s20, v79
    v_mul_f32 v82, v16, v70
    v_fma_f32 v82, -v17, v79, v82
    v_mul_f32 v17, v17, v70
    v_fmac_f32 v17, v16, v79
    v_lshlrev_b32 v70, 16, v89
    v_and_b32 v79, 0xffff0000, v89
    v_mul_f32 v70, s20, v70
    v_mul_f32 v79, s20, v79
    v_mul_f32 v16, v74, v70
    v_fma_f32 v16, -v49, v79, v16
    v_mul_f32 v49, v49, v70
    v_fmac_f32 v49, v74, v79
    v_lshlrev_b32 v70, 16, v90
    v_and_b32 v79, 0xffff0000, v90
    v_mul_f32 v70, s20, v70
    v_mul_f32 v79, s20, v79
    v_mul_f32 v74, v48, v70
    v_fma_f32 v74, -v19, v79, v74
    v_mul_f32 v19, v19, v70
    v_fmac_f32 v19, v48, v79
    v_lshlrev_b32 v70, 16, v91
    v_and_b32 v79, 0xffff0000, v91
    v_mul_f32 v70, s20, v70
    v_mul_f32 v79, s20, v79
    v_mul_f32 v48, v68, v70
    v_fma_f32 v48, -v23, v79, v48
    v_mul_f32 v23, v23, v70
    v_fmac_f32 v23, v68, v79
    v_lshlrev_b32 v70, 16, v92
    v_and_b32 v79, 0xffff0000, v92
    v_mul_f32 v70, s20, v70
    v_mul_f32 v79, s20, v79
    v_mul_f32 v68, v62, v70
    v_fma_f32 v68, -v27, v79, v68
    v_mul_f32 v27, v27, v70
    v_fmac_f32 v27, v62, v79
    v_lshlrev_b32 v70, 16, v93
    v_and_b32 v79, 0xffff0000, v93
    v_mul_f32 v70, s20, v70
    v_mul_f32 v79, s20, v79
    v_mul_f32 v62, v66, v70
    v_fma_f32 v62, -v39, v79, v62
    v_mul_f32 v39, v39, v70
    v_fmac_f32 v39, v66, v79
    v_lshlrev_b32 v70, 16, v94
    v_and_b32 v79, 0xffff0000, v94
    v_mul_f32 v70, s20, v70
    v_mul_f32 v79, s20, v79
    v_mul_f32 v66, v54, v70
    v_fma_f32 v66, -v29, v79, v66
    v_mul_f32 v29, v29, v70
    v_fmac_f32 v29, v54, v79
    v_lshlrev_b32 v70, 16, v95
    v_and_b32 v79, 0xffff0000, v95
    v_mul_f32 v70, s20, v70
    v_mul_f32 v79, s20, v79
    v_mul_f32 v54, v44, v70
    v_fma_f32 v54, -v37, v79, v54
    v_mul_f32 v37, v37, v70
    v_fmac_f32 v37, v44, v79
    v_lshlrev_b32 v70, 16, v96
    v_and_b32 v79, 0xffff0000, v96
    v_mul_f32 v70, s20, v70
    v_mul_f32 v79, s20, v79
    v_mul_f32 v44, v52, v70
    v_fma_f32 v44, -v43, v79, v44
    v_mul_f32 v43, v43, v70
    v_fmac_f32 v43, v52, v79
    v_lshlrev_b32 v70, 16, v97
    v_and_b32 v79, 0xffff0000, v97
    v_mul_f32 v70, s20, v70
    v_mul_f32 v79, s20, v79
    v_mul_f32 v52, v58, v70
    v_fma_f32 v52, -v71, v79, v52
    v_mul_f32 v71, v71, v70
    v_fmac_f32 v71, v58, v79
    v_lshlrev_b32 v70, 16, v98
    v_and_b32 v79, 0xffff0000, v98
    v_mul_f32 v70, s20, v70
    v_mul_f32 v79, s20, v79
    v_mul_f32 v58, v38, v70
    v_fma_f32 v58, -v61, v79, v58
    v_mul_f32 v61, v61, v70
    v_fmac_f32 v61, v38, v79
    v_lshlrev_b32 v70, 16, v99
    v_and_b32 v79, 0xffff0000, v99
    v_mul_f32 v70, s20, v70
    v_mul_f32 v79, s20, v79
    v_mul_f32 v38, v28, v70
    v_fma_f32 v38, -v69, v79, v38
    v_mul_f32 v69, v69, v70
    v_fmac_f32 v69, v28, v79
    v_lshlrev_b32 v70, 16, v100
    v_and_b32 v79, 0xffff0000, v100
    v_mul_f32 v70, s20, v70
    v_mul_f32 v79, s20, v79
    v_mul_f32 v28, v36, v70
    v_fma_f32 v28, -v41, v79, v28
    v_mul_f32 v41, v41, v70
    v_fmac_f32 v41, v36, v79
    v_lshlrev_b32 v70, 16, v101
    v_and_b32 v79, 0xffff0000, v101
    v_mul_f32 v70, s20, v70
    v_mul_f32 v79, s20, v79
    v_mul_f32 v36, v64, v70
    v_fma_f32 v36, -v57, v79, v36
    v_mul_f32 v57, v57, v70
    v_fmac_f32 v57, v64, v79
    v_lshlrev_b32 v70, 16, v102
    v_and_b32 v79, 0xffff0000, v102
    v_mul_f32 v70, s20, v70
    v_mul_f32 v79, s20, v79
    v_mul_f32 v64, v24, v70
    v_fma_f32 v64, -v63, v79, v64
    v_mul_f32 v63, v63, v70
    v_fmac_f32 v63, v24, v79
    v_lshlrev_b32 v70, 16, v103
    v_and_b32 v79, 0xffff0000, v103
    v_mul_f32 v70, s20, v70
    v_mul_f32 v79, s20, v79
    v_mul_f32 v24, v30, v70
    v_fma_f32 v24, -v67, v79, v24
    v_mul_f32 v67, v67, v70
    v_fmac_f32 v67, v30, v79
    v_lshlrev_b32 v70, 16, v104
    v_and_b32 v79, 0xffff0000, v104
    v_mul_f32 v70, s20, v70
    v_mul_f32 v79, s20, v79
    v_mul_f32 v30, v34, v70
    v_fma_f32 v30, -v75, v79, v30
    v_mul_f32 v75, v75, v70
    v_fmac_f32 v75, v34, v79
    v_lshlrev_b32 v70, 16, v105
    v_and_b32 v79, 0xffff0000, v105
    v_mul_f32 v70, s20, v70
    v_mul_f32 v79, s20, v79
    v_mul_f32 v34, v42, v70
    v_fma_f32 v34, -v77, v79, v34
    v_mul_f32 v77, v77, v70
    v_fmac_f32 v77, v42, v79
    v_lshlrev_b32 v70, 16, v106
    v_and_b32 v79, 0xffff0000, v106
    v_mul_f32 v70, s20, v70
    v_mul_f32 v79, s20, v79
    v_mul_f32 v42, v60, v70
    v_fma_f32 v42, -v73, v79, v42
    v_mul_f32 v73, v73, v70
    v_fmac_f32 v73, v60, v79
    v_lshlrev_b32 v70, 16, v107
    v_and_b32 v79, 0xffff0000, v107
    v_mul_f32 v70, s20, v70
    v_mul_f32 v79, s20, v79
    v_mul_f32 v60, v40, v70
    v_fma_f32 v60, -v21, v79, v60
    v_mul_f32 v21, v21, v70
    v_fmac_f32 v21, v40, v79
    v_lshlrev_b32 v70, 16, v108
    v_and_b32 v79, 0xffff0000, v108
    v_mul_f32 v70, s20, v70
    v_mul_f32 v79, s20, v79
    v_mul_f32 v40, v56, v70
    v_fma_f32 v40, -v65, v79, v40
    v_mul_f32 v65, v65, v70
    v_fmac_f32 v65, v56, v79
    v_lshlrev_b32 v70, 16, v109
    v_and_b32 v79, 0xffff0000, v109
    v_mul_f32 v70, s20, v70
    v_mul_f32 v79, s20, v79
    v_mul_f32 v56, v80, v70
    v_fma_f32 v56, -v25, v79, v56
    v_mul_f32 v25, v25, v70
    v_fmac_f32 v25, v80, v79
    v_lshlrev_b32 v70, 16, v110
    v_and_b32 v79, 0xffff0000, v110
    v_mul_f32 v70, s20, v70
    v_mul_f32 v79, s20, v79
    v_mul_f32 v80, v32, v70
    v_fma_f32 v80, -v31, v79, v80
    v_mul_f32 v31, v31, v70
    v_fmac_f32 v31, v32, v79
    v_lshlrev_b32 v70, 16, v111
    v_and_b32 v79, 0xffff0000, v111
    v_mul_f32 v70, s20, v70
    v_mul_f32 v79, s20, v79
    v_mul_f32 v32, v46, v70
    v_fma_f32 v32, -v35, v79, v32
    v_mul_f32 v35, v35, v70
    v_fmac_f32 v35, v46, v79
    v_lshlrev_b32 v70, 16, v112
    v_and_b32 v79, 0xffff0000, v112
    v_mul_f32 v70, s20, v70
    v_mul_f32 v79, s20, v79
    v_mul_f32 v46, v50, v70
    v_fma_f32 v46, -v81, v79, v46
    v_mul_f32 v81, v81, v70
    v_fmac_f32 v81, v50, v79
    v_lshlrev_b32 v70, 16, v113
    v_and_b32 v79, 0xffff0000, v113
    v_mul_f32 v70, s20, v70
    v_mul_f32 v79, s20, v79
    v_mul_f32 v50, v83, v70
    v_fma_f32 v50, -v33, v79, v50
    v_mul_f32 v33, v33, v70
    v_fmac_f32 v33, v83, v79
    v_lshlrev_b32 v70, 16, v114
    v_and_b32 v79, 0xffff0000, v114
    v_mul_f32 v70, s20, v70
    v_mul_f32 v79, s20, v79
    v_mul_f32 v83, v78, v70
    v_fma_f32 v83, -v47, v79, v83
    v_mul_f32 v47, v47, v70
    v_fmac_f32 v47, v78, v79
    v_lshlrev_b32 v70, 16, v115
    v_and_b32 v79, 0xffff0000, v115
    v_mul_f32 v70, s20, v70
    v_mul_f32 v79, s20, v79
    v_mul_f32 v78, v76, v70
    v_fma_f32 v78, -v51, v79, v78
    v_mul_f32 v51, v51, v70
    v_fmac_f32 v51, v76, v79
    v_lshlrev_b32 v70, 16, v116
    v_and_b32 v79, 0xffff0000, v116
    v_mul_f32 v70, s20, v70
    v_mul_f32 v79, s20, v79
    v_mul_f32 v76, v18, v70
    v_fma_f32 v76, -v45, v79, v76
    v_mul_f32 v45, v45, v70
    v_fmac_f32 v45, v18, v79
    v_lshlrev_b32 v70, 16, v117
    v_and_b32 v79, 0xffff0000, v117
    v_mul_f32 v70, s20, v70
    v_mul_f32 v79, s20, v79
    v_mul_f32 v18, v72, v70
    v_fma_f32 v18, -v53, v79, v18
    v_mul_f32 v53, v53, v70
    v_fmac_f32 v53, v72, v79
    v_lshlrev_b32 v70, 16, v118
    v_and_b32 v79, 0xffff0000, v118
    v_mul_f32 v70, s20, v70
    v_mul_f32 v79, s20, v79
    v_mul_f32 v72, v20, v70
    v_fma_f32 v72, -v55, v79, v72
    v_mul_f32 v55, v55, v70
    v_fmac_f32 v55, v20, v79
    v_lshlrev_b32 v70, 16, v119
    v_and_b32 v79, 0xffff0000, v119
    v_mul_f32 v70, s20, v70
    v_mul_f32 v79, s20, v79
    v_mul_f32 v20, v22, v70
    v_fma_f32 v20, -v59, v79, v20
    v_mul_f32 v59, v59, v70
    v_fmac_f32 v59, v22, v79
    s_nop 1
    v_mov_b32_dpp v70, v82 quad_perm:[1,0,3,2] row_mask:0xf bank_mask:0xf
    v_fma_f32 v82, v82, v9, v70
    v_mov_b32_dpp v70, v17 quad_perm:[1,0,3,2] row_mask:0xf bank_mask:0xf
    v_fma_f32 v17, v17, v9, v70
    v_mov_b32_dpp v70, v16 quad_perm:[1,0,3,2] row_mask:0xf bank_mask:0xf
    v_fma_f32 v16, v16, v9, v70
    v_mov_b32_dpp v70, v49 quad_perm:[1,0,3,2] row_mask:0xf bank_mask:0xf
    v_fma_f32 v49, v49, v9, v70
    v_mov_b32_dpp v70, v74 quad_perm:[1,0,3,2] row_mask:0xf bank_mask:0xf
    v_fma_f32 v74, v74, v9, v70
    v_mov_b32_dpp v70, v19 quad_perm:[1,0,3,2] row_mask:0xf bank_mask:0xf
    v_fma_f32 v19, v19, v9, v70
    v_mov_b32_dpp v70, v48 quad_perm:[1,0,3,2] row_mask:0xf bank_mask:0xf
    v_fma_f32 v48, v48, v9, v70
    v_mov_b32_dpp v70, v23 quad_perm:[1,0,3,2] row_mask:0xf bank_mask:0xf
    v_fma_f32 v23, v23, v9, v70
    v_mov_b32_dpp v70, v68 quad_perm:[1,0,3,2] row_mask:0xf bank_mask:0xf
    v_fma_f32 v68, v68, v9, v70
    v_mov_b32_dpp v70, v27 quad_perm:[1,0,3,2] row_mask:0xf bank_mask:0xf
    v_fma_f32 v27, v27, v9, v70
    v_mov_b32_dpp v70, v62 quad_perm:[1,0,3,2] row_mask:0xf bank_mask:0xf
    v_fma_f32 v62, v62, v9, v70
    v_mov_b32_dpp v70, v39 quad_perm:[1,0,3,2] row_mask:0xf bank_mask:0xf
    v_fma_f32 v39, v39, v9, v70
    v_mov_b32_dpp v70, v66 quad_perm:[1,0,3,2] row_mask:0xf bank_mask:0xf
    v_fma_f32 v66, v66, v9, v70
    v_mov_b32_dpp v70, v29 quad_perm:[1,0,3,2] row_mask:0xf bank_mask:0xf
    v_fma_f32 v29, v29, v9, v70
    v_mov_b32_dpp v70, v54 quad_perm:[1,0,3,2] row_mask:0xf bank_mask:0xf
    v_fma_f32 v54, v54, v9, v70
    v_mov_b32_dpp v70, v37 quad_perm:[1,0,3,2] row_mask:0xf bank_mask:0xf
    v_fma_f32 v37, v37, v9, v70
    v_mov_b32_dpp v70, v44 quad_perm:[1,0,3,2] row_mask:0xf bank_mask:0xf
    v_fma_f32 v44, v44, v9, v70
    v_mov_b32_dpp v70, v43 quad_perm:[1,0,3,2] row_mask:0xf bank_mask:0xf
    v_fma_f32 v43, v43, v9, v70
    v_mov_b32_dpp v70, v52 quad_perm:[1,0,3,2] row_mask:0xf bank_mask:0xf
    v_fma_f32 v52, v52, v9, v70
    v_mov_b32_dpp v70, v71 quad_perm:[1,0,3,2] row_mask:0xf bank_mask:0xf
    v_fma_f32 v71, v71, v9, v70
    v_mov_b32_dpp v70, v58 quad_perm:[1,0,3,2] row_mask:0xf bank_mask:0xf
    v_fma_f32 v58, v58, v9, v70
    v_mov_b32_dpp v70, v61 quad_perm:[1,0,3,2] row_mask:0xf bank_mask:0xf
    v_fma_f32 v61, v61, v9, v70
    v_mov_b32_dpp v70, v38 quad_perm:[1,0,3,2] row_mask:0xf bank_mask:0xf
    v_fma_f32 v38, v38, v9, v70
    v_mov_b32_dpp v70, v69 quad_perm:[1,0,3,2] row_mask:0xf bank_mask:0xf
    v_fma_f32 v69, v69, v9, v70
    v_mov_b32_dpp v70, v28 quad_perm:[1,0,3,2] row_mask:0xf bank_mask:0xf
    v_fma_f32 v28, v28, v9, v70
    v_mov_b32_dpp v70, v41 quad_perm:[1,0,3,2] row_mask:0xf bank_mask:0xf
    v_fma_f32 v41, v41, v9, v70
    v_mov_b32_dpp v70, v36 quad_perm:[1,0,3,2] row_mask:0xf bank_mask:0xf
    v_fma_f32 v36, v36, v9, v70
    v_mov_b32_dpp v70, v57 quad_perm:[1,0,3,2] row_mask:0xf bank_mask:0xf
    v_fma_f32 v57, v57, v9, v70
    v_mov_b32_dpp v70, v64 quad_perm:[1,0,3,2] row_mask:0xf bank_mask:0xf
    v_fma_f32 v64, v64, v9, v70
    v_mov_b32_dpp v70, v63 quad_perm:[1,0,3,2] row_mask:0xf bank_mask:0xf
    v_fma_f32 v63, v63, v9, v70
    v_mov_b32_dpp v70, v24 quad_perm:[1,0,3,2] row_mask:0xf bank_mask:0xf
    v_fma_f32 v24, v24, v9, v70
    v_mov_b32_dpp v70, v67 quad_perm:[1,0,3,2] row_mask:0xf bank_mask:0xf
    v_fma_f32 v67, v67, v9, v70
    v_mov_b32_dpp v70, v30 quad_perm:[1,0,3,2] row_mask:0xf bank_mask:0xf
    v_fma_f32 v30, v30, v9, v70
    v_mov_b32_dpp v70, v75 quad_perm:[1,0,3,2] row_mask:0xf bank_mask:0xf
    v_fma_f32 v75, v75, v9, v70
    v_mov_b32_dpp v70, v34 quad_perm:[1,0,3,2] row_mask:0xf bank_mask:0xf
    v_fma_f32 v34, v34, v9, v70
    v_mov_b32_dpp v70, v77 quad_perm:[1,0,3,2] row_mask:0xf bank_mask:0xf
    v_fma_f32 v77, v77, v9, v70
    v_mov_b32_dpp v70, v42 quad_perm:[1,0,3,2] row_mask:0xf bank_mask:0xf
    v_fma_f32 v42, v42, v9, v70
    v_mov_b32_dpp v70, v73 quad_perm:[1,0,3,2] row_mask:0xf bank_mask:0xf
    v_fma_f32 v73, v73, v9, v70
    v_mov_b32_dpp v70, v60 quad_perm:[1,0,3,2] row_mask:0xf bank_mask:0xf
    v_fma_f32 v60, v60, v9, v70
    v_mov_b32_dpp v70, v21 quad_perm:[1,0,3,2] row_mask:0xf bank_mask:0xf
    v_fma_f32 v21, v21, v9, v70
    v_mov_b32_dpp v70, v40 quad_perm:[1,0,3,2] row_mask:0xf bank_mask:0xf
    v_fma_f32 v40, v40, v9, v70
    v_mov_b32_dpp v70, v65 quad_perm:[1,0,3,2] row_mask:0xf bank_mask:0xf
    v_fma_f32 v65, v65, v9, v70
    v_mov_b32_dpp v70, v56 quad_perm:[1,0,3,2] row_mask:0xf bank_mask:0xf
    v_fma_f32 v56, v56, v9, v70
    v_mov_b32_dpp v70, v25 quad_perm:[1,0,3,2] row_mask:0xf bank_mask:0xf
    v_fma_f32 v25, v25, v9, v70
    v_mov_b32_dpp v70, v80 quad_perm:[1,0,3,2] row_mask:0xf bank_mask:0xf
    v_fma_f32 v80, v80, v9, v70
    v_mov_b32_dpp v70, v31 quad_perm:[1,0,3,2] row_mask:0xf bank_mask:0xf
    v_fma_f32 v31, v31, v9, v70
    v_mov_b32_dpp v70, v32 quad_perm:[1,0,3,2] row_mask:0xf bank_mask:0xf
    v_fma_f32 v32, v32, v9, v70
    v_mov_b32_dpp v70, v35 quad_perm:[1,0,3,2] row_mask:0xf bank_mask:0xf
    v_fma_f32 v35, v35, v9, v70
    v_mov_b32_dpp v70, v46 quad_perm:[1,0,3,2] row_mask:0xf bank_mask:0xf
    v_fma_f32 v46, v46, v9, v70
    v_mov_b32_dpp v70, v81 quad_perm:[1,0,3,2] row_mask:0xf bank_mask:0xf
    v_fma_f32 v81, v81, v9, v70
    v_mov_b32_dpp v70, v50 quad_perm:[1,0,3,2] row_mask:0xf bank_mask:0xf
    v_fma_f32 v50, v50, v9, v70
    v_mov_b32_dpp v70, v33 quad_perm:[1,0,3,2] row_mask:0xf bank_mask:0xf
    v_fma_f32 v33, v33, v9, v70
    v_mov_b32_dpp v70, v83 quad_perm:[1,0,3,2] row_mask:0xf bank_mask:0xf
    v_fma_f32 v83, v83, v9, v70
    v_mov_b32_dpp v70, v47 quad_perm:[1,0,3,2] row_mask:0xf bank_mask:0xf
    v_fma_f32 v47, v47, v9, v70
    v_mov_b32_dpp v70, v78 quad_perm:[1,0,3,2] row_mask:0xf bank_mask:0xf
    v_fma_f32 v78, v78, v9, v70
    v_mov_b32_dpp v70, v51 quad_perm:[1,0,3,2] row_mask:0xf bank_mask:0xf
    v_fma_f32 v51, v51, v9, v70
    v_mov_b32_dpp v70, v76 quad_perm:[1,0,3,2] row_mask:0xf bank_mask:0xf
    v_fma_f32 v76, v76, v9, v70
    v_mov_b32_dpp v70, v45 quad_perm:[1,0,3,2] row_mask:0xf bank_mask:0xf
    v_fma_f32 v45, v45, v9, v70
    v_mov_b32_dpp v70, v18 quad_perm:[1,0,3,2] row_mask:0xf bank_mask:0xf
    v_fma_f32 v18, v18, v9, v70
    v_mov_b32_dpp v70, v53 quad_perm:[1,0,3,2] row_mask:0xf bank_mask:0xf
    v_fma_f32 v53, v53, v9, v70
    v_mov_b32_dpp v70, v72 quad_perm:[1,0,3,2] row_mask:0xf bank_mask:0xf
    v_fma_f32 v72, v72, v9, v70
    v_mov_b32_dpp v70, v55 quad_perm:[1,0,3,2] row_mask:0xf bank_mask:0xf
    v_fma_f32 v55, v55, v9, v70
    v_mov_b32_dpp v70, v20 quad_perm:[1,0,3,2] row_mask:0xf bank_mask:0xf
    v_fma_f32 v20, v20, v9, v70
    v_mov_b32_dpp v70, v59 quad_perm:[1,0,3,2] row_mask:0xf bank_mask:0xf
    v_fma_f32 v59, v59, v9, v70
    v_mul_f32 v70, 0x3c800000, v10
    v_cos_f32 v79, v70
    v_sin_f32 v22, v70
    s_nop 0
    v_mul_f32 v26, v16, v79
    v_fma_f32 v26, -v49, v22, v26
    v_mul_f32 v49, v49, v79
    v_fmac_f32 v49, v16, v22
    v_mul_f32 v70, 0x3d000000, v10
    v_cos_f32 v79, v70
    v_sin_f32 v22, v70
    s_nop 0
    v_mul_f32 v16, v74, v79
    v_fma_f32 v16, -v19, v22, v16
    v_mul_f32 v19, v19, v79
    v_fmac_f32 v19, v74, v22
    v_mul_f32 v70, 0x3d400000, v10
    v_cos_f32 v79, v70
    v_sin_f32 v22, v70
    s_nop 0
    v_mul_f32 v74, v48, v79
    v_fma_f32 v74, -v23, v22, v74
    v_mul_f32 v23, v23, v79
    v_fmac_f32 v23, v48, v22
    v_mul_f32 v70, 0x3d800000, v10
    v_cos_f32 v79, v70
    v_sin_f32 v22, v70
    s_nop 0
    v_mul_f32 v48, v68, v79
    v_fma_f32 v48, -v27, v22, v48
    v_mul_f32 v27, v27, v79
    v_fmac_f32 v27, v68, v22
    v_mul_f32 v70, 0x3da00000, v10
    v_cos_f32 v79, v70
    v_sin_f32 v22, v70
    s_nop 0
    v_mul_f32 v68, v62, v79
    v_fma_f32 v68, -v39, v22, v68
    v_mul_f32 v39, v39, v79
    v_fmac_f32 v39, v62, v22
    v_mul_f32 v70, 0x3dc00000, v10
    v_cos_f32 v79, v70
    v_sin_f32 v22, v70
    s_nop 0
    v_mul_f32 v62, v66, v79
    v_fma_f32 v62, -v29, v22, v62
    v_mul_f32 v29, v29, v79
    v_fmac_f32 v29, v66, v22
    v_mul_f32 v70, 0x3de00000, v10
    v_cos_f32 v79, v70
    v_sin_f32 v22, v70
    s_nop 0
    v_mul_f32 v66, v54, v79
    v_fma_f32 v66, -v37, v22, v66
    v_mul_f32 v37, v37, v79
    v_fmac_f32 v37, v54, v22
    v_mul_f32 v70, 0x3e000000, v10
    v_cos_f32 v79, v70
    v_sin_f32 v22, v70
    s_nop 0
    v_mul_f32 v54, v44, v79
    v_fma_f32 v54, -v43, v22, v54
    v_mul_f32 v43, v43, v79
    v_fmac_f32 v43, v44, v22
    v_mul_f32 v70, 0x3e100000, v10
    v_cos_f32 v79, v70
    v_sin_f32 v22, v70
    s_nop 0
    v_mul_f32 v44, v52, v79
    v_fma_f32 v44, -v71, v22, v44
    v_mul_f32 v71, v71, v79
    v_fmac_f32 v71, v52, v22
    v_mul_f32 v70, 0x3e200000, v10
    v_cos_f32 v79, v70
    v_sin_f32 v22, v70
    s_nop 0
    v_mul_f32 v52, v58, v79
    v_fma_f32 v52, -v61, v22, v52
    v_mul_f32 v61, v61, v79
    v_fmac_f32 v61, v58, v22
    v_mul_f32 v70, 0x3e300000, v10
    v_cos_f32 v79, v70
    v_sin_f32 v22, v70
    s_nop 0
    v_mul_f32 v58, v38, v79
    v_fma_f32 v58, -v69, v22, v58
    v_mul_f32 v69, v69, v79
    v_fmac_f32 v69, v38, v22
    v_mul_f32 v70, 0x3e400000, v10
    v_cos_f32 v79, v70
    v_sin_f32 v22, v70
    s_nop 0
    v_mul_f32 v38, v28, v79
    v_fma_f32 v38, -v41, v22, v38
    v_mul_f32 v41, v41, v79
    v_fmac_f32 v41, v28, v22
    v_mul_f32 v70, 0x3e500000, v10
    v_cos_f32 v79, v70
    v_sin_f32 v22, v70
    s_nop 0
    v_mul_f32 v28, v36, v79
    v_fma_f32 v28, -v57, v22, v28
    v_mul_f32 v57, v57, v79
    v_fmac_f32 v57, v36, v22
    v_mul_f32 v70, 0x3e600000, v10
    v_cos_f32 v79, v70
    v_sin_f32 v22, v70
    s_nop 0
    v_mul_f32 v36, v64, v79
    v_fma_f32 v36, -v63, v22, v36
    v_mul_f32 v63, v63, v79
    v_fmac_f32 v63, v64, v22
    v_mul_f32 v70, 0x3e700000, v10
    v_cos_f32 v79, v70
    v_sin_f32 v22, v70
    s_nop 0
    v_mul_f32 v64, v24, v79
    v_fma_f32 v64, -v67, v22, v64
    v_mul_f32 v67, v67, v79
    v_fmac_f32 v67, v24, v22
    v_mul_f32 v70, 0x3e800000, v10
    v_cos_f32 v79, v70
    v_sin_f32 v22, v70
    s_nop 0
    v_mul_f32 v24, v30, v79
    v_fma_f32 v24, -v75, v22, v24
    v_mul_f32 v75, v75, v79
    v_fmac_f32 v75, v30, v22
    v_mul_f32 v70, 0x3e880000, v10
    v_cos_f32 v79, v70
    v_sin_f32 v22, v70
    s_nop 0
    v_mul_f32 v30, v34, v79
    v_fma_f32 v30, -v77, v22, v30
    v_mul_f32 v77, v77, v79
    v_fmac_f32 v77, v34, v22
    v_mul_f32 v70, 0x3e900000, v10
    v_cos_f32 v79, v70
    v_sin_f32 v22, v70
    s_nop 0
    v_mul_f32 v34, v42, v79
    v_fma_f32 v34, -v73, v22, v34
    v_mul_f32 v73, v73, v79
    v_fmac_f32 v73, v42, v22
    v_mul_f32 v70, 0x3e980000, v10
    v_cos_f32 v79, v70
    v_sin_f32 v22, v70
    s_nop 0
    v_mul_f32 v42, v60, v79
    v_fma_f32 v42, -v21, v22, v42
    v_mul_f32 v21, v21, v79
    v_fmac_f32 v21, v60, v22
    v_mul_f32 v70, 0x3ea00000, v10
    v_cos_f32 v79, v70
    v_sin_f32 v22, v70
    s_nop 0
    v_mul_f32 v60, v40, v79
    v_fma_f32 v60, -v65, v22, v60
    v_mul_f32 v65, v65, v79
    v_fmac_f32 v65, v40, v22
    v_mul_f32 v70, 0x3ea80000, v10
    v_cos_f32 v79, v70
    v_sin_f32 v22, v70
    s_nop 0
    v_mul_f32 v40, v56, v79
    v_fma_f32 v40, -v25, v22, v40
    v_mul_f32 v25, v25, v79
    v_fmac_f32 v25, v56, v22
    v_mul_f32 v70, 0x3eb00000, v10
    v_cos_f32 v79, v70
    v_sin_f32 v22, v70
    s_nop 0
    v_mul_f32 v56, v80, v79
    v_fma_f32 v56, -v31, v22, v56
    v_mul_f32 v31, v31, v79
    v_fmac_f32 v31, v80, v22
    v_mul_f32 v70, 0x3eb80000, v10
    v_cos_f32 v79, v70
    v_sin_f32 v22, v70
    s_nop 0
    v_mul_f32 v80, v32, v79
    v_fma_f32 v80, -v35, v22, v80
    v_mul_f32 v35, v35, v79
    v_fmac_f32 v35, v32, v22
    v_mul_f32 v70, 0x3ec00000, v10
    v_cos_f32 v79, v70
    v_sin_f32 v22, v70
    s_nop 0
    v_mul_f32 v32, v46, v79
    v_fma_f32 v32, -v81, v22, v32
    v_mul_f32 v81, v81, v79
    v_fmac_f32 v81, v46, v22
    v_mul_f32 v70, 0x3ec80000, v10
    v_cos_f32 v79, v70
    v_sin_f32 v22, v70
    s_nop 0
    v_mul_f32 v46, v50, v79
    v_fma_f32 v46, -v33, v22, v46
    v_mul_f32 v33, v33, v79
    v_fmac_f32 v33, v50, v22
    v_mul_f32 v70, 0x3ed00000, v10
    v_cos_f32 v79, v70
    v_sin_f32 v22, v70
    s_nop 0
    v_mul_f32 v50, v83, v79
    v_fma_f32 v50, -v47, v22, v50
    v_mul_f32 v47, v47, v79
    v_fmac_f32 v47, v83, v22
    v_mul_f32 v70, 0x3ed80000, v10
    v_cos_f32 v79, v70
    v_sin_f32 v22, v70
    s_nop 0
    v_mul_f32 v83, v78, v79
    v_fma_f32 v83, -v51, v22, v83
    v_mul_f32 v51, v51, v79
    v_fmac_f32 v51, v78, v22
    v_mul_f32 v70, 0x3ee00000, v10
    v_cos_f32 v79, v70
    v_sin_f32 v22, v70
    s_nop 0
    v_mul_f32 v78, v76, v79
    v_fma_f32 v78, -v45, v22, v78
    v_mul_f32 v45, v45, v79
    v_fmac_f32 v45, v76, v22
    v_mul_f32 v70, 0x3ee80000, v10
    v_cos_f32 v79, v70
    v_sin_f32 v22, v70
    s_nop 0
    v_mul_f32 v76, v18, v79
    v_fma_f32 v76, -v53, v22, v76
    v_mul_f32 v53, v53, v79
    v_fmac_f32 v53, v18, v22
    v_mul_f32 v70, 0x3ef00000, v10
    v_cos_f32 v79, v70
    v_sin_f32 v22, v70
    s_nop 0
    v_mul_f32 v18, v72, v79
    v_fma_f32 v18, -v55, v22, v18
    v_mul_f32 v55, v55, v79
    v_fmac_f32 v55, v72, v22
    v_mul_f32 v70, 0x3ef80000, v10
    v_cos_f32 v79, v70
    v_sin_f32 v22, v70
    s_nop 0
    v_mul_f32 v72, v20, v79
    v_fma_f32 v72, -v59, v22, v72
    v_mul_f32 v59, v59, v79
    v_fmac_f32 v59, v20, v22
    v_sub_f32 v70, v82, v24
    v_sub_f32 v79, v17, v75
    v_add_f32 v82, v82, v24
    v_add_f32 v17, v17, v75
    v_sub_f32 v24, v26, v30
    v_sub_f32 v75, v49, v77
    v_add_f32 v26, v26, v30
    v_add_f32 v49, v49, v77
    v_mul_f32 v30, 0x3f7b14be, v24
    v_mul_f32 v77, 0x3e47c5c2, v24
    v_fmac_f32 v30, 0xbe47c5c2, v75
    v_fmac_f32 v77, 0x3f7b14be, v75
    v_sub_f32 v24, v16, v34
    v_sub_f32 v75, v19, v73
    v_add_f32 v16, v16, v34
    v_add_f32 v19, v19, v73
    v_mul_f32 v34, 0x3f6c835e, v24
    v_mul_f32 v73, 0x3ec3ef15, v24
    v_fmac_f32 v34, 0xbec3ef15, v75
    v_fmac_f32 v73, 0x3f6c835e, v75
    v_sub_f32 v24, v74, v42
    v_sub_f32 v75, v23, v21
    v_add_f32 v74, v74, v42
    v_add_f32 v23, v23, v21
    v_mul_f32 v42, 0x3f54db31, v24
    v_mul_f32 v21, 0x3f0e39da, v24
    v_fmac_f32 v42, 0xbf0e39da, v75
    v_fmac_f32 v21, 0x3f54db31, v75
    v_sub_f32 v24, v48, v60
    v_sub_f32 v75, v27, v65
    v_add_f32 v48, v48, v60
    v_add_f32 v27, v27, v65
    v_mul_f32 v60, 0x3f3504f3, v24
    v_mul_f32 v65, 0x3f3504f3, v24
    v_fmac_f32 v60, 0xbf3504f3, v75
    v_fmac_f32 v65, 0x3f3504f3, v75
    v_sub_f32 v24, v68, v40
    v_sub_f32 v75, v39, v25
    v_add_f32 v68, v68, v40
    v_add_f32 v39, v39, v25
    v_mul_f32 v40, 0x3f0e39da, v24
    v_mul_f32 v25, 0x3f54db31, v24
    v_fmac_f32 v40, 0xbf54db31, v75
    v_fmac_f32 v25, 0x3f0e39da, v75
    v_sub_f32 v24, v62, v56
    v_sub_f32 v75, v29, v31
    v_add_f32 v62, v62, v56
    v_add_f32 v29, v29, v31
    v_mul_f32 v56, 0x3ec3ef15, v24
    v_mul_f32 v31, 0x3f6c835e, v24
    v_fmac_f32 v56, 0xbf6c835e, v75
    v_fmac_f32 v31, 0x3ec3ef15, v75
    v_sub_f32 v24, v66, v80
    v_sub_f32 v75, v37, v35
    v_add_f32 v66, v66, v80
    v_add_f32 v37, v37, v35
    v_mul_f32 v80, 0x3e47c5c2, v24
    v_mul_f32 v35, 0x3f7b14be, v24
    v_fmac_f32 v80, 0xbf7b14be, v75
    v_fmac_f32 v35, 0x3e47c5c2, v75
    v_sub_f32 v24, v81, v43
    v_sub_f32 v75, v54, v32
    v_add_f32 v54, v54, v32
    v_add_f32 v43, v43, v81
    v_sub_f32 v32, v44, v46
    v_sub_f32 v81, v71, v33
    v_add_f32 v44, v44, v46
    v_add_f32 v71, v71, v33
    v_mul_f32 v46, 0xbe47c5c2, v32
    v_mul_f32 v33, 0x3f7b14be, v32
    v_fmac_f32 v46, 0xbf7b14be, v81
    v_fmac_f32 v33, 0xbe47c5c2, v81
    v_sub_f32 v32, v52, v50
    v_sub_f32 v81, v61, v47
    v_add_f32 v52, v52, v50
    v_add_f32 v61, v61, v47
    v_mul_f32 v50, 0xbec3ef15, v32
    v_mul_f32 v47, 0x3f6c835e, v32
    v_fmac_f32 v50, 0xbf6c835e, v81
    v_fmac_f32 v47, 0xbec3ef15, v81
    v_sub_f32 v32, v58, v83
    v_sub_f32 v81, v69, v51
    v_add_f32 v58, v58, v83
    v_add_f32 v69, v69, v51
    v_mul_f32 v83, 0xbf0e39da, v32
    v_mul_f32 v51, 0x3f54db31, v32
    v_fmac_f32 v83, 0xbf54db31, v81
    v_fmac_f32 v51, 0xbf0e39da, v81
    v_sub_f32 v32, v38, v78
    v_sub_f32 v81, v41, v45
    v_add_f32 v38, v38, v78
    v_add_f32 v41, v41, v45
    v_mul_f32 v78, 0xbf3504f3, v32
    v_mul_f32 v45, 0x3f3504f3, v32
    v_fmac_f32 v78, 0xbf3504f3, v81
    v_fmac_f32 v45, 0xbf3504f3, v81
    v_sub_f32 v32, v28, v76
    v_sub_f32 v81, v57, v53
    v_add_f32 v28, v28, v76
    v_add_f32 v57, v57, v53
    v_mul_f32 v76, 0xbf54db31, v32
    v_mul_f32 v53, 0x3f0e39da, v32
    v_fmac_f32 v76, 0xbf0e39da, v81
    v_fmac_f32 v53, 0xbf54db31, v81
    v_sub_f32 v32, v36, v18
    v_sub_f32 v81, v63, v55
    v_add_f32 v36, v36, v18
    v_add_f32 v63, v63, v55
    v_mul_f32 v18, 0xbf6c835e, v32
    v_mul_f32 v55, 0x3ec3ef15, v32
    v_fmac_f32 v18, 0xbec3ef15, v81
    v_fmac_f32 v55, 0xbf6c835e, v81
    v_sub_f32 v32, v64, v72
    v_sub_f32 v81, v67, v59
    v_add_f32 v64, v64, v72
    v_add_f32 v67, v67, v59
    v_mul_f32 v72, 0xbf7b14be, v32
    v_mul_f32 v59, 0x3e47c5c2, v32
    v_fmac_f32 v72, 0xbe47c5c2, v81
    v_fmac_f32 v59, 0xbf7b14be, v81
    v_sub_f32 v32, v82, v54
    v_sub_f32 v81, v17, v43
    v_add_f32 v82, v82, v54
    v_add_f32 v17, v17, v43
    v_sub_f32 v54, v26, v44
    v_sub_f32 v43, v49, v71
    v_add_f32 v26, v26, v44
    v_add_f32 v49, v49, v71
    v_mul_f32 v44, 0x3f6c835e, v54
    v_mul_f32 v71, 0x3ec3ef15, v54
    v_fmac_f32 v44, 0xbec3ef15, v43
    v_fmac_f32 v71, 0x3f6c835e, v43
    v_sub_f32 v54, v16, v52
    v_sub_f32 v43, v19, v61
    v_add_f32 v16, v16, v52
    v_add_f32 v19, v19, v61
    v_mul_f32 v52, 0x3f3504f3, v54
    v_mul_f32 v61, 0x3f3504f3, v54
    v_fmac_f32 v52, 0xbf3504f3, v43
    v_fmac_f32 v61, 0x3f3504f3, v43
    v_sub_f32 v54, v74, v58
    v_sub_f32 v43, v23, v69
    v_add_f32 v74, v74, v58
    v_add_f32 v23, v23, v69
    v_mul_f32 v58, 0x3ec3ef15, v54
    v_mul_f32 v69, 0x3f6c835e, v54
    v_fmac_f32 v58, 0xbf6c835e, v43
    v_fmac_f32 v69, 0x3ec3ef15, v43
    v_sub_f32 v54, v41, v27
    v_sub_f32 v43, v48, v38
    v_add_f32 v48, v48, v38
    v_add_f32 v27, v27, v41
    v_sub_f32 v38, v68, v28
    v_sub_f32 v41, v39, v57
    v_add_f32 v68, v68, v28
    v_add_f32 v39, v39, v57
    v_mul_f32 v28, 0xbec3ef15, v38
    v_mul_f32 v57, 0x3f6c835e, v38
    v_fmac_f32 v28, 0xbf6c835e, v41
    v_fmac_f32 v57, 0xbec3ef15, v41
    v_sub_f32 v38, v62, v36
    v_sub_f32 v41, v29, v63
    v_add_f32 v62, v62, v36
    v_add_f32 v29, v29, v63
    v_mul_f32 v36, 0xbf3504f3, v38
    v_mul_f32 v63, 0x3f3504f3, v38
    v_fmac_f32 v36, 0xbf3504f3, v41
    v_fmac_f32 v63, 0xbf3504f3, v41
    v_sub_f32 v38, v66, v64
    v_sub_f32 v41, v37, v67
    v_add_f32 v66, v66, v64
    v_add_f32 v37, v37, v67
    v_mul_f32 v64, 0xbf6c835e, v38
    v_mul_f32 v67, 0x3ec3ef15, v38
    v_fmac_f32 v64, 0xbec3ef15, v41
    v_fmac_f32 v67, 0xbf6c835e, v41
    v_sub_f32 v38, v70, v24
    v_sub_f32 v41, v79, v75
    v_add_f32 v70, v70, v24
    v_add_f32 v79, v79, v75
    v_sub_f32 v24, v30, v46
    v_sub_f32 v75, v77, v33
    v_add_f32 v30, v30, v46
    v_add_f32 v77, v77, v33
    v_mul_f32 v46, 0x3f6c835e, v24
    v_mul_f32 v33, 0x3ec3ef15, v24
    v_fmac_f32 v46, 0xbec3ef15, v75
    v_fmac_f32 v33, 0x3f6c835e, v75
    v_sub_f32 v24, v34, v50
    v_sub_f32 v75, v73, v47
    v_add_f32 v34, v34, v50
    v_add_f32 v73, v73, v47
    v_mul_f32 v50, 0x3f3504f3, v24
    v_mul_f32 v47, 0x3f3504f3, v24
    v_fmac_f32 v50, 0xbf3504f3, v75
    v_fmac_f32 v47, 0x3f3504f3, v75
    v_sub_f32 v24, v42, v83
    v_sub_f32 v75, v21, v51
    v_add_f32 v42, v42, v83
    v_add_f32 v21, v21, v51
    v_mul_f32 v83, 0x3ec3ef15, v24
    v_mul_f32 v51, 0x3f6c835e, v24
    v_fmac_f32 v83, 0xbf6c835e, v75
    v_fmac_f32 v51, 0x3ec3ef15, v75
    v_sub_f32 v24, v45, v65
    v_sub_f32 v75, v60, v78
    v_add_f32 v60, v60, v78
    v_add_f32 v65, v65, v45
    v_sub_f32 v78, v40, v76
    v_sub_f32 v45, v25, v53
    v_add_f32 v40, v40, v76
    v_add_f32 v25, v25, v53
    v_mul_f32 v76, 0xbec3ef15, v78
    v_mul_f32 v53, 0x3f6c835e, v78
    v_fmac_f32 v76, 0xbf6c835e, v45
    v_fmac_f32 v53, 0xbec3ef15, v45
    v_sub_f32 v78, v56, v18
    v_sub_f32 v45, v31, v55
    v_add_f32 v56, v56, v18
    v_add_f32 v31, v31, v55
    v_mul_f32 v18, 0xbf3504f3, v78
    v_mul_f32 v55, 0x3f3504f3, v78
    v_fmac_f32 v18, 0xbf3504f3, v45
    v_fmac_f32 v55, 0xbf3504f3, v45
    v_sub_f32 v78, v80, v72
    v_sub_f32 v45, v35, v59
    v_add_f32 v80, v80, v72
    v_add_f32 v35, v35, v59
    v_mul_f32 v72, 0xbf6c835e, v78
    v_mul_f32 v59, 0x3ec3ef15, v78
    v_fmac_f32 v72, 0xbec3ef15, v45
    v_fmac_f32 v59, 0xbf6c835e, v45
    v_sub_f32 v78, v82, v48
    v_sub_f32 v45, v17, v27
    v_add_f32 v82, v82, v48
    v_add_f32 v17, v17, v27
    v_sub_f32 v48, v26, v68
    v_sub_f32 v27, v49, v39
    v_add_f32 v26, v26, v68
    v_add_f32 v49, v49, v39
    v_mul_f32 v68, 0x3f3504f3, v48
    v_mul_f32 v39, 0x3f3504f3, v48
    v_fmac_f32 v68, 0xbf3504f3, v27
    v_fmac_f32 v39, 0x3f3504f3, v27
    v_sub_f32 v48, v29, v19
    v_sub_f32 v27, v16, v62
    v_add_f32 v16, v16, v62
    v_add_f32 v19, v19, v29
    v_sub_f32 v62, v74, v66
    v_sub_f32 v29, v23, v37
    v_add_f32 v74, v74, v66
    v_add_f32 v23, v23, v37
    v_mul_f32 v66, 0xbf3504f3, v62
    v_mul_f32 v37, 0x3f3504f3, v62
    v_fmac_f32 v66, 0xbf3504f3, v29
    v_fmac_f32 v37, 0xbf3504f3, v29
    v_sub_f32 v62, v32, v54
    v_sub_f32 v29, v81, v43
    v_add_f32 v32, v32, v54
    v_add_f32 v81, v81, v43
    v_sub_f32 v54, v44, v28
    v_sub_f32 v43, v71, v57
    v_add_f32 v44, v44, v28
    v_add_f32 v71, v71, v57
    v_mul_f32 v28, 0x3f3504f3, v54
    v_mul_f32 v57, 0x3f3504f3, v54
    v_fmac_f32 v28, 0xbf3504f3, v43
    v_fmac_f32 v57, 0x3f3504f3, v43
    v_sub_f32 v54, v63, v61
    v_sub_f32 v43, v52, v36
    v_add_f32 v52, v52, v36
    v_add_f32 v61, v61, v63
    v_sub_f32 v36, v58, v64
    v_sub_f32 v63, v69, v67
    v_add_f32 v58, v58, v64
    v_add_f32 v69, v69, v67
    v_mul_f32 v64, 0xbf3504f3, v36
    v_mul_f32 v67, 0x3f3504f3, v36
    v_fmac_f32 v64, 0xbf3504f3, v63
    v_fmac_f32 v67, 0xbf3504f3, v63
    v_sub_f32 v36, v70, v60
    v_sub_f32 v63, v79, v65
    v_add_f32 v70, v70, v60
    v_add_f32 v79, v79, v65
    v_sub_f32 v60, v30, v40
    v_sub_f32 v65, v77, v25
    v_add_f32 v30, v30, v40
    v_add_f32 v77, v77, v25
    v_mul_f32 v40, 0x3f3504f3, v60
    v_mul_f32 v25, 0x3f3504f3, v60
    v_fmac_f32 v40, 0xbf3504f3, v65
    v_fmac_f32 v25, 0x3f3504f3, v65
    v_sub_f32 v60, v31, v73
    v_sub_f32 v65, v34, v56
    v_add_f32 v34, v34, v56
    v_add_f32 v73, v73, v31
    v_sub_f32 v56, v42, v80
    v_sub_f32 v31, v21, v35
    v_add_f32 v42, v42, v80
    v_add_f32 v21, v21, v35
    v_mul_f32 v80, 0xbf3504f3, v56
    v_mul_f32 v35, 0x3f3504f3, v56
    v_fmac_f32 v80, 0xbf3504f3, v31
    v_fmac_f32 v35, 0xbf3504f3, v31
    v_sub_f32 v56, v38, v24
    v_sub_f32 v31, v41, v75
    v_add_f32 v38, v38, v24
    v_add_f32 v41, v41, v75
    v_sub_f32 v24, v46, v76
    v_sub_f32 v75, v33, v53
    v_add_f32 v46, v46, v76
    v_add_f32 v33, v33, v53
    v_mul_f32 v76, 0x3f3504f3, v24
    v_mul_f32 v53, 0x3f3504f3, v24
    v_fmac_f32 v76, 0xbf3504f3, v75
    v_fmac_f32 v53, 0x3f3504f3, v75
    v_sub_f32 v24, v55, v47
    v_sub_f32 v75, v50, v18
    v_add_f32 v50, v50, v18
    v_add_f32 v47, v47, v55
    v_sub_f32 v18, v83, v72
    v_sub_f32 v55, v51, v59
    v_add_f32 v83, v83, v72
    v_add_f32 v51, v51, v59
    v_mul_f32 v72, 0xbf3504f3, v18
    v_mul_f32 v59, 0x3f3504f3, v18
    v_fmac_f32 v72, 0xbf3504f3, v55
    v_fmac_f32 v59, 0xbf3504f3, v55
    v_sub_f32 v18, v82, v16
    v_sub_f32 v55, v17, v19
    v_add_f32 v82, v82, v16
    v_add_f32 v17, v17, v19
    v_sub_f32 v16, v23, v49
    v_sub_f32 v19, v26, v74
    v_add_f32 v26, v26, v74
    v_add_f32 v49, v49, v23
    v_sub_f32 v74, v78, v48
    v_sub_f32 v23, v45, v27
    v_add_f32 v78, v78, v48
    v_add_f32 v45, v45, v27
    v_sub_f32 v48, v37, v39
    v_sub_f32 v27, v68, v66
    v_add_f32 v68, v68, v66
    v_add_f32 v39, v39, v37
    v_sub_f32 v66, v32, v52
    v_sub_f32 v37, v81, v61
    v_add_f32 v32, v32, v52
    v_add_f32 v81, v81, v61
    v_sub_f32 v52, v69, v71
    v_sub_f32 v61, v44, v58
    v_add_f32 v44, v44, v58
    v_add_f32 v71, v71, v69
    v_sub_f32 v58, v62, v54
    v_sub_f32 v69, v29, v43
    v_add_f32 v62, v62, v54
    v_add_f32 v29, v29, v43
    v_sub_f32 v54, v67, v57
    v_sub_f32 v43, v28, v64
    v_add_f32 v28, v28, v64
    v_add_f32 v57, v57, v67
    v_sub_f32 v64, v70, v34
    v_sub_f32 v67, v79, v73
    v_add_f32 v70, v70, v34
    v_add_f32 v79, v79, v73
    v_sub_f32 v34, v21, v77
    v_sub_f32 v73, v30, v42
    v_add_f32 v30, v30, v42
    v_add_f32 v77, v77, v21
    v_sub_f32 v42, v36, v60
    v_sub_f32 v21, v63, v65
    v_add_f32 v36, v36, v60
    v_add_f32 v63, v63, v65
    v_sub_f32 v60, v35, v25
    v_sub_f32 v65, v40, v80
    v_add_f32 v40, v40, v80
    v_add_f32 v25, v25, v35
    v_sub_f32 v80, v38, v50
    v_sub_f32 v35, v41, v47
    v_add_f32 v38, v38, v50
    v_add_f32 v41, v41, v47
    v_sub_f32 v50, v51, v33
    v_sub_f32 v47, v46, v83
    v_add_f32 v46, v46, v83
    v_add_f32 v33, v33, v51
    v_sub_f32 v83, v56, v24
    v_sub_f32 v51, v31, v75
    v_add_f32 v56, v56, v24
    v_add_f32 v31, v31, v75
    v_sub_f32 v24, v59, v53
    v_sub_f32 v75, v76, v72
    v_add_f32 v76, v76, v72
    v_add_f32 v53, v53, v59
    v_sub_f32 v72, v82, v26
    v_sub_f32 v59, v17, v49
    v_add_f32 v82, v82, v26
    v_add_f32 v17, v17, v49
    v_sub_f32 v26, v18, v16
    v_sub_f32 v49, v55, v19
    v_add_f32 v18, v18, v16
    v_add_f32 v55, v55, v19
    v_sub_f32 v16, v78, v68
    v_sub_f32 v19, v45, v39
    v_add_f32 v78, v78, v68
    v_add_f32 v45, v45, v39
    v_sub_f32 v68, v74, v48
    v_sub_f32 v39, v23, v27
    v_add_f32 v74, v74, v48
    v_add_f32 v23, v23, v27
    v_sub_f32 v48, v32, v44
    v_sub_f32 v27, v81, v71
    v_add_f32 v32, v32, v44
    v_add_f32 v81, v81, v71
    v_sub_f32 v44, v66, v52
    v_sub_f32 v71, v37, v61
    v_add_f32 v66, v66, v52
    v_add_f32 v37, v37, v61
    v_sub_f32 v52, v62, v28
    v_sub_f32 v61, v29, v57
    v_add_f32 v62, v62, v28
    v_add_f32 v29, v29, v57
    v_sub_f32 v28, v58, v54
    v_sub_f32 v57, v69, v43
    v_add_f32 v58, v58, v54
    v_add_f32 v69, v69, v43
    v_sub_f32 v54, v70, v30
    v_sub_f32 v43, v79, v77
    v_add_f32 v70, v70, v30
    v_add_f32 v79, v79, v77
    v_sub_f32 v30, v64, v34
    v_sub_f32 v77, v67, v73
    v_add_f32 v64, v64, v34
    v_add_f32 v67, v67, v73
    v_sub_f32 v34, v36, v40
    v_sub_f32 v73, v63, v25
    v_add_f32 v36, v36, v40
    v_add_f32 v63, v63, v25
    v_sub_f32 v40, v42, v60
    v_sub_f32 v25, v21, v65
    v_add_f32 v42, v42, v60
    v_add_f32 v21, v21, v65
    v_sub_f32 v60, v38, v46
    v_sub_f32 v65, v41, v33
    v_add_f32 v38, v38, v46
    v_add_f32 v41, v41, v33
    v_sub_f32 v46, v80, v50
    v_sub_f32 v33, v35, v47
    v_add_f32 v80, v80, v50
    v_add_f32 v35, v35, v47
    v_sub_f32 v50, v56, v76
    v_sub_f32 v47, v31, v53
    v_add_f32 v56, v56, v76
    v_add_f32 v31, v31, v53
    v_sub_f32 v76, v83, v24
    v_sub_f32 v53, v51, v75
    v_add_f32 v83, v83, v24
    v_add_f32 v51, v51, v75
    v_mul_f32 v12, v10, v8
    v_mul_f32 v12, 0x3a000000, v12
    v_mov_b32 v24, v12
    v_fmac_f32 v24, 0x00000000, v8
    v_cos_f32 v75, v24
    v_sin_f32 v22, v24
    s_nop 0
    v_mul_f32 v20, v82, v75
    v_fma_f32 v20, -v17, v22, v20
    v_mul_f32 v17, v17, v75
    v_fmac_f32 v17, v82, v22
    v_mov_b32 v24, v12
    v_fmac_f32 v24, 0x3a800000, v8
    v_cos_f32 v75, v24
    v_sin_f32 v22, v24
    s_nop 0
    v_mul_f32 v82, v70, v75
    v_fma_f32 v82, -v79, v22, v82
    v_mul_f32 v79, v79, v75
    v_fmac_f32 v79, v70, v22
    v_mov_b32 v24, v12
    v_fmac_f32 v24, 0x3b000000, v8
    v_cos_f32 v75, v24
    v_sin_f32 v22, v24
    s_nop 0
    v_mul_f32 v70, v32, v75
    v_fma_f32 v70, -v81, v22, v70
    v_mul_f32 v81, v81, v75
    v_fmac_f32 v81, v32, v22
    v_mov_b32 v24, v12
    v_fmac_f32 v24, 0x3b400000, v8
    v_cos_f32 v75, v24
    v_sin_f32 v22, v24
    s_nop 0
    v_mul_f32 v32, v38, v75
    v_fma_f32 v32, -v41, v22, v32
    v_mul_f32 v41, v41, v75
    v_fmac_f32 v41, v38, v22
    v_mov_b32 v24, v12
    v_fmac_f32 v24, 0x3b800000, v8
    v_cos_f32 v75, v24
    v_sin_f32 v22, v24
    s_nop 0
    v_mul_f32 v38, v78, v75
    v_fma_f32 v38, -v45, v22, v38
    v_mul_f32 v45, v45, v75
    v_fmac_f32 v45, v78, v22
    v_mov_b32 v24, v12
    v_fmac_f32 v24, 0x3ba00000, v8
    v_cos_f32 v75, v24
    v_sin_f32 v22, v24
    s_nop 0
    v_mul_f32 v78, v36, v75
    v_fma_f32 v78, -v63, v22, v78
    v_mul_f32 v63, v63, v75
    v_fmac_f32 v63, v36, v22
    v_mov_b32 v24, v12
    v_fmac_f32 v24, 0x3bc00000, v8
    v_cos_f32 v75, v24
    v_sin_f32 v22, v24
    s_nop 0
    v_mul_f32 v36, v62, v75
    v_fma_f32 v36, -v29, v22, v36
    v_mul_f32 v29, v29, v75
    v_fmac_f32 v29, v62, v22
    v_mov_b32 v24, v12
    v_fmac_f32 v24, 0x3be00000, v8
    v_cos_f32 v75, v24
    v_sin_f32 v22, v24
    s_nop 0
    v_mul_f32 v62, v56, v75
    v_fma_f32 v62, -v31, v22, v62
    v_mul_f32 v31, v31, v75
    v_fmac_f32 v31, v56, v22
    v_mov_b32 v24, v12
    v_fmac_f32 v24, 0x3c000000, v8
    v_cos_f32 v75, v24
    v_sin_f32 v22, v24
    s_nop 0
    v_mul_f32 v56, v18, v75
    v_fma_f32 v56, -v55, v22, v56
    v_mul_f32 v55, v55, v75
    v_fmac_f32 v55, v18, v22
    v_mov_b32 v24, v12
    v_fmac_f32 v24, 0x3c100000, v8
    v_cos_f32 v75, v24
    v_sin_f32 v22, v24
    s_nop 0
    v_mul_f32 v18, v64, v75
    v_fma_f32 v18, -v67, v22, v18
    v_mul_f32 v67, v67, v75
    v_fmac_f32 v67, v64, v22
    v_mov_b32 v24, v12
    v_fmac_f32 v24, 0x3c200000, v8
    v_cos_f32 v75, v24
    v_sin_f32 v22, v24
    s_nop 0
    v_mul_f32 v64, v66, v75
    v_fma_f32 v64, -v37, v22, v64
    v_mul_f32 v37, v37, v75
    v_fmac_f32 v37, v66, v22
    v_mov_b32 v24, v12
    v_fmac_f32 v24, 0x3c300000, v8
    v_cos_f32 v75, v24
    v_sin_f32 v22, v24
    s_nop 0
    v_mul_f32 v66, v80, v75
    v_fma_f32 v66, -v35, v22, v66
    v_mul_f32 v35, v35, v75
    v_fmac_f32 v35, v80, v22
    v_mov_b32 v24, v12
    v_fmac_f32 v24, 0x3c400000, v8
    v_cos_f32 v75, v24
    v_sin_f32 v22, v24
    s_nop 0
    v_mul_f32 v80, v74, v75
    v_fma_f32 v80, -v23, v22, v80
    v_mul_f32 v23, v23, v75
    v_fmac_f32 v23, v74, v22
    v_mov_b32 v24, v12
    v_fmac_f32 v24, 0x3c500000, v8
    v_cos_f32 v75, v24
    v_sin_f32 v22, v24
    s_nop 0
    v_mul_f32 v74, v42, v75
    v_fma_f32 v74, -v21, v22, v74
    v_mul_f32 v21, v21, v75
    v_fmac_f32 v21, v42, v22
    v_mov_b32 v24, v12
    v_fmac_f32 v24, 0x3c600000, v8
    v_cos_f32 v75, v24
    v_sin_f32 v22, v24
    s_nop 0
    v_mul_f32 v42, v58, v75
    v_fma_f32 v42, -v69, v22, v42
    v_mul_f32 v69, v69, v75
    v_fmac_f32 v69, v58, v22
    v_mov_b32 v24, v12
    v_fmac_f32 v24, 0x3c700000, v8
    v_cos_f32 v75, v24
    v_sin_f32 v22, v24
    s_nop 0
    v_mul_f32 v58, v83, v75
    v_fma_f32 v58, -v51, v22, v58
    v_mul_f32 v51, v51, v75
    v_fmac_f32 v51, v83, v22
    v_mov_b32 v24, v12
    v_fmac_f32 v24, 0x3c800000, v8
    v_cos_f32 v75, v24
    v_sin_f32 v22, v24
    s_nop 0
    v_mul_f32 v83, v72, v75
    v_fma_f32 v83, -v59, v22, v83
    v_mul_f32 v59, v59, v75
    v_fmac_f32 v59, v72, v22
    v_mov_b32 v24, v12
    v_fmac_f32 v24, 0x3c880000, v8
    v_cos_f32 v75, v24
    v_sin_f32 v22, v24
    s_nop 0
    v_mul_f32 v72, v54, v75
    v_fma_f32 v72, -v43, v22, v72
    v_mul_f32 v43, v43, v75
    v_fmac_f32 v43, v54, v22
    v_mov_b32 v24, v12
    v_fmac_f32 v24, 0x3c900000, v8
    v_cos_f32 v75, v24
    v_sin_f32 v22, v24
    s_nop 0
    v_mul_f32 v54, v48, v75
    v_fma_f32 v54, -v27, v22, v54
    v_mul_f32 v27, v27, v75
    v_fmac_f32 v27, v48, v22
    v_mov_b32 v24, v12
    v_fmac_f32 v24, 0x3c980000, v8
    v_cos_f32 v75, v24
    v_sin_f32 v22, v24
    s_nop 0
    v_mul_f32 v48, v60, v75
    v_fma_f32 v48, -v65, v22, v48
    v_mul_f32 v65, v65, v75
    v_fmac_f32 v65, v60, v22
    v_mov_b32 v24, v12
    v_fmac_f32 v24, 0x3ca00000, v8
    v_cos_f32 v75, v24
    v_sin_f32 v22, v24
    s_nop 0
    v_mul_f32 v60, v16, v75
    v_fma_f32 v60, -v19, v22, v60
    v_mul_f32 v19, v19, v75
    v_fmac_f32 v19, v16, v22
    v_mov_b32 v24, v12
    v_fmac_f32 v24, 0x3ca80000, v8
    v_cos_f32 v75, v24
    v_sin_f32 v22, v24
    s_nop 0
    v_mul_f32 v16, v34, v75
    v_fma_f32 v16, -v73, v22, v16
    v_mul_f32 v73, v73, v75
    v_fmac_f32 v73, v34, v22
    v_mov_b32 v24, v12
    v_fmac_f32 v24, 0x3cb00000, v8
    v_cos_f32 v75, v24
    v_sin_f32 v22, v24
    s_nop 0
    v_mul_f32 v34, v52, v75
    v_fma_f32 v34, -v61, v22, v34
    v_mul_f32 v61, v61, v75
    v_fmac_f32 v61, v52, v22
    v_mov_b32 v24, v12
    v_fmac_f32 v24, 0x3cb80000, v8
    v_cos_f32 v75, v24
    v_sin_f32 v22, v24
    s_nop 0
    v_mul_f32 v52, v50, v75
    v_fma_f32 v52, -v47, v22, v52
    v_mul_f32 v47, v47, v75
    v_fmac_f32 v47, v50, v22
    v_mov_b32 v24, v12
    v_fmac_f32 v24, 0x3cc00000, v8
    v_cos_f32 v75, v24
    v_sin_f32 v22, v24
    s_nop 0
    v_mul_f32 v50, v26, v75
    v_fma_f32 v50, -v49, v22, v50
    v_mul_f32 v49, v49, v75
    v_fmac_f32 v49, v26, v22
    v_mov_b32 v24, v12
    v_fmac_f32 v24, 0x3cc80000, v8
    v_cos_f32 v75, v24
    v_sin_f32 v22, v24
    s_nop 0
    v_mul_f32 v26, v30, v75
    v_fma_f32 v26, -v77, v22, v26
    v_mul_f32 v77, v77, v75
    v_fmac_f32 v77, v30, v22
    v_mov_b32 v24, v12
    v_fmac_f32 v24, 0x3cd00000, v8
    v_cos_f32 v75, v24
    v_sin_f32 v22, v24
    s_nop 0
    v_mul_f32 v30, v44, v75
    v_fma_f32 v30, -v71, v22, v30
    v_mul_f32 v71, v71, v75
    v_fmac_f32 v71, v44, v22
    v_mov_b32 v24, v12
    v_fmac_f32 v24, 0x3cd80000, v8
    v_cos_f32 v75, v24
    v_sin_f32 v22, v24
    s_nop 0
    v_mul_f32 v44, v46, v75
    v_fma_f32 v44, -v33, v22, v44
    v_mul_f32 v33, v33, v75
    v_fmac_f32 v33, v46, v22
    v_mov_b32 v24, v12
    v_fmac_f32 v24, 0x3ce00000, v8
    v_cos_f32 v75, v24
    v_sin_f32 v22, v24
    s_nop 0
    v_mul_f32 v46, v68, v75
    v_fma_f32 v46, -v39, v22, v46
    v_mul_f32 v39, v39, v75
    v_fmac_f32 v39, v68, v22
    v_mov_b32 v24, v12
    v_fmac_f32 v24, 0x3ce80000, v8
    v_cos_f32 v75, v24
    v_sin_f32 v22, v24
    s_nop 0
    v_mul_f32 v68, v40, v75
    v_fma_f32 v68, -v25, v22, v68
    v_mul_f32 v25, v25, v75
    v_fmac_f32 v25, v40, v22
    v_mov_b32 v24, v12
    v_fmac_f32 v24, 0x3cf00000, v8
    v_cos_f32 v75, v24
    v_sin_f32 v22, v24
    s_nop 0
    v_mul_f32 v40, v28, v75
    v_fma_f32 v40, -v57, v22, v40
    v_mul_f32 v57, v57, v75
    v_fmac_f32 v57, v28, v22
    v_mov_b32 v24, v12
    v_fmac_f32 v24, 0x3cf80000, v8
    v_cos_f32 v75, v24
    v_sin_f32 v22, v24
    s_nop 0
    v_mul_f32 v28, v76, v75
    v_fma_f32 v28, -v53, v22, v28
    v_mul_f32 v53, v53, v75
    v_fmac_f32 v53, v76, v22
    ds_write_b32 v4, v20 offset:0
    ds_write_b32 v4, v17 offset:4
    ds_write_b32 v4, v82 offset:16
    ds_write_b32 v4, v79 offset:20
    ds_write_b32 v4, v70 offset:32
    ds_write_b32 v4, v81 offset:36
    ds_write_b32 v4, v32 offset:48
    ds_write_b32 v4, v41 offset:52
    ds_write_b32 v4, v38 offset:64
    ds_write_b32 v4, v45 offset:68
    ds_write_b32 v4, v78 offset:80
    ds_write_b32 v4, v63 offset:84
    ds_write_b32 v4, v36 offset:96
    ds_write_b32 v4, v29 offset:100
    ds_write_b32 v4, v62 offset:112
    ds_write_b32 v4, v31 offset:116
    ds_write_b32 v4, v56 offset:128
    ds_write_b32 v4, v55 offset:132
    ds_write_b32 v4, v18 offset:144
    ds_write_b32 v4, v67 offset:148
    ds_write_b32 v4, v64 offset:160
    ds_write_b32 v4, v37 offset:164
    ds_write_b32 v4, v66 offset:176
    ds_write_b32 v4, v35 offset:180
    ds_write_b32 v4, v80 offset:192
    ds_write_b32 v4, v23 offset:196
    ds_write_b32 v4, v74 offset:208
    ds_write_b32 v4, v21 offset:212
    ds_write_b32 v4, v42 offset:224
    ds_write_b32 v4, v69 offset:228
    ds_write_b32 v4, v58 offset:240
    ds_write_b32 v4, v51 offset:244
    ds_write_b32 v4, v83 offset:256
    ds_write_b32 v4, v59 offset:260
    ds_write_b32 v4, v72 offset:272
    ds_write_b32 v4, v43 offset:276
    ds_write_b32 v4, v54 offset:288
    ds_write_b32 v4, v27 offset:292
    ds_write_b32 v4, v48 offset:304
    ds_write_b32 v4, v65 offset:308
    ds_write_b32 v4, v60 offset:320
    ds_write_b32 v4, v19 offset:324
    ds_write_b32 v4, v16 offset:336
    ds_write_b32 v4, v73 offset:340
    ds_write_b32 v4, v34 offset:352
    ds_write_b32 v4, v61 offset:356
    ds_write_b32 v4, v52 offset:368
    ds_write_b32 v4, v47 offset:372
    ds_write_b32 v4, v50 offset:384
    ds_write_b32 v4, v49 offset:388
    ds_write_b32 v4, v26 offset:400
    ds_write_b32 v4, v77 offset:404
    ds_write_b32 v4, v30 offset:416
    ds_write_b32 v4, v71 offset:420
    ds_write_b32 v4, v44 offset:432
    ds_write_b32 v4, v33 offset:436
    ds_write_b32 v4, v46 offset:448
    ds_write_b32 v4, v39 offset:452
    ds_write_b32 v4, v68 offset:464
    ds_write_b32 v4, v25 offset:468
    ds_write_b32 v4, v40 offset:480
    ds_write_b32 v4, v57 offset:484
    ds_write_b32 v4, v28 offset:496
    ds_write_b32 v4, v53 offset:500
    s_waitcnt lgkmcnt(0)
    ds_read_b32 v20, v3 offset:0
    ds_read_b32 v17, v3 offset:4
    ds_read_b32 v82, v3 offset:528
    ds_read_b32 v79, v3 offset:532
    ds_read_b32 v70, v3 offset:1056
    ds_read_b32 v81, v3 offset:1060
    ds_read_b32 v32, v3 offset:1584
    ds_read_b32 v41, v3 offset:1588
    ds_read_b32 v38, v3 offset:2112
    ds_read_b32 v45, v3 offset:2116
    ds_read_b32 v78, v3 offset:2640
    ds_read_b32 v63, v3 offset:2644
    ds_read_b32 v36, v3 offset:3168
    ds_read_b32 v29, v3 offset:3172
    s_waitcnt lgkmcnt(0)
    ds_read_b32 v62, v3 offset:3696
    ds_read_b32 v31, v3 offset:3700
    ds_read_b32 v56, v3 offset:4224
    ds_read_b32 v55, v3 offset:4228
    ds_read_b32 v18, v3 offset:4752
    ds_read_b32 v67, v3 offset:4756
    ds_read_b32 v64, v3 offset:5280
    ds_read_b32 v37, v3 offset:5284
    ds_read_b32 v66, v3 offset:5808
    ds_read_b32 v35, v3 offset:5812
    ds_read_b32 v80, v3 offset:6336
    ds_read_b32 v23, v3 offset:6340
    ds_read_b32 v74, v3 offset:6864
    ds_read_b32 v21, v3 offset:6868
    s_waitcnt lgkmcnt(0)
    ds_read_b32 v42, v3 offset:7392
    ds_read_b32 v69, v3 offset:7396
    ds_read_b32 v58, v3 offset:7920
    ds_read_b32 v51, v3 offset:7924
    ds_read_b32 v83, v3 offset:8448
    ds_read_b32 v59, v3 offset:8452
    ds_read_b32 v72, v3 offset:8976
    ds_read_b32 v43, v3 offset:8980
    ds_read_b32 v54, v3 offset:9504
    ds_read_b32 v27, v3 offset:9508
    ds_read_b32 v48, v3 offset:10032
    ds_read_b32 v65, v3 offset:10036
    ds_read_b32 v60, v3 offset:10560
    ds_read_b32 v19, v3 offset:10564
    s_waitcnt lgkmcnt(0)
    ds_read_b32 v16, v3 offset:11088
    ds_read_b32 v73, v3 offset:11092
    ds_read_b32 v34, v3 offset:11616
    ds_read_b32 v61, v3 offset:11620
    ds_read_b32 v52, v3 offset:12144
    ds_read_b32 v47, v3 offset:12148
    ds_read_b32 v50, v3 offset:12672
    ds_read_b32 v49, v3 offset:12676
    ds_read_b32 v26, v3 offset:13200
    ds_read_b32 v77, v3 offset:13204
    ds_read_b32 v30, v3 offset:13728
    ds_read_b32 v71, v3 offset:13732
    ds_read_b32 v44, v3 offset:14256
    ds_read_b32 v33, v3 offset:14260
    s_waitcnt lgkmcnt(0)
    ds_read_b32 v46, v3 offset:14784
    ds_read_b32 v39, v3 offset:14788
    ds_read_b32 v68, v3 offset:15312
    ds_read_b32 v25, v3 offset:15316
    ds_read_b32 v40, v3 offset:15840
    ds_read_b32 v57, v3 offset:15844
    ds_read_b32 v28, v3 offset:16368
    ds_read_b32 v53, v3 offset:16372
    s_waitcnt lgkmcnt(0)
    v_sub_f32 v24, v20, v83
    v_sub_f32 v75, v17, v59
    v_add_f32 v20, v20, v83
    v_add_f32 v17, v17, v59
    v_sub_f32 v83, v82, v72
    v_sub_f32 v59, v79, v43
    v_add_f32 v82, v82, v72
    v_add_f32 v79, v79, v43
    v_mul_f32 v72, 0x3f7b14be, v83
    v_mul_f32 v43, 0x3e47c5c2, v83
    v_fmac_f32 v72, 0xbe47c5c2, v59
    v_fmac_f32 v43, 0x3f7b14be, v59
    v_sub_f32 v83, v70, v54
    v_sub_f32 v59, v81, v27
    v_add_f32 v70, v70, v54
    v_add_f32 v81, v81, v27
    v_mul_f32 v54, 0x3f6c835e, v83
    v_mul_f32 v27, 0x3ec3ef15, v83
    v_fmac_f32 v54, 0xbec3ef15, v59
    v_fmac_f32 v27, 0x3f6c835e, v59
    v_sub_f32 v83, v32, v48
    v_sub_f32 v59, v41, v65
    v_add_f32 v32, v32, v48
    v_add_f32 v41, v41, v65
    v_mul_f32 v48, 0x3f54db31, v83
    v_mul_f32 v65, 0x3f0e39da, v83
    v_fmac_f32 v48, 0xbf0e39da, v59
    v_fmac_f32 v65, 0x3f54db31, v59
    v_sub_f32 v83, v38, v60
    v_sub_f32 v59, v45, v19
    v_add_f32 v38, v38, v60
    v_add_f32 v45, v45, v19
    v_mul_f32 v60, 0x3f3504f3, v83
    v_mul_f32 v19, 0x3f3504f3, v83
    v_fmac_f32 v60, 0xbf3504f3, v59
    v_fmac_f32 v19, 0x3f3504f3, v59
    v_sub_f32 v83, v78, v16
    v_sub_f32 v59, v63, v73
    v_add_f32 v78, v78, v16
    v_add_f32 v63, v63, v73
    v_mul_f32 v16, 0x3f0e39da, v83
    v_mul_f32 v73, 0x3f54db31, v83
    v_fmac_f32 v16, 0xbf54db31, v59
    v_fmac_f32 v73, 0x3f0e39da, v59
    v_sub_f32 v83, v36, v34
    v_sub_f32 v59, v29, v61
    v_add_f32 v36, v36, v34
    v_add_f32 v29, v29, v61
    v_mul_f32 v34, 0x3ec3ef15, v83
    v_mul_f32 v61, 0x3f6c835e, v83
    v_fmac_f32 v34, 0xbf6c835e, v59
    v_fmac_f32 v61, 0x3ec3ef15, v59
    v_sub_f32 v83, v62, v52
    v_sub_f32 v59, v31, v47
    v_add_f32 v62, v62, v52
    v_add_f32 v31, v31, v47
    v_mul_f32 v52, 0x3e47c5c2, v83
    v_mul_f32 v47, 0x3f7b14be, v83
    v_fmac_f32 v52, 0xbf7b14be, v59
    v_fmac_f32 v47, 0x3e47c5c2, v59
    v_sub_f32 v83, v49, v55
    v_sub_f32 v59, v56, v50
    v_add_f32 v56, v56, v50
    v_add_f32 v55, v55, v49
    v_sub_f32 v50, v18, v26
    v_sub_f32 v49, v67, v77
    v_add_f32 v18, v18, v26
    v_add_f32 v67, v67, v77
    v_mul_f32 v26, 0xbe47c5c2, v50
    v_mul_f32 v77, 0x3f7b14be, v50
    v_fmac_f32 v26, 0xbf7b14be, v49
    v_fmac_f32 v77, 0xbe47c5c2, v49
    v_sub_f32 v50, v64, v30
    v_sub_f32 v49, v37, v71
    v_add_f32 v64, v64, v30
    v_add_f32 v37, v37, v71
    v_mul_f32 v30, 0xbec3ef15, v50
    v_mul_f32 v71, 0x3f6c835e, v50
    v_fmac_f32 v30, 0xbf6c835e, v49
    v_fmac_f32 v71, 0xbec3ef15, v49
    v_sub_f32 v50, v66, v44
    v_sub_f32 v49, v35, v33
    v_add_f32 v66, v66, v44
    v_add_f32 v35, v35, v33
    v_mul_f32 v44, 0xbf0e39da, v50
    v_mul_f32 v33, 0x3f54db31, v50
    v_fmac_f32 v44, 0xbf54db31, v49
    v_fmac_f32 v33, 0xbf0e39da, v49
    v_sub_f32 v50, v80, v46
    v_sub_f32 v49, v23, v39
    v_add_f32 v80, v80, v46
    v_add_f32 v23, v23, v39
    v_mul_f32 v46, 0xbf3504f3, v50
    v_mul_f32 v39, 0x3f3504f3, v50
    v_fmac_f32 v46, 0xbf3504f3, v49
    v_fmac_f32 v39, 0xbf3504f3, v49
    v_sub_f32 v50, v74, v68
    v_sub_f32 v49, v21, v25
    v_add_f32 v74, v74, v68
    v_add_f32 v21, v21, v25
    v_mul_f32 v68, 0xbf54db31, v50
    v_mul_f32 v25, 0x3f0e39da, v50
    v_fmac_f32 v68, 0xbf0e39da, v49
    v_fmac_f32 v25, 0xbf54db31, v49
    v_sub_f32 v50, v42, v40
    v_sub_f32 v49, v69, v57
    v_add_f32 v42, v42, v40
    v_add_f32 v69, v69, v57
    v_mul_f32 v40, 0xbf6c835e, v50
    v_mul_f32 v57, 0x3ec3ef15, v50
    v_fmac_f32 v40, 0xbec3ef15, v49
    v_fmac_f32 v57, 0xbf6c835e, v49
    v_sub_f32 v50, v58, v28
    v_sub_f32 v49, v51, v53
    v_add_f32 v58, v58, v28
    v_add_f32 v51, v51, v53
    v_mul_f32 v28, 0xbf7b14be, v50
    v_mul_f32 v53, 0x3e47c5c2, v50
    v_fmac_f32 v28, 0xbe47c5c2, v49
    v_fmac_f32 v53, 0xbf7b14be, v49
    v_sub_f32 v50, v20, v56
    v_sub_f32 v49, v17, v55
    v_add_f32 v20, v20, v56
    v_add_f32 v17, v17, v55
    v_sub_f32 v56, v82, v18
    v_sub_f32 v55, v79, v67
    v_add_f32 v82, v82, v18
    v_add_f32 v79, v79, v67
    v_mul_f32 v18, 0x3f6c835e, v56
    v_mul_f32 v67, 0x3ec3ef15, v56
    v_fmac_f32 v18, 0xbec3ef15, v55
    v_fmac_f32 v67, 0x3f6c835e, v55
    v_sub_f32 v56, v70, v64
    v_sub_f32 v55, v81, v37
    v_add_f32 v70, v70, v64
    v_add_f32 v81, v81, v37
    v_mul_f32 v64, 0x3f3504f3, v56
    v_mul_f32 v37, 0x3f3504f3, v56
    v_fmac_f32 v64, 0xbf3504f3, v55
    v_fmac_f32 v37, 0x3f3504f3, v55
    v_sub_f32 v56, v32, v66
    v_sub_f32 v55, v41, v35
    v_add_f32 v32, v32, v66
    v_add_f32 v41, v41, v35
    v_mul_f32 v66, 0x3ec3ef15, v56
    v_mul_f32 v35, 0x3f6c835e, v56
    v_fmac_f32 v66, 0xbf6c835e, v55
    v_fmac_f32 v35, 0x3ec3ef15, v55
    v_sub_f32 v56, v23, v45
    v_sub_f32 v55, v38, v80
    v_add_f32 v38, v38, v80
    v_add_f32 v45, v45, v23
    v_sub_f32 v80, v78, v74
    v_sub_f32 v23, v63, v21
    v_add_f32 v78, v78, v74
    v_add_f32 v63, v63, v21
    v_mul_f32 v74, 0xbec3ef15, v80
    v_mul_f32 v21, 0x3f6c835e, v80
    v_fmac_f32 v74, 0xbf6c835e, v23
    v_fmac_f32 v21, 0xbec3ef15, v23
    v_sub_f32 v80, v36, v42
    v_sub_f32 v23, v29, v69
    v_add_f32 v36, v36, v42
    v_add_f32 v29, v29, v69
    v_mul_f32 v42, 0xbf3504f3, v80
    v_mul_f32 v69, 0x3f3504f3, v80
    v_fmac_f32 v42, 0xbf3504f3, v23
    v_fmac_f32 v69, 0xbf3504f3, v23
    v_sub_f32 v80, v62, v58
    v_sub_f32 v23, v31, v51
    v_add_f32 v62, v62, v58
    v_add_f32 v31, v31, v51
    v_mul_f32 v58, 0xbf6c835e, v80
    v_mul_f32 v51, 0x3ec3ef15, v80
    v_fmac_f32 v58, 0xbec3ef15, v23
    v_fmac_f32 v51, 0xbf6c835e, v23
    v_sub_f32 v80, v24, v83
    v_sub_f32 v23, v75, v59
    v_add_f32 v24, v24, v83
    v_add_f32 v75, v75, v59
    v_sub_f32 v83, v72, v26
    v_sub_f32 v59, v43, v77
    v_add_f32 v72, v72, v26
    v_add_f32 v43, v43, v77
    v_mul_f32 v26, 0x3f6c835e, v83
    v_mul_f32 v77, 0x3ec3ef15, v83
    v_fmac_f32 v26, 0xbec3ef15, v59
    v_fmac_f32 v77, 0x3f6c835e, v59
    v_sub_f32 v83, v54, v30
    v_sub_f32 v59, v27, v71
    v_add_f32 v54, v54, v30
    v_add_f32 v27, v27, v71
    v_mul_f32 v30, 0x3f3504f3, v83
    v_mul_f32 v71, 0x3f3504f3, v83
    v_fmac_f32 v30, 0xbf3504f3, v59
    v_fmac_f32 v71, 0x3f3504f3, v59
    v_sub_f32 v83, v48, v44
    v_sub_f32 v59, v65, v33
    v_add_f32 v48, v48, v44
    v_add_f32 v65, v65, v33
    v_mul_f32 v44, 0x3ec3ef15, v83
    v_mul_f32 v33, 0x3f6c835e, v83
    v_fmac_f32 v44, 0xbf6c835e, v59
    v_fmac_f32 v33, 0x3ec3ef15, v59
    v_sub_f32 v83, v39, v19
    v_sub_f32 v59, v60, v46
    v_add_f32 v60, v60, v46
    v_add_f32 v19, v19, v39
    v_sub_f32 v46, v16, v68
    v_sub_f32 v39, v73, v25
    v_add_f32 v16, v16, v68
    v_add_f32 v73, v73, v25
    v_mul_f32 v68, 0xbec3ef15, v46
    v_mul_f32 v25, 0x3f6c835e, v46
    v_fmac_f32 v68, 0xbf6c835e, v39
    v_fmac_f32 v25, 0xbec3ef15, v39
    v_sub_f32 v46, v34, v40
    v_sub_f32 v39, v61, v57
    v_add_f32 v34, v34, v40
    v_add_f32 v61, v61, v57
    v_mul_f32 v40, 0xbf3504f3, v46
    v_mul_f32 v57, 0x3f3504f3, v46
    v_fmac_f32 v40, 0xbf3504f3, v39
    v_fmac_f32 v57, 0xbf3504f3, v39
    v_sub_f32 v46, v52, v28
    v_sub_f32 v39, v47, v53
    v_add_f32 v52, v52, v28
    v_add_f32 v47, v47, v53
    v_mul_f32 v28, 0xbf6c835e, v46
    v_mul_f32 v53, 0x3ec3ef15, v46
    v_fmac_f32 v28, 0xbec3ef15, v39
    v_fmac_f32 v53, 0xbf6c835e, v39
    v_sub_f32 v46, v20, v38
    v_sub_f32 v39, v17, v45
    v_add_f32 v20, v20, v38
    v_add_f32 v17, v17, v45
    v_sub_f32 v38, v82, v78
    v_sub_f32 v45, v79, v63
    v_add_f32 v82, v82, v78
    v_add_f32 v79, v79, v63
    v_mul_f32 v78, 0x3f3504f3, v38
    v_mul_f32 v63, 0x3f3504f3, v38
    v_fmac_f32 v78, 0xbf3504f3, v45
    v_fmac_f32 v63, 0x3f3504f3, v45
    v_sub_f32 v38, v29, v81
    v_sub_f32 v45, v70, v36
    v_add_f32 v70, v70, v36
    v_add_f32 v81, v81, v29
    v_sub_f32 v36, v32, v62
    v_sub_f32 v29, v41, v31
    v_add_f32 v32, v32, v62
    v_add_f32 v41, v41, v31
    v_mul_f32 v62, 0xbf3504f3, v36
    v_mul_f32 v31, 0x3f3504f3, v36
    v_fmac_f32 v62, 0xbf3504f3, v29
    v_fmac_f32 v31, 0xbf3504f3, v29
    v_sub_f32 v36, v50, v56
    v_sub_f32 v29, v49, v55
    v_add_f32 v50, v50, v56
    v_add_f32 v49, v49, v55
    v_sub_f32 v56, v18, v74
    v_sub_f32 v55, v67, v21
    v_add_f32 v18, v18, v74
    v_add_f32 v67, v67, v21
    v_mul_f32 v74, 0x3f3504f3, v56
    v_mul_f32 v21, 0x3f3504f3, v56
    v_fmac_f32 v74, 0xbf3504f3, v55
    v_fmac_f32 v21, 0x3f3504f3, v55
    v_sub_f32 v56, v69, v37
    v_sub_f32 v55, v64, v42
    v_add_f32 v64, v64, v42
    v_add_f32 v37, v37, v69
    v_sub_f32 v42, v66, v58
    v_sub_f32 v69, v35, v51
    v_add_f32 v66, v66, v58
    v_add_f32 v35, v35, v51
    v_mul_f32 v58, 0xbf3504f3, v42
    v_mul_f32 v51, 0x3f3504f3, v42
    v_fmac_f32 v58, 0xbf3504f3, v69
    v_fmac_f32 v51, 0xbf3504f3, v69
    v_sub_f32 v42, v24, v60
    v_sub_f32 v69, v75, v19
    v_add_f32 v24, v24, v60
    v_add_f32 v75, v75, v19
    v_sub_f32 v60, v72, v16
    v_sub_f32 v19, v43, v73
    v_add_f32 v72, v72, v16
    v_add_f32 v43, v43, v73
    v_mul_f32 v16, 0x3f3504f3, v60
    v_mul_f32 v73, 0x3f3504f3, v60
    v_fmac_f32 v16, 0xbf3504f3, v19
    v_fmac_f32 v73, 0x3f3504f3, v19
    v_sub_f32 v60, v61, v27
    v_sub_f32 v19, v54, v34
    v_add_f32 v54, v54, v34
    v_add_f32 v27, v27, v61
    v_sub_f32 v34, v48, v52
    v_sub_f32 v61, v65, v47
    v_add_f32 v48, v48, v52
    v_add_f32 v65, v65, v47
    v_mul_f32 v52, 0xbf3504f3, v34
    v_mul_f32 v47, 0x3f3504f3, v34
    v_fmac_f32 v52, 0xbf3504f3, v61
    v_fmac_f32 v47, 0xbf3504f3, v61
    v_sub_f32 v34, v80, v83
    v_sub_f32 v61, v23, v59
    v_add_f32 v80, v80, v83
    v_add_f32 v23, v23, v59
    v_sub_f32 v83, v26, v68
    v_sub_f32 v59, v77, v25
    v_add_f32 v26, v26, v68
    v_add_f32 v77, v77, v25
    v_mul_f32 v68, 0x3f3504f3, v83
    v_mul_f32 v25, 0x3f3504f3, v83
    v_fmac_f32 v68, 0xbf3504f3, v59
    v_fmac_f32 v25, 0x3f3504f3, v59
    v_sub_f32 v83, v57, v71
    v_sub_f32 v59, v30, v40
    v_add_f32 v30, v30, v40
    v_add_f32 v71, v71, v57
    v_sub_f32 v40, v44, v28
    v_sub_f32 v57, v33, v53
    v_add_f32 v44, v44, v28
    v_add_f32 v33, v33, v53
    v_mul_f32 v28, 0xbf3504f3, v40
    v_mul_f32 v53, 0x3f3504f3, v40
    v_fmac_f32 v28, 0xbf3504f3, v57
    v_fmac_f32 v53, 0xbf3504f3, v57
    v_sub_f32 v40, v20, v70
    v_sub_f32 v57, v17, v81
    v_add_f32 v20, v20, v70
    v_add_f32 v17, v17, v81
    v_sub_f32 v70, v41, v79
    v_sub_f32 v81, v82, v32
    v_add_f32 v82, v82, v32
    v_add_f32 v79, v79, v41
    v_sub_f32 v32, v46, v38
    v_sub_f32 v41, v39, v45
    v_add_f32 v46, v46, v38
    v_add_f32 v39, v39, v45
    v_sub_f32 v38, v31, v63
    v_sub_f32 v45, v78, v62
    v_add_f32 v78, v78, v62
    v_add_f32 v63, v63, v31
    v_sub_f32 v62, v50, v64
    v_sub_f32 v31, v49, v37
    v_add_f32 v50, v50, v64
    v_add_f32 v49, v49, v37
    v_sub_f32 v64, v35, v67
    v_sub_f32 v37, v18, v66
    v_add_f32 v18, v18, v66
    v_add_f32 v67, v67, v35
    v_sub_f32 v66, v36, v56
    v_sub_f32 v35, v29, v55
    v_add_f32 v36, v36, v56
    v_add_f32 v29, v29, v55
    v_sub_f32 v56, v51, v21
    v_sub_f32 v55, v74, v58
    v_add_f32 v74, v74, v58
    v_add_f32 v21, v21, v51
    v_sub_f32 v58, v24, v54
    v_sub_f32 v51, v75, v27
    v_add_f32 v24, v24, v54
    v_add_f32 v75, v75, v27
    v_sub_f32 v54, v65, v43
    v_sub_f32 v27, v72, v48
    v_add_f32 v72, v72, v48
    v_add_f32 v43, v43, v65
    v_sub_f32 v48, v42, v60
    v_sub_f32 v65, v69, v19
    v_add_f32 v42, v42, v60
    v_add_f32 v69, v69, v19
    v_sub_f32 v60, v47, v73
    v_sub_f32 v19, v16, v52
    v_add_f32 v16, v16, v52
    v_add_f32 v73, v73, v47
    v_sub_f32 v52, v80, v30
    v_sub_f32 v47, v23, v71
    v_add_f32 v80, v80, v30
    v_add_f32 v23, v23, v71
    v_sub_f32 v30, v33, v77
    v_sub_f32 v71, v26, v44
    v_add_f32 v26, v26, v44
    v_add_f32 v77, v77, v33
    v_sub_f32 v44, v34, v83
    v_sub_f32 v33, v61, v59
    v_add_f32 v34, v34, v83
    v_add_f32 v61, v61, v59
    v_sub_f32 v83, v53, v25
    v_sub_f32 v59, v68, v28
    v_add_f32 v68, v68, v28
    v_add_f32 v25, v25, v53
    v_sub_f32 v28, v20, v82
    v_sub_f32 v53, v17, v79
    v_add_f32 v20, v20, v82
    v_add_f32 v17, v17, v79
    v_sub_f32 v82, v40, v70
    v_sub_f32 v79, v57, v81
    v_add_f32 v40, v40, v70
    v_add_f32 v57, v57, v81
    v_sub_f32 v70, v46, v78
    v_sub_f32 v81, v39, v63
    v_add_f32 v46, v46, v78
    v_add_f32 v39, v39, v63
    v_sub_f32 v78, v32, v38
    v_sub_f32 v63, v41, v45
    v_add_f32 v32, v32, v38
    v_add_f32 v41, v41, v45
    v_sub_f32 v38, v50, v18
    v_sub_f32 v45, v49, v67
    v_add_f32 v50, v50, v18
    v_add_f32 v49, v49, v67
    v_sub_f32 v18, v62, v64
    v_sub_f32 v67, v31, v37
    v_add_f32 v62, v62, v64
    v_add_f32 v31, v31, v37
    v_sub_f32 v64, v36, v74
    v_sub_f32 v37, v29, v21
    v_add_f32 v36, v36, v74
    v_add_f32 v29, v29, v21
    v_sub_f32 v74, v66, v56
    v_sub_f32 v21, v35, v55
    v_add_f32 v66, v66, v56
    v_add_f32 v35, v35, v55
    v_sub_f32 v56, v24, v72
    v_sub_f32 v55, v75, v43
    v_add_f32 v24, v24, v72
    v_add_f32 v75, v75, v43
    v_sub_f32 v72, v58, v54
    v_sub_f32 v43, v51, v27
    v_add_f32 v58, v58, v54
    v_add_f32 v51, v51, v27
    v_sub_f32 v54, v42, v16
    v_sub_f32 v27, v69, v73
    v_add_f32 v42, v42, v16
    v_add_f32 v69, v69, v73
    v_sub_f32 v16, v48, v60
    v_sub_f32 v73, v65, v19
    v_add_f32 v48, v48, v60
    v_add_f32 v65, v65, v19
    v_sub_f32 v60, v80, v26
    v_sub_f32 v19, v23, v77
    v_add_f32 v80, v80, v26
    v_add_f32 v23, v23, v77
    v_sub_f32 v26, v52, v30
    v_sub_f32 v77, v47, v71
    v_add_f32 v52, v52, v30
    v_add_f32 v47, v47, v71
    v_sub_f32 v30, v34, v68
    v_sub_f32 v71, v61, v25
    v_add_f32 v34, v34, v68
    v_add_f32 v61, v61, v25
    v_sub_f32 v68, v44, v83
    v_sub_f32 v25, v33, v59
    v_add_f32 v44, v44, v83
    v_add_f32 v33, v33, v59
    s_add_u32 s15, s14, 109051904
    v_lshlrev_b32 v5, 3, v1
    s_add_u32 s16, s15, 0
    v_mov_b32 v88, v20
    v_mov_b32 v89, v17
    buffer_store_dwordx2 v[88:89], v5, s[8:11], s16 offen sc1
    s_add_u32 s16, s15, 512
    v_mov_b32 v90, v24
    v_mov_b32 v91, v75
    buffer_store_dwordx2 v[90:91], v5, s[8:11], s16 offen sc1
    s_add_u32 s16, s15, 1024
    v_mov_b32 v92, v50
    v_mov_b32 v93, v49
    buffer_store_dwordx2 v[92:93], v5, s[8:11], s16 offen sc1
    s_add_u32 s16, s15, 1536
    v_mov_b32 v94, v80
    v_mov_b32 v95, v23
    buffer_store_dwordx2 v[94:95], v5, s[8:11], s16 offen sc1
    s_add_u32 s16, s15, 2048
    v_mov_b32 v96, v46
    v_mov_b32 v97, v39
    buffer_store_dwordx2 v[96:97], v5, s[8:11], s16 offen sc1
    s_add_u32 s16, s15, 2560
    v_mov_b32 v98, v42
    v_mov_b32 v99, v69
    buffer_store_dwordx2 v[98:99], v5, s[8:11], s16 offen sc1
    s_add_u32 s16, s15, 3072
    v_mov_b32 v100, v36
    v_mov_b32 v101, v29
    buffer_store_dwordx2 v[100:101], v5, s[8:11], s16 offen sc1
    s_add_u32 s16, s15, 3584
    v_mov_b32 v102, v34
    v_mov_b32 v103, v61
    buffer_store_dwordx2 v[102:103], v5, s[8:11], s16 offen sc1
    s_add_u32 s16, s15, 4096
    v_mov_b32 v88, v40
    v_mov_b32 v89, v57
    buffer_store_dwordx2 v[88:89], v5, s[8:11], s16 offen sc1
    s_add_u32 s16, s15, 4608
    v_mov_b32 v90, v58
    v_mov_b32 v91, v51
    buffer_store_dwordx2 v[90:91], v5, s[8:11], s16 offen sc1
    s_add_u32 s16, s15, 5120
    v_mov_b32 v92, v62
    v_mov_b32 v93, v31
    buffer_store_dwordx2 v[92:93], v5, s[8:11], s16 offen sc1
    s_add_u32 s16, s15, 5632
    v_mov_b32 v94, v52
    v_mov_b32 v95, v47
    buffer_store_dwordx2 v[94:95], v5, s[8:11], s16 offen sc1
    s_add_u32 s16, s15, 6144
    v_mov_b32 v96, v32
    v_mov_b32 v97, v41
    buffer_store_dwordx2 v[96:97], v5, s[8:11], s16 offen sc1
    s_add_u32 s16, s15, 6656
    v_mov_b32 v98, v48
    v_mov_b32 v99, v65
    buffer_store_dwordx2 v[98:99], v5, s[8:11], s16 offen sc1
    s_add_u32 s16, s15, 7168
    v_mov_b32 v100, v66
    v_mov_b32 v101, v35
    buffer_store_dwordx2 v[100:101], v5, s[8:11], s16 offen sc1
    s_add_u32 s16, s15, 7680
    v_mov_b32 v102, v44
    v_mov_b32 v103, v33
    buffer_store_dwordx2 v[102:103], v5, s[8:11], s16 offen sc1
    s_add_u32 s16, s15, 8192
    v_mov_b32 v88, v28
    v_mov_b32 v89, v53
    buffer_store_dwordx2 v[88:89], v5, s[8:11], s16 offen sc1
    s_add_u32 s16, s15, 8704
    v_mov_b32 v90, v56
    v_mov_b32 v91, v55
    buffer_store_dwordx2 v[90:91], v5, s[8:11], s16 offen sc1
    s_add_u32 s16, s15, 9216
    v_mov_b32 v92, v38
    v_mov_b32 v93, v45
    buffer_store_dwordx2 v[92:93], v5, s[8:11], s16 offen sc1
    s_add_u32 s16, s15, 9728
    v_mov_b32 v94, v60
    v_mov_b32 v95, v19
    buffer_store_dwordx2 v[94:95], v5, s[8:11], s16 offen sc1
    s_add_u32 s16, s15, 10240
    v_mov_b32 v96, v70
    v_mov_b32 v97, v81
    buffer_store_dwordx2 v[96:97], v5, s[8:11], s16 offen sc1
    s_add_u32 s16, s15, 10752
    v_mov_b32 v98, v54
    v_mov_b32 v99, v27
    buffer_store_dwordx2 v[98:99], v5, s[8:11], s16 offen sc1
    s_add_u32 s16, s15, 11264
    v_mov_b32 v100, v64
    v_mov_b32 v101, v37
    buffer_store_dwordx2 v[100:101], v5, s[8:11], s16 offen sc1
    s_add_u32 s16, s15, 11776
    v_mov_b32 v102, v30
    v_mov_b32 v103, v71
    buffer_store_dwordx2 v[102:103], v5, s[8:11], s16 offen sc1
    s_add_u32 s16, s15, 12288
    v_mov_b32 v88, v82
    v_mov_b32 v89, v79
    buffer_store_dwordx2 v[88:89], v5, s[8:11], s16 offen sc1
    s_add_u32 s16, s15, 12800
    v_mov_b32 v90, v72
    v_mov_b32 v91, v43
    buffer_store_dwordx2 v[90:91], v5, s[8:11], s16 offen sc1
    s_add_u32 s16, s15, 13312
    v_mov_b32 v92, v18
    v_mov_b32 v93, v67
    buffer_store_dwordx2 v[92:93], v5, s[8:11], s16 offen sc1
    s_add_u32 s16, s15, 13824
    v_mov_b32 v94, v26
    v_mov_b32 v95, v77
    buffer_store_dwordx2 v[94:95], v5, s[8:11], s16 offen sc1
    s_add_u32 s16, s15, 14336
    v_mov_b32 v96, v78
    v_mov_b32 v97, v63
    buffer_store_dwordx2 v[96:97], v5, s[8:11], s16 offen sc1
    s_add_u32 s16, s15, 14848
    v_mov_b32 v98, v16
    v_mov_b32 v99, v73
    buffer_store_dwordx2 v[98:99], v5, s[8:11], s16 offen sc1
    s_add_u32 s16, s15, 15360
    v_mov_b32 v100, v74
    v_mov_b32 v101, v21
    buffer_store_dwordx2 v[100:101], v5, s[8:11], s16 offen sc1
    s_add_u32 s16, s15, 15872
    v_mov_b32 v102, v68
    v_mov_b32 v103, v25
    buffer_store_dwordx2 v[102:103], v5, s[8:11], s16 offen sc1
mega_kernel_f2_end:
    s_add_u32 s93, s93, s39
    s_cmp_lt_u32 s93, s37
    s_cbranch_scc1 mega_kernel_f2l
mega_kernel_f2e:
    s_waitcnt vmcnt(0)
    s_barrier
    v_mov_b32 v1, 0
    v_mov_b32 v2, 1
    s_mov_b32 s82, 69259392
    v_cmp_eq_u32 vcc, 0, v0
    s_and_saveexec_b64 s[80:81], vcc
    s_cbranch_execz mega_kernel_sg1
    buffer_atomic_add v2, v1, s[84:87], s82 offen sc1
    mega_kernel_sg1:
    s_mov_b64 exec, s[80:81]
    s_cmp_eq_u32 s91, 3
    s_cbranch_scc0 mega_kernel_f3s
    s_load_dwordx2 s[4:5], s[0:1], 40
    s_load_dwordx2 s[8:9], s[0:1], 80
    v_lshrrev_b32 v2, 6, v0
    v_and_b32 v1, 63, v0
    v_readfirstlane_b32 s41, v2
    v_lshlrev_b32 v5, 4, v1
    s_waitcnt lgkmcnt(0)
    s_mov_b32 s6, 8388608
    s_mov_b32 s7, 0x00020000
    s_mov_b32 s10, 8388608
    s_mov_b32 s11, 0x00020000
    s_and_b32 s58, s40, 1
    s_lshr_b32 s59, s40, 1
    s_lshl_b32 s43, s58, 22
    s_lshl_b32 s44, s41, 20
    s_add_u32 s43, s43, s44
    s_lshl_b32 s44, s59, 7
    s_add_u32 s48, s43, s44
    s_and_b32 s56, s59, 3
    s_lshl_b32 s56, s56, 7
    v_lshrrev_b32 v2, 3, v1
    v_and_b32 v3, 7, v1
    v_lshlrev_b32 v16, 11, v2
    v_lshl_add_u32 v16, v3, 4, v16
    v_add_u32 v16, s48, v16
    v_and_b32 v3, 3, v1
    s_lshl_b32 s45, s41, 15
    v_bfe_u32 v17, v1, 2, 2
    v_lshrrev_b32 v18, 5, v1
    v_mul_u32_u24 v18, 4, v18
    v_add_u32 v17, v17, v18
    v_lshlrev_b32 v17, 7, v17
    v_bfe_u32 v18, v1, 4, 1
    v_lshl_add_u32 v17, v18, 5, v17
    v_lshl_add_u32 v17, v3, 3, v17
    v_add_u32 v17, s45, v17
    s_add_u32 m0, s45, 0
    s_add_u32 s44, s56, 0
    s_and_b32 s44, s44, 511
    s_lshl_b32 s44, s44, 11
    buffer_load_dwordx4 v16, s[4:7], s44 offen lds
    s_add_u32 m0, s45, 1024
    s_add_u32 s44, s56, 8
    s_and_b32 s44, s44, 511
    s_lshl_b32 s44, s44, 11
    buffer_load_dwordx4 v16, s[4:7], s44 offen lds
    s_add_u32 m0, s45, 2048
    s_add_u32 s44, s56, 16
    s_and_b32 s44, s44, 511
    s_lshl_b32 s44, s44, 11
    buffer_load_dwordx4 v16, s[4:7], s44 offen lds
    s_add_u32 m0, s45, 3072
    s_add_u32 s44, s56, 24
    s_and_b32 s44, s44, 511
    s_lshl_b32 s44, s44, 11
    buffer_load_dwordx4 v16, s[4:7], s44 offen lds
    s_add_u32 m0, s45, 4096
    s_add_u32 s44, s56, 32
    s_and_b32 s44, s44, 511
    s_lshl_b32 s44, s44, 11
    buffer_load_dwordx4 v16, s[4:7], s44 offen lds
    s_add_u32 m0, s45, 5120
    s_add_u32 s44, s56, 40
    s_and_b32 s44, s44, 511
    s_lshl_b32 s44, s44, 11
    buffer_load_dwordx4 v16, s[4:7], s44 offen lds
    s_add_u32 m0, s45, 6144
    s_add_u32 s44, s56, 48
    s_and_b32 s44, s44, 511
    s_lshl_b32 s44, s44, 11
    buffer_load_dwordx4 v16, s[4:7], s44 offen lds
    s_add_u32 m0, s45, 7168
    s_add_u32 s44, s56, 56
    s_and_b32 s44, s44, 511
    s_lshl_b32 s44, s44, 11
    buffer_load_dwordx4 v16, s[4:7], s44 offen lds
    s_add_u32 m0, s45, 8192
    s_add_u32 s44, s56, 64
    s_and_b32 s44, s44, 511
    s_lshl_b32 s44, s44, 11
    buffer_load_dwordx4 v16, s[4:7], s44 offen lds
    s_add_u32 m0, s45, 9216
    s_add_u32 s44, s56, 72
    s_and_b32 s44, s44, 511
    s_lshl_b32 s44, s44, 11
    buffer_load_dwordx4 v16, s[4:7], s44 offen lds
    s_add_u32 m0, s45, 10240
    s_add_u32 s44, s56, 80
    s_and_b32 s44, s44, 511
    s_lshl_b32 s44, s44, 11
    buffer_load_dwordx4 v16, s[4:7], s44 offen lds
    s_add_u32 m0, s45, 11264
    s_add_u32 s44, s56, 88
    s_and_b32 s44, s44, 511
    s_lshl_b32 s44, s44, 11
    buffer_load_dwordx4 v16, s[4:7], s44 offen lds
    s_add_u32 m0, s45, 12288
    s_add_u32 s44, s56, 96
    s_and_b32 s44, s44, 511
    s_lshl_b32 s44, s44, 11
    buffer_load_dwordx4 v16, s[4:7], s44 offen lds
    s_add_u32 m0, s45, 13312
    s_add_u32 s44, s56, 104
    s_and_b32 s44, s44, 511
    s_lshl_b32 s44, s44, 11
    buffer_load_dwordx4 v16, s[4:7], s44 offen lds
    s_add_u32 m0, s45, 14336
    s_add_u32 s44, s56, 112
    s_and_b32 s44, s44, 511
    s_lshl_b32 s44, s44, 11
    buffer_load_dwordx4 v16, s[4:7], s44 offen lds
    s_add_u32 m0, s45, 15360
    s_add_u32 s44, s56, 120
    s_and_b32 s44, s44, 511
    s_lshl_b32 s44, s44, 11
    buffer_load_dwordx4 v16, s[4:7], s44 offen lds
    s_add_u32 m0, s45, 16384
    s_add_u32 s44, s56, 128
    s_and_b32 s44, s44, 511
    s_lshl_b32 s44, s44, 11
    buffer_load_dwordx4 v16, s[4:7], s44 offen lds
    s_add_u32 m0, s45, 17408
    s_add_u32 s44, s56, 136
    s_and_b32 s44, s44, 511
    s_lshl_b32 s44, s44, 11
    buffer_load_dwordx4 v16, s[4:7], s44 offen lds
    s_add_u32 m0, s45, 18432
    s_add_u32 s44, s56, 144
    s_and_b32 s44, s44, 511
    s_lshl_b32 s44, s44, 11
    buffer_load_dwordx4 v16, s[4:7], s44 offen lds
    s_add_u32 m0, s45, 19456
    s_add_u32 s44, s56, 152
    s_and_b32 s44, s44, 511
    s_lshl_b32 s44, s44, 11
    buffer_load_dwordx4 v16, s[4:7], s44 offen lds
    s_add_u32 m0, s45, 20480
    s_add_u32 s44, s56, 160
    s_and_b32 s44, s44, 511
    s_lshl_b32 s44, s44, 11
    buffer_load_dwordx4 v16, s[4:7], s44 offen lds
    s_add_u32 m0, s45, 21504
    s_add_u32 s44, s56, 168
    s_and_b32 s44, s44, 511
    s_lshl_b32 s44, s44, 11
    buffer_load_dwordx4 v16, s[4:7], s44 offen lds
    s_add_u32 m0, s45, 22528
    s_add_u32 s44, s56, 176
    s_and_b32 s44, s44, 511
    s_lshl_b32 s44, s44, 11
    buffer_load_dwordx4 v16, s[4:7], s44 offen lds
    s_add_u32 m0, s45, 23552
    s_add_u32 s44, s56, 184
    s_and_b32 s44, s44, 511
    s_lshl_b32 s44, s44, 11
    buffer_load_dwordx4 v16, s[4:7], s44 offen lds
    s_add_u32 m0, s45, 24576
    s_add_u32 s44, s56, 192
    s_and_b32 s44, s44, 511
    s_lshl_b32 s44, s44, 11
    buffer_load_dwordx4 v16, s[4:7], s44 offen lds
    s_add_u32 m0, s45, 25600
    s_add_u32 s44, s56, 200
    s_and_b32 s44, s44, 511
    s_lshl_b32 s44, s44, 11
    buffer_load_dwordx4 v16, s[4:7], s44 offen lds
    s_add_u32 m0, s45, 26624
    s_add_u32 s44, s56, 208
    s_and_b32 s44, s44, 511
    s_lshl_b32 s44, s44, 11
    buffer_load_dwordx4 v16, s[4:7], s44 offen lds
    s_add_u32 m0, s45, 27648
    s_add_u32 s44, s56, 216
    s_and_b32 s44, s44, 511
    s_lshl_b32 s44, s44, 11
    buffer_load_dwordx4 v16, s[4:7], s44 offen lds
    s_add_u32 m0, s45, 28672
    s_add_u32 s44, s56, 224
    s_and_b32 s44, s44, 511
    s_lshl_b32 s44, s44, 11
    buffer_load_dwordx4 v16, s[4:7], s44 offen lds
    s_add_u32 m0, s45, 29696
    s_add_u32 s44, s56, 232
    s_and_b32 s44, s44, 511
    s_lshl_b32 s44, s44, 11
    buffer_load_dwordx4 v16, s[4:7], s44 offen lds
    s_add_u32 m0, s45, 30720
    s_add_u32 s44, s56, 240
    s_and_b32 s44, s44, 511
    s_lshl_b32 s44, s44, 11
    buffer_load_dwordx4 v16, s[4:7], s44 offen lds
    s_add_u32 m0, s45, 31744
    s_add_u32 s44, s56, 248
    s_and_b32 s44, s44, 511
    s_lshl_b32 s44, s44, 11
    buffer_load_dwordx4 v16, s[4:7], s44 offen lds
    s_waitcnt vmcnt(16)
    ds_read_b64_tr_b16 a[0:1], v17 offset:0
    ds_read_b64_tr_b16 a[2:3], v17 offset:2048
    ds_read_b64_tr_b16 a[4:5], v17 offset:64
    ds_read_b64_tr_b16 a[6:7], v17 offset:2112
    ds_read_b64_tr_b16 a[8:9], v17 offset:1024
    ds_read_b64_tr_b16 a[10:11], v17 offset:3072
    ds_read_b64_tr_b16 a[12:13], v17 offset:1088
    ds_read_b64_tr_b16 a[14:15], v17 offset:3136
    s_waitcnt lgkmcnt(0)
    ds_read_b64_tr_b16 a[16:17], v17 offset:4096
    ds_read_b64_tr_b16 a[18:19], v17 offset:6144
    ds_read_b64_tr_b16 a[20:21], v17 offset:4160
    ds_read_b64_tr_b16 a[22:23], v17 offset:6208
    ds_read_b64_tr_b16 a[24:25], v17 offset:5120
    ds_read_b64_tr_b16 a[26:27], v17 offset:7168
    ds_read_b64_tr_b16 a[28:29], v17 offset:5184
    ds_read_b64_tr_b16 a[30:31], v17 offset:7232
    s_waitcnt lgkmcnt(0)
    ds_read_b64_tr_b16 a[32:33], v17 offset:8192
    ds_read_b64_tr_b16 a[34:35], v17 offset:10240
    ds_read_b64_tr_b16 a[36:37], v17 offset:8256
    ds_read_b64_tr_b16 a[38:39], v17 offset:10304
    ds_read_b64_tr_b16 a[40:41], v17 offset:9216
    ds_read_b64_tr_b16 a[42:43], v17 offset:11264
    ds_read_b64_tr_b16 a[44:45], v17 offset:9280
    ds_read_b64_tr_b16 a[46:47], v17 offset:11328
    s_waitcnt lgkmcnt(0)
    ds_read_b64_tr_b16 a[48:49], v17 offset:12288
    ds_read_b64_tr_b16 a[50:51], v17 offset:14336
    ds_read_b64_tr_b16 a[52:53], v17 offset:12352
    ds_read_b64_tr_b16 a[54:55], v17 offset:14400
    ds_read_b64_tr_b16 a[56:57], v17 offset:13312
    ds_read_b64_tr_b16 a[58:59], v17 offset:15360
    ds_read_b64_tr_b16 a[60:61], v17 offset:13376
    ds_read_b64_tr_b16 a[62:63], v17 offset:15424
    s_waitcnt lgkmcnt(0)
    s_add_u32 m0, s45, 0
    s_add_u32 s44, s56, 256
    s_and_b32 s44, s44, 511
    s_lshl_b32 s44, s44, 11
    buffer_load_dwordx4 v16, s[4:7], s44 offen lds
    s_add_u32 m0, s45, 1024
    s_add_u32 s44, s56, 264
    s_and_b32 s44, s44, 511
    s_lshl_b32 s44, s44, 11
    buffer_load_dwordx4 v16, s[4:7], s44 offen lds
    s_add_u32 m0, s45, 2048
    s_add_u32 s44, s56, 272
    s_and_b32 s44, s44, 511
    s_lshl_b32 s44, s44, 11
    buffer_load_dwordx4 v16, s[4:7], s44 offen lds
    s_add_u32 m0, s45, 3072
    s_add_u32 s44, s56, 280
    s_and_b32 s44, s44, 511
    s_lshl_b32 s44, s44, 11
    buffer_load_dwordx4 v16, s[4:7], s44 offen lds
    s_add_u32 m0, s45, 4096
    s_add_u32 s44, s56, 288
    s_and_b32 s44, s44, 511
    s_lshl_b32 s44, s44, 11
    buffer_load_dwordx4 v16, s[4:7], s44 offen lds
    s_add_u32 m0, s45, 5120
    s_add_u32 s44, s56, 296
    s_and_b32 s44, s44, 511
    s_lshl_b32 s44, s44, 11
    buffer_load_dwordx4 v16, s[4:7], s44 offen lds
    s_add_u32 m0, s45, 6144
    s_add_u32 s44, s56, 304
    s_and_b32 s44, s44, 511
    s_lshl_b32 s44, s44, 11
    buffer_load_dwordx4 v16, s[4:7], s44 offen lds
    s_add_u32 m0, s45, 7168
    s_add_u32 s44, s56, 312
    s_and_b32 s44, s44, 511
    s_lshl_b32 s44, s44, 11
    buffer_load_dwordx4 v16, s[4:7], s44 offen lds
    s_add_u32 m0, s45, 8192
    s_add_u32 s44, s56, 320
    s_and_b32 s44, s44, 511
    s_lshl_b32 s44, s44, 11
    buffer_load_dwordx4 v16, s[4:7], s44 offen lds
    s_add_u32 m0, s45, 9216
    s_add_u32 s44, s56, 328
    s_and_b32 s44, s44, 511
    s_lshl_b32 s44, s44, 11
    buffer_load_dwordx4 v16, s[4:7], s44 offen lds
    s_add_u32 m0, s45, 10240
    s_add_u32 s44, s56, 336
    s_and_b32 s44, s44, 511
    s_lshl_b32 s44, s44, 11
    buffer_load_dwordx4 v16, s[4:7], s44 offen lds
    s_add_u32 m0, s45, 11264
    s_add_u32 s44, s56, 344
    s_and_b32 s44, s44, 511
    s_lshl_b32 s44, s44, 11
    buffer_load_dwordx4 v16, s[4:7], s44 offen lds
    s_add_u32 m0, s45, 12288
    s_add_u32 s44, s56, 352
    s_and_b32 s44, s44, 511
    s_lshl_b32 s44, s44, 11
    buffer_load_dwordx4 v16, s[4:7], s44 offen lds
    s_add_u32 m0, s45, 13312
    s_add_u32 s44, s56, 360
    s_and_b32 s44, s44, 511
    s_lshl_b32 s44, s44, 11
    buffer_load_dwordx4 v16, s[4:7], s44 offen lds
    s_add_u32 m0, s45, 14336
    s_add_u32 s44, s56, 368
    s_and_b32 s44, s44, 511
    s_lshl_b32 s44, s44, 11
    buffer_load_dwordx4 v16, s[4:7], s44 offen lds
    s_add_u32 m0, s45, 15360
    s_add_u32 s44, s56, 376
    s_and_b32 s44, s44, 511
    s_lshl_b32 s44, s44, 11
    buffer_load_dwordx4 v16, s[4:7], s44 offen lds
    s_waitcnt vmcnt(16)
    ds_read_b64_tr_b16 a[64:65], v17 offset:16384
    ds_read_b64_tr_b16 a[66:67], v17 offset:18432
    ds_read_b64_tr_b16 a[68:69], v17 offset:16448
    ds_read_b64_tr_b16 a[70:71], v17 offset:18496
    ds_read_b64_tr_b16 a[72:73], v17 offset:17408
    ds_read_b64_tr_b16 a[74:75], v17 offset:19456
    ds_read_b64_tr_b16 a[76:77], v17 offset:17472
    ds_read_b64_tr_b16 a[78:79], v17 offset:19520
    s_waitcnt lgkmcnt(0)
    ds_read_b64_tr_b16 a[80:81], v17 offset:20480
    ds_read_b64_tr_b16 a[82:83], v17 offset:22528
    ds_read_b64_tr_b16 a[84:85], v17 offset:20544
    ds_read_b64_tr_b16 a[86:87], v17 offset:22592
    ds_read_b64_tr_b16 a[88:89], v17 offset:21504
    ds_read_b64_tr_b16 a[90:91], v17 offset:23552
    ds_read_b64_tr_b16 a[92:93], v17 offset:21568
    ds_read_b64_tr_b16 a[94:95], v17 offset:23616
    s_waitcnt lgkmcnt(0)
    ds_read_b64_tr_b16 a[96:97], v17 offset:24576
    ds_read_b64_tr_b16 a[98:99], v17 offset:26624
    ds_read_b64_tr_b16 a[100:101], v17 offset:24640
    ds_read_b64_tr_b16 a[102:103], v17 offset:26688
    ds_read_b64_tr_b16 a[104:105], v17 offset:25600
    ds_read_b64_tr_b16 a[106:107], v17 offset:27648
    ds_read_b64_tr_b16 a[108:109], v17 offset:25664
    ds_read_b64_tr_b16 a[110:111], v17 offset:27712
    s_waitcnt lgkmcnt(0)
    ds_read_b64_tr_b16 a[112:113], v17 offset:28672
    ds_read_b64_tr_b16 a[114:115], v17 offset:30720
    ds_read_b64_tr_b16 a[116:117], v17 offset:28736
    ds_read_b64_tr_b16 a[118:119], v17 offset:30784
    ds_read_b64_tr_b16 a[120:121], v17 offset:29696
    ds_read_b64_tr_b16 a[122:123], v17 offset:31744
    ds_read_b64_tr_b16 a[124:125], v17 offset:29760
    ds_read_b64_tr_b16 a[126:127], v17 offset:31808
    s_waitcnt lgkmcnt(0)
    s_add_u32 m0, s45, 16384
    s_add_u32 s44, s56, 384
    s_and_b32 s44, s44, 511
    s_lshl_b32 s44, s44, 11
    buffer_load_dwordx4 v16, s[4:7], s44 offen lds
    s_add_u32 m0, s45, 17408
    s_add_u32 s44, s56, 392
    s_and_b32 s44, s44, 511
    s_lshl_b32 s44, s44, 11
    buffer_load_dwordx4 v16, s[4:7], s44 offen lds
    s_add_u32 m0, s45, 18432
    s_add_u32 s44, s56, 400
    s_and_b32 s44, s44, 511
    s_lshl_b32 s44, s44, 11
    buffer_load_dwordx4 v16, s[4:7], s44 offen lds
    s_add_u32 m0, s45, 19456
    s_add_u32 s44, s56, 408
    s_and_b32 s44, s44, 511
    s_lshl_b32 s44, s44, 11
    buffer_load_dwordx4 v16, s[4:7], s44 offen lds
    s_add_u32 m0, s45, 20480
    s_add_u32 s44, s56, 416
    s_and_b32 s44, s44, 511
    s_lshl_b32 s44, s44, 11
    buffer_load_dwordx4 v16, s[4:7], s44 offen lds
    s_add_u32 m0, s45, 21504
    s_add_u32 s44, s56, 424
    s_and_b32 s44, s44, 511
    s_lshl_b32 s44, s44, 11
    buffer_load_dwordx4 v16, s[4:7], s44 offen lds
    s_add_u32 m0, s45, 22528
    s_add_u32 s44, s56, 432
    s_and_b32 s44, s44, 511
    s_lshl_b32 s44, s44, 11
    buffer_load_dwordx4 v16, s[4:7], s44 offen lds
    s_add_u32 m0, s45, 23552
    s_add_u32 s44, s56, 440
    s_and_b32 s44, s44, 511
    s_lshl_b32 s44, s44, 11
    buffer_load_dwordx4 v16, s[4:7], s44 offen lds
    s_add_u32 m0, s45, 24576
    s_add_u32 s44, s56, 448
    s_and_b32 s44, s44, 511
    s_lshl_b32 s44, s44, 11
    buffer_load_dwordx4 v16, s[4:7], s44 offen lds
    s_add_u32 m0, s45, 25600
    s_add_u32 s44, s56, 456
    s_and_b32 s44, s44, 511
    s_lshl_b32 s44, s44, 11
    buffer_load_dwordx4 v16, s[4:7], s44 offen lds
    s_add_u32 m0, s45, 26624
    s_add_u32 s44, s56, 464
    s_and_b32 s44, s44, 511
    s_lshl_b32 s44, s44, 11
    buffer_load_dwordx4 v16, s[4:7], s44 offen lds
    s_add_u32 m0, s45, 27648
    s_add_u32 s44, s56, 472
    s_and_b32 s44, s44, 511
    s_lshl_b32 s44, s44, 11
    buffer_load_dwordx4 v16, s[4:7], s44 offen lds
    s_add_u32 m0, s45, 28672
    s_add_u32 s44, s56, 480
    s_and_b32 s44, s44, 511
    s_lshl_b32 s44, s44, 11
    buffer_load_dwordx4 v16, s[4:7], s44 offen lds
    s_add_u32 m0, s45, 29696
    s_add_u32 s44, s56, 488
    s_and_b32 s44, s44, 511
    s_lshl_b32 s44, s44, 11
    buffer_load_dwordx4 v16, s[4:7], s44 offen lds
    s_add_u32 m0, s45, 30720
    s_add_u32 s44, s56, 496
    s_and_b32 s44, s44, 511
    s_lshl_b32 s44, s44, 11
    buffer_load_dwordx4 v16, s[4:7], s44 offen lds
    s_add_u32 m0, s45, 31744
    s_add_u32 s44, s56, 504
    s_and_b32 s44, s44, 511
    s_lshl_b32 s44, s44, 11
    buffer_load_dwordx4 v16, s[4:7], s44 offen lds
    s_waitcnt vmcnt(16)
    ds_read_b64_tr_b16 a[128:129], v17 offset:0
    ds_read_b64_tr_b16 a[130:131], v17 offset:2048
    ds_read_b64_tr_b16 a[132:133], v17 offset:64
    ds_read_b64_tr_b16 a[134:135], v17 offset:2112
    ds_read_b64_tr_b16 a[136:137], v17 offset:1024
    ds_read_b64_tr_b16 a[138:139], v17 offset:3072
    ds_read_b64_tr_b16 a[140:141], v17 offset:1088
    ds_read_b64_tr_b16 a[142:143], v17 offset:3136
    s_waitcnt lgkmcnt(0)
    ds_read_b64_tr_b16 a[144:145], v17 offset:4096
    ds_read_b64_tr_b16 a[146:147], v17 offset:6144
    ds_read_b64_tr_b16 a[148:149], v17 offset:4160
    ds_read_b64_tr_b16 a[150:151], v17 offset:6208
    ds_read_b64_tr_b16 a[152:153], v17 offset:5120
    ds_read_b64_tr_b16 a[154:155], v17 offset:7168
    ds_read_b64_tr_b16 a[156:157], v17 offset:5184
    ds_read_b64_tr_b16 a[158:159], v17 offset:7232
    s_waitcnt lgkmcnt(0)
    ds_read_b64_tr_b16 a[160:161], v17 offset:8192
    ds_read_b64_tr_b16 a[162:163], v17 offset:10240
    ds_read_b64_tr_b16 a[164:165], v17 offset:8256
    ds_read_b64_tr_b16 a[166:167], v17 offset:10304
    ds_read_b64_tr_b16 a[168:169], v17 offset:9216
    ds_read_b64_tr_b16 a[170:171], v17 offset:11264
    ds_read_b64_tr_b16 a[172:173], v17 offset:9280
    ds_read_b64_tr_b16 a[174:175], v17 offset:11328
    s_waitcnt lgkmcnt(0)
    ds_read_b64_tr_b16 a[176:177], v17 offset:12288
    ds_read_b64_tr_b16 a[178:179], v17 offset:14336
    ds_read_b64_tr_b16 a[180:181], v17 offset:12352
    ds_read_b64_tr_b16 a[182:183], v17 offset:14400
    ds_read_b64_tr_b16 a[184:185], v17 offset:13312
    ds_read_b64_tr_b16 a[186:187], v17 offset:15360
    ds_read_b64_tr_b16 a[188:189], v17 offset:13376
    ds_read_b64_tr_b16 a[190:191], v17 offset:15424
    s_waitcnt lgkmcnt(0)
    s_waitcnt vmcnt(0)
    ds_read_b64_tr_b16 a[192:193], v17 offset:16384
    ds_read_b64_tr_b16 a[194:195], v17 offset:18432
    ds_read_b64_tr_b16 a[196:197], v17 offset:16448
    ds_read_b64_tr_b16 a[198:199], v17 offset:18496
    ds_read_b64_tr_b16 a[200:201], v17 offset:17408
    ds_read_b64_tr_b16 a[202:203], v17 offset:19456
    ds_read_b64_tr_b16 a[204:205], v17 offset:17472
    ds_read_b64_tr_b16 a[206:207], v17 offset:19520
    s_waitcnt lgkmcnt(0)
    ds_read_b64_tr_b16 a[208:209], v17 offset:20480
    ds_read_b64_tr_b16 a[210:211], v17 offset:22528
    ds_read_b64_tr_b16 a[212:213], v17 offset:20544
    ds_read_b64_tr_b16 a[214:215], v17 offset:22592
    ds_read_b64_tr_b16 a[216:217], v17 offset:21504
    ds_read_b64_tr_b16 a[218:219], v17 offset:23552
    ds_read_b64_tr_b16 a[220:221], v17 offset:21568
    ds_read_b64_tr_b16 a[222:223], v17 offset:23616
    s_waitcnt lgkmcnt(0)
    ds_read_b64_tr_b16 a[224:225], v17 offset:24576
    ds_read_b64_tr_b16 a[226:227], v17 offset:26624
    ds_read_b64_tr_b16 a[228:229], v17 offset:24640
    ds_read_b64_tr_b16 a[230:231], v17 offset:26688
    ds_read_b64_tr_b16 a[232:233], v17 offset:25600
    ds_read_b64_tr_b16 a[234:235], v17 offset:27648
    ds_read_b64_tr_b16 a[236:237], v17 offset:25664
    ds_read_b64_tr_b16 a[238:239], v17 offset:27712
    s_waitcnt lgkmcnt(0)
    ds_read_b64_tr_b16 a[240:241], v17 offset:28672
    ds_read_b64_tr_b16 a[242:243], v17 offset:30720
    ds_read_b64_tr_b16 a[244:245], v17 offset:28736
    ds_read_b64_tr_b16 a[246:247], v17 offset:30784
    ds_read_b64_tr_b16 a[248:249], v17 offset:29696
    ds_read_b64_tr_b16 a[250:251], v17 offset:31744
    ds_read_b64_tr_b16 a[252:253], v17 offset:29760
    ds_read_b64_tr_b16 a[254:255], v17 offset:31808
    s_waitcnt lgkmcnt(0)
    s_barrier
    s_lshl_b32 s56, s56, 6
    s_lshl_b32 s43, s58, 17
    s_lshl_b32 s44, s41, 15
    s_add_u32 s43, s43, s44
    s_add_u32 s43, s43, 134217728
    v_add_u32 v6, s43, v5
    v_and_b32 v2, 15, v1
    v_lshlrev_b32 v7, 2, v2
    s_lshl_b32 s43, s58, 8
    s_lshl_b32 s44, s41, 6
    s_add_u32 s43, s43, s44
    s_add_u32 s43, s43, 69255168
    v_add_u32 v7, s43, v7
    s_mul_i32 s43, s41, 8704
    v_lshrrev_b32 v2, 5, v1
    v_lshl_add_u32 v8, v2, 5, v5
    v_add_u32 v8, s43, v8
    v_and_b32 v2, 7, v1
    v_mul_u32_u24 v9, 544, v2
    v_lshrrev_b32 v3, 3, v1
    v_lshl_add_u32 v9, v3, 4, v9
    s_lshl_b32 s43, s41, 7
    v_add_u32 v9, s43, v9
    s_mul_i32 s43, s58, 4352
    s_sub_u32 s44, 4352, s43
    v_add_u32 v10, s44, v9
    v_add_u32 v9, s43, v9
    s_lshl_b32 s43, s41, 15
    s_lshl_b32 s44, s40, 6
    s_add_u32 s43, s43, s44
    v_lshlrev_b32 v11, 12, v3
    v_and_b32 v2, 7, v1
    v_lshl_add_u32 v11, v2, 3, v11
    v_add_u32 v11, s43, v11
    s_lshl_b32 s43, s40, 13
    s_lshl_b32 s44, s41, 10
    s_add_u32 s43, s43, s44
    s_add_u32 s43, s43, 67633152
    v_add_u32 v13, s43, v5
    v_xor_b32 v12, 8192, v13
    s_mov_b32 s42, 0
    s_mov_b32 s52, 0
    s_mov_b32 s53, 0
    s_mov_b32 s57, 0
mega_kernel_o_cold:
    s_cmp_gt_i32 s52, s42
    s_cbranch_scc1 mega_kernel_o_fk
mega_kernel_o_fw:
    buffer_load_dword v2, v7, s[84:87], 0 offen sc1
    s_waitcnt vmcnt(0)
    v_min_i32_dpp v2, v2, v2 quad_perm:[1,0,3,2] row_mask:0xf bank_mask:0xf
    s_nop 1
    v_min_i32_dpp v2, v2, v2 quad_perm:[2,3,0,1] row_mask:0xf bank_mask:0xf
    s_nop 1
    v_min_i32_dpp v2, v2, v2 row_ror:4 row_mask:0xf bank_mask:0xf
    s_nop 1
    v_min_i32_dpp v2, v2, v2 row_ror:8 row_mask:0xf bank_mask:0xf
    s_nop 0
    v_readfirstlane_b32 s52, v2
    s_cmp_gt_i32 s52, s42
    s_cbranch_scc1 mega_kernel_o_fk
    s_sleep 2
    s_branch mega_kernel_o_fw
mega_kernel_o_fk:
    s_lshl_b32 s50, s42, 18
    s_add_u32 s51, s56, 0
    s_and_b32 s51, s51, 0x7fff
    s_add_u32 s51, s51, s50
    buffer_load_dwordx4 v[96:99], v6, s[84:87], s51 offen offset:0 sc1
    buffer_load_dwordx4 v[100:103], v6, s[84:87], s51 offen offset:1024 sc1
    buffer_load_dwordx4 v[104:107], v6, s[84:87], s51 offen offset:2048 sc1
    buffer_load_dwordx4 v[108:111], v6, s[84:87], s51 offen offset:3072 sc1
    s_add_u32 s51, s56, 4096
    s_and_b32 s51, s51, 0x7fff
    s_add_u32 s51, s51, s50
    buffer_load_dwordx4 v[112:115], v6, s[84:87], s51 offen offset:0 sc1
    buffer_load_dwordx4 v[116:119], v6, s[84:87], s51 offen offset:1024 sc1
    buffer_load_dwordx4 v[120:123], v6, s[84:87], s51 offen offset:2048 sc1
    buffer_load_dwordx4 v[124:127], v6, s[84:87], s51 offen offset:3072 sc1
    s_add_u32 s51, s56, 8192
    s_and_b32 s51, s51, 0x7fff
    s_add_u32 s51, s51, s50
    buffer_load_dwordx4 v[128:131], v6, s[84:87], s51 offen offset:0 sc1
    buffer_load_dwordx4 v[132:135], v6, s[84:87], s51 offen offset:1024 sc1
    buffer_load_dwordx4 v[136:139], v6, s[84:87], s51 offen offset:2048 sc1
    buffer_load_dwordx4 v[140:143], v6, s[84:87], s51 offen offset:3072 sc1
    s_add_u32 s51, s56, 12288
    s_and_b32 s51, s51, 0x7fff
    s_add_u32 s51, s51, s50
    buffer_load_dwordx4 v[144:147], v6, s[84:87], s51 offen offset:0 sc1
    buffer_load_dwordx4 v[148:151], v6, s[84:87], s51 offen offset:1024 sc1
    buffer_load_dwordx4 v[152:155], v6, s[84:87], s51 offen offset:2048 sc1
    buffer_load_dwordx4 v[156:159], v6, s[84:87], s51 offen offset:3072 sc1
    s_add_u32 s51, s56, 16384
    s_and_b32 s51, s51, 0x7fff
    s_add_u32 s51, s51, s50
    buffer_load_dwordx4 v[160:163], v6, s[84:87], s51 offen offset:0 sc1
    buffer_load_dwordx4 v[164:167], v6, s[84:87], s51 offen offset:1024 sc1
    buffer_load_dwordx4 v[168:171], v6, s[84:87], s51 offen offset:2048 sc1
    buffer_load_dwordx4 v[172:175], v6, s[84:87], s51 offen offset:3072 sc1
    s_add_u32 s51, s56, 20480
    s_and_b32 s51, s51, 0x7fff
    s_add_u32 s51, s51, s50
    buffer_load_dwordx4 v[176:179], v6, s[84:87], s51 offen offset:0 sc1
    buffer_load_dwordx4 v[180:183], v6, s[84:87], s51 offen offset:1024 sc1
    buffer_load_dwordx4 v[184:187], v6, s[84:87], s51 offen offset:2048 sc1
    buffer_load_dwordx4 v[188:191], v6, s[84:87], s51 offen offset:3072 sc1
    s_add_u32 s51, s56, 24576
    s_and_b32 s51, s51, 0x7fff
    s_add_u32 s51, s51, s50
    buffer_load_dwordx4 v[192:195], v6, s[84:87], s51 offen offset:0 sc1
    buffer_load_dwordx4 v[196:199], v6, s[84:87], s51 offen offset:1024 sc1
    buffer_load_dwordx4 v[200:203], v6, s[84:87], s51 offen offset:2048 sc1
    buffer_load_dwordx4 v[204:207], v6, s[84:87], s51 offen offset:3072 sc1
    s_add_u32 s51, s56, 28672
    s_and_b32 s51, s51, 0x7fff
    s_add_u32 s51, s51, s50
    buffer_load_dwordx4 v[208:211], v6, s[84:87], s51 offen offset:0 sc1
    buffer_load_dwordx4 v[212:215], v6, s[84:87], s51 offen offset:1024 sc1
    buffer_load_dwordx4 v[216:219], v6, s[84:87], s51 offen offset:2048 sc1
    buffer_load_dwordx4 v[220:223], v6, s[84:87], s51 offen offset:3072 sc1
mega_kernel_o_w0:
    s_add_u32 s54, s42, 1
    s_sub_u32 s62, s42, 1
    s_lshl_b32 s50, s54, 18
    s_cmp_gt_i32 s52, s54
    s_cbranch_scc0 mega_kernel_o_n0
    s_waitcnt vmcnt(31)
    v_mfma_f32_32x32x16_bf16 v[20:35], a[0:3], v[96:99], 0
    v_mfma_f32_32x32x16_bf16 v[36:51], a[4:7], v[96:99], 0
    s_add_u32 s51, s56, 0
    s_and_b32 s51, s51, 0x7fff
    s_add_u32 s51, s51, s50
    buffer_load_dwordx4 v[96:99], v6, s[84:87], s51 offen offset:0 sc1
    s_waitcnt vmcnt(31)
    v_mfma_f32_32x32x16_bf16 v[20:35], a[8:11], v[100:103], v[20:35]
    v_mfma_f32_32x32x16_bf16 v[36:51], a[12:15], v[100:103], v[36:51]
    buffer_load_dwordx4 v[100:103], v6, s[84:87], s51 offen offset:1024 sc1
    s_waitcnt vmcnt(31)
    v_mfma_f32_32x32x16_bf16 v[20:35], a[16:19], v[104:107], v[20:35]
    v_mfma_f32_32x32x16_bf16 v[36:51], a[20:23], v[104:107], v[36:51]
    buffer_load_dwordx4 v[104:107], v6, s[84:87], s51 offen offset:2048 sc1
    s_waitcnt vmcnt(31)
    v_mfma_f32_32x32x16_bf16 v[20:35], a[24:27], v[108:111], v[20:35]
    v_mfma_f32_32x32x16_bf16 v[36:51], a[28:31], v[108:111], v[36:51]
    buffer_load_dwordx4 v[108:111], v6, s[84:87], s51 offen offset:3072 sc1
    s_waitcnt vmcnt(31)
    v_mfma_f32_32x32x16_bf16 v[20:35], a[32:35], v[112:115], v[20:35]
    v_mfma_f32_32x32x16_bf16 v[36:51], a[36:39], v[112:115], v[36:51]
    s_add_u32 s51, s56, 4096
    s_and_b32 s51, s51, 0x7fff
    s_add_u32 s51, s51, s50
    buffer_load_dwordx4 v[112:115], v6, s[84:87], s51 offen offset:0 sc1
    s_waitcnt vmcnt(31)
    v_mfma_f32_32x32x16_bf16 v[20:35], a[40:43], v[116:119], v[20:35]
    v_mfma_f32_32x32x16_bf16 v[36:51], a[44:47], v[116:119], v[36:51]
    buffer_load_dwordx4 v[116:119], v6, s[84:87], s51 offen offset:1024 sc1
    s_waitcnt vmcnt(31)
    v_mfma_f32_32x32x16_bf16 v[20:35], a[48:51], v[120:123], v[20:35]
    v_mfma_f32_32x32x16_bf16 v[36:51], a[52:55], v[120:123], v[36:51]
    buffer_load_dwordx4 v[120:123], v6, s[84:87], s51 offen offset:2048 sc1
    s_waitcnt vmcnt(31)
    v_mfma_f32_32x32x16_bf16 v[20:35], a[56:59], v[124:127], v[20:35]
    v_mfma_f32_32x32x16_bf16 v[36:51], a[60:63], v[124:127], v[36:51]
    buffer_load_dwordx4 v[124:127], v6, s[84:87], s51 offen offset:3072 sc1
    s_waitcnt vmcnt(31)
    v_mfma_f32_32x32x16_bf16 v[20:35], a[64:67], v[128:131], v[20:35]
    v_mfma_f32_32x32x16_bf16 v[36:51], a[68:71], v[128:131], v[36:51]
    s_add_u32 s51, s56, 8192
    s_and_b32 s51, s51, 0x7fff
    s_add_u32 s51, s51, s50
    buffer_load_dwordx4 v[128:131], v6, s[84:87], s51 offen offset:0 sc1
    s_waitcnt vmcnt(31)
    v_mfma_f32_32x32x16_bf16 v[20:35], a[72:75], v[132:135], v[20:35]
    v_mfma_f32_32x32x16_bf16 v[36:51], a[76:79], v[132:135], v[36:51]
    buffer_load_dwordx4 v[132:135], v6, s[84:87], s51 offen offset:1024 sc1
    s_waitcnt vmcnt(31)
    v_mfma_f32_32x32x16_bf16 v[20:35], a[80:83], v[136:139], v[20:35]
    v_mfma_f32_32x32x16_bf16 v[36:51], a[84:87], v[136:139], v[36:51]
    buffer_load_dwordx4 v[136:139], v6, s[84:87], s51 offen offset:2048 sc1
    s_waitcnt vmcnt(31)
    v_mfma_f32_32x32x16_bf16 v[20:35], a[88:91], v[140:143], v[20:35]
    v_mfma_f32_32x32x16_bf16 v[36:51], a[92:95], v[140:143], v[36:51]
    buffer_load_dwordx4 v[140:143], v6, s[84:87], s51 offen offset:3072 sc1
    s_waitcnt vmcnt(31)
    v_mfma_f32_32x32x16_bf16 v[20:35], a[96:99], v[144:147], v[20:35]
    v_mfma_f32_32x32x16_bf16 v[36:51], a[100:103], v[144:147], v[36:51]
    s_add_u32 s51, s56, 12288
    s_and_b32 s51, s51, 0x7fff
    s_add_u32 s51, s51, s50
    buffer_load_dwordx4 v[144:147], v6, s[84:87], s51 offen offset:0 sc1
    s_waitcnt vmcnt(31)
    v_mfma_f32_32x32x16_bf16 v[20:35], a[104:107], v[148:151], v[20:35]
    v_mfma_f32_32x32x16_bf16 v[36:51], a[108:111], v[148:151], v[36:51]
    buffer_load_dwordx4 v[148:151], v6, s[84:87], s51 offen offset:1024 sc1
    s_waitcnt vmcnt(31)
    v_mfma_f32_32x32x16_bf16 v[20:35], a[112:115], v[152:155], v[20:35]
    v_mfma_f32_32x32x16_bf16 v[36:51], a[116:119], v[152:155], v[36:51]
    buffer_load_dwordx4 v[152:155], v6, s[84:87], s51 offen offset:2048 sc1
    s_waitcnt vmcnt(31)
    v_mfma_f32_32x32x16_bf16 v[20:35], a[120:123], v[156:159], v[20:35]
    v_mfma_f32_32x32x16_bf16 v[36:51], a[124:127], v[156:159], v[36:51]
    buffer_load_dwordx4 v[156:159], v6, s[84:87], s51 offen offset:3072 sc1
    s_waitcnt vmcnt(31)
    v_mfma_f32_32x32x16_bf16 v[20:35], a[128:131], v[160:163], v[20:35]
    v_mfma_f32_32x32x16_bf16 v[36:51], a[132:135], v[160:163], v[36:51]
    s_add_u32 s51, s56, 16384
    s_and_b32 s51, s51, 0x7fff
    s_add_u32 s51, s51, s50
    buffer_load_dwordx4 v[160:163], v6, s[84:87], s51 offen offset:0 sc1
    s_waitcnt vmcnt(31)
    v_mfma_f32_32x32x16_bf16 v[20:35], a[136:139], v[164:167], v[20:35]
    v_mfma_f32_32x32x16_bf16 v[36:51], a[140:143], v[164:167], v[36:51]
    buffer_load_dwordx4 v[164:167], v6, s[84:87], s51 offen offset:1024 sc1
    s_waitcnt vmcnt(31)
    v_mfma_f32_32x32x16_bf16 v[20:35], a[144:147], v[168:171], v[20:35]
    v_mfma_f32_32x32x16_bf16 v[36:51], a[148:151], v[168:171], v[36:51]
    buffer_load_dwordx4 v[168:171], v6, s[84:87], s51 offen offset:2048 sc1
    s_waitcnt vmcnt(31)
    v_mfma_f32_32x32x16_bf16 v[20:35], a[152:155], v[172:175], v[20:35]
    v_mfma_f32_32x32x16_bf16 v[36:51], a[156:159], v[172:175], v[36:51]
    buffer_load_dwordx4 v[172:175], v6, s[84:87], s51 offen offset:3072 sc1
    s_waitcnt vmcnt(31)
    v_mfma_f32_32x32x16_bf16 v[20:35], a[160:163], v[176:179], v[20:35]
    v_mfma_f32_32x32x16_bf16 v[36:51], a[164:167], v[176:179], v[36:51]
    s_add_u32 s51, s56, 20480
    s_and_b32 s51, s51, 0x7fff
    s_add_u32 s51, s51, s50
    buffer_load_dwordx4 v[176:179], v6, s[84:87], s51 offen offset:0 sc1
    s_waitcnt vmcnt(31)
    v_mfma_f32_32x32x16_bf16 v[20:35], a[168:171], v[180:183], v[20:35]
    v_mfma_f32_32x32x16_bf16 v[36:51], a[172:175], v[180:183], v[36:51]
    buffer_load_dwordx4 v[180:183], v6, s[84:87], s51 offen offset:1024 sc1
    s_waitcnt vmcnt(31)
    v_mfma_f32_32x32x16_bf16 v[20:35], a[176:179], v[184:187], v[20:35]
    v_mfma_f32_32x32x16_bf16 v[36:51], a[180:183], v[184:187], v[36:51]
    buffer_load_dwordx4 v[184:187], v6, s[84:87], s51 offen offset:2048 sc1
    s_waitcnt vmcnt(31)
    v_mfma_f32_32x32x16_bf16 v[20:35], a[184:187], v[188:191], v[20:35]
    v_mfma_f32_32x32x16_bf16 v[36:51], a[188:191], v[188:191], v[36:51]
    buffer_load_dwordx4 v[188:191], v6, s[84:87], s51 offen offset:3072 sc1
    s_waitcnt vmcnt(31)
    v_mfma_f32_32x32x16_bf16 v[20:35], a[192:195], v[192:195], v[20:35]
    v_mfma_f32_32x32x16_bf16 v[36:51], a[196:199], v[192:195], v[36:51]
    s_add_u32 s51, s56, 24576
    s_and_b32 s51, s51, 0x7fff
    s_add_u32 s51, s51, s50
    buffer_load_dwordx4 v[192:195], v6, s[84:87], s51 offen offset:0 sc1
    s_waitcnt vmcnt(31)
    v_mfma_f32_32x32x16_bf16 v[20:35], a[200:203], v[196:199], v[20:35]
    v_mfma_f32_32x32x16_bf16 v[36:51], a[204:207], v[196:199], v[36:51]
    buffer_load_dwordx4 v[196:199], v6, s[84:87], s51 offen offset:1024 sc1
    s_waitcnt vmcnt(31)
    v_mfma_f32_32x32x16_bf16 v[20:35], a[208:211], v[200:203], v[20:35]
    v_mfma_f32_32x32x16_bf16 v[36:51], a[212:215], v[200:203], v[36:51]
    buffer_load_dwordx4 v[200:203], v6, s[84:87], s51 offen offset:2048 sc1
    s_waitcnt vmcnt(31)
    v_mfma_f32_32x32x16_bf16 v[20:35], a[216:219], v[204:207], v[20:35]
    v_mfma_f32_32x32x16_bf16 v[36:51], a[220:223], v[204:207], v[36:51]
    buffer_load_dwordx4 v[204:207], v6, s[84:87], s51 offen offset:3072 sc1
    s_waitcnt vmcnt(31)
    v_mfma_f32_32x32x16_bf16 v[20:35], a[224:227], v[208:211], v[20:35]
    v_mfma_f32_32x32x16_bf16 v[36:51], a[228:231], v[208:211], v[36:51]
    s_add_u32 s51, s56, 28672
    s_and_b32 s51, s51, 0x7fff
    s_add_u32 s51, s51, s50
    buffer_load_dwordx4 v[208:211], v6, s[84:87], s51 offen offset:0 sc1
    s_waitcnt vmcnt(31)
    v_mfma_f32_32x32x16_bf16 v[20:35], a[232:235], v[212:215], v[20:35]
    v_mfma_f32_32x32x16_bf16 v[36:51], a[236:239], v[212:215], v[36:51]
    buffer_load_dwordx4 v[212:215], v6, s[84:87], s51 offen offset:1024 sc1
    s_waitcnt vmcnt(31)
    v_mfma_f32_32x32x16_bf16 v[20:35], a[240:243], v[216:219], v[20:35]
    v_mfma_f32_32x32x16_bf16 v[36:51], a[244:247], v[216:219], v[36:51]
    buffer_load_dwordx4 v[216:219], v6, s[84:87], s51 offen offset:2048 sc1
    s_waitcnt vmcnt(31)
    v_mfma_f32_32x32x16_bf16 v[224:239], a[248:251], v[220:223], v[20:35]
    v_mfma_f32_32x32x16_bf16 v[240:255], a[252:255], v[220:223], v[36:51]
    buffer_load_dwordx4 v[220:223], v6, s[84:87], s51 offen offset:3072 sc1
    s_add_u32 s42, s42, 1
    s_branch mega_kernel_o_w1
mega_kernel_o_n0:
    s_waitcnt vmcnt(31)
    v_mfma_f32_32x32x16_bf16 v[20:35], a[0:3], v[96:99], 0
    v_mfma_f32_32x32x16_bf16 v[36:51], a[4:7], v[96:99], 0
    s_waitcnt vmcnt(30)
    v_mfma_f32_32x32x16_bf16 v[20:35], a[8:11], v[100:103], v[20:35]
    v_mfma_f32_32x32x16_bf16 v[36:51], a[12:15], v[100:103], v[36:51]
    s_waitcnt vmcnt(29)
    v_mfma_f32_32x32x16_bf16 v[20:35], a[16:19], v[104:107], v[20:35]
    v_mfma_f32_32x32x16_bf16 v[36:51], a[20:23], v[104:107], v[36:51]
    s_waitcnt vmcnt(28)
    v_mfma_f32_32x32x16_bf16 v[20:35], a[24:27], v[108:111], v[20:35]
    v_mfma_f32_32x32x16_bf16 v[36:51], a[28:31], v[108:111], v[36:51]
    s_waitcnt vmcnt(27)
    v_mfma_f32_32x32x16_bf16 v[20:35], a[32:35], v[112:115], v[20:35]
    v_mfma_f32_32x32x16_bf16 v[36:51], a[36:39], v[112:115], v[36:51]
    s_waitcnt vmcnt(26)
    v_mfma_f32_32x32x16_bf16 v[20:35], a[40:43], v[116:119], v[20:35]
    v_mfma_f32_32x32x16_bf16 v[36:51], a[44:47], v[116:119], v[36:51]
    s_waitcnt vmcnt(25)
    v_mfma_f32_32x32x16_bf16 v[20:35], a[48:51], v[120:123], v[20:35]
    v_mfma_f32_32x32x16_bf16 v[36:51], a[52:55], v[120:123], v[36:51]
    s_waitcnt vmcnt(24)
    v_mfma_f32_32x32x16_bf16 v[20:35], a[56:59], v[124:127], v[20:35]
    v_mfma_f32_32x32x16_bf16 v[36:51], a[60:63], v[124:127], v[36:51]
    s_waitcnt vmcnt(23)
    v_mfma_f32_32x32x16_bf16 v[20:35], a[64:67], v[128:131], v[20:35]
    v_mfma_f32_32x32x16_bf16 v[36:51], a[68:71], v[128:131], v[36:51]
    s_waitcnt vmcnt(22)
    v_mfma_f32_32x32x16_bf16 v[20:35], a[72:75], v[132:135], v[20:35]
    v_mfma_f32_32x32x16_bf16 v[36:51], a[76:79], v[132:135], v[36:51]
    s_waitcnt vmcnt(21)
    v_mfma_f32_32x32x16_bf16 v[20:35], a[80:83], v[136:139], v[20:35]
    v_mfma_f32_32x32x16_bf16 v[36:51], a[84:87], v[136:139], v[36:51]
    s_waitcnt vmcnt(20)
    v_mfma_f32_32x32x16_bf16 v[20:35], a[88:91], v[140:143], v[20:35]
    v_mfma_f32_32x32x16_bf16 v[36:51], a[92:95], v[140:143], v[36:51]
    s_waitcnt vmcnt(19)
    v_mfma_f32_32x32x16_bf16 v[20:35], a[96:99], v[144:147], v[20:35]
    v_mfma_f32_32x32x16_bf16 v[36:51], a[100:103], v[144:147], v[36:51]
    s_waitcnt vmcnt(18)
    v_mfma_f32_32x32x16_bf16 v[20:35], a[104:107], v[148:151], v[20:35]
    v_mfma_f32_32x32x16_bf16 v[36:51], a[108:111], v[148:151], v[36:51]
    s_waitcnt vmcnt(17)
    v_mfma_f32_32x32x16_bf16 v[20:35], a[112:115], v[152:155], v[20:35]
    v_mfma_f32_32x32x16_bf16 v[36:51], a[116:119], v[152:155], v[36:51]
    s_waitcnt vmcnt(16)
    v_mfma_f32_32x32x16_bf16 v[20:35], a[120:123], v[156:159], v[20:35]
    v_mfma_f32_32x32x16_bf16 v[36:51], a[124:127], v[156:159], v[36:51]
    s_waitcnt vmcnt(15)
    v_mfma_f32_32x32x16_bf16 v[20:35], a[128:131], v[160:163], v[20:35]
    v_mfma_f32_32x32x16_bf16 v[36:51], a[132:135], v[160:163], v[36:51]
    s_waitcnt vmcnt(14)
    v_mfma_f32_32x32x16_bf16 v[20:35], a[136:139], v[164:167], v[20:35]
    v_mfma_f32_32x32x16_bf16 v[36:51], a[140:143], v[164:167], v[36:51]
    s_waitcnt vmcnt(13)
    v_mfma_f32_32x32x16_bf16 v[20:35], a[144:147], v[168:171], v[20:35]
    v_mfma_f32_32x32x16_bf16 v[36:51], a[148:151], v[168:171], v[36:51]
    s_waitcnt vmcnt(12)
    v_mfma_f32_32x32x16_bf16 v[20:35], a[152:155], v[172:175], v[20:35]
    v_mfma_f32_32x32x16_bf16 v[36:51], a[156:159], v[172:175], v[36:51]
    s_waitcnt vmcnt(11)
    v_mfma_f32_32x32x16_bf16 v[20:35], a[160:163], v[176:179], v[20:35]
    v_mfma_f32_32x32x16_bf16 v[36:51], a[164:167], v[176:179], v[36:51]
    buffer_load_dword v15, v7, s[84:87], 0 offen sc1
    s_waitcnt vmcnt(10)
    v_mfma_f32_32x32x16_bf16 v[20:35], a[168:171], v[180:183], v[20:35]
    v_mfma_f32_32x32x16_bf16 v[36:51], a[172:175], v[180:183], v[36:51]
    s_waitcnt vmcnt(9)
    v_mfma_f32_32x32x16_bf16 v[20:35], a[176:179], v[184:187], v[20:35]
    v_mfma_f32_32x32x16_bf16 v[36:51], a[180:183], v[184:187], v[36:51]
    s_waitcnt vmcnt(8)
    v_mfma_f32_32x32x16_bf16 v[20:35], a[184:187], v[188:191], v[20:35]
    v_mfma_f32_32x32x16_bf16 v[36:51], a[188:191], v[188:191], v[36:51]
    s_waitcnt vmcnt(7)
    v_mfma_f32_32x32x16_bf16 v[20:35], a[192:195], v[192:195], v[20:35]
    v_mfma_f32_32x32x16_bf16 v[36:51], a[196:199], v[192:195], v[36:51]
    s_waitcnt vmcnt(6)
    v_mfma_f32_32x32x16_bf16 v[20:35], a[200:203], v[196:199], v[20:35]
    v_mfma_f32_32x32x16_bf16 v[36:51], a[204:207], v[196:199], v[36:51]
    s_waitcnt vmcnt(5)
    v_mfma_f32_32x32x16_bf16 v[20:35], a[208:211], v[200:203], v[20:35]
    v_mfma_f32_32x32x16_bf16 v[36:51], a[212:215], v[200:203], v[36:51]
    s_waitcnt vmcnt(4)
    v_mfma_f32_32x32x16_bf16 v[20:35], a[216:219], v[204:207], v[20:35]
    v_mfma_f32_32x32x16_bf16 v[36:51], a[220:223], v[204:207], v[36:51]
    s_waitcnt vmcnt(3)
    v_mfma_f32_32x32x16_bf16 v[20:35], a[224:227], v[208:211], v[20:35]
    v_mfma_f32_32x32x16_bf16 v[36:51], a[228:231], v[208:211], v[36:51]
    s_waitcnt vmcnt(2)
    v_mfma_f32_32x32x16_bf16 v[20:35], a[232:235], v[212:215], v[20:35]
    v_mfma_f32_32x32x16_bf16 v[36:51], a[236:239], v[212:215], v[36:51]
    s_waitcnt vmcnt(1)
    v_mfma_f32_32x32x16_bf16 v[20:35], a[240:243], v[216:219], v[20:35]
    v_mfma_f32_32x32x16_bf16 v[36:51], a[244:247], v[216:219], v[36:51]
    s_waitcnt vmcnt(0)
    v_mfma_f32_32x32x16_bf16 v[224:239], a[248:251], v[220:223], v[20:35]
    v_mfma_f32_32x32x16_bf16 v[240:255], a[252:255], v[220:223], v[36:51]
    s_branch mega_kernel_o_imm
mega_kernel_o_w1:
    s_add_u32 s54, s42, 1
    s_sub_u32 s62, s42, 1
    s_lshl_b32 s50, s54, 18
    s_cmp_gt_i32 s52, s54
    s_cbranch_scc0 mega_kernel_o_n1
    s_waitcnt vmcnt(31)
    v_mfma_f32_32x32x16_bf16 v[20:35], a[0:3], v[96:99], 0
    v_mfma_f32_32x32x16_bf16 v[36:51], a[4:7], v[96:99], 0
    s_add_u32 s51, s56, 0
    s_and_b32 s51, s51, 0x7fff
    s_add_u32 s51, s51, s50
    buffer_load_dwordx4 v[96:99], v6, s[84:87], s51 offen offset:0 sc1
    s_waitcnt vmcnt(31)
    v_mfma_f32_32x32x16_bf16 v[20:35], a[8:11], v[100:103], v[20:35]
    v_mfma_f32_32x32x16_bf16 v[36:51], a[12:15], v[100:103], v[36:51]
    buffer_load_dwordx4 v[100:103], v6, s[84:87], s51 offen offset:1024 sc1
    v_add_u32 v2, s53, v8
    v_add_u32 v3, s53, v9
    v_add_u32 v4, s53, v10
    s_waitcnt vmcnt(31)
    v_mfma_f32_32x32x16_bf16 v[20:35], a[16:19], v[104:107], v[20:35]
    v_mfma_f32_32x32x16_bf16 v[36:51], a[20:23], v[104:107], v[36:51]
    buffer_load_dwordx4 v[104:107], v6, s[84:87], s51 offen offset:2048 sc1
    ds_write_b128 v2, v[224:227] offset:0
    ds_write_b128 v2, v[228:231] offset:1088
    s_waitcnt vmcnt(31)
    v_mfma_f32_32x32x16_bf16 v[20:35], a[24:27], v[108:111], v[20:35]
    v_mfma_f32_32x32x16_bf16 v[36:51], a[28:31], v[108:111], v[36:51]
    buffer_load_dwordx4 v[108:111], v6, s[84:87], s51 offen offset:3072 sc1
    ds_write_b128 v2, v[232:235] offset:2176
    ds_write_b128 v2, v[236:239] offset:3264
    s_waitcnt vmcnt(31)
    v_mfma_f32_32x32x16_bf16 v[20:35], a[32:35], v[112:115], v[20:35]
    v_mfma_f32_32x32x16_bf16 v[36:51], a[36:39], v[112:115], v[36:51]
    s_add_u32 s51, s56, 4096
    s_and_b32 s51, s51, 0x7fff
    s_add_u32 s51, s51, s50
    buffer_load_dwordx4 v[112:115], v6, s[84:87], s51 offen offset:0 sc1
    ds_write_b128 v2, v[240:243] offset:4352
    ds_write_b128 v2, v[244:247] offset:5440
    s_waitcnt vmcnt(31)
    v_mfma_f32_32x32x16_bf16 v[20:35], a[40:43], v[116:119], v[20:35]
    v_mfma_f32_32x32x16_bf16 v[36:51], a[44:47], v[116:119], v[36:51]
    buffer_load_dwordx4 v[116:119], v6, s[84:87], s51 offen offset:1024 sc1
    ds_write_b128 v2, v[248:251] offset:6528
    ds_write_b128 v2, v[252:255] offset:7616
    s_waitcnt vmcnt(31)
    v_mfma_f32_32x32x16_bf16 v[20:35], a[48:51], v[120:123], v[20:35]
    v_mfma_f32_32x32x16_bf16 v[36:51], a[52:55], v[120:123], v[36:51]
    buffer_load_dwordx4 v[120:123], v6, s[84:87], s51 offen offset:2048 sc1
    s_waitcnt vmcnt(31)
    v_mfma_f32_32x32x16_bf16 v[20:35], a[56:59], v[124:127], v[20:35]
    v_mfma_f32_32x32x16_bf16 v[36:51], a[60:63], v[124:127], v[36:51]
    buffer_load_dwordx4 v[124:127], v6, s[84:87], s51 offen offset:3072 sc1
    s_waitcnt lgkmcnt(0)
    s_barrier
    ds_read_b128 v[52:55], v4 offset:0
    ds_read_b128 v[56:59], v4 offset:8704
    ds_read_b128 v[60:63], v4 offset:17408
    ds_read_b128 v[64:67], v4 offset:26112
    s_waitcnt vmcnt(31)
    v_mfma_f32_32x32x16_bf16 v[20:35], a[64:67], v[128:131], v[20:35]
    v_mfma_f32_32x32x16_bf16 v[36:51], a[68:71], v[128:131], v[36:51]
    s_add_u32 s51, s56, 8192
    s_and_b32 s51, s51, 0x7fff
    s_add_u32 s51, s51, s50
    buffer_load_dwordx4 v[128:131], v6, s[84:87], s51 offen offset:0 sc1
    ds_read_b128 v[68:71], v3 offset:0
    ds_read_b128 v[72:75], v3 offset:8704
    ds_read_b128 v[76:79], v3 offset:17408
    ds_read_b128 v[80:83], v3 offset:26112
    s_sub_u32 s53, 34816, s53
    s_bfe_u32 s61, s62, 0x10001
    s_and_b32 s60, s62, 1
    s_lshl_b32 s60, s60, 12
    s_waitcnt vmcnt(31)
    v_mfma_f32_32x32x16_bf16 v[20:35], a[72:75], v[132:135], v[20:35]
    v_mfma_f32_32x32x16_bf16 v[36:51], a[76:79], v[132:135], v[36:51]
    buffer_load_dwordx4 v[132:135], v6, s[84:87], s51 offen offset:1024 sc1
    s_waitcnt vmcnt(31)
    v_mfma_f32_32x32x16_bf16 v[20:35], a[80:83], v[136:139], v[20:35]
    v_mfma_f32_32x32x16_bf16 v[36:51], a[84:87], v[136:139], v[36:51]
    buffer_load_dwordx4 v[136:139], v6, s[84:87], s51 offen offset:2048 sc1
    s_waitcnt lgkmcnt(4)
    v_add_f32 v52, v52, v56
    v_add_f32 v60, v60, v64
    v_add_f32 v53, v53, v57
    v_add_f32 v61, v61, v65
    v_add_f32 v54, v54, v58
    v_add_f32 v62, v62, v66
    v_add_f32 v55, v55, v59
    v_add_f32 v63, v63, v67
    s_waitcnt vmcnt(31)
    v_mfma_f32_32x32x16_bf16 v[20:35], a[88:91], v[140:143], v[20:35]
    v_mfma_f32_32x32x16_bf16 v[36:51], a[92:95], v[140:143], v[36:51]
    buffer_load_dwordx4 v[140:143], v6, s[84:87], s51 offen offset:3072 sc1
    v_add_f32 v52, v52, v60
    v_add_f32 v53, v53, v61
    v_add_f32 v54, v54, v62
    v_add_f32 v55, v55, v63
    v_and_or_b32 v52, v52, -2, s61
    s_cmp_eq_u32 s95, 0
    s_cbranch_scc1 mega_kernel_o_sa1
    buffer_store_dwordx4 v[52:55], v12, s[84:87], s60 offen sc1
    s_branch mega_kernel_o_sb1
    mega_kernel_o_sa1:
    buffer_store_dwordx4 v[52:55], v12, s[84:87], s60 offen
    mega_kernel_o_sb1:
    s_waitcnt vmcnt(31)
    v_mfma_f32_32x32x16_bf16 v[20:35], a[96:99], v[144:147], v[20:35]
    v_mfma_f32_32x32x16_bf16 v[36:51], a[100:103], v[144:147], v[36:51]
    s_add_u32 s51, s56, 12288
    s_and_b32 s51, s51, 0x7fff
    s_add_u32 s51, s51, s50
    buffer_load_dwordx4 v[144:147], v6, s[84:87], s51 offen offset:0 sc1
    s_waitcnt lgkmcnt(0)
    v_add_f32 v68, v68, v72
    v_add_f32 v76, v76, v80
    v_add_f32 v69, v69, v73
    v_add_f32 v77, v77, v81
    v_add_f32 v70, v70, v74
    v_add_f32 v78, v78, v82
    v_add_f32 v71, v71, v75
    v_add_f32 v79, v79, v83
    s_waitcnt vmcnt(31)
    v_mfma_f32_32x32x16_bf16 v[20:35], a[104:107], v[148:151], v[20:35]
    v_mfma_f32_32x32x16_bf16 v[36:51], a[108:111], v[148:151], v[36:51]
    buffer_load_dwordx4 v[148:151], v6, s[84:87], s51 offen offset:1024 sc1
    v_add_f32 v84, v68, v76
    v_add_f32 v85, v69, v77
    v_add_f32 v86, v70, v78
    v_add_f32 v87, v71, v79
    s_waitcnt vmcnt(31)
    v_mfma_f32_32x32x16_bf16 v[20:35], a[112:115], v[152:155], v[20:35]
    v_mfma_f32_32x32x16_bf16 v[36:51], a[116:119], v[152:155], v[36:51]
    buffer_load_dwordx4 v[152:155], v6, s[84:87], s51 offen offset:2048 sc1
    s_waitcnt vmcnt(31)
    v_mfma_f32_32x32x16_bf16 v[20:35], a[120:123], v[156:159], v[20:35]
    v_mfma_f32_32x32x16_bf16 v[36:51], a[124:127], v[156:159], v[36:51]
    buffer_load_dwordx4 v[156:159], v6, s[84:87], s51 offen offset:3072 sc1
    s_waitcnt vmcnt(31)
    v_mfma_f32_32x32x16_bf16 v[20:35], a[128:131], v[160:163], v[20:35]
    v_mfma_f32_32x32x16_bf16 v[36:51], a[132:135], v[160:163], v[36:51]
    s_add_u32 s51, s56, 16384
    s_and_b32 s51, s51, 0x7fff
    s_add_u32 s51, s51, s50
    buffer_load_dwordx4 v[160:163], v6, s[84:87], s51 offen offset:0 sc1
    s_waitcnt vmcnt(31)
    v_mfma_f32_32x32x16_bf16 v[20:35], a[136:139], v[164:167], v[20:35]
    v_mfma_f32_32x32x16_bf16 v[36:51], a[140:143], v[164:167], v[36:51]
    buffer_load_dwordx4 v[164:167], v6, s[84:87], s51 offen offset:1024 sc1
    s_waitcnt vmcnt(31)
    v_mfma_f32_32x32x16_bf16 v[20:35], a[144:147], v[168:171], v[20:35]
    v_mfma_f32_32x32x16_bf16 v[36:51], a[148:151], v[168:171], v[36:51]
    buffer_load_dwordx4 v[168:171], v6, s[84:87], s51 offen offset:2048 sc1
    s_waitcnt vmcnt(31)
    v_mfma_f32_32x32x16_bf16 v[20:35], a[152:155], v[172:175], v[20:35]
    v_mfma_f32_32x32x16_bf16 v[36:51], a[156:159], v[172:175], v[36:51]
    buffer_load_dwordx4 v[172:175], v6, s[84:87], s51 offen offset:3072 sc1
    s_waitcnt vmcnt(31)
    v_mfma_f32_32x32x16_bf16 v[20:35], a[160:163], v[176:179], v[20:35]
    v_mfma_f32_32x32x16_bf16 v[36:51], a[164:167], v[176:179], v[36:51]
    s_add_u32 s51, s56, 20480
    s_and_b32 s51, s51, 0x7fff
    s_add_u32 s51, s51, s50
    buffer_load_dwordx4 v[176:179], v6, s[84:87], s51 offen offset:0 sc1
    s_waitcnt vmcnt(31)
    v_mfma_f32_32x32x16_bf16 v[20:35], a[168:171], v[180:183], v[20:35]
    v_mfma_f32_32x32x16_bf16 v[36:51], a[172:175], v[180:183], v[36:51]
    buffer_load_dwordx4 v[180:183], v6, s[84:87], s51 offen offset:1024 sc1
    s_waitcnt vmcnt(31)
    v_mfma_f32_32x32x16_bf16 v[20:35], a[176:179], v[184:187], v[20:35]
    v_mfma_f32_32x32x16_bf16 v[36:51], a[180:183], v[184:187], v[36:51]
    buffer_load_dwordx4 v[184:187], v6, s[84:87], s51 offen offset:2048 sc1
    s_waitcnt vmcnt(31)
    v_mfma_f32_32x32x16_bf16 v[20:35], a[184:187], v[188:191], v[20:35]
    v_mfma_f32_32x32x16_bf16 v[36:51], a[188:191], v[188:191], v[36:51]
    buffer_load_dwordx4 v[188:191], v6, s[84:87], s51 offen offset:3072 sc1
    s_waitcnt vmcnt(31)
    v_mfma_f32_32x32x16_bf16 v[20:35], a[192:195], v[192:195], v[20:35]
    v_mfma_f32_32x32x16_bf16 v[36:51], a[196:199], v[192:195], v[36:51]
    s_add_u32 s51, s56, 24576
    s_and_b32 s51, s51, 0x7fff
    s_add_u32 s51, s51, s50
    buffer_load_dwordx4 v[192:195], v6, s[84:87], s51 offen offset:0 sc1
    s_waitcnt vmcnt(31)
    v_mfma_f32_32x32x16_bf16 v[20:35], a[200:203], v[196:199], v[20:35]
    v_mfma_f32_32x32x16_bf16 v[36:51], a[204:207], v[196:199], v[36:51]
    buffer_load_dwordx4 v[196:199], v6, s[84:87], s51 offen offset:1024 sc1
    s_waitcnt vmcnt(31)
    v_mfma_f32_32x32x16_bf16 v[20:35], a[208:211], v[200:203], v[20:35]
    v_mfma_f32_32x32x16_bf16 v[36:51], a[212:215], v[200:203], v[36:51]
    buffer_load_dwordx4 v[200:203], v6, s[84:87], s51 offen offset:2048 sc1
    s_waitcnt vmcnt(31)
    v_mfma_f32_32x32x16_bf16 v[20:35], a[216:219], v[204:207], v[20:35]
    v_mfma_f32_32x32x16_bf16 v[36:51], a[220:223], v[204:207], v[36:51]
    buffer_load_dwordx4 v[204:207], v6, s[84:87], s51 offen offset:3072 sc1
    s_and_b32 s60, s62, 1
    s_lshl_b32 s60, s60, 12
    buffer_load_dwordx4 v[88:91], v13, s[84:87], s60 offen sc1
    s_waitcnt vmcnt(31)
    v_mfma_f32_32x32x16_bf16 v[20:35], a[224:227], v[208:211], v[20:35]
    v_mfma_f32_32x32x16_bf16 v[36:51], a[228:231], v[208:211], v[36:51]
    s_add_u32 s51, s56, 28672
    s_and_b32 s51, s51, 0x7fff
    s_add_u32 s51, s51, s50
    buffer_load_dwordx4 v[208:211], v6, s[84:87], s51 offen offset:0 sc1
    s_waitcnt vmcnt(31)
    v_mfma_f32_32x32x16_bf16 v[20:35], a[232:235], v[212:215], v[20:35]
    v_mfma_f32_32x32x16_bf16 v[36:51], a[236:239], v[212:215], v[36:51]
    buffer_load_dwordx4 v[212:215], v6, s[84:87], s51 offen offset:1024 sc1
    s_waitcnt vmcnt(31)
    v_mfma_f32_32x32x16_bf16 v[20:35], a[240:243], v[216:219], v[20:35]
    v_mfma_f32_32x32x16_bf16 v[36:51], a[244:247], v[216:219], v[36:51]
    buffer_load_dwordx4 v[216:219], v6, s[84:87], s51 offen offset:2048 sc1
    s_waitcnt vmcnt(31)
    v_mfma_f32_32x32x16_bf16 v[224:239], a[248:251], v[220:223], v[20:35]
    v_mfma_f32_32x32x16_bf16 v[240:255], a[252:255], v[220:223], v[36:51]
    buffer_load_dwordx4 v[220:223], v6, s[84:87], s51 offen offset:3072 sc1
    s_bfe_u32 s61, s62, 0x10001
    s_waitcnt vmcnt(4)
mega_kernel_o_f1c:
    v_and_b32 v14, 1, v88
    v_cmp_ne_u32 vcc, s61, v14
    s_cbranch_vccz mega_kernel_o_f1k
    s_and_b32 s60, s62, 1
    s_lshl_b32 s60, s60, 12
    buffer_load_dwordx4 v[88:91], v13, s[84:87], s60 offen sc1
    s_waitcnt vmcnt(0)
    s_branch mega_kernel_o_f1c
mega_kernel_o_f1k:
    v_pk_add_f32 v[88:89], v[88:89], v[84:85]
    v_pk_add_f32 v[90:91], v[90:91], v[86:87]
    s_lshl_b32 s60, s62, 17
    v_cvt_pk_bf16_f32 v92, v88, v89
    v_cvt_pk_bf16_f32 v93, v90, v91
    buffer_store_dwordx2 v[92:93], v11, s[8:11], s60 offen
    s_add_u32 s42, s42, 1
    s_branch mega_kernel_o_w1
mega_kernel_o_n1:
    s_waitcnt vmcnt(31)
    v_mfma_f32_32x32x16_bf16 v[20:35], a[0:3], v[96:99], 0
    v_mfma_f32_32x32x16_bf16 v[36:51], a[4:7], v[96:99], 0
    s_waitcnt vmcnt(30)
    v_mfma_f32_32x32x16_bf16 v[20:35], a[8:11], v[100:103], v[20:35]
    v_mfma_f32_32x32x16_bf16 v[36:51], a[12:15], v[100:103], v[36:51]
    v_add_u32 v2, s53, v8
    v_add_u32 v3, s53, v9
    v_add_u32 v4, s53, v10
    s_waitcnt vmcnt(29)
    v_mfma_f32_32x32x16_bf16 v[20:35], a[16:19], v[104:107], v[20:35]
    v_mfma_f32_32x32x16_bf16 v[36:51], a[20:23], v[104:107], v[36:51]
    ds_write_b128 v2, v[224:227] offset:0
    ds_write_b128 v2, v[228:231] offset:1088
    s_waitcnt vmcnt(28)
    v_mfma_f32_32x32x16_bf16 v[20:35], a[24:27], v[108:111], v[20:35]
    v_mfma_f32_32x32x16_bf16 v[36:51], a[28:31], v[108:111], v[36:51]
    ds_write_b128 v2, v[232:235] offset:2176
    ds_write_b128 v2, v[236:239] offset:3264
    s_waitcnt vmcnt(27)
    v_mfma_f32_32x32x16_bf16 v[20:35], a[32:35], v[112:115], v[20:35]
    v_mfma_f32_32x32x16_bf16 v[36:51], a[36:39], v[112:115], v[36:51]
    ds_write_b128 v2, v[240:243] offset:4352
    ds_write_b128 v2, v[244:247] offset:5440
    s_waitcnt vmcnt(26)
    v_mfma_f32_32x32x16_bf16 v[20:35], a[40:43], v[116:119], v[20:35]
    v_mfma_f32_32x32x16_bf16 v[36:51], a[44:47], v[116:119], v[36:51]
    ds_write_b128 v2, v[248:251] offset:6528
    ds_write_b128 v2, v[252:255] offset:7616
    s_waitcnt vmcnt(25)
    v_mfma_f32_32x32x16_bf16 v[20:35], a[48:51], v[120:123], v[20:35]
    v_mfma_f32_32x32x16_bf16 v[36:51], a[52:55], v[120:123], v[36:51]
    s_waitcnt vmcnt(24)
    v_mfma_f32_32x32x16_bf16 v[20:35], a[56:59], v[124:127], v[20:35]
    v_mfma_f32_32x32x16_bf16 v[36:51], a[60:63], v[124:127], v[36:51]
    s_waitcnt lgkmcnt(0)
    s_barrier
    ds_read_b128 v[52:55], v4 offset:0
    ds_read_b128 v[56:59], v4 offset:8704
    ds_read_b128 v[60:63], v4 offset:17408
    ds_read_b128 v[64:67], v4 offset:26112
    s_waitcnt vmcnt(23)
    v_mfma_f32_32x32x16_bf16 v[20:35], a[64:67], v[128:131], v[20:35]
    v_mfma_f32_32x32x16_bf16 v[36:51], a[68:71], v[128:131], v[36:51]
    ds_read_b128 v[68:71], v3 offset:0
    ds_read_b128 v[72:75], v3 offset:8704
    ds_read_b128 v[76:79], v3 offset:17408
    ds_read_b128 v[80:83], v3 offset:26112
    s_sub_u32 s53, 34816, s53
    s_bfe_u32 s61, s62, 0x10001
    s_and_b32 s60, s62, 1
    s_lshl_b32 s60, s60, 12
    s_waitcnt vmcnt(22)
    v_mfma_f32_32x32x16_bf16 v[20:35], a[72:75], v[132:135], v[20:35]
    v_mfma_f32_32x32x16_bf16 v[36:51], a[76:79], v[132:135], v[36:51]
    s_waitcnt vmcnt(21)
    v_mfma_f32_32x32x16_bf16 v[20:35], a[80:83], v[136:139], v[20:35]
    v_mfma_f32_32x32x16_bf16 v[36:51], a[84:87], v[136:139], v[36:51]
    s_waitcnt lgkmcnt(4)
    v_add_f32 v52, v52, v56
    v_add_f32 v60, v60, v64
    v_add_f32 v53, v53, v57
    v_add_f32 v61, v61, v65
    v_add_f32 v54, v54, v58
    v_add_f32 v62, v62, v66
    v_add_f32 v55, v55, v59
    v_add_f32 v63, v63, v67
    s_waitcnt vmcnt(20)
    v_mfma_f32_32x32x16_bf16 v[20:35], a[88:91], v[140:143], v[20:35]
    v_mfma_f32_32x32x16_bf16 v[36:51], a[92:95], v[140:143], v[36:51]
    v_add_f32 v52, v52, v60
    v_add_f32 v53, v53, v61
    v_add_f32 v54, v54, v62
    v_add_f32 v55, v55, v63
    v_and_or_b32 v52, v52, -2, s61
    s_cmp_eq_u32 s95, 0
    s_cbranch_scc1 mega_kernel_o_sa2
    buffer_store_dwordx4 v[52:55], v12, s[84:87], s60 offen sc1
    s_branch mega_kernel_o_sb2
    mega_kernel_o_sa2:
    buffer_store_dwordx4 v[52:55], v12, s[84:87], s60 offen
    mega_kernel_o_sb2:
    s_waitcnt vmcnt(19)
    v_mfma_f32_32x32x16_bf16 v[20:35], a[96:99], v[144:147], v[20:35]
    v_mfma_f32_32x32x16_bf16 v[36:51], a[100:103], v[144:147], v[36:51]
    s_waitcnt lgkmcnt(0)
    v_add_f32 v68, v68, v72
    v_add_f32 v76, v76, v80
    v_add_f32 v69, v69, v73
    v_add_f32 v77, v77, v81
    v_add_f32 v70, v70, v74
    v_add_f32 v78, v78, v82
    v_add_f32 v71, v71, v75
    v_add_f32 v79, v79, v83
    s_waitcnt vmcnt(18)
    v_mfma_f32_32x32x16_bf16 v[20:35], a[104:107], v[148:151], v[20:35]
    v_mfma_f32_32x32x16_bf16 v[36:51], a[108:111], v[148:151], v[36:51]
    v_add_f32 v84, v68, v76
    v_add_f32 v85, v69, v77
    v_add_f32 v86, v70, v78
    v_add_f32 v87, v71, v79
    s_waitcnt vmcnt(17)
    v_mfma_f32_32x32x16_bf16 v[20:35], a[112:115], v[152:155], v[20:35]
    v_mfma_f32_32x32x16_bf16 v[36:51], a[116:119], v[152:155], v[36:51]
    s_waitcnt vmcnt(16)
    v_mfma_f32_32x32x16_bf16 v[20:35], a[120:123], v[156:159], v[20:35]
    v_mfma_f32_32x32x16_bf16 v[36:51], a[124:127], v[156:159], v[36:51]
    s_waitcnt vmcnt(15)
    v_mfma_f32_32x32x16_bf16 v[20:35], a[128:131], v[160:163], v[20:35]
    v_mfma_f32_32x32x16_bf16 v[36:51], a[132:135], v[160:163], v[36:51]
    s_waitcnt vmcnt(14)
    v_mfma_f32_32x32x16_bf16 v[20:35], a[136:139], v[164:167], v[20:35]
    v_mfma_f32_32x32x16_bf16 v[36:51], a[140:143], v[164:167], v[36:51]
    s_waitcnt vmcnt(13)
    v_mfma_f32_32x32x16_bf16 v[20:35], a[144:147], v[168:171], v[20:35]
    v_mfma_f32_32x32x16_bf16 v[36:51], a[148:151], v[168:171], v[36:51]
    s_waitcnt vmcnt(12)
    v_mfma_f32_32x32x16_bf16 v[20:35], a[152:155], v[172:175], v[20:35]
    v_mfma_f32_32x32x16_bf16 v[36:51], a[156:159], v[172:175], v[36:51]
    s_waitcnt vmcnt(11)
    v_mfma_f32_32x32x16_bf16 v[20:35], a[160:163], v[176:179], v[20:35]
    v_mfma_f32_32x32x16_bf16 v[36:51], a[164:167], v[176:179], v[36:51]
    buffer_load_dword v15, v7, s[84:87], 0 offen sc1
    s_waitcnt vmcnt(10)
    v_mfma_f32_32x32x16_bf16 v[20:35], a[168:171], v[180:183], v[20:35]
    v_mfma_f32_32x32x16_bf16 v[36:51], a[172:175], v[180:183], v[36:51]
    s_waitcnt vmcnt(9)
    v_mfma_f32_32x32x16_bf16 v[20:35], a[176:179], v[184:187], v[20:35]
    v_mfma_f32_32x32x16_bf16 v[36:51], a[180:183], v[184:187], v[36:51]
    s_waitcnt vmcnt(8)
    v_mfma_f32_32x32x16_bf16 v[20:35], a[184:187], v[188:191], v[20:35]
    v_mfma_f32_32x32x16_bf16 v[36:51], a[188:191], v[188:191], v[36:51]
    s_waitcnt vmcnt(7)
    v_mfma_f32_32x32x16_bf16 v[20:35], a[192:195], v[192:195], v[20:35]
    v_mfma_f32_32x32x16_bf16 v[36:51], a[196:199], v[192:195], v[36:51]
    s_waitcnt vmcnt(6)
    v_mfma_f32_32x32x16_bf16 v[20:35], a[200:203], v[196:199], v[20:35]
    v_mfma_f32_32x32x16_bf16 v[36:51], a[204:207], v[196:199], v[36:51]
    s_waitcnt vmcnt(5)
    v_mfma_f32_32x32x16_bf16 v[20:35], a[208:211], v[200:203], v[20:35]
    v_mfma_f32_32x32x16_bf16 v[36:51], a[212:215], v[200:203], v[36:51]
    s_waitcnt vmcnt(4)
    v_mfma_f32_32x32x16_bf16 v[20:35], a[216:219], v[204:207], v[20:35]
    v_mfma_f32_32x32x16_bf16 v[36:51], a[220:223], v[204:207], v[36:51]
    s_and_b32 s60, s62, 1
    s_lshl_b32 s60, s60, 12
    buffer_load_dwordx4 v[88:91], v13, s[84:87], s60 offen sc1
    s_waitcnt vmcnt(3)
    v_mfma_f32_32x32x16_bf16 v[20:35], a[224:227], v[208:211], v[20:35]
    v_mfma_f32_32x32x16_bf16 v[36:51], a[228:231], v[208:211], v[36:51]
    s_waitcnt vmcnt(2)
    v_mfma_f32_32x32x16_bf16 v[20:35], a[232:235], v[212:215], v[20:35]
    v_mfma_f32_32x32x16_bf16 v[36:51], a[236:239], v[212:215], v[36:51]
    s_waitcnt vmcnt(1)
    v_mfma_f32_32x32x16_bf16 v[20:35], a[240:243], v[216:219], v[20:35]
    v_mfma_f32_32x32x16_bf16 v[36:51], a[244:247], v[216:219], v[36:51]
    s_waitcnt vmcnt(0)
    v_mfma_f32_32x32x16_bf16 v[224:239], a[248:251], v[220:223], v[20:35]
    v_mfma_f32_32x32x16_bf16 v[240:255], a[252:255], v[220:223], v[36:51]
    s_bfe_u32 s61, s62, 0x10001
    s_waitcnt vmcnt(0)
mega_kernel_o_f0c:
    v_and_b32 v14, 1, v88
    v_cmp_ne_u32 vcc, s61, v14
    s_cbranch_vccz mega_kernel_o_f0k
    s_and_b32 s60, s62, 1
    s_lshl_b32 s60, s60, 12
    buffer_load_dwordx4 v[88:91], v13, s[84:87], s60 offen sc1
    s_waitcnt vmcnt(0)
    s_branch mega_kernel_o_f0c
mega_kernel_o_f0k:
    v_pk_add_f32 v[88:89], v[88:89], v[84:85]
    v_pk_add_f32 v[90:91], v[90:91], v[86:87]
    s_lshl_b32 s60, s62, 17
    v_cvt_pk_bf16_f32 v92, v88, v89
    v_cvt_pk_bf16_f32 v93, v90, v91
    buffer_store_dwordx2 v[92:93], v11, s[8:11], s60 offen
mega_kernel_o_imm:
    s_waitcnt vmcnt(1)
    v_min_i32_dpp v15, v15, v15 quad_perm:[1,0,3,2] row_mask:0xf bank_mask:0xf
    s_nop 1
    v_min_i32_dpp v15, v15, v15 quad_perm:[2,3,0,1] row_mask:0xf bank_mask:0xf
    s_nop 1
    v_min_i32_dpp v15, v15, v15 row_ror:4 row_mask:0xf bank_mask:0xf
    s_nop 1
    v_min_i32_dpp v15, v15, v15 row_ror:8 row_mask:0xf bank_mask:0xf
    s_nop 0
    v_readfirstlane_b32 s52, v15
    s_cmp_gt_i32 s52, s54
    s_cbranch_scc0 mega_kernel_o_im2
    s_add_u32 s51, s56, 0
    s_and_b32 s51, s51, 0x7fff
    s_add_u32 s51, s51, s50
    buffer_load_dwordx4 v[96:99], v6, s[84:87], s51 offen offset:0 sc1
    buffer_load_dwordx4 v[100:103], v6, s[84:87], s51 offen offset:1024 sc1
    buffer_load_dwordx4 v[104:107], v6, s[84:87], s51 offen offset:2048 sc1
    buffer_load_dwordx4 v[108:111], v6, s[84:87], s51 offen offset:3072 sc1
    s_add_u32 s51, s56, 4096
    s_and_b32 s51, s51, 0x7fff
    s_add_u32 s51, s51, s50
    buffer_load_dwordx4 v[112:115], v6, s[84:87], s51 offen offset:0 sc1
    buffer_load_dwordx4 v[116:119], v6, s[84:87], s51 offen offset:1024 sc1
    buffer_load_dwordx4 v[120:123], v6, s[84:87], s51 offen offset:2048 sc1
    buffer_load_dwordx4 v[124:127], v6, s[84:87], s51 offen offset:3072 sc1
    s_add_u32 s51, s56, 8192
    s_and_b32 s51, s51, 0x7fff
    s_add_u32 s51, s51, s50
    buffer_load_dwordx4 v[128:131], v6, s[84:87], s51 offen offset:0 sc1
    buffer_load_dwordx4 v[132:135], v6, s[84:87], s51 offen offset:1024 sc1
    buffer_load_dwordx4 v[136:139], v6, s[84:87], s51 offen offset:2048 sc1
    buffer_load_dwordx4 v[140:143], v6, s[84:87], s51 offen offset:3072 sc1
    s_add_u32 s51, s56, 12288
    s_and_b32 s51, s51, 0x7fff
    s_add_u32 s51, s51, s50
    buffer_load_dwordx4 v[144:147], v6, s[84:87], s51 offen offset:0 sc1
    buffer_load_dwordx4 v[148:151], v6, s[84:87], s51 offen offset:1024 sc1
    buffer_load_dwordx4 v[152:155], v6, s[84:87], s51 offen offset:2048 sc1
    buffer_load_dwordx4 v[156:159], v6, s[84:87], s51 offen offset:3072 sc1
    s_add_u32 s51, s56, 16384
    s_and_b32 s51, s51, 0x7fff
    s_add_u32 s51, s51, s50
    buffer_load_dwordx4 v[160:163], v6, s[84:87], s51 offen offset:0 sc1
    buffer_load_dwordx4 v[164:167], v6, s[84:87], s51 offen offset:1024 sc1
    buffer_load_dwordx4 v[168:171], v6, s[84:87], s51 offen offset:2048 sc1
    buffer_load_dwordx4 v[172:175], v6, s[84:87], s51 offen offset:3072 sc1
    s_add_u32 s51, s56, 20480
    s_and_b32 s51, s51, 0x7fff
    s_add_u32 s51, s51, s50
    buffer_load_dwordx4 v[176:179], v6, s[84:87], s51 offen offset:0 sc1
    buffer_load_dwordx4 v[180:183], v6, s[84:87], s51 offen offset:1024 sc1
    buffer_load_dwordx4 v[184:187], v6, s[84:87], s51 offen offset:2048 sc1
    buffer_load_dwordx4 v[188:191], v6, s[84:87], s51 offen offset:3072 sc1
    s_add_u32 s51, s56, 24576
    s_and_b32 s51, s51, 0x7fff
    s_add_u32 s51, s51, s50
    buffer_load_dwordx4 v[192:195], v6, s[84:87], s51 offen offset:0 sc1
    buffer_load_dwordx4 v[196:199], v6, s[84:87], s51 offen offset:1024 sc1
    buffer_load_dwordx4 v[200:203], v6, s[84:87], s51 offen offset:2048 sc1
    buffer_load_dwordx4 v[204:207], v6, s[84:87], s51 offen offset:3072 sc1
    s_add_u32 s51, s56, 28672
    s_and_b32 s51, s51, 0x7fff
    s_add_u32 s51, s51, s50
    buffer_load_dwordx4 v[208:211], v6, s[84:87], s51 offen offset:0 sc1
    buffer_load_dwordx4 v[212:215], v6, s[84:87], s51 offen offset:1024 sc1
    buffer_load_dwordx4 v[216:219], v6, s[84:87], s51 offen offset:2048 sc1
    buffer_load_dwordx4 v[220:223], v6, s[84:87], s51 offen offset:3072 sc1
    s_add_u32 s42, s42, 1
    s_branch mega_kernel_o_w1
mega_kernel_o_im2:
    v_add_u32 v2, s53, v8
    v_add_u32 v3, s53, v9
    v_add_u32 v4, s53, v10
    ds_write_b128 v2, v[224:227] offset:0
    ds_write_b128 v2, v[228:231] offset:1088
    ds_write_b128 v2, v[232:235] offset:2176
    ds_write_b128 v2, v[236:239] offset:3264
    ds_write_b128 v2, v[240:243] offset:4352
    ds_write_b128 v2, v[244:247] offset:5440
    ds_write_b128 v2, v[248:251] offset:6528
    ds_write_b128 v2, v[252:255] offset:7616
    s_waitcnt lgkmcnt(0)
    s_barrier
    ds_read_b128 v[52:55], v4 offset:0
    ds_read_b128 v[56:59], v4 offset:8704
    ds_read_b128 v[60:63], v4 offset:17408
    ds_read_b128 v[64:67], v4 offset:26112
    ds_read_b128 v[68:71], v3 offset:0
    ds_read_b128 v[72:75], v3 offset:8704
    ds_read_b128 v[76:79], v3 offset:17408
    ds_read_b128 v[80:83], v3 offset:26112
    s_sub_u32 s53, 34816, s53
    s_bfe_u32 s61, s42, 0x10001
    s_and_b32 s60, s42, 1
    s_lshl_b32 s60, s60, 12
    s_waitcnt lgkmcnt(4)
    v_add_f32 v52, v52, v56
    v_add_f32 v60, v60, v64
    v_add_f32 v53, v53, v57
    v_add_f32 v61, v61, v65
    v_add_f32 v54, v54, v58
    v_add_f32 v62, v62, v66
    v_add_f32 v55, v55, v59
    v_add_f32 v63, v63, v67
    v_add_f32 v52, v52, v60
    v_add_f32 v53, v53, v61
    v_add_f32 v54, v54, v62
    v_add_f32 v55, v55, v63
    v_and_or_b32 v52, v52, -2, s61
    s_cmp_eq_u32 s95, 0
    s_cbranch_scc1 mega_kernel_o_sa3
    buffer_store_dwordx4 v[52:55], v12, s[84:87], s60 offen sc1
    s_branch mega_kernel_o_sb3
    mega_kernel_o_sa3:
    buffer_store_dwordx4 v[52:55], v12, s[84:87], s60 offen
    mega_kernel_o_sb3:
    s_waitcnt lgkmcnt(0)
    v_add_f32 v68, v68, v72
    v_add_f32 v76, v76, v80
    v_add_f32 v69, v69, v73
    v_add_f32 v77, v77, v81
    v_add_f32 v70, v70, v74
    v_add_f32 v78, v78, v82
    v_add_f32 v71, v71, v75
    v_add_f32 v79, v79, v83
    v_add_f32 v84, v68, v76
    v_add_f32 v85, v69, v77
    v_add_f32 v86, v70, v78
    v_add_f32 v87, v71, v79
    s_and_b32 s60, s42, 1
    s_lshl_b32 s60, s60, 12
    buffer_load_dwordx4 v[88:91], v13, s[84:87], s60 offen sc1
    s_bfe_u32 s61, s42, 0x10001
    s_waitcnt vmcnt(0)
mega_kernel_o_f2c:
    v_and_b32 v14, 1, v88
    v_cmp_ne_u32 vcc, s61, v14
    s_cbranch_vccz mega_kernel_o_f2k
    s_and_b32 s60, s42, 1
    s_lshl_b32 s60, s60, 12
    buffer_load_dwordx4 v[88:91], v13, s[84:87], s60 offen sc1
    s_waitcnt vmcnt(0)
    s_branch mega_kernel_o_f2c
mega_kernel_o_f2k:
    v_pk_add_f32 v[88:89], v[88:89], v[84:85]
    v_pk_add_f32 v[90:91], v[90:91], v[86:87]
    s_lshl_b32 s60, s42, 17
    v_cvt_pk_bf16_f32 v92, v88, v89
    v_cvt_pk_bf16_f32 v93, v90, v91
    buffer_store_dwordx2 v[92:93], v11, s[8:11], s60 offen
    s_add_u32 s42, s42, 1
    s_cmp_lt_u32 s42, 64
    s_cbranch_scc1 mega_kernel_o_cold
mega_kernel_o_quit:
    s_endpgm
mega_kernel_f3s:
    v_mov_b32 v1, 0
    s_mov_b32 s82, 69259392
mega_kernel_w1:
    s_sleep 8
    buffer_load_dword v2, v1, s[84:87], s82 offen sc1
    s_waitcnt vmcnt(0)
    v_cmp_ne_u32 vcc, 95, v2
    s_cbranch_vccnz mega_kernel_w1
    s_add_u32 s93, s92, 0
    s_cmp_lt_u32 s93, 128
    s_cbranch_scc0 mega_kernel_f3e
mega_kernel_f3l:
    s_barrier
    s_load_dwordx2 s[4:5], s[0:1], 80
    s_load_dwordx2 s[8:9], s[0:1], 96
    v_and_b32 v6, 7, v0
    v_lshrrev_b32 v7, 3, v0
    s_movk_i32 s13, 8448
    v_mul_lo_u32 v8, v6, s13
    v_lshl_add_u32 v4, v7, 3, v8
    v_lshlrev_b32 v5, 14, v7
    v_lshl_add_u32 v5, v6, 4, v5
    s_lshl_b32 s12, s93, 7
    s_add_u32 s12, s12, 109051904
    s_waitcnt lgkmcnt(0)
    s_mov_b32 s6, 8388608
    s_mov_b32 s7, 0x00020000
    s_mov_b32 s10, 268435456
    s_mov_b32 s11, 0x00020000
    s_add_u32 s13, s12, 0
    buffer_load_dwordx4 v[16:19], v5, s[8:11], s13 offen
    s_add_u32 s13, s12, 524288
    buffer_load_dwordx4 v[20:23], v5, s[8:11], s13 offen
    s_add_u32 s13, s12, 1048576
    buffer_load_dwordx4 v[24:27], v5, s[8:11], s13 offen
    s_add_u32 s13, s12, 1572864
    buffer_load_dwordx4 v[28:31], v5, s[8:11], s13 offen
    s_add_u32 s13, s12, 2097152
    buffer_load_dwordx4 v[32:35], v5, s[8:11], s13 offen
    s_add_u32 s13, s12, 2621440
    buffer_load_dwordx4 v[36:39], v5, s[8:11], s13 offen
    s_add_u32 s13, s12, 3145728
    buffer_load_dwordx4 v[40:43], v5, s[8:11], s13 offen
    s_add_u32 s13, s12, 3670016
    buffer_load_dwordx4 v[44:47], v5, s[8:11], s13 offen
    s_add_u32 s13, s12, 4194304
    buffer_load_dwordx4 v[48:51], v5, s[8:11], s13 offen
    s_add_u32 s13, s12, 4718592
    buffer_load_dwordx4 v[52:55], v5, s[8:11], s13 offen
    s_add_u32 s13, s12, 5242880
    buffer_load_dwordx4 v[56:59], v5, s[8:11], s13 offen
    s_add_u32 s13, s12, 5767168
    buffer_load_dwordx4 v[60:63], v5, s[8:11], s13 offen
    s_add_u32 s13, s12, 6291456
    buffer_load_dwordx4 v[64:67], v5, s[8:11], s13 offen
    s_add_u32 s13, s12, 6815744
    buffer_load_dwordx4 v[68:71], v5, s[8:11], s13 offen
    s_add_u32 s13, s12, 7340032
    buffer_load_dwordx4 v[72:75], v5, s[8:11], s13 offen
    s_add_u32 s13, s12, 7864320
    buffer_load_dwordx4 v[76:79], v5, s[8:11], s13 offen
    s_add_u32 s13, s12, 8388608
    buffer_load_dwordx4 v[80:83], v5, s[8:11], s13 offen
    s_waitcnt vmcnt(0)
    v_cmp_eq_u32 vcc, 0, v7
    s_nop 1
    v_mov_b32 v9, 0
    v_cndmask_b32 v17, v17, v9, vcc
    v_cndmask_b32 v19, v19, v9, vcc
    v_cndmask_b32 v81, v81, v9, vcc
    v_cndmask_b32 v83, v83, v9, vcc
    v_sub_u32 v6, 1024, v7
    v_and_b32 v6, 1023, v6
    v_lshl_add_u32 v6, v6, 3, v8
    v_sub_f32 v10, v16, v19
    v_add_f32 v11, v17, v18
    v_add_f32 v12, v16, v19
    v_sub_f32 v13, v18, v17
    ds_write_b64 v4, v[10:11] offset:0
    ds_write_b64 v6, v[12:13]
    v_sub_u32 v6, 992, v7
    v_and_b32 v6, 1023, v6
    v_lshl_add_u32 v6, v6, 3, v8
    v_sub_f32 v10, v20, v23
    v_add_f32 v11, v21, v22
    v_add_f32 v12, v20, v23
    v_sub_f32 v13, v22, v21
    ds_write_b64 v4, v[10:11] offset:256
    ds_write_b64 v6, v[12:13]
    v_sub_u32 v6, 960, v7
    v_and_b32 v6, 1023, v6
    v_lshl_add_u32 v6, v6, 3, v8
    v_sub_f32 v10, v24, v27
    v_add_f32 v11, v25, v26
    v_add_f32 v12, v24, v27
    v_sub_f32 v13, v26, v25
    ds_write_b64 v4, v[10:11] offset:512
    ds_write_b64 v6, v[12:13]
    v_sub_u32 v6, 928, v7
    v_and_b32 v6, 1023, v6
    v_lshl_add_u32 v6, v6, 3, v8
    v_sub_f32 v10, v28, v31
    v_add_f32 v11, v29, v30
    v_add_f32 v12, v28, v31
    v_sub_f32 v13, v30, v29
    ds_write_b64 v4, v[10:11] offset:768
    ds_write_b64 v6, v[12:13]
    v_sub_u32 v6, 896, v7
    v_and_b32 v6, 1023, v6
    v_lshl_add_u32 v6, v6, 3, v8
    v_sub_f32 v10, v32, v35
    v_add_f32 v11, v33, v34
    v_add_f32 v12, v32, v35
    v_sub_f32 v13, v34, v33
    ds_write_b64 v4, v[10:11] offset:1024
    ds_write_b64 v6, v[12:13]
    v_sub_u32 v6, 864, v7
    v_and_b32 v6, 1023, v6
    v_lshl_add_u32 v6, v6, 3, v8
    v_sub_f32 v10, v36, v39
    v_add_f32 v11, v37, v38
    v_add_f32 v12, v36, v39
    v_sub_f32 v13, v38, v37
    ds_write_b64 v4, v[10:11] offset:1280
    ds_write_b64 v6, v[12:13]
    v_sub_u32 v6, 832, v7
    v_and_b32 v6, 1023, v6
    v_lshl_add_u32 v6, v6, 3, v8
    v_sub_f32 v10, v40, v43
    v_add_f32 v11, v41, v42
    v_add_f32 v12, v40, v43
    v_sub_f32 v13, v42, v41
    ds_write_b64 v4, v[10:11] offset:1536
    ds_write_b64 v6, v[12:13]
    v_sub_u32 v6, 800, v7
    v_and_b32 v6, 1023, v6
    v_lshl_add_u32 v6, v6, 3, v8
    v_sub_f32 v10, v44, v47
    v_add_f32 v11, v45, v46
    v_add_f32 v12, v44, v47
    v_sub_f32 v13, v46, v45
    ds_write_b64 v4, v[10:11] offset:1792
    ds_write_b64 v6, v[12:13]
    v_sub_u32 v6, 768, v7
    v_and_b32 v6, 1023, v6
    v_lshl_add_u32 v6, v6, 3, v8
    v_sub_f32 v10, v48, v51
    v_add_f32 v11, v49, v50
    v_add_f32 v12, v48, v51
    v_sub_f32 v13, v50, v49
    ds_write_b64 v4, v[10:11] offset:2048
    ds_write_b64 v6, v[12:13]
    v_sub_u32 v6, 736, v7
    v_and_b32 v6, 1023, v6
    v_lshl_add_u32 v6, v6, 3, v8
    v_sub_f32 v10, v52, v55
    v_add_f32 v11, v53, v54
    v_add_f32 v12, v52, v55
    v_sub_f32 v13, v54, v53
    ds_write_b64 v4, v[10:11] offset:2304
    ds_write_b64 v6, v[12:13]
    v_sub_u32 v6, 704, v7
    v_and_b32 v6, 1023, v6
    v_lshl_add_u32 v6, v6, 3, v8
    v_sub_f32 v10, v56, v59
    v_add_f32 v11, v57, v58
    v_add_f32 v12, v56, v59
    v_sub_f32 v13, v58, v57
    ds_write_b64 v4, v[10:11] offset:2560
    ds_write_b64 v6, v[12:13]
    v_sub_u32 v6, 672, v7
    v_and_b32 v6, 1023, v6
    v_lshl_add_u32 v6, v6, 3, v8
    v_sub_f32 v10, v60, v63
    v_add_f32 v11, v61, v62
    v_add_f32 v12, v60, v63
    v_sub_f32 v13, v62, v61
    ds_write_b64 v4, v[10:11] offset:2816
    ds_write_b64 v6, v[12:13]
    v_sub_u32 v6, 640, v7
    v_and_b32 v6, 1023, v6
    v_lshl_add_u32 v6, v6, 3, v8
    v_sub_f32 v10, v64, v67
    v_add_f32 v11, v65, v66
    v_add_f32 v12, v64, v67
    v_sub_f32 v13, v66, v65
    ds_write_b64 v4, v[10:11] offset:3072
    ds_write_b64 v6, v[12:13]
    v_sub_u32 v6, 608, v7
    v_and_b32 v6, 1023, v6
    v_lshl_add_u32 v6, v6, 3, v8
    v_sub_f32 v10, v68, v71
    v_add_f32 v11, v69, v70
    v_add_f32 v12, v68, v71
    v_sub_f32 v13, v70, v69
    ds_write_b64 v4, v[10:11] offset:3328
    ds_write_b64 v6, v[12:13]
    v_sub_u32 v6, 576, v7
    v_and_b32 v6, 1023, v6
    v_lshl_add_u32 v6, v6, 3, v8
    v_sub_f32 v10, v72, v75
    v_add_f32 v11, v73, v74
    v_add_f32 v12, v72, v75
    v_sub_f32 v13, v74, v73
    ds_write_b64 v4, v[10:11] offset:3584
    ds_write_b64 v6, v[12:13]
    v_sub_u32 v6, 544, v7
    v_and_b32 v6, 1023, v6
    v_lshl_add_u32 v6, v6, 3, v8
    v_sub_f32 v10, v76, v79
    v_add_f32 v11, v77, v78
    v_add_f32 v12, v76, v79
    v_sub_f32 v13, v78, v77
    ds_write_b64 v4, v[10:11] offset:3840
    ds_write_b64 v6, v[12:13]
    s_and_saveexec_b64 s[14:15], vcc
    v_sub_u32 v6, 512, v7
    v_and_b32 v6, 1023, v6
    v_lshl_add_u32 v6, v6, 3, v8
    v_sub_f32 v10, v80, v83
    v_add_f32 v11, v81, v82
    v_add_f32 v12, v80, v83
    v_sub_f32 v13, v82, v81
    ds_write_b64 v4, v[10:11] offset:4096
    ds_write_b64 v6, v[12:13]
    s_mov_b64 exec, s[14:15]
    s_waitcnt lgkmcnt(0)
    s_barrier
    v_and_b32 v1, 31, v0
    v_lshrrev_b32 v2, 5, v0
    v_cvt_f32_u32 v3, v1
    s_movk_i32 s13, 8448
    v_mul_lo_u32 v7, v2, s13
    v_lshl_add_u32 v4, v1, 3, v7
    s_movk_i32 s13, 264
    v_mul_lo_u32 v5, v1, s13
    v_add_u32 v5, v5, v7
    ds_read_b32 v16, v4 offset:0
    ds_read_b32 v48, v4 offset:4
    ds_read_b32 v17, v4 offset:256
    ds_read_b32 v49, v4 offset:260
    ds_read_b32 v18, v4 offset:512
    ds_read_b32 v50, v4 offset:516
    ds_read_b32 v19, v4 offset:768
    ds_read_b32 v51, v4 offset:772
    ds_read_b32 v20, v4 offset:1024
    ds_read_b32 v52, v4 offset:1028
    ds_read_b32 v21, v4 offset:1280
    ds_read_b32 v53, v4 offset:1284
    ds_read_b32 v22, v4 offset:1536
    ds_read_b32 v54, v4 offset:1540
    s_waitcnt lgkmcnt(0)
    ds_read_b32 v23, v4 offset:1792
    ds_read_b32 v55, v4 offset:1796
    ds_read_b32 v24, v4 offset:2048
    ds_read_b32 v56, v4 offset:2052
    ds_read_b32 v25, v4 offset:2304
    ds_read_b32 v57, v4 offset:2308
    ds_read_b32 v26, v4 offset:2560
    ds_read_b32 v58, v4 offset:2564
    ds_read_b32 v27, v4 offset:2816
    ds_read_b32 v59, v4 offset:2820
    ds_read_b32 v28, v4 offset:3072
    ds_read_b32 v60, v4 offset:3076
    ds_read_b32 v29, v4 offset:3328
    ds_read_b32 v61, v4 offset:3332
    s_waitcnt lgkmcnt(0)
    ds_read_b32 v30, v4 offset:3584
    ds_read_b32 v62, v4 offset:3588
    ds_read_b32 v31, v4 offset:3840
    ds_read_b32 v63, v4 offset:3844
    ds_read_b32 v32, v4 offset:4096
    ds_read_b32 v64, v4 offset:4100
    ds_read_b32 v33, v4 offset:4352
    ds_read_b32 v65, v4 offset:4356
    ds_read_b32 v34, v4 offset:4608
    ds_read_b32 v66, v4 offset:4612
    ds_read_b32 v35, v4 offset:4864
    ds_read_b32 v67, v4 offset:4868
    ds_read_b32 v36, v4 offset:5120
    ds_read_b32 v68, v4 offset:5124
    s_waitcnt lgkmcnt(0)
    ds_read_b32 v37, v4 offset:5376
    ds_read_b32 v69, v4 offset:5380
    ds_read_b32 v38, v4 offset:5632
    ds_read_b32 v70, v4 offset:5636
    ds_read_b32 v39, v4 offset:5888
    ds_read_b32 v71, v4 offset:5892
    ds_read_b32 v40, v4 offset:6144
    ds_read_b32 v72, v4 offset:6148
    ds_read_b32 v41, v4 offset:6400
    ds_read_b32 v73, v4 offset:6404
    ds_read_b32 v42, v4 offset:6656
    ds_read_b32 v74, v4 offset:6660
    ds_read_b32 v43, v4 offset:6912
    ds_read_b32 v75, v4 offset:6916
    s_waitcnt lgkmcnt(0)
    ds_read_b32 v44, v4 offset:7168
    ds_read_b32 v76, v4 offset:7172
    ds_read_b32 v45, v4 offset:7424
    ds_read_b32 v77, v4 offset:7428
    ds_read_b32 v46, v4 offset:7680
    ds_read_b32 v78, v4 offset:7684
    ds_read_b32 v47, v4 offset:7936
    ds_read_b32 v79, v4 offset:7940
    s_waitcnt lgkmcnt(0)
    v_sub_f32 v80, v16, v32
    v_sub_f32 v81, v48, v64
    v_add_f32 v16, v16, v32
    v_add_f32 v48, v48, v64
    v_sub_f32 v32, v17, v33
    v_sub_f32 v64, v49, v65
    v_add_f32 v17, v17, v33
    v_add_f32 v49, v49, v65
    v_mul_f32 v33, 0x3f7b14be, v32
    v_mul_f32 v65, 0x3e47c5c2, v32
    v_fmac_f32 v33, 0xbe47c5c2, v64
    v_fmac_f32 v65, 0x3f7b14be, v64
    v_sub_f32 v32, v18, v34
    v_sub_f32 v64, v50, v66
    v_add_f32 v18, v18, v34
    v_add_f32 v50, v50, v66
    v_mul_f32 v34, 0x3f6c835e, v32
    v_mul_f32 v66, 0x3ec3ef15, v32
    v_fmac_f32 v34, 0xbec3ef15, v64
    v_fmac_f32 v66, 0x3f6c835e, v64
    v_sub_f32 v32, v19, v35
    v_sub_f32 v64, v51, v67
    v_add_f32 v19, v19, v35
    v_add_f32 v51, v51, v67
    v_mul_f32 v35, 0x3f54db31, v32
    v_mul_f32 v67, 0x3f0e39da, v32
    v_fmac_f32 v35, 0xbf0e39da, v64
    v_fmac_f32 v67, 0x3f54db31, v64
    v_sub_f32 v32, v20, v36
    v_sub_f32 v64, v52, v68
    v_add_f32 v20, v20, v36
    v_add_f32 v52, v52, v68
    v_mul_f32 v36, 0x3f3504f3, v32
    v_mul_f32 v68, 0x3f3504f3, v32
    v_fmac_f32 v36, 0xbf3504f3, v64
    v_fmac_f32 v68, 0x3f3504f3, v64
    v_sub_f32 v32, v21, v37
    v_sub_f32 v64, v53, v69
    v_add_f32 v21, v21, v37
    v_add_f32 v53, v53, v69
    v_mul_f32 v37, 0x3f0e39da, v32
    v_mul_f32 v69, 0x3f54db31, v32
    v_fmac_f32 v37, 0xbf54db31, v64
    v_fmac_f32 v69, 0x3f0e39da, v64
    v_sub_f32 v32, v22, v38
    v_sub_f32 v64, v54, v70
    v_add_f32 v22, v22, v38
    v_add_f32 v54, v54, v70
    v_mul_f32 v38, 0x3ec3ef15, v32
    v_mul_f32 v70, 0x3f6c835e, v32
    v_fmac_f32 v38, 0xbf6c835e, v64
    v_fmac_f32 v70, 0x3ec3ef15, v64
    v_sub_f32 v32, v23, v39
    v_sub_f32 v64, v55, v71
    v_add_f32 v23, v23, v39
    v_add_f32 v55, v55, v71
    v_mul_f32 v39, 0x3e47c5c2, v32
    v_mul_f32 v71, 0x3f7b14be, v32
    v_fmac_f32 v39, 0xbf7b14be, v64
    v_fmac_f32 v71, 0x3e47c5c2, v64
    v_sub_f32 v32, v72, v56
    v_sub_f32 v64, v24, v40
    v_add_f32 v24, v24, v40
    v_add_f32 v56, v56, v72
    v_sub_f32 v40, v25, v41
    v_sub_f32 v72, v57, v73
    v_add_f32 v25, v25, v41
    v_add_f32 v57, v57, v73
    v_mul_f32 v41, 0xbe47c5c2, v40
    v_mul_f32 v73, 0x3f7b14be, v40
    v_fmac_f32 v41, 0xbf7b14be, v72
    v_fmac_f32 v73, 0xbe47c5c2, v72
    v_sub_f32 v40, v26, v42
    v_sub_f32 v72, v58, v74
    v_add_f32 v26, v26, v42
    v_add_f32 v58, v58, v74
    v_mul_f32 v42, 0xbec3ef15, v40
    v_mul_f32 v74, 0x3f6c835e, v40
    v_fmac_f32 v42, 0xbf6c835e, v72
    v_fmac_f32 v74, 0xbec3ef15, v72
    v_sub_f32 v40, v27, v43
    v_sub_f32 v72, v59, v75
    v_add_f32 v27, v27, v43
    v_add_f32 v59, v59, v75
    v_mul_f32 v43, 0xbf0e39da, v40
    v_mul_f32 v75, 0x3f54db31, v40
    v_fmac_f32 v43, 0xbf54db31, v72
    v_fmac_f32 v75, 0xbf0e39da, v72
    v_sub_f32 v40, v28, v44
    v_sub_f32 v72, v60, v76
    v_add_f32 v28, v28, v44
    v_add_f32 v60, v60, v76
    v_mul_f32 v44, 0xbf3504f3, v40
    v_mul_f32 v76, 0x3f3504f3, v40
    v_fmac_f32 v44, 0xbf3504f3, v72
    v_fmac_f32 v76, 0xbf3504f3, v72
    v_sub_f32 v40, v29, v45
    v_sub_f32 v72, v61, v77
    v_add_f32 v29, v29, v45
    v_add_f32 v61, v61, v77
    v_mul_f32 v45, 0xbf54db31, v40
    v_mul_f32 v77, 0x3f0e39da, v40
    v_fmac_f32 v45, 0xbf0e39da, v72
    v_fmac_f32 v77, 0xbf54db31, v72
    v_sub_f32 v40, v30, v46
    v_sub_f32 v72, v62, v78
    v_add_f32 v30, v30, v46
    v_add_f32 v62, v62, v78
    v_mul_f32 v46, 0xbf6c835e, v40
    v_mul_f32 v78, 0x3ec3ef15, v40
    v_fmac_f32 v46, 0xbec3ef15, v72
    v_fmac_f32 v78, 0xbf6c835e, v72
    v_sub_f32 v40, v31, v47
    v_sub_f32 v72, v63, v79
    v_add_f32 v31, v31, v47
    v_add_f32 v63, v63, v79
    v_mul_f32 v47, 0xbf7b14be, v40
    v_mul_f32 v79, 0x3e47c5c2, v40
    v_fmac_f32 v47, 0xbe47c5c2, v72
    v_fmac_f32 v79, 0xbf7b14be, v72
    v_sub_f32 v40, v16, v24
    v_sub_f32 v72, v48, v56
    v_add_f32 v16, v16, v24
    v_add_f32 v48, v48, v56
    v_sub_f32 v24, v17, v25
    v_sub_f32 v56, v49, v57
    v_add_f32 v17, v17, v25
    v_add_f32 v49, v49, v57
    v_mul_f32 v25, 0x3f6c835e, v24
    v_mul_f32 v57, 0x3ec3ef15, v24
    v_fmac_f32 v25, 0xbec3ef15, v56
    v_fmac_f32 v57, 0x3f6c835e, v56
    v_sub_f32 v24, v18, v26
    v_sub_f32 v56, v50, v58
    v_add_f32 v18, v18, v26
    v_add_f32 v50, v50, v58
    v_mul_f32 v26, 0x3f3504f3, v24
    v_mul_f32 v58, 0x3f3504f3, v24
    v_fmac_f32 v26, 0xbf3504f3, v56
    v_fmac_f32 v58, 0x3f3504f3, v56
    v_sub_f32 v24, v19, v27
    v_sub_f32 v56, v51, v59
    v_add_f32 v19, v19, v27
    v_add_f32 v51, v51, v59
    v_mul_f32 v27, 0x3ec3ef15, v24
    v_mul_f32 v59, 0x3f6c835e, v24
    v_fmac_f32 v27, 0xbf6c835e, v56
    v_fmac_f32 v59, 0x3ec3ef15, v56
    v_sub_f32 v24, v60, v52
    v_sub_f32 v56, v20, v28
    v_add_f32 v20, v20, v28
    v_add_f32 v52, v52, v60
    v_sub_f32 v28, v21, v29
    v_sub_f32 v60, v53, v61
    v_add_f32 v21, v21, v29
    v_add_f32 v53, v53, v61
    v_mul_f32 v29, 0xbec3ef15, v28
    v_mul_f32 v61, 0x3f6c835e, v28
    v_fmac_f32 v29, 0xbf6c835e, v60
    v_fmac_f32 v61, 0xbec3ef15, v60
    v_sub_f32 v28, v22, v30
    v_sub_f32 v60, v54, v62
    v_add_f32 v22, v22, v30
    v_add_f32 v54, v54, v62
    v_mul_f32 v30, 0xbf3504f3, v28
    v_mul_f32 v62, 0x3f3504f3, v28
    v_fmac_f32 v30, 0xbf3504f3, v60
    v_fmac_f32 v62, 0xbf3504f3, v60
    v_sub_f32 v28, v23, v31
    v_sub_f32 v60, v55, v63
    v_add_f32 v23, v23, v31
    v_add_f32 v55, v55, v63
    v_mul_f32 v31, 0xbf6c835e, v28
    v_mul_f32 v63, 0x3ec3ef15, v28
    v_fmac_f32 v31, 0xbec3ef15, v60
    v_fmac_f32 v63, 0xbf6c835e, v60
    v_sub_f32 v28, v80, v32
    v_sub_f32 v60, v81, v64
    v_add_f32 v80, v80, v32
    v_add_f32 v81, v81, v64
    v_sub_f32 v32, v33, v41
    v_sub_f32 v64, v65, v73
    v_add_f32 v33, v33, v41
    v_add_f32 v65, v65, v73
    v_mul_f32 v41, 0x3f6c835e, v32
    v_mul_f32 v73, 0x3ec3ef15, v32
    v_fmac_f32 v41, 0xbec3ef15, v64
    v_fmac_f32 v73, 0x3f6c835e, v64
    v_sub_f32 v32, v34, v42
    v_sub_f32 v64, v66, v74
    v_add_f32 v34, v34, v42
    v_add_f32 v66, v66, v74
    v_mul_f32 v42, 0x3f3504f3, v32
    v_mul_f32 v74, 0x3f3504f3, v32
    v_fmac_f32 v42, 0xbf3504f3, v64
    v_fmac_f32 v74, 0x3f3504f3, v64
    v_sub_f32 v32, v35, v43
    v_sub_f32 v64, v67, v75
    v_add_f32 v35, v35, v43
    v_add_f32 v67, v67, v75
    v_mul_f32 v43, 0x3ec3ef15, v32
    v_mul_f32 v75, 0x3f6c835e, v32
    v_fmac_f32 v43, 0xbf6c835e, v64
    v_fmac_f32 v75, 0x3ec3ef15, v64
    v_sub_f32 v32, v76, v68
    v_sub_f32 v64, v36, v44
    v_add_f32 v36, v36, v44
    v_add_f32 v68, v68, v76
    v_sub_f32 v44, v37, v45
    v_sub_f32 v76, v69, v77
    v_add_f32 v37, v37, v45
    v_add_f32 v69, v69, v77
    v_mul_f32 v45, 0xbec3ef15, v44
    v_mul_f32 v77, 0x3f6c835e, v44
    v_fmac_f32 v45, 0xbf6c835e, v76
    v_fmac_f32 v77, 0xbec3ef15, v76
    v_sub_f32 v44, v38, v46
    v_sub_f32 v76, v70, v78
    v_add_f32 v38, v38, v46
    v_add_f32 v70, v70, v78
    v_mul_f32 v46, 0xbf3504f3, v44
    v_mul_f32 v78, 0x3f3504f3, v44
    v_fmac_f32 v46, 0xbf3504f3, v76
    v_fmac_f32 v78, 0xbf3504f3, v76
    v_sub_f32 v44, v39, v47
    v_sub_f32 v76, v71, v79
    v_add_f32 v39, v39, v47
    v_add_f32 v71, v71, v79
    v_mul_f32 v47, 0xbf6c835e, v44
    v_mul_f32 v79, 0x3ec3ef15, v44
    v_fmac_f32 v47, 0xbec3ef15, v76
    v_fmac_f32 v79, 0xbf6c835e, v76
    v_sub_f32 v44, v16, v20
    v_sub_f32 v76, v48, v52
    v_add_f32 v16, v16, v20
    v_add_f32 v48, v48, v52
    v_sub_f32 v20, v17, v21
    v_sub_f32 v52, v49, v53
    v_add_f32 v17, v17, v21
    v_add_f32 v49, v49, v53
    v_mul_f32 v21, 0x3f3504f3, v20
    v_mul_f32 v53, 0x3f3504f3, v20
    v_fmac_f32 v21, 0xbf3504f3, v52
    v_fmac_f32 v53, 0x3f3504f3, v52
    v_sub_f32 v20, v54, v50
    v_sub_f32 v52, v18, v22
    v_add_f32 v18, v18, v22
    v_add_f32 v50, v50, v54
    v_sub_f32 v22, v19, v23
    v_sub_f32 v54, v51, v55
    v_add_f32 v19, v19, v23
    v_add_f32 v51, v51, v55
    v_mul_f32 v23, 0xbf3504f3, v22
    v_mul_f32 v55, 0x3f3504f3, v22
    v_fmac_f32 v23, 0xbf3504f3, v54
    v_fmac_f32 v55, 0xbf3504f3, v54
    v_sub_f32 v22, v40, v24
    v_sub_f32 v54, v72, v56
    v_add_f32 v40, v40, v24
    v_add_f32 v72, v72, v56
    v_sub_f32 v24, v25, v29
    v_sub_f32 v56, v57, v61
    v_add_f32 v25, v25, v29
    v_add_f32 v57, v57, v61
    v_mul_f32 v29, 0x3f3504f3, v24
    v_mul_f32 v61, 0x3f3504f3, v24
    v_fmac_f32 v29, 0xbf3504f3, v56
    v_fmac_f32 v61, 0x3f3504f3, v56
    v_sub_f32 v24, v62, v58
    v_sub_f32 v56, v26, v30
    v_add_f32 v26, v26, v30
    v_add_f32 v58, v58, v62
    v_sub_f32 v30, v27, v31
    v_sub_f32 v62, v59, v63
    v_add_f32 v27, v27, v31
    v_add_f32 v59, v59, v63
    v_mul_f32 v31, 0xbf3504f3, v30
    v_mul_f32 v63, 0x3f3504f3, v30
    v_fmac_f32 v31, 0xbf3504f3, v62
    v_fmac_f32 v63, 0xbf3504f3, v62
    v_sub_f32 v30, v80, v36
    v_sub_f32 v62, v81, v68
    v_add_f32 v80, v80, v36
    v_add_f32 v81, v81, v68
    v_sub_f32 v36, v33, v37
    v_sub_f32 v68, v65, v69
    v_add_f32 v33, v33, v37
    v_add_f32 v65, v65, v69
    v_mul_f32 v37, 0x3f3504f3, v36
    v_mul_f32 v69, 0x3f3504f3, v36
    v_fmac_f32 v37, 0xbf3504f3, v68
    v_fmac_f32 v69, 0x3f3504f3, v68
    v_sub_f32 v36, v70, v66
    v_sub_f32 v68, v34, v38
    v_add_f32 v34, v34, v38
    v_add_f32 v66, v66, v70
    v_sub_f32 v38, v35, v39
    v_sub_f32 v70, v67, v71
    v_add_f32 v35, v35, v39
    v_add_f32 v67, v67, v71
    v_mul_f32 v39, 0xbf3504f3, v38
    v_mul_f32 v71, 0x3f3504f3, v38
    v_fmac_f32 v39, 0xbf3504f3, v70
    v_fmac_f32 v71, 0xbf3504f3, v70
    v_sub_f32 v38, v28, v32
    v_sub_f32 v70, v60, v64
    v_add_f32 v28, v28, v32
    v_add_f32 v60, v60, v64
    v_sub_f32 v32, v41, v45
    v_sub_f32 v64, v73, v77
    v_add_f32 v41, v41, v45
    v_add_f32 v73, v73, v77
    v_mul_f32 v45, 0x3f3504f3, v32
    v_mul_f32 v77, 0x3f3504f3, v32
    v_fmac_f32 v45, 0xbf3504f3, v64
    v_fmac_f32 v77, 0x3f3504f3, v64
    v_sub_f32 v32, v78, v74
    v_sub_f32 v64, v42, v46
    v_add_f32 v42, v42, v46
    v_add_f32 v74, v74, v78
    v_sub_f32 v46, v43, v47
    v_sub_f32 v78, v75, v79
    v_add_f32 v43, v43, v47
    v_add_f32 v75, v75, v79
    v_mul_f32 v47, 0xbf3504f3, v46
    v_mul_f32 v79, 0x3f3504f3, v46
    v_fmac_f32 v47, 0xbf3504f3, v78
    v_fmac_f32 v79, 0xbf3504f3, v78
    v_sub_f32 v46, v16, v18
    v_sub_f32 v78, v48, v50
    v_add_f32 v16, v16, v18
    v_add_f32 v48, v48, v50
    v_sub_f32 v18, v51, v49
    v_sub_f32 v50, v17, v19
    v_add_f32 v17, v17, v19
    v_add_f32 v49, v49, v51
    v_sub_f32 v19, v44, v20
    v_sub_f32 v51, v76, v52
    v_add_f32 v44, v44, v20
    v_add_f32 v76, v76, v52
    v_sub_f32 v20, v55, v53
    v_sub_f32 v52, v21, v23
    v_add_f32 v21, v21, v23
    v_add_f32 v53, v53, v55
    v_sub_f32 v23, v40, v26
    v_sub_f32 v55, v72, v58
    v_add_f32 v40, v40, v26
    v_add_f32 v72, v72, v58
    v_sub_f32 v26, v59, v57
    v_sub_f32 v58, v25, v27
    v_add_f32 v25, v25, v27
    v_add_f32 v57, v57, v59
    v_sub_f32 v27, v22, v24
    v_sub_f32 v59, v54, v56
    v_add_f32 v22, v22, v24
    v_add_f32 v54, v54, v56
    v_sub_f32 v24, v63, v61
    v_sub_f32 v56, v29, v31
    v_add_f32 v29, v29, v31
    v_add_f32 v61, v61, v63
    v_sub_f32 v31, v80, v34
    v_sub_f32 v63, v81, v66
    v_add_f32 v80, v80, v34
    v_add_f32 v81, v81, v66
    v_sub_f32 v34, v67, v65
    v_sub_f32 v66, v33, v35
    v_add_f32 v33, v33, v35
    v_add_f32 v65, v65, v67
    v_sub_f32 v35, v30, v36
    v_sub_f32 v67, v62, v68
    v_add_f32 v30, v30, v36
    v_add_f32 v62, v62, v68
    v_sub_f32 v36, v71, v69
    v_sub_f32 v68, v37, v39
    v_add_f32 v37, v37, v39
    v_add_f32 v69, v69, v71
    v_sub_f32 v39, v28, v42
    v_sub_f32 v71, v60, v74
    v_add_f32 v28, v28, v42
    v_add_f32 v60, v60, v74
    v_sub_f32 v42, v75, v73
    v_sub_f32 v74, v41, v43
    v_add_f32 v41, v41, v43
    v_add_f32 v73, v73, v75
    v_sub_f32 v43, v38, v32
    v_sub_f32 v75, v70, v64
    v_add_f32 v38, v38, v32
    v_add_f32 v70, v70, v64
    v_sub_f32 v32, v79, v77
    v_sub_f32 v64, v45, v47
    v_add_f32 v45, v45, v47
    v_add_f32 v77, v77, v79
    v_sub_f32 v47, v16, v17
    v_sub_f32 v79, v48, v49
    v_add_f32 v16, v16, v17
    v_add_f32 v48, v48, v49
    v_sub_f32 v17, v46, v18
    v_sub_f32 v49, v78, v50
    v_add_f32 v46, v46, v18
    v_add_f32 v78, v78, v50
    v_sub_f32 v18, v44, v21
    v_sub_f32 v50, v76, v53
    v_add_f32 v44, v44, v21
    v_add_f32 v76, v76, v53
    v_sub_f32 v21, v19, v20
    v_sub_f32 v53, v51, v52
    v_add_f32 v19, v19, v20
    v_add_f32 v51, v51, v52
    v_sub_f32 v20, v40, v25
    v_sub_f32 v52, v72, v57
    v_add_f32 v40, v40, v25
    v_add_f32 v72, v72, v57
    v_sub_f32 v25, v23, v26
    v_sub_f32 v57, v55, v58
    v_add_f32 v23, v23, v26
    v_add_f32 v55, v55, v58
    v_sub_f32 v26, v22, v29
    v_sub_f32 v58, v54, v61
    v_add_f32 v22, v22, v29
    v_add_f32 v54, v54, v61
    v_sub_f32 v29, v27, v24
    v_sub_f32 v61, v59, v56
    v_add_f32 v27, v27, v24
    v_add_f32 v59, v59, v56
    v_sub_f32 v24, v80, v33
    v_sub_f32 v56, v81, v65
    v_add_f32 v80, v80, v33
    v_add_f32 v81, v81, v65
    v_sub_f32 v33, v31, v34
    v_sub_f32 v65, v63, v66
    v_add_f32 v31, v31, v34
    v_add_f32 v63, v63, v66
    v_sub_f32 v34, v30, v37
    v_sub_f32 v66, v62, v69
    v_add_f32 v30, v30, v37
    v_add_f32 v62, v62, v69
    v_sub_f32 v37, v35, v36
    v_sub_f32 v69, v67, v68
    v_add_f32 v35, v35, v36
    v_add_f32 v67, v67, v68
    v_sub_f32 v36, v28, v41
    v_sub_f32 v68, v60, v73
    v_add_f32 v28, v28, v41
    v_add_f32 v60, v60, v73
    v_sub_f32 v41, v39, v42
    v_sub_f32 v73, v71, v74
    v_add_f32 v39, v39, v42
    v_add_f32 v71, v71, v74
    v_sub_f32 v42, v38, v45
    v_sub_f32 v74, v70, v77
    v_add_f32 v38, v38, v45
    v_add_f32 v70, v70, v77
    v_sub_f32 v45, v43, v32
    v_sub_f32 v77, v75, v64
    v_add_f32 v43, v43, v32
    v_add_f32 v75, v75, v64
    v_mul_f32 v32, 0x3a800000, v3
    v_cos_f32 v64, v32
    v_sin_f32 v82, v32
    s_nop 0
    v_mul_f32 v83, v80, v64
    v_fma_f32 v83, -v81, v82, v83
    v_mul_f32 v81, v81, v64
    v_fmac_f32 v81, v80, v82
    v_mul_f32 v32, 0x3b000000, v3
    v_cos_f32 v64, v32
    v_sin_f32 v82, v32
    s_nop 0
    v_mul_f32 v80, v40, v64
    v_fma_f32 v80, -v72, v82, v80
    v_mul_f32 v72, v72, v64
    v_fmac_f32 v72, v40, v82
    v_mul_f32 v32, 0x3b400000, v3
    v_cos_f32 v64, v32
    v_sin_f32 v82, v32
    s_nop 0
    v_mul_f32 v40, v28, v64
    v_fma_f32 v40, -v60, v82, v40
    v_mul_f32 v60, v60, v64
    v_fmac_f32 v60, v28, v82
    v_mul_f32 v32, 0x3b800000, v3
    v_cos_f32 v64, v32
    v_sin_f32 v82, v32
    s_nop 0
    v_mul_f32 v28, v44, v64
    v_fma_f32 v28, -v76, v82, v28
    v_mul_f32 v76, v76, v64
    v_fmac_f32 v76, v44, v82
    v_mul_f32 v32, 0x3ba00000, v3
    v_cos_f32 v64, v32
    v_sin_f32 v82, v32
    s_nop 0
    v_mul_f32 v44, v30, v64
    v_fma_f32 v44, -v62, v82, v44
    v_mul_f32 v62, v62, v64
    v_fmac_f32 v62, v30, v82
    v_mul_f32 v32, 0x3bc00000, v3
    v_cos_f32 v64, v32
    v_sin_f32 v82, v32
    s_nop 0
    v_mul_f32 v30, v22, v64
    v_fma_f32 v30, -v54, v82, v30
    v_mul_f32 v54, v54, v64
    v_fmac_f32 v54, v22, v82
    v_mul_f32 v32, 0x3be00000, v3
    v_cos_f32 v64, v32
    v_sin_f32 v82, v32
    s_nop 0
    v_mul_f32 v22, v38, v64
    v_fma_f32 v22, -v70, v82, v22
    v_mul_f32 v70, v70, v64
    v_fmac_f32 v70, v38, v82
    v_mul_f32 v32, 0x3c000000, v3
    v_cos_f32 v64, v32
    v_sin_f32 v82, v32
    s_nop 0
    v_mul_f32 v38, v46, v64
    v_fma_f32 v38, -v78, v82, v38
    v_mul_f32 v78, v78, v64
    v_fmac_f32 v78, v46, v82
    v_mul_f32 v32, 0x3c100000, v3
    v_cos_f32 v64, v32
    v_sin_f32 v82, v32
    s_nop 0
    v_mul_f32 v46, v31, v64
    v_fma_f32 v46, -v63, v82, v46
    v_mul_f32 v63, v63, v64
    v_fmac_f32 v63, v31, v82
    v_mul_f32 v32, 0x3c200000, v3
    v_cos_f32 v64, v32
    v_sin_f32 v82, v32
    s_nop 0
    v_mul_f32 v31, v23, v64
    v_fma_f32 v31, -v55, v82, v31
    v_mul_f32 v55, v55, v64
    v_fmac_f32 v55, v23, v82
    v_mul_f32 v32, 0x3c300000, v3
    v_cos_f32 v64, v32
    v_sin_f32 v82, v32
    s_nop 0
    v_mul_f32 v23, v39, v64
    v_fma_f32 v23, -v71, v82, v23
    v_mul_f32 v71, v71, v64
    v_fmac_f32 v71, v39, v82
    v_mul_f32 v32, 0x3c400000, v3
    v_cos_f32 v64, v32
    v_sin_f32 v82, v32
    s_nop 0
    v_mul_f32 v39, v19, v64
    v_fma_f32 v39, -v51, v82, v39
    v_mul_f32 v51, v51, v64
    v_fmac_f32 v51, v19, v82
    v_mul_f32 v32, 0x3c500000, v3
    v_cos_f32 v64, v32
    v_sin_f32 v82, v32
    s_nop 0
    v_mul_f32 v19, v35, v64
    v_fma_f32 v19, -v67, v82, v19
    v_mul_f32 v67, v67, v64
    v_fmac_f32 v67, v35, v82
    v_mul_f32 v32, 0x3c600000, v3
    v_cos_f32 v64, v32
    v_sin_f32 v82, v32
    s_nop 0
    v_mul_f32 v35, v27, v64
    v_fma_f32 v35, -v59, v82, v35
    v_mul_f32 v59, v59, v64
    v_fmac_f32 v59, v27, v82
    v_mul_f32 v32, 0x3c700000, v3
    v_cos_f32 v64, v32
    v_sin_f32 v82, v32
    s_nop 0
    v_mul_f32 v27, v43, v64
    v_fma_f32 v27, -v75, v82, v27
    v_mul_f32 v75, v75, v64
    v_fmac_f32 v75, v43, v82
    v_mul_f32 v32, 0x3c800000, v3
    v_cos_f32 v64, v32
    v_sin_f32 v82, v32
    s_nop 0
    v_mul_f32 v43, v47, v64
    v_fma_f32 v43, -v79, v82, v43
    v_mul_f32 v79, v79, v64
    v_fmac_f32 v79, v47, v82
    v_mul_f32 v32, 0x3c880000, v3
    v_cos_f32 v64, v32
    v_sin_f32 v82, v32
    s_nop 0
    v_mul_f32 v47, v24, v64
    v_fma_f32 v47, -v56, v82, v47
    v_mul_f32 v56, v56, v64
    v_fmac_f32 v56, v24, v82
    v_mul_f32 v32, 0x3c900000, v3
    v_cos_f32 v64, v32
    v_sin_f32 v82, v32
    s_nop 0
    v_mul_f32 v24, v20, v64
    v_fma_f32 v24, -v52, v82, v24
    v_mul_f32 v52, v52, v64
    v_fmac_f32 v52, v20, v82
    v_mul_f32 v32, 0x3c980000, v3
    v_cos_f32 v64, v32
    v_sin_f32 v82, v32
    s_nop 0
    v_mul_f32 v20, v36, v64
    v_fma_f32 v20, -v68, v82, v20
    v_mul_f32 v68, v68, v64
    v_fmac_f32 v68, v36, v82
    v_mul_f32 v32, 0x3ca00000, v3
    v_cos_f32 v64, v32
    v_sin_f32 v82, v32
    s_nop 0
    v_mul_f32 v36, v18, v64
    v_fma_f32 v36, -v50, v82, v36
    v_mul_f32 v50, v50, v64
    v_fmac_f32 v50, v18, v82
    v_mul_f32 v32, 0x3ca80000, v3
    v_cos_f32 v64, v32
    v_sin_f32 v82, v32
    s_nop 0
    v_mul_f32 v18, v34, v64
    v_fma_f32 v18, -v66, v82, v18
    v_mul_f32 v66, v66, v64
    v_fmac_f32 v66, v34, v82
    v_mul_f32 v32, 0x3cb00000, v3
    v_cos_f32 v64, v32
    v_sin_f32 v82, v32
    s_nop 0
    v_mul_f32 v34, v26, v64
    v_fma_f32 v34, -v58, v82, v34
    v_mul_f32 v58, v58, v64
    v_fmac_f32 v58, v26, v82
    v_mul_f32 v32, 0x3cb80000, v3
    v_cos_f32 v64, v32
    v_sin_f32 v82, v32
    s_nop 0
    v_mul_f32 v26, v42, v64
    v_fma_f32 v26, -v74, v82, v26
    v_mul_f32 v74, v74, v64
    v_fmac_f32 v74, v42, v82
    v_mul_f32 v32, 0x3cc00000, v3
    v_cos_f32 v64, v32
    v_sin_f32 v82, v32
    s_nop 0
    v_mul_f32 v42, v17, v64
    v_fma_f32 v42, -v49, v82, v42
    v_mul_f32 v49, v49, v64
    v_fmac_f32 v49, v17, v82
    v_mul_f32 v32, 0x3cc80000, v3
    v_cos_f32 v64, v32
    v_sin_f32 v82, v32
    s_nop 0
    v_mul_f32 v17, v33, v64
    v_fma_f32 v17, -v65, v82, v17
    v_mul_f32 v65, v65, v64
    v_fmac_f32 v65, v33, v82
    v_mul_f32 v32, 0x3cd00000, v3
    v_cos_f32 v64, v32
    v_sin_f32 v82, v32
    s_nop 0
    v_mul_f32 v33, v25, v64
    v_fma_f32 v33, -v57, v82, v33
    v_mul_f32 v57, v57, v64
    v_fmac_f32 v57, v25, v82
    v_mul_f32 v32, 0x3cd80000, v3
    v_cos_f32 v64, v32
    v_sin_f32 v82, v32
    s_nop 0
    v_mul_f32 v25, v41, v64
    v_fma_f32 v25, -v73, v82, v25
    v_mul_f32 v73, v73, v64
    v_fmac_f32 v73, v41, v82
    v_mul_f32 v32, 0x3ce00000, v3
    v_cos_f32 v64, v32
    v_sin_f32 v82, v32
    s_nop 0
    v_mul_f32 v41, v21, v64
    v_fma_f32 v41, -v53, v82, v41
    v_mul_f32 v53, v53, v64
    v_fmac_f32 v53, v21, v82
    v_mul_f32 v32, 0x3ce80000, v3
    v_cos_f32 v64, v32
    v_sin_f32 v82, v32
    s_nop 0
    v_mul_f32 v21, v37, v64
    v_fma_f32 v21, -v69, v82, v21
    v_mul_f32 v69, v69, v64
    v_fmac_f32 v69, v37, v82
    v_mul_f32 v32, 0x3cf00000, v3
    v_cos_f32 v64, v32
    v_sin_f32 v82, v32
    s_nop 0
    v_mul_f32 v37, v29, v64
    v_fma_f32 v37, -v61, v82, v37
    v_mul_f32 v61, v61, v64
    v_fmac_f32 v61, v29, v82
    v_mul_f32 v32, 0x3cf80000, v3
    v_cos_f32 v64, v32
    v_sin_f32 v82, v32
    s_nop 0
    v_mul_f32 v29, v45, v64
    v_fma_f32 v29, -v77, v82, v29
    v_mul_f32 v77, v77, v64
    v_fmac_f32 v77, v45, v82
    ds_write_b32 v4, v16 offset:0
    ds_write_b32 v4, v48 offset:4
    ds_write_b32 v4, v83 offset:264
    ds_write_b32 v4, v81 offset:268
    ds_write_b32 v4, v80 offset:528
    ds_write_b32 v4, v72 offset:532
    ds_write_b32 v4, v40 offset:792
    ds_write_b32 v4, v60 offset:796
    ds_write_b32 v4, v28 offset:1056
    ds_write_b32 v4, v76 offset:1060
    ds_write_b32 v4, v44 offset:1320
    ds_write_b32 v4, v62 offset:1324
    ds_write_b32 v4, v30 offset:1584
    ds_write_b32 v4, v54 offset:1588
    ds_write_b32 v4, v22 offset:1848
    ds_write_b32 v4, v70 offset:1852
    ds_write_b32 v4, v38 offset:2112
    ds_write_b32 v4, v78 offset:2116
    ds_write_b32 v4, v46 offset:2376
    ds_write_b32 v4, v63 offset:2380
    ds_write_b32 v4, v31 offset:2640
    ds_write_b32 v4, v55 offset:2644
    ds_write_b32 v4, v23 offset:2904
    ds_write_b32 v4, v71 offset:2908
    ds_write_b32 v4, v39 offset:3168
    ds_write_b32 v4, v51 offset:3172
    ds_write_b32 v4, v19 offset:3432
    ds_write_b32 v4, v67 offset:3436
    ds_write_b32 v4, v35 offset:3696
    ds_write_b32 v4, v59 offset:3700
    ds_write_b32 v4, v27 offset:3960
    ds_write_b32 v4, v75 offset:3964
    ds_write_b32 v4, v43 offset:4224
    ds_write_b32 v4, v79 offset:4228
    ds_write_b32 v4, v47 offset:4488
    ds_write_b32 v4, v56 offset:4492
    ds_write_b32 v4, v24 offset:4752
    ds_write_b32 v4, v52 offset:4756
    ds_write_b32 v4, v20 offset:5016
    ds_write_b32 v4, v68 offset:5020
    ds_write_b32 v4, v36 offset:5280
    ds_write_b32 v4, v50 offset:5284
    ds_write_b32 v4, v18 offset:5544
    ds_write_b32 v4, v66 offset:5548
    ds_write_b32 v4, v34 offset:5808
    ds_write_b32 v4, v58 offset:5812
    ds_write_b32 v4, v26 offset:6072
    ds_write_b32 v4, v74 offset:6076
    ds_write_b32 v4, v42 offset:6336
    ds_write_b32 v4, v49 offset:6340
    ds_write_b32 v4, v17 offset:6600
    ds_write_b32 v4, v65 offset:6604
    ds_write_b32 v4, v33 offset:6864
    ds_write_b32 v4, v57 offset:6868
    ds_write_b32 v4, v25 offset:7128
    ds_write_b32 v4, v73 offset:7132
    ds_write_b32 v4, v41 offset:7392
    ds_write_b32 v4, v53 offset:7396
    ds_write_b32 v4, v21 offset:7656
    ds_write_b32 v4, v69 offset:7660
    ds_write_b32 v4, v37 offset:7920
    ds_write_b32 v4, v61 offset:7924
    ds_write_b32 v4, v29 offset:8184
    ds_write_b32 v4, v77 offset:8188
    s_waitcnt lgkmcnt(0)
    ds_read_b32 v16, v5 offset:0
    ds_read_b32 v48, v5 offset:4
    ds_read_b32 v83, v5 offset:8
    ds_read_b32 v81, v5 offset:12
    ds_read_b32 v80, v5 offset:16
    ds_read_b32 v72, v5 offset:20
    ds_read_b32 v40, v5 offset:24
    ds_read_b32 v60, v5 offset:28
    ds_read_b32 v28, v5 offset:32
    ds_read_b32 v76, v5 offset:36
    ds_read_b32 v44, v5 offset:40
    ds_read_b32 v62, v5 offset:44
    ds_read_b32 v30, v5 offset:48
    ds_read_b32 v54, v5 offset:52
    s_waitcnt lgkmcnt(0)
    ds_read_b32 v22, v5 offset:56
    ds_read_b32 v70, v5 offset:60
    ds_read_b32 v38, v5 offset:64
    ds_read_b32 v78, v5 offset:68
    ds_read_b32 v46, v5 offset:72
    ds_read_b32 v63, v5 offset:76
    ds_read_b32 v31, v5 offset:80
    ds_read_b32 v55, v5 offset:84
    ds_read_b32 v23, v5 offset:88
    ds_read_b32 v71, v5 offset:92
    ds_read_b32 v39, v5 offset:96
    ds_read_b32 v51, v5 offset:100
    ds_read_b32 v19, v5 offset:104
    ds_read_b32 v67, v5 offset:108
    s_waitcnt lgkmcnt(0)
    ds_read_b32 v35, v5 offset:112
    ds_read_b32 v59, v5 offset:116
    ds_read_b32 v27, v5 offset:120
    ds_read_b32 v75, v5 offset:124
    ds_read_b32 v43, v5 offset:128
    ds_read_b32 v79, v5 offset:132
    ds_read_b32 v47, v5 offset:136
    ds_read_b32 v56, v5 offset:140
    ds_read_b32 v24, v5 offset:144
    ds_read_b32 v52, v5 offset:148
    ds_read_b32 v20, v5 offset:152
    ds_read_b32 v68, v5 offset:156
    ds_read_b32 v36, v5 offset:160
    ds_read_b32 v50, v5 offset:164
    s_waitcnt lgkmcnt(0)
    ds_read_b32 v18, v5 offset:168
    ds_read_b32 v66, v5 offset:172
    ds_read_b32 v34, v5 offset:176
    ds_read_b32 v58, v5 offset:180
    ds_read_b32 v26, v5 offset:184
    ds_read_b32 v74, v5 offset:188
    ds_read_b32 v42, v5 offset:192
    ds_read_b32 v49, v5 offset:196
    ds_read_b32 v17, v5 offset:200
    ds_read_b32 v65, v5 offset:204
    ds_read_b32 v33, v5 offset:208
    ds_read_b32 v57, v5 offset:212
    ds_read_b32 v25, v5 offset:216
    ds_read_b32 v73, v5 offset:220
    s_waitcnt lgkmcnt(0)
    ds_read_b32 v41, v5 offset:224
    ds_read_b32 v53, v5 offset:228
    ds_read_b32 v21, v5 offset:232
    ds_read_b32 v69, v5 offset:236
    ds_read_b32 v37, v5 offset:240
    ds_read_b32 v61, v5 offset:244
    ds_read_b32 v29, v5 offset:248
    ds_read_b32 v77, v5 offset:252
    s_waitcnt lgkmcnt(0)
    v_sub_f32 v32, v16, v43
    v_sub_f32 v64, v48, v79
    v_add_f32 v16, v16, v43
    v_add_f32 v48, v48, v79
    v_sub_f32 v43, v83, v47
    v_sub_f32 v79, v81, v56
    v_add_f32 v83, v83, v47
    v_add_f32 v81, v81, v56
    v_mul_f32 v47, 0x3f7b14be, v43
    v_mul_f32 v56, 0x3e47c5c2, v43
    v_fmac_f32 v47, 0xbe47c5c2, v79
    v_fmac_f32 v56, 0x3f7b14be, v79
    v_sub_f32 v43, v80, v24
    v_sub_f32 v79, v72, v52
    v_add_f32 v80, v80, v24
    v_add_f32 v72, v72, v52
    v_mul_f32 v24, 0x3f6c835e, v43
    v_mul_f32 v52, 0x3ec3ef15, v43
    v_fmac_f32 v24, 0xbec3ef15, v79
    v_fmac_f32 v52, 0x3f6c835e, v79
    v_sub_f32 v43, v40, v20
    v_sub_f32 v79, v60, v68
    v_add_f32 v40, v40, v20
    v_add_f32 v60, v60, v68
    v_mul_f32 v20, 0x3f54db31, v43
    v_mul_f32 v68, 0x3f0e39da, v43
    v_fmac_f32 v20, 0xbf0e39da, v79
    v_fmac_f32 v68, 0x3f54db31, v79
    v_sub_f32 v43, v28, v36
    v_sub_f32 v79, v76, v50
    v_add_f32 v28, v28, v36
    v_add_f32 v76, v76, v50
    v_mul_f32 v36, 0x3f3504f3, v43
    v_mul_f32 v50, 0x3f3504f3, v43
    v_fmac_f32 v36, 0xbf3504f3, v79
    v_fmac_f32 v50, 0x3f3504f3, v79
    v_sub_f32 v43, v44, v18
    v_sub_f32 v79, v62, v66
    v_add_f32 v44, v44, v18
    v_add_f32 v62, v62, v66
    v_mul_f32 v18, 0x3f0e39da, v43
    v_mul_f32 v66, 0x3f54db31, v43
    v_fmac_f32 v18, 0xbf54db31, v79
    v_fmac_f32 v66, 0x3f0e39da, v79
    v_sub_f32 v43, v30, v34
    v_sub_f32 v79, v54, v58
    v_add_f32 v30, v30, v34
    v_add_f32 v54, v54, v58
    v_mul_f32 v34, 0x3ec3ef15, v43
    v_mul_f32 v58, 0x3f6c835e, v43
    v_fmac_f32 v34, 0xbf6c835e, v79
    v_fmac_f32 v58, 0x3ec3ef15, v79
    v_sub_f32 v43, v22, v26
    v_sub_f32 v79, v70, v74
    v_add_f32 v22, v22, v26
    v_add_f32 v70, v70, v74
    v_mul_f32 v26, 0x3e47c5c2, v43
    v_mul_f32 v74, 0x3f7b14be, v43
    v_fmac_f32 v26, 0xbf7b14be, v79
    v_fmac_f32 v74, 0x3e47c5c2, v79
    v_sub_f32 v43, v49, v78
    v_sub_f32 v79, v38, v42
    v_add_f32 v38, v38, v42
    v_add_f32 v78, v78, v49
    v_sub_f32 v42, v46, v17
    v_sub_f32 v49, v63, v65
    v_add_f32 v46, v46, v17
    v_add_f32 v63, v63, v65
    v_mul_f32 v17, 0xbe47c5c2, v42
    v_mul_f32 v65, 0x3f7b14be, v42
    v_fmac_f32 v17, 0xbf7b14be, v49
    v_fmac_f32 v65, 0xbe47c5c2, v49
    v_sub_f32 v42, v31, v33
    v_sub_f32 v49, v55, v57
    v_add_f32 v31, v31, v33
    v_add_f32 v55, v55, v57
    v_mul_f32 v33, 0xbec3ef15, v42
    v_mul_f32 v57, 0x3f6c835e, v42
    v_fmac_f32 v33, 0xbf6c835e, v49
    v_fmac_f32 v57, 0xbec3ef15, v49
    v_sub_f32 v42, v23, v25
    v_sub_f32 v49, v71, v73
    v_add_f32 v23, v23, v25
    v_add_f32 v71, v71, v73
    v_mul_f32 v25, 0xbf0e39da, v42
    v_mul_f32 v73, 0x3f54db31, v42
    v_fmac_f32 v25, 0xbf54db31, v49
    v_fmac_f32 v73, 0xbf0e39da, v49
    v_sub_f32 v42, v39, v41
    v_sub_f32 v49, v51, v53
    v_add_f32 v39, v39, v41
    v_add_f32 v51, v51, v53
    v_mul_f32 v41, 0xbf3504f3, v42
    v_mul_f32 v53, 0x3f3504f3, v42
    v_fmac_f32 v41, 0xbf3504f3, v49
    v_fmac_f32 v53, 0xbf3504f3, v49
    v_sub_f32 v42, v19, v21
    v_sub_f32 v49, v67, v69
    v_add_f32 v19, v19, v21
    v_add_f32 v67, v67, v69
    v_mul_f32 v21, 0xbf54db31, v42
    v_mul_f32 v69, 0x3f0e39da, v42
    v_fmac_f32 v21, 0xbf0e39da, v49
    v_fmac_f32 v69, 0xbf54db31, v49
    v_sub_f32 v42, v35, v37
    v_sub_f32 v49, v59, v61
    v_add_f32 v35, v35, v37
    v_add_f32 v59, v59, v61
    v_mul_f32 v37, 0xbf6c835e, v42
    v_mul_f32 v61, 0x3ec3ef15, v42
    v_fmac_f32 v37, 0xbec3ef15, v49
    v_fmac_f32 v61, 0xbf6c835e, v49
    v_sub_f32 v42, v27, v29
    v_sub_f32 v49, v75, v77
    v_add_f32 v27, v27, v29
    v_add_f32 v75, v75, v77
    v_mul_f32 v29, 0xbf7b14be, v42
    v_mul_f32 v77, 0x3e47c5c2, v42
    v_fmac_f32 v29, 0xbe47c5c2, v49
    v_fmac_f32 v77, 0xbf7b14be, v49
    v_sub_f32 v42, v16, v38
    v_sub_f32 v49, v48, v78
    v_add_f32 v16, v16, v38
    v_add_f32 v48, v48, v78
    v_sub_f32 v38, v83, v46
    v_sub_f32 v78, v81, v63
    v_add_f32 v83, v83, v46
    v_add_f32 v81, v81, v63
    v_mul_f32 v46, 0x3f6c835e, v38
    v_mul_f32 v63, 0x3ec3ef15, v38
    v_fmac_f32 v46, 0xbec3ef15, v78
    v_fmac_f32 v63, 0x3f6c835e, v78
    v_sub_f32 v38, v80, v31
    v_sub_f32 v78, v72, v55
    v_add_f32 v80, v80, v31
    v_add_f32 v72, v72, v55
    v_mul_f32 v31, 0x3f3504f3, v38
    v_mul_f32 v55, 0x3f3504f3, v38
    v_fmac_f32 v31, 0xbf3504f3, v78
    v_fmac_f32 v55, 0x3f3504f3, v78
    v_sub_f32 v38, v40, v23
    v_sub_f32 v78, v60, v71
    v_add_f32 v40, v40, v23
    v_add_f32 v60, v60, v71
    v_mul_f32 v23, 0x3ec3ef15, v38
    v_mul_f32 v71, 0x3f6c835e, v38
    v_fmac_f32 v23, 0xbf6c835e, v78
    v_fmac_f32 v71, 0x3ec3ef15, v78
    v_sub_f32 v38, v51, v76
    v_sub_f32 v78, v28, v39
    v_add_f32 v28, v28, v39
    v_add_f32 v76, v76, v51
    v_sub_f32 v39, v44, v19
    v_sub_f32 v51, v62, v67
    v_add_f32 v44, v44, v19
    v_add_f32 v62, v62, v67
    v_mul_f32 v19, 0xbec3ef15, v39
    v_mul_f32 v67, 0x3f6c835e, v39
    v_fmac_f32 v19, 0xbf6c835e, v51
    v_fmac_f32 v67, 0xbec3ef15, v51
    v_sub_f32 v39, v30, v35
    v_sub_f32 v51, v54, v59
    v_add_f32 v30, v30, v35
    v_add_f32 v54, v54, v59
    v_mul_f32 v35, 0xbf3504f3, v39
    v_mul_f32 v59, 0x3f3504f3, v39
    v_fmac_f32 v35, 0xbf3504f3, v51
    v_fmac_f32 v59, 0xbf3504f3, v51
    v_sub_f32 v39, v22, v27
    v_sub_f32 v51, v70, v75
    v_add_f32 v22, v22, v27
    v_add_f32 v70, v70, v75
    v_mul_f32 v27, 0xbf6c835e, v39
    v_mul_f32 v75, 0x3ec3ef15, v39
    v_fmac_f32 v27, 0xbec3ef15, v51
    v_fmac_f32 v75, 0xbf6c835e, v51
    v_sub_f32 v39, v32, v43
    v_sub_f32 v51, v64, v79
    v_add_f32 v32, v32, v43
    v_add_f32 v64, v64, v79
    v_sub_f32 v43, v47, v17
    v_sub_f32 v79, v56, v65
    v_add_f32 v47, v47, v17
    v_add_f32 v56, v56, v65
    v_mul_f32 v17, 0x3f6c835e, v43
    v_mul_f32 v65, 0x3ec3ef15, v43
    v_fmac_f32 v17, 0xbec3ef15, v79
    v_fmac_f32 v65, 0x3f6c835e, v79
    v_sub_f32 v43, v24, v33
    v_sub_f32 v79, v52, v57
    v_add_f32 v24, v24, v33
    v_add_f32 v52, v52, v57
    v_mul_f32 v33, 0x3f3504f3, v43
    v_mul_f32 v57, 0x3f3504f3, v43
    v_fmac_f32 v33, 0xbf3504f3, v79
    v_fmac_f32 v57, 0x3f3504f3, v79
    v_sub_f32 v43, v20, v25
    v_sub_f32 v79, v68, v73
    v_add_f32 v20, v20, v25
    v_add_f32 v68, v68, v73
    v_mul_f32 v25, 0x3ec3ef15, v43
    v_mul_f32 v73, 0x3f6c835e, v43
    v_fmac_f32 v25, 0xbf6c835e, v79
    v_fmac_f32 v73, 0x3ec3ef15, v79
    v_sub_f32 v43, v53, v50
    v_sub_f32 v79, v36, v41
    v_add_f32 v36, v36, v41
    v_add_f32 v50, v50, v53
    v_sub_f32 v41, v18, v21
    v_sub_f32 v53, v66, v69
    v_add_f32 v18, v18, v21
    v_add_f32 v66, v66, v69
    v_mul_f32 v21, 0xbec3ef15, v41
    v_mul_f32 v69, 0x3f6c835e, v41
    v_fmac_f32 v21, 0xbf6c835e, v53
    v_fmac_f32 v69, 0xbec3ef15, v53
    v_sub_f32 v41, v34, v37
    v_sub_f32 v53, v58, v61
    v_add_f32 v34, v34, v37
    v_add_f32 v58, v58, v61
    v_mul_f32 v37, 0xbf3504f3, v41
    v_mul_f32 v61, 0x3f3504f3, v41
    v_fmac_f32 v37, 0xbf3504f3, v53
    v_fmac_f32 v61, 0xbf3504f3, v53
    v_sub_f32 v41, v26, v29
    v_sub_f32 v53, v74, v77
    v_add_f32 v26, v26, v29
    v_add_f32 v74, v74, v77
    v_mul_f32 v29, 0xbf6c835e, v41
    v_mul_f32 v77, 0x3ec3ef15, v41
    v_fmac_f32 v29, 0xbec3ef15, v53
    v_fmac_f32 v77, 0xbf6c835e, v53
    v_sub_f32 v41, v16, v28
    v_sub_f32 v53, v48, v76
    v_add_f32 v16, v16, v28
    v_add_f32 v48, v48, v76
    v_sub_f32 v28, v83, v44
    v_sub_f32 v76, v81, v62
    v_add_f32 v83, v83, v44
    v_add_f32 v81, v81, v62
    v_mul_f32 v44, 0x3f3504f3, v28
    v_mul_f32 v62, 0x3f3504f3, v28
    v_fmac_f32 v44, 0xbf3504f3, v76
    v_fmac_f32 v62, 0x3f3504f3, v76
    v_sub_f32 v28, v54, v72
    v_sub_f32 v76, v80, v30
    v_add_f32 v80, v80, v30
    v_add_f32 v72, v72, v54
    v_sub_f32 v30, v40, v22
    v_sub_f32 v54, v60, v70
    v_add_f32 v40, v40, v22
    v_add_f32 v60, v60, v70
    v_mul_f32 v22, 0xbf3504f3, v30
    v_mul_f32 v70, 0x3f3504f3, v30
    v_fmac_f32 v22, 0xbf3504f3, v54
    v_fmac_f32 v70, 0xbf3504f3, v54
    v_sub_f32 v30, v42, v38
    v_sub_f32 v54, v49, v78
    v_add_f32 v42, v42, v38
    v_add_f32 v49, v49, v78
    v_sub_f32 v38, v46, v19
    v_sub_f32 v78, v63, v67
    v_add_f32 v46, v46, v19
    v_add_f32 v63, v63, v67
    v_mul_f32 v19, 0x3f3504f3, v38
    v_mul_f32 v67, 0x3f3504f3, v38
    v_fmac_f32 v19, 0xbf3504f3, v78
    v_fmac_f32 v67, 0x3f3504f3, v78
    v_sub_f32 v38, v59, v55
    v_sub_f32 v78, v31, v35
    v_add_f32 v31, v31, v35
    v_add_f32 v55, v55, v59
    v_sub_f32 v35, v23, v27
    v_sub_f32 v59, v71, v75
    v_add_f32 v23, v23, v27
    v_add_f32 v71, v71, v75
    v_mul_f32 v27, 0xbf3504f3, v35
    v_mul_f32 v75, 0x3f3504f3, v35
    v_fmac_f32 v27, 0xbf3504f3, v59
    v_fmac_f32 v75, 0xbf3504f3, v59
    v_sub_f32 v35, v32, v36
    v_sub_f32 v59, v64, v50
    v_add_f32 v32, v32, v36
    v_add_f32 v64, v64, v50
    v_sub_f32 v36, v47, v18
    v_sub_f32 v50, v56, v66
    v_add_f32 v47, v47, v18
    v_add_f32 v56, v56, v66
    v_mul_f32 v18, 0x3f3504f3, v36
    v_mul_f32 v66, 0x3f3504f3, v36
    v_fmac_f32 v18, 0xbf3504f3, v50
    v_fmac_f32 v66, 0x3f3504f3, v50
    v_sub_f32 v36, v58, v52
    v_sub_f32 v50, v24, v34
    v_add_f32 v24, v24, v34
    v_add_f32 v52, v52, v58
    v_sub_f32 v34, v20, v26
    v_sub_f32 v58, v68, v74
    v_add_f32 v20, v20, v26
    v_add_f32 v68, v68, v74
    v_mul_f32 v26, 0xbf3504f3, v34
    v_mul_f32 v74, 0x3f3504f3, v34
    v_fmac_f32 v26, 0xbf3504f3, v58
    v_fmac_f32 v74, 0xbf3504f3, v58
    v_sub_f32 v34, v39, v43
    v_sub_f32 v58, v51, v79
    v_add_f32 v39, v39, v43
    v_add_f32 v51, v51, v79
    v_sub_f32 v43, v17, v21
    v_sub_f32 v79, v65, v69
    v_add_f32 v17, v17, v21
    v_add_f32 v65, v65, v69
    v_mul_f32 v21, 0x3f3504f3, v43
    v_mul_f32 v69, 0x3f3504f3, v43
    v_fmac_f32 v21, 0xbf3504f3, v79
    v_fmac_f32 v69, 0x3f3504f3, v79
    v_sub_f32 v43, v61, v57
    v_sub_f32 v79, v33, v37
    v_add_f32 v33, v33, v37
    v_add_f32 v57, v57, v61
    v_sub_f32 v37, v25, v29
    v_sub_f32 v61, v73, v77
    v_add_f32 v25, v25, v29
    v_add_f32 v73, v73, v77
    v_mul_f32 v29, 0xbf3504f3, v37
    v_mul_f32 v77, 0x3f3504f3, v37
    v_fmac_f32 v29, 0xbf3504f3, v61
    v_fmac_f32 v77, 0xbf3504f3, v61
    v_sub_f32 v37, v16, v80
    v_sub_f32 v61, v48, v72
    v_add_f32 v16, v16, v80
    v_add_f32 v48, v48, v72
    v_sub_f32 v80, v60, v81
    v_sub_f32 v72, v83, v40
    v_add_f32 v83, v83, v40
    v_add_f32 v81, v81, v60
    v_sub_f32 v40, v41, v28
    v_sub_f32 v60, v53, v76
    v_add_f32 v41, v41, v28
    v_add_f32 v53, v53, v76
    v_sub_f32 v28, v70, v62
    v_sub_f32 v76, v44, v22
    v_add_f32 v44, v44, v22
    v_add_f32 v62, v62, v70
    v_sub_f32 v22, v42, v31
    v_sub_f32 v70, v49, v55
    v_add_f32 v42, v42, v31
    v_add_f32 v49, v49, v55
    v_sub_f32 v31, v71, v63
    v_sub_f32 v55, v46, v23
    v_add_f32 v46, v46, v23
    v_add_f32 v63, v63, v71
    v_sub_f32 v23, v30, v38
    v_sub_f32 v71, v54, v78
    v_add_f32 v30, v30, v38
    v_add_f32 v54, v54, v78
    v_sub_f32 v38, v75, v67
    v_sub_f32 v78, v19, v27
    v_add_f32 v19, v19, v27
    v_add_f32 v67, v67, v75
    v_sub_f32 v27, v32, v24
    v_sub_f32 v75, v64, v52
    v_add_f32 v32, v32, v24
    v_add_f32 v64, v64, v52
    v_sub_f32 v24, v68, v56
    v_sub_f32 v52, v47, v20
    v_add_f32 v47, v47, v20
    v_add_f32 v56, v56, v68
    v_sub_f32 v20, v35, v36
    v_sub_f32 v68, v59, v50
    v_add_f32 v35, v35, v36
    v_add_f32 v59, v59, v50
    v_sub_f32 v36, v74, v66
    v_sub_f32 v50, v18, v26
    v_add_f32 v18, v18, v26
    v_add_f32 v66, v66, v74
    v_sub_f32 v26, v39, v33
    v_sub_f32 v74, v51, v57
    v_add_f32 v39, v39, v33
    v_add_f32 v51, v51, v57
    v_sub_f32 v33, v73, v65
    v_sub_f32 v57, v17, v25
    v_add_f32 v17, v17, v25
    v_add_f32 v65, v65, v73
    v_sub_f32 v25, v34, v43
    v_sub_f32 v73, v58, v79
    v_add_f32 v34, v34, v43
    v_add_f32 v58, v58, v79
    v_sub_f32 v43, v77, v69
    v_sub_f32 v79, v21, v29
    v_add_f32 v21, v21, v29
    v_add_f32 v69, v69, v77
    v_sub_f32 v29, v16, v83
    v_sub_f32 v77, v48, v81
    v_add_f32 v16, v16, v83
    v_add_f32 v48, v48, v81
    v_sub_f32 v83, v37, v80
    v_sub_f32 v81, v61, v72
    v_add_f32 v37, v37, v80
    v_add_f32 v61, v61, v72
    v_sub_f32 v80, v41, v44
    v_sub_f32 v72, v53, v62
    v_add_f32 v41, v41, v44
    v_add_f32 v53, v53, v62
    v_sub_f32 v44, v40, v28
    v_sub_f32 v62, v60, v76
    v_add_f32 v40, v40, v28
    v_add_f32 v60, v60, v76
    v_sub_f32 v28, v42, v46
    v_sub_f32 v76, v49, v63
    v_add_f32 v42, v42, v46
    v_add_f32 v49, v49, v63
    v_sub_f32 v46, v22, v31
    v_sub_f32 v63, v70, v55
    v_add_f32 v22, v22, v31
    v_add_f32 v70, v70, v55
    v_sub_f32 v31, v30, v19
    v_sub_f32 v55, v54, v67
    v_add_f32 v30, v30, v19
    v_add_f32 v54, v54, v67
    v_sub_f32 v19, v23, v38
    v_sub_f32 v67, v71, v78
    v_add_f32 v23, v23, v38
    v_add_f32 v71, v71, v78
    v_sub_f32 v38, v32, v47
    v_sub_f32 v78, v64, v56
    v_add_f32 v32, v32, v47
    v_add_f32 v64, v64, v56
    v_sub_f32 v47, v27, v24
    v_sub_f32 v56, v75, v52
    v_add_f32 v27, v27, v24
    v_add_f32 v75, v75, v52
    v_sub_f32 v24, v35, v18
    v_sub_f32 v52, v59, v66
    v_add_f32 v35, v35, v18
    v_add_f32 v59, v59, v66
    v_sub_f32 v18, v20, v36
    v_sub_f32 v66, v68, v50
    v_add_f32 v20, v20, v36
    v_add_f32 v68, v68, v50
    v_sub_f32 v36, v39, v17
    v_sub_f32 v50, v51, v65
    v_add_f32 v39, v39, v17
    v_add_f32 v51, v51, v65
    v_sub_f32 v17, v26, v33
    v_sub_f32 v65, v74, v57
    v_add_f32 v26, v26, v33
    v_add_f32 v74, v74, v57
    v_sub_f32 v33, v34, v21
    v_sub_f32 v57, v58, v69
    v_add_f32 v34, v34, v21
    v_add_f32 v58, v58, v69
    v_sub_f32 v21, v25, v43
    v_sub_f32 v69, v73, v79
    v_add_f32 v25, v25, v43
    v_add_f32 v73, v73, v79
    v_lshl_add_u32 v6, v1, 2, v7
    ds_write_b32 v6, v16 offset:0
    ds_write_b32 v6, v48 offset:4096
    ds_write_b32 v6, v32 offset:128
    ds_write_b32 v6, v64 offset:4224
    ds_write_b32 v6, v42 offset:256
    ds_write_b32 v6, v49 offset:4352
    ds_write_b32 v6, v39 offset:384
    ds_write_b32 v6, v51 offset:4480
    ds_write_b32 v6, v41 offset:512
    ds_write_b32 v6, v53 offset:4608
    ds_write_b32 v6, v35 offset:640
    ds_write_b32 v6, v59 offset:4736
    ds_write_b32 v6, v30 offset:768
    ds_write_b32 v6, v54 offset:4864
    ds_write_b32 v6, v34 offset:896
    ds_write_b32 v6, v58 offset:4992
    ds_write_b32 v6, v37 offset:1024
    ds_write_b32 v6, v61 offset:5120
    ds_write_b32 v6, v27 offset:1152
    ds_write_b32 v6, v75 offset:5248
    ds_write_b32 v6, v22 offset:1280
    ds_write_b32 v6, v70 offset:5376
    ds_write_b32 v6, v26 offset:1408
    ds_write_b32 v6, v74 offset:5504
    ds_write_b32 v6, v40 offset:1536
    ds_write_b32 v6, v60 offset:5632
    ds_write_b32 v6, v20 offset:1664
    ds_write_b32 v6, v68 offset:5760
    ds_write_b32 v6, v23 offset:1792
    ds_write_b32 v6, v71 offset:5888
    ds_write_b32 v6, v25 offset:1920
    ds_write_b32 v6, v73 offset:6016
    ds_write_b32 v6, v29 offset:2048
    ds_write_b32 v6, v77 offset:6144
    ds_write_b32 v6, v38 offset:2176
    ds_write_b32 v6, v78 offset:6272
    ds_write_b32 v6, v28 offset:2304
    ds_write_b32 v6, v76 offset:6400
    ds_write_b32 v6, v36 offset:2432
    ds_write_b32 v6, v50 offset:6528
    ds_write_b32 v6, v80 offset:2560
    ds_write_b32 v6, v72 offset:6656
    ds_write_b32 v6, v24 offset:2688
    ds_write_b32 v6, v52 offset:6784
    ds_write_b32 v6, v31 offset:2816
    ds_write_b32 v6, v55 offset:6912
    ds_write_b32 v6, v33 offset:2944
    ds_write_b32 v6, v57 offset:7040
    ds_write_b32 v6, v83 offset:3072
    ds_write_b32 v6, v81 offset:7168
    ds_write_b32 v6, v47 offset:3200
    ds_write_b32 v6, v56 offset:7296
    ds_write_b32 v6, v46 offset:3328
    ds_write_b32 v6, v63 offset:7424
    ds_write_b32 v6, v17 offset:3456
    ds_write_b32 v6, v65 offset:7552
    ds_write_b32 v6, v44 offset:3584
    ds_write_b32 v6, v62 offset:7680
    ds_write_b32 v6, v18 offset:3712
    ds_write_b32 v6, v66 offset:7808
    ds_write_b32 v6, v19 offset:3840
    ds_write_b32 v6, v67 offset:7936
    ds_write_b32 v6, v21 offset:3968
    ds_write_b32 v6, v69 offset:8064
    s_waitcnt lgkmcnt(0)
    s_barrier
    v_and_b32 v6, 127, v0
    v_lshrrev_b32 v7, 7, v0
    v_lshlrev_b32 v8, 5, v6
    v_lshl_add_u32 v8, v7, 12, v8
    v_lshlrev_b32 v5, 4, v6
    v_lshl_add_u32 v5, v7, 12, v5
    v_add_u32 v5, 2048, v5
    s_lshl_b32 s12, s93, 16
    ds_read_b128 v[16:19], v8 offset:0
    ds_read_b128 v[20:23], v8 offset:16
    s_waitcnt lgkmcnt(0)
    v_cvt_pk_bf16_f32 v24, v16, v17
    v_cvt_pk_bf16_f32 v25, v18, v19
    v_cvt_pk_bf16_f32 v26, v20, v21
    v_cvt_pk_bf16_f32 v27, v22, v23
    s_add_u32 s13, s12, 0
    buffer_store_dwordx4 v[24:27], v5, s[4:7], s13 offen
    s_nop 1
    ds_read_b128 v[16:19], v8 offset:8448
    ds_read_b128 v[20:23], v8 offset:8464
    s_waitcnt lgkmcnt(0)
    v_cvt_pk_bf16_f32 v24, v16, v17
    v_cvt_pk_bf16_f32 v25, v18, v19
    v_cvt_pk_bf16_f32 v26, v20, v21
    v_cvt_pk_bf16_f32 v27, v22, v23
    s_add_u32 s13, s12, 8192
    buffer_store_dwordx4 v[24:27], v5, s[4:7], s13 offen
    s_nop 1
    ds_read_b128 v[16:19], v8 offset:16896
    ds_read_b128 v[20:23], v8 offset:16912
    s_waitcnt lgkmcnt(0)
    v_cvt_pk_bf16_f32 v24, v16, v17
    v_cvt_pk_bf16_f32 v25, v18, v19
    v_cvt_pk_bf16_f32 v26, v20, v21
    v_cvt_pk_bf16_f32 v27, v22, v23
    s_add_u32 s13, s12, 16384
    buffer_store_dwordx4 v[24:27], v5, s[4:7], s13 offen
    s_nop 1
    ds_read_b128 v[16:19], v8 offset:25344
    ds_read_b128 v[20:23], v8 offset:25360
    s_waitcnt lgkmcnt(0)
    v_cvt_pk_bf16_f32 v24, v16, v17
    v_cvt_pk_bf16_f32 v25, v18, v19
    v_cvt_pk_bf16_f32 v26, v20, v21
    v_cvt_pk_bf16_f32 v27, v22, v23
    s_add_u32 s13, s12, 24576
    buffer_store_dwordx4 v[24:27], v5, s[4:7], s13 offen
    s_nop 1
    ds_read_b128 v[16:19], v8 offset:33792
    ds_read_b128 v[20:23], v8 offset:33808
    s_waitcnt lgkmcnt(0)
    v_cvt_pk_bf16_f32 v24, v16, v17
    v_cvt_pk_bf16_f32 v25, v18, v19
    v_cvt_pk_bf16_f32 v26, v20, v21
    v_cvt_pk_bf16_f32 v27, v22, v23
    s_add_u32 s13, s12, 32768
    buffer_store_dwordx4 v[24:27], v5, s[4:7], s13 offen
    s_nop 1
    ds_read_b128 v[16:19], v8 offset:42240
    ds_read_b128 v[20:23], v8 offset:42256
    s_waitcnt lgkmcnt(0)
    v_cvt_pk_bf16_f32 v24, v16, v17
    v_cvt_pk_bf16_f32 v25, v18, v19
    v_cvt_pk_bf16_f32 v26, v20, v21
    v_cvt_pk_bf16_f32 v27, v22, v23
    s_add_u32 s13, s12, 40960
    buffer_store_dwordx4 v[24:27], v5, s[4:7], s13 offen
    s_nop 1
    ds_read_b128 v[16:19], v8 offset:50688
    ds_read_b128 v[20:23], v8 offset:50704
    s_waitcnt lgkmcnt(0)
    v_cvt_pk_bf16_f32 v24, v16, v17
    v_cvt_pk_bf16_f32 v25, v18, v19
    v_cvt_pk_bf16_f32 v26, v20, v21
    v_cvt_pk_bf16_f32 v27, v22, v23
    s_add_u32 s13, s12, 49152
    buffer_store_dwordx4 v[24:27], v5, s[4:7], s13 offen
    s_nop 1
    ds_read_b128 v[16:19], v8 offset:59136
    ds_read_b128 v[20:23], v8 offset:59152
    s_waitcnt lgkmcnt(0)
    v_cvt_pk_bf16_f32 v24, v16, v17
    v_cvt_pk_bf16_f32 v25, v18, v19
    v_cvt_pk_bf16_f32 v26, v20, v21
    v_cvt_pk_bf16_f32 v27, v22, v23
    s_add_u32 s13, s12, 57344
    buffer_store_dwordx4 v[24:27], v5, s[4:7], s13 offen
    s_nop 1
    s_add_u32 s93, s93, 64
    s_cmp_lt_u32 s93, 128
    s_cbranch_scc1 mega_kernel_f3l
mega_kernel_f3e:
mega_kernel_exit:
    s_endpgm
mega_kernel_recf:
    s_load_dwordx2 s[20:21], s[0:1], 8
    s_load_dwordx2 s[16:17], s[0:1], 40
    s_load_dwordx2 s[4:5], s[0:1], 16
    s_load_dwordx2 s[8:9], s[0:1], 24
    s_load_dwordx2 s[12:13], s[0:1], 32
    v_lshrrev_b32 v4, 6, v0
    v_and_b32 v1, 63, v0
    v_readfirstlane_b32 s24, v4
    v_lshrrev_b32 v2, 4, v1
    v_and_b32 v3, 15, v1
    v_lshlrev_b32 v17, 4, v1
    s_lshr_b32 s28, s31, 2
    s_lshl_b32 s25, s30, 3
    s_add_u32 s25, s25, s28
    s_and_b32 s26, s31, 3
    s_waitcnt lgkmcnt(0)
    s_mov_b32 s22, 16384
    s_mov_b32 s23, 0x00020000
    s_mov_b32 s18, 8388608
    s_mov_b32 s19, 0x00020000
    s_mov_b32 s6, 8388608
    s_mov_b32 s7, 0x00020000
    s_mov_b32 s10, 8388608
    s_mov_b32 s11, 0x00020000
    s_mov_b32 s14, 8388608
    s_mov_b32 s15, 0x00020000
    s_lshl_b32 s28, s25, 8
    s_lshr_b32 s29, s26, 0
    s_lshl_b32 s29, s29, 6
    s_add_u32 s28, s28, s29
    s_lshl_b32 s29, s24, 21
    s_add_u32 s28, s28, s29
    v_lshrrev_b32 v4, 2, v1
    v_and_b32 v5, 3, v1
    v_lshlrev_b32 v40, 13, v4
    v_lshl_add_u32 v40, v5, 4, v40
    v_add_u32 v40, s28, v40
    s_lshl_b32 s28, s30, 21
    s_lshl_b32 s29, s24, 19
    s_add_u32 s28, s28, s29
    s_lshr_b32 s29, s31, 0
    s_lshl_b32 s29, s29, 6
    s_add_u32 s28, s28, s29
    v_lshlrev_b32 v41, 11, v4
    v_lshl_add_u32 v41, v5, 4, v41
    v_add_u32 v41, s28, v41
    s_lshl_b32 s47, s24, 15
    s_add_u32 s47, s47, 32768
    s_lshl_b32 s28, s31, 18
    s_lshl_b32 s29, s24, 16
    s_add_u32 s28, s28, s29
    s_lshl_b32 s29, s30, 11
    s_add_u32 s28, s28, s29
    v_lshlrev_b32 v48, 13, v2
    v_lshl_add_u32 v48, v3, 7, v48
    v_add_u32 v48, s28, v48
    s_lshl_b32 s28, s30, 21
    s_lshl_b32 s29, s31, 16
    s_add_u32 s28, s28, s29
    s_lshl_b32 s29, s24, 14
    s_add_u32 s28, s28, s29
    v_lshlrev_b32 v49, 7, v1
    v_add_u32 v49, s28, v49
    s_and_b32 s76, s31, 1
    s_mul_i32 s76, s76, 8
    s_and_b32 s28, s31, 15
    s_lshl_b32 s28, s28, 4
    s_lshl_b32 s29, s24, 8
    s_add_u32 s28, s28, s29
    v_add_u32 v53, s28, v3
    s_lshr_b32 s28, s31, 4
    s_lshl_b32 s28, s28, 10
    s_add_u32 s28, s28, 384
    v_mov_b32 v54, s28
    v_mov_b32 v55, 1920
    v_cmp_gt_u32 vcc, 32, v1
    s_nop 1
    v_cndmask_b32 v54, v55, v54, vcc
    s_lshl_b32 s29, s30, 11
    v_lshl_add_u32 v51, v53, 13, v54
    v_add_u32 v51, s29, v51
    s_lshl_b32 s29, s30, 21
    v_lshl_add_u32 v52, v53, 11, v54
    v_add_u32 v52, s29, v52
    buffer_load_dword v50, v51, s[4:7], 0 offen
    s_xor_b32 s29, s76, 0
    s_lshl_b32 s28, s29, 10
    s_add_u32 s28, s28, s47
    s_add_u32 m0, s28, 0
    s_lshl_b32 s29, s29, 17
    buffer_load_dwordx4 v40, s[4:7], s29 offen lds
    s_xor_b32 s29, s76, 1
    s_lshl_b32 s28, s29, 10
    s_add_u32 s28, s28, s47
    s_add_u32 m0, s28, 0
    s_lshl_b32 s29, s29, 17
    buffer_load_dwordx4 v40, s[4:7], s29 offen lds
    s_xor_b32 s29, s76, 2
    s_lshl_b32 s28, s29, 10
    s_add_u32 s28, s28, s47
    s_add_u32 m0, s28, 0
    s_lshl_b32 s29, s29, 17
    buffer_load_dwordx4 v40, s[4:7], s29 offen lds
    s_xor_b32 s29, s76, 3
    s_lshl_b32 s28, s29, 10
    s_add_u32 s28, s28, s47
    s_add_u32 m0, s28, 0
    s_lshl_b32 s29, s29, 17
    buffer_load_dwordx4 v40, s[4:7], s29 offen lds
    s_xor_b32 s29, s76, 4
    s_lshl_b32 s28, s29, 10
    s_add_u32 s28, s28, s47
    s_add_u32 m0, s28, 0
    s_lshl_b32 s29, s29, 17
    buffer_load_dwordx4 v40, s[4:7], s29 offen lds
    s_xor_b32 s29, s76, 5
    s_lshl_b32 s28, s29, 10
    s_add_u32 s28, s28, s47
    s_add_u32 m0, s28, 0
    s_lshl_b32 s29, s29, 17
    buffer_load_dwordx4 v40, s[4:7], s29 offen lds
    s_xor_b32 s29, s76, 6
    s_lshl_b32 s28, s29, 10
    s_add_u32 s28, s28, s47
    s_add_u32 m0, s28, 0
    s_lshl_b32 s29, s29, 17
    buffer_load_dwordx4 v40, s[4:7], s29 offen lds
    s_xor_b32 s29, s76, 7
    s_lshl_b32 s28, s29, 10
    s_add_u32 s28, s28, s47
    s_add_u32 m0, s28, 0
    s_lshl_b32 s29, s29, 17
    buffer_load_dwordx4 v40, s[4:7], s29 offen lds
    s_xor_b32 s29, s76, 8
    s_lshl_b32 s28, s29, 10
    s_add_u32 s28, s28, s47
    s_add_u32 m0, s28, 0
    s_lshl_b32 s29, s29, 17
    buffer_load_dwordx4 v40, s[4:7], s29 offen lds
    s_xor_b32 s29, s76, 9
    s_lshl_b32 s28, s29, 10
    s_add_u32 s28, s28, s47
    s_add_u32 m0, s28, 0
    s_lshl_b32 s29, s29, 17
    buffer_load_dwordx4 v40, s[4:7], s29 offen lds
    s_xor_b32 s29, s76, 10
    s_lshl_b32 s28, s29, 10
    s_add_u32 s28, s28, s47
    s_add_u32 m0, s28, 0
    s_lshl_b32 s29, s29, 17
    buffer_load_dwordx4 v40, s[4:7], s29 offen lds
    s_xor_b32 s29, s76, 11
    s_lshl_b32 s28, s29, 10
    s_add_u32 s28, s28, s47
    s_add_u32 m0, s28, 0
    s_lshl_b32 s29, s29, 17
    buffer_load_dwordx4 v40, s[4:7], s29 offen lds
    s_xor_b32 s29, s76, 12
    s_lshl_b32 s28, s29, 10
    s_add_u32 s28, s28, s47
    s_add_u32 m0, s28, 0
    s_lshl_b32 s29, s29, 17
    buffer_load_dwordx4 v40, s[4:7], s29 offen lds
    s_xor_b32 s29, s76, 13
    s_lshl_b32 s28, s29, 10
    s_add_u32 s28, s28, s47
    s_add_u32 m0, s28, 0
    s_lshl_b32 s29, s29, 17
    buffer_load_dwordx4 v40, s[4:7], s29 offen lds
    s_xor_b32 s29, s76, 14
    s_lshl_b32 s28, s29, 10
    s_add_u32 s28, s28, s47
    s_add_u32 m0, s28, 0
    s_lshl_b32 s29, s29, 17
    buffer_load_dwordx4 v40, s[4:7], s29 offen lds
    s_xor_b32 s29, s76, 15
    s_lshl_b32 s28, s29, 10
    s_add_u32 s28, s28, s47
    s_add_u32 m0, s28, 0
    s_lshl_b32 s29, s29, 17
    buffer_load_dwordx4 v40, s[4:7], s29 offen lds
    buffer_load_dword v50, v51, s[8:11], 0 offen
    s_xor_b32 s29, s76, 0
    s_lshl_b32 s28, s29, 10
    s_add_u32 s28, s28, s47
    s_add_u32 m0, s28, 16384
    s_lshl_b32 s29, s29, 17
    buffer_load_dwordx4 v40, s[8:11], s29 offen lds
    s_xor_b32 s29, s76, 1
    s_lshl_b32 s28, s29, 10
    s_add_u32 s28, s28, s47
    s_add_u32 m0, s28, 16384
    s_lshl_b32 s29, s29, 17
    buffer_load_dwordx4 v40, s[8:11], s29 offen lds
    s_xor_b32 s29, s76, 2
    s_lshl_b32 s28, s29, 10
    s_add_u32 s28, s28, s47
    s_add_u32 m0, s28, 16384
    s_lshl_b32 s29, s29, 17
    buffer_load_dwordx4 v40, s[8:11], s29 offen lds
    s_xor_b32 s29, s76, 3
    s_lshl_b32 s28, s29, 10
    s_add_u32 s28, s28, s47
    s_add_u32 m0, s28, 16384
    s_lshl_b32 s29, s29, 17
    buffer_load_dwordx4 v40, s[8:11], s29 offen lds
    s_xor_b32 s29, s76, 4
    s_lshl_b32 s28, s29, 10
    s_add_u32 s28, s28, s47
    s_add_u32 m0, s28, 16384
    s_lshl_b32 s29, s29, 17
    buffer_load_dwordx4 v40, s[8:11], s29 offen lds
    s_xor_b32 s29, s76, 5
    s_lshl_b32 s28, s29, 10
    s_add_u32 s28, s28, s47
    s_add_u32 m0, s28, 16384
    s_lshl_b32 s29, s29, 17
    buffer_load_dwordx4 v40, s[8:11], s29 offen lds
    s_xor_b32 s29, s76, 6
    s_lshl_b32 s28, s29, 10
    s_add_u32 s28, s28, s47
    s_add_u32 m0, s28, 16384
    s_lshl_b32 s29, s29, 17
    buffer_load_dwordx4 v40, s[8:11], s29 offen lds
    s_xor_b32 s29, s76, 7
    s_lshl_b32 s28, s29, 10
    s_add_u32 s28, s28, s47
    s_add_u32 m0, s28, 16384
    s_lshl_b32 s29, s29, 17
    buffer_load_dwordx4 v40, s[8:11], s29 offen lds
    s_xor_b32 s29, s76, 8
    s_lshl_b32 s28, s29, 10
    s_add_u32 s28, s28, s47
    s_add_u32 m0, s28, 16384
    s_lshl_b32 s29, s29, 17
    buffer_load_dwordx4 v40, s[8:11], s29 offen lds
    s_xor_b32 s29, s76, 9
    s_lshl_b32 s28, s29, 10
    s_add_u32 s28, s28, s47
    s_add_u32 m0, s28, 16384
    s_lshl_b32 s29, s29, 17
    buffer_load_dwordx4 v40, s[8:11], s29 offen lds
    s_xor_b32 s29, s76, 10
    s_lshl_b32 s28, s29, 10
    s_add_u32 s28, s28, s47
    s_add_u32 m0, s28, 16384
    s_lshl_b32 s29, s29, 17
    buffer_load_dwordx4 v40, s[8:11], s29 offen lds
    s_xor_b32 s29, s76, 11
    s_lshl_b32 s28, s29, 10
    s_add_u32 s28, s28, s47
    s_add_u32 m0, s28, 16384
    s_lshl_b32 s29, s29, 17
    buffer_load_dwordx4 v40, s[8:11], s29 offen lds
    s_xor_b32 s29, s76, 12
    s_lshl_b32 s28, s29, 10
    s_add_u32 s28, s28, s47
    s_add_u32 m0, s28, 16384
    s_lshl_b32 s29, s29, 17
    buffer_load_dwordx4 v40, s[8:11], s29 offen lds
    s_xor_b32 s29, s76, 13
    s_lshl_b32 s28, s29, 10
    s_add_u32 s28, s28, s47
    s_add_u32 m0, s28, 16384
    s_lshl_b32 s29, s29, 17
    buffer_load_dwordx4 v40, s[8:11], s29 offen lds
    s_xor_b32 s29, s76, 14
    s_lshl_b32 s28, s29, 10
    s_add_u32 s28, s28, s47
    s_add_u32 m0, s28, 16384
    s_lshl_b32 s29, s29, 17
    buffer_load_dwordx4 v40, s[8:11], s29 offen lds
    s_xor_b32 s29, s76, 15
    s_lshl_b32 s28, s29, 10
    s_add_u32 s28, s28, s47
    s_add_u32 m0, s28, 16384
    s_lshl_b32 s29, s29, 17
    buffer_load_dwordx4 v40, s[8:11], s29 offen lds
    s_mov_b32 s40, 0x00ff00ff
    s_mov_b32 s41, 0x00ff00ff
    s_mov_b32 s48, 0xff00ff00
    s_mov_b32 s49, 0xff00ff00
    s_mov_b32 s42, 0
    s_mov_b32 s43, 0x00ff00ff
    s_mov_b32 s32, 0x3e0293ee
    v_mov_b32 v23, 0xff7fffff
    v_mov_b32 v6, 0x4444
    v_mov_b32 v4, 0xeeee
    v_cndmask_b32 v6, v6, v4, s[48:49]
    v_mov_b32 v28, -1
    v_mov_b32 v29, -1
    v_mov_b32 v30, -1
    v_mov_b32 v31, -1
    s_lshl_b32 s28, s24, 12
    v_add_u32 v7, s28, v17
    v_and_b32 v4, 7, v1
    v_lshlrev_b32 v8, 11, v4
    v_lshrrev_b32 v5, 3, v1
    v_lshl_add_u32 v8, v5, 4, v8
    s_lshl_b32 s28, s24, 9
    v_add_u32 v8, s28, v8
    s_lshl_b32 s28, s31, 9
    v_lshlrev_b32 v9, 3, v1
    v_add_u32 v9, s28, v9
    v_and_b32 v4, 7, v3
    v_lshlrev_b32 v11, 7, v2
    v_lshl_add_u32 v11, v4, 4, v11
    v_add_u32 v22, 0, v11
    s_add_u32 s28, s28, 16384
    v_add_u32 v11, s28, v11
    v_and_b32 v5, 1, v2
    v_lshlrev_b32 v10, 7, v5
    v_lshl_add_u32 v10, v4, 4, v10
    v_add_u32 v10, 1024, v10
    s_xor_b32 s37, s31, 1
    s_lshl_b32 s37, s37, 11
    s_add_u32 s37, s37, 32768
    s_xor_b32 s38, s31, 2
    s_lshl_b32 s38, s38, 11
    s_add_u32 s38, s38, 32768
    s_xor_b32 s39, s31, 3
    s_lshl_b32 s39, s39, 11
    s_add_u32 s39, s39, 32768
    v_and_b32 v4, 1, v2
    v_mul_u32_u24 v14, 576, v4
    v_lshrrev_b32 v5, 1, v2
    v_lshl_add_u32 v5, v5, 4, v3
    v_lshl_add_u32 v14, v5, 2, v14
    s_mul_i32 s28, s24, 1152
    s_add_u32 s28, s28, 13312
    v_add_u32 v18, s28, v14
    s_mul_i32 s28, s24, 2304
    v_add_u32 v14, s28, v14
    v_add_u32 v15, 1152, v14
    v_mul_u32_u24 v16, 144, v3
    v_lshl_add_u32 v16, v2, 5, v16
    v_bfe_u32 v4, v1, 1, 3
    v_mul_u32_u24 v19, 144, v4
    v_lshl_add_u32 v19, v2, 5, v19
    v_and_b32 v4, 1, v1
    v_lshl_add_u32 v19, v4, 4, v19
    v_add_u32 v19, 13312, v19
    s_lshl_b32 s28, s24, 10
    s_add_u32 s28, s28, 9216
    v_add_u32 v20, s28, v17
    v_and_b32 v4, 31, v1
    v_lshlrev_b32 v21, 3, v4
    v_add_u32 v21, 17920, v21
    v_lshrrev_b32 v4, 2, v3
    v_and_b32 v42, 1, v4
    v_lshrrev_b32 v43, 1, v4
    v_lshrrev_b32 v44, 1, v2
    v_and_b32 v45, 1, v2
    v_lshl_add_u32 v46, v44, 4, v42
    v_lshl_add_u32 v46, v45, 2, v46
    v_lshl_add_u32 v46, v43, 3, v46
    v_lshl_add_u32 v47, v44, 3, v42
    v_lshl_add_u32 v47, v45, 4, v47
    v_lshl_add_u32 v47, v43, 2, v47
    v_and_b32 v5, 3, v3
    v_lshlrev_b32 v5, 3, v5
    v_lshl_add_u32 v46, v46, 6, v5
    v_lshl_add_u32 v47, v47, 6, v5
    s_and_b32 s28, s31, 0
    s_lshl_b32 s28, s28, 6
    s_add_u32 s28, s28, s47
    v_add_u32 v46, s28, v46
    v_add_u32 v47, s28, v47
    s_waitcnt vmcnt(17)
    ds_read_b64_tr_b16 a[0:1], v46 offset:0
    ds_read_b64_tr_b16 a[2:3], v46 offset:128
    ds_read_b64_tr_b16 a[4:5], v46 offset:2048
    ds_read_b64_tr_b16 a[6:7], v46 offset:2176
    ds_read_b64_tr_b16 a[8:9], v46 offset:4096
    ds_read_b64_tr_b16 a[10:11], v46 offset:4224
    ds_read_b64_tr_b16 a[12:13], v46 offset:6144
    ds_read_b64_tr_b16 a[14:15], v46 offset:6272
    s_waitcnt lgkmcnt(0)
    ds_read_b64_tr_b16 a[16:17], v46 offset:8192
    ds_read_b64_tr_b16 a[18:19], v46 offset:8320
    ds_read_b64_tr_b16 a[20:21], v46 offset:10240
    ds_read_b64_tr_b16 a[22:23], v46 offset:10368
    ds_read_b64_tr_b16 a[24:25], v46 offset:12288
    ds_read_b64_tr_b16 a[26:27], v46 offset:12416
    ds_read_b64_tr_b16 a[28:29], v46 offset:14336
    ds_read_b64_tr_b16 a[30:31], v46 offset:14464
    s_waitcnt lgkmcnt(0)
    ds_read_b64_tr_b16 a[32:33], v46 offset:32
    ds_read_b64_tr_b16 a[34:35], v46 offset:160
    ds_read_b64_tr_b16 a[36:37], v46 offset:2080
    ds_read_b64_tr_b16 a[38:39], v46 offset:2208
    ds_read_b64_tr_b16 a[40:41], v46 offset:4128
    ds_read_b64_tr_b16 a[42:43], v46 offset:4256
    ds_read_b64_tr_b16 a[44:45], v46 offset:6176
    ds_read_b64_tr_b16 a[46:47], v46 offset:6304
    s_waitcnt lgkmcnt(0)
    ds_read_b64_tr_b16 a[48:49], v46 offset:8224
    ds_read_b64_tr_b16 a[50:51], v46 offset:8352
    ds_read_b64_tr_b16 a[52:53], v46 offset:10272
    ds_read_b64_tr_b16 a[54:55], v46 offset:10400
    ds_read_b64_tr_b16 a[56:57], v46 offset:12320
    ds_read_b64_tr_b16 a[58:59], v46 offset:12448
    ds_read_b64_tr_b16 a[60:61], v46 offset:14368
    ds_read_b64_tr_b16 a[62:63], v46 offset:14496
    s_waitcnt lgkmcnt(0)
    buffer_load_dword v50, v51, s[12:15], 0 offen
    s_xor_b32 s29, s76, 0
    s_lshl_b32 s28, s29, 10
    s_add_u32 s28, s28, s47
    s_add_u32 m0, s28, 0
    s_lshl_b32 s29, s29, 17
    buffer_load_dwordx4 v40, s[12:15], s29 offen lds
    s_xor_b32 s29, s76, 1
    s_lshl_b32 s28, s29, 10
    s_add_u32 s28, s28, s47
    s_add_u32 m0, s28, 0
    s_lshl_b32 s29, s29, 17
    buffer_load_dwordx4 v40, s[12:15], s29 offen lds
    s_xor_b32 s29, s76, 2
    s_lshl_b32 s28, s29, 10
    s_add_u32 s28, s28, s47
    s_add_u32 m0, s28, 0
    s_lshl_b32 s29, s29, 17
    buffer_load_dwordx4 v40, s[12:15], s29 offen lds
    s_xor_b32 s29, s76, 3
    s_lshl_b32 s28, s29, 10
    s_add_u32 s28, s28, s47
    s_add_u32 m0, s28, 0
    s_lshl_b32 s29, s29, 17
    buffer_load_dwordx4 v40, s[12:15], s29 offen lds
    s_xor_b32 s29, s76, 4
    s_lshl_b32 s28, s29, 10
    s_add_u32 s28, s28, s47
    s_add_u32 m0, s28, 0
    s_lshl_b32 s29, s29, 17
    buffer_load_dwordx4 v40, s[12:15], s29 offen lds
    s_xor_b32 s29, s76, 5
    s_lshl_b32 s28, s29, 10
    s_add_u32 s28, s28, s47
    s_add_u32 m0, s28, 0
    s_lshl_b32 s29, s29, 17
    buffer_load_dwordx4 v40, s[12:15], s29 offen lds
    s_xor_b32 s29, s76, 6
    s_lshl_b32 s28, s29, 10
    s_add_u32 s28, s28, s47
    s_add_u32 m0, s28, 0
    s_lshl_b32 s29, s29, 17
    buffer_load_dwordx4 v40, s[12:15], s29 offen lds
    s_xor_b32 s29, s76, 7
    s_lshl_b32 s28, s29, 10
    s_add_u32 s28, s28, s47
    s_add_u32 m0, s28, 0
    s_lshl_b32 s29, s29, 17
    buffer_load_dwordx4 v40, s[12:15], s29 offen lds
    s_xor_b32 s29, s76, 8
    s_lshl_b32 s28, s29, 10
    s_add_u32 s28, s28, s47
    s_add_u32 m0, s28, 0
    s_lshl_b32 s29, s29, 17
    buffer_load_dwordx4 v40, s[12:15], s29 offen lds
    s_xor_b32 s29, s76, 9
    s_lshl_b32 s28, s29, 10
    s_add_u32 s28, s28, s47
    s_add_u32 m0, s28, 0
    s_lshl_b32 s29, s29, 17
    buffer_load_dwordx4 v40, s[12:15], s29 offen lds
    s_xor_b32 s29, s76, 10
    s_lshl_b32 s28, s29, 10
    s_add_u32 s28, s28, s47
    s_add_u32 m0, s28, 0
    s_lshl_b32 s29, s29, 17
    buffer_load_dwordx4 v40, s[12:15], s29 offen lds
    s_xor_b32 s29, s76, 11
    s_lshl_b32 s28, s29, 10
    s_add_u32 s28, s28, s47
    s_add_u32 m0, s28, 0
    s_lshl_b32 s29, s29, 17
    buffer_load_dwordx4 v40, s[12:15], s29 offen lds
    s_xor_b32 s29, s76, 12
    s_lshl_b32 s28, s29, 10
    s_add_u32 s28, s28, s47
    s_add_u32 m0, s28, 0
    s_lshl_b32 s29, s29, 17
    buffer_load_dwordx4 v40, s[12:15], s29 offen lds
    s_xor_b32 s29, s76, 13
    s_lshl_b32 s28, s29, 10
    s_add_u32 s28, s28, s47
    s_add_u32 m0, s28, 0
    s_lshl_b32 s29, s29, 17
    buffer_load_dwordx4 v40, s[12:15], s29 offen lds
    s_xor_b32 s29, s76, 14
    s_lshl_b32 s28, s29, 10
    s_add_u32 s28, s28, s47
    s_add_u32 m0, s28, 0
    s_lshl_b32 s29, s29, 17
    buffer_load_dwordx4 v40, s[12:15], s29 offen lds
    s_xor_b32 s29, s76, 15
    s_lshl_b32 s28, s29, 10
    s_add_u32 s28, s28, s47
    s_add_u32 m0, s28, 0
    s_lshl_b32 s29, s29, 17
    buffer_load_dwordx4 v40, s[12:15], s29 offen lds
    s_waitcnt vmcnt(17)
    ds_read_b64_tr_b16 a[64:65], v46 offset:16384
    ds_read_b64_tr_b16 a[66:67], v46 offset:16512
    ds_read_b64_tr_b16 a[68:69], v46 offset:18432
    ds_read_b64_tr_b16 a[70:71], v46 offset:18560
    ds_read_b64_tr_b16 a[72:73], v46 offset:20480
    ds_read_b64_tr_b16 a[74:75], v46 offset:20608
    ds_read_b64_tr_b16 a[76:77], v46 offset:22528
    ds_read_b64_tr_b16 a[78:79], v46 offset:22656
    s_waitcnt lgkmcnt(0)
    ds_read_b64_tr_b16 a[80:81], v46 offset:24576
    ds_read_b64_tr_b16 a[82:83], v46 offset:24704
    ds_read_b64_tr_b16 a[84:85], v46 offset:26624
    ds_read_b64_tr_b16 a[86:87], v46 offset:26752
    ds_read_b64_tr_b16 a[88:89], v46 offset:28672
    ds_read_b64_tr_b16 a[90:91], v46 offset:28800
    ds_read_b64_tr_b16 a[92:93], v46 offset:30720
    ds_read_b64_tr_b16 a[94:95], v46 offset:30848
    s_waitcnt lgkmcnt(0)
    ds_read_b64_tr_b16 a[96:97], v46 offset:16416
    ds_read_b64_tr_b16 a[98:99], v46 offset:16544
    ds_read_b64_tr_b16 a[100:101], v46 offset:18464
    ds_read_b64_tr_b16 a[102:103], v46 offset:18592
    ds_read_b64_tr_b16 a[104:105], v46 offset:20512
    ds_read_b64_tr_b16 a[106:107], v46 offset:20640
    ds_read_b64_tr_b16 a[108:109], v46 offset:22560
    ds_read_b64_tr_b16 a[110:111], v46 offset:22688
    s_waitcnt lgkmcnt(0)
    ds_read_b64_tr_b16 a[112:113], v46 offset:24608
    ds_read_b64_tr_b16 a[114:115], v46 offset:24736
    ds_read_b64_tr_b16 a[116:117], v46 offset:26656
    ds_read_b64_tr_b16 a[118:119], v46 offset:26784
    ds_read_b64_tr_b16 a[120:121], v46 offset:28704
    ds_read_b64_tr_b16 a[122:123], v46 offset:28832
    ds_read_b64_tr_b16 a[124:125], v46 offset:30752
    ds_read_b64_tr_b16 a[126:127], v46 offset:30880
    s_waitcnt lgkmcnt(0)
    buffer_load_dword v50, v52, s[16:19], 0 offen
    s_xor_b32 s29, s76, 0
    s_lshl_b32 s28, s29, 10
    s_add_u32 s28, s28, s47
    s_add_u32 m0, s28, 16384
    s_lshl_b32 s29, s29, 15
    buffer_load_dwordx4 v41, s[16:19], s29 offen lds
    s_xor_b32 s29, s76, 1
    s_lshl_b32 s28, s29, 10
    s_add_u32 s28, s28, s47
    s_add_u32 m0, s28, 16384
    s_lshl_b32 s29, s29, 15
    buffer_load_dwordx4 v41, s[16:19], s29 offen lds
    s_xor_b32 s29, s76, 2
    s_lshl_b32 s28, s29, 10
    s_add_u32 s28, s28, s47
    s_add_u32 m0, s28, 16384
    s_lshl_b32 s29, s29, 15
    buffer_load_dwordx4 v41, s[16:19], s29 offen lds
    s_xor_b32 s29, s76, 3
    s_lshl_b32 s28, s29, 10
    s_add_u32 s28, s28, s47
    s_add_u32 m0, s28, 16384
    s_lshl_b32 s29, s29, 15
    buffer_load_dwordx4 v41, s[16:19], s29 offen lds
    s_xor_b32 s29, s76, 4
    s_lshl_b32 s28, s29, 10
    s_add_u32 s28, s28, s47
    s_add_u32 m0, s28, 16384
    s_lshl_b32 s29, s29, 15
    buffer_load_dwordx4 v41, s[16:19], s29 offen lds
    s_xor_b32 s29, s76, 5
    s_lshl_b32 s28, s29, 10
    s_add_u32 s28, s28, s47
    s_add_u32 m0, s28, 16384
    s_lshl_b32 s29, s29, 15
    buffer_load_dwordx4 v41, s[16:19], s29 offen lds
    s_xor_b32 s29, s76, 6
    s_lshl_b32 s28, s29, 10
    s_add_u32 s28, s28, s47
    s_add_u32 m0, s28, 16384
    s_lshl_b32 s29, s29, 15
    buffer_load_dwordx4 v41, s[16:19], s29 offen lds
    s_xor_b32 s29, s76, 7
    s_lshl_b32 s28, s29, 10
    s_add_u32 s28, s28, s47
    s_add_u32 m0, s28, 16384
    s_lshl_b32 s29, s29, 15
    buffer_load_dwordx4 v41, s[16:19], s29 offen lds
    s_xor_b32 s29, s76, 8
    s_lshl_b32 s28, s29, 10
    s_add_u32 s28, s28, s47
    s_add_u32 m0, s28, 16384
    s_lshl_b32 s29, s29, 15
    buffer_load_dwordx4 v41, s[16:19], s29 offen lds
    s_xor_b32 s29, s76, 9
    s_lshl_b32 s28, s29, 10
    s_add_u32 s28, s28, s47
    s_add_u32 m0, s28, 16384
    s_lshl_b32 s29, s29, 15
    buffer_load_dwordx4 v41, s[16:19], s29 offen lds
    s_xor_b32 s29, s76, 10
    s_lshl_b32 s28, s29, 10
    s_add_u32 s28, s28, s47
    s_add_u32 m0, s28, 16384
    s_lshl_b32 s29, s29, 15
    buffer_load_dwordx4 v41, s[16:19], s29 offen lds
    s_xor_b32 s29, s76, 11
    s_lshl_b32 s28, s29, 10
    s_add_u32 s28, s28, s47
    s_add_u32 m0, s28, 16384
    s_lshl_b32 s29, s29, 15
    buffer_load_dwordx4 v41, s[16:19], s29 offen lds
    s_xor_b32 s29, s76, 12
    s_lshl_b32 s28, s29, 10
    s_add_u32 s28, s28, s47
    s_add_u32 m0, s28, 16384
    s_lshl_b32 s29, s29, 15
    buffer_load_dwordx4 v41, s[16:19], s29 offen lds
    s_xor_b32 s29, s76, 13
    s_lshl_b32 s28, s29, 10
    s_add_u32 s28, s28, s47
    s_add_u32 m0, s28, 16384
    s_lshl_b32 s29, s29, 15
    buffer_load_dwordx4 v41, s[16:19], s29 offen lds
    s_xor_b32 s29, s76, 14
    s_lshl_b32 s28, s29, 10
    s_add_u32 s28, s28, s47
    s_add_u32 m0, s28, 16384
    s_lshl_b32 s29, s29, 15
    buffer_load_dwordx4 v41, s[16:19], s29 offen lds
    s_xor_b32 s29, s76, 15
    s_lshl_b32 s28, s29, 10
    s_add_u32 s28, s28, s47
    s_add_u32 m0, s28, 16384
    s_lshl_b32 s29, s29, 15
    buffer_load_dwordx4 v41, s[16:19], s29 offen lds
    s_waitcnt vmcnt(17)
    ds_read_b64_tr_b16 a[128:129], v46 offset:0
    ds_read_b64_tr_b16 a[130:131], v46 offset:128
    ds_read_b64_tr_b16 a[132:133], v46 offset:2048
    ds_read_b64_tr_b16 a[134:135], v46 offset:2176
    ds_read_b64_tr_b16 a[136:137], v46 offset:4096
    ds_read_b64_tr_b16 a[138:139], v46 offset:4224
    ds_read_b64_tr_b16 a[140:141], v46 offset:6144
    ds_read_b64_tr_b16 a[142:143], v46 offset:6272
    s_waitcnt lgkmcnt(0)
    ds_read_b64_tr_b16 a[144:145], v46 offset:8192
    ds_read_b64_tr_b16 a[146:147], v46 offset:8320
    ds_read_b64_tr_b16 a[148:149], v46 offset:10240
    ds_read_b64_tr_b16 a[150:151], v46 offset:10368
    ds_read_b64_tr_b16 a[152:153], v46 offset:12288
    ds_read_b64_tr_b16 a[154:155], v46 offset:12416
    ds_read_b64_tr_b16 a[156:157], v46 offset:14336
    ds_read_b64_tr_b16 a[158:159], v46 offset:14464
    s_waitcnt lgkmcnt(0)
    ds_read_b64_tr_b16 a[160:161], v46 offset:32
    ds_read_b64_tr_b16 a[162:163], v46 offset:160
    ds_read_b64_tr_b16 a[164:165], v46 offset:2080
    ds_read_b64_tr_b16 a[166:167], v46 offset:2208
    ds_read_b64_tr_b16 a[168:169], v46 offset:4128
    ds_read_b64_tr_b16 a[170:171], v46 offset:4256
    ds_read_b64_tr_b16 a[172:173], v46 offset:6176
    ds_read_b64_tr_b16 a[174:175], v46 offset:6304
    s_waitcnt lgkmcnt(0)
    ds_read_b64_tr_b16 a[176:177], v46 offset:8224
    ds_read_b64_tr_b16 a[178:179], v46 offset:8352
    ds_read_b64_tr_b16 a[180:181], v46 offset:10272
    ds_read_b64_tr_b16 a[182:183], v46 offset:10400
    ds_read_b64_tr_b16 a[184:185], v46 offset:12320
    ds_read_b64_tr_b16 a[186:187], v46 offset:12448
    ds_read_b64_tr_b16 a[188:189], v46 offset:14368
    ds_read_b64_tr_b16 a[190:191], v46 offset:14496
    s_waitcnt lgkmcnt(0)
    s_waitcnt vmcnt(0)
    ds_read_b64_tr_b16 a[192:193], v47 offset:16384
    ds_read_b64_tr_b16 a[194:195], v47 offset:16512
    ds_read_b64_tr_b16 a[196:197], v47 offset:18432
    ds_read_b64_tr_b16 a[198:199], v47 offset:18560
    ds_read_b64_tr_b16 a[200:201], v47 offset:20480
    ds_read_b64_tr_b16 a[202:203], v47 offset:20608
    ds_read_b64_tr_b16 a[204:205], v47 offset:22528
    ds_read_b64_tr_b16 a[206:207], v47 offset:22656
    s_waitcnt lgkmcnt(0)
    ds_read_b64_tr_b16 a[208:209], v47 offset:24576
    ds_read_b64_tr_b16 a[210:211], v47 offset:24704
    ds_read_b64_tr_b16 a[212:213], v47 offset:26624
    ds_read_b64_tr_b16 a[214:215], v47 offset:26752
    ds_read_b64_tr_b16 a[216:217], v47 offset:28672
    ds_read_b64_tr_b16 a[218:219], v47 offset:28800
    ds_read_b64_tr_b16 a[220:221], v47 offset:30720
    ds_read_b64_tr_b16 a[222:223], v47 offset:30848
    s_waitcnt lgkmcnt(0)
    ds_read_b64_tr_b16 a[224:225], v47 offset:16416
    ds_read_b64_tr_b16 a[226:227], v47 offset:16544
    ds_read_b64_tr_b16 a[228:229], v47 offset:18464
    ds_read_b64_tr_b16 a[230:231], v47 offset:18592
    ds_read_b64_tr_b16 a[232:233], v47 offset:20512
    ds_read_b64_tr_b16 a[234:235], v47 offset:20640
    ds_read_b64_tr_b16 a[236:237], v47 offset:22560
    ds_read_b64_tr_b16 a[238:239], v47 offset:22688
    s_waitcnt lgkmcnt(0)
    ds_read_b64_tr_b16 a[240:241], v47 offset:24608
    ds_read_b64_tr_b16 a[242:243], v47 offset:24736
    ds_read_b64_tr_b16 a[244:245], v47 offset:26656
    ds_read_b64_tr_b16 a[246:247], v47 offset:26784
    ds_read_b64_tr_b16 a[248:249], v47 offset:28704
    ds_read_b64_tr_b16 a[250:251], v47 offset:28832
    ds_read_b64_tr_b16 a[252:253], v47 offset:30752
    ds_read_b64_tr_b16 a[254:255], v47 offset:30880
    s_waitcnt lgkmcnt(0)
    v_and_b32 v5, 15, v0
    v_lshlrev_b32 v5, 4, v5
    s_branch mega_kernel_syr
    mega_kernel_syrw:
    s_sleep 4
    mega_kernel_syr:
    buffer_load_dword v4, v5, s[72:75], 0 offen sc1
    s_waitcnt vmcnt(0)
    s_cmp_eq_u32 s95, 1
    s_cbranch_scc0 mega_kernel_syrf
    v_readlane_b32 s76, v4, 14
    s_mov_b32 s98, 0
    s_cmp_eq_u32 s76, 64
    s_cbranch_scc0 mega_kernel_syrw
    s_branch mega_kernel_syrd
    mega_kernel_syrf:
    s_mov_b32 s77, 0
    s_mov_b32 s78, 0
    v_readlane_b32 s76, v4, 0
    s_add_u32 s77, s77, s76
    s_xor_b32 s76, s76, 32
    s_or_b32 s78, s78, s76
    v_readlane_b32 s76, v4, 1
    s_add_u32 s77, s77, s76
    s_xor_b32 s76, s76, 32
    s_or_b32 s78, s78, s76
    v_readlane_b32 s76, v4, 2
    s_add_u32 s77, s77, s76
    s_xor_b32 s76, s76, 32
    s_or_b32 s78, s78, s76
    v_readlane_b32 s76, v4, 3
    s_add_u32 s77, s77, s76
    s_xor_b32 s76, s76, 32
    s_or_b32 s78, s78, s76
    v_readlane_b32 s76, v4, 4
    s_add_u32 s77, s77, s76
    s_xor_b32 s76, s76, 32
    s_or_b32 s78, s78, s76
    v_readlane_b32 s76, v4, 5
    s_add_u32 s77, s77, s76
    s_xor_b32 s76, s76, 32
    s_or_b32 s78, s78, s76
    v_readlane_b32 s76, v4, 6
    s_add_u32 s77, s77, s76
    s_xor_b32 s76, s76, 32
    s_or_b32 s78, s78, s76
    v_readlane_b32 s76, v4, 7
    s_add_u32 s77, s77, s76
    s_xor_b32 s76, s76, 32
    s_or_b32 s78, s78, s76
    s_cmp_eq_u32 s77, 256
    s_cbranch_scc0 mega_kernel_syrw
    v_mov_b32 v252, v4
    s_cmp_eq_u32 s78, 0
    s_cbranch_scc0 mega_kernel_slowent
    v_readlane_b32 s76, v4, 10
    v_readlane_b32 s77, v4, 8
    s_cmp_eq_u32 s76, 64
    s_cbranch_scc0 mega_kernel_syrw
    s_cmp_gt_u32 s77, 32
    s_cselect_b32 s98, 1, 0
    mega_kernel_syrd:
    s_lshr_b32 s28, s31, 3
    s_lshl_b32 s28, s28, 14
    s_lshl_b32 s29, s98, 13
    s_add_u32 s28, s28, s29
    s_and_b32 s29, s31, 7
    s_lshl_b32 s29, s29, 10
    s_add_u32 s28, s28, s29
    s_lshl_b32 s29, s30, 16
    s_add_u32 s28, s28, s29
    s_add_u32 s28, s28, 67108864
    v_add_u32 v12, s28, v17
    v_xor_b32 v25, 0x10000, v12
    v_xor_b32 v26, 0x20000, v12
    v_xor_b32 v27, 0x30000, v12
    s_lshl_b32 s28, s25, 2
    s_add_u32 s28, s28, s26
    s_mov_b32 s82, s28
    s_lshr_b32 s29, s28, 3
    s_xor_b32 s29, s29, s98
    s_and_b32 s29, s29, 1
    s_lshl_b32 s29, s29, 13
    s_lshl_b32 s76, s28, 18
    s_add_u32 s76, s76, s29
    s_mov_b32 s83, s76
    v_add_u32 v240, s76, v17
    v_add_u32 v241, 33554432, v240
    s_lshr_b32 s29, s28, 4
    s_xor_b32 s29, s29, s98
    s_and_b32 s29, s29, 1
    s_lshl_b32 s29, s29, 13
    s_lshl_b32 s79, s28, 17
    s_add_u32 s79, s79, s29
    s_add_u32 s79, s79, 71303168
    s_xor_b32 s29, s98, 1
    s_lshl_b32 s29, s29, 13
    s_lshl_b32 s28, s25, 7
    s_add_u32 s28, s28, s29
    s_add_u32 s28, s28, 69206016
    v_and_b32 v4, 1, v1
    v_lshlrev_b32 v24, 12, v4
    v_add_u32 v24, s28, v24
    s_lshl_b32 s29, s26, 2
    v_add_u32 v24, s29, v24
    s_xor_b32 s81, s98, 1
    s_lshl_b32 s81, s81, 13
    s_lshr_b32 s29, s82, 6
    s_lshl_b32 s29, s29, 14
    s_add_u32 s81, s81, s29
    s_and_b32 s29, s82, 63
    s_lshl_b32 s29, s29, 7
    s_add_u32 s81, s81, s29
    s_add_u32 s81, s81, 69222400
    v_mov_b32 v220, 0x3f803f80
    v_mov_b32 v221, 0x3f803f80
    v_mov_b32 v222, 0x3f803f80
    v_mov_b32 v223, 0x3f803f80
    v_mov_b32 v228, 0
    s_mov_b32 s27, 0
    s_mov_b32 s46, 0
    s_mov_b32 s44, 18432
    s_mov_b32 s45, 18432
    s_cmp_eq_u32 s24, 3
    s_cbranch_scc0 mega_kernel_rf_pfi
    s_mov_b32 s76, 0
    s_cmp_gt_i32 s46, s76
    s_cbranch_scc1 mega_kernel_rf_pf0ok
    mega_kernel_rf_pf0w:
    buffer_load_dword v4, v24, s[84:87], 0 offen sc1
    s_waitcnt vmcnt(0)
    v_readlane_b32 s46, v4, 0
    v_readlane_b32 s28, v4, 1
    s_nop 1
    s_min_i32 s46, s46, s28
    s_cmp_gt_i32 s46, s76
    s_cbranch_scc0 mega_kernel_rf_pf0w
    mega_kernel_rf_pf0ok:
    s_add_u32 s77, s76, s82
    s_bfe_u32 s28, s77, 0x40002
    s_lshl_b32 s28, s28, 14
    s_and_b32 s77, s77, 3
    s_lshl_b32 s77, s77, 11
    s_add_u32 s28, s28, s77
    s_add_u32 m0, s45, 0
    s_nop 0
    buffer_load_dwordx4 v240, s[84:87], s28 offen offset:0 sc1 lds
    s_add_u32 m0, s45, 0
    s_nop 0
    buffer_load_dwordx4 v240, s[84:87], s28 offen offset:1024 sc1 lds
    s_add_u32 m0, s45, 2048
    s_nop 0
    buffer_load_dwordx4 v241, s[84:87], s28 offen offset:0 sc1 lds
    s_add_u32 m0, s45, 2048
    s_nop 0
    buffer_load_dwordx4 v241, s[84:87], s28 offen offset:1024 sc1 lds
    s_add_u32 s45, s45, 4096
    s_cmp_eq_u32 s45, 30720
    s_cselect_b32 s45, 18432, s45
    s_waitcnt vmcnt(0) lgkmcnt(0)
mega_kernel_rf_pfi:
    v_mov_b32 v96, 0
    v_mov_b32 v97, 0
    v_mov_b32 v98, 0
    v_mov_b32 v99, 0
    v_mov_b32 v100, 0
    v_mov_b32 v101, 0
    v_mov_b32 v102, 0
    v_mov_b32 v103, 0
    v_mov_b32 v104, 0
    v_mov_b32 v105, 0
    v_mov_b32 v106, 0
    v_mov_b32 v107, 0
    v_mov_b32 v108, 0
    v_mov_b32 v109, 0
    v_mov_b32 v110, 0
    v_mov_b32 v111, 0
    v_mov_b32 v112, 0
    v_mov_b32 v113, 0
    v_mov_b32 v114, 0
    v_mov_b32 v115, 0
    v_mov_b32 v116, 0
    v_mov_b32 v117, 0
    v_mov_b32 v118, 0
    v_mov_b32 v119, 0
    s_barrier
    s_and_b32 s29, s27, 1
    s_lshl_b32 s33, s29, 17
    s_lshl_b32 s28, s30, 18
    s_add_u32 s33, s33, s28
    s_add_u32 s33, s33, 68157440
    s_xor_b32 s34, s33, 131072
    s_lshl_b32 s35, s29, 18
    s_bfe_u32 s47, s27, 0x10001
    s_branch mega_kernel_rf_first
mega_kernel_rf_loop:
    buffer_load_dwordx4 v[32:35], v7, s[84:87], s33 offen offset:0 sc1
    v_add_u32 v5, s44, v17
    ds_read_b128 v[156:159], v5 offset:0
    ds_read_b128 v[160:163], v5 offset:1024
    ds_read_b128 v[164:167], v5 offset:2048
    ds_read_b128 v[168:171], v5 offset:3072
    s_nop 4
    buffer_load_dwordx4 v[36:39], v7, s[84:87], s33 offen offset:1024 sc1
    s_nop 9
    buffer_load_dwordx4 v[40:43], v7, s[84:87], s33 offen offset:2048 sc1
    s_nop 9
    buffer_load_dwordx4 v[44:47], v7, s[84:87], s33 offen offset:3072 sc1
mega_kernel_rf_pa0:
    s_waitcnt vmcnt(3)
    v_max_u32 v4, v32, v34
    v_cmp_eq_u32 vcc, -1, v4
    s_cbranch_vccnz mega_kernel_rf_par0
mega_kernel_rf_pak0:
    v_smfmac_f32_16x16x64_bf16 v[96:99], v[32:35], a[0:7], v6
    v_smfmac_f32_16x16x64_bf16 v[100:103], v[32:35], a[32:39], v6
    v_smfmac_f32_16x16x64_bf16 v[104:107], v[32:35], a[64:71], v6
    v_smfmac_f32_16x16x64_bf16 v[108:111], v[32:35], a[96:103], v6
mega_kernel_rf_pa1:
    s_waitcnt vmcnt(2)
    v_max_u32 v4, v36, v38
    v_cmp_eq_u32 vcc, -1, v4
    s_cbranch_vccnz mega_kernel_rf_par1
mega_kernel_rf_pak1:
    v_smfmac_f32_16x16x64_bf16 v[96:99], v[36:39], a[8:15], v6
    v_smfmac_f32_16x16x64_bf16 v[100:103], v[36:39], a[40:47], v6
    v_smfmac_f32_16x16x64_bf16 v[104:107], v[36:39], a[72:79], v6
    v_smfmac_f32_16x16x64_bf16 v[108:111], v[36:39], a[104:111], v6
mega_kernel_rf_pa2:
    s_waitcnt vmcnt(1)
    v_max_u32 v4, v40, v42
    v_cmp_eq_u32 vcc, -1, v4
    s_cbranch_vccnz mega_kernel_rf_par2
mega_kernel_rf_pak2:
    v_smfmac_f32_16x16x64_bf16 v[96:99], v[40:43], a[16:23], v6
    v_smfmac_f32_16x16x64_bf16 v[100:103], v[40:43], a[48:55], v6
    v_smfmac_f32_16x16x64_bf16 v[104:107], v[40:43], a[80:87], v6
    v_smfmac_f32_16x16x64_bf16 v[108:111], v[40:43], a[112:119], v6
mega_kernel_rf_pa3:
    s_waitcnt vmcnt(0)
    v_max_u32 v4, v44, v46
    v_cmp_eq_u32 vcc, -1, v4
    s_cbranch_vccnz mega_kernel_rf_par3
mega_kernel_rf_pak3:
    v_smfmac_f32_16x16x64_bf16 v[96:99], v[44:47], a[24:31], v6
    v_smfmac_f32_16x16x64_bf16 v[100:103], v[44:47], a[56:63], v6
    v_smfmac_f32_16x16x64_bf16 v[104:107], v[44:47], a[88:95], v6
    v_smfmac_f32_16x16x64_bf16 v[108:111], v[44:47], a[120:127], v6
mega_kernel_rf_adone:
    s_nop 5
    v_permlane32_swap_b32 v96, v100
    v_permlane32_swap_b32 v97, v101
    v_permlane32_swap_b32 v98, v102
    v_permlane32_swap_b32 v99, v103
    v_pk_add_f32 v[96:97], v[96:97], v[100:101]
    v_pk_add_f32 v[98:99], v[98:99], v[102:103]
    ds_write2_b32 v14, v96, v97 offset0:0 offset1:36
    ds_write2_b32 v14, v98, v99 offset0:72 offset1:108
    v_permlane32_swap_b32 v104, v108
    v_permlane32_swap_b32 v105, v109
    v_permlane32_swap_b32 v106, v110
    v_permlane32_swap_b32 v107, v111
    v_pk_add_f32 v[104:105], v[104:105], v[108:109]
    v_pk_add_f32 v[106:107], v[106:107], v[110:111]
    ds_write2_b32 v15, v104, v105 offset0:0 offset1:36
    ds_write2_b32 v15, v106, v107 offset0:72 offset1:108
    v_smfmac_f32_16x16x64_bf16 v[112:115], v[32:35], a[128:135], v6
    v_smfmac_f32_16x16x64_bf16 v[116:119], v[32:35], a[160:167], v6
    v_smfmac_f32_16x16x64_bf16 v[112:115], v[36:39], a[136:143], v6
    v_smfmac_f32_16x16x64_bf16 v[116:119], v[36:39], a[168:175], v6
    s_waitcnt lgkmcnt(0)
    s_barrier
    s_cmp_lg_u32 s24, 0
    s_cbranch_scc1 mega_kernel_rf_side
    ds_read_b128 v[120:123], v16 offset:0
    ds_read_b128 v[124:127], v16 offset:16
    ds_read_b128 v[128:131], v16 offset:2304
    ds_read_b128 v[132:135], v16 offset:2320
    ds_read_b128 v[136:139], v16 offset:4608
    ds_read_b128 v[140:143], v16 offset:4624
    ds_read_b128 v[144:147], v16 offset:6912
    ds_read_b128 v[148:151], v16 offset:6928
    v_smfmac_f32_16x16x64_bf16 v[112:115], v[40:43], a[144:151], v6
    v_smfmac_f32_16x16x64_bf16 v[116:119], v[40:43], a[176:183], v6
    v_smfmac_f32_16x16x64_bf16 v[112:115], v[44:47], a[152:159], v6
    v_smfmac_f32_16x16x64_bf16 v[116:119], v[44:47], a[184:191], v6
    s_lshl_b32 s28, s31, 11
    s_add_u32 s28, s28, s33
    s_add_u32 s28, s28, 32768
    s_add_u32 s76, s37, s33
    s_add_u32 s77, s38, s33
    s_add_u32 s78, s39, s33
    s_waitcnt lgkmcnt(4)
    v_pk_add_f32 v[120:121], v[120:121], v[128:129]
    v_pk_add_f32 v[122:123], v[122:123], v[130:131]
    v_pk_add_f32 v[124:125], v[124:125], v[132:133]
    v_pk_add_f32 v[126:127], v[126:127], v[134:135]
    s_waitcnt lgkmcnt(0)
    v_pk_add_f32 v[136:137], v[136:137], v[144:145]
    v_pk_add_f32 v[138:139], v[138:139], v[146:147]
    v_pk_add_f32 v[140:141], v[140:141], v[148:149]
    v_pk_add_f32 v[142:143], v[142:143], v[150:151]
    v_pk_add_f32 v[120:121], v[120:121], v[136:137]
    v_pk_add_f32 v[122:123], v[122:123], v[138:139]
    v_pk_add_f32 v[124:125], v[124:125], v[140:141]
    v_pk_add_f32 v[126:127], v[126:127], v[142:143]
    v_cvt_pk_bf16_f32 v152, v120, v121
    v_cvt_pk_bf16_f32 v153, v122, v123
    v_cvt_pk_bf16_f32 v154, v124, v125
    v_cvt_pk_bf16_f32 v155, v126, v127
    s_nop 1
    v_mfma_f32_16x16x32_bf16 v[176:179], v[160:163], v[152:155], 0
    v_mfma_f32_16x16x32_bf16 v[172:175], v[156:159], v[152:155], 0
    v_mfma_f32_16x16x32_bf16 v[180:183], v[152:155], v[152:155], 0
    s_cmp_eq_u32 s27, 63
    s_cbranch_scc1 mega_kernel_rf_w0last
    s_nop 4
    v_mov_b32_dpp v172, v176 row_shr:8 row_mask:0xf bank_mask:0xc
    v_mov_b32_dpp v173, v177 row_shr:8 row_mask:0xf bank_mask:0xc
    v_mov_b32_dpp v174, v178 row_shr:8 row_mask:0xf bank_mask:0xc
    v_mov_b32_dpp v175, v179 row_shr:8 row_mask:0xf bank_mask:0xc
    v_min_u32 v180, -2, v180
    v_min_u32 v172, -2, v172
    s_mov_b64 exec, s[42:43]
    buffer_store_dwordx4 v[180:183], v10, s[84:87], s28 offen
    s_mov_b64 exec, -1
    buffer_store_dwordx4 v[172:175], v17, s[84:87], s28 offen
    v_permlane32_swap_b32 v112, v116
    v_permlane32_swap_b32 v113, v117
    v_permlane32_swap_b32 v114, v118
    v_permlane32_swap_b32 v115, v119
    v_pk_add_f32 v[112:113], v[112:113], v[116:117]
    v_pk_add_f32 v[114:115], v[114:115], v[118:119]
    ds_write_b128 v20, v[112:115]
    buffer_load_dwordx4 v[184:187], v17, s[84:87], s76 offen sc1
    buffer_load_dwordx4 v[188:191], v10, s[84:87], s76 offen sc1
    buffer_load_dwordx4 v[192:195], v17, s[84:87], s77 offen sc1
    buffer_load_dwordx4 v[196:199], v10, s[84:87], s77 offen sc1
    buffer_load_dwordx4 v[200:203], v17, s[84:87], s78 offen sc1
    buffer_load_dwordx4 v[204:207], v10, s[84:87], s78 offen sc1
    v_mov_b32 v96, 0
    v_mov_b32 v97, 0
    v_mov_b32 v98, 0
    v_mov_b32 v99, 0
    v_mov_b32 v100, 0
    v_mov_b32 v101, 0
    v_mov_b32 v102, 0
    v_mov_b32 v103, 0
    s_waitcnt lgkmcnt(0)
    s_barrier
    s_nop 7
    buffer_load_dwordx4 v[184:187], v17, s[84:87], s76 offen sc1
    buffer_load_dwordx4 v[188:191], v10, s[84:87], s76 offen sc1
    buffer_load_dwordx4 v[192:195], v17, s[84:87], s77 offen sc1
    buffer_load_dwordx4 v[196:199], v10, s[84:87], s77 offen sc1
    buffer_load_dwordx4 v[200:203], v17, s[84:87], s78 offen sc1
    buffer_load_dwordx4 v[204:207], v10, s[84:87], s78 offen sc1
mega_kernel_rf_p2:
    s_waitcnt vmcnt(6)
    v_max3_u32 v4, v184, v188, v192
    v_max3_u32 v5, v196, v200, v204
    v_max_u32 v4, v4, v5
    v_cmp_eq_u32 vcc, -1, v4
    s_cbranch_vccnz mega_kernel_rf_p2r
    v_pk_add_f32 v[180:181], v[180:181], v[188:189]
    v_pk_add_f32 v[124:125], v[196:197], v[204:205]
    v_pk_add_f32 v[182:183], v[182:183], v[190:191]
    v_pk_add_f32 v[126:127], v[198:199], v[206:207]
    v_pk_add_f32 v[172:173], v[172:173], v[184:185]
    v_pk_add_f32 v[120:121], v[192:193], v[200:201]
    v_pk_add_f32 v[174:175], v[174:175], v[186:187]
    v_pk_add_f32 v[122:123], v[194:195], v[202:203]
    v_pk_add_f32 v[180:181], v[180:181], v[124:125]
    v_pk_add_f32 v[182:183], v[182:183], v[126:127]
    v_pk_add_f32 v[172:173], v[172:173], v[120:121]
    v_pk_add_f32 v[174:175], v[174:175], v[122:123]
    v_cndmask_b32 v176, v23, v180, s[42:43]
    v_cndmask_b32 v177, v23, v181, s[42:43]
    v_cndmask_b32 v178, v23, v182, s[42:43]
    v_cndmask_b32 v179, v23, v183, s[42:43]
    v_max3_f32 v232, v172, v173, v174
    v_max3_f32 v233, v176, v177, v178
    v_max3_f32 v232, v232, v175, v179
    v_max_f32 v234, v232, v233
    s_barrier
    ds_read2_b64 v[208:211], v21 offset0:0 offset1:32
    v_max_f32_dpp v232, v234, v234 row_ror:8 row_mask:0xf bank_mask:0xf
    v_max_f32_dpp v233, v234, v234 row_ror:8 row_mask:0xf bank_mask:0xf
    s_nop 1
    v_permlane16_swap_b32 v232, v233
    s_nop 0
    v_max_f32 v234, v232, v233
    v_max_f32 v235, v232, v233
    s_nop 1
    v_permlane32_swap_b32 v234, v235
    s_nop 0
    v_max_f32 v232, v234, v235
    v_mul_f32 v232, s32, v232
    v_fma_f32 v176, v176, s32, -v232
    v_fma_f32 v177, v177, s32, -v232
    v_fma_f32 v178, v178, s32, -v232
    v_fma_f32 v179, v179, s32, -v232
    v_fma_f32 v172, v172, s32, -v232
    v_fma_f32 v173, v173, s32, -v232
    v_fma_f32 v174, v174, s32, -v232
    v_fma_f32 v175, v175, s32, -v232
    v_exp_f32 v176, v176
    v_exp_f32 v177, v177
    v_exp_f32 v178, v178
    v_exp_f32 v179, v179
    v_exp_f32 v172, v172
    v_cvt_pk_bf16_f32 v216, v176, v177
    v_cvt_pk_bf16_f32 v217, v178, v179
    v_exp_f32 v173, v173
    v_exp_f32 v174, v174
    v_mfma_f32_16x16x16_bf16 v[224:227], v[220:221], v[216:217], 0
    v_exp_f32 v175, v175
    v_cvt_pk_bf16_f32 v212, v172, v173
    s_waitcnt lgkmcnt(0)
    v_mfma_f32_16x16x16_bf16 v[120:123], v[208:209], v[216:217], 0
    v_cvt_pk_bf16_f32 v213, v174, v175
    v_mfma_f32_16x16x16_bf16 v[124:127], v[210:211], v[216:217], 0
    v_mov_b32_dpp v214, v212 row_ror:8 row_mask:0xf bank_mask:0xf
    v_mov_b32_dpp v215, v213 row_ror:8 row_mask:0xf bank_mask:0xf
    s_nop 1
    v_mfma_f32_16x16x32_bf16 v[224:227], v[220:223], v[212:215], v[224:227]
    v_mfma_f32_16x16x32_bf16 v[120:123], v[164:167], v[212:215], v[120:123]
    v_mfma_f32_16x16x32_bf16 v[124:127], v[168:171], v[212:215], v[124:127]
    s_add_u32 s29, s33, 16384
    s_nop 4
    v_rcp_f32 v234, v224
    v_rcp_f32 v235, v225
    s_nop 0
    v_pk_mul_f32 v[120:121], v[120:121], v[234:235]
    v_pk_mul_f32 v[122:123], v[122:123], v[234:235]
    v_pk_mul_f32 v[124:125], v[124:125], v[234:235]
    v_pk_mul_f32 v[126:127], v[126:127], v[234:235]
    v_cvt_pk_bf16_f32 v212, v120, v121
    v_cvt_pk_bf16_f32 v213, v122, v123
    v_cvt_pk_bf16_f32 v214, v124, v125
    v_cvt_pk_bf16_f32 v215, v126, v127
    v_min_u32 v212, -2, v212
    s_mov_b64 exec, s[40:41]
    buffer_store_dwordx4 v[212:215], v11, s[84:87], s33 offen
    s_mov_b64 exec, -1
mega_kernel_rf_b3:
    s_barrier
    buffer_load_dwordx4 v[32:35], v7, s[84:87], s29 offen offset:0 sc1
    s_nop 9
    buffer_load_dwordx4 v[36:39], v7, s[84:87], s29 offen offset:1024 sc1
    s_nop 9
    buffer_load_dwordx4 v[40:43], v7, s[84:87], s29 offen offset:2048 sc1
    s_nop 9
    buffer_load_dwordx4 v[44:47], v7, s[84:87], s29 offen offset:3072 sc1
mega_kernel_rf_pc0:
    s_waitcnt vmcnt(3)
    v_cmp_eq_u32 vcc, -1, v32
    s_cbranch_vccnz mega_kernel_rf_pcr0
mega_kernel_rf_pck0:
    v_smfmac_f32_16x16x64_bf16 v[96:99], v[32:35], a[192:199], v6
    v_smfmac_f32_16x16x64_bf16 v[100:103], v[32:35], a[224:231], v6
mega_kernel_rf_pc1:
    s_waitcnt vmcnt(2)
    v_cmp_eq_u32 vcc, -1, v36
    s_cbranch_vccnz mega_kernel_rf_pcr1
mega_kernel_rf_pck1:
    v_smfmac_f32_16x16x64_bf16 v[96:99], v[36:39], a[200:207], v6
    v_smfmac_f32_16x16x64_bf16 v[100:103], v[36:39], a[232:239], v6
mega_kernel_rf_pc2:
    s_waitcnt vmcnt(1)
    v_cmp_eq_u32 vcc, -1, v40
    s_cbranch_vccnz mega_kernel_rf_pcr2
mega_kernel_rf_pck2:
    v_smfmac_f32_16x16x64_bf16 v[96:99], v[40:43], a[208:215], v6
    v_smfmac_f32_16x16x64_bf16 v[100:103], v[40:43], a[240:247], v6
mega_kernel_rf_pc3:
    s_waitcnt vmcnt(0)
    v_cmp_eq_u32 vcc, -1, v44
    s_cbranch_vccnz mega_kernel_rf_pcr3
mega_kernel_rf_pck3:
    v_smfmac_f32_16x16x64_bf16 v[96:99], v[44:47], a[216:223], v6
    v_smfmac_f32_16x16x64_bf16 v[100:103], v[44:47], a[248:255], v6
    s_nop 7
    v_permlane32_swap_b32 v96, v100
    v_permlane32_swap_b32 v97, v101
    v_permlane32_swap_b32 v98, v102
    v_permlane32_swap_b32 v99, v103
    v_pk_add_f32 v[96:97], v[96:97], v[100:101]
    v_pk_add_f32 v[98:99], v[98:99], v[102:103]
    ds_write2_b32 v18, v96, v97 offset0:0 offset1:36
    ds_write2_b32 v18, v98, v99 offset0:72 offset1:108
    s_waitcnt lgkmcnt(0)
    s_barrier
    s_cmp_lg_u32 s24, 0
    s_cbranch_scc1 mega_kernel_rf_x1
    ds_read_b128 v[120:123], v19 offset:0
    ds_read_b128 v[124:127], v19 offset:1152
    ds_read_b128 v[128:131], v19 offset:2304
    ds_read_b128 v[132:135], v19 offset:3456
    v_mov_b32 v96, 0
    v_mov_b32 v97, 0
    v_mov_b32 v98, 0
    v_mov_b32 v99, 0
    v_mov_b32 v100, 0
    v_mov_b32 v101, 0
    v_mov_b32 v102, 0
    v_mov_b32 v103, 0
    v_mov_b32 v104, 0
    v_mov_b32 v105, 0
    v_mov_b32 v106, 0
    v_mov_b32 v107, 0
    v_mov_b32 v108, 0
    v_mov_b32 v109, 0
    v_mov_b32 v110, 0
    v_mov_b32 v111, 0
    v_mov_b32 v112, 0
    v_mov_b32 v113, 0
    v_mov_b32 v114, 0
    v_mov_b32 v115, 0
    v_mov_b32 v116, 0
    v_mov_b32 v117, 0
    v_mov_b32 v118, 0
    v_mov_b32 v119, 0
    s_waitcnt lgkmcnt(2)
    v_pk_add_f32 v[120:121], v[120:121], v[124:125]
    v_pk_add_f32 v[122:123], v[122:123], v[126:127]
    s_waitcnt lgkmcnt(0)
    v_pk_add_f32 v[128:129], v[128:129], v[132:133]
    v_pk_add_f32 v[130:131], v[130:131], v[134:135]
    v_pk_add_f32 v[120:121], v[120:121], v[128:129]
    v_pk_add_f32 v[122:123], v[122:123], v[130:131]
    v_and_or_b32 v120, v120, -2, s47
    v_and_or_b32 v121, v121, -2, s47
    v_and_or_b32 v122, v122, -2, s47
    v_and_or_b32 v123, v123, -2, s47
    buffer_store_dwordx4 v[120:123], v12, s[84:87], s35 offen sc1
    s_xor_b32 s76, s47, 1
    v_mov_b32 v48, s76
    v_mov_b32 v49, s76
    v_mov_b32 v50, s76
    v_mov_b32 v51, s76
    v_mov_b32 v52, s76
    v_mov_b32 v53, s76
    v_mov_b32 v54, s76
    v_mov_b32 v55, s76
    v_mov_b32 v56, s76
    v_mov_b32 v57, s76
    v_mov_b32 v58, s76
    v_mov_b32 v59, s76
    s_nop 15
    s_nop 15
    s_nop 7
    s_cmp_eq_u32 s47, 1
    s_cbranch_scc1 mega_kernel_rf_p4_1
mega_kernel_rf_p4_0:
    buffer_load_dwordx4 v[48:51], v25, s[84:87], s35 offen sc1
    buffer_load_dwordx4 v[52:55], v26, s[84:87], s35 offen sc1
    buffer_load_dwordx4 v[56:59], v27, s[84:87], s35 offen sc1
    s_waitcnt vmcnt(36)
    s_nop 1
    v_bitop3_b32 v4, v48, v49, v50 bitop3:0xfe
    v_bitop3_b32 v5, v54, v55, v56 bitop3:0xfe
    v_bitop3_b32 v4, v4, v51, v52 bitop3:0xfe
    v_bitop3_b32 v5, v5, v57, v58 bitop3:0xfe
    v_bitop3_b32 v4, v4, v53, v59 bitop3:0xfe
    v_bitop3_b32 v4, v4, v5, 1 bitop3:0xa8
    v_cmp_ne_u32 vcc, 0, v4
    s_cbranch_vccnz mega_kernel_rf_p4_0
    s_branch mega_kernel_rf_p4d
mega_kernel_rf_p4_1:
    buffer_load_dwordx4 v[48:51], v25, s[84:87], s35 offen sc1
    buffer_load_dwordx4 v[52:55], v26, s[84:87], s35 offen sc1
    buffer_load_dwordx4 v[56:59], v27, s[84:87], s35 offen sc1
    s_waitcnt vmcnt(36)
    s_nop 1
    v_bitop3_b32 v4, v48, v49, v50 bitop3:0x80
    v_bitop3_b32 v5, v54, v55, v56 bitop3:0x80
    v_bitop3_b32 v4, v4, v51, v52 bitop3:0x80
    v_bitop3_b32 v5, v5, v57, v58 bitop3:0x80
    v_bitop3_b32 v4, v4, v53, v59 bitop3:0x80
    v_bitop3_b32 v4, v4, v5, 1 bitop3:0x80
    v_cmp_ne_u32 vcc, 1, v4
    s_cbranch_vccnz mega_kernel_rf_p4_1
mega_kernel_rf_p4d:
    v_pk_add_f32 v[120:121], v[120:121], v[48:49]
    v_pk_add_f32 v[124:125], v[52:53], v[56:57]
    v_pk_add_f32 v[122:123], v[122:123], v[50:51]
    v_pk_add_f32 v[126:127], v[54:55], v[58:59]
    v_pk_add_f32 v[120:121], v[120:121], v[124:125]
    v_pk_add_f32 v[122:123], v[122:123], v[126:127]
    v_cvt_pk_bf16_f32 v212, v120, v121
    v_cvt_pk_bf16_f32 v213, v122, v123
    v_min_u32 v212, -2, v212
    buffer_store_dwordx2 v[212:213], v9, s[84:87], s34 offen
mega_kernel_rf_b5:
    s_add_u32 s27, s27, 1
    s_add_u32 s44, s44, 4096
    s_cmp_eq_u32 s44, 30720
    s_cselect_b32 s44, 18432, s44
    s_barrier
    s_and_b32 s29, s27, 1
    s_lshl_b32 s33, s29, 17
    s_lshl_b32 s28, s30, 18
    s_add_u32 s33, s33, s28
    s_add_u32 s33, s33, 68157440
    s_xor_b32 s34, s33, 131072
    s_lshl_b32 s35, s29, 18
    s_bfe_u32 s47, s27, 0x10001
    s_branch mega_kernel_rf_loop
mega_kernel_rf_x1:
    s_cmp_eq_u32 s24, 3
    s_cbranch_scc0 mega_kernel_rf_x4
    buffer_store_dwordx2 v[28:29], v9, s[84:87], s33 offen
    s_lshl_b32 s28, s31, 11
    s_add_u32 s28, s28, s33
    s_add_u32 s28, s28, 32768
    buffer_store_dwordx4 v[28:31], v17, s[84:87], s28 offen
    buffer_store_dwordx4 v[28:31], v10, s[84:87], s28 offen
    s_add_u32 s76, s27, 2
    s_cmp_lt_u32 s76, 63
    s_cbranch_scc0 mega_kernel_rf_x4
    s_cmp_gt_i32 s46, s76
    s_cbranch_scc0 mega_kernel_rf_x4
    s_add_u32 s77, s76, s82
    s_bfe_u32 s28, s77, 0x40002
    s_lshl_b32 s28, s28, 14
    s_and_b32 s77, s77, 3
    s_lshl_b32 s77, s77, 11
    s_add_u32 s28, s28, s77
    s_add_u32 s28, s28, s83
    s_add_u32 s28, s28, 33554432
    s_buffer_load_dword s78, s[84:87], s28 offset:0
    s_buffer_load_dword s78, s[84:87], s28 offset:128
    s_buffer_load_dword s78, s[84:87], s28 offset:256
    s_buffer_load_dword s78, s[84:87], s28 offset:384
    s_buffer_load_dword s78, s[84:87], s28 offset:512
    s_buffer_load_dword s78, s[84:87], s28 offset:640
    s_buffer_load_dword s78, s[84:87], s28 offset:768
    s_buffer_load_dword s78, s[84:87], s28 offset:896
    s_buffer_load_dword s78, s[84:87], s28 offset:1024
    s_buffer_load_dword s78, s[84:87], s28 offset:1152
    s_buffer_load_dword s78, s[84:87], s28 offset:1280
    s_buffer_load_dword s78, s[84:87], s28 offset:1408
    s_buffer_load_dword s78, s[84:87], s28 offset:1536
    s_buffer_load_dword s78, s[84:87], s28 offset:1664
    s_buffer_load_dword s78, s[84:87], s28 offset:1792
    s_buffer_load_dword s78, s[84:87], s28 offset:1920
mega_kernel_rf_x4:
    v_mov_b32 v96, 0
    v_mov_b32 v97, 0
    v_mov_b32 v98, 0
    v_mov_b32 v99, 0
    v_mov_b32 v100, 0
    v_mov_b32 v101, 0
    v_mov_b32 v102, 0
    v_mov_b32 v103, 0
    v_mov_b32 v104, 0
    v_mov_b32 v105, 0
    v_mov_b32 v106, 0
    v_mov_b32 v107, 0
    v_mov_b32 v108, 0
    v_mov_b32 v109, 0
    v_mov_b32 v110, 0
    v_mov_b32 v111, 0
    v_mov_b32 v112, 0
    v_mov_b32 v113, 0
    v_mov_b32 v114, 0
    v_mov_b32 v115, 0
    v_mov_b32 v116, 0
    v_mov_b32 v117, 0
    v_mov_b32 v118, 0
    v_mov_b32 v119, 0
    s_branch mega_kernel_rf_b5
mega_kernel_rf_p2r:
    buffer_load_dwordx4 v[184:187], v17, s[84:87], s76 offen sc1
    buffer_load_dwordx4 v[188:191], v10, s[84:87], s76 offen sc1
    buffer_load_dwordx4 v[192:195], v17, s[84:87], s77 offen sc1
    buffer_load_dwordx4 v[196:199], v10, s[84:87], s77 offen sc1
    buffer_load_dwordx4 v[200:203], v17, s[84:87], s78 offen sc1
    buffer_load_dwordx4 v[204:207], v10, s[84:87], s78 offen sc1
    s_branch mega_kernel_rf_p2
mega_kernel_rf_par0:
    buffer_load_dwordx4 v[32:35], v7, s[84:87], s33 offen offset:0 sc1
    buffer_load_dwordx4 v[36:39], v7, s[84:87], s33 offen offset:1024 sc1
    buffer_load_dwordx4 v[40:43], v7, s[84:87], s33 offen offset:2048 sc1
    buffer_load_dwordx4 v[44:47], v7, s[84:87], s33 offen offset:3072 sc1
    s_branch mega_kernel_rf_pa0
mega_kernel_rf_par1:
    buffer_load_dwordx4 v[36:39], v7, s[84:87], s33 offen offset:1024 sc1
    buffer_load_dwordx4 v[40:43], v7, s[84:87], s33 offen offset:2048 sc1
    buffer_load_dwordx4 v[44:47], v7, s[84:87], s33 offen offset:3072 sc1
    s_branch mega_kernel_rf_pa1
mega_kernel_rf_par2:
    buffer_load_dwordx4 v[40:43], v7, s[84:87], s33 offen offset:2048 sc1
    buffer_load_dwordx4 v[44:47], v7, s[84:87], s33 offen offset:3072 sc1
    s_branch mega_kernel_rf_pa2
mega_kernel_rf_par3:
    buffer_load_dwordx4 v[44:47], v7, s[84:87], s33 offen offset:3072 sc1
    s_branch mega_kernel_rf_pa3
mega_kernel_rf_pcr0:
    buffer_load_dwordx4 v[32:35], v7, s[84:87], s29 offen offset:0 sc1
    buffer_load_dwordx4 v[36:39], v7, s[84:87], s29 offen offset:1024 sc1
    buffer_load_dwordx4 v[40:43], v7, s[84:87], s29 offen offset:2048 sc1
    buffer_load_dwordx4 v[44:47], v7, s[84:87], s29 offen offset:3072 sc1
    s_branch mega_kernel_rf_pc0
mega_kernel_rf_pcr1:
    buffer_load_dwordx4 v[36:39], v7, s[84:87], s29 offen offset:1024 sc1
    buffer_load_dwordx4 v[40:43], v7, s[84:87], s29 offen offset:2048 sc1
    buffer_load_dwordx4 v[44:47], v7, s[84:87], s29 offen offset:3072 sc1
    s_branch mega_kernel_rf_pc1
mega_kernel_rf_pcr2:
    buffer_load_dwordx4 v[40:43], v7, s[84:87], s29 offen offset:2048 sc1
    buffer_load_dwordx4 v[44:47], v7, s[84:87], s29 offen offset:3072 sc1
    s_branch mega_kernel_rf_pc2
mega_kernel_rf_pcr3:
    buffer_load_dwordx4 v[44:47], v7, s[84:87], s29 offen offset:3072 sc1
    s_branch mega_kernel_rf_pc3
mega_kernel_rf_w0last:
    s_nop 7
    v_permlane32_swap_b32 v112, v116
    v_permlane32_swap_b32 v113, v117
    v_permlane32_swap_b32 v114, v118
    v_permlane32_swap_b32 v115, v119
    v_pk_add_f32 v[112:113], v[112:113], v[116:117]
    v_pk_add_f32 v[114:115], v[114:115], v[118:119]
    ds_write_b128 v20, v[112:115]
    s_waitcnt lgkmcnt(0)
    s_barrier
    s_branch mega_kernel_rf_end
mega_kernel_rf_side:
    s_cmp_eq_u32 s24, 3
    s_cbranch_scc1 mega_kernel_rf_sd3
    s_cmp_eq_u32 s24, 2
    s_cbranch_scc0 mega_kernel_rf_sd4
    s_mov_b64 exec, s[40:41]
    buffer_store_dwordx4 v[28:31], v11, s[84:87], s34 offen
    s_mov_b64 exec, -1
    s_branch mega_kernel_rf_sd4
    mega_kernel_rf_sd3:
    s_add_u32 s76, s27, 1
    s_cmp_lt_u32 s76, 63
    s_cbranch_scc0 mega_kernel_rf_sd4
    s_cmp_gt_i32 s46, s76
    s_cbranch_scc1 mega_kernel_rf_pf2ok
    mega_kernel_rf_pf2w:
    buffer_load_dword v4, v24, s[84:87], 0 offen sc1
    s_waitcnt vmcnt(0)
    v_readlane_b32 s46, v4, 0
    v_readlane_b32 s28, v4, 1
    s_nop 1
    s_min_i32 s46, s46, s28
    s_cmp_gt_i32 s46, s76
    s_cbranch_scc0 mega_kernel_rf_pf2w
    mega_kernel_rf_pf2ok:
    s_add_u32 s77, s76, s82
    s_bfe_u32 s28, s77, 0x40002
    s_lshl_b32 s28, s28, 14
    s_and_b32 s77, s77, 3
    s_lshl_b32 s77, s77, 11
    s_add_u32 s28, s28, s77
    s_add_u32 m0, s45, 0
    s_nop 0
    buffer_load_dwordx4 v240, s[84:87], s28 offen offset:0 sc1 lds
    s_add_u32 m0, s45, 0
    s_nop 0
    buffer_load_dwordx4 v240, s[84:87], s28 offen offset:1024 sc1 lds
    s_add_u32 m0, s45, 2048
    s_nop 0
    buffer_load_dwordx4 v241, s[84:87], s28 offen offset:0 sc1 lds
    s_add_u32 m0, s45, 2048
    s_nop 0
    buffer_load_dwordx4 v241, s[84:87], s28 offen offset:1024 sc1 lds
    s_add_u32 s45, s45, 4096
    s_cmp_eq_u32 s45, 30720
    s_cselect_b32 s45, 18432, s45
mega_kernel_rf_sd4:
    v_smfmac_f32_16x16x64_bf16 v[112:115], v[40:43], a[144:151], v6
    v_smfmac_f32_16x16x64_bf16 v[116:119], v[40:43], a[176:183], v6
    v_smfmac_f32_16x16x64_bf16 v[112:115], v[44:47], a[152:159], v6
    v_smfmac_f32_16x16x64_bf16 v[116:119], v[44:47], a[184:191], v6
    s_nop 7
    v_permlane32_swap_b32 v112, v116
    v_permlane32_swap_b32 v113, v117
    v_permlane32_swap_b32 v114, v118
    v_permlane32_swap_b32 v115, v119
    v_pk_add_f32 v[112:113], v[112:113], v[116:117]
    v_pk_add_f32 v[114:115], v[114:115], v[118:119]
    ds_write_b128 v20, v[112:115]
    v_mov_b32 v96, 0
    v_mov_b32 v97, 0
    v_mov_b32 v98, 0
    v_mov_b32 v99, 0
    v_mov_b32 v100, 0
    v_mov_b32 v101, 0
    v_mov_b32 v102, 0
    v_mov_b32 v103, 0
    s_cmp_eq_u32 s24, 1
    s_cbranch_scc0 mega_kernel_rf_s1
    s_waitcnt lgkmcnt(0)
    ds_read_b128 v[120:123], v16 offset:0
    ds_read_b128 v[124:127], v16 offset:16
    ds_read_b128 v[128:131], v16 offset:2304
    ds_read_b128 v[132:135], v16 offset:2320
    ds_read_b128 v[136:139], v16 offset:4608
    ds_read_b128 v[140:143], v16 offset:4624
    ds_read_b128 v[144:147], v16 offset:6912
    ds_read_b128 v[148:151], v16 offset:6928
    s_waitcnt lgkmcnt(4)
    v_pk_add_f32 v[120:121], v[120:121], v[128:129]
    v_pk_add_f32 v[122:123], v[122:123], v[130:131]
    v_pk_add_f32 v[124:125], v[124:125], v[132:133]
    v_pk_add_f32 v[126:127], v[126:127], v[134:135]
    s_waitcnt lgkmcnt(0)
    v_pk_add_f32 v[136:137], v[136:137], v[144:145]
    v_pk_add_f32 v[138:139], v[138:139], v[146:147]
    v_pk_add_f32 v[140:141], v[140:141], v[148:149]
    v_pk_add_f32 v[142:143], v[142:143], v[150:151]
    v_pk_add_f32 v[120:121], v[120:121], v[136:137]
    v_pk_add_f32 v[122:123], v[122:123], v[138:139]
    v_pk_add_f32 v[124:125], v[124:125], v[140:141]
    v_pk_add_f32 v[126:127], v[126:127], v[142:143]
    v_cvt_pk_bf16_f32 v244, v120, v121
    v_cvt_pk_bf16_f32 v245, v122, v123
    v_cvt_pk_bf16_f32 v246, v124, v125
    v_cvt_pk_bf16_f32 v247, v126, v127
mega_kernel_rf_s1:
    v_add_u32 v5, 9216, v17
    s_waitcnt lgkmcnt(0)
    s_barrier
    s_cmp_eq_u32 s24, 2
    s_cbranch_scc0 mega_kernel_rf_s3
    ds_read_b128 v[120:123], v5 offset:0
    ds_read_b128 v[124:127], v5 offset:1024
    ds_read_b128 v[128:131], v5 offset:2048
    ds_read_b128 v[132:135], v5 offset:3072
    v_lshrrev_b32 v5, 1, v17
    s_waitcnt lgkmcnt(2)
    v_pk_add_f32 v[120:121], v[120:121], v[124:125]
    v_pk_add_f32 v[122:123], v[122:123], v[126:127]
    s_waitcnt lgkmcnt(0)
    v_pk_add_f32 v[128:129], v[128:129], v[132:133]
    v_pk_add_f32 v[130:131], v[130:131], v[134:135]
    v_pk_add_f32 v[120:121], v[120:121], v[128:129]
    v_pk_add_f32 v[122:123], v[122:123], v[130:131]
    v_cvt_pk_bf16_f32 v244, v120, v121
    v_cvt_pk_bf16_f32 v245, v122, v123
    ds_write_b64 v5, v[244:245] offset:17920
    s_waitcnt lgkmcnt(0)
mega_kernel_rf_s3:
    s_cmp_eq_u32 s27, 63
    s_cbranch_scc1 mega_kernel_rf_slast
    s_add_u32 s29, s33, 16384
    s_barrier
    s_cmp_eq_u32 s24, 3
    s_cbranch_scc1 mega_kernel_rf_y3
    s_add_u32 s77, s27, s82
    s_bfe_u32 s28, s77, 0x30003
    s_lshl_b32 s28, s28, 14
    s_and_b32 s77, s77, 7
    s_lshl_b32 s77, s77, 10
    s_add_u32 s28, s28, s77
    s_add_u32 s28, s28, s79
    s_cmp_eq_u32 s24, 2
    s_cbranch_scc1 mega_kernel_rf_kv2a
    s_mov_b64 exec, s[48:49]
    buffer_store_dwordx4 v[244:247], v22, s[84:87], s28 offen sc1
    s_mov_b64 exec, -1
    s_branch mega_kernel_rf_kvda
    mega_kernel_rf_kv2a:
    v_lshlrev_b32 v4, 3, v1
    buffer_store_dwordx2 v[244:245], v4, s[84:87], s28 offen offset:512 sc1
    mega_kernel_rf_kvda:
    s_and_b32 s76, s27, 0
    s_cmp_ge_u32 s27, 52
    s_cselect_b32 s76, 0, s76
    s_add_u32 s76, s76, s24
    s_cmp_eq_u32 s76, 1
    s_cbranch_scc0 mega_kernel_rf_y4
    v_mov_b32 v5, s27
    s_mov_b64 exec, 1
    buffer_store_dword v5, v228, s[84:87], s81 offen sc1
    s_mov_b64 exec, -1
    s_branch mega_kernel_rf_y4
mega_kernel_rf_y3:
    s_add_u32 s76, s27, 2
    s_cmp_lt_u32 s76, 63
    s_cbranch_scc0 mega_kernel_rf_y4
    s_cmp_gt_i32 s46, s76
    s_cbranch_scc1 mega_kernel_rf_pf3ok
    mega_kernel_rf_pf3w:
    buffer_load_dword v4, v24, s[84:87], 0 offen sc1
    s_waitcnt vmcnt(0)
    v_readlane_b32 s46, v4, 0
    v_readlane_b32 s28, v4, 1
    s_nop 1
    s_min_i32 s46, s46, s28
    s_cmp_gt_i32 s46, s76
    s_cbranch_scc0 mega_kernel_rf_y4
    mega_kernel_rf_pf3ok:
    s_add_u32 s77, s76, s82
    s_bfe_u32 s28, s77, 0x40002
    s_lshl_b32 s28, s28, 14
    s_and_b32 s77, s77, 3
    s_lshl_b32 s77, s77, 11
    s_add_u32 s28, s28, s77
    s_add_u32 s28, s28, s83
    s_buffer_load_dword s78, s[84:87], s28 offset:0
    s_buffer_load_dword s78, s[84:87], s28 offset:128
    s_buffer_load_dword s78, s[84:87], s28 offset:256
    s_buffer_load_dword s78, s[84:87], s28 offset:384
    s_buffer_load_dword s78, s[84:87], s28 offset:512
    s_buffer_load_dword s78, s[84:87], s28 offset:640
    s_buffer_load_dword s78, s[84:87], s28 offset:768
    s_buffer_load_dword s78, s[84:87], s28 offset:896
    s_buffer_load_dword s78, s[84:87], s28 offset:1024
    s_buffer_load_dword s78, s[84:87], s28 offset:1152
    s_buffer_load_dword s78, s[84:87], s28 offset:1280
    s_buffer_load_dword s78, s[84:87], s28 offset:1408
    s_buffer_load_dword s78, s[84:87], s28 offset:1536
    s_buffer_load_dword s78, s[84:87], s28 offset:1664
    s_buffer_load_dword s78, s[84:87], s28 offset:1792
    s_buffer_load_dword s78, s[84:87], s28 offset:1920
mega_kernel_rf_y4:
    s_branch mega_kernel_rf_b3
mega_kernel_rf_first:
    buffer_load_dwordx4 v[32:35], v8, s[20:23], 0 offen offset:0
    buffer_load_dwordx4 v[36:39], v8, s[20:23], 0 offen offset:128
    buffer_load_dwordx4 v[40:43], v8, s[20:23], 0 offen offset:256
    buffer_load_dwordx4 v[44:47], v8, s[20:23], 0 offen offset:384
    v_add_u32 v5, s44, v17
    ds_read_b128 v[156:159], v5 offset:0
    ds_read_b128 v[160:163], v5 offset:1024
    ds_read_b128 v[164:167], v5 offset:2048
    ds_read_b128 v[168:171], v5 offset:3072
    s_waitcnt vmcnt(0)
    v_smfmac_f32_16x16x64_bf16 v[96:99], v[32:35], a[0:7], v6
    v_smfmac_f32_16x16x64_bf16 v[100:103], v[32:35], a[32:39], v6
    v_smfmac_f32_16x16x64_bf16 v[104:107], v[32:35], a[64:71], v6
    v_smfmac_f32_16x16x64_bf16 v[108:111], v[32:35], a[96:103], v6
    v_smfmac_f32_16x16x64_bf16 v[96:99], v[36:39], a[8:15], v6
    v_smfmac_f32_16x16x64_bf16 v[100:103], v[36:39], a[40:47], v6
    v_smfmac_f32_16x16x64_bf16 v[104:107], v[36:39], a[72:79], v6
    v_smfmac_f32_16x16x64_bf16 v[108:111], v[36:39], a[104:111], v6
    v_smfmac_f32_16x16x64_bf16 v[96:99], v[40:43], a[16:23], v6
    v_smfmac_f32_16x16x64_bf16 v[100:103], v[40:43], a[48:55], v6
    v_smfmac_f32_16x16x64_bf16 v[104:107], v[40:43], a[80:87], v6
    v_smfmac_f32_16x16x64_bf16 v[108:111], v[40:43], a[112:119], v6
    v_smfmac_f32_16x16x64_bf16 v[96:99], v[44:47], a[24:31], v6
    v_smfmac_f32_16x16x64_bf16 v[100:103], v[44:47], a[56:63], v6
    v_smfmac_f32_16x16x64_bf16 v[104:107], v[44:47], a[88:95], v6
    v_smfmac_f32_16x16x64_bf16 v[108:111], v[44:47], a[120:127], v6
    s_nop 1
    s_branch mega_kernel_rf_adone
mega_kernel_rf_slast:
    s_cmp_eq_u32 s24, 3
    s_cbranch_scc1 mega_kernel_rf_end
    s_add_u32 s77, s27, s82
    s_bfe_u32 s28, s77, 0x30003
    s_lshl_b32 s28, s28, 14
    s_and_b32 s77, s77, 7
    s_lshl_b32 s77, s77, 10
    s_add_u32 s28, s28, s77
    s_add_u32 s28, s28, s79
    s_cmp_eq_u32 s24, 2
    s_cbranch_scc1 mega_kernel_rf_kv2b
    s_mov_b64 exec, s[48:49]
    buffer_store_dwordx4 v[244:247], v22, s[84:87], s28 offen sc1
    s_mov_b64 exec, -1
    s_branch mega_kernel_rf_kvdb
    mega_kernel_rf_kv2b:
    v_lshlrev_b32 v4, 3, v1
    buffer_store_dwordx2 v[244:245], v4, s[84:87], s28 offen offset:512 sc1
    mega_kernel_rf_kvdb:
    s_waitcnt vmcnt(0)
    s_barrier
    s_mov_b32 s76, 64
    s_cmp_eq_u32 s24, 1
    s_cbranch_scc0 mega_kernel_rf_end
    v_mov_b32 v5, s76
    s_mov_b64 exec, 1
    buffer_store_dword v5, v228, s[84:87], s81 offen sc1
    s_mov_b64 exec, -1
mega_kernel_rf_end:
    s_endpgm
mega_kernel_recs:
    s_load_dwordx2 s[20:21], s[0:1], 8
    s_load_dwordx2 s[16:17], s[0:1], 40
    s_load_dwordx2 s[4:5], s[0:1], 16
    s_load_dwordx2 s[8:9], s[0:1], 24
    s_load_dwordx2 s[12:13], s[0:1], 32
    v_lshrrev_b32 v4, 6, v0
    v_and_b32 v1, 63, v0
    v_readfirstlane_b32 s24, v4
    v_lshrrev_b32 v2, 4, v1
    v_and_b32 v3, 15, v1
    v_lshlrev_b32 v17, 4, v1
    s_lshr_b32 s28, s31, 2
    s_lshl_b32 s25, s30, 3
    s_add_u32 s25, s25, s28
    s_and_b32 s26, s31, 3
    s_waitcnt lgkmcnt(0)
    s_mov_b32 s22, 16384
    s_mov_b32 s23, 0x00020000
    s_mov_b32 s18, 8388608
    s_mov_b32 s19, 0x00020000
    s_mov_b32 s6, 8388608
    s_mov_b32 s7, 0x00020000
    s_mov_b32 s10, 8388608
    s_mov_b32 s11, 0x00020000
    s_mov_b32 s14, 8388608
    s_mov_b32 s15, 0x00020000
    s_lshl_b32 s28, s25, 8
    s_lshr_b32 s29, s26, 0
    s_lshl_b32 s29, s29, 6
    s_add_u32 s28, s28, s29
    s_lshl_b32 s29, s24, 21
    s_add_u32 s28, s28, s29
    v_lshrrev_b32 v4, 2, v1
    v_and_b32 v5, 3, v1
    v_lshlrev_b32 v40, 13, v4
    v_lshl_add_u32 v40, v5, 4, v40
    v_add_u32 v40, s28, v40
    s_lshl_b32 s28, s30, 21
    s_lshl_b32 s29, s24, 19
    s_add_u32 s28, s28, s29
    s_lshr_b32 s29, s31, 0
    s_lshl_b32 s29, s29, 6
    s_add_u32 s28, s28, s29
    v_lshlrev_b32 v41, 11, v4
    v_lshl_add_u32 v41, v5, 4, v41
    v_add_u32 v41, s28, v41
    s_lshl_b32 s47, s24, 15
    s_add_u32 s47, s47, 32768
    s_lshl_b32 s28, s31, 18
    s_lshl_b32 s29, s24, 16
    s_add_u32 s28, s28, s29
    s_lshl_b32 s29, s30, 11
    s_add_u32 s28, s28, s29
    v_lshlrev_b32 v48, 13, v2
    v_lshl_add_u32 v48, v3, 7, v48
    v_add_u32 v48, s28, v48
    s_lshl_b32 s28, s30, 21
    s_lshl_b32 s29, s31, 16
    s_add_u32 s28, s28, s29
    s_lshl_b32 s29, s24, 14
    s_add_u32 s28, s28, s29
    v_lshlrev_b32 v49, 7, v1
    v_add_u32 v49, s28, v49
    s_and_b32 s76, s31, 1
    s_mul_i32 s76, s76, 8
    s_and_b32 s28, s31, 15
    s_lshl_b32 s28, s28, 4
    s_lshl_b32 s29, s24, 8
    s_add_u32 s28, s28, s29
    v_add_u32 v53, s28, v3
    s_lshr_b32 s28, s31, 4
    s_lshl_b32 s28, s28, 10
    s_add_u32 s28, s28, 384
    v_mov_b32 v54, s28
    v_mov_b32 v55, 1920
    v_cmp_gt_u32 vcc, 32, v1
    s_nop 1
    v_cndmask_b32 v54, v55, v54, vcc
    s_lshl_b32 s29, s30, 11
    v_lshl_add_u32 v51, v53, 13, v54
    v_add_u32 v51, s29, v51
    s_lshl_b32 s29, s30, 21
    v_lshl_add_u32 v52, v53, 11, v54
    v_add_u32 v52, s29, v52
    buffer_load_dword v50, v51, s[4:7], 0 offen
    s_xor_b32 s29, s76, 0
    s_lshl_b32 s28, s29, 10
    s_add_u32 s28, s28, s47
    s_add_u32 m0, s28, 0
    s_lshl_b32 s29, s29, 17
    buffer_load_dwordx4 v40, s[4:7], s29 offen lds
    s_xor_b32 s29, s76, 1
    s_lshl_b32 s28, s29, 10
    s_add_u32 s28, s28, s47
    s_add_u32 m0, s28, 0
    s_lshl_b32 s29, s29, 17
    buffer_load_dwordx4 v40, s[4:7], s29 offen lds
    s_xor_b32 s29, s76, 2
    s_lshl_b32 s28, s29, 10
    s_add_u32 s28, s28, s47
    s_add_u32 m0, s28, 0
    s_lshl_b32 s29, s29, 17
    buffer_load_dwordx4 v40, s[4:7], s29 offen lds
    s_xor_b32 s29, s76, 3
    s_lshl_b32 s28, s29, 10
    s_add_u32 s28, s28, s47
    s_add_u32 m0, s28, 0
    s_lshl_b32 s29, s29, 17
    buffer_load_dwordx4 v40, s[4:7], s29 offen lds
    s_xor_b32 s29, s76, 4
    s_lshl_b32 s28, s29, 10
    s_add_u32 s28, s28, s47
    s_add_u32 m0, s28, 0
    s_lshl_b32 s29, s29, 17
    buffer_load_dwordx4 v40, s[4:7], s29 offen lds
    s_xor_b32 s29, s76, 5
    s_lshl_b32 s28, s29, 10
    s_add_u32 s28, s28, s47
    s_add_u32 m0, s28, 0
    s_lshl_b32 s29, s29, 17
    buffer_load_dwordx4 v40, s[4:7], s29 offen lds
    s_xor_b32 s29, s76, 6
    s_lshl_b32 s28, s29, 10
    s_add_u32 s28, s28, s47
    s_add_u32 m0, s28, 0
    s_lshl_b32 s29, s29, 17
    buffer_load_dwordx4 v40, s[4:7], s29 offen lds
    s_xor_b32 s29, s76, 7
    s_lshl_b32 s28, s29, 10
    s_add_u32 s28, s28, s47
    s_add_u32 m0, s28, 0
    s_lshl_b32 s29, s29, 17
    buffer_load_dwordx4 v40, s[4:7], s29 offen lds
    s_xor_b32 s29, s76, 8
    s_lshl_b32 s28, s29, 10
    s_add_u32 s28, s28, s47
    s_add_u32 m0, s28, 0
    s_lshl_b32 s29, s29, 17
    buffer_load_dwordx4 v40, s[4:7], s29 offen lds
    s_xor_b32 s29, s76, 9
    s_lshl_b32 s28, s29, 10
    s_add_u32 s28, s28, s47
    s_add_u32 m0, s28, 0
    s_lshl_b32 s29, s29, 17
    buffer_load_dwordx4 v40, s[4:7], s29 offen lds
    s_xor_b32 s29, s76, 10
    s_lshl_b32 s28, s29, 10
    s_add_u32 s28, s28, s47
    s_add_u32 m0, s28, 0
    s_lshl_b32 s29, s29, 17
    buffer_load_dwordx4 v40, s[4:7], s29 offen lds
    s_xor_b32 s29, s76, 11
    s_lshl_b32 s28, s29, 10
    s_add_u32 s28, s28, s47
    s_add_u32 m0, s28, 0
    s_lshl_b32 s29, s29, 17
    buffer_load_dwordx4 v40, s[4:7], s29 offen lds
    s_xor_b32 s29, s76, 12
    s_lshl_b32 s28, s29, 10
    s_add_u32 s28, s28, s47
    s_add_u32 m0, s28, 0
    s_lshl_b32 s29, s29, 17
    buffer_load_dwordx4 v40, s[4:7], s29 offen lds
    s_xor_b32 s29, s76, 13
    s_lshl_b32 s28, s29, 10
    s_add_u32 s28, s28, s47
    s_add_u32 m0, s28, 0
    s_lshl_b32 s29, s29, 17
    buffer_load_dwordx4 v40, s[4:7], s29 offen lds
    s_xor_b32 s29, s76, 14
    s_lshl_b32 s28, s29, 10
    s_add_u32 s28, s28, s47
    s_add_u32 m0, s28, 0
    s_lshl_b32 s29, s29, 17
    buffer_load_dwordx4 v40, s[4:7], s29 offen lds
    s_xor_b32 s29, s76, 15
    s_lshl_b32 s28, s29, 10
    s_add_u32 s28, s28, s47
    s_add_u32 m0, s28, 0
    s_lshl_b32 s29, s29, 17
    buffer_load_dwordx4 v40, s[4:7], s29 offen lds
    buffer_load_dword v50, v51, s[8:11], 0 offen
    s_xor_b32 s29, s76, 0
    s_lshl_b32 s28, s29, 10
    s_add_u32 s28, s28, s47
    s_add_u32 m0, s28, 16384
    s_lshl_b32 s29, s29, 17
    buffer_load_dwordx4 v40, s[8:11], s29 offen lds
    s_xor_b32 s29, s76, 1
    s_lshl_b32 s28, s29, 10
    s_add_u32 s28, s28, s47
    s_add_u32 m0, s28, 16384
    s_lshl_b32 s29, s29, 17
    buffer_load_dwordx4 v40, s[8:11], s29 offen lds
    s_xor_b32 s29, s76, 2
    s_lshl_b32 s28, s29, 10
    s_add_u32 s28, s28, s47
    s_add_u32 m0, s28, 16384
    s_lshl_b32 s29, s29, 17
    buffer_load_dwordx4 v40, s[8:11], s29 offen lds
    s_xor_b32 s29, s76, 3
    s_lshl_b32 s28, s29, 10
    s_add_u32 s28, s28, s47
    s_add_u32 m0, s28, 16384
    s_lshl_b32 s29, s29, 17
    buffer_load_dwordx4 v40, s[8:11], s29 offen lds
    s_xor_b32 s29, s76, 4
    s_lshl_b32 s28, s29, 10
    s_add_u32 s28, s28, s47
    s_add_u32 m0, s28, 16384
    s_lshl_b32 s29, s29, 17
    buffer_load_dwordx4 v40, s[8:11], s29 offen lds
    s_xor_b32 s29, s76, 5
    s_lshl_b32 s28, s29, 10
    s_add_u32 s28, s28, s47
    s_add_u32 m0, s28, 16384
    s_lshl_b32 s29, s29, 17
    buffer_load_dwordx4 v40, s[8:11], s29 offen lds
    s_xor_b32 s29, s76, 6
    s_lshl_b32 s28, s29, 10
    s_add_u32 s28, s28, s47
    s_add_u32 m0, s28, 16384
    s_lshl_b32 s29, s29, 17
    buffer_load_dwordx4 v40, s[8:11], s29 offen lds
    s_xor_b32 s29, s76, 7
    s_lshl_b32 s28, s29, 10
    s_add_u32 s28, s28, s47
    s_add_u32 m0, s28, 16384
    s_lshl_b32 s29, s29, 17
    buffer_load_dwordx4 v40, s[8:11], s29 offen lds
    s_xor_b32 s29, s76, 8
    s_lshl_b32 s28, s29, 10
    s_add_u32 s28, s28, s47
    s_add_u32 m0, s28, 16384
    s_lshl_b32 s29, s29, 17
    buffer_load_dwordx4 v40, s[8:11], s29 offen lds
    s_xor_b32 s29, s76, 9
    s_lshl_b32 s28, s29, 10
    s_add_u32 s28, s28, s47
    s_add_u32 m0, s28, 16384
    s_lshl_b32 s29, s29, 17
    buffer_load_dwordx4 v40, s[8:11], s29 offen lds
    s_xor_b32 s29, s76, 10
    s_lshl_b32 s28, s29, 10
    s_add_u32 s28, s28, s47
    s_add_u32 m0, s28, 16384
    s_lshl_b32 s29, s29, 17
    buffer_load_dwordx4 v40, s[8:11], s29 offen lds
    s_xor_b32 s29, s76, 11
    s_lshl_b32 s28, s29, 10
    s_add_u32 s28, s28, s47
    s_add_u32 m0, s28, 16384
    s_lshl_b32 s29, s29, 17
    buffer_load_dwordx4 v40, s[8:11], s29 offen lds
    s_xor_b32 s29, s76, 12
    s_lshl_b32 s28, s29, 10
    s_add_u32 s28, s28, s47
    s_add_u32 m0, s28, 16384
    s_lshl_b32 s29, s29, 17
    buffer_load_dwordx4 v40, s[8:11], s29 offen lds
    s_xor_b32 s29, s76, 13
    s_lshl_b32 s28, s29, 10
    s_add_u32 s28, s28, s47
    s_add_u32 m0, s28, 16384
    s_lshl_b32 s29, s29, 17
    buffer_load_dwordx4 v40, s[8:11], s29 offen lds
    s_xor_b32 s29, s76, 14
    s_lshl_b32 s28, s29, 10
    s_add_u32 s28, s28, s47
    s_add_u32 m0, s28, 16384
    s_lshl_b32 s29, s29, 17
    buffer_load_dwordx4 v40, s[8:11], s29 offen lds
    s_xor_b32 s29, s76, 15
    s_lshl_b32 s28, s29, 10
    s_add_u32 s28, s28, s47
    s_add_u32 m0, s28, 16384
    s_lshl_b32 s29, s29, 17
    buffer_load_dwordx4 v40, s[8:11], s29 offen lds
    s_mov_b32 s40, 0x00ff00ff
    s_mov_b32 s41, 0x00ff00ff
    s_mov_b32 s48, 0xff00ff00
    s_mov_b32 s49, 0xff00ff00
    s_mov_b32 s42, 0
    s_mov_b32 s43, 0x00ff00ff
    s_mov_b32 s32, 0x3e0293ee
    v_mov_b32 v23, 0xff7fffff
    v_mov_b32 v6, 0x4444
    v_mov_b32 v4, 0xeeee
    v_cndmask_b32 v6, v6, v4, s[48:49]
    v_mov_b32 v28, -1
    v_mov_b32 v29, -1
    v_mov_b32 v30, -1
    v_mov_b32 v31, -1
    s_lshl_b32 s28, s24, 12
    v_add_u32 v7, s28, v17
    v_and_b32 v4, 7, v1
    v_lshlrev_b32 v8, 11, v4
    v_lshrrev_b32 v5, 3, v1
    v_lshl_add_u32 v8, v5, 4, v8
    s_lshl_b32 s28, s24, 9
    v_add_u32 v8, s28, v8
    s_lshl_b32 s28, s31, 9
    v_lshlrev_b32 v9, 3, v1
    v_add_u32 v9, s28, v9
    v_and_b32 v4, 7, v3
    v_lshlrev_b32 v11, 7, v2
    v_lshl_add_u32 v11, v4, 4, v11
    v_add_u32 v22, 0, v11
    s_add_u32 s28, s28, 16384
    v_add_u32 v11, s28, v11
    v_and_b32 v5, 1, v2
    v_lshlrev_b32 v10, 7, v5
    v_lshl_add_u32 v10, v4, 4, v10
    v_add_u32 v10, 1024, v10
    s_xor_b32 s37, s31, 1
    s_lshl_b32 s37, s37, 11
    s_add_u32 s37, s37, 32768
    s_xor_b32 s38, s31, 2
    s_lshl_b32 s38, s38, 11
    s_add_u32 s38, s38, 32768
    s_xor_b32 s39, s31, 3
    s_lshl_b32 s39, s39, 11
    s_add_u32 s39, s39, 32768
    v_and_b32 v4, 1, v2
    v_mul_u32_u24 v14, 576, v4
    v_lshrrev_b32 v5, 1, v2
    v_lshl_add_u32 v5, v5, 4, v3
    v_lshl_add_u32 v14, v5, 2, v14
    s_mul_i32 s28, s24, 1152
    s_add_u32 s28, s28, 13312
    v_add_u32 v18, s28, v14
    s_mul_i32 s28, s24, 2304
    v_add_u32 v14, s28, v14
    v_add_u32 v15, 1152, v14
    v_mul_u32_u24 v16, 144, v3
    v_lshl_add_u32 v16, v2, 5, v16
    v_bfe_u32 v4, v1, 1, 3
    v_mul_u32_u24 v19, 144, v4
    v_lshl_add_u32 v19, v2, 5, v19
    v_and_b32 v4, 1, v1
    v_lshl_add_u32 v19, v4, 4, v19
    v_add_u32 v19, 13312, v19
    s_lshl_b32 s28, s24, 10
    s_add_u32 s28, s28, 9216
    v_add_u32 v20, s28, v17
    v_and_b32 v4, 31, v1
    v_lshlrev_b32 v21, 3, v4
    v_add_u32 v21, 17920, v21
    v_lshrrev_b32 v4, 2, v3
    v_and_b32 v42, 1, v4
    v_lshrrev_b32 v43, 1, v4
    v_lshrrev_b32 v44, 1, v2
    v_and_b32 v45, 1, v2
    v_lshl_add_u32 v46, v44, 4, v42
    v_lshl_add_u32 v46, v45, 2, v46
    v_lshl_add_u32 v46, v43, 3, v46
    v_lshl_add_u32 v47, v44, 3, v42
    v_lshl_add_u32 v47, v45, 4, v47
    v_lshl_add_u32 v47, v43, 2, v47
    v_and_b32 v5, 3, v3
    v_lshlrev_b32 v5, 3, v5
    v_lshl_add_u32 v46, v46, 6, v5
    v_lshl_add_u32 v47, v47, 6, v5
    s_and_b32 s28, s31, 0
    s_lshl_b32 s28, s28, 6
    s_add_u32 s28, s28, s47
    v_add_u32 v46, s28, v46
    v_add_u32 v47, s28, v47
    s_waitcnt vmcnt(17)
    ds_read_b64_tr_b16 a[0:1], v46 offset:0
    ds_read_b64_tr_b16 a[2:3], v46 offset:128
    ds_read_b64_tr_b16 a[4:5], v46 offset:2048
    ds_read_b64_tr_b16 a[6:7], v46 offset:2176
    ds_read_b64_tr_b16 a[8:9], v46 offset:4096
    ds_read_b64_tr_b16 a[10:11], v46 offset:4224
    ds_read_b64_tr_b16 a[12:13], v46 offset:6144
    ds_read_b64_tr_b16 a[14:15], v46 offset:6272
    s_waitcnt lgkmcnt(0)
    ds_read_b64_tr_b16 a[16:17], v46 offset:8192
    ds_read_b64_tr_b16 a[18:19], v46 offset:8320
    ds_read_b64_tr_b16 a[20:21], v46 offset:10240
    ds_read_b64_tr_b16 a[22:23], v46 offset:10368
    ds_read_b64_tr_b16 a[24:25], v46 offset:12288
    ds_read_b64_tr_b16 a[26:27], v46 offset:12416
    ds_read_b64_tr_b16 a[28:29], v46 offset:14336
    ds_read_b64_tr_b16 a[30:31], v46 offset:14464
    s_waitcnt lgkmcnt(0)
    ds_read_b64_tr_b16 a[32:33], v46 offset:32
    ds_read_b64_tr_b16 a[34:35], v46 offset:160
    ds_read_b64_tr_b16 a[36:37], v46 offset:2080
    ds_read_b64_tr_b16 a[38:39], v46 offset:2208
    ds_read_b64_tr_b16 a[40:41], v46 offset:4128
    ds_read_b64_tr_b16 a[42:43], v46 offset:4256
    ds_read_b64_tr_b16 a[44:45], v46 offset:6176
    ds_read_b64_tr_b16 a[46:47], v46 offset:6304
    s_waitcnt lgkmcnt(0)
    ds_read_b64_tr_b16 a[48:49], v46 offset:8224
    ds_read_b64_tr_b16 a[50:51], v46 offset:8352
    ds_read_b64_tr_b16 a[52:53], v46 offset:10272
    ds_read_b64_tr_b16 a[54:55], v46 offset:10400
    ds_read_b64_tr_b16 a[56:57], v46 offset:12320
    ds_read_b64_tr_b16 a[58:59], v46 offset:12448
    ds_read_b64_tr_b16 a[60:61], v46 offset:14368
    ds_read_b64_tr_b16 a[62:63], v46 offset:14496
    s_waitcnt lgkmcnt(0)
    buffer_load_dword v50, v51, s[12:15], 0 offen
    s_xor_b32 s29, s76, 0
    s_lshl_b32 s28, s29, 10
    s_add_u32 s28, s28, s47
    s_add_u32 m0, s28, 0
    s_lshl_b32 s29, s29, 17
    buffer_load_dwordx4 v40, s[12:15], s29 offen lds
    s_xor_b32 s29, s76, 1
    s_lshl_b32 s28, s29, 10
    s_add_u32 s28, s28, s47
    s_add_u32 m0, s28, 0
    s_lshl_b32 s29, s29, 17
    buffer_load_dwordx4 v40, s[12:15], s29 offen lds
    s_xor_b32 s29, s76, 2
    s_lshl_b32 s28, s29, 10
    s_add_u32 s28, s28, s47
    s_add_u32 m0, s28, 0
    s_lshl_b32 s29, s29, 17
    buffer_load_dwordx4 v40, s[12:15], s29 offen lds
    s_xor_b32 s29, s76, 3
    s_lshl_b32 s28, s29, 10
    s_add_u32 s28, s28, s47
    s_add_u32 m0, s28, 0
    s_lshl_b32 s29, s29, 17
    buffer_load_dwordx4 v40, s[12:15], s29 offen lds
    s_xor_b32 s29, s76, 4
    s_lshl_b32 s28, s29, 10
    s_add_u32 s28, s28, s47
    s_add_u32 m0, s28, 0
    s_lshl_b32 s29, s29, 17
    buffer_load_dwordx4 v40, s[12:15], s29 offen lds
    s_xor_b32 s29, s76, 5
    s_lshl_b32 s28, s29, 10
    s_add_u32 s28, s28, s47
    s_add_u32 m0, s28, 0
    s_lshl_b32 s29, s29, 17
    buffer_load_dwordx4 v40, s[12:15], s29 offen lds
    s_xor_b32 s29, s76, 6
    s_lshl_b32 s28, s29, 10
    s_add_u32 s28, s28, s47
    s_add_u32 m0, s28, 0
    s_lshl_b32 s29, s29, 17
    buffer_load_dwordx4 v40, s[12:15], s29 offen lds
    s_xor_b32 s29, s76, 7
    s_lshl_b32 s28, s29, 10
    s_add_u32 s28, s28, s47
    s_add_u32 m0, s28, 0
    s_lshl_b32 s29, s29, 17
    buffer_load_dwordx4 v40, s[12:15], s29 offen lds
    s_xor_b32 s29, s76, 8
    s_lshl_b32 s28, s29, 10
    s_add_u32 s28, s28, s47
    s_add_u32 m0, s28, 0
    s_lshl_b32 s29, s29, 17
    buffer_load_dwordx4 v40, s[12:15], s29 offen lds
    s_xor_b32 s29, s76, 9
    s_lshl_b32 s28, s29, 10
    s_add_u32 s28, s28, s47
    s_add_u32 m0, s28, 0
    s_lshl_b32 s29, s29, 17
    buffer_load_dwordx4 v40, s[12:15], s29 offen lds
    s_xor_b32 s29, s76, 10
    s_lshl_b32 s28, s29, 10
    s_add_u32 s28, s28, s47
    s_add_u32 m0, s28, 0
    s_lshl_b32 s29, s29, 17
    buffer_load_dwordx4 v40, s[12:15], s29 offen lds
    s_xor_b32 s29, s76, 11
    s_lshl_b32 s28, s29, 10
    s_add_u32 s28, s28, s47
    s_add_u32 m0, s28, 0
    s_lshl_b32 s29, s29, 17
    buffer_load_dwordx4 v40, s[12:15], s29 offen lds
    s_xor_b32 s29, s76, 12
    s_lshl_b32 s28, s29, 10
    s_add_u32 s28, s28, s47
    s_add_u32 m0, s28, 0
    s_lshl_b32 s29, s29, 17
    buffer_load_dwordx4 v40, s[12:15], s29 offen lds
    s_xor_b32 s29, s76, 13
    s_lshl_b32 s28, s29, 10
    s_add_u32 s28, s28, s47
    s_add_u32 m0, s28, 0
    s_lshl_b32 s29, s29, 17
    buffer_load_dwordx4 v40, s[12:15], s29 offen lds
    s_xor_b32 s29, s76, 14
    s_lshl_b32 s28, s29, 10
    s_add_u32 s28, s28, s47
    s_add_u32 m0, s28, 0
    s_lshl_b32 s29, s29, 17
    buffer_load_dwordx4 v40, s[12:15], s29 offen lds
    s_xor_b32 s29, s76, 15
    s_lshl_b32 s28, s29, 10
    s_add_u32 s28, s28, s47
    s_add_u32 m0, s28, 0
    s_lshl_b32 s29, s29, 17
    buffer_load_dwordx4 v40, s[12:15], s29 offen lds
    s_waitcnt vmcnt(17)
    ds_read_b64_tr_b16 a[64:65], v46 offset:16384
    ds_read_b64_tr_b16 a[66:67], v46 offset:16512
    ds_read_b64_tr_b16 a[68:69], v46 offset:18432
    ds_read_b64_tr_b16 a[70:71], v46 offset:18560
    ds_read_b64_tr_b16 a[72:73], v46 offset:20480
    ds_read_b64_tr_b16 a[74:75], v46 offset:20608
    ds_read_b64_tr_b16 a[76:77], v46 offset:22528
    ds_read_b64_tr_b16 a[78:79], v46 offset:22656
    s_waitcnt lgkmcnt(0)
    ds_read_b64_tr_b16 a[80:81], v46 offset:24576
    ds_read_b64_tr_b16 a[82:83], v46 offset:24704
    ds_read_b64_tr_b16 a[84:85], v46 offset:26624
    ds_read_b64_tr_b16 a[86:87], v46 offset:26752
    ds_read_b64_tr_b16 a[88:89], v46 offset:28672
    ds_read_b64_tr_b16 a[90:91], v46 offset:28800
    ds_read_b64_tr_b16 a[92:93], v46 offset:30720
    ds_read_b64_tr_b16 a[94:95], v46 offset:30848
    s_waitcnt lgkmcnt(0)
    ds_read_b64_tr_b16 a[96:97], v46 offset:16416
    ds_read_b64_tr_b16 a[98:99], v46 offset:16544
    ds_read_b64_tr_b16 a[100:101], v46 offset:18464
    ds_read_b64_tr_b16 a[102:103], v46 offset:18592
    ds_read_b64_tr_b16 a[104:105], v46 offset:20512
    ds_read_b64_tr_b16 a[106:107], v46 offset:20640
    ds_read_b64_tr_b16 a[108:109], v46 offset:22560
    ds_read_b64_tr_b16 a[110:111], v46 offset:22688
    s_waitcnt lgkmcnt(0)
    ds_read_b64_tr_b16 a[112:113], v46 offset:24608
    ds_read_b64_tr_b16 a[114:115], v46 offset:24736
    ds_read_b64_tr_b16 a[116:117], v46 offset:26656
    ds_read_b64_tr_b16 a[118:119], v46 offset:26784
    ds_read_b64_tr_b16 a[120:121], v46 offset:28704
    ds_read_b64_tr_b16 a[122:123], v46 offset:28832
    ds_read_b64_tr_b16 a[124:125], v46 offset:30752
    ds_read_b64_tr_b16 a[126:127], v46 offset:30880
    s_waitcnt lgkmcnt(0)
    buffer_load_dword v50, v52, s[16:19], 0 offen
    s_xor_b32 s29, s76, 0
    s_lshl_b32 s28, s29, 10
    s_add_u32 s28, s28, s47
    s_add_u32 m0, s28, 16384
    s_lshl_b32 s29, s29, 15
    buffer_load_dwordx4 v41, s[16:19], s29 offen lds
    s_xor_b32 s29, s76, 1
    s_lshl_b32 s28, s29, 10
    s_add_u32 s28, s28, s47
    s_add_u32 m0, s28, 16384
    s_lshl_b32 s29, s29, 15
    buffer_load_dwordx4 v41, s[16:19], s29 offen lds
    s_xor_b32 s29, s76, 2
    s_lshl_b32 s28, s29, 10
    s_add_u32 s28, s28, s47
    s_add_u32 m0, s28, 16384
    s_lshl_b32 s29, s29, 15
    buffer_load_dwordx4 v41, s[16:19], s29 offen lds
    s_xor_b32 s29, s76, 3
    s_lshl_b32 s28, s29, 10
    s_add_u32 s28, s28, s47
    s_add_u32 m0, s28, 16384
    s_lshl_b32 s29, s29, 15
    buffer_load_dwordx4 v41, s[16:19], s29 offen lds
    s_xor_b32 s29, s76, 4
    s_lshl_b32 s28, s29, 10
    s_add_u32 s28, s28, s47
    s_add_u32 m0, s28, 16384
    s_lshl_b32 s29, s29, 15
    buffer_load_dwordx4 v41, s[16:19], s29 offen lds
    s_xor_b32 s29, s76, 5
    s_lshl_b32 s28, s29, 10
    s_add_u32 s28, s28, s47
    s_add_u32 m0, s28, 16384
    s_lshl_b32 s29, s29, 15
    buffer_load_dwordx4 v41, s[16:19], s29 offen lds
    s_xor_b32 s29, s76, 6
    s_lshl_b32 s28, s29, 10
    s_add_u32 s28, s28, s47
    s_add_u32 m0, s28, 16384
    s_lshl_b32 s29, s29, 15
    buffer_load_dwordx4 v41, s[16:19], s29 offen lds
    s_xor_b32 s29, s76, 7
    s_lshl_b32 s28, s29, 10
    s_add_u32 s28, s28, s47
    s_add_u32 m0, s28, 16384
    s_lshl_b32 s29, s29, 15
    buffer_load_dwordx4 v41, s[16:19], s29 offen lds
    s_xor_b32 s29, s76, 8
    s_lshl_b32 s28, s29, 10
    s_add_u32 s28, s28, s47
    s_add_u32 m0, s28, 16384
    s_lshl_b32 s29, s29, 15
    buffer_load_dwordx4 v41, s[16:19], s29 offen lds
    s_xor_b32 s29, s76, 9
    s_lshl_b32 s28, s29, 10
    s_add_u32 s28, s28, s47
    s_add_u32 m0, s28, 16384
    s_lshl_b32 s29, s29, 15
    buffer_load_dwordx4 v41, s[16:19], s29 offen lds
    s_xor_b32 s29, s76, 10
    s_lshl_b32 s28, s29, 10
    s_add_u32 s28, s28, s47
    s_add_u32 m0, s28, 16384
    s_lshl_b32 s29, s29, 15
    buffer_load_dwordx4 v41, s[16:19], s29 offen lds
    s_xor_b32 s29, s76, 11
    s_lshl_b32 s28, s29, 10
    s_add_u32 s28, s28, s47
    s_add_u32 m0, s28, 16384
    s_lshl_b32 s29, s29, 15
    buffer_load_dwordx4 v41, s[16:19], s29 offen lds
    s_xor_b32 s29, s76, 12
    s_lshl_b32 s28, s29, 10
    s_add_u32 s28, s28, s47
    s_add_u32 m0, s28, 16384
    s_lshl_b32 s29, s29, 15
    buffer_load_dwordx4 v41, s[16:19], s29 offen lds
    s_xor_b32 s29, s76, 13
    s_lshl_b32 s28, s29, 10
    s_add_u32 s28, s28, s47
    s_add_u32 m0, s28, 16384
    s_lshl_b32 s29, s29, 15
    buffer_load_dwordx4 v41, s[16:19], s29 offen lds
    s_xor_b32 s29, s76, 14
    s_lshl_b32 s28, s29, 10
    s_add_u32 s28, s28, s47
    s_add_u32 m0, s28, 16384
    s_lshl_b32 s29, s29, 15
    buffer_load_dwordx4 v41, s[16:19], s29 offen lds
    s_xor_b32 s29, s76, 15
    s_lshl_b32 s28, s29, 10
    s_add_u32 s28, s28, s47
    s_add_u32 m0, s28, 16384
    s_lshl_b32 s29, s29, 15
    buffer_load_dwordx4 v41, s[16:19], s29 offen lds
    s_waitcnt vmcnt(17)
    ds_read_b64_tr_b16 a[128:129], v46 offset:0
    ds_read_b64_tr_b16 a[130:131], v46 offset:128
    ds_read_b64_tr_b16 a[132:133], v46 offset:2048
    ds_read_b64_tr_b16 a[134:135], v46 offset:2176
    ds_read_b64_tr_b16 a[136:137], v46 offset:4096
    ds_read_b64_tr_b16 a[138:139], v46 offset:4224
    ds_read_b64_tr_b16 a[140:141], v46 offset:6144
    ds_read_b64_tr_b16 a[142:143], v46 offset:6272
    s_waitcnt lgkmcnt(0)
    ds_read_b64_tr_b16 a[144:145], v46 offset:8192
    ds_read_b64_tr_b16 a[146:147], v46 offset:8320
    ds_read_b64_tr_b16 a[148:149], v46 offset:10240
    ds_read_b64_tr_b16 a[150:151], v46 offset:10368
    ds_read_b64_tr_b16 a[152:153], v46 offset:12288
    ds_read_b64_tr_b16 a[154:155], v46 offset:12416
    ds_read_b64_tr_b16 a[156:157], v46 offset:14336
    ds_read_b64_tr_b16 a[158:159], v46 offset:14464
    s_waitcnt lgkmcnt(0)
    ds_read_b64_tr_b16 a[160:161], v46 offset:32
    ds_read_b64_tr_b16 a[162:163], v46 offset:160
    ds_read_b64_tr_b16 a[164:165], v46 offset:2080
    ds_read_b64_tr_b16 a[166:167], v46 offset:2208
    ds_read_b64_tr_b16 a[168:169], v46 offset:4128
    ds_read_b64_tr_b16 a[170:171], v46 offset:4256
    ds_read_b64_tr_b16 a[172:173], v46 offset:6176
    ds_read_b64_tr_b16 a[174:175], v46 offset:6304
    s_waitcnt lgkmcnt(0)
    ds_read_b64_tr_b16 a[176:177], v46 offset:8224
    ds_read_b64_tr_b16 a[178:179], v46 offset:8352
    ds_read_b64_tr_b16 a[180:181], v46 offset:10272
    ds_read_b64_tr_b16 a[182:183], v46 offset:10400
    ds_read_b64_tr_b16 a[184:185], v46 offset:12320
    ds_read_b64_tr_b16 a[186:187], v46 offset:12448
    ds_read_b64_tr_b16 a[188:189], v46 offset:14368
    ds_read_b64_tr_b16 a[190:191], v46 offset:14496
    s_waitcnt lgkmcnt(0)
    s_waitcnt vmcnt(0)
    ds_read_b64_tr_b16 a[192:193], v47 offset:16384
    ds_read_b64_tr_b16 a[194:195], v47 offset:16512
    ds_read_b64_tr_b16 a[196:197], v47 offset:18432
    ds_read_b64_tr_b16 a[198:199], v47 offset:18560
    ds_read_b64_tr_b16 a[200:201], v47 offset:20480
    ds_read_b64_tr_b16 a[202:203], v47 offset:20608
    ds_read_b64_tr_b16 a[204:205], v47 offset:22528
    ds_read_b64_tr_b16 a[206:207], v47 offset:22656
    s_waitcnt lgkmcnt(0)
    ds_read_b64_tr_b16 a[208:209], v47 offset:24576
    ds_read_b64_tr_b16 a[210:211], v47 offset:24704
    ds_read_b64_tr_b16 a[212:213], v47 offset:26624
    ds_read_b64_tr_b16 a[214:215], v47 offset:26752
    ds_read_b64_tr_b16 a[216:217], v47 offset:28672
    ds_read_b64_tr_b16 a[218:219], v47 offset:28800
    ds_read_b64_tr_b16 a[220:221], v47 offset:30720
    ds_read_b64_tr_b16 a[222:223], v47 offset:30848
    s_waitcnt lgkmcnt(0)
    ds_read_b64_tr_b16 a[224:225], v47 offset:16416
    ds_read_b64_tr_b16 a[226:227], v47 offset:16544
    ds_read_b64_tr_b16 a[228:229], v47 offset:18464
    ds_read_b64_tr_b16 a[230:231], v47 offset:18592
    ds_read_b64_tr_b16 a[232:233], v47 offset:20512
    ds_read_b64_tr_b16 a[234:235], v47 offset:20640
    ds_read_b64_tr_b16 a[236:237], v47 offset:22560
    ds_read_b64_tr_b16 a[238:239], v47 offset:22688
    s_waitcnt lgkmcnt(0)
    ds_read_b64_tr_b16 a[240:241], v47 offset:24608
    ds_read_b64_tr_b16 a[242:243], v47 offset:24736
    ds_read_b64_tr_b16 a[244:245], v47 offset:26656
    ds_read_b64_tr_b16 a[246:247], v47 offset:26784
    ds_read_b64_tr_b16 a[248:249], v47 offset:28704
    ds_read_b64_tr_b16 a[250:251], v47 offset:28832
    ds_read_b64_tr_b16 a[252:253], v47 offset:30752
    ds_read_b64_tr_b16 a[254:255], v47 offset:30880
    s_waitcnt lgkmcnt(0)
    v_and_b32 v5, 15, v0
    v_lshlrev_b32 v5, 4, v5
    s_branch mega_kernel_sys
    mega_kernel_sysw:
    s_sleep 4
    mega_kernel_sys:
    buffer_load_dword v4, v5, s[72:75], 0 offen sc1
    s_waitcnt vmcnt(0)
    s_cmp_eq_u32 s95, 1
    s_cbranch_scc0 mega_kernel_sysf
    v_readlane_b32 s76, v4, 14
    s_mov_b32 s98, 0
    s_cmp_eq_u32 s76, 64
    s_cbranch_scc0 mega_kernel_sysw
    s_branch mega_kernel_sysd
    mega_kernel_sysf:
    s_mov_b32 s77, 0
    s_mov_b32 s78, 0
    v_readlane_b32 s76, v4, 0
    s_add_u32 s77, s77, s76
    s_xor_b32 s76, s76, 32
    s_or_b32 s78, s78, s76
    v_readlane_b32 s76, v4, 1
    s_add_u32 s77, s77, s76
    s_xor_b32 s76, s76, 32
    s_or_b32 s78, s78, s76
    v_readlane_b32 s76, v4, 2
    s_add_u32 s77, s77, s76
    s_xor_b32 s76, s76, 32
    s_or_b32 s78, s78, s76
    v_readlane_b32 s76, v4, 3
    s_add_u32 s77, s77, s76
    s_xor_b32 s76, s76, 32
    s_or_b32 s78, s78, s76
    v_readlane_b32 s76, v4, 4
    s_add_u32 s77, s77, s76
    s_xor_b32 s76, s76, 32
    s_or_b32 s78, s78, s76
    v_readlane_b32 s76, v4, 5
    s_add_u32 s77, s77, s76
    s_xor_b32 s76, s76, 32
    s_or_b32 s78, s78, s76
    v_readlane_b32 s76, v4, 6
    s_add_u32 s77, s77, s76
    s_xor_b32 s76, s76, 32
    s_or_b32 s78, s78, s76
    v_readlane_b32 s76, v4, 7
    s_add_u32 s77, s77, s76
    s_xor_b32 s76, s76, 32
    s_or_b32 s78, s78, s76
    s_cmp_eq_u32 s77, 256
    s_cbranch_scc0 mega_kernel_sysw
    v_mov_b32 v252, v4
    s_cmp_eq_u32 s78, 0
    s_cbranch_scc0 mega_kernel_slowent
    v_readlane_b32 s76, v4, 10
    v_readlane_b32 s77, v4, 8
    s_cmp_eq_u32 s76, 64
    s_cbranch_scc0 mega_kernel_sysw
    s_cmp_gt_u32 s77, 32
    s_cselect_b32 s98, 1, 0
    mega_kernel_sysd:
    s_lshr_b32 s28, s31, 3
    s_lshl_b32 s28, s28, 14
    s_lshl_b32 s29, s98, 13
    s_add_u32 s28, s28, s29
    s_and_b32 s29, s31, 7
    s_lshl_b32 s29, s29, 10
    s_add_u32 s28, s28, s29
    s_lshl_b32 s29, s30, 16
    s_add_u32 s28, s28, s29
    s_add_u32 s28, s28, 67108864
    v_add_u32 v12, s28, v17
    v_xor_b32 v25, 0x10000, v12
    v_xor_b32 v26, 0x20000, v12
    v_xor_b32 v27, 0x30000, v12
    s_lshl_b32 s28, s25, 2
    s_add_u32 s28, s28, s26
    s_mov_b32 s82, s28
    s_lshr_b32 s29, s28, 3
    s_xor_b32 s29, s29, s98
    s_and_b32 s29, s29, 1
    s_lshl_b32 s29, s29, 13
    s_lshl_b32 s76, s28, 18
    s_add_u32 s76, s76, s29
    s_mov_b32 s83, s76
    v_add_u32 v240, s76, v17
    v_add_u32 v241, 33554432, v240
    s_lshr_b32 s29, s28, 4
    s_xor_b32 s29, s29, s98
    s_and_b32 s29, s29, 1
    s_lshl_b32 s29, s29, 13
    s_lshl_b32 s79, s28, 17
    s_add_u32 s79, s79, s29
    s_add_u32 s79, s79, 71303168
    s_xor_b32 s29, s98, 1
    s_lshl_b32 s29, s29, 13
    s_lshl_b32 s28, s25, 7
    s_add_u32 s28, s28, s29
    s_add_u32 s28, s28, 69206016
    v_and_b32 v4, 1, v1
    v_lshlrev_b32 v24, 12, v4
    v_add_u32 v24, s28, v24
    s_lshl_b32 s29, s26, 2
    v_add_u32 v24, s29, v24
    s_xor_b32 s81, s98, 1
    s_lshl_b32 s81, s81, 13
    s_lshr_b32 s29, s82, 6
    s_lshl_b32 s29, s29, 14
    s_add_u32 s81, s81, s29
    s_and_b32 s29, s82, 63
    s_lshl_b32 s29, s29, 7
    s_add_u32 s81, s81, s29
    s_add_u32 s81, s81, 69222400
    v_mov_b32 v220, 0x3f803f80
    v_mov_b32 v221, 0x3f803f80
    v_mov_b32 v222, 0x3f803f80
    v_mov_b32 v223, 0x3f803f80
    v_mov_b32 v228, 0
    s_mov_b32 s27, 0
    s_mov_b32 s46, 0
    s_mov_b32 s44, 18432
    s_mov_b32 s45, 18432
    s_cmp_eq_u32 s24, 3
    s_cbranch_scc0 mega_kernel_rs_pfi
    s_mov_b32 s76, 0
    s_cmp_gt_i32 s46, s76
    s_cbranch_scc1 mega_kernel_rs_pf0ok
    mega_kernel_rs_pf0w:
    buffer_load_dword v4, v24, s[84:87], 0 offen sc1
    s_waitcnt vmcnt(0)
    v_readlane_b32 s46, v4, 0
    v_readlane_b32 s28, v4, 1
    s_nop 1
    s_min_i32 s46, s46, s28
    s_cmp_gt_i32 s46, s76
    s_cbranch_scc0 mega_kernel_rs_pf0w
    mega_kernel_rs_pf0ok:
    s_add_u32 s77, s76, s82
    s_bfe_u32 s28, s77, 0x40002
    s_lshl_b32 s28, s28, 14
    s_and_b32 s77, s77, 3
    s_lshl_b32 s77, s77, 11
    s_add_u32 s28, s28, s77
    s_add_u32 m0, s45, 0
    s_nop 0
    buffer_load_dwordx4 v240, s[84:87], s28 offen offset:0 sc1 lds
    s_add_u32 m0, s45, 0
    s_nop 0
    buffer_load_dwordx4 v240, s[84:87], s28 offen offset:1024 sc1 lds
    s_add_u32 m0, s45, 2048
    s_nop 0
    buffer_load_dwordx4 v241, s[84:87], s28 offen offset:0 sc1 lds
    s_add_u32 m0, s45, 2048
    s_nop 0
    buffer_load_dwordx4 v241, s[84:87], s28 offen offset:1024 sc1 lds
    s_add_u32 s45, s45, 4096
    s_cmp_eq_u32 s45, 30720
    s_cselect_b32 s45, 18432, s45
    s_waitcnt vmcnt(0) lgkmcnt(0)
mega_kernel_rs_pfi:
    v_mov_b32 v96, 0
    v_mov_b32 v97, 0
    v_mov_b32 v98, 0
    v_mov_b32 v99, 0
    v_mov_b32 v100, 0
    v_mov_b32 v101, 0
    v_mov_b32 v102, 0
    v_mov_b32 v103, 0
    v_mov_b32 v104, 0
    v_mov_b32 v105, 0
    v_mov_b32 v106, 0
    v_mov_b32 v107, 0
    v_mov_b32 v108, 0
    v_mov_b32 v109, 0
    v_mov_b32 v110, 0
    v_mov_b32 v111, 0
    v_mov_b32 v112, 0
    v_mov_b32 v113, 0
    v_mov_b32 v114, 0
    v_mov_b32 v115, 0
    v_mov_b32 v116, 0
    v_mov_b32 v117, 0
    v_mov_b32 v118, 0
    v_mov_b32 v119, 0
    s_barrier
    s_and_b32 s29, s27, 1
    s_lshl_b32 s33, s29, 17
    s_lshl_b32 s28, s30, 18
    s_add_u32 s33, s33, s28
    s_add_u32 s33, s33, 68157440
    s_xor_b32 s34, s33, 131072
    s_lshl_b32 s35, s29, 18
    s_bfe_u32 s47, s27, 0x10001
    s_branch mega_kernel_rs_first
mega_kernel_rs_loop:
    buffer_load_dwordx4 v[32:35], v7, s[84:87], s33 offen offset:0 sc1
    v_add_u32 v5, s44, v17
    ds_read_b128 v[156:159], v5 offset:0
    ds_read_b128 v[160:163], v5 offset:1024
    ds_read_b128 v[164:167], v5 offset:2048
    ds_read_b128 v[168:171], v5 offset:3072
    s_nop 4
    buffer_load_dwordx4 v[36:39], v7, s[84:87], s33 offen offset:1024 sc1
    s_nop 9
    buffer_load_dwordx4 v[40:43], v7, s[84:87], s33 offen offset:2048 sc1
    s_nop 9
    buffer_load_dwordx4 v[44:47], v7, s[84:87], s33 offen offset:3072 sc1
mega_kernel_rs_pa0:
    s_waitcnt vmcnt(3)
    v_max_u32 v4, v32, v34
    v_cmp_eq_u32 vcc, -1, v4
    s_cbranch_vccnz mega_kernel_rs_par0
mega_kernel_rs_pak0:
    v_smfmac_f32_16x16x64_bf16 v[96:99], v[32:35], a[0:7], v6
    v_smfmac_f32_16x16x64_bf16 v[100:103], v[32:35], a[32:39], v6
    v_smfmac_f32_16x16x64_bf16 v[104:107], v[32:35], a[64:71], v6
    v_smfmac_f32_16x16x64_bf16 v[108:111], v[32:35], a[96:103], v6
mega_kernel_rs_pa1:
    s_waitcnt vmcnt(2)
    v_max_u32 v4, v36, v38
    v_cmp_eq_u32 vcc, -1, v4
    s_cbranch_vccnz mega_kernel_rs_par1
mega_kernel_rs_pak1:
    v_smfmac_f32_16x16x64_bf16 v[96:99], v[36:39], a[8:15], v6
    v_smfmac_f32_16x16x64_bf16 v[100:103], v[36:39], a[40:47], v6
    v_smfmac_f32_16x16x64_bf16 v[104:107], v[36:39], a[72:79], v6
    v_smfmac_f32_16x16x64_bf16 v[108:111], v[36:39], a[104:111], v6
mega_kernel_rs_pa2:
    s_waitcnt vmcnt(1)
    v_max_u32 v4, v40, v42
    v_cmp_eq_u32 vcc, -1, v4
    s_cbranch_vccnz mega_kernel_rs_par2
mega_kernel_rs_pak2:
    v_smfmac_f32_16x16x64_bf16 v[96:99], v[40:43], a[16:23], v6
    v_smfmac_f32_16x16x64_bf16 v[100:103], v[40:43], a[48:55], v6
    v_smfmac_f32_16x16x64_bf16 v[104:107], v[40:43], a[80:87], v6
    v_smfmac_f32_16x16x64_bf16 v[108:111], v[40:43], a[112:119], v6
mega_kernel_rs_pa3:
    s_waitcnt vmcnt(0)
    v_max_u32 v4, v44, v46
    v_cmp_eq_u32 vcc, -1, v4
    s_cbranch_vccnz mega_kernel_rs_par3
mega_kernel_rs_pak3:
    v_smfmac_f32_16x16x64_bf16 v[96:99], v[44:47], a[24:31], v6
    v_smfmac_f32_16x16x64_bf16 v[100:103], v[44:47], a[56:63], v6
    v_smfmac_f32_16x16x64_bf16 v[104:107], v[44:47], a[88:95], v6
    v_smfmac_f32_16x16x64_bf16 v[108:111], v[44:47], a[120:127], v6
mega_kernel_rs_adone:
    s_nop 5
    v_permlane32_swap_b32 v96, v100
    v_permlane32_swap_b32 v97, v101
    v_permlane32_swap_b32 v98, v102
    v_permlane32_swap_b32 v99, v103
    v_pk_add_f32 v[96:97], v[96:97], v[100:101]
    v_pk_add_f32 v[98:99], v[98:99], v[102:103]
    ds_write2_b32 v14, v96, v97 offset0:0 offset1:36
    ds_write2_b32 v14, v98, v99 offset0:72 offset1:108
    v_permlane32_swap_b32 v104, v108
    v_permlane32_swap_b32 v105, v109
    v_permlane32_swap_b32 v106, v110
    v_permlane32_swap_b32 v107, v111
    v_pk_add_f32 v[104:105], v[104:105], v[108:109]
    v_pk_add_f32 v[106:107], v[106:107], v[110:111]
    ds_write2_b32 v15, v104, v105 offset0:0 offset1:36
    ds_write2_b32 v15, v106, v107 offset0:72 offset1:108
    v_smfmac_f32_16x16x64_bf16 v[112:115], v[32:35], a[128:135], v6
    v_smfmac_f32_16x16x64_bf16 v[116:119], v[32:35], a[160:167], v6
    v_smfmac_f32_16x16x64_bf16 v[112:115], v[36:39], a[136:143], v6
    v_smfmac_f32_16x16x64_bf16 v[116:119], v[36:39], a[168:175], v6
    s_waitcnt lgkmcnt(0)
    s_barrier
    s_cmp_lg_u32 s24, 0
    s_cbranch_scc1 mega_kernel_rs_side
    ds_read_b128 v[120:123], v16 offset:0
    ds_read_b128 v[124:127], v16 offset:16
    ds_read_b128 v[128:131], v16 offset:2304
    ds_read_b128 v[132:135], v16 offset:2320
    ds_read_b128 v[136:139], v16 offset:4608
    ds_read_b128 v[140:143], v16 offset:4624
    ds_read_b128 v[144:147], v16 offset:6912
    ds_read_b128 v[148:151], v16 offset:6928
    v_smfmac_f32_16x16x64_bf16 v[112:115], v[40:43], a[144:151], v6
    v_smfmac_f32_16x16x64_bf16 v[116:119], v[40:43], a[176:183], v6
    v_smfmac_f32_16x16x64_bf16 v[112:115], v[44:47], a[152:159], v6
    v_smfmac_f32_16x16x64_bf16 v[116:119], v[44:47], a[184:191], v6
    s_lshl_b32 s28, s31, 11
    s_add_u32 s28, s28, s33
    s_add_u32 s28, s28, 32768
    s_add_u32 s76, s37, s33
    s_add_u32 s77, s38, s33
    s_add_u32 s78, s39, s33
    s_waitcnt lgkmcnt(4)
    v_pk_add_f32 v[120:121], v[120:121], v[128:129]
    v_pk_add_f32 v[122:123], v[122:123], v[130:131]
    v_pk_add_f32 v[124:125], v[124:125], v[132:133]
    v_pk_add_f32 v[126:127], v[126:127], v[134:135]
    s_waitcnt lgkmcnt(0)
    v_pk_add_f32 v[136:137], v[136:137], v[144:145]
    v_pk_add_f32 v[138:139], v[138:139], v[146:147]
    v_pk_add_f32 v[140:141], v[140:141], v[148:149]
    v_pk_add_f32 v[142:143], v[142:143], v[150:151]
    v_pk_add_f32 v[120:121], v[120:121], v[136:137]
    v_pk_add_f32 v[122:123], v[122:123], v[138:139]
    v_pk_add_f32 v[124:125], v[124:125], v[140:141]
    v_pk_add_f32 v[126:127], v[126:127], v[142:143]
    v_cvt_pk_bf16_f32 v152, v120, v121
    v_cvt_pk_bf16_f32 v153, v122, v123
    v_cvt_pk_bf16_f32 v154, v124, v125
    v_cvt_pk_bf16_f32 v155, v126, v127
    s_nop 1
    v_mfma_f32_16x16x32_bf16 v[176:179], v[160:163], v[152:155], 0
    v_mfma_f32_16x16x32_bf16 v[172:175], v[156:159], v[152:155], 0
    v_mfma_f32_16x16x32_bf16 v[180:183], v[152:155], v[152:155], 0
    s_cmp_eq_u32 s27, 63
    s_cbranch_scc1 mega_kernel_rs_w0last
    s_nop 4
    v_mov_b32_dpp v172, v176 row_shr:8 row_mask:0xf bank_mask:0xc
    v_mov_b32_dpp v173, v177 row_shr:8 row_mask:0xf bank_mask:0xc
    v_mov_b32_dpp v174, v178 row_shr:8 row_mask:0xf bank_mask:0xc
    v_mov_b32_dpp v175, v179 row_shr:8 row_mask:0xf bank_mask:0xc
    v_min_u32 v180, -2, v180
    v_min_u32 v172, -2, v172
    s_mov_b64 exec, s[42:43]
    buffer_store_dwordx4 v[180:183], v10, s[84:87], s28 offen sc1
    s_mov_b64 exec, -1
    buffer_store_dwordx4 v[172:175], v17, s[84:87], s28 offen sc1
    v_permlane32_swap_b32 v112, v116
    v_permlane32_swap_b32 v113, v117
    v_permlane32_swap_b32 v114, v118
    v_permlane32_swap_b32 v115, v119
    v_pk_add_f32 v[112:113], v[112:113], v[116:117]
    v_pk_add_f32 v[114:115], v[114:115], v[118:119]
    ds_write_b128 v20, v[112:115]
    buffer_load_dwordx4 v[184:187], v17, s[84:87], s76 offen sc1
    buffer_load_dwordx4 v[188:191], v10, s[84:87], s76 offen sc1
    buffer_load_dwordx4 v[192:195], v17, s[84:87], s77 offen sc1
    buffer_load_dwordx4 v[196:199], v10, s[84:87], s77 offen sc1
    buffer_load_dwordx4 v[200:203], v17, s[84:87], s78 offen sc1
    buffer_load_dwordx4 v[204:207], v10, s[84:87], s78 offen sc1
    v_mov_b32 v96, 0
    v_mov_b32 v97, 0
    v_mov_b32 v98, 0
    v_mov_b32 v99, 0
    v_mov_b32 v100, 0
    v_mov_b32 v101, 0
    v_mov_b32 v102, 0
    v_mov_b32 v103, 0
    s_waitcnt lgkmcnt(0)
    s_barrier
    s_nop 7
    buffer_load_dwordx4 v[184:187], v17, s[84:87], s76 offen sc1
    buffer_load_dwordx4 v[188:191], v10, s[84:87], s76 offen sc1
    buffer_load_dwordx4 v[192:195], v17, s[84:87], s77 offen sc1
    buffer_load_dwordx4 v[196:199], v10, s[84:87], s77 offen sc1
    buffer_load_dwordx4 v[200:203], v17, s[84:87], s78 offen sc1
    buffer_load_dwordx4 v[204:207], v10, s[84:87], s78 offen sc1
mega_kernel_rs_p2:
    s_waitcnt vmcnt(6)
    v_max3_u32 v4, v184, v188, v192
    v_max3_u32 v5, v196, v200, v204
    v_max_u32 v4, v4, v5
    v_cmp_eq_u32 vcc, -1, v4
    s_cbranch_vccnz mega_kernel_rs_p2r
    v_pk_add_f32 v[180:181], v[180:181], v[188:189]
    v_pk_add_f32 v[124:125], v[196:197], v[204:205]
    v_pk_add_f32 v[182:183], v[182:183], v[190:191]
    v_pk_add_f32 v[126:127], v[198:199], v[206:207]
    v_pk_add_f32 v[172:173], v[172:173], v[184:185]
    v_pk_add_f32 v[120:121], v[192:193], v[200:201]
    v_pk_add_f32 v[174:175], v[174:175], v[186:187]
    v_pk_add_f32 v[122:123], v[194:195], v[202:203]
    v_pk_add_f32 v[180:181], v[180:181], v[124:125]
    v_pk_add_f32 v[182:183], v[182:183], v[126:127]
    v_pk_add_f32 v[172:173], v[172:173], v[120:121]
    v_pk_add_f32 v[174:175], v[174:175], v[122:123]
    v_cndmask_b32 v176, v23, v180, s[42:43]
    v_cndmask_b32 v177, v23, v181, s[42:43]
    v_cndmask_b32 v178, v23, v182, s[42:43]
    v_cndmask_b32 v179, v23, v183, s[42:43]
    v_max3_f32 v232, v172, v173, v174
    v_max3_f32 v233, v176, v177, v178
    v_max3_f32 v232, v232, v175, v179
    v_max_f32 v234, v232, v233
    s_barrier
    ds_read2_b64 v[208:211], v21 offset0:0 offset1:32
    v_max_f32_dpp v232, v234, v234 row_ror:8 row_mask:0xf bank_mask:0xf
    v_max_f32_dpp v233, v234, v234 row_ror:8 row_mask:0xf bank_mask:0xf
    s_nop 1
    v_permlane16_swap_b32 v232, v233
    s_nop 0
    v_max_f32 v234, v232, v233
    v_max_f32 v235, v232, v233
    s_nop 1
    v_permlane32_swap_b32 v234, v235
    s_nop 0
    v_max_f32 v232, v234, v235
    v_mul_f32 v232, s32, v232
    v_fma_f32 v176, v176, s32, -v232
    v_fma_f32 v177, v177, s32, -v232
    v_fma_f32 v178, v178, s32, -v232
    v_fma_f32 v179, v179, s32, -v232
    v_fma_f32 v172, v172, s32, -v232
    v_fma_f32 v173, v173, s32, -v232
    v_fma_f32 v174, v174, s32, -v232
    v_fma_f32 v175, v175, s32, -v232
    v_exp_f32 v176, v176
    v_exp_f32 v177, v177
    v_exp_f32 v178, v178
    v_exp_f32 v179, v179
    v_exp_f32 v172, v172
    v_cvt_pk_bf16_f32 v216, v176, v177
    v_cvt_pk_bf16_f32 v217, v178, v179
    v_exp_f32 v173, v173
    v_exp_f32 v174, v174
    v_mfma_f32_16x16x16_bf16 v[224:227], v[220:221], v[216:217], 0
    v_exp_f32 v175, v175
    v_cvt_pk_bf16_f32 v212, v172, v173
    s_waitcnt lgkmcnt(0)
    v_mfma_f32_16x16x16_bf16 v[120:123], v[208:209], v[216:217], 0
    v_cvt_pk_bf16_f32 v213, v174, v175
    v_mfma_f32_16x16x16_bf16 v[124:127], v[210:211], v[216:217], 0
    v_mov_b32_dpp v214, v212 row_ror:8 row_mask:0xf bank_mask:0xf
    v_mov_b32_dpp v215, v213 row_ror:8 row_mask:0xf bank_mask:0xf
    s_nop 1
    v_mfma_f32_16x16x32_bf16 v[224:227], v[220:223], v[212:215], v[224:227]
    v_mfma_f32_16x16x32_bf16 v[120:123], v[164:167], v[212:215], v[120:123]
    v_mfma_f32_16x16x32_bf16 v[124:127], v[168:171], v[212:215], v[124:127]
    s_add_u32 s29, s33, 16384
    s_nop 4
    v_rcp_f32 v234, v224
    v_rcp_f32 v235, v225
    s_nop 0
    v_pk_mul_f32 v[120:121], v[120:121], v[234:235]
    v_pk_mul_f32 v[122:123], v[122:123], v[234:235]
    v_pk_mul_f32 v[124:125], v[124:125], v[234:235]
    v_pk_mul_f32 v[126:127], v[126:127], v[234:235]
    v_cvt_pk_bf16_f32 v212, v120, v121
    v_cvt_pk_bf16_f32 v213, v122, v123
    v_cvt_pk_bf16_f32 v214, v124, v125
    v_cvt_pk_bf16_f32 v215, v126, v127
    v_min_u32 v212, -2, v212
    s_mov_b64 exec, s[40:41]
    buffer_store_dwordx4 v[212:215], v11, s[84:87], s33 offen sc1
    s_mov_b64 exec, -1
mega_kernel_rs_b3:
    s_barrier
    buffer_load_dwordx4 v[32:35], v7, s[84:87], s29 offen offset:0 sc1
    s_nop 9
    buffer_load_dwordx4 v[36:39], v7, s[84:87], s29 offen offset:1024 sc1
    s_nop 9
    buffer_load_dwordx4 v[40:43], v7, s[84:87], s29 offen offset:2048 sc1
    s_nop 9
    buffer_load_dwordx4 v[44:47], v7, s[84:87], s29 offen offset:3072 sc1
mega_kernel_rs_pc0:
    s_waitcnt vmcnt(3)
    v_cmp_eq_u32 vcc, -1, v32
    s_cbranch_vccnz mega_kernel_rs_pcr0
mega_kernel_rs_pck0:
    v_smfmac_f32_16x16x64_bf16 v[96:99], v[32:35], a[192:199], v6
    v_smfmac_f32_16x16x64_bf16 v[100:103], v[32:35], a[224:231], v6
mega_kernel_rs_pc1:
    s_waitcnt vmcnt(2)
    v_cmp_eq_u32 vcc, -1, v36
    s_cbranch_vccnz mega_kernel_rs_pcr1
mega_kernel_rs_pck1:
    v_smfmac_f32_16x16x64_bf16 v[96:99], v[36:39], a[200:207], v6
    v_smfmac_f32_16x16x64_bf16 v[100:103], v[36:39], a[232:239], v6
mega_kernel_rs_pc2:
    s_waitcnt vmcnt(1)
    v_cmp_eq_u32 vcc, -1, v40
    s_cbranch_vccnz mega_kernel_rs_pcr2
mega_kernel_rs_pck2:
    v_smfmac_f32_16x16x64_bf16 v[96:99], v[40:43], a[208:215], v6
    v_smfmac_f32_16x16x64_bf16 v[100:103], v[40:43], a[240:247], v6
mega_kernel_rs_pc3:
    s_waitcnt vmcnt(0)
    v_cmp_eq_u32 vcc, -1, v44
    s_cbranch_vccnz mega_kernel_rs_pcr3
mega_kernel_rs_pck3:
    v_smfmac_f32_16x16x64_bf16 v[96:99], v[44:47], a[216:223], v6
    v_smfmac_f32_16x16x64_bf16 v[100:103], v[44:47], a[248:255], v6
    s_nop 7
    v_permlane32_swap_b32 v96, v100
    v_permlane32_swap_b32 v97, v101
    v_permlane32_swap_b32 v98, v102
    v_permlane32_swap_b32 v99, v103
    v_pk_add_f32 v[96:97], v[96:97], v[100:101]
    v_pk_add_f32 v[98:99], v[98:99], v[102:103]
    ds_write2_b32 v18, v96, v97 offset0:0 offset1:36
    ds_write2_b32 v18, v98, v99 offset0:72 offset1:108
    s_waitcnt lgkmcnt(0)
    s_barrier
    s_cmp_lg_u32 s24, 0
    s_cbranch_scc1 mega_kernel_rs_x1
    ds_read_b128 v[120:123], v19 offset:0
    ds_read_b128 v[124:127], v19 offset:1152
    ds_read_b128 v[128:131], v19 offset:2304
    ds_read_b128 v[132:135], v19 offset:3456
    v_mov_b32 v96, 0
    v_mov_b32 v97, 0
    v_mov_b32 v98, 0
    v_mov_b32 v99, 0
    v_mov_b32 v100, 0
    v_mov_b32 v101, 0
    v_mov_b32 v102, 0
    v_mov_b32 v103, 0
    v_mov_b32 v104, 0
    v_mov_b32 v105, 0
    v_mov_b32 v106, 0
    v_mov_b32 v107, 0
    v_mov_b32 v108, 0
    v_mov_b32 v109, 0
    v_mov_b32 v110, 0
    v_mov_b32 v111, 0
    v_mov_b32 v112, 0
    v_mov_b32 v113, 0
    v_mov_b32 v114, 0
    v_mov_b32 v115, 0
    v_mov_b32 v116, 0
    v_mov_b32 v117, 0
    v_mov_b32 v118, 0
    v_mov_b32 v119, 0
    s_waitcnt lgkmcnt(2)
    v_pk_add_f32 v[120:121], v[120:121], v[124:125]
    v_pk_add_f32 v[122:123], v[122:123], v[126:127]
    s_waitcnt lgkmcnt(0)
    v_pk_add_f32 v[128:129], v[128:129], v[132:133]
    v_pk_add_f32 v[130:131], v[130:131], v[134:135]
    v_pk_add_f32 v[120:121], v[120:121], v[128:129]
    v_pk_add_f32 v[122:123], v[122:123], v[130:131]
    v_and_or_b32 v120, v120, -2, s47
    v_and_or_b32 v121, v121, -2, s47
    v_and_or_b32 v122, v122, -2, s47
    v_and_or_b32 v123, v123, -2, s47
    buffer_store_dwordx4 v[120:123], v12, s[84:87], s35 offen sc1
    s_xor_b32 s76, s47, 1
    v_mov_b32 v48, s76
    v_mov_b32 v49, s76
    v_mov_b32 v50, s76
    v_mov_b32 v51, s76
    v_mov_b32 v52, s76
    v_mov_b32 v53, s76
    v_mov_b32 v54, s76
    v_mov_b32 v55, s76
    v_mov_b32 v56, s76
    v_mov_b32 v57, s76
    v_mov_b32 v58, s76
    v_mov_b32 v59, s76
    s_nop 15
    s_nop 15
    s_nop 7
    s_cmp_eq_u32 s47, 1
    s_cbranch_scc1 mega_kernel_rs_p4_1
mega_kernel_rs_p4_0:
    buffer_load_dwordx4 v[48:51], v25, s[84:87], s35 offen sc1
    buffer_load_dwordx4 v[52:55], v26, s[84:87], s35 offen sc1
    buffer_load_dwordx4 v[56:59], v27, s[84:87], s35 offen sc1
    s_waitcnt vmcnt(36)
    s_nop 1
    v_bitop3_b32 v4, v48, v49, v50 bitop3:0xfe
    v_bitop3_b32 v5, v54, v55, v56 bitop3:0xfe
    v_bitop3_b32 v4, v4, v51, v52 bitop3:0xfe
    v_bitop3_b32 v5, v5, v57, v58 bitop3:0xfe
    v_bitop3_b32 v4, v4, v53, v59 bitop3:0xfe
    v_bitop3_b32 v4, v4, v5, 1 bitop3:0xa8
    v_cmp_ne_u32 vcc, 0, v4
    s_cbranch_vccnz mega_kernel_rs_p4_0
    s_branch mega_kernel_rs_p4d
mega_kernel_rs_p4_1:
    buffer_load_dwordx4 v[48:51], v25, s[84:87], s35 offen sc1
    buffer_load_dwordx4 v[52:55], v26, s[84:87], s35 offen sc1
    buffer_load_dwordx4 v[56:59], v27, s[84:87], s35 offen sc1
    s_waitcnt vmcnt(36)
    s_nop 1
    v_bitop3_b32 v4, v48, v49, v50 bitop3:0x80
    v_bitop3_b32 v5, v54, v55, v56 bitop3:0x80
    v_bitop3_b32 v4, v4, v51, v52 bitop3:0x80
    v_bitop3_b32 v5, v5, v57, v58 bitop3:0x80
    v_bitop3_b32 v4, v4, v53, v59 bitop3:0x80
    v_bitop3_b32 v4, v4, v5, 1 bitop3:0x80
    v_cmp_ne_u32 vcc, 1, v4
    s_cbranch_vccnz mega_kernel_rs_p4_1
mega_kernel_rs_p4d:
    v_pk_add_f32 v[120:121], v[120:121], v[48:49]
    v_pk_add_f32 v[124:125], v[52:53], v[56:57]
    v_pk_add_f32 v[122:123], v[122:123], v[50:51]
    v_pk_add_f32 v[126:127], v[54:55], v[58:59]
    v_pk_add_f32 v[120:121], v[120:121], v[124:125]
    v_pk_add_f32 v[122:123], v[122:123], v[126:127]
    v_cvt_pk_bf16_f32 v212, v120, v121
    v_cvt_pk_bf16_f32 v213, v122, v123
    v_min_u32 v212, -2, v212
    buffer_store_dwordx2 v[212:213], v9, s[84:87], s34 offen sc1
mega_kernel_rs_b5:
    s_add_u32 s27, s27, 1
    s_add_u32 s44, s44, 4096
    s_cmp_eq_u32 s44, 30720
    s_cselect_b32 s44, 18432, s44
    s_barrier
    s_and_b32 s29, s27, 1
    s_lshl_b32 s33, s29, 17
    s_lshl_b32 s28, s30, 18
    s_add_u32 s33, s33, s28
    s_add_u32 s33, s33, 68157440
    s_xor_b32 s34, s33, 131072
    s_lshl_b32 s35, s29, 18
    s_bfe_u32 s47, s27, 0x10001
    s_branch mega_kernel_rs_loop
mega_kernel_rs_x1:
    s_cmp_eq_u32 s24, 3
    s_cbranch_scc0 mega_kernel_rs_x4
    buffer_store_dwordx2 v[28:29], v9, s[84:87], s33 offen sc1
    s_lshl_b32 s28, s31, 11
    s_add_u32 s28, s28, s33
    s_add_u32 s28, s28, 32768
    buffer_store_dwordx4 v[28:31], v17, s[84:87], s28 offen sc1
    buffer_store_dwordx4 v[28:31], v10, s[84:87], s28 offen sc1
    s_add_u32 s76, s27, 2
    s_cmp_lt_u32 s76, 63
    s_cbranch_scc0 mega_kernel_rs_x4
    s_cmp_gt_i32 s46, s76
    s_cbranch_scc0 mega_kernel_rs_x4
    s_add_u32 s77, s76, s82
    s_bfe_u32 s28, s77, 0x40002
    s_lshl_b32 s28, s28, 14
    s_and_b32 s77, s77, 3
    s_lshl_b32 s77, s77, 11
    s_add_u32 s28, s28, s77
    s_add_u32 s28, s28, s83
    s_add_u32 s28, s28, 33554432
    s_buffer_load_dword s78, s[84:87], s28 offset:0
    s_buffer_load_dword s78, s[84:87], s28 offset:128
    s_buffer_load_dword s78, s[84:87], s28 offset:256
    s_buffer_load_dword s78, s[84:87], s28 offset:384
    s_buffer_load_dword s78, s[84:87], s28 offset:512
    s_buffer_load_dword s78, s[84:87], s28 offset:640
    s_buffer_load_dword s78, s[84:87], s28 offset:768
    s_buffer_load_dword s78, s[84:87], s28 offset:896
    s_buffer_load_dword s78, s[84:87], s28 offset:1024
    s_buffer_load_dword s78, s[84:87], s28 offset:1152
    s_buffer_load_dword s78, s[84:87], s28 offset:1280
    s_buffer_load_dword s78, s[84:87], s28 offset:1408
    s_buffer_load_dword s78, s[84:87], s28 offset:1536
    s_buffer_load_dword s78, s[84:87], s28 offset:1664
    s_buffer_load_dword s78, s[84:87], s28 offset:1792
    s_buffer_load_dword s78, s[84:87], s28 offset:1920
mega_kernel_rs_x4:
    v_mov_b32 v96, 0
    v_mov_b32 v97, 0
    v_mov_b32 v98, 0
    v_mov_b32 v99, 0
    v_mov_b32 v100, 0
    v_mov_b32 v101, 0
    v_mov_b32 v102, 0
    v_mov_b32 v103, 0
    v_mov_b32 v104, 0
    v_mov_b32 v105, 0
    v_mov_b32 v106, 0
    v_mov_b32 v107, 0
    v_mov_b32 v108, 0
    v_mov_b32 v109, 0
    v_mov_b32 v110, 0
    v_mov_b32 v111, 0
    v_mov_b32 v112, 0
    v_mov_b32 v113, 0
    v_mov_b32 v114, 0
    v_mov_b32 v115, 0
    v_mov_b32 v116, 0
    v_mov_b32 v117, 0
    v_mov_b32 v118, 0
    v_mov_b32 v119, 0
    s_branch mega_kernel_rs_b5
mega_kernel_rs_p2r:
    buffer_load_dwordx4 v[184:187], v17, s[84:87], s76 offen sc1
    buffer_load_dwordx4 v[188:191], v10, s[84:87], s76 offen sc1
    buffer_load_dwordx4 v[192:195], v17, s[84:87], s77 offen sc1
    buffer_load_dwordx4 v[196:199], v10, s[84:87], s77 offen sc1
    buffer_load_dwordx4 v[200:203], v17, s[84:87], s78 offen sc1
    buffer_load_dwordx4 v[204:207], v10, s[84:87], s78 offen sc1
    s_branch mega_kernel_rs_p2
mega_kernel_rs_par0:
    buffer_load_dwordx4 v[32:35], v7, s[84:87], s33 offen offset:0 sc1
    buffer_load_dwordx4 v[36:39], v7, s[84:87], s33 offen offset:1024 sc1
    buffer_load_dwordx4 v[40:43], v7, s[84:87], s33 offen offset:2048 sc1
    buffer_load_dwordx4 v[44:47], v7, s[84:87], s33 offen offset:3072 sc1
    s_branch mega_kernel_rs_pa0
mega_kernel_rs_par1:
    buffer_load_dwordx4 v[36:39], v7, s[84:87], s33 offen offset:1024 sc1
    buffer_load_dwordx4 v[40:43], v7, s[84:87], s33 offen offset:2048 sc1
    buffer_load_dwordx4 v[44:47], v7, s[84:87], s33 offen offset:3072 sc1
    s_branch mega_kernel_rs_pa1
mega_kernel_rs_par2:
    buffer_load_dwordx4 v[40:43], v7, s[84:87], s33 offen offset:2048 sc1
    buffer_load_dwordx4 v[44:47], v7, s[84:87], s33 offen offset:3072 sc1
    s_branch mega_kernel_rs_pa2
mega_kernel_rs_par3:
    buffer_load_dwordx4 v[44:47], v7, s[84:87], s33 offen offset:3072 sc1
    s_branch mega_kernel_rs_pa3
mega_kernel_rs_pcr0:
    buffer_load_dwordx4 v[32:35], v7, s[84:87], s29 offen offset:0 sc1
    buffer_load_dwordx4 v[36:39], v7, s[84:87], s29 offen offset:1024 sc1
    buffer_load_dwordx4 v[40:43], v7, s[84:87], s29 offen offset:2048 sc1
    buffer_load_dwordx4 v[44:47], v7, s[84:87], s29 offen offset:3072 sc1
    s_branch mega_kernel_rs_pc0
mega_kernel_rs_pcr1:
    buffer_load_dwordx4 v[36:39], v7, s[84:87], s29 offen offset:1024 sc1
    buffer_load_dwordx4 v[40:43], v7, s[84:87], s29 offen offset:2048 sc1
    buffer_load_dwordx4 v[44:47], v7, s[84:87], s29 offen offset:3072 sc1
    s_branch mega_kernel_rs_pc1
mega_kernel_rs_pcr2:
    buffer_load_dwordx4 v[40:43], v7, s[84:87], s29 offen offset:2048 sc1
    buffer_load_dwordx4 v[44:47], v7, s[84:87], s29 offen offset:3072 sc1
    s_branch mega_kernel_rs_pc2
mega_kernel_rs_pcr3:
    buffer_load_dwordx4 v[44:47], v7, s[84:87], s29 offen offset:3072 sc1
    s_branch mega_kernel_rs_pc3
mega_kernel_rs_w0last:
    s_nop 7
    v_permlane32_swap_b32 v112, v116
    v_permlane32_swap_b32 v113, v117
    v_permlane32_swap_b32 v114, v118
    v_permlane32_swap_b32 v115, v119
    v_pk_add_f32 v[112:113], v[112:113], v[116:117]
    v_pk_add_f32 v[114:115], v[114:115], v[118:119]
    ds_write_b128 v20, v[112:115]
    s_waitcnt lgkmcnt(0)
    s_barrier
    s_branch mega_kernel_rs_end
mega_kernel_rs_side:
    s_cmp_eq_u32 s24, 3
    s_cbranch_scc1 mega_kernel_rs_sd3
    s_cmp_eq_u32 s24, 2
    s_cbranch_scc0 mega_kernel_rs_sd4
    s_mov_b64 exec, s[40:41]
    buffer_store_dwordx4 v[28:31], v11, s[84:87], s34 offen sc1
    s_mov_b64 exec, -1
    s_branch mega_kernel_rs_sd4
    mega_kernel_rs_sd3:
    s_add_u32 s76, s27, 1
    s_cmp_lt_u32 s76, 63
    s_cbranch_scc0 mega_kernel_rs_sd4
    s_cmp_gt_i32 s46, s76
    s_cbranch_scc1 mega_kernel_rs_pf2ok
    mega_kernel_rs_pf2w:
    buffer_load_dword v4, v24, s[84:87], 0 offen sc1
    s_waitcnt vmcnt(0)
    v_readlane_b32 s46, v4, 0
    v_readlane_b32 s28, v4, 1
    s_nop 1
    s_min_i32 s46, s46, s28
    s_cmp_gt_i32 s46, s76
    s_cbranch_scc0 mega_kernel_rs_pf2w
    mega_kernel_rs_pf2ok:
    s_add_u32 s77, s76, s82
    s_bfe_u32 s28, s77, 0x40002
    s_lshl_b32 s28, s28, 14
    s_and_b32 s77, s77, 3
    s_lshl_b32 s77, s77, 11
    s_add_u32 s28, s28, s77
    s_add_u32 m0, s45, 0
    s_nop 0
    buffer_load_dwordx4 v240, s[84:87], s28 offen offset:0 sc1 lds
    s_add_u32 m0, s45, 0
    s_nop 0
    buffer_load_dwordx4 v240, s[84:87], s28 offen offset:1024 sc1 lds
    s_add_u32 m0, s45, 2048
    s_nop 0
    buffer_load_dwordx4 v241, s[84:87], s28 offen offset:0 sc1 lds
    s_add_u32 m0, s45, 2048
    s_nop 0
    buffer_load_dwordx4 v241, s[84:87], s28 offen offset:1024 sc1 lds
    s_add_u32 s45, s45, 4096
    s_cmp_eq_u32 s45, 30720
    s_cselect_b32 s45, 18432, s45
mega_kernel_rs_sd4:
    v_smfmac_f32_16x16x64_bf16 v[112:115], v[40:43], a[144:151], v6
    v_smfmac_f32_16x16x64_bf16 v[116:119], v[40:43], a[176:183], v6
    v_smfmac_f32_16x16x64_bf16 v[112:115], v[44:47], a[152:159], v6
    v_smfmac_f32_16x16x64_bf16 v[116:119], v[44:47], a[184:191], v6
    s_nop 7
    v_permlane32_swap_b32 v112, v116
    v_permlane32_swap_b32 v113, v117
    v_permlane32_swap_b32 v114, v118
    v_permlane32_swap_b32 v115, v119
    v_pk_add_f32 v[112:113], v[112:113], v[116:117]
    v_pk_add_f32 v[114:115], v[114:115], v[118:119]
    ds_write_b128 v20, v[112:115]
    v_mov_b32 v96, 0
    v_mov_b32 v97, 0
    v_mov_b32 v98, 0
    v_mov_b32 v99, 0
    v_mov_b32 v100, 0
    v_mov_b32 v101, 0
    v_mov_b32 v102, 0
    v_mov_b32 v103, 0
    s_cmp_eq_u32 s24, 1
    s_cbranch_scc0 mega_kernel_rs_s1
    s_waitcnt lgkmcnt(0)
    ds_read_b128 v[120:123], v16 offset:0
    ds_read_b128 v[124:127], v16 offset:16
    ds_read_b128 v[128:131], v16 offset:2304
    ds_read_b128 v[132:135], v16 offset:2320
    ds_read_b128 v[136:139], v16 offset:4608
    ds_read_b128 v[140:143], v16 offset:4624
    ds_read_b128 v[144:147], v16 offset:6912
    ds_read_b128 v[148:151], v16 offset:6928
    s_waitcnt lgkmcnt(4)
    v_pk_add_f32 v[120:121], v[120:121], v[128:129]
    v_pk_add_f32 v[122:123], v[122:123], v[130:131]
    v_pk_add_f32 v[124:125], v[124:125], v[132:133]
    v_pk_add_f32 v[126:127], v[126:127], v[134:135]
    s_waitcnt lgkmcnt(0)
    v_pk_add_f32 v[136:137], v[136:137], v[144:145]
    v_pk_add_f32 v[138:139], v[138:139], v[146:147]
    v_pk_add_f32 v[140:141], v[140:141], v[148:149]
    v_pk_add_f32 v[142:143], v[142:143], v[150:151]
    v_pk_add_f32 v[120:121], v[120:121], v[136:137]
    v_pk_add_f32 v[122:123], v[122:123], v[138:139]
    v_pk_add_f32 v[124:125], v[124:125], v[140:141]
    v_pk_add_f32 v[126:127], v[126:127], v[142:143]
    v_cvt_pk_bf16_f32 v244, v120, v121
    v_cvt_pk_bf16_f32 v245, v122, v123
    v_cvt_pk_bf16_f32 v246, v124, v125
    v_cvt_pk_bf16_f32 v247, v126, v127
mega_kernel_rs_s1:
    v_add_u32 v5, 9216, v17
    s_waitcnt lgkmcnt(0)
    s_barrier
    s_cmp_eq_u32 s24, 2
    s_cbranch_scc0 mega_kernel_rs_s3
    ds_read_b128 v[120:123], v5 offset:0
    ds_read_b128 v[124:127], v5 offset:1024
    ds_read_b128 v[128:131], v5 offset:2048
    ds_read_b128 v[132:135], v5 offset:3072
    v_lshrrev_b32 v5, 1, v17
    s_waitcnt lgkmcnt(2)
    v_pk_add_f32 v[120:121], v[120:121], v[124:125]
    v_pk_add_f32 v[122:123], v[122:123], v[126:127]
    s_waitcnt lgkmcnt(0)
    v_pk_add_f32 v[128:129], v[128:129], v[132:133]
    v_pk_add_f32 v[130:131], v[130:131], v[134:135]
    v_pk_add_f32 v[120:121], v[120:121], v[128:129]
    v_pk_add_f32 v[122:123], v[122:123], v[130:131]
    v_cvt_pk_bf16_f32 v244, v120, v121
    v_cvt_pk_bf16_f32 v245, v122, v123
    ds_write_b64 v5, v[244:245] offset:17920
    s_waitcnt lgkmcnt(0)
mega_kernel_rs_s3:
    s_cmp_eq_u32 s27, 63
    s_cbranch_scc1 mega_kernel_rs_slast
    s_add_u32 s29, s33, 16384
    s_barrier
    s_cmp_eq_u32 s24, 3
    s_cbranch_scc1 mega_kernel_rs_y3
    s_add_u32 s77, s27, s82
    s_bfe_u32 s28, s77, 0x30003
    s_lshl_b32 s28, s28, 14
    s_and_b32 s77, s77, 7
    s_lshl_b32 s77, s77, 10
    s_add_u32 s28, s28, s77
    s_add_u32 s28, s28, s79
    s_cmp_eq_u32 s24, 2
    s_cbranch_scc1 mega_kernel_rs_kv2a
    s_mov_b64 exec, s[48:49]
    buffer_store_dwordx4 v[244:247], v22, s[84:87], s28 offen sc1
    s_mov_b64 exec, -1
    s_branch mega_kernel_rs_kvda
    mega_kernel_rs_kv2a:
    v_lshlrev_b32 v4, 3, v1
    buffer_store_dwordx2 v[244:245], v4, s[84:87], s28 offen offset:512 sc1
    mega_kernel_rs_kvda:
    s_and_b32 s76, s27, 0
    s_cmp_ge_u32 s27, 52
    s_cselect_b32 s76, 0, s76
    s_add_u32 s76, s76, s24
    s_cmp_eq_u32 s76, 1
    s_cbranch_scc0 mega_kernel_rs_y4
    v_mov_b32 v5, s27
    s_mov_b64 exec, 1
    buffer_store_dword v5, v228, s[84:87], s81 offen sc1
    s_mov_b64 exec, -1
    s_branch mega_kernel_rs_y4
mega_kernel_rs_y3:
    s_add_u32 s76, s27, 2
    s_cmp_lt_u32 s76, 63
    s_cbranch_scc0 mega_kernel_rs_y4
    s_cmp_gt_i32 s46, s76
    s_cbranch_scc1 mega_kernel_rs_pf3ok
    mega_kernel_rs_pf3w:
    buffer_load_dword v4, v24, s[84:87], 0 offen sc1
    s_waitcnt vmcnt(0)
    v_readlane_b32 s46, v4, 0
    v_readlane_b32 s28, v4, 1
    s_nop 1
    s_min_i32 s46, s46, s28
    s_cmp_gt_i32 s46, s76
    s_cbranch_scc0 mega_kernel_rs_y4
    mega_kernel_rs_pf3ok:
    s_add_u32 s77, s76, s82
    s_bfe_u32 s28, s77, 0x40002
    s_lshl_b32 s28, s28, 14
    s_and_b32 s77, s77, 3
    s_lshl_b32 s77, s77, 11
    s_add_u32 s28, s28, s77
    s_add_u32 s28, s28, s83
    s_buffer_load_dword s78, s[84:87], s28 offset:0
    s_buffer_load_dword s78, s[84:87], s28 offset:128
    s_buffer_load_dword s78, s[84:87], s28 offset:256
    s_buffer_load_dword s78, s[84:87], s28 offset:384
    s_buffer_load_dword s78, s[84:87], s28 offset:512
    s_buffer_load_dword s78, s[84:87], s28 offset:640
    s_buffer_load_dword s78, s[84:87], s28 offset:768
    s_buffer_load_dword s78, s[84:87], s28 offset:896
    s_buffer_load_dword s78, s[84:87], s28 offset:1024
    s_buffer_load_dword s78, s[84:87], s28 offset:1152
    s_buffer_load_dword s78, s[84:87], s28 offset:1280
    s_buffer_load_dword s78, s[84:87], s28 offset:1408
    s_buffer_load_dword s78, s[84:87], s28 offset:1536
    s_buffer_load_dword s78, s[84:87], s28 offset:1664
    s_buffer_load_dword s78, s[84:87], s28 offset:1792
    s_buffer_load_dword s78, s[84:87], s28 offset:1920
mega_kernel_rs_y4:
    s_branch mega_kernel_rs_b3
mega_kernel_rs_first:
    buffer_load_dwordx4 v[32:35], v8, s[20:23], 0 offen offset:0
    buffer_load_dwordx4 v[36:39], v8, s[20:23], 0 offen offset:128
    buffer_load_dwordx4 v[40:43], v8, s[20:23], 0 offen offset:256
    buffer_load_dwordx4 v[44:47], v8, s[20:23], 0 offen offset:384
    v_add_u32 v5, s44, v17
    ds_read_b128 v[156:159], v5 offset:0
    ds_read_b128 v[160:163], v5 offset:1024
    ds_read_b128 v[164:167], v5 offset:2048
    ds_read_b128 v[168:171], v5 offset:3072
    s_waitcnt vmcnt(0)
    v_smfmac_f32_16x16x64_bf16 v[96:99], v[32:35], a[0:7], v6
    v_smfmac_f32_16x16x64_bf16 v[100:103], v[32:35], a[32:39], v6
    v_smfmac_f32_16x16x64_bf16 v[104:107], v[32:35], a[64:71], v6
    v_smfmac_f32_16x16x64_bf16 v[108:111], v[32:35], a[96:103], v6
    v_smfmac_f32_16x16x64_bf16 v[96:99], v[36:39], a[8:15], v6
    v_smfmac_f32_16x16x64_bf16 v[100:103], v[36:39], a[40:47], v6
    v_smfmac_f32_16x16x64_bf16 v[104:107], v[36:39], a[72:79], v6
    v_smfmac_f32_16x16x64_bf16 v[108:111], v[36:39], a[104:111], v6
    v_smfmac_f32_16x16x64_bf16 v[96:99], v[40:43], a[16:23], v6
    v_smfmac_f32_16x16x64_bf16 v[100:103], v[40:43], a[48:55], v6
    v_smfmac_f32_16x16x64_bf16 v[104:107], v[40:43], a[80:87], v6
    v_smfmac_f32_16x16x64_bf16 v[108:111], v[40:43], a[112:119], v6
    v_smfmac_f32_16x16x64_bf16 v[96:99], v[44:47], a[24:31], v6
    v_smfmac_f32_16x16x64_bf16 v[100:103], v[44:47], a[56:63], v6
    v_smfmac_f32_16x16x64_bf16 v[104:107], v[44:47], a[88:95], v6
    v_smfmac_f32_16x16x64_bf16 v[108:111], v[44:47], a[120:127], v6
    s_nop 1
    s_branch mega_kernel_rs_adone
mega_kernel_rs_slast:
    s_cmp_eq_u32 s24, 3
    s_cbranch_scc1 mega_kernel_rs_end
    s_add_u32 s77, s27, s82
    s_bfe_u32 s28, s77, 0x30003
    s_lshl_b32 s28, s28, 14
    s_and_b32 s77, s77, 7
    s_lshl_b32 s77, s77, 10
    s_add_u32 s28, s28, s77
    s_add_u32 s28, s28, s79
    s_cmp_eq_u32 s24, 2
    s_cbranch_scc1 mega_kernel_rs_kv2b
    s_mov_b64 exec, s[48:49]
    buffer_store_dwordx4 v[244:247], v22, s[84:87], s28 offen sc1
    s_mov_b64 exec, -1
    s_branch mega_kernel_rs_kvdb
    mega_kernel_rs_kv2b:
    v_lshlrev_b32 v4, 3, v1
    buffer_store_dwordx2 v[244:245], v4, s[84:87], s28 offen offset:512 sc1
    mega_kernel_rs_kvdb:
    s_waitcnt vmcnt(0)
    s_barrier
    s_mov_b32 s76, 64
    s_cmp_eq_u32 s24, 1
    s_cbranch_scc0 mega_kernel_rs_end
    v_mov_b32 v5, s76
    s_mov_b64 exec, 1
    buffer_store_dword v5, v228, s[84:87], s81 offen sc1
    s_mov_b64 exec, -1
mega_kernel_rs_end:
    s_endpgm
.section .rodata,"a"
.p2align 6
.amdhsa_kernel mega_kernel
  .amdhsa_next_free_vgpr 512
  .amdhsa_next_free_sgpr 102
  .amdhsa_accum_offset 256
  .amdhsa_group_segment_fixed_size 0
  .amdhsa_kernarg_size 104
  .amdhsa_user_sgpr_count 2
  .amdhsa_user_sgpr_kernarg_segment_ptr 1
  .amdhsa_system_sgpr_workgroup_id_x 1
.end_amdhsa_kernel
```

```asm
; @launch kernel=mega_kernel grid=(256,1,1) block=(256,1,1) lds=163840
.amdgcn_target "amdgcn-amd-amdhsa--gfx950"
.text
.globl mega_kernel
.p2align 8
.type mega_kernel,@function
mega_kernel:
s_cmp_ge_u32 s2, 256
s_cbranch_scc1 mega_kernel_exit
s_load_dwordx2 s[84:85], s[0:1], 96
s_load_dwordx2 s[72:73], s[0:1], 88
s_getreg_b32 s90, hwreg(HW_REG_XCC_ID)
s_and_b32 s90, s90, 7
v_mov_b32 v1, 0
v_mov_b32 v2, 1
s_lshl_b32 s91, s90, 4
s_mov_b32 s95, 0
s_mov_b32 s99, 0
s_waitcnt lgkmcnt(0)
s_mov_b32 s86, 268435456
s_mov_b32 s87, 0x00020000
s_mov_b32 s74, 256
s_mov_b32 s75, 0x00020000
v_cmp_eq_u32 vcc, 0, v0
s_and_saveexec_b64 s[88:89], vcc
s_cbranch_execz mega_kernel_tkd
s_lshl_b32 s92, s2, 13
s_add_u32 s92, s92, 167772160
buffer_atomic_add v2, v1, s[72:75], s91 offen sc0
buffer_load_dword v251, v1, s[84:87], s92 offen offset:2048 sc1
s_waitcnt vmcnt(1)
ds_write_b32 v1, v2
s_waitcnt lgkmcnt(0)
mega_kernel_tkd:
s_mov_b64 exec, s[88:89]
s_barrier
ds_read_b32 v2, v1
s_waitcnt lgkmcnt(0)
v_readfirstlane_b32 s96, v2
s_barrier
s_cmp_lt_u32 s96, 32
s_cbranch_scc1 mega_kernel_spec
v_and_b32 v3, 15, v0
v_lshlrev_b32 v3, 4, v3
s_branch mega_kernel_syx
mega_kernel_syxw:
s_sleep 4
mega_kernel_syx:
buffer_load_dword v2, v3, s[72:75], 0 offen sc1
s_waitcnt vmcnt(0)
s_cmp_eq_u32 s95, 1
s_cbranch_scc0 mega_kernel_syxf
v_readlane_b32 s76, v2, 14
s_mov_b32 s98, 0
s_cmp_eq_u32 s76, 64
s_cbranch_scc0 mega_kernel_syxw
s_branch mega_kernel_syxd
mega_kernel_syxf:
s_mov_b32 s77, 0
s_mov_b32 s78, 0
v_readlane_b32 s76, v2, 0
s_add_u32 s77, s77, s76
s_xor_b32 s76, s76, 32
s_or_b32 s78, s78, s76
v_readlane_b32 s76, v2, 1
s_add_u32 s77, s77, s76
s_xor_b32 s76, s76, 32
s_or_b32 s78, s78, s76
v_readlane_b32 s76, v2, 2
s_add_u32 s77, s77, s76
s_xor_b32 s76, s76, 32
s_or_b32 s78, s78, s76
v_readlane_b32 s76, v2, 3
s_add_u32 s77, s77, s76
s_xor_b32 s76, s76, 32
s_or_b32 s78, s78, s76
v_readlane_b32 s76, v2, 4
s_add_u32 s77, s77, s76
s_xor_b32 s76, s76, 32
s_or_b32 s78, s78, s76
v_readlane_b32 s76, v2, 5
s_add_u32 s77, s77, s76
s_xor_b32 s76, s76, 32
s_or_b32 s78, s78, s76
v_readlane_b32 s76, v2, 6
s_add_u32 s77, s77, s76
s_xor_b32 s76, s76, 32
s_or_b32 s78, s78, s76
v_readlane_b32 s76, v2, 7
s_add_u32 s77, s77, s76
s_xor_b32 s76, s76, 32
s_or_b32 s78, s78, s76
s_cmp_eq_u32 s77, 256
s_cbranch_scc0 mega_kernel_syxw
v_mov_b32 v252, v2
s_cmp_eq_u32 s78, 0
s_cbranch_scc0 mega_kernel_slowent
v_readlane_b32 s76, v2, 10
v_readlane_b32 s77, v2, 8
s_cmp_eq_u32 s76, 64
s_cbranch_scc0 mega_kernel_syxw
s_cmp_gt_u32 s77, 32
s_cselect_b32 s98, 1, 0
mega_kernel_syxd:
mega_kernel_slowent:
s_mov_b64 exec, -1
s_waitcnt vmcnt(0) lgkmcnt(0)
s_barrier
s_mov_b32 s97, s96
v_readlane_b32 s76, v252, 0
s_cmp_gt_u32 s90, 0
s_cselect_b32 s76, s76, 0
s_add_u32 s97, s97, s76
v_readlane_b32 s76, v252, 1
s_cmp_gt_u32 s90, 1
s_cselect_b32 s76, s76, 0
s_add_u32 s97, s97, s76
v_readlane_b32 s76, v252, 2
s_cmp_gt_u32 s90, 2
s_cselect_b32 s76, s76, 0
s_add_u32 s97, s97, s76
v_readlane_b32 s76, v252, 3
s_cmp_gt_u32 s90, 3
s_cselect_b32 s76, s76, 0
s_add_u32 s97, s97, s76
v_readlane_b32 s76, v252, 4
s_cmp_gt_u32 s90, 4
s_cselect_b32 s76, s76, 0
s_add_u32 s97, s97, s76
v_readlane_b32 s76, v252, 5
s_cmp_gt_u32 s90, 5
s_cselect_b32 s76, s76, 0
s_add_u32 s97, s97, s76
v_readlane_b32 s76, v252, 6
s_cmp_gt_u32 s90, 6
s_cselect_b32 s76, s76, 0
s_add_u32 s97, s97, s76
v_mov_b32 v1, 0
v_mov_b32 v2, 1
v_cmp_eq_u32 vcc, 0, v0
s_and_saveexec_b64 s[88:89], vcc
s_cbranch_execz mega_kernel_sb1
buffer_atomic_add v2, v1, s[72:75], 0 offen offset:192 sc1
mega_kernel_sb1:
s_mov_b64 exec, s[88:89]
mega_kernel_sb2:
s_sleep 4
buffer_load_dword v2, v1, s[72:75], 0 offen offset:192 sc1
s_waitcnt vmcnt(0)
v_cmp_ne_u32 vcc, 256, v2
s_cbranch_vccnz mega_kernel_sb2
s_mov_b32 s95, 1
s_lshr_b32 s30, s97, 5
s_and_b32 s31, s97, 31
s_cmp_lt_u32 s97, 128
s_cbranch_scc1 mega_kernel_recs
s_sub_u32 s94, s97, 128
s_branch mega_kernel_bulk
mega_kernel_spec:
s_mov_b32 s30, s90
s_mov_b32 s31, s96
s_cmp_lt_u32 s90, 4
s_cbranch_scc1 mega_kernel_recf
s_sub_u32 s94, s90, 4
s_lshl_b32 s94, s94, 5
s_add_u32 s94, s94, s96
mega_kernel_bulk:
s_lshr_b32 s91, s94, 5
s_and_b32 s40, s94, 31
s_and_b32 s92, s91, 1
s_lshl_b32 s92, s92, 5
s_add_u32 s92, s92, s40
s_cmp_eq_u32 s91, 0
s_cbranch_scc1 mega_kernel_rk
s_cmp_eq_u32 s91, 1
s_cbranch_scc1 mega_kernel_rv
v_mov_b32 v8, -1
v_mov_b32 v9, -1
v_mov_b32 v10, -1
v_mov_b32 v11, -1
v_lshlrev_b32 v1, 4, v0
v_mov_b32 v2, 0
v_cmp_gt_u32 vcc, 64, v0
s_cbranch_vccz mega_kernel_nv
s_cmp_eq_u32 s95, 0
s_cbranch_scc0 mega_kernel_nv
s_lshr_b32 s60, s2, 1
s_lshl_b32 s60, s60, 14
s_and_b32 s61, s92, 1
s_lshl_b32 s66, s61, 13
s_add_u32 s60, s60, s66
s_and_b32 s66, s2, 1
s_lshl_b32 s66, s66, 10
s_add_u32 s60, s60, s66
s_add_u32 s60, s60, 167772160
s_mov_b32 s66, 0x7fffffff
s_mov_b32 s67, 0x7fffffff
s_mov_b64 exec, 0xff
s_waitcnt vmcnt(0)
s_memtime s[62:63]
s_waitcnt lgkmcnt(0)
buffer_store_dwordx4 v[8:11], v1, s[84:87], s60 offen offset:0 sc1
s_waitcnt vmcnt(0)
s_memtime s[64:65]
s_xor_b32 s60, s60, 8192
s_waitcnt lgkmcnt(0)
s_sub_u32 s64, s64, s62
s_min_u32 s66, s66, s64
s_memtime s[62:63]
s_waitcnt lgkmcnt(0)
buffer_store_dwordx4 v[8:11], v1, s[84:87], s60 offen offset:0 sc1
s_waitcnt vmcnt(0)
s_memtime s[64:65]
s_xor_b32 s60, s60, 8192
s_waitcnt lgkmcnt(0)
s_sub_u32 s64, s64, s62
s_min_u32 s67, s67, s64
s_memtime s[62:63]
s_waitcnt lgkmcnt(0)
buffer_store_dwordx4 v[8:11], v1, s[84:87], s60 offen offset:256 sc1
s_waitcnt vmcnt(0)
s_memtime s[64:65]
s_xor_b32 s60, s60, 8192
s_waitcnt lgkmcnt(0)
s_sub_u32 s64, s64, s62
s_min_u32 s66, s66, s64
s_memtime s[62:63]
s_waitcnt lgkmcnt(0)
buffer_store_dwordx4 v[8:11], v1, s[84:87], s60 offen offset:256 sc1
s_waitcnt vmcnt(0)
s_memtime s[64:65]
s_xor_b32 s60, s60, 8192
s_waitcnt lgkmcnt(0)
s_sub_u32 s64, s64, s62
s_min_u32 s67, s67, s64
s_cmp_lt_u32 s67, s66
s_cselect_b32 s60, 1, 0
s_xor_b32 s60, s60, s61
s_lshr_b32 s61, s90, 2
s_xor_b32 s60, s60, s61
v_mov_b32 v3, s60
s_mov_b64 exec, 1
buffer_atomic_add v3, v2, s[72:75], 0 offen offset:128 sc1
s_mov_b64 exec, -1
mega_kernel_nv:
s_barrier
s_lshl_b32 s60, s92, 12
s_add_u32 s60, s60, 67108864
buffer_store_dwordx4 v[8:11], v1, s[84:87], s60 offen sc1
s_add_u32 s60, s60, 262144
buffer_store_dwordx4 v[8:11], v1, s[84:87], s60 offen sc1
s_add_u32 s60, s60, 262144
buffer_store_dwordx4 v[8:11], v1, s[84:87], s60 offen sc1
s_add_u32 s60, s60, 262144
buffer_store_dwordx4 v[8:11], v1, s[84:87], s60 offen sc1
s_add_u32 s60, s60, 262144
buffer_store_dwordx4 v[8:11], v1, s[84:87], s60 offen sc1
s_add_u32 s60, s60, 262144
buffer_store_dwordx4 v[8:11], v1, s[84:87], s60 offen sc1
s_add_u32 s60, s60, 262144
buffer_store_dwordx4 v[8:11], v1, s[84:87], s60 offen sc1
s_add_u32 s60, s60, 262144
buffer_store_dwordx4 v[8:11], v1, s[84:87], s60 offen sc1
s_add_u32 s60, s60, 262144
s_lshr_b32 s62, s92, 1
s_and_b32 s63, s92, 1
s_add_u32 s63, s63, s62
s_lshl_b32 s62, s62, 19
s_and_b32 s64, s63, 14
s_lshl_b32 s64, s64, 13
s_add_u32 s62, s62, s64
s_and_b32 s64, s63, 1
s_lshl_b32 s64, s64, 12
s_add_u32 s62, s62, s64
s_add_u32 s62, s62, 150994944
s_add_u32 s62, s62, 8192
s_cmp_lt_u32 s92, 16
s_cbranch_scc0 mega_kernel_pz
buffer_store_dwordx4 v[8:11], v1, s[84:87], s60 offen sc1
mega_kernel_pz:
s_waitcnt vmcnt(0)
s_barrier
v_mov_b32 v3, 1
s_lshl_b32 s62, s95, 6
v_cmp_eq_u32 vcc, 0, v0
s_and_saveexec_b64 s[60:61], vcc
s_cbranch_execz mega_kernel_xps
buffer_atomic_add v3, v2, s[72:75], s62 offen offset:160 sc1
mega_kernel_xps:
s_mov_b64 exec, s[60:61]
s_cmp_eq_u32 s91, 2
s_cbranch_scc0 mega_kernel_rd
v_and_b32 v3, 15, v0
v_lshlrev_b32 v3, 4, v3
s_branch mega_kernel_syc
mega_kernel_sycw:
s_sleep 4
mega_kernel_syc:
buffer_load_dword v2, v3, s[72:75], 0 offen sc1
s_waitcnt vmcnt(0)
s_cmp_eq_u32 s95, 1
s_cbranch_scc0 mega_kernel_sycf
v_readlane_b32 s76, v2, 14
s_mov_b32 s98, 0
s_cmp_eq_u32 s76, 64
s_cbranch_scc0 mega_kernel_sycw
s_branch mega_kernel_sycd
mega_kernel_sycf:
s_mov_b32 s77, 0
s_mov_b32 s78, 0
v_readlane_b32 s76, v2, 0
s_add_u32 s77, s77, s76
s_xor_b32 s76, s76, 32
s_or_b32 s78, s78, s76
v_readlane_b32 s76, v2, 1
s_add_u32 s77, s77, s76
s_xor_b32 s76, s76, 32
s_or_b32 s78, s78, s76
v_readlane_b32 s76, v2, 2
s_add_u32 s77, s77, s76
s_xor_b32 s76, s76, 32
s_or_b32 s78, s78, s76
v_readlane_b32 s76, v2, 3
s_add_u32 s77, s77, s76
s_xor_b32 s76, s76, 32
s_or_b32 s78, s78, s76
v_readlane_b32 s76, v2, 4
s_add_u32 s77, s77, s76
s_xor_b32 s76, s76, 32
s_or_b32 s78, s78, s76
v_readlane_b32 s76, v2, 5
s_add_u32 s77, s77, s76
s_xor_b32 s76, s76, 32
s_or_b32 s78, s78, s76
v_readlane_b32 s76, v2, 6
s_add_u32 s77, s77, s76
s_xor_b32 s76, s76, 32
s_or_b32 s78, s78, s76
v_readlane_b32 s76, v2, 7
s_add_u32 s77, s77, s76
s_xor_b32 s76, s76, 32
s_or_b32 s78, s78, s76
s_cmp_eq_u32 s77, 256
s_cbranch_scc0 mega_kernel_sycw
v_mov_b32 v252, v2
s_cmp_eq_u32 s78, 0
s_cbranch_scc0 mega_kernel_slowent
v_readlane_b32 s76, v2, 10
v_readlane_b32 s77, v2, 8
s_cmp_eq_u32 s76, 64
s_cbranch_scc0 mega_kernel_sycw
s_cmp_gt_u32 s77, 32
s_cselect_b32 s98, 1, 0
mega_kernel_sycd:
s_load_dwordx2 s[4:5], s[0:1], 16
s_load_dwordx2 s[8:9], s[0:1], 0
v_lshrrev_b32 v2, 6, v0
v_and_b32 v1, 63, v0
v_readfirstlane_b32 s41, v2
v_lshlrev_b32 v5, 4, v1
s_waitcnt lgkmcnt(0)
s_mov_b32 s6, 8388608
s_mov_b32 s7, 0x00020000
s_mov_b32 s10, 4194304
s_mov_b32 s11, 0x00020000
s_lshl_b32 s43, s40, 8
s_lshl_b32 s44, s41, 6
s_add_u32 s48, s43, s44
s_and_b32 s43, s48, 0x7ff
v_add_u32 v19, s43, v1
v_lshlrev_b32 v19, 7, v19
buffer_load_dword v20, v19, s[8:11], 0 offen
v_lshrrev_b32 v2, 2, v1
v_and_b32 v3, 3, v1
v_lshlrev_b32 v16, 13, v2
v_lshl_add_u32 v16, v3, 4, v16
v_add_u32 v16, s48, v16
v_and_b32 v3, 3, v1
s_lshl_b32 s45, s41, 15
v_bfe_u32 v17, v1, 2, 2
v_lshrrev_b32 v18, 4, v1
v_lshl_add_u32 v17, v18, 3, v17
v_lshlrev_b32 v17, 6, v17
v_lshl_add_u32 v17, v3, 4, v17
v_add_u32 v17, s45, v17
s_add_u32 m0, s45, 0
s_mov_b32 s44, 0
buffer_load_dwordx4 v16, s[4:7], s44 offen lds
s_add_u32 m0, s45, 1024
s_mov_b32 s44, 131072
buffer_load_dwordx4 v16, s[4:7], s44 offen lds
s_add_u32 m0, s45, 2048
s_mov_b32 s44, 262144
buffer_load_dwordx4 v16, s[4:7], s44 offen lds
s_add_u32 m0, s45, 3072
s_mov_b32 s44, 393216
buffer_load_dwordx4 v16, s[4:7], s44 offen lds
s_add_u32 m0, s45, 4096
s_mov_b32 s44, 524288
buffer_load_dwordx4 v16, s[4:7], s44 offen lds
s_add_u32 m0, s45, 5120
s_mov_b32 s44, 655360
buffer_load_dwordx4 v16, s[4:7], s44 offen lds
s_add_u32 m0, s45, 6144
s_mov_b32 s44, 786432
buffer_load_dwordx4 v16, s[4:7], s44 offen lds
s_add_u32 m0, s45, 7168
s_mov_b32 s44, 917504
buffer_load_dwordx4 v16, s[4:7], s44 offen lds
s_add_u32 m0, s45, 8192
s_mov_b32 s44, 1048576
buffer_load_dwordx4 v16, s[4:7], s44 offen lds
s_add_u32 m0, s45, 9216
s_mov_b32 s44, 1179648
buffer_load_dwordx4 v16, s[4:7], s44 offen lds
s_add_u32 m0, s45, 10240
s_mov_b32 s44, 1310720
buffer_load_dwordx4 v16, s[4:7], s44 offen lds
s_add_u32 m0, s45, 11264
s_mov_b32 s44, 1441792
buffer_load_dwordx4 v16, s[4:7], s44 offen lds
s_add_u32 m0, s45, 12288
s_mov_b32 s44, 1572864
buffer_load_dwordx4 v16, s[4:7], s44 offen lds
s_add_u32 m0, s45, 13312
s_mov_b32 s44, 1703936
buffer_load_dwordx4 v16, s[4:7], s44 offen lds
s_add_u32 m0, s45, 14336
s_mov_b32 s44, 1835008
buffer_load_dwordx4 v16, s[4:7], s44 offen lds
s_add_u32 m0, s45, 15360
s_mov_b32 s44, 1966080
buffer_load_dwordx4 v16, s[4:7], s44 offen lds
s_add_u32 m0, s45, 16384
s_mov_b32 s44, 2097152
buffer_load_dwordx4 v16, s[4:7], s44 offen lds
s_add_u32 m0, s45, 17408
s_mov_b32 s44, 2228224
buffer_load_dwordx4 v16, s[4:7], s44 offen lds
s_add_u32 m0, s45, 18432
s_mov_b32 s44, 2359296
buffer_load_dwordx4 v16, s[4:7], s44 offen lds
s_add_u32 m0, s45, 19456
s_mov_b32 s44, 2490368
buffer_load_dwordx4 v16, s[4:7], s44 offen lds
s_add_u32 m0, s45, 20480
s_mov_b32 s44, 2621440
buffer_load_dwordx4 v16, s[4:7], s44 offen lds
s_add_u32 m0, s45, 21504
s_mov_b32 s44, 2752512
buffer_load_dwordx4 v16, s[4:7], s44 offen lds
s_add_u32 m0, s45, 22528
s_mov_b32 s44, 2883584
buffer_load_dwordx4 v16, s[4:7], s44 offen lds
s_add_u32 m0, s45, 23552
s_mov_b32 s44, 3014656
buffer_load_dwordx4 v16, s[4:7], s44 offen lds
s_add_u32 m0, s45, 24576
s_mov_b32 s44, 3145728
buffer_load_dwordx4 v16, s[4:7], s44 offen lds
s_add_u32 m0, s45, 25600
s_mov_b32 s44, 3276800
buffer_load_dwordx4 v16, s[4:7], s44 offen lds
s_add_u32 m0, s45, 26624
s_mov_b32 s44, 3407872
buffer_load_dwordx4 v16, s[4:7], s44 offen lds
s_add_u32 m0, s45, 27648
s_mov_b32 s44, 3538944
buffer_load_dwordx4 v16, s[4:7], s44 offen lds
s_add_u32 m0, s45, 28672
s_mov_b32 s44, 3670016
buffer_load_dwordx4 v16, s[4:7], s44 offen lds
s_add_u32 m0, s45, 29696
s_mov_b32 s44, 3801088
buffer_load_dwordx4 v16, s[4:7], s44 offen lds
s_add_u32 m0, s45, 30720
s_mov_b32 s44, 3932160
buffer_load_dwordx4 v16, s[4:7], s44 offen lds
s_add_u32 m0, s45, 31744
s_mov_b32 s44, 4063232
buffer_load_dwordx4 v16, s[4:7], s44 offen lds
s_waitcnt vmcnt(16)
ds_read_b64_tr_b16 a[0:1], v17 offset:0
ds_read_b64_tr_b16 a[2:3], v17 offset:256
ds_read_b64_tr_b16 a[4:5], v17 offset:8
ds_read_b64_tr_b16 a[6:7], v17 offset:264
ds_read_b64_tr_b16 a[8:9], v17 offset:2048
ds_read_b64_tr_b16 a[10:11], v17 offset:2304
ds_read_b64_tr_b16 a[12:13], v17 offset:2056
ds_read_b64_tr_b16 a[14:15], v17 offset:2312
s_waitcnt lgkmcnt(0)
ds_read_b64_tr_b16 a[16:17], v17 offset:4096
ds_read_b64_tr_b16 a[18:19], v17 offset:4352
ds_read_b64_tr_b16 a[20:21], v17 offset:4104
ds_read_b64_tr_b16 a[22:23], v17 offset:4360
ds_read_b64_tr_b16 a[24:25], v17 offset:6144
ds_read_b64_tr_b16 a[26:27], v17 offset:6400
ds_read_b64_tr_b16 a[28:29], v17 offset:6152
ds_read_b64_tr_b16 a[30:31], v17 offset:6408
s_waitcnt lgkmcnt(0)
ds_read_b64_tr_b16 a[32:33], v17 offset:8192
ds_read_b64_tr_b16 a[34:35], v17 offset:8448
ds_read_b64_tr_b16 a[36:37], v17 offset:8200
ds_read_b64_tr_b16 a[38:39], v17 offset:8456
ds_read_b64_tr_b16 a[40:41], v17 offset:10240
ds_read_b64_tr_b16 a[42:43], v17 offset:10496
ds_read_b64_tr_b16 a[44:45], v17 offset:10248
ds_read_b64_tr_b16 a[46:47], v17 offset:10504
s_waitcnt lgkmcnt(0)
ds_read_b64_tr_b16 a[48:49], v17 offset:12288
ds_read_b64_tr_b16 a[50:51], v17 offset:12544
ds_read_b64_tr_b16 a[52:53], v17 offset:12296
ds_read_b64_tr_b16 a[54:55], v17 offset:12552
ds_read_b64_tr_b16 a[56:57], v17 offset:14336
ds_read_b64_tr_b16 a[58:59], v17 offset:14592
ds_read_b64_tr_b16 a[60:61], v17 offset:14344
ds_read_b64_tr_b16 a[62:63], v17 offset:14600
s_waitcnt lgkmcnt(0)
s_add_u32 m0, s45, 0
s_mov_b32 s44, 4194304
buffer_load_dwordx4 v16, s[4:7], s44 offen lds
s_add_u32 m0, s45, 1024
s_mov_b32 s44, 4325376
buffer_load_dwordx4 v16, s[4:7], s44 offen lds
s_add_u32 m0, s45, 2048
s_mov_b32 s44, 4456448
buffer_load_dwordx4 v16, s[4:7], s44 offen lds
s_add_u32 m0, s45, 3072
s_mov_b32 s44, 4587520
buffer_load_dwordx4 v16, s[4:7], s44 offen lds
s_add_u32 m0, s45, 4096
s_mov_b32 s44, 4718592
buffer_load_dwordx4 v16, s[4:7], s44 offen lds
s_add_u32 m0, s45, 5120
s_mov_b32 s44, 4849664
buffer_load_dwordx4 v16, s[4:7], s44 offen lds
s_add_u32 m0, s45, 6144
s_mov_b32 s44, 4980736
buffer_load_dwordx4 v16, s[4:7], s44 offen lds
s_add_u32 m0, s45, 7168
s_mov_b32 s44, 5111808
buffer_load_dwordx4 v16, s[4:7], s44 offen lds
s_add_u32 m0, s45, 8192
s_mov_b32 s44, 5242880
buffer_load_dwordx4 v16, s[4:7], s44 offen lds
s_add_u32 m0, s45, 9216
s_mov_b32 s44, 5373952
buffer_load_dwordx4 v16, s[4:7], s44 offen lds
s_add_u32 m0, s45, 10240
s_mov_b32 s44, 5505024
buffer_load_dwordx4 v16, s[4:7], s44 offen lds
s_add_u32 m0, s45, 11264
s_mov_b32 s44, 5636096
buffer_load_dwordx4 v16, s[4:7], s44 offen lds
s_add_u32 m0, s45, 12288
s_mov_b32 s44, 5767168
buffer_load_dwordx4 v16, s[4:7], s44 offen lds
s_add_u32 m0, s45, 13312
s_mov_b32 s44, 5898240
buffer_load_dwordx4 v16, s[4:7], s44 offen lds
s_add_u32 m0, s45, 14336
s_mov_b32 s44, 6029312
buffer_load_dwordx4 v16, s[4:7], s44 offen lds
s_add_u32 m0, s45, 15360
s_mov_b32 s44, 6160384
buffer_load_dwordx4 v16, s[4:7], s44 offen lds
s_waitcnt vmcnt(16)
ds_read_b64_tr_b16 a[64:65], v17 offset:16384
ds_read_b64_tr_b16 a[66:67], v17 offset:16640
ds_read_b64_tr_b16 a[68:69], v17 offset:16392
ds_read_b64_tr_b16 a[70:71], v17 offset:16648
ds_read_b64_tr_b16 a[72:73], v17 offset:18432
ds_read_b64_tr_b16 a[74:75], v17 offset:18688
ds_read_b64_tr_b16 a[76:77], v17 offset:18440
ds_read_b64_tr_b16 a[78:79], v17 offset:18696
s_waitcnt lgkmcnt(0)
ds_read_b64_tr_b16 a[80:81], v17 offset:20480
ds_read_b64_tr_b16 a[82:83], v17 offset:20736
ds_read_b64_tr_b16 a[84:85], v17 offset:20488
ds_read_b64_tr_b16 a[86:87], v17 offset:20744
ds_read_b64_tr_b16 a[88:89], v17 offset:22528
ds_read_b64_tr_b16 a[90:91], v17 offset:22784
ds_read_b64_tr_b16 a[92:93], v17 offset:22536
ds_read_b64_tr_b16 a[94:95], v17 offset:22792
s_waitcnt lgkmcnt(0)
ds_read_b64_tr_b16 a[96:97], v17 offset:24576
ds_read_b64_tr_b16 a[98:99], v17 offset:24832
ds_read_b64_tr_b16 a[100:101], v17 offset:24584
ds_read_b64_tr_b16 a[102:103], v17 offset:24840
ds_read_b64_tr_b16 a[104:105], v17 offset:26624
ds_read_b64_tr_b16 a[106:107], v17 offset:26880
ds_read_b64_tr_b16 a[108:109], v17 offset:26632
ds_read_b64_tr_b16 a[110:111], v17 offset:26888
s_waitcnt lgkmcnt(0)
ds_read_b64_tr_b16 a[112:113], v17 offset:28672
ds_read_b64_tr_b16 a[114:115], v17 offset:28928
ds_read_b64_tr_b16 a[116:117], v17 offset:28680
ds_read_b64_tr_b16 a[118:119], v17 offset:28936
ds_read_b64_tr_b16 a[120:121], v17 offset:30720
ds_read_b64_tr_b16 a[122:123], v17 offset:30976
ds_read_b64_tr_b16 a[124:125], v17 offset:30728
ds_read_b64_tr_b16 a[126:127], v17 offset:30984
s_waitcnt lgkmcnt(0)
s_add_u32 m0, s45, 16384
s_mov_b32 s44, 6291456
buffer_load_dwordx4 v16, s[4:7], s44 offen lds
s_add_u32 m0, s45, 17408
s_mov_b32 s44, 6422528
buffer_load_dwordx4 v16, s[4:7], s44 offen lds
s_add_u32 m0, s45, 18432
s_mov_b32 s44, 6553600
buffer_load_dwordx4 v16, s[4:7], s44 offen lds
s_add_u32 m0, s45, 19456
s_mov_b32 s44, 6684672
buffer_load_dwordx4 v16, s[4:7], s44 offen lds
s_add_u32 m0, s45, 20480
s_mov_b32 s44, 6815744
buffer_load_dwordx4 v16, s[4:7], s44 offen lds
s_add_u32 m0, s45, 21504
s_mov_b32 s44, 6946816
buffer_load_dwordx4 v16, s[4:7], s44 offen lds
s_add_u32 m0, s45, 22528
s_mov_b32 s44, 7077888
buffer_load_dwordx4 v16, s[4:7], s44 offen lds
s_add_u32 m0, s45, 23552
s_mov_b32 s44, 7208960
buffer_load_dwordx4 v16, s[4:7], s44 offen lds
s_add_u32 m0, s45, 24576
s_mov_b32 s44, 7340032
buffer_load_dwordx4 v16, s[4:7], s44 offen lds
s_add_u32 m0, s45, 25600
s_mov_b32 s44, 7471104
buffer_load_dwordx4 v16, s[4:7], s44 offen lds
s_add_u32 m0, s45, 26624
s_mov_b32 s44, 7602176
buffer_load_dwordx4 v16, s[4:7], s44 offen lds
s_add_u32 m0, s45, 27648
s_mov_b32 s44, 7733248
buffer_load_dwordx4 v16, s[4:7], s44 offen lds
s_add_u32 m0, s45, 28672
s_mov_b32 s44, 7864320
buffer_load_dwordx4 v16, s[4:7], s44 offen lds
s_add_u32 m0, s45, 29696
s_mov_b32 s44, 7995392
buffer_load_dwordx4 v16, s[4:7], s44 offen lds
s_add_u32 m0, s45, 30720
s_mov_b32 s44, 8126464
buffer_load_dwordx4 v16, s[4:7], s44 offen lds
s_add_u32 m0, s45, 31744
s_mov_b32 s44, 8257536
buffer_load_dwordx4 v16, s[4:7], s44 offen lds
s_waitcnt vmcnt(16)
ds_read_b64_tr_b16 a[128:129], v17 offset:0
ds_read_b64_tr_b16 a[130:131], v17 offset:256
ds_read_b64_tr_b16 a[132:133], v17 offset:8
ds_read_b64_tr_b16 a[134:135], v17 offset:264
ds_read_b64_tr_b16 a[136:137], v17 offset:2048
ds_read_b64_tr_b16 a[138:139], v17 offset:2304
ds_read_b64_tr_b16 a[140:141], v17 offset:2056
ds_read_b64_tr_b16 a[142:143], v17 offset:2312
s_waitcnt lgkmcnt(0)
ds_read_b64_tr_b16 a[144:145], v17 offset:4096
ds_read_b64_tr_b16 a[146:147], v17 offset:4352
ds_read_b64_tr_b16 a[148:149], v17 offset:4104
ds_read_b64_tr_b16 a[150:151], v17 offset:4360
ds_read_b64_tr_b16 a[152:153], v17 offset:6144
ds_read_b64_tr_b16 a[154:155], v17 offset:6400
ds_read_b64_tr_b16 a[156:157], v17 offset:6152
ds_read_b64_tr_b16 a[158:159], v17 offset:6408
s_waitcnt lgkmcnt(0)
ds_read_b64_tr_b16 a[160:161], v17 offset:8192
ds_read_b64_tr_b16 a[162:163], v17 offset:8448
ds_read_b64_tr_b16 a[164:165], v17 offset:8200
ds_read_b64_tr_b16 a[166:167], v17 offset:8456
ds_read_b64_tr_b16 a[168:169], v17 offset:10240
ds_read_b64_tr_b16 a[170:171], v17 offset:10496
ds_read_b64_tr_b16 a[172:173], v17 offset:10248
ds_read_b64_tr_b16 a[174:175], v17 offset:10504
s_waitcnt lgkmcnt(0)
ds_read_b64_tr_b16 a[176:177], v17 offset:12288
ds_read_b64_tr_b16 a[178:179], v17 offset:12544
ds_read_b64_tr_b16 a[180:181], v17 offset:12296
ds_read_b64_tr_b16 a[182:183], v17 offset:12552
ds_read_b64_tr_b16 a[184:185], v17 offset:14336
ds_read_b64_tr_b16 a[186:187], v17 offset:14592
ds_read_b64_tr_b16 a[188:189], v17 offset:14344
ds_read_b64_tr_b16 a[190:191], v17 offset:14600
s_waitcnt lgkmcnt(0)
s_waitcnt vmcnt(0)
ds_read_b64_tr_b16 a[192:193], v17 offset:16384
ds_read_b64_tr_b16 a[194:195], v17 offset:16640
ds_read_b64_tr_b16 a[196:197], v17 offset:16392
ds_read_b64_tr_b16 a[198:199], v17 offset:16648
ds_read_b64_tr_b16 a[200:201], v17 offset:18432
ds_read_b64_tr_b16 a[202:203], v17 offset:18688
ds_read_b64_tr_b16 a[204:205], v17 offset:18440
ds_read_b64_tr_b16 a[206:207], v17 offset:18696
s_waitcnt lgkmcnt(0)
ds_read_b64_tr_b16 a[208:209], v17 offset:20480
ds_read_b64_tr_b16 a[210:211], v17 offset:20736
ds_read_b64_tr_b16 a[212:213], v17 offset:20488
ds_read_b64_tr_b16 a[214:215], v17 offset:20744
ds_read_b64_tr_b16 a[216:217], v17 offset:22528
ds_read_b64_tr_b16 a[218:219], v17 offset:22784
ds_read_b64_tr_b16 a[220:221], v17 offset:22536
ds_read_b64_tr_b16 a[222:223], v17 offset:22792
s_waitcnt lgkmcnt(0)
ds_read_b64_tr_b16 a[224:225], v17 offset:24576
ds_read_b64_tr_b16 a[226:227], v17 offset:24832
ds_read_b64_tr_b16 a[228:229], v17 offset:24584
ds_read_b64_tr_b16 a[230:231], v17 offset:24840
ds_read_b64_tr_b16 a[232:233], v17 offset:26624
ds_read_b64_tr_b16 a[234:235], v17 offset:26880
ds_read_b64_tr_b16 a[236:237], v17 offset:26632
ds_read_b64_tr_b16 a[238:239], v17 offset:26888
s_waitcnt lgkmcnt(0)
ds_read_b64_tr_b16 a[240:241], v17 offset:28672
ds_read_b64_tr_b16 a[242:243], v17 offset:28928
ds_read_b64_tr_b16 a[244:245], v17 offset:28680
ds_read_b64_tr_b16 a[246:247], v17 offset:28936
ds_read_b64_tr_b16 a[248:249], v17 offset:30720
ds_read_b64_tr_b16 a[250:251], v17 offset:30976
ds_read_b64_tr_b16 a[252:253], v17 offset:30728
ds_read_b64_tr_b16 a[254:255], v17 offset:30984
s_waitcnt lgkmcnt(0)
s_barrier
v_lshrrev_b32 v2, 3, v1
s_lshl_b32 s43, s41, 3
v_add_u32 v2, s43, v2
v_bfe_u32 v3, v2, 1, 3
v_and_b32 v4, 7, v1
v_xor_b32 v3, v3, v4
v_lshlrev_b32 v6, 11, v2
v_lshl_add_u32 v6, v3, 4, v6
s_lshl_b32 s46, s41, 10
v_and_b32 v2, 15, v1
v_bfe_u32 v3, v2, 1, 3
v_lshrrev_b32 v4, 4, v1
v_xor_b32 v3, v3, v4
v_lshlrev_b32 v8, 7, v2
v_lshl_add_u32 v8, v3, 4, v8
v_xor_b32 v9, 64, v8
v_add_u32 v10, 0x10000, v8
v_add_u32 v11, 0x10000, v9
v_mov_b32 v7, v5
s_lshl_b32 s47, s40, 2
s_add_u32 s47, s47, s41
s_mov_b32 s42, 0
v_lshrrev_b32 v92, 4, v1
v_and_b32 v93, 15, v1
s_and_b32 s52, s41, 1
s_lshr_b32 s53, s41, 1
s_mov_b32 s54, 0x3e0293ee
s_mov_b32 s55, 0
s_mov_b32 s56, 0
v_mov_b32 v97, 0xff7fffff
v_and_b32 v2, 7, v93
v_lshlrev_b32 v94, 7, v92
v_lshl_add_u32 v94, v2, 4, v94
v_and_b32 v2, 31, v1
v_lshlrev_b32 v95, 3, v2
v_lshrrev_b32 v2, 1, v92
v_lshlrev_b32 v96, 10, v2
v_and_b32 v2, 1, v92
v_lshl_add_u32 v96, v2, 9, v96
v_lshl_add_u32 v96, v93, 4, v96
s_lshl_b32 s43, s40, 13
s_lshl_b32 s44, s53, 12
s_add_u32 s43, s43, s44
s_lshl_b32 s44, s52, 8
s_add_u32 s43, s43, s44
s_add_u32 s43, s43, 134217728
v_add_u32 v96, s43, v96
s_lshl_b32 s43, s52, 4
v_add_u32 v98, s43, v93
v_lshlrev_b32 v2, 2, v92
v_sub_u32 v98, v98, v2
s_mov_b32 s28, 0
s_mov_b32 s29, -1
s_xor_b32 s44, s98, 1
s_lshl_b32 s44, s44, 13
s_lshl_b32 s43, s40, 7
s_add_u32 s43, s43, s44
s_add_u32 s43, s43, 69206016
v_and_b32 v2, 3, v1
v_bfe_u32 v3, v1, 2, 1
v_lshlrev_b32 v99, 12, v3
v_lshl_add_u32 v99, v2, 2, v99
v_add_u32 v99, s43, v99
s_xor_b32 s62, s98, 1
s_lshl_b32 s62, s62, 13
s_lshr_b32 s44, s47, 6
s_lshl_b32 s44, s44, 14
s_add_u32 s62, s62, s44
s_and_b32 s44, s47, 63
s_lshl_b32 s44, s44, 7
s_add_u32 s62, s62, s44
s_add_u32 s62, s62, 69222400
s_lshl_b32 s49, s47, 2
s_add_u32 s49, s49, 69255168
s_lshl_b32 s43, s41, 11
s_add_u32 s43, s43, 131072
v_add_u32 v101, s43, v7
s_lshl_b32 s43, s52, 10
s_add_u32 s43, s43, 131072
v_add_u32 v102, s43, v5
v_mov_b32 v16, 0
s_mov_b32 s50, 0
v_mov_b32 v104, 0x3f803f80
v_mov_b32 v105, 0x3f803f80
v_mov_b32 v106, 0x3f803f80
v_mov_b32 v107, 0x3f803f80
v_cmp_gt_i32 s[12:13], 0, v98
v_cmp_gt_i32 s[14:15], 1, v98
v_cmp_gt_i32 s[16:17], 2, v98
v_cmp_gt_i32 s[18:19], 3, v98
v_cmp_gt_i32 s[20:21], 16, v98
v_cmp_gt_i32 s[22:23], 17, v98
v_cmp_gt_i32 s[24:25], 18, v98
v_cmp_gt_i32 s[26:27], 19, v98
s_lshr_b32 s44, s47, 3
s_xor_b32 s44, s44, s98
s_and_b32 s44, s44, 1
s_lshl_b32 s44, s44, 13
s_lshl_b32 s58, s47, 18
s_add_u32 s58, s58, s44
s_add_u32 s58, s58, 0
s_lshr_b32 s44, s47, 4
s_xor_b32 s44, s44, s98
s_and_b32 s44, s44, 1
s_lshl_b32 s44, s44, 13
s_lshl_b32 s59, s47, 17
s_add_u32 s59, s59, s44
s_add_u32 s59, s59, 71303168
s_lshl_b32 s60, s41, 11
s_add_u32 s60, s60, 139264
s_lshl_b32 s61, s41, 10
s_add_u32 s61, s61, 155648
v_add_u32 v94, 155648, v94
s_lshl_b32 s43, s53, 11
s_add_u32 s43, s43, 156160
v_add_u32 v95, s43, v95
v_add_u32 v103, 139264, v5
s_lshl_b32 s43, s53, 12
s_add_u32 s43, s43, 147456
v_add_u32 v240, s43, v5
s_add_u32 m0, s46, 0
s_nop 0
buffer_load_dwordx4 v6, s[8:11], s50 offen offset:0 lds
s_add_u32 m0, s46, 3968
s_nop 0
buffer_load_dwordx4 v6, s[8:11], s50 offen offset:128 lds
s_add_u32 m0, s46, 7936
s_nop 0
buffer_load_dwordx4 v6, s[8:11], s50 offen offset:256 lds
s_add_u32 m0, s46, 11904
s_nop 0
buffer_load_dwordx4 v6, s[8:11], s50 offen offset:384 lds
s_add_u32 m0, s46, 15872
s_nop 0
buffer_load_dwordx4 v6, s[8:11], s50 offen offset:512 lds
s_add_u32 m0, s46, 19840
s_nop 0
buffer_load_dwordx4 v6, s[8:11], s50 offen offset:640 lds
s_add_u32 m0, s46, 23808
s_nop 0
buffer_load_dwordx4 v6, s[8:11], s50 offen offset:768 lds
s_add_u32 m0, s46, 27776
s_nop 0
buffer_load_dwordx4 v6, s[8:11], s50 offen offset:896 lds
s_add_u32 m0, s46, 31744
s_nop 0
buffer_load_dwordx4 v6, s[8:11], s50 offen offset:1024 lds
s_add_u32 m0, s46, 35712
s_nop 0
buffer_load_dwordx4 v6, s[8:11], s50 offen offset:1152 lds
s_add_u32 m0, s46, 39680
s_nop 0
buffer_load_dwordx4 v6, s[8:11], s50 offen offset:1280 lds
s_add_u32 m0, s46, 43648
s_nop 0
buffer_load_dwordx4 v6, s[8:11], s50 offen offset:1408 lds
s_add_u32 m0, s46, 47616
s_nop 0
buffer_load_dwordx4 v6, s[8:11], s50 offen offset:1536 lds
s_add_u32 m0, s46, 51584
s_nop 0
buffer_load_dwordx4 v6, s[8:11], s50 offen offset:1664 lds
s_add_u32 m0, s46, 55552
s_nop 0
buffer_load_dwordx4 v6, s[8:11], s50 offen offset:1792 lds
s_add_u32 m0, s46, 59520
s_nop 0
buffer_load_dwordx4 v6, s[8:11], s50 offen offset:1920 lds
s_waitcnt vmcnt(0)
s_barrier
s_mov_b32 s50, 0x10000
ds_read_b128 v[20:23], v8 offset:0
ds_read_b128 v[24:27], v8 offset:2048
ds_read_b128 v[28:31], v9 offset:0
ds_read_b128 v[32:35], v9 offset:2048
ds_read_b128 v[36:39], v8 offset:4096
ds_read_b128 v[40:43], v8 offset:6144
s_add_u32 m0, s46, 65536
s_waitcnt lgkmcnt(4)
v_mfma_f32_16x16x32_bf16 v[52:55], a[0:3], v[20:23], 0
ds_read_b128 v[44:47], v9 offset:4096
v_mfma_f32_16x16x32_bf16 v[56:59], a[4:7], v[20:23], 0
buffer_load_dwordx4 v6, s[8:11], s50 offen offset:0 lds
v_mfma_f32_16x16x32_bf16 v[60:63], a[0:3], v[24:27], 0
ds_read_b128 v[48:51], v9 offset:6144
v_mfma_f32_16x16x32_bf16 v[64:67], a[4:7], v[24:27], 0
s_add_u32 m0, s46, 69504
s_waitcnt lgkmcnt(4)
v_mfma_f32_16x16x32_bf16 v[52:55], a[8:11], v[28:31], v[52:55]
ds_read_b128 v[20:23], v8 offset:8192
v_mfma_f32_16x16x32_bf16 v[56:59], a[12:15], v[28:31], v[56:59]
buffer_load_dwordx4 v6, s[8:11], s50 offen offset:128 lds
v_mfma_f32_16x16x32_bf16 v[60:63], a[8:11], v[32:35], v[60:63]
ds_read_b128 v[24:27], v8 offset:10240
v_mfma_f32_16x16x32_bf16 v[64:67], a[12:15], v[32:35], v[64:67]
s_add_u32 m0, s46, 73472
s_waitcnt lgkmcnt(4)
v_mfma_f32_16x16x32_bf16 v[52:55], a[16:19], v[36:39], v[52:55]
ds_read_b128 v[28:31], v9 offset:8192
v_mfma_f32_16x16x32_bf16 v[56:59], a[20:23], v[36:39], v[56:59]
buffer_load_dwordx4 v6, s[8:11], s50 offen offset:256 lds
v_mfma_f32_16x16x32_bf16 v[60:63], a[16:19], v[40:43], v[60:63]
ds_read_b128 v[32:35], v9 offset:10240
v_mfma_f32_16x16x32_bf16 v[64:67], a[20:23], v[40:43], v[64:67]
s_add_u32 m0, s46, 77440
s_waitcnt lgkmcnt(4)
v_mfma_f32_16x16x32_bf16 v[52:55], a[24:27], v[44:47], v[52:55]
ds_read_b128 v[36:39], v8 offset:12288
v_mfma_f32_16x16x32_bf16 v[56:59], a[28:31], v[44:47], v[56:59]
buffer_load_dwordx4 v6, s[8:11], s50 offen offset:384 lds
v_mfma_f32_16x16x32_bf16 v[60:63], a[24:27], v[48:51], v[60:63]
ds_read_b128 v[40:43], v8 offset:14336
v_mfma_f32_16x16x32_bf16 v[64:67], a[28:31], v[48:51], v[64:67]
s_add_u32 m0, s46, 81408
s_waitcnt lgkmcnt(4)
v_mfma_f32_16x16x32_bf16 v[52:55], a[32:35], v[20:23], v[52:55]
ds_read_b128 v[44:47], v9 offset:12288
v_mfma_f32_16x16x32_bf16 v[56:59], a[36:39], v[20:23], v[56:59]
buffer_load_dwordx4 v6, s[8:11], s50 offen offset:512 lds
v_mfma_f32_16x16x32_bf16 v[60:63], a[32:35], v[24:27], v[60:63]
ds_read_b128 v[48:51], v9 offset:14336
v_mfma_f32_16x16x32_bf16 v[64:67], a[36:39], v[24:27], v[64:67]
s_add_u32 m0, s46, 85376
s_waitcnt lgkmcnt(4)
v_mfma_f32_16x16x32_bf16 v[52:55], a[40:43], v[28:31], v[52:55]
ds_read_b128 v[20:23], v8 offset:16384
v_mfma_f32_16x16x32_bf16 v[56:59], a[44:47], v[28:31], v[56:59]
buffer_load_dwordx4 v6, s[8:11], s50 offen offset:640 lds
v_mfma_f32_16x16x32_bf16 v[60:63], a[40:43], v[32:35], v[60:63]
ds_read_b128 v[24:27], v8 offset:18432
v_mfma_f32_16x16x32_bf16 v[64:67], a[44:47], v[32:35], v[64:67]
s_add_u32 m0, s46, 89344
s_waitcnt lgkmcnt(4)
v_mfma_f32_16x16x32_bf16 v[52:55], a[48:51], v[36:39], v[52:55]
ds_read_b128 v[28:31], v9 offset:16384
v_mfma_f32_16x16x32_bf16 v[56:59], a[52:55], v[36:39], v[56:59]
buffer_load_dwordx4 v6, s[8:11], s50 offen offset:768 lds
v_mfma_f32_16x16x32_bf16 v[60:63], a[48:51], v[40:43], v[60:63]
ds_read_b128 v[32:35], v9 offset:18432
v_mfma_f32_16x16x32_bf16 v[64:67], a[52:55], v[40:43], v[64:67]
s_add_u32 m0, s46, 93312
s_waitcnt lgkmcnt(4)
v_mfma_f32_16x16x32_bf16 v[52:55], a[56:59], v[44:47], v[52:55]
ds_read_b128 v[36:39], v8 offset:20480
v_mfma_f32_16x16x32_bf16 v[56:59], a[60:63], v[44:47], v[56:59]
buffer_load_dwordx4 v6, s[8:11], s50 offen offset:896 lds
v_mfma_f32_16x16x32_bf16 v[60:63], a[56:59], v[48:51], v[60:63]
ds_read_b128 v[40:43], v8 offset:22528
v_mfma_f32_16x16x32_bf16 v[64:67], a[60:63], v[48:51], v[64:67]
s_add_u32 m0, s46, 97280
s_waitcnt lgkmcnt(4)
v_mfma_f32_16x16x32_bf16 v[52:55], a[64:67], v[20:23], v[52:55]
ds_read_b128 v[44:47], v9 offset:20480
v_mfma_f32_16x16x32_bf16 v[56:59], a[68:71], v[20:23], v[56:59]
buffer_load_dwordx4 v6, s[8:11], s50 offen offset:1024 lds
v_mfma_f32_16x16x32_bf16 v[60:63], a[64:67], v[24:27], v[60:63]
ds_read_b128 v[48:51], v9 offset:22528
v_mfma_f32_16x16x32_bf16 v[64:67], a[68:71], v[24:27], v[64:67]
s_add_u32 m0, s46, 101248
s_waitcnt lgkmcnt(4)
v_mfma_f32_16x16x32_bf16 v[52:55], a[72:75], v[28:31], v[52:55]
ds_read_b128 v[20:23], v8 offset:24576
v_mfma_f32_16x16x32_bf16 v[56:59], a[76:79], v[28:31], v[56:59]
buffer_load_dwordx4 v6, s[8:11], s50 offen offset:1152 lds
v_mfma_f32_16x16x32_bf16 v[60:63], a[72:75], v[32:35], v[60:63]
ds_read_b128 v[24:27], v8 offset:26624
v_mfma_f32_16x16x32_bf16 v[64:67], a[76:79], v[32:35], v[64:67]
s_add_u32 m0, s46, 105216
s_waitcnt lgkmcnt(4)
v_mfma_f32_16x16x32_bf16 v[52:55], a[80:83], v[36:39], v[52:55]
ds_read_b128 v[28:31], v9 offset:24576
v_mfma_f32_16x16x32_bf16 v[56:59], a[84:87], v[36:39], v[56:59]
buffer_load_dwordx4 v6, s[8:11], s50 offen offset:1280 lds
v_mfma_f32_16x16x32_bf16 v[60:63], a[80:83], v[40:43], v[60:63]
ds_read_b128 v[32:35], v9 offset:26624
v_mfma_f32_16x16x32_bf16 v[64:67], a[84:87], v[40:43], v[64:67]
s_add_u32 m0, s46, 109184
s_waitcnt lgkmcnt(4)
v_mfma_f32_16x16x32_bf16 v[52:55], a[88:91], v[44:47], v[52:55]
ds_read_b128 v[36:39], v8 offset:28672
v_mfma_f32_16x16x32_bf16 v[56:59], a[92:95], v[44:47], v[56:59]
buffer_load_dwordx4 v6, s[8:11], s50 offen offset:1408 lds
v_mfma_f32_16x16x32_bf16 v[60:63], a[88:91], v[48:51], v[60:63]
ds_read_b128 v[40:43], v8 offset:30720
v_mfma_f32_16x16x32_bf16 v[64:67], a[92:95], v[48:51], v[64:67]
s_add_u32 m0, s46, 113152
s_waitcnt lgkmcnt(4)
v_mfma_f32_16x16x32_bf16 v[52:55], a[96:99], v[20:23], v[52:55]
ds_read_b128 v[44:47], v9 offset:28672
v_mfma_f32_16x16x32_bf16 v[56:59], a[100:103], v[20:23], v[56:59]
buffer_load_dwordx4 v6, s[8:11], s50 offen offset:1536 lds
v_mfma_f32_16x16x32_bf16 v[60:63], a[96:99], v[24:27], v[60:63]
ds_read_b128 v[48:51], v9 offset:30720
v_mfma_f32_16x16x32_bf16 v[64:67], a[100:103], v[24:27], v[64:67]
s_add_u32 m0, s46, 117120
s_waitcnt lgkmcnt(4)
v_mfma_f32_16x16x32_bf16 v[52:55], a[104:107], v[28:31], v[52:55]
ds_read_b128 v[20:23], v8 offset:32768
v_mfma_f32_16x16x32_bf16 v[56:59], a[108:111], v[28:31], v[56:59]
buffer_load_dwordx4 v6, s[8:11], s50 offen offset:1664 lds
v_mfma_f32_16x16x32_bf16 v[60:63], a[104:107], v[32:35], v[60:63]
ds_read_b128 v[24:27], v8 offset:34816
v_mfma_f32_16x16x32_bf16 v[64:67], a[108:111], v[32:35], v[64:67]
s_add_u32 m0, s46, 121088
s_waitcnt lgkmcnt(4)
v_mfma_f32_16x16x32_bf16 v[52:55], a[112:115], v[36:39], v[52:55]
ds_read_b128 v[28:31], v9 offset:32768
v_mfma_f32_16x16x32_bf16 v[56:59], a[116:119], v[36:39], v[56:59]
buffer_load_dwordx4 v6, s[8:11], s50 offen offset:1792 lds
v_mfma_f32_16x16x32_bf16 v[60:63], a[112:115], v[40:43], v[60:63]
ds_read_b128 v[32:35], v9 offset:34816
v_mfma_f32_16x16x32_bf16 v[64:67], a[116:119], v[40:43], v[64:67]
s_add_u32 m0, s46, 125056
s_waitcnt lgkmcnt(4)
v_mfma_f32_16x16x32_bf16 v[52:55], a[120:123], v[44:47], v[52:55]
ds_read_b128 v[36:39], v8 offset:36864
v_mfma_f32_16x16x32_bf16 v[56:59], a[124:127], v[44:47], v[56:59]
buffer_load_dwordx4 v6, s[8:11], s50 offen offset:1920 lds
v_mfma_f32_16x16x32_bf16 v[60:63], a[120:123], v[48:51], v[60:63]
ds_read_b128 v[40:43], v8 offset:38912
v_mfma_f32_16x16x32_bf16 v[64:67], a[124:127], v[48:51], v[64:67]
s_waitcnt lgkmcnt(4)
v_mfma_f32_16x16x32_bf16 v[52:55], a[128:131], v[20:23], v[52:55]
ds_read_b128 v[44:47], v9 offset:36864
v_mfma_f32_16x16x32_bf16 v[56:59], a[132:135], v[20:23], v[56:59]
v_mfma_f32_16x16x32_bf16 v[60:63], a[128:131], v[24:27], v[60:63]
ds_read_b128 v[48:51], v9 offset:38912
v_mfma_f32_16x16x32_bf16 v[64:67], a[132:135], v[24:27], v[64:67]
s_waitcnt lgkmcnt(4)
v_mfma_f32_16x16x32_bf16 v[52:55], a[136:139], v[28:31], v[52:55]
ds_read_b128 v[20:23], v8 offset:40960
v_mfma_f32_16x16x32_bf16 v[56:59], a[140:143], v[28:31], v[56:59]
v_mfma_f32_16x16x32_bf16 v[60:63], a[136:139], v[32:35], v[60:63]
ds_read_b128 v[24:27], v8 offset:43008
v_mfma_f32_16x16x32_bf16 v[64:67], a[140:143], v[32:35], v[64:67]
s_waitcnt lgkmcnt(4)
v_mfma_f32_16x16x32_bf16 v[52:55], a[144:147], v[36:39], v[52:55]
ds_read_b128 v[28:31], v9 offset:40960
v_mfma_f32_16x16x32_bf16 v[56:59], a[148:151], v[36:39], v[56:59]
v_mfma_f32_16x16x32_bf16 v[60:63], a[144:147], v[40:43], v[60:63]
ds_read_b128 v[32:35], v9 offset:43008
v_mfma_f32_16x16x32_bf16 v[64:67], a[148:151], v[40:43], v[64:67]
s_waitcnt lgkmcnt(4)
v_mfma_f32_16x16x32_bf16 v[52:55], a[152:155], v[44:47], v[52:55]
ds_read_b128 v[36:39], v8 offset:45056
v_mfma_f32_16x16x32_bf16 v[56:59], a[156:159], v[44:47], v[56:59]
v_mfma_f32_16x16x32_bf16 v[60:63], a[152:155], v[48:51], v[60:63]
ds_read_b128 v[40:43], v8 offset:47104
v_mfma_f32_16x16x32_bf16 v[64:67], a[156:159], v[48:51], v[64:67]
s_waitcnt lgkmcnt(4)
v_mfma_f32_16x16x32_bf16 v[52:55], a[160:163], v[20:23], v[52:55]
ds_read_b128 v[44:47], v9 offset:45056
v_mfma_f32_16x16x32_bf16 v[56:59], a[164:167], v[20:23], v[56:59]
v_mfma_f32_16x16x32_bf16 v[60:63], a[160:163], v[24:27], v[60:63]
ds_read_b128 v[48:51], v9 offset:47104
v_mfma_f32_16x16x32_bf16 v[64:67], a[164:167], v[24:27], v[64:67]
s_waitcnt lgkmcnt(4)
v_mfma_f32_16x16x32_bf16 v[52:55], a[168:171], v[28:31], v[52:55]
ds_read_b128 v[20:23], v8 offset:49152
v_mfma_f32_16x16x32_bf16 v[56:59], a[172:175], v[28:31], v[56:59]
v_mfma_f32_16x16x32_bf16 v[60:63], a[168:171], v[32:35], v[60:63]
ds_read_b128 v[24:27], v8 offset:51200
v_mfma_f32_16x16x32_bf16 v[64:67], a[172:175], v[32:35], v[64:67]
s_waitcnt lgkmcnt(4)
v_mfma_f32_16x16x32_bf16 v[52:55], a[176:179], v[36:39], v[52:55]
ds_read_b128 v[28:31], v9 offset:49152
v_mfma_f32_16x16x32_bf16 v[56:59], a[180:183], v[36:39], v[56:59]
v_mfma_f32_16x16x32_bf16 v[60:63], a[176:179], v[40:43], v[60:63]
ds_read_b128 v[32:35], v9 offset:51200
v_mfma_f32_16x16x32_bf16 v[64:67], a[180:183], v[40:43], v[64:67]
s_waitcnt lgkmcnt(4)
v_mfma_f32_16x16x32_bf16 v[52:55], a[184:187], v[44:47], v[52:55]
ds_read_b128 v[36:39], v8 offset:53248
v_mfma_f32_16x16x32_bf16 v[56:59], a[188:191], v[44:47], v[56:59]
v_mfma_f32_16x16x32_bf16 v[60:63], a[184:187], v[48:51], v[60:63]
ds_read_b128 v[40:43], v8 offset:55296
v_mfma_f32_16x16x32_bf16 v[64:67], a[188:191], v[48:51], v[64:67]
s_waitcnt lgkmcnt(4)
v_mfma_f32_16x16x32_bf16 v[52:55], a[192:195], v[20:23], v[52:55]
ds_read_b128 v[44:47], v9 offset:53248
v_mfma_f32_16x16x32_bf16 v[56:59], a[196:199], v[20:23], v[56:59]
v_mfma_f32_16x16x32_bf16 v[60:63], a[192:195], v[24:27], v[60:63]
ds_read_b128 v[48:51], v9 offset:55296
v_mfma_f32_16x16x32_bf16 v[64:67], a[196:199], v[24:27], v[64:67]
s_waitcnt lgkmcnt(4)
v_mfma_f32_16x16x32_bf16 v[52:55], a[200:203], v[28:31], v[52:55]
ds_read_b128 v[20:23], v8 offset:57344
v_mfma_f32_16x16x32_bf16 v[56:59], a[204:207], v[28:31], v[56:59]
v_mfma_f32_16x16x32_bf16 v[60:63], a[200:203], v[32:35], v[60:63]
ds_read_b128 v[24:27], v8 offset:59392
v_mfma_f32_16x16x32_bf16 v[64:67], a[204:207], v[32:35], v[64:67]
s_waitcnt lgkmcnt(4)
v_mfma_f32_16x16x32_bf16 v[52:55], a[208:211], v[36:39], v[52:55]
ds_read_b128 v[28:31], v9 offset:57344
v_mfma_f32_16x16x32_bf16 v[56:59], a[212:215], v[36:39], v[56:59]
v_mfma_f32_16x16x32_bf16 v[60:63], a[208:211], v[40:43], v[60:63]
ds_read_b128 v[32:35], v9 offset:59392
v_mfma_f32_16x16x32_bf16 v[64:67], a[212:215], v[40:43], v[64:67]
s_waitcnt lgkmcnt(4)
v_mfma_f32_16x16x32_bf16 v[52:55], a[216:219], v[44:47], v[52:55]
ds_read_b128 v[36:39], v8 offset:61440
v_mfma_f32_16x16x32_bf16 v[56:59], a[220:223], v[44:47], v[56:59]
v_mfma_f32_16x16x32_bf16 v[60:63], a[216:219], v[48:51], v[60:63]
ds_read_b128 v[40:43], v8 offset:63488
v_mfma_f32_16x16x32_bf16 v[64:67], a[220:223], v[48:51], v[64:67]
s_waitcnt lgkmcnt(4)
v_mfma_f32_16x16x32_bf16 v[52:55], a[224:227], v[20:23], v[52:55]
ds_read_b128 v[44:47], v9 offset:61440
v_mfma_f32_16x16x32_bf16 v[56:59], a[228:231], v[20:23], v[56:59]
v_mfma_f32_16x16x32_bf16 v[60:63], a[224:227], v[24:27], v[60:63]
ds_read_b128 v[48:51], v9 offset:63488
v_mfma_f32_16x16x32_bf16 v[64:67], a[228:231], v[24:27], v[64:67]
s_waitcnt lgkmcnt(5)
v_mfma_f32_16x16x32_bf16 v[52:55], a[232:235], v[28:31], v[52:55]
v_mfma_f32_16x16x32_bf16 v[56:59], a[236:239], v[28:31], v[56:59]
s_waitcnt lgkmcnt(4)
v_mfma_f32_16x16x32_bf16 v[60:63], a[232:235], v[32:35], v[60:63]
v_mfma_f32_16x16x32_bf16 v[64:67], a[236:239], v[32:35], v[64:67]
s_waitcnt lgkmcnt(3)
v_mfma_f32_16x16x32_bf16 v[52:55], a[240:243], v[36:39], v[52:55]
v_mfma_f32_16x16x32_bf16 v[56:59], a[244:247], v[36:39], v[56:59]
s_waitcnt lgkmcnt(2)
v_mfma_f32_16x16x32_bf16 v[60:63], a[240:243], v[40:43], v[60:63]
v_mfma_f32_16x16x32_bf16 v[64:67], a[244:247], v[40:43], v[64:67]
s_waitcnt lgkmcnt(1)
v_mfma_f32_16x16x32_bf16 v[52:55], a[248:251], v[44:47], v[52:55]
v_mfma_f32_16x16x32_bf16 v[56:59], a[252:255], v[44:47], v[56:59]
s_waitcnt lgkmcnt(0)
v_mfma_f32_16x16x32_bf16 v[60:63], a[248:251], v[48:51], v[60:63]
v_mfma_f32_16x16x32_bf16 v[64:67], a[252:255], v[48:51], v[64:67]
s_waitcnt vmcnt(0)
s_nop 9
mega_kernel_q_loop:
s_barrier
v_cvt_pk_bf16_f32 v84, v52, v53
v_cvt_pk_bf16_f32 v85, v54, v55
v_cvt_pk_bf16_f32 v86, v56, v57
v_cvt_pk_bf16_f32 v87, v58, v59
v_cvt_pk_bf16_f32 v88, v60, v61
v_cvt_pk_bf16_f32 v89, v62, v63
v_cvt_pk_bf16_f32 v90, v64, v65
v_cvt_pk_bf16_f32 v91, v66, v67
ds_write_b128 v101, v[84:87]
ds_write_b128 v101, v[88:91] offset:1024
s_cmp_gt_i32 s55, s42
s_cbranch_scc1 mega_kernel_q_kv1k
mega_kernel_q_kv1w:
buffer_load_dword v2, v99, s[84:87], 0 offen sc1
s_waitcnt vmcnt(0)
v_min_i32_dpp v2, v2, v2 quad_perm:[1,0,3,2] row_mask:0xf bank_mask:0xf
s_nop 1
v_min_i32_dpp v2, v2, v2 quad_perm:[2,3,0,1] row_mask:0xf bank_mask:0xf
s_nop 1
v_min_i32_dpp v2, v2, v2 row_ror:4 row_mask:0xf bank_mask:0xf
s_nop 0
v_readfirstlane_b32 s55, v2
s_cmp_gt_i32 s55, s42
s_cbranch_scc1 mega_kernel_q_kv1k
s_sleep 4
s_branch mega_kernel_q_kv1w
mega_kernel_q_kv1k:
s_add_u32 s51, s47, s42
s_bfe_u32 s57, s51, 0x40002
s_lshl_b32 s57, s57, 14
s_and_b32 s66, s51, 3
s_lshl_b32 s66, s66, 11
s_add_u32 s66, s66, s57
s_add_u32 s66, s66, s58
s_add_u32 s67, s66, 33554432
s_bfe_u32 s57, s51, 0x30003
s_lshl_b32 s57, s57, 14
s_and_b32 s68, s51, 7
s_lshl_b32 s68, s68, 10
s_add_u32 s68, s68, s57
s_add_u32 s68, s68, s59
s_add_u32 s50, s42, 2
s_min_u32 s50, s50, 63
s_lshl_b32 s50, s50, 16
s_cmp_gt_i32 s56, s42
s_cselect_b32 s30, 1, 0
ds_read_b128 v[20:23], v10 offset:0
ds_read_b128 v[24:27], v10 offset:2048
ds_read_b128 v[28:31], v11 offset:0
ds_read_b128 v[32:35], v11 offset:2048
ds_read_b128 v[36:39], v10 offset:4096
ds_read_b128 v[40:43], v10 offset:6144
s_add_u32 m0, s60, 0
s_waitcnt lgkmcnt(4)
v_mfma_f32_16x16x32_bf16 v[52:55], a[0:3], v[20:23], 0
ds_read_b128 v[44:47], v11 offset:4096
v_mfma_f32_16x16x32_bf16 v[56:59], a[4:7], v[20:23], 0
buffer_load_dwordx4 v5, s[84:87], s66 offen offset:0 sc1 lds
v_mfma_f32_16x16x32_bf16 v[60:63], a[0:3], v[24:27], 0
ds_read_b128 v[48:51], v11 offset:6144
v_mfma_f32_16x16x32_bf16 v[64:67], a[4:7], v[24:27], 0
s_add_u32 m0, s60, 0
s_waitcnt lgkmcnt(4)
v_mfma_f32_16x16x32_bf16 v[52:55], a[8:11], v[28:31], v[52:55]
ds_read_b128 v[20:23], v10 offset:8192
v_mfma_f32_16x16x32_bf16 v[56:59], a[12:15], v[28:31], v[56:59]
buffer_load_dwordx4 v5, s[84:87], s66 offen offset:1024 sc1 lds
v_mfma_f32_16x16x32_bf16 v[60:63], a[8:11], v[32:35], v[60:63]
ds_read_b128 v[24:27], v10 offset:10240
v_mfma_f32_16x16x32_bf16 v[64:67], a[12:15], v[32:35], v[64:67]
s_add_u32 m0, s60, 8192
s_waitcnt lgkmcnt(4)
v_mfma_f32_16x16x32_bf16 v[52:55], a[16:19], v[36:39], v[52:55]
ds_read_b128 v[28:31], v11 offset:8192
v_mfma_f32_16x16x32_bf16 v[56:59], a[20:23], v[36:39], v[56:59]
buffer_load_dwordx4 v5, s[84:87], s67 offen offset:0 sc1 lds
v_mfma_f32_16x16x32_bf16 v[60:63], a[16:19], v[40:43], v[60:63]
ds_read_b128 v[32:35], v11 offset:10240
v_mfma_f32_16x16x32_bf16 v[64:67], a[20:23], v[40:43], v[64:67]
s_add_u32 m0, s60, 8192
s_waitcnt lgkmcnt(4)
v_mfma_f32_16x16x32_bf16 v[52:55], a[24:27], v[44:47], v[52:55]
ds_read_b128 v[36:39], v10 offset:12288
v_mfma_f32_16x16x32_bf16 v[56:59], a[28:31], v[44:47], v[56:59]
buffer_load_dwordx4 v5, s[84:87], s67 offen offset:1024 sc1 lds
v_mfma_f32_16x16x32_bf16 v[60:63], a[24:27], v[48:51], v[60:63]
ds_read_b128 v[40:43], v10 offset:14336
v_mfma_f32_16x16x32_bf16 v[64:67], a[28:31], v[48:51], v[64:67]
s_waitcnt lgkmcnt(4)
v_mfma_f32_16x16x32_bf16 v[52:55], a[32:35], v[20:23], v[52:55]
ds_read_b128 v[44:47], v11 offset:12288
v_mfma_f32_16x16x32_bf16 v[56:59], a[36:39], v[20:23], v[56:59]
s_cmp_eq_u32 s30, 1
s_cbranch_scc0 mega_kernel_q_ke1
s_mov_b32 m0, s61
s_nop 0
buffer_load_dwordx4 v5, s[84:87], s68 offen sc1 lds
mega_kernel_q_ke1:
v_mfma_f32_16x16x32_bf16 v[60:63], a[32:35], v[24:27], v[60:63]
ds_read_b128 v[48:51], v11 offset:14336
v_mfma_f32_16x16x32_bf16 v[64:67], a[36:39], v[24:27], v[64:67]
s_add_u32 m0, s46, 0
s_waitcnt lgkmcnt(4)
v_mfma_f32_16x16x32_bf16 v[52:55], a[40:43], v[28:31], v[52:55]
ds_read_b128 v[20:23], v10 offset:16384
v_mfma_f32_16x16x32_bf16 v[56:59], a[44:47], v[28:31], v[56:59]
buffer_load_dwordx4 v6, s[8:11], s50 offen offset:0 lds
v_mfma_f32_16x16x32_bf16 v[60:63], a[40:43], v[32:35], v[60:63]
ds_read_b128 v[24:27], v10 offset:18432
v_mfma_f32_16x16x32_bf16 v[64:67], a[44:47], v[32:35], v[64:67]
s_add_u32 m0, s46, 3968
s_waitcnt lgkmcnt(4)
v_mfma_f32_16x16x32_bf16 v[52:55], a[48:51], v[36:39], v[52:55]
ds_read_b128 v[28:31], v11 offset:16384
v_mfma_f32_16x16x32_bf16 v[56:59], a[52:55], v[36:39], v[56:59]
buffer_load_dwordx4 v6, s[8:11], s50 offen offset:128 lds
v_mfma_f32_16x16x32_bf16 v[60:63], a[48:51], v[40:43], v[60:63]
ds_read_b128 v[32:35], v11 offset:18432
v_mfma_f32_16x16x32_bf16 v[64:67], a[52:55], v[40:43], v[64:67]
s_add_u32 m0, s46, 7936
s_waitcnt lgkmcnt(4)
v_mfma_f32_16x16x32_bf16 v[52:55], a[56:59], v[44:47], v[52:55]
ds_read_b128 v[36:39], v10 offset:20480
v_mfma_f32_16x16x32_bf16 v[56:59], a[60:63], v[44:47], v[56:59]
buffer_load_dwordx4 v6, s[8:11], s50 offen offset:256 lds
v_mfma_f32_16x16x32_bf16 v[60:63], a[56:59], v[48:51], v[60:63]
ds_read_b128 v[40:43], v10 offset:22528
v_mfma_f32_16x16x32_bf16 v[64:67], a[60:63], v[48:51], v[64:67]
s_add_u32 m0, s46, 11904
s_waitcnt lgkmcnt(4)
v_mfma_f32_16x16x32_bf16 v[52:55], a[64:67], v[20:23], v[52:55]
ds_read_b128 v[44:47], v11 offset:20480
v_mfma_f32_16x16x32_bf16 v[56:59], a[68:71], v[20:23], v[56:59]
buffer_load_dwordx4 v6, s[8:11], s50 offen offset:384 lds
v_mfma_f32_16x16x32_bf16 v[60:63], a[64:67], v[24:27], v[60:63]
ds_read_b128 v[48:51], v11 offset:22528
v_mfma_f32_16x16x32_bf16 v[64:67], a[68:71], v[24:27], v[64:67]
s_add_u32 m0, s46, 15872
s_waitcnt lgkmcnt(4)
v_mfma_f32_16x16x32_bf16 v[52:55], a[72:75], v[28:31], v[52:55]
ds_read_b128 v[20:23], v10 offset:24576
v_mfma_f32_16x16x32_bf16 v[56:59], a[76:79], v[28:31], v[56:59]
buffer_load_dwordx4 v6, s[8:11], s50 offen offset:512 lds
v_mfma_f32_16x16x32_bf16 v[60:63], a[72:75], v[32:35], v[60:63]
ds_read_b128 v[24:27], v10 offset:26624
v_mfma_f32_16x16x32_bf16 v[64:67], a[76:79], v[32:35], v[64:67]
s_add_u32 m0, s46, 19840
s_waitcnt lgkmcnt(4)
v_mfma_f32_16x16x32_bf16 v[52:55], a[80:83], v[36:39], v[52:55]
ds_read_b128 v[28:31], v11 offset:24576
v_mfma_f32_16x16x32_bf16 v[56:59], a[84:87], v[36:39], v[56:59]
buffer_load_dwordx4 v6, s[8:11], s50 offen offset:640 lds
v_mfma_f32_16x16x32_bf16 v[60:63], a[80:83], v[40:43], v[60:63]
ds_read_b128 v[32:35], v11 offset:26624
v_mfma_f32_16x16x32_bf16 v[64:67], a[84:87], v[40:43], v[64:67]
s_add_u32 m0, s46, 23808
s_waitcnt lgkmcnt(4)
v_mfma_f32_16x16x32_bf16 v[52:55], a[88:91], v[44:47], v[52:55]
ds_read_b128 v[36:39], v10 offset:28672
v_mfma_f32_16x16x32_bf16 v[56:59], a[92:95], v[44:47], v[56:59]
buffer_load_dwordx4 v6, s[8:11], s50 offen offset:768 lds
v_mfma_f32_16x16x32_bf16 v[60:63], a[88:91], v[48:51], v[60:63]
ds_read_b128 v[40:43], v10 offset:30720
v_mfma_f32_16x16x32_bf16 v[64:67], a[92:95], v[48:51], v[64:67]
s_add_u32 m0, s46, 27776
s_waitcnt lgkmcnt(4)
v_mfma_f32_16x16x32_bf16 v[52:55], a[96:99], v[20:23], v[52:55]
ds_read_b128 v[44:47], v11 offset:28672
v_mfma_f32_16x16x32_bf16 v[56:59], a[100:103], v[20:23], v[56:59]
buffer_load_dwordx4 v6, s[8:11], s50 offen offset:896 lds
v_mfma_f32_16x16x32_bf16 v[60:63], a[96:99], v[24:27], v[60:63]
ds_read_b128 v[48:51], v11 offset:30720
v_mfma_f32_16x16x32_bf16 v[64:67], a[100:103], v[24:27], v[64:67]
s_add_u32 m0, s46, 31744
s_waitcnt lgkmcnt(4)
v_mfma_f32_16x16x32_bf16 v[52:55], a[104:107], v[28:31], v[52:55]
ds_read_b128 v[20:23], v10 offset:32768
v_mfma_f32_16x16x32_bf16 v[56:59], a[108:111], v[28:31], v[56:59]
buffer_load_dwordx4 v6, s[8:11], s50 offen offset:1024 lds
v_mfma_f32_16x16x32_bf16 v[60:63], a[104:107], v[32:35], v[60:63]
ds_read_b128 v[24:27], v10 offset:34816
v_mfma_f32_16x16x32_bf16 v[64:67], a[108:111], v[32:35], v[64:67]
s_waitcnt vmcnt(13)
v_mov_b32 v17, s42
s_mov_b64 exec, 1
buffer_store_dword v17, v16, s[84:87], s49 offen sc1
s_mov_b64 exec, -1
s_add_u32 m0, s46, 35712
s_waitcnt lgkmcnt(4)
v_mfma_f32_16x16x32_bf16 v[52:55], a[112:115], v[36:39], v[52:55]
ds_read_b128 v[28:31], v11 offset:32768
v_mfma_f32_16x16x32_bf16 v[56:59], a[116:119], v[36:39], v[56:59]
buffer_load_dwordx4 v6, s[8:11], s50 offen offset:1152 lds
v_mfma_f32_16x16x32_bf16 v[60:63], a[112:115], v[40:43], v[60:63]
ds_read_b128 v[32:35], v11 offset:34816
v_mfma_f32_16x16x32_bf16 v[64:67], a[116:119], v[40:43], v[64:67]
v_mov_b32 v100, 0
s_mov_b64 exec, 1
buffer_atomic_add v100, v16, s[84:87], s62 offen sc0 sc1
s_mov_b64 exec, -1
s_add_u32 m0, s46, 39680
s_waitcnt lgkmcnt(4)
v_mfma_f32_16x16x32_bf16 v[52:55], a[120:123], v[44:47], v[52:55]
ds_read_b128 v[36:39], v10 offset:36864
v_mfma_f32_16x16x32_bf16 v[56:59], a[124:127], v[44:47], v[56:59]
buffer_load_dwordx4 v6, s[8:11], s50 offen offset:1280 lds
v_mfma_f32_16x16x32_bf16 v[60:63], a[120:123], v[48:51], v[60:63]
ds_read_b128 v[40:43], v10 offset:38912
v_mfma_f32_16x16x32_bf16 v[64:67], a[124:127], v[48:51], v[64:67]
s_add_u32 m0, s46, 43648
s_waitcnt lgkmcnt(4)
v_mfma_f32_16x16x32_bf16 v[52:55], a[128:131], v[20:23], v[52:55]
ds_read_b128 v[44:47], v11 offset:36864
v_mfma_f32_16x16x32_bf16 v[56:59], a[132:135], v[20:23], v[56:59]
buffer_load_dwordx4 v6, s[8:11], s50 offen offset:1408 lds
v_mfma_f32_16x16x32_bf16 v[60:63], a[128:131], v[24:27], v[60:63]
ds_read_b128 v[48:51], v11 offset:38912
v_mfma_f32_16x16x32_bf16 v[64:67], a[132:135], v[24:27], v[64:67]
s_add_u32 m0, s46, 47616
s_waitcnt lgkmcnt(4)
v_mfma_f32_16x16x32_bf16 v[52:55], a[136:139], v[28:31], v[52:55]
ds_read_b128 v[20:23], v10 offset:40960
v_mfma_f32_16x16x32_bf16 v[56:59], a[140:143], v[28:31], v[56:59]
buffer_load_dwordx4 v6, s[8:11], s50 offen offset:1536 lds
v_mfma_f32_16x16x32_bf16 v[60:63], a[136:139], v[32:35], v[60:63]
ds_read_b128 v[24:27], v10 offset:43008
v_mfma_f32_16x16x32_bf16 v[64:67], a[140:143], v[32:35], v[64:67]
s_add_u32 m0, s46, 51584
s_waitcnt lgkmcnt(4)
v_mfma_f32_16x16x32_bf16 v[52:55], a[144:147], v[36:39], v[52:55]
ds_read_b128 v[28:31], v11 offset:40960
v_mfma_f32_16x16x32_bf16 v[56:59], a[148:151], v[36:39], v[56:59]
buffer_load_dwordx4 v6, s[8:11], s50 offen offset:1664 lds
v_mfma_f32_16x16x32_bf16 v[60:63], a[144:147], v[40:43], v[60:63]
ds_read_b128 v[32:35], v11 offset:43008
v_mfma_f32_16x16x32_bf16 v[64:67], a[148:151], v[40:43], v[64:67]
s_add_u32 m0, s46, 55552
s_waitcnt lgkmcnt(4)
v_mfma_f32_16x16x32_bf16 v[52:55], a[152:155], v[44:47], v[52:55]
ds_read_b128 v[36:39], v10 offset:45056
v_mfma_f32_16x16x32_bf16 v[56:59], a[156:159], v[44:47], v[56:59]
buffer_load_dwordx4 v6, s[8:11], s50 offen offset:1792 lds
v_mfma_f32_16x16x32_bf16 v[60:63], a[152:155], v[48:51], v[60:63]
ds_read_b128 v[40:43], v10 offset:47104
v_mfma_f32_16x16x32_bf16 v[64:67], a[156:159], v[48:51], v[64:67]
s_add_u32 m0, s46, 59520
s_waitcnt lgkmcnt(4)
v_mfma_f32_16x16x32_bf16 v[52:55], a[160:163], v[20:23], v[52:55]
ds_read_b128 v[44:47], v11 offset:45056
v_mfma_f32_16x16x32_bf16 v[56:59], a[164:167], v[20:23], v[56:59]
buffer_load_dwordx4 v6, s[8:11], s50 offen offset:1920 lds
v_mfma_f32_16x16x32_bf16 v[60:63], a[160:163], v[24:27], v[60:63]
ds_read_b128 v[48:51], v11 offset:47104
v_mfma_f32_16x16x32_bf16 v[64:67], a[164:167], v[24:27], v[64:67]
s_waitcnt lgkmcnt(4)
v_mfma_f32_16x16x32_bf16 v[52:55], a[168:171], v[28:31], v[52:55]
ds_read_b128 v[20:23], v10 offset:49152
v_mfma_f32_16x16x32_bf16 v[56:59], a[172:175], v[28:31], v[56:59]
v_mfma_f32_16x16x32_bf16 v[60:63], a[168:171], v[32:35], v[60:63]
ds_read_b128 v[24:27], v10 offset:51200
v_mfma_f32_16x16x32_bf16 v[64:67], a[172:175], v[32:35], v[64:67]
s_waitcnt lgkmcnt(4)
v_mfma_f32_16x16x32_bf16 v[52:55], a[176:179], v[36:39], v[52:55]
ds_read_b128 v[28:31], v11 offset:49152
v_mfma_f32_16x16x32_bf16 v[56:59], a[180:183], v[36:39], v[56:59]
v_mfma_f32_16x16x32_bf16 v[60:63], a[176:179], v[40:43], v[60:63]
ds_read_b128 v[32:35], v11 offset:51200
v_mfma_f32_16x16x32_bf16 v[64:67], a[180:183], v[40:43], v[64:67]
s_waitcnt lgkmcnt(4)
v_mfma_f32_16x16x32_bf16 v[52:55], a[184:187], v[44:47], v[52:55]
ds_read_b128 v[36:39], v10 offset:53248
v_mfma_f32_16x16x32_bf16 v[56:59], a[188:191], v[44:47], v[56:59]
v_mfma_f32_16x16x32_bf16 v[60:63], a[184:187], v[48:51], v[60:63]
ds_read_b128 v[40:43], v10 offset:55296
v_mfma_f32_16x16x32_bf16 v[64:67], a[188:191], v[48:51], v[64:67]
s_waitcnt lgkmcnt(4)
v_mfma_f32_16x16x32_bf16 v[52:55], a[192:195], v[20:23], v[52:55]
ds_read_b128 v[44:47], v11 offset:53248
v_mfma_f32_16x16x32_bf16 v[56:59], a[196:199], v[20:23], v[56:59]
v_mfma_f32_16x16x32_bf16 v[60:63], a[192:195], v[24:27], v[60:63]
ds_read_b128 v[48:51], v11 offset:55296
v_mfma_f32_16x16x32_bf16 v[64:67], a[196:199], v[24:27], v[64:67]
s_waitcnt lgkmcnt(4)
v_mfma_f32_16x16x32_bf16 v[52:55], a[200:203], v[28:31], v[52:55]
ds_read_b128 v[20:23], v10 offset:57344
v_mfma_f32_16x16x32_bf16 v[56:59], a[204:207], v[28:31], v[56:59]
v_mfma_f32_16x16x32_bf16 v[60:63], a[200:203], v[32:35], v[60:63]
ds_read_b128 v[24:27], v10 offset:59392
v_mfma_f32_16x16x32_bf16 v[64:67], a[204:207], v[32:35], v[64:67]
s_waitcnt lgkmcnt(4)
v_mfma_f32_16x16x32_bf16 v[52:55], a[208:211], v[36:39], v[52:55]
ds_read_b128 v[28:31], v11 offset:57344
v_mfma_f32_16x16x32_bf16 v[56:59], a[212:215], v[36:39], v[56:59]
v_mfma_f32_16x16x32_bf16 v[60:63], a[208:211], v[40:43], v[60:63]
ds_read_b128 v[32:35], v11 offset:59392
v_mfma_f32_16x16x32_bf16 v[64:67], a[212:215], v[40:43], v[64:67]
s_waitcnt lgkmcnt(4)
v_mfma_f32_16x16x32_bf16 v[52:55], a[216:219], v[44:47], v[52:55]
ds_read_b128 v[36:39], v10 offset:61440
v_mfma_f32_16x16x32_bf16 v[56:59], a[220:223], v[44:47], v[56:59]
v_mfma_f32_16x16x32_bf16 v[60:63], a[216:219], v[48:51], v[60:63]
ds_read_b128 v[40:43], v10 offset:63488
v_mfma_f32_16x16x32_bf16 v[64:67], a[220:223], v[48:51], v[64:67]
s_waitcnt lgkmcnt(4)
v_mfma_f32_16x16x32_bf16 v[52:55], a[224:227], v[20:23], v[52:55]
ds_read_b128 v[44:47], v11 offset:61440
v_mfma_f32_16x16x32_bf16 v[56:59], a[228:231], v[20:23], v[56:59]
v_mfma_f32_16x16x32_bf16 v[60:63], a[224:227], v[24:27], v[60:63]
ds_read_b128 v[48:51], v11 offset:63488
v_mfma_f32_16x16x32_bf16 v[64:67], a[228:231], v[24:27], v[64:67]
s_waitcnt lgkmcnt(5)
v_mfma_f32_16x16x32_bf16 v[52:55], a[232:235], v[28:31], v[52:55]
v_mfma_f32_16x16x32_bf16 v[56:59], a[236:239], v[28:31], v[56:59]
s_waitcnt vmcnt(6)
v_readfirstlane_b32 s56, v100
s_cmp_eq_u32 s30, 1
s_cbranch_scc1 mega_kernel_q_kf1
s_cmp_gt_i32 s56, s42
s_cbranch_scc0 mega_kernel_q_kf1
s_mov_b32 s30, 1
s_mov_b32 m0, s61
s_nop 0
buffer_load_dwordx4 v5, s[84:87], s68 offen sc1 lds
mega_kernel_q_kf1:
s_waitcnt lgkmcnt(4)
v_mfma_f32_16x16x32_bf16 v[60:63], a[232:235], v[32:35], v[60:63]
v_mfma_f32_16x16x32_bf16 v[64:67], a[236:239], v[32:35], v[64:67]
s_waitcnt lgkmcnt(3)
v_mfma_f32_16x16x32_bf16 v[52:55], a[240:243], v[36:39], v[52:55]
v_mfma_f32_16x16x32_bf16 v[56:59], a[244:247], v[36:39], v[56:59]
s_waitcnt lgkmcnt(2)
v_mfma_f32_16x16x32_bf16 v[60:63], a[240:243], v[40:43], v[60:63]
v_mfma_f32_16x16x32_bf16 v[64:67], a[244:247], v[40:43], v[64:67]
s_waitcnt lgkmcnt(1)
v_mfma_f32_16x16x32_bf16 v[52:55], a[248:251], v[44:47], v[52:55]
v_mfma_f32_16x16x32_bf16 v[56:59], a[252:255], v[44:47], v[56:59]
s_waitcnt lgkmcnt(0)
v_mfma_f32_16x16x32_bf16 v[60:63], a[248:251], v[48:51], v[60:63]
v_mfma_f32_16x16x32_bf16 v[64:67], a[252:255], v[48:51], v[64:67]
s_cmp_eq_u32 s30, 1
s_cbranch_scc1 mega_kernel_q_kl1
mega_kernel_q_kw1:
v_mov_b32 v100, 0
s_mov_b64 exec, 1
buffer_atomic_add v100, v16, s[84:87], s62 offen sc0 sc1
s_mov_b64 exec, -1
s_waitcnt vmcnt(0)
v_readfirstlane_b32 s56, v100
s_cmp_gt_i32 s56, s42
s_cbranch_scc0 mega_kernel_q_kw1
s_mov_b32 m0, s61
s_nop 0
buffer_load_dwordx4 v5, s[84:87], s68 offen sc1 lds
mega_kernel_q_kl1:
s_waitcnt lgkmcnt(0) vmcnt(0)
s_barrier
ds_read_b128 v[184:187], v102 offset:0
ds_read_b128 v[112:115], v103 offset:0
ds_read_b128 v[128:131], v103 offset:1024
ds_read_b128 v[188:191], v102 offset:2048
ds_read_b128 v[116:119], v103 offset:2048
ds_read_b128 v[132:135], v103 offset:3072
ds_read_b128 v[192:195], v102 offset:4096
ds_read_b128 v[120:123], v103 offset:4096
ds_read_b128 v[136:139], v103 offset:5120
ds_read_b128 v[196:199], v102 offset:6144
ds_read_b128 v[124:127], v103 offset:6144
ds_read_b128 v[140:143], v103 offset:7168
s_waitcnt lgkmcnt(9)
v_mfma_f32_16x16x32_bf16 v[200:203], v[112:115], v[184:187], 0
v_mfma_f32_16x16x32_bf16 v[204:207], v[128:131], v[184:187], 0
ds_read_b128 v[160:163], v94 offset:0
s_waitcnt lgkmcnt(7)
v_mfma_f32_16x16x32_bf16 v[200:203], v[116:119], v[188:191], v[200:203]
v_mfma_f32_16x16x32_bf16 v[204:207], v[132:135], v[188:191], v[204:207]
ds_read_b128 v[164:167], v94 offset:1024
s_waitcnt lgkmcnt(5)
v_mfma_f32_16x16x32_bf16 v[200:203], v[120:123], v[192:195], v[200:203]
v_mfma_f32_16x16x32_bf16 v[204:207], v[136:139], v[192:195], v[204:207]
ds_read_b128 v[168:171], v94 offset:2048
s_waitcnt lgkmcnt(3)
v_mfma_f32_16x16x32_bf16 v[200:203], v[124:127], v[196:199], v[200:203]
v_mfma_f32_16x16x32_bf16 v[204:207], v[140:143], v[196:199], v[204:207]
ds_read_b128 v[172:175], v94 offset:3072
s_waitcnt lgkmcnt(3)
v_mfma_f32_16x16x32_bf16 v[208:211], v[160:163], v[184:187], 0
ds_read_b128 v[144:147], v240 offset:0
ds_read_b64 v[176:177], v95 offset:0
s_waitcnt lgkmcnt(4)
v_mfma_f32_16x16x32_bf16 v[208:211], v[164:167], v[188:191], v[208:211]
ds_read_b128 v[148:151], v240 offset:1024
ds_read_b64 v[178:179], v95 offset:256
s_waitcnt lgkmcnt(5)
v_mfma_f32_16x16x32_bf16 v[208:211], v[168:171], v[192:195], v[208:211]
ds_read_b128 v[152:155], v240 offset:2048
ds_read_b64 v[180:181], v95 offset:1024
s_waitcnt lgkmcnt(6)
v_mfma_f32_16x16x32_bf16 v[208:211], v[172:175], v[196:199], v[208:211]
ds_read_b128 v[156:159], v240 offset:3072
ds_read_b64 v[182:183], v95 offset:1280
s_nop 3
v_cndmask_b32 v200, v200, v97, s[12:13]
v_cndmask_b32 v201, v201, v97, s[14:15]
v_cndmask_b32 v202, v202, v97, s[16:17]
v_cndmask_b32 v203, v203, v97, s[18:19]
v_cndmask_b32 v204, v204, v97, s[20:21]
v_cndmask_b32 v205, v205, v97, s[22:23]
v_cndmask_b32 v206, v206, v97, s[24:25]
v_cndmask_b32 v207, v207, v97, s[26:27]
v_cndmask_b32 v208, v208, v97, s[28:29]
v_cndmask_b32 v209, v209, v97, s[28:29]
v_cndmask_b32 v210, v210, v97, s[28:29]
v_cndmask_b32 v211, v211, v97, s[28:29]
v_max3_f32 v236, v200, v201, v202
v_max3_f32 v236, v236, v203, v204
v_max3_f32 v236, v236, v205, v206
v_max3_f32 v236, v236, v207, v208
v_max3_f32 v236, v236, v209, v210
v_max_f32 v237, v236, v211
v_max_f32 v236, v236, v211
s_nop 1
v_permlane16_swap_b32 v236, v237
s_nop 0
v_max_f32 v238, v236, v237
v_max_f32 v239, v236, v237
s_nop 1
v_permlane32_swap_b32 v238, v239
s_nop 0
v_max_f32 v236, v238, v239
v_mul_f32 v236, s54, v236
v_fma_f32 v200, v200, s54, -v236
v_fma_f32 v201, v201, s54, -v236
v_fma_f32 v202, v202, s54, -v236
v_fma_f32 v203, v203, s54, -v236
v_fma_f32 v204, v204, s54, -v236
v_fma_f32 v205, v205, s54, -v236
v_fma_f32 v206, v206, s54, -v236
v_fma_f32 v207, v207, s54, -v236
v_fma_f32 v208, v208, s54, -v236
v_fma_f32 v209, v209, s54, -v236
v_fma_f32 v210, v210, s54, -v236
v_fma_f32 v211, v211, s54, -v236
v_exp_f32 v200, v200
v_exp_f32 v201, v201
v_exp_f32 v202, v202
v_exp_f32 v203, v203
v_exp_f32 v204, v204
v_exp_f32 v205, v205
v_exp_f32 v206, v206
v_exp_f32 v207, v207
v_exp_f32 v208, v208
v_exp_f32 v209, v209
v_exp_f32 v210, v210
v_exp_f32 v211, v211
s_nop 0
v_cvt_pk_bf16_f32 v212, v200, v201
v_cvt_pk_bf16_f32 v213, v202, v203
v_cvt_pk_bf16_f32 v214, v204, v205
v_cvt_pk_bf16_f32 v215, v206, v207
v_cvt_pk_bf16_f32 v216, v208, v209
v_cvt_pk_bf16_f32 v217, v210, v211
s_waitcnt lgkmcnt(0)
s_nop 0
v_mfma_f32_16x16x32_bf16 v[108:111], v[104:107], v[212:215], 0
v_mfma_f32_16x16x32_bf16 v[220:223], v[144:147], v[212:215], 0
v_mfma_f32_16x16x32_bf16 v[224:227], v[148:151], v[212:215], 0
v_mfma_f32_16x16x32_bf16 v[228:231], v[152:155], v[212:215], 0
v_mfma_f32_16x16x32_bf16 v[232:235], v[156:159], v[212:215], 0
v_mfma_f32_16x16x16_bf16 v[108:111], v[104:105], v[216:217], v[108:111]
v_mfma_f32_16x16x16_bf16 v[220:223], v[176:177], v[216:217], v[220:223]
v_mfma_f32_16x16x16_bf16 v[224:227], v[178:179], v[216:217], v[224:227]
v_mfma_f32_16x16x16_bf16 v[228:231], v[180:181], v[216:217], v[228:231]
v_mfma_f32_16x16x16_bf16 v[232:235], v[182:183], v[216:217], v[232:235]
s_lshl_b32 s51, s42, 18
s_nop 2
v_rcp_f32 v238, v108
v_rcp_f32 v239, v109
s_nop 1
v_pk_mul_f32 v[220:221], v[220:221], v[238:239]
v_pk_mul_f32 v[222:223], v[222:223], v[238:239]
v_pk_mul_f32 v[224:225], v[224:225], v[238:239]
v_pk_mul_f32 v[226:227], v[226:227], v[238:239]
v_pk_mul_f32 v[228:229], v[228:229], v[238:239]
v_pk_mul_f32 v[230:231], v[230:231], v[238:239]
v_pk_mul_f32 v[232:233], v[232:233], v[238:239]
v_pk_mul_f32 v[234:235], v[234:235], v[238:239]
v_cvt_pk_bf16_f32 v200, v220, v221
v_cvt_pk_bf16_f32 v201, v222, v223
v_cvt_pk_bf16_f32 v202, v224, v225
v_cvt_pk_bf16_f32 v203, v226, v227
v_cvt_pk_bf16_f32 v204, v228, v229
v_cvt_pk_bf16_f32 v205, v230, v231
v_cvt_pk_bf16_f32 v206, v232, v233
v_cvt_pk_bf16_f32 v207, v234, v235
buffer_store_dwordx4 v[200:203], v96, s[84:87], s51 offen sc1
buffer_store_dwordx4 v[204:207], v96, s[84:87], s51 offen offset:2048 sc1
s_add_u32 s42, s42, 1
s_cmp_eq_u32 s42, 63
s_cbranch_scc1 mega_kernel_q_last
s_barrier
v_cvt_pk_bf16_f32 v84, v52, v53
v_cvt_pk_bf16_f32 v85, v54, v55
v_cvt_pk_bf16_f32 v86, v56, v57
v_cvt_pk_bf16_f32 v87, v58, v59
v_cvt_pk_bf16_f32 v88, v60, v61
v_cvt_pk_bf16_f32 v89, v62, v63
v_cvt_pk_bf16_f32 v90, v64, v65
v_cvt_pk_bf16_f32 v91, v66, v67
ds_write_b128 v101, v[84:87]
ds_write_b128 v101, v[88:91] offset:1024
s_cmp_gt_i32 s55, s42
s_cbranch_scc1 mega_kernel_q_kv0k
mega_kernel_q_kv0w:
buffer_load_dword v2, v99, s[84:87], 0 offen sc1
s_waitcnt vmcnt(0)
v_min_i32_dpp v2, v2, v2 quad_perm:[1,0,3,2] row_mask:0xf bank_mask:0xf
s_nop 1
v_min_i32_dpp v2, v2, v2 quad_perm:[2,3,0,1] row_mask:0xf bank_mask:0xf
s_nop 1
v_min_i32_dpp v2, v2, v2 row_ror:4 row_mask:0xf bank_mask:0xf
s_nop 0
v_readfirstlane_b32 s55, v2
s_cmp_gt_i32 s55, s42
s_cbranch_scc1 mega_kernel_q_kv0k
s_sleep 4
s_branch mega_kernel_q_kv0w
mega_kernel_q_kv0k:
s_add_u32 s51, s47, s42
s_bfe_u32 s57, s51, 0x40002
s_lshl_b32 s57, s57, 14
s_and_b32 s66, s51, 3
s_lshl_b32 s66, s66, 11
s_add_u32 s66, s66, s57
s_add_u32 s66, s66, s58
s_add_u32 s67, s66, 33554432
s_bfe_u32 s57, s51, 0x30003
s_lshl_b32 s57, s57, 14
s_and_b32 s68, s51, 7
s_lshl_b32 s68, s68, 10
s_add_u32 s68, s68, s57
s_add_u32 s68, s68, s59
s_add_u32 s50, s42, 2
s_min_u32 s50, s50, 63
s_lshl_b32 s50, s50, 16
s_cmp_gt_i32 s56, s42
s_cselect_b32 s30, 1, 0
ds_read_b128 v[20:23], v8 offset:0
ds_read_b128 v[24:27], v8 offset:2048
ds_read_b128 v[28:31], v9 offset:0
ds_read_b128 v[32:35], v9 offset:2048
ds_read_b128 v[36:39], v8 offset:4096
ds_read_b128 v[40:43], v8 offset:6144
s_add_u32 m0, s60, 0
s_waitcnt lgkmcnt(4)
v_mfma_f32_16x16x32_bf16 v[52:55], a[0:3], v[20:23], 0
ds_read_b128 v[44:47], v9 offset:4096
v_mfma_f32_16x16x32_bf16 v[56:59], a[4:7], v[20:23], 0
buffer_load_dwordx4 v5, s[84:87], s66 offen offset:0 sc1 lds
v_mfma_f32_16x16x32_bf16 v[60:63], a[0:3], v[24:27], 0
ds_read_b128 v[48:51], v9 offset:6144
v_mfma_f32_16x16x32_bf16 v[64:67], a[4:7], v[24:27], 0
s_add_u32 m0, s60, 0
s_waitcnt lgkmcnt(4)
v_mfma_f32_16x16x32_bf16 v[52:55], a[8:11], v[28:31], v[52:55]
ds_read_b128 v[20:23], v8 offset:8192
v_mfma_f32_16x16x32_bf16 v[56:59], a[12:15], v[28:31], v[56:59]
buffer_load_dwordx4 v5, s[84:87], s66 offen offset:1024 sc1 lds
v_mfma_f32_16x16x32_bf16 v[60:63], a[8:11], v[32:35], v[60:63]
ds_read_b128 v[24:27], v8 offset:10240
v_mfma_f32_16x16x32_bf16 v[64:67], a[12:15], v[32:35], v[64:67]
s_add_u32 m0, s60, 8192
s_waitcnt lgkmcnt(4)
v_mfma_f32_16x16x32_bf16 v[52:55], a[16:19], v[36:39], v[52:55]
ds_read_b128 v[28:31], v9 offset:8192
v_mfma_f32_16x16x32_bf16 v[56:59], a[20:23], v[36:39], v[56:59]
buffer_load_dwordx4 v5, s[84:87], s67 offen offset:0 sc1 lds
v_mfma_f32_16x16x32_bf16 v[60:63], a[16:19], v[40:43], v[60:63]
ds_read_b128 v[32:35], v9 offset:10240
v_mfma_f32_16x16x32_bf16 v[64:67], a[20:23], v[40:43], v[64:67]
s_add_u32 m0, s60, 8192
s_waitcnt lgkmcnt(4)
v_mfma_f32_16x16x32_bf16 v[52:55], a[24:27], v[44:47], v[52:55]
ds_read_b128 v[36:39], v8 offset:12288
v_mfma_f32_16x16x32_bf16 v[56:59], a[28:31], v[44:47], v[56:59]
buffer_load_dwordx4 v5, s[84:87], s67 offen offset:1024 sc1 lds
v_mfma_f32_16x16x32_bf16 v[60:63], a[24:27], v[48:51], v[60:63]
ds_read_b128 v[40:43], v8 offset:14336
v_mfma_f32_16x16x32_bf16 v[64:67], a[28:31], v[48:51], v[64:67]
s_waitcnt lgkmcnt(4)
v_mfma_f32_16x16x32_bf16 v[52:55], a[32:35], v[20:23], v[52:55]
ds_read_b128 v[44:47], v9 offset:12288
v_mfma_f32_16x16x32_bf16 v[56:59], a[36:39], v[20:23], v[56:59]
s_cmp_eq_u32 s30, 1
s_cbranch_scc0 mega_kernel_q_ke0
s_mov_b32 m0, s61
s_nop 0
buffer_load_dwordx4 v5, s[84:87], s68 offen sc1 lds
mega_kernel_q_ke0:
v_mfma_f32_16x16x32_bf16 v[60:63], a[32:35], v[24:27], v[60:63]
ds_read_b128 v[48:51], v9 offset:14336
v_mfma_f32_16x16x32_bf16 v[64:67], a[36:39], v[24:27], v[64:67]
s_add_u32 m0, s46, 65536
s_waitcnt lgkmcnt(4)
v_mfma_f32_16x16x32_bf16 v[52:55], a[40:43], v[28:31], v[52:55]
ds_read_b128 v[20:23], v8 offset:16384
v_mfma_f32_16x16x32_bf16 v[56:59], a[44:47], v[28:31], v[56:59]
buffer_load_dwordx4 v6, s[8:11], s50 offen offset:0 lds
v_mfma_f32_16x16x32_bf16 v[60:63], a[40:43], v[32:35], v[60:63]
ds_read_b128 v[24:27], v8 offset:18432
v_mfma_f32_16x16x32_bf16 v[64:67], a[44:47], v[32:35], v[64:67]
s_add_u32 m0, s46, 69504
s_waitcnt lgkmcnt(4)
v_mfma_f32_16x16x32_bf16 v[52:55], a[48:51], v[36:39], v[52:55]
ds_read_b128 v[28:31], v9 offset:16384
v_mfma_f32_16x16x32_bf16 v[56:59], a[52:55], v[36:39], v[56:59]
buffer_load_dwordx4 v6, s[8:11], s50 offen offset:128 lds
v_mfma_f32_16x16x32_bf16 v[60:63], a[48:51], v[40:43], v[60:63]
ds_read_b128 v[32:35], v9 offset:18432
v_mfma_f32_16x16x32_bf16 v[64:67], a[52:55], v[40:43], v[64:67]
s_add_u32 m0, s46, 73472
s_waitcnt lgkmcnt(4)
v_mfma_f32_16x16x32_bf16 v[52:55], a[56:59], v[44:47], v[52:55]
ds_read_b128 v[36:39], v8 offset:20480
v_mfma_f32_16x16x32_bf16 v[56:59], a[60:63], v[44:47], v[56:59]
buffer_load_dwordx4 v6, s[8:11], s50 offen offset:256 lds
v_mfma_f32_16x16x32_bf16 v[60:63], a[56:59], v[48:51], v[60:63]
ds_read_b128 v[40:43], v8 offset:22528
v_mfma_f32_16x16x32_bf16 v[64:67], a[60:63], v[48:51], v[64:67]
s_add_u32 m0, s46, 77440
s_waitcnt lgkmcnt(4)
v_mfma_f32_16x16x32_bf16 v[52:55], a[64:67], v[20:23], v[52:55]
ds_read_b128 v[44:47], v9 offset:20480
v_mfma_f32_16x16x32_bf16 v[56:59], a[68:71], v[20:23], v[56:59]
buffer_load_dwordx4 v6, s[8:11], s50 offen offset:384 lds
v_mfma_f32_16x16x32_bf16 v[60:63], a[64:67], v[24:27], v[60:63]
ds_read_b128 v[48:51], v9 offset:22528
v_mfma_f32_16x16x32_bf16 v[64:67], a[68:71], v[24:27], v[64:67]
s_add_u32 m0, s46, 81408
s_waitcnt lgkmcnt(4)
v_mfma_f32_16x16x32_bf16 v[52:55], a[72:75], v[28:31], v[52:55]
ds_read_b128 v[20:23], v8 offset:24576
v_mfma_f32_16x16x32_bf16 v[56:59], a[76:79], v[28:31], v[56:59]
buffer_load_dwordx4 v6, s[8:11], s50 offen offset:512 lds
v_mfma_f32_16x16x32_bf16 v[60:63], a[72:75], v[32:35], v[60:63]
ds_read_b128 v[24:27], v8 offset:26624
v_mfma_f32_16x16x32_bf16 v[64:67], a[76:79], v[32:35], v[64:67]
s_add_u32 m0, s46, 85376
s_waitcnt lgkmcnt(4)
v_mfma_f32_16x16x32_bf16 v[52:55], a[80:83], v[36:39], v[52:55]
ds_read_b128 v[28:31], v9 offset:24576
v_mfma_f32_16x16x32_bf16 v[56:59], a[84:87], v[36:39], v[56:59]
buffer_load_dwordx4 v6, s[8:11], s50 offen offset:640 lds
v_mfma_f32_16x16x32_bf16 v[60:63], a[80:83], v[40:43], v[60:63]
ds_read_b128 v[32:35], v9 offset:26624
v_mfma_f32_16x16x32_bf16 v[64:67], a[84:87], v[40:43], v[64:67]
s_add_u32 m0, s46, 89344
s_waitcnt lgkmcnt(4)
v_mfma_f32_16x16x32_bf16 v[52:55], a[88:91], v[44:47], v[52:55]
ds_read_b128 v[36:39], v8 offset:28672
v_mfma_f32_16x16x32_bf16 v[56:59], a[92:95], v[44:47], v[56:59]
buffer_load_dwordx4 v6, s[8:11], s50 offen offset:768 lds
v_mfma_f32_16x16x32_bf16 v[60:63], a[88:91], v[48:51], v[60:63]
ds_read_b128 v[40:43], v8 offset:30720
v_mfma_f32_16x16x32_bf16 v[64:67], a[92:95], v[48:51], v[64:67]
s_add_u32 m0, s46, 93312
s_waitcnt lgkmcnt(4)
v_mfma_f32_16x16x32_bf16 v[52:55], a[96:99], v[20:23], v[52:55]
ds_read_b128 v[44:47], v9 offset:28672
v_mfma_f32_16x16x32_bf16 v[56:59], a[100:103], v[20:23], v[56:59]
buffer_load_dwordx4 v6, s[8:11], s50 offen offset:896 lds
v_mfma_f32_16x16x32_bf16 v[60:63], a[96:99], v[24:27], v[60:63]
ds_read_b128 v[48:51], v9 offset:30720
v_mfma_f32_16x16x32_bf16 v[64:67], a[100:103], v[24:27], v[64:67]
s_add_u32 m0, s46, 97280
s_waitcnt lgkmcnt(4)
v_mfma_f32_16x16x32_bf16 v[52:55], a[104:107], v[28:31], v[52:55]
ds_read_b128 v[20:23], v8 offset:32768
v_mfma_f32_16x16x32_bf16 v[56:59], a[108:111], v[28:31], v[56:59]
buffer_load_dwordx4 v6, s[8:11], s50 offen offset:1024 lds
v_mfma_f32_16x16x32_bf16 v[60:63], a[104:107], v[32:35], v[60:63]
ds_read_b128 v[24:27], v8 offset:34816
v_mfma_f32_16x16x32_bf16 v[64:67], a[108:111], v[32:35], v[64:67]
s_waitcnt vmcnt(13)
v_mov_b32 v17, s42
s_mov_b64 exec, 1
buffer_store_dword v17, v16, s[84:87], s49 offen sc1
s_mov_b64 exec, -1
s_add_u32 m0, s46, 101248
s_waitcnt lgkmcnt(4)
v_mfma_f32_16x16x32_bf16 v[52:55], a[112:115], v[36:39], v[52:55]
ds_read_b128 v[28:31], v9 offset:32768
v_mfma_f32_16x16x32_bf16 v[56:59], a[116:119], v[36:39], v[56:59]
buffer_load_dwordx4 v6, s[8:11], s50 offen offset:1152 lds
v_mfma_f32_16x16x32_bf16 v[60:63], a[112:115], v[40:43], v[60:63]
ds_read_b128 v[32:35], v9 offset:34816
v_mfma_f32_16x16x32_bf16 v[64:67], a[116:119], v[40:43], v[64:67]
v_mov_b32 v100, 0
s_mov_b64 exec, 1
buffer_atomic_add v100, v16, s[84:87], s62 offen sc0 sc1
s_mov_b64 exec, -1
s_add_u32 m0, s46, 105216
s_waitcnt lgkmcnt(4)
v_mfma_f32_16x16x32_bf16 v[52:55], a[120:123], v[44:47], v[52:55]
ds_read_b128 v[36:39], v8 offset:36864
v_mfma_f32_16x16x32_bf16 v[56:59], a[124:127], v[44:47], v[56:59]
buffer_load_dwordx4 v6, s[8:11], s50 offen offset:1280 lds
v_mfma_f32_16x16x32_bf16 v[60:63], a[120:123], v[48:51], v[60:63]
ds_read_b128 v[40:43], v8 offset:38912
v_mfma_f32_16x16x32_bf16 v[64:67], a[124:127], v[48:51], v[64:67]
s_add_u32 m0, s46, 109184
s_waitcnt lgkmcnt(4)
v_mfma_f32_16x16x32_bf16 v[52:55], a[128:131], v[20:23], v[52:55]
ds_read_b128 v[44:47], v9 offset:36864
v_mfma_f32_16x16x32_bf16 v[56:59], a[132:135], v[20:23], v[56:59]
buffer_load_dwordx4 v6, s[8:11], s50 offen offset:1408 lds
v_mfma_f32_16x16x32_bf16 v[60:63], a[128:131], v[24:27], v[60:63]
ds_read_b128 v[48:51], v9 offset:38912
v_mfma_f32_16x16x32_bf16 v[64:67], a[132:135], v[24:27], v[64:67]
s_add_u32 m0, s46, 113152
s_waitcnt lgkmcnt(4)
v_mfma_f32_16x16x32_bf16 v[52:55], a[136:139], v[28:31], v[52:55]
ds_read_b128 v[20:23], v8 offset:40960
v_mfma_f32_16x16x32_bf16 v[56:59], a[140:143], v[28:31], v[56:59]
buffer_load_dwordx4 v6, s[8:11], s50 offen offset:1536 lds
v_mfma_f32_16x16x32_bf16 v[60:63], a[136:139], v[32:35], v[60:63]
ds_read_b128 v[24:27], v8 offset:43008
v_mfma_f32_16x16x32_bf16 v[64:67], a[140:143], v[32:35], v[64:67]
s_add_u32 m0, s46, 117120
s_waitcnt lgkmcnt(4)
v_mfma_f32_16x16x32_bf16 v[52:55], a[144:147], v[36:39], v[52:55]
ds_read_b128 v[28:31], v9 offset:40960
v_mfma_f32_16x16x32_bf16 v[56:59], a[148:151], v[36:39], v[56:59]
buffer_load_dwordx4 v6, s[8:11], s50 offen offset:1664 lds
v_mfma_f32_16x16x32_bf16 v[60:63], a[144:147], v[40:43], v[60:63]
ds_read_b128 v[32:35], v9 offset:43008
v_mfma_f32_16x16x32_bf16 v[64:67], a[148:151], v[40:43], v[64:67]
s_add_u32 m0, s46, 121088
s_waitcnt lgkmcnt(4)
v_mfma_f32_16x16x32_bf16 v[52:55], a[152:155], v[44:47], v[52:55]
ds_read_b128 v[36:39], v8 offset:45056
v_mfma_f32_16x16x32_bf16 v[56:59], a[156:159], v[44:47], v[56:59]
buffer_load_dwordx4 v6, s[8:11], s50 offen offset:1792 lds
v_mfma_f32_16x16x32_bf16 v[60:63], a[152:155], v[48:51], v[60:63]
ds_read_b128 v[40:43], v8 offset:47104
v_mfma_f32_16x16x32_bf16 v[64:67], a[156:159], v[48:51], v[64:67]
s_add_u32 m0, s46, 125056
s_waitcnt lgkmcnt(4)
v_mfma_f32_16x16x32_bf16 v[52:55], a[160:163], v[20:23], v[52:55]
ds_read_b128 v[44:47], v9 offset:45056
v_mfma_f32_16x16x32_bf16 v[56:59], a[164:167], v[20:23], v[56:59]
buffer_load_dwordx4 v6, s[8:11], s50 offen offset:1920 lds
v_mfma_f32_16x16x32_bf16 v[60:63], a[160:163], v[24:27], v[60:63]
ds_read_b128 v[48:51], v9 offset:47104
v_mfma_f32_16x16x32_bf16 v[64:67], a[164:167], v[24:27], v[64:67]
s_waitcnt lgkmcnt(4)
v_mfma_f32_16x16x32_bf16 v[52:55], a[168:171], v[28:31], v[52:55]
ds_read_b128 v[20:23], v8 offset:49152
v_mfma_f32_16x16x32_bf16 v[56:59], a[172:175], v[28:31], v[56:59]
v_mfma_f32_16x16x32_bf16 v[60:63], a[168:171], v[32:35], v[60:63]
ds_read_b128 v[24:27], v8 offset:51200
v_mfma_f32_16x16x32_bf16 v[64:67], a[172:175], v[32:35], v[64:67]
s_waitcnt lgkmcnt(4)
v_mfma_f32_16x16x32_bf16 v[52:55], a[176:179], v[36:39], v[52:55]
ds_read_b128 v[28:31], v9 offset:49152
v_mfma_f32_16x16x32_bf16 v[56:59], a[180:183], v[36:39], v[56:59]
v_mfma_f32_16x16x32_bf16 v[60:63], a[176:179], v[40:43], v[60:63]
ds_read_b128 v[32:35], v9 offset:51200
v_mfma_f32_16x16x32_bf16 v[64:67], a[180:183], v[40:43], v[64:67]
s_waitcnt lgkmcnt(4)
v_mfma_f32_16x16x32_bf16 v[52:55], a[184:187], v[44:47], v[52:55]
ds_read_b128 v[36:39], v8 offset:53248
v_mfma_f32_16x16x32_bf16 v[56:59], a[188:191], v[44:47], v[56:59]
v_mfma_f32_16x16x32_bf16 v[60:63], a[184:187], v[48:51], v[60:63]
ds_read_b128 v[40:43], v8 offset:55296
v_mfma_f32_16x16x32_bf16 v[64:67], a[188:191], v[48:51], v[64:67]
s_waitcnt lgkmcnt(4)
v_mfma_f32_16x16x32_bf16 v[52:55], a[192:195], v[20:23], v[52:55]
ds_read_b128 v[44:47], v9 offset:53248
v_mfma_f32_16x16x32_bf16 v[56:59], a[196:199], v[20:23], v[56:59]
v_mfma_f32_16x16x32_bf16 v[60:63], a[192:195], v[24:27], v[60:63]
ds_read_b128 v[48:51], v9 offset:55296
v_mfma_f32_16x16x32_bf16 v[64:67], a[196:199], v[24:27], v[64:67]
s_waitcnt lgkmcnt(4)
v_mfma_f32_16x16x32_bf16 v[52:55], a[200:203], v[28:31], v[52:55]
ds_read_b128 v[20:23], v8 offset:57344
v_mfma_f32_16x16x32_bf16 v[56:59], a[204:207], v[28:31], v[56:59]
v_mfma_f32_16x16x32_bf16 v[60:63], a[200:203], v[32:35], v[60:63]
ds_read_b128 v[24:27], v8 offset:59392
v_mfma_f32_16x16x32_bf16 v[64:67], a[204:207], v[32:35], v[64:67]
s_waitcnt lgkmcnt(4)
v_mfma_f32_16x16x32_bf16 v[52:55], a[208:211], v[36:39], v[52:55]
ds_read_b128 v[28:31], v9 offset:57344
v_mfma_f32_16x16x32_bf16 v[56:59], a[212:215], v[36:39], v[56:59]
v_mfma_f32_16x16x32_bf16 v[60:63], a[208:211], v[40:43], v[60:63]
ds_read_b128 v[32:35], v9 offset:59392
v_mfma_f32_16x16x32_bf16 v[64:67], a[212:215], v[40:43], v[64:67]
s_waitcnt lgkmcnt(4)
v_mfma_f32_16x16x32_bf16 v[52:55], a[216:219], v[44:47], v[52:55]
ds_read_b128 v[36:39], v8 offset:61440
v_mfma_f32_16x16x32_bf16 v[56:59], a[220:223], v[44:47], v[56:59]
v_mfma_f32_16x16x32_bf16 v[60:63], a[216:219], v[48:51], v[60:63]
ds_read_b128 v[40:43], v8 offset:63488
v_mfma_f32_16x16x32_bf16 v[64:67], a[220:223], v[48:51], v[64:67]
s_waitcnt lgkmcnt(4)
v_mfma_f32_16x16x32_bf16 v[52:55], a[224:227], v[20:23], v[52:55]
ds_read_b128 v[44:47], v9 offset:61440
v_mfma_f32_16x16x32_bf16 v[56:59], a[228:231], v[20:23], v[56:59]
v_mfma_f32_16x16x32_bf16 v[60:63], a[224:227], v[24:27], v[60:63]
ds_read_b128 v[48:51], v9 offset:63488
v_mfma_f32_16x16x32_bf16 v[64:67], a[228:231], v[24:27], v[64:67]
s_waitcnt lgkmcnt(5)
v_mfma_f32_16x16x32_bf16 v[52:55], a[232:235], v[28:31], v[52:55]
v_mfma_f32_16x16x32_bf16 v[56:59], a[236:239], v[28:31], v[56:59]
s_waitcnt vmcnt(6)
v_readfirstlane_b32 s56, v100
s_cmp_eq_u32 s30, 1
s_cbranch_scc1 mega_kernel_q_kf0
s_cmp_gt_i32 s56, s42
s_cbranch_scc0 mega_kernel_q_kf0
s_mov_b32 s30, 1
s_mov_b32 m0, s61
s_nop 0
buffer_load_dwordx4 v5, s[84:87], s68 offen sc1 lds
mega_kernel_q_kf0:
s_waitcnt lgkmcnt(4)
v_mfma_f32_16x16x32_bf16 v[60:63], a[232:235], v[32:35], v[60:63]
v_mfma_f32_16x16x32_bf16 v[64:67], a[236:239], v[32:35], v[64:67]
s_waitcnt lgkmcnt(3)
v_mfma_f32_16x16x32_bf16 v[52:55], a[240:243], v[36:39], v[52:55]
v_mfma_f32_16x16x32_bf16 v[56:59], a[244:247], v[36:39], v[56:59]
s_waitcnt lgkmcnt(2)
v_mfma_f32_16x16x32_bf16 v[60:63], a[240:243], v[40:43], v[60:63]
v_mfma_f32_16x16x32_bf16 v[64:67], a[244:247], v[40:43], v[64:67]
s_waitcnt lgkmcnt(1)
v_mfma_f32_16x16x32_bf16 v[52:55], a[248:251], v[44:47], v[52:55]
v_mfma_f32_16x16x32_bf16 v[56:59], a[252:255], v[44:47], v[56:59]
s_waitcnt lgkmcnt(0)
v_mfma_f32_16x16x32_bf16 v[60:63], a[248:251], v[48:51], v[60:63]
v_mfma_f32_16x16x32_bf16 v[64:67], a[252:255], v[48:51], v[64:67]
s_cmp_eq_u32 s30, 1
s_cbranch_scc1 mega_kernel_q_kl0
mega_kernel_q_kw0:
v_mov_b32 v100, 0
s_mov_b64 exec, 1
buffer_atomic_add v100, v16, s[84:87], s62 offen sc0 sc1
s_mov_b64 exec, -1
s_waitcnt vmcnt(0)
v_readfirstlane_b32 s56, v100
s_cmp_gt_i32 s56, s42
s_cbranch_scc0 mega_kernel_q_kw0
s_mov_b32 m0, s61
s_nop 0
buffer_load_dwordx4 v5, s[84:87], s68 offen sc1 lds
mega_kernel_q_kl0:
s_waitcnt lgkmcnt(0) vmcnt(0)
s_barrier
ds_read_b128 v[184:187], v102 offset:0
ds_read_b128 v[112:115], v103 offset:0
ds_read_b128 v[128:131], v103 offset:1024
ds_read_b128 v[188:191], v102 offset:2048
ds_read_b128 v[116:119], v103 offset:2048
ds_read_b128 v[132:135], v103 offset:3072
ds_read_b128 v[192:195], v102 offset:4096
ds_read_b128 v[120:123], v103 offset:4096
ds_read_b128 v[136:139], v103 offset:5120
ds_read_b128 v[196:199], v102 offset:6144
ds_read_b128 v[124:127], v103 offset:6144
ds_read_b128 v[140:143], v103 offset:7168
s_waitcnt lgkmcnt(9)
v_mfma_f32_16x16x32_bf16 v[200:203], v[112:115], v[184:187], 0
v_mfma_f32_16x16x32_bf16 v[204:207], v[128:131], v[184:187], 0
ds_read_b128 v[160:163], v94 offset:0
s_waitcnt lgkmcnt(7)
v_mfma_f32_16x16x32_bf16 v[200:203], v[116:119], v[188:191], v[200:203]
v_mfma_f32_16x16x32_bf16 v[204:207], v[132:135], v[188:191], v[204:207]
ds_read_b128 v[164:167], v94 offset:1024
s_waitcnt lgkmcnt(5)
v_mfma_f32_16x16x32_bf16 v[200:203], v[120:123], v[192:195], v[200:203]
v_mfma_f32_16x16x32_bf16 v[204:207], v[136:139], v[192:195], v[204:207]
ds_read_b128 v[168:171], v94 offset:2048
s_waitcnt lgkmcnt(3)
v_mfma_f32_16x16x32_bf16 v[200:203], v[124:127], v[196:199], v[200:203]
v_mfma_f32_16x16x32_bf16 v[204:207], v[140:143], v[196:199], v[204:207]
ds_read_b128 v[172:175], v94 offset:3072
s_waitcnt lgkmcnt(3)
v_mfma_f32_16x16x32_bf16 v[208:211], v[160:163], v[184:187], 0
ds_read_b128 v[144:147], v240 offset:0
ds_read_b64 v[176:177], v95 offset:0
s_waitcnt lgkmcnt(4)
v_mfma_f32_16x16x32_bf16 v[208:211], v[164:167], v[188:191], v[208:211]
ds_read_b128 v[148:151], v240 offset:1024
ds_read_b64 v[178:179], v95 offset:256
s_waitcnt lgkmcnt(5)
v_mfma_f32_16x16x32_bf16 v[208:211], v[168:171], v[192:195], v[208:211]
ds_read_b128 v[152:155], v240 offset:2048
ds_read_b64 v[180:181], v95 offset:1024
s_waitcnt lgkmcnt(6)
v_mfma_f32_16x16x32_bf16 v[208:211], v[172:175], v[196:199], v[208:211]
ds_read_b128 v[156:159], v240 offset:3072
ds_read_b64 v[182:183], v95 offset:1280
s_nop 3
v_cndmask_b32 v200, v200, v97, s[12:13]
v_cndmask_b32 v201, v201, v97, s[14:15]
v_cndmask_b32 v202, v202, v97, s[16:17]
v_cndmask_b32 v203, v203, v97, s[18:19]
v_cndmask_b32 v204, v204, v97, s[20:21]
v_cndmask_b32 v205, v205, v97, s[22:23]
v_cndmask_b32 v206, v206, v97, s[24:25]
v_cndmask_b32 v207, v207, v97, s[26:27]
v_cndmask_b32 v208, v208, v97, s[28:29]
v_cndmask_b32 v209, v209, v97, s[28:29]
v_cndmask_b32 v210, v210, v97, s[28:29]
v_cndmask_b32 v211, v211, v97, s[28:29]
v_max3_f32 v236, v200, v201, v202
v_max3_f32 v236, v236, v203, v204
v_max3_f32 v236, v236, v205, v206
v_max3_f32 v236, v236, v207, v208
v_max3_f32 v236, v236, v209, v210
v_max_f32 v237, v236, v211
v_max_f32 v236, v236, v211
s_nop 1
v_permlane16_swap_b32 v236, v237
s_nop 0
v_max_f32 v238, v236, v237
v_max_f32 v239, v236, v237
s_nop 1
v_permlane32_swap_b32 v238, v239
s_nop 0
v_max_f32 v236, v238, v239
v_mul_f32 v236, s54, v236
v_fma_f32 v200, v200, s54, -v236
v_fma_f32 v201, v201, s54, -v236
v_fma_f32 v202, v202, s54, -v236
v_fma_f32 v203, v203, s54, -v236
v_fma_f32 v204, v204, s54, -v236
v_fma_f32 v205, v205, s54, -v236
v_fma_f32 v206, v206, s54, -v236
v_fma_f32 v207, v207, s54, -v236
v_fma_f32 v208, v208, s54, -v236
v_fma_f32 v209, v209, s54, -v236
v_fma_f32 v210, v210, s54, -v236
v_fma_f32 v211, v211, s54, -v236
v_exp_f32 v200, v200
v_exp_f32 v201, v201
v_exp_f32 v202, v202
v_exp_f32 v203, v203
v_exp_f32 v204, v204
v_exp_f32 v205, v205
v_exp_f32 v206, v206
v_exp_f32 v207, v207
v_exp_f32 v208, v208
v_exp_f32 v209, v209
v_exp_f32 v210, v210
v_exp_f32 v211, v211
s_nop 0
v_cvt_pk_bf16_f32 v212, v200, v201
v_cvt_pk_bf16_f32 v213, v202, v203
v_cvt_pk_bf16_f32 v214, v204, v205
v_cvt_pk_bf16_f32 v215, v206, v207
v_cvt_pk_bf16_f32 v216, v208, v209
v_cvt_pk_bf16_f32 v217, v210, v211
s_waitcnt lgkmcnt(0)
s_nop 0
v_mfma_f32_16x16x32_bf16 v[108:111], v[104:107], v[212:215], 0
v_mfma_f32_16x16x32_bf16 v[220:223], v[144:147], v[212:215], 0
v_mfma_f32_16x16x32_bf16 v[224:227], v[148:151], v[212:215], 0
v_mfma_f32_16x16x32_bf16 v[228:231], v[152:155], v[212:215], 0
v_mfma_f32_16x16x32_bf16 v[232:235], v[156:159], v[212:215], 0
v_mfma_f32_16x16x16_bf16 v[108:111], v[104:105], v[216:217], v[108:111]
v_mfma_f32_16x16x16_bf16 v[220:223], v[176:177], v[216:217], v[220:223]
v_mfma_f32_16x16x16_bf16 v[224:227], v[178:179], v[216:217], v[224:227]
v_mfma_f32_16x16x16_bf16 v[228:231], v[180:181], v[216:217], v[228:231]
v_mfma_f32_16x16x16_bf16 v[232:235], v[182:183], v[216:217], v[232:235]
s_lshl_b32 s51, s42, 18
s_nop 2
v_rcp_f32 v238, v108
v_rcp_f32 v239, v109
s_nop 1
v_pk_mul_f32 v[220:221], v[220:221], v[238:239]
v_pk_mul_f32 v[222:223], v[222:223], v[238:239]
v_pk_mul_f32 v[224:225], v[224:225], v[238:239]
v_pk_mul_f32 v[226:227], v[226:227], v[238:239]
v_pk_mul_f32 v[228:229], v[228:229], v[238:239]
v_pk_mul_f32 v[230:231], v[230:231], v[238:239]
v_pk_mul_f32 v[232:233], v[232:233], v[238:239]
v_pk_mul_f32 v[234:235], v[234:235], v[238:239]
v_cvt_pk_bf16_f32 v200, v220, v221
v_cvt_pk_bf16_f32 v201, v222, v223
v_cvt_pk_bf16_f32 v202, v224, v225
v_cvt_pk_bf16_f32 v203, v226, v227
v_cvt_pk_bf16_f32 v204, v228, v229
v_cvt_pk_bf16_f32 v205, v230, v231
v_cvt_pk_bf16_f32 v206, v232, v233
v_cvt_pk_bf16_f32 v207, v234, v235
buffer_store_dwordx4 v[200:203], v96, s[84:87], s51 offen sc1
buffer_store_dwordx4 v[204:207], v96, s[84:87], s51 offen offset:2048 sc1
s_add_u32 s42, s42, 1
s_branch mega_kernel_q_loop
mega_kernel_q_last:
s_barrier
v_cvt_pk_bf16_f32 v84, v52, v53
v_cvt_pk_bf16_f32 v85, v54, v55
v_cvt_pk_bf16_f32 v86, v56, v57
v_cvt_pk_bf16_f32 v87, v58, v59
v_cvt_pk_bf16_f32 v88, v60, v61
v_cvt_pk_bf16_f32 v89, v62, v63
v_cvt_pk_bf16_f32 v90, v64, v65
v_cvt_pk_bf16_f32 v91, v66, v67
ds_write_b128 v101, v[84:87]
ds_write_b128 v101, v[88:91] offset:1024
s_cmp_gt_i32 s55, s42
s_cbranch_scc1 mega_kernel_q_kv2k
mega_kernel_q_kv2w:
buffer_load_dword v2, v99, s[84:87], 0 offen sc1
s_waitcnt vmcnt(0)
v_min_i32_dpp v2, v2, v2 quad_perm:[1,0,3,2] row_mask:0xf bank_mask:0xf
s_nop 1
v_min_i32_dpp v2, v2, v2 quad_perm:[2,3,0,1] row_mask:0xf bank_mask:0xf
s_nop 1
v_min_i32_dpp v2, v2, v2 row_ror:4 row_mask:0xf bank_mask:0xf
s_nop 0
v_readfirstlane_b32 s55, v2
s_cmp_gt_i32 s55, s42
s_cbranch_scc1 mega_kernel_q_kv2k
s_sleep 4
s_branch mega_kernel_q_kv2w
mega_kernel_q_kv2k:
s_add_u32 s51, s47, s42
s_bfe_u32 s57, s51, 0x40002
s_lshl_b32 s57, s57, 14
s_and_b32 s66, s51, 3
s_lshl_b32 s66, s66, 11
s_add_u32 s66, s66, s57
s_add_u32 s66, s66, s58
s_add_u32 s67, s66, 33554432
s_bfe_u32 s57, s51, 0x30003
s_lshl_b32 s57, s57, 14
s_and_b32 s68, s51, 7
s_lshl_b32 s68, s68, 10
s_add_u32 s68, s68, s57
s_add_u32 s68, s68, s59
s_add_u32 s50, s42, 2
s_min_u32 s50, s50, 63
s_lshl_b32 s50, s50, 16
s_cmp_gt_i32 s56, s42
s_cselect_b32 s30, 1, 0
s_add_u32 m0, s60, 0
s_nop 0
buffer_load_dwordx4 v5, s[84:87], s66 offen offset:0 sc1 lds
s_add_u32 m0, s60, 0
s_nop 0
buffer_load_dwordx4 v5, s[84:87], s66 offen offset:1024 sc1 lds
s_add_u32 m0, s60, 8192
s_nop 0
buffer_load_dwordx4 v5, s[84:87], s67 offen offset:0 sc1 lds
s_add_u32 m0, s60, 8192
s_nop 0
buffer_load_dwordx4 v5, s[84:87], s67 offen offset:1024 sc1 lds
s_cmp_eq_u32 s30, 1
s_cbranch_scc0 mega_kernel_q_ke2
s_mov_b32 m0, s61
s_nop 0
buffer_load_dwordx4 v5, s[84:87], s68 offen sc1 lds
mega_kernel_q_ke2:
s_waitcnt vmcnt(4)
v_mov_b32 v17, s42
s_mov_b64 exec, 1
buffer_store_dword v17, v16, s[84:87], s49 offen sc1
s_mov_b64 exec, -1
s_cmp_eq_u32 s30, 1
s_cbranch_scc1 mega_kernel_q_kl2
mega_kernel_q_kw2:
v_mov_b32 v100, 0
s_mov_b64 exec, 1
buffer_atomic_add v100, v16, s[84:87], s62 offen sc0 sc1
s_mov_b64 exec, -1
s_waitcnt vmcnt(0)
v_readfirstlane_b32 s56, v100
s_cmp_gt_i32 s56, s42
s_cbranch_scc0 mega_kernel_q_kw2
s_mov_b32 m0, s61
s_nop 0
buffer_load_dwordx4 v5, s[84:87], s68 offen sc1 lds
mega_kernel_q_kl2:
s_waitcnt lgkmcnt(0) vmcnt(0)
s_barrier
ds_read_b128 v[184:187], v102 offset:0
ds_read_b128 v[112:115], v103 offset:0
ds_read_b128 v[128:131], v103 offset:1024
ds_read_b128 v[188:191], v102 offset:2048
ds_read_b128 v[116:119], v103 offset:2048
ds_read_b128 v[132:135], v103 offset:3072
ds_read_b128 v[192:195], v102 offset:4096
ds_read_b128 v[120:123], v103 offset:4096
ds_read_b128 v[136:139], v103 offset:5120
ds_read_b128 v[196:199], v102 offset:6144
ds_read_b128 v[124:127], v103 offset:6144
ds_read_b128 v[140:143], v103 offset:7168
s_waitcnt lgkmcnt(9)
v_mfma_f32_16x16x32_bf16 v[200:203], v[112:115], v[184:187], 0
v_mfma_f32_16x16x32_bf16 v[204:207], v[128:131], v[184:187], 0
ds_read_b128 v[160:163], v94 offset:0
s_waitcnt lgkmcnt(7)
v_mfma_f32_16x16x32_bf16 v[200:203], v[116:119], v[188:191], v[200:203]
v_mfma_f32_16x16x32_bf16 v[204:207], v[132:135], v[188:191], v[204:207]
ds_read_b128 v[164:167], v94 offset:1024
s_waitcnt lgkmcnt(5)
v_mfma_f32_16x16x32_bf16 v[200:203], v[120:123], v[192:195], v[200:203]
v_mfma_f32_16x16x32_bf16 v[204:207], v[136:139], v[192:195], v[204:207]
ds_read_b128 v[168:171], v94 offset:2048
s_waitcnt lgkmcnt(3)
v_mfma_f32_16x16x32_bf16 v[200:203], v[124:127], v[196:199], v[200:203]
v_mfma_f32_16x16x32_bf16 v[204:207], v[140:143], v[196:199], v[204:207]
ds_read_b128 v[172:175], v94 offset:3072
s_waitcnt lgkmcnt(3)
v_mfma_f32_16x16x32_bf16 v[208:211], v[160:163], v[184:187], 0
ds_read_b128 v[144:147], v240 offset:0
ds_read_b64 v[176:177], v95 offset:0
s_waitcnt lgkmcnt(4)
v_mfma_f32_16x16x32_bf16 v[208:211], v[164:167], v[188:191], v[208:211]
ds_read_b128 v[148:151], v240 offset:1024
ds_read_b64 v[178:179], v95 offset:256
s_waitcnt lgkmcnt(5)
v_mfma_f32_16x16x32_bf16 v[208:211], v[168:171], v[192:195], v[208:211]
ds_read_b128 v[152:155], v240 offset:2048
ds_read_b64 v[180:181], v95 offset:1024
s_waitcnt lgkmcnt(6)
v_mfma_f32_16x16x32_bf16 v[208:211], v[172:175], v[196:199], v[208:211]
ds_read_b128 v[156:159], v240 offset:3072
ds_read_b64 v[182:183], v95 offset:1280
s_nop 3
v_cndmask_b32 v200, v200, v97, s[12:13]
v_cndmask_b32 v201, v201, v97, s[14:15]
v_cndmask_b32 v202, v202, v97, s[16:17]
v_cndmask_b32 v203, v203, v97, s[18:19]
v_cndmask_b32 v204, v204, v97, s[20:21]
v_cndmask_b32 v205, v205, v97, s[22:23]
v_cndmask_b32 v206, v206, v97, s[24:25]
v_cndmask_b32 v207, v207, v97, s[26:27]
v_cndmask_b32 v208, v208, v97, s[28:29]
v_cndmask_b32 v209, v209, v97, s[28:29]
v_cndmask_b32 v210, v210, v97, s[28:29]
v_cndmask_b32 v211, v211, v97, s[28:29]
v_max3_f32 v236, v200, v201, v202
v_max3_f32 v236, v236, v203, v204
v_max3_f32 v236, v236, v205, v206
v_max3_f32 v236, v236, v207, v208
v_max3_f32 v236, v236, v209, v210
v_max_f32 v237, v236, v211
v_max_f32 v236, v236, v211
s_nop 1
v_permlane16_swap_b32 v236, v237
s_nop 0
v_max_f32 v238, v236, v237
v_max_f32 v239, v236, v237
s_nop 1
v_permlane32_swap_b32 v238, v239
s_nop 0
v_max_f32 v236, v238, v239
v_mul_f32 v236, s54, v236
v_fma_f32 v200, v200, s54, -v236
v_fma_f32 v201, v201, s54, -v236
v_fma_f32 v202, v202, s54, -v236
v_fma_f32 v203, v203, s54, -v236
v_fma_f32 v204, v204, s54, -v236
v_fma_f32 v205, v205, s54, -v236
v_fma_f32 v206, v206, s54, -v236
v_fma_f32 v207, v207, s54, -v236
v_fma_f32 v208, v208, s54, -v236
v_fma_f32 v209, v209, s54, -v236
v_fma_f32 v210, v210, s54, -v236
v_fma_f32 v211, v211, s54, -v236
v_exp_f32 v200, v200
v_exp_f32 v201, v201
v_exp_f32 v202, v202
v_exp_f32 v203, v203
v_exp_f32 v204, v204
v_exp_f32 v205, v205
v_exp_f32 v206, v206
v_exp_f32 v207, v207
v_exp_f32 v208, v208
v_exp_f32 v209, v209
v_exp_f32 v210, v210
v_exp_f32 v211, v211
s_nop 0
v_cvt_pk_bf16_f32 v212, v200, v201
v_cvt_pk_bf16_f32 v213, v202, v203
v_cvt_pk_bf16_f32 v214, v204, v205
v_cvt_pk_bf16_f32 v215, v206, v207
v_cvt_pk_bf16_f32 v216, v208, v209
v_cvt_pk_bf16_f32 v217, v210, v211
s_waitcnt lgkmcnt(0)
s_nop 0
v_mfma_f32_16x16x32_bf16 v[108:111], v[104:107], v[212:215], 0
v_mfma_f32_16x16x32_bf16 v[220:223], v[144:147], v[212:215], 0
v_mfma_f32_16x16x32_bf16 v[224:227], v[148:151], v[212:215], 0
v_mfma_f32_16x16x32_bf16 v[228:231], v[152:155], v[212:215], 0
v_mfma_f32_16x16x32_bf16 v[232:235], v[156:159], v[212:215], 0
v_mfma_f32_16x16x16_bf16 v[108:111], v[104:105], v[216:217], v[108:111]
v_mfma_f32_16x16x16_bf16 v[220:223], v[176:177], v[216:217], v[220:223]
v_mfma_f32_16x16x16_bf16 v[224:227], v[178:179], v[216:217], v[224:227]
v_mfma_f32_16x16x16_bf16 v[228:231], v[180:181], v[216:217], v[228:231]
v_mfma_f32_16x16x16_bf16 v[232:235], v[182:183], v[216:217], v[232:235]
s_lshl_b32 s51, s42, 18
s_nop 2
v_rcp_f32 v238, v108
v_rcp_f32 v239, v109
s_nop 1
v_pk_mul_f32 v[220:221], v[220:221], v[238:239]
v_pk_mul_f32 v[222:223], v[222:223], v[238:239]
v_pk_mul_f32 v[224:225], v[224:225], v[238:239]
v_pk_mul_f32 v[226:227], v[226:227], v[238:239]
v_pk_mul_f32 v[228:229], v[228:229], v[238:239]
v_pk_mul_f32 v[230:231], v[230:231], v[238:239]
v_pk_mul_f32 v[232:233], v[232:233], v[238:239]
v_pk_mul_f32 v[234:235], v[234:235], v[238:239]
v_cvt_pk_bf16_f32 v200, v220, v221
v_cvt_pk_bf16_f32 v201, v222, v223
v_cvt_pk_bf16_f32 v202, v224, v225
v_cvt_pk_bf16_f32 v203, v226, v227
v_cvt_pk_bf16_f32 v204, v228, v229
v_cvt_pk_bf16_f32 v205, v230, v231
v_cvt_pk_bf16_f32 v206, v232, v233
v_cvt_pk_bf16_f32 v207, v234, v235
buffer_store_dwordx4 v[200:203], v96, s[84:87], s51 offen sc1
buffer_store_dwordx4 v[204:207], v96, s[84:87], s51 offen offset:2048 sc1
s_add_u32 s42, s42, 1
s_waitcnt vmcnt(0)
v_mov_b32 v17, s42
s_mov_b64 exec, 1
buffer_store_dword v17, v16, s[84:87], s49 offen sc1
s_mov_b64 exec, -1
mega_kernel_q_quit:
s_endpgm
mega_kernel_rd:
s_mov_b32 s93, s40
s_load_dwordx2 s[4:5], s[0:1], 56
s_mov_b32 s48, 0x3f7ec46d
s_mov_b32 s49, 0x3dc8bd36
s_mov_b32 s50, 0x3f7b14be
s_mov_b32 s51, 0x3e47c5c2
s_mov_b32 s52, 0x3f74fa0b
s_mov_b32 s53, 0x3e94a031
s_mov_b32 s54, 0x3f6c835e
s_mov_b32 s55, 0x3ec3ef15
s_mov_b32 s56, 0x3f61c598
s_mov_b32 s57, 0x3ef15aea
s_mov_b32 s58, 0x3f54db31
s_mov_b32 s59, 0x3f0e39da
s_mov_b32 s60, 0x3f45e403
s_mov_b32 s61, 0x3f226799
s_mov_b32 s62, 0x3f3504f3
s_mov_b32 s63, 0x3f3504f3
v_and_b32 v1, 31, v0
v_lshrrev_b32 v2, 5, v0
v_cvt_f32_u32 v3, v1
v_mul_u32_u24 v10, 8448, v2
v_lshl_add_u32 v4, v1, 3, v10
v_mul_u32_u24 v5, 264, v1
v_add_u32 v5, v5, v10
v_and_b32 v11, 7, v0
v_lshrrev_b32 v9, 3, v0
v_mul_u32_u24 v10, 8448, v11
v_lshl_add_u32 v6, v9, 3, v10
v_lshlrev_b32 v7, 3, v9
v_sub_u32 v7, v10, v7
v_add_u32 v7, 4096, v7
v_lshlrev_b32 v8, 14, v9
v_lshl_add_u32 v8, v11, 4, v8
v_mul_f32 v12, 0xba800000, v3
v_cos_f32 v82, v12
v_sin_f32 v83, v12
v_mul_f32 v12, 0xbb000000, v3
v_cos_f32 v84, v12
v_sin_f32 v85, v12
v_mul_f32 v12, 0xbb400000, v3
v_cos_f32 v86, v12
v_sin_f32 v87, v12
v_mul_f32 v12, 0xbb800000, v3
v_cos_f32 v88, v12
v_sin_f32 v89, v12
v_mul_f32 v12, 0xbba00000, v3
v_cos_f32 v90, v12
v_sin_f32 v91, v12
v_mul_f32 v12, 0xbbc00000, v3
v_cos_f32 v92, v12
v_sin_f32 v93, v12
v_mul_f32 v12, 0xbbe00000, v3
v_cos_f32 v94, v12
v_sin_f32 v95, v12
v_mul_f32 v12, 0xbc000000, v3
v_cos_f32 v96, v12
v_sin_f32 v97, v12
v_mul_f32 v12, 0xbc100000, v3
v_cos_f32 v98, v12
v_sin_f32 v99, v12
v_mul_f32 v12, 0xbc200000, v3
v_cos_f32 v100, v12
v_sin_f32 v101, v12
v_mul_f32 v12, 0xbc300000, v3
v_cos_f32 v102, v12
v_sin_f32 v103, v12
v_mul_f32 v12, 0xbc400000, v3
v_cos_f32 v104, v12
v_sin_f32 v105, v12
v_mul_f32 v12, 0xbc500000, v3
v_cos_f32 v106, v12
v_sin_f32 v107, v12
v_mul_f32 v12, 0xbc600000, v3
v_cos_f32 v108, v12
v_sin_f32 v109, v12
v_mul_f32 v12, 0xbc700000, v3
v_cos_f32 v110, v12
v_sin_f32 v111, v12
v_mul_f32 v12, 0xbc800000, v3
v_cos_f32 v112, v12
v_sin_f32 v113, v12
v_mul_f32 v12, 0xbc880000, v3
v_cos_f32 v114, v12
v_sin_f32 v115, v12
v_mul_f32 v12, 0xbc900000, v3
v_cos_f32 v116, v12
v_sin_f32 v117, v12
v_mul_f32 v12, 0xbc980000, v3
v_cos_f32 v118, v12
v_sin_f32 v119, v12
v_mul_f32 v12, 0xbca00000, v3
v_cos_f32 v120, v12
v_sin_f32 v121, v12
v_mul_f32 v12, 0xbca80000, v3
v_cos_f32 v122, v12
v_sin_f32 v123, v12
v_mul_f32 v12, 0xbcb00000, v3
v_cos_f32 v124, v12
v_sin_f32 v125, v12
v_mul_f32 v12, 0xbcb80000, v3
v_cos_f32 v126, v12
v_sin_f32 v127, v12
v_mul_f32 v12, 0xbcc00000, v3
v_cos_f32 v128, v12
v_sin_f32 v129, v12
v_mul_f32 v12, 0xbcc80000, v3
v_cos_f32 v130, v12
v_sin_f32 v131, v12
v_mul_f32 v12, 0xbcd00000, v3
v_cos_f32 v132, v12
v_sin_f32 v133, v12
v_mul_f32 v12, 0xbcd80000, v3
v_cos_f32 v134, v12
v_sin_f32 v135, v12
v_mul_f32 v12, 0xbce00000, v3
v_cos_f32 v136, v12
v_sin_f32 v137, v12
v_mul_f32 v12, 0xbce80000, v3
v_cos_f32 v138, v12
v_sin_f32 v139, v12
v_mul_f32 v12, 0xbcf00000, v3
v_cos_f32 v140, v12
v_sin_f32 v141, v12
v_mul_f32 v12, 0xbcf80000, v3
v_cos_f32 v142, v12
v_sin_f32 v143, v12
v_lshlrev_b32 v12, 12, v2
v_lshl_add_u32 v12, v1, 1, v12
s_waitcnt lgkmcnt(0)
s_mov_b32 s6, 4194304
s_mov_b32 s7, 0x00020000
v_mov_b32 v144, 0
v_mov_b32 v145, 0
v_mov_b32 v146, 0
v_mov_b32 v147, 0
v_mov_b32 v148, 0
v_mov_b32 v149, 0
v_mov_b32 v150, 0
v_mov_b32 v151, 0
v_mov_b32 v152, 0
v_mov_b32 v153, 0
v_mov_b32 v154, 0
v_mov_b32 v155, 0
v_mov_b32 v156, 0
v_mov_b32 v157, 0
v_mov_b32 v158, 0
v_mov_b32 v159, 0
v_mov_b32 v160, 0
v_mov_b32 v161, 0
v_mov_b32 v162, 0
v_mov_b32 v163, 0
v_mov_b32 v164, 0
v_mov_b32 v165, 0
v_mov_b32 v166, 0
v_mov_b32 v167, 0
v_mov_b32 v168, 0
v_mov_b32 v169, 0
v_mov_b32 v170, 0
v_mov_b32 v171, 0
v_mov_b32 v172, 0
v_mov_b32 v173, 0
v_mov_b32 v174, 0
v_mov_b32 v175, 0
v_mov_b32 v176, 0
v_mov_b32 v177, 0
v_mov_b32 v178, 0
v_mov_b32 v179, 0
v_mov_b32 v180, 0
v_mov_b32 v181, 0
v_mov_b32 v182, 0
v_mov_b32 v183, 0
v_mov_b32 v184, 0
v_mov_b32 v185, 0
v_mov_b32 v186, 0
v_mov_b32 v187, 0
v_mov_b32 v188, 0
v_mov_b32 v189, 0
v_mov_b32 v190, 0
v_mov_b32 v191, 0
v_mov_b32 v192, 0
v_mov_b32 v193, 0
v_mov_b32 v194, 0
v_mov_b32 v195, 0
v_mov_b32 v196, 0
v_mov_b32 v197, 0
v_mov_b32 v198, 0
v_mov_b32 v199, 0
v_mov_b32 v200, 0
v_mov_b32 v201, 0
v_mov_b32 v202, 0
v_mov_b32 v203, 0
v_mov_b32 v204, 0
v_mov_b32 v205, 0
v_mov_b32 v206, 0
v_mov_b32 v207, 0
s_cmp_lt_u32 s93, 128
s_cbranch_scc0 mega_kernel_f1_e
s_lshl_b32 s12, s93, 15
buffer_load_short_d16_hi v144, v12, s[4:7], s12 offen offset:0
buffer_load_short_d16_hi v145, v12, s[4:7], s12 offen offset:2048
buffer_load_short_d16_hi v176, v12, s[4:7], s12 offen offset:1024
buffer_load_short_d16_hi v177, v12, s[4:7], s12 offen offset:3072
buffer_load_short_d16_hi v146, v12, s[4:7], s12 offen offset:64
buffer_load_short_d16_hi v147, v12, s[4:7], s12 offen offset:2112
buffer_load_short_d16_hi v178, v12, s[4:7], s12 offen offset:1088
buffer_load_short_d16_hi v179, v12, s[4:7], s12 offen offset:3136
buffer_load_short_d16_hi v148, v12, s[4:7], s12 offen offset:128
buffer_load_short_d16_hi v149, v12, s[4:7], s12 offen offset:2176
buffer_load_short_d16_hi v180, v12, s[4:7], s12 offen offset:1152
buffer_load_short_d16_hi v181, v12, s[4:7], s12 offen offset:3200
buffer_load_short_d16_hi v150, v12, s[4:7], s12 offen offset:192
buffer_load_short_d16_hi v151, v12, s[4:7], s12 offen offset:2240
buffer_load_short_d16_hi v182, v12, s[4:7], s12 offen offset:1216
buffer_load_short_d16_hi v183, v12, s[4:7], s12 offen offset:3264
buffer_load_short_d16_hi v152, v12, s[4:7], s12 offen offset:256
buffer_load_short_d16_hi v153, v12, s[4:7], s12 offen offset:2304
buffer_load_short_d16_hi v184, v12, s[4:7], s12 offen offset:1280
buffer_load_short_d16_hi v185, v12, s[4:7], s12 offen offset:3328
buffer_load_short_d16_hi v154, v12, s[4:7], s12 offen offset:320
buffer_load_short_d16_hi v155, v12, s[4:7], s12 offen offset:2368
buffer_load_short_d16_hi v186, v12, s[4:7], s12 offen offset:1344
buffer_load_short_d16_hi v187, v12, s[4:7], s12 offen offset:3392
buffer_load_short_d16_hi v156, v12, s[4:7], s12 offen offset:384
buffer_load_short_d16_hi v157, v12, s[4:7], s12 offen offset:2432
buffer_load_short_d16_hi v188, v12, s[4:7], s12 offen offset:1408
buffer_load_short_d16_hi v189, v12, s[4:7], s12 offen offset:3456
buffer_load_short_d16_hi v158, v12, s[4:7], s12 offen offset:448
buffer_load_short_d16_hi v159, v12, s[4:7], s12 offen offset:2496
buffer_load_short_d16_hi v190, v12, s[4:7], s12 offen offset:1472
buffer_load_short_d16_hi v191, v12, s[4:7], s12 offen offset:3520
buffer_load_short_d16_hi v160, v12, s[4:7], s12 offen offset:512
buffer_load_short_d16_hi v161, v12, s[4:7], s12 offen offset:2560
buffer_load_short_d16_hi v192, v12, s[4:7], s12 offen offset:1536
buffer_load_short_d16_hi v193, v12, s[4:7], s12 offen offset:3584
buffer_load_short_d16_hi v162, v12, s[4:7], s12 offen offset:576
buffer_load_short_d16_hi v163, v12, s[4:7], s12 offen offset:2624
buffer_load_short_d16_hi v194, v12, s[4:7], s12 offen offset:1600
buffer_load_short_d16_hi v195, v12, s[4:7], s12 offen offset:3648
buffer_load_short_d16_hi v164, v12, s[4:7], s12 offen offset:640
buffer_load_short_d16_hi v165, v12, s[4:7], s12 offen offset:2688
buffer_load_short_d16_hi v196, v12, s[4:7], s12 offen offset:1664
buffer_load_short_d16_hi v197, v12, s[4:7], s12 offen offset:3712
buffer_load_short_d16_hi v166, v12, s[4:7], s12 offen offset:704
buffer_load_short_d16_hi v167, v12, s[4:7], s12 offen offset:2752
buffer_load_short_d16_hi v198, v12, s[4:7], s12 offen offset:1728
buffer_load_short_d16_hi v199, v12, s[4:7], s12 offen offset:3776
buffer_load_short_d16_hi v168, v12, s[4:7], s12 offen offset:768
buffer_load_short_d16_hi v169, v12, s[4:7], s12 offen offset:2816
buffer_load_short_d16_hi v200, v12, s[4:7], s12 offen offset:1792
buffer_load_short_d16_hi v201, v12, s[4:7], s12 offen offset:3840
buffer_load_short_d16_hi v170, v12, s[4:7], s12 offen offset:832
buffer_load_short_d16_hi v171, v12, s[4:7], s12 offen offset:2880
buffer_load_short_d16_hi v202, v12, s[4:7], s12 offen offset:1856
buffer_load_short_d16_hi v203, v12, s[4:7], s12 offen offset:3904
buffer_load_short_d16_hi v172, v12, s[4:7], s12 offen offset:896
buffer_load_short_d16_hi v173, v12, s[4:7], s12 offen offset:2944
buffer_load_short_d16_hi v204, v12, s[4:7], s12 offen offset:1920
buffer_load_short_d16_hi v205, v12, s[4:7], s12 offen offset:3968
buffer_load_short_d16_hi v174, v12, s[4:7], s12 offen offset:960
buffer_load_short_d16_hi v175, v12, s[4:7], s12 offen offset:3008
buffer_load_short_d16_hi v206, v12, s[4:7], s12 offen offset:1984
buffer_load_short_d16_hi v207, v12, s[4:7], s12 offen offset:4032
s_waitcnt vmcnt(0)
mega_kernel_f1_l:
s_add_u32 s21, s93, 32
s_cmp_lt_u32 s21, 128
s_cselect_b32 s22, s21, s93
s_waitcnt vmcnt(17)
v_pk_add_f32 v[48:49], v[144:145], v[176:177] neg_lo:[0,1] neg_hi:[0,1]
v_pk_add_f32 v[16:17], v[144:145], v[176:177]
v_pk_add_f32 v[14:15], v[146:147], v[178:179] neg_lo:[0,1] neg_hi:[0,1]
v_pk_add_f32 v[18:19], v[146:147], v[178:179]
v_pk_mul_f32 v[50:51], v[14:15], s[50:51] op_sel:[0,0] op_sel_hi:[0,1] neg_lo:[0,0] neg_hi:[0,1]
v_pk_fma_f32 v[50:51], v[14:15], s[50:51], v[50:51] op_sel:[1,1,0] op_sel_hi:[1,0,1] neg_lo:[0,0,0] neg_hi:[0,0,0]
v_pk_add_f32 v[14:15], v[148:149], v[180:181] neg_lo:[0,1] neg_hi:[0,1]
v_pk_add_f32 v[20:21], v[148:149], v[180:181]
v_pk_mul_f32 v[52:53], v[14:15], s[54:55] op_sel:[0,0] op_sel_hi:[0,1] neg_lo:[0,0] neg_hi:[0,1]
v_pk_fma_f32 v[52:53], v[14:15], s[54:55], v[52:53] op_sel:[1,1,0] op_sel_hi:[1,0,1] neg_lo:[0,0,0] neg_hi:[0,0,0]
v_pk_add_f32 v[14:15], v[150:151], v[182:183] neg_lo:[0,1] neg_hi:[0,1]
v_pk_add_f32 v[22:23], v[150:151], v[182:183]
v_pk_mul_f32 v[54:55], v[14:15], s[58:59] op_sel:[0,0] op_sel_hi:[0,1] neg_lo:[0,0] neg_hi:[0,1]
v_pk_fma_f32 v[54:55], v[14:15], s[58:59], v[54:55] op_sel:[1,1,0] op_sel_hi:[1,0,1] neg_lo:[0,0,0] neg_hi:[0,0,0]
v_pk_add_f32 v[14:15], v[152:153], v[184:185] neg_lo:[0,1] neg_hi:[0,1]
v_pk_add_f32 v[24:25], v[152:153], v[184:185]
v_pk_mul_f32 v[56:57], v[14:15], s[62:63] op_sel:[0,0] op_sel_hi:[0,1] neg_lo:[0,0] neg_hi:[0,1]
v_pk_fma_f32 v[56:57], v[14:15], s[62:63], v[56:57] op_sel:[1,1,0] op_sel_hi:[1,0,1] neg_lo:[0,0,0] neg_hi:[0,0,0]
v_pk_add_f32 v[14:15], v[154:155], v[186:187] neg_lo:[0,1] neg_hi:[0,1]
v_pk_add_f32 v[26:27], v[154:155], v[186:187]
v_pk_mul_f32 v[58:59], v[14:15], s[58:59] op_sel:[0,1] op_sel_hi:[0,0] neg_lo:[0,0] neg_hi:[0,1]
v_pk_fma_f32 v[58:59], v[14:15], s[58:59], v[58:59] op_sel:[1,0,0] op_sel_hi:[1,1,1] neg_lo:[0,0,0] neg_hi:[0,0,0]
v_pk_add_f32 v[14:15], v[156:157], v[188:189] neg_lo:[0,1] neg_hi:[0,1]
v_pk_add_f32 v[28:29], v[156:157], v[188:189]
v_pk_mul_f32 v[60:61], v[14:15], s[54:55] op_sel:[0,1] op_sel_hi:[0,0] neg_lo:[0,0] neg_hi:[0,1]
v_pk_fma_f32 v[60:61], v[14:15], s[54:55], v[60:61] op_sel:[1,0,0] op_sel_hi:[1,1,1] neg_lo:[0,0,0] neg_hi:[0,0,0]
v_pk_add_f32 v[14:15], v[158:159], v[190:191] neg_lo:[0,1] neg_hi:[0,1]
v_pk_add_f32 v[30:31], v[158:159], v[190:191]
v_pk_mul_f32 v[62:63], v[14:15], s[50:51] op_sel:[0,1] op_sel_hi:[0,0] neg_lo:[0,0] neg_hi:[0,1]
v_pk_fma_f32 v[62:63], v[14:15], s[50:51], v[62:63] op_sel:[1,0,0] op_sel_hi:[1,1,1] neg_lo:[0,0,0] neg_hi:[0,0,0]
v_pk_add_f32 v[64:65], v[160:161], v[192:193] op_sel:[1,1] op_sel_hi:[0,0] neg_lo:[0,1] neg_hi:[1,0]
v_pk_add_f32 v[32:33], v[160:161], v[192:193]
v_pk_add_f32 v[14:15], v[162:163], v[194:195] neg_lo:[0,1] neg_hi:[0,1]
v_pk_add_f32 v[34:35], v[162:163], v[194:195]
v_pk_mul_f32 v[66:67], v[14:15], s[50:51] op_sel:[0,1] op_sel_hi:[0,0] neg_lo:[0,1] neg_hi:[0,1]
v_pk_fma_f32 v[66:67], v[14:15], s[50:51], v[66:67] op_sel:[1,0,0] op_sel_hi:[1,1,1] neg_lo:[0,0,0] neg_hi:[0,1,0]
v_pk_add_f32 v[14:15], v[164:165], v[196:197] neg_lo:[0,1] neg_hi:[0,1]
v_pk_add_f32 v[36:37], v[164:165], v[196:197]
v_pk_mul_f32 v[68:69], v[14:15], s[54:55] op_sel:[0,1] op_sel_hi:[0,0] neg_lo:[0,1] neg_hi:[0,1]
v_pk_fma_f32 v[68:69], v[14:15], s[54:55], v[68:69] op_sel:[1,0,0] op_sel_hi:[1,1,1] neg_lo:[0,0,0] neg_hi:[0,1,0]
v_pk_add_f32 v[14:15], v[166:167], v[198:199] neg_lo:[0,1] neg_hi:[0,1]
v_pk_add_f32 v[38:39], v[166:167], v[198:199]
v_pk_mul_f32 v[70:71], v[14:15], s[58:59] op_sel:[0,1] op_sel_hi:[0,0] neg_lo:[0,1] neg_hi:[0,1]
v_pk_fma_f32 v[70:71], v[14:15], s[58:59], v[70:71] op_sel:[1,0,0] op_sel_hi:[1,1,1] neg_lo:[0,0,0] neg_hi:[0,1,0]
v_pk_add_f32 v[14:15], v[168:169], v[200:201] neg_lo:[0,1] neg_hi:[0,1]
v_pk_add_f32 v[40:41], v[168:169], v[200:201]
v_pk_mul_f32 v[72:73], v[14:15], s[62:63] op_sel:[0,0] op_sel_hi:[0,1] neg_lo:[0,1] neg_hi:[0,1]
v_pk_fma_f32 v[72:73], v[14:15], s[62:63], v[72:73] op_sel:[1,1,0] op_sel_hi:[1,0,1] neg_lo:[0,0,0] neg_hi:[0,1,0]
v_pk_add_f32 v[14:15], v[170:171], v[202:203] neg_lo:[0,1] neg_hi:[0,1]
v_pk_add_f32 v[42:43], v[170:171], v[202:203]
v_pk_mul_f32 v[74:75], v[14:15], s[58:59] op_sel:[0,0] op_sel_hi:[0,1] neg_lo:[0,1] neg_hi:[0,1]
v_pk_fma_f32 v[74:75], v[14:15], s[58:59], v[74:75] op_sel:[1,1,0] op_sel_hi:[1,0,1] neg_lo:[0,0,0] neg_hi:[0,1,0]
v_pk_add_f32 v[14:15], v[172:173], v[204:205] neg_lo:[0,1] neg_hi:[0,1]
v_pk_add_f32 v[44:45], v[172:173], v[204:205]
v_pk_mul_f32 v[76:77], v[14:15], s[54:55] op_sel:[0,0] op_sel_hi:[0,1] neg_lo:[0,1] neg_hi:[0,1]
v_pk_fma_f32 v[76:77], v[14:15], s[54:55], v[76:77] op_sel:[1,1,0] op_sel_hi:[1,0,1] neg_lo:[0,0,0] neg_hi:[0,1,0]
v_pk_add_f32 v[14:15], v[174:175], v[206:207] neg_lo:[0,1] neg_hi:[0,1]
v_pk_add_f32 v[46:47], v[174:175], v[206:207]
v_pk_mul_f32 v[78:79], v[14:15], s[50:51] op_sel:[0,0] op_sel_hi:[0,1] neg_lo:[0,1] neg_hi:[0,1]
v_pk_fma_f32 v[78:79], v[14:15], s[50:51], v[78:79] op_sel:[1,1,0] op_sel_hi:[1,0,1] neg_lo:[0,0,0] neg_hi:[0,1,0]
s_lshl_b32 s12, s22, 15
buffer_load_short_d16_hi v144, v12, s[4:7], s12 offen offset:0
buffer_load_short_d16_hi v145, v12, s[4:7], s12 offen offset:2048
buffer_load_short_d16_hi v176, v12, s[4:7], s12 offen offset:1024
buffer_load_short_d16_hi v177, v12, s[4:7], s12 offen offset:3072
buffer_load_short_d16_hi v146, v12, s[4:7], s12 offen offset:64
buffer_load_short_d16_hi v147, v12, s[4:7], s12 offen offset:2112
buffer_load_short_d16_hi v178, v12, s[4:7], s12 offen offset:1088
buffer_load_short_d16_hi v179, v12, s[4:7], s12 offen offset:3136
buffer_load_short_d16_hi v148, v12, s[4:7], s12 offen offset:128
buffer_load_short_d16_hi v149, v12, s[4:7], s12 offen offset:2176
buffer_load_short_d16_hi v180, v12, s[4:7], s12 offen offset:1152
buffer_load_short_d16_hi v181, v12, s[4:7], s12 offen offset:3200
buffer_load_short_d16_hi v150, v12, s[4:7], s12 offen offset:192
buffer_load_short_d16_hi v151, v12, s[4:7], s12 offen offset:2240
buffer_load_short_d16_hi v182, v12, s[4:7], s12 offen offset:1216
buffer_load_short_d16_hi v183, v12, s[4:7], s12 offen offset:3264
buffer_load_short_d16_hi v152, v12, s[4:7], s12 offen offset:256
buffer_load_short_d16_hi v153, v12, s[4:7], s12 offen offset:2304
buffer_load_short_d16_hi v184, v12, s[4:7], s12 offen offset:1280
buffer_load_short_d16_hi v185, v12, s[4:7], s12 offen offset:3328
buffer_load_short_d16_hi v154, v12, s[4:7], s12 offen offset:320
buffer_load_short_d16_hi v155, v12, s[4:7], s12 offen offset:2368
buffer_load_short_d16_hi v186, v12, s[4:7], s12 offen offset:1344
buffer_load_short_d16_hi v187, v12, s[4:7], s12 offen offset:3392
buffer_load_short_d16_hi v156, v12, s[4:7], s12 offen offset:384
buffer_load_short_d16_hi v157, v12, s[4:7], s12 offen offset:2432
buffer_load_short_d16_hi v188, v12, s[4:7], s12 offen offset:1408
buffer_load_short_d16_hi v189, v12, s[4:7], s12 offen offset:3456
buffer_load_short_d16_hi v158, v12, s[4:7], s12 offen offset:448
buffer_load_short_d16_hi v159, v12, s[4:7], s12 offen offset:2496
buffer_load_short_d16_hi v190, v12, s[4:7], s12 offen offset:1472
buffer_load_short_d16_hi v191, v12, s[4:7], s12 offen offset:3520
buffer_load_short_d16_hi v160, v12, s[4:7], s12 offen offset:512
buffer_load_short_d16_hi v161, v12, s[4:7], s12 offen offset:2560
buffer_load_short_d16_hi v192, v12, s[4:7], s12 offen offset:1536
buffer_load_short_d16_hi v193, v12, s[4:7], s12 offen offset:3584
buffer_load_short_d16_hi v162, v12, s[4:7], s12 offen offset:576
buffer_load_short_d16_hi v163, v12, s[4:7], s12 offen offset:2624
buffer_load_short_d16_hi v194, v12, s[4:7], s12 offen offset:1600
buffer_load_short_d16_hi v195, v12, s[4:7], s12 offen offset:3648
buffer_load_short_d16_hi v164, v12, s[4:7], s12 offen offset:640
buffer_load_short_d16_hi v165, v12, s[4:7], s12 offen offset:2688
buffer_load_short_d16_hi v196, v12, s[4:7], s12 offen offset:1664
buffer_load_short_d16_hi v197, v12, s[4:7], s12 offen offset:3712
buffer_load_short_d16_hi v166, v12, s[4:7], s12 offen offset:704
buffer_load_short_d16_hi v167, v12, s[4:7], s12 offen offset:2752
buffer_load_short_d16_hi v198, v12, s[4:7], s12 offen offset:1728
buffer_load_short_d16_hi v199, v12, s[4:7], s12 offen offset:3776
buffer_load_short_d16_hi v168, v12, s[4:7], s12 offen offset:768
buffer_load_short_d16_hi v169, v12, s[4:7], s12 offen offset:2816
buffer_load_short_d16_hi v200, v12, s[4:7], s12 offen offset:1792
buffer_load_short_d16_hi v201, v12, s[4:7], s12 offen offset:3840
buffer_load_short_d16_hi v170, v12, s[4:7], s12 offen offset:832
buffer_load_short_d16_hi v171, v12, s[4:7], s12 offen offset:2880
buffer_load_short_d16_hi v202, v12, s[4:7], s12 offen offset:1856
buffer_load_short_d16_hi v203, v12, s[4:7], s12 offen offset:3904
buffer_load_short_d16_hi v172, v12, s[4:7], s12 offen offset:896
buffer_load_short_d16_hi v173, v12, s[4:7], s12 offen offset:2944
buffer_load_short_d16_hi v204, v12, s[4:7], s12 offen offset:1920
buffer_load_short_d16_hi v205, v12, s[4:7], s12 offen offset:3968
buffer_load_short_d16_hi v174, v12, s[4:7], s12 offen offset:960
buffer_load_short_d16_hi v175, v12, s[4:7], s12 offen offset:3008
buffer_load_short_d16_hi v206, v12, s[4:7], s12 offen offset:1984
buffer_load_short_d16_hi v207, v12, s[4:7], s12 offen offset:4032
v_pk_add_f32 v[14:15], v[16:17], v[32:33] neg_lo:[0,1] neg_hi:[0,1]
v_pk_add_f32 v[16:17], v[16:17], v[32:33]
v_pk_add_f32 v[32:33], v[18:19], v[34:35] neg_lo:[0,1] neg_hi:[0,1]
v_pk_add_f32 v[18:19], v[18:19], v[34:35]
v_pk_mul_f32 v[34:35], v[32:33], s[54:55] op_sel:[0,0] op_sel_hi:[0,1] neg_lo:[0,0] neg_hi:[0,1]
v_pk_fma_f32 v[34:35], v[32:33], s[54:55], v[34:35] op_sel:[1,1,0] op_sel_hi:[1,0,1] neg_lo:[0,0,0] neg_hi:[0,0,0]
v_pk_add_f32 v[32:33], v[20:21], v[36:37] neg_lo:[0,1] neg_hi:[0,1]
v_pk_add_f32 v[20:21], v[20:21], v[36:37]
v_pk_mul_f32 v[36:37], v[32:33], s[62:63] op_sel:[0,0] op_sel_hi:[0,1] neg_lo:[0,0] neg_hi:[0,1]
v_pk_fma_f32 v[36:37], v[32:33], s[62:63], v[36:37] op_sel:[1,1,0] op_sel_hi:[1,0,1] neg_lo:[0,0,0] neg_hi:[0,0,0]
v_pk_add_f32 v[32:33], v[22:23], v[38:39] neg_lo:[0,1] neg_hi:[0,1]
v_pk_add_f32 v[22:23], v[22:23], v[38:39]
v_pk_mul_f32 v[38:39], v[32:33], s[54:55] op_sel:[0,1] op_sel_hi:[0,0] neg_lo:[0,0] neg_hi:[0,1]
v_pk_fma_f32 v[38:39], v[32:33], s[54:55], v[38:39] op_sel:[1,0,0] op_sel_hi:[1,1,1] neg_lo:[0,0,0] neg_hi:[0,0,0]
v_pk_add_f32 v[32:33], v[24:25], v[40:41] op_sel:[1,1] op_sel_hi:[0,0] neg_lo:[0,1] neg_hi:[1,0]
v_pk_add_f32 v[24:25], v[24:25], v[40:41]
v_pk_add_f32 v[40:41], v[26:27], v[42:43] neg_lo:[0,1] neg_hi:[0,1]
v_pk_add_f32 v[26:27], v[26:27], v[42:43]
v_pk_mul_f32 v[42:43], v[40:41], s[54:55] op_sel:[0,1] op_sel_hi:[0,0] neg_lo:[0,1] neg_hi:[0,1]
v_pk_fma_f32 v[42:43], v[40:41], s[54:55], v[42:43] op_sel:[1,0,0] op_sel_hi:[1,1,1] neg_lo:[0,0,0] neg_hi:[0,1,0]
v_pk_add_f32 v[40:41], v[28:29], v[44:45] neg_lo:[0,1] neg_hi:[0,1]
v_pk_add_f32 v[28:29], v[28:29], v[44:45]
v_pk_mul_f32 v[44:45], v[40:41], s[62:63] op_sel:[0,0] op_sel_hi:[0,1] neg_lo:[0,1] neg_hi:[0,1]
v_pk_fma_f32 v[44:45], v[40:41], s[62:63], v[44:45] op_sel:[1,1,0] op_sel_hi:[1,0,1] neg_lo:[0,0,0] neg_hi:[0,1,0]
v_pk_add_f32 v[40:41], v[30:31], v[46:47] neg_lo:[0,1] neg_hi:[0,1]
v_pk_add_f32 v[30:31], v[30:31], v[46:47]
v_pk_mul_f32 v[46:47], v[40:41], s[54:55] op_sel:[0,0] op_sel_hi:[0,1] neg_lo:[0,1] neg_hi:[0,1]
v_pk_fma_f32 v[46:47], v[40:41], s[54:55], v[46:47] op_sel:[1,1,0] op_sel_hi:[1,0,1] neg_lo:[0,0,0] neg_hi:[0,1,0]
v_pk_add_f32 v[40:41], v[48:49], v[64:65] neg_lo:[0,1] neg_hi:[0,1]
v_pk_add_f32 v[48:49], v[48:49], v[64:65]
v_pk_add_f32 v[64:65], v[50:51], v[66:67] neg_lo:[0,1] neg_hi:[0,1]
v_pk_add_f32 v[50:51], v[50:51], v[66:67]
v_pk_mul_f32 v[66:67], v[64:65], s[54:55] op_sel:[0,0] op_sel_hi:[0,1] neg_lo:[0,0] neg_hi:[0,1]
v_pk_fma_f32 v[66:67], v[64:65], s[54:55], v[66:67] op_sel:[1,1,0] op_sel_hi:[1,0,1] neg_lo:[0,0,0] neg_hi:[0,0,0]
v_pk_add_f32 v[64:65], v[52:53], v[68:69] neg_lo:[0,1] neg_hi:[0,1]
v_pk_add_f32 v[52:53], v[52:53], v[68:69]
v_pk_mul_f32 v[68:69], v[64:65], s[62:63] op_sel:[0,0] op_sel_hi:[0,1] neg_lo:[0,0] neg_hi:[0,1]
v_pk_fma_f32 v[68:69], v[64:65], s[62:63], v[68:69] op_sel:[1,1,0] op_sel_hi:[1,0,1] neg_lo:[0,0,0] neg_hi:[0,0,0]
v_pk_add_f32 v[64:65], v[54:55], v[70:71] neg_lo:[0,1] neg_hi:[0,1]
v_pk_add_f32 v[54:55], v[54:55], v[70:71]
v_pk_mul_f32 v[70:71], v[64:65], s[54:55] op_sel:[0,1] op_sel_hi:[0,0] neg_lo:[0,0] neg_hi:[0,1]
v_pk_fma_f32 v[70:71], v[64:65], s[54:55], v[70:71] op_sel:[1,0,0] op_sel_hi:[1,1,1] neg_lo:[0,0,0] neg_hi:[0,0,0]
v_pk_add_f32 v[64:65], v[56:57], v[72:73] op_sel:[1,1] op_sel_hi:[0,0] neg_lo:[0,1] neg_hi:[1,0]
v_pk_add_f32 v[56:57], v[56:57], v[72:73]
v_pk_add_f32 v[72:73], v[58:59], v[74:75] neg_lo:[0,1] neg_hi:[0,1]
v_pk_add_f32 v[58:59], v[58:59], v[74:75]
v_pk_mul_f32 v[74:75], v[72:73], s[54:55] op_sel:[0,1] op_sel_hi:[0,0] neg_lo:[0,1] neg_hi:[0,1]
v_pk_fma_f32 v[74:75], v[72:73], s[54:55], v[74:75] op_sel:[1,0,0] op_sel_hi:[1,1,1] neg_lo:[0,0,0] neg_hi:[0,1,0]
v_pk_add_f32 v[72:73], v[60:61], v[76:77] neg_lo:[0,1] neg_hi:[0,1]
v_pk_add_f32 v[60:61], v[60:61], v[76:77]
v_pk_mul_f32 v[76:77], v[72:73], s[62:63] op_sel:[0,0] op_sel_hi:[0,1] neg_lo:[0,1] neg_hi:[0,1]
v_pk_fma_f32 v[76:77], v[72:73], s[62:63], v[76:77] op_sel:[1,1,0] op_sel_hi:[1,0,1] neg_lo:[0,0,0] neg_hi:[0,1,0]
v_pk_add_f32 v[72:73], v[62:63], v[78:79] neg_lo:[0,1] neg_hi:[0,1]
v_pk_add_f32 v[62:63], v[62:63], v[78:79]
v_pk_mul_f32 v[78:79], v[72:73], s[54:55] op_sel:[0,0] op_sel_hi:[0,1] neg_lo:[0,1] neg_hi:[0,1]
v_pk_fma_f32 v[78:79], v[72:73], s[54:55], v[78:79] op_sel:[1,1,0] op_sel_hi:[1,0,1] neg_lo:[0,0,0] neg_hi:[0,1,0]
v_pk_add_f32 v[72:73], v[16:17], v[24:25] neg_lo:[0,1] neg_hi:[0,1]
v_pk_add_f32 v[16:17], v[16:17], v[24:25]
v_pk_add_f32 v[24:25], v[18:19], v[26:27] neg_lo:[0,1] neg_hi:[0,1]
v_pk_add_f32 v[18:19], v[18:19], v[26:27]
v_pk_mul_f32 v[26:27], v[24:25], s[62:63] op_sel:[0,0] op_sel_hi:[0,1] neg_lo:[0,0] neg_hi:[0,1]
v_pk_fma_f32 v[26:27], v[24:25], s[62:63], v[26:27] op_sel:[1,1,0] op_sel_hi:[1,0,1] neg_lo:[0,0,0] neg_hi:[0,0,0]
v_pk_add_f32 v[24:25], v[20:21], v[28:29] op_sel:[1,1] op_sel_hi:[0,0] neg_lo:[0,1] neg_hi:[1,0]
v_pk_add_f32 v[20:21], v[20:21], v[28:29]
v_pk_add_f32 v[28:29], v[22:23], v[30:31] neg_lo:[0,1] neg_hi:[0,1]
v_pk_add_f32 v[22:23], v[22:23], v[30:31]
v_pk_mul_f32 v[30:31], v[28:29], s[62:63] op_sel:[0,0] op_sel_hi:[0,1] neg_lo:[0,1] neg_hi:[0,1]
v_pk_fma_f32 v[30:31], v[28:29], s[62:63], v[30:31] op_sel:[1,1,0] op_sel_hi:[1,0,1] neg_lo:[0,0,0] neg_hi:[0,1,0]
v_pk_add_f32 v[28:29], v[14:15], v[32:33] neg_lo:[0,1] neg_hi:[0,1]
v_pk_add_f32 v[14:15], v[14:15], v[32:33]
v_pk_add_f32 v[32:33], v[34:35], v[42:43] neg_lo:[0,1] neg_hi:[0,1]
v_pk_add_f32 v[34:35], v[34:35], v[42:43]
v_pk_mul_f32 v[42:43], v[32:33], s[62:63] op_sel:[0,0] op_sel_hi:[0,1] neg_lo:[0,0] neg_hi:[0,1]
v_pk_fma_f32 v[42:43], v[32:33], s[62:63], v[42:43] op_sel:[1,1,0] op_sel_hi:[1,0,1] neg_lo:[0,0,0] neg_hi:[0,0,0]
v_pk_add_f32 v[32:33], v[36:37], v[44:45] op_sel:[1,1] op_sel_hi:[0,0] neg_lo:[0,1] neg_hi:[1,0]
v_pk_add_f32 v[36:37], v[36:37], v[44:45]
v_pk_add_f32 v[44:45], v[38:39], v[46:47] neg_lo:[0,1] neg_hi:[0,1]
v_pk_add_f32 v[38:39], v[38:39], v[46:47]
v_pk_mul_f32 v[46:47], v[44:45], s[62:63] op_sel:[0,0] op_sel_hi:[0,1] neg_lo:[0,1] neg_hi:[0,1]
v_pk_fma_f32 v[46:47], v[44:45], s[62:63], v[46:47] op_sel:[1,1,0] op_sel_hi:[1,0,1] neg_lo:[0,0,0] neg_hi:[0,1,0]
v_pk_add_f32 v[44:45], v[48:49], v[56:57] neg_lo:[0,1] neg_hi:[0,1]
v_pk_add_f32 v[48:49], v[48:49], v[56:57]
v_pk_add_f32 v[56:57], v[50:51], v[58:59] neg_lo:[0,1] neg_hi:[0,1]
v_pk_add_f32 v[50:51], v[50:51], v[58:59]
v_pk_mul_f32 v[58:59], v[56:57], s[62:63] op_sel:[0,0] op_sel_hi:[0,1] neg_lo:[0,0] neg_hi:[0,1]
v_pk_fma_f32 v[58:59], v[56:57], s[62:63], v[58:59] op_sel:[1,1,0] op_sel_hi:[1,0,1] neg_lo:[0,0,0] neg_hi:[0,0,0]
v_pk_add_f32 v[56:57], v[52:53], v[60:61] op_sel:[1,1] op_sel_hi:[0,0] neg_lo:[0,1] neg_hi:[1,0]
v_pk_add_f32 v[52:53], v[52:53], v[60:61]
v_pk_add_f32 v[60:61], v[54:55], v[62:63] neg_lo:[0,1] neg_hi:[0,1]
v_pk_add_f32 v[54:55], v[54:55], v[62:63]
v_pk_mul_f32 v[62:63], v[60:61], s[62:63] op_sel:[0,0] op_sel_hi:[0,1] neg_lo:[0,1] neg_hi:[0,1]
v_pk_fma_f32 v[62:63], v[60:61], s[62:63], v[62:63] op_sel:[1,1,0] op_sel_hi:[1,0,1] neg_lo:[0,0,0] neg_hi:[0,1,0]
v_pk_add_f32 v[60:61], v[40:41], v[64:65] neg_lo:[0,1] neg_hi:[0,1]
v_pk_add_f32 v[40:41], v[40:41], v[64:65]
v_pk_add_f32 v[64:65], v[66:67], v[74:75] neg_lo:[0,1] neg_hi:[0,1]
v_pk_add_f32 v[66:67], v[66:67], v[74:75]
v_pk_mul_f32 v[74:75], v[64:65], s[62:63] op_sel:[0,0] op_sel_hi:[0,1] neg_lo:[0,0] neg_hi:[0,1]
v_pk_fma_f32 v[74:75], v[64:65], s[62:63], v[74:75] op_sel:[1,1,0] op_sel_hi:[1,0,1] neg_lo:[0,0,0] neg_hi:[0,0,0]
v_pk_add_f32 v[64:65], v[68:69], v[76:77] op_sel:[1,1] op_sel_hi:[0,0] neg_lo:[0,1] neg_hi:[1,0]
v_pk_add_f32 v[68:69], v[68:69], v[76:77]
v_pk_add_f32 v[76:77], v[70:71], v[78:79] neg_lo:[0,1] neg_hi:[0,1]
v_pk_add_f32 v[70:71], v[70:71], v[78:79]
v_pk_mul_f32 v[78:79], v[76:77], s[62:63] op_sel:[0,0] op_sel_hi:[0,1] neg_lo:[0,1] neg_hi:[0,1]
v_pk_fma_f32 v[78:79], v[76:77], s[62:63], v[78:79] op_sel:[1,1,0] op_sel_hi:[1,0,1] neg_lo:[0,0,0] neg_hi:[0,1,0]
v_pk_add_f32 v[76:77], v[16:17], v[20:21] neg_lo:[0,1] neg_hi:[0,1]
v_pk_add_f32 v[16:17], v[16:17], v[20:21]
v_pk_add_f32 v[20:21], v[18:19], v[22:23] op_sel:[1,1] op_sel_hi:[0,0] neg_lo:[0,1] neg_hi:[1,0]
v_pk_add_f32 v[18:19], v[18:19], v[22:23]
v_pk_add_f32 v[22:23], v[72:73], v[24:25] neg_lo:[0,1] neg_hi:[0,1]
v_pk_add_f32 v[72:73], v[72:73], v[24:25]
v_pk_add_f32 v[24:25], v[26:27], v[30:31] op_sel:[1,1] op_sel_hi:[0,0] neg_lo:[0,1] neg_hi:[1,0]
v_pk_add_f32 v[26:27], v[26:27], v[30:31]
v_pk_add_f32 v[30:31], v[14:15], v[36:37] neg_lo:[0,1] neg_hi:[0,1]
v_pk_add_f32 v[14:15], v[14:15], v[36:37]
v_pk_add_f32 v[36:37], v[34:35], v[38:39] op_sel:[1,1] op_sel_hi:[0,0] neg_lo:[0,1] neg_hi:[1,0]
v_pk_add_f32 v[34:35], v[34:35], v[38:39]
v_pk_add_f32 v[38:39], v[28:29], v[32:33] neg_lo:[0,1] neg_hi:[0,1]
v_pk_add_f32 v[28:29], v[28:29], v[32:33]
v_pk_add_f32 v[32:33], v[42:43], v[46:47] op_sel:[1,1] op_sel_hi:[0,0] neg_lo:[0,1] neg_hi:[1,0]
v_pk_add_f32 v[42:43], v[42:43], v[46:47]
v_pk_add_f32 v[46:47], v[48:49], v[52:53] neg_lo:[0,1] neg_hi:[0,1]
v_pk_add_f32 v[48:49], v[48:49], v[52:53]
v_pk_add_f32 v[52:53], v[50:51], v[54:55] op_sel:[1,1] op_sel_hi:[0,0] neg_lo:[0,1] neg_hi:[1,0]
v_pk_add_f32 v[50:51], v[50:51], v[54:55]
v_pk_add_f32 v[54:55], v[44:45], v[56:57] neg_lo:[0,1] neg_hi:[0,1]
v_pk_add_f32 v[44:45], v[44:45], v[56:57]
v_pk_add_f32 v[56:57], v[58:59], v[62:63] op_sel:[1,1] op_sel_hi:[0,0] neg_lo:[0,1] neg_hi:[1,0]
v_pk_add_f32 v[58:59], v[58:59], v[62:63]
v_pk_add_f32 v[62:63], v[40:41], v[68:69] neg_lo:[0,1] neg_hi:[0,1]
v_pk_add_f32 v[40:41], v[40:41], v[68:69]
v_pk_add_f32 v[68:69], v[66:67], v[70:71] op_sel:[1,1] op_sel_hi:[0,0] neg_lo:[0,1] neg_hi:[1,0]
v_pk_add_f32 v[66:67], v[66:67], v[70:71]
v_pk_add_f32 v[70:71], v[60:61], v[64:65] neg_lo:[0,1] neg_hi:[0,1]
v_pk_add_f32 v[60:61], v[60:61], v[64:65]
v_pk_add_f32 v[64:65], v[74:75], v[78:79] op_sel:[1,1] op_sel_hi:[0,0] neg_lo:[0,1] neg_hi:[1,0]
v_pk_add_f32 v[74:75], v[74:75], v[78:79]
v_pk_add_f32 v[78:79], v[16:17], v[18:19] neg_lo:[0,1] neg_hi:[0,1]
v_pk_add_f32 v[16:17], v[16:17], v[18:19]
v_pk_add_f32 v[18:19], v[76:77], v[20:21] neg_lo:[0,1] neg_hi:[0,1]
v_pk_add_f32 v[76:77], v[76:77], v[20:21]
v_pk_add_f32 v[20:21], v[72:73], v[26:27] neg_lo:[0,1] neg_hi:[0,1]
v_pk_add_f32 v[72:73], v[72:73], v[26:27]
v_pk_add_f32 v[26:27], v[22:23], v[24:25] neg_lo:[0,1] neg_hi:[0,1]
v_pk_add_f32 v[22:23], v[22:23], v[24:25]
v_pk_add_f32 v[24:25], v[14:15], v[34:35] neg_lo:[0,1] neg_hi:[0,1]
v_pk_add_f32 v[14:15], v[14:15], v[34:35]
v_pk_add_f32 v[34:35], v[30:31], v[36:37] neg_lo:[0,1] neg_hi:[0,1]
v_pk_add_f32 v[30:31], v[30:31], v[36:37]
v_pk_add_f32 v[36:37], v[28:29], v[42:43] neg_lo:[0,1] neg_hi:[0,1]
v_pk_add_f32 v[28:29], v[28:29], v[42:43]
v_pk_add_f32 v[42:43], v[38:39], v[32:33] neg_lo:[0,1] neg_hi:[0,1]
v_pk_add_f32 v[38:39], v[38:39], v[32:33]
v_pk_add_f32 v[32:33], v[48:49], v[50:51] neg_lo:[0,1] neg_hi:[0,1]
v_pk_add_f32 v[48:49], v[48:49], v[50:51]
v_pk_add_f32 v[50:51], v[46:47], v[52:53] neg_lo:[0,1] neg_hi:[0,1]
v_pk_add_f32 v[46:47], v[46:47], v[52:53]
v_pk_add_f32 v[52:53], v[44:45], v[58:59] neg_lo:[0,1] neg_hi:[0,1]
v_pk_add_f32 v[44:45], v[44:45], v[58:59]
v_pk_add_f32 v[58:59], v[54:55], v[56:57] neg_lo:[0,1] neg_hi:[0,1]
v_pk_add_f32 v[54:55], v[54:55], v[56:57]
v_pk_add_f32 v[56:57], v[40:41], v[66:67] neg_lo:[0,1] neg_hi:[0,1]
v_pk_add_f32 v[40:41], v[40:41], v[66:67]
v_pk_add_f32 v[66:67], v[62:63], v[68:69] neg_lo:[0,1] neg_hi:[0,1]
v_pk_add_f32 v[62:63], v[62:63], v[68:69]
v_pk_add_f32 v[68:69], v[60:61], v[74:75] neg_lo:[0,1] neg_hi:[0,1]
v_pk_add_f32 v[60:61], v[60:61], v[74:75]
v_pk_add_f32 v[74:75], v[70:71], v[64:65] neg_lo:[0,1] neg_hi:[0,1]
v_pk_add_f32 v[70:71], v[70:71], v[64:65]
v_pk_mul_f32 v[64:65], v[48:49], v[82:83] op_sel:[0,0] op_sel_hi:[0,1] neg_lo:[0,0] neg_hi:[0,0]
v_pk_fma_f32 v[48:49], v[48:49], v[82:83], v[64:65] op_sel:[1,1,0] op_sel_hi:[1,0,1] neg_lo:[0,1,0] neg_hi:[0,0,0]
v_pk_mul_f32 v[64:65], v[14:15], v[84:85] op_sel:[0,0] op_sel_hi:[0,1] neg_lo:[0,0] neg_hi:[0,0]
v_pk_fma_f32 v[14:15], v[14:15], v[84:85], v[64:65] op_sel:[1,1,0] op_sel_hi:[1,0,1] neg_lo:[0,1,0] neg_hi:[0,0,0]
v_pk_mul_f32 v[64:65], v[40:41], v[86:87] op_sel:[0,0] op_sel_hi:[0,1] neg_lo:[0,0] neg_hi:[0,0]
v_pk_fma_f32 v[40:41], v[40:41], v[86:87], v[64:65] op_sel:[1,1,0] op_sel_hi:[1,0,1] neg_lo:[0,1,0] neg_hi:[0,0,0]
v_pk_mul_f32 v[64:65], v[72:73], v[88:89] op_sel:[0,0] op_sel_hi:[0,1] neg_lo:[0,0] neg_hi:[0,0]
v_pk_fma_f32 v[72:73], v[72:73], v[88:89], v[64:65] op_sel:[1,1,0] op_sel_hi:[1,0,1] neg_lo:[0,1,0] neg_hi:[0,0,0]
v_pk_mul_f32 v[64:65], v[44:45], v[90:91] op_sel:[0,0] op_sel_hi:[0,1] neg_lo:[0,0] neg_hi:[0,0]
v_pk_fma_f32 v[44:45], v[44:45], v[90:91], v[64:65] op_sel:[1,1,0] op_sel_hi:[1,0,1] neg_lo:[0,1,0] neg_hi:[0,0,0]
v_pk_mul_f32 v[64:65], v[28:29], v[92:93] op_sel:[0,0] op_sel_hi:[0,1] neg_lo:[0,0] neg_hi:[0,0]
v_pk_fma_f32 v[28:29], v[28:29], v[92:93], v[64:65] op_sel:[1,1,0] op_sel_hi:[1,0,1] neg_lo:[0,1,0] neg_hi:[0,0,0]
v_pk_mul_f32 v[64:65], v[60:61], v[94:95] op_sel:[0,0] op_sel_hi:[0,1] neg_lo:[0,0] neg_hi:[0,0]
v_pk_fma_f32 v[60:61], v[60:61], v[94:95], v[64:65] op_sel:[1,1,0] op_sel_hi:[1,0,1] neg_lo:[0,1,0] neg_hi:[0,0,0]
v_pk_mul_f32 v[64:65], v[76:77], v[96:97] op_sel:[0,0] op_sel_hi:[0,1] neg_lo:[0,0] neg_hi:[0,0]
v_pk_fma_f32 v[76:77], v[76:77], v[96:97], v[64:65] op_sel:[1,1,0] op_sel_hi:[1,0,1] neg_lo:[0,1,0] neg_hi:[0,0,0]
v_pk_mul_f32 v[64:65], v[46:47], v[98:99] op_sel:[0,0] op_sel_hi:[0,1] neg_lo:[0,0] neg_hi:[0,0]
v_pk_fma_f32 v[46:47], v[46:47], v[98:99], v[64:65] op_sel:[1,1,0] op_sel_hi:[1,0,1] neg_lo:[0,1,0] neg_hi:[0,0,0]
v_pk_mul_f32 v[64:65], v[30:31], v[100:101] op_sel:[0,0] op_sel_hi:[0,1] neg_lo:[0,0] neg_hi:[0,0]
v_pk_fma_f32 v[30:31], v[30:31], v[100:101], v[64:65] op_sel:[1,1,0] op_sel_hi:[1,0,1] neg_lo:[0,1,0] neg_hi:[0,0,0]
v_pk_mul_f32 v[64:65], v[62:63], v[102:103] op_sel:[0,0] op_sel_hi:[0,1] neg_lo:[0,0] neg_hi:[0,0]
v_pk_fma_f32 v[62:63], v[62:63], v[102:103], v[64:65] op_sel:[1,1,0] op_sel_hi:[1,0,1] neg_lo:[0,1,0] neg_hi:[0,0,0]
v_pk_mul_f32 v[64:65], v[22:23], v[104:105] op_sel:[0,0] op_sel_hi:[0,1] neg_lo:[0,0] neg_hi:[0,0]
v_pk_fma_f32 v[22:23], v[22:23], v[104:105], v[64:65] op_sel:[1,1,0] op_sel_hi:[1,0,1] neg_lo:[0,1,0] neg_hi:[0,0,0]
v_pk_mul_f32 v[64:65], v[54:55], v[106:107] op_sel:[0,0] op_sel_hi:[0,1] neg_lo:[0,0] neg_hi:[0,0]
v_pk_fma_f32 v[54:55], v[54:55], v[106:107], v[64:65] op_sel:[1,1,0] op_sel_hi:[1,0,1] neg_lo:[0,1,0] neg_hi:[0,0,0]
v_pk_mul_f32 v[64:65], v[38:39], v[108:109] op_sel:[0,0] op_sel_hi:[0,1] neg_lo:[0,0] neg_hi:[0,0]
v_pk_fma_f32 v[38:39], v[38:39], v[108:109], v[64:65] op_sel:[1,1,0] op_sel_hi:[1,0,1] neg_lo:[0,1,0] neg_hi:[0,0,0]
v_pk_mul_f32 v[64:65], v[70:71], v[110:111] op_sel:[0,0] op_sel_hi:[0,1] neg_lo:[0,0] neg_hi:[0,0]
v_pk_fma_f32 v[70:71], v[70:71], v[110:111], v[64:65] op_sel:[1,1,0] op_sel_hi:[1,0,1] neg_lo:[0,1,0] neg_hi:[0,0,0]
v_pk_mul_f32 v[64:65], v[78:79], v[112:113] op_sel:[0,0] op_sel_hi:[0,1] neg_lo:[0,0] neg_hi:[0,0]
v_pk_fma_f32 v[78:79], v[78:79], v[112:113], v[64:65] op_sel:[1,1,0] op_sel_hi:[1,0,1] neg_lo:[0,1,0] neg_hi:[0,0,0]
v_pk_mul_f32 v[64:65], v[32:33], v[114:115] op_sel:[0,0] op_sel_hi:[0,1] neg_lo:[0,0] neg_hi:[0,0]
v_pk_fma_f32 v[32:33], v[32:33], v[114:115], v[64:65] op_sel:[1,1,0] op_sel_hi:[1,0,1] neg_lo:[0,1,0] neg_hi:[0,0,0]
v_pk_mul_f32 v[64:65], v[24:25], v[116:117] op_sel:[0,0] op_sel_hi:[0,1] neg_lo:[0,0] neg_hi:[0,0]
v_pk_fma_f32 v[24:25], v[24:25], v[116:117], v[64:65] op_sel:[1,1,0] op_sel_hi:[1,0,1] neg_lo:[0,1,0] neg_hi:[0,0,0]
v_pk_mul_f32 v[64:65], v[56:57], v[118:119] op_sel:[0,0] op_sel_hi:[0,1] neg_lo:[0,0] neg_hi:[0,0]
v_pk_fma_f32 v[56:57], v[56:57], v[118:119], v[64:65] op_sel:[1,1,0] op_sel_hi:[1,0,1] neg_lo:[0,1,0] neg_hi:[0,0,0]
v_pk_mul_f32 v[64:65], v[20:21], v[120:121] op_sel:[0,0] op_sel_hi:[0,1] neg_lo:[0,0] neg_hi:[0,0]
v_pk_fma_f32 v[20:21], v[20:21], v[120:121], v[64:65] op_sel:[1,1,0] op_sel_hi:[1,0,1] neg_lo:[0,1,0] neg_hi:[0,0,0]
v_pk_mul_f32 v[64:65], v[52:53], v[122:123] op_sel:[0,0] op_sel_hi:[0,1] neg_lo:[0,0] neg_hi:[0,0]
v_pk_fma_f32 v[52:53], v[52:53], v[122:123], v[64:65] op_sel:[1,1,0] op_sel_hi:[1,0,1] neg_lo:[0,1,0] neg_hi:[0,0,0]
v_pk_mul_f32 v[64:65], v[36:37], v[124:125] op_sel:[0,0] op_sel_hi:[0,1] neg_lo:[0,0] neg_hi:[0,0]
v_pk_fma_f32 v[36:37], v[36:37], v[124:125], v[64:65] op_sel:[1,1,0] op_sel_hi:[1,0,1] neg_lo:[0,1,0] neg_hi:[0,0,0]
v_pk_mul_f32 v[64:65], v[68:69], v[126:127] op_sel:[0,0] op_sel_hi:[0,1] neg_lo:[0,0] neg_hi:[0,0]
v_pk_fma_f32 v[68:69], v[68:69], v[126:127], v[64:65] op_sel:[1,1,0] op_sel_hi:[1,0,1] neg_lo:[0,1,0] neg_hi:[0,0,0]
v_pk_mul_f32 v[64:65], v[18:19], v[128:129] op_sel:[0,0] op_sel_hi:[0,1] neg_lo:[0,0] neg_hi:[0,0]
v_pk_fma_f32 v[18:19], v[18:19], v[128:129], v[64:65] op_sel:[1,1,0] op_sel_hi:[1,0,1] neg_lo:[0,1,0] neg_hi:[0,0,0]
v_pk_mul_f32 v[64:65], v[50:51], v[130:131] op_sel:[0,0] op_sel_hi:[0,1] neg_lo:[0,0] neg_hi:[0,0]
v_pk_fma_f32 v[50:51], v[50:51], v[130:131], v[64:65] op_sel:[1,1,0] op_sel_hi:[1,0,1] neg_lo:[0,1,0] neg_hi:[0,0,0]
v_pk_mul_f32 v[64:65], v[34:35], v[132:133] op_sel:[0,0] op_sel_hi:[0,1] neg_lo:[0,0] neg_hi:[0,0]
v_pk_fma_f32 v[34:35], v[34:35], v[132:133], v[64:65] op_sel:[1,1,0] op_sel_hi:[1,0,1] neg_lo:[0,1,0] neg_hi:[0,0,0]
v_pk_mul_f32 v[64:65], v[66:67], v[134:135] op_sel:[0,0] op_sel_hi:[0,1] neg_lo:[0,0] neg_hi:[0,0]
v_pk_fma_f32 v[66:67], v[66:67], v[134:135], v[64:65] op_sel:[1,1,0] op_sel_hi:[1,0,1] neg_lo:[0,1,0] neg_hi:[0,0,0]
v_pk_mul_f32 v[64:65], v[26:27], v[136:137] op_sel:[0,0] op_sel_hi:[0,1] neg_lo:[0,0] neg_hi:[0,0]
v_pk_fma_f32 v[26:27], v[26:27], v[136:137], v[64:65] op_sel:[1,1,0] op_sel_hi:[1,0,1] neg_lo:[0,1,0] neg_hi:[0,0,0]
v_pk_mul_f32 v[64:65], v[58:59], v[138:139] op_sel:[0,0] op_sel_hi:[0,1] neg_lo:[0,0] neg_hi:[0,0]
v_pk_fma_f32 v[58:59], v[58:59], v[138:139], v[64:65] op_sel:[1,1,0] op_sel_hi:[1,0,1] neg_lo:[0,1,0] neg_hi:[0,0,0]
v_pk_mul_f32 v[64:65], v[42:43], v[140:141] op_sel:[0,0] op_sel_hi:[0,1] neg_lo:[0,0] neg_hi:[0,0]
v_pk_fma_f32 v[42:43], v[42:43], v[140:141], v[64:65] op_sel:[1,1,0] op_sel_hi:[1,0,1] neg_lo:[0,1,0] neg_hi:[0,0,0]
v_pk_mul_f32 v[64:65], v[74:75], v[142:143] op_sel:[0,0] op_sel_hi:[0,1] neg_lo:[0,0] neg_hi:[0,0]
v_pk_fma_f32 v[74:75], v[74:75], v[142:143], v[64:65] op_sel:[1,1,0] op_sel_hi:[1,0,1] neg_lo:[0,1,0] neg_hi:[0,0,0]
s_barrier
ds_write_b64 v4, v[16:17] offset:0
ds_write_b64 v4, v[48:49] offset:264
ds_write_b64 v4, v[14:15] offset:528
ds_write_b64 v4, v[40:41] offset:792
ds_write_b64 v4, v[72:73] offset:1056
ds_write_b64 v4, v[44:45] offset:1320
ds_write_b64 v4, v[28:29] offset:1584
ds_write_b64 v4, v[60:61] offset:1848
ds_write_b64 v4, v[76:77] offset:2112
ds_write_b64 v4, v[46:47] offset:2376
ds_write_b64 v4, v[30:31] offset:2640
ds_write_b64 v4, v[62:63] offset:2904
ds_write_b64 v4, v[22:23] offset:3168
ds_write_b64 v4, v[54:55] offset:3432
ds_write_b64 v4, v[38:39] offset:3696
ds_write_b64 v4, v[70:71] offset:3960
ds_write_b64 v4, v[78:79] offset:4224
ds_write_b64 v4, v[32:33] offset:4488
ds_write_b64 v4, v[24:25] offset:4752
ds_write_b64 v4, v[56:57] offset:5016
ds_write_b64 v4, v[20:21] offset:5280
ds_write_b64 v4, v[52:53] offset:5544
ds_write_b64 v4, v[36:37] offset:5808
ds_write_b64 v4, v[68:69] offset:6072
ds_write_b64 v4, v[18:19] offset:6336
ds_write_b64 v4, v[50:51] offset:6600
ds_write_b64 v4, v[34:35] offset:6864
ds_write_b64 v4, v[66:67] offset:7128
ds_write_b64 v4, v[26:27] offset:7392
ds_write_b64 v4, v[58:59] offset:7656
ds_write_b64 v4, v[42:43] offset:7920
ds_write_b64 v4, v[74:75] offset:8184
s_waitcnt lgkmcnt(0)
ds_read_b64 v[16:17], v5 offset:0
ds_read_b64 v[48:49], v5 offset:128
ds_read_b64 v[18:19], v5 offset:8
ds_read_b64 v[50:51], v5 offset:136
ds_read_b64 v[20:21], v5 offset:16
ds_read_b64 v[52:53], v5 offset:144
ds_read_b64 v[22:23], v5 offset:24
ds_read_b64 v[54:55], v5 offset:152
ds_read_b64 v[24:25], v5 offset:32
ds_read_b64 v[56:57], v5 offset:160
ds_read_b64 v[26:27], v5 offset:40
ds_read_b64 v[58:59], v5 offset:168
ds_read_b64 v[28:29], v5 offset:48
ds_read_b64 v[60:61], v5 offset:176
ds_read_b64 v[30:31], v5 offset:56
ds_read_b64 v[62:63], v5 offset:184
ds_read_b64 v[32:33], v5 offset:64
ds_read_b64 v[64:65], v5 offset:192
ds_read_b64 v[34:35], v5 offset:72
ds_read_b64 v[66:67], v5 offset:200
ds_read_b64 v[36:37], v5 offset:80
ds_read_b64 v[68:69], v5 offset:208
ds_read_b64 v[38:39], v5 offset:88
ds_read_b64 v[70:71], v5 offset:216
ds_read_b64 v[40:41], v5 offset:96
ds_read_b64 v[72:73], v5 offset:224
ds_read_b64 v[42:43], v5 offset:104
ds_read_b64 v[74:75], v5 offset:232
ds_read_b64 v[44:45], v5 offset:112
ds_read_b64 v[76:77], v5 offset:240
ds_read_b64 v[46:47], v5 offset:120
ds_read_b64 v[78:79], v5 offset:248
s_waitcnt lgkmcnt(0)
v_pk_add_f32 v[14:15], v[16:17], v[48:49] neg_lo:[0,1] neg_hi:[0,1]
v_pk_add_f32 v[16:17], v[16:17], v[48:49]
v_pk_add_f32 v[48:49], v[18:19], v[50:51] neg_lo:[0,1] neg_hi:[0,1]
v_pk_add_f32 v[18:19], v[18:19], v[50:51]
v_pk_mul_f32 v[50:51], v[48:49], s[50:51] op_sel:[0,0] op_sel_hi:[0,1] neg_lo:[0,0] neg_hi:[0,1]
v_pk_fma_f32 v[50:51], v[48:49], s[50:51], v[50:51] op_sel:[1,1,0] op_sel_hi:[1,0,1] neg_lo:[0,0,0] neg_hi:[0,0,0]
v_pk_add_f32 v[48:49], v[20:21], v[52:53] neg_lo:[0,1] neg_hi:[0,1]
v_pk_add_f32 v[20:21], v[20:21], v[52:53]
v_pk_mul_f32 v[52:53], v[48:49], s[54:55] op_sel:[0,0] op_sel_hi:[0,1] neg_lo:[0,0] neg_hi:[0,1]
v_pk_fma_f32 v[52:53], v[48:49], s[54:55], v[52:53] op_sel:[1,1,0] op_sel_hi:[1,0,1] neg_lo:[0,0,0] neg_hi:[0,0,0]
v_pk_add_f32 v[48:49], v[22:23], v[54:55] neg_lo:[0,1] neg_hi:[0,1]
v_pk_add_f32 v[22:23], v[22:23], v[54:55]
v_pk_mul_f32 v[54:55], v[48:49], s[58:59] op_sel:[0,0] op_sel_hi:[0,1] neg_lo:[0,0] neg_hi:[0,1]
v_pk_fma_f32 v[54:55], v[48:49], s[58:59], v[54:55] op_sel:[1,1,0] op_sel_hi:[1,0,1] neg_lo:[0,0,0] neg_hi:[0,0,0]
v_pk_add_f32 v[48:49], v[24:25], v[56:57] neg_lo:[0,1] neg_hi:[0,1]
v_pk_add_f32 v[24:25], v[24:25], v[56:57]
v_pk_mul_f32 v[56:57], v[48:49], s[62:63] op_sel:[0,0] op_sel_hi:[0,1] neg_lo:[0,0] neg_hi:[0,1]
v_pk_fma_f32 v[56:57], v[48:49], s[62:63], v[56:57] op_sel:[1,1,0] op_sel_hi:[1,0,1] neg_lo:[0,0,0] neg_hi:[0,0,0]
v_pk_add_f32 v[48:49], v[26:27], v[58:59] neg_lo:[0,1] neg_hi:[0,1]
v_pk_add_f32 v[26:27], v[26:27], v[58:59]
v_pk_mul_f32 v[58:59], v[48:49], s[58:59] op_sel:[0,1] op_sel_hi:[0,0] neg_lo:[0,0] neg_hi:[0,1]
v_pk_fma_f32 v[58:59], v[48:49], s[58:59], v[58:59] op_sel:[1,0,0] op_sel_hi:[1,1,1] neg_lo:[0,0,0] neg_hi:[0,0,0]
v_pk_add_f32 v[48:49], v[28:29], v[60:61] neg_lo:[0,1] neg_hi:[0,1]
v_pk_add_f32 v[28:29], v[28:29], v[60:61]
v_pk_mul_f32 v[60:61], v[48:49], s[54:55] op_sel:[0,1] op_sel_hi:[0,0] neg_lo:[0,0] neg_hi:[0,1]
v_pk_fma_f32 v[60:61], v[48:49], s[54:55], v[60:61] op_sel:[1,0,0] op_sel_hi:[1,1,1] neg_lo:[0,0,0] neg_hi:[0,0,0]
v_pk_add_f32 v[48:49], v[30:31], v[62:63] neg_lo:[0,1] neg_hi:[0,1]
v_pk_add_f32 v[30:31], v[30:31], v[62:63]
v_pk_mul_f32 v[62:63], v[48:49], s[50:51] op_sel:[0,1] op_sel_hi:[0,0] neg_lo:[0,0] neg_hi:[0,1]
v_pk_fma_f32 v[62:63], v[48:49], s[50:51], v[62:63] op_sel:[1,0,0] op_sel_hi:[1,1,1] neg_lo:[0,0,0] neg_hi:[0,0,0]
v_pk_add_f32 v[48:49], v[32:33], v[64:65] op_sel:[1,1] op_sel_hi:[0,0] neg_lo:[0,1] neg_hi:[1,0]
v_pk_add_f32 v[32:33], v[32:33], v[64:65]
v_pk_add_f32 v[64:65], v[34:35], v[66:67] neg_lo:[0,1] neg_hi:[0,1]
v_pk_add_f32 v[34:35], v[34:35], v[66:67]
v_pk_mul_f32 v[66:67], v[64:65], s[50:51] op_sel:[0,1] op_sel_hi:[0,0] neg_lo:[0,1] neg_hi:[0,1]
v_pk_fma_f32 v[66:67], v[64:65], s[50:51], v[66:67] op_sel:[1,0,0] op_sel_hi:[1,1,1] neg_lo:[0,0,0] neg_hi:[0,1,0]
v_pk_add_f32 v[64:65], v[36:37], v[68:69] neg_lo:[0,1] neg_hi:[0,1]
v_pk_add_f32 v[36:37], v[36:37], v[68:69]
v_pk_mul_f32 v[68:69], v[64:65], s[54:55] op_sel:[0,1] op_sel_hi:[0,0] neg_lo:[0,1] neg_hi:[0,1]
v_pk_fma_f32 v[68:69], v[64:65], s[54:55], v[68:69] op_sel:[1,0,0] op_sel_hi:[1,1,1] neg_lo:[0,0,0] neg_hi:[0,1,0]
v_pk_add_f32 v[64:65], v[38:39], v[70:71] neg_lo:[0,1] neg_hi:[0,1]
v_pk_add_f32 v[38:39], v[38:39], v[70:71]
v_pk_mul_f32 v[70:71], v[64:65], s[58:59] op_sel:[0,1] op_sel_hi:[0,0] neg_lo:[0,1] neg_hi:[0,1]
v_pk_fma_f32 v[70:71], v[64:65], s[58:59], v[70:71] op_sel:[1,0,0] op_sel_hi:[1,1,1] neg_lo:[0,0,0] neg_hi:[0,1,0]
v_pk_add_f32 v[64:65], v[40:41], v[72:73] neg_lo:[0,1] neg_hi:[0,1]
v_pk_add_f32 v[40:41], v[40:41], v[72:73]
v_pk_mul_f32 v[72:73], v[64:65], s[62:63] op_sel:[0,0] op_sel_hi:[0,1] neg_lo:[0,1] neg_hi:[0,1]
v_pk_fma_f32 v[72:73], v[64:65], s[62:63], v[72:73] op_sel:[1,1,0] op_sel_hi:[1,0,1] neg_lo:[0,0,0] neg_hi:[0,1,0]
v_pk_add_f32 v[64:65], v[42:43], v[74:75] neg_lo:[0,1] neg_hi:[0,1]
v_pk_add_f32 v[42:43], v[42:43], v[74:75]
v_pk_mul_f32 v[74:75], v[64:65], s[58:59] op_sel:[0,0] op_sel_hi:[0,1] neg_lo:[0,1] neg_hi:[0,1]
v_pk_fma_f32 v[74:75], v[64:65], s[58:59], v[74:75] op_sel:[1,1,0] op_sel_hi:[1,0,1] neg_lo:[0,0,0] neg_hi:[0,1,0]
v_pk_add_f32 v[64:65], v[44:45], v[76:77] neg_lo:[0,1] neg_hi:[0,1]
v_pk_add_f32 v[44:45], v[44:45], v[76:77]
v_pk_mul_f32 v[76:77], v[64:65], s[54:55] op_sel:[0,0] op_sel_hi:[0,1] neg_lo:[0,1] neg_hi:[0,1]
v_pk_fma_f32 v[76:77], v[64:65], s[54:55], v[76:77] op_sel:[1,1,0] op_sel_hi:[1,0,1] neg_lo:[0,0,0] neg_hi:[0,1,0]
v_pk_add_f32 v[64:65], v[46:47], v[78:79] neg_lo:[0,1] neg_hi:[0,1]
v_pk_add_f32 v[46:47], v[46:47], v[78:79]
v_pk_mul_f32 v[78:79], v[64:65], s[50:51] op_sel:[0,0] op_sel_hi:[0,1] neg_lo:[0,1] neg_hi:[0,1]
v_pk_fma_f32 v[78:79], v[64:65], s[50:51], v[78:79] op_sel:[1,1,0] op_sel_hi:[1,0,1] neg_lo:[0,0,0] neg_hi:[0,1,0]
v_pk_add_f32 v[64:65], v[16:17], v[32:33] neg_lo:[0,1] neg_hi:[0,1]
v_pk_add_f32 v[16:17], v[16:17], v[32:33]
v_pk_add_f32 v[32:33], v[18:19], v[34:35] neg_lo:[0,1] neg_hi:[0,1]
v_pk_add_f32 v[18:19], v[18:19], v[34:35]
v_pk_mul_f32 v[34:35], v[32:33], s[54:55] op_sel:[0,0] op_sel_hi:[0,1] neg_lo:[0,0] neg_hi:[0,1]
v_pk_fma_f32 v[34:35], v[32:33], s[54:55], v[34:35] op_sel:[1,1,0] op_sel_hi:[1,0,1] neg_lo:[0,0,0] neg_hi:[0,0,0]
v_pk_add_f32 v[32:33], v[20:21], v[36:37] neg_lo:[0,1] neg_hi:[0,1]
v_pk_add_f32 v[20:21], v[20:21], v[36:37]
v_pk_mul_f32 v[36:37], v[32:33], s[62:63] op_sel:[0,0] op_sel_hi:[0,1] neg_lo:[0,0] neg_hi:[0,1]
v_pk_fma_f32 v[36:37], v[32:33], s[62:63], v[36:37] op_sel:[1,1,0] op_sel_hi:[1,0,1] neg_lo:[0,0,0] neg_hi:[0,0,0]
v_pk_add_f32 v[32:33], v[22:23], v[38:39] neg_lo:[0,1] neg_hi:[0,1]
v_pk_add_f32 v[22:23], v[22:23], v[38:39]
v_pk_mul_f32 v[38:39], v[32:33], s[54:55] op_sel:[0,1] op_sel_hi:[0,0] neg_lo:[0,0] neg_hi:[0,1]
v_pk_fma_f32 v[38:39], v[32:33], s[54:55], v[38:39] op_sel:[1,0,0] op_sel_hi:[1,1,1] neg_lo:[0,0,0] neg_hi:[0,0,0]
v_pk_add_f32 v[32:33], v[24:25], v[40:41] op_sel:[1,1] op_sel_hi:[0,0] neg_lo:[0,1] neg_hi:[1,0]
v_pk_add_f32 v[24:25], v[24:25], v[40:41]
v_pk_add_f32 v[40:41], v[26:27], v[42:43] neg_lo:[0,1] neg_hi:[0,1]
v_pk_add_f32 v[26:27], v[26:27], v[42:43]
v_pk_mul_f32 v[42:43], v[40:41], s[54:55] op_sel:[0,1] op_sel_hi:[0,0] neg_lo:[0,1] neg_hi:[0,1]
v_pk_fma_f32 v[42:43], v[40:41], s[54:55], v[42:43] op_sel:[1,0,0] op_sel_hi:[1,1,1] neg_lo:[0,0,0] neg_hi:[0,1,0]
v_pk_add_f32 v[40:41], v[28:29], v[44:45] neg_lo:[0,1] neg_hi:[0,1]
v_pk_add_f32 v[28:29], v[28:29], v[44:45]
v_pk_mul_f32 v[44:45], v[40:41], s[62:63] op_sel:[0,0] op_sel_hi:[0,1] neg_lo:[0,1] neg_hi:[0,1]
v_pk_fma_f32 v[44:45], v[40:41], s[62:63], v[44:45] op_sel:[1,1,0] op_sel_hi:[1,0,1] neg_lo:[0,0,0] neg_hi:[0,1,0]
v_pk_add_f32 v[40:41], v[30:31], v[46:47] neg_lo:[0,1] neg_hi:[0,1]
v_pk_add_f32 v[30:31], v[30:31], v[46:47]
v_pk_mul_f32 v[46:47], v[40:41], s[54:55] op_sel:[0,0] op_sel_hi:[0,1] neg_lo:[0,1] neg_hi:[0,1]
v_pk_fma_f32 v[46:47], v[40:41], s[54:55], v[46:47] op_sel:[1,1,0] op_sel_hi:[1,0,1] neg_lo:[0,0,0] neg_hi:[0,1,0]
v_pk_add_f32 v[40:41], v[14:15], v[48:49] neg_lo:[0,1] neg_hi:[0,1]
v_pk_add_f32 v[14:15], v[14:15], v[48:49]
v_pk_add_f32 v[48:49], v[50:51], v[66:67] neg_lo:[0,1] neg_hi:[0,1]
v_pk_add_f32 v[50:51], v[50:51], v[66:67]
v_pk_mul_f32 v[66:67], v[48:49], s[54:55] op_sel:[0,0] op_sel_hi:[0,1] neg_lo:[0,0] neg_hi:[0,1]
v_pk_fma_f32 v[66:67], v[48:49], s[54:55], v[66:67] op_sel:[1,1,0] op_sel_hi:[1,0,1] neg_lo:[0,0,0] neg_hi:[0,0,0]
v_pk_add_f32 v[48:49], v[52:53], v[68:69] neg_lo:[0,1] neg_hi:[0,1]
v_pk_add_f32 v[52:53], v[52:53], v[68:69]
v_pk_mul_f32 v[68:69], v[48:49], s[62:63] op_sel:[0,0] op_sel_hi:[0,1] neg_lo:[0,0] neg_hi:[0,1]
v_pk_fma_f32 v[68:69], v[48:49], s[62:63], v[68:69] op_sel:[1,1,0] op_sel_hi:[1,0,1] neg_lo:[0,0,0] neg_hi:[0,0,0]
v_pk_add_f32 v[48:49], v[54:55], v[70:71] neg_lo:[0,1] neg_hi:[0,1]
v_pk_add_f32 v[54:55], v[54:55], v[70:71]
v_pk_mul_f32 v[70:71], v[48:49], s[54:55] op_sel:[0,1] op_sel_hi:[0,0] neg_lo:[0,0] neg_hi:[0,1]
v_pk_fma_f32 v[70:71], v[48:49], s[54:55], v[70:71] op_sel:[1,0,0] op_sel_hi:[1,1,1] neg_lo:[0,0,0] neg_hi:[0,0,0]
v_pk_add_f32 v[48:49], v[56:57], v[72:73] op_sel:[1,1] op_sel_hi:[0,0] neg_lo:[0,1] neg_hi:[1,0]
v_pk_add_f32 v[56:57], v[56:57], v[72:73]
v_pk_add_f32 v[72:73], v[58:59], v[74:75] neg_lo:[0,1] neg_hi:[0,1]
v_pk_add_f32 v[58:59], v[58:59], v[74:75]
v_pk_mul_f32 v[74:75], v[72:73], s[54:55] op_sel:[0,1] op_sel_hi:[0,0] neg_lo:[0,1] neg_hi:[0,1]
v_pk_fma_f32 v[74:75], v[72:73], s[54:55], v[74:75] op_sel:[1,0,0] op_sel_hi:[1,1,1] neg_lo:[0,0,0] neg_hi:[0,1,0]
v_pk_add_f32 v[72:73], v[60:61], v[76:77] neg_lo:[0,1] neg_hi:[0,1]
v_pk_add_f32 v[60:61], v[60:61], v[76:77]
v_pk_mul_f32 v[76:77], v[72:73], s[62:63] op_sel:[0,0] op_sel_hi:[0,1] neg_lo:[0,1] neg_hi:[0,1]
v_pk_fma_f32 v[76:77], v[72:73], s[62:63], v[76:77] op_sel:[1,1,0] op_sel_hi:[1,0,1] neg_lo:[0,0,0] neg_hi:[0,1,0]
v_pk_add_f32 v[72:73], v[62:63], v[78:79] neg_lo:[0,1] neg_hi:[0,1]
v_pk_add_f32 v[62:63], v[62:63], v[78:79]
v_pk_mul_f32 v[78:79], v[72:73], s[54:55] op_sel:[0,0] op_sel_hi:[0,1] neg_lo:[0,1] neg_hi:[0,1]
v_pk_fma_f32 v[78:79], v[72:73], s[54:55], v[78:79] op_sel:[1,1,0] op_sel_hi:[1,0,1] neg_lo:[0,0,0] neg_hi:[0,1,0]
v_pk_add_f32 v[72:73], v[16:17], v[24:25] neg_lo:[0,1] neg_hi:[0,1]
v_pk_add_f32 v[16:17], v[16:17], v[24:25]
v_pk_add_f32 v[24:25], v[18:19], v[26:27] neg_lo:[0,1] neg_hi:[0,1]
v_pk_add_f32 v[18:19], v[18:19], v[26:27]
v_pk_mul_f32 v[26:27], v[24:25], s[62:63] op_sel:[0,0] op_sel_hi:[0,1] neg_lo:[0,0] neg_hi:[0,1]
v_pk_fma_f32 v[26:27], v[24:25], s[62:63], v[26:27] op_sel:[1,1,0] op_sel_hi:[1,0,1] neg_lo:[0,0,0] neg_hi:[0,0,0]
v_pk_add_f32 v[24:25], v[20:21], v[28:29] op_sel:[1,1] op_sel_hi:[0,0] neg_lo:[0,1] neg_hi:[1,0]
v_pk_add_f32 v[20:21], v[20:21], v[28:29]
v_pk_add_f32 v[28:29], v[22:23], v[30:31] neg_lo:[0,1] neg_hi:[0,1]
v_pk_add_f32 v[22:23], v[22:23], v[30:31]
v_pk_mul_f32 v[30:31], v[28:29], s[62:63] op_sel:[0,0] op_sel_hi:[0,1] neg_lo:[0,1] neg_hi:[0,1]
v_pk_fma_f32 v[30:31], v[28:29], s[62:63], v[30:31] op_sel:[1,1,0] op_sel_hi:[1,0,1] neg_lo:[0,0,0] neg_hi:[0,1,0]
v_pk_add_f32 v[28:29], v[64:65], v[32:33] neg_lo:[0,1] neg_hi:[0,1]
v_pk_add_f32 v[64:65], v[64:65], v[32:33]
v_pk_add_f32 v[32:33], v[34:35], v[42:43] neg_lo:[0,1] neg_hi:[0,1]
v_pk_add_f32 v[34:35], v[34:35], v[42:43]
v_pk_mul_f32 v[42:43], v[32:33], s[62:63] op_sel:[0,0] op_sel_hi:[0,1] neg_lo:[0,0] neg_hi:[0,1]
v_pk_fma_f32 v[42:43], v[32:33], s[62:63], v[42:43] op_sel:[1,1,0] op_sel_hi:[1,0,1] neg_lo:[0,0,0] neg_hi:[0,0,0]
v_pk_add_f32 v[32:33], v[36:37], v[44:45] op_sel:[1,1] op_sel_hi:[0,0] neg_lo:[0,1] neg_hi:[1,0]
v_pk_add_f32 v[36:37], v[36:37], v[44:45]
v_pk_add_f32 v[44:45], v[38:39], v[46:47] neg_lo:[0,1] neg_hi:[0,1]
v_pk_add_f32 v[38:39], v[38:39], v[46:47]
v_pk_mul_f32 v[46:47], v[44:45], s[62:63] op_sel:[0,0] op_sel_hi:[0,1] neg_lo:[0,1] neg_hi:[0,1]
v_pk_fma_f32 v[46:47], v[44:45], s[62:63], v[46:47] op_sel:[1,1,0] op_sel_hi:[1,0,1] neg_lo:[0,0,0] neg_hi:[0,1,0]
v_pk_add_f32 v[44:45], v[14:15], v[56:57] neg_lo:[0,1] neg_hi:[0,1]
v_pk_add_f32 v[14:15], v[14:15], v[56:57]
v_pk_add_f32 v[56:57], v[50:51], v[58:59] neg_lo:[0,1] neg_hi:[0,1]
v_pk_add_f32 v[50:51], v[50:51], v[58:59]
v_pk_mul_f32 v[58:59], v[56:57], s[62:63] op_sel:[0,0] op_sel_hi:[0,1] neg_lo:[0,0] neg_hi:[0,1]
v_pk_fma_f32 v[58:59], v[56:57], s[62:63], v[58:59] op_sel:[1,1,0] op_sel_hi:[1,0,1] neg_lo:[0,0,0] neg_hi:[0,0,0]
v_pk_add_f32 v[56:57], v[52:53], v[60:61] op_sel:[1,1] op_sel_hi:[0,0] neg_lo:[0,1] neg_hi:[1,0]
v_pk_add_f32 v[52:53], v[52:53], v[60:61]
v_pk_add_f32 v[60:61], v[54:55], v[62:63] neg_lo:[0,1] neg_hi:[0,1]
v_pk_add_f32 v[54:55], v[54:55], v[62:63]
v_pk_mul_f32 v[62:63], v[60:61], s[62:63] op_sel:[0,0] op_sel_hi:[0,1] neg_lo:[0,1] neg_hi:[0,1]
v_pk_fma_f32 v[62:63], v[60:61], s[62:63], v[62:63] op_sel:[1,1,0] op_sel_hi:[1,0,1] neg_lo:[0,0,0] neg_hi:[0,1,0]
v_pk_add_f32 v[60:61], v[40:41], v[48:49] neg_lo:[0,1] neg_hi:[0,1]
v_pk_add_f32 v[40:41], v[40:41], v[48:49]
v_pk_add_f32 v[48:49], v[66:67], v[74:75] neg_lo:[0,1] neg_hi:[0,1]
v_pk_add_f32 v[66:67], v[66:67], v[74:75]
v_pk_mul_f32 v[74:75], v[48:49], s[62:63] op_sel:[0,0] op_sel_hi:[0,1] neg_lo:[0,0] neg_hi:[0,1]
v_pk_fma_f32 v[74:75], v[48:49], s[62:63], v[74:75] op_sel:[1,1,0] op_sel_hi:[1,0,1] neg_lo:[0,0,0] neg_hi:[0,0,0]
v_pk_add_f32 v[48:49], v[68:69], v[76:77] op_sel:[1,1] op_sel_hi:[0,0] neg_lo:[0,1] neg_hi:[1,0]
v_pk_add_f32 v[68:69], v[68:69], v[76:77]
v_pk_add_f32 v[76:77], v[70:71], v[78:79] neg_lo:[0,1] neg_hi:[0,1]
v_pk_add_f32 v[70:71], v[70:71], v[78:79]
v_pk_mul_f32 v[78:79], v[76:77], s[62:63] op_sel:[0,0] op_sel_hi:[0,1] neg_lo:[0,1] neg_hi:[0,1]
v_pk_fma_f32 v[78:79], v[76:77], s[62:63], v[78:79] op_sel:[1,1,0] op_sel_hi:[1,0,1] neg_lo:[0,0,0] neg_hi:[0,1,0]
v_pk_add_f32 v[76:77], v[16:17], v[20:21] neg_lo:[0,1] neg_hi:[0,1]
v_pk_add_f32 v[16:17], v[16:17], v[20:21]
v_pk_add_f32 v[20:21], v[18:19], v[22:23] op_sel:[1,1] op_sel_hi:[0,0] neg_lo:[0,1] neg_hi:[1,0]
v_pk_add_f32 v[18:19], v[18:19], v[22:23]
v_pk_add_f32 v[22:23], v[72:73], v[24:25] neg_lo:[0,1] neg_hi:[0,1]
v_pk_add_f32 v[72:73], v[72:73], v[24:25]
v_pk_add_f32 v[24:25], v[26:27], v[30:31] op_sel:[1,1] op_sel_hi:[0,0] neg_lo:[0,1] neg_hi:[1,0]
v_pk_add_f32 v[26:27], v[26:27], v[30:31]
v_pk_add_f32 v[30:31], v[64:65], v[36:37] neg_lo:[0,1] neg_hi:[0,1]
v_pk_add_f32 v[64:65], v[64:65], v[36:37]
v_pk_add_f32 v[36:37], v[34:35], v[38:39] op_sel:[1,1] op_sel_hi:[0,0] neg_lo:[0,1] neg_hi:[1,0]
v_pk_add_f32 v[34:35], v[34:35], v[38:39]
v_pk_add_f32 v[38:39], v[28:29], v[32:33] neg_lo:[0,1] neg_hi:[0,1]
v_pk_add_f32 v[28:29], v[28:29], v[32:33]
v_pk_add_f32 v[32:33], v[42:43], v[46:47] op_sel:[1,1] op_sel_hi:[0,0] neg_lo:[0,1] neg_hi:[1,0]
v_pk_add_f32 v[42:43], v[42:43], v[46:47]
v_pk_add_f32 v[46:47], v[14:15], v[52:53] neg_lo:[0,1] neg_hi:[0,1]
v_pk_add_f32 v[14:15], v[14:15], v[52:53]
v_pk_add_f32 v[52:53], v[50:51], v[54:55] op_sel:[1,1] op_sel_hi:[0,0] neg_lo:[0,1] neg_hi:[1,0]
v_pk_add_f32 v[50:51], v[50:51], v[54:55]
v_pk_add_f32 v[54:55], v[44:45], v[56:57] neg_lo:[0,1] neg_hi:[0,1]
v_pk_add_f32 v[44:45], v[44:45], v[56:57]
v_pk_add_f32 v[56:57], v[58:59], v[62:63] op_sel:[1,1] op_sel_hi:[0,0] neg_lo:[0,1] neg_hi:[1,0]
v_pk_add_f32 v[58:59], v[58:59], v[62:63]
v_pk_add_f32 v[62:63], v[40:41], v[68:69] neg_lo:[0,1] neg_hi:[0,1]
v_pk_add_f32 v[40:41], v[40:41], v[68:69]
v_pk_add_f32 v[68:69], v[66:67], v[70:71] op_sel:[1,1] op_sel_hi:[0,0] neg_lo:[0,1] neg_hi:[1,0]
v_pk_add_f32 v[66:67], v[66:67], v[70:71]
v_pk_add_f32 v[70:71], v[60:61], v[48:49] neg_lo:[0,1] neg_hi:[0,1]
v_pk_add_f32 v[60:61], v[60:61], v[48:49]
v_pk_add_f32 v[48:49], v[74:75], v[78:79] op_sel:[1,1] op_sel_hi:[0,0] neg_lo:[0,1] neg_hi:[1,0]
v_pk_add_f32 v[74:75], v[74:75], v[78:79]
v_pk_add_f32 v[78:79], v[16:17], v[18:19] neg_lo:[0,1] neg_hi:[0,1]
v_pk_add_f32 v[16:17], v[16:17], v[18:19]
v_pk_add_f32 v[18:19], v[76:77], v[20:21] neg_lo:[0,1] neg_hi:[0,1]
v_pk_add_f32 v[76:77], v[76:77], v[20:21]
v_pk_add_f32 v[20:21], v[72:73], v[26:27] neg_lo:[0,1] neg_hi:[0,1]
v_pk_add_f32 v[72:73], v[72:73], v[26:27]
v_pk_add_f32 v[26:27], v[22:23], v[24:25] neg_lo:[0,1] neg_hi:[0,1]
v_pk_add_f32 v[22:23], v[22:23], v[24:25]
v_pk_add_f32 v[24:25], v[64:65], v[34:35] neg_lo:[0,1] neg_hi:[0,1]
v_pk_add_f32 v[64:65], v[64:65], v[34:35]
v_pk_add_f32 v[34:35], v[30:31], v[36:37] neg_lo:[0,1] neg_hi:[0,1]
v_pk_add_f32 v[30:31], v[30:31], v[36:37]
v_pk_add_f32 v[36:37], v[28:29], v[42:43] neg_lo:[0,1] neg_hi:[0,1]
v_pk_add_f32 v[28:29], v[28:29], v[42:43]
v_pk_add_f32 v[42:43], v[38:39], v[32:33] neg_lo:[0,1] neg_hi:[0,1]
v_pk_add_f32 v[38:39], v[38:39], v[32:33]
v_pk_add_f32 v[32:33], v[14:15], v[50:51] neg_lo:[0,1] neg_hi:[0,1]
v_pk_add_f32 v[14:15], v[14:15], v[50:51]
v_pk_add_f32 v[50:51], v[46:47], v[52:53] neg_lo:[0,1] neg_hi:[0,1]
v_pk_add_f32 v[46:47], v[46:47], v[52:53]
v_pk_add_f32 v[52:53], v[44:45], v[58:59] neg_lo:[0,1] neg_hi:[0,1]
v_pk_add_f32 v[44:45], v[44:45], v[58:59]
v_pk_add_f32 v[58:59], v[54:55], v[56:57] neg_lo:[0,1] neg_hi:[0,1]
v_pk_add_f32 v[54:55], v[54:55], v[56:57]
v_pk_add_f32 v[56:57], v[40:41], v[66:67] neg_lo:[0,1] neg_hi:[0,1]
v_pk_add_f32 v[40:41], v[40:41], v[66:67]
v_pk_add_f32 v[66:67], v[62:63], v[68:69] neg_lo:[0,1] neg_hi:[0,1]
v_pk_add_f32 v[62:63], v[62:63], v[68:69]
v_pk_add_f32 v[68:69], v[60:61], v[74:75] neg_lo:[0,1] neg_hi:[0,1]
v_pk_add_f32 v[60:61], v[60:61], v[74:75]
v_pk_add_f32 v[74:75], v[70:71], v[48:49] neg_lo:[0,1] neg_hi:[0,1]
v_pk_add_f32 v[70:71], v[70:71], v[48:49]
ds_write_b64 v4, v[16:17] offset:0
ds_write_b64 v4, v[14:15] offset:256
ds_write_b64 v4, v[64:65] offset:512
ds_write_b64 v4, v[40:41] offset:768
ds_write_b64 v4, v[72:73] offset:1024
ds_write_b64 v4, v[44:45] offset:1280
ds_write_b64 v4, v[28:29] offset:1536
ds_write_b64 v4, v[60:61] offset:1792
ds_write_b64 v4, v[76:77] offset:2048
ds_write_b64 v4, v[46:47] offset:2304
ds_write_b64 v4, v[30:31] offset:2560
ds_write_b64 v4, v[62:63] offset:2816
ds_write_b64 v4, v[22:23] offset:3072
ds_write_b64 v4, v[54:55] offset:3328
ds_write_b64 v4, v[38:39] offset:3584
ds_write_b64 v4, v[70:71] offset:3840
ds_write_b64 v4, v[78:79] offset:4096
ds_write_b64 v4, v[32:33] offset:4352
ds_write_b64 v4, v[24:25] offset:4608
ds_write_b64 v4, v[56:57] offset:4864
ds_write_b64 v4, v[20:21] offset:5120
ds_write_b64 v4, v[52:53] offset:5376
ds_write_b64 v4, v[36:37] offset:5632
ds_write_b64 v4, v[68:69] offset:5888
ds_write_b64 v4, v[18:19] offset:6144
ds_write_b64 v4, v[50:51] offset:6400
ds_write_b64 v4, v[34:35] offset:6656
ds_write_b64 v4, v[66:67] offset:6912
ds_write_b64 v4, v[26:27] offset:7168
ds_write_b64 v4, v[58:59] offset:7424
ds_write_b64 v4, v[42:43] offset:7680
ds_write_b64 v4, v[74:75] offset:7936
ds_write_b64 v4, v[16:17] offset:8192
s_waitcnt lgkmcnt(0)
s_barrier
s_lshl_b32 s13, s93, 7
s_add_u32 s13, s13, 96468992
ds_read_b64 v[16:17], v6 offset:0
ds_read_b64 v[18:19], v7 offset:4096
ds_read_b64 v[20:21], v6 offset:256
ds_read_b64 v[22:23], v7 offset:3840
ds_read_b64 v[24:25], v6 offset:512
ds_read_b64 v[26:27], v7 offset:3584
ds_read_b64 v[28:29], v6 offset:768
ds_read_b64 v[30:31], v7 offset:3328
ds_read_b64 v[32:33], v6 offset:1024
ds_read_b64 v[34:35], v7 offset:3072
ds_read_b64 v[36:37], v6 offset:1280
ds_read_b64 v[38:39], v7 offset:2816
s_waitcnt lgkmcnt(10)
v_pk_add_f32 v[208:209], v[16:17], v[18:19] neg_hi:[0,1]
v_pk_add_f32 v[210:211], v[16:17], v[18:19] op_sel:[1,1] op_sel_hi:[0,0] neg_hi:[1,0]
ds_read_b64 v[40:41], v6 offset:1536
ds_read_b64 v[42:43], v7 offset:2560
buffer_store_dwordx4 v[208:211], v8, s[84:87], s13 offen sc1
s_add_u32 s13, s13, 524288
s_waitcnt lgkmcnt(10)
v_pk_add_f32 v[212:213], v[20:21], v[22:23] neg_hi:[0,1]
v_pk_add_f32 v[214:215], v[20:21], v[22:23] op_sel:[1,1] op_sel_hi:[0,0] neg_hi:[1,0]
ds_read_b64 v[44:45], v6 offset:1792
ds_read_b64 v[46:47], v7 offset:2304
buffer_store_dwordx4 v[212:215], v8, s[84:87], s13 offen sc1
s_add_u32 s13, s13, 524288
s_waitcnt lgkmcnt(10)
v_pk_add_f32 v[216:217], v[24:25], v[26:27] neg_hi:[0,1]
v_pk_add_f32 v[218:219], v[24:25], v[26:27] op_sel:[1,1] op_sel_hi:[0,0] neg_hi:[1,0]
ds_read_b64 v[16:17], v6 offset:2048
ds_read_b64 v[18:19], v7 offset:2048
buffer_store_dwordx4 v[216:219], v8, s[84:87], s13 offen sc1
s_add_u32 s13, s13, 524288
s_waitcnt lgkmcnt(10)
v_pk_add_f32 v[220:221], v[28:29], v[30:31] neg_hi:[0,1]
v_pk_add_f32 v[222:223], v[28:29], v[30:31] op_sel:[1,1] op_sel_hi:[0,0] neg_hi:[1,0]
ds_read_b64 v[20:21], v6 offset:2304
ds_read_b64 v[22:23], v7 offset:1792
buffer_store_dwordx4 v[220:223], v8, s[84:87], s13 offen sc1
s_add_u32 s13, s13, 524288
s_waitcnt lgkmcnt(10)
v_pk_add_f32 v[224:225], v[32:33], v[34:35] neg_hi:[0,1]
v_pk_add_f32 v[226:227], v[32:33], v[34:35] op_sel:[1,1] op_sel_hi:[0,0] neg_hi:[1,0]
ds_read_b64 v[24:25], v6 offset:2560
ds_read_b64 v[26:27], v7 offset:1536
buffer_store_dwordx4 v[224:227], v8, s[84:87], s13 offen sc1
s_add_u32 s13, s13, 524288
s_waitcnt lgkmcnt(10)
v_pk_add_f32 v[228:229], v[36:37], v[38:39] neg_hi:[0,1]
v_pk_add_f32 v[230:231], v[36:37], v[38:39] op_sel:[1,1] op_sel_hi:[0,0] neg_hi:[1,0]
ds_read_b64 v[28:29], v6 offset:2816
ds_read_b64 v[30:31], v7 offset:1280
buffer_store_dwordx4 v[228:231], v8, s[84:87], s13 offen sc1
s_add_u32 s13, s13, 524288
s_waitcnt lgkmcnt(10)
v_pk_add_f32 v[232:233], v[40:41], v[42:43] neg_hi:[0,1]
v_pk_add_f32 v[234:235], v[40:41], v[42:43] op_sel:[1,1] op_sel_hi:[0,0] neg_hi:[1,0]
ds_read_b64 v[32:33], v6 offset:3072
ds_read_b64 v[34:35], v7 offset:1024
buffer_store_dwordx4 v[232:235], v8, s[84:87], s13 offen sc1
s_add_u32 s13, s13, 524288
s_waitcnt lgkmcnt(10)
v_pk_add_f32 v[236:237], v[44:45], v[46:47] neg_hi:[0,1]
v_pk_add_f32 v[238:239], v[44:45], v[46:47] op_sel:[1,1] op_sel_hi:[0,0] neg_hi:[1,0]
ds_read_b64 v[36:37], v6 offset:3328
ds_read_b64 v[38:39], v7 offset:768
buffer_store_dwordx4 v[236:239], v8, s[84:87], s13 offen sc1
s_add_u32 s13, s13, 524288
s_waitcnt lgkmcnt(10)
v_pk_add_f32 v[208:209], v[16:17], v[18:19] neg_hi:[0,1]
v_pk_add_f32 v[210:211], v[16:17], v[18:19] op_sel:[1,1] op_sel_hi:[0,0] neg_hi:[1,0]
ds_read_b64 v[40:41], v6 offset:3584
ds_read_b64 v[42:43], v7 offset:512
buffer_store_dwordx4 v[208:211], v8, s[84:87], s13 offen sc1
s_add_u32 s13, s13, 524288
s_waitcnt lgkmcnt(10)
v_pk_add_f32 v[212:213], v[20:21], v[22:23] neg_hi:[0,1]
v_pk_add_f32 v[214:215], v[20:21], v[22:23] op_sel:[1,1] op_sel_hi:[0,0] neg_hi:[1,0]
ds_read_b64 v[44:45], v6 offset:3840
ds_read_b64 v[46:47], v7 offset:256
buffer_store_dwordx4 v[212:215], v8, s[84:87], s13 offen sc1
s_add_u32 s13, s13, 524288
s_waitcnt lgkmcnt(10)
v_pk_add_f32 v[216:217], v[24:25], v[26:27] neg_hi:[0,1]
v_pk_add_f32 v[218:219], v[24:25], v[26:27] op_sel:[1,1] op_sel_hi:[0,0] neg_hi:[1,0]
ds_read_b64 v[16:17], v6 offset:4096
ds_read_b64 v[18:19], v7 offset:0
buffer_store_dwordx4 v[216:219], v8, s[84:87], s13 offen sc1
s_add_u32 s13, s13, 524288
s_waitcnt lgkmcnt(10)
v_pk_add_f32 v[220:221], v[28:29], v[30:31] neg_hi:[0,1]
v_pk_add_f32 v[222:223], v[28:29], v[30:31] op_sel:[1,1] op_sel_hi:[0,0] neg_hi:[1,0]
buffer_store_dwordx4 v[220:223], v8, s[84:87], s13 offen sc1
s_add_u32 s13, s13, 524288
s_waitcnt lgkmcnt(8)
v_pk_add_f32 v[224:225], v[32:33], v[34:35] neg_hi:[0,1]
v_pk_add_f32 v[226:227], v[32:33], v[34:35] op_sel:[1,1] op_sel_hi:[0,0] neg_hi:[1,0]
buffer_store_dwordx4 v[224:227], v8, s[84:87], s13 offen sc1
s_add_u32 s13, s13, 524288
s_waitcnt lgkmcnt(6)
v_pk_add_f32 v[228:229], v[36:37], v[38:39] neg_hi:[0,1]
v_pk_add_f32 v[230:231], v[36:37], v[38:39] op_sel:[1,1] op_sel_hi:[0,0] neg_hi:[1,0]
buffer_store_dwordx4 v[228:231], v8, s[84:87], s13 offen sc1
s_add_u32 s13, s13, 524288
s_waitcnt lgkmcnt(4)
v_pk_add_f32 v[232:233], v[40:41], v[42:43] neg_hi:[0,1]
v_pk_add_f32 v[234:235], v[40:41], v[42:43] op_sel:[1,1] op_sel_hi:[0,0] neg_hi:[1,0]
buffer_store_dwordx4 v[232:235], v8, s[84:87], s13 offen sc1
s_add_u32 s13, s13, 524288
s_waitcnt lgkmcnt(2)
v_pk_add_f32 v[236:237], v[44:45], v[46:47] neg_hi:[0,1]
v_pk_add_f32 v[238:239], v[44:45], v[46:47] op_sel:[1,1] op_sel_hi:[0,0] neg_hi:[1,0]
buffer_store_dwordx4 v[236:239], v8, s[84:87], s13 offen sc1
s_add_u32 s13, s13, 524288
s_waitcnt lgkmcnt(0)
v_pk_add_f32 v[208:209], v[16:17], v[18:19] neg_hi:[0,1]
v_pk_add_f32 v[210:211], v[16:17], v[18:19] op_sel:[1,1] op_sel_hi:[0,0] neg_hi:[1,0]
v_cmp_eq_u32 vcc, 0, v9
s_nop 1
v_cndmask_b32 v13, -16, v8, vcc
buffer_store_dwordx4 v[208:211], v13, s[84:87], s13 offen sc1
s_add_u32 s13, s13, 524288
s_mov_b32 s93, s21
s_cmp_lt_u32 s93, 128
s_cbranch_scc1 mega_kernel_f1_l
mega_kernel_f1_e:
s_mov_b32 s93, s40
s_waitcnt vmcnt(0)
s_load_dwordx2 s[4:5], s[0:1], 64
s_load_dwordx2 s[8:9], s[0:1], 72
v_and_b32 v1, 63, v0
v_lshrrev_b32 v2, 6, v0
v_mul_u32_u24 v3, 1026, v2
v_lshl_add_u32 v3, v1, 1, v3
v_mul_u32_u24 v4, 65, v1
v_add_u32 v4, v4, v2
v_lshlrev_b32 v4, 2, v4
v_lshrrev_b32 v7, 4, v0
v_and_b32 v8, 15, v0
v_mul_u32_u24 v5, 65, v7
v_lshl_add_u32 v5, v8, 2, v5
v_lshlrev_b32 v5, 2, v5
v_lshlrev_b32 v6, 13, v7
v_lshl_add_u32 v6, v8, 4, v6
s_add_u32 s24, s84, 121634816
s_addc_u32 s25, s85, 0
s_mov_b32 s26, 4202496
s_mov_b32 s27, 0x00020000
s_waitcnt lgkmcnt(0)
s_mov_b32 s6, 2101248
s_mov_b32 s7, 0x00020000
s_mov_b32 s10, 2101248
s_mov_b32 s11, 0x00020000
s_cmp_lt_u32 s93, 288
s_cbranch_scc0 mega_kernel_f0_e
s_and_b32 s12, s93, 31
s_mul_i32 s12, s12, 65664
s_lshr_b32 s13, s93, 5
s_lshl_b32 s13, s13, 7
s_add_u32 s12, s12, s13
buffer_load_ushort v16, v3, s[4:7], s12 offen
buffer_load_ushort v32, v3, s[8:11], s12 offen
s_add_u32 s12, s12, 4104
buffer_load_ushort v17, v3, s[4:7], s12 offen
buffer_load_ushort v33, v3, s[8:11], s12 offen
s_add_u32 s12, s12, 4104
buffer_load_ushort v18, v3, s[4:7], s12 offen
buffer_load_ushort v34, v3, s[8:11], s12 offen
s_add_u32 s12, s12, 4104
buffer_load_ushort v19, v3, s[4:7], s12 offen
buffer_load_ushort v35, v3, s[8:11], s12 offen
s_add_u32 s12, s12, 4104
buffer_load_ushort v20, v3, s[4:7], s12 offen
buffer_load_ushort v36, v3, s[8:11], s12 offen
s_add_u32 s12, s12, 4104
buffer_load_ushort v21, v3, s[4:7], s12 offen
buffer_load_ushort v37, v3, s[8:11], s12 offen
s_add_u32 s12, s12, 4104
buffer_load_ushort v22, v3, s[4:7], s12 offen
buffer_load_ushort v38, v3, s[8:11], s12 offen
s_add_u32 s12, s12, 4104
buffer_load_ushort v23, v3, s[4:7], s12 offen
buffer_load_ushort v39, v3, s[8:11], s12 offen
s_add_u32 s12, s12, 4104
buffer_load_ushort v24, v3, s[4:7], s12 offen
buffer_load_ushort v40, v3, s[8:11], s12 offen
s_add_u32 s12, s12, 4104
buffer_load_ushort v25, v3, s[4:7], s12 offen
buffer_load_ushort v41, v3, s[8:11], s12 offen
s_add_u32 s12, s12, 4104
buffer_load_ushort v26, v3, s[4:7], s12 offen
buffer_load_ushort v42, v3, s[8:11], s12 offen
s_add_u32 s12, s12, 4104
buffer_load_ushort v27, v3, s[4:7], s12 offen
buffer_load_ushort v43, v3, s[8:11], s12 offen
s_add_u32 s12, s12, 4104
buffer_load_ushort v28, v3, s[4:7], s12 offen
buffer_load_ushort v44, v3, s[8:11], s12 offen
s_add_u32 s12, s12, 4104
buffer_load_ushort v29, v3, s[4:7], s12 offen
buffer_load_ushort v45, v3, s[8:11], s12 offen
s_add_u32 s12, s12, 4104
buffer_load_ushort v30, v3, s[4:7], s12 offen
buffer_load_ushort v46, v3, s[8:11], s12 offen
s_add_u32 s12, s12, 4104
buffer_load_ushort v31, v3, s[4:7], s12 offen
buffer_load_ushort v47, v3, s[8:11], s12 offen
s_add_u32 s12, s12, 4104
s_waitcnt vmcnt(0)
mega_kernel_f0_l:
s_add_u32 s21, s93, 32
s_cmp_lt_u32 s21, 288
s_cselect_b32 s22, s21, s93
s_waitcnt vmcnt(4)
v_lshl_or_b32 v48, v32, 16, v16
v_lshl_or_b32 v49, v33, 16, v17
v_lshl_or_b32 v50, v34, 16, v18
v_lshl_or_b32 v51, v35, 16, v19
v_lshl_or_b32 v52, v36, 16, v20
v_lshl_or_b32 v53, v37, 16, v21
v_lshl_or_b32 v54, v38, 16, v22
v_lshl_or_b32 v55, v39, 16, v23
v_lshl_or_b32 v56, v40, 16, v24
v_lshl_or_b32 v57, v41, 16, v25
v_lshl_or_b32 v58, v42, 16, v26
v_lshl_or_b32 v59, v43, 16, v27
v_lshl_or_b32 v60, v44, 16, v28
v_lshl_or_b32 v61, v45, 16, v29
v_lshl_or_b32 v62, v46, 16, v30
v_lshl_or_b32 v63, v47, 16, v31
s_and_b32 s12, s22, 31
s_mul_i32 s12, s12, 65664
s_lshr_b32 s13, s22, 5
s_lshl_b32 s13, s13, 7
s_add_u32 s12, s12, s13
buffer_load_ushort v16, v3, s[4:7], s12 offen
buffer_load_ushort v32, v3, s[8:11], s12 offen
s_add_u32 s12, s12, 4104
buffer_load_ushort v17, v3, s[4:7], s12 offen
buffer_load_ushort v33, v3, s[8:11], s12 offen
s_add_u32 s12, s12, 4104
buffer_load_ushort v18, v3, s[4:7], s12 offen
buffer_load_ushort v34, v3, s[8:11], s12 offen
s_add_u32 s12, s12, 4104
buffer_load_ushort v19, v3, s[4:7], s12 offen
buffer_load_ushort v35, v3, s[8:11], s12 offen
s_add_u32 s12, s12, 4104
buffer_load_ushort v20, v3, s[4:7], s12 offen
buffer_load_ushort v36, v3, s[8:11], s12 offen
s_add_u32 s12, s12, 4104
buffer_load_ushort v21, v3, s[4:7], s12 offen
buffer_load_ushort v37, v3, s[8:11], s12 offen
s_add_u32 s12, s12, 4104
buffer_load_ushort v22, v3, s[4:7], s12 offen
buffer_load_ushort v38, v3, s[8:11], s12 offen
s_add_u32 s12, s12, 4104
buffer_load_ushort v23, v3, s[4:7], s12 offen
buffer_load_ushort v39, v3, s[8:11], s12 offen
s_add_u32 s12, s12, 4104
buffer_load_ushort v24, v3, s[4:7], s12 offen
buffer_load_ushort v40, v3, s[8:11], s12 offen
s_add_u32 s12, s12, 4104
buffer_load_ushort v25, v3, s[4:7], s12 offen
buffer_load_ushort v41, v3, s[8:11], s12 offen
s_add_u32 s12, s12, 4104
buffer_load_ushort v26, v3, s[4:7], s12 offen
buffer_load_ushort v42, v3, s[8:11], s12 offen
s_add_u32 s12, s12, 4104
buffer_load_ushort v27, v3, s[4:7], s12 offen
buffer_load_ushort v43, v3, s[8:11], s12 offen
s_add_u32 s12, s12, 4104
buffer_load_ushort v28, v3, s[4:7], s12 offen
buffer_load_ushort v44, v3, s[8:11], s12 offen
s_add_u32 s12, s12, 4104
buffer_load_ushort v29, v3, s[4:7], s12 offen
buffer_load_ushort v45, v3, s[8:11], s12 offen
s_add_u32 s12, s12, 4104
buffer_load_ushort v30, v3, s[4:7], s12 offen
buffer_load_ushort v46, v3, s[8:11], s12 offen
s_add_u32 s12, s12, 4104
buffer_load_ushort v31, v3, s[4:7], s12 offen
buffer_load_ushort v47, v3, s[8:11], s12 offen
s_add_u32 s12, s12, 4104
s_barrier
ds_write_b32 v4, v48 offset:0
ds_write_b32 v4, v49 offset:16
ds_write_b32 v4, v50 offset:32
ds_write_b32 v4, v51 offset:48
ds_write_b32 v4, v52 offset:64
ds_write_b32 v4, v53 offset:80
ds_write_b32 v4, v54 offset:96
ds_write_b32 v4, v55 offset:112
ds_write_b32 v4, v56 offset:128
ds_write_b32 v4, v57 offset:144
ds_write_b32 v4, v58 offset:160
ds_write_b32 v4, v59 offset:176
s_waitcnt lgkmcnt(4)
ds_write_b32 v4, v60 offset:192
ds_write_b32 v4, v61 offset:208
ds_write_b32 v4, v62 offset:224
ds_write_b32 v4, v63 offset:240
s_waitcnt lgkmcnt(0)
s_barrier
ds_read2_b32 v[64:65], v5 offset0:0 offset1:1
ds_read_b32 v66, v5 offset:8
ds_read_b32 v67, v5 offset:12
ds_read_b32 v68, v5 offset:4160
ds_read_b32 v69, v5 offset:4164
ds_read_b32 v70, v5 offset:4168
ds_read_b32 v71, v5 offset:4172
ds_read_b32 v72, v5 offset:8320
ds_read_b32 v73, v5 offset:8324
ds_read_b32 v74, v5 offset:8328
ds_read_b32 v75, v5 offset:8332
ds_read_b32 v76, v5 offset:12480
ds_read_b32 v77, v5 offset:12484
ds_read_b32 v78, v5 offset:12488
ds_read_b32 v79, v5 offset:12492
s_and_b32 s14, s93, 31
s_lshl_b32 s14, s14, 8
s_lshr_b32 s15, s93, 5
s_lshl_b32 s15, s15, 19
s_add_u32 s14, s14, s15
s_waitcnt lgkmcnt(0)
buffer_store_dwordx4 v[64:67], v6, s[24:27], s14 offen sc1
s_add_u32 s14, s14, 131072
buffer_store_dwordx4 v[68:71], v6, s[24:27], s14 offen sc1
s_add_u32 s14, s14, 131072
buffer_store_dwordx4 v[72:75], v6, s[24:27], s14 offen sc1
s_add_u32 s14, s14, 131072
buffer_store_dwordx4 v[76:79], v6, s[24:27], s14 offen sc1
s_add_u32 s14, s14, 131072
s_mov_b32 s93, s21
s_cmp_lt_u32 s93, 288
s_cbranch_scc1 mega_kernel_f0_l
mega_kernel_f0_e:
v_and_b32 v3, 15, v0
v_lshlrev_b32 v3, 4, v3
s_branch mega_kernel_syd
mega_kernel_sydw:
s_sleep 4
mega_kernel_syd:
buffer_load_dword v2, v3, s[72:75], 0 offen sc1
s_waitcnt vmcnt(0)
s_cmp_eq_u32 s95, 1
s_cbranch_scc0 mega_kernel_sydf
v_readlane_b32 s76, v2, 14
s_mov_b32 s98, 0
s_cmp_eq_u32 s76, 64
s_cbranch_scc0 mega_kernel_sydw
s_branch mega_kernel_sydd
mega_kernel_sydf:
s_mov_b32 s77, 0
s_mov_b32 s78, 0
v_readlane_b32 s76, v2, 0
s_add_u32 s77, s77, s76
s_xor_b32 s76, s76, 32
s_or_b32 s78, s78, s76
v_readlane_b32 s76, v2, 1
s_add_u32 s77, s77, s76
s_xor_b32 s76, s76, 32
s_or_b32 s78, s78, s76
v_readlane_b32 s76, v2, 2
s_add_u32 s77, s77, s76
s_xor_b32 s76, s76, 32
s_or_b32 s78, s78, s76
v_readlane_b32 s76, v2, 3
s_add_u32 s77, s77, s76
s_xor_b32 s76, s76, 32
s_or_b32 s78, s78, s76
v_readlane_b32 s76, v2, 4
s_add_u32 s77, s77, s76
s_xor_b32 s76, s76, 32
s_or_b32 s78, s78, s76
v_readlane_b32 s76, v2, 5
s_add_u32 s77, s77, s76
s_xor_b32 s76, s76, 32
s_or_b32 s78, s78, s76
v_readlane_b32 s76, v2, 6
s_add_u32 s77, s77, s76
s_xor_b32 s76, s76, 32
s_or_b32 s78, s78, s76
v_readlane_b32 s76, v2, 7
s_add_u32 s77, s77, s76
s_xor_b32 s76, s76, 32
s_or_b32 s78, s78, s76
s_cmp_eq_u32 s77, 256
s_cbranch_scc0 mega_kernel_sydw
v_mov_b32 v252, v2
s_cmp_eq_u32 s78, 0
s_cbranch_scc0 mega_kernel_slowent
v_readlane_b32 s76, v2, 10
v_readlane_b32 s77, v2, 8
s_cmp_eq_u32 s76, 64
s_cbranch_scc0 mega_kernel_sydw
s_cmp_gt_u32 s77, 32
s_cselect_b32 s98, 1, 0
mega_kernel_sydd:
s_waitcnt vmcnt(0)
s_barrier
v_mov_b32 v1, 0
v_mov_b32 v2, 1
s_mov_b32 s82, 69259264
v_cmp_eq_u32 vcc, 0, v0
s_and_saveexec_b64 s[80:81], vcc
s_cbranch_execz mega_kernel_sg0
buffer_atomic_add v2, v1, s[84:87], s82 offen sc1
mega_kernel_sg0:
s_mov_b64 exec, s[80:81]
s_add_u32 s38, s40, 128
s_mov_b32 s39, 32
s_mov_b32 s37, 129
s_cmp_lt_u32 s38, 129
s_cbranch_scc1 mega_kernel_f2s
s_branch mega_kernel_f2e
mega_kernel_rk:
s_load_dwordx2 s[4:5], s[0:1], 24
s_load_dwordx2 s[8:9], s[0:1], 0
v_lshrrev_b32 v2, 6, v0
v_and_b32 v1, 63, v0
v_readfirstlane_b32 s41, v2
v_lshlrev_b32 v5, 4, v1
s_waitcnt lgkmcnt(0)
s_mov_b32 s6, 8388608
s_mov_b32 s7, 0x00020000
s_mov_b32 s10, 4194304
s_mov_b32 s11, 0x00020000
s_lshl_b32 s43, s40, 8
s_lshl_b32 s44, s41, 6
s_add_u32 s48, s43, s44
s_and_b32 s43, s48, 0x7ff
v_add_u32 v19, s43, v1
v_lshlrev_b32 v19, 7, v19
buffer_load_dword v20, v19, s[8:11], 0 offen
v_lshrrev_b32 v2, 2, v1
v_and_b32 v3, 3, v1
v_lshlrev_b32 v16, 13, v2
v_lshl_add_u32 v16, v3, 4, v16
v_add_u32 v16, s48, v16
v_and_b32 v3, 3, v1
s_lshl_b32 s45, s41, 15
v_bfe_u32 v17, v1, 2, 2
v_lshrrev_b32 v18, 4, v1
v_lshl_add_u32 v17, v18, 3, v17
v_lshlrev_b32 v17, 6, v17
v_lshl_add_u32 v17, v3, 4, v17
v_add_u32 v17, s45, v17
s_add_u32 m0, s45, 0
s_mov_b32 s44, 0
buffer_load_dwordx4 v16, s[4:7], s44 offen lds
s_add_u32 m0, s45, 1024
s_mov_b32 s44, 131072
buffer_load_dwordx4 v16, s[4:7], s44 offen lds
s_add_u32 m0, s45, 2048
s_mov_b32 s44, 262144
buffer_load_dwordx4 v16, s[4:7], s44 offen lds
s_add_u32 m0, s45, 3072
s_mov_b32 s44, 393216
buffer_load_dwordx4 v16, s[4:7], s44 offen lds
s_add_u32 m0, s45, 4096
s_mov_b32 s44, 524288
buffer_load_dwordx4 v16, s[4:7], s44 offen lds
s_add_u32 m0, s45, 5120
s_mov_b32 s44, 655360
buffer_load_dwordx4 v16, s[4:7], s44 offen lds
s_add_u32 m0, s45, 6144
s_mov_b32 s44, 786432
buffer_load_dwordx4 v16, s[4:7], s44 offen lds
s_add_u32 m0, s45, 7168
s_mov_b32 s44, 917504
buffer_load_dwordx4 v16, s[4:7], s44 offen lds
s_add_u32 m0, s45, 8192
s_mov_b32 s44, 1048576
buffer_load_dwordx4 v16, s[4:7], s44 offen lds
s_add_u32 m0, s45, 9216
s_mov_b32 s44, 1179648
buffer_load_dwordx4 v16, s[4:7], s44 offen lds
s_add_u32 m0, s45, 10240
s_mov_b32 s44, 1310720
buffer_load_dwordx4 v16, s[4:7], s44 offen lds
s_add_u32 m0, s45, 11264
s_mov_b32 s44, 1441792
buffer_load_dwordx4 v16, s[4:7], s44 offen lds
s_add_u32 m0, s45, 12288
s_mov_b32 s44, 1572864
buffer_load_dwordx4 v16, s[4:7], s44 offen lds
s_add_u32 m0, s45, 13312
s_mov_b32 s44, 1703936
buffer_load_dwordx4 v16, s[4:7], s44 offen lds
s_add_u32 m0, s45, 14336
s_mov_b32 s44, 1835008
buffer_load_dwordx4 v16, s[4:7], s44 offen lds
s_add_u32 m0, s45, 15360
s_mov_b32 s44, 1966080
buffer_load_dwordx4 v16, s[4:7], s44 offen lds
s_add_u32 m0, s45, 16384
s_mov_b32 s44, 2097152
buffer_load_dwordx4 v16, s[4:7], s44 offen lds
s_add_u32 m0, s45, 17408
s_mov_b32 s44, 2228224
buffer_load_dwordx4 v16, s[4:7], s44 offen lds
s_add_u32 m0, s45, 18432
s_mov_b32 s44, 2359296
buffer_load_dwordx4 v16, s[4:7], s44 offen lds
s_add_u32 m0, s45, 19456
s_mov_b32 s44, 2490368
buffer_load_dwordx4 v16, s[4:7], s44 offen lds
s_add_u32 m0, s45, 20480
s_mov_b32 s44, 2621440
buffer_load_dwordx4 v16, s[4:7], s44 offen lds
s_add_u32 m0, s45, 21504
s_mov_b32 s44, 2752512
buffer_load_dwordx4 v16, s[4:7], s44 offen lds
s_add_u32 m0, s45, 22528
s_mov_b32 s44, 2883584
buffer_load_dwordx4 v16, s[4:7], s44 offen lds
s_add_u32 m0, s45, 23552
s_mov_b32 s44, 3014656
buffer_load_dwordx4 v16, s[4:7], s44 offen lds
s_add_u32 m0, s45, 24576
s_mov_b32 s44, 3145728
buffer_load_dwordx4 v16, s[4:7], s44 offen lds
s_add_u32 m0, s45, 25600
s_mov_b32 s44, 3276800
buffer_load_dwordx4 v16, s[4:7], s44 offen lds
s_add_u32 m0, s45, 26624
s_mov_b32 s44, 3407872
buffer_load_dwordx4 v16, s[4:7], s44 offen lds
s_add_u32 m0, s45, 27648
s_mov_b32 s44, 3538944
buffer_load_dwordx4 v16, s[4:7], s44 offen lds
s_add_u32 m0, s45, 28672
s_mov_b32 s44, 3670016
buffer_load_dwordx4 v16, s[4:7], s44 offen lds
s_add_u32 m0, s45, 29696
s_mov_b32 s44, 3801088
buffer_load_dwordx4 v16, s[4:7], s44 offen lds
s_add_u32 m0, s45, 30720
s_mov_b32 s44, 3932160
buffer_load_dwordx4 v16, s[4:7], s44 offen lds
s_add_u32 m0, s45, 31744
s_mov_b32 s44, 4063232
buffer_load_dwordx4 v16, s[4:7], s44 offen lds
s_waitcnt vmcnt(16)
ds_read_b64_tr_b16 a[0:1], v17 offset:0
ds_read_b64_tr_b16 a[2:3], v17 offset:256
ds_read_b64_tr_b16 a[4:5], v17 offset:8
ds_read_b64_tr_b16 a[6:7], v17 offset:264
ds_read_b64_tr_b16 a[8:9], v17 offset:2048
ds_read_b64_tr_b16 a[10:11], v17 offset:2304
ds_read_b64_tr_b16 a[12:13], v17 offset:2056
ds_read_b64_tr_b16 a[14:15], v17 offset:2312
s_waitcnt lgkmcnt(0)
ds_read_b64_tr_b16 a[16:17], v17 offset:4096
ds_read_b64_tr_b16 a[18:19], v17 offset:4352
ds_read_b64_tr_b16 a[20:21], v17 offset:4104
ds_read_b64_tr_b16 a[22:23], v17 offset:4360
ds_read_b64_tr_b16 a[24:25], v17 offset:6144
ds_read_b64_tr_b16 a[26:27], v17 offset:6400
ds_read_b64_tr_b16 a[28:29], v17 offset:6152
ds_read_b64_tr_b16 a[30:31], v17 offset:6408
s_waitcnt lgkmcnt(0)
ds_read_b64_tr_b16 a[32:33], v17 offset:8192
ds_read_b64_tr_b16 a[34:35], v17 offset:8448
ds_read_b64_tr_b16 a[36:37], v17 offset:8200
ds_read_b64_tr_b16 a[38:39], v17 offset:8456
ds_read_b64_tr_b16 a[40:41], v17 offset:10240
ds_read_b64_tr_b16 a[42:43], v17 offset:10496
ds_read_b64_tr_b16 a[44:45], v17 offset:10248
ds_read_b64_tr_b16 a[46:47], v17 offset:10504
s_waitcnt lgkmcnt(0)
ds_read_b64_tr_b16 a[48:49], v17 offset:12288
ds_read_b64_tr_b16 a[50:51], v17 offset:12544
ds_read_b64_tr_b16 a[52:53], v17 offset:12296
ds_read_b64_tr_b16 a[54:55], v17 offset:12552
ds_read_b64_tr_b16 a[56:57], v17 offset:14336
ds_read_b64_tr_b16 a[58:59], v17 offset:14592
ds_read_b64_tr_b16 a[60:61], v17 offset:14344
ds_read_b64_tr_b16 a[62:63], v17 offset:14600
s_waitcnt lgkmcnt(0)
s_add_u32 m0, s45, 0
s_mov_b32 s44, 4194304
buffer_load_dwordx4 v16, s[4:7], s44 offen lds
s_add_u32 m0, s45, 1024
s_mov_b32 s44, 4325376
buffer_load_dwordx4 v16, s[4:7], s44 offen lds
s_add_u32 m0, s45, 2048
s_mov_b32 s44, 4456448
buffer_load_dwordx4 v16, s[4:7], s44 offen lds
s_add_u32 m0, s45, 3072
s_mov_b32 s44, 4587520
buffer_load_dwordx4 v16, s[4:7], s44 offen lds
s_add_u32 m0, s45, 4096
s_mov_b32 s44, 4718592
buffer_load_dwordx4 v16, s[4:7], s44 offen lds
s_add_u32 m0, s45, 5120
s_mov_b32 s44, 4849664
buffer_load_dwordx4 v16, s[4:7], s44 offen lds
s_add_u32 m0, s45, 6144
s_mov_b32 s44, 4980736
buffer_load_dwordx4 v16, s[4:7], s44 offen lds
s_add_u32 m0, s45, 7168
s_mov_b32 s44, 5111808
buffer_load_dwordx4 v16, s[4:7], s44 offen lds
s_add_u32 m0, s45, 8192
s_mov_b32 s44, 5242880
buffer_load_dwordx4 v16, s[4:7], s44 offen lds
s_add_u32 m0, s45, 9216
s_mov_b32 s44, 5373952
buffer_load_dwordx4 v16, s[4:7], s44 offen lds
s_add_u32 m0, s45, 10240
s_mov_b32 s44, 5505024
buffer_load_dwordx4 v16, s[4:7], s44 offen lds
s_add_u32 m0, s45, 11264
s_mov_b32 s44, 5636096
buffer_load_dwordx4 v16, s[4:7], s44 offen lds
s_add_u32 m0, s45, 12288
s_mov_b32 s44, 5767168
buffer_load_dwordx4 v16, s[4:7], s44 offen lds
s_add_u32 m0, s45, 13312
s_mov_b32 s44, 5898240
buffer_load_dwordx4 v16, s[4:7], s44 offen lds
s_add_u32 m0, s45, 14336
s_mov_b32 s44, 6029312
buffer_load_dwordx4 v16, s[4:7], s44 offen lds
s_add_u32 m0, s45, 15360
s_mov_b32 s44, 6160384
buffer_load_dwordx4 v16, s[4:7], s44 offen lds
s_waitcnt vmcnt(16)
ds_read_b64_tr_b16 a[64:65], v17 offset:16384
ds_read_b64_tr_b16 a[66:67], v17 offset:16640
ds_read_b64_tr_b16 a[68:69], v17 offset:16392
ds_read_b64_tr_b16 a[70:71], v17 offset:16648
ds_read_b64_tr_b16 a[72:73], v17 offset:18432
ds_read_b64_tr_b16 a[74:75], v17 offset:18688
ds_read_b64_tr_b16 a[76:77], v17 offset:18440
ds_read_b64_tr_b16 a[78:79], v17 offset:18696
s_waitcnt lgkmcnt(0)
ds_read_b64_tr_b16 a[80:81], v17 offset:20480
ds_read_b64_tr_b16 a[82:83], v17 offset:20736
ds_read_b64_tr_b16 a[84:85], v17 offset:20488
ds_read_b64_tr_b16 a[86:87], v17 offset:20744
ds_read_b64_tr_b16 a[88:89], v17 offset:22528
ds_read_b64_tr_b16 a[90:91], v17 offset:22784
ds_read_b64_tr_b16 a[92:93], v17 offset:22536
ds_read_b64_tr_b16 a[94:95], v17 offset:22792
s_waitcnt lgkmcnt(0)
ds_read_b64_tr_b16 a[96:97], v17 offset:24576
ds_read_b64_tr_b16 a[98:99], v17 offset:24832
ds_read_b64_tr_b16 a[100:101], v17 offset:24584
ds_read_b64_tr_b16 a[102:103], v17 offset:24840
ds_read_b64_tr_b16 a[104:105], v17 offset:26624
ds_read_b64_tr_b16 a[106:107], v17 offset:26880
ds_read_b64_tr_b16 a[108:109], v17 offset:26632
ds_read_b64_tr_b16 a[110:111], v17 offset:26888
s_waitcnt lgkmcnt(0)
ds_read_b64_tr_b16 a[112:113], v17 offset:28672
ds_read_b64_tr_b16 a[114:115], v17 offset:28928
ds_read_b64_tr_b16 a[116:117], v17 offset:28680
ds_read_b64_tr_b16 a[118:119], v17 offset:28936
ds_read_b64_tr_b16 a[120:121], v17 offset:30720
ds_read_b64_tr_b16 a[122:123], v17 offset:30976
ds_read_b64_tr_b16 a[124:125], v17 offset:30728
ds_read_b64_tr_b16 a[126:127], v17 offset:30984
s_waitcnt lgkmcnt(0)
s_add_u32 m0, s45, 16384
s_mov_b32 s44, 6291456
buffer_load_dwordx4 v16, s[4:7], s44 offen lds
s_add_u32 m0, s45, 17408
s_mov_b32 s44, 6422528
buffer_load_dwordx4 v16, s[4:7], s44 offen lds
s_add_u32 m0, s45, 18432
s_mov_b32 s44, 6553600
buffer_load_dwordx4 v16, s[4:7], s44 offen lds
s_add_u32 m0, s45, 19456
s_mov_b32 s44, 6684672
buffer_load_dwordx4 v16, s[4:7], s44 offen lds
s_add_u32 m0, s45, 20480
s_mov_b32 s44, 6815744
buffer_load_dwordx4 v16, s[4:7], s44 offen lds
s_add_u32 m0, s45, 21504
s_mov_b32 s44, 6946816
buffer_load_dwordx4 v16, s[4:7], s44 offen lds
s_add_u32 m0, s45, 22528
s_mov_b32 s44, 7077888
buffer_load_dwordx4 v16, s[4:7], s44 offen lds
s_add_u32 m0, s45, 23552
s_mov_b32 s44, 7208960
buffer_load_dwordx4 v16, s[4:7], s44 offen lds
s_add_u32 m0, s45, 24576
s_mov_b32 s44, 7340032
buffer_load_dwordx4 v16, s[4:7], s44 offen lds
s_add_u32 m0, s45, 25600
s_mov_b32 s44, 7471104
buffer_load_dwordx4 v16, s[4:7], s44 offen lds
s_add_u32 m0, s45, 26624
s_mov_b32 s44, 7602176
buffer_load_dwordx4 v16, s[4:7], s44 offen lds
s_add_u32 m0, s45, 27648
s_mov_b32 s44, 7733248
buffer_load_dwordx4 v16, s[4:7], s44 offen lds
s_add_u32 m0, s45, 28672
s_mov_b32 s44, 7864320
buffer_load_dwordx4 v16, s[4:7], s44 offen lds
s_add_u32 m0, s45, 29696
s_mov_b32 s44, 7995392
buffer_load_dwordx4 v16, s[4:7], s44 offen lds
s_add_u32 m0, s45, 30720
s_mov_b32 s44, 8126464
buffer_load_dwordx4 v16, s[4:7], s44 offen lds
s_add_u32 m0, s45, 31744
s_mov_b32 s44, 8257536
buffer_load_dwordx4 v16, s[4:7], s44 offen lds
s_waitcnt vmcnt(16)
ds_read_b64_tr_b16 a[128:129], v17 offset:0
ds_read_b64_tr_b16 a[130:131], v17 offset:256
ds_read_b64_tr_b16 a[132:133], v17 offset:8
ds_read_b64_tr_b16 a[134:135], v17 offset:264
ds_read_b64_tr_b16 a[136:137], v17 offset:2048
ds_read_b64_tr_b16 a[138:139], v17 offset:2304
ds_read_b64_tr_b16 a[140:141], v17 offset:2056
ds_read_b64_tr_b16 a[142:143], v17 offset:2312
s_waitcnt lgkmcnt(0)
ds_read_b64_tr_b16 a[144:145], v17 offset:4096
ds_read_b64_tr_b16 a[146:147], v17 offset:4352
ds_read_b64_tr_b16 a[148:149], v17 offset:4104
ds_read_b64_tr_b16 a[150:151], v17 offset:4360
ds_read_b64_tr_b16 a[152:153], v17 offset:6144
ds_read_b64_tr_b16 a[154:155], v17 offset:6400
ds_read_b64_tr_b16 a[156:157], v17 offset:6152
ds_read_b64_tr_b16 a[158:159], v17 offset:6408
s_waitcnt lgkmcnt(0)
ds_read_b64_tr_b16 a[160:161], v17 offset:8192
ds_read_b64_tr_b16 a[162:163], v17 offset:8448
ds_read_b64_tr_b16 a[164:165], v17 offset:8200
ds_read_b64_tr_b16 a[166:167], v17 offset:8456
ds_read_b64_tr_b16 a[168:169], v17 offset:10240
ds_read_b64_tr_b16 a[170:171], v17 offset:10496
ds_read_b64_tr_b16 a[172:173], v17 offset:10248
ds_read_b64_tr_b16 a[174:175], v17 offset:10504
s_waitcnt lgkmcnt(0)
ds_read_b64_tr_b16 a[176:177], v17 offset:12288
ds_read_b64_tr_b16 a[178:179], v17 offset:12544
ds_read_b64_tr_b16 a[180:181], v17 offset:12296
ds_read_b64_tr_b16 a[182:183], v17 offset:12552
ds_read_b64_tr_b16 a[184:185], v17 offset:14336
ds_read_b64_tr_b16 a[186:187], v17 offset:14592
ds_read_b64_tr_b16 a[188:189], v17 offset:14344
ds_read_b64_tr_b16 a[190:191], v17 offset:14600
s_waitcnt lgkmcnt(0)
s_waitcnt vmcnt(0)
ds_read_b64_tr_b16 a[192:193], v17 offset:16384
ds_read_b64_tr_b16 a[194:195], v17 offset:16640
ds_read_b64_tr_b16 a[196:197], v17 offset:16392
ds_read_b64_tr_b16 a[198:199], v17 offset:16648
ds_read_b64_tr_b16 a[200:201], v17 offset:18432
ds_read_b64_tr_b16 a[202:203], v17 offset:18688
ds_read_b64_tr_b16 a[204:205], v17 offset:18440
ds_read_b64_tr_b16 a[206:207], v17 offset:18696
s_waitcnt lgkmcnt(0)
ds_read_b64_tr_b16 a[208:209], v17 offset:20480
ds_read_b64_tr_b16 a[210:211], v17 offset:20736
ds_read_b64_tr_b16 a[212:213], v17 offset:20488
ds_read_b64_tr_b16 a[214:215], v17 offset:20744
ds_read_b64_tr_b16 a[216:217], v17 offset:22528
ds_read_b64_tr_b16 a[218:219], v17 offset:22784
ds_read_b64_tr_b16 a[220:221], v17 offset:22536
ds_read_b64_tr_b16 a[222:223], v17 offset:22792
s_waitcnt lgkmcnt(0)
ds_read_b64_tr_b16 a[224:225], v17 offset:24576
ds_read_b64_tr_b16 a[226:227], v17 offset:24832
ds_read_b64_tr_b16 a[228:229], v17 offset:24584
ds_read_b64_tr_b16 a[230:231], v17 offset:24840
ds_read_b64_tr_b16 a[232:233], v17 offset:26624
ds_read_b64_tr_b16 a[234:235], v17 offset:26880
ds_read_b64_tr_b16 a[236:237], v17 offset:26632
ds_read_b64_tr_b16 a[238:239], v17 offset:26888
s_waitcnt lgkmcnt(0)
ds_read_b64_tr_b16 a[240:241], v17 offset:28672
ds_read_b64_tr_b16 a[242:243], v17 offset:28928
ds_read_b64_tr_b16 a[244:245], v17 offset:28680
ds_read_b64_tr_b16 a[246:247], v17 offset:28936
ds_read_b64_tr_b16 a[248:249], v17 offset:30720
ds_read_b64_tr_b16 a[250:251], v17 offset:30976
ds_read_b64_tr_b16 a[252:253], v17 offset:30728
ds_read_b64_tr_b16 a[254:255], v17 offset:30984
s_waitcnt lgkmcnt(0)
s_barrier
v_lshrrev_b32 v2, 3, v1
s_lshl_b32 s43, s41, 3
v_add_u32 v2, s43, v2
v_bfe_u32 v3, v2, 1, 3
v_and_b32 v4, 7, v1
v_xor_b32 v3, v3, v4
v_lshlrev_b32 v6, 11, v2
v_lshl_add_u32 v6, v3, 4, v6
s_lshl_b32 s46, s41, 10
v_and_b32 v2, 15, v1
v_bfe_u32 v3, v2, 1, 3
v_lshrrev_b32 v4, 4, v1
v_xor_b32 v3, v3, v4
v_lshlrev_b32 v8, 7, v2
v_lshl_add_u32 v8, v3, 4, v8
v_xor_b32 v9, 64, v8
v_add_u32 v10, 0x10000, v8
v_add_u32 v11, 0x10000, v9
v_mov_b32 v7, v5
s_lshl_b32 s47, s40, 2
s_add_u32 s47, s47, s41
s_mov_b32 s42, 0
s_mov_b32 s50, 0
s_add_u32 m0, s46, 0
s_nop 0
buffer_load_dwordx4 v6, s[8:11], s50 offen offset:0 lds
s_add_u32 m0, s46, 3968
s_nop 0
buffer_load_dwordx4 v6, s[8:11], s50 offen offset:128 lds
s_add_u32 m0, s46, 7936
s_nop 0
buffer_load_dwordx4 v6, s[8:11], s50 offen offset:256 lds
s_add_u32 m0, s46, 11904
s_nop 0
buffer_load_dwordx4 v6, s[8:11], s50 offen offset:384 lds
s_add_u32 m0, s46, 15872
s_nop 0
buffer_load_dwordx4 v6, s[8:11], s50 offen offset:512 lds
s_add_u32 m0, s46, 19840
s_nop 0
buffer_load_dwordx4 v6, s[8:11], s50 offen offset:640 lds
s_add_u32 m0, s46, 23808
s_nop 0
buffer_load_dwordx4 v6, s[8:11], s50 offen offset:768 lds
s_add_u32 m0, s46, 27776
s_nop 0
buffer_load_dwordx4 v6, s[8:11], s50 offen offset:896 lds
s_add_u32 m0, s46, 31744
s_nop 0
buffer_load_dwordx4 v6, s[8:11], s50 offen offset:1024 lds
s_add_u32 m0, s46, 35712
s_nop 0
buffer_load_dwordx4 v6, s[8:11], s50 offen offset:1152 lds
s_add_u32 m0, s46, 39680
s_nop 0
buffer_load_dwordx4 v6, s[8:11], s50 offen offset:1280 lds
s_add_u32 m0, s46, 43648
s_nop 0
buffer_load_dwordx4 v6, s[8:11], s50 offen offset:1408 lds
s_add_u32 m0, s46, 47616
s_nop 0
buffer_load_dwordx4 v6, s[8:11], s50 offen offset:1536 lds
s_add_u32 m0, s46, 51584
s_nop 0
buffer_load_dwordx4 v6, s[8:11], s50 offen offset:1664 lds
s_add_u32 m0, s46, 55552
s_nop 0
buffer_load_dwordx4 v6, s[8:11], s50 offen offset:1792 lds
s_add_u32 m0, s46, 59520
s_nop 0
buffer_load_dwordx4 v6, s[8:11], s50 offen offset:1920 lds
s_and_b32 s53, s47, 31
s_lshl_b32 s53, s53, 4
v_add_u32 v19, s53, v1
v_lshlrev_b32 v19, 7, v19
s_waitcnt vmcnt(0)
s_barrier
s_add_u32 s50, s42, 1
s_min_u32 s50, s50, 63
s_lshl_b32 s50, s50, 16
ds_read_b128 v[20:23], v8 offset:0
ds_read_b128 v[24:27], v8 offset:2048
ds_read_b128 v[28:31], v9 offset:0
ds_read_b128 v[32:35], v9 offset:2048
ds_read_b128 v[36:39], v8 offset:4096
ds_read_b128 v[40:43], v8 offset:6144
s_waitcnt lgkmcnt(4)
v_mfma_f32_16x16x32_bf16 v[52:55], a[0:3], v[20:23], 0
ds_read_b128 v[44:47], v9 offset:4096
v_mfma_f32_16x16x32_bf16 v[56:59], a[4:7], v[20:23], 0
v_mfma_f32_16x16x32_bf16 v[60:63], a[0:3], v[24:27], 0
ds_read_b128 v[48:51], v9 offset:6144
v_mfma_f32_16x16x32_bf16 v[64:67], a[4:7], v[24:27], 0
s_waitcnt lgkmcnt(4)
v_mfma_f32_16x16x32_bf16 v[52:55], a[8:11], v[28:31], v[52:55]
ds_read_b128 v[20:23], v8 offset:8192
v_mfma_f32_16x16x32_bf16 v[56:59], a[12:15], v[28:31], v[56:59]
v_mfma_f32_16x16x32_bf16 v[60:63], a[8:11], v[32:35], v[60:63]
ds_read_b128 v[24:27], v8 offset:10240
v_mfma_f32_16x16x32_bf16 v[64:67], a[12:15], v[32:35], v[64:67]
s_waitcnt lgkmcnt(4)
v_mfma_f32_16x16x32_bf16 v[52:55], a[16:19], v[36:39], v[52:55]
ds_read_b128 v[28:31], v9 offset:8192
v_mfma_f32_16x16x32_bf16 v[56:59], a[20:23], v[36:39], v[56:59]
v_mfma_f32_16x16x32_bf16 v[60:63], a[16:19], v[40:43], v[60:63]
ds_read_b128 v[32:35], v9 offset:10240
v_mfma_f32_16x16x32_bf16 v[64:67], a[20:23], v[40:43], v[64:67]
s_waitcnt lgkmcnt(4)
v_mfma_f32_16x16x32_bf16 v[52:55], a[24:27], v[44:47], v[52:55]
ds_read_b128 v[36:39], v8 offset:12288
v_mfma_f32_16x16x32_bf16 v[56:59], a[28:31], v[44:47], v[56:59]
s_add_u32 m0, s46, 65536
v_mfma_f32_16x16x32_bf16 v[60:63], a[24:27], v[48:51], v[60:63]
ds_read_b128 v[40:43], v8 offset:14336
v_mfma_f32_16x16x32_bf16 v[64:67], a[28:31], v[48:51], v[64:67]
buffer_load_dwordx4 v6, s[8:11], s50 offen offset:0 lds
s_waitcnt lgkmcnt(4)
v_mfma_f32_16x16x32_bf16 v[52:55], a[32:35], v[20:23], v[52:55]
ds_read_b128 v[44:47], v9 offset:12288
v_mfma_f32_16x16x32_bf16 v[56:59], a[36:39], v[20:23], v[56:59]
s_add_u32 m0, s46, 69504
v_mfma_f32_16x16x32_bf16 v[60:63], a[32:35], v[24:27], v[60:63]
ds_read_b128 v[48:51], v9 offset:14336
v_mfma_f32_16x16x32_bf16 v[64:67], a[36:39], v[24:27], v[64:67]
buffer_load_dwordx4 v6, s[8:11], s50 offen offset:128 lds
s_waitcnt lgkmcnt(4)
v_mfma_f32_16x16x32_bf16 v[52:55], a[40:43], v[28:31], v[52:55]
ds_read_b128 v[20:23], v8 offset:16384
v_mfma_f32_16x16x32_bf16 v[56:59], a[44:47], v[28:31], v[56:59]
s_add_u32 m0, s46, 73472
v_mfma_f32_16x16x32_bf16 v[60:63], a[40:43], v[32:35], v[60:63]
ds_read_b128 v[24:27], v8 offset:18432
v_mfma_f32_16x16x32_bf16 v[64:67], a[44:47], v[32:35], v[64:67]
buffer_load_dwordx4 v6, s[8:11], s50 offen offset:256 lds
s_waitcnt lgkmcnt(4)
v_mfma_f32_16x16x32_bf16 v[52:55], a[48:51], v[36:39], v[52:55]
ds_read_b128 v[28:31], v9 offset:16384
v_mfma_f32_16x16x32_bf16 v[56:59], a[52:55], v[36:39], v[56:59]
s_add_u32 m0, s46, 77440
v_mfma_f32_16x16x32_bf16 v[60:63], a[48:51], v[40:43], v[60:63]
ds_read_b128 v[32:35], v9 offset:18432
v_mfma_f32_16x16x32_bf16 v[64:67], a[52:55], v[40:43], v[64:67]
buffer_load_dwordx4 v6, s[8:11], s50 offen offset:384 lds
s_waitcnt lgkmcnt(4)
v_mfma_f32_16x16x32_bf16 v[52:55], a[56:59], v[44:47], v[52:55]
ds_read_b128 v[36:39], v8 offset:20480
v_mfma_f32_16x16x32_bf16 v[56:59], a[60:63], v[44:47], v[56:59]
s_add_u32 m0, s46, 81408
v_mfma_f32_16x16x32_bf16 v[60:63], a[56:59], v[48:51], v[60:63]
ds_read_b128 v[40:43], v8 offset:22528
v_mfma_f32_16x16x32_bf16 v[64:67], a[60:63], v[48:51], v[64:67]
buffer_load_dwordx4 v6, s[8:11], s50 offen offset:512 lds
s_waitcnt lgkmcnt(4)
v_mfma_f32_16x16x32_bf16 v[52:55], a[64:67], v[20:23], v[52:55]
ds_read_b128 v[44:47], v9 offset:20480
v_mfma_f32_16x16x32_bf16 v[56:59], a[68:71], v[20:23], v[56:59]
s_add_u32 m0, s46, 85376
v_mfma_f32_16x16x32_bf16 v[60:63], a[64:67], v[24:27], v[60:63]
ds_read_b128 v[48:51], v9 offset:22528
v_mfma_f32_16x16x32_bf16 v[64:67], a[68:71], v[24:27], v[64:67]
buffer_load_dwordx4 v6, s[8:11], s50 offen offset:640 lds
s_waitcnt lgkmcnt(4)
v_mfma_f32_16x16x32_bf16 v[52:55], a[72:75], v[28:31], v[52:55]
ds_read_b128 v[20:23], v8 offset:24576
v_mfma_f32_16x16x32_bf16 v[56:59], a[76:79], v[28:31], v[56:59]
s_add_u32 m0, s46, 89344
v_mfma_f32_16x16x32_bf16 v[60:63], a[72:75], v[32:35], v[60:63]
ds_read_b128 v[24:27], v8 offset:26624
v_mfma_f32_16x16x32_bf16 v[64:67], a[76:79], v[32:35], v[64:67]
buffer_load_dwordx4 v6, s[8:11], s50 offen offset:768 lds
s_waitcnt lgkmcnt(4)
v_mfma_f32_16x16x32_bf16 v[52:55], a[80:83], v[36:39], v[52:55]
ds_read_b128 v[28:31], v9 offset:24576
v_mfma_f32_16x16x32_bf16 v[56:59], a[84:87], v[36:39], v[56:59]
s_add_u32 m0, s46, 93312
v_mfma_f32_16x16x32_bf16 v[60:63], a[80:83], v[40:43], v[60:63]
ds_read_b128 v[32:35], v9 offset:26624
v_mfma_f32_16x16x32_bf16 v[64:67], a[84:87], v[40:43], v[64:67]
buffer_load_dwordx4 v6, s[8:11], s50 offen offset:896 lds
s_waitcnt lgkmcnt(4)
v_mfma_f32_16x16x32_bf16 v[52:55], a[88:91], v[44:47], v[52:55]
ds_read_b128 v[36:39], v8 offset:28672
v_mfma_f32_16x16x32_bf16 v[56:59], a[92:95], v[44:47], v[56:59]
s_add_u32 m0, s46, 97280
v_mfma_f32_16x16x32_bf16 v[60:63], a[88:91], v[48:51], v[60:63]
ds_read_b128 v[40:43], v8 offset:30720
v_mfma_f32_16x16x32_bf16 v[64:67], a[92:95], v[48:51], v[64:67]
buffer_load_dwordx4 v6, s[8:11], s50 offen offset:1024 lds
s_waitcnt lgkmcnt(4)
v_mfma_f32_16x16x32_bf16 v[52:55], a[96:99], v[20:23], v[52:55]
ds_read_b128 v[44:47], v9 offset:28672
v_mfma_f32_16x16x32_bf16 v[56:59], a[100:103], v[20:23], v[56:59]
s_add_u32 m0, s46, 101248
v_mfma_f32_16x16x32_bf16 v[60:63], a[96:99], v[24:27], v[60:63]
ds_read_b128 v[48:51], v9 offset:30720
v_mfma_f32_16x16x32_bf16 v[64:67], a[100:103], v[24:27], v[64:67]
buffer_load_dwordx4 v6, s[8:11], s50 offen offset:1152 lds
s_waitcnt lgkmcnt(4)
v_mfma_f32_16x16x32_bf16 v[52:55], a[104:107], v[28:31], v[52:55]
ds_read_b128 v[20:23], v8 offset:32768
v_mfma_f32_16x16x32_bf16 v[56:59], a[108:111], v[28:31], v[56:59]
s_add_u32 m0, s46, 105216
v_mfma_f32_16x16x32_bf16 v[60:63], a[104:107], v[32:35], v[60:63]
ds_read_b128 v[24:27], v8 offset:34816
v_mfma_f32_16x16x32_bf16 v[64:67], a[108:111], v[32:35], v[64:67]
buffer_load_dwordx4 v6, s[8:11], s50 offen offset:1280 lds
s_waitcnt lgkmcnt(4)
v_mfma_f32_16x16x32_bf16 v[52:55], a[112:115], v[36:39], v[52:55]
ds_read_b128 v[28:31], v9 offset:32768
v_mfma_f32_16x16x32_bf16 v[56:59], a[116:119], v[36:39], v[56:59]
s_add_u32 m0, s46, 109184
v_mfma_f32_16x16x32_bf16 v[60:63], a[112:115], v[40:43], v[60:63]
ds_read_b128 v[32:35], v9 offset:34816
v_mfma_f32_16x16x32_bf16 v[64:67], a[116:119], v[40:43], v[64:67]
buffer_load_dwordx4 v6, s[8:11], s50 offen offset:1408 lds
s_waitcnt lgkmcnt(4)
v_mfma_f32_16x16x32_bf16 v[52:55], a[120:123], v[44:47], v[52:55]
ds_read_b128 v[36:39], v8 offset:36864
v_mfma_f32_16x16x32_bf16 v[56:59], a[124:127], v[44:47], v[56:59]
s_add_u32 m0, s46, 113152
v_mfma_f32_16x16x32_bf16 v[60:63], a[120:123], v[48:51], v[60:63]
ds_read_b128 v[40:43], v8 offset:38912
v_mfma_f32_16x16x32_bf16 v[64:67], a[124:127], v[48:51], v[64:67]
buffer_load_dwordx4 v6, s[8:11], s50 offen offset:1536 lds
s_waitcnt lgkmcnt(4)
v_mfma_f32_16x16x32_bf16 v[52:55], a[128:131], v[20:23], v[52:55]
ds_read_b128 v[44:47], v9 offset:36864
v_mfma_f32_16x16x32_bf16 v[56:59], a[132:135], v[20:23], v[56:59]
s_add_u32 m0, s46, 117120
v_mfma_f32_16x16x32_bf16 v[60:63], a[128:131], v[24:27], v[60:63]
ds_read_b128 v[48:51], v9 offset:38912
v_mfma_f32_16x16x32_bf16 v[64:67], a[132:135], v[24:27], v[64:67]
buffer_load_dwordx4 v6, s[8:11], s50 offen offset:1664 lds
s_waitcnt lgkmcnt(4)
v_mfma_f32_16x16x32_bf16 v[52:55], a[136:139], v[28:31], v[52:55]
ds_read_b128 v[20:23], v8 offset:40960
v_mfma_f32_16x16x32_bf16 v[56:59], a[140:143], v[28:31], v[56:59]
s_add_u32 m0, s46, 121088
v_mfma_f32_16x16x32_bf16 v[60:63], a[136:139], v[32:35], v[60:63]
ds_read_b128 v[24:27], v8 offset:43008
v_mfma_f32_16x16x32_bf16 v[64:67], a[140:143], v[32:35], v[64:67]
buffer_load_dwordx4 v6, s[8:11], s50 offen offset:1792 lds
s_waitcnt lgkmcnt(4)
v_mfma_f32_16x16x32_bf16 v[52:55], a[144:147], v[36:39], v[52:55]
ds_read_b128 v[28:31], v9 offset:40960
v_mfma_f32_16x16x32_bf16 v[56:59], a[148:151], v[36:39], v[56:59]
s_add_u32 m0, s46, 125056
v_mfma_f32_16x16x32_bf16 v[60:63], a[144:147], v[40:43], v[60:63]
ds_read_b128 v[32:35], v9 offset:43008
v_mfma_f32_16x16x32_bf16 v[64:67], a[148:151], v[40:43], v[64:67]
buffer_load_dwordx4 v6, s[8:11], s50 offen offset:1920 lds
s_waitcnt lgkmcnt(4)
v_mfma_f32_16x16x32_bf16 v[52:55], a[152:155], v[44:47], v[52:55]
ds_read_b128 v[36:39], v8 offset:45056
v_mfma_f32_16x16x32_bf16 v[56:59], a[156:159], v[44:47], v[56:59]
v_mfma_f32_16x16x32_bf16 v[60:63], a[152:155], v[48:51], v[60:63]
ds_read_b128 v[40:43], v8 offset:47104
v_mfma_f32_16x16x32_bf16 v[64:67], a[156:159], v[48:51], v[64:67]
s_waitcnt lgkmcnt(4)
v_mfma_f32_16x16x32_bf16 v[52:55], a[160:163], v[20:23], v[52:55]
ds_read_b128 v[44:47], v9 offset:45056
v_mfma_f32_16x16x32_bf16 v[56:59], a[164:167], v[20:23], v[56:59]
v_mfma_f32_16x16x32_bf16 v[60:63], a[160:163], v[24:27], v[60:63]
ds_read_b128 v[48:51], v9 offset:47104
v_mfma_f32_16x16x32_bf16 v[64:67], a[164:167], v[24:27], v[64:67]
s_waitcnt lgkmcnt(4)
v_mfma_f32_16x16x32_bf16 v[52:55], a[168:171], v[28:31], v[52:55]
ds_read_b128 v[20:23], v8 offset:49152
v_mfma_f32_16x16x32_bf16 v[56:59], a[172:175], v[28:31], v[56:59]
v_mfma_f32_16x16x32_bf16 v[60:63], a[168:171], v[32:35], v[60:63]
ds_read_b128 v[24:27], v8 offset:51200
v_mfma_f32_16x16x32_bf16 v[64:67], a[172:175], v[32:35], v[64:67]
s_waitcnt lgkmcnt(4)
v_mfma_f32_16x16x32_bf16 v[52:55], a[176:179], v[36:39], v[52:55]
ds_read_b128 v[28:31], v9 offset:49152
v_mfma_f32_16x16x32_bf16 v[56:59], a[180:183], v[36:39], v[56:59]
s_add_u32 s53, s42, 3
s_min_u32 s53, s53, 63
s_lshl_b32 s53, s53, 16
s_mov_b64 exec, 0xffff
buffer_load_dword v18, v19, s[8:11], s53 offen
s_mov_b64 exec, -1
v_mfma_f32_16x16x32_bf16 v[60:63], a[176:179], v[40:43], v[60:63]
ds_read_b128 v[32:35], v9 offset:51200
v_mfma_f32_16x16x32_bf16 v[64:67], a[180:183], v[40:43], v[64:67]
s_waitcnt lgkmcnt(4)
v_mfma_f32_16x16x32_bf16 v[52:55], a[184:187], v[44:47], v[52:55]
ds_read_b128 v[36:39], v8 offset:53248
v_mfma_f32_16x16x32_bf16 v[56:59], a[188:191], v[44:47], v[56:59]
v_mfma_f32_16x16x32_bf16 v[60:63], a[184:187], v[48:51], v[60:63]
ds_read_b128 v[40:43], v8 offset:55296
v_mfma_f32_16x16x32_bf16 v[64:67], a[188:191], v[48:51], v[64:67]
s_waitcnt lgkmcnt(4)
v_mfma_f32_16x16x32_bf16 v[52:55], a[192:195], v[20:23], v[52:55]
ds_read_b128 v[44:47], v9 offset:53248
v_mfma_f32_16x16x32_bf16 v[56:59], a[196:199], v[20:23], v[56:59]
v_mfma_f32_16x16x32_bf16 v[60:63], a[192:195], v[24:27], v[60:63]
ds_read_b128 v[48:51], v9 offset:55296
v_mfma_f32_16x16x32_bf16 v[64:67], a[196:199], v[24:27], v[64:67]
s_waitcnt lgkmcnt(4)
v_mfma_f32_16x16x32_bf16 v[52:55], a[200:203], v[28:31], v[52:55]
ds_read_b128 v[20:23], v8 offset:57344
v_mfma_f32_16x16x32_bf16 v[56:59], a[204:207], v[28:31], v[56:59]
v_mfma_f32_16x16x32_bf16 v[60:63], a[200:203], v[32:35], v[60:63]
ds_read_b128 v[24:27], v8 offset:59392
v_mfma_f32_16x16x32_bf16 v[64:67], a[204:207], v[32:35], v[64:67]
s_waitcnt lgkmcnt(4)
v_mfma_f32_16x16x32_bf16 v[52:55], a[208:211], v[36:39], v[52:55]
ds_read_b128 v[28:31], v9 offset:57344
v_mfma_f32_16x16x32_bf16 v[56:59], a[212:215], v[36:39], v[56:59]
v_mfma_f32_16x16x32_bf16 v[60:63], a[208:211], v[40:43], v[60:63]
ds_read_b128 v[32:35], v9 offset:59392
v_mfma_f32_16x16x32_bf16 v[64:67], a[212:215], v[40:43], v[64:67]
s_waitcnt lgkmcnt(4)
v_mfma_f32_16x16x32_bf16 v[52:55], a[216:219], v[44:47], v[52:55]
ds_read_b128 v[36:39], v8 offset:61440
v_mfma_f32_16x16x32_bf16 v[56:59], a[220:223], v[44:47], v[56:59]
v_mfma_f32_16x16x32_bf16 v[60:63], a[216:219], v[48:51], v[60:63]
ds_read_b128 v[40:43], v8 offset:63488
v_mfma_f32_16x16x32_bf16 v[64:67], a[220:223], v[48:51], v[64:67]
s_waitcnt lgkmcnt(4)
v_mfma_f32_16x16x32_bf16 v[52:55], a[224:227], v[20:23], v[52:55]
ds_read_b128 v[44:47], v9 offset:61440
v_mfma_f32_16x16x32_bf16 v[56:59], a[228:231], v[20:23], v[56:59]
v_mfma_f32_16x16x32_bf16 v[60:63], a[224:227], v[24:27], v[60:63]
ds_read_b128 v[48:51], v9 offset:63488
v_mfma_f32_16x16x32_bf16 v[64:67], a[228:231], v[24:27], v[64:67]
s_waitcnt lgkmcnt(5)
v_mfma_f32_16x16x32_bf16 v[52:55], a[232:235], v[28:31], v[52:55]
v_mfma_f32_16x16x32_bf16 v[56:59], a[236:239], v[28:31], v[56:59]
s_waitcnt lgkmcnt(4)
v_mfma_f32_16x16x32_bf16 v[60:63], a[232:235], v[32:35], v[60:63]
v_mfma_f32_16x16x32_bf16 v[64:67], a[236:239], v[32:35], v[64:67]
s_waitcnt lgkmcnt(3)
v_mfma_f32_16x16x32_bf16 v[52:55], a[240:243], v[36:39], v[52:55]
v_mfma_f32_16x16x32_bf16 v[56:59], a[244:247], v[36:39], v[56:59]
s_waitcnt lgkmcnt(2)
v_mfma_f32_16x16x32_bf16 v[60:63], a[240:243], v[40:43], v[60:63]
v_mfma_f32_16x16x32_bf16 v[64:67], a[244:247], v[40:43], v[64:67]
s_waitcnt lgkmcnt(1)
v_mfma_f32_16x16x32_bf16 v[52:55], a[248:251], v[44:47], v[52:55]
v_mfma_f32_16x16x32_bf16 v[56:59], a[252:255], v[44:47], v[56:59]
s_waitcnt lgkmcnt(0)
v_mfma_f32_16x16x32_bf16 v[60:63], a[248:251], v[48:51], v[60:63]
v_mfma_f32_16x16x32_bf16 v[64:67], a[252:255], v[48:51], v[64:67]
s_add_u32 s42, s42, 1
v_and_b32 v3, 15, v0
v_lshlrev_b32 v3, 4, v3
s_branch mega_kernel_syk
mega_kernel_sykw:
s_sleep 4
mega_kernel_syk:
buffer_load_dword v2, v3, s[72:75], 0 offen sc1
s_waitcnt vmcnt(0)
s_cmp_eq_u32 s95, 1
s_cbranch_scc0 mega_kernel_sykf
v_readlane_b32 s76, v2, 14
s_mov_b32 s98, 0
s_cmp_eq_u32 s76, 64
s_cbranch_scc0 mega_kernel_sykw
s_branch mega_kernel_sykd
mega_kernel_sykf:
s_mov_b32 s77, 0
s_mov_b32 s78, 0
v_readlane_b32 s76, v2, 0
s_add_u32 s77, s77, s76
s_xor_b32 s76, s76, 32
s_or_b32 s78, s78, s76
v_readlane_b32 s76, v2, 1
s_add_u32 s77, s77, s76
s_xor_b32 s76, s76, 32
s_or_b32 s78, s78, s76
v_readlane_b32 s76, v2, 2
s_add_u32 s77, s77, s76
s_xor_b32 s76, s76, 32
s_or_b32 s78, s78, s76
v_readlane_b32 s76, v2, 3
s_add_u32 s77, s77, s76
s_xor_b32 s76, s76, 32
s_or_b32 s78, s78, s76
v_readlane_b32 s76, v2, 4
s_add_u32 s77, s77, s76
s_xor_b32 s76, s76, 32
s_or_b32 s78, s78, s76
v_readlane_b32 s76, v2, 5
s_add_u32 s77, s77, s76
s_xor_b32 s76, s76, 32
s_or_b32 s78, s78, s76
v_readlane_b32 s76, v2, 6
s_add_u32 s77, s77, s76
s_xor_b32 s76, s76, 32
s_or_b32 s78, s78, s76
v_readlane_b32 s76, v2, 7
s_add_u32 s77, s77, s76
s_xor_b32 s76, s76, 32
s_or_b32 s78, s78, s76
s_cmp_eq_u32 s77, 256
s_cbranch_scc0 mega_kernel_sykw
v_mov_b32 v252, v2
s_cmp_eq_u32 s78, 0
s_cbranch_scc0 mega_kernel_slowent
v_readlane_b32 s76, v2, 10
v_readlane_b32 s77, v2, 8
s_cmp_eq_u32 s76, 64
s_cbranch_scc0 mega_kernel_sykw
s_cmp_gt_u32 s77, 32
s_cselect_b32 s98, 1, 0
mega_kernel_sykd:
s_lshr_b32 s44, s47, 3
s_xor_b32 s44, s44, s98
s_and_b32 s44, s44, 1
s_lshl_b32 s44, s44, 13
s_lshl_b32 s48, s47, 18
s_add_u32 s48, s48, s44
s_add_u32 s48, s48, 0
s_xor_b32 s44, s98, 1
s_lshl_b32 s44, s44, 13
s_lshl_b32 s49, s40, 7
s_add_u32 s49, s49, s44
s_lshl_b32 s44, s41, 2
s_add_u32 s49, s49, s44
s_add_u32 s49, s49, 69206016
v_mov_b32 v16, 0
v_cvt_pk_bf16_f32 v84, v52, v53
v_cvt_pk_bf16_f32 v85, v54, v55
v_cvt_pk_bf16_f32 v86, v56, v57
v_cvt_pk_bf16_f32 v87, v58, v59
v_cvt_pk_bf16_f32 v88, v60, v61
v_cvt_pk_bf16_f32 v89, v62, v63
v_cvt_pk_bf16_f32 v90, v64, v65
v_cvt_pk_bf16_f32 v91, v66, v67
s_add_u32 s51, s42, s47
s_sub_u32 s51, s51, 1
s_bfe_u32 s52, s51, 0x40002
s_lshl_b32 s52, s52, 14
s_and_b32 s51, s51, 3
s_lshl_b32 s51, s51, 11
s_add_u32 s51, s51, s52
s_add_u32 s51, s51, s48
buffer_store_dwordx4 v[84:87], v7, s[84:87], s51 offen sc1
buffer_store_dwordx4 v[88:91], v7, s[84:87], s51 offen offset:1024 sc1
s_waitcnt vmcnt(0)
v_mov_b32 v17, s42
s_mov_b64 exec, 1
buffer_store_dword v17, v16, s[84:87], s49 offen sc1
s_mov_b64 exec, -1
mega_kernel_k_loop:
s_waitcnt vmcnt(2)
s_barrier
s_add_u32 s50, s42, 1
s_min_u32 s50, s50, 63
s_lshl_b32 s50, s50, 16
ds_read_b128 v[20:23], v10 offset:0
ds_read_b128 v[24:27], v10 offset:2048
ds_read_b128 v[28:31], v11 offset:0
ds_read_b128 v[32:35], v11 offset:2048
ds_read_b128 v[36:39], v10 offset:4096
ds_read_b128 v[40:43], v10 offset:6144
s_waitcnt lgkmcnt(4)
v_mfma_f32_16x16x32_bf16 v[68:71], a[0:3], v[20:23], 0
ds_read_b128 v[44:47], v11 offset:4096
v_mfma_f32_16x16x32_bf16 v[72:75], a[4:7], v[20:23], 0
v_cvt_pk_bf16_f32 v84, v52, v53
v_cvt_pk_bf16_f32 v85, v54, v55
v_cvt_pk_bf16_f32 v86, v56, v57
v_mfma_f32_16x16x32_bf16 v[76:79], a[0:3], v[24:27], 0
ds_read_b128 v[48:51], v11 offset:6144
v_mfma_f32_16x16x32_bf16 v[80:83], a[4:7], v[24:27], 0
v_cvt_pk_bf16_f32 v87, v58, v59
v_cvt_pk_bf16_f32 v88, v60, v61
v_cvt_pk_bf16_f32 v89, v62, v63
s_waitcnt lgkmcnt(4)
v_mfma_f32_16x16x32_bf16 v[68:71], a[8:11], v[28:31], v[68:71]
ds_read_b128 v[20:23], v10 offset:8192
v_mfma_f32_16x16x32_bf16 v[72:75], a[12:15], v[28:31], v[72:75]
v_cvt_pk_bf16_f32 v90, v64, v65
v_cvt_pk_bf16_f32 v91, v66, v67
v_mfma_f32_16x16x32_bf16 v[76:79], a[8:11], v[32:35], v[76:79]
ds_read_b128 v[24:27], v10 offset:10240
v_mfma_f32_16x16x32_bf16 v[80:83], a[12:15], v[32:35], v[80:83]
s_add_u32 s51, s42, s47
s_sub_u32 s51, s51, 1
s_bfe_u32 s52, s51, 0x40002
s_lshl_b32 s52, s52, 14
s_waitcnt lgkmcnt(4)
v_mfma_f32_16x16x32_bf16 v[68:71], a[16:19], v[36:39], v[68:71]
ds_read_b128 v[28:31], v11 offset:8192
v_mfma_f32_16x16x32_bf16 v[72:75], a[20:23], v[36:39], v[72:75]
s_and_b32 s51, s51, 3
s_lshl_b32 s51, s51, 11
s_add_u32 s51, s51, s52
s_add_u32 s51, s51, s48
buffer_store_dwordx4 v[84:87], v7, s[84:87], s51 offen sc1
v_mfma_f32_16x16x32_bf16 v[76:79], a[16:19], v[40:43], v[76:79]
ds_read_b128 v[32:35], v11 offset:10240
v_mfma_f32_16x16x32_bf16 v[80:83], a[20:23], v[40:43], v[80:83]
buffer_store_dwordx4 v[88:91], v7, s[84:87], s51 offen offset:1024 sc1
s_waitcnt lgkmcnt(4)
v_mfma_f32_16x16x32_bf16 v[68:71], a[24:27], v[44:47], v[68:71]
ds_read_b128 v[36:39], v10 offset:12288
v_mfma_f32_16x16x32_bf16 v[72:75], a[28:31], v[44:47], v[72:75]
s_add_u32 m0, s46, 0
v_mfma_f32_16x16x32_bf16 v[76:79], a[24:27], v[48:51], v[76:79]
ds_read_b128 v[40:43], v10 offset:14336
v_mfma_f32_16x16x32_bf16 v[80:83], a[28:31], v[48:51], v[80:83]
buffer_load_dwordx4 v6, s[8:11], s50 offen offset:0 lds
s_waitcnt lgkmcnt(4)
v_mfma_f32_16x16x32_bf16 v[68:71], a[32:35], v[20:23], v[68:71]
ds_read_b128 v[44:47], v11 offset:12288
v_mfma_f32_16x16x32_bf16 v[72:75], a[36:39], v[20:23], v[72:75]
s_add_u32 m0, s46, 3968
v_mfma_f32_16x16x32_bf16 v[76:79], a[32:35], v[24:27], v[76:79]
ds_read_b128 v[48:51], v11 offset:14336
v_mfma_f32_16x16x32_bf16 v[80:83], a[36:39], v[24:27], v[80:83]
buffer_load_dwordx4 v6, s[8:11], s50 offen offset:128 lds
s_waitcnt lgkmcnt(4)
v_mfma_f32_16x16x32_bf16 v[68:71], a[40:43], v[28:31], v[68:71]
ds_read_b128 v[20:23], v10 offset:16384
v_mfma_f32_16x16x32_bf16 v[72:75], a[44:47], v[28:31], v[72:75]
s_add_u32 m0, s46, 7936
v_mfma_f32_16x16x32_bf16 v[76:79], a[40:43], v[32:35], v[76:79]
ds_read_b128 v[24:27], v10 offset:18432
v_mfma_f32_16x16x32_bf16 v[80:83], a[44:47], v[32:35], v[80:83]
buffer_load_dwordx4 v6, s[8:11], s50 offen offset:256 lds
s_waitcnt lgkmcnt(4)
v_mfma_f32_16x16x32_bf16 v[68:71], a[48:51], v[36:39], v[68:71]
ds_read_b128 v[28:31], v11 offset:16384
v_mfma_f32_16x16x32_bf16 v[72:75], a[52:55], v[36:39], v[72:75]
s_add_u32 m0, s46, 11904
v_mfma_f32_16x16x32_bf16 v[76:79], a[48:51], v[40:43], v[76:79]
ds_read_b128 v[32:35], v11 offset:18432
v_mfma_f32_16x16x32_bf16 v[80:83], a[52:55], v[40:43], v[80:83]
buffer_load_dwordx4 v6, s[8:11], s50 offen offset:384 lds
s_waitcnt lgkmcnt(4)
v_mfma_f32_16x16x32_bf16 v[68:71], a[56:59], v[44:47], v[68:71]
ds_read_b128 v[36:39], v10 offset:20480
v_mfma_f32_16x16x32_bf16 v[72:75], a[60:63], v[44:47], v[72:75]
s_add_u32 m0, s46, 15872
v_mfma_f32_16x16x32_bf16 v[76:79], a[56:59], v[48:51], v[76:79]
ds_read_b128 v[40:43], v10 offset:22528
v_mfma_f32_16x16x32_bf16 v[80:83], a[60:63], v[48:51], v[80:83]
buffer_load_dwordx4 v6, s[8:11], s50 offen offset:512 lds
s_waitcnt lgkmcnt(4)
v_mfma_f32_16x16x32_bf16 v[68:71], a[64:67], v[20:23], v[68:71]
ds_read_b128 v[44:47], v11 offset:20480
v_mfma_f32_16x16x32_bf16 v[72:75], a[68:71], v[20:23], v[72:75]
s_add_u32 m0, s46, 19840
v_mfma_f32_16x16x32_bf16 v[76:79], a[64:67], v[24:27], v[76:79]
ds_read_b128 v[48:51], v11 offset:22528
v_mfma_f32_16x16x32_bf16 v[80:83], a[68:71], v[24:27], v[80:83]
buffer_load_dwordx4 v6, s[8:11], s50 offen offset:640 lds
s_waitcnt lgkmcnt(4)
v_mfma_f32_16x16x32_bf16 v[68:71], a[72:75], v[28:31], v[68:71]
ds_read_b128 v[20:23], v10 offset:24576
v_mfma_f32_16x16x32_bf16 v[72:75], a[76:79], v[28:31], v[72:75]
s_add_u32 m0, s46, 23808
v_mfma_f32_16x16x32_bf16 v[76:79], a[72:75], v[32:35], v[76:79]
ds_read_b128 v[24:27], v10 offset:26624
v_mfma_f32_16x16x32_bf16 v[80:83], a[76:79], v[32:35], v[80:83]
buffer_load_dwordx4 v6, s[8:11], s50 offen offset:768 lds
s_waitcnt lgkmcnt(4)
v_mfma_f32_16x16x32_bf16 v[68:71], a[80:83], v[36:39], v[68:71]
ds_read_b128 v[28:31], v11 offset:24576
v_mfma_f32_16x16x32_bf16 v[72:75], a[84:87], v[36:39], v[72:75]
s_add_u32 m0, s46, 27776
v_mfma_f32_16x16x32_bf16 v[76:79], a[80:83], v[40:43], v[76:79]
ds_read_b128 v[32:35], v11 offset:26624
v_mfma_f32_16x16x32_bf16 v[80:83], a[84:87], v[40:43], v[80:83]
buffer_load_dwordx4 v6, s[8:11], s50 offen offset:896 lds
s_waitcnt lgkmcnt(4)
v_mfma_f32_16x16x32_bf16 v[68:71], a[88:91], v[44:47], v[68:71]
ds_read_b128 v[36:39], v10 offset:28672
v_mfma_f32_16x16x32_bf16 v[72:75], a[92:95], v[44:47], v[72:75]
s_add_u32 m0, s46, 31744
v_mfma_f32_16x16x32_bf16 v[76:79], a[88:91], v[48:51], v[76:79]
ds_read_b128 v[40:43], v10 offset:30720
v_mfma_f32_16x16x32_bf16 v[80:83], a[92:95], v[48:51], v[80:83]
buffer_load_dwordx4 v6, s[8:11], s50 offen offset:1024 lds
s_waitcnt lgkmcnt(4)
v_mfma_f32_16x16x32_bf16 v[68:71], a[96:99], v[20:23], v[68:71]
ds_read_b128 v[44:47], v11 offset:28672
v_mfma_f32_16x16x32_bf16 v[72:75], a[100:103], v[20:23], v[72:75]
s_add_u32 m0, s46, 35712
v_mfma_f32_16x16x32_bf16 v[76:79], a[96:99], v[24:27], v[76:79]
ds_read_b128 v[48:51], v11 offset:30720
v_mfma_f32_16x16x32_bf16 v[80:83], a[100:103], v[24:27], v[80:83]
buffer_load_dwordx4 v6, s[8:11], s50 offen offset:1152 lds
s_waitcnt lgkmcnt(4)
v_mfma_f32_16x16x32_bf16 v[68:71], a[104:107], v[28:31], v[68:71]
ds_read_b128 v[20:23], v10 offset:32768
v_mfma_f32_16x16x32_bf16 v[72:75], a[108:111], v[28:31], v[72:75]
s_add_u32 m0, s46, 39680
v_mfma_f32_16x16x32_bf16 v[76:79], a[104:107], v[32:35], v[76:79]
ds_read_b128 v[24:27], v10 offset:34816
v_mfma_f32_16x16x32_bf16 v[80:83], a[108:111], v[32:35], v[80:83]
buffer_load_dwordx4 v6, s[8:11], s50 offen offset:1280 lds
s_waitcnt lgkmcnt(4)
v_mfma_f32_16x16x32_bf16 v[68:71], a[112:115], v[36:39], v[68:71]
ds_read_b128 v[28:31], v11 offset:32768
v_mfma_f32_16x16x32_bf16 v[72:75], a[116:119], v[36:39], v[72:75]
s_add_u32 m0, s46, 43648
v_mfma_f32_16x16x32_bf16 v[76:79], a[112:115], v[40:43], v[76:79]
ds_read_b128 v[32:35], v11 offset:34816
v_mfma_f32_16x16x32_bf16 v[80:83], a[116:119], v[40:43], v[80:83]
buffer_load_dwordx4 v6, s[8:11], s50 offen offset:1408 lds
s_waitcnt lgkmcnt(4)
v_mfma_f32_16x16x32_bf16 v[68:71], a[120:123], v[44:47], v[68:71]
ds_read_b128 v[36:39], v10 offset:36864
v_mfma_f32_16x16x32_bf16 v[72:75], a[124:127], v[44:47], v[72:75]
s_add_u32 m0, s46, 47616
v_mfma_f32_16x16x32_bf16 v[76:79], a[120:123], v[48:51], v[76:79]
ds_read_b128 v[40:43], v10 offset:38912
v_mfma_f32_16x16x32_bf16 v[80:83], a[124:127], v[48:51], v[80:83]
buffer_load_dwordx4 v6, s[8:11], s50 offen offset:1536 lds
s_waitcnt lgkmcnt(4)
v_mfma_f32_16x16x32_bf16 v[68:71], a[128:131], v[20:23], v[68:71]
ds_read_b128 v[44:47], v11 offset:36864
v_mfma_f32_16x16x32_bf16 v[72:75], a[132:135], v[20:23], v[72:75]
s_add_u32 m0, s46, 51584
v_mfma_f32_16x16x32_bf16 v[76:79], a[128:131], v[24:27], v[76:79]
ds_read_b128 v[48:51], v11 offset:38912
v_mfma_f32_16x16x32_bf16 v[80:83], a[132:135], v[24:27], v[80:83]
buffer_load_dwordx4 v6, s[8:11], s50 offen offset:1664 lds
s_waitcnt lgkmcnt(4)
v_mfma_f32_16x16x32_bf16 v[68:71], a[136:139], v[28:31], v[68:71]
ds_read_b128 v[20:23], v10 offset:40960
v_mfma_f32_16x16x32_bf16 v[72:75], a[140:143], v[28:31], v[72:75]
s_add_u32 m0, s46, 55552
v_mfma_f32_16x16x32_bf16 v[76:79], a[136:139], v[32:35], v[76:79]
ds_read_b128 v[24:27], v10 offset:43008
v_mfma_f32_16x16x32_bf16 v[80:83], a[140:143], v[32:35], v[80:83]
buffer_load_dwordx4 v6, s[8:11], s50 offen offset:1792 lds
s_waitcnt lgkmcnt(4)
v_mfma_f32_16x16x32_bf16 v[68:71], a[144:147], v[36:39], v[68:71]
ds_read_b128 v[28:31], v11 offset:40960
v_mfma_f32_16x16x32_bf16 v[72:75], a[148:151], v[36:39], v[72:75]
s_add_u32 m0, s46, 59520
v_mfma_f32_16x16x32_bf16 v[76:79], a[144:147], v[40:43], v[76:79]
ds_read_b128 v[32:35], v11 offset:43008
v_mfma_f32_16x16x32_bf16 v[80:83], a[148:151], v[40:43], v[80:83]
buffer_load_dwordx4 v6, s[8:11], s50 offen offset:1920 lds
s_waitcnt lgkmcnt(4)
v_mfma_f32_16x16x32_bf16 v[68:71], a[152:155], v[44:47], v[68:71]
ds_read_b128 v[36:39], v10 offset:45056
v_mfma_f32_16x16x32_bf16 v[72:75], a[156:159], v[44:47], v[72:75]
v_mfma_f32_16x16x32_bf16 v[76:79], a[152:155], v[48:51], v[76:79]
ds_read_b128 v[40:43], v10 offset:47104
v_mfma_f32_16x16x32_bf16 v[80:83], a[156:159], v[48:51], v[80:83]
s_waitcnt lgkmcnt(4)
v_mfma_f32_16x16x32_bf16 v[68:71], a[160:163], v[20:23], v[68:71]
ds_read_b128 v[44:47], v11 offset:45056
v_mfma_f32_16x16x32_bf16 v[72:75], a[164:167], v[20:23], v[72:75]
v_mfma_f32_16x16x32_bf16 v[76:79], a[160:163], v[24:27], v[76:79]
ds_read_b128 v[48:51], v11 offset:47104
v_mfma_f32_16x16x32_bf16 v[80:83], a[164:167], v[24:27], v[80:83]
s_waitcnt lgkmcnt(4)
v_mfma_f32_16x16x32_bf16 v[68:71], a[168:171], v[28:31], v[68:71]
ds_read_b128 v[20:23], v10 offset:49152
v_mfma_f32_16x16x32_bf16 v[72:75], a[172:175], v[28:31], v[72:75]
s_waitcnt vmcnt(16)
v_mov_b32 v17, s42
s_mov_b64 exec, 1
buffer_store_dword v17, v16, s[84:87], s49 offen sc1
s_mov_b64 exec, -1
v_mfma_f32_16x16x32_bf16 v[76:79], a[168:171], v[32:35], v[76:79]
ds_read_b128 v[24:27], v10 offset:51200
v_mfma_f32_16x16x32_bf16 v[80:83], a[172:175], v[32:35], v[80:83]
s_waitcnt lgkmcnt(4)
v_mfma_f32_16x16x32_bf16 v[68:71], a[176:179], v[36:39], v[68:71]
ds_read_b128 v[28:31], v11 offset:49152
v_mfma_f32_16x16x32_bf16 v[72:75], a[180:183], v[36:39], v[72:75]
s_add_u32 s53, s42, 3
s_min_u32 s53, s53, 63
s_lshl_b32 s53, s53, 16
s_mov_b64 exec, 0xffff
buffer_load_dword v18, v19, s[8:11], s53 offen
s_mov_b64 exec, -1
v_mfma_f32_16x16x32_bf16 v[76:79], a[176:179], v[40:43], v[76:79]
ds_read_b128 v[32:35], v11 offset:51200
v_mfma_f32_16x16x32_bf16 v[80:83], a[180:183], v[40:43], v[80:83]
s_waitcnt lgkmcnt(4)
v_mfma_f32_16x16x32_bf16 v[68:71], a[184:187], v[44:47], v[68:71]
ds_read_b128 v[36:39], v10 offset:53248
v_mfma_f32_16x16x32_bf16 v[72:75], a[188:191], v[44:47], v[72:75]
v_mfma_f32_16x16x32_bf16 v[76:79], a[184:187], v[48:51], v[76:79]
ds_read_b128 v[40:43], v10 offset:55296
v_mfma_f32_16x16x32_bf16 v[80:83], a[188:191], v[48:51], v[80:83]
s_waitcnt lgkmcnt(4)
v_mfma_f32_16x16x32_bf16 v[68:71], a[192:195], v[20:23], v[68:71]
ds_read_b128 v[44:47], v11 offset:53248
v_mfma_f32_16x16x32_bf16 v[72:75], a[196:199], v[20:23], v[72:75]
v_mfma_f32_16x16x32_bf16 v[76:79], a[192:195], v[24:27], v[76:79]
ds_read_b128 v[48:51], v11 offset:55296
v_mfma_f32_16x16x32_bf16 v[80:83], a[196:199], v[24:27], v[80:83]
s_waitcnt lgkmcnt(4)
v_mfma_f32_16x16x32_bf16 v[68:71], a[200:203], v[28:31], v[68:71]
ds_read_b128 v[20:23], v10 offset:57344
v_mfma_f32_16x16x32_bf16 v[72:75], a[204:207], v[28:31], v[72:75]
v_mfma_f32_16x16x32_bf16 v[76:79], a[200:203], v[32:35], v[76:79]
ds_read_b128 v[24:27], v10 offset:59392
v_mfma_f32_16x16x32_bf16 v[80:83], a[204:207], v[32:35], v[80:83]
s_waitcnt lgkmcnt(4)
v_mfma_f32_16x16x32_bf16 v[68:71], a[208:211], v[36:39], v[68:71]
ds_read_b128 v[28:31], v11 offset:57344
v_mfma_f32_16x16x32_bf16 v[72:75], a[212:215], v[36:39], v[72:75]
v_mfma_f32_16x16x32_bf16 v[76:79], a[208:211], v[40:43], v[76:79]
ds_read_b128 v[32:35], v11 offset:59392
v_mfma_f32_16x16x32_bf16 v[80:83], a[212:215], v[40:43], v[80:83]
s_waitcnt lgkmcnt(4)
v_mfma_f32_16x16x32_bf16 v[68:71], a[216:219], v[44:47], v[68:71]
ds_read_b128 v[36:39], v10 offset:61440
v_mfma_f32_16x16x32_bf16 v[72:75], a[220:223], v[44:47], v[72:75]
v_mfma_f32_16x16x32_bf16 v[76:79], a[216:219], v[48:51], v[76:79]
ds_read_b128 v[40:43], v10 offset:63488
v_mfma_f32_16x16x32_bf16 v[80:83], a[220:223], v[48:51], v[80:83]
s_waitcnt lgkmcnt(4)
v_mfma_f32_16x16x32_bf16 v[68:71], a[224:227], v[20:23], v[68:71]
ds_read_b128 v[44:47], v11 offset:61440
v_mfma_f32_16x16x32_bf16 v[72:75], a[228:231], v[20:23], v[72:75]
v_mfma_f32_16x16x32_bf16 v[76:79], a[224:227], v[24:27], v[76:79]
ds_read_b128 v[48:51], v11 offset:63488
v_mfma_f32_16x16x32_bf16 v[80:83], a[228:231], v[24:27], v[80:83]
s_waitcnt lgkmcnt(5)
v_mfma_f32_16x16x32_bf16 v[68:71], a[232:235], v[28:31], v[68:71]
v_mfma_f32_16x16x32_bf16 v[72:75], a[236:239], v[28:31], v[72:75]
s_waitcnt lgkmcnt(4)
v_mfma_f32_16x16x32_bf16 v[76:79], a[232:235], v[32:35], v[76:79]
v_mfma_f32_16x16x32_bf16 v[80:83], a[236:239], v[32:35], v[80:83]
s_waitcnt lgkmcnt(3)
v_mfma_f32_16x16x32_bf16 v[68:71], a[240:243], v[36:39], v[68:71]
v_mfma_f32_16x16x32_bf16 v[72:75], a[244:247], v[36:39], v[72:75]
s_waitcnt lgkmcnt(2)
v_mfma_f32_16x16x32_bf16 v[76:79], a[240:243], v[40:43], v[76:79]
v_mfma_f32_16x16x32_bf16 v[80:83], a[244:247], v[40:43], v[80:83]
s_waitcnt lgkmcnt(1)
v_mfma_f32_16x16x32_bf16 v[68:71], a[248:251], v[44:47], v[68:71]
v_mfma_f32_16x16x32_bf16 v[72:75], a[252:255], v[44:47], v[72:75]
s_waitcnt lgkmcnt(0)
v_mfma_f32_16x16x32_bf16 v[76:79], a[248:251], v[48:51], v[76:79]
v_mfma_f32_16x16x32_bf16 v[80:83], a[252:255], v[48:51], v[80:83]
s_add_u32 s42, s42, 1
s_cmp_eq_u32 s42, 64
s_cbranch_scc1 mega_kernel_k_fin
s_waitcnt vmcnt(2)
s_barrier
s_add_u32 s50, s42, 1
s_min_u32 s50, s50, 63
s_lshl_b32 s50, s50, 16
ds_read_b128 v[20:23], v8 offset:0
ds_read_b128 v[24:27], v8 offset:2048
ds_read_b128 v[28:31], v9 offset:0
ds_read_b128 v[32:35], v9 offset:2048
ds_read_b128 v[36:39], v8 offset:4096
ds_read_b128 v[40:43], v8 offset:6144
s_waitcnt lgkmcnt(4)
v_mfma_f32_16x16x32_bf16 v[52:55], a[0:3], v[20:23], 0
ds_read_b128 v[44:47], v9 offset:4096
v_mfma_f32_16x16x32_bf16 v[56:59], a[4:7], v[20:23], 0
v_cvt_pk_bf16_f32 v84, v68, v69
v_cvt_pk_bf16_f32 v85, v70, v71
v_cvt_pk_bf16_f32 v86, v72, v73
v_mfma_f32_16x16x32_bf16 v[60:63], a[0:3], v[24:27], 0
ds_read_b128 v[48:51], v9 offset:6144
v_mfma_f32_16x16x32_bf16 v[64:67], a[4:7], v[24:27], 0
v_cvt_pk_bf16_f32 v87, v74, v75
v_cvt_pk_bf16_f32 v88, v76, v77
v_cvt_pk_bf16_f32 v89, v78, v79
s_waitcnt lgkmcnt(4)
v_mfma_f32_16x16x32_bf16 v[52:55], a[8:11], v[28:31], v[52:55]
ds_read_b128 v[20:23], v8 offset:8192
v_mfma_f32_16x16x32_bf16 v[56:59], a[12:15], v[28:31], v[56:59]
v_cvt_pk_bf16_f32 v90, v80, v81
v_cvt_pk_bf16_f32 v91, v82, v83
v_mfma_f32_16x16x32_bf16 v[60:63], a[8:11], v[32:35], v[60:63]
ds_read_b128 v[24:27], v8 offset:10240
v_mfma_f32_16x16x32_bf16 v[64:67], a[12:15], v[32:35], v[64:67]
s_add_u32 s51, s42, s47
s_sub_u32 s51, s51, 1
s_bfe_u32 s52, s51, 0x40002
s_lshl_b32 s52, s52, 14
s_waitcnt lgkmcnt(4)
v_mfma_f32_16x16x32_bf16 v[52:55], a[16:19], v[36:39], v[52:55]
ds_read_b128 v[28:31], v9 offset:8192
v_mfma_f32_16x16x32_bf16 v[56:59], a[20:23], v[36:39], v[56:59]
s_and_b32 s51, s51, 3
s_lshl_b32 s51, s51, 11
s_add_u32 s51, s51, s52
s_add_u32 s51, s51, s48
buffer_store_dwordx4 v[84:87], v7, s[84:87], s51 offen sc1
v_mfma_f32_16x16x32_bf16 v[60:63], a[16:19], v[40:43], v[60:63]
ds_read_b128 v[32:35], v9 offset:10240
v_mfma_f32_16x16x32_bf16 v[64:67], a[20:23], v[40:43], v[64:67]
buffer_store_dwordx4 v[88:91], v7, s[84:87], s51 offen offset:1024 sc1
s_waitcnt lgkmcnt(4)
v_mfma_f32_16x16x32_bf16 v[52:55], a[24:27], v[44:47], v[52:55]
ds_read_b128 v[36:39], v8 offset:12288
v_mfma_f32_16x16x32_bf16 v[56:59], a[28:31], v[44:47], v[56:59]
s_add_u32 m0, s46, 65536
v_mfma_f32_16x16x32_bf16 v[60:63], a[24:27], v[48:51], v[60:63]
ds_read_b128 v[40:43], v8 offset:14336
v_mfma_f32_16x16x32_bf16 v[64:67], a[28:31], v[48:51], v[64:67]
buffer_load_dwordx4 v6, s[8:11], s50 offen offset:0 lds
s_waitcnt lgkmcnt(4)
v_mfma_f32_16x16x32_bf16 v[52:55], a[32:35], v[20:23], v[52:55]
ds_read_b128 v[44:47], v9 offset:12288
v_mfma_f32_16x16x32_bf16 v[56:59], a[36:39], v[20:23], v[56:59]
s_add_u32 m0, s46, 69504
v_mfma_f32_16x16x32_bf16 v[60:63], a[32:35], v[24:27], v[60:63]
ds_read_b128 v[48:51], v9 offset:14336
v_mfma_f32_16x16x32_bf16 v[64:67], a[36:39], v[24:27], v[64:67]
buffer_load_dwordx4 v6, s[8:11], s50 offen offset:128 lds
s_waitcnt lgkmcnt(4)
v_mfma_f32_16x16x32_bf16 v[52:55], a[40:43], v[28:31], v[52:55]
ds_read_b128 v[20:23], v8 offset:16384
v_mfma_f32_16x16x32_bf16 v[56:59], a[44:47], v[28:31], v[56:59]
s_add_u32 m0, s46, 73472
v_mfma_f32_16x16x32_bf16 v[60:63], a[40:43], v[32:35], v[60:63]
ds_read_b128 v[24:27], v8 offset:18432
v_mfma_f32_16x16x32_bf16 v[64:67], a[44:47], v[32:35], v[64:67]
buffer_load_dwordx4 v6, s[8:11], s50 offen offset:256 lds
s_waitcnt lgkmcnt(4)
v_mfma_f32_16x16x32_bf16 v[52:55], a[48:51], v[36:39], v[52:55]
ds_read_b128 v[28:31], v9 offset:16384
v_mfma_f32_16x16x32_bf16 v[56:59], a[52:55], v[36:39], v[56:59]
s_add_u32 m0, s46, 77440
v_mfma_f32_16x16x32_bf16 v[60:63], a[48:51], v[40:43], v[60:63]
ds_read_b128 v[32:35], v9 offset:18432
v_mfma_f32_16x16x32_bf16 v[64:67], a[52:55], v[40:43], v[64:67]
buffer_load_dwordx4 v6, s[8:11], s50 offen offset:384 lds
s_waitcnt lgkmcnt(4)
v_mfma_f32_16x16x32_bf16 v[52:55], a[56:59], v[44:47], v[52:55]
ds_read_b128 v[36:39], v8 offset:20480
v_mfma_f32_16x16x32_bf16 v[56:59], a[60:63], v[44:47], v[56:59]
s_add_u32 m0, s46, 81408
v_mfma_f32_16x16x32_bf16 v[60:63], a[56:59], v[48:51], v[60:63]
ds_read_b128 v[40:43], v8 offset:22528
v_mfma_f32_16x16x32_bf16 v[64:67], a[60:63], v[48:51], v[64:67]
buffer_load_dwordx4 v6, s[8:11], s50 offen offset:512 lds
s_waitcnt lgkmcnt(4)
v_mfma_f32_16x16x32_bf16 v[52:55], a[64:67], v[20:23], v[52:55]
ds_read_b128 v[44:47], v9 offset:20480
v_mfma_f32_16x16x32_bf16 v[56:59], a[68:71], v[20:23], v[56:59]
s_add_u32 m0, s46, 85376
v_mfma_f32_16x16x32_bf16 v[60:63], a[64:67], v[24:27], v[60:63]
ds_read_b128 v[48:51], v9 offset:22528
v_mfma_f32_16x16x32_bf16 v[64:67], a[68:71], v[24:27], v[64:67]
buffer_load_dwordx4 v6, s[8:11], s50 offen offset:640 lds
s_waitcnt lgkmcnt(4)
v_mfma_f32_16x16x32_bf16 v[52:55], a[72:75], v[28:31], v[52:55]
ds_read_b128 v[20:23], v8 offset:24576
v_mfma_f32_16x16x32_bf16 v[56:59], a[76:79], v[28:31], v[56:59]
s_add_u32 m0, s46, 89344
v_mfma_f32_16x16x32_bf16 v[60:63], a[72:75], v[32:35], v[60:63]
ds_read_b128 v[24:27], v8 offset:26624
v_mfma_f32_16x16x32_bf16 v[64:67], a[76:79], v[32:35], v[64:67]
buffer_load_dwordx4 v6, s[8:11], s50 offen offset:768 lds
s_waitcnt lgkmcnt(4)
v_mfma_f32_16x16x32_bf16 v[52:55], a[80:83], v[36:39], v[52:55]
ds_read_b128 v[28:31], v9 offset:24576
v_mfma_f32_16x16x32_bf16 v[56:59], a[84:87], v[36:39], v[56:59]
s_add_u32 m0, s46, 93312
v_mfma_f32_16x16x32_bf16 v[60:63], a[80:83], v[40:43], v[60:63]
ds_read_b128 v[32:35], v9 offset:26624
v_mfma_f32_16x16x32_bf16 v[64:67], a[84:87], v[40:43], v[64:67]
buffer_load_dwordx4 v6, s[8:11], s50 offen offset:896 lds
s_waitcnt lgkmcnt(4)
v_mfma_f32_16x16x32_bf16 v[52:55], a[88:91], v[44:47], v[52:55]
ds_read_b128 v[36:39], v8 offset:28672
v_mfma_f32_16x16x32_bf16 v[56:59], a[92:95], v[44:47], v[56:59]
s_add_u32 m0, s46, 97280
v_mfma_f32_16x16x32_bf16 v[60:63], a[88:91], v[48:51], v[60:63]
ds_read_b128 v[40:43], v8 offset:30720
v_mfma_f32_16x16x32_bf16 v[64:67], a[92:95], v[48:51], v[64:67]
buffer_load_dwordx4 v6, s[8:11], s50 offen offset:1024 lds
s_waitcnt lgkmcnt(4)
v_mfma_f32_16x16x32_bf16 v[52:55], a[96:99], v[20:23], v[52:55]
ds_read_b128 v[44:47], v9 offset:28672
v_mfma_f32_16x16x32_bf16 v[56:59], a[100:103], v[20:23], v[56:59]
s_add_u32 m0, s46, 101248
v_mfma_f32_16x16x32_bf16 v[60:63], a[96:99], v[24:27], v[60:63]
ds_read_b128 v[48:51], v9 offset:30720
v_mfma_f32_16x16x32_bf16 v[64:67], a[100:103], v[24:27], v[64:67]
buffer_load_dwordx4 v6, s[8:11], s50 offen offset:1152 lds
s_waitcnt lgkmcnt(4)
v_mfma_f32_16x16x32_bf16 v[52:55], a[104:107], v[28:31], v[52:55]
ds_read_b128 v[20:23], v8 offset:32768
v_mfma_f32_16x16x32_bf16 v[56:59], a[108:111], v[28:31], v[56:59]
s_add_u32 m0, s46, 105216
v_mfma_f32_16x16x32_bf16 v[60:63], a[104:107], v[32:35], v[60:63]
ds_read_b128 v[24:27], v8 offset:34816
v_mfma_f32_16x16x32_bf16 v[64:67], a[108:111], v[32:35], v[64:67]
buffer_load_dwordx4 v6, s[8:11], s50 offen offset:1280 lds
s_waitcnt lgkmcnt(4)
v_mfma_f32_16x16x32_bf16 v[52:55], a[112:115], v[36:39], v[52:55]
ds_read_b128 v[28:31], v9 offset:32768
v_mfma_f32_16x16x32_bf16 v[56:59], a[116:119], v[36:39], v[56:59]
s_add_u32 m0, s46, 109184
v_mfma_f32_16x16x32_bf16 v[60:63], a[112:115], v[40:43], v[60:63]
ds_read_b128 v[32:35], v9 offset:34816
v_mfma_f32_16x16x32_bf16 v[64:67], a[116:119], v[40:43], v[64:67]
buffer_load_dwordx4 v6, s[8:11], s50 offen offset:1408 lds
s_waitcnt lgkmcnt(4)
v_mfma_f32_16x16x32_bf16 v[52:55], a[120:123], v[44:47], v[52:55]
ds_read_b128 v[36:39], v8 offset:36864
v_mfma_f32_16x16x32_bf16 v[56:59], a[124:127], v[44:47], v[56:59]
s_add_u32 m0, s46, 113152
v_mfma_f32_16x16x32_bf16 v[60:63], a[120:123], v[48:51], v[60:63]
ds_read_b128 v[40:43], v8 offset:38912
v_mfma_f32_16x16x32_bf16 v[64:67], a[124:127], v[48:51], v[64:67]
buffer_load_dwordx4 v6, s[8:11], s50 offen offset:1536 lds
s_waitcnt lgkmcnt(4)
v_mfma_f32_16x16x32_bf16 v[52:55], a[128:131], v[20:23], v[52:55]
ds_read_b128 v[44:47], v9 offset:36864
v_mfma_f32_16x16x32_bf16 v[56:59], a[132:135], v[20:23], v[56:59]
s_add_u32 m0, s46, 117120
v_mfma_f32_16x16x32_bf16 v[60:63], a[128:131], v[24:27], v[60:63]
ds_read_b128 v[48:51], v9 offset:38912
v_mfma_f32_16x16x32_bf16 v[64:67], a[132:135], v[24:27], v[64:67]
buffer_load_dwordx4 v6, s[8:11], s50 offen offset:1664 lds
s_waitcnt lgkmcnt(4)
v_mfma_f32_16x16x32_bf16 v[52:55], a[136:139], v[28:31], v[52:55]
ds_read_b128 v[20:23], v8 offset:40960
v_mfma_f32_16x16x32_bf16 v[56:59], a[140:143], v[28:31], v[56:59]
s_add_u32 m0, s46, 121088
v_mfma_f32_16x16x32_bf16 v[60:63], a[136:139], v[32:35], v[60:63]
ds_read_b128 v[24:27], v8 offset:43008
v_mfma_f32_16x16x32_bf16 v[64:67], a[140:143], v[32:35], v[64:67]
buffer_load_dwordx4 v6, s[8:11], s50 offen offset:1792 lds
s_waitcnt lgkmcnt(4)
v_mfma_f32_16x16x32_bf16 v[52:55], a[144:147], v[36:39], v[52:55]
ds_read_b128 v[28:31], v9 offset:40960
v_mfma_f32_16x16x32_bf16 v[56:59], a[148:151], v[36:39], v[56:59]
s_add_u32 m0, s46, 125056
v_mfma_f32_16x16x32_bf16 v[60:63], a[144:147], v[40:43], v[60:63]
ds_read_b128 v[32:35], v9 offset:43008
v_mfma_f32_16x16x32_bf16 v[64:67], a[148:151], v[40:43], v[64:67]
buffer_load_dwordx4 v6, s[8:11], s50 offen offset:1920 lds
s_waitcnt lgkmcnt(4)
v_mfma_f32_16x16x32_bf16 v[52:55], a[152:155], v[44:47], v[52:55]
ds_read_b128 v[36:39], v8 offset:45056
v_mfma_f32_16x16x32_bf16 v[56:59], a[156:159], v[44:47], v[56:59]
v_mfma_f32_16x16x32_bf16 v[60:63], a[152:155], v[48:51], v[60:63]
ds_read_b128 v[40:43], v8 offset:47104
v_mfma_f32_16x16x32_bf16 v[64:67], a[156:159], v[48:51], v[64:67]
s_waitcnt lgkmcnt(4)
v_mfma_f32_16x16x32_bf16 v[52:55], a[160:163], v[20:23], v[52:55]
ds_read_b128 v[44:47], v9 offset:45056
v_mfma_f32_16x16x32_bf16 v[56:59], a[164:167], v[20:23], v[56:59]
v_mfma_f32_16x16x32_bf16 v[60:63], a[160:163], v[24:27], v[60:63]
ds_read_b128 v[48:51], v9 offset:47104
v_mfma_f32_16x16x32_bf16 v[64:67], a[164:167], v[24:27], v[64:67]
s_waitcnt lgkmcnt(4)
v_mfma_f32_16x16x32_bf16 v[52:55], a[168:171], v[28:31], v[52:55]
ds_read_b128 v[20:23], v8 offset:49152
v_mfma_f32_16x16x32_bf16 v[56:59], a[172:175], v[28:31], v[56:59]
s_waitcnt vmcnt(16)
v_mov_b32 v17, s42
s_mov_b64 exec, 1
buffer_store_dword v17, v16, s[84:87], s49 offen sc1
s_mov_b64 exec, -1
v_mfma_f32_16x16x32_bf16 v[60:63], a[168:171], v[32:35], v[60:63]
ds_read_b128 v[24:27], v8 offset:51200
v_mfma_f32_16x16x32_bf16 v[64:67], a[172:175], v[32:35], v[64:67]
s_waitcnt lgkmcnt(4)
v_mfma_f32_16x16x32_bf16 v[52:55], a[176:179], v[36:39], v[52:55]
ds_read_b128 v[28:31], v9 offset:49152
v_mfma_f32_16x16x32_bf16 v[56:59], a[180:183], v[36:39], v[56:59]
s_add_u32 s53, s42, 3
s_min_u32 s53, s53, 63
s_lshl_b32 s53, s53, 16
s_mov_b64 exec, 0xffff
buffer_load_dword v18, v19, s[8:11], s53 offen
s_mov_b64 exec, -1
v_mfma_f32_16x16x32_bf16 v[60:63], a[176:179], v[40:43], v[60:63]
ds_read_b128 v[32:35], v9 offset:51200
v_mfma_f32_16x16x32_bf16 v[64:67], a[180:183], v[40:43], v[64:67]
s_waitcnt lgkmcnt(4)
v_mfma_f32_16x16x32_bf16 v[52:55], a[184:187], v[44:47], v[52:55]
ds_read_b128 v[36:39], v8 offset:53248
v_mfma_f32_16x16x32_bf16 v[56:59], a[188:191], v[44:47], v[56:59]
v_mfma_f32_16x16x32_bf16 v[60:63], a[184:187], v[48:51], v[60:63]
ds_read_b128 v[40:43], v8 offset:55296
v_mfma_f32_16x16x32_bf16 v[64:67], a[188:191], v[48:51], v[64:67]
s_waitcnt lgkmcnt(4)
v_mfma_f32_16x16x32_bf16 v[52:55], a[192:195], v[20:23], v[52:55]
ds_read_b128 v[44:47], v9 offset:53248
v_mfma_f32_16x16x32_bf16 v[56:59], a[196:199], v[20:23], v[56:59]
v_mfma_f32_16x16x32_bf16 v[60:63], a[192:195], v[24:27], v[60:63]
ds_read_b128 v[48:51], v9 offset:55296
v_mfma_f32_16x16x32_bf16 v[64:67], a[196:199], v[24:27], v[64:67]
s_waitcnt lgkmcnt(4)
v_mfma_f32_16x16x32_bf16 v[52:55], a[200:203], v[28:31], v[52:55]
ds_read_b128 v[20:23], v8 offset:57344
v_mfma_f32_16x16x32_bf16 v[56:59], a[204:207], v[28:31], v[56:59]
v_mfma_f32_16x16x32_bf16 v[60:63], a[200:203], v[32:35], v[60:63]
ds_read_b128 v[24:27], v8 offset:59392
v_mfma_f32_16x16x32_bf16 v[64:67], a[204:207], v[32:35], v[64:67]
s_waitcnt lgkmcnt(4)
v_mfma_f32_16x16x32_bf16 v[52:55], a[208:211], v[36:39], v[52:55]
ds_read_b128 v[28:31], v9 offset:57344
v_mfma_f32_16x16x32_bf16 v[56:59], a[212:215], v[36:39], v[56:59]
v_mfma_f32_16x16x32_bf16 v[60:63], a[208:211], v[40:43], v[60:63]
ds_read_b128 v[32:35], v9 offset:59392
v_mfma_f32_16x16x32_bf16 v[64:67], a[212:215], v[40:43], v[64:67]
s_waitcnt lgkmcnt(4)
v_mfma_f32_16x16x32_bf16 v[52:55], a[216:219], v[44:47], v[52:55]
ds_read_b128 v[36:39], v8 offset:61440
v_mfma_f32_16x16x32_bf16 v[56:59], a[220:223], v[44:47], v[56:59]
v_mfma_f32_16x16x32_bf16 v[60:63], a[216:219], v[48:51], v[60:63]
ds_read_b128 v[40:43], v8 offset:63488
v_mfma_f32_16x16x32_bf16 v[64:67], a[220:223], v[48:51], v[64:67]
s_waitcnt lgkmcnt(4)
v_mfma_f32_16x16x32_bf16 v[52:55], a[224:227], v[20:23], v[52:55]
ds_read_b128 v[44:47], v9 offset:61440
v_mfma_f32_16x16x32_bf16 v[56:59], a[228:231], v[20:23], v[56:59]
v_mfma_f32_16x16x32_bf16 v[60:63], a[224:227], v[24:27], v[60:63]
ds_read_b128 v[48:51], v9 offset:63488
v_mfma_f32_16x16x32_bf16 v[64:67], a[228:231], v[24:27], v[64:67]
s_waitcnt lgkmcnt(5)
v_mfma_f32_16x16x32_bf16 v[52:55], a[232:235], v[28:31], v[52:55]
v_mfma_f32_16x16x32_bf16 v[56:59], a[236:239], v[28:31], v[56:59]
s_waitcnt lgkmcnt(4)
v_mfma_f32_16x16x32_bf16 v[60:63], a[232:235], v[32:35], v[60:63]
v_mfma_f32_16x16x32_bf16 v[64:67], a[236:239], v[32:35], v[64:67]
s_waitcnt lgkmcnt(3)
v_mfma_f32_16x16x32_bf16 v[52:55], a[240:243], v[36:39], v[52:55]
v_mfma_f32_16x16x32_bf16 v[56:59], a[244:247], v[36:39], v[56:59]
s_waitcnt lgkmcnt(2)
v_mfma_f32_16x16x32_bf16 v[60:63], a[240:243], v[40:43], v[60:63]
v_mfma_f32_16x16x32_bf16 v[64:67], a[244:247], v[40:43], v[64:67]
s_waitcnt lgkmcnt(1)
v_mfma_f32_16x16x32_bf16 v[52:55], a[248:251], v[44:47], v[52:55]
v_mfma_f32_16x16x32_bf16 v[56:59], a[252:255], v[44:47], v[56:59]
s_waitcnt lgkmcnt(0)
v_mfma_f32_16x16x32_bf16 v[60:63], a[248:251], v[48:51], v[60:63]
v_mfma_f32_16x16x32_bf16 v[64:67], a[252:255], v[48:51], v[64:67]
s_add_u32 s42, s42, 1
s_branch mega_kernel_k_loop
mega_kernel_k_fin:
s_nop 11
v_cvt_pk_bf16_f32 v84, v68, v69
v_cvt_pk_bf16_f32 v85, v70, v71
v_cvt_pk_bf16_f32 v86, v72, v73
v_cvt_pk_bf16_f32 v87, v74, v75
v_cvt_pk_bf16_f32 v88, v76, v77
v_cvt_pk_bf16_f32 v89, v78, v79
v_cvt_pk_bf16_f32 v90, v80, v81
v_cvt_pk_bf16_f32 v91, v82, v83
s_add_u32 s51, s42, s47
s_sub_u32 s51, s51, 1
s_bfe_u32 s52, s51, 0x40002
s_lshl_b32 s52, s52, 14
s_and_b32 s51, s51, 3
s_lshl_b32 s51, s51, 11
s_add_u32 s51, s51, s52
s_add_u32 s51, s51, s48
buffer_store_dwordx4 v[84:87], v7, s[84:87], s51 offen sc1
buffer_store_dwordx4 v[88:91], v7, s[84:87], s51 offen offset:1024 sc1
s_waitcnt vmcnt(0)
v_mov_b32 v17, s42
s_mov_b64 exec, 1
buffer_store_dword v17, v16, s[84:87], s49 offen sc1
s_mov_b64 exec, -1
s_waitcnt vmcnt(0)
s_barrier
s_branch mega_kernel_fft
mega_kernel_rv:
s_load_dwordx2 s[4:5], s[0:1], 32
s_load_dwordx2 s[8:9], s[0:1], 0
v_lshrrev_b32 v2, 6, v0
v_and_b32 v1, 63, v0
v_readfirstlane_b32 s41, v2
v_lshlrev_b32 v5, 4, v1
s_waitcnt lgkmcnt(0)
s_mov_b32 s6, 8388608
s_mov_b32 s7, 0x00020000
s_mov_b32 s10, 4194304
s_mov_b32 s11, 0x00020000
s_lshl_b32 s43, s40, 8
s_lshl_b32 s44, s41, 6
s_add_u32 s48, s43, s44
s_and_b32 s43, s48, 0x7ff
v_add_u32 v19, s43, v1
v_lshlrev_b32 v19, 7, v19
buffer_load_dword v20, v19, s[8:11], 0 offen
v_lshrrev_b32 v2, 2, v1
v_and_b32 v3, 3, v1
v_lshlrev_b32 v16, 13, v2
v_lshl_add_u32 v16, v3, 4, v16
v_add_u32 v16, s48, v16
v_and_b32 v3, 3, v1
s_lshl_b32 s45, s41, 15
v_bfe_u32 v17, v1, 2, 2
v_lshrrev_b32 v18, 4, v1
v_lshl_add_u32 v17, v18, 3, v17
v_lshlrev_b32 v17, 6, v17
v_lshl_add_u32 v17, v3, 3, v17
v_add_u32 v17, s45, v17
s_add_u32 m0, s45, 0
s_mov_b32 s44, 0
buffer_load_dwordx4 v16, s[4:7], s44 offen lds
s_add_u32 m0, s45, 1024
s_mov_b32 s44, 131072
buffer_load_dwordx4 v16, s[4:7], s44 offen lds
s_add_u32 m0, s45, 2048
s_mov_b32 s44, 262144
buffer_load_dwordx4 v16, s[4:7], s44 offen lds
s_add_u32 m0, s45, 3072
s_mov_b32 s44, 393216
buffer_load_dwordx4 v16, s[4:7], s44 offen lds
s_add_u32 m0, s45, 4096
s_mov_b32 s44, 524288
buffer_load_dwordx4 v16, s[4:7], s44 offen lds
s_add_u32 m0, s45, 5120
s_mov_b32 s44, 655360
buffer_load_dwordx4 v16, s[4:7], s44 offen lds
s_add_u32 m0, s45, 6144
s_mov_b32 s44, 786432
buffer_load_dwordx4 v16, s[4:7], s44 offen lds
s_add_u32 m0, s45, 7168
s_mov_b32 s44, 917504
buffer_load_dwordx4 v16, s[4:7], s44 offen lds
s_add_u32 m0, s45, 8192
s_mov_b32 s44, 1048576
buffer_load_dwordx4 v16, s[4:7], s44 offen lds
s_add_u32 m0, s45, 9216
s_mov_b32 s44, 1179648
buffer_load_dwordx4 v16, s[4:7], s44 offen lds
s_add_u32 m0, s45, 10240
s_mov_b32 s44, 1310720
buffer_load_dwordx4 v16, s[4:7], s44 offen lds
s_add_u32 m0, s45, 11264
s_mov_b32 s44, 1441792
buffer_load_dwordx4 v16, s[4:7], s44 offen lds
s_add_u32 m0, s45, 12288
s_mov_b32 s44, 1572864
buffer_load_dwordx4 v16, s[4:7], s44 offen lds
s_add_u32 m0, s45, 13312
s_mov_b32 s44, 1703936
buffer_load_dwordx4 v16, s[4:7], s44 offen lds
s_add_u32 m0, s45, 14336
s_mov_b32 s44, 1835008
buffer_load_dwordx4 v16, s[4:7], s44 offen lds
s_add_u32 m0, s45, 15360
s_mov_b32 s44, 1966080
buffer_load_dwordx4 v16, s[4:7], s44 offen lds
s_add_u32 m0, s45, 16384
s_mov_b32 s44, 2097152
buffer_load_dwordx4 v16, s[4:7], s44 offen lds
s_add_u32 m0, s45, 17408
s_mov_b32 s44, 2228224
buffer_load_dwordx4 v16, s[4:7], s44 offen lds
s_add_u32 m0, s45, 18432
s_mov_b32 s44, 2359296
buffer_load_dwordx4 v16, s[4:7], s44 offen lds
s_add_u32 m0, s45, 19456
s_mov_b32 s44, 2490368
buffer_load_dwordx4 v16, s[4:7], s44 offen lds
s_add_u32 m0, s45, 20480
s_mov_b32 s44, 2621440
buffer_load_dwordx4 v16, s[4:7], s44 offen lds
s_add_u32 m0, s45, 21504
s_mov_b32 s44, 2752512
buffer_load_dwordx4 v16, s[4:7], s44 offen lds
s_add_u32 m0, s45, 22528
s_mov_b32 s44, 2883584
buffer_load_dwordx4 v16, s[4:7], s44 offen lds
s_add_u32 m0, s45, 23552
s_mov_b32 s44, 3014656
buffer_load_dwordx4 v16, s[4:7], s44 offen lds
s_add_u32 m0, s45, 24576
s_mov_b32 s44, 3145728
buffer_load_dwordx4 v16, s[4:7], s44 offen lds
s_add_u32 m0, s45, 25600
s_mov_b32 s44, 3276800
buffer_load_dwordx4 v16, s[4:7], s44 offen lds
s_add_u32 m0, s45, 26624
s_mov_b32 s44, 3407872
buffer_load_dwordx4 v16, s[4:7], s44 offen lds
s_add_u32 m0, s45, 27648
s_mov_b32 s44, 3538944
buffer_load_dwordx4 v16, s[4:7], s44 offen lds
s_add_u32 m0, s45, 28672
s_mov_b32 s44, 3670016
buffer_load_dwordx4 v16, s[4:7], s44 offen lds
s_add_u32 m0, s45, 29696
s_mov_b32 s44, 3801088
buffer_load_dwordx4 v16, s[4:7], s44 offen lds
s_add_u32 m0, s45, 30720
s_mov_b32 s44, 3932160
buffer_load_dwordx4 v16, s[4:7], s44 offen lds
s_add_u32 m0, s45, 31744
s_mov_b32 s44, 4063232
buffer_load_dwordx4 v16, s[4:7], s44 offen lds
s_waitcnt vmcnt(16)
ds_read_b64_tr_b16 a[0:1], v17 offset:0
ds_read_b64_tr_b16 a[2:3], v17 offset:256
ds_read_b64_tr_b16 a[4:5], v17 offset:32
ds_read_b64_tr_b16 a[6:7], v17 offset:288
ds_read_b64_tr_b16 a[8:9], v17 offset:2048
ds_read_b64_tr_b16 a[10:11], v17 offset:2304
ds_read_b64_tr_b16 a[12:13], v17 offset:2080
ds_read_b64_tr_b16 a[14:15], v17 offset:2336
s_waitcnt lgkmcnt(0)
ds_read_b64_tr_b16 a[16:17], v17 offset:4096
ds_read_b64_tr_b16 a[18:19], v17 offset:4352
ds_read_b64_tr_b16 a[20:21], v17 offset:4128
ds_read_b64_tr_b16 a[22:23], v17 offset:4384
ds_read_b64_tr_b16 a[24:25], v17 offset:6144
ds_read_b64_tr_b16 a[26:27], v17 offset:6400
ds_read_b64_tr_b16 a[28:29], v17 offset:6176
ds_read_b64_tr_b16 a[30:31], v17 offset:6432
s_waitcnt lgkmcnt(0)
ds_read_b64_tr_b16 a[32:33], v17 offset:8192
ds_read_b64_tr_b16 a[34:35], v17 offset:8448
ds_read_b64_tr_b16 a[36:37], v17 offset:8224
ds_read_b64_tr_b16 a[38:39], v17 offset:8480
ds_read_b64_tr_b16 a[40:41], v17 offset:10240
ds_read_b64_tr_b16 a[42:43], v17 offset:10496
ds_read_b64_tr_b16 a[44:45], v17 offset:10272
ds_read_b64_tr_b16 a[46:47], v17 offset:10528
s_waitcnt lgkmcnt(0)
ds_read_b64_tr_b16 a[48:49], v17 offset:12288
ds_read_b64_tr_b16 a[50:51], v17 offset:12544
ds_read_b64_tr_b16 a[52:53], v17 offset:12320
ds_read_b64_tr_b16 a[54:55], v17 offset:12576
ds_read_b64_tr_b16 a[56:57], v17 offset:14336
ds_read_b64_tr_b16 a[58:59], v17 offset:14592
ds_read_b64_tr_b16 a[60:61], v17 offset:14368
ds_read_b64_tr_b16 a[62:63], v17 offset:14624
s_waitcnt lgkmcnt(0)
s_add_u32 m0, s45, 0
s_mov_b32 s44, 4194304
buffer_load_dwordx4 v16, s[4:7], s44 offen lds
s_add_u32 m0, s45, 1024
s_mov_b32 s44, 4325376
buffer_load_dwordx4 v16, s[4:7], s44 offen lds
s_add_u32 m0, s45, 2048
s_mov_b32 s44, 4456448
buffer_load_dwordx4 v16, s[4:7], s44 offen lds
s_add_u32 m0, s45, 3072
s_mov_b32 s44, 4587520
buffer_load_dwordx4 v16, s[4:7], s44 offen lds
s_add_u32 m0, s45, 4096
s_mov_b32 s44, 4718592
buffer_load_dwordx4 v16, s[4:7], s44 offen lds
s_add_u32 m0, s45, 5120
s_mov_b32 s44, 4849664
buffer_load_dwordx4 v16, s[4:7], s44 offen lds
s_add_u32 m0, s45, 6144
s_mov_b32 s44, 4980736
buffer_load_dwordx4 v16, s[4:7], s44 offen lds
s_add_u32 m0, s45, 7168
s_mov_b32 s44, 5111808
buffer_load_dwordx4 v16, s[4:7], s44 offen lds
s_add_u32 m0, s45, 8192
s_mov_b32 s44, 5242880
buffer_load_dwordx4 v16, s[4:7], s44 offen lds
s_add_u32 m0, s45, 9216
s_mov_b32 s44, 5373952
buffer_load_dwordx4 v16, s[4:7], s44 offen lds
s_add_u32 m0, s45, 10240
s_mov_b32 s44, 5505024
buffer_load_dwordx4 v16, s[4:7], s44 offen lds
s_add_u32 m0, s45, 11264
s_mov_b32 s44, 5636096
buffer_load_dwordx4 v16, s[4:7], s44 offen lds
s_add_u32 m0, s45, 12288
s_mov_b32 s44, 5767168
buffer_load_dwordx4 v16, s[4:7], s44 offen lds
s_add_u32 m0, s45, 13312
s_mov_b32 s44, 5898240
buffer_load_dwordx4 v16, s[4:7], s44 offen lds
s_add_u32 m0, s45, 14336
s_mov_b32 s44, 6029312
buffer_load_dwordx4 v16, s[4:7], s44 offen lds
s_add_u32 m0, s45, 15360
s_mov_b32 s44, 6160384
buffer_load_dwordx4 v16, s[4:7], s44 offen lds
s_waitcnt vmcnt(16)
ds_read_b64_tr_b16 a[64:65], v17 offset:16384
ds_read_b64_tr_b16 a[66:67], v17 offset:16640
ds_read_b64_tr_b16 a[68:69], v17 offset:16416
ds_read_b64_tr_b16 a[70:71], v17 offset:16672
ds_read_b64_tr_b16 a[72:73], v17 offset:18432
ds_read_b64_tr_b16 a[74:75], v17 offset:18688
ds_read_b64_tr_b16 a[76:77], v17 offset:18464
ds_read_b64_tr_b16 a[78:79], v17 offset:18720
s_waitcnt lgkmcnt(0)
ds_read_b64_tr_b16 a[80:81], v17 offset:20480
ds_read_b64_tr_b16 a[82:83], v17 offset:20736
ds_read_b64_tr_b16 a[84:85], v17 offset:20512
ds_read_b64_tr_b16 a[86:87], v17 offset:20768
ds_read_b64_tr_b16 a[88:89], v17 offset:22528
ds_read_b64_tr_b16 a[90:91], v17 offset:22784
ds_read_b64_tr_b16 a[92:93], v17 offset:22560
ds_read_b64_tr_b16 a[94:95], v17 offset:22816
s_waitcnt lgkmcnt(0)
ds_read_b64_tr_b16 a[96:97], v17 offset:24576
ds_read_b64_tr_b16 a[98:99], v17 offset:24832
ds_read_b64_tr_b16 a[100:101], v17 offset:24608
ds_read_b64_tr_b16 a[102:103], v17 offset:24864
ds_read_b64_tr_b16 a[104:105], v17 offset:26624
ds_read_b64_tr_b16 a[106:107], v17 offset:26880
ds_read_b64_tr_b16 a[108:109], v17 offset:26656
ds_read_b64_tr_b16 a[110:111], v17 offset:26912
s_waitcnt lgkmcnt(0)
ds_read_b64_tr_b16 a[112:113], v17 offset:28672
ds_read_b64_tr_b16 a[114:115], v17 offset:28928
ds_read_b64_tr_b16 a[116:117], v17 offset:28704
ds_read_b64_tr_b16 a[118:119], v17 offset:28960
ds_read_b64_tr_b16 a[120:121], v17 offset:30720
ds_read_b64_tr_b16 a[122:123], v17 offset:30976
ds_read_b64_tr_b16 a[124:125], v17 offset:30752
ds_read_b64_tr_b16 a[126:127], v17 offset:31008
s_waitcnt lgkmcnt(0)
s_add_u32 m0, s45, 16384
s_mov_b32 s44, 6291456
buffer_load_dwordx4 v16, s[4:7], s44 offen lds
s_add_u32 m0, s45, 17408
s_mov_b32 s44, 6422528
buffer_load_dwordx4 v16, s[4:7], s44 offen lds
s_add_u32 m0, s45, 18432
s_mov_b32 s44, 6553600
buffer_load_dwordx4 v16, s[4:7], s44 offen lds
s_add_u32 m0, s45, 19456
s_mov_b32 s44, 6684672
buffer_load_dwordx4 v16, s[4:7], s44 offen lds
s_add_u32 m0, s45, 20480
s_mov_b32 s44, 6815744
buffer_load_dwordx4 v16, s[4:7], s44 offen lds
s_add_u32 m0, s45, 21504
s_mov_b32 s44, 6946816
buffer_load_dwordx4 v16, s[4:7], s44 offen lds
s_add_u32 m0, s45, 22528
s_mov_b32 s44, 7077888
buffer_load_dwordx4 v16, s[4:7], s44 offen lds
s_add_u32 m0, s45, 23552
s_mov_b32 s44, 7208960
buffer_load_dwordx4 v16, s[4:7], s44 offen lds
s_add_u32 m0, s45, 24576
s_mov_b32 s44, 7340032
buffer_load_dwordx4 v16, s[4:7], s44 offen lds
s_add_u32 m0, s45, 25600
s_mov_b32 s44, 7471104
buffer_load_dwordx4 v16, s[4:7], s44 offen lds
s_add_u32 m0, s45, 26624
s_mov_b32 s44, 7602176
buffer_load_dwordx4 v16, s[4:7], s44 offen lds
s_add_u32 m0, s45, 27648
s_mov_b32 s44, 7733248
buffer_load_dwordx4 v16, s[4:7], s44 offen lds
s_add_u32 m0, s45, 28672
s_mov_b32 s44, 7864320
buffer_load_dwordx4 v16, s[4:7], s44 offen lds
s_add_u32 m0, s45, 29696
s_mov_b32 s44, 7995392
buffer_load_dwordx4 v16, s[4:7], s44 offen lds
s_add_u32 m0, s45, 30720
s_mov_b32 s44, 8126464
buffer_load_dwordx4 v16, s[4:7], s44 offen lds
s_add_u32 m0, s45, 31744
s_mov_b32 s44, 8257536
buffer_load_dwordx4 v16, s[4:7], s44 offen lds
s_waitcnt vmcnt(16)
ds_read_b64_tr_b16 a[128:129], v17 offset:0
ds_read_b64_tr_b16 a[130:131], v17 offset:256
ds_read_b64_tr_b16 a[132:133], v17 offset:32
ds_read_b64_tr_b16 a[134:135], v17 offset:288
ds_read_b64_tr_b16 a[136:137], v17 offset:2048
ds_read_b64_tr_b16 a[138:139], v17 offset:2304
ds_read_b64_tr_b16 a[140:141], v17 offset:2080
ds_read_b64_tr_b16 a[142:143], v17 offset:2336
s_waitcnt lgkmcnt(0)
ds_read_b64_tr_b16 a[144:145], v17 offset:4096
ds_read_b64_tr_b16 a[146:147], v17 offset:4352
ds_read_b64_tr_b16 a[148:149], v17 offset:4128
ds_read_b64_tr_b16 a[150:151], v17 offset:4384
ds_read_b64_tr_b16 a[152:153], v17 offset:6144
ds_read_b64_tr_b16 a[154:155], v17 offset:6400
ds_read_b64_tr_b16 a[156:157], v17 offset:6176
ds_read_b64_tr_b16 a[158:159], v17 offset:6432
s_waitcnt lgkmcnt(0)
ds_read_b64_tr_b16 a[160:161], v17 offset:8192
ds_read_b64_tr_b16 a[162:163], v17 offset:8448
ds_read_b64_tr_b16 a[164:165], v17 offset:8224
ds_read_b64_tr_b16 a[166:167], v17 offset:8480
ds_read_b64_tr_b16 a[168:169], v17 offset:10240
ds_read_b64_tr_b16 a[170:171], v17 offset:10496
ds_read_b64_tr_b16 a[172:173], v17 offset:10272
ds_read_b64_tr_b16 a[174:175], v17 offset:10528
s_waitcnt lgkmcnt(0)
ds_read_b64_tr_b16 a[176:177], v17 offset:12288
ds_read_b64_tr_b16 a[178:179], v17 offset:12544
ds_read_b64_tr_b16 a[180:181], v17 offset:12320
ds_read_b64_tr_b16 a[182:183], v17 offset:12576
ds_read_b64_tr_b16 a[184:185], v17 offset:14336
ds_read_b64_tr_b16 a[186:187], v17 offset:14592
ds_read_b64_tr_b16 a[188:189], v17 offset:14368
ds_read_b64_tr_b16 a[190:191], v17 offset:14624
s_waitcnt lgkmcnt(0)
s_waitcnt vmcnt(0)
ds_read_b64_tr_b16 a[192:193], v17 offset:16384
ds_read_b64_tr_b16 a[194:195], v17 offset:16640
ds_read_b64_tr_b16 a[196:197], v17 offset:16416
ds_read_b64_tr_b16 a[198:199], v17 offset:16672
ds_read_b64_tr_b16 a[200:201], v17 offset:18432
ds_read_b64_tr_b16 a[202:203], v17 offset:18688
ds_read_b64_tr_b16 a[204:205], v17 offset:18464
ds_read_b64_tr_b16 a[206:207], v17 offset:18720
s_waitcnt lgkmcnt(0)
ds_read_b64_tr_b16 a[208:209], v17 offset:20480
ds_read_b64_tr_b16 a[210:211], v17 offset:20736
ds_read_b64_tr_b16 a[212:213], v17 offset:20512
ds_read_b64_tr_b16 a[214:215], v17 offset:20768
ds_read_b64_tr_b16 a[216:217], v17 offset:22528
ds_read_b64_tr_b16 a[218:219], v17 offset:22784
ds_read_b64_tr_b16 a[220:221], v17 offset:22560
ds_read_b64_tr_b16 a[222:223], v17 offset:22816
s_waitcnt lgkmcnt(0)
ds_read_b64_tr_b16 a[224:225], v17 offset:24576
ds_read_b64_tr_b16 a[226:227], v17 offset:24832
ds_read_b64_tr_b16 a[228:229], v17 offset:24608
ds_read_b64_tr_b16 a[230:231], v17 offset:24864
ds_read_b64_tr_b16 a[232:233], v17 offset:26624
ds_read_b64_tr_b16 a[234:235], v17 offset:26880
ds_read_b64_tr_b16 a[236:237], v17 offset:26656
ds_read_b64_tr_b16 a[238:239], v17 offset:26912
s_waitcnt lgkmcnt(0)
ds_read_b64_tr_b16 a[240:241], v17 offset:28672
ds_read_b64_tr_b16 a[242:243], v17 offset:28928
ds_read_b64_tr_b16 a[244:245], v17 offset:28704
ds_read_b64_tr_b16 a[246:247], v17 offset:28960
ds_read_b64_tr_b16 a[248:249], v17 offset:30720
ds_read_b64_tr_b16 a[250:251], v17 offset:30976
ds_read_b64_tr_b16 a[252:253], v17 offset:30752
ds_read_b64_tr_b16 a[254:255], v17 offset:31008
s_waitcnt lgkmcnt(0)
s_barrier
v_lshrrev_b32 v2, 3, v1
s_lshl_b32 s43, s41, 3
v_add_u32 v2, s43, v2
v_bfe_u32 v3, v2, 1, 3
v_and_b32 v4, 7, v1
v_xor_b32 v3, v3, v4
v_lshlrev_b32 v6, 11, v2
v_lshl_add_u32 v6, v3, 4, v6
s_lshl_b32 s46, s41, 10
v_and_b32 v2, 15, v1
v_bfe_u32 v3, v2, 1, 3
v_lshrrev_b32 v4, 4, v1
v_xor_b32 v3, v3, v4
v_lshlrev_b32 v8, 7, v2
v_lshl_add_u32 v8, v3, 4, v8
v_xor_b32 v9, 64, v8
v_add_u32 v10, 0x10000, v8
v_add_u32 v11, 0x10000, v9
v_mov_b32 v7, v5
s_lshl_b32 s47, s40, 2
s_add_u32 s47, s47, s41
s_mov_b32 s42, 0
s_mov_b32 s50, 0
s_add_u32 m0, s46, 0
s_nop 0
buffer_load_dwordx4 v6, s[8:11], s50 offen offset:0 lds
s_add_u32 m0, s46, 3968
s_nop 0
buffer_load_dwordx4 v6, s[8:11], s50 offen offset:128 lds
s_add_u32 m0, s46, 7936
s_nop 0
buffer_load_dwordx4 v6, s[8:11], s50 offen offset:256 lds
s_add_u32 m0, s46, 11904
s_nop 0
buffer_load_dwordx4 v6, s[8:11], s50 offen offset:384 lds
s_add_u32 m0, s46, 15872
s_nop 0
buffer_load_dwordx4 v6, s[8:11], s50 offen offset:512 lds
s_add_u32 m0, s46, 19840
s_nop 0
buffer_load_dwordx4 v6, s[8:11], s50 offen offset:640 lds
s_add_u32 m0, s46, 23808
s_nop 0
buffer_load_dwordx4 v6, s[8:11], s50 offen offset:768 lds
s_add_u32 m0, s46, 27776
s_nop 0
buffer_load_dwordx4 v6, s[8:11], s50 offen offset:896 lds
s_add_u32 m0, s46, 31744
s_nop 0
buffer_load_dwordx4 v6, s[8:11], s50 offen offset:1024 lds
s_add_u32 m0, s46, 35712
s_nop 0
buffer_load_dwordx4 v6, s[8:11], s50 offen offset:1152 lds
s_add_u32 m0, s46, 39680
s_nop 0
buffer_load_dwordx4 v6, s[8:11], s50 offen offset:1280 lds
s_add_u32 m0, s46, 43648
s_nop 0
buffer_load_dwordx4 v6, s[8:11], s50 offen offset:1408 lds
s_add_u32 m0, s46, 47616
s_nop 0
buffer_load_dwordx4 v6, s[8:11], s50 offen offset:1536 lds
s_add_u32 m0, s46, 51584
s_nop 0
buffer_load_dwordx4 v6, s[8:11], s50 offen offset:1664 lds
s_add_u32 m0, s46, 55552
s_nop 0
buffer_load_dwordx4 v6, s[8:11], s50 offen offset:1792 lds
s_add_u32 m0, s46, 59520
s_nop 0
buffer_load_dwordx4 v6, s[8:11], s50 offen offset:1920 lds
s_and_b32 s53, s47, 31
s_lshl_b32 s53, s53, 4
v_add_u32 v19, s53, v1
v_lshlrev_b32 v19, 7, v19
s_waitcnt vmcnt(0)
s_barrier
s_add_u32 s50, s42, 1
s_min_u32 s50, s50, 63
s_lshl_b32 s50, s50, 16
ds_read_b128 v[20:23], v8 offset:0
ds_read_b128 v[24:27], v8 offset:2048
ds_read_b128 v[28:31], v9 offset:0
ds_read_b128 v[32:35], v9 offset:2048
ds_read_b128 v[36:39], v8 offset:4096
ds_read_b128 v[40:43], v8 offset:6144
s_waitcnt lgkmcnt(4)
v_mfma_f32_16x16x32_bf16 v[52:55], v[20:23], a[0:3], 0
ds_read_b128 v[44:47], v9 offset:4096
v_mfma_f32_16x16x32_bf16 v[56:59], v[20:23], a[4:7], 0
v_mfma_f32_16x16x32_bf16 v[60:63], v[24:27], a[0:3], 0
ds_read_b128 v[48:51], v9 offset:6144
v_mfma_f32_16x16x32_bf16 v[64:67], v[24:27], a[4:7], 0
s_waitcnt lgkmcnt(4)
v_mfma_f32_16x16x32_bf16 v[52:55], v[28:31], a[8:11], v[52:55]
ds_read_b128 v[20:23], v8 offset:8192
v_mfma_f32_16x16x32_bf16 v[56:59], v[28:31], a[12:15], v[56:59]
v_mfma_f32_16x16x32_bf16 v[60:63], v[32:35], a[8:11], v[60:63]
ds_read_b128 v[24:27], v8 offset:10240
v_mfma_f32_16x16x32_bf16 v[64:67], v[32:35], a[12:15], v[64:67]
s_waitcnt lgkmcnt(4)
v_mfma_f32_16x16x32_bf16 v[52:55], v[36:39], a[16:19], v[52:55]
ds_read_b128 v[28:31], v9 offset:8192
v_mfma_f32_16x16x32_bf16 v[56:59], v[36:39], a[20:23], v[56:59]
v_mfma_f32_16x16x32_bf16 v[60:63], v[40:43], a[16:19], v[60:63]
ds_read_b128 v[32:35], v9 offset:10240
v_mfma_f32_16x16x32_bf16 v[64:67], v[40:43], a[20:23], v[64:67]
s_waitcnt lgkmcnt(4)
v_mfma_f32_16x16x32_bf16 v[52:55], v[44:47], a[24:27], v[52:55]
ds_read_b128 v[36:39], v8 offset:12288
v_mfma_f32_16x16x32_bf16 v[56:59], v[44:47], a[28:31], v[56:59]
s_add_u32 m0, s46, 65536
v_mfma_f32_16x16x32_bf16 v[60:63], v[48:51], a[24:27], v[60:63]
ds_read_b128 v[40:43], v8 offset:14336
v_mfma_f32_16x16x32_bf16 v[64:67], v[48:51], a[28:31], v[64:67]
buffer_load_dwordx4 v6, s[8:11], s50 offen offset:0 lds
s_waitcnt lgkmcnt(4)
v_mfma_f32_16x16x32_bf16 v[52:55], v[20:23], a[32:35], v[52:55]
ds_read_b128 v[44:47], v9 offset:12288
v_mfma_f32_16x16x32_bf16 v[56:59], v[20:23], a[36:39], v[56:59]
s_add_u32 m0, s46, 69504
v_mfma_f32_16x16x32_bf16 v[60:63], v[24:27], a[32:35], v[60:63]
ds_read_b128 v[48:51], v9 offset:14336
v_mfma_f32_16x16x32_bf16 v[64:67], v[24:27], a[36:39], v[64:67]
buffer_load_dwordx4 v6, s[8:11], s50 offen offset:128 lds
s_waitcnt lgkmcnt(4)
v_mfma_f32_16x16x32_bf16 v[52:55], v[28:31], a[40:43], v[52:55]
ds_read_b128 v[20:23], v8 offset:16384
v_mfma_f32_16x16x32_bf16 v[56:59], v[28:31], a[44:47], v[56:59]
s_add_u32 m0, s46, 73472
v_mfma_f32_16x16x32_bf16 v[60:63], v[32:35], a[40:43], v[60:63]
ds_read_b128 v[24:27], v8 offset:18432
v_mfma_f32_16x16x32_bf16 v[64:67], v[32:35], a[44:47], v[64:67]
buffer_load_dwordx4 v6, s[8:11], s50 offen offset:256 lds
s_waitcnt lgkmcnt(4)
v_mfma_f32_16x16x32_bf16 v[52:55], v[36:39], a[48:51], v[52:55]
ds_read_b128 v[28:31], v9 offset:16384
v_mfma_f32_16x16x32_bf16 v[56:59], v[36:39], a[52:55], v[56:59]
s_add_u32 m0, s46, 77440
v_mfma_f32_16x16x32_bf16 v[60:63], v[40:43], a[48:51], v[60:63]
ds_read_b128 v[32:35], v9 offset:18432
v_mfma_f32_16x16x32_bf16 v[64:67], v[40:43], a[52:55], v[64:67]
buffer_load_dwordx4 v6, s[8:11], s50 offen offset:384 lds
s_waitcnt lgkmcnt(4)
v_mfma_f32_16x16x32_bf16 v[52:55], v[44:47], a[56:59], v[52:55]
ds_read_b128 v[36:39], v8 offset:20480
v_mfma_f32_16x16x32_bf16 v[56:59], v[44:47], a[60:63], v[56:59]
s_add_u32 m0, s46, 81408
v_mfma_f32_16x16x32_bf16 v[60:63], v[48:51], a[56:59], v[60:63]
ds_read_b128 v[40:43], v8 offset:22528
v_mfma_f32_16x16x32_bf16 v[64:67], v[48:51], a[60:63], v[64:67]
buffer_load_dwordx4 v6, s[8:11], s50 offen offset:512 lds
s_waitcnt lgkmcnt(4)
v_mfma_f32_16x16x32_bf16 v[52:55], v[20:23], a[64:67], v[52:55]
ds_read_b128 v[44:47], v9 offset:20480
v_mfma_f32_16x16x32_bf16 v[56:59], v[20:23], a[68:71], v[56:59]
s_add_u32 m0, s46, 85376
v_mfma_f32_16x16x32_bf16 v[60:63], v[24:27], a[64:67], v[60:63]
ds_read_b128 v[48:51], v9 offset:22528
v_mfma_f32_16x16x32_bf16 v[64:67], v[24:27], a[68:71], v[64:67]
buffer_load_dwordx4 v6, s[8:11], s50 offen offset:640 lds
s_waitcnt lgkmcnt(4)
v_mfma_f32_16x16x32_bf16 v[52:55], v[28:31], a[72:75], v[52:55]
ds_read_b128 v[20:23], v8 offset:24576
v_mfma_f32_16x16x32_bf16 v[56:59], v[28:31], a[76:79], v[56:59]
s_add_u32 m0, s46, 89344
v_mfma_f32_16x16x32_bf16 v[60:63], v[32:35], a[72:75], v[60:63]
ds_read_b128 v[24:27], v8 offset:26624
v_mfma_f32_16x16x32_bf16 v[64:67], v[32:35], a[76:79], v[64:67]
buffer_load_dwordx4 v6, s[8:11], s50 offen offset:768 lds
s_waitcnt lgkmcnt(4)
v_mfma_f32_16x16x32_bf16 v[52:55], v[36:39], a[80:83], v[52:55]
ds_read_b128 v[28:31], v9 offset:24576
v_mfma_f32_16x16x32_bf16 v[56:59], v[36:39], a[84:87], v[56:59]
s_add_u32 m0, s46, 93312
v_mfma_f32_16x16x32_bf16 v[60:63], v[40:43], a[80:83], v[60:63]
ds_read_b128 v[32:35], v9 offset:26624
v_mfma_f32_16x16x32_bf16 v[64:67], v[40:43], a[84:87], v[64:67]
buffer_load_dwordx4 v6, s[8:11], s50 offen offset:896 lds
s_waitcnt lgkmcnt(4)
v_mfma_f32_16x16x32_bf16 v[52:55], v[44:47], a[88:91], v[52:55]
ds_read_b128 v[36:39], v8 offset:28672
v_mfma_f32_16x16x32_bf16 v[56:59], v[44:47], a[92:95], v[56:59]
s_add_u32 m0, s46, 97280
v_mfma_f32_16x16x32_bf16 v[60:63], v[48:51], a[88:91], v[60:63]
ds_read_b128 v[40:43], v8 offset:30720
v_mfma_f32_16x16x32_bf16 v[64:67], v[48:51], a[92:95], v[64:67]
buffer_load_dwordx4 v6, s[8:11], s50 offen offset:1024 lds
s_waitcnt lgkmcnt(4)
v_mfma_f32_16x16x32_bf16 v[52:55], v[20:23], a[96:99], v[52:55]
ds_read_b128 v[44:47], v9 offset:28672
v_mfma_f32_16x16x32_bf16 v[56:59], v[20:23], a[100:103], v[56:59]
s_add_u32 m0, s46, 101248
v_mfma_f32_16x16x32_bf16 v[60:63], v[24:27], a[96:99], v[60:63]
ds_read_b128 v[48:51], v9 offset:30720
v_mfma_f32_16x16x32_bf16 v[64:67], v[24:27], a[100:103], v[64:67]
buffer_load_dwordx4 v6, s[8:11], s50 offen offset:1152 lds
s_waitcnt lgkmcnt(4)
v_mfma_f32_16x16x32_bf16 v[52:55], v[28:31], a[104:107], v[52:55]
ds_read_b128 v[20:23], v8 offset:32768
v_mfma_f32_16x16x32_bf16 v[56:59], v[28:31], a[108:111], v[56:59]
s_add_u32 m0, s46, 105216
v_mfma_f32_16x16x32_bf16 v[60:63], v[32:35], a[104:107], v[60:63]
ds_read_b128 v[24:27], v8 offset:34816
v_mfma_f32_16x16x32_bf16 v[64:67], v[32:35], a[108:111], v[64:67]
buffer_load_dwordx4 v6, s[8:11], s50 offen offset:1280 lds
s_waitcnt lgkmcnt(4)
v_mfma_f32_16x16x32_bf16 v[52:55], v[36:39], a[112:115], v[52:55]
ds_read_b128 v[28:31], v9 offset:32768
v_mfma_f32_16x16x32_bf16 v[56:59], v[36:39], a[116:119], v[56:59]
s_add_u32 m0, s46, 109184
v_mfma_f32_16x16x32_bf16 v[60:63], v[40:43], a[112:115], v[60:63]
ds_read_b128 v[32:35], v9 offset:34816
v_mfma_f32_16x16x32_bf16 v[64:67], v[40:43], a[116:119], v[64:67]
buffer_load_dwordx4 v6, s[8:11], s50 offen offset:1408 lds
s_waitcnt lgkmcnt(4)
v_mfma_f32_16x16x32_bf16 v[52:55], v[44:47], a[120:123], v[52:55]
ds_read_b128 v[36:39], v8 offset:36864
v_mfma_f32_16x16x32_bf16 v[56:59], v[44:47], a[124:127], v[56:59]
s_add_u32 m0, s46, 113152
v_mfma_f32_16x16x32_bf16 v[60:63], v[48:51], a[120:123], v[60:63]
ds_read_b128 v[40:43], v8 offset:38912
v_mfma_f32_16x16x32_bf16 v[64:67], v[48:51], a[124:127], v[64:67]
buffer_load_dwordx4 v6, s[8:11], s50 offen offset:1536 lds
s_waitcnt lgkmcnt(4)
v_mfma_f32_16x16x32_bf16 v[52:55], v[20:23], a[128:131], v[52:55]
ds_read_b128 v[44:47], v9 offset:36864
v_mfma_f32_16x16x32_bf16 v[56:59], v[20:23], a[132:135], v[56:59]
s_add_u32 m0, s46, 117120
v_mfma_f32_16x16x32_bf16 v[60:63], v[24:27], a[128:131], v[60:63]
ds_read_b128 v[48:51], v9 offset:38912
v_mfma_f32_16x16x32_bf16 v[64:67], v[24:27], a[132:135], v[64:67]
buffer_load_dwordx4 v6, s[8:11], s50 offen offset:1664 lds
s_waitcnt lgkmcnt(4)
v_mfma_f32_16x16x32_bf16 v[52:55], v[28:31], a[136:139], v[52:55]
ds_read_b128 v[20:23], v8 offset:40960
v_mfma_f32_16x16x32_bf16 v[56:59], v[28:31], a[140:143], v[56:59]
s_add_u32 m0, s46, 121088
v_mfma_f32_16x16x32_bf16 v[60:63], v[32:35], a[136:139], v[60:63]
ds_read_b128 v[24:27], v8 offset:43008
v_mfma_f32_16x16x32_bf16 v[64:67], v[32:35], a[140:143], v[64:67]
buffer_load_dwordx4 v6, s[8:11], s50 offen offset:1792 lds
s_waitcnt lgkmcnt(4)
v_mfma_f32_16x16x32_bf16 v[52:55], v[36:39], a[144:147], v[52:55]
ds_read_b128 v[28:31], v9 offset:40960
v_mfma_f32_16x16x32_bf16 v[56:59], v[36:39], a[148:151], v[56:59]
s_add_u32 m0, s46, 125056
v_mfma_f32_16x16x32_bf16 v[60:63], v[40:43], a[144:147], v[60:63]
ds_read_b128 v[32:35], v9 offset:43008
v_mfma_f32_16x16x32_bf16 v[64:67], v[40:43], a[148:151], v[64:67]
buffer_load_dwordx4 v6, s[8:11], s50 offen offset:1920 lds
s_waitcnt lgkmcnt(4)
v_mfma_f32_16x16x32_bf16 v[52:55], v[44:47], a[152:155], v[52:55]
ds_read_b128 v[36:39], v8 offset:45056
v_mfma_f32_16x16x32_bf16 v[56:59], v[44:47], a[156:159], v[56:59]
v_mfma_f32_16x16x32_bf16 v[60:63], v[48:51], a[152:155], v[60:63]
ds_read_b128 v[40:43], v8 offset:47104
v_mfma_f32_16x16x32_bf16 v[64:67], v[48:51], a[156:159], v[64:67]
s_waitcnt lgkmcnt(4)
v_mfma_f32_16x16x32_bf16 v[52:55], v[20:23], a[160:163], v[52:55]
ds_read_b128 v[44:47], v9 offset:45056
v_mfma_f32_16x16x32_bf16 v[56:59], v[20:23], a[164:167], v[56:59]
v_mfma_f32_16x16x32_bf16 v[60:63], v[24:27], a[160:163], v[60:63]
ds_read_b128 v[48:51], v9 offset:47104
v_mfma_f32_16x16x32_bf16 v[64:67], v[24:27], a[164:167], v[64:67]
s_waitcnt lgkmcnt(4)
v_mfma_f32_16x16x32_bf16 v[52:55], v[28:31], a[168:171], v[52:55]
ds_read_b128 v[20:23], v8 offset:49152
v_mfma_f32_16x16x32_bf16 v[56:59], v[28:31], a[172:175], v[56:59]
v_mfma_f32_16x16x32_bf16 v[60:63], v[32:35], a[168:171], v[60:63]
ds_read_b128 v[24:27], v8 offset:51200
v_mfma_f32_16x16x32_bf16 v[64:67], v[32:35], a[172:175], v[64:67]
s_waitcnt lgkmcnt(4)
v_mfma_f32_16x16x32_bf16 v[52:55], v[36:39], a[176:179], v[52:55]
ds_read_b128 v[28:31], v9 offset:49152
v_mfma_f32_16x16x32_bf16 v[56:59], v[36:39], a[180:183], v[56:59]
s_add_u32 s53, s42, 3
s_min_u32 s53, s53, 63
s_lshl_b32 s53, s53, 16
s_mov_b64 exec, 0xffff
buffer_load_dword v18, v19, s[8:11], s53 offen
s_mov_b64 exec, -1
v_mfma_f32_16x16x32_bf16 v[60:63], v[40:43], a[176:179], v[60:63]
ds_read_b128 v[32:35], v9 offset:51200
v_mfma_f32_16x16x32_bf16 v[64:67], v[40:43], a[180:183], v[64:67]
s_waitcnt lgkmcnt(4)
v_mfma_f32_16x16x32_bf16 v[52:55], v[44:47], a[184:187], v[52:55]
ds_read_b128 v[36:39], v8 offset:53248
v_mfma_f32_16x16x32_bf16 v[56:59], v[44:47], a[188:191], v[56:59]
v_mfma_f32_16x16x32_bf16 v[60:63], v[48:51], a[184:187], v[60:63]
ds_read_b128 v[40:43], v8 offset:55296
v_mfma_f32_16x16x32_bf16 v[64:67], v[48:51], a[188:191], v[64:67]
s_waitcnt lgkmcnt(4)
v_mfma_f32_16x16x32_bf16 v[52:55], v[20:23], a[192:195], v[52:55]
ds_read_b128 v[44:47], v9 offset:53248
v_mfma_f32_16x16x32_bf16 v[56:59], v[20:23], a[196:199], v[56:59]
v_mfma_f32_16x16x32_bf16 v[60:63], v[24:27], a[192:195], v[60:63]
ds_read_b128 v[48:51], v9 offset:55296
v_mfma_f32_16x16x32_bf16 v[64:67], v[24:27], a[196:199], v[64:67]
s_waitcnt lgkmcnt(4)
v_mfma_f32_16x16x32_bf16 v[52:55], v[28:31], a[200:203], v[52:55]
ds_read_b128 v[20:23], v8 offset:57344
v_mfma_f32_16x16x32_bf16 v[56:59], v[28:31], a[204:207], v[56:59]
v_mfma_f32_16x16x32_bf16 v[60:63], v[32:35], a[200:203], v[60:63]
ds_read_b128 v[24:27], v8 offset:59392
v_mfma_f32_16x16x32_bf16 v[64:67], v[32:35], a[204:207], v[64:67]
s_waitcnt lgkmcnt(4)
v_mfma_f32_16x16x32_bf16 v[52:55], v[36:39], a[208:211], v[52:55]
ds_read_b128 v[28:31], v9 offset:57344
v_mfma_f32_16x16x32_bf16 v[56:59], v[36:39], a[212:215], v[56:59]
v_mfma_f32_16x16x32_bf16 v[60:63], v[40:43], a[208:211], v[60:63]
ds_read_b128 v[32:35], v9 offset:59392
v_mfma_f32_16x16x32_bf16 v[64:67], v[40:43], a[212:215], v[64:67]
s_waitcnt lgkmcnt(4)
v_mfma_f32_16x16x32_bf16 v[52:55], v[44:47], a[216:219], v[52:55]
ds_read_b128 v[36:39], v8 offset:61440
v_mfma_f32_16x16x32_bf16 v[56:59], v[44:47], a[220:223], v[56:59]
v_mfma_f32_16x16x32_bf16 v[60:63], v[48:51], a[216:219], v[60:63]
ds_read_b128 v[40:43], v8 offset:63488
v_mfma_f32_16x16x32_bf16 v[64:67], v[48:51], a[220:223], v[64:67]
s_waitcnt lgkmcnt(4)
v_mfma_f32_16x16x32_bf16 v[52:55], v[20:23], a[224:227], v[52:55]
ds_read_b128 v[44:47], v9 offset:61440
v_mfma_f32_16x16x32_bf16 v[56:59], v[20:23], a[228:231], v[56:59]
v_mfma_f32_16x16x32_bf16 v[60:63], v[24:27], a[224:227], v[60:63]
ds_read_b128 v[48:51], v9 offset:63488
v_mfma_f32_16x16x32_bf16 v[64:67], v[24:27], a[228:231], v[64:67]
s_waitcnt lgkmcnt(5)
v_mfma_f32_16x16x32_bf16 v[52:55], v[28:31], a[232:235], v[52:55]
v_mfma_f32_16x16x32_bf16 v[56:59], v[28:31], a[236:239], v[56:59]
s_waitcnt lgkmcnt(4)
v_mfma_f32_16x16x32_bf16 v[60:63], v[32:35], a[232:235], v[60:63]
v_mfma_f32_16x16x32_bf16 v[64:67], v[32:35], a[236:239], v[64:67]
s_waitcnt lgkmcnt(3)
v_mfma_f32_16x16x32_bf16 v[52:55], v[36:39], a[240:243], v[52:55]
v_mfma_f32_16x16x32_bf16 v[56:59], v[36:39], a[244:247], v[56:59]
s_waitcnt lgkmcnt(2)
v_mfma_f32_16x16x32_bf16 v[60:63], v[40:43], a[240:243], v[60:63]
v_mfma_f32_16x16x32_bf16 v[64:67], v[40:43], a[244:247], v[64:67]
s_waitcnt lgkmcnt(1)
v_mfma_f32_16x16x32_bf16 v[52:55], v[44:47], a[248:251], v[52:55]
v_mfma_f32_16x16x32_bf16 v[56:59], v[44:47], a[252:255], v[56:59]
s_waitcnt lgkmcnt(0)
v_mfma_f32_16x16x32_bf16 v[60:63], v[48:51], a[248:251], v[60:63]
v_mfma_f32_16x16x32_bf16 v[64:67], v[48:51], a[252:255], v[64:67]
s_add_u32 s42, s42, 1
v_and_b32 v3, 15, v0
v_lshlrev_b32 v3, 4, v3
s_branch mega_kernel_syv
mega_kernel_syvw:
s_sleep 4
mega_kernel_syv:
buffer_load_dword v2, v3, s[72:75], 0 offen sc1
s_waitcnt vmcnt(0)
s_cmp_eq_u32 s95, 1
s_cbranch_scc0 mega_kernel_syvf
v_readlane_b32 s76, v2, 14
s_mov_b32 s98, 0
s_cmp_eq_u32 s76, 64
s_cbranch_scc0 mega_kernel_syvw
s_branch mega_kernel_syvd
mega_kernel_syvf:
s_mov_b32 s77, 0
s_mov_b32 s78, 0
v_readlane_b32 s76, v2, 0
s_add_u32 s77, s77, s76
s_xor_b32 s76, s76, 32
s_or_b32 s78, s78, s76
v_readlane_b32 s76, v2, 1
s_add_u32 s77, s77, s76
s_xor_b32 s76, s76, 32
s_or_b32 s78, s78, s76
v_readlane_b32 s76, v2, 2
s_add_u32 s77, s77, s76
s_xor_b32 s76, s76, 32
s_or_b32 s78, s78, s76
v_readlane_b32 s76, v2, 3
s_add_u32 s77, s77, s76
s_xor_b32 s76, s76, 32
s_or_b32 s78, s78, s76
v_readlane_b32 s76, v2, 4
s_add_u32 s77, s77, s76
s_xor_b32 s76, s76, 32
s_or_b32 s78, s78, s76
v_readlane_b32 s76, v2, 5
s_add_u32 s77, s77, s76
s_xor_b32 s76, s76, 32
s_or_b32 s78, s78, s76
v_readlane_b32 s76, v2, 6
s_add_u32 s77, s77, s76
s_xor_b32 s76, s76, 32
s_or_b32 s78, s78, s76
v_readlane_b32 s76, v2, 7
s_add_u32 s77, s77, s76
s_xor_b32 s76, s76, 32
s_or_b32 s78, s78, s76
s_cmp_eq_u32 s77, 256
s_cbranch_scc0 mega_kernel_syvw
v_mov_b32 v252, v2
s_cmp_eq_u32 s78, 0
s_cbranch_scc0 mega_kernel_slowent
v_readlane_b32 s76, v2, 10
v_readlane_b32 s77, v2, 8
s_cmp_eq_u32 s76, 64
s_cbranch_scc0 mega_kernel_syvw
s_cmp_gt_u32 s77, 32
s_cselect_b32 s98, 1, 0
mega_kernel_syvd:
s_lshr_b32 s44, s47, 3
s_xor_b32 s44, s44, s98
s_and_b32 s44, s44, 1
s_lshl_b32 s44, s44, 13
s_lshl_b32 s48, s47, 18
s_add_u32 s48, s48, s44
s_add_u32 s48, s48, 33554432
s_xor_b32 s44, s98, 1
s_lshl_b32 s44, s44, 13
s_lshl_b32 s49, s40, 7
s_add_u32 s49, s49, s44
s_lshl_b32 s44, s41, 2
s_add_u32 s49, s49, s44
s_add_u32 s49, s49, 69210112
v_mov_b32 v16, 0
v_cvt_pk_bf16_f32 v84, v52, v53
v_cvt_pk_bf16_f32 v85, v54, v55
v_cvt_pk_bf16_f32 v86, v60, v61
v_cvt_pk_bf16_f32 v87, v62, v63
v_cvt_pk_bf16_f32 v88, v56, v57
v_cvt_pk_bf16_f32 v89, v58, v59
v_cvt_pk_bf16_f32 v90, v64, v65
v_cvt_pk_bf16_f32 v91, v66, v67
s_add_u32 s51, s42, s47
s_sub_u32 s51, s51, 1
s_bfe_u32 s52, s51, 0x40002
s_lshl_b32 s52, s52, 14
s_and_b32 s51, s51, 3
s_lshl_b32 s51, s51, 11
s_add_u32 s51, s51, s52
s_add_u32 s51, s51, s48
buffer_store_dwordx4 v[84:87], v7, s[84:87], s51 offen sc1
buffer_store_dwordx4 v[88:91], v7, s[84:87], s51 offen offset:1024 sc1
s_waitcnt vmcnt(0)
v_mov_b32 v17, s42
s_mov_b64 exec, 1
buffer_store_dword v17, v16, s[84:87], s49 offen sc1
s_mov_b64 exec, -1
mega_kernel_v_loop:
s_waitcnt vmcnt(2)
s_barrier
s_add_u32 s50, s42, 1
s_min_u32 s50, s50, 63
s_lshl_b32 s50, s50, 16
ds_read_b128 v[20:23], v10 offset:0
ds_read_b128 v[24:27], v10 offset:2048
ds_read_b128 v[28:31], v11 offset:0
ds_read_b128 v[32:35], v11 offset:2048
ds_read_b128 v[36:39], v10 offset:4096
ds_read_b128 v[40:43], v10 offset:6144
s_waitcnt lgkmcnt(4)
v_mfma_f32_16x16x32_bf16 v[68:71], v[20:23], a[0:3], 0
ds_read_b128 v[44:47], v11 offset:4096
v_mfma_f32_16x16x32_bf16 v[72:75], v[20:23], a[4:7], 0
v_cvt_pk_bf16_f32 v84, v52, v53
v_cvt_pk_bf16_f32 v85, v54, v55
v_cvt_pk_bf16_f32 v86, v60, v61
v_mfma_f32_16x16x32_bf16 v[76:79], v[24:27], a[0:3], 0
ds_read_b128 v[48:51], v11 offset:6144
v_mfma_f32_16x16x32_bf16 v[80:83], v[24:27], a[4:7], 0
v_cvt_pk_bf16_f32 v87, v62, v63
v_cvt_pk_bf16_f32 v88, v56, v57
v_cvt_pk_bf16_f32 v89, v58, v59
s_waitcnt lgkmcnt(4)
v_mfma_f32_16x16x32_bf16 v[68:71], v[28:31], a[8:11], v[68:71]
ds_read_b128 v[20:23], v10 offset:8192
v_mfma_f32_16x16x32_bf16 v[72:75], v[28:31], a[12:15], v[72:75]
v_cvt_pk_bf16_f32 v90, v64, v65
v_cvt_pk_bf16_f32 v91, v66, v67
v_mfma_f32_16x16x32_bf16 v[76:79], v[32:35], a[8:11], v[76:79]
ds_read_b128 v[24:27], v10 offset:10240
v_mfma_f32_16x16x32_bf16 v[80:83], v[32:35], a[12:15], v[80:83]
s_add_u32 s51, s42, s47
s_sub_u32 s51, s51, 1
s_bfe_u32 s52, s51, 0x40002
s_lshl_b32 s52, s52, 14
s_waitcnt lgkmcnt(4)
v_mfma_f32_16x16x32_bf16 v[68:71], v[36:39], a[16:19], v[68:71]
ds_read_b128 v[28:31], v11 offset:8192
v_mfma_f32_16x16x32_bf16 v[72:75], v[36:39], a[20:23], v[72:75]
s_and_b32 s51, s51, 3
s_lshl_b32 s51, s51, 11
s_add_u32 s51, s51, s52
s_add_u32 s51, s51, s48
buffer_store_dwordx4 v[84:87], v7, s[84:87], s51 offen sc1
v_mfma_f32_16x16x32_bf16 v[76:79], v[40:43], a[16:19], v[76:79]
ds_read_b128 v[32:35], v11 offset:10240
v_mfma_f32_16x16x32_bf16 v[80:83], v[40:43], a[20:23], v[80:83]
buffer_store_dwordx4 v[88:91], v7, s[84:87], s51 offen offset:1024 sc1
s_waitcnt lgkmcnt(4)
v_mfma_f32_16x16x32_bf16 v[68:71], v[44:47], a[24:27], v[68:71]
ds_read_b128 v[36:39], v10 offset:12288
v_mfma_f32_16x16x32_bf16 v[72:75], v[44:47], a[28:31], v[72:75]
s_add_u32 m0, s46, 0
v_mfma_f32_16x16x32_bf16 v[76:79], v[48:51], a[24:27], v[76:79]
ds_read_b128 v[40:43], v10 offset:14336
v_mfma_f32_16x16x32_bf16 v[80:83], v[48:51], a[28:31], v[80:83]
buffer_load_dwordx4 v6, s[8:11], s50 offen offset:0 lds
s_waitcnt lgkmcnt(4)
v_mfma_f32_16x16x32_bf16 v[68:71], v[20:23], a[32:35], v[68:71]
ds_read_b128 v[44:47], v11 offset:12288
v_mfma_f32_16x16x32_bf16 v[72:75], v[20:23], a[36:39], v[72:75]
s_add_u32 m0, s46, 3968
v_mfma_f32_16x16x32_bf16 v[76:79], v[24:27], a[32:35], v[76:79]
ds_read_b128 v[48:51], v11 offset:14336
v_mfma_f32_16x16x32_bf16 v[80:83], v[24:27], a[36:39], v[80:83]
buffer_load_dwordx4 v6, s[8:11], s50 offen offset:128 lds
s_waitcnt lgkmcnt(4)
v_mfma_f32_16x16x32_bf16 v[68:71], v[28:31], a[40:43], v[68:71]
ds_read_b128 v[20:23], v10 offset:16384
v_mfma_f32_16x16x32_bf16 v[72:75], v[28:31], a[44:47], v[72:75]
s_add_u32 m0, s46, 7936
v_mfma_f32_16x16x32_bf16 v[76:79], v[32:35], a[40:43], v[76:79]
ds_read_b128 v[24:27], v10 offset:18432
v_mfma_f32_16x16x32_bf16 v[80:83], v[32:35], a[44:47], v[80:83]
buffer_load_dwordx4 v6, s[8:11], s50 offen offset:256 lds
s_waitcnt lgkmcnt(4)
v_mfma_f32_16x16x32_bf16 v[68:71], v[36:39], a[48:51], v[68:71]
ds_read_b128 v[28:31], v11 offset:16384
v_mfma_f32_16x16x32_bf16 v[72:75], v[36:39], a[52:55], v[72:75]
s_add_u32 m0, s46, 11904
v_mfma_f32_16x16x32_bf16 v[76:79], v[40:43], a[48:51], v[76:79]
ds_read_b128 v[32:35], v11 offset:18432
v_mfma_f32_16x16x32_bf16 v[80:83], v[40:43], a[52:55], v[80:83]
buffer_load_dwordx4 v6, s[8:11], s50 offen offset:384 lds
s_waitcnt lgkmcnt(4)
v_mfma_f32_16x16x32_bf16 v[68:71], v[44:47], a[56:59], v[68:71]
ds_read_b128 v[36:39], v10 offset:20480
v_mfma_f32_16x16x32_bf16 v[72:75], v[44:47], a[60:63], v[72:75]
s_add_u32 m0, s46, 15872
v_mfma_f32_16x16x32_bf16 v[76:79], v[48:51], a[56:59], v[76:79]
ds_read_b128 v[40:43], v10 offset:22528
v_mfma_f32_16x16x32_bf16 v[80:83], v[48:51], a[60:63], v[80:83]
buffer_load_dwordx4 v6, s[8:11], s50 offen offset:512 lds
s_waitcnt lgkmcnt(4)
v_mfma_f32_16x16x32_bf16 v[68:71], v[20:23], a[64:67], v[68:71]
ds_read_b128 v[44:47], v11 offset:20480
v_mfma_f32_16x16x32_bf16 v[72:75], v[20:23], a[68:71], v[72:75]
s_add_u32 m0, s46, 19840
v_mfma_f32_16x16x32_bf16 v[76:79], v[24:27], a[64:67], v[76:79]
ds_read_b128 v[48:51], v11 offset:22528
v_mfma_f32_16x16x32_bf16 v[80:83], v[24:27], a[68:71], v[80:83]
buffer_load_dwordx4 v6, s[8:11], s50 offen offset:640 lds
s_waitcnt lgkmcnt(4)
v_mfma_f32_16x16x32_bf16 v[68:71], v[28:31], a[72:75], v[68:71]
ds_read_b128 v[20:23], v10 offset:24576
v_mfma_f32_16x16x32_bf16 v[72:75], v[28:31], a[76:79], v[72:75]
s_add_u32 m0, s46, 23808
v_mfma_f32_16x16x32_bf16 v[76:79], v[32:35], a[72:75], v[76:79]
ds_read_b128 v[24:27], v10 offset:26624
v_mfma_f32_16x16x32_bf16 v[80:83], v[32:35], a[76:79], v[80:83]
buffer_load_dwordx4 v6, s[8:11], s50 offen offset:768 lds
s_waitcnt lgkmcnt(4)
v_mfma_f32_16x16x32_bf16 v[68:71], v[36:39], a[80:83], v[68:71]
ds_read_b128 v[28:31], v11 offset:24576
v_mfma_f32_16x16x32_bf16 v[72:75], v[36:39], a[84:87], v[72:75]
s_add_u32 m0, s46, 27776
v_mfma_f32_16x16x32_bf16 v[76:79], v[40:43], a[80:83], v[76:79]
ds_read_b128 v[32:35], v11 offset:26624
v_mfma_f32_16x16x32_bf16 v[80:83], v[40:43], a[84:87], v[80:83]
buffer_load_dwordx4 v6, s[8:11], s50 offen offset:896 lds
s_waitcnt lgkmcnt(4)
v_mfma_f32_16x16x32_bf16 v[68:71], v[44:47], a[88:91], v[68:71]
ds_read_b128 v[36:39], v10 offset:28672
v_mfma_f32_16x16x32_bf16 v[72:75], v[44:47], a[92:95], v[72:75]
s_add_u32 m0, s46, 31744
v_mfma_f32_16x16x32_bf16 v[76:79], v[48:51], a[88:91], v[76:79]
ds_read_b128 v[40:43], v10 offset:30720
v_mfma_f32_16x16x32_bf16 v[80:83], v[48:51], a[92:95], v[80:83]
buffer_load_dwordx4 v6, s[8:11], s50 offen offset:1024 lds
s_waitcnt lgkmcnt(4)
v_mfma_f32_16x16x32_bf16 v[68:71], v[20:23], a[96:99], v[68:71]
ds_read_b128 v[44:47], v11 offset:28672
v_mfma_f32_16x16x32_bf16 v[72:75], v[20:23], a[100:103], v[72:75]
s_add_u32 m0, s46, 35712
v_mfma_f32_16x16x32_bf16 v[76:79], v[24:27], a[96:99], v[76:79]
ds_read_b128 v[48:51], v11 offset:30720
v_mfma_f32_16x16x32_bf16 v[80:83], v[24:27], a[100:103], v[80:83]
buffer_load_dwordx4 v6, s[8:11], s50 offen offset:1152 lds
s_waitcnt lgkmcnt(4)
v_mfma_f32_16x16x32_bf16 v[68:71], v[28:31], a[104:107], v[68:71]
ds_read_b128 v[20:23], v10 offset:32768
v_mfma_f32_16x16x32_bf16 v[72:75], v[28:31], a[108:111], v[72:75]
s_add_u32 m0, s46, 39680
v_mfma_f32_16x16x32_bf16 v[76:79], v[32:35], a[104:107], v[76:79]
ds_read_b128 v[24:27], v10 offset:34816
v_mfma_f32_16x16x32_bf16 v[80:83], v[32:35], a[108:111], v[80:83]
buffer_load_dwordx4 v6, s[8:11], s50 offen offset:1280 lds
s_waitcnt lgkmcnt(4)
v_mfma_f32_16x16x32_bf16 v[68:71], v[36:39], a[112:115], v[68:71]
ds_read_b128 v[28:31], v11 offset:32768
v_mfma_f32_16x16x32_bf16 v[72:75], v[36:39], a[116:119], v[72:75]
s_add_u32 m0, s46, 43648
v_mfma_f32_16x16x32_bf16 v[76:79], v[40:43], a[112:115], v[76:79]
ds_read_b128 v[32:35], v11 offset:34816
v_mfma_f32_16x16x32_bf16 v[80:83], v[40:43], a[116:119], v[80:83]
buffer_load_dwordx4 v6, s[8:11], s50 offen offset:1408 lds
s_waitcnt lgkmcnt(4)
v_mfma_f32_16x16x32_bf16 v[68:71], v[44:47], a[120:123], v[68:71]
ds_read_b128 v[36:39], v10 offset:36864
v_mfma_f32_16x16x32_bf16 v[72:75], v[44:47], a[124:127], v[72:75]
s_add_u32 m0, s46, 47616
v_mfma_f32_16x16x32_bf16 v[76:79], v[48:51], a[120:123], v[76:79]
ds_read_b128 v[40:43], v10 offset:38912
v_mfma_f32_16x16x32_bf16 v[80:83], v[48:51], a[124:127], v[80:83]
buffer_load_dwordx4 v6, s[8:11], s50 offen offset:1536 lds
s_waitcnt lgkmcnt(4)
v_mfma_f32_16x16x32_bf16 v[68:71], v[20:23], a[128:131], v[68:71]
ds_read_b128 v[44:47], v11 offset:36864
v_mfma_f32_16x16x32_bf16 v[72:75], v[20:23], a[132:135], v[72:75]
s_add_u32 m0, s46, 51584
v_mfma_f32_16x16x32_bf16 v[76:79], v[24:27], a[128:131], v[76:79]
ds_read_b128 v[48:51], v11 offset:38912
v_mfma_f32_16x16x32_bf16 v[80:83], v[24:27], a[132:135], v[80:83]
buffer_load_dwordx4 v6, s[8:11], s50 offen offset:1664 lds
s_waitcnt lgkmcnt(4)
v_mfma_f32_16x16x32_bf16 v[68:71], v[28:31], a[136:139], v[68:71]
ds_read_b128 v[20:23], v10 offset:40960
v_mfma_f32_16x16x32_bf16 v[72:75], v[28:31], a[140:143], v[72:75]
s_add_u32 m0, s46, 55552
v_mfma_f32_16x16x32_bf16 v[76:79], v[32:35], a[136:139], v[76:79]
ds_read_b128 v[24:27], v10 offset:43008
v_mfma_f32_16x16x32_bf16 v[80:83], v[32:35], a[140:143], v[80:83]
buffer_load_dwordx4 v6, s[8:11], s50 offen offset:1792 lds
s_waitcnt lgkmcnt(4)
v_mfma_f32_16x16x32_bf16 v[68:71], v[36:39], a[144:147], v[68:71]
ds_read_b128 v[28:31], v11 offset:40960
v_mfma_f32_16x16x32_bf16 v[72:75], v[36:39], a[148:151], v[72:75]
s_add_u32 m0, s46, 59520
v_mfma_f32_16x16x32_bf16 v[76:79], v[40:43], a[144:147], v[76:79]
ds_read_b128 v[32:35], v11 offset:43008
v_mfma_f32_16x16x32_bf16 v[80:83], v[40:43], a[148:151], v[80:83]
buffer_load_dwordx4 v6, s[8:11], s50 offen offset:1920 lds
s_waitcnt lgkmcnt(4)
v_mfma_f32_16x16x32_bf16 v[68:71], v[44:47], a[152:155], v[68:71]
ds_read_b128 v[36:39], v10 offset:45056
v_mfma_f32_16x16x32_bf16 v[72:75], v[44:47], a[156:159], v[72:75]
v_mfma_f32_16x16x32_bf16 v[76:79], v[48:51], a[152:155], v[76:79]
ds_read_b128 v[40:43], v10 offset:47104
v_mfma_f32_16x16x32_bf16 v[80:83], v[48:51], a[156:159], v[80:83]
s_waitcnt lgkmcnt(4)
v_mfma_f32_16x16x32_bf16 v[68:71], v[20:23], a[160:163], v[68:71]
ds_read_b128 v[44:47], v11 offset:45056
v_mfma_f32_16x16x32_bf16 v[72:75], v[20:23], a[164:167], v[72:75]
v_mfma_f32_16x16x32_bf16 v[76:79], v[24:27], a[160:163], v[76:79]
ds_read_b128 v[48:51], v11 offset:47104
v_mfma_f32_16x16x32_bf16 v[80:83], v[24:27], a[164:167], v[80:83]
s_waitcnt lgkmcnt(4)
v_mfma_f32_16x16x32_bf16 v[68:71], v[28:31], a[168:171], v[68:71]
ds_read_b128 v[20:23], v10 offset:49152
v_mfma_f32_16x16x32_bf16 v[72:75], v[28:31], a[172:175], v[72:75]
s_waitcnt vmcnt(16)
v_mov_b32 v17, s42
s_mov_b64 exec, 1
buffer_store_dword v17, v16, s[84:87], s49 offen sc1
s_mov_b64 exec, -1
v_mfma_f32_16x16x32_bf16 v[76:79], v[32:35], a[168:171], v[76:79]
ds_read_b128 v[24:27], v10 offset:51200
v_mfma_f32_16x16x32_bf16 v[80:83], v[32:35], a[172:175], v[80:83]
s_waitcnt lgkmcnt(4)
v_mfma_f32_16x16x32_bf16 v[68:71], v[36:39], a[176:179], v[68:71]
ds_read_b128 v[28:31], v11 offset:49152
v_mfma_f32_16x16x32_bf16 v[72:75], v[36:39], a[180:183], v[72:75]
s_add_u32 s53, s42, 3
s_min_u32 s53, s53, 63
s_lshl_b32 s53, s53, 16
s_mov_b64 exec, 0xffff
buffer_load_dword v18, v19, s[8:11], s53 offen
s_mov_b64 exec, -1
v_mfma_f32_16x16x32_bf16 v[76:79], v[40:43], a[176:179], v[76:79]
ds_read_b128 v[32:35], v11 offset:51200
v_mfma_f32_16x16x32_bf16 v[80:83], v[40:43], a[180:183], v[80:83]
s_waitcnt lgkmcnt(4)
v_mfma_f32_16x16x32_bf16 v[68:71], v[44:47], a[184:187], v[68:71]
ds_read_b128 v[36:39], v10 offset:53248
v_mfma_f32_16x16x32_bf16 v[72:75], v[44:47], a[188:191], v[72:75]
v_mfma_f32_16x16x32_bf16 v[76:79], v[48:51], a[184:187], v[76:79]
ds_read_b128 v[40:43], v10 offset:55296
v_mfma_f32_16x16x32_bf16 v[80:83], v[48:51], a[188:191], v[80:83]
s_waitcnt lgkmcnt(4)
v_mfma_f32_16x16x32_bf16 v[68:71], v[20:23], a[192:195], v[68:71]
ds_read_b128 v[44:47], v11 offset:53248
v_mfma_f32_16x16x32_bf16 v[72:75], v[20:23], a[196:199], v[72:75]
v_mfma_f32_16x16x32_bf16 v[76:79], v[24:27], a[192:195], v[76:79]
ds_read_b128 v[48:51], v11 offset:55296
v_mfma_f32_16x16x32_bf16 v[80:83], v[24:27], a[196:199], v[80:83]
s_waitcnt lgkmcnt(4)
v_mfma_f32_16x16x32_bf16 v[68:71], v[28:31], a[200:203], v[68:71]
ds_read_b128 v[20:23], v10 offset:57344
v_mfma_f32_16x16x32_bf16 v[72:75], v[28:31], a[204:207], v[72:75]
v_mfma_f32_16x16x32_bf16 v[76:79], v[32:35], a[200:203], v[76:79]
ds_read_b128 v[24:27], v10 offset:59392
v_mfma_f32_16x16x32_bf16 v[80:83], v[32:35], a[204:207], v[80:83]
s_waitcnt lgkmcnt(4)
v_mfma_f32_16x16x32_bf16 v[68:71], v[36:39], a[208:211], v[68:71]
ds_read_b128 v[28:31], v11 offset:57344
v_mfma_f32_16x16x32_bf16 v[72:75], v[36:39], a[212:215], v[72:75]
v_mfma_f32_16x16x32_bf16 v[76:79], v[40:43], a[208:211], v[76:79]
ds_read_b128 v[32:35], v11 offset:59392
v_mfma_f32_16x16x32_bf16 v[80:83], v[40:43], a[212:215], v[80:83]
s_waitcnt lgkmcnt(4)
v_mfma_f32_16x16x32_bf16 v[68:71], v[44:47], a[216:219], v[68:71]
ds_read_b128 v[36:39], v10 offset:61440
v_mfma_f32_16x16x32_bf16 v[72:75], v[44:47], a[220:223], v[72:75]
v_mfma_f32_16x16x32_bf16 v[76:79], v[48:51], a[216:219], v[76:79]
ds_read_b128 v[40:43], v10 offset:63488
v_mfma_f32_16x16x32_bf16 v[80:83], v[48:51], a[220:223], v[80:83]
s_waitcnt lgkmcnt(4)
v_mfma_f32_16x16x32_bf16 v[68:71], v[20:23], a[224:227], v[68:71]
ds_read_b128 v[44:47], v11 offset:61440
v_mfma_f32_16x16x32_bf16 v[72:75], v[20:23], a[228:231], v[72:75]
v_mfma_f32_16x16x32_bf16 v[76:79], v[24:27], a[224:227], v[76:79]
ds_read_b128 v[48:51], v11 offset:63488
v_mfma_f32_16x16x32_bf16 v[80:83], v[24:27], a[228:231], v[80:83]
s_waitcnt lgkmcnt(5)
v_mfma_f32_16x16x32_bf16 v[68:71], v[28:31], a[232:235], v[68:71]
v_mfma_f32_16x16x32_bf16 v[72:75], v[28:31], a[236:239], v[72:75]
s_waitcnt lgkmcnt(4)
v_mfma_f32_16x16x32_bf16 v[76:79], v[32:35], a[232:235], v[76:79]
v_mfma_f32_16x16x32_bf16 v[80:83], v[32:35], a[236:239], v[80:83]
s_waitcnt lgkmcnt(3)
v_mfma_f32_16x16x32_bf16 v[68:71], v[36:39], a[240:243], v[68:71]
v_mfma_f32_16x16x32_bf16 v[72:75], v[36:39], a[244:247], v[72:75]
s_waitcnt lgkmcnt(2)
v_mfma_f32_16x16x32_bf16 v[76:79], v[40:43], a[240:243], v[76:79]
v_mfma_f32_16x16x32_bf16 v[80:83], v[40:43], a[244:247], v[80:83]
s_waitcnt lgkmcnt(1)
v_mfma_f32_16x16x32_bf16 v[68:71], v[44:47], a[248:251], v[68:71]
v_mfma_f32_16x16x32_bf16 v[72:75], v[44:47], a[252:255], v[72:75]
s_waitcnt lgkmcnt(0)
v_mfma_f32_16x16x32_bf16 v[76:79], v[48:51], a[248:251], v[76:79]
v_mfma_f32_16x16x32_bf16 v[80:83], v[48:51], a[252:255], v[80:83]
s_add_u32 s42, s42, 1
s_cmp_eq_u32 s42, 64
s_cbranch_scc1 mega_kernel_v_fin
s_waitcnt vmcnt(2)
s_barrier
s_add_u32 s50, s42, 1
s_min_u32 s50, s50, 63
s_lshl_b32 s50, s50, 16
ds_read_b128 v[20:23], v8 offset:0
ds_read_b128 v[24:27], v8 offset:2048
ds_read_b128 v[28:31], v9 offset:0
ds_read_b128 v[32:35], v9 offset:2048
ds_read_b128 v[36:39], v8 offset:4096
ds_read_b128 v[40:43], v8 offset:6144
s_waitcnt lgkmcnt(4)
v_mfma_f32_16x16x32_bf16 v[52:55], v[20:23], a[0:3], 0
ds_read_b128 v[44:47], v9 offset:4096
v_mfma_f32_16x16x32_bf16 v[56:59], v[20:23], a[4:7], 0
v_cvt_pk_bf16_f32 v84, v68, v69
v_cvt_pk_bf16_f32 v85, v70, v71
v_cvt_pk_bf16_f32 v86, v76, v77
v_mfma_f32_16x16x32_bf16 v[60:63], v[24:27], a[0:3], 0
ds_read_b128 v[48:51], v9 offset:6144
v_mfma_f32_16x16x32_bf16 v[64:67], v[24:27], a[4:7], 0
v_cvt_pk_bf16_f32 v87, v78, v79
v_cvt_pk_bf16_f32 v88, v72, v73
v_cvt_pk_bf16_f32 v89, v74, v75
s_waitcnt lgkmcnt(4)
v_mfma_f32_16x16x32_bf16 v[52:55], v[28:31], a[8:11], v[52:55]
ds_read_b128 v[20:23], v8 offset:8192
v_mfma_f32_16x16x32_bf16 v[56:59], v[28:31], a[12:15], v[56:59]
v_cvt_pk_bf16_f32 v90, v80, v81
v_cvt_pk_bf16_f32 v91, v82, v83
v_mfma_f32_16x16x32_bf16 v[60:63], v[32:35], a[8:11], v[60:63]
ds_read_b128 v[24:27], v8 offset:10240
v_mfma_f32_16x16x32_bf16 v[64:67], v[32:35], a[12:15], v[64:67]
s_add_u32 s51, s42, s47
s_sub_u32 s51, s51, 1
s_bfe_u32 s52, s51, 0x40002
s_lshl_b32 s52, s52, 14
s_waitcnt lgkmcnt(4)
v_mfma_f32_16x16x32_bf16 v[52:55], v[36:39], a[16:19], v[52:55]
ds_read_b128 v[28:31], v9 offset:8192
v_mfma_f32_16x16x32_bf16 v[56:59], v[36:39], a[20:23], v[56:59]
s_and_b32 s51, s51, 3
s_lshl_b32 s51, s51, 11
s_add_u32 s51, s51, s52
s_add_u32 s51, s51, s48
buffer_store_dwordx4 v[84:87], v7, s[84:87], s51 offen sc1
v_mfma_f32_16x16x32_bf16 v[60:63], v[40:43], a[16:19], v[60:63]
ds_read_b128 v[32:35], v9 offset:10240
v_mfma_f32_16x16x32_bf16 v[64:67], v[40:43], a[20:23], v[64:67]
buffer_store_dwordx4 v[88:91], v7, s[84:87], s51 offen offset:1024 sc1
s_waitcnt lgkmcnt(4)
v_mfma_f32_16x16x32_bf16 v[52:55], v[44:47], a[24:27], v[52:55]
ds_read_b128 v[36:39], v8 offset:12288
v_mfma_f32_16x16x32_bf16 v[56:59], v[44:47], a[28:31], v[56:59]
s_add_u32 m0, s46, 65536
v_mfma_f32_16x16x32_bf16 v[60:63], v[48:51], a[24:27], v[60:63]
ds_read_b128 v[40:43], v8 offset:14336
v_mfma_f32_16x16x32_bf16 v[64:67], v[48:51], a[28:31], v[64:67]
buffer_load_dwordx4 v6, s[8:11], s50 offen offset:0 lds
s_waitcnt lgkmcnt(4)
v_mfma_f32_16x16x32_bf16 v[52:55], v[20:23], a[32:35], v[52:55]
ds_read_b128 v[44:47], v9 offset:12288
v_mfma_f32_16x16x32_bf16 v[56:59], v[20:23], a[36:39], v[56:59]
s_add_u32 m0, s46, 69504
v_mfma_f32_16x16x32_bf16 v[60:63], v[24:27], a[32:35], v[60:63]
ds_read_b128 v[48:51], v9 offset:14336
v_mfma_f32_16x16x32_bf16 v[64:67], v[24:27], a[36:39], v[64:67]
buffer_load_dwordx4 v6, s[8:11], s50 offen offset:128 lds
s_waitcnt lgkmcnt(4)
v_mfma_f32_16x16x32_bf16 v[52:55], v[28:31], a[40:43], v[52:55]
ds_read_b128 v[20:23], v8 offset:16384
v_mfma_f32_16x16x32_bf16 v[56:59], v[28:31], a[44:47], v[56:59]
s_add_u32 m0, s46, 73472
v_mfma_f32_16x16x32_bf16 v[60:63], v[32:35], a[40:43], v[60:63]
ds_read_b128 v[24:27], v8 offset:18432
v_mfma_f32_16x16x32_bf16 v[64:67], v[32:35], a[44:47], v[64:67]
buffer_load_dwordx4 v6, s[8:11], s50 offen offset:256 lds
s_waitcnt lgkmcnt(4)
v_mfma_f32_16x16x32_bf16 v[52:55], v[36:39], a[48:51], v[52:55]
ds_read_b128 v[28:31], v9 offset:16384
v_mfma_f32_16x16x32_bf16 v[56:59], v[36:39], a[52:55], v[56:59]
s_add_u32 m0, s46, 77440
v_mfma_f32_16x16x32_bf16 v[60:63], v[40:43], a[48:51], v[60:63]
ds_read_b128 v[32:35], v9 offset:18432
v_mfma_f32_16x16x32_bf16 v[64:67], v[40:43], a[52:55], v[64:67]
buffer_load_dwordx4 v6, s[8:11], s50 offen offset:384 lds
s_waitcnt lgkmcnt(4)
v_mfma_f32_16x16x32_bf16 v[52:55], v[44:47], a[56:59], v[52:55]
ds_read_b128 v[36:39], v8 offset:20480
v_mfma_f32_16x16x32_bf16 v[56:59], v[44:47], a[60:63], v[56:59]
s_add_u32 m0, s46, 81408
v_mfma_f32_16x16x32_bf16 v[60:63], v[48:51], a[56:59], v[60:63]
ds_read_b128 v[40:43], v8 offset:22528
v_mfma_f32_16x16x32_bf16 v[64:67], v[48:51], a[60:63], v[64:67]
buffer_load_dwordx4 v6, s[8:11], s50 offen offset:512 lds
s_waitcnt lgkmcnt(4)
v_mfma_f32_16x16x32_bf16 v[52:55], v[20:23], a[64:67], v[52:55]
ds_read_b128 v[44:47], v9 offset:20480
v_mfma_f32_16x16x32_bf16 v[56:59], v[20:23], a[68:71], v[56:59]
s_add_u32 m0, s46, 85376
v_mfma_f32_16x16x32_bf16 v[60:63], v[24:27], a[64:67], v[60:63]
ds_read_b128 v[48:51], v9 offset:22528
v_mfma_f32_16x16x32_bf16 v[64:67], v[24:27], a[68:71], v[64:67]
buffer_load_dwordx4 v6, s[8:11], s50 offen offset:640 lds
s_waitcnt lgkmcnt(4)
v_mfma_f32_16x16x32_bf16 v[52:55], v[28:31], a[72:75], v[52:55]
ds_read_b128 v[20:23], v8 offset:24576
v_mfma_f32_16x16x32_bf16 v[56:59], v[28:31], a[76:79], v[56:59]
s_add_u32 m0, s46, 89344
v_mfma_f32_16x16x32_bf16 v[60:63], v[32:35], a[72:75], v[60:63]
ds_read_b128 v[24:27], v8 offset:26624
v_mfma_f32_16x16x32_bf16 v[64:67], v[32:35], a[76:79], v[64:67]
buffer_load_dwordx4 v6, s[8:11], s50 offen offset:768 lds
s_waitcnt lgkmcnt(4)
v_mfma_f32_16x16x32_bf16 v[52:55], v[36:39], a[80:83], v[52:55]
ds_read_b128 v[28:31], v9 offset:24576
v_mfma_f32_16x16x32_bf16 v[56:59], v[36:39], a[84:87], v[56:59]
s_add_u32 m0, s46, 93312
v_mfma_f32_16x16x32_bf16 v[60:63], v[40:43], a[80:83], v[60:63]
ds_read_b128 v[32:35], v9 offset:26624
v_mfma_f32_16x16x32_bf16 v[64:67], v[40:43], a[84:87], v[64:67]
buffer_load_dwordx4 v6, s[8:11], s50 offen offset:896 lds
s_waitcnt lgkmcnt(4)
v_mfma_f32_16x16x32_bf16 v[52:55], v[44:47], a[88:91], v[52:55]
ds_read_b128 v[36:39], v8 offset:28672
v_mfma_f32_16x16x32_bf16 v[56:59], v[44:47], a[92:95], v[56:59]
s_add_u32 m0, s46, 97280
v_mfma_f32_16x16x32_bf16 v[60:63], v[48:51], a[88:91], v[60:63]
ds_read_b128 v[40:43], v8 offset:30720
v_mfma_f32_16x16x32_bf16 v[64:67], v[48:51], a[92:95], v[64:67]
buffer_load_dwordx4 v6, s[8:11], s50 offen offset:1024 lds
s_waitcnt lgkmcnt(4)
v_mfma_f32_16x16x32_bf16 v[52:55], v[20:23], a[96:99], v[52:55]
ds_read_b128 v[44:47], v9 offset:28672
v_mfma_f32_16x16x32_bf16 v[56:59], v[20:23], a[100:103], v[56:59]
s_add_u32 m0, s46, 101248
v_mfma_f32_16x16x32_bf16 v[60:63], v[24:27], a[96:99], v[60:63]
ds_read_b128 v[48:51], v9 offset:30720
v_mfma_f32_16x16x32_bf16 v[64:67], v[24:27], a[100:103], v[64:67]
buffer_load_dwordx4 v6, s[8:11], s50 offen offset:1152 lds
s_waitcnt lgkmcnt(4)
v_mfma_f32_16x16x32_bf16 v[52:55], v[28:31], a[104:107], v[52:55]
ds_read_b128 v[20:23], v8 offset:32768
v_mfma_f32_16x16x32_bf16 v[56:59], v[28:31], a[108:111], v[56:59]
s_add_u32 m0, s46, 105216
v_mfma_f32_16x16x32_bf16 v[60:63], v[32:35], a[104:107], v[60:63]
ds_read_b128 v[24:27], v8 offset:34816
v_mfma_f32_16x16x32_bf16 v[64:67], v[32:35], a[108:111], v[64:67]
buffer_load_dwordx4 v6, s[8:11], s50 offen offset:1280 lds
s_waitcnt lgkmcnt(4)
v_mfma_f32_16x16x32_bf16 v[52:55], v[36:39], a[112:115], v[52:55]
ds_read_b128 v[28:31], v9 offset:32768
v_mfma_f32_16x16x32_bf16 v[56:59], v[36:39], a[116:119], v[56:59]
s_add_u32 m0, s46, 109184
v_mfma_f32_16x16x32_bf16 v[60:63], v[40:43], a[112:115], v[60:63]
ds_read_b128 v[32:35], v9 offset:34816
v_mfma_f32_16x16x32_bf16 v[64:67], v[40:43], a[116:119], v[64:67]
buffer_load_dwordx4 v6, s[8:11], s50 offen offset:1408 lds
s_waitcnt lgkmcnt(4)
v_mfma_f32_16x16x32_bf16 v[52:55], v[44:47], a[120:123], v[52:55]
ds_read_b128 v[36:39], v8 offset:36864
v_mfma_f32_16x16x32_bf16 v[56:59], v[44:47], a[124:127], v[56:59]
s_add_u32 m0, s46, 113152
v_mfma_f32_16x16x32_bf16 v[60:63], v[48:51], a[120:123], v[60:63]
ds_read_b128 v[40:43], v8 offset:38912
v_mfma_f32_16x16x32_bf16 v[64:67], v[48:51], a[124:127], v[64:67]
buffer_load_dwordx4 v6, s[8:11], s50 offen offset:1536 lds
s_waitcnt lgkmcnt(4)
v_mfma_f32_16x16x32_bf16 v[52:55], v[20:23], a[128:131], v[52:55]
ds_read_b128 v[44:47], v9 offset:36864
v_mfma_f32_16x16x32_bf16 v[56:59], v[20:23], a[132:135], v[56:59]
s_add_u32 m0, s46, 117120
v_mfma_f32_16x16x32_bf16 v[60:63], v[24:27], a[128:131], v[60:63]
ds_read_b128 v[48:51], v9 offset:38912
v_mfma_f32_16x16x32_bf16 v[64:67], v[24:27], a[132:135], v[64:67]
buffer_load_dwordx4 v6, s[8:11], s50 offen offset:1664 lds
s_waitcnt lgkmcnt(4)
v_mfma_f32_16x16x32_bf16 v[52:55], v[28:31], a[136:139], v[52:55]
ds_read_b128 v[20:23], v8 offset:40960
v_mfma_f32_16x16x32_bf16 v[56:59], v[28:31], a[140:143], v[56:59]
s_add_u32 m0, s46, 121088
v_mfma_f32_16x16x32_bf16 v[60:63], v[32:35], a[136:139], v[60:63]
ds_read_b128 v[24:27], v8 offset:43008
v_mfma_f32_16x16x32_bf16 v[64:67], v[32:35], a[140:143], v[64:67]
buffer_load_dwordx4 v6, s[8:11], s50 offen offset:1792 lds
s_waitcnt lgkmcnt(4)
v_mfma_f32_16x16x32_bf16 v[52:55], v[36:39], a[144:147], v[52:55]
ds_read_b128 v[28:31], v9 offset:40960
v_mfma_f32_16x16x32_bf16 v[56:59], v[36:39], a[148:151], v[56:59]
s_add_u32 m0, s46, 125056
v_mfma_f32_16x16x32_bf16 v[60:63], v[40:43], a[144:147], v[60:63]
ds_read_b128 v[32:35], v9 offset:43008
v_mfma_f32_16x16x32_bf16 v[64:67], v[40:43], a[148:151], v[64:67]
buffer_load_dwordx4 v6, s[8:11], s50 offen offset:1920 lds
s_waitcnt lgkmcnt(4)
v_mfma_f32_16x16x32_bf16 v[52:55], v[44:47], a[152:155], v[52:55]
ds_read_b128 v[36:39], v8 offset:45056
v_mfma_f32_16x16x32_bf16 v[56:59], v[44:47], a[156:159], v[56:59]
v_mfma_f32_16x16x32_bf16 v[60:63], v[48:51], a[152:155], v[60:63]
ds_read_b128 v[40:43], v8 offset:47104
v_mfma_f32_16x16x32_bf16 v[64:67], v[48:51], a[156:159], v[64:67]
s_waitcnt lgkmcnt(4)
v_mfma_f32_16x16x32_bf16 v[52:55], v[20:23], a[160:163], v[52:55]
ds_read_b128 v[44:47], v9 offset:45056
v_mfma_f32_16x16x32_bf16 v[56:59], v[20:23], a[164:167], v[56:59]
v_mfma_f32_16x16x32_bf16 v[60:63], v[24:27], a[160:163], v[60:63]
ds_read_b128 v[48:51], v9 offset:47104
v_mfma_f32_16x16x32_bf16 v[64:67], v[24:27], a[164:167], v[64:67]
s_waitcnt lgkmcnt(4)
v_mfma_f32_16x16x32_bf16 v[52:55], v[28:31], a[168:171], v[52:55]
ds_read_b128 v[20:23], v8 offset:49152
v_mfma_f32_16x16x32_bf16 v[56:59], v[28:31], a[172:175], v[56:59]
s_waitcnt vmcnt(16)
v_mov_b32 v17, s42
s_mov_b64 exec, 1
buffer_store_dword v17, v16, s[84:87], s49 offen sc1
s_mov_b64 exec, -1
v_mfma_f32_16x16x32_bf16 v[60:63], v[32:35], a[168:171], v[60:63]
ds_read_b128 v[24:27], v8 offset:51200
v_mfma_f32_16x16x32_bf16 v[64:67], v[32:35], a[172:175], v[64:67]
s_waitcnt lgkmcnt(4)
v_mfma_f32_16x16x32_bf16 v[52:55], v[36:39], a[176:179], v[52:55]
ds_read_b128 v[28:31], v9 offset:49152
v_mfma_f32_16x16x32_bf16 v[56:59], v[36:39], a[180:183], v[56:59]
s_add_u32 s53, s42, 3
s_min_u32 s53, s53, 63
s_lshl_b32 s53, s53, 16
s_mov_b64 exec, 0xffff
buffer_load_dword v18, v19, s[8:11], s53 offen
s_mov_b64 exec, -1
v_mfma_f32_16x16x32_bf16 v[60:63], v[40:43], a[176:179], v[60:63]
ds_read_b128 v[32:35], v9 offset:51200
v_mfma_f32_16x16x32_bf16 v[64:67], v[40:43], a[180:183], v[64:67]
s_waitcnt lgkmcnt(4)
v_mfma_f32_16x16x32_bf16 v[52:55], v[44:47], a[184:187], v[52:55]
ds_read_b128 v[36:39], v8 offset:53248
v_mfma_f32_16x16x32_bf16 v[56:59], v[44:47], a[188:191], v[56:59]
v_mfma_f32_16x16x32_bf16 v[60:63], v[48:51], a[184:187], v[60:63]
ds_read_b128 v[40:43], v8 offset:55296
v_mfma_f32_16x16x32_bf16 v[64:67], v[48:51], a[188:191], v[64:67]
s_waitcnt lgkmcnt(4)
v_mfma_f32_16x16x32_bf16 v[52:55], v[20:23], a[192:195], v[52:55]
ds_read_b128 v[44:47], v9 offset:53248
v_mfma_f32_16x16x32_bf16 v[56:59], v[20:23], a[196:199], v[56:59]
v_mfma_f32_16x16x32_bf16 v[60:63], v[24:27], a[192:195], v[60:63]
ds_read_b128 v[48:51], v9 offset:55296
v_mfma_f32_16x16x32_bf16 v[64:67], v[24:27], a[196:199], v[64:67]
s_waitcnt lgkmcnt(4)
v_mfma_f32_16x16x32_bf16 v[52:55], v[28:31], a[200:203], v[52:55]
ds_read_b128 v[20:23], v8 offset:57344
v_mfma_f32_16x16x32_bf16 v[56:59], v[28:31], a[204:207], v[56:59]
v_mfma_f32_16x16x32_bf16 v[60:63], v[32:35], a[200:203], v[60:63]
ds_read_b128 v[24:27], v8 offset:59392
v_mfma_f32_16x16x32_bf16 v[64:67], v[32:35], a[204:207], v[64:67]
s_waitcnt lgkmcnt(4)
v_mfma_f32_16x16x32_bf16 v[52:55], v[36:39], a[208:211], v[52:55]
ds_read_b128 v[28:31], v9 offset:57344
v_mfma_f32_16x16x32_bf16 v[56:59], v[36:39], a[212:215], v[56:59]
v_mfma_f32_16x16x32_bf16 v[60:63], v[40:43], a[208:211], v[60:63]
ds_read_b128 v[32:35], v9 offset:59392
v_mfma_f32_16x16x32_bf16 v[64:67], v[40:43], a[212:215], v[64:67]
s_waitcnt lgkmcnt(4)
v_mfma_f32_16x16x32_bf16 v[52:55], v[44:47], a[216:219], v[52:55]
ds_read_b128 v[36:39], v8 offset:61440
v_mfma_f32_16x16x32_bf16 v[56:59], v[44:47], a[220:223], v[56:59]
v_mfma_f32_16x16x32_bf16 v[60:63], v[48:51], a[216:219], v[60:63]
ds_read_b128 v[40:43], v8 offset:63488
v_mfma_f32_16x16x32_bf16 v[64:67], v[48:51], a[220:223], v[64:67]
s_waitcnt lgkmcnt(4)
v_mfma_f32_16x16x32_bf16 v[52:55], v[20:23], a[224:227], v[52:55]
ds_read_b128 v[44:47], v9 offset:61440
v_mfma_f32_16x16x32_bf16 v[56:59], v[20:23], a[228:231], v[56:59]
v_mfma_f32_16x16x32_bf16 v[60:63], v[24:27], a[224:227], v[60:63]
ds_read_b128 v[48:51], v9 offset:63488
v_mfma_f32_16x16x32_bf16 v[64:67], v[24:27], a[228:231], v[64:67]
s_waitcnt lgkmcnt(5)
v_mfma_f32_16x16x32_bf16 v[52:55], v[28:31], a[232:235], v[52:55]
v_mfma_f32_16x16x32_bf16 v[56:59], v[28:31], a[236:239], v[56:59]
s_waitcnt lgkmcnt(4)
v_mfma_f32_16x16x32_bf16 v[60:63], v[32:35], a[232:235], v[60:63]
v_mfma_f32_16x16x32_bf16 v[64:67], v[32:35], a[236:239], v[64:67]
s_waitcnt lgkmcnt(3)
v_mfma_f32_16x16x32_bf16 v[52:55], v[36:39], a[240:243], v[52:55]
v_mfma_f32_16x16x32_bf16 v[56:59], v[36:39], a[244:247], v[56:59]
s_waitcnt lgkmcnt(2)
v_mfma_f32_16x16x32_bf16 v[60:63], v[40:43], a[240:243], v[60:63]
v_mfma_f32_16x16x32_bf16 v[64:67], v[40:43], a[244:247], v[64:67]
s_waitcnt lgkmcnt(1)
v_mfma_f32_16x16x32_bf16 v[52:55], v[44:47], a[248:251], v[52:55]
v_mfma_f32_16x16x32_bf16 v[56:59], v[44:47], a[252:255], v[56:59]
s_waitcnt lgkmcnt(0)
v_mfma_f32_16x16x32_bf16 v[60:63], v[48:51], a[248:251], v[60:63]
v_mfma_f32_16x16x32_bf16 v[64:67], v[48:51], a[252:255], v[64:67]
s_add_u32 s42, s42, 1
s_branch mega_kernel_v_loop
mega_kernel_v_fin:
s_nop 11
v_cvt_pk_bf16_f32 v84, v68, v69
v_cvt_pk_bf16_f32 v85, v70, v71
v_cvt_pk_bf16_f32 v86, v76, v77
v_cvt_pk_bf16_f32 v87, v78, v79
v_cvt_pk_bf16_f32 v88, v72, v73
v_cvt_pk_bf16_f32 v89, v74, v75
v_cvt_pk_bf16_f32 v90, v80, v81
v_cvt_pk_bf16_f32 v91, v82, v83
s_add_u32 s51, s42, s47
s_sub_u32 s51, s51, 1
s_bfe_u32 s52, s51, 0x40002
s_lshl_b32 s52, s52, 14
s_and_b32 s51, s51, 3
s_lshl_b32 s51, s51, 11
s_add_u32 s51, s51, s52
s_add_u32 s51, s51, s48
buffer_store_dwordx4 v[84:87], v7, s[84:87], s51 offen sc1
buffer_store_dwordx4 v[88:91], v7, s[84:87], s51 offen offset:1024 sc1
s_waitcnt vmcnt(0)
v_mov_b32 v17, s42
s_mov_b64 exec, 1
buffer_store_dword v17, v16, s[84:87], s49 offen sc1
s_mov_b64 exec, -1
s_waitcnt vmcnt(0)
s_barrier
mega_kernel_fft:
s_mov_b32 s38, s92
s_mov_b32 s39, 64
s_mov_b32 s37, 128
mega_kernel_f2s:
v_mov_b32 v1, 0
s_mov_b32 s82, 69259264
mega_kernel_w0:
s_sleep 8
buffer_load_dword v2, v1, s[84:87], s82 offen sc1
s_waitcnt vmcnt(0)
v_cmp_ne_u32 vcc, 31, v2
s_cbranch_vccnz mega_kernel_w0
s_mov_b32 s48, 0x3f7ec46d
s_mov_b32 s49, 0x3dc8bd36
s_mov_b32 s50, 0x3f7b14be
s_mov_b32 s51, 0x3e47c5c2
s_mov_b32 s52, 0x3f74fa0b
s_mov_b32 s53, 0x3e94a031
s_mov_b32 s54, 0x3f6c835e
s_mov_b32 s55, 0x3ec3ef15
s_mov_b32 s56, 0x3f61c598
s_mov_b32 s57, 0x3ef15aea
s_mov_b32 s58, 0x3f54db31
s_mov_b32 s59, 0x3f0e39da
s_mov_b32 s60, 0x3f45e403
s_mov_b32 s61, 0x3f226799
s_mov_b32 s62, 0x3f3504f3
s_mov_b32 s63, 0x3f3504f3
v_lshrrev_b32 v10, 6, v0
v_and_b32 v1, 63, v0
v_readfirstlane_b32 s16, v10
v_cvt_f32_u32 v2, v1
v_lshlrev_b32 v5, 3, v1
s_mul_i32 s17, s16, 16896
v_add_u32 v3, s17, v5
v_and_b32 v7, 1, v1
v_lshrrev_b32 v6, 1, v1
v_cvt_f32_u32 v8, v6
v_cvt_f32_u32 v10, v7
v_mul_u32_u24 v4, 528, v6
v_lshl_add_u32 v4, v7, 3, v4
v_add_u32 v4, s17, v4
v_lshlrev_b32 v11, 12, v7
v_lshl_add_u32 v11, v6, 2, v11
v_fma_f32 v9, v10, 2.0, -1.0
v_sub_f32 v7, 0, v9
v_mul_f32 v13, v10, v8
v_mul_f32 v13, 0x3a000000, v13
s_mov_b32 s18, 0xaaaaaaaa
s_mov_b32 s19, 0xaaaaaaaa
v_mul_f32 v12, 0xba000000, v2
v_cos_f32 v82, v12
v_sin_f32 v83, v12
v_mul_f32 v12, 0xba800000, v2
v_cos_f32 v84, v12
v_sin_f32 v85, v12
v_mul_f32 v12, 0xbac00000, v2
v_cos_f32 v86, v12
v_sin_f32 v87, v12
v_mul_f32 v12, 0xbb000000, v2
v_cos_f32 v88, v12
v_sin_f32 v89, v12
v_mul_f32 v12, 0xbb200000, v2
v_cos_f32 v90, v12
v_sin_f32 v91, v12
v_mul_f32 v12, 0xbb400000, v2
v_cos_f32 v92, v12
v_sin_f32 v93, v12
v_mul_f32 v12, 0xbb600000, v2
v_cos_f32 v94, v12
v_sin_f32 v95, v12
v_mul_f32 v12, 0xbb800000, v2
v_cos_f32 v96, v12
v_sin_f32 v97, v12
v_mul_f32 v12, 0xbb900000, v2
v_cos_f32 v98, v12
v_sin_f32 v99, v12
v_mul_f32 v12, 0xbba00000, v2
v_cos_f32 v100, v12
v_sin_f32 v101, v12
v_mul_f32 v12, 0xbbb00000, v2
v_cos_f32 v102, v12
v_sin_f32 v103, v12
v_mul_f32 v12, 0xbbc00000, v2
v_cos_f32 v104, v12
v_sin_f32 v105, v12
v_mul_f32 v12, 0xbbd00000, v2
v_cos_f32 v106, v12
v_sin_f32 v107, v12
v_mul_f32 v12, 0xbbe00000, v2
v_cos_f32 v108, v12
v_sin_f32 v109, v12
v_mul_f32 v12, 0xbbf00000, v2
v_cos_f32 v110, v12
v_sin_f32 v111, v12
v_mul_f32 v12, 0xbc000000, v2
v_cos_f32 v112, v12
v_sin_f32 v113, v12
v_mul_f32 v12, 0xbc080000, v2
v_cos_f32 v114, v12
v_sin_f32 v115, v12
v_mul_f32 v12, 0xbc100000, v2
v_cos_f32 v116, v12
v_sin_f32 v117, v12
v_mul_f32 v12, 0xbc180000, v2
v_cos_f32 v118, v12
v_sin_f32 v119, v12
v_mul_f32 v12, 0xbc200000, v2
v_cos_f32 v120, v12
v_sin_f32 v121, v12
v_mul_f32 v12, 0xbc280000, v2
v_cos_f32 v122, v12
v_sin_f32 v123, v12
v_mul_f32 v12, 0xbc300000, v2
v_cos_f32 v124, v12
v_sin_f32 v125, v12
v_mul_f32 v12, 0xbc380000, v2
v_cos_f32 v126, v12
v_sin_f32 v127, v12
v_mul_f32 v12, 0xbc400000, v2
v_cos_f32 v128, v12
v_sin_f32 v129, v12
v_mul_f32 v12, 0xbc480000, v2
v_cos_f32 v130, v12
v_sin_f32 v131, v12
v_mul_f32 v12, 0xbc500000, v2
v_cos_f32 v132, v12
v_sin_f32 v133, v12
v_mul_f32 v12, 0xbc580000, v2
v_cos_f32 v134, v12
v_sin_f32 v135, v12
v_mul_f32 v12, 0xbc600000, v2
v_cos_f32 v136, v12
v_sin_f32 v137, v12
v_mul_f32 v12, 0xbc680000, v2
v_cos_f32 v138, v12
v_sin_f32 v139, v12
v_mul_f32 v12, 0xbc700000, v2
v_cos_f32 v140, v12
v_sin_f32 v141, v12
v_mul_f32 v12, 0xbc780000, v2
v_cos_f32 v142, v12
v_sin_f32 v143, v12
v_mov_b32 v12, v13
v_fmac_f32 v12, 0x00000000, v8
v_cos_f32 v144, v12
v_sin_f32 v145, v12
v_mov_b32 v12, v13
v_fmac_f32 v12, 0x3a800000, v8
v_cos_f32 v146, v12
v_sin_f32 v147, v12
v_mov_b32 v12, v13
v_fmac_f32 v12, 0x3b000000, v8
v_cos_f32 v148, v12
v_sin_f32 v149, v12
v_mov_b32 v12, v13
v_fmac_f32 v12, 0x3b400000, v8
v_cos_f32 v150, v12
v_sin_f32 v151, v12
v_mov_b32 v12, v13
v_fmac_f32 v12, 0x3b800000, v8
v_cos_f32 v152, v12
v_sin_f32 v153, v12
v_mov_b32 v12, v13
v_fmac_f32 v12, 0x3ba00000, v8
v_cos_f32 v154, v12
v_sin_f32 v155, v12
v_mov_b32 v12, v13
v_fmac_f32 v12, 0x3bc00000, v8
v_cos_f32 v156, v12
v_sin_f32 v157, v12
v_mov_b32 v12, v13
v_fmac_f32 v12, 0x3be00000, v8
v_cos_f32 v158, v12
v_sin_f32 v159, v12
v_mov_b32 v12, v13
v_fmac_f32 v12, 0x3c000000, v8
v_cos_f32 v160, v12
v_sin_f32 v161, v12
v_mov_b32 v12, v13
v_fmac_f32 v12, 0x3c100000, v8
v_cos_f32 v162, v12
v_sin_f32 v163, v12
v_mov_b32 v12, v13
v_fmac_f32 v12, 0x3c200000, v8
v_cos_f32 v164, v12
v_sin_f32 v165, v12
v_mov_b32 v12, v13
v_fmac_f32 v12, 0x3c300000, v8
v_cos_f32 v166, v12
v_sin_f32 v167, v12
v_mov_b32 v12, v13
v_fmac_f32 v12, 0x3c400000, v8
v_cos_f32 v168, v12
v_sin_f32 v169, v12
v_mov_b32 v12, v13
v_fmac_f32 v12, 0x3c500000, v8
v_cos_f32 v170, v12
v_sin_f32 v171, v12
v_mov_b32 v12, v13
v_fmac_f32 v12, 0x3c600000, v8
v_cos_f32 v172, v12
v_sin_f32 v173, v12
v_mov_b32 v12, v13
v_fmac_f32 v12, 0x3c700000, v8
v_cos_f32 v174, v12
v_sin_f32 v175, v12
v_mov_b32 v12, v13
v_fmac_f32 v12, 0x3c800000, v8
v_cos_f32 v176, v12
v_sin_f32 v177, v12
v_mov_b32 v12, v13
v_fmac_f32 v12, 0x3c880000, v8
v_cos_f32 v178, v12
v_sin_f32 v179, v12
v_mov_b32 v12, v13
v_fmac_f32 v12, 0x3c900000, v8
v_cos_f32 v180, v12
v_sin_f32 v181, v12
v_mov_b32 v12, v13
v_fmac_f32 v12, 0x3c980000, v8
v_cos_f32 v182, v12
v_sin_f32 v183, v12
v_mov_b32 v12, v13
v_fmac_f32 v12, 0x3ca00000, v8
v_cos_f32 v184, v12
v_sin_f32 v185, v12
v_mov_b32 v12, v13
v_fmac_f32 v12, 0x3ca80000, v8
v_cos_f32 v186, v12
v_sin_f32 v187, v12
v_mov_b32 v12, v13
v_fmac_f32 v12, 0x3cb00000, v8
v_cos_f32 v188, v12
v_sin_f32 v189, v12
v_mov_b32 v12, v13
v_fmac_f32 v12, 0x3cb80000, v8
v_cos_f32 v190, v12
v_sin_f32 v191, v12
v_mov_b32 v12, v13
v_fmac_f32 v12, 0x3cc00000, v8
v_cos_f32 v192, v12
v_sin_f32 v193, v12
v_mov_b32 v12, v13
v_fmac_f32 v12, 0x3cc80000, v8
v_cos_f32 v194, v12
v_sin_f32 v195, v12
v_mov_b32 v12, v13
v_fmac_f32 v12, 0x3cd00000, v8
v_cos_f32 v196, v12
v_sin_f32 v197, v12
v_mov_b32 v12, v13
v_fmac_f32 v12, 0x3cd80000, v8
v_cos_f32 v198, v12
v_sin_f32 v199, v12
v_mov_b32 v12, v13
v_fmac_f32 v12, 0x3ce00000, v8
v_cos_f32 v200, v12
v_sin_f32 v201, v12
v_mov_b32 v12, v13
v_fmac_f32 v12, 0x3ce80000, v8
v_cos_f32 v202, v12
v_sin_f32 v203, v12
v_mov_b32 v12, v13
v_fmac_f32 v12, 0x3cf00000, v8
v_cos_f32 v204, v12
v_sin_f32 v205, v12
v_mov_b32 v12, v13
v_fmac_f32 v12, 0x3cf80000, v8
v_cos_f32 v206, v12
v_sin_f32 v207, v12
s_nop 0
v_mul_f32 v144, 0x34800000, v144
v_mul_f32 v145, 0x34800000, v145
v_mul_f32 v146, 0x34800000, v146
v_mul_f32 v147, 0x34800000, v147
v_mul_f32 v148, 0x34800000, v148
v_mul_f32 v149, 0x34800000, v149
v_mul_f32 v150, 0x34800000, v150
v_mul_f32 v151, 0x34800000, v151
v_mul_f32 v152, 0x34800000, v152
v_mul_f32 v153, 0x34800000, v153
v_mul_f32 v154, 0x34800000, v154
v_mul_f32 v155, 0x34800000, v155
v_mul_f32 v156, 0x34800000, v156
v_mul_f32 v157, 0x34800000, v157
v_mul_f32 v158, 0x34800000, v158
v_mul_f32 v159, 0x34800000, v159
v_mul_f32 v160, 0x34800000, v160
v_mul_f32 v161, 0x34800000, v161
v_mul_f32 v162, 0x34800000, v162
v_mul_f32 v163, 0x34800000, v163
v_mul_f32 v164, 0x34800000, v164
v_mul_f32 v165, 0x34800000, v165
v_mul_f32 v166, 0x34800000, v166
v_mul_f32 v167, 0x34800000, v167
v_mul_f32 v168, 0x34800000, v168
v_mul_f32 v169, 0x34800000, v169
v_mul_f32 v170, 0x34800000, v170
v_mul_f32 v171, 0x34800000, v171
v_mul_f32 v172, 0x34800000, v172
v_mul_f32 v173, 0x34800000, v173
v_mul_f32 v174, 0x34800000, v174
v_mul_f32 v175, 0x34800000, v175
v_mul_f32 v176, 0x34800000, v176
v_mul_f32 v177, 0x34800000, v177
v_mul_f32 v178, 0x34800000, v178
v_mul_f32 v179, 0x34800000, v179
v_mul_f32 v180, 0x34800000, v180
v_mul_f32 v181, 0x34800000, v181
v_mul_f32 v182, 0x34800000, v182
v_mul_f32 v183, 0x34800000, v183
v_mul_f32 v184, 0x34800000, v184
v_mul_f32 v185, 0x34800000, v185
v_mul_f32 v186, 0x34800000, v186
v_mul_f32 v187, 0x34800000, v187
v_mul_f32 v188, 0x34800000, v188
v_mul_f32 v189, 0x34800000, v189
v_mul_f32 v190, 0x34800000, v190
v_mul_f32 v191, 0x34800000, v191
v_mul_f32 v192, 0x34800000, v192
v_mul_f32 v193, 0x34800000, v193
v_mul_f32 v194, 0x34800000, v194
v_mul_f32 v195, 0x34800000, v195
v_mul_f32 v196, 0x34800000, v196
v_mul_f32 v197, 0x34800000, v197
v_mul_f32 v198, 0x34800000, v198
v_mul_f32 v199, 0x34800000, v199
v_mul_f32 v200, 0x34800000, v200
v_mul_f32 v201, 0x34800000, v201
v_mul_f32 v202, 0x34800000, v202
v_mul_f32 v203, 0x34800000, v203
v_mul_f32 v204, 0x34800000, v204
v_mul_f32 v205, 0x34800000, v205
v_mul_f32 v206, 0x34800000, v206
v_mul_f32 v207, 0x34800000, v207
s_cmp_lt_u32 s38, s37
s_cbranch_scc0 mega_kernel_f2_e
s_lshl_b32 s12, s38, 2
s_add_u32 s12, s12, s16
s_min_u32 s12, s12, 512
s_lshl_b32 s13, s12, 13
s_lshl_b32 s12, s12, 14
s_add_u32 s12, s12, 96468992
s_add_u32 s13, s13, 121634816
buffer_load_dwordx2 a[0:1], v5, s[84:87], s12 offen offset:0 sc1
buffer_load_dwordx2 a[2:3], v5, s[84:87], s12 offen offset:512 sc1
buffer_load_dwordx2 a[4:5], v5, s[84:87], s12 offen offset:1024 sc1
buffer_load_dwordx2 a[6:7], v5, s[84:87], s12 offen offset:1536 sc1
buffer_load_dwordx2 a[8:9], v5, s[84:87], s12 offen offset:2048 sc1
buffer_load_dwordx2 a[10:11], v5, s[84:87], s12 offen offset:2560 sc1
buffer_load_dwordx2 a[12:13], v5, s[84:87], s12 offen offset:3072 sc1
buffer_load_dwordx2 a[14:15], v5, s[84:87], s12 offen offset:3584 sc1
s_add_u32 s12, s12, 4096
buffer_load_dwordx2 a[16:17], v5, s[84:87], s12 offen offset:0 sc1
buffer_load_dwordx2 a[18:19], v5, s[84:87], s12 offen offset:512 sc1
buffer_load_dwordx2 a[20:21], v5, s[84:87], s12 offen offset:1024 sc1
buffer_load_dwordx2 a[22:23], v5, s[84:87], s12 offen offset:1536 sc1
buffer_load_dwordx2 a[24:25], v5, s[84:87], s12 offen offset:2048 sc1
buffer_load_dwordx2 a[26:27], v5, s[84:87], s12 offen offset:2560 sc1
buffer_load_dwordx2 a[28:29], v5, s[84:87], s12 offen offset:3072 sc1
buffer_load_dwordx2 a[30:31], v5, s[84:87], s12 offen offset:3584 sc1
s_add_u32 s12, s12, 4096
buffer_load_dwordx2 a[32:33], v5, s[84:87], s12 offen offset:0 sc1
buffer_load_dwordx2 a[34:35], v5, s[84:87], s12 offen offset:512 sc1
buffer_load_dwordx2 a[36:37], v5, s[84:87], s12 offen offset:1024 sc1
buffer_load_dwordx2 a[38:39], v5, s[84:87], s12 offen offset:1536 sc1
buffer_load_dwordx2 a[40:41], v5, s[84:87], s12 offen offset:2048 sc1
buffer_load_dwordx2 a[42:43], v5, s[84:87], s12 offen offset:2560 sc1
buffer_load_dwordx2 a[44:45], v5, s[84:87], s12 offen offset:3072 sc1
buffer_load_dwordx2 a[46:47], v5, s[84:87], s12 offen offset:3584 sc1
s_add_u32 s12, s12, 4096
buffer_load_dwordx2 a[48:49], v5, s[84:87], s12 offen offset:0 sc1
buffer_load_dwordx2 a[50:51], v5, s[84:87], s12 offen offset:512 sc1
buffer_load_dwordx2 a[52:53], v5, s[84:87], s12 offen offset:1024 sc1
buffer_load_dwordx2 a[54:55], v5, s[84:87], s12 offen offset:1536 sc1
buffer_load_dwordx2 a[56:57], v5, s[84:87], s12 offen offset:2048 sc1
buffer_load_dwordx2 a[58:59], v5, s[84:87], s12 offen offset:2560 sc1
buffer_load_dwordx2 a[60:61], v5, s[84:87], s12 offen offset:3072 sc1
buffer_load_dwordx2 a[62:63], v5, s[84:87], s12 offen offset:3584 sc1
s_add_u32 s12, s12, 4096
buffer_load_dword a64, v11, s[84:87], s13 offen offset:0 sc1
buffer_load_dword a65, v11, s[84:87], s13 offen offset:128 sc1
buffer_load_dword a66, v11, s[84:87], s13 offen offset:256 sc1
buffer_load_dword a67, v11, s[84:87], s13 offen offset:384 sc1
buffer_load_dword a68, v11, s[84:87], s13 offen offset:512 sc1
buffer_load_dword a69, v11, s[84:87], s13 offen offset:640 sc1
buffer_load_dword a70, v11, s[84:87], s13 offen offset:768 sc1
buffer_load_dword a71, v11, s[84:87], s13 offen offset:896 sc1
buffer_load_dword a72, v11, s[84:87], s13 offen offset:1024 sc1
buffer_load_dword a73, v11, s[84:87], s13 offen offset:1152 sc1
buffer_load_dword a74, v11, s[84:87], s13 offen offset:1280 sc1
buffer_load_dword a75, v11, s[84:87], s13 offen offset:1408 sc1
buffer_load_dword a76, v11, s[84:87], s13 offen offset:1536 sc1
buffer_load_dword a77, v11, s[84:87], s13 offen offset:1664 sc1
buffer_load_dword a78, v11, s[84:87], s13 offen offset:1792 sc1
buffer_load_dword a79, v11, s[84:87], s13 offen offset:1920 sc1
buffer_load_dword a80, v11, s[84:87], s13 offen offset:2048 sc1
buffer_load_dword a81, v11, s[84:87], s13 offen offset:2176 sc1
buffer_load_dword a82, v11, s[84:87], s13 offen offset:2304 sc1
buffer_load_dword a83, v11, s[84:87], s13 offen offset:2432 sc1
buffer_load_dword a84, v11, s[84:87], s13 offen offset:2560 sc1
buffer_load_dword a85, v11, s[84:87], s13 offen offset:2688 sc1
buffer_load_dword a86, v11, s[84:87], s13 offen offset:2816 sc1
buffer_load_dword a87, v11, s[84:87], s13 offen offset:2944 sc1
buffer_load_dword a88, v11, s[84:87], s13 offen offset:3072 sc1
buffer_load_dword a89, v11, s[84:87], s13 offen offset:3200 sc1
buffer_load_dword a90, v11, s[84:87], s13 offen offset:3328 sc1
buffer_load_dword a91, v11, s[84:87], s13 offen offset:3456 sc1
buffer_load_dword a92, v11, s[84:87], s13 offen offset:3584 sc1
buffer_load_dword a93, v11, s[84:87], s13 offen offset:3712 sc1
buffer_load_dword a94, v11, s[84:87], s13 offen offset:3840 sc1
buffer_load_dword a95, v11, s[84:87], s13 offen offset:3968 sc1
s_waitcnt vmcnt(0)
mega_kernel_f2_l:
s_add_u32 s21, s38, s39
s_cmp_lt_u32 s21, s37
s_cselect_b32 s22, s21, s38
s_waitcnt vmcnt(32)
v_accvgpr_read_b32 v16, a0
v_accvgpr_read_b32 v17, a1
v_accvgpr_read_b32 v18, a2
v_accvgpr_read_b32 v19, a3
v_accvgpr_read_b32 v20, a4
v_accvgpr_read_b32 v21, a5
v_accvgpr_read_b32 v22, a6
v_accvgpr_read_b32 v23, a7
v_accvgpr_read_b32 v24, a8
v_accvgpr_read_b32 v25, a9
v_accvgpr_read_b32 v26, a10
v_accvgpr_read_b32 v27, a11
v_accvgpr_read_b32 v28, a12
v_accvgpr_read_b32 v29, a13
v_accvgpr_read_b32 v30, a14
v_accvgpr_read_b32 v31, a15
v_accvgpr_read_b32 v32, a16
v_accvgpr_read_b32 v33, a17
v_accvgpr_read_b32 v34, a18
v_accvgpr_read_b32 v35, a19
v_accvgpr_read_b32 v36, a20
v_accvgpr_read_b32 v37, a21
v_accvgpr_read_b32 v38, a22
v_accvgpr_read_b32 v39, a23
v_accvgpr_read_b32 v40, a24
v_accvgpr_read_b32 v41, a25
v_accvgpr_read_b32 v42, a26
v_accvgpr_read_b32 v43, a27
v_accvgpr_read_b32 v44, a28
v_accvgpr_read_b32 v45, a29
v_accvgpr_read_b32 v46, a30
v_accvgpr_read_b32 v47, a31
v_accvgpr_read_b32 v48, a32
v_accvgpr_read_b32 v49, a33
v_accvgpr_read_b32 v50, a34
v_accvgpr_read_b32 v51, a35
v_accvgpr_read_b32 v52, a36
v_accvgpr_read_b32 v53, a37
v_accvgpr_read_b32 v54, a38
v_accvgpr_read_b32 v55, a39
v_accvgpr_read_b32 v56, a40
v_accvgpr_read_b32 v57, a41
v_accvgpr_read_b32 v58, a42
v_accvgpr_read_b32 v59, a43
v_accvgpr_read_b32 v60, a44
v_accvgpr_read_b32 v61, a45
v_accvgpr_read_b32 v62, a46
v_accvgpr_read_b32 v63, a47
v_accvgpr_read_b32 v64, a48
v_accvgpr_read_b32 v65, a49
v_accvgpr_read_b32 v66, a50
v_accvgpr_read_b32 v67, a51
v_accvgpr_read_b32 v68, a52
v_accvgpr_read_b32 v69, a53
v_accvgpr_read_b32 v70, a54
v_accvgpr_read_b32 v71, a55
v_accvgpr_read_b32 v72, a56
v_accvgpr_read_b32 v73, a57
v_accvgpr_read_b32 v74, a58
v_accvgpr_read_b32 v75, a59
v_accvgpr_read_b32 v76, a60
v_accvgpr_read_b32 v77, a61
v_accvgpr_read_b32 v78, a62
v_accvgpr_read_b32 v79, a63
v_accvgpr_read_b32 v208, a64
v_accvgpr_read_b32 v209, a65
v_accvgpr_read_b32 v210, a66
v_accvgpr_read_b32 v211, a67
v_accvgpr_read_b32 v212, a68
v_accvgpr_read_b32 v213, a69
v_accvgpr_read_b32 v214, a70
v_accvgpr_read_b32 v215, a71
v_accvgpr_read_b32 v216, a72
v_accvgpr_read_b32 v217, a73
v_accvgpr_read_b32 v218, a74
v_accvgpr_read_b32 v219, a75
v_accvgpr_read_b32 v220, a76
v_accvgpr_read_b32 v221, a77
v_accvgpr_read_b32 v222, a78
v_accvgpr_read_b32 v223, a79
v_accvgpr_read_b32 v224, a80
v_accvgpr_read_b32 v225, a81
v_accvgpr_read_b32 v226, a82
v_accvgpr_read_b32 v227, a83
v_accvgpr_read_b32 v228, a84
v_accvgpr_read_b32 v229, a85
v_accvgpr_read_b32 v230, a86
v_accvgpr_read_b32 v231, a87
v_accvgpr_read_b32 v232, a88
v_accvgpr_read_b32 v233, a89
v_accvgpr_read_b32 v234, a90
v_accvgpr_read_b32 v235, a91
v_accvgpr_read_b32 v236, a92
v_accvgpr_read_b32 v237, a93
v_accvgpr_read_b32 v238, a94
v_accvgpr_read_b32 v239, a95
s_lshl_b32 s12, s22, 2
s_add_u32 s12, s12, s16
s_min_u32 s12, s12, 512
s_lshl_b32 s13, s12, 13
s_lshl_b32 s12, s12, 14
s_add_u32 s12, s12, 96468992
s_add_u32 s13, s13, 121634816
buffer_load_dwordx2 a[0:1], v5, s[84:87], s12 offen offset:0 sc1
buffer_load_dwordx2 a[2:3], v5, s[84:87], s12 offen offset:512 sc1
buffer_load_dwordx2 a[4:5], v5, s[84:87], s12 offen offset:1024 sc1
buffer_load_dwordx2 a[6:7], v5, s[84:87], s12 offen offset:1536 sc1
buffer_load_dwordx2 a[8:9], v5, s[84:87], s12 offen offset:2048 sc1
buffer_load_dwordx2 a[10:11], v5, s[84:87], s12 offen offset:2560 sc1
buffer_load_dwordx2 a[12:13], v5, s[84:87], s12 offen offset:3072 sc1
buffer_load_dwordx2 a[14:15], v5, s[84:87], s12 offen offset:3584 sc1
s_add_u32 s12, s12, 4096
buffer_load_dwordx2 a[16:17], v5, s[84:87], s12 offen offset:0 sc1
buffer_load_dwordx2 a[18:19], v5, s[84:87], s12 offen offset:512 sc1
buffer_load_dwordx2 a[20:21], v5, s[84:87], s12 offen offset:1024 sc1
buffer_load_dwordx2 a[22:23], v5, s[84:87], s12 offen offset:1536 sc1
buffer_load_dwordx2 a[24:25], v5, s[84:87], s12 offen offset:2048 sc1
buffer_load_dwordx2 a[26:27], v5, s[84:87], s12 offen offset:2560 sc1
buffer_load_dwordx2 a[28:29], v5, s[84:87], s12 offen offset:3072 sc1
buffer_load_dwordx2 a[30:31], v5, s[84:87], s12 offen offset:3584 sc1
s_add_u32 s12, s12, 4096
buffer_load_dwordx2 a[32:33], v5, s[84:87], s12 offen offset:0 sc1
buffer_load_dwordx2 a[34:35], v5, s[84:87], s12 offen offset:512 sc1
buffer_load_dwordx2 a[36:37], v5, s[84:87], s12 offen offset:1024 sc1
buffer_load_dwordx2 a[38:39], v5, s[84:87], s12 offen offset:1536 sc1
buffer_load_dwordx2 a[40:41], v5, s[84:87], s12 offen offset:2048 sc1
buffer_load_dwordx2 a[42:43], v5, s[84:87], s12 offen offset:2560 sc1
buffer_load_dwordx2 a[44:45], v5, s[84:87], s12 offen offset:3072 sc1
buffer_load_dwordx2 a[46:47], v5, s[84:87], s12 offen offset:3584 sc1
s_add_u32 s12, s12, 4096
buffer_load_dwordx2 a[48:49], v5, s[84:87], s12 offen offset:0 sc1
buffer_load_dwordx2 a[50:51], v5, s[84:87], s12 offen offset:512 sc1
buffer_load_dwordx2 a[52:53], v5, s[84:87], s12 offen offset:1024 sc1
buffer_load_dwordx2 a[54:55], v5, s[84:87], s12 offen offset:1536 sc1
buffer_load_dwordx2 a[56:57], v5, s[84:87], s12 offen offset:2048 sc1
buffer_load_dwordx2 a[58:59], v5, s[84:87], s12 offen offset:2560 sc1
buffer_load_dwordx2 a[60:61], v5, s[84:87], s12 offen offset:3072 sc1
buffer_load_dwordx2 a[62:63], v5, s[84:87], s12 offen offset:3584 sc1
s_add_u32 s12, s12, 4096
buffer_load_dword a64, v11, s[84:87], s13 offen offset:0 sc1
buffer_load_dword a65, v11, s[84:87], s13 offen offset:128 sc1
buffer_load_dword a66, v11, s[84:87], s13 offen offset:256 sc1
buffer_load_dword a67, v11, s[84:87], s13 offen offset:384 sc1
buffer_load_dword a68, v11, s[84:87], s13 offen offset:512 sc1
buffer_load_dword a69, v11, s[84:87], s13 offen offset:640 sc1
buffer_load_dword a70, v11, s[84:87], s13 offen offset:768 sc1
buffer_load_dword a71, v11, s[84:87], s13 offen offset:896 sc1
buffer_load_dword a72, v11, s[84:87], s13 offen offset:1024 sc1
buffer_load_dword a73, v11, s[84:87], s13 offen offset:1152 sc1
buffer_load_dword a74, v11, s[84:87], s13 offen offset:1280 sc1
buffer_load_dword a75, v11, s[84:87], s13 offen offset:1408 sc1
buffer_load_dword a76, v11, s[84:87], s13 offen offset:1536 sc1
buffer_load_dword a77, v11, s[84:87], s13 offen offset:1664 sc1
buffer_load_dword a78, v11, s[84:87], s13 offen offset:1792 sc1
buffer_load_dword a79, v11, s[84:87], s13 offen offset:1920 sc1
buffer_load_dword a80, v11, s[84:87], s13 offen offset:2048 sc1
buffer_load_dword a81, v11, s[84:87], s13 offen offset:2176 sc1
buffer_load_dword a82, v11, s[84:87], s13 offen offset:2304 sc1
buffer_load_dword a83, v11, s[84:87], s13 offen offset:2432 sc1
buffer_load_dword a84, v11, s[84:87], s13 offen offset:2560 sc1
buffer_load_dword a85, v11, s[84:87], s13 offen offset:2688 sc1
buffer_load_dword a86, v11, s[84:87], s13 offen offset:2816 sc1
buffer_load_dword a87, v11, s[84:87], s13 offen offset:2944 sc1
buffer_load_dword a88, v11, s[84:87], s13 offen offset:3072 sc1
buffer_load_dword a89, v11, s[84:87], s13 offen offset:3200 sc1
buffer_load_dword a90, v11, s[84:87], s13 offen offset:3328 sc1
buffer_load_dword a91, v11, s[84:87], s13 offen offset:3456 sc1
buffer_load_dword a92, v11, s[84:87], s13 offen offset:3584 sc1
buffer_load_dword a93, v11, s[84:87], s13 offen offset:3712 sc1
buffer_load_dword a94, v11, s[84:87], s13 offen offset:3840 sc1
buffer_load_dword a95, v11, s[84:87], s13 offen offset:3968 sc1
v_pk_add_f32 v[14:15], v[16:17], v[48:49] neg_lo:[0,1] neg_hi:[0,1]
v_pk_add_f32 v[16:17], v[16:17], v[48:49]
v_pk_add_f32 v[48:49], v[18:19], v[50:51] neg_lo:[0,1] neg_hi:[0,1]
v_pk_add_f32 v[18:19], v[18:19], v[50:51]
v_pk_mul_f32 v[50:51], v[48:49], s[50:51] op_sel:[0,0] op_sel_hi:[0,1] neg_lo:[0,0] neg_hi:[0,1]
v_pk_fma_f32 v[50:51], v[48:49], s[50:51], v[50:51] op_sel:[1,1,0] op_sel_hi:[1,0,1] neg_lo:[0,0,0] neg_hi:[0,0,0]
v_pk_add_f32 v[48:49], v[20:21], v[52:53] neg_lo:[0,1] neg_hi:[0,1]
v_pk_add_f32 v[20:21], v[20:21], v[52:53]
v_pk_mul_f32 v[52:53], v[48:49], s[54:55] op_sel:[0,0] op_sel_hi:[0,1] neg_lo:[0,0] neg_hi:[0,1]
v_pk_fma_f32 v[52:53], v[48:49], s[54:55], v[52:53] op_sel:[1,1,0] op_sel_hi:[1,0,1] neg_lo:[0,0,0] neg_hi:[0,0,0]
v_pk_add_f32 v[48:49], v[22:23], v[54:55] neg_lo:[0,1] neg_hi:[0,1]
v_pk_add_f32 v[22:23], v[22:23], v[54:55]
v_pk_mul_f32 v[54:55], v[48:49], s[58:59] op_sel:[0,0] op_sel_hi:[0,1] neg_lo:[0,0] neg_hi:[0,1]
v_pk_fma_f32 v[54:55], v[48:49], s[58:59], v[54:55] op_sel:[1,1,0] op_sel_hi:[1,0,1] neg_lo:[0,0,0] neg_hi:[0,0,0]
v_pk_add_f32 v[48:49], v[24:25], v[56:57] neg_lo:[0,1] neg_hi:[0,1]
v_pk_add_f32 v[24:25], v[24:25], v[56:57]
v_pk_mul_f32 v[56:57], v[48:49], s[62:63] op_sel:[0,0] op_sel_hi:[0,1] neg_lo:[0,0] neg_hi:[0,1]
v_pk_fma_f32 v[56:57], v[48:49], s[62:63], v[56:57] op_sel:[1,1,0] op_sel_hi:[1,0,1] neg_lo:[0,0,0] neg_hi:[0,0,0]
v_pk_add_f32 v[48:49], v[26:27], v[58:59] neg_lo:[0,1] neg_hi:[0,1]
v_pk_add_f32 v[26:27], v[26:27], v[58:59]
v_pk_mul_f32 v[58:59], v[48:49], s[58:59] op_sel:[0,1] op_sel_hi:[0,0] neg_lo:[0,0] neg_hi:[0,1]
v_pk_fma_f32 v[58:59], v[48:49], s[58:59], v[58:59] op_sel:[1,0,0] op_sel_hi:[1,1,1] neg_lo:[0,0,0] neg_hi:[0,0,0]
v_pk_add_f32 v[48:49], v[28:29], v[60:61] neg_lo:[0,1] neg_hi:[0,1]
v_pk_add_f32 v[28:29], v[28:29], v[60:61]
v_pk_mul_f32 v[60:61], v[48:49], s[54:55] op_sel:[0,1] op_sel_hi:[0,0] neg_lo:[0,0] neg_hi:[0,1]
v_pk_fma_f32 v[60:61], v[48:49], s[54:55], v[60:61] op_sel:[1,0,0] op_sel_hi:[1,1,1] neg_lo:[0,0,0] neg_hi:[0,0,0]
v_pk_add_f32 v[48:49], v[30:31], v[62:63] neg_lo:[0,1] neg_hi:[0,1]
v_pk_add_f32 v[30:31], v[30:31], v[62:63]
v_pk_mul_f32 v[62:63], v[48:49], s[50:51] op_sel:[0,1] op_sel_hi:[0,0] neg_lo:[0,0] neg_hi:[0,1]
v_pk_fma_f32 v[62:63], v[48:49], s[50:51], v[62:63] op_sel:[1,0,0] op_sel_hi:[1,1,1] neg_lo:[0,0,0] neg_hi:[0,0,0]
v_pk_add_f32 v[48:49], v[32:33], v[64:65] op_sel:[1,1] op_sel_hi:[0,0] neg_lo:[0,1] neg_hi:[1,0]
v_pk_add_f32 v[32:33], v[32:33], v[64:65]
v_pk_add_f32 v[64:65], v[34:35], v[66:67] neg_lo:[0,1] neg_hi:[0,1]
v_pk_add_f32 v[34:35], v[34:35], v[66:67]
v_pk_mul_f32 v[66:67], v[64:65], s[50:51] op_sel:[0,1] op_sel_hi:[0,0] neg_lo:[0,1] neg_hi:[0,1]
v_pk_fma_f32 v[66:67], v[64:65], s[50:51], v[66:67] op_sel:[1,0,0] op_sel_hi:[1,1,1] neg_lo:[0,0,0] neg_hi:[0,1,0]
v_pk_add_f32 v[64:65], v[36:37], v[68:69] neg_lo:[0,1] neg_hi:[0,1]
v_pk_add_f32 v[36:37], v[36:37], v[68:69]
v_pk_mul_f32 v[68:69], v[64:65], s[54:55] op_sel:[0,1] op_sel_hi:[0,0] neg_lo:[0,1] neg_hi:[0,1]
v_pk_fma_f32 v[68:69], v[64:65], s[54:55], v[68:69] op_sel:[1,0,0] op_sel_hi:[1,1,1] neg_lo:[0,0,0] neg_hi:[0,1,0]
v_pk_add_f32 v[64:65], v[38:39], v[70:71] neg_lo:[0,1] neg_hi:[0,1]
v_pk_add_f32 v[38:39], v[38:39], v[70:71]
v_pk_mul_f32 v[70:71], v[64:65], s[58:59] op_sel:[0,1] op_sel_hi:[0,0] neg_lo:[0,1] neg_hi:[0,1]
v_pk_fma_f32 v[70:71], v[64:65], s[58:59], v[70:71] op_sel:[1,0,0] op_sel_hi:[1,1,1] neg_lo:[0,0,0] neg_hi:[0,1,0]
v_pk_add_f32 v[64:65], v[40:41], v[72:73] neg_lo:[0,1] neg_hi:[0,1]
v_pk_add_f32 v[40:41], v[40:41], v[72:73]
v_pk_mul_f32 v[72:73], v[64:65], s[62:63] op_sel:[0,0] op_sel_hi:[0,1] neg_lo:[0,1] neg_hi:[0,1]
v_pk_fma_f32 v[72:73], v[64:65], s[62:63], v[72:73] op_sel:[1,1,0] op_sel_hi:[1,0,1] neg_lo:[0,0,0] neg_hi:[0,1,0]
v_pk_add_f32 v[64:65], v[42:43], v[74:75] neg_lo:[0,1] neg_hi:[0,1]
v_pk_add_f32 v[42:43], v[42:43], v[74:75]
v_pk_mul_f32 v[74:75], v[64:65], s[58:59] op_sel:[0,0] op_sel_hi:[0,1] neg_lo:[0,1] neg_hi:[0,1]
v_pk_fma_f32 v[74:75], v[64:65], s[58:59], v[74:75] op_sel:[1,1,0] op_sel_hi:[1,0,1] neg_lo:[0,0,0] neg_hi:[0,1,0]
v_pk_add_f32 v[64:65], v[44:45], v[76:77] neg_lo:[0,1] neg_hi:[0,1]
v_pk_add_f32 v[44:45], v[44:45], v[76:77]
v_pk_mul_f32 v[76:77], v[64:65], s[54:55] op_sel:[0,0] op_sel_hi:[0,1] neg_lo:[0,1] neg_hi:[0,1]
v_pk_fma_f32 v[76:77], v[64:65], s[54:55], v[76:77] op_sel:[1,1,0] op_sel_hi:[1,0,1] neg_lo:[0,0,0] neg_hi:[0,1,0]
v_pk_add_f32 v[64:65], v[46:47], v[78:79] neg_lo:[0,1] neg_hi:[0,1]
v_pk_add_f32 v[46:47], v[46:47], v[78:79]
v_pk_mul_f32 v[78:79], v[64:65], s[50:51] op_sel:[0,0] op_sel_hi:[0,1] neg_lo:[0,1] neg_hi:[0,1]
v_pk_fma_f32 v[78:79], v[64:65], s[50:51], v[78:79] op_sel:[1,1,0] op_sel_hi:[1,0,1] neg_lo:[0,0,0] neg_hi:[0,1,0]
v_pk_add_f32 v[64:65], v[16:17], v[32:33] neg_lo:[0,1] neg_hi:[0,1]
v_pk_add_f32 v[16:17], v[16:17], v[32:33]
v_pk_add_f32 v[32:33], v[18:19], v[34:35] neg_lo:[0,1] neg_hi:[0,1]
v_pk_add_f32 v[18:19], v[18:19], v[34:35]
v_pk_mul_f32 v[34:35], v[32:33], s[54:55] op_sel:[0,0] op_sel_hi:[0,1] neg_lo:[0,0] neg_hi:[0,1]
v_pk_fma_f32 v[34:35], v[32:33], s[54:55], v[34:35] op_sel:[1,1,0] op_sel_hi:[1,0,1] neg_lo:[0,0,0] neg_hi:[0,0,0]
v_pk_add_f32 v[32:33], v[20:21], v[36:37] neg_lo:[0,1] neg_hi:[0,1]
v_pk_add_f32 v[20:21], v[20:21], v[36:37]
v_pk_mul_f32 v[36:37], v[32:33], s[62:63] op_sel:[0,0] op_sel_hi:[0,1] neg_lo:[0,0] neg_hi:[0,1]
v_pk_fma_f32 v[36:37], v[32:33], s[62:63], v[36:37] op_sel:[1,1,0] op_sel_hi:[1,0,1] neg_lo:[0,0,0] neg_hi:[0,0,0]
v_pk_add_f32 v[32:33], v[22:23], v[38:39] neg_lo:[0,1] neg_hi:[0,1]
v_pk_add_f32 v[22:23], v[22:23], v[38:39]
v_pk_mul_f32 v[38:39], v[32:33], s[54:55] op_sel:[0,1] op_sel_hi:[0,0] neg_lo:[0,0] neg_hi:[0,1]
v_pk_fma_f32 v[38:39], v[32:33], s[54:55], v[38:39] op_sel:[1,0,0] op_sel_hi:[1,1,1] neg_lo:[0,0,0] neg_hi:[0,0,0]
v_pk_add_f32 v[32:33], v[24:25], v[40:41] op_sel:[1,1] op_sel_hi:[0,0] neg_lo:[0,1] neg_hi:[1,0]
v_pk_add_f32 v[24:25], v[24:25], v[40:41]
v_pk_add_f32 v[40:41], v[26:27], v[42:43] neg_lo:[0,1] neg_hi:[0,1]
v_pk_add_f32 v[26:27], v[26:27], v[42:43]
v_pk_mul_f32 v[42:43], v[40:41], s[54:55] op_sel:[0,1] op_sel_hi:[0,0] neg_lo:[0,1] neg_hi:[0,1]
v_pk_fma_f32 v[42:43], v[40:41], s[54:55], v[42:43] op_sel:[1,0,0] op_sel_hi:[1,1,1] neg_lo:[0,0,0] neg_hi:[0,1,0]
v_pk_add_f32 v[40:41], v[28:29], v[44:45] neg_lo:[0,1] neg_hi:[0,1]
v_pk_add_f32 v[28:29], v[28:29], v[44:45]
v_pk_mul_f32 v[44:45], v[40:41], s[62:63] op_sel:[0,0] op_sel_hi:[0,1] neg_lo:[0,1] neg_hi:[0,1]
v_pk_fma_f32 v[44:45], v[40:41], s[62:63], v[44:45] op_sel:[1,1,0] op_sel_hi:[1,0,1] neg_lo:[0,0,0] neg_hi:[0,1,0]
v_pk_add_f32 v[40:41], v[30:31], v[46:47] neg_lo:[0,1] neg_hi:[0,1]
v_pk_add_f32 v[30:31], v[30:31], v[46:47]
v_pk_mul_f32 v[46:47], v[40:41], s[54:55] op_sel:[0,0] op_sel_hi:[0,1] neg_lo:[0,1] neg_hi:[0,1]
v_pk_fma_f32 v[46:47], v[40:41], s[54:55], v[46:47] op_sel:[1,1,0] op_sel_hi:[1,0,1] neg_lo:[0,0,0] neg_hi:[0,1,0]
v_pk_add_f32 v[40:41], v[14:15], v[48:49] neg_lo:[0,1] neg_hi:[0,1]
v_pk_add_f32 v[14:15], v[14:15], v[48:49]
v_pk_add_f32 v[48:49], v[50:51], v[66:67] neg_lo:[0,1] neg_hi:[0,1]
v_pk_add_f32 v[50:51], v[50:51], v[66:67]
v_pk_mul_f32 v[66:67], v[48:49], s[54:55] op_sel:[0,0] op_sel_hi:[0,1] neg_lo:[0,0] neg_hi:[0,1]
v_pk_fma_f32 v[66:67], v[48:49], s[54:55], v[66:67] op_sel:[1,1,0] op_sel_hi:[1,0,1] neg_lo:[0,0,0] neg_hi:[0,0,0]
v_pk_add_f32 v[48:49], v[52:53], v[68:69] neg_lo:[0,1] neg_hi:[0,1]
v_pk_add_f32 v[52:53], v[52:53], v[68:69]
v_pk_mul_f32 v[68:69], v[48:49], s[62:63] op_sel:[0,0] op_sel_hi:[0,1] neg_lo:[0,0] neg_hi:[0,1]
v_pk_fma_f32 v[68:69], v[48:49], s[62:63], v[68:69] op_sel:[1,1,0] op_sel_hi:[1,0,1] neg_lo:[0,0,0] neg_hi:[0,0,0]
v_pk_add_f32 v[48:49], v[54:55], v[70:71] neg_lo:[0,1] neg_hi:[0,1]
v_pk_add_f32 v[54:55], v[54:55], v[70:71]
v_pk_mul_f32 v[70:71], v[48:49], s[54:55] op_sel:[0,1] op_sel_hi:[0,0] neg_lo:[0,0] neg_hi:[0,1]
v_pk_fma_f32 v[70:71], v[48:49], s[54:55], v[70:71] op_sel:[1,0,0] op_sel_hi:[1,1,1] neg_lo:[0,0,0] neg_hi:[0,0,0]
v_pk_add_f32 v[48:49], v[56:57], v[72:73] op_sel:[1,1] op_sel_hi:[0,0] neg_lo:[0,1] neg_hi:[1,0]
v_pk_add_f32 v[56:57], v[56:57], v[72:73]
v_pk_add_f32 v[72:73], v[58:59], v[74:75] neg_lo:[0,1] neg_hi:[0,1]
v_pk_add_f32 v[58:59], v[58:59], v[74:75]
v_pk_mul_f32 v[74:75], v[72:73], s[54:55] op_sel:[0,1] op_sel_hi:[0,0] neg_lo:[0,1] neg_hi:[0,1]
v_pk_fma_f32 v[74:75], v[72:73], s[54:55], v[74:75] op_sel:[1,0,0] op_sel_hi:[1,1,1] neg_lo:[0,0,0] neg_hi:[0,1,0]
v_pk_add_f32 v[72:73], v[60:61], v[76:77] neg_lo:[0,1] neg_hi:[0,1]
v_pk_add_f32 v[60:61], v[60:61], v[76:77]
v_pk_mul_f32 v[76:77], v[72:73], s[62:63] op_sel:[0,0] op_sel_hi:[0,1] neg_lo:[0,1] neg_hi:[0,1]
v_pk_fma_f32 v[76:77], v[72:73], s[62:63], v[76:77] op_sel:[1,1,0] op_sel_hi:[1,0,1] neg_lo:[0,0,0] neg_hi:[0,1,0]
v_pk_add_f32 v[72:73], v[62:63], v[78:79] neg_lo:[0,1] neg_hi:[0,1]
v_pk_add_f32 v[62:63], v[62:63], v[78:79]
v_pk_mul_f32 v[78:79], v[72:73], s[54:55] op_sel:[0,0] op_sel_hi:[0,1] neg_lo:[0,1] neg_hi:[0,1]
v_pk_fma_f32 v[78:79], v[72:73], s[54:55], v[78:79] op_sel:[1,1,0] op_sel_hi:[1,0,1] neg_lo:[0,0,0] neg_hi:[0,1,0]
v_pk_add_f32 v[72:73], v[16:17], v[24:25] neg_lo:[0,1] neg_hi:[0,1]
v_pk_add_f32 v[16:17], v[16:17], v[24:25]
v_pk_add_f32 v[24:25], v[18:19], v[26:27] neg_lo:[0,1] neg_hi:[0,1]
v_pk_add_f32 v[18:19], v[18:19], v[26:27]
v_pk_mul_f32 v[26:27], v[24:25], s[62:63] op_sel:[0,0] op_sel_hi:[0,1] neg_lo:[0,0] neg_hi:[0,1]
v_pk_fma_f32 v[26:27], v[24:25], s[62:63], v[26:27] op_sel:[1,1,0] op_sel_hi:[1,0,1] neg_lo:[0,0,0] neg_hi:[0,0,0]
v_pk_add_f32 v[24:25], v[20:21], v[28:29] op_sel:[1,1] op_sel_hi:[0,0] neg_lo:[0,1] neg_hi:[1,0]
v_pk_add_f32 v[20:21], v[20:21], v[28:29]
v_pk_add_f32 v[28:29], v[22:23], v[30:31] neg_lo:[0,1] neg_hi:[0,1]
v_pk_add_f32 v[22:23], v[22:23], v[30:31]
v_pk_mul_f32 v[30:31], v[28:29], s[62:63] op_sel:[0,0] op_sel_hi:[0,1] neg_lo:[0,1] neg_hi:[0,1]
v_pk_fma_f32 v[30:31], v[28:29], s[62:63], v[30:31] op_sel:[1,1,0] op_sel_hi:[1,0,1] neg_lo:[0,0,0] neg_hi:[0,1,0]
v_pk_add_f32 v[28:29], v[64:65], v[32:33] neg_lo:[0,1] neg_hi:[0,1]
v_pk_add_f32 v[64:65], v[64:65], v[32:33]
v_pk_add_f32 v[32:33], v[34:35], v[42:43] neg_lo:[0,1] neg_hi:[0,1]
v_pk_add_f32 v[34:35], v[34:35], v[42:43]
v_pk_mul_f32 v[42:43], v[32:33], s[62:63] op_sel:[0,0] op_sel_hi:[0,1] neg_lo:[0,0] neg_hi:[0,1]
v_pk_fma_f32 v[42:43], v[32:33], s[62:63], v[42:43] op_sel:[1,1,0] op_sel_hi:[1,0,1] neg_lo:[0,0,0] neg_hi:[0,0,0]
v_pk_add_f32 v[32:33], v[36:37], v[44:45] op_sel:[1,1] op_sel_hi:[0,0] neg_lo:[0,1] neg_hi:[1,0]
v_pk_add_f32 v[36:37], v[36:37], v[44:45]
v_pk_add_f32 v[44:45], v[38:39], v[46:47] neg_lo:[0,1] neg_hi:[0,1]
v_pk_add_f32 v[38:39], v[38:39], v[46:47]
v_pk_mul_f32 v[46:47], v[44:45], s[62:63] op_sel:[0,0] op_sel_hi:[0,1] neg_lo:[0,1] neg_hi:[0,1]
v_pk_fma_f32 v[46:47], v[44:45], s[62:63], v[46:47] op_sel:[1,1,0] op_sel_hi:[1,0,1] neg_lo:[0,0,0] neg_hi:[0,1,0]
v_pk_add_f32 v[44:45], v[14:15], v[56:57] neg_lo:[0,1] neg_hi:[0,1]
v_pk_add_f32 v[14:15], v[14:15], v[56:57]
v_pk_add_f32 v[56:57], v[50:51], v[58:59] neg_lo:[0,1] neg_hi:[0,1]
v_pk_add_f32 v[50:51], v[50:51], v[58:59]
v_pk_mul_f32 v[58:59], v[56:57], s[62:63] op_sel:[0,0] op_sel_hi:[0,1] neg_lo:[0,0] neg_hi:[0,1]
v_pk_fma_f32 v[58:59], v[56:57], s[62:63], v[58:59] op_sel:[1,1,0] op_sel_hi:[1,0,1] neg_lo:[0,0,0] neg_hi:[0,0,0]
v_pk_add_f32 v[56:57], v[52:53], v[60:61] op_sel:[1,1] op_sel_hi:[0,0] neg_lo:[0,1] neg_hi:[1,0]
v_pk_add_f32 v[52:53], v[52:53], v[60:61]
v_pk_add_f32 v[60:61], v[54:55], v[62:63] neg_lo:[0,1] neg_hi:[0,1]
v_pk_add_f32 v[54:55], v[54:55], v[62:63]
v_pk_mul_f32 v[62:63], v[60:61], s[62:63] op_sel:[0,0] op_sel_hi:[0,1] neg_lo:[0,1] neg_hi:[0,1]
v_pk_fma_f32 v[62:63], v[60:61], s[62:63], v[62:63] op_sel:[1,1,0] op_sel_hi:[1,0,1] neg_lo:[0,0,0] neg_hi:[0,1,0]
v_pk_add_f32 v[60:61], v[40:41], v[48:49] neg_lo:[0,1] neg_hi:[0,1]
v_pk_add_f32 v[40:41], v[40:41], v[48:49]
v_pk_add_f32 v[48:49], v[66:67], v[74:75] neg_lo:[0,1] neg_hi:[0,1]
v_pk_add_f32 v[66:67], v[66:67], v[74:75]
v_pk_mul_f32 v[74:75], v[48:49], s[62:63] op_sel:[0,0] op_sel_hi:[0,1] neg_lo:[0,0] neg_hi:[0,1]
v_pk_fma_f32 v[74:75], v[48:49], s[62:63], v[74:75] op_sel:[1,1,0] op_sel_hi:[1,0,1] neg_lo:[0,0,0] neg_hi:[0,0,0]
v_pk_add_f32 v[48:49], v[68:69], v[76:77] op_sel:[1,1] op_sel_hi:[0,0] neg_lo:[0,1] neg_hi:[1,0]
v_pk_add_f32 v[68:69], v[68:69], v[76:77]
v_pk_add_f32 v[76:77], v[70:71], v[78:79] neg_lo:[0,1] neg_hi:[0,1]
v_pk_add_f32 v[70:71], v[70:71], v[78:79]
v_pk_mul_f32 v[78:79], v[76:77], s[62:63] op_sel:[0,0] op_sel_hi:[0,1] neg_lo:[0,1] neg_hi:[0,1]
v_pk_fma_f32 v[78:79], v[76:77], s[62:63], v[78:79] op_sel:[1,1,0] op_sel_hi:[1,0,1] neg_lo:[0,0,0] neg_hi:[0,1,0]
v_pk_add_f32 v[76:77], v[16:17], v[20:21] neg_lo:[0,1] neg_hi:[0,1]
v_pk_add_f32 v[16:17], v[16:17], v[20:21]
v_pk_add_f32 v[20:21], v[18:19], v[22:23] op_sel:[1,1] op_sel_hi:[0,0] neg_lo:[0,1] neg_hi:[1,0]
v_pk_add_f32 v[18:19], v[18:19], v[22:23]
v_pk_add_f32 v[22:23], v[72:73], v[24:25] neg_lo:[0,1] neg_hi:[0,1]
v_pk_add_f32 v[72:73], v[72:73], v[24:25]
v_pk_add_f32 v[24:25], v[26:27], v[30:31] op_sel:[1,1] op_sel_hi:[0,0] neg_lo:[0,1] neg_hi:[1,0]
v_pk_add_f32 v[26:27], v[26:27], v[30:31]
v_pk_add_f32 v[30:31], v[64:65], v[36:37] neg_lo:[0,1] neg_hi:[0,1]
v_pk_add_f32 v[64:65], v[64:65], v[36:37]
v_pk_add_f32 v[36:37], v[34:35], v[38:39] op_sel:[1,1] op_sel_hi:[0,0] neg_lo:[0,1] neg_hi:[1,0]
v_pk_add_f32 v[34:35], v[34:35], v[38:39]
v_pk_add_f32 v[38:39], v[28:29], v[32:33] neg_lo:[0,1] neg_hi:[0,1]
v_pk_add_f32 v[28:29], v[28:29], v[32:33]
v_pk_add_f32 v[32:33], v[42:43], v[46:47] op_sel:[1,1] op_sel_hi:[0,0] neg_lo:[0,1] neg_hi:[1,0]
v_pk_add_f32 v[42:43], v[42:43], v[46:47]
v_pk_add_f32 v[46:47], v[14:15], v[52:53] neg_lo:[0,1] neg_hi:[0,1]
v_pk_add_f32 v[14:15], v[14:15], v[52:53]
v_pk_add_f32 v[52:53], v[50:51], v[54:55] op_sel:[1,1] op_sel_hi:[0,0] neg_lo:[0,1] neg_hi:[1,0]
v_pk_add_f32 v[50:51], v[50:51], v[54:55]
v_pk_add_f32 v[54:55], v[44:45], v[56:57] neg_lo:[0,1] neg_hi:[0,1]
v_pk_add_f32 v[44:45], v[44:45], v[56:57]
v_pk_add_f32 v[56:57], v[58:59], v[62:63] op_sel:[1,1] op_sel_hi:[0,0] neg_lo:[0,1] neg_hi:[1,0]
v_pk_add_f32 v[58:59], v[58:59], v[62:63]
v_pk_add_f32 v[62:63], v[40:41], v[68:69] neg_lo:[0,1] neg_hi:[0,1]
v_pk_add_f32 v[40:41], v[40:41], v[68:69]
v_pk_add_f32 v[68:69], v[66:67], v[70:71] op_sel:[1,1] op_sel_hi:[0,0] neg_lo:[0,1] neg_hi:[1,0]
v_pk_add_f32 v[66:67], v[66:67], v[70:71]
v_pk_add_f32 v[70:71], v[60:61], v[48:49] neg_lo:[0,1] neg_hi:[0,1]
v_pk_add_f32 v[60:61], v[60:61], v[48:49]
v_pk_add_f32 v[48:49], v[74:75], v[78:79] op_sel:[1,1] op_sel_hi:[0,0] neg_lo:[0,1] neg_hi:[1,0]
v_pk_add_f32 v[74:75], v[74:75], v[78:79]
v_pk_add_f32 v[78:79], v[16:17], v[18:19] neg_lo:[0,1] neg_hi:[0,1]
v_pk_add_f32 v[16:17], v[16:17], v[18:19]
v_pk_add_f32 v[18:19], v[76:77], v[20:21] neg_lo:[0,1] neg_hi:[0,1]
v_pk_add_f32 v[76:77], v[76:77], v[20:21]
v_pk_add_f32 v[20:21], v[72:73], v[26:27] neg_lo:[0,1] neg_hi:[0,1]
v_pk_add_f32 v[72:73], v[72:73], v[26:27]
v_pk_add_f32 v[26:27], v[22:23], v[24:25] neg_lo:[0,1] neg_hi:[0,1]
v_pk_add_f32 v[22:23], v[22:23], v[24:25]
v_pk_add_f32 v[24:25], v[64:65], v[34:35] neg_lo:[0,1] neg_hi:[0,1]
v_pk_add_f32 v[64:65], v[64:65], v[34:35]
v_pk_add_f32 v[34:35], v[30:31], v[36:37] neg_lo:[0,1] neg_hi:[0,1]
v_pk_add_f32 v[30:31], v[30:31], v[36:37]
v_pk_add_f32 v[36:37], v[28:29], v[42:43] neg_lo:[0,1] neg_hi:[0,1]
v_pk_add_f32 v[28:29], v[28:29], v[42:43]
v_pk_add_f32 v[42:43], v[38:39], v[32:33] neg_lo:[0,1] neg_hi:[0,1]
v_pk_add_f32 v[38:39], v[38:39], v[32:33]
v_pk_add_f32 v[32:33], v[14:15], v[50:51] neg_lo:[0,1] neg_hi:[0,1]
v_pk_add_f32 v[14:15], v[14:15], v[50:51]
v_pk_add_f32 v[50:51], v[46:47], v[52:53] neg_lo:[0,1] neg_hi:[0,1]
v_pk_add_f32 v[46:47], v[46:47], v[52:53]
v_pk_add_f32 v[52:53], v[44:45], v[58:59] neg_lo:[0,1] neg_hi:[0,1]
v_pk_add_f32 v[44:45], v[44:45], v[58:59]
v_pk_add_f32 v[58:59], v[54:55], v[56:57] neg_lo:[0,1] neg_hi:[0,1]
v_pk_add_f32 v[54:55], v[54:55], v[56:57]
v_pk_add_f32 v[56:57], v[40:41], v[66:67] neg_lo:[0,1] neg_hi:[0,1]
v_pk_add_f32 v[40:41], v[40:41], v[66:67]
v_pk_add_f32 v[66:67], v[62:63], v[68:69] neg_lo:[0,1] neg_hi:[0,1]
v_pk_add_f32 v[62:63], v[62:63], v[68:69]
v_pk_add_f32 v[68:69], v[60:61], v[74:75] neg_lo:[0,1] neg_hi:[0,1]
v_pk_add_f32 v[60:61], v[60:61], v[74:75]
v_pk_add_f32 v[74:75], v[70:71], v[48:49] neg_lo:[0,1] neg_hi:[0,1]
v_pk_add_f32 v[70:71], v[70:71], v[48:49]
v_pk_mul_f32 v[48:49], v[14:15], v[82:83] op_sel:[0,0] op_sel_hi:[0,1] neg_lo:[0,0] neg_hi:[0,0]
v_pk_fma_f32 v[14:15], v[14:15], v[82:83], v[48:49] op_sel:[1,1,0] op_sel_hi:[1,0,1] neg_lo:[0,1,0] neg_hi:[0,0,0]
v_pk_mul_f32 v[48:49], v[64:65], v[84:85] op_sel:[0,0] op_sel_hi:[0,1] neg_lo:[0,0] neg_hi:[0,0]
v_pk_fma_f32 v[64:65], v[64:65], v[84:85], v[48:49] op_sel:[1,1,0] op_sel_hi:[1,0,1] neg_lo:[0,1,0] neg_hi:[0,0,0]
v_pk_mul_f32 v[48:49], v[40:41], v[86:87] op_sel:[0,0] op_sel_hi:[0,1] neg_lo:[0,0] neg_hi:[0,0]
v_pk_fma_f32 v[40:41], v[40:41], v[86:87], v[48:49] op_sel:[1,1,0] op_sel_hi:[1,0,1] neg_lo:[0,1,0] neg_hi:[0,0,0]
v_pk_mul_f32 v[48:49], v[72:73], v[88:89] op_sel:[0,0] op_sel_hi:[0,1] neg_lo:[0,0] neg_hi:[0,0]
v_pk_fma_f32 v[72:73], v[72:73], v[88:89], v[48:49] op_sel:[1,1,0] op_sel_hi:[1,0,1] neg_lo:[0,1,0] neg_hi:[0,0,0]
v_pk_mul_f32 v[48:49], v[44:45], v[90:91] op_sel:[0,0] op_sel_hi:[0,1] neg_lo:[0,0] neg_hi:[0,0]
v_pk_fma_f32 v[44:45], v[44:45], v[90:91], v[48:49] op_sel:[1,1,0] op_sel_hi:[1,0,1] neg_lo:[0,1,0] neg_hi:[0,0,0]
v_pk_mul_f32 v[48:49], v[28:29], v[92:93] op_sel:[0,0] op_sel_hi:[0,1] neg_lo:[0,0] neg_hi:[0,0]
v_pk_fma_f32 v[28:29], v[28:29], v[92:93], v[48:49] op_sel:[1,1,0] op_sel_hi:[1,0,1] neg_lo:[0,1,0] neg_hi:[0,0,0]
v_pk_mul_f32 v[48:49], v[60:61], v[94:95] op_sel:[0,0] op_sel_hi:[0,1] neg_lo:[0,0] neg_hi:[0,0]
v_pk_fma_f32 v[60:61], v[60:61], v[94:95], v[48:49] op_sel:[1,1,0] op_sel_hi:[1,0,1] neg_lo:[0,1,0] neg_hi:[0,0,0]
v_pk_mul_f32 v[48:49], v[76:77], v[96:97] op_sel:[0,0] op_sel_hi:[0,1] neg_lo:[0,0] neg_hi:[0,0]
v_pk_fma_f32 v[76:77], v[76:77], v[96:97], v[48:49] op_sel:[1,1,0] op_sel_hi:[1,0,1] neg_lo:[0,1,0] neg_hi:[0,0,0]
v_pk_mul_f32 v[48:49], v[46:47], v[98:99] op_sel:[0,0] op_sel_hi:[0,1] neg_lo:[0,0] neg_hi:[0,0]
v_pk_fma_f32 v[46:47], v[46:47], v[98:99], v[48:49] op_sel:[1,1,0] op_sel_hi:[1,0,1] neg_lo:[0,1,0] neg_hi:[0,0,0]
v_pk_mul_f32 v[48:49], v[30:31], v[100:101] op_sel:[0,0] op_sel_hi:[0,1] neg_lo:[0,0] neg_hi:[0,0]
v_pk_fma_f32 v[30:31], v[30:31], v[100:101], v[48:49] op_sel:[1,1,0] op_sel_hi:[1,0,1] neg_lo:[0,1,0] neg_hi:[0,0,0]
v_pk_mul_f32 v[48:49], v[62:63], v[102:103] op_sel:[0,0] op_sel_hi:[0,1] neg_lo:[0,0] neg_hi:[0,0]
v_pk_fma_f32 v[62:63], v[62:63], v[102:103], v[48:49] op_sel:[1,1,0] op_sel_hi:[1,0,1] neg_lo:[0,1,0] neg_hi:[0,0,0]
v_pk_mul_f32 v[48:49], v[22:23], v[104:105] op_sel:[0,0] op_sel_hi:[0,1] neg_lo:[0,0] neg_hi:[0,0]
v_pk_fma_f32 v[22:23], v[22:23], v[104:105], v[48:49] op_sel:[1,1,0] op_sel_hi:[1,0,1] neg_lo:[0,1,0] neg_hi:[0,0,0]
v_pk_mul_f32 v[48:49], v[54:55], v[106:107] op_sel:[0,0] op_sel_hi:[0,1] neg_lo:[0,0] neg_hi:[0,0]
v_pk_fma_f32 v[54:55], v[54:55], v[106:107], v[48:49] op_sel:[1,1,0] op_sel_hi:[1,0,1] neg_lo:[0,1,0] neg_hi:[0,0,0]
v_pk_mul_f32 v[48:49], v[38:39], v[108:109] op_sel:[0,0] op_sel_hi:[0,1] neg_lo:[0,0] neg_hi:[0,0]
v_pk_fma_f32 v[38:39], v[38:39], v[108:109], v[48:49] op_sel:[1,1,0] op_sel_hi:[1,0,1] neg_lo:[0,1,0] neg_hi:[0,0,0]
v_pk_mul_f32 v[48:49], v[70:71], v[110:111] op_sel:[0,0] op_sel_hi:[0,1] neg_lo:[0,0] neg_hi:[0,0]
v_pk_fma_f32 v[70:71], v[70:71], v[110:111], v[48:49] op_sel:[1,1,0] op_sel_hi:[1,0,1] neg_lo:[0,1,0] neg_hi:[0,0,0]
v_pk_mul_f32 v[48:49], v[78:79], v[112:113] op_sel:[0,0] op_sel_hi:[0,1] neg_lo:[0,0] neg_hi:[0,0]
v_pk_fma_f32 v[78:79], v[78:79], v[112:113], v[48:49] op_sel:[1,1,0] op_sel_hi:[1,0,1] neg_lo:[0,1,0] neg_hi:[0,0,0]
v_pk_mul_f32 v[48:49], v[32:33], v[114:115] op_sel:[0,0] op_sel_hi:[0,1] neg_lo:[0,0] neg_hi:[0,0]
v_pk_fma_f32 v[32:33], v[32:33], v[114:115], v[48:49] op_sel:[1,1,0] op_sel_hi:[1,0,1] neg_lo:[0,1,0] neg_hi:[0,0,0]
v_pk_mul_f32 v[48:49], v[24:25], v[116:117] op_sel:[0,0] op_sel_hi:[0,1] neg_lo:[0,0] neg_hi:[0,0]
v_pk_fma_f32 v[24:25], v[24:25], v[116:117], v[48:49] op_sel:[1,1,0] op_sel_hi:[1,0,1] neg_lo:[0,1,0] neg_hi:[0,0,0]
v_pk_mul_f32 v[48:49], v[56:57], v[118:119] op_sel:[0,0] op_sel_hi:[0,1] neg_lo:[0,0] neg_hi:[0,0]
v_pk_fma_f32 v[56:57], v[56:57], v[118:119], v[48:49] op_sel:[1,1,0] op_sel_hi:[1,0,1] neg_lo:[0,1,0] neg_hi:[0,0,0]
v_pk_mul_f32 v[48:49], v[20:21], v[120:121] op_sel:[0,0] op_sel_hi:[0,1] neg_lo:[0,0] neg_hi:[0,0]
v_pk_fma_f32 v[20:21], v[20:21], v[120:121], v[48:49] op_sel:[1,1,0] op_sel_hi:[1,0,1] neg_lo:[0,1,0] neg_hi:[0,0,0]
v_pk_mul_f32 v[48:49], v[52:53], v[122:123] op_sel:[0,0] op_sel_hi:[0,1] neg_lo:[0,0] neg_hi:[0,0]
v_pk_fma_f32 v[52:53], v[52:53], v[122:123], v[48:49] op_sel:[1,1,0] op_sel_hi:[1,0,1] neg_lo:[0,1,0] neg_hi:[0,0,0]
v_pk_mul_f32 v[48:49], v[36:37], v[124:125] op_sel:[0,0] op_sel_hi:[0,1] neg_lo:[0,0] neg_hi:[0,0]
v_pk_fma_f32 v[36:37], v[36:37], v[124:125], v[48:49] op_sel:[1,1,0] op_sel_hi:[1,0,1] neg_lo:[0,1,0] neg_hi:[0,0,0]
v_pk_mul_f32 v[48:49], v[68:69], v[126:127] op_sel:[0,0] op_sel_hi:[0,1] neg_lo:[0,0] neg_hi:[0,0]
v_pk_fma_f32 v[68:69], v[68:69], v[126:127], v[48:49] op_sel:[1,1,0] op_sel_hi:[1,0,1] neg_lo:[0,1,0] neg_hi:[0,0,0]
v_pk_mul_f32 v[48:49], v[18:19], v[128:129] op_sel:[0,0] op_sel_hi:[0,1] neg_lo:[0,0] neg_hi:[0,0]
v_pk_fma_f32 v[18:19], v[18:19], v[128:129], v[48:49] op_sel:[1,1,0] op_sel_hi:[1,0,1] neg_lo:[0,1,0] neg_hi:[0,0,0]
v_pk_mul_f32 v[48:49], v[50:51], v[130:131] op_sel:[0,0] op_sel_hi:[0,1] neg_lo:[0,0] neg_hi:[0,0]
v_pk_fma_f32 v[50:51], v[50:51], v[130:131], v[48:49] op_sel:[1,1,0] op_sel_hi:[1,0,1] neg_lo:[0,1,0] neg_hi:[0,0,0]
v_pk_mul_f32 v[48:49], v[34:35], v[132:133] op_sel:[0,0] op_sel_hi:[0,1] neg_lo:[0,0] neg_hi:[0,0]
v_pk_fma_f32 v[34:35], v[34:35], v[132:133], v[48:49] op_sel:[1,1,0] op_sel_hi:[1,0,1] neg_lo:[0,1,0] neg_hi:[0,0,0]
v_pk_mul_f32 v[48:49], v[66:67], v[134:135] op_sel:[0,0] op_sel_hi:[0,1] neg_lo:[0,0] neg_hi:[0,0]
v_pk_fma_f32 v[66:67], v[66:67], v[134:135], v[48:49] op_sel:[1,1,0] op_sel_hi:[1,0,1] neg_lo:[0,1,0] neg_hi:[0,0,0]
v_pk_mul_f32 v[48:49], v[26:27], v[136:137] op_sel:[0,0] op_sel_hi:[0,1] neg_lo:[0,0] neg_hi:[0,0]
v_pk_fma_f32 v[26:27], v[26:27], v[136:137], v[48:49] op_sel:[1,1,0] op_sel_hi:[1,0,1] neg_lo:[0,1,0] neg_hi:[0,0,0]
v_pk_mul_f32 v[48:49], v[58:59], v[138:139] op_sel:[0,0] op_sel_hi:[0,1] neg_lo:[0,0] neg_hi:[0,0]
v_pk_fma_f32 v[58:59], v[58:59], v[138:139], v[48:49] op_sel:[1,1,0] op_sel_hi:[1,0,1] neg_lo:[0,1,0] neg_hi:[0,0,0]
v_pk_mul_f32 v[48:49], v[42:43], v[140:141] op_sel:[0,0] op_sel_hi:[0,1] neg_lo:[0,0] neg_hi:[0,0]
v_pk_fma_f32 v[42:43], v[42:43], v[140:141], v[48:49] op_sel:[1,1,0] op_sel_hi:[1,0,1] neg_lo:[0,1,0] neg_hi:[0,0,0]
v_pk_mul_f32 v[48:49], v[74:75], v[142:143] op_sel:[0,0] op_sel_hi:[0,1] neg_lo:[0,0] neg_hi:[0,0]
v_pk_fma_f32 v[74:75], v[74:75], v[142:143], v[48:49] op_sel:[1,1,0] op_sel_hi:[1,0,1] neg_lo:[0,1,0] neg_hi:[0,0,0]
ds_write_b64 v3, v[16:17] offset:0
ds_write_b64 v3, v[14:15] offset:528
ds_write_b64 v3, v[64:65] offset:1056
ds_write_b64 v3, v[40:41] offset:1584
ds_write_b64 v3, v[72:73] offset:2112
ds_write_b64 v3, v[44:45] offset:2640
ds_write_b64 v3, v[28:29] offset:3168
ds_write_b64 v3, v[60:61] offset:3696
ds_write_b64 v3, v[76:77] offset:4224
ds_write_b64 v3, v[46:47] offset:4752
ds_write_b64 v3, v[30:31] offset:5280
ds_write_b64 v3, v[62:63] offset:5808
ds_write_b64 v3, v[22:23] offset:6336
ds_write_b64 v3, v[54:55] offset:6864
ds_write_b64 v3, v[38:39] offset:7392
ds_write_b64 v3, v[70:71] offset:7920
ds_write_b64 v3, v[78:79] offset:8448
ds_write_b64 v3, v[32:33] offset:8976
ds_write_b64 v3, v[24:25] offset:9504
ds_write_b64 v3, v[56:57] offset:10032
ds_write_b64 v3, v[20:21] offset:10560
ds_write_b64 v3, v[52:53] offset:11088
ds_write_b64 v3, v[36:37] offset:11616
ds_write_b64 v3, v[68:69] offset:12144
ds_write_b64 v3, v[18:19] offset:12672
ds_write_b64 v3, v[50:51] offset:13200
ds_write_b64 v3, v[34:35] offset:13728
ds_write_b64 v3, v[66:67] offset:14256
ds_write_b64 v3, v[26:27] offset:14784
ds_write_b64 v3, v[58:59] offset:15312
ds_write_b64 v3, v[42:43] offset:15840
ds_write_b64 v3, v[74:75] offset:16368
s_waitcnt lgkmcnt(0)
ds_read_b64 v[16:17], v4 offset:0
ds_read_b64 v[48:49], v4 offset:256
ds_read_b64 v[18:19], v4 offset:16
ds_read_b64 v[50:51], v4 offset:272
ds_read_b64 v[20:21], v4 offset:32
ds_read_b64 v[52:53], v4 offset:288
ds_read_b64 v[22:23], v4 offset:48
ds_read_b64 v[54:55], v4 offset:304
ds_read_b64 v[24:25], v4 offset:64
ds_read_b64 v[56:57], v4 offset:320
ds_read_b64 v[26:27], v4 offset:80
ds_read_b64 v[58:59], v4 offset:336
ds_read_b64 v[28:29], v4 offset:96
ds_read_b64 v[60:61], v4 offset:352
ds_read_b64 v[30:31], v4 offset:112
ds_read_b64 v[62:63], v4 offset:368
ds_read_b64 v[32:33], v4 offset:128
ds_read_b64 v[64:65], v4 offset:384
ds_read_b64 v[34:35], v4 offset:144
ds_read_b64 v[66:67], v4 offset:400
ds_read_b64 v[36:37], v4 offset:160
ds_read_b64 v[68:69], v4 offset:416
ds_read_b64 v[38:39], v4 offset:176
ds_read_b64 v[70:71], v4 offset:432
ds_read_b64 v[40:41], v4 offset:192
ds_read_b64 v[72:73], v4 offset:448
ds_read_b64 v[42:43], v4 offset:208
ds_read_b64 v[74:75], v4 offset:464
ds_read_b64 v[44:45], v4 offset:224
ds_read_b64 v[76:77], v4 offset:480
ds_read_b64 v[46:47], v4 offset:240
ds_read_b64 v[78:79], v4 offset:496
s_waitcnt lgkmcnt(0)
v_pk_add_f32 v[14:15], v[16:17], v[48:49] neg_lo:[0,1] neg_hi:[0,1]
v_pk_add_f32 v[16:17], v[16:17], v[48:49]
v_pk_add_f32 v[48:49], v[18:19], v[50:51] neg_lo:[0,1] neg_hi:[0,1]
v_pk_add_f32 v[18:19], v[18:19], v[50:51]
v_pk_mul_f32 v[50:51], v[48:49], s[50:51] op_sel:[0,0] op_sel_hi:[0,1] neg_lo:[0,0] neg_hi:[0,1]
v_pk_fma_f32 v[50:51], v[48:49], s[50:51], v[50:51] op_sel:[1,1,0] op_sel_hi:[1,0,1] neg_lo:[0,0,0] neg_hi:[0,0,0]
v_pk_add_f32 v[48:49], v[20:21], v[52:53] neg_lo:[0,1] neg_hi:[0,1]
v_pk_add_f32 v[20:21], v[20:21], v[52:53]
v_pk_mul_f32 v[52:53], v[48:49], s[54:55] op_sel:[0,0] op_sel_hi:[0,1] neg_lo:[0,0] neg_hi:[0,1]
v_pk_fma_f32 v[52:53], v[48:49], s[54:55], v[52:53] op_sel:[1,1,0] op_sel_hi:[1,0,1] neg_lo:[0,0,0] neg_hi:[0,0,0]
v_pk_add_f32 v[48:49], v[22:23], v[54:55] neg_lo:[0,1] neg_hi:[0,1]
v_pk_add_f32 v[22:23], v[22:23], v[54:55]
v_pk_mul_f32 v[54:55], v[48:49], s[58:59] op_sel:[0,0] op_sel_hi:[0,1] neg_lo:[0,0] neg_hi:[0,1]
v_pk_fma_f32 v[54:55], v[48:49], s[58:59], v[54:55] op_sel:[1,1,0] op_sel_hi:[1,0,1] neg_lo:[0,0,0] neg_hi:[0,0,0]
v_pk_add_f32 v[48:49], v[24:25], v[56:57] neg_lo:[0,1] neg_hi:[0,1]
v_pk_add_f32 v[24:25], v[24:25], v[56:57]
v_pk_mul_f32 v[56:57], v[48:49], s[62:63] op_sel:[0,0] op_sel_hi:[0,1] neg_lo:[0,0] neg_hi:[0,1]
v_pk_fma_f32 v[56:57], v[48:49], s[62:63], v[56:57] op_sel:[1,1,0] op_sel_hi:[1,0,1] neg_lo:[0,0,0] neg_hi:[0,0,0]
v_pk_add_f32 v[48:49], v[26:27], v[58:59] neg_lo:[0,1] neg_hi:[0,1]
v_pk_add_f32 v[26:27], v[26:27], v[58:59]
v_pk_mul_f32 v[58:59], v[48:49], s[58:59] op_sel:[0,1] op_sel_hi:[0,0] neg_lo:[0,0] neg_hi:[0,1]
v_pk_fma_f32 v[58:59], v[48:49], s[58:59], v[58:59] op_sel:[1,0,0] op_sel_hi:[1,1,1] neg_lo:[0,0,0] neg_hi:[0,0,0]
v_pk_add_f32 v[48:49], v[28:29], v[60:61] neg_lo:[0,1] neg_hi:[0,1]
v_pk_add_f32 v[28:29], v[28:29], v[60:61]
v_pk_mul_f32 v[60:61], v[48:49], s[54:55] op_sel:[0,1] op_sel_hi:[0,0] neg_lo:[0,0] neg_hi:[0,1]
v_pk_fma_f32 v[60:61], v[48:49], s[54:55], v[60:61] op_sel:[1,0,0] op_sel_hi:[1,1,1] neg_lo:[0,0,0] neg_hi:[0,0,0]
v_pk_add_f32 v[48:49], v[30:31], v[62:63] neg_lo:[0,1] neg_hi:[0,1]
v_pk_add_f32 v[30:31], v[30:31], v[62:63]
v_pk_mul_f32 v[62:63], v[48:49], s[50:51] op_sel:[0,1] op_sel_hi:[0,0] neg_lo:[0,0] neg_hi:[0,1]
v_pk_fma_f32 v[62:63], v[48:49], s[50:51], v[62:63] op_sel:[1,0,0] op_sel_hi:[1,1,1] neg_lo:[0,0,0] neg_hi:[0,0,0]
v_pk_add_f32 v[48:49], v[32:33], v[64:65] op_sel:[1,1] op_sel_hi:[0,0] neg_lo:[0,1] neg_hi:[1,0]
v_pk_add_f32 v[32:33], v[32:33], v[64:65]
v_pk_add_f32 v[64:65], v[34:35], v[66:67] neg_lo:[0,1] neg_hi:[0,1]
v_pk_add_f32 v[34:35], v[34:35], v[66:67]
v_pk_mul_f32 v[66:67], v[64:65], s[50:51] op_sel:[0,1] op_sel_hi:[0,0] neg_lo:[0,1] neg_hi:[0,1]
v_pk_fma_f32 v[66:67], v[64:65], s[50:51], v[66:67] op_sel:[1,0,0] op_sel_hi:[1,1,1] neg_lo:[0,0,0] neg_hi:[0,1,0]
v_pk_add_f32 v[64:65], v[36:37], v[68:69] neg_lo:[0,1] neg_hi:[0,1]
v_pk_add_f32 v[36:37], v[36:37], v[68:69]
v_pk_mul_f32 v[68:69], v[64:65], s[54:55] op_sel:[0,1] op_sel_hi:[0,0] neg_lo:[0,1] neg_hi:[0,1]
v_pk_fma_f32 v[68:69], v[64:65], s[54:55], v[68:69] op_sel:[1,0,0] op_sel_hi:[1,1,1] neg_lo:[0,0,0] neg_hi:[0,1,0]
v_pk_add_f32 v[64:65], v[38:39], v[70:71] neg_lo:[0,1] neg_hi:[0,1]
v_pk_add_f32 v[38:39], v[38:39], v[70:71]
v_pk_mul_f32 v[70:71], v[64:65], s[58:59] op_sel:[0,1] op_sel_hi:[0,0] neg_lo:[0,1] neg_hi:[0,1]
v_pk_fma_f32 v[70:71], v[64:65], s[58:59], v[70:71] op_sel:[1,0,0] op_sel_hi:[1,1,1] neg_lo:[0,0,0] neg_hi:[0,1,0]
v_pk_add_f32 v[64:65], v[40:41], v[72:73] neg_lo:[0,1] neg_hi:[0,1]
v_pk_add_f32 v[40:41], v[40:41], v[72:73]
v_pk_mul_f32 v[72:73], v[64:65], s[62:63] op_sel:[0,0] op_sel_hi:[0,1] neg_lo:[0,1] neg_hi:[0,1]
v_pk_fma_f32 v[72:73], v[64:65], s[62:63], v[72:73] op_sel:[1,1,0] op_sel_hi:[1,0,1] neg_lo:[0,0,0] neg_hi:[0,1,0]
v_pk_add_f32 v[64:65], v[42:43], v[74:75] neg_lo:[0,1] neg_hi:[0,1]
v_pk_add_f32 v[42:43], v[42:43], v[74:75]
v_pk_mul_f32 v[74:75], v[64:65], s[58:59] op_sel:[0,0] op_sel_hi:[0,1] neg_lo:[0,1] neg_hi:[0,1]
v_pk_fma_f32 v[74:75], v[64:65], s[58:59], v[74:75] op_sel:[1,1,0] op_sel_hi:[1,0,1] neg_lo:[0,0,0] neg_hi:[0,1,0]
v_pk_add_f32 v[64:65], v[44:45], v[76:77] neg_lo:[0,1] neg_hi:[0,1]
v_pk_add_f32 v[44:45], v[44:45], v[76:77]
v_pk_mul_f32 v[76:77], v[64:65], s[54:55] op_sel:[0,0] op_sel_hi:[0,1] neg_lo:[0,1] neg_hi:[0,1]
v_pk_fma_f32 v[76:77], v[64:65], s[54:55], v[76:77] op_sel:[1,1,0] op_sel_hi:[1,0,1] neg_lo:[0,0,0] neg_hi:[0,1,0]
v_pk_add_f32 v[64:65], v[46:47], v[78:79] neg_lo:[0,1] neg_hi:[0,1]
v_pk_add_f32 v[46:47], v[46:47], v[78:79]
v_pk_mul_f32 v[78:79], v[64:65], s[50:51] op_sel:[0,0] op_sel_hi:[0,1] neg_lo:[0,1] neg_hi:[0,1]
v_pk_fma_f32 v[78:79], v[64:65], s[50:51], v[78:79] op_sel:[1,1,0] op_sel_hi:[1,0,1] neg_lo:[0,0,0] neg_hi:[0,1,0]
v_pk_add_f32 v[64:65], v[16:17], v[32:33] neg_lo:[0,1] neg_hi:[0,1]
v_pk_add_f32 v[16:17], v[16:17], v[32:33]
v_pk_add_f32 v[32:33], v[18:19], v[34:35] neg_lo:[0,1] neg_hi:[0,1]
v_pk_add_f32 v[18:19], v[18:19], v[34:35]
v_pk_mul_f32 v[34:35], v[32:33], s[54:55] op_sel:[0,0] op_sel_hi:[0,1] neg_lo:[0,0] neg_hi:[0,1]
v_pk_fma_f32 v[34:35], v[32:33], s[54:55], v[34:35] op_sel:[1,1,0] op_sel_hi:[1,0,1] neg_lo:[0,0,0] neg_hi:[0,0,0]
v_pk_add_f32 v[32:33], v[20:21], v[36:37] neg_lo:[0,1] neg_hi:[0,1]
v_pk_add_f32 v[20:21], v[20:21], v[36:37]
v_pk_mul_f32 v[36:37], v[32:33], s[62:63] op_sel:[0,0] op_sel_hi:[0,1] neg_lo:[0,0] neg_hi:[0,1]
v_pk_fma_f32 v[36:37], v[32:33], s[62:63], v[36:37] op_sel:[1,1,0] op_sel_hi:[1,0,1] neg_lo:[0,0,0] neg_hi:[0,0,0]
v_pk_add_f32 v[32:33], v[22:23], v[38:39] neg_lo:[0,1] neg_hi:[0,1]
v_pk_add_f32 v[22:23], v[22:23], v[38:39]
v_pk_mul_f32 v[38:39], v[32:33], s[54:55] op_sel:[0,1] op_sel_hi:[0,0] neg_lo:[0,0] neg_hi:[0,1]
v_pk_fma_f32 v[38:39], v[32:33], s[54:55], v[38:39] op_sel:[1,0,0] op_sel_hi:[1,1,1] neg_lo:[0,0,0] neg_hi:[0,0,0]
v_pk_add_f32 v[32:33], v[24:25], v[40:41] op_sel:[1,1] op_sel_hi:[0,0] neg_lo:[0,1] neg_hi:[1,0]
v_pk_add_f32 v[24:25], v[24:25], v[40:41]
v_pk_add_f32 v[40:41], v[26:27], v[42:43] neg_lo:[0,1] neg_hi:[0,1]
v_pk_add_f32 v[26:27], v[26:27], v[42:43]
v_pk_mul_f32 v[42:43], v[40:41], s[54:55] op_sel:[0,1] op_sel_hi:[0,0] neg_lo:[0,1] neg_hi:[0,1]
v_pk_fma_f32 v[42:43], v[40:41], s[54:55], v[42:43] op_sel:[1,0,0] op_sel_hi:[1,1,1] neg_lo:[0,0,0] neg_hi:[0,1,0]
v_pk_add_f32 v[40:41], v[28:29], v[44:45] neg_lo:[0,1] neg_hi:[0,1]
v_pk_add_f32 v[28:29], v[28:29], v[44:45]
v_pk_mul_f32 v[44:45], v[40:41], s[62:63] op_sel:[0,0] op_sel_hi:[0,1] neg_lo:[0,1] neg_hi:[0,1]
v_pk_fma_f32 v[44:45], v[40:41], s[62:63], v[44:45] op_sel:[1,1,0] op_sel_hi:[1,0,1] neg_lo:[0,0,0] neg_hi:[0,1,0]
v_pk_add_f32 v[40:41], v[30:31], v[46:47] neg_lo:[0,1] neg_hi:[0,1]
v_pk_add_f32 v[30:31], v[30:31], v[46:47]
v_pk_mul_f32 v[46:47], v[40:41], s[54:55] op_sel:[0,0] op_sel_hi:[0,1] neg_lo:[0,1] neg_hi:[0,1]
v_pk_fma_f32 v[46:47], v[40:41], s[54:55], v[46:47] op_sel:[1,1,0] op_sel_hi:[1,0,1] neg_lo:[0,0,0] neg_hi:[0,1,0]
v_pk_add_f32 v[40:41], v[14:15], v[48:49] neg_lo:[0,1] neg_hi:[0,1]
v_pk_add_f32 v[14:15], v[14:15], v[48:49]
v_pk_add_f32 v[48:49], v[50:51], v[66:67] neg_lo:[0,1] neg_hi:[0,1]
v_pk_add_f32 v[50:51], v[50:51], v[66:67]
v_pk_mul_f32 v[66:67], v[48:49], s[54:55] op_sel:[0,0] op_sel_hi:[0,1] neg_lo:[0,0] neg_hi:[0,1]
v_pk_fma_f32 v[66:67], v[48:49], s[54:55], v[66:67] op_sel:[1,1,0] op_sel_hi:[1,0,1] neg_lo:[0,0,0] neg_hi:[0,0,0]
v_pk_add_f32 v[48:49], v[52:53], v[68:69] neg_lo:[0,1] neg_hi:[0,1]
v_pk_add_f32 v[52:53], v[52:53], v[68:69]
v_pk_mul_f32 v[68:69], v[48:49], s[62:63] op_sel:[0,0] op_sel_hi:[0,1] neg_lo:[0,0] neg_hi:[0,1]
v_pk_fma_f32 v[68:69], v[48:49], s[62:63], v[68:69] op_sel:[1,1,0] op_sel_hi:[1,0,1] neg_lo:[0,0,0] neg_hi:[0,0,0]
v_pk_add_f32 v[48:49], v[54:55], v[70:71] neg_lo:[0,1] neg_hi:[0,1]
v_pk_add_f32 v[54:55], v[54:55], v[70:71]
v_pk_mul_f32 v[70:71], v[48:49], s[54:55] op_sel:[0,1] op_sel_hi:[0,0] neg_lo:[0,0] neg_hi:[0,1]
v_pk_fma_f32 v[70:71], v[48:49], s[54:55], v[70:71] op_sel:[1,0,0] op_sel_hi:[1,1,1] neg_lo:[0,0,0] neg_hi:[0,0,0]
v_pk_add_f32 v[48:49], v[56:57], v[72:73] op_sel:[1,1] op_sel_hi:[0,0] neg_lo:[0,1] neg_hi:[1,0]
v_pk_add_f32 v[56:57], v[56:57], v[72:73]
v_pk_add_f32 v[72:73], v[58:59], v[74:75] neg_lo:[0,1] neg_hi:[0,1]
v_pk_add_f32 v[58:59], v[58:59], v[74:75]
v_pk_mul_f32 v[74:75], v[72:73], s[54:55] op_sel:[0,1] op_sel_hi:[0,0] neg_lo:[0,1] neg_hi:[0,1]
v_pk_fma_f32 v[74:75], v[72:73], s[54:55], v[74:75] op_sel:[1,0,0] op_sel_hi:[1,1,1] neg_lo:[0,0,0] neg_hi:[0,1,0]
v_pk_add_f32 v[72:73], v[60:61], v[76:77] neg_lo:[0,1] neg_hi:[0,1]
v_pk_add_f32 v[60:61], v[60:61], v[76:77]
v_pk_mul_f32 v[76:77], v[72:73], s[62:63] op_sel:[0,0] op_sel_hi:[0,1] neg_lo:[0,1] neg_hi:[0,1]
v_pk_fma_f32 v[76:77], v[72:73], s[62:63], v[76:77] op_sel:[1,1,0] op_sel_hi:[1,0,1] neg_lo:[0,0,0] neg_hi:[0,1,0]
v_pk_add_f32 v[72:73], v[62:63], v[78:79] neg_lo:[0,1] neg_hi:[0,1]
v_pk_add_f32 v[62:63], v[62:63], v[78:79]
v_pk_mul_f32 v[78:79], v[72:73], s[54:55] op_sel:[0,0] op_sel_hi:[0,1] neg_lo:[0,1] neg_hi:[0,1]
v_pk_fma_f32 v[78:79], v[72:73], s[54:55], v[78:79] op_sel:[1,1,0] op_sel_hi:[1,0,1] neg_lo:[0,0,0] neg_hi:[0,1,0]
v_pk_add_f32 v[72:73], v[16:17], v[24:25] neg_lo:[0,1] neg_hi:[0,1]
v_pk_add_f32 v[16:17], v[16:17], v[24:25]
v_pk_add_f32 v[24:25], v[18:19], v[26:27] neg_lo:[0,1] neg_hi:[0,1]
v_pk_add_f32 v[18:19], v[18:19], v[26:27]
v_pk_mul_f32 v[26:27], v[24:25], s[62:63] op_sel:[0,0] op_sel_hi:[0,1] neg_lo:[0,0] neg_hi:[0,1]
v_pk_fma_f32 v[26:27], v[24:25], s[62:63], v[26:27] op_sel:[1,1,0] op_sel_hi:[1,0,1] neg_lo:[0,0,0] neg_hi:[0,0,0]
v_pk_add_f32 v[24:25], v[20:21], v[28:29] op_sel:[1,1] op_sel_hi:[0,0] neg_lo:[0,1] neg_hi:[1,0]
v_pk_add_f32 v[20:21], v[20:21], v[28:29]
v_pk_add_f32 v[28:29], v[22:23], v[30:31] neg_lo:[0,1] neg_hi:[0,1]
v_pk_add_f32 v[22:23], v[22:23], v[30:31]
v_pk_mul_f32 v[30:31], v[28:29], s[62:63] op_sel:[0,0] op_sel_hi:[0,1] neg_lo:[0,1] neg_hi:[0,1]
v_pk_fma_f32 v[30:31], v[28:29], s[62:63], v[30:31] op_sel:[1,1,0] op_sel_hi:[1,0,1] neg_lo:[0,0,0] neg_hi:[0,1,0]
v_pk_add_f32 v[28:29], v[64:65], v[32:33] neg_lo:[0,1] neg_hi:[0,1]
v_pk_add_f32 v[64:65], v[64:65], v[32:33]
v_pk_add_f32 v[32:33], v[34:35], v[42:43] neg_lo:[0,1] neg_hi:[0,1]
v_pk_add_f32 v[34:35], v[34:35], v[42:43]
v_pk_mul_f32 v[42:43], v[32:33], s[62:63] op_sel:[0,0] op_sel_hi:[0,1] neg_lo:[0,0] neg_hi:[0,1]
v_pk_fma_f32 v[42:43], v[32:33], s[62:63], v[42:43] op_sel:[1,1,0] op_sel_hi:[1,0,1] neg_lo:[0,0,0] neg_hi:[0,0,0]
v_pk_add_f32 v[32:33], v[36:37], v[44:45] op_sel:[1,1] op_sel_hi:[0,0] neg_lo:[0,1] neg_hi:[1,0]
v_pk_add_f32 v[36:37], v[36:37], v[44:45]
v_pk_add_f32 v[44:45], v[38:39], v[46:47] neg_lo:[0,1] neg_hi:[0,1]
v_pk_add_f32 v[38:39], v[38:39], v[46:47]
v_pk_mul_f32 v[46:47], v[44:45], s[62:63] op_sel:[0,0] op_sel_hi:[0,1] neg_lo:[0,1] neg_hi:[0,1]
v_pk_fma_f32 v[46:47], v[44:45], s[62:63], v[46:47] op_sel:[1,1,0] op_sel_hi:[1,0,1] neg_lo:[0,0,0] neg_hi:[0,1,0]
v_pk_add_f32 v[44:45], v[14:15], v[56:57] neg_lo:[0,1] neg_hi:[0,1]
v_pk_add_f32 v[14:15], v[14:15], v[56:57]
v_pk_add_f32 v[56:57], v[50:51], v[58:59] neg_lo:[0,1] neg_hi:[0,1]
v_pk_add_f32 v[50:51], v[50:51], v[58:59]
v_pk_mul_f32 v[58:59], v[56:57], s[62:63] op_sel:[0,0] op_sel_hi:[0,1] neg_lo:[0,0] neg_hi:[0,1]
v_pk_fma_f32 v[58:59], v[56:57], s[62:63], v[58:59] op_sel:[1,1,0] op_sel_hi:[1,0,1] neg_lo:[0,0,0] neg_hi:[0,0,0]
v_pk_add_f32 v[56:57], v[52:53], v[60:61] op_sel:[1,1] op_sel_hi:[0,0] neg_lo:[0,1] neg_hi:[1,0]
v_pk_add_f32 v[52:53], v[52:53], v[60:61]
v_pk_add_f32 v[60:61], v[54:55], v[62:63] neg_lo:[0,1] neg_hi:[0,1]
v_pk_add_f32 v[54:55], v[54:55], v[62:63]
v_pk_mul_f32 v[62:63], v[60:61], s[62:63] op_sel:[0,0] op_sel_hi:[0,1] neg_lo:[0,1] neg_hi:[0,1]
v_pk_fma_f32 v[62:63], v[60:61], s[62:63], v[62:63] op_sel:[1,1,0] op_sel_hi:[1,0,1] neg_lo:[0,0,0] neg_hi:[0,1,0]
v_pk_add_f32 v[60:61], v[40:41], v[48:49] neg_lo:[0,1] neg_hi:[0,1]
v_pk_add_f32 v[40:41], v[40:41], v[48:49]
v_pk_add_f32 v[48:49], v[66:67], v[74:75] neg_lo:[0,1] neg_hi:[0,1]
v_pk_add_f32 v[66:67], v[66:67], v[74:75]
v_pk_mul_f32 v[74:75], v[48:49], s[62:63] op_sel:[0,0] op_sel_hi:[0,1] neg_lo:[0,0] neg_hi:[0,1]
v_pk_fma_f32 v[74:75], v[48:49], s[62:63], v[74:75] op_sel:[1,1,0] op_sel_hi:[1,0,1] neg_lo:[0,0,0] neg_hi:[0,0,0]
v_pk_add_f32 v[48:49], v[68:69], v[76:77] op_sel:[1,1] op_sel_hi:[0,0] neg_lo:[0,1] neg_hi:[1,0]
v_pk_add_f32 v[68:69], v[68:69], v[76:77]
v_pk_add_f32 v[76:77], v[70:71], v[78:79] neg_lo:[0,1] neg_hi:[0,1]
v_pk_add_f32 v[70:71], v[70:71], v[78:79]
v_pk_mul_f32 v[78:79], v[76:77], s[62:63] op_sel:[0,0] op_sel_hi:[0,1] neg_lo:[0,1] neg_hi:[0,1]
v_pk_fma_f32 v[78:79], v[76:77], s[62:63], v[78:79] op_sel:[1,1,0] op_sel_hi:[1,0,1] neg_lo:[0,0,0] neg_hi:[0,1,0]
v_pk_add_f32 v[76:77], v[16:17], v[20:21] neg_lo:[0,1] neg_hi:[0,1]
v_pk_add_f32 v[16:17], v[16:17], v[20:21]
v_pk_add_f32 v[20:21], v[18:19], v[22:23] op_sel:[1,1] op_sel_hi:[0,0] neg_lo:[0,1] neg_hi:[1,0]
v_pk_add_f32 v[18:19], v[18:19], v[22:23]
v_pk_add_f32 v[22:23], v[72:73], v[24:25] neg_lo:[0,1] neg_hi:[0,1]
v_pk_add_f32 v[72:73], v[72:73], v[24:25]
v_pk_add_f32 v[24:25], v[26:27], v[30:31] op_sel:[1,1] op_sel_hi:[0,0] neg_lo:[0,1] neg_hi:[1,0]
v_pk_add_f32 v[26:27], v[26:27], v[30:31]
v_pk_add_f32 v[30:31], v[64:65], v[36:37] neg_lo:[0,1] neg_hi:[0,1]
v_pk_add_f32 v[64:65], v[64:65], v[36:37]
v_pk_add_f32 v[36:37], v[34:35], v[38:39] op_sel:[1,1] op_sel_hi:[0,0] neg_lo:[0,1] neg_hi:[1,0]
v_pk_add_f32 v[34:35], v[34:35], v[38:39]
v_pk_add_f32 v[38:39], v[28:29], v[32:33] neg_lo:[0,1] neg_hi:[0,1]
v_pk_add_f32 v[28:29], v[28:29], v[32:33]
v_pk_add_f32 v[32:33], v[42:43], v[46:47] op_sel:[1,1] op_sel_hi:[0,0] neg_lo:[0,1] neg_hi:[1,0]
v_pk_add_f32 v[42:43], v[42:43], v[46:47]
v_pk_add_f32 v[46:47], v[14:15], v[52:53] neg_lo:[0,1] neg_hi:[0,1]
v_pk_add_f32 v[14:15], v[14:15], v[52:53]
v_pk_add_f32 v[52:53], v[50:51], v[54:55] op_sel:[1,1] op_sel_hi:[0,0] neg_lo:[0,1] neg_hi:[1,0]
v_pk_add_f32 v[50:51], v[50:51], v[54:55]
v_pk_add_f32 v[54:55], v[44:45], v[56:57] neg_lo:[0,1] neg_hi:[0,1]
v_pk_add_f32 v[44:45], v[44:45], v[56:57]
v_pk_add_f32 v[56:57], v[58:59], v[62:63] op_sel:[1,1] op_sel_hi:[0,0] neg_lo:[0,1] neg_hi:[1,0]
v_pk_add_f32 v[58:59], v[58:59], v[62:63]
v_pk_add_f32 v[62:63], v[40:41], v[68:69] neg_lo:[0,1] neg_hi:[0,1]
v_pk_add_f32 v[40:41], v[40:41], v[68:69]
v_pk_add_f32 v[68:69], v[66:67], v[70:71] op_sel:[1,1] op_sel_hi:[0,0] neg_lo:[0,1] neg_hi:[1,0]
v_pk_add_f32 v[66:67], v[66:67], v[70:71]
v_pk_add_f32 v[70:71], v[60:61], v[48:49] neg_lo:[0,1] neg_hi:[0,1]
v_pk_add_f32 v[60:61], v[60:61], v[48:49]
v_pk_add_f32 v[48:49], v[74:75], v[78:79] op_sel:[1,1] op_sel_hi:[0,0] neg_lo:[0,1] neg_hi:[1,0]
v_pk_add_f32 v[74:75], v[74:75], v[78:79]
v_pk_add_f32 v[78:79], v[16:17], v[18:19] neg_lo:[0,1] neg_hi:[0,1]
v_pk_add_f32 v[16:17], v[16:17], v[18:19]
v_pk_add_f32 v[18:19], v[76:77], v[20:21] neg_lo:[0,1] neg_hi:[0,1]
v_pk_add_f32 v[76:77], v[76:77], v[20:21]
v_pk_add_f32 v[20:21], v[72:73], v[26:27] neg_lo:[0,1] neg_hi:[0,1]
v_pk_add_f32 v[72:73], v[72:73], v[26:27]
v_pk_add_f32 v[26:27], v[22:23], v[24:25] neg_lo:[0,1] neg_hi:[0,1]
v_pk_add_f32 v[22:23], v[22:23], v[24:25]
v_pk_add_f32 v[24:25], v[64:65], v[34:35] neg_lo:[0,1] neg_hi:[0,1]
v_pk_add_f32 v[64:65], v[64:65], v[34:35]
v_pk_add_f32 v[34:35], v[30:31], v[36:37] neg_lo:[0,1] neg_hi:[0,1]
v_pk_add_f32 v[30:31], v[30:31], v[36:37]
v_pk_add_f32 v[36:37], v[28:29], v[42:43] neg_lo:[0,1] neg_hi:[0,1]
v_pk_add_f32 v[28:29], v[28:29], v[42:43]
v_pk_add_f32 v[42:43], v[38:39], v[32:33] neg_lo:[0,1] neg_hi:[0,1]
v_pk_add_f32 v[38:39], v[38:39], v[32:33]
v_pk_add_f32 v[32:33], v[14:15], v[50:51] neg_lo:[0,1] neg_hi:[0,1]
v_pk_add_f32 v[14:15], v[14:15], v[50:51]
v_pk_add_f32 v[50:51], v[46:47], v[52:53] neg_lo:[0,1] neg_hi:[0,1]
v_pk_add_f32 v[46:47], v[46:47], v[52:53]
v_pk_add_f32 v[52:53], v[44:45], v[58:59] neg_lo:[0,1] neg_hi:[0,1]
v_pk_add_f32 v[44:45], v[44:45], v[58:59]
v_pk_add_f32 v[58:59], v[54:55], v[56:57] neg_lo:[0,1] neg_hi:[0,1]
v_pk_add_f32 v[54:55], v[54:55], v[56:57]
v_pk_add_f32 v[56:57], v[40:41], v[66:67] neg_lo:[0,1] neg_hi:[0,1]
v_pk_add_f32 v[40:41], v[40:41], v[66:67]
v_pk_add_f32 v[66:67], v[62:63], v[68:69] neg_lo:[0,1] neg_hi:[0,1]
v_pk_add_f32 v[62:63], v[62:63], v[68:69]
v_pk_add_f32 v[68:69], v[60:61], v[74:75] neg_lo:[0,1] neg_hi:[0,1]
v_pk_add_f32 v[60:61], v[60:61], v[74:75]
v_pk_add_f32 v[74:75], v[70:71], v[48:49] neg_lo:[0,1] neg_hi:[0,1]
v_pk_add_f32 v[70:71], v[70:71], v[48:49]
s_mov_b64 exec, s[18:19]
v_pk_add_f32 v[16:17], v[16:17], 0 neg_lo:[1,0] neg_hi:[1,0]
v_pk_mul_f32 v[48:49], v[14:15], s[48:49] op_sel:[0,0] op_sel_hi:[0,1] neg_lo:[0,1] neg_hi:[0,0]
v_pk_fma_f32 v[14:15], v[14:15], s[48:49], v[48:49] op_sel:[1,1,0] op_sel_hi:[1,0,1] neg_lo:[0,1,0] neg_hi:[0,1,0]
v_pk_mul_f32 v[48:49], v[64:65], s[50:51] op_sel:[0,0] op_sel_hi:[0,1] neg_lo:[0,1] neg_hi:[0,0]
v_pk_fma_f32 v[64:65], v[64:65], s[50:51], v[48:49] op_sel:[1,1,0] op_sel_hi:[1,0,1] neg_lo:[0,1,0] neg_hi:[0,1,0]
v_pk_mul_f32 v[48:49], v[40:41], s[52:53] op_sel:[0,0] op_sel_hi:[0,1] neg_lo:[0,1] neg_hi:[0,0]
v_pk_fma_f32 v[40:41], v[40:41], s[52:53], v[48:49] op_sel:[1,1,0] op_sel_hi:[1,0,1] neg_lo:[0,1,0] neg_hi:[0,1,0]
v_pk_mul_f32 v[48:49], v[72:73], s[54:55] op_sel:[0,0] op_sel_hi:[0,1] neg_lo:[0,1] neg_hi:[0,0]
v_pk_fma_f32 v[72:73], v[72:73], s[54:55], v[48:49] op_sel:[1,1,0] op_sel_hi:[1,0,1] neg_lo:[0,1,0] neg_hi:[0,1,0]
v_pk_mul_f32 v[48:49], v[44:45], s[56:57] op_sel:[0,0] op_sel_hi:[0,1] neg_lo:[0,1] neg_hi:[0,0]
v_pk_fma_f32 v[44:45], v[44:45], s[56:57], v[48:49] op_sel:[1,1,0] op_sel_hi:[1,0,1] neg_lo:[0,1,0] neg_hi:[0,1,0]
v_pk_mul_f32 v[48:49], v[28:29], s[58:59] op_sel:[0,0] op_sel_hi:[0,1] neg_lo:[0,1] neg_hi:[0,0]
v_pk_fma_f32 v[28:29], v[28:29], s[58:59], v[48:49] op_sel:[1,1,0] op_sel_hi:[1,0,1] neg_lo:[0,1,0] neg_hi:[0,1,0]
v_pk_mul_f32 v[48:49], v[60:61], s[60:61] op_sel:[0,0] op_sel_hi:[0,1] neg_lo:[0,1] neg_hi:[0,0]
v_pk_fma_f32 v[60:61], v[60:61], s[60:61], v[48:49] op_sel:[1,1,0] op_sel_hi:[1,0,1] neg_lo:[0,1,0] neg_hi:[0,1,0]
v_pk_mul_f32 v[48:49], v[76:77], s[62:63] op_sel:[0,0] op_sel_hi:[0,1] neg_lo:[0,1] neg_hi:[0,0]
v_pk_fma_f32 v[76:77], v[76:77], s[62:63], v[48:49] op_sel:[1,1,0] op_sel_hi:[1,0,1] neg_lo:[0,1,0] neg_hi:[0,1,0]
v_pk_mul_f32 v[48:49], v[46:47], s[60:61] op_sel:[0,1] op_sel_hi:[0,0] neg_lo:[0,1] neg_hi:[0,0]
v_pk_fma_f32 v[46:47], v[46:47], s[60:61], v[48:49] op_sel:[1,0,0] op_sel_hi:[1,1,1] neg_lo:[0,1,0] neg_hi:[0,1,0]
v_pk_mul_f32 v[48:49], v[30:31], s[58:59] op_sel:[0,1] op_sel_hi:[0,0] neg_lo:[0,1] neg_hi:[0,0]
v_pk_fma_f32 v[30:31], v[30:31], s[58:59], v[48:49] op_sel:[1,0,0] op_sel_hi:[1,1,1] neg_lo:[0,1,0] neg_hi:[0,1,0]
v_pk_mul_f32 v[48:49], v[62:63], s[56:57] op_sel:[0,1] op_sel_hi:[0,0] neg_lo:[0,1] neg_hi:[0,0]
v_pk_fma_f32 v[62:63], v[62:63], s[56:57], v[48:49] op_sel:[1,0,0] op_sel_hi:[1,1,1] neg_lo:[0,1,0] neg_hi:[0,1,0]
v_pk_mul_f32 v[48:49], v[22:23], s[54:55] op_sel:[0,1] op_sel_hi:[0,0] neg_lo:[0,1] neg_hi:[0,0]
v_pk_fma_f32 v[22:23], v[22:23], s[54:55], v[48:49] op_sel:[1,0,0] op_sel_hi:[1,1,1] neg_lo:[0,1,0] neg_hi:[0,1,0]
v_pk_mul_f32 v[48:49], v[54:55], s[52:53] op_sel:[0,1] op_sel_hi:[0,0] neg_lo:[0,1] neg_hi:[0,0]
v_pk_fma_f32 v[54:55], v[54:55], s[52:53], v[48:49] op_sel:[1,0,0] op_sel_hi:[1,1,1] neg_lo:[0,1,0] neg_hi:[0,1,0]
v_pk_mul_f32 v[48:49], v[38:39], s[50:51] op_sel:[0,1] op_sel_hi:[0,0] neg_lo:[0,1] neg_hi:[0,0]
v_pk_fma_f32 v[38:39], v[38:39], s[50:51], v[48:49] op_sel:[1,0,0] op_sel_hi:[1,1,1] neg_lo:[0,1,0] neg_hi:[0,1,0]
v_pk_mul_f32 v[48:49], v[70:71], s[48:49] op_sel:[0,1] op_sel_hi:[0,0] neg_lo:[0,1] neg_hi:[0,0]
v_pk_fma_f32 v[70:71], v[70:71], s[48:49], v[48:49] op_sel:[1,0,0] op_sel_hi:[1,1,1] neg_lo:[0,1,0] neg_hi:[0,1,0]
v_pk_add_f32 v[78:79], v[78:79], 0 op_sel:[1,0] op_sel_hi:[0,0] neg_lo:[1,0] neg_hi:[0,0]
v_pk_mul_f32 v[48:49], v[32:33], s[48:49] op_sel:[0,1] op_sel_hi:[0,0] neg_lo:[0,0] neg_hi:[0,0]
v_pk_fma_f32 v[32:33], v[32:33], s[48:49], v[48:49] op_sel:[1,0,0] op_sel_hi:[1,1,1] neg_lo:[0,1,0] neg_hi:[0,0,0]
v_pk_mul_f32 v[48:49], v[24:25], s[50:51] op_sel:[0,1] op_sel_hi:[0,0] neg_lo:[0,0] neg_hi:[0,0]
v_pk_fma_f32 v[24:25], v[24:25], s[50:51], v[48:49] op_sel:[1,0,0] op_sel_hi:[1,1,1] neg_lo:[0,1,0] neg_hi:[0,0,0]
v_pk_mul_f32 v[48:49], v[56:57], s[52:53] op_sel:[0,1] op_sel_hi:[0,0] neg_lo:[0,0] neg_hi:[0,0]
v_pk_fma_f32 v[56:57], v[56:57], s[52:53], v[48:49] op_sel:[1,0,0] op_sel_hi:[1,1,1] neg_lo:[0,1,0] neg_hi:[0,0,0]
v_pk_mul_f32 v[48:49], v[20:21], s[54:55] op_sel:[0,1] op_sel_hi:[0,0] neg_lo:[0,0] neg_hi:[0,0]
v_pk_fma_f32 v[20:21], v[20:21], s[54:55], v[48:49] op_sel:[1,0,0] op_sel_hi:[1,1,1] neg_lo:[0,1,0] neg_hi:[0,0,0]
v_pk_mul_f32 v[48:49], v[52:53], s[56:57] op_sel:[0,1] op_sel_hi:[0,0] neg_lo:[0,0] neg_hi:[0,0]
v_pk_fma_f32 v[52:53], v[52:53], s[56:57], v[48:49] op_sel:[1,0,0] op_sel_hi:[1,1,1] neg_lo:[0,1,0] neg_hi:[0,0,0]
v_pk_mul_f32 v[48:49], v[36:37], s[58:59] op_sel:[0,1] op_sel_hi:[0,0] neg_lo:[0,0] neg_hi:[0,0]
v_pk_fma_f32 v[36:37], v[36:37], s[58:59], v[48:49] op_sel:[1,0,0] op_sel_hi:[1,1,1] neg_lo:[0,1,0] neg_hi:[0,0,0]
v_pk_mul_f32 v[48:49], v[68:69], s[60:61] op_sel:[0,1] op_sel_hi:[0,0] neg_lo:[0,0] neg_hi:[0,0]
v_pk_fma_f32 v[68:69], v[68:69], s[60:61], v[48:49] op_sel:[1,0,0] op_sel_hi:[1,1,1] neg_lo:[0,1,0] neg_hi:[0,0,0]
v_pk_mul_f32 v[48:49], v[18:19], s[62:63] op_sel:[0,0] op_sel_hi:[0,1] neg_lo:[0,0] neg_hi:[0,0]
v_pk_fma_f32 v[18:19], v[18:19], s[62:63], v[48:49] op_sel:[1,1,0] op_sel_hi:[1,0,1] neg_lo:[0,1,0] neg_hi:[0,0,0]
v_pk_mul_f32 v[48:49], v[50:51], s[60:61] op_sel:[0,0] op_sel_hi:[0,1] neg_lo:[0,0] neg_hi:[0,0]
v_pk_fma_f32 v[50:51], v[50:51], s[60:61], v[48:49] op_sel:[1,1,0] op_sel_hi:[1,0,1] neg_lo:[0,1,0] neg_hi:[0,0,0]
v_pk_mul_f32 v[48:49], v[34:35], s[58:59] op_sel:[0,0] op_sel_hi:[0,1] neg_lo:[0,0] neg_hi:[0,0]
v_pk_fma_f32 v[34:35], v[34:35], s[58:59], v[48:49] op_sel:[1,1,0] op_sel_hi:[1,0,1] neg_lo:[0,1,0] neg_hi:[0,0,0]
v_pk_mul_f32 v[48:49], v[66:67], s[56:57] op_sel:[0,0] op_sel_hi:[0,1] neg_lo:[0,0] neg_hi:[0,0]
v_pk_fma_f32 v[66:67], v[66:67], s[56:57], v[48:49] op_sel:[1,1,0] op_sel_hi:[1,0,1] neg_lo:[0,1,0] neg_hi:[0,0,0]
v_pk_mul_f32 v[48:49], v[26:27], s[54:55] op_sel:[0,0] op_sel_hi:[0,1] neg_lo:[0,0] neg_hi:[0,0]
v_pk_fma_f32 v[26:27], v[26:27], s[54:55], v[48:49] op_sel:[1,1,0] op_sel_hi:[1,0,1] neg_lo:[0,1,0] neg_hi:[0,0,0]
v_pk_mul_f32 v[48:49], v[58:59], s[52:53] op_sel:[0,0] op_sel_hi:[0,1] neg_lo:[0,0] neg_hi:[0,0]
v_pk_fma_f32 v[58:59], v[58:59], s[52:53], v[48:49] op_sel:[1,1,0] op_sel_hi:[1,0,1] neg_lo:[0,1,0] neg_hi:[0,0,0]
v_pk_mul_f32 v[48:49], v[42:43], s[50:51] op_sel:[0,0] op_sel_hi:[0,1] neg_lo:[0,0] neg_hi:[0,0]
v_pk_fma_f32 v[42:43], v[42:43], s[50:51], v[48:49] op_sel:[1,1,0] op_sel_hi:[1,0,1] neg_lo:[0,1,0] neg_hi:[0,0,0]
v_pk_mul_f32 v[48:49], v[74:75], s[48:49] op_sel:[0,0] op_sel_hi:[0,1] neg_lo:[0,0] neg_hi:[0,0]
v_pk_fma_f32 v[74:75], v[74:75], s[48:49], v[48:49] op_sel:[1,1,0] op_sel_hi:[1,0,1] neg_lo:[0,1,0] neg_hi:[0,0,0]
s_mov_b64 exec, -1
v_fmac_f32_dpp v16, v16, v9 quad_perm:[1,0,3,2] row_mask:0xf bank_mask:0xf
v_fmac_f32_dpp v17, v17, v9 quad_perm:[1,0,3,2] row_mask:0xf bank_mask:0xf
v_fmac_f32_dpp v14, v14, v9 quad_perm:[1,0,3,2] row_mask:0xf bank_mask:0xf
v_fmac_f32_dpp v15, v15, v9 quad_perm:[1,0,3,2] row_mask:0xf bank_mask:0xf
v_fmac_f32_dpp v64, v64, v9 quad_perm:[1,0,3,2] row_mask:0xf bank_mask:0xf
v_fmac_f32_dpp v65, v65, v9 quad_perm:[1,0,3,2] row_mask:0xf bank_mask:0xf
v_fmac_f32_dpp v40, v40, v9 quad_perm:[1,0,3,2] row_mask:0xf bank_mask:0xf
v_fmac_f32_dpp v41, v41, v9 quad_perm:[1,0,3,2] row_mask:0xf bank_mask:0xf
v_fmac_f32_dpp v72, v72, v9 quad_perm:[1,0,3,2] row_mask:0xf bank_mask:0xf
v_fmac_f32_dpp v73, v73, v9 quad_perm:[1,0,3,2] row_mask:0xf bank_mask:0xf
v_fmac_f32_dpp v44, v44, v9 quad_perm:[1,0,3,2] row_mask:0xf bank_mask:0xf
v_fmac_f32_dpp v45, v45, v9 quad_perm:[1,0,3,2] row_mask:0xf bank_mask:0xf
v_fmac_f32_dpp v28, v28, v9 quad_perm:[1,0,3,2] row_mask:0xf bank_mask:0xf
v_fmac_f32_dpp v29, v29, v9 quad_perm:[1,0,3,2] row_mask:0xf bank_mask:0xf
v_fmac_f32_dpp v60, v60, v9 quad_perm:[1,0,3,2] row_mask:0xf bank_mask:0xf
v_fmac_f32_dpp v61, v61, v9 quad_perm:[1,0,3,2] row_mask:0xf bank_mask:0xf
v_fmac_f32_dpp v76, v76, v9 quad_perm:[1,0,3,2] row_mask:0xf bank_mask:0xf
v_fmac_f32_dpp v77, v77, v9 quad_perm:[1,0,3,2] row_mask:0xf bank_mask:0xf
v_fmac_f32_dpp v46, v46, v9 quad_perm:[1,0,3,2] row_mask:0xf bank_mask:0xf
v_fmac_f32_dpp v47, v47, v9 quad_perm:[1,0,3,2] row_mask:0xf bank_mask:0xf
v_fmac_f32_dpp v30, v30, v9 quad_perm:[1,0,3,2] row_mask:0xf bank_mask:0xf
v_fmac_f32_dpp v31, v31, v9 quad_perm:[1,0,3,2] row_mask:0xf bank_mask:0xf
v_fmac_f32_dpp v62, v62, v9 quad_perm:[1,0,3,2] row_mask:0xf bank_mask:0xf
v_fmac_f32_dpp v63, v63, v9 quad_perm:[1,0,3,2] row_mask:0xf bank_mask:0xf
v_fmac_f32_dpp v22, v22, v9 quad_perm:[1,0,3,2] row_mask:0xf bank_mask:0xf
v_fmac_f32_dpp v23, v23, v9 quad_perm:[1,0,3,2] row_mask:0xf bank_mask:0xf
v_fmac_f32_dpp v54, v54, v9 quad_perm:[1,0,3,2] row_mask:0xf bank_mask:0xf
v_fmac_f32_dpp v55, v55, v9 quad_perm:[1,0,3,2] row_mask:0xf bank_mask:0xf
v_fmac_f32_dpp v38, v38, v9 quad_perm:[1,0,3,2] row_mask:0xf bank_mask:0xf
v_fmac_f32_dpp v39, v39, v9 quad_perm:[1,0,3,2] row_mask:0xf bank_mask:0xf
v_fmac_f32_dpp v70, v70, v9 quad_perm:[1,0,3,2] row_mask:0xf bank_mask:0xf
v_fmac_f32_dpp v71, v71, v9 quad_perm:[1,0,3,2] row_mask:0xf bank_mask:0xf
v_fmac_f32_dpp v78, v78, v9 quad_perm:[1,0,3,2] row_mask:0xf bank_mask:0xf
v_fmac_f32_dpp v79, v79, v9 quad_perm:[1,0,3,2] row_mask:0xf bank_mask:0xf
v_fmac_f32_dpp v32, v32, v9 quad_perm:[1,0,3,2] row_mask:0xf bank_mask:0xf
v_fmac_f32_dpp v33, v33, v9 quad_perm:[1,0,3,2] row_mask:0xf bank_mask:0xf
v_fmac_f32_dpp v24, v24, v9 quad_perm:[1,0,3,2] row_mask:0xf bank_mask:0xf
v_fmac_f32_dpp v25, v25, v9 quad_perm:[1,0,3,2] row_mask:0xf bank_mask:0xf
v_fmac_f32_dpp v56, v56, v9 quad_perm:[1,0,3,2] row_mask:0xf bank_mask:0xf
v_fmac_f32_dpp v57, v57, v9 quad_perm:[1,0,3,2] row_mask:0xf bank_mask:0xf
v_fmac_f32_dpp v20, v20, v9 quad_perm:[1,0,3,2] row_mask:0xf bank_mask:0xf
v_fmac_f32_dpp v21, v21, v9 quad_perm:[1,0,3,2] row_mask:0xf bank_mask:0xf
v_fmac_f32_dpp v52, v52, v9 quad_perm:[1,0,3,2] row_mask:0xf bank_mask:0xf
v_fmac_f32_dpp v53, v53, v9 quad_perm:[1,0,3,2] row_mask:0xf bank_mask:0xf
v_fmac_f32_dpp v36, v36, v9 quad_perm:[1,0,3,2] row_mask:0xf bank_mask:0xf
v_fmac_f32_dpp v37, v37, v9 quad_perm:[1,0,3,2] row_mask:0xf bank_mask:0xf
v_fmac_f32_dpp v68, v68, v9 quad_perm:[1,0,3,2] row_mask:0xf bank_mask:0xf
v_fmac_f32_dpp v69, v69, v9 quad_perm:[1,0,3,2] row_mask:0xf bank_mask:0xf
v_fmac_f32_dpp v18, v18, v9 quad_perm:[1,0,3,2] row_mask:0xf bank_mask:0xf
v_fmac_f32_dpp v19, v19, v9 quad_perm:[1,0,3,2] row_mask:0xf bank_mask:0xf
v_fmac_f32_dpp v50, v50, v9 quad_perm:[1,0,3,2] row_mask:0xf bank_mask:0xf
v_fmac_f32_dpp v51, v51, v9 quad_perm:[1,0,3,2] row_mask:0xf bank_mask:0xf
v_fmac_f32_dpp v34, v34, v9 quad_perm:[1,0,3,2] row_mask:0xf bank_mask:0xf
v_fmac_f32_dpp v35, v35, v9 quad_perm:[1,0,3,2] row_mask:0xf bank_mask:0xf
v_fmac_f32_dpp v66, v66, v9 quad_perm:[1,0,3,2] row_mask:0xf bank_mask:0xf
v_fmac_f32_dpp v67, v67, v9 quad_perm:[1,0,3,2] row_mask:0xf bank_mask:0xf
v_fmac_f32_dpp v26, v26, v9 quad_perm:[1,0,3,2] row_mask:0xf bank_mask:0xf
v_fmac_f32_dpp v27, v27, v9 quad_perm:[1,0,3,2] row_mask:0xf bank_mask:0xf
v_fmac_f32_dpp v58, v58, v9 quad_perm:[1,0,3,2] row_mask:0xf bank_mask:0xf
v_fmac_f32_dpp v59, v59, v9 quad_perm:[1,0,3,2] row_mask:0xf bank_mask:0xf
v_fmac_f32_dpp v42, v42, v9 quad_perm:[1,0,3,2] row_mask:0xf bank_mask:0xf
v_fmac_f32_dpp v43, v43, v9 quad_perm:[1,0,3,2] row_mask:0xf bank_mask:0xf
v_fmac_f32_dpp v74, v74, v9 quad_perm:[1,0,3,2] row_mask:0xf bank_mask:0xf
v_fmac_f32_dpp v75, v75, v9 quad_perm:[1,0,3,2] row_mask:0xf bank_mask:0xf
v_lshlrev_b32 v240, 16, v208
v_and_b32 v241, 0xffff0000, v208
v_pk_mul_f32 v[48:49], v[16:17], v[240:241] op_sel:[0,0] op_sel_hi:[0,1] neg_lo:[0,0] neg_hi:[0,0]
v_pk_fma_f32 v[16:17], v[16:17], v[240:241], v[48:49] op_sel:[1,1,0] op_sel_hi:[1,0,1] neg_lo:[0,1,0] neg_hi:[0,0,0]
v_lshlrev_b32 v240, 16, v209
v_and_b32 v241, 0xffff0000, v209
v_pk_mul_f32 v[48:49], v[14:15], v[240:241] op_sel:[0,0] op_sel_hi:[0,1] neg_lo:[0,0] neg_hi:[0,0]
v_pk_fma_f32 v[14:15], v[14:15], v[240:241], v[48:49] op_sel:[1,1,0] op_sel_hi:[1,0,1] neg_lo:[0,1,0] neg_hi:[0,0,0]
v_lshlrev_b32 v240, 16, v210
v_and_b32 v241, 0xffff0000, v210
v_pk_mul_f32 v[48:49], v[64:65], v[240:241] op_sel:[0,0] op_sel_hi:[0,1] neg_lo:[0,0] neg_hi:[0,0]
v_pk_fma_f32 v[64:65], v[64:65], v[240:241], v[48:49] op_sel:[1,1,0] op_sel_hi:[1,0,1] neg_lo:[0,1,0] neg_hi:[0,0,0]
v_lshlrev_b32 v240, 16, v211
v_and_b32 v241, 0xffff0000, v211
v_pk_mul_f32 v[48:49], v[40:41], v[240:241] op_sel:[0,0] op_sel_hi:[0,1] neg_lo:[0,0] neg_hi:[0,0]
v_pk_fma_f32 v[40:41], v[40:41], v[240:241], v[48:49] op_sel:[1,1,0] op_sel_hi:[1,0,1] neg_lo:[0,1,0] neg_hi:[0,0,0]
v_lshlrev_b32 v240, 16, v212
v_and_b32 v241, 0xffff0000, v212
v_pk_mul_f32 v[48:49], v[72:73], v[240:241] op_sel:[0,0] op_sel_hi:[0,1] neg_lo:[0,0] neg_hi:[0,0]
v_pk_fma_f32 v[72:73], v[72:73], v[240:241], v[48:49] op_sel:[1,1,0] op_sel_hi:[1,0,1] neg_lo:[0,1,0] neg_hi:[0,0,0]
v_lshlrev_b32 v240, 16, v213
v_and_b32 v241, 0xffff0000, v213
v_pk_mul_f32 v[48:49], v[44:45], v[240:241] op_sel:[0,0] op_sel_hi:[0,1] neg_lo:[0,0] neg_hi:[0,0]
v_pk_fma_f32 v[44:45], v[44:45], v[240:241], v[48:49] op_sel:[1,1,0] op_sel_hi:[1,0,1] neg_lo:[0,1,0] neg_hi:[0,0,0]
v_lshlrev_b32 v240, 16, v214
v_and_b32 v241, 0xffff0000, v214
v_pk_mul_f32 v[48:49], v[28:29], v[240:241] op_sel:[0,0] op_sel_hi:[0,1] neg_lo:[0,0] neg_hi:[0,0]
v_pk_fma_f32 v[28:29], v[28:29], v[240:241], v[48:49] op_sel:[1,1,0] op_sel_hi:[1,0,1] neg_lo:[0,1,0] neg_hi:[0,0,0]
v_lshlrev_b32 v240, 16, v215
v_and_b32 v241, 0xffff0000, v215
v_pk_mul_f32 v[48:49], v[60:61], v[240:241] op_sel:[0,0] op_sel_hi:[0,1] neg_lo:[0,0] neg_hi:[0,0]
v_pk_fma_f32 v[60:61], v[60:61], v[240:241], v[48:49] op_sel:[1,1,0] op_sel_hi:[1,0,1] neg_lo:[0,1,0] neg_hi:[0,0,0]
v_lshlrev_b32 v240, 16, v216
v_and_b32 v241, 0xffff0000, v216
v_pk_mul_f32 v[48:49], v[76:77], v[240:241] op_sel:[0,0] op_sel_hi:[0,1] neg_lo:[0,0] neg_hi:[0,0]
v_pk_fma_f32 v[76:77], v[76:77], v[240:241], v[48:49] op_sel:[1,1,0] op_sel_hi:[1,0,1] neg_lo:[0,1,0] neg_hi:[0,0,0]
v_lshlrev_b32 v240, 16, v217
v_and_b32 v241, 0xffff0000, v217
v_pk_mul_f32 v[48:49], v[46:47], v[240:241] op_sel:[0,0] op_sel_hi:[0,1] neg_lo:[0,0] neg_hi:[0,0]
v_pk_fma_f32 v[46:47], v[46:47], v[240:241], v[48:49] op_sel:[1,1,0] op_sel_hi:[1,0,1] neg_lo:[0,1,0] neg_hi:[0,0,0]
v_lshlrev_b32 v240, 16, v218
v_and_b32 v241, 0xffff0000, v218
v_pk_mul_f32 v[48:49], v[30:31], v[240:241] op_sel:[0,0] op_sel_hi:[0,1] neg_lo:[0,0] neg_hi:[0,0]
v_pk_fma_f32 v[30:31], v[30:31], v[240:241], v[48:49] op_sel:[1,1,0] op_sel_hi:[1,0,1] neg_lo:[0,1,0] neg_hi:[0,0,0]
v_lshlrev_b32 v240, 16, v219
v_and_b32 v241, 0xffff0000, v219
v_pk_mul_f32 v[48:49], v[62:63], v[240:241] op_sel:[0,0] op_sel_hi:[0,1] neg_lo:[0,0] neg_hi:[0,0]
v_pk_fma_f32 v[62:63], v[62:63], v[240:241], v[48:49] op_sel:[1,1,0] op_sel_hi:[1,0,1] neg_lo:[0,1,0] neg_hi:[0,0,0]
v_lshlrev_b32 v240, 16, v220
v_and_b32 v241, 0xffff0000, v220
v_pk_mul_f32 v[48:49], v[22:23], v[240:241] op_sel:[0,0] op_sel_hi:[0,1] neg_lo:[0,0] neg_hi:[0,0]
v_pk_fma_f32 v[22:23], v[22:23], v[240:241], v[48:49] op_sel:[1,1,0] op_sel_hi:[1,0,1] neg_lo:[0,1,0] neg_hi:[0,0,0]
v_lshlrev_b32 v240, 16, v221
v_and_b32 v241, 0xffff0000, v221
v_pk_mul_f32 v[48:49], v[54:55], v[240:241] op_sel:[0,0] op_sel_hi:[0,1] neg_lo:[0,0] neg_hi:[0,0]
v_pk_fma_f32 v[54:55], v[54:55], v[240:241], v[48:49] op_sel:[1,1,0] op_sel_hi:[1,0,1] neg_lo:[0,1,0] neg_hi:[0,0,0]
v_lshlrev_b32 v240, 16, v222
v_and_b32 v241, 0xffff0000, v222
v_pk_mul_f32 v[48:49], v[38:39], v[240:241] op_sel:[0,0] op_sel_hi:[0,1] neg_lo:[0,0] neg_hi:[0,0]
v_pk_fma_f32 v[38:39], v[38:39], v[240:241], v[48:49] op_sel:[1,1,0] op_sel_hi:[1,0,1] neg_lo:[0,1,0] neg_hi:[0,0,0]
v_lshlrev_b32 v240, 16, v223
v_and_b32 v241, 0xffff0000, v223
v_pk_mul_f32 v[48:49], v[70:71], v[240:241] op_sel:[0,0] op_sel_hi:[0,1] neg_lo:[0,0] neg_hi:[0,0]
v_pk_fma_f32 v[70:71], v[70:71], v[240:241], v[48:49] op_sel:[1,1,0] op_sel_hi:[1,0,1] neg_lo:[0,1,0] neg_hi:[0,0,0]
v_lshlrev_b32 v240, 16, v224
v_and_b32 v241, 0xffff0000, v224
v_pk_mul_f32 v[48:49], v[78:79], v[240:241] op_sel:[0,0] op_sel_hi:[0,1] neg_lo:[0,0] neg_hi:[0,0]
v_pk_fma_f32 v[78:79], v[78:79], v[240:241], v[48:49] op_sel:[1,1,0] op_sel_hi:[1,0,1] neg_lo:[0,1,0] neg_hi:[0,0,0]
v_lshlrev_b32 v240, 16, v225
v_and_b32 v241, 0xffff0000, v225
v_pk_mul_f32 v[48:49], v[32:33], v[240:241] op_sel:[0,0] op_sel_hi:[0,1] neg_lo:[0,0] neg_hi:[0,0]
v_pk_fma_f32 v[32:33], v[32:33], v[240:241], v[48:49] op_sel:[1,1,0] op_sel_hi:[1,0,1] neg_lo:[0,1,0] neg_hi:[0,0,0]
v_lshlrev_b32 v240, 16, v226
v_and_b32 v241, 0xffff0000, v226
v_pk_mul_f32 v[48:49], v[24:25], v[240:241] op_sel:[0,0] op_sel_hi:[0,1] neg_lo:[0,0] neg_hi:[0,0]
v_pk_fma_f32 v[24:25], v[24:25], v[240:241], v[48:49] op_sel:[1,1,0] op_sel_hi:[1,0,1] neg_lo:[0,1,0] neg_hi:[0,0,0]
v_lshlrev_b32 v240, 16, v227
v_and_b32 v241, 0xffff0000, v227
v_pk_mul_f32 v[48:49], v[56:57], v[240:241] op_sel:[0,0] op_sel_hi:[0,1] neg_lo:[0,0] neg_hi:[0,0]
v_pk_fma_f32 v[56:57], v[56:57], v[240:241], v[48:49] op_sel:[1,1,0] op_sel_hi:[1,0,1] neg_lo:[0,1,0] neg_hi:[0,0,0]
v_lshlrev_b32 v240, 16, v228
v_and_b32 v241, 0xffff0000, v228
v_pk_mul_f32 v[48:49], v[20:21], v[240:241] op_sel:[0,0] op_sel_hi:[0,1] neg_lo:[0,0] neg_hi:[0,0]
v_pk_fma_f32 v[20:21], v[20:21], v[240:241], v[48:49] op_sel:[1,1,0] op_sel_hi:[1,0,1] neg_lo:[0,1,0] neg_hi:[0,0,0]
v_lshlrev_b32 v240, 16, v229
v_and_b32 v241, 0xffff0000, v229
v_pk_mul_f32 v[48:49], v[52:53], v[240:241] op_sel:[0,0] op_sel_hi:[0,1] neg_lo:[0,0] neg_hi:[0,0]
v_pk_fma_f32 v[52:53], v[52:53], v[240:241], v[48:49] op_sel:[1,1,0] op_sel_hi:[1,0,1] neg_lo:[0,1,0] neg_hi:[0,0,0]
v_lshlrev_b32 v240, 16, v230
v_and_b32 v241, 0xffff0000, v230
v_pk_mul_f32 v[48:49], v[36:37], v[240:241] op_sel:[0,0] op_sel_hi:[0,1] neg_lo:[0,0] neg_hi:[0,0]
v_pk_fma_f32 v[36:37], v[36:37], v[240:241], v[48:49] op_sel:[1,1,0] op_sel_hi:[1,0,1] neg_lo:[0,1,0] neg_hi:[0,0,0]
v_lshlrev_b32 v240, 16, v231
v_and_b32 v241, 0xffff0000, v231
v_pk_mul_f32 v[48:49], v[68:69], v[240:241] op_sel:[0,0] op_sel_hi:[0,1] neg_lo:[0,0] neg_hi:[0,0]
v_pk_fma_f32 v[68:69], v[68:69], v[240:241], v[48:49] op_sel:[1,1,0] op_sel_hi:[1,0,1] neg_lo:[0,1,0] neg_hi:[0,0,0]
v_lshlrev_b32 v240, 16, v232
v_and_b32 v241, 0xffff0000, v232
v_pk_mul_f32 v[48:49], v[18:19], v[240:241] op_sel:[0,0] op_sel_hi:[0,1] neg_lo:[0,0] neg_hi:[0,0]
v_pk_fma_f32 v[18:19], v[18:19], v[240:241], v[48:49] op_sel:[1,1,0] op_sel_hi:[1,0,1] neg_lo:[0,1,0] neg_hi:[0,0,0]
v_lshlrev_b32 v240, 16, v233
v_and_b32 v241, 0xffff0000, v233
v_pk_mul_f32 v[48:49], v[50:51], v[240:241] op_sel:[0,0] op_sel_hi:[0,1] neg_lo:[0,0] neg_hi:[0,0]
v_pk_fma_f32 v[50:51], v[50:51], v[240:241], v[48:49] op_sel:[1,1,0] op_sel_hi:[1,0,1] neg_lo:[0,1,0] neg_hi:[0,0,0]
v_lshlrev_b32 v240, 16, v234
v_and_b32 v241, 0xffff0000, v234
v_pk_mul_f32 v[48:49], v[34:35], v[240:241] op_sel:[0,0] op_sel_hi:[0,1] neg_lo:[0,0] neg_hi:[0,0]
v_pk_fma_f32 v[34:35], v[34:35], v[240:241], v[48:49] op_sel:[1,1,0] op_sel_hi:[1,0,1] neg_lo:[0,1,0] neg_hi:[0,0,0]
v_lshlrev_b32 v240, 16, v235
v_and_b32 v241, 0xffff0000, v235
v_pk_mul_f32 v[48:49], v[66:67], v[240:241] op_sel:[0,0] op_sel_hi:[0,1] neg_lo:[0,0] neg_hi:[0,0]
v_pk_fma_f32 v[66:67], v[66:67], v[240:241], v[48:49] op_sel:[1,1,0] op_sel_hi:[1,0,1] neg_lo:[0,1,0] neg_hi:[0,0,0]
v_lshlrev_b32 v240, 16, v236
v_and_b32 v241, 0xffff0000, v236
v_pk_mul_f32 v[48:49], v[26:27], v[240:241] op_sel:[0,0] op_sel_hi:[0,1] neg_lo:[0,0] neg_hi:[0,0]
v_pk_fma_f32 v[26:27], v[26:27], v[240:241], v[48:49] op_sel:[1,1,0] op_sel_hi:[1,0,1] neg_lo:[0,1,0] neg_hi:[0,0,0]
v_lshlrev_b32 v240, 16, v237
v_and_b32 v241, 0xffff0000, v237
v_pk_mul_f32 v[48:49], v[58:59], v[240:241] op_sel:[0,0] op_sel_hi:[0,1] neg_lo:[0,0] neg_hi:[0,0]
v_pk_fma_f32 v[58:59], v[58:59], v[240:241], v[48:49] op_sel:[1,1,0] op_sel_hi:[1,0,1] neg_lo:[0,1,0] neg_hi:[0,0,0]
v_lshlrev_b32 v240, 16, v238
v_and_b32 v241, 0xffff0000, v238
v_pk_mul_f32 v[48:49], v[42:43], v[240:241] op_sel:[0,0] op_sel_hi:[0,1] neg_lo:[0,0] neg_hi:[0,0]
v_pk_fma_f32 v[42:43], v[42:43], v[240:241], v[48:49] op_sel:[1,1,0] op_sel_hi:[1,0,1] neg_lo:[0,1,0] neg_hi:[0,0,0]
v_lshlrev_b32 v240, 16, v239
v_and_b32 v241, 0xffff0000, v239
v_pk_mul_f32 v[48:49], v[74:75], v[240:241] op_sel:[0,0] op_sel_hi:[0,1] neg_lo:[0,0] neg_hi:[0,0]
v_pk_fma_f32 v[74:75], v[74:75], v[240:241], v[48:49] op_sel:[1,1,0] op_sel_hi:[1,0,1] neg_lo:[0,1,0] neg_hi:[0,0,0]
v_fmac_f32_dpp v16, v16, v7 quad_perm:[1,0,3,2] row_mask:0xf bank_mask:0xf
v_fmac_f32_dpp v17, v17, v7 quad_perm:[1,0,3,2] row_mask:0xf bank_mask:0xf
v_fmac_f32_dpp v14, v14, v7 quad_perm:[1,0,3,2] row_mask:0xf bank_mask:0xf
v_fmac_f32_dpp v15, v15, v7 quad_perm:[1,0,3,2] row_mask:0xf bank_mask:0xf
v_fmac_f32_dpp v64, v64, v7 quad_perm:[1,0,3,2] row_mask:0xf bank_mask:0xf
v_fmac_f32_dpp v65, v65, v7 quad_perm:[1,0,3,2] row_mask:0xf bank_mask:0xf
v_fmac_f32_dpp v40, v40, v7 quad_perm:[1,0,3,2] row_mask:0xf bank_mask:0xf
v_fmac_f32_dpp v41, v41, v7 quad_perm:[1,0,3,2] row_mask:0xf bank_mask:0xf
v_fmac_f32_dpp v72, v72, v7 quad_perm:[1,0,3,2] row_mask:0xf bank_mask:0xf
v_fmac_f32_dpp v73, v73, v7 quad_perm:[1,0,3,2] row_mask:0xf bank_mask:0xf
v_fmac_f32_dpp v44, v44, v7 quad_perm:[1,0,3,2] row_mask:0xf bank_mask:0xf
v_fmac_f32_dpp v45, v45, v7 quad_perm:[1,0,3,2] row_mask:0xf bank_mask:0xf
v_fmac_f32_dpp v28, v28, v7 quad_perm:[1,0,3,2] row_mask:0xf bank_mask:0xf
v_fmac_f32_dpp v29, v29, v7 quad_perm:[1,0,3,2] row_mask:0xf bank_mask:0xf
v_fmac_f32_dpp v60, v60, v7 quad_perm:[1,0,3,2] row_mask:0xf bank_mask:0xf
v_fmac_f32_dpp v61, v61, v7 quad_perm:[1,0,3,2] row_mask:0xf bank_mask:0xf
v_fmac_f32_dpp v76, v76, v7 quad_perm:[1,0,3,2] row_mask:0xf bank_mask:0xf
v_fmac_f32_dpp v77, v77, v7 quad_perm:[1,0,3,2] row_mask:0xf bank_mask:0xf
v_fmac_f32_dpp v46, v46, v7 quad_perm:[1,0,3,2] row_mask:0xf bank_mask:0xf
v_fmac_f32_dpp v47, v47, v7 quad_perm:[1,0,3,2] row_mask:0xf bank_mask:0xf
v_fmac_f32_dpp v30, v30, v7 quad_perm:[1,0,3,2] row_mask:0xf bank_mask:0xf
v_fmac_f32_dpp v31, v31, v7 quad_perm:[1,0,3,2] row_mask:0xf bank_mask:0xf
v_fmac_f32_dpp v62, v62, v7 quad_perm:[1,0,3,2] row_mask:0xf bank_mask:0xf
v_fmac_f32_dpp v63, v63, v7 quad_perm:[1,0,3,2] row_mask:0xf bank_mask:0xf
v_fmac_f32_dpp v22, v22, v7 quad_perm:[1,0,3,2] row_mask:0xf bank_mask:0xf
v_fmac_f32_dpp v23, v23, v7 quad_perm:[1,0,3,2] row_mask:0xf bank_mask:0xf
v_fmac_f32_dpp v54, v54, v7 quad_perm:[1,0,3,2] row_mask:0xf bank_mask:0xf
v_fmac_f32_dpp v55, v55, v7 quad_perm:[1,0,3,2] row_mask:0xf bank_mask:0xf
v_fmac_f32_dpp v38, v38, v7 quad_perm:[1,0,3,2] row_mask:0xf bank_mask:0xf
v_fmac_f32_dpp v39, v39, v7 quad_perm:[1,0,3,2] row_mask:0xf bank_mask:0xf
v_fmac_f32_dpp v70, v70, v7 quad_perm:[1,0,3,2] row_mask:0xf bank_mask:0xf
v_fmac_f32_dpp v71, v71, v7 quad_perm:[1,0,3,2] row_mask:0xf bank_mask:0xf
v_fmac_f32_dpp v78, v78, v7 quad_perm:[1,0,3,2] row_mask:0xf bank_mask:0xf
v_fmac_f32_dpp v79, v79, v7 quad_perm:[1,0,3,2] row_mask:0xf bank_mask:0xf
v_fmac_f32_dpp v32, v32, v7 quad_perm:[1,0,3,2] row_mask:0xf bank_mask:0xf
v_fmac_f32_dpp v33, v33, v7 quad_perm:[1,0,3,2] row_mask:0xf bank_mask:0xf
v_fmac_f32_dpp v24, v24, v7 quad_perm:[1,0,3,2] row_mask:0xf bank_mask:0xf
v_fmac_f32_dpp v25, v25, v7 quad_perm:[1,0,3,2] row_mask:0xf bank_mask:0xf
v_fmac_f32_dpp v56, v56, v7 quad_perm:[1,0,3,2] row_mask:0xf bank_mask:0xf
v_fmac_f32_dpp v57, v57, v7 quad_perm:[1,0,3,2] row_mask:0xf bank_mask:0xf
v_fmac_f32_dpp v20, v20, v7 quad_perm:[1,0,3,2] row_mask:0xf bank_mask:0xf
v_fmac_f32_dpp v21, v21, v7 quad_perm:[1,0,3,2] row_mask:0xf bank_mask:0xf
v_fmac_f32_dpp v52, v52, v7 quad_perm:[1,0,3,2] row_mask:0xf bank_mask:0xf
v_fmac_f32_dpp v53, v53, v7 quad_perm:[1,0,3,2] row_mask:0xf bank_mask:0xf
v_fmac_f32_dpp v36, v36, v7 quad_perm:[1,0,3,2] row_mask:0xf bank_mask:0xf
v_fmac_f32_dpp v37, v37, v7 quad_perm:[1,0,3,2] row_mask:0xf bank_mask:0xf
v_fmac_f32_dpp v68, v68, v7 quad_perm:[1,0,3,2] row_mask:0xf bank_mask:0xf
v_fmac_f32_dpp v69, v69, v7 quad_perm:[1,0,3,2] row_mask:0xf bank_mask:0xf
v_fmac_f32_dpp v18, v18, v7 quad_perm:[1,0,3,2] row_mask:0xf bank_mask:0xf
v_fmac_f32_dpp v19, v19, v7 quad_perm:[1,0,3,2] row_mask:0xf bank_mask:0xf
v_fmac_f32_dpp v50, v50, v7 quad_perm:[1,0,3,2] row_mask:0xf bank_mask:0xf
v_fmac_f32_dpp v51, v51, v7 quad_perm:[1,0,3,2] row_mask:0xf bank_mask:0xf
v_fmac_f32_dpp v34, v34, v7 quad_perm:[1,0,3,2] row_mask:0xf bank_mask:0xf
v_fmac_f32_dpp v35, v35, v7 quad_perm:[1,0,3,2] row_mask:0xf bank_mask:0xf
v_fmac_f32_dpp v66, v66, v7 quad_perm:[1,0,3,2] row_mask:0xf bank_mask:0xf
v_fmac_f32_dpp v67, v67, v7 quad_perm:[1,0,3,2] row_mask:0xf bank_mask:0xf
v_fmac_f32_dpp v26, v26, v7 quad_perm:[1,0,3,2] row_mask:0xf bank_mask:0xf
v_fmac_f32_dpp v27, v27, v7 quad_perm:[1,0,3,2] row_mask:0xf bank_mask:0xf
v_fmac_f32_dpp v58, v58, v7 quad_perm:[1,0,3,2] row_mask:0xf bank_mask:0xf
v_fmac_f32_dpp v59, v59, v7 quad_perm:[1,0,3,2] row_mask:0xf bank_mask:0xf
v_fmac_f32_dpp v42, v42, v7 quad_perm:[1,0,3,2] row_mask:0xf bank_mask:0xf
v_fmac_f32_dpp v43, v43, v7 quad_perm:[1,0,3,2] row_mask:0xf bank_mask:0xf
v_fmac_f32_dpp v74, v74, v7 quad_perm:[1,0,3,2] row_mask:0xf bank_mask:0xf
v_fmac_f32_dpp v75, v75, v7 quad_perm:[1,0,3,2] row_mask:0xf bank_mask:0xf
s_mov_b64 exec, s[18:19]
v_pk_add_f32 v[16:17], v[16:17], 0 neg_lo:[1,0] neg_hi:[1,0]
v_pk_mul_f32 v[48:49], v[14:15], s[48:49] op_sel:[0,0] op_sel_hi:[0,1] neg_lo:[0,1] neg_hi:[0,1]
v_pk_fma_f32 v[14:15], v[14:15], s[48:49], v[48:49] op_sel:[1,1,0] op_sel_hi:[1,0,1] neg_lo:[0,0,0] neg_hi:[0,1,0]
v_pk_mul_f32 v[48:49], v[64:65], s[50:51] op_sel:[0,0] op_sel_hi:[0,1] neg_lo:[0,1] neg_hi:[0,1]
v_pk_fma_f32 v[64:65], v[64:65], s[50:51], v[48:49] op_sel:[1,1,0] op_sel_hi:[1,0,1] neg_lo:[0,0,0] neg_hi:[0,1,0]
v_pk_mul_f32 v[48:49], v[40:41], s[52:53] op_sel:[0,0] op_sel_hi:[0,1] neg_lo:[0,1] neg_hi:[0,1]
v_pk_fma_f32 v[40:41], v[40:41], s[52:53], v[48:49] op_sel:[1,1,0] op_sel_hi:[1,0,1] neg_lo:[0,0,0] neg_hi:[0,1,0]
v_pk_mul_f32 v[48:49], v[72:73], s[54:55] op_sel:[0,0] op_sel_hi:[0,1] neg_lo:[0,1] neg_hi:[0,1]
v_pk_fma_f32 v[72:73], v[72:73], s[54:55], v[48:49] op_sel:[1,1,0] op_sel_hi:[1,0,1] neg_lo:[0,0,0] neg_hi:[0,1,0]
v_pk_mul_f32 v[48:49], v[44:45], s[56:57] op_sel:[0,0] op_sel_hi:[0,1] neg_lo:[0,1] neg_hi:[0,1]
v_pk_fma_f32 v[44:45], v[44:45], s[56:57], v[48:49] op_sel:[1,1,0] op_sel_hi:[1,0,1] neg_lo:[0,0,0] neg_hi:[0,1,0]
v_pk_mul_f32 v[48:49], v[28:29], s[58:59] op_sel:[0,0] op_sel_hi:[0,1] neg_lo:[0,1] neg_hi:[0,1]
v_pk_fma_f32 v[28:29], v[28:29], s[58:59], v[48:49] op_sel:[1,1,0] op_sel_hi:[1,0,1] neg_lo:[0,0,0] neg_hi:[0,1,0]
v_pk_mul_f32 v[48:49], v[60:61], s[60:61] op_sel:[0,0] op_sel_hi:[0,1] neg_lo:[0,1] neg_hi:[0,1]
v_pk_fma_f32 v[60:61], v[60:61], s[60:61], v[48:49] op_sel:[1,1,0] op_sel_hi:[1,0,1] neg_lo:[0,0,0] neg_hi:[0,1,0]
v_pk_mul_f32 v[48:49], v[76:77], s[62:63] op_sel:[0,0] op_sel_hi:[0,1] neg_lo:[0,1] neg_hi:[0,1]
v_pk_fma_f32 v[76:77], v[76:77], s[62:63], v[48:49] op_sel:[1,1,0] op_sel_hi:[1,0,1] neg_lo:[0,0,0] neg_hi:[0,1,0]
v_pk_mul_f32 v[48:49], v[46:47], s[60:61] op_sel:[0,1] op_sel_hi:[0,0] neg_lo:[0,1] neg_hi:[0,1]
v_pk_fma_f32 v[46:47], v[46:47], s[60:61], v[48:49] op_sel:[1,0,0] op_sel_hi:[1,1,1] neg_lo:[0,0,0] neg_hi:[0,1,0]
v_pk_mul_f32 v[48:49], v[30:31], s[58:59] op_sel:[0,1] op_sel_hi:[0,0] neg_lo:[0,1] neg_hi:[0,1]
v_pk_fma_f32 v[30:31], v[30:31], s[58:59], v[48:49] op_sel:[1,0,0] op_sel_hi:[1,1,1] neg_lo:[0,0,0] neg_hi:[0,1,0]
v_pk_mul_f32 v[48:49], v[62:63], s[56:57] op_sel:[0,1] op_sel_hi:[0,0] neg_lo:[0,1] neg_hi:[0,1]
v_pk_fma_f32 v[62:63], v[62:63], s[56:57], v[48:49] op_sel:[1,0,0] op_sel_hi:[1,1,1] neg_lo:[0,0,0] neg_hi:[0,1,0]
v_pk_mul_f32 v[48:49], v[22:23], s[54:55] op_sel:[0,1] op_sel_hi:[0,0] neg_lo:[0,1] neg_hi:[0,1]
v_pk_fma_f32 v[22:23], v[22:23], s[54:55], v[48:49] op_sel:[1,0,0] op_sel_hi:[1,1,1] neg_lo:[0,0,0] neg_hi:[0,1,0]
v_pk_mul_f32 v[48:49], v[54:55], s[52:53] op_sel:[0,1] op_sel_hi:[0,0] neg_lo:[0,1] neg_hi:[0,1]
v_pk_fma_f32 v[54:55], v[54:55], s[52:53], v[48:49] op_sel:[1,0,0] op_sel_hi:[1,1,1] neg_lo:[0,0,0] neg_hi:[0,1,0]
v_pk_mul_f32 v[48:49], v[38:39], s[50:51] op_sel:[0,1] op_sel_hi:[0,0] neg_lo:[0,1] neg_hi:[0,1]
v_pk_fma_f32 v[38:39], v[38:39], s[50:51], v[48:49] op_sel:[1,0,0] op_sel_hi:[1,1,1] neg_lo:[0,0,0] neg_hi:[0,1,0]
v_pk_mul_f32 v[48:49], v[70:71], s[48:49] op_sel:[0,1] op_sel_hi:[0,0] neg_lo:[0,1] neg_hi:[0,1]
v_pk_fma_f32 v[70:71], v[70:71], s[48:49], v[48:49] op_sel:[1,0,0] op_sel_hi:[1,1,1] neg_lo:[0,0,0] neg_hi:[0,1,0]
v_pk_add_f32 v[78:79], v[78:79], 0 op_sel:[1,0] op_sel_hi:[0,0] neg_lo:[0,0] neg_hi:[1,0]
v_pk_mul_f32 v[48:49], v[32:33], s[48:49] op_sel:[0,1] op_sel_hi:[0,0] neg_lo:[0,0] neg_hi:[0,1]
v_pk_fma_f32 v[32:33], v[32:33], s[48:49], v[48:49] op_sel:[1,0,0] op_sel_hi:[1,1,1] neg_lo:[0,0,0] neg_hi:[0,0,0]
v_pk_mul_f32 v[48:49], v[24:25], s[50:51] op_sel:[0,1] op_sel_hi:[0,0] neg_lo:[0,0] neg_hi:[0,1]
v_pk_fma_f32 v[24:25], v[24:25], s[50:51], v[48:49] op_sel:[1,0,0] op_sel_hi:[1,1,1] neg_lo:[0,0,0] neg_hi:[0,0,0]
v_pk_mul_f32 v[48:49], v[56:57], s[52:53] op_sel:[0,1] op_sel_hi:[0,0] neg_lo:[0,0] neg_hi:[0,1]
v_pk_fma_f32 v[56:57], v[56:57], s[52:53], v[48:49] op_sel:[1,0,0] op_sel_hi:[1,1,1] neg_lo:[0,0,0] neg_hi:[0,0,0]
v_pk_mul_f32 v[48:49], v[20:21], s[54:55] op_sel:[0,1] op_sel_hi:[0,0] neg_lo:[0,0] neg_hi:[0,1]
v_pk_fma_f32 v[20:21], v[20:21], s[54:55], v[48:49] op_sel:[1,0,0] op_sel_hi:[1,1,1] neg_lo:[0,0,0] neg_hi:[0,0,0]
v_pk_mul_f32 v[48:49], v[52:53], s[56:57] op_sel:[0,1] op_sel_hi:[0,0] neg_lo:[0,0] neg_hi:[0,1]
v_pk_fma_f32 v[52:53], v[52:53], s[56:57], v[48:49] op_sel:[1,0,0] op_sel_hi:[1,1,1] neg_lo:[0,0,0] neg_hi:[0,0,0]
v_pk_mul_f32 v[48:49], v[36:37], s[58:59] op_sel:[0,1] op_sel_hi:[0,0] neg_lo:[0,0] neg_hi:[0,1]
v_pk_fma_f32 v[36:37], v[36:37], s[58:59], v[48:49] op_sel:[1,0,0] op_sel_hi:[1,1,1] neg_lo:[0,0,0] neg_hi:[0,0,0]
v_pk_mul_f32 v[48:49], v[68:69], s[60:61] op_sel:[0,1] op_sel_hi:[0,0] neg_lo:[0,0] neg_hi:[0,1]
v_pk_fma_f32 v[68:69], v[68:69], s[60:61], v[48:49] op_sel:[1,0,0] op_sel_hi:[1,1,1] neg_lo:[0,0,0] neg_hi:[0,0,0]
v_pk_mul_f32 v[48:49], v[18:19], s[62:63] op_sel:[0,0] op_sel_hi:[0,1] neg_lo:[0,0] neg_hi:[0,1]
v_pk_fma_f32 v[18:19], v[18:19], s[62:63], v[48:49] op_sel:[1,1,0] op_sel_hi:[1,0,1] neg_lo:[0,0,0] neg_hi:[0,0,0]
v_pk_mul_f32 v[48:49], v[50:51], s[60:61] op_sel:[0,0] op_sel_hi:[0,1] neg_lo:[0,0] neg_hi:[0,1]
v_pk_fma_f32 v[50:51], v[50:51], s[60:61], v[48:49] op_sel:[1,1,0] op_sel_hi:[1,0,1] neg_lo:[0,0,0] neg_hi:[0,0,0]
v_pk_mul_f32 v[48:49], v[34:35], s[58:59] op_sel:[0,0] op_sel_hi:[0,1] neg_lo:[0,0] neg_hi:[0,1]
v_pk_fma_f32 v[34:35], v[34:35], s[58:59], v[48:49] op_sel:[1,1,0] op_sel_hi:[1,0,1] neg_lo:[0,0,0] neg_hi:[0,0,0]
v_pk_mul_f32 v[48:49], v[66:67], s[56:57] op_sel:[0,0] op_sel_hi:[0,1] neg_lo:[0,0] neg_hi:[0,1]
v_pk_fma_f32 v[66:67], v[66:67], s[56:57], v[48:49] op_sel:[1,1,0] op_sel_hi:[1,0,1] neg_lo:[0,0,0] neg_hi:[0,0,0]
v_pk_mul_f32 v[48:49], v[26:27], s[54:55] op_sel:[0,0] op_sel_hi:[0,1] neg_lo:[0,0] neg_hi:[0,1]
v_pk_fma_f32 v[26:27], v[26:27], s[54:55], v[48:49] op_sel:[1,1,0] op_sel_hi:[1,0,1] neg_lo:[0,0,0] neg_hi:[0,0,0]
v_pk_mul_f32 v[48:49], v[58:59], s[52:53] op_sel:[0,0] op_sel_hi:[0,1] neg_lo:[0,0] neg_hi:[0,1]
v_pk_fma_f32 v[58:59], v[58:59], s[52:53], v[48:49] op_sel:[1,1,0] op_sel_hi:[1,0,1] neg_lo:[0,0,0] neg_hi:[0,0,0]
v_pk_mul_f32 v[48:49], v[42:43], s[50:51] op_sel:[0,0] op_sel_hi:[0,1] neg_lo:[0,0] neg_hi:[0,1]
v_pk_fma_f32 v[42:43], v[42:43], s[50:51], v[48:49] op_sel:[1,1,0] op_sel_hi:[1,0,1] neg_lo:[0,0,0] neg_hi:[0,0,0]
v_pk_mul_f32 v[48:49], v[74:75], s[48:49] op_sel:[0,0] op_sel_hi:[0,1] neg_lo:[0,0] neg_hi:[0,1]
v_pk_fma_f32 v[74:75], v[74:75], s[48:49], v[48:49] op_sel:[1,1,0] op_sel_hi:[1,0,1] neg_lo:[0,0,0] neg_hi:[0,0,0]
s_mov_b64 exec, -1
v_pk_add_f32 v[48:49], v[16:17], v[78:79] neg_lo:[0,1] neg_hi:[0,1]
v_pk_add_f32 v[16:17], v[16:17], v[78:79]
v_pk_add_f32 v[78:79], v[14:15], v[32:33] neg_lo:[0,1] neg_hi:[0,1]
v_pk_add_f32 v[14:15], v[14:15], v[32:33]
v_pk_mul_f32 v[32:33], v[78:79], s[50:51] op_sel:[0,0] op_sel_hi:[0,1] neg_lo:[0,0] neg_hi:[0,0]
v_pk_fma_f32 v[32:33], v[78:79], s[50:51], v[32:33] op_sel:[1,1,0] op_sel_hi:[1,0,1] neg_lo:[0,1,0] neg_hi:[0,0,0]
v_pk_add_f32 v[78:79], v[64:65], v[24:25] neg_lo:[0,1] neg_hi:[0,1]
v_pk_add_f32 v[64:65], v[64:65], v[24:25]
v_pk_mul_f32 v[24:25], v[78:79], s[54:55] op_sel:[0,0] op_sel_hi:[0,1] neg_lo:[0,0] neg_hi:[0,0]
v_pk_fma_f32 v[24:25], v[78:79], s[54:55], v[24:25] op_sel:[1,1,0] op_sel_hi:[1,0,1] neg_lo:[0,1,0] neg_hi:[0,0,0]
v_pk_add_f32 v[78:79], v[40:41], v[56:57] neg_lo:[0,1] neg_hi:[0,1]
v_pk_add_f32 v[40:41], v[40:41], v[56:57]
v_pk_mul_f32 v[56:57], v[78:79], s[58:59] op_sel:[0,0] op_sel_hi:[0,1] neg_lo:[0,0] neg_hi:[0,0]
v_pk_fma_f32 v[56:57], v[78:79], s[58:59], v[56:57] op_sel:[1,1,0] op_sel_hi:[1,0,1] neg_lo:[0,1,0] neg_hi:[0,0,0]
v_pk_add_f32 v[78:79], v[72:73], v[20:21] neg_lo:[0,1] neg_hi:[0,1]
v_pk_add_f32 v[72:73], v[72:73], v[20:21]
v_pk_mul_f32 v[20:21], v[78:79], s[62:63] op_sel:[0,0] op_sel_hi:[0,1] neg_lo:[0,0] neg_hi:[0,0]
v_pk_fma_f32 v[20:21], v[78:79], s[62:63], v[20:21] op_sel:[1,1,0] op_sel_hi:[1,0,1] neg_lo:[0,1,0] neg_hi:[0,0,0]
v_pk_add_f32 v[78:79], v[44:45], v[52:53] neg_lo:[0,1] neg_hi:[0,1]
v_pk_add_f32 v[44:45], v[44:45], v[52:53]
v_pk_mul_f32 v[52:53], v[78:79], s[58:59] op_sel:[0,1] op_sel_hi:[0,0] neg_lo:[0,0] neg_hi:[0,0]
v_pk_fma_f32 v[52:53], v[78:79], s[58:59], v[52:53] op_sel:[1,0,0] op_sel_hi:[1,1,1] neg_lo:[0,1,0] neg_hi:[0,0,0]
v_pk_add_f32 v[78:79], v[28:29], v[36:37] neg_lo:[0,1] neg_hi:[0,1]
v_pk_add_f32 v[28:29], v[28:29], v[36:37]
v_pk_mul_f32 v[36:37], v[78:79], s[54:55] op_sel:[0,1] op_sel_hi:[0,0] neg_lo:[0,0] neg_hi:[0,0]
v_pk_fma_f32 v[36:37], v[78:79], s[54:55], v[36:37] op_sel:[1,0,0] op_sel_hi:[1,1,1] neg_lo:[0,1,0] neg_hi:[0,0,0]
v_pk_add_f32 v[78:79], v[60:61], v[68:69] neg_lo:[0,1] neg_hi:[0,1]
v_pk_add_f32 v[60:61], v[60:61], v[68:69]
v_pk_mul_f32 v[68:69], v[78:79], s[50:51] op_sel:[0,1] op_sel_hi:[0,0] neg_lo:[0,0] neg_hi:[0,0]
v_pk_fma_f32 v[68:69], v[78:79], s[50:51], v[68:69] op_sel:[1,0,0] op_sel_hi:[1,1,1] neg_lo:[0,1,0] neg_hi:[0,0,0]
v_pk_add_f32 v[78:79], v[76:77], v[18:19] op_sel:[1,1] op_sel_hi:[0,0] neg_lo:[1,0] neg_hi:[0,1]
v_pk_add_f32 v[76:77], v[76:77], v[18:19]
v_pk_add_f32 v[18:19], v[46:47], v[50:51] neg_lo:[0,1] neg_hi:[0,1]
v_pk_add_f32 v[46:47], v[46:47], v[50:51]
v_pk_mul_f32 v[50:51], v[18:19], s[50:51] op_sel:[0,1] op_sel_hi:[0,0] neg_lo:[0,1] neg_hi:[0,0]
v_pk_fma_f32 v[50:51], v[18:19], s[50:51], v[50:51] op_sel:[1,0,0] op_sel_hi:[1,1,1] neg_lo:[0,1,0] neg_hi:[0,1,0]
v_pk_add_f32 v[18:19], v[30:31], v[34:35] neg_lo:[0,1] neg_hi:[0,1]
v_pk_add_f32 v[30:31], v[30:31], v[34:35]
v_pk_mul_f32 v[34:35], v[18:19], s[54:55] op_sel:[0,1] op_sel_hi:[0,0] neg_lo:[0,1] neg_hi:[0,0]
v_pk_fma_f32 v[34:35], v[18:19], s[54:55], v[34:35] op_sel:[1,0,0] op_sel_hi:[1,1,1] neg_lo:[0,1,0] neg_hi:[0,1,0]
v_pk_add_f32 v[18:19], v[62:63], v[66:67] neg_lo:[0,1] neg_hi:[0,1]
v_pk_add_f32 v[62:63], v[62:63], v[66:67]
v_pk_mul_f32 v[66:67], v[18:19], s[58:59] op_sel:[0,1] op_sel_hi:[0,0] neg_lo:[0,1] neg_hi:[0,0]
v_pk_fma_f32 v[66:67], v[18:19], s[58:59], v[66:67] op_sel:[1,0,0] op_sel_hi:[1,1,1] neg_lo:[0,1,0] neg_hi:[0,1,0]
v_pk_add_f32 v[18:19], v[22:23], v[26:27] neg_lo:[0,1] neg_hi:[0,1]
v_pk_add_f32 v[22:23], v[22:23], v[26:27]
v_pk_mul_f32 v[26:27], v[18:19], s[62:63] op_sel:[0,0] op_sel_hi:[0,1] neg_lo:[0,1] neg_hi:[0,0]
v_pk_fma_f32 v[26:27], v[18:19], s[62:63], v[26:27] op_sel:[1,1,0] op_sel_hi:[1,0,1] neg_lo:[0,1,0] neg_hi:[0,1,0]
v_pk_add_f32 v[18:19], v[54:55], v[58:59] neg_lo:[0,1] neg_hi:[0,1]
v_pk_add_f32 v[54:55], v[54:55], v[58:59]
v_pk_mul_f32 v[58:59], v[18:19], s[58:59] op_sel:[0,0] op_sel_hi:[0,1] neg_lo:[0,1] neg_hi:[0,0]
v_pk_fma_f32 v[58:59], v[18:19], s[58:59], v[58:59] op_sel:[1,1,0] op_sel_hi:[1,0,1] neg_lo:[0,1,0] neg_hi:[0,1,0]
v_pk_add_f32 v[18:19], v[38:39], v[42:43] neg_lo:[0,1] neg_hi:[0,1]
v_pk_add_f32 v[38:39], v[38:39], v[42:43]
v_pk_mul_f32 v[42:43], v[18:19], s[54:55] op_sel:[0,0] op_sel_hi:[0,1] neg_lo:[0,1] neg_hi:[0,0]
v_pk_fma_f32 v[42:43], v[18:19], s[54:55], v[42:43] op_sel:[1,1,0] op_sel_hi:[1,0,1] neg_lo:[0,1,0] neg_hi:[0,1,0]
v_pk_add_f32 v[18:19], v[70:71], v[74:75] neg_lo:[0,1] neg_hi:[0,1]
v_pk_add_f32 v[70:71], v[70:71], v[74:75]
v_pk_mul_f32 v[74:75], v[18:19], s[50:51] op_sel:[0,0] op_sel_hi:[0,1] neg_lo:[0,1] neg_hi:[0,0]
v_pk_fma_f32 v[74:75], v[18:19], s[50:51], v[74:75] op_sel:[1,1,0] op_sel_hi:[1,0,1] neg_lo:[0,1,0] neg_hi:[0,1,0]
v_pk_add_f32 v[18:19], v[16:17], v[76:77] neg_lo:[0,1] neg_hi:[0,1]
v_pk_add_f32 v[16:17], v[16:17], v[76:77]
v_pk_add_f32 v[76:77], v[14:15], v[46:47] neg_lo:[0,1] neg_hi:[0,1]
v_pk_add_f32 v[14:15], v[14:15], v[46:47]
v_pk_mul_f32 v[46:47], v[76:77], s[54:55] op_sel:[0,0] op_sel_hi:[0,1] neg_lo:[0,0] neg_hi:[0,0]
v_pk_fma_f32 v[46:47], v[76:77], s[54:55], v[46:47] op_sel:[1,1,0] op_sel_hi:[1,0,1] neg_lo:[0,1,0] neg_hi:[0,0,0]
v_pk_add_f32 v[76:77], v[64:65], v[30:31] neg_lo:[0,1] neg_hi:[0,1]
v_pk_add_f32 v[64:65], v[64:65], v[30:31]
v_pk_mul_f32 v[30:31], v[76:77], s[62:63] op_sel:[0,0] op_sel_hi:[0,1] neg_lo:[0,0] neg_hi:[0,0]
v_pk_fma_f32 v[30:31], v[76:77], s[62:63], v[30:31] op_sel:[1,1,0] op_sel_hi:[1,0,1] neg_lo:[0,1,0] neg_hi:[0,0,0]
v_pk_add_f32 v[76:77], v[40:41], v[62:63] neg_lo:[0,1] neg_hi:[0,1]
v_pk_add_f32 v[40:41], v[40:41], v[62:63]
v_pk_mul_f32 v[62:63], v[76:77], s[54:55] op_sel:[0,1] op_sel_hi:[0,0] neg_lo:[0,0] neg_hi:[0,0]
v_pk_fma_f32 v[62:63], v[76:77], s[54:55], v[62:63] op_sel:[1,0,0] op_sel_hi:[1,1,1] neg_lo:[0,1,0] neg_hi:[0,0,0]
v_pk_add_f32 v[76:77], v[72:73], v[22:23] op_sel:[1,1] op_sel_hi:[0,0] neg_lo:[1,0] neg_hi:[0,1]
v_pk_add_f32 v[72:73], v[72:73], v[22:23]
v_pk_add_f32 v[22:23], v[44:45], v[54:55] neg_lo:[0,1] neg_hi:[0,1]
v_pk_add_f32 v[44:45], v[44:45], v[54:55]
v_pk_mul_f32 v[54:55], v[22:23], s[54:55] op_sel:[0,1] op_sel_hi:[0,0] neg_lo:[0,1] neg_hi:[0,0]
v_pk_fma_f32 v[54:55], v[22:23], s[54:55], v[54:55] op_sel:[1,0,0] op_sel_hi:[1,1,1] neg_lo:[0,1,0] neg_hi:[0,1,0]
v_pk_add_f32 v[22:23], v[28:29], v[38:39] neg_lo:[0,1] neg_hi:[0,1]
v_pk_add_f32 v[28:29], v[28:29], v[38:39]
v_pk_mul_f32 v[38:39], v[22:23], s[62:63] op_sel:[0,0] op_sel_hi:[0,1] neg_lo:[0,1] neg_hi:[0,0]
v_pk_fma_f32 v[38:39], v[22:23], s[62:63], v[38:39] op_sel:[1,1,0] op_sel_hi:[1,0,1] neg_lo:[0,1,0] neg_hi:[0,1,0]
v_pk_add_f32 v[22:23], v[60:61], v[70:71] neg_lo:[0,1] neg_hi:[0,1]
v_pk_add_f32 v[60:61], v[60:61], v[70:71]
v_pk_mul_f32 v[70:71], v[22:23], s[54:55] op_sel:[0,0] op_sel_hi:[0,1] neg_lo:[0,1] neg_hi:[0,0]
v_pk_fma_f32 v[70:71], v[22:23], s[54:55], v[70:71] op_sel:[1,1,0] op_sel_hi:[1,0,1] neg_lo:[0,1,0] neg_hi:[0,1,0]
v_pk_add_f32 v[22:23], v[48:49], v[78:79] neg_lo:[0,1] neg_hi:[0,1]
v_pk_add_f32 v[48:49], v[48:49], v[78:79]
v_pk_add_f32 v[78:79], v[32:33], v[50:51] neg_lo:[0,1] neg_hi:[0,1]
v_pk_add_f32 v[32:33], v[32:33], v[50:51]
v_pk_mul_f32 v[50:51], v[78:79], s[54:55] op_sel:[0,0] op_sel_hi:[0,1] neg_lo:[0,0] neg_hi:[0,0]
v_pk_fma_f32 v[50:51], v[78:79], s[54:55], v[50:51] op_sel:[1,1,0] op_sel_hi:[1,0,1] neg_lo:[0,1,0] neg_hi:[0,0,0]
v_pk_add_f32 v[78:79], v[24:25], v[34:35] neg_lo:[0,1] neg_hi:[0,1]
v_pk_add_f32 v[24:25], v[24:25], v[34:35]
v_pk_mul_f32 v[34:35], v[78:79], s[62:63] op_sel:[0,0] op_sel_hi:[0,1] neg_lo:[0,0] neg_hi:[0,0]
v_pk_fma_f32 v[34:35], v[78:79], s[62:63], v[34:35] op_sel:[1,1,0] op_sel_hi:[1,0,1] neg_lo:[0,1,0] neg_hi:[0,0,0]
v_pk_add_f32 v[78:79], v[56:57], v[66:67] neg_lo:[0,1] neg_hi:[0,1]
v_pk_add_f32 v[56:57], v[56:57], v[66:67]
v_pk_mul_f32 v[66:67], v[78:79], s[54:55] op_sel:[0,1] op_sel_hi:[0,0] neg_lo:[0,0] neg_hi:[0,0]
v_pk_fma_f32 v[66:67], v[78:79], s[54:55], v[66:67] op_sel:[1,0,0] op_sel_hi:[1,1,1] neg_lo:[0,1,0] neg_hi:[0,0,0]
v_pk_add_f32 v[78:79], v[20:21], v[26:27] op_sel:[1,1] op_sel_hi:[0,0] neg_lo:[1,0] neg_hi:[0,1]
v_pk_add_f32 v[20:21], v[20:21], v[26:27]
v_pk_add_f32 v[26:27], v[52:53], v[58:59] neg_lo:[0,1] neg_hi:[0,1]
v_pk_add_f32 v[52:53], v[52:53], v[58:59]
v_pk_mul_f32 v[58:59], v[26:27], s[54:55] op_sel:[0,1] op_sel_hi:[0,0] neg_lo:[0,1] neg_hi:[0,0]
v_pk_fma_f32 v[58:59], v[26:27], s[54:55], v[58:59] op_sel:[1,0,0] op_sel_hi:[1,1,1] neg_lo:[0,1,0] neg_hi:[0,1,0]
v_pk_add_f32 v[26:27], v[36:37], v[42:43] neg_lo:[0,1] neg_hi:[0,1]
v_pk_add_f32 v[36:37], v[36:37], v[42:43]
v_pk_mul_f32 v[42:43], v[26:27], s[62:63] op_sel:[0,0] op_sel_hi:[0,1] neg_lo:[0,1] neg_hi:[0,0]
v_pk_fma_f32 v[42:43], v[26:27], s[62:63], v[42:43] op_sel:[1,1,0] op_sel_hi:[1,0,1] neg_lo:[0,1,0] neg_hi:[0,1,0]
v_pk_add_f32 v[26:27], v[68:69], v[74:75] neg_lo:[0,1] neg_hi:[0,1]
v_pk_add_f32 v[68:69], v[68:69], v[74:75]
v_pk_mul_f32 v[74:75], v[26:27], s[54:55] op_sel:[0,0] op_sel_hi:[0,1] neg_lo:[0,1] neg_hi:[0,0]
v_pk_fma_f32 v[74:75], v[26:27], s[54:55], v[74:75] op_sel:[1,1,0] op_sel_hi:[1,0,1] neg_lo:[0,1,0] neg_hi:[0,1,0]
v_pk_add_f32 v[26:27], v[16:17], v[72:73] neg_lo:[0,1] neg_hi:[0,1]
v_pk_add_f32 v[16:17], v[16:17], v[72:73]
v_pk_add_f32 v[72:73], v[14:15], v[44:45] neg_lo:[0,1] neg_hi:[0,1]
v_pk_add_f32 v[14:15], v[14:15], v[44:45]
v_pk_mul_f32 v[44:45], v[72:73], s[62:63] op_sel:[0,0] op_sel_hi:[0,1] neg_lo:[0,0] neg_hi:[0,0]
v_pk_fma_f32 v[44:45], v[72:73], s[62:63], v[44:45] op_sel:[1,1,0] op_sel_hi:[1,0,1] neg_lo:[0,1,0] neg_hi:[0,0,0]
v_pk_add_f32 v[72:73], v[64:65], v[28:29] op_sel:[1,1] op_sel_hi:[0,0] neg_lo:[1,0] neg_hi:[0,1]
v_pk_add_f32 v[64:65], v[64:65], v[28:29]
v_pk_add_f32 v[28:29], v[40:41], v[60:61] neg_lo:[0,1] neg_hi:[0,1]
v_pk_add_f32 v[40:41], v[40:41], v[60:61]
v_pk_mul_f32 v[60:61], v[28:29], s[62:63] op_sel:[0,0] op_sel_hi:[0,1] neg_lo:[0,1] neg_hi:[0,0]
v_pk_fma_f32 v[60:61], v[28:29], s[62:63], v[60:61] op_sel:[1,1,0] op_sel_hi:[1,0,1] neg_lo:[0,1,0] neg_hi:[0,1,0]
v_pk_add_f32 v[28:29], v[18:19], v[76:77] neg_lo:[0,1] neg_hi:[0,1]
v_pk_add_f32 v[18:19], v[18:19], v[76:77]
v_pk_add_f32 v[76:77], v[46:47], v[54:55] neg_lo:[0,1] neg_hi:[0,1]
v_pk_add_f32 v[46:47], v[46:47], v[54:55]
v_pk_mul_f32 v[54:55], v[76:77], s[62:63] op_sel:[0,0] op_sel_hi:[0,1] neg_lo:[0,0] neg_hi:[0,0]
v_pk_fma_f32 v[54:55], v[76:77], s[62:63], v[54:55] op_sel:[1,1,0] op_sel_hi:[1,0,1] neg_lo:[0,1,0] neg_hi:[0,0,0]
v_pk_add_f32 v[76:77], v[30:31], v[38:39] op_sel:[1,1] op_sel_hi:[0,0] neg_lo:[1,0] neg_hi:[0,1]
v_pk_add_f32 v[30:31], v[30:31], v[38:39]
v_pk_add_f32 v[38:39], v[62:63], v[70:71] neg_lo:[0,1] neg_hi:[0,1]
v_pk_add_f32 v[62:63], v[62:63], v[70:71]
v_pk_mul_f32 v[70:71], v[38:39], s[62:63] op_sel:[0,0] op_sel_hi:[0,1] neg_lo:[0,1] neg_hi:[0,0]
v_pk_fma_f32 v[70:71], v[38:39], s[62:63], v[70:71] op_sel:[1,1,0] op_sel_hi:[1,0,1] neg_lo:[0,1,0] neg_hi:[0,1,0]
v_pk_add_f32 v[38:39], v[48:49], v[20:21] neg_lo:[0,1] neg_hi:[0,1]
v_pk_add_f32 v[48:49], v[48:49], v[20:21]
v_pk_add_f32 v[20:21], v[32:33], v[52:53] neg_lo:[0,1] neg_hi:[0,1]
v_pk_add_f32 v[32:33], v[32:33], v[52:53]
v_pk_mul_f32 v[52:53], v[20:21], s[62:63] op_sel:[0,0] op_sel_hi:[0,1] neg_lo:[0,0] neg_hi:[0,0]
v_pk_fma_f32 v[52:53], v[20:21], s[62:63], v[52:53] op_sel:[1,1,0] op_sel_hi:[1,0,1] neg_lo:[0,1,0] neg_hi:[0,0,0]
v_pk_add_f32 v[20:21], v[24:25], v[36:37] op_sel:[1,1] op_sel_hi:[0,0] neg_lo:[1,0] neg_hi:[0,1]
v_pk_add_f32 v[24:25], v[24:25], v[36:37]
v_pk_add_f32 v[36:37], v[56:57], v[68:69] neg_lo:[0,1] neg_hi:[0,1]
v_pk_add_f32 v[56:57], v[56:57], v[68:69]
v_pk_mul_f32 v[68:69], v[36:37], s[62:63] op_sel:[0,0] op_sel_hi:[0,1] neg_lo:[0,1] neg_hi:[0,0]
v_pk_fma_f32 v[68:69], v[36:37], s[62:63], v[68:69] op_sel:[1,1,0] op_sel_hi:[1,0,1] neg_lo:[0,1,0] neg_hi:[0,1,0]
v_pk_add_f32 v[36:37], v[22:23], v[78:79] neg_lo:[0,1] neg_hi:[0,1]
v_pk_add_f32 v[22:23], v[22:23], v[78:79]
v_pk_add_f32 v[78:79], v[50:51], v[58:59] neg_lo:[0,1] neg_hi:[0,1]
v_pk_add_f32 v[50:51], v[50:51], v[58:59]
v_pk_mul_f32 v[58:59], v[78:79], s[62:63] op_sel:[0,0] op_sel_hi:[0,1] neg_lo:[0,0] neg_hi:[0,0]
v_pk_fma_f32 v[58:59], v[78:79], s[62:63], v[58:59] op_sel:[1,1,0] op_sel_hi:[1,0,1] neg_lo:[0,1,0] neg_hi:[0,0,0]
v_pk_add_f32 v[78:79], v[34:35], v[42:43] op_sel:[1,1] op_sel_hi:[0,0] neg_lo:[1,0] neg_hi:[0,1]
v_pk_add_f32 v[34:35], v[34:35], v[42:43]
v_pk_add_f32 v[42:43], v[66:67], v[74:75] neg_lo:[0,1] neg_hi:[0,1]
v_pk_add_f32 v[66:67], v[66:67], v[74:75]
v_pk_mul_f32 v[74:75], v[42:43], s[62:63] op_sel:[0,0] op_sel_hi:[0,1] neg_lo:[0,1] neg_hi:[0,0]
v_pk_fma_f32 v[74:75], v[42:43], s[62:63], v[74:75] op_sel:[1,1,0] op_sel_hi:[1,0,1] neg_lo:[0,1,0] neg_hi:[0,1,0]
v_pk_add_f32 v[42:43], v[16:17], v[64:65] neg_lo:[0,1] neg_hi:[0,1]
v_pk_add_f32 v[16:17], v[16:17], v[64:65]
v_pk_add_f32 v[64:65], v[14:15], v[40:41] op_sel:[1,1] op_sel_hi:[0,0] neg_lo:[1,0] neg_hi:[0,1]
v_pk_add_f32 v[14:15], v[14:15], v[40:41]
v_pk_add_f32 v[40:41], v[26:27], v[72:73] neg_lo:[0,1] neg_hi:[0,1]
v_pk_add_f32 v[26:27], v[26:27], v[72:73]
v_pk_add_f32 v[72:73], v[44:45], v[60:61] op_sel:[1,1] op_sel_hi:[0,0] neg_lo:[1,0] neg_hi:[0,1]
v_pk_add_f32 v[44:45], v[44:45], v[60:61]
v_pk_add_f32 v[60:61], v[18:19], v[30:31] neg_lo:[0,1] neg_hi:[0,1]
v_pk_add_f32 v[18:19], v[18:19], v[30:31]
v_pk_add_f32 v[30:31], v[46:47], v[62:63] op_sel:[1,1] op_sel_hi:[0,0] neg_lo:[1,0] neg_hi:[0,1]
v_pk_add_f32 v[46:47], v[46:47], v[62:63]
v_pk_add_f32 v[62:63], v[28:29], v[76:77] neg_lo:[0,1] neg_hi:[0,1]
v_pk_add_f32 v[28:29], v[28:29], v[76:77]
v_pk_add_f32 v[76:77], v[54:55], v[70:71] op_sel:[1,1] op_sel_hi:[0,0] neg_lo:[1,0] neg_hi:[0,1]
v_pk_add_f32 v[54:55], v[54:55], v[70:71]
v_pk_add_f32 v[70:71], v[48:49], v[24:25] neg_lo:[0,1] neg_hi:[0,1]
v_pk_add_f32 v[48:49], v[48:49], v[24:25]
v_pk_add_f32 v[24:25], v[32:33], v[56:57] op_sel:[1,1] op_sel_hi:[0,0] neg_lo:[1,0] neg_hi:[0,1]
v_pk_add_f32 v[32:33], v[32:33], v[56:57]
v_pk_add_f32 v[56:57], v[38:39], v[20:21] neg_lo:[0,1] neg_hi:[0,1]
v_pk_add_f32 v[38:39], v[38:39], v[20:21]
v_pk_add_f32 v[20:21], v[52:53], v[68:69] op_sel:[1,1] op_sel_hi:[0,0] neg_lo:[1,0] neg_hi:[0,1]
v_pk_add_f32 v[52:53], v[52:53], v[68:69]
v_pk_add_f32 v[68:69], v[22:23], v[34:35] neg_lo:[0,1] neg_hi:[0,1]
v_pk_add_f32 v[22:23], v[22:23], v[34:35]
v_pk_add_f32 v[34:35], v[50:51], v[66:67] op_sel:[1,1] op_sel_hi:[0,0] neg_lo:[1,0] neg_hi:[0,1]
v_pk_add_f32 v[50:51], v[50:51], v[66:67]
v_pk_add_f32 v[66:67], v[36:37], v[78:79] neg_lo:[0,1] neg_hi:[0,1]
v_pk_add_f32 v[36:37], v[36:37], v[78:79]
v_pk_add_f32 v[78:79], v[58:59], v[74:75] op_sel:[1,1] op_sel_hi:[0,0] neg_lo:[1,0] neg_hi:[0,1]
v_pk_add_f32 v[58:59], v[58:59], v[74:75]
v_pk_add_f32 v[74:75], v[16:17], v[14:15] neg_lo:[0,1] neg_hi:[0,1]
v_pk_add_f32 v[16:17], v[16:17], v[14:15]
v_pk_add_f32 v[14:15], v[42:43], v[64:65] neg_lo:[0,1] neg_hi:[0,1]
v_pk_add_f32 v[42:43], v[42:43], v[64:65]
v_pk_add_f32 v[64:65], v[26:27], v[44:45] neg_lo:[0,1] neg_hi:[0,1]
v_pk_add_f32 v[26:27], v[26:27], v[44:45]
v_pk_add_f32 v[44:45], v[40:41], v[72:73] neg_lo:[0,1] neg_hi:[0,1]
v_pk_add_f32 v[40:41], v[40:41], v[72:73]
v_pk_add_f32 v[72:73], v[18:19], v[46:47] neg_lo:[0,1] neg_hi:[0,1]
v_pk_add_f32 v[18:19], v[18:19], v[46:47]
v_pk_add_f32 v[46:47], v[60:61], v[30:31] neg_lo:[0,1] neg_hi:[0,1]
v_pk_add_f32 v[60:61], v[60:61], v[30:31]
v_pk_add_f32 v[30:31], v[28:29], v[54:55] neg_lo:[0,1] neg_hi:[0,1]
v_pk_add_f32 v[28:29], v[28:29], v[54:55]
v_pk_add_f32 v[54:55], v[62:63], v[76:77] neg_lo:[0,1] neg_hi:[0,1]
v_pk_add_f32 v[62:63], v[62:63], v[76:77]
v_pk_add_f32 v[76:77], v[48:49], v[32:33] neg_lo:[0,1] neg_hi:[0,1]
v_pk_add_f32 v[48:49], v[48:49], v[32:33]
v_pk_add_f32 v[32:33], v[70:71], v[24:25] neg_lo:[0,1] neg_hi:[0,1]
v_pk_add_f32 v[70:71], v[70:71], v[24:25]
v_pk_add_f32 v[24:25], v[38:39], v[52:53] neg_lo:[0,1] neg_hi:[0,1]
v_pk_add_f32 v[38:39], v[38:39], v[52:53]
v_pk_add_f32 v[52:53], v[56:57], v[20:21] neg_lo:[0,1] neg_hi:[0,1]
v_pk_add_f32 v[56:57], v[56:57], v[20:21]
v_pk_add_f32 v[20:21], v[22:23], v[50:51] neg_lo:[0,1] neg_hi:[0,1]
v_pk_add_f32 v[22:23], v[22:23], v[50:51]
v_pk_add_f32 v[50:51], v[68:69], v[34:35] neg_lo:[0,1] neg_hi:[0,1]
v_pk_add_f32 v[68:69], v[68:69], v[34:35]
v_pk_add_f32 v[34:35], v[36:37], v[58:59] neg_lo:[0,1] neg_hi:[0,1]
v_pk_add_f32 v[36:37], v[36:37], v[58:59]
v_pk_add_f32 v[58:59], v[66:67], v[78:79] neg_lo:[0,1] neg_hi:[0,1]
v_pk_add_f32 v[66:67], v[66:67], v[78:79]
v_pk_mul_f32 v[78:79], v[16:17], v[144:145] op_sel:[0,0] op_sel_hi:[0,1] neg_lo:[0,0] neg_hi:[0,0]
v_pk_fma_f32 v[16:17], v[16:17], v[144:145], v[78:79] op_sel:[1,1,0] op_sel_hi:[1,0,1] neg_lo:[0,1,0] neg_hi:[0,0,0]
v_pk_mul_f32 v[78:79], v[48:49], v[146:147] op_sel:[0,0] op_sel_hi:[0,1] neg_lo:[0,0] neg_hi:[0,0]
v_pk_fma_f32 v[48:49], v[48:49], v[146:147], v[78:79] op_sel:[1,1,0] op_sel_hi:[1,0,1] neg_lo:[0,1,0] neg_hi:[0,0,0]
v_pk_mul_f32 v[78:79], v[18:19], v[148:149] op_sel:[0,0] op_sel_hi:[0,1] neg_lo:[0,0] neg_hi:[0,0]
v_pk_fma_f32 v[18:19], v[18:19], v[148:149], v[78:79] op_sel:[1,1,0] op_sel_hi:[1,0,1] neg_lo:[0,1,0] neg_hi:[0,0,0]
v_pk_mul_f32 v[78:79], v[22:23], v[150:151] op_sel:[0,0] op_sel_hi:[0,1] neg_lo:[0,0] neg_hi:[0,0]
v_pk_fma_f32 v[22:23], v[22:23], v[150:151], v[78:79] op_sel:[1,1,0] op_sel_hi:[1,0,1] neg_lo:[0,1,0] neg_hi:[0,0,0]
v_pk_mul_f32 v[78:79], v[26:27], v[152:153] op_sel:[0,0] op_sel_hi:[0,1] neg_lo:[0,0] neg_hi:[0,0]
v_pk_fma_f32 v[26:27], v[26:27], v[152:153], v[78:79] op_sel:[1,1,0] op_sel_hi:[1,0,1] neg_lo:[0,1,0] neg_hi:[0,0,0]
v_pk_mul_f32 v[78:79], v[38:39], v[154:155] op_sel:[0,0] op_sel_hi:[0,1] neg_lo:[0,0] neg_hi:[0,0]
v_pk_fma_f32 v[38:39], v[38:39], v[154:155], v[78:79] op_sel:[1,1,0] op_sel_hi:[1,0,1] neg_lo:[0,1,0] neg_hi:[0,0,0]
v_pk_mul_f32 v[78:79], v[28:29], v[156:157] op_sel:[0,0] op_sel_hi:[0,1] neg_lo:[0,0] neg_hi:[0,0]
v_pk_fma_f32 v[28:29], v[28:29], v[156:157], v[78:79] op_sel:[1,1,0] op_sel_hi:[1,0,1] neg_lo:[0,1,0] neg_hi:[0,0,0]
v_pk_mul_f32 v[78:79], v[36:37], v[158:159] op_sel:[0,0] op_sel_hi:[0,1] neg_lo:[0,0] neg_hi:[0,0]
v_pk_fma_f32 v[36:37], v[36:37], v[158:159], v[78:79] op_sel:[1,1,0] op_sel_hi:[1,0,1] neg_lo:[0,1,0] neg_hi:[0,0,0]
v_pk_mul_f32 v[78:79], v[42:43], v[160:161] op_sel:[0,0] op_sel_hi:[0,1] neg_lo:[0,0] neg_hi:[0,0]
v_pk_fma_f32 v[42:43], v[42:43], v[160:161], v[78:79] op_sel:[1,1,0] op_sel_hi:[1,0,1] neg_lo:[0,1,0] neg_hi:[0,0,0]
v_pk_mul_f32 v[78:79], v[70:71], v[162:163] op_sel:[0,0] op_sel_hi:[0,1] neg_lo:[0,0] neg_hi:[0,0]
v_pk_fma_f32 v[70:71], v[70:71], v[162:163], v[78:79] op_sel:[1,1,0] op_sel_hi:[1,0,1] neg_lo:[0,1,0] neg_hi:[0,0,0]
v_pk_mul_f32 v[78:79], v[60:61], v[164:165] op_sel:[0,0] op_sel_hi:[0,1] neg_lo:[0,0] neg_hi:[0,0]
v_pk_fma_f32 v[60:61], v[60:61], v[164:165], v[78:79] op_sel:[1,1,0] op_sel_hi:[1,0,1] neg_lo:[0,1,0] neg_hi:[0,0,0]
v_pk_mul_f32 v[78:79], v[68:69], v[166:167] op_sel:[0,0] op_sel_hi:[0,1] neg_lo:[0,0] neg_hi:[0,0]
v_pk_fma_f32 v[68:69], v[68:69], v[166:167], v[78:79] op_sel:[1,1,0] op_sel_hi:[1,0,1] neg_lo:[0,1,0] neg_hi:[0,0,0]
v_pk_mul_f32 v[78:79], v[40:41], v[168:169] op_sel:[0,0] op_sel_hi:[0,1] neg_lo:[0,0] neg_hi:[0,0]
v_pk_fma_f32 v[40:41], v[40:41], v[168:169], v[78:79] op_sel:[1,1,0] op_sel_hi:[1,0,1] neg_lo:[0,1,0] neg_hi:[0,0,0]
v_pk_mul_f32 v[78:79], v[56:57], v[170:171] op_sel:[0,0] op_sel_hi:[0,1] neg_lo:[0,0] neg_hi:[0,0]
v_pk_fma_f32 v[56:57], v[56:57], v[170:171], v[78:79] op_sel:[1,1,0] op_sel_hi:[1,0,1] neg_lo:[0,1,0] neg_hi:[0,0,0]
v_pk_mul_f32 v[78:79], v[62:63], v[172:173] op_sel:[0,0] op_sel_hi:[0,1] neg_lo:[0,0] neg_hi:[0,0]
v_pk_fma_f32 v[62:63], v[62:63], v[172:173], v[78:79] op_sel:[1,1,0] op_sel_hi:[1,0,1] neg_lo:[0,1,0] neg_hi:[0,0,0]
v_pk_mul_f32 v[78:79], v[66:67], v[174:175] op_sel:[0,0] op_sel_hi:[0,1] neg_lo:[0,0] neg_hi:[0,0]
v_pk_fma_f32 v[66:67], v[66:67], v[174:175], v[78:79] op_sel:[1,1,0] op_sel_hi:[1,0,1] neg_lo:[0,1,0] neg_hi:[0,0,0]
v_pk_mul_f32 v[78:79], v[74:75], v[176:177] op_sel:[0,0] op_sel_hi:[0,1] neg_lo:[0,0] neg_hi:[0,0]
v_pk_fma_f32 v[74:75], v[74:75], v[176:177], v[78:79] op_sel:[1,1,0] op_sel_hi:[1,0,1] neg_lo:[0,1,0] neg_hi:[0,0,0]
v_pk_mul_f32 v[78:79], v[76:77], v[178:179] op_sel:[0,0] op_sel_hi:[0,1] neg_lo:[0,0] neg_hi:[0,0]
v_pk_fma_f32 v[76:77], v[76:77], v[178:179], v[78:79] op_sel:[1,1,0] op_sel_hi:[1,0,1] neg_lo:[0,1,0] neg_hi:[0,0,0]
v_pk_mul_f32 v[78:79], v[72:73], v[180:181] op_sel:[0,0] op_sel_hi:[0,1] neg_lo:[0,0] neg_hi:[0,0]
v_pk_fma_f32 v[72:73], v[72:73], v[180:181], v[78:79] op_sel:[1,1,0] op_sel_hi:[1,0,1] neg_lo:[0,1,0] neg_hi:[0,0,0]
v_pk_mul_f32 v[78:79], v[20:21], v[182:183] op_sel:[0,0] op_sel_hi:[0,1] neg_lo:[0,0] neg_hi:[0,0]
v_pk_fma_f32 v[20:21], v[20:21], v[182:183], v[78:79] op_sel:[1,1,0] op_sel_hi:[1,0,1] neg_lo:[0,1,0] neg_hi:[0,0,0]
v_pk_mul_f32 v[78:79], v[64:65], v[184:185] op_sel:[0,0] op_sel_hi:[0,1] neg_lo:[0,0] neg_hi:[0,0]
v_pk_fma_f32 v[64:65], v[64:65], v[184:185], v[78:79] op_sel:[1,1,0] op_sel_hi:[1,0,1] neg_lo:[0,1,0] neg_hi:[0,0,0]
v_pk_mul_f32 v[78:79], v[24:25], v[186:187] op_sel:[0,0] op_sel_hi:[0,1] neg_lo:[0,0] neg_hi:[0,0]
v_pk_fma_f32 v[24:25], v[24:25], v[186:187], v[78:79] op_sel:[1,1,0] op_sel_hi:[1,0,1] neg_lo:[0,1,0] neg_hi:[0,0,0]
v_pk_mul_f32 v[78:79], v[30:31], v[188:189] op_sel:[0,0] op_sel_hi:[0,1] neg_lo:[0,0] neg_hi:[0,0]
v_pk_fma_f32 v[30:31], v[30:31], v[188:189], v[78:79] op_sel:[1,1,0] op_sel_hi:[1,0,1] neg_lo:[0,1,0] neg_hi:[0,0,0]
v_pk_mul_f32 v[78:79], v[34:35], v[190:191] op_sel:[0,0] op_sel_hi:[0,1] neg_lo:[0,0] neg_hi:[0,0]
v_pk_fma_f32 v[34:35], v[34:35], v[190:191], v[78:79] op_sel:[1,1,0] op_sel_hi:[1,0,1] neg_lo:[0,1,0] neg_hi:[0,0,0]
v_pk_mul_f32 v[78:79], v[14:15], v[192:193] op_sel:[0,0] op_sel_hi:[0,1] neg_lo:[0,0] neg_hi:[0,0]
v_pk_fma_f32 v[14:15], v[14:15], v[192:193], v[78:79] op_sel:[1,1,0] op_sel_hi:[1,0,1] neg_lo:[0,1,0] neg_hi:[0,0,0]
v_pk_mul_f32 v[78:79], v[32:33], v[194:195] op_sel:[0,0] op_sel_hi:[0,1] neg_lo:[0,0] neg_hi:[0,0]
v_pk_fma_f32 v[32:33], v[32:33], v[194:195], v[78:79] op_sel:[1,1,0] op_sel_hi:[1,0,1] neg_lo:[0,1,0] neg_hi:[0,0,0]
v_pk_mul_f32 v[78:79], v[46:47], v[196:197] op_sel:[0,0] op_sel_hi:[0,1] neg_lo:[0,0] neg_hi:[0,0]
v_pk_fma_f32 v[46:47], v[46:47], v[196:197], v[78:79] op_sel:[1,1,0] op_sel_hi:[1,0,1] neg_lo:[0,1,0] neg_hi:[0,0,0]
v_pk_mul_f32 v[78:79], v[50:51], v[198:199] op_sel:[0,0] op_sel_hi:[0,1] neg_lo:[0,0] neg_hi:[0,0]
v_pk_fma_f32 v[50:51], v[50:51], v[198:199], v[78:79] op_sel:[1,1,0] op_sel_hi:[1,0,1] neg_lo:[0,1,0] neg_hi:[0,0,0]
v_pk_mul_f32 v[78:79], v[44:45], v[200:201] op_sel:[0,0] op_sel_hi:[0,1] neg_lo:[0,0] neg_hi:[0,0]
v_pk_fma_f32 v[44:45], v[44:45], v[200:201], v[78:79] op_sel:[1,1,0] op_sel_hi:[1,0,1] neg_lo:[0,1,0] neg_hi:[0,0,0]
v_pk_mul_f32 v[78:79], v[52:53], v[202:203] op_sel:[0,0] op_sel_hi:[0,1] neg_lo:[0,0] neg_hi:[0,0]
v_pk_fma_f32 v[52:53], v[52:53], v[202:203], v[78:79] op_sel:[1,1,0] op_sel_hi:[1,0,1] neg_lo:[0,1,0] neg_hi:[0,0,0]
v_pk_mul_f32 v[78:79], v[54:55], v[204:205] op_sel:[0,0] op_sel_hi:[0,1] neg_lo:[0,0] neg_hi:[0,0]
v_pk_fma_f32 v[54:55], v[54:55], v[204:205], v[78:79] op_sel:[1,1,0] op_sel_hi:[1,0,1] neg_lo:[0,1,0] neg_hi:[0,0,0]
v_pk_mul_f32 v[78:79], v[58:59], v[206:207] op_sel:[0,0] op_sel_hi:[0,1] neg_lo:[0,0] neg_hi:[0,0]
v_pk_fma_f32 v[58:59], v[58:59], v[206:207], v[78:79] op_sel:[1,1,0] op_sel_hi:[1,0,1] neg_lo:[0,1,0] neg_hi:[0,0,0]
ds_write_b64 v4, v[16:17] offset:0
ds_write_b64 v4, v[48:49] offset:16
ds_write_b64 v4, v[18:19] offset:32
ds_write_b64 v4, v[22:23] offset:48
ds_write_b64 v4, v[26:27] offset:64
ds_write_b64 v4, v[38:39] offset:80
ds_write_b64 v4, v[28:29] offset:96
ds_write_b64 v4, v[36:37] offset:112
ds_write_b64 v4, v[42:43] offset:128
ds_write_b64 v4, v[70:71] offset:144
ds_write_b64 v4, v[60:61] offset:160
ds_write_b64 v4, v[68:69] offset:176
ds_write_b64 v4, v[40:41] offset:192
ds_write_b64 v4, v[56:57] offset:208
ds_write_b64 v4, v[62:63] offset:224
ds_write_b64 v4, v[66:67] offset:240
ds_write_b64 v4, v[74:75] offset:256
ds_write_b64 v4, v[76:77] offset:272
ds_write_b64 v4, v[72:73] offset:288
ds_write_b64 v4, v[20:21] offset:304
ds_write_b64 v4, v[64:65] offset:320
ds_write_b64 v4, v[24:25] offset:336
ds_write_b64 v4, v[30:31] offset:352
ds_write_b64 v4, v[34:35] offset:368
ds_write_b64 v4, v[14:15] offset:384
ds_write_b64 v4, v[32:33] offset:400
ds_write_b64 v4, v[46:47] offset:416
ds_write_b64 v4, v[50:51] offset:432
ds_write_b64 v4, v[44:45] offset:448
ds_write_b64 v4, v[52:53] offset:464
ds_write_b64 v4, v[54:55] offset:480
ds_write_b64 v4, v[58:59] offset:496
s_waitcnt lgkmcnt(0)
ds_read_b64 v[16:17], v3 offset:0
ds_read_b64 v[48:49], v3 offset:8448
ds_read_b64 v[18:19], v3 offset:528
ds_read_b64 v[50:51], v3 offset:8976
ds_read_b64 v[20:21], v3 offset:1056
ds_read_b64 v[52:53], v3 offset:9504
ds_read_b64 v[22:23], v3 offset:1584
ds_read_b64 v[54:55], v3 offset:10032
ds_read_b64 v[24:25], v3 offset:2112
ds_read_b64 v[56:57], v3 offset:10560
ds_read_b64 v[26:27], v3 offset:2640
ds_read_b64 v[58:59], v3 offset:11088
ds_read_b64 v[28:29], v3 offset:3168
ds_read_b64 v[60:61], v3 offset:11616
ds_read_b64 v[30:31], v3 offset:3696
ds_read_b64 v[62:63], v3 offset:12144
ds_read_b64 v[32:33], v3 offset:4224
ds_read_b64 v[64:65], v3 offset:12672
ds_read_b64 v[34:35], v3 offset:4752
ds_read_b64 v[66:67], v3 offset:13200
ds_read_b64 v[36:37], v3 offset:5280
ds_read_b64 v[68:69], v3 offset:13728
ds_read_b64 v[38:39], v3 offset:5808
ds_read_b64 v[70:71], v3 offset:14256
ds_read_b64 v[40:41], v3 offset:6336
ds_read_b64 v[72:73], v3 offset:14784
ds_read_b64 v[42:43], v3 offset:6864
ds_read_b64 v[74:75], v3 offset:15312
ds_read_b64 v[44:45], v3 offset:7392
ds_read_b64 v[76:77], v3 offset:15840
ds_read_b64 v[46:47], v3 offset:7920
ds_read_b64 v[78:79], v3 offset:16368
s_waitcnt lgkmcnt(0)
v_pk_add_f32 v[14:15], v[16:17], v[48:49] neg_lo:[0,1] neg_hi:[0,1]
v_pk_add_f32 v[16:17], v[16:17], v[48:49]
v_pk_add_f32 v[48:49], v[18:19], v[50:51] neg_lo:[0,1] neg_hi:[0,1]
v_pk_add_f32 v[18:19], v[18:19], v[50:51]
v_pk_mul_f32 v[50:51], v[48:49], s[50:51] op_sel:[0,0] op_sel_hi:[0,1] neg_lo:[0,0] neg_hi:[0,0]
v_pk_fma_f32 v[50:51], v[48:49], s[50:51], v[50:51] op_sel:[1,1,0] op_sel_hi:[1,0,1] neg_lo:[0,1,0] neg_hi:[0,0,0]
v_pk_add_f32 v[48:49], v[20:21], v[52:53] neg_lo:[0,1] neg_hi:[0,1]
v_pk_add_f32 v[20:21], v[20:21], v[52:53]
v_pk_mul_f32 v[52:53], v[48:49], s[54:55] op_sel:[0,0] op_sel_hi:[0,1] neg_lo:[0,0] neg_hi:[0,0]
v_pk_fma_f32 v[52:53], v[48:49], s[54:55], v[52:53] op_sel:[1,1,0] op_sel_hi:[1,0,1] neg_lo:[0,1,0] neg_hi:[0,0,0]
v_pk_add_f32 v[48:49], v[22:23], v[54:55] neg_lo:[0,1] neg_hi:[0,1]
v_pk_add_f32 v[22:23], v[22:23], v[54:55]
v_pk_mul_f32 v[54:55], v[48:49], s[58:59] op_sel:[0,0] op_sel_hi:[0,1] neg_lo:[0,0] neg_hi:[0,0]
v_pk_fma_f32 v[54:55], v[48:49], s[58:59], v[54:55] op_sel:[1,1,0] op_sel_hi:[1,0,1] neg_lo:[0,1,0] neg_hi:[0,0,0]
v_pk_add_f32 v[48:49], v[24:25], v[56:57] neg_lo:[0,1] neg_hi:[0,1]
v_pk_add_f32 v[24:25], v[24:25], v[56:57]
v_pk_mul_f32 v[56:57], v[48:49], s[62:63] op_sel:[0,0] op_sel_hi:[0,1] neg_lo:[0,0] neg_hi:[0,0]
v_pk_fma_f32 v[56:57], v[48:49], s[62:63], v[56:57] op_sel:[1,1,0] op_sel_hi:[1,0,1] neg_lo:[0,1,0] neg_hi:[0,0,0]
v_pk_add_f32 v[48:49], v[26:27], v[58:59] neg_lo:[0,1] neg_hi:[0,1]
v_pk_add_f32 v[26:27], v[26:27], v[58:59]
v_pk_mul_f32 v[58:59], v[48:49], s[58:59] op_sel:[0,1] op_sel_hi:[0,0] neg_lo:[0,0] neg_hi:[0,0]
v_pk_fma_f32 v[58:59], v[48:49], s[58:59], v[58:59] op_sel:[1,0,0] op_sel_hi:[1,1,1] neg_lo:[0,1,0] neg_hi:[0,0,0]
v_pk_add_f32 v[48:49], v[28:29], v[60:61] neg_lo:[0,1] neg_hi:[0,1]
v_pk_add_f32 v[28:29], v[28:29], v[60:61]
v_pk_mul_f32 v[60:61], v[48:49], s[54:55] op_sel:[0,1] op_sel_hi:[0,0] neg_lo:[0,0] neg_hi:[0,0]
v_pk_fma_f32 v[60:61], v[48:49], s[54:55], v[60:61] op_sel:[1,0,0] op_sel_hi:[1,1,1] neg_lo:[0,1,0] neg_hi:[0,0,0]
v_pk_add_f32 v[48:49], v[30:31], v[62:63] neg_lo:[0,1] neg_hi:[0,1]
v_pk_add_f32 v[30:31], v[30:31], v[62:63]
v_pk_mul_f32 v[62:63], v[48:49], s[50:51] op_sel:[0,1] op_sel_hi:[0,0] neg_lo:[0,0] neg_hi:[0,0]
v_pk_fma_f32 v[62:63], v[48:49], s[50:51], v[62:63] op_sel:[1,0,0] op_sel_hi:[1,1,1] neg_lo:[0,1,0] neg_hi:[0,0,0]
v_pk_add_f32 v[48:49], v[32:33], v[64:65] op_sel:[1,1] op_sel_hi:[0,0] neg_lo:[1,0] neg_hi:[0,1]
v_pk_add_f32 v[32:33], v[32:33], v[64:65]
v_pk_add_f32 v[64:65], v[34:35], v[66:67] neg_lo:[0,1] neg_hi:[0,1]
v_pk_add_f32 v[34:35], v[34:35], v[66:67]
v_pk_mul_f32 v[66:67], v[64:65], s[50:51] op_sel:[0,1] op_sel_hi:[0,0] neg_lo:[0,1] neg_hi:[0,0]
v_pk_fma_f32 v[66:67], v[64:65], s[50:51], v[66:67] op_sel:[1,0,0] op_sel_hi:[1,1,1] neg_lo:[0,1,0] neg_hi:[0,1,0]
v_pk_add_f32 v[64:65], v[36:37], v[68:69] neg_lo:[0,1] neg_hi:[0,1]
v_pk_add_f32 v[36:37], v[36:37], v[68:69]
v_pk_mul_f32 v[68:69], v[64:65], s[54:55] op_sel:[0,1] op_sel_hi:[0,0] neg_lo:[0,1] neg_hi:[0,0]
v_pk_fma_f32 v[68:69], v[64:65], s[54:55], v[68:69] op_sel:[1,0,0] op_sel_hi:[1,1,1] neg_lo:[0,1,0] neg_hi:[0,1,0]
v_pk_add_f32 v[64:65], v[38:39], v[70:71] neg_lo:[0,1] neg_hi:[0,1]
v_pk_add_f32 v[38:39], v[38:39], v[70:71]
v_pk_mul_f32 v[70:71], v[64:65], s[58:59] op_sel:[0,1] op_sel_hi:[0,0] neg_lo:[0,1] neg_hi:[0,0]
v_pk_fma_f32 v[70:71], v[64:65], s[58:59], v[70:71] op_sel:[1,0,0] op_sel_hi:[1,1,1] neg_lo:[0,1,0] neg_hi:[0,1,0]
v_pk_add_f32 v[64:65], v[40:41], v[72:73] neg_lo:[0,1] neg_hi:[0,1]
v_pk_add_f32 v[40:41], v[40:41], v[72:73]
v_pk_mul_f32 v[72:73], v[64:65], s[62:63] op_sel:[0,0] op_sel_hi:[0,1] neg_lo:[0,1] neg_hi:[0,0]
v_pk_fma_f32 v[72:73], v[64:65], s[62:63], v[72:73] op_sel:[1,1,0] op_sel_hi:[1,0,1] neg_lo:[0,1,0] neg_hi:[0,1,0]
v_pk_add_f32 v[64:65], v[42:43], v[74:75] neg_lo:[0,1] neg_hi:[0,1]
v_pk_add_f32 v[42:43], v[42:43], v[74:75]
v_pk_mul_f32 v[74:75], v[64:65], s[58:59] op_sel:[0,0] op_sel_hi:[0,1] neg_lo:[0,1] neg_hi:[0,0]
v_pk_fma_f32 v[74:75], v[64:65], s[58:59], v[74:75] op_sel:[1,1,0] op_sel_hi:[1,0,1] neg_lo:[0,1,0] neg_hi:[0,1,0]
v_pk_add_f32 v[64:65], v[44:45], v[76:77] neg_lo:[0,1] neg_hi:[0,1]
v_pk_add_f32 v[44:45], v[44:45], v[76:77]
v_pk_mul_f32 v[76:77], v[64:65], s[54:55] op_sel:[0,0] op_sel_hi:[0,1] neg_lo:[0,1] neg_hi:[0,0]
v_pk_fma_f32 v[76:77], v[64:65], s[54:55], v[76:77] op_sel:[1,1,0] op_sel_hi:[1,0,1] neg_lo:[0,1,0] neg_hi:[0,1,0]
v_pk_add_f32 v[64:65], v[46:47], v[78:79] neg_lo:[0,1] neg_hi:[0,1]
v_pk_add_f32 v[46:47], v[46:47], v[78:79]
v_pk_mul_f32 v[78:79], v[64:65], s[50:51] op_sel:[0,0] op_sel_hi:[0,1] neg_lo:[0,1] neg_hi:[0,0]
v_pk_fma_f32 v[78:79], v[64:65], s[50:51], v[78:79] op_sel:[1,1,0] op_sel_hi:[1,0,1] neg_lo:[0,1,0] neg_hi:[0,1,0]
v_pk_add_f32 v[64:65], v[16:17], v[32:33] neg_lo:[0,1] neg_hi:[0,1]
v_pk_add_f32 v[16:17], v[16:17], v[32:33]
v_pk_add_f32 v[32:33], v[18:19], v[34:35] neg_lo:[0,1] neg_hi:[0,1]
v_pk_add_f32 v[18:19], v[18:19], v[34:35]
v_pk_mul_f32 v[34:35], v[32:33], s[54:55] op_sel:[0,0] op_sel_hi:[0,1] neg_lo:[0,0] neg_hi:[0,0]
v_pk_fma_f32 v[34:35], v[32:33], s[54:55], v[34:35] op_sel:[1,1,0] op_sel_hi:[1,0,1] neg_lo:[0,1,0] neg_hi:[0,0,0]
v_pk_add_f32 v[32:33], v[20:21], v[36:37] neg_lo:[0,1] neg_hi:[0,1]
v_pk_add_f32 v[20:21], v[20:21], v[36:37]
v_pk_mul_f32 v[36:37], v[32:33], s[62:63] op_sel:[0,0] op_sel_hi:[0,1] neg_lo:[0,0] neg_hi:[0,0]
v_pk_fma_f32 v[36:37], v[32:33], s[62:63], v[36:37] op_sel:[1,1,0] op_sel_hi:[1,0,1] neg_lo:[0,1,0] neg_hi:[0,0,0]
v_pk_add_f32 v[32:33], v[22:23], v[38:39] neg_lo:[0,1] neg_hi:[0,1]
v_pk_add_f32 v[22:23], v[22:23], v[38:39]
v_pk_mul_f32 v[38:39], v[32:33], s[54:55] op_sel:[0,1] op_sel_hi:[0,0] neg_lo:[0,0] neg_hi:[0,0]
v_pk_fma_f32 v[38:39], v[32:33], s[54:55], v[38:39] op_sel:[1,0,0] op_sel_hi:[1,1,1] neg_lo:[0,1,0] neg_hi:[0,0,0]
v_pk_add_f32 v[32:33], v[24:25], v[40:41] op_sel:[1,1] op_sel_hi:[0,0] neg_lo:[1,0] neg_hi:[0,1]
v_pk_add_f32 v[24:25], v[24:25], v[40:41]
v_pk_add_f32 v[40:41], v[26:27], v[42:43] neg_lo:[0,1] neg_hi:[0,1]
v_pk_add_f32 v[26:27], v[26:27], v[42:43]
v_pk_mul_f32 v[42:43], v[40:41], s[54:55] op_sel:[0,1] op_sel_hi:[0,0] neg_lo:[0,1] neg_hi:[0,0]
v_pk_fma_f32 v[42:43], v[40:41], s[54:55], v[42:43] op_sel:[1,0,0] op_sel_hi:[1,1,1] neg_lo:[0,1,0] neg_hi:[0,1,0]
v_pk_add_f32 v[40:41], v[28:29], v[44:45] neg_lo:[0,1] neg_hi:[0,1]
v_pk_add_f32 v[28:29], v[28:29], v[44:45]
v_pk_mul_f32 v[44:45], v[40:41], s[62:63] op_sel:[0,0] op_sel_hi:[0,1] neg_lo:[0,1] neg_hi:[0,0]
v_pk_fma_f32 v[44:45], v[40:41], s[62:63], v[44:45] op_sel:[1,1,0] op_sel_hi:[1,0,1] neg_lo:[0,1,0] neg_hi:[0,1,0]
v_pk_add_f32 v[40:41], v[30:31], v[46:47] neg_lo:[0,1] neg_hi:[0,1]
v_pk_add_f32 v[30:31], v[30:31], v[46:47]
v_pk_mul_f32 v[46:47], v[40:41], s[54:55] op_sel:[0,0] op_sel_hi:[0,1] neg_lo:[0,1] neg_hi:[0,0]
v_pk_fma_f32 v[46:47], v[40:41], s[54:55], v[46:47] op_sel:[1,1,0] op_sel_hi:[1,0,1] neg_lo:[0,1,0] neg_hi:[0,1,0]
v_pk_add_f32 v[40:41], v[14:15], v[48:49] neg_lo:[0,1] neg_hi:[0,1]
v_pk_add_f32 v[14:15], v[14:15], v[48:49]
v_pk_add_f32 v[48:49], v[50:51], v[66:67] neg_lo:[0,1] neg_hi:[0,1]
v_pk_add_f32 v[50:51], v[50:51], v[66:67]
v_pk_mul_f32 v[66:67], v[48:49], s[54:55] op_sel:[0,0] op_sel_hi:[0,1] neg_lo:[0,0] neg_hi:[0,0]
v_pk_fma_f32 v[66:67], v[48:49], s[54:55], v[66:67] op_sel:[1,1,0] op_sel_hi:[1,0,1] neg_lo:[0,1,0] neg_hi:[0,0,0]
v_pk_add_f32 v[48:49], v[52:53], v[68:69] neg_lo:[0,1] neg_hi:[0,1]
v_pk_add_f32 v[52:53], v[52:53], v[68:69]
v_pk_mul_f32 v[68:69], v[48:49], s[62:63] op_sel:[0,0] op_sel_hi:[0,1] neg_lo:[0,0] neg_hi:[0,0]
v_pk_fma_f32 v[68:69], v[48:49], s[62:63], v[68:69] op_sel:[1,1,0] op_sel_hi:[1,0,1] neg_lo:[0,1,0] neg_hi:[0,0,0]
v_pk_add_f32 v[48:49], v[54:55], v[70:71] neg_lo:[0,1] neg_hi:[0,1]
v_pk_add_f32 v[54:55], v[54:55], v[70:71]
v_pk_mul_f32 v[70:71], v[48:49], s[54:55] op_sel:[0,1] op_sel_hi:[0,0] neg_lo:[0,0] neg_hi:[0,0]
v_pk_fma_f32 v[70:71], v[48:49], s[54:55], v[70:71] op_sel:[1,0,0] op_sel_hi:[1,1,1] neg_lo:[0,1,0] neg_hi:[0,0,0]
v_pk_add_f32 v[48:49], v[56:57], v[72:73] op_sel:[1,1] op_sel_hi:[0,0] neg_lo:[1,0] neg_hi:[0,1]
v_pk_add_f32 v[56:57], v[56:57], v[72:73]
v_pk_add_f32 v[72:73], v[58:59], v[74:75] neg_lo:[0,1] neg_hi:[0,1]
v_pk_add_f32 v[58:59], v[58:59], v[74:75]
v_pk_mul_f32 v[74:75], v[72:73], s[54:55] op_sel:[0,1] op_sel_hi:[0,0] neg_lo:[0,1] neg_hi:[0,0]
v_pk_fma_f32 v[74:75], v[72:73], s[54:55], v[74:75] op_sel:[1,0,0] op_sel_hi:[1,1,1] neg_lo:[0,1,0] neg_hi:[0,1,0]
v_pk_add_f32 v[72:73], v[60:61], v[76:77] neg_lo:[0,1] neg_hi:[0,1]
v_pk_add_f32 v[60:61], v[60:61], v[76:77]
v_pk_mul_f32 v[76:77], v[72:73], s[62:63] op_sel:[0,0] op_sel_hi:[0,1] neg_lo:[0,1] neg_hi:[0,0]
v_pk_fma_f32 v[76:77], v[72:73], s[62:63], v[76:77] op_sel:[1,1,0] op_sel_hi:[1,0,1] neg_lo:[0,1,0] neg_hi:[0,1,0]
v_pk_add_f32 v[72:73], v[62:63], v[78:79] neg_lo:[0,1] neg_hi:[0,1]
v_pk_add_f32 v[62:63], v[62:63], v[78:79]
v_pk_mul_f32 v[78:79], v[72:73], s[54:55] op_sel:[0,0] op_sel_hi:[0,1] neg_lo:[0,1] neg_hi:[0,0]
v_pk_fma_f32 v[78:79], v[72:73], s[54:55], v[78:79] op_sel:[1,1,0] op_sel_hi:[1,0,1] neg_lo:[0,1,0] neg_hi:[0,1,0]
v_pk_add_f32 v[72:73], v[16:17], v[24:25] neg_lo:[0,1] neg_hi:[0,1]
v_pk_add_f32 v[16:17], v[16:17], v[24:25]
v_pk_add_f32 v[24:25], v[18:19], v[26:27] neg_lo:[0,1] neg_hi:[0,1]
v_pk_add_f32 v[18:19], v[18:19], v[26:27]
v_pk_mul_f32 v[26:27], v[24:25], s[62:63] op_sel:[0,0] op_sel_hi:[0,1] neg_lo:[0,0] neg_hi:[0,0]
v_pk_fma_f32 v[26:27], v[24:25], s[62:63], v[26:27] op_sel:[1,1,0] op_sel_hi:[1,0,1] neg_lo:[0,1,0] neg_hi:[0,0,0]
v_pk_add_f32 v[24:25], v[20:21], v[28:29] op_sel:[1,1] op_sel_hi:[0,0] neg_lo:[1,0] neg_hi:[0,1]
v_pk_add_f32 v[20:21], v[20:21], v[28:29]
v_pk_add_f32 v[28:29], v[22:23], v[30:31] neg_lo:[0,1] neg_hi:[0,1]
v_pk_add_f32 v[22:23], v[22:23], v[30:31]
v_pk_mul_f32 v[30:31], v[28:29], s[62:63] op_sel:[0,0] op_sel_hi:[0,1] neg_lo:[0,1] neg_hi:[0,0]
v_pk_fma_f32 v[30:31], v[28:29], s[62:63], v[30:31] op_sel:[1,1,0] op_sel_hi:[1,0,1] neg_lo:[0,1,0] neg_hi:[0,1,0]
v_pk_add_f32 v[28:29], v[64:65], v[32:33] neg_lo:[0,1] neg_hi:[0,1]
v_pk_add_f32 v[64:65], v[64:65], v[32:33]
v_pk_add_f32 v[32:33], v[34:35], v[42:43] neg_lo:[0,1] neg_hi:[0,1]
v_pk_add_f32 v[34:35], v[34:35], v[42:43]
v_pk_mul_f32 v[42:43], v[32:33], s[62:63] op_sel:[0,0] op_sel_hi:[0,1] neg_lo:[0,0] neg_hi:[0,0]
v_pk_fma_f32 v[42:43], v[32:33], s[62:63], v[42:43] op_sel:[1,1,0] op_sel_hi:[1,0,1] neg_lo:[0,1,0] neg_hi:[0,0,0]
v_pk_add_f32 v[32:33], v[36:37], v[44:45] op_sel:[1,1] op_sel_hi:[0,0] neg_lo:[1,0] neg_hi:[0,1]
v_pk_add_f32 v[36:37], v[36:37], v[44:45]
v_pk_add_f32 v[44:45], v[38:39], v[46:47] neg_lo:[0,1] neg_hi:[0,1]
v_pk_add_f32 v[38:39], v[38:39], v[46:47]
v_pk_mul_f32 v[46:47], v[44:45], s[62:63] op_sel:[0,0] op_sel_hi:[0,1] neg_lo:[0,1] neg_hi:[0,0]
v_pk_fma_f32 v[46:47], v[44:45], s[62:63], v[46:47] op_sel:[1,1,0] op_sel_hi:[1,0,1] neg_lo:[0,1,0] neg_hi:[0,1,0]
v_pk_add_f32 v[44:45], v[14:15], v[56:57] neg_lo:[0,1] neg_hi:[0,1]
v_pk_add_f32 v[14:15], v[14:15], v[56:57]
v_pk_add_f32 v[56:57], v[50:51], v[58:59] neg_lo:[0,1] neg_hi:[0,1]
v_pk_add_f32 v[50:51], v[50:51], v[58:59]
v_pk_mul_f32 v[58:59], v[56:57], s[62:63] op_sel:[0,0] op_sel_hi:[0,1] neg_lo:[0,0] neg_hi:[0,0]
v_pk_fma_f32 v[58:59], v[56:57], s[62:63], v[58:59] op_sel:[1,1,0] op_sel_hi:[1,0,1] neg_lo:[0,1,0] neg_hi:[0,0,0]
v_pk_add_f32 v[56:57], v[52:53], v[60:61] op_sel:[1,1] op_sel_hi:[0,0] neg_lo:[1,0] neg_hi:[0,1]
v_pk_add_f32 v[52:53], v[52:53], v[60:61]
v_pk_add_f32 v[60:61], v[54:55], v[62:63] neg_lo:[0,1] neg_hi:[0,1]
v_pk_add_f32 v[54:55], v[54:55], v[62:63]
v_pk_mul_f32 v[62:63], v[60:61], s[62:63] op_sel:[0,0] op_sel_hi:[0,1] neg_lo:[0,1] neg_hi:[0,0]
v_pk_fma_f32 v[62:63], v[60:61], s[62:63], v[62:63] op_sel:[1,1,0] op_sel_hi:[1,0,1] neg_lo:[0,1,0] neg_hi:[0,1,0]
v_pk_add_f32 v[60:61], v[40:41], v[48:49] neg_lo:[0,1] neg_hi:[0,1]
v_pk_add_f32 v[40:41], v[40:41], v[48:49]
v_pk_add_f32 v[48:49], v[66:67], v[74:75] neg_lo:[0,1] neg_hi:[0,1]
v_pk_add_f32 v[66:67], v[66:67], v[74:75]
v_pk_mul_f32 v[74:75], v[48:49], s[62:63] op_sel:[0,0] op_sel_hi:[0,1] neg_lo:[0,0] neg_hi:[0,0]
v_pk_fma_f32 v[74:75], v[48:49], s[62:63], v[74:75] op_sel:[1,1,0] op_sel_hi:[1,0,1] neg_lo:[0,1,0] neg_hi:[0,0,0]
v_pk_add_f32 v[48:49], v[68:69], v[76:77] op_sel:[1,1] op_sel_hi:[0,0] neg_lo:[1,0] neg_hi:[0,1]
v_pk_add_f32 v[68:69], v[68:69], v[76:77]
v_pk_add_f32 v[76:77], v[70:71], v[78:79] neg_lo:[0,1] neg_hi:[0,1]
v_pk_add_f32 v[70:71], v[70:71], v[78:79]
v_pk_mul_f32 v[78:79], v[76:77], s[62:63] op_sel:[0,0] op_sel_hi:[0,1] neg_lo:[0,1] neg_hi:[0,0]
v_pk_fma_f32 v[78:79], v[76:77], s[62:63], v[78:79] op_sel:[1,1,0] op_sel_hi:[1,0,1] neg_lo:[0,1,0] neg_hi:[0,1,0]
v_pk_add_f32 v[76:77], v[16:17], v[20:21] neg_lo:[0,1] neg_hi:[0,1]
v_pk_add_f32 v[16:17], v[16:17], v[20:21]
v_pk_add_f32 v[20:21], v[18:19], v[22:23] op_sel:[1,1] op_sel_hi:[0,0] neg_lo:[1,0] neg_hi:[0,1]
v_pk_add_f32 v[18:19], v[18:19], v[22:23]
v_pk_add_f32 v[22:23], v[72:73], v[24:25] neg_lo:[0,1] neg_hi:[0,1]
v_pk_add_f32 v[72:73], v[72:73], v[24:25]
v_pk_add_f32 v[24:25], v[26:27], v[30:31] op_sel:[1,1] op_sel_hi:[0,0] neg_lo:[1,0] neg_hi:[0,1]
v_pk_add_f32 v[26:27], v[26:27], v[30:31]
v_pk_add_f32 v[30:31], v[64:65], v[36:37] neg_lo:[0,1] neg_hi:[0,1]
v_pk_add_f32 v[64:65], v[64:65], v[36:37]
v_pk_add_f32 v[36:37], v[34:35], v[38:39] op_sel:[1,1] op_sel_hi:[0,0] neg_lo:[1,0] neg_hi:[0,1]
v_pk_add_f32 v[34:35], v[34:35], v[38:39]
v_pk_add_f32 v[38:39], v[28:29], v[32:33] neg_lo:[0,1] neg_hi:[0,1]
v_pk_add_f32 v[28:29], v[28:29], v[32:33]
v_pk_add_f32 v[32:33], v[42:43], v[46:47] op_sel:[1,1] op_sel_hi:[0,0] neg_lo:[1,0] neg_hi:[0,1]
v_pk_add_f32 v[42:43], v[42:43], v[46:47]
v_pk_add_f32 v[46:47], v[14:15], v[52:53] neg_lo:[0,1] neg_hi:[0,1]
v_pk_add_f32 v[14:15], v[14:15], v[52:53]
v_pk_add_f32 v[52:53], v[50:51], v[54:55] op_sel:[1,1] op_sel_hi:[0,0] neg_lo:[1,0] neg_hi:[0,1]
v_pk_add_f32 v[50:51], v[50:51], v[54:55]
v_pk_add_f32 v[54:55], v[44:45], v[56:57] neg_lo:[0,1] neg_hi:[0,1]
v_pk_add_f32 v[44:45], v[44:45], v[56:57]
v_pk_add_f32 v[56:57], v[58:59], v[62:63] op_sel:[1,1] op_sel_hi:[0,0] neg_lo:[1,0] neg_hi:[0,1]
v_pk_add_f32 v[58:59], v[58:59], v[62:63]
v_pk_add_f32 v[62:63], v[40:41], v[68:69] neg_lo:[0,1] neg_hi:[0,1]
v_pk_add_f32 v[40:41], v[40:41], v[68:69]
v_pk_add_f32 v[68:69], v[66:67], v[70:71] op_sel:[1,1] op_sel_hi:[0,0] neg_lo:[1,0] neg_hi:[0,1]
v_pk_add_f32 v[66:67], v[66:67], v[70:71]
v_pk_add_f32 v[70:71], v[60:61], v[48:49] neg_lo:[0,1] neg_hi:[0,1]
v_pk_add_f32 v[60:61], v[60:61], v[48:49]
v_pk_add_f32 v[48:49], v[74:75], v[78:79] op_sel:[1,1] op_sel_hi:[0,0] neg_lo:[1,0] neg_hi:[0,1]
v_pk_add_f32 v[74:75], v[74:75], v[78:79]
v_pk_add_f32 v[78:79], v[16:17], v[18:19] neg_lo:[0,1] neg_hi:[0,1]
v_pk_add_f32 v[16:17], v[16:17], v[18:19]
v_pk_add_f32 v[18:19], v[76:77], v[20:21] neg_lo:[0,1] neg_hi:[0,1]
v_pk_add_f32 v[76:77], v[76:77], v[20:21]
v_pk_add_f32 v[20:21], v[72:73], v[26:27] neg_lo:[0,1] neg_hi:[0,1]
v_pk_add_f32 v[72:73], v[72:73], v[26:27]
v_pk_add_f32 v[26:27], v[22:23], v[24:25] neg_lo:[0,1] neg_hi:[0,1]
v_pk_add_f32 v[22:23], v[22:23], v[24:25]
v_pk_add_f32 v[24:25], v[64:65], v[34:35] neg_lo:[0,1] neg_hi:[0,1]
v_pk_add_f32 v[64:65], v[64:65], v[34:35]
v_pk_add_f32 v[34:35], v[30:31], v[36:37] neg_lo:[0,1] neg_hi:[0,1]
v_pk_add_f32 v[30:31], v[30:31], v[36:37]
v_pk_add_f32 v[36:37], v[28:29], v[42:43] neg_lo:[0,1] neg_hi:[0,1]
v_pk_add_f32 v[28:29], v[28:29], v[42:43]
v_pk_add_f32 v[42:43], v[38:39], v[32:33] neg_lo:[0,1] neg_hi:[0,1]
v_pk_add_f32 v[38:39], v[38:39], v[32:33]
v_pk_add_f32 v[32:33], v[14:15], v[50:51] neg_lo:[0,1] neg_hi:[0,1]
v_pk_add_f32 v[14:15], v[14:15], v[50:51]
v_pk_add_f32 v[50:51], v[46:47], v[52:53] neg_lo:[0,1] neg_hi:[0,1]
v_pk_add_f32 v[46:47], v[46:47], v[52:53]
v_pk_add_f32 v[52:53], v[44:45], v[58:59] neg_lo:[0,1] neg_hi:[0,1]
v_pk_add_f32 v[44:45], v[44:45], v[58:59]
v_pk_add_f32 v[58:59], v[54:55], v[56:57] neg_lo:[0,1] neg_hi:[0,1]
v_pk_add_f32 v[54:55], v[54:55], v[56:57]
v_pk_add_f32 v[56:57], v[40:41], v[66:67] neg_lo:[0,1] neg_hi:[0,1]
v_pk_add_f32 v[40:41], v[40:41], v[66:67]
v_pk_add_f32 v[66:67], v[62:63], v[68:69] neg_lo:[0,1] neg_hi:[0,1]
v_pk_add_f32 v[62:63], v[62:63], v[68:69]
v_pk_add_f32 v[68:69], v[60:61], v[74:75] neg_lo:[0,1] neg_hi:[0,1]
v_pk_add_f32 v[60:61], v[60:61], v[74:75]
v_pk_add_f32 v[74:75], v[70:71], v[48:49] neg_lo:[0,1] neg_hi:[0,1]
v_pk_add_f32 v[70:71], v[70:71], v[48:49]
s_lshl_b32 s12, s38, 2
s_add_u32 s12, s12, s16
s_min_u32 s12, s12, 512
s_lshl_b32 s12, s12, 14
s_add_u32 s12, s12, 109051904
buffer_store_dwordx2 v[16:17], v5, s[84:87], s12 offen offset:0 sc1
buffer_store_dwordx2 v[14:15], v5, s[84:87], s12 offen offset:512 sc1
buffer_store_dwordx2 v[64:65], v5, s[84:87], s12 offen offset:1024 sc1
buffer_store_dwordx2 v[40:41], v5, s[84:87], s12 offen offset:1536 sc1
buffer_store_dwordx2 v[72:73], v5, s[84:87], s12 offen offset:2048 sc1
buffer_store_dwordx2 v[44:45], v5, s[84:87], s12 offen offset:2560 sc1
buffer_store_dwordx2 v[28:29], v5, s[84:87], s12 offen offset:3072 sc1
buffer_store_dwordx2 v[60:61], v5, s[84:87], s12 offen offset:3584 sc1
s_add_u32 s12, s12, 4096
buffer_store_dwordx2 v[76:77], v5, s[84:87], s12 offen offset:0 sc1
buffer_store_dwordx2 v[46:47], v5, s[84:87], s12 offen offset:512 sc1
buffer_store_dwordx2 v[30:31], v5, s[84:87], s12 offen offset:1024 sc1
buffer_store_dwordx2 v[62:63], v5, s[84:87], s12 offen offset:1536 sc1
buffer_store_dwordx2 v[22:23], v5, s[84:87], s12 offen offset:2048 sc1
buffer_store_dwordx2 v[54:55], v5, s[84:87], s12 offen offset:2560 sc1
buffer_store_dwordx2 v[38:39], v5, s[84:87], s12 offen offset:3072 sc1
buffer_store_dwordx2 v[70:71], v5, s[84:87], s12 offen offset:3584 sc1
s_add_u32 s12, s12, 4096
buffer_store_dwordx2 v[78:79], v5, s[84:87], s12 offen offset:0 sc1
buffer_store_dwordx2 v[32:33], v5, s[84:87], s12 offen offset:512 sc1
buffer_store_dwordx2 v[24:25], v5, s[84:87], s12 offen offset:1024 sc1
buffer_store_dwordx2 v[56:57], v5, s[84:87], s12 offen offset:1536 sc1
buffer_store_dwordx2 v[20:21], v5, s[84:87], s12 offen offset:2048 sc1
buffer_store_dwordx2 v[52:53], v5, s[84:87], s12 offen offset:2560 sc1
buffer_store_dwordx2 v[36:37], v5, s[84:87], s12 offen offset:3072 sc1
buffer_store_dwordx2 v[68:69], v5, s[84:87], s12 offen offset:3584 sc1
s_add_u32 s12, s12, 4096
buffer_store_dwordx2 v[18:19], v5, s[84:87], s12 offen offset:0 sc1
buffer_store_dwordx2 v[50:51], v5, s[84:87], s12 offen offset:512 sc1
buffer_store_dwordx2 v[34:35], v5, s[84:87], s12 offen offset:1024 sc1
buffer_store_dwordx2 v[66:67], v5, s[84:87], s12 offen offset:1536 sc1
buffer_store_dwordx2 v[26:27], v5, s[84:87], s12 offen offset:2048 sc1
buffer_store_dwordx2 v[58:59], v5, s[84:87], s12 offen offset:2560 sc1
buffer_store_dwordx2 v[42:43], v5, s[84:87], s12 offen offset:3072 sc1
buffer_store_dwordx2 v[74:75], v5, s[84:87], s12 offen offset:3584 sc1
s_add_u32 s12, s12, 4096
s_mov_b32 s38, s21
s_cmp_lt_u32 s38, s37
s_cbranch_scc1 mega_kernel_f2_l
mega_kernel_f2_e:
mega_kernel_f2e:
s_waitcnt vmcnt(0)
s_barrier
v_mov_b32 v1, 0
v_mov_b32 v2, 1
s_mov_b32 s82, 69259392
v_cmp_eq_u32 vcc, 0, v0
s_and_saveexec_b64 s[80:81], vcc
s_cbranch_execz mega_kernel_sg1
buffer_atomic_add v2, v1, s[84:87], s82 offen sc1
mega_kernel_sg1:
s_mov_b64 exec, s[80:81]
s_mov_b32 s64, 0
s_mov_b32 s65, 62
s_mov_b32 s66, 0
s_mov_b32 s67, 0
s_cmp_eq_u32 s91, 3
s_cbranch_scc1 mega_kernel_out
v_mov_b32 v1, 0
s_mov_b32 s82, 69259392
mega_kernel_w1:
s_sleep 8
buffer_load_dword v2, v1, s[84:87], s82 offen sc1
s_waitcnt vmcnt(0)
v_cmp_ne_u32 vcc, 95, v2
s_cbranch_vccnz mega_kernel_w1
s_mov_b32 s93, s92
s_load_dwordx2 s[4:5], s[0:1], 80
s_mov_b32 s48, 0x3f7ec46d
s_mov_b32 s49, 0x3dc8bd36
s_mov_b32 s50, 0x3f7b14be
s_mov_b32 s51, 0x3e47c5c2
s_mov_b32 s52, 0x3f74fa0b
s_mov_b32 s53, 0x3e94a031
s_mov_b32 s54, 0x3f6c835e
s_mov_b32 s55, 0x3ec3ef15
s_mov_b32 s56, 0x3f61c598
s_mov_b32 s57, 0x3ef15aea
s_mov_b32 s58, 0x3f54db31
s_mov_b32 s59, 0x3f0e39da
s_mov_b32 s60, 0x3f45e403
s_mov_b32 s61, 0x3f226799
s_mov_b32 s62, 0x3f3504f3
s_mov_b32 s63, 0x3f3504f3
v_and_b32 v1, 31, v0
v_lshrrev_b32 v2, 5, v0
v_cvt_f32_u32 v3, v1
v_mul_u32_u24 v10, 8448, v2
v_lshl_add_u32 v4, v1, 3, v10
v_mul_u32_u24 v5, 264, v1
v_add_u32 v5, v5, v10
v_and_b32 v11, 7, v0
v_lshrrev_b32 v9, 3, v0
v_mul_u32_u24 v10, 8448, v11
v_lshl_add_u32 v6, v9, 3, v10
v_lshlrev_b32 v7, 3, v9
v_sub_u32 v7, v10, v7
v_add_u32 v7, 4096, v7
v_lshlrev_b32 v8, 14, v9
v_lshl_add_u32 v8, v11, 4, v8
v_mul_f32 v12, 0x3a800000, v3
v_cos_f32 v82, v12
v_sin_f32 v83, v12
v_mul_f32 v12, 0x3b000000, v3
v_cos_f32 v84, v12
v_sin_f32 v85, v12
v_mul_f32 v12, 0x3b400000, v3
v_cos_f32 v86, v12
v_sin_f32 v87, v12
v_mul_f32 v12, 0x3b800000, v3
v_cos_f32 v88, v12
v_sin_f32 v89, v12
v_mul_f32 v12, 0x3ba00000, v3
v_cos_f32 v90, v12
v_sin_f32 v91, v12
v_mul_f32 v12, 0x3bc00000, v3
v_cos_f32 v92, v12
v_sin_f32 v93, v12
v_mul_f32 v12, 0x3be00000, v3
v_cos_f32 v94, v12
v_sin_f32 v95, v12
v_mul_f32 v12, 0x3c000000, v3
v_cos_f32 v96, v12
v_sin_f32 v97, v12
v_mul_f32 v12, 0x3c100000, v3
v_cos_f32 v98, v12
v_sin_f32 v99, v12
v_mul_f32 v12, 0x3c200000, v3
v_cos_f32 v100, v12
v_sin_f32 v101, v12
v_mul_f32 v12, 0x3c300000, v3
v_cos_f32 v102, v12
v_sin_f32 v103, v12
v_mul_f32 v12, 0x3c400000, v3
v_cos_f32 v104, v12
v_sin_f32 v105, v12
v_mul_f32 v12, 0x3c500000, v3
v_cos_f32 v106, v12
v_sin_f32 v107, v12
v_mul_f32 v12, 0x3c600000, v3
v_cos_f32 v108, v12
v_sin_f32 v109, v12
v_mul_f32 v12, 0x3c700000, v3
v_cos_f32 v110, v12
v_sin_f32 v111, v12
v_mul_f32 v12, 0x3c800000, v3
v_cos_f32 v112, v12
v_sin_f32 v113, v12
v_mul_f32 v12, 0x3c880000, v3
v_cos_f32 v114, v12
v_sin_f32 v115, v12
v_mul_f32 v12, 0x3c900000, v3
v_cos_f32 v116, v12
v_sin_f32 v117, v12
v_mul_f32 v12, 0x3c980000, v3
v_cos_f32 v118, v12
v_sin_f32 v119, v12
v_mul_f32 v12, 0x3ca00000, v3
v_cos_f32 v120, v12
v_sin_f32 v121, v12
v_mul_f32 v12, 0x3ca80000, v3
v_cos_f32 v122, v12
v_sin_f32 v123, v12
v_mul_f32 v12, 0x3cb00000, v3
v_cos_f32 v124, v12
v_sin_f32 v125, v12
v_mul_f32 v12, 0x3cb80000, v3
v_cos_f32 v126, v12
v_sin_f32 v127, v12
v_mul_f32 v12, 0x3cc00000, v3
v_cos_f32 v128, v12
v_sin_f32 v129, v12
v_mul_f32 v12, 0x3cc80000, v3
v_cos_f32 v130, v12
v_sin_f32 v131, v12
v_mul_f32 v12, 0x3cd00000, v3
v_cos_f32 v132, v12
v_sin_f32 v133, v12
v_mul_f32 v12, 0x3cd80000, v3
v_cos_f32 v134, v12
v_sin_f32 v135, v12
v_mul_f32 v12, 0x3ce00000, v3
v_cos_f32 v136, v12
v_sin_f32 v137, v12
v_mul_f32 v12, 0x3ce80000, v3
v_cos_f32 v138, v12
v_sin_f32 v139, v12
v_mul_f32 v12, 0x3cf00000, v3
v_cos_f32 v140, v12
v_sin_f32 v141, v12
v_mul_f32 v12, 0x3cf80000, v3
v_cos_f32 v142, v12
v_sin_f32 v143, v12
v_lshlrev_b32 v12, 2, v1
v_sub_u32 v12, v4, v12
v_and_b32 v10, 127, v0
v_lshrrev_b32 v11, 7, v0
v_lshlrev_b32 v2, 5, v10
v_lshl_add_u32 v2, v11, 12, v2
v_lshlrev_b32 v3, 4, v10
v_lshl_add_u32 v3, v11, 12, v3
v_add_u32 v3, 2048, v3
v_cmp_eq_u32 s[14:15], 0, v9
s_waitcnt lgkmcnt(0)
s_mov_b32 s6, 8388608
s_mov_b32 s7, 0x00020000
s_cmp_lt_u32 s93, 128
s_cbranch_scc0 mega_kernel_f3_e
s_lshl_b32 s12, s93, 7
s_add_u32 s12, s12, 109051904
buffer_load_dwordx4 v[144:147], v8, s[84:87], s12 offen sc1
s_add_u32 s12, s12, 524288
buffer_load_dwordx4 v[148:151], v8, s[84:87], s12 offen sc1
s_add_u32 s12, s12, 524288
buffer_load_dwordx4 v[152:155], v8, s[84:87], s12 offen sc1
s_add_u32 s12, s12, 524288
buffer_load_dwordx4 v[156:159], v8, s[84:87], s12 offen sc1
s_add_u32 s12, s12, 524288
buffer_load_dwordx4 v[160:163], v8, s[84:87], s12 offen sc1
s_add_u32 s12, s12, 524288
buffer_load_dwordx4 v[164:167], v8, s[84:87], s12 offen sc1
s_add_u32 s12, s12, 524288
buffer_load_dwordx4 v[168:171], v8, s[84:87], s12 offen sc1
s_add_u32 s12, s12, 524288
buffer_load_dwordx4 v[172:175], v8, s[84:87], s12 offen sc1
s_add_u32 s12, s12, 524288
buffer_load_dwordx4 v[176:179], v8, s[84:87], s12 offen sc1
s_add_u32 s12, s12, 524288
buffer_load_dwordx4 v[180:183], v8, s[84:87], s12 offen sc1
s_add_u32 s12, s12, 524288
buffer_load_dwordx4 v[184:187], v8, s[84:87], s12 offen sc1
s_add_u32 s12, s12, 524288
buffer_load_dwordx4 v[188:191], v8, s[84:87], s12 offen sc1
s_add_u32 s12, s12, 524288
buffer_load_dwordx4 v[192:195], v8, s[84:87], s12 offen sc1
s_add_u32 s12, s12, 524288
buffer_load_dwordx4 v[196:199], v8, s[84:87], s12 offen sc1
s_add_u32 s12, s12, 524288
buffer_load_dwordx4 v[200:203], v8, s[84:87], s12 offen sc1
s_add_u32 s12, s12, 524288
buffer_load_dwordx4 v[204:207], v8, s[84:87], s12 offen sc1
s_add_u32 s12, s12, 524288
buffer_load_dwordx4 v[208:211], v8, s[84:87], s12 offen sc1
s_add_u32 s12, s12, 524288
s_waitcnt vmcnt(0)
mega_kernel_f3_l:
s_add_u32 s21, s93, 64
s_cmp_lt_u32 s21, 128
s_cselect_b32 s22, s21, s93
s_waitcnt vmcnt(8)
s_barrier
v_cndmask_b32 v145, v145, 0, s[14:15]
v_cndmask_b32 v147, v147, 0, s[14:15]
v_cndmask_b32 v209, v209, 0, s[14:15]
v_cndmask_b32 v211, v211, 0, s[14:15]
v_pk_add_f32 v[16:17], v[144:145], v[146:147] op_sel:[0,1] op_sel_hi:[1,0] neg_lo:[0,1]
v_pk_add_f32 v[18:19], v[144:145], v[146:147] op_sel:[0,1] op_sel_hi:[1,0] neg_hi:[1,0]
ds_write_b64 v6, v[16:17] offset:0
ds_write_b64 v7, v[18:19] offset:4096
v_pk_add_f32 v[20:21], v[148:149], v[150:151] op_sel:[0,1] op_sel_hi:[1,0] neg_lo:[0,1]
v_pk_add_f32 v[22:23], v[148:149], v[150:151] op_sel:[0,1] op_sel_hi:[1,0] neg_hi:[1,0]
ds_write_b64 v6, v[20:21] offset:256
ds_write_b64 v7, v[22:23] offset:3840
v_pk_add_f32 v[24:25], v[152:153], v[154:155] op_sel:[0,1] op_sel_hi:[1,0] neg_lo:[0,1]
v_pk_add_f32 v[26:27], v[152:153], v[154:155] op_sel:[0,1] op_sel_hi:[1,0] neg_hi:[1,0]
ds_write_b64 v6, v[24:25] offset:512
ds_write_b64 v7, v[26:27] offset:3584
v_pk_add_f32 v[28:29], v[156:157], v[158:159] op_sel:[0,1] op_sel_hi:[1,0] neg_lo:[0,1]
v_pk_add_f32 v[30:31], v[156:157], v[158:159] op_sel:[0,1] op_sel_hi:[1,0] neg_hi:[1,0]
ds_write_b64 v6, v[28:29] offset:768
ds_write_b64 v7, v[30:31] offset:3328
v_pk_add_f32 v[32:33], v[160:161], v[162:163] op_sel:[0,1] op_sel_hi:[1,0] neg_lo:[0,1]
v_pk_add_f32 v[34:35], v[160:161], v[162:163] op_sel:[0,1] op_sel_hi:[1,0] neg_hi:[1,0]
ds_write_b64 v6, v[32:33] offset:1024
ds_write_b64 v7, v[34:35] offset:3072
v_pk_add_f32 v[36:37], v[164:165], v[166:167] op_sel:[0,1] op_sel_hi:[1,0] neg_lo:[0,1]
v_pk_add_f32 v[38:39], v[164:165], v[166:167] op_sel:[0,1] op_sel_hi:[1,0] neg_hi:[1,0]
ds_write_b64 v6, v[36:37] offset:1280
ds_write_b64 v7, v[38:39] offset:2816
v_pk_add_f32 v[40:41], v[168:169], v[170:171] op_sel:[0,1] op_sel_hi:[1,0] neg_lo:[0,1]
v_pk_add_f32 v[42:43], v[168:169], v[170:171] op_sel:[0,1] op_sel_hi:[1,0] neg_hi:[1,0]
ds_write_b64 v6, v[40:41] offset:1536
ds_write_b64 v7, v[42:43] offset:2560
v_pk_add_f32 v[44:45], v[172:173], v[174:175] op_sel:[0,1] op_sel_hi:[1,0] neg_lo:[0,1]
v_pk_add_f32 v[46:47], v[172:173], v[174:175] op_sel:[0,1] op_sel_hi:[1,0] neg_hi:[1,0]
ds_write_b64 v6, v[44:45] offset:1792
ds_write_b64 v7, v[46:47] offset:2304
v_pk_add_f32 v[48:49], v[176:177], v[178:179] op_sel:[0,1] op_sel_hi:[1,0] neg_lo:[0,1]
v_pk_add_f32 v[50:51], v[176:177], v[178:179] op_sel:[0,1] op_sel_hi:[1,0] neg_hi:[1,0]
ds_write_b64 v6, v[48:49] offset:2048
ds_write_b64 v7, v[50:51] offset:2048
v_pk_add_f32 v[52:53], v[180:181], v[182:183] op_sel:[0,1] op_sel_hi:[1,0] neg_lo:[0,1]
v_pk_add_f32 v[54:55], v[180:181], v[182:183] op_sel:[0,1] op_sel_hi:[1,0] neg_hi:[1,0]
ds_write_b64 v6, v[52:53] offset:2304
ds_write_b64 v7, v[54:55] offset:1792
v_pk_add_f32 v[56:57], v[184:185], v[186:187] op_sel:[0,1] op_sel_hi:[1,0] neg_lo:[0,1]
v_pk_add_f32 v[58:59], v[184:185], v[186:187] op_sel:[0,1] op_sel_hi:[1,0] neg_hi:[1,0]
ds_write_b64 v6, v[56:57] offset:2560
ds_write_b64 v7, v[58:59] offset:1536
v_pk_add_f32 v[60:61], v[188:189], v[190:191] op_sel:[0,1] op_sel_hi:[1,0] neg_lo:[0,1]
v_pk_add_f32 v[62:63], v[188:189], v[190:191] op_sel:[0,1] op_sel_hi:[1,0] neg_hi:[1,0]
ds_write_b64 v6, v[60:61] offset:2816
ds_write_b64 v7, v[62:63] offset:1280
v_pk_add_f32 v[64:65], v[192:193], v[194:195] op_sel:[0,1] op_sel_hi:[1,0] neg_lo:[0,1]
v_pk_add_f32 v[66:67], v[192:193], v[194:195] op_sel:[0,1] op_sel_hi:[1,0] neg_hi:[1,0]
ds_write_b64 v6, v[64:65] offset:3072
ds_write_b64 v7, v[66:67] offset:1024
v_pk_add_f32 v[68:69], v[196:197], v[198:199] op_sel:[0,1] op_sel_hi:[1,0] neg_lo:[0,1]
v_pk_add_f32 v[70:71], v[196:197], v[198:199] op_sel:[0,1] op_sel_hi:[1,0] neg_hi:[1,0]
ds_write_b64 v6, v[68:69] offset:3328
ds_write_b64 v7, v[70:71] offset:768
v_pk_add_f32 v[72:73], v[200:201], v[202:203] op_sel:[0,1] op_sel_hi:[1,0] neg_lo:[0,1]
v_pk_add_f32 v[74:75], v[200:201], v[202:203] op_sel:[0,1] op_sel_hi:[1,0] neg_hi:[1,0]
ds_write_b64 v6, v[72:73] offset:3584
ds_write_b64 v7, v[74:75] offset:512
s_waitcnt lgkmcnt(8)
v_pk_add_f32 v[76:77], v[204:205], v[206:207] op_sel:[0,1] op_sel_hi:[1,0] neg_lo:[0,1]
v_pk_add_f32 v[78:79], v[204:205], v[206:207] op_sel:[0,1] op_sel_hi:[1,0] neg_hi:[1,0]
ds_write_b64 v6, v[76:77] offset:3840
ds_write_b64 v7, v[78:79] offset:256
v_pk_add_f32 v[16:17], v[208:209], v[210:211] op_sel:[0,1] op_sel_hi:[1,0] neg_lo:[0,1]
v_pk_add_f32 v[18:19], v[208:209], v[210:211] op_sel:[0,1] op_sel_hi:[1,0] neg_hi:[1,0]
s_mov_b64 exec, s[14:15]
ds_write_b64 v6, v[16:17] offset:4096
s_mov_b64 exec, -1
s_lshl_b32 s12, s22, 7
s_add_u32 s12, s12, 109051904
buffer_load_dwordx4 v[144:147], v8, s[84:87], s12 offen sc1
s_add_u32 s12, s12, 524288
buffer_load_dwordx4 v[148:151], v8, s[84:87], s12 offen sc1
s_add_u32 s12, s12, 524288
buffer_load_dwordx4 v[152:155], v8, s[84:87], s12 offen sc1
s_add_u32 s12, s12, 524288
buffer_load_dwordx4 v[156:159], v8, s[84:87], s12 offen sc1
s_add_u32 s12, s12, 524288
buffer_load_dwordx4 v[160:163], v8, s[84:87], s12 offen sc1
s_add_u32 s12, s12, 524288
buffer_load_dwordx4 v[164:167], v8, s[84:87], s12 offen sc1
s_add_u32 s12, s12, 524288
buffer_load_dwordx4 v[168:171], v8, s[84:87], s12 offen sc1
s_add_u32 s12, s12, 524288
buffer_load_dwordx4 v[172:175], v8, s[84:87], s12 offen sc1
s_add_u32 s12, s12, 524288
buffer_load_dwordx4 v[176:179], v8, s[84:87], s12 offen sc1
s_add_u32 s12, s12, 524288
buffer_load_dwordx4 v[180:183], v8, s[84:87], s12 offen sc1
s_add_u32 s12, s12, 524288
buffer_load_dwordx4 v[184:187], v8, s[84:87], s12 offen sc1
s_add_u32 s12, s12, 524288
buffer_load_dwordx4 v[188:191], v8, s[84:87], s12 offen sc1
s_add_u32 s12, s12, 524288
buffer_load_dwordx4 v[192:195], v8, s[84:87], s12 offen sc1
s_add_u32 s12, s12, 524288
buffer_load_dwordx4 v[196:199], v8, s[84:87], s12 offen sc1
s_add_u32 s12, s12, 524288
buffer_load_dwordx4 v[200:203], v8, s[84:87], s12 offen sc1
s_add_u32 s12, s12, 524288
buffer_load_dwordx4 v[204:207], v8, s[84:87], s12 offen sc1
s_add_u32 s12, s12, 524288
buffer_load_dwordx4 v[208:211], v8, s[84:87], s12 offen sc1
s_add_u32 s12, s12, 524288
s_waitcnt lgkmcnt(0)
s_barrier
ds_read_b64 v[16:17], v4 offset:0
ds_read_b64 v[48:49], v4 offset:4096
ds_read_b64 v[18:19], v4 offset:256
ds_read_b64 v[50:51], v4 offset:4352
ds_read_b64 v[20:21], v4 offset:512
ds_read_b64 v[52:53], v4 offset:4608
ds_read_b64 v[22:23], v4 offset:768
ds_read_b64 v[54:55], v4 offset:4864
ds_read_b64 v[24:25], v4 offset:1024
ds_read_b64 v[56:57], v4 offset:5120
ds_read_b64 v[26:27], v4 offset:1280
ds_read_b64 v[58:59], v4 offset:5376
ds_read_b64 v[28:29], v4 offset:1536
ds_read_b64 v[60:61], v4 offset:5632
ds_read_b64 v[30:31], v4 offset:1792
ds_read_b64 v[62:63], v4 offset:5888
ds_read_b64 v[32:33], v4 offset:2048
ds_read_b64 v[64:65], v4 offset:6144
ds_read_b64 v[34:35], v4 offset:2304
ds_read_b64 v[66:67], v4 offset:6400
ds_read_b64 v[36:37], v4 offset:2560
ds_read_b64 v[68:69], v4 offset:6656
ds_read_b64 v[38:39], v4 offset:2816
ds_read_b64 v[70:71], v4 offset:6912
ds_read_b64 v[40:41], v4 offset:3072
ds_read_b64 v[72:73], v4 offset:7168
ds_read_b64 v[42:43], v4 offset:3328
ds_read_b64 v[74:75], v4 offset:7424
ds_read_b64 v[44:45], v4 offset:3584
ds_read_b64 v[76:77], v4 offset:7680
ds_read_b64 v[46:47], v4 offset:3840
ds_read_b64 v[78:79], v4 offset:7936
s_waitcnt lgkmcnt(0)
v_pk_add_f32 v[14:15], v[16:17], v[48:49] neg_lo:[0,1] neg_hi:[0,1]
v_pk_add_f32 v[16:17], v[16:17], v[48:49]
v_pk_add_f32 v[48:49], v[18:19], v[50:51] neg_lo:[0,1] neg_hi:[0,1]
v_pk_add_f32 v[18:19], v[18:19], v[50:51]
v_pk_mul_f32 v[50:51], v[48:49], s[50:51] op_sel:[0,0] op_sel_hi:[0,1] neg_lo:[0,0] neg_hi:[0,0]
v_pk_fma_f32 v[50:51], v[48:49], s[50:51], v[50:51] op_sel:[1,1,0] op_sel_hi:[1,0,1] neg_lo:[0,1,0] neg_hi:[0,0,0]
v_pk_add_f32 v[48:49], v[20:21], v[52:53] neg_lo:[0,1] neg_hi:[0,1]
v_pk_add_f32 v[20:21], v[20:21], v[52:53]
v_pk_mul_f32 v[52:53], v[48:49], s[54:55] op_sel:[0,0] op_sel_hi:[0,1] neg_lo:[0,0] neg_hi:[0,0]
v_pk_fma_f32 v[52:53], v[48:49], s[54:55], v[52:53] op_sel:[1,1,0] op_sel_hi:[1,0,1] neg_lo:[0,1,0] neg_hi:[0,0,0]
v_pk_add_f32 v[48:49], v[22:23], v[54:55] neg_lo:[0,1] neg_hi:[0,1]
v_pk_add_f32 v[22:23], v[22:23], v[54:55]
v_pk_mul_f32 v[54:55], v[48:49], s[58:59] op_sel:[0,0] op_sel_hi:[0,1] neg_lo:[0,0] neg_hi:[0,0]
v_pk_fma_f32 v[54:55], v[48:49], s[58:59], v[54:55] op_sel:[1,1,0] op_sel_hi:[1,0,1] neg_lo:[0,1,0] neg_hi:[0,0,0]
v_pk_add_f32 v[48:49], v[24:25], v[56:57] neg_lo:[0,1] neg_hi:[0,1]
v_pk_add_f32 v[24:25], v[24:25], v[56:57]
v_pk_mul_f32 v[56:57], v[48:49], s[62:63] op_sel:[0,0] op_sel_hi:[0,1] neg_lo:[0,0] neg_hi:[0,0]
v_pk_fma_f32 v[56:57], v[48:49], s[62:63], v[56:57] op_sel:[1,1,0] op_sel_hi:[1,0,1] neg_lo:[0,1,0] neg_hi:[0,0,0]
v_pk_add_f32 v[48:49], v[26:27], v[58:59] neg_lo:[0,1] neg_hi:[0,1]
v_pk_add_f32 v[26:27], v[26:27], v[58:59]
v_pk_mul_f32 v[58:59], v[48:49], s[58:59] op_sel:[0,1] op_sel_hi:[0,0] neg_lo:[0,0] neg_hi:[0,0]
v_pk_fma_f32 v[58:59], v[48:49], s[58:59], v[58:59] op_sel:[1,0,0] op_sel_hi:[1,1,1] neg_lo:[0,1,0] neg_hi:[0,0,0]
v_pk_add_f32 v[48:49], v[28:29], v[60:61] neg_lo:[0,1] neg_hi:[0,1]
v_pk_add_f32 v[28:29], v[28:29], v[60:61]
v_pk_mul_f32 v[60:61], v[48:49], s[54:55] op_sel:[0,1] op_sel_hi:[0,0] neg_lo:[0,0] neg_hi:[0,0]
v_pk_fma_f32 v[60:61], v[48:49], s[54:55], v[60:61] op_sel:[1,0,0] op_sel_hi:[1,1,1] neg_lo:[0,1,0] neg_hi:[0,0,0]
v_pk_add_f32 v[48:49], v[30:31], v[62:63] neg_lo:[0,1] neg_hi:[0,1]
v_pk_add_f32 v[30:31], v[30:31], v[62:63]
v_pk_mul_f32 v[62:63], v[48:49], s[50:51] op_sel:[0,1] op_sel_hi:[0,0] neg_lo:[0,0] neg_hi:[0,0]
v_pk_fma_f32 v[62:63], v[48:49], s[50:51], v[62:63] op_sel:[1,0,0] op_sel_hi:[1,1,1] neg_lo:[0,1,0] neg_hi:[0,0,0]
v_pk_add_f32 v[48:49], v[32:33], v[64:65] op_sel:[1,1] op_sel_hi:[0,0] neg_lo:[1,0] neg_hi:[0,1]
v_pk_add_f32 v[32:33], v[32:33], v[64:65]
v_pk_add_f32 v[64:65], v[34:35], v[66:67] neg_lo:[0,1] neg_hi:[0,1]
v_pk_add_f32 v[34:35], v[34:35], v[66:67]
v_pk_mul_f32 v[66:67], v[64:65], s[50:51] op_sel:[0,1] op_sel_hi:[0,0] neg_lo:[0,1] neg_hi:[0,0]
v_pk_fma_f32 v[66:67], v[64:65], s[50:51], v[66:67] op_sel:[1,0,0] op_sel_hi:[1,1,1] neg_lo:[0,1,0] neg_hi:[0,1,0]
v_pk_add_f32 v[64:65], v[36:37], v[68:69] neg_lo:[0,1] neg_hi:[0,1]
v_pk_add_f32 v[36:37], v[36:37], v[68:69]
v_pk_mul_f32 v[68:69], v[64:65], s[54:55] op_sel:[0,1] op_sel_hi:[0,0] neg_lo:[0,1] neg_hi:[0,0]
v_pk_fma_f32 v[68:69], v[64:65], s[54:55], v[68:69] op_sel:[1,0,0] op_sel_hi:[1,1,1] neg_lo:[0,1,0] neg_hi:[0,1,0]
v_pk_add_f32 v[64:65], v[38:39], v[70:71] neg_lo:[0,1] neg_hi:[0,1]
v_pk_add_f32 v[38:39], v[38:39], v[70:71]
v_pk_mul_f32 v[70:71], v[64:65], s[58:59] op_sel:[0,1] op_sel_hi:[0,0] neg_lo:[0,1] neg_hi:[0,0]
v_pk_fma_f32 v[70:71], v[64:65], s[58:59], v[70:71] op_sel:[1,0,0] op_sel_hi:[1,1,1] neg_lo:[0,1,0] neg_hi:[0,1,0]
v_pk_add_f32 v[64:65], v[40:41], v[72:73] neg_lo:[0,1] neg_hi:[0,1]
v_pk_add_f32 v[40:41], v[40:41], v[72:73]
v_pk_mul_f32 v[72:73], v[64:65], s[62:63] op_sel:[0,0] op_sel_hi:[0,1] neg_lo:[0,1] neg_hi:[0,0]
v_pk_fma_f32 v[72:73], v[64:65], s[62:63], v[72:73] op_sel:[1,1,0] op_sel_hi:[1,0,1] neg_lo:[0,1,0] neg_hi:[0,1,0]
v_pk_add_f32 v[64:65], v[42:43], v[74:75] neg_lo:[0,1] neg_hi:[0,1]
v_pk_add_f32 v[42:43], v[42:43], v[74:75]
v_pk_mul_f32 v[74:75], v[64:65], s[58:59] op_sel:[0,0] op_sel_hi:[0,1] neg_lo:[0,1] neg_hi:[0,0]
v_pk_fma_f32 v[74:75], v[64:65], s[58:59], v[74:75] op_sel:[1,1,0] op_sel_hi:[1,0,1] neg_lo:[0,1,0] neg_hi:[0,1,0]
v_pk_add_f32 v[64:65], v[44:45], v[76:77] neg_lo:[0,1] neg_hi:[0,1]
v_pk_add_f32 v[44:45], v[44:45], v[76:77]
v_pk_mul_f32 v[76:77], v[64:65], s[54:55] op_sel:[0,0] op_sel_hi:[0,1] neg_lo:[0,1] neg_hi:[0,0]
v_pk_fma_f32 v[76:77], v[64:65], s[54:55], v[76:77] op_sel:[1,1,0] op_sel_hi:[1,0,1] neg_lo:[0,1,0] neg_hi:[0,1,0]
v_pk_add_f32 v[64:65], v[46:47], v[78:79] neg_lo:[0,1] neg_hi:[0,1]
v_pk_add_f32 v[46:47], v[46:47], v[78:79]
v_pk_mul_f32 v[78:79], v[64:65], s[50:51] op_sel:[0,0] op_sel_hi:[0,1] neg_lo:[0,1] neg_hi:[0,0]
v_pk_fma_f32 v[78:79], v[64:65], s[50:51], v[78:79] op_sel:[1,1,0] op_sel_hi:[1,0,1] neg_lo:[0,1,0] neg_hi:[0,1,0]
v_pk_add_f32 v[64:65], v[16:17], v[32:33] neg_lo:[0,1] neg_hi:[0,1]
v_pk_add_f32 v[16:17], v[16:17], v[32:33]
v_pk_add_f32 v[32:33], v[18:19], v[34:35] neg_lo:[0,1] neg_hi:[0,1]
v_pk_add_f32 v[18:19], v[18:19], v[34:35]
v_pk_mul_f32 v[34:35], v[32:33], s[54:55] op_sel:[0,0] op_sel_hi:[0,1] neg_lo:[0,0] neg_hi:[0,0]
v_pk_fma_f32 v[34:35], v[32:33], s[54:55], v[34:35] op_sel:[1,1,0] op_sel_hi:[1,0,1] neg_lo:[0,1,0] neg_hi:[0,0,0]
v_pk_add_f32 v[32:33], v[20:21], v[36:37] neg_lo:[0,1] neg_hi:[0,1]
v_pk_add_f32 v[20:21], v[20:21], v[36:37]
v_pk_mul_f32 v[36:37], v[32:33], s[62:63] op_sel:[0,0] op_sel_hi:[0,1] neg_lo:[0,0] neg_hi:[0,0]
v_pk_fma_f32 v[36:37], v[32:33], s[62:63], v[36:37] op_sel:[1,1,0] op_sel_hi:[1,0,1] neg_lo:[0,1,0] neg_hi:[0,0,0]
v_pk_add_f32 v[32:33], v[22:23], v[38:39] neg_lo:[0,1] neg_hi:[0,1]
v_pk_add_f32 v[22:23], v[22:23], v[38:39]
v_pk_mul_f32 v[38:39], v[32:33], s[54:55] op_sel:[0,1] op_sel_hi:[0,0] neg_lo:[0,0] neg_hi:[0,0]
v_pk_fma_f32 v[38:39], v[32:33], s[54:55], v[38:39] op_sel:[1,0,0] op_sel_hi:[1,1,1] neg_lo:[0,1,0] neg_hi:[0,0,0]
v_pk_add_f32 v[32:33], v[24:25], v[40:41] op_sel:[1,1] op_sel_hi:[0,0] neg_lo:[1,0] neg_hi:[0,1]
v_pk_add_f32 v[24:25], v[24:25], v[40:41]
v_pk_add_f32 v[40:41], v[26:27], v[42:43] neg_lo:[0,1] neg_hi:[0,1]
v_pk_add_f32 v[26:27], v[26:27], v[42:43]
v_pk_mul_f32 v[42:43], v[40:41], s[54:55] op_sel:[0,1] op_sel_hi:[0,0] neg_lo:[0,1] neg_hi:[0,0]
v_pk_fma_f32 v[42:43], v[40:41], s[54:55], v[42:43] op_sel:[1,0,0] op_sel_hi:[1,1,1] neg_lo:[0,1,0] neg_hi:[0,1,0]
v_pk_add_f32 v[40:41], v[28:29], v[44:45] neg_lo:[0,1] neg_hi:[0,1]
v_pk_add_f32 v[28:29], v[28:29], v[44:45]
v_pk_mul_f32 v[44:45], v[40:41], s[62:63] op_sel:[0,0] op_sel_hi:[0,1] neg_lo:[0,1] neg_hi:[0,0]
v_pk_fma_f32 v[44:45], v[40:41], s[62:63], v[44:45] op_sel:[1,1,0] op_sel_hi:[1,0,1] neg_lo:[0,1,0] neg_hi:[0,1,0]
v_pk_add_f32 v[40:41], v[30:31], v[46:47] neg_lo:[0,1] neg_hi:[0,1]
v_pk_add_f32 v[30:31], v[30:31], v[46:47]
v_pk_mul_f32 v[46:47], v[40:41], s[54:55] op_sel:[0,0] op_sel_hi:[0,1] neg_lo:[0,1] neg_hi:[0,0]
v_pk_fma_f32 v[46:47], v[40:41], s[54:55], v[46:47] op_sel:[1,1,0] op_sel_hi:[1,0,1] neg_lo:[0,1,0] neg_hi:[0,1,0]
v_pk_add_f32 v[40:41], v[14:15], v[48:49] neg_lo:[0,1] neg_hi:[0,1]
v_pk_add_f32 v[14:15], v[14:15], v[48:49]
v_pk_add_f32 v[48:49], v[50:51], v[66:67] neg_lo:[0,1] neg_hi:[0,1]
v_pk_add_f32 v[50:51], v[50:51], v[66:67]
v_pk_mul_f32 v[66:67], v[48:49], s[54:55] op_sel:[0,0] op_sel_hi:[0,1] neg_lo:[0,0] neg_hi:[0,0]
v_pk_fma_f32 v[66:67], v[48:49], s[54:55], v[66:67] op_sel:[1,1,0] op_sel_hi:[1,0,1] neg_lo:[0,1,0] neg_hi:[0,0,0]
v_pk_add_f32 v[48:49], v[52:53], v[68:69] neg_lo:[0,1] neg_hi:[0,1]
v_pk_add_f32 v[52:53], v[52:53], v[68:69]
v_pk_mul_f32 v[68:69], v[48:49], s[62:63] op_sel:[0,0] op_sel_hi:[0,1] neg_lo:[0,0] neg_hi:[0,0]
v_pk_fma_f32 v[68:69], v[48:49], s[62:63], v[68:69] op_sel:[1,1,0] op_sel_hi:[1,0,1] neg_lo:[0,1,0] neg_hi:[0,0,0]
v_pk_add_f32 v[48:49], v[54:55], v[70:71] neg_lo:[0,1] neg_hi:[0,1]
v_pk_add_f32 v[54:55], v[54:55], v[70:71]
v_pk_mul_f32 v[70:71], v[48:49], s[54:55] op_sel:[0,1] op_sel_hi:[0,0] neg_lo:[0,0] neg_hi:[0,0]
v_pk_fma_f32 v[70:71], v[48:49], s[54:55], v[70:71] op_sel:[1,0,0] op_sel_hi:[1,1,1] neg_lo:[0,1,0] neg_hi:[0,0,0]
v_pk_add_f32 v[48:49], v[56:57], v[72:73] op_sel:[1,1] op_sel_hi:[0,0] neg_lo:[1,0] neg_hi:[0,1]
v_pk_add_f32 v[56:57], v[56:57], v[72:73]
v_pk_add_f32 v[72:73], v[58:59], v[74:75] neg_lo:[0,1] neg_hi:[0,1]
v_pk_add_f32 v[58:59], v[58:59], v[74:75]
v_pk_mul_f32 v[74:75], v[72:73], s[54:55] op_sel:[0,1] op_sel_hi:[0,0] neg_lo:[0,1] neg_hi:[0,0]
v_pk_fma_f32 v[74:75], v[72:73], s[54:55], v[74:75] op_sel:[1,0,0] op_sel_hi:[1,1,1] neg_lo:[0,1,0] neg_hi:[0,1,0]
v_pk_add_f32 v[72:73], v[60:61], v[76:77] neg_lo:[0,1] neg_hi:[0,1]
v_pk_add_f32 v[60:61], v[60:61], v[76:77]
v_pk_mul_f32 v[76:77], v[72:73], s[62:63] op_sel:[0,0] op_sel_hi:[0,1] neg_lo:[0,1] neg_hi:[0,0]
v_pk_fma_f32 v[76:77], v[72:73], s[62:63], v[76:77] op_sel:[1,1,0] op_sel_hi:[1,0,1] neg_lo:[0,1,0] neg_hi:[0,1,0]
v_pk_add_f32 v[72:73], v[62:63], v[78:79] neg_lo:[0,1] neg_hi:[0,1]
v_pk_add_f32 v[62:63], v[62:63], v[78:79]
v_pk_mul_f32 v[78:79], v[72:73], s[54:55] op_sel:[0,0] op_sel_hi:[0,1] neg_lo:[0,1] neg_hi:[0,0]
v_pk_fma_f32 v[78:79], v[72:73], s[54:55], v[78:79] op_sel:[1,1,0] op_sel_hi:[1,0,1] neg_lo:[0,1,0] neg_hi:[0,1,0]
v_pk_add_f32 v[72:73], v[16:17], v[24:25] neg_lo:[0,1] neg_hi:[0,1]
v_pk_add_f32 v[16:17], v[16:17], v[24:25]
v_pk_add_f32 v[24:25], v[18:19], v[26:27] neg_lo:[0,1] neg_hi:[0,1]
v_pk_add_f32 v[18:19], v[18:19], v[26:27]
v_pk_mul_f32 v[26:27], v[24:25], s[62:63] op_sel:[0,0] op_sel_hi:[0,1] neg_lo:[0,0] neg_hi:[0,0]
v_pk_fma_f32 v[26:27], v[24:25], s[62:63], v[26:27] op_sel:[1,1,0] op_sel_hi:[1,0,1] neg_lo:[0,1,0] neg_hi:[0,0,0]
v_pk_add_f32 v[24:25], v[20:21], v[28:29] op_sel:[1,1] op_sel_hi:[0,0] neg_lo:[1,0] neg_hi:[0,1]
v_pk_add_f32 v[20:21], v[20:21], v[28:29]
v_pk_add_f32 v[28:29], v[22:23], v[30:31] neg_lo:[0,1] neg_hi:[0,1]
v_pk_add_f32 v[22:23], v[22:23], v[30:31]
v_pk_mul_f32 v[30:31], v[28:29], s[62:63] op_sel:[0,0] op_sel_hi:[0,1] neg_lo:[0,1] neg_hi:[0,0]
v_pk_fma_f32 v[30:31], v[28:29], s[62:63], v[30:31] op_sel:[1,1,0] op_sel_hi:[1,0,1] neg_lo:[0,1,0] neg_hi:[0,1,0]
v_pk_add_f32 v[28:29], v[64:65], v[32:33] neg_lo:[0,1] neg_hi:[0,1]
v_pk_add_f32 v[64:65], v[64:65], v[32:33]
v_pk_add_f32 v[32:33], v[34:35], v[42:43] neg_lo:[0,1] neg_hi:[0,1]
v_pk_add_f32 v[34:35], v[34:35], v[42:43]
v_pk_mul_f32 v[42:43], v[32:33], s[62:63] op_sel:[0,0] op_sel_hi:[0,1] neg_lo:[0,0] neg_hi:[0,0]
v_pk_fma_f32 v[42:43], v[32:33], s[62:63], v[42:43] op_sel:[1,1,0] op_sel_hi:[1,0,1] neg_lo:[0,1,0] neg_hi:[0,0,0]
v_pk_add_f32 v[32:33], v[36:37], v[44:45] op_sel:[1,1] op_sel_hi:[0,0] neg_lo:[1,0] neg_hi:[0,1]
v_pk_add_f32 v[36:37], v[36:37], v[44:45]
v_pk_add_f32 v[44:45], v[38:39], v[46:47] neg_lo:[0,1] neg_hi:[0,1]
v_pk_add_f32 v[38:39], v[38:39], v[46:47]
v_pk_mul_f32 v[46:47], v[44:45], s[62:63] op_sel:[0,0] op_sel_hi:[0,1] neg_lo:[0,1] neg_hi:[0,0]
v_pk_fma_f32 v[46:47], v[44:45], s[62:63], v[46:47] op_sel:[1,1,0] op_sel_hi:[1,0,1] neg_lo:[0,1,0] neg_hi:[0,1,0]
v_pk_add_f32 v[44:45], v[14:15], v[56:57] neg_lo:[0,1] neg_hi:[0,1]
v_pk_add_f32 v[14:15], v[14:15], v[56:57]
v_pk_add_f32 v[56:57], v[50:51], v[58:59] neg_lo:[0,1] neg_hi:[0,1]
v_pk_add_f32 v[50:51], v[50:51], v[58:59]
v_pk_mul_f32 v[58:59], v[56:57], s[62:63] op_sel:[0,0] op_sel_hi:[0,1] neg_lo:[0,0] neg_hi:[0,0]
v_pk_fma_f32 v[58:59], v[56:57], s[62:63], v[58:59] op_sel:[1,1,0] op_sel_hi:[1,0,1] neg_lo:[0,1,0] neg_hi:[0,0,0]
v_pk_add_f32 v[56:57], v[52:53], v[60:61] op_sel:[1,1] op_sel_hi:[0,0] neg_lo:[1,0] neg_hi:[0,1]
v_pk_add_f32 v[52:53], v[52:53], v[60:61]
v_pk_add_f32 v[60:61], v[54:55], v[62:63] neg_lo:[0,1] neg_hi:[0,1]
v_pk_add_f32 v[54:55], v[54:55], v[62:63]
v_pk_mul_f32 v[62:63], v[60:61], s[62:63] op_sel:[0,0] op_sel_hi:[0,1] neg_lo:[0,1] neg_hi:[0,0]
v_pk_fma_f32 v[62:63], v[60:61], s[62:63], v[62:63] op_sel:[1,1,0] op_sel_hi:[1,0,1] neg_lo:[0,1,0] neg_hi:[0,1,0]
v_pk_add_f32 v[60:61], v[40:41], v[48:49] neg_lo:[0,1] neg_hi:[0,1]
v_pk_add_f32 v[40:41], v[40:41], v[48:49]
v_pk_add_f32 v[48:49], v[66:67], v[74:75] neg_lo:[0,1] neg_hi:[0,1]
v_pk_add_f32 v[66:67], v[66:67], v[74:75]
v_pk_mul_f32 v[74:75], v[48:49], s[62:63] op_sel:[0,0] op_sel_hi:[0,1] neg_lo:[0,0] neg_hi:[0,0]
v_pk_fma_f32 v[74:75], v[48:49], s[62:63], v[74:75] op_sel:[1,1,0] op_sel_hi:[1,0,1] neg_lo:[0,1,0] neg_hi:[0,0,0]
v_pk_add_f32 v[48:49], v[68:69], v[76:77] op_sel:[1,1] op_sel_hi:[0,0] neg_lo:[1,0] neg_hi:[0,1]
v_pk_add_f32 v[68:69], v[68:69], v[76:77]
v_pk_add_f32 v[76:77], v[70:71], v[78:79] neg_lo:[0,1] neg_hi:[0,1]
v_pk_add_f32 v[70:71], v[70:71], v[78:79]
v_pk_mul_f32 v[78:79], v[76:77], s[62:63] op_sel:[0,0] op_sel_hi:[0,1] neg_lo:[0,1] neg_hi:[0,0]
v_pk_fma_f32 v[78:79], v[76:77], s[62:63], v[78:79] op_sel:[1,1,0] op_sel_hi:[1,0,1] neg_lo:[0,1,0] neg_hi:[0,1,0]
v_pk_add_f32 v[76:77], v[16:17], v[20:21] neg_lo:[0,1] neg_hi:[0,1]
v_pk_add_f32 v[16:17], v[16:17], v[20:21]
v_pk_add_f32 v[20:21], v[18:19], v[22:23] op_sel:[1,1] op_sel_hi:[0,0] neg_lo:[1,0] neg_hi:[0,1]
v_pk_add_f32 v[18:19], v[18:19], v[22:23]
v_pk_add_f32 v[22:23], v[72:73], v[24:25] neg_lo:[0,1] neg_hi:[0,1]
v_pk_add_f32 v[72:73], v[72:73], v[24:25]
v_pk_add_f32 v[24:25], v[26:27], v[30:31] op_sel:[1,1] op_sel_hi:[0,0] neg_lo:[1,0] neg_hi:[0,1]
v_pk_add_f32 v[26:27], v[26:27], v[30:31]
v_pk_add_f32 v[30:31], v[64:65], v[36:37] neg_lo:[0,1] neg_hi:[0,1]
v_pk_add_f32 v[64:65], v[64:65], v[36:37]
v_pk_add_f32 v[36:37], v[34:35], v[38:39] op_sel:[1,1] op_sel_hi:[0,0] neg_lo:[1,0] neg_hi:[0,1]
v_pk_add_f32 v[34:35], v[34:35], v[38:39]
v_pk_add_f32 v[38:39], v[28:29], v[32:33] neg_lo:[0,1] neg_hi:[0,1]
v_pk_add_f32 v[28:29], v[28:29], v[32:33]
v_pk_add_f32 v[32:33], v[42:43], v[46:47] op_sel:[1,1] op_sel_hi:[0,0] neg_lo:[1,0] neg_hi:[0,1]
v_pk_add_f32 v[42:43], v[42:43], v[46:47]
v_pk_add_f32 v[46:47], v[14:15], v[52:53] neg_lo:[0,1] neg_hi:[0,1]
v_pk_add_f32 v[14:15], v[14:15], v[52:53]
v_pk_add_f32 v[52:53], v[50:51], v[54:55] op_sel:[1,1] op_sel_hi:[0,0] neg_lo:[1,0] neg_hi:[0,1]
v_pk_add_f32 v[50:51], v[50:51], v[54:55]
v_pk_add_f32 v[54:55], v[44:45], v[56:57] neg_lo:[0,1] neg_hi:[0,1]
v_pk_add_f32 v[44:45], v[44:45], v[56:57]
v_pk_add_f32 v[56:57], v[58:59], v[62:63] op_sel:[1,1] op_sel_hi:[0,0] neg_lo:[1,0] neg_hi:[0,1]
v_pk_add_f32 v[58:59], v[58:59], v[62:63]
v_pk_add_f32 v[62:63], v[40:41], v[68:69] neg_lo:[0,1] neg_hi:[0,1]
v_pk_add_f32 v[40:41], v[40:41], v[68:69]
v_pk_add_f32 v[68:69], v[66:67], v[70:71] op_sel:[1,1] op_sel_hi:[0,0] neg_lo:[1,0] neg_hi:[0,1]
v_pk_add_f32 v[66:67], v[66:67], v[70:71]
v_pk_add_f32 v[70:71], v[60:61], v[48:49] neg_lo:[0,1] neg_hi:[0,1]
v_pk_add_f32 v[60:61], v[60:61], v[48:49]
v_pk_add_f32 v[48:49], v[74:75], v[78:79] op_sel:[1,1] op_sel_hi:[0,0] neg_lo:[1,0] neg_hi:[0,1]
v_pk_add_f32 v[74:75], v[74:75], v[78:79]
v_pk_add_f32 v[78:79], v[16:17], v[18:19] neg_lo:[0,1] neg_hi:[0,1]
v_pk_add_f32 v[16:17], v[16:17], v[18:19]
v_pk_add_f32 v[18:19], v[76:77], v[20:21] neg_lo:[0,1] neg_hi:[0,1]
v_pk_add_f32 v[76:77], v[76:77], v[20:21]
v_pk_add_f32 v[20:21], v[72:73], v[26:27] neg_lo:[0,1] neg_hi:[0,1]
v_pk_add_f32 v[72:73], v[72:73], v[26:27]
v_pk_add_f32 v[26:27], v[22:23], v[24:25] neg_lo:[0,1] neg_hi:[0,1]
v_pk_add_f32 v[22:23], v[22:23], v[24:25]
v_pk_add_f32 v[24:25], v[64:65], v[34:35] neg_lo:[0,1] neg_hi:[0,1]
v_pk_add_f32 v[64:65], v[64:65], v[34:35]
v_pk_add_f32 v[34:35], v[30:31], v[36:37] neg_lo:[0,1] neg_hi:[0,1]
v_pk_add_f32 v[30:31], v[30:31], v[36:37]
v_pk_add_f32 v[36:37], v[28:29], v[42:43] neg_lo:[0,1] neg_hi:[0,1]
v_pk_add_f32 v[28:29], v[28:29], v[42:43]
v_pk_add_f32 v[42:43], v[38:39], v[32:33] neg_lo:[0,1] neg_hi:[0,1]
v_pk_add_f32 v[38:39], v[38:39], v[32:33]
v_pk_add_f32 v[32:33], v[14:15], v[50:51] neg_lo:[0,1] neg_hi:[0,1]
v_pk_add_f32 v[14:15], v[14:15], v[50:51]
v_pk_add_f32 v[50:51], v[46:47], v[52:53] neg_lo:[0,1] neg_hi:[0,1]
v_pk_add_f32 v[46:47], v[46:47], v[52:53]
v_pk_add_f32 v[52:53], v[44:45], v[58:59] neg_lo:[0,1] neg_hi:[0,1]
v_pk_add_f32 v[44:45], v[44:45], v[58:59]
v_pk_add_f32 v[58:59], v[54:55], v[56:57] neg_lo:[0,1] neg_hi:[0,1]
v_pk_add_f32 v[54:55], v[54:55], v[56:57]
v_pk_add_f32 v[56:57], v[40:41], v[66:67] neg_lo:[0,1] neg_hi:[0,1]
v_pk_add_f32 v[40:41], v[40:41], v[66:67]
v_pk_add_f32 v[66:67], v[62:63], v[68:69] neg_lo:[0,1] neg_hi:[0,1]
v_pk_add_f32 v[62:63], v[62:63], v[68:69]
v_pk_add_f32 v[68:69], v[60:61], v[74:75] neg_lo:[0,1] neg_hi:[0,1]
v_pk_add_f32 v[60:61], v[60:61], v[74:75]
v_pk_add_f32 v[74:75], v[70:71], v[48:49] neg_lo:[0,1] neg_hi:[0,1]
v_pk_add_f32 v[70:71], v[70:71], v[48:49]
v_pk_mul_f32 v[48:49], v[14:15], v[82:83] op_sel:[0,0] op_sel_hi:[0,1] neg_lo:[0,0] neg_hi:[0,0]
v_pk_fma_f32 v[14:15], v[14:15], v[82:83], v[48:49] op_sel:[1,1,0] op_sel_hi:[1,0,1] neg_lo:[0,1,0] neg_hi:[0,0,0]
v_pk_mul_f32 v[48:49], v[64:65], v[84:85] op_sel:[0,0] op_sel_hi:[0,1] neg_lo:[0,0] neg_hi:[0,0]
v_pk_fma_f32 v[64:65], v[64:65], v[84:85], v[48:49] op_sel:[1,1,0] op_sel_hi:[1,0,1] neg_lo:[0,1,0] neg_hi:[0,0,0]
v_pk_mul_f32 v[48:49], v[40:41], v[86:87] op_sel:[0,0] op_sel_hi:[0,1] neg_lo:[0,0] neg_hi:[0,0]
v_pk_fma_f32 v[40:41], v[40:41], v[86:87], v[48:49] op_sel:[1,1,0] op_sel_hi:[1,0,1] neg_lo:[0,1,0] neg_hi:[0,0,0]
v_pk_mul_f32 v[48:49], v[72:73], v[88:89] op_sel:[0,0] op_sel_hi:[0,1] neg_lo:[0,0] neg_hi:[0,0]
v_pk_fma_f32 v[72:73], v[72:73], v[88:89], v[48:49] op_sel:[1,1,0] op_sel_hi:[1,0,1] neg_lo:[0,1,0] neg_hi:[0,0,0]
v_pk_mul_f32 v[48:49], v[44:45], v[90:91] op_sel:[0,0] op_sel_hi:[0,1] neg_lo:[0,0] neg_hi:[0,0]
v_pk_fma_f32 v[44:45], v[44:45], v[90:91], v[48:49] op_sel:[1,1,0] op_sel_hi:[1,0,1] neg_lo:[0,1,0] neg_hi:[0,0,0]
v_pk_mul_f32 v[48:49], v[28:29], v[92:93] op_sel:[0,0] op_sel_hi:[0,1] neg_lo:[0,0] neg_hi:[0,0]
v_pk_fma_f32 v[28:29], v[28:29], v[92:93], v[48:49] op_sel:[1,1,0] op_sel_hi:[1,0,1] neg_lo:[0,1,0] neg_hi:[0,0,0]
v_pk_mul_f32 v[48:49], v[60:61], v[94:95] op_sel:[0,0] op_sel_hi:[0,1] neg_lo:[0,0] neg_hi:[0,0]
v_pk_fma_f32 v[60:61], v[60:61], v[94:95], v[48:49] op_sel:[1,1,0] op_sel_hi:[1,0,1] neg_lo:[0,1,0] neg_hi:[0,0,0]
v_pk_mul_f32 v[48:49], v[76:77], v[96:97] op_sel:[0,0] op_sel_hi:[0,1] neg_lo:[0,0] neg_hi:[0,0]
v_pk_fma_f32 v[76:77], v[76:77], v[96:97], v[48:49] op_sel:[1,1,0] op_sel_hi:[1,0,1] neg_lo:[0,1,0] neg_hi:[0,0,0]
v_pk_mul_f32 v[48:49], v[46:47], v[98:99] op_sel:[0,0] op_sel_hi:[0,1] neg_lo:[0,0] neg_hi:[0,0]
v_pk_fma_f32 v[46:47], v[46:47], v[98:99], v[48:49] op_sel:[1,1,0] op_sel_hi:[1,0,1] neg_lo:[0,1,0] neg_hi:[0,0,0]
v_pk_mul_f32 v[48:49], v[30:31], v[100:101] op_sel:[0,0] op_sel_hi:[0,1] neg_lo:[0,0] neg_hi:[0,0]
v_pk_fma_f32 v[30:31], v[30:31], v[100:101], v[48:49] op_sel:[1,1,0] op_sel_hi:[1,0,1] neg_lo:[0,1,0] neg_hi:[0,0,0]
v_pk_mul_f32 v[48:49], v[62:63], v[102:103] op_sel:[0,0] op_sel_hi:[0,1] neg_lo:[0,0] neg_hi:[0,0]
v_pk_fma_f32 v[62:63], v[62:63], v[102:103], v[48:49] op_sel:[1,1,0] op_sel_hi:[1,0,1] neg_lo:[0,1,0] neg_hi:[0,0,0]
v_pk_mul_f32 v[48:49], v[22:23], v[104:105] op_sel:[0,0] op_sel_hi:[0,1] neg_lo:[0,0] neg_hi:[0,0]
v_pk_fma_f32 v[22:23], v[22:23], v[104:105], v[48:49] op_sel:[1,1,0] op_sel_hi:[1,0,1] neg_lo:[0,1,0] neg_hi:[0,0,0]
v_pk_mul_f32 v[48:49], v[54:55], v[106:107] op_sel:[0,0] op_sel_hi:[0,1] neg_lo:[0,0] neg_hi:[0,0]
v_pk_fma_f32 v[54:55], v[54:55], v[106:107], v[48:49] op_sel:[1,1,0] op_sel_hi:[1,0,1] neg_lo:[0,1,0] neg_hi:[0,0,0]
v_pk_mul_f32 v[48:49], v[38:39], v[108:109] op_sel:[0,0] op_sel_hi:[0,1] neg_lo:[0,0] neg_hi:[0,0]
v_pk_fma_f32 v[38:39], v[38:39], v[108:109], v[48:49] op_sel:[1,1,0] op_sel_hi:[1,0,1] neg_lo:[0,1,0] neg_hi:[0,0,0]
v_pk_mul_f32 v[48:49], v[70:71], v[110:111] op_sel:[0,0] op_sel_hi:[0,1] neg_lo:[0,0] neg_hi:[0,0]
v_pk_fma_f32 v[70:71], v[70:71], v[110:111], v[48:49] op_sel:[1,1,0] op_sel_hi:[1,0,1] neg_lo:[0,1,0] neg_hi:[0,0,0]
v_pk_mul_f32 v[48:49], v[78:79], v[112:113] op_sel:[0,0] op_sel_hi:[0,1] neg_lo:[0,0] neg_hi:[0,0]
v_pk_fma_f32 v[78:79], v[78:79], v[112:113], v[48:49] op_sel:[1,1,0] op_sel_hi:[1,0,1] neg_lo:[0,1,0] neg_hi:[0,0,0]
v_pk_mul_f32 v[48:49], v[32:33], v[114:115] op_sel:[0,0] op_sel_hi:[0,1] neg_lo:[0,0] neg_hi:[0,0]
v_pk_fma_f32 v[32:33], v[32:33], v[114:115], v[48:49] op_sel:[1,1,0] op_sel_hi:[1,0,1] neg_lo:[0,1,0] neg_hi:[0,0,0]
v_pk_mul_f32 v[48:49], v[24:25], v[116:117] op_sel:[0,0] op_sel_hi:[0,1] neg_lo:[0,0] neg_hi:[0,0]
v_pk_fma_f32 v[24:25], v[24:25], v[116:117], v[48:49] op_sel:[1,1,0] op_sel_hi:[1,0,1] neg_lo:[0,1,0] neg_hi:[0,0,0]
v_pk_mul_f32 v[48:49], v[56:57], v[118:119] op_sel:[0,0] op_sel_hi:[0,1] neg_lo:[0,0] neg_hi:[0,0]
v_pk_fma_f32 v[56:57], v[56:57], v[118:119], v[48:49] op_sel:[1,1,0] op_sel_hi:[1,0,1] neg_lo:[0,1,0] neg_hi:[0,0,0]
v_pk_mul_f32 v[48:49], v[20:21], v[120:121] op_sel:[0,0] op_sel_hi:[0,1] neg_lo:[0,0] neg_hi:[0,0]
v_pk_fma_f32 v[20:21], v[20:21], v[120:121], v[48:49] op_sel:[1,1,0] op_sel_hi:[1,0,1] neg_lo:[0,1,0] neg_hi:[0,0,0]
v_pk_mul_f32 v[48:49], v[52:53], v[122:123] op_sel:[0,0] op_sel_hi:[0,1] neg_lo:[0,0] neg_hi:[0,0]
v_pk_fma_f32 v[52:53], v[52:53], v[122:123], v[48:49] op_sel:[1,1,0] op_sel_hi:[1,0,1] neg_lo:[0,1,0] neg_hi:[0,0,0]
v_pk_mul_f32 v[48:49], v[36:37], v[124:125] op_sel:[0,0] op_sel_hi:[0,1] neg_lo:[0,0] neg_hi:[0,0]
v_pk_fma_f32 v[36:37], v[36:37], v[124:125], v[48:49] op_sel:[1,1,0] op_sel_hi:[1,0,1] neg_lo:[0,1,0] neg_hi:[0,0,0]
v_pk_mul_f32 v[48:49], v[68:69], v[126:127] op_sel:[0,0] op_sel_hi:[0,1] neg_lo:[0,0] neg_hi:[0,0]
v_pk_fma_f32 v[68:69], v[68:69], v[126:127], v[48:49] op_sel:[1,1,0] op_sel_hi:[1,0,1] neg_lo:[0,1,0] neg_hi:[0,0,0]
v_pk_mul_f32 v[48:49], v[18:19], v[128:129] op_sel:[0,0] op_sel_hi:[0,1] neg_lo:[0,0] neg_hi:[0,0]
v_pk_fma_f32 v[18:19], v[18:19], v[128:129], v[48:49] op_sel:[1,1,0] op_sel_hi:[1,0,1] neg_lo:[0,1,0] neg_hi:[0,0,0]
v_pk_mul_f32 v[48:49], v[50:51], v[130:131] op_sel:[0,0] op_sel_hi:[0,1] neg_lo:[0,0] neg_hi:[0,0]
v_pk_fma_f32 v[50:51], v[50:51], v[130:131], v[48:49] op_sel:[1,1,0] op_sel_hi:[1,0,1] neg_lo:[0,1,0] neg_hi:[0,0,0]
v_pk_mul_f32 v[48:49], v[34:35], v[132:133] op_sel:[0,0] op_sel_hi:[0,1] neg_lo:[0,0] neg_hi:[0,0]
v_pk_fma_f32 v[34:35], v[34:35], v[132:133], v[48:49] op_sel:[1,1,0] op_sel_hi:[1,0,1] neg_lo:[0,1,0] neg_hi:[0,0,0]
v_pk_mul_f32 v[48:49], v[66:67], v[134:135] op_sel:[0,0] op_sel_hi:[0,1] neg_lo:[0,0] neg_hi:[0,0]
v_pk_fma_f32 v[66:67], v[66:67], v[134:135], v[48:49] op_sel:[1,1,0] op_sel_hi:[1,0,1] neg_lo:[0,1,0] neg_hi:[0,0,0]
v_pk_mul_f32 v[48:49], v[26:27], v[136:137] op_sel:[0,0] op_sel_hi:[0,1] neg_lo:[0,0] neg_hi:[0,0]
v_pk_fma_f32 v[26:27], v[26:27], v[136:137], v[48:49] op_sel:[1,1,0] op_sel_hi:[1,0,1] neg_lo:[0,1,0] neg_hi:[0,0,0]
v_pk_mul_f32 v[48:49], v[58:59], v[138:139] op_sel:[0,0] op_sel_hi:[0,1] neg_lo:[0,0] neg_hi:[0,0]
v_pk_fma_f32 v[58:59], v[58:59], v[138:139], v[48:49] op_sel:[1,1,0] op_sel_hi:[1,0,1] neg_lo:[0,1,0] neg_hi:[0,0,0]
v_pk_mul_f32 v[48:49], v[42:43], v[140:141] op_sel:[0,0] op_sel_hi:[0,1] neg_lo:[0,0] neg_hi:[0,0]
v_pk_fma_f32 v[42:43], v[42:43], v[140:141], v[48:49] op_sel:[1,1,0] op_sel_hi:[1,0,1] neg_lo:[0,1,0] neg_hi:[0,0,0]
v_pk_mul_f32 v[48:49], v[74:75], v[142:143] op_sel:[0,0] op_sel_hi:[0,1] neg_lo:[0,0] neg_hi:[0,0]
v_pk_fma_f32 v[74:75], v[74:75], v[142:143], v[48:49] op_sel:[1,1,0] op_sel_hi:[1,0,1] neg_lo:[0,1,0] neg_hi:[0,0,0]
ds_write_b64 v4, v[16:17] offset:0
ds_write_b64 v4, v[14:15] offset:264
ds_write_b64 v4, v[64:65] offset:528
ds_write_b64 v4, v[40:41] offset:792
ds_write_b64 v4, v[72:73] offset:1056
ds_write_b64 v4, v[44:45] offset:1320
ds_write_b64 v4, v[28:29] offset:1584
ds_write_b64 v4, v[60:61] offset:1848
ds_write_b64 v4, v[76:77] offset:2112
ds_write_b64 v4, v[46:47] offset:2376
ds_write_b64 v4, v[30:31] offset:2640
ds_write_b64 v4, v[62:63] offset:2904
ds_write_b64 v4, v[22:23] offset:3168
ds_write_b64 v4, v[54:55] offset:3432
ds_write_b64 v4, v[38:39] offset:3696
ds_write_b64 v4, v[70:71] offset:3960
ds_write_b64 v4, v[78:79] offset:4224
ds_write_b64 v4, v[32:33] offset:4488
ds_write_b64 v4, v[24:25] offset:4752
ds_write_b64 v4, v[56:57] offset:5016
ds_write_b64 v4, v[20:21] offset:5280
ds_write_b64 v4, v[52:53] offset:5544
ds_write_b64 v4, v[36:37] offset:5808
ds_write_b64 v4, v[68:69] offset:6072
ds_write_b64 v4, v[18:19] offset:6336
ds_write_b64 v4, v[50:51] offset:6600
ds_write_b64 v4, v[34:35] offset:6864
ds_write_b64 v4, v[66:67] offset:7128
ds_write_b64 v4, v[26:27] offset:7392
ds_write_b64 v4, v[58:59] offset:7656
ds_write_b64 v4, v[42:43] offset:7920
ds_write_b64 v4, v[74:75] offset:8184
s_waitcnt lgkmcnt(0)
ds_read_b64 v[16:17], v5 offset:0
ds_read_b64 v[48:49], v5 offset:128
ds_read_b64 v[18:19], v5 offset:8
ds_read_b64 v[50:51], v5 offset:136
ds_read_b64 v[20:21], v5 offset:16
ds_read_b64 v[52:53], v5 offset:144
ds_read_b64 v[22:23], v5 offset:24
ds_read_b64 v[54:55], v5 offset:152
ds_read_b64 v[24:25], v5 offset:32
ds_read_b64 v[56:57], v5 offset:160
ds_read_b64 v[26:27], v5 offset:40
ds_read_b64 v[58:59], v5 offset:168
ds_read_b64 v[28:29], v5 offset:48
ds_read_b64 v[60:61], v5 offset:176
ds_read_b64 v[30:31], v5 offset:56
ds_read_b64 v[62:63], v5 offset:184
ds_read_b64 v[32:33], v5 offset:64
ds_read_b64 v[64:65], v5 offset:192
ds_read_b64 v[34:35], v5 offset:72
ds_read_b64 v[66:67], v5 offset:200
ds_read_b64 v[36:37], v5 offset:80
ds_read_b64 v[68:69], v5 offset:208
ds_read_b64 v[38:39], v5 offset:88
ds_read_b64 v[70:71], v5 offset:216
ds_read_b64 v[40:41], v5 offset:96
ds_read_b64 v[72:73], v5 offset:224
ds_read_b64 v[42:43], v5 offset:104
ds_read_b64 v[74:75], v5 offset:232
ds_read_b64 v[44:45], v5 offset:112
ds_read_b64 v[76:77], v5 offset:240
ds_read_b64 v[46:47], v5 offset:120
ds_read_b64 v[78:79], v5 offset:248
s_waitcnt lgkmcnt(0)
v_pk_add_f32 v[14:15], v[16:17], v[48:49] neg_lo:[0,1] neg_hi:[0,1]
v_pk_add_f32 v[16:17], v[16:17], v[48:49]
v_pk_add_f32 v[48:49], v[18:19], v[50:51] neg_lo:[0,1] neg_hi:[0,1]
v_pk_add_f32 v[18:19], v[18:19], v[50:51]
v_pk_mul_f32 v[50:51], v[48:49], s[50:51] op_sel:[0,0] op_sel_hi:[0,1] neg_lo:[0,0] neg_hi:[0,0]
v_pk_fma_f32 v[50:51], v[48:49], s[50:51], v[50:51] op_sel:[1,1,0] op_sel_hi:[1,0,1] neg_lo:[0,1,0] neg_hi:[0,0,0]
v_pk_add_f32 v[48:49], v[20:21], v[52:53] neg_lo:[0,1] neg_hi:[0,1]
v_pk_add_f32 v[20:21], v[20:21], v[52:53]
v_pk_mul_f32 v[52:53], v[48:49], s[54:55] op_sel:[0,0] op_sel_hi:[0,1] neg_lo:[0,0] neg_hi:[0,0]
v_pk_fma_f32 v[52:53], v[48:49], s[54:55], v[52:53] op_sel:[1,1,0] op_sel_hi:[1,0,1] neg_lo:[0,1,0] neg_hi:[0,0,0]
v_pk_add_f32 v[48:49], v[22:23], v[54:55] neg_lo:[0,1] neg_hi:[0,1]
v_pk_add_f32 v[22:23], v[22:23], v[54:55]
v_pk_mul_f32 v[54:55], v[48:49], s[58:59] op_sel:[0,0] op_sel_hi:[0,1] neg_lo:[0,0] neg_hi:[0,0]
v_pk_fma_f32 v[54:55], v[48:49], s[58:59], v[54:55] op_sel:[1,1,0] op_sel_hi:[1,0,1] neg_lo:[0,1,0] neg_hi:[0,0,0]
v_pk_add_f32 v[48:49], v[24:25], v[56:57] neg_lo:[0,1] neg_hi:[0,1]
v_pk_add_f32 v[24:25], v[24:25], v[56:57]
v_pk_mul_f32 v[56:57], v[48:49], s[62:63] op_sel:[0,0] op_sel_hi:[0,1] neg_lo:[0,0] neg_hi:[0,0]
v_pk_fma_f32 v[56:57], v[48:49], s[62:63], v[56:57] op_sel:[1,1,0] op_sel_hi:[1,0,1] neg_lo:[0,1,0] neg_hi:[0,0,0]
v_pk_add_f32 v[48:49], v[26:27], v[58:59] neg_lo:[0,1] neg_hi:[0,1]
v_pk_add_f32 v[26:27], v[26:27], v[58:59]
v_pk_mul_f32 v[58:59], v[48:49], s[58:59] op_sel:[0,1] op_sel_hi:[0,0] neg_lo:[0,0] neg_hi:[0,0]
v_pk_fma_f32 v[58:59], v[48:49], s[58:59], v[58:59] op_sel:[1,0,0] op_sel_hi:[1,1,1] neg_lo:[0,1,0] neg_hi:[0,0,0]
v_pk_add_f32 v[48:49], v[28:29], v[60:61] neg_lo:[0,1] neg_hi:[0,1]
v_pk_add_f32 v[28:29], v[28:29], v[60:61]
v_pk_mul_f32 v[60:61], v[48:49], s[54:55] op_sel:[0,1] op_sel_hi:[0,0] neg_lo:[0,0] neg_hi:[0,0]
v_pk_fma_f32 v[60:61], v[48:49], s[54:55], v[60:61] op_sel:[1,0,0] op_sel_hi:[1,1,1] neg_lo:[0,1,0] neg_hi:[0,0,0]
v_pk_add_f32 v[48:49], v[30:31], v[62:63] neg_lo:[0,1] neg_hi:[0,1]
v_pk_add_f32 v[30:31], v[30:31], v[62:63]
v_pk_mul_f32 v[62:63], v[48:49], s[50:51] op_sel:[0,1] op_sel_hi:[0,0] neg_lo:[0,0] neg_hi:[0,0]
v_pk_fma_f32 v[62:63], v[48:49], s[50:51], v[62:63] op_sel:[1,0,0] op_sel_hi:[1,1,1] neg_lo:[0,1,0] neg_hi:[0,0,0]
v_pk_add_f32 v[48:49], v[32:33], v[64:65] op_sel:[1,1] op_sel_hi:[0,0] neg_lo:[1,0] neg_hi:[0,1]
v_pk_add_f32 v[32:33], v[32:33], v[64:65]
v_pk_add_f32 v[64:65], v[34:35], v[66:67] neg_lo:[0,1] neg_hi:[0,1]
v_pk_add_f32 v[34:35], v[34:35], v[66:67]
v_pk_mul_f32 v[66:67], v[64:65], s[50:51] op_sel:[0,1] op_sel_hi:[0,0] neg_lo:[0,1] neg_hi:[0,0]
v_pk_fma_f32 v[66:67], v[64:65], s[50:51], v[66:67] op_sel:[1,0,0] op_sel_hi:[1,1,1] neg_lo:[0,1,0] neg_hi:[0,1,0]
v_pk_add_f32 v[64:65], v[36:37], v[68:69] neg_lo:[0,1] neg_hi:[0,1]
v_pk_add_f32 v[36:37], v[36:37], v[68:69]
v_pk_mul_f32 v[68:69], v[64:65], s[54:55] op_sel:[0,1] op_sel_hi:[0,0] neg_lo:[0,1] neg_hi:[0,0]
v_pk_fma_f32 v[68:69], v[64:65], s[54:55], v[68:69] op_sel:[1,0,0] op_sel_hi:[1,1,1] neg_lo:[0,1,0] neg_hi:[0,1,0]
v_pk_add_f32 v[64:65], v[38:39], v[70:71] neg_lo:[0,1] neg_hi:[0,1]
v_pk_add_f32 v[38:39], v[38:39], v[70:71]
v_pk_mul_f32 v[70:71], v[64:65], s[58:59] op_sel:[0,1] op_sel_hi:[0,0] neg_lo:[0,1] neg_hi:[0,0]
v_pk_fma_f32 v[70:71], v[64:65], s[58:59], v[70:71] op_sel:[1,0,0] op_sel_hi:[1,1,1] neg_lo:[0,1,0] neg_hi:[0,1,0]
v_pk_add_f32 v[64:65], v[40:41], v[72:73] neg_lo:[0,1] neg_hi:[0,1]
v_pk_add_f32 v[40:41], v[40:41], v[72:73]
v_pk_mul_f32 v[72:73], v[64:65], s[62:63] op_sel:[0,0] op_sel_hi:[0,1] neg_lo:[0,1] neg_hi:[0,0]
v_pk_fma_f32 v[72:73], v[64:65], s[62:63], v[72:73] op_sel:[1,1,0] op_sel_hi:[1,0,1] neg_lo:[0,1,0] neg_hi:[0,1,0]
v_pk_add_f32 v[64:65], v[42:43], v[74:75] neg_lo:[0,1] neg_hi:[0,1]
v_pk_add_f32 v[42:43], v[42:43], v[74:75]
v_pk_mul_f32 v[74:75], v[64:65], s[58:59] op_sel:[0,0] op_sel_hi:[0,1] neg_lo:[0,1] neg_hi:[0,0]
v_pk_fma_f32 v[74:75], v[64:65], s[58:59], v[74:75] op_sel:[1,1,0] op_sel_hi:[1,0,1] neg_lo:[0,1,0] neg_hi:[0,1,0]
v_pk_add_f32 v[64:65], v[44:45], v[76:77] neg_lo:[0,1] neg_hi:[0,1]
v_pk_add_f32 v[44:45], v[44:45], v[76:77]
v_pk_mul_f32 v[76:77], v[64:65], s[54:55] op_sel:[0,0] op_sel_hi:[0,1] neg_lo:[0,1] neg_hi:[0,0]
v_pk_fma_f32 v[76:77], v[64:65], s[54:55], v[76:77] op_sel:[1,1,0] op_sel_hi:[1,0,1] neg_lo:[0,1,0] neg_hi:[0,1,0]
v_pk_add_f32 v[64:65], v[46:47], v[78:79] neg_lo:[0,1] neg_hi:[0,1]
v_pk_add_f32 v[46:47], v[46:47], v[78:79]
v_pk_mul_f32 v[78:79], v[64:65], s[50:51] op_sel:[0,0] op_sel_hi:[0,1] neg_lo:[0,1] neg_hi:[0,0]
v_pk_fma_f32 v[78:79], v[64:65], s[50:51], v[78:79] op_sel:[1,1,0] op_sel_hi:[1,0,1] neg_lo:[0,1,0] neg_hi:[0,1,0]
v_pk_add_f32 v[64:65], v[16:17], v[32:33] neg_lo:[0,1] neg_hi:[0,1]
v_pk_add_f32 v[16:17], v[16:17], v[32:33]
v_pk_add_f32 v[32:33], v[18:19], v[34:35] neg_lo:[0,1] neg_hi:[0,1]
v_pk_add_f32 v[18:19], v[18:19], v[34:35]
v_pk_mul_f32 v[34:35], v[32:33], s[54:55] op_sel:[0,0] op_sel_hi:[0,1] neg_lo:[0,0] neg_hi:[0,0]
v_pk_fma_f32 v[34:35], v[32:33], s[54:55], v[34:35] op_sel:[1,1,0] op_sel_hi:[1,0,1] neg_lo:[0,1,0] neg_hi:[0,0,0]
v_pk_add_f32 v[32:33], v[20:21], v[36:37] neg_lo:[0,1] neg_hi:[0,1]
v_pk_add_f32 v[20:21], v[20:21], v[36:37]
v_pk_mul_f32 v[36:37], v[32:33], s[62:63] op_sel:[0,0] op_sel_hi:[0,1] neg_lo:[0,0] neg_hi:[0,0]
v_pk_fma_f32 v[36:37], v[32:33], s[62:63], v[36:37] op_sel:[1,1,0] op_sel_hi:[1,0,1] neg_lo:[0,1,0] neg_hi:[0,0,0]
v_pk_add_f32 v[32:33], v[22:23], v[38:39] neg_lo:[0,1] neg_hi:[0,1]
v_pk_add_f32 v[22:23], v[22:23], v[38:39]
v_pk_mul_f32 v[38:39], v[32:33], s[54:55] op_sel:[0,1] op_sel_hi:[0,0] neg_lo:[0,0] neg_hi:[0,0]
v_pk_fma_f32 v[38:39], v[32:33], s[54:55], v[38:39] op_sel:[1,0,0] op_sel_hi:[1,1,1] neg_lo:[0,1,0] neg_hi:[0,0,0]
v_pk_add_f32 v[32:33], v[24:25], v[40:41] op_sel:[1,1] op_sel_hi:[0,0] neg_lo:[1,0] neg_hi:[0,1]
v_pk_add_f32 v[24:25], v[24:25], v[40:41]
v_pk_add_f32 v[40:41], v[26:27], v[42:43] neg_lo:[0,1] neg_hi:[0,1]
v_pk_add_f32 v[26:27], v[26:27], v[42:43]
v_pk_mul_f32 v[42:43], v[40:41], s[54:55] op_sel:[0,1] op_sel_hi:[0,0] neg_lo:[0,1] neg_hi:[0,0]
v_pk_fma_f32 v[42:43], v[40:41], s[54:55], v[42:43] op_sel:[1,0,0] op_sel_hi:[1,1,1] neg_lo:[0,1,0] neg_hi:[0,1,0]
v_pk_add_f32 v[40:41], v[28:29], v[44:45] neg_lo:[0,1] neg_hi:[0,1]
v_pk_add_f32 v[28:29], v[28:29], v[44:45]
v_pk_mul_f32 v[44:45], v[40:41], s[62:63] op_sel:[0,0] op_sel_hi:[0,1] neg_lo:[0,1] neg_hi:[0,0]
v_pk_fma_f32 v[44:45], v[40:41], s[62:63], v[44:45] op_sel:[1,1,0] op_sel_hi:[1,0,1] neg_lo:[0,1,0] neg_hi:[0,1,0]
v_pk_add_f32 v[40:41], v[30:31], v[46:47] neg_lo:[0,1] neg_hi:[0,1]
v_pk_add_f32 v[30:31], v[30:31], v[46:47]
v_pk_mul_f32 v[46:47], v[40:41], s[54:55] op_sel:[0,0] op_sel_hi:[0,1] neg_lo:[0,1] neg_hi:[0,0]
v_pk_fma_f32 v[46:47], v[40:41], s[54:55], v[46:47] op_sel:[1,1,0] op_sel_hi:[1,0,1] neg_lo:[0,1,0] neg_hi:[0,1,0]
v_pk_add_f32 v[40:41], v[14:15], v[48:49] neg_lo:[0,1] neg_hi:[0,1]
v_pk_add_f32 v[14:15], v[14:15], v[48:49]
v_pk_add_f32 v[48:49], v[50:51], v[66:67] neg_lo:[0,1] neg_hi:[0,1]
v_pk_add_f32 v[50:51], v[50:51], v[66:67]
v_pk_mul_f32 v[66:67], v[48:49], s[54:55] op_sel:[0,0] op_sel_hi:[0,1] neg_lo:[0,0] neg_hi:[0,0]
v_pk_fma_f32 v[66:67], v[48:49], s[54:55], v[66:67] op_sel:[1,1,0] op_sel_hi:[1,0,1] neg_lo:[0,1,0] neg_hi:[0,0,0]
v_pk_add_f32 v[48:49], v[52:53], v[68:69] neg_lo:[0,1] neg_hi:[0,1]
v_pk_add_f32 v[52:53], v[52:53], v[68:69]
v_pk_mul_f32 v[68:69], v[48:49], s[62:63] op_sel:[0,0] op_sel_hi:[0,1] neg_lo:[0,0] neg_hi:[0,0]
v_pk_fma_f32 v[68:69], v[48:49], s[62:63], v[68:69] op_sel:[1,1,0] op_sel_hi:[1,0,1] neg_lo:[0,1,0] neg_hi:[0,0,0]
v_pk_add_f32 v[48:49], v[54:55], v[70:71] neg_lo:[0,1] neg_hi:[0,1]
v_pk_add_f32 v[54:55], v[54:55], v[70:71]
v_pk_mul_f32 v[70:71], v[48:49], s[54:55] op_sel:[0,1] op_sel_hi:[0,0] neg_lo:[0,0] neg_hi:[0,0]
v_pk_fma_f32 v[70:71], v[48:49], s[54:55], v[70:71] op_sel:[1,0,0] op_sel_hi:[1,1,1] neg_lo:[0,1,0] neg_hi:[0,0,0]
v_pk_add_f32 v[48:49], v[56:57], v[72:73] op_sel:[1,1] op_sel_hi:[0,0] neg_lo:[1,0] neg_hi:[0,1]
v_pk_add_f32 v[56:57], v[56:57], v[72:73]
v_pk_add_f32 v[72:73], v[58:59], v[74:75] neg_lo:[0,1] neg_hi:[0,1]
v_pk_add_f32 v[58:59], v[58:59], v[74:75]
v_pk_mul_f32 v[74:75], v[72:73], s[54:55] op_sel:[0,1] op_sel_hi:[0,0] neg_lo:[0,1] neg_hi:[0,0]
v_pk_fma_f32 v[74:75], v[72:73], s[54:55], v[74:75] op_sel:[1,0,0] op_sel_hi:[1,1,1] neg_lo:[0,1,0] neg_hi:[0,1,0]
v_pk_add_f32 v[72:73], v[60:61], v[76:77] neg_lo:[0,1] neg_hi:[0,1]
v_pk_add_f32 v[60:61], v[60:61], v[76:77]
v_pk_mul_f32 v[76:77], v[72:73], s[62:63] op_sel:[0,0] op_sel_hi:[0,1] neg_lo:[0,1] neg_hi:[0,0]
v_pk_fma_f32 v[76:77], v[72:73], s[62:63], v[76:77] op_sel:[1,1,0] op_sel_hi:[1,0,1] neg_lo:[0,1,0] neg_hi:[0,1,0]
v_pk_add_f32 v[72:73], v[62:63], v[78:79] neg_lo:[0,1] neg_hi:[0,1]
v_pk_add_f32 v[62:63], v[62:63], v[78:79]
v_pk_mul_f32 v[78:79], v[72:73], s[54:55] op_sel:[0,0] op_sel_hi:[0,1] neg_lo:[0,1] neg_hi:[0,0]
v_pk_fma_f32 v[78:79], v[72:73], s[54:55], v[78:79] op_sel:[1,1,0] op_sel_hi:[1,0,1] neg_lo:[0,1,0] neg_hi:[0,1,0]
v_pk_add_f32 v[72:73], v[16:17], v[24:25] neg_lo:[0,1] neg_hi:[0,1]
v_pk_add_f32 v[16:17], v[16:17], v[24:25]
v_pk_add_f32 v[24:25], v[18:19], v[26:27] neg_lo:[0,1] neg_hi:[0,1]
v_pk_add_f32 v[18:19], v[18:19], v[26:27]
v_pk_mul_f32 v[26:27], v[24:25], s[62:63] op_sel:[0,0] op_sel_hi:[0,1] neg_lo:[0,0] neg_hi:[0,0]
v_pk_fma_f32 v[26:27], v[24:25], s[62:63], v[26:27] op_sel:[1,1,0] op_sel_hi:[1,0,1] neg_lo:[0,1,0] neg_hi:[0,0,0]
v_pk_add_f32 v[24:25], v[20:21], v[28:29] op_sel:[1,1] op_sel_hi:[0,0] neg_lo:[1,0] neg_hi:[0,1]
v_pk_add_f32 v[20:21], v[20:21], v[28:29]
v_pk_add_f32 v[28:29], v[22:23], v[30:31] neg_lo:[0,1] neg_hi:[0,1]
v_pk_add_f32 v[22:23], v[22:23], v[30:31]
v_pk_mul_f32 v[30:31], v[28:29], s[62:63] op_sel:[0,0] op_sel_hi:[0,1] neg_lo:[0,1] neg_hi:[0,0]
v_pk_fma_f32 v[30:31], v[28:29], s[62:63], v[30:31] op_sel:[1,1,0] op_sel_hi:[1,0,1] neg_lo:[0,1,0] neg_hi:[0,1,0]
v_pk_add_f32 v[28:29], v[64:65], v[32:33] neg_lo:[0,1] neg_hi:[0,1]
v_pk_add_f32 v[64:65], v[64:65], v[32:33]
v_pk_add_f32 v[32:33], v[34:35], v[42:43] neg_lo:[0,1] neg_hi:[0,1]
v_pk_add_f32 v[34:35], v[34:35], v[42:43]
v_pk_mul_f32 v[42:43], v[32:33], s[62:63] op_sel:[0,0] op_sel_hi:[0,1] neg_lo:[0,0] neg_hi:[0,0]
v_pk_fma_f32 v[42:43], v[32:33], s[62:63], v[42:43] op_sel:[1,1,0] op_sel_hi:[1,0,1] neg_lo:[0,1,0] neg_hi:[0,0,0]
v_pk_add_f32 v[32:33], v[36:37], v[44:45] op_sel:[1,1] op_sel_hi:[0,0] neg_lo:[1,0] neg_hi:[0,1]
v_pk_add_f32 v[36:37], v[36:37], v[44:45]
v_pk_add_f32 v[44:45], v[38:39], v[46:47] neg_lo:[0,1] neg_hi:[0,1]
v_pk_add_f32 v[38:39], v[38:39], v[46:47]
v_pk_mul_f32 v[46:47], v[44:45], s[62:63] op_sel:[0,0] op_sel_hi:[0,1] neg_lo:[0,1] neg_hi:[0,0]
v_pk_fma_f32 v[46:47], v[44:45], s[62:63], v[46:47] op_sel:[1,1,0] op_sel_hi:[1,0,1] neg_lo:[0,1,0] neg_hi:[0,1,0]
v_pk_add_f32 v[44:45], v[14:15], v[56:57] neg_lo:[0,1] neg_hi:[0,1]
v_pk_add_f32 v[14:15], v[14:15], v[56:57]
v_pk_add_f32 v[56:57], v[50:51], v[58:59] neg_lo:[0,1] neg_hi:[0,1]
v_pk_add_f32 v[50:51], v[50:51], v[58:59]
v_pk_mul_f32 v[58:59], v[56:57], s[62:63] op_sel:[0,0] op_sel_hi:[0,1] neg_lo:[0,0] neg_hi:[0,0]
v_pk_fma_f32 v[58:59], v[56:57], s[62:63], v[58:59] op_sel:[1,1,0] op_sel_hi:[1,0,1] neg_lo:[0,1,0] neg_hi:[0,0,0]
v_pk_add_f32 v[56:57], v[52:53], v[60:61] op_sel:[1,1] op_sel_hi:[0,0] neg_lo:[1,0] neg_hi:[0,1]
v_pk_add_f32 v[52:53], v[52:53], v[60:61]
v_pk_add_f32 v[60:61], v[54:55], v[62:63] neg_lo:[0,1] neg_hi:[0,1]
v_pk_add_f32 v[54:55], v[54:55], v[62:63]
v_pk_mul_f32 v[62:63], v[60:61], s[62:63] op_sel:[0,0] op_sel_hi:[0,1] neg_lo:[0,1] neg_hi:[0,0]
v_pk_fma_f32 v[62:63], v[60:61], s[62:63], v[62:63] op_sel:[1,1,0] op_sel_hi:[1,0,1] neg_lo:[0,1,0] neg_hi:[0,1,0]
v_pk_add_f32 v[60:61], v[40:41], v[48:49] neg_lo:[0,1] neg_hi:[0,1]
v_pk_add_f32 v[40:41], v[40:41], v[48:49]
v_pk_add_f32 v[48:49], v[66:67], v[74:75] neg_lo:[0,1] neg_hi:[0,1]
v_pk_add_f32 v[66:67], v[66:67], v[74:75]
v_pk_mul_f32 v[74:75], v[48:49], s[62:63] op_sel:[0,0] op_sel_hi:[0,1] neg_lo:[0,0] neg_hi:[0,0]
v_pk_fma_f32 v[74:75], v[48:49], s[62:63], v[74:75] op_sel:[1,1,0] op_sel_hi:[1,0,1] neg_lo:[0,1,0] neg_hi:[0,0,0]
v_pk_add_f32 v[48:49], v[68:69], v[76:77] op_sel:[1,1] op_sel_hi:[0,0] neg_lo:[1,0] neg_hi:[0,1]
v_pk_add_f32 v[68:69], v[68:69], v[76:77]
v_pk_add_f32 v[76:77], v[70:71], v[78:79] neg_lo:[0,1] neg_hi:[0,1]
v_pk_add_f32 v[70:71], v[70:71], v[78:79]
v_pk_mul_f32 v[78:79], v[76:77], s[62:63] op_sel:[0,0] op_sel_hi:[0,1] neg_lo:[0,1] neg_hi:[0,0]
v_pk_fma_f32 v[78:79], v[76:77], s[62:63], v[78:79] op_sel:[1,1,0] op_sel_hi:[1,0,1] neg_lo:[0,1,0] neg_hi:[0,1,0]
v_pk_add_f32 v[76:77], v[16:17], v[20:21] neg_lo:[0,1] neg_hi:[0,1]
v_pk_add_f32 v[16:17], v[16:17], v[20:21]
v_pk_add_f32 v[20:21], v[18:19], v[22:23] op_sel:[1,1] op_sel_hi:[0,0] neg_lo:[1,0] neg_hi:[0,1]
v_pk_add_f32 v[18:19], v[18:19], v[22:23]
v_pk_add_f32 v[22:23], v[72:73], v[24:25] neg_lo:[0,1] neg_hi:[0,1]
v_pk_add_f32 v[72:73], v[72:73], v[24:25]
v_pk_add_f32 v[24:25], v[26:27], v[30:31] op_sel:[1,1] op_sel_hi:[0,0] neg_lo:[1,0] neg_hi:[0,1]
v_pk_add_f32 v[26:27], v[26:27], v[30:31]
v_pk_add_f32 v[30:31], v[64:65], v[36:37] neg_lo:[0,1] neg_hi:[0,1]
v_pk_add_f32 v[64:65], v[64:65], v[36:37]
v_pk_add_f32 v[36:37], v[34:35], v[38:39] op_sel:[1,1] op_sel_hi:[0,0] neg_lo:[1,0] neg_hi:[0,1]
v_pk_add_f32 v[34:35], v[34:35], v[38:39]
v_pk_add_f32 v[38:39], v[28:29], v[32:33] neg_lo:[0,1] neg_hi:[0,1]
v_pk_add_f32 v[28:29], v[28:29], v[32:33]
v_pk_add_f32 v[32:33], v[42:43], v[46:47] op_sel:[1,1] op_sel_hi:[0,0] neg_lo:[1,0] neg_hi:[0,1]
v_pk_add_f32 v[42:43], v[42:43], v[46:47]
v_pk_add_f32 v[46:47], v[14:15], v[52:53] neg_lo:[0,1] neg_hi:[0,1]
v_pk_add_f32 v[14:15], v[14:15], v[52:53]
v_pk_add_f32 v[52:53], v[50:51], v[54:55] op_sel:[1,1] op_sel_hi:[0,0] neg_lo:[1,0] neg_hi:[0,1]
v_pk_add_f32 v[50:51], v[50:51], v[54:55]
v_pk_add_f32 v[54:55], v[44:45], v[56:57] neg_lo:[0,1] neg_hi:[0,1]
v_pk_add_f32 v[44:45], v[44:45], v[56:57]
v_pk_add_f32 v[56:57], v[58:59], v[62:63] op_sel:[1,1] op_sel_hi:[0,0] neg_lo:[1,0] neg_hi:[0,1]
v_pk_add_f32 v[58:59], v[58:59], v[62:63]
v_pk_add_f32 v[62:63], v[40:41], v[68:69] neg_lo:[0,1] neg_hi:[0,1]
v_pk_add_f32 v[40:41], v[40:41], v[68:69]
v_pk_add_f32 v[68:69], v[66:67], v[70:71] op_sel:[1,1] op_sel_hi:[0,0] neg_lo:[1,0] neg_hi:[0,1]
v_pk_add_f32 v[66:67], v[66:67], v[70:71]
v_pk_add_f32 v[70:71], v[60:61], v[48:49] neg_lo:[0,1] neg_hi:[0,1]
v_pk_add_f32 v[60:61], v[60:61], v[48:49]
v_pk_add_f32 v[48:49], v[74:75], v[78:79] op_sel:[1,1] op_sel_hi:[0,0] neg_lo:[1,0] neg_hi:[0,1]
v_pk_add_f32 v[74:75], v[74:75], v[78:79]
v_pk_add_f32 v[78:79], v[16:17], v[18:19] neg_lo:[0,1] neg_hi:[0,1]
v_pk_add_f32 v[16:17], v[16:17], v[18:19]
v_pk_add_f32 v[18:19], v[76:77], v[20:21] neg_lo:[0,1] neg_hi:[0,1]
v_pk_add_f32 v[76:77], v[76:77], v[20:21]
v_pk_add_f32 v[20:21], v[72:73], v[26:27] neg_lo:[0,1] neg_hi:[0,1]
v_pk_add_f32 v[72:73], v[72:73], v[26:27]
v_pk_add_f32 v[26:27], v[22:23], v[24:25] neg_lo:[0,1] neg_hi:[0,1]
v_pk_add_f32 v[22:23], v[22:23], v[24:25]
v_pk_add_f32 v[24:25], v[64:65], v[34:35] neg_lo:[0,1] neg_hi:[0,1]
v_pk_add_f32 v[64:65], v[64:65], v[34:35]
v_pk_add_f32 v[34:35], v[30:31], v[36:37] neg_lo:[0,1] neg_hi:[0,1]
v_pk_add_f32 v[30:31], v[30:31], v[36:37]
v_pk_add_f32 v[36:37], v[28:29], v[42:43] neg_lo:[0,1] neg_hi:[0,1]
v_pk_add_f32 v[28:29], v[28:29], v[42:43]
v_pk_add_f32 v[42:43], v[38:39], v[32:33] neg_lo:[0,1] neg_hi:[0,1]
v_pk_add_f32 v[38:39], v[38:39], v[32:33]
v_pk_add_f32 v[32:33], v[14:15], v[50:51] neg_lo:[0,1] neg_hi:[0,1]
v_pk_add_f32 v[14:15], v[14:15], v[50:51]
v_pk_add_f32 v[50:51], v[46:47], v[52:53] neg_lo:[0,1] neg_hi:[0,1]
v_pk_add_f32 v[46:47], v[46:47], v[52:53]
v_pk_add_f32 v[52:53], v[44:45], v[58:59] neg_lo:[0,1] neg_hi:[0,1]
v_pk_add_f32 v[44:45], v[44:45], v[58:59]
v_pk_add_f32 v[58:59], v[54:55], v[56:57] neg_lo:[0,1] neg_hi:[0,1]
v_pk_add_f32 v[54:55], v[54:55], v[56:57]
v_pk_add_f32 v[56:57], v[40:41], v[66:67] neg_lo:[0,1] neg_hi:[0,1]
v_pk_add_f32 v[40:41], v[40:41], v[66:67]
v_pk_add_f32 v[66:67], v[62:63], v[68:69] neg_lo:[0,1] neg_hi:[0,1]
v_pk_add_f32 v[62:63], v[62:63], v[68:69]
v_pk_add_f32 v[68:69], v[60:61], v[74:75] neg_lo:[0,1] neg_hi:[0,1]
v_pk_add_f32 v[60:61], v[60:61], v[74:75]
v_pk_add_f32 v[74:75], v[70:71], v[48:49] neg_lo:[0,1] neg_hi:[0,1]
v_pk_add_f32 v[70:71], v[70:71], v[48:49]
ds_write2st64_b32 v12, v16, v17 offset0:0 offset1:16
ds_write_b32 v12, v14 offset:128
ds_write_b32 v12, v15 offset:4224
ds_write_b32 v12, v64 offset:256
ds_write_b32 v12, v65 offset:4352
ds_write_b32 v12, v40 offset:384
ds_write_b32 v12, v41 offset:4480
ds_write_b32 v12, v72 offset:512
ds_write_b32 v12, v73 offset:4608
ds_write_b32 v12, v44 offset:640
ds_write_b32 v12, v45 offset:4736
ds_write_b32 v12, v28 offset:768
ds_write_b32 v12, v29 offset:4864
ds_write_b32 v12, v60 offset:896
ds_write_b32 v12, v61 offset:4992
ds_write_b32 v12, v76 offset:1024
ds_write_b32 v12, v77 offset:5120
ds_write_b32 v12, v46 offset:1152
ds_write_b32 v12, v47 offset:5248
ds_write_b32 v12, v30 offset:1280
ds_write_b32 v12, v31 offset:5376
ds_write_b32 v12, v62 offset:1408
ds_write_b32 v12, v63 offset:5504
ds_write_b32 v12, v22 offset:1536
ds_write_b32 v12, v23 offset:5632
ds_write_b32 v12, v54 offset:1664
ds_write_b32 v12, v55 offset:5760
ds_write_b32 v12, v38 offset:1792
ds_write_b32 v12, v39 offset:5888
ds_write_b32 v12, v70 offset:1920
ds_write_b32 v12, v71 offset:6016
ds_write_b32 v12, v78 offset:2048
ds_write_b32 v12, v79 offset:6144
ds_write_b32 v12, v32 offset:2176
ds_write_b32 v12, v33 offset:6272
ds_write_b32 v12, v24 offset:2304
ds_write_b32 v12, v25 offset:6400
ds_write_b32 v12, v56 offset:2432
ds_write_b32 v12, v57 offset:6528
ds_write_b32 v12, v20 offset:2560
ds_write_b32 v12, v21 offset:6656
ds_write_b32 v12, v52 offset:2688
ds_write_b32 v12, v53 offset:6784
ds_write_b32 v12, v36 offset:2816
ds_write_b32 v12, v37 offset:6912
ds_write_b32 v12, v68 offset:2944
ds_write_b32 v12, v69 offset:7040
ds_write_b32 v12, v18 offset:3072
ds_write_b32 v12, v19 offset:7168
ds_write_b32 v12, v50 offset:3200
ds_write_b32 v12, v51 offset:7296
ds_write_b32 v12, v34 offset:3328
ds_write_b32 v12, v35 offset:7424
ds_write_b32 v12, v66 offset:3456
ds_write_b32 v12, v67 offset:7552
ds_write_b32 v12, v26 offset:3584
ds_write_b32 v12, v27 offset:7680
ds_write_b32 v12, v58 offset:3712
ds_write_b32 v12, v59 offset:7808
ds_write_b32 v12, v42 offset:3840
ds_write_b32 v12, v43 offset:7936
ds_write_b32 v12, v74 offset:3968
ds_write_b32 v12, v75 offset:8064
s_waitcnt lgkmcnt(0)
s_barrier
s_lshl_b32 s13, s93, 16
ds_read_b128 v[16:19], v2 offset:0
ds_read_b128 v[20:23], v2 offset:16
ds_read_b128 v[24:27], v2 offset:8448
ds_read_b128 v[28:31], v2 offset:8464
ds_read_b128 v[32:35], v2 offset:16896
ds_read_b128 v[36:39], v2 offset:16912
ds_read_b128 v[40:43], v2 offset:25344
ds_read_b128 v[44:47], v2 offset:25360
ds_read_b128 v[48:51], v2 offset:33792
ds_read_b128 v[52:55], v2 offset:33808
ds_read_b128 v[56:59], v2 offset:42240
ds_read_b128 v[60:63], v2 offset:42256
ds_read_b128 v[64:67], v2 offset:50688
ds_read_b128 v[68:71], v2 offset:50704
s_waitcnt lgkmcnt(12)
ds_read_b128 v[72:75], v2 offset:59136
ds_read_b128 v[76:79], v2 offset:59152
s_waitcnt lgkmcnt(14)
v_cvt_pk_bf16_f32 v216, v16, v17
v_cvt_pk_bf16_f32 v217, v18, v19
v_cvt_pk_bf16_f32 v218, v20, v21
v_cvt_pk_bf16_f32 v219, v22, v23
buffer_store_dwordx4 v[216:219], v3, s[4:7], s13 offen
s_add_u32 s13, s13, 8192
s_waitcnt lgkmcnt(12)
v_cvt_pk_bf16_f32 v220, v24, v25
v_cvt_pk_bf16_f32 v221, v26, v27
v_cvt_pk_bf16_f32 v222, v28, v29
v_cvt_pk_bf16_f32 v223, v30, v31
buffer_store_dwordx4 v[220:223], v3, s[4:7], s13 offen
s_add_u32 s13, s13, 8192
s_waitcnt lgkmcnt(10)
v_cvt_pk_bf16_f32 v224, v32, v33
v_cvt_pk_bf16_f32 v225, v34, v35
v_cvt_pk_bf16_f32 v226, v36, v37
v_cvt_pk_bf16_f32 v227, v38, v39
buffer_store_dwordx4 v[224:227], v3, s[4:7], s13 offen
s_add_u32 s13, s13, 8192
s_waitcnt lgkmcnt(8)
v_cvt_pk_bf16_f32 v228, v40, v41
v_cvt_pk_bf16_f32 v229, v42, v43
v_cvt_pk_bf16_f32 v230, v44, v45
v_cvt_pk_bf16_f32 v231, v46, v47
buffer_store_dwordx4 v[228:231], v3, s[4:7], s13 offen
s_add_u32 s13, s13, 8192
s_waitcnt lgkmcnt(6)
v_cvt_pk_bf16_f32 v232, v48, v49
v_cvt_pk_bf16_f32 v233, v50, v51
v_cvt_pk_bf16_f32 v234, v52, v53
v_cvt_pk_bf16_f32 v235, v54, v55
buffer_store_dwordx4 v[232:235], v3, s[4:7], s13 offen
s_add_u32 s13, s13, 8192
s_waitcnt lgkmcnt(4)
v_cvt_pk_bf16_f32 v236, v56, v57
v_cvt_pk_bf16_f32 v237, v58, v59
v_cvt_pk_bf16_f32 v238, v60, v61
v_cvt_pk_bf16_f32 v239, v62, v63
buffer_store_dwordx4 v[236:239], v3, s[4:7], s13 offen
s_add_u32 s13, s13, 8192
s_waitcnt lgkmcnt(2)
v_cvt_pk_bf16_f32 v240, v64, v65
v_cvt_pk_bf16_f32 v241, v66, v67
v_cvt_pk_bf16_f32 v242, v68, v69
v_cvt_pk_bf16_f32 v243, v70, v71
buffer_store_dwordx4 v[240:243], v3, s[4:7], s13 offen
s_add_u32 s13, s13, 8192
s_waitcnt lgkmcnt(0)
v_cvt_pk_bf16_f32 v244, v72, v73
v_cvt_pk_bf16_f32 v245, v74, v75
v_cvt_pk_bf16_f32 v246, v76, v77
v_cvt_pk_bf16_f32 v247, v78, v79
buffer_store_dwordx4 v[244:247], v3, s[4:7], s13 offen
s_add_u32 s13, s13, 8192
s_mov_b32 s93, s21
s_cmp_lt_u32 s93, 128
s_cbranch_scc1 mega_kernel_f3_l
mega_kernel_f3_e:
s_add_u32 s64, s91, 62
s_add_u32 s65, s91, 63
s_mov_b32 s66, 262144
s_mov_b32 s67, 1
s_waitcnt vmcnt(0)
s_barrier
mega_kernel_out:
s_load_dwordx2 s[4:5], s[0:1], 40
s_load_dwordx2 s[8:9], s[0:1], 80
v_lshrrev_b32 v2, 6, v0
v_and_b32 v1, 63, v0
v_readfirstlane_b32 s41, v2
v_lshlrev_b32 v5, 4, v1
s_waitcnt lgkmcnt(0)
s_mov_b32 s6, 8388608
s_mov_b32 s7, 0x00020000
s_mov_b32 s10, 8388608
s_mov_b32 s11, 0x00020000
s_and_b32 s58, s40, 1
s_lshr_b32 s59, s40, 1
s_lshl_b32 s43, s58, 22
s_lshl_b32 s44, s41, 20
s_add_u32 s43, s43, s44
s_lshl_b32 s44, s59, 7
s_add_u32 s48, s43, s44
s_and_b32 s56, s59, 3
s_lshl_b32 s56, s56, 7
v_lshrrev_b32 v2, 3, v1
v_and_b32 v3, 7, v1
v_lshlrev_b32 v16, 11, v2
v_lshl_add_u32 v16, v3, 4, v16
v_add_u32 v16, s48, v16
v_and_b32 v3, 3, v1
s_lshl_b32 s45, s41, 15
v_bfe_u32 v17, v1, 2, 2
v_lshrrev_b32 v18, 5, v1
v_mul_u32_u24 v18, 4, v18
v_add_u32 v17, v17, v18
v_lshlrev_b32 v17, 7, v17
v_bfe_u32 v18, v1, 4, 1
v_lshl_add_u32 v17, v18, 5, v17
v_lshl_add_u32 v17, v3, 3, v17
v_add_u32 v17, s45, v17
s_add_u32 m0, s45, 0
s_add_u32 s44, s56, 0
s_and_b32 s44, s44, 511
s_lshl_b32 s44, s44, 11
buffer_load_dwordx4 v16, s[4:7], s44 offen lds
s_add_u32 m0, s45, 1024
s_add_u32 s44, s56, 8
s_and_b32 s44, s44, 511
s_lshl_b32 s44, s44, 11
buffer_load_dwordx4 v16, s[4:7], s44 offen lds
s_add_u32 m0, s45, 2048
s_add_u32 s44, s56, 16
s_and_b32 s44, s44, 511
s_lshl_b32 s44, s44, 11
buffer_load_dwordx4 v16, s[4:7], s44 offen lds
s_add_u32 m0, s45, 3072
s_add_u32 s44, s56, 24
s_and_b32 s44, s44, 511
s_lshl_b32 s44, s44, 11
buffer_load_dwordx4 v16, s[4:7], s44 offen lds
s_add_u32 m0, s45, 4096
s_add_u32 s44, s56, 32
s_and_b32 s44, s44, 511
s_lshl_b32 s44, s44, 11
buffer_load_dwordx4 v16, s[4:7], s44 offen lds
s_add_u32 m0, s45, 5120
s_add_u32 s44, s56, 40
s_and_b32 s44, s44, 511
s_lshl_b32 s44, s44, 11
buffer_load_dwordx4 v16, s[4:7], s44 offen lds
s_add_u32 m0, s45, 6144
s_add_u32 s44, s56, 48
s_and_b32 s44, s44, 511
s_lshl_b32 s44, s44, 11
buffer_load_dwordx4 v16, s[4:7], s44 offen lds
s_add_u32 m0, s45, 7168
s_add_u32 s44, s56, 56
s_and_b32 s44, s44, 511
s_lshl_b32 s44, s44, 11
buffer_load_dwordx4 v16, s[4:7], s44 offen lds
s_add_u32 m0, s45, 8192
s_add_u32 s44, s56, 64
s_and_b32 s44, s44, 511
s_lshl_b32 s44, s44, 11
buffer_load_dwordx4 v16, s[4:7], s44 offen lds
s_add_u32 m0, s45, 9216
s_add_u32 s44, s56, 72
s_and_b32 s44, s44, 511
s_lshl_b32 s44, s44, 11
buffer_load_dwordx4 v16, s[4:7], s44 offen lds
s_add_u32 m0, s45, 10240
s_add_u32 s44, s56, 80
s_and_b32 s44, s44, 511
s_lshl_b32 s44, s44, 11
buffer_load_dwordx4 v16, s[4:7], s44 offen lds
s_add_u32 m0, s45, 11264
s_add_u32 s44, s56, 88
s_and_b32 s44, s44, 511
s_lshl_b32 s44, s44, 11
buffer_load_dwordx4 v16, s[4:7], s44 offen lds
s_add_u32 m0, s45, 12288
s_add_u32 s44, s56, 96
s_and_b32 s44, s44, 511
s_lshl_b32 s44, s44, 11
buffer_load_dwordx4 v16, s[4:7], s44 offen lds
s_add_u32 m0, s45, 13312
s_add_u32 s44, s56, 104
s_and_b32 s44, s44, 511
s_lshl_b32 s44, s44, 11
buffer_load_dwordx4 v16, s[4:7], s44 offen lds
s_add_u32 m0, s45, 14336
s_add_u32 s44, s56, 112
s_and_b32 s44, s44, 511
s_lshl_b32 s44, s44, 11
buffer_load_dwordx4 v16, s[4:7], s44 offen lds
s_add_u32 m0, s45, 15360
s_add_u32 s44, s56, 120
s_and_b32 s44, s44, 511
s_lshl_b32 s44, s44, 11
buffer_load_dwordx4 v16, s[4:7], s44 offen lds
s_add_u32 m0, s45, 16384
s_add_u32 s44, s56, 128
s_and_b32 s44, s44, 511
s_lshl_b32 s44, s44, 11
buffer_load_dwordx4 v16, s[4:7], s44 offen lds
s_add_u32 m0, s45, 17408
s_add_u32 s44, s56, 136
s_and_b32 s44, s44, 511
s_lshl_b32 s44, s44, 11
buffer_load_dwordx4 v16, s[4:7], s44 offen lds
s_add_u32 m0, s45, 18432
s_add_u32 s44, s56, 144
s_and_b32 s44, s44, 511
s_lshl_b32 s44, s44, 11
buffer_load_dwordx4 v16, s[4:7], s44 offen lds
s_add_u32 m0, s45, 19456
s_add_u32 s44, s56, 152
s_and_b32 s44, s44, 511
s_lshl_b32 s44, s44, 11
buffer_load_dwordx4 v16, s[4:7], s44 offen lds
s_add_u32 m0, s45, 20480
s_add_u32 s44, s56, 160
s_and_b32 s44, s44, 511
s_lshl_b32 s44, s44, 11
buffer_load_dwordx4 v16, s[4:7], s44 offen lds
s_add_u32 m0, s45, 21504
s_add_u32 s44, s56, 168
s_and_b32 s44, s44, 511
s_lshl_b32 s44, s44, 11
buffer_load_dwordx4 v16, s[4:7], s44 offen lds
s_add_u32 m0, s45, 22528
s_add_u32 s44, s56, 176
s_and_b32 s44, s44, 511
s_lshl_b32 s44, s44, 11
buffer_load_dwordx4 v16, s[4:7], s44 offen lds
s_add_u32 m0, s45, 23552
s_add_u32 s44, s56, 184
s_and_b32 s44, s44, 511
s_lshl_b32 s44, s44, 11
buffer_load_dwordx4 v16, s[4:7], s44 offen lds
s_add_u32 m0, s45, 24576
s_add_u32 s44, s56, 192
s_and_b32 s44, s44, 511
s_lshl_b32 s44, s44, 11
buffer_load_dwordx4 v16, s[4:7], s44 offen lds
s_add_u32 m0, s45, 25600
s_add_u32 s44, s56, 200
s_and_b32 s44, s44, 511
s_lshl_b32 s44, s44, 11
buffer_load_dwordx4 v16, s[4:7], s44 offen lds
s_add_u32 m0, s45, 26624
s_add_u32 s44, s56, 208
s_and_b32 s44, s44, 511
s_lshl_b32 s44, s44, 11
buffer_load_dwordx4 v16, s[4:7], s44 offen lds
s_add_u32 m0, s45, 27648
s_add_u32 s44, s56, 216
s_and_b32 s44, s44, 511
s_lshl_b32 s44, s44, 11
buffer_load_dwordx4 v16, s[4:7], s44 offen lds
s_add_u32 m0, s45, 28672
s_add_u32 s44, s56, 224
s_and_b32 s44, s44, 511
s_lshl_b32 s44, s44, 11
buffer_load_dwordx4 v16, s[4:7], s44 offen lds
s_add_u32 m0, s45, 29696
s_add_u32 s44, s56, 232
s_and_b32 s44, s44, 511
s_lshl_b32 s44, s44, 11
buffer_load_dwordx4 v16, s[4:7], s44 offen lds
s_add_u32 m0, s45, 30720
s_add_u32 s44, s56, 240
s_and_b32 s44, s44, 511
s_lshl_b32 s44, s44, 11
buffer_load_dwordx4 v16, s[4:7], s44 offen lds
s_add_u32 m0, s45, 31744
s_add_u32 s44, s56, 248
s_and_b32 s44, s44, 511
s_lshl_b32 s44, s44, 11
buffer_load_dwordx4 v16, s[4:7], s44 offen lds
s_waitcnt vmcnt(16)
ds_read_b64_tr_b16 a[0:1], v17 offset:0
ds_read_b64_tr_b16 a[2:3], v17 offset:2048
ds_read_b64_tr_b16 a[4:5], v17 offset:64
ds_read_b64_tr_b16 a[6:7], v17 offset:2112
ds_read_b64_tr_b16 a[8:9], v17 offset:1024
ds_read_b64_tr_b16 a[10:11], v17 offset:3072
ds_read_b64_tr_b16 a[12:13], v17 offset:1088
ds_read_b64_tr_b16 a[14:15], v17 offset:3136
s_waitcnt lgkmcnt(0)
ds_read_b64_tr_b16 a[16:17], v17 offset:4096
ds_read_b64_tr_b16 a[18:19], v17 offset:6144
ds_read_b64_tr_b16 a[20:21], v17 offset:4160
ds_read_b64_tr_b16 a[22:23], v17 offset:6208
ds_read_b64_tr_b16 a[24:25], v17 offset:5120
ds_read_b64_tr_b16 a[26:27], v17 offset:7168
ds_read_b64_tr_b16 a[28:29], v17 offset:5184
ds_read_b64_tr_b16 a[30:31], v17 offset:7232
s_waitcnt lgkmcnt(0)
ds_read_b64_tr_b16 a[32:33], v17 offset:8192
ds_read_b64_tr_b16 a[34:35], v17 offset:10240
ds_read_b64_tr_b16 a[36:37], v17 offset:8256
ds_read_b64_tr_b16 a[38:39], v17 offset:10304
ds_read_b64_tr_b16 a[40:41], v17 offset:9216
ds_read_b64_tr_b16 a[42:43], v17 offset:11264
ds_read_b64_tr_b16 a[44:45], v17 offset:9280
ds_read_b64_tr_b16 a[46:47], v17 offset:11328
s_waitcnt lgkmcnt(0)
ds_read_b64_tr_b16 a[48:49], v17 offset:12288
ds_read_b64_tr_b16 a[50:51], v17 offset:14336
ds_read_b64_tr_b16 a[52:53], v17 offset:12352
ds_read_b64_tr_b16 a[54:55], v17 offset:14400
ds_read_b64_tr_b16 a[56:57], v17 offset:13312
ds_read_b64_tr_b16 a[58:59], v17 offset:15360
ds_read_b64_tr_b16 a[60:61], v17 offset:13376
ds_read_b64_tr_b16 a[62:63], v17 offset:15424
s_waitcnt lgkmcnt(0)
s_add_u32 m0, s45, 0
s_add_u32 s44, s56, 256
s_and_b32 s44, s44, 511
s_lshl_b32 s44, s44, 11
buffer_load_dwordx4 v16, s[4:7], s44 offen lds
s_add_u32 m0, s45, 1024
s_add_u32 s44, s56, 264
s_and_b32 s44, s44, 511
s_lshl_b32 s44, s44, 11
buffer_load_dwordx4 v16, s[4:7], s44 offen lds
s_add_u32 m0, s45, 2048
s_add_u32 s44, s56, 272
s_and_b32 s44, s44, 511
s_lshl_b32 s44, s44, 11
buffer_load_dwordx4 v16, s[4:7], s44 offen lds
s_add_u32 m0, s45, 3072
s_add_u32 s44, s56, 280
s_and_b32 s44, s44, 511
s_lshl_b32 s44, s44, 11
buffer_load_dwordx4 v16, s[4:7], s44 offen lds
s_add_u32 m0, s45, 4096
s_add_u32 s44, s56, 288
s_and_b32 s44, s44, 511
s_lshl_b32 s44, s44, 11
buffer_load_dwordx4 v16, s[4:7], s44 offen lds
s_add_u32 m0, s45, 5120
s_add_u32 s44, s56, 296
s_and_b32 s44, s44, 511
s_lshl_b32 s44, s44, 11
buffer_load_dwordx4 v16, s[4:7], s44 offen lds
s_add_u32 m0, s45, 6144
s_add_u32 s44, s56, 304
s_and_b32 s44, s44, 511
s_lshl_b32 s44, s44, 11
buffer_load_dwordx4 v16, s[4:7], s44 offen lds
s_add_u32 m0, s45, 7168
s_add_u32 s44, s56, 312
s_and_b32 s44, s44, 511
s_lshl_b32 s44, s44, 11
buffer_load_dwordx4 v16, s[4:7], s44 offen lds
s_add_u32 m0, s45, 8192
s_add_u32 s44, s56, 320
s_and_b32 s44, s44, 511
s_lshl_b32 s44, s44, 11
buffer_load_dwordx4 v16, s[4:7], s44 offen lds
s_add_u32 m0, s45, 9216
s_add_u32 s44, s56, 328
s_and_b32 s44, s44, 511
s_lshl_b32 s44, s44, 11
buffer_load_dwordx4 v16, s[4:7], s44 offen lds
s_add_u32 m0, s45, 10240
s_add_u32 s44, s56, 336
s_and_b32 s44, s44, 511
s_lshl_b32 s44, s44, 11
buffer_load_dwordx4 v16, s[4:7], s44 offen lds
s_add_u32 m0, s45, 11264
s_add_u32 s44, s56, 344
s_and_b32 s44, s44, 511
s_lshl_b32 s44, s44, 11
buffer_load_dwordx4 v16, s[4:7], s44 offen lds
s_add_u32 m0, s45, 12288
s_add_u32 s44, s56, 352
s_and_b32 s44, s44, 511
s_lshl_b32 s44, s44, 11
buffer_load_dwordx4 v16, s[4:7], s44 offen lds
s_add_u32 m0, s45, 13312
s_add_u32 s44, s56, 360
s_and_b32 s44, s44, 511
s_lshl_b32 s44, s44, 11
buffer_load_dwordx4 v16, s[4:7], s44 offen lds
s_add_u32 m0, s45, 14336
s_add_u32 s44, s56, 368
s_and_b32 s44, s44, 511
s_lshl_b32 s44, s44, 11
buffer_load_dwordx4 v16, s[4:7], s44 offen lds
s_add_u32 m0, s45, 15360
s_add_u32 s44, s56, 376
s_and_b32 s44, s44, 511
s_lshl_b32 s44, s44, 11
buffer_load_dwordx4 v16, s[4:7], s44 offen lds
s_waitcnt vmcnt(16)
ds_read_b64_tr_b16 a[64:65], v17 offset:16384
ds_read_b64_tr_b16 a[66:67], v17 offset:18432
ds_read_b64_tr_b16 a[68:69], v17 offset:16448
ds_read_b64_tr_b16 a[70:71], v17 offset:18496
ds_read_b64_tr_b16 a[72:73], v17 offset:17408
ds_read_b64_tr_b16 a[74:75], v17 offset:19456
ds_read_b64_tr_b16 a[76:77], v17 offset:17472
ds_read_b64_tr_b16 a[78:79], v17 offset:19520
s_waitcnt lgkmcnt(0)
ds_read_b64_tr_b16 a[80:81], v17 offset:20480
ds_read_b64_tr_b16 a[82:83], v17 offset:22528
ds_read_b64_tr_b16 a[84:85], v17 offset:20544
ds_read_b64_tr_b16 a[86:87], v17 offset:22592
ds_read_b64_tr_b16 a[88:89], v17 offset:21504
ds_read_b64_tr_b16 a[90:91], v17 offset:23552
ds_read_b64_tr_b16 a[92:93], v17 offset:21568
ds_read_b64_tr_b16 a[94:95], v17 offset:23616
s_waitcnt lgkmcnt(0)
ds_read_b64_tr_b16 a[96:97], v17 offset:24576
ds_read_b64_tr_b16 a[98:99], v17 offset:26624
ds_read_b64_tr_b16 a[100:101], v17 offset:24640
ds_read_b64_tr_b16 a[102:103], v17 offset:26688
ds_read_b64_tr_b16 a[104:105], v17 offset:25600
ds_read_b64_tr_b16 a[106:107], v17 offset:27648
ds_read_b64_tr_b16 a[108:109], v17 offset:25664
ds_read_b64_tr_b16 a[110:111], v17 offset:27712
s_waitcnt lgkmcnt(0)
ds_read_b64_tr_b16 a[112:113], v17 offset:28672
ds_read_b64_tr_b16 a[114:115], v17 offset:30720
ds_read_b64_tr_b16 a[116:117], v17 offset:28736
ds_read_b64_tr_b16 a[118:119], v17 offset:30784
ds_read_b64_tr_b16 a[120:121], v17 offset:29696
ds_read_b64_tr_b16 a[122:123], v17 offset:31744
ds_read_b64_tr_b16 a[124:125], v17 offset:29760
ds_read_b64_tr_b16 a[126:127], v17 offset:31808
s_waitcnt lgkmcnt(0)
s_add_u32 m0, s45, 16384
s_add_u32 s44, s56, 384
s_and_b32 s44, s44, 511
s_lshl_b32 s44, s44, 11
buffer_load_dwordx4 v16, s[4:7], s44 offen lds
s_add_u32 m0, s45, 17408
s_add_u32 s44, s56, 392
s_and_b32 s44, s44, 511
s_lshl_b32 s44, s44, 11
buffer_load_dwordx4 v16, s[4:7], s44 offen lds
s_add_u32 m0, s45, 18432
s_add_u32 s44, s56, 400
s_and_b32 s44, s44, 511
s_lshl_b32 s44, s44, 11
buffer_load_dwordx4 v16, s[4:7], s44 offen lds
s_add_u32 m0, s45, 19456
s_add_u32 s44, s56, 408
s_and_b32 s44, s44, 511
s_lshl_b32 s44, s44, 11
buffer_load_dwordx4 v16, s[4:7], s44 offen lds
s_add_u32 m0, s45, 20480
s_add_u32 s44, s56, 416
s_and_b32 s44, s44, 511
s_lshl_b32 s44, s44, 11
buffer_load_dwordx4 v16, s[4:7], s44 offen lds
s_add_u32 m0, s45, 21504
s_add_u32 s44, s56, 424
s_and_b32 s44, s44, 511
s_lshl_b32 s44, s44, 11
buffer_load_dwordx4 v16, s[4:7], s44 offen lds
s_add_u32 m0, s45, 22528
s_add_u32 s44, s56, 432
s_and_b32 s44, s44, 511
s_lshl_b32 s44, s44, 11
buffer_load_dwordx4 v16, s[4:7], s44 offen lds
s_add_u32 m0, s45, 23552
s_add_u32 s44, s56, 440
s_and_b32 s44, s44, 511
s_lshl_b32 s44, s44, 11
buffer_load_dwordx4 v16, s[4:7], s44 offen lds
s_add_u32 m0, s45, 24576
s_add_u32 s44, s56, 448
s_and_b32 s44, s44, 511
s_lshl_b32 s44, s44, 11
buffer_load_dwordx4 v16, s[4:7], s44 offen lds
s_add_u32 m0, s45, 25600
s_add_u32 s44, s56, 456
s_and_b32 s44, s44, 511
s_lshl_b32 s44, s44, 11
buffer_load_dwordx4 v16, s[4:7], s44 offen lds
s_add_u32 m0, s45, 26624
s_add_u32 s44, s56, 464
s_and_b32 s44, s44, 511
s_lshl_b32 s44, s44, 11
buffer_load_dwordx4 v16, s[4:7], s44 offen lds
s_add_u32 m0, s45, 27648
s_add_u32 s44, s56, 472
s_and_b32 s44, s44, 511
s_lshl_b32 s44, s44, 11
buffer_load_dwordx4 v16, s[4:7], s44 offen lds
s_add_u32 m0, s45, 28672
s_add_u32 s44, s56, 480
s_and_b32 s44, s44, 511
s_lshl_b32 s44, s44, 11
buffer_load_dwordx4 v16, s[4:7], s44 offen lds
s_add_u32 m0, s45, 29696
s_add_u32 s44, s56, 488
s_and_b32 s44, s44, 511
s_lshl_b32 s44, s44, 11
buffer_load_dwordx4 v16, s[4:7], s44 offen lds
s_add_u32 m0, s45, 30720
s_add_u32 s44, s56, 496
s_and_b32 s44, s44, 511
s_lshl_b32 s44, s44, 11
buffer_load_dwordx4 v16, s[4:7], s44 offen lds
s_add_u32 m0, s45, 31744
s_add_u32 s44, s56, 504
s_and_b32 s44, s44, 511
s_lshl_b32 s44, s44, 11
buffer_load_dwordx4 v16, s[4:7], s44 offen lds
s_waitcnt vmcnt(16)
ds_read_b64_tr_b16 a[128:129], v17 offset:0
ds_read_b64_tr_b16 a[130:131], v17 offset:2048
ds_read_b64_tr_b16 a[132:133], v17 offset:64
ds_read_b64_tr_b16 a[134:135], v17 offset:2112
ds_read_b64_tr_b16 a[136:137], v17 offset:1024
ds_read_b64_tr_b16 a[138:139], v17 offset:3072
ds_read_b64_tr_b16 a[140:141], v17 offset:1088
ds_read_b64_tr_b16 a[142:143], v17 offset:3136
s_waitcnt lgkmcnt(0)
ds_read_b64_tr_b16 a[144:145], v17 offset:4096
ds_read_b64_tr_b16 a[146:147], v17 offset:6144
ds_read_b64_tr_b16 a[148:149], v17 offset:4160
ds_read_b64_tr_b16 a[150:151], v17 offset:6208
ds_read_b64_tr_b16 a[152:153], v17 offset:5120
ds_read_b64_tr_b16 a[154:155], v17 offset:7168
ds_read_b64_tr_b16 a[156:157], v17 offset:5184
ds_read_b64_tr_b16 a[158:159], v17 offset:7232
s_waitcnt lgkmcnt(0)
ds_read_b64_tr_b16 a[160:161], v17 offset:8192
ds_read_b64_tr_b16 a[162:163], v17 offset:10240
ds_read_b64_tr_b16 a[164:165], v17 offset:8256
ds_read_b64_tr_b16 a[166:167], v17 offset:10304
ds_read_b64_tr_b16 a[168:169], v17 offset:9216
ds_read_b64_tr_b16 a[170:171], v17 offset:11264
ds_read_b64_tr_b16 a[172:173], v17 offset:9280
ds_read_b64_tr_b16 a[174:175], v17 offset:11328
s_waitcnt lgkmcnt(0)
ds_read_b64_tr_b16 a[176:177], v17 offset:12288
ds_read_b64_tr_b16 a[178:179], v17 offset:14336
ds_read_b64_tr_b16 a[180:181], v17 offset:12352
ds_read_b64_tr_b16 a[182:183], v17 offset:14400
ds_read_b64_tr_b16 a[184:185], v17 offset:13312
ds_read_b64_tr_b16 a[186:187], v17 offset:15360
ds_read_b64_tr_b16 a[188:189], v17 offset:13376
ds_read_b64_tr_b16 a[190:191], v17 offset:15424
s_waitcnt lgkmcnt(0)
s_waitcnt vmcnt(0)
ds_read_b64_tr_b16 a[192:193], v17 offset:16384
ds_read_b64_tr_b16 a[194:195], v17 offset:18432
ds_read_b64_tr_b16 a[196:197], v17 offset:16448
ds_read_b64_tr_b16 a[198:199], v17 offset:18496
ds_read_b64_tr_b16 a[200:201], v17 offset:17408
ds_read_b64_tr_b16 a[202:203], v17 offset:19456
ds_read_b64_tr_b16 a[204:205], v17 offset:17472
ds_read_b64_tr_b16 a[206:207], v17 offset:19520
s_waitcnt lgkmcnt(0)
ds_read_b64_tr_b16 a[208:209], v17 offset:20480
ds_read_b64_tr_b16 a[210:211], v17 offset:22528
ds_read_b64_tr_b16 a[212:213], v17 offset:20544
ds_read_b64_tr_b16 a[214:215], v17 offset:22592
ds_read_b64_tr_b16 a[216:217], v17 offset:21504
ds_read_b64_tr_b16 a[218:219], v17 offset:23552
ds_read_b64_tr_b16 a[220:221], v17 offset:21568
ds_read_b64_tr_b16 a[222:223], v17 offset:23616
s_waitcnt lgkmcnt(0)
ds_read_b64_tr_b16 a[224:225], v17 offset:24576
ds_read_b64_tr_b16 a[226:227], v17 offset:26624
ds_read_b64_tr_b16 a[228:229], v17 offset:24640
ds_read_b64_tr_b16 a[230:231], v17 offset:26688
ds_read_b64_tr_b16 a[232:233], v17 offset:25600
ds_read_b64_tr_b16 a[234:235], v17 offset:27648
ds_read_b64_tr_b16 a[236:237], v17 offset:25664
ds_read_b64_tr_b16 a[238:239], v17 offset:27712
s_waitcnt lgkmcnt(0)
ds_read_b64_tr_b16 a[240:241], v17 offset:28672
ds_read_b64_tr_b16 a[242:243], v17 offset:30720
ds_read_b64_tr_b16 a[244:245], v17 offset:28736
ds_read_b64_tr_b16 a[246:247], v17 offset:30784
ds_read_b64_tr_b16 a[248:249], v17 offset:29696
ds_read_b64_tr_b16 a[250:251], v17 offset:31744
ds_read_b64_tr_b16 a[252:253], v17 offset:29760
ds_read_b64_tr_b16 a[254:255], v17 offset:31808
s_waitcnt lgkmcnt(0)
s_barrier
s_lshl_b32 s56, s56, 6
s_lshl_b32 s43, s58, 17
s_lshl_b32 s44, s41, 15
s_add_u32 s43, s43, s44
s_add_u32 s43, s43, 134217728
v_add_u32 v6, s43, v5
v_and_b32 v2, 15, v1
v_lshlrev_b32 v7, 2, v2
s_lshl_b32 s43, s58, 8
s_lshl_b32 s44, s41, 6
s_add_u32 s43, s43, s44
s_add_u32 s43, s43, 69255168
v_add_u32 v7, s43, v7
s_mul_i32 s43, s41, 8704
v_lshrrev_b32 v2, 5, v1
v_lshl_add_u32 v8, v2, 5, v5
v_add_u32 v8, s43, v8
v_and_b32 v2, 7, v1
v_mul_u32_u24 v9, 544, v2
v_lshrrev_b32 v3, 3, v1
v_lshl_add_u32 v9, v3, 4, v9
s_lshl_b32 s43, s41, 7
v_add_u32 v9, s43, v9
s_mul_i32 s43, s58, 4352
s_sub_u32 s44, 4352, s43
v_add_u32 v10, s44, v9
v_add_u32 v9, s43, v9
s_lshl_b32 s43, s41, 15
s_lshl_b32 s44, s40, 6
s_add_u32 s43, s43, s44
v_lshlrev_b32 v11, 12, v3
v_and_b32 v2, 7, v1
v_lshl_add_u32 v11, v2, 3, v11
v_add_u32 v11, s43, v11
s_lshl_b32 s43, s40, 13
s_lshl_b32 s44, s41, 10
s_add_u32 s43, s43, s44
s_add_u32 s43, s43, 67633152
s_add_u32 s43, s43, s66
v_add_u32 v13, s43, v5
v_xor_b32 v12, 8192, v13
s_mov_b32 s42, s64
s_mov_b32 s52, 0
s_mov_b32 s53, 0
s_mov_b32 s57, 0
mega_kernel_o_cold:
s_cmp_gt_i32 s52, s42
s_cbranch_scc1 mega_kernel_o_fk
mega_kernel_o_fw:
buffer_load_dword v2, v7, s[84:87], 0 offen sc1
s_waitcnt vmcnt(0)
v_min_i32_dpp v2, v2, v2 quad_perm:[1,0,3,2] row_mask:0xf bank_mask:0xf
s_nop 1
v_min_i32_dpp v2, v2, v2 quad_perm:[2,3,0,1] row_mask:0xf bank_mask:0xf
s_nop 1
v_min_i32_dpp v2, v2, v2 row_ror:4 row_mask:0xf bank_mask:0xf
s_nop 1
v_min_i32_dpp v2, v2, v2 row_ror:8 row_mask:0xf bank_mask:0xf
s_nop 0
v_readfirstlane_b32 s52, v2
s_min_i32 s52, s52, s65
s_cmp_gt_i32 s52, s42
s_cbranch_scc1 mega_kernel_o_fk
s_sleep 2
s_add_u32 s43, s52, 2
s_cmp_gt_i32 s43, s42
s_cbranch_scc1 mega_kernel_o_fw
s_sleep 48
s_branch mega_kernel_o_fw
mega_kernel_o_fk:
s_lshl_b32 s50, s42, 18
s_add_u32 s51, s56, 0
s_and_b32 s51, s51, 0x7fff
s_add_u32 s51, s51, s50
buffer_load_dwordx4 v[96:99], v6, s[84:87], s51 offen offset:0 sc1
buffer_load_dwordx4 v[100:103], v6, s[84:87], s51 offen offset:1024 sc1
buffer_load_dwordx4 v[104:107], v6, s[84:87], s51 offen offset:2048 sc1
buffer_load_dwordx4 v[108:111], v6, s[84:87], s51 offen offset:3072 sc1
s_add_u32 s51, s56, 4096
s_and_b32 s51, s51, 0x7fff
s_add_u32 s51, s51, s50
buffer_load_dwordx4 v[112:115], v6, s[84:87], s51 offen offset:0 sc1
buffer_load_dwordx4 v[116:119], v6, s[84:87], s51 offen offset:1024 sc1
buffer_load_dwordx4 v[120:123], v6, s[84:87], s51 offen offset:2048 sc1
buffer_load_dwordx4 v[124:127], v6, s[84:87], s51 offen offset:3072 sc1
s_add_u32 s51, s56, 8192
s_and_b32 s51, s51, 0x7fff
s_add_u32 s51, s51, s50
buffer_load_dwordx4 v[128:131], v6, s[84:87], s51 offen offset:0 sc1
buffer_load_dwordx4 v[132:135], v6, s[84:87], s51 offen offset:1024 sc1
buffer_load_dwordx4 v[136:139], v6, s[84:87], s51 offen offset:2048 sc1
buffer_load_dwordx4 v[140:143], v6, s[84:87], s51 offen offset:3072 sc1
s_add_u32 s51, s56, 12288
s_and_b32 s51, s51, 0x7fff
s_add_u32 s51, s51, s50
buffer_load_dwordx4 v[144:147], v6, s[84:87], s51 offen offset:0 sc1
buffer_load_dwordx4 v[148:151], v6, s[84:87], s51 offen offset:1024 sc1
buffer_load_dwordx4 v[152:155], v6, s[84:87], s51 offen offset:2048 sc1
buffer_load_dwordx4 v[156:159], v6, s[84:87], s51 offen offset:3072 sc1
s_add_u32 s51, s56, 16384
s_and_b32 s51, s51, 0x7fff
s_add_u32 s51, s51, s50
buffer_load_dwordx4 v[160:163], v6, s[84:87], s51 offen offset:0 sc1
buffer_load_dwordx4 v[164:167], v6, s[84:87], s51 offen offset:1024 sc1
buffer_load_dwordx4 v[168:171], v6, s[84:87], s51 offen offset:2048 sc1
buffer_load_dwordx4 v[172:175], v6, s[84:87], s51 offen offset:3072 sc1
s_add_u32 s51, s56, 20480
s_and_b32 s51, s51, 0x7fff
s_add_u32 s51, s51, s50
buffer_load_dwordx4 v[176:179], v6, s[84:87], s51 offen offset:0 sc1
buffer_load_dwordx4 v[180:183], v6, s[84:87], s51 offen offset:1024 sc1
buffer_load_dwordx4 v[184:187], v6, s[84:87], s51 offen offset:2048 sc1
buffer_load_dwordx4 v[188:191], v6, s[84:87], s51 offen offset:3072 sc1
s_add_u32 s51, s56, 24576
s_and_b32 s51, s51, 0x7fff
s_add_u32 s51, s51, s50
buffer_load_dwordx4 v[192:195], v6, s[84:87], s51 offen offset:0 sc1
buffer_load_dwordx4 v[196:199], v6, s[84:87], s51 offen offset:1024 sc1
buffer_load_dwordx4 v[200:203], v6, s[84:87], s51 offen offset:2048 sc1
buffer_load_dwordx4 v[204:207], v6, s[84:87], s51 offen offset:3072 sc1
s_add_u32 s51, s56, 28672
s_and_b32 s51, s51, 0x7fff
s_add_u32 s51, s51, s50
buffer_load_dwordx4 v[208:211], v6, s[84:87], s51 offen offset:0 sc1
buffer_load_dwordx4 v[212:215], v6, s[84:87], s51 offen offset:1024 sc1
buffer_load_dwordx4 v[216:219], v6, s[84:87], s51 offen offset:2048 sc1
buffer_load_dwordx4 v[220:223], v6, s[84:87], s51 offen offset:3072 sc1
mega_kernel_o_w0:
s_add_u32 s54, s42, 1
s_sub_u32 s62, s42, 1
s_lshl_b32 s50, s54, 18
s_cmp_gt_i32 s52, s54
s_cbranch_scc0 mega_kernel_o_n0
s_waitcnt vmcnt(31)
v_mfma_f32_32x32x16_bf16 v[20:35], a[0:3], v[96:99], 0
v_mfma_f32_32x32x16_bf16 v[36:51], a[4:7], v[96:99], 0
s_add_u32 s51, s56, 0
s_and_b32 s51, s51, 0x7fff
s_add_u32 s51, s51, s50
buffer_load_dwordx4 v[96:99], v6, s[84:87], s51 offen offset:0 sc1
s_waitcnt vmcnt(31)
v_mfma_f32_32x32x16_bf16 v[20:35], a[8:11], v[100:103], v[20:35]
v_mfma_f32_32x32x16_bf16 v[36:51], a[12:15], v[100:103], v[36:51]
buffer_load_dwordx4 v[100:103], v6, s[84:87], s51 offen offset:1024 sc1
s_waitcnt vmcnt(31)
v_mfma_f32_32x32x16_bf16 v[20:35], a[16:19], v[104:107], v[20:35]
v_mfma_f32_32x32x16_bf16 v[36:51], a[20:23], v[104:107], v[36:51]
buffer_load_dwordx4 v[104:107], v6, s[84:87], s51 offen offset:2048 sc1
s_waitcnt vmcnt(31)
v_mfma_f32_32x32x16_bf16 v[20:35], a[24:27], v[108:111], v[20:35]
v_mfma_f32_32x32x16_bf16 v[36:51], a[28:31], v[108:111], v[36:51]
buffer_load_dwordx4 v[108:111], v6, s[84:87], s51 offen offset:3072 sc1
s_waitcnt vmcnt(31)
v_mfma_f32_32x32x16_bf16 v[20:35], a[32:35], v[112:115], v[20:35]
v_mfma_f32_32x32x16_bf16 v[36:51], a[36:39], v[112:115], v[36:51]
s_add_u32 s51, s56, 4096
s_and_b32 s51, s51, 0x7fff
s_add_u32 s51, s51, s50
buffer_load_dwordx4 v[112:115], v6, s[84:87], s51 offen offset:0 sc1
s_waitcnt vmcnt(31)
v_mfma_f32_32x32x16_bf16 v[20:35], a[40:43], v[116:119], v[20:35]
v_mfma_f32_32x32x16_bf16 v[36:51], a[44:47], v[116:119], v[36:51]
buffer_load_dwordx4 v[116:119], v6, s[84:87], s51 offen offset:1024 sc1
s_waitcnt vmcnt(31)
v_mfma_f32_32x32x16_bf16 v[20:35], a[48:51], v[120:123], v[20:35]
v_mfma_f32_32x32x16_bf16 v[36:51], a[52:55], v[120:123], v[36:51]
buffer_load_dwordx4 v[120:123], v6, s[84:87], s51 offen offset:2048 sc1
s_waitcnt vmcnt(31)
v_mfma_f32_32x32x16_bf16 v[20:35], a[56:59], v[124:127], v[20:35]
v_mfma_f32_32x32x16_bf16 v[36:51], a[60:63], v[124:127], v[36:51]
buffer_load_dwordx4 v[124:127], v6, s[84:87], s51 offen offset:3072 sc1
s_waitcnt vmcnt(31)
v_mfma_f32_32x32x16_bf16 v[20:35], a[64:67], v[128:131], v[20:35]
v_mfma_f32_32x32x16_bf16 v[36:51], a[68:71], v[128:131], v[36:51]
s_add_u32 s51, s56, 8192
s_and_b32 s51, s51, 0x7fff
s_add_u32 s51, s51, s50
buffer_load_dwordx4 v[128:131], v6, s[84:87], s51 offen offset:0 sc1
s_waitcnt vmcnt(31)
v_mfma_f32_32x32x16_bf16 v[20:35], a[72:75], v[132:135], v[20:35]
v_mfma_f32_32x32x16_bf16 v[36:51], a[76:79], v[132:135], v[36:51]
buffer_load_dwordx4 v[132:135], v6, s[84:87], s51 offen offset:1024 sc1
s_waitcnt vmcnt(31)
v_mfma_f32_32x32x16_bf16 v[20:35], a[80:83], v[136:139], v[20:35]
v_mfma_f32_32x32x16_bf16 v[36:51], a[84:87], v[136:139], v[36:51]
buffer_load_dwordx4 v[136:139], v6, s[84:87], s51 offen offset:2048 sc1
s_waitcnt vmcnt(31)
v_mfma_f32_32x32x16_bf16 v[20:35], a[88:91], v[140:143], v[20:35]
v_mfma_f32_32x32x16_bf16 v[36:51], a[92:95], v[140:143], v[36:51]
buffer_load_dwordx4 v[140:143], v6, s[84:87], s51 offen offset:3072 sc1
s_waitcnt vmcnt(31)
v_mfma_f32_32x32x16_bf16 v[20:35], a[96:99], v[144:147], v[20:35]
v_mfma_f32_32x32x16_bf16 v[36:51], a[100:103], v[144:147], v[36:51]
s_add_u32 s51, s56, 12288
s_and_b32 s51, s51, 0x7fff
s_add_u32 s51, s51, s50
buffer_load_dwordx4 v[144:147], v6, s[84:87], s51 offen offset:0 sc1
s_waitcnt vmcnt(31)
v_mfma_f32_32x32x16_bf16 v[20:35], a[104:107], v[148:151], v[20:35]
v_mfma_f32_32x32x16_bf16 v[36:51], a[108:111], v[148:151], v[36:51]
buffer_load_dwordx4 v[148:151], v6, s[84:87], s51 offen offset:1024 sc1
s_waitcnt vmcnt(31)
v_mfma_f32_32x32x16_bf16 v[20:35], a[112:115], v[152:155], v[20:35]
v_mfma_f32_32x32x16_bf16 v[36:51], a[116:119], v[152:155], v[36:51]
buffer_load_dwordx4 v[152:155], v6, s[84:87], s51 offen offset:2048 sc1
s_waitcnt vmcnt(31)
v_mfma_f32_32x32x16_bf16 v[20:35], a[120:123], v[156:159], v[20:35]
v_mfma_f32_32x32x16_bf16 v[36:51], a[124:127], v[156:159], v[36:51]
buffer_load_dwordx4 v[156:159], v6, s[84:87], s51 offen offset:3072 sc1
s_waitcnt vmcnt(31)
v_mfma_f32_32x32x16_bf16 v[20:35], a[128:131], v[160:163], v[20:35]
v_mfma_f32_32x32x16_bf16 v[36:51], a[132:135], v[160:163], v[36:51]
s_add_u32 s51, s56, 16384
s_and_b32 s51, s51, 0x7fff
s_add_u32 s51, s51, s50
buffer_load_dwordx4 v[160:163], v6, s[84:87], s51 offen offset:0 sc1
s_waitcnt vmcnt(31)
v_mfma_f32_32x32x16_bf16 v[20:35], a[136:139], v[164:167], v[20:35]
v_mfma_f32_32x32x16_bf16 v[36:51], a[140:143], v[164:167], v[36:51]
buffer_load_dwordx4 v[164:167], v6, s[84:87], s51 offen offset:1024 sc1
s_waitcnt vmcnt(31)
v_mfma_f32_32x32x16_bf16 v[20:35], a[144:147], v[168:171], v[20:35]
v_mfma_f32_32x32x16_bf16 v[36:51], a[148:151], v[168:171], v[36:51]
buffer_load_dwordx4 v[168:171], v6, s[84:87], s51 offen offset:2048 sc1
s_waitcnt vmcnt(31)
v_mfma_f32_32x32x16_bf16 v[20:35], a[152:155], v[172:175], v[20:35]
v_mfma_f32_32x32x16_bf16 v[36:51], a[156:159], v[172:175], v[36:51]
buffer_load_dwordx4 v[172:175], v6, s[84:87], s51 offen offset:3072 sc1
s_waitcnt vmcnt(31)
v_mfma_f32_32x32x16_bf16 v[20:35], a[160:163], v[176:179], v[20:35]
v_mfma_f32_32x32x16_bf16 v[36:51], a[164:167], v[176:179], v[36:51]
s_add_u32 s51, s56, 20480
s_and_b32 s51, s51, 0x7fff
s_add_u32 s51, s51, s50
buffer_load_dwordx4 v[176:179], v6, s[84:87], s51 offen offset:0 sc1
s_waitcnt vmcnt(31)
v_mfma_f32_32x32x16_bf16 v[20:35], a[168:171], v[180:183], v[20:35]
v_mfma_f32_32x32x16_bf16 v[36:51], a[172:175], v[180:183], v[36:51]
buffer_load_dwordx4 v[180:183], v6, s[84:87], s51 offen offset:1024 sc1
s_waitcnt vmcnt(31)
v_mfma_f32_32x32x16_bf16 v[20:35], a[176:179], v[184:187], v[20:35]
v_mfma_f32_32x32x16_bf16 v[36:51], a[180:183], v[184:187], v[36:51]
buffer_load_dwordx4 v[184:187], v6, s[84:87], s51 offen offset:2048 sc1
s_waitcnt vmcnt(31)
v_mfma_f32_32x32x16_bf16 v[20:35], a[184:187], v[188:191], v[20:35]
v_mfma_f32_32x32x16_bf16 v[36:51], a[188:191], v[188:191], v[36:51]
buffer_load_dwordx4 v[188:191], v6, s[84:87], s51 offen offset:3072 sc1
s_waitcnt vmcnt(31)
v_mfma_f32_32x32x16_bf16 v[20:35], a[192:195], v[192:195], v[20:35]
v_mfma_f32_32x32x16_bf16 v[36:51], a[196:199], v[192:195], v[36:51]
s_add_u32 s51, s56, 24576
s_and_b32 s51, s51, 0x7fff
s_add_u32 s51, s51, s50
buffer_load_dwordx4 v[192:195], v6, s[84:87], s51 offen offset:0 sc1
s_waitcnt vmcnt(31)
v_mfma_f32_32x32x16_bf16 v[20:35], a[200:203], v[196:199], v[20:35]
v_mfma_f32_32x32x16_bf16 v[36:51], a[204:207], v[196:199], v[36:51]
buffer_load_dwordx4 v[196:199], v6, s[84:87], s51 offen offset:1024 sc1
s_waitcnt vmcnt(31)
v_mfma_f32_32x32x16_bf16 v[20:35], a[208:211], v[200:203], v[20:35]
v_mfma_f32_32x32x16_bf16 v[36:51], a[212:215], v[200:203], v[36:51]
buffer_load_dwordx4 v[200:203], v6, s[84:87], s51 offen offset:2048 sc1
s_waitcnt vmcnt(31)
v_mfma_f32_32x32x16_bf16 v[20:35], a[216:219], v[204:207], v[20:35]
v_mfma_f32_32x32x16_bf16 v[36:51], a[220:223], v[204:207], v[36:51]
buffer_load_dwordx4 v[204:207], v6, s[84:87], s51 offen offset:3072 sc1
s_waitcnt vmcnt(31)
v_mfma_f32_32x32x16_bf16 v[20:35], a[224:227], v[208:211], v[20:35]
v_mfma_f32_32x32x16_bf16 v[36:51], a[228:231], v[208:211], v[36:51]
s_add_u32 s51, s56, 28672
s_and_b32 s51, s51, 0x7fff
s_add_u32 s51, s51, s50
buffer_load_dwordx4 v[208:211], v6, s[84:87], s51 offen offset:0 sc1
s_waitcnt vmcnt(31)
v_mfma_f32_32x32x16_bf16 v[20:35], a[232:235], v[212:215], v[20:35]
v_mfma_f32_32x32x16_bf16 v[36:51], a[236:239], v[212:215], v[36:51]
buffer_load_dwordx4 v[212:215], v6, s[84:87], s51 offen offset:1024 sc1
s_waitcnt vmcnt(31)
v_mfma_f32_32x32x16_bf16 v[20:35], a[240:243], v[216:219], v[20:35]
v_mfma_f32_32x32x16_bf16 v[36:51], a[244:247], v[216:219], v[36:51]
buffer_load_dwordx4 v[216:219], v6, s[84:87], s51 offen offset:2048 sc1
s_waitcnt vmcnt(31)
v_mfma_f32_32x32x16_bf16 v[224:239], a[248:251], v[220:223], v[20:35]
v_mfma_f32_32x32x16_bf16 v[240:255], a[252:255], v[220:223], v[36:51]
buffer_load_dwordx4 v[220:223], v6, s[84:87], s51 offen offset:3072 sc1
s_add_u32 s42, s42, 1
s_branch mega_kernel_o_w1
mega_kernel_o_n0:
s_waitcnt vmcnt(31)
v_mfma_f32_32x32x16_bf16 v[20:35], a[0:3], v[96:99], 0
v_mfma_f32_32x32x16_bf16 v[36:51], a[4:7], v[96:99], 0
s_waitcnt vmcnt(30)
v_mfma_f32_32x32x16_bf16 v[20:35], a[8:11], v[100:103], v[20:35]
v_mfma_f32_32x32x16_bf16 v[36:51], a[12:15], v[100:103], v[36:51]
s_waitcnt vmcnt(29)
v_mfma_f32_32x32x16_bf16 v[20:35], a[16:19], v[104:107], v[20:35]
v_mfma_f32_32x32x16_bf16 v[36:51], a[20:23], v[104:107], v[36:51]
s_waitcnt vmcnt(28)
v_mfma_f32_32x32x16_bf16 v[20:35], a[24:27], v[108:111], v[20:35]
v_mfma_f32_32x32x16_bf16 v[36:51], a[28:31], v[108:111], v[36:51]
s_waitcnt vmcnt(27)
v_mfma_f32_32x32x16_bf16 v[20:35], a[32:35], v[112:115], v[20:35]
v_mfma_f32_32x32x16_bf16 v[36:51], a[36:39], v[112:115], v[36:51]
s_waitcnt vmcnt(26)
v_mfma_f32_32x32x16_bf16 v[20:35], a[40:43], v[116:119], v[20:35]
v_mfma_f32_32x32x16_bf16 v[36:51], a[44:47], v[116:119], v[36:51]
s_waitcnt vmcnt(25)
v_mfma_f32_32x32x16_bf16 v[20:35], a[48:51], v[120:123], v[20:35]
v_mfma_f32_32x32x16_bf16 v[36:51], a[52:55], v[120:123], v[36:51]
s_waitcnt vmcnt(24)
v_mfma_f32_32x32x16_bf16 v[20:35], a[56:59], v[124:127], v[20:35]
v_mfma_f32_32x32x16_bf16 v[36:51], a[60:63], v[124:127], v[36:51]
s_waitcnt vmcnt(23)
v_mfma_f32_32x32x16_bf16 v[20:35], a[64:67], v[128:131], v[20:35]
v_mfma_f32_32x32x16_bf16 v[36:51], a[68:71], v[128:131], v[36:51]
s_waitcnt vmcnt(22)
v_mfma_f32_32x32x16_bf16 v[20:35], a[72:75], v[132:135], v[20:35]
v_mfma_f32_32x32x16_bf16 v[36:51], a[76:79], v[132:135], v[36:51]
s_waitcnt vmcnt(21)
v_mfma_f32_32x32x16_bf16 v[20:35], a[80:83], v[136:139], v[20:35]
v_mfma_f32_32x32x16_bf16 v[36:51], a[84:87], v[136:139], v[36:51]
s_waitcnt vmcnt(20)
v_mfma_f32_32x32x16_bf16 v[20:35], a[88:91], v[140:143], v[20:35]
v_mfma_f32_32x32x16_bf16 v[36:51], a[92:95], v[140:143], v[36:51]
s_waitcnt vmcnt(19)
v_mfma_f32_32x32x16_bf16 v[20:35], a[96:99], v[144:147], v[20:35]
v_mfma_f32_32x32x16_bf16 v[36:51], a[100:103], v[144:147], v[36:51]
s_waitcnt vmcnt(18)
v_mfma_f32_32x32x16_bf16 v[20:35], a[104:107], v[148:151], v[20:35]
v_mfma_f32_32x32x16_bf16 v[36:51], a[108:111], v[148:151], v[36:51]
s_waitcnt vmcnt(17)
v_mfma_f32_32x32x16_bf16 v[20:35], a[112:115], v[152:155], v[20:35]
v_mfma_f32_32x32x16_bf16 v[36:51], a[116:119], v[152:155], v[36:51]
s_waitcnt vmcnt(16)
v_mfma_f32_32x32x16_bf16 v[20:35], a[120:123], v[156:159], v[20:35]
v_mfma_f32_32x32x16_bf16 v[36:51], a[124:127], v[156:159], v[36:51]
s_waitcnt vmcnt(15)
v_mfma_f32_32x32x16_bf16 v[20:35], a[128:131], v[160:163], v[20:35]
v_mfma_f32_32x32x16_bf16 v[36:51], a[132:135], v[160:163], v[36:51]
s_waitcnt vmcnt(14)
v_mfma_f32_32x32x16_bf16 v[20:35], a[136:139], v[164:167], v[20:35]
v_mfma_f32_32x32x16_bf16 v[36:51], a[140:143], v[164:167], v[36:51]
s_waitcnt vmcnt(13)
v_mfma_f32_32x32x16_bf16 v[20:35], a[144:147], v[168:171], v[20:35]
v_mfma_f32_32x32x16_bf16 v[36:51], a[148:151], v[168:171], v[36:51]
s_waitcnt vmcnt(12)
v_mfma_f32_32x32x16_bf16 v[20:35], a[152:155], v[172:175], v[20:35]
v_mfma_f32_32x32x16_bf16 v[36:51], a[156:159], v[172:175], v[36:51]
s_waitcnt vmcnt(11)
v_mfma_f32_32x32x16_bf16 v[20:35], a[160:163], v[176:179], v[20:35]
v_mfma_f32_32x32x16_bf16 v[36:51], a[164:167], v[176:179], v[36:51]
buffer_load_dword v15, v7, s[84:87], 0 offen sc1
s_waitcnt vmcnt(10)
v_mfma_f32_32x32x16_bf16 v[20:35], a[168:171], v[180:183], v[20:35]
v_mfma_f32_32x32x16_bf16 v[36:51], a[172:175], v[180:183], v[36:51]
s_waitcnt vmcnt(9)
v_mfma_f32_32x32x16_bf16 v[20:35], a[176:179], v[184:187], v[20:35]
v_mfma_f32_32x32x16_bf16 v[36:51], a[180:183], v[184:187], v[36:51]
s_waitcnt vmcnt(8)
v_mfma_f32_32x32x16_bf16 v[20:35], a[184:187], v[188:191], v[20:35]
v_mfma_f32_32x32x16_bf16 v[36:51], a[188:191], v[188:191], v[36:51]
s_waitcnt vmcnt(7)
v_mfma_f32_32x32x16_bf16 v[20:35], a[192:195], v[192:195], v[20:35]
v_mfma_f32_32x32x16_bf16 v[36:51], a[196:199], v[192:195], v[36:51]
s_waitcnt vmcnt(6)
v_mfma_f32_32x32x16_bf16 v[20:35], a[200:203], v[196:199], v[20:35]
v_mfma_f32_32x32x16_bf16 v[36:51], a[204:207], v[196:199], v[36:51]
s_waitcnt vmcnt(5)
v_mfma_f32_32x32x16_bf16 v[20:35], a[208:211], v[200:203], v[20:35]
v_mfma_f32_32x32x16_bf16 v[36:51], a[212:215], v[200:203], v[36:51]
s_waitcnt vmcnt(4)
v_mfma_f32_32x32x16_bf16 v[20:35], a[216:219], v[204:207], v[20:35]
v_mfma_f32_32x32x16_bf16 v[36:51], a[220:223], v[204:207], v[36:51]
s_waitcnt vmcnt(3)
v_mfma_f32_32x32x16_bf16 v[20:35], a[224:227], v[208:211], v[20:35]
v_mfma_f32_32x32x16_bf16 v[36:51], a[228:231], v[208:211], v[36:51]
s_waitcnt vmcnt(2)
v_mfma_f32_32x32x16_bf16 v[20:35], a[232:235], v[212:215], v[20:35]
v_mfma_f32_32x32x16_bf16 v[36:51], a[236:239], v[212:215], v[36:51]
s_waitcnt vmcnt(1)
v_mfma_f32_32x32x16_bf16 v[20:35], a[240:243], v[216:219], v[20:35]
v_mfma_f32_32x32x16_bf16 v[36:51], a[244:247], v[216:219], v[36:51]
s_waitcnt vmcnt(0)
v_mfma_f32_32x32x16_bf16 v[224:239], a[248:251], v[220:223], v[20:35]
v_mfma_f32_32x32x16_bf16 v[240:255], a[252:255], v[220:223], v[36:51]
s_branch mega_kernel_o_imm
mega_kernel_o_w1:
s_add_u32 s54, s42, 1
s_sub_u32 s62, s42, 1
s_lshl_b32 s50, s54, 18
s_cmp_gt_i32 s52, s54
s_cbranch_scc0 mega_kernel_o_n1
s_waitcnt vmcnt(31)
v_mfma_f32_32x32x16_bf16 v[20:35], a[0:3], v[96:99], 0
v_mfma_f32_32x32x16_bf16 v[36:51], a[4:7], v[96:99], 0
s_add_u32 s51, s56, 0
s_and_b32 s51, s51, 0x7fff
s_add_u32 s51, s51, s50
buffer_load_dwordx4 v[96:99], v6, s[84:87], s51 offen offset:0 sc1
s_waitcnt vmcnt(31)
v_mfma_f32_32x32x16_bf16 v[20:35], a[8:11], v[100:103], v[20:35]
v_mfma_f32_32x32x16_bf16 v[36:51], a[12:15], v[100:103], v[36:51]
buffer_load_dwordx4 v[100:103], v6, s[84:87], s51 offen offset:1024 sc1
v_add_u32 v2, s53, v8
v_add_u32 v3, s53, v9
v_add_u32 v4, s53, v10
s_waitcnt vmcnt(31)
v_mfma_f32_32x32x16_bf16 v[20:35], a[16:19], v[104:107], v[20:35]
v_mfma_f32_32x32x16_bf16 v[36:51], a[20:23], v[104:107], v[36:51]
buffer_load_dwordx4 v[104:107], v6, s[84:87], s51 offen offset:2048 sc1
ds_write_b128 v2, v[224:227] offset:0
ds_write_b128 v2, v[228:231] offset:1088
s_waitcnt vmcnt(31)
v_mfma_f32_32x32x16_bf16 v[20:35], a[24:27], v[108:111], v[20:35]
v_mfma_f32_32x32x16_bf16 v[36:51], a[28:31], v[108:111], v[36:51]
buffer_load_dwordx4 v[108:111], v6, s[84:87], s51 offen offset:3072 sc1
ds_write_b128 v2, v[232:235] offset:2176
ds_write_b128 v2, v[236:239] offset:3264
s_waitcnt vmcnt(31)
v_mfma_f32_32x32x16_bf16 v[20:35], a[32:35], v[112:115], v[20:35]
v_mfma_f32_32x32x16_bf16 v[36:51], a[36:39], v[112:115], v[36:51]
s_add_u32 s51, s56, 4096
s_and_b32 s51, s51, 0x7fff
s_add_u32 s51, s51, s50
buffer_load_dwordx4 v[112:115], v6, s[84:87], s51 offen offset:0 sc1
ds_write_b128 v2, v[240:243] offset:4352
ds_write_b128 v2, v[244:247] offset:5440
s_waitcnt vmcnt(31)
v_mfma_f32_32x32x16_bf16 v[20:35], a[40:43], v[116:119], v[20:35]
v_mfma_f32_32x32x16_bf16 v[36:51], a[44:47], v[116:119], v[36:51]
buffer_load_dwordx4 v[116:119], v6, s[84:87], s51 offen offset:1024 sc1
ds_write_b128 v2, v[248:251] offset:6528
ds_write_b128 v2, v[252:255] offset:7616
s_waitcnt vmcnt(31)
v_mfma_f32_32x32x16_bf16 v[20:35], a[48:51], v[120:123], v[20:35]
v_mfma_f32_32x32x16_bf16 v[36:51], a[52:55], v[120:123], v[36:51]
buffer_load_dwordx4 v[120:123], v6, s[84:87], s51 offen offset:2048 sc1
s_waitcnt vmcnt(31)
v_mfma_f32_32x32x16_bf16 v[20:35], a[56:59], v[124:127], v[20:35]
v_mfma_f32_32x32x16_bf16 v[36:51], a[60:63], v[124:127], v[36:51]
buffer_load_dwordx4 v[124:127], v6, s[84:87], s51 offen offset:3072 sc1
s_waitcnt lgkmcnt(0)
s_barrier
ds_read_b128 v[52:55], v4 offset:0
ds_read_b128 v[56:59], v4 offset:8704
ds_read_b128 v[60:63], v4 offset:17408
ds_read_b128 v[64:67], v4 offset:26112
s_waitcnt vmcnt(31)
v_mfma_f32_32x32x16_bf16 v[20:35], a[64:67], v[128:131], v[20:35]
v_mfma_f32_32x32x16_bf16 v[36:51], a[68:71], v[128:131], v[36:51]
s_add_u32 s51, s56, 8192
s_and_b32 s51, s51, 0x7fff
s_add_u32 s51, s51, s50
buffer_load_dwordx4 v[128:131], v6, s[84:87], s51 offen offset:0 sc1
ds_read_b128 v[68:71], v3 offset:0
ds_read_b128 v[72:75], v3 offset:8704
ds_read_b128 v[76:79], v3 offset:17408
ds_read_b128 v[80:83], v3 offset:26112
s_sub_u32 s53, 34816, s53
s_bfe_u32 s61, s62, 0x10001
s_xor_b32 s61, s61, s67
s_and_b32 s60, s62, 1
s_lshl_b32 s60, s60, 12
s_waitcnt vmcnt(31)
v_mfma_f32_32x32x16_bf16 v[20:35], a[72:75], v[132:135], v[20:35]
v_mfma_f32_32x32x16_bf16 v[36:51], a[76:79], v[132:135], v[36:51]
buffer_load_dwordx4 v[132:135], v6, s[84:87], s51 offen offset:1024 sc1
s_waitcnt vmcnt(31)
v_mfma_f32_32x32x16_bf16 v[20:35], a[80:83], v[136:139], v[20:35]
v_mfma_f32_32x32x16_bf16 v[36:51], a[84:87], v[136:139], v[36:51]
buffer_load_dwordx4 v[136:139], v6, s[84:87], s51 offen offset:2048 sc1
s_waitcnt lgkmcnt(4)
v_add_f32 v52, v52, v56
v_add_f32 v60, v60, v64
v_add_f32 v53, v53, v57
v_add_f32 v61, v61, v65
v_add_f32 v54, v54, v58
v_add_f32 v62, v62, v66
v_add_f32 v55, v55, v59
v_add_f32 v63, v63, v67
s_waitcnt vmcnt(31)
v_mfma_f32_32x32x16_bf16 v[20:35], a[88:91], v[140:143], v[20:35]
v_mfma_f32_32x32x16_bf16 v[36:51], a[92:95], v[140:143], v[36:51]
buffer_load_dwordx4 v[140:143], v6, s[84:87], s51 offen offset:3072 sc1
v_add_f32 v52, v52, v60
v_add_f32 v53, v53, v61
v_add_f32 v54, v54, v62
v_add_f32 v55, v55, v63
v_and_or_b32 v52, v52, -2, s61
s_cmp_eq_u32 s95, 0
s_cbranch_scc1 mega_kernel_o_sa1
buffer_store_dwordx4 v[52:55], v12, s[84:87], s60 offen sc1
s_branch mega_kernel_o_sb1
mega_kernel_o_sa1:
buffer_store_dwordx4 v[52:55], v12, s[84:87], s60 offen
mega_kernel_o_sb1:
s_waitcnt vmcnt(31)
v_mfma_f32_32x32x16_bf16 v[20:35], a[96:99], v[144:147], v[20:35]
v_mfma_f32_32x32x16_bf16 v[36:51], a[100:103], v[144:147], v[36:51]
s_add_u32 s51, s56, 12288
s_and_b32 s51, s51, 0x7fff
s_add_u32 s51, s51, s50
buffer_load_dwordx4 v[144:147], v6, s[84:87], s51 offen offset:0 sc1
s_waitcnt lgkmcnt(0)
v_add_f32 v68, v68, v72
v_add_f32 v76, v76, v80
v_add_f32 v69, v69, v73
v_add_f32 v77, v77, v81
v_add_f32 v70, v70, v74
v_add_f32 v78, v78, v82
v_add_f32 v71, v71, v75
v_add_f32 v79, v79, v83
s_waitcnt vmcnt(31)
v_mfma_f32_32x32x16_bf16 v[20:35], a[104:107], v[148:151], v[20:35]
v_mfma_f32_32x32x16_bf16 v[36:51], a[108:111], v[148:151], v[36:51]
buffer_load_dwordx4 v[148:151], v6, s[84:87], s51 offen offset:1024 sc1
v_add_f32 v84, v68, v76
v_add_f32 v85, v69, v77
v_add_f32 v86, v70, v78
v_add_f32 v87, v71, v79
s_waitcnt vmcnt(31)
v_mfma_f32_32x32x16_bf16 v[20:35], a[112:115], v[152:155], v[20:35]
v_mfma_f32_32x32x16_bf16 v[36:51], a[116:119], v[152:155], v[36:51]
buffer_load_dwordx4 v[152:155], v6, s[84:87], s51 offen offset:2048 sc1
s_waitcnt vmcnt(31)
v_mfma_f32_32x32x16_bf16 v[20:35], a[120:123], v[156:159], v[20:35]
v_mfma_f32_32x32x16_bf16 v[36:51], a[124:127], v[156:159], v[36:51]
buffer_load_dwordx4 v[156:159], v6, s[84:87], s51 offen offset:3072 sc1
s_waitcnt vmcnt(31)
v_mfma_f32_32x32x16_bf16 v[20:35], a[128:131], v[160:163], v[20:35]
v_mfma_f32_32x32x16_bf16 v[36:51], a[132:135], v[160:163], v[36:51]
s_add_u32 s51, s56, 16384
s_and_b32 s51, s51, 0x7fff
s_add_u32 s51, s51, s50
buffer_load_dwordx4 v[160:163], v6, s[84:87], s51 offen offset:0 sc1
s_waitcnt vmcnt(31)
v_mfma_f32_32x32x16_bf16 v[20:35], a[136:139], v[164:167], v[20:35]
v_mfma_f32_32x32x16_bf16 v[36:51], a[140:143], v[164:167], v[36:51]
buffer_load_dwordx4 v[164:167], v6, s[84:87], s51 offen offset:1024 sc1
s_waitcnt vmcnt(31)
v_mfma_f32_32x32x16_bf16 v[20:35], a[144:147], v[168:171], v[20:35]
v_mfma_f32_32x32x16_bf16 v[36:51], a[148:151], v[168:171], v[36:51]
buffer_load_dwordx4 v[168:171], v6, s[84:87], s51 offen offset:2048 sc1
s_waitcnt vmcnt(31)
v_mfma_f32_32x32x16_bf16 v[20:35], a[152:155], v[172:175], v[20:35]
v_mfma_f32_32x32x16_bf16 v[36:51], a[156:159], v[172:175], v[36:51]
buffer_load_dwordx4 v[172:175], v6, s[84:87], s51 offen offset:3072 sc1
s_waitcnt vmcnt(31)
v_mfma_f32_32x32x16_bf16 v[20:35], a[160:163], v[176:179], v[20:35]
v_mfma_f32_32x32x16_bf16 v[36:51], a[164:167], v[176:179], v[36:51]
s_add_u32 s51, s56, 20480
s_and_b32 s51, s51, 0x7fff
s_add_u32 s51, s51, s50
buffer_load_dwordx4 v[176:179], v6, s[84:87], s51 offen offset:0 sc1
s_waitcnt vmcnt(31)
v_mfma_f32_32x32x16_bf16 v[20:35], a[168:171], v[180:183], v[20:35]
v_mfma_f32_32x32x16_bf16 v[36:51], a[172:175], v[180:183], v[36:51]
buffer_load_dwordx4 v[180:183], v6, s[84:87], s51 offen offset:1024 sc1
s_waitcnt vmcnt(31)
v_mfma_f32_32x32x16_bf16 v[20:35], a[176:179], v[184:187], v[20:35]
v_mfma_f32_32x32x16_bf16 v[36:51], a[180:183], v[184:187], v[36:51]
buffer_load_dwordx4 v[184:187], v6, s[84:87], s51 offen offset:2048 sc1
s_waitcnt vmcnt(31)
v_mfma_f32_32x32x16_bf16 v[20:35], a[184:187], v[188:191], v[20:35]
v_mfma_f32_32x32x16_bf16 v[36:51], a[188:191], v[188:191], v[36:51]
buffer_load_dwordx4 v[188:191], v6, s[84:87], s51 offen offset:3072 sc1
s_waitcnt vmcnt(31)
v_mfma_f32_32x32x16_bf16 v[20:35], a[192:195], v[192:195], v[20:35]
v_mfma_f32_32x32x16_bf16 v[36:51], a[196:199], v[192:195], v[36:51]
s_add_u32 s51, s56, 24576
s_and_b32 s51, s51, 0x7fff
s_add_u32 s51, s51, s50
buffer_load_dwordx4 v[192:195], v6, s[84:87], s51 offen offset:0 sc1
s_waitcnt vmcnt(31)
v_mfma_f32_32x32x16_bf16 v[20:35], a[200:203], v[196:199], v[20:35]
v_mfma_f32_32x32x16_bf16 v[36:51], a[204:207], v[196:199], v[36:51]
buffer_load_dwordx4 v[196:199], v6, s[84:87], s51 offen offset:1024 sc1
s_waitcnt vmcnt(31)
v_mfma_f32_32x32x16_bf16 v[20:35], a[208:211], v[200:203], v[20:35]
v_mfma_f32_32x32x16_bf16 v[36:51], a[212:215], v[200:203], v[36:51]
buffer_load_dwordx4 v[200:203], v6, s[84:87], s51 offen offset:2048 sc1
s_waitcnt vmcnt(31)
v_mfma_f32_32x32x16_bf16 v[20:35], a[216:219], v[204:207], v[20:35]
v_mfma_f32_32x32x16_bf16 v[36:51], a[220:223], v[204:207], v[36:51]
buffer_load_dwordx4 v[204:207], v6, s[84:87], s51 offen offset:3072 sc1
s_and_b32 s60, s62, 1
s_lshl_b32 s60, s60, 12
buffer_load_dwordx4 v[88:91], v13, s[84:87], s60 offen sc1
s_waitcnt vmcnt(31)
v_mfma_f32_32x32x16_bf16 v[20:35], a[224:227], v[208:211], v[20:35]
v_mfma_f32_32x32x16_bf16 v[36:51], a[228:231], v[208:211], v[36:51]
s_add_u32 s51, s56, 28672
s_and_b32 s51, s51, 0x7fff
s_add_u32 s51, s51, s50
buffer_load_dwordx4 v[208:211], v6, s[84:87], s51 offen offset:0 sc1
s_waitcnt vmcnt(31)
v_mfma_f32_32x32x16_bf16 v[20:35], a[232:235], v[212:215], v[20:35]
v_mfma_f32_32x32x16_bf16 v[36:51], a[236:239], v[212:215], v[36:51]
buffer_load_dwordx4 v[212:215], v6, s[84:87], s51 offen offset:1024 sc1
s_waitcnt vmcnt(31)
v_mfma_f32_32x32x16_bf16 v[20:35], a[240:243], v[216:219], v[20:35]
v_mfma_f32_32x32x16_bf16 v[36:51], a[244:247], v[216:219], v[36:51]
buffer_load_dwordx4 v[216:219], v6, s[84:87], s51 offen offset:2048 sc1
s_waitcnt vmcnt(31)
v_mfma_f32_32x32x16_bf16 v[224:239], a[248:251], v[220:223], v[20:35]
v_mfma_f32_32x32x16_bf16 v[240:255], a[252:255], v[220:223], v[36:51]
buffer_load_dwordx4 v[220:223], v6, s[84:87], s51 offen offset:3072 sc1
s_bfe_u32 s61, s62, 0x10001
s_xor_b32 s61, s61, s67
s_waitcnt vmcnt(4)
mega_kernel_o_f1c:
v_and_b32 v14, 1, v88
v_cmp_ne_u32 vcc, s61, v14
s_cbranch_vccz mega_kernel_o_f1k
s_and_b32 s60, s62, 1
s_lshl_b32 s60, s60, 12
buffer_load_dwordx4 v[88:91], v13, s[84:87], s60 offen sc1
s_waitcnt vmcnt(0)
s_branch mega_kernel_o_f1c
mega_kernel_o_f1k:
v_pk_add_f32 v[88:89], v[88:89], v[84:85]
v_pk_add_f32 v[90:91], v[90:91], v[86:87]
s_lshl_b32 s60, s62, 17
v_cvt_pk_bf16_f32 v92, v88, v89
v_cvt_pk_bf16_f32 v93, v90, v91
buffer_store_dwordx2 v[92:93], v11, s[8:11], s60 offen
s_add_u32 s42, s42, 1
s_branch mega_kernel_o_w1
mega_kernel_o_n1:
s_waitcnt vmcnt(31)
v_mfma_f32_32x32x16_bf16 v[20:35], a[0:3], v[96:99], 0
v_mfma_f32_32x32x16_bf16 v[36:51], a[4:7], v[96:99], 0
s_waitcnt vmcnt(30)
v_mfma_f32_32x32x16_bf16 v[20:35], a[8:11], v[100:103], v[20:35]
v_mfma_f32_32x32x16_bf16 v[36:51], a[12:15], v[100:103], v[36:51]
v_add_u32 v2, s53, v8
v_add_u32 v3, s53, v9
v_add_u32 v4, s53, v10
s_waitcnt vmcnt(29)
v_mfma_f32_32x32x16_bf16 v[20:35], a[16:19], v[104:107], v[20:35]
v_mfma_f32_32x32x16_bf16 v[36:51], a[20:23], v[104:107], v[36:51]
ds_write_b128 v2, v[224:227] offset:0
ds_write_b128 v2, v[228:231] offset:1088
s_waitcnt vmcnt(28)
v_mfma_f32_32x32x16_bf16 v[20:35], a[24:27], v[108:111], v[20:35]
v_mfma_f32_32x32x16_bf16 v[36:51], a[28:31], v[108:111], v[36:51]
ds_write_b128 v2, v[232:235] offset:2176
ds_write_b128 v2, v[236:239] offset:3264
s_waitcnt vmcnt(27)
v_mfma_f32_32x32x16_bf16 v[20:35], a[32:35], v[112:115], v[20:35]
v_mfma_f32_32x32x16_bf16 v[36:51], a[36:39], v[112:115], v[36:51]
ds_write_b128 v2, v[240:243] offset:4352
ds_write_b128 v2, v[244:247] offset:5440
s_waitcnt vmcnt(26)
v_mfma_f32_32x32x16_bf16 v[20:35], a[40:43], v[116:119], v[20:35]
v_mfma_f32_32x32x16_bf16 v[36:51], a[44:47], v[116:119], v[36:51]
ds_write_b128 v2, v[248:251] offset:6528
ds_write_b128 v2, v[252:255] offset:7616
s_waitcnt vmcnt(25)
v_mfma_f32_32x32x16_bf16 v[20:35], a[48:51], v[120:123], v[20:35]
v_mfma_f32_32x32x16_bf16 v[36:51], a[52:55], v[120:123], v[36:51]
s_waitcnt vmcnt(24)
v_mfma_f32_32x32x16_bf16 v[20:35], a[56:59], v[124:127], v[20:35]
v_mfma_f32_32x32x16_bf16 v[36:51], a[60:63], v[124:127], v[36:51]
s_waitcnt lgkmcnt(0)
s_barrier
ds_read_b128 v[52:55], v4 offset:0
ds_read_b128 v[56:59], v4 offset:8704
ds_read_b128 v[60:63], v4 offset:17408
ds_read_b128 v[64:67], v4 offset:26112
s_waitcnt vmcnt(23)
v_mfma_f32_32x32x16_bf16 v[20:35], a[64:67], v[128:131], v[20:35]
v_mfma_f32_32x32x16_bf16 v[36:51], a[68:71], v[128:131], v[36:51]
ds_read_b128 v[68:71], v3 offset:0
ds_read_b128 v[72:75], v3 offset:8704
ds_read_b128 v[76:79], v3 offset:17408
ds_read_b128 v[80:83], v3 offset:26112
s_sub_u32 s53, 34816, s53
s_bfe_u32 s61, s62, 0x10001
s_xor_b32 s61, s61, s67
s_and_b32 s60, s62, 1
s_lshl_b32 s60, s60, 12
s_waitcnt vmcnt(22)
v_mfma_f32_32x32x16_bf16 v[20:35], a[72:75], v[132:135], v[20:35]
v_mfma_f32_32x32x16_bf16 v[36:51], a[76:79], v[132:135], v[36:51]
s_waitcnt vmcnt(21)
v_mfma_f32_32x32x16_bf16 v[20:35], a[80:83], v[136:139], v[20:35]
v_mfma_f32_32x32x16_bf16 v[36:51], a[84:87], v[136:139], v[36:51]
s_waitcnt lgkmcnt(4)
v_add_f32 v52, v52, v56
v_add_f32 v60, v60, v64
v_add_f32 v53, v53, v57
v_add_f32 v61, v61, v65
v_add_f32 v54, v54, v58
v_add_f32 v62, v62, v66
v_add_f32 v55, v55, v59
v_add_f32 v63, v63, v67
s_waitcnt vmcnt(20)
v_mfma_f32_32x32x16_bf16 v[20:35], a[88:91], v[140:143], v[20:35]
v_mfma_f32_32x32x16_bf16 v[36:51], a[92:95], v[140:143], v[36:51]
v_add_f32 v52, v52, v60
v_add_f32 v53, v53, v61
v_add_f32 v54, v54, v62
v_add_f32 v55, v55, v63
v_and_or_b32 v52, v52, -2, s61
s_cmp_eq_u32 s95, 0
s_cbranch_scc1 mega_kernel_o_sa2
buffer_store_dwordx4 v[52:55], v12, s[84:87], s60 offen sc1
s_branch mega_kernel_o_sb2
mega_kernel_o_sa2:
buffer_store_dwordx4 v[52:55], v12, s[84:87], s60 offen
mega_kernel_o_sb2:
s_waitcnt vmcnt(19)
v_mfma_f32_32x32x16_bf16 v[20:35], a[96:99], v[144:147], v[20:35]
v_mfma_f32_32x32x16_bf16 v[36:51], a[100:103], v[144:147], v[36:51]
s_waitcnt lgkmcnt(0)
v_add_f32 v68, v68, v72
v_add_f32 v76, v76, v80
v_add_f32 v69, v69, v73
v_add_f32 v77, v77, v81
v_add_f32 v70, v70, v74
v_add_f32 v78, v78, v82
v_add_f32 v71, v71, v75
v_add_f32 v79, v79, v83
s_waitcnt vmcnt(18)
v_mfma_f32_32x32x16_bf16 v[20:35], a[104:107], v[148:151], v[20:35]
v_mfma_f32_32x32x16_bf16 v[36:51], a[108:111], v[148:151], v[36:51]
v_add_f32 v84, v68, v76
v_add_f32 v85, v69, v77
v_add_f32 v86, v70, v78
v_add_f32 v87, v71, v79
s_waitcnt vmcnt(17)
v_mfma_f32_32x32x16_bf16 v[20:35], a[112:115], v[152:155], v[20:35]
v_mfma_f32_32x32x16_bf16 v[36:51], a[116:119], v[152:155], v[36:51]
s_waitcnt vmcnt(16)
v_mfma_f32_32x32x16_bf16 v[20:35], a[120:123], v[156:159], v[20:35]
v_mfma_f32_32x32x16_bf16 v[36:51], a[124:127], v[156:159], v[36:51]
s_waitcnt vmcnt(15)
v_mfma_f32_32x32x16_bf16 v[20:35], a[128:131], v[160:163], v[20:35]
v_mfma_f32_32x32x16_bf16 v[36:51], a[132:135], v[160:163], v[36:51]
s_waitcnt vmcnt(14)
v_mfma_f32_32x32x16_bf16 v[20:35], a[136:139], v[164:167], v[20:35]
v_mfma_f32_32x32x16_bf16 v[36:51], a[140:143], v[164:167], v[36:51]
s_waitcnt vmcnt(13)
v_mfma_f32_32x32x16_bf16 v[20:35], a[144:147], v[168:171], v[20:35]
v_mfma_f32_32x32x16_bf16 v[36:51], a[148:151], v[168:171], v[36:51]
s_waitcnt vmcnt(12)
v_mfma_f32_32x32x16_bf16 v[20:35], a[152:155], v[172:175], v[20:35]
v_mfma_f32_32x32x16_bf16 v[36:51], a[156:159], v[172:175], v[36:51]
s_waitcnt vmcnt(11)
v_mfma_f32_32x32x16_bf16 v[20:35], a[160:163], v[176:179], v[20:35]
v_mfma_f32_32x32x16_bf16 v[36:51], a[164:167], v[176:179], v[36:51]
buffer_load_dword v15, v7, s[84:87], 0 offen sc1
s_waitcnt vmcnt(10)
v_mfma_f32_32x32x16_bf16 v[20:35], a[168:171], v[180:183], v[20:35]
v_mfma_f32_32x32x16_bf16 v[36:51], a[172:175], v[180:183], v[36:51]
s_waitcnt vmcnt(9)
v_mfma_f32_32x32x16_bf16 v[20:35], a[176:179], v[184:187], v[20:35]
v_mfma_f32_32x32x16_bf16 v[36:51], a[180:183], v[184:187], v[36:51]
s_waitcnt vmcnt(8)
v_mfma_f32_32x32x16_bf16 v[20:35], a[184:187], v[188:191], v[20:35]
v_mfma_f32_32x32x16_bf16 v[36:51], a[188:191], v[188:191], v[36:51]
s_waitcnt vmcnt(7)
v_mfma_f32_32x32x16_bf16 v[20:35], a[192:195], v[192:195], v[20:35]
v_mfma_f32_32x32x16_bf16 v[36:51], a[196:199], v[192:195], v[36:51]
s_waitcnt vmcnt(6)
v_mfma_f32_32x32x16_bf16 v[20:35], a[200:203], v[196:199], v[20:35]
v_mfma_f32_32x32x16_bf16 v[36:51], a[204:207], v[196:199], v[36:51]
s_waitcnt vmcnt(5)
v_mfma_f32_32x32x16_bf16 v[20:35], a[208:211], v[200:203], v[20:35]
v_mfma_f32_32x32x16_bf16 v[36:51], a[212:215], v[200:203], v[36:51]
s_waitcnt vmcnt(4)
v_mfma_f32_32x32x16_bf16 v[20:35], a[216:219], v[204:207], v[20:35]
v_mfma_f32_32x32x16_bf16 v[36:51], a[220:223], v[204:207], v[36:51]
s_and_b32 s60, s62, 1
s_lshl_b32 s60, s60, 12
buffer_load_dwordx4 v[88:91], v13, s[84:87], s60 offen sc1
s_waitcnt vmcnt(3)
v_mfma_f32_32x32x16_bf16 v[20:35], a[224:227], v[208:211], v[20:35]
v_mfma_f32_32x32x16_bf16 v[36:51], a[228:231], v[208:211], v[36:51]
s_waitcnt vmcnt(2)
v_mfma_f32_32x32x16_bf16 v[20:35], a[232:235], v[212:215], v[20:35]
v_mfma_f32_32x32x16_bf16 v[36:51], a[236:239], v[212:215], v[36:51]
s_waitcnt vmcnt(1)
v_mfma_f32_32x32x16_bf16 v[20:35], a[240:243], v[216:219], v[20:35]
v_mfma_f32_32x32x16_bf16 v[36:51], a[244:247], v[216:219], v[36:51]
s_waitcnt vmcnt(0)
v_mfma_f32_32x32x16_bf16 v[224:239], a[248:251], v[220:223], v[20:35]
v_mfma_f32_32x32x16_bf16 v[240:255], a[252:255], v[220:223], v[36:51]
s_bfe_u32 s61, s62, 0x10001
s_xor_b32 s61, s61, s67
s_waitcnt vmcnt(0)
mega_kernel_o_f0c:
v_and_b32 v14, 1, v88
v_cmp_ne_u32 vcc, s61, v14
s_cbranch_vccz mega_kernel_o_f0k
s_and_b32 s60, s62, 1
s_lshl_b32 s60, s60, 12
buffer_load_dwordx4 v[88:91], v13, s[84:87], s60 offen sc1
s_waitcnt vmcnt(0)
s_branch mega_kernel_o_f0c
mega_kernel_o_f0k:
v_pk_add_f32 v[88:89], v[88:89], v[84:85]
v_pk_add_f32 v[90:91], v[90:91], v[86:87]
s_lshl_b32 s60, s62, 17
v_cvt_pk_bf16_f32 v92, v88, v89
v_cvt_pk_bf16_f32 v93, v90, v91
buffer_store_dwordx2 v[92:93], v11, s[8:11], s60 offen
mega_kernel_o_imm:
s_waitcnt vmcnt(1)
v_min_i32_dpp v15, v15, v15 quad_perm:[1,0,3,2] row_mask:0xf bank_mask:0xf
s_nop 1
v_min_i32_dpp v15, v15, v15 quad_perm:[2,3,0,1] row_mask:0xf bank_mask:0xf
s_nop 1
v_min_i32_dpp v15, v15, v15 row_ror:4 row_mask:0xf bank_mask:0xf
s_nop 1
v_min_i32_dpp v15, v15, v15 row_ror:8 row_mask:0xf bank_mask:0xf
s_nop 0
v_readfirstlane_b32 s52, v15
s_min_i32 s52, s52, s65
s_cmp_gt_i32 s52, s54
s_cbranch_scc0 mega_kernel_o_im2
s_add_u32 s51, s56, 0
s_and_b32 s51, s51, 0x7fff
s_add_u32 s51, s51, s50
buffer_load_dwordx4 v[96:99], v6, s[84:87], s51 offen offset:0 sc1
buffer_load_dwordx4 v[100:103], v6, s[84:87], s51 offen offset:1024 sc1
buffer_load_dwordx4 v[104:107], v6, s[84:87], s51 offen offset:2048 sc1
buffer_load_dwordx4 v[108:111], v6, s[84:87], s51 offen offset:3072 sc1
s_add_u32 s51, s56, 4096
s_and_b32 s51, s51, 0x7fff
s_add_u32 s51, s51, s50
buffer_load_dwordx4 v[112:115], v6, s[84:87], s51 offen offset:0 sc1
buffer_load_dwordx4 v[116:119], v6, s[84:87], s51 offen offset:1024 sc1
buffer_load_dwordx4 v[120:123], v6, s[84:87], s51 offen offset:2048 sc1
buffer_load_dwordx4 v[124:127], v6, s[84:87], s51 offen offset:3072 sc1
s_add_u32 s51, s56, 8192
s_and_b32 s51, s51, 0x7fff
s_add_u32 s51, s51, s50
buffer_load_dwordx4 v[128:131], v6, s[84:87], s51 offen offset:0 sc1
buffer_load_dwordx4 v[132:135], v6, s[84:87], s51 offen offset:1024 sc1
buffer_load_dwordx4 v[136:139], v6, s[84:87], s51 offen offset:2048 sc1
buffer_load_dwordx4 v[140:143], v6, s[84:87], s51 offen offset:3072 sc1
s_add_u32 s51, s56, 12288
s_and_b32 s51, s51, 0x7fff
s_add_u32 s51, s51, s50
buffer_load_dwordx4 v[144:147], v6, s[84:87], s51 offen offset:0 sc1
buffer_load_dwordx4 v[148:151], v6, s[84:87], s51 offen offset:1024 sc1
buffer_load_dwordx4 v[152:155], v6, s[84:87], s51 offen offset:2048 sc1
buffer_load_dwordx4 v[156:159], v6, s[84:87], s51 offen offset:3072 sc1
s_add_u32 s51, s56, 16384
s_and_b32 s51, s51, 0x7fff
s_add_u32 s51, s51, s50
buffer_load_dwordx4 v[160:163], v6, s[84:87], s51 offen offset:0 sc1
buffer_load_dwordx4 v[164:167], v6, s[84:87], s51 offen offset:1024 sc1
buffer_load_dwordx4 v[168:171], v6, s[84:87], s51 offen offset:2048 sc1
buffer_load_dwordx4 v[172:175], v6, s[84:87], s51 offen offset:3072 sc1
s_add_u32 s51, s56, 20480
s_and_b32 s51, s51, 0x7fff
s_add_u32 s51, s51, s50
buffer_load_dwordx4 v[176:179], v6, s[84:87], s51 offen offset:0 sc1
buffer_load_dwordx4 v[180:183], v6, s[84:87], s51 offen offset:1024 sc1
buffer_load_dwordx4 v[184:187], v6, s[84:87], s51 offen offset:2048 sc1
buffer_load_dwordx4 v[188:191], v6, s[84:87], s51 offen offset:3072 sc1
s_add_u32 s51, s56, 24576
s_and_b32 s51, s51, 0x7fff
s_add_u32 s51, s51, s50
buffer_load_dwordx4 v[192:195], v6, s[84:87], s51 offen offset:0 sc1
buffer_load_dwordx4 v[196:199], v6, s[84:87], s51 offen offset:1024 sc1
buffer_load_dwordx4 v[200:203], v6, s[84:87], s51 offen offset:2048 sc1
buffer_load_dwordx4 v[204:207], v6, s[84:87], s51 offen offset:3072 sc1
s_add_u32 s51, s56, 28672
s_and_b32 s51, s51, 0x7fff
s_add_u32 s51, s51, s50
buffer_load_dwordx4 v[208:211], v6, s[84:87], s51 offen offset:0 sc1
buffer_load_dwordx4 v[212:215], v6, s[84:87], s51 offen offset:1024 sc1
buffer_load_dwordx4 v[216:219], v6, s[84:87], s51 offen offset:2048 sc1
buffer_load_dwordx4 v[220:223], v6, s[84:87], s51 offen offset:3072 sc1
s_add_u32 s42, s42, 1
s_branch mega_kernel_o_w1
mega_kernel_o_im2:
v_add_u32 v2, s53, v8
v_add_u32 v3, s53, v9
v_add_u32 v4, s53, v10
ds_write_b128 v2, v[224:227] offset:0
ds_write_b128 v2, v[228:231] offset:1088
ds_write_b128 v2, v[232:235] offset:2176
ds_write_b128 v2, v[236:239] offset:3264
ds_write_b128 v2, v[240:243] offset:4352
ds_write_b128 v2, v[244:247] offset:5440
ds_write_b128 v2, v[248:251] offset:6528
ds_write_b128 v2, v[252:255] offset:7616
s_waitcnt lgkmcnt(0)
s_barrier
ds_read_b128 v[52:55], v4 offset:0
ds_read_b128 v[56:59], v4 offset:8704
ds_read_b128 v[60:63], v4 offset:17408
ds_read_b128 v[64:67], v4 offset:26112
ds_read_b128 v[68:71], v3 offset:0
ds_read_b128 v[72:75], v3 offset:8704
ds_read_b128 v[76:79], v3 offset:17408
ds_read_b128 v[80:83], v3 offset:26112
s_sub_u32 s53, 34816, s53
s_bfe_u32 s61, s42, 0x10001
s_xor_b32 s61, s61, s67
s_and_b32 s60, s42, 1
s_lshl_b32 s60, s60, 12
s_waitcnt lgkmcnt(4)
v_add_f32 v52, v52, v56
v_add_f32 v60, v60, v64
v_add_f32 v53, v53, v57
v_add_f32 v61, v61, v65
v_add_f32 v54, v54, v58
v_add_f32 v62, v62, v66
v_add_f32 v55, v55, v59
v_add_f32 v63, v63, v67
v_add_f32 v52, v52, v60
v_add_f32 v53, v53, v61
v_add_f32 v54, v54, v62
v_add_f32 v55, v55, v63
v_and_or_b32 v52, v52, -2, s61
s_cmp_eq_u32 s95, 0
s_cbranch_scc1 mega_kernel_o_sa3
buffer_store_dwordx4 v[52:55], v12, s[84:87], s60 offen sc1
s_branch mega_kernel_o_sb3
mega_kernel_o_sa3:
buffer_store_dwordx4 v[52:55], v12, s[84:87], s60 offen
mega_kernel_o_sb3:
s_waitcnt lgkmcnt(0)
v_add_f32 v68, v68, v72
v_add_f32 v76, v76, v80
v_add_f32 v69, v69, v73
v_add_f32 v77, v77, v81
v_add_f32 v70, v70, v74
v_add_f32 v78, v78, v82
v_add_f32 v71, v71, v75
v_add_f32 v79, v79, v83
v_add_f32 v84, v68, v76
v_add_f32 v85, v69, v77
v_add_f32 v86, v70, v78
v_add_f32 v87, v71, v79
s_and_b32 s60, s42, 1
s_lshl_b32 s60, s60, 12
buffer_load_dwordx4 v[88:91], v13, s[84:87], s60 offen sc1
s_bfe_u32 s61, s42, 0x10001
s_xor_b32 s61, s61, s67
s_waitcnt vmcnt(0)
mega_kernel_o_f2c:
v_and_b32 v14, 1, v88
v_cmp_ne_u32 vcc, s61, v14
s_cbranch_vccz mega_kernel_o_f2k
s_and_b32 s60, s42, 1
s_lshl_b32 s60, s60, 12
buffer_load_dwordx4 v[88:91], v13, s[84:87], s60 offen sc1
s_waitcnt vmcnt(0)
s_branch mega_kernel_o_f2c
mega_kernel_o_f2k:
v_pk_add_f32 v[88:89], v[88:89], v[84:85]
v_pk_add_f32 v[90:91], v[90:91], v[86:87]
s_lshl_b32 s60, s42, 17
v_cvt_pk_bf16_f32 v92, v88, v89
v_cvt_pk_bf16_f32 v93, v90, v91
buffer_store_dwordx2 v[92:93], v11, s[8:11], s60 offen
s_add_u32 s42, s42, 1
s_cmp_lt_u32 s42, s65
s_cbranch_scc1 mega_kernel_o_cold
mega_kernel_o_quit:
s_endpgm
mega_kernel_exit:
s_endpgm
mega_kernel_recf:
s_load_dwordx2 s[20:21], s[0:1], 8
s_load_dwordx2 s[16:17], s[0:1], 40
s_load_dwordx2 s[4:5], s[0:1], 16
s_load_dwordx2 s[8:9], s[0:1], 24
s_load_dwordx2 s[12:13], s[0:1], 32
v_lshrrev_b32 v4, 6, v0
v_and_b32 v1, 63, v0
v_readfirstlane_b32 s24, v4
v_lshrrev_b32 v2, 4, v1
v_and_b32 v3, 15, v1
v_lshlrev_b32 v17, 4, v1
s_lshr_b32 s28, s31, 2
s_lshl_b32 s25, s30, 3
s_add_u32 s25, s25, s28
s_and_b32 s26, s31, 3
s_waitcnt lgkmcnt(0)
s_mov_b32 s22, 16384
s_mov_b32 s23, 0x00020000
s_mov_b32 s18, 8388608
s_mov_b32 s19, 0x00020000
s_mov_b32 s6, 8388608
s_mov_b32 s7, 0x00020000
s_mov_b32 s10, 8388608
s_mov_b32 s11, 0x00020000
s_mov_b32 s14, 8388608
s_mov_b32 s15, 0x00020000
s_lshl_b32 s28, s25, 8
s_lshr_b32 s29, s26, 0
s_lshl_b32 s29, s29, 6
s_add_u32 s28, s28, s29
s_lshl_b32 s29, s24, 21
s_add_u32 s28, s28, s29
v_lshrrev_b32 v4, 2, v1
v_and_b32 v5, 3, v1
v_lshlrev_b32 v40, 13, v4
v_lshl_add_u32 v40, v5, 4, v40
v_add_u32 v40, s28, v40
s_lshl_b32 s28, s30, 21
s_lshl_b32 s29, s24, 19
s_add_u32 s28, s28, s29
s_lshr_b32 s29, s31, 0
s_lshl_b32 s29, s29, 6
s_add_u32 s28, s28, s29
v_lshlrev_b32 v41, 11, v4
v_lshl_add_u32 v41, v5, 4, v41
v_add_u32 v41, s28, v41
s_lshl_b32 s47, s24, 15
s_add_u32 s47, s47, 32768
s_lshl_b32 s28, s31, 18
s_lshl_b32 s29, s24, 16
s_add_u32 s28, s28, s29
s_lshl_b32 s29, s30, 11
s_add_u32 s28, s28, s29
v_lshlrev_b32 v48, 13, v2
v_lshl_add_u32 v48, v3, 7, v48
v_add_u32 v48, s28, v48
s_lshl_b32 s28, s30, 21
s_lshl_b32 s29, s31, 16
s_add_u32 s28, s28, s29
s_lshl_b32 s29, s24, 14
s_add_u32 s28, s28, s29
v_lshlrev_b32 v49, 7, v1
v_add_u32 v49, s28, v49
s_and_b32 s76, s31, 1
s_mul_i32 s76, s76, 8
s_and_b32 s28, s31, 15
s_lshl_b32 s28, s28, 4
s_lshl_b32 s29, s24, 8
s_add_u32 s28, s28, s29
v_add_u32 v53, s28, v3
s_lshr_b32 s28, s31, 4
s_lshl_b32 s28, s28, 10
s_add_u32 s28, s28, 384
v_mov_b32 v54, s28
v_mov_b32 v55, 1920
v_cmp_gt_u32 vcc, 32, v1
s_nop 1
v_cndmask_b32 v54, v55, v54, vcc
s_lshl_b32 s29, s30, 11
v_lshl_add_u32 v51, v53, 13, v54
v_add_u32 v51, s29, v51
s_lshl_b32 s29, s30, 21
v_lshl_add_u32 v52, v53, 11, v54
v_add_u32 v52, s29, v52
buffer_load_dword v50, v51, s[4:7], 0 offen
s_xor_b32 s29, s76, 0
s_lshl_b32 s28, s29, 10
s_add_u32 s28, s28, s47
s_add_u32 m0, s28, 0
s_lshl_b32 s29, s29, 17
buffer_load_dwordx4 v40, s[4:7], s29 offen lds
s_xor_b32 s29, s76, 1
s_lshl_b32 s28, s29, 10
s_add_u32 s28, s28, s47
s_add_u32 m0, s28, 0
s_lshl_b32 s29, s29, 17
buffer_load_dwordx4 v40, s[4:7], s29 offen lds
s_xor_b32 s29, s76, 2
s_lshl_b32 s28, s29, 10
s_add_u32 s28, s28, s47
s_add_u32 m0, s28, 0
s_lshl_b32 s29, s29, 17
buffer_load_dwordx4 v40, s[4:7], s29 offen lds
s_xor_b32 s29, s76, 3
s_lshl_b32 s28, s29, 10
s_add_u32 s28, s28, s47
s_add_u32 m0, s28, 0
s_lshl_b32 s29, s29, 17
buffer_load_dwordx4 v40, s[4:7], s29 offen lds
s_xor_b32 s29, s76, 4
s_lshl_b32 s28, s29, 10
s_add_u32 s28, s28, s47
s_add_u32 m0, s28, 0
s_lshl_b32 s29, s29, 17
buffer_load_dwordx4 v40, s[4:7], s29 offen lds
s_xor_b32 s29, s76, 5
s_lshl_b32 s28, s29, 10
s_add_u32 s28, s28, s47
s_add_u32 m0, s28, 0
s_lshl_b32 s29, s29, 17
buffer_load_dwordx4 v40, s[4:7], s29 offen lds
s_xor_b32 s29, s76, 6
s_lshl_b32 s28, s29, 10
s_add_u32 s28, s28, s47
s_add_u32 m0, s28, 0
s_lshl_b32 s29, s29, 17
buffer_load_dwordx4 v40, s[4:7], s29 offen lds
s_xor_b32 s29, s76, 7
s_lshl_b32 s28, s29, 10
s_add_u32 s28, s28, s47
s_add_u32 m0, s28, 0
s_lshl_b32 s29, s29, 17
buffer_load_dwordx4 v40, s[4:7], s29 offen lds
s_xor_b32 s29, s76, 8
s_lshl_b32 s28, s29, 10
s_add_u32 s28, s28, s47
s_add_u32 m0, s28, 0
s_lshl_b32 s29, s29, 17
buffer_load_dwordx4 v40, s[4:7], s29 offen lds
s_xor_b32 s29, s76, 9
s_lshl_b32 s28, s29, 10
s_add_u32 s28, s28, s47
s_add_u32 m0, s28, 0
s_lshl_b32 s29, s29, 17
buffer_load_dwordx4 v40, s[4:7], s29 offen lds
s_xor_b32 s29, s76, 10
s_lshl_b32 s28, s29, 10
s_add_u32 s28, s28, s47
s_add_u32 m0, s28, 0
s_lshl_b32 s29, s29, 17
buffer_load_dwordx4 v40, s[4:7], s29 offen lds
s_xor_b32 s29, s76, 11
s_lshl_b32 s28, s29, 10
s_add_u32 s28, s28, s47
s_add_u32 m0, s28, 0
s_lshl_b32 s29, s29, 17
buffer_load_dwordx4 v40, s[4:7], s29 offen lds
s_xor_b32 s29, s76, 12
s_lshl_b32 s28, s29, 10
s_add_u32 s28, s28, s47
s_add_u32 m0, s28, 0
s_lshl_b32 s29, s29, 17
buffer_load_dwordx4 v40, s[4:7], s29 offen lds
s_xor_b32 s29, s76, 13
s_lshl_b32 s28, s29, 10
s_add_u32 s28, s28, s47
s_add_u32 m0, s28, 0
s_lshl_b32 s29, s29, 17
buffer_load_dwordx4 v40, s[4:7], s29 offen lds
s_xor_b32 s29, s76, 14
s_lshl_b32 s28, s29, 10
s_add_u32 s28, s28, s47
s_add_u32 m0, s28, 0
s_lshl_b32 s29, s29, 17
buffer_load_dwordx4 v40, s[4:7], s29 offen lds
s_xor_b32 s29, s76, 15
s_lshl_b32 s28, s29, 10
s_add_u32 s28, s28, s47
s_add_u32 m0, s28, 0
s_lshl_b32 s29, s29, 17
buffer_load_dwordx4 v40, s[4:7], s29 offen lds
buffer_load_dword v50, v51, s[8:11], 0 offen
s_xor_b32 s29, s76, 0
s_lshl_b32 s28, s29, 10
s_add_u32 s28, s28, s47
s_add_u32 m0, s28, 16384
s_lshl_b32 s29, s29, 17
buffer_load_dwordx4 v40, s[8:11], s29 offen lds
s_xor_b32 s29, s76, 1
s_lshl_b32 s28, s29, 10
s_add_u32 s28, s28, s47
s_add_u32 m0, s28, 16384
s_lshl_b32 s29, s29, 17
buffer_load_dwordx4 v40, s[8:11], s29 offen lds
s_xor_b32 s29, s76, 2
s_lshl_b32 s28, s29, 10
s_add_u32 s28, s28, s47
s_add_u32 m0, s28, 16384
s_lshl_b32 s29, s29, 17
buffer_load_dwordx4 v40, s[8:11], s29 offen lds
s_xor_b32 s29, s76, 3
s_lshl_b32 s28, s29, 10
s_add_u32 s28, s28, s47
s_add_u32 m0, s28, 16384
s_lshl_b32 s29, s29, 17
buffer_load_dwordx4 v40, s[8:11], s29 offen lds
s_xor_b32 s29, s76, 4
s_lshl_b32 s28, s29, 10
s_add_u32 s28, s28, s47
s_add_u32 m0, s28, 16384
s_lshl_b32 s29, s29, 17
buffer_load_dwordx4 v40, s[8:11], s29 offen lds
s_xor_b32 s29, s76, 5
s_lshl_b32 s28, s29, 10
s_add_u32 s28, s28, s47
s_add_u32 m0, s28, 16384
s_lshl_b32 s29, s29, 17
buffer_load_dwordx4 v40, s[8:11], s29 offen lds
s_xor_b32 s29, s76, 6
s_lshl_b32 s28, s29, 10
s_add_u32 s28, s28, s47
s_add_u32 m0, s28, 16384
s_lshl_b32 s29, s29, 17
buffer_load_dwordx4 v40, s[8:11], s29 offen lds
s_xor_b32 s29, s76, 7
s_lshl_b32 s28, s29, 10
s_add_u32 s28, s28, s47
s_add_u32 m0, s28, 16384
s_lshl_b32 s29, s29, 17
buffer_load_dwordx4 v40, s[8:11], s29 offen lds
s_xor_b32 s29, s76, 8
s_lshl_b32 s28, s29, 10
s_add_u32 s28, s28, s47
s_add_u32 m0, s28, 16384
s_lshl_b32 s29, s29, 17
buffer_load_dwordx4 v40, s[8:11], s29 offen lds
s_xor_b32 s29, s76, 9
s_lshl_b32 s28, s29, 10
s_add_u32 s28, s28, s47
s_add_u32 m0, s28, 16384
s_lshl_b32 s29, s29, 17
buffer_load_dwordx4 v40, s[8:11], s29 offen lds
s_xor_b32 s29, s76, 10
s_lshl_b32 s28, s29, 10
s_add_u32 s28, s28, s47
s_add_u32 m0, s28, 16384
s_lshl_b32 s29, s29, 17
buffer_load_dwordx4 v40, s[8:11], s29 offen lds
s_xor_b32 s29, s76, 11
s_lshl_b32 s28, s29, 10
s_add_u32 s28, s28, s47
s_add_u32 m0, s28, 16384
s_lshl_b32 s29, s29, 17
buffer_load_dwordx4 v40, s[8:11], s29 offen lds
s_xor_b32 s29, s76, 12
s_lshl_b32 s28, s29, 10
s_add_u32 s28, s28, s47
s_add_u32 m0, s28, 16384
s_lshl_b32 s29, s29, 17
buffer_load_dwordx4 v40, s[8:11], s29 offen lds
s_xor_b32 s29, s76, 13
s_lshl_b32 s28, s29, 10
s_add_u32 s28, s28, s47
s_add_u32 m0, s28, 16384
s_lshl_b32 s29, s29, 17
buffer_load_dwordx4 v40, s[8:11], s29 offen lds
s_xor_b32 s29, s76, 14
s_lshl_b32 s28, s29, 10
s_add_u32 s28, s28, s47
s_add_u32 m0, s28, 16384
s_lshl_b32 s29, s29, 17
buffer_load_dwordx4 v40, s[8:11], s29 offen lds
s_xor_b32 s29, s76, 15
s_lshl_b32 s28, s29, 10
s_add_u32 s28, s28, s47
s_add_u32 m0, s28, 16384
s_lshl_b32 s29, s29, 17
buffer_load_dwordx4 v40, s[8:11], s29 offen lds
s_mov_b32 s40, 0x00ff00ff
s_mov_b32 s41, 0x00ff00ff
s_mov_b32 s48, 0xff00ff00
s_mov_b32 s49, 0xff00ff00
s_mov_b32 s42, 0
s_mov_b32 s43, 0x00ff00ff
s_mov_b32 s32, 0x3e0293ee
v_mov_b32 v23, 0xff7fffff
v_mov_b32 v6, 0x4444
v_mov_b32 v4, 0xeeee
v_cndmask_b32 v6, v6, v4, s[48:49]
v_mov_b32 v28, -1
v_mov_b32 v29, -1
v_mov_b32 v30, -1
v_mov_b32 v31, -1
s_lshl_b32 s28, s24, 12
v_add_u32 v7, s28, v17
v_and_b32 v4, 7, v1
v_lshlrev_b32 v8, 11, v4
v_lshrrev_b32 v5, 3, v1
v_lshl_add_u32 v8, v5, 4, v8
s_lshl_b32 s28, s24, 9
v_add_u32 v8, s28, v8
s_lshl_b32 s28, s31, 9
v_lshlrev_b32 v9, 3, v1
v_add_u32 v9, s28, v9
v_and_b32 v4, 7, v3
v_lshlrev_b32 v11, 7, v2
v_lshl_add_u32 v11, v4, 4, v11
v_add_u32 v22, 0, v11
s_add_u32 s28, s28, 16384
v_add_u32 v11, s28, v11
v_and_b32 v5, 1, v2
v_lshlrev_b32 v10, 7, v5
v_lshl_add_u32 v10, v4, 4, v10
v_add_u32 v10, 1024, v10
s_xor_b32 s37, s31, 1
s_lshl_b32 s37, s37, 11
s_add_u32 s37, s37, 32768
s_xor_b32 s38, s31, 2
s_lshl_b32 s38, s38, 11
s_add_u32 s38, s38, 32768
s_xor_b32 s39, s31, 3
s_lshl_b32 s39, s39, 11
s_add_u32 s39, s39, 32768
v_and_b32 v4, 1, v2
v_mul_u32_u24 v14, 576, v4
v_lshrrev_b32 v5, 1, v2
v_lshl_add_u32 v5, v5, 4, v3
v_lshl_add_u32 v14, v5, 2, v14
s_mul_i32 s28, s24, 1152
s_add_u32 s28, s28, 13312
v_add_u32 v18, s28, v14
s_mul_i32 s28, s24, 2304
v_add_u32 v14, s28, v14
v_add_u32 v15, 1152, v14
v_mul_u32_u24 v16, 144, v3
v_lshl_add_u32 v16, v2, 5, v16
v_bfe_u32 v4, v1, 1, 3
v_mul_u32_u24 v19, 144, v4
v_lshl_add_u32 v19, v2, 5, v19
v_and_b32 v4, 1, v1
v_lshl_add_u32 v19, v4, 4, v19
v_add_u32 v19, 13312, v19
s_lshl_b32 s28, s24, 10
s_add_u32 s28, s28, 9216
v_add_u32 v20, s28, v17
v_and_b32 v4, 31, v1
v_lshlrev_b32 v21, 3, v4
v_add_u32 v21, 17920, v21
v_lshrrev_b32 v4, 2, v3
v_and_b32 v42, 1, v4
v_lshrrev_b32 v43, 1, v4
v_lshrrev_b32 v44, 1, v2
v_and_b32 v45, 1, v2
v_lshl_add_u32 v46, v44, 4, v42
v_lshl_add_u32 v46, v45, 2, v46
v_lshl_add_u32 v46, v43, 3, v46
v_lshl_add_u32 v47, v44, 3, v42
v_lshl_add_u32 v47, v45, 4, v47
v_lshl_add_u32 v47, v43, 2, v47
v_and_b32 v5, 3, v3
v_lshlrev_b32 v5, 3, v5
v_lshl_add_u32 v46, v46, 6, v5
v_lshl_add_u32 v47, v47, 6, v5
s_and_b32 s28, s31, 0
s_lshl_b32 s28, s28, 6
s_add_u32 s28, s28, s47
v_add_u32 v46, s28, v46
v_add_u32 v47, s28, v47
s_waitcnt vmcnt(17)
ds_read_b64_tr_b16 a[0:1], v46 offset:0
ds_read_b64_tr_b16 a[2:3], v46 offset:128
ds_read_b64_tr_b16 a[4:5], v46 offset:2048
ds_read_b64_tr_b16 a[6:7], v46 offset:2176
ds_read_b64_tr_b16 a[8:9], v46 offset:4096
ds_read_b64_tr_b16 a[10:11], v46 offset:4224
ds_read_b64_tr_b16 a[12:13], v46 offset:6144
ds_read_b64_tr_b16 a[14:15], v46 offset:6272
s_waitcnt lgkmcnt(0)
ds_read_b64_tr_b16 a[16:17], v46 offset:8192
ds_read_b64_tr_b16 a[18:19], v46 offset:8320
ds_read_b64_tr_b16 a[20:21], v46 offset:10240
ds_read_b64_tr_b16 a[22:23], v46 offset:10368
ds_read_b64_tr_b16 a[24:25], v46 offset:12288
ds_read_b64_tr_b16 a[26:27], v46 offset:12416
ds_read_b64_tr_b16 a[28:29], v46 offset:14336
ds_read_b64_tr_b16 a[30:31], v46 offset:14464
s_waitcnt lgkmcnt(0)
ds_read_b64_tr_b16 a[32:33], v46 offset:32
ds_read_b64_tr_b16 a[34:35], v46 offset:160
ds_read_b64_tr_b16 a[36:37], v46 offset:2080
ds_read_b64_tr_b16 a[38:39], v46 offset:2208
ds_read_b64_tr_b16 a[40:41], v46 offset:4128
ds_read_b64_tr_b16 a[42:43], v46 offset:4256
ds_read_b64_tr_b16 a[44:45], v46 offset:6176
ds_read_b64_tr_b16 a[46:47], v46 offset:6304
s_waitcnt lgkmcnt(0)
ds_read_b64_tr_b16 a[48:49], v46 offset:8224
ds_read_b64_tr_b16 a[50:51], v46 offset:8352
ds_read_b64_tr_b16 a[52:53], v46 offset:10272
ds_read_b64_tr_b16 a[54:55], v46 offset:10400
ds_read_b64_tr_b16 a[56:57], v46 offset:12320
ds_read_b64_tr_b16 a[58:59], v46 offset:12448
ds_read_b64_tr_b16 a[60:61], v46 offset:14368
ds_read_b64_tr_b16 a[62:63], v46 offset:14496
s_waitcnt lgkmcnt(0)
buffer_load_dword v50, v51, s[12:15], 0 offen
s_xor_b32 s29, s76, 0
s_lshl_b32 s28, s29, 10
s_add_u32 s28, s28, s47
s_add_u32 m0, s28, 0
s_lshl_b32 s29, s29, 17
buffer_load_dwordx4 v40, s[12:15], s29 offen lds
s_xor_b32 s29, s76, 1
s_lshl_b32 s28, s29, 10
s_add_u32 s28, s28, s47
s_add_u32 m0, s28, 0
s_lshl_b32 s29, s29, 17
buffer_load_dwordx4 v40, s[12:15], s29 offen lds
s_xor_b32 s29, s76, 2
s_lshl_b32 s28, s29, 10
s_add_u32 s28, s28, s47
s_add_u32 m0, s28, 0
s_lshl_b32 s29, s29, 17
buffer_load_dwordx4 v40, s[12:15], s29 offen lds
s_xor_b32 s29, s76, 3
s_lshl_b32 s28, s29, 10
s_add_u32 s28, s28, s47
s_add_u32 m0, s28, 0
s_lshl_b32 s29, s29, 17
buffer_load_dwordx4 v40, s[12:15], s29 offen lds
s_xor_b32 s29, s76, 4
s_lshl_b32 s28, s29, 10
s_add_u32 s28, s28, s47
s_add_u32 m0, s28, 0
s_lshl_b32 s29, s29, 17
buffer_load_dwordx4 v40, s[12:15], s29 offen lds
s_xor_b32 s29, s76, 5
s_lshl_b32 s28, s29, 10
s_add_u32 s28, s28, s47
s_add_u32 m0, s28, 0
s_lshl_b32 s29, s29, 17
buffer_load_dwordx4 v40, s[12:15], s29 offen lds
s_xor_b32 s29, s76, 6
s_lshl_b32 s28, s29, 10
s_add_u32 s28, s28, s47
s_add_u32 m0, s28, 0
s_lshl_b32 s29, s29, 17
buffer_load_dwordx4 v40, s[12:15], s29 offen lds
s_xor_b32 s29, s76, 7
s_lshl_b32 s28, s29, 10
s_add_u32 s28, s28, s47
s_add_u32 m0, s28, 0
s_lshl_b32 s29, s29, 17
buffer_load_dwordx4 v40, s[12:15], s29 offen lds
s_xor_b32 s29, s76, 8
s_lshl_b32 s28, s29, 10
s_add_u32 s28, s28, s47
s_add_u32 m0, s28, 0
s_lshl_b32 s29, s29, 17
buffer_load_dwordx4 v40, s[12:15], s29 offen lds
s_xor_b32 s29, s76, 9
s_lshl_b32 s28, s29, 10
s_add_u32 s28, s28, s47
s_add_u32 m0, s28, 0
s_lshl_b32 s29, s29, 17
buffer_load_dwordx4 v40, s[12:15], s29 offen lds
s_xor_b32 s29, s76, 10
s_lshl_b32 s28, s29, 10
s_add_u32 s28, s28, s47
s_add_u32 m0, s28, 0
s_lshl_b32 s29, s29, 17
buffer_load_dwordx4 v40, s[12:15], s29 offen lds
s_xor_b32 s29, s76, 11
s_lshl_b32 s28, s29, 10
s_add_u32 s28, s28, s47
s_add_u32 m0, s28, 0
s_lshl_b32 s29, s29, 17
buffer_load_dwordx4 v40, s[12:15], s29 offen lds
s_xor_b32 s29, s76, 12
s_lshl_b32 s28, s29, 10
s_add_u32 s28, s28, s47
s_add_u32 m0, s28, 0
s_lshl_b32 s29, s29, 17
buffer_load_dwordx4 v40, s[12:15], s29 offen lds
s_xor_b32 s29, s76, 13
s_lshl_b32 s28, s29, 10
s_add_u32 s28, s28, s47
s_add_u32 m0, s28, 0
s_lshl_b32 s29, s29, 17
buffer_load_dwordx4 v40, s[12:15], s29 offen lds
s_xor_b32 s29, s76, 14
s_lshl_b32 s28, s29, 10
s_add_u32 s28, s28, s47
s_add_u32 m0, s28, 0
s_lshl_b32 s29, s29, 17
buffer_load_dwordx4 v40, s[12:15], s29 offen lds
s_xor_b32 s29, s76, 15
s_lshl_b32 s28, s29, 10
s_add_u32 s28, s28, s47
s_add_u32 m0, s28, 0
s_lshl_b32 s29, s29, 17
buffer_load_dwordx4 v40, s[12:15], s29 offen lds
s_waitcnt vmcnt(17)
ds_read_b64_tr_b16 a[64:65], v46 offset:16384
ds_read_b64_tr_b16 a[66:67], v46 offset:16512
ds_read_b64_tr_b16 a[68:69], v46 offset:18432
ds_read_b64_tr_b16 a[70:71], v46 offset:18560
ds_read_b64_tr_b16 a[72:73], v46 offset:20480
ds_read_b64_tr_b16 a[74:75], v46 offset:20608
ds_read_b64_tr_b16 a[76:77], v46 offset:22528
ds_read_b64_tr_b16 a[78:79], v46 offset:22656
s_waitcnt lgkmcnt(0)
ds_read_b64_tr_b16 a[80:81], v46 offset:24576
ds_read_b64_tr_b16 a[82:83], v46 offset:24704
ds_read_b64_tr_b16 a[84:85], v46 offset:26624
ds_read_b64_tr_b16 a[86:87], v46 offset:26752
ds_read_b64_tr_b16 a[88:89], v46 offset:28672
ds_read_b64_tr_b16 a[90:91], v46 offset:28800
ds_read_b64_tr_b16 a[92:93], v46 offset:30720
ds_read_b64_tr_b16 a[94:95], v46 offset:30848
s_waitcnt lgkmcnt(0)
ds_read_b64_tr_b16 a[96:97], v46 offset:16416
ds_read_b64_tr_b16 a[98:99], v46 offset:16544
ds_read_b64_tr_b16 a[100:101], v46 offset:18464
ds_read_b64_tr_b16 a[102:103], v46 offset:18592
ds_read_b64_tr_b16 a[104:105], v46 offset:20512
ds_read_b64_tr_b16 a[106:107], v46 offset:20640
ds_read_b64_tr_b16 a[108:109], v46 offset:22560
ds_read_b64_tr_b16 a[110:111], v46 offset:22688
s_waitcnt lgkmcnt(0)
ds_read_b64_tr_b16 a[112:113], v46 offset:24608
ds_read_b64_tr_b16 a[114:115], v46 offset:24736
ds_read_b64_tr_b16 a[116:117], v46 offset:26656
ds_read_b64_tr_b16 a[118:119], v46 offset:26784
ds_read_b64_tr_b16 a[120:121], v46 offset:28704
ds_read_b64_tr_b16 a[122:123], v46 offset:28832
ds_read_b64_tr_b16 a[124:125], v46 offset:30752
ds_read_b64_tr_b16 a[126:127], v46 offset:30880
s_waitcnt lgkmcnt(0)
buffer_load_dword v50, v52, s[16:19], 0 offen
s_xor_b32 s29, s76, 0
s_lshl_b32 s28, s29, 10
s_add_u32 s28, s28, s47
s_add_u32 m0, s28, 16384
s_lshl_b32 s29, s29, 15
buffer_load_dwordx4 v41, s[16:19], s29 offen lds
s_xor_b32 s29, s76, 1
s_lshl_b32 s28, s29, 10
s_add_u32 s28, s28, s47
s_add_u32 m0, s28, 16384
s_lshl_b32 s29, s29, 15
buffer_load_dwordx4 v41, s[16:19], s29 offen lds
s_xor_b32 s29, s76, 2
s_lshl_b32 s28, s29, 10
s_add_u32 s28, s28, s47
s_add_u32 m0, s28, 16384
s_lshl_b32 s29, s29, 15
buffer_load_dwordx4 v41, s[16:19], s29 offen lds
s_xor_b32 s29, s76, 3
s_lshl_b32 s28, s29, 10
s_add_u32 s28, s28, s47
s_add_u32 m0, s28, 16384
s_lshl_b32 s29, s29, 15
buffer_load_dwordx4 v41, s[16:19], s29 offen lds
s_xor_b32 s29, s76, 4
s_lshl_b32 s28, s29, 10
s_add_u32 s28, s28, s47
s_add_u32 m0, s28, 16384
s_lshl_b32 s29, s29, 15
buffer_load_dwordx4 v41, s[16:19], s29 offen lds
s_xor_b32 s29, s76, 5
s_lshl_b32 s28, s29, 10
s_add_u32 s28, s28, s47
s_add_u32 m0, s28, 16384
s_lshl_b32 s29, s29, 15
buffer_load_dwordx4 v41, s[16:19], s29 offen lds
s_xor_b32 s29, s76, 6
s_lshl_b32 s28, s29, 10
s_add_u32 s28, s28, s47
s_add_u32 m0, s28, 16384
s_lshl_b32 s29, s29, 15
buffer_load_dwordx4 v41, s[16:19], s29 offen lds
s_xor_b32 s29, s76, 7
s_lshl_b32 s28, s29, 10
s_add_u32 s28, s28, s47
s_add_u32 m0, s28, 16384
s_lshl_b32 s29, s29, 15
buffer_load_dwordx4 v41, s[16:19], s29 offen lds
s_xor_b32 s29, s76, 8
s_lshl_b32 s28, s29, 10
s_add_u32 s28, s28, s47
s_add_u32 m0, s28, 16384
s_lshl_b32 s29, s29, 15
buffer_load_dwordx4 v41, s[16:19], s29 offen lds
s_xor_b32 s29, s76, 9
s_lshl_b32 s28, s29, 10
s_add_u32 s28, s28, s47
s_add_u32 m0, s28, 16384
s_lshl_b32 s29, s29, 15
buffer_load_dwordx4 v41, s[16:19], s29 offen lds
s_xor_b32 s29, s76, 10
s_lshl_b32 s28, s29, 10
s_add_u32 s28, s28, s47
s_add_u32 m0, s28, 16384
s_lshl_b32 s29, s29, 15
buffer_load_dwordx4 v41, s[16:19], s29 offen lds
s_xor_b32 s29, s76, 11
s_lshl_b32 s28, s29, 10
s_add_u32 s28, s28, s47
s_add_u32 m0, s28, 16384
s_lshl_b32 s29, s29, 15
buffer_load_dwordx4 v41, s[16:19], s29 offen lds
s_xor_b32 s29, s76, 12
s_lshl_b32 s28, s29, 10
s_add_u32 s28, s28, s47
s_add_u32 m0, s28, 16384
s_lshl_b32 s29, s29, 15
buffer_load_dwordx4 v41, s[16:19], s29 offen lds
s_xor_b32 s29, s76, 13
s_lshl_b32 s28, s29, 10
s_add_u32 s28, s28, s47
s_add_u32 m0, s28, 16384
s_lshl_b32 s29, s29, 15
buffer_load_dwordx4 v41, s[16:19], s29 offen lds
s_xor_b32 s29, s76, 14
s_lshl_b32 s28, s29, 10
s_add_u32 s28, s28, s47
s_add_u32 m0, s28, 16384
s_lshl_b32 s29, s29, 15
buffer_load_dwordx4 v41, s[16:19], s29 offen lds
s_xor_b32 s29, s76, 15
s_lshl_b32 s28, s29, 10
s_add_u32 s28, s28, s47
s_add_u32 m0, s28, 16384
s_lshl_b32 s29, s29, 15
buffer_load_dwordx4 v41, s[16:19], s29 offen lds
s_waitcnt vmcnt(17)
ds_read_b64_tr_b16 a[128:129], v46 offset:0
ds_read_b64_tr_b16 a[130:131], v46 offset:128
ds_read_b64_tr_b16 a[132:133], v46 offset:2048
ds_read_b64_tr_b16 a[134:135], v46 offset:2176
ds_read_b64_tr_b16 a[136:137], v46 offset:4096
ds_read_b64_tr_b16 a[138:139], v46 offset:4224
ds_read_b64_tr_b16 a[140:141], v46 offset:6144
ds_read_b64_tr_b16 a[142:143], v46 offset:6272
s_waitcnt lgkmcnt(0)
ds_read_b64_tr_b16 a[144:145], v46 offset:8192
ds_read_b64_tr_b16 a[146:147], v46 offset:8320
ds_read_b64_tr_b16 a[148:149], v46 offset:10240
ds_read_b64_tr_b16 a[150:151], v46 offset:10368
ds_read_b64_tr_b16 a[152:153], v46 offset:12288
ds_read_b64_tr_b16 a[154:155], v46 offset:12416
ds_read_b64_tr_b16 a[156:157], v46 offset:14336
ds_read_b64_tr_b16 a[158:159], v46 offset:14464
s_waitcnt lgkmcnt(0)
ds_read_b64_tr_b16 a[160:161], v46 offset:32
ds_read_b64_tr_b16 a[162:163], v46 offset:160
ds_read_b64_tr_b16 a[164:165], v46 offset:2080
ds_read_b64_tr_b16 a[166:167], v46 offset:2208
ds_read_b64_tr_b16 a[168:169], v46 offset:4128
ds_read_b64_tr_b16 a[170:171], v46 offset:4256
ds_read_b64_tr_b16 a[172:173], v46 offset:6176
ds_read_b64_tr_b16 a[174:175], v46 offset:6304
s_waitcnt lgkmcnt(0)
ds_read_b64_tr_b16 a[176:177], v46 offset:8224
ds_read_b64_tr_b16 a[178:179], v46 offset:8352
ds_read_b64_tr_b16 a[180:181], v46 offset:10272
ds_read_b64_tr_b16 a[182:183], v46 offset:10400
ds_read_b64_tr_b16 a[184:185], v46 offset:12320
ds_read_b64_tr_b16 a[186:187], v46 offset:12448
ds_read_b64_tr_b16 a[188:189], v46 offset:14368
ds_read_b64_tr_b16 a[190:191], v46 offset:14496
s_waitcnt lgkmcnt(0)
s_waitcnt vmcnt(0)
ds_read_b64_tr_b16 a[192:193], v47 offset:16384
ds_read_b64_tr_b16 a[194:195], v47 offset:16512
ds_read_b64_tr_b16 a[196:197], v47 offset:18432
ds_read_b64_tr_b16 a[198:199], v47 offset:18560
ds_read_b64_tr_b16 a[200:201], v47 offset:20480
ds_read_b64_tr_b16 a[202:203], v47 offset:20608
ds_read_b64_tr_b16 a[204:205], v47 offset:22528
ds_read_b64_tr_b16 a[206:207], v47 offset:22656
s_waitcnt lgkmcnt(0)
ds_read_b64_tr_b16 a[208:209], v47 offset:24576
ds_read_b64_tr_b16 a[210:211], v47 offset:24704
ds_read_b64_tr_b16 a[212:213], v47 offset:26624
ds_read_b64_tr_b16 a[214:215], v47 offset:26752
ds_read_b64_tr_b16 a[216:217], v47 offset:28672
ds_read_b64_tr_b16 a[218:219], v47 offset:28800
ds_read_b64_tr_b16 a[220:221], v47 offset:30720
ds_read_b64_tr_b16 a[222:223], v47 offset:30848
s_waitcnt lgkmcnt(0)
ds_read_b64_tr_b16 a[224:225], v47 offset:16416
ds_read_b64_tr_b16 a[226:227], v47 offset:16544
ds_read_b64_tr_b16 a[228:229], v47 offset:18464
ds_read_b64_tr_b16 a[230:231], v47 offset:18592
ds_read_b64_tr_b16 a[232:233], v47 offset:20512
ds_read_b64_tr_b16 a[234:235], v47 offset:20640
ds_read_b64_tr_b16 a[236:237], v47 offset:22560
ds_read_b64_tr_b16 a[238:239], v47 offset:22688
s_waitcnt lgkmcnt(0)
ds_read_b64_tr_b16 a[240:241], v47 offset:24608
ds_read_b64_tr_b16 a[242:243], v47 offset:24736
ds_read_b64_tr_b16 a[244:245], v47 offset:26656
ds_read_b64_tr_b16 a[246:247], v47 offset:26784
ds_read_b64_tr_b16 a[248:249], v47 offset:28704
ds_read_b64_tr_b16 a[250:251], v47 offset:28832
ds_read_b64_tr_b16 a[252:253], v47 offset:30752
ds_read_b64_tr_b16 a[254:255], v47 offset:30880
s_waitcnt lgkmcnt(0)
v_and_b32 v5, 15, v0
v_lshlrev_b32 v5, 4, v5
s_branch mega_kernel_syr
mega_kernel_syrw:
s_sleep 4
mega_kernel_syr:
buffer_load_dword v4, v5, s[72:75], 0 offen sc1
s_waitcnt vmcnt(0)
s_cmp_eq_u32 s95, 1
s_cbranch_scc0 mega_kernel_syrf
v_readlane_b32 s76, v4, 14
s_mov_b32 s98, 0
s_cmp_eq_u32 s76, 64
s_cbranch_scc0 mega_kernel_syrw
s_branch mega_kernel_syrd
mega_kernel_syrf:
s_mov_b32 s77, 0
s_mov_b32 s78, 0
v_readlane_b32 s76, v4, 0
s_add_u32 s77, s77, s76
s_xor_b32 s76, s76, 32
s_or_b32 s78, s78, s76
v_readlane_b32 s76, v4, 1
s_add_u32 s77, s77, s76
s_xor_b32 s76, s76, 32
s_or_b32 s78, s78, s76
v_readlane_b32 s76, v4, 2
s_add_u32 s77, s77, s76
s_xor_b32 s76, s76, 32
s_or_b32 s78, s78, s76
v_readlane_b32 s76, v4, 3
s_add_u32 s77, s77, s76
s_xor_b32 s76, s76, 32
s_or_b32 s78, s78, s76
v_readlane_b32 s76, v4, 4
s_add_u32 s77, s77, s76
s_xor_b32 s76, s76, 32
s_or_b32 s78, s78, s76
v_readlane_b32 s76, v4, 5
s_add_u32 s77, s77, s76
s_xor_b32 s76, s76, 32
s_or_b32 s78, s78, s76
v_readlane_b32 s76, v4, 6
s_add_u32 s77, s77, s76
s_xor_b32 s76, s76, 32
s_or_b32 s78, s78, s76
v_readlane_b32 s76, v4, 7
s_add_u32 s77, s77, s76
s_xor_b32 s76, s76, 32
s_or_b32 s78, s78, s76
s_cmp_eq_u32 s77, 256
s_cbranch_scc0 mega_kernel_syrw
v_mov_b32 v252, v4
s_cmp_eq_u32 s78, 0
s_cbranch_scc0 mega_kernel_slowent
v_readlane_b32 s76, v4, 10
v_readlane_b32 s77, v4, 8
s_cmp_eq_u32 s76, 64
s_cbranch_scc0 mega_kernel_syrw
s_cmp_gt_u32 s77, 32
s_cselect_b32 s98, 1, 0
mega_kernel_syrd:
s_lshr_b32 s28, s31, 3
s_lshl_b32 s28, s28, 14
s_lshl_b32 s29, s98, 13
s_add_u32 s28, s28, s29
s_and_b32 s29, s31, 7
s_lshl_b32 s29, s29, 10
s_add_u32 s28, s28, s29
s_lshl_b32 s29, s30, 16
s_add_u32 s28, s28, s29
s_add_u32 s28, s28, 67108864
v_add_u32 v12, s28, v17
v_xor_b32 v25, 0x10000, v12
v_xor_b32 v26, 0x20000, v12
v_xor_b32 v27, 0x30000, v12
s_lshl_b32 s28, s25, 2
s_add_u32 s28, s28, s26
s_mov_b32 s82, s28
s_lshr_b32 s29, s28, 3
s_xor_b32 s29, s29, s98
s_and_b32 s29, s29, 1
s_lshl_b32 s29, s29, 13
s_lshl_b32 s76, s28, 18
s_add_u32 s76, s76, s29
s_mov_b32 s83, s76
v_add_u32 v240, s76, v17
v_add_u32 v241, 33554432, v240
s_lshr_b32 s29, s28, 4
s_xor_b32 s29, s29, s98
s_and_b32 s29, s29, 1
s_lshl_b32 s29, s29, 13
s_lshl_b32 s79, s28, 17
s_add_u32 s79, s79, s29
s_add_u32 s79, s79, 71303168
s_xor_b32 s29, s98, 1
s_lshl_b32 s29, s29, 13
s_lshl_b32 s28, s25, 7
s_add_u32 s28, s28, s29
s_add_u32 s28, s28, 69206016
v_and_b32 v4, 1, v1
v_lshlrev_b32 v24, 12, v4
v_add_u32 v24, s28, v24
s_lshl_b32 s29, s26, 2
v_add_u32 v24, s29, v24
s_xor_b32 s81, s98, 1
s_lshl_b32 s81, s81, 13
s_lshr_b32 s29, s82, 6
s_lshl_b32 s29, s29, 14
s_add_u32 s81, s81, s29
s_and_b32 s29, s82, 63
s_lshl_b32 s29, s29, 7
s_add_u32 s81, s81, s29
s_add_u32 s81, s81, 69222400
v_mov_b32 v220, 0x3f803f80
v_mov_b32 v221, 0x3f803f80
v_mov_b32 v222, 0x3f803f80
v_mov_b32 v223, 0x3f803f80
v_mov_b32 v228, 0
s_mov_b32 s27, 0
s_mov_b32 s46, 0
s_mov_b32 s44, 18432
s_mov_b32 s45, 18432
s_cmp_eq_u32 s24, 3
s_cbranch_scc0 mega_kernel_rf_pfi
s_mov_b32 s76, 0
s_cmp_gt_i32 s46, s76
s_cbranch_scc1 mega_kernel_rf_pf0ok
mega_kernel_rf_pf0w:
buffer_load_dword v4, v24, s[84:87], 0 offen sc1
s_waitcnt vmcnt(0)
v_readlane_b32 s46, v4, 0
v_readlane_b32 s28, v4, 1
s_nop 1
s_min_i32 s46, s46, s28
s_cmp_gt_i32 s46, s76
s_cbranch_scc0 mega_kernel_rf_pf0w
mega_kernel_rf_pf0ok:
s_add_u32 s77, s76, s82
s_bfe_u32 s28, s77, 0x40002
s_lshl_b32 s28, s28, 14
s_and_b32 s77, s77, 3
s_lshl_b32 s77, s77, 11
s_add_u32 s28, s28, s77
s_add_u32 m0, s45, 0
s_nop 0
buffer_load_dwordx4 v240, s[84:87], s28 offen offset:0 sc1 lds
s_add_u32 m0, s45, 0
s_nop 0
buffer_load_dwordx4 v240, s[84:87], s28 offen offset:1024 sc1 lds
s_add_u32 m0, s45, 2048
s_nop 0
buffer_load_dwordx4 v241, s[84:87], s28 offen offset:0 sc1 lds
s_add_u32 m0, s45, 2048
s_nop 0
buffer_load_dwordx4 v241, s[84:87], s28 offen offset:1024 sc1 lds
s_add_u32 s45, s45, 4096
s_cmp_eq_u32 s45, 30720
s_cselect_b32 s45, 18432, s45
s_waitcnt vmcnt(0) lgkmcnt(0)
mega_kernel_rf_pfi:
v_mov_b32 v96, 0
v_mov_b32 v97, 0
v_mov_b32 v98, 0
v_mov_b32 v99, 0
v_mov_b32 v100, 0
v_mov_b32 v101, 0
v_mov_b32 v102, 0
v_mov_b32 v103, 0
v_mov_b32 v104, 0
v_mov_b32 v105, 0
v_mov_b32 v106, 0
v_mov_b32 v107, 0
v_mov_b32 v108, 0
v_mov_b32 v109, 0
v_mov_b32 v110, 0
v_mov_b32 v111, 0
v_mov_b32 v112, 0
v_mov_b32 v113, 0
v_mov_b32 v114, 0
v_mov_b32 v115, 0
v_mov_b32 v116, 0
v_mov_b32 v117, 0
v_mov_b32 v118, 0
v_mov_b32 v119, 0
s_barrier
s_and_b32 s29, s27, 1
s_lshl_b32 s33, s29, 17
s_lshl_b32 s28, s30, 18
s_add_u32 s33, s33, s28
s_add_u32 s33, s33, 68157440
s_xor_b32 s34, s33, 131072
s_lshl_b32 s35, s29, 18
s_bfe_u32 s47, s27, 0x10001
s_branch mega_kernel_rf_first
mega_kernel_rf_loop:
buffer_load_dwordx4 v[32:35], v7, s[84:87], s33 offen offset:0 sc1
v_add_u32 v5, s44, v17
ds_read_b128 v[156:159], v5 offset:0
ds_read_b128 v[160:163], v5 offset:1024
ds_read_b128 v[164:167], v5 offset:2048
ds_read_b128 v[168:171], v5 offset:3072
s_nop 4
buffer_load_dwordx4 v[36:39], v7, s[84:87], s33 offen offset:1024 sc1
s_nop 9
buffer_load_dwordx4 v[40:43], v7, s[84:87], s33 offen offset:2048 sc1
s_nop 9
buffer_load_dwordx4 v[44:47], v7, s[84:87], s33 offen offset:3072 sc1
s_waitcnt vmcnt(3)
v_max_u32 v4, v32, v34
v_cmp_eq_u32 vcc, -1, v4
s_cbranch_vccnz mega_kernel_rf_pa_15_0f
v_smfmac_f32_16x16x64_bf16 v[96:99], v[32:35], a[0:7], v6
v_smfmac_f32_16x16x64_bf16 v[100:103], v[32:35], a[32:39], v6
v_smfmac_f32_16x16x64_bf16 v[104:107], v[32:35], a[64:71], v6
s_waitcnt vmcnt(2)
v_max_u32 v4, v36, v38
v_cmp_eq_u32 vcc, -1, v4
v_smfmac_f32_16x16x64_bf16 v[108:111], v[32:35], a[96:103], v6
s_cbranch_vccnz mega_kernel_rf_pa_14_1f
v_smfmac_f32_16x16x64_bf16 v[96:99], v[36:39], a[8:15], v6
v_smfmac_f32_16x16x64_bf16 v[100:103], v[36:39], a[40:47], v6
v_smfmac_f32_16x16x64_bf16 v[104:107], v[36:39], a[72:79], v6
s_waitcnt vmcnt(1)
v_max_u32 v4, v40, v42
v_cmp_eq_u32 vcc, -1, v4
v_smfmac_f32_16x16x64_bf16 v[108:111], v[36:39], a[104:111], v6
s_cbranch_vccnz mega_kernel_rf_pa_12_2f
v_smfmac_f32_16x16x64_bf16 v[96:99], v[40:43], a[16:23], v6
v_smfmac_f32_16x16x64_bf16 v[100:103], v[40:43], a[48:55], v6
v_smfmac_f32_16x16x64_bf16 v[104:107], v[40:43], a[80:87], v6
s_waitcnt vmcnt(0)
v_max_u32 v4, v44, v46
v_cmp_eq_u32 vcc, -1, v4
v_smfmac_f32_16x16x64_bf16 v[108:111], v[40:43], a[112:119], v6
s_cbranch_vccnz mega_kernel_rf_pa_8_3f
v_smfmac_f32_16x16x64_bf16 v[96:99], v[44:47], a[24:31], v6
v_smfmac_f32_16x16x64_bf16 v[100:103], v[44:47], a[56:63], v6
v_smfmac_f32_16x16x64_bf16 v[104:107], v[44:47], a[88:95], v6
v_smfmac_f32_16x16x64_bf16 v[108:111], v[44:47], a[120:127], v6
mega_kernel_rf_pa_d:
mega_kernel_rf_adone:
s_nop 5
v_permlane32_swap_b32 v96, v100
v_permlane32_swap_b32 v97, v101
v_permlane32_swap_b32 v98, v102
v_permlane32_swap_b32 v99, v103
v_pk_add_f32 v[96:97], v[96:97], v[100:101]
v_pk_add_f32 v[98:99], v[98:99], v[102:103]
ds_write2_b32 v14, v96, v97 offset0:0 offset1:36
ds_write2_b32 v14, v98, v99 offset0:72 offset1:108
v_permlane32_swap_b32 v104, v108
v_permlane32_swap_b32 v105, v109
v_permlane32_swap_b32 v106, v110
v_permlane32_swap_b32 v107, v111
v_pk_add_f32 v[104:105], v[104:105], v[108:109]
v_pk_add_f32 v[106:107], v[106:107], v[110:111]
ds_write2_b32 v15, v104, v105 offset0:0 offset1:36
ds_write2_b32 v15, v106, v107 offset0:72 offset1:108
v_smfmac_f32_16x16x64_bf16 v[112:115], v[32:35], a[128:135], v6
v_smfmac_f32_16x16x64_bf16 v[116:119], v[32:35], a[160:167], v6
v_smfmac_f32_16x16x64_bf16 v[112:115], v[36:39], a[136:143], v6
v_smfmac_f32_16x16x64_bf16 v[116:119], v[36:39], a[168:175], v6
s_waitcnt lgkmcnt(0)
s_barrier
s_cmp_lg_u32 s24, 0
s_cbranch_scc1 mega_kernel_rf_side
ds_read_b128 v[120:123], v16 offset:0
ds_read_b128 v[124:127], v16 offset:16
ds_read_b128 v[128:131], v16 offset:2304
ds_read_b128 v[132:135], v16 offset:2320
ds_read_b128 v[136:139], v16 offset:4608
ds_read_b128 v[140:143], v16 offset:4624
ds_read_b128 v[144:147], v16 offset:6912
ds_read_b128 v[148:151], v16 offset:6928
v_smfmac_f32_16x16x64_bf16 v[112:115], v[40:43], a[144:151], v6
v_smfmac_f32_16x16x64_bf16 v[116:119], v[40:43], a[176:183], v6
v_smfmac_f32_16x16x64_bf16 v[112:115], v[44:47], a[152:159], v6
v_smfmac_f32_16x16x64_bf16 v[116:119], v[44:47], a[184:191], v6
s_lshl_b32 s28, s31, 11
s_add_u32 s28, s28, s33
s_add_u32 s28, s28, 32768
s_add_u32 s76, s37, s33
s_add_u32 s77, s38, s33
s_add_u32 s78, s39, s33
s_waitcnt lgkmcnt(4)
v_pk_add_f32 v[120:121], v[120:121], v[128:129]
v_pk_add_f32 v[122:123], v[122:123], v[130:131]
v_pk_add_f32 v[124:125], v[124:125], v[132:133]
v_pk_add_f32 v[126:127], v[126:127], v[134:135]
s_waitcnt lgkmcnt(0)
v_pk_add_f32 v[136:137], v[136:137], v[144:145]
v_pk_add_f32 v[138:139], v[138:139], v[146:147]
v_pk_add_f32 v[140:141], v[140:141], v[148:149]
v_pk_add_f32 v[142:143], v[142:143], v[150:151]
v_pk_add_f32 v[120:121], v[120:121], v[136:137]
v_pk_add_f32 v[122:123], v[122:123], v[138:139]
v_pk_add_f32 v[124:125], v[124:125], v[140:141]
v_pk_add_f32 v[126:127], v[126:127], v[142:143]
v_cvt_pk_bf16_f32 v152, v120, v121
v_cvt_pk_bf16_f32 v153, v122, v123
v_cvt_pk_bf16_f32 v154, v124, v125
v_cvt_pk_bf16_f32 v155, v126, v127
s_nop 1
v_mfma_f32_16x16x32_bf16 v[176:179], v[160:163], v[152:155], 0
v_mfma_f32_16x16x32_bf16 v[172:175], v[156:159], v[152:155], 0
v_mfma_f32_16x16x32_bf16 v[180:183], v[152:155], v[152:155], 0
s_cmp_eq_u32 s27, 63
s_cbranch_scc1 mega_kernel_rf_w0last
s_nop 4
v_mov_b32_dpp v172, v176 row_shr:8 row_mask:0xf bank_mask:0xc
v_mov_b32_dpp v173, v177 row_shr:8 row_mask:0xf bank_mask:0xc
v_mov_b32_dpp v174, v178 row_shr:8 row_mask:0xf bank_mask:0xc
v_mov_b32_dpp v175, v179 row_shr:8 row_mask:0xf bank_mask:0xc
v_min_u32 v180, -2, v180
v_min_u32 v172, -2, v172
s_mov_b64 exec, s[42:43]
buffer_store_dwordx4 v[180:183], v10, s[84:87], s28 offen
s_mov_b64 exec, -1
buffer_store_dwordx4 v[172:175], v17, s[84:87], s28 offen
v_permlane32_swap_b32 v112, v116
v_permlane32_swap_b32 v113, v117
v_permlane32_swap_b32 v114, v118
v_permlane32_swap_b32 v115, v119
v_pk_add_f32 v[112:113], v[112:113], v[116:117]
v_pk_add_f32 v[114:115], v[114:115], v[118:119]
ds_write_b128 v20, v[112:115]
s_waitcnt lgkmcnt(0)
s_barrier
v_mov_b32 v96, 0
v_mov_b32 v97, 0
v_mov_b32 v98, 0
v_mov_b32 v99, 0
v_mov_b32 v100, 0
v_mov_b32 v101, 0
v_mov_b32 v102, 0
v_mov_b32 v103, 0
buffer_load_dwordx4 v[184:187], v17, s[84:87], s76 offen sc1
buffer_load_dwordx4 v[188:191], v10, s[84:87], s76 offen sc1
buffer_load_dwordx4 v[192:195], v17, s[84:87], s77 offen sc1
buffer_load_dwordx4 v[196:199], v10, s[84:87], s77 offen sc1
buffer_load_dwordx4 v[200:203], v17, s[84:87], s78 offen sc1
buffer_load_dwordx4 v[204:207], v10, s[84:87], s78 offen sc1
s_nop 15
s_nop 7
buffer_load_dwordx4 v[184:187], v17, s[84:87], s76 offen sc1
buffer_load_dwordx4 v[188:191], v10, s[84:87], s76 offen sc1
buffer_load_dwordx4 v[192:195], v17, s[84:87], s77 offen sc1
buffer_load_dwordx4 v[196:199], v10, s[84:87], s77 offen sc1
buffer_load_dwordx4 v[200:203], v17, s[84:87], s78 offen sc1
buffer_load_dwordx4 v[204:207], v10, s[84:87], s78 offen sc1
mega_kernel_rf_p2:
s_waitcnt vmcnt(6)
v_max3_u32 v4, v184, v188, v192
v_max3_u32 v5, v196, v200, v204
v_max_u32 v4, v4, v5
v_cmp_eq_u32 vcc, -1, v4
s_cbranch_vccnz mega_kernel_rf_p2r
v_pk_add_f32 v[180:181], v[180:181], v[188:189]
v_pk_add_f32 v[124:125], v[196:197], v[204:205]
v_pk_add_f32 v[182:183], v[182:183], v[190:191]
v_pk_add_f32 v[126:127], v[198:199], v[206:207]
v_pk_add_f32 v[172:173], v[172:173], v[184:185]
v_pk_add_f32 v[120:121], v[192:193], v[200:201]
v_pk_add_f32 v[174:175], v[174:175], v[186:187]
v_pk_add_f32 v[122:123], v[194:195], v[202:203]
v_pk_add_f32 v[180:181], v[180:181], v[124:125]
v_pk_add_f32 v[182:183], v[182:183], v[126:127]
v_pk_add_f32 v[172:173], v[172:173], v[120:121]
v_pk_add_f32 v[174:175], v[174:175], v[122:123]
v_cndmask_b32 v176, v23, v180, s[42:43]
v_cndmask_b32 v177, v23, v181, s[42:43]
v_cndmask_b32 v178, v23, v182, s[42:43]
v_cndmask_b32 v179, v23, v183, s[42:43]
v_max3_f32 v232, v172, v173, v174
v_max3_f32 v233, v176, v177, v178
v_max3_f32 v232, v232, v175, v179
v_max_f32 v234, v232, v233
s_barrier
ds_read2_b64 v[208:211], v21 offset0:0 offset1:32
v_max_f32_dpp v232, v234, v234 row_ror:8 row_mask:0xf bank_mask:0xf
v_max_f32_dpp v233, v234, v234 row_ror:8 row_mask:0xf bank_mask:0xf
s_nop 1
v_permlane16_swap_b32 v232, v233
s_nop 0
v_max_f32 v234, v232, v233
v_max_f32 v235, v232, v233
s_nop 1
v_permlane32_swap_b32 v234, v235
s_nop 0
v_max_f32 v232, v234, v235
v_mul_f32 v232, s32, v232
v_fma_f32 v176, v176, s32, -v232
v_fma_f32 v177, v177, s32, -v232
v_fma_f32 v178, v178, s32, -v232
v_fma_f32 v179, v179, s32, -v232
v_fma_f32 v172, v172, s32, -v232
v_fma_f32 v173, v173, s32, -v232
v_fma_f32 v174, v174, s32, -v232
v_fma_f32 v175, v175, s32, -v232
v_exp_f32 v176, v176
v_exp_f32 v177, v177
v_exp_f32 v178, v178
v_exp_f32 v179, v179
v_exp_f32 v172, v172
v_cvt_pk_bf16_f32 v216, v176, v177
v_cvt_pk_bf16_f32 v217, v178, v179
v_exp_f32 v173, v173
v_exp_f32 v174, v174
v_mfma_f32_16x16x16_bf16 v[224:227], v[220:221], v[216:217], 0
v_exp_f32 v175, v175
v_cvt_pk_bf16_f32 v212, v172, v173
s_waitcnt lgkmcnt(0)
v_mfma_f32_16x16x16_bf16 v[120:123], v[208:209], v[216:217], 0
v_cvt_pk_bf16_f32 v213, v174, v175
v_mfma_f32_16x16x16_bf16 v[124:127], v[210:211], v[216:217], 0
v_mov_b32_dpp v214, v212 row_ror:8 row_mask:0xf bank_mask:0xf
v_mov_b32_dpp v215, v213 row_ror:8 row_mask:0xf bank_mask:0xf
s_nop 1
v_mfma_f32_16x16x32_bf16 v[224:227], v[220:223], v[212:215], v[224:227]
v_mfma_f32_16x16x32_bf16 v[120:123], v[164:167], v[212:215], v[120:123]
v_mfma_f32_16x16x32_bf16 v[124:127], v[168:171], v[212:215], v[124:127]
s_add_u32 s29, s33, 16384
s_nop 4
v_rcp_f32 v234, v224
v_rcp_f32 v235, v225
s_nop 0
v_pk_mul_f32 v[120:121], v[120:121], v[234:235]
v_pk_mul_f32 v[122:123], v[122:123], v[234:235]
v_pk_mul_f32 v[124:125], v[124:125], v[234:235]
v_pk_mul_f32 v[126:127], v[126:127], v[234:235]
v_cvt_pk_bf16_f32 v212, v120, v121
v_cvt_pk_bf16_f32 v213, v122, v123
v_cvt_pk_bf16_f32 v214, v124, v125
v_cvt_pk_bf16_f32 v215, v126, v127
v_min_u32 v212, -2, v212
s_mov_b64 exec, s[40:41]
buffer_store_dwordx4 v[212:215], v11, s[84:87], s33 offen
s_mov_b64 exec, -1
mega_kernel_rf_b3:
s_barrier
s_nop 9
buffer_load_dwordx4 v[32:35], v7, s[84:87], s29 offen offset:0 sc1
s_nop 9
buffer_load_dwordx4 v[36:39], v7, s[84:87], s29 offen offset:1024 sc1
s_nop 9
buffer_load_dwordx4 v[40:43], v7, s[84:87], s29 offen offset:2048 sc1
s_nop 9
buffer_load_dwordx4 v[44:47], v7, s[84:87], s29 offen offset:3072 sc1
mega_kernel_rf_pc_15_0:
s_waitcnt vmcnt(3)
v_cmp_eq_u32 vcc, -1, v32
s_cbranch_vccnz mega_kernel_rf_pc_15_0f
v_smfmac_f32_16x16x64_bf16 v[96:99], v[32:35], a[192:199], v6
v_smfmac_f32_16x16x64_bf16 v[100:103], v[32:35], a[224:231], v6
mega_kernel_rf_pc_14_1:
s_waitcnt vmcnt(2)
v_cmp_eq_u32 vcc, -1, v36
s_cbranch_vccnz mega_kernel_rf_pc_14_1f
v_smfmac_f32_16x16x64_bf16 v[96:99], v[36:39], a[200:207], v6
v_smfmac_f32_16x16x64_bf16 v[100:103], v[36:39], a[232:239], v6
mega_kernel_rf_pc_12_2:
s_waitcnt vmcnt(1)
v_cmp_eq_u32 vcc, -1, v40
s_cbranch_vccnz mega_kernel_rf_pc_12_2f
v_smfmac_f32_16x16x64_bf16 v[96:99], v[40:43], a[208:215], v6
v_smfmac_f32_16x16x64_bf16 v[100:103], v[40:43], a[240:247], v6
mega_kernel_rf_pc_8_3:
s_waitcnt vmcnt(0)
v_cmp_eq_u32 vcc, -1, v44
s_cbranch_vccnz mega_kernel_rf_pc_8_3f
v_smfmac_f32_16x16x64_bf16 v[96:99], v[44:47], a[216:223], v6
v_smfmac_f32_16x16x64_bf16 v[100:103], v[44:47], a[248:255], v6
mega_kernel_rf_pc_d:
s_nop 7
v_permlane32_swap_b32 v96, v100
v_permlane32_swap_b32 v97, v101
v_permlane32_swap_b32 v98, v102
v_permlane32_swap_b32 v99, v103
v_pk_add_f32 v[96:97], v[96:97], v[100:101]
v_pk_add_f32 v[98:99], v[98:99], v[102:103]
ds_write2_b32 v18, v96, v97 offset0:0 offset1:36
ds_write2_b32 v18, v98, v99 offset0:72 offset1:108
s_waitcnt lgkmcnt(0)
s_barrier
s_cmp_lg_u32 s24, 0
s_cbranch_scc1 mega_kernel_rf_x1
ds_read_b128 v[120:123], v19 offset:0
ds_read_b128 v[124:127], v19 offset:1152
ds_read_b128 v[128:131], v19 offset:2304
ds_read_b128 v[132:135], v19 offset:3456
s_waitcnt lgkmcnt(2)
v_pk_add_f32 v[120:121], v[120:121], v[124:125]
v_pk_add_f32 v[122:123], v[122:123], v[126:127]
s_waitcnt lgkmcnt(0)
v_pk_add_f32 v[128:129], v[128:129], v[132:133]
v_pk_add_f32 v[130:131], v[130:131], v[134:135]
v_pk_add_f32 v[120:121], v[120:121], v[128:129]
v_pk_add_f32 v[122:123], v[122:123], v[130:131]
v_and_or_b32 v120, v120, -2, s47
v_and_or_b32 v121, v121, -2, s47
v_and_or_b32 v122, v122, -2, s47
v_and_or_b32 v123, v123, -2, s47
buffer_store_dwordx4 v[120:123], v12, s[84:87], s35 offen sc1
s_xor_b32 s76, s47, 1
v_mov_b32 v48, s76
v_mov_b32 v49, s76
v_mov_b32 v50, s76
v_mov_b32 v51, s76
v_mov_b32 v52, s76
v_mov_b32 v53, s76
v_mov_b32 v54, s76
v_mov_b32 v55, s76
v_mov_b32 v56, s76
v_mov_b32 v57, s76
v_mov_b32 v58, s76
v_mov_b32 v59, s76
v_mov_b32 v96, 0
v_mov_b32 v97, 0
v_mov_b32 v98, 0
v_mov_b32 v99, 0
v_mov_b32 v100, 0
v_mov_b32 v101, 0
v_mov_b32 v102, 0
v_mov_b32 v103, 0
v_mov_b32 v104, 0
v_mov_b32 v105, 0
v_mov_b32 v106, 0
v_mov_b32 v107, 0
v_mov_b32 v108, 0
v_mov_b32 v109, 0
v_mov_b32 v110, 0
v_mov_b32 v111, 0
v_mov_b32 v112, 0
v_mov_b32 v113, 0
v_mov_b32 v114, 0
v_mov_b32 v115, 0
v_mov_b32 v116, 0
v_mov_b32 v117, 0
v_mov_b32 v118, 0
v_mov_b32 v119, 0
s_nop 15
s_cmp_eq_u32 s47, 1
s_cbranch_scc1 mega_kernel_rf_p4_1
mega_kernel_rf_p4_0:
buffer_load_dwordx4 v[48:51], v25, s[84:87], s35 offen sc1
buffer_load_dwordx4 v[52:55], v26, s[84:87], s35 offen sc1
buffer_load_dwordx4 v[56:59], v27, s[84:87], s35 offen sc1
s_waitcnt vmcnt(36)
s_nop 1
v_bitop3_b32 v4, v48, v49, v50 bitop3:0xfe
v_bitop3_b32 v5, v54, v55, v56 bitop3:0xfe
v_bitop3_b32 v4, v4, v51, v52 bitop3:0xfe
v_bitop3_b32 v5, v5, v57, v58 bitop3:0xfe
v_bitop3_b32 v4, v4, v53, v59 bitop3:0xfe
v_bitop3_b32 v4, v4, v5, 1 bitop3:0xa8
v_cmp_ne_u32 vcc, 0, v4
s_cbranch_vccnz mega_kernel_rf_p4_0
s_branch mega_kernel_rf_p4d
mega_kernel_rf_p4_1:
buffer_load_dwordx4 v[48:51], v25, s[84:87], s35 offen sc1
buffer_load_dwordx4 v[52:55], v26, s[84:87], s35 offen sc1
buffer_load_dwordx4 v[56:59], v27, s[84:87], s35 offen sc1
s_waitcnt vmcnt(36)
s_nop 1
v_bitop3_b32 v4, v48, v49, v50 bitop3:0x80
v_bitop3_b32 v5, v54, v55, v56 bitop3:0x80
v_bitop3_b32 v4, v4, v51, v52 bitop3:0x80
v_bitop3_b32 v5, v5, v57, v58 bitop3:0x80
v_bitop3_b32 v4, v4, v53, v59 bitop3:0x80
v_bitop3_b32 v4, v4, v5, 1 bitop3:0x80
v_cmp_ne_u32 vcc, 1, v4
s_cbranch_vccnz mega_kernel_rf_p4_1
mega_kernel_rf_p4d:
v_pk_add_f32 v[120:121], v[120:121], v[48:49]
v_pk_add_f32 v[124:125], v[52:53], v[56:57]
v_pk_add_f32 v[122:123], v[122:123], v[50:51]
v_pk_add_f32 v[126:127], v[54:55], v[58:59]
v_pk_add_f32 v[120:121], v[120:121], v[124:125]
v_pk_add_f32 v[122:123], v[122:123], v[126:127]
v_cvt_pk_bf16_f32 v212, v120, v121
v_cvt_pk_bf16_f32 v213, v122, v123
v_min_u32 v212, -2, v212
buffer_store_dwordx2 v[212:213], v9, s[84:87], s34 offen
mega_kernel_rf_b5:
s_add_u32 s27, s27, 1
s_add_u32 s44, s44, 4096
s_cmp_eq_u32 s44, 30720
s_cselect_b32 s44, 18432, s44
s_mov_b32 s28, s33
s_mov_b32 s33, s34
s_mov_b32 s34, s28
s_xor_b32 s35, s35, 262144
s_bfe_u32 s47, s27, 0x10001
s_barrier
s_nop 9
s_branch mega_kernel_rf_loop
mega_kernel_rf_x1:
s_cmp_eq_u32 s24, 1
s_cbranch_scc0 mega_kernel_rf_x2
s_add_u32 s76, s27, 1
v_mov_b32 v5, s76
s_mov_b64 exec, 1
buffer_store_dword v5, v228, s[84:87], s81 offen sc1
s_mov_b64 exec, -1
mega_kernel_rf_x2:
s_cmp_eq_u32 s24, 3
s_cbranch_scc0 mega_kernel_rf_x4
buffer_store_dwordx2 v[28:29], v9, s[84:87], s33 offen
s_lshl_b32 s28, s31, 11
s_add_u32 s28, s28, s33
s_add_u32 s28, s28, 32768
buffer_store_dwordx4 v[28:31], v17, s[84:87], s28 offen
buffer_store_dwordx4 v[28:31], v10, s[84:87], s28 offen
s_add_u32 s76, s27, 2
s_cmp_lt_u32 s76, 63
s_cbranch_scc0 mega_kernel_rf_x4
s_cmp_gt_i32 s46, s76
s_cbranch_scc0 mega_kernel_rf_x4
s_add_u32 s77, s76, s82
s_bfe_u32 s28, s77, 0x40002
s_lshl_b32 s28, s28, 14
s_and_b32 s77, s77, 3
s_lshl_b32 s77, s77, 11
s_add_u32 s28, s28, s77
s_add_u32 s28, s28, s83
s_add_u32 s28, s28, 33554432
s_buffer_load_dword s78, s[84:87], s28 offset:0
s_buffer_load_dword s78, s[84:87], s28 offset:128
s_buffer_load_dword s78, s[84:87], s28 offset:256
s_buffer_load_dword s78, s[84:87], s28 offset:384
s_buffer_load_dword s78, s[84:87], s28 offset:512
s_buffer_load_dword s78, s[84:87], s28 offset:640
s_buffer_load_dword s78, s[84:87], s28 offset:768
s_buffer_load_dword s78, s[84:87], s28 offset:896
s_buffer_load_dword s78, s[84:87], s28 offset:1024
s_buffer_load_dword s78, s[84:87], s28 offset:1152
s_buffer_load_dword s78, s[84:87], s28 offset:1280
s_buffer_load_dword s78, s[84:87], s28 offset:1408
s_buffer_load_dword s78, s[84:87], s28 offset:1536
s_buffer_load_dword s78, s[84:87], s28 offset:1664
s_buffer_load_dword s78, s[84:87], s28 offset:1792
s_buffer_load_dword s78, s[84:87], s28 offset:1920
mega_kernel_rf_x4:
v_mov_b32 v96, 0
v_mov_b32 v97, 0
v_mov_b32 v98, 0
v_mov_b32 v99, 0
v_mov_b32 v100, 0
v_mov_b32 v101, 0
v_mov_b32 v102, 0
v_mov_b32 v103, 0
v_mov_b32 v104, 0
v_mov_b32 v105, 0
v_mov_b32 v106, 0
v_mov_b32 v107, 0
v_mov_b32 v108, 0
v_mov_b32 v109, 0
v_mov_b32 v110, 0
v_mov_b32 v111, 0
v_mov_b32 v112, 0
v_mov_b32 v113, 0
v_mov_b32 v114, 0
v_mov_b32 v115, 0
v_mov_b32 v116, 0
v_mov_b32 v117, 0
v_mov_b32 v118, 0
v_mov_b32 v119, 0
s_branch mega_kernel_rf_b5
mega_kernel_rf_p2r:
buffer_load_dwordx4 v[184:187], v17, s[84:87], s76 offen sc1
buffer_load_dwordx4 v[188:191], v10, s[84:87], s76 offen sc1
buffer_load_dwordx4 v[192:195], v17, s[84:87], s77 offen sc1
buffer_load_dwordx4 v[196:199], v10, s[84:87], s77 offen sc1
buffer_load_dwordx4 v[200:203], v17, s[84:87], s78 offen sc1
buffer_load_dwordx4 v[204:207], v10, s[84:87], s78 offen sc1
s_branch mega_kernel_rf_p2
mega_kernel_rf_pa_1_0f:
s_mov_b64 exec, vcc
buffer_load_dwordx4 v[32:35], v7, s[84:87], s33 offen offset:0 sc1
s_mov_b64 exec, -1
s_branch mega_kernel_rf_pa_1_0
mega_kernel_rf_pa_1_0:
s_waitcnt vmcnt(0)
v_max_u32 v4, v32, v34
v_cmp_eq_u32 vcc, -1, v4
s_cbranch_vccnz mega_kernel_rf_pa_1_0f
v_smfmac_f32_16x16x64_bf16 v[96:99], v[32:35], a[0:7], v6
v_smfmac_f32_16x16x64_bf16 v[100:103], v[32:35], a[32:39], v6
v_smfmac_f32_16x16x64_bf16 v[104:107], v[32:35], a[64:71], v6
v_smfmac_f32_16x16x64_bf16 v[108:111], v[32:35], a[96:103], v6
s_branch mega_kernel_rf_pa_d
mega_kernel_rf_pa_2_1f:
s_mov_b64 exec, vcc
buffer_load_dwordx4 v[36:39], v7, s[84:87], s33 offen offset:1024 sc1
s_mov_b64 exec, -1
s_branch mega_kernel_rf_pa_2_1
mega_kernel_rf_pa_2_1:
s_waitcnt vmcnt(0)
v_max_u32 v4, v36, v38
v_cmp_eq_u32 vcc, -1, v4
s_cbranch_vccnz mega_kernel_rf_pa_2_1f
v_smfmac_f32_16x16x64_bf16 v[96:99], v[36:39], a[8:15], v6
v_smfmac_f32_16x16x64_bf16 v[100:103], v[36:39], a[40:47], v6
v_smfmac_f32_16x16x64_bf16 v[104:107], v[36:39], a[72:79], v6
v_smfmac_f32_16x16x64_bf16 v[108:111], v[36:39], a[104:111], v6
s_branch mega_kernel_rf_pa_d
mega_kernel_rf_pa_3_0f:
s_mov_b64 exec, vcc
buffer_load_dwordx4 v[32:35], v7, s[84:87], s33 offen offset:0 sc1
s_mov_b64 exec, -1
s_branch mega_kernel_rf_pa_3_1
mega_kernel_rf_pa_3_0:
s_waitcnt vmcnt(1)
v_max_u32 v4, v32, v34
v_cmp_eq_u32 vcc, -1, v4
s_cbranch_vccnz mega_kernel_rf_pa_3_0f
v_smfmac_f32_16x16x64_bf16 v[96:99], v[32:35], a[0:7], v6
v_smfmac_f32_16x16x64_bf16 v[100:103], v[32:35], a[32:39], v6
v_smfmac_f32_16x16x64_bf16 v[104:107], v[32:35], a[64:71], v6
v_smfmac_f32_16x16x64_bf16 v[108:111], v[32:35], a[96:103], v6
s_branch mega_kernel_rf_pa_2_1
mega_kernel_rf_pa_3_1f:
s_mov_b64 exec, vcc
buffer_load_dwordx4 v[36:39], v7, s[84:87], s33 offen offset:1024 sc1
s_mov_b64 exec, -1
s_branch mega_kernel_rf_pa_3_0
mega_kernel_rf_pa_3_1:
s_waitcnt vmcnt(1)
v_max_u32 v4, v36, v38
v_cmp_eq_u32 vcc, -1, v4
s_cbranch_vccnz mega_kernel_rf_pa_3_1f
v_smfmac_f32_16x16x64_bf16 v[96:99], v[36:39], a[8:15], v6
v_smfmac_f32_16x16x64_bf16 v[100:103], v[36:39], a[40:47], v6
v_smfmac_f32_16x16x64_bf16 v[104:107], v[36:39], a[72:79], v6
v_smfmac_f32_16x16x64_bf16 v[108:111], v[36:39], a[104:111], v6
s_branch mega_kernel_rf_pa_1_0
mega_kernel_rf_pa_4_2f:
s_mov_b64 exec, vcc
buffer_load_dwordx4 v[40:43], v7, s[84:87], s33 offen offset:2048 sc1
s_mov_b64 exec, -1
s_branch mega_kernel_rf_pa_4_2
mega_kernel_rf_pa_4_2:
s_waitcnt vmcnt(0)
v_max_u32 v4, v40, v42
v_cmp_eq_u32 vcc, -1, v4
s_cbranch_vccnz mega_kernel_rf_pa_4_2f
v_smfmac_f32_16x16x64_bf16 v[96:99], v[40:43], a[16:23], v6
v_smfmac_f32_16x16x64_bf16 v[100:103], v[40:43], a[48:55], v6
v_smfmac_f32_16x16x64_bf16 v[104:107], v[40:43], a[80:87], v6
v_smfmac_f32_16x16x64_bf16 v[108:111], v[40:43], a[112:119], v6
s_branch mega_kernel_rf_pa_d
mega_kernel_rf_pa_5_0f:
s_mov_b64 exec, vcc
buffer_load_dwordx4 v[32:35], v7, s[84:87], s33 offen offset:0 sc1
s_mov_b64 exec, -1
s_branch mega_kernel_rf_pa_5_2
mega_kernel_rf_pa_5_0:
s_waitcnt vmcnt(1)
v_max_u32 v4, v32, v34
v_cmp_eq_u32 vcc, -1, v4
s_cbranch_vccnz mega_kernel_rf_pa_5_0f
v_smfmac_f32_16x16x64_bf16 v[96:99], v[32:35], a[0:7], v6
v_smfmac_f32_16x16x64_bf16 v[100:103], v[32:35], a[32:39], v6
v_smfmac_f32_16x16x64_bf16 v[104:107], v[32:35], a[64:71], v6
v_smfmac_f32_16x16x64_bf16 v[108:111], v[32:35], a[96:103], v6
s_branch mega_kernel_rf_pa_4_2
mega_kernel_rf_pa_5_2f:
s_mov_b64 exec, vcc
buffer_load_dwordx4 v[40:43], v7, s[84:87], s33 offen offset:2048 sc1
s_mov_b64 exec, -1
s_branch mega_kernel_rf_pa_5_0
mega_kernel_rf_pa_5_2:
s_waitcnt vmcnt(1)
v_max_u32 v4, v40, v42
v_cmp_eq_u32 vcc, -1, v4
s_cbranch_vccnz mega_kernel_rf_pa_5_2f
v_smfmac_f32_16x16x64_bf16 v[96:99], v[40:43], a[16:23], v6
v_smfmac_f32_16x16x64_bf16 v[100:103], v[40:43], a[48:55], v6
v_smfmac_f32_16x16x64_bf16 v[104:107], v[40:43], a[80:87], v6
v_smfmac_f32_16x16x64_bf16 v[108:111], v[40:43], a[112:119], v6
s_branch mega_kernel_rf_pa_1_0
mega_kernel_rf_pa_6_1f:
s_mov_b64 exec, vcc
buffer_load_dwordx4 v[36:39], v7, s[84:87], s33 offen offset:1024 sc1
s_mov_b64 exec, -1
s_branch mega_kernel_rf_pa_6_2
mega_kernel_rf_pa_6_1:
s_waitcnt vmcnt(1)
v_max_u32 v4, v36, v38
v_cmp_eq_u32 vcc, -1, v4
s_cbranch_vccnz mega_kernel_rf_pa_6_1f
v_smfmac_f32_16x16x64_bf16 v[96:99], v[36:39], a[8:15], v6
v_smfmac_f32_16x16x64_bf16 v[100:103], v[36:39], a[40:47], v6
v_smfmac_f32_16x16x64_bf16 v[104:107], v[36:39], a[72:79], v6
v_smfmac_f32_16x16x64_bf16 v[108:111], v[36:39], a[104:111], v6
s_branch mega_kernel_rf_pa_4_2
mega_kernel_rf_pa_6_2f:
s_mov_b64 exec, vcc
buffer_load_dwordx4 v[40:43], v7, s[84:87], s33 offen offset:2048 sc1
s_mov_b64 exec, -1
s_branch mega_kernel_rf_pa_6_1
mega_kernel_rf_pa_6_2:
s_waitcnt vmcnt(1)
v_max_u32 v4, v40, v42
v_cmp_eq_u32 vcc, -1, v4
s_cbranch_vccnz mega_kernel_rf_pa_6_2f
v_smfmac_f32_16x16x64_bf16 v[96:99], v[40:43], a[16:23], v6
v_smfmac_f32_16x16x64_bf16 v[100:103], v[40:43], a[48:55], v6
v_smfmac_f32_16x16x64_bf16 v[104:107], v[40:43], a[80:87], v6
v_smfmac_f32_16x16x64_bf16 v[108:111], v[40:43], a[112:119], v6
s_branch mega_kernel_rf_pa_2_1
mega_kernel_rf_pa_7_0f:
s_mov_b64 exec, vcc
buffer_load_dwordx4 v[32:35], v7, s[84:87], s33 offen offset:0 sc1
s_mov_b64 exec, -1
s_branch mega_kernel_rf_pa_7_1
mega_kernel_rf_pa_7_0:
s_waitcnt vmcnt(2)
v_max_u32 v4, v32, v34
v_cmp_eq_u32 vcc, -1, v4
s_cbranch_vccnz mega_kernel_rf_pa_7_0f
v_smfmac_f32_16x16x64_bf16 v[96:99], v[32:35], a[0:7], v6
v_smfmac_f32_16x16x64_bf16 v[100:103], v[32:35], a[32:39], v6
v_smfmac_f32_16x16x64_bf16 v[104:107], v[32:35], a[64:71], v6
v_smfmac_f32_16x16x64_bf16 v[108:111], v[32:35], a[96:103], v6
s_branch mega_kernel_rf_pa_6_1
mega_kernel_rf_pa_7_1f:
s_mov_b64 exec, vcc
buffer_load_dwordx4 v[36:39], v7, s[84:87], s33 offen offset:1024 sc1
s_mov_b64 exec, -1
s_branch mega_kernel_rf_pa_7_2
mega_kernel_rf_pa_7_1:
s_waitcnt vmcnt(2)
v_max_u32 v4, v36, v38
v_cmp_eq_u32 vcc, -1, v4
s_cbranch_vccnz mega_kernel_rf_pa_7_1f
v_smfmac_f32_16x16x64_bf16 v[96:99], v[36:39], a[8:15], v6
v_smfmac_f32_16x16x64_bf16 v[100:103], v[36:39], a[40:47], v6
v_smfmac_f32_16x16x64_bf16 v[104:107], v[36:39], a[72:79], v6
v_smfmac_f32_16x16x64_bf16 v[108:111], v[36:39], a[104:111], v6
s_branch mega_kernel_rf_pa_5_2
mega_kernel_rf_pa_7_2f:
s_mov_b64 exec, vcc
buffer_load_dwordx4 v[40:43], v7, s[84:87], s33 offen offset:2048 sc1
s_mov_b64 exec, -1
s_branch mega_kernel_rf_pa_7_0
mega_kernel_rf_pa_7_2:
s_waitcnt vmcnt(2)
v_max_u32 v4, v40, v42
v_cmp_eq_u32 vcc, -1, v4
s_cbranch_vccnz mega_kernel_rf_pa_7_2f
v_smfmac_f32_16x16x64_bf16 v[96:99], v[40:43], a[16:23], v6
v_smfmac_f32_16x16x64_bf16 v[100:103], v[40:43], a[48:55], v6
v_smfmac_f32_16x16x64_bf16 v[104:107], v[40:43], a[80:87], v6
v_smfmac_f32_16x16x64_bf16 v[108:111], v[40:43], a[112:119], v6
s_branch mega_kernel_rf_pa_3_0
mega_kernel_rf_pa_8_3f:
s_mov_b64 exec, vcc
buffer_load_dwordx4 v[44:47], v7, s[84:87], s33 offen offset:3072 sc1
s_mov_b64 exec, -1
s_branch mega_kernel_rf_pa_8_3
mega_kernel_rf_pa_8_3:
s_waitcnt vmcnt(0)
v_max_u32 v4, v44, v46
v_cmp_eq_u32 vcc, -1, v4
s_cbranch_vccnz mega_kernel_rf_pa_8_3f
v_smfmac_f32_16x16x64_bf16 v[96:99], v[44:47], a[24:31], v6
v_smfmac_f32_16x16x64_bf16 v[100:103], v[44:47], a[56:63], v6
v_smfmac_f32_16x16x64_bf16 v[104:107], v[44:47], a[88:95], v6
v_smfmac_f32_16x16x64_bf16 v[108:111], v[44:47], a[120:127], v6
s_branch mega_kernel_rf_pa_d
mega_kernel_rf_pa_9_0f:
s_mov_b64 exec, vcc
buffer_load_dwordx4 v[32:35], v7, s[84:87], s33 offen offset:0 sc1
s_mov_b64 exec, -1
s_branch mega_kernel_rf_pa_9_3
mega_kernel_rf_pa_9_0:
s_waitcnt vmcnt(1)
v_max_u32 v4, v32, v34
v_cmp_eq_u32 vcc, -1, v4
s_cbranch_vccnz mega_kernel_rf_pa_9_0f
v_smfmac_f32_16x16x64_bf16 v[96:99], v[32:35], a[0:7], v6
v_smfmac_f32_16x16x64_bf16 v[100:103], v[32:35], a[32:39], v6
v_smfmac_f32_16x16x64_bf16 v[104:107], v[32:35], a[64:71], v6
v_smfmac_f32_16x16x64_bf16 v[108:111], v[32:35], a[96:103], v6
s_branch mega_kernel_rf_pa_8_3
mega_kernel_rf_pa_9_3f:
s_mov_b64 exec, vcc
buffer_load_dwordx4 v[44:47], v7, s[84:87], s33 offen offset:3072 sc1
s_mov_b64 exec, -1
s_branch mega_kernel_rf_pa_9_0
mega_kernel_rf_pa_9_3:
s_waitcnt vmcnt(1)
v_max_u32 v4, v44, v46
v_cmp_eq_u32 vcc, -1, v4
s_cbranch_vccnz mega_kernel_rf_pa_9_3f
v_smfmac_f32_16x16x64_bf16 v[96:99], v[44:47], a[24:31], v6
v_smfmac_f32_16x16x64_bf16 v[100:103], v[44:47], a[56:63], v6
v_smfmac_f32_16x16x64_bf16 v[104:107], v[44:47], a[88:95], v6
v_smfmac_f32_16x16x64_bf16 v[108:111], v[44:47], a[120:127], v6
s_branch mega_kernel_rf_pa_1_0
mega_kernel_rf_pa_10_1f:
s_mov_b64 exec, vcc
buffer_load_dwordx4 v[36:39], v7, s[84:87], s33 offen offset:1024 sc1
s_mov_b64 exec, -1
s_branch mega_kernel_rf_pa_10_3
mega_kernel_rf_pa_10_1:
s_waitcnt vmcnt(1)
v_max_u32 v4, v36, v38
v_cmp_eq_u32 vcc, -1, v4
s_cbranch_vccnz mega_kernel_rf_pa_10_1f
v_smfmac_f32_16x16x64_bf16 v[96:99], v[36:39], a[8:15], v6
v_smfmac_f32_16x16x64_bf16 v[100:103], v[36:39], a[40:47], v6
v_smfmac_f32_16x16x64_bf16 v[104:107], v[36:39], a[72:79], v6
v_smfmac_f32_16x16x64_bf16 v[108:111], v[36:39], a[104:111], v6
s_branch mega_kernel_rf_pa_8_3
mega_kernel_rf_pa_10_3f:
s_mov_b64 exec, vcc
buffer_load_dwordx4 v[44:47], v7, s[84:87], s33 offen offset:3072 sc1
s_mov_b64 exec, -1
s_branch mega_kernel_rf_pa_10_1
mega_kernel_rf_pa_10_3:
s_waitcnt vmcnt(1)
v_max_u32 v4, v44, v46
v_cmp_eq_u32 vcc, -1, v4
s_cbranch_vccnz mega_kernel_rf_pa_10_3f
v_smfmac_f32_16x16x64_bf16 v[96:99], v[44:47], a[24:31], v6
v_smfmac_f32_16x16x64_bf16 v[100:103], v[44:47], a[56:63], v6
v_smfmac_f32_16x16x64_bf16 v[104:107], v[44:47], a[88:95], v6
v_smfmac_f32_16x16x64_bf16 v[108:111], v[44:47], a[120:127], v6
s_branch mega_kernel_rf_pa_2_1
mega_kernel_rf_pa_11_0f:
s_mov_b64 exec, vcc
buffer_load_dwordx4 v[32:35], v7, s[84:87], s33 offen offset:0 sc1
s_mov_b64 exec, -1
s_branch mega_kernel_rf_pa_11_1
mega_kernel_rf_pa_11_0:
s_waitcnt vmcnt(2)
v_max_u32 v4, v32, v34
v_cmp_eq_u32 vcc, -1, v4
s_cbranch_vccnz mega_kernel_rf_pa_11_0f
v_smfmac_f32_16x16x64_bf16 v[96:99], v[32:35], a[0:7], v6
v_smfmac_f32_16x16x64_bf16 v[100:103], v[32:35], a[32:39], v6
v_smfmac_f32_16x16x64_bf16 v[104:107], v[32:35], a[64:71], v6
v_smfmac_f32_16x16x64_bf16 v[108:111], v[32:35], a[96:103], v6
s_branch mega_kernel_rf_pa_10_1
mega_kernel_rf_pa_11_1f:
s_mov_b64 exec, vcc
buffer_load_dwordx4 v[36:39], v7, s[84:87], s33 offen offset:1024 sc1
s_mov_b64 exec, -1
s_branch mega_kernel_rf_pa_11_3
mega_kernel_rf_pa_11_1:
s_waitcnt vmcnt(2)
v_max_u32 v4, v36, v38
v_cmp_eq_u32 vcc, -1, v4
s_cbranch_vccnz mega_kernel_rf_pa_11_1f
v_smfmac_f32_16x16x64_bf16 v[96:99], v[36:39], a[8:15], v6
v_smfmac_f32_16x16x64_bf16 v[100:103], v[36:39], a[40:47], v6
v_smfmac_f32_16x16x64_bf16 v[104:107], v[36:39], a[72:79], v6
v_smfmac_f32_16x16x64_bf16 v[108:111], v[36:39], a[104:111], v6
s_branch mega_kernel_rf_pa_9_3
mega_kernel_rf_pa_11_3f:
s_mov_b64 exec, vcc
buffer_load_dwordx4 v[44:47], v7, s[84:87], s33 offen offset:3072 sc1
s_mov_b64 exec, -1
s_branch mega_kernel_rf_pa_11_0
mega_kernel_rf_pa_11_3:
s_waitcnt vmcnt(2)
v_max_u32 v4, v44, v46
v_cmp_eq_u32 vcc, -1, v4
s_cbranch_vccnz mega_kernel_rf_pa_11_3f
v_smfmac_f32_16x16x64_bf16 v[96:99], v[44:47], a[24:31], v6
v_smfmac_f32_16x16x64_bf16 v[100:103], v[44:47], a[56:63], v6
v_smfmac_f32_16x16x64_bf16 v[104:107], v[44:47], a[88:95], v6
v_smfmac_f32_16x16x64_bf16 v[108:111], v[44:47], a[120:127], v6
s_branch mega_kernel_rf_pa_3_0
mega_kernel_rf_pa_12_2f:
s_mov_b64 exec, vcc
buffer_load_dwordx4 v[40:43], v7, s[84:87], s33 offen offset:2048 sc1
s_mov_b64 exec, -1
s_branch mega_kernel_rf_pa_12_3
mega_kernel_rf_pa_12_2:
s_waitcnt vmcnt(1)
v_max_u32 v4, v40, v42
v_cmp_eq_u32 vcc, -1, v4
s_cbranch_vccnz mega_kernel_rf_pa_12_2f
v_smfmac_f32_16x16x64_bf16 v[96:99], v[40:43], a[16:23], v6
v_smfmac_f32_16x16x64_bf16 v[100:103], v[40:43], a[48:55], v6
v_smfmac_f32_16x16x64_bf16 v[104:107], v[40:43], a[80:87], v6
v_smfmac_f32_16x16x64_bf16 v[108:111], v[40:43], a[112:119], v6
s_branch mega_kernel_rf_pa_8_3
mega_kernel_rf_pa_12_3f:
s_mov_b64 exec, vcc
buffer_load_dwordx4 v[44:47], v7, s[84:87], s33 offen offset:3072 sc1
s_mov_b64 exec, -1
s_branch mega_kernel_rf_pa_12_2
mega_kernel_rf_pa_12_3:
s_waitcnt vmcnt(1)
v_max_u32 v4, v44, v46
v_cmp_eq_u32 vcc, -1, v4
s_cbranch_vccnz mega_kernel_rf_pa_12_3f
v_smfmac_f32_16x16x64_bf16 v[96:99], v[44:47], a[24:31], v6
v_smfmac_f32_16x16x64_bf16 v[100:103], v[44:47], a[56:63], v6
v_smfmac_f32_16x16x64_bf16 v[104:107], v[44:47], a[88:95], v6
v_smfmac_f32_16x16x64_bf16 v[108:111], v[44:47], a[120:127], v6
s_branch mega_kernel_rf_pa_4_2
mega_kernel_rf_pa_13_0f:
s_mov_b64 exec, vcc
buffer_load_dwordx4 v[32:35], v7, s[84:87], s33 offen offset:0 sc1
s_mov_b64 exec, -1
s_branch mega_kernel_rf_pa_13_2
mega_kernel_rf_pa_13_0:
s_waitcnt vmcnt(2)
v_max_u32 v4, v32, v34
v_cmp_eq_u32 vcc, -1, v4
s_cbranch_vccnz mega_kernel_rf_pa_13_0f
v_smfmac_f32_16x16x64_bf16 v[96:99], v[32:35], a[0:7], v6
v_smfmac_f32_16x16x64_bf16 v[100:103], v[32:35], a[32:39], v6
v_smfmac_f32_16x16x64_bf16 v[104:107], v[32:35], a[64:71], v6
v_smfmac_f32_16x16x64_bf16 v[108:111], v[32:35], a[96:103], v6
s_branch mega_kernel_rf_pa_12_2
mega_kernel_rf_pa_13_2f:
s_mov_b64 exec, vcc
buffer_load_dwordx4 v[40:43], v7, s[84:87], s33 offen offset:2048 sc1
s_mov_b64 exec, -1
s_branch mega_kernel_rf_pa_13_3
mega_kernel_rf_pa_13_2:
s_waitcnt vmcnt(2)
v_max_u32 v4, v40, v42
v_cmp_eq_u32 vcc, -1, v4
s_cbranch_vccnz mega_kernel_rf_pa_13_2f
v_smfmac_f32_16x16x64_bf16 v[96:99], v[40:43], a[16:23], v6
v_smfmac_f32_16x16x64_bf16 v[100:103], v[40:43], a[48:55], v6
v_smfmac_f32_16x16x64_bf16 v[104:107], v[40:43], a[80:87], v6
v_smfmac_f32_16x16x64_bf16 v[108:111], v[40:43], a[112:119], v6
s_branch mega_kernel_rf_pa_9_3
mega_kernel_rf_pa_13_3f:
s_mov_b64 exec, vcc
buffer_load_dwordx4 v[44:47], v7, s[84:87], s33 offen offset:3072 sc1
s_mov_b64 exec, -1
s_branch mega_kernel_rf_pa_13_0
mega_kernel_rf_pa_13_3:
s_waitcnt vmcnt(2)
v_max_u32 v4, v44, v46
v_cmp_eq_u32 vcc, -1, v4
s_cbranch_vccnz mega_kernel_rf_pa_13_3f
v_smfmac_f32_16x16x64_bf16 v[96:99], v[44:47], a[24:31], v6
v_smfmac_f32_16x16x64_bf16 v[100:103], v[44:47], a[56:63], v6
v_smfmac_f32_16x16x64_bf16 v[104:107], v[44:47], a[88:95], v6
v_smfmac_f32_16x16x64_bf16 v[108:111], v[44:47], a[120:127], v6
s_branch mega_kernel_rf_pa_5_0
mega_kernel_rf_pa_14_1f:
s_mov_b64 exec, vcc
buffer_load_dwordx4 v[36:39], v7, s[84:87], s33 offen offset:1024 sc1
s_mov_b64 exec, -1
s_branch mega_kernel_rf_pa_14_2
mega_kernel_rf_pa_14_1:
s_waitcnt vmcnt(2)
v_max_u32 v4, v36, v38
v_cmp_eq_u32 vcc, -1, v4
s_cbranch_vccnz mega_kernel_rf_pa_14_1f
v_smfmac_f32_16x16x64_bf16 v[96:99], v[36:39], a[8:15], v6
v_smfmac_f32_16x16x64_bf16 v[100:103], v[36:39], a[40:47], v6
v_smfmac_f32_16x16x64_bf16 v[104:107], v[36:39], a[72:79], v6
v_smfmac_f32_16x16x64_bf16 v[108:111], v[36:39], a[104:111], v6
s_branch mega_kernel_rf_pa_12_2
mega_kernel_rf_pa_14_2f:
s_mov_b64 exec, vcc
buffer_load_dwordx4 v[40:43], v7, s[84:87], s33 offen offset:2048 sc1
s_mov_b64 exec, -1
s_branch mega_kernel_rf_pa_14_3
mega_kernel_rf_pa_14_2:
s_waitcnt vmcnt(2)
v_max_u32 v4, v40, v42
v_cmp_eq_u32 vcc, -1, v4
s_cbranch_vccnz mega_kernel_rf_pa_14_2f
v_smfmac_f32_16x16x64_bf16 v[96:99], v[40:43], a[16:23], v6
v_smfmac_f32_16x16x64_bf16 v[100:103], v[40:43], a[48:55], v6
v_smfmac_f32_16x16x64_bf16 v[104:107], v[40:43], a[80:87], v6
v_smfmac_f32_16x16x64_bf16 v[108:111], v[40:43], a[112:119], v6
s_branch mega_kernel_rf_pa_10_3
mega_kernel_rf_pa_14_3f:
s_mov_b64 exec, vcc
buffer_load_dwordx4 v[44:47], v7, s[84:87], s33 offen offset:3072 sc1
s_mov_b64 exec, -1
s_branch mega_kernel_rf_pa_14_1
mega_kernel_rf_pa_14_3:
s_waitcnt vmcnt(2)
v_max_u32 v4, v44, v46
v_cmp_eq_u32 vcc, -1, v4
s_cbranch_vccnz mega_kernel_rf_pa_14_3f
v_smfmac_f32_16x16x64_bf16 v[96:99], v[44:47], a[24:31], v6
v_smfmac_f32_16x16x64_bf16 v[100:103], v[44:47], a[56:63], v6
v_smfmac_f32_16x16x64_bf16 v[104:107], v[44:47], a[88:95], v6
v_smfmac_f32_16x16x64_bf16 v[108:111], v[44:47], a[120:127], v6
s_branch mega_kernel_rf_pa_6_1
mega_kernel_rf_pa_15_0f:
s_mov_b64 exec, vcc
buffer_load_dwordx4 v[32:35], v7, s[84:87], s33 offen offset:0 sc1
s_mov_b64 exec, -1
s_branch mega_kernel_rf_pa_15_1
mega_kernel_rf_pa_15_0:
s_waitcnt vmcnt(3)
v_max_u32 v4, v32, v34
v_cmp_eq_u32 vcc, -1, v4
s_cbranch_vccnz mega_kernel_rf_pa_15_0f
v_smfmac_f32_16x16x64_bf16 v[96:99], v[32:35], a[0:7], v6
v_smfmac_f32_16x16x64_bf16 v[100:103], v[32:35], a[32:39], v6
v_smfmac_f32_16x16x64_bf16 v[104:107], v[32:35], a[64:71], v6
v_smfmac_f32_16x16x64_bf16 v[108:111], v[32:35], a[96:103], v6
s_branch mega_kernel_rf_pa_14_1
mega_kernel_rf_pa_15_1f:
s_mov_b64 exec, vcc
buffer_load_dwordx4 v[36:39], v7, s[84:87], s33 offen offset:1024 sc1
s_mov_b64 exec, -1
s_branch mega_kernel_rf_pa_15_2
mega_kernel_rf_pa_15_1:
s_waitcnt vmcnt(3)
v_max_u32 v4, v36, v38
v_cmp_eq_u32 vcc, -1, v4
s_cbranch_vccnz mega_kernel_rf_pa_15_1f
v_smfmac_f32_16x16x64_bf16 v[96:99], v[36:39], a[8:15], v6
v_smfmac_f32_16x16x64_bf16 v[100:103], v[36:39], a[40:47], v6
v_smfmac_f32_16x16x64_bf16 v[104:107], v[36:39], a[72:79], v6
v_smfmac_f32_16x16x64_bf16 v[108:111], v[36:39], a[104:111], v6
s_branch mega_kernel_rf_pa_13_2
mega_kernel_rf_pa_15_2f:
s_mov_b64 exec, vcc
buffer_load_dwordx4 v[40:43], v7, s[84:87], s33 offen offset:2048 sc1
s_mov_b64 exec, -1
s_branch mega_kernel_rf_pa_15_3
mega_kernel_rf_pa_15_2:
s_waitcnt vmcnt(3)
v_max_u32 v4, v40, v42
v_cmp_eq_u32 vcc, -1, v4
s_cbranch_vccnz mega_kernel_rf_pa_15_2f
v_smfmac_f32_16x16x64_bf16 v[96:99], v[40:43], a[16:23], v6
v_smfmac_f32_16x16x64_bf16 v[100:103], v[40:43], a[48:55], v6
v_smfmac_f32_16x16x64_bf16 v[104:107], v[40:43], a[80:87], v6
v_smfmac_f32_16x16x64_bf16 v[108:111], v[40:43], a[112:119], v6
s_branch mega_kernel_rf_pa_11_3
mega_kernel_rf_pa_15_3f:
s_mov_b64 exec, vcc
buffer_load_dwordx4 v[44:47], v7, s[84:87], s33 offen offset:3072 sc1
s_mov_b64 exec, -1
s_branch mega_kernel_rf_pa_15_0
mega_kernel_rf_pa_15_3:
s_waitcnt vmcnt(3)
v_max_u32 v4, v44, v46
v_cmp_eq_u32 vcc, -1, v4
s_cbranch_vccnz mega_kernel_rf_pa_15_3f
v_smfmac_f32_16x16x64_bf16 v[96:99], v[44:47], a[24:31], v6
v_smfmac_f32_16x16x64_bf16 v[100:103], v[44:47], a[56:63], v6
v_smfmac_f32_16x16x64_bf16 v[104:107], v[44:47], a[88:95], v6
v_smfmac_f32_16x16x64_bf16 v[108:111], v[44:47], a[120:127], v6
s_branch mega_kernel_rf_pa_7_0
mega_kernel_rf_pc_1_0f:
s_mov_b64 exec, vcc
buffer_load_dwordx4 v[32:35], v7, s[84:87], s29 offen offset:0 sc1
s_mov_b64 exec, -1
s_branch mega_kernel_rf_pc_1_0
mega_kernel_rf_pc_1_0:
s_waitcnt vmcnt(0)
v_cmp_eq_u32 vcc, -1, v32
s_cbranch_vccnz mega_kernel_rf_pc_1_0f
v_smfmac_f32_16x16x64_bf16 v[96:99], v[32:35], a[192:199], v6
v_smfmac_f32_16x16x64_bf16 v[100:103], v[32:35], a[224:231], v6
s_branch mega_kernel_rf_pc_d
mega_kernel_rf_pc_2_1f:
s_mov_b64 exec, vcc
buffer_load_dwordx4 v[36:39], v7, s[84:87], s29 offen offset:1024 sc1
s_mov_b64 exec, -1
s_branch mega_kernel_rf_pc_2_1
mega_kernel_rf_pc_2_1:
s_waitcnt vmcnt(0)
v_cmp_eq_u32 vcc, -1, v36
s_cbranch_vccnz mega_kernel_rf_pc_2_1f
v_smfmac_f32_16x16x64_bf16 v[96:99], v[36:39], a[200:207], v6
v_smfmac_f32_16x16x64_bf16 v[100:103], v[36:39], a[232:239], v6
s_branch mega_kernel_rf_pc_d
mega_kernel_rf_pc_3_0f:
s_mov_b64 exec, vcc
buffer_load_dwordx4 v[32:35], v7, s[84:87], s29 offen offset:0 sc1
s_mov_b64 exec, -1
s_branch mega_kernel_rf_pc_3_1
mega_kernel_rf_pc_3_0:
s_waitcnt vmcnt(1)
v_cmp_eq_u32 vcc, -1, v32
s_cbranch_vccnz mega_kernel_rf_pc_3_0f
v_smfmac_f32_16x16x64_bf16 v[96:99], v[32:35], a[192:199], v6
v_smfmac_f32_16x16x64_bf16 v[100:103], v[32:35], a[224:231], v6
s_branch mega_kernel_rf_pc_2_1
mega_kernel_rf_pc_3_1f:
s_mov_b64 exec, vcc
buffer_load_dwordx4 v[36:39], v7, s[84:87], s29 offen offset:1024 sc1
s_mov_b64 exec, -1
s_branch mega_kernel_rf_pc_3_0
mega_kernel_rf_pc_3_1:
s_waitcnt vmcnt(1)
v_cmp_eq_u32 vcc, -1, v36
s_cbranch_vccnz mega_kernel_rf_pc_3_1f
v_smfmac_f32_16x16x64_bf16 v[96:99], v[36:39], a[200:207], v6
v_smfmac_f32_16x16x64_bf16 v[100:103], v[36:39], a[232:239], v6
s_branch mega_kernel_rf_pc_1_0
mega_kernel_rf_pc_4_2f:
s_mov_b64 exec, vcc
buffer_load_dwordx4 v[40:43], v7, s[84:87], s29 offen offset:2048 sc1
s_mov_b64 exec, -1
s_branch mega_kernel_rf_pc_4_2
mega_kernel_rf_pc_4_2:
s_waitcnt vmcnt(0)
v_cmp_eq_u32 vcc, -1, v40
s_cbranch_vccnz mega_kernel_rf_pc_4_2f
v_smfmac_f32_16x16x64_bf16 v[96:99], v[40:43], a[208:215], v6
v_smfmac_f32_16x16x64_bf16 v[100:103], v[40:43], a[240:247], v6
s_branch mega_kernel_rf_pc_d
mega_kernel_rf_pc_5_0f:
s_mov_b64 exec, vcc
buffer_load_dwordx4 v[32:35], v7, s[84:87], s29 offen offset:0 sc1
s_mov_b64 exec, -1
s_branch mega_kernel_rf_pc_5_2
mega_kernel_rf_pc_5_0:
s_waitcnt vmcnt(1)
v_cmp_eq_u32 vcc, -1, v32
s_cbranch_vccnz mega_kernel_rf_pc_5_0f
v_smfmac_f32_16x16x64_bf16 v[96:99], v[32:35], a[192:199], v6
v_smfmac_f32_16x16x64_bf16 v[100:103], v[32:35], a[224:231], v6
s_branch mega_kernel_rf_pc_4_2
mega_kernel_rf_pc_5_2f:
s_mov_b64 exec, vcc
buffer_load_dwordx4 v[40:43], v7, s[84:87], s29 offen offset:2048 sc1
s_mov_b64 exec, -1
s_branch mega_kernel_rf_pc_5_0
mega_kernel_rf_pc_5_2:
s_waitcnt vmcnt(1)
v_cmp_eq_u32 vcc, -1, v40
s_cbranch_vccnz mega_kernel_rf_pc_5_2f
v_smfmac_f32_16x16x64_bf16 v[96:99], v[40:43], a[208:215], v6
v_smfmac_f32_16x16x64_bf16 v[100:103], v[40:43], a[240:247], v6
s_branch mega_kernel_rf_pc_1_0
mega_kernel_rf_pc_6_1f:
s_mov_b64 exec, vcc
buffer_load_dwordx4 v[36:39], v7, s[84:87], s29 offen offset:1024 sc1
s_mov_b64 exec, -1
s_branch mega_kernel_rf_pc_6_2
mega_kernel_rf_pc_6_1:
s_waitcnt vmcnt(1)
v_cmp_eq_u32 vcc, -1, v36
s_cbranch_vccnz mega_kernel_rf_pc_6_1f
v_smfmac_f32_16x16x64_bf16 v[96:99], v[36:39], a[200:207], v6
v_smfmac_f32_16x16x64_bf16 v[100:103], v[36:39], a[232:239], v6
s_branch mega_kernel_rf_pc_4_2
mega_kernel_rf_pc_6_2f:
s_mov_b64 exec, vcc
buffer_load_dwordx4 v[40:43], v7, s[84:87], s29 offen offset:2048 sc1
s_mov_b64 exec, -1
s_branch mega_kernel_rf_pc_6_1
mega_kernel_rf_pc_6_2:
s_waitcnt vmcnt(1)
v_cmp_eq_u32 vcc, -1, v40
s_cbranch_vccnz mega_kernel_rf_pc_6_2f
v_smfmac_f32_16x16x64_bf16 v[96:99], v[40:43], a[208:215], v6
v_smfmac_f32_16x16x64_bf16 v[100:103], v[40:43], a[240:247], v6
s_branch mega_kernel_rf_pc_2_1
mega_kernel_rf_pc_7_0f:
s_mov_b64 exec, vcc
buffer_load_dwordx4 v[32:35], v7, s[84:87], s29 offen offset:0 sc1
s_mov_b64 exec, -1
s_branch mega_kernel_rf_pc_7_1
mega_kernel_rf_pc_7_0:
s_waitcnt vmcnt(2)
v_cmp_eq_u32 vcc, -1, v32
s_cbranch_vccnz mega_kernel_rf_pc_7_0f
v_smfmac_f32_16x16x64_bf16 v[96:99], v[32:35], a[192:199], v6
v_smfmac_f32_16x16x64_bf16 v[100:103], v[32:35], a[224:231], v6
s_branch mega_kernel_rf_pc_6_1
mega_kernel_rf_pc_7_1f:
s_mov_b64 exec, vcc
buffer_load_dwordx4 v[36:39], v7, s[84:87], s29 offen offset:1024 sc1
s_mov_b64 exec, -1
s_branch mega_kernel_rf_pc_7_2
mega_kernel_rf_pc_7_1:
s_waitcnt vmcnt(2)
v_cmp_eq_u32 vcc, -1, v36
s_cbranch_vccnz mega_kernel_rf_pc_7_1f
v_smfmac_f32_16x16x64_bf16 v[96:99], v[36:39], a[200:207], v6
v_smfmac_f32_16x16x64_bf16 v[100:103], v[36:39], a[232:239], v6
s_branch mega_kernel_rf_pc_5_2
mega_kernel_rf_pc_7_2f:
s_mov_b64 exec, vcc
buffer_load_dwordx4 v[40:43], v7, s[84:87], s29 offen offset:2048 sc1
s_mov_b64 exec, -1
s_branch mega_kernel_rf_pc_7_0
mega_kernel_rf_pc_7_2:
s_waitcnt vmcnt(2)
v_cmp_eq_u32 vcc, -1, v40
s_cbranch_vccnz mega_kernel_rf_pc_7_2f
v_smfmac_f32_16x16x64_bf16 v[96:99], v[40:43], a[208:215], v6
v_smfmac_f32_16x16x64_bf16 v[100:103], v[40:43], a[240:247], v6
s_branch mega_kernel_rf_pc_3_0
mega_kernel_rf_pc_8_3f:
s_mov_b64 exec, vcc
buffer_load_dwordx4 v[44:47], v7, s[84:87], s29 offen offset:3072 sc1
s_mov_b64 exec, -1
s_branch mega_kernel_rf_pc_8_3
mega_kernel_rf_pc_9_0f:
s_mov_b64 exec, vcc
buffer_load_dwordx4 v[32:35], v7, s[84:87], s29 offen offset:0 sc1
s_mov_b64 exec, -1
s_branch mega_kernel_rf_pc_9_3
mega_kernel_rf_pc_9_0:
s_waitcnt vmcnt(1)
v_cmp_eq_u32 vcc, -1, v32
s_cbranch_vccnz mega_kernel_rf_pc_9_0f
v_smfmac_f32_16x16x64_bf16 v[96:99], v[32:35], a[192:199], v6
v_smfmac_f32_16x16x64_bf16 v[100:103], v[32:35], a[224:231], v6
s_branch mega_kernel_rf_pc_8_3
mega_kernel_rf_pc_9_3f:
s_mov_b64 exec, vcc
buffer_load_dwordx4 v[44:47], v7, s[84:87], s29 offen offset:3072 sc1
s_mov_b64 exec, -1
s_branch mega_kernel_rf_pc_9_0
mega_kernel_rf_pc_9_3:
s_waitcnt vmcnt(1)
v_cmp_eq_u32 vcc, -1, v44
s_cbranch_vccnz mega_kernel_rf_pc_9_3f
v_smfmac_f32_16x16x64_bf16 v[96:99], v[44:47], a[216:223], v6
v_smfmac_f32_16x16x64_bf16 v[100:103], v[44:47], a[248:255], v6
s_branch mega_kernel_rf_pc_1_0
mega_kernel_rf_pc_10_1f:
s_mov_b64 exec, vcc
buffer_load_dwordx4 v[36:39], v7, s[84:87], s29 offen offset:1024 sc1
s_mov_b64 exec, -1
s_branch mega_kernel_rf_pc_10_3
mega_kernel_rf_pc_10_1:
s_waitcnt vmcnt(1)
v_cmp_eq_u32 vcc, -1, v36
s_cbranch_vccnz mega_kernel_rf_pc_10_1f
v_smfmac_f32_16x16x64_bf16 v[96:99], v[36:39], a[200:207], v6
v_smfmac_f32_16x16x64_bf16 v[100:103], v[36:39], a[232:239], v6
s_branch mega_kernel_rf_pc_8_3
mega_kernel_rf_pc_10_3f:
s_mov_b64 exec, vcc
buffer_load_dwordx4 v[44:47], v7, s[84:87], s29 offen offset:3072 sc1
s_mov_b64 exec, -1
s_branch mega_kernel_rf_pc_10_1
mega_kernel_rf_pc_10_3:
s_waitcnt vmcnt(1)
v_cmp_eq_u32 vcc, -1, v44
s_cbranch_vccnz mega_kernel_rf_pc_10_3f
v_smfmac_f32_16x16x64_bf16 v[96:99], v[44:47], a[216:223], v6
v_smfmac_f32_16x16x64_bf16 v[100:103], v[44:47], a[248:255], v6
s_branch mega_kernel_rf_pc_2_1
mega_kernel_rf_pc_11_0f:
s_mov_b64 exec, vcc
buffer_load_dwordx4 v[32:35], v7, s[84:87], s29 offen offset:0 sc1
s_mov_b64 exec, -1
s_branch mega_kernel_rf_pc_11_1
mega_kernel_rf_pc_11_0:
s_waitcnt vmcnt(2)
v_cmp_eq_u32 vcc, -1, v32
s_cbranch_vccnz mega_kernel_rf_pc_11_0f
v_smfmac_f32_16x16x64_bf16 v[96:99], v[32:35], a[192:199], v6
v_smfmac_f32_16x16x64_bf16 v[100:103], v[32:35], a[224:231], v6
s_branch mega_kernel_rf_pc_10_1
mega_kernel_rf_pc_11_1f:
s_mov_b64 exec, vcc
buffer_load_dwordx4 v[36:39], v7, s[84:87], s29 offen offset:1024 sc1
s_mov_b64 exec, -1
s_branch mega_kernel_rf_pc_11_3
mega_kernel_rf_pc_11_1:
s_waitcnt vmcnt(2)
v_cmp_eq_u32 vcc, -1, v36
s_cbranch_vccnz mega_kernel_rf_pc_11_1f
v_smfmac_f32_16x16x64_bf16 v[96:99], v[36:39], a[200:207], v6
v_smfmac_f32_16x16x64_bf16 v[100:103], v[36:39], a[232:239], v6
s_branch mega_kernel_rf_pc_9_3
mega_kernel_rf_pc_11_3f:
s_mov_b64 exec, vcc
buffer_load_dwordx4 v[44:47], v7, s[84:87], s29 offen offset:3072 sc1
s_mov_b64 exec, -1
s_branch mega_kernel_rf_pc_11_0
mega_kernel_rf_pc_11_3:
s_waitcnt vmcnt(2)
v_cmp_eq_u32 vcc, -1, v44
s_cbranch_vccnz mega_kernel_rf_pc_11_3f
v_smfmac_f32_16x16x64_bf16 v[96:99], v[44:47], a[216:223], v6
v_smfmac_f32_16x16x64_bf16 v[100:103], v[44:47], a[248:255], v6
s_branch mega_kernel_rf_pc_3_0
mega_kernel_rf_pc_12_2f:
s_mov_b64 exec, vcc
buffer_load_dwordx4 v[40:43], v7, s[84:87], s29 offen offset:2048 sc1
s_mov_b64 exec, -1
s_branch mega_kernel_rf_pc_12_3
mega_kernel_rf_pc_12_3f:
s_mov_b64 exec, vcc
buffer_load_dwordx4 v[44:47], v7, s[84:87], s29 offen offset:3072 sc1
s_mov_b64 exec, -1
s_branch mega_kernel_rf_pc_12_2
mega_kernel_rf_pc_12_3:
s_waitcnt vmcnt(1)
v_cmp_eq_u32 vcc, -1, v44
s_cbranch_vccnz mega_kernel_rf_pc_12_3f
v_smfmac_f32_16x16x64_bf16 v[96:99], v[44:47], a[216:223], v6
v_smfmac_f32_16x16x64_bf16 v[100:103], v[44:47], a[248:255], v6
s_branch mega_kernel_rf_pc_4_2
mega_kernel_rf_pc_13_0f:
s_mov_b64 exec, vcc
buffer_load_dwordx4 v[32:35], v7, s[84:87], s29 offen offset:0 sc1
s_mov_b64 exec, -1
s_branch mega_kernel_rf_pc_13_2
mega_kernel_rf_pc_13_0:
s_waitcnt vmcnt(2)
v_cmp_eq_u32 vcc, -1, v32
s_cbranch_vccnz mega_kernel_rf_pc_13_0f
v_smfmac_f32_16x16x64_bf16 v[96:99], v[32:35], a[192:199], v6
v_smfmac_f32_16x16x64_bf16 v[100:103], v[32:35], a[224:231], v6
s_branch mega_kernel_rf_pc_12_2
mega_kernel_rf_pc_13_2f:
s_mov_b64 exec, vcc
buffer_load_dwordx4 v[40:43], v7, s[84:87], s29 offen offset:2048 sc1
s_mov_b64 exec, -1
s_branch mega_kernel_rf_pc_13_3
mega_kernel_rf_pc_13_2:
s_waitcnt vmcnt(2)
v_cmp_eq_u32 vcc, -1, v40
s_cbranch_vccnz mega_kernel_rf_pc_13_2f
v_smfmac_f32_16x16x64_bf16 v[96:99], v[40:43], a[208:215], v6
v_smfmac_f32_16x16x64_bf16 v[100:103], v[40:43], a[240:247], v6
s_branch mega_kernel_rf_pc_9_3
mega_kernel_rf_pc_13_3f:
s_mov_b64 exec, vcc
buffer_load_dwordx4 v[44:47], v7, s[84:87], s29 offen offset:3072 sc1
s_mov_b64 exec, -1
s_branch mega_kernel_rf_pc_13_0
mega_kernel_rf_pc_13_3:
s_waitcnt vmcnt(2)
v_cmp_eq_u32 vcc, -1, v44
s_cbranch_vccnz mega_kernel_rf_pc_13_3f
v_smfmac_f32_16x16x64_bf16 v[96:99], v[44:47], a[216:223], v6
v_smfmac_f32_16x16x64_bf16 v[100:103], v[44:47], a[248:255], v6
s_branch mega_kernel_rf_pc_5_0
mega_kernel_rf_pc_14_1f:
s_mov_b64 exec, vcc
buffer_load_dwordx4 v[36:39], v7, s[84:87], s29 offen offset:1024 sc1
s_mov_b64 exec, -1
s_branch mega_kernel_rf_pc_14_2
mega_kernel_rf_pc_14_2f:
s_mov_b64 exec, vcc
buffer_load_dwordx4 v[40:43], v7, s[84:87], s29 offen offset:2048 sc1
s_mov_b64 exec, -1
s_branch mega_kernel_rf_pc_14_3
mega_kernel_rf_pc_14_2:
s_waitcnt vmcnt(2)
v_cmp_eq_u32 vcc, -1, v40
s_cbranch_vccnz mega_kernel_rf_pc_14_2f
v_smfmac_f32_16x16x64_bf16 v[96:99], v[40:43], a[208:215], v6
v_smfmac_f32_16x16x64_bf16 v[100:103], v[40:43], a[240:247], v6
s_branch mega_kernel_rf_pc_10_3
mega_kernel_rf_pc_14_3f:
s_mov_b64 exec, vcc
buffer_load_dwordx4 v[44:47], v7, s[84:87], s29 offen offset:3072 sc1
s_mov_b64 exec, -1
s_branch mega_kernel_rf_pc_14_1
mega_kernel_rf_pc_14_3:
s_waitcnt vmcnt(2)
v_cmp_eq_u32 vcc, -1, v44
s_cbranch_vccnz mega_kernel_rf_pc_14_3f
v_smfmac_f32_16x16x64_bf16 v[96:99], v[44:47], a[216:223], v6
v_smfmac_f32_16x16x64_bf16 v[100:103], v[44:47], a[248:255], v6
s_branch mega_kernel_rf_pc_6_1
mega_kernel_rf_pc_15_0f:
s_mov_b64 exec, vcc
buffer_load_dwordx4 v[32:35], v7, s[84:87], s29 offen offset:0 sc1
s_mov_b64 exec, -1
s_branch mega_kernel_rf_pc_15_1
mega_kernel_rf_pc_15_1f:
s_mov_b64 exec, vcc
buffer_load_dwordx4 v[36:39], v7, s[84:87], s29 offen offset:1024 sc1
s_mov_b64 exec, -1
s_branch mega_kernel_rf_pc_15_2
mega_kernel_rf_pc_15_1:
s_waitcnt vmcnt(3)
v_cmp_eq_u32 vcc, -1, v36
s_cbranch_vccnz mega_kernel_rf_pc_15_1f
v_smfmac_f32_16x16x64_bf16 v[96:99], v[36:39], a[200:207], v6
v_smfmac_f32_16x16x64_bf16 v[100:103], v[36:39], a[232:239], v6
s_branch mega_kernel_rf_pc_13_2
mega_kernel_rf_pc_15_2f:
s_mov_b64 exec, vcc
buffer_load_dwordx4 v[40:43], v7, s[84:87], s29 offen offset:2048 sc1
s_mov_b64 exec, -1
s_branch mega_kernel_rf_pc_15_3
mega_kernel_rf_pc_15_2:
s_waitcnt vmcnt(3)
v_cmp_eq_u32 vcc, -1, v40
s_cbranch_vccnz mega_kernel_rf_pc_15_2f
v_smfmac_f32_16x16x64_bf16 v[96:99], v[40:43], a[208:215], v6
v_smfmac_f32_16x16x64_bf16 v[100:103], v[40:43], a[240:247], v6
s_branch mega_kernel_rf_pc_11_3
mega_kernel_rf_pc_15_3f:
s_mov_b64 exec, vcc
buffer_load_dwordx4 v[44:47], v7, s[84:87], s29 offen offset:3072 sc1
s_mov_b64 exec, -1
s_branch mega_kernel_rf_pc_15_0
mega_kernel_rf_pc_15_3:
s_waitcnt vmcnt(3)
v_cmp_eq_u32 vcc, -1, v44
s_cbranch_vccnz mega_kernel_rf_pc_15_3f
v_smfmac_f32_16x16x64_bf16 v[96:99], v[44:47], a[216:223], v6
v_smfmac_f32_16x16x64_bf16 v[100:103], v[44:47], a[248:255], v6
s_branch mega_kernel_rf_pc_7_0
mega_kernel_rf_w0last:
s_nop 7
v_permlane32_swap_b32 v112, v116
v_permlane32_swap_b32 v113, v117
v_permlane32_swap_b32 v114, v118
v_permlane32_swap_b32 v115, v119
v_pk_add_f32 v[112:113], v[112:113], v[116:117]
v_pk_add_f32 v[114:115], v[114:115], v[118:119]
ds_write_b128 v20, v[112:115]
s_waitcnt lgkmcnt(0)
s_barrier
s_branch mega_kernel_rf_end
mega_kernel_rf_side:
s_cmp_eq_u32 s24, 3
s_cbranch_scc1 mega_kernel_rf_sd3
s_cmp_eq_u32 s24, 2
s_cbranch_scc0 mega_kernel_rf_sd4
s_mov_b64 exec, s[40:41]
buffer_store_dwordx4 v[28:31], v11, s[84:87], s34 offen
s_mov_b64 exec, -1
s_branch mega_kernel_rf_sd4
mega_kernel_rf_sd3:
s_add_u32 s76, s27, 1
s_cmp_lt_u32 s76, 63
s_cbranch_scc0 mega_kernel_rf_sd4
s_cmp_gt_i32 s46, s76
s_cbranch_scc1 mega_kernel_rf_pf2ok
mega_kernel_rf_pf2w:
buffer_load_dword v4, v24, s[84:87], 0 offen sc1
s_waitcnt vmcnt(0)
v_readlane_b32 s46, v4, 0
v_readlane_b32 s28, v4, 1
s_nop 1
s_min_i32 s46, s46, s28
s_cmp_gt_i32 s46, s76
s_cbranch_scc0 mega_kernel_rf_pf2w
mega_kernel_rf_pf2ok:
s_add_u32 s77, s76, s82
s_bfe_u32 s28, s77, 0x40002
s_lshl_b32 s28, s28, 14
s_and_b32 s77, s77, 3
s_lshl_b32 s77, s77, 11
s_add_u32 s28, s28, s77
s_add_u32 m0, s45, 0
s_nop 0
buffer_load_dwordx4 v240, s[84:87], s28 offen offset:0 sc1 lds
s_add_u32 m0, s45, 0
s_nop 0
buffer_load_dwordx4 v240, s[84:87], s28 offen offset:1024 sc1 lds
s_add_u32 m0, s45, 2048
s_nop 0
buffer_load_dwordx4 v241, s[84:87], s28 offen offset:0 sc1 lds
s_add_u32 m0, s45, 2048
s_nop 0
buffer_load_dwordx4 v241, s[84:87], s28 offen offset:1024 sc1 lds
s_add_u32 s45, s45, 4096
s_cmp_eq_u32 s45, 30720
s_cselect_b32 s45, 18432, s45
mega_kernel_rf_sd4:
v_smfmac_f32_16x16x64_bf16 v[112:115], v[40:43], a[144:151], v6
v_smfmac_f32_16x16x64_bf16 v[116:119], v[40:43], a[176:183], v6
v_smfmac_f32_16x16x64_bf16 v[112:115], v[44:47], a[152:159], v6
v_smfmac_f32_16x16x64_bf16 v[116:119], v[44:47], a[184:191], v6
s_nop 7
v_permlane32_swap_b32 v112, v116
v_permlane32_swap_b32 v113, v117
v_permlane32_swap_b32 v114, v118
v_permlane32_swap_b32 v115, v119
v_pk_add_f32 v[112:113], v[112:113], v[116:117]
v_pk_add_f32 v[114:115], v[114:115], v[118:119]
ds_write_b128 v20, v[112:115]
v_mov_b32 v96, 0
v_mov_b32 v97, 0
v_mov_b32 v98, 0
v_mov_b32 v99, 0
v_mov_b32 v100, 0
v_mov_b32 v101, 0
v_mov_b32 v102, 0
v_mov_b32 v103, 0
s_cmp_eq_u32 s24, 1
s_cbranch_scc0 mega_kernel_rf_s1
s_waitcnt lgkmcnt(0)
ds_read_b128 v[120:123], v16 offset:0
ds_read_b128 v[124:127], v16 offset:16
ds_read_b128 v[128:131], v16 offset:2304
ds_read_b128 v[132:135], v16 offset:2320
ds_read_b128 v[136:139], v16 offset:4608
ds_read_b128 v[140:143], v16 offset:4624
ds_read_b128 v[144:147], v16 offset:6912
ds_read_b128 v[148:151], v16 offset:6928
s_waitcnt lgkmcnt(4)
v_pk_add_f32 v[120:121], v[120:121], v[128:129]
v_pk_add_f32 v[122:123], v[122:123], v[130:131]
v_pk_add_f32 v[124:125], v[124:125], v[132:133]
v_pk_add_f32 v[126:127], v[126:127], v[134:135]
s_waitcnt lgkmcnt(0)
v_pk_add_f32 v[136:137], v[136:137], v[144:145]
v_pk_add_f32 v[138:139], v[138:139], v[146:147]
v_pk_add_f32 v[140:141], v[140:141], v[148:149]
v_pk_add_f32 v[142:143], v[142:143], v[150:151]
v_pk_add_f32 v[120:121], v[120:121], v[136:137]
v_pk_add_f32 v[122:123], v[122:123], v[138:139]
v_pk_add_f32 v[124:125], v[124:125], v[140:141]
v_pk_add_f32 v[126:127], v[126:127], v[142:143]
v_cvt_pk_bf16_f32 v244, v120, v121
v_cvt_pk_bf16_f32 v245, v122, v123
v_cvt_pk_bf16_f32 v246, v124, v125
v_cvt_pk_bf16_f32 v247, v126, v127
mega_kernel_rf_s1:
v_add_u32 v5, 9216, v17
s_waitcnt lgkmcnt(0)
s_barrier
s_cmp_eq_u32 s24, 2
s_cbranch_scc1 mega_kernel_rf_s2
s_cmp_eq_u32 s24, 3
s_cbranch_scc0 mega_kernel_rf_s3
s_add_u32 s76, s27, 2
s_cmp_lt_u32 s76, 63
s_cbranch_scc0 mega_kernel_rf_s3
s_cmp_gt_i32 s46, s76
s_cbranch_scc0 mega_kernel_rf_s3
s_add_u32 s77, s76, s82
s_bfe_u32 s28, s77, 0x40002
s_lshl_b32 s28, s28, 14
s_and_b32 s77, s77, 3
s_lshl_b32 s77, s77, 11
s_add_u32 s28, s28, s77
s_add_u32 s28, s28, s83
s_buffer_load_dword s78, s[84:87], s28 offset:0
s_buffer_load_dword s78, s[84:87], s28 offset:128
s_buffer_load_dword s78, s[84:87], s28 offset:256
s_buffer_load_dword s78, s[84:87], s28 offset:384
s_buffer_load_dword s78, s[84:87], s28 offset:512
s_buffer_load_dword s78, s[84:87], s28 offset:640
s_buffer_load_dword s78, s[84:87], s28 offset:768
s_buffer_load_dword s78, s[84:87], s28 offset:896
s_buffer_load_dword s78, s[84:87], s28 offset:1024
s_buffer_load_dword s78, s[84:87], s28 offset:1152
s_buffer_load_dword s78, s[84:87], s28 offset:1280
s_buffer_load_dword s78, s[84:87], s28 offset:1408
s_buffer_load_dword s78, s[84:87], s28 offset:1536
s_buffer_load_dword s78, s[84:87], s28 offset:1664
s_buffer_load_dword s78, s[84:87], s28 offset:1792
s_buffer_load_dword s78, s[84:87], s28 offset:1920
s_branch mega_kernel_rf_s3
mega_kernel_rf_s2:
ds_read_b128 v[120:123], v5 offset:0
ds_read_b128 v[124:127], v5 offset:1024
ds_read_b128 v[128:131], v5 offset:2048
ds_read_b128 v[132:135], v5 offset:3072
v_lshrrev_b32 v5, 1, v17
s_waitcnt lgkmcnt(2)
v_pk_add_f32 v[120:121], v[120:121], v[124:125]
v_pk_add_f32 v[122:123], v[122:123], v[126:127]
s_waitcnt lgkmcnt(0)
v_pk_add_f32 v[128:129], v[128:129], v[132:133]
v_pk_add_f32 v[130:131], v[130:131], v[134:135]
v_pk_add_f32 v[120:121], v[120:121], v[128:129]
v_pk_add_f32 v[122:123], v[122:123], v[130:131]
v_cvt_pk_bf16_f32 v244, v120, v121
v_cvt_pk_bf16_f32 v245, v122, v123
ds_write_b64 v5, v[244:245] offset:17920
s_waitcnt lgkmcnt(0)
mega_kernel_rf_s3:
s_cmp_eq_u32 s27, 63
s_cbranch_scc1 mega_kernel_rf_slast
s_add_u32 s29, s33, 16384
s_barrier
s_cmp_eq_u32 s24, 3
s_cbranch_scc1 mega_kernel_rf_y3
s_add_u32 s77, s27, s82
s_bfe_u32 s28, s77, 0x30003
s_lshl_b32 s28, s28, 14
s_and_b32 s77, s77, 7
s_lshl_b32 s77, s77, 10
s_add_u32 s28, s28, s77
s_add_u32 s28, s28, s79
s_cmp_eq_u32 s24, 2
s_cbranch_scc1 mega_kernel_rf_kv2a
s_mov_b64 exec, s[48:49]
buffer_store_dwordx4 v[244:247], v22, s[84:87], s28 offen sc1
s_mov_b64 exec, -1
s_branch mega_kernel_rf_kvda
mega_kernel_rf_kv2a:
v_lshlrev_b32 v4, 3, v1
buffer_store_dwordx2 v[244:245], v4, s[84:87], s28 offen offset:512 sc1
mega_kernel_rf_kvda:
s_branch mega_kernel_rf_y4
mega_kernel_rf_y3:
s_add_u32 s76, s27, 2
s_cmp_lt_u32 s76, 63
s_cbranch_scc0 mega_kernel_rf_y4
s_add_u32 s76, s27, 3
s_cmp_gt_i32 s46, s76
s_cbranch_scc1 mega_kernel_rf_pf4ok
mega_kernel_rf_pf4w:
buffer_load_dword v4, v24, s[84:87], 0 offen sc1
s_waitcnt vmcnt(0)
v_readlane_b32 s46, v4, 0
v_readlane_b32 s28, v4, 1
s_nop 1
s_min_i32 s46, s46, s28
s_cmp_gt_i32 s46, s76
s_cbranch_scc0 mega_kernel_rf_y4
mega_kernel_rf_pf4ok:
mega_kernel_rf_y4:
s_branch mega_kernel_rf_b3
mega_kernel_rf_first:
buffer_load_dwordx4 v[32:35], v8, s[20:23], 0 offen offset:0
buffer_load_dwordx4 v[36:39], v8, s[20:23], 0 offen offset:128
buffer_load_dwordx4 v[40:43], v8, s[20:23], 0 offen offset:256
buffer_load_dwordx4 v[44:47], v8, s[20:23], 0 offen offset:384
v_add_u32 v5, s44, v17
ds_read_b128 v[156:159], v5 offset:0
ds_read_b128 v[160:163], v5 offset:1024
ds_read_b128 v[164:167], v5 offset:2048
ds_read_b128 v[168:171], v5 offset:3072
s_waitcnt vmcnt(0)
v_smfmac_f32_16x16x64_bf16 v[96:99], v[32:35], a[0:7], v6
v_smfmac_f32_16x16x64_bf16 v[100:103], v[32:35], a[32:39], v6
v_smfmac_f32_16x16x64_bf16 v[104:107], v[32:35], a[64:71], v6
v_smfmac_f32_16x16x64_bf16 v[108:111], v[32:35], a[96:103], v6
v_smfmac_f32_16x16x64_bf16 v[96:99], v[36:39], a[8:15], v6
v_smfmac_f32_16x16x64_bf16 v[100:103], v[36:39], a[40:47], v6
v_smfmac_f32_16x16x64_bf16 v[104:107], v[36:39], a[72:79], v6
v_smfmac_f32_16x16x64_bf16 v[108:111], v[36:39], a[104:111], v6
v_smfmac_f32_16x16x64_bf16 v[96:99], v[40:43], a[16:23], v6
v_smfmac_f32_16x16x64_bf16 v[100:103], v[40:43], a[48:55], v6
v_smfmac_f32_16x16x64_bf16 v[104:107], v[40:43], a[80:87], v6
v_smfmac_f32_16x16x64_bf16 v[108:111], v[40:43], a[112:119], v6
v_smfmac_f32_16x16x64_bf16 v[96:99], v[44:47], a[24:31], v6
v_smfmac_f32_16x16x64_bf16 v[100:103], v[44:47], a[56:63], v6
v_smfmac_f32_16x16x64_bf16 v[104:107], v[44:47], a[88:95], v6
v_smfmac_f32_16x16x64_bf16 v[108:111], v[44:47], a[120:127], v6
s_nop 1
s_branch mega_kernel_rf_adone
mega_kernel_rf_slast:
s_cmp_eq_u32 s24, 3
s_cbranch_scc1 mega_kernel_rf_end
s_add_u32 s77, s27, s82
s_bfe_u32 s28, s77, 0x30003
s_lshl_b32 s28, s28, 14
s_and_b32 s77, s77, 7
s_lshl_b32 s77, s77, 10
s_add_u32 s28, s28, s77
s_add_u32 s28, s28, s79
s_cmp_eq_u32 s24, 2
s_cbranch_scc1 mega_kernel_rf_kv2b
s_mov_b64 exec, s[48:49]
buffer_store_dwordx4 v[244:247], v22, s[84:87], s28 offen sc1
s_mov_b64 exec, -1
s_branch mega_kernel_rf_kvdb
mega_kernel_rf_kv2b:
v_lshlrev_b32 v4, 3, v1
buffer_store_dwordx2 v[244:245], v4, s[84:87], s28 offen offset:512 sc1
mega_kernel_rf_kvdb:
s_waitcnt vmcnt(0)
s_barrier
s_mov_b32 s76, 64
s_cmp_eq_u32 s24, 1
s_cbranch_scc0 mega_kernel_rf_end
v_mov_b32 v5, s76
s_mov_b64 exec, 1
buffer_store_dword v5, v228, s[84:87], s81 offen sc1
s_mov_b64 exec, -1
mega_kernel_rf_end:
s_endpgm
mega_kernel_recs:
s_load_dwordx2 s[20:21], s[0:1], 8
s_load_dwordx2 s[16:17], s[0:1], 40
s_load_dwordx2 s[4:5], s[0:1], 16
s_load_dwordx2 s[8:9], s[0:1], 24
s_load_dwordx2 s[12:13], s[0:1], 32
v_lshrrev_b32 v4, 6, v0
v_and_b32 v1, 63, v0
v_readfirstlane_b32 s24, v4
v_lshrrev_b32 v2, 4, v1
v_and_b32 v3, 15, v1
v_lshlrev_b32 v17, 4, v1
s_lshr_b32 s28, s31, 2
s_lshl_b32 s25, s30, 3
s_add_u32 s25, s25, s28
s_and_b32 s26, s31, 3
s_waitcnt lgkmcnt(0)
s_mov_b32 s22, 16384
s_mov_b32 s23, 0x00020000
s_mov_b32 s18, 8388608
s_mov_b32 s19, 0x00020000
s_mov_b32 s6, 8388608
s_mov_b32 s7, 0x00020000
s_mov_b32 s10, 8388608
s_mov_b32 s11, 0x00020000
s_mov_b32 s14, 8388608
s_mov_b32 s15, 0x00020000
s_lshl_b32 s28, s25, 8
s_lshr_b32 s29, s26, 0
s_lshl_b32 s29, s29, 6
s_add_u32 s28, s28, s29
s_lshl_b32 s29, s24, 21
s_add_u32 s28, s28, s29
v_lshrrev_b32 v4, 2, v1
v_and_b32 v5, 3, v1
v_lshlrev_b32 v40, 13, v4
v_lshl_add_u32 v40, v5, 4, v40
v_add_u32 v40, s28, v40
s_lshl_b32 s28, s30, 21
s_lshl_b32 s29, s24, 19
s_add_u32 s28, s28, s29
s_lshr_b32 s29, s31, 0
s_lshl_b32 s29, s29, 6
s_add_u32 s28, s28, s29
v_lshlrev_b32 v41, 11, v4
v_lshl_add_u32 v41, v5, 4, v41
v_add_u32 v41, s28, v41
s_lshl_b32 s47, s24, 15
s_add_u32 s47, s47, 32768
s_lshl_b32 s28, s31, 18
s_lshl_b32 s29, s24, 16
s_add_u32 s28, s28, s29
s_lshl_b32 s29, s30, 11
s_add_u32 s28, s28, s29
v_lshlrev_b32 v48, 13, v2
v_lshl_add_u32 v48, v3, 7, v48
v_add_u32 v48, s28, v48
s_lshl_b32 s28, s30, 21
s_lshl_b32 s29, s31, 16
s_add_u32 s28, s28, s29
s_lshl_b32 s29, s24, 14
s_add_u32 s28, s28, s29
v_lshlrev_b32 v49, 7, v1
v_add_u32 v49, s28, v49
s_and_b32 s76, s31, 1
s_mul_i32 s76, s76, 8
s_and_b32 s28, s31, 15
s_lshl_b32 s28, s28, 4
s_lshl_b32 s29, s24, 8
s_add_u32 s28, s28, s29
v_add_u32 v53, s28, v3
s_lshr_b32 s28, s31, 4
s_lshl_b32 s28, s28, 10
s_add_u32 s28, s28, 384
v_mov_b32 v54, s28
v_mov_b32 v55, 1920
v_cmp_gt_u32 vcc, 32, v1
s_nop 1
v_cndmask_b32 v54, v55, v54, vcc
s_lshl_b32 s29, s30, 11
v_lshl_add_u32 v51, v53, 13, v54
v_add_u32 v51, s29, v51
s_lshl_b32 s29, s30, 21
v_lshl_add_u32 v52, v53, 11, v54
v_add_u32 v52, s29, v52
buffer_load_dword v50, v51, s[4:7], 0 offen
s_xor_b32 s29, s76, 0
s_lshl_b32 s28, s29, 10
s_add_u32 s28, s28, s47
s_add_u32 m0, s28, 0
s_lshl_b32 s29, s29, 17
buffer_load_dwordx4 v40, s[4:7], s29 offen lds
s_xor_b32 s29, s76, 1
s_lshl_b32 s28, s29, 10
s_add_u32 s28, s28, s47
s_add_u32 m0, s28, 0
s_lshl_b32 s29, s29, 17
buffer_load_dwordx4 v40, s[4:7], s29 offen lds
s_xor_b32 s29, s76, 2
s_lshl_b32 s28, s29, 10
s_add_u32 s28, s28, s47
s_add_u32 m0, s28, 0
s_lshl_b32 s29, s29, 17
buffer_load_dwordx4 v40, s[4:7], s29 offen lds
s_xor_b32 s29, s76, 3
s_lshl_b32 s28, s29, 10
s_add_u32 s28, s28, s47
s_add_u32 m0, s28, 0
s_lshl_b32 s29, s29, 17
buffer_load_dwordx4 v40, s[4:7], s29 offen lds
s_xor_b32 s29, s76, 4
s_lshl_b32 s28, s29, 10
s_add_u32 s28, s28, s47
s_add_u32 m0, s28, 0
s_lshl_b32 s29, s29, 17
buffer_load_dwordx4 v40, s[4:7], s29 offen lds
s_xor_b32 s29, s76, 5
s_lshl_b32 s28, s29, 10
s_add_u32 s28, s28, s47
s_add_u32 m0, s28, 0
s_lshl_b32 s29, s29, 17
buffer_load_dwordx4 v40, s[4:7], s29 offen lds
s_xor_b32 s29, s76, 6
s_lshl_b32 s28, s29, 10
s_add_u32 s28, s28, s47
s_add_u32 m0, s28, 0
s_lshl_b32 s29, s29, 17
buffer_load_dwordx4 v40, s[4:7], s29 offen lds
s_xor_b32 s29, s76, 7
s_lshl_b32 s28, s29, 10
s_add_u32 s28, s28, s47
s_add_u32 m0, s28, 0
s_lshl_b32 s29, s29, 17
buffer_load_dwordx4 v40, s[4:7], s29 offen lds
s_xor_b32 s29, s76, 8
s_lshl_b32 s28, s29, 10
s_add_u32 s28, s28, s47
s_add_u32 m0, s28, 0
s_lshl_b32 s29, s29, 17
buffer_load_dwordx4 v40, s[4:7], s29 offen lds
s_xor_b32 s29, s76, 9
s_lshl_b32 s28, s29, 10
s_add_u32 s28, s28, s47
s_add_u32 m0, s28, 0
s_lshl_b32 s29, s29, 17
buffer_load_dwordx4 v40, s[4:7], s29 offen lds
s_xor_b32 s29, s76, 10
s_lshl_b32 s28, s29, 10
s_add_u32 s28, s28, s47
s_add_u32 m0, s28, 0
s_lshl_b32 s29, s29, 17
buffer_load_dwordx4 v40, s[4:7], s29 offen lds
s_xor_b32 s29, s76, 11
s_lshl_b32 s28, s29, 10
s_add_u32 s28, s28, s47
s_add_u32 m0, s28, 0
s_lshl_b32 s29, s29, 17
buffer_load_dwordx4 v40, s[4:7], s29 offen lds
s_xor_b32 s29, s76, 12
s_lshl_b32 s28, s29, 10
s_add_u32 s28, s28, s47
s_add_u32 m0, s28, 0
s_lshl_b32 s29, s29, 17
buffer_load_dwordx4 v40, s[4:7], s29 offen lds
s_xor_b32 s29, s76, 13
s_lshl_b32 s28, s29, 10
s_add_u32 s28, s28, s47
s_add_u32 m0, s28, 0
s_lshl_b32 s29, s29, 17
buffer_load_dwordx4 v40, s[4:7], s29 offen lds
s_xor_b32 s29, s76, 14
s_lshl_b32 s28, s29, 10
s_add_u32 s28, s28, s47
s_add_u32 m0, s28, 0
s_lshl_b32 s29, s29, 17
buffer_load_dwordx4 v40, s[4:7], s29 offen lds
s_xor_b32 s29, s76, 15
s_lshl_b32 s28, s29, 10
s_add_u32 s28, s28, s47
s_add_u32 m0, s28, 0
s_lshl_b32 s29, s29, 17
buffer_load_dwordx4 v40, s[4:7], s29 offen lds
buffer_load_dword v50, v51, s[8:11], 0 offen
s_xor_b32 s29, s76, 0
s_lshl_b32 s28, s29, 10
s_add_u32 s28, s28, s47
s_add_u32 m0, s28, 16384
s_lshl_b32 s29, s29, 17
buffer_load_dwordx4 v40, s[8:11], s29 offen lds
s_xor_b32 s29, s76, 1
s_lshl_b32 s28, s29, 10
s_add_u32 s28, s28, s47
s_add_u32 m0, s28, 16384
s_lshl_b32 s29, s29, 17
buffer_load_dwordx4 v40, s[8:11], s29 offen lds
s_xor_b32 s29, s76, 2
s_lshl_b32 s28, s29, 10
s_add_u32 s28, s28, s47
s_add_u32 m0, s28, 16384
s_lshl_b32 s29, s29, 17
buffer_load_dwordx4 v40, s[8:11], s29 offen lds
s_xor_b32 s29, s76, 3
s_lshl_b32 s28, s29, 10
s_add_u32 s28, s28, s47
s_add_u32 m0, s28, 16384
s_lshl_b32 s29, s29, 17
buffer_load_dwordx4 v40, s[8:11], s29 offen lds
s_xor_b32 s29, s76, 4
s_lshl_b32 s28, s29, 10
s_add_u32 s28, s28, s47
s_add_u32 m0, s28, 16384
s_lshl_b32 s29, s29, 17
buffer_load_dwordx4 v40, s[8:11], s29 offen lds
s_xor_b32 s29, s76, 5
s_lshl_b32 s28, s29, 10
s_add_u32 s28, s28, s47
s_add_u32 m0, s28, 16384
s_lshl_b32 s29, s29, 17
buffer_load_dwordx4 v40, s[8:11], s29 offen lds
s_xor_b32 s29, s76, 6
s_lshl_b32 s28, s29, 10
s_add_u32 s28, s28, s47
s_add_u32 m0, s28, 16384
s_lshl_b32 s29, s29, 17
buffer_load_dwordx4 v40, s[8:11], s29 offen lds
s_xor_b32 s29, s76, 7
s_lshl_b32 s28, s29, 10
s_add_u32 s28, s28, s47
s_add_u32 m0, s28, 16384
s_lshl_b32 s29, s29, 17
buffer_load_dwordx4 v40, s[8:11], s29 offen lds
s_xor_b32 s29, s76, 8
s_lshl_b32 s28, s29, 10
s_add_u32 s28, s28, s47
s_add_u32 m0, s28, 16384
s_lshl_b32 s29, s29, 17
buffer_load_dwordx4 v40, s[8:11], s29 offen lds
s_xor_b32 s29, s76, 9
s_lshl_b32 s28, s29, 10
s_add_u32 s28, s28, s47
s_add_u32 m0, s28, 16384
s_lshl_b32 s29, s29, 17
buffer_load_dwordx4 v40, s[8:11], s29 offen lds
s_xor_b32 s29, s76, 10
s_lshl_b32 s28, s29, 10
s_add_u32 s28, s28, s47
s_add_u32 m0, s28, 16384
s_lshl_b32 s29, s29, 17
buffer_load_dwordx4 v40, s[8:11], s29 offen lds
s_xor_b32 s29, s76, 11
s_lshl_b32 s28, s29, 10
s_add_u32 s28, s28, s47
s_add_u32 m0, s28, 16384
s_lshl_b32 s29, s29, 17
buffer_load_dwordx4 v40, s[8:11], s29 offen lds
s_xor_b32 s29, s76, 12
s_lshl_b32 s28, s29, 10
s_add_u32 s28, s28, s47
s_add_u32 m0, s28, 16384
s_lshl_b32 s29, s29, 17
buffer_load_dwordx4 v40, s[8:11], s29 offen lds
s_xor_b32 s29, s76, 13
s_lshl_b32 s28, s29, 10
s_add_u32 s28, s28, s47
s_add_u32 m0, s28, 16384
s_lshl_b32 s29, s29, 17
buffer_load_dwordx4 v40, s[8:11], s29 offen lds
s_xor_b32 s29, s76, 14
s_lshl_b32 s28, s29, 10
s_add_u32 s28, s28, s47
s_add_u32 m0, s28, 16384
s_lshl_b32 s29, s29, 17
buffer_load_dwordx4 v40, s[8:11], s29 offen lds
s_xor_b32 s29, s76, 15
s_lshl_b32 s28, s29, 10
s_add_u32 s28, s28, s47
s_add_u32 m0, s28, 16384
s_lshl_b32 s29, s29, 17
buffer_load_dwordx4 v40, s[8:11], s29 offen lds
s_mov_b32 s40, 0x00ff00ff
s_mov_b32 s41, 0x00ff00ff
s_mov_b32 s48, 0xff00ff00
s_mov_b32 s49, 0xff00ff00
s_mov_b32 s42, 0
s_mov_b32 s43, 0x00ff00ff
s_mov_b32 s32, 0x3e0293ee
v_mov_b32 v23, 0xff7fffff
v_mov_b32 v6, 0x4444
v_mov_b32 v4, 0xeeee
v_cndmask_b32 v6, v6, v4, s[48:49]
v_mov_b32 v28, -1
v_mov_b32 v29, -1
v_mov_b32 v30, -1
v_mov_b32 v31, -1
s_lshl_b32 s28, s24, 12
v_add_u32 v7, s28, v17
v_and_b32 v4, 7, v1
v_lshlrev_b32 v8, 11, v4
v_lshrrev_b32 v5, 3, v1
v_lshl_add_u32 v8, v5, 4, v8
s_lshl_b32 s28, s24, 9
v_add_u32 v8, s28, v8
s_lshl_b32 s28, s31, 9
v_lshlrev_b32 v9, 3, v1
v_add_u32 v9, s28, v9
v_and_b32 v4, 7, v3
v_lshlrev_b32 v11, 7, v2
v_lshl_add_u32 v11, v4, 4, v11
v_add_u32 v22, 0, v11
s_add_u32 s28, s28, 16384
v_add_u32 v11, s28, v11
v_and_b32 v5, 1, v2
v_lshlrev_b32 v10, 7, v5
v_lshl_add_u32 v10, v4, 4, v10
v_add_u32 v10, 1024, v10
s_xor_b32 s37, s31, 1
s_lshl_b32 s37, s37, 11
s_add_u32 s37, s37, 32768
s_xor_b32 s38, s31, 2
s_lshl_b32 s38, s38, 11
s_add_u32 s38, s38, 32768
s_xor_b32 s39, s31, 3
s_lshl_b32 s39, s39, 11
s_add_u32 s39, s39, 32768
v_and_b32 v4, 1, v2
v_mul_u32_u24 v14, 576, v4
v_lshrrev_b32 v5, 1, v2
v_lshl_add_u32 v5, v5, 4, v3
v_lshl_add_u32 v14, v5, 2, v14
s_mul_i32 s28, s24, 1152
s_add_u32 s28, s28, 13312
v_add_u32 v18, s28, v14
s_mul_i32 s28, s24, 2304
v_add_u32 v14, s28, v14
v_add_u32 v15, 1152, v14
v_mul_u32_u24 v16, 144, v3
v_lshl_add_u32 v16, v2, 5, v16
v_bfe_u32 v4, v1, 1, 3
v_mul_u32_u24 v19, 144, v4
v_lshl_add_u32 v19, v2, 5, v19
v_and_b32 v4, 1, v1
v_lshl_add_u32 v19, v4, 4, v19
v_add_u32 v19, 13312, v19
s_lshl_b32 s28, s24, 10
s_add_u32 s28, s28, 9216
v_add_u32 v20, s28, v17
v_and_b32 v4, 31, v1
v_lshlrev_b32 v21, 3, v4
v_add_u32 v21, 17920, v21
v_lshrrev_b32 v4, 2, v3
v_and_b32 v42, 1, v4
v_lshrrev_b32 v43, 1, v4
v_lshrrev_b32 v44, 1, v2
v_and_b32 v45, 1, v2
v_lshl_add_u32 v46, v44, 4, v42
v_lshl_add_u32 v46, v45, 2, v46
v_lshl_add_u32 v46, v43, 3, v46
v_lshl_add_u32 v47, v44, 3, v42
v_lshl_add_u32 v47, v45, 4, v47
v_lshl_add_u32 v47, v43, 2, v47
v_and_b32 v5, 3, v3
v_lshlrev_b32 v5, 3, v5
v_lshl_add_u32 v46, v46, 6, v5
v_lshl_add_u32 v47, v47, 6, v5
s_and_b32 s28, s31, 0
s_lshl_b32 s28, s28, 6
s_add_u32 s28, s28, s47
v_add_u32 v46, s28, v46
v_add_u32 v47, s28, v47
s_waitcnt vmcnt(17)
ds_read_b64_tr_b16 a[0:1], v46 offset:0
ds_read_b64_tr_b16 a[2:3], v46 offset:128
ds_read_b64_tr_b16 a[4:5], v46 offset:2048
ds_read_b64_tr_b16 a[6:7], v46 offset:2176
ds_read_b64_tr_b16 a[8:9], v46 offset:4096
ds_read_b64_tr_b16 a[10:11], v46 offset:4224
ds_read_b64_tr_b16 a[12:13], v46 offset:6144
ds_read_b64_tr_b16 a[14:15], v46 offset:6272
s_waitcnt lgkmcnt(0)
ds_read_b64_tr_b16 a[16:17], v46 offset:8192
ds_read_b64_tr_b16 a[18:19], v46 offset:8320
ds_read_b64_tr_b16 a[20:21], v46 offset:10240
ds_read_b64_tr_b16 a[22:23], v46 offset:10368
ds_read_b64_tr_b16 a[24:25], v46 offset:12288
ds_read_b64_tr_b16 a[26:27], v46 offset:12416
ds_read_b64_tr_b16 a[28:29], v46 offset:14336
ds_read_b64_tr_b16 a[30:31], v46 offset:14464
s_waitcnt lgkmcnt(0)
ds_read_b64_tr_b16 a[32:33], v46 offset:32
ds_read_b64_tr_b16 a[34:35], v46 offset:160
ds_read_b64_tr_b16 a[36:37], v46 offset:2080
ds_read_b64_tr_b16 a[38:39], v46 offset:2208
ds_read_b64_tr_b16 a[40:41], v46 offset:4128
ds_read_b64_tr_b16 a[42:43], v46 offset:4256
ds_read_b64_tr_b16 a[44:45], v46 offset:6176
ds_read_b64_tr_b16 a[46:47], v46 offset:6304
s_waitcnt lgkmcnt(0)
ds_read_b64_tr_b16 a[48:49], v46 offset:8224
ds_read_b64_tr_b16 a[50:51], v46 offset:8352
ds_read_b64_tr_b16 a[52:53], v46 offset:10272
ds_read_b64_tr_b16 a[54:55], v46 offset:10400
ds_read_b64_tr_b16 a[56:57], v46 offset:12320
ds_read_b64_tr_b16 a[58:59], v46 offset:12448
ds_read_b64_tr_b16 a[60:61], v46 offset:14368
ds_read_b64_tr_b16 a[62:63], v46 offset:14496
s_waitcnt lgkmcnt(0)
buffer_load_dword v50, v51, s[12:15], 0 offen
s_xor_b32 s29, s76, 0
s_lshl_b32 s28, s29, 10
s_add_u32 s28, s28, s47
s_add_u32 m0, s28, 0
s_lshl_b32 s29, s29, 17
buffer_load_dwordx4 v40, s[12:15], s29 offen lds
s_xor_b32 s29, s76, 1
s_lshl_b32 s28, s29, 10
s_add_u32 s28, s28, s47
s_add_u32 m0, s28, 0
s_lshl_b32 s29, s29, 17
buffer_load_dwordx4 v40, s[12:15], s29 offen lds
s_xor_b32 s29, s76, 2
s_lshl_b32 s28, s29, 10
s_add_u32 s28, s28, s47
s_add_u32 m0, s28, 0
s_lshl_b32 s29, s29, 17
buffer_load_dwordx4 v40, s[12:15], s29 offen lds
s_xor_b32 s29, s76, 3
s_lshl_b32 s28, s29, 10
s_add_u32 s28, s28, s47
s_add_u32 m0, s28, 0
s_lshl_b32 s29, s29, 17
buffer_load_dwordx4 v40, s[12:15], s29 offen lds
s_xor_b32 s29, s76, 4
s_lshl_b32 s28, s29, 10
s_add_u32 s28, s28, s47
s_add_u32 m0, s28, 0
s_lshl_b32 s29, s29, 17
buffer_load_dwordx4 v40, s[12:15], s29 offen lds
s_xor_b32 s29, s76, 5
s_lshl_b32 s28, s29, 10
s_add_u32 s28, s28, s47
s_add_u32 m0, s28, 0
s_lshl_b32 s29, s29, 17
buffer_load_dwordx4 v40, s[12:15], s29 offen lds
s_xor_b32 s29, s76, 6
s_lshl_b32 s28, s29, 10
s_add_u32 s28, s28, s47
s_add_u32 m0, s28, 0
s_lshl_b32 s29, s29, 17
buffer_load_dwordx4 v40, s[12:15], s29 offen lds
s_xor_b32 s29, s76, 7
s_lshl_b32 s28, s29, 10
s_add_u32 s28, s28, s47
s_add_u32 m0, s28, 0
s_lshl_b32 s29, s29, 17
buffer_load_dwordx4 v40, s[12:15], s29 offen lds
s_xor_b32 s29, s76, 8
s_lshl_b32 s28, s29, 10
s_add_u32 s28, s28, s47
s_add_u32 m0, s28, 0
s_lshl_b32 s29, s29, 17
buffer_load_dwordx4 v40, s[12:15], s29 offen lds
s_xor_b32 s29, s76, 9
s_lshl_b32 s28, s29, 10
s_add_u32 s28, s28, s47
s_add_u32 m0, s28, 0
s_lshl_b32 s29, s29, 17
buffer_load_dwordx4 v40, s[12:15], s29 offen lds
s_xor_b32 s29, s76, 10
s_lshl_b32 s28, s29, 10
s_add_u32 s28, s28, s47
s_add_u32 m0, s28, 0
s_lshl_b32 s29, s29, 17
buffer_load_dwordx4 v40, s[12:15], s29 offen lds
s_xor_b32 s29, s76, 11
s_lshl_b32 s28, s29, 10
s_add_u32 s28, s28, s47
s_add_u32 m0, s28, 0
s_lshl_b32 s29, s29, 17
buffer_load_dwordx4 v40, s[12:15], s29 offen lds
s_xor_b32 s29, s76, 12
s_lshl_b32 s28, s29, 10
s_add_u32 s28, s28, s47
s_add_u32 m0, s28, 0
s_lshl_b32 s29, s29, 17
buffer_load_dwordx4 v40, s[12:15], s29 offen lds
s_xor_b32 s29, s76, 13
s_lshl_b32 s28, s29, 10
s_add_u32 s28, s28, s47
s_add_u32 m0, s28, 0
s_lshl_b32 s29, s29, 17
buffer_load_dwordx4 v40, s[12:15], s29 offen lds
s_xor_b32 s29, s76, 14
s_lshl_b32 s28, s29, 10
s_add_u32 s28, s28, s47
s_add_u32 m0, s28, 0
s_lshl_b32 s29, s29, 17
buffer_load_dwordx4 v40, s[12:15], s29 offen lds
s_xor_b32 s29, s76, 15
s_lshl_b32 s28, s29, 10
s_add_u32 s28, s28, s47
s_add_u32 m0, s28, 0
s_lshl_b32 s29, s29, 17
buffer_load_dwordx4 v40, s[12:15], s29 offen lds
s_waitcnt vmcnt(17)
ds_read_b64_tr_b16 a[64:65], v46 offset:16384
ds_read_b64_tr_b16 a[66:67], v46 offset:16512
ds_read_b64_tr_b16 a[68:69], v46 offset:18432
ds_read_b64_tr_b16 a[70:71], v46 offset:18560
ds_read_b64_tr_b16 a[72:73], v46 offset:20480
ds_read_b64_tr_b16 a[74:75], v46 offset:20608
ds_read_b64_tr_b16 a[76:77], v46 offset:22528
ds_read_b64_tr_b16 a[78:79], v46 offset:22656
s_waitcnt lgkmcnt(0)
ds_read_b64_tr_b16 a[80:81], v46 offset:24576
ds_read_b64_tr_b16 a[82:83], v46 offset:24704
ds_read_b64_tr_b16 a[84:85], v46 offset:26624
ds_read_b64_tr_b16 a[86:87], v46 offset:26752
ds_read_b64_tr_b16 a[88:89], v46 offset:28672
ds_read_b64_tr_b16 a[90:91], v46 offset:28800
ds_read_b64_tr_b16 a[92:93], v46 offset:30720
ds_read_b64_tr_b16 a[94:95], v46 offset:30848
s_waitcnt lgkmcnt(0)
ds_read_b64_tr_b16 a[96:97], v46 offset:16416
ds_read_b64_tr_b16 a[98:99], v46 offset:16544
ds_read_b64_tr_b16 a[100:101], v46 offset:18464
ds_read_b64_tr_b16 a[102:103], v46 offset:18592
ds_read_b64_tr_b16 a[104:105], v46 offset:20512
ds_read_b64_tr_b16 a[106:107], v46 offset:20640
ds_read_b64_tr_b16 a[108:109], v46 offset:22560
ds_read_b64_tr_b16 a[110:111], v46 offset:22688
s_waitcnt lgkmcnt(0)
ds_read_b64_tr_b16 a[112:113], v46 offset:24608
ds_read_b64_tr_b16 a[114:115], v46 offset:24736
ds_read_b64_tr_b16 a[116:117], v46 offset:26656
ds_read_b64_tr_b16 a[118:119], v46 offset:26784
ds_read_b64_tr_b16 a[120:121], v46 offset:28704
ds_read_b64_tr_b16 a[122:123], v46 offset:28832
ds_read_b64_tr_b16 a[124:125], v46 offset:30752
ds_read_b64_tr_b16 a[126:127], v46 offset:30880
s_waitcnt lgkmcnt(0)
buffer_load_dword v50, v52, s[16:19], 0 offen
s_xor_b32 s29, s76, 0
s_lshl_b32 s28, s29, 10
s_add_u32 s28, s28, s47
s_add_u32 m0, s28, 16384
s_lshl_b32 s29, s29, 15
buffer_load_dwordx4 v41, s[16:19], s29 offen lds
s_xor_b32 s29, s76, 1
s_lshl_b32 s28, s29, 10
s_add_u32 s28, s28, s47
s_add_u32 m0, s28, 16384
s_lshl_b32 s29, s29, 15
buffer_load_dwordx4 v41, s[16:19], s29 offen lds
s_xor_b32 s29, s76, 2
s_lshl_b32 s28, s29, 10
s_add_u32 s28, s28, s47
s_add_u32 m0, s28, 16384
s_lshl_b32 s29, s29, 15
buffer_load_dwordx4 v41, s[16:19], s29 offen lds
s_xor_b32 s29, s76, 3
s_lshl_b32 s28, s29, 10
s_add_u32 s28, s28, s47
s_add_u32 m0, s28, 16384
s_lshl_b32 s29, s29, 15
buffer_load_dwordx4 v41, s[16:19], s29 offen lds
s_xor_b32 s29, s76, 4
s_lshl_b32 s28, s29, 10
s_add_u32 s28, s28, s47
s_add_u32 m0, s28, 16384
s_lshl_b32 s29, s29, 15
buffer_load_dwordx4 v41, s[16:19], s29 offen lds
s_xor_b32 s29, s76, 5
s_lshl_b32 s28, s29, 10
s_add_u32 s28, s28, s47
s_add_u32 m0, s28, 16384
s_lshl_b32 s29, s29, 15
buffer_load_dwordx4 v41, s[16:19], s29 offen lds
s_xor_b32 s29, s76, 6
s_lshl_b32 s28, s29, 10
s_add_u32 s28, s28, s47
s_add_u32 m0, s28, 16384
s_lshl_b32 s29, s29, 15
buffer_load_dwordx4 v41, s[16:19], s29 offen lds
s_xor_b32 s29, s76, 7
s_lshl_b32 s28, s29, 10
s_add_u32 s28, s28, s47
s_add_u32 m0, s28, 16384
s_lshl_b32 s29, s29, 15
buffer_load_dwordx4 v41, s[16:19], s29 offen lds
s_xor_b32 s29, s76, 8
s_lshl_b32 s28, s29, 10
s_add_u32 s28, s28, s47
s_add_u32 m0, s28, 16384
s_lshl_b32 s29, s29, 15
buffer_load_dwordx4 v41, s[16:19], s29 offen lds
s_xor_b32 s29, s76, 9
s_lshl_b32 s28, s29, 10
s_add_u32 s28, s28, s47
s_add_u32 m0, s28, 16384
s_lshl_b32 s29, s29, 15
buffer_load_dwordx4 v41, s[16:19], s29 offen lds
s_xor_b32 s29, s76, 10
s_lshl_b32 s28, s29, 10
s_add_u32 s28, s28, s47
s_add_u32 m0, s28, 16384
s_lshl_b32 s29, s29, 15
buffer_load_dwordx4 v41, s[16:19], s29 offen lds
s_xor_b32 s29, s76, 11
s_lshl_b32 s28, s29, 10
s_add_u32 s28, s28, s47
s_add_u32 m0, s28, 16384
s_lshl_b32 s29, s29, 15
buffer_load_dwordx4 v41, s[16:19], s29 offen lds
s_xor_b32 s29, s76, 12
s_lshl_b32 s28, s29, 10
s_add_u32 s28, s28, s47
s_add_u32 m0, s28, 16384
s_lshl_b32 s29, s29, 15
buffer_load_dwordx4 v41, s[16:19], s29 offen lds
s_xor_b32 s29, s76, 13
s_lshl_b32 s28, s29, 10
s_add_u32 s28, s28, s47
s_add_u32 m0, s28, 16384
s_lshl_b32 s29, s29, 15
buffer_load_dwordx4 v41, s[16:19], s29 offen lds
s_xor_b32 s29, s76, 14
s_lshl_b32 s28, s29, 10
s_add_u32 s28, s28, s47
s_add_u32 m0, s28, 16384
s_lshl_b32 s29, s29, 15
buffer_load_dwordx4 v41, s[16:19], s29 offen lds
s_xor_b32 s29, s76, 15
s_lshl_b32 s28, s29, 10
s_add_u32 s28, s28, s47
s_add_u32 m0, s28, 16384
s_lshl_b32 s29, s29, 15
buffer_load_dwordx4 v41, s[16:19], s29 offen lds
s_waitcnt vmcnt(17)
ds_read_b64_tr_b16 a[128:129], v46 offset:0
ds_read_b64_tr_b16 a[130:131], v46 offset:128
ds_read_b64_tr_b16 a[132:133], v46 offset:2048
ds_read_b64_tr_b16 a[134:135], v46 offset:2176
ds_read_b64_tr_b16 a[136:137], v46 offset:4096
ds_read_b64_tr_b16 a[138:139], v46 offset:4224
ds_read_b64_tr_b16 a[140:141], v46 offset:6144
ds_read_b64_tr_b16 a[142:143], v46 offset:6272
s_waitcnt lgkmcnt(0)
ds_read_b64_tr_b16 a[144:145], v46 offset:8192
ds_read_b64_tr_b16 a[146:147], v46 offset:8320
ds_read_b64_tr_b16 a[148:149], v46 offset:10240
ds_read_b64_tr_b16 a[150:151], v46 offset:10368
ds_read_b64_tr_b16 a[152:153], v46 offset:12288
ds_read_b64_tr_b16 a[154:155], v46 offset:12416
ds_read_b64_tr_b16 a[156:157], v46 offset:14336
ds_read_b64_tr_b16 a[158:159], v46 offset:14464
s_waitcnt lgkmcnt(0)
ds_read_b64_tr_b16 a[160:161], v46 offset:32
ds_read_b64_tr_b16 a[162:163], v46 offset:160
ds_read_b64_tr_b16 a[164:165], v46 offset:2080
ds_read_b64_tr_b16 a[166:167], v46 offset:2208
ds_read_b64_tr_b16 a[168:169], v46 offset:4128
ds_read_b64_tr_b16 a[170:171], v46 offset:4256
ds_read_b64_tr_b16 a[172:173], v46 offset:6176
ds_read_b64_tr_b16 a[174:175], v46 offset:6304
s_waitcnt lgkmcnt(0)
ds_read_b64_tr_b16 a[176:177], v46 offset:8224
ds_read_b64_tr_b16 a[178:179], v46 offset:8352
ds_read_b64_tr_b16 a[180:181], v46 offset:10272
ds_read_b64_tr_b16 a[182:183], v46 offset:10400
ds_read_b64_tr_b16 a[184:185], v46 offset:12320
ds_read_b64_tr_b16 a[186:187], v46 offset:12448
ds_read_b64_tr_b16 a[188:189], v46 offset:14368
ds_read_b64_tr_b16 a[190:191], v46 offset:14496
s_waitcnt lgkmcnt(0)
s_waitcnt vmcnt(0)
ds_read_b64_tr_b16 a[192:193], v47 offset:16384
ds_read_b64_tr_b16 a[194:195], v47 offset:16512
ds_read_b64_tr_b16 a[196:197], v47 offset:18432
ds_read_b64_tr_b16 a[198:199], v47 offset:18560
ds_read_b64_tr_b16 a[200:201], v47 offset:20480
ds_read_b64_tr_b16 a[202:203], v47 offset:20608
ds_read_b64_tr_b16 a[204:205], v47 offset:22528
ds_read_b64_tr_b16 a[206:207], v47 offset:22656
s_waitcnt lgkmcnt(0)
ds_read_b64_tr_b16 a[208:209], v47 offset:24576
ds_read_b64_tr_b16 a[210:211], v47 offset:24704
ds_read_b64_tr_b16 a[212:213], v47 offset:26624
ds_read_b64_tr_b16 a[214:215], v47 offset:26752
ds_read_b64_tr_b16 a[216:217], v47 offset:28672
ds_read_b64_tr_b16 a[218:219], v47 offset:28800
ds_read_b64_tr_b16 a[220:221], v47 offset:30720
ds_read_b64_tr_b16 a[222:223], v47 offset:30848
s_waitcnt lgkmcnt(0)
ds_read_b64_tr_b16 a[224:225], v47 offset:16416
ds_read_b64_tr_b16 a[226:227], v47 offset:16544
ds_read_b64_tr_b16 a[228:229], v47 offset:18464
ds_read_b64_tr_b16 a[230:231], v47 offset:18592
ds_read_b64_tr_b16 a[232:233], v47 offset:20512
ds_read_b64_tr_b16 a[234:235], v47 offset:20640
ds_read_b64_tr_b16 a[236:237], v47 offset:22560
ds_read_b64_tr_b16 a[238:239], v47 offset:22688
s_waitcnt lgkmcnt(0)
ds_read_b64_tr_b16 a[240:241], v47 offset:24608
ds_read_b64_tr_b16 a[242:243], v47 offset:24736
ds_read_b64_tr_b16 a[244:245], v47 offset:26656
ds_read_b64_tr_b16 a[246:247], v47 offset:26784
ds_read_b64_tr_b16 a[248:249], v47 offset:28704
ds_read_b64_tr_b16 a[250:251], v47 offset:28832
ds_read_b64_tr_b16 a[252:253], v47 offset:30752
ds_read_b64_tr_b16 a[254:255], v47 offset:30880
s_waitcnt lgkmcnt(0)
v_and_b32 v5, 15, v0
v_lshlrev_b32 v5, 4, v5
s_branch mega_kernel_sys
mega_kernel_sysw:
s_sleep 4
mega_kernel_sys:
buffer_load_dword v4, v5, s[72:75], 0 offen sc1
s_waitcnt vmcnt(0)
s_cmp_eq_u32 s95, 1
s_cbranch_scc0 mega_kernel_sysf
v_readlane_b32 s76, v4, 14
s_mov_b32 s98, 0
s_cmp_eq_u32 s76, 64
s_cbranch_scc0 mega_kernel_sysw
s_branch mega_kernel_sysd
mega_kernel_sysf:
s_mov_b32 s77, 0
s_mov_b32 s78, 0
v_readlane_b32 s76, v4, 0
s_add_u32 s77, s77, s76
s_xor_b32 s76, s76, 32
s_or_b32 s78, s78, s76
v_readlane_b32 s76, v4, 1
s_add_u32 s77, s77, s76
s_xor_b32 s76, s76, 32
s_or_b32 s78, s78, s76
v_readlane_b32 s76, v4, 2
s_add_u32 s77, s77, s76
s_xor_b32 s76, s76, 32
s_or_b32 s78, s78, s76
v_readlane_b32 s76, v4, 3
s_add_u32 s77, s77, s76
s_xor_b32 s76, s76, 32
s_or_b32 s78, s78, s76
v_readlane_b32 s76, v4, 4
s_add_u32 s77, s77, s76
s_xor_b32 s76, s76, 32
s_or_b32 s78, s78, s76
v_readlane_b32 s76, v4, 5
s_add_u32 s77, s77, s76
s_xor_b32 s76, s76, 32
s_or_b32 s78, s78, s76
v_readlane_b32 s76, v4, 6
s_add_u32 s77, s77, s76
s_xor_b32 s76, s76, 32
s_or_b32 s78, s78, s76
v_readlane_b32 s76, v4, 7
s_add_u32 s77, s77, s76
s_xor_b32 s76, s76, 32
s_or_b32 s78, s78, s76
s_cmp_eq_u32 s77, 256
s_cbranch_scc0 mega_kernel_sysw
v_mov_b32 v252, v4
s_cmp_eq_u32 s78, 0
s_cbranch_scc0 mega_kernel_slowent
v_readlane_b32 s76, v4, 10
v_readlane_b32 s77, v4, 8
s_cmp_eq_u32 s76, 64
s_cbranch_scc0 mega_kernel_sysw
s_cmp_gt_u32 s77, 32
s_cselect_b32 s98, 1, 0
mega_kernel_sysd:
s_lshr_b32 s28, s31, 3
s_lshl_b32 s28, s28, 14
s_lshl_b32 s29, s98, 13
s_add_u32 s28, s28, s29
s_and_b32 s29, s31, 7
s_lshl_b32 s29, s29, 10
s_add_u32 s28, s28, s29
s_lshl_b32 s29, s30, 16
s_add_u32 s28, s28, s29
s_add_u32 s28, s28, 67108864
v_add_u32 v12, s28, v17
v_xor_b32 v25, 0x10000, v12
v_xor_b32 v26, 0x20000, v12
v_xor_b32 v27, 0x30000, v12
s_lshl_b32 s28, s25, 2
s_add_u32 s28, s28, s26
s_mov_b32 s82, s28
s_lshr_b32 s29, s28, 3
s_xor_b32 s29, s29, s98
s_and_b32 s29, s29, 1
s_lshl_b32 s29, s29, 13
s_lshl_b32 s76, s28, 18
s_add_u32 s76, s76, s29
s_mov_b32 s83, s76
v_add_u32 v240, s76, v17
v_add_u32 v241, 33554432, v240
s_lshr_b32 s29, s28, 4
s_xor_b32 s29, s29, s98
s_and_b32 s29, s29, 1
s_lshl_b32 s29, s29, 13
s_lshl_b32 s79, s28, 17
s_add_u32 s79, s79, s29
s_add_u32 s79, s79, 71303168
s_xor_b32 s29, s98, 1
s_lshl_b32 s29, s29, 13
s_lshl_b32 s28, s25, 7
s_add_u32 s28, s28, s29
s_add_u32 s28, s28, 69206016
v_and_b32 v4, 1, v1
v_lshlrev_b32 v24, 12, v4
v_add_u32 v24, s28, v24
s_lshl_b32 s29, s26, 2
v_add_u32 v24, s29, v24
s_xor_b32 s81, s98, 1
s_lshl_b32 s81, s81, 13
s_lshr_b32 s29, s82, 6
s_lshl_b32 s29, s29, 14
s_add_u32 s81, s81, s29
s_and_b32 s29, s82, 63
s_lshl_b32 s29, s29, 7
s_add_u32 s81, s81, s29
s_add_u32 s81, s81, 69222400
v_mov_b32 v220, 0x3f803f80
v_mov_b32 v221, 0x3f803f80
v_mov_b32 v222, 0x3f803f80
v_mov_b32 v223, 0x3f803f80
v_mov_b32 v228, 0
s_mov_b32 s27, 0
s_mov_b32 s46, 0
s_mov_b32 s44, 18432
s_mov_b32 s45, 18432
s_cmp_eq_u32 s24, 3
s_cbranch_scc0 mega_kernel_rs_pfi
s_mov_b32 s76, 0
s_cmp_gt_i32 s46, s76
s_cbranch_scc1 mega_kernel_rs_pf0ok
mega_kernel_rs_pf0w:
buffer_load_dword v4, v24, s[84:87], 0 offen sc1
s_waitcnt vmcnt(0)
v_readlane_b32 s46, v4, 0
v_readlane_b32 s28, v4, 1
s_nop 1
s_min_i32 s46, s46, s28
s_cmp_gt_i32 s46, s76
s_cbranch_scc0 mega_kernel_rs_pf0w
mega_kernel_rs_pf0ok:
s_add_u32 s77, s76, s82
s_bfe_u32 s28, s77, 0x40002
s_lshl_b32 s28, s28, 14
s_and_b32 s77, s77, 3
s_lshl_b32 s77, s77, 11
s_add_u32 s28, s28, s77
s_add_u32 m0, s45, 0
s_nop 0
buffer_load_dwordx4 v240, s[84:87], s28 offen offset:0 sc1 lds
s_add_u32 m0, s45, 0
s_nop 0
buffer_load_dwordx4 v240, s[84:87], s28 offen offset:1024 sc1 lds
s_add_u32 m0, s45, 2048
s_nop 0
buffer_load_dwordx4 v241, s[84:87], s28 offen offset:0 sc1 lds
s_add_u32 m0, s45, 2048
s_nop 0
buffer_load_dwordx4 v241, s[84:87], s28 offen offset:1024 sc1 lds
s_add_u32 s45, s45, 4096
s_cmp_eq_u32 s45, 30720
s_cselect_b32 s45, 18432, s45
s_waitcnt vmcnt(0) lgkmcnt(0)
mega_kernel_rs_pfi:
v_mov_b32 v96, 0
v_mov_b32 v97, 0
v_mov_b32 v98, 0
v_mov_b32 v99, 0
v_mov_b32 v100, 0
v_mov_b32 v101, 0
v_mov_b32 v102, 0
v_mov_b32 v103, 0
v_mov_b32 v104, 0
v_mov_b32 v105, 0
v_mov_b32 v106, 0
v_mov_b32 v107, 0
v_mov_b32 v108, 0
v_mov_b32 v109, 0
v_mov_b32 v110, 0
v_mov_b32 v111, 0
v_mov_b32 v112, 0
v_mov_b32 v113, 0
v_mov_b32 v114, 0
v_mov_b32 v115, 0
v_mov_b32 v116, 0
v_mov_b32 v117, 0
v_mov_b32 v118, 0
v_mov_b32 v119, 0
s_barrier
s_and_b32 s29, s27, 1
s_lshl_b32 s33, s29, 17
s_lshl_b32 s28, s30, 18
s_add_u32 s33, s33, s28
s_add_u32 s33, s33, 68157440
s_xor_b32 s34, s33, 131072
s_lshl_b32 s35, s29, 18
s_bfe_u32 s47, s27, 0x10001
s_branch mega_kernel_rs_first
mega_kernel_rs_loop:
buffer_load_dwordx4 v[32:35], v7, s[84:87], s33 offen offset:0 sc1
v_add_u32 v5, s44, v17
ds_read_b128 v[156:159], v5 offset:0
ds_read_b128 v[160:163], v5 offset:1024
ds_read_b128 v[164:167], v5 offset:2048
ds_read_b128 v[168:171], v5 offset:3072
s_nop 4
buffer_load_dwordx4 v[36:39], v7, s[84:87], s33 offen offset:1024 sc1
s_nop 9
buffer_load_dwordx4 v[40:43], v7, s[84:87], s33 offen offset:2048 sc1
s_nop 9
buffer_load_dwordx4 v[44:47], v7, s[84:87], s33 offen offset:3072 sc1
s_waitcnt vmcnt(3)
v_max_u32 v4, v32, v34
v_cmp_eq_u32 vcc, -1, v4
s_cbranch_vccnz mega_kernel_rs_pa_15_0f
v_smfmac_f32_16x16x64_bf16 v[96:99], v[32:35], a[0:7], v6
v_smfmac_f32_16x16x64_bf16 v[100:103], v[32:35], a[32:39], v6
v_smfmac_f32_16x16x64_bf16 v[104:107], v[32:35], a[64:71], v6
s_waitcnt vmcnt(2)
v_max_u32 v4, v36, v38
v_cmp_eq_u32 vcc, -1, v4
v_smfmac_f32_16x16x64_bf16 v[108:111], v[32:35], a[96:103], v6
s_cbranch_vccnz mega_kernel_rs_pa_14_1f
v_smfmac_f32_16x16x64_bf16 v[96:99], v[36:39], a[8:15], v6
v_smfmac_f32_16x16x64_bf16 v[100:103], v[36:39], a[40:47], v6
v_smfmac_f32_16x16x64_bf16 v[104:107], v[36:39], a[72:79], v6
s_waitcnt vmcnt(1)
v_max_u32 v4, v40, v42
v_cmp_eq_u32 vcc, -1, v4
v_smfmac_f32_16x16x64_bf16 v[108:111], v[36:39], a[104:111], v6
s_cbranch_vccnz mega_kernel_rs_pa_12_2f
v_smfmac_f32_16x16x64_bf16 v[96:99], v[40:43], a[16:23], v6
v_smfmac_f32_16x16x64_bf16 v[100:103], v[40:43], a[48:55], v6
v_smfmac_f32_16x16x64_bf16 v[104:107], v[40:43], a[80:87], v6
s_waitcnt vmcnt(0)
v_max_u32 v4, v44, v46
v_cmp_eq_u32 vcc, -1, v4
v_smfmac_f32_16x16x64_bf16 v[108:111], v[40:43], a[112:119], v6
s_cbranch_vccnz mega_kernel_rs_pa_8_3f
v_smfmac_f32_16x16x64_bf16 v[96:99], v[44:47], a[24:31], v6
v_smfmac_f32_16x16x64_bf16 v[100:103], v[44:47], a[56:63], v6
v_smfmac_f32_16x16x64_bf16 v[104:107], v[44:47], a[88:95], v6
v_smfmac_f32_16x16x64_bf16 v[108:111], v[44:47], a[120:127], v6
mega_kernel_rs_pa_d:
mega_kernel_rs_adone:
s_nop 5
v_permlane32_swap_b32 v96, v100
v_permlane32_swap_b32 v97, v101
v_permlane32_swap_b32 v98, v102
v_permlane32_swap_b32 v99, v103
v_pk_add_f32 v[96:97], v[96:97], v[100:101]
v_pk_add_f32 v[98:99], v[98:99], v[102:103]
ds_write2_b32 v14, v96, v97 offset0:0 offset1:36
ds_write2_b32 v14, v98, v99 offset0:72 offset1:108
v_permlane32_swap_b32 v104, v108
v_permlane32_swap_b32 v105, v109
v_permlane32_swap_b32 v106, v110
v_permlane32_swap_b32 v107, v111
v_pk_add_f32 v[104:105], v[104:105], v[108:109]
v_pk_add_f32 v[106:107], v[106:107], v[110:111]
ds_write2_b32 v15, v104, v105 offset0:0 offset1:36
ds_write2_b32 v15, v106, v107 offset0:72 offset1:108
v_smfmac_f32_16x16x64_bf16 v[112:115], v[32:35], a[128:135], v6
v_smfmac_f32_16x16x64_bf16 v[116:119], v[32:35], a[160:167], v6
v_smfmac_f32_16x16x64_bf16 v[112:115], v[36:39], a[136:143], v6
v_smfmac_f32_16x16x64_bf16 v[116:119], v[36:39], a[168:175], v6
s_waitcnt lgkmcnt(0)
s_barrier
s_cmp_lg_u32 s24, 0
s_cbranch_scc1 mega_kernel_rs_side
ds_read_b128 v[120:123], v16 offset:0
ds_read_b128 v[124:127], v16 offset:16
ds_read_b128 v[128:131], v16 offset:2304
ds_read_b128 v[132:135], v16 offset:2320
ds_read_b128 v[136:139], v16 offset:4608
ds_read_b128 v[140:143], v16 offset:4624
ds_read_b128 v[144:147], v16 offset:6912
ds_read_b128 v[148:151], v16 offset:6928
v_smfmac_f32_16x16x64_bf16 v[112:115], v[40:43], a[144:151], v6
v_smfmac_f32_16x16x64_bf16 v[116:119], v[40:43], a[176:183], v6
v_smfmac_f32_16x16x64_bf16 v[112:115], v[44:47], a[152:159], v6
v_smfmac_f32_16x16x64_bf16 v[116:119], v[44:47], a[184:191], v6
s_lshl_b32 s28, s31, 11
s_add_u32 s28, s28, s33
s_add_u32 s28, s28, 32768
s_add_u32 s76, s37, s33
s_add_u32 s77, s38, s33
s_add_u32 s78, s39, s33
s_waitcnt lgkmcnt(4)
v_pk_add_f32 v[120:121], v[120:121], v[128:129]
v_pk_add_f32 v[122:123], v[122:123], v[130:131]
v_pk_add_f32 v[124:125], v[124:125], v[132:133]
v_pk_add_f32 v[126:127], v[126:127], v[134:135]
s_waitcnt lgkmcnt(0)
v_pk_add_f32 v[136:137], v[136:137], v[144:145]
v_pk_add_f32 v[138:139], v[138:139], v[146:147]
v_pk_add_f32 v[140:141], v[140:141], v[148:149]
v_pk_add_f32 v[142:143], v[142:143], v[150:151]
v_pk_add_f32 v[120:121], v[120:121], v[136:137]
v_pk_add_f32 v[122:123], v[122:123], v[138:139]
v_pk_add_f32 v[124:125], v[124:125], v[140:141]
v_pk_add_f32 v[126:127], v[126:127], v[142:143]
v_cvt_pk_bf16_f32 v152, v120, v121
v_cvt_pk_bf16_f32 v153, v122, v123
v_cvt_pk_bf16_f32 v154, v124, v125
v_cvt_pk_bf16_f32 v155, v126, v127
s_nop 1
v_mfma_f32_16x16x32_bf16 v[176:179], v[160:163], v[152:155], 0
v_mfma_f32_16x16x32_bf16 v[172:175], v[156:159], v[152:155], 0
v_mfma_f32_16x16x32_bf16 v[180:183], v[152:155], v[152:155], 0
s_cmp_eq_u32 s27, 63
s_cbranch_scc1 mega_kernel_rs_w0last
s_nop 4
v_mov_b32_dpp v172, v176 row_shr:8 row_mask:0xf bank_mask:0xc
v_mov_b32_dpp v173, v177 row_shr:8 row_mask:0xf bank_mask:0xc
v_mov_b32_dpp v174, v178 row_shr:8 row_mask:0xf bank_mask:0xc
v_mov_b32_dpp v175, v179 row_shr:8 row_mask:0xf bank_mask:0xc
v_min_u32 v180, -2, v180
v_min_u32 v172, -2, v172
s_mov_b64 exec, s[42:43]
buffer_store_dwordx4 v[180:183], v10, s[84:87], s28 offen sc1
s_mov_b64 exec, -1
buffer_store_dwordx4 v[172:175], v17, s[84:87], s28 offen sc1
v_permlane32_swap_b32 v112, v116
v_permlane32_swap_b32 v113, v117
v_permlane32_swap_b32 v114, v118
v_permlane32_swap_b32 v115, v119
v_pk_add_f32 v[112:113], v[112:113], v[116:117]
v_pk_add_f32 v[114:115], v[114:115], v[118:119]
ds_write_b128 v20, v[112:115]
s_waitcnt lgkmcnt(0)
s_barrier
v_mov_b32 v96, 0
v_mov_b32 v97, 0
v_mov_b32 v98, 0
v_mov_b32 v99, 0
v_mov_b32 v100, 0
v_mov_b32 v101, 0
v_mov_b32 v102, 0
v_mov_b32 v103, 0
buffer_load_dwordx4 v[184:187], v17, s[84:87], s76 offen sc1
buffer_load_dwordx4 v[188:191], v10, s[84:87], s76 offen sc1
buffer_load_dwordx4 v[192:195], v17, s[84:87], s77 offen sc1
buffer_load_dwordx4 v[196:199], v10, s[84:87], s77 offen sc1
buffer_load_dwordx4 v[200:203], v17, s[84:87], s78 offen sc1
buffer_load_dwordx4 v[204:207], v10, s[84:87], s78 offen sc1
s_nop 15
s_nop 7
buffer_load_dwordx4 v[184:187], v17, s[84:87], s76 offen sc1
buffer_load_dwordx4 v[188:191], v10, s[84:87], s76 offen sc1
buffer_load_dwordx4 v[192:195], v17, s[84:87], s77 offen sc1
buffer_load_dwordx4 v[196:199], v10, s[84:87], s77 offen sc1
buffer_load_dwordx4 v[200:203], v17, s[84:87], s78 offen sc1
buffer_load_dwordx4 v[204:207], v10, s[84:87], s78 offen sc1
mega_kernel_rs_p2:
s_waitcnt vmcnt(6)
v_max3_u32 v4, v184, v188, v192
v_max3_u32 v5, v196, v200, v204
v_max_u32 v4, v4, v5
v_cmp_eq_u32 vcc, -1, v4
s_cbranch_vccnz mega_kernel_rs_p2r
v_pk_add_f32 v[180:181], v[180:181], v[188:189]
v_pk_add_f32 v[124:125], v[196:197], v[204:205]
v_pk_add_f32 v[182:183], v[182:183], v[190:191]
v_pk_add_f32 v[126:127], v[198:199], v[206:207]
v_pk_add_f32 v[172:173], v[172:173], v[184:185]
v_pk_add_f32 v[120:121], v[192:193], v[200:201]
v_pk_add_f32 v[174:175], v[174:175], v[186:187]
v_pk_add_f32 v[122:123], v[194:195], v[202:203]
v_pk_add_f32 v[180:181], v[180:181], v[124:125]
v_pk_add_f32 v[182:183], v[182:183], v[126:127]
v_pk_add_f32 v[172:173], v[172:173], v[120:121]
v_pk_add_f32 v[174:175], v[174:175], v[122:123]
v_cndmask_b32 v176, v23, v180, s[42:43]
v_cndmask_b32 v177, v23, v181, s[42:43]
v_cndmask_b32 v178, v23, v182, s[42:43]
v_cndmask_b32 v179, v23, v183, s[42:43]
v_max3_f32 v232, v172, v173, v174
v_max3_f32 v233, v176, v177, v178
v_max3_f32 v232, v232, v175, v179
v_max_f32 v234, v232, v233
s_barrier
ds_read2_b64 v[208:211], v21 offset0:0 offset1:32
v_max_f32_dpp v232, v234, v234 row_ror:8 row_mask:0xf bank_mask:0xf
v_max_f32_dpp v233, v234, v234 row_ror:8 row_mask:0xf bank_mask:0xf
s_nop 1
v_permlane16_swap_b32 v232, v233
s_nop 0
v_max_f32 v234, v232, v233
v_max_f32 v235, v232, v233
s_nop 1
v_permlane32_swap_b32 v234, v235
s_nop 0
v_max_f32 v232, v234, v235
v_mul_f32 v232, s32, v232
v_fma_f32 v176, v176, s32, -v232
v_fma_f32 v177, v177, s32, -v232
v_fma_f32 v178, v178, s32, -v232
v_fma_f32 v179, v179, s32, -v232
v_fma_f32 v172, v172, s32, -v232
v_fma_f32 v173, v173, s32, -v232
v_fma_f32 v174, v174, s32, -v232
v_fma_f32 v175, v175, s32, -v232
v_exp_f32 v176, v176
v_exp_f32 v177, v177
v_exp_f32 v178, v178
v_exp_f32 v179, v179
v_exp_f32 v172, v172
v_cvt_pk_bf16_f32 v216, v176, v177
v_cvt_pk_bf16_f32 v217, v178, v179
v_exp_f32 v173, v173
v_exp_f32 v174, v174
v_mfma_f32_16x16x16_bf16 v[224:227], v[220:221], v[216:217], 0
v_exp_f32 v175, v175
v_cvt_pk_bf16_f32 v212, v172, v173
s_waitcnt lgkmcnt(0)
v_mfma_f32_16x16x16_bf16 v[120:123], v[208:209], v[216:217], 0
v_cvt_pk_bf16_f32 v213, v174, v175
v_mfma_f32_16x16x16_bf16 v[124:127], v[210:211], v[216:217], 0
v_mov_b32_dpp v214, v212 row_ror:8 row_mask:0xf bank_mask:0xf
v_mov_b32_dpp v215, v213 row_ror:8 row_mask:0xf bank_mask:0xf
s_nop 1
v_mfma_f32_16x16x32_bf16 v[224:227], v[220:223], v[212:215], v[224:227]
v_mfma_f32_16x16x32_bf16 v[120:123], v[164:167], v[212:215], v[120:123]
v_mfma_f32_16x16x32_bf16 v[124:127], v[168:171], v[212:215], v[124:127]
s_add_u32 s29, s33, 16384
s_nop 4
v_rcp_f32 v234, v224
v_rcp_f32 v235, v225
s_nop 0
v_pk_mul_f32 v[120:121], v[120:121], v[234:235]
v_pk_mul_f32 v[122:123], v[122:123], v[234:235]
v_pk_mul_f32 v[124:125], v[124:125], v[234:235]
v_pk_mul_f32 v[126:127], v[126:127], v[234:235]
v_cvt_pk_bf16_f32 v212, v120, v121
v_cvt_pk_bf16_f32 v213, v122, v123
v_cvt_pk_bf16_f32 v214, v124, v125
v_cvt_pk_bf16_f32 v215, v126, v127
v_min_u32 v212, -2, v212
s_mov_b64 exec, s[40:41]
buffer_store_dwordx4 v[212:215], v11, s[84:87], s33 offen sc1
s_mov_b64 exec, -1
mega_kernel_rs_b3:
s_barrier
s_nop 9
buffer_load_dwordx4 v[32:35], v7, s[84:87], s29 offen offset:0 sc1
s_nop 9
buffer_load_dwordx4 v[36:39], v7, s[84:87], s29 offen offset:1024 sc1
s_nop 9
buffer_load_dwordx4 v[40:43], v7, s[84:87], s29 offen offset:2048 sc1
s_nop 9
buffer_load_dwordx4 v[44:47], v7, s[84:87], s29 offen offset:3072 sc1
mega_kernel_rs_pc_15_0:
s_waitcnt vmcnt(3)
v_cmp_eq_u32 vcc, -1, v32
s_cbranch_vccnz mega_kernel_rs_pc_15_0f
v_smfmac_f32_16x16x64_bf16 v[96:99], v[32:35], a[192:199], v6
v_smfmac_f32_16x16x64_bf16 v[100:103], v[32:35], a[224:231], v6
mega_kernel_rs_pc_14_1:
s_waitcnt vmcnt(2)
v_cmp_eq_u32 vcc, -1, v36
s_cbranch_vccnz mega_kernel_rs_pc_14_1f
v_smfmac_f32_16x16x64_bf16 v[96:99], v[36:39], a[200:207], v6
v_smfmac_f32_16x16x64_bf16 v[100:103], v[36:39], a[232:239], v6
mega_kernel_rs_pc_12_2:
s_waitcnt vmcnt(1)
v_cmp_eq_u32 vcc, -1, v40
s_cbranch_vccnz mega_kernel_rs_pc_12_2f
v_smfmac_f32_16x16x64_bf16 v[96:99], v[40:43], a[208:215], v6
v_smfmac_f32_16x16x64_bf16 v[100:103], v[40:43], a[240:247], v6
mega_kernel_rs_pc_8_3:
s_waitcnt vmcnt(0)
v_cmp_eq_u32 vcc, -1, v44
s_cbranch_vccnz mega_kernel_rs_pc_8_3f
v_smfmac_f32_16x16x64_bf16 v[96:99], v[44:47], a[216:223], v6
v_smfmac_f32_16x16x64_bf16 v[100:103], v[44:47], a[248:255], v6
mega_kernel_rs_pc_d:
s_nop 7
v_permlane32_swap_b32 v96, v100
v_permlane32_swap_b32 v97, v101
v_permlane32_swap_b32 v98, v102
v_permlane32_swap_b32 v99, v103
v_pk_add_f32 v[96:97], v[96:97], v[100:101]
v_pk_add_f32 v[98:99], v[98:99], v[102:103]
ds_write2_b32 v18, v96, v97 offset0:0 offset1:36
ds_write2_b32 v18, v98, v99 offset0:72 offset1:108
s_waitcnt lgkmcnt(0)
s_barrier
s_cmp_lg_u32 s24, 0
s_cbranch_scc1 mega_kernel_rs_x1
ds_read_b128 v[120:123], v19 offset:0
ds_read_b128 v[124:127], v19 offset:1152
ds_read_b128 v[128:131], v19 offset:2304
ds_read_b128 v[132:135], v19 offset:3456
s_waitcnt lgkmcnt(2)
v_pk_add_f32 v[120:121], v[120:121], v[124:125]
v_pk_add_f32 v[122:123], v[122:123], v[126:127]
s_waitcnt lgkmcnt(0)
v_pk_add_f32 v[128:129], v[128:129], v[132:133]
v_pk_add_f32 v[130:131], v[130:131], v[134:135]
v_pk_add_f32 v[120:121], v[120:121], v[128:129]
v_pk_add_f32 v[122:123], v[122:123], v[130:131]
v_and_or_b32 v120, v120, -2, s47
v_and_or_b32 v121, v121, -2, s47
v_and_or_b32 v122, v122, -2, s47
v_and_or_b32 v123, v123, -2, s47
buffer_store_dwordx4 v[120:123], v12, s[84:87], s35 offen sc1
s_xor_b32 s76, s47, 1
v_mov_b32 v48, s76
v_mov_b32 v49, s76
v_mov_b32 v50, s76
v_mov_b32 v51, s76
v_mov_b32 v52, s76
v_mov_b32 v53, s76
v_mov_b32 v54, s76
v_mov_b32 v55, s76
v_mov_b32 v56, s76
v_mov_b32 v57, s76
v_mov_b32 v58, s76
v_mov_b32 v59, s76
v_mov_b32 v96, 0
v_mov_b32 v97, 0
v_mov_b32 v98, 0
v_mov_b32 v99, 0
v_mov_b32 v100, 0
v_mov_b32 v101, 0
v_mov_b32 v102, 0
v_mov_b32 v103, 0
v_mov_b32 v104, 0
v_mov_b32 v105, 0
v_mov_b32 v106, 0
v_mov_b32 v107, 0
v_mov_b32 v108, 0
v_mov_b32 v109, 0
v_mov_b32 v110, 0
v_mov_b32 v111, 0
v_mov_b32 v112, 0
v_mov_b32 v113, 0
v_mov_b32 v114, 0
v_mov_b32 v115, 0
v_mov_b32 v116, 0
v_mov_b32 v117, 0
v_mov_b32 v118, 0
v_mov_b32 v119, 0
s_nop 15
s_cmp_eq_u32 s47, 1
s_cbranch_scc1 mega_kernel_rs_p4_1
mega_kernel_rs_p4_0:
buffer_load_dwordx4 v[48:51], v25, s[84:87], s35 offen sc1
buffer_load_dwordx4 v[52:55], v26, s[84:87], s35 offen sc1
buffer_load_dwordx4 v[56:59], v27, s[84:87], s35 offen sc1
s_waitcnt vmcnt(36)
s_nop 1
v_bitop3_b32 v4, v48, v49, v50 bitop3:0xfe
v_bitop3_b32 v5, v54, v55, v56 bitop3:0xfe
v_bitop3_b32 v4, v4, v51, v52 bitop3:0xfe
v_bitop3_b32 v5, v5, v57, v58 bitop3:0xfe
v_bitop3_b32 v4, v4, v53, v59 bitop3:0xfe
v_bitop3_b32 v4, v4, v5, 1 bitop3:0xa8
v_cmp_ne_u32 vcc, 0, v4
s_cbranch_vccnz mega_kernel_rs_p4_0
s_branch mega_kernel_rs_p4d
mega_kernel_rs_p4_1:
buffer_load_dwordx4 v[48:51], v25, s[84:87], s35 offen sc1
buffer_load_dwordx4 v[52:55], v26, s[84:87], s35 offen sc1
buffer_load_dwordx4 v[56:59], v27, s[84:87], s35 offen sc1
s_waitcnt vmcnt(36)
s_nop 1
v_bitop3_b32 v4, v48, v49, v50 bitop3:0x80
v_bitop3_b32 v5, v54, v55, v56 bitop3:0x80
v_bitop3_b32 v4, v4, v51, v52 bitop3:0x80
v_bitop3_b32 v5, v5, v57, v58 bitop3:0x80
v_bitop3_b32 v4, v4, v53, v59 bitop3:0x80
v_bitop3_b32 v4, v4, v5, 1 bitop3:0x80
v_cmp_ne_u32 vcc, 1, v4
s_cbranch_vccnz mega_kernel_rs_p4_1
mega_kernel_rs_p4d:
v_pk_add_f32 v[120:121], v[120:121], v[48:49]
v_pk_add_f32 v[124:125], v[52:53], v[56:57]
v_pk_add_f32 v[122:123], v[122:123], v[50:51]
v_pk_add_f32 v[126:127], v[54:55], v[58:59]
v_pk_add_f32 v[120:121], v[120:121], v[124:125]
v_pk_add_f32 v[122:123], v[122:123], v[126:127]
v_cvt_pk_bf16_f32 v212, v120, v121
v_cvt_pk_bf16_f32 v213, v122, v123
v_min_u32 v212, -2, v212
buffer_store_dwordx2 v[212:213], v9, s[84:87], s34 offen sc1
mega_kernel_rs_b5:
s_add_u32 s27, s27, 1
s_add_u32 s44, s44, 4096
s_cmp_eq_u32 s44, 30720
s_cselect_b32 s44, 18432, s44
s_mov_b32 s28, s33
s_mov_b32 s33, s34
s_mov_b32 s34, s28
s_xor_b32 s35, s35, 262144
s_bfe_u32 s47, s27, 0x10001
s_barrier
s_nop 9
s_branch mega_kernel_rs_loop
mega_kernel_rs_x1:
s_cmp_eq_u32 s24, 1
s_cbranch_scc0 mega_kernel_rs_x2
s_add_u32 s76, s27, 1
v_mov_b32 v5, s76
s_mov_b64 exec, 1
buffer_store_dword v5, v228, s[84:87], s81 offen sc1
s_mov_b64 exec, -1
mega_kernel_rs_x2:
s_cmp_eq_u32 s24, 3
s_cbranch_scc0 mega_kernel_rs_x4
buffer_store_dwordx2 v[28:29], v9, s[84:87], s33 offen sc1
s_lshl_b32 s28, s31, 11
s_add_u32 s28, s28, s33
s_add_u32 s28, s28, 32768
buffer_store_dwordx4 v[28:31], v17, s[84:87], s28 offen sc1
buffer_store_dwordx4 v[28:31], v10, s[84:87], s28 offen sc1
s_add_u32 s76, s27, 2
s_cmp_lt_u32 s76, 63
s_cbranch_scc0 mega_kernel_rs_x4
s_cmp_gt_i32 s46, s76
s_cbranch_scc0 mega_kernel_rs_x4
s_add_u32 s77, s76, s82
s_bfe_u32 s28, s77, 0x40002
s_lshl_b32 s28, s28, 14
s_and_b32 s77, s77, 3
s_lshl_b32 s77, s77, 11
s_add_u32 s28, s28, s77
s_add_u32 s28, s28, s83
s_add_u32 s28, s28, 33554432
s_buffer_load_dword s78, s[84:87], s28 offset:0
s_buffer_load_dword s78, s[84:87], s28 offset:128
s_buffer_load_dword s78, s[84:87], s28 offset:256
s_buffer_load_dword s78, s[84:87], s28 offset:384
s_buffer_load_dword s78, s[84:87], s28 offset:512
s_buffer_load_dword s78, s[84:87], s28 offset:640
s_buffer_load_dword s78, s[84:87], s28 offset:768
s_buffer_load_dword s78, s[84:87], s28 offset:896
s_buffer_load_dword s78, s[84:87], s28 offset:1024
s_buffer_load_dword s78, s[84:87], s28 offset:1152
s_buffer_load_dword s78, s[84:87], s28 offset:1280
s_buffer_load_dword s78, s[84:87], s28 offset:1408
s_buffer_load_dword s78, s[84:87], s28 offset:1536
s_buffer_load_dword s78, s[84:87], s28 offset:1664
s_buffer_load_dword s78, s[84:87], s28 offset:1792
s_buffer_load_dword s78, s[84:87], s28 offset:1920
mega_kernel_rs_x4:
v_mov_b32 v96, 0
v_mov_b32 v97, 0
v_mov_b32 v98, 0
v_mov_b32 v99, 0
v_mov_b32 v100, 0
v_mov_b32 v101, 0
v_mov_b32 v102, 0
v_mov_b32 v103, 0
v_mov_b32 v104, 0
v_mov_b32 v105, 0
v_mov_b32 v106, 0
v_mov_b32 v107, 0
v_mov_b32 v108, 0
v_mov_b32 v109, 0
v_mov_b32 v110, 0
v_mov_b32 v111, 0
v_mov_b32 v112, 0
v_mov_b32 v113, 0
v_mov_b32 v114, 0
v_mov_b32 v115, 0
v_mov_b32 v116, 0
v_mov_b32 v117, 0
v_mov_b32 v118, 0
v_mov_b32 v119, 0
s_branch mega_kernel_rs_b5
mega_kernel_rs_p2r:
buffer_load_dwordx4 v[184:187], v17, s[84:87], s76 offen sc1
buffer_load_dwordx4 v[188:191], v10, s[84:87], s76 offen sc1
buffer_load_dwordx4 v[192:195], v17, s[84:87], s77 offen sc1
buffer_load_dwordx4 v[196:199], v10, s[84:87], s77 offen sc1
buffer_load_dwordx4 v[200:203], v17, s[84:87], s78 offen sc1
buffer_load_dwordx4 v[204:207], v10, s[84:87], s78 offen sc1
s_branch mega_kernel_rs_p2
mega_kernel_rs_pa_1_0f:
s_mov_b64 exec, vcc
buffer_load_dwordx4 v[32:35], v7, s[84:87], s33 offen offset:0 sc1
s_mov_b64 exec, -1
s_branch mega_kernel_rs_pa_1_0
mega_kernel_rs_pa_1_0:
s_waitcnt vmcnt(0)
v_max_u32 v4, v32, v34
v_cmp_eq_u32 vcc, -1, v4
s_cbranch_vccnz mega_kernel_rs_pa_1_0f
v_smfmac_f32_16x16x64_bf16 v[96:99], v[32:35], a[0:7], v6
v_smfmac_f32_16x16x64_bf16 v[100:103], v[32:35], a[32:39], v6
v_smfmac_f32_16x16x64_bf16 v[104:107], v[32:35], a[64:71], v6
v_smfmac_f32_16x16x64_bf16 v[108:111], v[32:35], a[96:103], v6
s_branch mega_kernel_rs_pa_d
mega_kernel_rs_pa_2_1f:
s_mov_b64 exec, vcc
buffer_load_dwordx4 v[36:39], v7, s[84:87], s33 offen offset:1024 sc1
s_mov_b64 exec, -1
s_branch mega_kernel_rs_pa_2_1
mega_kernel_rs_pa_2_1:
s_waitcnt vmcnt(0)
v_max_u32 v4, v36, v38
v_cmp_eq_u32 vcc, -1, v4
s_cbranch_vccnz mega_kernel_rs_pa_2_1f
v_smfmac_f32_16x16x64_bf16 v[96:99], v[36:39], a[8:15], v6
v_smfmac_f32_16x16x64_bf16 v[100:103], v[36:39], a[40:47], v6
v_smfmac_f32_16x16x64_bf16 v[104:107], v[36:39], a[72:79], v6
v_smfmac_f32_16x16x64_bf16 v[108:111], v[36:39], a[104:111], v6
s_branch mega_kernel_rs_pa_d
mega_kernel_rs_pa_3_0f:
s_mov_b64 exec, vcc
buffer_load_dwordx4 v[32:35], v7, s[84:87], s33 offen offset:0 sc1
s_mov_b64 exec, -1
s_branch mega_kernel_rs_pa_3_1
mega_kernel_rs_pa_3_0:
s_waitcnt vmcnt(1)
v_max_u32 v4, v32, v34
v_cmp_eq_u32 vcc, -1, v4
s_cbranch_vccnz mega_kernel_rs_pa_3_0f
v_smfmac_f32_16x16x64_bf16 v[96:99], v[32:35], a[0:7], v6
v_smfmac_f32_16x16x64_bf16 v[100:103], v[32:35], a[32:39], v6
v_smfmac_f32_16x16x64_bf16 v[104:107], v[32:35], a[64:71], v6
v_smfmac_f32_16x16x64_bf16 v[108:111], v[32:35], a[96:103], v6
s_branch mega_kernel_rs_pa_2_1
mega_kernel_rs_pa_3_1f:
s_mov_b64 exec, vcc
buffer_load_dwordx4 v[36:39], v7, s[84:87], s33 offen offset:1024 sc1
s_mov_b64 exec, -1
s_branch mega_kernel_rs_pa_3_0
mega_kernel_rs_pa_3_1:
s_waitcnt vmcnt(1)
v_max_u32 v4, v36, v38
v_cmp_eq_u32 vcc, -1, v4
s_cbranch_vccnz mega_kernel_rs_pa_3_1f
v_smfmac_f32_16x16x64_bf16 v[96:99], v[36:39], a[8:15], v6
v_smfmac_f32_16x16x64_bf16 v[100:103], v[36:39], a[40:47], v6
v_smfmac_f32_16x16x64_bf16 v[104:107], v[36:39], a[72:79], v6
v_smfmac_f32_16x16x64_bf16 v[108:111], v[36:39], a[104:111], v6
s_branch mega_kernel_rs_pa_1_0
mega_kernel_rs_pa_4_2f:
s_mov_b64 exec, vcc
buffer_load_dwordx4 v[40:43], v7, s[84:87], s33 offen offset:2048 sc1
s_mov_b64 exec, -1
s_branch mega_kernel_rs_pa_4_2
mega_kernel_rs_pa_4_2:
s_waitcnt vmcnt(0)
v_max_u32 v4, v40, v42
v_cmp_eq_u32 vcc, -1, v4
s_cbranch_vccnz mega_kernel_rs_pa_4_2f
v_smfmac_f32_16x16x64_bf16 v[96:99], v[40:43], a[16:23], v6
v_smfmac_f32_16x16x64_bf16 v[100:103], v[40:43], a[48:55], v6
v_smfmac_f32_16x16x64_bf16 v[104:107], v[40:43], a[80:87], v6
v_smfmac_f32_16x16x64_bf16 v[108:111], v[40:43], a[112:119], v6
s_branch mega_kernel_rs_pa_d
mega_kernel_rs_pa_5_0f:
s_mov_b64 exec, vcc
buffer_load_dwordx4 v[32:35], v7, s[84:87], s33 offen offset:0 sc1
s_mov_b64 exec, -1
s_branch mega_kernel_rs_pa_5_2
mega_kernel_rs_pa_5_0:
s_waitcnt vmcnt(1)
v_max_u32 v4, v32, v34
v_cmp_eq_u32 vcc, -1, v4
s_cbranch_vccnz mega_kernel_rs_pa_5_0f
v_smfmac_f32_16x16x64_bf16 v[96:99], v[32:35], a[0:7], v6
v_smfmac_f32_16x16x64_bf16 v[100:103], v[32:35], a[32:39], v6
v_smfmac_f32_16x16x64_bf16 v[104:107], v[32:35], a[64:71], v6
v_smfmac_f32_16x16x64_bf16 v[108:111], v[32:35], a[96:103], v6
s_branch mega_kernel_rs_pa_4_2
mega_kernel_rs_pa_5_2f:
s_mov_b64 exec, vcc
buffer_load_dwordx4 v[40:43], v7, s[84:87], s33 offen offset:2048 sc1
s_mov_b64 exec, -1
s_branch mega_kernel_rs_pa_5_0
mega_kernel_rs_pa_5_2:
s_waitcnt vmcnt(1)
v_max_u32 v4, v40, v42
v_cmp_eq_u32 vcc, -1, v4
s_cbranch_vccnz mega_kernel_rs_pa_5_2f
v_smfmac_f32_16x16x64_bf16 v[96:99], v[40:43], a[16:23], v6
v_smfmac_f32_16x16x64_bf16 v[100:103], v[40:43], a[48:55], v6
v_smfmac_f32_16x16x64_bf16 v[104:107], v[40:43], a[80:87], v6
v_smfmac_f32_16x16x64_bf16 v[108:111], v[40:43], a[112:119], v6
s_branch mega_kernel_rs_pa_1_0
mega_kernel_rs_pa_6_1f:
s_mov_b64 exec, vcc
buffer_load_dwordx4 v[36:39], v7, s[84:87], s33 offen offset:1024 sc1
s_mov_b64 exec, -1
s_branch mega_kernel_rs_pa_6_2
mega_kernel_rs_pa_6_1:
s_waitcnt vmcnt(1)
v_max_u32 v4, v36, v38
v_cmp_eq_u32 vcc, -1, v4
s_cbranch_vccnz mega_kernel_rs_pa_6_1f
v_smfmac_f32_16x16x64_bf16 v[96:99], v[36:39], a[8:15], v6
v_smfmac_f32_16x16x64_bf16 v[100:103], v[36:39], a[40:47], v6
v_smfmac_f32_16x16x64_bf16 v[104:107], v[36:39], a[72:79], v6
v_smfmac_f32_16x16x64_bf16 v[108:111], v[36:39], a[104:111], v6
s_branch mega_kernel_rs_pa_4_2
mega_kernel_rs_pa_6_2f:
s_mov_b64 exec, vcc
buffer_load_dwordx4 v[40:43], v7, s[84:87], s33 offen offset:2048 sc1
s_mov_b64 exec, -1
s_branch mega_kernel_rs_pa_6_1
mega_kernel_rs_pa_6_2:
s_waitcnt vmcnt(1)
v_max_u32 v4, v40, v42
v_cmp_eq_u32 vcc, -1, v4
s_cbranch_vccnz mega_kernel_rs_pa_6_2f
v_smfmac_f32_16x16x64_bf16 v[96:99], v[40:43], a[16:23], v6
v_smfmac_f32_16x16x64_bf16 v[100:103], v[40:43], a[48:55], v6
v_smfmac_f32_16x16x64_bf16 v[104:107], v[40:43], a[80:87], v6
v_smfmac_f32_16x16x64_bf16 v[108:111], v[40:43], a[112:119], v6
s_branch mega_kernel_rs_pa_2_1
mega_kernel_rs_pa_7_0f:
s_mov_b64 exec, vcc
buffer_load_dwordx4 v[32:35], v7, s[84:87], s33 offen offset:0 sc1
s_mov_b64 exec, -1
s_branch mega_kernel_rs_pa_7_1
mega_kernel_rs_pa_7_0:
s_waitcnt vmcnt(2)
v_max_u32 v4, v32, v34
v_cmp_eq_u32 vcc, -1, v4
s_cbranch_vccnz mega_kernel_rs_pa_7_0f
v_smfmac_f32_16x16x64_bf16 v[96:99], v[32:35], a[0:7], v6
v_smfmac_f32_16x16x64_bf16 v[100:103], v[32:35], a[32:39], v6
v_smfmac_f32_16x16x64_bf16 v[104:107], v[32:35], a[64:71], v6
v_smfmac_f32_16x16x64_bf16 v[108:111], v[32:35], a[96:103], v6
s_branch mega_kernel_rs_pa_6_1
mega_kernel_rs_pa_7_1f:
s_mov_b64 exec, vcc
buffer_load_dwordx4 v[36:39], v7, s[84:87], s33 offen offset:1024 sc1
s_mov_b64 exec, -1
s_branch mega_kernel_rs_pa_7_2
mega_kernel_rs_pa_7_1:
s_waitcnt vmcnt(2)
v_max_u32 v4, v36, v38
v_cmp_eq_u32 vcc, -1, v4
s_cbranch_vccnz mega_kernel_rs_pa_7_1f
v_smfmac_f32_16x16x64_bf16 v[96:99], v[36:39], a[8:15], v6
v_smfmac_f32_16x16x64_bf16 v[100:103], v[36:39], a[40:47], v6
v_smfmac_f32_16x16x64_bf16 v[104:107], v[36:39], a[72:79], v6
v_smfmac_f32_16x16x64_bf16 v[108:111], v[36:39], a[104:111], v6
s_branch mega_kernel_rs_pa_5_2
mega_kernel_rs_pa_7_2f:
s_mov_b64 exec, vcc
buffer_load_dwordx4 v[40:43], v7, s[84:87], s33 offen offset:2048 sc1
s_mov_b64 exec, -1
s_branch mega_kernel_rs_pa_7_0
mega_kernel_rs_pa_7_2:
s_waitcnt vmcnt(2)
v_max_u32 v4, v40, v42
v_cmp_eq_u32 vcc, -1, v4
s_cbranch_vccnz mega_kernel_rs_pa_7_2f
v_smfmac_f32_16x16x64_bf16 v[96:99], v[40:43], a[16:23], v6
v_smfmac_f32_16x16x64_bf16 v[100:103], v[40:43], a[48:55], v6
v_smfmac_f32_16x16x64_bf16 v[104:107], v[40:43], a[80:87], v6
v_smfmac_f32_16x16x64_bf16 v[108:111], v[40:43], a[112:119], v6
s_branch mega_kernel_rs_pa_3_0
mega_kernel_rs_pa_8_3f:
s_mov_b64 exec, vcc
buffer_load_dwordx4 v[44:47], v7, s[84:87], s33 offen offset:3072 sc1
s_mov_b64 exec, -1
s_branch mega_kernel_rs_pa_8_3
mega_kernel_rs_pa_8_3:
s_waitcnt vmcnt(0)
v_max_u32 v4, v44, v46
v_cmp_eq_u32 vcc, -1, v4
s_cbranch_vccnz mega_kernel_rs_pa_8_3f
v_smfmac_f32_16x16x64_bf16 v[96:99], v[44:47], a[24:31], v6
v_smfmac_f32_16x16x64_bf16 v[100:103], v[44:47], a[56:63], v6
v_smfmac_f32_16x16x64_bf16 v[104:107], v[44:47], a[88:95], v6
v_smfmac_f32_16x16x64_bf16 v[108:111], v[44:47], a[120:127], v6
s_branch mega_kernel_rs_pa_d
mega_kernel_rs_pa_9_0f:
s_mov_b64 exec, vcc
buffer_load_dwordx4 v[32:35], v7, s[84:87], s33 offen offset:0 sc1
s_mov_b64 exec, -1
s_branch mega_kernel_rs_pa_9_3
mega_kernel_rs_pa_9_0:
s_waitcnt vmcnt(1)
v_max_u32 v4, v32, v34
v_cmp_eq_u32 vcc, -1, v4
s_cbranch_vccnz mega_kernel_rs_pa_9_0f
v_smfmac_f32_16x16x64_bf16 v[96:99], v[32:35], a[0:7], v6
v_smfmac_f32_16x16x64_bf16 v[100:103], v[32:35], a[32:39], v6
v_smfmac_f32_16x16x64_bf16 v[104:107], v[32:35], a[64:71], v6
v_smfmac_f32_16x16x64_bf16 v[108:111], v[32:35], a[96:103], v6
s_branch mega_kernel_rs_pa_8_3
mega_kernel_rs_pa_9_3f:
s_mov_b64 exec, vcc
buffer_load_dwordx4 v[44:47], v7, s[84:87], s33 offen offset:3072 sc1
s_mov_b64 exec, -1
s_branch mega_kernel_rs_pa_9_0
mega_kernel_rs_pa_9_3:
s_waitcnt vmcnt(1)
v_max_u32 v4, v44, v46
v_cmp_eq_u32 vcc, -1, v4
s_cbranch_vccnz mega_kernel_rs_pa_9_3f
v_smfmac_f32_16x16x64_bf16 v[96:99], v[44:47], a[24:31], v6
v_smfmac_f32_16x16x64_bf16 v[100:103], v[44:47], a[56:63], v6
v_smfmac_f32_16x16x64_bf16 v[104:107], v[44:47], a[88:95], v6
v_smfmac_f32_16x16x64_bf16 v[108:111], v[44:47], a[120:127], v6
s_branch mega_kernel_rs_pa_1_0
mega_kernel_rs_pa_10_1f:
s_mov_b64 exec, vcc
buffer_load_dwordx4 v[36:39], v7, s[84:87], s33 offen offset:1024 sc1
s_mov_b64 exec, -1
s_branch mega_kernel_rs_pa_10_3
mega_kernel_rs_pa_10_1:
s_waitcnt vmcnt(1)
v_max_u32 v4, v36, v38
v_cmp_eq_u32 vcc, -1, v4
s_cbranch_vccnz mega_kernel_rs_pa_10_1f
v_smfmac_f32_16x16x64_bf16 v[96:99], v[36:39], a[8:15], v6
v_smfmac_f32_16x16x64_bf16 v[100:103], v[36:39], a[40:47], v6
v_smfmac_f32_16x16x64_bf16 v[104:107], v[36:39], a[72:79], v6
v_smfmac_f32_16x16x64_bf16 v[108:111], v[36:39], a[104:111], v6
s_branch mega_kernel_rs_pa_8_3
mega_kernel_rs_pa_10_3f:
s_mov_b64 exec, vcc
buffer_load_dwordx4 v[44:47], v7, s[84:87], s33 offen offset:3072 sc1
s_mov_b64 exec, -1
s_branch mega_kernel_rs_pa_10_1
mega_kernel_rs_pa_10_3:
s_waitcnt vmcnt(1)
v_max_u32 v4, v44, v46
v_cmp_eq_u32 vcc, -1, v4
s_cbranch_vccnz mega_kernel_rs_pa_10_3f
v_smfmac_f32_16x16x64_bf16 v[96:99], v[44:47], a[24:31], v6
v_smfmac_f32_16x16x64_bf16 v[100:103], v[44:47], a[56:63], v6
v_smfmac_f32_16x16x64_bf16 v[104:107], v[44:47], a[88:95], v6
v_smfmac_f32_16x16x64_bf16 v[108:111], v[44:47], a[120:127], v6
s_branch mega_kernel_rs_pa_2_1
mega_kernel_rs_pa_11_0f:
s_mov_b64 exec, vcc
buffer_load_dwordx4 v[32:35], v7, s[84:87], s33 offen offset:0 sc1
s_mov_b64 exec, -1
s_branch mega_kernel_rs_pa_11_1
mega_kernel_rs_pa_11_0:
s_waitcnt vmcnt(2)
v_max_u32 v4, v32, v34
v_cmp_eq_u32 vcc, -1, v4
s_cbranch_vccnz mega_kernel_rs_pa_11_0f
v_smfmac_f32_16x16x64_bf16 v[96:99], v[32:35], a[0:7], v6
v_smfmac_f32_16x16x64_bf16 v[100:103], v[32:35], a[32:39], v6
v_smfmac_f32_16x16x64_bf16 v[104:107], v[32:35], a[64:71], v6
v_smfmac_f32_16x16x64_bf16 v[108:111], v[32:35], a[96:103], v6
s_branch mega_kernel_rs_pa_10_1
mega_kernel_rs_pa_11_1f:
s_mov_b64 exec, vcc
buffer_load_dwordx4 v[36:39], v7, s[84:87], s33 offen offset:1024 sc1
s_mov_b64 exec, -1
s_branch mega_kernel_rs_pa_11_3
mega_kernel_rs_pa_11_1:
s_waitcnt vmcnt(2)
v_max_u32 v4, v36, v38
v_cmp_eq_u32 vcc, -1, v4
s_cbranch_vccnz mega_kernel_rs_pa_11_1f
v_smfmac_f32_16x16x64_bf16 v[96:99], v[36:39], a[8:15], v6
v_smfmac_f32_16x16x64_bf16 v[100:103], v[36:39], a[40:47], v6
v_smfmac_f32_16x16x64_bf16 v[104:107], v[36:39], a[72:79], v6
v_smfmac_f32_16x16x64_bf16 v[108:111], v[36:39], a[104:111], v6
s_branch mega_kernel_rs_pa_9_3
mega_kernel_rs_pa_11_3f:
s_mov_b64 exec, vcc
buffer_load_dwordx4 v[44:47], v7, s[84:87], s33 offen offset:3072 sc1
s_mov_b64 exec, -1
s_branch mega_kernel_rs_pa_11_0
mega_kernel_rs_pa_11_3:
s_waitcnt vmcnt(2)
v_max_u32 v4, v44, v46
v_cmp_eq_u32 vcc, -1, v4
s_cbranch_vccnz mega_kernel_rs_pa_11_3f
v_smfmac_f32_16x16x64_bf16 v[96:99], v[44:47], a[24:31], v6
v_smfmac_f32_16x16x64_bf16 v[100:103], v[44:47], a[56:63], v6
v_smfmac_f32_16x16x64_bf16 v[104:107], v[44:47], a[88:95], v6
v_smfmac_f32_16x16x64_bf16 v[108:111], v[44:47], a[120:127], v6
s_branch mega_kernel_rs_pa_3_0
mega_kernel_rs_pa_12_2f:
s_mov_b64 exec, vcc
buffer_load_dwordx4 v[40:43], v7, s[84:87], s33 offen offset:2048 sc1
s_mov_b64 exec, -1
s_branch mega_kernel_rs_pa_12_3
mega_kernel_rs_pa_12_2:
s_waitcnt vmcnt(1)
v_max_u32 v4, v40, v42
v_cmp_eq_u32 vcc, -1, v4
s_cbranch_vccnz mega_kernel_rs_pa_12_2f
v_smfmac_f32_16x16x64_bf16 v[96:99], v[40:43], a[16:23], v6
v_smfmac_f32_16x16x64_bf16 v[100:103], v[40:43], a[48:55], v6
v_smfmac_f32_16x16x64_bf16 v[104:107], v[40:43], a[80:87], v6
v_smfmac_f32_16x16x64_bf16 v[108:111], v[40:43], a[112:119], v6
s_branch mega_kernel_rs_pa_8_3
mega_kernel_rs_pa_12_3f:
s_mov_b64 exec, vcc
buffer_load_dwordx4 v[44:47], v7, s[84:87], s33 offen offset:3072 sc1
s_mov_b64 exec, -1
s_branch mega_kernel_rs_pa_12_2
mega_kernel_rs_pa_12_3:
s_waitcnt vmcnt(1)
v_max_u32 v4, v44, v46
v_cmp_eq_u32 vcc, -1, v4
s_cbranch_vccnz mega_kernel_rs_pa_12_3f
v_smfmac_f32_16x16x64_bf16 v[96:99], v[44:47], a[24:31], v6
v_smfmac_f32_16x16x64_bf16 v[100:103], v[44:47], a[56:63], v6
v_smfmac_f32_16x16x64_bf16 v[104:107], v[44:47], a[88:95], v6
v_smfmac_f32_16x16x64_bf16 v[108:111], v[44:47], a[120:127], v6
s_branch mega_kernel_rs_pa_4_2
mega_kernel_rs_pa_13_0f:
s_mov_b64 exec, vcc
buffer_load_dwordx4 v[32:35], v7, s[84:87], s33 offen offset:0 sc1
s_mov_b64 exec, -1
s_branch mega_kernel_rs_pa_13_2
mega_kernel_rs_pa_13_0:
s_waitcnt vmcnt(2)
v_max_u32 v4, v32, v34
v_cmp_eq_u32 vcc, -1, v4
s_cbranch_vccnz mega_kernel_rs_pa_13_0f
v_smfmac_f32_16x16x64_bf16 v[96:99], v[32:35], a[0:7], v6
v_smfmac_f32_16x16x64_bf16 v[100:103], v[32:35], a[32:39], v6
v_smfmac_f32_16x16x64_bf16 v[104:107], v[32:35], a[64:71], v6
v_smfmac_f32_16x16x64_bf16 v[108:111], v[32:35], a[96:103], v6
s_branch mega_kernel_rs_pa_12_2
mega_kernel_rs_pa_13_2f:
s_mov_b64 exec, vcc
buffer_load_dwordx4 v[40:43], v7, s[84:87], s33 offen offset:2048 sc1
s_mov_b64 exec, -1
s_branch mega_kernel_rs_pa_13_3
mega_kernel_rs_pa_13_2:
s_waitcnt vmcnt(2)
v_max_u32 v4, v40, v42
v_cmp_eq_u32 vcc, -1, v4
s_cbranch_vccnz mega_kernel_rs_pa_13_2f
v_smfmac_f32_16x16x64_bf16 v[96:99], v[40:43], a[16:23], v6
v_smfmac_f32_16x16x64_bf16 v[100:103], v[40:43], a[48:55], v6
v_smfmac_f32_16x16x64_bf16 v[104:107], v[40:43], a[80:87], v6
v_smfmac_f32_16x16x64_bf16 v[108:111], v[40:43], a[112:119], v6
s_branch mega_kernel_rs_pa_9_3
mega_kernel_rs_pa_13_3f:
s_mov_b64 exec, vcc
buffer_load_dwordx4 v[44:47], v7, s[84:87], s33 offen offset:3072 sc1
s_mov_b64 exec, -1
s_branch mega_kernel_rs_pa_13_0
mega_kernel_rs_pa_13_3:
s_waitcnt vmcnt(2)
v_max_u32 v4, v44, v46
v_cmp_eq_u32 vcc, -1, v4
s_cbranch_vccnz mega_kernel_rs_pa_13_3f
v_smfmac_f32_16x16x64_bf16 v[96:99], v[44:47], a[24:31], v6
v_smfmac_f32_16x16x64_bf16 v[100:103], v[44:47], a[56:63], v6
v_smfmac_f32_16x16x64_bf16 v[104:107], v[44:47], a[88:95], v6
v_smfmac_f32_16x16x64_bf16 v[108:111], v[44:47], a[120:127], v6
s_branch mega_kernel_rs_pa_5_0
mega_kernel_rs_pa_14_1f:
s_mov_b64 exec, vcc
buffer_load_dwordx4 v[36:39], v7, s[84:87], s33 offen offset:1024 sc1
s_mov_b64 exec, -1
s_branch mega_kernel_rs_pa_14_2
mega_kernel_rs_pa_14_1:
s_waitcnt vmcnt(2)
v_max_u32 v4, v36, v38
v_cmp_eq_u32 vcc, -1, v4
s_cbranch_vccnz mega_kernel_rs_pa_14_1f
v_smfmac_f32_16x16x64_bf16 v[96:99], v[36:39], a[8:15], v6
v_smfmac_f32_16x16x64_bf16 v[100:103], v[36:39], a[40:47], v6
v_smfmac_f32_16x16x64_bf16 v[104:107], v[36:39], a[72:79], v6
v_smfmac_f32_16x16x64_bf16 v[108:111], v[36:39], a[104:111], v6
s_branch mega_kernel_rs_pa_12_2
mega_kernel_rs_pa_14_2f:
s_mov_b64 exec, vcc
buffer_load_dwordx4 v[40:43], v7, s[84:87], s33 offen offset:2048 sc1
s_mov_b64 exec, -1
s_branch mega_kernel_rs_pa_14_3
mega_kernel_rs_pa_14_2:
s_waitcnt vmcnt(2)
v_max_u32 v4, v40, v42
v_cmp_eq_u32 vcc, -1, v4
s_cbranch_vccnz mega_kernel_rs_pa_14_2f
v_smfmac_f32_16x16x64_bf16 v[96:99], v[40:43], a[16:23], v6
v_smfmac_f32_16x16x64_bf16 v[100:103], v[40:43], a[48:55], v6
v_smfmac_f32_16x16x64_bf16 v[104:107], v[40:43], a[80:87], v6
v_smfmac_f32_16x16x64_bf16 v[108:111], v[40:43], a[112:119], v6
s_branch mega_kernel_rs_pa_10_3
mega_kernel_rs_pa_14_3f:
s_mov_b64 exec, vcc
buffer_load_dwordx4 v[44:47], v7, s[84:87], s33 offen offset:3072 sc1
s_mov_b64 exec, -1
s_branch mega_kernel_rs_pa_14_1
mega_kernel_rs_pa_14_3:
s_waitcnt vmcnt(2)
v_max_u32 v4, v44, v46
v_cmp_eq_u32 vcc, -1, v4
s_cbranch_vccnz mega_kernel_rs_pa_14_3f
v_smfmac_f32_16x16x64_bf16 v[96:99], v[44:47], a[24:31], v6
v_smfmac_f32_16x16x64_bf16 v[100:103], v[44:47], a[56:63], v6
v_smfmac_f32_16x16x64_bf16 v[104:107], v[44:47], a[88:95], v6
v_smfmac_f32_16x16x64_bf16 v[108:111], v[44:47], a[120:127], v6
s_branch mega_kernel_rs_pa_6_1
mega_kernel_rs_pa_15_0f:
s_mov_b64 exec, vcc
buffer_load_dwordx4 v[32:35], v7, s[84:87], s33 offen offset:0 sc1
s_mov_b64 exec, -1
s_branch mega_kernel_rs_pa_15_1
mega_kernel_rs_pa_15_0:
s_waitcnt vmcnt(3)
v_max_u32 v4, v32, v34
v_cmp_eq_u32 vcc, -1, v4
s_cbranch_vccnz mega_kernel_rs_pa_15_0f
v_smfmac_f32_16x16x64_bf16 v[96:99], v[32:35], a[0:7], v6
v_smfmac_f32_16x16x64_bf16 v[100:103], v[32:35], a[32:39], v6
v_smfmac_f32_16x16x64_bf16 v[104:107], v[32:35], a[64:71], v6
v_smfmac_f32_16x16x64_bf16 v[108:111], v[32:35], a[96:103], v6
s_branch mega_kernel_rs_pa_14_1
mega_kernel_rs_pa_15_1f:
s_mov_b64 exec, vcc
buffer_load_dwordx4 v[36:39], v7, s[84:87], s33 offen offset:1024 sc1
s_mov_b64 exec, -1
s_branch mega_kernel_rs_pa_15_2
mega_kernel_rs_pa_15_1:
s_waitcnt vmcnt(3)
v_max_u32 v4, v36, v38
v_cmp_eq_u32 vcc, -1, v4
s_cbranch_vccnz mega_kernel_rs_pa_15_1f
v_smfmac_f32_16x16x64_bf16 v[96:99], v[36:39], a[8:15], v6
v_smfmac_f32_16x16x64_bf16 v[100:103], v[36:39], a[40:47], v6
v_smfmac_f32_16x16x64_bf16 v[104:107], v[36:39], a[72:79], v6
v_smfmac_f32_16x16x64_bf16 v[108:111], v[36:39], a[104:111], v6
s_branch mega_kernel_rs_pa_13_2
mega_kernel_rs_pa_15_2f:
s_mov_b64 exec, vcc
buffer_load_dwordx4 v[40:43], v7, s[84:87], s33 offen offset:2048 sc1
s_mov_b64 exec, -1
s_branch mega_kernel_rs_pa_15_3
mega_kernel_rs_pa_15_2:
s_waitcnt vmcnt(3)
v_max_u32 v4, v40, v42
v_cmp_eq_u32 vcc, -1, v4
s_cbranch_vccnz mega_kernel_rs_pa_15_2f
v_smfmac_f32_16x16x64_bf16 v[96:99], v[40:43], a[16:23], v6
v_smfmac_f32_16x16x64_bf16 v[100:103], v[40:43], a[48:55], v6
v_smfmac_f32_16x16x64_bf16 v[104:107], v[40:43], a[80:87], v6
v_smfmac_f32_16x16x64_bf16 v[108:111], v[40:43], a[112:119], v6
s_branch mega_kernel_rs_pa_11_3
mega_kernel_rs_pa_15_3f:
s_mov_b64 exec, vcc
buffer_load_dwordx4 v[44:47], v7, s[84:87], s33 offen offset:3072 sc1
s_mov_b64 exec, -1
s_branch mega_kernel_rs_pa_15_0
mega_kernel_rs_pa_15_3:
s_waitcnt vmcnt(3)
v_max_u32 v4, v44, v46
v_cmp_eq_u32 vcc, -1, v4
s_cbranch_vccnz mega_kernel_rs_pa_15_3f
v_smfmac_f32_16x16x64_bf16 v[96:99], v[44:47], a[24:31], v6
v_smfmac_f32_16x16x64_bf16 v[100:103], v[44:47], a[56:63], v6
v_smfmac_f32_16x16x64_bf16 v[104:107], v[44:47], a[88:95], v6
v_smfmac_f32_16x16x64_bf16 v[108:111], v[44:47], a[120:127], v6
s_branch mega_kernel_rs_pa_7_0
mega_kernel_rs_pc_1_0f:
s_mov_b64 exec, vcc
buffer_load_dwordx4 v[32:35], v7, s[84:87], s29 offen offset:0 sc1
s_mov_b64 exec, -1
s_branch mega_kernel_rs_pc_1_0
mega_kernel_rs_pc_1_0:
s_waitcnt vmcnt(0)
v_cmp_eq_u32 vcc, -1, v32
s_cbranch_vccnz mega_kernel_rs_pc_1_0f
v_smfmac_f32_16x16x64_bf16 v[96:99], v[32:35], a[192:199], v6
v_smfmac_f32_16x16x64_bf16 v[100:103], v[32:35], a[224:231], v6
s_branch mega_kernel_rs_pc_d
mega_kernel_rs_pc_2_1f:
s_mov_b64 exec, vcc
buffer_load_dwordx4 v[36:39], v7, s[84:87], s29 offen offset:1024 sc1
s_mov_b64 exec, -1
s_branch mega_kernel_rs_pc_2_1
mega_kernel_rs_pc_2_1:
s_waitcnt vmcnt(0)
v_cmp_eq_u32 vcc, -1, v36
s_cbranch_vccnz mega_kernel_rs_pc_2_1f
v_smfmac_f32_16x16x64_bf16 v[96:99], v[36:39], a[200:207], v6
v_smfmac_f32_16x16x64_bf16 v[100:103], v[36:39], a[232:239], v6
s_branch mega_kernel_rs_pc_d
mega_kernel_rs_pc_3_0f:
s_mov_b64 exec, vcc
buffer_load_dwordx4 v[32:35], v7, s[84:87], s29 offen offset:0 sc1
s_mov_b64 exec, -1
s_branch mega_kernel_rs_pc_3_1
mega_kernel_rs_pc_3_0:
s_waitcnt vmcnt(1)
v_cmp_eq_u32 vcc, -1, v32
s_cbranch_vccnz mega_kernel_rs_pc_3_0f
v_smfmac_f32_16x16x64_bf16 v[96:99], v[32:35], a[192:199], v6
v_smfmac_f32_16x16x64_bf16 v[100:103], v[32:35], a[224:231], v6
s_branch mega_kernel_rs_pc_2_1
mega_kernel_rs_pc_3_1f:
s_mov_b64 exec, vcc
buffer_load_dwordx4 v[36:39], v7, s[84:87], s29 offen offset:1024 sc1
s_mov_b64 exec, -1
s_branch mega_kernel_rs_pc_3_0
mega_kernel_rs_pc_3_1:
s_waitcnt vmcnt(1)
v_cmp_eq_u32 vcc, -1, v36
s_cbranch_vccnz mega_kernel_rs_pc_3_1f
v_smfmac_f32_16x16x64_bf16 v[96:99], v[36:39], a[200:207], v6
v_smfmac_f32_16x16x64_bf16 v[100:103], v[36:39], a[232:239], v6
s_branch mega_kernel_rs_pc_1_0
mega_kernel_rs_pc_4_2f:
s_mov_b64 exec, vcc
buffer_load_dwordx4 v[40:43], v7, s[84:87], s29 offen offset:2048 sc1
s_mov_b64 exec, -1
s_branch mega_kernel_rs_pc_4_2
mega_kernel_rs_pc_4_2:
s_waitcnt vmcnt(0)
v_cmp_eq_u32 vcc, -1, v40
s_cbranch_vccnz mega_kernel_rs_pc_4_2f
v_smfmac_f32_16x16x64_bf16 v[96:99], v[40:43], a[208:215], v6
v_smfmac_f32_16x16x64_bf16 v[100:103], v[40:43], a[240:247], v6
s_branch mega_kernel_rs_pc_d
mega_kernel_rs_pc_5_0f:
s_mov_b64 exec, vcc
buffer_load_dwordx4 v[32:35], v7, s[84:87], s29 offen offset:0 sc1
s_mov_b64 exec, -1
s_branch mega_kernel_rs_pc_5_2
mega_kernel_rs_pc_5_0:
s_waitcnt vmcnt(1)
v_cmp_eq_u32 vcc, -1, v32
s_cbranch_vccnz mega_kernel_rs_pc_5_0f
v_smfmac_f32_16x16x64_bf16 v[96:99], v[32:35], a[192:199], v6
v_smfmac_f32_16x16x64_bf16 v[100:103], v[32:35], a[224:231], v6
s_branch mega_kernel_rs_pc_4_2
mega_kernel_rs_pc_5_2f:
s_mov_b64 exec, vcc
buffer_load_dwordx4 v[40:43], v7, s[84:87], s29 offen offset:2048 sc1
s_mov_b64 exec, -1
s_branch mega_kernel_rs_pc_5_0
mega_kernel_rs_pc_5_2:
s_waitcnt vmcnt(1)
v_cmp_eq_u32 vcc, -1, v40
s_cbranch_vccnz mega_kernel_rs_pc_5_2f
v_smfmac_f32_16x16x64_bf16 v[96:99], v[40:43], a[208:215], v6
v_smfmac_f32_16x16x64_bf16 v[100:103], v[40:43], a[240:247], v6
s_branch mega_kernel_rs_pc_1_0
mega_kernel_rs_pc_6_1f:
s_mov_b64 exec, vcc
buffer_load_dwordx4 v[36:39], v7, s[84:87], s29 offen offset:1024 sc1
s_mov_b64 exec, -1
s_branch mega_kernel_rs_pc_6_2
mega_kernel_rs_pc_6_1:
s_waitcnt vmcnt(1)
v_cmp_eq_u32 vcc, -1, v36
s_cbranch_vccnz mega_kernel_rs_pc_6_1f
v_smfmac_f32_16x16x64_bf16 v[96:99], v[36:39], a[200:207], v6
v_smfmac_f32_16x16x64_bf16 v[100:103], v[36:39], a[232:239], v6
s_branch mega_kernel_rs_pc_4_2
mega_kernel_rs_pc_6_2f:
s_mov_b64 exec, vcc
buffer_load_dwordx4 v[40:43], v7, s[84:87], s29 offen offset:2048 sc1
s_mov_b64 exec, -1
s_branch mega_kernel_rs_pc_6_1
mega_kernel_rs_pc_6_2:
s_waitcnt vmcnt(1)
v_cmp_eq_u32 vcc, -1, v40
s_cbranch_vccnz mega_kernel_rs_pc_6_2f
v_smfmac_f32_16x16x64_bf16 v[96:99], v[40:43], a[208:215], v6
v_smfmac_f32_16x16x64_bf16 v[100:103], v[40:43], a[240:247], v6
s_branch mega_kernel_rs_pc_2_1
mega_kernel_rs_pc_7_0f:
s_mov_b64 exec, vcc
buffer_load_dwordx4 v[32:35], v7, s[84:87], s29 offen offset:0 sc1
s_mov_b64 exec, -1
s_branch mega_kernel_rs_pc_7_1
mega_kernel_rs_pc_7_0:
s_waitcnt vmcnt(2)
v_cmp_eq_u32 vcc, -1, v32
s_cbranch_vccnz mega_kernel_rs_pc_7_0f
v_smfmac_f32_16x16x64_bf16 v[96:99], v[32:35], a[192:199], v6
v_smfmac_f32_16x16x64_bf16 v[100:103], v[32:35], a[224:231], v6
s_branch mega_kernel_rs_pc_6_1
mega_kernel_rs_pc_7_1f:
s_mov_b64 exec, vcc
buffer_load_dwordx4 v[36:39], v7, s[84:87], s29 offen offset:1024 sc1
s_mov_b64 exec, -1
s_branch mega_kernel_rs_pc_7_2
mega_kernel_rs_pc_7_1:
s_waitcnt vmcnt(2)
v_cmp_eq_u32 vcc, -1, v36
s_cbranch_vccnz mega_kernel_rs_pc_7_1f
v_smfmac_f32_16x16x64_bf16 v[96:99], v[36:39], a[200:207], v6
v_smfmac_f32_16x16x64_bf16 v[100:103], v[36:39], a[232:239], v6
s_branch mega_kernel_rs_pc_5_2
mega_kernel_rs_pc_7_2f:
s_mov_b64 exec, vcc
buffer_load_dwordx4 v[40:43], v7, s[84:87], s29 offen offset:2048 sc1
s_mov_b64 exec, -1
s_branch mega_kernel_rs_pc_7_0
mega_kernel_rs_pc_7_2:
s_waitcnt vmcnt(2)
v_cmp_eq_u32 vcc, -1, v40
s_cbranch_vccnz mega_kernel_rs_pc_7_2f
v_smfmac_f32_16x16x64_bf16 v[96:99], v[40:43], a[208:215], v6
v_smfmac_f32_16x16x64_bf16 v[100:103], v[40:43], a[240:247], v6
s_branch mega_kernel_rs_pc_3_0
mega_kernel_rs_pc_8_3f:
s_mov_b64 exec, vcc
buffer_load_dwordx4 v[44:47], v7, s[84:87], s29 offen offset:3072 sc1
s_mov_b64 exec, -1
s_branch mega_kernel_rs_pc_8_3
mega_kernel_rs_pc_9_0f:
s_mov_b64 exec, vcc
buffer_load_dwordx4 v[32:35], v7, s[84:87], s29 offen offset:0 sc1
s_mov_b64 exec, -1
s_branch mega_kernel_rs_pc_9_3
mega_kernel_rs_pc_9_0:
s_waitcnt vmcnt(1)
v_cmp_eq_u32 vcc, -1, v32
s_cbranch_vccnz mega_kernel_rs_pc_9_0f
v_smfmac_f32_16x16x64_bf16 v[96:99], v[32:35], a[192:199], v6
v_smfmac_f32_16x16x64_bf16 v[100:103], v[32:35], a[224:231], v6
s_branch mega_kernel_rs_pc_8_3
mega_kernel_rs_pc_9_3f:
s_mov_b64 exec, vcc
buffer_load_dwordx4 v[44:47], v7, s[84:87], s29 offen offset:3072 sc1
s_mov_b64 exec, -1
s_branch mega_kernel_rs_pc_9_0
mega_kernel_rs_pc_9_3:
s_waitcnt vmcnt(1)
v_cmp_eq_u32 vcc, -1, v44
s_cbranch_vccnz mega_kernel_rs_pc_9_3f
v_smfmac_f32_16x16x64_bf16 v[96:99], v[44:47], a[216:223], v6
v_smfmac_f32_16x16x64_bf16 v[100:103], v[44:47], a[248:255], v6
s_branch mega_kernel_rs_pc_1_0
mega_kernel_rs_pc_10_1f:
s_mov_b64 exec, vcc
buffer_load_dwordx4 v[36:39], v7, s[84:87], s29 offen offset:1024 sc1
s_mov_b64 exec, -1
s_branch mega_kernel_rs_pc_10_3
mega_kernel_rs_pc_10_1:
s_waitcnt vmcnt(1)
v_cmp_eq_u32 vcc, -1, v36
s_cbranch_vccnz mega_kernel_rs_pc_10_1f
v_smfmac_f32_16x16x64_bf16 v[96:99], v[36:39], a[200:207], v6
v_smfmac_f32_16x16x64_bf16 v[100:103], v[36:39], a[232:239], v6
s_branch mega_kernel_rs_pc_8_3
mega_kernel_rs_pc_10_3f:
s_mov_b64 exec, vcc
buffer_load_dwordx4 v[44:47], v7, s[84:87], s29 offen offset:3072 sc1
s_mov_b64 exec, -1
s_branch mega_kernel_rs_pc_10_1
mega_kernel_rs_pc_10_3:
s_waitcnt vmcnt(1)
v_cmp_eq_u32 vcc, -1, v44
s_cbranch_vccnz mega_kernel_rs_pc_10_3f
v_smfmac_f32_16x16x64_bf16 v[96:99], v[44:47], a[216:223], v6
v_smfmac_f32_16x16x64_bf16 v[100:103], v[44:47], a[248:255], v6
s_branch mega_kernel_rs_pc_2_1
mega_kernel_rs_pc_11_0f:
s_mov_b64 exec, vcc
buffer_load_dwordx4 v[32:35], v7, s[84:87], s29 offen offset:0 sc1
s_mov_b64 exec, -1
s_branch mega_kernel_rs_pc_11_1
mega_kernel_rs_pc_11_0:
s_waitcnt vmcnt(2)
v_cmp_eq_u32 vcc, -1, v32
s_cbranch_vccnz mega_kernel_rs_pc_11_0f
v_smfmac_f32_16x16x64_bf16 v[96:99], v[32:35], a[192:199], v6
v_smfmac_f32_16x16x64_bf16 v[100:103], v[32:35], a[224:231], v6
s_branch mega_kernel_rs_pc_10_1
mega_kernel_rs_pc_11_1f:
s_mov_b64 exec, vcc
buffer_load_dwordx4 v[36:39], v7, s[84:87], s29 offen offset:1024 sc1
s_mov_b64 exec, -1
s_branch mega_kernel_rs_pc_11_3
mega_kernel_rs_pc_11_1:
s_waitcnt vmcnt(2)
v_cmp_eq_u32 vcc, -1, v36
s_cbranch_vccnz mega_kernel_rs_pc_11_1f
v_smfmac_f32_16x16x64_bf16 v[96:99], v[36:39], a[200:207], v6
v_smfmac_f32_16x16x64_bf16 v[100:103], v[36:39], a[232:239], v6
s_branch mega_kernel_rs_pc_9_3
mega_kernel_rs_pc_11_3f:
s_mov_b64 exec, vcc
buffer_load_dwordx4 v[44:47], v7, s[84:87], s29 offen offset:3072 sc1
s_mov_b64 exec, -1
s_branch mega_kernel_rs_pc_11_0
mega_kernel_rs_pc_11_3:
s_waitcnt vmcnt(2)
v_cmp_eq_u32 vcc, -1, v44
s_cbranch_vccnz mega_kernel_rs_pc_11_3f
v_smfmac_f32_16x16x64_bf16 v[96:99], v[44:47], a[216:223], v6
v_smfmac_f32_16x16x64_bf16 v[100:103], v[44:47], a[248:255], v6
s_branch mega_kernel_rs_pc_3_0
mega_kernel_rs_pc_12_2f:
s_mov_b64 exec, vcc
buffer_load_dwordx4 v[40:43], v7, s[84:87], s29 offen offset:2048 sc1
s_mov_b64 exec, -1
s_branch mega_kernel_rs_pc_12_3
mega_kernel_rs_pc_12_3f:
s_mov_b64 exec, vcc
buffer_load_dwordx4 v[44:47], v7, s[84:87], s29 offen offset:3072 sc1
s_mov_b64 exec, -1
s_branch mega_kernel_rs_pc_12_2
mega_kernel_rs_pc_12_3:
s_waitcnt vmcnt(1)
v_cmp_eq_u32 vcc, -1, v44
s_cbranch_vccnz mega_kernel_rs_pc_12_3f
v_smfmac_f32_16x16x64_bf16 v[96:99], v[44:47], a[216:223], v6
v_smfmac_f32_16x16x64_bf16 v[100:103], v[44:47], a[248:255], v6
s_branch mega_kernel_rs_pc_4_2
mega_kernel_rs_pc_13_0f:
s_mov_b64 exec, vcc
buffer_load_dwordx4 v[32:35], v7, s[84:87], s29 offen offset:0 sc1
s_mov_b64 exec, -1
s_branch mega_kernel_rs_pc_13_2
mega_kernel_rs_pc_13_0:
s_waitcnt vmcnt(2)
v_cmp_eq_u32 vcc, -1, v32
s_cbranch_vccnz mega_kernel_rs_pc_13_0f
v_smfmac_f32_16x16x64_bf16 v[96:99], v[32:35], a[192:199], v6
v_smfmac_f32_16x16x64_bf16 v[100:103], v[32:35], a[224:231], v6
s_branch mega_kernel_rs_pc_12_2
mega_kernel_rs_pc_13_2f:
s_mov_b64 exec, vcc
buffer_load_dwordx4 v[40:43], v7, s[84:87], s29 offen offset:2048 sc1
s_mov_b64 exec, -1
s_branch mega_kernel_rs_pc_13_3
mega_kernel_rs_pc_13_2:
s_waitcnt vmcnt(2)
v_cmp_eq_u32 vcc, -1, v40
s_cbranch_vccnz mega_kernel_rs_pc_13_2f
v_smfmac_f32_16x16x64_bf16 v[96:99], v[40:43], a[208:215], v6
v_smfmac_f32_16x16x64_bf16 v[100:103], v[40:43], a[240:247], v6
s_branch mega_kernel_rs_pc_9_3
mega_kernel_rs_pc_13_3f:
s_mov_b64 exec, vcc
buffer_load_dwordx4 v[44:47], v7, s[84:87], s29 offen offset:3072 sc1
s_mov_b64 exec, -1
s_branch mega_kernel_rs_pc_13_0
mega_kernel_rs_pc_13_3:
s_waitcnt vmcnt(2)
v_cmp_eq_u32 vcc, -1, v44
s_cbranch_vccnz mega_kernel_rs_pc_13_3f
v_smfmac_f32_16x16x64_bf16 v[96:99], v[44:47], a[216:223], v6
v_smfmac_f32_16x16x64_bf16 v[100:103], v[44:47], a[248:255], v6
s_branch mega_kernel_rs_pc_5_0
mega_kernel_rs_pc_14_1f:
s_mov_b64 exec, vcc
buffer_load_dwordx4 v[36:39], v7, s[84:87], s29 offen offset:1024 sc1
s_mov_b64 exec, -1
s_branch mega_kernel_rs_pc_14_2
mega_kernel_rs_pc_14_2f:
s_mov_b64 exec, vcc
buffer_load_dwordx4 v[40:43], v7, s[84:87], s29 offen offset:2048 sc1
s_mov_b64 exec, -1
s_branch mega_kernel_rs_pc_14_3
mega_kernel_rs_pc_14_2:
s_waitcnt vmcnt(2)
v_cmp_eq_u32 vcc, -1, v40
s_cbranch_vccnz mega_kernel_rs_pc_14_2f
v_smfmac_f32_16x16x64_bf16 v[96:99], v[40:43], a[208:215], v6
v_smfmac_f32_16x16x64_bf16 v[100:103], v[40:43], a[240:247], v6
s_branch mega_kernel_rs_pc_10_3
mega_kernel_rs_pc_14_3f:
s_mov_b64 exec, vcc
buffer_load_dwordx4 v[44:47], v7, s[84:87], s29 offen offset:3072 sc1
s_mov_b64 exec, -1
s_branch mega_kernel_rs_pc_14_1
mega_kernel_rs_pc_14_3:
s_waitcnt vmcnt(2)
v_cmp_eq_u32 vcc, -1, v44
s_cbranch_vccnz mega_kernel_rs_pc_14_3f
v_smfmac_f32_16x16x64_bf16 v[96:99], v[44:47], a[216:223], v6
v_smfmac_f32_16x16x64_bf16 v[100:103], v[44:47], a[248:255], v6
s_branch mega_kernel_rs_pc_6_1
mega_kernel_rs_pc_15_0f:
s_mov_b64 exec, vcc
buffer_load_dwordx4 v[32:35], v7, s[84:87], s29 offen offset:0 sc1
s_mov_b64 exec, -1
s_branch mega_kernel_rs_pc_15_1
mega_kernel_rs_pc_15_1f:
s_mov_b64 exec, vcc
buffer_load_dwordx4 v[36:39], v7, s[84:87], s29 offen offset:1024 sc1
s_mov_b64 exec, -1
s_branch mega_kernel_rs_pc_15_2
mega_kernel_rs_pc_15_1:
s_waitcnt vmcnt(3)
v_cmp_eq_u32 vcc, -1, v36
s_cbranch_vccnz mega_kernel_rs_pc_15_1f
v_smfmac_f32_16x16x64_bf16 v[96:99], v[36:39], a[200:207], v6
v_smfmac_f32_16x16x64_bf16 v[100:103], v[36:39], a[232:239], v6
s_branch mega_kernel_rs_pc_13_2
mega_kernel_rs_pc_15_2f:
s_mov_b64 exec, vcc
buffer_load_dwordx4 v[40:43], v7, s[84:87], s29 offen offset:2048 sc1
s_mov_b64 exec, -1
s_branch mega_kernel_rs_pc_15_3
mega_kernel_rs_pc_15_2:
s_waitcnt vmcnt(3)
v_cmp_eq_u32 vcc, -1, v40
s_cbranch_vccnz mega_kernel_rs_pc_15_2f
v_smfmac_f32_16x16x64_bf16 v[96:99], v[40:43], a[208:215], v6
v_smfmac_f32_16x16x64_bf16 v[100:103], v[40:43], a[240:247], v6
s_branch mega_kernel_rs_pc_11_3
mega_kernel_rs_pc_15_3f:
s_mov_b64 exec, vcc
buffer_load_dwordx4 v[44:47], v7, s[84:87], s29 offen offset:3072 sc1
s_mov_b64 exec, -1
s_branch mega_kernel_rs_pc_15_0
mega_kernel_rs_pc_15_3:
s_waitcnt vmcnt(3)
v_cmp_eq_u32 vcc, -1, v44
s_cbranch_vccnz mega_kernel_rs_pc_15_3f
v_smfmac_f32_16x16x64_bf16 v[96:99], v[44:47], a[216:223], v6
v_smfmac_f32_16x16x64_bf16 v[100:103], v[44:47], a[248:255], v6
s_branch mega_kernel_rs_pc_7_0
mega_kernel_rs_w0last:
s_nop 7
v_permlane32_swap_b32 v112, v116
v_permlane32_swap_b32 v113, v117
v_permlane32_swap_b32 v114, v118
v_permlane32_swap_b32 v115, v119
v_pk_add_f32 v[112:113], v[112:113], v[116:117]
v_pk_add_f32 v[114:115], v[114:115], v[118:119]
ds_write_b128 v20, v[112:115]
s_waitcnt lgkmcnt(0)
s_barrier
s_branch mega_kernel_rs_end
mega_kernel_rs_side:
s_cmp_eq_u32 s24, 3
s_cbranch_scc1 mega_kernel_rs_sd3
s_cmp_eq_u32 s24, 2
s_cbranch_scc0 mega_kernel_rs_sd4
s_mov_b64 exec, s[40:41]
buffer_store_dwordx4 v[28:31], v11, s[84:87], s34 offen sc1
s_mov_b64 exec, -1
s_branch mega_kernel_rs_sd4
mega_kernel_rs_sd3:
s_add_u32 s76, s27, 1
s_cmp_lt_u32 s76, 63
s_cbranch_scc0 mega_kernel_rs_sd4
s_cmp_gt_i32 s46, s76
s_cbranch_scc1 mega_kernel_rs_pf2ok
mega_kernel_rs_pf2w:
buffer_load_dword v4, v24, s[84:87], 0 offen sc1
s_waitcnt vmcnt(0)
v_readlane_b32 s46, v4, 0
v_readlane_b32 s28, v4, 1
s_nop 1
s_min_i32 s46, s46, s28
s_cmp_gt_i32 s46, s76
s_cbranch_scc0 mega_kernel_rs_pf2w
mega_kernel_rs_pf2ok:
s_add_u32 s77, s76, s82
s_bfe_u32 s28, s77, 0x40002
s_lshl_b32 s28, s28, 14
s_and_b32 s77, s77, 3
s_lshl_b32 s77, s77, 11
s_add_u32 s28, s28, s77
s_add_u32 m0, s45, 0
s_nop 0
buffer_load_dwordx4 v240, s[84:87], s28 offen offset:0 sc1 lds
s_add_u32 m0, s45, 0
s_nop 0
buffer_load_dwordx4 v240, s[84:87], s28 offen offset:1024 sc1 lds
s_add_u32 m0, s45, 2048
s_nop 0
buffer_load_dwordx4 v241, s[84:87], s28 offen offset:0 sc1 lds
s_add_u32 m0, s45, 2048
s_nop 0
buffer_load_dwordx4 v241, s[84:87], s28 offen offset:1024 sc1 lds
s_add_u32 s45, s45, 4096
s_cmp_eq_u32 s45, 30720
s_cselect_b32 s45, 18432, s45
mega_kernel_rs_sd4:
v_smfmac_f32_16x16x64_bf16 v[112:115], v[40:43], a[144:151], v6
v_smfmac_f32_16x16x64_bf16 v[116:119], v[40:43], a[176:183], v6
v_smfmac_f32_16x16x64_bf16 v[112:115], v[44:47], a[152:159], v6
v_smfmac_f32_16x16x64_bf16 v[116:119], v[44:47], a[184:191], v6
s_nop 7
v_permlane32_swap_b32 v112, v116
v_permlane32_swap_b32 v113, v117
v_permlane32_swap_b32 v114, v118
v_permlane32_swap_b32 v115, v119
v_pk_add_f32 v[112:113], v[112:113], v[116:117]
v_pk_add_f32 v[114:115], v[114:115], v[118:119]
ds_write_b128 v20, v[112:115]
v_mov_b32 v96, 0
v_mov_b32 v97, 0
v_mov_b32 v98, 0
v_mov_b32 v99, 0
v_mov_b32 v100, 0
v_mov_b32 v101, 0
v_mov_b32 v102, 0
v_mov_b32 v103, 0
s_cmp_eq_u32 s24, 1
s_cbranch_scc0 mega_kernel_rs_s1
s_waitcnt lgkmcnt(0)
ds_read_b128 v[120:123], v16 offset:0
ds_read_b128 v[124:127], v16 offset:16
ds_read_b128 v[128:131], v16 offset:2304
ds_read_b128 v[132:135], v16 offset:2320
ds_read_b128 v[136:139], v16 offset:4608
ds_read_b128 v[140:143], v16 offset:4624
ds_read_b128 v[144:147], v16 offset:6912
ds_read_b128 v[148:151], v16 offset:6928
s_waitcnt lgkmcnt(4)
v_pk_add_f32 v[120:121], v[120:121], v[128:129]
v_pk_add_f32 v[122:123], v[122:123], v[130:131]
v_pk_add_f32 v[124:125], v[124:125], v[132:133]
v_pk_add_f32 v[126:127], v[126:127], v[134:135]
s_waitcnt lgkmcnt(0)
v_pk_add_f32 v[136:137], v[136:137], v[144:145]
v_pk_add_f32 v[138:139], v[138:139], v[146:147]
v_pk_add_f32 v[140:141], v[140:141], v[148:149]
v_pk_add_f32 v[142:143], v[142:143], v[150:151]
v_pk_add_f32 v[120:121], v[120:121], v[136:137]
v_pk_add_f32 v[122:123], v[122:123], v[138:139]
v_pk_add_f32 v[124:125], v[124:125], v[140:141]
v_pk_add_f32 v[126:127], v[126:127], v[142:143]
v_cvt_pk_bf16_f32 v244, v120, v121
v_cvt_pk_bf16_f32 v245, v122, v123
v_cvt_pk_bf16_f32 v246, v124, v125
v_cvt_pk_bf16_f32 v247, v126, v127
mega_kernel_rs_s1:
v_add_u32 v5, 9216, v17
s_waitcnt lgkmcnt(0)
s_barrier
s_cmp_eq_u32 s24, 2
s_cbranch_scc1 mega_kernel_rs_s2
s_cmp_eq_u32 s24, 3
s_cbranch_scc0 mega_kernel_rs_s3
s_add_u32 s76, s27, 2
s_cmp_lt_u32 s76, 63
s_cbranch_scc0 mega_kernel_rs_s3
s_cmp_gt_i32 s46, s76
s_cbranch_scc0 mega_kernel_rs_s3
s_add_u32 s77, s76, s82
s_bfe_u32 s28, s77, 0x40002
s_lshl_b32 s28, s28, 14
s_and_b32 s77, s77, 3
s_lshl_b32 s77, s77, 11
s_add_u32 s28, s28, s77
s_add_u32 s28, s28, s83
s_buffer_load_dword s78, s[84:87], s28 offset:0
s_buffer_load_dword s78, s[84:87], s28 offset:128
s_buffer_load_dword s78, s[84:87], s28 offset:256
s_buffer_load_dword s78, s[84:87], s28 offset:384
s_buffer_load_dword s78, s[84:87], s28 offset:512
s_buffer_load_dword s78, s[84:87], s28 offset:640
s_buffer_load_dword s78, s[84:87], s28 offset:768
s_buffer_load_dword s78, s[84:87], s28 offset:896
s_buffer_load_dword s78, s[84:87], s28 offset:1024
s_buffer_load_dword s78, s[84:87], s28 offset:1152
s_buffer_load_dword s78, s[84:87], s28 offset:1280
s_buffer_load_dword s78, s[84:87], s28 offset:1408
s_buffer_load_dword s78, s[84:87], s28 offset:1536
s_buffer_load_dword s78, s[84:87], s28 offset:1664
s_buffer_load_dword s78, s[84:87], s28 offset:1792
s_buffer_load_dword s78, s[84:87], s28 offset:1920
s_branch mega_kernel_rs_s3
mega_kernel_rs_s2:
ds_read_b128 v[120:123], v5 offset:0
ds_read_b128 v[124:127], v5 offset:1024
ds_read_b128 v[128:131], v5 offset:2048
ds_read_b128 v[132:135], v5 offset:3072
v_lshrrev_b32 v5, 1, v17
s_waitcnt lgkmcnt(2)
v_pk_add_f32 v[120:121], v[120:121], v[124:125]
v_pk_add_f32 v[122:123], v[122:123], v[126:127]
s_waitcnt lgkmcnt(0)
v_pk_add_f32 v[128:129], v[128:129], v[132:133]
v_pk_add_f32 v[130:131], v[130:131], v[134:135]
v_pk_add_f32 v[120:121], v[120:121], v[128:129]
v_pk_add_f32 v[122:123], v[122:123], v[130:131]
v_cvt_pk_bf16_f32 v244, v120, v121
v_cvt_pk_bf16_f32 v245, v122, v123
ds_write_b64 v5, v[244:245] offset:17920
s_waitcnt lgkmcnt(0)
mega_kernel_rs_s3:
s_cmp_eq_u32 s27, 63
s_cbranch_scc1 mega_kernel_rs_slast
s_add_u32 s29, s33, 16384
s_barrier
s_cmp_eq_u32 s24, 3
s_cbranch_scc1 mega_kernel_rs_y3
s_add_u32 s77, s27, s82
s_bfe_u32 s28, s77, 0x30003
s_lshl_b32 s28, s28, 14
s_and_b32 s77, s77, 7
s_lshl_b32 s77, s77, 10
s_add_u32 s28, s28, s77
s_add_u32 s28, s28, s79
s_cmp_eq_u32 s24, 2
s_cbranch_scc1 mega_kernel_rs_kv2a
s_mov_b64 exec, s[48:49]
buffer_store_dwordx4 v[244:247], v22, s[84:87], s28 offen sc1
s_mov_b64 exec, -1
s_branch mega_kernel_rs_kvda
mega_kernel_rs_kv2a:
v_lshlrev_b32 v4, 3, v1
buffer_store_dwordx2 v[244:245], v4, s[84:87], s28 offen offset:512 sc1
mega_kernel_rs_kvda:
s_branch mega_kernel_rs_y4
mega_kernel_rs_y3:
s_add_u32 s76, s27, 2
s_cmp_lt_u32 s76, 63
s_cbranch_scc0 mega_kernel_rs_y4
s_add_u32 s76, s27, 3
s_cmp_gt_i32 s46, s76
s_cbranch_scc1 mega_kernel_rs_pf4ok
mega_kernel_rs_pf4w:
buffer_load_dword v4, v24, s[84:87], 0 offen sc1
s_waitcnt vmcnt(0)
v_readlane_b32 s46, v4, 0
v_readlane_b32 s28, v4, 1
s_nop 1
s_min_i32 s46, s46, s28
s_cmp_gt_i32 s46, s76
s_cbranch_scc0 mega_kernel_rs_y4
mega_kernel_rs_pf4ok:
mega_kernel_rs_y4:
s_branch mega_kernel_rs_b3
mega_kernel_rs_first:
buffer_load_dwordx4 v[32:35], v8, s[20:23], 0 offen offset:0
buffer_load_dwordx4 v[36:39], v8, s[20:23], 0 offen offset:128
buffer_load_dwordx4 v[40:43], v8, s[20:23], 0 offen offset:256
buffer_load_dwordx4 v[44:47], v8, s[20:23], 0 offen offset:384
v_add_u32 v5, s44, v17
ds_read_b128 v[156:159], v5 offset:0
ds_read_b128 v[160:163], v5 offset:1024
ds_read_b128 v[164:167], v5 offset:2048
ds_read_b128 v[168:171], v5 offset:3072
s_waitcnt vmcnt(0)
v_smfmac_f32_16x16x64_bf16 v[96:99], v[32:35], a[0:7], v6
v_smfmac_f32_16x16x64_bf16 v[100:103], v[32:35], a[32:39], v6
v_smfmac_f32_16x16x64_bf16 v[104:107], v[32:35], a[64:71], v6
v_smfmac_f32_16x16x64_bf16 v[108:111], v[32:35], a[96:103], v6
v_smfmac_f32_16x16x64_bf16 v[96:99], v[36:39], a[8:15], v6
v_smfmac_f32_16x16x64_bf16 v[100:103], v[36:39], a[40:47], v6
v_smfmac_f32_16x16x64_bf16 v[104:107], v[36:39], a[72:79], v6
v_smfmac_f32_16x16x64_bf16 v[108:111], v[36:39], a[104:111], v6
v_smfmac_f32_16x16x64_bf16 v[96:99], v[40:43], a[16:23], v6
v_smfmac_f32_16x16x64_bf16 v[100:103], v[40:43], a[48:55], v6
v_smfmac_f32_16x16x64_bf16 v[104:107], v[40:43], a[80:87], v6
v_smfmac_f32_16x16x64_bf16 v[108:111], v[40:43], a[112:119], v6
v_smfmac_f32_16x16x64_bf16 v[96:99], v[44:47], a[24:31], v6
v_smfmac_f32_16x16x64_bf16 v[100:103], v[44:47], a[56:63], v6
v_smfmac_f32_16x16x64_bf16 v[104:107], v[44:47], a[88:95], v6
v_smfmac_f32_16x16x64_bf16 v[108:111], v[44:47], a[120:127], v6
s_nop 1
s_branch mega_kernel_rs_adone
mega_kernel_rs_slast:
s_cmp_eq_u32 s24, 3
s_cbranch_scc1 mega_kernel_rs_end
s_add_u32 s77, s27, s82
s_bfe_u32 s28, s77, 0x30003
s_lshl_b32 s28, s28, 14
s_and_b32 s77, s77, 7
s_lshl_b32 s77, s77, 10
s_add_u32 s28, s28, s77
s_add_u32 s28, s28, s79
s_cmp_eq_u32 s24, 2
s_cbranch_scc1 mega_kernel_rs_kv2b
s_mov_b64 exec, s[48:49]
buffer_store_dwordx4 v[244:247], v22, s[84:87], s28 offen sc1
s_mov_b64 exec, -1
s_branch mega_kernel_rs_kvdb
mega_kernel_rs_kv2b:
v_lshlrev_b32 v4, 3, v1
buffer_store_dwordx2 v[244:245], v4, s[84:87], s28 offen offset:512 sc1
mega_kernel_rs_kvdb:
s_waitcnt vmcnt(0)
s_barrier
s_mov_b32 s76, 64
s_cmp_eq_u32 s24, 1
s_cbranch_scc0 mega_kernel_rs_end
v_mov_b32 v5, s76
s_mov_b64 exec, 1
buffer_store_dword v5, v228, s[84:87], s81 offen sc1
s_mov_b64 exec, -1
mega_kernel_rs_end:
s_endpgm
.section .rodata,"a"
.p2align 6
.amdhsa_kernel mega_kernel
  .amdhsa_next_free_vgpr 512
  .amdhsa_next_free_sgpr 102
  .amdhsa_accum_offset 256
  .amdhsa_group_segment_fixed_size 0
  .amdhsa_kernarg_size 104
  .amdhsa_user_sgpr_count 2
  .amdhsa_user_sgpr_kernarg_segment_ptr 1
  .amdhsa_system_sgpr_workgroup_id_x 1
.end_amdhsa_kernel
```

```asm
; @launch kernel=mega_kernel grid=(256,1,1) block=(256,1,1) lds=163840
.amdgcn_target "amdgcn-amd-amdhsa--gfx950"
.text
.globl mega_kernel
.p2align 8
.type mega_kernel,@function
mega_kernel:
s_cmp_ge_u32 s2, 256
s_cbranch_scc1 mega_kernel_exit
s_load_dwordx2 s[84:85], s[0:1], 96
s_load_dwordx2 s[72:73], s[0:1], 88
s_getreg_b32 s90, hwreg(HW_REG_XCC_ID)
s_and_b32 s90, s90, 7
v_mov_b32 v1, 0
v_mov_b32 v2, 1
s_lshl_b32 s91, s90, 4
s_mov_b32 s95, 0
s_mov_b32 s99, 0
s_waitcnt lgkmcnt(0)
s_mov_b32 s86, 268435456
s_mov_b32 s87, 0x00020000
s_mov_b32 s74, 256
s_mov_b32 s75, 0x00020000
v_cmp_eq_u32 vcc, 0, v0
s_and_saveexec_b64 s[88:89], vcc
s_cbranch_execz mega_kernel_tkd
s_lshl_b32 s92, s2, 13
s_add_u32 s92, s92, 167772160
buffer_atomic_add v2, v1, s[72:75], s91 offen sc0
buffer_load_dword v251, v1, s[84:87], s92 offen offset:2048 sc1
s_waitcnt vmcnt(1)
ds_write_b32 v1, v2
s_waitcnt lgkmcnt(0)
mega_kernel_tkd:
s_mov_b64 exec, s[88:89]
s_barrier
ds_read_b32 v2, v1
s_waitcnt lgkmcnt(0)
v_readfirstlane_b32 s96, v2
s_barrier
s_cmp_lt_u32 s96, 32
s_cbranch_scc1 mega_kernel_spec
v_and_b32 v3, 15, v0
v_lshlrev_b32 v3, 4, v3
s_branch mega_kernel_syx
mega_kernel_syxw:
s_sleep 4
mega_kernel_syx:
buffer_load_dword v2, v3, s[72:75], 0 offen sc1
s_waitcnt vmcnt(0)
s_cmp_eq_u32 s95, 1
s_cbranch_scc0 mega_kernel_syxf
v_readlane_b32 s76, v2, 14
s_mov_b32 s98, 0
s_cmp_eq_u32 s76, 64
s_cbranch_scc0 mega_kernel_syxw
s_branch mega_kernel_syxd
mega_kernel_syxf:
s_mov_b32 s77, 0
s_mov_b32 s78, 0
v_readlane_b32 s76, v2, 0
s_add_u32 s77, s77, s76
s_xor_b32 s76, s76, 32
s_or_b32 s78, s78, s76
v_readlane_b32 s76, v2, 1
s_add_u32 s77, s77, s76
s_xor_b32 s76, s76, 32
s_or_b32 s78, s78, s76
v_readlane_b32 s76, v2, 2
s_add_u32 s77, s77, s76
s_xor_b32 s76, s76, 32
s_or_b32 s78, s78, s76
v_readlane_b32 s76, v2, 3
s_add_u32 s77, s77, s76
s_xor_b32 s76, s76, 32
s_or_b32 s78, s78, s76
v_readlane_b32 s76, v2, 4
s_add_u32 s77, s77, s76
s_xor_b32 s76, s76, 32
s_or_b32 s78, s78, s76
v_readlane_b32 s76, v2, 5
s_add_u32 s77, s77, s76
s_xor_b32 s76, s76, 32
s_or_b32 s78, s78, s76
v_readlane_b32 s76, v2, 6
s_add_u32 s77, s77, s76
s_xor_b32 s76, s76, 32
s_or_b32 s78, s78, s76
v_readlane_b32 s76, v2, 7
s_add_u32 s77, s77, s76
s_xor_b32 s76, s76, 32
s_or_b32 s78, s78, s76
s_cmp_eq_u32 s77, 256
s_cbranch_scc0 mega_kernel_syxw
v_mov_b32 v252, v2
s_cmp_eq_u32 s78, 0
s_cbranch_scc0 mega_kernel_slowent
v_readlane_b32 s76, v2, 10
v_readlane_b32 s77, v2, 8
s_cmp_eq_u32 s76, 64
s_cbranch_scc0 mega_kernel_syxw
s_cmp_gt_u32 s77, 32
s_cselect_b32 s98, 1, 0
mega_kernel_syxd:
mega_kernel_slowent:
s_mov_b64 exec, -1
s_waitcnt vmcnt(0) lgkmcnt(0)
s_barrier
s_mov_b32 s97, s96
v_readlane_b32 s76, v252, 0
s_cmp_gt_u32 s90, 0
s_cselect_b32 s76, s76, 0
s_add_u32 s97, s97, s76
v_readlane_b32 s76, v252, 1
s_cmp_gt_u32 s90, 1
s_cselect_b32 s76, s76, 0
s_add_u32 s97, s97, s76
v_readlane_b32 s76, v252, 2
s_cmp_gt_u32 s90, 2
s_cselect_b32 s76, s76, 0
s_add_u32 s97, s97, s76
v_readlane_b32 s76, v252, 3
s_cmp_gt_u32 s90, 3
s_cselect_b32 s76, s76, 0
s_add_u32 s97, s97, s76
v_readlane_b32 s76, v252, 4
s_cmp_gt_u32 s90, 4
s_cselect_b32 s76, s76, 0
s_add_u32 s97, s97, s76
v_readlane_b32 s76, v252, 5
s_cmp_gt_u32 s90, 5
s_cselect_b32 s76, s76, 0
s_add_u32 s97, s97, s76
v_readlane_b32 s76, v252, 6
s_cmp_gt_u32 s90, 6
s_cselect_b32 s76, s76, 0
s_add_u32 s97, s97, s76
v_mov_b32 v1, 0
v_mov_b32 v2, 1
v_cmp_eq_u32 vcc, 0, v0
s_and_saveexec_b64 s[88:89], vcc
s_cbranch_execz mega_kernel_sb1
buffer_atomic_add v2, v1, s[72:75], 0 offen offset:192 sc1
mega_kernel_sb1:
s_mov_b64 exec, s[88:89]
mega_kernel_sb2:
s_sleep 4
buffer_load_dword v2, v1, s[72:75], 0 offen offset:192 sc1
s_waitcnt vmcnt(0)
v_cmp_ne_u32 vcc, 256, v2
s_cbranch_vccnz mega_kernel_sb2
s_mov_b32 s95, 1
s_lshr_b32 s30, s97, 5
s_and_b32 s31, s97, 31
s_cmp_lt_u32 s97, 128
s_cbranch_scc1 mega_kernel_recs
s_sub_u32 s94, s97, 128
s_branch mega_kernel_bulk
mega_kernel_spec:
s_mov_b32 s30, s90
s_mov_b32 s31, s96
s_cmp_lt_u32 s90, 4
s_cbranch_scc1 mega_kernel_recf
s_sub_u32 s94, s90, 4
s_lshl_b32 s94, s94, 5
s_add_u32 s94, s94, s96
mega_kernel_bulk:
s_lshr_b32 s91, s94, 5
s_and_b32 s40, s94, 31
s_and_b32 s92, s91, 1
s_lshl_b32 s92, s92, 5
s_add_u32 s92, s92, s40
s_cmp_eq_u32 s91, 0
s_cbranch_scc1 mega_kernel_rk
s_cmp_eq_u32 s91, 1
s_cbranch_scc1 mega_kernel_rv
v_mov_b32 v8, -1
v_mov_b32 v9, -1
v_mov_b32 v10, -1
v_mov_b32 v11, -1
v_lshlrev_b32 v1, 4, v0
v_mov_b32 v2, 0
v_cmp_gt_u32 vcc, 64, v0
s_cbranch_vccz mega_kernel_nv
s_cmp_eq_u32 s95, 0
s_cbranch_scc0 mega_kernel_nv
s_lshr_b32 s60, s2, 1
s_lshl_b32 s60, s60, 14
s_and_b32 s61, s92, 1
s_lshl_b32 s66, s61, 13
s_add_u32 s60, s60, s66
s_and_b32 s66, s2, 1
s_lshl_b32 s66, s66, 10
s_add_u32 s60, s60, s66
s_add_u32 s60, s60, 167772160
s_mov_b32 s66, 0x7fffffff
s_mov_b32 s67, 0x7fffffff
s_mov_b64 exec, 0xff
s_waitcnt vmcnt(0)
s_memtime s[62:63]
s_waitcnt lgkmcnt(0)
buffer_store_dwordx4 v[8:11], v1, s[84:87], s60 offen offset:0 sc1
s_waitcnt vmcnt(0)
s_memtime s[64:65]
s_xor_b32 s60, s60, 8192
s_waitcnt lgkmcnt(0)
s_sub_u32 s64, s64, s62
s_min_u32 s66, s66, s64
s_memtime s[62:63]
s_waitcnt lgkmcnt(0)
buffer_store_dwordx4 v[8:11], v1, s[84:87], s60 offen offset:0 sc1
s_waitcnt vmcnt(0)
s_memtime s[64:65]
s_xor_b32 s60, s60, 8192
s_waitcnt lgkmcnt(0)
s_sub_u32 s64, s64, s62
s_min_u32 s67, s67, s64
s_memtime s[62:63]
s_waitcnt lgkmcnt(0)
buffer_store_dwordx4 v[8:11], v1, s[84:87], s60 offen offset:256 sc1
s_waitcnt vmcnt(0)
s_memtime s[64:65]
s_xor_b32 s60, s60, 8192
s_waitcnt lgkmcnt(0)
s_sub_u32 s64, s64, s62
s_min_u32 s66, s66, s64
s_memtime s[62:63]
s_waitcnt lgkmcnt(0)
buffer_store_dwordx4 v[8:11], v1, s[84:87], s60 offen offset:256 sc1
s_waitcnt vmcnt(0)
s_memtime s[64:65]
s_xor_b32 s60, s60, 8192
s_waitcnt lgkmcnt(0)
s_sub_u32 s64, s64, s62
s_min_u32 s67, s67, s64
s_cmp_lt_u32 s67, s66
s_cselect_b32 s60, 1, 0
s_xor_b32 s60, s60, s61
s_lshr_b32 s61, s90, 2
s_xor_b32 s60, s60, s61
v_mov_b32 v3, s60
s_mov_b64 exec, 1
buffer_atomic_add v3, v2, s[72:75], 0 offen offset:128 sc1
s_mov_b64 exec, -1
mega_kernel_nv:
s_barrier
s_lshl_b32 s60, s92, 12
s_add_u32 s60, s60, 67108864
buffer_store_dwordx4 v[8:11], v1, s[84:87], s60 offen sc1
s_add_u32 s60, s60, 262144
buffer_store_dwordx4 v[8:11], v1, s[84:87], s60 offen sc1
s_add_u32 s60, s60, 262144
buffer_store_dwordx4 v[8:11], v1, s[84:87], s60 offen sc1
s_add_u32 s60, s60, 262144
buffer_store_dwordx4 v[8:11], v1, s[84:87], s60 offen sc1
s_add_u32 s60, s60, 262144
buffer_store_dwordx4 v[8:11], v1, s[84:87], s60 offen sc1
s_add_u32 s60, s60, 262144
buffer_store_dwordx4 v[8:11], v1, s[84:87], s60 offen sc1
s_add_u32 s60, s60, 262144
buffer_store_dwordx4 v[8:11], v1, s[84:87], s60 offen sc1
s_add_u32 s60, s60, 262144
buffer_store_dwordx4 v[8:11], v1, s[84:87], s60 offen sc1
s_add_u32 s60, s60, 262144
s_lshr_b32 s62, s92, 1
s_and_b32 s63, s92, 1
s_add_u32 s63, s63, s62
s_lshl_b32 s62, s62, 19
s_and_b32 s64, s63, 14
s_lshl_b32 s64, s64, 13
s_add_u32 s62, s62, s64
s_and_b32 s64, s63, 1
s_lshl_b32 s64, s64, 12
s_add_u32 s62, s62, s64
s_add_u32 s62, s62, 150994944
s_add_u32 s62, s62, 8192
s_cmp_lt_u32 s92, 16
s_cbranch_scc0 mega_kernel_pz
buffer_store_dwordx4 v[8:11], v1, s[84:87], s60 offen sc1
mega_kernel_pz:
s_waitcnt vmcnt(0)
s_barrier
v_mov_b32 v3, 1
s_lshl_b32 s62, s95, 6
v_cmp_eq_u32 vcc, 0, v0
s_and_saveexec_b64 s[60:61], vcc
s_cbranch_execz mega_kernel_xps
buffer_atomic_add v3, v2, s[72:75], s62 offen offset:160 sc1
mega_kernel_xps:
s_mov_b64 exec, s[60:61]
s_cmp_eq_u32 s91, 2
s_cbranch_scc0 mega_kernel_rd
v_and_b32 v3, 15, v0
v_lshlrev_b32 v3, 4, v3
s_branch mega_kernel_syc
mega_kernel_sycw:
s_sleep 4
mega_kernel_syc:
buffer_load_dword v2, v3, s[72:75], 0 offen sc1
s_waitcnt vmcnt(0)
s_cmp_eq_u32 s95, 1
s_cbranch_scc0 mega_kernel_sycf
v_readlane_b32 s76, v2, 14
s_mov_b32 s98, 0
s_cmp_eq_u32 s76, 64
s_cbranch_scc0 mega_kernel_sycw
s_branch mega_kernel_sycd
mega_kernel_sycf:
s_mov_b32 s77, 0
s_mov_b32 s78, 0
v_readlane_b32 s76, v2, 0
s_add_u32 s77, s77, s76
s_xor_b32 s76, s76, 32
s_or_b32 s78, s78, s76
v_readlane_b32 s76, v2, 1
s_add_u32 s77, s77, s76
s_xor_b32 s76, s76, 32
s_or_b32 s78, s78, s76
v_readlane_b32 s76, v2, 2
s_add_u32 s77, s77, s76
s_xor_b32 s76, s76, 32
s_or_b32 s78, s78, s76
v_readlane_b32 s76, v2, 3
s_add_u32 s77, s77, s76
s_xor_b32 s76, s76, 32
s_or_b32 s78, s78, s76
v_readlane_b32 s76, v2, 4
s_add_u32 s77, s77, s76
s_xor_b32 s76, s76, 32
s_or_b32 s78, s78, s76
v_readlane_b32 s76, v2, 5
s_add_u32 s77, s77, s76
s_xor_b32 s76, s76, 32
s_or_b32 s78, s78, s76
v_readlane_b32 s76, v2, 6
s_add_u32 s77, s77, s76
s_xor_b32 s76, s76, 32
s_or_b32 s78, s78, s76
v_readlane_b32 s76, v2, 7
s_add_u32 s77, s77, s76
s_xor_b32 s76, s76, 32
s_or_b32 s78, s78, s76
s_cmp_eq_u32 s77, 256
s_cbranch_scc0 mega_kernel_sycw
v_mov_b32 v252, v2
s_cmp_eq_u32 s78, 0
s_cbranch_scc0 mega_kernel_slowent
v_readlane_b32 s76, v2, 10
v_readlane_b32 s77, v2, 8
s_cmp_eq_u32 s76, 64
s_cbranch_scc0 mega_kernel_sycw
s_cmp_gt_u32 s77, 32
s_cselect_b32 s98, 1, 0
mega_kernel_sycd:
s_load_dwordx2 s[4:5], s[0:1], 16
s_load_dwordx2 s[8:9], s[0:1], 0
v_lshrrev_b32 v2, 6, v0
v_and_b32 v1, 63, v0
v_readfirstlane_b32 s41, v2
v_lshlrev_b32 v5, 4, v1
s_waitcnt lgkmcnt(0)
s_mov_b32 s6, 8388608
s_mov_b32 s7, 0x00020000
s_mov_b32 s10, 4194304
s_mov_b32 s11, 0x00020000
s_lshl_b32 s43, s40, 8
s_lshl_b32 s44, s41, 6
s_add_u32 s48, s43, s44
s_and_b32 s43, s48, 0x7ff
v_add_u32 v19, s43, v1
v_lshlrev_b32 v19, 7, v19
buffer_load_dword v250, v19, s[8:11], 0 offen
s_nop 0
v_lshrrev_b32 v2, 3, v1
s_lshl_b32 s43, s41, 3
v_add_u32 v2, s43, v2
v_bfe_u32 v3, v2, 1, 3
v_and_b32 v4, 7, v1
v_xor_b32 v3, v3, v4
v_lshlrev_b32 v6, 11, v2
v_lshl_add_u32 v6, v3, 4, v6
s_lshl_b32 s46, s41, 10
v_and_b32 v2, 15, v1
v_bfe_u32 v3, v2, 1, 3
v_lshrrev_b32 v4, 4, v1
v_xor_b32 v3, v3, v4
v_lshlrev_b32 v8, 7, v2
v_lshl_add_u32 v8, v3, 4, v8
v_xor_b32 v9, 64, v8
v_add_u32 v10, 0x10000, v8
v_add_u32 v11, 0x10000, v9
v_mov_b32 v7, v5
s_lshl_b32 s47, s40, 2
s_add_u32 s47, s47, s41
s_mov_b32 s42, 0
s_mov_b32 s50, 0
s_add_u32 m0, s46, 0
s_nop 0
buffer_load_dwordx4 v6, s[8:11], s50 offen offset:0 lds
s_add_u32 m0, s46, 3968
s_nop 0
buffer_load_dwordx4 v6, s[8:11], s50 offen offset:128 lds
s_add_u32 m0, s46, 7936
s_nop 0
buffer_load_dwordx4 v6, s[8:11], s50 offen offset:256 lds
s_add_u32 m0, s46, 11904
s_nop 0
buffer_load_dwordx4 v6, s[8:11], s50 offen offset:384 lds
s_add_u32 m0, s46, 15872
s_nop 0
buffer_load_dwordx4 v6, s[8:11], s50 offen offset:512 lds
s_add_u32 m0, s46, 19840
s_nop 0
buffer_load_dwordx4 v6, s[8:11], s50 offen offset:640 lds
s_add_u32 m0, s46, 23808
s_nop 0
buffer_load_dwordx4 v6, s[8:11], s50 offen offset:768 lds
s_add_u32 m0, s46, 27776
s_nop 0
buffer_load_dwordx4 v6, s[8:11], s50 offen offset:896 lds
s_add_u32 m0, s46, 31744
s_nop 0
buffer_load_dwordx4 v6, s[8:11], s50 offen offset:1024 lds
s_add_u32 m0, s46, 35712
s_nop 0
buffer_load_dwordx4 v6, s[8:11], s50 offen offset:1152 lds
s_add_u32 m0, s46, 39680
s_nop 0
buffer_load_dwordx4 v6, s[8:11], s50 offen offset:1280 lds
s_add_u32 m0, s46, 43648
s_nop 0
buffer_load_dwordx4 v6, s[8:11], s50 offen offset:1408 lds
s_add_u32 m0, s46, 47616
s_nop 0
buffer_load_dwordx4 v6, s[8:11], s50 offen offset:1536 lds
s_add_u32 m0, s46, 51584
s_nop 0
buffer_load_dwordx4 v6, s[8:11], s50 offen offset:1664 lds
s_add_u32 m0, s46, 55552
s_nop 0
buffer_load_dwordx4 v6, s[8:11], s50 offen offset:1792 lds
s_add_u32 m0, s46, 59520
s_nop 0
buffer_load_dwordx4 v6, s[8:11], s50 offen offset:1920 lds
v_lshrrev_b32 v2, 2, v1
v_and_b32 v3, 3, v1
v_lshlrev_b32 v16, 13, v2
v_lshl_add_u32 v16, v3, 4, v16
v_add_u32 v16, s48, v16
s_mul_i32 s45, s41, 24576
s_add_u32 s45, s45, 65536
v_bfe_u32 v17, v1, 2, 2
v_lshrrev_b32 v18, 4, v1
v_lshl_add_u32 v17, v18, 3, v17
v_lshlrev_b32 v17, 6, v17
v_lshl_add_u32 v17, v3, 4, v17
v_add_u32 v17, s45, v17
s_and_b32 s43, s40, 3
s_lshl_b32 s43, s43, 2
s_add_u32 s43, s43, s41
s_lshl_b32 s43, s43, 3
v_and_b32 v12, 7, v1
v_add_u32 v12, s43, v12
s_lshr_b32 s43, s40, 2
s_lshl_b32 s43, s43, 10
s_add_u32 s44, s43, 896
s_add_u32 s43, s43, 384
s_cmp_ge_u32 s40, 28
s_cselect_b32 s44, s44, s43
v_mov_b32 v13, s43
v_mov_b32 v14, s44
v_cmp_gt_u32 vcc, 32, v1
s_nop 1
v_cndmask_b32 v13, v14, v13, vcc
v_lshl_add_u32 v12, v12, 13, v13
s_mov_b32 s44, 0
buffer_load_dword v250, v12, s[4:7], s44 offen
s_add_u32 m0, s45, 0
s_mov_b32 s44, 0
buffer_load_dwordx4 v16, s[4:7], s44 offen lds
s_add_u32 m0, s45, 1024
s_mov_b32 s44, 131072
buffer_load_dwordx4 v16, s[4:7], s44 offen lds
s_add_u32 m0, s45, 2048
s_mov_b32 s44, 262144
buffer_load_dwordx4 v16, s[4:7], s44 offen lds
s_add_u32 m0, s45, 3072
s_mov_b32 s44, 393216
buffer_load_dwordx4 v16, s[4:7], s44 offen lds
s_add_u32 m0, s45, 4096
s_mov_b32 s44, 524288
buffer_load_dwordx4 v16, s[4:7], s44 offen lds
s_add_u32 m0, s45, 5120
s_mov_b32 s44, 655360
buffer_load_dwordx4 v16, s[4:7], s44 offen lds
s_add_u32 m0, s45, 6144
s_mov_b32 s44, 786432
buffer_load_dwordx4 v16, s[4:7], s44 offen lds
s_add_u32 m0, s45, 7168
s_mov_b32 s44, 917504
buffer_load_dwordx4 v16, s[4:7], s44 offen lds
s_mov_b32 s44, 1048576
buffer_load_dword v250, v12, s[4:7], s44 offen
s_add_u32 m0, s45, 8192
s_mov_b32 s44, 1048576
buffer_load_dwordx4 v16, s[4:7], s44 offen lds
s_add_u32 m0, s45, 9216
s_mov_b32 s44, 1179648
buffer_load_dwordx4 v16, s[4:7], s44 offen lds
s_add_u32 m0, s45, 10240
s_mov_b32 s44, 1310720
buffer_load_dwordx4 v16, s[4:7], s44 offen lds
s_add_u32 m0, s45, 11264
s_mov_b32 s44, 1441792
buffer_load_dwordx4 v16, s[4:7], s44 offen lds
s_add_u32 m0, s45, 12288
s_mov_b32 s44, 1572864
buffer_load_dwordx4 v16, s[4:7], s44 offen lds
s_add_u32 m0, s45, 13312
s_mov_b32 s44, 1703936
buffer_load_dwordx4 v16, s[4:7], s44 offen lds
s_add_u32 m0, s45, 14336
s_mov_b32 s44, 1835008
buffer_load_dwordx4 v16, s[4:7], s44 offen lds
s_add_u32 m0, s45, 15360
s_mov_b32 s44, 1966080
buffer_load_dwordx4 v16, s[4:7], s44 offen lds
s_mov_b32 s44, 2097152
buffer_load_dword v250, v12, s[4:7], s44 offen
s_add_u32 m0, s45, 16384
s_mov_b32 s44, 2097152
buffer_load_dwordx4 v16, s[4:7], s44 offen lds
s_add_u32 m0, s45, 17408
s_mov_b32 s44, 2228224
buffer_load_dwordx4 v16, s[4:7], s44 offen lds
s_add_u32 m0, s45, 18432
s_mov_b32 s44, 2359296
buffer_load_dwordx4 v16, s[4:7], s44 offen lds
s_add_u32 m0, s45, 19456
s_mov_b32 s44, 2490368
buffer_load_dwordx4 v16, s[4:7], s44 offen lds
s_add_u32 m0, s45, 20480
s_mov_b32 s44, 2621440
buffer_load_dwordx4 v16, s[4:7], s44 offen lds
s_add_u32 m0, s45, 21504
s_mov_b32 s44, 2752512
buffer_load_dwordx4 v16, s[4:7], s44 offen lds
s_add_u32 m0, s45, 22528
s_mov_b32 s44, 2883584
buffer_load_dwordx4 v16, s[4:7], s44 offen lds
s_add_u32 m0, s45, 23552
s_mov_b32 s44, 3014656
buffer_load_dwordx4 v16, s[4:7], s44 offen lds
s_waitcnt vmcnt(18)
s_barrier
ds_read_b64_tr_b16 a[0:1], v17 offset:0
ds_read_b64_tr_b16 a[2:3], v17 offset:256
ds_read_b64_tr_b16 a[4:5], v17 offset:8
ds_read_b64_tr_b16 a[6:7], v17 offset:264
ds_read_b64_tr_b16 a[8:9], v17 offset:2048
ds_read_b64_tr_b16 a[10:11], v17 offset:2304
ds_read_b64_tr_b16 a[12:13], v17 offset:2056
ds_read_b64_tr_b16 a[14:15], v17 offset:2312
s_waitcnt lgkmcnt(0)
ds_read_b64_tr_b16 a[16:17], v17 offset:4096
ds_read_b64_tr_b16 a[18:19], v17 offset:4352
ds_read_b64_tr_b16 a[20:21], v17 offset:4104
ds_read_b64_tr_b16 a[22:23], v17 offset:4360
ds_read_b64_tr_b16 a[24:25], v17 offset:6144
ds_read_b64_tr_b16 a[26:27], v17 offset:6400
ds_read_b64_tr_b16 a[28:29], v17 offset:6152
ds_read_b64_tr_b16 a[30:31], v17 offset:6408
s_waitcnt lgkmcnt(0)
ds_read_b128 v[20:23], v8 offset:0
ds_read_b128 v[24:27], v8 offset:2048
ds_read_b128 v[28:31], v9 offset:0
ds_read_b128 v[32:35], v9 offset:2048
ds_read_b128 v[36:39], v8 offset:4096
ds_read_b128 v[40:43], v8 offset:6144
ds_read_b128 v[44:47], v9 offset:4096
ds_read_b128 v[48:51], v9 offset:6144
s_mov_b32 s44, 3145728
buffer_load_dword v250, v12, s[4:7], s44 offen
s_add_u32 m0, s45, 0
s_mov_b32 s44, 3145728
buffer_load_dwordx4 v16, s[4:7], s44 offen lds
s_add_u32 m0, s45, 1024
s_mov_b32 s44, 3276800
buffer_load_dwordx4 v16, s[4:7], s44 offen lds
s_add_u32 m0, s45, 2048
s_mov_b32 s44, 3407872
buffer_load_dwordx4 v16, s[4:7], s44 offen lds
s_add_u32 m0, s45, 3072
s_mov_b32 s44, 3538944
buffer_load_dwordx4 v16, s[4:7], s44 offen lds
s_add_u32 m0, s45, 4096
s_mov_b32 s44, 3670016
buffer_load_dwordx4 v16, s[4:7], s44 offen lds
s_add_u32 m0, s45, 5120
s_mov_b32 s44, 3801088
buffer_load_dwordx4 v16, s[4:7], s44 offen lds
s_add_u32 m0, s45, 6144
s_mov_b32 s44, 3932160
buffer_load_dwordx4 v16, s[4:7], s44 offen lds
s_add_u32 m0, s45, 7168
s_mov_b32 s44, 4063232
buffer_load_dwordx4 v16, s[4:7], s44 offen lds
s_waitcnt lgkmcnt(0)
v_mfma_f32_16x16x32_bf16 v[52:55], a[0:3], v[20:23], 0
v_mfma_f32_16x16x32_bf16 v[56:59], a[4:7], v[20:23], 0
v_mfma_f32_16x16x32_bf16 v[60:63], a[0:3], v[24:27], 0
v_mfma_f32_16x16x32_bf16 v[64:67], a[4:7], v[24:27], 0
v_mfma_f32_16x16x32_bf16 v[52:55], a[8:11], v[28:31], v[52:55]
v_mfma_f32_16x16x32_bf16 v[56:59], a[12:15], v[28:31], v[56:59]
v_mfma_f32_16x16x32_bf16 v[60:63], a[8:11], v[32:35], v[60:63]
v_mfma_f32_16x16x32_bf16 v[64:67], a[12:15], v[32:35], v[64:67]
v_mfma_f32_16x16x32_bf16 v[52:55], a[16:19], v[36:39], v[52:55]
v_mfma_f32_16x16x32_bf16 v[56:59], a[20:23], v[36:39], v[56:59]
v_mfma_f32_16x16x32_bf16 v[60:63], a[16:19], v[40:43], v[60:63]
v_mfma_f32_16x16x32_bf16 v[64:67], a[20:23], v[40:43], v[64:67]
v_mfma_f32_16x16x32_bf16 v[52:55], a[24:27], v[44:47], v[52:55]
v_mfma_f32_16x16x32_bf16 v[56:59], a[28:31], v[44:47], v[56:59]
v_mfma_f32_16x16x32_bf16 v[60:63], a[24:27], v[48:51], v[60:63]
v_mfma_f32_16x16x32_bf16 v[64:67], a[28:31], v[48:51], v[64:67]
s_waitcnt vmcnt(18)
ds_read_b64_tr_b16 a[32:33], v17 offset:8192
ds_read_b64_tr_b16 a[34:35], v17 offset:8448
ds_read_b64_tr_b16 a[36:37], v17 offset:8200
ds_read_b64_tr_b16 a[38:39], v17 offset:8456
ds_read_b64_tr_b16 a[40:41], v17 offset:10240
ds_read_b64_tr_b16 a[42:43], v17 offset:10496
ds_read_b64_tr_b16 a[44:45], v17 offset:10248
ds_read_b64_tr_b16 a[46:47], v17 offset:10504
s_waitcnt lgkmcnt(0)
ds_read_b64_tr_b16 a[48:49], v17 offset:12288
ds_read_b64_tr_b16 a[50:51], v17 offset:12544
ds_read_b64_tr_b16 a[52:53], v17 offset:12296
ds_read_b64_tr_b16 a[54:55], v17 offset:12552
ds_read_b64_tr_b16 a[56:57], v17 offset:14336
ds_read_b64_tr_b16 a[58:59], v17 offset:14592
ds_read_b64_tr_b16 a[60:61], v17 offset:14344
ds_read_b64_tr_b16 a[62:63], v17 offset:14600
s_waitcnt lgkmcnt(0)
ds_read_b128 v[20:23], v8 offset:8192
ds_read_b128 v[24:27], v8 offset:10240
ds_read_b128 v[28:31], v9 offset:8192
ds_read_b128 v[32:35], v9 offset:10240
ds_read_b128 v[36:39], v8 offset:12288
ds_read_b128 v[40:43], v8 offset:14336
ds_read_b128 v[44:47], v9 offset:12288
ds_read_b128 v[48:51], v9 offset:14336
s_mov_b32 s44, 4194304
buffer_load_dword v250, v12, s[4:7], s44 offen
s_add_u32 m0, s45, 8192
s_mov_b32 s44, 4194304
buffer_load_dwordx4 v16, s[4:7], s44 offen lds
s_add_u32 m0, s45, 9216
s_mov_b32 s44, 4325376
buffer_load_dwordx4 v16, s[4:7], s44 offen lds
s_add_u32 m0, s45, 10240
s_mov_b32 s44, 4456448
buffer_load_dwordx4 v16, s[4:7], s44 offen lds
s_add_u32 m0, s45, 11264
s_mov_b32 s44, 4587520
buffer_load_dwordx4 v16, s[4:7], s44 offen lds
s_add_u32 m0, s45, 12288
s_mov_b32 s44, 4718592
buffer_load_dwordx4 v16, s[4:7], s44 offen lds
s_add_u32 m0, s45, 13312
s_mov_b32 s44, 4849664
buffer_load_dwordx4 v16, s[4:7], s44 offen lds
s_add_u32 m0, s45, 14336
s_mov_b32 s44, 4980736
buffer_load_dwordx4 v16, s[4:7], s44 offen lds
s_add_u32 m0, s45, 15360
s_mov_b32 s44, 5111808
buffer_load_dwordx4 v16, s[4:7], s44 offen lds
s_waitcnt lgkmcnt(0)
v_mfma_f32_16x16x32_bf16 v[52:55], a[32:35], v[20:23], v[52:55]
v_mfma_f32_16x16x32_bf16 v[56:59], a[36:39], v[20:23], v[56:59]
v_mfma_f32_16x16x32_bf16 v[60:63], a[32:35], v[24:27], v[60:63]
v_mfma_f32_16x16x32_bf16 v[64:67], a[36:39], v[24:27], v[64:67]
v_mfma_f32_16x16x32_bf16 v[52:55], a[40:43], v[28:31], v[52:55]
v_mfma_f32_16x16x32_bf16 v[56:59], a[44:47], v[28:31], v[56:59]
v_mfma_f32_16x16x32_bf16 v[60:63], a[40:43], v[32:35], v[60:63]
v_mfma_f32_16x16x32_bf16 v[64:67], a[44:47], v[32:35], v[64:67]
v_mfma_f32_16x16x32_bf16 v[52:55], a[48:51], v[36:39], v[52:55]
v_mfma_f32_16x16x32_bf16 v[56:59], a[52:55], v[36:39], v[56:59]
v_mfma_f32_16x16x32_bf16 v[60:63], a[48:51], v[40:43], v[60:63]
v_mfma_f32_16x16x32_bf16 v[64:67], a[52:55], v[40:43], v[64:67]
v_mfma_f32_16x16x32_bf16 v[52:55], a[56:59], v[44:47], v[52:55]
v_mfma_f32_16x16x32_bf16 v[56:59], a[60:63], v[44:47], v[56:59]
v_mfma_f32_16x16x32_bf16 v[60:63], a[56:59], v[48:51], v[60:63]
v_mfma_f32_16x16x32_bf16 v[64:67], a[60:63], v[48:51], v[64:67]
s_waitcnt vmcnt(18)
ds_read_b64_tr_b16 a[64:65], v17 offset:16384
ds_read_b64_tr_b16 a[66:67], v17 offset:16640
ds_read_b64_tr_b16 a[68:69], v17 offset:16392
ds_read_b64_tr_b16 a[70:71], v17 offset:16648
ds_read_b64_tr_b16 a[72:73], v17 offset:18432
ds_read_b64_tr_b16 a[74:75], v17 offset:18688
ds_read_b64_tr_b16 a[76:77], v17 offset:18440
ds_read_b64_tr_b16 a[78:79], v17 offset:18696
s_waitcnt lgkmcnt(0)
ds_read_b64_tr_b16 a[80:81], v17 offset:20480
ds_read_b64_tr_b16 a[82:83], v17 offset:20736
ds_read_b64_tr_b16 a[84:85], v17 offset:20488
ds_read_b64_tr_b16 a[86:87], v17 offset:20744
ds_read_b64_tr_b16 a[88:89], v17 offset:22528
ds_read_b64_tr_b16 a[90:91], v17 offset:22784
ds_read_b64_tr_b16 a[92:93], v17 offset:22536
ds_read_b64_tr_b16 a[94:95], v17 offset:22792
s_waitcnt lgkmcnt(0)
ds_read_b128 v[20:23], v8 offset:16384
ds_read_b128 v[24:27], v8 offset:18432
ds_read_b128 v[28:31], v9 offset:16384
ds_read_b128 v[32:35], v9 offset:18432
ds_read_b128 v[36:39], v8 offset:20480
ds_read_b128 v[40:43], v8 offset:22528
ds_read_b128 v[44:47], v9 offset:20480
ds_read_b128 v[48:51], v9 offset:22528
s_mov_b32 s44, 5242880
buffer_load_dword v250, v12, s[4:7], s44 offen
s_add_u32 m0, s45, 16384
s_mov_b32 s44, 5242880
buffer_load_dwordx4 v16, s[4:7], s44 offen lds
s_add_u32 m0, s45, 17408
s_mov_b32 s44, 5373952
buffer_load_dwordx4 v16, s[4:7], s44 offen lds
s_add_u32 m0, s45, 18432
s_mov_b32 s44, 5505024
buffer_load_dwordx4 v16, s[4:7], s44 offen lds
s_add_u32 m0, s45, 19456
s_mov_b32 s44, 5636096
buffer_load_dwordx4 v16, s[4:7], s44 offen lds
s_add_u32 m0, s45, 20480
s_mov_b32 s44, 5767168
buffer_load_dwordx4 v16, s[4:7], s44 offen lds
s_add_u32 m0, s45, 21504
s_mov_b32 s44, 5898240
buffer_load_dwordx4 v16, s[4:7], s44 offen lds
s_add_u32 m0, s45, 22528
s_mov_b32 s44, 6029312
buffer_load_dwordx4 v16, s[4:7], s44 offen lds
s_add_u32 m0, s45, 23552
s_mov_b32 s44, 6160384
buffer_load_dwordx4 v16, s[4:7], s44 offen lds
s_waitcnt lgkmcnt(0)
v_mfma_f32_16x16x32_bf16 v[52:55], a[64:67], v[20:23], v[52:55]
v_mfma_f32_16x16x32_bf16 v[56:59], a[68:71], v[20:23], v[56:59]
v_mfma_f32_16x16x32_bf16 v[60:63], a[64:67], v[24:27], v[60:63]
v_mfma_f32_16x16x32_bf16 v[64:67], a[68:71], v[24:27], v[64:67]
v_mfma_f32_16x16x32_bf16 v[52:55], a[72:75], v[28:31], v[52:55]
v_mfma_f32_16x16x32_bf16 v[56:59], a[76:79], v[28:31], v[56:59]
v_mfma_f32_16x16x32_bf16 v[60:63], a[72:75], v[32:35], v[60:63]
v_mfma_f32_16x16x32_bf16 v[64:67], a[76:79], v[32:35], v[64:67]
v_mfma_f32_16x16x32_bf16 v[52:55], a[80:83], v[36:39], v[52:55]
v_mfma_f32_16x16x32_bf16 v[56:59], a[84:87], v[36:39], v[56:59]
v_mfma_f32_16x16x32_bf16 v[60:63], a[80:83], v[40:43], v[60:63]
v_mfma_f32_16x16x32_bf16 v[64:67], a[84:87], v[40:43], v[64:67]
v_mfma_f32_16x16x32_bf16 v[52:55], a[88:91], v[44:47], v[52:55]
v_mfma_f32_16x16x32_bf16 v[56:59], a[92:95], v[44:47], v[56:59]
v_mfma_f32_16x16x32_bf16 v[60:63], a[88:91], v[48:51], v[60:63]
v_mfma_f32_16x16x32_bf16 v[64:67], a[92:95], v[48:51], v[64:67]
s_waitcnt vmcnt(18)
ds_read_b64_tr_b16 a[96:97], v17 offset:0
ds_read_b64_tr_b16 a[98:99], v17 offset:256
ds_read_b64_tr_b16 a[100:101], v17 offset:8
ds_read_b64_tr_b16 a[102:103], v17 offset:264
ds_read_b64_tr_b16 a[104:105], v17 offset:2048
ds_read_b64_tr_b16 a[106:107], v17 offset:2304
ds_read_b64_tr_b16 a[108:109], v17 offset:2056
ds_read_b64_tr_b16 a[110:111], v17 offset:2312
s_waitcnt lgkmcnt(0)
ds_read_b64_tr_b16 a[112:113], v17 offset:4096
ds_read_b64_tr_b16 a[114:115], v17 offset:4352
ds_read_b64_tr_b16 a[116:117], v17 offset:4104
ds_read_b64_tr_b16 a[118:119], v17 offset:4360
ds_read_b64_tr_b16 a[120:121], v17 offset:6144
ds_read_b64_tr_b16 a[122:123], v17 offset:6400
ds_read_b64_tr_b16 a[124:125], v17 offset:6152
ds_read_b64_tr_b16 a[126:127], v17 offset:6408
s_waitcnt lgkmcnt(0)
ds_read_b128 v[20:23], v8 offset:24576
ds_read_b128 v[24:27], v8 offset:26624
ds_read_b128 v[28:31], v9 offset:24576
ds_read_b128 v[32:35], v9 offset:26624
ds_read_b128 v[36:39], v8 offset:28672
ds_read_b128 v[40:43], v8 offset:30720
ds_read_b128 v[44:47], v9 offset:28672
ds_read_b128 v[48:51], v9 offset:30720
s_mov_b32 s44, 6291456
buffer_load_dword v250, v12, s[4:7], s44 offen
s_add_u32 m0, s45, 0
s_mov_b32 s44, 6291456
buffer_load_dwordx4 v16, s[4:7], s44 offen lds
s_add_u32 m0, s45, 1024
s_mov_b32 s44, 6422528
buffer_load_dwordx4 v16, s[4:7], s44 offen lds
s_add_u32 m0, s45, 2048
s_mov_b32 s44, 6553600
buffer_load_dwordx4 v16, s[4:7], s44 offen lds
s_add_u32 m0, s45, 3072
s_mov_b32 s44, 6684672
buffer_load_dwordx4 v16, s[4:7], s44 offen lds
s_add_u32 m0, s45, 4096
s_mov_b32 s44, 6815744
buffer_load_dwordx4 v16, s[4:7], s44 offen lds
s_add_u32 m0, s45, 5120
s_mov_b32 s44, 6946816
buffer_load_dwordx4 v16, s[4:7], s44 offen lds
s_add_u32 m0, s45, 6144
s_mov_b32 s44, 7077888
buffer_load_dwordx4 v16, s[4:7], s44 offen lds
s_add_u32 m0, s45, 7168
s_mov_b32 s44, 7208960
buffer_load_dwordx4 v16, s[4:7], s44 offen lds
s_waitcnt lgkmcnt(0)
v_mfma_f32_16x16x32_bf16 v[52:55], a[96:99], v[20:23], v[52:55]
v_mfma_f32_16x16x32_bf16 v[56:59], a[100:103], v[20:23], v[56:59]
v_mfma_f32_16x16x32_bf16 v[60:63], a[96:99], v[24:27], v[60:63]
v_mfma_f32_16x16x32_bf16 v[64:67], a[100:103], v[24:27], v[64:67]
v_mfma_f32_16x16x32_bf16 v[52:55], a[104:107], v[28:31], v[52:55]
v_mfma_f32_16x16x32_bf16 v[56:59], a[108:111], v[28:31], v[56:59]
v_mfma_f32_16x16x32_bf16 v[60:63], a[104:107], v[32:35], v[60:63]
v_mfma_f32_16x16x32_bf16 v[64:67], a[108:111], v[32:35], v[64:67]
v_mfma_f32_16x16x32_bf16 v[52:55], a[112:115], v[36:39], v[52:55]
v_mfma_f32_16x16x32_bf16 v[56:59], a[116:119], v[36:39], v[56:59]
v_mfma_f32_16x16x32_bf16 v[60:63], a[112:115], v[40:43], v[60:63]
v_mfma_f32_16x16x32_bf16 v[64:67], a[116:119], v[40:43], v[64:67]
v_mfma_f32_16x16x32_bf16 v[52:55], a[120:123], v[44:47], v[52:55]
v_mfma_f32_16x16x32_bf16 v[56:59], a[124:127], v[44:47], v[56:59]
v_mfma_f32_16x16x32_bf16 v[60:63], a[120:123], v[48:51], v[60:63]
v_mfma_f32_16x16x32_bf16 v[64:67], a[124:127], v[48:51], v[64:67]
s_waitcnt vmcnt(18)
ds_read_b64_tr_b16 a[128:129], v17 offset:8192
ds_read_b64_tr_b16 a[130:131], v17 offset:8448
ds_read_b64_tr_b16 a[132:133], v17 offset:8200
ds_read_b64_tr_b16 a[134:135], v17 offset:8456
ds_read_b64_tr_b16 a[136:137], v17 offset:10240
ds_read_b64_tr_b16 a[138:139], v17 offset:10496
ds_read_b64_tr_b16 a[140:141], v17 offset:10248
ds_read_b64_tr_b16 a[142:143], v17 offset:10504
s_waitcnt lgkmcnt(0)
ds_read_b64_tr_b16 a[144:145], v17 offset:12288
ds_read_b64_tr_b16 a[146:147], v17 offset:12544
ds_read_b64_tr_b16 a[148:149], v17 offset:12296
ds_read_b64_tr_b16 a[150:151], v17 offset:12552
ds_read_b64_tr_b16 a[152:153], v17 offset:14336
ds_read_b64_tr_b16 a[154:155], v17 offset:14592
ds_read_b64_tr_b16 a[156:157], v17 offset:14344
ds_read_b64_tr_b16 a[158:159], v17 offset:14600
s_waitcnt lgkmcnt(0)
ds_read_b128 v[20:23], v8 offset:32768
ds_read_b128 v[24:27], v8 offset:34816
ds_read_b128 v[28:31], v9 offset:32768
ds_read_b128 v[32:35], v9 offset:34816
ds_read_b128 v[36:39], v8 offset:36864
ds_read_b128 v[40:43], v8 offset:38912
ds_read_b128 v[44:47], v9 offset:36864
ds_read_b128 v[48:51], v9 offset:38912
s_mov_b32 s44, 7340032
buffer_load_dword v250, v12, s[4:7], s44 offen
s_add_u32 m0, s45, 8192
s_mov_b32 s44, 7340032
buffer_load_dwordx4 v16, s[4:7], s44 offen lds
s_add_u32 m0, s45, 9216
s_mov_b32 s44, 7471104
buffer_load_dwordx4 v16, s[4:7], s44 offen lds
s_add_u32 m0, s45, 10240
s_mov_b32 s44, 7602176
buffer_load_dwordx4 v16, s[4:7], s44 offen lds
s_add_u32 m0, s45, 11264
s_mov_b32 s44, 7733248
buffer_load_dwordx4 v16, s[4:7], s44 offen lds
s_add_u32 m0, s45, 12288
s_mov_b32 s44, 7864320
buffer_load_dwordx4 v16, s[4:7], s44 offen lds
s_add_u32 m0, s45, 13312
s_mov_b32 s44, 7995392
buffer_load_dwordx4 v16, s[4:7], s44 offen lds
s_add_u32 m0, s45, 14336
s_mov_b32 s44, 8126464
buffer_load_dwordx4 v16, s[4:7], s44 offen lds
s_add_u32 m0, s45, 15360
s_mov_b32 s44, 8257536
buffer_load_dwordx4 v16, s[4:7], s44 offen lds
s_waitcnt lgkmcnt(0)
v_mfma_f32_16x16x32_bf16 v[52:55], a[128:131], v[20:23], v[52:55]
v_mfma_f32_16x16x32_bf16 v[56:59], a[132:135], v[20:23], v[56:59]
v_mfma_f32_16x16x32_bf16 v[60:63], a[128:131], v[24:27], v[60:63]
v_mfma_f32_16x16x32_bf16 v[64:67], a[132:135], v[24:27], v[64:67]
v_mfma_f32_16x16x32_bf16 v[52:55], a[136:139], v[28:31], v[52:55]
v_mfma_f32_16x16x32_bf16 v[56:59], a[140:143], v[28:31], v[56:59]
v_mfma_f32_16x16x32_bf16 v[60:63], a[136:139], v[32:35], v[60:63]
v_mfma_f32_16x16x32_bf16 v[64:67], a[140:143], v[32:35], v[64:67]
v_mfma_f32_16x16x32_bf16 v[52:55], a[144:147], v[36:39], v[52:55]
v_mfma_f32_16x16x32_bf16 v[56:59], a[148:151], v[36:39], v[56:59]
v_mfma_f32_16x16x32_bf16 v[60:63], a[144:147], v[40:43], v[60:63]
v_mfma_f32_16x16x32_bf16 v[64:67], a[148:151], v[40:43], v[64:67]
v_mfma_f32_16x16x32_bf16 v[52:55], a[152:155], v[44:47], v[52:55]
v_mfma_f32_16x16x32_bf16 v[56:59], a[156:159], v[44:47], v[56:59]
v_mfma_f32_16x16x32_bf16 v[60:63], a[152:155], v[48:51], v[60:63]
v_mfma_f32_16x16x32_bf16 v[64:67], a[156:159], v[48:51], v[64:67]
s_waitcnt vmcnt(18)
ds_read_b64_tr_b16 a[160:161], v17 offset:16384
ds_read_b64_tr_b16 a[162:163], v17 offset:16640
ds_read_b64_tr_b16 a[164:165], v17 offset:16392
ds_read_b64_tr_b16 a[166:167], v17 offset:16648
ds_read_b64_tr_b16 a[168:169], v17 offset:18432
ds_read_b64_tr_b16 a[170:171], v17 offset:18688
ds_read_b64_tr_b16 a[172:173], v17 offset:18440
ds_read_b64_tr_b16 a[174:175], v17 offset:18696
s_waitcnt lgkmcnt(0)
ds_read_b64_tr_b16 a[176:177], v17 offset:20480
ds_read_b64_tr_b16 a[178:179], v17 offset:20736
ds_read_b64_tr_b16 a[180:181], v17 offset:20488
ds_read_b64_tr_b16 a[182:183], v17 offset:20744
ds_read_b64_tr_b16 a[184:185], v17 offset:22528
ds_read_b64_tr_b16 a[186:187], v17 offset:22784
ds_read_b64_tr_b16 a[188:189], v17 offset:22536
ds_read_b64_tr_b16 a[190:191], v17 offset:22792
s_waitcnt lgkmcnt(0)
ds_read_b128 v[20:23], v8 offset:40960
ds_read_b128 v[24:27], v8 offset:43008
ds_read_b128 v[28:31], v9 offset:40960
ds_read_b128 v[32:35], v9 offset:43008
ds_read_b128 v[36:39], v8 offset:45056
ds_read_b128 v[40:43], v8 offset:47104
ds_read_b128 v[44:47], v9 offset:45056
ds_read_b128 v[48:51], v9 offset:47104
s_waitcnt lgkmcnt(0)
v_mfma_f32_16x16x32_bf16 v[52:55], a[160:163], v[20:23], v[52:55]
v_mfma_f32_16x16x32_bf16 v[56:59], a[164:167], v[20:23], v[56:59]
v_mfma_f32_16x16x32_bf16 v[60:63], a[160:163], v[24:27], v[60:63]
v_mfma_f32_16x16x32_bf16 v[64:67], a[164:167], v[24:27], v[64:67]
v_mfma_f32_16x16x32_bf16 v[52:55], a[168:171], v[28:31], v[52:55]
v_mfma_f32_16x16x32_bf16 v[56:59], a[172:175], v[28:31], v[56:59]
v_mfma_f32_16x16x32_bf16 v[60:63], a[168:171], v[32:35], v[60:63]
v_mfma_f32_16x16x32_bf16 v[64:67], a[172:175], v[32:35], v[64:67]
v_mfma_f32_16x16x32_bf16 v[52:55], a[176:179], v[36:39], v[52:55]
v_mfma_f32_16x16x32_bf16 v[56:59], a[180:183], v[36:39], v[56:59]
v_mfma_f32_16x16x32_bf16 v[60:63], a[176:179], v[40:43], v[60:63]
v_mfma_f32_16x16x32_bf16 v[64:67], a[180:183], v[40:43], v[64:67]
v_mfma_f32_16x16x32_bf16 v[52:55], a[184:187], v[44:47], v[52:55]
v_mfma_f32_16x16x32_bf16 v[56:59], a[188:191], v[44:47], v[56:59]
v_mfma_f32_16x16x32_bf16 v[60:63], a[184:187], v[48:51], v[60:63]
v_mfma_f32_16x16x32_bf16 v[64:67], a[188:191], v[48:51], v[64:67]
s_waitcnt vmcnt(9)
ds_read_b64_tr_b16 a[192:193], v17 offset:0
ds_read_b64_tr_b16 a[194:195], v17 offset:256
ds_read_b64_tr_b16 a[196:197], v17 offset:8
ds_read_b64_tr_b16 a[198:199], v17 offset:264
ds_read_b64_tr_b16 a[200:201], v17 offset:2048
ds_read_b64_tr_b16 a[202:203], v17 offset:2304
ds_read_b64_tr_b16 a[204:205], v17 offset:2056
ds_read_b64_tr_b16 a[206:207], v17 offset:2312
s_waitcnt lgkmcnt(0)
ds_read_b64_tr_b16 a[208:209], v17 offset:4096
ds_read_b64_tr_b16 a[210:211], v17 offset:4352
ds_read_b64_tr_b16 a[212:213], v17 offset:4104
ds_read_b64_tr_b16 a[214:215], v17 offset:4360
ds_read_b64_tr_b16 a[216:217], v17 offset:6144
ds_read_b64_tr_b16 a[218:219], v17 offset:6400
ds_read_b64_tr_b16 a[220:221], v17 offset:6152
ds_read_b64_tr_b16 a[222:223], v17 offset:6408
s_waitcnt lgkmcnt(0)
ds_read_b128 v[20:23], v8 offset:49152
ds_read_b128 v[24:27], v8 offset:51200
ds_read_b128 v[28:31], v9 offset:49152
ds_read_b128 v[32:35], v9 offset:51200
ds_read_b128 v[36:39], v8 offset:53248
ds_read_b128 v[40:43], v8 offset:55296
ds_read_b128 v[44:47], v9 offset:53248
ds_read_b128 v[48:51], v9 offset:55296
s_waitcnt lgkmcnt(0)
v_mfma_f32_16x16x32_bf16 v[52:55], a[192:195], v[20:23], v[52:55]
v_mfma_f32_16x16x32_bf16 v[56:59], a[196:199], v[20:23], v[56:59]
v_mfma_f32_16x16x32_bf16 v[60:63], a[192:195], v[24:27], v[60:63]
v_mfma_f32_16x16x32_bf16 v[64:67], a[196:199], v[24:27], v[64:67]
v_mfma_f32_16x16x32_bf16 v[52:55], a[200:203], v[28:31], v[52:55]
v_mfma_f32_16x16x32_bf16 v[56:59], a[204:207], v[28:31], v[56:59]
v_mfma_f32_16x16x32_bf16 v[60:63], a[200:203], v[32:35], v[60:63]
v_mfma_f32_16x16x32_bf16 v[64:67], a[204:207], v[32:35], v[64:67]
v_mfma_f32_16x16x32_bf16 v[52:55], a[208:211], v[36:39], v[52:55]
v_mfma_f32_16x16x32_bf16 v[56:59], a[212:215], v[36:39], v[56:59]
v_mfma_f32_16x16x32_bf16 v[60:63], a[208:211], v[40:43], v[60:63]
v_mfma_f32_16x16x32_bf16 v[64:67], a[212:215], v[40:43], v[64:67]
v_mfma_f32_16x16x32_bf16 v[52:55], a[216:219], v[44:47], v[52:55]
v_mfma_f32_16x16x32_bf16 v[56:59], a[220:223], v[44:47], v[56:59]
v_mfma_f32_16x16x32_bf16 v[60:63], a[216:219], v[48:51], v[60:63]
v_mfma_f32_16x16x32_bf16 v[64:67], a[220:223], v[48:51], v[64:67]
s_waitcnt vmcnt(0)
ds_read_b64_tr_b16 a[224:225], v17 offset:8192
ds_read_b64_tr_b16 a[226:227], v17 offset:8448
ds_read_b64_tr_b16 a[228:229], v17 offset:8200
ds_read_b64_tr_b16 a[230:231], v17 offset:8456
ds_read_b64_tr_b16 a[232:233], v17 offset:10240
ds_read_b64_tr_b16 a[234:235], v17 offset:10496
ds_read_b64_tr_b16 a[236:237], v17 offset:10248
ds_read_b64_tr_b16 a[238:239], v17 offset:10504
s_waitcnt lgkmcnt(0)
ds_read_b64_tr_b16 a[240:241], v17 offset:12288
ds_read_b64_tr_b16 a[242:243], v17 offset:12544
ds_read_b64_tr_b16 a[244:245], v17 offset:12296
ds_read_b64_tr_b16 a[246:247], v17 offset:12552
ds_read_b64_tr_b16 a[248:249], v17 offset:14336
ds_read_b64_tr_b16 a[250:251], v17 offset:14592
ds_read_b64_tr_b16 a[252:253], v17 offset:14344
ds_read_b64_tr_b16 a[254:255], v17 offset:14600
s_waitcnt lgkmcnt(0)
ds_read_b128 v[20:23], v8 offset:57344
ds_read_b128 v[24:27], v8 offset:59392
ds_read_b128 v[28:31], v9 offset:57344
ds_read_b128 v[32:35], v9 offset:59392
ds_read_b128 v[36:39], v8 offset:61440
ds_read_b128 v[40:43], v8 offset:63488
ds_read_b128 v[44:47], v9 offset:61440
ds_read_b128 v[48:51], v9 offset:63488
s_waitcnt lgkmcnt(0)
v_mfma_f32_16x16x32_bf16 v[52:55], a[224:227], v[20:23], v[52:55]
v_mfma_f32_16x16x32_bf16 v[56:59], a[228:231], v[20:23], v[56:59]
v_mfma_f32_16x16x32_bf16 v[60:63], a[224:227], v[24:27], v[60:63]
v_mfma_f32_16x16x32_bf16 v[64:67], a[228:231], v[24:27], v[64:67]
v_mfma_f32_16x16x32_bf16 v[52:55], a[232:235], v[28:31], v[52:55]
v_mfma_f32_16x16x32_bf16 v[56:59], a[236:239], v[28:31], v[56:59]
v_mfma_f32_16x16x32_bf16 v[60:63], a[232:235], v[32:35], v[60:63]
v_mfma_f32_16x16x32_bf16 v[64:67], a[236:239], v[32:35], v[64:67]
v_mfma_f32_16x16x32_bf16 v[52:55], a[240:243], v[36:39], v[52:55]
v_mfma_f32_16x16x32_bf16 v[56:59], a[244:247], v[36:39], v[56:59]
v_mfma_f32_16x16x32_bf16 v[60:63], a[240:243], v[40:43], v[60:63]
v_mfma_f32_16x16x32_bf16 v[64:67], a[244:247], v[40:43], v[64:67]
v_mfma_f32_16x16x32_bf16 v[52:55], a[248:251], v[44:47], v[52:55]
v_mfma_f32_16x16x32_bf16 v[56:59], a[252:255], v[44:47], v[56:59]
v_mfma_f32_16x16x32_bf16 v[60:63], a[248:251], v[48:51], v[60:63]
v_mfma_f32_16x16x32_bf16 v[64:67], a[252:255], v[48:51], v[64:67]
s_barrier
s_mov_b32 s50, 0x10000
s_add_u32 m0, s46, 65536
s_nop 0
buffer_load_dwordx4 v6, s[8:11], s50 offen offset:0 lds
s_add_u32 m0, s46, 69504
s_nop 0
buffer_load_dwordx4 v6, s[8:11], s50 offen offset:128 lds
s_add_u32 m0, s46, 73472
s_nop 0
buffer_load_dwordx4 v6, s[8:11], s50 offen offset:256 lds
s_add_u32 m0, s46, 77440
s_nop 0
buffer_load_dwordx4 v6, s[8:11], s50 offen offset:384 lds
s_add_u32 m0, s46, 81408
s_nop 0
buffer_load_dwordx4 v6, s[8:11], s50 offen offset:512 lds
s_add_u32 m0, s46, 85376
s_nop 0
buffer_load_dwordx4 v6, s[8:11], s50 offen offset:640 lds
s_add_u32 m0, s46, 89344
s_nop 0
buffer_load_dwordx4 v6, s[8:11], s50 offen offset:768 lds
s_add_u32 m0, s46, 93312
s_nop 0
buffer_load_dwordx4 v6, s[8:11], s50 offen offset:896 lds
s_add_u32 m0, s46, 97280
s_nop 0
buffer_load_dwordx4 v6, s[8:11], s50 offen offset:1024 lds
s_add_u32 m0, s46, 101248
s_nop 0
buffer_load_dwordx4 v6, s[8:11], s50 offen offset:1152 lds
s_add_u32 m0, s46, 105216
s_nop 0
buffer_load_dwordx4 v6, s[8:11], s50 offen offset:1280 lds
s_add_u32 m0, s46, 109184
s_nop 0
buffer_load_dwordx4 v6, s[8:11], s50 offen offset:1408 lds
s_add_u32 m0, s46, 113152
s_nop 0
buffer_load_dwordx4 v6, s[8:11], s50 offen offset:1536 lds
s_add_u32 m0, s46, 117120
s_nop 0
buffer_load_dwordx4 v6, s[8:11], s50 offen offset:1664 lds
s_add_u32 m0, s46, 121088
s_nop 0
buffer_load_dwordx4 v6, s[8:11], s50 offen offset:1792 lds
s_add_u32 m0, s46, 125056
s_nop 0
buffer_load_dwordx4 v6, s[8:11], s50 offen offset:1920 lds
v_lshrrev_b32 v92, 4, v1
v_and_b32 v93, 15, v1
s_and_b32 s52, s41, 1
s_lshr_b32 s53, s41, 1
s_mov_b32 s54, 0x3e0293ee
s_mov_b32 s55, 0
s_mov_b32 s56, 0
v_mov_b32 v97, 0xff7fffff
v_and_b32 v2, 7, v93
v_lshlrev_b32 v94, 7, v92
v_lshl_add_u32 v94, v2, 4, v94
v_and_b32 v2, 31, v1
v_lshlrev_b32 v95, 3, v2
v_lshrrev_b32 v2, 1, v92
v_lshlrev_b32 v96, 10, v2
v_and_b32 v2, 1, v92
v_lshl_add_u32 v96, v2, 9, v96
v_lshl_add_u32 v96, v93, 4, v96
s_lshl_b32 s43, s40, 13
s_lshl_b32 s44, s53, 12
s_add_u32 s43, s43, s44
s_lshl_b32 s44, s52, 8
s_add_u32 s43, s43, s44
s_add_u32 s43, s43, 134217728
v_add_u32 v96, s43, v96
s_lshl_b32 s43, s52, 4
v_add_u32 v98, s43, v93
v_lshlrev_b32 v2, 2, v92
v_sub_u32 v98, v98, v2
s_mov_b32 s28, 0
s_mov_b32 s29, -1
s_xor_b32 s44, s98, 1
s_lshl_b32 s44, s44, 13
s_lshl_b32 s43, s40, 7
s_add_u32 s43, s43, s44
s_add_u32 s43, s43, 69206016
v_and_b32 v2, 3, v1
v_bfe_u32 v3, v1, 2, 1
v_lshlrev_b32 v99, 12, v3
v_lshl_add_u32 v99, v2, 2, v99
v_add_u32 v99, s43, v99
s_xor_b32 s62, s98, 1
s_lshl_b32 s62, s62, 13
s_lshr_b32 s44, s47, 6
s_lshl_b32 s44, s44, 14
s_add_u32 s62, s62, s44
s_and_b32 s44, s47, 63
s_lshl_b32 s44, s44, 7
s_add_u32 s62, s62, s44
s_add_u32 s62, s62, 69222400
s_lshl_b32 s49, s47, 2
s_add_u32 s49, s49, 69255168
s_lshl_b32 s43, s41, 11
s_add_u32 s43, s43, 131072
v_add_u32 v101, s43, v7
s_lshl_b32 s43, s52, 10
s_add_u32 s43, s43, 131072
v_add_u32 v102, s43, v5
v_mov_b32 v16, 0
s_mov_b32 s50, 0
v_mov_b32 v104, 0x3f803f80
v_mov_b32 v105, 0x3f803f80
v_mov_b32 v106, 0x3f803f80
v_mov_b32 v107, 0x3f803f80
v_cmp_gt_i32 s[12:13], 0, v98
v_cmp_gt_i32 s[14:15], 1, v98
v_cmp_gt_i32 s[16:17], 2, v98
v_cmp_gt_i32 s[18:19], 3, v98
v_cmp_gt_i32 s[20:21], 16, v98
v_cmp_gt_i32 s[22:23], 17, v98
v_cmp_gt_i32 s[24:25], 18, v98
v_cmp_gt_i32 s[26:27], 19, v98
s_lshr_b32 s44, s47, 3
s_xor_b32 s44, s44, s98
s_and_b32 s44, s44, 1
s_lshl_b32 s44, s44, 13
s_lshl_b32 s58, s47, 18
s_add_u32 s58, s58, s44
s_add_u32 s58, s58, 0
s_lshr_b32 s44, s47, 4
s_xor_b32 s44, s44, s98
s_and_b32 s44, s44, 1
s_lshl_b32 s44, s44, 13
s_lshl_b32 s59, s47, 17
s_add_u32 s59, s59, s44
s_add_u32 s59, s59, 71303168
s_lshl_b32 s60, s41, 11
s_add_u32 s60, s60, 139264
s_lshl_b32 s61, s41, 10
s_add_u32 s61, s61, 155648
v_add_u32 v94, 155648, v94
s_lshl_b32 s43, s53, 11
s_add_u32 s43, s43, 156160
v_add_u32 v95, s43, v95
v_add_u32 v103, 139264, v5
s_lshl_b32 s43, s53, 12
s_add_u32 s43, s43, 147456
v_add_u32 v240, s43, v5
s_waitcnt vmcnt(0)
v_mov_b32 v68, v52
v_mov_b32 v69, v53
v_mov_b32 v70, v54
v_mov_b32 v71, v55
v_mov_b32 v72, v56
v_mov_b32 v73, v57
v_mov_b32 v74, v58
v_mov_b32 v75, v59
v_mov_b32 v76, v60
v_mov_b32 v77, v61
v_mov_b32 v78, v62
v_mov_b32 v79, v63
v_mov_b32 v80, v64
v_mov_b32 v81, v65
v_mov_b32 v82, v66
v_mov_b32 v83, v67
mega_kernel_q_loop:
s_barrier
s_cmp_gt_i32 s55, s42
s_cbranch_scc1 mega_kernel_q_kv1k
mega_kernel_q_kv1w:
buffer_load_dword v2, v99, s[84:87], 0 offen sc1
s_waitcnt vmcnt(0)
v_min_i32_dpp v2, v2, v2 quad_perm:[1,0,3,2] row_mask:0xf bank_mask:0xf
s_nop 1
v_min_i32_dpp v2, v2, v2 quad_perm:[2,3,0,1] row_mask:0xf bank_mask:0xf
s_nop 1
v_min_i32_dpp v2, v2, v2 row_ror:4 row_mask:0xf bank_mask:0xf
s_nop 0
v_readfirstlane_b32 s55, v2
s_cmp_gt_i32 s55, s42
s_cbranch_scc1 mega_kernel_q_kv1k
s_sleep 4
s_branch mega_kernel_q_kv1w
mega_kernel_q_kv1k:
ds_read_b128 v[20:23], v10 offset:0
ds_read_b128 v[24:27], v10 offset:2048
ds_read_b128 v[28:31], v11 offset:0
ds_read_b128 v[32:35], v11 offset:2048
ds_read_b128 v[36:39], v10 offset:4096
ds_read_b128 v[40:43], v10 offset:6144
s_add_u32 s51, s47, s42
s_bfe_u32 s57, s51, 0x40002
s_lshl_b32 s57, s57, 14
s_and_b32 s66, s51, 3
s_lshl_b32 s66, s66, 11
s_add_u32 s66, s66, s57
s_add_u32 s66, s66, s58
s_add_u32 s67, s66, 33554432
s_bfe_u32 s57, s51, 0x30003
s_lshl_b32 s57, s57, 14
s_and_b32 s68, s51, 7
s_lshl_b32 s68, s68, 10
s_add_u32 s68, s68, s57
s_add_u32 s68, s68, s59
s_add_u32 s50, s42, 2
s_min_u32 s50, s50, 63
s_lshl_b32 s50, s50, 16
s_cmp_gt_i32 s56, s42
s_cselect_b32 s30, 1, 0
s_add_u32 m0, s60, 0
s_waitcnt lgkmcnt(4)
v_mfma_f32_16x16x32_bf16 v[52:55], a[0:3], v[20:23], 0
ds_read_b128 v[44:47], v11 offset:4096
v_mfma_f32_16x16x32_bf16 v[56:59], a[4:7], v[20:23], 0
buffer_load_dwordx4 v5, s[84:87], s66 offen offset:0 sc1 lds
v_mfma_f32_16x16x32_bf16 v[60:63], a[0:3], v[24:27], 0
ds_read_b128 v[48:51], v11 offset:6144
v_mfma_f32_16x16x32_bf16 v[64:67], a[4:7], v[24:27], 0
s_add_u32 m0, s60, 0
s_waitcnt lgkmcnt(4)
v_mfma_f32_16x16x32_bf16 v[52:55], a[8:11], v[28:31], v[52:55]
ds_read_b128 v[20:23], v10 offset:8192
v_mfma_f32_16x16x32_bf16 v[56:59], a[12:15], v[28:31], v[56:59]
buffer_load_dwordx4 v5, s[84:87], s66 offen offset:1024 sc1 lds
v_mfma_f32_16x16x32_bf16 v[60:63], a[8:11], v[32:35], v[60:63]
ds_read_b128 v[24:27], v10 offset:10240
v_mfma_f32_16x16x32_bf16 v[64:67], a[12:15], v[32:35], v[64:67]
s_add_u32 m0, s60, 8192
s_waitcnt lgkmcnt(4)
v_mfma_f32_16x16x32_bf16 v[52:55], a[16:19], v[36:39], v[52:55]
ds_read_b128 v[28:31], v11 offset:8192
v_mfma_f32_16x16x32_bf16 v[56:59], a[20:23], v[36:39], v[56:59]
buffer_load_dwordx4 v5, s[84:87], s67 offen offset:0 sc1 lds
v_mfma_f32_16x16x32_bf16 v[60:63], a[16:19], v[40:43], v[60:63]
ds_read_b128 v[32:35], v11 offset:10240
v_mfma_f32_16x16x32_bf16 v[64:67], a[20:23], v[40:43], v[64:67]
s_add_u32 m0, s60, 8192
s_waitcnt lgkmcnt(4)
v_mfma_f32_16x16x32_bf16 v[52:55], a[24:27], v[44:47], v[52:55]
ds_read_b128 v[36:39], v10 offset:12288
v_mfma_f32_16x16x32_bf16 v[56:59], a[28:31], v[44:47], v[56:59]
buffer_load_dwordx4 v5, s[84:87], s67 offen offset:1024 sc1 lds
v_mfma_f32_16x16x32_bf16 v[60:63], a[24:27], v[48:51], v[60:63]
ds_read_b128 v[40:43], v10 offset:14336
v_mfma_f32_16x16x32_bf16 v[64:67], a[28:31], v[48:51], v[64:67]
s_waitcnt lgkmcnt(4)
v_mfma_f32_16x16x32_bf16 v[52:55], a[32:35], v[20:23], v[52:55]
ds_read_b128 v[44:47], v11 offset:12288
v_mfma_f32_16x16x32_bf16 v[56:59], a[36:39], v[20:23], v[56:59]
s_cmp_eq_u32 s30, 1
s_cbranch_scc0 mega_kernel_q_ke1
s_mov_b32 m0, s61
s_nop 0
buffer_load_dwordx4 v5, s[84:87], s68 offen sc1 lds
mega_kernel_q_ke1:
v_mfma_f32_16x16x32_bf16 v[60:63], a[32:35], v[24:27], v[60:63]
ds_read_b128 v[48:51], v11 offset:14336
v_mfma_f32_16x16x32_bf16 v[64:67], a[36:39], v[24:27], v[64:67]
s_add_u32 m0, s46, 0
s_waitcnt lgkmcnt(4)
v_mfma_f32_16x16x32_bf16 v[52:55], a[40:43], v[28:31], v[52:55]
ds_read_b128 v[20:23], v10 offset:16384
v_mfma_f32_16x16x32_bf16 v[56:59], a[44:47], v[28:31], v[56:59]
buffer_load_dwordx4 v6, s[8:11], s50 offen offset:0 lds
v_mfma_f32_16x16x32_bf16 v[60:63], a[40:43], v[32:35], v[60:63]
ds_read_b128 v[24:27], v10 offset:18432
v_mfma_f32_16x16x32_bf16 v[64:67], a[44:47], v[32:35], v[64:67]
s_add_u32 m0, s46, 3968
s_waitcnt lgkmcnt(4)
v_mfma_f32_16x16x32_bf16 v[52:55], a[48:51], v[36:39], v[52:55]
ds_read_b128 v[28:31], v11 offset:16384
v_mfma_f32_16x16x32_bf16 v[56:59], a[52:55], v[36:39], v[56:59]
buffer_load_dwordx4 v6, s[8:11], s50 offen offset:128 lds
v_mfma_f32_16x16x32_bf16 v[60:63], a[48:51], v[40:43], v[60:63]
ds_read_b128 v[32:35], v11 offset:18432
v_mfma_f32_16x16x32_bf16 v[64:67], a[52:55], v[40:43], v[64:67]
s_add_u32 m0, s46, 7936
s_waitcnt lgkmcnt(4)
v_mfma_f32_16x16x32_bf16 v[52:55], a[56:59], v[44:47], v[52:55]
ds_read_b128 v[36:39], v10 offset:20480
v_mfma_f32_16x16x32_bf16 v[56:59], a[60:63], v[44:47], v[56:59]
buffer_load_dwordx4 v6, s[8:11], s50 offen offset:256 lds
v_mfma_f32_16x16x32_bf16 v[60:63], a[56:59], v[48:51], v[60:63]
ds_read_b128 v[40:43], v10 offset:22528
v_mfma_f32_16x16x32_bf16 v[64:67], a[60:63], v[48:51], v[64:67]
s_add_u32 m0, s46, 11904
s_waitcnt lgkmcnt(4)
v_mfma_f32_16x16x32_bf16 v[52:55], a[64:67], v[20:23], v[52:55]
ds_read_b128 v[44:47], v11 offset:20480
v_mfma_f32_16x16x32_bf16 v[56:59], a[68:71], v[20:23], v[56:59]
buffer_load_dwordx4 v6, s[8:11], s50 offen offset:384 lds
v_mfma_f32_16x16x32_bf16 v[60:63], a[64:67], v[24:27], v[60:63]
ds_read_b128 v[48:51], v11 offset:22528
v_mfma_f32_16x16x32_bf16 v[64:67], a[68:71], v[24:27], v[64:67]
s_add_u32 m0, s46, 15872
s_waitcnt lgkmcnt(4)
v_mfma_f32_16x16x32_bf16 v[52:55], a[72:75], v[28:31], v[52:55]
ds_read_b128 v[20:23], v10 offset:24576
v_mfma_f32_16x16x32_bf16 v[56:59], a[76:79], v[28:31], v[56:59]
buffer_load_dwordx4 v6, s[8:11], s50 offen offset:512 lds
v_mfma_f32_16x16x32_bf16 v[60:63], a[72:75], v[32:35], v[60:63]
ds_read_b128 v[24:27], v10 offset:26624
v_mfma_f32_16x16x32_bf16 v[64:67], a[76:79], v[32:35], v[64:67]
s_add_u32 m0, s46, 19840
s_waitcnt lgkmcnt(4)
v_mfma_f32_16x16x32_bf16 v[52:55], a[80:83], v[36:39], v[52:55]
ds_read_b128 v[28:31], v11 offset:24576
v_mfma_f32_16x16x32_bf16 v[56:59], a[84:87], v[36:39], v[56:59]
buffer_load_dwordx4 v6, s[8:11], s50 offen offset:640 lds
v_mfma_f32_16x16x32_bf16 v[60:63], a[80:83], v[40:43], v[60:63]
ds_read_b128 v[32:35], v11 offset:26624
v_mfma_f32_16x16x32_bf16 v[64:67], a[84:87], v[40:43], v[64:67]
s_add_u32 m0, s46, 23808
s_waitcnt lgkmcnt(4)
v_mfma_f32_16x16x32_bf16 v[52:55], a[88:91], v[44:47], v[52:55]
ds_read_b128 v[36:39], v10 offset:28672
v_mfma_f32_16x16x32_bf16 v[56:59], a[92:95], v[44:47], v[56:59]
buffer_load_dwordx4 v6, s[8:11], s50 offen offset:768 lds
v_mfma_f32_16x16x32_bf16 v[60:63], a[88:91], v[48:51], v[60:63]
ds_read_b128 v[40:43], v10 offset:30720
v_mfma_f32_16x16x32_bf16 v[64:67], a[92:95], v[48:51], v[64:67]
s_add_u32 m0, s46, 27776
s_waitcnt lgkmcnt(4)
v_mfma_f32_16x16x32_bf16 v[52:55], a[96:99], v[20:23], v[52:55]
ds_read_b128 v[44:47], v11 offset:28672
v_mfma_f32_16x16x32_bf16 v[56:59], a[100:103], v[20:23], v[56:59]
buffer_load_dwordx4 v6, s[8:11], s50 offen offset:896 lds
v_mfma_f32_16x16x32_bf16 v[60:63], a[96:99], v[24:27], v[60:63]
ds_read_b128 v[48:51], v11 offset:30720
v_mfma_f32_16x16x32_bf16 v[64:67], a[100:103], v[24:27], v[64:67]
s_add_u32 m0, s46, 31744
s_waitcnt lgkmcnt(4)
v_mfma_f32_16x16x32_bf16 v[52:55], a[104:107], v[28:31], v[52:55]
ds_read_b128 v[20:23], v10 offset:32768
v_mfma_f32_16x16x32_bf16 v[56:59], a[108:111], v[28:31], v[56:59]
buffer_load_dwordx4 v6, s[8:11], s50 offen offset:1024 lds
v_mfma_f32_16x16x32_bf16 v[60:63], a[104:107], v[32:35], v[60:63]
ds_read_b128 v[24:27], v10 offset:34816
v_mfma_f32_16x16x32_bf16 v[64:67], a[108:111], v[32:35], v[64:67]
s_waitcnt vmcnt(13)
v_mov_b32 v17, s42
s_mov_b64 exec, 1
buffer_store_dword v17, v16, s[84:87], s49 offen sc1
s_mov_b64 exec, -1
s_add_u32 m0, s46, 35712
s_waitcnt lgkmcnt(4)
v_mfma_f32_16x16x32_bf16 v[52:55], a[112:115], v[36:39], v[52:55]
ds_read_b128 v[28:31], v11 offset:32768
v_mfma_f32_16x16x32_bf16 v[56:59], a[116:119], v[36:39], v[56:59]
buffer_load_dwordx4 v6, s[8:11], s50 offen offset:1152 lds
v_mfma_f32_16x16x32_bf16 v[60:63], a[112:115], v[40:43], v[60:63]
ds_read_b128 v[32:35], v11 offset:34816
v_mfma_f32_16x16x32_bf16 v[64:67], a[116:119], v[40:43], v[64:67]
v_mov_b32 v100, 0
s_mov_b64 exec, 1
buffer_atomic_add v100, v16, s[84:87], s62 offen sc0 sc1
s_mov_b64 exec, -1
s_add_u32 m0, s46, 39680
s_waitcnt lgkmcnt(4)
v_mfma_f32_16x16x32_bf16 v[52:55], a[120:123], v[44:47], v[52:55]
ds_read_b128 v[36:39], v10 offset:36864
v_mfma_f32_16x16x32_bf16 v[56:59], a[124:127], v[44:47], v[56:59]
buffer_load_dwordx4 v6, s[8:11], s50 offen offset:1280 lds
v_mfma_f32_16x16x32_bf16 v[60:63], a[120:123], v[48:51], v[60:63]
ds_read_b128 v[40:43], v10 offset:38912
v_mfma_f32_16x16x32_bf16 v[64:67], a[124:127], v[48:51], v[64:67]
s_add_u32 m0, s46, 43648
s_waitcnt lgkmcnt(4)
v_mfma_f32_16x16x32_bf16 v[52:55], a[128:131], v[20:23], v[52:55]
ds_read_b128 v[44:47], v11 offset:36864
v_mfma_f32_16x16x32_bf16 v[56:59], a[132:135], v[20:23], v[56:59]
buffer_load_dwordx4 v6, s[8:11], s50 offen offset:1408 lds
v_mfma_f32_16x16x32_bf16 v[60:63], a[128:131], v[24:27], v[60:63]
ds_read_b128 v[48:51], v11 offset:38912
v_mfma_f32_16x16x32_bf16 v[64:67], a[132:135], v[24:27], v[64:67]
s_add_u32 m0, s46, 47616
s_waitcnt lgkmcnt(4)
v_mfma_f32_16x16x32_bf16 v[52:55], a[136:139], v[28:31], v[52:55]
ds_read_b128 v[20:23], v10 offset:40960
v_mfma_f32_16x16x32_bf16 v[56:59], a[140:143], v[28:31], v[56:59]
buffer_load_dwordx4 v6, s[8:11], s50 offen offset:1536 lds
v_mfma_f32_16x16x32_bf16 v[60:63], a[136:139], v[32:35], v[60:63]
ds_read_b128 v[24:27], v10 offset:43008
v_mfma_f32_16x16x32_bf16 v[64:67], a[140:143], v[32:35], v[64:67]
s_add_u32 m0, s46, 51584
s_waitcnt lgkmcnt(4)
v_mfma_f32_16x16x32_bf16 v[52:55], a[144:147], v[36:39], v[52:55]
ds_read_b128 v[28:31], v11 offset:40960
v_mfma_f32_16x16x32_bf16 v[56:59], a[148:151], v[36:39], v[56:59]
buffer_load_dwordx4 v6, s[8:11], s50 offen offset:1664 lds
v_mfma_f32_16x16x32_bf16 v[60:63], a[144:147], v[40:43], v[60:63]
ds_read_b128 v[32:35], v11 offset:43008
v_mfma_f32_16x16x32_bf16 v[64:67], a[148:151], v[40:43], v[64:67]
s_add_u32 m0, s46, 55552
s_waitcnt lgkmcnt(4)
v_mfma_f32_16x16x32_bf16 v[52:55], a[152:155], v[44:47], v[52:55]
ds_read_b128 v[36:39], v10 offset:45056
v_mfma_f32_16x16x32_bf16 v[56:59], a[156:159], v[44:47], v[56:59]
buffer_load_dwordx4 v6, s[8:11], s50 offen offset:1792 lds
v_mfma_f32_16x16x32_bf16 v[60:63], a[152:155], v[48:51], v[60:63]
ds_read_b128 v[40:43], v10 offset:47104
v_mfma_f32_16x16x32_bf16 v[64:67], a[156:159], v[48:51], v[64:67]
s_add_u32 m0, s46, 59520
s_waitcnt lgkmcnt(4)
v_mfma_f32_16x16x32_bf16 v[52:55], a[160:163], v[20:23], v[52:55]
ds_read_b128 v[44:47], v11 offset:45056
v_mfma_f32_16x16x32_bf16 v[56:59], a[164:167], v[20:23], v[56:59]
buffer_load_dwordx4 v6, s[8:11], s50 offen offset:1920 lds
v_mfma_f32_16x16x32_bf16 v[60:63], a[160:163], v[24:27], v[60:63]
ds_read_b128 v[48:51], v11 offset:47104
v_mfma_f32_16x16x32_bf16 v[64:67], a[164:167], v[24:27], v[64:67]
s_waitcnt lgkmcnt(4)
v_mfma_f32_16x16x32_bf16 v[52:55], a[168:171], v[28:31], v[52:55]
ds_read_b128 v[20:23], v10 offset:49152
v_mfma_f32_16x16x32_bf16 v[56:59], a[172:175], v[28:31], v[56:59]
v_mfma_f32_16x16x32_bf16 v[60:63], a[168:171], v[32:35], v[60:63]
ds_read_b128 v[24:27], v10 offset:51200
v_mfma_f32_16x16x32_bf16 v[64:67], a[172:175], v[32:35], v[64:67]
v_cvt_pk_bf16_f32 v84, v68, v69
v_cvt_pk_bf16_f32 v85, v70, v71
s_waitcnt lgkmcnt(4)
v_mfma_f32_16x16x32_bf16 v[52:55], a[176:179], v[36:39], v[52:55]
ds_read_b128 v[28:31], v11 offset:49152
v_mfma_f32_16x16x32_bf16 v[56:59], a[180:183], v[36:39], v[56:59]
v_mfma_f32_16x16x32_bf16 v[60:63], a[176:179], v[40:43], v[60:63]
ds_read_b128 v[32:35], v11 offset:51200
v_mfma_f32_16x16x32_bf16 v[64:67], a[180:183], v[40:43], v[64:67]
v_cvt_pk_bf16_f32 v86, v72, v73
v_cvt_pk_bf16_f32 v87, v74, v75
s_waitcnt lgkmcnt(4)
v_mfma_f32_16x16x32_bf16 v[52:55], a[184:187], v[44:47], v[52:55]
ds_read_b128 v[36:39], v10 offset:53248
v_mfma_f32_16x16x32_bf16 v[56:59], a[188:191], v[44:47], v[56:59]
v_mfma_f32_16x16x32_bf16 v[60:63], a[184:187], v[48:51], v[60:63]
ds_read_b128 v[40:43], v10 offset:55296
v_mfma_f32_16x16x32_bf16 v[64:67], a[188:191], v[48:51], v[64:67]
v_cvt_pk_bf16_f32 v88, v76, v77
v_cvt_pk_bf16_f32 v89, v78, v79
s_waitcnt lgkmcnt(4)
v_mfma_f32_16x16x32_bf16 v[52:55], a[192:195], v[20:23], v[52:55]
ds_read_b128 v[44:47], v11 offset:53248
v_mfma_f32_16x16x32_bf16 v[56:59], a[196:199], v[20:23], v[56:59]
v_mfma_f32_16x16x32_bf16 v[60:63], a[192:195], v[24:27], v[60:63]
ds_read_b128 v[48:51], v11 offset:55296
v_mfma_f32_16x16x32_bf16 v[64:67], a[196:199], v[24:27], v[64:67]
v_cvt_pk_bf16_f32 v90, v80, v81
v_cvt_pk_bf16_f32 v91, v82, v83
s_waitcnt lgkmcnt(4)
v_mfma_f32_16x16x32_bf16 v[52:55], a[200:203], v[28:31], v[52:55]
ds_read_b128 v[20:23], v10 offset:57344
v_mfma_f32_16x16x32_bf16 v[56:59], a[204:207], v[28:31], v[56:59]
v_mfma_f32_16x16x32_bf16 v[60:63], a[200:203], v[32:35], v[60:63]
ds_read_b128 v[24:27], v10 offset:59392
v_mfma_f32_16x16x32_bf16 v[64:67], a[204:207], v[32:35], v[64:67]
s_waitcnt lgkmcnt(4)
v_mfma_f32_16x16x32_bf16 v[52:55], a[208:211], v[36:39], v[52:55]
ds_read_b128 v[28:31], v11 offset:57344
v_mfma_f32_16x16x32_bf16 v[56:59], a[212:215], v[36:39], v[56:59]
v_mfma_f32_16x16x32_bf16 v[60:63], a[208:211], v[40:43], v[60:63]
ds_read_b128 v[32:35], v11 offset:59392
v_mfma_f32_16x16x32_bf16 v[64:67], a[212:215], v[40:43], v[64:67]
s_waitcnt lgkmcnt(4)
v_mfma_f32_16x16x32_bf16 v[52:55], a[216:219], v[44:47], v[52:55]
ds_read_b128 v[36:39], v10 offset:61440
v_mfma_f32_16x16x32_bf16 v[56:59], a[220:223], v[44:47], v[56:59]
s_waitcnt vmcnt(6)
v_readfirstlane_b32 s56, v100
s_cmp_eq_u32 s30, 1
s_cbranch_scc1 mega_kernel_q_kf1
s_cmp_gt_i32 s56, s42
s_cbranch_scc0 mega_kernel_q_kf1
s_mov_b32 s30, 1
s_mov_b32 m0, s61
s_nop 0
buffer_load_dwordx4 v5, s[84:87], s68 offen sc1 lds
mega_kernel_q_kf1:
v_mfma_f32_16x16x32_bf16 v[60:63], a[216:219], v[48:51], v[60:63]
ds_read_b128 v[40:43], v10 offset:63488
v_mfma_f32_16x16x32_bf16 v[64:67], a[220:223], v[48:51], v[64:67]
s_waitcnt lgkmcnt(4)
v_mfma_f32_16x16x32_bf16 v[52:55], a[224:227], v[20:23], v[52:55]
ds_read_b128 v[44:47], v11 offset:61440
v_mfma_f32_16x16x32_bf16 v[56:59], a[228:231], v[20:23], v[56:59]
v_mfma_f32_16x16x32_bf16 v[60:63], a[224:227], v[24:27], v[60:63]
ds_read_b128 v[48:51], v11 offset:63488
v_mfma_f32_16x16x32_bf16 v[64:67], a[228:231], v[24:27], v[64:67]
s_waitcnt lgkmcnt(5)
v_mfma_f32_16x16x32_bf16 v[52:55], a[232:235], v[28:31], v[52:55]
v_mfma_f32_16x16x32_bf16 v[56:59], a[236:239], v[28:31], v[56:59]
s_waitcnt lgkmcnt(4)
v_mfma_f32_16x16x32_bf16 v[60:63], a[232:235], v[32:35], v[60:63]
v_mfma_f32_16x16x32_bf16 v[64:67], a[236:239], v[32:35], v[64:67]
s_waitcnt lgkmcnt(3)
v_mfma_f32_16x16x32_bf16 v[52:55], a[240:243], v[36:39], v[52:55]
v_mfma_f32_16x16x32_bf16 v[56:59], a[244:247], v[36:39], v[56:59]
s_waitcnt lgkmcnt(2)
v_mfma_f32_16x16x32_bf16 v[60:63], a[240:243], v[40:43], v[60:63]
v_mfma_f32_16x16x32_bf16 v[64:67], a[244:247], v[40:43], v[64:67]
ds_write_b128 v101, v[84:87]
ds_write_b128 v101, v[88:91] offset:1024
s_waitcnt lgkmcnt(1)
v_mfma_f32_16x16x32_bf16 v[68:71], a[248:251], v[44:47], v[52:55]
v_mfma_f32_16x16x32_bf16 v[72:75], a[252:255], v[44:47], v[56:59]
s_waitcnt lgkmcnt(0)
v_mfma_f32_16x16x32_bf16 v[76:79], a[248:251], v[48:51], v[60:63]
v_mfma_f32_16x16x32_bf16 v[80:83], a[252:255], v[48:51], v[64:67]
s_cmp_eq_u32 s30, 1
s_cbranch_scc1 mega_kernel_q_kl1
mega_kernel_q_kw1:
v_mov_b32 v100, 0
s_mov_b64 exec, 1
buffer_atomic_add v100, v16, s[84:87], s62 offen sc0 sc1
s_mov_b64 exec, -1
s_waitcnt vmcnt(0)
v_readfirstlane_b32 s56, v100
s_cmp_gt_i32 s56, s42
s_cbranch_scc0 mega_kernel_q_kw1
s_mov_b32 m0, s61
s_nop 0
buffer_load_dwordx4 v5, s[84:87], s68 offen sc1 lds
mega_kernel_q_kl1:
s_waitcnt lgkmcnt(0) vmcnt(0)
s_barrier
ds_read_b128 v[184:187], v102 offset:0
ds_read_b128 v[112:115], v103 offset:0
ds_read_b128 v[128:131], v103 offset:1024
ds_read_b128 v[188:191], v102 offset:2048
ds_read_b128 v[116:119], v103 offset:2048
ds_read_b128 v[132:135], v103 offset:3072
ds_read_b128 v[192:195], v102 offset:4096
ds_read_b128 v[120:123], v103 offset:4096
ds_read_b128 v[136:139], v103 offset:5120
ds_read_b128 v[196:199], v102 offset:6144
ds_read_b128 v[124:127], v103 offset:6144
ds_read_b128 v[140:143], v103 offset:7168
s_waitcnt lgkmcnt(9)
v_mfma_f32_16x16x32_bf16 v[200:203], v[112:115], v[184:187], 0
v_mfma_f32_16x16x32_bf16 v[204:207], v[128:131], v[184:187], 0
ds_read_b128 v[160:163], v94 offset:0
s_waitcnt lgkmcnt(7)
v_mfma_f32_16x16x32_bf16 v[200:203], v[116:119], v[188:191], v[200:203]
v_mfma_f32_16x16x32_bf16 v[204:207], v[132:135], v[188:191], v[204:207]
ds_read_b128 v[164:167], v94 offset:1024
s_waitcnt lgkmcnt(5)
v_mfma_f32_16x16x32_bf16 v[200:203], v[120:123], v[192:195], v[200:203]
v_mfma_f32_16x16x32_bf16 v[204:207], v[136:139], v[192:195], v[204:207]
ds_read_b128 v[168:171], v94 offset:2048
s_waitcnt lgkmcnt(3)
v_mfma_f32_16x16x32_bf16 v[200:203], v[124:127], v[196:199], v[200:203]
v_mfma_f32_16x16x32_bf16 v[204:207], v[140:143], v[196:199], v[204:207]
ds_read_b128 v[172:175], v94 offset:3072
s_waitcnt lgkmcnt(3)
v_mfma_f32_16x16x32_bf16 v[208:211], v[160:163], v[184:187], 0
ds_read_b128 v[144:147], v240 offset:0
ds_read_b64 v[176:177], v95 offset:0
s_waitcnt lgkmcnt(4)
v_mfma_f32_16x16x32_bf16 v[208:211], v[164:167], v[188:191], v[208:211]
ds_read_b128 v[148:151], v240 offset:1024
ds_read_b64 v[178:179], v95 offset:256
s_waitcnt lgkmcnt(5)
v_mfma_f32_16x16x32_bf16 v[208:211], v[168:171], v[192:195], v[208:211]
ds_read_b128 v[152:155], v240 offset:2048
ds_read_b64 v[180:181], v95 offset:1024
s_waitcnt lgkmcnt(6)
v_mfma_f32_16x16x32_bf16 v[208:211], v[172:175], v[196:199], v[208:211]
ds_read_b128 v[156:159], v240 offset:3072
ds_read_b64 v[182:183], v95 offset:1280
s_nop 3
v_cndmask_b32 v200, v200, v97, s[12:13]
v_cndmask_b32 v201, v201, v97, s[14:15]
v_cndmask_b32 v202, v202, v97, s[16:17]
v_cndmask_b32 v203, v203, v97, s[18:19]
v_cndmask_b32 v204, v204, v97, s[20:21]
v_cndmask_b32 v205, v205, v97, s[22:23]
v_cndmask_b32 v206, v206, v97, s[24:25]
v_cndmask_b32 v207, v207, v97, s[26:27]
v_cndmask_b32 v208, v208, v97, s[28:29]
v_cndmask_b32 v209, v209, v97, s[28:29]
v_cndmask_b32 v210, v210, v97, s[28:29]
v_cndmask_b32 v211, v211, v97, s[28:29]
v_max3_f32 v236, v200, v201, v202
v_max3_f32 v236, v236, v203, v204
v_max3_f32 v236, v236, v205, v206
v_max3_f32 v236, v236, v207, v208
v_max3_f32 v236, v236, v209, v210
v_max_f32 v237, v236, v211
v_max_f32 v236, v236, v211
s_nop 1
v_permlane16_swap_b32 v236, v237
s_nop 0
v_max_f32 v238, v236, v237
v_max_f32 v239, v236, v237
s_nop 1
v_permlane32_swap_b32 v238, v239
s_nop 0
v_max_f32 v236, v238, v239
v_mul_f32 v236, s54, v236
v_pk_fma_f32 v[200:201], v[200:201], s[54:55], v[236:237] op_sel_hi:[1,0,0] neg_lo:[0,0,1] neg_hi:[0,0,1]
v_pk_fma_f32 v[202:203], v[202:203], s[54:55], v[236:237] op_sel_hi:[1,0,0] neg_lo:[0,0,1] neg_hi:[0,0,1]
v_pk_fma_f32 v[204:205], v[204:205], s[54:55], v[236:237] op_sel_hi:[1,0,0] neg_lo:[0,0,1] neg_hi:[0,0,1]
v_pk_fma_f32 v[206:207], v[206:207], s[54:55], v[236:237] op_sel_hi:[1,0,0] neg_lo:[0,0,1] neg_hi:[0,0,1]
v_pk_fma_f32 v[208:209], v[208:209], s[54:55], v[236:237] op_sel_hi:[1,0,0] neg_lo:[0,0,1] neg_hi:[0,0,1]
v_pk_fma_f32 v[210:211], v[210:211], s[54:55], v[236:237] op_sel_hi:[1,0,0] neg_lo:[0,0,1] neg_hi:[0,0,1]
v_exp_f32 v200, v200
v_exp_f32 v201, v201
v_exp_f32 v202, v202
v_exp_f32 v203, v203
v_exp_f32 v204, v204
v_exp_f32 v205, v205
v_exp_f32 v206, v206
v_exp_f32 v207, v207
v_exp_f32 v208, v208
v_exp_f32 v209, v209
v_exp_f32 v210, v210
v_exp_f32 v211, v211
s_nop 0
v_cvt_pk_bf16_f32 v212, v200, v201
v_cvt_pk_bf16_f32 v213, v202, v203
v_cvt_pk_bf16_f32 v214, v204, v205
v_cvt_pk_bf16_f32 v215, v206, v207
v_cvt_pk_bf16_f32 v216, v208, v209
v_cvt_pk_bf16_f32 v217, v210, v211
s_waitcnt lgkmcnt(0)
s_nop 0
v_mfma_f32_16x16x32_bf16 v[108:111], v[104:107], v[212:215], 0
v_mfma_f32_16x16x32_bf16 v[220:223], v[144:147], v[212:215], 0
v_mfma_f32_16x16x32_bf16 v[224:227], v[148:151], v[212:215], 0
v_mfma_f32_16x16x32_bf16 v[228:231], v[152:155], v[212:215], 0
v_mfma_f32_16x16x32_bf16 v[232:235], v[156:159], v[212:215], 0
v_mfma_f32_16x16x16_bf16 v[108:111], v[104:105], v[216:217], v[108:111]
v_mfma_f32_16x16x16_bf16 v[220:223], v[176:177], v[216:217], v[220:223]
v_mfma_f32_16x16x16_bf16 v[224:227], v[178:179], v[216:217], v[224:227]
v_mfma_f32_16x16x16_bf16 v[228:231], v[180:181], v[216:217], v[228:231]
v_mfma_f32_16x16x16_bf16 v[232:235], v[182:183], v[216:217], v[232:235]
s_lshl_b32 s51, s42, 18
s_nop 2
v_rcp_f32 v238, v108
v_rcp_f32 v239, v109
s_nop 1
v_pk_mul_f32 v[220:221], v[220:221], v[238:239]
v_pk_mul_f32 v[222:223], v[222:223], v[238:239]
v_pk_mul_f32 v[224:225], v[224:225], v[238:239]
v_pk_mul_f32 v[226:227], v[226:227], v[238:239]
v_pk_mul_f32 v[228:229], v[228:229], v[238:239]
v_pk_mul_f32 v[230:231], v[230:231], v[238:239]
v_pk_mul_f32 v[232:233], v[232:233], v[238:239]
v_pk_mul_f32 v[234:235], v[234:235], v[238:239]
v_cvt_pk_bf16_f32 v200, v220, v221
v_cvt_pk_bf16_f32 v201, v222, v223
v_cvt_pk_bf16_f32 v202, v224, v225
v_cvt_pk_bf16_f32 v203, v226, v227
v_cvt_pk_bf16_f32 v204, v228, v229
v_cvt_pk_bf16_f32 v205, v230, v231
v_cvt_pk_bf16_f32 v206, v232, v233
v_cvt_pk_bf16_f32 v207, v234, v235
buffer_store_dwordx4 v[200:203], v96, s[84:87], s51 offen sc1
buffer_store_dwordx4 v[204:207], v96, s[84:87], s51 offen offset:2048 sc1
s_add_u32 s42, s42, 1
s_cmp_eq_u32 s42, 63
s_cbranch_scc1 mega_kernel_q_last
s_barrier
s_cmp_gt_i32 s55, s42
s_cbranch_scc1 mega_kernel_q_kv0k
mega_kernel_q_kv0w:
buffer_load_dword v2, v99, s[84:87], 0 offen sc1
s_waitcnt vmcnt(0)
v_min_i32_dpp v2, v2, v2 quad_perm:[1,0,3,2] row_mask:0xf bank_mask:0xf
s_nop 1
v_min_i32_dpp v2, v2, v2 quad_perm:[2,3,0,1] row_mask:0xf bank_mask:0xf
s_nop 1
v_min_i32_dpp v2, v2, v2 row_ror:4 row_mask:0xf bank_mask:0xf
s_nop 0
v_readfirstlane_b32 s55, v2
s_cmp_gt_i32 s55, s42
s_cbranch_scc1 mega_kernel_q_kv0k
s_sleep 4
s_branch mega_kernel_q_kv0w
mega_kernel_q_kv0k:
ds_read_b128 v[20:23], v8 offset:0
ds_read_b128 v[24:27], v8 offset:2048
ds_read_b128 v[28:31], v9 offset:0
ds_read_b128 v[32:35], v9 offset:2048
ds_read_b128 v[36:39], v8 offset:4096
ds_read_b128 v[40:43], v8 offset:6144
s_add_u32 s51, s47, s42
s_bfe_u32 s57, s51, 0x40002
s_lshl_b32 s57, s57, 14
s_and_b32 s66, s51, 3
s_lshl_b32 s66, s66, 11
s_add_u32 s66, s66, s57
s_add_u32 s66, s66, s58
s_add_u32 s67, s66, 33554432
s_bfe_u32 s57, s51, 0x30003
s_lshl_b32 s57, s57, 14
s_and_b32 s68, s51, 7
s_lshl_b32 s68, s68, 10
s_add_u32 s68, s68, s57
s_add_u32 s68, s68, s59
s_add_u32 s50, s42, 2
s_min_u32 s50, s50, 63
s_lshl_b32 s50, s50, 16
s_cmp_gt_i32 s56, s42
s_cselect_b32 s30, 1, 0
s_add_u32 m0, s60, 0
s_waitcnt lgkmcnt(4)
v_mfma_f32_16x16x32_bf16 v[52:55], a[0:3], v[20:23], 0
ds_read_b128 v[44:47], v9 offset:4096
v_mfma_f32_16x16x32_bf16 v[56:59], a[4:7], v[20:23], 0
buffer_load_dwordx4 v5, s[84:87], s66 offen offset:0 sc1 lds
v_mfma_f32_16x16x32_bf16 v[60:63], a[0:3], v[24:27], 0
ds_read_b128 v[48:51], v9 offset:6144
v_mfma_f32_16x16x32_bf16 v[64:67], a[4:7], v[24:27], 0
s_add_u32 m0, s60, 0
s_waitcnt lgkmcnt(4)
v_mfma_f32_16x16x32_bf16 v[52:55], a[8:11], v[28:31], v[52:55]
ds_read_b128 v[20:23], v8 offset:8192
v_mfma_f32_16x16x32_bf16 v[56:59], a[12:15], v[28:31], v[56:59]
buffer_load_dwordx4 v5, s[84:87], s66 offen offset:1024 sc1 lds
v_mfma_f32_16x16x32_bf16 v[60:63], a[8:11], v[32:35], v[60:63]
ds_read_b128 v[24:27], v8 offset:10240
v_mfma_f32_16x16x32_bf16 v[64:67], a[12:15], v[32:35], v[64:67]
s_add_u32 m0, s60, 8192
s_waitcnt lgkmcnt(4)
v_mfma_f32_16x16x32_bf16 v[52:55], a[16:19], v[36:39], v[52:55]
ds_read_b128 v[28:31], v9 offset:8192
v_mfma_f32_16x16x32_bf16 v[56:59], a[20:23], v[36:39], v[56:59]
buffer_load_dwordx4 v5, s[84:87], s67 offen offset:0 sc1 lds
v_mfma_f32_16x16x32_bf16 v[60:63], a[16:19], v[40:43], v[60:63]
ds_read_b128 v[32:35], v9 offset:10240
v_mfma_f32_16x16x32_bf16 v[64:67], a[20:23], v[40:43], v[64:67]
s_add_u32 m0, s60, 8192
s_waitcnt lgkmcnt(4)
v_mfma_f32_16x16x32_bf16 v[52:55], a[24:27], v[44:47], v[52:55]
ds_read_b128 v[36:39], v8 offset:12288
v_mfma_f32_16x16x32_bf16 v[56:59], a[28:31], v[44:47], v[56:59]
buffer_load_dwordx4 v5, s[84:87], s67 offen offset:1024 sc1 lds
v_mfma_f32_16x16x32_bf16 v[60:63], a[24:27], v[48:51], v[60:63]
ds_read_b128 v[40:43], v8 offset:14336
v_mfma_f32_16x16x32_bf16 v[64:67], a[28:31], v[48:51], v[64:67]
s_waitcnt lgkmcnt(4)
v_mfma_f32_16x16x32_bf16 v[52:55], a[32:35], v[20:23], v[52:55]
ds_read_b128 v[44:47], v9 offset:12288
v_mfma_f32_16x16x32_bf16 v[56:59], a[36:39], v[20:23], v[56:59]
s_cmp_eq_u32 s30, 1
s_cbranch_scc0 mega_kernel_q_ke0
s_mov_b32 m0, s61
s_nop 0
buffer_load_dwordx4 v5, s[84:87], s68 offen sc1 lds
mega_kernel_q_ke0:
v_mfma_f32_16x16x32_bf16 v[60:63], a[32:35], v[24:27], v[60:63]
ds_read_b128 v[48:51], v9 offset:14336
v_mfma_f32_16x16x32_bf16 v[64:67], a[36:39], v[24:27], v[64:67]
s_add_u32 m0, s46, 65536
s_waitcnt lgkmcnt(4)
v_mfma_f32_16x16x32_bf16 v[52:55], a[40:43], v[28:31], v[52:55]
ds_read_b128 v[20:23], v8 offset:16384
v_mfma_f32_16x16x32_bf16 v[56:59], a[44:47], v[28:31], v[56:59]
buffer_load_dwordx4 v6, s[8:11], s50 offen offset:0 lds
v_mfma_f32_16x16x32_bf16 v[60:63], a[40:43], v[32:35], v[60:63]
ds_read_b128 v[24:27], v8 offset:18432
v_mfma_f32_16x16x32_bf16 v[64:67], a[44:47], v[32:35], v[64:67]
s_add_u32 m0, s46, 69504
s_waitcnt lgkmcnt(4)
v_mfma_f32_16x16x32_bf16 v[52:55], a[48:51], v[36:39], v[52:55]
ds_read_b128 v[28:31], v9 offset:16384
v_mfma_f32_16x16x32_bf16 v[56:59], a[52:55], v[36:39], v[56:59]
buffer_load_dwordx4 v6, s[8:11], s50 offen offset:128 lds
v_mfma_f32_16x16x32_bf16 v[60:63], a[48:51], v[40:43], v[60:63]
ds_read_b128 v[32:35], v9 offset:18432
v_mfma_f32_16x16x32_bf16 v[64:67], a[52:55], v[40:43], v[64:67]
s_add_u32 m0, s46, 73472
s_waitcnt lgkmcnt(4)
v_mfma_f32_16x16x32_bf16 v[52:55], a[56:59], v[44:47], v[52:55]
ds_read_b128 v[36:39], v8 offset:20480
v_mfma_f32_16x16x32_bf16 v[56:59], a[60:63], v[44:47], v[56:59]
buffer_load_dwordx4 v6, s[8:11], s50 offen offset:256 lds
v_mfma_f32_16x16x32_bf16 v[60:63], a[56:59], v[48:51], v[60:63]
ds_read_b128 v[40:43], v8 offset:22528
v_mfma_f32_16x16x32_bf16 v[64:67], a[60:63], v[48:51], v[64:67]
s_add_u32 m0, s46, 77440
s_waitcnt lgkmcnt(4)
v_mfma_f32_16x16x32_bf16 v[52:55], a[64:67], v[20:23], v[52:55]
ds_read_b128 v[44:47], v9 offset:20480
v_mfma_f32_16x16x32_bf16 v[56:59], a[68:71], v[20:23], v[56:59]
buffer_load_dwordx4 v6, s[8:11], s50 offen offset:384 lds
v_mfma_f32_16x16x32_bf16 v[60:63], a[64:67], v[24:27], v[60:63]
ds_read_b128 v[48:51], v9 offset:22528
v_mfma_f32_16x16x32_bf16 v[64:67], a[68:71], v[24:27], v[64:67]
s_add_u32 m0, s46, 81408
s_waitcnt lgkmcnt(4)
v_mfma_f32_16x16x32_bf16 v[52:55], a[72:75], v[28:31], v[52:55]
ds_read_b128 v[20:23], v8 offset:24576
v_mfma_f32_16x16x32_bf16 v[56:59], a[76:79], v[28:31], v[56:59]
buffer_load_dwordx4 v6, s[8:11], s50 offen offset:512 lds
v_mfma_f32_16x16x32_bf16 v[60:63], a[72:75], v[32:35], v[60:63]
ds_read_b128 v[24:27], v8 offset:26624
v_mfma_f32_16x16x32_bf16 v[64:67], a[76:79], v[32:35], v[64:67]
s_add_u32 m0, s46, 85376
s_waitcnt lgkmcnt(4)
v_mfma_f32_16x16x32_bf16 v[52:55], a[80:83], v[36:39], v[52:55]
ds_read_b128 v[28:31], v9 offset:24576
v_mfma_f32_16x16x32_bf16 v[56:59], a[84:87], v[36:39], v[56:59]
buffer_load_dwordx4 v6, s[8:11], s50 offen offset:640 lds
v_mfma_f32_16x16x32_bf16 v[60:63], a[80:83], v[40:43], v[60:63]
ds_read_b128 v[32:35], v9 offset:26624
v_mfma_f32_16x16x32_bf16 v[64:67], a[84:87], v[40:43], v[64:67]
s_add_u32 m0, s46, 89344
s_waitcnt lgkmcnt(4)
v_mfma_f32_16x16x32_bf16 v[52:55], a[88:91], v[44:47], v[52:55]
ds_read_b128 v[36:39], v8 offset:28672
v_mfma_f32_16x16x32_bf16 v[56:59], a[92:95], v[44:47], v[56:59]
buffer_load_dwordx4 v6, s[8:11], s50 offen offset:768 lds
v_mfma_f32_16x16x32_bf16 v[60:63], a[88:91], v[48:51], v[60:63]
ds_read_b128 v[40:43], v8 offset:30720
v_mfma_f32_16x16x32_bf16 v[64:67], a[92:95], v[48:51], v[64:67]
s_add_u32 m0, s46, 93312
s_waitcnt lgkmcnt(4)
v_mfma_f32_16x16x32_bf16 v[52:55], a[96:99], v[20:23], v[52:55]
ds_read_b128 v[44:47], v9 offset:28672
v_mfma_f32_16x16x32_bf16 v[56:59], a[100:103], v[20:23], v[56:59]
buffer_load_dwordx4 v6, s[8:11], s50 offen offset:896 lds
v_mfma_f32_16x16x32_bf16 v[60:63], a[96:99], v[24:27], v[60:63]
ds_read_b128 v[48:51], v9 offset:30720
v_mfma_f32_16x16x32_bf16 v[64:67], a[100:103], v[24:27], v[64:67]
s_add_u32 m0, s46, 97280
s_waitcnt lgkmcnt(4)
v_mfma_f32_16x16x32_bf16 v[52:55], a[104:107], v[28:31], v[52:55]
ds_read_b128 v[20:23], v8 offset:32768
v_mfma_f32_16x16x32_bf16 v[56:59], a[108:111], v[28:31], v[56:59]
buffer_load_dwordx4 v6, s[8:11], s50 offen offset:1024 lds
v_mfma_f32_16x16x32_bf16 v[60:63], a[104:107], v[32:35], v[60:63]
ds_read_b128 v[24:27], v8 offset:34816
v_mfma_f32_16x16x32_bf16 v[64:67], a[108:111], v[32:35], v[64:67]
s_waitcnt vmcnt(13)
v_mov_b32 v17, s42
s_mov_b64 exec, 1
buffer_store_dword v17, v16, s[84:87], s49 offen sc1
s_mov_b64 exec, -1
s_add_u32 m0, s46, 101248
s_waitcnt lgkmcnt(4)
v_mfma_f32_16x16x32_bf16 v[52:55], a[112:115], v[36:39], v[52:55]
ds_read_b128 v[28:31], v9 offset:32768
v_mfma_f32_16x16x32_bf16 v[56:59], a[116:119], v[36:39], v[56:59]
buffer_load_dwordx4 v6, s[8:11], s50 offen offset:1152 lds
v_mfma_f32_16x16x32_bf16 v[60:63], a[112:115], v[40:43], v[60:63]
ds_read_b128 v[32:35], v9 offset:34816
v_mfma_f32_16x16x32_bf16 v[64:67], a[116:119], v[40:43], v[64:67]
v_mov_b32 v100, 0
s_mov_b64 exec, 1
buffer_atomic_add v100, v16, s[84:87], s62 offen sc0 sc1
s_mov_b64 exec, -1
s_add_u32 m0, s46, 105216
s_waitcnt lgkmcnt(4)
v_mfma_f32_16x16x32_bf16 v[52:55], a[120:123], v[44:47], v[52:55]
ds_read_b128 v[36:39], v8 offset:36864
v_mfma_f32_16x16x32_bf16 v[56:59], a[124:127], v[44:47], v[56:59]
buffer_load_dwordx4 v6, s[8:11], s50 offen offset:1280 lds
v_mfma_f32_16x16x32_bf16 v[60:63], a[120:123], v[48:51], v[60:63]
ds_read_b128 v[40:43], v8 offset:38912
v_mfma_f32_16x16x32_bf16 v[64:67], a[124:127], v[48:51], v[64:67]
s_add_u32 m0, s46, 109184
s_waitcnt lgkmcnt(4)
v_mfma_f32_16x16x32_bf16 v[52:55], a[128:131], v[20:23], v[52:55]
ds_read_b128 v[44:47], v9 offset:36864
v_mfma_f32_16x16x32_bf16 v[56:59], a[132:135], v[20:23], v[56:59]
buffer_load_dwordx4 v6, s[8:11], s50 offen offset:1408 lds
v_mfma_f32_16x16x32_bf16 v[60:63], a[128:131], v[24:27], v[60:63]
ds_read_b128 v[48:51], v9 offset:38912
v_mfma_f32_16x16x32_bf16 v[64:67], a[132:135], v[24:27], v[64:67]
s_add_u32 m0, s46, 113152
s_waitcnt lgkmcnt(4)
v_mfma_f32_16x16x32_bf16 v[52:55], a[136:139], v[28:31], v[52:55]
ds_read_b128 v[20:23], v8 offset:40960
v_mfma_f32_16x16x32_bf16 v[56:59], a[140:143], v[28:31], v[56:59]
buffer_load_dwordx4 v6, s[8:11], s50 offen offset:1536 lds
v_mfma_f32_16x16x32_bf16 v[60:63], a[136:139], v[32:35], v[60:63]
ds_read_b128 v[24:27], v8 offset:43008
v_mfma_f32_16x16x32_bf16 v[64:67], a[140:143], v[32:35], v[64:67]
s_add_u32 m0, s46, 117120
s_waitcnt lgkmcnt(4)
v_mfma_f32_16x16x32_bf16 v[52:55], a[144:147], v[36:39], v[52:55]
ds_read_b128 v[28:31], v9 offset:40960
v_mfma_f32_16x16x32_bf16 v[56:59], a[148:151], v[36:39], v[56:59]
buffer_load_dwordx4 v6, s[8:11], s50 offen offset:1664 lds
v_mfma_f32_16x16x32_bf16 v[60:63], a[144:147], v[40:43], v[60:63]
ds_read_b128 v[32:35], v9 offset:43008
v_mfma_f32_16x16x32_bf16 v[64:67], a[148:151], v[40:43], v[64:67]
s_add_u32 m0, s46, 121088
s_waitcnt lgkmcnt(4)
v_mfma_f32_16x16x32_bf16 v[52:55], a[152:155], v[44:47], v[52:55]
ds_read_b128 v[36:39], v8 offset:45056
v_mfma_f32_16x16x32_bf16 v[56:59], a[156:159], v[44:47], v[56:59]
buffer_load_dwordx4 v6, s[8:11], s50 offen offset:1792 lds
v_mfma_f32_16x16x32_bf16 v[60:63], a[152:155], v[48:51], v[60:63]
ds_read_b128 v[40:43], v8 offset:47104
v_mfma_f32_16x16x32_bf16 v[64:67], a[156:159], v[48:51], v[64:67]
s_add_u32 m0, s46, 125056
s_waitcnt lgkmcnt(4)
v_mfma_f32_16x16x32_bf16 v[52:55], a[160:163], v[20:23], v[52:55]
ds_read_b128 v[44:47], v9 offset:45056
v_mfma_f32_16x16x32_bf16 v[56:59], a[164:167], v[20:23], v[56:59]
buffer_load_dwordx4 v6, s[8:11], s50 offen offset:1920 lds
v_mfma_f32_16x16x32_bf16 v[60:63], a[160:163], v[24:27], v[60:63]
ds_read_b128 v[48:51], v9 offset:47104
v_mfma_f32_16x16x32_bf16 v[64:67], a[164:167], v[24:27], v[64:67]
s_waitcnt lgkmcnt(4)
v_mfma_f32_16x16x32_bf16 v[52:55], a[168:171], v[28:31], v[52:55]
ds_read_b128 v[20:23], v8 offset:49152
v_mfma_f32_16x16x32_bf16 v[56:59], a[172:175], v[28:31], v[56:59]
v_mfma_f32_16x16x32_bf16 v[60:63], a[168:171], v[32:35], v[60:63]
ds_read_b128 v[24:27], v8 offset:51200
v_mfma_f32_16x16x32_bf16 v[64:67], a[172:175], v[32:35], v[64:67]
v_cvt_pk_bf16_f32 v84, v68, v69
v_cvt_pk_bf16_f32 v85, v70, v71
s_waitcnt lgkmcnt(4)
v_mfma_f32_16x16x32_bf16 v[52:55], a[176:179], v[36:39], v[52:55]
ds_read_b128 v[28:31], v9 offset:49152
v_mfma_f32_16x16x32_bf16 v[56:59], a[180:183], v[36:39], v[56:59]
v_mfma_f32_16x16x32_bf16 v[60:63], a[176:179], v[40:43], v[60:63]
ds_read_b128 v[32:35], v9 offset:51200
v_mfma_f32_16x16x32_bf16 v[64:67], a[180:183], v[40:43], v[64:67]
v_cvt_pk_bf16_f32 v86, v72, v73
v_cvt_pk_bf16_f32 v87, v74, v75
s_waitcnt lgkmcnt(4)
v_mfma_f32_16x16x32_bf16 v[52:55], a[184:187], v[44:47], v[52:55]
ds_read_b128 v[36:39], v8 offset:53248
v_mfma_f32_16x16x32_bf16 v[56:59], a[188:191], v[44:47], v[56:59]
v_mfma_f32_16x16x32_bf16 v[60:63], a[184:187], v[48:51], v[60:63]
ds_read_b128 v[40:43], v8 offset:55296
v_mfma_f32_16x16x32_bf16 v[64:67], a[188:191], v[48:51], v[64:67]
v_cvt_pk_bf16_f32 v88, v76, v77
v_cvt_pk_bf16_f32 v89, v78, v79
s_waitcnt lgkmcnt(4)
v_mfma_f32_16x16x32_bf16 v[52:55], a[192:195], v[20:23], v[52:55]
ds_read_b128 v[44:47], v9 offset:53248
v_mfma_f32_16x16x32_bf16 v[56:59], a[196:199], v[20:23], v[56:59]
v_mfma_f32_16x16x32_bf16 v[60:63], a[192:195], v[24:27], v[60:63]
ds_read_b128 v[48:51], v9 offset:55296
v_mfma_f32_16x16x32_bf16 v[64:67], a[196:199], v[24:27], v[64:67]
v_cvt_pk_bf16_f32 v90, v80, v81
v_cvt_pk_bf16_f32 v91, v82, v83
s_waitcnt lgkmcnt(4)
v_mfma_f32_16x16x32_bf16 v[52:55], a[200:203], v[28:31], v[52:55]
ds_read_b128 v[20:23], v8 offset:57344
v_mfma_f32_16x16x32_bf16 v[56:59], a[204:207], v[28:31], v[56:59]
v_mfma_f32_16x16x32_bf16 v[60:63], a[200:203], v[32:35], v[60:63]
ds_read_b128 v[24:27], v8 offset:59392
v_mfma_f32_16x16x32_bf16 v[64:67], a[204:207], v[32:35], v[64:67]
s_waitcnt lgkmcnt(4)
v_mfma_f32_16x16x32_bf16 v[52:55], a[208:211], v[36:39], v[52:55]
ds_read_b128 v[28:31], v9 offset:57344
v_mfma_f32_16x16x32_bf16 v[56:59], a[212:215], v[36:39], v[56:59]
v_mfma_f32_16x16x32_bf16 v[60:63], a[208:211], v[40:43], v[60:63]
ds_read_b128 v[32:35], v9 offset:59392
v_mfma_f32_16x16x32_bf16 v[64:67], a[212:215], v[40:43], v[64:67]
s_waitcnt lgkmcnt(4)
v_mfma_f32_16x16x32_bf16 v[52:55], a[216:219], v[44:47], v[52:55]
ds_read_b128 v[36:39], v8 offset:61440
v_mfma_f32_16x16x32_bf16 v[56:59], a[220:223], v[44:47], v[56:59]
s_waitcnt vmcnt(6)
v_readfirstlane_b32 s56, v100
s_cmp_eq_u32 s30, 1
s_cbranch_scc1 mega_kernel_q_kf0
s_cmp_gt_i32 s56, s42
s_cbranch_scc0 mega_kernel_q_kf0
s_mov_b32 s30, 1
s_mov_b32 m0, s61
s_nop 0
buffer_load_dwordx4 v5, s[84:87], s68 offen sc1 lds
mega_kernel_q_kf0:
v_mfma_f32_16x16x32_bf16 v[60:63], a[216:219], v[48:51], v[60:63]
ds_read_b128 v[40:43], v8 offset:63488
v_mfma_f32_16x16x32_bf16 v[64:67], a[220:223], v[48:51], v[64:67]
s_waitcnt lgkmcnt(4)
v_mfma_f32_16x16x32_bf16 v[52:55], a[224:227], v[20:23], v[52:55]
ds_read_b128 v[44:47], v9 offset:61440
v_mfma_f32_16x16x32_bf16 v[56:59], a[228:231], v[20:23], v[56:59]
v_mfma_f32_16x16x32_bf16 v[60:63], a[224:227], v[24:27], v[60:63]
ds_read_b128 v[48:51], v9 offset:63488
v_mfma_f32_16x16x32_bf16 v[64:67], a[228:231], v[24:27], v[64:67]
s_waitcnt lgkmcnt(5)
v_mfma_f32_16x16x32_bf16 v[52:55], a[232:235], v[28:31], v[52:55]
v_mfma_f32_16x16x32_bf16 v[56:59], a[236:239], v[28:31], v[56:59]
s_waitcnt lgkmcnt(4)
v_mfma_f32_16x16x32_bf16 v[60:63], a[232:235], v[32:35], v[60:63]
v_mfma_f32_16x16x32_bf16 v[64:67], a[236:239], v[32:35], v[64:67]
s_waitcnt lgkmcnt(3)
v_mfma_f32_16x16x32_bf16 v[52:55], a[240:243], v[36:39], v[52:55]
v_mfma_f32_16x16x32_bf16 v[56:59], a[244:247], v[36:39], v[56:59]
s_waitcnt lgkmcnt(2)
v_mfma_f32_16x16x32_bf16 v[60:63], a[240:243], v[40:43], v[60:63]
v_mfma_f32_16x16x32_bf16 v[64:67], a[244:247], v[40:43], v[64:67]
ds_write_b128 v101, v[84:87]
ds_write_b128 v101, v[88:91] offset:1024
s_waitcnt lgkmcnt(1)
v_mfma_f32_16x16x32_bf16 v[68:71], a[248:251], v[44:47], v[52:55]
v_mfma_f32_16x16x32_bf16 v[72:75], a[252:255], v[44:47], v[56:59]
s_waitcnt lgkmcnt(0)
v_mfma_f32_16x16x32_bf16 v[76:79], a[248:251], v[48:51], v[60:63]
v_mfma_f32_16x16x32_bf16 v[80:83], a[252:255], v[48:51], v[64:67]
s_cmp_eq_u32 s30, 1
s_cbranch_scc1 mega_kernel_q_kl0
mega_kernel_q_kw0:
v_mov_b32 v100, 0
s_mov_b64 exec, 1
buffer_atomic_add v100, v16, s[84:87], s62 offen sc0 sc1
s_mov_b64 exec, -1
s_waitcnt vmcnt(0)
v_readfirstlane_b32 s56, v100
s_cmp_gt_i32 s56, s42
s_cbranch_scc0 mega_kernel_q_kw0
s_mov_b32 m0, s61
s_nop 0
buffer_load_dwordx4 v5, s[84:87], s68 offen sc1 lds
mega_kernel_q_kl0:
s_waitcnt lgkmcnt(0) vmcnt(0)
s_barrier
ds_read_b128 v[184:187], v102 offset:0
ds_read_b128 v[112:115], v103 offset:0
ds_read_b128 v[128:131], v103 offset:1024
ds_read_b128 v[188:191], v102 offset:2048
ds_read_b128 v[116:119], v103 offset:2048
ds_read_b128 v[132:135], v103 offset:3072
ds_read_b128 v[192:195], v102 offset:4096
ds_read_b128 v[120:123], v103 offset:4096
ds_read_b128 v[136:139], v103 offset:5120
ds_read_b128 v[196:199], v102 offset:6144
ds_read_b128 v[124:127], v103 offset:6144
ds_read_b128 v[140:143], v103 offset:7168
s_waitcnt lgkmcnt(9)
v_mfma_f32_16x16x32_bf16 v[200:203], v[112:115], v[184:187], 0
v_mfma_f32_16x16x32_bf16 v[204:207], v[128:131], v[184:187], 0
ds_read_b128 v[160:163], v94 offset:0
s_waitcnt lgkmcnt(7)
v_mfma_f32_16x16x32_bf16 v[200:203], v[116:119], v[188:191], v[200:203]
v_mfma_f32_16x16x32_bf16 v[204:207], v[132:135], v[188:191], v[204:207]
ds_read_b128 v[164:167], v94 offset:1024
s_waitcnt lgkmcnt(5)
v_mfma_f32_16x16x32_bf16 v[200:203], v[120:123], v[192:195], v[200:203]
v_mfma_f32_16x16x32_bf16 v[204:207], v[136:139], v[192:195], v[204:207]
ds_read_b128 v[168:171], v94 offset:2048
s_waitcnt lgkmcnt(3)
v_mfma_f32_16x16x32_bf16 v[200:203], v[124:127], v[196:199], v[200:203]
v_mfma_f32_16x16x32_bf16 v[204:207], v[140:143], v[196:199], v[204:207]
ds_read_b128 v[172:175], v94 offset:3072
s_waitcnt lgkmcnt(3)
v_mfma_f32_16x16x32_bf16 v[208:211], v[160:163], v[184:187], 0
ds_read_b128 v[144:147], v240 offset:0
ds_read_b64 v[176:177], v95 offset:0
s_waitcnt lgkmcnt(4)
v_mfma_f32_16x16x32_bf16 v[208:211], v[164:167], v[188:191], v[208:211]
ds_read_b128 v[148:151], v240 offset:1024
ds_read_b64 v[178:179], v95 offset:256
s_waitcnt lgkmcnt(5)
v_mfma_f32_16x16x32_bf16 v[208:211], v[168:171], v[192:195], v[208:211]
ds_read_b128 v[152:155], v240 offset:2048
ds_read_b64 v[180:181], v95 offset:1024
s_waitcnt lgkmcnt(6)
v_mfma_f32_16x16x32_bf16 v[208:211], v[172:175], v[196:199], v[208:211]
ds_read_b128 v[156:159], v240 offset:3072
ds_read_b64 v[182:183], v95 offset:1280
s_nop 3
v_cndmask_b32 v200, v200, v97, s[12:13]
v_cndmask_b32 v201, v201, v97, s[14:15]
v_cndmask_b32 v202, v202, v97, s[16:17]
v_cndmask_b32 v203, v203, v97, s[18:19]
v_cndmask_b32 v204, v204, v97, s[20:21]
v_cndmask_b32 v205, v205, v97, s[22:23]
v_cndmask_b32 v206, v206, v97, s[24:25]
v_cndmask_b32 v207, v207, v97, s[26:27]
v_cndmask_b32 v208, v208, v97, s[28:29]
v_cndmask_b32 v209, v209, v97, s[28:29]
v_cndmask_b32 v210, v210, v97, s[28:29]
v_cndmask_b32 v211, v211, v97, s[28:29]
v_max3_f32 v236, v200, v201, v202
v_max3_f32 v236, v236, v203, v204
v_max3_f32 v236, v236, v205, v206
v_max3_f32 v236, v236, v207, v208
v_max3_f32 v236, v236, v209, v210
v_max_f32 v237, v236, v211
v_max_f32 v236, v236, v211
s_nop 1
v_permlane16_swap_b32 v236, v237
s_nop 0
v_max_f32 v238, v236, v237
v_max_f32 v239, v236, v237
s_nop 1
v_permlane32_swap_b32 v238, v239
s_nop 0
v_max_f32 v236, v238, v239
v_mul_f32 v236, s54, v236
v_pk_fma_f32 v[200:201], v[200:201], s[54:55], v[236:237] op_sel_hi:[1,0,0] neg_lo:[0,0,1] neg_hi:[0,0,1]
v_pk_fma_f32 v[202:203], v[202:203], s[54:55], v[236:237] op_sel_hi:[1,0,0] neg_lo:[0,0,1] neg_hi:[0,0,1]
v_pk_fma_f32 v[204:205], v[204:205], s[54:55], v[236:237] op_sel_hi:[1,0,0] neg_lo:[0,0,1] neg_hi:[0,0,1]
v_pk_fma_f32 v[206:207], v[206:207], s[54:55], v[236:237] op_sel_hi:[1,0,0] neg_lo:[0,0,1] neg_hi:[0,0,1]
v_pk_fma_f32 v[208:209], v[208:209], s[54:55], v[236:237] op_sel_hi:[1,0,0] neg_lo:[0,0,1] neg_hi:[0,0,1]
v_pk_fma_f32 v[210:211], v[210:211], s[54:55], v[236:237] op_sel_hi:[1,0,0] neg_lo:[0,0,1] neg_hi:[0,0,1]
v_exp_f32 v200, v200
v_exp_f32 v201, v201
v_exp_f32 v202, v202
v_exp_f32 v203, v203
v_exp_f32 v204, v204
v_exp_f32 v205, v205
v_exp_f32 v206, v206
v_exp_f32 v207, v207
v_exp_f32 v208, v208
v_exp_f32 v209, v209
v_exp_f32 v210, v210
v_exp_f32 v211, v211
s_nop 0
v_cvt_pk_bf16_f32 v212, v200, v201
v_cvt_pk_bf16_f32 v213, v202, v203
v_cvt_pk_bf16_f32 v214, v204, v205
v_cvt_pk_bf16_f32 v215, v206, v207
v_cvt_pk_bf16_f32 v216, v208, v209
v_cvt_pk_bf16_f32 v217, v210, v211
s_waitcnt lgkmcnt(0)
s_nop 0
v_mfma_f32_16x16x32_bf16 v[108:111], v[104:107], v[212:215], 0
v_mfma_f32_16x16x32_bf16 v[220:223], v[144:147], v[212:215], 0
v_mfma_f32_16x16x32_bf16 v[224:227], v[148:151], v[212:215], 0
v_mfma_f32_16x16x32_bf16 v[228:231], v[152:155], v[212:215], 0
v_mfma_f32_16x16x32_bf16 v[232:235], v[156:159], v[212:215], 0
v_mfma_f32_16x16x16_bf16 v[108:111], v[104:105], v[216:217], v[108:111]
v_mfma_f32_16x16x16_bf16 v[220:223], v[176:177], v[216:217], v[220:223]
v_mfma_f32_16x16x16_bf16 v[224:227], v[178:179], v[216:217], v[224:227]
v_mfma_f32_16x16x16_bf16 v[228:231], v[180:181], v[216:217], v[228:231]
v_mfma_f32_16x16x16_bf16 v[232:235], v[182:183], v[216:217], v[232:235]
s_lshl_b32 s51, s42, 18
s_nop 2
v_rcp_f32 v238, v108
v_rcp_f32 v239, v109
s_nop 1
v_pk_mul_f32 v[220:221], v[220:221], v[238:239]
v_pk_mul_f32 v[222:223], v[222:223], v[238:239]
v_pk_mul_f32 v[224:225], v[224:225], v[238:239]
v_pk_mul_f32 v[226:227], v[226:227], v[238:239]
v_pk_mul_f32 v[228:229], v[228:229], v[238:239]
v_pk_mul_f32 v[230:231], v[230:231], v[238:239]
v_pk_mul_f32 v[232:233], v[232:233], v[238:239]
v_pk_mul_f32 v[234:235], v[234:235], v[238:239]
v_cvt_pk_bf16_f32 v200, v220, v221
v_cvt_pk_bf16_f32 v201, v222, v223
v_cvt_pk_bf16_f32 v202, v224, v225
v_cvt_pk_bf16_f32 v203, v226, v227
v_cvt_pk_bf16_f32 v204, v228, v229
v_cvt_pk_bf16_f32 v205, v230, v231
v_cvt_pk_bf16_f32 v206, v232, v233
v_cvt_pk_bf16_f32 v207, v234, v235
buffer_store_dwordx4 v[200:203], v96, s[84:87], s51 offen sc1
buffer_store_dwordx4 v[204:207], v96, s[84:87], s51 offen offset:2048 sc1
s_add_u32 s42, s42, 1
s_branch mega_kernel_q_loop
mega_kernel_q_last:
s_barrier
s_cmp_gt_i32 s55, s42
s_cbranch_scc1 mega_kernel_q_kv2k
mega_kernel_q_kv2w:
buffer_load_dword v2, v99, s[84:87], 0 offen sc1
s_waitcnt vmcnt(0)
v_min_i32_dpp v2, v2, v2 quad_perm:[1,0,3,2] row_mask:0xf bank_mask:0xf
s_nop 1
v_min_i32_dpp v2, v2, v2 quad_perm:[2,3,0,1] row_mask:0xf bank_mask:0xf
s_nop 1
v_min_i32_dpp v2, v2, v2 row_ror:4 row_mask:0xf bank_mask:0xf
s_nop 0
v_readfirstlane_b32 s55, v2
s_cmp_gt_i32 s55, s42
s_cbranch_scc1 mega_kernel_q_kv2k
s_sleep 4
s_branch mega_kernel_q_kv2w
mega_kernel_q_kv2k:
s_add_u32 s51, s47, s42
s_bfe_u32 s57, s51, 0x40002
s_lshl_b32 s57, s57, 14
s_and_b32 s66, s51, 3
s_lshl_b32 s66, s66, 11
s_add_u32 s66, s66, s57
s_add_u32 s66, s66, s58
s_add_u32 s67, s66, 33554432
s_bfe_u32 s57, s51, 0x30003
s_lshl_b32 s57, s57, 14
s_and_b32 s68, s51, 7
s_lshl_b32 s68, s68, 10
s_add_u32 s68, s68, s57
s_add_u32 s68, s68, s59
s_add_u32 s50, s42, 2
s_min_u32 s50, s50, 63
s_lshl_b32 s50, s50, 16
s_cmp_gt_i32 s56, s42
s_cselect_b32 s30, 1, 0
s_add_u32 m0, s60, 0
s_nop 0
buffer_load_dwordx4 v5, s[84:87], s66 offen offset:0 sc1 lds
s_add_u32 m0, s60, 0
s_nop 0
buffer_load_dwordx4 v5, s[84:87], s66 offen offset:1024 sc1 lds
s_add_u32 m0, s60, 8192
s_nop 0
buffer_load_dwordx4 v5, s[84:87], s67 offen offset:0 sc1 lds
s_add_u32 m0, s60, 8192
s_nop 0
buffer_load_dwordx4 v5, s[84:87], s67 offen offset:1024 sc1 lds
s_cmp_eq_u32 s30, 1
s_cbranch_scc0 mega_kernel_q_ke2
s_mov_b32 m0, s61
s_nop 0
buffer_load_dwordx4 v5, s[84:87], s68 offen sc1 lds
mega_kernel_q_ke2:
v_cvt_pk_bf16_f32 v84, v68, v69
v_cvt_pk_bf16_f32 v85, v70, v71
v_cvt_pk_bf16_f32 v86, v72, v73
v_cvt_pk_bf16_f32 v87, v74, v75
v_cvt_pk_bf16_f32 v88, v76, v77
v_cvt_pk_bf16_f32 v89, v78, v79
v_cvt_pk_bf16_f32 v90, v80, v81
v_cvt_pk_bf16_f32 v91, v82, v83
ds_write_b128 v101, v[84:87]
ds_write_b128 v101, v[88:91] offset:1024
s_waitcnt vmcnt(4)
v_mov_b32 v17, s42
s_mov_b64 exec, 1
buffer_store_dword v17, v16, s[84:87], s49 offen sc1
s_mov_b64 exec, -1
s_cmp_eq_u32 s30, 1
s_cbranch_scc1 mega_kernel_q_kl2
mega_kernel_q_kw2:
v_mov_b32 v100, 0
s_mov_b64 exec, 1
buffer_atomic_add v100, v16, s[84:87], s62 offen sc0 sc1
s_mov_b64 exec, -1
s_waitcnt vmcnt(0)
v_readfirstlane_b32 s56, v100
s_cmp_gt_i32 s56, s42
s_cbranch_scc0 mega_kernel_q_kw2
s_mov_b32 m0, s61
s_nop 0
buffer_load_dwordx4 v5, s[84:87], s68 offen sc1 lds
mega_kernel_q_kl2:
s_waitcnt lgkmcnt(0) vmcnt(0)
s_barrier
ds_read_b128 v[184:187], v102 offset:0
ds_read_b128 v[112:115], v103 offset:0
ds_read_b128 v[128:131], v103 offset:1024
ds_read_b128 v[188:191], v102 offset:2048
ds_read_b128 v[116:119], v103 offset:2048
ds_read_b128 v[132:135], v103 offset:3072
ds_read_b128 v[192:195], v102 offset:4096
ds_read_b128 v[120:123], v103 offset:4096
ds_read_b128 v[136:139], v103 offset:5120
ds_read_b128 v[196:199], v102 offset:6144
ds_read_b128 v[124:127], v103 offset:6144
ds_read_b128 v[140:143], v103 offset:7168
s_waitcnt lgkmcnt(9)
v_mfma_f32_16x16x32_bf16 v[200:203], v[112:115], v[184:187], 0
v_mfma_f32_16x16x32_bf16 v[204:207], v[128:131], v[184:187], 0
ds_read_b128 v[160:163], v94 offset:0
s_waitcnt lgkmcnt(7)
v_mfma_f32_16x16x32_bf16 v[200:203], v[116:119], v[188:191], v[200:203]
v_mfma_f32_16x16x32_bf16 v[204:207], v[132:135], v[188:191], v[204:207]
ds_read_b128 v[164:167], v94 offset:1024
s_waitcnt lgkmcnt(5)
v_mfma_f32_16x16x32_bf16 v[200:203], v[120:123], v[192:195], v[200:203]
v_mfma_f32_16x16x32_bf16 v[204:207], v[136:139], v[192:195], v[204:207]
ds_read_b128 v[168:171], v94 offset:2048
s_waitcnt lgkmcnt(3)
v_mfma_f32_16x16x32_bf16 v[200:203], v[124:127], v[196:199], v[200:203]
v_mfma_f32_16x16x32_bf16 v[204:207], v[140:143], v[196:199], v[204:207]
ds_read_b128 v[172:175], v94 offset:3072
s_waitcnt lgkmcnt(3)
v_mfma_f32_16x16x32_bf16 v[208:211], v[160:163], v[184:187], 0
ds_read_b128 v[144:147], v240 offset:0
ds_read_b64 v[176:177], v95 offset:0
s_waitcnt lgkmcnt(4)
v_mfma_f32_16x16x32_bf16 v[208:211], v[164:167], v[188:191], v[208:211]
ds_read_b128 v[148:151], v240 offset:1024
ds_read_b64 v[178:179], v95 offset:256
s_waitcnt lgkmcnt(5)
v_mfma_f32_16x16x32_bf16 v[208:211], v[168:171], v[192:195], v[208:211]
ds_read_b128 v[152:155], v240 offset:2048
ds_read_b64 v[180:181], v95 offset:1024
s_waitcnt lgkmcnt(6)
v_mfma_f32_16x16x32_bf16 v[208:211], v[172:175], v[196:199], v[208:211]
ds_read_b128 v[156:159], v240 offset:3072
ds_read_b64 v[182:183], v95 offset:1280
s_nop 3
v_cndmask_b32 v200, v200, v97, s[12:13]
v_cndmask_b32 v201, v201, v97, s[14:15]
v_cndmask_b32 v202, v202, v97, s[16:17]
v_cndmask_b32 v203, v203, v97, s[18:19]
v_cndmask_b32 v204, v204, v97, s[20:21]
v_cndmask_b32 v205, v205, v97, s[22:23]
v_cndmask_b32 v206, v206, v97, s[24:25]
v_cndmask_b32 v207, v207, v97, s[26:27]
v_cndmask_b32 v208, v208, v97, s[28:29]
v_cndmask_b32 v209, v209, v97, s[28:29]
v_cndmask_b32 v210, v210, v97, s[28:29]
v_cndmask_b32 v211, v211, v97, s[28:29]
v_max3_f32 v236, v200, v201, v202
v_max3_f32 v236, v236, v203, v204
v_max3_f32 v236, v236, v205, v206
v_max3_f32 v236, v236, v207, v208
v_max3_f32 v236, v236, v209, v210
v_max_f32 v237, v236, v211
v_max_f32 v236, v236, v211
s_nop 1
v_permlane16_swap_b32 v236, v237
s_nop 0
v_max_f32 v238, v236, v237
v_max_f32 v239, v236, v237
s_nop 1
v_permlane32_swap_b32 v238, v239
s_nop 0
v_max_f32 v236, v238, v239
v_mul_f32 v236, s54, v236
v_pk_fma_f32 v[200:201], v[200:201], s[54:55], v[236:237] op_sel_hi:[1,0,0] neg_lo:[0,0,1] neg_hi:[0,0,1]
v_pk_fma_f32 v[202:203], v[202:203], s[54:55], v[236:237] op_sel_hi:[1,0,0] neg_lo:[0,0,1] neg_hi:[0,0,1]
v_pk_fma_f32 v[204:205], v[204:205], s[54:55], v[236:237] op_sel_hi:[1,0,0] neg_lo:[0,0,1] neg_hi:[0,0,1]
v_pk_fma_f32 v[206:207], v[206:207], s[54:55], v[236:237] op_sel_hi:[1,0,0] neg_lo:[0,0,1] neg_hi:[0,0,1]
v_pk_fma_f32 v[208:209], v[208:209], s[54:55], v[236:237] op_sel_hi:[1,0,0] neg_lo:[0,0,1] neg_hi:[0,0,1]
v_pk_fma_f32 v[210:211], v[210:211], s[54:55], v[236:237] op_sel_hi:[1,0,0] neg_lo:[0,0,1] neg_hi:[0,0,1]
v_exp_f32 v200, v200
v_exp_f32 v201, v201
v_exp_f32 v202, v202
v_exp_f32 v203, v203
v_exp_f32 v204, v204
v_exp_f32 v205, v205
v_exp_f32 v206, v206
v_exp_f32 v207, v207
v_exp_f32 v208, v208
v_exp_f32 v209, v209
v_exp_f32 v210, v210
v_exp_f32 v211, v211
s_nop 0
v_cvt_pk_bf16_f32 v212, v200, v201
v_cvt_pk_bf16_f32 v213, v202, v203
v_cvt_pk_bf16_f32 v214, v204, v205
v_cvt_pk_bf16_f32 v215, v206, v207
v_cvt_pk_bf16_f32 v216, v208, v209
v_cvt_pk_bf16_f32 v217, v210, v211
s_waitcnt lgkmcnt(0)
s_nop 0
v_mfma_f32_16x16x32_bf16 v[108:111], v[104:107], v[212:215], 0
v_mfma_f32_16x16x32_bf16 v[220:223], v[144:147], v[212:215], 0
v_mfma_f32_16x16x32_bf16 v[224:227], v[148:151], v[212:215], 0
v_mfma_f32_16x16x32_bf16 v[228:231], v[152:155], v[212:215], 0
v_mfma_f32_16x16x32_bf16 v[232:235], v[156:159], v[212:215], 0
v_mfma_f32_16x16x16_bf16 v[108:111], v[104:105], v[216:217], v[108:111]
v_mfma_f32_16x16x16_bf16 v[220:223], v[176:177], v[216:217], v[220:223]
v_mfma_f32_16x16x16_bf16 v[224:227], v[178:179], v[216:217], v[224:227]
v_mfma_f32_16x16x16_bf16 v[228:231], v[180:181], v[216:217], v[228:231]
v_mfma_f32_16x16x16_bf16 v[232:235], v[182:183], v[216:217], v[232:235]
s_lshl_b32 s51, s42, 18
s_nop 2
v_rcp_f32 v238, v108
v_rcp_f32 v239, v109
s_nop 1
v_pk_mul_f32 v[220:221], v[220:221], v[238:239]
v_pk_mul_f32 v[222:223], v[222:223], v[238:239]
v_pk_mul_f32 v[224:225], v[224:225], v[238:239]
v_pk_mul_f32 v[226:227], v[226:227], v[238:239]
v_pk_mul_f32 v[228:229], v[228:229], v[238:239]
v_pk_mul_f32 v[230:231], v[230:231], v[238:239]
v_pk_mul_f32 v[232:233], v[232:233], v[238:239]
v_pk_mul_f32 v[234:235], v[234:235], v[238:239]
v_cvt_pk_bf16_f32 v200, v220, v221
v_cvt_pk_bf16_f32 v201, v222, v223
v_cvt_pk_bf16_f32 v202, v224, v225
v_cvt_pk_bf16_f32 v203, v226, v227
v_cvt_pk_bf16_f32 v204, v228, v229
v_cvt_pk_bf16_f32 v205, v230, v231
v_cvt_pk_bf16_f32 v206, v232, v233
v_cvt_pk_bf16_f32 v207, v234, v235
buffer_store_dwordx4 v[200:203], v96, s[84:87], s51 offen sc1
buffer_store_dwordx4 v[204:207], v96, s[84:87], s51 offen offset:2048 sc1
s_add_u32 s42, s42, 1
s_waitcnt vmcnt(0)
v_mov_b32 v17, s42
s_mov_b64 exec, 1
buffer_store_dword v17, v16, s[84:87], s49 offen sc1
s_mov_b64 exec, -1
mega_kernel_q_quit:
s_endpgm
mega_kernel_rd:
s_mov_b32 s93, s40
s_load_dwordx2 s[4:5], s[0:1], 56
s_mov_b32 s48, 0x3f7ec46d
s_mov_b32 s49, 0x3dc8bd36
s_mov_b32 s50, 0x3f7b14be
s_mov_b32 s51, 0x3e47c5c2
s_mov_b32 s52, 0x3f74fa0b
s_mov_b32 s53, 0x3e94a031
s_mov_b32 s54, 0x3f6c835e
s_mov_b32 s55, 0x3ec3ef15
s_mov_b32 s56, 0x3f61c598
s_mov_b32 s57, 0x3ef15aea
s_mov_b32 s58, 0x3f54db31
s_mov_b32 s59, 0x3f0e39da
s_mov_b32 s60, 0x3f45e403
s_mov_b32 s61, 0x3f226799
s_mov_b32 s62, 0x3f3504f3
s_mov_b32 s63, 0x3f3504f3
v_and_b32 v1, 31, v0
v_lshrrev_b32 v2, 5, v0
v_cvt_f32_u32 v3, v1
v_mul_u32_u24 v10, 8448, v2
v_lshl_add_u32 v4, v1, 3, v10
v_mul_u32_u24 v5, 264, v1
v_add_u32 v5, v5, v10
v_and_b32 v11, 7, v0
v_lshrrev_b32 v9, 3, v0
v_mul_u32_u24 v10, 8448, v11
v_lshl_add_u32 v6, v9, 3, v10
v_lshlrev_b32 v7, 3, v9
v_sub_u32 v7, v10, v7
v_add_u32 v7, 4096, v7
v_lshlrev_b32 v8, 14, v9
v_lshl_add_u32 v8, v11, 4, v8
v_mul_f32 v12, 0xba800000, v3
v_cos_f32 v82, v12
v_sin_f32 v83, v12
v_mul_f32 v12, 0xbb000000, v3
v_cos_f32 v84, v12
v_sin_f32 v85, v12
v_mul_f32 v12, 0xbb400000, v3
v_cos_f32 v86, v12
v_sin_f32 v87, v12
v_mul_f32 v12, 0xbb800000, v3
v_cos_f32 v88, v12
v_sin_f32 v89, v12
v_mul_f32 v12, 0xbba00000, v3
v_cos_f32 v90, v12
v_sin_f32 v91, v12
v_mul_f32 v12, 0xbbc00000, v3
v_cos_f32 v92, v12
v_sin_f32 v93, v12
v_mul_f32 v12, 0xbbe00000, v3
v_cos_f32 v94, v12
v_sin_f32 v95, v12
v_mul_f32 v12, 0xbc000000, v3
v_cos_f32 v96, v12
v_sin_f32 v97, v12
v_mul_f32 v12, 0xbc100000, v3
v_cos_f32 v98, v12
v_sin_f32 v99, v12
v_mul_f32 v12, 0xbc200000, v3
v_cos_f32 v100, v12
v_sin_f32 v101, v12
v_mul_f32 v12, 0xbc300000, v3
v_cos_f32 v102, v12
v_sin_f32 v103, v12
v_mul_f32 v12, 0xbc400000, v3
v_cos_f32 v104, v12
v_sin_f32 v105, v12
v_mul_f32 v12, 0xbc500000, v3
v_cos_f32 v106, v12
v_sin_f32 v107, v12
v_mul_f32 v12, 0xbc600000, v3
v_cos_f32 v108, v12
v_sin_f32 v109, v12
v_mul_f32 v12, 0xbc700000, v3
v_cos_f32 v110, v12
v_sin_f32 v111, v12
v_mul_f32 v12, 0xbc800000, v3
v_cos_f32 v112, v12
v_sin_f32 v113, v12
v_mul_f32 v12, 0xbc880000, v3
v_cos_f32 v114, v12
v_sin_f32 v115, v12
v_mul_f32 v12, 0xbc900000, v3
v_cos_f32 v116, v12
v_sin_f32 v117, v12
v_mul_f32 v12, 0xbc980000, v3
v_cos_f32 v118, v12
v_sin_f32 v119, v12
v_mul_f32 v12, 0xbca00000, v3
v_cos_f32 v120, v12
v_sin_f32 v121, v12
v_mul_f32 v12, 0xbca80000, v3
v_cos_f32 v122, v12
v_sin_f32 v123, v12
v_mul_f32 v12, 0xbcb00000, v3
v_cos_f32 v124, v12
v_sin_f32 v125, v12
v_mul_f32 v12, 0xbcb80000, v3
v_cos_f32 v126, v12
v_sin_f32 v127, v12
v_mul_f32 v12, 0xbcc00000, v3
v_cos_f32 v128, v12
v_sin_f32 v129, v12
v_mul_f32 v12, 0xbcc80000, v3
v_cos_f32 v130, v12
v_sin_f32 v131, v12
v_mul_f32 v12, 0xbcd00000, v3
v_cos_f32 v132, v12
v_sin_f32 v133, v12
v_mul_f32 v12, 0xbcd80000, v3
v_cos_f32 v134, v12
v_sin_f32 v135, v12
v_mul_f32 v12, 0xbce00000, v3
v_cos_f32 v136, v12
v_sin_f32 v137, v12
v_mul_f32 v12, 0xbce80000, v3
v_cos_f32 v138, v12
v_sin_f32 v139, v12
v_mul_f32 v12, 0xbcf00000, v3
v_cos_f32 v140, v12
v_sin_f32 v141, v12
v_mul_f32 v12, 0xbcf80000, v3
v_cos_f32 v142, v12
v_sin_f32 v143, v12
v_lshlrev_b32 v12, 12, v2
v_lshl_add_u32 v12, v1, 1, v12
s_waitcnt lgkmcnt(0)
s_mov_b32 s6, 4194304
s_mov_b32 s7, 0x00020000
v_mov_b32 v144, 0
v_mov_b32 v145, 0
v_mov_b32 v146, 0
v_mov_b32 v147, 0
v_mov_b32 v148, 0
v_mov_b32 v149, 0
v_mov_b32 v150, 0
v_mov_b32 v151, 0
v_mov_b32 v152, 0
v_mov_b32 v153, 0
v_mov_b32 v154, 0
v_mov_b32 v155, 0
v_mov_b32 v156, 0
v_mov_b32 v157, 0
v_mov_b32 v158, 0
v_mov_b32 v159, 0
v_mov_b32 v160, 0
v_mov_b32 v161, 0
v_mov_b32 v162, 0
v_mov_b32 v163, 0
v_mov_b32 v164, 0
v_mov_b32 v165, 0
v_mov_b32 v166, 0
v_mov_b32 v167, 0
v_mov_b32 v168, 0
v_mov_b32 v169, 0
v_mov_b32 v170, 0
v_mov_b32 v171, 0
v_mov_b32 v172, 0
v_mov_b32 v173, 0
v_mov_b32 v174, 0
v_mov_b32 v175, 0
v_mov_b32 v176, 0
v_mov_b32 v177, 0
v_mov_b32 v178, 0
v_mov_b32 v179, 0
v_mov_b32 v180, 0
v_mov_b32 v181, 0
v_mov_b32 v182, 0
v_mov_b32 v183, 0
v_mov_b32 v184, 0
v_mov_b32 v185, 0
v_mov_b32 v186, 0
v_mov_b32 v187, 0
v_mov_b32 v188, 0
v_mov_b32 v189, 0
v_mov_b32 v190, 0
v_mov_b32 v191, 0
v_mov_b32 v192, 0
v_mov_b32 v193, 0
v_mov_b32 v194, 0
v_mov_b32 v195, 0
v_mov_b32 v196, 0
v_mov_b32 v197, 0
v_mov_b32 v198, 0
v_mov_b32 v199, 0
v_mov_b32 v200, 0
v_mov_b32 v201, 0
v_mov_b32 v202, 0
v_mov_b32 v203, 0
v_mov_b32 v204, 0
v_mov_b32 v205, 0
v_mov_b32 v206, 0
v_mov_b32 v207, 0
s_cmp_lt_u32 s93, 128
s_cbranch_scc0 mega_kernel_f1_e
s_lshl_b32 s12, s93, 15
buffer_load_short_d16_hi v144, v12, s[4:7], s12 offen offset:0
buffer_load_short_d16_hi v145, v12, s[4:7], s12 offen offset:2048
buffer_load_short_d16_hi v176, v12, s[4:7], s12 offen offset:1024
buffer_load_short_d16_hi v177, v12, s[4:7], s12 offen offset:3072
buffer_load_short_d16_hi v146, v12, s[4:7], s12 offen offset:64
buffer_load_short_d16_hi v147, v12, s[4:7], s12 offen offset:2112
buffer_load_short_d16_hi v178, v12, s[4:7], s12 offen offset:1088
buffer_load_short_d16_hi v179, v12, s[4:7], s12 offen offset:3136
buffer_load_short_d16_hi v148, v12, s[4:7], s12 offen offset:128
buffer_load_short_d16_hi v149, v12, s[4:7], s12 offen offset:2176
buffer_load_short_d16_hi v180, v12, s[4:7], s12 offen offset:1152
buffer_load_short_d16_hi v181, v12, s[4:7], s12 offen offset:3200
buffer_load_short_d16_hi v150, v12, s[4:7], s12 offen offset:192
buffer_load_short_d16_hi v151, v12, s[4:7], s12 offen offset:2240
buffer_load_short_d16_hi v182, v12, s[4:7], s12 offen offset:1216
buffer_load_short_d16_hi v183, v12, s[4:7], s12 offen offset:3264
buffer_load_short_d16_hi v152, v12, s[4:7], s12 offen offset:256
buffer_load_short_d16_hi v153, v12, s[4:7], s12 offen offset:2304
buffer_load_short_d16_hi v184, v12, s[4:7], s12 offen offset:1280
buffer_load_short_d16_hi v185, v12, s[4:7], s12 offen offset:3328
buffer_load_short_d16_hi v154, v12, s[4:7], s12 offen offset:320
buffer_load_short_d16_hi v155, v12, s[4:7], s12 offen offset:2368
buffer_load_short_d16_hi v186, v12, s[4:7], s12 offen offset:1344
buffer_load_short_d16_hi v187, v12, s[4:7], s12 offen offset:3392
buffer_load_short_d16_hi v156, v12, s[4:7], s12 offen offset:384
buffer_load_short_d16_hi v157, v12, s[4:7], s12 offen offset:2432
buffer_load_short_d16_hi v188, v12, s[4:7], s12 offen offset:1408
buffer_load_short_d16_hi v189, v12, s[4:7], s12 offen offset:3456
buffer_load_short_d16_hi v158, v12, s[4:7], s12 offen offset:448
buffer_load_short_d16_hi v159, v12, s[4:7], s12 offen offset:2496
buffer_load_short_d16_hi v190, v12, s[4:7], s12 offen offset:1472
buffer_load_short_d16_hi v191, v12, s[4:7], s12 offen offset:3520
buffer_load_short_d16_hi v160, v12, s[4:7], s12 offen offset:512
buffer_load_short_d16_hi v161, v12, s[4:7], s12 offen offset:2560
buffer_load_short_d16_hi v192, v12, s[4:7], s12 offen offset:1536
buffer_load_short_d16_hi v193, v12, s[4:7], s12 offen offset:3584
buffer_load_short_d16_hi v162, v12, s[4:7], s12 offen offset:576
buffer_load_short_d16_hi v163, v12, s[4:7], s12 offen offset:2624
buffer_load_short_d16_hi v194, v12, s[4:7], s12 offen offset:1600
buffer_load_short_d16_hi v195, v12, s[4:7], s12 offen offset:3648
buffer_load_short_d16_hi v164, v12, s[4:7], s12 offen offset:640
buffer_load_short_d16_hi v165, v12, s[4:7], s12 offen offset:2688
buffer_load_short_d16_hi v196, v12, s[4:7], s12 offen offset:1664
buffer_load_short_d16_hi v197, v12, s[4:7], s12 offen offset:3712
buffer_load_short_d16_hi v166, v12, s[4:7], s12 offen offset:704
buffer_load_short_d16_hi v167, v12, s[4:7], s12 offen offset:2752
buffer_load_short_d16_hi v198, v12, s[4:7], s12 offen offset:1728
buffer_load_short_d16_hi v199, v12, s[4:7], s12 offen offset:3776
buffer_load_short_d16_hi v168, v12, s[4:7], s12 offen offset:768
buffer_load_short_d16_hi v169, v12, s[4:7], s12 offen offset:2816
buffer_load_short_d16_hi v200, v12, s[4:7], s12 offen offset:1792
buffer_load_short_d16_hi v201, v12, s[4:7], s12 offen offset:3840
buffer_load_short_d16_hi v170, v12, s[4:7], s12 offen offset:832
buffer_load_short_d16_hi v171, v12, s[4:7], s12 offen offset:2880
buffer_load_short_d16_hi v202, v12, s[4:7], s12 offen offset:1856
buffer_load_short_d16_hi v203, v12, s[4:7], s12 offen offset:3904
buffer_load_short_d16_hi v172, v12, s[4:7], s12 offen offset:896
buffer_load_short_d16_hi v173, v12, s[4:7], s12 offen offset:2944
buffer_load_short_d16_hi v204, v12, s[4:7], s12 offen offset:1920
buffer_load_short_d16_hi v205, v12, s[4:7], s12 offen offset:3968
buffer_load_short_d16_hi v174, v12, s[4:7], s12 offen offset:960
buffer_load_short_d16_hi v175, v12, s[4:7], s12 offen offset:3008
buffer_load_short_d16_hi v206, v12, s[4:7], s12 offen offset:1984
buffer_load_short_d16_hi v207, v12, s[4:7], s12 offen offset:4032
s_waitcnt vmcnt(0)
mega_kernel_f1_l:
s_add_u32 s21, s93, 32
s_cmp_lt_u32 s21, 128
s_cselect_b32 s22, s21, s93
s_waitcnt vmcnt(17)
v_pk_add_f32 v[48:49], v[144:145], v[176:177] neg_lo:[0,1] neg_hi:[0,1]
v_pk_add_f32 v[16:17], v[144:145], v[176:177]
v_pk_add_f32 v[14:15], v[146:147], v[178:179] neg_lo:[0,1] neg_hi:[0,1]
v_pk_add_f32 v[18:19], v[146:147], v[178:179]
v_pk_mul_f32 v[50:51], v[14:15], s[50:51] op_sel:[0,0] op_sel_hi:[0,1] neg_lo:[0,0] neg_hi:[0,1]
v_pk_fma_f32 v[50:51], v[14:15], s[50:51], v[50:51] op_sel:[1,1,0] op_sel_hi:[1,0,1] neg_lo:[0,0,0] neg_hi:[0,0,0]
v_pk_add_f32 v[14:15], v[148:149], v[180:181] neg_lo:[0,1] neg_hi:[0,1]
v_pk_add_f32 v[20:21], v[148:149], v[180:181]
v_pk_mul_f32 v[52:53], v[14:15], s[54:55] op_sel:[0,0] op_sel_hi:[0,1] neg_lo:[0,0] neg_hi:[0,1]
v_pk_fma_f32 v[52:53], v[14:15], s[54:55], v[52:53] op_sel:[1,1,0] op_sel_hi:[1,0,1] neg_lo:[0,0,0] neg_hi:[0,0,0]
v_pk_add_f32 v[14:15], v[150:151], v[182:183] neg_lo:[0,1] neg_hi:[0,1]
v_pk_add_f32 v[22:23], v[150:151], v[182:183]
v_pk_mul_f32 v[54:55], v[14:15], s[58:59] op_sel:[0,0] op_sel_hi:[0,1] neg_lo:[0,0] neg_hi:[0,1]
v_pk_fma_f32 v[54:55], v[14:15], s[58:59], v[54:55] op_sel:[1,1,0] op_sel_hi:[1,0,1] neg_lo:[0,0,0] neg_hi:[0,0,0]
v_pk_add_f32 v[14:15], v[152:153], v[184:185] neg_lo:[0,1] neg_hi:[0,1]
v_pk_add_f32 v[24:25], v[152:153], v[184:185]
v_pk_mul_f32 v[56:57], v[14:15], s[62:63] op_sel:[0,0] op_sel_hi:[0,1] neg_lo:[0,0] neg_hi:[0,1]
v_pk_fma_f32 v[56:57], v[14:15], s[62:63], v[56:57] op_sel:[1,1,0] op_sel_hi:[1,0,1] neg_lo:[0,0,0] neg_hi:[0,0,0]
v_pk_add_f32 v[14:15], v[154:155], v[186:187] neg_lo:[0,1] neg_hi:[0,1]
v_pk_add_f32 v[26:27], v[154:155], v[186:187]
v_pk_mul_f32 v[58:59], v[14:15], s[58:59] op_sel:[0,1] op_sel_hi:[0,0] neg_lo:[0,0] neg_hi:[0,1]
v_pk_fma_f32 v[58:59], v[14:15], s[58:59], v[58:59] op_sel:[1,0,0] op_sel_hi:[1,1,1] neg_lo:[0,0,0] neg_hi:[0,0,0]
v_pk_add_f32 v[14:15], v[156:157], v[188:189] neg_lo:[0,1] neg_hi:[0,1]
v_pk_add_f32 v[28:29], v[156:157], v[188:189]
v_pk_mul_f32 v[60:61], v[14:15], s[54:55] op_sel:[0,1] op_sel_hi:[0,0] neg_lo:[0,0] neg_hi:[0,1]
v_pk_fma_f32 v[60:61], v[14:15], s[54:55], v[60:61] op_sel:[1,0,0] op_sel_hi:[1,1,1] neg_lo:[0,0,0] neg_hi:[0,0,0]
v_pk_add_f32 v[14:15], v[158:159], v[190:191] neg_lo:[0,1] neg_hi:[0,1]
v_pk_add_f32 v[30:31], v[158:159], v[190:191]
v_pk_mul_f32 v[62:63], v[14:15], s[50:51] op_sel:[0,1] op_sel_hi:[0,0] neg_lo:[0,0] neg_hi:[0,1]
v_pk_fma_f32 v[62:63], v[14:15], s[50:51], v[62:63] op_sel:[1,0,0] op_sel_hi:[1,1,1] neg_lo:[0,0,0] neg_hi:[0,0,0]
v_pk_add_f32 v[64:65], v[160:161], v[192:193] op_sel:[1,1] op_sel_hi:[0,0] neg_lo:[0,1] neg_hi:[1,0]
v_pk_add_f32 v[32:33], v[160:161], v[192:193]
v_pk_add_f32 v[14:15], v[162:163], v[194:195] neg_lo:[0,1] neg_hi:[0,1]
v_pk_add_f32 v[34:35], v[162:163], v[194:195]
v_pk_mul_f32 v[66:67], v[14:15], s[50:51] op_sel:[0,1] op_sel_hi:[0,0] neg_lo:[0,1] neg_hi:[0,1]
v_pk_fma_f32 v[66:67], v[14:15], s[50:51], v[66:67] op_sel:[1,0,0] op_sel_hi:[1,1,1] neg_lo:[0,0,0] neg_hi:[0,1,0]
v_pk_add_f32 v[14:15], v[164:165], v[196:197] neg_lo:[0,1] neg_hi:[0,1]
v_pk_add_f32 v[36:37], v[164:165], v[196:197]
v_pk_mul_f32 v[68:69], v[14:15], s[54:55] op_sel:[0,1] op_sel_hi:[0,0] neg_lo:[0,1] neg_hi:[0,1]
v_pk_fma_f32 v[68:69], v[14:15], s[54:55], v[68:69] op_sel:[1,0,0] op_sel_hi:[1,1,1] neg_lo:[0,0,0] neg_hi:[0,1,0]
v_pk_add_f32 v[14:15], v[166:167], v[198:199] neg_lo:[0,1] neg_hi:[0,1]
v_pk_add_f32 v[38:39], v[166:167], v[198:199]
v_pk_mul_f32 v[70:71], v[14:15], s[58:59] op_sel:[0,1] op_sel_hi:[0,0] neg_lo:[0,1] neg_hi:[0,1]
v_pk_fma_f32 v[70:71], v[14:15], s[58:59], v[70:71] op_sel:[1,0,0] op_sel_hi:[1,1,1] neg_lo:[0,0,0] neg_hi:[0,1,0]
v_pk_add_f32 v[14:15], v[168:169], v[200:201] neg_lo:[0,1] neg_hi:[0,1]
v_pk_add_f32 v[40:41], v[168:169], v[200:201]
v_pk_mul_f32 v[72:73], v[14:15], s[62:63] op_sel:[0,0] op_sel_hi:[0,1] neg_lo:[0,1] neg_hi:[0,1]
v_pk_fma_f32 v[72:73], v[14:15], s[62:63], v[72:73] op_sel:[1,1,0] op_sel_hi:[1,0,1] neg_lo:[0,0,0] neg_hi:[0,1,0]
v_pk_add_f32 v[14:15], v[170:171], v[202:203] neg_lo:[0,1] neg_hi:[0,1]
v_pk_add_f32 v[42:43], v[170:171], v[202:203]
v_pk_mul_f32 v[74:75], v[14:15], s[58:59] op_sel:[0,0] op_sel_hi:[0,1] neg_lo:[0,1] neg_hi:[0,1]
v_pk_fma_f32 v[74:75], v[14:15], s[58:59], v[74:75] op_sel:[1,1,0] op_sel_hi:[1,0,1] neg_lo:[0,0,0] neg_hi:[0,1,0]
v_pk_add_f32 v[14:15], v[172:173], v[204:205] neg_lo:[0,1] neg_hi:[0,1]
v_pk_add_f32 v[44:45], v[172:173], v[204:205]
v_pk_mul_f32 v[76:77], v[14:15], s[54:55] op_sel:[0,0] op_sel_hi:[0,1] neg_lo:[0,1] neg_hi:[0,1]
v_pk_fma_f32 v[76:77], v[14:15], s[54:55], v[76:77] op_sel:[1,1,0] op_sel_hi:[1,0,1] neg_lo:[0,0,0] neg_hi:[0,1,0]
v_pk_add_f32 v[14:15], v[174:175], v[206:207] neg_lo:[0,1] neg_hi:[0,1]
v_pk_add_f32 v[46:47], v[174:175], v[206:207]
v_pk_mul_f32 v[78:79], v[14:15], s[50:51] op_sel:[0,0] op_sel_hi:[0,1] neg_lo:[0,1] neg_hi:[0,1]
v_pk_fma_f32 v[78:79], v[14:15], s[50:51], v[78:79] op_sel:[1,1,0] op_sel_hi:[1,0,1] neg_lo:[0,0,0] neg_hi:[0,1,0]
s_lshl_b32 s12, s22, 15
buffer_load_short_d16_hi v144, v12, s[4:7], s12 offen offset:0
buffer_load_short_d16_hi v145, v12, s[4:7], s12 offen offset:2048
buffer_load_short_d16_hi v176, v12, s[4:7], s12 offen offset:1024
buffer_load_short_d16_hi v177, v12, s[4:7], s12 offen offset:3072
buffer_load_short_d16_hi v146, v12, s[4:7], s12 offen offset:64
buffer_load_short_d16_hi v147, v12, s[4:7], s12 offen offset:2112
buffer_load_short_d16_hi v178, v12, s[4:7], s12 offen offset:1088
buffer_load_short_d16_hi v179, v12, s[4:7], s12 offen offset:3136
buffer_load_short_d16_hi v148, v12, s[4:7], s12 offen offset:128
buffer_load_short_d16_hi v149, v12, s[4:7], s12 offen offset:2176
buffer_load_short_d16_hi v180, v12, s[4:7], s12 offen offset:1152
buffer_load_short_d16_hi v181, v12, s[4:7], s12 offen offset:3200
buffer_load_short_d16_hi v150, v12, s[4:7], s12 offen offset:192
buffer_load_short_d16_hi v151, v12, s[4:7], s12 offen offset:2240
buffer_load_short_d16_hi v182, v12, s[4:7], s12 offen offset:1216
buffer_load_short_d16_hi v183, v12, s[4:7], s12 offen offset:3264
buffer_load_short_d16_hi v152, v12, s[4:7], s12 offen offset:256
buffer_load_short_d16_hi v153, v12, s[4:7], s12 offen offset:2304
buffer_load_short_d16_hi v184, v12, s[4:7], s12 offen offset:1280
buffer_load_short_d16_hi v185, v12, s[4:7], s12 offen offset:3328
buffer_load_short_d16_hi v154, v12, s[4:7], s12 offen offset:320
buffer_load_short_d16_hi v155, v12, s[4:7], s12 offen offset:2368
buffer_load_short_d16_hi v186, v12, s[4:7], s12 offen offset:1344
buffer_load_short_d16_hi v187, v12, s[4:7], s12 offen offset:3392
buffer_load_short_d16_hi v156, v12, s[4:7], s12 offen offset:384
buffer_load_short_d16_hi v157, v12, s[4:7], s12 offen offset:2432
buffer_load_short_d16_hi v188, v12, s[4:7], s12 offen offset:1408
buffer_load_short_d16_hi v189, v12, s[4:7], s12 offen offset:3456
buffer_load_short_d16_hi v158, v12, s[4:7], s12 offen offset:448
buffer_load_short_d16_hi v159, v12, s[4:7], s12 offen offset:2496
buffer_load_short_d16_hi v190, v12, s[4:7], s12 offen offset:1472
buffer_load_short_d16_hi v191, v12, s[4:7], s12 offen offset:3520
buffer_load_short_d16_hi v160, v12, s[4:7], s12 offen offset:512
buffer_load_short_d16_hi v161, v12, s[4:7], s12 offen offset:2560
buffer_load_short_d16_hi v192, v12, s[4:7], s12 offen offset:1536
buffer_load_short_d16_hi v193, v12, s[4:7], s12 offen offset:3584
buffer_load_short_d16_hi v162, v12, s[4:7], s12 offen offset:576
buffer_load_short_d16_hi v163, v12, s[4:7], s12 offen offset:2624
buffer_load_short_d16_hi v194, v12, s[4:7], s12 offen offset:1600
buffer_load_short_d16_hi v195, v12, s[4:7], s12 offen offset:3648
buffer_load_short_d16_hi v164, v12, s[4:7], s12 offen offset:640
buffer_load_short_d16_hi v165, v12, s[4:7], s12 offen offset:2688
buffer_load_short_d16_hi v196, v12, s[4:7], s12 offen offset:1664
buffer_load_short_d16_hi v197, v12, s[4:7], s12 offen offset:3712
buffer_load_short_d16_hi v166, v12, s[4:7], s12 offen offset:704
buffer_load_short_d16_hi v167, v12, s[4:7], s12 offen offset:2752
buffer_load_short_d16_hi v198, v12, s[4:7], s12 offen offset:1728
buffer_load_short_d16_hi v199, v12, s[4:7], s12 offen offset:3776
buffer_load_short_d16_hi v168, v12, s[4:7], s12 offen offset:768
buffer_load_short_d16_hi v169, v12, s[4:7], s12 offen offset:2816
buffer_load_short_d16_hi v200, v12, s[4:7], s12 offen offset:1792
buffer_load_short_d16_hi v201, v12, s[4:7], s12 offen offset:3840
buffer_load_short_d16_hi v170, v12, s[4:7], s12 offen offset:832
buffer_load_short_d16_hi v171, v12, s[4:7], s12 offen offset:2880
buffer_load_short_d16_hi v202, v12, s[4:7], s12 offen offset:1856
buffer_load_short_d16_hi v203, v12, s[4:7], s12 offen offset:3904
buffer_load_short_d16_hi v172, v12, s[4:7], s12 offen offset:896
buffer_load_short_d16_hi v173, v12, s[4:7], s12 offen offset:2944
buffer_load_short_d16_hi v204, v12, s[4:7], s12 offen offset:1920
buffer_load_short_d16_hi v205, v12, s[4:7], s12 offen offset:3968
buffer_load_short_d16_hi v174, v12, s[4:7], s12 offen offset:960
buffer_load_short_d16_hi v175, v12, s[4:7], s12 offen offset:3008
buffer_load_short_d16_hi v206, v12, s[4:7], s12 offen offset:1984
buffer_load_short_d16_hi v207, v12, s[4:7], s12 offen offset:4032
v_pk_add_f32 v[14:15], v[16:17], v[32:33] neg_lo:[0,1] neg_hi:[0,1]
v_pk_add_f32 v[16:17], v[16:17], v[32:33]
v_pk_add_f32 v[32:33], v[18:19], v[34:35] neg_lo:[0,1] neg_hi:[0,1]
v_pk_add_f32 v[18:19], v[18:19], v[34:35]
v_pk_mul_f32 v[34:35], v[32:33], s[54:55] op_sel:[0,0] op_sel_hi:[0,1] neg_lo:[0,0] neg_hi:[0,1]
v_pk_fma_f32 v[34:35], v[32:33], s[54:55], v[34:35] op_sel:[1,1,0] op_sel_hi:[1,0,1] neg_lo:[0,0,0] neg_hi:[0,0,0]
v_pk_add_f32 v[32:33], v[20:21], v[36:37] neg_lo:[0,1] neg_hi:[0,1]
v_pk_add_f32 v[20:21], v[20:21], v[36:37]
v_pk_mul_f32 v[36:37], v[32:33], s[62:63] op_sel:[0,0] op_sel_hi:[0,1] neg_lo:[0,0] neg_hi:[0,1]
v_pk_fma_f32 v[36:37], v[32:33], s[62:63], v[36:37] op_sel:[1,1,0] op_sel_hi:[1,0,1] neg_lo:[0,0,0] neg_hi:[0,0,0]
v_pk_add_f32 v[32:33], v[22:23], v[38:39] neg_lo:[0,1] neg_hi:[0,1]
v_pk_add_f32 v[22:23], v[22:23], v[38:39]
v_pk_mul_f32 v[38:39], v[32:33], s[54:55] op_sel:[0,1] op_sel_hi:[0,0] neg_lo:[0,0] neg_hi:[0,1]
v_pk_fma_f32 v[38:39], v[32:33], s[54:55], v[38:39] op_sel:[1,0,0] op_sel_hi:[1,1,1] neg_lo:[0,0,0] neg_hi:[0,0,0]
v_pk_add_f32 v[32:33], v[24:25], v[40:41] op_sel:[1,1] op_sel_hi:[0,0] neg_lo:[0,1] neg_hi:[1,0]
v_pk_add_f32 v[24:25], v[24:25], v[40:41]
v_pk_add_f32 v[40:41], v[26:27], v[42:43] neg_lo:[0,1] neg_hi:[0,1]
v_pk_add_f32 v[26:27], v[26:27], v[42:43]
v_pk_mul_f32 v[42:43], v[40:41], s[54:55] op_sel:[0,1] op_sel_hi:[0,0] neg_lo:[0,1] neg_hi:[0,1]
v_pk_fma_f32 v[42:43], v[40:41], s[54:55], v[42:43] op_sel:[1,0,0] op_sel_hi:[1,1,1] neg_lo:[0,0,0] neg_hi:[0,1,0]
v_pk_add_f32 v[40:41], v[28:29], v[44:45] neg_lo:[0,1] neg_hi:[0,1]
v_pk_add_f32 v[28:29], v[28:29], v[44:45]
v_pk_mul_f32 v[44:45], v[40:41], s[62:63] op_sel:[0,0] op_sel_hi:[0,1] neg_lo:[0,1] neg_hi:[0,1]
v_pk_fma_f32 v[44:45], v[40:41], s[62:63], v[44:45] op_sel:[1,1,0] op_sel_hi:[1,0,1] neg_lo:[0,0,0] neg_hi:[0,1,0]
v_pk_add_f32 v[40:41], v[30:31], v[46:47] neg_lo:[0,1] neg_hi:[0,1]
v_pk_add_f32 v[30:31], v[30:31], v[46:47]
v_pk_mul_f32 v[46:47], v[40:41], s[54:55] op_sel:[0,0] op_sel_hi:[0,1] neg_lo:[0,1] neg_hi:[0,1]
v_pk_fma_f32 v[46:47], v[40:41], s[54:55], v[46:47] op_sel:[1,1,0] op_sel_hi:[1,0,1] neg_lo:[0,0,0] neg_hi:[0,1,0]
v_pk_add_f32 v[40:41], v[48:49], v[64:65] neg_lo:[0,1] neg_hi:[0,1]
v_pk_add_f32 v[48:49], v[48:49], v[64:65]
v_pk_add_f32 v[64:65], v[50:51], v[66:67] neg_lo:[0,1] neg_hi:[0,1]
v_pk_add_f32 v[50:51], v[50:51], v[66:67]
v_pk_mul_f32 v[66:67], v[64:65], s[54:55] op_sel:[0,0] op_sel_hi:[0,1] neg_lo:[0,0] neg_hi:[0,1]
v_pk_fma_f32 v[66:67], v[64:65], s[54:55], v[66:67] op_sel:[1,1,0] op_sel_hi:[1,0,1] neg_lo:[0,0,0] neg_hi:[0,0,0]
v_pk_add_f32 v[64:65], v[52:53], v[68:69] neg_lo:[0,1] neg_hi:[0,1]
v_pk_add_f32 v[52:53], v[52:53], v[68:69]
v_pk_mul_f32 v[68:69], v[64:65], s[62:63] op_sel:[0,0] op_sel_hi:[0,1] neg_lo:[0,0] neg_hi:[0,1]
v_pk_fma_f32 v[68:69], v[64:65], s[62:63], v[68:69] op_sel:[1,1,0] op_sel_hi:[1,0,1] neg_lo:[0,0,0] neg_hi:[0,0,0]
v_pk_add_f32 v[64:65], v[54:55], v[70:71] neg_lo:[0,1] neg_hi:[0,1]
v_pk_add_f32 v[54:55], v[54:55], v[70:71]
v_pk_mul_f32 v[70:71], v[64:65], s[54:55] op_sel:[0,1] op_sel_hi:[0,0] neg_lo:[0,0] neg_hi:[0,1]
v_pk_fma_f32 v[70:71], v[64:65], s[54:55], v[70:71] op_sel:[1,0,0] op_sel_hi:[1,1,1] neg_lo:[0,0,0] neg_hi:[0,0,0]
v_pk_add_f32 v[64:65], v[56:57], v[72:73] op_sel:[1,1] op_sel_hi:[0,0] neg_lo:[0,1] neg_hi:[1,0]
v_pk_add_f32 v[56:57], v[56:57], v[72:73]
v_pk_add_f32 v[72:73], v[58:59], v[74:75] neg_lo:[0,1] neg_hi:[0,1]
v_pk_add_f32 v[58:59], v[58:59], v[74:75]
v_pk_mul_f32 v[74:75], v[72:73], s[54:55] op_sel:[0,1] op_sel_hi:[0,0] neg_lo:[0,1] neg_hi:[0,1]
v_pk_fma_f32 v[74:75], v[72:73], s[54:55], v[74:75] op_sel:[1,0,0] op_sel_hi:[1,1,1] neg_lo:[0,0,0] neg_hi:[0,1,0]
v_pk_add_f32 v[72:73], v[60:61], v[76:77] neg_lo:[0,1] neg_hi:[0,1]
v_pk_add_f32 v[60:61], v[60:61], v[76:77]
v_pk_mul_f32 v[76:77], v[72:73], s[62:63] op_sel:[0,0] op_sel_hi:[0,1] neg_lo:[0,1] neg_hi:[0,1]
v_pk_fma_f32 v[76:77], v[72:73], s[62:63], v[76:77] op_sel:[1,1,0] op_sel_hi:[1,0,1] neg_lo:[0,0,0] neg_hi:[0,1,0]
v_pk_add_f32 v[72:73], v[62:63], v[78:79] neg_lo:[0,1] neg_hi:[0,1]
v_pk_add_f32 v[62:63], v[62:63], v[78:79]
v_pk_mul_f32 v[78:79], v[72:73], s[54:55] op_sel:[0,0] op_sel_hi:[0,1] neg_lo:[0,1] neg_hi:[0,1]
v_pk_fma_f32 v[78:79], v[72:73], s[54:55], v[78:79] op_sel:[1,1,0] op_sel_hi:[1,0,1] neg_lo:[0,0,0] neg_hi:[0,1,0]
v_pk_add_f32 v[72:73], v[16:17], v[24:25] neg_lo:[0,1] neg_hi:[0,1]
v_pk_add_f32 v[16:17], v[16:17], v[24:25]
v_pk_add_f32 v[24:25], v[18:19], v[26:27] neg_lo:[0,1] neg_hi:[0,1]
v_pk_add_f32 v[18:19], v[18:19], v[26:27]
v_pk_mul_f32 v[26:27], v[24:25], s[62:63] op_sel:[0,0] op_sel_hi:[0,1] neg_lo:[0,0] neg_hi:[0,1]
v_pk_fma_f32 v[26:27], v[24:25], s[62:63], v[26:27] op_sel:[1,1,0] op_sel_hi:[1,0,1] neg_lo:[0,0,0] neg_hi:[0,0,0]
v_pk_add_f32 v[24:25], v[20:21], v[28:29] op_sel:[1,1] op_sel_hi:[0,0] neg_lo:[0,1] neg_hi:[1,0]
v_pk_add_f32 v[20:21], v[20:21], v[28:29]
v_pk_add_f32 v[28:29], v[22:23], v[30:31] neg_lo:[0,1] neg_hi:[0,1]
v_pk_add_f32 v[22:23], v[22:23], v[30:31]
v_pk_mul_f32 v[30:31], v[28:29], s[62:63] op_sel:[0,0] op_sel_hi:[0,1] neg_lo:[0,1] neg_hi:[0,1]
v_pk_fma_f32 v[30:31], v[28:29], s[62:63], v[30:31] op_sel:[1,1,0] op_sel_hi:[1,0,1] neg_lo:[0,0,0] neg_hi:[0,1,0]
v_pk_add_f32 v[28:29], v[14:15], v[32:33] neg_lo:[0,1] neg_hi:[0,1]
v_pk_add_f32 v[14:15], v[14:15], v[32:33]
v_pk_add_f32 v[32:33], v[34:35], v[42:43] neg_lo:[0,1] neg_hi:[0,1]
v_pk_add_f32 v[34:35], v[34:35], v[42:43]
v_pk_mul_f32 v[42:43], v[32:33], s[62:63] op_sel:[0,0] op_sel_hi:[0,1] neg_lo:[0,0] neg_hi:[0,1]
v_pk_fma_f32 v[42:43], v[32:33], s[62:63], v[42:43] op_sel:[1,1,0] op_sel_hi:[1,0,1] neg_lo:[0,0,0] neg_hi:[0,0,0]
v_pk_add_f32 v[32:33], v[36:37], v[44:45] op_sel:[1,1] op_sel_hi:[0,0] neg_lo:[0,1] neg_hi:[1,0]
v_pk_add_f32 v[36:37], v[36:37], v[44:45]
v_pk_add_f32 v[44:45], v[38:39], v[46:47] neg_lo:[0,1] neg_hi:[0,1]
v_pk_add_f32 v[38:39], v[38:39], v[46:47]
v_pk_mul_f32 v[46:47], v[44:45], s[62:63] op_sel:[0,0] op_sel_hi:[0,1] neg_lo:[0,1] neg_hi:[0,1]
v_pk_fma_f32 v[46:47], v[44:45], s[62:63], v[46:47] op_sel:[1,1,0] op_sel_hi:[1,0,1] neg_lo:[0,0,0] neg_hi:[0,1,0]
v_pk_add_f32 v[44:45], v[48:49], v[56:57] neg_lo:[0,1] neg_hi:[0,1]
v_pk_add_f32 v[48:49], v[48:49], v[56:57]
v_pk_add_f32 v[56:57], v[50:51], v[58:59] neg_lo:[0,1] neg_hi:[0,1]
v_pk_add_f32 v[50:51], v[50:51], v[58:59]
v_pk_mul_f32 v[58:59], v[56:57], s[62:63] op_sel:[0,0] op_sel_hi:[0,1] neg_lo:[0,0] neg_hi:[0,1]
v_pk_fma_f32 v[58:59], v[56:57], s[62:63], v[58:59] op_sel:[1,1,0] op_sel_hi:[1,0,1] neg_lo:[0,0,0] neg_hi:[0,0,0]
v_pk_add_f32 v[56:57], v[52:53], v[60:61] op_sel:[1,1] op_sel_hi:[0,0] neg_lo:[0,1] neg_hi:[1,0]
v_pk_add_f32 v[52:53], v[52:53], v[60:61]
v_pk_add_f32 v[60:61], v[54:55], v[62:63] neg_lo:[0,1] neg_hi:[0,1]
v_pk_add_f32 v[54:55], v[54:55], v[62:63]
v_pk_mul_f32 v[62:63], v[60:61], s[62:63] op_sel:[0,0] op_sel_hi:[0,1] neg_lo:[0,1] neg_hi:[0,1]
v_pk_fma_f32 v[62:63], v[60:61], s[62:63], v[62:63] op_sel:[1,1,0] op_sel_hi:[1,0,1] neg_lo:[0,0,0] neg_hi:[0,1,0]
v_pk_add_f32 v[60:61], v[40:41], v[64:65] neg_lo:[0,1] neg_hi:[0,1]
v_pk_add_f32 v[40:41], v[40:41], v[64:65]
v_pk_add_f32 v[64:65], v[66:67], v[74:75] neg_lo:[0,1] neg_hi:[0,1]
v_pk_add_f32 v[66:67], v[66:67], v[74:75]
v_pk_mul_f32 v[74:75], v[64:65], s[62:63] op_sel:[0,0] op_sel_hi:[0,1] neg_lo:[0,0] neg_hi:[0,1]
v_pk_fma_f32 v[74:75], v[64:65], s[62:63], v[74:75] op_sel:[1,1,0] op_sel_hi:[1,0,1] neg_lo:[0,0,0] neg_hi:[0,0,0]
v_pk_add_f32 v[64:65], v[68:69], v[76:77] op_sel:[1,1] op_sel_hi:[0,0] neg_lo:[0,1] neg_hi:[1,0]
v_pk_add_f32 v[68:69], v[68:69], v[76:77]
v_pk_add_f32 v[76:77], v[70:71], v[78:79] neg_lo:[0,1] neg_hi:[0,1]
v_pk_add_f32 v[70:71], v[70:71], v[78:79]
v_pk_mul_f32 v[78:79], v[76:77], s[62:63] op_sel:[0,0] op_sel_hi:[0,1] neg_lo:[0,1] neg_hi:[0,1]
v_pk_fma_f32 v[78:79], v[76:77], s[62:63], v[78:79] op_sel:[1,1,0] op_sel_hi:[1,0,1] neg_lo:[0,0,0] neg_hi:[0,1,0]
v_pk_add_f32 v[76:77], v[16:17], v[20:21] neg_lo:[0,1] neg_hi:[0,1]
v_pk_add_f32 v[16:17], v[16:17], v[20:21]
v_pk_add_f32 v[20:21], v[18:19], v[22:23] op_sel:[1,1] op_sel_hi:[0,0] neg_lo:[0,1] neg_hi:[1,0]
v_pk_add_f32 v[18:19], v[18:19], v[22:23]
v_pk_add_f32 v[22:23], v[72:73], v[24:25] neg_lo:[0,1] neg_hi:[0,1]
v_pk_add_f32 v[72:73], v[72:73], v[24:25]
v_pk_add_f32 v[24:25], v[26:27], v[30:31] op_sel:[1,1] op_sel_hi:[0,0] neg_lo:[0,1] neg_hi:[1,0]
v_pk_add_f32 v[26:27], v[26:27], v[30:31]
v_pk_add_f32 v[30:31], v[14:15], v[36:37] neg_lo:[0,1] neg_hi:[0,1]
v_pk_add_f32 v[14:15], v[14:15], v[36:37]
v_pk_add_f32 v[36:37], v[34:35], v[38:39] op_sel:[1,1] op_sel_hi:[0,0] neg_lo:[0,1] neg_hi:[1,0]
v_pk_add_f32 v[34:35], v[34:35], v[38:39]
v_pk_add_f32 v[38:39], v[28:29], v[32:33] neg_lo:[0,1] neg_hi:[0,1]
v_pk_add_f32 v[28:29], v[28:29], v[32:33]
v_pk_add_f32 v[32:33], v[42:43], v[46:47] op_sel:[1,1] op_sel_hi:[0,0] neg_lo:[0,1] neg_hi:[1,0]
v_pk_add_f32 v[42:43], v[42:43], v[46:47]
v_pk_add_f32 v[46:47], v[48:49], v[52:53] neg_lo:[0,1] neg_hi:[0,1]
v_pk_add_f32 v[48:49], v[48:49], v[52:53]
v_pk_add_f32 v[52:53], v[50:51], v[54:55] op_sel:[1,1] op_sel_hi:[0,0] neg_lo:[0,1] neg_hi:[1,0]
v_pk_add_f32 v[50:51], v[50:51], v[54:55]
v_pk_add_f32 v[54:55], v[44:45], v[56:57] neg_lo:[0,1] neg_hi:[0,1]
v_pk_add_f32 v[44:45], v[44:45], v[56:57]
v_pk_add_f32 v[56:57], v[58:59], v[62:63] op_sel:[1,1] op_sel_hi:[0,0] neg_lo:[0,1] neg_hi:[1,0]
v_pk_add_f32 v[58:59], v[58:59], v[62:63]
v_pk_add_f32 v[62:63], v[40:41], v[68:69] neg_lo:[0,1] neg_hi:[0,1]
v_pk_add_f32 v[40:41], v[40:41], v[68:69]
v_pk_add_f32 v[68:69], v[66:67], v[70:71] op_sel:[1,1] op_sel_hi:[0,0] neg_lo:[0,1] neg_hi:[1,0]
v_pk_add_f32 v[66:67], v[66:67], v[70:71]
v_pk_add_f32 v[70:71], v[60:61], v[64:65] neg_lo:[0,1] neg_hi:[0,1]
v_pk_add_f32 v[60:61], v[60:61], v[64:65]
v_pk_add_f32 v[64:65], v[74:75], v[78:79] op_sel:[1,1] op_sel_hi:[0,0] neg_lo:[0,1] neg_hi:[1,0]
v_pk_add_f32 v[74:75], v[74:75], v[78:79]
v_pk_add_f32 v[78:79], v[16:17], v[18:19] neg_lo:[0,1] neg_hi:[0,1]
v_pk_add_f32 v[16:17], v[16:17], v[18:19]
v_pk_add_f32 v[18:19], v[76:77], v[20:21] neg_lo:[0,1] neg_hi:[0,1]
v_pk_add_f32 v[76:77], v[76:77], v[20:21]
v_pk_add_f32 v[20:21], v[72:73], v[26:27] neg_lo:[0,1] neg_hi:[0,1]
v_pk_add_f32 v[72:73], v[72:73], v[26:27]
v_pk_add_f32 v[26:27], v[22:23], v[24:25] neg_lo:[0,1] neg_hi:[0,1]
v_pk_add_f32 v[22:23], v[22:23], v[24:25]
v_pk_add_f32 v[24:25], v[14:15], v[34:35] neg_lo:[0,1] neg_hi:[0,1]
v_pk_add_f32 v[14:15], v[14:15], v[34:35]
v_pk_add_f32 v[34:35], v[30:31], v[36:37] neg_lo:[0,1] neg_hi:[0,1]
v_pk_add_f32 v[30:31], v[30:31], v[36:37]
v_pk_add_f32 v[36:37], v[28:29], v[42:43] neg_lo:[0,1] neg_hi:[0,1]
v_pk_add_f32 v[28:29], v[28:29], v[42:43]
v_pk_add_f32 v[42:43], v[38:39], v[32:33] neg_lo:[0,1] neg_hi:[0,1]
v_pk_add_f32 v[38:39], v[38:39], v[32:33]
v_pk_add_f32 v[32:33], v[48:49], v[50:51] neg_lo:[0,1] neg_hi:[0,1]
v_pk_add_f32 v[48:49], v[48:49], v[50:51]
v_pk_add_f32 v[50:51], v[46:47], v[52:53] neg_lo:[0,1] neg_hi:[0,1]
v_pk_add_f32 v[46:47], v[46:47], v[52:53]
v_pk_add_f32 v[52:53], v[44:45], v[58:59] neg_lo:[0,1] neg_hi:[0,1]
v_pk_add_f32 v[44:45], v[44:45], v[58:59]
v_pk_add_f32 v[58:59], v[54:55], v[56:57] neg_lo:[0,1] neg_hi:[0,1]
v_pk_add_f32 v[54:55], v[54:55], v[56:57]
v_pk_add_f32 v[56:57], v[40:41], v[66:67] neg_lo:[0,1] neg_hi:[0,1]
v_pk_add_f32 v[40:41], v[40:41], v[66:67]
v_pk_add_f32 v[66:67], v[62:63], v[68:69] neg_lo:[0,1] neg_hi:[0,1]
v_pk_add_f32 v[62:63], v[62:63], v[68:69]
v_pk_add_f32 v[68:69], v[60:61], v[74:75] neg_lo:[0,1] neg_hi:[0,1]
v_pk_add_f32 v[60:61], v[60:61], v[74:75]
v_pk_add_f32 v[74:75], v[70:71], v[64:65] neg_lo:[0,1] neg_hi:[0,1]
v_pk_add_f32 v[70:71], v[70:71], v[64:65]
v_pk_mul_f32 v[64:65], v[48:49], v[82:83] op_sel:[0,0] op_sel_hi:[0,1] neg_lo:[0,0] neg_hi:[0,0]
v_pk_fma_f32 v[48:49], v[48:49], v[82:83], v[64:65] op_sel:[1,1,0] op_sel_hi:[1,0,1] neg_lo:[0,1,0] neg_hi:[0,0,0]
v_pk_mul_f32 v[64:65], v[14:15], v[84:85] op_sel:[0,0] op_sel_hi:[0,1] neg_lo:[0,0] neg_hi:[0,0]
v_pk_fma_f32 v[14:15], v[14:15], v[84:85], v[64:65] op_sel:[1,1,0] op_sel_hi:[1,0,1] neg_lo:[0,1,0] neg_hi:[0,0,0]
v_pk_mul_f32 v[64:65], v[40:41], v[86:87] op_sel:[0,0] op_sel_hi:[0,1] neg_lo:[0,0] neg_hi:[0,0]
v_pk_fma_f32 v[40:41], v[40:41], v[86:87], v[64:65] op_sel:[1,1,0] op_sel_hi:[1,0,1] neg_lo:[0,1,0] neg_hi:[0,0,0]
v_pk_mul_f32 v[64:65], v[72:73], v[88:89] op_sel:[0,0] op_sel_hi:[0,1] neg_lo:[0,0] neg_hi:[0,0]
v_pk_fma_f32 v[72:73], v[72:73], v[88:89], v[64:65] op_sel:[1,1,0] op_sel_hi:[1,0,1] neg_lo:[0,1,0] neg_hi:[0,0,0]
v_pk_mul_f32 v[64:65], v[44:45], v[90:91] op_sel:[0,0] op_sel_hi:[0,1] neg_lo:[0,0] neg_hi:[0,0]
v_pk_fma_f32 v[44:45], v[44:45], v[90:91], v[64:65] op_sel:[1,1,0] op_sel_hi:[1,0,1] neg_lo:[0,1,0] neg_hi:[0,0,0]
v_pk_mul_f32 v[64:65], v[28:29], v[92:93] op_sel:[0,0] op_sel_hi:[0,1] neg_lo:[0,0] neg_hi:[0,0]
v_pk_fma_f32 v[28:29], v[28:29], v[92:93], v[64:65] op_sel:[1,1,0] op_sel_hi:[1,0,1] neg_lo:[0,1,0] neg_hi:[0,0,0]
v_pk_mul_f32 v[64:65], v[60:61], v[94:95] op_sel:[0,0] op_sel_hi:[0,1] neg_lo:[0,0] neg_hi:[0,0]
v_pk_fma_f32 v[60:61], v[60:61], v[94:95], v[64:65] op_sel:[1,1,0] op_sel_hi:[1,0,1] neg_lo:[0,1,0] neg_hi:[0,0,0]
v_pk_mul_f32 v[64:65], v[76:77], v[96:97] op_sel:[0,0] op_sel_hi:[0,1] neg_lo:[0,0] neg_hi:[0,0]
v_pk_fma_f32 v[76:77], v[76:77], v[96:97], v[64:65] op_sel:[1,1,0] op_sel_hi:[1,0,1] neg_lo:[0,1,0] neg_hi:[0,0,0]
v_pk_mul_f32 v[64:65], v[46:47], v[98:99] op_sel:[0,0] op_sel_hi:[0,1] neg_lo:[0,0] neg_hi:[0,0]
v_pk_fma_f32 v[46:47], v[46:47], v[98:99], v[64:65] op_sel:[1,1,0] op_sel_hi:[1,0,1] neg_lo:[0,1,0] neg_hi:[0,0,0]
v_pk_mul_f32 v[64:65], v[30:31], v[100:101] op_sel:[0,0] op_sel_hi:[0,1] neg_lo:[0,0] neg_hi:[0,0]
v_pk_fma_f32 v[30:31], v[30:31], v[100:101], v[64:65] op_sel:[1,1,0] op_sel_hi:[1,0,1] neg_lo:[0,1,0] neg_hi:[0,0,0]
v_pk_mul_f32 v[64:65], v[62:63], v[102:103] op_sel:[0,0] op_sel_hi:[0,1] neg_lo:[0,0] neg_hi:[0,0]
v_pk_fma_f32 v[62:63], v[62:63], v[102:103], v[64:65] op_sel:[1,1,0] op_sel_hi:[1,0,1] neg_lo:[0,1,0] neg_hi:[0,0,0]
v_pk_mul_f32 v[64:65], v[22:23], v[104:105] op_sel:[0,0] op_sel_hi:[0,1] neg_lo:[0,0] neg_hi:[0,0]
v_pk_fma_f32 v[22:23], v[22:23], v[104:105], v[64:65] op_sel:[1,1,0] op_sel_hi:[1,0,1] neg_lo:[0,1,0] neg_hi:[0,0,0]
v_pk_mul_f32 v[64:65], v[54:55], v[106:107] op_sel:[0,0] op_sel_hi:[0,1] neg_lo:[0,0] neg_hi:[0,0]
v_pk_fma_f32 v[54:55], v[54:55], v[106:107], v[64:65] op_sel:[1,1,0] op_sel_hi:[1,0,1] neg_lo:[0,1,0] neg_hi:[0,0,0]
v_pk_mul_f32 v[64:65], v[38:39], v[108:109] op_sel:[0,0] op_sel_hi:[0,1] neg_lo:[0,0] neg_hi:[0,0]
v_pk_fma_f32 v[38:39], v[38:39], v[108:109], v[64:65] op_sel:[1,1,0] op_sel_hi:[1,0,1] neg_lo:[0,1,0] neg_hi:[0,0,0]
v_pk_mul_f32 v[64:65], v[70:71], v[110:111] op_sel:[0,0] op_sel_hi:[0,1] neg_lo:[0,0] neg_hi:[0,0]
v_pk_fma_f32 v[70:71], v[70:71], v[110:111], v[64:65] op_sel:[1,1,0] op_sel_hi:[1,0,1] neg_lo:[0,1,0] neg_hi:[0,0,0]
v_pk_mul_f32 v[64:65], v[78:79], v[112:113] op_sel:[0,0] op_sel_hi:[0,1] neg_lo:[0,0] neg_hi:[0,0]
v_pk_fma_f32 v[78:79], v[78:79], v[112:113], v[64:65] op_sel:[1,1,0] op_sel_hi:[1,0,1] neg_lo:[0,1,0] neg_hi:[0,0,0]
v_pk_mul_f32 v[64:65], v[32:33], v[114:115] op_sel:[0,0] op_sel_hi:[0,1] neg_lo:[0,0] neg_hi:[0,0]
v_pk_fma_f32 v[32:33], v[32:33], v[114:115], v[64:65] op_sel:[1,1,0] op_sel_hi:[1,0,1] neg_lo:[0,1,0] neg_hi:[0,0,0]
v_pk_mul_f32 v[64:65], v[24:25], v[116:117] op_sel:[0,0] op_sel_hi:[0,1] neg_lo:[0,0] neg_hi:[0,0]
v_pk_fma_f32 v[24:25], v[24:25], v[116:117], v[64:65] op_sel:[1,1,0] op_sel_hi:[1,0,1] neg_lo:[0,1,0] neg_hi:[0,0,0]
v_pk_mul_f32 v[64:65], v[56:57], v[118:119] op_sel:[0,0] op_sel_hi:[0,1] neg_lo:[0,0] neg_hi:[0,0]
v_pk_fma_f32 v[56:57], v[56:57], v[118:119], v[64:65] op_sel:[1,1,0] op_sel_hi:[1,0,1] neg_lo:[0,1,0] neg_hi:[0,0,0]
v_pk_mul_f32 v[64:65], v[20:21], v[120:121] op_sel:[0,0] op_sel_hi:[0,1] neg_lo:[0,0] neg_hi:[0,0]
v_pk_fma_f32 v[20:21], v[20:21], v[120:121], v[64:65] op_sel:[1,1,0] op_sel_hi:[1,0,1] neg_lo:[0,1,0] neg_hi:[0,0,0]
v_pk_mul_f32 v[64:65], v[52:53], v[122:123] op_sel:[0,0] op_sel_hi:[0,1] neg_lo:[0,0] neg_hi:[0,0]
v_pk_fma_f32 v[52:53], v[52:53], v[122:123], v[64:65] op_sel:[1,1,0] op_sel_hi:[1,0,1] neg_lo:[0,1,0] neg_hi:[0,0,0]
v_pk_mul_f32 v[64:65], v[36:37], v[124:125] op_sel:[0,0] op_sel_hi:[0,1] neg_lo:[0,0] neg_hi:[0,0]
v_pk_fma_f32 v[36:37], v[36:37], v[124:125], v[64:65] op_sel:[1,1,0] op_sel_hi:[1,0,1] neg_lo:[0,1,0] neg_hi:[0,0,0]
v_pk_mul_f32 v[64:65], v[68:69], v[126:127] op_sel:[0,0] op_sel_hi:[0,1] neg_lo:[0,0] neg_hi:[0,0]
v_pk_fma_f32 v[68:69], v[68:69], v[126:127], v[64:65] op_sel:[1,1,0] op_sel_hi:[1,0,1] neg_lo:[0,1,0] neg_hi:[0,0,0]
v_pk_mul_f32 v[64:65], v[18:19], v[128:129] op_sel:[0,0] op_sel_hi:[0,1] neg_lo:[0,0] neg_hi:[0,0]
v_pk_fma_f32 v[18:19], v[18:19], v[128:129], v[64:65] op_sel:[1,1,0] op_sel_hi:[1,0,1] neg_lo:[0,1,0] neg_hi:[0,0,0]
v_pk_mul_f32 v[64:65], v[50:51], v[130:131] op_sel:[0,0] op_sel_hi:[0,1] neg_lo:[0,0] neg_hi:[0,0]
v_pk_fma_f32 v[50:51], v[50:51], v[130:131], v[64:65] op_sel:[1,1,0] op_sel_hi:[1,0,1] neg_lo:[0,1,0] neg_hi:[0,0,0]
v_pk_mul_f32 v[64:65], v[34:35], v[132:133] op_sel:[0,0] op_sel_hi:[0,1] neg_lo:[0,0] neg_hi:[0,0]
v_pk_fma_f32 v[34:35], v[34:35], v[132:133], v[64:65] op_sel:[1,1,0] op_sel_hi:[1,0,1] neg_lo:[0,1,0] neg_hi:[0,0,0]
v_pk_mul_f32 v[64:65], v[66:67], v[134:135] op_sel:[0,0] op_sel_hi:[0,1] neg_lo:[0,0] neg_hi:[0,0]
v_pk_fma_f32 v[66:67], v[66:67], v[134:135], v[64:65] op_sel:[1,1,0] op_sel_hi:[1,0,1] neg_lo:[0,1,0] neg_hi:[0,0,0]
v_pk_mul_f32 v[64:65], v[26:27], v[136:137] op_sel:[0,0] op_sel_hi:[0,1] neg_lo:[0,0] neg_hi:[0,0]
v_pk_fma_f32 v[26:27], v[26:27], v[136:137], v[64:65] op_sel:[1,1,0] op_sel_hi:[1,0,1] neg_lo:[0,1,0] neg_hi:[0,0,0]
v_pk_mul_f32 v[64:65], v[58:59], v[138:139] op_sel:[0,0] op_sel_hi:[0,1] neg_lo:[0,0] neg_hi:[0,0]
v_pk_fma_f32 v[58:59], v[58:59], v[138:139], v[64:65] op_sel:[1,1,0] op_sel_hi:[1,0,1] neg_lo:[0,1,0] neg_hi:[0,0,0]
v_pk_mul_f32 v[64:65], v[42:43], v[140:141] op_sel:[0,0] op_sel_hi:[0,1] neg_lo:[0,0] neg_hi:[0,0]
v_pk_fma_f32 v[42:43], v[42:43], v[140:141], v[64:65] op_sel:[1,1,0] op_sel_hi:[1,0,1] neg_lo:[0,1,0] neg_hi:[0,0,0]
v_pk_mul_f32 v[64:65], v[74:75], v[142:143] op_sel:[0,0] op_sel_hi:[0,1] neg_lo:[0,0] neg_hi:[0,0]
v_pk_fma_f32 v[74:75], v[74:75], v[142:143], v[64:65] op_sel:[1,1,0] op_sel_hi:[1,0,1] neg_lo:[0,1,0] neg_hi:[0,0,0]
s_barrier
ds_write_b64 v4, v[16:17] offset:0
ds_write_b64 v4, v[48:49] offset:264
ds_write_b64 v4, v[14:15] offset:528
ds_write_b64 v4, v[40:41] offset:792
ds_write_b64 v4, v[72:73] offset:1056
ds_write_b64 v4, v[44:45] offset:1320
ds_write_b64 v4, v[28:29] offset:1584
ds_write_b64 v4, v[60:61] offset:1848
ds_write_b64 v4, v[76:77] offset:2112
ds_write_b64 v4, v[46:47] offset:2376
ds_write_b64 v4, v[30:31] offset:2640
ds_write_b64 v4, v[62:63] offset:2904
ds_write_b64 v4, v[22:23] offset:3168
ds_write_b64 v4, v[54:55] offset:3432
ds_write_b64 v4, v[38:39] offset:3696
ds_write_b64 v4, v[70:71] offset:3960
ds_write_b64 v4, v[78:79] offset:4224
ds_write_b64 v4, v[32:33] offset:4488
ds_write_b64 v4, v[24:25] offset:4752
ds_write_b64 v4, v[56:57] offset:5016
ds_write_b64 v4, v[20:21] offset:5280
ds_write_b64 v4, v[52:53] offset:5544
ds_write_b64 v4, v[36:37] offset:5808
ds_write_b64 v4, v[68:69] offset:6072
ds_write_b64 v4, v[18:19] offset:6336
ds_write_b64 v4, v[50:51] offset:6600
ds_write_b64 v4, v[34:35] offset:6864
ds_write_b64 v4, v[66:67] offset:7128
ds_write_b64 v4, v[26:27] offset:7392
ds_write_b64 v4, v[58:59] offset:7656
ds_write_b64 v4, v[42:43] offset:7920
ds_write_b64 v4, v[74:75] offset:8184
s_waitcnt lgkmcnt(0)
ds_read_b64 v[16:17], v5 offset:0
ds_read_b64 v[48:49], v5 offset:128
ds_read_b64 v[18:19], v5 offset:8
ds_read_b64 v[50:51], v5 offset:136
ds_read_b64 v[20:21], v5 offset:16
ds_read_b64 v[52:53], v5 offset:144
ds_read_b64 v[22:23], v5 offset:24
ds_read_b64 v[54:55], v5 offset:152
ds_read_b64 v[24:25], v5 offset:32
ds_read_b64 v[56:57], v5 offset:160
ds_read_b64 v[26:27], v5 offset:40
ds_read_b64 v[58:59], v5 offset:168
ds_read_b64 v[28:29], v5 offset:48
ds_read_b64 v[60:61], v5 offset:176
ds_read_b64 v[30:31], v5 offset:56
ds_read_b64 v[62:63], v5 offset:184
ds_read_b64 v[32:33], v5 offset:64
ds_read_b64 v[64:65], v5 offset:192
ds_read_b64 v[34:35], v5 offset:72
ds_read_b64 v[66:67], v5 offset:200
ds_read_b64 v[36:37], v5 offset:80
ds_read_b64 v[68:69], v5 offset:208
ds_read_b64 v[38:39], v5 offset:88
ds_read_b64 v[70:71], v5 offset:216
ds_read_b64 v[40:41], v5 offset:96
ds_read_b64 v[72:73], v5 offset:224
ds_read_b64 v[42:43], v5 offset:104
ds_read_b64 v[74:75], v5 offset:232
ds_read_b64 v[44:45], v5 offset:112
ds_read_b64 v[76:77], v5 offset:240
ds_read_b64 v[46:47], v5 offset:120
ds_read_b64 v[78:79], v5 offset:248
s_waitcnt lgkmcnt(0)
v_pk_add_f32 v[14:15], v[16:17], v[48:49] neg_lo:[0,1] neg_hi:[0,1]
v_pk_add_f32 v[16:17], v[16:17], v[48:49]
v_pk_add_f32 v[48:49], v[18:19], v[50:51] neg_lo:[0,1] neg_hi:[0,1]
v_pk_add_f32 v[18:19], v[18:19], v[50:51]
v_pk_mul_f32 v[50:51], v[48:49], s[50:51] op_sel:[0,0] op_sel_hi:[0,1] neg_lo:[0,0] neg_hi:[0,1]
v_pk_fma_f32 v[50:51], v[48:49], s[50:51], v[50:51] op_sel:[1,1,0] op_sel_hi:[1,0,1] neg_lo:[0,0,0] neg_hi:[0,0,0]
v_pk_add_f32 v[48:49], v[20:21], v[52:53] neg_lo:[0,1] neg_hi:[0,1]
v_pk_add_f32 v[20:21], v[20:21], v[52:53]
v_pk_mul_f32 v[52:53], v[48:49], s[54:55] op_sel:[0,0] op_sel_hi:[0,1] neg_lo:[0,0] neg_hi:[0,1]
v_pk_fma_f32 v[52:53], v[48:49], s[54:55], v[52:53] op_sel:[1,1,0] op_sel_hi:[1,0,1] neg_lo:[0,0,0] neg_hi:[0,0,0]
v_pk_add_f32 v[48:49], v[22:23], v[54:55] neg_lo:[0,1] neg_hi:[0,1]
v_pk_add_f32 v[22:23], v[22:23], v[54:55]
v_pk_mul_f32 v[54:55], v[48:49], s[58:59] op_sel:[0,0] op_sel_hi:[0,1] neg_lo:[0,0] neg_hi:[0,1]
v_pk_fma_f32 v[54:55], v[48:49], s[58:59], v[54:55] op_sel:[1,1,0] op_sel_hi:[1,0,1] neg_lo:[0,0,0] neg_hi:[0,0,0]
v_pk_add_f32 v[48:49], v[24:25], v[56:57] neg_lo:[0,1] neg_hi:[0,1]
v_pk_add_f32 v[24:25], v[24:25], v[56:57]
v_pk_mul_f32 v[56:57], v[48:49], s[62:63] op_sel:[0,0] op_sel_hi:[0,1] neg_lo:[0,0] neg_hi:[0,1]
v_pk_fma_f32 v[56:57], v[48:49], s[62:63], v[56:57] op_sel:[1,1,0] op_sel_hi:[1,0,1] neg_lo:[0,0,0] neg_hi:[0,0,0]
v_pk_add_f32 v[48:49], v[26:27], v[58:59] neg_lo:[0,1] neg_hi:[0,1]
v_pk_add_f32 v[26:27], v[26:27], v[58:59]
v_pk_mul_f32 v[58:59], v[48:49], s[58:59] op_sel:[0,1] op_sel_hi:[0,0] neg_lo:[0,0] neg_hi:[0,1]
v_pk_fma_f32 v[58:59], v[48:49], s[58:59], v[58:59] op_sel:[1,0,0] op_sel_hi:[1,1,1] neg_lo:[0,0,0] neg_hi:[0,0,0]
v_pk_add_f32 v[48:49], v[28:29], v[60:61] neg_lo:[0,1] neg_hi:[0,1]
v_pk_add_f32 v[28:29], v[28:29], v[60:61]
v_pk_mul_f32 v[60:61], v[48:49], s[54:55] op_sel:[0,1] op_sel_hi:[0,0] neg_lo:[0,0] neg_hi:[0,1]
v_pk_fma_f32 v[60:61], v[48:49], s[54:55], v[60:61] op_sel:[1,0,0] op_sel_hi:[1,1,1] neg_lo:[0,0,0] neg_hi:[0,0,0]
v_pk_add_f32 v[48:49], v[30:31], v[62:63] neg_lo:[0,1] neg_hi:[0,1]
v_pk_add_f32 v[30:31], v[30:31], v[62:63]
v_pk_mul_f32 v[62:63], v[48:49], s[50:51] op_sel:[0,1] op_sel_hi:[0,0] neg_lo:[0,0] neg_hi:[0,1]
v_pk_fma_f32 v[62:63], v[48:49], s[50:51], v[62:63] op_sel:[1,0,0] op_sel_hi:[1,1,1] neg_lo:[0,0,0] neg_hi:[0,0,0]
v_pk_add_f32 v[48:49], v[32:33], v[64:65] op_sel:[1,1] op_sel_hi:[0,0] neg_lo:[0,1] neg_hi:[1,0]
v_pk_add_f32 v[32:33], v[32:33], v[64:65]
v_pk_add_f32 v[64:65], v[34:35], v[66:67] neg_lo:[0,1] neg_hi:[0,1]
v_pk_add_f32 v[34:35], v[34:35], v[66:67]
v_pk_mul_f32 v[66:67], v[64:65], s[50:51] op_sel:[0,1] op_sel_hi:[0,0] neg_lo:[0,1] neg_hi:[0,1]
v_pk_fma_f32 v[66:67], v[64:65], s[50:51], v[66:67] op_sel:[1,0,0] op_sel_hi:[1,1,1] neg_lo:[0,0,0] neg_hi:[0,1,0]
v_pk_add_f32 v[64:65], v[36:37], v[68:69] neg_lo:[0,1] neg_hi:[0,1]
v_pk_add_f32 v[36:37], v[36:37], v[68:69]
v_pk_mul_f32 v[68:69], v[64:65], s[54:55] op_sel:[0,1] op_sel_hi:[0,0] neg_lo:[0,1] neg_hi:[0,1]
v_pk_fma_f32 v[68:69], v[64:65], s[54:55], v[68:69] op_sel:[1,0,0] op_sel_hi:[1,1,1] neg_lo:[0,0,0] neg_hi:[0,1,0]
v_pk_add_f32 v[64:65], v[38:39], v[70:71] neg_lo:[0,1] neg_hi:[0,1]
v_pk_add_f32 v[38:39], v[38:39], v[70:71]
v_pk_mul_f32 v[70:71], v[64:65], s[58:59] op_sel:[0,1] op_sel_hi:[0,0] neg_lo:[0,1] neg_hi:[0,1]
v_pk_fma_f32 v[70:71], v[64:65], s[58:59], v[70:71] op_sel:[1,0,0] op_sel_hi:[1,1,1] neg_lo:[0,0,0] neg_hi:[0,1,0]
v_pk_add_f32 v[64:65], v[40:41], v[72:73] neg_lo:[0,1] neg_hi:[0,1]
v_pk_add_f32 v[40:41], v[40:41], v[72:73]
v_pk_mul_f32 v[72:73], v[64:65], s[62:63] op_sel:[0,0] op_sel_hi:[0,1] neg_lo:[0,1] neg_hi:[0,1]
v_pk_fma_f32 v[72:73], v[64:65], s[62:63], v[72:73] op_sel:[1,1,0] op_sel_hi:[1,0,1] neg_lo:[0,0,0] neg_hi:[0,1,0]
v_pk_add_f32 v[64:65], v[42:43], v[74:75] neg_lo:[0,1] neg_hi:[0,1]
v_pk_add_f32 v[42:43], v[42:43], v[74:75]
v_pk_mul_f32 v[74:75], v[64:65], s[58:59] op_sel:[0,0] op_sel_hi:[0,1] neg_lo:[0,1] neg_hi:[0,1]
v_pk_fma_f32 v[74:75], v[64:65], s[58:59], v[74:75] op_sel:[1,1,0] op_sel_hi:[1,0,1] neg_lo:[0,0,0] neg_hi:[0,1,0]
v_pk_add_f32 v[64:65], v[44:45], v[76:77] neg_lo:[0,1] neg_hi:[0,1]
v_pk_add_f32 v[44:45], v[44:45], v[76:77]
v_pk_mul_f32 v[76:77], v[64:65], s[54:55] op_sel:[0,0] op_sel_hi:[0,1] neg_lo:[0,1] neg_hi:[0,1]
v_pk_fma_f32 v[76:77], v[64:65], s[54:55], v[76:77] op_sel:[1,1,0] op_sel_hi:[1,0,1] neg_lo:[0,0,0] neg_hi:[0,1,0]
v_pk_add_f32 v[64:65], v[46:47], v[78:79] neg_lo:[0,1] neg_hi:[0,1]
v_pk_add_f32 v[46:47], v[46:47], v[78:79]
v_pk_mul_f32 v[78:79], v[64:65], s[50:51] op_sel:[0,0] op_sel_hi:[0,1] neg_lo:[0,1] neg_hi:[0,1]
v_pk_fma_f32 v[78:79], v[64:65], s[50:51], v[78:79] op_sel:[1,1,0] op_sel_hi:[1,0,1] neg_lo:[0,0,0] neg_hi:[0,1,0]
v_pk_add_f32 v[64:65], v[16:17], v[32:33] neg_lo:[0,1] neg_hi:[0,1]
v_pk_add_f32 v[16:17], v[16:17], v[32:33]
v_pk_add_f32 v[32:33], v[18:19], v[34:35] neg_lo:[0,1] neg_hi:[0,1]
v_pk_add_f32 v[18:19], v[18:19], v[34:35]
v_pk_mul_f32 v[34:35], v[32:33], s[54:55] op_sel:[0,0] op_sel_hi:[0,1] neg_lo:[0,0] neg_hi:[0,1]
v_pk_fma_f32 v[34:35], v[32:33], s[54:55], v[34:35] op_sel:[1,1,0] op_sel_hi:[1,0,1] neg_lo:[0,0,0] neg_hi:[0,0,0]
v_pk_add_f32 v[32:33], v[20:21], v[36:37] neg_lo:[0,1] neg_hi:[0,1]
v_pk_add_f32 v[20:21], v[20:21], v[36:37]
v_pk_mul_f32 v[36:37], v[32:33], s[62:63] op_sel:[0,0] op_sel_hi:[0,1] neg_lo:[0,0] neg_hi:[0,1]
v_pk_fma_f32 v[36:37], v[32:33], s[62:63], v[36:37] op_sel:[1,1,0] op_sel_hi:[1,0,1] neg_lo:[0,0,0] neg_hi:[0,0,0]
v_pk_add_f32 v[32:33], v[22:23], v[38:39] neg_lo:[0,1] neg_hi:[0,1]
v_pk_add_f32 v[22:23], v[22:23], v[38:39]
v_pk_mul_f32 v[38:39], v[32:33], s[54:55] op_sel:[0,1] op_sel_hi:[0,0] neg_lo:[0,0] neg_hi:[0,1]
v_pk_fma_f32 v[38:39], v[32:33], s[54:55], v[38:39] op_sel:[1,0,0] op_sel_hi:[1,1,1] neg_lo:[0,0,0] neg_hi:[0,0,0]
v_pk_add_f32 v[32:33], v[24:25], v[40:41] op_sel:[1,1] op_sel_hi:[0,0] neg_lo:[0,1] neg_hi:[1,0]
v_pk_add_f32 v[24:25], v[24:25], v[40:41]
v_pk_add_f32 v[40:41], v[26:27], v[42:43] neg_lo:[0,1] neg_hi:[0,1]
v_pk_add_f32 v[26:27], v[26:27], v[42:43]
v_pk_mul_f32 v[42:43], v[40:41], s[54:55] op_sel:[0,1] op_sel_hi:[0,0] neg_lo:[0,1] neg_hi:[0,1]
v_pk_fma_f32 v[42:43], v[40:41], s[54:55], v[42:43] op_sel:[1,0,0] op_sel_hi:[1,1,1] neg_lo:[0,0,0] neg_hi:[0,1,0]
v_pk_add_f32 v[40:41], v[28:29], v[44:45] neg_lo:[0,1] neg_hi:[0,1]
v_pk_add_f32 v[28:29], v[28:29], v[44:45]
v_pk_mul_f32 v[44:45], v[40:41], s[62:63] op_sel:[0,0] op_sel_hi:[0,1] neg_lo:[0,1] neg_hi:[0,1]
v_pk_fma_f32 v[44:45], v[40:41], s[62:63], v[44:45] op_sel:[1,1,0] op_sel_hi:[1,0,1] neg_lo:[0,0,0] neg_hi:[0,1,0]
v_pk_add_f32 v[40:41], v[30:31], v[46:47] neg_lo:[0,1] neg_hi:[0,1]
v_pk_add_f32 v[30:31], v[30:31], v[46:47]
v_pk_mul_f32 v[46:47], v[40:41], s[54:55] op_sel:[0,0] op_sel_hi:[0,1] neg_lo:[0,1] neg_hi:[0,1]
v_pk_fma_f32 v[46:47], v[40:41], s[54:55], v[46:47] op_sel:[1,1,0] op_sel_hi:[1,0,1] neg_lo:[0,0,0] neg_hi:[0,1,0]
v_pk_add_f32 v[40:41], v[14:15], v[48:49] neg_lo:[0,1] neg_hi:[0,1]
v_pk_add_f32 v[14:15], v[14:15], v[48:49]
v_pk_add_f32 v[48:49], v[50:51], v[66:67] neg_lo:[0,1] neg_hi:[0,1]
v_pk_add_f32 v[50:51], v[50:51], v[66:67]
v_pk_mul_f32 v[66:67], v[48:49], s[54:55] op_sel:[0,0] op_sel_hi:[0,1] neg_lo:[0,0] neg_hi:[0,1]
v_pk_fma_f32 v[66:67], v[48:49], s[54:55], v[66:67] op_sel:[1,1,0] op_sel_hi:[1,0,1] neg_lo:[0,0,0] neg_hi:[0,0,0]
v_pk_add_f32 v[48:49], v[52:53], v[68:69] neg_lo:[0,1] neg_hi:[0,1]
v_pk_add_f32 v[52:53], v[52:53], v[68:69]
v_pk_mul_f32 v[68:69], v[48:49], s[62:63] op_sel:[0,0] op_sel_hi:[0,1] neg_lo:[0,0] neg_hi:[0,1]
v_pk_fma_f32 v[68:69], v[48:49], s[62:63], v[68:69] op_sel:[1,1,0] op_sel_hi:[1,0,1] neg_lo:[0,0,0] neg_hi:[0,0,0]
v_pk_add_f32 v[48:49], v[54:55], v[70:71] neg_lo:[0,1] neg_hi:[0,1]
v_pk_add_f32 v[54:55], v[54:55], v[70:71]
v_pk_mul_f32 v[70:71], v[48:49], s[54:55] op_sel:[0,1] op_sel_hi:[0,0] neg_lo:[0,0] neg_hi:[0,1]
v_pk_fma_f32 v[70:71], v[48:49], s[54:55], v[70:71] op_sel:[1,0,0] op_sel_hi:[1,1,1] neg_lo:[0,0,0] neg_hi:[0,0,0]
v_pk_add_f32 v[48:49], v[56:57], v[72:73] op_sel:[1,1] op_sel_hi:[0,0] neg_lo:[0,1] neg_hi:[1,0]
v_pk_add_f32 v[56:57], v[56:57], v[72:73]
v_pk_add_f32 v[72:73], v[58:59], v[74:75] neg_lo:[0,1] neg_hi:[0,1]
v_pk_add_f32 v[58:59], v[58:59], v[74:75]
v_pk_mul_f32 v[74:75], v[72:73], s[54:55] op_sel:[0,1] op_sel_hi:[0,0] neg_lo:[0,1] neg_hi:[0,1]
v_pk_fma_f32 v[74:75], v[72:73], s[54:55], v[74:75] op_sel:[1,0,0] op_sel_hi:[1,1,1] neg_lo:[0,0,0] neg_hi:[0,1,0]
v_pk_add_f32 v[72:73], v[60:61], v[76:77] neg_lo:[0,1] neg_hi:[0,1]
v_pk_add_f32 v[60:61], v[60:61], v[76:77]
v_pk_mul_f32 v[76:77], v[72:73], s[62:63] op_sel:[0,0] op_sel_hi:[0,1] neg_lo:[0,1] neg_hi:[0,1]
v_pk_fma_f32 v[76:77], v[72:73], s[62:63], v[76:77] op_sel:[1,1,0] op_sel_hi:[1,0,1] neg_lo:[0,0,0] neg_hi:[0,1,0]
v_pk_add_f32 v[72:73], v[62:63], v[78:79] neg_lo:[0,1] neg_hi:[0,1]
v_pk_add_f32 v[62:63], v[62:63], v[78:79]
v_pk_mul_f32 v[78:79], v[72:73], s[54:55] op_sel:[0,0] op_sel_hi:[0,1] neg_lo:[0,1] neg_hi:[0,1]
v_pk_fma_f32 v[78:79], v[72:73], s[54:55], v[78:79] op_sel:[1,1,0] op_sel_hi:[1,0,1] neg_lo:[0,0,0] neg_hi:[0,1,0]
v_pk_add_f32 v[72:73], v[16:17], v[24:25] neg_lo:[0,1] neg_hi:[0,1]
v_pk_add_f32 v[16:17], v[16:17], v[24:25]
v_pk_add_f32 v[24:25], v[18:19], v[26:27] neg_lo:[0,1] neg_hi:[0,1]
v_pk_add_f32 v[18:19], v[18:19], v[26:27]
v_pk_mul_f32 v[26:27], v[24:25], s[62:63] op_sel:[0,0] op_sel_hi:[0,1] neg_lo:[0,0] neg_hi:[0,1]
v_pk_fma_f32 v[26:27], v[24:25], s[62:63], v[26:27] op_sel:[1,1,0] op_sel_hi:[1,0,1] neg_lo:[0,0,0] neg_hi:[0,0,0]
v_pk_add_f32 v[24:25], v[20:21], v[28:29] op_sel:[1,1] op_sel_hi:[0,0] neg_lo:[0,1] neg_hi:[1,0]
v_pk_add_f32 v[20:21], v[20:21], v[28:29]
v_pk_add_f32 v[28:29], v[22:23], v[30:31] neg_lo:[0,1] neg_hi:[0,1]
v_pk_add_f32 v[22:23], v[22:23], v[30:31]
v_pk_mul_f32 v[30:31], v[28:29], s[62:63] op_sel:[0,0] op_sel_hi:[0,1] neg_lo:[0,1] neg_hi:[0,1]
v_pk_fma_f32 v[30:31], v[28:29], s[62:63], v[30:31] op_sel:[1,1,0] op_sel_hi:[1,0,1] neg_lo:[0,0,0] neg_hi:[0,1,0]
v_pk_add_f32 v[28:29], v[64:65], v[32:33] neg_lo:[0,1] neg_hi:[0,1]
v_pk_add_f32 v[64:65], v[64:65], v[32:33]
v_pk_add_f32 v[32:33], v[34:35], v[42:43] neg_lo:[0,1] neg_hi:[0,1]
v_pk_add_f32 v[34:35], v[34:35], v[42:43]
v_pk_mul_f32 v[42:43], v[32:33], s[62:63] op_sel:[0,0] op_sel_hi:[0,1] neg_lo:[0,0] neg_hi:[0,1]
v_pk_fma_f32 v[42:43], v[32:33], s[62:63], v[42:43] op_sel:[1,1,0] op_sel_hi:[1,0,1] neg_lo:[0,0,0] neg_hi:[0,0,0]
v_pk_add_f32 v[32:33], v[36:37], v[44:45] op_sel:[1,1] op_sel_hi:[0,0] neg_lo:[0,1] neg_hi:[1,0]
v_pk_add_f32 v[36:37], v[36:37], v[44:45]
v_pk_add_f32 v[44:45], v[38:39], v[46:47] neg_lo:[0,1] neg_hi:[0,1]
v_pk_add_f32 v[38:39], v[38:39], v[46:47]
v_pk_mul_f32 v[46:47], v[44:45], s[62:63] op_sel:[0,0] op_sel_hi:[0,1] neg_lo:[0,1] neg_hi:[0,1]
v_pk_fma_f32 v[46:47], v[44:45], s[62:63], v[46:47] op_sel:[1,1,0] op_sel_hi:[1,0,1] neg_lo:[0,0,0] neg_hi:[0,1,0]
v_pk_add_f32 v[44:45], v[14:15], v[56:57] neg_lo:[0,1] neg_hi:[0,1]
v_pk_add_f32 v[14:15], v[14:15], v[56:57]
v_pk_add_f32 v[56:57], v[50:51], v[58:59] neg_lo:[0,1] neg_hi:[0,1]
v_pk_add_f32 v[50:51], v[50:51], v[58:59]
v_pk_mul_f32 v[58:59], v[56:57], s[62:63] op_sel:[0,0] op_sel_hi:[0,1] neg_lo:[0,0] neg_hi:[0,1]
v_pk_fma_f32 v[58:59], v[56:57], s[62:63], v[58:59] op_sel:[1,1,0] op_sel_hi:[1,0,1] neg_lo:[0,0,0] neg_hi:[0,0,0]
v_pk_add_f32 v[56:57], v[52:53], v[60:61] op_sel:[1,1] op_sel_hi:[0,0] neg_lo:[0,1] neg_hi:[1,0]
v_pk_add_f32 v[52:53], v[52:53], v[60:61]
v_pk_add_f32 v[60:61], v[54:55], v[62:63] neg_lo:[0,1] neg_hi:[0,1]
v_pk_add_f32 v[54:55], v[54:55], v[62:63]
v_pk_mul_f32 v[62:63], v[60:61], s[62:63] op_sel:[0,0] op_sel_hi:[0,1] neg_lo:[0,1] neg_hi:[0,1]
v_pk_fma_f32 v[62:63], v[60:61], s[62:63], v[62:63] op_sel:[1,1,0] op_sel_hi:[1,0,1] neg_lo:[0,0,0] neg_hi:[0,1,0]
v_pk_add_f32 v[60:61], v[40:41], v[48:49] neg_lo:[0,1] neg_hi:[0,1]
v_pk_add_f32 v[40:41], v[40:41], v[48:49]
v_pk_add_f32 v[48:49], v[66:67], v[74:75] neg_lo:[0,1] neg_hi:[0,1]
v_pk_add_f32 v[66:67], v[66:67], v[74:75]
v_pk_mul_f32 v[74:75], v[48:49], s[62:63] op_sel:[0,0] op_sel_hi:[0,1] neg_lo:[0,0] neg_hi:[0,1]
v_pk_fma_f32 v[74:75], v[48:49], s[62:63], v[74:75] op_sel:[1,1,0] op_sel_hi:[1,0,1] neg_lo:[0,0,0] neg_hi:[0,0,0]
v_pk_add_f32 v[48:49], v[68:69], v[76:77] op_sel:[1,1] op_sel_hi:[0,0] neg_lo:[0,1] neg_hi:[1,0]
v_pk_add_f32 v[68:69], v[68:69], v[76:77]
v_pk_add_f32 v[76:77], v[70:71], v[78:79] neg_lo:[0,1] neg_hi:[0,1]
v_pk_add_f32 v[70:71], v[70:71], v[78:79]
v_pk_mul_f32 v[78:79], v[76:77], s[62:63] op_sel:[0,0] op_sel_hi:[0,1] neg_lo:[0,1] neg_hi:[0,1]
v_pk_fma_f32 v[78:79], v[76:77], s[62:63], v[78:79] op_sel:[1,1,0] op_sel_hi:[1,0,1] neg_lo:[0,0,0] neg_hi:[0,1,0]
v_pk_add_f32 v[76:77], v[16:17], v[20:21] neg_lo:[0,1] neg_hi:[0,1]
v_pk_add_f32 v[16:17], v[16:17], v[20:21]
v_pk_add_f32 v[20:21], v[18:19], v[22:23] op_sel:[1,1] op_sel_hi:[0,0] neg_lo:[0,1] neg_hi:[1,0]
v_pk_add_f32 v[18:19], v[18:19], v[22:23]
v_pk_add_f32 v[22:23], v[72:73], v[24:25] neg_lo:[0,1] neg_hi:[0,1]
v_pk_add_f32 v[72:73], v[72:73], v[24:25]
v_pk_add_f32 v[24:25], v[26:27], v[30:31] op_sel:[1,1] op_sel_hi:[0,0] neg_lo:[0,1] neg_hi:[1,0]
v_pk_add_f32 v[26:27], v[26:27], v[30:31]
v_pk_add_f32 v[30:31], v[64:65], v[36:37] neg_lo:[0,1] neg_hi:[0,1]
v_pk_add_f32 v[64:65], v[64:65], v[36:37]
v_pk_add_f32 v[36:37], v[34:35], v[38:39] op_sel:[1,1] op_sel_hi:[0,0] neg_lo:[0,1] neg_hi:[1,0]
v_pk_add_f32 v[34:35], v[34:35], v[38:39]
v_pk_add_f32 v[38:39], v[28:29], v[32:33] neg_lo:[0,1] neg_hi:[0,1]
v_pk_add_f32 v[28:29], v[28:29], v[32:33]
v_pk_add_f32 v[32:33], v[42:43], v[46:47] op_sel:[1,1] op_sel_hi:[0,0] neg_lo:[0,1] neg_hi:[1,0]
v_pk_add_f32 v[42:43], v[42:43], v[46:47]
v_pk_add_f32 v[46:47], v[14:15], v[52:53] neg_lo:[0,1] neg_hi:[0,1]
v_pk_add_f32 v[14:15], v[14:15], v[52:53]
v_pk_add_f32 v[52:53], v[50:51], v[54:55] op_sel:[1,1] op_sel_hi:[0,0] neg_lo:[0,1] neg_hi:[1,0]
v_pk_add_f32 v[50:51], v[50:51], v[54:55]
v_pk_add_f32 v[54:55], v[44:45], v[56:57] neg_lo:[0,1] neg_hi:[0,1]
v_pk_add_f32 v[44:45], v[44:45], v[56:57]
v_pk_add_f32 v[56:57], v[58:59], v[62:63] op_sel:[1,1] op_sel_hi:[0,0] neg_lo:[0,1] neg_hi:[1,0]
v_pk_add_f32 v[58:59], v[58:59], v[62:63]
v_pk_add_f32 v[62:63], v[40:41], v[68:69] neg_lo:[0,1] neg_hi:[0,1]
v_pk_add_f32 v[40:41], v[40:41], v[68:69]
v_pk_add_f32 v[68:69], v[66:67], v[70:71] op_sel:[1,1] op_sel_hi:[0,0] neg_lo:[0,1] neg_hi:[1,0]
v_pk_add_f32 v[66:67], v[66:67], v[70:71]
v_pk_add_f32 v[70:71], v[60:61], v[48:49] neg_lo:[0,1] neg_hi:[0,1]
v_pk_add_f32 v[60:61], v[60:61], v[48:49]
v_pk_add_f32 v[48:49], v[74:75], v[78:79] op_sel:[1,1] op_sel_hi:[0,0] neg_lo:[0,1] neg_hi:[1,0]
v_pk_add_f32 v[74:75], v[74:75], v[78:79]
v_pk_add_f32 v[78:79], v[16:17], v[18:19] neg_lo:[0,1] neg_hi:[0,1]
v_pk_add_f32 v[16:17], v[16:17], v[18:19]
v_pk_add_f32 v[18:19], v[76:77], v[20:21] neg_lo:[0,1] neg_hi:[0,1]
v_pk_add_f32 v[76:77], v[76:77], v[20:21]
v_pk_add_f32 v[20:21], v[72:73], v[26:27] neg_lo:[0,1] neg_hi:[0,1]
v_pk_add_f32 v[72:73], v[72:73], v[26:27]
v_pk_add_f32 v[26:27], v[22:23], v[24:25] neg_lo:[0,1] neg_hi:[0,1]
v_pk_add_f32 v[22:23], v[22:23], v[24:25]
v_pk_add_f32 v[24:25], v[64:65], v[34:35] neg_lo:[0,1] neg_hi:[0,1]
v_pk_add_f32 v[64:65], v[64:65], v[34:35]
v_pk_add_f32 v[34:35], v[30:31], v[36:37] neg_lo:[0,1] neg_hi:[0,1]
v_pk_add_f32 v[30:31], v[30:31], v[36:37]
v_pk_add_f32 v[36:37], v[28:29], v[42:43] neg_lo:[0,1] neg_hi:[0,1]
v_pk_add_f32 v[28:29], v[28:29], v[42:43]
v_pk_add_f32 v[42:43], v[38:39], v[32:33] neg_lo:[0,1] neg_hi:[0,1]
v_pk_add_f32 v[38:39], v[38:39], v[32:33]
v_pk_add_f32 v[32:33], v[14:15], v[50:51] neg_lo:[0,1] neg_hi:[0,1]
v_pk_add_f32 v[14:15], v[14:15], v[50:51]
v_pk_add_f32 v[50:51], v[46:47], v[52:53] neg_lo:[0,1] neg_hi:[0,1]
v_pk_add_f32 v[46:47], v[46:47], v[52:53]
v_pk_add_f32 v[52:53], v[44:45], v[58:59] neg_lo:[0,1] neg_hi:[0,1]
v_pk_add_f32 v[44:45], v[44:45], v[58:59]
v_pk_add_f32 v[58:59], v[54:55], v[56:57] neg_lo:[0,1] neg_hi:[0,1]
v_pk_add_f32 v[54:55], v[54:55], v[56:57]
v_pk_add_f32 v[56:57], v[40:41], v[66:67] neg_lo:[0,1] neg_hi:[0,1]
v_pk_add_f32 v[40:41], v[40:41], v[66:67]
v_pk_add_f32 v[66:67], v[62:63], v[68:69] neg_lo:[0,1] neg_hi:[0,1]
v_pk_add_f32 v[62:63], v[62:63], v[68:69]
v_pk_add_f32 v[68:69], v[60:61], v[74:75] neg_lo:[0,1] neg_hi:[0,1]
v_pk_add_f32 v[60:61], v[60:61], v[74:75]
v_pk_add_f32 v[74:75], v[70:71], v[48:49] neg_lo:[0,1] neg_hi:[0,1]
v_pk_add_f32 v[70:71], v[70:71], v[48:49]
ds_write_b64 v4, v[16:17] offset:0
ds_write_b64 v4, v[14:15] offset:256
ds_write_b64 v4, v[64:65] offset:512
ds_write_b64 v4, v[40:41] offset:768
ds_write_b64 v4, v[72:73] offset:1024
ds_write_b64 v4, v[44:45] offset:1280
ds_write_b64 v4, v[28:29] offset:1536
ds_write_b64 v4, v[60:61] offset:1792
ds_write_b64 v4, v[76:77] offset:2048
ds_write_b64 v4, v[46:47] offset:2304
ds_write_b64 v4, v[30:31] offset:2560
ds_write_b64 v4, v[62:63] offset:2816
ds_write_b64 v4, v[22:23] offset:3072
ds_write_b64 v4, v[54:55] offset:3328
ds_write_b64 v4, v[38:39] offset:3584
ds_write_b64 v4, v[70:71] offset:3840
ds_write_b64 v4, v[78:79] offset:4096
ds_write_b64 v4, v[32:33] offset:4352
ds_write_b64 v4, v[24:25] offset:4608
ds_write_b64 v4, v[56:57] offset:4864
ds_write_b64 v4, v[20:21] offset:5120
ds_write_b64 v4, v[52:53] offset:5376
ds_write_b64 v4, v[36:37] offset:5632
ds_write_b64 v4, v[68:69] offset:5888
ds_write_b64 v4, v[18:19] offset:6144
ds_write_b64 v4, v[50:51] offset:6400
ds_write_b64 v4, v[34:35] offset:6656
ds_write_b64 v4, v[66:67] offset:6912
ds_write_b64 v4, v[26:27] offset:7168
ds_write_b64 v4, v[58:59] offset:7424
ds_write_b64 v4, v[42:43] offset:7680
ds_write_b64 v4, v[74:75] offset:7936
ds_write_b64 v4, v[16:17] offset:8192
s_waitcnt lgkmcnt(0)
s_barrier
s_lshl_b32 s13, s93, 7
s_add_u32 s13, s13, 96468992
ds_read_b64 v[16:17], v6 offset:0
ds_read_b64 v[18:19], v7 offset:4096
ds_read_b64 v[20:21], v6 offset:256
ds_read_b64 v[22:23], v7 offset:3840
ds_read_b64 v[24:25], v6 offset:512
ds_read_b64 v[26:27], v7 offset:3584
ds_read_b64 v[28:29], v6 offset:768
ds_read_b64 v[30:31], v7 offset:3328
ds_read_b64 v[32:33], v6 offset:1024
ds_read_b64 v[34:35], v7 offset:3072
ds_read_b64 v[36:37], v6 offset:1280
ds_read_b64 v[38:39], v7 offset:2816
s_waitcnt lgkmcnt(10)
v_pk_add_f32 v[208:209], v[16:17], v[18:19] neg_hi:[0,1]
v_pk_add_f32 v[210:211], v[16:17], v[18:19] op_sel:[1,1] op_sel_hi:[0,0] neg_hi:[1,0]
ds_read_b64 v[40:41], v6 offset:1536
ds_read_b64 v[42:43], v7 offset:2560
buffer_store_dwordx4 v[208:211], v8, s[84:87], s13 offen sc1
s_add_u32 s13, s13, 524288
s_waitcnt lgkmcnt(10)
v_pk_add_f32 v[212:213], v[20:21], v[22:23] neg_hi:[0,1]
v_pk_add_f32 v[214:215], v[20:21], v[22:23] op_sel:[1,1] op_sel_hi:[0,0] neg_hi:[1,0]
ds_read_b64 v[44:45], v6 offset:1792
ds_read_b64 v[46:47], v7 offset:2304
buffer_store_dwordx4 v[212:215], v8, s[84:87], s13 offen sc1
s_add_u32 s13, s13, 524288
s_waitcnt lgkmcnt(10)
v_pk_add_f32 v[216:217], v[24:25], v[26:27] neg_hi:[0,1]
v_pk_add_f32 v[218:219], v[24:25], v[26:27] op_sel:[1,1] op_sel_hi:[0,0] neg_hi:[1,0]
ds_read_b64 v[16:17], v6 offset:2048
ds_read_b64 v[18:19], v7 offset:2048
buffer_store_dwordx4 v[216:219], v8, s[84:87], s13 offen sc1
s_add_u32 s13, s13, 524288
s_waitcnt lgkmcnt(10)
v_pk_add_f32 v[220:221], v[28:29], v[30:31] neg_hi:[0,1]
v_pk_add_f32 v[222:223], v[28:29], v[30:31] op_sel:[1,1] op_sel_hi:[0,0] neg_hi:[1,0]
ds_read_b64 v[20:21], v6 offset:2304
ds_read_b64 v[22:23], v7 offset:1792
buffer_store_dwordx4 v[220:223], v8, s[84:87], s13 offen sc1
s_add_u32 s13, s13, 524288
s_waitcnt lgkmcnt(10)
v_pk_add_f32 v[224:225], v[32:33], v[34:35] neg_hi:[0,1]
v_pk_add_f32 v[226:227], v[32:33], v[34:35] op_sel:[1,1] op_sel_hi:[0,0] neg_hi:[1,0]
ds_read_b64 v[24:25], v6 offset:2560
ds_read_b64 v[26:27], v7 offset:1536
buffer_store_dwordx4 v[224:227], v8, s[84:87], s13 offen sc1
s_add_u32 s13, s13, 524288
s_waitcnt lgkmcnt(10)
v_pk_add_f32 v[228:229], v[36:37], v[38:39] neg_hi:[0,1]
v_pk_add_f32 v[230:231], v[36:37], v[38:39] op_sel:[1,1] op_sel_hi:[0,0] neg_hi:[1,0]
ds_read_b64 v[28:29], v6 offset:2816
ds_read_b64 v[30:31], v7 offset:1280
buffer_store_dwordx4 v[228:231], v8, s[84:87], s13 offen sc1
s_add_u32 s13, s13, 524288
s_waitcnt lgkmcnt(10)
v_pk_add_f32 v[232:233], v[40:41], v[42:43] neg_hi:[0,1]
v_pk_add_f32 v[234:235], v[40:41], v[42:43] op_sel:[1,1] op_sel_hi:[0,0] neg_hi:[1,0]
ds_read_b64 v[32:33], v6 offset:3072
ds_read_b64 v[34:35], v7 offset:1024
buffer_store_dwordx4 v[232:235], v8, s[84:87], s13 offen sc1
s_add_u32 s13, s13, 524288
s_waitcnt lgkmcnt(10)
v_pk_add_f32 v[236:237], v[44:45], v[46:47] neg_hi:[0,1]
v_pk_add_f32 v[238:239], v[44:45], v[46:47] op_sel:[1,1] op_sel_hi:[0,0] neg_hi:[1,0]
ds_read_b64 v[36:37], v6 offset:3328
ds_read_b64 v[38:39], v7 offset:768
buffer_store_dwordx4 v[236:239], v8, s[84:87], s13 offen sc1
s_add_u32 s13, s13, 524288
s_waitcnt lgkmcnt(10)
v_pk_add_f32 v[208:209], v[16:17], v[18:19] neg_hi:[0,1]
v_pk_add_f32 v[210:211], v[16:17], v[18:19] op_sel:[1,1] op_sel_hi:[0,0] neg_hi:[1,0]
ds_read_b64 v[40:41], v6 offset:3584
ds_read_b64 v[42:43], v7 offset:512
buffer_store_dwordx4 v[208:211], v8, s[84:87], s13 offen sc1
s_add_u32 s13, s13, 524288
s_waitcnt lgkmcnt(10)
v_pk_add_f32 v[212:213], v[20:21], v[22:23] neg_hi:[0,1]
v_pk_add_f32 v[214:215], v[20:21], v[22:23] op_sel:[1,1] op_sel_hi:[0,0] neg_hi:[1,0]
ds_read_b64 v[44:45], v6 offset:3840
ds_read_b64 v[46:47], v7 offset:256
buffer_store_dwordx4 v[212:215], v8, s[84:87], s13 offen sc1
s_add_u32 s13, s13, 524288
s_waitcnt lgkmcnt(10)
v_pk_add_f32 v[216:217], v[24:25], v[26:27] neg_hi:[0,1]
v_pk_add_f32 v[218:219], v[24:25], v[26:27] op_sel:[1,1] op_sel_hi:[0,0] neg_hi:[1,0]
ds_read_b64 v[16:17], v6 offset:4096
ds_read_b64 v[18:19], v7 offset:0
buffer_store_dwordx4 v[216:219], v8, s[84:87], s13 offen sc1
s_add_u32 s13, s13, 524288
s_waitcnt lgkmcnt(10)
v_pk_add_f32 v[220:221], v[28:29], v[30:31] neg_hi:[0,1]
v_pk_add_f32 v[222:223], v[28:29], v[30:31] op_sel:[1,1] op_sel_hi:[0,0] neg_hi:[1,0]
buffer_store_dwordx4 v[220:223], v8, s[84:87], s13 offen sc1
s_add_u32 s13, s13, 524288
s_waitcnt lgkmcnt(8)
v_pk_add_f32 v[224:225], v[32:33], v[34:35] neg_hi:[0,1]
v_pk_add_f32 v[226:227], v[32:33], v[34:35] op_sel:[1,1] op_sel_hi:[0,0] neg_hi:[1,0]
buffer_store_dwordx4 v[224:227], v8, s[84:87], s13 offen sc1
s_add_u32 s13, s13, 524288
s_waitcnt lgkmcnt(6)
v_pk_add_f32 v[228:229], v[36:37], v[38:39] neg_hi:[0,1]
v_pk_add_f32 v[230:231], v[36:37], v[38:39] op_sel:[1,1] op_sel_hi:[0,0] neg_hi:[1,0]
buffer_store_dwordx4 v[228:231], v8, s[84:87], s13 offen sc1
s_add_u32 s13, s13, 524288
s_waitcnt lgkmcnt(4)
v_pk_add_f32 v[232:233], v[40:41], v[42:43] neg_hi:[0,1]
v_pk_add_f32 v[234:235], v[40:41], v[42:43] op_sel:[1,1] op_sel_hi:[0,0] neg_hi:[1,0]
buffer_store_dwordx4 v[232:235], v8, s[84:87], s13 offen sc1
s_add_u32 s13, s13, 524288
s_waitcnt lgkmcnt(2)
v_pk_add_f32 v[236:237], v[44:45], v[46:47] neg_hi:[0,1]
v_pk_add_f32 v[238:239], v[44:45], v[46:47] op_sel:[1,1] op_sel_hi:[0,0] neg_hi:[1,0]
buffer_store_dwordx4 v[236:239], v8, s[84:87], s13 offen sc1
s_add_u32 s13, s13, 524288
s_waitcnt lgkmcnt(0)
v_pk_add_f32 v[208:209], v[16:17], v[18:19] neg_hi:[0,1]
v_pk_add_f32 v[210:211], v[16:17], v[18:19] op_sel:[1,1] op_sel_hi:[0,0] neg_hi:[1,0]
v_cmp_eq_u32 vcc, 0, v9
s_nop 1
v_cndmask_b32 v13, -16, v8, vcc
buffer_store_dwordx4 v[208:211], v13, s[84:87], s13 offen sc1
s_add_u32 s13, s13, 524288
s_mov_b32 s93, s21
s_cmp_lt_u32 s93, 128
s_cbranch_scc1 mega_kernel_f1_l
mega_kernel_f1_e:
s_mov_b32 s93, s40
s_waitcnt vmcnt(0)
s_load_dwordx2 s[4:5], s[0:1], 64
s_load_dwordx2 s[8:9], s[0:1], 72
v_and_b32 v1, 63, v0
v_lshrrev_b32 v2, 6, v0
v_mul_u32_u24 v3, 1026, v2
v_lshl_add_u32 v3, v1, 1, v3
v_mul_u32_u24 v4, 65, v1
v_add_u32 v4, v4, v2
v_lshlrev_b32 v4, 2, v4
v_lshrrev_b32 v7, 4, v0
v_and_b32 v8, 15, v0
v_mul_u32_u24 v5, 65, v7
v_lshl_add_u32 v5, v8, 2, v5
v_lshlrev_b32 v5, 2, v5
v_lshlrev_b32 v6, 13, v7
v_lshl_add_u32 v6, v8, 4, v6
s_add_u32 s24, s84, 121634816
s_addc_u32 s25, s85, 0
s_mov_b32 s26, 4202496
s_mov_b32 s27, 0x00020000
s_waitcnt lgkmcnt(0)
s_mov_b32 s6, 2101248
s_mov_b32 s7, 0x00020000
s_mov_b32 s10, 2101248
s_mov_b32 s11, 0x00020000
s_cmp_lt_u32 s93, 288
s_cbranch_scc0 mega_kernel_f0_e
s_and_b32 s12, s93, 31
s_mul_i32 s12, s12, 65664
s_lshr_b32 s13, s93, 5
s_lshl_b32 s13, s13, 7
s_add_u32 s12, s12, s13
buffer_load_ushort v16, v3, s[4:7], s12 offen
buffer_load_ushort v32, v3, s[8:11], s12 offen
s_add_u32 s12, s12, 4104
buffer_load_ushort v17, v3, s[4:7], s12 offen
buffer_load_ushort v33, v3, s[8:11], s12 offen
s_add_u32 s12, s12, 4104
buffer_load_ushort v18, v3, s[4:7], s12 offen
buffer_load_ushort v34, v3, s[8:11], s12 offen
s_add_u32 s12, s12, 4104
buffer_load_ushort v19, v3, s[4:7], s12 offen
buffer_load_ushort v35, v3, s[8:11], s12 offen
s_add_u32 s12, s12, 4104
buffer_load_ushort v20, v3, s[4:7], s12 offen
buffer_load_ushort v36, v3, s[8:11], s12 offen
s_add_u32 s12, s12, 4104
buffer_load_ushort v21, v3, s[4:7], s12 offen
buffer_load_ushort v37, v3, s[8:11], s12 offen
s_add_u32 s12, s12, 4104
buffer_load_ushort v22, v3, s[4:7], s12 offen
buffer_load_ushort v38, v3, s[8:11], s12 offen
s_add_u32 s12, s12, 4104
buffer_load_ushort v23, v3, s[4:7], s12 offen
buffer_load_ushort v39, v3, s[8:11], s12 offen
s_add_u32 s12, s12, 4104
buffer_load_ushort v24, v3, s[4:7], s12 offen
buffer_load_ushort v40, v3, s[8:11], s12 offen
s_add_u32 s12, s12, 4104
buffer_load_ushort v25, v3, s[4:7], s12 offen
buffer_load_ushort v41, v3, s[8:11], s12 offen
s_add_u32 s12, s12, 4104
buffer_load_ushort v26, v3, s[4:7], s12 offen
buffer_load_ushort v42, v3, s[8:11], s12 offen
s_add_u32 s12, s12, 4104
buffer_load_ushort v27, v3, s[4:7], s12 offen
buffer_load_ushort v43, v3, s[8:11], s12 offen
s_add_u32 s12, s12, 4104
buffer_load_ushort v28, v3, s[4:7], s12 offen
buffer_load_ushort v44, v3, s[8:11], s12 offen
s_add_u32 s12, s12, 4104
buffer_load_ushort v29, v3, s[4:7], s12 offen
buffer_load_ushort v45, v3, s[8:11], s12 offen
s_add_u32 s12, s12, 4104
buffer_load_ushort v30, v3, s[4:7], s12 offen
buffer_load_ushort v46, v3, s[8:11], s12 offen
s_add_u32 s12, s12, 4104
buffer_load_ushort v31, v3, s[4:7], s12 offen
buffer_load_ushort v47, v3, s[8:11], s12 offen
s_add_u32 s12, s12, 4104
s_waitcnt vmcnt(0)
mega_kernel_f0_l:
s_add_u32 s21, s93, 32
s_cmp_lt_u32 s21, 288
s_cselect_b32 s22, s21, s93
s_waitcnt vmcnt(4)
v_lshl_or_b32 v48, v32, 16, v16
v_lshl_or_b32 v49, v33, 16, v17
v_lshl_or_b32 v50, v34, 16, v18
v_lshl_or_b32 v51, v35, 16, v19
v_lshl_or_b32 v52, v36, 16, v20
v_lshl_or_b32 v53, v37, 16, v21
v_lshl_or_b32 v54, v38, 16, v22
v_lshl_or_b32 v55, v39, 16, v23
v_lshl_or_b32 v56, v40, 16, v24
v_lshl_or_b32 v57, v41, 16, v25
v_lshl_or_b32 v58, v42, 16, v26
v_lshl_or_b32 v59, v43, 16, v27
v_lshl_or_b32 v60, v44, 16, v28
v_lshl_or_b32 v61, v45, 16, v29
v_lshl_or_b32 v62, v46, 16, v30
v_lshl_or_b32 v63, v47, 16, v31
s_and_b32 s12, s22, 31
s_mul_i32 s12, s12, 65664
s_lshr_b32 s13, s22, 5
s_lshl_b32 s13, s13, 7
s_add_u32 s12, s12, s13
buffer_load_ushort v16, v3, s[4:7], s12 offen
buffer_load_ushort v32, v3, s[8:11], s12 offen
s_add_u32 s12, s12, 4104
buffer_load_ushort v17, v3, s[4:7], s12 offen
buffer_load_ushort v33, v3, s[8:11], s12 offen
s_add_u32 s12, s12, 4104
buffer_load_ushort v18, v3, s[4:7], s12 offen
buffer_load_ushort v34, v3, s[8:11], s12 offen
s_add_u32 s12, s12, 4104
buffer_load_ushort v19, v3, s[4:7], s12 offen
buffer_load_ushort v35, v3, s[8:11], s12 offen
s_add_u32 s12, s12, 4104
buffer_load_ushort v20, v3, s[4:7], s12 offen
buffer_load_ushort v36, v3, s[8:11], s12 offen
s_add_u32 s12, s12, 4104
buffer_load_ushort v21, v3, s[4:7], s12 offen
buffer_load_ushort v37, v3, s[8:11], s12 offen
s_add_u32 s12, s12, 4104
buffer_load_ushort v22, v3, s[4:7], s12 offen
buffer_load_ushort v38, v3, s[8:11], s12 offen
s_add_u32 s12, s12, 4104
buffer_load_ushort v23, v3, s[4:7], s12 offen
buffer_load_ushort v39, v3, s[8:11], s12 offen
s_add_u32 s12, s12, 4104
buffer_load_ushort v24, v3, s[4:7], s12 offen
buffer_load_ushort v40, v3, s[8:11], s12 offen
s_add_u32 s12, s12, 4104
buffer_load_ushort v25, v3, s[4:7], s12 offen
buffer_load_ushort v41, v3, s[8:11], s12 offen
s_add_u32 s12, s12, 4104
buffer_load_ushort v26, v3, s[4:7], s12 offen
buffer_load_ushort v42, v3, s[8:11], s12 offen
s_add_u32 s12, s12, 4104
buffer_load_ushort v27, v3, s[4:7], s12 offen
buffer_load_ushort v43, v3, s[8:11], s12 offen
s_add_u32 s12, s12, 4104
buffer_load_ushort v28, v3, s[4:7], s12 offen
buffer_load_ushort v44, v3, s[8:11], s12 offen
s_add_u32 s12, s12, 4104
buffer_load_ushort v29, v3, s[4:7], s12 offen
buffer_load_ushort v45, v3, s[8:11], s12 offen
s_add_u32 s12, s12, 4104
buffer_load_ushort v30, v3, s[4:7], s12 offen
buffer_load_ushort v46, v3, s[8:11], s12 offen
s_add_u32 s12, s12, 4104
buffer_load_ushort v31, v3, s[4:7], s12 offen
buffer_load_ushort v47, v3, s[8:11], s12 offen
s_add_u32 s12, s12, 4104
s_barrier
ds_write_b32 v4, v48 offset:0
ds_write_b32 v4, v49 offset:16
ds_write_b32 v4, v50 offset:32
ds_write_b32 v4, v51 offset:48
ds_write_b32 v4, v52 offset:64
ds_write_b32 v4, v53 offset:80
ds_write_b32 v4, v54 offset:96
ds_write_b32 v4, v55 offset:112
ds_write_b32 v4, v56 offset:128
ds_write_b32 v4, v57 offset:144
ds_write_b32 v4, v58 offset:160
ds_write_b32 v4, v59 offset:176
s_waitcnt lgkmcnt(4)
ds_write_b32 v4, v60 offset:192
ds_write_b32 v4, v61 offset:208
ds_write_b32 v4, v62 offset:224
ds_write_b32 v4, v63 offset:240
s_waitcnt lgkmcnt(0)
s_barrier
ds_read2_b32 v[64:65], v5 offset0:0 offset1:1
ds_read_b32 v66, v5 offset:8
ds_read_b32 v67, v5 offset:12
ds_read_b32 v68, v5 offset:4160
ds_read_b32 v69, v5 offset:4164
ds_read_b32 v70, v5 offset:4168
ds_read_b32 v71, v5 offset:4172
ds_read_b32 v72, v5 offset:8320
ds_read_b32 v73, v5 offset:8324
ds_read_b32 v74, v5 offset:8328
ds_read_b32 v75, v5 offset:8332
ds_read_b32 v76, v5 offset:12480
ds_read_b32 v77, v5 offset:12484
ds_read_b32 v78, v5 offset:12488
ds_read_b32 v79, v5 offset:12492
s_and_b32 s14, s93, 31
s_lshl_b32 s14, s14, 8
s_lshr_b32 s15, s93, 5
s_lshl_b32 s15, s15, 19
s_add_u32 s14, s14, s15
s_waitcnt lgkmcnt(0)
buffer_store_dwordx4 v[64:67], v6, s[24:27], s14 offen sc1
s_add_u32 s14, s14, 131072
buffer_store_dwordx4 v[68:71], v6, s[24:27], s14 offen sc1
s_add_u32 s14, s14, 131072
buffer_store_dwordx4 v[72:75], v6, s[24:27], s14 offen sc1
s_add_u32 s14, s14, 131072
buffer_store_dwordx4 v[76:79], v6, s[24:27], s14 offen sc1
s_add_u32 s14, s14, 131072
s_mov_b32 s93, s21
s_cmp_lt_u32 s93, 288
s_cbranch_scc1 mega_kernel_f0_l
mega_kernel_f0_e:
v_and_b32 v3, 15, v0
v_lshlrev_b32 v3, 4, v3
s_branch mega_kernel_syd
mega_kernel_sydw:
s_sleep 4
mega_kernel_syd:
buffer_load_dword v2, v3, s[72:75], 0 offen sc1
s_waitcnt vmcnt(0)
s_cmp_eq_u32 s95, 1
s_cbranch_scc0 mega_kernel_sydf
v_readlane_b32 s76, v2, 14
s_mov_b32 s98, 0
s_cmp_eq_u32 s76, 64
s_cbranch_scc0 mega_kernel_sydw
s_branch mega_kernel_sydd
mega_kernel_sydf:
s_mov_b32 s77, 0
s_mov_b32 s78, 0
v_readlane_b32 s76, v2, 0
s_add_u32 s77, s77, s76
s_xor_b32 s76, s76, 32
s_or_b32 s78, s78, s76
v_readlane_b32 s76, v2, 1
s_add_u32 s77, s77, s76
s_xor_b32 s76, s76, 32
s_or_b32 s78, s78, s76
v_readlane_b32 s76, v2, 2
s_add_u32 s77, s77, s76
s_xor_b32 s76, s76, 32
s_or_b32 s78, s78, s76
v_readlane_b32 s76, v2, 3
s_add_u32 s77, s77, s76
s_xor_b32 s76, s76, 32
s_or_b32 s78, s78, s76
v_readlane_b32 s76, v2, 4
s_add_u32 s77, s77, s76
s_xor_b32 s76, s76, 32
s_or_b32 s78, s78, s76
v_readlane_b32 s76, v2, 5
s_add_u32 s77, s77, s76
s_xor_b32 s76, s76, 32
s_or_b32 s78, s78, s76
v_readlane_b32 s76, v2, 6
s_add_u32 s77, s77, s76
s_xor_b32 s76, s76, 32
s_or_b32 s78, s78, s76
v_readlane_b32 s76, v2, 7
s_add_u32 s77, s77, s76
s_xor_b32 s76, s76, 32
s_or_b32 s78, s78, s76
s_cmp_eq_u32 s77, 256
s_cbranch_scc0 mega_kernel_sydw
v_mov_b32 v252, v2
s_cmp_eq_u32 s78, 0
s_cbranch_scc0 mega_kernel_slowent
v_readlane_b32 s76, v2, 10
v_readlane_b32 s77, v2, 8
s_cmp_eq_u32 s76, 64
s_cbranch_scc0 mega_kernel_sydw
s_cmp_gt_u32 s77, 32
s_cselect_b32 s98, 1, 0
mega_kernel_sydd:
s_waitcnt vmcnt(0)
s_barrier
v_mov_b32 v1, 0
v_mov_b32 v2, 1
s_mov_b32 s82, 69259264
v_cmp_eq_u32 vcc, 0, v0
s_and_saveexec_b64 s[80:81], vcc
s_cbranch_execz mega_kernel_sg0
buffer_atomic_add v2, v1, s[84:87], s82 offen sc1
mega_kernel_sg0:
s_mov_b64 exec, s[80:81]
s_add_u32 s38, s40, 129
s_mov_b32 s39, 32
s_mov_b32 s37, 129
s_cmp_lt_u32 s38, 129
s_cbranch_scc1 mega_kernel_f2s
s_branch mega_kernel_f2e
mega_kernel_rk:
s_load_dwordx2 s[4:5], s[0:1], 24
s_load_dwordx2 s[8:9], s[0:1], 0
v_lshrrev_b32 v2, 6, v0
v_and_b32 v1, 63, v0
v_readfirstlane_b32 s41, v2
v_lshlrev_b32 v5, 4, v1
s_waitcnt lgkmcnt(0)
s_mov_b32 s6, 8388608
s_mov_b32 s7, 0x00020000
s_mov_b32 s10, 4194304
s_mov_b32 s11, 0x00020000
s_lshl_b32 s43, s40, 8
s_lshl_b32 s44, s41, 6
s_add_u32 s48, s43, s44
s_and_b32 s43, s48, 0x7ff
v_add_u32 v19, s43, v1
v_lshlrev_b32 v19, 7, v19
buffer_load_dword v250, v19, s[8:11], 0 offen
s_nop 0
v_lshrrev_b32 v2, 3, v1
s_lshl_b32 s43, s41, 3
v_add_u32 v2, s43, v2
v_bfe_u32 v3, v2, 1, 3
v_and_b32 v4, 7, v1
v_xor_b32 v3, v3, v4
v_lshlrev_b32 v6, 11, v2
v_lshl_add_u32 v6, v3, 4, v6
s_lshl_b32 s46, s41, 10
v_and_b32 v2, 15, v1
v_bfe_u32 v3, v2, 1, 3
v_lshrrev_b32 v4, 4, v1
v_xor_b32 v3, v3, v4
v_lshlrev_b32 v8, 7, v2
v_lshl_add_u32 v8, v3, 4, v8
v_xor_b32 v9, 64, v8
v_add_u32 v10, 0x10000, v8
v_add_u32 v11, 0x10000, v9
v_mov_b32 v7, v5
s_lshl_b32 s47, s40, 2
s_add_u32 s47, s47, s41
s_mov_b32 s42, 0
s_mov_b32 s50, 0
s_add_u32 m0, s46, 0
s_nop 0
buffer_load_dwordx4 v6, s[8:11], s50 offen offset:0 lds
s_add_u32 m0, s46, 3968
s_nop 0
buffer_load_dwordx4 v6, s[8:11], s50 offen offset:128 lds
s_add_u32 m0, s46, 7936
s_nop 0
buffer_load_dwordx4 v6, s[8:11], s50 offen offset:256 lds
s_add_u32 m0, s46, 11904
s_nop 0
buffer_load_dwordx4 v6, s[8:11], s50 offen offset:384 lds
s_add_u32 m0, s46, 15872
s_nop 0
buffer_load_dwordx4 v6, s[8:11], s50 offen offset:512 lds
s_add_u32 m0, s46, 19840
s_nop 0
buffer_load_dwordx4 v6, s[8:11], s50 offen offset:640 lds
s_add_u32 m0, s46, 23808
s_nop 0
buffer_load_dwordx4 v6, s[8:11], s50 offen offset:768 lds
s_add_u32 m0, s46, 27776
s_nop 0
buffer_load_dwordx4 v6, s[8:11], s50 offen offset:896 lds
s_add_u32 m0, s46, 31744
s_nop 0
buffer_load_dwordx4 v6, s[8:11], s50 offen offset:1024 lds
s_add_u32 m0, s46, 35712
s_nop 0
buffer_load_dwordx4 v6, s[8:11], s50 offen offset:1152 lds
s_add_u32 m0, s46, 39680
s_nop 0
buffer_load_dwordx4 v6, s[8:11], s50 offen offset:1280 lds
s_add_u32 m0, s46, 43648
s_nop 0
buffer_load_dwordx4 v6, s[8:11], s50 offen offset:1408 lds
s_add_u32 m0, s46, 47616
s_nop 0
buffer_load_dwordx4 v6, s[8:11], s50 offen offset:1536 lds
s_add_u32 m0, s46, 51584
s_nop 0
buffer_load_dwordx4 v6, s[8:11], s50 offen offset:1664 lds
s_add_u32 m0, s46, 55552
s_nop 0
buffer_load_dwordx4 v6, s[8:11], s50 offen offset:1792 lds
s_add_u32 m0, s46, 59520
s_nop 0
buffer_load_dwordx4 v6, s[8:11], s50 offen offset:1920 lds
v_lshrrev_b32 v2, 2, v1
v_and_b32 v3, 3, v1
v_lshlrev_b32 v16, 13, v2
v_lshl_add_u32 v16, v3, 4, v16
v_add_u32 v16, s48, v16
s_mul_i32 s45, s41, 24576
s_add_u32 s45, s45, 65536
v_bfe_u32 v17, v1, 2, 2
v_lshrrev_b32 v18, 4, v1
v_lshl_add_u32 v17, v18, 3, v17
v_lshlrev_b32 v17, 6, v17
v_lshl_add_u32 v17, v3, 4, v17
v_add_u32 v17, s45, v17
s_and_b32 s43, s40, 3
s_lshl_b32 s43, s43, 2
s_add_u32 s43, s43, s41
s_lshl_b32 s43, s43, 3
v_and_b32 v12, 7, v1
v_add_u32 v12, s43, v12
s_lshr_b32 s43, s40, 2
s_lshl_b32 s43, s43, 10
s_add_u32 s44, s43, 896
s_add_u32 s43, s43, 384
s_cmp_ge_u32 s40, 28
s_cselect_b32 s44, s44, s43
v_mov_b32 v13, s43
v_mov_b32 v14, s44
v_cmp_gt_u32 vcc, 32, v1
s_nop 1
v_cndmask_b32 v13, v14, v13, vcc
v_lshl_add_u32 v12, v12, 13, v13
s_mov_b32 s44, 0
buffer_load_dword v250, v12, s[4:7], s44 offen
s_add_u32 m0, s45, 0
s_mov_b32 s44, 0
buffer_load_dwordx4 v16, s[4:7], s44 offen lds
s_add_u32 m0, s45, 1024
s_mov_b32 s44, 131072
buffer_load_dwordx4 v16, s[4:7], s44 offen lds
s_add_u32 m0, s45, 2048
s_mov_b32 s44, 262144
buffer_load_dwordx4 v16, s[4:7], s44 offen lds
s_add_u32 m0, s45, 3072
s_mov_b32 s44, 393216
buffer_load_dwordx4 v16, s[4:7], s44 offen lds
s_add_u32 m0, s45, 4096
s_mov_b32 s44, 524288
buffer_load_dwordx4 v16, s[4:7], s44 offen lds
s_add_u32 m0, s45, 5120
s_mov_b32 s44, 655360
buffer_load_dwordx4 v16, s[4:7], s44 offen lds
s_add_u32 m0, s45, 6144
s_mov_b32 s44, 786432
buffer_load_dwordx4 v16, s[4:7], s44 offen lds
s_add_u32 m0, s45, 7168
s_mov_b32 s44, 917504
buffer_load_dwordx4 v16, s[4:7], s44 offen lds
s_mov_b32 s44, 1048576
buffer_load_dword v250, v12, s[4:7], s44 offen
s_add_u32 m0, s45, 8192
s_mov_b32 s44, 1048576
buffer_load_dwordx4 v16, s[4:7], s44 offen lds
s_add_u32 m0, s45, 9216
s_mov_b32 s44, 1179648
buffer_load_dwordx4 v16, s[4:7], s44 offen lds
s_add_u32 m0, s45, 10240
s_mov_b32 s44, 1310720
buffer_load_dwordx4 v16, s[4:7], s44 offen lds
s_add_u32 m0, s45, 11264
s_mov_b32 s44, 1441792
buffer_load_dwordx4 v16, s[4:7], s44 offen lds
s_add_u32 m0, s45, 12288
s_mov_b32 s44, 1572864
buffer_load_dwordx4 v16, s[4:7], s44 offen lds
s_add_u32 m0, s45, 13312
s_mov_b32 s44, 1703936
buffer_load_dwordx4 v16, s[4:7], s44 offen lds
s_add_u32 m0, s45, 14336
s_mov_b32 s44, 1835008
buffer_load_dwordx4 v16, s[4:7], s44 offen lds
s_add_u32 m0, s45, 15360
s_mov_b32 s44, 1966080
buffer_load_dwordx4 v16, s[4:7], s44 offen lds
s_mov_b32 s44, 2097152
buffer_load_dword v250, v12, s[4:7], s44 offen
s_add_u32 m0, s45, 16384
s_mov_b32 s44, 2097152
buffer_load_dwordx4 v16, s[4:7], s44 offen lds
s_add_u32 m0, s45, 17408
s_mov_b32 s44, 2228224
buffer_load_dwordx4 v16, s[4:7], s44 offen lds
s_add_u32 m0, s45, 18432
s_mov_b32 s44, 2359296
buffer_load_dwordx4 v16, s[4:7], s44 offen lds
s_add_u32 m0, s45, 19456
s_mov_b32 s44, 2490368
buffer_load_dwordx4 v16, s[4:7], s44 offen lds
s_add_u32 m0, s45, 20480
s_mov_b32 s44, 2621440
buffer_load_dwordx4 v16, s[4:7], s44 offen lds
s_add_u32 m0, s45, 21504
s_mov_b32 s44, 2752512
buffer_load_dwordx4 v16, s[4:7], s44 offen lds
s_add_u32 m0, s45, 22528
s_mov_b32 s44, 2883584
buffer_load_dwordx4 v16, s[4:7], s44 offen lds
s_add_u32 m0, s45, 23552
s_mov_b32 s44, 3014656
buffer_load_dwordx4 v16, s[4:7], s44 offen lds
s_waitcnt vmcnt(18)
s_barrier
ds_read_b64_tr_b16 a[0:1], v17 offset:0
ds_read_b64_tr_b16 a[2:3], v17 offset:256
ds_read_b64_tr_b16 a[4:5], v17 offset:8
ds_read_b64_tr_b16 a[6:7], v17 offset:264
ds_read_b64_tr_b16 a[8:9], v17 offset:2048
ds_read_b64_tr_b16 a[10:11], v17 offset:2304
ds_read_b64_tr_b16 a[12:13], v17 offset:2056
ds_read_b64_tr_b16 a[14:15], v17 offset:2312
s_waitcnt lgkmcnt(0)
ds_read_b64_tr_b16 a[16:17], v17 offset:4096
ds_read_b64_tr_b16 a[18:19], v17 offset:4352
ds_read_b64_tr_b16 a[20:21], v17 offset:4104
ds_read_b64_tr_b16 a[22:23], v17 offset:4360
ds_read_b64_tr_b16 a[24:25], v17 offset:6144
ds_read_b64_tr_b16 a[26:27], v17 offset:6400
ds_read_b64_tr_b16 a[28:29], v17 offset:6152
ds_read_b64_tr_b16 a[30:31], v17 offset:6408
s_waitcnt lgkmcnt(0)
ds_read_b128 v[20:23], v8 offset:0
ds_read_b128 v[24:27], v8 offset:2048
ds_read_b128 v[28:31], v9 offset:0
ds_read_b128 v[32:35], v9 offset:2048
ds_read_b128 v[36:39], v8 offset:4096
ds_read_b128 v[40:43], v8 offset:6144
ds_read_b128 v[44:47], v9 offset:4096
ds_read_b128 v[48:51], v9 offset:6144
s_mov_b32 s44, 3145728
buffer_load_dword v250, v12, s[4:7], s44 offen
s_add_u32 m0, s45, 0
s_mov_b32 s44, 3145728
buffer_load_dwordx4 v16, s[4:7], s44 offen lds
s_add_u32 m0, s45, 1024
s_mov_b32 s44, 3276800
buffer_load_dwordx4 v16, s[4:7], s44 offen lds
s_add_u32 m0, s45, 2048
s_mov_b32 s44, 3407872
buffer_load_dwordx4 v16, s[4:7], s44 offen lds
s_add_u32 m0, s45, 3072
s_mov_b32 s44, 3538944
buffer_load_dwordx4 v16, s[4:7], s44 offen lds
s_add_u32 m0, s45, 4096
s_mov_b32 s44, 3670016
buffer_load_dwordx4 v16, s[4:7], s44 offen lds
s_add_u32 m0, s45, 5120
s_mov_b32 s44, 3801088
buffer_load_dwordx4 v16, s[4:7], s44 offen lds
s_add_u32 m0, s45, 6144
s_mov_b32 s44, 3932160
buffer_load_dwordx4 v16, s[4:7], s44 offen lds
s_add_u32 m0, s45, 7168
s_mov_b32 s44, 4063232
buffer_load_dwordx4 v16, s[4:7], s44 offen lds
s_waitcnt lgkmcnt(0)
v_mfma_f32_16x16x32_bf16 v[52:55], a[0:3], v[20:23], 0
v_mfma_f32_16x16x32_bf16 v[56:59], a[4:7], v[20:23], 0
v_mfma_f32_16x16x32_bf16 v[60:63], a[0:3], v[24:27], 0
v_mfma_f32_16x16x32_bf16 v[64:67], a[4:7], v[24:27], 0
v_mfma_f32_16x16x32_bf16 v[52:55], a[8:11], v[28:31], v[52:55]
v_mfma_f32_16x16x32_bf16 v[56:59], a[12:15], v[28:31], v[56:59]
v_mfma_f32_16x16x32_bf16 v[60:63], a[8:11], v[32:35], v[60:63]
v_mfma_f32_16x16x32_bf16 v[64:67], a[12:15], v[32:35], v[64:67]
v_mfma_f32_16x16x32_bf16 v[52:55], a[16:19], v[36:39], v[52:55]
v_mfma_f32_16x16x32_bf16 v[56:59], a[20:23], v[36:39], v[56:59]
v_mfma_f32_16x16x32_bf16 v[60:63], a[16:19], v[40:43], v[60:63]
v_mfma_f32_16x16x32_bf16 v[64:67], a[20:23], v[40:43], v[64:67]
v_mfma_f32_16x16x32_bf16 v[52:55], a[24:27], v[44:47], v[52:55]
v_mfma_f32_16x16x32_bf16 v[56:59], a[28:31], v[44:47], v[56:59]
v_mfma_f32_16x16x32_bf16 v[60:63], a[24:27], v[48:51], v[60:63]
v_mfma_f32_16x16x32_bf16 v[64:67], a[28:31], v[48:51], v[64:67]
s_waitcnt vmcnt(18)
ds_read_b64_tr_b16 a[32:33], v17 offset:8192
ds_read_b64_tr_b16 a[34:35], v17 offset:8448
ds_read_b64_tr_b16 a[36:37], v17 offset:8200
ds_read_b64_tr_b16 a[38:39], v17 offset:8456
ds_read_b64_tr_b16 a[40:41], v17 offset:10240
ds_read_b64_tr_b16 a[42:43], v17 offset:10496
ds_read_b64_tr_b16 a[44:45], v17 offset:10248
ds_read_b64_tr_b16 a[46:47], v17 offset:10504
s_waitcnt lgkmcnt(0)
ds_read_b64_tr_b16 a[48:49], v17 offset:12288
ds_read_b64_tr_b16 a[50:51], v17 offset:12544
ds_read_b64_tr_b16 a[52:53], v17 offset:12296
ds_read_b64_tr_b16 a[54:55], v17 offset:12552
ds_read_b64_tr_b16 a[56:57], v17 offset:14336
ds_read_b64_tr_b16 a[58:59], v17 offset:14592
ds_read_b64_tr_b16 a[60:61], v17 offset:14344
ds_read_b64_tr_b16 a[62:63], v17 offset:14600
s_waitcnt lgkmcnt(0)
ds_read_b128 v[20:23], v8 offset:8192
ds_read_b128 v[24:27], v8 offset:10240
ds_read_b128 v[28:31], v9 offset:8192
ds_read_b128 v[32:35], v9 offset:10240
ds_read_b128 v[36:39], v8 offset:12288
ds_read_b128 v[40:43], v8 offset:14336
ds_read_b128 v[44:47], v9 offset:12288
ds_read_b128 v[48:51], v9 offset:14336
s_mov_b32 s44, 4194304
buffer_load_dword v250, v12, s[4:7], s44 offen
s_add_u32 m0, s45, 8192
s_mov_b32 s44, 4194304
buffer_load_dwordx4 v16, s[4:7], s44 offen lds
s_add_u32 m0, s45, 9216
s_mov_b32 s44, 4325376
buffer_load_dwordx4 v16, s[4:7], s44 offen lds
s_add_u32 m0, s45, 10240
s_mov_b32 s44, 4456448
buffer_load_dwordx4 v16, s[4:7], s44 offen lds
s_add_u32 m0, s45, 11264
s_mov_b32 s44, 4587520
buffer_load_dwordx4 v16, s[4:7], s44 offen lds
s_add_u32 m0, s45, 12288
s_mov_b32 s44, 4718592
buffer_load_dwordx4 v16, s[4:7], s44 offen lds
s_add_u32 m0, s45, 13312
s_mov_b32 s44, 4849664
buffer_load_dwordx4 v16, s[4:7], s44 offen lds
s_add_u32 m0, s45, 14336
s_mov_b32 s44, 4980736
buffer_load_dwordx4 v16, s[4:7], s44 offen lds
s_add_u32 m0, s45, 15360
s_mov_b32 s44, 5111808
buffer_load_dwordx4 v16, s[4:7], s44 offen lds
s_waitcnt lgkmcnt(0)
v_mfma_f32_16x16x32_bf16 v[52:55], a[32:35], v[20:23], v[52:55]
v_mfma_f32_16x16x32_bf16 v[56:59], a[36:39], v[20:23], v[56:59]
v_mfma_f32_16x16x32_bf16 v[60:63], a[32:35], v[24:27], v[60:63]
v_mfma_f32_16x16x32_bf16 v[64:67], a[36:39], v[24:27], v[64:67]
v_mfma_f32_16x16x32_bf16 v[52:55], a[40:43], v[28:31], v[52:55]
v_mfma_f32_16x16x32_bf16 v[56:59], a[44:47], v[28:31], v[56:59]
v_mfma_f32_16x16x32_bf16 v[60:63], a[40:43], v[32:35], v[60:63]
v_mfma_f32_16x16x32_bf16 v[64:67], a[44:47], v[32:35], v[64:67]
v_mfma_f32_16x16x32_bf16 v[52:55], a[48:51], v[36:39], v[52:55]
v_mfma_f32_16x16x32_bf16 v[56:59], a[52:55], v[36:39], v[56:59]
v_mfma_f32_16x16x32_bf16 v[60:63], a[48:51], v[40:43], v[60:63]
v_mfma_f32_16x16x32_bf16 v[64:67], a[52:55], v[40:43], v[64:67]
v_mfma_f32_16x16x32_bf16 v[52:55], a[56:59], v[44:47], v[52:55]
v_mfma_f32_16x16x32_bf16 v[56:59], a[60:63], v[44:47], v[56:59]
v_mfma_f32_16x16x32_bf16 v[60:63], a[56:59], v[48:51], v[60:63]
v_mfma_f32_16x16x32_bf16 v[64:67], a[60:63], v[48:51], v[64:67]
s_waitcnt vmcnt(18)
ds_read_b64_tr_b16 a[64:65], v17 offset:16384
ds_read_b64_tr_b16 a[66:67], v17 offset:16640
ds_read_b64_tr_b16 a[68:69], v17 offset:16392
ds_read_b64_tr_b16 a[70:71], v17 offset:16648
ds_read_b64_tr_b16 a[72:73], v17 offset:18432
ds_read_b64_tr_b16 a[74:75], v17 offset:18688
ds_read_b64_tr_b16 a[76:77], v17 offset:18440
ds_read_b64_tr_b16 a[78:79], v17 offset:18696
s_waitcnt lgkmcnt(0)
ds_read_b64_tr_b16 a[80:81], v17 offset:20480
ds_read_b64_tr_b16 a[82:83], v17 offset:20736
ds_read_b64_tr_b16 a[84:85], v17 offset:20488
ds_read_b64_tr_b16 a[86:87], v17 offset:20744
ds_read_b64_tr_b16 a[88:89], v17 offset:22528
ds_read_b64_tr_b16 a[90:91], v17 offset:22784
ds_read_b64_tr_b16 a[92:93], v17 offset:22536
ds_read_b64_tr_b16 a[94:95], v17 offset:22792
s_waitcnt lgkmcnt(0)
ds_read_b128 v[20:23], v8 offset:16384
ds_read_b128 v[24:27], v8 offset:18432
ds_read_b128 v[28:31], v9 offset:16384
ds_read_b128 v[32:35], v9 offset:18432
ds_read_b128 v[36:39], v8 offset:20480
ds_read_b128 v[40:43], v8 offset:22528
ds_read_b128 v[44:47], v9 offset:20480
ds_read_b128 v[48:51], v9 offset:22528
s_mov_b32 s44, 5242880
buffer_load_dword v250, v12, s[4:7], s44 offen
s_add_u32 m0, s45, 16384
s_mov_b32 s44, 5242880
buffer_load_dwordx4 v16, s[4:7], s44 offen lds
s_add_u32 m0, s45, 17408
s_mov_b32 s44, 5373952
buffer_load_dwordx4 v16, s[4:7], s44 offen lds
s_add_u32 m0, s45, 18432
s_mov_b32 s44, 5505024
buffer_load_dwordx4 v16, s[4:7], s44 offen lds
s_add_u32 m0, s45, 19456
s_mov_b32 s44, 5636096
buffer_load_dwordx4 v16, s[4:7], s44 offen lds
s_add_u32 m0, s45, 20480
s_mov_b32 s44, 5767168
buffer_load_dwordx4 v16, s[4:7], s44 offen lds
s_add_u32 m0, s45, 21504
s_mov_b32 s44, 5898240
buffer_load_dwordx4 v16, s[4:7], s44 offen lds
s_add_u32 m0, s45, 22528
s_mov_b32 s44, 6029312
buffer_load_dwordx4 v16, s[4:7], s44 offen lds
s_add_u32 m0, s45, 23552
s_mov_b32 s44, 6160384
buffer_load_dwordx4 v16, s[4:7], s44 offen lds
s_waitcnt lgkmcnt(0)
v_mfma_f32_16x16x32_bf16 v[52:55], a[64:67], v[20:23], v[52:55]
v_mfma_f32_16x16x32_bf16 v[56:59], a[68:71], v[20:23], v[56:59]
v_mfma_f32_16x16x32_bf16 v[60:63], a[64:67], v[24:27], v[60:63]
v_mfma_f32_16x16x32_bf16 v[64:67], a[68:71], v[24:27], v[64:67]
v_mfma_f32_16x16x32_bf16 v[52:55], a[72:75], v[28:31], v[52:55]
v_mfma_f32_16x16x32_bf16 v[56:59], a[76:79], v[28:31], v[56:59]
v_mfma_f32_16x16x32_bf16 v[60:63], a[72:75], v[32:35], v[60:63]
v_mfma_f32_16x16x32_bf16 v[64:67], a[76:79], v[32:35], v[64:67]
v_mfma_f32_16x16x32_bf16 v[52:55], a[80:83], v[36:39], v[52:55]
v_mfma_f32_16x16x32_bf16 v[56:59], a[84:87], v[36:39], v[56:59]
v_mfma_f32_16x16x32_bf16 v[60:63], a[80:83], v[40:43], v[60:63]
v_mfma_f32_16x16x32_bf16 v[64:67], a[84:87], v[40:43], v[64:67]
v_mfma_f32_16x16x32_bf16 v[52:55], a[88:91], v[44:47], v[52:55]
v_mfma_f32_16x16x32_bf16 v[56:59], a[92:95], v[44:47], v[56:59]
v_mfma_f32_16x16x32_bf16 v[60:63], a[88:91], v[48:51], v[60:63]
v_mfma_f32_16x16x32_bf16 v[64:67], a[92:95], v[48:51], v[64:67]
s_waitcnt vmcnt(18)
ds_read_b64_tr_b16 a[96:97], v17 offset:0
ds_read_b64_tr_b16 a[98:99], v17 offset:256
ds_read_b64_tr_b16 a[100:101], v17 offset:8
ds_read_b64_tr_b16 a[102:103], v17 offset:264
ds_read_b64_tr_b16 a[104:105], v17 offset:2048
ds_read_b64_tr_b16 a[106:107], v17 offset:2304
ds_read_b64_tr_b16 a[108:109], v17 offset:2056
ds_read_b64_tr_b16 a[110:111], v17 offset:2312
s_waitcnt lgkmcnt(0)
ds_read_b64_tr_b16 a[112:113], v17 offset:4096
ds_read_b64_tr_b16 a[114:115], v17 offset:4352
ds_read_b64_tr_b16 a[116:117], v17 offset:4104
ds_read_b64_tr_b16 a[118:119], v17 offset:4360
ds_read_b64_tr_b16 a[120:121], v17 offset:6144
ds_read_b64_tr_b16 a[122:123], v17 offset:6400
ds_read_b64_tr_b16 a[124:125], v17 offset:6152
ds_read_b64_tr_b16 a[126:127], v17 offset:6408
s_waitcnt lgkmcnt(0)
ds_read_b128 v[20:23], v8 offset:24576
ds_read_b128 v[24:27], v8 offset:26624
ds_read_b128 v[28:31], v9 offset:24576
ds_read_b128 v[32:35], v9 offset:26624
ds_read_b128 v[36:39], v8 offset:28672
ds_read_b128 v[40:43], v8 offset:30720
ds_read_b128 v[44:47], v9 offset:28672
ds_read_b128 v[48:51], v9 offset:30720
s_mov_b32 s44, 6291456
buffer_load_dword v250, v12, s[4:7], s44 offen
s_add_u32 m0, s45, 0
s_mov_b32 s44, 6291456
buffer_load_dwordx4 v16, s[4:7], s44 offen lds
s_add_u32 m0, s45, 1024
s_mov_b32 s44, 6422528
buffer_load_dwordx4 v16, s[4:7], s44 offen lds
s_add_u32 m0, s45, 2048
s_mov_b32 s44, 6553600
buffer_load_dwordx4 v16, s[4:7], s44 offen lds
s_add_u32 m0, s45, 3072
s_mov_b32 s44, 6684672
buffer_load_dwordx4 v16, s[4:7], s44 offen lds
s_add_u32 m0, s45, 4096
s_mov_b32 s44, 6815744
buffer_load_dwordx4 v16, s[4:7], s44 offen lds
s_add_u32 m0, s45, 5120
s_mov_b32 s44, 6946816
buffer_load_dwordx4 v16, s[4:7], s44 offen lds
s_add_u32 m0, s45, 6144
s_mov_b32 s44, 7077888
buffer_load_dwordx4 v16, s[4:7], s44 offen lds
s_add_u32 m0, s45, 7168
s_mov_b32 s44, 7208960
buffer_load_dwordx4 v16, s[4:7], s44 offen lds
s_waitcnt lgkmcnt(0)
v_mfma_f32_16x16x32_bf16 v[52:55], a[96:99], v[20:23], v[52:55]
v_mfma_f32_16x16x32_bf16 v[56:59], a[100:103], v[20:23], v[56:59]
v_mfma_f32_16x16x32_bf16 v[60:63], a[96:99], v[24:27], v[60:63]
v_mfma_f32_16x16x32_bf16 v[64:67], a[100:103], v[24:27], v[64:67]
v_mfma_f32_16x16x32_bf16 v[52:55], a[104:107], v[28:31], v[52:55]
v_mfma_f32_16x16x32_bf16 v[56:59], a[108:111], v[28:31], v[56:59]
v_mfma_f32_16x16x32_bf16 v[60:63], a[104:107], v[32:35], v[60:63]
v_mfma_f32_16x16x32_bf16 v[64:67], a[108:111], v[32:35], v[64:67]
v_mfma_f32_16x16x32_bf16 v[52:55], a[112:115], v[36:39], v[52:55]
v_mfma_f32_16x16x32_bf16 v[56:59], a[116:119], v[36:39], v[56:59]
v_mfma_f32_16x16x32_bf16 v[60:63], a[112:115], v[40:43], v[60:63]
v_mfma_f32_16x16x32_bf16 v[64:67], a[116:119], v[40:43], v[64:67]
v_mfma_f32_16x16x32_bf16 v[52:55], a[120:123], v[44:47], v[52:55]
v_mfma_f32_16x16x32_bf16 v[56:59], a[124:127], v[44:47], v[56:59]
v_mfma_f32_16x16x32_bf16 v[60:63], a[120:123], v[48:51], v[60:63]
v_mfma_f32_16x16x32_bf16 v[64:67], a[124:127], v[48:51], v[64:67]
s_waitcnt vmcnt(18)
ds_read_b64_tr_b16 a[128:129], v17 offset:8192
ds_read_b64_tr_b16 a[130:131], v17 offset:8448
ds_read_b64_tr_b16 a[132:133], v17 offset:8200
ds_read_b64_tr_b16 a[134:135], v17 offset:8456
ds_read_b64_tr_b16 a[136:137], v17 offset:10240
ds_read_b64_tr_b16 a[138:139], v17 offset:10496
ds_read_b64_tr_b16 a[140:141], v17 offset:10248
ds_read_b64_tr_b16 a[142:143], v17 offset:10504
s_waitcnt lgkmcnt(0)
ds_read_b64_tr_b16 a[144:145], v17 offset:12288
ds_read_b64_tr_b16 a[146:147], v17 offset:12544
ds_read_b64_tr_b16 a[148:149], v17 offset:12296
ds_read_b64_tr_b16 a[150:151], v17 offset:12552
ds_read_b64_tr_b16 a[152:153], v17 offset:14336
ds_read_b64_tr_b16 a[154:155], v17 offset:14592
ds_read_b64_tr_b16 a[156:157], v17 offset:14344
ds_read_b64_tr_b16 a[158:159], v17 offset:14600
s_waitcnt lgkmcnt(0)
ds_read_b128 v[20:23], v8 offset:32768
ds_read_b128 v[24:27], v8 offset:34816
ds_read_b128 v[28:31], v9 offset:32768
ds_read_b128 v[32:35], v9 offset:34816
ds_read_b128 v[36:39], v8 offset:36864
ds_read_b128 v[40:43], v8 offset:38912
ds_read_b128 v[44:47], v9 offset:36864
ds_read_b128 v[48:51], v9 offset:38912
s_mov_b32 s44, 7340032
buffer_load_dword v250, v12, s[4:7], s44 offen
s_add_u32 m0, s45, 8192
s_mov_b32 s44, 7340032
buffer_load_dwordx4 v16, s[4:7], s44 offen lds
s_add_u32 m0, s45, 9216
s_mov_b32 s44, 7471104
buffer_load_dwordx4 v16, s[4:7], s44 offen lds
s_add_u32 m0, s45, 10240
s_mov_b32 s44, 7602176
buffer_load_dwordx4 v16, s[4:7], s44 offen lds
s_add_u32 m0, s45, 11264
s_mov_b32 s44, 7733248
buffer_load_dwordx4 v16, s[4:7], s44 offen lds
s_add_u32 m0, s45, 12288
s_mov_b32 s44, 7864320
buffer_load_dwordx4 v16, s[4:7], s44 offen lds
s_add_u32 m0, s45, 13312
s_mov_b32 s44, 7995392
buffer_load_dwordx4 v16, s[4:7], s44 offen lds
s_add_u32 m0, s45, 14336
s_mov_b32 s44, 8126464
buffer_load_dwordx4 v16, s[4:7], s44 offen lds
s_add_u32 m0, s45, 15360
s_mov_b32 s44, 8257536
buffer_load_dwordx4 v16, s[4:7], s44 offen lds
s_waitcnt lgkmcnt(0)
v_mfma_f32_16x16x32_bf16 v[52:55], a[128:131], v[20:23], v[52:55]
v_mfma_f32_16x16x32_bf16 v[56:59], a[132:135], v[20:23], v[56:59]
v_mfma_f32_16x16x32_bf16 v[60:63], a[128:131], v[24:27], v[60:63]
v_mfma_f32_16x16x32_bf16 v[64:67], a[132:135], v[24:27], v[64:67]
v_mfma_f32_16x16x32_bf16 v[52:55], a[136:139], v[28:31], v[52:55]
v_mfma_f32_16x16x32_bf16 v[56:59], a[140:143], v[28:31], v[56:59]
v_mfma_f32_16x16x32_bf16 v[60:63], a[136:139], v[32:35], v[60:63]
v_mfma_f32_16x16x32_bf16 v[64:67], a[140:143], v[32:35], v[64:67]
v_mfma_f32_16x16x32_bf16 v[52:55], a[144:147], v[36:39], v[52:55]
v_mfma_f32_16x16x32_bf16 v[56:59], a[148:151], v[36:39], v[56:59]
v_mfma_f32_16x16x32_bf16 v[60:63], a[144:147], v[40:43], v[60:63]
v_mfma_f32_16x16x32_bf16 v[64:67], a[148:151], v[40:43], v[64:67]
v_mfma_f32_16x16x32_bf16 v[52:55], a[152:155], v[44:47], v[52:55]
v_mfma_f32_16x16x32_bf16 v[56:59], a[156:159], v[44:47], v[56:59]
v_mfma_f32_16x16x32_bf16 v[60:63], a[152:155], v[48:51], v[60:63]
v_mfma_f32_16x16x32_bf16 v[64:67], a[156:159], v[48:51], v[64:67]
s_waitcnt vmcnt(18)
ds_read_b64_tr_b16 a[160:161], v17 offset:16384
ds_read_b64_tr_b16 a[162:163], v17 offset:16640
ds_read_b64_tr_b16 a[164:165], v17 offset:16392
ds_read_b64_tr_b16 a[166:167], v17 offset:16648
ds_read_b64_tr_b16 a[168:169], v17 offset:18432
ds_read_b64_tr_b16 a[170:171], v17 offset:18688
ds_read_b64_tr_b16 a[172:173], v17 offset:18440
ds_read_b64_tr_b16 a[174:175], v17 offset:18696
s_waitcnt lgkmcnt(0)
ds_read_b64_tr_b16 a[176:177], v17 offset:20480
ds_read_b64_tr_b16 a[178:179], v17 offset:20736
ds_read_b64_tr_b16 a[180:181], v17 offset:20488
ds_read_b64_tr_b16 a[182:183], v17 offset:20744
ds_read_b64_tr_b16 a[184:185], v17 offset:22528
ds_read_b64_tr_b16 a[186:187], v17 offset:22784
ds_read_b64_tr_b16 a[188:189], v17 offset:22536
ds_read_b64_tr_b16 a[190:191], v17 offset:22792
s_waitcnt lgkmcnt(0)
ds_read_b128 v[20:23], v8 offset:40960
ds_read_b128 v[24:27], v8 offset:43008
ds_read_b128 v[28:31], v9 offset:40960
ds_read_b128 v[32:35], v9 offset:43008
ds_read_b128 v[36:39], v8 offset:45056
ds_read_b128 v[40:43], v8 offset:47104
ds_read_b128 v[44:47], v9 offset:45056
ds_read_b128 v[48:51], v9 offset:47104
s_waitcnt lgkmcnt(0)
v_mfma_f32_16x16x32_bf16 v[52:55], a[160:163], v[20:23], v[52:55]
v_mfma_f32_16x16x32_bf16 v[56:59], a[164:167], v[20:23], v[56:59]
v_mfma_f32_16x16x32_bf16 v[60:63], a[160:163], v[24:27], v[60:63]
v_mfma_f32_16x16x32_bf16 v[64:67], a[164:167], v[24:27], v[64:67]
v_mfma_f32_16x16x32_bf16 v[52:55], a[168:171], v[28:31], v[52:55]
v_mfma_f32_16x16x32_bf16 v[56:59], a[172:175], v[28:31], v[56:59]
v_mfma_f32_16x16x32_bf16 v[60:63], a[168:171], v[32:35], v[60:63]
v_mfma_f32_16x16x32_bf16 v[64:67], a[172:175], v[32:35], v[64:67]
v_mfma_f32_16x16x32_bf16 v[52:55], a[176:179], v[36:39], v[52:55]
v_mfma_f32_16x16x32_bf16 v[56:59], a[180:183], v[36:39], v[56:59]
v_mfma_f32_16x16x32_bf16 v[60:63], a[176:179], v[40:43], v[60:63]
v_mfma_f32_16x16x32_bf16 v[64:67], a[180:183], v[40:43], v[64:67]
v_mfma_f32_16x16x32_bf16 v[52:55], a[184:187], v[44:47], v[52:55]
v_mfma_f32_16x16x32_bf16 v[56:59], a[188:191], v[44:47], v[56:59]
v_mfma_f32_16x16x32_bf16 v[60:63], a[184:187], v[48:51], v[60:63]
v_mfma_f32_16x16x32_bf16 v[64:67], a[188:191], v[48:51], v[64:67]
s_waitcnt vmcnt(9)
ds_read_b64_tr_b16 a[192:193], v17 offset:0
ds_read_b64_tr_b16 a[194:195], v17 offset:256
ds_read_b64_tr_b16 a[196:197], v17 offset:8
ds_read_b64_tr_b16 a[198:199], v17 offset:264
ds_read_b64_tr_b16 a[200:201], v17 offset:2048
ds_read_b64_tr_b16 a[202:203], v17 offset:2304
ds_read_b64_tr_b16 a[204:205], v17 offset:2056
ds_read_b64_tr_b16 a[206:207], v17 offset:2312
s_waitcnt lgkmcnt(0)
ds_read_b64_tr_b16 a[208:209], v17 offset:4096
ds_read_b64_tr_b16 a[210:211], v17 offset:4352
ds_read_b64_tr_b16 a[212:213], v17 offset:4104
ds_read_b64_tr_b16 a[214:215], v17 offset:4360
ds_read_b64_tr_b16 a[216:217], v17 offset:6144
ds_read_b64_tr_b16 a[218:219], v17 offset:6400
ds_read_b64_tr_b16 a[220:221], v17 offset:6152
ds_read_b64_tr_b16 a[222:223], v17 offset:6408
s_waitcnt lgkmcnt(0)
ds_read_b128 v[20:23], v8 offset:49152
ds_read_b128 v[24:27], v8 offset:51200
ds_read_b128 v[28:31], v9 offset:49152
ds_read_b128 v[32:35], v9 offset:51200
ds_read_b128 v[36:39], v8 offset:53248
ds_read_b128 v[40:43], v8 offset:55296
ds_read_b128 v[44:47], v9 offset:53248
ds_read_b128 v[48:51], v9 offset:55296
s_waitcnt lgkmcnt(0)
v_mfma_f32_16x16x32_bf16 v[52:55], a[192:195], v[20:23], v[52:55]
v_mfma_f32_16x16x32_bf16 v[56:59], a[196:199], v[20:23], v[56:59]
v_mfma_f32_16x16x32_bf16 v[60:63], a[192:195], v[24:27], v[60:63]
v_mfma_f32_16x16x32_bf16 v[64:67], a[196:199], v[24:27], v[64:67]
v_mfma_f32_16x16x32_bf16 v[52:55], a[200:203], v[28:31], v[52:55]
v_mfma_f32_16x16x32_bf16 v[56:59], a[204:207], v[28:31], v[56:59]
v_mfma_f32_16x16x32_bf16 v[60:63], a[200:203], v[32:35], v[60:63]
v_mfma_f32_16x16x32_bf16 v[64:67], a[204:207], v[32:35], v[64:67]
v_mfma_f32_16x16x32_bf16 v[52:55], a[208:211], v[36:39], v[52:55]
v_mfma_f32_16x16x32_bf16 v[56:59], a[212:215], v[36:39], v[56:59]
v_mfma_f32_16x16x32_bf16 v[60:63], a[208:211], v[40:43], v[60:63]
v_mfma_f32_16x16x32_bf16 v[64:67], a[212:215], v[40:43], v[64:67]
v_mfma_f32_16x16x32_bf16 v[52:55], a[216:219], v[44:47], v[52:55]
v_mfma_f32_16x16x32_bf16 v[56:59], a[220:223], v[44:47], v[56:59]
v_mfma_f32_16x16x32_bf16 v[60:63], a[216:219], v[48:51], v[60:63]
v_mfma_f32_16x16x32_bf16 v[64:67], a[220:223], v[48:51], v[64:67]
s_waitcnt vmcnt(0)
ds_read_b64_tr_b16 a[224:225], v17 offset:8192
ds_read_b64_tr_b16 a[226:227], v17 offset:8448
ds_read_b64_tr_b16 a[228:229], v17 offset:8200
ds_read_b64_tr_b16 a[230:231], v17 offset:8456
ds_read_b64_tr_b16 a[232:233], v17 offset:10240
ds_read_b64_tr_b16 a[234:235], v17 offset:10496
ds_read_b64_tr_b16 a[236:237], v17 offset:10248
ds_read_b64_tr_b16 a[238:239], v17 offset:10504
s_waitcnt lgkmcnt(0)
ds_read_b64_tr_b16 a[240:241], v17 offset:12288
ds_read_b64_tr_b16 a[242:243], v17 offset:12544
ds_read_b64_tr_b16 a[244:245], v17 offset:12296
ds_read_b64_tr_b16 a[246:247], v17 offset:12552
ds_read_b64_tr_b16 a[248:249], v17 offset:14336
ds_read_b64_tr_b16 a[250:251], v17 offset:14592
ds_read_b64_tr_b16 a[252:253], v17 offset:14344
ds_read_b64_tr_b16 a[254:255], v17 offset:14600
s_waitcnt lgkmcnt(0)
ds_read_b128 v[20:23], v8 offset:57344
ds_read_b128 v[24:27], v8 offset:59392
ds_read_b128 v[28:31], v9 offset:57344
ds_read_b128 v[32:35], v9 offset:59392
ds_read_b128 v[36:39], v8 offset:61440
ds_read_b128 v[40:43], v8 offset:63488
ds_read_b128 v[44:47], v9 offset:61440
ds_read_b128 v[48:51], v9 offset:63488
s_waitcnt lgkmcnt(0)
v_mfma_f32_16x16x32_bf16 v[52:55], a[224:227], v[20:23], v[52:55]
v_mfma_f32_16x16x32_bf16 v[56:59], a[228:231], v[20:23], v[56:59]
v_mfma_f32_16x16x32_bf16 v[60:63], a[224:227], v[24:27], v[60:63]
v_mfma_f32_16x16x32_bf16 v[64:67], a[228:231], v[24:27], v[64:67]
v_mfma_f32_16x16x32_bf16 v[52:55], a[232:235], v[28:31], v[52:55]
v_mfma_f32_16x16x32_bf16 v[56:59], a[236:239], v[28:31], v[56:59]
v_mfma_f32_16x16x32_bf16 v[60:63], a[232:235], v[32:35], v[60:63]
v_mfma_f32_16x16x32_bf16 v[64:67], a[236:239], v[32:35], v[64:67]
v_mfma_f32_16x16x32_bf16 v[52:55], a[240:243], v[36:39], v[52:55]
v_mfma_f32_16x16x32_bf16 v[56:59], a[244:247], v[36:39], v[56:59]
v_mfma_f32_16x16x32_bf16 v[60:63], a[240:243], v[40:43], v[60:63]
v_mfma_f32_16x16x32_bf16 v[64:67], a[244:247], v[40:43], v[64:67]
v_mfma_f32_16x16x32_bf16 v[52:55], a[248:251], v[44:47], v[52:55]
v_mfma_f32_16x16x32_bf16 v[56:59], a[252:255], v[44:47], v[56:59]
v_mfma_f32_16x16x32_bf16 v[60:63], a[248:251], v[48:51], v[60:63]
v_mfma_f32_16x16x32_bf16 v[64:67], a[252:255], v[48:51], v[64:67]
s_barrier
s_mov_b32 s50, 0x10000
s_add_u32 m0, s46, 65536
s_nop 0
buffer_load_dwordx4 v6, s[8:11], s50 offen offset:0 lds
s_add_u32 m0, s46, 69504
s_nop 0
buffer_load_dwordx4 v6, s[8:11], s50 offen offset:128 lds
s_add_u32 m0, s46, 73472
s_nop 0
buffer_load_dwordx4 v6, s[8:11], s50 offen offset:256 lds
s_add_u32 m0, s46, 77440
s_nop 0
buffer_load_dwordx4 v6, s[8:11], s50 offen offset:384 lds
s_add_u32 m0, s46, 81408
s_nop 0
buffer_load_dwordx4 v6, s[8:11], s50 offen offset:512 lds
s_add_u32 m0, s46, 85376
s_nop 0
buffer_load_dwordx4 v6, s[8:11], s50 offen offset:640 lds
s_add_u32 m0, s46, 89344
s_nop 0
buffer_load_dwordx4 v6, s[8:11], s50 offen offset:768 lds
s_add_u32 m0, s46, 93312
s_nop 0
buffer_load_dwordx4 v6, s[8:11], s50 offen offset:896 lds
s_add_u32 m0, s46, 97280
s_nop 0
buffer_load_dwordx4 v6, s[8:11], s50 offen offset:1024 lds
s_add_u32 m0, s46, 101248
s_nop 0
buffer_load_dwordx4 v6, s[8:11], s50 offen offset:1152 lds
s_add_u32 m0, s46, 105216
s_nop 0
buffer_load_dwordx4 v6, s[8:11], s50 offen offset:1280 lds
s_add_u32 m0, s46, 109184
s_nop 0
buffer_load_dwordx4 v6, s[8:11], s50 offen offset:1408 lds
s_add_u32 m0, s46, 113152
s_nop 0
buffer_load_dwordx4 v6, s[8:11], s50 offen offset:1536 lds
s_add_u32 m0, s46, 117120
s_nop 0
buffer_load_dwordx4 v6, s[8:11], s50 offen offset:1664 lds
s_add_u32 m0, s46, 121088
s_nop 0
buffer_load_dwordx4 v6, s[8:11], s50 offen offset:1792 lds
s_add_u32 m0, s46, 125056
s_nop 0
buffer_load_dwordx4 v6, s[8:11], s50 offen offset:1920 lds
s_and_b32 s53, s47, 31
s_lshl_b32 s53, s53, 4
v_add_u32 v19, s53, v1
v_lshlrev_b32 v19, 7, v19
s_mov_b32 s42, 1
v_and_b32 v3, 15, v0
v_lshlrev_b32 v3, 4, v3
s_branch mega_kernel_syk
mega_kernel_sykw:
s_sleep 4
mega_kernel_syk:
buffer_load_dword v2, v3, s[72:75], 0 offen sc1
s_waitcnt vmcnt(0)
s_cmp_eq_u32 s95, 1
s_cbranch_scc0 mega_kernel_sykf
v_readlane_b32 s76, v2, 14
s_mov_b32 s98, 0
s_cmp_eq_u32 s76, 64
s_cbranch_scc0 mega_kernel_sykw
s_branch mega_kernel_sykd
mega_kernel_sykf:
s_mov_b32 s77, 0
s_mov_b32 s78, 0
v_readlane_b32 s76, v2, 0
s_add_u32 s77, s77, s76
s_xor_b32 s76, s76, 32
s_or_b32 s78, s78, s76
v_readlane_b32 s76, v2, 1
s_add_u32 s77, s77, s76
s_xor_b32 s76, s76, 32
s_or_b32 s78, s78, s76
v_readlane_b32 s76, v2, 2
s_add_u32 s77, s77, s76
s_xor_b32 s76, s76, 32
s_or_b32 s78, s78, s76
v_readlane_b32 s76, v2, 3
s_add_u32 s77, s77, s76
s_xor_b32 s76, s76, 32
s_or_b32 s78, s78, s76
v_readlane_b32 s76, v2, 4
s_add_u32 s77, s77, s76
s_xor_b32 s76, s76, 32
s_or_b32 s78, s78, s76
v_readlane_b32 s76, v2, 5
s_add_u32 s77, s77, s76
s_xor_b32 s76, s76, 32
s_or_b32 s78, s78, s76
v_readlane_b32 s76, v2, 6
s_add_u32 s77, s77, s76
s_xor_b32 s76, s76, 32
s_or_b32 s78, s78, s76
v_readlane_b32 s76, v2, 7
s_add_u32 s77, s77, s76
s_xor_b32 s76, s76, 32
s_or_b32 s78, s78, s76
s_cmp_eq_u32 s77, 256
s_cbranch_scc0 mega_kernel_sykw
v_mov_b32 v252, v2
s_cmp_eq_u32 s78, 0
s_cbranch_scc0 mega_kernel_slowent
v_readlane_b32 s76, v2, 10
v_readlane_b32 s77, v2, 8
s_cmp_eq_u32 s76, 64
s_cbranch_scc0 mega_kernel_sykw
s_cmp_gt_u32 s77, 32
s_cselect_b32 s98, 1, 0
mega_kernel_sykd:
s_lshr_b32 s44, s47, 3
s_xor_b32 s44, s44, s98
s_and_b32 s44, s44, 1
s_lshl_b32 s44, s44, 13
s_lshl_b32 s48, s47, 18
s_add_u32 s48, s48, s44
s_add_u32 s48, s48, 0
s_xor_b32 s44, s98, 1
s_lshl_b32 s44, s44, 13
s_lshl_b32 s49, s40, 7
s_add_u32 s49, s49, s44
s_lshl_b32 s44, s41, 2
s_add_u32 s49, s49, s44
s_add_u32 s49, s49, 69206016
v_mov_b32 v16, 0
v_cvt_pk_bf16_f32 v84, v52, v53
v_cvt_pk_bf16_f32 v85, v54, v55
v_cvt_pk_bf16_f32 v86, v56, v57
v_cvt_pk_bf16_f32 v87, v58, v59
v_cvt_pk_bf16_f32 v88, v60, v61
v_cvt_pk_bf16_f32 v89, v62, v63
v_cvt_pk_bf16_f32 v90, v64, v65
v_cvt_pk_bf16_f32 v91, v66, v67
s_add_u32 s51, s42, s47
s_sub_u32 s51, s51, 1
s_bfe_u32 s52, s51, 0x40002
s_lshl_b32 s52, s52, 14
s_and_b32 s51, s51, 3
s_lshl_b32 s51, s51, 11
s_add_u32 s51, s51, s52
s_add_u32 s51, s51, s48
buffer_store_dwordx4 v[84:87], v7, s[84:87], s51 offen sc1
buffer_store_dwordx4 v[88:91], v7, s[84:87], s51 offen offset:1024 sc1
s_waitcnt vmcnt(0)
v_mov_b32 v17, s42
s_mov_b64 exec, 1
buffer_store_dword v17, v16, s[84:87], s49 offen sc1
s_mov_b64 exec, -1
mega_kernel_k_loop:
s_waitcnt vmcnt(2)
s_barrier
s_add_u32 s50, s42, 1
s_min_u32 s50, s50, 63
s_lshl_b32 s50, s50, 16
ds_read_b128 v[20:23], v10 offset:0
ds_read_b128 v[24:27], v10 offset:2048
ds_read_b128 v[28:31], v11 offset:0
ds_read_b128 v[32:35], v11 offset:2048
ds_read_b128 v[36:39], v10 offset:4096
ds_read_b128 v[40:43], v10 offset:6144
s_waitcnt lgkmcnt(4)
v_mfma_f32_16x16x32_bf16 v[68:71], a[0:3], v[20:23], 0
ds_read_b128 v[44:47], v11 offset:4096
v_mfma_f32_16x16x32_bf16 v[72:75], a[4:7], v[20:23], 0
v_cvt_pk_bf16_f32 v84, v52, v53
v_cvt_pk_bf16_f32 v85, v54, v55
v_cvt_pk_bf16_f32 v86, v56, v57
v_mfma_f32_16x16x32_bf16 v[76:79], a[0:3], v[24:27], 0
ds_read_b128 v[48:51], v11 offset:6144
v_mfma_f32_16x16x32_bf16 v[80:83], a[4:7], v[24:27], 0
v_cvt_pk_bf16_f32 v87, v58, v59
v_cvt_pk_bf16_f32 v88, v60, v61
v_cvt_pk_bf16_f32 v89, v62, v63
s_waitcnt lgkmcnt(4)
v_mfma_f32_16x16x32_bf16 v[68:71], a[8:11], v[28:31], v[68:71]
ds_read_b128 v[20:23], v10 offset:8192
v_mfma_f32_16x16x32_bf16 v[72:75], a[12:15], v[28:31], v[72:75]
v_cvt_pk_bf16_f32 v90, v64, v65
v_cvt_pk_bf16_f32 v91, v66, v67
v_mfma_f32_16x16x32_bf16 v[76:79], a[8:11], v[32:35], v[76:79]
ds_read_b128 v[24:27], v10 offset:10240
v_mfma_f32_16x16x32_bf16 v[80:83], a[12:15], v[32:35], v[80:83]
s_add_u32 s51, s42, s47
s_sub_u32 s51, s51, 1
s_bfe_u32 s52, s51, 0x40002
s_lshl_b32 s52, s52, 14
s_waitcnt lgkmcnt(4)
v_mfma_f32_16x16x32_bf16 v[68:71], a[16:19], v[36:39], v[68:71]
ds_read_b128 v[28:31], v11 offset:8192
v_mfma_f32_16x16x32_bf16 v[72:75], a[20:23], v[36:39], v[72:75]
s_and_b32 s51, s51, 3
s_lshl_b32 s51, s51, 11
s_add_u32 s51, s51, s52
s_add_u32 s51, s51, s48
buffer_store_dwordx4 v[84:87], v7, s[84:87], s51 offen sc1
v_mfma_f32_16x16x32_bf16 v[76:79], a[16:19], v[40:43], v[76:79]
ds_read_b128 v[32:35], v11 offset:10240
v_mfma_f32_16x16x32_bf16 v[80:83], a[20:23], v[40:43], v[80:83]
buffer_store_dwordx4 v[88:91], v7, s[84:87], s51 offen offset:1024 sc1
s_waitcnt lgkmcnt(4)
v_mfma_f32_16x16x32_bf16 v[68:71], a[24:27], v[44:47], v[68:71]
ds_read_b128 v[36:39], v10 offset:12288
v_mfma_f32_16x16x32_bf16 v[72:75], a[28:31], v[44:47], v[72:75]
s_add_u32 m0, s46, 0
v_mfma_f32_16x16x32_bf16 v[76:79], a[24:27], v[48:51], v[76:79]
ds_read_b128 v[40:43], v10 offset:14336
v_mfma_f32_16x16x32_bf16 v[80:83], a[28:31], v[48:51], v[80:83]
buffer_load_dwordx4 v6, s[8:11], s50 offen offset:0 lds
s_waitcnt lgkmcnt(4)
v_mfma_f32_16x16x32_bf16 v[68:71], a[32:35], v[20:23], v[68:71]
ds_read_b128 v[44:47], v11 offset:12288
v_mfma_f32_16x16x32_bf16 v[72:75], a[36:39], v[20:23], v[72:75]
s_add_u32 m0, s46, 3968
v_mfma_f32_16x16x32_bf16 v[76:79], a[32:35], v[24:27], v[76:79]
ds_read_b128 v[48:51], v11 offset:14336
v_mfma_f32_16x16x32_bf16 v[80:83], a[36:39], v[24:27], v[80:83]
buffer_load_dwordx4 v6, s[8:11], s50 offen offset:128 lds
s_waitcnt lgkmcnt(4)
v_mfma_f32_16x16x32_bf16 v[68:71], a[40:43], v[28:31], v[68:71]
ds_read_b128 v[20:23], v10 offset:16384
v_mfma_f32_16x16x32_bf16 v[72:75], a[44:47], v[28:31], v[72:75]
s_add_u32 m0, s46, 7936
v_mfma_f32_16x16x32_bf16 v[76:79], a[40:43], v[32:35], v[76:79]
ds_read_b128 v[24:27], v10 offset:18432
v_mfma_f32_16x16x32_bf16 v[80:83], a[44:47], v[32:35], v[80:83]
buffer_load_dwordx4 v6, s[8:11], s50 offen offset:256 lds
s_waitcnt lgkmcnt(4)
v_mfma_f32_16x16x32_bf16 v[68:71], a[48:51], v[36:39], v[68:71]
ds_read_b128 v[28:31], v11 offset:16384
v_mfma_f32_16x16x32_bf16 v[72:75], a[52:55], v[36:39], v[72:75]
s_add_u32 m0, s46, 11904
v_mfma_f32_16x16x32_bf16 v[76:79], a[48:51], v[40:43], v[76:79]
ds_read_b128 v[32:35], v11 offset:18432
v_mfma_f32_16x16x32_bf16 v[80:83], a[52:55], v[40:43], v[80:83]
buffer_load_dwordx4 v6, s[8:11], s50 offen offset:384 lds
s_waitcnt lgkmcnt(4)
v_mfma_f32_16x16x32_bf16 v[68:71], a[56:59], v[44:47], v[68:71]
ds_read_b128 v[36:39], v10 offset:20480
v_mfma_f32_16x16x32_bf16 v[72:75], a[60:63], v[44:47], v[72:75]
s_add_u32 m0, s46, 15872
v_mfma_f32_16x16x32_bf16 v[76:79], a[56:59], v[48:51], v[76:79]
ds_read_b128 v[40:43], v10 offset:22528
v_mfma_f32_16x16x32_bf16 v[80:83], a[60:63], v[48:51], v[80:83]
buffer_load_dwordx4 v6, s[8:11], s50 offen offset:512 lds
s_waitcnt lgkmcnt(4)
v_mfma_f32_16x16x32_bf16 v[68:71], a[64:67], v[20:23], v[68:71]
ds_read_b128 v[44:47], v11 offset:20480
v_mfma_f32_16x16x32_bf16 v[72:75], a[68:71], v[20:23], v[72:75]
s_add_u32 m0, s46, 19840
v_mfma_f32_16x16x32_bf16 v[76:79], a[64:67], v[24:27], v[76:79]
ds_read_b128 v[48:51], v11 offset:22528
v_mfma_f32_16x16x32_bf16 v[80:83], a[68:71], v[24:27], v[80:83]
buffer_load_dwordx4 v6, s[8:11], s50 offen offset:640 lds
s_waitcnt lgkmcnt(4)
v_mfma_f32_16x16x32_bf16 v[68:71], a[72:75], v[28:31], v[68:71]
ds_read_b128 v[20:23], v10 offset:24576
v_mfma_f32_16x16x32_bf16 v[72:75], a[76:79], v[28:31], v[72:75]
s_add_u32 m0, s46, 23808
v_mfma_f32_16x16x32_bf16 v[76:79], a[72:75], v[32:35], v[76:79]
ds_read_b128 v[24:27], v10 offset:26624
v_mfma_f32_16x16x32_bf16 v[80:83], a[76:79], v[32:35], v[80:83]
buffer_load_dwordx4 v6, s[8:11], s50 offen offset:768 lds
s_waitcnt lgkmcnt(4)
v_mfma_f32_16x16x32_bf16 v[68:71], a[80:83], v[36:39], v[68:71]
ds_read_b128 v[28:31], v11 offset:24576
v_mfma_f32_16x16x32_bf16 v[72:75], a[84:87], v[36:39], v[72:75]
s_add_u32 m0, s46, 27776
v_mfma_f32_16x16x32_bf16 v[76:79], a[80:83], v[40:43], v[76:79]
ds_read_b128 v[32:35], v11 offset:26624
v_mfma_f32_16x16x32_bf16 v[80:83], a[84:87], v[40:43], v[80:83]
buffer_load_dwordx4 v6, s[8:11], s50 offen offset:896 lds
s_waitcnt lgkmcnt(4)
v_mfma_f32_16x16x32_bf16 v[68:71], a[88:91], v[44:47], v[68:71]
ds_read_b128 v[36:39], v10 offset:28672
v_mfma_f32_16x16x32_bf16 v[72:75], a[92:95], v[44:47], v[72:75]
s_add_u32 m0, s46, 31744
v_mfma_f32_16x16x32_bf16 v[76:79], a[88:91], v[48:51], v[76:79]
ds_read_b128 v[40:43], v10 offset:30720
v_mfma_f32_16x16x32_bf16 v[80:83], a[92:95], v[48:51], v[80:83]
buffer_load_dwordx4 v6, s[8:11], s50 offen offset:1024 lds
s_waitcnt lgkmcnt(4)
v_mfma_f32_16x16x32_bf16 v[68:71], a[96:99], v[20:23], v[68:71]
ds_read_b128 v[44:47], v11 offset:28672
v_mfma_f32_16x16x32_bf16 v[72:75], a[100:103], v[20:23], v[72:75]
s_add_u32 m0, s46, 35712
v_mfma_f32_16x16x32_bf16 v[76:79], a[96:99], v[24:27], v[76:79]
ds_read_b128 v[48:51], v11 offset:30720
v_mfma_f32_16x16x32_bf16 v[80:83], a[100:103], v[24:27], v[80:83]
buffer_load_dwordx4 v6, s[8:11], s50 offen offset:1152 lds
s_waitcnt lgkmcnt(4)
v_mfma_f32_16x16x32_bf16 v[68:71], a[104:107], v[28:31], v[68:71]
ds_read_b128 v[20:23], v10 offset:32768
v_mfma_f32_16x16x32_bf16 v[72:75], a[108:111], v[28:31], v[72:75]
s_add_u32 m0, s46, 39680
v_mfma_f32_16x16x32_bf16 v[76:79], a[104:107], v[32:35], v[76:79]
ds_read_b128 v[24:27], v10 offset:34816
v_mfma_f32_16x16x32_bf16 v[80:83], a[108:111], v[32:35], v[80:83]
buffer_load_dwordx4 v6, s[8:11], s50 offen offset:1280 lds
s_waitcnt lgkmcnt(4)
v_mfma_f32_16x16x32_bf16 v[68:71], a[112:115], v[36:39], v[68:71]
ds_read_b128 v[28:31], v11 offset:32768
v_mfma_f32_16x16x32_bf16 v[72:75], a[116:119], v[36:39], v[72:75]
s_add_u32 m0, s46, 43648
v_mfma_f32_16x16x32_bf16 v[76:79], a[112:115], v[40:43], v[76:79]
ds_read_b128 v[32:35], v11 offset:34816
v_mfma_f32_16x16x32_bf16 v[80:83], a[116:119], v[40:43], v[80:83]
buffer_load_dwordx4 v6, s[8:11], s50 offen offset:1408 lds
s_waitcnt lgkmcnt(4)
v_mfma_f32_16x16x32_bf16 v[68:71], a[120:123], v[44:47], v[68:71]
ds_read_b128 v[36:39], v10 offset:36864
v_mfma_f32_16x16x32_bf16 v[72:75], a[124:127], v[44:47], v[72:75]
s_add_u32 m0, s46, 47616
v_mfma_f32_16x16x32_bf16 v[76:79], a[120:123], v[48:51], v[76:79]
ds_read_b128 v[40:43], v10 offset:38912
v_mfma_f32_16x16x32_bf16 v[80:83], a[124:127], v[48:51], v[80:83]
buffer_load_dwordx4 v6, s[8:11], s50 offen offset:1536 lds
s_waitcnt lgkmcnt(4)
v_mfma_f32_16x16x32_bf16 v[68:71], a[128:131], v[20:23], v[68:71]
ds_read_b128 v[44:47], v11 offset:36864
v_mfma_f32_16x16x32_bf16 v[72:75], a[132:135], v[20:23], v[72:75]
s_add_u32 m0, s46, 51584
v_mfma_f32_16x16x32_bf16 v[76:79], a[128:131], v[24:27], v[76:79]
ds_read_b128 v[48:51], v11 offset:38912
v_mfma_f32_16x16x32_bf16 v[80:83], a[132:135], v[24:27], v[80:83]
buffer_load_dwordx4 v6, s[8:11], s50 offen offset:1664 lds
s_waitcnt lgkmcnt(4)
v_mfma_f32_16x16x32_bf16 v[68:71], a[136:139], v[28:31], v[68:71]
ds_read_b128 v[20:23], v10 offset:40960
v_mfma_f32_16x16x32_bf16 v[72:75], a[140:143], v[28:31], v[72:75]
s_add_u32 m0, s46, 55552
v_mfma_f32_16x16x32_bf16 v[76:79], a[136:139], v[32:35], v[76:79]
ds_read_b128 v[24:27], v10 offset:43008
v_mfma_f32_16x16x32_bf16 v[80:83], a[140:143], v[32:35], v[80:83]
buffer_load_dwordx4 v6, s[8:11], s50 offen offset:1792 lds
s_waitcnt lgkmcnt(4)
v_mfma_f32_16x16x32_bf16 v[68:71], a[144:147], v[36:39], v[68:71]
ds_read_b128 v[28:31], v11 offset:40960
v_mfma_f32_16x16x32_bf16 v[72:75], a[148:151], v[36:39], v[72:75]
s_add_u32 m0, s46, 59520
v_mfma_f32_16x16x32_bf16 v[76:79], a[144:147], v[40:43], v[76:79]
ds_read_b128 v[32:35], v11 offset:43008
v_mfma_f32_16x16x32_bf16 v[80:83], a[148:151], v[40:43], v[80:83]
buffer_load_dwordx4 v6, s[8:11], s50 offen offset:1920 lds
s_waitcnt lgkmcnt(4)
v_mfma_f32_16x16x32_bf16 v[68:71], a[152:155], v[44:47], v[68:71]
ds_read_b128 v[36:39], v10 offset:45056
v_mfma_f32_16x16x32_bf16 v[72:75], a[156:159], v[44:47], v[72:75]
v_mfma_f32_16x16x32_bf16 v[76:79], a[152:155], v[48:51], v[76:79]
ds_read_b128 v[40:43], v10 offset:47104
v_mfma_f32_16x16x32_bf16 v[80:83], a[156:159], v[48:51], v[80:83]
s_waitcnt lgkmcnt(4)
v_mfma_f32_16x16x32_bf16 v[68:71], a[160:163], v[20:23], v[68:71]
ds_read_b128 v[44:47], v11 offset:45056
v_mfma_f32_16x16x32_bf16 v[72:75], a[164:167], v[20:23], v[72:75]
v_mfma_f32_16x16x32_bf16 v[76:79], a[160:163], v[24:27], v[76:79]
ds_read_b128 v[48:51], v11 offset:47104
v_mfma_f32_16x16x32_bf16 v[80:83], a[164:167], v[24:27], v[80:83]
s_waitcnt lgkmcnt(4)
v_mfma_f32_16x16x32_bf16 v[68:71], a[168:171], v[28:31], v[68:71]
ds_read_b128 v[20:23], v10 offset:49152
v_mfma_f32_16x16x32_bf16 v[72:75], a[172:175], v[28:31], v[72:75]
s_waitcnt vmcnt(16)
v_mov_b32 v17, s42
s_mov_b64 exec, 1
buffer_store_dword v17, v16, s[84:87], s49 offen sc1
s_mov_b64 exec, -1
v_mfma_f32_16x16x32_bf16 v[76:79], a[168:171], v[32:35], v[76:79]
ds_read_b128 v[24:27], v10 offset:51200
v_mfma_f32_16x16x32_bf16 v[80:83], a[172:175], v[32:35], v[80:83]
s_waitcnt lgkmcnt(4)
v_mfma_f32_16x16x32_bf16 v[68:71], a[176:179], v[36:39], v[68:71]
ds_read_b128 v[28:31], v11 offset:49152
v_mfma_f32_16x16x32_bf16 v[72:75], a[180:183], v[36:39], v[72:75]
s_add_u32 s53, s42, 3
s_min_u32 s53, s53, 63
s_lshl_b32 s53, s53, 16
s_mov_b64 exec, 0xffff
buffer_load_dword v250, v19, s[8:11], s53 offen
s_mov_b64 exec, -1
v_mfma_f32_16x16x32_bf16 v[76:79], a[176:179], v[40:43], v[76:79]
ds_read_b128 v[32:35], v11 offset:51200
v_mfma_f32_16x16x32_bf16 v[80:83], a[180:183], v[40:43], v[80:83]
s_waitcnt lgkmcnt(4)
v_mfma_f32_16x16x32_bf16 v[68:71], a[184:187], v[44:47], v[68:71]
ds_read_b128 v[36:39], v10 offset:53248
v_mfma_f32_16x16x32_bf16 v[72:75], a[188:191], v[44:47], v[72:75]
v_mfma_f32_16x16x32_bf16 v[76:79], a[184:187], v[48:51], v[76:79]
ds_read_b128 v[40:43], v10 offset:55296
v_mfma_f32_16x16x32_bf16 v[80:83], a[188:191], v[48:51], v[80:83]
s_waitcnt lgkmcnt(4)
v_mfma_f32_16x16x32_bf16 v[68:71], a[192:195], v[20:23], v[68:71]
ds_read_b128 v[44:47], v11 offset:53248
v_mfma_f32_16x16x32_bf16 v[72:75], a[196:199], v[20:23], v[72:75]
v_mfma_f32_16x16x32_bf16 v[76:79], a[192:195], v[24:27], v[76:79]
ds_read_b128 v[48:51], v11 offset:55296
v_mfma_f32_16x16x32_bf16 v[80:83], a[196:199], v[24:27], v[80:83]
s_waitcnt lgkmcnt(4)
v_mfma_f32_16x16x32_bf16 v[68:71], a[200:203], v[28:31], v[68:71]
ds_read_b128 v[20:23], v10 offset:57344
v_mfma_f32_16x16x32_bf16 v[72:75], a[204:207], v[28:31], v[72:75]
v_mfma_f32_16x16x32_bf16 v[76:79], a[200:203], v[32:35], v[76:79]
ds_read_b128 v[24:27], v10 offset:59392
v_mfma_f32_16x16x32_bf16 v[80:83], a[204:207], v[32:35], v[80:83]
s_waitcnt lgkmcnt(4)
v_mfma_f32_16x16x32_bf16 v[68:71], a[208:211], v[36:39], v[68:71]
ds_read_b128 v[28:31], v11 offset:57344
v_mfma_f32_16x16x32_bf16 v[72:75], a[212:215], v[36:39], v[72:75]
v_mfma_f32_16x16x32_bf16 v[76:79], a[208:211], v[40:43], v[76:79]
ds_read_b128 v[32:35], v11 offset:59392
v_mfma_f32_16x16x32_bf16 v[80:83], a[212:215], v[40:43], v[80:83]
s_waitcnt lgkmcnt(4)
v_mfma_f32_16x16x32_bf16 v[68:71], a[216:219], v[44:47], v[68:71]
ds_read_b128 v[36:39], v10 offset:61440
v_mfma_f32_16x16x32_bf16 v[72:75], a[220:223], v[44:47], v[72:75]
v_mfma_f32_16x16x32_bf16 v[76:79], a[216:219], v[48:51], v[76:79]
ds_read_b128 v[40:43], v10 offset:63488
v_mfma_f32_16x16x32_bf16 v[80:83], a[220:223], v[48:51], v[80:83]
s_waitcnt lgkmcnt(4)
v_mfma_f32_16x16x32_bf16 v[68:71], a[224:227], v[20:23], v[68:71]
ds_read_b128 v[44:47], v11 offset:61440
v_mfma_f32_16x16x32_bf16 v[72:75], a[228:231], v[20:23], v[72:75]
v_mfma_f32_16x16x32_bf16 v[76:79], a[224:227], v[24:27], v[76:79]
ds_read_b128 v[48:51], v11 offset:63488
v_mfma_f32_16x16x32_bf16 v[80:83], a[228:231], v[24:27], v[80:83]
s_waitcnt lgkmcnt(5)
v_mfma_f32_16x16x32_bf16 v[68:71], a[232:235], v[28:31], v[68:71]
v_mfma_f32_16x16x32_bf16 v[72:75], a[236:239], v[28:31], v[72:75]
s_waitcnt lgkmcnt(4)
v_mfma_f32_16x16x32_bf16 v[76:79], a[232:235], v[32:35], v[76:79]
v_mfma_f32_16x16x32_bf16 v[80:83], a[236:239], v[32:35], v[80:83]
s_waitcnt lgkmcnt(3)
v_mfma_f32_16x16x32_bf16 v[68:71], a[240:243], v[36:39], v[68:71]
v_mfma_f32_16x16x32_bf16 v[72:75], a[244:247], v[36:39], v[72:75]
s_waitcnt lgkmcnt(2)
v_mfma_f32_16x16x32_bf16 v[76:79], a[240:243], v[40:43], v[76:79]
v_mfma_f32_16x16x32_bf16 v[80:83], a[244:247], v[40:43], v[80:83]
s_waitcnt lgkmcnt(1)
v_mfma_f32_16x16x32_bf16 v[68:71], a[248:251], v[44:47], v[68:71]
v_mfma_f32_16x16x32_bf16 v[72:75], a[252:255], v[44:47], v[72:75]
s_waitcnt lgkmcnt(0)
v_mfma_f32_16x16x32_bf16 v[76:79], a[248:251], v[48:51], v[76:79]
v_mfma_f32_16x16x32_bf16 v[80:83], a[252:255], v[48:51], v[80:83]
s_add_u32 s42, s42, 1
s_cmp_eq_u32 s42, 64
s_cbranch_scc1 mega_kernel_k_fin
s_waitcnt vmcnt(2)
s_barrier
s_add_u32 s50, s42, 1
s_min_u32 s50, s50, 63
s_lshl_b32 s50, s50, 16
ds_read_b128 v[20:23], v8 offset:0
ds_read_b128 v[24:27], v8 offset:2048
ds_read_b128 v[28:31], v9 offset:0
ds_read_b128 v[32:35], v9 offset:2048
ds_read_b128 v[36:39], v8 offset:4096
ds_read_b128 v[40:43], v8 offset:6144
s_waitcnt lgkmcnt(4)
v_mfma_f32_16x16x32_bf16 v[52:55], a[0:3], v[20:23], 0
ds_read_b128 v[44:47], v9 offset:4096
v_mfma_f32_16x16x32_bf16 v[56:59], a[4:7], v[20:23], 0
v_cvt_pk_bf16_f32 v84, v68, v69
v_cvt_pk_bf16_f32 v85, v70, v71
v_cvt_pk_bf16_f32 v86, v72, v73
v_mfma_f32_16x16x32_bf16 v[60:63], a[0:3], v[24:27], 0
ds_read_b128 v[48:51], v9 offset:6144
v_mfma_f32_16x16x32_bf16 v[64:67], a[4:7], v[24:27], 0
v_cvt_pk_bf16_f32 v87, v74, v75
v_cvt_pk_bf16_f32 v88, v76, v77
v_cvt_pk_bf16_f32 v89, v78, v79
s_waitcnt lgkmcnt(4)
v_mfma_f32_16x16x32_bf16 v[52:55], a[8:11], v[28:31], v[52:55]
ds_read_b128 v[20:23], v8 offset:8192
v_mfma_f32_16x16x32_bf16 v[56:59], a[12:15], v[28:31], v[56:59]
v_cvt_pk_bf16_f32 v90, v80, v81
v_cvt_pk_bf16_f32 v91, v82, v83
v_mfma_f32_16x16x32_bf16 v[60:63], a[8:11], v[32:35], v[60:63]
ds_read_b128 v[24:27], v8 offset:10240
v_mfma_f32_16x16x32_bf16 v[64:67], a[12:15], v[32:35], v[64:67]
s_add_u32 s51, s42, s47
s_sub_u32 s51, s51, 1
s_bfe_u32 s52, s51, 0x40002
s_lshl_b32 s52, s52, 14
s_waitcnt lgkmcnt(4)
v_mfma_f32_16x16x32_bf16 v[52:55], a[16:19], v[36:39], v[52:55]
ds_read_b128 v[28:31], v9 offset:8192
v_mfma_f32_16x16x32_bf16 v[56:59], a[20:23], v[36:39], v[56:59]
s_and_b32 s51, s51, 3
s_lshl_b32 s51, s51, 11
s_add_u32 s51, s51, s52
s_add_u32 s51, s51, s48
buffer_store_dwordx4 v[84:87], v7, s[84:87], s51 offen sc1
v_mfma_f32_16x16x32_bf16 v[60:63], a[16:19], v[40:43], v[60:63]
ds_read_b128 v[32:35], v9 offset:10240
v_mfma_f32_16x16x32_bf16 v[64:67], a[20:23], v[40:43], v[64:67]
buffer_store_dwordx4 v[88:91], v7, s[84:87], s51 offen offset:1024 sc1
s_waitcnt lgkmcnt(4)
v_mfma_f32_16x16x32_bf16 v[52:55], a[24:27], v[44:47], v[52:55]
ds_read_b128 v[36:39], v8 offset:12288
v_mfma_f32_16x16x32_bf16 v[56:59], a[28:31], v[44:47], v[56:59]
s_add_u32 m0, s46, 65536
v_mfma_f32_16x16x32_bf16 v[60:63], a[24:27], v[48:51], v[60:63]
ds_read_b128 v[40:43], v8 offset:14336
v_mfma_f32_16x16x32_bf16 v[64:67], a[28:31], v[48:51], v[64:67]
buffer_load_dwordx4 v6, s[8:11], s50 offen offset:0 lds
s_waitcnt lgkmcnt(4)
v_mfma_f32_16x16x32_bf16 v[52:55], a[32:35], v[20:23], v[52:55]
ds_read_b128 v[44:47], v9 offset:12288
v_mfma_f32_16x16x32_bf16 v[56:59], a[36:39], v[20:23], v[56:59]
s_add_u32 m0, s46, 69504
v_mfma_f32_16x16x32_bf16 v[60:63], a[32:35], v[24:27], v[60:63]
ds_read_b128 v[48:51], v9 offset:14336
v_mfma_f32_16x16x32_bf16 v[64:67], a[36:39], v[24:27], v[64:67]
buffer_load_dwordx4 v6, s[8:11], s50 offen offset:128 lds
s_waitcnt lgkmcnt(4)
v_mfma_f32_16x16x32_bf16 v[52:55], a[40:43], v[28:31], v[52:55]
ds_read_b128 v[20:23], v8 offset:16384
v_mfma_f32_16x16x32_bf16 v[56:59], a[44:47], v[28:31], v[56:59]
s_add_u32 m0, s46, 73472
v_mfma_f32_16x16x32_bf16 v[60:63], a[40:43], v[32:35], v[60:63]
ds_read_b128 v[24:27], v8 offset:18432
v_mfma_f32_16x16x32_bf16 v[64:67], a[44:47], v[32:35], v[64:67]
buffer_load_dwordx4 v6, s[8:11], s50 offen offset:256 lds
s_waitcnt lgkmcnt(4)
v_mfma_f32_16x16x32_bf16 v[52:55], a[48:51], v[36:39], v[52:55]
ds_read_b128 v[28:31], v9 offset:16384
v_mfma_f32_16x16x32_bf16 v[56:59], a[52:55], v[36:39], v[56:59]
s_add_u32 m0, s46, 77440
v_mfma_f32_16x16x32_bf16 v[60:63], a[48:51], v[40:43], v[60:63]
ds_read_b128 v[32:35], v9 offset:18432
v_mfma_f32_16x16x32_bf16 v[64:67], a[52:55], v[40:43], v[64:67]
buffer_load_dwordx4 v6, s[8:11], s50 offen offset:384 lds
s_waitcnt lgkmcnt(4)
v_mfma_f32_16x16x32_bf16 v[52:55], a[56:59], v[44:47], v[52:55]
ds_read_b128 v[36:39], v8 offset:20480
v_mfma_f32_16x16x32_bf16 v[56:59], a[60:63], v[44:47], v[56:59]
s_add_u32 m0, s46, 81408
v_mfma_f32_16x16x32_bf16 v[60:63], a[56:59], v[48:51], v[60:63]
ds_read_b128 v[40:43], v8 offset:22528
v_mfma_f32_16x16x32_bf16 v[64:67], a[60:63], v[48:51], v[64:67]
buffer_load_dwordx4 v6, s[8:11], s50 offen offset:512 lds
s_waitcnt lgkmcnt(4)
v_mfma_f32_16x16x32_bf16 v[52:55], a[64:67], v[20:23], v[52:55]
ds_read_b128 v[44:47], v9 offset:20480
v_mfma_f32_16x16x32_bf16 v[56:59], a[68:71], v[20:23], v[56:59]
s_add_u32 m0, s46, 85376
v_mfma_f32_16x16x32_bf16 v[60:63], a[64:67], v[24:27], v[60:63]
ds_read_b128 v[48:51], v9 offset:22528
v_mfma_f32_16x16x32_bf16 v[64:67], a[68:71], v[24:27], v[64:67]
buffer_load_dwordx4 v6, s[8:11], s50 offen offset:640 lds
s_waitcnt lgkmcnt(4)
v_mfma_f32_16x16x32_bf16 v[52:55], a[72:75], v[28:31], v[52:55]
ds_read_b128 v[20:23], v8 offset:24576
v_mfma_f32_16x16x32_bf16 v[56:59], a[76:79], v[28:31], v[56:59]
s_add_u32 m0, s46, 89344
v_mfma_f32_16x16x32_bf16 v[60:63], a[72:75], v[32:35], v[60:63]
ds_read_b128 v[24:27], v8 offset:26624
v_mfma_f32_16x16x32_bf16 v[64:67], a[76:79], v[32:35], v[64:67]
buffer_load_dwordx4 v6, s[8:11], s50 offen offset:768 lds
s_waitcnt lgkmcnt(4)
v_mfma_f32_16x16x32_bf16 v[52:55], a[80:83], v[36:39], v[52:55]
ds_read_b128 v[28:31], v9 offset:24576
v_mfma_f32_16x16x32_bf16 v[56:59], a[84:87], v[36:39], v[56:59]
s_add_u32 m0, s46, 93312
v_mfma_f32_16x16x32_bf16 v[60:63], a[80:83], v[40:43], v[60:63]
ds_read_b128 v[32:35], v9 offset:26624
v_mfma_f32_16x16x32_bf16 v[64:67], a[84:87], v[40:43], v[64:67]
buffer_load_dwordx4 v6, s[8:11], s50 offen offset:896 lds
s_waitcnt lgkmcnt(4)
v_mfma_f32_16x16x32_bf16 v[52:55], a[88:91], v[44:47], v[52:55]
ds_read_b128 v[36:39], v8 offset:28672
v_mfma_f32_16x16x32_bf16 v[56:59], a[92:95], v[44:47], v[56:59]
s_add_u32 m0, s46, 97280
v_mfma_f32_16x16x32_bf16 v[60:63], a[88:91], v[48:51], v[60:63]
ds_read_b128 v[40:43], v8 offset:30720
v_mfma_f32_16x16x32_bf16 v[64:67], a[92:95], v[48:51], v[64:67]
buffer_load_dwordx4 v6, s[8:11], s50 offen offset:1024 lds
s_waitcnt lgkmcnt(4)
v_mfma_f32_16x16x32_bf16 v[52:55], a[96:99], v[20:23], v[52:55]
ds_read_b128 v[44:47], v9 offset:28672
v_mfma_f32_16x16x32_bf16 v[56:59], a[100:103], v[20:23], v[56:59]
s_add_u32 m0, s46, 101248
v_mfma_f32_16x16x32_bf16 v[60:63], a[96:99], v[24:27], v[60:63]
ds_read_b128 v[48:51], v9 offset:30720
v_mfma_f32_16x16x32_bf16 v[64:67], a[100:103], v[24:27], v[64:67]
buffer_load_dwordx4 v6, s[8:11], s50 offen offset:1152 lds
s_waitcnt lgkmcnt(4)
v_mfma_f32_16x16x32_bf16 v[52:55], a[104:107], v[28:31], v[52:55]
ds_read_b128 v[20:23], v8 offset:32768
v_mfma_f32_16x16x32_bf16 v[56:59], a[108:111], v[28:31], v[56:59]
s_add_u32 m0, s46, 105216
v_mfma_f32_16x16x32_bf16 v[60:63], a[104:107], v[32:35], v[60:63]
ds_read_b128 v[24:27], v8 offset:34816
v_mfma_f32_16x16x32_bf16 v[64:67], a[108:111], v[32:35], v[64:67]
buffer_load_dwordx4 v6, s[8:11], s50 offen offset:1280 lds
s_waitcnt lgkmcnt(4)
v_mfma_f32_16x16x32_bf16 v[52:55], a[112:115], v[36:39], v[52:55]
ds_read_b128 v[28:31], v9 offset:32768
v_mfma_f32_16x16x32_bf16 v[56:59], a[116:119], v[36:39], v[56:59]
s_add_u32 m0, s46, 109184
v_mfma_f32_16x16x32_bf16 v[60:63], a[112:115], v[40:43], v[60:63]
ds_read_b128 v[32:35], v9 offset:34816
v_mfma_f32_16x16x32_bf16 v[64:67], a[116:119], v[40:43], v[64:67]
buffer_load_dwordx4 v6, s[8:11], s50 offen offset:1408 lds
s_waitcnt lgkmcnt(4)
v_mfma_f32_16x16x32_bf16 v[52:55], a[120:123], v[44:47], v[52:55]
ds_read_b128 v[36:39], v8 offset:36864
v_mfma_f32_16x16x32_bf16 v[56:59], a[124:127], v[44:47], v[56:59]
s_add_u32 m0, s46, 113152
v_mfma_f32_16x16x32_bf16 v[60:63], a[120:123], v[48:51], v[60:63]
ds_read_b128 v[40:43], v8 offset:38912
v_mfma_f32_16x16x32_bf16 v[64:67], a[124:127], v[48:51], v[64:67]
buffer_load_dwordx4 v6, s[8:11], s50 offen offset:1536 lds
s_waitcnt lgkmcnt(4)
v_mfma_f32_16x16x32_bf16 v[52:55], a[128:131], v[20:23], v[52:55]
ds_read_b128 v[44:47], v9 offset:36864
v_mfma_f32_16x16x32_bf16 v[56:59], a[132:135], v[20:23], v[56:59]
s_add_u32 m0, s46, 117120
v_mfma_f32_16x16x32_bf16 v[60:63], a[128:131], v[24:27], v[60:63]
ds_read_b128 v[48:51], v9 offset:38912
v_mfma_f32_16x16x32_bf16 v[64:67], a[132:135], v[24:27], v[64:67]
buffer_load_dwordx4 v6, s[8:11], s50 offen offset:1664 lds
s_waitcnt lgkmcnt(4)
v_mfma_f32_16x16x32_bf16 v[52:55], a[136:139], v[28:31], v[52:55]
ds_read_b128 v[20:23], v8 offset:40960
v_mfma_f32_16x16x32_bf16 v[56:59], a[140:143], v[28:31], v[56:59]
s_add_u32 m0, s46, 121088
v_mfma_f32_16x16x32_bf16 v[60:63], a[136:139], v[32:35], v[60:63]
ds_read_b128 v[24:27], v8 offset:43008
v_mfma_f32_16x16x32_bf16 v[64:67], a[140:143], v[32:35], v[64:67]
buffer_load_dwordx4 v6, s[8:11], s50 offen offset:1792 lds
s_waitcnt lgkmcnt(4)
v_mfma_f32_16x16x32_bf16 v[52:55], a[144:147], v[36:39], v[52:55]
ds_read_b128 v[28:31], v9 offset:40960
v_mfma_f32_16x16x32_bf16 v[56:59], a[148:151], v[36:39], v[56:59]
s_add_u32 m0, s46, 125056
v_mfma_f32_16x16x32_bf16 v[60:63], a[144:147], v[40:43], v[60:63]
ds_read_b128 v[32:35], v9 offset:43008
v_mfma_f32_16x16x32_bf16 v[64:67], a[148:151], v[40:43], v[64:67]
buffer_load_dwordx4 v6, s[8:11], s50 offen offset:1920 lds
s_waitcnt lgkmcnt(4)
v_mfma_f32_16x16x32_bf16 v[52:55], a[152:155], v[44:47], v[52:55]
ds_read_b128 v[36:39], v8 offset:45056
v_mfma_f32_16x16x32_bf16 v[56:59], a[156:159], v[44:47], v[56:59]
v_mfma_f32_16x16x32_bf16 v[60:63], a[152:155], v[48:51], v[60:63]
ds_read_b128 v[40:43], v8 offset:47104
v_mfma_f32_16x16x32_bf16 v[64:67], a[156:159], v[48:51], v[64:67]
s_waitcnt lgkmcnt(4)
v_mfma_f32_16x16x32_bf16 v[52:55], a[160:163], v[20:23], v[52:55]
ds_read_b128 v[44:47], v9 offset:45056
v_mfma_f32_16x16x32_bf16 v[56:59], a[164:167], v[20:23], v[56:59]
v_mfma_f32_16x16x32_bf16 v[60:63], a[160:163], v[24:27], v[60:63]
ds_read_b128 v[48:51], v9 offset:47104
v_mfma_f32_16x16x32_bf16 v[64:67], a[164:167], v[24:27], v[64:67]
s_waitcnt lgkmcnt(4)
v_mfma_f32_16x16x32_bf16 v[52:55], a[168:171], v[28:31], v[52:55]
ds_read_b128 v[20:23], v8 offset:49152
v_mfma_f32_16x16x32_bf16 v[56:59], a[172:175], v[28:31], v[56:59]
s_waitcnt vmcnt(16)
v_mov_b32 v17, s42
s_mov_b64 exec, 1
buffer_store_dword v17, v16, s[84:87], s49 offen sc1
s_mov_b64 exec, -1
v_mfma_f32_16x16x32_bf16 v[60:63], a[168:171], v[32:35], v[60:63]
ds_read_b128 v[24:27], v8 offset:51200
v_mfma_f32_16x16x32_bf16 v[64:67], a[172:175], v[32:35], v[64:67]
s_waitcnt lgkmcnt(4)
v_mfma_f32_16x16x32_bf16 v[52:55], a[176:179], v[36:39], v[52:55]
ds_read_b128 v[28:31], v9 offset:49152
v_mfma_f32_16x16x32_bf16 v[56:59], a[180:183], v[36:39], v[56:59]
s_add_u32 s53, s42, 3
s_min_u32 s53, s53, 63
s_lshl_b32 s53, s53, 16
s_mov_b64 exec, 0xffff
buffer_load_dword v250, v19, s[8:11], s53 offen
s_mov_b64 exec, -1
v_mfma_f32_16x16x32_bf16 v[60:63], a[176:179], v[40:43], v[60:63]
ds_read_b128 v[32:35], v9 offset:51200
v_mfma_f32_16x16x32_bf16 v[64:67], a[180:183], v[40:43], v[64:67]
s_waitcnt lgkmcnt(4)
v_mfma_f32_16x16x32_bf16 v[52:55], a[184:187], v[44:47], v[52:55]
ds_read_b128 v[36:39], v8 offset:53248
v_mfma_f32_16x16x32_bf16 v[56:59], a[188:191], v[44:47], v[56:59]
v_mfma_f32_16x16x32_bf16 v[60:63], a[184:187], v[48:51], v[60:63]
ds_read_b128 v[40:43], v8 offset:55296
v_mfma_f32_16x16x32_bf16 v[64:67], a[188:191], v[48:51], v[64:67]
s_waitcnt lgkmcnt(4)
v_mfma_f32_16x16x32_bf16 v[52:55], a[192:195], v[20:23], v[52:55]
ds_read_b128 v[44:47], v9 offset:53248
v_mfma_f32_16x16x32_bf16 v[56:59], a[196:199], v[20:23], v[56:59]
v_mfma_f32_16x16x32_bf16 v[60:63], a[192:195], v[24:27], v[60:63]
ds_read_b128 v[48:51], v9 offset:55296
v_mfma_f32_16x16x32_bf16 v[64:67], a[196:199], v[24:27], v[64:67]
s_waitcnt lgkmcnt(4)
v_mfma_f32_16x16x32_bf16 v[52:55], a[200:203], v[28:31], v[52:55]
ds_read_b128 v[20:23], v8 offset:57344
v_mfma_f32_16x16x32_bf16 v[56:59], a[204:207], v[28:31], v[56:59]
v_mfma_f32_16x16x32_bf16 v[60:63], a[200:203], v[32:35], v[60:63]
ds_read_b128 v[24:27], v8 offset:59392
v_mfma_f32_16x16x32_bf16 v[64:67], a[204:207], v[32:35], v[64:67]
s_waitcnt lgkmcnt(4)
v_mfma_f32_16x16x32_bf16 v[52:55], a[208:211], v[36:39], v[52:55]
ds_read_b128 v[28:31], v9 offset:57344
v_mfma_f32_16x16x32_bf16 v[56:59], a[212:215], v[36:39], v[56:59]
v_mfma_f32_16x16x32_bf16 v[60:63], a[208:211], v[40:43], v[60:63]
ds_read_b128 v[32:35], v9 offset:59392
v_mfma_f32_16x16x32_bf16 v[64:67], a[212:215], v[40:43], v[64:67]
s_waitcnt lgkmcnt(4)
v_mfma_f32_16x16x32_bf16 v[52:55], a[216:219], v[44:47], v[52:55]
ds_read_b128 v[36:39], v8 offset:61440
v_mfma_f32_16x16x32_bf16 v[56:59], a[220:223], v[44:47], v[56:59]
v_mfma_f32_16x16x32_bf16 v[60:63], a[216:219], v[48:51], v[60:63]
ds_read_b128 v[40:43], v8 offset:63488
v_mfma_f32_16x16x32_bf16 v[64:67], a[220:223], v[48:51], v[64:67]
s_waitcnt lgkmcnt(4)
v_mfma_f32_16x16x32_bf16 v[52:55], a[224:227], v[20:23], v[52:55]
ds_read_b128 v[44:47], v9 offset:61440
v_mfma_f32_16x16x32_bf16 v[56:59], a[228:231], v[20:23], v[56:59]
v_mfma_f32_16x16x32_bf16 v[60:63], a[224:227], v[24:27], v[60:63]
ds_read_b128 v[48:51], v9 offset:63488
v_mfma_f32_16x16x32_bf16 v[64:67], a[228:231], v[24:27], v[64:67]
s_waitcnt lgkmcnt(5)
v_mfma_f32_16x16x32_bf16 v[52:55], a[232:235], v[28:31], v[52:55]
v_mfma_f32_16x16x32_bf16 v[56:59], a[236:239], v[28:31], v[56:59]
s_waitcnt lgkmcnt(4)
v_mfma_f32_16x16x32_bf16 v[60:63], a[232:235], v[32:35], v[60:63]
v_mfma_f32_16x16x32_bf16 v[64:67], a[236:239], v[32:35], v[64:67]
s_waitcnt lgkmcnt(3)
v_mfma_f32_16x16x32_bf16 v[52:55], a[240:243], v[36:39], v[52:55]
v_mfma_f32_16x16x32_bf16 v[56:59], a[244:247], v[36:39], v[56:59]
s_waitcnt lgkmcnt(2)
v_mfma_f32_16x16x32_bf16 v[60:63], a[240:243], v[40:43], v[60:63]
v_mfma_f32_16x16x32_bf16 v[64:67], a[244:247], v[40:43], v[64:67]
s_waitcnt lgkmcnt(1)
v_mfma_f32_16x16x32_bf16 v[52:55], a[248:251], v[44:47], v[52:55]
v_mfma_f32_16x16x32_bf16 v[56:59], a[252:255], v[44:47], v[56:59]
s_waitcnt lgkmcnt(0)
v_mfma_f32_16x16x32_bf16 v[60:63], a[248:251], v[48:51], v[60:63]
v_mfma_f32_16x16x32_bf16 v[64:67], a[252:255], v[48:51], v[64:67]
s_add_u32 s42, s42, 1
s_branch mega_kernel_k_loop
mega_kernel_k_fin:
s_nop 11
v_cvt_pk_bf16_f32 v84, v68, v69
v_cvt_pk_bf16_f32 v85, v70, v71
v_cvt_pk_bf16_f32 v86, v72, v73
v_cvt_pk_bf16_f32 v87, v74, v75
v_cvt_pk_bf16_f32 v88, v76, v77
v_cvt_pk_bf16_f32 v89, v78, v79
v_cvt_pk_bf16_f32 v90, v80, v81
v_cvt_pk_bf16_f32 v91, v82, v83
s_add_u32 s51, s42, s47
s_sub_u32 s51, s51, 1
s_bfe_u32 s52, s51, 0x40002
s_lshl_b32 s52, s52, 14
s_and_b32 s51, s51, 3
s_lshl_b32 s51, s51, 11
s_add_u32 s51, s51, s52
s_add_u32 s51, s51, s48
buffer_store_dwordx4 v[84:87], v7, s[84:87], s51 offen sc1
buffer_store_dwordx4 v[88:91], v7, s[84:87], s51 offen offset:1024 sc1
s_waitcnt vmcnt(0)
v_mov_b32 v17, s42
s_mov_b64 exec, 1
buffer_store_dword v17, v16, s[84:87], s49 offen sc1
s_mov_b64 exec, -1
s_waitcnt vmcnt(0)
s_barrier
s_branch mega_kernel_fft
mega_kernel_rv:
s_load_dwordx2 s[4:5], s[0:1], 32
s_load_dwordx2 s[8:9], s[0:1], 0
v_lshrrev_b32 v2, 6, v0
v_and_b32 v1, 63, v0
v_readfirstlane_b32 s41, v2
v_lshlrev_b32 v5, 4, v1
s_waitcnt lgkmcnt(0)
s_mov_b32 s6, 8388608
s_mov_b32 s7, 0x00020000
s_mov_b32 s10, 4194304
s_mov_b32 s11, 0x00020000
s_lshl_b32 s43, s40, 8
s_lshl_b32 s44, s41, 6
s_add_u32 s48, s43, s44
s_and_b32 s43, s48, 0x7ff
v_add_u32 v19, s43, v1
v_lshlrev_b32 v19, 7, v19
buffer_load_dword v250, v19, s[8:11], 0 offen
s_nop 0
v_lshrrev_b32 v2, 3, v1
s_lshl_b32 s43, s41, 3
v_add_u32 v2, s43, v2
v_bfe_u32 v3, v2, 1, 3
v_and_b32 v4, 7, v1
v_xor_b32 v3, v3, v4
v_lshlrev_b32 v6, 11, v2
v_lshl_add_u32 v6, v3, 4, v6
s_lshl_b32 s46, s41, 10
v_and_b32 v2, 15, v1
v_bfe_u32 v3, v2, 1, 3
v_lshrrev_b32 v4, 4, v1
v_xor_b32 v3, v3, v4
v_lshlrev_b32 v8, 7, v2
v_lshl_add_u32 v8, v3, 4, v8
v_xor_b32 v9, 64, v8
v_add_u32 v10, 0x10000, v8
v_add_u32 v11, 0x10000, v9
v_mov_b32 v7, v5
s_lshl_b32 s47, s40, 2
s_add_u32 s47, s47, s41
s_mov_b32 s42, 0
s_mov_b32 s50, 0
s_add_u32 m0, s46, 0
s_nop 0
buffer_load_dwordx4 v6, s[8:11], s50 offen offset:0 lds
s_add_u32 m0, s46, 3968
s_nop 0
buffer_load_dwordx4 v6, s[8:11], s50 offen offset:128 lds
s_add_u32 m0, s46, 7936
s_nop 0
buffer_load_dwordx4 v6, s[8:11], s50 offen offset:256 lds
s_add_u32 m0, s46, 11904
s_nop 0
buffer_load_dwordx4 v6, s[8:11], s50 offen offset:384 lds
s_add_u32 m0, s46, 15872
s_nop 0
buffer_load_dwordx4 v6, s[8:11], s50 offen offset:512 lds
s_add_u32 m0, s46, 19840
s_nop 0
buffer_load_dwordx4 v6, s[8:11], s50 offen offset:640 lds
s_add_u32 m0, s46, 23808
s_nop 0
buffer_load_dwordx4 v6, s[8:11], s50 offen offset:768 lds
s_add_u32 m0, s46, 27776
s_nop 0
buffer_load_dwordx4 v6, s[8:11], s50 offen offset:896 lds
s_add_u32 m0, s46, 31744
s_nop 0
buffer_load_dwordx4 v6, s[8:11], s50 offen offset:1024 lds
s_add_u32 m0, s46, 35712
s_nop 0
buffer_load_dwordx4 v6, s[8:11], s50 offen offset:1152 lds
s_add_u32 m0, s46, 39680
s_nop 0
buffer_load_dwordx4 v6, s[8:11], s50 offen offset:1280 lds
s_add_u32 m0, s46, 43648
s_nop 0
buffer_load_dwordx4 v6, s[8:11], s50 offen offset:1408 lds
s_add_u32 m0, s46, 47616
s_nop 0
buffer_load_dwordx4 v6, s[8:11], s50 offen offset:1536 lds
s_add_u32 m0, s46, 51584
s_nop 0
buffer_load_dwordx4 v6, s[8:11], s50 offen offset:1664 lds
s_add_u32 m0, s46, 55552
s_nop 0
buffer_load_dwordx4 v6, s[8:11], s50 offen offset:1792 lds
s_add_u32 m0, s46, 59520
s_nop 0
buffer_load_dwordx4 v6, s[8:11], s50 offen offset:1920 lds
v_lshrrev_b32 v2, 2, v1
v_and_b32 v3, 3, v1
v_lshlrev_b32 v16, 13, v2
v_lshl_add_u32 v16, v3, 4, v16
v_add_u32 v16, s48, v16
s_mul_i32 s45, s41, 24576
s_add_u32 s45, s45, 65536
v_bfe_u32 v17, v1, 2, 2
v_lshrrev_b32 v18, 4, v1
v_lshl_add_u32 v17, v18, 3, v17
v_lshlrev_b32 v17, 6, v17
v_lshl_add_u32 v17, v3, 3, v17
v_add_u32 v17, s45, v17
s_and_b32 s43, s40, 3
s_lshl_b32 s43, s43, 2
s_add_u32 s43, s43, s41
s_lshl_b32 s43, s43, 3
v_and_b32 v12, 7, v1
v_add_u32 v12, s43, v12
s_lshr_b32 s43, s40, 2
s_lshl_b32 s43, s43, 10
s_add_u32 s44, s43, 896
s_add_u32 s43, s43, 384
s_cmp_ge_u32 s40, 28
s_cselect_b32 s44, s44, s43
v_mov_b32 v13, s43
v_mov_b32 v14, s44
v_cmp_gt_u32 vcc, 32, v1
s_nop 1
v_cndmask_b32 v13, v14, v13, vcc
v_lshl_add_u32 v12, v12, 13, v13
s_mov_b32 s44, 0
buffer_load_dword v250, v12, s[4:7], s44 offen
s_add_u32 m0, s45, 0
s_mov_b32 s44, 0
buffer_load_dwordx4 v16, s[4:7], s44 offen lds
s_add_u32 m0, s45, 1024
s_mov_b32 s44, 131072
buffer_load_dwordx4 v16, s[4:7], s44 offen lds
s_add_u32 m0, s45, 2048
s_mov_b32 s44, 262144
buffer_load_dwordx4 v16, s[4:7], s44 offen lds
s_add_u32 m0, s45, 3072
s_mov_b32 s44, 393216
buffer_load_dwordx4 v16, s[4:7], s44 offen lds
s_add_u32 m0, s45, 4096
s_mov_b32 s44, 524288
buffer_load_dwordx4 v16, s[4:7], s44 offen lds
s_add_u32 m0, s45, 5120
s_mov_b32 s44, 655360
buffer_load_dwordx4 v16, s[4:7], s44 offen lds
s_add_u32 m0, s45, 6144
s_mov_b32 s44, 786432
buffer_load_dwordx4 v16, s[4:7], s44 offen lds
s_add_u32 m0, s45, 7168
s_mov_b32 s44, 917504
buffer_load_dwordx4 v16, s[4:7], s44 offen lds
s_mov_b32 s44, 1048576
buffer_load_dword v250, v12, s[4:7], s44 offen
s_add_u32 m0, s45, 8192
s_mov_b32 s44, 1048576
buffer_load_dwordx4 v16, s[4:7], s44 offen lds
s_add_u32 m0, s45, 9216
s_mov_b32 s44, 1179648
buffer_load_dwordx4 v16, s[4:7], s44 offen lds
s_add_u32 m0, s45, 10240
s_mov_b32 s44, 1310720
buffer_load_dwordx4 v16, s[4:7], s44 offen lds
s_add_u32 m0, s45, 11264
s_mov_b32 s44, 1441792
buffer_load_dwordx4 v16, s[4:7], s44 offen lds
s_add_u32 m0, s45, 12288
s_mov_b32 s44, 1572864
buffer_load_dwordx4 v16, s[4:7], s44 offen lds
s_add_u32 m0, s45, 13312
s_mov_b32 s44, 1703936
buffer_load_dwordx4 v16, s[4:7], s44 offen lds
s_add_u32 m0, s45, 14336
s_mov_b32 s44, 1835008
buffer_load_dwordx4 v16, s[4:7], s44 offen lds
s_add_u32 m0, s45, 15360
s_mov_b32 s44, 1966080
buffer_load_dwordx4 v16, s[4:7], s44 offen lds
s_mov_b32 s44, 2097152
buffer_load_dword v250, v12, s[4:7], s44 offen
s_add_u32 m0, s45, 16384
s_mov_b32 s44, 2097152
buffer_load_dwordx4 v16, s[4:7], s44 offen lds
s_add_u32 m0, s45, 17408
s_mov_b32 s44, 2228224
buffer_load_dwordx4 v16, s[4:7], s44 offen lds
s_add_u32 m0, s45, 18432
s_mov_b32 s44, 2359296
buffer_load_dwordx4 v16, s[4:7], s44 offen lds
s_add_u32 m0, s45, 19456
s_mov_b32 s44, 2490368
buffer_load_dwordx4 v16, s[4:7], s44 offen lds
s_add_u32 m0, s45, 20480
s_mov_b32 s44, 2621440
buffer_load_dwordx4 v16, s[4:7], s44 offen lds
s_add_u32 m0, s45, 21504
s_mov_b32 s44, 2752512
buffer_load_dwordx4 v16, s[4:7], s44 offen lds
s_add_u32 m0, s45, 22528
s_mov_b32 s44, 2883584
buffer_load_dwordx4 v16, s[4:7], s44 offen lds
s_add_u32 m0, s45, 23552
s_mov_b32 s44, 3014656
buffer_load_dwordx4 v16, s[4:7], s44 offen lds
s_waitcnt vmcnt(18)
s_barrier
ds_read_b64_tr_b16 a[0:1], v17 offset:0
ds_read_b64_tr_b16 a[2:3], v17 offset:256
ds_read_b64_tr_b16 a[4:5], v17 offset:32
ds_read_b64_tr_b16 a[6:7], v17 offset:288
ds_read_b64_tr_b16 a[8:9], v17 offset:2048
ds_read_b64_tr_b16 a[10:11], v17 offset:2304
ds_read_b64_tr_b16 a[12:13], v17 offset:2080
ds_read_b64_tr_b16 a[14:15], v17 offset:2336
s_waitcnt lgkmcnt(0)
ds_read_b64_tr_b16 a[16:17], v17 offset:4096
ds_read_b64_tr_b16 a[18:19], v17 offset:4352
ds_read_b64_tr_b16 a[20:21], v17 offset:4128
ds_read_b64_tr_b16 a[22:23], v17 offset:4384
ds_read_b64_tr_b16 a[24:25], v17 offset:6144
ds_read_b64_tr_b16 a[26:27], v17 offset:6400
ds_read_b64_tr_b16 a[28:29], v17 offset:6176
ds_read_b64_tr_b16 a[30:31], v17 offset:6432
s_waitcnt lgkmcnt(0)
ds_read_b128 v[20:23], v8 offset:0
ds_read_b128 v[24:27], v8 offset:2048
ds_read_b128 v[28:31], v9 offset:0
ds_read_b128 v[32:35], v9 offset:2048
ds_read_b128 v[36:39], v8 offset:4096
ds_read_b128 v[40:43], v8 offset:6144
ds_read_b128 v[44:47], v9 offset:4096
ds_read_b128 v[48:51], v9 offset:6144
s_mov_b32 s44, 3145728
buffer_load_dword v250, v12, s[4:7], s44 offen
s_add_u32 m0, s45, 0
s_mov_b32 s44, 3145728
buffer_load_dwordx4 v16, s[4:7], s44 offen lds
s_add_u32 m0, s45, 1024
s_mov_b32 s44, 3276800
buffer_load_dwordx4 v16, s[4:7], s44 offen lds
s_add_u32 m0, s45, 2048
s_mov_b32 s44, 3407872
buffer_load_dwordx4 v16, s[4:7], s44 offen lds
s_add_u32 m0, s45, 3072
s_mov_b32 s44, 3538944
buffer_load_dwordx4 v16, s[4:7], s44 offen lds
s_add_u32 m0, s45, 4096
s_mov_b32 s44, 3670016
buffer_load_dwordx4 v16, s[4:7], s44 offen lds
s_add_u32 m0, s45, 5120
s_mov_b32 s44, 3801088
buffer_load_dwordx4 v16, s[4:7], s44 offen lds
s_add_u32 m0, s45, 6144
s_mov_b32 s44, 3932160
buffer_load_dwordx4 v16, s[4:7], s44 offen lds
s_add_u32 m0, s45, 7168
s_mov_b32 s44, 4063232
buffer_load_dwordx4 v16, s[4:7], s44 offen lds
s_waitcnt lgkmcnt(0)
v_mfma_f32_16x16x32_bf16 v[52:55], v[20:23], a[0:3], 0
v_mfma_f32_16x16x32_bf16 v[56:59], v[20:23], a[4:7], 0
v_mfma_f32_16x16x32_bf16 v[60:63], v[24:27], a[0:3], 0
v_mfma_f32_16x16x32_bf16 v[64:67], v[24:27], a[4:7], 0
v_mfma_f32_16x16x32_bf16 v[52:55], v[28:31], a[8:11], v[52:55]
v_mfma_f32_16x16x32_bf16 v[56:59], v[28:31], a[12:15], v[56:59]
v_mfma_f32_16x16x32_bf16 v[60:63], v[32:35], a[8:11], v[60:63]
v_mfma_f32_16x16x32_bf16 v[64:67], v[32:35], a[12:15], v[64:67]
v_mfma_f32_16x16x32_bf16 v[52:55], v[36:39], a[16:19], v[52:55]
v_mfma_f32_16x16x32_bf16 v[56:59], v[36:39], a[20:23], v[56:59]
v_mfma_f32_16x16x32_bf16 v[60:63], v[40:43], a[16:19], v[60:63]
v_mfma_f32_16x16x32_bf16 v[64:67], v[40:43], a[20:23], v[64:67]
v_mfma_f32_16x16x32_bf16 v[52:55], v[44:47], a[24:27], v[52:55]
v_mfma_f32_16x16x32_bf16 v[56:59], v[44:47], a[28:31], v[56:59]
v_mfma_f32_16x16x32_bf16 v[60:63], v[48:51], a[24:27], v[60:63]
v_mfma_f32_16x16x32_bf16 v[64:67], v[48:51], a[28:31], v[64:67]
s_waitcnt vmcnt(18)
ds_read_b64_tr_b16 a[32:33], v17 offset:8192
ds_read_b64_tr_b16 a[34:35], v17 offset:8448
ds_read_b64_tr_b16 a[36:37], v17 offset:8224
ds_read_b64_tr_b16 a[38:39], v17 offset:8480
ds_read_b64_tr_b16 a[40:41], v17 offset:10240
ds_read_b64_tr_b16 a[42:43], v17 offset:10496
ds_read_b64_tr_b16 a[44:45], v17 offset:10272
ds_read_b64_tr_b16 a[46:47], v17 offset:10528
s_waitcnt lgkmcnt(0)
ds_read_b64_tr_b16 a[48:49], v17 offset:12288
ds_read_b64_tr_b16 a[50:51], v17 offset:12544
ds_read_b64_tr_b16 a[52:53], v17 offset:12320
ds_read_b64_tr_b16 a[54:55], v17 offset:12576
ds_read_b64_tr_b16 a[56:57], v17 offset:14336
ds_read_b64_tr_b16 a[58:59], v17 offset:14592
ds_read_b64_tr_b16 a[60:61], v17 offset:14368
ds_read_b64_tr_b16 a[62:63], v17 offset:14624
s_waitcnt lgkmcnt(0)
ds_read_b128 v[20:23], v8 offset:8192
ds_read_b128 v[24:27], v8 offset:10240
ds_read_b128 v[28:31], v9 offset:8192
ds_read_b128 v[32:35], v9 offset:10240
ds_read_b128 v[36:39], v8 offset:12288
ds_read_b128 v[40:43], v8 offset:14336
ds_read_b128 v[44:47], v9 offset:12288
ds_read_b128 v[48:51], v9 offset:14336
s_mov_b32 s44, 4194304
buffer_load_dword v250, v12, s[4:7], s44 offen
s_add_u32 m0, s45, 8192
s_mov_b32 s44, 4194304
buffer_load_dwordx4 v16, s[4:7], s44 offen lds
s_add_u32 m0, s45, 9216
s_mov_b32 s44, 4325376
buffer_load_dwordx4 v16, s[4:7], s44 offen lds
s_add_u32 m0, s45, 10240
s_mov_b32 s44, 4456448
buffer_load_dwordx4 v16, s[4:7], s44 offen lds
s_add_u32 m0, s45, 11264
s_mov_b32 s44, 4587520
buffer_load_dwordx4 v16, s[4:7], s44 offen lds
s_add_u32 m0, s45, 12288
s_mov_b32 s44, 4718592
buffer_load_dwordx4 v16, s[4:7], s44 offen lds
s_add_u32 m0, s45, 13312
s_mov_b32 s44, 4849664
buffer_load_dwordx4 v16, s[4:7], s44 offen lds
s_add_u32 m0, s45, 14336
s_mov_b32 s44, 4980736
buffer_load_dwordx4 v16, s[4:7], s44 offen lds
s_add_u32 m0, s45, 15360
s_mov_b32 s44, 5111808
buffer_load_dwordx4 v16, s[4:7], s44 offen lds
s_waitcnt lgkmcnt(0)
v_mfma_f32_16x16x32_bf16 v[52:55], v[20:23], a[32:35], v[52:55]
v_mfma_f32_16x16x32_bf16 v[56:59], v[20:23], a[36:39], v[56:59]
v_mfma_f32_16x16x32_bf16 v[60:63], v[24:27], a[32:35], v[60:63]
v_mfma_f32_16x16x32_bf16 v[64:67], v[24:27], a[36:39], v[64:67]
v_mfma_f32_16x16x32_bf16 v[52:55], v[28:31], a[40:43], v[52:55]
v_mfma_f32_16x16x32_bf16 v[56:59], v[28:31], a[44:47], v[56:59]
v_mfma_f32_16x16x32_bf16 v[60:63], v[32:35], a[40:43], v[60:63]
v_mfma_f32_16x16x32_bf16 v[64:67], v[32:35], a[44:47], v[64:67]
v_mfma_f32_16x16x32_bf16 v[52:55], v[36:39], a[48:51], v[52:55]
v_mfma_f32_16x16x32_bf16 v[56:59], v[36:39], a[52:55], v[56:59]
v_mfma_f32_16x16x32_bf16 v[60:63], v[40:43], a[48:51], v[60:63]
v_mfma_f32_16x16x32_bf16 v[64:67], v[40:43], a[52:55], v[64:67]
v_mfma_f32_16x16x32_bf16 v[52:55], v[44:47], a[56:59], v[52:55]
v_mfma_f32_16x16x32_bf16 v[56:59], v[44:47], a[60:63], v[56:59]
v_mfma_f32_16x16x32_bf16 v[60:63], v[48:51], a[56:59], v[60:63]
v_mfma_f32_16x16x32_bf16 v[64:67], v[48:51], a[60:63], v[64:67]
s_waitcnt vmcnt(18)
ds_read_b64_tr_b16 a[64:65], v17 offset:16384
ds_read_b64_tr_b16 a[66:67], v17 offset:16640
ds_read_b64_tr_b16 a[68:69], v17 offset:16416
ds_read_b64_tr_b16 a[70:71], v17 offset:16672
ds_read_b64_tr_b16 a[72:73], v17 offset:18432
ds_read_b64_tr_b16 a[74:75], v17 offset:18688
ds_read_b64_tr_b16 a[76:77], v17 offset:18464
ds_read_b64_tr_b16 a[78:79], v17 offset:18720
s_waitcnt lgkmcnt(0)
ds_read_b64_tr_b16 a[80:81], v17 offset:20480
ds_read_b64_tr_b16 a[82:83], v17 offset:20736
ds_read_b64_tr_b16 a[84:85], v17 offset:20512
ds_read_b64_tr_b16 a[86:87], v17 offset:20768
ds_read_b64_tr_b16 a[88:89], v17 offset:22528
ds_read_b64_tr_b16 a[90:91], v17 offset:22784
ds_read_b64_tr_b16 a[92:93], v17 offset:22560
ds_read_b64_tr_b16 a[94:95], v17 offset:22816
s_waitcnt lgkmcnt(0)
ds_read_b128 v[20:23], v8 offset:16384
ds_read_b128 v[24:27], v8 offset:18432
ds_read_b128 v[28:31], v9 offset:16384
ds_read_b128 v[32:35], v9 offset:18432
ds_read_b128 v[36:39], v8 offset:20480
ds_read_b128 v[40:43], v8 offset:22528
ds_read_b128 v[44:47], v9 offset:20480
ds_read_b128 v[48:51], v9 offset:22528
s_mov_b32 s44, 5242880
buffer_load_dword v250, v12, s[4:7], s44 offen
s_add_u32 m0, s45, 16384
s_mov_b32 s44, 5242880
buffer_load_dwordx4 v16, s[4:7], s44 offen lds
s_add_u32 m0, s45, 17408
s_mov_b32 s44, 5373952
buffer_load_dwordx4 v16, s[4:7], s44 offen lds
s_add_u32 m0, s45, 18432
s_mov_b32 s44, 5505024
buffer_load_dwordx4 v16, s[4:7], s44 offen lds
s_add_u32 m0, s45, 19456
s_mov_b32 s44, 5636096
buffer_load_dwordx4 v16, s[4:7], s44 offen lds
s_add_u32 m0, s45, 20480
s_mov_b32 s44, 5767168
buffer_load_dwordx4 v16, s[4:7], s44 offen lds
s_add_u32 m0, s45, 21504
s_mov_b32 s44, 5898240
buffer_load_dwordx4 v16, s[4:7], s44 offen lds
s_add_u32 m0, s45, 22528
s_mov_b32 s44, 6029312
buffer_load_dwordx4 v16, s[4:7], s44 offen lds
s_add_u32 m0, s45, 23552
s_mov_b32 s44, 6160384
buffer_load_dwordx4 v16, s[4:7], s44 offen lds
s_waitcnt lgkmcnt(0)
v_mfma_f32_16x16x32_bf16 v[52:55], v[20:23], a[64:67], v[52:55]
v_mfma_f32_16x16x32_bf16 v[56:59], v[20:23], a[68:71], v[56:59]
v_mfma_f32_16x16x32_bf16 v[60:63], v[24:27], a[64:67], v[60:63]
v_mfma_f32_16x16x32_bf16 v[64:67], v[24:27], a[68:71], v[64:67]
v_mfma_f32_16x16x32_bf16 v[52:55], v[28:31], a[72:75], v[52:55]
v_mfma_f32_16x16x32_bf16 v[56:59], v[28:31], a[76:79], v[56:59]
v_mfma_f32_16x16x32_bf16 v[60:63], v[32:35], a[72:75], v[60:63]
v_mfma_f32_16x16x32_bf16 v[64:67], v[32:35], a[76:79], v[64:67]
v_mfma_f32_16x16x32_bf16 v[52:55], v[36:39], a[80:83], v[52:55]
v_mfma_f32_16x16x32_bf16 v[56:59], v[36:39], a[84:87], v[56:59]
v_mfma_f32_16x16x32_bf16 v[60:63], v[40:43], a[80:83], v[60:63]
v_mfma_f32_16x16x32_bf16 v[64:67], v[40:43], a[84:87], v[64:67]
v_mfma_f32_16x16x32_bf16 v[52:55], v[44:47], a[88:91], v[52:55]
v_mfma_f32_16x16x32_bf16 v[56:59], v[44:47], a[92:95], v[56:59]
v_mfma_f32_16x16x32_bf16 v[60:63], v[48:51], a[88:91], v[60:63]
v_mfma_f32_16x16x32_bf16 v[64:67], v[48:51], a[92:95], v[64:67]
s_waitcnt vmcnt(18)
ds_read_b64_tr_b16 a[96:97], v17 offset:0
ds_read_b64_tr_b16 a[98:99], v17 offset:256
ds_read_b64_tr_b16 a[100:101], v17 offset:32
ds_read_b64_tr_b16 a[102:103], v17 offset:288
ds_read_b64_tr_b16 a[104:105], v17 offset:2048
ds_read_b64_tr_b16 a[106:107], v17 offset:2304
ds_read_b64_tr_b16 a[108:109], v17 offset:2080
ds_read_b64_tr_b16 a[110:111], v17 offset:2336
s_waitcnt lgkmcnt(0)
ds_read_b64_tr_b16 a[112:113], v17 offset:4096
ds_read_b64_tr_b16 a[114:115], v17 offset:4352
ds_read_b64_tr_b16 a[116:117], v17 offset:4128
ds_read_b64_tr_b16 a[118:119], v17 offset:4384
ds_read_b64_tr_b16 a[120:121], v17 offset:6144
ds_read_b64_tr_b16 a[122:123], v17 offset:6400
ds_read_b64_tr_b16 a[124:125], v17 offset:6176
ds_read_b64_tr_b16 a[126:127], v17 offset:6432
s_waitcnt lgkmcnt(0)
ds_read_b128 v[20:23], v8 offset:24576
ds_read_b128 v[24:27], v8 offset:26624
ds_read_b128 v[28:31], v9 offset:24576
ds_read_b128 v[32:35], v9 offset:26624
ds_read_b128 v[36:39], v8 offset:28672
ds_read_b128 v[40:43], v8 offset:30720
ds_read_b128 v[44:47], v9 offset:28672
ds_read_b128 v[48:51], v9 offset:30720
s_mov_b32 s44, 6291456
buffer_load_dword v250, v12, s[4:7], s44 offen
s_add_u32 m0, s45, 0
s_mov_b32 s44, 6291456
buffer_load_dwordx4 v16, s[4:7], s44 offen lds
s_add_u32 m0, s45, 1024
s_mov_b32 s44, 6422528
buffer_load_dwordx4 v16, s[4:7], s44 offen lds
s_add_u32 m0, s45, 2048
s_mov_b32 s44, 6553600
buffer_load_dwordx4 v16, s[4:7], s44 offen lds
s_add_u32 m0, s45, 3072
s_mov_b32 s44, 6684672
buffer_load_dwordx4 v16, s[4:7], s44 offen lds
s_add_u32 m0, s45, 4096
s_mov_b32 s44, 6815744
buffer_load_dwordx4 v16, s[4:7], s44 offen lds
s_add_u32 m0, s45, 5120
s_mov_b32 s44, 6946816
buffer_load_dwordx4 v16, s[4:7], s44 offen lds
s_add_u32 m0, s45, 6144
s_mov_b32 s44, 7077888
buffer_load_dwordx4 v16, s[4:7], s44 offen lds
s_add_u32 m0, s45, 7168
s_mov_b32 s44, 7208960
buffer_load_dwordx4 v16, s[4:7], s44 offen lds
s_waitcnt lgkmcnt(0)
v_mfma_f32_16x16x32_bf16 v[52:55], v[20:23], a[96:99], v[52:55]
v_mfma_f32_16x16x32_bf16 v[56:59], v[20:23], a[100:103], v[56:59]
v_mfma_f32_16x16x32_bf16 v[60:63], v[24:27], a[96:99], v[60:63]
v_mfma_f32_16x16x32_bf16 v[64:67], v[24:27], a[100:103], v[64:67]
v_mfma_f32_16x16x32_bf16 v[52:55], v[28:31], a[104:107], v[52:55]
v_mfma_f32_16x16x32_bf16 v[56:59], v[28:31], a[108:111], v[56:59]
v_mfma_f32_16x16x32_bf16 v[60:63], v[32:35], a[104:107], v[60:63]
v_mfma_f32_16x16x32_bf16 v[64:67], v[32:35], a[108:111], v[64:67]
v_mfma_f32_16x16x32_bf16 v[52:55], v[36:39], a[112:115], v[52:55]
v_mfma_f32_16x16x32_bf16 v[56:59], v[36:39], a[116:119], v[56:59]
v_mfma_f32_16x16x32_bf16 v[60:63], v[40:43], a[112:115], v[60:63]
v_mfma_f32_16x16x32_bf16 v[64:67], v[40:43], a[116:119], v[64:67]
v_mfma_f32_16x16x32_bf16 v[52:55], v[44:47], a[120:123], v[52:55]
v_mfma_f32_16x16x32_bf16 v[56:59], v[44:47], a[124:127], v[56:59]
v_mfma_f32_16x16x32_bf16 v[60:63], v[48:51], a[120:123], v[60:63]
v_mfma_f32_16x16x32_bf16 v[64:67], v[48:51], a[124:127], v[64:67]
s_waitcnt vmcnt(18)
ds_read_b64_tr_b16 a[128:129], v17 offset:8192
ds_read_b64_tr_b16 a[130:131], v17 offset:8448
ds_read_b64_tr_b16 a[132:133], v17 offset:8224
ds_read_b64_tr_b16 a[134:135], v17 offset:8480
ds_read_b64_tr_b16 a[136:137], v17 offset:10240
ds_read_b64_tr_b16 a[138:139], v17 offset:10496
ds_read_b64_tr_b16 a[140:141], v17 offset:10272
ds_read_b64_tr_b16 a[142:143], v17 offset:10528
s_waitcnt lgkmcnt(0)
ds_read_b64_tr_b16 a[144:145], v17 offset:12288
ds_read_b64_tr_b16 a[146:147], v17 offset:12544
ds_read_b64_tr_b16 a[148:149], v17 offset:12320
ds_read_b64_tr_b16 a[150:151], v17 offset:12576
ds_read_b64_tr_b16 a[152:153], v17 offset:14336
ds_read_b64_tr_b16 a[154:155], v17 offset:14592
ds_read_b64_tr_b16 a[156:157], v17 offset:14368
ds_read_b64_tr_b16 a[158:159], v17 offset:14624
s_waitcnt lgkmcnt(0)
ds_read_b128 v[20:23], v8 offset:32768
ds_read_b128 v[24:27], v8 offset:34816
ds_read_b128 v[28:31], v9 offset:32768
ds_read_b128 v[32:35], v9 offset:34816
ds_read_b128 v[36:39], v8 offset:36864
ds_read_b128 v[40:43], v8 offset:38912
ds_read_b128 v[44:47], v9 offset:36864
ds_read_b128 v[48:51], v9 offset:38912
s_mov_b32 s44, 7340032
buffer_load_dword v250, v12, s[4:7], s44 offen
s_add_u32 m0, s45, 8192
s_mov_b32 s44, 7340032
buffer_load_dwordx4 v16, s[4:7], s44 offen lds
s_add_u32 m0, s45, 9216
s_mov_b32 s44, 7471104
buffer_load_dwordx4 v16, s[4:7], s44 offen lds
s_add_u32 m0, s45, 10240
s_mov_b32 s44, 7602176
buffer_load_dwordx4 v16, s[4:7], s44 offen lds
s_add_u32 m0, s45, 11264
s_mov_b32 s44, 7733248
buffer_load_dwordx4 v16, s[4:7], s44 offen lds
s_add_u32 m0, s45, 12288
s_mov_b32 s44, 7864320
buffer_load_dwordx4 v16, s[4:7], s44 offen lds
s_add_u32 m0, s45, 13312
s_mov_b32 s44, 7995392
buffer_load_dwordx4 v16, s[4:7], s44 offen lds
s_add_u32 m0, s45, 14336
s_mov_b32 s44, 8126464
buffer_load_dwordx4 v16, s[4:7], s44 offen lds
s_add_u32 m0, s45, 15360
s_mov_b32 s44, 8257536
buffer_load_dwordx4 v16, s[4:7], s44 offen lds
s_waitcnt lgkmcnt(0)
v_mfma_f32_16x16x32_bf16 v[52:55], v[20:23], a[128:131], v[52:55]
v_mfma_f32_16x16x32_bf16 v[56:59], v[20:23], a[132:135], v[56:59]
v_mfma_f32_16x16x32_bf16 v[60:63], v[24:27], a[128:131], v[60:63]
v_mfma_f32_16x16x32_bf16 v[64:67], v[24:27], a[132:135], v[64:67]
v_mfma_f32_16x16x32_bf16 v[52:55], v[28:31], a[136:139], v[52:55]
v_mfma_f32_16x16x32_bf16 v[56:59], v[28:31], a[140:143], v[56:59]
v_mfma_f32_16x16x32_bf16 v[60:63], v[32:35], a[136:139], v[60:63]
v_mfma_f32_16x16x32_bf16 v[64:67], v[32:35], a[140:143], v[64:67]
v_mfma_f32_16x16x32_bf16 v[52:55], v[36:39], a[144:147], v[52:55]
v_mfma_f32_16x16x32_bf16 v[56:59], v[36:39], a[148:151], v[56:59]
v_mfma_f32_16x16x32_bf16 v[60:63], v[40:43], a[144:147], v[60:63]
v_mfma_f32_16x16x32_bf16 v[64:67], v[40:43], a[148:151], v[64:67]
v_mfma_f32_16x16x32_bf16 v[52:55], v[44:47], a[152:155], v[52:55]
v_mfma_f32_16x16x32_bf16 v[56:59], v[44:47], a[156:159], v[56:59]
v_mfma_f32_16x16x32_bf16 v[60:63], v[48:51], a[152:155], v[60:63]
v_mfma_f32_16x16x32_bf16 v[64:67], v[48:51], a[156:159], v[64:67]
s_waitcnt vmcnt(18)
ds_read_b64_tr_b16 a[160:161], v17 offset:16384
ds_read_b64_tr_b16 a[162:163], v17 offset:16640
ds_read_b64_tr_b16 a[164:165], v17 offset:16416
ds_read_b64_tr_b16 a[166:167], v17 offset:16672
ds_read_b64_tr_b16 a[168:169], v17 offset:18432
ds_read_b64_tr_b16 a[170:171], v17 offset:18688
ds_read_b64_tr_b16 a[172:173], v17 offset:18464
ds_read_b64_tr_b16 a[174:175], v17 offset:18720
s_waitcnt lgkmcnt(0)
ds_read_b64_tr_b16 a[176:177], v17 offset:20480
ds_read_b64_tr_b16 a[178:179], v17 offset:20736
ds_read_b64_tr_b16 a[180:181], v17 offset:20512
ds_read_b64_tr_b16 a[182:183], v17 offset:20768
ds_read_b64_tr_b16 a[184:185], v17 offset:22528
ds_read_b64_tr_b16 a[186:187], v17 offset:22784
ds_read_b64_tr_b16 a[188:189], v17 offset:22560
ds_read_b64_tr_b16 a[190:191], v17 offset:22816
s_waitcnt lgkmcnt(0)
ds_read_b128 v[20:23], v8 offset:40960
ds_read_b128 v[24:27], v8 offset:43008
ds_read_b128 v[28:31], v9 offset:40960
ds_read_b128 v[32:35], v9 offset:43008
ds_read_b128 v[36:39], v8 offset:45056
ds_read_b128 v[40:43], v8 offset:47104
ds_read_b128 v[44:47], v9 offset:45056
ds_read_b128 v[48:51], v9 offset:47104
s_waitcnt lgkmcnt(0)
v_mfma_f32_16x16x32_bf16 v[52:55], v[20:23], a[160:163], v[52:55]
v_mfma_f32_16x16x32_bf16 v[56:59], v[20:23], a[164:167], v[56:59]
v_mfma_f32_16x16x32_bf16 v[60:63], v[24:27], a[160:163], v[60:63]
v_mfma_f32_16x16x32_bf16 v[64:67], v[24:27], a[164:167], v[64:67]
v_mfma_f32_16x16x32_bf16 v[52:55], v[28:31], a[168:171], v[52:55]
v_mfma_f32_16x16x32_bf16 v[56:59], v[28:31], a[172:175], v[56:59]
v_mfma_f32_16x16x32_bf16 v[60:63], v[32:35], a[168:171], v[60:63]
v_mfma_f32_16x16x32_bf16 v[64:67], v[32:35], a[172:175], v[64:67]
v_mfma_f32_16x16x32_bf16 v[52:55], v[36:39], a[176:179], v[52:55]
v_mfma_f32_16x16x32_bf16 v[56:59], v[36:39], a[180:183], v[56:59]
v_mfma_f32_16x16x32_bf16 v[60:63], v[40:43], a[176:179], v[60:63]
v_mfma_f32_16x16x32_bf16 v[64:67], v[40:43], a[180:183], v[64:67]
v_mfma_f32_16x16x32_bf16 v[52:55], v[44:47], a[184:187], v[52:55]
v_mfma_f32_16x16x32_bf16 v[56:59], v[44:47], a[188:191], v[56:59]
v_mfma_f32_16x16x32_bf16 v[60:63], v[48:51], a[184:187], v[60:63]
v_mfma_f32_16x16x32_bf16 v[64:67], v[48:51], a[188:191], v[64:67]
s_waitcnt vmcnt(9)
ds_read_b64_tr_b16 a[192:193], v17 offset:0
ds_read_b64_tr_b16 a[194:195], v17 offset:256
ds_read_b64_tr_b16 a[196:197], v17 offset:32
ds_read_b64_tr_b16 a[198:199], v17 offset:288
ds_read_b64_tr_b16 a[200:201], v17 offset:2048
ds_read_b64_tr_b16 a[202:203], v17 offset:2304
ds_read_b64_tr_b16 a[204:205], v17 offset:2080
ds_read_b64_tr_b16 a[206:207], v17 offset:2336
s_waitcnt lgkmcnt(0)
ds_read_b64_tr_b16 a[208:209], v17 offset:4096
ds_read_b64_tr_b16 a[210:211], v17 offset:4352
ds_read_b64_tr_b16 a[212:213], v17 offset:4128
ds_read_b64_tr_b16 a[214:215], v17 offset:4384
ds_read_b64_tr_b16 a[216:217], v17 offset:6144
ds_read_b64_tr_b16 a[218:219], v17 offset:6400
ds_read_b64_tr_b16 a[220:221], v17 offset:6176
ds_read_b64_tr_b16 a[222:223], v17 offset:6432
s_waitcnt lgkmcnt(0)
ds_read_b128 v[20:23], v8 offset:49152
ds_read_b128 v[24:27], v8 offset:51200
ds_read_b128 v[28:31], v9 offset:49152
ds_read_b128 v[32:35], v9 offset:51200
ds_read_b128 v[36:39], v8 offset:53248
ds_read_b128 v[40:43], v8 offset:55296
ds_read_b128 v[44:47], v9 offset:53248
ds_read_b128 v[48:51], v9 offset:55296
s_waitcnt lgkmcnt(0)
v_mfma_f32_16x16x32_bf16 v[52:55], v[20:23], a[192:195], v[52:55]
v_mfma_f32_16x16x32_bf16 v[56:59], v[20:23], a[196:199], v[56:59]
v_mfma_f32_16x16x32_bf16 v[60:63], v[24:27], a[192:195], v[60:63]
v_mfma_f32_16x16x32_bf16 v[64:67], v[24:27], a[196:199], v[64:67]
v_mfma_f32_16x16x32_bf16 v[52:55], v[28:31], a[200:203], v[52:55]
v_mfma_f32_16x16x32_bf16 v[56:59], v[28:31], a[204:207], v[56:59]
v_mfma_f32_16x16x32_bf16 v[60:63], v[32:35], a[200:203], v[60:63]
v_mfma_f32_16x16x32_bf16 v[64:67], v[32:35], a[204:207], v[64:67]
v_mfma_f32_16x16x32_bf16 v[52:55], v[36:39], a[208:211], v[52:55]
v_mfma_f32_16x16x32_bf16 v[56:59], v[36:39], a[212:215], v[56:59]
v_mfma_f32_16x16x32_bf16 v[60:63], v[40:43], a[208:211], v[60:63]
v_mfma_f32_16x16x32_bf16 v[64:67], v[40:43], a[212:215], v[64:67]
v_mfma_f32_16x16x32_bf16 v[52:55], v[44:47], a[216:219], v[52:55]
v_mfma_f32_16x16x32_bf16 v[56:59], v[44:47], a[220:223], v[56:59]
v_mfma_f32_16x16x32_bf16 v[60:63], v[48:51], a[216:219], v[60:63]
v_mfma_f32_16x16x32_bf16 v[64:67], v[48:51], a[220:223], v[64:67]
s_waitcnt vmcnt(0)
ds_read_b64_tr_b16 a[224:225], v17 offset:8192
ds_read_b64_tr_b16 a[226:227], v17 offset:8448
ds_read_b64_tr_b16 a[228:229], v17 offset:8224
ds_read_b64_tr_b16 a[230:231], v17 offset:8480
ds_read_b64_tr_b16 a[232:233], v17 offset:10240
ds_read_b64_tr_b16 a[234:235], v17 offset:10496
ds_read_b64_tr_b16 a[236:237], v17 offset:10272
ds_read_b64_tr_b16 a[238:239], v17 offset:10528
s_waitcnt lgkmcnt(0)
ds_read_b64_tr_b16 a[240:241], v17 offset:12288
ds_read_b64_tr_b16 a[242:243], v17 offset:12544
ds_read_b64_tr_b16 a[244:245], v17 offset:12320
ds_read_b64_tr_b16 a[246:247], v17 offset:12576
ds_read_b64_tr_b16 a[248:249], v17 offset:14336
ds_read_b64_tr_b16 a[250:251], v17 offset:14592
ds_read_b64_tr_b16 a[252:253], v17 offset:14368
ds_read_b64_tr_b16 a[254:255], v17 offset:14624
s_waitcnt lgkmcnt(0)
ds_read_b128 v[20:23], v8 offset:57344
ds_read_b128 v[24:27], v8 offset:59392
ds_read_b128 v[28:31], v9 offset:57344
ds_read_b128 v[32:35], v9 offset:59392
ds_read_b128 v[36:39], v8 offset:61440
ds_read_b128 v[40:43], v8 offset:63488
ds_read_b128 v[44:47], v9 offset:61440
ds_read_b128 v[48:51], v9 offset:63488
s_waitcnt lgkmcnt(0)
v_mfma_f32_16x16x32_bf16 v[52:55], v[20:23], a[224:227], v[52:55]
v_mfma_f32_16x16x32_bf16 v[56:59], v[20:23], a[228:231], v[56:59]
v_mfma_f32_16x16x32_bf16 v[60:63], v[24:27], a[224:227], v[60:63]
v_mfma_f32_16x16x32_bf16 v[64:67], v[24:27], a[228:231], v[64:67]
v_mfma_f32_16x16x32_bf16 v[52:55], v[28:31], a[232:235], v[52:55]
v_mfma_f32_16x16x32_bf16 v[56:59], v[28:31], a[236:239], v[56:59]
v_mfma_f32_16x16x32_bf16 v[60:63], v[32:35], a[232:235], v[60:63]
v_mfma_f32_16x16x32_bf16 v[64:67], v[32:35], a[236:239], v[64:67]
v_mfma_f32_16x16x32_bf16 v[52:55], v[36:39], a[240:243], v[52:55]
v_mfma_f32_16x16x32_bf16 v[56:59], v[36:39], a[244:247], v[56:59]
v_mfma_f32_16x16x32_bf16 v[60:63], v[40:43], a[240:243], v[60:63]
v_mfma_f32_16x16x32_bf16 v[64:67], v[40:43], a[244:247], v[64:67]
v_mfma_f32_16x16x32_bf16 v[52:55], v[44:47], a[248:251], v[52:55]
v_mfma_f32_16x16x32_bf16 v[56:59], v[44:47], a[252:255], v[56:59]
v_mfma_f32_16x16x32_bf16 v[60:63], v[48:51], a[248:251], v[60:63]
v_mfma_f32_16x16x32_bf16 v[64:67], v[48:51], a[252:255], v[64:67]
s_barrier
s_mov_b32 s50, 0x10000
s_add_u32 m0, s46, 65536
s_nop 0
buffer_load_dwordx4 v6, s[8:11], s50 offen offset:0 lds
s_add_u32 m0, s46, 69504
s_nop 0
buffer_load_dwordx4 v6, s[8:11], s50 offen offset:128 lds
s_add_u32 m0, s46, 73472
s_nop 0
buffer_load_dwordx4 v6, s[8:11], s50 offen offset:256 lds
s_add_u32 m0, s46, 77440
s_nop 0
buffer_load_dwordx4 v6, s[8:11], s50 offen offset:384 lds
s_add_u32 m0, s46, 81408
s_nop 0
buffer_load_dwordx4 v6, s[8:11], s50 offen offset:512 lds
s_add_u32 m0, s46, 85376
s_nop 0
buffer_load_dwordx4 v6, s[8:11], s50 offen offset:640 lds
s_add_u32 m0, s46, 89344
s_nop 0
buffer_load_dwordx4 v6, s[8:11], s50 offen offset:768 lds
s_add_u32 m0, s46, 93312
s_nop 0
buffer_load_dwordx4 v6, s[8:11], s50 offen offset:896 lds
s_add_u32 m0, s46, 97280
s_nop 0
buffer_load_dwordx4 v6, s[8:11], s50 offen offset:1024 lds
s_add_u32 m0, s46, 101248
s_nop 0
buffer_load_dwordx4 v6, s[8:11], s50 offen offset:1152 lds
s_add_u32 m0, s46, 105216
s_nop 0
buffer_load_dwordx4 v6, s[8:11], s50 offen offset:1280 lds
s_add_u32 m0, s46, 109184
s_nop 0
buffer_load_dwordx4 v6, s[8:11], s50 offen offset:1408 lds
s_add_u32 m0, s46, 113152
s_nop 0
buffer_load_dwordx4 v6, s[8:11], s50 offen offset:1536 lds
s_add_u32 m0, s46, 117120
s_nop 0
buffer_load_dwordx4 v6, s[8:11], s50 offen offset:1664 lds
s_add_u32 m0, s46, 121088
s_nop 0
buffer_load_dwordx4 v6, s[8:11], s50 offen offset:1792 lds
s_add_u32 m0, s46, 125056
s_nop 0
buffer_load_dwordx4 v6, s[8:11], s50 offen offset:1920 lds
s_and_b32 s53, s47, 31
s_lshl_b32 s53, s53, 4
v_add_u32 v19, s53, v1
v_lshlrev_b32 v19, 7, v19
s_mov_b32 s42, 1
v_and_b32 v3, 15, v0
v_lshlrev_b32 v3, 4, v3
s_branch mega_kernel_syv
mega_kernel_syvw:
s_sleep 4
mega_kernel_syv:
buffer_load_dword v2, v3, s[72:75], 0 offen sc1
s_waitcnt vmcnt(0)
s_cmp_eq_u32 s95, 1
s_cbranch_scc0 mega_kernel_syvf
v_readlane_b32 s76, v2, 14
s_mov_b32 s98, 0
s_cmp_eq_u32 s76, 64
s_cbranch_scc0 mega_kernel_syvw
s_branch mega_kernel_syvd
mega_kernel_syvf:
s_mov_b32 s77, 0
s_mov_b32 s78, 0
v_readlane_b32 s76, v2, 0
s_add_u32 s77, s77, s76
s_xor_b32 s76, s76, 32
s_or_b32 s78, s78, s76
v_readlane_b32 s76, v2, 1
s_add_u32 s77, s77, s76
s_xor_b32 s76, s76, 32
s_or_b32 s78, s78, s76
v_readlane_b32 s76, v2, 2
s_add_u32 s77, s77, s76
s_xor_b32 s76, s76, 32
s_or_b32 s78, s78, s76
v_readlane_b32 s76, v2, 3
s_add_u32 s77, s77, s76
s_xor_b32 s76, s76, 32
s_or_b32 s78, s78, s76
v_readlane_b32 s76, v2, 4
s_add_u32 s77, s77, s76
s_xor_b32 s76, s76, 32
s_or_b32 s78, s78, s76
v_readlane_b32 s76, v2, 5
s_add_u32 s77, s77, s76
s_xor_b32 s76, s76, 32
s_or_b32 s78, s78, s76
v_readlane_b32 s76, v2, 6
s_add_u32 s77, s77, s76
s_xor_b32 s76, s76, 32
s_or_b32 s78, s78, s76
v_readlane_b32 s76, v2, 7
s_add_u32 s77, s77, s76
s_xor_b32 s76, s76, 32
s_or_b32 s78, s78, s76
s_cmp_eq_u32 s77, 256
s_cbranch_scc0 mega_kernel_syvw
v_mov_b32 v252, v2
s_cmp_eq_u32 s78, 0
s_cbranch_scc0 mega_kernel_slowent
v_readlane_b32 s76, v2, 10
v_readlane_b32 s77, v2, 8
s_cmp_eq_u32 s76, 64
s_cbranch_scc0 mega_kernel_syvw
s_cmp_gt_u32 s77, 32
s_cselect_b32 s98, 1, 0
mega_kernel_syvd:
s_lshr_b32 s44, s47, 3
s_xor_b32 s44, s44, s98
s_and_b32 s44, s44, 1
s_lshl_b32 s44, s44, 13
s_lshl_b32 s48, s47, 18
s_add_u32 s48, s48, s44
s_add_u32 s48, s48, 33554432
s_xor_b32 s44, s98, 1
s_lshl_b32 s44, s44, 13
s_lshl_b32 s49, s40, 7
s_add_u32 s49, s49, s44
s_lshl_b32 s44, s41, 2
s_add_u32 s49, s49, s44
s_add_u32 s49, s49, 69210112
v_mov_b32 v16, 0
v_cvt_pk_bf16_f32 v84, v52, v53
v_cvt_pk_bf16_f32 v85, v54, v55
v_cvt_pk_bf16_f32 v86, v60, v61
v_cvt_pk_bf16_f32 v87, v62, v63
v_cvt_pk_bf16_f32 v88, v56, v57
v_cvt_pk_bf16_f32 v89, v58, v59
v_cvt_pk_bf16_f32 v90, v64, v65
v_cvt_pk_bf16_f32 v91, v66, v67
s_add_u32 s51, s42, s47
s_sub_u32 s51, s51, 1
s_bfe_u32 s52, s51, 0x40002
s_lshl_b32 s52, s52, 14
s_and_b32 s51, s51, 3
s_lshl_b32 s51, s51, 11
s_add_u32 s51, s51, s52
s_add_u32 s51, s51, s48
buffer_store_dwordx4 v[84:87], v7, s[84:87], s51 offen sc1
buffer_store_dwordx4 v[88:91], v7, s[84:87], s51 offen offset:1024 sc1
s_waitcnt vmcnt(0)
v_mov_b32 v17, s42
s_mov_b64 exec, 1
buffer_store_dword v17, v16, s[84:87], s49 offen sc1
s_mov_b64 exec, -1
mega_kernel_v_loop:
s_waitcnt vmcnt(2)
s_barrier
s_add_u32 s50, s42, 1
s_min_u32 s50, s50, 63
s_lshl_b32 s50, s50, 16
ds_read_b128 v[20:23], v10 offset:0
ds_read_b128 v[24:27], v10 offset:2048
ds_read_b128 v[28:31], v11 offset:0
ds_read_b128 v[32:35], v11 offset:2048
ds_read_b128 v[36:39], v10 offset:4096
ds_read_b128 v[40:43], v10 offset:6144
s_waitcnt lgkmcnt(4)
v_mfma_f32_16x16x32_bf16 v[68:71], v[20:23], a[0:3], 0
ds_read_b128 v[44:47], v11 offset:4096
v_mfma_f32_16x16x32_bf16 v[72:75], v[20:23], a[4:7], 0
v_cvt_pk_bf16_f32 v84, v52, v53
v_cvt_pk_bf16_f32 v85, v54, v55
v_cvt_pk_bf16_f32 v86, v60, v61
v_mfma_f32_16x16x32_bf16 v[76:79], v[24:27], a[0:3], 0
ds_read_b128 v[48:51], v11 offset:6144
v_mfma_f32_16x16x32_bf16 v[80:83], v[24:27], a[4:7], 0
v_cvt_pk_bf16_f32 v87, v62, v63
v_cvt_pk_bf16_f32 v88, v56, v57
v_cvt_pk_bf16_f32 v89, v58, v59
s_waitcnt lgkmcnt(4)
v_mfma_f32_16x16x32_bf16 v[68:71], v[28:31], a[8:11], v[68:71]
ds_read_b128 v[20:23], v10 offset:8192
v_mfma_f32_16x16x32_bf16 v[72:75], v[28:31], a[12:15], v[72:75]
v_cvt_pk_bf16_f32 v90, v64, v65
v_cvt_pk_bf16_f32 v91, v66, v67
v_mfma_f32_16x16x32_bf16 v[76:79], v[32:35], a[8:11], v[76:79]
ds_read_b128 v[24:27], v10 offset:10240
v_mfma_f32_16x16x32_bf16 v[80:83], v[32:35], a[12:15], v[80:83]
s_add_u32 s51, s42, s47
s_sub_u32 s51, s51, 1
s_bfe_u32 s52, s51, 0x40002
s_lshl_b32 s52, s52, 14
s_waitcnt lgkmcnt(4)
v_mfma_f32_16x16x32_bf16 v[68:71], v[36:39], a[16:19], v[68:71]
ds_read_b128 v[28:31], v11 offset:8192
v_mfma_f32_16x16x32_bf16 v[72:75], v[36:39], a[20:23], v[72:75]
s_and_b32 s51, s51, 3
s_lshl_b32 s51, s51, 11
s_add_u32 s51, s51, s52
s_add_u32 s51, s51, s48
buffer_store_dwordx4 v[84:87], v7, s[84:87], s51 offen sc1
v_mfma_f32_16x16x32_bf16 v[76:79], v[40:43], a[16:19], v[76:79]
ds_read_b128 v[32:35], v11 offset:10240
v_mfma_f32_16x16x32_bf16 v[80:83], v[40:43], a[20:23], v[80:83]
buffer_store_dwordx4 v[88:91], v7, s[84:87], s51 offen offset:1024 sc1
s_waitcnt lgkmcnt(4)
v_mfma_f32_16x16x32_bf16 v[68:71], v[44:47], a[24:27], v[68:71]
ds_read_b128 v[36:39], v10 offset:12288
v_mfma_f32_16x16x32_bf16 v[72:75], v[44:47], a[28:31], v[72:75]
s_add_u32 m0, s46, 0
v_mfma_f32_16x16x32_bf16 v[76:79], v[48:51], a[24:27], v[76:79]
ds_read_b128 v[40:43], v10 offset:14336
v_mfma_f32_16x16x32_bf16 v[80:83], v[48:51], a[28:31], v[80:83]
buffer_load_dwordx4 v6, s[8:11], s50 offen offset:0 lds
s_waitcnt lgkmcnt(4)
v_mfma_f32_16x16x32_bf16 v[68:71], v[20:23], a[32:35], v[68:71]
ds_read_b128 v[44:47], v11 offset:12288
v_mfma_f32_16x16x32_bf16 v[72:75], v[20:23], a[36:39], v[72:75]
s_add_u32 m0, s46, 3968
v_mfma_f32_16x16x32_bf16 v[76:79], v[24:27], a[32:35], v[76:79]
ds_read_b128 v[48:51], v11 offset:14336
v_mfma_f32_16x16x32_bf16 v[80:83], v[24:27], a[36:39], v[80:83]
buffer_load_dwordx4 v6, s[8:11], s50 offen offset:128 lds
s_waitcnt lgkmcnt(4)
v_mfma_f32_16x16x32_bf16 v[68:71], v[28:31], a[40:43], v[68:71]
ds_read_b128 v[20:23], v10 offset:16384
v_mfma_f32_16x16x32_bf16 v[72:75], v[28:31], a[44:47], v[72:75]
s_add_u32 m0, s46, 7936
v_mfma_f32_16x16x32_bf16 v[76:79], v[32:35], a[40:43], v[76:79]
ds_read_b128 v[24:27], v10 offset:18432
v_mfma_f32_16x16x32_bf16 v[80:83], v[32:35], a[44:47], v[80:83]
buffer_load_dwordx4 v6, s[8:11], s50 offen offset:256 lds
s_waitcnt lgkmcnt(4)
v_mfma_f32_16x16x32_bf16 v[68:71], v[36:39], a[48:51], v[68:71]
ds_read_b128 v[28:31], v11 offset:16384
v_mfma_f32_16x16x32_bf16 v[72:75], v[36:39], a[52:55], v[72:75]
s_add_u32 m0, s46, 11904
v_mfma_f32_16x16x32_bf16 v[76:79], v[40:43], a[48:51], v[76:79]
ds_read_b128 v[32:35], v11 offset:18432
v_mfma_f32_16x16x32_bf16 v[80:83], v[40:43], a[52:55], v[80:83]
buffer_load_dwordx4 v6, s[8:11], s50 offen offset:384 lds
s_waitcnt lgkmcnt(4)
v_mfma_f32_16x16x32_bf16 v[68:71], v[44:47], a[56:59], v[68:71]
ds_read_b128 v[36:39], v10 offset:20480
v_mfma_f32_16x16x32_bf16 v[72:75], v[44:47], a[60:63], v[72:75]
s_add_u32 m0, s46, 15872
v_mfma_f32_16x16x32_bf16 v[76:79], v[48:51], a[56:59], v[76:79]
ds_read_b128 v[40:43], v10 offset:22528
v_mfma_f32_16x16x32_bf16 v[80:83], v[48:51], a[60:63], v[80:83]
buffer_load_dwordx4 v6, s[8:11], s50 offen offset:512 lds
s_waitcnt lgkmcnt(4)
v_mfma_f32_16x16x32_bf16 v[68:71], v[20:23], a[64:67], v[68:71]
ds_read_b128 v[44:47], v11 offset:20480
v_mfma_f32_16x16x32_bf16 v[72:75], v[20:23], a[68:71], v[72:75]
s_add_u32 m0, s46, 19840
v_mfma_f32_16x16x32_bf16 v[76:79], v[24:27], a[64:67], v[76:79]
ds_read_b128 v[48:51], v11 offset:22528
v_mfma_f32_16x16x32_bf16 v[80:83], v[24:27], a[68:71], v[80:83]
buffer_load_dwordx4 v6, s[8:11], s50 offen offset:640 lds
s_waitcnt lgkmcnt(4)
v_mfma_f32_16x16x32_bf16 v[68:71], v[28:31], a[72:75], v[68:71]
ds_read_b128 v[20:23], v10 offset:24576
v_mfma_f32_16x16x32_bf16 v[72:75], v[28:31], a[76:79], v[72:75]
s_add_u32 m0, s46, 23808
v_mfma_f32_16x16x32_bf16 v[76:79], v[32:35], a[72:75], v[76:79]
ds_read_b128 v[24:27], v10 offset:26624
v_mfma_f32_16x16x32_bf16 v[80:83], v[32:35], a[76:79], v[80:83]
buffer_load_dwordx4 v6, s[8:11], s50 offen offset:768 lds
s_waitcnt lgkmcnt(4)
v_mfma_f32_16x16x32_bf16 v[68:71], v[36:39], a[80:83], v[68:71]
ds_read_b128 v[28:31], v11 offset:24576
v_mfma_f32_16x16x32_bf16 v[72:75], v[36:39], a[84:87], v[72:75]
s_add_u32 m0, s46, 27776
v_mfma_f32_16x16x32_bf16 v[76:79], v[40:43], a[80:83], v[76:79]
ds_read_b128 v[32:35], v11 offset:26624
v_mfma_f32_16x16x32_bf16 v[80:83], v[40:43], a[84:87], v[80:83]
buffer_load_dwordx4 v6, s[8:11], s50 offen offset:896 lds
s_waitcnt lgkmcnt(4)
v_mfma_f32_16x16x32_bf16 v[68:71], v[44:47], a[88:91], v[68:71]
ds_read_b128 v[36:39], v10 offset:28672
v_mfma_f32_16x16x32_bf16 v[72:75], v[44:47], a[92:95], v[72:75]
s_add_u32 m0, s46, 31744
v_mfma_f32_16x16x32_bf16 v[76:79], v[48:51], a[88:91], v[76:79]
ds_read_b128 v[40:43], v10 offset:30720
v_mfma_f32_16x16x32_bf16 v[80:83], v[48:51], a[92:95], v[80:83]
buffer_load_dwordx4 v6, s[8:11], s50 offen offset:1024 lds
s_waitcnt lgkmcnt(4)
v_mfma_f32_16x16x32_bf16 v[68:71], v[20:23], a[96:99], v[68:71]
ds_read_b128 v[44:47], v11 offset:28672
v_mfma_f32_16x16x32_bf16 v[72:75], v[20:23], a[100:103], v[72:75]
s_add_u32 m0, s46, 35712
v_mfma_f32_16x16x32_bf16 v[76:79], v[24:27], a[96:99], v[76:79]
ds_read_b128 v[48:51], v11 offset:30720
v_mfma_f32_16x16x32_bf16 v[80:83], v[24:27], a[100:103], v[80:83]
buffer_load_dwordx4 v6, s[8:11], s50 offen offset:1152 lds
s_waitcnt lgkmcnt(4)
v_mfma_f32_16x16x32_bf16 v[68:71], v[28:31], a[104:107], v[68:71]
ds_read_b128 v[20:23], v10 offset:32768
v_mfma_f32_16x16x32_bf16 v[72:75], v[28:31], a[108:111], v[72:75]
s_add_u32 m0, s46, 39680
v_mfma_f32_16x16x32_bf16 v[76:79], v[32:35], a[104:107], v[76:79]
ds_read_b128 v[24:27], v10 offset:34816
v_mfma_f32_16x16x32_bf16 v[80:83], v[32:35], a[108:111], v[80:83]
buffer_load_dwordx4 v6, s[8:11], s50 offen offset:1280 lds
s_waitcnt lgkmcnt(4)
v_mfma_f32_16x16x32_bf16 v[68:71], v[36:39], a[112:115], v[68:71]
ds_read_b128 v[28:31], v11 offset:32768
v_mfma_f32_16x16x32_bf16 v[72:75], v[36:39], a[116:119], v[72:75]
s_add_u32 m0, s46, 43648
v_mfma_f32_16x16x32_bf16 v[76:79], v[40:43], a[112:115], v[76:79]
ds_read_b128 v[32:35], v11 offset:34816
v_mfma_f32_16x16x32_bf16 v[80:83], v[40:43], a[116:119], v[80:83]
buffer_load_dwordx4 v6, s[8:11], s50 offen offset:1408 lds
s_waitcnt lgkmcnt(4)
v_mfma_f32_16x16x32_bf16 v[68:71], v[44:47], a[120:123], v[68:71]
ds_read_b128 v[36:39], v10 offset:36864
v_mfma_f32_16x16x32_bf16 v[72:75], v[44:47], a[124:127], v[72:75]
s_add_u32 m0, s46, 47616
v_mfma_f32_16x16x32_bf16 v[76:79], v[48:51], a[120:123], v[76:79]
ds_read_b128 v[40:43], v10 offset:38912
v_mfma_f32_16x16x32_bf16 v[80:83], v[48:51], a[124:127], v[80:83]
buffer_load_dwordx4 v6, s[8:11], s50 offen offset:1536 lds
s_waitcnt lgkmcnt(4)
v_mfma_f32_16x16x32_bf16 v[68:71], v[20:23], a[128:131], v[68:71]
ds_read_b128 v[44:47], v11 offset:36864
v_mfma_f32_16x16x32_bf16 v[72:75], v[20:23], a[132:135], v[72:75]
s_add_u32 m0, s46, 51584
v_mfma_f32_16x16x32_bf16 v[76:79], v[24:27], a[128:131], v[76:79]
ds_read_b128 v[48:51], v11 offset:38912
v_mfma_f32_16x16x32_bf16 v[80:83], v[24:27], a[132:135], v[80:83]
buffer_load_dwordx4 v6, s[8:11], s50 offen offset:1664 lds
s_waitcnt lgkmcnt(4)
v_mfma_f32_16x16x32_bf16 v[68:71], v[28:31], a[136:139], v[68:71]
ds_read_b128 v[20:23], v10 offset:40960
v_mfma_f32_16x16x32_bf16 v[72:75], v[28:31], a[140:143], v[72:75]
s_add_u32 m0, s46, 55552
v_mfma_f32_16x16x32_bf16 v[76:79], v[32:35], a[136:139], v[76:79]
ds_read_b128 v[24:27], v10 offset:43008
v_mfma_f32_16x16x32_bf16 v[80:83], v[32:35], a[140:143], v[80:83]
buffer_load_dwordx4 v6, s[8:11], s50 offen offset:1792 lds
s_waitcnt lgkmcnt(4)
v_mfma_f32_16x16x32_bf16 v[68:71], v[36:39], a[144:147], v[68:71]
ds_read_b128 v[28:31], v11 offset:40960
v_mfma_f32_16x16x32_bf16 v[72:75], v[36:39], a[148:151], v[72:75]
s_add_u32 m0, s46, 59520
v_mfma_f32_16x16x32_bf16 v[76:79], v[40:43], a[144:147], v[76:79]
ds_read_b128 v[32:35], v11 offset:43008
v_mfma_f32_16x16x32_bf16 v[80:83], v[40:43], a[148:151], v[80:83]
buffer_load_dwordx4 v6, s[8:11], s50 offen offset:1920 lds
s_waitcnt lgkmcnt(4)
v_mfma_f32_16x16x32_bf16 v[68:71], v[44:47], a[152:155], v[68:71]
ds_read_b128 v[36:39], v10 offset:45056
v_mfma_f32_16x16x32_bf16 v[72:75], v[44:47], a[156:159], v[72:75]
v_mfma_f32_16x16x32_bf16 v[76:79], v[48:51], a[152:155], v[76:79]
ds_read_b128 v[40:43], v10 offset:47104
v_mfma_f32_16x16x32_bf16 v[80:83], v[48:51], a[156:159], v[80:83]
s_waitcnt lgkmcnt(4)
v_mfma_f32_16x16x32_bf16 v[68:71], v[20:23], a[160:163], v[68:71]
ds_read_b128 v[44:47], v11 offset:45056
v_mfma_f32_16x16x32_bf16 v[72:75], v[20:23], a[164:167], v[72:75]
v_mfma_f32_16x16x32_bf16 v[76:79], v[24:27], a[160:163], v[76:79]
ds_read_b128 v[48:51], v11 offset:47104
v_mfma_f32_16x16x32_bf16 v[80:83], v[24:27], a[164:167], v[80:83]
s_waitcnt lgkmcnt(4)
v_mfma_f32_16x16x32_bf16 v[68:71], v[28:31], a[168:171], v[68:71]
ds_read_b128 v[20:23], v10 offset:49152
v_mfma_f32_16x16x32_bf16 v[72:75], v[28:31], a[172:175], v[72:75]
s_waitcnt vmcnt(16)
v_mov_b32 v17, s42
s_mov_b64 exec, 1
buffer_store_dword v17, v16, s[84:87], s49 offen sc1
s_mov_b64 exec, -1
v_mfma_f32_16x16x32_bf16 v[76:79], v[32:35], a[168:171], v[76:79]
ds_read_b128 v[24:27], v10 offset:51200
v_mfma_f32_16x16x32_bf16 v[80:83], v[32:35], a[172:175], v[80:83]
s_waitcnt lgkmcnt(4)
v_mfma_f32_16x16x32_bf16 v[68:71], v[36:39], a[176:179], v[68:71]
ds_read_b128 v[28:31], v11 offset:49152
v_mfma_f32_16x16x32_bf16 v[72:75], v[36:39], a[180:183], v[72:75]
s_add_u32 s53, s42, 3
s_min_u32 s53, s53, 63
s_lshl_b32 s53, s53, 16
s_mov_b64 exec, 0xffff
buffer_load_dword v250, v19, s[8:11], s53 offen
s_mov_b64 exec, -1
v_mfma_f32_16x16x32_bf16 v[76:79], v[40:43], a[176:179], v[76:79]
ds_read_b128 v[32:35], v11 offset:51200
v_mfma_f32_16x16x32_bf16 v[80:83], v[40:43], a[180:183], v[80:83]
s_waitcnt lgkmcnt(4)
v_mfma_f32_16x16x32_bf16 v[68:71], v[44:47], a[184:187], v[68:71]
ds_read_b128 v[36:39], v10 offset:53248
v_mfma_f32_16x16x32_bf16 v[72:75], v[44:47], a[188:191], v[72:75]
v_mfma_f32_16x16x32_bf16 v[76:79], v[48:51], a[184:187], v[76:79]
ds_read_b128 v[40:43], v10 offset:55296
v_mfma_f32_16x16x32_bf16 v[80:83], v[48:51], a[188:191], v[80:83]
s_waitcnt lgkmcnt(4)
v_mfma_f32_16x16x32_bf16 v[68:71], v[20:23], a[192:195], v[68:71]
ds_read_b128 v[44:47], v11 offset:53248
v_mfma_f32_16x16x32_bf16 v[72:75], v[20:23], a[196:199], v[72:75]
v_mfma_f32_16x16x32_bf16 v[76:79], v[24:27], a[192:195], v[76:79]
ds_read_b128 v[48:51], v11 offset:55296
v_mfma_f32_16x16x32_bf16 v[80:83], v[24:27], a[196:199], v[80:83]
s_waitcnt lgkmcnt(4)
v_mfma_f32_16x16x32_bf16 v[68:71], v[28:31], a[200:203], v[68:71]
ds_read_b128 v[20:23], v10 offset:57344
v_mfma_f32_16x16x32_bf16 v[72:75], v[28:31], a[204:207], v[72:75]
v_mfma_f32_16x16x32_bf16 v[76:79], v[32:35], a[200:203], v[76:79]
ds_read_b128 v[24:27], v10 offset:59392
v_mfma_f32_16x16x32_bf16 v[80:83], v[32:35], a[204:207], v[80:83]
s_waitcnt lgkmcnt(4)
v_mfma_f32_16x16x32_bf16 v[68:71], v[36:39], a[208:211], v[68:71]
ds_read_b128 v[28:31], v11 offset:57344
v_mfma_f32_16x16x32_bf16 v[72:75], v[36:39], a[212:215], v[72:75]
v_mfma_f32_16x16x32_bf16 v[76:79], v[40:43], a[208:211], v[76:79]
ds_read_b128 v[32:35], v11 offset:59392
v_mfma_f32_16x16x32_bf16 v[80:83], v[40:43], a[212:215], v[80:83]
s_waitcnt lgkmcnt(4)
v_mfma_f32_16x16x32_bf16 v[68:71], v[44:47], a[216:219], v[68:71]
ds_read_b128 v[36:39], v10 offset:61440
v_mfma_f32_16x16x32_bf16 v[72:75], v[44:47], a[220:223], v[72:75]
v_mfma_f32_16x16x32_bf16 v[76:79], v[48:51], a[216:219], v[76:79]
ds_read_b128 v[40:43], v10 offset:63488
v_mfma_f32_16x16x32_bf16 v[80:83], v[48:51], a[220:223], v[80:83]
s_waitcnt lgkmcnt(4)
v_mfma_f32_16x16x32_bf16 v[68:71], v[20:23], a[224:227], v[68:71]
ds_read_b128 v[44:47], v11 offset:61440
v_mfma_f32_16x16x32_bf16 v[72:75], v[20:23], a[228:231], v[72:75]
v_mfma_f32_16x16x32_bf16 v[76:79], v[24:27], a[224:227], v[76:79]
ds_read_b128 v[48:51], v11 offset:63488
v_mfma_f32_16x16x32_bf16 v[80:83], v[24:27], a[228:231], v[80:83]
s_waitcnt lgkmcnt(5)
v_mfma_f32_16x16x32_bf16 v[68:71], v[28:31], a[232:235], v[68:71]
v_mfma_f32_16x16x32_bf16 v[72:75], v[28:31], a[236:239], v[72:75]
s_waitcnt lgkmcnt(4)
v_mfma_f32_16x16x32_bf16 v[76:79], v[32:35], a[232:235], v[76:79]
v_mfma_f32_16x16x32_bf16 v[80:83], v[32:35], a[236:239], v[80:83]
s_waitcnt lgkmcnt(3)
v_mfma_f32_16x16x32_bf16 v[68:71], v[36:39], a[240:243], v[68:71]
v_mfma_f32_16x16x32_bf16 v[72:75], v[36:39], a[244:247], v[72:75]
s_waitcnt lgkmcnt(2)
v_mfma_f32_16x16x32_bf16 v[76:79], v[40:43], a[240:243], v[76:79]
v_mfma_f32_16x16x32_bf16 v[80:83], v[40:43], a[244:247], v[80:83]
s_waitcnt lgkmcnt(1)
v_mfma_f32_16x16x32_bf16 v[68:71], v[44:47], a[248:251], v[68:71]
v_mfma_f32_16x16x32_bf16 v[72:75], v[44:47], a[252:255], v[72:75]
s_waitcnt lgkmcnt(0)
v_mfma_f32_16x16x32_bf16 v[76:79], v[48:51], a[248:251], v[76:79]
v_mfma_f32_16x16x32_bf16 v[80:83], v[48:51], a[252:255], v[80:83]
s_add_u32 s42, s42, 1
s_cmp_eq_u32 s42, 64
s_cbranch_scc1 mega_kernel_v_fin
s_waitcnt vmcnt(2)
s_barrier
s_add_u32 s50, s42, 1
s_min_u32 s50, s50, 63
s_lshl_b32 s50, s50, 16
ds_read_b128 v[20:23], v8 offset:0
ds_read_b128 v[24:27], v8 offset:2048
ds_read_b128 v[28:31], v9 offset:0
ds_read_b128 v[32:35], v9 offset:2048
ds_read_b128 v[36:39], v8 offset:4096
ds_read_b128 v[40:43], v8 offset:6144
s_waitcnt lgkmcnt(4)
v_mfma_f32_16x16x32_bf16 v[52:55], v[20:23], a[0:3], 0
ds_read_b128 v[44:47], v9 offset:4096
v_mfma_f32_16x16x32_bf16 v[56:59], v[20:23], a[4:7], 0
v_cvt_pk_bf16_f32 v84, v68, v69
v_cvt_pk_bf16_f32 v85, v70, v71
v_cvt_pk_bf16_f32 v86, v76, v77
v_mfma_f32_16x16x32_bf16 v[60:63], v[24:27], a[0:3], 0
ds_read_b128 v[48:51], v9 offset:6144
v_mfma_f32_16x16x32_bf16 v[64:67], v[24:27], a[4:7], 0
v_cvt_pk_bf16_f32 v87, v78, v79
v_cvt_pk_bf16_f32 v88, v72, v73
v_cvt_pk_bf16_f32 v89, v74, v75
s_waitcnt lgkmcnt(4)
v_mfma_f32_16x16x32_bf16 v[52:55], v[28:31], a[8:11], v[52:55]
ds_read_b128 v[20:23], v8 offset:8192
v_mfma_f32_16x16x32_bf16 v[56:59], v[28:31], a[12:15], v[56:59]
v_cvt_pk_bf16_f32 v90, v80, v81
v_cvt_pk_bf16_f32 v91, v82, v83
v_mfma_f32_16x16x32_bf16 v[60:63], v[32:35], a[8:11], v[60:63]
ds_read_b128 v[24:27], v8 offset:10240
v_mfma_f32_16x16x32_bf16 v[64:67], v[32:35], a[12:15], v[64:67]
s_add_u32 s51, s42, s47
s_sub_u32 s51, s51, 1
s_bfe_u32 s52, s51, 0x40002
s_lshl_b32 s52, s52, 14
s_waitcnt lgkmcnt(4)
v_mfma_f32_16x16x32_bf16 v[52:55], v[36:39], a[16:19], v[52:55]
ds_read_b128 v[28:31], v9 offset:8192
v_mfma_f32_16x16x32_bf16 v[56:59], v[36:39], a[20:23], v[56:59]
s_and_b32 s51, s51, 3
s_lshl_b32 s51, s51, 11
s_add_u32 s51, s51, s52
s_add_u32 s51, s51, s48
buffer_store_dwordx4 v[84:87], v7, s[84:87], s51 offen sc1
v_mfma_f32_16x16x32_bf16 v[60:63], v[40:43], a[16:19], v[60:63]
ds_read_b128 v[32:35], v9 offset:10240
v_mfma_f32_16x16x32_bf16 v[64:67], v[40:43], a[20:23], v[64:67]
buffer_store_dwordx4 v[88:91], v7, s[84:87], s51 offen offset:1024 sc1
s_waitcnt lgkmcnt(4)
v_mfma_f32_16x16x32_bf16 v[52:55], v[44:47], a[24:27], v[52:55]
ds_read_b128 v[36:39], v8 offset:12288
v_mfma_f32_16x16x32_bf16 v[56:59], v[44:47], a[28:31], v[56:59]
s_add_u32 m0, s46, 65536
v_mfma_f32_16x16x32_bf16 v[60:63], v[48:51], a[24:27], v[60:63]
ds_read_b128 v[40:43], v8 offset:14336
v_mfma_f32_16x16x32_bf16 v[64:67], v[48:51], a[28:31], v[64:67]
buffer_load_dwordx4 v6, s[8:11], s50 offen offset:0 lds
s_waitcnt lgkmcnt(4)
v_mfma_f32_16x16x32_bf16 v[52:55], v[20:23], a[32:35], v[52:55]
ds_read_b128 v[44:47], v9 offset:12288
v_mfma_f32_16x16x32_bf16 v[56:59], v[20:23], a[36:39], v[56:59]
s_add_u32 m0, s46, 69504
v_mfma_f32_16x16x32_bf16 v[60:63], v[24:27], a[32:35], v[60:63]
ds_read_b128 v[48:51], v9 offset:14336
v_mfma_f32_16x16x32_bf16 v[64:67], v[24:27], a[36:39], v[64:67]
buffer_load_dwordx4 v6, s[8:11], s50 offen offset:128 lds
s_waitcnt lgkmcnt(4)
v_mfma_f32_16x16x32_bf16 v[52:55], v[28:31], a[40:43], v[52:55]
ds_read_b128 v[20:23], v8 offset:16384
v_mfma_f32_16x16x32_bf16 v[56:59], v[28:31], a[44:47], v[56:59]
s_add_u32 m0, s46, 73472
v_mfma_f32_16x16x32_bf16 v[60:63], v[32:35], a[40:43], v[60:63]
ds_read_b128 v[24:27], v8 offset:18432
v_mfma_f32_16x16x32_bf16 v[64:67], v[32:35], a[44:47], v[64:67]
buffer_load_dwordx4 v6, s[8:11], s50 offen offset:256 lds
s_waitcnt lgkmcnt(4)
v_mfma_f32_16x16x32_bf16 v[52:55], v[36:39], a[48:51], v[52:55]
ds_read_b128 v[28:31], v9 offset:16384
v_mfma_f32_16x16x32_bf16 v[56:59], v[36:39], a[52:55], v[56:59]
s_add_u32 m0, s46, 77440
v_mfma_f32_16x16x32_bf16 v[60:63], v[40:43], a[48:51], v[60:63]
ds_read_b128 v[32:35], v9 offset:18432
v_mfma_f32_16x16x32_bf16 v[64:67], v[40:43], a[52:55], v[64:67]
buffer_load_dwordx4 v6, s[8:11], s50 offen offset:384 lds
s_waitcnt lgkmcnt(4)
v_mfma_f32_16x16x32_bf16 v[52:55], v[44:47], a[56:59], v[52:55]
ds_read_b128 v[36:39], v8 offset:20480
v_mfma_f32_16x16x32_bf16 v[56:59], v[44:47], a[60:63], v[56:59]
s_add_u32 m0, s46, 81408
v_mfma_f32_16x16x32_bf16 v[60:63], v[48:51], a[56:59], v[60:63]
ds_read_b128 v[40:43], v8 offset:22528
v_mfma_f32_16x16x32_bf16 v[64:67], v[48:51], a[60:63], v[64:67]
buffer_load_dwordx4 v6, s[8:11], s50 offen offset:512 lds
s_waitcnt lgkmcnt(4)
v_mfma_f32_16x16x32_bf16 v[52:55], v[20:23], a[64:67], v[52:55]
ds_read_b128 v[44:47], v9 offset:20480
v_mfma_f32_16x16x32_bf16 v[56:59], v[20:23], a[68:71], v[56:59]
s_add_u32 m0, s46, 85376
v_mfma_f32_16x16x32_bf16 v[60:63], v[24:27], a[64:67], v[60:63]
ds_read_b128 v[48:51], v9 offset:22528
v_mfma_f32_16x16x32_bf16 v[64:67], v[24:27], a[68:71], v[64:67]
buffer_load_dwordx4 v6, s[8:11], s50 offen offset:640 lds
s_waitcnt lgkmcnt(4)
v_mfma_f32_16x16x32_bf16 v[52:55], v[28:31], a[72:75], v[52:55]
ds_read_b128 v[20:23], v8 offset:24576
v_mfma_f32_16x16x32_bf16 v[56:59], v[28:31], a[76:79], v[56:59]
s_add_u32 m0, s46, 89344
v_mfma_f32_16x16x32_bf16 v[60:63], v[32:35], a[72:75], v[60:63]
ds_read_b128 v[24:27], v8 offset:26624
v_mfma_f32_16x16x32_bf16 v[64:67], v[32:35], a[76:79], v[64:67]
buffer_load_dwordx4 v6, s[8:11], s50 offen offset:768 lds
s_waitcnt lgkmcnt(4)
v_mfma_f32_16x16x32_bf16 v[52:55], v[36:39], a[80:83], v[52:55]
ds_read_b128 v[28:31], v9 offset:24576
v_mfma_f32_16x16x32_bf16 v[56:59], v[36:39], a[84:87], v[56:59]
s_add_u32 m0, s46, 93312
v_mfma_f32_16x16x32_bf16 v[60:63], v[40:43], a[80:83], v[60:63]
ds_read_b128 v[32:35], v9 offset:26624
v_mfma_f32_16x16x32_bf16 v[64:67], v[40:43], a[84:87], v[64:67]
buffer_load_dwordx4 v6, s[8:11], s50 offen offset:896 lds
s_waitcnt lgkmcnt(4)
v_mfma_f32_16x16x32_bf16 v[52:55], v[44:47], a[88:91], v[52:55]
ds_read_b128 v[36:39], v8 offset:28672
v_mfma_f32_16x16x32_bf16 v[56:59], v[44:47], a[92:95], v[56:59]
s_add_u32 m0, s46, 97280
v_mfma_f32_16x16x32_bf16 v[60:63], v[48:51], a[88:91], v[60:63]
ds_read_b128 v[40:43], v8 offset:30720
v_mfma_f32_16x16x32_bf16 v[64:67], v[48:51], a[92:95], v[64:67]
buffer_load_dwordx4 v6, s[8:11], s50 offen offset:1024 lds
s_waitcnt lgkmcnt(4)
v_mfma_f32_16x16x32_bf16 v[52:55], v[20:23], a[96:99], v[52:55]
ds_read_b128 v[44:47], v9 offset:28672
v_mfma_f32_16x16x32_bf16 v[56:59], v[20:23], a[100:103], v[56:59]
s_add_u32 m0, s46, 101248
v_mfma_f32_16x16x32_bf16 v[60:63], v[24:27], a[96:99], v[60:63]
ds_read_b128 v[48:51], v9 offset:30720
v_mfma_f32_16x16x32_bf16 v[64:67], v[24:27], a[100:103], v[64:67]
buffer_load_dwordx4 v6, s[8:11], s50 offen offset:1152 lds
s_waitcnt lgkmcnt(4)
v_mfma_f32_16x16x32_bf16 v[52:55], v[28:31], a[104:107], v[52:55]
ds_read_b128 v[20:23], v8 offset:32768
v_mfma_f32_16x16x32_bf16 v[56:59], v[28:31], a[108:111], v[56:59]
s_add_u32 m0, s46, 105216
v_mfma_f32_16x16x32_bf16 v[60:63], v[32:35], a[104:107], v[60:63]
ds_read_b128 v[24:27], v8 offset:34816
v_mfma_f32_16x16x32_bf16 v[64:67], v[32:35], a[108:111], v[64:67]
buffer_load_dwordx4 v6, s[8:11], s50 offen offset:1280 lds
s_waitcnt lgkmcnt(4)
v_mfma_f32_16x16x32_bf16 v[52:55], v[36:39], a[112:115], v[52:55]
ds_read_b128 v[28:31], v9 offset:32768
v_mfma_f32_16x16x32_bf16 v[56:59], v[36:39], a[116:119], v[56:59]
s_add_u32 m0, s46, 109184
v_mfma_f32_16x16x32_bf16 v[60:63], v[40:43], a[112:115], v[60:63]
ds_read_b128 v[32:35], v9 offset:34816
v_mfma_f32_16x16x32_bf16 v[64:67], v[40:43], a[116:119], v[64:67]
buffer_load_dwordx4 v6, s[8:11], s50 offen offset:1408 lds
s_waitcnt lgkmcnt(4)
v_mfma_f32_16x16x32_bf16 v[52:55], v[44:47], a[120:123], v[52:55]
ds_read_b128 v[36:39], v8 offset:36864
v_mfma_f32_16x16x32_bf16 v[56:59], v[44:47], a[124:127], v[56:59]
s_add_u32 m0, s46, 113152
v_mfma_f32_16x16x32_bf16 v[60:63], v[48:51], a[120:123], v[60:63]
ds_read_b128 v[40:43], v8 offset:38912
v_mfma_f32_16x16x32_bf16 v[64:67], v[48:51], a[124:127], v[64:67]
buffer_load_dwordx4 v6, s[8:11], s50 offen offset:1536 lds
s_waitcnt lgkmcnt(4)
v_mfma_f32_16x16x32_bf16 v[52:55], v[20:23], a[128:131], v[52:55]
ds_read_b128 v[44:47], v9 offset:36864
v_mfma_f32_16x16x32_bf16 v[56:59], v[20:23], a[132:135], v[56:59]
s_add_u32 m0, s46, 117120
v_mfma_f32_16x16x32_bf16 v[60:63], v[24:27], a[128:131], v[60:63]
ds_read_b128 v[48:51], v9 offset:38912
v_mfma_f32_16x16x32_bf16 v[64:67], v[24:27], a[132:135], v[64:67]
buffer_load_dwordx4 v6, s[8:11], s50 offen offset:1664 lds
s_waitcnt lgkmcnt(4)
v_mfma_f32_16x16x32_bf16 v[52:55], v[28:31], a[136:139], v[52:55]
ds_read_b128 v[20:23], v8 offset:40960
v_mfma_f32_16x16x32_bf16 v[56:59], v[28:31], a[140:143], v[56:59]
s_add_u32 m0, s46, 121088
v_mfma_f32_16x16x32_bf16 v[60:63], v[32:35], a[136:139], v[60:63]
ds_read_b128 v[24:27], v8 offset:43008
v_mfma_f32_16x16x32_bf16 v[64:67], v[32:35], a[140:143], v[64:67]
buffer_load_dwordx4 v6, s[8:11], s50 offen offset:1792 lds
s_waitcnt lgkmcnt(4)
v_mfma_f32_16x16x32_bf16 v[52:55], v[36:39], a[144:147], v[52:55]
ds_read_b128 v[28:31], v9 offset:40960
v_mfma_f32_16x16x32_bf16 v[56:59], v[36:39], a[148:151], v[56:59]
s_add_u32 m0, s46, 125056
v_mfma_f32_16x16x32_bf16 v[60:63], v[40:43], a[144:147], v[60:63]
ds_read_b128 v[32:35], v9 offset:43008
v_mfma_f32_16x16x32_bf16 v[64:67], v[40:43], a[148:151], v[64:67]
buffer_load_dwordx4 v6, s[8:11], s50 offen offset:1920 lds
s_waitcnt lgkmcnt(4)
v_mfma_f32_16x16x32_bf16 v[52:55], v[44:47], a[152:155], v[52:55]
ds_read_b128 v[36:39], v8 offset:45056
v_mfma_f32_16x16x32_bf16 v[56:59], v[44:47], a[156:159], v[56:59]
v_mfma_f32_16x16x32_bf16 v[60:63], v[48:51], a[152:155], v[60:63]
ds_read_b128 v[40:43], v8 offset:47104
v_mfma_f32_16x16x32_bf16 v[64:67], v[48:51], a[156:159], v[64:67]
s_waitcnt lgkmcnt(4)
v_mfma_f32_16x16x32_bf16 v[52:55], v[20:23], a[160:163], v[52:55]
ds_read_b128 v[44:47], v9 offset:45056
v_mfma_f32_16x16x32_bf16 v[56:59], v[20:23], a[164:167], v[56:59]
v_mfma_f32_16x16x32_bf16 v[60:63], v[24:27], a[160:163], v[60:63]
ds_read_b128 v[48:51], v9 offset:47104
v_mfma_f32_16x16x32_bf16 v[64:67], v[24:27], a[164:167], v[64:67]
s_waitcnt lgkmcnt(4)
v_mfma_f32_16x16x32_bf16 v[52:55], v[28:31], a[168:171], v[52:55]
ds_read_b128 v[20:23], v8 offset:49152
v_mfma_f32_16x16x32_bf16 v[56:59], v[28:31], a[172:175], v[56:59]
s_waitcnt vmcnt(16)
v_mov_b32 v17, s42
s_mov_b64 exec, 1
buffer_store_dword v17, v16, s[84:87], s49 offen sc1
s_mov_b64 exec, -1
v_mfma_f32_16x16x32_bf16 v[60:63], v[32:35], a[168:171], v[60:63]
ds_read_b128 v[24:27], v8 offset:51200
v_mfma_f32_16x16x32_bf16 v[64:67], v[32:35], a[172:175], v[64:67]
s_waitcnt lgkmcnt(4)
v_mfma_f32_16x16x32_bf16 v[52:55], v[36:39], a[176:179], v[52:55]
ds_read_b128 v[28:31], v9 offset:49152
v_mfma_f32_16x16x32_bf16 v[56:59], v[36:39], a[180:183], v[56:59]
s_add_u32 s53, s42, 3
s_min_u32 s53, s53, 63
s_lshl_b32 s53, s53, 16
s_mov_b64 exec, 0xffff
buffer_load_dword v250, v19, s[8:11], s53 offen
s_mov_b64 exec, -1
v_mfma_f32_16x16x32_bf16 v[60:63], v[40:43], a[176:179], v[60:63]
ds_read_b128 v[32:35], v9 offset:51200
v_mfma_f32_16x16x32_bf16 v[64:67], v[40:43], a[180:183], v[64:67]
s_waitcnt lgkmcnt(4)
v_mfma_f32_16x16x32_bf16 v[52:55], v[44:47], a[184:187], v[52:55]
ds_read_b128 v[36:39], v8 offset:53248
v_mfma_f32_16x16x32_bf16 v[56:59], v[44:47], a[188:191], v[56:59]
v_mfma_f32_16x16x32_bf16 v[60:63], v[48:51], a[184:187], v[60:63]
ds_read_b128 v[40:43], v8 offset:55296
v_mfma_f32_16x16x32_bf16 v[64:67], v[48:51], a[188:191], v[64:67]
s_waitcnt lgkmcnt(4)
v_mfma_f32_16x16x32_bf16 v[52:55], v[20:23], a[192:195], v[52:55]
ds_read_b128 v[44:47], v9 offset:53248
v_mfma_f32_16x16x32_bf16 v[56:59], v[20:23], a[196:199], v[56:59]
v_mfma_f32_16x16x32_bf16 v[60:63], v[24:27], a[192:195], v[60:63]
ds_read_b128 v[48:51], v9 offset:55296
v_mfma_f32_16x16x32_bf16 v[64:67], v[24:27], a[196:199], v[64:67]
s_waitcnt lgkmcnt(4)
v_mfma_f32_16x16x32_bf16 v[52:55], v[28:31], a[200:203], v[52:55]
ds_read_b128 v[20:23], v8 offset:57344
v_mfma_f32_16x16x32_bf16 v[56:59], v[28:31], a[204:207], v[56:59]
v_mfma_f32_16x16x32_bf16 v[60:63], v[32:35], a[200:203], v[60:63]
ds_read_b128 v[24:27], v8 offset:59392
v_mfma_f32_16x16x32_bf16 v[64:67], v[32:35], a[204:207], v[64:67]
s_waitcnt lgkmcnt(4)
v_mfma_f32_16x16x32_bf16 v[52:55], v[36:39], a[208:211], v[52:55]
ds_read_b128 v[28:31], v9 offset:57344
v_mfma_f32_16x16x32_bf16 v[56:59], v[36:39], a[212:215], v[56:59]
v_mfma_f32_16x16x32_bf16 v[60:63], v[40:43], a[208:211], v[60:63]
ds_read_b128 v[32:35], v9 offset:59392
v_mfma_f32_16x16x32_bf16 v[64:67], v[40:43], a[212:215], v[64:67]
s_waitcnt lgkmcnt(4)
v_mfma_f32_16x16x32_bf16 v[52:55], v[44:47], a[216:219], v[52:55]
ds_read_b128 v[36:39], v8 offset:61440
v_mfma_f32_16x16x32_bf16 v[56:59], v[44:47], a[220:223], v[56:59]
v_mfma_f32_16x16x32_bf16 v[60:63], v[48:51], a[216:219], v[60:63]
ds_read_b128 v[40:43], v8 offset:63488
v_mfma_f32_16x16x32_bf16 v[64:67], v[48:51], a[220:223], v[64:67]
s_waitcnt lgkmcnt(4)
v_mfma_f32_16x16x32_bf16 v[52:55], v[20:23], a[224:227], v[52:55]
ds_read_b128 v[44:47], v9 offset:61440
v_mfma_f32_16x16x32_bf16 v[56:59], v[20:23], a[228:231], v[56:59]
v_mfma_f32_16x16x32_bf16 v[60:63], v[24:27], a[224:227], v[60:63]
ds_read_b128 v[48:51], v9 offset:63488
v_mfma_f32_16x16x32_bf16 v[64:67], v[24:27], a[228:231], v[64:67]
s_waitcnt lgkmcnt(5)
v_mfma_f32_16x16x32_bf16 v[52:55], v[28:31], a[232:235], v[52:55]
v_mfma_f32_16x16x32_bf16 v[56:59], v[28:31], a[236:239], v[56:59]
s_waitcnt lgkmcnt(4)
v_mfma_f32_16x16x32_bf16 v[60:63], v[32:35], a[232:235], v[60:63]
v_mfma_f32_16x16x32_bf16 v[64:67], v[32:35], a[236:239], v[64:67]
s_waitcnt lgkmcnt(3)
v_mfma_f32_16x16x32_bf16 v[52:55], v[36:39], a[240:243], v[52:55]
v_mfma_f32_16x16x32_bf16 v[56:59], v[36:39], a[244:247], v[56:59]
s_waitcnt lgkmcnt(2)
v_mfma_f32_16x16x32_bf16 v[60:63], v[40:43], a[240:243], v[60:63]
v_mfma_f32_16x16x32_bf16 v[64:67], v[40:43], a[244:247], v[64:67]
s_waitcnt lgkmcnt(1)
v_mfma_f32_16x16x32_bf16 v[52:55], v[44:47], a[248:251], v[52:55]
v_mfma_f32_16x16x32_bf16 v[56:59], v[44:47], a[252:255], v[56:59]
s_waitcnt lgkmcnt(0)
v_mfma_f32_16x16x32_bf16 v[60:63], v[48:51], a[248:251], v[60:63]
v_mfma_f32_16x16x32_bf16 v[64:67], v[48:51], a[252:255], v[64:67]
s_add_u32 s42, s42, 1
s_branch mega_kernel_v_loop
mega_kernel_v_fin:
s_nop 11
v_cvt_pk_bf16_f32 v84, v68, v69
v_cvt_pk_bf16_f32 v85, v70, v71
v_cvt_pk_bf16_f32 v86, v76, v77
v_cvt_pk_bf16_f32 v87, v78, v79
v_cvt_pk_bf16_f32 v88, v72, v73
v_cvt_pk_bf16_f32 v89, v74, v75
v_cvt_pk_bf16_f32 v90, v80, v81
v_cvt_pk_bf16_f32 v91, v82, v83
s_add_u32 s51, s42, s47
s_sub_u32 s51, s51, 1
s_bfe_u32 s52, s51, 0x40002
s_lshl_b32 s52, s52, 14
s_and_b32 s51, s51, 3
s_lshl_b32 s51, s51, 11
s_add_u32 s51, s51, s52
s_add_u32 s51, s51, s48
buffer_store_dwordx4 v[84:87], v7, s[84:87], s51 offen sc1
buffer_store_dwordx4 v[88:91], v7, s[84:87], s51 offen offset:1024 sc1
s_waitcnt vmcnt(0)
v_mov_b32 v17, s42
s_mov_b64 exec, 1
buffer_store_dword v17, v16, s[84:87], s49 offen sc1
s_mov_b64 exec, -1
s_waitcnt vmcnt(0)
s_barrier
mega_kernel_fft:
s_mov_b32 s38, s92
s_mov_b32 s39, 64
s_mov_b32 s37, 129
mega_kernel_f2s:
v_mov_b32 v1, 0
s_mov_b32 s82, 69259264
mega_kernel_w0:
s_sleep 8
buffer_load_dword v2, v1, s[84:87], s82 offen sc1
s_waitcnt vmcnt(0)
v_cmp_ne_u32 vcc, 31, v2
s_cbranch_vccnz mega_kernel_w0
s_mov_b32 s48, 0x3f7ec46d
s_mov_b32 s49, 0x3dc8bd36
s_mov_b32 s50, 0x3f7b14be
s_mov_b32 s51, 0x3e47c5c2
s_mov_b32 s52, 0x3f74fa0b
s_mov_b32 s53, 0x3e94a031
s_mov_b32 s54, 0x3f6c835e
s_mov_b32 s55, 0x3ec3ef15
s_mov_b32 s56, 0x3f61c598
s_mov_b32 s57, 0x3ef15aea
s_mov_b32 s58, 0x3f54db31
s_mov_b32 s59, 0x3f0e39da
s_mov_b32 s60, 0x3f45e403
s_mov_b32 s61, 0x3f226799
s_mov_b32 s62, 0x3f3504f3
s_mov_b32 s63, 0x3f3504f3
v_lshrrev_b32 v10, 6, v0
v_and_b32 v1, 63, v0
v_readfirstlane_b32 s16, v10
v_cvt_f32_u32 v2, v1
v_lshlrev_b32 v5, 3, v1
s_mul_i32 s17, s16, 16896
v_add_u32 v3, s17, v5
v_and_b32 v7, 1, v1
v_lshrrev_b32 v6, 1, v1
v_cvt_f32_u32 v8, v6
v_cvt_f32_u32 v10, v7
v_mul_u32_u24 v4, 528, v6
v_lshl_add_u32 v4, v7, 3, v4
v_add_u32 v4, s17, v4
v_lshlrev_b32 v11, 12, v7
v_lshl_add_u32 v11, v6, 2, v11
v_fma_f32 v9, v10, 2.0, -1.0
v_sub_f32 v7, 0, v9
v_mul_f32 v13, v10, v8
v_mul_f32 v13, 0x3a000000, v13
s_mov_b32 s18, 0xaaaaaaaa
s_mov_b32 s19, 0xaaaaaaaa
v_mul_f32 v12, 0xba000000, v2
v_cos_f32 v82, v12
v_sin_f32 v83, v12
v_mul_f32 v12, 0xba800000, v2
v_cos_f32 v84, v12
v_sin_f32 v85, v12
v_mul_f32 v12, 0xbac00000, v2
v_cos_f32 v86, v12
v_sin_f32 v87, v12
v_mul_f32 v12, 0xbb000000, v2
v_cos_f32 v88, v12
v_sin_f32 v89, v12
v_mul_f32 v12, 0xbb200000, v2
v_cos_f32 v90, v12
v_sin_f32 v91, v12
v_mul_f32 v12, 0xbb400000, v2
v_cos_f32 v92, v12
v_sin_f32 v93, v12
v_mul_f32 v12, 0xbb600000, v2
v_cos_f32 v94, v12
v_sin_f32 v95, v12
v_mul_f32 v12, 0xbb800000, v2
v_cos_f32 v96, v12
v_sin_f32 v97, v12
v_mul_f32 v12, 0xbb900000, v2
v_cos_f32 v98, v12
v_sin_f32 v99, v12
v_mul_f32 v12, 0xbba00000, v2
v_cos_f32 v100, v12
v_sin_f32 v101, v12
v_mul_f32 v12, 0xbbb00000, v2
v_cos_f32 v102, v12
v_sin_f32 v103, v12
v_mul_f32 v12, 0xbbc00000, v2
v_cos_f32 v104, v12
v_sin_f32 v105, v12
v_mul_f32 v12, 0xbbd00000, v2
v_cos_f32 v106, v12
v_sin_f32 v107, v12
v_mul_f32 v12, 0xbbe00000, v2
v_cos_f32 v108, v12
v_sin_f32 v109, v12
v_mul_f32 v12, 0xbbf00000, v2
v_cos_f32 v110, v12
v_sin_f32 v111, v12
v_mul_f32 v12, 0xbc000000, v2
v_cos_f32 v112, v12
v_sin_f32 v113, v12
v_mul_f32 v12, 0xbc080000, v2
v_cos_f32 v114, v12
v_sin_f32 v115, v12
v_mul_f32 v12, 0xbc100000, v2
v_cos_f32 v116, v12
v_sin_f32 v117, v12
v_mul_f32 v12, 0xbc180000, v2
v_cos_f32 v118, v12
v_sin_f32 v119, v12
v_mul_f32 v12, 0xbc200000, v2
v_cos_f32 v120, v12
v_sin_f32 v121, v12
v_mul_f32 v12, 0xbc280000, v2
v_cos_f32 v122, v12
v_sin_f32 v123, v12
v_mul_f32 v12, 0xbc300000, v2
v_cos_f32 v124, v12
v_sin_f32 v125, v12
v_mul_f32 v12, 0xbc380000, v2
v_cos_f32 v126, v12
v_sin_f32 v127, v12
v_mul_f32 v12, 0xbc400000, v2
v_cos_f32 v128, v12
v_sin_f32 v129, v12
v_mul_f32 v12, 0xbc480000, v2
v_cos_f32 v130, v12
v_sin_f32 v131, v12
v_mul_f32 v12, 0xbc500000, v2
v_cos_f32 v132, v12
v_sin_f32 v133, v12
v_mul_f32 v12, 0xbc580000, v2
v_cos_f32 v134, v12
v_sin_f32 v135, v12
v_mul_f32 v12, 0xbc600000, v2
v_cos_f32 v136, v12
v_sin_f32 v137, v12
v_mul_f32 v12, 0xbc680000, v2
v_cos_f32 v138, v12
v_sin_f32 v139, v12
v_mul_f32 v12, 0xbc700000, v2
v_cos_f32 v140, v12
v_sin_f32 v141, v12
v_mul_f32 v12, 0xbc780000, v2
v_cos_f32 v142, v12
v_sin_f32 v143, v12
v_mov_b32 v12, v13
v_fmac_f32 v12, 0x00000000, v8
v_cos_f32 v144, v12
v_sin_f32 v145, v12
v_mov_b32 v12, v13
v_fmac_f32 v12, 0x3a800000, v8
v_cos_f32 v146, v12
v_sin_f32 v147, v12
v_mov_b32 v12, v13
v_fmac_f32 v12, 0x3b000000, v8
v_cos_f32 v148, v12
v_sin_f32 v149, v12
v_mov_b32 v12, v13
v_fmac_f32 v12, 0x3b400000, v8
v_cos_f32 v150, v12
v_sin_f32 v151, v12
v_mov_b32 v12, v13
v_fmac_f32 v12, 0x3b800000, v8
v_cos_f32 v152, v12
v_sin_f32 v153, v12
v_mov_b32 v12, v13
v_fmac_f32 v12, 0x3ba00000, v8
v_cos_f32 v154, v12
v_sin_f32 v155, v12
v_mov_b32 v12, v13
v_fmac_f32 v12, 0x3bc00000, v8
v_cos_f32 v156, v12
v_sin_f32 v157, v12
v_mov_b32 v12, v13
v_fmac_f32 v12, 0x3be00000, v8
v_cos_f32 v158, v12
v_sin_f32 v159, v12
v_mov_b32 v12, v13
v_fmac_f32 v12, 0x3c000000, v8
v_cos_f32 v160, v12
v_sin_f32 v161, v12
v_mov_b32 v12, v13
v_fmac_f32 v12, 0x3c100000, v8
v_cos_f32 v162, v12
v_sin_f32 v163, v12
v_mov_b32 v12, v13
v_fmac_f32 v12, 0x3c200000, v8
v_cos_f32 v164, v12
v_sin_f32 v165, v12
v_mov_b32 v12, v13
v_fmac_f32 v12, 0x3c300000, v8
v_cos_f32 v166, v12
v_sin_f32 v167, v12
v_mov_b32 v12, v13
v_fmac_f32 v12, 0x3c400000, v8
v_cos_f32 v168, v12
v_sin_f32 v169, v12
v_mov_b32 v12, v13
v_fmac_f32 v12, 0x3c500000, v8
v_cos_f32 v170, v12
v_sin_f32 v171, v12
v_mov_b32 v12, v13
v_fmac_f32 v12, 0x3c600000, v8
v_cos_f32 v172, v12
v_sin_f32 v173, v12
v_mov_b32 v12, v13
v_fmac_f32 v12, 0x3c700000, v8
v_cos_f32 v174, v12
v_sin_f32 v175, v12
v_mov_b32 v12, v13
v_fmac_f32 v12, 0x3c800000, v8
v_cos_f32 v176, v12
v_sin_f32 v177, v12
v_mov_b32 v12, v13
v_fmac_f32 v12, 0x3c880000, v8
v_cos_f32 v178, v12
v_sin_f32 v179, v12
v_mov_b32 v12, v13
v_fmac_f32 v12, 0x3c900000, v8
v_cos_f32 v180, v12
v_sin_f32 v181, v12
v_mov_b32 v12, v13
v_fmac_f32 v12, 0x3c980000, v8
v_cos_f32 v182, v12
v_sin_f32 v183, v12
v_mov_b32 v12, v13
v_fmac_f32 v12, 0x3ca00000, v8
v_cos_f32 v184, v12
v_sin_f32 v185, v12
v_mov_b32 v12, v13
v_fmac_f32 v12, 0x3ca80000, v8
v_cos_f32 v186, v12
v_sin_f32 v187, v12
v_mov_b32 v12, v13
v_fmac_f32 v12, 0x3cb00000, v8
v_cos_f32 v188, v12
v_sin_f32 v189, v12
v_mov_b32 v12, v13
v_fmac_f32 v12, 0x3cb80000, v8
v_cos_f32 v190, v12
v_sin_f32 v191, v12
v_mov_b32 v12, v13
v_fmac_f32 v12, 0x3cc00000, v8
v_cos_f32 v192, v12
v_sin_f32 v193, v12
v_mov_b32 v12, v13
v_fmac_f32 v12, 0x3cc80000, v8
v_cos_f32 v194, v12
v_sin_f32 v195, v12
v_mov_b32 v12, v13
v_fmac_f32 v12, 0x3cd00000, v8
v_cos_f32 v196, v12
v_sin_f32 v197, v12
v_mov_b32 v12, v13
v_fmac_f32 v12, 0x3cd80000, v8
v_cos_f32 v198, v12
v_sin_f32 v199, v12
v_mov_b32 v12, v13
v_fmac_f32 v12, 0x3ce00000, v8
v_cos_f32 v200, v12
v_sin_f32 v201, v12
v_mov_b32 v12, v13
v_fmac_f32 v12, 0x3ce80000, v8
v_cos_f32 v202, v12
v_sin_f32 v203, v12
v_mov_b32 v12, v13
v_fmac_f32 v12, 0x3cf00000, v8
v_cos_f32 v204, v12
v_sin_f32 v205, v12
v_mov_b32 v12, v13
v_fmac_f32 v12, 0x3cf80000, v8
v_cos_f32 v206, v12
v_sin_f32 v207, v12
s_nop 0
v_mul_f32 v144, 0x34800000, v144
v_mul_f32 v145, 0x34800000, v145
v_mul_f32 v146, 0x34800000, v146
v_mul_f32 v147, 0x34800000, v147
v_mul_f32 v148, 0x34800000, v148
v_mul_f32 v149, 0x34800000, v149
v_mul_f32 v150, 0x34800000, v150
v_mul_f32 v151, 0x34800000, v151
v_mul_f32 v152, 0x34800000, v152
v_mul_f32 v153, 0x34800000, v153
v_mul_f32 v154, 0x34800000, v154
v_mul_f32 v155, 0x34800000, v155
v_mul_f32 v156, 0x34800000, v156
v_mul_f32 v157, 0x34800000, v157
v_mul_f32 v158, 0x34800000, v158
v_mul_f32 v159, 0x34800000, v159
v_mul_f32 v160, 0x34800000, v160
v_mul_f32 v161, 0x34800000, v161
v_mul_f32 v162, 0x34800000, v162
v_mul_f32 v163, 0x34800000, v163
v_mul_f32 v164, 0x34800000, v164
v_mul_f32 v165, 0x34800000, v165
v_mul_f32 v166, 0x34800000, v166
v_mul_f32 v167, 0x34800000, v167
v_mul_f32 v168, 0x34800000, v168
v_mul_f32 v169, 0x34800000, v169
v_mul_f32 v170, 0x34800000, v170
v_mul_f32 v171, 0x34800000, v171
v_mul_f32 v172, 0x34800000, v172
v_mul_f32 v173, 0x34800000, v173
v_mul_f32 v174, 0x34800000, v174
v_mul_f32 v175, 0x34800000, v175
v_mul_f32 v176, 0x34800000, v176
v_mul_f32 v177, 0x34800000, v177
v_mul_f32 v178, 0x34800000, v178
v_mul_f32 v179, 0x34800000, v179
v_mul_f32 v180, 0x34800000, v180
v_mul_f32 v181, 0x34800000, v181
v_mul_f32 v182, 0x34800000, v182
v_mul_f32 v183, 0x34800000, v183
v_mul_f32 v184, 0x34800000, v184
v_mul_f32 v185, 0x34800000, v185
v_mul_f32 v186, 0x34800000, v186
v_mul_f32 v187, 0x34800000, v187
v_mul_f32 v188, 0x34800000, v188
v_mul_f32 v189, 0x34800000, v189
v_mul_f32 v190, 0x34800000, v190
v_mul_f32 v191, 0x34800000, v191
v_mul_f32 v192, 0x34800000, v192
v_mul_f32 v193, 0x34800000, v193
v_mul_f32 v194, 0x34800000, v194
v_mul_f32 v195, 0x34800000, v195
v_mul_f32 v196, 0x34800000, v196
v_mul_f32 v197, 0x34800000, v197
v_mul_f32 v198, 0x34800000, v198
v_mul_f32 v199, 0x34800000, v199
v_mul_f32 v200, 0x34800000, v200
v_mul_f32 v201, 0x34800000, v201
v_mul_f32 v202, 0x34800000, v202
v_mul_f32 v203, 0x34800000, v203
v_mul_f32 v204, 0x34800000, v204
v_mul_f32 v205, 0x34800000, v205
v_mul_f32 v206, 0x34800000, v206
v_mul_f32 v207, 0x34800000, v207
s_cmp_lt_u32 s38, s37
s_cbranch_scc0 mega_kernel_f2_e
s_lshl_b32 s12, s38, 2
s_add_u32 s12, s12, s16
s_min_u32 s12, s12, 512
s_lshl_b32 s13, s12, 13
s_lshl_b32 s12, s12, 14
s_add_u32 s12, s12, 96468992
s_add_u32 s13, s13, 121634816
buffer_load_dwordx2 a[0:1], v5, s[84:87], s12 offen offset:0 sc1
buffer_load_dwordx2 a[2:3], v5, s[84:87], s12 offen offset:512 sc1
buffer_load_dwordx2 a[4:5], v5, s[84:87], s12 offen offset:1024 sc1
buffer_load_dwordx2 a[6:7], v5, s[84:87], s12 offen offset:1536 sc1
buffer_load_dwordx2 a[8:9], v5, s[84:87], s12 offen offset:2048 sc1
buffer_load_dwordx2 a[10:11], v5, s[84:87], s12 offen offset:2560 sc1
buffer_load_dwordx2 a[12:13], v5, s[84:87], s12 offen offset:3072 sc1
buffer_load_dwordx2 a[14:15], v5, s[84:87], s12 offen offset:3584 sc1
s_add_u32 s12, s12, 4096
buffer_load_dwordx2 a[16:17], v5, s[84:87], s12 offen offset:0 sc1
buffer_load_dwordx2 a[18:19], v5, s[84:87], s12 offen offset:512 sc1
buffer_load_dwordx2 a[20:21], v5, s[84:87], s12 offen offset:1024 sc1
buffer_load_dwordx2 a[22:23], v5, s[84:87], s12 offen offset:1536 sc1
buffer_load_dwordx2 a[24:25], v5, s[84:87], s12 offen offset:2048 sc1
buffer_load_dwordx2 a[26:27], v5, s[84:87], s12 offen offset:2560 sc1
buffer_load_dwordx2 a[28:29], v5, s[84:87], s12 offen offset:3072 sc1
buffer_load_dwordx2 a[30:31], v5, s[84:87], s12 offen offset:3584 sc1
s_add_u32 s12, s12, 4096
buffer_load_dwordx2 a[32:33], v5, s[84:87], s12 offen offset:0 sc1
buffer_load_dwordx2 a[34:35], v5, s[84:87], s12 offen offset:512 sc1
buffer_load_dwordx2 a[36:37], v5, s[84:87], s12 offen offset:1024 sc1
buffer_load_dwordx2 a[38:39], v5, s[84:87], s12 offen offset:1536 sc1
buffer_load_dwordx2 a[40:41], v5, s[84:87], s12 offen offset:2048 sc1
buffer_load_dwordx2 a[42:43], v5, s[84:87], s12 offen offset:2560 sc1
buffer_load_dwordx2 a[44:45], v5, s[84:87], s12 offen offset:3072 sc1
buffer_load_dwordx2 a[46:47], v5, s[84:87], s12 offen offset:3584 sc1
s_add_u32 s12, s12, 4096
buffer_load_dwordx2 a[48:49], v5, s[84:87], s12 offen offset:0 sc1
buffer_load_dwordx2 a[50:51], v5, s[84:87], s12 offen offset:512 sc1
buffer_load_dwordx2 a[52:53], v5, s[84:87], s12 offen offset:1024 sc1
buffer_load_dwordx2 a[54:55], v5, s[84:87], s12 offen offset:1536 sc1
buffer_load_dwordx2 a[56:57], v5, s[84:87], s12 offen offset:2048 sc1
buffer_load_dwordx2 a[58:59], v5, s[84:87], s12 offen offset:2560 sc1
buffer_load_dwordx2 a[60:61], v5, s[84:87], s12 offen offset:3072 sc1
buffer_load_dwordx2 a[62:63], v5, s[84:87], s12 offen offset:3584 sc1
s_add_u32 s12, s12, 4096
buffer_load_dword a64, v11, s[84:87], s13 offen offset:0 sc1
buffer_load_dword a65, v11, s[84:87], s13 offen offset:128 sc1
buffer_load_dword a66, v11, s[84:87], s13 offen offset:256 sc1
buffer_load_dword a67, v11, s[84:87], s13 offen offset:384 sc1
buffer_load_dword a68, v11, s[84:87], s13 offen offset:512 sc1
buffer_load_dword a69, v11, s[84:87], s13 offen offset:640 sc1
buffer_load_dword a70, v11, s[84:87], s13 offen offset:768 sc1
buffer_load_dword a71, v11, s[84:87], s13 offen offset:896 sc1
buffer_load_dword a72, v11, s[84:87], s13 offen offset:1024 sc1
buffer_load_dword a73, v11, s[84:87], s13 offen offset:1152 sc1
buffer_load_dword a74, v11, s[84:87], s13 offen offset:1280 sc1
buffer_load_dword a75, v11, s[84:87], s13 offen offset:1408 sc1
buffer_load_dword a76, v11, s[84:87], s13 offen offset:1536 sc1
buffer_load_dword a77, v11, s[84:87], s13 offen offset:1664 sc1
buffer_load_dword a78, v11, s[84:87], s13 offen offset:1792 sc1
buffer_load_dword a79, v11, s[84:87], s13 offen offset:1920 sc1
buffer_load_dword a80, v11, s[84:87], s13 offen offset:2048 sc1
buffer_load_dword a81, v11, s[84:87], s13 offen offset:2176 sc1
buffer_load_dword a82, v11, s[84:87], s13 offen offset:2304 sc1
buffer_load_dword a83, v11, s[84:87], s13 offen offset:2432 sc1
buffer_load_dword a84, v11, s[84:87], s13 offen offset:2560 sc1
buffer_load_dword a85, v11, s[84:87], s13 offen offset:2688 sc1
buffer_load_dword a86, v11, s[84:87], s13 offen offset:2816 sc1
buffer_load_dword a87, v11, s[84:87], s13 offen offset:2944 sc1
buffer_load_dword a88, v11, s[84:87], s13 offen offset:3072 sc1
buffer_load_dword a89, v11, s[84:87], s13 offen offset:3200 sc1
buffer_load_dword a90, v11, s[84:87], s13 offen offset:3328 sc1
buffer_load_dword a91, v11, s[84:87], s13 offen offset:3456 sc1
buffer_load_dword a92, v11, s[84:87], s13 offen offset:3584 sc1
buffer_load_dword a93, v11, s[84:87], s13 offen offset:3712 sc1
buffer_load_dword a94, v11, s[84:87], s13 offen offset:3840 sc1
buffer_load_dword a95, v11, s[84:87], s13 offen offset:3968 sc1
s_waitcnt vmcnt(0)
mega_kernel_f2_l:
s_add_u32 s21, s38, s39
s_cmp_lt_u32 s21, s37
s_cselect_b32 s22, s21, s38
s_waitcnt vmcnt(32)
v_accvgpr_read_b32 v16, a0
v_accvgpr_read_b32 v17, a1
v_accvgpr_read_b32 v18, a2
v_accvgpr_read_b32 v19, a3
v_accvgpr_read_b32 v20, a4
v_accvgpr_read_b32 v21, a5
v_accvgpr_read_b32 v22, a6
v_accvgpr_read_b32 v23, a7
v_accvgpr_read_b32 v24, a8
v_accvgpr_read_b32 v25, a9
v_accvgpr_read_b32 v26, a10
v_accvgpr_read_b32 v27, a11
v_accvgpr_read_b32 v28, a12
v_accvgpr_read_b32 v29, a13
v_accvgpr_read_b32 v30, a14
v_accvgpr_read_b32 v31, a15
v_accvgpr_read_b32 v32, a16
v_accvgpr_read_b32 v33, a17
v_accvgpr_read_b32 v34, a18
v_accvgpr_read_b32 v35, a19
v_accvgpr_read_b32 v36, a20
v_accvgpr_read_b32 v37, a21
v_accvgpr_read_b32 v38, a22
v_accvgpr_read_b32 v39, a23
v_accvgpr_read_b32 v40, a24
v_accvgpr_read_b32 v41, a25
v_accvgpr_read_b32 v42, a26
v_accvgpr_read_b32 v43, a27
v_accvgpr_read_b32 v44, a28
v_accvgpr_read_b32 v45, a29
v_accvgpr_read_b32 v46, a30
v_accvgpr_read_b32 v47, a31
v_accvgpr_read_b32 v48, a32
v_accvgpr_read_b32 v49, a33
v_accvgpr_read_b32 v50, a34
v_accvgpr_read_b32 v51, a35
v_accvgpr_read_b32 v52, a36
v_accvgpr_read_b32 v53, a37
v_accvgpr_read_b32 v54, a38
v_accvgpr_read_b32 v55, a39
v_accvgpr_read_b32 v56, a40
v_accvgpr_read_b32 v57, a41
v_accvgpr_read_b32 v58, a42
v_accvgpr_read_b32 v59, a43
v_accvgpr_read_b32 v60, a44
v_accvgpr_read_b32 v61, a45
v_accvgpr_read_b32 v62, a46
v_accvgpr_read_b32 v63, a47
v_accvgpr_read_b32 v64, a48
v_accvgpr_read_b32 v65, a49
v_accvgpr_read_b32 v66, a50
v_accvgpr_read_b32 v67, a51
v_accvgpr_read_b32 v68, a52
v_accvgpr_read_b32 v69, a53
v_accvgpr_read_b32 v70, a54
v_accvgpr_read_b32 v71, a55
v_accvgpr_read_b32 v72, a56
v_accvgpr_read_b32 v73, a57
v_accvgpr_read_b32 v74, a58
v_accvgpr_read_b32 v75, a59
v_accvgpr_read_b32 v76, a60
v_accvgpr_read_b32 v77, a61
v_accvgpr_read_b32 v78, a62
v_accvgpr_read_b32 v79, a63
v_accvgpr_read_b32 v208, a64
v_accvgpr_read_b32 v209, a65
v_accvgpr_read_b32 v210, a66
v_accvgpr_read_b32 v211, a67
v_accvgpr_read_b32 v212, a68
v_accvgpr_read_b32 v213, a69
v_accvgpr_read_b32 v214, a70
v_accvgpr_read_b32 v215, a71
v_accvgpr_read_b32 v216, a72
v_accvgpr_read_b32 v217, a73
v_accvgpr_read_b32 v218, a74
v_accvgpr_read_b32 v219, a75
v_accvgpr_read_b32 v220, a76
v_accvgpr_read_b32 v221, a77
v_accvgpr_read_b32 v222, a78
v_accvgpr_read_b32 v223, a79
v_accvgpr_read_b32 v224, a80
v_accvgpr_read_b32 v225, a81
v_accvgpr_read_b32 v226, a82
v_accvgpr_read_b32 v227, a83
v_accvgpr_read_b32 v228, a84
v_accvgpr_read_b32 v229, a85
v_accvgpr_read_b32 v230, a86
v_accvgpr_read_b32 v231, a87
v_accvgpr_read_b32 v232, a88
v_accvgpr_read_b32 v233, a89
v_accvgpr_read_b32 v234, a90
v_accvgpr_read_b32 v235, a91
v_accvgpr_read_b32 v236, a92
v_accvgpr_read_b32 v237, a93
v_accvgpr_read_b32 v238, a94
v_accvgpr_read_b32 v239, a95
s_lshl_b32 s12, s22, 2
s_add_u32 s12, s12, s16
s_min_u32 s12, s12, 512
s_lshl_b32 s13, s12, 13
s_lshl_b32 s12, s12, 14
s_add_u32 s12, s12, 96468992
s_add_u32 s13, s13, 121634816
buffer_load_dwordx2 a[0:1], v5, s[84:87], s12 offen offset:0 sc1
buffer_load_dwordx2 a[2:3], v5, s[84:87], s12 offen offset:512 sc1
buffer_load_dwordx2 a[4:5], v5, s[84:87], s12 offen offset:1024 sc1
buffer_load_dwordx2 a[6:7], v5, s[84:87], s12 offen offset:1536 sc1
buffer_load_dwordx2 a[8:9], v5, s[84:87], s12 offen offset:2048 sc1
buffer_load_dwordx2 a[10:11], v5, s[84:87], s12 offen offset:2560 sc1
buffer_load_dwordx2 a[12:13], v5, s[84:87], s12 offen offset:3072 sc1
buffer_load_dwordx2 a[14:15], v5, s[84:87], s12 offen offset:3584 sc1
s_add_u32 s12, s12, 4096
buffer_load_dwordx2 a[16:17], v5, s[84:87], s12 offen offset:0 sc1
buffer_load_dwordx2 a[18:19], v5, s[84:87], s12 offen offset:512 sc1
buffer_load_dwordx2 a[20:21], v5, s[84:87], s12 offen offset:1024 sc1
buffer_load_dwordx2 a[22:23], v5, s[84:87], s12 offen offset:1536 sc1
buffer_load_dwordx2 a[24:25], v5, s[84:87], s12 offen offset:2048 sc1
buffer_load_dwordx2 a[26:27], v5, s[84:87], s12 offen offset:2560 sc1
buffer_load_dwordx2 a[28:29], v5, s[84:87], s12 offen offset:3072 sc1
buffer_load_dwordx2 a[30:31], v5, s[84:87], s12 offen offset:3584 sc1
s_add_u32 s12, s12, 4096
buffer_load_dwordx2 a[32:33], v5, s[84:87], s12 offen offset:0 sc1
buffer_load_dwordx2 a[34:35], v5, s[84:87], s12 offen offset:512 sc1
buffer_load_dwordx2 a[36:37], v5, s[84:87], s12 offen offset:1024 sc1
buffer_load_dwordx2 a[38:39], v5, s[84:87], s12 offen offset:1536 sc1
buffer_load_dwordx2 a[40:41], v5, s[84:87], s12 offen offset:2048 sc1
buffer_load_dwordx2 a[42:43], v5, s[84:87], s12 offen offset:2560 sc1
buffer_load_dwordx2 a[44:45], v5, s[84:87], s12 offen offset:3072 sc1
buffer_load_dwordx2 a[46:47], v5, s[84:87], s12 offen offset:3584 sc1
s_add_u32 s12, s12, 4096
buffer_load_dwordx2 a[48:49], v5, s[84:87], s12 offen offset:0 sc1
buffer_load_dwordx2 a[50:51], v5, s[84:87], s12 offen offset:512 sc1
buffer_load_dwordx2 a[52:53], v5, s[84:87], s12 offen offset:1024 sc1
buffer_load_dwordx2 a[54:55], v5, s[84:87], s12 offen offset:1536 sc1
buffer_load_dwordx2 a[56:57], v5, s[84:87], s12 offen offset:2048 sc1
buffer_load_dwordx2 a[58:59], v5, s[84:87], s12 offen offset:2560 sc1
buffer_load_dwordx2 a[60:61], v5, s[84:87], s12 offen offset:3072 sc1
buffer_load_dwordx2 a[62:63], v5, s[84:87], s12 offen offset:3584 sc1
s_add_u32 s12, s12, 4096
buffer_load_dword a64, v11, s[84:87], s13 offen offset:0 sc1
buffer_load_dword a65, v11, s[84:87], s13 offen offset:128 sc1
buffer_load_dword a66, v11, s[84:87], s13 offen offset:256 sc1
buffer_load_dword a67, v11, s[84:87], s13 offen offset:384 sc1
buffer_load_dword a68, v11, s[84:87], s13 offen offset:512 sc1
buffer_load_dword a69, v11, s[84:87], s13 offen offset:640 sc1
buffer_load_dword a70, v11, s[84:87], s13 offen offset:768 sc1
buffer_load_dword a71, v11, s[84:87], s13 offen offset:896 sc1
buffer_load_dword a72, v11, s[84:87], s13 offen offset:1024 sc1
buffer_load_dword a73, v11, s[84:87], s13 offen offset:1152 sc1
buffer_load_dword a74, v11, s[84:87], s13 offen offset:1280 sc1
buffer_load_dword a75, v11, s[84:87], s13 offen offset:1408 sc1
buffer_load_dword a76, v11, s[84:87], s13 offen offset:1536 sc1
buffer_load_dword a77, v11, s[84:87], s13 offen offset:1664 sc1
buffer_load_dword a78, v11, s[84:87], s13 offen offset:1792 sc1
buffer_load_dword a79, v11, s[84:87], s13 offen offset:1920 sc1
buffer_load_dword a80, v11, s[84:87], s13 offen offset:2048 sc1
buffer_load_dword a81, v11, s[84:87], s13 offen offset:2176 sc1
buffer_load_dword a82, v11, s[84:87], s13 offen offset:2304 sc1
buffer_load_dword a83, v11, s[84:87], s13 offen offset:2432 sc1
buffer_load_dword a84, v11, s[84:87], s13 offen offset:2560 sc1
buffer_load_dword a85, v11, s[84:87], s13 offen offset:2688 sc1
buffer_load_dword a86, v11, s[84:87], s13 offen offset:2816 sc1
buffer_load_dword a87, v11, s[84:87], s13 offen offset:2944 sc1
buffer_load_dword a88, v11, s[84:87], s13 offen offset:3072 sc1
buffer_load_dword a89, v11, s[84:87], s13 offen offset:3200 sc1
buffer_load_dword a90, v11, s[84:87], s13 offen offset:3328 sc1
buffer_load_dword a91, v11, s[84:87], s13 offen offset:3456 sc1
buffer_load_dword a92, v11, s[84:87], s13 offen offset:3584 sc1
buffer_load_dword a93, v11, s[84:87], s13 offen offset:3712 sc1
buffer_load_dword a94, v11, s[84:87], s13 offen offset:3840 sc1
buffer_load_dword a95, v11, s[84:87], s13 offen offset:3968 sc1
v_pk_add_f32 v[14:15], v[16:17], v[48:49] neg_lo:[0,1] neg_hi:[0,1]
v_pk_add_f32 v[16:17], v[16:17], v[48:49]
v_pk_add_f32 v[48:49], v[18:19], v[50:51] neg_lo:[0,1] neg_hi:[0,1]
v_pk_add_f32 v[18:19], v[18:19], v[50:51]
v_pk_mul_f32 v[50:51], v[48:49], s[50:51] op_sel:[0,0] op_sel_hi:[0,1] neg_lo:[0,0] neg_hi:[0,1]
v_pk_fma_f32 v[50:51], v[48:49], s[50:51], v[50:51] op_sel:[1,1,0] op_sel_hi:[1,0,1] neg_lo:[0,0,0] neg_hi:[0,0,0]
v_pk_add_f32 v[48:49], v[20:21], v[52:53] neg_lo:[0,1] neg_hi:[0,1]
v_pk_add_f32 v[20:21], v[20:21], v[52:53]
v_pk_mul_f32 v[52:53], v[48:49], s[54:55] op_sel:[0,0] op_sel_hi:[0,1] neg_lo:[0,0] neg_hi:[0,1]
v_pk_fma_f32 v[52:53], v[48:49], s[54:55], v[52:53] op_sel:[1,1,0] op_sel_hi:[1,0,1] neg_lo:[0,0,0] neg_hi:[0,0,0]
v_pk_add_f32 v[48:49], v[22:23], v[54:55] neg_lo:[0,1] neg_hi:[0,1]
v_pk_add_f32 v[22:23], v[22:23], v[54:55]
v_pk_mul_f32 v[54:55], v[48:49], s[58:59] op_sel:[0,0] op_sel_hi:[0,1] neg_lo:[0,0] neg_hi:[0,1]
v_pk_fma_f32 v[54:55], v[48:49], s[58:59], v[54:55] op_sel:[1,1,0] op_sel_hi:[1,0,1] neg_lo:[0,0,0] neg_hi:[0,0,0]
v_pk_add_f32 v[48:49], v[24:25], v[56:57] neg_lo:[0,1] neg_hi:[0,1]
v_pk_add_f32 v[24:25], v[24:25], v[56:57]
v_pk_mul_f32 v[56:57], v[48:49], s[62:63] op_sel:[0,0] op_sel_hi:[0,1] neg_lo:[0,0] neg_hi:[0,1]
v_pk_fma_f32 v[56:57], v[48:49], s[62:63], v[56:57] op_sel:[1,1,0] op_sel_hi:[1,0,1] neg_lo:[0,0,0] neg_hi:[0,0,0]
v_pk_add_f32 v[48:49], v[26:27], v[58:59] neg_lo:[0,1] neg_hi:[0,1]
v_pk_add_f32 v[26:27], v[26:27], v[58:59]
v_pk_mul_f32 v[58:59], v[48:49], s[58:59] op_sel:[0,1] op_sel_hi:[0,0] neg_lo:[0,0] neg_hi:[0,1]
v_pk_fma_f32 v[58:59], v[48:49], s[58:59], v[58:59] op_sel:[1,0,0] op_sel_hi:[1,1,1] neg_lo:[0,0,0] neg_hi:[0,0,0]
v_pk_add_f32 v[48:49], v[28:29], v[60:61] neg_lo:[0,1] neg_hi:[0,1]
v_pk_add_f32 v[28:29], v[28:29], v[60:61]
v_pk_mul_f32 v[60:61], v[48:49], s[54:55] op_sel:[0,1] op_sel_hi:[0,0] neg_lo:[0,0] neg_hi:[0,1]
v_pk_fma_f32 v[60:61], v[48:49], s[54:55], v[60:61] op_sel:[1,0,0] op_sel_hi:[1,1,1] neg_lo:[0,0,0] neg_hi:[0,0,0]
v_pk_add_f32 v[48:49], v[30:31], v[62:63] neg_lo:[0,1] neg_hi:[0,1]
v_pk_add_f32 v[30:31], v[30:31], v[62:63]
v_pk_mul_f32 v[62:63], v[48:49], s[50:51] op_sel:[0,1] op_sel_hi:[0,0] neg_lo:[0,0] neg_hi:[0,1]
v_pk_fma_f32 v[62:63], v[48:49], s[50:51], v[62:63] op_sel:[1,0,0] op_sel_hi:[1,1,1] neg_lo:[0,0,0] neg_hi:[0,0,0]
v_pk_add_f32 v[48:49], v[32:33], v[64:65] op_sel:[1,1] op_sel_hi:[0,0] neg_lo:[0,1] neg_hi:[1,0]
v_pk_add_f32 v[32:33], v[32:33], v[64:65]
v_pk_add_f32 v[64:65], v[34:35], v[66:67] neg_lo:[0,1] neg_hi:[0,1]
v_pk_add_f32 v[34:35], v[34:35], v[66:67]
v_pk_mul_f32 v[66:67], v[64:65], s[50:51] op_sel:[0,1] op_sel_hi:[0,0] neg_lo:[0,1] neg_hi:[0,1]
v_pk_fma_f32 v[66:67], v[64:65], s[50:51], v[66:67] op_sel:[1,0,0] op_sel_hi:[1,1,1] neg_lo:[0,0,0] neg_hi:[0,1,0]
v_pk_add_f32 v[64:65], v[36:37], v[68:69] neg_lo:[0,1] neg_hi:[0,1]
v_pk_add_f32 v[36:37], v[36:37], v[68:69]
v_pk_mul_f32 v[68:69], v[64:65], s[54:55] op_sel:[0,1] op_sel_hi:[0,0] neg_lo:[0,1] neg_hi:[0,1]
v_pk_fma_f32 v[68:69], v[64:65], s[54:55], v[68:69] op_sel:[1,0,0] op_sel_hi:[1,1,1] neg_lo:[0,0,0] neg_hi:[0,1,0]
v_pk_add_f32 v[64:65], v[38:39], v[70:71] neg_lo:[0,1] neg_hi:[0,1]
v_pk_add_f32 v[38:39], v[38:39], v[70:71]
v_pk_mul_f32 v[70:71], v[64:65], s[58:59] op_sel:[0,1] op_sel_hi:[0,0] neg_lo:[0,1] neg_hi:[0,1]
v_pk_fma_f32 v[70:71], v[64:65], s[58:59], v[70:71] op_sel:[1,0,0] op_sel_hi:[1,1,1] neg_lo:[0,0,0] neg_hi:[0,1,0]
v_pk_add_f32 v[64:65], v[40:41], v[72:73] neg_lo:[0,1] neg_hi:[0,1]
v_pk_add_f32 v[40:41], v[40:41], v[72:73]
v_pk_mul_f32 v[72:73], v[64:65], s[62:63] op_sel:[0,0] op_sel_hi:[0,1] neg_lo:[0,1] neg_hi:[0,1]
v_pk_fma_f32 v[72:73], v[64:65], s[62:63], v[72:73] op_sel:[1,1,0] op_sel_hi:[1,0,1] neg_lo:[0,0,0] neg_hi:[0,1,0]
v_pk_add_f32 v[64:65], v[42:43], v[74:75] neg_lo:[0,1] neg_hi:[0,1]
v_pk_add_f32 v[42:43], v[42:43], v[74:75]
v_pk_mul_f32 v[74:75], v[64:65], s[58:59] op_sel:[0,0] op_sel_hi:[0,1] neg_lo:[0,1] neg_hi:[0,1]
v_pk_fma_f32 v[74:75], v[64:65], s[58:59], v[74:75] op_sel:[1,1,0] op_sel_hi:[1,0,1] neg_lo:[0,0,0] neg_hi:[0,1,0]
v_pk_add_f32 v[64:65], v[44:45], v[76:77] neg_lo:[0,1] neg_hi:[0,1]
v_pk_add_f32 v[44:45], v[44:45], v[76:77]
v_pk_mul_f32 v[76:77], v[64:65], s[54:55] op_sel:[0,0] op_sel_hi:[0,1] neg_lo:[0,1] neg_hi:[0,1]
v_pk_fma_f32 v[76:77], v[64:65], s[54:55], v[76:77] op_sel:[1,1,0] op_sel_hi:[1,0,1] neg_lo:[0,0,0] neg_hi:[0,1,0]
v_pk_add_f32 v[64:65], v[46:47], v[78:79] neg_lo:[0,1] neg_hi:[0,1]
v_pk_add_f32 v[46:47], v[46:47], v[78:79]
v_pk_mul_f32 v[78:79], v[64:65], s[50:51] op_sel:[0,0] op_sel_hi:[0,1] neg_lo:[0,1] neg_hi:[0,1]
v_pk_fma_f32 v[78:79], v[64:65], s[50:51], v[78:79] op_sel:[1,1,0] op_sel_hi:[1,0,1] neg_lo:[0,0,0] neg_hi:[0,1,0]
v_pk_add_f32 v[64:65], v[16:17], v[32:33] neg_lo:[0,1] neg_hi:[0,1]
v_pk_add_f32 v[16:17], v[16:17], v[32:33]
v_pk_add_f32 v[32:33], v[18:19], v[34:35] neg_lo:[0,1] neg_hi:[0,1]
v_pk_add_f32 v[18:19], v[18:19], v[34:35]
v_pk_mul_f32 v[34:35], v[32:33], s[54:55] op_sel:[0,0] op_sel_hi:[0,1] neg_lo:[0,0] neg_hi:[0,1]
v_pk_fma_f32 v[34:35], v[32:33], s[54:55], v[34:35] op_sel:[1,1,0] op_sel_hi:[1,0,1] neg_lo:[0,0,0] neg_hi:[0,0,0]
v_pk_add_f32 v[32:33], v[20:21], v[36:37] neg_lo:[0,1] neg_hi:[0,1]
v_pk_add_f32 v[20:21], v[20:21], v[36:37]
v_pk_mul_f32 v[36:37], v[32:33], s[62:63] op_sel:[0,0] op_sel_hi:[0,1] neg_lo:[0,0] neg_hi:[0,1]
v_pk_fma_f32 v[36:37], v[32:33], s[62:63], v[36:37] op_sel:[1,1,0] op_sel_hi:[1,0,1] neg_lo:[0,0,0] neg_hi:[0,0,0]
v_pk_add_f32 v[32:33], v[22:23], v[38:39] neg_lo:[0,1] neg_hi:[0,1]
v_pk_add_f32 v[22:23], v[22:23], v[38:39]
v_pk_mul_f32 v[38:39], v[32:33], s[54:55] op_sel:[0,1] op_sel_hi:[0,0] neg_lo:[0,0] neg_hi:[0,1]
v_pk_fma_f32 v[38:39], v[32:33], s[54:55], v[38:39] op_sel:[1,0,0] op_sel_hi:[1,1,1] neg_lo:[0,0,0] neg_hi:[0,0,0]
v_pk_add_f32 v[32:33], v[24:25], v[40:41] op_sel:[1,1] op_sel_hi:[0,0] neg_lo:[0,1] neg_hi:[1,0]
v_pk_add_f32 v[24:25], v[24:25], v[40:41]
v_pk_add_f32 v[40:41], v[26:27], v[42:43] neg_lo:[0,1] neg_hi:[0,1]
v_pk_add_f32 v[26:27], v[26:27], v[42:43]
v_pk_mul_f32 v[42:43], v[40:41], s[54:55] op_sel:[0,1] op_sel_hi:[0,0] neg_lo:[0,1] neg_hi:[0,1]
v_pk_fma_f32 v[42:43], v[40:41], s[54:55], v[42:43] op_sel:[1,0,0] op_sel_hi:[1,1,1] neg_lo:[0,0,0] neg_hi:[0,1,0]
v_pk_add_f32 v[40:41], v[28:29], v[44:45] neg_lo:[0,1] neg_hi:[0,1]
v_pk_add_f32 v[28:29], v[28:29], v[44:45]
v_pk_mul_f32 v[44:45], v[40:41], s[62:63] op_sel:[0,0] op_sel_hi:[0,1] neg_lo:[0,1] neg_hi:[0,1]
v_pk_fma_f32 v[44:45], v[40:41], s[62:63], v[44:45] op_sel:[1,1,0] op_sel_hi:[1,0,1] neg_lo:[0,0,0] neg_hi:[0,1,0]
v_pk_add_f32 v[40:41], v[30:31], v[46:47] neg_lo:[0,1] neg_hi:[0,1]
v_pk_add_f32 v[30:31], v[30:31], v[46:47]
v_pk_mul_f32 v[46:47], v[40:41], s[54:55] op_sel:[0,0] op_sel_hi:[0,1] neg_lo:[0,1] neg_hi:[0,1]
v_pk_fma_f32 v[46:47], v[40:41], s[54:55], v[46:47] op_sel:[1,1,0] op_sel_hi:[1,0,1] neg_lo:[0,0,0] neg_hi:[0,1,0]
v_pk_add_f32 v[40:41], v[14:15], v[48:49] neg_lo:[0,1] neg_hi:[0,1]
v_pk_add_f32 v[14:15], v[14:15], v[48:49]
v_pk_add_f32 v[48:49], v[50:51], v[66:67] neg_lo:[0,1] neg_hi:[0,1]
v_pk_add_f32 v[50:51], v[50:51], v[66:67]
v_pk_mul_f32 v[66:67], v[48:49], s[54:55] op_sel:[0,0] op_sel_hi:[0,1] neg_lo:[0,0] neg_hi:[0,1]
v_pk_fma_f32 v[66:67], v[48:49], s[54:55], v[66:67] op_sel:[1,1,0] op_sel_hi:[1,0,1] neg_lo:[0,0,0] neg_hi:[0,0,0]
v_pk_add_f32 v[48:49], v[52:53], v[68:69] neg_lo:[0,1] neg_hi:[0,1]
v_pk_add_f32 v[52:53], v[52:53], v[68:69]
v_pk_mul_f32 v[68:69], v[48:49], s[62:63] op_sel:[0,0] op_sel_hi:[0,1] neg_lo:[0,0] neg_hi:[0,1]
v_pk_fma_f32 v[68:69], v[48:49], s[62:63], v[68:69] op_sel:[1,1,0] op_sel_hi:[1,0,1] neg_lo:[0,0,0] neg_hi:[0,0,0]
v_pk_add_f32 v[48:49], v[54:55], v[70:71] neg_lo:[0,1] neg_hi:[0,1]
v_pk_add_f32 v[54:55], v[54:55], v[70:71]
v_pk_mul_f32 v[70:71], v[48:49], s[54:55] op_sel:[0,1] op_sel_hi:[0,0] neg_lo:[0,0] neg_hi:[0,1]
v_pk_fma_f32 v[70:71], v[48:49], s[54:55], v[70:71] op_sel:[1,0,0] op_sel_hi:[1,1,1] neg_lo:[0,0,0] neg_hi:[0,0,0]
v_pk_add_f32 v[48:49], v[56:57], v[72:73] op_sel:[1,1] op_sel_hi:[0,0] neg_lo:[0,1] neg_hi:[1,0]
v_pk_add_f32 v[56:57], v[56:57], v[72:73]
v_pk_add_f32 v[72:73], v[58:59], v[74:75] neg_lo:[0,1] neg_hi:[0,1]
v_pk_add_f32 v[58:59], v[58:59], v[74:75]
v_pk_mul_f32 v[74:75], v[72:73], s[54:55] op_sel:[0,1] op_sel_hi:[0,0] neg_lo:[0,1] neg_hi:[0,1]
v_pk_fma_f32 v[74:75], v[72:73], s[54:55], v[74:75] op_sel:[1,0,0] op_sel_hi:[1,1,1] neg_lo:[0,0,0] neg_hi:[0,1,0]
v_pk_add_f32 v[72:73], v[60:61], v[76:77] neg_lo:[0,1] neg_hi:[0,1]
v_pk_add_f32 v[60:61], v[60:61], v[76:77]
v_pk_mul_f32 v[76:77], v[72:73], s[62:63] op_sel:[0,0] op_sel_hi:[0,1] neg_lo:[0,1] neg_hi:[0,1]
v_pk_fma_f32 v[76:77], v[72:73], s[62:63], v[76:77] op_sel:[1,1,0] op_sel_hi:[1,0,1] neg_lo:[0,0,0] neg_hi:[0,1,0]
v_pk_add_f32 v[72:73], v[62:63], v[78:79] neg_lo:[0,1] neg_hi:[0,1]
v_pk_add_f32 v[62:63], v[62:63], v[78:79]
v_pk_mul_f32 v[78:79], v[72:73], s[54:55] op_sel:[0,0] op_sel_hi:[0,1] neg_lo:[0,1] neg_hi:[0,1]
v_pk_fma_f32 v[78:79], v[72:73], s[54:55], v[78:79] op_sel:[1,1,0] op_sel_hi:[1,0,1] neg_lo:[0,0,0] neg_hi:[0,1,0]
v_pk_add_f32 v[72:73], v[16:17], v[24:25] neg_lo:[0,1] neg_hi:[0,1]
v_pk_add_f32 v[16:17], v[16:17], v[24:25]
v_pk_add_f32 v[24:25], v[18:19], v[26:27] neg_lo:[0,1] neg_hi:[0,1]
v_pk_add_f32 v[18:19], v[18:19], v[26:27]
v_pk_mul_f32 v[26:27], v[24:25], s[62:63] op_sel:[0,0] op_sel_hi:[0,1] neg_lo:[0,0] neg_hi:[0,1]
v_pk_fma_f32 v[26:27], v[24:25], s[62:63], v[26:27] op_sel:[1,1,0] op_sel_hi:[1,0,1] neg_lo:[0,0,0] neg_hi:[0,0,0]
v_pk_add_f32 v[24:25], v[20:21], v[28:29] op_sel:[1,1] op_sel_hi:[0,0] neg_lo:[0,1] neg_hi:[1,0]
v_pk_add_f32 v[20:21], v[20:21], v[28:29]
v_pk_add_f32 v[28:29], v[22:23], v[30:31] neg_lo:[0,1] neg_hi:[0,1]
v_pk_add_f32 v[22:23], v[22:23], v[30:31]
v_pk_mul_f32 v[30:31], v[28:29], s[62:63] op_sel:[0,0] op_sel_hi:[0,1] neg_lo:[0,1] neg_hi:[0,1]
v_pk_fma_f32 v[30:31], v[28:29], s[62:63], v[30:31] op_sel:[1,1,0] op_sel_hi:[1,0,1] neg_lo:[0,0,0] neg_hi:[0,1,0]
v_pk_add_f32 v[28:29], v[64:65], v[32:33] neg_lo:[0,1] neg_hi:[0,1]
v_pk_add_f32 v[64:65], v[64:65], v[32:33]
v_pk_add_f32 v[32:33], v[34:35], v[42:43] neg_lo:[0,1] neg_hi:[0,1]
v_pk_add_f32 v[34:35], v[34:35], v[42:43]
v_pk_mul_f32 v[42:43], v[32:33], s[62:63] op_sel:[0,0] op_sel_hi:[0,1] neg_lo:[0,0] neg_hi:[0,1]
v_pk_fma_f32 v[42:43], v[32:33], s[62:63], v[42:43] op_sel:[1,1,0] op_sel_hi:[1,0,1] neg_lo:[0,0,0] neg_hi:[0,0,0]
v_pk_add_f32 v[32:33], v[36:37], v[44:45] op_sel:[1,1] op_sel_hi:[0,0] neg_lo:[0,1] neg_hi:[1,0]
v_pk_add_f32 v[36:37], v[36:37], v[44:45]
v_pk_add_f32 v[44:45], v[38:39], v[46:47] neg_lo:[0,1] neg_hi:[0,1]
v_pk_add_f32 v[38:39], v[38:39], v[46:47]
v_pk_mul_f32 v[46:47], v[44:45], s[62:63] op_sel:[0,0] op_sel_hi:[0,1] neg_lo:[0,1] neg_hi:[0,1]
v_pk_fma_f32 v[46:47], v[44:45], s[62:63], v[46:47] op_sel:[1,1,0] op_sel_hi:[1,0,1] neg_lo:[0,0,0] neg_hi:[0,1,0]
v_pk_add_f32 v[44:45], v[14:15], v[56:57] neg_lo:[0,1] neg_hi:[0,1]
v_pk_add_f32 v[14:15], v[14:15], v[56:57]
v_pk_add_f32 v[56:57], v[50:51], v[58:59] neg_lo:[0,1] neg_hi:[0,1]
v_pk_add_f32 v[50:51], v[50:51], v[58:59]
v_pk_mul_f32 v[58:59], v[56:57], s[62:63] op_sel:[0,0] op_sel_hi:[0,1] neg_lo:[0,0] neg_hi:[0,1]
v_pk_fma_f32 v[58:59], v[56:57], s[62:63], v[58:59] op_sel:[1,1,0] op_sel_hi:[1,0,1] neg_lo:[0,0,0] neg_hi:[0,0,0]
v_pk_add_f32 v[56:57], v[52:53], v[60:61] op_sel:[1,1] op_sel_hi:[0,0] neg_lo:[0,1] neg_hi:[1,0]
v_pk_add_f32 v[52:53], v[52:53], v[60:61]
v_pk_add_f32 v[60:61], v[54:55], v[62:63] neg_lo:[0,1] neg_hi:[0,1]
v_pk_add_f32 v[54:55], v[54:55], v[62:63]
v_pk_mul_f32 v[62:63], v[60:61], s[62:63] op_sel:[0,0] op_sel_hi:[0,1] neg_lo:[0,1] neg_hi:[0,1]
v_pk_fma_f32 v[62:63], v[60:61], s[62:63], v[62:63] op_sel:[1,1,0] op_sel_hi:[1,0,1] neg_lo:[0,0,0] neg_hi:[0,1,0]
v_pk_add_f32 v[60:61], v[40:41], v[48:49] neg_lo:[0,1] neg_hi:[0,1]
v_pk_add_f32 v[40:41], v[40:41], v[48:49]
v_pk_add_f32 v[48:49], v[66:67], v[74:75] neg_lo:[0,1] neg_hi:[0,1]
v_pk_add_f32 v[66:67], v[66:67], v[74:75]
v_pk_mul_f32 v[74:75], v[48:49], s[62:63] op_sel:[0,0] op_sel_hi:[0,1] neg_lo:[0,0] neg_hi:[0,1]
v_pk_fma_f32 v[74:75], v[48:49], s[62:63], v[74:75] op_sel:[1,1,0] op_sel_hi:[1,0,1] neg_lo:[0,0,0] neg_hi:[0,0,0]
v_pk_add_f32 v[48:49], v[68:69], v[76:77] op_sel:[1,1] op_sel_hi:[0,0] neg_lo:[0,1] neg_hi:[1,0]
v_pk_add_f32 v[68:69], v[68:69], v[76:77]
v_pk_add_f32 v[76:77], v[70:71], v[78:79] neg_lo:[0,1] neg_hi:[0,1]
v_pk_add_f32 v[70:71], v[70:71], v[78:79]
v_pk_mul_f32 v[78:79], v[76:77], s[62:63] op_sel:[0,0] op_sel_hi:[0,1] neg_lo:[0,1] neg_hi:[0,1]
v_pk_fma_f32 v[78:79], v[76:77], s[62:63], v[78:79] op_sel:[1,1,0] op_sel_hi:[1,0,1] neg_lo:[0,0,0] neg_hi:[0,1,0]
v_pk_add_f32 v[76:77], v[16:17], v[20:21] neg_lo:[0,1] neg_hi:[0,1]
v_pk_add_f32 v[16:17], v[16:17], v[20:21]
v_pk_add_f32 v[20:21], v[18:19], v[22:23] op_sel:[1,1] op_sel_hi:[0,0] neg_lo:[0,1] neg_hi:[1,0]
v_pk_add_f32 v[18:19], v[18:19], v[22:23]
v_pk_add_f32 v[22:23], v[72:73], v[24:25] neg_lo:[0,1] neg_hi:[0,1]
v_pk_add_f32 v[72:73], v[72:73], v[24:25]
v_pk_add_f32 v[24:25], v[26:27], v[30:31] op_sel:[1,1] op_sel_hi:[0,0] neg_lo:[0,1] neg_hi:[1,0]
v_pk_add_f32 v[26:27], v[26:27], v[30:31]
v_pk_add_f32 v[30:31], v[64:65], v[36:37] neg_lo:[0,1] neg_hi:[0,1]
v_pk_add_f32 v[64:65], v[64:65], v[36:37]
v_pk_add_f32 v[36:37], v[34:35], v[38:39] op_sel:[1,1] op_sel_hi:[0,0] neg_lo:[0,1] neg_hi:[1,0]
v_pk_add_f32 v[34:35], v[34:35], v[38:39]
v_pk_add_f32 v[38:39], v[28:29], v[32:33] neg_lo:[0,1] neg_hi:[0,1]
v_pk_add_f32 v[28:29], v[28:29], v[32:33]
v_pk_add_f32 v[32:33], v[42:43], v[46:47] op_sel:[1,1] op_sel_hi:[0,0] neg_lo:[0,1] neg_hi:[1,0]
v_pk_add_f32 v[42:43], v[42:43], v[46:47]
v_pk_add_f32 v[46:47], v[14:15], v[52:53] neg_lo:[0,1] neg_hi:[0,1]
v_pk_add_f32 v[14:15], v[14:15], v[52:53]
v_pk_add_f32 v[52:53], v[50:51], v[54:55] op_sel:[1,1] op_sel_hi:[0,0] neg_lo:[0,1] neg_hi:[1,0]
v_pk_add_f32 v[50:51], v[50:51], v[54:55]
v_pk_add_f32 v[54:55], v[44:45], v[56:57] neg_lo:[0,1] neg_hi:[0,1]
v_pk_add_f32 v[44:45], v[44:45], v[56:57]
v_pk_add_f32 v[56:57], v[58:59], v[62:63] op_sel:[1,1] op_sel_hi:[0,0] neg_lo:[0,1] neg_hi:[1,0]
v_pk_add_f32 v[58:59], v[58:59], v[62:63]
v_pk_add_f32 v[62:63], v[40:41], v[68:69] neg_lo:[0,1] neg_hi:[0,1]
v_pk_add_f32 v[40:41], v[40:41], v[68:69]
v_pk_add_f32 v[68:69], v[66:67], v[70:71] op_sel:[1,1] op_sel_hi:[0,0] neg_lo:[0,1] neg_hi:[1,0]
v_pk_add_f32 v[66:67], v[66:67], v[70:71]
v_pk_add_f32 v[70:71], v[60:61], v[48:49] neg_lo:[0,1] neg_hi:[0,1]
v_pk_add_f32 v[60:61], v[60:61], v[48:49]
v_pk_add_f32 v[48:49], v[74:75], v[78:79] op_sel:[1,1] op_sel_hi:[0,0] neg_lo:[0,1] neg_hi:[1,0]
v_pk_add_f32 v[74:75], v[74:75], v[78:79]
v_pk_add_f32 v[78:79], v[16:17], v[18:19] neg_lo:[0,1] neg_hi:[0,1]
v_pk_add_f32 v[16:17], v[16:17], v[18:19]
v_pk_add_f32 v[18:19], v[76:77], v[20:21] neg_lo:[0,1] neg_hi:[0,1]
v_pk_add_f32 v[76:77], v[76:77], v[20:21]
v_pk_add_f32 v[20:21], v[72:73], v[26:27] neg_lo:[0,1] neg_hi:[0,1]
v_pk_add_f32 v[72:73], v[72:73], v[26:27]
v_pk_add_f32 v[26:27], v[22:23], v[24:25] neg_lo:[0,1] neg_hi:[0,1]
v_pk_add_f32 v[22:23], v[22:23], v[24:25]
v_pk_add_f32 v[24:25], v[64:65], v[34:35] neg_lo:[0,1] neg_hi:[0,1]
v_pk_add_f32 v[64:65], v[64:65], v[34:35]
v_pk_add_f32 v[34:35], v[30:31], v[36:37] neg_lo:[0,1] neg_hi:[0,1]
v_pk_add_f32 v[30:31], v[30:31], v[36:37]
v_pk_add_f32 v[36:37], v[28:29], v[42:43] neg_lo:[0,1] neg_hi:[0,1]
v_pk_add_f32 v[28:29], v[28:29], v[42:43]
v_pk_add_f32 v[42:43], v[38:39], v[32:33] neg_lo:[0,1] neg_hi:[0,1]
v_pk_add_f32 v[38:39], v[38:39], v[32:33]
v_pk_add_f32 v[32:33], v[14:15], v[50:51] neg_lo:[0,1] neg_hi:[0,1]
v_pk_add_f32 v[14:15], v[14:15], v[50:51]
v_pk_add_f32 v[50:51], v[46:47], v[52:53] neg_lo:[0,1] neg_hi:[0,1]
v_pk_add_f32 v[46:47], v[46:47], v[52:53]
v_pk_add_f32 v[52:53], v[44:45], v[58:59] neg_lo:[0,1] neg_hi:[0,1]
v_pk_add_f32 v[44:45], v[44:45], v[58:59]
v_pk_add_f32 v[58:59], v[54:55], v[56:57] neg_lo:[0,1] neg_hi:[0,1]
v_pk_add_f32 v[54:55], v[54:55], v[56:57]
v_pk_add_f32 v[56:57], v[40:41], v[66:67] neg_lo:[0,1] neg_hi:[0,1]
v_pk_add_f32 v[40:41], v[40:41], v[66:67]
v_pk_add_f32 v[66:67], v[62:63], v[68:69] neg_lo:[0,1] neg_hi:[0,1]
v_pk_add_f32 v[62:63], v[62:63], v[68:69]
v_pk_add_f32 v[68:69], v[60:61], v[74:75] neg_lo:[0,1] neg_hi:[0,1]
v_pk_add_f32 v[60:61], v[60:61], v[74:75]
v_pk_add_f32 v[74:75], v[70:71], v[48:49] neg_lo:[0,1] neg_hi:[0,1]
v_pk_add_f32 v[70:71], v[70:71], v[48:49]
v_pk_mul_f32 v[48:49], v[14:15], v[82:83] op_sel:[0,0] op_sel_hi:[0,1] neg_lo:[0,0] neg_hi:[0,0]
v_pk_fma_f32 v[14:15], v[14:15], v[82:83], v[48:49] op_sel:[1,1,0] op_sel_hi:[1,0,1] neg_lo:[0,1,0] neg_hi:[0,0,0]
v_pk_mul_f32 v[48:49], v[64:65], v[84:85] op_sel:[0,0] op_sel_hi:[0,1] neg_lo:[0,0] neg_hi:[0,0]
v_pk_fma_f32 v[64:65], v[64:65], v[84:85], v[48:49] op_sel:[1,1,0] op_sel_hi:[1,0,1] neg_lo:[0,1,0] neg_hi:[0,0,0]
v_pk_mul_f32 v[48:49], v[40:41], v[86:87] op_sel:[0,0] op_sel_hi:[0,1] neg_lo:[0,0] neg_hi:[0,0]
v_pk_fma_f32 v[40:41], v[40:41], v[86:87], v[48:49] op_sel:[1,1,0] op_sel_hi:[1,0,1] neg_lo:[0,1,0] neg_hi:[0,0,0]
v_pk_mul_f32 v[48:49], v[72:73], v[88:89] op_sel:[0,0] op_sel_hi:[0,1] neg_lo:[0,0] neg_hi:[0,0]
v_pk_fma_f32 v[72:73], v[72:73], v[88:89], v[48:49] op_sel:[1,1,0] op_sel_hi:[1,0,1] neg_lo:[0,1,0] neg_hi:[0,0,0]
v_pk_mul_f32 v[48:49], v[44:45], v[90:91] op_sel:[0,0] op_sel_hi:[0,1] neg_lo:[0,0] neg_hi:[0,0]
v_pk_fma_f32 v[44:45], v[44:45], v[90:91], v[48:49] op_sel:[1,1,0] op_sel_hi:[1,0,1] neg_lo:[0,1,0] neg_hi:[0,0,0]
v_pk_mul_f32 v[48:49], v[28:29], v[92:93] op_sel:[0,0] op_sel_hi:[0,1] neg_lo:[0,0] neg_hi:[0,0]
v_pk_fma_f32 v[28:29], v[28:29], v[92:93], v[48:49] op_sel:[1,1,0] op_sel_hi:[1,0,1] neg_lo:[0,1,0] neg_hi:[0,0,0]
v_pk_mul_f32 v[48:49], v[60:61], v[94:95] op_sel:[0,0] op_sel_hi:[0,1] neg_lo:[0,0] neg_hi:[0,0]
v_pk_fma_f32 v[60:61], v[60:61], v[94:95], v[48:49] op_sel:[1,1,0] op_sel_hi:[1,0,1] neg_lo:[0,1,0] neg_hi:[0,0,0]
v_pk_mul_f32 v[48:49], v[76:77], v[96:97] op_sel:[0,0] op_sel_hi:[0,1] neg_lo:[0,0] neg_hi:[0,0]
v_pk_fma_f32 v[76:77], v[76:77], v[96:97], v[48:49] op_sel:[1,1,0] op_sel_hi:[1,0,1] neg_lo:[0,1,0] neg_hi:[0,0,0]
v_pk_mul_f32 v[48:49], v[46:47], v[98:99] op_sel:[0,0] op_sel_hi:[0,1] neg_lo:[0,0] neg_hi:[0,0]
v_pk_fma_f32 v[46:47], v[46:47], v[98:99], v[48:49] op_sel:[1,1,0] op_sel_hi:[1,0,1] neg_lo:[0,1,0] neg_hi:[0,0,0]
v_pk_mul_f32 v[48:49], v[30:31], v[100:101] op_sel:[0,0] op_sel_hi:[0,1] neg_lo:[0,0] neg_hi:[0,0]
v_pk_fma_f32 v[30:31], v[30:31], v[100:101], v[48:49] op_sel:[1,1,0] op_sel_hi:[1,0,1] neg_lo:[0,1,0] neg_hi:[0,0,0]
v_pk_mul_f32 v[48:49], v[62:63], v[102:103] op_sel:[0,0] op_sel_hi:[0,1] neg_lo:[0,0] neg_hi:[0,0]
v_pk_fma_f32 v[62:63], v[62:63], v[102:103], v[48:49] op_sel:[1,1,0] op_sel_hi:[1,0,1] neg_lo:[0,1,0] neg_hi:[0,0,0]
v_pk_mul_f32 v[48:49], v[22:23], v[104:105] op_sel:[0,0] op_sel_hi:[0,1] neg_lo:[0,0] neg_hi:[0,0]
v_pk_fma_f32 v[22:23], v[22:23], v[104:105], v[48:49] op_sel:[1,1,0] op_sel_hi:[1,0,1] neg_lo:[0,1,0] neg_hi:[0,0,0]
v_pk_mul_f32 v[48:49], v[54:55], v[106:107] op_sel:[0,0] op_sel_hi:[0,1] neg_lo:[0,0] neg_hi:[0,0]
v_pk_fma_f32 v[54:55], v[54:55], v[106:107], v[48:49] op_sel:[1,1,0] op_sel_hi:[1,0,1] neg_lo:[0,1,0] neg_hi:[0,0,0]
v_pk_mul_f32 v[48:49], v[38:39], v[108:109] op_sel:[0,0] op_sel_hi:[0,1] neg_lo:[0,0] neg_hi:[0,0]
v_pk_fma_f32 v[38:39], v[38:39], v[108:109], v[48:49] op_sel:[1,1,0] op_sel_hi:[1,0,1] neg_lo:[0,1,0] neg_hi:[0,0,0]
v_pk_mul_f32 v[48:49], v[70:71], v[110:111] op_sel:[0,0] op_sel_hi:[0,1] neg_lo:[0,0] neg_hi:[0,0]
v_pk_fma_f32 v[70:71], v[70:71], v[110:111], v[48:49] op_sel:[1,1,0] op_sel_hi:[1,0,1] neg_lo:[0,1,0] neg_hi:[0,0,0]
v_pk_mul_f32 v[48:49], v[78:79], v[112:113] op_sel:[0,0] op_sel_hi:[0,1] neg_lo:[0,0] neg_hi:[0,0]
v_pk_fma_f32 v[78:79], v[78:79], v[112:113], v[48:49] op_sel:[1,1,0] op_sel_hi:[1,0,1] neg_lo:[0,1,0] neg_hi:[0,0,0]
v_pk_mul_f32 v[48:49], v[32:33], v[114:115] op_sel:[0,0] op_sel_hi:[0,1] neg_lo:[0,0] neg_hi:[0,0]
v_pk_fma_f32 v[32:33], v[32:33], v[114:115], v[48:49] op_sel:[1,1,0] op_sel_hi:[1,0,1] neg_lo:[0,1,0] neg_hi:[0,0,0]
v_pk_mul_f32 v[48:49], v[24:25], v[116:117] op_sel:[0,0] op_sel_hi:[0,1] neg_lo:[0,0] neg_hi:[0,0]
v_pk_fma_f32 v[24:25], v[24:25], v[116:117], v[48:49] op_sel:[1,1,0] op_sel_hi:[1,0,1] neg_lo:[0,1,0] neg_hi:[0,0,0]
v_pk_mul_f32 v[48:49], v[56:57], v[118:119] op_sel:[0,0] op_sel_hi:[0,1] neg_lo:[0,0] neg_hi:[0,0]
v_pk_fma_f32 v[56:57], v[56:57], v[118:119], v[48:49] op_sel:[1,1,0] op_sel_hi:[1,0,1] neg_lo:[0,1,0] neg_hi:[0,0,0]
v_pk_mul_f32 v[48:49], v[20:21], v[120:121] op_sel:[0,0] op_sel_hi:[0,1] neg_lo:[0,0] neg_hi:[0,0]
v_pk_fma_f32 v[20:21], v[20:21], v[120:121], v[48:49] op_sel:[1,1,0] op_sel_hi:[1,0,1] neg_lo:[0,1,0] neg_hi:[0,0,0]
v_pk_mul_f32 v[48:49], v[52:53], v[122:123] op_sel:[0,0] op_sel_hi:[0,1] neg_lo:[0,0] neg_hi:[0,0]
v_pk_fma_f32 v[52:53], v[52:53], v[122:123], v[48:49] op_sel:[1,1,0] op_sel_hi:[1,0,1] neg_lo:[0,1,0] neg_hi:[0,0,0]
v_pk_mul_f32 v[48:49], v[36:37], v[124:125] op_sel:[0,0] op_sel_hi:[0,1] neg_lo:[0,0] neg_hi:[0,0]
v_pk_fma_f32 v[36:37], v[36:37], v[124:125], v[48:49] op_sel:[1,1,0] op_sel_hi:[1,0,1] neg_lo:[0,1,0] neg_hi:[0,0,0]
v_pk_mul_f32 v[48:49], v[68:69], v[126:127] op_sel:[0,0] op_sel_hi:[0,1] neg_lo:[0,0] neg_hi:[0,0]
v_pk_fma_f32 v[68:69], v[68:69], v[126:127], v[48:49] op_sel:[1,1,0] op_sel_hi:[1,0,1] neg_lo:[0,1,0] neg_hi:[0,0,0]
v_pk_mul_f32 v[48:49], v[18:19], v[128:129] op_sel:[0,0] op_sel_hi:[0,1] neg_lo:[0,0] neg_hi:[0,0]
v_pk_fma_f32 v[18:19], v[18:19], v[128:129], v[48:49] op_sel:[1,1,0] op_sel_hi:[1,0,1] neg_lo:[0,1,0] neg_hi:[0,0,0]
v_pk_mul_f32 v[48:49], v[50:51], v[130:131] op_sel:[0,0] op_sel_hi:[0,1] neg_lo:[0,0] neg_hi:[0,0]
v_pk_fma_f32 v[50:51], v[50:51], v[130:131], v[48:49] op_sel:[1,1,0] op_sel_hi:[1,0,1] neg_lo:[0,1,0] neg_hi:[0,0,0]
v_pk_mul_f32 v[48:49], v[34:35], v[132:133] op_sel:[0,0] op_sel_hi:[0,1] neg_lo:[0,0] neg_hi:[0,0]
v_pk_fma_f32 v[34:35], v[34:35], v[132:133], v[48:49] op_sel:[1,1,0] op_sel_hi:[1,0,1] neg_lo:[0,1,0] neg_hi:[0,0,0]
v_pk_mul_f32 v[48:49], v[66:67], v[134:135] op_sel:[0,0] op_sel_hi:[0,1] neg_lo:[0,0] neg_hi:[0,0]
v_pk_fma_f32 v[66:67], v[66:67], v[134:135], v[48:49] op_sel:[1,1,0] op_sel_hi:[1,0,1] neg_lo:[0,1,0] neg_hi:[0,0,0]
v_pk_mul_f32 v[48:49], v[26:27], v[136:137] op_sel:[0,0] op_sel_hi:[0,1] neg_lo:[0,0] neg_hi:[0,0]
v_pk_fma_f32 v[26:27], v[26:27], v[136:137], v[48:49] op_sel:[1,1,0] op_sel_hi:[1,0,1] neg_lo:[0,1,0] neg_hi:[0,0,0]
v_pk_mul_f32 v[48:49], v[58:59], v[138:139] op_sel:[0,0] op_sel_hi:[0,1] neg_lo:[0,0] neg_hi:[0,0]
v_pk_fma_f32 v[58:59], v[58:59], v[138:139], v[48:49] op_sel:[1,1,0] op_sel_hi:[1,0,1] neg_lo:[0,1,0] neg_hi:[0,0,0]
v_pk_mul_f32 v[48:49], v[42:43], v[140:141] op_sel:[0,0] op_sel_hi:[0,1] neg_lo:[0,0] neg_hi:[0,0]
v_pk_fma_f32 v[42:43], v[42:43], v[140:141], v[48:49] op_sel:[1,1,0] op_sel_hi:[1,0,1] neg_lo:[0,1,0] neg_hi:[0,0,0]
v_pk_mul_f32 v[48:49], v[74:75], v[142:143] op_sel:[0,0] op_sel_hi:[0,1] neg_lo:[0,0] neg_hi:[0,0]
v_pk_fma_f32 v[74:75], v[74:75], v[142:143], v[48:49] op_sel:[1,1,0] op_sel_hi:[1,0,1] neg_lo:[0,1,0] neg_hi:[0,0,0]
ds_write_b64 v3, v[16:17] offset:0
ds_write_b64 v3, v[14:15] offset:528
ds_write_b64 v3, v[64:65] offset:1056
ds_write_b64 v3, v[40:41] offset:1584
ds_write_b64 v3, v[72:73] offset:2112
ds_write_b64 v3, v[44:45] offset:2640
ds_write_b64 v3, v[28:29] offset:3168
ds_write_b64 v3, v[60:61] offset:3696
ds_write_b64 v3, v[76:77] offset:4224
ds_write_b64 v3, v[46:47] offset:4752
ds_write_b64 v3, v[30:31] offset:5280
ds_write_b64 v3, v[62:63] offset:5808
ds_write_b64 v3, v[22:23] offset:6336
ds_write_b64 v3, v[54:55] offset:6864
ds_write_b64 v3, v[38:39] offset:7392
ds_write_b64 v3, v[70:71] offset:7920
ds_write_b64 v3, v[78:79] offset:8448
ds_write_b64 v3, v[32:33] offset:8976
ds_write_b64 v3, v[24:25] offset:9504
ds_write_b64 v3, v[56:57] offset:10032
ds_write_b64 v3, v[20:21] offset:10560
ds_write_b64 v3, v[52:53] offset:11088
ds_write_b64 v3, v[36:37] offset:11616
ds_write_b64 v3, v[68:69] offset:12144
ds_write_b64 v3, v[18:19] offset:12672
ds_write_b64 v3, v[50:51] offset:13200
ds_write_b64 v3, v[34:35] offset:13728
ds_write_b64 v3, v[66:67] offset:14256
ds_write_b64 v3, v[26:27] offset:14784
ds_write_b64 v3, v[58:59] offset:15312
ds_write_b64 v3, v[42:43] offset:15840
ds_write_b64 v3, v[74:75] offset:16368
s_waitcnt lgkmcnt(0)
ds_read_b64 v[16:17], v4 offset:0
ds_read_b64 v[48:49], v4 offset:256
ds_read_b64 v[18:19], v4 offset:16
ds_read_b64 v[50:51], v4 offset:272
ds_read_b64 v[20:21], v4 offset:32
ds_read_b64 v[52:53], v4 offset:288
ds_read_b64 v[22:23], v4 offset:48
ds_read_b64 v[54:55], v4 offset:304
ds_read_b64 v[24:25], v4 offset:64
ds_read_b64 v[56:57], v4 offset:320
ds_read_b64 v[26:27], v4 offset:80
ds_read_b64 v[58:59], v4 offset:336
ds_read_b64 v[28:29], v4 offset:96
ds_read_b64 v[60:61], v4 offset:352
ds_read_b64 v[30:31], v4 offset:112
ds_read_b64 v[62:63], v4 offset:368
ds_read_b64 v[32:33], v4 offset:128
ds_read_b64 v[64:65], v4 offset:384
ds_read_b64 v[34:35], v4 offset:144
ds_read_b64 v[66:67], v4 offset:400
ds_read_b64 v[36:37], v4 offset:160
ds_read_b64 v[68:69], v4 offset:416
ds_read_b64 v[38:39], v4 offset:176
ds_read_b64 v[70:71], v4 offset:432
ds_read_b64 v[40:41], v4 offset:192
ds_read_b64 v[72:73], v4 offset:448
ds_read_b64 v[42:43], v4 offset:208
ds_read_b64 v[74:75], v4 offset:464
ds_read_b64 v[44:45], v4 offset:224
ds_read_b64 v[76:77], v4 offset:480
ds_read_b64 v[46:47], v4 offset:240
ds_read_b64 v[78:79], v4 offset:496
s_waitcnt lgkmcnt(0)
v_pk_add_f32 v[14:15], v[16:17], v[48:49] neg_lo:[0,1] neg_hi:[0,1]
v_pk_add_f32 v[16:17], v[16:17], v[48:49]
v_pk_add_f32 v[48:49], v[18:19], v[50:51] neg_lo:[0,1] neg_hi:[0,1]
v_pk_add_f32 v[18:19], v[18:19], v[50:51]
v_pk_mul_f32 v[50:51], v[48:49], s[50:51] op_sel:[0,0] op_sel_hi:[0,1] neg_lo:[0,0] neg_hi:[0,1]
v_pk_fma_f32 v[50:51], v[48:49], s[50:51], v[50:51] op_sel:[1,1,0] op_sel_hi:[1,0,1] neg_lo:[0,0,0] neg_hi:[0,0,0]
v_pk_add_f32 v[48:49], v[20:21], v[52:53] neg_lo:[0,1] neg_hi:[0,1]
v_pk_add_f32 v[20:21], v[20:21], v[52:53]
v_pk_mul_f32 v[52:53], v[48:49], s[54:55] op_sel:[0,0] op_sel_hi:[0,1] neg_lo:[0,0] neg_hi:[0,1]
v_pk_fma_f32 v[52:53], v[48:49], s[54:55], v[52:53] op_sel:[1,1,0] op_sel_hi:[1,0,1] neg_lo:[0,0,0] neg_hi:[0,0,0]
v_pk_add_f32 v[48:49], v[22:23], v[54:55] neg_lo:[0,1] neg_hi:[0,1]
v_pk_add_f32 v[22:23], v[22:23], v[54:55]
v_pk_mul_f32 v[54:55], v[48:49], s[58:59] op_sel:[0,0] op_sel_hi:[0,1] neg_lo:[0,0] neg_hi:[0,1]
v_pk_fma_f32 v[54:55], v[48:49], s[58:59], v[54:55] op_sel:[1,1,0] op_sel_hi:[1,0,1] neg_lo:[0,0,0] neg_hi:[0,0,0]
v_pk_add_f32 v[48:49], v[24:25], v[56:57] neg_lo:[0,1] neg_hi:[0,1]
v_pk_add_f32 v[24:25], v[24:25], v[56:57]
v_pk_mul_f32 v[56:57], v[48:49], s[62:63] op_sel:[0,0] op_sel_hi:[0,1] neg_lo:[0,0] neg_hi:[0,1]
v_pk_fma_f32 v[56:57], v[48:49], s[62:63], v[56:57] op_sel:[1,1,0] op_sel_hi:[1,0,1] neg_lo:[0,0,0] neg_hi:[0,0,0]
v_pk_add_f32 v[48:49], v[26:27], v[58:59] neg_lo:[0,1] neg_hi:[0,1]
v_pk_add_f32 v[26:27], v[26:27], v[58:59]
v_pk_mul_f32 v[58:59], v[48:49], s[58:59] op_sel:[0,1] op_sel_hi:[0,0] neg_lo:[0,0] neg_hi:[0,1]
v_pk_fma_f32 v[58:59], v[48:49], s[58:59], v[58:59] op_sel:[1,0,0] op_sel_hi:[1,1,1] neg_lo:[0,0,0] neg_hi:[0,0,0]
v_pk_add_f32 v[48:49], v[28:29], v[60:61] neg_lo:[0,1] neg_hi:[0,1]
v_pk_add_f32 v[28:29], v[28:29], v[60:61]
v_pk_mul_f32 v[60:61], v[48:49], s[54:55] op_sel:[0,1] op_sel_hi:[0,0] neg_lo:[0,0] neg_hi:[0,1]
v_pk_fma_f32 v[60:61], v[48:49], s[54:55], v[60:61] op_sel:[1,0,0] op_sel_hi:[1,1,1] neg_lo:[0,0,0] neg_hi:[0,0,0]
v_pk_add_f32 v[48:49], v[30:31], v[62:63] neg_lo:[0,1] neg_hi:[0,1]
v_pk_add_f32 v[30:31], v[30:31], v[62:63]
v_pk_mul_f32 v[62:63], v[48:49], s[50:51] op_sel:[0,1] op_sel_hi:[0,0] neg_lo:[0,0] neg_hi:[0,1]
v_pk_fma_f32 v[62:63], v[48:49], s[50:51], v[62:63] op_sel:[1,0,0] op_sel_hi:[1,1,1] neg_lo:[0,0,0] neg_hi:[0,0,0]
v_pk_add_f32 v[48:49], v[32:33], v[64:65] op_sel:[1,1] op_sel_hi:[0,0] neg_lo:[0,1] neg_hi:[1,0]
v_pk_add_f32 v[32:33], v[32:33], v[64:65]
v_pk_add_f32 v[64:65], v[34:35], v[66:67] neg_lo:[0,1] neg_hi:[0,1]
v_pk_add_f32 v[34:35], v[34:35], v[66:67]
v_pk_mul_f32 v[66:67], v[64:65], s[50:51] op_sel:[0,1] op_sel_hi:[0,0] neg_lo:[0,1] neg_hi:[0,1]
v_pk_fma_f32 v[66:67], v[64:65], s[50:51], v[66:67] op_sel:[1,0,0] op_sel_hi:[1,1,1] neg_lo:[0,0,0] neg_hi:[0,1,0]
v_pk_add_f32 v[64:65], v[36:37], v[68:69] neg_lo:[0,1] neg_hi:[0,1]
v_pk_add_f32 v[36:37], v[36:37], v[68:69]
v_pk_mul_f32 v[68:69], v[64:65], s[54:55] op_sel:[0,1] op_sel_hi:[0,0] neg_lo:[0,1] neg_hi:[0,1]
v_pk_fma_f32 v[68:69], v[64:65], s[54:55], v[68:69] op_sel:[1,0,0] op_sel_hi:[1,1,1] neg_lo:[0,0,0] neg_hi:[0,1,0]
v_pk_add_f32 v[64:65], v[38:39], v[70:71] neg_lo:[0,1] neg_hi:[0,1]
v_pk_add_f32 v[38:39], v[38:39], v[70:71]
v_pk_mul_f32 v[70:71], v[64:65], s[58:59] op_sel:[0,1] op_sel_hi:[0,0] neg_lo:[0,1] neg_hi:[0,1]
v_pk_fma_f32 v[70:71], v[64:65], s[58:59], v[70:71] op_sel:[1,0,0] op_sel_hi:[1,1,1] neg_lo:[0,0,0] neg_hi:[0,1,0]
v_pk_add_f32 v[64:65], v[40:41], v[72:73] neg_lo:[0,1] neg_hi:[0,1]
v_pk_add_f32 v[40:41], v[40:41], v[72:73]
v_pk_mul_f32 v[72:73], v[64:65], s[62:63] op_sel:[0,0] op_sel_hi:[0,1] neg_lo:[0,1] neg_hi:[0,1]
v_pk_fma_f32 v[72:73], v[64:65], s[62:63], v[72:73] op_sel:[1,1,0] op_sel_hi:[1,0,1] neg_lo:[0,0,0] neg_hi:[0,1,0]
v_pk_add_f32 v[64:65], v[42:43], v[74:75] neg_lo:[0,1] neg_hi:[0,1]
v_pk_add_f32 v[42:43], v[42:43], v[74:75]
v_pk_mul_f32 v[74:75], v[64:65], s[58:59] op_sel:[0,0] op_sel_hi:[0,1] neg_lo:[0,1] neg_hi:[0,1]
v_pk_fma_f32 v[74:75], v[64:65], s[58:59], v[74:75] op_sel:[1,1,0] op_sel_hi:[1,0,1] neg_lo:[0,0,0] neg_hi:[0,1,0]
v_pk_add_f32 v[64:65], v[44:45], v[76:77] neg_lo:[0,1] neg_hi:[0,1]
v_pk_add_f32 v[44:45], v[44:45], v[76:77]
v_pk_mul_f32 v[76:77], v[64:65], s[54:55] op_sel:[0,0] op_sel_hi:[0,1] neg_lo:[0,1] neg_hi:[0,1]
v_pk_fma_f32 v[76:77], v[64:65], s[54:55], v[76:77] op_sel:[1,1,0] op_sel_hi:[1,0,1] neg_lo:[0,0,0] neg_hi:[0,1,0]
v_pk_add_f32 v[64:65], v[46:47], v[78:79] neg_lo:[0,1] neg_hi:[0,1]
v_pk_add_f32 v[46:47], v[46:47], v[78:79]
v_pk_mul_f32 v[78:79], v[64:65], s[50:51] op_sel:[0,0] op_sel_hi:[0,1] neg_lo:[0,1] neg_hi:[0,1]
v_pk_fma_f32 v[78:79], v[64:65], s[50:51], v[78:79] op_sel:[1,1,0] op_sel_hi:[1,0,1] neg_lo:[0,0,0] neg_hi:[0,1,0]
v_pk_add_f32 v[64:65], v[16:17], v[32:33] neg_lo:[0,1] neg_hi:[0,1]
v_pk_add_f32 v[16:17], v[16:17], v[32:33]
v_pk_add_f32 v[32:33], v[18:19], v[34:35] neg_lo:[0,1] neg_hi:[0,1]
v_pk_add_f32 v[18:19], v[18:19], v[34:35]
v_pk_mul_f32 v[34:35], v[32:33], s[54:55] op_sel:[0,0] op_sel_hi:[0,1] neg_lo:[0,0] neg_hi:[0,1]
v_pk_fma_f32 v[34:35], v[32:33], s[54:55], v[34:35] op_sel:[1,1,0] op_sel_hi:[1,0,1] neg_lo:[0,0,0] neg_hi:[0,0,0]
v_pk_add_f32 v[32:33], v[20:21], v[36:37] neg_lo:[0,1] neg_hi:[0,1]
v_pk_add_f32 v[20:21], v[20:21], v[36:37]
v_pk_mul_f32 v[36:37], v[32:33], s[62:63] op_sel:[0,0] op_sel_hi:[0,1] neg_lo:[0,0] neg_hi:[0,1]
v_pk_fma_f32 v[36:37], v[32:33], s[62:63], v[36:37] op_sel:[1,1,0] op_sel_hi:[1,0,1] neg_lo:[0,0,0] neg_hi:[0,0,0]
v_pk_add_f32 v[32:33], v[22:23], v[38:39] neg_lo:[0,1] neg_hi:[0,1]
v_pk_add_f32 v[22:23], v[22:23], v[38:39]
v_pk_mul_f32 v[38:39], v[32:33], s[54:55] op_sel:[0,1] op_sel_hi:[0,0] neg_lo:[0,0] neg_hi:[0,1]
v_pk_fma_f32 v[38:39], v[32:33], s[54:55], v[38:39] op_sel:[1,0,0] op_sel_hi:[1,1,1] neg_lo:[0,0,0] neg_hi:[0,0,0]
v_pk_add_f32 v[32:33], v[24:25], v[40:41] op_sel:[1,1] op_sel_hi:[0,0] neg_lo:[0,1] neg_hi:[1,0]
v_pk_add_f32 v[24:25], v[24:25], v[40:41]
v_pk_add_f32 v[40:41], v[26:27], v[42:43] neg_lo:[0,1] neg_hi:[0,1]
v_pk_add_f32 v[26:27], v[26:27], v[42:43]
v_pk_mul_f32 v[42:43], v[40:41], s[54:55] op_sel:[0,1] op_sel_hi:[0,0] neg_lo:[0,1] neg_hi:[0,1]
v_pk_fma_f32 v[42:43], v[40:41], s[54:55], v[42:43] op_sel:[1,0,0] op_sel_hi:[1,1,1] neg_lo:[0,0,0] neg_hi:[0,1,0]
v_pk_add_f32 v[40:41], v[28:29], v[44:45] neg_lo:[0,1] neg_hi:[0,1]
v_pk_add_f32 v[28:29], v[28:29], v[44:45]
v_pk_mul_f32 v[44:45], v[40:41], s[62:63] op_sel:[0,0] op_sel_hi:[0,1] neg_lo:[0,1] neg_hi:[0,1]
v_pk_fma_f32 v[44:45], v[40:41], s[62:63], v[44:45] op_sel:[1,1,0] op_sel_hi:[1,0,1] neg_lo:[0,0,0] neg_hi:[0,1,0]
v_pk_add_f32 v[40:41], v[30:31], v[46:47] neg_lo:[0,1] neg_hi:[0,1]
v_pk_add_f32 v[30:31], v[30:31], v[46:47]
v_pk_mul_f32 v[46:47], v[40:41], s[54:55] op_sel:[0,0] op_sel_hi:[0,1] neg_lo:[0,1] neg_hi:[0,1]
v_pk_fma_f32 v[46:47], v[40:41], s[54:55], v[46:47] op_sel:[1,1,0] op_sel_hi:[1,0,1] neg_lo:[0,0,0] neg_hi:[0,1,0]
v_pk_add_f32 v[40:41], v[14:15], v[48:49] neg_lo:[0,1] neg_hi:[0,1]
v_pk_add_f32 v[14:15], v[14:15], v[48:49]
v_pk_add_f32 v[48:49], v[50:51], v[66:67] neg_lo:[0,1] neg_hi:[0,1]
v_pk_add_f32 v[50:51], v[50:51], v[66:67]
v_pk_mul_f32 v[66:67], v[48:49], s[54:55] op_sel:[0,0] op_sel_hi:[0,1] neg_lo:[0,0] neg_hi:[0,1]
v_pk_fma_f32 v[66:67], v[48:49], s[54:55], v[66:67] op_sel:[1,1,0] op_sel_hi:[1,0,1] neg_lo:[0,0,0] neg_hi:[0,0,0]
v_pk_add_f32 v[48:49], v[52:53], v[68:69] neg_lo:[0,1] neg_hi:[0,1]
v_pk_add_f32 v[52:53], v[52:53], v[68:69]
v_pk_mul_f32 v[68:69], v[48:49], s[62:63] op_sel:[0,0] op_sel_hi:[0,1] neg_lo:[0,0] neg_hi:[0,1]
v_pk_fma_f32 v[68:69], v[48:49], s[62:63], v[68:69] op_sel:[1,1,0] op_sel_hi:[1,0,1] neg_lo:[0,0,0] neg_hi:[0,0,0]
v_pk_add_f32 v[48:49], v[54:55], v[70:71] neg_lo:[0,1] neg_hi:[0,1]
v_pk_add_f32 v[54:55], v[54:55], v[70:71]
v_pk_mul_f32 v[70:71], v[48:49], s[54:55] op_sel:[0,1] op_sel_hi:[0,0] neg_lo:[0,0] neg_hi:[0,1]
v_pk_fma_f32 v[70:71], v[48:49], s[54:55], v[70:71] op_sel:[1,0,0] op_sel_hi:[1,1,1] neg_lo:[0,0,0] neg_hi:[0,0,0]
v_pk_add_f32 v[48:49], v[56:57], v[72:73] op_sel:[1,1] op_sel_hi:[0,0] neg_lo:[0,1] neg_hi:[1,0]
v_pk_add_f32 v[56:57], v[56:57], v[72:73]
v_pk_add_f32 v[72:73], v[58:59], v[74:75] neg_lo:[0,1] neg_hi:[0,1]
v_pk_add_f32 v[58:59], v[58:59], v[74:75]
v_pk_mul_f32 v[74:75], v[72:73], s[54:55] op_sel:[0,1] op_sel_hi:[0,0] neg_lo:[0,1] neg_hi:[0,1]
v_pk_fma_f32 v[74:75], v[72:73], s[54:55], v[74:75] op_sel:[1,0,0] op_sel_hi:[1,1,1] neg_lo:[0,0,0] neg_hi:[0,1,0]
v_pk_add_f32 v[72:73], v[60:61], v[76:77] neg_lo:[0,1] neg_hi:[0,1]
v_pk_add_f32 v[60:61], v[60:61], v[76:77]
v_pk_mul_f32 v[76:77], v[72:73], s[62:63] op_sel:[0,0] op_sel_hi:[0,1] neg_lo:[0,1] neg_hi:[0,1]
v_pk_fma_f32 v[76:77], v[72:73], s[62:63], v[76:77] op_sel:[1,1,0] op_sel_hi:[1,0,1] neg_lo:[0,0,0] neg_hi:[0,1,0]
v_pk_add_f32 v[72:73], v[62:63], v[78:79] neg_lo:[0,1] neg_hi:[0,1]
v_pk_add_f32 v[62:63], v[62:63], v[78:79]
v_pk_mul_f32 v[78:79], v[72:73], s[54:55] op_sel:[0,0] op_sel_hi:[0,1] neg_lo:[0,1] neg_hi:[0,1]
v_pk_fma_f32 v[78:79], v[72:73], s[54:55], v[78:79] op_sel:[1,1,0] op_sel_hi:[1,0,1] neg_lo:[0,0,0] neg_hi:[0,1,0]
v_pk_add_f32 v[72:73], v[16:17], v[24:25] neg_lo:[0,1] neg_hi:[0,1]
v_pk_add_f32 v[16:17], v[16:17], v[24:25]
v_pk_add_f32 v[24:25], v[18:19], v[26:27] neg_lo:[0,1] neg_hi:[0,1]
v_pk_add_f32 v[18:19], v[18:19], v[26:27]
v_pk_mul_f32 v[26:27], v[24:25], s[62:63] op_sel:[0,0] op_sel_hi:[0,1] neg_lo:[0,0] neg_hi:[0,1]
v_pk_fma_f32 v[26:27], v[24:25], s[62:63], v[26:27] op_sel:[1,1,0] op_sel_hi:[1,0,1] neg_lo:[0,0,0] neg_hi:[0,0,0]
v_pk_add_f32 v[24:25], v[20:21], v[28:29] op_sel:[1,1] op_sel_hi:[0,0] neg_lo:[0,1] neg_hi:[1,0]
v_pk_add_f32 v[20:21], v[20:21], v[28:29]
v_pk_add_f32 v[28:29], v[22:23], v[30:31] neg_lo:[0,1] neg_hi:[0,1]
v_pk_add_f32 v[22:23], v[22:23], v[30:31]
v_pk_mul_f32 v[30:31], v[28:29], s[62:63] op_sel:[0,0] op_sel_hi:[0,1] neg_lo:[0,1] neg_hi:[0,1]
v_pk_fma_f32 v[30:31], v[28:29], s[62:63], v[30:31] op_sel:[1,1,0] op_sel_hi:[1,0,1] neg_lo:[0,0,0] neg_hi:[0,1,0]
v_pk_add_f32 v[28:29], v[64:65], v[32:33] neg_lo:[0,1] neg_hi:[0,1]
v_pk_add_f32 v[64:65], v[64:65], v[32:33]
v_pk_add_f32 v[32:33], v[34:35], v[42:43] neg_lo:[0,1] neg_hi:[0,1]
v_pk_add_f32 v[34:35], v[34:35], v[42:43]
v_pk_mul_f32 v[42:43], v[32:33], s[62:63] op_sel:[0,0] op_sel_hi:[0,1] neg_lo:[0,0] neg_hi:[0,1]
v_pk_fma_f32 v[42:43], v[32:33], s[62:63], v[42:43] op_sel:[1,1,0] op_sel_hi:[1,0,1] neg_lo:[0,0,0] neg_hi:[0,0,0]
v_pk_add_f32 v[32:33], v[36:37], v[44:45] op_sel:[1,1] op_sel_hi:[0,0] neg_lo:[0,1] neg_hi:[1,0]
v_pk_add_f32 v[36:37], v[36:37], v[44:45]
v_pk_add_f32 v[44:45], v[38:39], v[46:47] neg_lo:[0,1] neg_hi:[0,1]
v_pk_add_f32 v[38:39], v[38:39], v[46:47]
v_pk_mul_f32 v[46:47], v[44:45], s[62:63] op_sel:[0,0] op_sel_hi:[0,1] neg_lo:[0,1] neg_hi:[0,1]
v_pk_fma_f32 v[46:47], v[44:45], s[62:63], v[46:47] op_sel:[1,1,0] op_sel_hi:[1,0,1] neg_lo:[0,0,0] neg_hi:[0,1,0]
v_pk_add_f32 v[44:45], v[14:15], v[56:57] neg_lo:[0,1] neg_hi:[0,1]
v_pk_add_f32 v[14:15], v[14:15], v[56:57]
v_pk_add_f32 v[56:57], v[50:51], v[58:59] neg_lo:[0,1] neg_hi:[0,1]
v_pk_add_f32 v[50:51], v[50:51], v[58:59]
v_pk_mul_f32 v[58:59], v[56:57], s[62:63] op_sel:[0,0] op_sel_hi:[0,1] neg_lo:[0,0] neg_hi:[0,1]
v_pk_fma_f32 v[58:59], v[56:57], s[62:63], v[58:59] op_sel:[1,1,0] op_sel_hi:[1,0,1] neg_lo:[0,0,0] neg_hi:[0,0,0]
v_pk_add_f32 v[56:57], v[52:53], v[60:61] op_sel:[1,1] op_sel_hi:[0,0] neg_lo:[0,1] neg_hi:[1,0]
v_pk_add_f32 v[52:53], v[52:53], v[60:61]
v_pk_add_f32 v[60:61], v[54:55], v[62:63] neg_lo:[0,1] neg_hi:[0,1]
v_pk_add_f32 v[54:55], v[54:55], v[62:63]
v_pk_mul_f32 v[62:63], v[60:61], s[62:63] op_sel:[0,0] op_sel_hi:[0,1] neg_lo:[0,1] neg_hi:[0,1]
v_pk_fma_f32 v[62:63], v[60:61], s[62:63], v[62:63] op_sel:[1,1,0] op_sel_hi:[1,0,1] neg_lo:[0,0,0] neg_hi:[0,1,0]
v_pk_add_f32 v[60:61], v[40:41], v[48:49] neg_lo:[0,1] neg_hi:[0,1]
v_pk_add_f32 v[40:41], v[40:41], v[48:49]
v_pk_add_f32 v[48:49], v[66:67], v[74:75] neg_lo:[0,1] neg_hi:[0,1]
v_pk_add_f32 v[66:67], v[66:67], v[74:75]
v_pk_mul_f32 v[74:75], v[48:49], s[62:63] op_sel:[0,0] op_sel_hi:[0,1] neg_lo:[0,0] neg_hi:[0,1]
v_pk_fma_f32 v[74:75], v[48:49], s[62:63], v[74:75] op_sel:[1,1,0] op_sel_hi:[1,0,1] neg_lo:[0,0,0] neg_hi:[0,0,0]
v_pk_add_f32 v[48:49], v[68:69], v[76:77] op_sel:[1,1] op_sel_hi:[0,0] neg_lo:[0,1] neg_hi:[1,0]
v_pk_add_f32 v[68:69], v[68:69], v[76:77]
v_pk_add_f32 v[76:77], v[70:71], v[78:79] neg_lo:[0,1] neg_hi:[0,1]
v_pk_add_f32 v[70:71], v[70:71], v[78:79]
v_pk_mul_f32 v[78:79], v[76:77], s[62:63] op_sel:[0,0] op_sel_hi:[0,1] neg_lo:[0,1] neg_hi:[0,1]
v_pk_fma_f32 v[78:79], v[76:77], s[62:63], v[78:79] op_sel:[1,1,0] op_sel_hi:[1,0,1] neg_lo:[0,0,0] neg_hi:[0,1,0]
v_pk_add_f32 v[76:77], v[16:17], v[20:21] neg_lo:[0,1] neg_hi:[0,1]
v_pk_add_f32 v[16:17], v[16:17], v[20:21]
v_pk_add_f32 v[20:21], v[18:19], v[22:23] op_sel:[1,1] op_sel_hi:[0,0] neg_lo:[0,1] neg_hi:[1,0]
v_pk_add_f32 v[18:19], v[18:19], v[22:23]
v_pk_add_f32 v[22:23], v[72:73], v[24:25] neg_lo:[0,1] neg_hi:[0,1]
v_pk_add_f32 v[72:73], v[72:73], v[24:25]
v_pk_add_f32 v[24:25], v[26:27], v[30:31] op_sel:[1,1] op_sel_hi:[0,0] neg_lo:[0,1] neg_hi:[1,0]
v_pk_add_f32 v[26:27], v[26:27], v[30:31]
v_pk_add_f32 v[30:31], v[64:65], v[36:37] neg_lo:[0,1] neg_hi:[0,1]
v_pk_add_f32 v[64:65], v[64:65], v[36:37]
v_pk_add_f32 v[36:37], v[34:35], v[38:39] op_sel:[1,1] op_sel_hi:[0,0] neg_lo:[0,1] neg_hi:[1,0]
v_pk_add_f32 v[34:35], v[34:35], v[38:39]
v_pk_add_f32 v[38:39], v[28:29], v[32:33] neg_lo:[0,1] neg_hi:[0,1]
v_pk_add_f32 v[28:29], v[28:29], v[32:33]
v_pk_add_f32 v[32:33], v[42:43], v[46:47] op_sel:[1,1] op_sel_hi:[0,0] neg_lo:[0,1] neg_hi:[1,0]
v_pk_add_f32 v[42:43], v[42:43], v[46:47]
v_pk_add_f32 v[46:47], v[14:15], v[52:53] neg_lo:[0,1] neg_hi:[0,1]
v_pk_add_f32 v[14:15], v[14:15], v[52:53]
v_pk_add_f32 v[52:53], v[50:51], v[54:55] op_sel:[1,1] op_sel_hi:[0,0] neg_lo:[0,1] neg_hi:[1,0]
v_pk_add_f32 v[50:51], v[50:51], v[54:55]
v_pk_add_f32 v[54:55], v[44:45], v[56:57] neg_lo:[0,1] neg_hi:[0,1]
v_pk_add_f32 v[44:45], v[44:45], v[56:57]
v_pk_add_f32 v[56:57], v[58:59], v[62:63] op_sel:[1,1] op_sel_hi:[0,0] neg_lo:[0,1] neg_hi:[1,0]
v_pk_add_f32 v[58:59], v[58:59], v[62:63]
v_pk_add_f32 v[62:63], v[40:41], v[68:69] neg_lo:[0,1] neg_hi:[0,1]
v_pk_add_f32 v[40:41], v[40:41], v[68:69]
v_pk_add_f32 v[68:69], v[66:67], v[70:71] op_sel:[1,1] op_sel_hi:[0,0] neg_lo:[0,1] neg_hi:[1,0]
v_pk_add_f32 v[66:67], v[66:67], v[70:71]
v_pk_add_f32 v[70:71], v[60:61], v[48:49] neg_lo:[0,1] neg_hi:[0,1]
v_pk_add_f32 v[60:61], v[60:61], v[48:49]
v_pk_add_f32 v[48:49], v[74:75], v[78:79] op_sel:[1,1] op_sel_hi:[0,0] neg_lo:[0,1] neg_hi:[1,0]
v_pk_add_f32 v[74:75], v[74:75], v[78:79]
v_pk_add_f32 v[78:79], v[16:17], v[18:19] neg_lo:[0,1] neg_hi:[0,1]
v_pk_add_f32 v[16:17], v[16:17], v[18:19]
v_pk_add_f32 v[18:19], v[76:77], v[20:21] neg_lo:[0,1] neg_hi:[0,1]
v_pk_add_f32 v[76:77], v[76:77], v[20:21]
v_pk_add_f32 v[20:21], v[72:73], v[26:27] neg_lo:[0,1] neg_hi:[0,1]
v_pk_add_f32 v[72:73], v[72:73], v[26:27]
v_pk_add_f32 v[26:27], v[22:23], v[24:25] neg_lo:[0,1] neg_hi:[0,1]
v_pk_add_f32 v[22:23], v[22:23], v[24:25]
v_pk_add_f32 v[24:25], v[64:65], v[34:35] neg_lo:[0,1] neg_hi:[0,1]
v_pk_add_f32 v[64:65], v[64:65], v[34:35]
v_pk_add_f32 v[34:35], v[30:31], v[36:37] neg_lo:[0,1] neg_hi:[0,1]
v_pk_add_f32 v[30:31], v[30:31], v[36:37]
v_pk_add_f32 v[36:37], v[28:29], v[42:43] neg_lo:[0,1] neg_hi:[0,1]
v_pk_add_f32 v[28:29], v[28:29], v[42:43]
v_pk_add_f32 v[42:43], v[38:39], v[32:33] neg_lo:[0,1] neg_hi:[0,1]
v_pk_add_f32 v[38:39], v[38:39], v[32:33]
v_pk_add_f32 v[32:33], v[14:15], v[50:51] neg_lo:[0,1] neg_hi:[0,1]
v_pk_add_f32 v[14:15], v[14:15], v[50:51]
v_pk_add_f32 v[50:51], v[46:47], v[52:53] neg_lo:[0,1] neg_hi:[0,1]
v_pk_add_f32 v[46:47], v[46:47], v[52:53]
v_pk_add_f32 v[52:53], v[44:45], v[58:59] neg_lo:[0,1] neg_hi:[0,1]
v_pk_add_f32 v[44:45], v[44:45], v[58:59]
v_pk_add_f32 v[58:59], v[54:55], v[56:57] neg_lo:[0,1] neg_hi:[0,1]
v_pk_add_f32 v[54:55], v[54:55], v[56:57]
v_pk_add_f32 v[56:57], v[40:41], v[66:67] neg_lo:[0,1] neg_hi:[0,1]
v_pk_add_f32 v[40:41], v[40:41], v[66:67]
v_pk_add_f32 v[66:67], v[62:63], v[68:69] neg_lo:[0,1] neg_hi:[0,1]
v_pk_add_f32 v[62:63], v[62:63], v[68:69]
v_pk_add_f32 v[68:69], v[60:61], v[74:75] neg_lo:[0,1] neg_hi:[0,1]
v_pk_add_f32 v[60:61], v[60:61], v[74:75]
v_pk_add_f32 v[74:75], v[70:71], v[48:49] neg_lo:[0,1] neg_hi:[0,1]
v_pk_add_f32 v[70:71], v[70:71], v[48:49]
s_mov_b64 exec, s[18:19]
v_pk_add_f32 v[16:17], v[16:17], 0 neg_lo:[1,0] neg_hi:[1,0]
v_pk_mul_f32 v[48:49], v[14:15], s[48:49] op_sel:[0,0] op_sel_hi:[0,1] neg_lo:[0,1] neg_hi:[0,0]
v_pk_fma_f32 v[14:15], v[14:15], s[48:49], v[48:49] op_sel:[1,1,0] op_sel_hi:[1,0,1] neg_lo:[0,1,0] neg_hi:[0,1,0]
v_pk_mul_f32 v[48:49], v[64:65], s[50:51] op_sel:[0,0] op_sel_hi:[0,1] neg_lo:[0,1] neg_hi:[0,0]
v_pk_fma_f32 v[64:65], v[64:65], s[50:51], v[48:49] op_sel:[1,1,0] op_sel_hi:[1,0,1] neg_lo:[0,1,0] neg_hi:[0,1,0]
v_pk_mul_f32 v[48:49], v[40:41], s[52:53] op_sel:[0,0] op_sel_hi:[0,1] neg_lo:[0,1] neg_hi:[0,0]
v_pk_fma_f32 v[40:41], v[40:41], s[52:53], v[48:49] op_sel:[1,1,0] op_sel_hi:[1,0,1] neg_lo:[0,1,0] neg_hi:[0,1,0]
v_pk_mul_f32 v[48:49], v[72:73], s[54:55] op_sel:[0,0] op_sel_hi:[0,1] neg_lo:[0,1] neg_hi:[0,0]
v_pk_fma_f32 v[72:73], v[72:73], s[54:55], v[48:49] op_sel:[1,1,0] op_sel_hi:[1,0,1] neg_lo:[0,1,0] neg_hi:[0,1,0]
v_pk_mul_f32 v[48:49], v[44:45], s[56:57] op_sel:[0,0] op_sel_hi:[0,1] neg_lo:[0,1] neg_hi:[0,0]
v_pk_fma_f32 v[44:45], v[44:45], s[56:57], v[48:49] op_sel:[1,1,0] op_sel_hi:[1,0,1] neg_lo:[0,1,0] neg_hi:[0,1,0]
v_pk_mul_f32 v[48:49], v[28:29], s[58:59] op_sel:[0,0] op_sel_hi:[0,1] neg_lo:[0,1] neg_hi:[0,0]
v_pk_fma_f32 v[28:29], v[28:29], s[58:59], v[48:49] op_sel:[1,1,0] op_sel_hi:[1,0,1] neg_lo:[0,1,0] neg_hi:[0,1,0]
v_pk_mul_f32 v[48:49], v[60:61], s[60:61] op_sel:[0,0] op_sel_hi:[0,1] neg_lo:[0,1] neg_hi:[0,0]
v_pk_fma_f32 v[60:61], v[60:61], s[60:61], v[48:49] op_sel:[1,1,0] op_sel_hi:[1,0,1] neg_lo:[0,1,0] neg_hi:[0,1,0]
v_pk_mul_f32 v[48:49], v[76:77], s[62:63] op_sel:[0,0] op_sel_hi:[0,1] neg_lo:[0,1] neg_hi:[0,0]
v_pk_fma_f32 v[76:77], v[76:77], s[62:63], v[48:49] op_sel:[1,1,0] op_sel_hi:[1,0,1] neg_lo:[0,1,0] neg_hi:[0,1,0]
v_pk_mul_f32 v[48:49], v[46:47], s[60:61] op_sel:[0,1] op_sel_hi:[0,0] neg_lo:[0,1] neg_hi:[0,0]
v_pk_fma_f32 v[46:47], v[46:47], s[60:61], v[48:49] op_sel:[1,0,0] op_sel_hi:[1,1,1] neg_lo:[0,1,0] neg_hi:[0,1,0]
v_pk_mul_f32 v[48:49], v[30:31], s[58:59] op_sel:[0,1] op_sel_hi:[0,0] neg_lo:[0,1] neg_hi:[0,0]
v_pk_fma_f32 v[30:31], v[30:31], s[58:59], v[48:49] op_sel:[1,0,0] op_sel_hi:[1,1,1] neg_lo:[0,1,0] neg_hi:[0,1,0]
v_pk_mul_f32 v[48:49], v[62:63], s[56:57] op_sel:[0,1] op_sel_hi:[0,0] neg_lo:[0,1] neg_hi:[0,0]
v_pk_fma_f32 v[62:63], v[62:63], s[56:57], v[48:49] op_sel:[1,0,0] op_sel_hi:[1,1,1] neg_lo:[0,1,0] neg_hi:[0,1,0]
v_pk_mul_f32 v[48:49], v[22:23], s[54:55] op_sel:[0,1] op_sel_hi:[0,0] neg_lo:[0,1] neg_hi:[0,0]
v_pk_fma_f32 v[22:23], v[22:23], s[54:55], v[48:49] op_sel:[1,0,0] op_sel_hi:[1,1,1] neg_lo:[0,1,0] neg_hi:[0,1,0]
v_pk_mul_f32 v[48:49], v[54:55], s[52:53] op_sel:[0,1] op_sel_hi:[0,0] neg_lo:[0,1] neg_hi:[0,0]
v_pk_fma_f32 v[54:55], v[54:55], s[52:53], v[48:49] op_sel:[1,0,0] op_sel_hi:[1,1,1] neg_lo:[0,1,0] neg_hi:[0,1,0]
v_pk_mul_f32 v[48:49], v[38:39], s[50:51] op_sel:[0,1] op_sel_hi:[0,0] neg_lo:[0,1] neg_hi:[0,0]
v_pk_fma_f32 v[38:39], v[38:39], s[50:51], v[48:49] op_sel:[1,0,0] op_sel_hi:[1,1,1] neg_lo:[0,1,0] neg_hi:[0,1,0]
v_pk_mul_f32 v[48:49], v[70:71], s[48:49] op_sel:[0,1] op_sel_hi:[0,0] neg_lo:[0,1] neg_hi:[0,0]
v_pk_fma_f32 v[70:71], v[70:71], s[48:49], v[48:49] op_sel:[1,0,0] op_sel_hi:[1,1,1] neg_lo:[0,1,0] neg_hi:[0,1,0]
v_pk_add_f32 v[78:79], v[78:79], 0 op_sel:[1,0] op_sel_hi:[0,0] neg_lo:[1,0] neg_hi:[0,0]
v_pk_mul_f32 v[48:49], v[32:33], s[48:49] op_sel:[0,1] op_sel_hi:[0,0] neg_lo:[0,0] neg_hi:[0,0]
v_pk_fma_f32 v[32:33], v[32:33], s[48:49], v[48:49] op_sel:[1,0,0] op_sel_hi:[1,1,1] neg_lo:[0,1,0] neg_hi:[0,0,0]
v_pk_mul_f32 v[48:49], v[24:25], s[50:51] op_sel:[0,1] op_sel_hi:[0,0] neg_lo:[0,0] neg_hi:[0,0]
v_pk_fma_f32 v[24:25], v[24:25], s[50:51], v[48:49] op_sel:[1,0,0] op_sel_hi:[1,1,1] neg_lo:[0,1,0] neg_hi:[0,0,0]
v_pk_mul_f32 v[48:49], v[56:57], s[52:53] op_sel:[0,1] op_sel_hi:[0,0] neg_lo:[0,0] neg_hi:[0,0]
v_pk_fma_f32 v[56:57], v[56:57], s[52:53], v[48:49] op_sel:[1,0,0] op_sel_hi:[1,1,1] neg_lo:[0,1,0] neg_hi:[0,0,0]
v_pk_mul_f32 v[48:49], v[20:21], s[54:55] op_sel:[0,1] op_sel_hi:[0,0] neg_lo:[0,0] neg_hi:[0,0]
v_pk_fma_f32 v[20:21], v[20:21], s[54:55], v[48:49] op_sel:[1,0,0] op_sel_hi:[1,1,1] neg_lo:[0,1,0] neg_hi:[0,0,0]
v_pk_mul_f32 v[48:49], v[52:53], s[56:57] op_sel:[0,1] op_sel_hi:[0,0] neg_lo:[0,0] neg_hi:[0,0]
v_pk_fma_f32 v[52:53], v[52:53], s[56:57], v[48:49] op_sel:[1,0,0] op_sel_hi:[1,1,1] neg_lo:[0,1,0] neg_hi:[0,0,0]
v_pk_mul_f32 v[48:49], v[36:37], s[58:59] op_sel:[0,1] op_sel_hi:[0,0] neg_lo:[0,0] neg_hi:[0,0]
v_pk_fma_f32 v[36:37], v[36:37], s[58:59], v[48:49] op_sel:[1,0,0] op_sel_hi:[1,1,1] neg_lo:[0,1,0] neg_hi:[0,0,0]
v_pk_mul_f32 v[48:49], v[68:69], s[60:61] op_sel:[0,1] op_sel_hi:[0,0] neg_lo:[0,0] neg_hi:[0,0]
v_pk_fma_f32 v[68:69], v[68:69], s[60:61], v[48:49] op_sel:[1,0,0] op_sel_hi:[1,1,1] neg_lo:[0,1,0] neg_hi:[0,0,0]
v_pk_mul_f32 v[48:49], v[18:19], s[62:63] op_sel:[0,0] op_sel_hi:[0,1] neg_lo:[0,0] neg_hi:[0,0]
v_pk_fma_f32 v[18:19], v[18:19], s[62:63], v[48:49] op_sel:[1,1,0] op_sel_hi:[1,0,1] neg_lo:[0,1,0] neg_hi:[0,0,0]
v_pk_mul_f32 v[48:49], v[50:51], s[60:61] op_sel:[0,0] op_sel_hi:[0,1] neg_lo:[0,0] neg_hi:[0,0]
v_pk_fma_f32 v[50:51], v[50:51], s[60:61], v[48:49] op_sel:[1,1,0] op_sel_hi:[1,0,1] neg_lo:[0,1,0] neg_hi:[0,0,0]
v_pk_mul_f32 v[48:49], v[34:35], s[58:59] op_sel:[0,0] op_sel_hi:[0,1] neg_lo:[0,0] neg_hi:[0,0]
v_pk_fma_f32 v[34:35], v[34:35], s[58:59], v[48:49] op_sel:[1,1,0] op_sel_hi:[1,0,1] neg_lo:[0,1,0] neg_hi:[0,0,0]
v_pk_mul_f32 v[48:49], v[66:67], s[56:57] op_sel:[0,0] op_sel_hi:[0,1] neg_lo:[0,0] neg_hi:[0,0]
v_pk_fma_f32 v[66:67], v[66:67], s[56:57], v[48:49] op_sel:[1,1,0] op_sel_hi:[1,0,1] neg_lo:[0,1,0] neg_hi:[0,0,0]
v_pk_mul_f32 v[48:49], v[26:27], s[54:55] op_sel:[0,0] op_sel_hi:[0,1] neg_lo:[0,0] neg_hi:[0,0]
v_pk_fma_f32 v[26:27], v[26:27], s[54:55], v[48:49] op_sel:[1,1,0] op_sel_hi:[1,0,1] neg_lo:[0,1,0] neg_hi:[0,0,0]
v_pk_mul_f32 v[48:49], v[58:59], s[52:53] op_sel:[0,0] op_sel_hi:[0,1] neg_lo:[0,0] neg_hi:[0,0]
v_pk_fma_f32 v[58:59], v[58:59], s[52:53], v[48:49] op_sel:[1,1,0] op_sel_hi:[1,0,1] neg_lo:[0,1,0] neg_hi:[0,0,0]
v_pk_mul_f32 v[48:49], v[42:43], s[50:51] op_sel:[0,0] op_sel_hi:[0,1] neg_lo:[0,0] neg_hi:[0,0]
v_pk_fma_f32 v[42:43], v[42:43], s[50:51], v[48:49] op_sel:[1,1,0] op_sel_hi:[1,0,1] neg_lo:[0,1,0] neg_hi:[0,0,0]
v_pk_mul_f32 v[48:49], v[74:75], s[48:49] op_sel:[0,0] op_sel_hi:[0,1] neg_lo:[0,0] neg_hi:[0,0]
v_pk_fma_f32 v[74:75], v[74:75], s[48:49], v[48:49] op_sel:[1,1,0] op_sel_hi:[1,0,1] neg_lo:[0,1,0] neg_hi:[0,0,0]
s_mov_b64 exec, -1
v_fmac_f32_dpp v16, v16, v9 quad_perm:[1,0,3,2] row_mask:0xf bank_mask:0xf
v_fmac_f32_dpp v17, v17, v9 quad_perm:[1,0,3,2] row_mask:0xf bank_mask:0xf
v_fmac_f32_dpp v14, v14, v9 quad_perm:[1,0,3,2] row_mask:0xf bank_mask:0xf
v_fmac_f32_dpp v15, v15, v9 quad_perm:[1,0,3,2] row_mask:0xf bank_mask:0xf
v_fmac_f32_dpp v64, v64, v9 quad_perm:[1,0,3,2] row_mask:0xf bank_mask:0xf
v_fmac_f32_dpp v65, v65, v9 quad_perm:[1,0,3,2] row_mask:0xf bank_mask:0xf
v_fmac_f32_dpp v40, v40, v9 quad_perm:[1,0,3,2] row_mask:0xf bank_mask:0xf
v_fmac_f32_dpp v41, v41, v9 quad_perm:[1,0,3,2] row_mask:0xf bank_mask:0xf
v_fmac_f32_dpp v72, v72, v9 quad_perm:[1,0,3,2] row_mask:0xf bank_mask:0xf
v_fmac_f32_dpp v73, v73, v9 quad_perm:[1,0,3,2] row_mask:0xf bank_mask:0xf
v_fmac_f32_dpp v44, v44, v9 quad_perm:[1,0,3,2] row_mask:0xf bank_mask:0xf
v_fmac_f32_dpp v45, v45, v9 quad_perm:[1,0,3,2] row_mask:0xf bank_mask:0xf
v_fmac_f32_dpp v28, v28, v9 quad_perm:[1,0,3,2] row_mask:0xf bank_mask:0xf
v_fmac_f32_dpp v29, v29, v9 quad_perm:[1,0,3,2] row_mask:0xf bank_mask:0xf
v_fmac_f32_dpp v60, v60, v9 quad_perm:[1,0,3,2] row_mask:0xf bank_mask:0xf
v_fmac_f32_dpp v61, v61, v9 quad_perm:[1,0,3,2] row_mask:0xf bank_mask:0xf
v_fmac_f32_dpp v76, v76, v9 quad_perm:[1,0,3,2] row_mask:0xf bank_mask:0xf
v_fmac_f32_dpp v77, v77, v9 quad_perm:[1,0,3,2] row_mask:0xf bank_mask:0xf
v_fmac_f32_dpp v46, v46, v9 quad_perm:[1,0,3,2] row_mask:0xf bank_mask:0xf
v_fmac_f32_dpp v47, v47, v9 quad_perm:[1,0,3,2] row_mask:0xf bank_mask:0xf
v_fmac_f32_dpp v30, v30, v9 quad_perm:[1,0,3,2] row_mask:0xf bank_mask:0xf
v_fmac_f32_dpp v31, v31, v9 quad_perm:[1,0,3,2] row_mask:0xf bank_mask:0xf
v_fmac_f32_dpp v62, v62, v9 quad_perm:[1,0,3,2] row_mask:0xf bank_mask:0xf
v_fmac_f32_dpp v63, v63, v9 quad_perm:[1,0,3,2] row_mask:0xf bank_mask:0xf
v_fmac_f32_dpp v22, v22, v9 quad_perm:[1,0,3,2] row_mask:0xf bank_mask:0xf
v_fmac_f32_dpp v23, v23, v9 quad_perm:[1,0,3,2] row_mask:0xf bank_mask:0xf
v_fmac_f32_dpp v54, v54, v9 quad_perm:[1,0,3,2] row_mask:0xf bank_mask:0xf
v_fmac_f32_dpp v55, v55, v9 quad_perm:[1,0,3,2] row_mask:0xf bank_mask:0xf
v_fmac_f32_dpp v38, v38, v9 quad_perm:[1,0,3,2] row_mask:0xf bank_mask:0xf
v_fmac_f32_dpp v39, v39, v9 quad_perm:[1,0,3,2] row_mask:0xf bank_mask:0xf
v_fmac_f32_dpp v70, v70, v9 quad_perm:[1,0,3,2] row_mask:0xf bank_mask:0xf
v_fmac_f32_dpp v71, v71, v9 quad_perm:[1,0,3,2] row_mask:0xf bank_mask:0xf
v_fmac_f32_dpp v78, v78, v9 quad_perm:[1,0,3,2] row_mask:0xf bank_mask:0xf
v_fmac_f32_dpp v79, v79, v9 quad_perm:[1,0,3,2] row_mask:0xf bank_mask:0xf
v_fmac_f32_dpp v32, v32, v9 quad_perm:[1,0,3,2] row_mask:0xf bank_mask:0xf
v_fmac_f32_dpp v33, v33, v9 quad_perm:[1,0,3,2] row_mask:0xf bank_mask:0xf
v_fmac_f32_dpp v24, v24, v9 quad_perm:[1,0,3,2] row_mask:0xf bank_mask:0xf
v_fmac_f32_dpp v25, v25, v9 quad_perm:[1,0,3,2] row_mask:0xf bank_mask:0xf
v_fmac_f32_dpp v56, v56, v9 quad_perm:[1,0,3,2] row_mask:0xf bank_mask:0xf
v_fmac_f32_dpp v57, v57, v9 quad_perm:[1,0,3,2] row_mask:0xf bank_mask:0xf
v_fmac_f32_dpp v20, v20, v9 quad_perm:[1,0,3,2] row_mask:0xf bank_mask:0xf
v_fmac_f32_dpp v21, v21, v9 quad_perm:[1,0,3,2] row_mask:0xf bank_mask:0xf
v_fmac_f32_dpp v52, v52, v9 quad_perm:[1,0,3,2] row_mask:0xf bank_mask:0xf
v_fmac_f32_dpp v53, v53, v9 quad_perm:[1,0,3,2] row_mask:0xf bank_mask:0xf
v_fmac_f32_dpp v36, v36, v9 quad_perm:[1,0,3,2] row_mask:0xf bank_mask:0xf
v_fmac_f32_dpp v37, v37, v9 quad_perm:[1,0,3,2] row_mask:0xf bank_mask:0xf
v_fmac_f32_dpp v68, v68, v9 quad_perm:[1,0,3,2] row_mask:0xf bank_mask:0xf
v_fmac_f32_dpp v69, v69, v9 quad_perm:[1,0,3,2] row_mask:0xf bank_mask:0xf
v_fmac_f32_dpp v18, v18, v9 quad_perm:[1,0,3,2] row_mask:0xf bank_mask:0xf
v_fmac_f32_dpp v19, v19, v9 quad_perm:[1,0,3,2] row_mask:0xf bank_mask:0xf
v_fmac_f32_dpp v50, v50, v9 quad_perm:[1,0,3,2] row_mask:0xf bank_mask:0xf
v_fmac_f32_dpp v51, v51, v9 quad_perm:[1,0,3,2] row_mask:0xf bank_mask:0xf
v_fmac_f32_dpp v34, v34, v9 quad_perm:[1,0,3,2] row_mask:0xf bank_mask:0xf
v_fmac_f32_dpp v35, v35, v9 quad_perm:[1,0,3,2] row_mask:0xf bank_mask:0xf
v_fmac_f32_dpp v66, v66, v9 quad_perm:[1,0,3,2] row_mask:0xf bank_mask:0xf
v_fmac_f32_dpp v67, v67, v9 quad_perm:[1,0,3,2] row_mask:0xf bank_mask:0xf
v_fmac_f32_dpp v26, v26, v9 quad_perm:[1,0,3,2] row_mask:0xf bank_mask:0xf
v_fmac_f32_dpp v27, v27, v9 quad_perm:[1,0,3,2] row_mask:0xf bank_mask:0xf
v_fmac_f32_dpp v58, v58, v9 quad_perm:[1,0,3,2] row_mask:0xf bank_mask:0xf
v_fmac_f32_dpp v59, v59, v9 quad_perm:[1,0,3,2] row_mask:0xf bank_mask:0xf
v_fmac_f32_dpp v42, v42, v9 quad_perm:[1,0,3,2] row_mask:0xf bank_mask:0xf
v_fmac_f32_dpp v43, v43, v9 quad_perm:[1,0,3,2] row_mask:0xf bank_mask:0xf
v_fmac_f32_dpp v74, v74, v9 quad_perm:[1,0,3,2] row_mask:0xf bank_mask:0xf
v_fmac_f32_dpp v75, v75, v9 quad_perm:[1,0,3,2] row_mask:0xf bank_mask:0xf
v_lshlrev_b32 v240, 16, v208
v_and_b32 v241, 0xffff0000, v208
v_pk_mul_f32 v[48:49], v[16:17], v[240:241] op_sel:[0,0] op_sel_hi:[0,1] neg_lo:[0,0] neg_hi:[0,0]
v_pk_fma_f32 v[16:17], v[16:17], v[240:241], v[48:49] op_sel:[1,1,0] op_sel_hi:[1,0,1] neg_lo:[0,1,0] neg_hi:[0,0,0]
v_lshlrev_b32 v240, 16, v209
v_and_b32 v241, 0xffff0000, v209
v_pk_mul_f32 v[48:49], v[14:15], v[240:241] op_sel:[0,0] op_sel_hi:[0,1] neg_lo:[0,0] neg_hi:[0,0]
v_pk_fma_f32 v[14:15], v[14:15], v[240:241], v[48:49] op_sel:[1,1,0] op_sel_hi:[1,0,1] neg_lo:[0,1,0] neg_hi:[0,0,0]
v_lshlrev_b32 v240, 16, v210
v_and_b32 v241, 0xffff0000, v210
v_pk_mul_f32 v[48:49], v[64:65], v[240:241] op_sel:[0,0] op_sel_hi:[0,1] neg_lo:[0,0] neg_hi:[0,0]
v_pk_fma_f32 v[64:65], v[64:65], v[240:241], v[48:49] op_sel:[1,1,0] op_sel_hi:[1,0,1] neg_lo:[0,1,0] neg_hi:[0,0,0]
v_lshlrev_b32 v240, 16, v211
v_and_b32 v241, 0xffff0000, v211
v_pk_mul_f32 v[48:49], v[40:41], v[240:241] op_sel:[0,0] op_sel_hi:[0,1] neg_lo:[0,0] neg_hi:[0,0]
v_pk_fma_f32 v[40:41], v[40:41], v[240:241], v[48:49] op_sel:[1,1,0] op_sel_hi:[1,0,1] neg_lo:[0,1,0] neg_hi:[0,0,0]
v_lshlrev_b32 v240, 16, v212
v_and_b32 v241, 0xffff0000, v212
v_pk_mul_f32 v[48:49], v[72:73], v[240:241] op_sel:[0,0] op_sel_hi:[0,1] neg_lo:[0,0] neg_hi:[0,0]
v_pk_fma_f32 v[72:73], v[72:73], v[240:241], v[48:49] op_sel:[1,1,0] op_sel_hi:[1,0,1] neg_lo:[0,1,0] neg_hi:[0,0,0]
v_lshlrev_b32 v240, 16, v213
v_and_b32 v241, 0xffff0000, v213
v_pk_mul_f32 v[48:49], v[44:45], v[240:241] op_sel:[0,0] op_sel_hi:[0,1] neg_lo:[0,0] neg_hi:[0,0]
v_pk_fma_f32 v[44:45], v[44:45], v[240:241], v[48:49] op_sel:[1,1,0] op_sel_hi:[1,0,1] neg_lo:[0,1,0] neg_hi:[0,0,0]
v_lshlrev_b32 v240, 16, v214
v_and_b32 v241, 0xffff0000, v214
v_pk_mul_f32 v[48:49], v[28:29], v[240:241] op_sel:[0,0] op_sel_hi:[0,1] neg_lo:[0,0] neg_hi:[0,0]
v_pk_fma_f32 v[28:29], v[28:29], v[240:241], v[48:49] op_sel:[1,1,0] op_sel_hi:[1,0,1] neg_lo:[0,1,0] neg_hi:[0,0,0]
v_lshlrev_b32 v240, 16, v215
v_and_b32 v241, 0xffff0000, v215
v_pk_mul_f32 v[48:49], v[60:61], v[240:241] op_sel:[0,0] op_sel_hi:[0,1] neg_lo:[0,0] neg_hi:[0,0]
v_pk_fma_f32 v[60:61], v[60:61], v[240:241], v[48:49] op_sel:[1,1,0] op_sel_hi:[1,0,1] neg_lo:[0,1,0] neg_hi:[0,0,0]
v_lshlrev_b32 v240, 16, v216
v_and_b32 v241, 0xffff0000, v216
v_pk_mul_f32 v[48:49], v[76:77], v[240:241] op_sel:[0,0] op_sel_hi:[0,1] neg_lo:[0,0] neg_hi:[0,0]
v_pk_fma_f32 v[76:77], v[76:77], v[240:241], v[48:49] op_sel:[1,1,0] op_sel_hi:[1,0,1] neg_lo:[0,1,0] neg_hi:[0,0,0]
v_lshlrev_b32 v240, 16, v217
v_and_b32 v241, 0xffff0000, v217
v_pk_mul_f32 v[48:49], v[46:47], v[240:241] op_sel:[0,0] op_sel_hi:[0,1] neg_lo:[0,0] neg_hi:[0,0]
v_pk_fma_f32 v[46:47], v[46:47], v[240:241], v[48:49] op_sel:[1,1,0] op_sel_hi:[1,0,1] neg_lo:[0,1,0] neg_hi:[0,0,0]
v_lshlrev_b32 v240, 16, v218
v_and_b32 v241, 0xffff0000, v218
v_pk_mul_f32 v[48:49], v[30:31], v[240:241] op_sel:[0,0] op_sel_hi:[0,1] neg_lo:[0,0] neg_hi:[0,0]
v_pk_fma_f32 v[30:31], v[30:31], v[240:241], v[48:49] op_sel:[1,1,0] op_sel_hi:[1,0,1] neg_lo:[0,1,0] neg_hi:[0,0,0]
v_lshlrev_b32 v240, 16, v219
v_and_b32 v241, 0xffff0000, v219
v_pk_mul_f32 v[48:49], v[62:63], v[240:241] op_sel:[0,0] op_sel_hi:[0,1] neg_lo:[0,0] neg_hi:[0,0]
v_pk_fma_f32 v[62:63], v[62:63], v[240:241], v[48:49] op_sel:[1,1,0] op_sel_hi:[1,0,1] neg_lo:[0,1,0] neg_hi:[0,0,0]
v_lshlrev_b32 v240, 16, v220
v_and_b32 v241, 0xffff0000, v220
v_pk_mul_f32 v[48:49], v[22:23], v[240:241] op_sel:[0,0] op_sel_hi:[0,1] neg_lo:[0,0] neg_hi:[0,0]
v_pk_fma_f32 v[22:23], v[22:23], v[240:241], v[48:49] op_sel:[1,1,0] op_sel_hi:[1,0,1] neg_lo:[0,1,0] neg_hi:[0,0,0]
v_lshlrev_b32 v240, 16, v221
v_and_b32 v241, 0xffff0000, v221
v_pk_mul_f32 v[48:49], v[54:55], v[240:241] op_sel:[0,0] op_sel_hi:[0,1] neg_lo:[0,0] neg_hi:[0,0]
v_pk_fma_f32 v[54:55], v[54:55], v[240:241], v[48:49] op_sel:[1,1,0] op_sel_hi:[1,0,1] neg_lo:[0,1,0] neg_hi:[0,0,0]
v_lshlrev_b32 v240, 16, v222
v_and_b32 v241, 0xffff0000, v222
v_pk_mul_f32 v[48:49], v[38:39], v[240:241] op_sel:[0,0] op_sel_hi:[0,1] neg_lo:[0,0] neg_hi:[0,0]
v_pk_fma_f32 v[38:39], v[38:39], v[240:241], v[48:49] op_sel:[1,1,0] op_sel_hi:[1,0,1] neg_lo:[0,1,0] neg_hi:[0,0,0]
v_lshlrev_b32 v240, 16, v223
v_and_b32 v241, 0xffff0000, v223
v_pk_mul_f32 v[48:49], v[70:71], v[240:241] op_sel:[0,0] op_sel_hi:[0,1] neg_lo:[0,0] neg_hi:[0,0]
v_pk_fma_f32 v[70:71], v[70:71], v[240:241], v[48:49] op_sel:[1,1,0] op_sel_hi:[1,0,1] neg_lo:[0,1,0] neg_hi:[0,0,0]
v_lshlrev_b32 v240, 16, v224
v_and_b32 v241, 0xffff0000, v224
v_pk_mul_f32 v[48:49], v[78:79], v[240:241] op_sel:[0,0] op_sel_hi:[0,1] neg_lo:[0,0] neg_hi:[0,0]
v_pk_fma_f32 v[78:79], v[78:79], v[240:241], v[48:49] op_sel:[1,1,0] op_sel_hi:[1,0,1] neg_lo:[0,1,0] neg_hi:[0,0,0]
v_lshlrev_b32 v240, 16, v225
v_and_b32 v241, 0xffff0000, v225
v_pk_mul_f32 v[48:49], v[32:33], v[240:241] op_sel:[0,0] op_sel_hi:[0,1] neg_lo:[0,0] neg_hi:[0,0]
v_pk_fma_f32 v[32:33], v[32:33], v[240:241], v[48:49] op_sel:[1,1,0] op_sel_hi:[1,0,1] neg_lo:[0,1,0] neg_hi:[0,0,0]
v_lshlrev_b32 v240, 16, v226
v_and_b32 v241, 0xffff0000, v226
v_pk_mul_f32 v[48:49], v[24:25], v[240:241] op_sel:[0,0] op_sel_hi:[0,1] neg_lo:[0,0] neg_hi:[0,0]
v_pk_fma_f32 v[24:25], v[24:25], v[240:241], v[48:49] op_sel:[1,1,0] op_sel_hi:[1,0,1] neg_lo:[0,1,0] neg_hi:[0,0,0]
v_lshlrev_b32 v240, 16, v227
v_and_b32 v241, 0xffff0000, v227
v_pk_mul_f32 v[48:49], v[56:57], v[240:241] op_sel:[0,0] op_sel_hi:[0,1] neg_lo:[0,0] neg_hi:[0,0]
v_pk_fma_f32 v[56:57], v[56:57], v[240:241], v[48:49] op_sel:[1,1,0] op_sel_hi:[1,0,1] neg_lo:[0,1,0] neg_hi:[0,0,0]
v_lshlrev_b32 v240, 16, v228
v_and_b32 v241, 0xffff0000, v228
v_pk_mul_f32 v[48:49], v[20:21], v[240:241] op_sel:[0,0] op_sel_hi:[0,1] neg_lo:[0,0] neg_hi:[0,0]
v_pk_fma_f32 v[20:21], v[20:21], v[240:241], v[48:49] op_sel:[1,1,0] op_sel_hi:[1,0,1] neg_lo:[0,1,0] neg_hi:[0,0,0]
v_lshlrev_b32 v240, 16, v229
v_and_b32 v241, 0xffff0000, v229
v_pk_mul_f32 v[48:49], v[52:53], v[240:241] op_sel:[0,0] op_sel_hi:[0,1] neg_lo:[0,0] neg_hi:[0,0]
v_pk_fma_f32 v[52:53], v[52:53], v[240:241], v[48:49] op_sel:[1,1,0] op_sel_hi:[1,0,1] neg_lo:[0,1,0] neg_hi:[0,0,0]
v_lshlrev_b32 v240, 16, v230
v_and_b32 v241, 0xffff0000, v230
v_pk_mul_f32 v[48:49], v[36:37], v[240:241] op_sel:[0,0] op_sel_hi:[0,1] neg_lo:[0,0] neg_hi:[0,0]
v_pk_fma_f32 v[36:37], v[36:37], v[240:241], v[48:49] op_sel:[1,1,0] op_sel_hi:[1,0,1] neg_lo:[0,1,0] neg_hi:[0,0,0]
v_lshlrev_b32 v240, 16, v231
v_and_b32 v241, 0xffff0000, v231
v_pk_mul_f32 v[48:49], v[68:69], v[240:241] op_sel:[0,0] op_sel_hi:[0,1] neg_lo:[0,0] neg_hi:[0,0]
v_pk_fma_f32 v[68:69], v[68:69], v[240:241], v[48:49] op_sel:[1,1,0] op_sel_hi:[1,0,1] neg_lo:[0,1,0] neg_hi:[0,0,0]
v_lshlrev_b32 v240, 16, v232
v_and_b32 v241, 0xffff0000, v232
v_pk_mul_f32 v[48:49], v[18:19], v[240:241] op_sel:[0,0] op_sel_hi:[0,1] neg_lo:[0,0] neg_hi:[0,0]
v_pk_fma_f32 v[18:19], v[18:19], v[240:241], v[48:49] op_sel:[1,1,0] op_sel_hi:[1,0,1] neg_lo:[0,1,0] neg_hi:[0,0,0]
v_lshlrev_b32 v240, 16, v233
v_and_b32 v241, 0xffff0000, v233
v_pk_mul_f32 v[48:49], v[50:51], v[240:241] op_sel:[0,0] op_sel_hi:[0,1] neg_lo:[0,0] neg_hi:[0,0]
v_pk_fma_f32 v[50:51], v[50:51], v[240:241], v[48:49] op_sel:[1,1,0] op_sel_hi:[1,0,1] neg_lo:[0,1,0] neg_hi:[0,0,0]
v_lshlrev_b32 v240, 16, v234
v_and_b32 v241, 0xffff0000, v234
v_pk_mul_f32 v[48:49], v[34:35], v[240:241] op_sel:[0,0] op_sel_hi:[0,1] neg_lo:[0,0] neg_hi:[0,0]
v_pk_fma_f32 v[34:35], v[34:35], v[240:241], v[48:49] op_sel:[1,1,0] op_sel_hi:[1,0,1] neg_lo:[0,1,0] neg_hi:[0,0,0]
v_lshlrev_b32 v240, 16, v235
v_and_b32 v241, 0xffff0000, v235
v_pk_mul_f32 v[48:49], v[66:67], v[240:241] op_sel:[0,0] op_sel_hi:[0,1] neg_lo:[0,0] neg_hi:[0,0]
v_pk_fma_f32 v[66:67], v[66:67], v[240:241], v[48:49] op_sel:[1,1,0] op_sel_hi:[1,0,1] neg_lo:[0,1,0] neg_hi:[0,0,0]
v_lshlrev_b32 v240, 16, v236
v_and_b32 v241, 0xffff0000, v236
v_pk_mul_f32 v[48:49], v[26:27], v[240:241] op_sel:[0,0] op_sel_hi:[0,1] neg_lo:[0,0] neg_hi:[0,0]
v_pk_fma_f32 v[26:27], v[26:27], v[240:241], v[48:49] op_sel:[1,1,0] op_sel_hi:[1,0,1] neg_lo:[0,1,0] neg_hi:[0,0,0]
v_lshlrev_b32 v240, 16, v237
v_and_b32 v241, 0xffff0000, v237
v_pk_mul_f32 v[48:49], v[58:59], v[240:241] op_sel:[0,0] op_sel_hi:[0,1] neg_lo:[0,0] neg_hi:[0,0]
v_pk_fma_f32 v[58:59], v[58:59], v[240:241], v[48:49] op_sel:[1,1,0] op_sel_hi:[1,0,1] neg_lo:[0,1,0] neg_hi:[0,0,0]
v_lshlrev_b32 v240, 16, v238
v_and_b32 v241, 0xffff0000, v238
v_pk_mul_f32 v[48:49], v[42:43], v[240:241] op_sel:[0,0] op_sel_hi:[0,1] neg_lo:[0,0] neg_hi:[0,0]
v_pk_fma_f32 v[42:43], v[42:43], v[240:241], v[48:49] op_sel:[1,1,0] op_sel_hi:[1,0,1] neg_lo:[0,1,0] neg_hi:[0,0,0]
v_lshlrev_b32 v240, 16, v239
v_and_b32 v241, 0xffff0000, v239
v_pk_mul_f32 v[48:49], v[74:75], v[240:241] op_sel:[0,0] op_sel_hi:[0,1] neg_lo:[0,0] neg_hi:[0,0]
v_pk_fma_f32 v[74:75], v[74:75], v[240:241], v[48:49] op_sel:[1,1,0] op_sel_hi:[1,0,1] neg_lo:[0,1,0] neg_hi:[0,0,0]
v_fmac_f32_dpp v16, v16, v7 quad_perm:[1,0,3,2] row_mask:0xf bank_mask:0xf
v_fmac_f32_dpp v17, v17, v7 quad_perm:[1,0,3,2] row_mask:0xf bank_mask:0xf
v_fmac_f32_dpp v14, v14, v7 quad_perm:[1,0,3,2] row_mask:0xf bank_mask:0xf
v_fmac_f32_dpp v15, v15, v7 quad_perm:[1,0,3,2] row_mask:0xf bank_mask:0xf
v_fmac_f32_dpp v64, v64, v7 quad_perm:[1,0,3,2] row_mask:0xf bank_mask:0xf
v_fmac_f32_dpp v65, v65, v7 quad_perm:[1,0,3,2] row_mask:0xf bank_mask:0xf
v_fmac_f32_dpp v40, v40, v7 quad_perm:[1,0,3,2] row_mask:0xf bank_mask:0xf
v_fmac_f32_dpp v41, v41, v7 quad_perm:[1,0,3,2] row_mask:0xf bank_mask:0xf
v_fmac_f32_dpp v72, v72, v7 quad_perm:[1,0,3,2] row_mask:0xf bank_mask:0xf
v_fmac_f32_dpp v73, v73, v7 quad_perm:[1,0,3,2] row_mask:0xf bank_mask:0xf
v_fmac_f32_dpp v44, v44, v7 quad_perm:[1,0,3,2] row_mask:0xf bank_mask:0xf
v_fmac_f32_dpp v45, v45, v7 quad_perm:[1,0,3,2] row_mask:0xf bank_mask:0xf
v_fmac_f32_dpp v28, v28, v7 quad_perm:[1,0,3,2] row_mask:0xf bank_mask:0xf
v_fmac_f32_dpp v29, v29, v7 quad_perm:[1,0,3,2] row_mask:0xf bank_mask:0xf
v_fmac_f32_dpp v60, v60, v7 quad_perm:[1,0,3,2] row_mask:0xf bank_mask:0xf
v_fmac_f32_dpp v61, v61, v7 quad_perm:[1,0,3,2] row_mask:0xf bank_mask:0xf
v_fmac_f32_dpp v76, v76, v7 quad_perm:[1,0,3,2] row_mask:0xf bank_mask:0xf
v_fmac_f32_dpp v77, v77, v7 quad_perm:[1,0,3,2] row_mask:0xf bank_mask:0xf
v_fmac_f32_dpp v46, v46, v7 quad_perm:[1,0,3,2] row_mask:0xf bank_mask:0xf
v_fmac_f32_dpp v47, v47, v7 quad_perm:[1,0,3,2] row_mask:0xf bank_mask:0xf
v_fmac_f32_dpp v30, v30, v7 quad_perm:[1,0,3,2] row_mask:0xf bank_mask:0xf
v_fmac_f32_dpp v31, v31, v7 quad_perm:[1,0,3,2] row_mask:0xf bank_mask:0xf
v_fmac_f32_dpp v62, v62, v7 quad_perm:[1,0,3,2] row_mask:0xf bank_mask:0xf
v_fmac_f32_dpp v63, v63, v7 quad_perm:[1,0,3,2] row_mask:0xf bank_mask:0xf
v_fmac_f32_dpp v22, v22, v7 quad_perm:[1,0,3,2] row_mask:0xf bank_mask:0xf
v_fmac_f32_dpp v23, v23, v7 quad_perm:[1,0,3,2] row_mask:0xf bank_mask:0xf
v_fmac_f32_dpp v54, v54, v7 quad_perm:[1,0,3,2] row_mask:0xf bank_mask:0xf
v_fmac_f32_dpp v55, v55, v7 quad_perm:[1,0,3,2] row_mask:0xf bank_mask:0xf
v_fmac_f32_dpp v38, v38, v7 quad_perm:[1,0,3,2] row_mask:0xf bank_mask:0xf
v_fmac_f32_dpp v39, v39, v7 quad_perm:[1,0,3,2] row_mask:0xf bank_mask:0xf
v_fmac_f32_dpp v70, v70, v7 quad_perm:[1,0,3,2] row_mask:0xf bank_mask:0xf
v_fmac_f32_dpp v71, v71, v7 quad_perm:[1,0,3,2] row_mask:0xf bank_mask:0xf
v_fmac_f32_dpp v78, v78, v7 quad_perm:[1,0,3,2] row_mask:0xf bank_mask:0xf
v_fmac_f32_dpp v79, v79, v7 quad_perm:[1,0,3,2] row_mask:0xf bank_mask:0xf
v_fmac_f32_dpp v32, v32, v7 quad_perm:[1,0,3,2] row_mask:0xf bank_mask:0xf
v_fmac_f32_dpp v33, v33, v7 quad_perm:[1,0,3,2] row_mask:0xf bank_mask:0xf
v_fmac_f32_dpp v24, v24, v7 quad_perm:[1,0,3,2] row_mask:0xf bank_mask:0xf
v_fmac_f32_dpp v25, v25, v7 quad_perm:[1,0,3,2] row_mask:0xf bank_mask:0xf
v_fmac_f32_dpp v56, v56, v7 quad_perm:[1,0,3,2] row_mask:0xf bank_mask:0xf
v_fmac_f32_dpp v57, v57, v7 quad_perm:[1,0,3,2] row_mask:0xf bank_mask:0xf
v_fmac_f32_dpp v20, v20, v7 quad_perm:[1,0,3,2] row_mask:0xf bank_mask:0xf
v_fmac_f32_dpp v21, v21, v7 quad_perm:[1,0,3,2] row_mask:0xf bank_mask:0xf
v_fmac_f32_dpp v52, v52, v7 quad_perm:[1,0,3,2] row_mask:0xf bank_mask:0xf
v_fmac_f32_dpp v53, v53, v7 quad_perm:[1,0,3,2] row_mask:0xf bank_mask:0xf
v_fmac_f32_dpp v36, v36, v7 quad_perm:[1,0,3,2] row_mask:0xf bank_mask:0xf
v_fmac_f32_dpp v37, v37, v7 quad_perm:[1,0,3,2] row_mask:0xf bank_mask:0xf
v_fmac_f32_dpp v68, v68, v7 quad_perm:[1,0,3,2] row_mask:0xf bank_mask:0xf
v_fmac_f32_dpp v69, v69, v7 quad_perm:[1,0,3,2] row_mask:0xf bank_mask:0xf
v_fmac_f32_dpp v18, v18, v7 quad_perm:[1,0,3,2] row_mask:0xf bank_mask:0xf
v_fmac_f32_dpp v19, v19, v7 quad_perm:[1,0,3,2] row_mask:0xf bank_mask:0xf
v_fmac_f32_dpp v50, v50, v7 quad_perm:[1,0,3,2] row_mask:0xf bank_mask:0xf
v_fmac_f32_dpp v51, v51, v7 quad_perm:[1,0,3,2] row_mask:0xf bank_mask:0xf
v_fmac_f32_dpp v34, v34, v7 quad_perm:[1,0,3,2] row_mask:0xf bank_mask:0xf
v_fmac_f32_dpp v35, v35, v7 quad_perm:[1,0,3,2] row_mask:0xf bank_mask:0xf
v_fmac_f32_dpp v66, v66, v7 quad_perm:[1,0,3,2] row_mask:0xf bank_mask:0xf
v_fmac_f32_dpp v67, v67, v7 quad_perm:[1,0,3,2] row_mask:0xf bank_mask:0xf
v_fmac_f32_dpp v26, v26, v7 quad_perm:[1,0,3,2] row_mask:0xf bank_mask:0xf
v_fmac_f32_dpp v27, v27, v7 quad_perm:[1,0,3,2] row_mask:0xf bank_mask:0xf
v_fmac_f32_dpp v58, v58, v7 quad_perm:[1,0,3,2] row_mask:0xf bank_mask:0xf
v_fmac_f32_dpp v59, v59, v7 quad_perm:[1,0,3,2] row_mask:0xf bank_mask:0xf
v_fmac_f32_dpp v42, v42, v7 quad_perm:[1,0,3,2] row_mask:0xf bank_mask:0xf
v_fmac_f32_dpp v43, v43, v7 quad_perm:[1,0,3,2] row_mask:0xf bank_mask:0xf
v_fmac_f32_dpp v74, v74, v7 quad_perm:[1,0,3,2] row_mask:0xf bank_mask:0xf
v_fmac_f32_dpp v75, v75, v7 quad_perm:[1,0,3,2] row_mask:0xf bank_mask:0xf
s_mov_b64 exec, s[18:19]
v_pk_add_f32 v[16:17], v[16:17], 0 neg_lo:[1,0] neg_hi:[1,0]
v_pk_mul_f32 v[48:49], v[14:15], s[48:49] op_sel:[0,0] op_sel_hi:[0,1] neg_lo:[0,1] neg_hi:[0,1]
v_pk_fma_f32 v[14:15], v[14:15], s[48:49], v[48:49] op_sel:[1,1,0] op_sel_hi:[1,0,1] neg_lo:[0,0,0] neg_hi:[0,1,0]
v_pk_mul_f32 v[48:49], v[64:65], s[50:51] op_sel:[0,0] op_sel_hi:[0,1] neg_lo:[0,1] neg_hi:[0,1]
v_pk_fma_f32 v[64:65], v[64:65], s[50:51], v[48:49] op_sel:[1,1,0] op_sel_hi:[1,0,1] neg_lo:[0,0,0] neg_hi:[0,1,0]
v_pk_mul_f32 v[48:49], v[40:41], s[52:53] op_sel:[0,0] op_sel_hi:[0,1] neg_lo:[0,1] neg_hi:[0,1]
v_pk_fma_f32 v[40:41], v[40:41], s[52:53], v[48:49] op_sel:[1,1,0] op_sel_hi:[1,0,1] neg_lo:[0,0,0] neg_hi:[0,1,0]
v_pk_mul_f32 v[48:49], v[72:73], s[54:55] op_sel:[0,0] op_sel_hi:[0,1] neg_lo:[0,1] neg_hi:[0,1]
v_pk_fma_f32 v[72:73], v[72:73], s[54:55], v[48:49] op_sel:[1,1,0] op_sel_hi:[1,0,1] neg_lo:[0,0,0] neg_hi:[0,1,0]
v_pk_mul_f32 v[48:49], v[44:45], s[56:57] op_sel:[0,0] op_sel_hi:[0,1] neg_lo:[0,1] neg_hi:[0,1]
v_pk_fma_f32 v[44:45], v[44:45], s[56:57], v[48:49] op_sel:[1,1,0] op_sel_hi:[1,0,1] neg_lo:[0,0,0] neg_hi:[0,1,0]
v_pk_mul_f32 v[48:49], v[28:29], s[58:59] op_sel:[0,0] op_sel_hi:[0,1] neg_lo:[0,1] neg_hi:[0,1]
v_pk_fma_f32 v[28:29], v[28:29], s[58:59], v[48:49] op_sel:[1,1,0] op_sel_hi:[1,0,1] neg_lo:[0,0,0] neg_hi:[0,1,0]
v_pk_mul_f32 v[48:49], v[60:61], s[60:61] op_sel:[0,0] op_sel_hi:[0,1] neg_lo:[0,1] neg_hi:[0,1]
v_pk_fma_f32 v[60:61], v[60:61], s[60:61], v[48:49] op_sel:[1,1,0] op_sel_hi:[1,0,1] neg_lo:[0,0,0] neg_hi:[0,1,0]
v_pk_mul_f32 v[48:49], v[76:77], s[62:63] op_sel:[0,0] op_sel_hi:[0,1] neg_lo:[0,1] neg_hi:[0,1]
v_pk_fma_f32 v[76:77], v[76:77], s[62:63], v[48:49] op_sel:[1,1,0] op_sel_hi:[1,0,1] neg_lo:[0,0,0] neg_hi:[0,1,0]
v_pk_mul_f32 v[48:49], v[46:47], s[60:61] op_sel:[0,1] op_sel_hi:[0,0] neg_lo:[0,1] neg_hi:[0,1]
v_pk_fma_f32 v[46:47], v[46:47], s[60:61], v[48:49] op_sel:[1,0,0] op_sel_hi:[1,1,1] neg_lo:[0,0,0] neg_hi:[0,1,0]
v_pk_mul_f32 v[48:49], v[30:31], s[58:59] op_sel:[0,1] op_sel_hi:[0,0] neg_lo:[0,1] neg_hi:[0,1]
v_pk_fma_f32 v[30:31], v[30:31], s[58:59], v[48:49] op_sel:[1,0,0] op_sel_hi:[1,1,1] neg_lo:[0,0,0] neg_hi:[0,1,0]
v_pk_mul_f32 v[48:49], v[62:63], s[56:57] op_sel:[0,1] op_sel_hi:[0,0] neg_lo:[0,1] neg_hi:[0,1]
v_pk_fma_f32 v[62:63], v[62:63], s[56:57], v[48:49] op_sel:[1,0,0] op_sel_hi:[1,1,1] neg_lo:[0,0,0] neg_hi:[0,1,0]
v_pk_mul_f32 v[48:49], v[22:23], s[54:55] op_sel:[0,1] op_sel_hi:[0,0] neg_lo:[0,1] neg_hi:[0,1]
v_pk_fma_f32 v[22:23], v[22:23], s[54:55], v[48:49] op_sel:[1,0,0] op_sel_hi:[1,1,1] neg_lo:[0,0,0] neg_hi:[0,1,0]
v_pk_mul_f32 v[48:49], v[54:55], s[52:53] op_sel:[0,1] op_sel_hi:[0,0] neg_lo:[0,1] neg_hi:[0,1]
v_pk_fma_f32 v[54:55], v[54:55], s[52:53], v[48:49] op_sel:[1,0,0] op_sel_hi:[1,1,1] neg_lo:[0,0,0] neg_hi:[0,1,0]
v_pk_mul_f32 v[48:49], v[38:39], s[50:51] op_sel:[0,1] op_sel_hi:[0,0] neg_lo:[0,1] neg_hi:[0,1]
v_pk_fma_f32 v[38:39], v[38:39], s[50:51], v[48:49] op_sel:[1,0,0] op_sel_hi:[1,1,1] neg_lo:[0,0,0] neg_hi:[0,1,0]
v_pk_mul_f32 v[48:49], v[70:71], s[48:49] op_sel:[0,1] op_sel_hi:[0,0] neg_lo:[0,1] neg_hi:[0,1]
v_pk_fma_f32 v[70:71], v[70:71], s[48:49], v[48:49] op_sel:[1,0,0] op_sel_hi:[1,1,1] neg_lo:[0,0,0] neg_hi:[0,1,0]
v_pk_add_f32 v[78:79], v[78:79], 0 op_sel:[1,0] op_sel_hi:[0,0] neg_lo:[0,0] neg_hi:[1,0]
v_pk_mul_f32 v[48:49], v[32:33], s[48:49] op_sel:[0,1] op_sel_hi:[0,0] neg_lo:[0,0] neg_hi:[0,1]
v_pk_fma_f32 v[32:33], v[32:33], s[48:49], v[48:49] op_sel:[1,0,0] op_sel_hi:[1,1,1] neg_lo:[0,0,0] neg_hi:[0,0,0]
v_pk_mul_f32 v[48:49], v[24:25], s[50:51] op_sel:[0,1] op_sel_hi:[0,0] neg_lo:[0,0] neg_hi:[0,1]
v_pk_fma_f32 v[24:25], v[24:25], s[50:51], v[48:49] op_sel:[1,0,0] op_sel_hi:[1,1,1] neg_lo:[0,0,0] neg_hi:[0,0,0]
v_pk_mul_f32 v[48:49], v[56:57], s[52:53] op_sel:[0,1] op_sel_hi:[0,0] neg_lo:[0,0] neg_hi:[0,1]
v_pk_fma_f32 v[56:57], v[56:57], s[52:53], v[48:49] op_sel:[1,0,0] op_sel_hi:[1,1,1] neg_lo:[0,0,0] neg_hi:[0,0,0]
v_pk_mul_f32 v[48:49], v[20:21], s[54:55] op_sel:[0,1] op_sel_hi:[0,0] neg_lo:[0,0] neg_hi:[0,1]
v_pk_fma_f32 v[20:21], v[20:21], s[54:55], v[48:49] op_sel:[1,0,0] op_sel_hi:[1,1,1] neg_lo:[0,0,0] neg_hi:[0,0,0]
v_pk_mul_f32 v[48:49], v[52:53], s[56:57] op_sel:[0,1] op_sel_hi:[0,0] neg_lo:[0,0] neg_hi:[0,1]
v_pk_fma_f32 v[52:53], v[52:53], s[56:57], v[48:49] op_sel:[1,0,0] op_sel_hi:[1,1,1] neg_lo:[0,0,0] neg_hi:[0,0,0]
v_pk_mul_f32 v[48:49], v[36:37], s[58:59] op_sel:[0,1] op_sel_hi:[0,0] neg_lo:[0,0] neg_hi:[0,1]
v_pk_fma_f32 v[36:37], v[36:37], s[58:59], v[48:49] op_sel:[1,0,0] op_sel_hi:[1,1,1] neg_lo:[0,0,0] neg_hi:[0,0,0]
v_pk_mul_f32 v[48:49], v[68:69], s[60:61] op_sel:[0,1] op_sel_hi:[0,0] neg_lo:[0,0] neg_hi:[0,1]
v_pk_fma_f32 v[68:69], v[68:69], s[60:61], v[48:49] op_sel:[1,0,0] op_sel_hi:[1,1,1] neg_lo:[0,0,0] neg_hi:[0,0,0]
v_pk_mul_f32 v[48:49], v[18:19], s[62:63] op_sel:[0,0] op_sel_hi:[0,1] neg_lo:[0,0] neg_hi:[0,1]
v_pk_fma_f32 v[18:19], v[18:19], s[62:63], v[48:49] op_sel:[1,1,0] op_sel_hi:[1,0,1] neg_lo:[0,0,0] neg_hi:[0,0,0]
v_pk_mul_f32 v[48:49], v[50:51], s[60:61] op_sel:[0,0] op_sel_hi:[0,1] neg_lo:[0,0] neg_hi:[0,1]
v_pk_fma_f32 v[50:51], v[50:51], s[60:61], v[48:49] op_sel:[1,1,0] op_sel_hi:[1,0,1] neg_lo:[0,0,0] neg_hi:[0,0,0]
v_pk_mul_f32 v[48:49], v[34:35], s[58:59] op_sel:[0,0] op_sel_hi:[0,1] neg_lo:[0,0] neg_hi:[0,1]
v_pk_fma_f32 v[34:35], v[34:35], s[58:59], v[48:49] op_sel:[1,1,0] op_sel_hi:[1,0,1] neg_lo:[0,0,0] neg_hi:[0,0,0]
v_pk_mul_f32 v[48:49], v[66:67], s[56:57] op_sel:[0,0] op_sel_hi:[0,1] neg_lo:[0,0] neg_hi:[0,1]
v_pk_fma_f32 v[66:67], v[66:67], s[56:57], v[48:49] op_sel:[1,1,0] op_sel_hi:[1,0,1] neg_lo:[0,0,0] neg_hi:[0,0,0]
v_pk_mul_f32 v[48:49], v[26:27], s[54:55] op_sel:[0,0] op_sel_hi:[0,1] neg_lo:[0,0] neg_hi:[0,1]
v_pk_fma_f32 v[26:27], v[26:27], s[54:55], v[48:49] op_sel:[1,1,0] op_sel_hi:[1,0,1] neg_lo:[0,0,0] neg_hi:[0,0,0]
v_pk_mul_f32 v[48:49], v[58:59], s[52:53] op_sel:[0,0] op_sel_hi:[0,1] neg_lo:[0,0] neg_hi:[0,1]
v_pk_fma_f32 v[58:59], v[58:59], s[52:53], v[48:49] op_sel:[1,1,0] op_sel_hi:[1,0,1] neg_lo:[0,0,0] neg_hi:[0,0,0]
v_pk_mul_f32 v[48:49], v[42:43], s[50:51] op_sel:[0,0] op_sel_hi:[0,1] neg_lo:[0,0] neg_hi:[0,1]
v_pk_fma_f32 v[42:43], v[42:43], s[50:51], v[48:49] op_sel:[1,1,0] op_sel_hi:[1,0,1] neg_lo:[0,0,0] neg_hi:[0,0,0]
v_pk_mul_f32 v[48:49], v[74:75], s[48:49] op_sel:[0,0] op_sel_hi:[0,1] neg_lo:[0,0] neg_hi:[0,1]
v_pk_fma_f32 v[74:75], v[74:75], s[48:49], v[48:49] op_sel:[1,1,0] op_sel_hi:[1,0,1] neg_lo:[0,0,0] neg_hi:[0,0,0]
s_mov_b64 exec, -1
v_pk_add_f32 v[48:49], v[16:17], v[78:79] neg_lo:[0,1] neg_hi:[0,1]
v_pk_add_f32 v[16:17], v[16:17], v[78:79]
v_pk_add_f32 v[78:79], v[14:15], v[32:33] neg_lo:[0,1] neg_hi:[0,1]
v_pk_add_f32 v[14:15], v[14:15], v[32:33]
v_pk_mul_f32 v[32:33], v[78:79], s[50:51] op_sel:[0,0] op_sel_hi:[0,1] neg_lo:[0,0] neg_hi:[0,0]
v_pk_fma_f32 v[32:33], v[78:79], s[50:51], v[32:33] op_sel:[1,1,0] op_sel_hi:[1,0,1] neg_lo:[0,1,0] neg_hi:[0,0,0]
v_pk_add_f32 v[78:79], v[64:65], v[24:25] neg_lo:[0,1] neg_hi:[0,1]
v_pk_add_f32 v[64:65], v[64:65], v[24:25]
v_pk_mul_f32 v[24:25], v[78:79], s[54:55] op_sel:[0,0] op_sel_hi:[0,1] neg_lo:[0,0] neg_hi:[0,0]
v_pk_fma_f32 v[24:25], v[78:79], s[54:55], v[24:25] op_sel:[1,1,0] op_sel_hi:[1,0,1] neg_lo:[0,1,0] neg_hi:[0,0,0]
v_pk_add_f32 v[78:79], v[40:41], v[56:57] neg_lo:[0,1] neg_hi:[0,1]
v_pk_add_f32 v[40:41], v[40:41], v[56:57]
v_pk_mul_f32 v[56:57], v[78:79], s[58:59] op_sel:[0,0] op_sel_hi:[0,1] neg_lo:[0,0] neg_hi:[0,0]
v_pk_fma_f32 v[56:57], v[78:79], s[58:59], v[56:57] op_sel:[1,1,0] op_sel_hi:[1,0,1] neg_lo:[0,1,0] neg_hi:[0,0,0]
v_pk_add_f32 v[78:79], v[72:73], v[20:21] neg_lo:[0,1] neg_hi:[0,1]
v_pk_add_f32 v[72:73], v[72:73], v[20:21]
v_pk_mul_f32 v[20:21], v[78:79], s[62:63] op_sel:[0,0] op_sel_hi:[0,1] neg_lo:[0,0] neg_hi:[0,0]
v_pk_fma_f32 v[20:21], v[78:79], s[62:63], v[20:21] op_sel:[1,1,0] op_sel_hi:[1,0,1] neg_lo:[0,1,0] neg_hi:[0,0,0]
v_pk_add_f32 v[78:79], v[44:45], v[52:53] neg_lo:[0,1] neg_hi:[0,1]
v_pk_add_f32 v[44:45], v[44:45], v[52:53]
v_pk_mul_f32 v[52:53], v[78:79], s[58:59] op_sel:[0,1] op_sel_hi:[0,0] neg_lo:[0,0] neg_hi:[0,0]
v_pk_fma_f32 v[52:53], v[78:79], s[58:59], v[52:53] op_sel:[1,0,0] op_sel_hi:[1,1,1] neg_lo:[0,1,0] neg_hi:[0,0,0]
v_pk_add_f32 v[78:79], v[28:29], v[36:37] neg_lo:[0,1] neg_hi:[0,1]
v_pk_add_f32 v[28:29], v[28:29], v[36:37]
v_pk_mul_f32 v[36:37], v[78:79], s[54:55] op_sel:[0,1] op_sel_hi:[0,0] neg_lo:[0,0] neg_hi:[0,0]
v_pk_fma_f32 v[36:37], v[78:79], s[54:55], v[36:37] op_sel:[1,0,0] op_sel_hi:[1,1,1] neg_lo:[0,1,0] neg_hi:[0,0,0]
v_pk_add_f32 v[78:79], v[60:61], v[68:69] neg_lo:[0,1] neg_hi:[0,1]
v_pk_add_f32 v[60:61], v[60:61], v[68:69]
v_pk_mul_f32 v[68:69], v[78:79], s[50:51] op_sel:[0,1] op_sel_hi:[0,0] neg_lo:[0,0] neg_hi:[0,0]
v_pk_fma_f32 v[68:69], v[78:79], s[50:51], v[68:69] op_sel:[1,0,0] op_sel_hi:[1,1,1] neg_lo:[0,1,0] neg_hi:[0,0,0]
v_pk_add_f32 v[78:79], v[76:77], v[18:19] op_sel:[1,1] op_sel_hi:[0,0] neg_lo:[1,0] neg_hi:[0,1]
v_pk_add_f32 v[76:77], v[76:77], v[18:19]
v_pk_add_f32 v[18:19], v[46:47], v[50:51] neg_lo:[0,1] neg_hi:[0,1]
v_pk_add_f32 v[46:47], v[46:47], v[50:51]
v_pk_mul_f32 v[50:51], v[18:19], s[50:51] op_sel:[0,1] op_sel_hi:[0,0] neg_lo:[0,1] neg_hi:[0,0]
v_pk_fma_f32 v[50:51], v[18:19], s[50:51], v[50:51] op_sel:[1,0,0] op_sel_hi:[1,1,1] neg_lo:[0,1,0] neg_hi:[0,1,0]
v_pk_add_f32 v[18:19], v[30:31], v[34:35] neg_lo:[0,1] neg_hi:[0,1]
v_pk_add_f32 v[30:31], v[30:31], v[34:35]
v_pk_mul_f32 v[34:35], v[18:19], s[54:55] op_sel:[0,1] op_sel_hi:[0,0] neg_lo:[0,1] neg_hi:[0,0]
v_pk_fma_f32 v[34:35], v[18:19], s[54:55], v[34:35] op_sel:[1,0,0] op_sel_hi:[1,1,1] neg_lo:[0,1,0] neg_hi:[0,1,0]
v_pk_add_f32 v[18:19], v[62:63], v[66:67] neg_lo:[0,1] neg_hi:[0,1]
v_pk_add_f32 v[62:63], v[62:63], v[66:67]
v_pk_mul_f32 v[66:67], v[18:19], s[58:59] op_sel:[0,1] op_sel_hi:[0,0] neg_lo:[0,1] neg_hi:[0,0]
v_pk_fma_f32 v[66:67], v[18:19], s[58:59], v[66:67] op_sel:[1,0,0] op_sel_hi:[1,1,1] neg_lo:[0,1,0] neg_hi:[0,1,0]
v_pk_add_f32 v[18:19], v[22:23], v[26:27] neg_lo:[0,1] neg_hi:[0,1]
v_pk_add_f32 v[22:23], v[22:23], v[26:27]
v_pk_mul_f32 v[26:27], v[18:19], s[62:63] op_sel:[0,0] op_sel_hi:[0,1] neg_lo:[0,1] neg_hi:[0,0]
v_pk_fma_f32 v[26:27], v[18:19], s[62:63], v[26:27] op_sel:[1,1,0] op_sel_hi:[1,0,1] neg_lo:[0,1,0] neg_hi:[0,1,0]
v_pk_add_f32 v[18:19], v[54:55], v[58:59] neg_lo:[0,1] neg_hi:[0,1]
v_pk_add_f32 v[54:55], v[54:55], v[58:59]
v_pk_mul_f32 v[58:59], v[18:19], s[58:59] op_sel:[0,0] op_sel_hi:[0,1] neg_lo:[0,1] neg_hi:[0,0]
v_pk_fma_f32 v[58:59], v[18:19], s[58:59], v[58:59] op_sel:[1,1,0] op_sel_hi:[1,0,1] neg_lo:[0,1,0] neg_hi:[0,1,0]
v_pk_add_f32 v[18:19], v[38:39], v[42:43] neg_lo:[0,1] neg_hi:[0,1]
v_pk_add_f32 v[38:39], v[38:39], v[42:43]
v_pk_mul_f32 v[42:43], v[18:19], s[54:55] op_sel:[0,0] op_sel_hi:[0,1] neg_lo:[0,1] neg_hi:[0,0]
v_pk_fma_f32 v[42:43], v[18:19], s[54:55], v[42:43] op_sel:[1,1,0] op_sel_hi:[1,0,1] neg_lo:[0,1,0] neg_hi:[0,1,0]
v_pk_add_f32 v[18:19], v[70:71], v[74:75] neg_lo:[0,1] neg_hi:[0,1]
v_pk_add_f32 v[70:71], v[70:71], v[74:75]
v_pk_mul_f32 v[74:75], v[18:19], s[50:51] op_sel:[0,0] op_sel_hi:[0,1] neg_lo:[0,1] neg_hi:[0,0]
v_pk_fma_f32 v[74:75], v[18:19], s[50:51], v[74:75] op_sel:[1,1,0] op_sel_hi:[1,0,1] neg_lo:[0,1,0] neg_hi:[0,1,0]
v_pk_add_f32 v[18:19], v[16:17], v[76:77] neg_lo:[0,1] neg_hi:[0,1]
v_pk_add_f32 v[16:17], v[16:17], v[76:77]
v_pk_add_f32 v[76:77], v[14:15], v[46:47] neg_lo:[0,1] neg_hi:[0,1]
v_pk_add_f32 v[14:15], v[14:15], v[46:47]
v_pk_mul_f32 v[46:47], v[76:77], s[54:55] op_sel:[0,0] op_sel_hi:[0,1] neg_lo:[0,0] neg_hi:[0,0]
v_pk_fma_f32 v[46:47], v[76:77], s[54:55], v[46:47] op_sel:[1,1,0] op_sel_hi:[1,0,1] neg_lo:[0,1,0] neg_hi:[0,0,0]
v_pk_add_f32 v[76:77], v[64:65], v[30:31] neg_lo:[0,1] neg_hi:[0,1]
v_pk_add_f32 v[64:65], v[64:65], v[30:31]
v_pk_mul_f32 v[30:31], v[76:77], s[62:63] op_sel:[0,0] op_sel_hi:[0,1] neg_lo:[0,0] neg_hi:[0,0]
v_pk_fma_f32 v[30:31], v[76:77], s[62:63], v[30:31] op_sel:[1,1,0] op_sel_hi:[1,0,1] neg_lo:[0,1,0] neg_hi:[0,0,0]
v_pk_add_f32 v[76:77], v[40:41], v[62:63] neg_lo:[0,1] neg_hi:[0,1]
v_pk_add_f32 v[40:41], v[40:41], v[62:63]
v_pk_mul_f32 v[62:63], v[76:77], s[54:55] op_sel:[0,1] op_sel_hi:[0,0] neg_lo:[0,0] neg_hi:[0,0]
v_pk_fma_f32 v[62:63], v[76:77], s[54:55], v[62:63] op_sel:[1,0,0] op_sel_hi:[1,1,1] neg_lo:[0,1,0] neg_hi:[0,0,0]
v_pk_add_f32 v[76:77], v[72:73], v[22:23] op_sel:[1,1] op_sel_hi:[0,0] neg_lo:[1,0] neg_hi:[0,1]
v_pk_add_f32 v[72:73], v[72:73], v[22:23]
v_pk_add_f32 v[22:23], v[44:45], v[54:55] neg_lo:[0,1] neg_hi:[0,1]
v_pk_add_f32 v[44:45], v[44:45], v[54:55]
v_pk_mul_f32 v[54:55], v[22:23], s[54:55] op_sel:[0,1] op_sel_hi:[0,0] neg_lo:[0,1] neg_hi:[0,0]
v_pk_fma_f32 v[54:55], v[22:23], s[54:55], v[54:55] op_sel:[1,0,0] op_sel_hi:[1,1,1] neg_lo:[0,1,0] neg_hi:[0,1,0]
v_pk_add_f32 v[22:23], v[28:29], v[38:39] neg_lo:[0,1] neg_hi:[0,1]
v_pk_add_f32 v[28:29], v[28:29], v[38:39]
v_pk_mul_f32 v[38:39], v[22:23], s[62:63] op_sel:[0,0] op_sel_hi:[0,1] neg_lo:[0,1] neg_hi:[0,0]
v_pk_fma_f32 v[38:39], v[22:23], s[62:63], v[38:39] op_sel:[1,1,0] op_sel_hi:[1,0,1] neg_lo:[0,1,0] neg_hi:[0,1,0]
v_pk_add_f32 v[22:23], v[60:61], v[70:71] neg_lo:[0,1] neg_hi:[0,1]
v_pk_add_f32 v[60:61], v[60:61], v[70:71]
v_pk_mul_f32 v[70:71], v[22:23], s[54:55] op_sel:[0,0] op_sel_hi:[0,1] neg_lo:[0,1] neg_hi:[0,0]
v_pk_fma_f32 v[70:71], v[22:23], s[54:55], v[70:71] op_sel:[1,1,0] op_sel_hi:[1,0,1] neg_lo:[0,1,0] neg_hi:[0,1,0]
v_pk_add_f32 v[22:23], v[48:49], v[78:79] neg_lo:[0,1] neg_hi:[0,1]
v_pk_add_f32 v[48:49], v[48:49], v[78:79]
v_pk_add_f32 v[78:79], v[32:33], v[50:51] neg_lo:[0,1] neg_hi:[0,1]
v_pk_add_f32 v[32:33], v[32:33], v[50:51]
v_pk_mul_f32 v[50:51], v[78:79], s[54:55] op_sel:[0,0] op_sel_hi:[0,1] neg_lo:[0,0] neg_hi:[0,0]
v_pk_fma_f32 v[50:51], v[78:79], s[54:55], v[50:51] op_sel:[1,1,0] op_sel_hi:[1,0,1] neg_lo:[0,1,0] neg_hi:[0,0,0]
v_pk_add_f32 v[78:79], v[24:25], v[34:35] neg_lo:[0,1] neg_hi:[0,1]
v_pk_add_f32 v[24:25], v[24:25], v[34:35]
v_pk_mul_f32 v[34:35], v[78:79], s[62:63] op_sel:[0,0] op_sel_hi:[0,1] neg_lo:[0,0] neg_hi:[0,0]
v_pk_fma_f32 v[34:35], v[78:79], s[62:63], v[34:35] op_sel:[1,1,0] op_sel_hi:[1,0,1] neg_lo:[0,1,0] neg_hi:[0,0,0]
v_pk_add_f32 v[78:79], v[56:57], v[66:67] neg_lo:[0,1] neg_hi:[0,1]
v_pk_add_f32 v[56:57], v[56:57], v[66:67]
v_pk_mul_f32 v[66:67], v[78:79], s[54:55] op_sel:[0,1] op_sel_hi:[0,0] neg_lo:[0,0] neg_hi:[0,0]
v_pk_fma_f32 v[66:67], v[78:79], s[54:55], v[66:67] op_sel:[1,0,0] op_sel_hi:[1,1,1] neg_lo:[0,1,0] neg_hi:[0,0,0]
v_pk_add_f32 v[78:79], v[20:21], v[26:27] op_sel:[1,1] op_sel_hi:[0,0] neg_lo:[1,0] neg_hi:[0,1]
v_pk_add_f32 v[20:21], v[20:21], v[26:27]
v_pk_add_f32 v[26:27], v[52:53], v[58:59] neg_lo:[0,1] neg_hi:[0,1]
v_pk_add_f32 v[52:53], v[52:53], v[58:59]
v_pk_mul_f32 v[58:59], v[26:27], s[54:55] op_sel:[0,1] op_sel_hi:[0,0] neg_lo:[0,1] neg_hi:[0,0]
v_pk_fma_f32 v[58:59], v[26:27], s[54:55], v[58:59] op_sel:[1,0,0] op_sel_hi:[1,1,1] neg_lo:[0,1,0] neg_hi:[0,1,0]
v_pk_add_f32 v[26:27], v[36:37], v[42:43] neg_lo:[0,1] neg_hi:[0,1]
v_pk_add_f32 v[36:37], v[36:37], v[42:43]
v_pk_mul_f32 v[42:43], v[26:27], s[62:63] op_sel:[0,0] op_sel_hi:[0,1] neg_lo:[0,1] neg_hi:[0,0]
v_pk_fma_f32 v[42:43], v[26:27], s[62:63], v[42:43] op_sel:[1,1,0] op_sel_hi:[1,0,1] neg_lo:[0,1,0] neg_hi:[0,1,0]
v_pk_add_f32 v[26:27], v[68:69], v[74:75] neg_lo:[0,1] neg_hi:[0,1]
v_pk_add_f32 v[68:69], v[68:69], v[74:75]
v_pk_mul_f32 v[74:75], v[26:27], s[54:55] op_sel:[0,0] op_sel_hi:[0,1] neg_lo:[0,1] neg_hi:[0,0]
v_pk_fma_f32 v[74:75], v[26:27], s[54:55], v[74:75] op_sel:[1,1,0] op_sel_hi:[1,0,1] neg_lo:[0,1,0] neg_hi:[0,1,0]
v_pk_add_f32 v[26:27], v[16:17], v[72:73] neg_lo:[0,1] neg_hi:[0,1]
v_pk_add_f32 v[16:17], v[16:17], v[72:73]
v_pk_add_f32 v[72:73], v[14:15], v[44:45] neg_lo:[0,1] neg_hi:[0,1]
v_pk_add_f32 v[14:15], v[14:15], v[44:45]
v_pk_mul_f32 v[44:45], v[72:73], s[62:63] op_sel:[0,0] op_sel_hi:[0,1] neg_lo:[0,0] neg_hi:[0,0]
v_pk_fma_f32 v[44:45], v[72:73], s[62:63], v[44:45] op_sel:[1,1,0] op_sel_hi:[1,0,1] neg_lo:[0,1,0] neg_hi:[0,0,0]
v_pk_add_f32 v[72:73], v[64:65], v[28:29] op_sel:[1,1] op_sel_hi:[0,0] neg_lo:[1,0] neg_hi:[0,1]
v_pk_add_f32 v[64:65], v[64:65], v[28:29]
v_pk_add_f32 v[28:29], v[40:41], v[60:61] neg_lo:[0,1] neg_hi:[0,1]
v_pk_add_f32 v[40:41], v[40:41], v[60:61]
v_pk_mul_f32 v[60:61], v[28:29], s[62:63] op_sel:[0,0] op_sel_hi:[0,1] neg_lo:[0,1] neg_hi:[0,0]
v_pk_fma_f32 v[60:61], v[28:29], s[62:63], v[60:61] op_sel:[1,1,0] op_sel_hi:[1,0,1] neg_lo:[0,1,0] neg_hi:[0,1,0]
v_pk_add_f32 v[28:29], v[18:19], v[76:77] neg_lo:[0,1] neg_hi:[0,1]
v_pk_add_f32 v[18:19], v[18:19], v[76:77]
v_pk_add_f32 v[76:77], v[46:47], v[54:55] neg_lo:[0,1] neg_hi:[0,1]
v_pk_add_f32 v[46:47], v[46:47], v[54:55]
v_pk_mul_f32 v[54:55], v[76:77], s[62:63] op_sel:[0,0] op_sel_hi:[0,1] neg_lo:[0,0] neg_hi:[0,0]
v_pk_fma_f32 v[54:55], v[76:77], s[62:63], v[54:55] op_sel:[1,1,0] op_sel_hi:[1,0,1] neg_lo:[0,1,0] neg_hi:[0,0,0]
v_pk_add_f32 v[76:77], v[30:31], v[38:39] op_sel:[1,1] op_sel_hi:[0,0] neg_lo:[1,0] neg_hi:[0,1]
v_pk_add_f32 v[30:31], v[30:31], v[38:39]
v_pk_add_f32 v[38:39], v[62:63], v[70:71] neg_lo:[0,1] neg_hi:[0,1]
v_pk_add_f32 v[62:63], v[62:63], v[70:71]
v_pk_mul_f32 v[70:71], v[38:39], s[62:63] op_sel:[0,0] op_sel_hi:[0,1] neg_lo:[0,1] neg_hi:[0,0]
v_pk_fma_f32 v[70:71], v[38:39], s[62:63], v[70:71] op_sel:[1,1,0] op_sel_hi:[1,0,1] neg_lo:[0,1,0] neg_hi:[0,1,0]
v_pk_add_f32 v[38:39], v[48:49], v[20:21] neg_lo:[0,1] neg_hi:[0,1]
v_pk_add_f32 v[48:49], v[48:49], v[20:21]
v_pk_add_f32 v[20:21], v[32:33], v[52:53] neg_lo:[0,1] neg_hi:[0,1]
v_pk_add_f32 v[32:33], v[32:33], v[52:53]
v_pk_mul_f32 v[52:53], v[20:21], s[62:63] op_sel:[0,0] op_sel_hi:[0,1] neg_lo:[0,0] neg_hi:[0,0]
v_pk_fma_f32 v[52:53], v[20:21], s[62:63], v[52:53] op_sel:[1,1,0] op_sel_hi:[1,0,1] neg_lo:[0,1,0] neg_hi:[0,0,0]
v_pk_add_f32 v[20:21], v[24:25], v[36:37] op_sel:[1,1] op_sel_hi:[0,0] neg_lo:[1,0] neg_hi:[0,1]
v_pk_add_f32 v[24:25], v[24:25], v[36:37]
v_pk_add_f32 v[36:37], v[56:57], v[68:69] neg_lo:[0,1] neg_hi:[0,1]
v_pk_add_f32 v[56:57], v[56:57], v[68:69]
v_pk_mul_f32 v[68:69], v[36:37], s[62:63] op_sel:[0,0] op_sel_hi:[0,1] neg_lo:[0,1] neg_hi:[0,0]
v_pk_fma_f32 v[68:69], v[36:37], s[62:63], v[68:69] op_sel:[1,1,0] op_sel_hi:[1,0,1] neg_lo:[0,1,0] neg_hi:[0,1,0]
v_pk_add_f32 v[36:37], v[22:23], v[78:79] neg_lo:[0,1] neg_hi:[0,1]
v_pk_add_f32 v[22:23], v[22:23], v[78:79]
v_pk_add_f32 v[78:79], v[50:51], v[58:59] neg_lo:[0,1] neg_hi:[0,1]
v_pk_add_f32 v[50:51], v[50:51], v[58:59]
v_pk_mul_f32 v[58:59], v[78:79], s[62:63] op_sel:[0,0] op_sel_hi:[0,1] neg_lo:[0,0] neg_hi:[0,0]
v_pk_fma_f32 v[58:59], v[78:79], s[62:63], v[58:59] op_sel:[1,1,0] op_sel_hi:[1,0,1] neg_lo:[0,1,0] neg_hi:[0,0,0]
v_pk_add_f32 v[78:79], v[34:35], v[42:43] op_sel:[1,1] op_sel_hi:[0,0] neg_lo:[1,0] neg_hi:[0,1]
v_pk_add_f32 v[34:35], v[34:35], v[42:43]
v_pk_add_f32 v[42:43], v[66:67], v[74:75] neg_lo:[0,1] neg_hi:[0,1]
v_pk_add_f32 v[66:67], v[66:67], v[74:75]
v_pk_mul_f32 v[74:75], v[42:43], s[62:63] op_sel:[0,0] op_sel_hi:[0,1] neg_lo:[0,1] neg_hi:[0,0]
v_pk_fma_f32 v[74:75], v[42:43], s[62:63], v[74:75] op_sel:[1,1,0] op_sel_hi:[1,0,1] neg_lo:[0,1,0] neg_hi:[0,1,0]
v_pk_add_f32 v[42:43], v[16:17], v[64:65] neg_lo:[0,1] neg_hi:[0,1]
v_pk_add_f32 v[16:17], v[16:17], v[64:65]
v_pk_add_f32 v[64:65], v[14:15], v[40:41] op_sel:[1,1] op_sel_hi:[0,0] neg_lo:[1,0] neg_hi:[0,1]
v_pk_add_f32 v[14:15], v[14:15], v[40:41]
v_pk_add_f32 v[40:41], v[26:27], v[72:73] neg_lo:[0,1] neg_hi:[0,1]
v_pk_add_f32 v[26:27], v[26:27], v[72:73]
v_pk_add_f32 v[72:73], v[44:45], v[60:61] op_sel:[1,1] op_sel_hi:[0,0] neg_lo:[1,0] neg_hi:[0,1]
v_pk_add_f32 v[44:45], v[44:45], v[60:61]
v_pk_add_f32 v[60:61], v[18:19], v[30:31] neg_lo:[0,1] neg_hi:[0,1]
v_pk_add_f32 v[18:19], v[18:19], v[30:31]
v_pk_add_f32 v[30:31], v[46:47], v[62:63] op_sel:[1,1] op_sel_hi:[0,0] neg_lo:[1,0] neg_hi:[0,1]
v_pk_add_f32 v[46:47], v[46:47], v[62:63]
v_pk_add_f32 v[62:63], v[28:29], v[76:77] neg_lo:[0,1] neg_hi:[0,1]
v_pk_add_f32 v[28:29], v[28:29], v[76:77]
v_pk_add_f32 v[76:77], v[54:55], v[70:71] op_sel:[1,1] op_sel_hi:[0,0] neg_lo:[1,0] neg_hi:[0,1]
v_pk_add_f32 v[54:55], v[54:55], v[70:71]
v_pk_add_f32 v[70:71], v[48:49], v[24:25] neg_lo:[0,1] neg_hi:[0,1]
v_pk_add_f32 v[48:49], v[48:49], v[24:25]
v_pk_add_f32 v[24:25], v[32:33], v[56:57] op_sel:[1,1] op_sel_hi:[0,0] neg_lo:[1,0] neg_hi:[0,1]
v_pk_add_f32 v[32:33], v[32:33], v[56:57]
v_pk_add_f32 v[56:57], v[38:39], v[20:21] neg_lo:[0,1] neg_hi:[0,1]
v_pk_add_f32 v[38:39], v[38:39], v[20:21]
v_pk_add_f32 v[20:21], v[52:53], v[68:69] op_sel:[1,1] op_sel_hi:[0,0] neg_lo:[1,0] neg_hi:[0,1]
v_pk_add_f32 v[52:53], v[52:53], v[68:69]
v_pk_add_f32 v[68:69], v[22:23], v[34:35] neg_lo:[0,1] neg_hi:[0,1]
v_pk_add_f32 v[22:23], v[22:23], v[34:35]
v_pk_add_f32 v[34:35], v[50:51], v[66:67] op_sel:[1,1] op_sel_hi:[0,0] neg_lo:[1,0] neg_hi:[0,1]
v_pk_add_f32 v[50:51], v[50:51], v[66:67]
v_pk_add_f32 v[66:67], v[36:37], v[78:79] neg_lo:[0,1] neg_hi:[0,1]
v_pk_add_f32 v[36:37], v[36:37], v[78:79]
v_pk_add_f32 v[78:79], v[58:59], v[74:75] op_sel:[1,1] op_sel_hi:[0,0] neg_lo:[1,0] neg_hi:[0,1]
v_pk_add_f32 v[58:59], v[58:59], v[74:75]
v_pk_add_f32 v[74:75], v[16:17], v[14:15] neg_lo:[0,1] neg_hi:[0,1]
v_pk_add_f32 v[16:17], v[16:17], v[14:15]
v_pk_add_f32 v[14:15], v[42:43], v[64:65] neg_lo:[0,1] neg_hi:[0,1]
v_pk_add_f32 v[42:43], v[42:43], v[64:65]
v_pk_add_f32 v[64:65], v[26:27], v[44:45] neg_lo:[0,1] neg_hi:[0,1]
v_pk_add_f32 v[26:27], v[26:27], v[44:45]
v_pk_add_f32 v[44:45], v[40:41], v[72:73] neg_lo:[0,1] neg_hi:[0,1]
v_pk_add_f32 v[40:41], v[40:41], v[72:73]
v_pk_add_f32 v[72:73], v[18:19], v[46:47] neg_lo:[0,1] neg_hi:[0,1]
v_pk_add_f32 v[18:19], v[18:19], v[46:47]
v_pk_add_f32 v[46:47], v[60:61], v[30:31] neg_lo:[0,1] neg_hi:[0,1]
v_pk_add_f32 v[60:61], v[60:61], v[30:31]
v_pk_add_f32 v[30:31], v[28:29], v[54:55] neg_lo:[0,1] neg_hi:[0,1]
v_pk_add_f32 v[28:29], v[28:29], v[54:55]
v_pk_add_f32 v[54:55], v[62:63], v[76:77] neg_lo:[0,1] neg_hi:[0,1]
v_pk_add_f32 v[62:63], v[62:63], v[76:77]
v_pk_add_f32 v[76:77], v[48:49], v[32:33] neg_lo:[0,1] neg_hi:[0,1]
v_pk_add_f32 v[48:49], v[48:49], v[32:33]
v_pk_add_f32 v[32:33], v[70:71], v[24:25] neg_lo:[0,1] neg_hi:[0,1]
v_pk_add_f32 v[70:71], v[70:71], v[24:25]
v_pk_add_f32 v[24:25], v[38:39], v[52:53] neg_lo:[0,1] neg_hi:[0,1]
v_pk_add_f32 v[38:39], v[38:39], v[52:53]
v_pk_add_f32 v[52:53], v[56:57], v[20:21] neg_lo:[0,1] neg_hi:[0,1]
v_pk_add_f32 v[56:57], v[56:57], v[20:21]
v_pk_add_f32 v[20:21], v[22:23], v[50:51] neg_lo:[0,1] neg_hi:[0,1]
v_pk_add_f32 v[22:23], v[22:23], v[50:51]
v_pk_add_f32 v[50:51], v[68:69], v[34:35] neg_lo:[0,1] neg_hi:[0,1]
v_pk_add_f32 v[68:69], v[68:69], v[34:35]
v_pk_add_f32 v[34:35], v[36:37], v[58:59] neg_lo:[0,1] neg_hi:[0,1]
v_pk_add_f32 v[36:37], v[36:37], v[58:59]
v_pk_add_f32 v[58:59], v[66:67], v[78:79] neg_lo:[0,1] neg_hi:[0,1]
v_pk_add_f32 v[66:67], v[66:67], v[78:79]
v_pk_mul_f32 v[78:79], v[16:17], v[144:145] op_sel:[0,0] op_sel_hi:[0,1] neg_lo:[0,0] neg_hi:[0,0]
v_pk_fma_f32 v[16:17], v[16:17], v[144:145], v[78:79] op_sel:[1,1,0] op_sel_hi:[1,0,1] neg_lo:[0,1,0] neg_hi:[0,0,0]
v_pk_mul_f32 v[78:79], v[48:49], v[146:147] op_sel:[0,0] op_sel_hi:[0,1] neg_lo:[0,0] neg_hi:[0,0]
v_pk_fma_f32 v[48:49], v[48:49], v[146:147], v[78:79] op_sel:[1,1,0] op_sel_hi:[1,0,1] neg_lo:[0,1,0] neg_hi:[0,0,0]
v_pk_mul_f32 v[78:79], v[18:19], v[148:149] op_sel:[0,0] op_sel_hi:[0,1] neg_lo:[0,0] neg_hi:[0,0]
v_pk_fma_f32 v[18:19], v[18:19], v[148:149], v[78:79] op_sel:[1,1,0] op_sel_hi:[1,0,1] neg_lo:[0,1,0] neg_hi:[0,0,0]
v_pk_mul_f32 v[78:79], v[22:23], v[150:151] op_sel:[0,0] op_sel_hi:[0,1] neg_lo:[0,0] neg_hi:[0,0]
v_pk_fma_f32 v[22:23], v[22:23], v[150:151], v[78:79] op_sel:[1,1,0] op_sel_hi:[1,0,1] neg_lo:[0,1,0] neg_hi:[0,0,0]
v_pk_mul_f32 v[78:79], v[26:27], v[152:153] op_sel:[0,0] op_sel_hi:[0,1] neg_lo:[0,0] neg_hi:[0,0]
v_pk_fma_f32 v[26:27], v[26:27], v[152:153], v[78:79] op_sel:[1,1,0] op_sel_hi:[1,0,1] neg_lo:[0,1,0] neg_hi:[0,0,0]
v_pk_mul_f32 v[78:79], v[38:39], v[154:155] op_sel:[0,0] op_sel_hi:[0,1] neg_lo:[0,0] neg_hi:[0,0]
v_pk_fma_f32 v[38:39], v[38:39], v[154:155], v[78:79] op_sel:[1,1,0] op_sel_hi:[1,0,1] neg_lo:[0,1,0] neg_hi:[0,0,0]
v_pk_mul_f32 v[78:79], v[28:29], v[156:157] op_sel:[0,0] op_sel_hi:[0,1] neg_lo:[0,0] neg_hi:[0,0]
v_pk_fma_f32 v[28:29], v[28:29], v[156:157], v[78:79] op_sel:[1,1,0] op_sel_hi:[1,0,1] neg_lo:[0,1,0] neg_hi:[0,0,0]
v_pk_mul_f32 v[78:79], v[36:37], v[158:159] op_sel:[0,0] op_sel_hi:[0,1] neg_lo:[0,0] neg_hi:[0,0]
v_pk_fma_f32 v[36:37], v[36:37], v[158:159], v[78:79] op_sel:[1,1,0] op_sel_hi:[1,0,1] neg_lo:[0,1,0] neg_hi:[0,0,0]
v_pk_mul_f32 v[78:79], v[42:43], v[160:161] op_sel:[0,0] op_sel_hi:[0,1] neg_lo:[0,0] neg_hi:[0,0]
v_pk_fma_f32 v[42:43], v[42:43], v[160:161], v[78:79] op_sel:[1,1,0] op_sel_hi:[1,0,1] neg_lo:[0,1,0] neg_hi:[0,0,0]
v_pk_mul_f32 v[78:79], v[70:71], v[162:163] op_sel:[0,0] op_sel_hi:[0,1] neg_lo:[0,0] neg_hi:[0,0]
v_pk_fma_f32 v[70:71], v[70:71], v[162:163], v[78:79] op_sel:[1,1,0] op_sel_hi:[1,0,1] neg_lo:[0,1,0] neg_hi:[0,0,0]
v_pk_mul_f32 v[78:79], v[60:61], v[164:165] op_sel:[0,0] op_sel_hi:[0,1] neg_lo:[0,0] neg_hi:[0,0]
v_pk_fma_f32 v[60:61], v[60:61], v[164:165], v[78:79] op_sel:[1,1,0] op_sel_hi:[1,0,1] neg_lo:[0,1,0] neg_hi:[0,0,0]
v_pk_mul_f32 v[78:79], v[68:69], v[166:167] op_sel:[0,0] op_sel_hi:[0,1] neg_lo:[0,0] neg_hi:[0,0]
v_pk_fma_f32 v[68:69], v[68:69], v[166:167], v[78:79] op_sel:[1,1,0] op_sel_hi:[1,0,1] neg_lo:[0,1,0] neg_hi:[0,0,0]
v_pk_mul_f32 v[78:79], v[40:41], v[168:169] op_sel:[0,0] op_sel_hi:[0,1] neg_lo:[0,0] neg_hi:[0,0]
v_pk_fma_f32 v[40:41], v[40:41], v[168:169], v[78:79] op_sel:[1,1,0] op_sel_hi:[1,0,1] neg_lo:[0,1,0] neg_hi:[0,0,0]
v_pk_mul_f32 v[78:79], v[56:57], v[170:171] op_sel:[0,0] op_sel_hi:[0,1] neg_lo:[0,0] neg_hi:[0,0]
v_pk_fma_f32 v[56:57], v[56:57], v[170:171], v[78:79] op_sel:[1,1,0] op_sel_hi:[1,0,1] neg_lo:[0,1,0] neg_hi:[0,0,0]
v_pk_mul_f32 v[78:79], v[62:63], v[172:173] op_sel:[0,0] op_sel_hi:[0,1] neg_lo:[0,0] neg_hi:[0,0]
v_pk_fma_f32 v[62:63], v[62:63], v[172:173], v[78:79] op_sel:[1,1,0] op_sel_hi:[1,0,1] neg_lo:[0,1,0] neg_hi:[0,0,0]
v_pk_mul_f32 v[78:79], v[66:67], v[174:175] op_sel:[0,0] op_sel_hi:[0,1] neg_lo:[0,0] neg_hi:[0,0]
v_pk_fma_f32 v[66:67], v[66:67], v[174:175], v[78:79] op_sel:[1,1,0] op_sel_hi:[1,0,1] neg_lo:[0,1,0] neg_hi:[0,0,0]
v_pk_mul_f32 v[78:79], v[74:75], v[176:177] op_sel:[0,0] op_sel_hi:[0,1] neg_lo:[0,0] neg_hi:[0,0]
v_pk_fma_f32 v[74:75], v[74:75], v[176:177], v[78:79] op_sel:[1,1,0] op_sel_hi:[1,0,1] neg_lo:[0,1,0] neg_hi:[0,0,0]
v_pk_mul_f32 v[78:79], v[76:77], v[178:179] op_sel:[0,0] op_sel_hi:[0,1] neg_lo:[0,0] neg_hi:[0,0]
v_pk_fma_f32 v[76:77], v[76:77], v[178:179], v[78:79] op_sel:[1,1,0] op_sel_hi:[1,0,1] neg_lo:[0,1,0] neg_hi:[0,0,0]
v_pk_mul_f32 v[78:79], v[72:73], v[180:181] op_sel:[0,0] op_sel_hi:[0,1] neg_lo:[0,0] neg_hi:[0,0]
v_pk_fma_f32 v[72:73], v[72:73], v[180:181], v[78:79] op_sel:[1,1,0] op_sel_hi:[1,0,1] neg_lo:[0,1,0] neg_hi:[0,0,0]
v_pk_mul_f32 v[78:79], v[20:21], v[182:183] op_sel:[0,0] op_sel_hi:[0,1] neg_lo:[0,0] neg_hi:[0,0]
v_pk_fma_f32 v[20:21], v[20:21], v[182:183], v[78:79] op_sel:[1,1,0] op_sel_hi:[1,0,1] neg_lo:[0,1,0] neg_hi:[0,0,0]
v_pk_mul_f32 v[78:79], v[64:65], v[184:185] op_sel:[0,0] op_sel_hi:[0,1] neg_lo:[0,0] neg_hi:[0,0]
v_pk_fma_f32 v[64:65], v[64:65], v[184:185], v[78:79] op_sel:[1,1,0] op_sel_hi:[1,0,1] neg_lo:[0,1,0] neg_hi:[0,0,0]
v_pk_mul_f32 v[78:79], v[24:25], v[186:187] op_sel:[0,0] op_sel_hi:[0,1] neg_lo:[0,0] neg_hi:[0,0]
v_pk_fma_f32 v[24:25], v[24:25], v[186:187], v[78:79] op_sel:[1,1,0] op_sel_hi:[1,0,1] neg_lo:[0,1,0] neg_hi:[0,0,0]
v_pk_mul_f32 v[78:79], v[30:31], v[188:189] op_sel:[0,0] op_sel_hi:[0,1] neg_lo:[0,0] neg_hi:[0,0]
v_pk_fma_f32 v[30:31], v[30:31], v[188:189], v[78:79] op_sel:[1,1,0] op_sel_hi:[1,0,1] neg_lo:[0,1,0] neg_hi:[0,0,0]
v_pk_mul_f32 v[78:79], v[34:35], v[190:191] op_sel:[0,0] op_sel_hi:[0,1] neg_lo:[0,0] neg_hi:[0,0]
v_pk_fma_f32 v[34:35], v[34:35], v[190:191], v[78:79] op_sel:[1,1,0] op_sel_hi:[1,0,1] neg_lo:[0,1,0] neg_hi:[0,0,0]
v_pk_mul_f32 v[78:79], v[14:15], v[192:193] op_sel:[0,0] op_sel_hi:[0,1] neg_lo:[0,0] neg_hi:[0,0]
v_pk_fma_f32 v[14:15], v[14:15], v[192:193], v[78:79] op_sel:[1,1,0] op_sel_hi:[1,0,1] neg_lo:[0,1,0] neg_hi:[0,0,0]
v_pk_mul_f32 v[78:79], v[32:33], v[194:195] op_sel:[0,0] op_sel_hi:[0,1] neg_lo:[0,0] neg_hi:[0,0]
v_pk_fma_f32 v[32:33], v[32:33], v[194:195], v[78:79] op_sel:[1,1,0] op_sel_hi:[1,0,1] neg_lo:[0,1,0] neg_hi:[0,0,0]
v_pk_mul_f32 v[78:79], v[46:47], v[196:197] op_sel:[0,0] op_sel_hi:[0,1] neg_lo:[0,0] neg_hi:[0,0]
v_pk_fma_f32 v[46:47], v[46:47], v[196:197], v[78:79] op_sel:[1,1,0] op_sel_hi:[1,0,1] neg_lo:[0,1,0] neg_hi:[0,0,0]
v_pk_mul_f32 v[78:79], v[50:51], v[198:199] op_sel:[0,0] op_sel_hi:[0,1] neg_lo:[0,0] neg_hi:[0,0]
v_pk_fma_f32 v[50:51], v[50:51], v[198:199], v[78:79] op_sel:[1,1,0] op_sel_hi:[1,0,1] neg_lo:[0,1,0] neg_hi:[0,0,0]
v_pk_mul_f32 v[78:79], v[44:45], v[200:201] op_sel:[0,0] op_sel_hi:[0,1] neg_lo:[0,0] neg_hi:[0,0]
v_pk_fma_f32 v[44:45], v[44:45], v[200:201], v[78:79] op_sel:[1,1,0] op_sel_hi:[1,0,1] neg_lo:[0,1,0] neg_hi:[0,0,0]
v_pk_mul_f32 v[78:79], v[52:53], v[202:203] op_sel:[0,0] op_sel_hi:[0,1] neg_lo:[0,0] neg_hi:[0,0]
v_pk_fma_f32 v[52:53], v[52:53], v[202:203], v[78:79] op_sel:[1,1,0] op_sel_hi:[1,0,1] neg_lo:[0,1,0] neg_hi:[0,0,0]
v_pk_mul_f32 v[78:79], v[54:55], v[204:205] op_sel:[0,0] op_sel_hi:[0,1] neg_lo:[0,0] neg_hi:[0,0]
v_pk_fma_f32 v[54:55], v[54:55], v[204:205], v[78:79] op_sel:[1,1,0] op_sel_hi:[1,0,1] neg_lo:[0,1,0] neg_hi:[0,0,0]
v_pk_mul_f32 v[78:79], v[58:59], v[206:207] op_sel:[0,0] op_sel_hi:[0,1] neg_lo:[0,0] neg_hi:[0,0]
v_pk_fma_f32 v[58:59], v[58:59], v[206:207], v[78:79] op_sel:[1,1,0] op_sel_hi:[1,0,1] neg_lo:[0,1,0] neg_hi:[0,0,0]
ds_write_b64 v4, v[16:17] offset:0
ds_write_b64 v4, v[48:49] offset:16
ds_write_b64 v4, v[18:19] offset:32
ds_write_b64 v4, v[22:23] offset:48
ds_write_b64 v4, v[26:27] offset:64
ds_write_b64 v4, v[38:39] offset:80
ds_write_b64 v4, v[28:29] offset:96
ds_write_b64 v4, v[36:37] offset:112
ds_write_b64 v4, v[42:43] offset:128
ds_write_b64 v4, v[70:71] offset:144
ds_write_b64 v4, v[60:61] offset:160
ds_write_b64 v4, v[68:69] offset:176
ds_write_b64 v4, v[40:41] offset:192
ds_write_b64 v4, v[56:57] offset:208
ds_write_b64 v4, v[62:63] offset:224
ds_write_b64 v4, v[66:67] offset:240
ds_write_b64 v4, v[74:75] offset:256
ds_write_b64 v4, v[76:77] offset:272
ds_write_b64 v4, v[72:73] offset:288
ds_write_b64 v4, v[20:21] offset:304
ds_write_b64 v4, v[64:65] offset:320
ds_write_b64 v4, v[24:25] offset:336
ds_write_b64 v4, v[30:31] offset:352
ds_write_b64 v4, v[34:35] offset:368
ds_write_b64 v4, v[14:15] offset:384
ds_write_b64 v4, v[32:33] offset:400
ds_write_b64 v4, v[46:47] offset:416
ds_write_b64 v4, v[50:51] offset:432
ds_write_b64 v4, v[44:45] offset:448
ds_write_b64 v4, v[52:53] offset:464
ds_write_b64 v4, v[54:55] offset:480
ds_write_b64 v4, v[58:59] offset:496
s_waitcnt lgkmcnt(0)
ds_read_b64 v[16:17], v3 offset:0
ds_read_b64 v[48:49], v3 offset:8448
ds_read_b64 v[18:19], v3 offset:528
ds_read_b64 v[50:51], v3 offset:8976
ds_read_b64 v[20:21], v3 offset:1056
ds_read_b64 v[52:53], v3 offset:9504
ds_read_b64 v[22:23], v3 offset:1584
ds_read_b64 v[54:55], v3 offset:10032
ds_read_b64 v[24:25], v3 offset:2112
ds_read_b64 v[56:57], v3 offset:10560
ds_read_b64 v[26:27], v3 offset:2640
ds_read_b64 v[58:59], v3 offset:11088
ds_read_b64 v[28:29], v3 offset:3168
ds_read_b64 v[60:61], v3 offset:11616
ds_read_b64 v[30:31], v3 offset:3696
ds_read_b64 v[62:63], v3 offset:12144
ds_read_b64 v[32:33], v3 offset:4224
ds_read_b64 v[64:65], v3 offset:12672
ds_read_b64 v[34:35], v3 offset:4752
ds_read_b64 v[66:67], v3 offset:13200
ds_read_b64 v[36:37], v3 offset:5280
ds_read_b64 v[68:69], v3 offset:13728
ds_read_b64 v[38:39], v3 offset:5808
ds_read_b64 v[70:71], v3 offset:14256
ds_read_b64 v[40:41], v3 offset:6336
ds_read_b64 v[72:73], v3 offset:14784
ds_read_b64 v[42:43], v3 offset:6864
ds_read_b64 v[74:75], v3 offset:15312
ds_read_b64 v[44:45], v3 offset:7392
ds_read_b64 v[76:77], v3 offset:15840
ds_read_b64 v[46:47], v3 offset:7920
ds_read_b64 v[78:79], v3 offset:16368
s_waitcnt lgkmcnt(0)
v_pk_add_f32 v[14:15], v[16:17], v[48:49] neg_lo:[0,1] neg_hi:[0,1]
v_pk_add_f32 v[16:17], v[16:17], v[48:49]
v_pk_add_f32 v[48:49], v[18:19], v[50:51] neg_lo:[0,1] neg_hi:[0,1]
v_pk_add_f32 v[18:19], v[18:19], v[50:51]
v_pk_mul_f32 v[50:51], v[48:49], s[50:51] op_sel:[0,0] op_sel_hi:[0,1] neg_lo:[0,0] neg_hi:[0,0]
v_pk_fma_f32 v[50:51], v[48:49], s[50:51], v[50:51] op_sel:[1,1,0] op_sel_hi:[1,0,1] neg_lo:[0,1,0] neg_hi:[0,0,0]
v_pk_add_f32 v[48:49], v[20:21], v[52:53] neg_lo:[0,1] neg_hi:[0,1]
v_pk_add_f32 v[20:21], v[20:21], v[52:53]
v_pk_mul_f32 v[52:53], v[48:49], s[54:55] op_sel:[0,0] op_sel_hi:[0,1] neg_lo:[0,0] neg_hi:[0,0]
v_pk_fma_f32 v[52:53], v[48:49], s[54:55], v[52:53] op_sel:[1,1,0] op_sel_hi:[1,0,1] neg_lo:[0,1,0] neg_hi:[0,0,0]
v_pk_add_f32 v[48:49], v[22:23], v[54:55] neg_lo:[0,1] neg_hi:[0,1]
v_pk_add_f32 v[22:23], v[22:23], v[54:55]
v_pk_mul_f32 v[54:55], v[48:49], s[58:59] op_sel:[0,0] op_sel_hi:[0,1] neg_lo:[0,0] neg_hi:[0,0]
v_pk_fma_f32 v[54:55], v[48:49], s[58:59], v[54:55] op_sel:[1,1,0] op_sel_hi:[1,0,1] neg_lo:[0,1,0] neg_hi:[0,0,0]
v_pk_add_f32 v[48:49], v[24:25], v[56:57] neg_lo:[0,1] neg_hi:[0,1]
v_pk_add_f32 v[24:25], v[24:25], v[56:57]
v_pk_mul_f32 v[56:57], v[48:49], s[62:63] op_sel:[0,0] op_sel_hi:[0,1] neg_lo:[0,0] neg_hi:[0,0]
v_pk_fma_f32 v[56:57], v[48:49], s[62:63], v[56:57] op_sel:[1,1,0] op_sel_hi:[1,0,1] neg_lo:[0,1,0] neg_hi:[0,0,0]
v_pk_add_f32 v[48:49], v[26:27], v[58:59] neg_lo:[0,1] neg_hi:[0,1]
v_pk_add_f32 v[26:27], v[26:27], v[58:59]
v_pk_mul_f32 v[58:59], v[48:49], s[58:59] op_sel:[0,1] op_sel_hi:[0,0] neg_lo:[0,0] neg_hi:[0,0]
v_pk_fma_f32 v[58:59], v[48:49], s[58:59], v[58:59] op_sel:[1,0,0] op_sel_hi:[1,1,1] neg_lo:[0,1,0] neg_hi:[0,0,0]
v_pk_add_f32 v[48:49], v[28:29], v[60:61] neg_lo:[0,1] neg_hi:[0,1]
v_pk_add_f32 v[28:29], v[28:29], v[60:61]
v_pk_mul_f32 v[60:61], v[48:49], s[54:55] op_sel:[0,1] op_sel_hi:[0,0] neg_lo:[0,0] neg_hi:[0,0]
v_pk_fma_f32 v[60:61], v[48:49], s[54:55], v[60:61] op_sel:[1,0,0] op_sel_hi:[1,1,1] neg_lo:[0,1,0] neg_hi:[0,0,0]
v_pk_add_f32 v[48:49], v[30:31], v[62:63] neg_lo:[0,1] neg_hi:[0,1]
v_pk_add_f32 v[30:31], v[30:31], v[62:63]
v_pk_mul_f32 v[62:63], v[48:49], s[50:51] op_sel:[0,1] op_sel_hi:[0,0] neg_lo:[0,0] neg_hi:[0,0]
v_pk_fma_f32 v[62:63], v[48:49], s[50:51], v[62:63] op_sel:[1,0,0] op_sel_hi:[1,1,1] neg_lo:[0,1,0] neg_hi:[0,0,0]
v_pk_add_f32 v[48:49], v[32:33], v[64:65] op_sel:[1,1] op_sel_hi:[0,0] neg_lo:[1,0] neg_hi:[0,1]
v_pk_add_f32 v[32:33], v[32:33], v[64:65]
v_pk_add_f32 v[64:65], v[34:35], v[66:67] neg_lo:[0,1] neg_hi:[0,1]
v_pk_add_f32 v[34:35], v[34:35], v[66:67]
v_pk_mul_f32 v[66:67], v[64:65], s[50:51] op_sel:[0,1] op_sel_hi:[0,0] neg_lo:[0,1] neg_hi:[0,0]
v_pk_fma_f32 v[66:67], v[64:65], s[50:51], v[66:67] op_sel:[1,0,0] op_sel_hi:[1,1,1] neg_lo:[0,1,0] neg_hi:[0,1,0]
v_pk_add_f32 v[64:65], v[36:37], v[68:69] neg_lo:[0,1] neg_hi:[0,1]
v_pk_add_f32 v[36:37], v[36:37], v[68:69]
v_pk_mul_f32 v[68:69], v[64:65], s[54:55] op_sel:[0,1] op_sel_hi:[0,0] neg_lo:[0,1] neg_hi:[0,0]
v_pk_fma_f32 v[68:69], v[64:65], s[54:55], v[68:69] op_sel:[1,0,0] op_sel_hi:[1,1,1] neg_lo:[0,1,0] neg_hi:[0,1,0]
v_pk_add_f32 v[64:65], v[38:39], v[70:71] neg_lo:[0,1] neg_hi:[0,1]
v_pk_add_f32 v[38:39], v[38:39], v[70:71]
v_pk_mul_f32 v[70:71], v[64:65], s[58:59] op_sel:[0,1] op_sel_hi:[0,0] neg_lo:[0,1] neg_hi:[0,0]
v_pk_fma_f32 v[70:71], v[64:65], s[58:59], v[70:71] op_sel:[1,0,0] op_sel_hi:[1,1,1] neg_lo:[0,1,0] neg_hi:[0,1,0]
v_pk_add_f32 v[64:65], v[40:41], v[72:73] neg_lo:[0,1] neg_hi:[0,1]
v_pk_add_f32 v[40:41], v[40:41], v[72:73]
v_pk_mul_f32 v[72:73], v[64:65], s[62:63] op_sel:[0,0] op_sel_hi:[0,1] neg_lo:[0,1] neg_hi:[0,0]
v_pk_fma_f32 v[72:73], v[64:65], s[62:63], v[72:73] op_sel:[1,1,0] op_sel_hi:[1,0,1] neg_lo:[0,1,0] neg_hi:[0,1,0]
v_pk_add_f32 v[64:65], v[42:43], v[74:75] neg_lo:[0,1] neg_hi:[0,1]
v_pk_add_f32 v[42:43], v[42:43], v[74:75]
v_pk_mul_f32 v[74:75], v[64:65], s[58:59] op_sel:[0,0] op_sel_hi:[0,1] neg_lo:[0,1] neg_hi:[0,0]
v_pk_fma_f32 v[74:75], v[64:65], s[58:59], v[74:75] op_sel:[1,1,0] op_sel_hi:[1,0,1] neg_lo:[0,1,0] neg_hi:[0,1,0]
v_pk_add_f32 v[64:65], v[44:45], v[76:77] neg_lo:[0,1] neg_hi:[0,1]
v_pk_add_f32 v[44:45], v[44:45], v[76:77]
v_pk_mul_f32 v[76:77], v[64:65], s[54:55] op_sel:[0,0] op_sel_hi:[0,1] neg_lo:[0,1] neg_hi:[0,0]
v_pk_fma_f32 v[76:77], v[64:65], s[54:55], v[76:77] op_sel:[1,1,0] op_sel_hi:[1,0,1] neg_lo:[0,1,0] neg_hi:[0,1,0]
v_pk_add_f32 v[64:65], v[46:47], v[78:79] neg_lo:[0,1] neg_hi:[0,1]
v_pk_add_f32 v[46:47], v[46:47], v[78:79]
v_pk_mul_f32 v[78:79], v[64:65], s[50:51] op_sel:[0,0] op_sel_hi:[0,1] neg_lo:[0,1] neg_hi:[0,0]
v_pk_fma_f32 v[78:79], v[64:65], s[50:51], v[78:79] op_sel:[1,1,0] op_sel_hi:[1,0,1] neg_lo:[0,1,0] neg_hi:[0,1,0]
v_pk_add_f32 v[64:65], v[16:17], v[32:33] neg_lo:[0,1] neg_hi:[0,1]
v_pk_add_f32 v[16:17], v[16:17], v[32:33]
v_pk_add_f32 v[32:33], v[18:19], v[34:35] neg_lo:[0,1] neg_hi:[0,1]
v_pk_add_f32 v[18:19], v[18:19], v[34:35]
v_pk_mul_f32 v[34:35], v[32:33], s[54:55] op_sel:[0,0] op_sel_hi:[0,1] neg_lo:[0,0] neg_hi:[0,0]
v_pk_fma_f32 v[34:35], v[32:33], s[54:55], v[34:35] op_sel:[1,1,0] op_sel_hi:[1,0,1] neg_lo:[0,1,0] neg_hi:[0,0,0]
v_pk_add_f32 v[32:33], v[20:21], v[36:37] neg_lo:[0,1] neg_hi:[0,1]
v_pk_add_f32 v[20:21], v[20:21], v[36:37]
v_pk_mul_f32 v[36:37], v[32:33], s[62:63] op_sel:[0,0] op_sel_hi:[0,1] neg_lo:[0,0] neg_hi:[0,0]
v_pk_fma_f32 v[36:37], v[32:33], s[62:63], v[36:37] op_sel:[1,1,0] op_sel_hi:[1,0,1] neg_lo:[0,1,0] neg_hi:[0,0,0]
v_pk_add_f32 v[32:33], v[22:23], v[38:39] neg_lo:[0,1] neg_hi:[0,1]
v_pk_add_f32 v[22:23], v[22:23], v[38:39]
v_pk_mul_f32 v[38:39], v[32:33], s[54:55] op_sel:[0,1] op_sel_hi:[0,0] neg_lo:[0,0] neg_hi:[0,0]
v_pk_fma_f32 v[38:39], v[32:33], s[54:55], v[38:39] op_sel:[1,0,0] op_sel_hi:[1,1,1] neg_lo:[0,1,0] neg_hi:[0,0,0]
v_pk_add_f32 v[32:33], v[24:25], v[40:41] op_sel:[1,1] op_sel_hi:[0,0] neg_lo:[1,0] neg_hi:[0,1]
v_pk_add_f32 v[24:25], v[24:25], v[40:41]
v_pk_add_f32 v[40:41], v[26:27], v[42:43] neg_lo:[0,1] neg_hi:[0,1]
v_pk_add_f32 v[26:27], v[26:27], v[42:43]
v_pk_mul_f32 v[42:43], v[40:41], s[54:55] op_sel:[0,1] op_sel_hi:[0,0] neg_lo:[0,1] neg_hi:[0,0]
v_pk_fma_f32 v[42:43], v[40:41], s[54:55], v[42:43] op_sel:[1,0,0] op_sel_hi:[1,1,1] neg_lo:[0,1,0] neg_hi:[0,1,0]
v_pk_add_f32 v[40:41], v[28:29], v[44:45] neg_lo:[0,1] neg_hi:[0,1]
v_pk_add_f32 v[28:29], v[28:29], v[44:45]
v_pk_mul_f32 v[44:45], v[40:41], s[62:63] op_sel:[0,0] op_sel_hi:[0,1] neg_lo:[0,1] neg_hi:[0,0]
v_pk_fma_f32 v[44:45], v[40:41], s[62:63], v[44:45] op_sel:[1,1,0] op_sel_hi:[1,0,1] neg_lo:[0,1,0] neg_hi:[0,1,0]
v_pk_add_f32 v[40:41], v[30:31], v[46:47] neg_lo:[0,1] neg_hi:[0,1]
v_pk_add_f32 v[30:31], v[30:31], v[46:47]
v_pk_mul_f32 v[46:47], v[40:41], s[54:55] op_sel:[0,0] op_sel_hi:[0,1] neg_lo:[0,1] neg_hi:[0,0]
v_pk_fma_f32 v[46:47], v[40:41], s[54:55], v[46:47] op_sel:[1,1,0] op_sel_hi:[1,0,1] neg_lo:[0,1,0] neg_hi:[0,1,0]
v_pk_add_f32 v[40:41], v[14:15], v[48:49] neg_lo:[0,1] neg_hi:[0,1]
v_pk_add_f32 v[14:15], v[14:15], v[48:49]
v_pk_add_f32 v[48:49], v[50:51], v[66:67] neg_lo:[0,1] neg_hi:[0,1]
v_pk_add_f32 v[50:51], v[50:51], v[66:67]
v_pk_mul_f32 v[66:67], v[48:49], s[54:55] op_sel:[0,0] op_sel_hi:[0,1] neg_lo:[0,0] neg_hi:[0,0]
v_pk_fma_f32 v[66:67], v[48:49], s[54:55], v[66:67] op_sel:[1,1,0] op_sel_hi:[1,0,1] neg_lo:[0,1,0] neg_hi:[0,0,0]
v_pk_add_f32 v[48:49], v[52:53], v[68:69] neg_lo:[0,1] neg_hi:[0,1]
v_pk_add_f32 v[52:53], v[52:53], v[68:69]
v_pk_mul_f32 v[68:69], v[48:49], s[62:63] op_sel:[0,0] op_sel_hi:[0,1] neg_lo:[0,0] neg_hi:[0,0]
v_pk_fma_f32 v[68:69], v[48:49], s[62:63], v[68:69] op_sel:[1,1,0] op_sel_hi:[1,0,1] neg_lo:[0,1,0] neg_hi:[0,0,0]
v_pk_add_f32 v[48:49], v[54:55], v[70:71] neg_lo:[0,1] neg_hi:[0,1]
v_pk_add_f32 v[54:55], v[54:55], v[70:71]
v_pk_mul_f32 v[70:71], v[48:49], s[54:55] op_sel:[0,1] op_sel_hi:[0,0] neg_lo:[0,0] neg_hi:[0,0]
v_pk_fma_f32 v[70:71], v[48:49], s[54:55], v[70:71] op_sel:[1,0,0] op_sel_hi:[1,1,1] neg_lo:[0,1,0] neg_hi:[0,0,0]
v_pk_add_f32 v[48:49], v[56:57], v[72:73] op_sel:[1,1] op_sel_hi:[0,0] neg_lo:[1,0] neg_hi:[0,1]
v_pk_add_f32 v[56:57], v[56:57], v[72:73]
v_pk_add_f32 v[72:73], v[58:59], v[74:75] neg_lo:[0,1] neg_hi:[0,1]
v_pk_add_f32 v[58:59], v[58:59], v[74:75]
v_pk_mul_f32 v[74:75], v[72:73], s[54:55] op_sel:[0,1] op_sel_hi:[0,0] neg_lo:[0,1] neg_hi:[0,0]
v_pk_fma_f32 v[74:75], v[72:73], s[54:55], v[74:75] op_sel:[1,0,0] op_sel_hi:[1,1,1] neg_lo:[0,1,0] neg_hi:[0,1,0]
v_pk_add_f32 v[72:73], v[60:61], v[76:77] neg_lo:[0,1] neg_hi:[0,1]
v_pk_add_f32 v[60:61], v[60:61], v[76:77]
v_pk_mul_f32 v[76:77], v[72:73], s[62:63] op_sel:[0,0] op_sel_hi:[0,1] neg_lo:[0,1] neg_hi:[0,0]
v_pk_fma_f32 v[76:77], v[72:73], s[62:63], v[76:77] op_sel:[1,1,0] op_sel_hi:[1,0,1] neg_lo:[0,1,0] neg_hi:[0,1,0]
v_pk_add_f32 v[72:73], v[62:63], v[78:79] neg_lo:[0,1] neg_hi:[0,1]
v_pk_add_f32 v[62:63], v[62:63], v[78:79]
v_pk_mul_f32 v[78:79], v[72:73], s[54:55] op_sel:[0,0] op_sel_hi:[0,1] neg_lo:[0,1] neg_hi:[0,0]
v_pk_fma_f32 v[78:79], v[72:73], s[54:55], v[78:79] op_sel:[1,1,0] op_sel_hi:[1,0,1] neg_lo:[0,1,0] neg_hi:[0,1,0]
v_pk_add_f32 v[72:73], v[16:17], v[24:25] neg_lo:[0,1] neg_hi:[0,1]
v_pk_add_f32 v[16:17], v[16:17], v[24:25]
v_pk_add_f32 v[24:25], v[18:19], v[26:27] neg_lo:[0,1] neg_hi:[0,1]
v_pk_add_f32 v[18:19], v[18:19], v[26:27]
v_pk_mul_f32 v[26:27], v[24:25], s[62:63] op_sel:[0,0] op_sel_hi:[0,1] neg_lo:[0,0] neg_hi:[0,0]
v_pk_fma_f32 v[26:27], v[24:25], s[62:63], v[26:27] op_sel:[1,1,0] op_sel_hi:[1,0,1] neg_lo:[0,1,0] neg_hi:[0,0,0]
v_pk_add_f32 v[24:25], v[20:21], v[28:29] op_sel:[1,1] op_sel_hi:[0,0] neg_lo:[1,0] neg_hi:[0,1]
v_pk_add_f32 v[20:21], v[20:21], v[28:29]
v_pk_add_f32 v[28:29], v[22:23], v[30:31] neg_lo:[0,1] neg_hi:[0,1]
v_pk_add_f32 v[22:23], v[22:23], v[30:31]
v_pk_mul_f32 v[30:31], v[28:29], s[62:63] op_sel:[0,0] op_sel_hi:[0,1] neg_lo:[0,1] neg_hi:[0,0]
v_pk_fma_f32 v[30:31], v[28:29], s[62:63], v[30:31] op_sel:[1,1,0] op_sel_hi:[1,0,1] neg_lo:[0,1,0] neg_hi:[0,1,0]
v_pk_add_f32 v[28:29], v[64:65], v[32:33] neg_lo:[0,1] neg_hi:[0,1]
v_pk_add_f32 v[64:65], v[64:65], v[32:33]
v_pk_add_f32 v[32:33], v[34:35], v[42:43] neg_lo:[0,1] neg_hi:[0,1]
v_pk_add_f32 v[34:35], v[34:35], v[42:43]
v_pk_mul_f32 v[42:43], v[32:33], s[62:63] op_sel:[0,0] op_sel_hi:[0,1] neg_lo:[0,0] neg_hi:[0,0]
v_pk_fma_f32 v[42:43], v[32:33], s[62:63], v[42:43] op_sel:[1,1,0] op_sel_hi:[1,0,1] neg_lo:[0,1,0] neg_hi:[0,0,0]
v_pk_add_f32 v[32:33], v[36:37], v[44:45] op_sel:[1,1] op_sel_hi:[0,0] neg_lo:[1,0] neg_hi:[0,1]
v_pk_add_f32 v[36:37], v[36:37], v[44:45]
v_pk_add_f32 v[44:45], v[38:39], v[46:47] neg_lo:[0,1] neg_hi:[0,1]
v_pk_add_f32 v[38:39], v[38:39], v[46:47]
v_pk_mul_f32 v[46:47], v[44:45], s[62:63] op_sel:[0,0] op_sel_hi:[0,1] neg_lo:[0,1] neg_hi:[0,0]
v_pk_fma_f32 v[46:47], v[44:45], s[62:63], v[46:47] op_sel:[1,1,0] op_sel_hi:[1,0,1] neg_lo:[0,1,0] neg_hi:[0,1,0]
v_pk_add_f32 v[44:45], v[14:15], v[56:57] neg_lo:[0,1] neg_hi:[0,1]
v_pk_add_f32 v[14:15], v[14:15], v[56:57]
v_pk_add_f32 v[56:57], v[50:51], v[58:59] neg_lo:[0,1] neg_hi:[0,1]
v_pk_add_f32 v[50:51], v[50:51], v[58:59]
v_pk_mul_f32 v[58:59], v[56:57], s[62:63] op_sel:[0,0] op_sel_hi:[0,1] neg_lo:[0,0] neg_hi:[0,0]
v_pk_fma_f32 v[58:59], v[56:57], s[62:63], v[58:59] op_sel:[1,1,0] op_sel_hi:[1,0,1] neg_lo:[0,1,0] neg_hi:[0,0,0]
v_pk_add_f32 v[56:57], v[52:53], v[60:61] op_sel:[1,1] op_sel_hi:[0,0] neg_lo:[1,0] neg_hi:[0,1]
v_pk_add_f32 v[52:53], v[52:53], v[60:61]
v_pk_add_f32 v[60:61], v[54:55], v[62:63] neg_lo:[0,1] neg_hi:[0,1]
v_pk_add_f32 v[54:55], v[54:55], v[62:63]
v_pk_mul_f32 v[62:63], v[60:61], s[62:63] op_sel:[0,0] op_sel_hi:[0,1] neg_lo:[0,1] neg_hi:[0,0]
v_pk_fma_f32 v[62:63], v[60:61], s[62:63], v[62:63] op_sel:[1,1,0] op_sel_hi:[1,0,1] neg_lo:[0,1,0] neg_hi:[0,1,0]
v_pk_add_f32 v[60:61], v[40:41], v[48:49] neg_lo:[0,1] neg_hi:[0,1]
v_pk_add_f32 v[40:41], v[40:41], v[48:49]
v_pk_add_f32 v[48:49], v[66:67], v[74:75] neg_lo:[0,1] neg_hi:[0,1]
v_pk_add_f32 v[66:67], v[66:67], v[74:75]
v_pk_mul_f32 v[74:75], v[48:49], s[62:63] op_sel:[0,0] op_sel_hi:[0,1] neg_lo:[0,0] neg_hi:[0,0]
v_pk_fma_f32 v[74:75], v[48:49], s[62:63], v[74:75] op_sel:[1,1,0] op_sel_hi:[1,0,1] neg_lo:[0,1,0] neg_hi:[0,0,0]
v_pk_add_f32 v[48:49], v[68:69], v[76:77] op_sel:[1,1] op_sel_hi:[0,0] neg_lo:[1,0] neg_hi:[0,1]
v_pk_add_f32 v[68:69], v[68:69], v[76:77]
v_pk_add_f32 v[76:77], v[70:71], v[78:79] neg_lo:[0,1] neg_hi:[0,1]
v_pk_add_f32 v[70:71], v[70:71], v[78:79]
v_pk_mul_f32 v[78:79], v[76:77], s[62:63] op_sel:[0,0] op_sel_hi:[0,1] neg_lo:[0,1] neg_hi:[0,0]
v_pk_fma_f32 v[78:79], v[76:77], s[62:63], v[78:79] op_sel:[1,1,0] op_sel_hi:[1,0,1] neg_lo:[0,1,0] neg_hi:[0,1,0]
v_pk_add_f32 v[76:77], v[16:17], v[20:21] neg_lo:[0,1] neg_hi:[0,1]
v_pk_add_f32 v[16:17], v[16:17], v[20:21]
v_pk_add_f32 v[20:21], v[18:19], v[22:23] op_sel:[1,1] op_sel_hi:[0,0] neg_lo:[1,0] neg_hi:[0,1]
v_pk_add_f32 v[18:19], v[18:19], v[22:23]
v_pk_add_f32 v[22:23], v[72:73], v[24:25] neg_lo:[0,1] neg_hi:[0,1]
v_pk_add_f32 v[72:73], v[72:73], v[24:25]
v_pk_add_f32 v[24:25], v[26:27], v[30:31] op_sel:[1,1] op_sel_hi:[0,0] neg_lo:[1,0] neg_hi:[0,1]
v_pk_add_f32 v[26:27], v[26:27], v[30:31]
v_pk_add_f32 v[30:31], v[64:65], v[36:37] neg_lo:[0,1] neg_hi:[0,1]
v_pk_add_f32 v[64:65], v[64:65], v[36:37]
v_pk_add_f32 v[36:37], v[34:35], v[38:39] op_sel:[1,1] op_sel_hi:[0,0] neg_lo:[1,0] neg_hi:[0,1]
v_pk_add_f32 v[34:35], v[34:35], v[38:39]
v_pk_add_f32 v[38:39], v[28:29], v[32:33] neg_lo:[0,1] neg_hi:[0,1]
v_pk_add_f32 v[28:29], v[28:29], v[32:33]
v_pk_add_f32 v[32:33], v[42:43], v[46:47] op_sel:[1,1] op_sel_hi:[0,0] neg_lo:[1,0] neg_hi:[0,1]
v_pk_add_f32 v[42:43], v[42:43], v[46:47]
v_pk_add_f32 v[46:47], v[14:15], v[52:53] neg_lo:[0,1] neg_hi:[0,1]
v_pk_add_f32 v[14:15], v[14:15], v[52:53]
v_pk_add_f32 v[52:53], v[50:51], v[54:55] op_sel:[1,1] op_sel_hi:[0,0] neg_lo:[1,0] neg_hi:[0,1]
v_pk_add_f32 v[50:51], v[50:51], v[54:55]
v_pk_add_f32 v[54:55], v[44:45], v[56:57] neg_lo:[0,1] neg_hi:[0,1]
v_pk_add_f32 v[44:45], v[44:45], v[56:57]
v_pk_add_f32 v[56:57], v[58:59], v[62:63] op_sel:[1,1] op_sel_hi:[0,0] neg_lo:[1,0] neg_hi:[0,1]
v_pk_add_f32 v[58:59], v[58:59], v[62:63]
v_pk_add_f32 v[62:63], v[40:41], v[68:69] neg_lo:[0,1] neg_hi:[0,1]
v_pk_add_f32 v[40:41], v[40:41], v[68:69]
v_pk_add_f32 v[68:69], v[66:67], v[70:71] op_sel:[1,1] op_sel_hi:[0,0] neg_lo:[1,0] neg_hi:[0,1]
v_pk_add_f32 v[66:67], v[66:67], v[70:71]
v_pk_add_f32 v[70:71], v[60:61], v[48:49] neg_lo:[0,1] neg_hi:[0,1]
v_pk_add_f32 v[60:61], v[60:61], v[48:49]
v_pk_add_f32 v[48:49], v[74:75], v[78:79] op_sel:[1,1] op_sel_hi:[0,0] neg_lo:[1,0] neg_hi:[0,1]
v_pk_add_f32 v[74:75], v[74:75], v[78:79]
v_pk_add_f32 v[78:79], v[16:17], v[18:19] neg_lo:[0,1] neg_hi:[0,1]
v_pk_add_f32 v[16:17], v[16:17], v[18:19]
v_pk_add_f32 v[18:19], v[76:77], v[20:21] neg_lo:[0,1] neg_hi:[0,1]
v_pk_add_f32 v[76:77], v[76:77], v[20:21]
v_pk_add_f32 v[20:21], v[72:73], v[26:27] neg_lo:[0,1] neg_hi:[0,1]
v_pk_add_f32 v[72:73], v[72:73], v[26:27]
v_pk_add_f32 v[26:27], v[22:23], v[24:25] neg_lo:[0,1] neg_hi:[0,1]
v_pk_add_f32 v[22:23], v[22:23], v[24:25]
v_pk_add_f32 v[24:25], v[64:65], v[34:35] neg_lo:[0,1] neg_hi:[0,1]
v_pk_add_f32 v[64:65], v[64:65], v[34:35]
v_pk_add_f32 v[34:35], v[30:31], v[36:37] neg_lo:[0,1] neg_hi:[0,1]
v_pk_add_f32 v[30:31], v[30:31], v[36:37]
v_pk_add_f32 v[36:37], v[28:29], v[42:43] neg_lo:[0,1] neg_hi:[0,1]
v_pk_add_f32 v[28:29], v[28:29], v[42:43]
v_pk_add_f32 v[42:43], v[38:39], v[32:33] neg_lo:[0,1] neg_hi:[0,1]
v_pk_add_f32 v[38:39], v[38:39], v[32:33]
v_pk_add_f32 v[32:33], v[14:15], v[50:51] neg_lo:[0,1] neg_hi:[0,1]
v_pk_add_f32 v[14:15], v[14:15], v[50:51]
v_pk_add_f32 v[50:51], v[46:47], v[52:53] neg_lo:[0,1] neg_hi:[0,1]
v_pk_add_f32 v[46:47], v[46:47], v[52:53]
v_pk_add_f32 v[52:53], v[44:45], v[58:59] neg_lo:[0,1] neg_hi:[0,1]
v_pk_add_f32 v[44:45], v[44:45], v[58:59]
v_pk_add_f32 v[58:59], v[54:55], v[56:57] neg_lo:[0,1] neg_hi:[0,1]
v_pk_add_f32 v[54:55], v[54:55], v[56:57]
v_pk_add_f32 v[56:57], v[40:41], v[66:67] neg_lo:[0,1] neg_hi:[0,1]
v_pk_add_f32 v[40:41], v[40:41], v[66:67]
v_pk_add_f32 v[66:67], v[62:63], v[68:69] neg_lo:[0,1] neg_hi:[0,1]
v_pk_add_f32 v[62:63], v[62:63], v[68:69]
v_pk_add_f32 v[68:69], v[60:61], v[74:75] neg_lo:[0,1] neg_hi:[0,1]
v_pk_add_f32 v[60:61], v[60:61], v[74:75]
v_pk_add_f32 v[74:75], v[70:71], v[48:49] neg_lo:[0,1] neg_hi:[0,1]
v_pk_add_f32 v[70:71], v[70:71], v[48:49]
s_lshl_b32 s12, s38, 2
s_add_u32 s12, s12, s16
s_min_u32 s12, s12, 512
s_lshl_b32 s12, s12, 14
s_add_u32 s12, s12, 109051904
buffer_store_dwordx2 v[16:17], v5, s[84:87], s12 offen offset:0 sc1
buffer_store_dwordx2 v[14:15], v5, s[84:87], s12 offen offset:512 sc1
buffer_store_dwordx2 v[64:65], v5, s[84:87], s12 offen offset:1024 sc1
buffer_store_dwordx2 v[40:41], v5, s[84:87], s12 offen offset:1536 sc1
buffer_store_dwordx2 v[72:73], v5, s[84:87], s12 offen offset:2048 sc1
buffer_store_dwordx2 v[44:45], v5, s[84:87], s12 offen offset:2560 sc1
buffer_store_dwordx2 v[28:29], v5, s[84:87], s12 offen offset:3072 sc1
buffer_store_dwordx2 v[60:61], v5, s[84:87], s12 offen offset:3584 sc1
s_add_u32 s12, s12, 4096
buffer_store_dwordx2 v[76:77], v5, s[84:87], s12 offen offset:0 sc1
buffer_store_dwordx2 v[46:47], v5, s[84:87], s12 offen offset:512 sc1
buffer_store_dwordx2 v[30:31], v5, s[84:87], s12 offen offset:1024 sc1
buffer_store_dwordx2 v[62:63], v5, s[84:87], s12 offen offset:1536 sc1
buffer_store_dwordx2 v[22:23], v5, s[84:87], s12 offen offset:2048 sc1
buffer_store_dwordx2 v[54:55], v5, s[84:87], s12 offen offset:2560 sc1
buffer_store_dwordx2 v[38:39], v5, s[84:87], s12 offen offset:3072 sc1
buffer_store_dwordx2 v[70:71], v5, s[84:87], s12 offen offset:3584 sc1
s_add_u32 s12, s12, 4096
buffer_store_dwordx2 v[78:79], v5, s[84:87], s12 offen offset:0 sc1
buffer_store_dwordx2 v[32:33], v5, s[84:87], s12 offen offset:512 sc1
buffer_store_dwordx2 v[24:25], v5, s[84:87], s12 offen offset:1024 sc1
buffer_store_dwordx2 v[56:57], v5, s[84:87], s12 offen offset:1536 sc1
buffer_store_dwordx2 v[20:21], v5, s[84:87], s12 offen offset:2048 sc1
buffer_store_dwordx2 v[52:53], v5, s[84:87], s12 offen offset:2560 sc1
buffer_store_dwordx2 v[36:37], v5, s[84:87], s12 offen offset:3072 sc1
buffer_store_dwordx2 v[68:69], v5, s[84:87], s12 offen offset:3584 sc1
s_add_u32 s12, s12, 4096
buffer_store_dwordx2 v[18:19], v5, s[84:87], s12 offen offset:0 sc1
buffer_store_dwordx2 v[50:51], v5, s[84:87], s12 offen offset:512 sc1
buffer_store_dwordx2 v[34:35], v5, s[84:87], s12 offen offset:1024 sc1
buffer_store_dwordx2 v[66:67], v5, s[84:87], s12 offen offset:1536 sc1
buffer_store_dwordx2 v[26:27], v5, s[84:87], s12 offen offset:2048 sc1
buffer_store_dwordx2 v[58:59], v5, s[84:87], s12 offen offset:2560 sc1
buffer_store_dwordx2 v[42:43], v5, s[84:87], s12 offen offset:3072 sc1
buffer_store_dwordx2 v[74:75], v5, s[84:87], s12 offen offset:3584 sc1
s_add_u32 s12, s12, 4096
s_mov_b32 s38, s21
s_cmp_lt_u32 s38, s37
s_cbranch_scc1 mega_kernel_f2_l
mega_kernel_f2_e:
mega_kernel_f2e:
s_waitcnt vmcnt(0)
s_barrier
v_mov_b32 v1, 0
v_mov_b32 v2, 1
s_mov_b32 s82, 69259392
v_cmp_eq_u32 vcc, 0, v0
s_and_saveexec_b64 s[80:81], vcc
s_cbranch_execz mega_kernel_sg1
buffer_atomic_add v2, v1, s[84:87], s82 offen sc1
mega_kernel_sg1:
s_mov_b64 exec, s[80:81]
s_mov_b32 s64, 0
s_mov_b32 s65, 62
s_mov_b32 s66, 0
s_mov_b32 s67, 0
s_cmp_eq_u32 s91, 3
s_cbranch_scc1 mega_kernel_out
v_mov_b32 v1, 0
s_mov_b32 s82, 69259392
mega_kernel_w1:
s_sleep 8
buffer_load_dword v2, v1, s[84:87], s82 offen sc1
s_waitcnt vmcnt(0)
v_cmp_ne_u32 vcc, 95, v2
s_cbranch_vccnz mega_kernel_w1
s_mov_b32 s93, s92
s_load_dwordx2 s[4:5], s[0:1], 80
s_mov_b32 s48, 0x3f7ec46d
s_mov_b32 s49, 0x3dc8bd36
s_mov_b32 s50, 0x3f7b14be
s_mov_b32 s51, 0x3e47c5c2
s_mov_b32 s52, 0x3f74fa0b
s_mov_b32 s53, 0x3e94a031
s_mov_b32 s54, 0x3f6c835e
s_mov_b32 s55, 0x3ec3ef15
s_mov_b32 s56, 0x3f61c598
s_mov_b32 s57, 0x3ef15aea
s_mov_b32 s58, 0x3f54db31
s_mov_b32 s59, 0x3f0e39da
s_mov_b32 s60, 0x3f45e403
s_mov_b32 s61, 0x3f226799
s_mov_b32 s62, 0x3f3504f3
s_mov_b32 s63, 0x3f3504f3
v_and_b32 v1, 31, v0
v_lshrrev_b32 v2, 5, v0
v_cvt_f32_u32 v3, v1
v_mul_u32_u24 v10, 8448, v2
v_lshl_add_u32 v4, v1, 3, v10
v_mul_u32_u24 v5, 264, v1
v_add_u32 v5, v5, v10
v_and_b32 v11, 7, v0
v_lshrrev_b32 v9, 3, v0
v_mul_u32_u24 v10, 8448, v11
v_lshl_add_u32 v6, v9, 3, v10
v_lshlrev_b32 v7, 3, v9
v_sub_u32 v7, v10, v7
v_add_u32 v7, 4096, v7
v_lshlrev_b32 v8, 14, v9
v_lshl_add_u32 v8, v11, 4, v8
v_mul_f32 v12, 0x3a800000, v3
v_cos_f32 v82, v12
v_sin_f32 v83, v12
v_mul_f32 v12, 0x3b000000, v3
v_cos_f32 v84, v12
v_sin_f32 v85, v12
v_mul_f32 v12, 0x3b400000, v3
v_cos_f32 v86, v12
v_sin_f32 v87, v12
v_mul_f32 v12, 0x3b800000, v3
v_cos_f32 v88, v12
v_sin_f32 v89, v12
v_mul_f32 v12, 0x3ba00000, v3
v_cos_f32 v90, v12
v_sin_f32 v91, v12
v_mul_f32 v12, 0x3bc00000, v3
v_cos_f32 v92, v12
v_sin_f32 v93, v12
v_mul_f32 v12, 0x3be00000, v3
v_cos_f32 v94, v12
v_sin_f32 v95, v12
v_mul_f32 v12, 0x3c000000, v3
v_cos_f32 v96, v12
v_sin_f32 v97, v12
v_mul_f32 v12, 0x3c100000, v3
v_cos_f32 v98, v12
v_sin_f32 v99, v12
v_mul_f32 v12, 0x3c200000, v3
v_cos_f32 v100, v12
v_sin_f32 v101, v12
v_mul_f32 v12, 0x3c300000, v3
v_cos_f32 v102, v12
v_sin_f32 v103, v12
v_mul_f32 v12, 0x3c400000, v3
v_cos_f32 v104, v12
v_sin_f32 v105, v12
v_mul_f32 v12, 0x3c500000, v3
v_cos_f32 v106, v12
v_sin_f32 v107, v12
v_mul_f32 v12, 0x3c600000, v3
v_cos_f32 v108, v12
v_sin_f32 v109, v12
v_mul_f32 v12, 0x3c700000, v3
v_cos_f32 v110, v12
v_sin_f32 v111, v12
v_mul_f32 v12, 0x3c800000, v3
v_cos_f32 v112, v12
v_sin_f32 v113, v12
v_mul_f32 v12, 0x3c880000, v3
v_cos_f32 v114, v12
v_sin_f32 v115, v12
v_mul_f32 v12, 0x3c900000, v3
v_cos_f32 v116, v12
v_sin_f32 v117, v12
v_mul_f32 v12, 0x3c980000, v3
v_cos_f32 v118, v12
v_sin_f32 v119, v12
v_mul_f32 v12, 0x3ca00000, v3
v_cos_f32 v120, v12
v_sin_f32 v121, v12
v_mul_f32 v12, 0x3ca80000, v3
v_cos_f32 v122, v12
v_sin_f32 v123, v12
v_mul_f32 v12, 0x3cb00000, v3
v_cos_f32 v124, v12
v_sin_f32 v125, v12
v_mul_f32 v12, 0x3cb80000, v3
v_cos_f32 v126, v12
v_sin_f32 v127, v12
v_mul_f32 v12, 0x3cc00000, v3
v_cos_f32 v128, v12
v_sin_f32 v129, v12
v_mul_f32 v12, 0x3cc80000, v3
v_cos_f32 v130, v12
v_sin_f32 v131, v12
v_mul_f32 v12, 0x3cd00000, v3
v_cos_f32 v132, v12
v_sin_f32 v133, v12
v_mul_f32 v12, 0x3cd80000, v3
v_cos_f32 v134, v12
v_sin_f32 v135, v12
v_mul_f32 v12, 0x3ce00000, v3
v_cos_f32 v136, v12
v_sin_f32 v137, v12
v_mul_f32 v12, 0x3ce80000, v3
v_cos_f32 v138, v12
v_sin_f32 v139, v12
v_mul_f32 v12, 0x3cf00000, v3
v_cos_f32 v140, v12
v_sin_f32 v141, v12
v_mul_f32 v12, 0x3cf80000, v3
v_cos_f32 v142, v12
v_sin_f32 v143, v12
v_lshlrev_b32 v12, 2, v1
v_sub_u32 v12, v4, v12
v_and_b32 v10, 127, v0
v_lshrrev_b32 v11, 7, v0
v_lshlrev_b32 v2, 5, v10
v_lshl_add_u32 v2, v11, 12, v2
v_lshlrev_b32 v3, 4, v10
v_lshl_add_u32 v3, v11, 12, v3
v_add_u32 v3, 2048, v3
v_cmp_eq_u32 s[14:15], 0, v9
s_waitcnt lgkmcnt(0)
s_mov_b32 s6, 8388608
s_mov_b32 s7, 0x00020000
s_cmp_lt_u32 s93, 128
s_cbranch_scc0 mega_kernel_f3_e
s_lshl_b32 s12, s93, 7
s_add_u32 s12, s12, 109051904
buffer_load_dwordx4 v[144:147], v8, s[84:87], s12 offen sc1
s_add_u32 s12, s12, 524288
buffer_load_dwordx4 v[148:151], v8, s[84:87], s12 offen sc1
s_add_u32 s12, s12, 524288
buffer_load_dwordx4 v[152:155], v8, s[84:87], s12 offen sc1
s_add_u32 s12, s12, 524288
buffer_load_dwordx4 v[156:159], v8, s[84:87], s12 offen sc1
s_add_u32 s12, s12, 524288
buffer_load_dwordx4 v[160:163], v8, s[84:87], s12 offen sc1
s_add_u32 s12, s12, 524288
buffer_load_dwordx4 v[164:167], v8, s[84:87], s12 offen sc1
s_add_u32 s12, s12, 524288
buffer_load_dwordx4 v[168:171], v8, s[84:87], s12 offen sc1
s_add_u32 s12, s12, 524288
buffer_load_dwordx4 v[172:175], v8, s[84:87], s12 offen sc1
s_add_u32 s12, s12, 524288
buffer_load_dwordx4 v[176:179], v8, s[84:87], s12 offen sc1
s_add_u32 s12, s12, 524288
buffer_load_dwordx4 v[180:183], v8, s[84:87], s12 offen sc1
s_add_u32 s12, s12, 524288
buffer_load_dwordx4 v[184:187], v8, s[84:87], s12 offen sc1
s_add_u32 s12, s12, 524288
buffer_load_dwordx4 v[188:191], v8, s[84:87], s12 offen sc1
s_add_u32 s12, s12, 524288
buffer_load_dwordx4 v[192:195], v8, s[84:87], s12 offen sc1
s_add_u32 s12, s12, 524288
buffer_load_dwordx4 v[196:199], v8, s[84:87], s12 offen sc1
s_add_u32 s12, s12, 524288
buffer_load_dwordx4 v[200:203], v8, s[84:87], s12 offen sc1
s_add_u32 s12, s12, 524288
buffer_load_dwordx4 v[204:207], v8, s[84:87], s12 offen sc1
s_add_u32 s12, s12, 524288
buffer_load_dwordx4 v[208:211], v8, s[84:87], s12 offen sc1
s_add_u32 s12, s12, 524288
s_waitcnt vmcnt(0)
mega_kernel_f3_l:
s_add_u32 s21, s93, 64
s_cmp_lt_u32 s21, 128
s_cselect_b32 s22, s21, s93
s_waitcnt vmcnt(8)
s_barrier
v_cndmask_b32 v145, v145, 0, s[14:15]
v_cndmask_b32 v147, v147, 0, s[14:15]
v_cndmask_b32 v209, v209, 0, s[14:15]
v_cndmask_b32 v211, v211, 0, s[14:15]
v_pk_add_f32 v[16:17], v[144:145], v[146:147] op_sel:[0,1] op_sel_hi:[1,0] neg_lo:[0,1]
v_pk_add_f32 v[18:19], v[144:145], v[146:147] op_sel:[0,1] op_sel_hi:[1,0] neg_hi:[1,0]
ds_write_b64 v6, v[16:17] offset:0
ds_write_b64 v7, v[18:19] offset:4096
v_pk_add_f32 v[20:21], v[148:149], v[150:151] op_sel:[0,1] op_sel_hi:[1,0] neg_lo:[0,1]
v_pk_add_f32 v[22:23], v[148:149], v[150:151] op_sel:[0,1] op_sel_hi:[1,0] neg_hi:[1,0]
ds_write_b64 v6, v[20:21] offset:256
ds_write_b64 v7, v[22:23] offset:3840
v_pk_add_f32 v[24:25], v[152:153], v[154:155] op_sel:[0,1] op_sel_hi:[1,0] neg_lo:[0,1]
v_pk_add_f32 v[26:27], v[152:153], v[154:155] op_sel:[0,1] op_sel_hi:[1,0] neg_hi:[1,0]
ds_write_b64 v6, v[24:25] offset:512
ds_write_b64 v7, v[26:27] offset:3584
v_pk_add_f32 v[28:29], v[156:157], v[158:159] op_sel:[0,1] op_sel_hi:[1,0] neg_lo:[0,1]
v_pk_add_f32 v[30:31], v[156:157], v[158:159] op_sel:[0,1] op_sel_hi:[1,0] neg_hi:[1,0]
ds_write_b64 v6, v[28:29] offset:768
ds_write_b64 v7, v[30:31] offset:3328
v_pk_add_f32 v[32:33], v[160:161], v[162:163] op_sel:[0,1] op_sel_hi:[1,0] neg_lo:[0,1]
v_pk_add_f32 v[34:35], v[160:161], v[162:163] op_sel:[0,1] op_sel_hi:[1,0] neg_hi:[1,0]
ds_write_b64 v6, v[32:33] offset:1024
ds_write_b64 v7, v[34:35] offset:3072
v_pk_add_f32 v[36:37], v[164:165], v[166:167] op_sel:[0,1] op_sel_hi:[1,0] neg_lo:[0,1]
v_pk_add_f32 v[38:39], v[164:165], v[166:167] op_sel:[0,1] op_sel_hi:[1,0] neg_hi:[1,0]
ds_write_b64 v6, v[36:37] offset:1280
ds_write_b64 v7, v[38:39] offset:2816
v_pk_add_f32 v[40:41], v[168:169], v[170:171] op_sel:[0,1] op_sel_hi:[1,0] neg_lo:[0,1]
v_pk_add_f32 v[42:43], v[168:169], v[170:171] op_sel:[0,1] op_sel_hi:[1,0] neg_hi:[1,0]
ds_write_b64 v6, v[40:41] offset:1536
ds_write_b64 v7, v[42:43] offset:2560
v_pk_add_f32 v[44:45], v[172:173], v[174:175] op_sel:[0,1] op_sel_hi:[1,0] neg_lo:[0,1]
v_pk_add_f32 v[46:47], v[172:173], v[174:175] op_sel:[0,1] op_sel_hi:[1,0] neg_hi:[1,0]
ds_write_b64 v6, v[44:45] offset:1792
ds_write_b64 v7, v[46:47] offset:2304
v_pk_add_f32 v[48:49], v[176:177], v[178:179] op_sel:[0,1] op_sel_hi:[1,0] neg_lo:[0,1]
v_pk_add_f32 v[50:51], v[176:177], v[178:179] op_sel:[0,1] op_sel_hi:[1,0] neg_hi:[1,0]
ds_write_b64 v6, v[48:49] offset:2048
ds_write_b64 v7, v[50:51] offset:2048
v_pk_add_f32 v[52:53], v[180:181], v[182:183] op_sel:[0,1] op_sel_hi:[1,0] neg_lo:[0,1]
v_pk_add_f32 v[54:55], v[180:181], v[182:183] op_sel:[0,1] op_sel_hi:[1,0] neg_hi:[1,0]
ds_write_b64 v6, v[52:53] offset:2304
ds_write_b64 v7, v[54:55] offset:1792
v_pk_add_f32 v[56:57], v[184:185], v[186:187] op_sel:[0,1] op_sel_hi:[1,0] neg_lo:[0,1]
v_pk_add_f32 v[58:59], v[184:185], v[186:187] op_sel:[0,1] op_sel_hi:[1,0] neg_hi:[1,0]
ds_write_b64 v6, v[56:57] offset:2560
ds_write_b64 v7, v[58:59] offset:1536
v_pk_add_f32 v[60:61], v[188:189], v[190:191] op_sel:[0,1] op_sel_hi:[1,0] neg_lo:[0,1]
v_pk_add_f32 v[62:63], v[188:189], v[190:191] op_sel:[0,1] op_sel_hi:[1,0] neg_hi:[1,0]
ds_write_b64 v6, v[60:61] offset:2816
ds_write_b64 v7, v[62:63] offset:1280
v_pk_add_f32 v[64:65], v[192:193], v[194:195] op_sel:[0,1] op_sel_hi:[1,0] neg_lo:[0,1]
v_pk_add_f32 v[66:67], v[192:193], v[194:195] op_sel:[0,1] op_sel_hi:[1,0] neg_hi:[1,0]
ds_write_b64 v6, v[64:65] offset:3072
ds_write_b64 v7, v[66:67] offset:1024
v_pk_add_f32 v[68:69], v[196:197], v[198:199] op_sel:[0,1] op_sel_hi:[1,0] neg_lo:[0,1]
v_pk_add_f32 v[70:71], v[196:197], v[198:199] op_sel:[0,1] op_sel_hi:[1,0] neg_hi:[1,0]
ds_write_b64 v6, v[68:69] offset:3328
ds_write_b64 v7, v[70:71] offset:768
v_pk_add_f32 v[72:73], v[200:201], v[202:203] op_sel:[0,1] op_sel_hi:[1,0] neg_lo:[0,1]
v_pk_add_f32 v[74:75], v[200:201], v[202:203] op_sel:[0,1] op_sel_hi:[1,0] neg_hi:[1,0]
ds_write_b64 v6, v[72:73] offset:3584
ds_write_b64 v7, v[74:75] offset:512
s_waitcnt lgkmcnt(8)
v_pk_add_f32 v[76:77], v[204:205], v[206:207] op_sel:[0,1] op_sel_hi:[1,0] neg_lo:[0,1]
v_pk_add_f32 v[78:79], v[204:205], v[206:207] op_sel:[0,1] op_sel_hi:[1,0] neg_hi:[1,0]
ds_write_b64 v6, v[76:77] offset:3840
ds_write_b64 v7, v[78:79] offset:256
v_pk_add_f32 v[16:17], v[208:209], v[210:211] op_sel:[0,1] op_sel_hi:[1,0] neg_lo:[0,1]
v_pk_add_f32 v[18:19], v[208:209], v[210:211] op_sel:[0,1] op_sel_hi:[1,0] neg_hi:[1,0]
s_mov_b64 exec, s[14:15]
ds_write_b64 v6, v[16:17] offset:4096
s_mov_b64 exec, -1
s_lshl_b32 s12, s22, 7
s_add_u32 s12, s12, 109051904
buffer_load_dwordx4 v[144:147], v8, s[84:87], s12 offen sc1
s_add_u32 s12, s12, 524288
buffer_load_dwordx4 v[148:151], v8, s[84:87], s12 offen sc1
s_add_u32 s12, s12, 524288
buffer_load_dwordx4 v[152:155], v8, s[84:87], s12 offen sc1
s_add_u32 s12, s12, 524288
buffer_load_dwordx4 v[156:159], v8, s[84:87], s12 offen sc1
s_add_u32 s12, s12, 524288
buffer_load_dwordx4 v[160:163], v8, s[84:87], s12 offen sc1
s_add_u32 s12, s12, 524288
buffer_load_dwordx4 v[164:167], v8, s[84:87], s12 offen sc1
s_add_u32 s12, s12, 524288
buffer_load_dwordx4 v[168:171], v8, s[84:87], s12 offen sc1
s_add_u32 s12, s12, 524288
buffer_load_dwordx4 v[172:175], v8, s[84:87], s12 offen sc1
s_add_u32 s12, s12, 524288
buffer_load_dwordx4 v[176:179], v8, s[84:87], s12 offen sc1
s_add_u32 s12, s12, 524288
buffer_load_dwordx4 v[180:183], v8, s[84:87], s12 offen sc1
s_add_u32 s12, s12, 524288
buffer_load_dwordx4 v[184:187], v8, s[84:87], s12 offen sc1
s_add_u32 s12, s12, 524288
buffer_load_dwordx4 v[188:191], v8, s[84:87], s12 offen sc1
s_add_u32 s12, s12, 524288
buffer_load_dwordx4 v[192:195], v8, s[84:87], s12 offen sc1
s_add_u32 s12, s12, 524288
buffer_load_dwordx4 v[196:199], v8, s[84:87], s12 offen sc1
s_add_u32 s12, s12, 524288
buffer_load_dwordx4 v[200:203], v8, s[84:87], s12 offen sc1
s_add_u32 s12, s12, 524288
buffer_load_dwordx4 v[204:207], v8, s[84:87], s12 offen sc1
s_add_u32 s12, s12, 524288
buffer_load_dwordx4 v[208:211], v8, s[84:87], s12 offen sc1
s_add_u32 s12, s12, 524288
s_waitcnt lgkmcnt(0)
s_barrier
ds_read_b64 v[16:17], v4 offset:0
ds_read_b64 v[48:49], v4 offset:4096
ds_read_b64 v[18:19], v4 offset:256
ds_read_b64 v[50:51], v4 offset:4352
ds_read_b64 v[20:21], v4 offset:512
ds_read_b64 v[52:53], v4 offset:4608
ds_read_b64 v[22:23], v4 offset:768
ds_read_b64 v[54:55], v4 offset:4864
ds_read_b64 v[24:25], v4 offset:1024
ds_read_b64 v[56:57], v4 offset:5120
ds_read_b64 v[26:27], v4 offset:1280
ds_read_b64 v[58:59], v4 offset:5376
ds_read_b64 v[28:29], v4 offset:1536
ds_read_b64 v[60:61], v4 offset:5632
ds_read_b64 v[30:31], v4 offset:1792
ds_read_b64 v[62:63], v4 offset:5888
ds_read_b64 v[32:33], v4 offset:2048
ds_read_b64 v[64:65], v4 offset:6144
ds_read_b64 v[34:35], v4 offset:2304
ds_read_b64 v[66:67], v4 offset:6400
ds_read_b64 v[36:37], v4 offset:2560
ds_read_b64 v[68:69], v4 offset:6656
ds_read_b64 v[38:39], v4 offset:2816
ds_read_b64 v[70:71], v4 offset:6912
ds_read_b64 v[40:41], v4 offset:3072
ds_read_b64 v[72:73], v4 offset:7168
ds_read_b64 v[42:43], v4 offset:3328
ds_read_b64 v[74:75], v4 offset:7424
ds_read_b64 v[44:45], v4 offset:3584
ds_read_b64 v[76:77], v4 offset:7680
ds_read_b64 v[46:47], v4 offset:3840
ds_read_b64 v[78:79], v4 offset:7936
s_waitcnt lgkmcnt(0)
v_pk_add_f32 v[14:15], v[16:17], v[48:49] neg_lo:[0,1] neg_hi:[0,1]
v_pk_add_f32 v[16:17], v[16:17], v[48:49]
v_pk_add_f32 v[48:49], v[18:19], v[50:51] neg_lo:[0,1] neg_hi:[0,1]
v_pk_add_f32 v[18:19], v[18:19], v[50:51]
v_pk_mul_f32 v[50:51], v[48:49], s[50:51] op_sel:[0,0] op_sel_hi:[0,1] neg_lo:[0,0] neg_hi:[0,0]
v_pk_fma_f32 v[50:51], v[48:49], s[50:51], v[50:51] op_sel:[1,1,0] op_sel_hi:[1,0,1] neg_lo:[0,1,0] neg_hi:[0,0,0]
v_pk_add_f32 v[48:49], v[20:21], v[52:53] neg_lo:[0,1] neg_hi:[0,1]
v_pk_add_f32 v[20:21], v[20:21], v[52:53]
v_pk_mul_f32 v[52:53], v[48:49], s[54:55] op_sel:[0,0] op_sel_hi:[0,1] neg_lo:[0,0] neg_hi:[0,0]
v_pk_fma_f32 v[52:53], v[48:49], s[54:55], v[52:53] op_sel:[1,1,0] op_sel_hi:[1,0,1] neg_lo:[0,1,0] neg_hi:[0,0,0]
v_pk_add_f32 v[48:49], v[22:23], v[54:55] neg_lo:[0,1] neg_hi:[0,1]
v_pk_add_f32 v[22:23], v[22:23], v[54:55]
v_pk_mul_f32 v[54:55], v[48:49], s[58:59] op_sel:[0,0] op_sel_hi:[0,1] neg_lo:[0,0] neg_hi:[0,0]
v_pk_fma_f32 v[54:55], v[48:49], s[58:59], v[54:55] op_sel:[1,1,0] op_sel_hi:[1,0,1] neg_lo:[0,1,0] neg_hi:[0,0,0]
v_pk_add_f32 v[48:49], v[24:25], v[56:57] neg_lo:[0,1] neg_hi:[0,1]
v_pk_add_f32 v[24:25], v[24:25], v[56:57]
v_pk_mul_f32 v[56:57], v[48:49], s[62:63] op_sel:[0,0] op_sel_hi:[0,1] neg_lo:[0,0] neg_hi:[0,0]
v_pk_fma_f32 v[56:57], v[48:49], s[62:63], v[56:57] op_sel:[1,1,0] op_sel_hi:[1,0,1] neg_lo:[0,1,0] neg_hi:[0,0,0]
v_pk_add_f32 v[48:49], v[26:27], v[58:59] neg_lo:[0,1] neg_hi:[0,1]
v_pk_add_f32 v[26:27], v[26:27], v[58:59]
v_pk_mul_f32 v[58:59], v[48:49], s[58:59] op_sel:[0,1] op_sel_hi:[0,0] neg_lo:[0,0] neg_hi:[0,0]
v_pk_fma_f32 v[58:59], v[48:49], s[58:59], v[58:59] op_sel:[1,0,0] op_sel_hi:[1,1,1] neg_lo:[0,1,0] neg_hi:[0,0,0]
v_pk_add_f32 v[48:49], v[28:29], v[60:61] neg_lo:[0,1] neg_hi:[0,1]
v_pk_add_f32 v[28:29], v[28:29], v[60:61]
v_pk_mul_f32 v[60:61], v[48:49], s[54:55] op_sel:[0,1] op_sel_hi:[0,0] neg_lo:[0,0] neg_hi:[0,0]
v_pk_fma_f32 v[60:61], v[48:49], s[54:55], v[60:61] op_sel:[1,0,0] op_sel_hi:[1,1,1] neg_lo:[0,1,0] neg_hi:[0,0,0]
v_pk_add_f32 v[48:49], v[30:31], v[62:63] neg_lo:[0,1] neg_hi:[0,1]
v_pk_add_f32 v[30:31], v[30:31], v[62:63]
v_pk_mul_f32 v[62:63], v[48:49], s[50:51] op_sel:[0,1] op_sel_hi:[0,0] neg_lo:[0,0] neg_hi:[0,0]
v_pk_fma_f32 v[62:63], v[48:49], s[50:51], v[62:63] op_sel:[1,0,0] op_sel_hi:[1,1,1] neg_lo:[0,1,0] neg_hi:[0,0,0]
v_pk_add_f32 v[48:49], v[32:33], v[64:65] op_sel:[1,1] op_sel_hi:[0,0] neg_lo:[1,0] neg_hi:[0,1]
v_pk_add_f32 v[32:33], v[32:33], v[64:65]
v_pk_add_f32 v[64:65], v[34:35], v[66:67] neg_lo:[0,1] neg_hi:[0,1]
v_pk_add_f32 v[34:35], v[34:35], v[66:67]
v_pk_mul_f32 v[66:67], v[64:65], s[50:51] op_sel:[0,1] op_sel_hi:[0,0] neg_lo:[0,1] neg_hi:[0,0]
v_pk_fma_f32 v[66:67], v[64:65], s[50:51], v[66:67] op_sel:[1,0,0] op_sel_hi:[1,1,1] neg_lo:[0,1,0] neg_hi:[0,1,0]
v_pk_add_f32 v[64:65], v[36:37], v[68:69] neg_lo:[0,1] neg_hi:[0,1]
v_pk_add_f32 v[36:37], v[36:37], v[68:69]
v_pk_mul_f32 v[68:69], v[64:65], s[54:55] op_sel:[0,1] op_sel_hi:[0,0] neg_lo:[0,1] neg_hi:[0,0]
v_pk_fma_f32 v[68:69], v[64:65], s[54:55], v[68:69] op_sel:[1,0,0] op_sel_hi:[1,1,1] neg_lo:[0,1,0] neg_hi:[0,1,0]
v_pk_add_f32 v[64:65], v[38:39], v[70:71] neg_lo:[0,1] neg_hi:[0,1]
v_pk_add_f32 v[38:39], v[38:39], v[70:71]
v_pk_mul_f32 v[70:71], v[64:65], s[58:59] op_sel:[0,1] op_sel_hi:[0,0] neg_lo:[0,1] neg_hi:[0,0]
v_pk_fma_f32 v[70:71], v[64:65], s[58:59], v[70:71] op_sel:[1,0,0] op_sel_hi:[1,1,1] neg_lo:[0,1,0] neg_hi:[0,1,0]
v_pk_add_f32 v[64:65], v[40:41], v[72:73] neg_lo:[0,1] neg_hi:[0,1]
v_pk_add_f32 v[40:41], v[40:41], v[72:73]
v_pk_mul_f32 v[72:73], v[64:65], s[62:63] op_sel:[0,0] op_sel_hi:[0,1] neg_lo:[0,1] neg_hi:[0,0]
v_pk_fma_f32 v[72:73], v[64:65], s[62:63], v[72:73] op_sel:[1,1,0] op_sel_hi:[1,0,1] neg_lo:[0,1,0] neg_hi:[0,1,0]
v_pk_add_f32 v[64:65], v[42:43], v[74:75] neg_lo:[0,1] neg_hi:[0,1]
v_pk_add_f32 v[42:43], v[42:43], v[74:75]
v_pk_mul_f32 v[74:75], v[64:65], s[58:59] op_sel:[0,0] op_sel_hi:[0,1] neg_lo:[0,1] neg_hi:[0,0]
v_pk_fma_f32 v[74:75], v[64:65], s[58:59], v[74:75] op_sel:[1,1,0] op_sel_hi:[1,0,1] neg_lo:[0,1,0] neg_hi:[0,1,0]
v_pk_add_f32 v[64:65], v[44:45], v[76:77] neg_lo:[0,1] neg_hi:[0,1]
v_pk_add_f32 v[44:45], v[44:45], v[76:77]
v_pk_mul_f32 v[76:77], v[64:65], s[54:55] op_sel:[0,0] op_sel_hi:[0,1] neg_lo:[0,1] neg_hi:[0,0]
v_pk_fma_f32 v[76:77], v[64:65], s[54:55], v[76:77] op_sel:[1,1,0] op_sel_hi:[1,0,1] neg_lo:[0,1,0] neg_hi:[0,1,0]
v_pk_add_f32 v[64:65], v[46:47], v[78:79] neg_lo:[0,1] neg_hi:[0,1]
v_pk_add_f32 v[46:47], v[46:47], v[78:79]
v_pk_mul_f32 v[78:79], v[64:65], s[50:51] op_sel:[0,0] op_sel_hi:[0,1] neg_lo:[0,1] neg_hi:[0,0]
v_pk_fma_f32 v[78:79], v[64:65], s[50:51], v[78:79] op_sel:[1,1,0] op_sel_hi:[1,0,1] neg_lo:[0,1,0] neg_hi:[0,1,0]
v_pk_add_f32 v[64:65], v[16:17], v[32:33] neg_lo:[0,1] neg_hi:[0,1]
v_pk_add_f32 v[16:17], v[16:17], v[32:33]
v_pk_add_f32 v[32:33], v[18:19], v[34:35] neg_lo:[0,1] neg_hi:[0,1]
v_pk_add_f32 v[18:19], v[18:19], v[34:35]
v_pk_mul_f32 v[34:35], v[32:33], s[54:55] op_sel:[0,0] op_sel_hi:[0,1] neg_lo:[0,0] neg_hi:[0,0]
v_pk_fma_f32 v[34:35], v[32:33], s[54:55], v[34:35] op_sel:[1,1,0] op_sel_hi:[1,0,1] neg_lo:[0,1,0] neg_hi:[0,0,0]
v_pk_add_f32 v[32:33], v[20:21], v[36:37] neg_lo:[0,1] neg_hi:[0,1]
v_pk_add_f32 v[20:21], v[20:21], v[36:37]
v_pk_mul_f32 v[36:37], v[32:33], s[62:63] op_sel:[0,0] op_sel_hi:[0,1] neg_lo:[0,0] neg_hi:[0,0]
v_pk_fma_f32 v[36:37], v[32:33], s[62:63], v[36:37] op_sel:[1,1,0] op_sel_hi:[1,0,1] neg_lo:[0,1,0] neg_hi:[0,0,0]
v_pk_add_f32 v[32:33], v[22:23], v[38:39] neg_lo:[0,1] neg_hi:[0,1]
v_pk_add_f32 v[22:23], v[22:23], v[38:39]
v_pk_mul_f32 v[38:39], v[32:33], s[54:55] op_sel:[0,1] op_sel_hi:[0,0] neg_lo:[0,0] neg_hi:[0,0]
v_pk_fma_f32 v[38:39], v[32:33], s[54:55], v[38:39] op_sel:[1,0,0] op_sel_hi:[1,1,1] neg_lo:[0,1,0] neg_hi:[0,0,0]
v_pk_add_f32 v[32:33], v[24:25], v[40:41] op_sel:[1,1] op_sel_hi:[0,0] neg_lo:[1,0] neg_hi:[0,1]
v_pk_add_f32 v[24:25], v[24:25], v[40:41]
v_pk_add_f32 v[40:41], v[26:27], v[42:43] neg_lo:[0,1] neg_hi:[0,1]
v_pk_add_f32 v[26:27], v[26:27], v[42:43]
v_pk_mul_f32 v[42:43], v[40:41], s[54:55] op_sel:[0,1] op_sel_hi:[0,0] neg_lo:[0,1] neg_hi:[0,0]
v_pk_fma_f32 v[42:43], v[40:41], s[54:55], v[42:43] op_sel:[1,0,0] op_sel_hi:[1,1,1] neg_lo:[0,1,0] neg_hi:[0,1,0]
v_pk_add_f32 v[40:41], v[28:29], v[44:45] neg_lo:[0,1] neg_hi:[0,1]
v_pk_add_f32 v[28:29], v[28:29], v[44:45]
v_pk_mul_f32 v[44:45], v[40:41], s[62:63] op_sel:[0,0] op_sel_hi:[0,1] neg_lo:[0,1] neg_hi:[0,0]
v_pk_fma_f32 v[44:45], v[40:41], s[62:63], v[44:45] op_sel:[1,1,0] op_sel_hi:[1,0,1] neg_lo:[0,1,0] neg_hi:[0,1,0]
v_pk_add_f32 v[40:41], v[30:31], v[46:47] neg_lo:[0,1] neg_hi:[0,1]
v_pk_add_f32 v[30:31], v[30:31], v[46:47]
v_pk_mul_f32 v[46:47], v[40:41], s[54:55] op_sel:[0,0] op_sel_hi:[0,1] neg_lo:[0,1] neg_hi:[0,0]
v_pk_fma_f32 v[46:47], v[40:41], s[54:55], v[46:47] op_sel:[1,1,0] op_sel_hi:[1,0,1] neg_lo:[0,1,0] neg_hi:[0,1,0]
v_pk_add_f32 v[40:41], v[14:15], v[48:49] neg_lo:[0,1] neg_hi:[0,1]
v_pk_add_f32 v[14:15], v[14:15], v[48:49]
v_pk_add_f32 v[48:49], v[50:51], v[66:67] neg_lo:[0,1] neg_hi:[0,1]
v_pk_add_f32 v[50:51], v[50:51], v[66:67]
v_pk_mul_f32 v[66:67], v[48:49], s[54:55] op_sel:[0,0] op_sel_hi:[0,1] neg_lo:[0,0] neg_hi:[0,0]
v_pk_fma_f32 v[66:67], v[48:49], s[54:55], v[66:67] op_sel:[1,1,0] op_sel_hi:[1,0,1] neg_lo:[0,1,0] neg_hi:[0,0,0]
v_pk_add_f32 v[48:49], v[52:53], v[68:69] neg_lo:[0,1] neg_hi:[0,1]
v_pk_add_f32 v[52:53], v[52:53], v[68:69]
v_pk_mul_f32 v[68:69], v[48:49], s[62:63] op_sel:[0,0] op_sel_hi:[0,1] neg_lo:[0,0] neg_hi:[0,0]
v_pk_fma_f32 v[68:69], v[48:49], s[62:63], v[68:69] op_sel:[1,1,0] op_sel_hi:[1,0,1] neg_lo:[0,1,0] neg_hi:[0,0,0]
v_pk_add_f32 v[48:49], v[54:55], v[70:71] neg_lo:[0,1] neg_hi:[0,1]
v_pk_add_f32 v[54:55], v[54:55], v[70:71]
v_pk_mul_f32 v[70:71], v[48:49], s[54:55] op_sel:[0,1] op_sel_hi:[0,0] neg_lo:[0,0] neg_hi:[0,0]
v_pk_fma_f32 v[70:71], v[48:49], s[54:55], v[70:71] op_sel:[1,0,0] op_sel_hi:[1,1,1] neg_lo:[0,1,0] neg_hi:[0,0,0]
v_pk_add_f32 v[48:49], v[56:57], v[72:73] op_sel:[1,1] op_sel_hi:[0,0] neg_lo:[1,0] neg_hi:[0,1]
v_pk_add_f32 v[56:57], v[56:57], v[72:73]
v_pk_add_f32 v[72:73], v[58:59], v[74:75] neg_lo:[0,1] neg_hi:[0,1]
v_pk_add_f32 v[58:59], v[58:59], v[74:75]
v_pk_mul_f32 v[74:75], v[72:73], s[54:55] op_sel:[0,1] op_sel_hi:[0,0] neg_lo:[0,1] neg_hi:[0,0]
v_pk_fma_f32 v[74:75], v[72:73], s[54:55], v[74:75] op_sel:[1,0,0] op_sel_hi:[1,1,1] neg_lo:[0,1,0] neg_hi:[0,1,0]
v_pk_add_f32 v[72:73], v[60:61], v[76:77] neg_lo:[0,1] neg_hi:[0,1]
v_pk_add_f32 v[60:61], v[60:61], v[76:77]
v_pk_mul_f32 v[76:77], v[72:73], s[62:63] op_sel:[0,0] op_sel_hi:[0,1] neg_lo:[0,1] neg_hi:[0,0]
v_pk_fma_f32 v[76:77], v[72:73], s[62:63], v[76:77] op_sel:[1,1,0] op_sel_hi:[1,0,1] neg_lo:[0,1,0] neg_hi:[0,1,0]
v_pk_add_f32 v[72:73], v[62:63], v[78:79] neg_lo:[0,1] neg_hi:[0,1]
v_pk_add_f32 v[62:63], v[62:63], v[78:79]
v_pk_mul_f32 v[78:79], v[72:73], s[54:55] op_sel:[0,0] op_sel_hi:[0,1] neg_lo:[0,1] neg_hi:[0,0]
v_pk_fma_f32 v[78:79], v[72:73], s[54:55], v[78:79] op_sel:[1,1,0] op_sel_hi:[1,0,1] neg_lo:[0,1,0] neg_hi:[0,1,0]
v_pk_add_f32 v[72:73], v[16:17], v[24:25] neg_lo:[0,1] neg_hi:[0,1]
v_pk_add_f32 v[16:17], v[16:17], v[24:25]
v_pk_add_f32 v[24:25], v[18:19], v[26:27] neg_lo:[0,1] neg_hi:[0,1]
v_pk_add_f32 v[18:19], v[18:19], v[26:27]
v_pk_mul_f32 v[26:27], v[24:25], s[62:63] op_sel:[0,0] op_sel_hi:[0,1] neg_lo:[0,0] neg_hi:[0,0]
v_pk_fma_f32 v[26:27], v[24:25], s[62:63], v[26:27] op_sel:[1,1,0] op_sel_hi:[1,0,1] neg_lo:[0,1,0] neg_hi:[0,0,0]
v_pk_add_f32 v[24:25], v[20:21], v[28:29] op_sel:[1,1] op_sel_hi:[0,0] neg_lo:[1,0] neg_hi:[0,1]
v_pk_add_f32 v[20:21], v[20:21], v[28:29]
v_pk_add_f32 v[28:29], v[22:23], v[30:31] neg_lo:[0,1] neg_hi:[0,1]
v_pk_add_f32 v[22:23], v[22:23], v[30:31]
v_pk_mul_f32 v[30:31], v[28:29], s[62:63] op_sel:[0,0] op_sel_hi:[0,1] neg_lo:[0,1] neg_hi:[0,0]
v_pk_fma_f32 v[30:31], v[28:29], s[62:63], v[30:31] op_sel:[1,1,0] op_sel_hi:[1,0,1] neg_lo:[0,1,0] neg_hi:[0,1,0]
v_pk_add_f32 v[28:29], v[64:65], v[32:33] neg_lo:[0,1] neg_hi:[0,1]
v_pk_add_f32 v[64:65], v[64:65], v[32:33]
v_pk_add_f32 v[32:33], v[34:35], v[42:43] neg_lo:[0,1] neg_hi:[0,1]
v_pk_add_f32 v[34:35], v[34:35], v[42:43]
v_pk_mul_f32 v[42:43], v[32:33], s[62:63] op_sel:[0,0] op_sel_hi:[0,1] neg_lo:[0,0] neg_hi:[0,0]
v_pk_fma_f32 v[42:43], v[32:33], s[62:63], v[42:43] op_sel:[1,1,0] op_sel_hi:[1,0,1] neg_lo:[0,1,0] neg_hi:[0,0,0]
v_pk_add_f32 v[32:33], v[36:37], v[44:45] op_sel:[1,1] op_sel_hi:[0,0] neg_lo:[1,0] neg_hi:[0,1]
v_pk_add_f32 v[36:37], v[36:37], v[44:45]
v_pk_add_f32 v[44:45], v[38:39], v[46:47] neg_lo:[0,1] neg_hi:[0,1]
v_pk_add_f32 v[38:39], v[38:39], v[46:47]
v_pk_mul_f32 v[46:47], v[44:45], s[62:63] op_sel:[0,0] op_sel_hi:[0,1] neg_lo:[0,1] neg_hi:[0,0]
v_pk_fma_f32 v[46:47], v[44:45], s[62:63], v[46:47] op_sel:[1,1,0] op_sel_hi:[1,0,1] neg_lo:[0,1,0] neg_hi:[0,1,0]
v_pk_add_f32 v[44:45], v[14:15], v[56:57] neg_lo:[0,1] neg_hi:[0,1]
v_pk_add_f32 v[14:15], v[14:15], v[56:57]
v_pk_add_f32 v[56:57], v[50:51], v[58:59] neg_lo:[0,1] neg_hi:[0,1]
v_pk_add_f32 v[50:51], v[50:51], v[58:59]
v_pk_mul_f32 v[58:59], v[56:57], s[62:63] op_sel:[0,0] op_sel_hi:[0,1] neg_lo:[0,0] neg_hi:[0,0]
v_pk_fma_f32 v[58:59], v[56:57], s[62:63], v[58:59] op_sel:[1,1,0] op_sel_hi:[1,0,1] neg_lo:[0,1,0] neg_hi:[0,0,0]
v_pk_add_f32 v[56:57], v[52:53], v[60:61] op_sel:[1,1] op_sel_hi:[0,0] neg_lo:[1,0] neg_hi:[0,1]
v_pk_add_f32 v[52:53], v[52:53], v[60:61]
v_pk_add_f32 v[60:61], v[54:55], v[62:63] neg_lo:[0,1] neg_hi:[0,1]
v_pk_add_f32 v[54:55], v[54:55], v[62:63]
v_pk_mul_f32 v[62:63], v[60:61], s[62:63] op_sel:[0,0] op_sel_hi:[0,1] neg_lo:[0,1] neg_hi:[0,0]
v_pk_fma_f32 v[62:63], v[60:61], s[62:63], v[62:63] op_sel:[1,1,0] op_sel_hi:[1,0,1] neg_lo:[0,1,0] neg_hi:[0,1,0]
v_pk_add_f32 v[60:61], v[40:41], v[48:49] neg_lo:[0,1] neg_hi:[0,1]
v_pk_add_f32 v[40:41], v[40:41], v[48:49]
v_pk_add_f32 v[48:49], v[66:67], v[74:75] neg_lo:[0,1] neg_hi:[0,1]
v_pk_add_f32 v[66:67], v[66:67], v[74:75]
v_pk_mul_f32 v[74:75], v[48:49], s[62:63] op_sel:[0,0] op_sel_hi:[0,1] neg_lo:[0,0] neg_hi:[0,0]
v_pk_fma_f32 v[74:75], v[48:49], s[62:63], v[74:75] op_sel:[1,1,0] op_sel_hi:[1,0,1] neg_lo:[0,1,0] neg_hi:[0,0,0]
v_pk_add_f32 v[48:49], v[68:69], v[76:77] op_sel:[1,1] op_sel_hi:[0,0] neg_lo:[1,0] neg_hi:[0,1]
v_pk_add_f32 v[68:69], v[68:69], v[76:77]
v_pk_add_f32 v[76:77], v[70:71], v[78:79] neg_lo:[0,1] neg_hi:[0,1]
v_pk_add_f32 v[70:71], v[70:71], v[78:79]
v_pk_mul_f32 v[78:79], v[76:77], s[62:63] op_sel:[0,0] op_sel_hi:[0,1] neg_lo:[0,1] neg_hi:[0,0]
v_pk_fma_f32 v[78:79], v[76:77], s[62:63], v[78:79] op_sel:[1,1,0] op_sel_hi:[1,0,1] neg_lo:[0,1,0] neg_hi:[0,1,0]
v_pk_add_f32 v[76:77], v[16:17], v[20:21] neg_lo:[0,1] neg_hi:[0,1]
v_pk_add_f32 v[16:17], v[16:17], v[20:21]
v_pk_add_f32 v[20:21], v[18:19], v[22:23] op_sel:[1,1] op_sel_hi:[0,0] neg_lo:[1,0] neg_hi:[0,1]
v_pk_add_f32 v[18:19], v[18:19], v[22:23]
v_pk_add_f32 v[22:23], v[72:73], v[24:25] neg_lo:[0,1] neg_hi:[0,1]
v_pk_add_f32 v[72:73], v[72:73], v[24:25]
v_pk_add_f32 v[24:25], v[26:27], v[30:31] op_sel:[1,1] op_sel_hi:[0,0] neg_lo:[1,0] neg_hi:[0,1]
v_pk_add_f32 v[26:27], v[26:27], v[30:31]
v_pk_add_f32 v[30:31], v[64:65], v[36:37] neg_lo:[0,1] neg_hi:[0,1]
v_pk_add_f32 v[64:65], v[64:65], v[36:37]
v_pk_add_f32 v[36:37], v[34:35], v[38:39] op_sel:[1,1] op_sel_hi:[0,0] neg_lo:[1,0] neg_hi:[0,1]
v_pk_add_f32 v[34:35], v[34:35], v[38:39]
v_pk_add_f32 v[38:39], v[28:29], v[32:33] neg_lo:[0,1] neg_hi:[0,1]
v_pk_add_f32 v[28:29], v[28:29], v[32:33]
v_pk_add_f32 v[32:33], v[42:43], v[46:47] op_sel:[1,1] op_sel_hi:[0,0] neg_lo:[1,0] neg_hi:[0,1]
v_pk_add_f32 v[42:43], v[42:43], v[46:47]
v_pk_add_f32 v[46:47], v[14:15], v[52:53] neg_lo:[0,1] neg_hi:[0,1]
v_pk_add_f32 v[14:15], v[14:15], v[52:53]
v_pk_add_f32 v[52:53], v[50:51], v[54:55] op_sel:[1,1] op_sel_hi:[0,0] neg_lo:[1,0] neg_hi:[0,1]
v_pk_add_f32 v[50:51], v[50:51], v[54:55]
v_pk_add_f32 v[54:55], v[44:45], v[56:57] neg_lo:[0,1] neg_hi:[0,1]
v_pk_add_f32 v[44:45], v[44:45], v[56:57]
v_pk_add_f32 v[56:57], v[58:59], v[62:63] op_sel:[1,1] op_sel_hi:[0,0] neg_lo:[1,0] neg_hi:[0,1]
v_pk_add_f32 v[58:59], v[58:59], v[62:63]
v_pk_add_f32 v[62:63], v[40:41], v[68:69] neg_lo:[0,1] neg_hi:[0,1]
v_pk_add_f32 v[40:41], v[40:41], v[68:69]
v_pk_add_f32 v[68:69], v[66:67], v[70:71] op_sel:[1,1] op_sel_hi:[0,0] neg_lo:[1,0] neg_hi:[0,1]
v_pk_add_f32 v[66:67], v[66:67], v[70:71]
v_pk_add_f32 v[70:71], v[60:61], v[48:49] neg_lo:[0,1] neg_hi:[0,1]
v_pk_add_f32 v[60:61], v[60:61], v[48:49]
v_pk_add_f32 v[48:49], v[74:75], v[78:79] op_sel:[1,1] op_sel_hi:[0,0] neg_lo:[1,0] neg_hi:[0,1]
v_pk_add_f32 v[74:75], v[74:75], v[78:79]
v_pk_add_f32 v[78:79], v[16:17], v[18:19] neg_lo:[0,1] neg_hi:[0,1]
v_pk_add_f32 v[16:17], v[16:17], v[18:19]
v_pk_add_f32 v[18:19], v[76:77], v[20:21] neg_lo:[0,1] neg_hi:[0,1]
v_pk_add_f32 v[76:77], v[76:77], v[20:21]
v_pk_add_f32 v[20:21], v[72:73], v[26:27] neg_lo:[0,1] neg_hi:[0,1]
v_pk_add_f32 v[72:73], v[72:73], v[26:27]
v_pk_add_f32 v[26:27], v[22:23], v[24:25] neg_lo:[0,1] neg_hi:[0,1]
v_pk_add_f32 v[22:23], v[22:23], v[24:25]
v_pk_add_f32 v[24:25], v[64:65], v[34:35] neg_lo:[0,1] neg_hi:[0,1]
v_pk_add_f32 v[64:65], v[64:65], v[34:35]
v_pk_add_f32 v[34:35], v[30:31], v[36:37] neg_lo:[0,1] neg_hi:[0,1]
v_pk_add_f32 v[30:31], v[30:31], v[36:37]
v_pk_add_f32 v[36:37], v[28:29], v[42:43] neg_lo:[0,1] neg_hi:[0,1]
v_pk_add_f32 v[28:29], v[28:29], v[42:43]
v_pk_add_f32 v[42:43], v[38:39], v[32:33] neg_lo:[0,1] neg_hi:[0,1]
v_pk_add_f32 v[38:39], v[38:39], v[32:33]
v_pk_add_f32 v[32:33], v[14:15], v[50:51] neg_lo:[0,1] neg_hi:[0,1]
v_pk_add_f32 v[14:15], v[14:15], v[50:51]
v_pk_add_f32 v[50:51], v[46:47], v[52:53] neg_lo:[0,1] neg_hi:[0,1]
v_pk_add_f32 v[46:47], v[46:47], v[52:53]
v_pk_add_f32 v[52:53], v[44:45], v[58:59] neg_lo:[0,1] neg_hi:[0,1]
v_pk_add_f32 v[44:45], v[44:45], v[58:59]
v_pk_add_f32 v[58:59], v[54:55], v[56:57] neg_lo:[0,1] neg_hi:[0,1]
v_pk_add_f32 v[54:55], v[54:55], v[56:57]
v_pk_add_f32 v[56:57], v[40:41], v[66:67] neg_lo:[0,1] neg_hi:[0,1]
v_pk_add_f32 v[40:41], v[40:41], v[66:67]
v_pk_add_f32 v[66:67], v[62:63], v[68:69] neg_lo:[0,1] neg_hi:[0,1]
v_pk_add_f32 v[62:63], v[62:63], v[68:69]
v_pk_add_f32 v[68:69], v[60:61], v[74:75] neg_lo:[0,1] neg_hi:[0,1]
v_pk_add_f32 v[60:61], v[60:61], v[74:75]
v_pk_add_f32 v[74:75], v[70:71], v[48:49] neg_lo:[0,1] neg_hi:[0,1]
v_pk_add_f32 v[70:71], v[70:71], v[48:49]
v_pk_mul_f32 v[48:49], v[14:15], v[82:83] op_sel:[0,0] op_sel_hi:[0,1] neg_lo:[0,0] neg_hi:[0,0]
v_pk_fma_f32 v[14:15], v[14:15], v[82:83], v[48:49] op_sel:[1,1,0] op_sel_hi:[1,0,1] neg_lo:[0,1,0] neg_hi:[0,0,0]
v_pk_mul_f32 v[48:49], v[64:65], v[84:85] op_sel:[0,0] op_sel_hi:[0,1] neg_lo:[0,0] neg_hi:[0,0]
v_pk_fma_f32 v[64:65], v[64:65], v[84:85], v[48:49] op_sel:[1,1,0] op_sel_hi:[1,0,1] neg_lo:[0,1,0] neg_hi:[0,0,0]
v_pk_mul_f32 v[48:49], v[40:41], v[86:87] op_sel:[0,0] op_sel_hi:[0,1] neg_lo:[0,0] neg_hi:[0,0]
v_pk_fma_f32 v[40:41], v[40:41], v[86:87], v[48:49] op_sel:[1,1,0] op_sel_hi:[1,0,1] neg_lo:[0,1,0] neg_hi:[0,0,0]
v_pk_mul_f32 v[48:49], v[72:73], v[88:89] op_sel:[0,0] op_sel_hi:[0,1] neg_lo:[0,0] neg_hi:[0,0]
v_pk_fma_f32 v[72:73], v[72:73], v[88:89], v[48:49] op_sel:[1,1,0] op_sel_hi:[1,0,1] neg_lo:[0,1,0] neg_hi:[0,0,0]
v_pk_mul_f32 v[48:49], v[44:45], v[90:91] op_sel:[0,0] op_sel_hi:[0,1] neg_lo:[0,0] neg_hi:[0,0]
v_pk_fma_f32 v[44:45], v[44:45], v[90:91], v[48:49] op_sel:[1,1,0] op_sel_hi:[1,0,1] neg_lo:[0,1,0] neg_hi:[0,0,0]
v_pk_mul_f32 v[48:49], v[28:29], v[92:93] op_sel:[0,0] op_sel_hi:[0,1] neg_lo:[0,0] neg_hi:[0,0]
v_pk_fma_f32 v[28:29], v[28:29], v[92:93], v[48:49] op_sel:[1,1,0] op_sel_hi:[1,0,1] neg_lo:[0,1,0] neg_hi:[0,0,0]
v_pk_mul_f32 v[48:49], v[60:61], v[94:95] op_sel:[0,0] op_sel_hi:[0,1] neg_lo:[0,0] neg_hi:[0,0]
v_pk_fma_f32 v[60:61], v[60:61], v[94:95], v[48:49] op_sel:[1,1,0] op_sel_hi:[1,0,1] neg_lo:[0,1,0] neg_hi:[0,0,0]
v_pk_mul_f32 v[48:49], v[76:77], v[96:97] op_sel:[0,0] op_sel_hi:[0,1] neg_lo:[0,0] neg_hi:[0,0]
v_pk_fma_f32 v[76:77], v[76:77], v[96:97], v[48:49] op_sel:[1,1,0] op_sel_hi:[1,0,1] neg_lo:[0,1,0] neg_hi:[0,0,0]
v_pk_mul_f32 v[48:49], v[46:47], v[98:99] op_sel:[0,0] op_sel_hi:[0,1] neg_lo:[0,0] neg_hi:[0,0]
v_pk_fma_f32 v[46:47], v[46:47], v[98:99], v[48:49] op_sel:[1,1,0] op_sel_hi:[1,0,1] neg_lo:[0,1,0] neg_hi:[0,0,0]
v_pk_mul_f32 v[48:49], v[30:31], v[100:101] op_sel:[0,0] op_sel_hi:[0,1] neg_lo:[0,0] neg_hi:[0,0]
v_pk_fma_f32 v[30:31], v[30:31], v[100:101], v[48:49] op_sel:[1,1,0] op_sel_hi:[1,0,1] neg_lo:[0,1,0] neg_hi:[0,0,0]
v_pk_mul_f32 v[48:49], v[62:63], v[102:103] op_sel:[0,0] op_sel_hi:[0,1] neg_lo:[0,0] neg_hi:[0,0]
v_pk_fma_f32 v[62:63], v[62:63], v[102:103], v[48:49] op_sel:[1,1,0] op_sel_hi:[1,0,1] neg_lo:[0,1,0] neg_hi:[0,0,0]
v_pk_mul_f32 v[48:49], v[22:23], v[104:105] op_sel:[0,0] op_sel_hi:[0,1] neg_lo:[0,0] neg_hi:[0,0]
v_pk_fma_f32 v[22:23], v[22:23], v[104:105], v[48:49] op_sel:[1,1,0] op_sel_hi:[1,0,1] neg_lo:[0,1,0] neg_hi:[0,0,0]
v_pk_mul_f32 v[48:49], v[54:55], v[106:107] op_sel:[0,0] op_sel_hi:[0,1] neg_lo:[0,0] neg_hi:[0,0]
v_pk_fma_f32 v[54:55], v[54:55], v[106:107], v[48:49] op_sel:[1,1,0] op_sel_hi:[1,0,1] neg_lo:[0,1,0] neg_hi:[0,0,0]
v_pk_mul_f32 v[48:49], v[38:39], v[108:109] op_sel:[0,0] op_sel_hi:[0,1] neg_lo:[0,0] neg_hi:[0,0]
v_pk_fma_f32 v[38:39], v[38:39], v[108:109], v[48:49] op_sel:[1,1,0] op_sel_hi:[1,0,1] neg_lo:[0,1,0] neg_hi:[0,0,0]
v_pk_mul_f32 v[48:49], v[70:71], v[110:111] op_sel:[0,0] op_sel_hi:[0,1] neg_lo:[0,0] neg_hi:[0,0]
v_pk_fma_f32 v[70:71], v[70:71], v[110:111], v[48:49] op_sel:[1,1,0] op_sel_hi:[1,0,1] neg_lo:[0,1,0] neg_hi:[0,0,0]
v_pk_mul_f32 v[48:49], v[78:79], v[112:113] op_sel:[0,0] op_sel_hi:[0,1] neg_lo:[0,0] neg_hi:[0,0]
v_pk_fma_f32 v[78:79], v[78:79], v[112:113], v[48:49] op_sel:[1,1,0] op_sel_hi:[1,0,1] neg_lo:[0,1,0] neg_hi:[0,0,0]
v_pk_mul_f32 v[48:49], v[32:33], v[114:115] op_sel:[0,0] op_sel_hi:[0,1] neg_lo:[0,0] neg_hi:[0,0]
v_pk_fma_f32 v[32:33], v[32:33], v[114:115], v[48:49] op_sel:[1,1,0] op_sel_hi:[1,0,1] neg_lo:[0,1,0] neg_hi:[0,0,0]
v_pk_mul_f32 v[48:49], v[24:25], v[116:117] op_sel:[0,0] op_sel_hi:[0,1] neg_lo:[0,0] neg_hi:[0,0]
v_pk_fma_f32 v[24:25], v[24:25], v[116:117], v[48:49] op_sel:[1,1,0] op_sel_hi:[1,0,1] neg_lo:[0,1,0] neg_hi:[0,0,0]
v_pk_mul_f32 v[48:49], v[56:57], v[118:119] op_sel:[0,0] op_sel_hi:[0,1] neg_lo:[0,0] neg_hi:[0,0]
v_pk_fma_f32 v[56:57], v[56:57], v[118:119], v[48:49] op_sel:[1,1,0] op_sel_hi:[1,0,1] neg_lo:[0,1,0] neg_hi:[0,0,0]
v_pk_mul_f32 v[48:49], v[20:21], v[120:121] op_sel:[0,0] op_sel_hi:[0,1] neg_lo:[0,0] neg_hi:[0,0]
v_pk_fma_f32 v[20:21], v[20:21], v[120:121], v[48:49] op_sel:[1,1,0] op_sel_hi:[1,0,1] neg_lo:[0,1,0] neg_hi:[0,0,0]
v_pk_mul_f32 v[48:49], v[52:53], v[122:123] op_sel:[0,0] op_sel_hi:[0,1] neg_lo:[0,0] neg_hi:[0,0]
v_pk_fma_f32 v[52:53], v[52:53], v[122:123], v[48:49] op_sel:[1,1,0] op_sel_hi:[1,0,1] neg_lo:[0,1,0] neg_hi:[0,0,0]
v_pk_mul_f32 v[48:49], v[36:37], v[124:125] op_sel:[0,0] op_sel_hi:[0,1] neg_lo:[0,0] neg_hi:[0,0]
v_pk_fma_f32 v[36:37], v[36:37], v[124:125], v[48:49] op_sel:[1,1,0] op_sel_hi:[1,0,1] neg_lo:[0,1,0] neg_hi:[0,0,0]
v_pk_mul_f32 v[48:49], v[68:69], v[126:127] op_sel:[0,0] op_sel_hi:[0,1] neg_lo:[0,0] neg_hi:[0,0]
v_pk_fma_f32 v[68:69], v[68:69], v[126:127], v[48:49] op_sel:[1,1,0] op_sel_hi:[1,0,1] neg_lo:[0,1,0] neg_hi:[0,0,0]
v_pk_mul_f32 v[48:49], v[18:19], v[128:129] op_sel:[0,0] op_sel_hi:[0,1] neg_lo:[0,0] neg_hi:[0,0]
v_pk_fma_f32 v[18:19], v[18:19], v[128:129], v[48:49] op_sel:[1,1,0] op_sel_hi:[1,0,1] neg_lo:[0,1,0] neg_hi:[0,0,0]
v_pk_mul_f32 v[48:49], v[50:51], v[130:131] op_sel:[0,0] op_sel_hi:[0,1] neg_lo:[0,0] neg_hi:[0,0]
v_pk_fma_f32 v[50:51], v[50:51], v[130:131], v[48:49] op_sel:[1,1,0] op_sel_hi:[1,0,1] neg_lo:[0,1,0] neg_hi:[0,0,0]
v_pk_mul_f32 v[48:49], v[34:35], v[132:133] op_sel:[0,0] op_sel_hi:[0,1] neg_lo:[0,0] neg_hi:[0,0]
v_pk_fma_f32 v[34:35], v[34:35], v[132:133], v[48:49] op_sel:[1,1,0] op_sel_hi:[1,0,1] neg_lo:[0,1,0] neg_hi:[0,0,0]
v_pk_mul_f32 v[48:49], v[66:67], v[134:135] op_sel:[0,0] op_sel_hi:[0,1] neg_lo:[0,0] neg_hi:[0,0]
v_pk_fma_f32 v[66:67], v[66:67], v[134:135], v[48:49] op_sel:[1,1,0] op_sel_hi:[1,0,1] neg_lo:[0,1,0] neg_hi:[0,0,0]
v_pk_mul_f32 v[48:49], v[26:27], v[136:137] op_sel:[0,0] op_sel_hi:[0,1] neg_lo:[0,0] neg_hi:[0,0]
v_pk_fma_f32 v[26:27], v[26:27], v[136:137], v[48:49] op_sel:[1,1,0] op_sel_hi:[1,0,1] neg_lo:[0,1,0] neg_hi:[0,0,0]
v_pk_mul_f32 v[48:49], v[58:59], v[138:139] op_sel:[0,0] op_sel_hi:[0,1] neg_lo:[0,0] neg_hi:[0,0]
v_pk_fma_f32 v[58:59], v[58:59], v[138:139], v[48:49] op_sel:[1,1,0] op_sel_hi:[1,0,1] neg_lo:[0,1,0] neg_hi:[0,0,0]
v_pk_mul_f32 v[48:49], v[42:43], v[140:141] op_sel:[0,0] op_sel_hi:[0,1] neg_lo:[0,0] neg_hi:[0,0]
v_pk_fma_f32 v[42:43], v[42:43], v[140:141], v[48:49] op_sel:[1,1,0] op_sel_hi:[1,0,1] neg_lo:[0,1,0] neg_hi:[0,0,0]
v_pk_mul_f32 v[48:49], v[74:75], v[142:143] op_sel:[0,0] op_sel_hi:[0,1] neg_lo:[0,0] neg_hi:[0,0]
v_pk_fma_f32 v[74:75], v[74:75], v[142:143], v[48:49] op_sel:[1,1,0] op_sel_hi:[1,0,1] neg_lo:[0,1,0] neg_hi:[0,0,0]
ds_write_b64 v4, v[16:17] offset:0
ds_write_b64 v4, v[14:15] offset:264
ds_write_b64 v4, v[64:65] offset:528
ds_write_b64 v4, v[40:41] offset:792
ds_write_b64 v4, v[72:73] offset:1056
ds_write_b64 v4, v[44:45] offset:1320
ds_write_b64 v4, v[28:29] offset:1584
ds_write_b64 v4, v[60:61] offset:1848
ds_write_b64 v4, v[76:77] offset:2112
ds_write_b64 v4, v[46:47] offset:2376
ds_write_b64 v4, v[30:31] offset:2640
ds_write_b64 v4, v[62:63] offset:2904
ds_write_b64 v4, v[22:23] offset:3168
ds_write_b64 v4, v[54:55] offset:3432
ds_write_b64 v4, v[38:39] offset:3696
ds_write_b64 v4, v[70:71] offset:3960
ds_write_b64 v4, v[78:79] offset:4224
ds_write_b64 v4, v[32:33] offset:4488
ds_write_b64 v4, v[24:25] offset:4752
ds_write_b64 v4, v[56:57] offset:5016
ds_write_b64 v4, v[20:21] offset:5280
ds_write_b64 v4, v[52:53] offset:5544
ds_write_b64 v4, v[36:37] offset:5808
ds_write_b64 v4, v[68:69] offset:6072
ds_write_b64 v4, v[18:19] offset:6336
ds_write_b64 v4, v[50:51] offset:6600
ds_write_b64 v4, v[34:35] offset:6864
ds_write_b64 v4, v[66:67] offset:7128
ds_write_b64 v4, v[26:27] offset:7392
ds_write_b64 v4, v[58:59] offset:7656
ds_write_b64 v4, v[42:43] offset:7920
ds_write_b64 v4, v[74:75] offset:8184
s_waitcnt lgkmcnt(0)
ds_read_b64 v[16:17], v5 offset:0
ds_read_b64 v[48:49], v5 offset:128
ds_read_b64 v[18:19], v5 offset:8
ds_read_b64 v[50:51], v5 offset:136
ds_read_b64 v[20:21], v5 offset:16
ds_read_b64 v[52:53], v5 offset:144
ds_read_b64 v[22:23], v5 offset:24
ds_read_b64 v[54:55], v5 offset:152
ds_read_b64 v[24:25], v5 offset:32
ds_read_b64 v[56:57], v5 offset:160
ds_read_b64 v[26:27], v5 offset:40
ds_read_b64 v[58:59], v5 offset:168
ds_read_b64 v[28:29], v5 offset:48
ds_read_b64 v[60:61], v5 offset:176
ds_read_b64 v[30:31], v5 offset:56
ds_read_b64 v[62:63], v5 offset:184
ds_read_b64 v[32:33], v5 offset:64
ds_read_b64 v[64:65], v5 offset:192
ds_read_b64 v[34:35], v5 offset:72
ds_read_b64 v[66:67], v5 offset:200
ds_read_b64 v[36:37], v5 offset:80
ds_read_b64 v[68:69], v5 offset:208
ds_read_b64 v[38:39], v5 offset:88
ds_read_b64 v[70:71], v5 offset:216
ds_read_b64 v[40:41], v5 offset:96
ds_read_b64 v[72:73], v5 offset:224
ds_read_b64 v[42:43], v5 offset:104
ds_read_b64 v[74:75], v5 offset:232
ds_read_b64 v[44:45], v5 offset:112
ds_read_b64 v[76:77], v5 offset:240
ds_read_b64 v[46:47], v5 offset:120
ds_read_b64 v[78:79], v5 offset:248
s_waitcnt lgkmcnt(0)
v_pk_add_f32 v[14:15], v[16:17], v[48:49] neg_lo:[0,1] neg_hi:[0,1]
v_pk_add_f32 v[16:17], v[16:17], v[48:49]
v_pk_add_f32 v[48:49], v[18:19], v[50:51] neg_lo:[0,1] neg_hi:[0,1]
v_pk_add_f32 v[18:19], v[18:19], v[50:51]
v_pk_mul_f32 v[50:51], v[48:49], s[50:51] op_sel:[0,0] op_sel_hi:[0,1] neg_lo:[0,0] neg_hi:[0,0]
v_pk_fma_f32 v[50:51], v[48:49], s[50:51], v[50:51] op_sel:[1,1,0] op_sel_hi:[1,0,1] neg_lo:[0,1,0] neg_hi:[0,0,0]
v_pk_add_f32 v[48:49], v[20:21], v[52:53] neg_lo:[0,1] neg_hi:[0,1]
v_pk_add_f32 v[20:21], v[20:21], v[52:53]
v_pk_mul_f32 v[52:53], v[48:49], s[54:55] op_sel:[0,0] op_sel_hi:[0,1] neg_lo:[0,0] neg_hi:[0,0]
v_pk_fma_f32 v[52:53], v[48:49], s[54:55], v[52:53] op_sel:[1,1,0] op_sel_hi:[1,0,1] neg_lo:[0,1,0] neg_hi:[0,0,0]
v_pk_add_f32 v[48:49], v[22:23], v[54:55] neg_lo:[0,1] neg_hi:[0,1]
v_pk_add_f32 v[22:23], v[22:23], v[54:55]
v_pk_mul_f32 v[54:55], v[48:49], s[58:59] op_sel:[0,0] op_sel_hi:[0,1] neg_lo:[0,0] neg_hi:[0,0]
v_pk_fma_f32 v[54:55], v[48:49], s[58:59], v[54:55] op_sel:[1,1,0] op_sel_hi:[1,0,1] neg_lo:[0,1,0] neg_hi:[0,0,0]
v_pk_add_f32 v[48:49], v[24:25], v[56:57] neg_lo:[0,1] neg_hi:[0,1]
v_pk_add_f32 v[24:25], v[24:25], v[56:57]
v_pk_mul_f32 v[56:57], v[48:49], s[62:63] op_sel:[0,0] op_sel_hi:[0,1] neg_lo:[0,0] neg_hi:[0,0]
v_pk_fma_f32 v[56:57], v[48:49], s[62:63], v[56:57] op_sel:[1,1,0] op_sel_hi:[1,0,1] neg_lo:[0,1,0] neg_hi:[0,0,0]
v_pk_add_f32 v[48:49], v[26:27], v[58:59] neg_lo:[0,1] neg_hi:[0,1]
v_pk_add_f32 v[26:27], v[26:27], v[58:59]
v_pk_mul_f32 v[58:59], v[48:49], s[58:59] op_sel:[0,1] op_sel_hi:[0,0] neg_lo:[0,0] neg_hi:[0,0]
v_pk_fma_f32 v[58:59], v[48:49], s[58:59], v[58:59] op_sel:[1,0,0] op_sel_hi:[1,1,1] neg_lo:[0,1,0] neg_hi:[0,0,0]
v_pk_add_f32 v[48:49], v[28:29], v[60:61] neg_lo:[0,1] neg_hi:[0,1]
v_pk_add_f32 v[28:29], v[28:29], v[60:61]
v_pk_mul_f32 v[60:61], v[48:49], s[54:55] op_sel:[0,1] op_sel_hi:[0,0] neg_lo:[0,0] neg_hi:[0,0]
v_pk_fma_f32 v[60:61], v[48:49], s[54:55], v[60:61] op_sel:[1,0,0] op_sel_hi:[1,1,1] neg_lo:[0,1,0] neg_hi:[0,0,0]
v_pk_add_f32 v[48:49], v[30:31], v[62:63] neg_lo:[0,1] neg_hi:[0,1]
v_pk_add_f32 v[30:31], v[30:31], v[62:63]
v_pk_mul_f32 v[62:63], v[48:49], s[50:51] op_sel:[0,1] op_sel_hi:[0,0] neg_lo:[0,0] neg_hi:[0,0]
v_pk_fma_f32 v[62:63], v[48:49], s[50:51], v[62:63] op_sel:[1,0,0] op_sel_hi:[1,1,1] neg_lo:[0,1,0] neg_hi:[0,0,0]
v_pk_add_f32 v[48:49], v[32:33], v[64:65] op_sel:[1,1] op_sel_hi:[0,0] neg_lo:[1,0] neg_hi:[0,1]
v_pk_add_f32 v[32:33], v[32:33], v[64:65]
v_pk_add_f32 v[64:65], v[34:35], v[66:67] neg_lo:[0,1] neg_hi:[0,1]
v_pk_add_f32 v[34:35], v[34:35], v[66:67]
v_pk_mul_f32 v[66:67], v[64:65], s[50:51] op_sel:[0,1] op_sel_hi:[0,0] neg_lo:[0,1] neg_hi:[0,0]
v_pk_fma_f32 v[66:67], v[64:65], s[50:51], v[66:67] op_sel:[1,0,0] op_sel_hi:[1,1,1] neg_lo:[0,1,0] neg_hi:[0,1,0]
v_pk_add_f32 v[64:65], v[36:37], v[68:69] neg_lo:[0,1] neg_hi:[0,1]
v_pk_add_f32 v[36:37], v[36:37], v[68:69]
v_pk_mul_f32 v[68:69], v[64:65], s[54:55] op_sel:[0,1] op_sel_hi:[0,0] neg_lo:[0,1] neg_hi:[0,0]
v_pk_fma_f32 v[68:69], v[64:65], s[54:55], v[68:69] op_sel:[1,0,0] op_sel_hi:[1,1,1] neg_lo:[0,1,0] neg_hi:[0,1,0]
v_pk_add_f32 v[64:65], v[38:39], v[70:71] neg_lo:[0,1] neg_hi:[0,1]
v_pk_add_f32 v[38:39], v[38:39], v[70:71]
v_pk_mul_f32 v[70:71], v[64:65], s[58:59] op_sel:[0,1] op_sel_hi:[0,0] neg_lo:[0,1] neg_hi:[0,0]
v_pk_fma_f32 v[70:71], v[64:65], s[58:59], v[70:71] op_sel:[1,0,0] op_sel_hi:[1,1,1] neg_lo:[0,1,0] neg_hi:[0,1,0]
v_pk_add_f32 v[64:65], v[40:41], v[72:73] neg_lo:[0,1] neg_hi:[0,1]
v_pk_add_f32 v[40:41], v[40:41], v[72:73]
v_pk_mul_f32 v[72:73], v[64:65], s[62:63] op_sel:[0,0] op_sel_hi:[0,1] neg_lo:[0,1] neg_hi:[0,0]
v_pk_fma_f32 v[72:73], v[64:65], s[62:63], v[72:73] op_sel:[1,1,0] op_sel_hi:[1,0,1] neg_lo:[0,1,0] neg_hi:[0,1,0]
v_pk_add_f32 v[64:65], v[42:43], v[74:75] neg_lo:[0,1] neg_hi:[0,1]
v_pk_add_f32 v[42:43], v[42:43], v[74:75]
v_pk_mul_f32 v[74:75], v[64:65], s[58:59] op_sel:[0,0] op_sel_hi:[0,1] neg_lo:[0,1] neg_hi:[0,0]
v_pk_fma_f32 v[74:75], v[64:65], s[58:59], v[74:75] op_sel:[1,1,0] op_sel_hi:[1,0,1] neg_lo:[0,1,0] neg_hi:[0,1,0]
v_pk_add_f32 v[64:65], v[44:45], v[76:77] neg_lo:[0,1] neg_hi:[0,1]
v_pk_add_f32 v[44:45], v[44:45], v[76:77]
v_pk_mul_f32 v[76:77], v[64:65], s[54:55] op_sel:[0,0] op_sel_hi:[0,1] neg_lo:[0,1] neg_hi:[0,0]
v_pk_fma_f32 v[76:77], v[64:65], s[54:55], v[76:77] op_sel:[1,1,0] op_sel_hi:[1,0,1] neg_lo:[0,1,0] neg_hi:[0,1,0]
v_pk_add_f32 v[64:65], v[46:47], v[78:79] neg_lo:[0,1] neg_hi:[0,1]
v_pk_add_f32 v[46:47], v[46:47], v[78:79]
v_pk_mul_f32 v[78:79], v[64:65], s[50:51] op_sel:[0,0] op_sel_hi:[0,1] neg_lo:[0,1] neg_hi:[0,0]
v_pk_fma_f32 v[78:79], v[64:65], s[50:51], v[78:79] op_sel:[1,1,0] op_sel_hi:[1,0,1] neg_lo:[0,1,0] neg_hi:[0,1,0]
v_pk_add_f32 v[64:65], v[16:17], v[32:33] neg_lo:[0,1] neg_hi:[0,1]
v_pk_add_f32 v[16:17], v[16:17], v[32:33]
v_pk_add_f32 v[32:33], v[18:19], v[34:35] neg_lo:[0,1] neg_hi:[0,1]
v_pk_add_f32 v[18:19], v[18:19], v[34:35]
v_pk_mul_f32 v[34:35], v[32:33], s[54:55] op_sel:[0,0] op_sel_hi:[0,1] neg_lo:[0,0] neg_hi:[0,0]
v_pk_fma_f32 v[34:35], v[32:33], s[54:55], v[34:35] op_sel:[1,1,0] op_sel_hi:[1,0,1] neg_lo:[0,1,0] neg_hi:[0,0,0]
v_pk_add_f32 v[32:33], v[20:21], v[36:37] neg_lo:[0,1] neg_hi:[0,1]
v_pk_add_f32 v[20:21], v[20:21], v[36:37]
v_pk_mul_f32 v[36:37], v[32:33], s[62:63] op_sel:[0,0] op_sel_hi:[0,1] neg_lo:[0,0] neg_hi:[0,0]
v_pk_fma_f32 v[36:37], v[32:33], s[62:63], v[36:37] op_sel:[1,1,0] op_sel_hi:[1,0,1] neg_lo:[0,1,0] neg_hi:[0,0,0]
v_pk_add_f32 v[32:33], v[22:23], v[38:39] neg_lo:[0,1] neg_hi:[0,1]
v_pk_add_f32 v[22:23], v[22:23], v[38:39]
v_pk_mul_f32 v[38:39], v[32:33], s[54:55] op_sel:[0,1] op_sel_hi:[0,0] neg_lo:[0,0] neg_hi:[0,0]
v_pk_fma_f32 v[38:39], v[32:33], s[54:55], v[38:39] op_sel:[1,0,0] op_sel_hi:[1,1,1] neg_lo:[0,1,0] neg_hi:[0,0,0]
v_pk_add_f32 v[32:33], v[24:25], v[40:41] op_sel:[1,1] op_sel_hi:[0,0] neg_lo:[1,0] neg_hi:[0,1]
v_pk_add_f32 v[24:25], v[24:25], v[40:41]
v_pk_add_f32 v[40:41], v[26:27], v[42:43] neg_lo:[0,1] neg_hi:[0,1]
v_pk_add_f32 v[26:27], v[26:27], v[42:43]
v_pk_mul_f32 v[42:43], v[40:41], s[54:55] op_sel:[0,1] op_sel_hi:[0,0] neg_lo:[0,1] neg_hi:[0,0]
v_pk_fma_f32 v[42:43], v[40:41], s[54:55], v[42:43] op_sel:[1,0,0] op_sel_hi:[1,1,1] neg_lo:[0,1,0] neg_hi:[0,1,0]
v_pk_add_f32 v[40:41], v[28:29], v[44:45] neg_lo:[0,1] neg_hi:[0,1]
v_pk_add_f32 v[28:29], v[28:29], v[44:45]
v_pk_mul_f32 v[44:45], v[40:41], s[62:63] op_sel:[0,0] op_sel_hi:[0,1] neg_lo:[0,1] neg_hi:[0,0]
v_pk_fma_f32 v[44:45], v[40:41], s[62:63], v[44:45] op_sel:[1,1,0] op_sel_hi:[1,0,1] neg_lo:[0,1,0] neg_hi:[0,1,0]
v_pk_add_f32 v[40:41], v[30:31], v[46:47] neg_lo:[0,1] neg_hi:[0,1]
v_pk_add_f32 v[30:31], v[30:31], v[46:47]
v_pk_mul_f32 v[46:47], v[40:41], s[54:55] op_sel:[0,0] op_sel_hi:[0,1] neg_lo:[0,1] neg_hi:[0,0]
v_pk_fma_f32 v[46:47], v[40:41], s[54:55], v[46:47] op_sel:[1,1,0] op_sel_hi:[1,0,1] neg_lo:[0,1,0] neg_hi:[0,1,0]
v_pk_add_f32 v[40:41], v[14:15], v[48:49] neg_lo:[0,1] neg_hi:[0,1]
v_pk_add_f32 v[14:15], v[14:15], v[48:49]
v_pk_add_f32 v[48:49], v[50:51], v[66:67] neg_lo:[0,1] neg_hi:[0,1]
v_pk_add_f32 v[50:51], v[50:51], v[66:67]
v_pk_mul_f32 v[66:67], v[48:49], s[54:55] op_sel:[0,0] op_sel_hi:[0,1] neg_lo:[0,0] neg_hi:[0,0]
v_pk_fma_f32 v[66:67], v[48:49], s[54:55], v[66:67] op_sel:[1,1,0] op_sel_hi:[1,0,1] neg_lo:[0,1,0] neg_hi:[0,0,0]
v_pk_add_f32 v[48:49], v[52:53], v[68:69] neg_lo:[0,1] neg_hi:[0,1]
v_pk_add_f32 v[52:53], v[52:53], v[68:69]
v_pk_mul_f32 v[68:69], v[48:49], s[62:63] op_sel:[0,0] op_sel_hi:[0,1] neg_lo:[0,0] neg_hi:[0,0]
v_pk_fma_f32 v[68:69], v[48:49], s[62:63], v[68:69] op_sel:[1,1,0] op_sel_hi:[1,0,1] neg_lo:[0,1,0] neg_hi:[0,0,0]
v_pk_add_f32 v[48:49], v[54:55], v[70:71] neg_lo:[0,1] neg_hi:[0,1]
v_pk_add_f32 v[54:55], v[54:55], v[70:71]
v_pk_mul_f32 v[70:71], v[48:49], s[54:55] op_sel:[0,1] op_sel_hi:[0,0] neg_lo:[0,0] neg_hi:[0,0]
v_pk_fma_f32 v[70:71], v[48:49], s[54:55], v[70:71] op_sel:[1,0,0] op_sel_hi:[1,1,1] neg_lo:[0,1,0] neg_hi:[0,0,0]
v_pk_add_f32 v[48:49], v[56:57], v[72:73] op_sel:[1,1] op_sel_hi:[0,0] neg_lo:[1,0] neg_hi:[0,1]
v_pk_add_f32 v[56:57], v[56:57], v[72:73]
v_pk_add_f32 v[72:73], v[58:59], v[74:75] neg_lo:[0,1] neg_hi:[0,1]
v_pk_add_f32 v[58:59], v[58:59], v[74:75]
v_pk_mul_f32 v[74:75], v[72:73], s[54:55] op_sel:[0,1] op_sel_hi:[0,0] neg_lo:[0,1] neg_hi:[0,0]
v_pk_fma_f32 v[74:75], v[72:73], s[54:55], v[74:75] op_sel:[1,0,0] op_sel_hi:[1,1,1] neg_lo:[0,1,0] neg_hi:[0,1,0]
v_pk_add_f32 v[72:73], v[60:61], v[76:77] neg_lo:[0,1] neg_hi:[0,1]
v_pk_add_f32 v[60:61], v[60:61], v[76:77]
v_pk_mul_f32 v[76:77], v[72:73], s[62:63] op_sel:[0,0] op_sel_hi:[0,1] neg_lo:[0,1] neg_hi:[0,0]
v_pk_fma_f32 v[76:77], v[72:73], s[62:63], v[76:77] op_sel:[1,1,0] op_sel_hi:[1,0,1] neg_lo:[0,1,0] neg_hi:[0,1,0]
v_pk_add_f32 v[72:73], v[62:63], v[78:79] neg_lo:[0,1] neg_hi:[0,1]
v_pk_add_f32 v[62:63], v[62:63], v[78:79]
v_pk_mul_f32 v[78:79], v[72:73], s[54:55] op_sel:[0,0] op_sel_hi:[0,1] neg_lo:[0,1] neg_hi:[0,0]
v_pk_fma_f32 v[78:79], v[72:73], s[54:55], v[78:79] op_sel:[1,1,0] op_sel_hi:[1,0,1] neg_lo:[0,1,0] neg_hi:[0,1,0]
v_pk_add_f32 v[72:73], v[16:17], v[24:25] neg_lo:[0,1] neg_hi:[0,1]
v_pk_add_f32 v[16:17], v[16:17], v[24:25]
v_pk_add_f32 v[24:25], v[18:19], v[26:27] neg_lo:[0,1] neg_hi:[0,1]
v_pk_add_f32 v[18:19], v[18:19], v[26:27]
v_pk_mul_f32 v[26:27], v[24:25], s[62:63] op_sel:[0,0] op_sel_hi:[0,1] neg_lo:[0,0] neg_hi:[0,0]
v_pk_fma_f32 v[26:27], v[24:25], s[62:63], v[26:27] op_sel:[1,1,0] op_sel_hi:[1,0,1] neg_lo:[0,1,0] neg_hi:[0,0,0]
v_pk_add_f32 v[24:25], v[20:21], v[28:29] op_sel:[1,1] op_sel_hi:[0,0] neg_lo:[1,0] neg_hi:[0,1]
v_pk_add_f32 v[20:21], v[20:21], v[28:29]
v_pk_add_f32 v[28:29], v[22:23], v[30:31] neg_lo:[0,1] neg_hi:[0,1]
v_pk_add_f32 v[22:23], v[22:23], v[30:31]
v_pk_mul_f32 v[30:31], v[28:29], s[62:63] op_sel:[0,0] op_sel_hi:[0,1] neg_lo:[0,1] neg_hi:[0,0]
v_pk_fma_f32 v[30:31], v[28:29], s[62:63], v[30:31] op_sel:[1,1,0] op_sel_hi:[1,0,1] neg_lo:[0,1,0] neg_hi:[0,1,0]
v_pk_add_f32 v[28:29], v[64:65], v[32:33] neg_lo:[0,1] neg_hi:[0,1]
v_pk_add_f32 v[64:65], v[64:65], v[32:33]
v_pk_add_f32 v[32:33], v[34:35], v[42:43] neg_lo:[0,1] neg_hi:[0,1]
v_pk_add_f32 v[34:35], v[34:35], v[42:43]
v_pk_mul_f32 v[42:43], v[32:33], s[62:63] op_sel:[0,0] op_sel_hi:[0,1] neg_lo:[0,0] neg_hi:[0,0]
v_pk_fma_f32 v[42:43], v[32:33], s[62:63], v[42:43] op_sel:[1,1,0] op_sel_hi:[1,0,1] neg_lo:[0,1,0] neg_hi:[0,0,0]
v_pk_add_f32 v[32:33], v[36:37], v[44:45] op_sel:[1,1] op_sel_hi:[0,0] neg_lo:[1,0] neg_hi:[0,1]
v_pk_add_f32 v[36:37], v[36:37], v[44:45]
v_pk_add_f32 v[44:45], v[38:39], v[46:47] neg_lo:[0,1] neg_hi:[0,1]
v_pk_add_f32 v[38:39], v[38:39], v[46:47]
v_pk_mul_f32 v[46:47], v[44:45], s[62:63] op_sel:[0,0] op_sel_hi:[0,1] neg_lo:[0,1] neg_hi:[0,0]
v_pk_fma_f32 v[46:47], v[44:45], s[62:63], v[46:47] op_sel:[1,1,0] op_sel_hi:[1,0,1] neg_lo:[0,1,0] neg_hi:[0,1,0]
v_pk_add_f32 v[44:45], v[14:15], v[56:57] neg_lo:[0,1] neg_hi:[0,1]
v_pk_add_f32 v[14:15], v[14:15], v[56:57]
v_pk_add_f32 v[56:57], v[50:51], v[58:59] neg_lo:[0,1] neg_hi:[0,1]
v_pk_add_f32 v[50:51], v[50:51], v[58:59]
v_pk_mul_f32 v[58:59], v[56:57], s[62:63] op_sel:[0,0] op_sel_hi:[0,1] neg_lo:[0,0] neg_hi:[0,0]
v_pk_fma_f32 v[58:59], v[56:57], s[62:63], v[58:59] op_sel:[1,1,0] op_sel_hi:[1,0,1] neg_lo:[0,1,0] neg_hi:[0,0,0]
v_pk_add_f32 v[56:57], v[52:53], v[60:61] op_sel:[1,1] op_sel_hi:[0,0] neg_lo:[1,0] neg_hi:[0,1]
v_pk_add_f32 v[52:53], v[52:53], v[60:61]
v_pk_add_f32 v[60:61], v[54:55], v[62:63] neg_lo:[0,1] neg_hi:[0,1]
v_pk_add_f32 v[54:55], v[54:55], v[62:63]
v_pk_mul_f32 v[62:63], v[60:61], s[62:63] op_sel:[0,0] op_sel_hi:[0,1] neg_lo:[0,1] neg_hi:[0,0]
v_pk_fma_f32 v[62:63], v[60:61], s[62:63], v[62:63] op_sel:[1,1,0] op_sel_hi:[1,0,1] neg_lo:[0,1,0] neg_hi:[0,1,0]
v_pk_add_f32 v[60:61], v[40:41], v[48:49] neg_lo:[0,1] neg_hi:[0,1]
v_pk_add_f32 v[40:41], v[40:41], v[48:49]
v_pk_add_f32 v[48:49], v[66:67], v[74:75] neg_lo:[0,1] neg_hi:[0,1]
v_pk_add_f32 v[66:67], v[66:67], v[74:75]
v_pk_mul_f32 v[74:75], v[48:49], s[62:63] op_sel:[0,0] op_sel_hi:[0,1] neg_lo:[0,0] neg_hi:[0,0]
v_pk_fma_f32 v[74:75], v[48:49], s[62:63], v[74:75] op_sel:[1,1,0] op_sel_hi:[1,0,1] neg_lo:[0,1,0] neg_hi:[0,0,0]
v_pk_add_f32 v[48:49], v[68:69], v[76:77] op_sel:[1,1] op_sel_hi:[0,0] neg_lo:[1,0] neg_hi:[0,1]
v_pk_add_f32 v[68:69], v[68:69], v[76:77]
v_pk_add_f32 v[76:77], v[70:71], v[78:79] neg_lo:[0,1] neg_hi:[0,1]
v_pk_add_f32 v[70:71], v[70:71], v[78:79]
v_pk_mul_f32 v[78:79], v[76:77], s[62:63] op_sel:[0,0] op_sel_hi:[0,1] neg_lo:[0,1] neg_hi:[0,0]
v_pk_fma_f32 v[78:79], v[76:77], s[62:63], v[78:79] op_sel:[1,1,0] op_sel_hi:[1,0,1] neg_lo:[0,1,0] neg_hi:[0,1,0]
v_pk_add_f32 v[76:77], v[16:17], v[20:21] neg_lo:[0,1] neg_hi:[0,1]
v_pk_add_f32 v[16:17], v[16:17], v[20:21]
v_pk_add_f32 v[20:21], v[18:19], v[22:23] op_sel:[1,1] op_sel_hi:[0,0] neg_lo:[1,0] neg_hi:[0,1]
v_pk_add_f32 v[18:19], v[18:19], v[22:23]
v_pk_add_f32 v[22:23], v[72:73], v[24:25] neg_lo:[0,1] neg_hi:[0,1]
v_pk_add_f32 v[72:73], v[72:73], v[24:25]
v_pk_add_f32 v[24:25], v[26:27], v[30:31] op_sel:[1,1] op_sel_hi:[0,0] neg_lo:[1,0] neg_hi:[0,1]
v_pk_add_f32 v[26:27], v[26:27], v[30:31]
v_pk_add_f32 v[30:31], v[64:65], v[36:37] neg_lo:[0,1] neg_hi:[0,1]
v_pk_add_f32 v[64:65], v[64:65], v[36:37]
v_pk_add_f32 v[36:37], v[34:35], v[38:39] op_sel:[1,1] op_sel_hi:[0,0] neg_lo:[1,0] neg_hi:[0,1]
v_pk_add_f32 v[34:35], v[34:35], v[38:39]
v_pk_add_f32 v[38:39], v[28:29], v[32:33] neg_lo:[0,1] neg_hi:[0,1]
v_pk_add_f32 v[28:29], v[28:29], v[32:33]
v_pk_add_f32 v[32:33], v[42:43], v[46:47] op_sel:[1,1] op_sel_hi:[0,0] neg_lo:[1,0] neg_hi:[0,1]
v_pk_add_f32 v[42:43], v[42:43], v[46:47]
v_pk_add_f32 v[46:47], v[14:15], v[52:53] neg_lo:[0,1] neg_hi:[0,1]
v_pk_add_f32 v[14:15], v[14:15], v[52:53]
v_pk_add_f32 v[52:53], v[50:51], v[54:55] op_sel:[1,1] op_sel_hi:[0,0] neg_lo:[1,0] neg_hi:[0,1]
v_pk_add_f32 v[50:51], v[50:51], v[54:55]
v_pk_add_f32 v[54:55], v[44:45], v[56:57] neg_lo:[0,1] neg_hi:[0,1]
v_pk_add_f32 v[44:45], v[44:45], v[56:57]
v_pk_add_f32 v[56:57], v[58:59], v[62:63] op_sel:[1,1] op_sel_hi:[0,0] neg_lo:[1,0] neg_hi:[0,1]
v_pk_add_f32 v[58:59], v[58:59], v[62:63]
v_pk_add_f32 v[62:63], v[40:41], v[68:69] neg_lo:[0,1] neg_hi:[0,1]
v_pk_add_f32 v[40:41], v[40:41], v[68:69]
v_pk_add_f32 v[68:69], v[66:67], v[70:71] op_sel:[1,1] op_sel_hi:[0,0] neg_lo:[1,0] neg_hi:[0,1]
v_pk_add_f32 v[66:67], v[66:67], v[70:71]
v_pk_add_f32 v[70:71], v[60:61], v[48:49] neg_lo:[0,1] neg_hi:[0,1]
v_pk_add_f32 v[60:61], v[60:61], v[48:49]
v_pk_add_f32 v[48:49], v[74:75], v[78:79] op_sel:[1,1] op_sel_hi:[0,0] neg_lo:[1,0] neg_hi:[0,1]
v_pk_add_f32 v[74:75], v[74:75], v[78:79]
v_pk_add_f32 v[78:79], v[16:17], v[18:19] neg_lo:[0,1] neg_hi:[0,1]
v_pk_add_f32 v[16:17], v[16:17], v[18:19]
v_pk_add_f32 v[18:19], v[76:77], v[20:21] neg_lo:[0,1] neg_hi:[0,1]
v_pk_add_f32 v[76:77], v[76:77], v[20:21]
v_pk_add_f32 v[20:21], v[72:73], v[26:27] neg_lo:[0,1] neg_hi:[0,1]
v_pk_add_f32 v[72:73], v[72:73], v[26:27]
v_pk_add_f32 v[26:27], v[22:23], v[24:25] neg_lo:[0,1] neg_hi:[0,1]
v_pk_add_f32 v[22:23], v[22:23], v[24:25]
v_pk_add_f32 v[24:25], v[64:65], v[34:35] neg_lo:[0,1] neg_hi:[0,1]
v_pk_add_f32 v[64:65], v[64:65], v[34:35]
v_pk_add_f32 v[34:35], v[30:31], v[36:37] neg_lo:[0,1] neg_hi:[0,1]
v_pk_add_f32 v[30:31], v[30:31], v[36:37]
v_pk_add_f32 v[36:37], v[28:29], v[42:43] neg_lo:[0,1] neg_hi:[0,1]
v_pk_add_f32 v[28:29], v[28:29], v[42:43]
v_pk_add_f32 v[42:43], v[38:39], v[32:33] neg_lo:[0,1] neg_hi:[0,1]
v_pk_add_f32 v[38:39], v[38:39], v[32:33]
v_pk_add_f32 v[32:33], v[14:15], v[50:51] neg_lo:[0,1] neg_hi:[0,1]
v_pk_add_f32 v[14:15], v[14:15], v[50:51]
v_pk_add_f32 v[50:51], v[46:47], v[52:53] neg_lo:[0,1] neg_hi:[0,1]
v_pk_add_f32 v[46:47], v[46:47], v[52:53]
v_pk_add_f32 v[52:53], v[44:45], v[58:59] neg_lo:[0,1] neg_hi:[0,1]
v_pk_add_f32 v[44:45], v[44:45], v[58:59]
v_pk_add_f32 v[58:59], v[54:55], v[56:57] neg_lo:[0,1] neg_hi:[0,1]
v_pk_add_f32 v[54:55], v[54:55], v[56:57]
v_pk_add_f32 v[56:57], v[40:41], v[66:67] neg_lo:[0,1] neg_hi:[0,1]
v_pk_add_f32 v[40:41], v[40:41], v[66:67]
v_pk_add_f32 v[66:67], v[62:63], v[68:69] neg_lo:[0,1] neg_hi:[0,1]
v_pk_add_f32 v[62:63], v[62:63], v[68:69]
v_pk_add_f32 v[68:69], v[60:61], v[74:75] neg_lo:[0,1] neg_hi:[0,1]
v_pk_add_f32 v[60:61], v[60:61], v[74:75]
v_pk_add_f32 v[74:75], v[70:71], v[48:49] neg_lo:[0,1] neg_hi:[0,1]
v_pk_add_f32 v[70:71], v[70:71], v[48:49]
ds_write2st64_b32 v12, v16, v17 offset0:0 offset1:16
ds_write_b32 v12, v14 offset:128
ds_write_b32 v12, v15 offset:4224
ds_write_b32 v12, v64 offset:256
ds_write_b32 v12, v65 offset:4352
ds_write_b32 v12, v40 offset:384
ds_write_b32 v12, v41 offset:4480
ds_write_b32 v12, v72 offset:512
ds_write_b32 v12, v73 offset:4608
ds_write_b32 v12, v44 offset:640
ds_write_b32 v12, v45 offset:4736
ds_write_b32 v12, v28 offset:768
ds_write_b32 v12, v29 offset:4864
ds_write_b32 v12, v60 offset:896
ds_write_b32 v12, v61 offset:4992
ds_write_b32 v12, v76 offset:1024
ds_write_b32 v12, v77 offset:5120
ds_write_b32 v12, v46 offset:1152
ds_write_b32 v12, v47 offset:5248
ds_write_b32 v12, v30 offset:1280
ds_write_b32 v12, v31 offset:5376
ds_write_b32 v12, v62 offset:1408
ds_write_b32 v12, v63 offset:5504
ds_write_b32 v12, v22 offset:1536
ds_write_b32 v12, v23 offset:5632
ds_write_b32 v12, v54 offset:1664
ds_write_b32 v12, v55 offset:5760
ds_write_b32 v12, v38 offset:1792
ds_write_b32 v12, v39 offset:5888
ds_write_b32 v12, v70 offset:1920
ds_write_b32 v12, v71 offset:6016
ds_write_b32 v12, v78 offset:2048
ds_write_b32 v12, v79 offset:6144
ds_write_b32 v12, v32 offset:2176
ds_write_b32 v12, v33 offset:6272
ds_write_b32 v12, v24 offset:2304
ds_write_b32 v12, v25 offset:6400
ds_write_b32 v12, v56 offset:2432
ds_write_b32 v12, v57 offset:6528
ds_write_b32 v12, v20 offset:2560
ds_write_b32 v12, v21 offset:6656
ds_write_b32 v12, v52 offset:2688
ds_write_b32 v12, v53 offset:6784
ds_write_b32 v12, v36 offset:2816
ds_write_b32 v12, v37 offset:6912
ds_write_b32 v12, v68 offset:2944
ds_write_b32 v12, v69 offset:7040
ds_write_b32 v12, v18 offset:3072
ds_write_b32 v12, v19 offset:7168
ds_write_b32 v12, v50 offset:3200
ds_write_b32 v12, v51 offset:7296
ds_write_b32 v12, v34 offset:3328
ds_write_b32 v12, v35 offset:7424
ds_write_b32 v12, v66 offset:3456
ds_write_b32 v12, v67 offset:7552
ds_write_b32 v12, v26 offset:3584
ds_write_b32 v12, v27 offset:7680
ds_write_b32 v12, v58 offset:3712
ds_write_b32 v12, v59 offset:7808
ds_write_b32 v12, v42 offset:3840
ds_write_b32 v12, v43 offset:7936
ds_write_b32 v12, v74 offset:3968
ds_write_b32 v12, v75 offset:8064
s_waitcnt lgkmcnt(0)
s_barrier
s_lshl_b32 s13, s93, 16
ds_read_b128 v[16:19], v2 offset:0
ds_read_b128 v[20:23], v2 offset:16
ds_read_b128 v[24:27], v2 offset:8448
ds_read_b128 v[28:31], v2 offset:8464
ds_read_b128 v[32:35], v2 offset:16896
ds_read_b128 v[36:39], v2 offset:16912
ds_read_b128 v[40:43], v2 offset:25344
ds_read_b128 v[44:47], v2 offset:25360
ds_read_b128 v[48:51], v2 offset:33792
ds_read_b128 v[52:55], v2 offset:33808
ds_read_b128 v[56:59], v2 offset:42240
ds_read_b128 v[60:63], v2 offset:42256
ds_read_b128 v[64:67], v2 offset:50688
ds_read_b128 v[68:71], v2 offset:50704
s_waitcnt lgkmcnt(12)
ds_read_b128 v[72:75], v2 offset:59136
ds_read_b128 v[76:79], v2 offset:59152
s_waitcnt lgkmcnt(14)
v_cvt_pk_bf16_f32 v216, v16, v17
v_cvt_pk_bf16_f32 v217, v18, v19
v_cvt_pk_bf16_f32 v218, v20, v21
v_cvt_pk_bf16_f32 v219, v22, v23
buffer_store_dwordx4 v[216:219], v3, s[4:7], s13 offen
s_add_u32 s13, s13, 8192
s_waitcnt lgkmcnt(12)
v_cvt_pk_bf16_f32 v220, v24, v25
v_cvt_pk_bf16_f32 v221, v26, v27
v_cvt_pk_bf16_f32 v222, v28, v29
v_cvt_pk_bf16_f32 v223, v30, v31
buffer_store_dwordx4 v[220:223], v3, s[4:7], s13 offen
s_add_u32 s13, s13, 8192
s_waitcnt lgkmcnt(10)
v_cvt_pk_bf16_f32 v224, v32, v33
v_cvt_pk_bf16_f32 v225, v34, v35
v_cvt_pk_bf16_f32 v226, v36, v37
v_cvt_pk_bf16_f32 v227, v38, v39
buffer_store_dwordx4 v[224:227], v3, s[4:7], s13 offen
s_add_u32 s13, s13, 8192
s_waitcnt lgkmcnt(8)
v_cvt_pk_bf16_f32 v228, v40, v41
v_cvt_pk_bf16_f32 v229, v42, v43
v_cvt_pk_bf16_f32 v230, v44, v45
v_cvt_pk_bf16_f32 v231, v46, v47
buffer_store_dwordx4 v[228:231], v3, s[4:7], s13 offen
s_add_u32 s13, s13, 8192
s_waitcnt lgkmcnt(6)
v_cvt_pk_bf16_f32 v232, v48, v49
v_cvt_pk_bf16_f32 v233, v50, v51
v_cvt_pk_bf16_f32 v234, v52, v53
v_cvt_pk_bf16_f32 v235, v54, v55
buffer_store_dwordx4 v[232:235], v3, s[4:7], s13 offen
s_add_u32 s13, s13, 8192
s_waitcnt lgkmcnt(4)
v_cvt_pk_bf16_f32 v236, v56, v57
v_cvt_pk_bf16_f32 v237, v58, v59
v_cvt_pk_bf16_f32 v238, v60, v61
v_cvt_pk_bf16_f32 v239, v62, v63
buffer_store_dwordx4 v[236:239], v3, s[4:7], s13 offen
s_add_u32 s13, s13, 8192
s_waitcnt lgkmcnt(2)
v_cvt_pk_bf16_f32 v240, v64, v65
v_cvt_pk_bf16_f32 v241, v66, v67
v_cvt_pk_bf16_f32 v242, v68, v69
v_cvt_pk_bf16_f32 v243, v70, v71
buffer_store_dwordx4 v[240:243], v3, s[4:7], s13 offen
s_add_u32 s13, s13, 8192
s_waitcnt lgkmcnt(0)
v_cvt_pk_bf16_f32 v244, v72, v73
v_cvt_pk_bf16_f32 v245, v74, v75
v_cvt_pk_bf16_f32 v246, v76, v77
v_cvt_pk_bf16_f32 v247, v78, v79
buffer_store_dwordx4 v[244:247], v3, s[4:7], s13 offen
s_add_u32 s13, s13, 8192
s_mov_b32 s93, s21
s_cmp_lt_u32 s93, 128
s_cbranch_scc1 mega_kernel_f3_l
mega_kernel_f3_e:
s_add_u32 s64, s91, 62
s_add_u32 s65, s91, 63
s_mov_b32 s66, 262144
s_mov_b32 s67, 1
s_waitcnt vmcnt(0)
s_barrier
mega_kernel_out:
s_load_dwordx2 s[4:5], s[0:1], 40
s_load_dwordx2 s[8:9], s[0:1], 80
v_lshrrev_b32 v2, 6, v0
v_and_b32 v1, 63, v0
v_readfirstlane_b32 s41, v2
v_lshlrev_b32 v5, 4, v1
s_waitcnt lgkmcnt(0)
s_mov_b32 s6, 8388608
s_mov_b32 s7, 0x00020000
s_mov_b32 s10, 8388608
s_mov_b32 s11, 0x00020000
s_and_b32 s58, s40, 1
s_lshr_b32 s59, s40, 1
s_lshl_b32 s43, s58, 22
s_lshl_b32 s44, s41, 20
s_add_u32 s43, s43, s44
s_lshl_b32 s44, s59, 7
s_add_u32 s48, s43, s44
s_and_b32 s56, s59, 7
s_lshl_b32 s56, s56, 6
v_lshrrev_b32 v2, 3, v1
v_and_b32 v3, 7, v1
v_lshlrev_b32 v16, 11, v2
v_lshl_add_u32 v16, v3, 4, v16
v_add_u32 v16, s48, v16
v_and_b32 v3, 3, v1
s_lshl_b32 s45, s41, 15
v_bfe_u32 v17, v1, 2, 2
v_lshrrev_b32 v18, 5, v1
v_mul_u32_u24 v18, 4, v18
v_add_u32 v17, v17, v18
v_lshlrev_b32 v17, 7, v17
v_bfe_u32 v18, v1, 4, 1
v_lshl_add_u32 v17, v18, 5, v17
v_lshl_add_u32 v17, v3, 3, v17
v_add_u32 v17, s45, v17
s_add_u32 m0, s45, 0
s_add_u32 s44, s56, 0
s_and_b32 s44, s44, 511
s_lshl_b32 s44, s44, 11
buffer_load_dwordx4 v16, s[4:7], s44 offen lds
s_add_u32 m0, s45, 1024
s_add_u32 s44, s56, 8
s_and_b32 s44, s44, 511
s_lshl_b32 s44, s44, 11
buffer_load_dwordx4 v16, s[4:7], s44 offen lds
s_add_u32 m0, s45, 2048
s_add_u32 s44, s56, 16
s_and_b32 s44, s44, 511
s_lshl_b32 s44, s44, 11
buffer_load_dwordx4 v16, s[4:7], s44 offen lds
s_add_u32 m0, s45, 3072
s_add_u32 s44, s56, 24
s_and_b32 s44, s44, 511
s_lshl_b32 s44, s44, 11
buffer_load_dwordx4 v16, s[4:7], s44 offen lds
s_add_u32 m0, s45, 4096
s_add_u32 s44, s56, 32
s_and_b32 s44, s44, 511
s_lshl_b32 s44, s44, 11
buffer_load_dwordx4 v16, s[4:7], s44 offen lds
s_add_u32 m0, s45, 5120
s_add_u32 s44, s56, 40
s_and_b32 s44, s44, 511
s_lshl_b32 s44, s44, 11
buffer_load_dwordx4 v16, s[4:7], s44 offen lds
s_add_u32 m0, s45, 6144
s_add_u32 s44, s56, 48
s_and_b32 s44, s44, 511
s_lshl_b32 s44, s44, 11
buffer_load_dwordx4 v16, s[4:7], s44 offen lds
s_add_u32 m0, s45, 7168
s_add_u32 s44, s56, 56
s_and_b32 s44, s44, 511
s_lshl_b32 s44, s44, 11
buffer_load_dwordx4 v16, s[4:7], s44 offen lds
s_add_u32 m0, s45, 8192
s_add_u32 s44, s56, 64
s_and_b32 s44, s44, 511
s_lshl_b32 s44, s44, 11
buffer_load_dwordx4 v16, s[4:7], s44 offen lds
s_add_u32 m0, s45, 9216
s_add_u32 s44, s56, 72
s_and_b32 s44, s44, 511
s_lshl_b32 s44, s44, 11
buffer_load_dwordx4 v16, s[4:7], s44 offen lds
s_add_u32 m0, s45, 10240
s_add_u32 s44, s56, 80
s_and_b32 s44, s44, 511
s_lshl_b32 s44, s44, 11
buffer_load_dwordx4 v16, s[4:7], s44 offen lds
s_add_u32 m0, s45, 11264
s_add_u32 s44, s56, 88
s_and_b32 s44, s44, 511
s_lshl_b32 s44, s44, 11
buffer_load_dwordx4 v16, s[4:7], s44 offen lds
s_add_u32 m0, s45, 12288
s_add_u32 s44, s56, 96
s_and_b32 s44, s44, 511
s_lshl_b32 s44, s44, 11
buffer_load_dwordx4 v16, s[4:7], s44 offen lds
s_add_u32 m0, s45, 13312
s_add_u32 s44, s56, 104
s_and_b32 s44, s44, 511
s_lshl_b32 s44, s44, 11
buffer_load_dwordx4 v16, s[4:7], s44 offen lds
s_add_u32 m0, s45, 14336
s_add_u32 s44, s56, 112
s_and_b32 s44, s44, 511
s_lshl_b32 s44, s44, 11
buffer_load_dwordx4 v16, s[4:7], s44 offen lds
s_add_u32 m0, s45, 15360
s_add_u32 s44, s56, 120
s_and_b32 s44, s44, 511
s_lshl_b32 s44, s44, 11
buffer_load_dwordx4 v16, s[4:7], s44 offen lds
s_add_u32 m0, s45, 16384
s_add_u32 s44, s56, 128
s_and_b32 s44, s44, 511
s_lshl_b32 s44, s44, 11
buffer_load_dwordx4 v16, s[4:7], s44 offen lds
s_add_u32 m0, s45, 17408
s_add_u32 s44, s56, 136
s_and_b32 s44, s44, 511
s_lshl_b32 s44, s44, 11
buffer_load_dwordx4 v16, s[4:7], s44 offen lds
s_add_u32 m0, s45, 18432
s_add_u32 s44, s56, 144
s_and_b32 s44, s44, 511
s_lshl_b32 s44, s44, 11
buffer_load_dwordx4 v16, s[4:7], s44 offen lds
s_add_u32 m0, s45, 19456
s_add_u32 s44, s56, 152
s_and_b32 s44, s44, 511
s_lshl_b32 s44, s44, 11
buffer_load_dwordx4 v16, s[4:7], s44 offen lds
s_add_u32 m0, s45, 20480
s_add_u32 s44, s56, 160
s_and_b32 s44, s44, 511
s_lshl_b32 s44, s44, 11
buffer_load_dwordx4 v16, s[4:7], s44 offen lds
s_add_u32 m0, s45, 21504
s_add_u32 s44, s56, 168
s_and_b32 s44, s44, 511
s_lshl_b32 s44, s44, 11
buffer_load_dwordx4 v16, s[4:7], s44 offen lds
s_add_u32 m0, s45, 22528
s_add_u32 s44, s56, 176
s_and_b32 s44, s44, 511
s_lshl_b32 s44, s44, 11
buffer_load_dwordx4 v16, s[4:7], s44 offen lds
s_add_u32 m0, s45, 23552
s_add_u32 s44, s56, 184
s_and_b32 s44, s44, 511
s_lshl_b32 s44, s44, 11
buffer_load_dwordx4 v16, s[4:7], s44 offen lds
s_add_u32 m0, s45, 24576
s_add_u32 s44, s56, 192
s_and_b32 s44, s44, 511
s_lshl_b32 s44, s44, 11
buffer_load_dwordx4 v16, s[4:7], s44 offen lds
s_add_u32 m0, s45, 25600
s_add_u32 s44, s56, 200
s_and_b32 s44, s44, 511
s_lshl_b32 s44, s44, 11
buffer_load_dwordx4 v16, s[4:7], s44 offen lds
s_add_u32 m0, s45, 26624
s_add_u32 s44, s56, 208
s_and_b32 s44, s44, 511
s_lshl_b32 s44, s44, 11
buffer_load_dwordx4 v16, s[4:7], s44 offen lds
s_add_u32 m0, s45, 27648
s_add_u32 s44, s56, 216
s_and_b32 s44, s44, 511
s_lshl_b32 s44, s44, 11
buffer_load_dwordx4 v16, s[4:7], s44 offen lds
s_add_u32 m0, s45, 28672
s_add_u32 s44, s56, 224
s_and_b32 s44, s44, 511
s_lshl_b32 s44, s44, 11
buffer_load_dwordx4 v16, s[4:7], s44 offen lds
s_add_u32 m0, s45, 29696
s_add_u32 s44, s56, 232
s_and_b32 s44, s44, 511
s_lshl_b32 s44, s44, 11
buffer_load_dwordx4 v16, s[4:7], s44 offen lds
s_add_u32 m0, s45, 30720
s_add_u32 s44, s56, 240
s_and_b32 s44, s44, 511
s_lshl_b32 s44, s44, 11
buffer_load_dwordx4 v16, s[4:7], s44 offen lds
s_add_u32 m0, s45, 31744
s_add_u32 s44, s56, 248
s_and_b32 s44, s44, 511
s_lshl_b32 s44, s44, 11
buffer_load_dwordx4 v16, s[4:7], s44 offen lds
s_waitcnt vmcnt(16)
ds_read_b64_tr_b16 a[0:1], v17 offset:0
ds_read_b64_tr_b16 a[2:3], v17 offset:2048
ds_read_b64_tr_b16 a[4:5], v17 offset:64
ds_read_b64_tr_b16 a[6:7], v17 offset:2112
ds_read_b64_tr_b16 a[8:9], v17 offset:1024
ds_read_b64_tr_b16 a[10:11], v17 offset:3072
ds_read_b64_tr_b16 a[12:13], v17 offset:1088
ds_read_b64_tr_b16 a[14:15], v17 offset:3136
s_waitcnt lgkmcnt(0)
ds_read_b64_tr_b16 a[16:17], v17 offset:4096
ds_read_b64_tr_b16 a[18:19], v17 offset:6144
ds_read_b64_tr_b16 a[20:21], v17 offset:4160
ds_read_b64_tr_b16 a[22:23], v17 offset:6208
ds_read_b64_tr_b16 a[24:25], v17 offset:5120
ds_read_b64_tr_b16 a[26:27], v17 offset:7168
ds_read_b64_tr_b16 a[28:29], v17 offset:5184
ds_read_b64_tr_b16 a[30:31], v17 offset:7232
s_waitcnt lgkmcnt(0)
ds_read_b64_tr_b16 a[32:33], v17 offset:8192
ds_read_b64_tr_b16 a[34:35], v17 offset:10240
ds_read_b64_tr_b16 a[36:37], v17 offset:8256
ds_read_b64_tr_b16 a[38:39], v17 offset:10304
ds_read_b64_tr_b16 a[40:41], v17 offset:9216
ds_read_b64_tr_b16 a[42:43], v17 offset:11264
ds_read_b64_tr_b16 a[44:45], v17 offset:9280
ds_read_b64_tr_b16 a[46:47], v17 offset:11328
s_waitcnt lgkmcnt(0)
ds_read_b64_tr_b16 a[48:49], v17 offset:12288
ds_read_b64_tr_b16 a[50:51], v17 offset:14336
ds_read_b64_tr_b16 a[52:53], v17 offset:12352
ds_read_b64_tr_b16 a[54:55], v17 offset:14400
ds_read_b64_tr_b16 a[56:57], v17 offset:13312
ds_read_b64_tr_b16 a[58:59], v17 offset:15360
ds_read_b64_tr_b16 a[60:61], v17 offset:13376
ds_read_b64_tr_b16 a[62:63], v17 offset:15424
s_waitcnt lgkmcnt(0)
s_add_u32 m0, s45, 0
s_add_u32 s44, s56, 256
s_and_b32 s44, s44, 511
s_lshl_b32 s44, s44, 11
buffer_load_dwordx4 v16, s[4:7], s44 offen lds
s_add_u32 m0, s45, 1024
s_add_u32 s44, s56, 264
s_and_b32 s44, s44, 511
s_lshl_b32 s44, s44, 11
buffer_load_dwordx4 v16, s[4:7], s44 offen lds
s_add_u32 m0, s45, 2048
s_add_u32 s44, s56, 272
s_and_b32 s44, s44, 511
s_lshl_b32 s44, s44, 11
buffer_load_dwordx4 v16, s[4:7], s44 offen lds
s_add_u32 m0, s45, 3072
s_add_u32 s44, s56, 280
s_and_b32 s44, s44, 511
s_lshl_b32 s44, s44, 11
buffer_load_dwordx4 v16, s[4:7], s44 offen lds
s_add_u32 m0, s45, 4096
s_add_u32 s44, s56, 288
s_and_b32 s44, s44, 511
s_lshl_b32 s44, s44, 11
buffer_load_dwordx4 v16, s[4:7], s44 offen lds
s_add_u32 m0, s45, 5120
s_add_u32 s44, s56, 296
s_and_b32 s44, s44, 511
s_lshl_b32 s44, s44, 11
buffer_load_dwordx4 v16, s[4:7], s44 offen lds
s_add_u32 m0, s45, 6144
s_add_u32 s44, s56, 304
s_and_b32 s44, s44, 511
s_lshl_b32 s44, s44, 11
buffer_load_dwordx4 v16, s[4:7], s44 offen lds
s_add_u32 m0, s45, 7168
s_add_u32 s44, s56, 312
s_and_b32 s44, s44, 511
s_lshl_b32 s44, s44, 11
buffer_load_dwordx4 v16, s[4:7], s44 offen lds
s_add_u32 m0, s45, 8192
s_add_u32 s44, s56, 320
s_and_b32 s44, s44, 511
s_lshl_b32 s44, s44, 11
buffer_load_dwordx4 v16, s[4:7], s44 offen lds
s_add_u32 m0, s45, 9216
s_add_u32 s44, s56, 328
s_and_b32 s44, s44, 511
s_lshl_b32 s44, s44, 11
buffer_load_dwordx4 v16, s[4:7], s44 offen lds
s_add_u32 m0, s45, 10240
s_add_u32 s44, s56, 336
s_and_b32 s44, s44, 511
s_lshl_b32 s44, s44, 11
buffer_load_dwordx4 v16, s[4:7], s44 offen lds
s_add_u32 m0, s45, 11264
s_add_u32 s44, s56, 344
s_and_b32 s44, s44, 511
s_lshl_b32 s44, s44, 11
buffer_load_dwordx4 v16, s[4:7], s44 offen lds
s_add_u32 m0, s45, 12288
s_add_u32 s44, s56, 352
s_and_b32 s44, s44, 511
s_lshl_b32 s44, s44, 11
buffer_load_dwordx4 v16, s[4:7], s44 offen lds
s_add_u32 m0, s45, 13312
s_add_u32 s44, s56, 360
s_and_b32 s44, s44, 511
s_lshl_b32 s44, s44, 11
buffer_load_dwordx4 v16, s[4:7], s44 offen lds
s_add_u32 m0, s45, 14336
s_add_u32 s44, s56, 368
s_and_b32 s44, s44, 511
s_lshl_b32 s44, s44, 11
buffer_load_dwordx4 v16, s[4:7], s44 offen lds
s_add_u32 m0, s45, 15360
s_add_u32 s44, s56, 376
s_and_b32 s44, s44, 511
s_lshl_b32 s44, s44, 11
buffer_load_dwordx4 v16, s[4:7], s44 offen lds
s_waitcnt vmcnt(16)
ds_read_b64_tr_b16 a[64:65], v17 offset:16384
ds_read_b64_tr_b16 a[66:67], v17 offset:18432
ds_read_b64_tr_b16 a[68:69], v17 offset:16448
ds_read_b64_tr_b16 a[70:71], v17 offset:18496
ds_read_b64_tr_b16 a[72:73], v17 offset:17408
ds_read_b64_tr_b16 a[74:75], v17 offset:19456
ds_read_b64_tr_b16 a[76:77], v17 offset:17472
ds_read_b64_tr_b16 a[78:79], v17 offset:19520
s_waitcnt lgkmcnt(0)
ds_read_b64_tr_b16 a[80:81], v17 offset:20480
ds_read_b64_tr_b16 a[82:83], v17 offset:22528
ds_read_b64_tr_b16 a[84:85], v17 offset:20544
ds_read_b64_tr_b16 a[86:87], v17 offset:22592
ds_read_b64_tr_b16 a[88:89], v17 offset:21504
ds_read_b64_tr_b16 a[90:91], v17 offset:23552
ds_read_b64_tr_b16 a[92:93], v17 offset:21568
ds_read_b64_tr_b16 a[94:95], v17 offset:23616
s_waitcnt lgkmcnt(0)
ds_read_b64_tr_b16 a[96:97], v17 offset:24576
ds_read_b64_tr_b16 a[98:99], v17 offset:26624
ds_read_b64_tr_b16 a[100:101], v17 offset:24640
ds_read_b64_tr_b16 a[102:103], v17 offset:26688
ds_read_b64_tr_b16 a[104:105], v17 offset:25600
ds_read_b64_tr_b16 a[106:107], v17 offset:27648
ds_read_b64_tr_b16 a[108:109], v17 offset:25664
ds_read_b64_tr_b16 a[110:111], v17 offset:27712
s_waitcnt lgkmcnt(0)
ds_read_b64_tr_b16 a[112:113], v17 offset:28672
ds_read_b64_tr_b16 a[114:115], v17 offset:30720
ds_read_b64_tr_b16 a[116:117], v17 offset:28736
ds_read_b64_tr_b16 a[118:119], v17 offset:30784
ds_read_b64_tr_b16 a[120:121], v17 offset:29696
ds_read_b64_tr_b16 a[122:123], v17 offset:31744
ds_read_b64_tr_b16 a[124:125], v17 offset:29760
ds_read_b64_tr_b16 a[126:127], v17 offset:31808
s_waitcnt lgkmcnt(0)
s_add_u32 m0, s45, 16384
s_add_u32 s44, s56, 384
s_and_b32 s44, s44, 511
s_lshl_b32 s44, s44, 11
buffer_load_dwordx4 v16, s[4:7], s44 offen lds
s_add_u32 m0, s45, 17408
s_add_u32 s44, s56, 392
s_and_b32 s44, s44, 511
s_lshl_b32 s44, s44, 11
buffer_load_dwordx4 v16, s[4:7], s44 offen lds
s_add_u32 m0, s45, 18432
s_add_u32 s44, s56, 400
s_and_b32 s44, s44, 511
s_lshl_b32 s44, s44, 11
buffer_load_dwordx4 v16, s[4:7], s44 offen lds
s_add_u32 m0, s45, 19456
s_add_u32 s44, s56, 408
s_and_b32 s44, s44, 511
s_lshl_b32 s44, s44, 11
buffer_load_dwordx4 v16, s[4:7], s44 offen lds
s_add_u32 m0, s45, 20480
s_add_u32 s44, s56, 416
s_and_b32 s44, s44, 511
s_lshl_b32 s44, s44, 11
buffer_load_dwordx4 v16, s[4:7], s44 offen lds
s_add_u32 m0, s45, 21504
s_add_u32 s44, s56, 424
s_and_b32 s44, s44, 511
s_lshl_b32 s44, s44, 11
buffer_load_dwordx4 v16, s[4:7], s44 offen lds
s_add_u32 m0, s45, 22528
s_add_u32 s44, s56, 432
s_and_b32 s44, s44, 511
s_lshl_b32 s44, s44, 11
buffer_load_dwordx4 v16, s[4:7], s44 offen lds
s_add_u32 m0, s45, 23552
s_add_u32 s44, s56, 440
s_and_b32 s44, s44, 511
s_lshl_b32 s44, s44, 11
buffer_load_dwordx4 v16, s[4:7], s44 offen lds
s_add_u32 m0, s45, 24576
s_add_u32 s44, s56, 448
s_and_b32 s44, s44, 511
s_lshl_b32 s44, s44, 11
buffer_load_dwordx4 v16, s[4:7], s44 offen lds
s_add_u32 m0, s45, 25600
s_add_u32 s44, s56, 456
s_and_b32 s44, s44, 511
s_lshl_b32 s44, s44, 11
buffer_load_dwordx4 v16, s[4:7], s44 offen lds
s_add_u32 m0, s45, 26624
s_add_u32 s44, s56, 464
s_and_b32 s44, s44, 511
s_lshl_b32 s44, s44, 11
buffer_load_dwordx4 v16, s[4:7], s44 offen lds
s_add_u32 m0, s45, 27648
s_add_u32 s44, s56, 472
s_and_b32 s44, s44, 511
s_lshl_b32 s44, s44, 11
buffer_load_dwordx4 v16, s[4:7], s44 offen lds
s_add_u32 m0, s45, 28672
s_add_u32 s44, s56, 480
s_and_b32 s44, s44, 511
s_lshl_b32 s44, s44, 11
buffer_load_dwordx4 v16, s[4:7], s44 offen lds
s_add_u32 m0, s45, 29696
s_add_u32 s44, s56, 488
s_and_b32 s44, s44, 511
s_lshl_b32 s44, s44, 11
buffer_load_dwordx4 v16, s[4:7], s44 offen lds
s_add_u32 m0, s45, 30720
s_add_u32 s44, s56, 496
s_and_b32 s44, s44, 511
s_lshl_b32 s44, s44, 11
buffer_load_dwordx4 v16, s[4:7], s44 offen lds
s_add_u32 m0, s45, 31744
s_add_u32 s44, s56, 504
s_and_b32 s44, s44, 511
s_lshl_b32 s44, s44, 11
buffer_load_dwordx4 v16, s[4:7], s44 offen lds
s_waitcnt vmcnt(16)
ds_read_b64_tr_b16 a[128:129], v17 offset:0
ds_read_b64_tr_b16 a[130:131], v17 offset:2048
ds_read_b64_tr_b16 a[132:133], v17 offset:64
ds_read_b64_tr_b16 a[134:135], v17 offset:2112
ds_read_b64_tr_b16 a[136:137], v17 offset:1024
ds_read_b64_tr_b16 a[138:139], v17 offset:3072
ds_read_b64_tr_b16 a[140:141], v17 offset:1088
ds_read_b64_tr_b16 a[142:143], v17 offset:3136
s_waitcnt lgkmcnt(0)
ds_read_b64_tr_b16 a[144:145], v17 offset:4096
ds_read_b64_tr_b16 a[146:147], v17 offset:6144
ds_read_b64_tr_b16 a[148:149], v17 offset:4160
ds_read_b64_tr_b16 a[150:151], v17 offset:6208
ds_read_b64_tr_b16 a[152:153], v17 offset:5120
ds_read_b64_tr_b16 a[154:155], v17 offset:7168
ds_read_b64_tr_b16 a[156:157], v17 offset:5184
ds_read_b64_tr_b16 a[158:159], v17 offset:7232
s_waitcnt lgkmcnt(0)
ds_read_b64_tr_b16 a[160:161], v17 offset:8192
ds_read_b64_tr_b16 a[162:163], v17 offset:10240
ds_read_b64_tr_b16 a[164:165], v17 offset:8256
ds_read_b64_tr_b16 a[166:167], v17 offset:10304
ds_read_b64_tr_b16 a[168:169], v17 offset:9216
ds_read_b64_tr_b16 a[170:171], v17 offset:11264
ds_read_b64_tr_b16 a[172:173], v17 offset:9280
ds_read_b64_tr_b16 a[174:175], v17 offset:11328
s_waitcnt lgkmcnt(0)
ds_read_b64_tr_b16 a[176:177], v17 offset:12288
ds_read_b64_tr_b16 a[178:179], v17 offset:14336
ds_read_b64_tr_b16 a[180:181], v17 offset:12352
ds_read_b64_tr_b16 a[182:183], v17 offset:14400
ds_read_b64_tr_b16 a[184:185], v17 offset:13312
ds_read_b64_tr_b16 a[186:187], v17 offset:15360
ds_read_b64_tr_b16 a[188:189], v17 offset:13376
ds_read_b64_tr_b16 a[190:191], v17 offset:15424
s_waitcnt lgkmcnt(0)
s_waitcnt vmcnt(0)
ds_read_b64_tr_b16 a[192:193], v17 offset:16384
ds_read_b64_tr_b16 a[194:195], v17 offset:18432
ds_read_b64_tr_b16 a[196:197], v17 offset:16448
ds_read_b64_tr_b16 a[198:199], v17 offset:18496
ds_read_b64_tr_b16 a[200:201], v17 offset:17408
ds_read_b64_tr_b16 a[202:203], v17 offset:19456
ds_read_b64_tr_b16 a[204:205], v17 offset:17472
ds_read_b64_tr_b16 a[206:207], v17 offset:19520
s_waitcnt lgkmcnt(0)
ds_read_b64_tr_b16 a[208:209], v17 offset:20480
ds_read_b64_tr_b16 a[210:211], v17 offset:22528
ds_read_b64_tr_b16 a[212:213], v17 offset:20544
ds_read_b64_tr_b16 a[214:215], v17 offset:22592
ds_read_b64_tr_b16 a[216:217], v17 offset:21504
ds_read_b64_tr_b16 a[218:219], v17 offset:23552
ds_read_b64_tr_b16 a[220:221], v17 offset:21568
ds_read_b64_tr_b16 a[222:223], v17 offset:23616
s_waitcnt lgkmcnt(0)
ds_read_b64_tr_b16 a[224:225], v17 offset:24576
ds_read_b64_tr_b16 a[226:227], v17 offset:26624
ds_read_b64_tr_b16 a[228:229], v17 offset:24640
ds_read_b64_tr_b16 a[230:231], v17 offset:26688
ds_read_b64_tr_b16 a[232:233], v17 offset:25600
ds_read_b64_tr_b16 a[234:235], v17 offset:27648
ds_read_b64_tr_b16 a[236:237], v17 offset:25664
ds_read_b64_tr_b16 a[238:239], v17 offset:27712
s_waitcnt lgkmcnt(0)
ds_read_b64_tr_b16 a[240:241], v17 offset:28672
ds_read_b64_tr_b16 a[242:243], v17 offset:30720
ds_read_b64_tr_b16 a[244:245], v17 offset:28736
ds_read_b64_tr_b16 a[246:247], v17 offset:30784
ds_read_b64_tr_b16 a[248:249], v17 offset:29696
ds_read_b64_tr_b16 a[250:251], v17 offset:31744
ds_read_b64_tr_b16 a[252:253], v17 offset:29760
ds_read_b64_tr_b16 a[254:255], v17 offset:31808
s_waitcnt lgkmcnt(0)
s_barrier
s_lshl_b32 s56, s56, 6
s_lshl_b32 s43, s58, 17
s_lshl_b32 s44, s41, 15
s_add_u32 s43, s43, s44
s_add_u32 s43, s43, 134217728
v_add_u32 v6, s43, v5
v_and_b32 v2, 15, v1
v_lshlrev_b32 v7, 2, v2
s_lshl_b32 s43, s58, 8
s_lshl_b32 s44, s41, 6
s_add_u32 s43, s43, s44
s_add_u32 s43, s43, 69255168
v_add_u32 v7, s43, v7
s_mul_i32 s43, s41, 8704
v_lshrrev_b32 v2, 5, v1
v_lshl_add_u32 v8, v2, 5, v5
v_add_u32 v8, s43, v8
v_and_b32 v2, 7, v1
v_mul_u32_u24 v9, 544, v2
v_lshrrev_b32 v3, 3, v1
v_lshl_add_u32 v9, v3, 4, v9
s_lshl_b32 s43, s41, 7
v_add_u32 v9, s43, v9
s_mul_i32 s43, s58, 4352
s_sub_u32 s44, 4352, s43
v_add_u32 v10, s44, v9
v_add_u32 v9, s43, v9
s_lshl_b32 s43, s41, 15
s_lshl_b32 s44, s40, 6
s_add_u32 s43, s43, s44
v_lshlrev_b32 v11, 12, v3
v_and_b32 v2, 7, v1
v_lshl_add_u32 v11, v2, 3, v11
v_add_u32 v11, s43, v11
s_lshl_b32 s43, s40, 13
s_lshl_b32 s44, s41, 10
s_add_u32 s43, s43, s44
s_add_u32 s43, s43, 67633152
s_add_u32 s43, s43, s66
v_add_u32 v13, s43, v5
v_xor_b32 v12, 8192, v13
s_mov_b32 s42, s64
s_mov_b32 s52, 0
s_mov_b32 s53, 0
s_mov_b32 s57, 0
mega_kernel_o_cold:
s_cmp_gt_i32 s52, s42
s_cbranch_scc1 mega_kernel_o_fk
mega_kernel_o_fw:
buffer_load_dword v2, v7, s[84:87], 0 offen sc1
s_waitcnt vmcnt(0)
v_min_i32_dpp v2, v2, v2 quad_perm:[1,0,3,2] row_mask:0xf bank_mask:0xf
s_nop 1
v_min_i32_dpp v2, v2, v2 quad_perm:[2,3,0,1] row_mask:0xf bank_mask:0xf
s_nop 1
v_min_i32_dpp v2, v2, v2 row_ror:4 row_mask:0xf bank_mask:0xf
s_nop 1
v_min_i32_dpp v2, v2, v2 row_ror:8 row_mask:0xf bank_mask:0xf
s_nop 0
v_readfirstlane_b32 s52, v2
s_min_i32 s52, s52, s65
s_cmp_gt_i32 s52, s42
s_cbranch_scc1 mega_kernel_o_fk
s_sleep 2
s_add_u32 s43, s52, 2
s_cmp_gt_i32 s43, s42
s_cbranch_scc1 mega_kernel_o_fw
s_sleep 48
s_branch mega_kernel_o_fw
mega_kernel_o_fk:
s_lshl_b32 s50, s42, 18
s_add_u32 s51, s56, 0
s_and_b32 s51, s51, 0x7fff
s_add_u32 s51, s51, s50
buffer_load_dwordx4 v[96:99], v6, s[84:87], s51 offen offset:0 sc1
buffer_load_dwordx4 v[100:103], v6, s[84:87], s51 offen offset:1024 sc1
buffer_load_dwordx4 v[104:107], v6, s[84:87], s51 offen offset:2048 sc1
buffer_load_dwordx4 v[108:111], v6, s[84:87], s51 offen offset:3072 sc1
s_add_u32 s51, s56, 4096
s_and_b32 s51, s51, 0x7fff
s_add_u32 s51, s51, s50
buffer_load_dwordx4 v[112:115], v6, s[84:87], s51 offen offset:0 sc1
buffer_load_dwordx4 v[116:119], v6, s[84:87], s51 offen offset:1024 sc1
buffer_load_dwordx4 v[120:123], v6, s[84:87], s51 offen offset:2048 sc1
buffer_load_dwordx4 v[124:127], v6, s[84:87], s51 offen offset:3072 sc1
s_add_u32 s51, s56, 8192
s_and_b32 s51, s51, 0x7fff
s_add_u32 s51, s51, s50
buffer_load_dwordx4 v[128:131], v6, s[84:87], s51 offen offset:0 sc1
buffer_load_dwordx4 v[132:135], v6, s[84:87], s51 offen offset:1024 sc1
buffer_load_dwordx4 v[136:139], v6, s[84:87], s51 offen offset:2048 sc1
buffer_load_dwordx4 v[140:143], v6, s[84:87], s51 offen offset:3072 sc1
s_add_u32 s51, s56, 12288
s_and_b32 s51, s51, 0x7fff
s_add_u32 s51, s51, s50
buffer_load_dwordx4 v[144:147], v6, s[84:87], s51 offen offset:0 sc1
buffer_load_dwordx4 v[148:151], v6, s[84:87], s51 offen offset:1024 sc1
buffer_load_dwordx4 v[152:155], v6, s[84:87], s51 offen offset:2048 sc1
buffer_load_dwordx4 v[156:159], v6, s[84:87], s51 offen offset:3072 sc1
s_add_u32 s51, s56, 16384
s_and_b32 s51, s51, 0x7fff
s_add_u32 s51, s51, s50
buffer_load_dwordx4 v[160:163], v6, s[84:87], s51 offen offset:0 sc1
buffer_load_dwordx4 v[164:167], v6, s[84:87], s51 offen offset:1024 sc1
buffer_load_dwordx4 v[168:171], v6, s[84:87], s51 offen offset:2048 sc1
buffer_load_dwordx4 v[172:175], v6, s[84:87], s51 offen offset:3072 sc1
s_add_u32 s51, s56, 20480
s_and_b32 s51, s51, 0x7fff
s_add_u32 s51, s51, s50
buffer_load_dwordx4 v[176:179], v6, s[84:87], s51 offen offset:0 sc1
buffer_load_dwordx4 v[180:183], v6, s[84:87], s51 offen offset:1024 sc1
buffer_load_dwordx4 v[184:187], v6, s[84:87], s51 offen offset:2048 sc1
buffer_load_dwordx4 v[188:191], v6, s[84:87], s51 offen offset:3072 sc1
s_add_u32 s51, s56, 24576
s_and_b32 s51, s51, 0x7fff
s_add_u32 s51, s51, s50
buffer_load_dwordx4 v[192:195], v6, s[84:87], s51 offen offset:0 sc1
buffer_load_dwordx4 v[196:199], v6, s[84:87], s51 offen offset:1024 sc1
buffer_load_dwordx4 v[200:203], v6, s[84:87], s51 offen offset:2048 sc1
buffer_load_dwordx4 v[204:207], v6, s[84:87], s51 offen offset:3072 sc1
s_add_u32 s51, s56, 28672
s_and_b32 s51, s51, 0x7fff
s_add_u32 s51, s51, s50
buffer_load_dwordx4 v[208:211], v6, s[84:87], s51 offen offset:0 sc1
buffer_load_dwordx4 v[212:215], v6, s[84:87], s51 offen offset:1024 sc1
buffer_load_dwordx4 v[216:219], v6, s[84:87], s51 offen offset:2048 sc1
buffer_load_dwordx4 v[220:223], v6, s[84:87], s51 offen offset:3072 sc1
mega_kernel_o_w0:
s_add_u32 s54, s42, 1
s_sub_u32 s62, s42, 1
s_lshl_b32 s50, s54, 18
s_cmp_gt_i32 s52, s54
s_cbranch_scc0 mega_kernel_o_n0
s_waitcnt vmcnt(31)
v_mfma_f32_32x32x16_bf16 v[20:35], a[0:3], v[96:99], 0
v_mfma_f32_32x32x16_bf16 v[36:51], a[4:7], v[96:99], 0
s_add_u32 s51, s56, 0
s_and_b32 s51, s51, 0x7fff
s_add_u32 s51, s51, s50
buffer_load_dwordx4 v[96:99], v6, s[84:87], s51 offen offset:0 sc1
s_waitcnt vmcnt(31)
v_mfma_f32_32x32x16_bf16 v[20:35], a[8:11], v[100:103], v[20:35]
v_mfma_f32_32x32x16_bf16 v[36:51], a[12:15], v[100:103], v[36:51]
buffer_load_dwordx4 v[100:103], v6, s[84:87], s51 offen offset:1024 sc1
s_waitcnt vmcnt(31)
v_mfma_f32_32x32x16_bf16 v[20:35], a[16:19], v[104:107], v[20:35]
v_mfma_f32_32x32x16_bf16 v[36:51], a[20:23], v[104:107], v[36:51]
buffer_load_dwordx4 v[104:107], v6, s[84:87], s51 offen offset:2048 sc1
s_waitcnt vmcnt(31)
v_mfma_f32_32x32x16_bf16 v[20:35], a[24:27], v[108:111], v[20:35]
v_mfma_f32_32x32x16_bf16 v[36:51], a[28:31], v[108:111], v[36:51]
buffer_load_dwordx4 v[108:111], v6, s[84:87], s51 offen offset:3072 sc1
s_waitcnt vmcnt(31)
v_mfma_f32_32x32x16_bf16 v[20:35], a[32:35], v[112:115], v[20:35]
v_mfma_f32_32x32x16_bf16 v[36:51], a[36:39], v[112:115], v[36:51]
s_add_u32 s51, s56, 4096
s_and_b32 s51, s51, 0x7fff
s_add_u32 s51, s51, s50
buffer_load_dwordx4 v[112:115], v6, s[84:87], s51 offen offset:0 sc1
s_waitcnt vmcnt(31)
v_mfma_f32_32x32x16_bf16 v[20:35], a[40:43], v[116:119], v[20:35]
v_mfma_f32_32x32x16_bf16 v[36:51], a[44:47], v[116:119], v[36:51]
buffer_load_dwordx4 v[116:119], v6, s[84:87], s51 offen offset:1024 sc1
s_waitcnt vmcnt(31)
v_mfma_f32_32x32x16_bf16 v[20:35], a[48:51], v[120:123], v[20:35]
v_mfma_f32_32x32x16_bf16 v[36:51], a[52:55], v[120:123], v[36:51]
buffer_load_dwordx4 v[120:123], v6, s[84:87], s51 offen offset:2048 sc1
s_waitcnt vmcnt(31)
v_mfma_f32_32x32x16_bf16 v[20:35], a[56:59], v[124:127], v[20:35]
v_mfma_f32_32x32x16_bf16 v[36:51], a[60:63], v[124:127], v[36:51]
buffer_load_dwordx4 v[124:127], v6, s[84:87], s51 offen offset:3072 sc1
s_waitcnt vmcnt(31)
v_mfma_f32_32x32x16_bf16 v[20:35], a[64:67], v[128:131], v[20:35]
v_mfma_f32_32x32x16_bf16 v[36:51], a[68:71], v[128:131], v[36:51]
s_add_u32 s51, s56, 8192
s_and_b32 s51, s51, 0x7fff
s_add_u32 s51, s51, s50
buffer_load_dwordx4 v[128:131], v6, s[84:87], s51 offen offset:0 sc1
s_waitcnt vmcnt(31)
v_mfma_f32_32x32x16_bf16 v[20:35], a[72:75], v[132:135], v[20:35]
v_mfma_f32_32x32x16_bf16 v[36:51], a[76:79], v[132:135], v[36:51]
buffer_load_dwordx4 v[132:135], v6, s[84:87], s51 offen offset:1024 sc1
s_waitcnt vmcnt(31)
v_mfma_f32_32x32x16_bf16 v[20:35], a[80:83], v[136:139], v[20:35]
v_mfma_f32_32x32x16_bf16 v[36:51], a[84:87], v[136:139], v[36:51]
buffer_load_dwordx4 v[136:139], v6, s[84:87], s51 offen offset:2048 sc1
s_waitcnt vmcnt(31)
v_mfma_f32_32x32x16_bf16 v[20:35], a[88:91], v[140:143], v[20:35]
v_mfma_f32_32x32x16_bf16 v[36:51], a[92:95], v[140:143], v[36:51]
buffer_load_dwordx4 v[140:143], v6, s[84:87], s51 offen offset:3072 sc1
s_waitcnt vmcnt(31)
v_mfma_f32_32x32x16_bf16 v[20:35], a[96:99], v[144:147], v[20:35]
v_mfma_f32_32x32x16_bf16 v[36:51], a[100:103], v[144:147], v[36:51]
s_add_u32 s51, s56, 12288
s_and_b32 s51, s51, 0x7fff
s_add_u32 s51, s51, s50
buffer_load_dwordx4 v[144:147], v6, s[84:87], s51 offen offset:0 sc1
s_waitcnt vmcnt(31)
v_mfma_f32_32x32x16_bf16 v[20:35], a[104:107], v[148:151], v[20:35]
v_mfma_f32_32x32x16_bf16 v[36:51], a[108:111], v[148:151], v[36:51]
buffer_load_dwordx4 v[148:151], v6, s[84:87], s51 offen offset:1024 sc1
s_waitcnt vmcnt(31)
v_mfma_f32_32x32x16_bf16 v[20:35], a[112:115], v[152:155], v[20:35]
v_mfma_f32_32x32x16_bf16 v[36:51], a[116:119], v[152:155], v[36:51]
buffer_load_dwordx4 v[152:155], v6, s[84:87], s51 offen offset:2048 sc1
s_waitcnt vmcnt(31)
v_mfma_f32_32x32x16_bf16 v[20:35], a[120:123], v[156:159], v[20:35]
v_mfma_f32_32x32x16_bf16 v[36:51], a[124:127], v[156:159], v[36:51]
buffer_load_dwordx4 v[156:159], v6, s[84:87], s51 offen offset:3072 sc1
s_waitcnt vmcnt(31)
v_mfma_f32_32x32x16_bf16 v[20:35], a[128:131], v[160:163], v[20:35]
v_mfma_f32_32x32x16_bf16 v[36:51], a[132:135], v[160:163], v[36:51]
s_add_u32 s51, s56, 16384
s_and_b32 s51, s51, 0x7fff
s_add_u32 s51, s51, s50
buffer_load_dwordx4 v[160:163], v6, s[84:87], s51 offen offset:0 sc1
s_waitcnt vmcnt(31)
v_mfma_f32_32x32x16_bf16 v[20:35], a[136:139], v[164:167], v[20:35]
v_mfma_f32_32x32x16_bf16 v[36:51], a[140:143], v[164:167], v[36:51]
buffer_load_dwordx4 v[164:167], v6, s[84:87], s51 offen offset:1024 sc1
s_waitcnt vmcnt(31)
v_mfma_f32_32x32x16_bf16 v[20:35], a[144:147], v[168:171], v[20:35]
v_mfma_f32_32x32x16_bf16 v[36:51], a[148:151], v[168:171], v[36:51]
buffer_load_dwordx4 v[168:171], v6, s[84:87], s51 offen offset:2048 sc1
s_waitcnt vmcnt(31)
v_mfma_f32_32x32x16_bf16 v[20:35], a[152:155], v[172:175], v[20:35]
v_mfma_f32_32x32x16_bf16 v[36:51], a[156:159], v[172:175], v[36:51]
buffer_load_dwordx4 v[172:175], v6, s[84:87], s51 offen offset:3072 sc1
s_waitcnt vmcnt(31)
v_mfma_f32_32x32x16_bf16 v[20:35], a[160:163], v[176:179], v[20:35]
v_mfma_f32_32x32x16_bf16 v[36:51], a[164:167], v[176:179], v[36:51]
s_add_u32 s51, s56, 20480
s_and_b32 s51, s51, 0x7fff
s_add_u32 s51, s51, s50
buffer_load_dwordx4 v[176:179], v6, s[84:87], s51 offen offset:0 sc1
s_waitcnt vmcnt(31)
v_mfma_f32_32x32x16_bf16 v[20:35], a[168:171], v[180:183], v[20:35]
v_mfma_f32_32x32x16_bf16 v[36:51], a[172:175], v[180:183], v[36:51]
buffer_load_dwordx4 v[180:183], v6, s[84:87], s51 offen offset:1024 sc1
s_waitcnt vmcnt(31)
v_mfma_f32_32x32x16_bf16 v[20:35], a[176:179], v[184:187], v[20:35]
v_mfma_f32_32x32x16_bf16 v[36:51], a[180:183], v[184:187], v[36:51]
buffer_load_dwordx4 v[184:187], v6, s[84:87], s51 offen offset:2048 sc1
s_waitcnt vmcnt(31)
v_mfma_f32_32x32x16_bf16 v[20:35], a[184:187], v[188:191], v[20:35]
v_mfma_f32_32x32x16_bf16 v[36:51], a[188:191], v[188:191], v[36:51]
buffer_load_dwordx4 v[188:191], v6, s[84:87], s51 offen offset:3072 sc1
s_waitcnt vmcnt(31)
v_mfma_f32_32x32x16_bf16 v[20:35], a[192:195], v[192:195], v[20:35]
v_mfma_f32_32x32x16_bf16 v[36:51], a[196:199], v[192:195], v[36:51]
s_add_u32 s51, s56, 24576
s_and_b32 s51, s51, 0x7fff
s_add_u32 s51, s51, s50
buffer_load_dwordx4 v[192:195], v6, s[84:87], s51 offen offset:0 sc1
s_waitcnt vmcnt(31)
v_mfma_f32_32x32x16_bf16 v[20:35], a[200:203], v[196:199], v[20:35]
v_mfma_f32_32x32x16_bf16 v[36:51], a[204:207], v[196:199], v[36:51]
buffer_load_dwordx4 v[196:199], v6, s[84:87], s51 offen offset:1024 sc1
s_waitcnt vmcnt(31)
v_mfma_f32_32x32x16_bf16 v[20:35], a[208:211], v[200:203], v[20:35]
v_mfma_f32_32x32x16_bf16 v[36:51], a[212:215], v[200:203], v[36:51]
buffer_load_dwordx4 v[200:203], v6, s[84:87], s51 offen offset:2048 sc1
s_waitcnt vmcnt(31)
v_mfma_f32_32x32x16_bf16 v[20:35], a[216:219], v[204:207], v[20:35]
v_mfma_f32_32x32x16_bf16 v[36:51], a[220:223], v[204:207], v[36:51]
buffer_load_dwordx4 v[204:207], v6, s[84:87], s51 offen offset:3072 sc1
s_waitcnt vmcnt(31)
v_mfma_f32_32x32x16_bf16 v[20:35], a[224:227], v[208:211], v[20:35]
v_mfma_f32_32x32x16_bf16 v[36:51], a[228:231], v[208:211], v[36:51]
s_add_u32 s51, s56, 28672
s_and_b32 s51, s51, 0x7fff
s_add_u32 s51, s51, s50
buffer_load_dwordx4 v[208:211], v6, s[84:87], s51 offen offset:0 sc1
s_waitcnt vmcnt(31)
v_mfma_f32_32x32x16_bf16 v[20:35], a[232:235], v[212:215], v[20:35]
v_mfma_f32_32x32x16_bf16 v[36:51], a[236:239], v[212:215], v[36:51]
buffer_load_dwordx4 v[212:215], v6, s[84:87], s51 offen offset:1024 sc1
s_waitcnt vmcnt(31)
v_mfma_f32_32x32x16_bf16 v[20:35], a[240:243], v[216:219], v[20:35]
v_mfma_f32_32x32x16_bf16 v[36:51], a[244:247], v[216:219], v[36:51]
buffer_load_dwordx4 v[216:219], v6, s[84:87], s51 offen offset:2048 sc1
s_waitcnt vmcnt(31)
v_mfma_f32_32x32x16_bf16 v[224:239], a[248:251], v[220:223], v[20:35]
v_mfma_f32_32x32x16_bf16 v[240:255], a[252:255], v[220:223], v[36:51]
buffer_load_dwordx4 v[220:223], v6, s[84:87], s51 offen offset:3072 sc1
s_add_u32 s42, s42, 1
s_branch mega_kernel_o_w1
mega_kernel_o_n0:
s_waitcnt vmcnt(31)
v_mfma_f32_32x32x16_bf16 v[20:35], a[0:3], v[96:99], 0
v_mfma_f32_32x32x16_bf16 v[36:51], a[4:7], v[96:99], 0
s_waitcnt vmcnt(30)
v_mfma_f32_32x32x16_bf16 v[20:35], a[8:11], v[100:103], v[20:35]
v_mfma_f32_32x32x16_bf16 v[36:51], a[12:15], v[100:103], v[36:51]
s_waitcnt vmcnt(29)
v_mfma_f32_32x32x16_bf16 v[20:35], a[16:19], v[104:107], v[20:35]
v_mfma_f32_32x32x16_bf16 v[36:51], a[20:23], v[104:107], v[36:51]
s_waitcnt vmcnt(28)
v_mfma_f32_32x32x16_bf16 v[20:35], a[24:27], v[108:111], v[20:35]
v_mfma_f32_32x32x16_bf16 v[36:51], a[28:31], v[108:111], v[36:51]
s_waitcnt vmcnt(27)
v_mfma_f32_32x32x16_bf16 v[20:35], a[32:35], v[112:115], v[20:35]
v_mfma_f32_32x32x16_bf16 v[36:51], a[36:39], v[112:115], v[36:51]
s_waitcnt vmcnt(26)
v_mfma_f32_32x32x16_bf16 v[20:35], a[40:43], v[116:119], v[20:35]
v_mfma_f32_32x32x16_bf16 v[36:51], a[44:47], v[116:119], v[36:51]
s_waitcnt vmcnt(25)
v_mfma_f32_32x32x16_bf16 v[20:35], a[48:51], v[120:123], v[20:35]
v_mfma_f32_32x32x16_bf16 v[36:51], a[52:55], v[120:123], v[36:51]
s_waitcnt vmcnt(24)
v_mfma_f32_32x32x16_bf16 v[20:35], a[56:59], v[124:127], v[20:35]
v_mfma_f32_32x32x16_bf16 v[36:51], a[60:63], v[124:127], v[36:51]
s_waitcnt vmcnt(23)
v_mfma_f32_32x32x16_bf16 v[20:35], a[64:67], v[128:131], v[20:35]
v_mfma_f32_32x32x16_bf16 v[36:51], a[68:71], v[128:131], v[36:51]
s_waitcnt vmcnt(22)
v_mfma_f32_32x32x16_bf16 v[20:35], a[72:75], v[132:135], v[20:35]
v_mfma_f32_32x32x16_bf16 v[36:51], a[76:79], v[132:135], v[36:51]
s_waitcnt vmcnt(21)
v_mfma_f32_32x32x16_bf16 v[20:35], a[80:83], v[136:139], v[20:35]
v_mfma_f32_32x32x16_bf16 v[36:51], a[84:87], v[136:139], v[36:51]
s_waitcnt vmcnt(20)
v_mfma_f32_32x32x16_bf16 v[20:35], a[88:91], v[140:143], v[20:35]
v_mfma_f32_32x32x16_bf16 v[36:51], a[92:95], v[140:143], v[36:51]
s_waitcnt vmcnt(19)
v_mfma_f32_32x32x16_bf16 v[20:35], a[96:99], v[144:147], v[20:35]
v_mfma_f32_32x32x16_bf16 v[36:51], a[100:103], v[144:147], v[36:51]
s_waitcnt vmcnt(18)
v_mfma_f32_32x32x16_bf16 v[20:35], a[104:107], v[148:151], v[20:35]
v_mfma_f32_32x32x16_bf16 v[36:51], a[108:111], v[148:151], v[36:51]
s_waitcnt vmcnt(17)
v_mfma_f32_32x32x16_bf16 v[20:35], a[112:115], v[152:155], v[20:35]
v_mfma_f32_32x32x16_bf16 v[36:51], a[116:119], v[152:155], v[36:51]
s_waitcnt vmcnt(16)
v_mfma_f32_32x32x16_bf16 v[20:35], a[120:123], v[156:159], v[20:35]
v_mfma_f32_32x32x16_bf16 v[36:51], a[124:127], v[156:159], v[36:51]
s_waitcnt vmcnt(15)
v_mfma_f32_32x32x16_bf16 v[20:35], a[128:131], v[160:163], v[20:35]
v_mfma_f32_32x32x16_bf16 v[36:51], a[132:135], v[160:163], v[36:51]
s_waitcnt vmcnt(14)
v_mfma_f32_32x32x16_bf16 v[20:35], a[136:139], v[164:167], v[20:35]
v_mfma_f32_32x32x16_bf16 v[36:51], a[140:143], v[164:167], v[36:51]
s_waitcnt vmcnt(13)
v_mfma_f32_32x32x16_bf16 v[20:35], a[144:147], v[168:171], v[20:35]
v_mfma_f32_32x32x16_bf16 v[36:51], a[148:151], v[168:171], v[36:51]
s_waitcnt vmcnt(12)
v_mfma_f32_32x32x16_bf16 v[20:35], a[152:155], v[172:175], v[20:35]
v_mfma_f32_32x32x16_bf16 v[36:51], a[156:159], v[172:175], v[36:51]
s_waitcnt vmcnt(11)
v_mfma_f32_32x32x16_bf16 v[20:35], a[160:163], v[176:179], v[20:35]
v_mfma_f32_32x32x16_bf16 v[36:51], a[164:167], v[176:179], v[36:51]
buffer_load_dword v15, v7, s[84:87], 0 offen sc1
s_waitcnt vmcnt(10)
v_mfma_f32_32x32x16_bf16 v[20:35], a[168:171], v[180:183], v[20:35]
v_mfma_f32_32x32x16_bf16 v[36:51], a[172:175], v[180:183], v[36:51]
s_waitcnt vmcnt(9)
v_mfma_f32_32x32x16_bf16 v[20:35], a[176:179], v[184:187], v[20:35]
v_mfma_f32_32x32x16_bf16 v[36:51], a[180:183], v[184:187], v[36:51]
s_waitcnt vmcnt(8)
v_mfma_f32_32x32x16_bf16 v[20:35], a[184:187], v[188:191], v[20:35]
v_mfma_f32_32x32x16_bf16 v[36:51], a[188:191], v[188:191], v[36:51]
s_waitcnt vmcnt(7)
v_mfma_f32_32x32x16_bf16 v[20:35], a[192:195], v[192:195], v[20:35]
v_mfma_f32_32x32x16_bf16 v[36:51], a[196:199], v[192:195], v[36:51]
s_waitcnt vmcnt(6)
v_mfma_f32_32x32x16_bf16 v[20:35], a[200:203], v[196:199], v[20:35]
v_mfma_f32_32x32x16_bf16 v[36:51], a[204:207], v[196:199], v[36:51]
s_waitcnt vmcnt(5)
v_mfma_f32_32x32x16_bf16 v[20:35], a[208:211], v[200:203], v[20:35]
v_mfma_f32_32x32x16_bf16 v[36:51], a[212:215], v[200:203], v[36:51]
s_waitcnt vmcnt(4)
v_mfma_f32_32x32x16_bf16 v[20:35], a[216:219], v[204:207], v[20:35]
v_mfma_f32_32x32x16_bf16 v[36:51], a[220:223], v[204:207], v[36:51]
s_waitcnt vmcnt(3)
v_mfma_f32_32x32x16_bf16 v[20:35], a[224:227], v[208:211], v[20:35]
v_mfma_f32_32x32x16_bf16 v[36:51], a[228:231], v[208:211], v[36:51]
s_waitcnt vmcnt(2)
v_mfma_f32_32x32x16_bf16 v[20:35], a[232:235], v[212:215], v[20:35]
v_mfma_f32_32x32x16_bf16 v[36:51], a[236:239], v[212:215], v[36:51]
s_waitcnt vmcnt(1)
v_mfma_f32_32x32x16_bf16 v[20:35], a[240:243], v[216:219], v[20:35]
v_mfma_f32_32x32x16_bf16 v[36:51], a[244:247], v[216:219], v[36:51]
s_waitcnt vmcnt(0)
v_mfma_f32_32x32x16_bf16 v[224:239], a[248:251], v[220:223], v[20:35]
v_mfma_f32_32x32x16_bf16 v[240:255], a[252:255], v[220:223], v[36:51]
s_branch mega_kernel_o_imm
mega_kernel_o_w1:
s_add_u32 s54, s42, 1
s_sub_u32 s62, s42, 1
s_lshl_b32 s50, s54, 18
s_cmp_gt_i32 s52, s54
s_cbranch_scc0 mega_kernel_o_n1
s_waitcnt vmcnt(31)
v_mfma_f32_32x32x16_bf16 v[20:35], a[0:3], v[96:99], 0
v_mfma_f32_32x32x16_bf16 v[36:51], a[4:7], v[96:99], 0
s_add_u32 s51, s56, 0
s_and_b32 s51, s51, 0x7fff
s_add_u32 s51, s51, s50
buffer_load_dwordx4 v[96:99], v6, s[84:87], s51 offen offset:0 sc1
s_waitcnt vmcnt(31)
v_mfma_f32_32x32x16_bf16 v[20:35], a[8:11], v[100:103], v[20:35]
v_mfma_f32_32x32x16_bf16 v[36:51], a[12:15], v[100:103], v[36:51]
buffer_load_dwordx4 v[100:103], v6, s[84:87], s51 offen offset:1024 sc1
v_add_u32 v2, s53, v8
v_add_u32 v3, s53, v9
v_add_u32 v4, s53, v10
s_waitcnt vmcnt(31)
v_mfma_f32_32x32x16_bf16 v[20:35], a[16:19], v[104:107], v[20:35]
v_mfma_f32_32x32x16_bf16 v[36:51], a[20:23], v[104:107], v[36:51]
buffer_load_dwordx4 v[104:107], v6, s[84:87], s51 offen offset:2048 sc1
ds_write_b128 v2, v[224:227] offset:0
ds_write_b128 v2, v[228:231] offset:1088
s_waitcnt vmcnt(31)
v_mfma_f32_32x32x16_bf16 v[20:35], a[24:27], v[108:111], v[20:35]
v_mfma_f32_32x32x16_bf16 v[36:51], a[28:31], v[108:111], v[36:51]
buffer_load_dwordx4 v[108:111], v6, s[84:87], s51 offen offset:3072 sc1
ds_write_b128 v2, v[232:235] offset:2176
ds_write_b128 v2, v[236:239] offset:3264
s_waitcnt vmcnt(31)
v_mfma_f32_32x32x16_bf16 v[20:35], a[32:35], v[112:115], v[20:35]
v_mfma_f32_32x32x16_bf16 v[36:51], a[36:39], v[112:115], v[36:51]
s_add_u32 s51, s56, 4096
s_and_b32 s51, s51, 0x7fff
s_add_u32 s51, s51, s50
buffer_load_dwordx4 v[112:115], v6, s[84:87], s51 offen offset:0 sc1
ds_write_b128 v2, v[240:243] offset:4352
ds_write_b128 v2, v[244:247] offset:5440
s_waitcnt vmcnt(31)
v_mfma_f32_32x32x16_bf16 v[20:35], a[40:43], v[116:119], v[20:35]
v_mfma_f32_32x32x16_bf16 v[36:51], a[44:47], v[116:119], v[36:51]
buffer_load_dwordx4 v[116:119], v6, s[84:87], s51 offen offset:1024 sc1
ds_write_b128 v2, v[248:251] offset:6528
ds_write_b128 v2, v[252:255] offset:7616
s_waitcnt vmcnt(31)
v_mfma_f32_32x32x16_bf16 v[20:35], a[48:51], v[120:123], v[20:35]
v_mfma_f32_32x32x16_bf16 v[36:51], a[52:55], v[120:123], v[36:51]
buffer_load_dwordx4 v[120:123], v6, s[84:87], s51 offen offset:2048 sc1
s_waitcnt vmcnt(31)
v_mfma_f32_32x32x16_bf16 v[20:35], a[56:59], v[124:127], v[20:35]
v_mfma_f32_32x32x16_bf16 v[36:51], a[60:63], v[124:127], v[36:51]
buffer_load_dwordx4 v[124:127], v6, s[84:87], s51 offen offset:3072 sc1
s_waitcnt lgkmcnt(0)
s_barrier
ds_read_b128 v[52:55], v4 offset:0
ds_read_b128 v[56:59], v4 offset:8704
ds_read_b128 v[60:63], v4 offset:17408
ds_read_b128 v[64:67], v4 offset:26112
s_waitcnt vmcnt(31)
v_mfma_f32_32x32x16_bf16 v[20:35], a[64:67], v[128:131], v[20:35]
v_mfma_f32_32x32x16_bf16 v[36:51], a[68:71], v[128:131], v[36:51]
s_add_u32 s51, s56, 8192
s_and_b32 s51, s51, 0x7fff
s_add_u32 s51, s51, s50
buffer_load_dwordx4 v[128:131], v6, s[84:87], s51 offen offset:0 sc1
ds_read_b128 v[68:71], v3 offset:0
ds_read_b128 v[72:75], v3 offset:8704
ds_read_b128 v[76:79], v3 offset:17408
ds_read_b128 v[80:83], v3 offset:26112
s_sub_u32 s53, 34816, s53
s_bfe_u32 s61, s62, 0x10001
s_xor_b32 s61, s61, s67
s_and_b32 s60, s62, 1
s_lshl_b32 s60, s60, 12
s_waitcnt vmcnt(31)
v_mfma_f32_32x32x16_bf16 v[20:35], a[72:75], v[132:135], v[20:35]
v_mfma_f32_32x32x16_bf16 v[36:51], a[76:79], v[132:135], v[36:51]
buffer_load_dwordx4 v[132:135], v6, s[84:87], s51 offen offset:1024 sc1
s_waitcnt vmcnt(31)
v_mfma_f32_32x32x16_bf16 v[20:35], a[80:83], v[136:139], v[20:35]
v_mfma_f32_32x32x16_bf16 v[36:51], a[84:87], v[136:139], v[36:51]
buffer_load_dwordx4 v[136:139], v6, s[84:87], s51 offen offset:2048 sc1
s_waitcnt lgkmcnt(4)
v_add_f32 v52, v52, v56
v_add_f32 v60, v60, v64
v_add_f32 v53, v53, v57
v_add_f32 v61, v61, v65
v_add_f32 v54, v54, v58
v_add_f32 v62, v62, v66
v_add_f32 v55, v55, v59
v_add_f32 v63, v63, v67
s_waitcnt vmcnt(31)
v_mfma_f32_32x32x16_bf16 v[20:35], a[88:91], v[140:143], v[20:35]
v_mfma_f32_32x32x16_bf16 v[36:51], a[92:95], v[140:143], v[36:51]
buffer_load_dwordx4 v[140:143], v6, s[84:87], s51 offen offset:3072 sc1
v_add_f32 v52, v52, v60
v_add_f32 v53, v53, v61
v_add_f32 v54, v54, v62
v_add_f32 v55, v55, v63
v_and_or_b32 v52, v52, -2, s61
s_cmp_eq_u32 s95, 0
s_cbranch_scc1 mega_kernel_o_sa1
buffer_store_dwordx4 v[52:55], v12, s[84:87], s60 offen sc1
s_branch mega_kernel_o_sb1
mega_kernel_o_sa1:
buffer_store_dwordx4 v[52:55], v12, s[84:87], s60 offen
mega_kernel_o_sb1:
s_waitcnt vmcnt(31)
v_mfma_f32_32x32x16_bf16 v[20:35], a[96:99], v[144:147], v[20:35]
v_mfma_f32_32x32x16_bf16 v[36:51], a[100:103], v[144:147], v[36:51]
s_add_u32 s51, s56, 12288
s_and_b32 s51, s51, 0x7fff
s_add_u32 s51, s51, s50
buffer_load_dwordx4 v[144:147], v6, s[84:87], s51 offen offset:0 sc1
s_waitcnt lgkmcnt(0)
v_add_f32 v68, v68, v72
v_add_f32 v76, v76, v80
v_add_f32 v69, v69, v73
v_add_f32 v77, v77, v81
v_add_f32 v70, v70, v74
v_add_f32 v78, v78, v82
v_add_f32 v71, v71, v75
v_add_f32 v79, v79, v83
s_waitcnt vmcnt(31)
v_mfma_f32_32x32x16_bf16 v[20:35], a[104:107], v[148:151], v[20:35]
v_mfma_f32_32x32x16_bf16 v[36:51], a[108:111], v[148:151], v[36:51]
buffer_load_dwordx4 v[148:151], v6, s[84:87], s51 offen offset:1024 sc1
v_add_f32 v84, v68, v76
v_add_f32 v85, v69, v77
v_add_f32 v86, v70, v78
v_add_f32 v87, v71, v79
s_waitcnt vmcnt(31)
v_mfma_f32_32x32x16_bf16 v[20:35], a[112:115], v[152:155], v[20:35]
v_mfma_f32_32x32x16_bf16 v[36:51], a[116:119], v[152:155], v[36:51]
buffer_load_dwordx4 v[152:155], v6, s[84:87], s51 offen offset:2048 sc1
s_waitcnt vmcnt(31)
v_mfma_f32_32x32x16_bf16 v[20:35], a[120:123], v[156:159], v[20:35]
v_mfma_f32_32x32x16_bf16 v[36:51], a[124:127], v[156:159], v[36:51]
buffer_load_dwordx4 v[156:159], v6, s[84:87], s51 offen offset:3072 sc1
s_waitcnt vmcnt(31)
v_mfma_f32_32x32x16_bf16 v[20:35], a[128:131], v[160:163], v[20:35]
v_mfma_f32_32x32x16_bf16 v[36:51], a[132:135], v[160:163], v[36:51]
s_add_u32 s51, s56, 16384
s_and_b32 s51, s51, 0x7fff
s_add_u32 s51, s51, s50
buffer_load_dwordx4 v[160:163], v6, s[84:87], s51 offen offset:0 sc1
s_waitcnt vmcnt(31)
v_mfma_f32_32x32x16_bf16 v[20:35], a[136:139], v[164:167], v[20:35]
v_mfma_f32_32x32x16_bf16 v[36:51], a[140:143], v[164:167], v[36:51]
buffer_load_dwordx4 v[164:167], v6, s[84:87], s51 offen offset:1024 sc1
s_waitcnt vmcnt(31)
v_mfma_f32_32x32x16_bf16 v[20:35], a[144:147], v[168:171], v[20:35]
v_mfma_f32_32x32x16_bf16 v[36:51], a[148:151], v[168:171], v[36:51]
buffer_load_dwordx4 v[168:171], v6, s[84:87], s51 offen offset:2048 sc1
s_waitcnt vmcnt(31)
v_mfma_f32_32x32x16_bf16 v[20:35], a[152:155], v[172:175], v[20:35]
v_mfma_f32_32x32x16_bf16 v[36:51], a[156:159], v[172:175], v[36:51]
buffer_load_dwordx4 v[172:175], v6, s[84:87], s51 offen offset:3072 sc1
s_waitcnt vmcnt(31)
v_mfma_f32_32x32x16_bf16 v[20:35], a[160:163], v[176:179], v[20:35]
v_mfma_f32_32x32x16_bf16 v[36:51], a[164:167], v[176:179], v[36:51]
s_add_u32 s51, s56, 20480
s_and_b32 s51, s51, 0x7fff
s_add_u32 s51, s51, s50
buffer_load_dwordx4 v[176:179], v6, s[84:87], s51 offen offset:0 sc1
s_waitcnt vmcnt(31)
v_mfma_f32_32x32x16_bf16 v[20:35], a[168:171], v[180:183], v[20:35]
v_mfma_f32_32x32x16_bf16 v[36:51], a[172:175], v[180:183], v[36:51]
buffer_load_dwordx4 v[180:183], v6, s[84:87], s51 offen offset:1024 sc1
s_waitcnt vmcnt(31)
v_mfma_f32_32x32x16_bf16 v[20:35], a[176:179], v[184:187], v[20:35]
v_mfma_f32_32x32x16_bf16 v[36:51], a[180:183], v[184:187], v[36:51]
buffer_load_dwordx4 v[184:187], v6, s[84:87], s51 offen offset:2048 sc1
s_waitcnt vmcnt(31)
v_mfma_f32_32x32x16_bf16 v[20:35], a[184:187], v[188:191], v[20:35]
v_mfma_f32_32x32x16_bf16 v[36:51], a[188:191], v[188:191], v[36:51]
buffer_load_dwordx4 v[188:191], v6, s[84:87], s51 offen offset:3072 sc1
s_waitcnt vmcnt(31)
v_mfma_f32_32x32x16_bf16 v[20:35], a[192:195], v[192:195], v[20:35]
v_mfma_f32_32x32x16_bf16 v[36:51], a[196:199], v[192:195], v[36:51]
s_add_u32 s51, s56, 24576
s_and_b32 s51, s51, 0x7fff
s_add_u32 s51, s51, s50
buffer_load_dwordx4 v[192:195], v6, s[84:87], s51 offen offset:0 sc1
s_waitcnt vmcnt(31)
v_mfma_f32_32x32x16_bf16 v[20:35], a[200:203], v[196:199], v[20:35]
v_mfma_f32_32x32x16_bf16 v[36:51], a[204:207], v[196:199], v[36:51]
buffer_load_dwordx4 v[196:199], v6, s[84:87], s51 offen offset:1024 sc1
s_waitcnt vmcnt(31)
v_mfma_f32_32x32x16_bf16 v[20:35], a[208:211], v[200:203], v[20:35]
v_mfma_f32_32x32x16_bf16 v[36:51], a[212:215], v[200:203], v[36:51]
buffer_load_dwordx4 v[200:203], v6, s[84:87], s51 offen offset:2048 sc1
s_waitcnt vmcnt(31)
v_mfma_f32_32x32x16_bf16 v[20:35], a[216:219], v[204:207], v[20:35]
v_mfma_f32_32x32x16_bf16 v[36:51], a[220:223], v[204:207], v[36:51]
buffer_load_dwordx4 v[204:207], v6, s[84:87], s51 offen offset:3072 sc1
s_and_b32 s60, s62, 1
s_lshl_b32 s60, s60, 12
buffer_load_dwordx4 v[88:91], v13, s[84:87], s60 offen sc1
s_waitcnt vmcnt(31)
v_mfma_f32_32x32x16_bf16 v[20:35], a[224:227], v[208:211], v[20:35]
v_mfma_f32_32x32x16_bf16 v[36:51], a[228:231], v[208:211], v[36:51]
s_add_u32 s51, s56, 28672
s_and_b32 s51, s51, 0x7fff
s_add_u32 s51, s51, s50
buffer_load_dwordx4 v[208:211], v6, s[84:87], s51 offen offset:0 sc1
s_waitcnt vmcnt(31)
v_mfma_f32_32x32x16_bf16 v[20:35], a[232:235], v[212:215], v[20:35]
v_mfma_f32_32x32x16_bf16 v[36:51], a[236:239], v[212:215], v[36:51]
buffer_load_dwordx4 v[212:215], v6, s[84:87], s51 offen offset:1024 sc1
s_waitcnt vmcnt(31)
v_mfma_f32_32x32x16_bf16 v[20:35], a[240:243], v[216:219], v[20:35]
v_mfma_f32_32x32x16_bf16 v[36:51], a[244:247], v[216:219], v[36:51]
buffer_load_dwordx4 v[216:219], v6, s[84:87], s51 offen offset:2048 sc1
s_waitcnt vmcnt(31)
v_mfma_f32_32x32x16_bf16 v[224:239], a[248:251], v[220:223], v[20:35]
v_mfma_f32_32x32x16_bf16 v[240:255], a[252:255], v[220:223], v[36:51]
buffer_load_dwordx4 v[220:223], v6, s[84:87], s51 offen offset:3072 sc1
s_bfe_u32 s61, s62, 0x10001
s_xor_b32 s61, s61, s67
s_waitcnt vmcnt(4)
mega_kernel_o_f1c:
v_and_b32 v14, 1, v88
v_cmp_ne_u32 vcc, s61, v14
s_cbranch_vccz mega_kernel_o_f1k
s_and_b32 s60, s62, 1
s_lshl_b32 s60, s60, 12
buffer_load_dwordx4 v[88:91], v13, s[84:87], s60 offen sc1
s_waitcnt vmcnt(0)
s_branch mega_kernel_o_f1c
mega_kernel_o_f1k:
v_pk_add_f32 v[88:89], v[88:89], v[84:85]
v_pk_add_f32 v[90:91], v[90:91], v[86:87]
s_lshl_b32 s60, s62, 17
v_cvt_pk_bf16_f32 v92, v88, v89
v_cvt_pk_bf16_f32 v93, v90, v91
buffer_store_dwordx2 v[92:93], v11, s[8:11], s60 offen
s_add_u32 s42, s42, 1
s_branch mega_kernel_o_w1
mega_kernel_o_n1:
s_waitcnt vmcnt(31)
v_mfma_f32_32x32x16_bf16 v[20:35], a[0:3], v[96:99], 0
v_mfma_f32_32x32x16_bf16 v[36:51], a[4:7], v[96:99], 0
s_waitcnt vmcnt(30)
v_mfma_f32_32x32x16_bf16 v[20:35], a[8:11], v[100:103], v[20:35]
v_mfma_f32_32x32x16_bf16 v[36:51], a[12:15], v[100:103], v[36:51]
v_add_u32 v2, s53, v8
v_add_u32 v3, s53, v9
v_add_u32 v4, s53, v10
s_waitcnt vmcnt(29)
v_mfma_f32_32x32x16_bf16 v[20:35], a[16:19], v[104:107], v[20:35]
v_mfma_f32_32x32x16_bf16 v[36:51], a[20:23], v[104:107], v[36:51]
ds_write_b128 v2, v[224:227] offset:0
ds_write_b128 v2, v[228:231] offset:1088
s_waitcnt vmcnt(28)
v_mfma_f32_32x32x16_bf16 v[20:35], a[24:27], v[108:111], v[20:35]
v_mfma_f32_32x32x16_bf16 v[36:51], a[28:31], v[108:111], v[36:51]
ds_write_b128 v2, v[232:235] offset:2176
ds_write_b128 v2, v[236:239] offset:3264
s_waitcnt vmcnt(27)
v_mfma_f32_32x32x16_bf16 v[20:35], a[32:35], v[112:115], v[20:35]
v_mfma_f32_32x32x16_bf16 v[36:51], a[36:39], v[112:115], v[36:51]
ds_write_b128 v2, v[240:243] offset:4352
ds_write_b128 v2, v[244:247] offset:5440
s_waitcnt vmcnt(26)
v_mfma_f32_32x32x16_bf16 v[20:35], a[40:43], v[116:119], v[20:35]
v_mfma_f32_32x32x16_bf16 v[36:51], a[44:47], v[116:119], v[36:51]
ds_write_b128 v2, v[248:251] offset:6528
ds_write_b128 v2, v[252:255] offset:7616
s_waitcnt vmcnt(25)
v_mfma_f32_32x32x16_bf16 v[20:35], a[48:51], v[120:123], v[20:35]
v_mfma_f32_32x32x16_bf16 v[36:51], a[52:55], v[120:123], v[36:51]
s_waitcnt vmcnt(24)
v_mfma_f32_32x32x16_bf16 v[20:35], a[56:59], v[124:127], v[20:35]
v_mfma_f32_32x32x16_bf16 v[36:51], a[60:63], v[124:127], v[36:51]
s_waitcnt lgkmcnt(0)
s_barrier
ds_read_b128 v[52:55], v4 offset:0
ds_read_b128 v[56:59], v4 offset:8704
ds_read_b128 v[60:63], v4 offset:17408
ds_read_b128 v[64:67], v4 offset:26112
s_waitcnt vmcnt(23)
v_mfma_f32_32x32x16_bf16 v[20:35], a[64:67], v[128:131], v[20:35]
v_mfma_f32_32x32x16_bf16 v[36:51], a[68:71], v[128:131], v[36:51]
ds_read_b128 v[68:71], v3 offset:0
ds_read_b128 v[72:75], v3 offset:8704
ds_read_b128 v[76:79], v3 offset:17408
ds_read_b128 v[80:83], v3 offset:26112
s_sub_u32 s53, 34816, s53
s_bfe_u32 s61, s62, 0x10001
s_xor_b32 s61, s61, s67
s_and_b32 s60, s62, 1
s_lshl_b32 s60, s60, 12
s_waitcnt vmcnt(22)
v_mfma_f32_32x32x16_bf16 v[20:35], a[72:75], v[132:135], v[20:35]
v_mfma_f32_32x32x16_bf16 v[36:51], a[76:79], v[132:135], v[36:51]
s_waitcnt vmcnt(21)
v_mfma_f32_32x32x16_bf16 v[20:35], a[80:83], v[136:139], v[20:35]
v_mfma_f32_32x32x16_bf16 v[36:51], a[84:87], v[136:139], v[36:51]
s_waitcnt lgkmcnt(4)
v_add_f32 v52, v52, v56
v_add_f32 v60, v60, v64
v_add_f32 v53, v53, v57
v_add_f32 v61, v61, v65
v_add_f32 v54, v54, v58
v_add_f32 v62, v62, v66
v_add_f32 v55, v55, v59
v_add_f32 v63, v63, v67
s_waitcnt vmcnt(20)
v_mfma_f32_32x32x16_bf16 v[20:35], a[88:91], v[140:143], v[20:35]
v_mfma_f32_32x32x16_bf16 v[36:51], a[92:95], v[140:143], v[36:51]
v_add_f32 v52, v52, v60
v_add_f32 v53, v53, v61
v_add_f32 v54, v54, v62
v_add_f32 v55, v55, v63
v_and_or_b32 v52, v52, -2, s61
s_cmp_eq_u32 s95, 0
s_cbranch_scc1 mega_kernel_o_sa2
buffer_store_dwordx4 v[52:55], v12, s[84:87], s60 offen sc1
s_branch mega_kernel_o_sb2
mega_kernel_o_sa2:
buffer_store_dwordx4 v[52:55], v12, s[84:87], s60 offen
mega_kernel_o_sb2:
s_waitcnt vmcnt(19)
v_mfma_f32_32x32x16_bf16 v[20:35], a[96:99], v[144:147], v[20:35]
v_mfma_f32_32x32x16_bf16 v[36:51], a[100:103], v[144:147], v[36:51]
s_waitcnt lgkmcnt(0)
v_add_f32 v68, v68, v72
v_add_f32 v76, v76, v80
v_add_f32 v69, v69, v73
v_add_f32 v77, v77, v81
v_add_f32 v70, v70, v74
v_add_f32 v78, v78, v82
v_add_f32 v71, v71, v75
v_add_f32 v79, v79, v83
s_waitcnt vmcnt(18)
v_mfma_f32_32x32x16_bf16 v[20:35], a[104:107], v[148:151], v[20:35]
v_mfma_f32_32x32x16_bf16 v[36:51], a[108:111], v[148:151], v[36:51]
v_add_f32 v84, v68, v76
v_add_f32 v85, v69, v77
v_add_f32 v86, v70, v78
v_add_f32 v87, v71, v79
s_waitcnt vmcnt(17)
v_mfma_f32_32x32x16_bf16 v[20:35], a[112:115], v[152:155], v[20:35]
v_mfma_f32_32x32x16_bf16 v[36:51], a[116:119], v[152:155], v[36:51]
s_waitcnt vmcnt(16)
v_mfma_f32_32x32x16_bf16 v[20:35], a[120:123], v[156:159], v[20:35]
v_mfma_f32_32x32x16_bf16 v[36:51], a[124:127], v[156:159], v[36:51]
s_waitcnt vmcnt(15)
v_mfma_f32_32x32x16_bf16 v[20:35], a[128:131], v[160:163], v[20:35]
v_mfma_f32_32x32x16_bf16 v[36:51], a[132:135], v[160:163], v[36:51]
s_waitcnt vmcnt(14)
v_mfma_f32_32x32x16_bf16 v[20:35], a[136:139], v[164:167], v[20:35]
v_mfma_f32_32x32x16_bf16 v[36:51], a[140:143], v[164:167], v[36:51]
s_waitcnt vmcnt(13)
v_mfma_f32_32x32x16_bf16 v[20:35], a[144:147], v[168:171], v[20:35]
v_mfma_f32_32x32x16_bf16 v[36:51], a[148:151], v[168:171], v[36:51]
s_waitcnt vmcnt(12)
v_mfma_f32_32x32x16_bf16 v[20:35], a[152:155], v[172:175], v[20:35]
v_mfma_f32_32x32x16_bf16 v[36:51], a[156:159], v[172:175], v[36:51]
s_waitcnt vmcnt(11)
v_mfma_f32_32x32x16_bf16 v[20:35], a[160:163], v[176:179], v[20:35]
v_mfma_f32_32x32x16_bf16 v[36:51], a[164:167], v[176:179], v[36:51]
buffer_load_dword v15, v7, s[84:87], 0 offen sc1
s_waitcnt vmcnt(10)
v_mfma_f32_32x32x16_bf16 v[20:35], a[168:171], v[180:183], v[20:35]
v_mfma_f32_32x32x16_bf16 v[36:51], a[172:175], v[180:183], v[36:51]
s_waitcnt vmcnt(9)
v_mfma_f32_32x32x16_bf16 v[20:35], a[176:179], v[184:187], v[20:35]
v_mfma_f32_32x32x16_bf16 v[36:51], a[180:183], v[184:187], v[36:51]
s_waitcnt vmcnt(8)
v_mfma_f32_32x32x16_bf16 v[20:35], a[184:187], v[188:191], v[20:35]
v_mfma_f32_32x32x16_bf16 v[36:51], a[188:191], v[188:191], v[36:51]
s_waitcnt vmcnt(7)
v_mfma_f32_32x32x16_bf16 v[20:35], a[192:195], v[192:195], v[20:35]
v_mfma_f32_32x32x16_bf16 v[36:51], a[196:199], v[192:195], v[36:51]
s_waitcnt vmcnt(6)
v_mfma_f32_32x32x16_bf16 v[20:35], a[200:203], v[196:199], v[20:35]
v_mfma_f32_32x32x16_bf16 v[36:51], a[204:207], v[196:199], v[36:51]
s_waitcnt vmcnt(5)
v_mfma_f32_32x32x16_bf16 v[20:35], a[208:211], v[200:203], v[20:35]
v_mfma_f32_32x32x16_bf16 v[36:51], a[212:215], v[200:203], v[36:51]
s_waitcnt vmcnt(4)
v_mfma_f32_32x32x16_bf16 v[20:35], a[216:219], v[204:207], v[20:35]
v_mfma_f32_32x32x16_bf16 v[36:51], a[220:223], v[204:207], v[36:51]
s_and_b32 s60, s62, 1
s_lshl_b32 s60, s60, 12
buffer_load_dwordx4 v[88:91], v13, s[84:87], s60 offen sc1
s_waitcnt vmcnt(3)
v_mfma_f32_32x32x16_bf16 v[20:35], a[224:227], v[208:211], v[20:35]
v_mfma_f32_32x32x16_bf16 v[36:51], a[228:231], v[208:211], v[36:51]
s_waitcnt vmcnt(2)
v_mfma_f32_32x32x16_bf16 v[20:35], a[232:235], v[212:215], v[20:35]
v_mfma_f32_32x32x16_bf16 v[36:51], a[236:239], v[212:215], v[36:51]
s_waitcnt vmcnt(1)
v_mfma_f32_32x32x16_bf16 v[20:35], a[240:243], v[216:219], v[20:35]
v_mfma_f32_32x32x16_bf16 v[36:51], a[244:247], v[216:219], v[36:51]
s_waitcnt vmcnt(0)
v_mfma_f32_32x32x16_bf16 v[224:239], a[248:251], v[220:223], v[20:35]
v_mfma_f32_32x32x16_bf16 v[240:255], a[252:255], v[220:223], v[36:51]
s_bfe_u32 s61, s62, 0x10001
s_xor_b32 s61, s61, s67
s_waitcnt vmcnt(0)
mega_kernel_o_f0c:
v_and_b32 v14, 1, v88
v_cmp_ne_u32 vcc, s61, v14
s_cbranch_vccz mega_kernel_o_f0k
s_and_b32 s60, s62, 1
s_lshl_b32 s60, s60, 12
buffer_load_dwordx4 v[88:91], v13, s[84:87], s60 offen sc1
s_waitcnt vmcnt(0)
s_branch mega_kernel_o_f0c
mega_kernel_o_f0k:
v_pk_add_f32 v[88:89], v[88:89], v[84:85]
v_pk_add_f32 v[90:91], v[90:91], v[86:87]
s_lshl_b32 s60, s62, 17
v_cvt_pk_bf16_f32 v92, v88, v89
v_cvt_pk_bf16_f32 v93, v90, v91
buffer_store_dwordx2 v[92:93], v11, s[8:11], s60 offen
mega_kernel_o_imm:
s_waitcnt vmcnt(1)
v_min_i32_dpp v15, v15, v15 quad_perm:[1,0,3,2] row_mask:0xf bank_mask:0xf
s_nop 1
v_min_i32_dpp v15, v15, v15 quad_perm:[2,3,0,1] row_mask:0xf bank_mask:0xf
s_nop 1
v_min_i32_dpp v15, v15, v15 row_ror:4 row_mask:0xf bank_mask:0xf
s_nop 1
v_min_i32_dpp v15, v15, v15 row_ror:8 row_mask:0xf bank_mask:0xf
s_nop 0
v_readfirstlane_b32 s52, v15
s_min_i32 s52, s52, s65
s_cmp_gt_i32 s52, s54
s_cbranch_scc0 mega_kernel_o_im2
s_add_u32 s51, s56, 0
s_and_b32 s51, s51, 0x7fff
s_add_u32 s51, s51, s50
buffer_load_dwordx4 v[96:99], v6, s[84:87], s51 offen offset:0 sc1
buffer_load_dwordx4 v[100:103], v6, s[84:87], s51 offen offset:1024 sc1
buffer_load_dwordx4 v[104:107], v6, s[84:87], s51 offen offset:2048 sc1
buffer_load_dwordx4 v[108:111], v6, s[84:87], s51 offen offset:3072 sc1
s_add_u32 s51, s56, 4096
s_and_b32 s51, s51, 0x7fff
s_add_u32 s51, s51, s50
buffer_load_dwordx4 v[112:115], v6, s[84:87], s51 offen offset:0 sc1
buffer_load_dwordx4 v[116:119], v6, s[84:87], s51 offen offset:1024 sc1
buffer_load_dwordx4 v[120:123], v6, s[84:87], s51 offen offset:2048 sc1
buffer_load_dwordx4 v[124:127], v6, s[84:87], s51 offen offset:3072 sc1
s_add_u32 s51, s56, 8192
s_and_b32 s51, s51, 0x7fff
s_add_u32 s51, s51, s50
buffer_load_dwordx4 v[128:131], v6, s[84:87], s51 offen offset:0 sc1
buffer_load_dwordx4 v[132:135], v6, s[84:87], s51 offen offset:1024 sc1
buffer_load_dwordx4 v[136:139], v6, s[84:87], s51 offen offset:2048 sc1
buffer_load_dwordx4 v[140:143], v6, s[84:87], s51 offen offset:3072 sc1
s_add_u32 s51, s56, 12288
s_and_b32 s51, s51, 0x7fff
s_add_u32 s51, s51, s50
buffer_load_dwordx4 v[144:147], v6, s[84:87], s51 offen offset:0 sc1
buffer_load_dwordx4 v[148:151], v6, s[84:87], s51 offen offset:1024 sc1
buffer_load_dwordx4 v[152:155], v6, s[84:87], s51 offen offset:2048 sc1
buffer_load_dwordx4 v[156:159], v6, s[84:87], s51 offen offset:3072 sc1
s_add_u32 s51, s56, 16384
s_and_b32 s51, s51, 0x7fff
s_add_u32 s51, s51, s50
buffer_load_dwordx4 v[160:163], v6, s[84:87], s51 offen offset:0 sc1
buffer_load_dwordx4 v[164:167], v6, s[84:87], s51 offen offset:1024 sc1
buffer_load_dwordx4 v[168:171], v6, s[84:87], s51 offen offset:2048 sc1
buffer_load_dwordx4 v[172:175], v6, s[84:87], s51 offen offset:3072 sc1
s_add_u32 s51, s56, 20480
s_and_b32 s51, s51, 0x7fff
s_add_u32 s51, s51, s50
buffer_load_dwordx4 v[176:179], v6, s[84:87], s51 offen offset:0 sc1
buffer_load_dwordx4 v[180:183], v6, s[84:87], s51 offen offset:1024 sc1
buffer_load_dwordx4 v[184:187], v6, s[84:87], s51 offen offset:2048 sc1
buffer_load_dwordx4 v[188:191], v6, s[84:87], s51 offen offset:3072 sc1
s_add_u32 s51, s56, 24576
s_and_b32 s51, s51, 0x7fff
s_add_u32 s51, s51, s50
buffer_load_dwordx4 v[192:195], v6, s[84:87], s51 offen offset:0 sc1
buffer_load_dwordx4 v[196:199], v6, s[84:87], s51 offen offset:1024 sc1
buffer_load_dwordx4 v[200:203], v6, s[84:87], s51 offen offset:2048 sc1
buffer_load_dwordx4 v[204:207], v6, s[84:87], s51 offen offset:3072 sc1
s_add_u32 s51, s56, 28672
s_and_b32 s51, s51, 0x7fff
s_add_u32 s51, s51, s50
buffer_load_dwordx4 v[208:211], v6, s[84:87], s51 offen offset:0 sc1
buffer_load_dwordx4 v[212:215], v6, s[84:87], s51 offen offset:1024 sc1
buffer_load_dwordx4 v[216:219], v6, s[84:87], s51 offen offset:2048 sc1
buffer_load_dwordx4 v[220:223], v6, s[84:87], s51 offen offset:3072 sc1
s_add_u32 s42, s42, 1
s_branch mega_kernel_o_w1
mega_kernel_o_im2:
v_add_u32 v2, s53, v8
v_add_u32 v3, s53, v9
v_add_u32 v4, s53, v10
ds_write_b128 v2, v[224:227] offset:0
ds_write_b128 v2, v[228:231] offset:1088
ds_write_b128 v2, v[232:235] offset:2176
ds_write_b128 v2, v[236:239] offset:3264
ds_write_b128 v2, v[240:243] offset:4352
ds_write_b128 v2, v[244:247] offset:5440
ds_write_b128 v2, v[248:251] offset:6528
ds_write_b128 v2, v[252:255] offset:7616
s_waitcnt lgkmcnt(0)
s_barrier
ds_read_b128 v[52:55], v4 offset:0
ds_read_b128 v[56:59], v4 offset:8704
ds_read_b128 v[60:63], v4 offset:17408
ds_read_b128 v[64:67], v4 offset:26112
ds_read_b128 v[68:71], v3 offset:0
ds_read_b128 v[72:75], v3 offset:8704
ds_read_b128 v[76:79], v3 offset:17408
ds_read_b128 v[80:83], v3 offset:26112
s_sub_u32 s53, 34816, s53
s_bfe_u32 s61, s42, 0x10001
s_xor_b32 s61, s61, s67
s_and_b32 s60, s42, 1
s_lshl_b32 s60, s60, 12
s_waitcnt lgkmcnt(4)
v_add_f32 v52, v52, v56
v_add_f32 v60, v60, v64
v_add_f32 v53, v53, v57
v_add_f32 v61, v61, v65
v_add_f32 v54, v54, v58
v_add_f32 v62, v62, v66
v_add_f32 v55, v55, v59
v_add_f32 v63, v63, v67
v_add_f32 v52, v52, v60
v_add_f32 v53, v53, v61
v_add_f32 v54, v54, v62
v_add_f32 v55, v55, v63
v_and_or_b32 v52, v52, -2, s61
s_cmp_eq_u32 s95, 0
s_cbranch_scc1 mega_kernel_o_sa3
buffer_store_dwordx4 v[52:55], v12, s[84:87], s60 offen sc1
s_branch mega_kernel_o_sb3
mega_kernel_o_sa3:
buffer_store_dwordx4 v[52:55], v12, s[84:87], s60 offen
mega_kernel_o_sb3:
s_waitcnt lgkmcnt(0)
v_add_f32 v68, v68, v72
v_add_f32 v76, v76, v80
v_add_f32 v69, v69, v73
v_add_f32 v77, v77, v81
v_add_f32 v70, v70, v74
v_add_f32 v78, v78, v82
v_add_f32 v71, v71, v75
v_add_f32 v79, v79, v83
v_add_f32 v84, v68, v76
v_add_f32 v85, v69, v77
v_add_f32 v86, v70, v78
v_add_f32 v87, v71, v79
s_and_b32 s60, s42, 1
s_lshl_b32 s60, s60, 12
buffer_load_dwordx4 v[88:91], v13, s[84:87], s60 offen sc1
s_bfe_u32 s61, s42, 0x10001
s_xor_b32 s61, s61, s67
s_waitcnt vmcnt(0)
mega_kernel_o_f2c:
v_and_b32 v14, 1, v88
v_cmp_ne_u32 vcc, s61, v14
s_cbranch_vccz mega_kernel_o_f2k
s_and_b32 s60, s42, 1
s_lshl_b32 s60, s60, 12
buffer_load_dwordx4 v[88:91], v13, s[84:87], s60 offen sc1
s_waitcnt vmcnt(0)
s_branch mega_kernel_o_f2c
mega_kernel_o_f2k:
v_pk_add_f32 v[88:89], v[88:89], v[84:85]
v_pk_add_f32 v[90:91], v[90:91], v[86:87]
s_lshl_b32 s60, s42, 17
v_cvt_pk_bf16_f32 v92, v88, v89
v_cvt_pk_bf16_f32 v93, v90, v91
buffer_store_dwordx2 v[92:93], v11, s[8:11], s60 offen
s_add_u32 s42, s42, 1
s_cmp_lt_u32 s42, s65
s_cbranch_scc1 mega_kernel_o_cold
mega_kernel_o_quit:
s_endpgm
mega_kernel_exit:
s_endpgm
mega_kernel_recf:
s_load_dwordx2 s[20:21], s[0:1], 8
s_load_dwordx2 s[16:17], s[0:1], 40
s_load_dwordx2 s[4:5], s[0:1], 16
s_load_dwordx2 s[8:9], s[0:1], 24
s_load_dwordx2 s[12:13], s[0:1], 32
v_lshrrev_b32 v4, 6, v0
v_and_b32 v1, 63, v0
v_readfirstlane_b32 s24, v4
v_lshrrev_b32 v2, 4, v1
v_and_b32 v3, 15, v1
v_lshlrev_b32 v17, 4, v1
s_lshr_b32 s28, s31, 2
s_lshl_b32 s25, s30, 3
s_add_u32 s25, s25, s28
s_and_b32 s26, s31, 3
s_waitcnt lgkmcnt(0)
s_mov_b32 s22, 16384
s_mov_b32 s23, 0x00020000
s_mov_b32 s18, 8388608
s_mov_b32 s19, 0x00020000
s_mov_b32 s6, 8388608
s_mov_b32 s7, 0x00020000
s_mov_b32 s10, 8388608
s_mov_b32 s11, 0x00020000
s_mov_b32 s14, 8388608
s_mov_b32 s15, 0x00020000
s_lshl_b32 s28, s25, 8
s_lshr_b32 s29, s26, 0
s_lshl_b32 s29, s29, 6
s_add_u32 s28, s28, s29
s_lshl_b32 s29, s24, 21
s_add_u32 s28, s28, s29
v_lshrrev_b32 v4, 2, v1
v_and_b32 v5, 3, v1
v_lshlrev_b32 v40, 13, v4
v_lshl_add_u32 v40, v5, 4, v40
v_add_u32 v40, s28, v40
s_lshl_b32 s28, s30, 21
s_lshl_b32 s29, s24, 19
s_add_u32 s28, s28, s29
s_lshr_b32 s29, s31, 0
s_lshl_b32 s29, s29, 6
s_add_u32 s28, s28, s29
v_lshlrev_b32 v41, 11, v4
v_lshl_add_u32 v41, v5, 4, v41
v_add_u32 v41, s28, v41
s_lshl_b32 s47, s24, 15
s_add_u32 s47, s47, 32768
s_lshl_b32 s28, s31, 18
s_lshl_b32 s29, s24, 16
s_add_u32 s28, s28, s29
s_lshl_b32 s29, s30, 11
s_add_u32 s28, s28, s29
v_lshlrev_b32 v48, 13, v2
v_lshl_add_u32 v48, v3, 7, v48
v_add_u32 v48, s28, v48
s_lshl_b32 s28, s30, 21
s_lshl_b32 s29, s31, 16
s_add_u32 s28, s28, s29
s_lshl_b32 s29, s24, 14
s_add_u32 s28, s28, s29
v_lshlrev_b32 v49, 7, v1
v_add_u32 v49, s28, v49
s_and_b32 s76, s31, 1
s_mul_i32 s76, s76, 8
s_and_b32 s28, s31, 15
s_lshl_b32 s28, s28, 4
s_lshl_b32 s29, s24, 8
s_add_u32 s28, s28, s29
v_add_u32 v53, s28, v3
s_lshr_b32 s28, s31, 4
s_lshl_b32 s28, s28, 10
s_add_u32 s28, s28, 384
v_mov_b32 v54, s28
v_mov_b32 v55, 1920
v_cmp_gt_u32 vcc, 32, v1
s_nop 1
v_cndmask_b32 v54, v55, v54, vcc
s_lshl_b32 s29, s30, 11
v_lshl_add_u32 v51, v53, 13, v54
v_add_u32 v51, s29, v51
s_lshl_b32 s29, s30, 21
v_lshl_add_u32 v52, v53, 11, v54
v_add_u32 v52, s29, v52
buffer_load_dword v50, v51, s[4:7], 0 offen
s_xor_b32 s29, s76, 0
s_lshl_b32 s28, s29, 10
s_add_u32 s28, s28, s47
s_add_u32 m0, s28, 0
s_lshl_b32 s29, s29, 17
buffer_load_dwordx4 v40, s[4:7], s29 offen lds
s_xor_b32 s29, s76, 1
s_lshl_b32 s28, s29, 10
s_add_u32 s28, s28, s47
s_add_u32 m0, s28, 0
s_lshl_b32 s29, s29, 17
buffer_load_dwordx4 v40, s[4:7], s29 offen lds
s_xor_b32 s29, s76, 2
s_lshl_b32 s28, s29, 10
s_add_u32 s28, s28, s47
s_add_u32 m0, s28, 0
s_lshl_b32 s29, s29, 17
buffer_load_dwordx4 v40, s[4:7], s29 offen lds
s_xor_b32 s29, s76, 3
s_lshl_b32 s28, s29, 10
s_add_u32 s28, s28, s47
s_add_u32 m0, s28, 0
s_lshl_b32 s29, s29, 17
buffer_load_dwordx4 v40, s[4:7], s29 offen lds
s_xor_b32 s29, s76, 4
s_lshl_b32 s28, s29, 10
s_add_u32 s28, s28, s47
s_add_u32 m0, s28, 0
s_lshl_b32 s29, s29, 17
buffer_load_dwordx4 v40, s[4:7], s29 offen lds
s_xor_b32 s29, s76, 5
s_lshl_b32 s28, s29, 10
s_add_u32 s28, s28, s47
s_add_u32 m0, s28, 0
s_lshl_b32 s29, s29, 17
buffer_load_dwordx4 v40, s[4:7], s29 offen lds
s_xor_b32 s29, s76, 6
s_lshl_b32 s28, s29, 10
s_add_u32 s28, s28, s47
s_add_u32 m0, s28, 0
s_lshl_b32 s29, s29, 17
buffer_load_dwordx4 v40, s[4:7], s29 offen lds
s_xor_b32 s29, s76, 7
s_lshl_b32 s28, s29, 10
s_add_u32 s28, s28, s47
s_add_u32 m0, s28, 0
s_lshl_b32 s29, s29, 17
buffer_load_dwordx4 v40, s[4:7], s29 offen lds
s_xor_b32 s29, s76, 8
s_lshl_b32 s28, s29, 10
s_add_u32 s28, s28, s47
s_add_u32 m0, s28, 0
s_lshl_b32 s29, s29, 17
buffer_load_dwordx4 v40, s[4:7], s29 offen lds
s_xor_b32 s29, s76, 9
s_lshl_b32 s28, s29, 10
s_add_u32 s28, s28, s47
s_add_u32 m0, s28, 0
s_lshl_b32 s29, s29, 17
buffer_load_dwordx4 v40, s[4:7], s29 offen lds
s_xor_b32 s29, s76, 10
s_lshl_b32 s28, s29, 10
s_add_u32 s28, s28, s47
s_add_u32 m0, s28, 0
s_lshl_b32 s29, s29, 17
buffer_load_dwordx4 v40, s[4:7], s29 offen lds
s_xor_b32 s29, s76, 11
s_lshl_b32 s28, s29, 10
s_add_u32 s28, s28, s47
s_add_u32 m0, s28, 0
s_lshl_b32 s29, s29, 17
buffer_load_dwordx4 v40, s[4:7], s29 offen lds
s_xor_b32 s29, s76, 12
s_lshl_b32 s28, s29, 10
s_add_u32 s28, s28, s47
s_add_u32 m0, s28, 0
s_lshl_b32 s29, s29, 17
buffer_load_dwordx4 v40, s[4:7], s29 offen lds
s_xor_b32 s29, s76, 13
s_lshl_b32 s28, s29, 10
s_add_u32 s28, s28, s47
s_add_u32 m0, s28, 0
s_lshl_b32 s29, s29, 17
buffer_load_dwordx4 v40, s[4:7], s29 offen lds
s_xor_b32 s29, s76, 14
s_lshl_b32 s28, s29, 10
s_add_u32 s28, s28, s47
s_add_u32 m0, s28, 0
s_lshl_b32 s29, s29, 17
buffer_load_dwordx4 v40, s[4:7], s29 offen lds
s_xor_b32 s29, s76, 15
s_lshl_b32 s28, s29, 10
s_add_u32 s28, s28, s47
s_add_u32 m0, s28, 0
s_lshl_b32 s29, s29, 17
buffer_load_dwordx4 v40, s[4:7], s29 offen lds
buffer_load_dword v50, v51, s[8:11], 0 offen
s_xor_b32 s29, s76, 0
s_lshl_b32 s28, s29, 10
s_add_u32 s28, s28, s47
s_add_u32 m0, s28, 16384
s_lshl_b32 s29, s29, 17
buffer_load_dwordx4 v40, s[8:11], s29 offen lds
s_xor_b32 s29, s76, 1
s_lshl_b32 s28, s29, 10
s_add_u32 s28, s28, s47
s_add_u32 m0, s28, 16384
s_lshl_b32 s29, s29, 17
buffer_load_dwordx4 v40, s[8:11], s29 offen lds
s_xor_b32 s29, s76, 2
s_lshl_b32 s28, s29, 10
s_add_u32 s28, s28, s47
s_add_u32 m0, s28, 16384
s_lshl_b32 s29, s29, 17
buffer_load_dwordx4 v40, s[8:11], s29 offen lds
s_xor_b32 s29, s76, 3
s_lshl_b32 s28, s29, 10
s_add_u32 s28, s28, s47
s_add_u32 m0, s28, 16384
s_lshl_b32 s29, s29, 17
buffer_load_dwordx4 v40, s[8:11], s29 offen lds
s_xor_b32 s29, s76, 4
s_lshl_b32 s28, s29, 10
s_add_u32 s28, s28, s47
s_add_u32 m0, s28, 16384
s_lshl_b32 s29, s29, 17
buffer_load_dwordx4 v40, s[8:11], s29 offen lds
s_xor_b32 s29, s76, 5
s_lshl_b32 s28, s29, 10
s_add_u32 s28, s28, s47
s_add_u32 m0, s28, 16384
s_lshl_b32 s29, s29, 17
buffer_load_dwordx4 v40, s[8:11], s29 offen lds
s_xor_b32 s29, s76, 6
s_lshl_b32 s28, s29, 10
s_add_u32 s28, s28, s47
s_add_u32 m0, s28, 16384
s_lshl_b32 s29, s29, 17
buffer_load_dwordx4 v40, s[8:11], s29 offen lds
s_xor_b32 s29, s76, 7
s_lshl_b32 s28, s29, 10
s_add_u32 s28, s28, s47
s_add_u32 m0, s28, 16384
s_lshl_b32 s29, s29, 17
buffer_load_dwordx4 v40, s[8:11], s29 offen lds
s_xor_b32 s29, s76, 8
s_lshl_b32 s28, s29, 10
s_add_u32 s28, s28, s47
s_add_u32 m0, s28, 16384
s_lshl_b32 s29, s29, 17
buffer_load_dwordx4 v40, s[8:11], s29 offen lds
s_xor_b32 s29, s76, 9
s_lshl_b32 s28, s29, 10
s_add_u32 s28, s28, s47
s_add_u32 m0, s28, 16384
s_lshl_b32 s29, s29, 17
buffer_load_dwordx4 v40, s[8:11], s29 offen lds
s_xor_b32 s29, s76, 10
s_lshl_b32 s28, s29, 10
s_add_u32 s28, s28, s47
s_add_u32 m0, s28, 16384
s_lshl_b32 s29, s29, 17
buffer_load_dwordx4 v40, s[8:11], s29 offen lds
s_xor_b32 s29, s76, 11
s_lshl_b32 s28, s29, 10
s_add_u32 s28, s28, s47
s_add_u32 m0, s28, 16384
s_lshl_b32 s29, s29, 17
buffer_load_dwordx4 v40, s[8:11], s29 offen lds
s_xor_b32 s29, s76, 12
s_lshl_b32 s28, s29, 10
s_add_u32 s28, s28, s47
s_add_u32 m0, s28, 16384
s_lshl_b32 s29, s29, 17
buffer_load_dwordx4 v40, s[8:11], s29 offen lds
s_xor_b32 s29, s76, 13
s_lshl_b32 s28, s29, 10
s_add_u32 s28, s28, s47
s_add_u32 m0, s28, 16384
s_lshl_b32 s29, s29, 17
buffer_load_dwordx4 v40, s[8:11], s29 offen lds
s_xor_b32 s29, s76, 14
s_lshl_b32 s28, s29, 10
s_add_u32 s28, s28, s47
s_add_u32 m0, s28, 16384
s_lshl_b32 s29, s29, 17
buffer_load_dwordx4 v40, s[8:11], s29 offen lds
s_xor_b32 s29, s76, 15
s_lshl_b32 s28, s29, 10
s_add_u32 s28, s28, s47
s_add_u32 m0, s28, 16384
s_lshl_b32 s29, s29, 17
buffer_load_dwordx4 v40, s[8:11], s29 offen lds
s_mov_b32 s40, 0x00ff00ff
s_mov_b32 s41, 0x00ff00ff
s_mov_b32 s48, 0xff00ff00
s_mov_b32 s49, 0xff00ff00
s_mov_b32 s42, 0
s_mov_b32 s43, 0x00ff00ff
s_mov_b32 s32, 0x3e0293ee
v_mov_b32 v23, 0xff800000
v_mov_b32 v6, 0x4444
v_mov_b32 v4, 0xeeee
v_cndmask_b32 v6, v6, v4, s[48:49]
v_mov_b32 v28, -1
v_mov_b32 v29, -1
v_mov_b32 v30, -1
v_mov_b32 v31, -1
s_lshl_b32 s28, s24, 12
v_add_u32 v7, s28, v17
v_and_b32 v4, 7, v1
v_lshlrev_b32 v8, 11, v4
v_lshrrev_b32 v5, 3, v1
v_lshl_add_u32 v8, v5, 4, v8
s_lshl_b32 s28, s24, 9
v_add_u32 v8, s28, v8
s_lshl_b32 s28, s31, 9
v_lshlrev_b32 v9, 3, v1
v_add_u32 v9, s28, v9
v_and_b32 v4, 7, v3
v_lshlrev_b32 v11, 7, v2
v_lshl_add_u32 v11, v4, 4, v11
v_add_u32 v22, 0, v11
s_add_u32 s28, s28, 16384
v_add_u32 v11, s28, v11
v_and_b32 v5, 1, v2
v_lshlrev_b32 v10, 7, v5
v_lshl_add_u32 v10, v4, 4, v10
v_add_u32 v10, 1024, v10
s_xor_b32 s37, s31, 1
s_lshl_b32 s37, s37, 11
s_add_u32 s37, s37, 32768
s_xor_b32 s38, s31, 2
s_lshl_b32 s38, s38, 11
s_add_u32 s38, s38, 32768
s_xor_b32 s39, s31, 3
s_lshl_b32 s39, s39, 11
s_add_u32 s39, s39, 32768
v_and_b32 v4, 1, v2
v_mul_u32_u24 v14, 576, v4
v_lshrrev_b32 v5, 1, v2
v_lshl_add_u32 v5, v5, 4, v3
v_lshl_add_u32 v14, v5, 2, v14
s_mul_i32 s28, s24, 1152
s_add_u32 s28, s28, 13312
v_add_u32 v18, s28, v14
s_mul_i32 s28, s24, 2304
v_add_u32 v14, s28, v14
v_add_u32 v15, 1152, v14
v_mul_u32_u24 v16, 144, v3
v_lshl_add_u32 v16, v2, 5, v16
v_bfe_u32 v4, v1, 1, 3
v_mul_u32_u24 v19, 144, v4
v_lshl_add_u32 v19, v2, 5, v19
v_and_b32 v4, 1, v1
v_lshl_add_u32 v19, v4, 4, v19
v_add_u32 v19, 13312, v19
s_lshl_b32 s28, s24, 10
s_add_u32 s28, s28, 9216
v_add_u32 v20, s28, v17
v_and_b32 v4, 31, v1
v_lshlrev_b32 v21, 3, v4
v_add_u32 v21, 17920, v21
v_lshrrev_b32 v4, 2, v3
v_and_b32 v42, 1, v4
v_lshrrev_b32 v43, 1, v4
v_lshrrev_b32 v44, 1, v2
v_and_b32 v45, 1, v2
v_lshl_add_u32 v46, v44, 4, v42
v_lshl_add_u32 v46, v45, 2, v46
v_lshl_add_u32 v46, v43, 3, v46
v_lshl_add_u32 v47, v44, 3, v42
v_lshl_add_u32 v47, v45, 4, v47
v_lshl_add_u32 v47, v43, 2, v47
v_and_b32 v5, 3, v3
v_lshlrev_b32 v5, 3, v5
v_lshl_add_u32 v46, v46, 6, v5
v_lshl_add_u32 v47, v47, 6, v5
s_and_b32 s28, s31, 0
s_lshl_b32 s28, s28, 6
s_add_u32 s28, s28, s47
v_add_u32 v46, s28, v46
v_add_u32 v47, s28, v47
s_waitcnt vmcnt(17)
ds_read_b64_tr_b16 a[0:1], v46 offset:0
ds_read_b64_tr_b16 a[2:3], v46 offset:128
ds_read_b64_tr_b16 a[4:5], v46 offset:2048
ds_read_b64_tr_b16 a[6:7], v46 offset:2176
ds_read_b64_tr_b16 a[8:9], v46 offset:4096
ds_read_b64_tr_b16 a[10:11], v46 offset:4224
ds_read_b64_tr_b16 a[12:13], v46 offset:6144
ds_read_b64_tr_b16 a[14:15], v46 offset:6272
s_waitcnt lgkmcnt(0)
ds_read_b64_tr_b16 a[16:17], v46 offset:8192
ds_read_b64_tr_b16 a[18:19], v46 offset:8320
ds_read_b64_tr_b16 a[20:21], v46 offset:10240
ds_read_b64_tr_b16 a[22:23], v46 offset:10368
ds_read_b64_tr_b16 a[24:25], v46 offset:12288
ds_read_b64_tr_b16 a[26:27], v46 offset:12416
ds_read_b64_tr_b16 a[28:29], v46 offset:14336
ds_read_b64_tr_b16 a[30:31], v46 offset:14464
s_waitcnt lgkmcnt(0)
ds_read_b64_tr_b16 a[32:33], v46 offset:32
ds_read_b64_tr_b16 a[34:35], v46 offset:160
ds_read_b64_tr_b16 a[36:37], v46 offset:2080
ds_read_b64_tr_b16 a[38:39], v46 offset:2208
ds_read_b64_tr_b16 a[40:41], v46 offset:4128
ds_read_b64_tr_b16 a[42:43], v46 offset:4256
ds_read_b64_tr_b16 a[44:45], v46 offset:6176
ds_read_b64_tr_b16 a[46:47], v46 offset:6304
s_waitcnt lgkmcnt(0)
ds_read_b64_tr_b16 a[48:49], v46 offset:8224
ds_read_b64_tr_b16 a[50:51], v46 offset:8352
ds_read_b64_tr_b16 a[52:53], v46 offset:10272
ds_read_b64_tr_b16 a[54:55], v46 offset:10400
ds_read_b64_tr_b16 a[56:57], v46 offset:12320
ds_read_b64_tr_b16 a[58:59], v46 offset:12448
ds_read_b64_tr_b16 a[60:61], v46 offset:14368
ds_read_b64_tr_b16 a[62:63], v46 offset:14496
s_waitcnt lgkmcnt(0)
buffer_load_dword v50, v51, s[12:15], 0 offen
s_xor_b32 s29, s76, 0
s_lshl_b32 s28, s29, 10
s_add_u32 s28, s28, s47
s_add_u32 m0, s28, 0
s_lshl_b32 s29, s29, 17
buffer_load_dwordx4 v40, s[12:15], s29 offen lds
s_xor_b32 s29, s76, 1
s_lshl_b32 s28, s29, 10
s_add_u32 s28, s28, s47
s_add_u32 m0, s28, 0
s_lshl_b32 s29, s29, 17
buffer_load_dwordx4 v40, s[12:15], s29 offen lds
s_xor_b32 s29, s76, 2
s_lshl_b32 s28, s29, 10
s_add_u32 s28, s28, s47
s_add_u32 m0, s28, 0
s_lshl_b32 s29, s29, 17
buffer_load_dwordx4 v40, s[12:15], s29 offen lds
s_xor_b32 s29, s76, 3
s_lshl_b32 s28, s29, 10
s_add_u32 s28, s28, s47
s_add_u32 m0, s28, 0
s_lshl_b32 s29, s29, 17
buffer_load_dwordx4 v40, s[12:15], s29 offen lds
s_xor_b32 s29, s76, 4
s_lshl_b32 s28, s29, 10
s_add_u32 s28, s28, s47
s_add_u32 m0, s28, 0
s_lshl_b32 s29, s29, 17
buffer_load_dwordx4 v40, s[12:15], s29 offen lds
s_xor_b32 s29, s76, 5
s_lshl_b32 s28, s29, 10
s_add_u32 s28, s28, s47
s_add_u32 m0, s28, 0
s_lshl_b32 s29, s29, 17
buffer_load_dwordx4 v40, s[12:15], s29 offen lds
s_xor_b32 s29, s76, 6
s_lshl_b32 s28, s29, 10
s_add_u32 s28, s28, s47
s_add_u32 m0, s28, 0
s_lshl_b32 s29, s29, 17
buffer_load_dwordx4 v40, s[12:15], s29 offen lds
s_xor_b32 s29, s76, 7
s_lshl_b32 s28, s29, 10
s_add_u32 s28, s28, s47
s_add_u32 m0, s28, 0
s_lshl_b32 s29, s29, 17
buffer_load_dwordx4 v40, s[12:15], s29 offen lds
s_xor_b32 s29, s76, 8
s_lshl_b32 s28, s29, 10
s_add_u32 s28, s28, s47
s_add_u32 m0, s28, 0
s_lshl_b32 s29, s29, 17
buffer_load_dwordx4 v40, s[12:15], s29 offen lds
s_xor_b32 s29, s76, 9
s_lshl_b32 s28, s29, 10
s_add_u32 s28, s28, s47
s_add_u32 m0, s28, 0
s_lshl_b32 s29, s29, 17
buffer_load_dwordx4 v40, s[12:15], s29 offen lds
s_xor_b32 s29, s76, 10
s_lshl_b32 s28, s29, 10
s_add_u32 s28, s28, s47
s_add_u32 m0, s28, 0
s_lshl_b32 s29, s29, 17
buffer_load_dwordx4 v40, s[12:15], s29 offen lds
s_xor_b32 s29, s76, 11
s_lshl_b32 s28, s29, 10
s_add_u32 s28, s28, s47
s_add_u32 m0, s28, 0
s_lshl_b32 s29, s29, 17
buffer_load_dwordx4 v40, s[12:15], s29 offen lds
s_xor_b32 s29, s76, 12
s_lshl_b32 s28, s29, 10
s_add_u32 s28, s28, s47
s_add_u32 m0, s28, 0
s_lshl_b32 s29, s29, 17
buffer_load_dwordx4 v40, s[12:15], s29 offen lds
s_xor_b32 s29, s76, 13
s_lshl_b32 s28, s29, 10
s_add_u32 s28, s28, s47
s_add_u32 m0, s28, 0
s_lshl_b32 s29, s29, 17
buffer_load_dwordx4 v40, s[12:15], s29 offen lds
s_xor_b32 s29, s76, 14
s_lshl_b32 s28, s29, 10
s_add_u32 s28, s28, s47
s_add_u32 m0, s28, 0
s_lshl_b32 s29, s29, 17
buffer_load_dwordx4 v40, s[12:15], s29 offen lds
s_xor_b32 s29, s76, 15
s_lshl_b32 s28, s29, 10
s_add_u32 s28, s28, s47
s_add_u32 m0, s28, 0
s_lshl_b32 s29, s29, 17
buffer_load_dwordx4 v40, s[12:15], s29 offen lds
s_waitcnt vmcnt(17)
ds_read_b64_tr_b16 a[64:65], v46 offset:16384
ds_read_b64_tr_b16 a[66:67], v46 offset:16512
ds_read_b64_tr_b16 a[68:69], v46 offset:18432
ds_read_b64_tr_b16 a[70:71], v46 offset:18560
ds_read_b64_tr_b16 a[72:73], v46 offset:20480
ds_read_b64_tr_b16 a[74:75], v46 offset:20608
ds_read_b64_tr_b16 a[76:77], v46 offset:22528
ds_read_b64_tr_b16 a[78:79], v46 offset:22656
s_waitcnt lgkmcnt(0)
ds_read_b64_tr_b16 a[80:81], v46 offset:24576
ds_read_b64_tr_b16 a[82:83], v46 offset:24704
ds_read_b64_tr_b16 a[84:85], v46 offset:26624
ds_read_b64_tr_b16 a[86:87], v46 offset:26752
ds_read_b64_tr_b16 a[88:89], v46 offset:28672
ds_read_b64_tr_b16 a[90:91], v46 offset:28800
ds_read_b64_tr_b16 a[92:93], v46 offset:30720
ds_read_b64_tr_b16 a[94:95], v46 offset:30848
s_waitcnt lgkmcnt(0)
ds_read_b64_tr_b16 a[96:97], v46 offset:16416
ds_read_b64_tr_b16 a[98:99], v46 offset:16544
ds_read_b64_tr_b16 a[100:101], v46 offset:18464
ds_read_b64_tr_b16 a[102:103], v46 offset:18592
ds_read_b64_tr_b16 a[104:105], v46 offset:20512
ds_read_b64_tr_b16 a[106:107], v46 offset:20640
ds_read_b64_tr_b16 a[108:109], v46 offset:22560
ds_read_b64_tr_b16 a[110:111], v46 offset:22688
s_waitcnt lgkmcnt(0)
ds_read_b64_tr_b16 a[112:113], v46 offset:24608
ds_read_b64_tr_b16 a[114:115], v46 offset:24736
ds_read_b64_tr_b16 a[116:117], v46 offset:26656
ds_read_b64_tr_b16 a[118:119], v46 offset:26784
ds_read_b64_tr_b16 a[120:121], v46 offset:28704
ds_read_b64_tr_b16 a[122:123], v46 offset:28832
ds_read_b64_tr_b16 a[124:125], v46 offset:30752
ds_read_b64_tr_b16 a[126:127], v46 offset:30880
s_waitcnt lgkmcnt(0)
buffer_load_dword v50, v52, s[16:19], 0 offen
s_xor_b32 s29, s76, 0
s_lshl_b32 s28, s29, 10
s_add_u32 s28, s28, s47
s_add_u32 m0, s28, 16384
s_lshl_b32 s29, s29, 15
buffer_load_dwordx4 v41, s[16:19], s29 offen lds
s_xor_b32 s29, s76, 1
s_lshl_b32 s28, s29, 10
s_add_u32 s28, s28, s47
s_add_u32 m0, s28, 16384
s_lshl_b32 s29, s29, 15
buffer_load_dwordx4 v41, s[16:19], s29 offen lds
s_xor_b32 s29, s76, 2
s_lshl_b32 s28, s29, 10
s_add_u32 s28, s28, s47
s_add_u32 m0, s28, 16384
s_lshl_b32 s29, s29, 15
buffer_load_dwordx4 v41, s[16:19], s29 offen lds
s_xor_b32 s29, s76, 3
s_lshl_b32 s28, s29, 10
s_add_u32 s28, s28, s47
s_add_u32 m0, s28, 16384
s_lshl_b32 s29, s29, 15
buffer_load_dwordx4 v41, s[16:19], s29 offen lds
s_xor_b32 s29, s76, 4
s_lshl_b32 s28, s29, 10
s_add_u32 s28, s28, s47
s_add_u32 m0, s28, 16384
s_lshl_b32 s29, s29, 15
buffer_load_dwordx4 v41, s[16:19], s29 offen lds
s_xor_b32 s29, s76, 5
s_lshl_b32 s28, s29, 10
s_add_u32 s28, s28, s47
s_add_u32 m0, s28, 16384
s_lshl_b32 s29, s29, 15
buffer_load_dwordx4 v41, s[16:19], s29 offen lds
s_xor_b32 s29, s76, 6
s_lshl_b32 s28, s29, 10
s_add_u32 s28, s28, s47
s_add_u32 m0, s28, 16384
s_lshl_b32 s29, s29, 15
buffer_load_dwordx4 v41, s[16:19], s29 offen lds
s_xor_b32 s29, s76, 7
s_lshl_b32 s28, s29, 10
s_add_u32 s28, s28, s47
s_add_u32 m0, s28, 16384
s_lshl_b32 s29, s29, 15
buffer_load_dwordx4 v41, s[16:19], s29 offen lds
s_xor_b32 s29, s76, 8
s_lshl_b32 s28, s29, 10
s_add_u32 s28, s28, s47
s_add_u32 m0, s28, 16384
s_lshl_b32 s29, s29, 15
buffer_load_dwordx4 v41, s[16:19], s29 offen lds
s_xor_b32 s29, s76, 9
s_lshl_b32 s28, s29, 10
s_add_u32 s28, s28, s47
s_add_u32 m0, s28, 16384
s_lshl_b32 s29, s29, 15
buffer_load_dwordx4 v41, s[16:19], s29 offen lds
s_xor_b32 s29, s76, 10
s_lshl_b32 s28, s29, 10
s_add_u32 s28, s28, s47
s_add_u32 m0, s28, 16384
s_lshl_b32 s29, s29, 15
buffer_load_dwordx4 v41, s[16:19], s29 offen lds
s_xor_b32 s29, s76, 11
s_lshl_b32 s28, s29, 10
s_add_u32 s28, s28, s47
s_add_u32 m0, s28, 16384
s_lshl_b32 s29, s29, 15
buffer_load_dwordx4 v41, s[16:19], s29 offen lds
s_xor_b32 s29, s76, 12
s_lshl_b32 s28, s29, 10
s_add_u32 s28, s28, s47
s_add_u32 m0, s28, 16384
s_lshl_b32 s29, s29, 15
buffer_load_dwordx4 v41, s[16:19], s29 offen lds
s_xor_b32 s29, s76, 13
s_lshl_b32 s28, s29, 10
s_add_u32 s28, s28, s47
s_add_u32 m0, s28, 16384
s_lshl_b32 s29, s29, 15
buffer_load_dwordx4 v41, s[16:19], s29 offen lds
s_xor_b32 s29, s76, 14
s_lshl_b32 s28, s29, 10
s_add_u32 s28, s28, s47
s_add_u32 m0, s28, 16384
s_lshl_b32 s29, s29, 15
buffer_load_dwordx4 v41, s[16:19], s29 offen lds
s_xor_b32 s29, s76, 15
s_lshl_b32 s28, s29, 10
s_add_u32 s28, s28, s47
s_add_u32 m0, s28, 16384
s_lshl_b32 s29, s29, 15
buffer_load_dwordx4 v41, s[16:19], s29 offen lds
s_waitcnt vmcnt(17)
ds_read_b64_tr_b16 a[128:129], v46 offset:0
ds_read_b64_tr_b16 a[130:131], v46 offset:128
ds_read_b64_tr_b16 a[132:133], v46 offset:2048
ds_read_b64_tr_b16 a[134:135], v46 offset:2176
ds_read_b64_tr_b16 a[136:137], v46 offset:4096
ds_read_b64_tr_b16 a[138:139], v46 offset:4224
ds_read_b64_tr_b16 a[140:141], v46 offset:6144
ds_read_b64_tr_b16 a[142:143], v46 offset:6272
s_waitcnt lgkmcnt(0)
ds_read_b64_tr_b16 a[144:145], v46 offset:8192
ds_read_b64_tr_b16 a[146:147], v46 offset:8320
ds_read_b64_tr_b16 a[148:149], v46 offset:10240
ds_read_b64_tr_b16 a[150:151], v46 offset:10368
ds_read_b64_tr_b16 a[152:153], v46 offset:12288
ds_read_b64_tr_b16 a[154:155], v46 offset:12416
ds_read_b64_tr_b16 a[156:157], v46 offset:14336
ds_read_b64_tr_b16 a[158:159], v46 offset:14464
s_waitcnt lgkmcnt(0)
ds_read_b64_tr_b16 a[160:161], v46 offset:32
ds_read_b64_tr_b16 a[162:163], v46 offset:160
ds_read_b64_tr_b16 a[164:165], v46 offset:2080
ds_read_b64_tr_b16 a[166:167], v46 offset:2208
ds_read_b64_tr_b16 a[168:169], v46 offset:4128
ds_read_b64_tr_b16 a[170:171], v46 offset:4256
ds_read_b64_tr_b16 a[172:173], v46 offset:6176
ds_read_b64_tr_b16 a[174:175], v46 offset:6304
s_waitcnt lgkmcnt(0)
ds_read_b64_tr_b16 a[176:177], v46 offset:8224
ds_read_b64_tr_b16 a[178:179], v46 offset:8352
ds_read_b64_tr_b16 a[180:181], v46 offset:10272
ds_read_b64_tr_b16 a[182:183], v46 offset:10400
ds_read_b64_tr_b16 a[184:185], v46 offset:12320
ds_read_b64_tr_b16 a[186:187], v46 offset:12448
ds_read_b64_tr_b16 a[188:189], v46 offset:14368
ds_read_b64_tr_b16 a[190:191], v46 offset:14496
s_waitcnt lgkmcnt(0)
s_waitcnt vmcnt(0)
ds_read_b64_tr_b16 a[192:193], v47 offset:16384
ds_read_b64_tr_b16 a[194:195], v47 offset:16512
ds_read_b64_tr_b16 a[196:197], v47 offset:18432
ds_read_b64_tr_b16 a[198:199], v47 offset:18560
ds_read_b64_tr_b16 a[200:201], v47 offset:20480
ds_read_b64_tr_b16 a[202:203], v47 offset:20608
ds_read_b64_tr_b16 a[204:205], v47 offset:22528
ds_read_b64_tr_b16 a[206:207], v47 offset:22656
s_waitcnt lgkmcnt(0)
ds_read_b64_tr_b16 a[208:209], v47 offset:24576
ds_read_b64_tr_b16 a[210:211], v47 offset:24704
ds_read_b64_tr_b16 a[212:213], v47 offset:26624
ds_read_b64_tr_b16 a[214:215], v47 offset:26752
ds_read_b64_tr_b16 a[216:217], v47 offset:28672
ds_read_b64_tr_b16 a[218:219], v47 offset:28800
ds_read_b64_tr_b16 a[220:221], v47 offset:30720
ds_read_b64_tr_b16 a[222:223], v47 offset:30848
s_waitcnt lgkmcnt(0)
ds_read_b64_tr_b16 a[224:225], v47 offset:16416
ds_read_b64_tr_b16 a[226:227], v47 offset:16544
ds_read_b64_tr_b16 a[228:229], v47 offset:18464
ds_read_b64_tr_b16 a[230:231], v47 offset:18592
ds_read_b64_tr_b16 a[232:233], v47 offset:20512
ds_read_b64_tr_b16 a[234:235], v47 offset:20640
ds_read_b64_tr_b16 a[236:237], v47 offset:22560
ds_read_b64_tr_b16 a[238:239], v47 offset:22688
s_waitcnt lgkmcnt(0)
ds_read_b64_tr_b16 a[240:241], v47 offset:24608
ds_read_b64_tr_b16 a[242:243], v47 offset:24736
ds_read_b64_tr_b16 a[244:245], v47 offset:26656
ds_read_b64_tr_b16 a[246:247], v47 offset:26784
ds_read_b64_tr_b16 a[248:249], v47 offset:28704
ds_read_b64_tr_b16 a[250:251], v47 offset:28832
ds_read_b64_tr_b16 a[252:253], v47 offset:30752
ds_read_b64_tr_b16 a[254:255], v47 offset:30880
s_waitcnt lgkmcnt(0)
v_and_b32 v5, 15, v0
v_lshlrev_b32 v5, 4, v5
s_branch mega_kernel_syr
mega_kernel_syrw:
s_sleep 4
mega_kernel_syr:
buffer_load_dword v4, v5, s[72:75], 0 offen sc1
s_waitcnt vmcnt(0)
s_cmp_eq_u32 s95, 1
s_cbranch_scc0 mega_kernel_syrf
v_readlane_b32 s76, v4, 14
s_mov_b32 s98, 0
s_cmp_eq_u32 s76, 64
s_cbranch_scc0 mega_kernel_syrw
s_branch mega_kernel_syrd
mega_kernel_syrf:
s_mov_b32 s77, 0
s_mov_b32 s78, 0
v_readlane_b32 s76, v4, 0
s_add_u32 s77, s77, s76
s_xor_b32 s76, s76, 32
s_or_b32 s78, s78, s76
v_readlane_b32 s76, v4, 1
s_add_u32 s77, s77, s76
s_xor_b32 s76, s76, 32
s_or_b32 s78, s78, s76
v_readlane_b32 s76, v4, 2
s_add_u32 s77, s77, s76
s_xor_b32 s76, s76, 32
s_or_b32 s78, s78, s76
v_readlane_b32 s76, v4, 3
s_add_u32 s77, s77, s76
s_xor_b32 s76, s76, 32
s_or_b32 s78, s78, s76
v_readlane_b32 s76, v4, 4
s_add_u32 s77, s77, s76
s_xor_b32 s76, s76, 32
s_or_b32 s78, s78, s76
v_readlane_b32 s76, v4, 5
s_add_u32 s77, s77, s76
s_xor_b32 s76, s76, 32
s_or_b32 s78, s78, s76
v_readlane_b32 s76, v4, 6
s_add_u32 s77, s77, s76
s_xor_b32 s76, s76, 32
s_or_b32 s78, s78, s76
v_readlane_b32 s76, v4, 7
s_add_u32 s77, s77, s76
s_xor_b32 s76, s76, 32
s_or_b32 s78, s78, s76
s_cmp_eq_u32 s77, 256
s_cbranch_scc0 mega_kernel_syrw
v_mov_b32 v252, v4
s_cmp_eq_u32 s78, 0
s_cbranch_scc0 mega_kernel_slowent
v_readlane_b32 s76, v4, 10
v_readlane_b32 s77, v4, 8
s_cmp_eq_u32 s76, 64
s_cbranch_scc0 mega_kernel_syrw
s_cmp_gt_u32 s77, 32
s_cselect_b32 s98, 1, 0
mega_kernel_syrd:
s_lshr_b32 s28, s31, 3
s_lshl_b32 s28, s28, 14
s_lshl_b32 s29, s98, 13
s_add_u32 s28, s28, s29
s_and_b32 s29, s31, 7
s_lshl_b32 s29, s29, 10
s_add_u32 s28, s28, s29
s_lshl_b32 s29, s30, 16
s_add_u32 s28, s28, s29
s_add_u32 s28, s28, 67108864
v_add_u32 v12, s28, v17
v_xor_b32 v25, 0x10000, v12
v_xor_b32 v26, 0x20000, v12
v_xor_b32 v27, 0x30000, v12
s_lshl_b32 s28, s25, 2
s_add_u32 s28, s28, s26
s_mov_b32 s82, s28
s_lshr_b32 s29, s28, 3
s_xor_b32 s29, s29, s98
s_and_b32 s29, s29, 1
s_lshl_b32 s29, s29, 13
s_lshl_b32 s76, s28, 18
s_add_u32 s76, s76, s29
s_mov_b32 s83, s76
v_add_u32 v240, s76, v17
v_add_u32 v241, 33554432, v240
s_lshr_b32 s29, s28, 4
s_xor_b32 s29, s29, s98
s_and_b32 s29, s29, 1
s_lshl_b32 s29, s29, 13
s_lshl_b32 s79, s28, 17
s_add_u32 s79, s79, s29
s_add_u32 s79, s79, 71303168
s_xor_b32 s29, s98, 1
s_lshl_b32 s29, s29, 13
s_lshl_b32 s28, s25, 7
s_add_u32 s28, s28, s29
s_add_u32 s28, s28, 69206016
v_and_b32 v4, 1, v1
v_lshlrev_b32 v24, 12, v4
v_add_u32 v24, s28, v24
s_lshl_b32 s29, s26, 2
v_add_u32 v24, s29, v24
s_xor_b32 s81, s98, 1
s_lshl_b32 s81, s81, 13
s_lshr_b32 s29, s82, 6
s_lshl_b32 s29, s29, 14
s_add_u32 s81, s81, s29
s_and_b32 s29, s82, 63
s_lshl_b32 s29, s29, 7
s_add_u32 s81, s81, s29
s_add_u32 s81, s81, 69222400
v_mov_b32 v220, 0x3f803f80
v_mov_b32 v221, 0x3f803f80
v_mov_b32 v222, 0x3f803f80
v_mov_b32 v223, 0x3f803f80
v_mov_b32 v228, 0
s_mov_b32 s27, 0
s_mov_b32 s46, 0
s_mov_b32 s44, 18432
s_mov_b32 s45, 18432
s_cmp_eq_u32 s24, 3
s_cbranch_scc0 mega_kernel_rf_pfi
s_mov_b32 s76, 0
s_cmp_gt_i32 s46, s76
s_cbranch_scc1 mega_kernel_rf_pf0ok
mega_kernel_rf_pf0w:
buffer_load_dword v4, v24, s[84:87], 0 offen sc1
s_waitcnt vmcnt(0)
v_readlane_b32 s46, v4, 0
v_readlane_b32 s28, v4, 1
s_nop 1
s_min_i32 s46, s46, s28
s_cmp_gt_i32 s46, s76
s_cbranch_scc0 mega_kernel_rf_pf0w
mega_kernel_rf_pf0ok:
s_add_u32 s77, s76, s82
s_bfe_u32 s28, s77, 0x40002
s_lshl_b32 s28, s28, 14
s_and_b32 s77, s77, 3
s_lshl_b32 s77, s77, 11
s_add_u32 s28, s28, s77
s_add_u32 m0, s45, 0
s_nop 0
buffer_load_dwordx4 v240, s[84:87], s28 offen offset:0 sc1 lds
s_add_u32 m0, s45, 0
s_nop 0
buffer_load_dwordx4 v240, s[84:87], s28 offen offset:1024 sc1 lds
s_add_u32 m0, s45, 2048
s_nop 0
buffer_load_dwordx4 v241, s[84:87], s28 offen offset:0 sc1 lds
s_add_u32 m0, s45, 2048
s_nop 0
buffer_load_dwordx4 v241, s[84:87], s28 offen offset:1024 sc1 lds
s_add_u32 s45, s45, 4096
s_cmp_eq_u32 s45, 30720
s_cselect_b32 s45, 18432, s45
s_waitcnt vmcnt(0) lgkmcnt(0)
mega_kernel_rf_pfi:
v_mov_b32 v96, 0
v_mov_b32 v97, 0
v_mov_b32 v98, 0
v_mov_b32 v99, 0
v_mov_b32 v100, 0
v_mov_b32 v101, 0
v_mov_b32 v102, 0
v_mov_b32 v103, 0
v_mov_b32 v104, 0
v_mov_b32 v105, 0
v_mov_b32 v106, 0
v_mov_b32 v107, 0
v_mov_b32 v108, 0
v_mov_b32 v109, 0
v_mov_b32 v110, 0
v_mov_b32 v111, 0
v_mov_b32 v112, 0
v_mov_b32 v113, 0
v_mov_b32 v114, 0
v_mov_b32 v115, 0
v_mov_b32 v116, 0
v_mov_b32 v117, 0
v_mov_b32 v118, 0
v_mov_b32 v119, 0
s_barrier
s_and_b32 s29, s27, 1
s_lshl_b32 s33, s29, 17
s_lshl_b32 s28, s30, 18
s_add_u32 s33, s33, s28
s_add_u32 s33, s33, 68157440
s_xor_b32 s34, s33, 131072
s_lshl_b32 s35, s29, 18
s_bfe_u32 s47, s27, 0x10001
s_branch mega_kernel_rf_first
mega_kernel_rf_loop:
buffer_load_dwordx4 v[32:35], v7, s[84:87], s33 offen offset:0 sc1
v_add_u32 v5, s44, v17
ds_read_b128 v[156:159], v5 offset:0
ds_read_b128 v[160:163], v5 offset:1024
ds_read_b128 v[164:167], v5 offset:2048
ds_read_b128 v[168:171], v5 offset:3072
s_nop 4
buffer_load_dwordx4 v[36:39], v7, s[84:87], s33 offen offset:1024 sc1
s_nop 9
buffer_load_dwordx4 v[40:43], v7, s[84:87], s33 offen offset:2048 sc1
s_nop 9
buffer_load_dwordx4 v[44:47], v7, s[84:87], s33 offen offset:3072 sc1
s_waitcnt vmcnt(3)
v_max_u32 v4, v32, v34
v_cmp_eq_u32 vcc, -1, v4
s_cbranch_vccnz mega_kernel_rf_pa_15_0f
v_smfmac_f32_16x16x64_bf16 v[96:99], v[32:35], a[0:7], v6
v_smfmac_f32_16x16x64_bf16 v[100:103], v[32:35], a[32:39], v6
v_smfmac_f32_16x16x64_bf16 v[104:107], v[32:35], a[64:71], v6
s_waitcnt vmcnt(2)
v_max_u32 v4, v36, v38
v_cmp_eq_u32 vcc, -1, v4
v_smfmac_f32_16x16x64_bf16 v[108:111], v[32:35], a[96:103], v6
s_cbranch_vccnz mega_kernel_rf_pa_14_1f
v_smfmac_f32_16x16x64_bf16 v[96:99], v[36:39], a[8:15], v6
v_smfmac_f32_16x16x64_bf16 v[100:103], v[36:39], a[40:47], v6
v_smfmac_f32_16x16x64_bf16 v[104:107], v[36:39], a[72:79], v6
s_waitcnt vmcnt(1)
v_max_u32 v4, v40, v42
v_cmp_eq_u32 vcc, -1, v4
v_smfmac_f32_16x16x64_bf16 v[108:111], v[36:39], a[104:111], v6
s_cbranch_vccnz mega_kernel_rf_pa_12_2f
v_smfmac_f32_16x16x64_bf16 v[96:99], v[40:43], a[16:23], v6
v_smfmac_f32_16x16x64_bf16 v[100:103], v[40:43], a[48:55], v6
v_smfmac_f32_16x16x64_bf16 v[104:107], v[40:43], a[80:87], v6
s_waitcnt vmcnt(0)
v_max_u32 v4, v44, v46
v_cmp_eq_u32 vcc, -1, v4
v_smfmac_f32_16x16x64_bf16 v[108:111], v[40:43], a[112:119], v6
s_cbranch_vccnz mega_kernel_rf_pa_8_3f
v_smfmac_f32_16x16x64_bf16 v[96:99], v[44:47], a[24:31], v6
v_smfmac_f32_16x16x64_bf16 v[100:103], v[44:47], a[56:63], v6
v_smfmac_f32_16x16x64_bf16 v[104:107], v[44:47], a[88:95], v6
v_smfmac_f32_16x16x64_bf16 v[108:111], v[44:47], a[120:127], v6
mega_kernel_rf_pa_d:
mega_kernel_rf_adone:
s_nop 5
v_permlane32_swap_b32 v96, v100
v_permlane32_swap_b32 v97, v101
v_permlane32_swap_b32 v98, v102
v_permlane32_swap_b32 v99, v103
v_pk_add_f32 v[96:97], v[96:97], v[100:101]
v_pk_add_f32 v[98:99], v[98:99], v[102:103]
ds_write2_b32 v14, v96, v97 offset0:0 offset1:36
ds_write2_b32 v14, v98, v99 offset0:72 offset1:108
v_permlane32_swap_b32 v104, v108
v_permlane32_swap_b32 v105, v109
v_permlane32_swap_b32 v106, v110
v_permlane32_swap_b32 v107, v111
v_pk_add_f32 v[104:105], v[104:105], v[108:109]
v_pk_add_f32 v[106:107], v[106:107], v[110:111]
ds_write2_b32 v15, v104, v105 offset0:0 offset1:36
ds_write2_b32 v15, v106, v107 offset0:72 offset1:108
v_smfmac_f32_16x16x64_bf16 v[112:115], v[32:35], a[128:135], v6
v_smfmac_f32_16x16x64_bf16 v[116:119], v[32:35], a[160:167], v6
v_smfmac_f32_16x16x64_bf16 v[112:115], v[36:39], a[136:143], v6
v_smfmac_f32_16x16x64_bf16 v[116:119], v[36:39], a[168:175], v6
s_waitcnt lgkmcnt(0)
s_barrier
s_cmp_lg_u32 s24, 0
s_cbranch_scc1 mega_kernel_rf_side
ds_read_b128 v[120:123], v16 offset:0
ds_read_b128 v[124:127], v16 offset:16
ds_read_b128 v[128:131], v16 offset:2304
ds_read_b128 v[132:135], v16 offset:2320
ds_read_b128 v[136:139], v16 offset:4608
ds_read_b128 v[140:143], v16 offset:4624
ds_read_b128 v[144:147], v16 offset:6912
ds_read_b128 v[148:151], v16 offset:6928
v_smfmac_f32_16x16x64_bf16 v[112:115], v[40:43], a[144:151], v6
v_smfmac_f32_16x16x64_bf16 v[116:119], v[40:43], a[176:183], v6
v_smfmac_f32_16x16x64_bf16 v[112:115], v[44:47], a[152:159], v6
v_smfmac_f32_16x16x64_bf16 v[116:119], v[44:47], a[184:191], v6
s_lshl_b32 s28, s31, 11
s_add_u32 s28, s28, s33
s_add_u32 s28, s28, 32768
s_add_u32 s76, s37, s33
s_add_u32 s77, s38, s33
s_add_u32 s78, s39, s33
s_waitcnt lgkmcnt(4)
v_pk_add_f32 v[120:121], v[120:121], v[128:129]
v_pk_add_f32 v[122:123], v[122:123], v[130:131]
v_pk_add_f32 v[124:125], v[124:125], v[132:133]
v_pk_add_f32 v[126:127], v[126:127], v[134:135]
s_waitcnt lgkmcnt(0)
v_pk_add_f32 v[136:137], v[136:137], v[144:145]
v_pk_add_f32 v[138:139], v[138:139], v[146:147]
v_pk_add_f32 v[140:141], v[140:141], v[148:149]
v_pk_add_f32 v[142:143], v[142:143], v[150:151]
v_pk_add_f32 v[120:121], v[120:121], v[136:137]
v_pk_add_f32 v[122:123], v[122:123], v[138:139]
v_pk_add_f32 v[124:125], v[124:125], v[140:141]
v_pk_add_f32 v[126:127], v[126:127], v[142:143]
v_cvt_pk_bf16_f32 v152, v120, v121
v_cvt_pk_bf16_f32 v153, v122, v123
v_cvt_pk_bf16_f32 v154, v124, v125
v_cvt_pk_bf16_f32 v155, v126, v127
s_nop 1
v_mfma_f32_16x16x32_bf16 v[176:179], v[160:163], v[152:155], 0
v_mfma_f32_16x16x32_bf16 v[172:175], v[156:159], v[152:155], 0
v_mfma_f32_16x16x32_bf16 v[180:183], v[152:155], v[152:155], 0
s_cmp_eq_u32 s27, 63
s_cbranch_scc1 mega_kernel_rf_w0last
s_nop 4
v_mov_b32_dpp v172, v176 row_shr:8 row_mask:0xf bank_mask:0xc
v_mov_b32_dpp v173, v177 row_shr:8 row_mask:0xf bank_mask:0xc
v_mov_b32_dpp v174, v178 row_shr:8 row_mask:0xf bank_mask:0xc
v_mov_b32_dpp v175, v179 row_shr:8 row_mask:0xf bank_mask:0xc
v_min_u32 v180, -2, v180
v_min_u32 v172, -2, v172
s_mov_b64 exec, s[42:43]
buffer_store_dwordx4 v[180:183], v10, s[84:87], s28 offen
s_mov_b64 exec, -1
buffer_store_dwordx4 v[172:175], v17, s[84:87], s28 offen
v_permlane32_swap_b32 v112, v116
v_permlane32_swap_b32 v113, v117
v_permlane32_swap_b32 v114, v118
v_permlane32_swap_b32 v115, v119
v_pk_add_f32 v[112:113], v[112:113], v[116:117]
v_pk_add_f32 v[114:115], v[114:115], v[118:119]
ds_write_b128 v20, v[112:115]
s_waitcnt lgkmcnt(0)
s_barrier
v_mov_b32 v96, 0
v_mov_b32 v97, 0
v_mov_b32 v98, 0
v_mov_b32 v99, 0
v_mov_b32 v100, 0
v_mov_b32 v101, 0
v_mov_b32 v102, 0
v_mov_b32 v103, 0
v_cndmask_b32 v176, v23, v180, s[42:43]
v_cndmask_b32 v177, v23, v181, s[42:43]
v_cndmask_b32 v178, v23, v182, s[42:43]
v_cndmask_b32 v179, v23, v183, s[42:43]
buffer_load_dwordx4 v[184:187], v17, s[84:87], s76 offen sc1
buffer_load_dwordx4 v[188:191], v10, s[84:87], s76 offen sc1
buffer_load_dwordx4 v[192:195], v17, s[84:87], s77 offen sc1
buffer_load_dwordx4 v[196:199], v10, s[84:87], s77 offen sc1
buffer_load_dwordx4 v[200:203], v17, s[84:87], s78 offen sc1
buffer_load_dwordx4 v[204:207], v10, s[84:87], s78 offen sc1
s_nop 15
s_nop 7
buffer_load_dwordx4 v[184:187], v17, s[84:87], s76 offen sc1
buffer_load_dwordx4 v[188:191], v10, s[84:87], s76 offen sc1
buffer_load_dwordx4 v[192:195], v17, s[84:87], s77 offen sc1
buffer_load_dwordx4 v[196:199], v10, s[84:87], s77 offen sc1
buffer_load_dwordx4 v[200:203], v17, s[84:87], s78 offen sc1
buffer_load_dwordx4 v[204:207], v10, s[84:87], s78 offen sc1
mega_kernel_rf_p2:
s_waitcnt vmcnt(6)
v_max3_u32 v4, v184, v188, v192
v_max3_u32 v5, v196, v200, v204
v_max_u32 v4, v4, v5
v_cmp_eq_u32 vcc, -1, v4
s_cbranch_vccnz mega_kernel_rf_p2r
v_pk_add_f32 v[176:177], v[176:177], v[188:189]
v_pk_add_f32 v[124:125], v[196:197], v[204:205]
v_pk_add_f32 v[178:179], v[178:179], v[190:191]
v_pk_add_f32 v[126:127], v[198:199], v[206:207]
v_pk_add_f32 v[172:173], v[172:173], v[184:185]
v_pk_add_f32 v[120:121], v[192:193], v[200:201]
v_pk_add_f32 v[174:175], v[174:175], v[186:187]
v_pk_add_f32 v[122:123], v[194:195], v[202:203]
v_pk_add_f32 v[176:177], v[176:177], v[124:125]
v_pk_add_f32 v[178:179], v[178:179], v[126:127]
v_pk_add_f32 v[172:173], v[172:173], v[120:121]
v_pk_add_f32 v[174:175], v[174:175], v[122:123]
v_max3_f32 v232, v172, v173, v174
v_max3_f32 v233, v176, v177, v178
v_max3_f32 v232, v232, v175, v179
v_max_f32 v234, v232, v233
s_barrier
ds_read2_b64 v[208:211], v21 offset0:0 offset1:32
v_max_f32_dpp v232, v234, v234 row_ror:8 row_mask:0xf bank_mask:0xf
v_max_f32_dpp v233, v234, v234 row_ror:8 row_mask:0xf bank_mask:0xf
s_nop 1
v_permlane16_swap_b32 v232, v233
s_nop 0
v_max_f32 v234, v232, v233
v_max_f32 v235, v232, v233
s_nop 1
v_permlane32_swap_b32 v234, v235
s_nop 0
v_max_f32 v232, v234, v235
v_mul_f32 v232, s32, v232
v_pk_fma_f32 v[176:177], v[176:177], s[32:33], v[232:233] op_sel_hi:[1,0,0] neg_lo:[0,0,1] neg_hi:[0,0,1]
v_pk_fma_f32 v[178:179], v[178:179], s[32:33], v[232:233] op_sel_hi:[1,0,0] neg_lo:[0,0,1] neg_hi:[0,0,1]
v_pk_fma_f32 v[172:173], v[172:173], s[32:33], v[232:233] op_sel_hi:[1,0,0] neg_lo:[0,0,1] neg_hi:[0,0,1]
v_pk_fma_f32 v[174:175], v[174:175], s[32:33], v[232:233] op_sel_hi:[1,0,0] neg_lo:[0,0,1] neg_hi:[0,0,1]
v_exp_f32 v176, v176
v_exp_f32 v177, v177
v_exp_f32 v178, v178
v_exp_f32 v179, v179
v_exp_f32 v172, v172
v_cvt_pk_bf16_f32 v216, v176, v177
v_cvt_pk_bf16_f32 v217, v178, v179
v_exp_f32 v173, v173
v_exp_f32 v174, v174
v_mfma_f32_16x16x16_bf16 v[224:227], v[220:221], v[216:217], 0
v_exp_f32 v175, v175
v_cvt_pk_bf16_f32 v212, v172, v173
s_waitcnt lgkmcnt(0)
v_mfma_f32_16x16x16_bf16 v[120:123], v[208:209], v[216:217], 0
v_cvt_pk_bf16_f32 v213, v174, v175
v_mfma_f32_16x16x16_bf16 v[124:127], v[210:211], v[216:217], 0
v_mov_b32_dpp v214, v212 row_ror:8 row_mask:0xf bank_mask:0xf
v_mov_b32_dpp v215, v213 row_ror:8 row_mask:0xf bank_mask:0xf
s_nop 1
v_mfma_f32_16x16x32_bf16 v[224:227], v[220:223], v[212:215], v[224:227]
v_mfma_f32_16x16x32_bf16 v[120:123], v[164:167], v[212:215], v[120:123]
v_mfma_f32_16x16x32_bf16 v[124:127], v[168:171], v[212:215], v[124:127]
s_add_u32 s29, s33, 16384
s_nop 4
v_rcp_f32 v234, v224
s_nop 0
v_pk_mul_f32 v[120:121], v[120:121], v[234:235] op_sel_hi:[1,0]
v_pk_mul_f32 v[122:123], v[122:123], v[234:235] op_sel_hi:[1,0]
v_pk_mul_f32 v[124:125], v[124:125], v[234:235] op_sel_hi:[1,0]
v_pk_mul_f32 v[126:127], v[126:127], v[234:235] op_sel_hi:[1,0]
v_cvt_pk_bf16_f32 v212, v120, v121
v_cvt_pk_bf16_f32 v213, v122, v123
v_cvt_pk_bf16_f32 v214, v124, v125
v_cvt_pk_bf16_f32 v215, v126, v127
v_min_u32 v212, -2, v212
s_mov_b64 exec, s[40:41]
buffer_store_dwordx4 v[212:215], v11, s[84:87], s33 offen
s_mov_b64 exec, -1
mega_kernel_rf_b3:
s_barrier
s_nop 9
buffer_load_dwordx4 v[32:35], v7, s[84:87], s29 offen offset:0 sc1
s_nop 9
buffer_load_dwordx4 v[36:39], v7, s[84:87], s29 offen offset:1024 sc1
s_nop 9
buffer_load_dwordx4 v[40:43], v7, s[84:87], s29 offen offset:2048 sc1
s_nop 9
buffer_load_dwordx4 v[44:47], v7, s[84:87], s29 offen offset:3072 sc1
mega_kernel_rf_pc_15_0:
s_waitcnt vmcnt(3)
v_cmp_eq_u32 vcc, -1, v32
s_cbranch_vccnz mega_kernel_rf_pc_15_0f
v_smfmac_f32_16x16x64_bf16 v[96:99], v[32:35], a[192:199], v6
v_smfmac_f32_16x16x64_bf16 v[100:103], v[32:35], a[224:231], v6
mega_kernel_rf_pc_14_1:
s_waitcnt vmcnt(2)
v_cmp_eq_u32 vcc, -1, v36
s_cbranch_vccnz mega_kernel_rf_pc_14_1f
v_smfmac_f32_16x16x64_bf16 v[96:99], v[36:39], a[200:207], v6
v_smfmac_f32_16x16x64_bf16 v[100:103], v[36:39], a[232:239], v6
mega_kernel_rf_pc_12_2:
s_waitcnt vmcnt(1)
v_cmp_eq_u32 vcc, -1, v40
s_cbranch_vccnz mega_kernel_rf_pc_12_2f
v_smfmac_f32_16x16x64_bf16 v[96:99], v[40:43], a[208:215], v6
v_smfmac_f32_16x16x64_bf16 v[100:103], v[40:43], a[240:247], v6
mega_kernel_rf_pc_8_3:
s_waitcnt vmcnt(0)
v_cmp_eq_u32 vcc, -1, v44
s_cbranch_vccnz mega_kernel_rf_pc_8_3f
v_smfmac_f32_16x16x64_bf16 v[96:99], v[44:47], a[216:223], v6
v_smfmac_f32_16x16x64_bf16 v[100:103], v[44:47], a[248:255], v6
mega_kernel_rf_pc_d:
s_nop 7
v_permlane32_swap_b32 v96, v100
v_permlane32_swap_b32 v97, v101
v_permlane32_swap_b32 v98, v102
v_permlane32_swap_b32 v99, v103
v_pk_add_f32 v[96:97], v[96:97], v[100:101]
v_pk_add_f32 v[98:99], v[98:99], v[102:103]
ds_write2_b32 v18, v96, v97 offset0:0 offset1:36
ds_write2_b32 v18, v98, v99 offset0:72 offset1:108
s_waitcnt lgkmcnt(0)
s_barrier
s_cmp_lg_u32 s24, 0
s_cbranch_scc1 mega_kernel_rf_x1
ds_read_b128 v[120:123], v19 offset:0
ds_read_b128 v[124:127], v19 offset:1152
ds_read_b128 v[128:131], v19 offset:2304
ds_read_b128 v[132:135], v19 offset:3456
s_waitcnt lgkmcnt(2)
v_pk_add_f32 v[120:121], v[120:121], v[124:125]
v_pk_add_f32 v[122:123], v[122:123], v[126:127]
s_waitcnt lgkmcnt(0)
v_pk_add_f32 v[128:129], v[128:129], v[132:133]
v_pk_add_f32 v[130:131], v[130:131], v[134:135]
v_pk_add_f32 v[120:121], v[120:121], v[128:129]
v_pk_add_f32 v[122:123], v[122:123], v[130:131]
v_and_or_b32 v120, v120, -2, s47
v_and_or_b32 v121, v121, -2, s47
v_and_or_b32 v122, v122, -2, s47
v_and_or_b32 v123, v123, -2, s47
buffer_store_dwordx4 v[120:123], v12, s[84:87], s35 offen sc1
s_xor_b32 s76, s47, 1
v_mov_b32 v48, s76
v_mov_b32 v49, s76
v_mov_b32 v50, s76
v_mov_b32 v51, s76
v_mov_b32 v52, s76
v_mov_b32 v53, s76
v_mov_b32 v54, s76
v_mov_b32 v55, s76
v_mov_b32 v56, s76
v_mov_b32 v57, s76
v_mov_b32 v58, s76
v_mov_b32 v59, s76
v_mov_b32 v96, 0
v_mov_b32 v97, 0
v_mov_b32 v98, 0
v_mov_b32 v99, 0
v_mov_b32 v100, 0
v_mov_b32 v101, 0
v_mov_b32 v102, 0
v_mov_b32 v103, 0
v_mov_b32 v104, 0
v_mov_b32 v105, 0
v_mov_b32 v106, 0
v_mov_b32 v107, 0
v_mov_b32 v108, 0
v_mov_b32 v109, 0
v_mov_b32 v110, 0
v_mov_b32 v111, 0
v_mov_b32 v112, 0
v_mov_b32 v113, 0
v_mov_b32 v114, 0
v_mov_b32 v115, 0
v_mov_b32 v116, 0
v_mov_b32 v117, 0
v_mov_b32 v118, 0
v_mov_b32 v119, 0
s_nop 15
s_cmp_eq_u32 s47, 1
s_cbranch_scc1 mega_kernel_rf_p4_1
mega_kernel_rf_p4_0:
buffer_load_dwordx4 v[48:51], v25, s[84:87], s35 offen sc1
buffer_load_dwordx4 v[52:55], v26, s[84:87], s35 offen sc1
buffer_load_dwordx4 v[56:59], v27, s[84:87], s35 offen sc1
s_waitcnt vmcnt(36)
s_nop 1
v_bitop3_b32 v4, v48, v49, v50 bitop3:0xfe
v_bitop3_b32 v5, v54, v55, v56 bitop3:0xfe
v_bitop3_b32 v4, v4, v51, v52 bitop3:0xfe
v_bitop3_b32 v5, v5, v57, v58 bitop3:0xfe
v_bitop3_b32 v4, v4, v53, v59 bitop3:0xfe
v_bitop3_b32 v4, v4, v5, 1 bitop3:0xa8
v_cmp_ne_u32 vcc, 0, v4
s_cbranch_vccnz mega_kernel_rf_p4_0
s_branch mega_kernel_rf_p4d
mega_kernel_rf_p4_1:
buffer_load_dwordx4 v[48:51], v25, s[84:87], s35 offen sc1
buffer_load_dwordx4 v[52:55], v26, s[84:87], s35 offen sc1
buffer_load_dwordx4 v[56:59], v27, s[84:87], s35 offen sc1
s_waitcnt vmcnt(36)
s_nop 1
v_bitop3_b32 v4, v48, v49, v50 bitop3:0x80
v_bitop3_b32 v5, v54, v55, v56 bitop3:0x80
v_bitop3_b32 v4, v4, v51, v52 bitop3:0x80
v_bitop3_b32 v5, v5, v57, v58 bitop3:0x80
v_bitop3_b32 v4, v4, v53, v59 bitop3:0x80
v_bitop3_b32 v4, v4, v5, 1 bitop3:0x80
v_cmp_ne_u32 vcc, 1, v4
s_cbranch_vccnz mega_kernel_rf_p4_1
mega_kernel_rf_p4d:
v_pk_add_f32 v[120:121], v[120:121], v[48:49]
v_pk_add_f32 v[124:125], v[52:53], v[56:57]
v_pk_add_f32 v[122:123], v[122:123], v[50:51]
v_pk_add_f32 v[126:127], v[54:55], v[58:59]
v_pk_add_f32 v[120:121], v[120:121], v[124:125]
v_pk_add_f32 v[122:123], v[122:123], v[126:127]
v_cvt_pk_bf16_f32 v212, v120, v121
v_cvt_pk_bf16_f32 v213, v122, v123
v_min_u32 v212, -2, v212
buffer_store_dwordx2 v[212:213], v9, s[84:87], s34 offen
mega_kernel_rf_b5:
s_add_u32 s27, s27, 1
s_add_u32 s44, s44, 4096
s_cmp_eq_u32 s44, 30720
s_cselect_b32 s44, 18432, s44
s_mov_b32 s28, s33
s_mov_b32 s33, s34
s_mov_b32 s34, s28
s_xor_b32 s35, s35, 262144
s_bfe_u32 s47, s27, 0x10001
s_barrier
s_nop 9
s_branch mega_kernel_rf_loop
mega_kernel_rf_x1:
s_cmp_eq_u32 s24, 1
s_cbranch_scc0 mega_kernel_rf_x2
s_add_u32 s76, s27, 1
v_mov_b32 v5, s76
s_mov_b64 exec, 1
buffer_store_dword v5, v228, s[84:87], s81 offen sc1
s_mov_b64 exec, -1
mega_kernel_rf_x2:
s_cmp_eq_u32 s24, 3
s_cbranch_scc0 mega_kernel_rf_x4
s_cmp_eq_u32 s36, 1
s_cbranch_scc0 mega_kernel_rf_x5
s_add_u32 s76, s27, 1
s_cmp_gt_i32 s46, s76
s_cbranch_scc1 mega_kernel_rf_pf1ok
mega_kernel_rf_pf1w:
buffer_load_dword v4, v24, s[84:87], 0 offen sc1
s_waitcnt vmcnt(0)
v_readlane_b32 s46, v4, 0
v_readlane_b32 s28, v4, 1
s_nop 1
s_min_i32 s46, s46, s28
s_cmp_gt_i32 s46, s76
s_cbranch_scc0 mega_kernel_rf_pf1w
mega_kernel_rf_pf1ok:
s_add_u32 s77, s76, s82
s_bfe_u32 s28, s77, 0x40002
s_lshl_b32 s28, s28, 14
s_and_b32 s77, s77, 3
s_lshl_b32 s77, s77, 11
s_add_u32 s28, s28, s77
s_add_u32 m0, s45, 0
s_nop 0
buffer_load_dwordx4 v240, s[84:87], s28 offen offset:0 sc1 lds
s_add_u32 m0, s45, 0
s_nop 0
buffer_load_dwordx4 v240, s[84:87], s28 offen offset:1024 sc1 lds
s_add_u32 m0, s45, 2048
s_nop 0
buffer_load_dwordx4 v241, s[84:87], s28 offen offset:0 sc1 lds
s_add_u32 m0, s45, 2048
s_nop 0
buffer_load_dwordx4 v241, s[84:87], s28 offen offset:1024 sc1 lds
s_add_u32 s45, s45, 4096
s_cmp_eq_u32 s45, 30720
s_cselect_b32 s45, 18432, s45
s_waitcnt vmcnt(0)
mega_kernel_rf_x5:
s_add_u32 s76, s27, 3
s_min_u32 s76, s76, 63
s_cmp_gt_i32 s46, s76
s_cbranch_scc1 mega_kernel_rf_pf2ok
mega_kernel_rf_pf2w:
buffer_load_dword v4, v24, s[84:87], 0 offen sc1
s_waitcnt vmcnt(0)
v_readlane_b32 s46, v4, 0
v_readlane_b32 s28, v4, 1
s_nop 1
s_min_i32 s46, s46, s28
s_cmp_gt_i32 s46, s76
s_cbranch_scc0 mega_kernel_rf_x6
mega_kernel_rf_pf2ok:
mega_kernel_rf_x6:
s_add_u32 s76, s27, 2
s_cmp_lt_u32 s76, 63
s_cbranch_scc0 mega_kernel_rf_x4
s_cmp_gt_i32 s46, s76
s_cbranch_scc0 mega_kernel_rf_x4
s_add_u32 s77, s76, s82
s_bfe_u32 s28, s77, 0x40002
s_lshl_b32 s28, s28, 14
s_and_b32 s77, s77, 3
s_lshl_b32 s77, s77, 11
s_add_u32 s28, s28, s77
s_add_u32 s28, s28, s83
s_add_u32 s28, s28, 33554432
s_buffer_load_dword s78, s[84:87], s28 offset:0
s_buffer_load_dword s78, s[84:87], s28 offset:128
s_buffer_load_dword s78, s[84:87], s28 offset:256
s_buffer_load_dword s78, s[84:87], s28 offset:384
s_buffer_load_dword s78, s[84:87], s28 offset:512
s_buffer_load_dword s78, s[84:87], s28 offset:640
s_buffer_load_dword s78, s[84:87], s28 offset:768
s_buffer_load_dword s78, s[84:87], s28 offset:896
s_buffer_load_dword s78, s[84:87], s28 offset:1024
s_buffer_load_dword s78, s[84:87], s28 offset:1152
s_buffer_load_dword s78, s[84:87], s28 offset:1280
s_buffer_load_dword s78, s[84:87], s28 offset:1408
s_buffer_load_dword s78, s[84:87], s28 offset:1536
s_buffer_load_dword s78, s[84:87], s28 offset:1664
s_buffer_load_dword s78, s[84:87], s28 offset:1792
s_buffer_load_dword s78, s[84:87], s28 offset:1920
mega_kernel_rf_x4:
v_mov_b32 v96, 0
v_mov_b32 v97, 0
v_mov_b32 v98, 0
v_mov_b32 v99, 0
v_mov_b32 v100, 0
v_mov_b32 v101, 0
v_mov_b32 v102, 0
v_mov_b32 v103, 0
v_mov_b32 v104, 0
v_mov_b32 v105, 0
v_mov_b32 v106, 0
v_mov_b32 v107, 0
v_mov_b32 v108, 0
v_mov_b32 v109, 0
v_mov_b32 v110, 0
v_mov_b32 v111, 0
v_mov_b32 v112, 0
v_mov_b32 v113, 0
v_mov_b32 v114, 0
v_mov_b32 v115, 0
v_mov_b32 v116, 0
v_mov_b32 v117, 0
v_mov_b32 v118, 0
v_mov_b32 v119, 0
s_branch mega_kernel_rf_b5
mega_kernel_rf_p2r:
buffer_load_dwordx4 v[184:187], v17, s[84:87], s76 offen sc1
buffer_load_dwordx4 v[188:191], v10, s[84:87], s76 offen sc1
buffer_load_dwordx4 v[192:195], v17, s[84:87], s77 offen sc1
buffer_load_dwordx4 v[196:199], v10, s[84:87], s77 offen sc1
buffer_load_dwordx4 v[200:203], v17, s[84:87], s78 offen sc1
buffer_load_dwordx4 v[204:207], v10, s[84:87], s78 offen sc1
s_branch mega_kernel_rf_p2
mega_kernel_rf_pa_1_0f:
s_mov_b64 exec, vcc
buffer_load_dwordx4 v[32:35], v7, s[84:87], s33 offen offset:0 sc1
s_mov_b64 exec, -1
s_branch mega_kernel_rf_pa_1_0
mega_kernel_rf_pa_1_0:
s_waitcnt vmcnt(0)
v_max_u32 v4, v32, v34
v_cmp_eq_u32 vcc, -1, v4
s_cbranch_vccnz mega_kernel_rf_pa_1_0f
v_smfmac_f32_16x16x64_bf16 v[96:99], v[32:35], a[0:7], v6
v_smfmac_f32_16x16x64_bf16 v[100:103], v[32:35], a[32:39], v6
v_smfmac_f32_16x16x64_bf16 v[104:107], v[32:35], a[64:71], v6
v_smfmac_f32_16x16x64_bf16 v[108:111], v[32:35], a[96:103], v6
s_branch mega_kernel_rf_pa_d
mega_kernel_rf_pa_2_1f:
s_mov_b64 exec, vcc
buffer_load_dwordx4 v[36:39], v7, s[84:87], s33 offen offset:1024 sc1
s_mov_b64 exec, -1
s_branch mega_kernel_rf_pa_2_1
mega_kernel_rf_pa_2_1:
s_waitcnt vmcnt(0)
v_max_u32 v4, v36, v38
v_cmp_eq_u32 vcc, -1, v4
s_cbranch_vccnz mega_kernel_rf_pa_2_1f
v_smfmac_f32_16x16x64_bf16 v[96:99], v[36:39], a[8:15], v6
v_smfmac_f32_16x16x64_bf16 v[100:103], v[36:39], a[40:47], v6
v_smfmac_f32_16x16x64_bf16 v[104:107], v[36:39], a[72:79], v6
v_smfmac_f32_16x16x64_bf16 v[108:111], v[36:39], a[104:111], v6
s_branch mega_kernel_rf_pa_d
mega_kernel_rf_pa_3_0f:
s_mov_b64 exec, vcc
buffer_load_dwordx4 v[32:35], v7, s[84:87], s33 offen offset:0 sc1
s_mov_b64 exec, -1
s_branch mega_kernel_rf_pa_3_1
mega_kernel_rf_pa_3_0:
s_waitcnt vmcnt(1)
v_max_u32 v4, v32, v34
v_cmp_eq_u32 vcc, -1, v4
s_cbranch_vccnz mega_kernel_rf_pa_3_0f
v_smfmac_f32_16x16x64_bf16 v[96:99], v[32:35], a[0:7], v6
v_smfmac_f32_16x16x64_bf16 v[100:103], v[32:35], a[32:39], v6
v_smfmac_f32_16x16x64_bf16 v[104:107], v[32:35], a[64:71], v6
v_smfmac_f32_16x16x64_bf16 v[108:111], v[32:35], a[96:103], v6
s_branch mega_kernel_rf_pa_2_1
mega_kernel_rf_pa_3_1f:
s_mov_b64 exec, vcc
buffer_load_dwordx4 v[36:39], v7, s[84:87], s33 offen offset:1024 sc1
s_mov_b64 exec, -1
s_branch mega_kernel_rf_pa_3_0
mega_kernel_rf_pa_3_1:
s_waitcnt vmcnt(1)
v_max_u32 v4, v36, v38
v_cmp_eq_u32 vcc, -1, v4
s_cbranch_vccnz mega_kernel_rf_pa_3_1f
v_smfmac_f32_16x16x64_bf16 v[96:99], v[36:39], a[8:15], v6
v_smfmac_f32_16x16x64_bf16 v[100:103], v[36:39], a[40:47], v6
v_smfmac_f32_16x16x64_bf16 v[104:107], v[36:39], a[72:79], v6
v_smfmac_f32_16x16x64_bf16 v[108:111], v[36:39], a[104:111], v6
s_branch mega_kernel_rf_pa_1_0
mega_kernel_rf_pa_4_2f:
s_mov_b64 exec, vcc
buffer_load_dwordx4 v[40:43], v7, s[84:87], s33 offen offset:2048 sc1
s_mov_b64 exec, -1
s_branch mega_kernel_rf_pa_4_2
mega_kernel_rf_pa_4_2:
s_waitcnt vmcnt(0)
v_max_u32 v4, v40, v42
v_cmp_eq_u32 vcc, -1, v4
s_cbranch_vccnz mega_kernel_rf_pa_4_2f
v_smfmac_f32_16x16x64_bf16 v[96:99], v[40:43], a[16:23], v6
v_smfmac_f32_16x16x64_bf16 v[100:103], v[40:43], a[48:55], v6
v_smfmac_f32_16x16x64_bf16 v[104:107], v[40:43], a[80:87], v6
v_smfmac_f32_16x16x64_bf16 v[108:111], v[40:43], a[112:119], v6
s_branch mega_kernel_rf_pa_d
mega_kernel_rf_pa_5_0f:
s_mov_b64 exec, vcc
buffer_load_dwordx4 v[32:35], v7, s[84:87], s33 offen offset:0 sc1
s_mov_b64 exec, -1
s_branch mega_kernel_rf_pa_5_2
mega_kernel_rf_pa_5_0:
s_waitcnt vmcnt(1)
v_max_u32 v4, v32, v34
v_cmp_eq_u32 vcc, -1, v4
s_cbranch_vccnz mega_kernel_rf_pa_5_0f
v_smfmac_f32_16x16x64_bf16 v[96:99], v[32:35], a[0:7], v6
v_smfmac_f32_16x16x64_bf16 v[100:103], v[32:35], a[32:39], v6
v_smfmac_f32_16x16x64_bf16 v[104:107], v[32:35], a[64:71], v6
v_smfmac_f32_16x16x64_bf16 v[108:111], v[32:35], a[96:103], v6
s_branch mega_kernel_rf_pa_4_2
mega_kernel_rf_pa_5_2f:
s_mov_b64 exec, vcc
buffer_load_dwordx4 v[40:43], v7, s[84:87], s33 offen offset:2048 sc1
s_mov_b64 exec, -1
s_branch mega_kernel_rf_pa_5_0
mega_kernel_rf_pa_5_2:
s_waitcnt vmcnt(1)
v_max_u32 v4, v40, v42
v_cmp_eq_u32 vcc, -1, v4
s_cbranch_vccnz mega_kernel_rf_pa_5_2f
v_smfmac_f32_16x16x64_bf16 v[96:99], v[40:43], a[16:23], v6
v_smfmac_f32_16x16x64_bf16 v[100:103], v[40:43], a[48:55], v6
v_smfmac_f32_16x16x64_bf16 v[104:107], v[40:43], a[80:87], v6
v_smfmac_f32_16x16x64_bf16 v[108:111], v[40:43], a[112:119], v6
s_branch mega_kernel_rf_pa_1_0
mega_kernel_rf_pa_6_1f:
s_mov_b64 exec, vcc
buffer_load_dwordx4 v[36:39], v7, s[84:87], s33 offen offset:1024 sc1
s_mov_b64 exec, -1
s_branch mega_kernel_rf_pa_6_2
mega_kernel_rf_pa_6_1:
s_waitcnt vmcnt(1)
v_max_u32 v4, v36, v38
v_cmp_eq_u32 vcc, -1, v4
s_cbranch_vccnz mega_kernel_rf_pa_6_1f
v_smfmac_f32_16x16x64_bf16 v[96:99], v[36:39], a[8:15], v6
v_smfmac_f32_16x16x64_bf16 v[100:103], v[36:39], a[40:47], v6
v_smfmac_f32_16x16x64_bf16 v[104:107], v[36:39], a[72:79], v6
v_smfmac_f32_16x16x64_bf16 v[108:111], v[36:39], a[104:111], v6
s_branch mega_kernel_rf_pa_4_2
mega_kernel_rf_pa_6_2f:
s_mov_b64 exec, vcc
buffer_load_dwordx4 v[40:43], v7, s[84:87], s33 offen offset:2048 sc1
s_mov_b64 exec, -1
s_branch mega_kernel_rf_pa_6_1
mega_kernel_rf_pa_6_2:
s_waitcnt vmcnt(1)
v_max_u32 v4, v40, v42
v_cmp_eq_u32 vcc, -1, v4
s_cbranch_vccnz mega_kernel_rf_pa_6_2f
v_smfmac_f32_16x16x64_bf16 v[96:99], v[40:43], a[16:23], v6
v_smfmac_f32_16x16x64_bf16 v[100:103], v[40:43], a[48:55], v6
v_smfmac_f32_16x16x64_bf16 v[104:107], v[40:43], a[80:87], v6
v_smfmac_f32_16x16x64_bf16 v[108:111], v[40:43], a[112:119], v6
s_branch mega_kernel_rf_pa_2_1
mega_kernel_rf_pa_7_0f:
s_mov_b64 exec, vcc
buffer_load_dwordx4 v[32:35], v7, s[84:87], s33 offen offset:0 sc1
s_mov_b64 exec, -1
s_branch mega_kernel_rf_pa_7_1
mega_kernel_rf_pa_7_0:
s_waitcnt vmcnt(2)
v_max_u32 v4, v32, v34
v_cmp_eq_u32 vcc, -1, v4
s_cbranch_vccnz mega_kernel_rf_pa_7_0f
v_smfmac_f32_16x16x64_bf16 v[96:99], v[32:35], a[0:7], v6
v_smfmac_f32_16x16x64_bf16 v[100:103], v[32:35], a[32:39], v6
v_smfmac_f32_16x16x64_bf16 v[104:107], v[32:35], a[64:71], v6
v_smfmac_f32_16x16x64_bf16 v[108:111], v[32:35], a[96:103], v6
s_branch mega_kernel_rf_pa_6_1
mega_kernel_rf_pa_7_1f:
s_mov_b64 exec, vcc
buffer_load_dwordx4 v[36:39], v7, s[84:87], s33 offen offset:1024 sc1
s_mov_b64 exec, -1
s_branch mega_kernel_rf_pa_7_2
mega_kernel_rf_pa_7_1:
s_waitcnt vmcnt(2)
v_max_u32 v4, v36, v38
v_cmp_eq_u32 vcc, -1, v4
s_cbranch_vccnz mega_kernel_rf_pa_7_1f
v_smfmac_f32_16x16x64_bf16 v[96:99], v[36:39], a[8:15], v6
v_smfmac_f32_16x16x64_bf16 v[100:103], v[36:39], a[40:47], v6
v_smfmac_f32_16x16x64_bf16 v[104:107], v[36:39], a[72:79], v6
v_smfmac_f32_16x16x64_bf16 v[108:111], v[36:39], a[104:111], v6
s_branch mega_kernel_rf_pa_5_2
mega_kernel_rf_pa_7_2f:
s_mov_b64 exec, vcc
buffer_load_dwordx4 v[40:43], v7, s[84:87], s33 offen offset:2048 sc1
s_mov_b64 exec, -1
s_branch mega_kernel_rf_pa_7_0
mega_kernel_rf_pa_7_2:
s_waitcnt vmcnt(2)
v_max_u32 v4, v40, v42
v_cmp_eq_u32 vcc, -1, v4
s_cbranch_vccnz mega_kernel_rf_pa_7_2f
v_smfmac_f32_16x16x64_bf16 v[96:99], v[40:43], a[16:23], v6
v_smfmac_f32_16x16x64_bf16 v[100:103], v[40:43], a[48:55], v6
v_smfmac_f32_16x16x64_bf16 v[104:107], v[40:43], a[80:87], v6
v_smfmac_f32_16x16x64_bf16 v[108:111], v[40:43], a[112:119], v6
s_branch mega_kernel_rf_pa_3_0
mega_kernel_rf_pa_8_3f:
s_mov_b64 exec, vcc
buffer_load_dwordx4 v[44:47], v7, s[84:87], s33 offen offset:3072 sc1
s_mov_b64 exec, -1
s_branch mega_kernel_rf_pa_8_3
mega_kernel_rf_pa_8_3:
s_waitcnt vmcnt(0)
v_max_u32 v4, v44, v46
v_cmp_eq_u32 vcc, -1, v4
s_cbranch_vccnz mega_kernel_rf_pa_8_3f
v_smfmac_f32_16x16x64_bf16 v[96:99], v[44:47], a[24:31], v6
v_smfmac_f32_16x16x64_bf16 v[100:103], v[44:47], a[56:63], v6
v_smfmac_f32_16x16x64_bf16 v[104:107], v[44:47], a[88:95], v6
v_smfmac_f32_16x16x64_bf16 v[108:111], v[44:47], a[120:127], v6
s_branch mega_kernel_rf_pa_d
mega_kernel_rf_pa_9_0f:
s_mov_b64 exec, vcc
buffer_load_dwordx4 v[32:35], v7, s[84:87], s33 offen offset:0 sc1
s_mov_b64 exec, -1
s_branch mega_kernel_rf_pa_9_3
mega_kernel_rf_pa_9_0:
s_waitcnt vmcnt(1)
v_max_u32 v4, v32, v34
v_cmp_eq_u32 vcc, -1, v4
s_cbranch_vccnz mega_kernel_rf_pa_9_0f
v_smfmac_f32_16x16x64_bf16 v[96:99], v[32:35], a[0:7], v6
v_smfmac_f32_16x16x64_bf16 v[100:103], v[32:35], a[32:39], v6
v_smfmac_f32_16x16x64_bf16 v[104:107], v[32:35], a[64:71], v6
v_smfmac_f32_16x16x64_bf16 v[108:111], v[32:35], a[96:103], v6
s_branch mega_kernel_rf_pa_8_3
mega_kernel_rf_pa_9_3f:
s_mov_b64 exec, vcc
buffer_load_dwordx4 v[44:47], v7, s[84:87], s33 offen offset:3072 sc1
s_mov_b64 exec, -1
s_branch mega_kernel_rf_pa_9_0
mega_kernel_rf_pa_9_3:
s_waitcnt vmcnt(1)
v_max_u32 v4, v44, v46
v_cmp_eq_u32 vcc, -1, v4
s_cbranch_vccnz mega_kernel_rf_pa_9_3f
v_smfmac_f32_16x16x64_bf16 v[96:99], v[44:47], a[24:31], v6
v_smfmac_f32_16x16x64_bf16 v[100:103], v[44:47], a[56:63], v6
v_smfmac_f32_16x16x64_bf16 v[104:107], v[44:47], a[88:95], v6
v_smfmac_f32_16x16x64_bf16 v[108:111], v[44:47], a[120:127], v6
s_branch mega_kernel_rf_pa_1_0
mega_kernel_rf_pa_10_1f:
s_mov_b64 exec, vcc
buffer_load_dwordx4 v[36:39], v7, s[84:87], s33 offen offset:1024 sc1
s_mov_b64 exec, -1
s_branch mega_kernel_rf_pa_10_3
mega_kernel_rf_pa_10_1:
s_waitcnt vmcnt(1)
v_max_u32 v4, v36, v38
v_cmp_eq_u32 vcc, -1, v4
s_cbranch_vccnz mega_kernel_rf_pa_10_1f
v_smfmac_f32_16x16x64_bf16 v[96:99], v[36:39], a[8:15], v6
v_smfmac_f32_16x16x64_bf16 v[100:103], v[36:39], a[40:47], v6
v_smfmac_f32_16x16x64_bf16 v[104:107], v[36:39], a[72:79], v6
v_smfmac_f32_16x16x64_bf16 v[108:111], v[36:39], a[104:111], v6
s_branch mega_kernel_rf_pa_8_3
mega_kernel_rf_pa_10_3f:
s_mov_b64 exec, vcc
buffer_load_dwordx4 v[44:47], v7, s[84:87], s33 offen offset:3072 sc1
s_mov_b64 exec, -1
s_branch mega_kernel_rf_pa_10_1
mega_kernel_rf_pa_10_3:
s_waitcnt vmcnt(1)
v_max_u32 v4, v44, v46
v_cmp_eq_u32 vcc, -1, v4
s_cbranch_vccnz mega_kernel_rf_pa_10_3f
v_smfmac_f32_16x16x64_bf16 v[96:99], v[44:47], a[24:31], v6
v_smfmac_f32_16x16x64_bf16 v[100:103], v[44:47], a[56:63], v6
v_smfmac_f32_16x16x64_bf16 v[104:107], v[44:47], a[88:95], v6
v_smfmac_f32_16x16x64_bf16 v[108:111], v[44:47], a[120:127], v6
s_branch mega_kernel_rf_pa_2_1
mega_kernel_rf_pa_11_0f:
s_mov_b64 exec, vcc
buffer_load_dwordx4 v[32:35], v7, s[84:87], s33 offen offset:0 sc1
s_mov_b64 exec, -1
s_branch mega_kernel_rf_pa_11_1
mega_kernel_rf_pa_11_0:
s_waitcnt vmcnt(2)
v_max_u32 v4, v32, v34
v_cmp_eq_u32 vcc, -1, v4
s_cbranch_vccnz mega_kernel_rf_pa_11_0f
v_smfmac_f32_16x16x64_bf16 v[96:99], v[32:35], a[0:7], v6
v_smfmac_f32_16x16x64_bf16 v[100:103], v[32:35], a[32:39], v6
v_smfmac_f32_16x16x64_bf16 v[104:107], v[32:35], a[64:71], v6
v_smfmac_f32_16x16x64_bf16 v[108:111], v[32:35], a[96:103], v6
s_branch mega_kernel_rf_pa_10_1
mega_kernel_rf_pa_11_1f:
s_mov_b64 exec, vcc
buffer_load_dwordx4 v[36:39], v7, s[84:87], s33 offen offset:1024 sc1
s_mov_b64 exec, -1
s_branch mega_kernel_rf_pa_11_3
mega_kernel_rf_pa_11_1:
s_waitcnt vmcnt(2)
v_max_u32 v4, v36, v38
v_cmp_eq_u32 vcc, -1, v4
s_cbranch_vccnz mega_kernel_rf_pa_11_1f
v_smfmac_f32_16x16x64_bf16 v[96:99], v[36:39], a[8:15], v6
v_smfmac_f32_16x16x64_bf16 v[100:103], v[36:39], a[40:47], v6
v_smfmac_f32_16x16x64_bf16 v[104:107], v[36:39], a[72:79], v6
v_smfmac_f32_16x16x64_bf16 v[108:111], v[36:39], a[104:111], v6
s_branch mega_kernel_rf_pa_9_3
mega_kernel_rf_pa_11_3f:
s_mov_b64 exec, vcc
buffer_load_dwordx4 v[44:47], v7, s[84:87], s33 offen offset:3072 sc1
s_mov_b64 exec, -1
s_branch mega_kernel_rf_pa_11_0
mega_kernel_rf_pa_11_3:
s_waitcnt vmcnt(2)
v_max_u32 v4, v44, v46
v_cmp_eq_u32 vcc, -1, v4
s_cbranch_vccnz mega_kernel_rf_pa_11_3f
v_smfmac_f32_16x16x64_bf16 v[96:99], v[44:47], a[24:31], v6
v_smfmac_f32_16x16x64_bf16 v[100:103], v[44:47], a[56:63], v6
v_smfmac_f32_16x16x64_bf16 v[104:107], v[44:47], a[88:95], v6
v_smfmac_f32_16x16x64_bf16 v[108:111], v[44:47], a[120:127], v6
s_branch mega_kernel_rf_pa_3_0
mega_kernel_rf_pa_12_2f:
s_mov_b64 exec, vcc
buffer_load_dwordx4 v[40:43], v7, s[84:87], s33 offen offset:2048 sc1
s_mov_b64 exec, -1
s_branch mega_kernel_rf_pa_12_3
mega_kernel_rf_pa_12_2:
s_waitcnt vmcnt(1)
v_max_u32 v4, v40, v42
v_cmp_eq_u32 vcc, -1, v4
s_cbranch_vccnz mega_kernel_rf_pa_12_2f
v_smfmac_f32_16x16x64_bf16 v[96:99], v[40:43], a[16:23], v6
v_smfmac_f32_16x16x64_bf16 v[100:103], v[40:43], a[48:55], v6
v_smfmac_f32_16x16x64_bf16 v[104:107], v[40:43], a[80:87], v6
v_smfmac_f32_16x16x64_bf16 v[108:111], v[40:43], a[112:119], v6
s_branch mega_kernel_rf_pa_8_3
mega_kernel_rf_pa_12_3f:
s_mov_b64 exec, vcc
buffer_load_dwordx4 v[44:47], v7, s[84:87], s33 offen offset:3072 sc1
s_mov_b64 exec, -1
s_branch mega_kernel_rf_pa_12_2
mega_kernel_rf_pa_12_3:
s_waitcnt vmcnt(1)
v_max_u32 v4, v44, v46
v_cmp_eq_u32 vcc, -1, v4
s_cbranch_vccnz mega_kernel_rf_pa_12_3f
v_smfmac_f32_16x16x64_bf16 v[96:99], v[44:47], a[24:31], v6
v_smfmac_f32_16x16x64_bf16 v[100:103], v[44:47], a[56:63], v6
v_smfmac_f32_16x16x64_bf16 v[104:107], v[44:47], a[88:95], v6
v_smfmac_f32_16x16x64_bf16 v[108:111], v[44:47], a[120:127], v6
s_branch mega_kernel_rf_pa_4_2
mega_kernel_rf_pa_13_0f:
s_mov_b64 exec, vcc
buffer_load_dwordx4 v[32:35], v7, s[84:87], s33 offen offset:0 sc1
s_mov_b64 exec, -1
s_branch mega_kernel_rf_pa_13_2
mega_kernel_rf_pa_13_0:
s_waitcnt vmcnt(2)
v_max_u32 v4, v32, v34
v_cmp_eq_u32 vcc, -1, v4
s_cbranch_vccnz mega_kernel_rf_pa_13_0f
v_smfmac_f32_16x16x64_bf16 v[96:99], v[32:35], a[0:7], v6
v_smfmac_f32_16x16x64_bf16 v[100:103], v[32:35], a[32:39], v6
v_smfmac_f32_16x16x64_bf16 v[104:107], v[32:35], a[64:71], v6
v_smfmac_f32_16x16x64_bf16 v[108:111], v[32:35], a[96:103], v6
s_branch mega_kernel_rf_pa_12_2
mega_kernel_rf_pa_13_2f:
s_mov_b64 exec, vcc
buffer_load_dwordx4 v[40:43], v7, s[84:87], s33 offen offset:2048 sc1
s_mov_b64 exec, -1
s_branch mega_kernel_rf_pa_13_3
mega_kernel_rf_pa_13_2:
s_waitcnt vmcnt(2)
v_max_u32 v4, v40, v42
v_cmp_eq_u32 vcc, -1, v4
s_cbranch_vccnz mega_kernel_rf_pa_13_2f
v_smfmac_f32_16x16x64_bf16 v[96:99], v[40:43], a[16:23], v6
v_smfmac_f32_16x16x64_bf16 v[100:103], v[40:43], a[48:55], v6
v_smfmac_f32_16x16x64_bf16 v[104:107], v[40:43], a[80:87], v6
v_smfmac_f32_16x16x64_bf16 v[108:111], v[40:43], a[112:119], v6
s_branch mega_kernel_rf_pa_9_3
mega_kernel_rf_pa_13_3f:
s_mov_b64 exec, vcc
buffer_load_dwordx4 v[44:47], v7, s[84:87], s33 offen offset:3072 sc1
s_mov_b64 exec, -1
s_branch mega_kernel_rf_pa_13_0
mega_kernel_rf_pa_13_3:
s_waitcnt vmcnt(2)
v_max_u32 v4, v44, v46
v_cmp_eq_u32 vcc, -1, v4
s_cbranch_vccnz mega_kernel_rf_pa_13_3f
v_smfmac_f32_16x16x64_bf16 v[96:99], v[44:47], a[24:31], v6
v_smfmac_f32_16x16x64_bf16 v[100:103], v[44:47], a[56:63], v6
v_smfmac_f32_16x16x64_bf16 v[104:107], v[44:47], a[88:95], v6
v_smfmac_f32_16x16x64_bf16 v[108:111], v[44:47], a[120:127], v6
s_branch mega_kernel_rf_pa_5_0
mega_kernel_rf_pa_14_1f:
s_mov_b64 exec, vcc
buffer_load_dwordx4 v[36:39], v7, s[84:87], s33 offen offset:1024 sc1
s_mov_b64 exec, -1
s_branch mega_kernel_rf_pa_14_2
mega_kernel_rf_pa_14_1:
s_waitcnt vmcnt(2)
v_max_u32 v4, v36, v38
v_cmp_eq_u32 vcc, -1, v4
s_cbranch_vccnz mega_kernel_rf_pa_14_1f
v_smfmac_f32_16x16x64_bf16 v[96:99], v[36:39], a[8:15], v6
v_smfmac_f32_16x16x64_bf16 v[100:103], v[36:39], a[40:47], v6
v_smfmac_f32_16x16x64_bf16 v[104:107], v[36:39], a[72:79], v6
v_smfmac_f32_16x16x64_bf16 v[108:111], v[36:39], a[104:111], v6
s_branch mega_kernel_rf_pa_12_2
mega_kernel_rf_pa_14_2f:
s_mov_b64 exec, vcc
buffer_load_dwordx4 v[40:43], v7, s[84:87], s33 offen offset:2048 sc1
s_mov_b64 exec, -1
s_branch mega_kernel_rf_pa_14_3
mega_kernel_rf_pa_14_2:
s_waitcnt vmcnt(2)
v_max_u32 v4, v40, v42
v_cmp_eq_u32 vcc, -1, v4
s_cbranch_vccnz mega_kernel_rf_pa_14_2f
v_smfmac_f32_16x16x64_bf16 v[96:99], v[40:43], a[16:23], v6
v_smfmac_f32_16x16x64_bf16 v[100:103], v[40:43], a[48:55], v6
v_smfmac_f32_16x16x64_bf16 v[104:107], v[40:43], a[80:87], v6
v_smfmac_f32_16x16x64_bf16 v[108:111], v[40:43], a[112:119], v6
s_branch mega_kernel_rf_pa_10_3
mega_kernel_rf_pa_14_3f:
s_mov_b64 exec, vcc
buffer_load_dwordx4 v[44:47], v7, s[84:87], s33 offen offset:3072 sc1
s_mov_b64 exec, -1
s_branch mega_kernel_rf_pa_14_1
mega_kernel_rf_pa_14_3:
s_waitcnt vmcnt(2)
v_max_u32 v4, v44, v46
v_cmp_eq_u32 vcc, -1, v4
s_cbranch_vccnz mega_kernel_rf_pa_14_3f
v_smfmac_f32_16x16x64_bf16 v[96:99], v[44:47], a[24:31], v6
v_smfmac_f32_16x16x64_bf16 v[100:103], v[44:47], a[56:63], v6
v_smfmac_f32_16x16x64_bf16 v[104:107], v[44:47], a[88:95], v6
v_smfmac_f32_16x16x64_bf16 v[108:111], v[44:47], a[120:127], v6
s_branch mega_kernel_rf_pa_6_1
mega_kernel_rf_pa_15_0f:
s_mov_b64 exec, vcc
buffer_load_dwordx4 v[32:35], v7, s[84:87], s33 offen offset:0 sc1
s_mov_b64 exec, -1
s_branch mega_kernel_rf_pa_15_1
mega_kernel_rf_pa_15_0:
s_waitcnt vmcnt(3)
v_max_u32 v4, v32, v34
v_cmp_eq_u32 vcc, -1, v4
s_cbranch_vccnz mega_kernel_rf_pa_15_0f
v_smfmac_f32_16x16x64_bf16 v[96:99], v[32:35], a[0:7], v6
v_smfmac_f32_16x16x64_bf16 v[100:103], v[32:35], a[32:39], v6
v_smfmac_f32_16x16x64_bf16 v[104:107], v[32:35], a[64:71], v6
v_smfmac_f32_16x16x64_bf16 v[108:111], v[32:35], a[96:103], v6
s_branch mega_kernel_rf_pa_14_1
mega_kernel_rf_pa_15_1f:
s_mov_b64 exec, vcc
buffer_load_dwordx4 v[36:39], v7, s[84:87], s33 offen offset:1024 sc1
s_mov_b64 exec, -1
s_branch mega_kernel_rf_pa_15_2
mega_kernel_rf_pa_15_1:
s_waitcnt vmcnt(3)
v_max_u32 v4, v36, v38
v_cmp_eq_u32 vcc, -1, v4
s_cbranch_vccnz mega_kernel_rf_pa_15_1f
v_smfmac_f32_16x16x64_bf16 v[96:99], v[36:39], a[8:15], v6
v_smfmac_f32_16x16x64_bf16 v[100:103], v[36:39], a[40:47], v6
v_smfmac_f32_16x16x64_bf16 v[104:107], v[36:39], a[72:79], v6
v_smfmac_f32_16x16x64_bf16 v[108:111], v[36:39], a[104:111], v6
s_branch mega_kernel_rf_pa_13_2
mega_kernel_rf_pa_15_2f:
s_mov_b64 exec, vcc
buffer_load_dwordx4 v[40:43], v7, s[84:87], s33 offen offset:2048 sc1
s_mov_b64 exec, -1
s_branch mega_kernel_rf_pa_15_3
mega_kernel_rf_pa_15_2:
s_waitcnt vmcnt(3)
v_max_u32 v4, v40, v42
v_cmp_eq_u32 vcc, -1, v4
s_cbranch_vccnz mega_kernel_rf_pa_15_2f
v_smfmac_f32_16x16x64_bf16 v[96:99], v[40:43], a[16:23], v6
v_smfmac_f32_16x16x64_bf16 v[100:103], v[40:43], a[48:55], v6
v_smfmac_f32_16x16x64_bf16 v[104:107], v[40:43], a[80:87], v6
v_smfmac_f32_16x16x64_bf16 v[108:111], v[40:43], a[112:119], v6
s_branch mega_kernel_rf_pa_11_3
mega_kernel_rf_pa_15_3f:
s_mov_b64 exec, vcc
buffer_load_dwordx4 v[44:47], v7, s[84:87], s33 offen offset:3072 sc1
s_mov_b64 exec, -1
s_branch mega_kernel_rf_pa_15_0
mega_kernel_rf_pa_15_3:
s_waitcnt vmcnt(3)
v_max_u32 v4, v44, v46
v_cmp_eq_u32 vcc, -1, v4
s_cbranch_vccnz mega_kernel_rf_pa_15_3f
v_smfmac_f32_16x16x64_bf16 v[96:99], v[44:47], a[24:31], v6
v_smfmac_f32_16x16x64_bf16 v[100:103], v[44:47], a[56:63], v6
v_smfmac_f32_16x16x64_bf16 v[104:107], v[44:47], a[88:95], v6
v_smfmac_f32_16x16x64_bf16 v[108:111], v[44:47], a[120:127], v6
s_branch mega_kernel_rf_pa_7_0
mega_kernel_rf_pc_1_0f:
s_mov_b64 exec, vcc
buffer_load_dwordx4 v[32:35], v7, s[84:87], s29 offen offset:0 sc1
s_mov_b64 exec, -1
s_branch mega_kernel_rf_pc_1_0
mega_kernel_rf_pc_1_0:
s_waitcnt vmcnt(0)
v_cmp_eq_u32 vcc, -1, v32
s_cbranch_vccnz mega_kernel_rf_pc_1_0f
v_smfmac_f32_16x16x64_bf16 v[96:99], v[32:35], a[192:199], v6
v_smfmac_f32_16x16x64_bf16 v[100:103], v[32:35], a[224:231], v6
s_branch mega_kernel_rf_pc_d
mega_kernel_rf_pc_2_1f:
s_mov_b64 exec, vcc
buffer_load_dwordx4 v[36:39], v7, s[84:87], s29 offen offset:1024 sc1
s_mov_b64 exec, -1
s_branch mega_kernel_rf_pc_2_1
mega_kernel_rf_pc_2_1:
s_waitcnt vmcnt(0)
v_cmp_eq_u32 vcc, -1, v36
s_cbranch_vccnz mega_kernel_rf_pc_2_1f
v_smfmac_f32_16x16x64_bf16 v[96:99], v[36:39], a[200:207], v6
v_smfmac_f32_16x16x64_bf16 v[100:103], v[36:39], a[232:239], v6
s_branch mega_kernel_rf_pc_d
mega_kernel_rf_pc_3_0f:
s_mov_b64 exec, vcc
buffer_load_dwordx4 v[32:35], v7, s[84:87], s29 offen offset:0 sc1
s_mov_b64 exec, -1
s_branch mega_kernel_rf_pc_3_1
mega_kernel_rf_pc_3_0:
s_waitcnt vmcnt(1)
v_cmp_eq_u32 vcc, -1, v32
s_cbranch_vccnz mega_kernel_rf_pc_3_0f
v_smfmac_f32_16x16x64_bf16 v[96:99], v[32:35], a[192:199], v6
v_smfmac_f32_16x16x64_bf16 v[100:103], v[32:35], a[224:231], v6
s_branch mega_kernel_rf_pc_2_1
mega_kernel_rf_pc_3_1f:
s_mov_b64 exec, vcc
buffer_load_dwordx4 v[36:39], v7, s[84:87], s29 offen offset:1024 sc1
s_mov_b64 exec, -1
s_branch mega_kernel_rf_pc_3_0
mega_kernel_rf_pc_3_1:
s_waitcnt vmcnt(1)
v_cmp_eq_u32 vcc, -1, v36
s_cbranch_vccnz mega_kernel_rf_pc_3_1f
v_smfmac_f32_16x16x64_bf16 v[96:99], v[36:39], a[200:207], v6
v_smfmac_f32_16x16x64_bf16 v[100:103], v[36:39], a[232:239], v6
s_branch mega_kernel_rf_pc_1_0
mega_kernel_rf_pc_4_2f:
s_mov_b64 exec, vcc
buffer_load_dwordx4 v[40:43], v7, s[84:87], s29 offen offset:2048 sc1
s_mov_b64 exec, -1
s_branch mega_kernel_rf_pc_4_2
mega_kernel_rf_pc_4_2:
s_waitcnt vmcnt(0)
v_cmp_eq_u32 vcc, -1, v40
s_cbranch_vccnz mega_kernel_rf_pc_4_2f
v_smfmac_f32_16x16x64_bf16 v[96:99], v[40:43], a[208:215], v6
v_smfmac_f32_16x16x64_bf16 v[100:103], v[40:43], a[240:247], v6
s_branch mega_kernel_rf_pc_d
mega_kernel_rf_pc_5_0f:
s_mov_b64 exec, vcc
buffer_load_dwordx4 v[32:35], v7, s[84:87], s29 offen offset:0 sc1
s_mov_b64 exec, -1
s_branch mega_kernel_rf_pc_5_2
mega_kernel_rf_pc_5_0:
s_waitcnt vmcnt(1)
v_cmp_eq_u32 vcc, -1, v32
s_cbranch_vccnz mega_kernel_rf_pc_5_0f
v_smfmac_f32_16x16x64_bf16 v[96:99], v[32:35], a[192:199], v6
v_smfmac_f32_16x16x64_bf16 v[100:103], v[32:35], a[224:231], v6
s_branch mega_kernel_rf_pc_4_2
mega_kernel_rf_pc_5_2f:
s_mov_b64 exec, vcc
buffer_load_dwordx4 v[40:43], v7, s[84:87], s29 offen offset:2048 sc1
s_mov_b64 exec, -1
s_branch mega_kernel_rf_pc_5_0
mega_kernel_rf_pc_5_2:
s_waitcnt vmcnt(1)
v_cmp_eq_u32 vcc, -1, v40
s_cbranch_vccnz mega_kernel_rf_pc_5_2f
v_smfmac_f32_16x16x64_bf16 v[96:99], v[40:43], a[208:215], v6
v_smfmac_f32_16x16x64_bf16 v[100:103], v[40:43], a[240:247], v6
s_branch mega_kernel_rf_pc_1_0
mega_kernel_rf_pc_6_1f:
s_mov_b64 exec, vcc
buffer_load_dwordx4 v[36:39], v7, s[84:87], s29 offen offset:1024 sc1
s_mov_b64 exec, -1
s_branch mega_kernel_rf_pc_6_2
mega_kernel_rf_pc_6_1:
s_waitcnt vmcnt(1)
v_cmp_eq_u32 vcc, -1, v36
s_cbranch_vccnz mega_kernel_rf_pc_6_1f
v_smfmac_f32_16x16x64_bf16 v[96:99], v[36:39], a[200:207], v6
v_smfmac_f32_16x16x64_bf16 v[100:103], v[36:39], a[232:239], v6
s_branch mega_kernel_rf_pc_4_2
mega_kernel_rf_pc_6_2f:
s_mov_b64 exec, vcc
buffer_load_dwordx4 v[40:43], v7, s[84:87], s29 offen offset:2048 sc1
s_mov_b64 exec, -1
s_branch mega_kernel_rf_pc_6_1
mega_kernel_rf_pc_6_2:
s_waitcnt vmcnt(1)
v_cmp_eq_u32 vcc, -1, v40
s_cbranch_vccnz mega_kernel_rf_pc_6_2f
v_smfmac_f32_16x16x64_bf16 v[96:99], v[40:43], a[208:215], v6
v_smfmac_f32_16x16x64_bf16 v[100:103], v[40:43], a[240:247], v6
s_branch mega_kernel_rf_pc_2_1
mega_kernel_rf_pc_7_0f:
s_mov_b64 exec, vcc
buffer_load_dwordx4 v[32:35], v7, s[84:87], s29 offen offset:0 sc1
s_mov_b64 exec, -1
s_branch mega_kernel_rf_pc_7_1
mega_kernel_rf_pc_7_0:
s_waitcnt vmcnt(2)
v_cmp_eq_u32 vcc, -1, v32
s_cbranch_vccnz mega_kernel_rf_pc_7_0f
v_smfmac_f32_16x16x64_bf16 v[96:99], v[32:35], a[192:199], v6
v_smfmac_f32_16x16x64_bf16 v[100:103], v[32:35], a[224:231], v6
s_branch mega_kernel_rf_pc_6_1
mega_kernel_rf_pc_7_1f:
s_mov_b64 exec, vcc
buffer_load_dwordx4 v[36:39], v7, s[84:87], s29 offen offset:1024 sc1
s_mov_b64 exec, -1
s_branch mega_kernel_rf_pc_7_2
mega_kernel_rf_pc_7_1:
s_waitcnt vmcnt(2)
v_cmp_eq_u32 vcc, -1, v36
s_cbranch_vccnz mega_kernel_rf_pc_7_1f
v_smfmac_f32_16x16x64_bf16 v[96:99], v[36:39], a[200:207], v6
v_smfmac_f32_16x16x64_bf16 v[100:103], v[36:39], a[232:239], v6
s_branch mega_kernel_rf_pc_5_2
mega_kernel_rf_pc_7_2f:
s_mov_b64 exec, vcc
buffer_load_dwordx4 v[40:43], v7, s[84:87], s29 offen offset:2048 sc1
s_mov_b64 exec, -1
s_branch mega_kernel_rf_pc_7_0
mega_kernel_rf_pc_7_2:
s_waitcnt vmcnt(2)
v_cmp_eq_u32 vcc, -1, v40
s_cbranch_vccnz mega_kernel_rf_pc_7_2f
v_smfmac_f32_16x16x64_bf16 v[96:99], v[40:43], a[208:215], v6
v_smfmac_f32_16x16x64_bf16 v[100:103], v[40:43], a[240:247], v6
s_branch mega_kernel_rf_pc_3_0
mega_kernel_rf_pc_8_3f:
s_mov_b64 exec, vcc
buffer_load_dwordx4 v[44:47], v7, s[84:87], s29 offen offset:3072 sc1
s_mov_b64 exec, -1
s_branch mega_kernel_rf_pc_8_3
mega_kernel_rf_pc_9_0f:
s_mov_b64 exec, vcc
buffer_load_dwordx4 v[32:35], v7, s[84:87], s29 offen offset:0 sc1
s_mov_b64 exec, -1
s_branch mega_kernel_rf_pc_9_3
mega_kernel_rf_pc_9_0:
s_waitcnt vmcnt(1)
v_cmp_eq_u32 vcc, -1, v32
s_cbranch_vccnz mega_kernel_rf_pc_9_0f
v_smfmac_f32_16x16x64_bf16 v[96:99], v[32:35], a[192:199], v6
v_smfmac_f32_16x16x64_bf16 v[100:103], v[32:35], a[224:231], v6
s_branch mega_kernel_rf_pc_8_3
mega_kernel_rf_pc_9_3f:
s_mov_b64 exec, vcc
buffer_load_dwordx4 v[44:47], v7, s[84:87], s29 offen offset:3072 sc1
s_mov_b64 exec, -1
s_branch mega_kernel_rf_pc_9_0
mega_kernel_rf_pc_9_3:
s_waitcnt vmcnt(1)
v_cmp_eq_u32 vcc, -1, v44
s_cbranch_vccnz mega_kernel_rf_pc_9_3f
v_smfmac_f32_16x16x64_bf16 v[96:99], v[44:47], a[216:223], v6
v_smfmac_f32_16x16x64_bf16 v[100:103], v[44:47], a[248:255], v6
s_branch mega_kernel_rf_pc_1_0
mega_kernel_rf_pc_10_1f:
s_mov_b64 exec, vcc
buffer_load_dwordx4 v[36:39], v7, s[84:87], s29 offen offset:1024 sc1
s_mov_b64 exec, -1
s_branch mega_kernel_rf_pc_10_3
mega_kernel_rf_pc_10_1:
s_waitcnt vmcnt(1)
v_cmp_eq_u32 vcc, -1, v36
s_cbranch_vccnz mega_kernel_rf_pc_10_1f
v_smfmac_f32_16x16x64_bf16 v[96:99], v[36:39], a[200:207], v6
v_smfmac_f32_16x16x64_bf16 v[100:103], v[36:39], a[232:239], v6
s_branch mega_kernel_rf_pc_8_3
mega_kernel_rf_pc_10_3f:
s_mov_b64 exec, vcc
buffer_load_dwordx4 v[44:47], v7, s[84:87], s29 offen offset:3072 sc1
s_mov_b64 exec, -1
s_branch mega_kernel_rf_pc_10_1
mega_kernel_rf_pc_10_3:
s_waitcnt vmcnt(1)
v_cmp_eq_u32 vcc, -1, v44
s_cbranch_vccnz mega_kernel_rf_pc_10_3f
v_smfmac_f32_16x16x64_bf16 v[96:99], v[44:47], a[216:223], v6
v_smfmac_f32_16x16x64_bf16 v[100:103], v[44:47], a[248:255], v6
s_branch mega_kernel_rf_pc_2_1
mega_kernel_rf_pc_11_0f:
s_mov_b64 exec, vcc
buffer_load_dwordx4 v[32:35], v7, s[84:87], s29 offen offset:0 sc1
s_mov_b64 exec, -1
s_branch mega_kernel_rf_pc_11_1
mega_kernel_rf_pc_11_0:
s_waitcnt vmcnt(2)
v_cmp_eq_u32 vcc, -1, v32
s_cbranch_vccnz mega_kernel_rf_pc_11_0f
v_smfmac_f32_16x16x64_bf16 v[96:99], v[32:35], a[192:199], v6
v_smfmac_f32_16x16x64_bf16 v[100:103], v[32:35], a[224:231], v6
s_branch mega_kernel_rf_pc_10_1
mega_kernel_rf_pc_11_1f:
s_mov_b64 exec, vcc
buffer_load_dwordx4 v[36:39], v7, s[84:87], s29 offen offset:1024 sc1
s_mov_b64 exec, -1
s_branch mega_kernel_rf_pc_11_3
mega_kernel_rf_pc_11_1:
s_waitcnt vmcnt(2)
v_cmp_eq_u32 vcc, -1, v36
s_cbranch_vccnz mega_kernel_rf_pc_11_1f
v_smfmac_f32_16x16x64_bf16 v[96:99], v[36:39], a[200:207], v6
v_smfmac_f32_16x16x64_bf16 v[100:103], v[36:39], a[232:239], v6
s_branch mega_kernel_rf_pc_9_3
mega_kernel_rf_pc_11_3f:
s_mov_b64 exec, vcc
buffer_load_dwordx4 v[44:47], v7, s[84:87], s29 offen offset:3072 sc1
s_mov_b64 exec, -1
s_branch mega_kernel_rf_pc_11_0
mega_kernel_rf_pc_11_3:
s_waitcnt vmcnt(2)
v_cmp_eq_u32 vcc, -1, v44
s_cbranch_vccnz mega_kernel_rf_pc_11_3f
v_smfmac_f32_16x16x64_bf16 v[96:99], v[44:47], a[216:223], v6
v_smfmac_f32_16x16x64_bf16 v[100:103], v[44:47], a[248:255], v6
s_branch mega_kernel_rf_pc_3_0
mega_kernel_rf_pc_12_2f:
s_mov_b64 exec, vcc
buffer_load_dwordx4 v[40:43], v7, s[84:87], s29 offen offset:2048 sc1
s_mov_b64 exec, -1
s_branch mega_kernel_rf_pc_12_3
mega_kernel_rf_pc_12_3f:
s_mov_b64 exec, vcc
buffer_load_dwordx4 v[44:47], v7, s[84:87], s29 offen offset:3072 sc1
s_mov_b64 exec, -1
s_branch mega_kernel_rf_pc_12_2
mega_kernel_rf_pc_12_3:
s_waitcnt vmcnt(1)
v_cmp_eq_u32 vcc, -1, v44
s_cbranch_vccnz mega_kernel_rf_pc_12_3f
v_smfmac_f32_16x16x64_bf16 v[96:99], v[44:47], a[216:223], v6
v_smfmac_f32_16x16x64_bf16 v[100:103], v[44:47], a[248:255], v6
s_branch mega_kernel_rf_pc_4_2
mega_kernel_rf_pc_13_0f:
s_mov_b64 exec, vcc
buffer_load_dwordx4 v[32:35], v7, s[84:87], s29 offen offset:0 sc1
s_mov_b64 exec, -1
s_branch mega_kernel_rf_pc_13_2
mega_kernel_rf_pc_13_0:
s_waitcnt vmcnt(2)
v_cmp_eq_u32 vcc, -1, v32
s_cbranch_vccnz mega_kernel_rf_pc_13_0f
v_smfmac_f32_16x16x64_bf16 v[96:99], v[32:35], a[192:199], v6
v_smfmac_f32_16x16x64_bf16 v[100:103], v[32:35], a[224:231], v6
s_branch mega_kernel_rf_pc_12_2
mega_kernel_rf_pc_13_2f:
s_mov_b64 exec, vcc
buffer_load_dwordx4 v[40:43], v7, s[84:87], s29 offen offset:2048 sc1
s_mov_b64 exec, -1
s_branch mega_kernel_rf_pc_13_3
mega_kernel_rf_pc_13_2:
s_waitcnt vmcnt(2)
v_cmp_eq_u32 vcc, -1, v40
s_cbranch_vccnz mega_kernel_rf_pc_13_2f
v_smfmac_f32_16x16x64_bf16 v[96:99], v[40:43], a[208:215], v6
v_smfmac_f32_16x16x64_bf16 v[100:103], v[40:43], a[240:247], v6
s_branch mega_kernel_rf_pc_9_3
mega_kernel_rf_pc_13_3f:
s_mov_b64 exec, vcc
buffer_load_dwordx4 v[44:47], v7, s[84:87], s29 offen offset:3072 sc1
s_mov_b64 exec, -1
s_branch mega_kernel_rf_pc_13_0
mega_kernel_rf_pc_13_3:
s_waitcnt vmcnt(2)
v_cmp_eq_u32 vcc, -1, v44
s_cbranch_vccnz mega_kernel_rf_pc_13_3f
v_smfmac_f32_16x16x64_bf16 v[96:99], v[44:47], a[216:223], v6
v_smfmac_f32_16x16x64_bf16 v[100:103], v[44:47], a[248:255], v6
s_branch mega_kernel_rf_pc_5_0
mega_kernel_rf_pc_14_1f:
s_mov_b64 exec, vcc
buffer_load_dwordx4 v[36:39], v7, s[84:87], s29 offen offset:1024 sc1
s_mov_b64 exec, -1
s_branch mega_kernel_rf_pc_14_2
mega_kernel_rf_pc_14_2f:
s_mov_b64 exec, vcc
buffer_load_dwordx4 v[40:43], v7, s[84:87], s29 offen offset:2048 sc1
s_mov_b64 exec, -1
s_branch mega_kernel_rf_pc_14_3
mega_kernel_rf_pc_14_2:
s_waitcnt vmcnt(2)
v_cmp_eq_u32 vcc, -1, v40
s_cbranch_vccnz mega_kernel_rf_pc_14_2f
v_smfmac_f32_16x16x64_bf16 v[96:99], v[40:43], a[208:215], v6
v_smfmac_f32_16x16x64_bf16 v[100:103], v[40:43], a[240:247], v6
s_branch mega_kernel_rf_pc_10_3
mega_kernel_rf_pc_14_3f:
s_mov_b64 exec, vcc
buffer_load_dwordx4 v[44:47], v7, s[84:87], s29 offen offset:3072 sc1
s_mov_b64 exec, -1
s_branch mega_kernel_rf_pc_14_1
mega_kernel_rf_pc_14_3:
s_waitcnt vmcnt(2)
v_cmp_eq_u32 vcc, -1, v44
s_cbranch_vccnz mega_kernel_rf_pc_14_3f
v_smfmac_f32_16x16x64_bf16 v[96:99], v[44:47], a[216:223], v6
v_smfmac_f32_16x16x64_bf16 v[100:103], v[44:47], a[248:255], v6
s_branch mega_kernel_rf_pc_6_1
mega_kernel_rf_pc_15_0f:
s_mov_b64 exec, vcc
buffer_load_dwordx4 v[32:35], v7, s[84:87], s29 offen offset:0 sc1
s_mov_b64 exec, -1
s_branch mega_kernel_rf_pc_15_1
mega_kernel_rf_pc_15_1f:
s_mov_b64 exec, vcc
buffer_load_dwordx4 v[36:39], v7, s[84:87], s29 offen offset:1024 sc1
s_mov_b64 exec, -1
s_branch mega_kernel_rf_pc_15_2
mega_kernel_rf_pc_15_1:
s_waitcnt vmcnt(3)
v_cmp_eq_u32 vcc, -1, v36
s_cbranch_vccnz mega_kernel_rf_pc_15_1f
v_smfmac_f32_16x16x64_bf16 v[96:99], v[36:39], a[200:207], v6
v_smfmac_f32_16x16x64_bf16 v[100:103], v[36:39], a[232:239], v6
s_branch mega_kernel_rf_pc_13_2
mega_kernel_rf_pc_15_2f:
s_mov_b64 exec, vcc
buffer_load_dwordx4 v[40:43], v7, s[84:87], s29 offen offset:2048 sc1
s_mov_b64 exec, -1
s_branch mega_kernel_rf_pc_15_3
mega_kernel_rf_pc_15_2:
s_waitcnt vmcnt(3)
v_cmp_eq_u32 vcc, -1, v40
s_cbranch_vccnz mega_kernel_rf_pc_15_2f
v_smfmac_f32_16x16x64_bf16 v[96:99], v[40:43], a[208:215], v6
v_smfmac_f32_16x16x64_bf16 v[100:103], v[40:43], a[240:247], v6
s_branch mega_kernel_rf_pc_11_3
mega_kernel_rf_pc_15_3f:
s_mov_b64 exec, vcc
buffer_load_dwordx4 v[44:47], v7, s[84:87], s29 offen offset:3072 sc1
s_mov_b64 exec, -1
s_branch mega_kernel_rf_pc_15_0
mega_kernel_rf_pc_15_3:
s_waitcnt vmcnt(3)
v_cmp_eq_u32 vcc, -1, v44
s_cbranch_vccnz mega_kernel_rf_pc_15_3f
v_smfmac_f32_16x16x64_bf16 v[96:99], v[44:47], a[216:223], v6
v_smfmac_f32_16x16x64_bf16 v[100:103], v[44:47], a[248:255], v6
s_branch mega_kernel_rf_pc_7_0
mega_kernel_rf_w0last:
s_nop 7
v_permlane32_swap_b32 v112, v116
v_permlane32_swap_b32 v113, v117
v_permlane32_swap_b32 v114, v118
v_permlane32_swap_b32 v115, v119
v_pk_add_f32 v[112:113], v[112:113], v[116:117]
v_pk_add_f32 v[114:115], v[114:115], v[118:119]
ds_write_b128 v20, v[112:115]
s_waitcnt lgkmcnt(0)
s_barrier
s_branch mega_kernel_rf_end
mega_kernel_rf_side:
s_cmp_eq_u32 s24, 3
s_cbranch_scc1 mega_kernel_rf_sd3
s_cmp_eq_u32 s24, 2
s_cbranch_scc0 mega_kernel_rf_sd4
s_mov_b64 exec, s[40:41]
buffer_store_dwordx4 v[28:31], v11, s[84:87], s34 offen
s_mov_b64 exec, -1
buffer_store_dwordx2 v[28:29], v9, s[84:87], s34 offen
s_lshl_b32 s28, s31, 11
s_add_u32 s28, s28, s34
s_add_u32 s28, s28, 32768
buffer_store_dwordx4 v[28:31], v17, s[84:87], s28 offen
buffer_store_dwordx4 v[28:31], v10, s[84:87], s28 offen
s_branch mega_kernel_rf_sd4
mega_kernel_rf_sd3:
s_mov_b32 s36, 0
s_add_u32 s76, s27, 1
s_cmp_lt_u32 s76, 63
s_cbranch_scc0 mega_kernel_rf_sd4
s_cmp_gt_i32 s46, s76
s_cselect_b32 s36, 0, 1
s_cbranch_scc0 mega_kernel_rf_sd4
s_add_u32 s77, s76, s82
s_bfe_u32 s28, s77, 0x40002
s_lshl_b32 s28, s28, 14
s_and_b32 s77, s77, 3
s_lshl_b32 s77, s77, 11
s_add_u32 s28, s28, s77
s_add_u32 m0, s45, 0
s_nop 0
buffer_load_dwordx4 v240, s[84:87], s28 offen offset:0 sc1 lds
s_add_u32 m0, s45, 0
s_nop 0
buffer_load_dwordx4 v240, s[84:87], s28 offen offset:1024 sc1 lds
s_add_u32 m0, s45, 2048
s_nop 0
buffer_load_dwordx4 v241, s[84:87], s28 offen offset:0 sc1 lds
s_add_u32 m0, s45, 2048
s_nop 0
buffer_load_dwordx4 v241, s[84:87], s28 offen offset:1024 sc1 lds
s_add_u32 s45, s45, 4096
s_cmp_eq_u32 s45, 30720
s_cselect_b32 s45, 18432, s45
mega_kernel_rf_sd4:
v_smfmac_f32_16x16x64_bf16 v[112:115], v[40:43], a[144:151], v6
v_smfmac_f32_16x16x64_bf16 v[116:119], v[40:43], a[176:183], v6
v_smfmac_f32_16x16x64_bf16 v[112:115], v[44:47], a[152:159], v6
v_smfmac_f32_16x16x64_bf16 v[116:119], v[44:47], a[184:191], v6
s_nop 7
v_permlane32_swap_b32 v112, v116
v_permlane32_swap_b32 v113, v117
v_permlane32_swap_b32 v114, v118
v_permlane32_swap_b32 v115, v119
v_pk_add_f32 v[112:113], v[112:113], v[116:117]
v_pk_add_f32 v[114:115], v[114:115], v[118:119]
ds_write_b128 v20, v[112:115]
v_mov_b32 v96, 0
v_mov_b32 v97, 0
v_mov_b32 v98, 0
v_mov_b32 v99, 0
v_mov_b32 v100, 0
v_mov_b32 v101, 0
v_mov_b32 v102, 0
v_mov_b32 v103, 0
s_cmp_eq_u32 s24, 1
s_cbranch_scc0 mega_kernel_rf_s1
s_waitcnt lgkmcnt(0)
ds_read_b128 v[120:123], v16 offset:0
ds_read_b128 v[124:127], v16 offset:16
ds_read_b128 v[128:131], v16 offset:2304
ds_read_b128 v[132:135], v16 offset:2320
ds_read_b128 v[136:139], v16 offset:4608
ds_read_b128 v[140:143], v16 offset:4624
ds_read_b128 v[144:147], v16 offset:6912
ds_read_b128 v[148:151], v16 offset:6928
s_waitcnt lgkmcnt(4)
v_pk_add_f32 v[120:121], v[120:121], v[128:129]
v_pk_add_f32 v[122:123], v[122:123], v[130:131]
v_pk_add_f32 v[124:125], v[124:125], v[132:133]
v_pk_add_f32 v[126:127], v[126:127], v[134:135]
s_waitcnt lgkmcnt(0)
v_pk_add_f32 v[136:137], v[136:137], v[144:145]
v_pk_add_f32 v[138:139], v[138:139], v[146:147]
v_pk_add_f32 v[140:141], v[140:141], v[148:149]
v_pk_add_f32 v[142:143], v[142:143], v[150:151]
v_pk_add_f32 v[120:121], v[120:121], v[136:137]
v_pk_add_f32 v[122:123], v[122:123], v[138:139]
v_pk_add_f32 v[124:125], v[124:125], v[140:141]
v_pk_add_f32 v[126:127], v[126:127], v[142:143]
v_cvt_pk_bf16_f32 v244, v120, v121
v_cvt_pk_bf16_f32 v245, v122, v123
v_cvt_pk_bf16_f32 v246, v124, v125
v_cvt_pk_bf16_f32 v247, v126, v127
mega_kernel_rf_s1:
v_add_u32 v5, 9216, v17
s_waitcnt lgkmcnt(0)
s_barrier
s_cmp_eq_u32 s24, 2
s_cbranch_scc1 mega_kernel_rf_s2
s_cmp_eq_u32 s24, 3
s_cbranch_scc0 mega_kernel_rf_s3
s_add_u32 s76, s27, 2
s_cmp_lt_u32 s76, 63
s_cbranch_scc0 mega_kernel_rf_s3
s_cmp_gt_i32 s46, s76
s_cbranch_scc0 mega_kernel_rf_s3
s_add_u32 s77, s76, s82
s_bfe_u32 s28, s77, 0x40002
s_lshl_b32 s28, s28, 14
s_and_b32 s77, s77, 3
s_lshl_b32 s77, s77, 11
s_add_u32 s28, s28, s77
s_add_u32 s28, s28, s83
s_buffer_load_dword s78, s[84:87], s28 offset:0
s_buffer_load_dword s78, s[84:87], s28 offset:128
s_buffer_load_dword s78, s[84:87], s28 offset:256
s_buffer_load_dword s78, s[84:87], s28 offset:384
s_buffer_load_dword s78, s[84:87], s28 offset:512
s_buffer_load_dword s78, s[84:87], s28 offset:640
s_buffer_load_dword s78, s[84:87], s28 offset:768
s_buffer_load_dword s78, s[84:87], s28 offset:896
s_buffer_load_dword s78, s[84:87], s28 offset:1024
s_buffer_load_dword s78, s[84:87], s28 offset:1152
s_buffer_load_dword s78, s[84:87], s28 offset:1280
s_buffer_load_dword s78, s[84:87], s28 offset:1408
s_buffer_load_dword s78, s[84:87], s28 offset:1536
s_buffer_load_dword s78, s[84:87], s28 offset:1664
s_buffer_load_dword s78, s[84:87], s28 offset:1792
s_buffer_load_dword s78, s[84:87], s28 offset:1920
s_branch mega_kernel_rf_s3
mega_kernel_rf_s2:
ds_read_b128 v[120:123], v5 offset:0
ds_read_b128 v[124:127], v5 offset:1024
ds_read_b128 v[128:131], v5 offset:2048
ds_read_b128 v[132:135], v5 offset:3072
v_lshrrev_b32 v5, 1, v17
s_waitcnt lgkmcnt(2)
v_pk_add_f32 v[120:121], v[120:121], v[124:125]
v_pk_add_f32 v[122:123], v[122:123], v[126:127]
s_waitcnt lgkmcnt(0)
v_pk_add_f32 v[128:129], v[128:129], v[132:133]
v_pk_add_f32 v[130:131], v[130:131], v[134:135]
v_pk_add_f32 v[120:121], v[120:121], v[128:129]
v_pk_add_f32 v[122:123], v[122:123], v[130:131]
v_cvt_pk_bf16_f32 v244, v120, v121
v_cvt_pk_bf16_f32 v245, v122, v123
ds_write_b64 v5, v[244:245] offset:17920
s_waitcnt lgkmcnt(0) vmcnt(0)
mega_kernel_rf_s3:
s_cmp_eq_u32 s27, 63
s_cbranch_scc1 mega_kernel_rf_slast
s_add_u32 s29, s33, 16384
s_barrier
s_cmp_eq_u32 s24, 3
s_cbranch_scc1 mega_kernel_rf_y3
s_add_u32 s77, s27, s82
s_bfe_u32 s28, s77, 0x30003
s_lshl_b32 s28, s28, 14
s_and_b32 s77, s77, 7
s_lshl_b32 s77, s77, 10
s_add_u32 s28, s28, s77
s_add_u32 s28, s28, s79
s_cmp_eq_u32 s24, 2
s_cbranch_scc1 mega_kernel_rf_kv2a
s_mov_b64 exec, s[48:49]
buffer_store_dwordx4 v[244:247], v22, s[84:87], s28 offen sc1
s_mov_b64 exec, -1
s_branch mega_kernel_rf_kvda
mega_kernel_rf_kv2a:
v_lshlrev_b32 v4, 3, v1
buffer_store_dwordx2 v[244:245], v4, s[84:87], s28 offen offset:512 sc1
mega_kernel_rf_kvda:
s_branch mega_kernel_rf_y4
mega_kernel_rf_y3:
s_add_u32 s76, s27, 2
s_cmp_lt_u32 s76, 63
s_cbranch_scc0 mega_kernel_rf_y4
mega_kernel_rf_y4:
s_branch mega_kernel_rf_b3
mega_kernel_rf_first:
buffer_load_dwordx4 v[32:35], v8, s[20:23], 0 offen offset:0
buffer_load_dwordx4 v[36:39], v8, s[20:23], 0 offen offset:128
buffer_load_dwordx4 v[40:43], v8, s[20:23], 0 offen offset:256
buffer_load_dwordx4 v[44:47], v8, s[20:23], 0 offen offset:384
v_add_u32 v5, s44, v17
ds_read_b128 v[156:159], v5 offset:0
ds_read_b128 v[160:163], v5 offset:1024
ds_read_b128 v[164:167], v5 offset:2048
ds_read_b128 v[168:171], v5 offset:3072
s_waitcnt vmcnt(0)
v_smfmac_f32_16x16x64_bf16 v[96:99], v[32:35], a[0:7], v6
v_smfmac_f32_16x16x64_bf16 v[100:103], v[32:35], a[32:39], v6
v_smfmac_f32_16x16x64_bf16 v[104:107], v[32:35], a[64:71], v6
v_smfmac_f32_16x16x64_bf16 v[108:111], v[32:35], a[96:103], v6
v_smfmac_f32_16x16x64_bf16 v[96:99], v[36:39], a[8:15], v6
v_smfmac_f32_16x16x64_bf16 v[100:103], v[36:39], a[40:47], v6
v_smfmac_f32_16x16x64_bf16 v[104:107], v[36:39], a[72:79], v6
v_smfmac_f32_16x16x64_bf16 v[108:111], v[36:39], a[104:111], v6
v_smfmac_f32_16x16x64_bf16 v[96:99], v[40:43], a[16:23], v6
v_smfmac_f32_16x16x64_bf16 v[100:103], v[40:43], a[48:55], v6
v_smfmac_f32_16x16x64_bf16 v[104:107], v[40:43], a[80:87], v6
v_smfmac_f32_16x16x64_bf16 v[108:111], v[40:43], a[112:119], v6
v_smfmac_f32_16x16x64_bf16 v[96:99], v[44:47], a[24:31], v6
v_smfmac_f32_16x16x64_bf16 v[100:103], v[44:47], a[56:63], v6
v_smfmac_f32_16x16x64_bf16 v[104:107], v[44:47], a[88:95], v6
v_smfmac_f32_16x16x64_bf16 v[108:111], v[44:47], a[120:127], v6
s_nop 1
s_branch mega_kernel_rf_adone
mega_kernel_rf_slast:
s_cmp_eq_u32 s24, 3
s_cbranch_scc1 mega_kernel_rf_end
s_add_u32 s77, s27, s82
s_bfe_u32 s28, s77, 0x30003
s_lshl_b32 s28, s28, 14
s_and_b32 s77, s77, 7
s_lshl_b32 s77, s77, 10
s_add_u32 s28, s28, s77
s_add_u32 s28, s28, s79
s_cmp_eq_u32 s24, 2
s_cbranch_scc1 mega_kernel_rf_kv2b
s_mov_b64 exec, s[48:49]
buffer_store_dwordx4 v[244:247], v22, s[84:87], s28 offen sc1
s_mov_b64 exec, -1
s_branch mega_kernel_rf_kvdb
mega_kernel_rf_kv2b:
v_lshlrev_b32 v4, 3, v1
buffer_store_dwordx2 v[244:245], v4, s[84:87], s28 offen offset:512 sc1
mega_kernel_rf_kvdb:
s_waitcnt vmcnt(0)
s_barrier
s_mov_b32 s76, 64
s_cmp_eq_u32 s24, 1
s_cbranch_scc0 mega_kernel_rf_end
v_mov_b32 v5, s76
s_mov_b64 exec, 1
buffer_store_dword v5, v228, s[84:87], s81 offen sc1
s_mov_b64 exec, -1
mega_kernel_rf_end:
s_endpgm
mega_kernel_recs:
s_load_dwordx2 s[20:21], s[0:1], 8
s_load_dwordx2 s[16:17], s[0:1], 40
s_load_dwordx2 s[4:5], s[0:1], 16
s_load_dwordx2 s[8:9], s[0:1], 24
s_load_dwordx2 s[12:13], s[0:1], 32
v_lshrrev_b32 v4, 6, v0
v_and_b32 v1, 63, v0
v_readfirstlane_b32 s24, v4
v_lshrrev_b32 v2, 4, v1
v_and_b32 v3, 15, v1
v_lshlrev_b32 v17, 4, v1
s_lshr_b32 s28, s31, 2
s_lshl_b32 s25, s30, 3
s_add_u32 s25, s25, s28
s_and_b32 s26, s31, 3
s_waitcnt lgkmcnt(0)
s_mov_b32 s22, 16384
s_mov_b32 s23, 0x00020000
s_mov_b32 s18, 8388608
s_mov_b32 s19, 0x00020000
s_mov_b32 s6, 8388608
s_mov_b32 s7, 0x00020000
s_mov_b32 s10, 8388608
s_mov_b32 s11, 0x00020000
s_mov_b32 s14, 8388608
s_mov_b32 s15, 0x00020000
s_lshl_b32 s28, s25, 8
s_lshr_b32 s29, s26, 0
s_lshl_b32 s29, s29, 6
s_add_u32 s28, s28, s29
s_lshl_b32 s29, s24, 21
s_add_u32 s28, s28, s29
v_lshrrev_b32 v4, 2, v1
v_and_b32 v5, 3, v1
v_lshlrev_b32 v40, 13, v4
v_lshl_add_u32 v40, v5, 4, v40
v_add_u32 v40, s28, v40
s_lshl_b32 s28, s30, 21
s_lshl_b32 s29, s24, 19
s_add_u32 s28, s28, s29
s_lshr_b32 s29, s31, 0
s_lshl_b32 s29, s29, 6
s_add_u32 s28, s28, s29
v_lshlrev_b32 v41, 11, v4
v_lshl_add_u32 v41, v5, 4, v41
v_add_u32 v41, s28, v41
s_lshl_b32 s47, s24, 15
s_add_u32 s47, s47, 32768
s_lshl_b32 s28, s31, 18
s_lshl_b32 s29, s24, 16
s_add_u32 s28, s28, s29
s_lshl_b32 s29, s30, 11
s_add_u32 s28, s28, s29
v_lshlrev_b32 v48, 13, v2
v_lshl_add_u32 v48, v3, 7, v48
v_add_u32 v48, s28, v48
s_lshl_b32 s28, s30, 21
s_lshl_b32 s29, s31, 16
s_add_u32 s28, s28, s29
s_lshl_b32 s29, s24, 14
s_add_u32 s28, s28, s29
v_lshlrev_b32 v49, 7, v1
v_add_u32 v49, s28, v49
s_and_b32 s76, s31, 1
s_mul_i32 s76, s76, 8
s_and_b32 s28, s31, 15
s_lshl_b32 s28, s28, 4
s_lshl_b32 s29, s24, 8
s_add_u32 s28, s28, s29
v_add_u32 v53, s28, v3
s_lshr_b32 s28, s31, 4
s_lshl_b32 s28, s28, 10
s_add_u32 s28, s28, 384
v_mov_b32 v54, s28
v_mov_b32 v55, 1920
v_cmp_gt_u32 vcc, 32, v1
s_nop 1
v_cndmask_b32 v54, v55, v54, vcc
s_lshl_b32 s29, s30, 11
v_lshl_add_u32 v51, v53, 13, v54
v_add_u32 v51, s29, v51
s_lshl_b32 s29, s30, 21
v_lshl_add_u32 v52, v53, 11, v54
v_add_u32 v52, s29, v52
buffer_load_dword v50, v51, s[4:7], 0 offen
s_xor_b32 s29, s76, 0
s_lshl_b32 s28, s29, 10
s_add_u32 s28, s28, s47
s_add_u32 m0, s28, 0
s_lshl_b32 s29, s29, 17
buffer_load_dwordx4 v40, s[4:7], s29 offen lds
s_xor_b32 s29, s76, 1
s_lshl_b32 s28, s29, 10
s_add_u32 s28, s28, s47
s_add_u32 m0, s28, 0
s_lshl_b32 s29, s29, 17
buffer_load_dwordx4 v40, s[4:7], s29 offen lds
s_xor_b32 s29, s76, 2
s_lshl_b32 s28, s29, 10
s_add_u32 s28, s28, s47
s_add_u32 m0, s28, 0
s_lshl_b32 s29, s29, 17
buffer_load_dwordx4 v40, s[4:7], s29 offen lds
s_xor_b32 s29, s76, 3
s_lshl_b32 s28, s29, 10
s_add_u32 s28, s28, s47
s_add_u32 m0, s28, 0
s_lshl_b32 s29, s29, 17
buffer_load_dwordx4 v40, s[4:7], s29 offen lds
s_xor_b32 s29, s76, 4
s_lshl_b32 s28, s29, 10
s_add_u32 s28, s28, s47
s_add_u32 m0, s28, 0
s_lshl_b32 s29, s29, 17
buffer_load_dwordx4 v40, s[4:7], s29 offen lds
s_xor_b32 s29, s76, 5
s_lshl_b32 s28, s29, 10
s_add_u32 s28, s28, s47
s_add_u32 m0, s28, 0
s_lshl_b32 s29, s29, 17
buffer_load_dwordx4 v40, s[4:7], s29 offen lds
s_xor_b32 s29, s76, 6
s_lshl_b32 s28, s29, 10
s_add_u32 s28, s28, s47
s_add_u32 m0, s28, 0
s_lshl_b32 s29, s29, 17
buffer_load_dwordx4 v40, s[4:7], s29 offen lds
s_xor_b32 s29, s76, 7
s_lshl_b32 s28, s29, 10
s_add_u32 s28, s28, s47
s_add_u32 m0, s28, 0
s_lshl_b32 s29, s29, 17
buffer_load_dwordx4 v40, s[4:7], s29 offen lds
s_xor_b32 s29, s76, 8
s_lshl_b32 s28, s29, 10
s_add_u32 s28, s28, s47
s_add_u32 m0, s28, 0
s_lshl_b32 s29, s29, 17
buffer_load_dwordx4 v40, s[4:7], s29 offen lds
s_xor_b32 s29, s76, 9
s_lshl_b32 s28, s29, 10
s_add_u32 s28, s28, s47
s_add_u32 m0, s28, 0
s_lshl_b32 s29, s29, 17
buffer_load_dwordx4 v40, s[4:7], s29 offen lds
s_xor_b32 s29, s76, 10
s_lshl_b32 s28, s29, 10
s_add_u32 s28, s28, s47
s_add_u32 m0, s28, 0
s_lshl_b32 s29, s29, 17
buffer_load_dwordx4 v40, s[4:7], s29 offen lds
s_xor_b32 s29, s76, 11
s_lshl_b32 s28, s29, 10
s_add_u32 s28, s28, s47
s_add_u32 m0, s28, 0
s_lshl_b32 s29, s29, 17
buffer_load_dwordx4 v40, s[4:7], s29 offen lds
s_xor_b32 s29, s76, 12
s_lshl_b32 s28, s29, 10
s_add_u32 s28, s28, s47
s_add_u32 m0, s28, 0
s_lshl_b32 s29, s29, 17
buffer_load_dwordx4 v40, s[4:7], s29 offen lds
s_xor_b32 s29, s76, 13
s_lshl_b32 s28, s29, 10
s_add_u32 s28, s28, s47
s_add_u32 m0, s28, 0
s_lshl_b32 s29, s29, 17
buffer_load_dwordx4 v40, s[4:7], s29 offen lds
s_xor_b32 s29, s76, 14
s_lshl_b32 s28, s29, 10
s_add_u32 s28, s28, s47
s_add_u32 m0, s28, 0
s_lshl_b32 s29, s29, 17
buffer_load_dwordx4 v40, s[4:7], s29 offen lds
s_xor_b32 s29, s76, 15
s_lshl_b32 s28, s29, 10
s_add_u32 s28, s28, s47
s_add_u32 m0, s28, 0
s_lshl_b32 s29, s29, 17
buffer_load_dwordx4 v40, s[4:7], s29 offen lds
buffer_load_dword v50, v51, s[8:11], 0 offen
s_xor_b32 s29, s76, 0
s_lshl_b32 s28, s29, 10
s_add_u32 s28, s28, s47
s_add_u32 m0, s28, 16384
s_lshl_b32 s29, s29, 17
buffer_load_dwordx4 v40, s[8:11], s29 offen lds
s_xor_b32 s29, s76, 1
s_lshl_b32 s28, s29, 10
s_add_u32 s28, s28, s47
s_add_u32 m0, s28, 16384
s_lshl_b32 s29, s29, 17
buffer_load_dwordx4 v40, s[8:11], s29 offen lds
s_xor_b32 s29, s76, 2
s_lshl_b32 s28, s29, 10
s_add_u32 s28, s28, s47
s_add_u32 m0, s28, 16384
s_lshl_b32 s29, s29, 17
buffer_load_dwordx4 v40, s[8:11], s29 offen lds
s_xor_b32 s29, s76, 3
s_lshl_b32 s28, s29, 10
s_add_u32 s28, s28, s47
s_add_u32 m0, s28, 16384
s_lshl_b32 s29, s29, 17
buffer_load_dwordx4 v40, s[8:11], s29 offen lds
s_xor_b32 s29, s76, 4
s_lshl_b32 s28, s29, 10
s_add_u32 s28, s28, s47
s_add_u32 m0, s28, 16384
s_lshl_b32 s29, s29, 17
buffer_load_dwordx4 v40, s[8:11], s29 offen lds
s_xor_b32 s29, s76, 5
s_lshl_b32 s28, s29, 10
s_add_u32 s28, s28, s47
s_add_u32 m0, s28, 16384
s_lshl_b32 s29, s29, 17
buffer_load_dwordx4 v40, s[8:11], s29 offen lds
s_xor_b32 s29, s76, 6
s_lshl_b32 s28, s29, 10
s_add_u32 s28, s28, s47
s_add_u32 m0, s28, 16384
s_lshl_b32 s29, s29, 17
buffer_load_dwordx4 v40, s[8:11], s29 offen lds
s_xor_b32 s29, s76, 7
s_lshl_b32 s28, s29, 10
s_add_u32 s28, s28, s47
s_add_u32 m0, s28, 16384
s_lshl_b32 s29, s29, 17
buffer_load_dwordx4 v40, s[8:11], s29 offen lds
s_xor_b32 s29, s76, 8
s_lshl_b32 s28, s29, 10
s_add_u32 s28, s28, s47
s_add_u32 m0, s28, 16384
s_lshl_b32 s29, s29, 17
buffer_load_dwordx4 v40, s[8:11], s29 offen lds
s_xor_b32 s29, s76, 9
s_lshl_b32 s28, s29, 10
s_add_u32 s28, s28, s47
s_add_u32 m0, s28, 16384
s_lshl_b32 s29, s29, 17
buffer_load_dwordx4 v40, s[8:11], s29 offen lds
s_xor_b32 s29, s76, 10
s_lshl_b32 s28, s29, 10
s_add_u32 s28, s28, s47
s_add_u32 m0, s28, 16384
s_lshl_b32 s29, s29, 17
buffer_load_dwordx4 v40, s[8:11], s29 offen lds
s_xor_b32 s29, s76, 11
s_lshl_b32 s28, s29, 10
s_add_u32 s28, s28, s47
s_add_u32 m0, s28, 16384
s_lshl_b32 s29, s29, 17
buffer_load_dwordx4 v40, s[8:11], s29 offen lds
s_xor_b32 s29, s76, 12
s_lshl_b32 s28, s29, 10
s_add_u32 s28, s28, s47
s_add_u32 m0, s28, 16384
s_lshl_b32 s29, s29, 17
buffer_load_dwordx4 v40, s[8:11], s29 offen lds
s_xor_b32 s29, s76, 13
s_lshl_b32 s28, s29, 10
s_add_u32 s28, s28, s47
s_add_u32 m0, s28, 16384
s_lshl_b32 s29, s29, 17
buffer_load_dwordx4 v40, s[8:11], s29 offen lds
s_xor_b32 s29, s76, 14
s_lshl_b32 s28, s29, 10
s_add_u32 s28, s28, s47
s_add_u32 m0, s28, 16384
s_lshl_b32 s29, s29, 17
buffer_load_dwordx4 v40, s[8:11], s29 offen lds
s_xor_b32 s29, s76, 15
s_lshl_b32 s28, s29, 10
s_add_u32 s28, s28, s47
s_add_u32 m0, s28, 16384
s_lshl_b32 s29, s29, 17
buffer_load_dwordx4 v40, s[8:11], s29 offen lds
s_mov_b32 s40, 0x00ff00ff
s_mov_b32 s41, 0x00ff00ff
s_mov_b32 s48, 0xff00ff00
s_mov_b32 s49, 0xff00ff00
s_mov_b32 s42, 0
s_mov_b32 s43, 0x00ff00ff
s_mov_b32 s32, 0x3e0293ee
v_mov_b32 v23, 0xff800000
v_mov_b32 v6, 0x4444
v_mov_b32 v4, 0xeeee
v_cndmask_b32 v6, v6, v4, s[48:49]
v_mov_b32 v28, -1
v_mov_b32 v29, -1
v_mov_b32 v30, -1
v_mov_b32 v31, -1
s_lshl_b32 s28, s24, 12
v_add_u32 v7, s28, v17
v_and_b32 v4, 7, v1
v_lshlrev_b32 v8, 11, v4
v_lshrrev_b32 v5, 3, v1
v_lshl_add_u32 v8, v5, 4, v8
s_lshl_b32 s28, s24, 9
v_add_u32 v8, s28, v8
s_lshl_b32 s28, s31, 9
v_lshlrev_b32 v9, 3, v1
v_add_u32 v9, s28, v9
v_and_b32 v4, 7, v3
v_lshlrev_b32 v11, 7, v2
v_lshl_add_u32 v11, v4, 4, v11
v_add_u32 v22, 0, v11
s_add_u32 s28, s28, 16384
v_add_u32 v11, s28, v11
v_and_b32 v5, 1, v2
v_lshlrev_b32 v10, 7, v5
v_lshl_add_u32 v10, v4, 4, v10
v_add_u32 v10, 1024, v10
s_xor_b32 s37, s31, 1
s_lshl_b32 s37, s37, 11
s_add_u32 s37, s37, 32768
s_xor_b32 s38, s31, 2
s_lshl_b32 s38, s38, 11
s_add_u32 s38, s38, 32768
s_xor_b32 s39, s31, 3
s_lshl_b32 s39, s39, 11
s_add_u32 s39, s39, 32768
v_and_b32 v4, 1, v2
v_mul_u32_u24 v14, 576, v4
v_lshrrev_b32 v5, 1, v2
v_lshl_add_u32 v5, v5, 4, v3
v_lshl_add_u32 v14, v5, 2, v14
s_mul_i32 s28, s24, 1152
s_add_u32 s28, s28, 13312
v_add_u32 v18, s28, v14
s_mul_i32 s28, s24, 2304
v_add_u32 v14, s28, v14
v_add_u32 v15, 1152, v14
v_mul_u32_u24 v16, 144, v3
v_lshl_add_u32 v16, v2, 5, v16
v_bfe_u32 v4, v1, 1, 3
v_mul_u32_u24 v19, 144, v4
v_lshl_add_u32 v19, v2, 5, v19
v_and_b32 v4, 1, v1
v_lshl_add_u32 v19, v4, 4, v19
v_add_u32 v19, 13312, v19
s_lshl_b32 s28, s24, 10
s_add_u32 s28, s28, 9216
v_add_u32 v20, s28, v17
v_and_b32 v4, 31, v1
v_lshlrev_b32 v21, 3, v4
v_add_u32 v21, 17920, v21
v_lshrrev_b32 v4, 2, v3
v_and_b32 v42, 1, v4
v_lshrrev_b32 v43, 1, v4
v_lshrrev_b32 v44, 1, v2
v_and_b32 v45, 1, v2
v_lshl_add_u32 v46, v44, 4, v42
v_lshl_add_u32 v46, v45, 2, v46
v_lshl_add_u32 v46, v43, 3, v46
v_lshl_add_u32 v47, v44, 3, v42
v_lshl_add_u32 v47, v45, 4, v47
v_lshl_add_u32 v47, v43, 2, v47
v_and_b32 v5, 3, v3
v_lshlrev_b32 v5, 3, v5
v_lshl_add_u32 v46, v46, 6, v5
v_lshl_add_u32 v47, v47, 6, v5
s_and_b32 s28, s31, 0
s_lshl_b32 s28, s28, 6
s_add_u32 s28, s28, s47
v_add_u32 v46, s28, v46
v_add_u32 v47, s28, v47
s_waitcnt vmcnt(17)
ds_read_b64_tr_b16 a[0:1], v46 offset:0
ds_read_b64_tr_b16 a[2:3], v46 offset:128
ds_read_b64_tr_b16 a[4:5], v46 offset:2048
ds_read_b64_tr_b16 a[6:7], v46 offset:2176
ds_read_b64_tr_b16 a[8:9], v46 offset:4096
ds_read_b64_tr_b16 a[10:11], v46 offset:4224
ds_read_b64_tr_b16 a[12:13], v46 offset:6144
ds_read_b64_tr_b16 a[14:15], v46 offset:6272
s_waitcnt lgkmcnt(0)
ds_read_b64_tr_b16 a[16:17], v46 offset:8192
ds_read_b64_tr_b16 a[18:19], v46 offset:8320
ds_read_b64_tr_b16 a[20:21], v46 offset:10240
ds_read_b64_tr_b16 a[22:23], v46 offset:10368
ds_read_b64_tr_b16 a[24:25], v46 offset:12288
ds_read_b64_tr_b16 a[26:27], v46 offset:12416
ds_read_b64_tr_b16 a[28:29], v46 offset:14336
ds_read_b64_tr_b16 a[30:31], v46 offset:14464
s_waitcnt lgkmcnt(0)
ds_read_b64_tr_b16 a[32:33], v46 offset:32
ds_read_b64_tr_b16 a[34:35], v46 offset:160
ds_read_b64_tr_b16 a[36:37], v46 offset:2080
ds_read_b64_tr_b16 a[38:39], v46 offset:2208
ds_read_b64_tr_b16 a[40:41], v46 offset:4128
ds_read_b64_tr_b16 a[42:43], v46 offset:4256
ds_read_b64_tr_b16 a[44:45], v46 offset:6176
ds_read_b64_tr_b16 a[46:47], v46 offset:6304
s_waitcnt lgkmcnt(0)
ds_read_b64_tr_b16 a[48:49], v46 offset:8224
ds_read_b64_tr_b16 a[50:51], v46 offset:8352
ds_read_b64_tr_b16 a[52:53], v46 offset:10272
ds_read_b64_tr_b16 a[54:55], v46 offset:10400
ds_read_b64_tr_b16 a[56:57], v46 offset:12320
ds_read_b64_tr_b16 a[58:59], v46 offset:12448
ds_read_b64_tr_b16 a[60:61], v46 offset:14368
ds_read_b64_tr_b16 a[62:63], v46 offset:14496
s_waitcnt lgkmcnt(0)
buffer_load_dword v50, v51, s[12:15], 0 offen
s_xor_b32 s29, s76, 0
s_lshl_b32 s28, s29, 10
s_add_u32 s28, s28, s47
s_add_u32 m0, s28, 0
s_lshl_b32 s29, s29, 17
buffer_load_dwordx4 v40, s[12:15], s29 offen lds
s_xor_b32 s29, s76, 1
s_lshl_b32 s28, s29, 10
s_add_u32 s28, s28, s47
s_add_u32 m0, s28, 0
s_lshl_b32 s29, s29, 17
buffer_load_dwordx4 v40, s[12:15], s29 offen lds
s_xor_b32 s29, s76, 2
s_lshl_b32 s28, s29, 10
s_add_u32 s28, s28, s47
s_add_u32 m0, s28, 0
s_lshl_b32 s29, s29, 17
buffer_load_dwordx4 v40, s[12:15], s29 offen lds
s_xor_b32 s29, s76, 3
s_lshl_b32 s28, s29, 10
s_add_u32 s28, s28, s47
s_add_u32 m0, s28, 0
s_lshl_b32 s29, s29, 17
buffer_load_dwordx4 v40, s[12:15], s29 offen lds
s_xor_b32 s29, s76, 4
s_lshl_b32 s28, s29, 10
s_add_u32 s28, s28, s47
s_add_u32 m0, s28, 0
s_lshl_b32 s29, s29, 17
buffer_load_dwordx4 v40, s[12:15], s29 offen lds
s_xor_b32 s29, s76, 5
s_lshl_b32 s28, s29, 10
s_add_u32 s28, s28, s47
s_add_u32 m0, s28, 0
s_lshl_b32 s29, s29, 17
buffer_load_dwordx4 v40, s[12:15], s29 offen lds
s_xor_b32 s29, s76, 6
s_lshl_b32 s28, s29, 10
s_add_u32 s28, s28, s47
s_add_u32 m0, s28, 0
s_lshl_b32 s29, s29, 17
buffer_load_dwordx4 v40, s[12:15], s29 offen lds
s_xor_b32 s29, s76, 7
s_lshl_b32 s28, s29, 10
s_add_u32 s28, s28, s47
s_add_u32 m0, s28, 0
s_lshl_b32 s29, s29, 17
buffer_load_dwordx4 v40, s[12:15], s29 offen lds
s_xor_b32 s29, s76, 8
s_lshl_b32 s28, s29, 10
s_add_u32 s28, s28, s47
s_add_u32 m0, s28, 0
s_lshl_b32 s29, s29, 17
buffer_load_dwordx4 v40, s[12:15], s29 offen lds
s_xor_b32 s29, s76, 9
s_lshl_b32 s28, s29, 10
s_add_u32 s28, s28, s47
s_add_u32 m0, s28, 0
s_lshl_b32 s29, s29, 17
buffer_load_dwordx4 v40, s[12:15], s29 offen lds
s_xor_b32 s29, s76, 10
s_lshl_b32 s28, s29, 10
s_add_u32 s28, s28, s47
s_add_u32 m0, s28, 0
s_lshl_b32 s29, s29, 17
buffer_load_dwordx4 v40, s[12:15], s29 offen lds
s_xor_b32 s29, s76, 11
s_lshl_b32 s28, s29, 10
s_add_u32 s28, s28, s47
s_add_u32 m0, s28, 0
s_lshl_b32 s29, s29, 17
buffer_load_dwordx4 v40, s[12:15], s29 offen lds
s_xor_b32 s29, s76, 12
s_lshl_b32 s28, s29, 10
s_add_u32 s28, s28, s47
s_add_u32 m0, s28, 0
s_lshl_b32 s29, s29, 17
buffer_load_dwordx4 v40, s[12:15], s29 offen lds
s_xor_b32 s29, s76, 13
s_lshl_b32 s28, s29, 10
s_add_u32 s28, s28, s47
s_add_u32 m0, s28, 0
s_lshl_b32 s29, s29, 17
buffer_load_dwordx4 v40, s[12:15], s29 offen lds
s_xor_b32 s29, s76, 14
s_lshl_b32 s28, s29, 10
s_add_u32 s28, s28, s47
s_add_u32 m0, s28, 0
s_lshl_b32 s29, s29, 17
buffer_load_dwordx4 v40, s[12:15], s29 offen lds
s_xor_b32 s29, s76, 15
s_lshl_b32 s28, s29, 10
s_add_u32 s28, s28, s47
s_add_u32 m0, s28, 0
s_lshl_b32 s29, s29, 17
buffer_load_dwordx4 v40, s[12:15], s29 offen lds
s_waitcnt vmcnt(17)
ds_read_b64_tr_b16 a[64:65], v46 offset:16384
ds_read_b64_tr_b16 a[66:67], v46 offset:16512
ds_read_b64_tr_b16 a[68:69], v46 offset:18432
ds_read_b64_tr_b16 a[70:71], v46 offset:18560
ds_read_b64_tr_b16 a[72:73], v46 offset:20480
ds_read_b64_tr_b16 a[74:75], v46 offset:20608
ds_read_b64_tr_b16 a[76:77], v46 offset:22528
ds_read_b64_tr_b16 a[78:79], v46 offset:22656
s_waitcnt lgkmcnt(0)
ds_read_b64_tr_b16 a[80:81], v46 offset:24576
ds_read_b64_tr_b16 a[82:83], v46 offset:24704
ds_read_b64_tr_b16 a[84:85], v46 offset:26624
ds_read_b64_tr_b16 a[86:87], v46 offset:26752
ds_read_b64_tr_b16 a[88:89], v46 offset:28672
ds_read_b64_tr_b16 a[90:91], v46 offset:28800
ds_read_b64_tr_b16 a[92:93], v46 offset:30720
ds_read_b64_tr_b16 a[94:95], v46 offset:30848
s_waitcnt lgkmcnt(0)
ds_read_b64_tr_b16 a[96:97], v46 offset:16416
ds_read_b64_tr_b16 a[98:99], v46 offset:16544
ds_read_b64_tr_b16 a[100:101], v46 offset:18464
ds_read_b64_tr_b16 a[102:103], v46 offset:18592
ds_read_b64_tr_b16 a[104:105], v46 offset:20512
ds_read_b64_tr_b16 a[106:107], v46 offset:20640
ds_read_b64_tr_b16 a[108:109], v46 offset:22560
ds_read_b64_tr_b16 a[110:111], v46 offset:22688
s_waitcnt lgkmcnt(0)
ds_read_b64_tr_b16 a[112:113], v46 offset:24608
ds_read_b64_tr_b16 a[114:115], v46 offset:24736
ds_read_b64_tr_b16 a[116:117], v46 offset:26656
ds_read_b64_tr_b16 a[118:119], v46 offset:26784
ds_read_b64_tr_b16 a[120:121], v46 offset:28704
ds_read_b64_tr_b16 a[122:123], v46 offset:28832
ds_read_b64_tr_b16 a[124:125], v46 offset:30752
ds_read_b64_tr_b16 a[126:127], v46 offset:30880
s_waitcnt lgkmcnt(0)
buffer_load_dword v50, v52, s[16:19], 0 offen
s_xor_b32 s29, s76, 0
s_lshl_b32 s28, s29, 10
s_add_u32 s28, s28, s47
s_add_u32 m0, s28, 16384
s_lshl_b32 s29, s29, 15
buffer_load_dwordx4 v41, s[16:19], s29 offen lds
s_xor_b32 s29, s76, 1
s_lshl_b32 s28, s29, 10
s_add_u32 s28, s28, s47
s_add_u32 m0, s28, 16384
s_lshl_b32 s29, s29, 15
buffer_load_dwordx4 v41, s[16:19], s29 offen lds
s_xor_b32 s29, s76, 2
s_lshl_b32 s28, s29, 10
s_add_u32 s28, s28, s47
s_add_u32 m0, s28, 16384
s_lshl_b32 s29, s29, 15
buffer_load_dwordx4 v41, s[16:19], s29 offen lds
s_xor_b32 s29, s76, 3
s_lshl_b32 s28, s29, 10
s_add_u32 s28, s28, s47
s_add_u32 m0, s28, 16384
s_lshl_b32 s29, s29, 15
buffer_load_dwordx4 v41, s[16:19], s29 offen lds
s_xor_b32 s29, s76, 4
s_lshl_b32 s28, s29, 10
s_add_u32 s28, s28, s47
s_add_u32 m0, s28, 16384
s_lshl_b32 s29, s29, 15
buffer_load_dwordx4 v41, s[16:19], s29 offen lds
s_xor_b32 s29, s76, 5
s_lshl_b32 s28, s29, 10
s_add_u32 s28, s28, s47
s_add_u32 m0, s28, 16384
s_lshl_b32 s29, s29, 15
buffer_load_dwordx4 v41, s[16:19], s29 offen lds
s_xor_b32 s29, s76, 6
s_lshl_b32 s28, s29, 10
s_add_u32 s28, s28, s47
s_add_u32 m0, s28, 16384
s_lshl_b32 s29, s29, 15
buffer_load_dwordx4 v41, s[16:19], s29 offen lds
s_xor_b32 s29, s76, 7
s_lshl_b32 s28, s29, 10
s_add_u32 s28, s28, s47
s_add_u32 m0, s28, 16384
s_lshl_b32 s29, s29, 15
buffer_load_dwordx4 v41, s[16:19], s29 offen lds
s_xor_b32 s29, s76, 8
s_lshl_b32 s28, s29, 10
s_add_u32 s28, s28, s47
s_add_u32 m0, s28, 16384
s_lshl_b32 s29, s29, 15
buffer_load_dwordx4 v41, s[16:19], s29 offen lds
s_xor_b32 s29, s76, 9
s_lshl_b32 s28, s29, 10
s_add_u32 s28, s28, s47
s_add_u32 m0, s28, 16384
s_lshl_b32 s29, s29, 15
buffer_load_dwordx4 v41, s[16:19], s29 offen lds
s_xor_b32 s29, s76, 10
s_lshl_b32 s28, s29, 10
s_add_u32 s28, s28, s47
s_add_u32 m0, s28, 16384
s_lshl_b32 s29, s29, 15
buffer_load_dwordx4 v41, s[16:19], s29 offen lds
s_xor_b32 s29, s76, 11
s_lshl_b32 s28, s29, 10
s_add_u32 s28, s28, s47
s_add_u32 m0, s28, 16384
s_lshl_b32 s29, s29, 15
buffer_load_dwordx4 v41, s[16:19], s29 offen lds
s_xor_b32 s29, s76, 12
s_lshl_b32 s28, s29, 10
s_add_u32 s28, s28, s47
s_add_u32 m0, s28, 16384
s_lshl_b32 s29, s29, 15
buffer_load_dwordx4 v41, s[16:19], s29 offen lds
s_xor_b32 s29, s76, 13
s_lshl_b32 s28, s29, 10
s_add_u32 s28, s28, s47
s_add_u32 m0, s28, 16384
s_lshl_b32 s29, s29, 15
buffer_load_dwordx4 v41, s[16:19], s29 offen lds
s_xor_b32 s29, s76, 14
s_lshl_b32 s28, s29, 10
s_add_u32 s28, s28, s47
s_add_u32 m0, s28, 16384
s_lshl_b32 s29, s29, 15
buffer_load_dwordx4 v41, s[16:19], s29 offen lds
s_xor_b32 s29, s76, 15
s_lshl_b32 s28, s29, 10
s_add_u32 s28, s28, s47
s_add_u32 m0, s28, 16384
s_lshl_b32 s29, s29, 15
buffer_load_dwordx4 v41, s[16:19], s29 offen lds
s_waitcnt vmcnt(17)
ds_read_b64_tr_b16 a[128:129], v46 offset:0
ds_read_b64_tr_b16 a[130:131], v46 offset:128
ds_read_b64_tr_b16 a[132:133], v46 offset:2048
ds_read_b64_tr_b16 a[134:135], v46 offset:2176
ds_read_b64_tr_b16 a[136:137], v46 offset:4096
ds_read_b64_tr_b16 a[138:139], v46 offset:4224
ds_read_b64_tr_b16 a[140:141], v46 offset:6144
ds_read_b64_tr_b16 a[142:143], v46 offset:6272
s_waitcnt lgkmcnt(0)
ds_read_b64_tr_b16 a[144:145], v46 offset:8192
ds_read_b64_tr_b16 a[146:147], v46 offset:8320
ds_read_b64_tr_b16 a[148:149], v46 offset:10240
ds_read_b64_tr_b16 a[150:151], v46 offset:10368
ds_read_b64_tr_b16 a[152:153], v46 offset:12288
ds_read_b64_tr_b16 a[154:155], v46 offset:12416
ds_read_b64_tr_b16 a[156:157], v46 offset:14336
ds_read_b64_tr_b16 a[158:159], v46 offset:14464
s_waitcnt lgkmcnt(0)
ds_read_b64_tr_b16 a[160:161], v46 offset:32
ds_read_b64_tr_b16 a[162:163], v46 offset:160
ds_read_b64_tr_b16 a[164:165], v46 offset:2080
ds_read_b64_tr_b16 a[166:167], v46 offset:2208
ds_read_b64_tr_b16 a[168:169], v46 offset:4128
ds_read_b64_tr_b16 a[170:171], v46 offset:4256
ds_read_b64_tr_b16 a[172:173], v46 offset:6176
ds_read_b64_tr_b16 a[174:175], v46 offset:6304
s_waitcnt lgkmcnt(0)
ds_read_b64_tr_b16 a[176:177], v46 offset:8224
ds_read_b64_tr_b16 a[178:179], v46 offset:8352
ds_read_b64_tr_b16 a[180:181], v46 offset:10272
ds_read_b64_tr_b16 a[182:183], v46 offset:10400
ds_read_b64_tr_b16 a[184:185], v46 offset:12320
ds_read_b64_tr_b16 a[186:187], v46 offset:12448
ds_read_b64_tr_b16 a[188:189], v46 offset:14368
ds_read_b64_tr_b16 a[190:191], v46 offset:14496
s_waitcnt lgkmcnt(0)
s_waitcnt vmcnt(0)
ds_read_b64_tr_b16 a[192:193], v47 offset:16384
ds_read_b64_tr_b16 a[194:195], v47 offset:16512
ds_read_b64_tr_b16 a[196:197], v47 offset:18432
ds_read_b64_tr_b16 a[198:199], v47 offset:18560
ds_read_b64_tr_b16 a[200:201], v47 offset:20480
ds_read_b64_tr_b16 a[202:203], v47 offset:20608
ds_read_b64_tr_b16 a[204:205], v47 offset:22528
ds_read_b64_tr_b16 a[206:207], v47 offset:22656
s_waitcnt lgkmcnt(0)
ds_read_b64_tr_b16 a[208:209], v47 offset:24576
ds_read_b64_tr_b16 a[210:211], v47 offset:24704
ds_read_b64_tr_b16 a[212:213], v47 offset:26624
ds_read_b64_tr_b16 a[214:215], v47 offset:26752
ds_read_b64_tr_b16 a[216:217], v47 offset:28672
ds_read_b64_tr_b16 a[218:219], v47 offset:28800
ds_read_b64_tr_b16 a[220:221], v47 offset:30720
ds_read_b64_tr_b16 a[222:223], v47 offset:30848
s_waitcnt lgkmcnt(0)
ds_read_b64_tr_b16 a[224:225], v47 offset:16416
ds_read_b64_tr_b16 a[226:227], v47 offset:16544
ds_read_b64_tr_b16 a[228:229], v47 offset:18464
ds_read_b64_tr_b16 a[230:231], v47 offset:18592
ds_read_b64_tr_b16 a[232:233], v47 offset:20512
ds_read_b64_tr_b16 a[234:235], v47 offset:20640
ds_read_b64_tr_b16 a[236:237], v47 offset:22560
ds_read_b64_tr_b16 a[238:239], v47 offset:22688
s_waitcnt lgkmcnt(0)
ds_read_b64_tr_b16 a[240:241], v47 offset:24608
ds_read_b64_tr_b16 a[242:243], v47 offset:24736
ds_read_b64_tr_b16 a[244:245], v47 offset:26656
ds_read_b64_tr_b16 a[246:247], v47 offset:26784
ds_read_b64_tr_b16 a[248:249], v47 offset:28704
ds_read_b64_tr_b16 a[250:251], v47 offset:28832
ds_read_b64_tr_b16 a[252:253], v47 offset:30752
ds_read_b64_tr_b16 a[254:255], v47 offset:30880
s_waitcnt lgkmcnt(0)
v_and_b32 v5, 15, v0
v_lshlrev_b32 v5, 4, v5
s_branch mega_kernel_sys
mega_kernel_sysw:
s_sleep 4
mega_kernel_sys:
buffer_load_dword v4, v5, s[72:75], 0 offen sc1
s_waitcnt vmcnt(0)
s_cmp_eq_u32 s95, 1
s_cbranch_scc0 mega_kernel_sysf
v_readlane_b32 s76, v4, 14
s_mov_b32 s98, 0
s_cmp_eq_u32 s76, 64
s_cbranch_scc0 mega_kernel_sysw
s_branch mega_kernel_sysd
mega_kernel_sysf:
s_mov_b32 s77, 0
s_mov_b32 s78, 0
v_readlane_b32 s76, v4, 0
s_add_u32 s77, s77, s76
s_xor_b32 s76, s76, 32
s_or_b32 s78, s78, s76
v_readlane_b32 s76, v4, 1
s_add_u32 s77, s77, s76
s_xor_b32 s76, s76, 32
s_or_b32 s78, s78, s76
v_readlane_b32 s76, v4, 2
s_add_u32 s77, s77, s76
s_xor_b32 s76, s76, 32
s_or_b32 s78, s78, s76
v_readlane_b32 s76, v4, 3
s_add_u32 s77, s77, s76
s_xor_b32 s76, s76, 32
s_or_b32 s78, s78, s76
v_readlane_b32 s76, v4, 4
s_add_u32 s77, s77, s76
s_xor_b32 s76, s76, 32
s_or_b32 s78, s78, s76
v_readlane_b32 s76, v4, 5
s_add_u32 s77, s77, s76
s_xor_b32 s76, s76, 32
s_or_b32 s78, s78, s76
v_readlane_b32 s76, v4, 6
s_add_u32 s77, s77, s76
s_xor_b32 s76, s76, 32
s_or_b32 s78, s78, s76
v_readlane_b32 s76, v4, 7
s_add_u32 s77, s77, s76
s_xor_b32 s76, s76, 32
s_or_b32 s78, s78, s76
s_cmp_eq_u32 s77, 256
s_cbranch_scc0 mega_kernel_sysw
v_mov_b32 v252, v4
s_cmp_eq_u32 s78, 0
s_cbranch_scc0 mega_kernel_slowent
v_readlane_b32 s76, v4, 10
v_readlane_b32 s77, v4, 8
s_cmp_eq_u32 s76, 64
s_cbranch_scc0 mega_kernel_sysw
s_cmp_gt_u32 s77, 32
s_cselect_b32 s98, 1, 0
mega_kernel_sysd:
s_lshr_b32 s28, s31, 3
s_lshl_b32 s28, s28, 14
s_lshl_b32 s29, s98, 13
s_add_u32 s28, s28, s29
s_and_b32 s29, s31, 7
s_lshl_b32 s29, s29, 10
s_add_u32 s28, s28, s29
s_lshl_b32 s29, s30, 16
s_add_u32 s28, s28, s29
s_add_u32 s28, s28, 67108864
v_add_u32 v12, s28, v17
v_xor_b32 v25, 0x10000, v12
v_xor_b32 v26, 0x20000, v12
v_xor_b32 v27, 0x30000, v12
s_lshl_b32 s28, s25, 2
s_add_u32 s28, s28, s26
s_mov_b32 s82, s28
s_lshr_b32 s29, s28, 3
s_xor_b32 s29, s29, s98
s_and_b32 s29, s29, 1
s_lshl_b32 s29, s29, 13
s_lshl_b32 s76, s28, 18
s_add_u32 s76, s76, s29
s_mov_b32 s83, s76
v_add_u32 v240, s76, v17
v_add_u32 v241, 33554432, v240
s_lshr_b32 s29, s28, 4
s_xor_b32 s29, s29, s98
s_and_b32 s29, s29, 1
s_lshl_b32 s29, s29, 13
s_lshl_b32 s79, s28, 17
s_add_u32 s79, s79, s29
s_add_u32 s79, s79, 71303168
s_xor_b32 s29, s98, 1
s_lshl_b32 s29, s29, 13
s_lshl_b32 s28, s25, 7
s_add_u32 s28, s28, s29
s_add_u32 s28, s28, 69206016
v_and_b32 v4, 1, v1
v_lshlrev_b32 v24, 12, v4
v_add_u32 v24, s28, v24
s_lshl_b32 s29, s26, 2
v_add_u32 v24, s29, v24
s_xor_b32 s81, s98, 1
s_lshl_b32 s81, s81, 13
s_lshr_b32 s29, s82, 6
s_lshl_b32 s29, s29, 14
s_add_u32 s81, s81, s29
s_and_b32 s29, s82, 63
s_lshl_b32 s29, s29, 7
s_add_u32 s81, s81, s29
s_add_u32 s81, s81, 69222400
v_mov_b32 v220, 0x3f803f80
v_mov_b32 v221, 0x3f803f80
v_mov_b32 v222, 0x3f803f80
v_mov_b32 v223, 0x3f803f80
v_mov_b32 v228, 0
s_mov_b32 s27, 0
s_mov_b32 s46, 0
s_mov_b32 s44, 18432
s_mov_b32 s45, 18432
s_cmp_eq_u32 s24, 3
s_cbranch_scc0 mega_kernel_rs_pfi
s_mov_b32 s76, 0
s_cmp_gt_i32 s46, s76
s_cbranch_scc1 mega_kernel_rs_pf0ok
mega_kernel_rs_pf0w:
buffer_load_dword v4, v24, s[84:87], 0 offen sc1
s_waitcnt vmcnt(0)
v_readlane_b32 s46, v4, 0
v_readlane_b32 s28, v4, 1
s_nop 1
s_min_i32 s46, s46, s28
s_cmp_gt_i32 s46, s76
s_cbranch_scc0 mega_kernel_rs_pf0w
mega_kernel_rs_pf0ok:
s_add_u32 s77, s76, s82
s_bfe_u32 s28, s77, 0x40002
s_lshl_b32 s28, s28, 14
s_and_b32 s77, s77, 3
s_lshl_b32 s77, s77, 11
s_add_u32 s28, s28, s77
s_add_u32 m0, s45, 0
s_nop 0
buffer_load_dwordx4 v240, s[84:87], s28 offen offset:0 sc1 lds
s_add_u32 m0, s45, 0
s_nop 0
buffer_load_dwordx4 v240, s[84:87], s28 offen offset:1024 sc1 lds
s_add_u32 m0, s45, 2048
s_nop 0
buffer_load_dwordx4 v241, s[84:87], s28 offen offset:0 sc1 lds
s_add_u32 m0, s45, 2048
s_nop 0
buffer_load_dwordx4 v241, s[84:87], s28 offen offset:1024 sc1 lds
s_add_u32 s45, s45, 4096
s_cmp_eq_u32 s45, 30720
s_cselect_b32 s45, 18432, s45
s_waitcnt vmcnt(0) lgkmcnt(0)
mega_kernel_rs_pfi:
v_mov_b32 v96, 0
v_mov_b32 v97, 0
v_mov_b32 v98, 0
v_mov_b32 v99, 0
v_mov_b32 v100, 0
v_mov_b32 v101, 0
v_mov_b32 v102, 0
v_mov_b32 v103, 0
v_mov_b32 v104, 0
v_mov_b32 v105, 0
v_mov_b32 v106, 0
v_mov_b32 v107, 0
v_mov_b32 v108, 0
v_mov_b32 v109, 0
v_mov_b32 v110, 0
v_mov_b32 v111, 0
v_mov_b32 v112, 0
v_mov_b32 v113, 0
v_mov_b32 v114, 0
v_mov_b32 v115, 0
v_mov_b32 v116, 0
v_mov_b32 v117, 0
v_mov_b32 v118, 0
v_mov_b32 v119, 0
s_barrier
s_and_b32 s29, s27, 1
s_lshl_b32 s33, s29, 17
s_lshl_b32 s28, s30, 18
s_add_u32 s33, s33, s28
s_add_u32 s33, s33, 68157440
s_xor_b32 s34, s33, 131072
s_lshl_b32 s35, s29, 18
s_bfe_u32 s47, s27, 0x10001
s_branch mega_kernel_rs_first
mega_kernel_rs_loop:
buffer_load_dwordx4 v[32:35], v7, s[84:87], s33 offen offset:0 sc1
v_add_u32 v5, s44, v17
ds_read_b128 v[156:159], v5 offset:0
ds_read_b128 v[160:163], v5 offset:1024
ds_read_b128 v[164:167], v5 offset:2048
ds_read_b128 v[168:171], v5 offset:3072
s_nop 4
buffer_load_dwordx4 v[36:39], v7, s[84:87], s33 offen offset:1024 sc1
s_nop 9
buffer_load_dwordx4 v[40:43], v7, s[84:87], s33 offen offset:2048 sc1
s_nop 9
buffer_load_dwordx4 v[44:47], v7, s[84:87], s33 offen offset:3072 sc1
s_waitcnt vmcnt(3)
v_max_u32 v4, v32, v34
v_cmp_eq_u32 vcc, -1, v4
s_cbranch_vccnz mega_kernel_rs_pa_15_0f
v_smfmac_f32_16x16x64_bf16 v[96:99], v[32:35], a[0:7], v6
v_smfmac_f32_16x16x64_bf16 v[100:103], v[32:35], a[32:39], v6
v_smfmac_f32_16x16x64_bf16 v[104:107], v[32:35], a[64:71], v6
s_waitcnt vmcnt(2)
v_max_u32 v4, v36, v38
v_cmp_eq_u32 vcc, -1, v4
v_smfmac_f32_16x16x64_bf16 v[108:111], v[32:35], a[96:103], v6
s_cbranch_vccnz mega_kernel_rs_pa_14_1f
v_smfmac_f32_16x16x64_bf16 v[96:99], v[36:39], a[8:15], v6
v_smfmac_f32_16x16x64_bf16 v[100:103], v[36:39], a[40:47], v6
v_smfmac_f32_16x16x64_bf16 v[104:107], v[36:39], a[72:79], v6
s_waitcnt vmcnt(1)
v_max_u32 v4, v40, v42
v_cmp_eq_u32 vcc, -1, v4
v_smfmac_f32_16x16x64_bf16 v[108:111], v[36:39], a[104:111], v6
s_cbranch_vccnz mega_kernel_rs_pa_12_2f
v_smfmac_f32_16x16x64_bf16 v[96:99], v[40:43], a[16:23], v6
v_smfmac_f32_16x16x64_bf16 v[100:103], v[40:43], a[48:55], v6
v_smfmac_f32_16x16x64_bf16 v[104:107], v[40:43], a[80:87], v6
s_waitcnt vmcnt(0)
v_max_u32 v4, v44, v46
v_cmp_eq_u32 vcc, -1, v4
v_smfmac_f32_16x16x64_bf16 v[108:111], v[40:43], a[112:119], v6
s_cbranch_vccnz mega_kernel_rs_pa_8_3f
v_smfmac_f32_16x16x64_bf16 v[96:99], v[44:47], a[24:31], v6
v_smfmac_f32_16x16x64_bf16 v[100:103], v[44:47], a[56:63], v6
v_smfmac_f32_16x16x64_bf16 v[104:107], v[44:47], a[88:95], v6
v_smfmac_f32_16x16x64_bf16 v[108:111], v[44:47], a[120:127], v6
mega_kernel_rs_pa_d:
mega_kernel_rs_adone:
s_nop 5
v_permlane32_swap_b32 v96, v100
v_permlane32_swap_b32 v97, v101
v_permlane32_swap_b32 v98, v102
v_permlane32_swap_b32 v99, v103
v_pk_add_f32 v[96:97], v[96:97], v[100:101]
v_pk_add_f32 v[98:99], v[98:99], v[102:103]
ds_write2_b32 v14, v96, v97 offset0:0 offset1:36
ds_write2_b32 v14, v98, v99 offset0:72 offset1:108
v_permlane32_swap_b32 v104, v108
v_permlane32_swap_b32 v105, v109
v_permlane32_swap_b32 v106, v110
v_permlane32_swap_b32 v107, v111
v_pk_add_f32 v[104:105], v[104:105], v[108:109]
v_pk_add_f32 v[106:107], v[106:107], v[110:111]
ds_write2_b32 v15, v104, v105 offset0:0 offset1:36
ds_write2_b32 v15, v106, v107 offset0:72 offset1:108
v_smfmac_f32_16x16x64_bf16 v[112:115], v[32:35], a[128:135], v6
v_smfmac_f32_16x16x64_bf16 v[116:119], v[32:35], a[160:167], v6
v_smfmac_f32_16x16x64_bf16 v[112:115], v[36:39], a[136:143], v6
v_smfmac_f32_16x16x64_bf16 v[116:119], v[36:39], a[168:175], v6
s_waitcnt lgkmcnt(0)
s_barrier
s_cmp_lg_u32 s24, 0
s_cbranch_scc1 mega_kernel_rs_side
ds_read_b128 v[120:123], v16 offset:0
ds_read_b128 v[124:127], v16 offset:16
ds_read_b128 v[128:131], v16 offset:2304
ds_read_b128 v[132:135], v16 offset:2320
ds_read_b128 v[136:139], v16 offset:4608
ds_read_b128 v[140:143], v16 offset:4624
ds_read_b128 v[144:147], v16 offset:6912
ds_read_b128 v[148:151], v16 offset:6928
v_smfmac_f32_16x16x64_bf16 v[112:115], v[40:43], a[144:151], v6
v_smfmac_f32_16x16x64_bf16 v[116:119], v[40:43], a[176:183], v6
v_smfmac_f32_16x16x64_bf16 v[112:115], v[44:47], a[152:159], v6
v_smfmac_f32_16x16x64_bf16 v[116:119], v[44:47], a[184:191], v6
s_lshl_b32 s28, s31, 11
s_add_u32 s28, s28, s33
s_add_u32 s28, s28, 32768
s_add_u32 s76, s37, s33
s_add_u32 s77, s38, s33
s_add_u32 s78, s39, s33
s_waitcnt lgkmcnt(4)
v_pk_add_f32 v[120:121], v[120:121], v[128:129]
v_pk_add_f32 v[122:123], v[122:123], v[130:131]
v_pk_add_f32 v[124:125], v[124:125], v[132:133]
v_pk_add_f32 v[126:127], v[126:127], v[134:135]
s_waitcnt lgkmcnt(0)
v_pk_add_f32 v[136:137], v[136:137], v[144:145]
v_pk_add_f32 v[138:139], v[138:139], v[146:147]
v_pk_add_f32 v[140:141], v[140:141], v[148:149]
v_pk_add_f32 v[142:143], v[142:143], v[150:151]
v_pk_add_f32 v[120:121], v[120:121], v[136:137]
v_pk_add_f32 v[122:123], v[122:123], v[138:139]
v_pk_add_f32 v[124:125], v[124:125], v[140:141]
v_pk_add_f32 v[126:127], v[126:127], v[142:143]
v_cvt_pk_bf16_f32 v152, v120, v121
v_cvt_pk_bf16_f32 v153, v122, v123
v_cvt_pk_bf16_f32 v154, v124, v125
v_cvt_pk_bf16_f32 v155, v126, v127
s_nop 1
v_mfma_f32_16x16x32_bf16 v[176:179], v[160:163], v[152:155], 0
v_mfma_f32_16x16x32_bf16 v[172:175], v[156:159], v[152:155], 0
v_mfma_f32_16x16x32_bf16 v[180:183], v[152:155], v[152:155], 0
s_cmp_eq_u32 s27, 63
s_cbranch_scc1 mega_kernel_rs_w0last
s_nop 4
v_mov_b32_dpp v172, v176 row_shr:8 row_mask:0xf bank_mask:0xc
v_mov_b32_dpp v173, v177 row_shr:8 row_mask:0xf bank_mask:0xc
v_mov_b32_dpp v174, v178 row_shr:8 row_mask:0xf bank_mask:0xc
v_mov_b32_dpp v175, v179 row_shr:8 row_mask:0xf bank_mask:0xc
v_min_u32 v180, -2, v180
v_min_u32 v172, -2, v172
s_mov_b64 exec, s[42:43]
buffer_store_dwordx4 v[180:183], v10, s[84:87], s28 offen sc1
s_mov_b64 exec, -1
buffer_store_dwordx4 v[172:175], v17, s[84:87], s28 offen sc1
v_permlane32_swap_b32 v112, v116
v_permlane32_swap_b32 v113, v117
v_permlane32_swap_b32 v114, v118
v_permlane32_swap_b32 v115, v119
v_pk_add_f32 v[112:113], v[112:113], v[116:117]
v_pk_add_f32 v[114:115], v[114:115], v[118:119]
ds_write_b128 v20, v[112:115]
s_waitcnt lgkmcnt(0)
s_barrier
v_mov_b32 v96, 0
v_mov_b32 v97, 0
v_mov_b32 v98, 0
v_mov_b32 v99, 0
v_mov_b32 v100, 0
v_mov_b32 v101, 0
v_mov_b32 v102, 0
v_mov_b32 v103, 0
v_cndmask_b32 v176, v23, v180, s[42:43]
v_cndmask_b32 v177, v23, v181, s[42:43]
v_cndmask_b32 v178, v23, v182, s[42:43]
v_cndmask_b32 v179, v23, v183, s[42:43]
buffer_load_dwordx4 v[184:187], v17, s[84:87], s76 offen sc1
buffer_load_dwordx4 v[188:191], v10, s[84:87], s76 offen sc1
buffer_load_dwordx4 v[192:195], v17, s[84:87], s77 offen sc1
buffer_load_dwordx4 v[196:199], v10, s[84:87], s77 offen sc1
buffer_load_dwordx4 v[200:203], v17, s[84:87], s78 offen sc1
buffer_load_dwordx4 v[204:207], v10, s[84:87], s78 offen sc1
s_nop 15
s_nop 7
buffer_load_dwordx4 v[184:187], v17, s[84:87], s76 offen sc1
buffer_load_dwordx4 v[188:191], v10, s[84:87], s76 offen sc1
buffer_load_dwordx4 v[192:195], v17, s[84:87], s77 offen sc1
buffer_load_dwordx4 v[196:199], v10, s[84:87], s77 offen sc1
buffer_load_dwordx4 v[200:203], v17, s[84:87], s78 offen sc1
buffer_load_dwordx4 v[204:207], v10, s[84:87], s78 offen sc1
mega_kernel_rs_p2:
s_waitcnt vmcnt(6)
v_max3_u32 v4, v184, v188, v192
v_max3_u32 v5, v196, v200, v204
v_max_u32 v4, v4, v5
v_cmp_eq_u32 vcc, -1, v4
s_cbranch_vccnz mega_kernel_rs_p2r
v_pk_add_f32 v[176:177], v[176:177], v[188:189]
v_pk_add_f32 v[124:125], v[196:197], v[204:205]
v_pk_add_f32 v[178:179], v[178:179], v[190:191]
v_pk_add_f32 v[126:127], v[198:199], v[206:207]
v_pk_add_f32 v[172:173], v[172:173], v[184:185]
v_pk_add_f32 v[120:121], v[192:193], v[200:201]
v_pk_add_f32 v[174:175], v[174:175], v[186:187]
v_pk_add_f32 v[122:123], v[194:195], v[202:203]
v_pk_add_f32 v[176:177], v[176:177], v[124:125]
v_pk_add_f32 v[178:179], v[178:179], v[126:127]
v_pk_add_f32 v[172:173], v[172:173], v[120:121]
v_pk_add_f32 v[174:175], v[174:175], v[122:123]
v_max3_f32 v232, v172, v173, v174
v_max3_f32 v233, v176, v177, v178
v_max3_f32 v232, v232, v175, v179
v_max_f32 v234, v232, v233
s_barrier
ds_read2_b64 v[208:211], v21 offset0:0 offset1:32
v_max_f32_dpp v232, v234, v234 row_ror:8 row_mask:0xf bank_mask:0xf
v_max_f32_dpp v233, v234, v234 row_ror:8 row_mask:0xf bank_mask:0xf
s_nop 1
v_permlane16_swap_b32 v232, v233
s_nop 0
v_max_f32 v234, v232, v233
v_max_f32 v235, v232, v233
s_nop 1
v_permlane32_swap_b32 v234, v235
s_nop 0
v_max_f32 v232, v234, v235
v_mul_f32 v232, s32, v232
v_pk_fma_f32 v[176:177], v[176:177], s[32:33], v[232:233] op_sel_hi:[1,0,0] neg_lo:[0,0,1] neg_hi:[0,0,1]
v_pk_fma_f32 v[178:179], v[178:179], s[32:33], v[232:233] op_sel_hi:[1,0,0] neg_lo:[0,0,1] neg_hi:[0,0,1]
v_pk_fma_f32 v[172:173], v[172:173], s[32:33], v[232:233] op_sel_hi:[1,0,0] neg_lo:[0,0,1] neg_hi:[0,0,1]
v_pk_fma_f32 v[174:175], v[174:175], s[32:33], v[232:233] op_sel_hi:[1,0,0] neg_lo:[0,0,1] neg_hi:[0,0,1]
v_exp_f32 v176, v176
v_exp_f32 v177, v177
v_exp_f32 v178, v178
v_exp_f32 v179, v179
v_exp_f32 v172, v172
v_cvt_pk_bf16_f32 v216, v176, v177
v_cvt_pk_bf16_f32 v217, v178, v179
v_exp_f32 v173, v173
v_exp_f32 v174, v174
v_mfma_f32_16x16x16_bf16 v[224:227], v[220:221], v[216:217], 0
v_exp_f32 v175, v175
v_cvt_pk_bf16_f32 v212, v172, v173
s_waitcnt lgkmcnt(0)
v_mfma_f32_16x16x16_bf16 v[120:123], v[208:209], v[216:217], 0
v_cvt_pk_bf16_f32 v213, v174, v175
v_mfma_f32_16x16x16_bf16 v[124:127], v[210:211], v[216:217], 0
v_mov_b32_dpp v214, v212 row_ror:8 row_mask:0xf bank_mask:0xf
v_mov_b32_dpp v215, v213 row_ror:8 row_mask:0xf bank_mask:0xf
s_nop 1
v_mfma_f32_16x16x32_bf16 v[224:227], v[220:223], v[212:215], v[224:227]
v_mfma_f32_16x16x32_bf16 v[120:123], v[164:167], v[212:215], v[120:123]
v_mfma_f32_16x16x32_bf16 v[124:127], v[168:171], v[212:215], v[124:127]
s_add_u32 s29, s33, 16384
s_nop 4
v_rcp_f32 v234, v224
s_nop 0
v_pk_mul_f32 v[120:121], v[120:121], v[234:235] op_sel_hi:[1,0]
v_pk_mul_f32 v[122:123], v[122:123], v[234:235] op_sel_hi:[1,0]
v_pk_mul_f32 v[124:125], v[124:125], v[234:235] op_sel_hi:[1,0]
v_pk_mul_f32 v[126:127], v[126:127], v[234:235] op_sel_hi:[1,0]
v_cvt_pk_bf16_f32 v212, v120, v121
v_cvt_pk_bf16_f32 v213, v122, v123
v_cvt_pk_bf16_f32 v214, v124, v125
v_cvt_pk_bf16_f32 v215, v126, v127
v_min_u32 v212, -2, v212
s_mov_b64 exec, s[40:41]
buffer_store_dwordx4 v[212:215], v11, s[84:87], s33 offen sc1
s_mov_b64 exec, -1
mega_kernel_rs_b3:
s_barrier
s_nop 9
buffer_load_dwordx4 v[32:35], v7, s[84:87], s29 offen offset:0 sc1
s_nop 9
buffer_load_dwordx4 v[36:39], v7, s[84:87], s29 offen offset:1024 sc1
s_nop 9
buffer_load_dwordx4 v[40:43], v7, s[84:87], s29 offen offset:2048 sc1
s_nop 9
buffer_load_dwordx4 v[44:47], v7, s[84:87], s29 offen offset:3072 sc1
mega_kernel_rs_pc_15_0:
s_waitcnt vmcnt(3)
v_cmp_eq_u32 vcc, -1, v32
s_cbranch_vccnz mega_kernel_rs_pc_15_0f
v_smfmac_f32_16x16x64_bf16 v[96:99], v[32:35], a[192:199], v6
v_smfmac_f32_16x16x64_bf16 v[100:103], v[32:35], a[224:231], v6
mega_kernel_rs_pc_14_1:
s_waitcnt vmcnt(2)
v_cmp_eq_u32 vcc, -1, v36
s_cbranch_vccnz mega_kernel_rs_pc_14_1f
v_smfmac_f32_16x16x64_bf16 v[96:99], v[36:39], a[200:207], v6
v_smfmac_f32_16x16x64_bf16 v[100:103], v[36:39], a[232:239], v6
mega_kernel_rs_pc_12_2:
s_waitcnt vmcnt(1)
v_cmp_eq_u32 vcc, -1, v40
s_cbranch_vccnz mega_kernel_rs_pc_12_2f
v_smfmac_f32_16x16x64_bf16 v[96:99], v[40:43], a[208:215], v6
v_smfmac_f32_16x16x64_bf16 v[100:103], v[40:43], a[240:247], v6
mega_kernel_rs_pc_8_3:
s_waitcnt vmcnt(0)
v_cmp_eq_u32 vcc, -1, v44
s_cbranch_vccnz mega_kernel_rs_pc_8_3f
v_smfmac_f32_16x16x64_bf16 v[96:99], v[44:47], a[216:223], v6
v_smfmac_f32_16x16x64_bf16 v[100:103], v[44:47], a[248:255], v6
mega_kernel_rs_pc_d:
s_nop 7
v_permlane32_swap_b32 v96, v100
v_permlane32_swap_b32 v97, v101
v_permlane32_swap_b32 v98, v102
v_permlane32_swap_b32 v99, v103
v_pk_add_f32 v[96:97], v[96:97], v[100:101]
v_pk_add_f32 v[98:99], v[98:99], v[102:103]
ds_write2_b32 v18, v96, v97 offset0:0 offset1:36
ds_write2_b32 v18, v98, v99 offset0:72 offset1:108
s_waitcnt lgkmcnt(0)
s_barrier
s_cmp_lg_u32 s24, 0
s_cbranch_scc1 mega_kernel_rs_x1
ds_read_b128 v[120:123], v19 offset:0
ds_read_b128 v[124:127], v19 offset:1152
ds_read_b128 v[128:131], v19 offset:2304
ds_read_b128 v[132:135], v19 offset:3456
s_waitcnt lgkmcnt(2)
v_pk_add_f32 v[120:121], v[120:121], v[124:125]
v_pk_add_f32 v[122:123], v[122:123], v[126:127]
s_waitcnt lgkmcnt(0)
v_pk_add_f32 v[128:129], v[128:129], v[132:133]
v_pk_add_f32 v[130:131], v[130:131], v[134:135]
v_pk_add_f32 v[120:121], v[120:121], v[128:129]
v_pk_add_f32 v[122:123], v[122:123], v[130:131]
v_and_or_b32 v120, v120, -2, s47
v_and_or_b32 v121, v121, -2, s47
v_and_or_b32 v122, v122, -2, s47
v_and_or_b32 v123, v123, -2, s47
buffer_store_dwordx4 v[120:123], v12, s[84:87], s35 offen sc1
s_xor_b32 s76, s47, 1
v_mov_b32 v48, s76
v_mov_b32 v49, s76
v_mov_b32 v50, s76
v_mov_b32 v51, s76
v_mov_b32 v52, s76
v_mov_b32 v53, s76
v_mov_b32 v54, s76
v_mov_b32 v55, s76
v_mov_b32 v56, s76
v_mov_b32 v57, s76
v_mov_b32 v58, s76
v_mov_b32 v59, s76
v_mov_b32 v96, 0
v_mov_b32 v97, 0
v_mov_b32 v98, 0
v_mov_b32 v99, 0
v_mov_b32 v100, 0
v_mov_b32 v101, 0
v_mov_b32 v102, 0
v_mov_b32 v103, 0
v_mov_b32 v104, 0
v_mov_b32 v105, 0
v_mov_b32 v106, 0
v_mov_b32 v107, 0
v_mov_b32 v108, 0
v_mov_b32 v109, 0
v_mov_b32 v110, 0
v_mov_b32 v111, 0
v_mov_b32 v112, 0
v_mov_b32 v113, 0
v_mov_b32 v114, 0
v_mov_b32 v115, 0
v_mov_b32 v116, 0
v_mov_b32 v117, 0
v_mov_b32 v118, 0
v_mov_b32 v119, 0
s_nop 15
s_cmp_eq_u32 s47, 1
s_cbranch_scc1 mega_kernel_rs_p4_1
mega_kernel_rs_p4_0:
buffer_load_dwordx4 v[48:51], v25, s[84:87], s35 offen sc1
buffer_load_dwordx4 v[52:55], v26, s[84:87], s35 offen sc1
buffer_load_dwordx4 v[56:59], v27, s[84:87], s35 offen sc1
s_waitcnt vmcnt(36)
s_nop 1
v_bitop3_b32 v4, v48, v49, v50 bitop3:0xfe
v_bitop3_b32 v5, v54, v55, v56 bitop3:0xfe
v_bitop3_b32 v4, v4, v51, v52 bitop3:0xfe
v_bitop3_b32 v5, v5, v57, v58 bitop3:0xfe
v_bitop3_b32 v4, v4, v53, v59 bitop3:0xfe
v_bitop3_b32 v4, v4, v5, 1 bitop3:0xa8
v_cmp_ne_u32 vcc, 0, v4
s_cbranch_vccnz mega_kernel_rs_p4_0
s_branch mega_kernel_rs_p4d
mega_kernel_rs_p4_1:
buffer_load_dwordx4 v[48:51], v25, s[84:87], s35 offen sc1
buffer_load_dwordx4 v[52:55], v26, s[84:87], s35 offen sc1
buffer_load_dwordx4 v[56:59], v27, s[84:87], s35 offen sc1
s_waitcnt vmcnt(36)
s_nop 1
v_bitop3_b32 v4, v48, v49, v50 bitop3:0x80
v_bitop3_b32 v5, v54, v55, v56 bitop3:0x80
v_bitop3_b32 v4, v4, v51, v52 bitop3:0x80
v_bitop3_b32 v5, v5, v57, v58 bitop3:0x80
v_bitop3_b32 v4, v4, v53, v59 bitop3:0x80
v_bitop3_b32 v4, v4, v5, 1 bitop3:0x80
v_cmp_ne_u32 vcc, 1, v4
s_cbranch_vccnz mega_kernel_rs_p4_1
mega_kernel_rs_p4d:
v_pk_add_f32 v[120:121], v[120:121], v[48:49]
v_pk_add_f32 v[124:125], v[52:53], v[56:57]
v_pk_add_f32 v[122:123], v[122:123], v[50:51]
v_pk_add_f32 v[126:127], v[54:55], v[58:59]
v_pk_add_f32 v[120:121], v[120:121], v[124:125]
v_pk_add_f32 v[122:123], v[122:123], v[126:127]
v_cvt_pk_bf16_f32 v212, v120, v121
v_cvt_pk_bf16_f32 v213, v122, v123
v_min_u32 v212, -2, v212
buffer_store_dwordx2 v[212:213], v9, s[84:87], s34 offen sc1
mega_kernel_rs_b5:
s_add_u32 s27, s27, 1
s_add_u32 s44, s44, 4096
s_cmp_eq_u32 s44, 30720
s_cselect_b32 s44, 18432, s44
s_mov_b32 s28, s33
s_mov_b32 s33, s34
s_mov_b32 s34, s28
s_xor_b32 s35, s35, 262144
s_bfe_u32 s47, s27, 0x10001
s_barrier
s_nop 9
s_branch mega_kernel_rs_loop
mega_kernel_rs_x1:
s_cmp_eq_u32 s24, 1
s_cbranch_scc0 mega_kernel_rs_x2
s_add_u32 s76, s27, 1
v_mov_b32 v5, s76
s_mov_b64 exec, 1
buffer_store_dword v5, v228, s[84:87], s81 offen sc1
s_mov_b64 exec, -1
mega_kernel_rs_x2:
s_cmp_eq_u32 s24, 3
s_cbranch_scc0 mega_kernel_rs_x4
s_cmp_eq_u32 s36, 1
s_cbranch_scc0 mega_kernel_rs_x5
s_add_u32 s76, s27, 1
s_cmp_gt_i32 s46, s76
s_cbranch_scc1 mega_kernel_rs_pf1ok
mega_kernel_rs_pf1w:
buffer_load_dword v4, v24, s[84:87], 0 offen sc1
s_waitcnt vmcnt(0)
v_readlane_b32 s46, v4, 0
v_readlane_b32 s28, v4, 1
s_nop 1
s_min_i32 s46, s46, s28
s_cmp_gt_i32 s46, s76
s_cbranch_scc0 mega_kernel_rs_pf1w
mega_kernel_rs_pf1ok:
s_add_u32 s77, s76, s82
s_bfe_u32 s28, s77, 0x40002
s_lshl_b32 s28, s28, 14
s_and_b32 s77, s77, 3
s_lshl_b32 s77, s77, 11
s_add_u32 s28, s28, s77
s_add_u32 m0, s45, 0
s_nop 0
buffer_load_dwordx4 v240, s[84:87], s28 offen offset:0 sc1 lds
s_add_u32 m0, s45, 0
s_nop 0
buffer_load_dwordx4 v240, s[84:87], s28 offen offset:1024 sc1 lds
s_add_u32 m0, s45, 2048
s_nop 0
buffer_load_dwordx4 v241, s[84:87], s28 offen offset:0 sc1 lds
s_add_u32 m0, s45, 2048
s_nop 0
buffer_load_dwordx4 v241, s[84:87], s28 offen offset:1024 sc1 lds
s_add_u32 s45, s45, 4096
s_cmp_eq_u32 s45, 30720
s_cselect_b32 s45, 18432, s45
s_waitcnt vmcnt(0)
mega_kernel_rs_x5:
s_add_u32 s76, s27, 3
s_min_u32 s76, s76, 63
s_cmp_gt_i32 s46, s76
s_cbranch_scc1 mega_kernel_rs_pf2ok
mega_kernel_rs_pf2w:
buffer_load_dword v4, v24, s[84:87], 0 offen sc1
s_waitcnt vmcnt(0)
v_readlane_b32 s46, v4, 0
v_readlane_b32 s28, v4, 1
s_nop 1
s_min_i32 s46, s46, s28
s_cmp_gt_i32 s46, s76
s_cbranch_scc0 mega_kernel_rs_x6
mega_kernel_rs_pf2ok:
mega_kernel_rs_x6:
s_add_u32 s76, s27, 2
s_cmp_lt_u32 s76, 63
s_cbranch_scc0 mega_kernel_rs_x4
s_cmp_gt_i32 s46, s76
s_cbranch_scc0 mega_kernel_rs_x4
s_add_u32 s77, s76, s82
s_bfe_u32 s28, s77, 0x40002
s_lshl_b32 s28, s28, 14
s_and_b32 s77, s77, 3
s_lshl_b32 s77, s77, 11
s_add_u32 s28, s28, s77
s_add_u32 s28, s28, s83
s_add_u32 s28, s28, 33554432
s_buffer_load_dword s78, s[84:87], s28 offset:0
s_buffer_load_dword s78, s[84:87], s28 offset:128
s_buffer_load_dword s78, s[84:87], s28 offset:256
s_buffer_load_dword s78, s[84:87], s28 offset:384
s_buffer_load_dword s78, s[84:87], s28 offset:512
s_buffer_load_dword s78, s[84:87], s28 offset:640
s_buffer_load_dword s78, s[84:87], s28 offset:768
s_buffer_load_dword s78, s[84:87], s28 offset:896
s_buffer_load_dword s78, s[84:87], s28 offset:1024
s_buffer_load_dword s78, s[84:87], s28 offset:1152
s_buffer_load_dword s78, s[84:87], s28 offset:1280
s_buffer_load_dword s78, s[84:87], s28 offset:1408
s_buffer_load_dword s78, s[84:87], s28 offset:1536
s_buffer_load_dword s78, s[84:87], s28 offset:1664
s_buffer_load_dword s78, s[84:87], s28 offset:1792
s_buffer_load_dword s78, s[84:87], s28 offset:1920
mega_kernel_rs_x4:
v_mov_b32 v96, 0
v_mov_b32 v97, 0
v_mov_b32 v98, 0
v_mov_b32 v99, 0
v_mov_b32 v100, 0
v_mov_b32 v101, 0
v_mov_b32 v102, 0
v_mov_b32 v103, 0
v_mov_b32 v104, 0
v_mov_b32 v105, 0
v_mov_b32 v106, 0
v_mov_b32 v107, 0
v_mov_b32 v108, 0
v_mov_b32 v109, 0
v_mov_b32 v110, 0
v_mov_b32 v111, 0
v_mov_b32 v112, 0
v_mov_b32 v113, 0
v_mov_b32 v114, 0
v_mov_b32 v115, 0
v_mov_b32 v116, 0
v_mov_b32 v117, 0
v_mov_b32 v118, 0
v_mov_b32 v119, 0
s_branch mega_kernel_rs_b5
mega_kernel_rs_p2r:
buffer_load_dwordx4 v[184:187], v17, s[84:87], s76 offen sc1
buffer_load_dwordx4 v[188:191], v10, s[84:87], s76 offen sc1
buffer_load_dwordx4 v[192:195], v17, s[84:87], s77 offen sc1
buffer_load_dwordx4 v[196:199], v10, s[84:87], s77 offen sc1
buffer_load_dwordx4 v[200:203], v17, s[84:87], s78 offen sc1
buffer_load_dwordx4 v[204:207], v10, s[84:87], s78 offen sc1
s_branch mega_kernel_rs_p2
mega_kernel_rs_pa_1_0f:
s_mov_b64 exec, vcc
buffer_load_dwordx4 v[32:35], v7, s[84:87], s33 offen offset:0 sc1
s_mov_b64 exec, -1
s_branch mega_kernel_rs_pa_1_0
mega_kernel_rs_pa_1_0:
s_waitcnt vmcnt(0)
v_max_u32 v4, v32, v34
v_cmp_eq_u32 vcc, -1, v4
s_cbranch_vccnz mega_kernel_rs_pa_1_0f
v_smfmac_f32_16x16x64_bf16 v[96:99], v[32:35], a[0:7], v6
v_smfmac_f32_16x16x64_bf16 v[100:103], v[32:35], a[32:39], v6
v_smfmac_f32_16x16x64_bf16 v[104:107], v[32:35], a[64:71], v6
v_smfmac_f32_16x16x64_bf16 v[108:111], v[32:35], a[96:103], v6
s_branch mega_kernel_rs_pa_d
mega_kernel_rs_pa_2_1f:
s_mov_b64 exec, vcc
buffer_load_dwordx4 v[36:39], v7, s[84:87], s33 offen offset:1024 sc1
s_mov_b64 exec, -1
s_branch mega_kernel_rs_pa_2_1
mega_kernel_rs_pa_2_1:
s_waitcnt vmcnt(0)
v_max_u32 v4, v36, v38
v_cmp_eq_u32 vcc, -1, v4
s_cbranch_vccnz mega_kernel_rs_pa_2_1f
v_smfmac_f32_16x16x64_bf16 v[96:99], v[36:39], a[8:15], v6
v_smfmac_f32_16x16x64_bf16 v[100:103], v[36:39], a[40:47], v6
v_smfmac_f32_16x16x64_bf16 v[104:107], v[36:39], a[72:79], v6
v_smfmac_f32_16x16x64_bf16 v[108:111], v[36:39], a[104:111], v6
s_branch mega_kernel_rs_pa_d
mega_kernel_rs_pa_3_0f:
s_mov_b64 exec, vcc
buffer_load_dwordx4 v[32:35], v7, s[84:87], s33 offen offset:0 sc1
s_mov_b64 exec, -1
s_branch mega_kernel_rs_pa_3_1
mega_kernel_rs_pa_3_0:
s_waitcnt vmcnt(1)
v_max_u32 v4, v32, v34
v_cmp_eq_u32 vcc, -1, v4
s_cbranch_vccnz mega_kernel_rs_pa_3_0f
v_smfmac_f32_16x16x64_bf16 v[96:99], v[32:35], a[0:7], v6
v_smfmac_f32_16x16x64_bf16 v[100:103], v[32:35], a[32:39], v6
v_smfmac_f32_16x16x64_bf16 v[104:107], v[32:35], a[64:71], v6
v_smfmac_f32_16x16x64_bf16 v[108:111], v[32:35], a[96:103], v6
s_branch mega_kernel_rs_pa_2_1
mega_kernel_rs_pa_3_1f:
s_mov_b64 exec, vcc
buffer_load_dwordx4 v[36:39], v7, s[84:87], s33 offen offset:1024 sc1
s_mov_b64 exec, -1
s_branch mega_kernel_rs_pa_3_0
mega_kernel_rs_pa_3_1:
s_waitcnt vmcnt(1)
v_max_u32 v4, v36, v38
v_cmp_eq_u32 vcc, -1, v4
s_cbranch_vccnz mega_kernel_rs_pa_3_1f
v_smfmac_f32_16x16x64_bf16 v[96:99], v[36:39], a[8:15], v6
v_smfmac_f32_16x16x64_bf16 v[100:103], v[36:39], a[40:47], v6
v_smfmac_f32_16x16x64_bf16 v[104:107], v[36:39], a[72:79], v6
v_smfmac_f32_16x16x64_bf16 v[108:111], v[36:39], a[104:111], v6
s_branch mega_kernel_rs_pa_1_0
mega_kernel_rs_pa_4_2f:
s_mov_b64 exec, vcc
buffer_load_dwordx4 v[40:43], v7, s[84:87], s33 offen offset:2048 sc1
s_mov_b64 exec, -1
s_branch mega_kernel_rs_pa_4_2
mega_kernel_rs_pa_4_2:
s_waitcnt vmcnt(0)
v_max_u32 v4, v40, v42
v_cmp_eq_u32 vcc, -1, v4
s_cbranch_vccnz mega_kernel_rs_pa_4_2f
v_smfmac_f32_16x16x64_bf16 v[96:99], v[40:43], a[16:23], v6
v_smfmac_f32_16x16x64_bf16 v[100:103], v[40:43], a[48:55], v6
v_smfmac_f32_16x16x64_bf16 v[104:107], v[40:43], a[80:87], v6
v_smfmac_f32_16x16x64_bf16 v[108:111], v[40:43], a[112:119], v6
s_branch mega_kernel_rs_pa_d
mega_kernel_rs_pa_5_0f:
s_mov_b64 exec, vcc
buffer_load_dwordx4 v[32:35], v7, s[84:87], s33 offen offset:0 sc1
s_mov_b64 exec, -1
s_branch mega_kernel_rs_pa_5_2
mega_kernel_rs_pa_5_0:
s_waitcnt vmcnt(1)
v_max_u32 v4, v32, v34
v_cmp_eq_u32 vcc, -1, v4
s_cbranch_vccnz mega_kernel_rs_pa_5_0f
v_smfmac_f32_16x16x64_bf16 v[96:99], v[32:35], a[0:7], v6
v_smfmac_f32_16x16x64_bf16 v[100:103], v[32:35], a[32:39], v6
v_smfmac_f32_16x16x64_bf16 v[104:107], v[32:35], a[64:71], v6
v_smfmac_f32_16x16x64_bf16 v[108:111], v[32:35], a[96:103], v6
s_branch mega_kernel_rs_pa_4_2
mega_kernel_rs_pa_5_2f:
s_mov_b64 exec, vcc
buffer_load_dwordx4 v[40:43], v7, s[84:87], s33 offen offset:2048 sc1
s_mov_b64 exec, -1
s_branch mega_kernel_rs_pa_5_0
mega_kernel_rs_pa_5_2:
s_waitcnt vmcnt(1)
v_max_u32 v4, v40, v42
v_cmp_eq_u32 vcc, -1, v4
s_cbranch_vccnz mega_kernel_rs_pa_5_2f
v_smfmac_f32_16x16x64_bf16 v[96:99], v[40:43], a[16:23], v6
v_smfmac_f32_16x16x64_bf16 v[100:103], v[40:43], a[48:55], v6
v_smfmac_f32_16x16x64_bf16 v[104:107], v[40:43], a[80:87], v6
v_smfmac_f32_16x16x64_bf16 v[108:111], v[40:43], a[112:119], v6
s_branch mega_kernel_rs_pa_1_0
mega_kernel_rs_pa_6_1f:
s_mov_b64 exec, vcc
buffer_load_dwordx4 v[36:39], v7, s[84:87], s33 offen offset:1024 sc1
s_mov_b64 exec, -1
s_branch mega_kernel_rs_pa_6_2
mega_kernel_rs_pa_6_1:
s_waitcnt vmcnt(1)
v_max_u32 v4, v36, v38
v_cmp_eq_u32 vcc, -1, v4
s_cbranch_vccnz mega_kernel_rs_pa_6_1f
v_smfmac_f32_16x16x64_bf16 v[96:99], v[36:39], a[8:15], v6
v_smfmac_f32_16x16x64_bf16 v[100:103], v[36:39], a[40:47], v6
v_smfmac_f32_16x16x64_bf16 v[104:107], v[36:39], a[72:79], v6
v_smfmac_f32_16x16x64_bf16 v[108:111], v[36:39], a[104:111], v6
s_branch mega_kernel_rs_pa_4_2
mega_kernel_rs_pa_6_2f:
s_mov_b64 exec, vcc
buffer_load_dwordx4 v[40:43], v7, s[84:87], s33 offen offset:2048 sc1
s_mov_b64 exec, -1
s_branch mega_kernel_rs_pa_6_1
mega_kernel_rs_pa_6_2:
s_waitcnt vmcnt(1)
v_max_u32 v4, v40, v42
v_cmp_eq_u32 vcc, -1, v4
s_cbranch_vccnz mega_kernel_rs_pa_6_2f
v_smfmac_f32_16x16x64_bf16 v[96:99], v[40:43], a[16:23], v6
v_smfmac_f32_16x16x64_bf16 v[100:103], v[40:43], a[48:55], v6
v_smfmac_f32_16x16x64_bf16 v[104:107], v[40:43], a[80:87], v6
v_smfmac_f32_16x16x64_bf16 v[108:111], v[40:43], a[112:119], v6
s_branch mega_kernel_rs_pa_2_1
mega_kernel_rs_pa_7_0f:
s_mov_b64 exec, vcc
buffer_load_dwordx4 v[32:35], v7, s[84:87], s33 offen offset:0 sc1
s_mov_b64 exec, -1
s_branch mega_kernel_rs_pa_7_1
mega_kernel_rs_pa_7_0:
s_waitcnt vmcnt(2)
v_max_u32 v4, v32, v34
v_cmp_eq_u32 vcc, -1, v4
s_cbranch_vccnz mega_kernel_rs_pa_7_0f
v_smfmac_f32_16x16x64_bf16 v[96:99], v[32:35], a[0:7], v6
v_smfmac_f32_16x16x64_bf16 v[100:103], v[32:35], a[32:39], v6
v_smfmac_f32_16x16x64_bf16 v[104:107], v[32:35], a[64:71], v6
v_smfmac_f32_16x16x64_bf16 v[108:111], v[32:35], a[96:103], v6
s_branch mega_kernel_rs_pa_6_1
mega_kernel_rs_pa_7_1f:
s_mov_b64 exec, vcc
buffer_load_dwordx4 v[36:39], v7, s[84:87], s33 offen offset:1024 sc1
s_mov_b64 exec, -1
s_branch mega_kernel_rs_pa_7_2
mega_kernel_rs_pa_7_1:
s_waitcnt vmcnt(2)
v_max_u32 v4, v36, v38
v_cmp_eq_u32 vcc, -1, v4
s_cbranch_vccnz mega_kernel_rs_pa_7_1f
v_smfmac_f32_16x16x64_bf16 v[96:99], v[36:39], a[8:15], v6
v_smfmac_f32_16x16x64_bf16 v[100:103], v[36:39], a[40:47], v6
v_smfmac_f32_16x16x64_bf16 v[104:107], v[36:39], a[72:79], v6
v_smfmac_f32_16x16x64_bf16 v[108:111], v[36:39], a[104:111], v6
s_branch mega_kernel_rs_pa_5_2
mega_kernel_rs_pa_7_2f:
s_mov_b64 exec, vcc
buffer_load_dwordx4 v[40:43], v7, s[84:87], s33 offen offset:2048 sc1
s_mov_b64 exec, -1
s_branch mega_kernel_rs_pa_7_0
mega_kernel_rs_pa_7_2:
s_waitcnt vmcnt(2)
v_max_u32 v4, v40, v42
v_cmp_eq_u32 vcc, -1, v4
s_cbranch_vccnz mega_kernel_rs_pa_7_2f
v_smfmac_f32_16x16x64_bf16 v[96:99], v[40:43], a[16:23], v6
v_smfmac_f32_16x16x64_bf16 v[100:103], v[40:43], a[48:55], v6
v_smfmac_f32_16x16x64_bf16 v[104:107], v[40:43], a[80:87], v6
v_smfmac_f32_16x16x64_bf16 v[108:111], v[40:43], a[112:119], v6
s_branch mega_kernel_rs_pa_3_0
mega_kernel_rs_pa_8_3f:
s_mov_b64 exec, vcc
buffer_load_dwordx4 v[44:47], v7, s[84:87], s33 offen offset:3072 sc1
s_mov_b64 exec, -1
s_branch mega_kernel_rs_pa_8_3
mega_kernel_rs_pa_8_3:
s_waitcnt vmcnt(0)
v_max_u32 v4, v44, v46
v_cmp_eq_u32 vcc, -1, v4
s_cbranch_vccnz mega_kernel_rs_pa_8_3f
v_smfmac_f32_16x16x64_bf16 v[96:99], v[44:47], a[24:31], v6
v_smfmac_f32_16x16x64_bf16 v[100:103], v[44:47], a[56:63], v6
v_smfmac_f32_16x16x64_bf16 v[104:107], v[44:47], a[88:95], v6
v_smfmac_f32_16x16x64_bf16 v[108:111], v[44:47], a[120:127], v6
s_branch mega_kernel_rs_pa_d
mega_kernel_rs_pa_9_0f:
s_mov_b64 exec, vcc
buffer_load_dwordx4 v[32:35], v7, s[84:87], s33 offen offset:0 sc1
s_mov_b64 exec, -1
s_branch mega_kernel_rs_pa_9_3
mega_kernel_rs_pa_9_0:
s_waitcnt vmcnt(1)
v_max_u32 v4, v32, v34
v_cmp_eq_u32 vcc, -1, v4
s_cbranch_vccnz mega_kernel_rs_pa_9_0f
v_smfmac_f32_16x16x64_bf16 v[96:99], v[32:35], a[0:7], v6
v_smfmac_f32_16x16x64_bf16 v[100:103], v[32:35], a[32:39], v6
v_smfmac_f32_16x16x64_bf16 v[104:107], v[32:35], a[64:71], v6
v_smfmac_f32_16x16x64_bf16 v[108:111], v[32:35], a[96:103], v6
s_branch mega_kernel_rs_pa_8_3
mega_kernel_rs_pa_9_3f:
s_mov_b64 exec, vcc
buffer_load_dwordx4 v[44:47], v7, s[84:87], s33 offen offset:3072 sc1
s_mov_b64 exec, -1
s_branch mega_kernel_rs_pa_9_0
mega_kernel_rs_pa_9_3:
s_waitcnt vmcnt(1)
v_max_u32 v4, v44, v46
v_cmp_eq_u32 vcc, -1, v4
s_cbranch_vccnz mega_kernel_rs_pa_9_3f
v_smfmac_f32_16x16x64_bf16 v[96:99], v[44:47], a[24:31], v6
v_smfmac_f32_16x16x64_bf16 v[100:103], v[44:47], a[56:63], v6
v_smfmac_f32_16x16x64_bf16 v[104:107], v[44:47], a[88:95], v6
v_smfmac_f32_16x16x64_bf16 v[108:111], v[44:47], a[120:127], v6
s_branch mega_kernel_rs_pa_1_0
mega_kernel_rs_pa_10_1f:
s_mov_b64 exec, vcc
buffer_load_dwordx4 v[36:39], v7, s[84:87], s33 offen offset:1024 sc1
s_mov_b64 exec, -1
s_branch mega_kernel_rs_pa_10_3
mega_kernel_rs_pa_10_1:
s_waitcnt vmcnt(1)
v_max_u32 v4, v36, v38
v_cmp_eq_u32 vcc, -1, v4
s_cbranch_vccnz mega_kernel_rs_pa_10_1f
v_smfmac_f32_16x16x64_bf16 v[96:99], v[36:39], a[8:15], v6
v_smfmac_f32_16x16x64_bf16 v[100:103], v[36:39], a[40:47], v6
v_smfmac_f32_16x16x64_bf16 v[104:107], v[36:39], a[72:79], v6
v_smfmac_f32_16x16x64_bf16 v[108:111], v[36:39], a[104:111], v6
s_branch mega_kernel_rs_pa_8_3
mega_kernel_rs_pa_10_3f:
s_mov_b64 exec, vcc
buffer_load_dwordx4 v[44:47], v7, s[84:87], s33 offen offset:3072 sc1
s_mov_b64 exec, -1
s_branch mega_kernel_rs_pa_10_1
mega_kernel_rs_pa_10_3:
s_waitcnt vmcnt(1)
v_max_u32 v4, v44, v46
v_cmp_eq_u32 vcc, -1, v4
s_cbranch_vccnz mega_kernel_rs_pa_10_3f
v_smfmac_f32_16x16x64_bf16 v[96:99], v[44:47], a[24:31], v6
v_smfmac_f32_16x16x64_bf16 v[100:103], v[44:47], a[56:63], v6
v_smfmac_f32_16x16x64_bf16 v[104:107], v[44:47], a[88:95], v6
v_smfmac_f32_16x16x64_bf16 v[108:111], v[44:47], a[120:127], v6
s_branch mega_kernel_rs_pa_2_1
mega_kernel_rs_pa_11_0f:
s_mov_b64 exec, vcc
buffer_load_dwordx4 v[32:35], v7, s[84:87], s33 offen offset:0 sc1
s_mov_b64 exec, -1
s_branch mega_kernel_rs_pa_11_1
mega_kernel_rs_pa_11_0:
s_waitcnt vmcnt(2)
v_max_u32 v4, v32, v34
v_cmp_eq_u32 vcc, -1, v4
s_cbranch_vccnz mega_kernel_rs_pa_11_0f
v_smfmac_f32_16x16x64_bf16 v[96:99], v[32:35], a[0:7], v6
v_smfmac_f32_16x16x64_bf16 v[100:103], v[32:35], a[32:39], v6
v_smfmac_f32_16x16x64_bf16 v[104:107], v[32:35], a[64:71], v6
v_smfmac_f32_16x16x64_bf16 v[108:111], v[32:35], a[96:103], v6
s_branch mega_kernel_rs_pa_10_1
mega_kernel_rs_pa_11_1f:
s_mov_b64 exec, vcc
buffer_load_dwordx4 v[36:39], v7, s[84:87], s33 offen offset:1024 sc1
s_mov_b64 exec, -1
s_branch mega_kernel_rs_pa_11_3
mega_kernel_rs_pa_11_1:
s_waitcnt vmcnt(2)
v_max_u32 v4, v36, v38
v_cmp_eq_u32 vcc, -1, v4
s_cbranch_vccnz mega_kernel_rs_pa_11_1f
v_smfmac_f32_16x16x64_bf16 v[96:99], v[36:39], a[8:15], v6
v_smfmac_f32_16x16x64_bf16 v[100:103], v[36:39], a[40:47], v6
v_smfmac_f32_16x16x64_bf16 v[104:107], v[36:39], a[72:79], v6
v_smfmac_f32_16x16x64_bf16 v[108:111], v[36:39], a[104:111], v6
s_branch mega_kernel_rs_pa_9_3
mega_kernel_rs_pa_11_3f:
s_mov_b64 exec, vcc
buffer_load_dwordx4 v[44:47], v7, s[84:87], s33 offen offset:3072 sc1
s_mov_b64 exec, -1
s_branch mega_kernel_rs_pa_11_0
mega_kernel_rs_pa_11_3:
s_waitcnt vmcnt(2)
v_max_u32 v4, v44, v46
v_cmp_eq_u32 vcc, -1, v4
s_cbranch_vccnz mega_kernel_rs_pa_11_3f
v_smfmac_f32_16x16x64_bf16 v[96:99], v[44:47], a[24:31], v6
v_smfmac_f32_16x16x64_bf16 v[100:103], v[44:47], a[56:63], v6
v_smfmac_f32_16x16x64_bf16 v[104:107], v[44:47], a[88:95], v6
v_smfmac_f32_16x16x64_bf16 v[108:111], v[44:47], a[120:127], v6
s_branch mega_kernel_rs_pa_3_0
mega_kernel_rs_pa_12_2f:
s_mov_b64 exec, vcc
buffer_load_dwordx4 v[40:43], v7, s[84:87], s33 offen offset:2048 sc1
s_mov_b64 exec, -1
s_branch mega_kernel_rs_pa_12_3
mega_kernel_rs_pa_12_2:
s_waitcnt vmcnt(1)
v_max_u32 v4, v40, v42
v_cmp_eq_u32 vcc, -1, v4
s_cbranch_vccnz mega_kernel_rs_pa_12_2f
v_smfmac_f32_16x16x64_bf16 v[96:99], v[40:43], a[16:23], v6
v_smfmac_f32_16x16x64_bf16 v[100:103], v[40:43], a[48:55], v6
v_smfmac_f32_16x16x64_bf16 v[104:107], v[40:43], a[80:87], v6
v_smfmac_f32_16x16x64_bf16 v[108:111], v[40:43], a[112:119], v6
s_branch mega_kernel_rs_pa_8_3
mega_kernel_rs_pa_12_3f:
s_mov_b64 exec, vcc
buffer_load_dwordx4 v[44:47], v7, s[84:87], s33 offen offset:3072 sc1
s_mov_b64 exec, -1
s_branch mega_kernel_rs_pa_12_2
mega_kernel_rs_pa_12_3:
s_waitcnt vmcnt(1)
v_max_u32 v4, v44, v46
v_cmp_eq_u32 vcc, -1, v4
s_cbranch_vccnz mega_kernel_rs_pa_12_3f
v_smfmac_f32_16x16x64_bf16 v[96:99], v[44:47], a[24:31], v6
v_smfmac_f32_16x16x64_bf16 v[100:103], v[44:47], a[56:63], v6
v_smfmac_f32_16x16x64_bf16 v[104:107], v[44:47], a[88:95], v6
v_smfmac_f32_16x16x64_bf16 v[108:111], v[44:47], a[120:127], v6
s_branch mega_kernel_rs_pa_4_2
mega_kernel_rs_pa_13_0f:
s_mov_b64 exec, vcc
buffer_load_dwordx4 v[32:35], v7, s[84:87], s33 offen offset:0 sc1
s_mov_b64 exec, -1
s_branch mega_kernel_rs_pa_13_2
mega_kernel_rs_pa_13_0:
s_waitcnt vmcnt(2)
v_max_u32 v4, v32, v34
v_cmp_eq_u32 vcc, -1, v4
s_cbranch_vccnz mega_kernel_rs_pa_13_0f
v_smfmac_f32_16x16x64_bf16 v[96:99], v[32:35], a[0:7], v6
v_smfmac_f32_16x16x64_bf16 v[100:103], v[32:35], a[32:39], v6
v_smfmac_f32_16x16x64_bf16 v[104:107], v[32:35], a[64:71], v6
v_smfmac_f32_16x16x64_bf16 v[108:111], v[32:35], a[96:103], v6
s_branch mega_kernel_rs_pa_12_2
mega_kernel_rs_pa_13_2f:
s_mov_b64 exec, vcc
buffer_load_dwordx4 v[40:43], v7, s[84:87], s33 offen offset:2048 sc1
s_mov_b64 exec, -1
s_branch mega_kernel_rs_pa_13_3
mega_kernel_rs_pa_13_2:
s_waitcnt vmcnt(2)
v_max_u32 v4, v40, v42
v_cmp_eq_u32 vcc, -1, v4
s_cbranch_vccnz mega_kernel_rs_pa_13_2f
v_smfmac_f32_16x16x64_bf16 v[96:99], v[40:43], a[16:23], v6
v_smfmac_f32_16x16x64_bf16 v[100:103], v[40:43], a[48:55], v6
v_smfmac_f32_16x16x64_bf16 v[104:107], v[40:43], a[80:87], v6
v_smfmac_f32_16x16x64_bf16 v[108:111], v[40:43], a[112:119], v6
s_branch mega_kernel_rs_pa_9_3
mega_kernel_rs_pa_13_3f:
s_mov_b64 exec, vcc
buffer_load_dwordx4 v[44:47], v7, s[84:87], s33 offen offset:3072 sc1
s_mov_b64 exec, -1
s_branch mega_kernel_rs_pa_13_0
mega_kernel_rs_pa_13_3:
s_waitcnt vmcnt(2)
v_max_u32 v4, v44, v46
v_cmp_eq_u32 vcc, -1, v4
s_cbranch_vccnz mega_kernel_rs_pa_13_3f
v_smfmac_f32_16x16x64_bf16 v[96:99], v[44:47], a[24:31], v6
v_smfmac_f32_16x16x64_bf16 v[100:103], v[44:47], a[56:63], v6
v_smfmac_f32_16x16x64_bf16 v[104:107], v[44:47], a[88:95], v6
v_smfmac_f32_16x16x64_bf16 v[108:111], v[44:47], a[120:127], v6
s_branch mega_kernel_rs_pa_5_0
mega_kernel_rs_pa_14_1f:
s_mov_b64 exec, vcc
buffer_load_dwordx4 v[36:39], v7, s[84:87], s33 offen offset:1024 sc1
s_mov_b64 exec, -1
s_branch mega_kernel_rs_pa_14_2
mega_kernel_rs_pa_14_1:
s_waitcnt vmcnt(2)
v_max_u32 v4, v36, v38
v_cmp_eq_u32 vcc, -1, v4
s_cbranch_vccnz mega_kernel_rs_pa_14_1f
v_smfmac_f32_16x16x64_bf16 v[96:99], v[36:39], a[8:15], v6
v_smfmac_f32_16x16x64_bf16 v[100:103], v[36:39], a[40:47], v6
v_smfmac_f32_16x16x64_bf16 v[104:107], v[36:39], a[72:79], v6
v_smfmac_f32_16x16x64_bf16 v[108:111], v[36:39], a[104:111], v6
s_branch mega_kernel_rs_pa_12_2
mega_kernel_rs_pa_14_2f:
s_mov_b64 exec, vcc
buffer_load_dwordx4 v[40:43], v7, s[84:87], s33 offen offset:2048 sc1
s_mov_b64 exec, -1
s_branch mega_kernel_rs_pa_14_3
mega_kernel_rs_pa_14_2:
s_waitcnt vmcnt(2)
v_max_u32 v4, v40, v42
v_cmp_eq_u32 vcc, -1, v4
s_cbranch_vccnz mega_kernel_rs_pa_14_2f
v_smfmac_f32_16x16x64_bf16 v[96:99], v[40:43], a[16:23], v6
v_smfmac_f32_16x16x64_bf16 v[100:103], v[40:43], a[48:55], v6
v_smfmac_f32_16x16x64_bf16 v[104:107], v[40:43], a[80:87], v6
v_smfmac_f32_16x16x64_bf16 v[108:111], v[40:43], a[112:119], v6
s_branch mega_kernel_rs_pa_10_3
mega_kernel_rs_pa_14_3f:
s_mov_b64 exec, vcc
buffer_load_dwordx4 v[44:47], v7, s[84:87], s33 offen offset:3072 sc1
s_mov_b64 exec, -1
s_branch mega_kernel_rs_pa_14_1
mega_kernel_rs_pa_14_3:
s_waitcnt vmcnt(2)
v_max_u32 v4, v44, v46
v_cmp_eq_u32 vcc, -1, v4
s_cbranch_vccnz mega_kernel_rs_pa_14_3f
v_smfmac_f32_16x16x64_bf16 v[96:99], v[44:47], a[24:31], v6
v_smfmac_f32_16x16x64_bf16 v[100:103], v[44:47], a[56:63], v6
v_smfmac_f32_16x16x64_bf16 v[104:107], v[44:47], a[88:95], v6
v_smfmac_f32_16x16x64_bf16 v[108:111], v[44:47], a[120:127], v6
s_branch mega_kernel_rs_pa_6_1
mega_kernel_rs_pa_15_0f:
s_mov_b64 exec, vcc
buffer_load_dwordx4 v[32:35], v7, s[84:87], s33 offen offset:0 sc1
s_mov_b64 exec, -1
s_branch mega_kernel_rs_pa_15_1
mega_kernel_rs_pa_15_0:
s_waitcnt vmcnt(3)
v_max_u32 v4, v32, v34
v_cmp_eq_u32 vcc, -1, v4
s_cbranch_vccnz mega_kernel_rs_pa_15_0f
v_smfmac_f32_16x16x64_bf16 v[96:99], v[32:35], a[0:7], v6
v_smfmac_f32_16x16x64_bf16 v[100:103], v[32:35], a[32:39], v6
v_smfmac_f32_16x16x64_bf16 v[104:107], v[32:35], a[64:71], v6
v_smfmac_f32_16x16x64_bf16 v[108:111], v[32:35], a[96:103], v6
s_branch mega_kernel_rs_pa_14_1
mega_kernel_rs_pa_15_1f:
s_mov_b64 exec, vcc
buffer_load_dwordx4 v[36:39], v7, s[84:87], s33 offen offset:1024 sc1
s_mov_b64 exec, -1
s_branch mega_kernel_rs_pa_15_2
mega_kernel_rs_pa_15_1:
s_waitcnt vmcnt(3)
v_max_u32 v4, v36, v38
v_cmp_eq_u32 vcc, -1, v4
s_cbranch_vccnz mega_kernel_rs_pa_15_1f
v_smfmac_f32_16x16x64_bf16 v[96:99], v[36:39], a[8:15], v6
v_smfmac_f32_16x16x64_bf16 v[100:103], v[36:39], a[40:47], v6
v_smfmac_f32_16x16x64_bf16 v[104:107], v[36:39], a[72:79], v6
v_smfmac_f32_16x16x64_bf16 v[108:111], v[36:39], a[104:111], v6
s_branch mega_kernel_rs_pa_13_2
mega_kernel_rs_pa_15_2f:
s_mov_b64 exec, vcc
buffer_load_dwordx4 v[40:43], v7, s[84:87], s33 offen offset:2048 sc1
s_mov_b64 exec, -1
s_branch mega_kernel_rs_pa_15_3
mega_kernel_rs_pa_15_2:
s_waitcnt vmcnt(3)
v_max_u32 v4, v40, v42
v_cmp_eq_u32 vcc, -1, v4
s_cbranch_vccnz mega_kernel_rs_pa_15_2f
v_smfmac_f32_16x16x64_bf16 v[96:99], v[40:43], a[16:23], v6
v_smfmac_f32_16x16x64_bf16 v[100:103], v[40:43], a[48:55], v6
v_smfmac_f32_16x16x64_bf16 v[104:107], v[40:43], a[80:87], v6
v_smfmac_f32_16x16x64_bf16 v[108:111], v[40:43], a[112:119], v6
s_branch mega_kernel_rs_pa_11_3
mega_kernel_rs_pa_15_3f:
s_mov_b64 exec, vcc
buffer_load_dwordx4 v[44:47], v7, s[84:87], s33 offen offset:3072 sc1
s_mov_b64 exec, -1
s_branch mega_kernel_rs_pa_15_0
mega_kernel_rs_pa_15_3:
s_waitcnt vmcnt(3)
v_max_u32 v4, v44, v46
v_cmp_eq_u32 vcc, -1, v4
s_cbranch_vccnz mega_kernel_rs_pa_15_3f
v_smfmac_f32_16x16x64_bf16 v[96:99], v[44:47], a[24:31], v6
v_smfmac_f32_16x16x64_bf16 v[100:103], v[44:47], a[56:63], v6
v_smfmac_f32_16x16x64_bf16 v[104:107], v[44:47], a[88:95], v6
v_smfmac_f32_16x16x64_bf16 v[108:111], v[44:47], a[120:127], v6
s_branch mega_kernel_rs_pa_7_0
mega_kernel_rs_pc_1_0f:
s_mov_b64 exec, vcc
buffer_load_dwordx4 v[32:35], v7, s[84:87], s29 offen offset:0 sc1
s_mov_b64 exec, -1
s_branch mega_kernel_rs_pc_1_0
mega_kernel_rs_pc_1_0:
s_waitcnt vmcnt(0)
v_cmp_eq_u32 vcc, -1, v32
s_cbranch_vccnz mega_kernel_rs_pc_1_0f
v_smfmac_f32_16x16x64_bf16 v[96:99], v[32:35], a[192:199], v6
v_smfmac_f32_16x16x64_bf16 v[100:103], v[32:35], a[224:231], v6
s_branch mega_kernel_rs_pc_d
mega_kernel_rs_pc_2_1f:
s_mov_b64 exec, vcc
buffer_load_dwordx4 v[36:39], v7, s[84:87], s29 offen offset:1024 sc1
s_mov_b64 exec, -1
s_branch mega_kernel_rs_pc_2_1
mega_kernel_rs_pc_2_1:
s_waitcnt vmcnt(0)
v_cmp_eq_u32 vcc, -1, v36
s_cbranch_vccnz mega_kernel_rs_pc_2_1f
v_smfmac_f32_16x16x64_bf16 v[96:99], v[36:39], a[200:207], v6
v_smfmac_f32_16x16x64_bf16 v[100:103], v[36:39], a[232:239], v6
s_branch mega_kernel_rs_pc_d
mega_kernel_rs_pc_3_0f:
s_mov_b64 exec, vcc
buffer_load_dwordx4 v[32:35], v7, s[84:87], s29 offen offset:0 sc1
s_mov_b64 exec, -1
s_branch mega_kernel_rs_pc_3_1
mega_kernel_rs_pc_3_0:
s_waitcnt vmcnt(1)
v_cmp_eq_u32 vcc, -1, v32
s_cbranch_vccnz mega_kernel_rs_pc_3_0f
v_smfmac_f32_16x16x64_bf16 v[96:99], v[32:35], a[192:199], v6
v_smfmac_f32_16x16x64_bf16 v[100:103], v[32:35], a[224:231], v6
s_branch mega_kernel_rs_pc_2_1
mega_kernel_rs_pc_3_1f:
s_mov_b64 exec, vcc
buffer_load_dwordx4 v[36:39], v7, s[84:87], s29 offen offset:1024 sc1
s_mov_b64 exec, -1
s_branch mega_kernel_rs_pc_3_0
mega_kernel_rs_pc_3_1:
s_waitcnt vmcnt(1)
v_cmp_eq_u32 vcc, -1, v36
s_cbranch_vccnz mega_kernel_rs_pc_3_1f
v_smfmac_f32_16x16x64_bf16 v[96:99], v[36:39], a[200:207], v6
v_smfmac_f32_16x16x64_bf16 v[100:103], v[36:39], a[232:239], v6
s_branch mega_kernel_rs_pc_1_0
mega_kernel_rs_pc_4_2f:
s_mov_b64 exec, vcc
buffer_load_dwordx4 v[40:43], v7, s[84:87], s29 offen offset:2048 sc1
s_mov_b64 exec, -1
s_branch mega_kernel_rs_pc_4_2
mega_kernel_rs_pc_4_2:
s_waitcnt vmcnt(0)
v_cmp_eq_u32 vcc, -1, v40
s_cbranch_vccnz mega_kernel_rs_pc_4_2f
v_smfmac_f32_16x16x64_bf16 v[96:99], v[40:43], a[208:215], v6
v_smfmac_f32_16x16x64_bf16 v[100:103], v[40:43], a[240:247], v6
s_branch mega_kernel_rs_pc_d
mega_kernel_rs_pc_5_0f:
s_mov_b64 exec, vcc
buffer_load_dwordx4 v[32:35], v7, s[84:87], s29 offen offset:0 sc1
s_mov_b64 exec, -1
s_branch mega_kernel_rs_pc_5_2
mega_kernel_rs_pc_5_0:
s_waitcnt vmcnt(1)
v_cmp_eq_u32 vcc, -1, v32
s_cbranch_vccnz mega_kernel_rs_pc_5_0f
v_smfmac_f32_16x16x64_bf16 v[96:99], v[32:35], a[192:199], v6
v_smfmac_f32_16x16x64_bf16 v[100:103], v[32:35], a[224:231], v6
s_branch mega_kernel_rs_pc_4_2
mega_kernel_rs_pc_5_2f:
s_mov_b64 exec, vcc
buffer_load_dwordx4 v[40:43], v7, s[84:87], s29 offen offset:2048 sc1
s_mov_b64 exec, -1
s_branch mega_kernel_rs_pc_5_0
mega_kernel_rs_pc_5_2:
s_waitcnt vmcnt(1)
v_cmp_eq_u32 vcc, -1, v40
s_cbranch_vccnz mega_kernel_rs_pc_5_2f
v_smfmac_f32_16x16x64_bf16 v[96:99], v[40:43], a[208:215], v6
v_smfmac_f32_16x16x64_bf16 v[100:103], v[40:43], a[240:247], v6
s_branch mega_kernel_rs_pc_1_0
mega_kernel_rs_pc_6_1f:
s_mov_b64 exec, vcc
buffer_load_dwordx4 v[36:39], v7, s[84:87], s29 offen offset:1024 sc1
s_mov_b64 exec, -1
s_branch mega_kernel_rs_pc_6_2
mega_kernel_rs_pc_6_1:
s_waitcnt vmcnt(1)
v_cmp_eq_u32 vcc, -1, v36
s_cbranch_vccnz mega_kernel_rs_pc_6_1f
v_smfmac_f32_16x16x64_bf16 v[96:99], v[36:39], a[200:207], v6
v_smfmac_f32_16x16x64_bf16 v[100:103], v[36:39], a[232:239], v6
s_branch mega_kernel_rs_pc_4_2
mega_kernel_rs_pc_6_2f:
s_mov_b64 exec, vcc
buffer_load_dwordx4 v[40:43], v7, s[84:87], s29 offen offset:2048 sc1
s_mov_b64 exec, -1
s_branch mega_kernel_rs_pc_6_1
mega_kernel_rs_pc_6_2:
s_waitcnt vmcnt(1)
v_cmp_eq_u32 vcc, -1, v40
s_cbranch_vccnz mega_kernel_rs_pc_6_2f
v_smfmac_f32_16x16x64_bf16 v[96:99], v[40:43], a[208:215], v6
v_smfmac_f32_16x16x64_bf16 v[100:103], v[40:43], a[240:247], v6
s_branch mega_kernel_rs_pc_2_1
mega_kernel_rs_pc_7_0f:
s_mov_b64 exec, vcc
buffer_load_dwordx4 v[32:35], v7, s[84:87], s29 offen offset:0 sc1
s_mov_b64 exec, -1
s_branch mega_kernel_rs_pc_7_1
mega_kernel_rs_pc_7_0:
s_waitcnt vmcnt(2)
v_cmp_eq_u32 vcc, -1, v32
s_cbranch_vccnz mega_kernel_rs_pc_7_0f
v_smfmac_f32_16x16x64_bf16 v[96:99], v[32:35], a[192:199], v6
v_smfmac_f32_16x16x64_bf16 v[100:103], v[32:35], a[224:231], v6
s_branch mega_kernel_rs_pc_6_1
mega_kernel_rs_pc_7_1f:
s_mov_b64 exec, vcc
buffer_load_dwordx4 v[36:39], v7, s[84:87], s29 offen offset:1024 sc1
s_mov_b64 exec, -1
s_branch mega_kernel_rs_pc_7_2
mega_kernel_rs_pc_7_1:
s_waitcnt vmcnt(2)
v_cmp_eq_u32 vcc, -1, v36
s_cbranch_vccnz mega_kernel_rs_pc_7_1f
v_smfmac_f32_16x16x64_bf16 v[96:99], v[36:39], a[200:207], v6
v_smfmac_f32_16x16x64_bf16 v[100:103], v[36:39], a[232:239], v6
s_branch mega_kernel_rs_pc_5_2
mega_kernel_rs_pc_7_2f:
s_mov_b64 exec, vcc
buffer_load_dwordx4 v[40:43], v7, s[84:87], s29 offen offset:2048 sc1
s_mov_b64 exec, -1
s_branch mega_kernel_rs_pc_7_0
mega_kernel_rs_pc_7_2:
s_waitcnt vmcnt(2)
v_cmp_eq_u32 vcc, -1, v40
s_cbranch_vccnz mega_kernel_rs_pc_7_2f
v_smfmac_f32_16x16x64_bf16 v[96:99], v[40:43], a[208:215], v6
v_smfmac_f32_16x16x64_bf16 v[100:103], v[40:43], a[240:247], v6
s_branch mega_kernel_rs_pc_3_0
mega_kernel_rs_pc_8_3f:
s_mov_b64 exec, vcc
buffer_load_dwordx4 v[44:47], v7, s[84:87], s29 offen offset:3072 sc1
s_mov_b64 exec, -1
s_branch mega_kernel_rs_pc_8_3
mega_kernel_rs_pc_9_0f:
s_mov_b64 exec, vcc
buffer_load_dwordx4 v[32:35], v7, s[84:87], s29 offen offset:0 sc1
s_mov_b64 exec, -1
s_branch mega_kernel_rs_pc_9_3
mega_kernel_rs_pc_9_0:
s_waitcnt vmcnt(1)
v_cmp_eq_u32 vcc, -1, v32
s_cbranch_vccnz mega_kernel_rs_pc_9_0f
v_smfmac_f32_16x16x64_bf16 v[96:99], v[32:35], a[192:199], v6
v_smfmac_f32_16x16x64_bf16 v[100:103], v[32:35], a[224:231], v6
s_branch mega_kernel_rs_pc_8_3
mega_kernel_rs_pc_9_3f:
s_mov_b64 exec, vcc
buffer_load_dwordx4 v[44:47], v7, s[84:87], s29 offen offset:3072 sc1
s_mov_b64 exec, -1
s_branch mega_kernel_rs_pc_9_0
mega_kernel_rs_pc_9_3:
s_waitcnt vmcnt(1)
v_cmp_eq_u32 vcc, -1, v44
s_cbranch_vccnz mega_kernel_rs_pc_9_3f
v_smfmac_f32_16x16x64_bf16 v[96:99], v[44:47], a[216:223], v6
v_smfmac_f32_16x16x64_bf16 v[100:103], v[44:47], a[248:255], v6
s_branch mega_kernel_rs_pc_1_0
mega_kernel_rs_pc_10_1f:
s_mov_b64 exec, vcc
buffer_load_dwordx4 v[36:39], v7, s[84:87], s29 offen offset:1024 sc1
s_mov_b64 exec, -1
s_branch mega_kernel_rs_pc_10_3
mega_kernel_rs_pc_10_1:
s_waitcnt vmcnt(1)
v_cmp_eq_u32 vcc, -1, v36
s_cbranch_vccnz mega_kernel_rs_pc_10_1f
v_smfmac_f32_16x16x64_bf16 v[96:99], v[36:39], a[200:207], v6
v_smfmac_f32_16x16x64_bf16 v[100:103], v[36:39], a[232:239], v6
s_branch mega_kernel_rs_pc_8_3
mega_kernel_rs_pc_10_3f:
s_mov_b64 exec, vcc
buffer_load_dwordx4 v[44:47], v7, s[84:87], s29 offen offset:3072 sc1
s_mov_b64 exec, -1
s_branch mega_kernel_rs_pc_10_1
mega_kernel_rs_pc_10_3:
s_waitcnt vmcnt(1)
v_cmp_eq_u32 vcc, -1, v44
s_cbranch_vccnz mega_kernel_rs_pc_10_3f
v_smfmac_f32_16x16x64_bf16 v[96:99], v[44:47], a[216:223], v6
v_smfmac_f32_16x16x64_bf16 v[100:103], v[44:47], a[248:255], v6
s_branch mega_kernel_rs_pc_2_1
mega_kernel_rs_pc_11_0f:
s_mov_b64 exec, vcc
buffer_load_dwordx4 v[32:35], v7, s[84:87], s29 offen offset:0 sc1
s_mov_b64 exec, -1
s_branch mega_kernel_rs_pc_11_1
mega_kernel_rs_pc_11_0:
s_waitcnt vmcnt(2)
v_cmp_eq_u32 vcc, -1, v32
s_cbranch_vccnz mega_kernel_rs_pc_11_0f
v_smfmac_f32_16x16x64_bf16 v[96:99], v[32:35], a[192:199], v6
v_smfmac_f32_16x16x64_bf16 v[100:103], v[32:35], a[224:231], v6
s_branch mega_kernel_rs_pc_10_1
mega_kernel_rs_pc_11_1f:
s_mov_b64 exec, vcc
buffer_load_dwordx4 v[36:39], v7, s[84:87], s29 offen offset:1024 sc1
s_mov_b64 exec, -1
s_branch mega_kernel_rs_pc_11_3
mega_kernel_rs_pc_11_1:
s_waitcnt vmcnt(2)
v_cmp_eq_u32 vcc, -1, v36
s_cbranch_vccnz mega_kernel_rs_pc_11_1f
v_smfmac_f32_16x16x64_bf16 v[96:99], v[36:39], a[200:207], v6
v_smfmac_f32_16x16x64_bf16 v[100:103], v[36:39], a[232:239], v6
s_branch mega_kernel_rs_pc_9_3
mega_kernel_rs_pc_11_3f:
s_mov_b64 exec, vcc
buffer_load_dwordx4 v[44:47], v7, s[84:87], s29 offen offset:3072 sc1
s_mov_b64 exec, -1
s_branch mega_kernel_rs_pc_11_0
mega_kernel_rs_pc_11_3:
s_waitcnt vmcnt(2)
v_cmp_eq_u32 vcc, -1, v44
s_cbranch_vccnz mega_kernel_rs_pc_11_3f
v_smfmac_f32_16x16x64_bf16 v[96:99], v[44:47], a[216:223], v6
v_smfmac_f32_16x16x64_bf16 v[100:103], v[44:47], a[248:255], v6
s_branch mega_kernel_rs_pc_3_0
mega_kernel_rs_pc_12_2f:
s_mov_b64 exec, vcc
buffer_load_dwordx4 v[40:43], v7, s[84:87], s29 offen offset:2048 sc1
s_mov_b64 exec, -1
s_branch mega_kernel_rs_pc_12_3
mega_kernel_rs_pc_12_3f:
s_mov_b64 exec, vcc
buffer_load_dwordx4 v[44:47], v7, s[84:87], s29 offen offset:3072 sc1
s_mov_b64 exec, -1
s_branch mega_kernel_rs_pc_12_2
mega_kernel_rs_pc_12_3:
s_waitcnt vmcnt(1)
v_cmp_eq_u32 vcc, -1, v44
s_cbranch_vccnz mega_kernel_rs_pc_12_3f
v_smfmac_f32_16x16x64_bf16 v[96:99], v[44:47], a[216:223], v6
v_smfmac_f32_16x16x64_bf16 v[100:103], v[44:47], a[248:255], v6
s_branch mega_kernel_rs_pc_4_2
mega_kernel_rs_pc_13_0f:
s_mov_b64 exec, vcc
buffer_load_dwordx4 v[32:35], v7, s[84:87], s29 offen offset:0 sc1
s_mov_b64 exec, -1
s_branch mega_kernel_rs_pc_13_2
mega_kernel_rs_pc_13_0:
s_waitcnt vmcnt(2)
v_cmp_eq_u32 vcc, -1, v32
s_cbranch_vccnz mega_kernel_rs_pc_13_0f
v_smfmac_f32_16x16x64_bf16 v[96:99], v[32:35], a[192:199], v6
v_smfmac_f32_16x16x64_bf16 v[100:103], v[32:35], a[224:231], v6
s_branch mega_kernel_rs_pc_12_2
mega_kernel_rs_pc_13_2f:
s_mov_b64 exec, vcc
buffer_load_dwordx4 v[40:43], v7, s[84:87], s29 offen offset:2048 sc1
s_mov_b64 exec, -1
s_branch mega_kernel_rs_pc_13_3
mega_kernel_rs_pc_13_2:
s_waitcnt vmcnt(2)
v_cmp_eq_u32 vcc, -1, v40
s_cbranch_vccnz mega_kernel_rs_pc_13_2f
v_smfmac_f32_16x16x64_bf16 v[96:99], v[40:43], a[208:215], v6
v_smfmac_f32_16x16x64_bf16 v[100:103], v[40:43], a[240:247], v6
s_branch mega_kernel_rs_pc_9_3
mega_kernel_rs_pc_13_3f:
s_mov_b64 exec, vcc
buffer_load_dwordx4 v[44:47], v7, s[84:87], s29 offen offset:3072 sc1
s_mov_b64 exec, -1
s_branch mega_kernel_rs_pc_13_0
mega_kernel_rs_pc_13_3:
s_waitcnt vmcnt(2)
v_cmp_eq_u32 vcc, -1, v44
s_cbranch_vccnz mega_kernel_rs_pc_13_3f
v_smfmac_f32_16x16x64_bf16 v[96:99], v[44:47], a[216:223], v6
v_smfmac_f32_16x16x64_bf16 v[100:103], v[44:47], a[248:255], v6
s_branch mega_kernel_rs_pc_5_0
mega_kernel_rs_pc_14_1f:
s_mov_b64 exec, vcc
buffer_load_dwordx4 v[36:39], v7, s[84:87], s29 offen offset:1024 sc1
s_mov_b64 exec, -1
s_branch mega_kernel_rs_pc_14_2
mega_kernel_rs_pc_14_2f:
s_mov_b64 exec, vcc
buffer_load_dwordx4 v[40:43], v7, s[84:87], s29 offen offset:2048 sc1
s_mov_b64 exec, -1
s_branch mega_kernel_rs_pc_14_3
mega_kernel_rs_pc_14_2:
s_waitcnt vmcnt(2)
v_cmp_eq_u32 vcc, -1, v40
s_cbranch_vccnz mega_kernel_rs_pc_14_2f
v_smfmac_f32_16x16x64_bf16 v[96:99], v[40:43], a[208:215], v6
v_smfmac_f32_16x16x64_bf16 v[100:103], v[40:43], a[240:247], v6
s_branch mega_kernel_rs_pc_10_3
mega_kernel_rs_pc_14_3f:
s_mov_b64 exec, vcc
buffer_load_dwordx4 v[44:47], v7, s[84:87], s29 offen offset:3072 sc1
s_mov_b64 exec, -1
s_branch mega_kernel_rs_pc_14_1
mega_kernel_rs_pc_14_3:
s_waitcnt vmcnt(2)
v_cmp_eq_u32 vcc, -1, v44
s_cbranch_vccnz mega_kernel_rs_pc_14_3f
v_smfmac_f32_16x16x64_bf16 v[96:99], v[44:47], a[216:223], v6
v_smfmac_f32_16x16x64_bf16 v[100:103], v[44:47], a[248:255], v6
s_branch mega_kernel_rs_pc_6_1
mega_kernel_rs_pc_15_0f:
s_mov_b64 exec, vcc
buffer_load_dwordx4 v[32:35], v7, s[84:87], s29 offen offset:0 sc1
s_mov_b64 exec, -1
s_branch mega_kernel_rs_pc_15_1
mega_kernel_rs_pc_15_1f:
s_mov_b64 exec, vcc
buffer_load_dwordx4 v[36:39], v7, s[84:87], s29 offen offset:1024 sc1
s_mov_b64 exec, -1
s_branch mega_kernel_rs_pc_15_2
mega_kernel_rs_pc_15_1:
s_waitcnt vmcnt(3)
v_cmp_eq_u32 vcc, -1, v36
s_cbranch_vccnz mega_kernel_rs_pc_15_1f
v_smfmac_f32_16x16x64_bf16 v[96:99], v[36:39], a[200:207], v6
v_smfmac_f32_16x16x64_bf16 v[100:103], v[36:39], a[232:239], v6
s_branch mega_kernel_rs_pc_13_2
mega_kernel_rs_pc_15_2f:
s_mov_b64 exec, vcc
buffer_load_dwordx4 v[40:43], v7, s[84:87], s29 offen offset:2048 sc1
s_mov_b64 exec, -1
s_branch mega_kernel_rs_pc_15_3
mega_kernel_rs_pc_15_2:
s_waitcnt vmcnt(3)
v_cmp_eq_u32 vcc, -1, v40
s_cbranch_vccnz mega_kernel_rs_pc_15_2f
v_smfmac_f32_16x16x64_bf16 v[96:99], v[40:43], a[208:215], v6
v_smfmac_f32_16x16x64_bf16 v[100:103], v[40:43], a[240:247], v6
s_branch mega_kernel_rs_pc_11_3
mega_kernel_rs_pc_15_3f:
s_mov_b64 exec, vcc
buffer_load_dwordx4 v[44:47], v7, s[84:87], s29 offen offset:3072 sc1
s_mov_b64 exec, -1
s_branch mega_kernel_rs_pc_15_0
mega_kernel_rs_pc_15_3:
s_waitcnt vmcnt(3)
v_cmp_eq_u32 vcc, -1, v44
s_cbranch_vccnz mega_kernel_rs_pc_15_3f
v_smfmac_f32_16x16x64_bf16 v[96:99], v[44:47], a[216:223], v6
v_smfmac_f32_16x16x64_bf16 v[100:103], v[44:47], a[248:255], v6
s_branch mega_kernel_rs_pc_7_0
mega_kernel_rs_w0last:
s_nop 7
v_permlane32_swap_b32 v112, v116
v_permlane32_swap_b32 v113, v117
v_permlane32_swap_b32 v114, v118
v_permlane32_swap_b32 v115, v119
v_pk_add_f32 v[112:113], v[112:113], v[116:117]
v_pk_add_f32 v[114:115], v[114:115], v[118:119]
ds_write_b128 v20, v[112:115]
s_waitcnt lgkmcnt(0)
s_barrier
s_branch mega_kernel_rs_end
mega_kernel_rs_side:
s_cmp_eq_u32 s24, 3
s_cbranch_scc1 mega_kernel_rs_sd3
s_cmp_eq_u32 s24, 2
s_cbranch_scc0 mega_kernel_rs_sd4
s_mov_b64 exec, s[40:41]
buffer_store_dwordx4 v[28:31], v11, s[84:87], s34 offen sc1
s_mov_b64 exec, -1
buffer_store_dwordx2 v[28:29], v9, s[84:87], s34 offen sc1
s_lshl_b32 s28, s31, 11
s_add_u32 s28, s28, s34
s_add_u32 s28, s28, 32768
buffer_store_dwordx4 v[28:31], v17, s[84:87], s28 offen sc1
buffer_store_dwordx4 v[28:31], v10, s[84:87], s28 offen sc1
s_branch mega_kernel_rs_sd4
mega_kernel_rs_sd3:
s_mov_b32 s36, 0
s_add_u32 s76, s27, 1
s_cmp_lt_u32 s76, 63
s_cbranch_scc0 mega_kernel_rs_sd4
s_cmp_gt_i32 s46, s76
s_cselect_b32 s36, 0, 1
s_cbranch_scc0 mega_kernel_rs_sd4
s_add_u32 s77, s76, s82
s_bfe_u32 s28, s77, 0x40002
s_lshl_b32 s28, s28, 14
s_and_b32 s77, s77, 3
s_lshl_b32 s77, s77, 11
s_add_u32 s28, s28, s77
s_add_u32 m0, s45, 0
s_nop 0
buffer_load_dwordx4 v240, s[84:87], s28 offen offset:0 sc1 lds
s_add_u32 m0, s45, 0
s_nop 0
buffer_load_dwordx4 v240, s[84:87], s28 offen offset:1024 sc1 lds
s_add_u32 m0, s45, 2048
s_nop 0
buffer_load_dwordx4 v241, s[84:87], s28 offen offset:0 sc1 lds
s_add_u32 m0, s45, 2048
s_nop 0
buffer_load_dwordx4 v241, s[84:87], s28 offen offset:1024 sc1 lds
s_add_u32 s45, s45, 4096
s_cmp_eq_u32 s45, 30720
s_cselect_b32 s45, 18432, s45
mega_kernel_rs_sd4:
v_smfmac_f32_16x16x64_bf16 v[112:115], v[40:43], a[144:151], v6
v_smfmac_f32_16x16x64_bf16 v[116:119], v[40:43], a[176:183], v6
v_smfmac_f32_16x16x64_bf16 v[112:115], v[44:47], a[152:159], v6
v_smfmac_f32_16x16x64_bf16 v[116:119], v[44:47], a[184:191], v6
s_nop 7
v_permlane32_swap_b32 v112, v116
v_permlane32_swap_b32 v113, v117
v_permlane32_swap_b32 v114, v118
v_permlane32_swap_b32 v115, v119
v_pk_add_f32 v[112:113], v[112:113], v[116:117]
v_pk_add_f32 v[114:115], v[114:115], v[118:119]
ds_write_b128 v20, v[112:115]
v_mov_b32 v96, 0
v_mov_b32 v97, 0
v_mov_b32 v98, 0
v_mov_b32 v99, 0
v_mov_b32 v100, 0
v_mov_b32 v101, 0
v_mov_b32 v102, 0
v_mov_b32 v103, 0
s_cmp_eq_u32 s24, 1
s_cbranch_scc0 mega_kernel_rs_s1
s_waitcnt lgkmcnt(0)
ds_read_b128 v[120:123], v16 offset:0
ds_read_b128 v[124:127], v16 offset:16
ds_read_b128 v[128:131], v16 offset:2304
ds_read_b128 v[132:135], v16 offset:2320
ds_read_b128 v[136:139], v16 offset:4608
ds_read_b128 v[140:143], v16 offset:4624
ds_read_b128 v[144:147], v16 offset:6912
ds_read_b128 v[148:151], v16 offset:6928
s_waitcnt lgkmcnt(4)
v_pk_add_f32 v[120:121], v[120:121], v[128:129]
v_pk_add_f32 v[122:123], v[122:123], v[130:131]
v_pk_add_f32 v[124:125], v[124:125], v[132:133]
v_pk_add_f32 v[126:127], v[126:127], v[134:135]
s_waitcnt lgkmcnt(0)
v_pk_add_f32 v[136:137], v[136:137], v[144:145]
v_pk_add_f32 v[138:139], v[138:139], v[146:147]
v_pk_add_f32 v[140:141], v[140:141], v[148:149]
v_pk_add_f32 v[142:143], v[142:143], v[150:151]
v_pk_add_f32 v[120:121], v[120:121], v[136:137]
v_pk_add_f32 v[122:123], v[122:123], v[138:139]
v_pk_add_f32 v[124:125], v[124:125], v[140:141]
v_pk_add_f32 v[126:127], v[126:127], v[142:143]
v_cvt_pk_bf16_f32 v244, v120, v121
v_cvt_pk_bf16_f32 v245, v122, v123
v_cvt_pk_bf16_f32 v246, v124, v125
v_cvt_pk_bf16_f32 v247, v126, v127
mega_kernel_rs_s1:
v_add_u32 v5, 9216, v17
s_waitcnt lgkmcnt(0)
s_barrier
s_cmp_eq_u32 s24, 2
s_cbranch_scc1 mega_kernel_rs_s2
s_cmp_eq_u32 s24, 3
s_cbranch_scc0 mega_kernel_rs_s3
s_add_u32 s76, s27, 2
s_cmp_lt_u32 s76, 63
s_cbranch_scc0 mega_kernel_rs_s3
s_cmp_gt_i32 s46, s76
s_cbranch_scc0 mega_kernel_rs_s3
s_add_u32 s77, s76, s82
s_bfe_u32 s28, s77, 0x40002
s_lshl_b32 s28, s28, 14
s_and_b32 s77, s77, 3
s_lshl_b32 s77, s77, 11
s_add_u32 s28, s28, s77
s_add_u32 s28, s28, s83
s_buffer_load_dword s78, s[84:87], s28 offset:0
s_buffer_load_dword s78, s[84:87], s28 offset:128
s_buffer_load_dword s78, s[84:87], s28 offset:256
s_buffer_load_dword s78, s[84:87], s28 offset:384
s_buffer_load_dword s78, s[84:87], s28 offset:512
s_buffer_load_dword s78, s[84:87], s28 offset:640
s_buffer_load_dword s78, s[84:87], s28 offset:768
s_buffer_load_dword s78, s[84:87], s28 offset:896
s_buffer_load_dword s78, s[84:87], s28 offset:1024
s_buffer_load_dword s78, s[84:87], s28 offset:1152
s_buffer_load_dword s78, s[84:87], s28 offset:1280
s_buffer_load_dword s78, s[84:87], s28 offset:1408
s_buffer_load_dword s78, s[84:87], s28 offset:1536
s_buffer_load_dword s78, s[84:87], s28 offset:1664
s_buffer_load_dword s78, s[84:87], s28 offset:1792
s_buffer_load_dword s78, s[84:87], s28 offset:1920
s_branch mega_kernel_rs_s3
mega_kernel_rs_s2:
ds_read_b128 v[120:123], v5 offset:0
ds_read_b128 v[124:127], v5 offset:1024
ds_read_b128 v[128:131], v5 offset:2048
ds_read_b128 v[132:135], v5 offset:3072
v_lshrrev_b32 v5, 1, v17
s_waitcnt lgkmcnt(2)
v_pk_add_f32 v[120:121], v[120:121], v[124:125]
v_pk_add_f32 v[122:123], v[122:123], v[126:127]
s_waitcnt lgkmcnt(0)
v_pk_add_f32 v[128:129], v[128:129], v[132:133]
v_pk_add_f32 v[130:131], v[130:131], v[134:135]
v_pk_add_f32 v[120:121], v[120:121], v[128:129]
v_pk_add_f32 v[122:123], v[122:123], v[130:131]
v_cvt_pk_bf16_f32 v244, v120, v121
v_cvt_pk_bf16_f32 v245, v122, v123
ds_write_b64 v5, v[244:245] offset:17920
s_waitcnt lgkmcnt(0) vmcnt(0)
mega_kernel_rs_s3:
s_cmp_eq_u32 s27, 63
s_cbranch_scc1 mega_kernel_rs_slast
s_add_u32 s29, s33, 16384
s_barrier
s_cmp_eq_u32 s24, 3
s_cbranch_scc1 mega_kernel_rs_y3
s_add_u32 s77, s27, s82
s_bfe_u32 s28, s77, 0x30003
s_lshl_b32 s28, s28, 14
s_and_b32 s77, s77, 7
s_lshl_b32 s77, s77, 10
s_add_u32 s28, s28, s77
s_add_u32 s28, s28, s79
s_cmp_eq_u32 s24, 2
s_cbranch_scc1 mega_kernel_rs_kv2a
s_mov_b64 exec, s[48:49]
buffer_store_dwordx4 v[244:247], v22, s[84:87], s28 offen sc1
s_mov_b64 exec, -1
s_branch mega_kernel_rs_kvda
mega_kernel_rs_kv2a:
v_lshlrev_b32 v4, 3, v1
buffer_store_dwordx2 v[244:245], v4, s[84:87], s28 offen offset:512 sc1
mega_kernel_rs_kvda:
s_branch mega_kernel_rs_y4
mega_kernel_rs_y3:
s_add_u32 s76, s27, 2
s_cmp_lt_u32 s76, 63
s_cbranch_scc0 mega_kernel_rs_y4
mega_kernel_rs_y4:
s_branch mega_kernel_rs_b3
mega_kernel_rs_first:
buffer_load_dwordx4 v[32:35], v8, s[20:23], 0 offen offset:0
buffer_load_dwordx4 v[36:39], v8, s[20:23], 0 offen offset:128
buffer_load_dwordx4 v[40:43], v8, s[20:23], 0 offen offset:256
buffer_load_dwordx4 v[44:47], v8, s[20:23], 0 offen offset:384
v_add_u32 v5, s44, v17
ds_read_b128 v[156:159], v5 offset:0
ds_read_b128 v[160:163], v5 offset:1024
ds_read_b128 v[164:167], v5 offset:2048
ds_read_b128 v[168:171], v5 offset:3072
s_waitcnt vmcnt(0)
v_smfmac_f32_16x16x64_bf16 v[96:99], v[32:35], a[0:7], v6
v_smfmac_f32_16x16x64_bf16 v[100:103], v[32:35], a[32:39], v6
v_smfmac_f32_16x16x64_bf16 v[104:107], v[32:35], a[64:71], v6
v_smfmac_f32_16x16x64_bf16 v[108:111], v[32:35], a[96:103], v6
v_smfmac_f32_16x16x64_bf16 v[96:99], v[36:39], a[8:15], v6
v_smfmac_f32_16x16x64_bf16 v[100:103], v[36:39], a[40:47], v6
v_smfmac_f32_16x16x64_bf16 v[104:107], v[36:39], a[72:79], v6
v_smfmac_f32_16x16x64_bf16 v[108:111], v[36:39], a[104:111], v6
v_smfmac_f32_16x16x64_bf16 v[96:99], v[40:43], a[16:23], v6
v_smfmac_f32_16x16x64_bf16 v[100:103], v[40:43], a[48:55], v6
v_smfmac_f32_16x16x64_bf16 v[104:107], v[40:43], a[80:87], v6
v_smfmac_f32_16x16x64_bf16 v[108:111], v[40:43], a[112:119], v6
v_smfmac_f32_16x16x64_bf16 v[96:99], v[44:47], a[24:31], v6
v_smfmac_f32_16x16x64_bf16 v[100:103], v[44:47], a[56:63], v6
v_smfmac_f32_16x16x64_bf16 v[104:107], v[44:47], a[88:95], v6
v_smfmac_f32_16x16x64_bf16 v[108:111], v[44:47], a[120:127], v6
s_nop 1
s_branch mega_kernel_rs_adone
mega_kernel_rs_slast:
s_cmp_eq_u32 s24, 3
s_cbranch_scc1 mega_kernel_rs_end
s_add_u32 s77, s27, s82
s_bfe_u32 s28, s77, 0x30003
s_lshl_b32 s28, s28, 14
s_and_b32 s77, s77, 7
s_lshl_b32 s77, s77, 10
s_add_u32 s28, s28, s77
s_add_u32 s28, s28, s79
s_cmp_eq_u32 s24, 2
s_cbranch_scc1 mega_kernel_rs_kv2b
s_mov_b64 exec, s[48:49]
buffer_store_dwordx4 v[244:247], v22, s[84:87], s28 offen sc1
s_mov_b64 exec, -1
s_branch mega_kernel_rs_kvdb
mega_kernel_rs_kv2b:
v_lshlrev_b32 v4, 3, v1
buffer_store_dwordx2 v[244:245], v4, s[84:87], s28 offen offset:512 sc1
mega_kernel_rs_kvdb:
s_waitcnt vmcnt(0)
s_barrier
s_mov_b32 s76, 64
s_cmp_eq_u32 s24, 1
s_cbranch_scc0 mega_kernel_rs_end
v_mov_b32 v5, s76
s_mov_b64 exec, 1
buffer_store_dword v5, v228, s[84:87], s81 offen sc1
s_mov_b64 exec, -1
mega_kernel_rs_end:
s_endpgm
.section .rodata,"a"
.p2align 6
.amdhsa_kernel mega_kernel
  .amdhsa_next_free_vgpr 512
  .amdhsa_next_free_sgpr 102
  .amdhsa_accum_offset 256
  .amdhsa_group_segment_fixed_size 0
  .amdhsa_kernarg_size 104
  .amdhsa_user_sgpr_count 2
  .amdhsa_user_sgpr_kernarg_segment_ptr 1
  .amdhsa_system_sgpr_workgroup_id_x 1
.end_amdhsa_kernel
```

```asm
; @launch kernel=mega_kernel grid=(256,1,1) block=(256,1,1) lds=163840
.amdgcn_target "amdgcn-amd-amdhsa--gfx950"
.text
.globl mega_kernel
.p2align 8
.type mega_kernel,@function
mega_kernel:
s_cmp_ge_u32 s2, 256
s_cbranch_scc1 mega_kernel_exit
s_load_dwordx2 s[84:85], s[0:1], 96
s_load_dwordx2 s[72:73], s[0:1], 88
s_getreg_b32 s90, hwreg(HW_REG_XCC_ID)
s_and_b32 s90, s90, 7
v_mov_b32 v1, 0
v_mov_b32 v2, 1
s_lshl_b32 s91, s90, 4
s_mov_b32 s95, 0
s_mov_b32 s99, 0
s_waitcnt lgkmcnt(0)
s_mov_b32 s86, 268435456
s_mov_b32 s87, 0x00020000
s_mov_b32 s74, 256
s_mov_b32 s75, 0x00020000
v_cmp_eq_u32 vcc, 0, v0
s_and_saveexec_b64 s[88:89], vcc
s_cbranch_execz mega_kernel_tkd
s_lshl_b32 s92, s2, 13
s_add_u32 s92, s92, 167772160
buffer_atomic_add v2, v1, s[72:75], s91 offen sc0
buffer_load_dword v251, v1, s[84:87], s92 offen offset:2048 sc1
s_waitcnt vmcnt(1)
ds_write_b32 v1, v2
s_waitcnt lgkmcnt(0)
mega_kernel_tkd:
s_mov_b64 exec, s[88:89]
s_barrier
ds_read_b32 v2, v1
s_waitcnt lgkmcnt(0)
v_readfirstlane_b32 s96, v2
s_barrier
s_cmp_lt_u32 s96, 32
s_cbranch_scc1 mega_kernel_spec
v_and_b32 v3, 15, v0
v_lshlrev_b32 v3, 4, v3
s_branch mega_kernel_syx
mega_kernel_syxw:
s_sleep 4
mega_kernel_syx:
buffer_load_dword v2, v3, s[72:75], 0 offen sc1
s_waitcnt vmcnt(0)
s_cmp_eq_u32 s95, 1
s_cbranch_scc0 mega_kernel_syxf
v_readlane_b32 s76, v2, 14
s_mov_b32 s98, 0
s_cmp_eq_u32 s76, 64
s_cbranch_scc0 mega_kernel_syxw
s_branch mega_kernel_syxd
mega_kernel_syxf:
s_mov_b32 s77, 0
s_mov_b32 s78, 0
v_readlane_b32 s76, v2, 0
s_add_u32 s77, s77, s76
s_xor_b32 s76, s76, 32
s_or_b32 s78, s78, s76
v_readlane_b32 s76, v2, 1
s_add_u32 s77, s77, s76
s_xor_b32 s76, s76, 32
s_or_b32 s78, s78, s76
v_readlane_b32 s76, v2, 2
s_add_u32 s77, s77, s76
s_xor_b32 s76, s76, 32
s_or_b32 s78, s78, s76
v_readlane_b32 s76, v2, 3
s_add_u32 s77, s77, s76
s_xor_b32 s76, s76, 32
s_or_b32 s78, s78, s76
v_readlane_b32 s76, v2, 4
s_add_u32 s77, s77, s76
s_xor_b32 s76, s76, 32
s_or_b32 s78, s78, s76
v_readlane_b32 s76, v2, 5
s_add_u32 s77, s77, s76
s_xor_b32 s76, s76, 32
s_or_b32 s78, s78, s76
v_readlane_b32 s76, v2, 6
s_add_u32 s77, s77, s76
s_xor_b32 s76, s76, 32
s_or_b32 s78, s78, s76
v_readlane_b32 s76, v2, 7
s_add_u32 s77, s77, s76
s_xor_b32 s76, s76, 32
s_or_b32 s78, s78, s76
s_cmp_eq_u32 s77, 256
s_cbranch_scc0 mega_kernel_syxw
v_mov_b32 v252, v2
s_cmp_eq_u32 s78, 0
s_cbranch_scc0 mega_kernel_slowent
v_readlane_b32 s76, v2, 10
v_readlane_b32 s77, v2, 8
s_cmp_eq_u32 s76, 64
s_cbranch_scc0 mega_kernel_syxw
s_cmp_gt_u32 s77, 32
s_cselect_b32 s98, 1, 0
mega_kernel_syxd:
mega_kernel_slowent:
s_mov_b64 exec, -1
s_waitcnt vmcnt(0) lgkmcnt(0)
s_barrier
s_mov_b32 s97, s96
v_readlane_b32 s76, v252, 0
s_cmp_gt_u32 s90, 0
s_cselect_b32 s76, s76, 0
s_add_u32 s97, s97, s76
v_readlane_b32 s76, v252, 1
s_cmp_gt_u32 s90, 1
s_cselect_b32 s76, s76, 0
s_add_u32 s97, s97, s76
v_readlane_b32 s76, v252, 2
s_cmp_gt_u32 s90, 2
s_cselect_b32 s76, s76, 0
s_add_u32 s97, s97, s76
v_readlane_b32 s76, v252, 3
s_cmp_gt_u32 s90, 3
s_cselect_b32 s76, s76, 0
s_add_u32 s97, s97, s76
v_readlane_b32 s76, v252, 4
s_cmp_gt_u32 s90, 4
s_cselect_b32 s76, s76, 0
s_add_u32 s97, s97, s76
v_readlane_b32 s76, v252, 5
s_cmp_gt_u32 s90, 5
s_cselect_b32 s76, s76, 0
s_add_u32 s97, s97, s76
v_readlane_b32 s76, v252, 6
s_cmp_gt_u32 s90, 6
s_cselect_b32 s76, s76, 0
s_add_u32 s97, s97, s76
v_mov_b32 v1, 0
v_mov_b32 v2, 1
v_cmp_eq_u32 vcc, 0, v0
s_and_saveexec_b64 s[88:89], vcc
s_cbranch_execz mega_kernel_sb1
buffer_atomic_add v2, v1, s[72:75], 0 offen offset:192 sc1
mega_kernel_sb1:
s_mov_b64 exec, s[88:89]
mega_kernel_sb2:
s_sleep 4
buffer_load_dword v2, v1, s[72:75], 0 offen offset:192 sc1
s_waitcnt vmcnt(0)
v_cmp_ne_u32 vcc, 256, v2
s_cbranch_vccnz mega_kernel_sb2
s_mov_b32 s95, 1
s_lshr_b32 s30, s97, 5
s_and_b32 s31, s97, 31
s_cmp_lt_u32 s97, 128
s_cbranch_scc1 mega_kernel_recs
s_sub_u32 s94, s97, 128
s_branch mega_kernel_bulk
mega_kernel_spec:
s_mov_b32 s30, s90
s_mov_b32 s31, s96
s_cmp_lt_u32 s90, 4
s_cbranch_scc1 mega_kernel_recf
s_sub_u32 s94, s90, 4
s_lshl_b32 s94, s94, 5
s_add_u32 s94, s94, s96
mega_kernel_bulk:
s_lshr_b32 s91, s94, 5
s_and_b32 s40, s94, 31
s_and_b32 s92, s91, 1
s_lshl_b32 s92, s92, 5
s_add_u32 s92, s92, s40
s_cmp_eq_u32 s91, 0
s_cbranch_scc1 mega_kernel_rk
s_cmp_eq_u32 s91, 1
s_cbranch_scc1 mega_kernel_rv
v_mov_b32 v8, -1
v_mov_b32 v9, -1
v_mov_b32 v10, -1
v_mov_b32 v11, -1
v_lshlrev_b32 v1, 4, v0
v_mov_b32 v2, 0
v_cmp_gt_u32 vcc, 64, v0
s_cbranch_vccz mega_kernel_nv
s_cmp_eq_u32 s95, 0
s_cbranch_scc0 mega_kernel_nv
s_lshr_b32 s60, s2, 1
s_lshl_b32 s60, s60, 14
s_and_b32 s61, s92, 1
s_lshl_b32 s66, s61, 13
s_add_u32 s60, s60, s66
s_and_b32 s66, s2, 1
s_lshl_b32 s66, s66, 10
s_add_u32 s60, s60, s66
s_add_u32 s60, s60, 167772160
s_mov_b32 s66, 0x7fffffff
s_mov_b32 s67, 0x7fffffff
s_mov_b64 exec, 0xff
s_waitcnt vmcnt(0)
s_memtime s[62:63]
s_waitcnt lgkmcnt(0)
buffer_store_dwordx4 v[8:11], v1, s[84:87], s60 offen offset:0 sc1
s_waitcnt vmcnt(0)
s_memtime s[64:65]
s_xor_b32 s60, s60, 8192
s_waitcnt lgkmcnt(0)
s_sub_u32 s64, s64, s62
s_min_u32 s66, s66, s64
s_memtime s[62:63]
s_waitcnt lgkmcnt(0)
buffer_store_dwordx4 v[8:11], v1, s[84:87], s60 offen offset:0 sc1
s_waitcnt vmcnt(0)
s_memtime s[64:65]
s_xor_b32 s60, s60, 8192
s_waitcnt lgkmcnt(0)
s_sub_u32 s64, s64, s62
s_min_u32 s67, s67, s64
s_memtime s[62:63]
s_waitcnt lgkmcnt(0)
buffer_store_dwordx4 v[8:11], v1, s[84:87], s60 offen offset:256 sc1
s_waitcnt vmcnt(0)
s_memtime s[64:65]
s_xor_b32 s60, s60, 8192
s_waitcnt lgkmcnt(0)
s_sub_u32 s64, s64, s62
s_min_u32 s66, s66, s64
s_memtime s[62:63]
s_waitcnt lgkmcnt(0)
buffer_store_dwordx4 v[8:11], v1, s[84:87], s60 offen offset:256 sc1
s_waitcnt vmcnt(0)
s_memtime s[64:65]
s_xor_b32 s60, s60, 8192
s_waitcnt lgkmcnt(0)
s_sub_u32 s64, s64, s62
s_min_u32 s67, s67, s64
s_cmp_lt_u32 s67, s66
s_cselect_b32 s60, 1, 0
s_xor_b32 s60, s60, s61
s_lshr_b32 s61, s90, 2
s_xor_b32 s60, s60, s61
v_mov_b32 v3, s60
s_mov_b64 exec, 1
buffer_atomic_add v3, v2, s[72:75], 0 offen offset:128 sc1
s_mov_b64 exec, -1
mega_kernel_nv:
s_barrier
s_lshl_b32 s60, s92, 12
s_add_u32 s60, s60, 67108864
buffer_store_dwordx4 v[8:11], v1, s[84:87], s60 offen sc1
s_add_u32 s60, s60, 262144
buffer_store_dwordx4 v[8:11], v1, s[84:87], s60 offen sc1
s_add_u32 s60, s60, 262144
buffer_store_dwordx4 v[8:11], v1, s[84:87], s60 offen sc1
s_add_u32 s60, s60, 262144
buffer_store_dwordx4 v[8:11], v1, s[84:87], s60 offen sc1
s_add_u32 s60, s60, 262144
buffer_store_dwordx4 v[8:11], v1, s[84:87], s60 offen sc1
s_add_u32 s60, s60, 262144
buffer_store_dwordx4 v[8:11], v1, s[84:87], s60 offen sc1
s_add_u32 s60, s60, 262144
buffer_store_dwordx4 v[8:11], v1, s[84:87], s60 offen sc1
s_add_u32 s60, s60, 262144
buffer_store_dwordx4 v[8:11], v1, s[84:87], s60 offen sc1
s_add_u32 s60, s60, 262144
s_lshr_b32 s62, s92, 1
s_and_b32 s63, s92, 1
s_add_u32 s63, s63, s62
s_lshl_b32 s62, s62, 19
s_and_b32 s64, s63, 14
s_lshl_b32 s64, s64, 13
s_add_u32 s62, s62, s64
s_and_b32 s64, s63, 1
s_lshl_b32 s64, s64, 12
s_add_u32 s62, s62, s64
s_add_u32 s62, s62, 150994944
s_add_u32 s62, s62, 8192
s_cmp_lt_u32 s92, 16
s_cbranch_scc0 mega_kernel_pz
buffer_store_dwordx4 v[8:11], v1, s[84:87], s60 offen sc1
mega_kernel_pz:
s_waitcnt vmcnt(0)
s_barrier
v_mov_b32 v3, 1
s_lshl_b32 s62, s95, 6
v_cmp_eq_u32 vcc, 0, v0
s_and_saveexec_b64 s[60:61], vcc
s_cbranch_execz mega_kernel_xps
buffer_atomic_add v3, v2, s[72:75], s62 offen offset:160 sc1
mega_kernel_xps:
s_mov_b64 exec, s[60:61]
s_cmp_eq_u32 s91, 2
s_cbranch_scc0 mega_kernel_rd
v_and_b32 v3, 15, v0
v_lshlrev_b32 v3, 4, v3
s_branch mega_kernel_syc
mega_kernel_sycw:
s_sleep 4
mega_kernel_syc:
buffer_load_dword v2, v3, s[72:75], 0 offen sc1
s_waitcnt vmcnt(0)
s_cmp_eq_u32 s95, 1
s_cbranch_scc0 mega_kernel_sycf
v_readlane_b32 s76, v2, 14
s_mov_b32 s98, 0
s_cmp_eq_u32 s76, 64
s_cbranch_scc0 mega_kernel_sycw
s_branch mega_kernel_sycd
mega_kernel_sycf:
s_mov_b32 s77, 0
s_mov_b32 s78, 0
v_readlane_b32 s76, v2, 0
s_add_u32 s77, s77, s76
s_xor_b32 s76, s76, 32
s_or_b32 s78, s78, s76
v_readlane_b32 s76, v2, 1
s_add_u32 s77, s77, s76
s_xor_b32 s76, s76, 32
s_or_b32 s78, s78, s76
v_readlane_b32 s76, v2, 2
s_add_u32 s77, s77, s76
s_xor_b32 s76, s76, 32
s_or_b32 s78, s78, s76
v_readlane_b32 s76, v2, 3
s_add_u32 s77, s77, s76
s_xor_b32 s76, s76, 32
s_or_b32 s78, s78, s76
v_readlane_b32 s76, v2, 4
s_add_u32 s77, s77, s76
s_xor_b32 s76, s76, 32
s_or_b32 s78, s78, s76
v_readlane_b32 s76, v2, 5
s_add_u32 s77, s77, s76
s_xor_b32 s76, s76, 32
s_or_b32 s78, s78, s76
v_readlane_b32 s76, v2, 6
s_add_u32 s77, s77, s76
s_xor_b32 s76, s76, 32
s_or_b32 s78, s78, s76
v_readlane_b32 s76, v2, 7
s_add_u32 s77, s77, s76
s_xor_b32 s76, s76, 32
s_or_b32 s78, s78, s76
s_cmp_eq_u32 s77, 256
s_cbranch_scc0 mega_kernel_sycw
v_mov_b32 v252, v2
s_cmp_eq_u32 s78, 0
s_cbranch_scc0 mega_kernel_slowent
v_readlane_b32 s76, v2, 10
v_readlane_b32 s77, v2, 8
s_cmp_eq_u32 s76, 64
s_cbranch_scc0 mega_kernel_sycw
s_cmp_gt_u32 s77, 32
s_cselect_b32 s98, 1, 0
mega_kernel_sycd:
s_load_dwordx2 s[4:5], s[0:1], 16
s_load_dwordx2 s[8:9], s[0:1], 0
v_lshrrev_b32 v2, 6, v0
v_and_b32 v1, 63, v0
v_readfirstlane_b32 s41, v2
v_lshlrev_b32 v5, 4, v1
s_waitcnt lgkmcnt(0)
s_mov_b32 s6, 8388608
s_mov_b32 s7, 0x00020000
s_mov_b32 s10, 4194304
s_mov_b32 s11, 0x00020000
s_lshl_b32 s43, s40, 8
s_lshl_b32 s44, s41, 6
s_add_u32 s48, s43, s44
s_and_b32 s43, s48, 0x7ff
v_add_u32 v19, s43, v1
v_lshlrev_b32 v19, 7, v19
buffer_load_dword v250, v19, s[8:11], 0 offen
s_nop 0
v_lshrrev_b32 v2, 3, v1
s_lshl_b32 s43, s41, 3
v_add_u32 v2, s43, v2
v_bfe_u32 v3, v2, 1, 3
v_and_b32 v4, 7, v1
v_xor_b32 v3, v3, v4
v_lshlrev_b32 v6, 11, v2
v_lshl_add_u32 v6, v3, 4, v6
s_lshl_b32 s46, s41, 10
v_and_b32 v2, 15, v1
v_bfe_u32 v3, v2, 1, 3
v_lshrrev_b32 v4, 4, v1
v_xor_b32 v3, v3, v4
v_lshlrev_b32 v8, 7, v2
v_lshl_add_u32 v8, v3, 4, v8
v_xor_b32 v9, 64, v8
v_add_u32 v10, 0x10000, v8
v_add_u32 v11, 0x10000, v9
v_mov_b32 v7, v5
s_lshl_b32 s47, s40, 2
s_add_u32 s47, s47, s41
s_mov_b32 s42, 0
s_mov_b32 s50, 0
s_add_u32 m0, s46, 0
s_nop 0
buffer_load_dwordx4 v6, s[8:11], s50 offen offset:0 lds
s_add_u32 m0, s46, 3968
s_nop 0
buffer_load_dwordx4 v6, s[8:11], s50 offen offset:128 lds
s_add_u32 m0, s46, 7936
s_nop 0
buffer_load_dwordx4 v6, s[8:11], s50 offen offset:256 lds
s_add_u32 m0, s46, 11904
s_nop 0
buffer_load_dwordx4 v6, s[8:11], s50 offen offset:384 lds
s_add_u32 m0, s46, 15872
s_nop 0
buffer_load_dwordx4 v6, s[8:11], s50 offen offset:512 lds
s_add_u32 m0, s46, 19840
s_nop 0
buffer_load_dwordx4 v6, s[8:11], s50 offen offset:640 lds
s_add_u32 m0, s46, 23808
s_nop 0
buffer_load_dwordx4 v6, s[8:11], s50 offen offset:768 lds
s_add_u32 m0, s46, 27776
s_nop 0
buffer_load_dwordx4 v6, s[8:11], s50 offen offset:896 lds
s_add_u32 m0, s46, 31744
s_nop 0
buffer_load_dwordx4 v6, s[8:11], s50 offen offset:1024 lds
s_add_u32 m0, s46, 35712
s_nop 0
buffer_load_dwordx4 v6, s[8:11], s50 offen offset:1152 lds
s_add_u32 m0, s46, 39680
s_nop 0
buffer_load_dwordx4 v6, s[8:11], s50 offen offset:1280 lds
s_add_u32 m0, s46, 43648
s_nop 0
buffer_load_dwordx4 v6, s[8:11], s50 offen offset:1408 lds
s_add_u32 m0, s46, 47616
s_nop 0
buffer_load_dwordx4 v6, s[8:11], s50 offen offset:1536 lds
s_add_u32 m0, s46, 51584
s_nop 0
buffer_load_dwordx4 v6, s[8:11], s50 offen offset:1664 lds
s_add_u32 m0, s46, 55552
s_nop 0
buffer_load_dwordx4 v6, s[8:11], s50 offen offset:1792 lds
s_add_u32 m0, s46, 59520
s_nop 0
buffer_load_dwordx4 v6, s[8:11], s50 offen offset:1920 lds
v_lshrrev_b32 v2, 2, v1
v_and_b32 v3, 3, v1
v_lshlrev_b32 v16, 13, v2
v_lshl_add_u32 v16, v3, 4, v16
v_add_u32 v16, s48, v16
s_mul_i32 s45, s41, 24576
s_add_u32 s45, s45, 65536
v_bfe_u32 v17, v1, 2, 2
v_lshrrev_b32 v18, 4, v1
v_lshl_add_u32 v17, v18, 3, v17
v_lshlrev_b32 v17, 6, v17
v_lshl_add_u32 v17, v3, 4, v17
v_add_u32 v17, s45, v17
s_and_b32 s43, s40, 3
s_lshl_b32 s43, s43, 2
s_add_u32 s43, s43, s41
s_lshl_b32 s43, s43, 3
v_and_b32 v12, 7, v1
v_add_u32 v12, s43, v12
s_lshr_b32 s43, s40, 2
s_lshl_b32 s43, s43, 10
s_add_u32 s44, s43, 896
s_add_u32 s43, s43, 384
s_cmp_ge_u32 s40, 28
s_cselect_b32 s44, s44, s43
v_mov_b32 v13, s43
v_mov_b32 v14, s44
v_cmp_gt_u32 vcc, 32, v1
s_nop 1
v_cndmask_b32 v13, v14, v13, vcc
v_lshl_add_u32 v12, v12, 13, v13
s_mov_b32 s44, 0
buffer_load_dword v250, v12, s[4:7], s44 offen
s_add_u32 m0, s45, 0
s_mov_b32 s44, 0
buffer_load_dwordx4 v16, s[4:7], s44 offen lds
s_add_u32 m0, s45, 1024
s_mov_b32 s44, 131072
buffer_load_dwordx4 v16, s[4:7], s44 offen lds
s_add_u32 m0, s45, 2048
s_mov_b32 s44, 262144
buffer_load_dwordx4 v16, s[4:7], s44 offen lds
s_add_u32 m0, s45, 3072
s_mov_b32 s44, 393216
buffer_load_dwordx4 v16, s[4:7], s44 offen lds
s_add_u32 m0, s45, 4096
s_mov_b32 s44, 524288
buffer_load_dwordx4 v16, s[4:7], s44 offen lds
s_add_u32 m0, s45, 5120
s_mov_b32 s44, 655360
buffer_load_dwordx4 v16, s[4:7], s44 offen lds
s_add_u32 m0, s45, 6144
s_mov_b32 s44, 786432
buffer_load_dwordx4 v16, s[4:7], s44 offen lds
s_add_u32 m0, s45, 7168
s_mov_b32 s44, 917504
buffer_load_dwordx4 v16, s[4:7], s44 offen lds
s_mov_b32 s44, 1048576
buffer_load_dword v250, v12, s[4:7], s44 offen
s_add_u32 m0, s45, 8192
s_mov_b32 s44, 1048576
buffer_load_dwordx4 v16, s[4:7], s44 offen lds
s_add_u32 m0, s45, 9216
s_mov_b32 s44, 1179648
buffer_load_dwordx4 v16, s[4:7], s44 offen lds
s_add_u32 m0, s45, 10240
s_mov_b32 s44, 1310720
buffer_load_dwordx4 v16, s[4:7], s44 offen lds
s_add_u32 m0, s45, 11264
s_mov_b32 s44, 1441792
buffer_load_dwordx4 v16, s[4:7], s44 offen lds
s_add_u32 m0, s45, 12288
s_mov_b32 s44, 1572864
buffer_load_dwordx4 v16, s[4:7], s44 offen lds
s_add_u32 m0, s45, 13312
s_mov_b32 s44, 1703936
buffer_load_dwordx4 v16, s[4:7], s44 offen lds
s_add_u32 m0, s45, 14336
s_mov_b32 s44, 1835008
buffer_load_dwordx4 v16, s[4:7], s44 offen lds
s_add_u32 m0, s45, 15360
s_mov_b32 s44, 1966080
buffer_load_dwordx4 v16, s[4:7], s44 offen lds
s_mov_b32 s44, 2097152
buffer_load_dword v250, v12, s[4:7], s44 offen
s_add_u32 m0, s45, 16384
s_mov_b32 s44, 2097152
buffer_load_dwordx4 v16, s[4:7], s44 offen lds
s_add_u32 m0, s45, 17408
s_mov_b32 s44, 2228224
buffer_load_dwordx4 v16, s[4:7], s44 offen lds
s_add_u32 m0, s45, 18432
s_mov_b32 s44, 2359296
buffer_load_dwordx4 v16, s[4:7], s44 offen lds
s_add_u32 m0, s45, 19456
s_mov_b32 s44, 2490368
buffer_load_dwordx4 v16, s[4:7], s44 offen lds
s_add_u32 m0, s45, 20480
s_mov_b32 s44, 2621440
buffer_load_dwordx4 v16, s[4:7], s44 offen lds
s_add_u32 m0, s45, 21504
s_mov_b32 s44, 2752512
buffer_load_dwordx4 v16, s[4:7], s44 offen lds
s_add_u32 m0, s45, 22528
s_mov_b32 s44, 2883584
buffer_load_dwordx4 v16, s[4:7], s44 offen lds
s_add_u32 m0, s45, 23552
s_mov_b32 s44, 3014656
buffer_load_dwordx4 v16, s[4:7], s44 offen lds
s_waitcnt vmcnt(18)
s_barrier
ds_read_b64_tr_b16 a[0:1], v17 offset:0
ds_read_b64_tr_b16 a[2:3], v17 offset:256
ds_read_b64_tr_b16 a[4:5], v17 offset:8
ds_read_b64_tr_b16 a[6:7], v17 offset:264
ds_read_b64_tr_b16 a[8:9], v17 offset:2048
ds_read_b64_tr_b16 a[10:11], v17 offset:2304
ds_read_b64_tr_b16 a[12:13], v17 offset:2056
ds_read_b64_tr_b16 a[14:15], v17 offset:2312
s_waitcnt lgkmcnt(0)
ds_read_b64_tr_b16 a[16:17], v17 offset:4096
ds_read_b64_tr_b16 a[18:19], v17 offset:4352
ds_read_b64_tr_b16 a[20:21], v17 offset:4104
ds_read_b64_tr_b16 a[22:23], v17 offset:4360
ds_read_b64_tr_b16 a[24:25], v17 offset:6144
ds_read_b64_tr_b16 a[26:27], v17 offset:6400
ds_read_b64_tr_b16 a[28:29], v17 offset:6152
ds_read_b64_tr_b16 a[30:31], v17 offset:6408
s_waitcnt lgkmcnt(0)
ds_read_b128 v[20:23], v8 offset:0
ds_read_b128 v[24:27], v8 offset:2048
ds_read_b128 v[28:31], v9 offset:0
ds_read_b128 v[32:35], v9 offset:2048
ds_read_b128 v[36:39], v8 offset:4096
ds_read_b128 v[40:43], v8 offset:6144
ds_read_b128 v[44:47], v9 offset:4096
ds_read_b128 v[48:51], v9 offset:6144
s_mov_b32 s44, 3145728
buffer_load_dword v250, v12, s[4:7], s44 offen
s_add_u32 m0, s45, 0
s_mov_b32 s44, 3145728
buffer_load_dwordx4 v16, s[4:7], s44 offen lds
s_add_u32 m0, s45, 1024
s_mov_b32 s44, 3276800
buffer_load_dwordx4 v16, s[4:7], s44 offen lds
s_add_u32 m0, s45, 2048
s_mov_b32 s44, 3407872
buffer_load_dwordx4 v16, s[4:7], s44 offen lds
s_add_u32 m0, s45, 3072
s_mov_b32 s44, 3538944
buffer_load_dwordx4 v16, s[4:7], s44 offen lds
s_add_u32 m0, s45, 4096
s_mov_b32 s44, 3670016
buffer_load_dwordx4 v16, s[4:7], s44 offen lds
s_add_u32 m0, s45, 5120
s_mov_b32 s44, 3801088
buffer_load_dwordx4 v16, s[4:7], s44 offen lds
s_add_u32 m0, s45, 6144
s_mov_b32 s44, 3932160
buffer_load_dwordx4 v16, s[4:7], s44 offen lds
s_add_u32 m0, s45, 7168
s_mov_b32 s44, 4063232
buffer_load_dwordx4 v16, s[4:7], s44 offen lds
s_waitcnt lgkmcnt(0)
v_mfma_f32_16x16x32_bf16 v[52:55], a[0:3], v[20:23], 0
v_mfma_f32_16x16x32_bf16 v[56:59], a[4:7], v[20:23], 0
v_mfma_f32_16x16x32_bf16 v[60:63], a[0:3], v[24:27], 0
v_mfma_f32_16x16x32_bf16 v[64:67], a[4:7], v[24:27], 0
v_mfma_f32_16x16x32_bf16 v[52:55], a[8:11], v[28:31], v[52:55]
v_mfma_f32_16x16x32_bf16 v[56:59], a[12:15], v[28:31], v[56:59]
v_mfma_f32_16x16x32_bf16 v[60:63], a[8:11], v[32:35], v[60:63]
v_mfma_f32_16x16x32_bf16 v[64:67], a[12:15], v[32:35], v[64:67]
v_mfma_f32_16x16x32_bf16 v[52:55], a[16:19], v[36:39], v[52:55]
v_mfma_f32_16x16x32_bf16 v[56:59], a[20:23], v[36:39], v[56:59]
v_mfma_f32_16x16x32_bf16 v[60:63], a[16:19], v[40:43], v[60:63]
v_mfma_f32_16x16x32_bf16 v[64:67], a[20:23], v[40:43], v[64:67]
v_mfma_f32_16x16x32_bf16 v[52:55], a[24:27], v[44:47], v[52:55]
v_mfma_f32_16x16x32_bf16 v[56:59], a[28:31], v[44:47], v[56:59]
v_mfma_f32_16x16x32_bf16 v[60:63], a[24:27], v[48:51], v[60:63]
v_mfma_f32_16x16x32_bf16 v[64:67], a[28:31], v[48:51], v[64:67]
s_waitcnt vmcnt(18)
ds_read_b64_tr_b16 a[32:33], v17 offset:8192
ds_read_b64_tr_b16 a[34:35], v17 offset:8448
ds_read_b64_tr_b16 a[36:37], v17 offset:8200
ds_read_b64_tr_b16 a[38:39], v17 offset:8456
ds_read_b64_tr_b16 a[40:41], v17 offset:10240
ds_read_b64_tr_b16 a[42:43], v17 offset:10496
ds_read_b64_tr_b16 a[44:45], v17 offset:10248
ds_read_b64_tr_b16 a[46:47], v17 offset:10504
s_waitcnt lgkmcnt(0)
ds_read_b64_tr_b16 a[48:49], v17 offset:12288
ds_read_b64_tr_b16 a[50:51], v17 offset:12544
ds_read_b64_tr_b16 a[52:53], v17 offset:12296
ds_read_b64_tr_b16 a[54:55], v17 offset:12552
ds_read_b64_tr_b16 a[56:57], v17 offset:14336
ds_read_b64_tr_b16 a[58:59], v17 offset:14592
ds_read_b64_tr_b16 a[60:61], v17 offset:14344
ds_read_b64_tr_b16 a[62:63], v17 offset:14600
s_waitcnt lgkmcnt(0)
ds_read_b128 v[20:23], v8 offset:8192
ds_read_b128 v[24:27], v8 offset:10240
ds_read_b128 v[28:31], v9 offset:8192
ds_read_b128 v[32:35], v9 offset:10240
ds_read_b128 v[36:39], v8 offset:12288
ds_read_b128 v[40:43], v8 offset:14336
ds_read_b128 v[44:47], v9 offset:12288
ds_read_b128 v[48:51], v9 offset:14336
s_mov_b32 s44, 4194304
buffer_load_dword v250, v12, s[4:7], s44 offen
s_add_u32 m0, s45, 8192
s_mov_b32 s44, 4194304
buffer_load_dwordx4 v16, s[4:7], s44 offen lds
s_add_u32 m0, s45, 9216
s_mov_b32 s44, 4325376
buffer_load_dwordx4 v16, s[4:7], s44 offen lds
s_add_u32 m0, s45, 10240
s_mov_b32 s44, 4456448
buffer_load_dwordx4 v16, s[4:7], s44 offen lds
s_add_u32 m0, s45, 11264
s_mov_b32 s44, 4587520
buffer_load_dwordx4 v16, s[4:7], s44 offen lds
s_add_u32 m0, s45, 12288
s_mov_b32 s44, 4718592
buffer_load_dwordx4 v16, s[4:7], s44 offen lds
s_add_u32 m0, s45, 13312
s_mov_b32 s44, 4849664
buffer_load_dwordx4 v16, s[4:7], s44 offen lds
s_add_u32 m0, s45, 14336
s_mov_b32 s44, 4980736
buffer_load_dwordx4 v16, s[4:7], s44 offen lds
s_add_u32 m0, s45, 15360
s_mov_b32 s44, 5111808
buffer_load_dwordx4 v16, s[4:7], s44 offen lds
s_waitcnt lgkmcnt(0)
v_mfma_f32_16x16x32_bf16 v[52:55], a[32:35], v[20:23], v[52:55]
v_mfma_f32_16x16x32_bf16 v[56:59], a[36:39], v[20:23], v[56:59]
v_mfma_f32_16x16x32_bf16 v[60:63], a[32:35], v[24:27], v[60:63]
v_mfma_f32_16x16x32_bf16 v[64:67], a[36:39], v[24:27], v[64:67]
v_mfma_f32_16x16x32_bf16 v[52:55], a[40:43], v[28:31], v[52:55]
v_mfma_f32_16x16x32_bf16 v[56:59], a[44:47], v[28:31], v[56:59]
v_mfma_f32_16x16x32_bf16 v[60:63], a[40:43], v[32:35], v[60:63]
v_mfma_f32_16x16x32_bf16 v[64:67], a[44:47], v[32:35], v[64:67]
v_mfma_f32_16x16x32_bf16 v[52:55], a[48:51], v[36:39], v[52:55]
v_mfma_f32_16x16x32_bf16 v[56:59], a[52:55], v[36:39], v[56:59]
v_mfma_f32_16x16x32_bf16 v[60:63], a[48:51], v[40:43], v[60:63]
v_mfma_f32_16x16x32_bf16 v[64:67], a[52:55], v[40:43], v[64:67]
v_mfma_f32_16x16x32_bf16 v[52:55], a[56:59], v[44:47], v[52:55]
v_mfma_f32_16x16x32_bf16 v[56:59], a[60:63], v[44:47], v[56:59]
v_mfma_f32_16x16x32_bf16 v[60:63], a[56:59], v[48:51], v[60:63]
v_mfma_f32_16x16x32_bf16 v[64:67], a[60:63], v[48:51], v[64:67]
s_waitcnt vmcnt(18)
ds_read_b64_tr_b16 a[64:65], v17 offset:16384
ds_read_b64_tr_b16 a[66:67], v17 offset:16640
ds_read_b64_tr_b16 a[68:69], v17 offset:16392
ds_read_b64_tr_b16 a[70:71], v17 offset:16648
ds_read_b64_tr_b16 a[72:73], v17 offset:18432
ds_read_b64_tr_b16 a[74:75], v17 offset:18688
ds_read_b64_tr_b16 a[76:77], v17 offset:18440
ds_read_b64_tr_b16 a[78:79], v17 offset:18696
s_waitcnt lgkmcnt(0)
ds_read_b64_tr_b16 a[80:81], v17 offset:20480
ds_read_b64_tr_b16 a[82:83], v17 offset:20736
ds_read_b64_tr_b16 a[84:85], v17 offset:20488
ds_read_b64_tr_b16 a[86:87], v17 offset:20744
ds_read_b64_tr_b16 a[88:89], v17 offset:22528
ds_read_b64_tr_b16 a[90:91], v17 offset:22784
ds_read_b64_tr_b16 a[92:93], v17 offset:22536
ds_read_b64_tr_b16 a[94:95], v17 offset:22792
s_waitcnt lgkmcnt(0)
ds_read_b128 v[20:23], v8 offset:16384
ds_read_b128 v[24:27], v8 offset:18432
ds_read_b128 v[28:31], v9 offset:16384
ds_read_b128 v[32:35], v9 offset:18432
ds_read_b128 v[36:39], v8 offset:20480
ds_read_b128 v[40:43], v8 offset:22528
ds_read_b128 v[44:47], v9 offset:20480
ds_read_b128 v[48:51], v9 offset:22528
s_mov_b32 s44, 5242880
buffer_load_dword v250, v12, s[4:7], s44 offen
s_add_u32 m0, s45, 16384
s_mov_b32 s44, 5242880
buffer_load_dwordx4 v16, s[4:7], s44 offen lds
s_add_u32 m0, s45, 17408
s_mov_b32 s44, 5373952
buffer_load_dwordx4 v16, s[4:7], s44 offen lds
s_add_u32 m0, s45, 18432
s_mov_b32 s44, 5505024
buffer_load_dwordx4 v16, s[4:7], s44 offen lds
s_add_u32 m0, s45, 19456
s_mov_b32 s44, 5636096
buffer_load_dwordx4 v16, s[4:7], s44 offen lds
s_add_u32 m0, s45, 20480
s_mov_b32 s44, 5767168
buffer_load_dwordx4 v16, s[4:7], s44 offen lds
s_add_u32 m0, s45, 21504
s_mov_b32 s44, 5898240
buffer_load_dwordx4 v16, s[4:7], s44 offen lds
s_add_u32 m0, s45, 22528
s_mov_b32 s44, 6029312
buffer_load_dwordx4 v16, s[4:7], s44 offen lds
s_add_u32 m0, s45, 23552
s_mov_b32 s44, 6160384
buffer_load_dwordx4 v16, s[4:7], s44 offen lds
s_waitcnt lgkmcnt(0)
v_mfma_f32_16x16x32_bf16 v[52:55], a[64:67], v[20:23], v[52:55]
v_mfma_f32_16x16x32_bf16 v[56:59], a[68:71], v[20:23], v[56:59]
v_mfma_f32_16x16x32_bf16 v[60:63], a[64:67], v[24:27], v[60:63]
v_mfma_f32_16x16x32_bf16 v[64:67], a[68:71], v[24:27], v[64:67]
v_mfma_f32_16x16x32_bf16 v[52:55], a[72:75], v[28:31], v[52:55]
v_mfma_f32_16x16x32_bf16 v[56:59], a[76:79], v[28:31], v[56:59]
v_mfma_f32_16x16x32_bf16 v[60:63], a[72:75], v[32:35], v[60:63]
v_mfma_f32_16x16x32_bf16 v[64:67], a[76:79], v[32:35], v[64:67]
v_mfma_f32_16x16x32_bf16 v[52:55], a[80:83], v[36:39], v[52:55]
v_mfma_f32_16x16x32_bf16 v[56:59], a[84:87], v[36:39], v[56:59]
v_mfma_f32_16x16x32_bf16 v[60:63], a[80:83], v[40:43], v[60:63]
v_mfma_f32_16x16x32_bf16 v[64:67], a[84:87], v[40:43], v[64:67]
v_mfma_f32_16x16x32_bf16 v[52:55], a[88:91], v[44:47], v[52:55]
v_mfma_f32_16x16x32_bf16 v[56:59], a[92:95], v[44:47], v[56:59]
v_mfma_f32_16x16x32_bf16 v[60:63], a[88:91], v[48:51], v[60:63]
v_mfma_f32_16x16x32_bf16 v[64:67], a[92:95], v[48:51], v[64:67]
s_waitcnt vmcnt(18)
ds_read_b64_tr_b16 a[96:97], v17 offset:0
ds_read_b64_tr_b16 a[98:99], v17 offset:256
ds_read_b64_tr_b16 a[100:101], v17 offset:8
ds_read_b64_tr_b16 a[102:103], v17 offset:264
ds_read_b64_tr_b16 a[104:105], v17 offset:2048
ds_read_b64_tr_b16 a[106:107], v17 offset:2304
ds_read_b64_tr_b16 a[108:109], v17 offset:2056
ds_read_b64_tr_b16 a[110:111], v17 offset:2312
s_waitcnt lgkmcnt(0)
ds_read_b64_tr_b16 a[112:113], v17 offset:4096
ds_read_b64_tr_b16 a[114:115], v17 offset:4352
ds_read_b64_tr_b16 a[116:117], v17 offset:4104
ds_read_b64_tr_b16 a[118:119], v17 offset:4360
ds_read_b64_tr_b16 a[120:121], v17 offset:6144
ds_read_b64_tr_b16 a[122:123], v17 offset:6400
ds_read_b64_tr_b16 a[124:125], v17 offset:6152
ds_read_b64_tr_b16 a[126:127], v17 offset:6408
s_waitcnt lgkmcnt(0)
ds_read_b128 v[20:23], v8 offset:24576
ds_read_b128 v[24:27], v8 offset:26624
ds_read_b128 v[28:31], v9 offset:24576
ds_read_b128 v[32:35], v9 offset:26624
ds_read_b128 v[36:39], v8 offset:28672
ds_read_b128 v[40:43], v8 offset:30720
ds_read_b128 v[44:47], v9 offset:28672
ds_read_b128 v[48:51], v9 offset:30720
s_mov_b32 s44, 6291456
buffer_load_dword v250, v12, s[4:7], s44 offen
s_add_u32 m0, s45, 0
s_mov_b32 s44, 6291456
buffer_load_dwordx4 v16, s[4:7], s44 offen lds
s_add_u32 m0, s45, 1024
s_mov_b32 s44, 6422528
buffer_load_dwordx4 v16, s[4:7], s44 offen lds
s_add_u32 m0, s45, 2048
s_mov_b32 s44, 6553600
buffer_load_dwordx4 v16, s[4:7], s44 offen lds
s_add_u32 m0, s45, 3072
s_mov_b32 s44, 6684672
buffer_load_dwordx4 v16, s[4:7], s44 offen lds
s_add_u32 m0, s45, 4096
s_mov_b32 s44, 6815744
buffer_load_dwordx4 v16, s[4:7], s44 offen lds
s_add_u32 m0, s45, 5120
s_mov_b32 s44, 6946816
buffer_load_dwordx4 v16, s[4:7], s44 offen lds
s_add_u32 m0, s45, 6144
s_mov_b32 s44, 7077888
buffer_load_dwordx4 v16, s[4:7], s44 offen lds
s_add_u32 m0, s45, 7168
s_mov_b32 s44, 7208960
buffer_load_dwordx4 v16, s[4:7], s44 offen lds
s_waitcnt lgkmcnt(0)
v_mfma_f32_16x16x32_bf16 v[52:55], a[96:99], v[20:23], v[52:55]
v_mfma_f32_16x16x32_bf16 v[56:59], a[100:103], v[20:23], v[56:59]
v_mfma_f32_16x16x32_bf16 v[60:63], a[96:99], v[24:27], v[60:63]
v_mfma_f32_16x16x32_bf16 v[64:67], a[100:103], v[24:27], v[64:67]
v_mfma_f32_16x16x32_bf16 v[52:55], a[104:107], v[28:31], v[52:55]
v_mfma_f32_16x16x32_bf16 v[56:59], a[108:111], v[28:31], v[56:59]
v_mfma_f32_16x16x32_bf16 v[60:63], a[104:107], v[32:35], v[60:63]
v_mfma_f32_16x16x32_bf16 v[64:67], a[108:111], v[32:35], v[64:67]
v_mfma_f32_16x16x32_bf16 v[52:55], a[112:115], v[36:39], v[52:55]
v_mfma_f32_16x16x32_bf16 v[56:59], a[116:119], v[36:39], v[56:59]
v_mfma_f32_16x16x32_bf16 v[60:63], a[112:115], v[40:43], v[60:63]
v_mfma_f32_16x16x32_bf16 v[64:67], a[116:119], v[40:43], v[64:67]
v_mfma_f32_16x16x32_bf16 v[52:55], a[120:123], v[44:47], v[52:55]
v_mfma_f32_16x16x32_bf16 v[56:59], a[124:127], v[44:47], v[56:59]
v_mfma_f32_16x16x32_bf16 v[60:63], a[120:123], v[48:51], v[60:63]
v_mfma_f32_16x16x32_bf16 v[64:67], a[124:127], v[48:51], v[64:67]
s_waitcnt vmcnt(18)
ds_read_b64_tr_b16 a[128:129], v17 offset:8192
ds_read_b64_tr_b16 a[130:131], v17 offset:8448
ds_read_b64_tr_b16 a[132:133], v17 offset:8200
ds_read_b64_tr_b16 a[134:135], v17 offset:8456
ds_read_b64_tr_b16 a[136:137], v17 offset:10240
ds_read_b64_tr_b16 a[138:139], v17 offset:10496
ds_read_b64_tr_b16 a[140:141], v17 offset:10248
ds_read_b64_tr_b16 a[142:143], v17 offset:10504
s_waitcnt lgkmcnt(0)
ds_read_b64_tr_b16 a[144:145], v17 offset:12288
ds_read_b64_tr_b16 a[146:147], v17 offset:12544
ds_read_b64_tr_b16 a[148:149], v17 offset:12296
ds_read_b64_tr_b16 a[150:151], v17 offset:12552
ds_read_b64_tr_b16 a[152:153], v17 offset:14336
ds_read_b64_tr_b16 a[154:155], v17 offset:14592
ds_read_b64_tr_b16 a[156:157], v17 offset:14344
ds_read_b64_tr_b16 a[158:159], v17 offset:14600
s_waitcnt lgkmcnt(0)
ds_read_b128 v[20:23], v8 offset:32768
ds_read_b128 v[24:27], v8 offset:34816
ds_read_b128 v[28:31], v9 offset:32768
ds_read_b128 v[32:35], v9 offset:34816
ds_read_b128 v[36:39], v8 offset:36864
ds_read_b128 v[40:43], v8 offset:38912
ds_read_b128 v[44:47], v9 offset:36864
ds_read_b128 v[48:51], v9 offset:38912
s_mov_b32 s44, 7340032
buffer_load_dword v250, v12, s[4:7], s44 offen
s_add_u32 m0, s45, 8192
s_mov_b32 s44, 7340032
buffer_load_dwordx4 v16, s[4:7], s44 offen lds
s_add_u32 m0, s45, 9216
s_mov_b32 s44, 7471104
buffer_load_dwordx4 v16, s[4:7], s44 offen lds
s_add_u32 m0, s45, 10240
s_mov_b32 s44, 7602176
buffer_load_dwordx4 v16, s[4:7], s44 offen lds
s_add_u32 m0, s45, 11264
s_mov_b32 s44, 7733248
buffer_load_dwordx4 v16, s[4:7], s44 offen lds
s_add_u32 m0, s45, 12288
s_mov_b32 s44, 7864320
buffer_load_dwordx4 v16, s[4:7], s44 offen lds
s_add_u32 m0, s45, 13312
s_mov_b32 s44, 7995392
buffer_load_dwordx4 v16, s[4:7], s44 offen lds
s_add_u32 m0, s45, 14336
s_mov_b32 s44, 8126464
buffer_load_dwordx4 v16, s[4:7], s44 offen lds
s_add_u32 m0, s45, 15360
s_mov_b32 s44, 8257536
buffer_load_dwordx4 v16, s[4:7], s44 offen lds
s_waitcnt lgkmcnt(0)
v_mfma_f32_16x16x32_bf16 v[52:55], a[128:131], v[20:23], v[52:55]
v_mfma_f32_16x16x32_bf16 v[56:59], a[132:135], v[20:23], v[56:59]
v_mfma_f32_16x16x32_bf16 v[60:63], a[128:131], v[24:27], v[60:63]
v_mfma_f32_16x16x32_bf16 v[64:67], a[132:135], v[24:27], v[64:67]
v_mfma_f32_16x16x32_bf16 v[52:55], a[136:139], v[28:31], v[52:55]
v_mfma_f32_16x16x32_bf16 v[56:59], a[140:143], v[28:31], v[56:59]
v_mfma_f32_16x16x32_bf16 v[60:63], a[136:139], v[32:35], v[60:63]
v_mfma_f32_16x16x32_bf16 v[64:67], a[140:143], v[32:35], v[64:67]
v_mfma_f32_16x16x32_bf16 v[52:55], a[144:147], v[36:39], v[52:55]
v_mfma_f32_16x16x32_bf16 v[56:59], a[148:151], v[36:39], v[56:59]
v_mfma_f32_16x16x32_bf16 v[60:63], a[144:147], v[40:43], v[60:63]
v_mfma_f32_16x16x32_bf16 v[64:67], a[148:151], v[40:43], v[64:67]
v_mfma_f32_16x16x32_bf16 v[52:55], a[152:155], v[44:47], v[52:55]
v_mfma_f32_16x16x32_bf16 v[56:59], a[156:159], v[44:47], v[56:59]
v_mfma_f32_16x16x32_bf16 v[60:63], a[152:155], v[48:51], v[60:63]
v_mfma_f32_16x16x32_bf16 v[64:67], a[156:159], v[48:51], v[64:67]
s_waitcnt vmcnt(18)
ds_read_b64_tr_b16 a[160:161], v17 offset:16384
ds_read_b64_tr_b16 a[162:163], v17 offset:16640
ds_read_b64_tr_b16 a[164:165], v17 offset:16392
ds_read_b64_tr_b16 a[166:167], v17 offset:16648
ds_read_b64_tr_b16 a[168:169], v17 offset:18432
ds_read_b64_tr_b16 a[170:171], v17 offset:18688
ds_read_b64_tr_b16 a[172:173], v17 offset:18440
ds_read_b64_tr_b16 a[174:175], v17 offset:18696
s_waitcnt lgkmcnt(0)
ds_read_b64_tr_b16 a[176:177], v17 offset:20480
ds_read_b64_tr_b16 a[178:179], v17 offset:20736
ds_read_b64_tr_b16 a[180:181], v17 offset:20488
ds_read_b64_tr_b16 a[182:183], v17 offset:20744
ds_read_b64_tr_b16 a[184:185], v17 offset:22528
ds_read_b64_tr_b16 a[186:187], v17 offset:22784
ds_read_b64_tr_b16 a[188:189], v17 offset:22536
ds_read_b64_tr_b16 a[190:191], v17 offset:22792
s_waitcnt lgkmcnt(0)
ds_read_b128 v[20:23], v8 offset:40960
ds_read_b128 v[24:27], v8 offset:43008
ds_read_b128 v[28:31], v9 offset:40960
ds_read_b128 v[32:35], v9 offset:43008
ds_read_b128 v[36:39], v8 offset:45056
ds_read_b128 v[40:43], v8 offset:47104
ds_read_b128 v[44:47], v9 offset:45056
ds_read_b128 v[48:51], v9 offset:47104
s_waitcnt lgkmcnt(0)
v_mfma_f32_16x16x32_bf16 v[52:55], a[160:163], v[20:23], v[52:55]
v_mfma_f32_16x16x32_bf16 v[56:59], a[164:167], v[20:23], v[56:59]
v_mfma_f32_16x16x32_bf16 v[60:63], a[160:163], v[24:27], v[60:63]
v_mfma_f32_16x16x32_bf16 v[64:67], a[164:167], v[24:27], v[64:67]
v_mfma_f32_16x16x32_bf16 v[52:55], a[168:171], v[28:31], v[52:55]
v_mfma_f32_16x16x32_bf16 v[56:59], a[172:175], v[28:31], v[56:59]
v_mfma_f32_16x16x32_bf16 v[60:63], a[168:171], v[32:35], v[60:63]
v_mfma_f32_16x16x32_bf16 v[64:67], a[172:175], v[32:35], v[64:67]
v_mfma_f32_16x16x32_bf16 v[52:55], a[176:179], v[36:39], v[52:55]
v_mfma_f32_16x16x32_bf16 v[56:59], a[180:183], v[36:39], v[56:59]
v_mfma_f32_16x16x32_bf16 v[60:63], a[176:179], v[40:43], v[60:63]
v_mfma_f32_16x16x32_bf16 v[64:67], a[180:183], v[40:43], v[64:67]
v_mfma_f32_16x16x32_bf16 v[52:55], a[184:187], v[44:47], v[52:55]
v_mfma_f32_16x16x32_bf16 v[56:59], a[188:191], v[44:47], v[56:59]
v_mfma_f32_16x16x32_bf16 v[60:63], a[184:187], v[48:51], v[60:63]
v_mfma_f32_16x16x32_bf16 v[64:67], a[188:191], v[48:51], v[64:67]
s_waitcnt vmcnt(9)
ds_read_b64_tr_b16 a[192:193], v17 offset:0
ds_read_b64_tr_b16 a[194:195], v17 offset:256
ds_read_b64_tr_b16 a[196:197], v17 offset:8
ds_read_b64_tr_b16 a[198:199], v17 offset:264
ds_read_b64_tr_b16 a[200:201], v17 offset:2048
ds_read_b64_tr_b16 a[202:203], v17 offset:2304
ds_read_b64_tr_b16 a[204:205], v17 offset:2056
ds_read_b64_tr_b16 a[206:207], v17 offset:2312
s_waitcnt lgkmcnt(0)
ds_read_b64_tr_b16 a[208:209], v17 offset:4096
ds_read_b64_tr_b16 a[210:211], v17 offset:4352
ds_read_b64_tr_b16 a[212:213], v17 offset:4104
ds_read_b64_tr_b16 a[214:215], v17 offset:4360
ds_read_b64_tr_b16 a[216:217], v17 offset:6144
ds_read_b64_tr_b16 a[218:219], v17 offset:6400
ds_read_b64_tr_b16 a[220:221], v17 offset:6152
ds_read_b64_tr_b16 a[222:223], v17 offset:6408
s_waitcnt lgkmcnt(0)
ds_read_b128 v[20:23], v8 offset:49152
ds_read_b128 v[24:27], v8 offset:51200
ds_read_b128 v[28:31], v9 offset:49152
ds_read_b128 v[32:35], v9 offset:51200
ds_read_b128 v[36:39], v8 offset:53248
ds_read_b128 v[40:43], v8 offset:55296
ds_read_b128 v[44:47], v9 offset:53248
ds_read_b128 v[48:51], v9 offset:55296
s_waitcnt lgkmcnt(0)
v_mfma_f32_16x16x32_bf16 v[52:55], a[192:195], v[20:23], v[52:55]
v_mfma_f32_16x16x32_bf16 v[56:59], a[196:199], v[20:23], v[56:59]
v_mfma_f32_16x16x32_bf16 v[60:63], a[192:195], v[24:27], v[60:63]
v_mfma_f32_16x16x32_bf16 v[64:67], a[196:199], v[24:27], v[64:67]
v_mfma_f32_16x16x32_bf16 v[52:55], a[200:203], v[28:31], v[52:55]
v_mfma_f32_16x16x32_bf16 v[56:59], a[204:207], v[28:31], v[56:59]
v_mfma_f32_16x16x32_bf16 v[60:63], a[200:203], v[32:35], v[60:63]
v_mfma_f32_16x16x32_bf16 v[64:67], a[204:207], v[32:35], v[64:67]
v_mfma_f32_16x16x32_bf16 v[52:55], a[208:211], v[36:39], v[52:55]
v_mfma_f32_16x16x32_bf16 v[56:59], a[212:215], v[36:39], v[56:59]
v_mfma_f32_16x16x32_bf16 v[60:63], a[208:211], v[40:43], v[60:63]
v_mfma_f32_16x16x32_bf16 v[64:67], a[212:215], v[40:43], v[64:67]
v_mfma_f32_16x16x32_bf16 v[52:55], a[216:219], v[44:47], v[52:55]
v_mfma_f32_16x16x32_bf16 v[56:59], a[220:223], v[44:47], v[56:59]
v_mfma_f32_16x16x32_bf16 v[60:63], a[216:219], v[48:51], v[60:63]
v_mfma_f32_16x16x32_bf16 v[64:67], a[220:223], v[48:51], v[64:67]
s_waitcnt vmcnt(0)
ds_read_b64_tr_b16 a[224:225], v17 offset:8192
ds_read_b64_tr_b16 a[226:227], v17 offset:8448
ds_read_b64_tr_b16 a[228:229], v17 offset:8200
ds_read_b64_tr_b16 a[230:231], v17 offset:8456
ds_read_b64_tr_b16 a[232:233], v17 offset:10240
ds_read_b64_tr_b16 a[234:235], v17 offset:10496
ds_read_b64_tr_b16 a[236:237], v17 offset:10248
ds_read_b64_tr_b16 a[238:239], v17 offset:10504
s_waitcnt lgkmcnt(0)
ds_read_b64_tr_b16 a[240:241], v17 offset:12288
ds_read_b64_tr_b16 a[242:243], v17 offset:12544
ds_read_b64_tr_b16 a[244:245], v17 offset:12296
ds_read_b64_tr_b16 a[246:247], v17 offset:12552
ds_read_b64_tr_b16 a[248:249], v17 offset:14336
ds_read_b64_tr_b16 a[250:251], v17 offset:14592
ds_read_b64_tr_b16 a[252:253], v17 offset:14344
ds_read_b64_tr_b16 a[254:255], v17 offset:14600
s_waitcnt lgkmcnt(0)
ds_read_b128 v[20:23], v8 offset:57344
ds_read_b128 v[24:27], v8 offset:59392
ds_read_b128 v[28:31], v9 offset:57344
ds_read_b128 v[32:35], v9 offset:59392
ds_read_b128 v[36:39], v8 offset:61440
ds_read_b128 v[40:43], v8 offset:63488
ds_read_b128 v[44:47], v9 offset:61440
ds_read_b128 v[48:51], v9 offset:63488
s_waitcnt lgkmcnt(0)
v_mfma_f32_16x16x32_bf16 v[52:55], a[224:227], v[20:23], v[52:55]
v_mfma_f32_16x16x32_bf16 v[56:59], a[228:231], v[20:23], v[56:59]
v_mfma_f32_16x16x32_bf16 v[60:63], a[224:227], v[24:27], v[60:63]
v_mfma_f32_16x16x32_bf16 v[64:67], a[228:231], v[24:27], v[64:67]
v_mfma_f32_16x16x32_bf16 v[52:55], a[232:235], v[28:31], v[52:55]
v_mfma_f32_16x16x32_bf16 v[56:59], a[236:239], v[28:31], v[56:59]
v_mfma_f32_16x16x32_bf16 v[60:63], a[232:235], v[32:35], v[60:63]
v_mfma_f32_16x16x32_bf16 v[64:67], a[236:239], v[32:35], v[64:67]
v_mfma_f32_16x16x32_bf16 v[52:55], a[240:243], v[36:39], v[52:55]
v_mfma_f32_16x16x32_bf16 v[56:59], a[244:247], v[36:39], v[56:59]
v_mfma_f32_16x16x32_bf16 v[60:63], a[240:243], v[40:43], v[60:63]
v_mfma_f32_16x16x32_bf16 v[64:67], a[244:247], v[40:43], v[64:67]
v_mfma_f32_16x16x32_bf16 v[52:55], a[248:251], v[44:47], v[52:55]
v_mfma_f32_16x16x32_bf16 v[56:59], a[252:255], v[44:47], v[56:59]
v_mfma_f32_16x16x32_bf16 v[60:63], a[248:251], v[48:51], v[60:63]
v_mfma_f32_16x16x32_bf16 v[64:67], a[252:255], v[48:51], v[64:67]
s_barrier
s_mov_b32 s50, 0x10000
s_add_u32 m0, s46, 65536
s_nop 0
buffer_load_dwordx4 v6, s[8:11], s50 offen offset:0 lds
s_add_u32 m0, s46, 69504
s_nop 0
buffer_load_dwordx4 v6, s[8:11], s50 offen offset:128 lds
s_add_u32 m0, s46, 73472
s_nop 0
buffer_load_dwordx4 v6, s[8:11], s50 offen offset:256 lds
s_add_u32 m0, s46, 77440
s_nop 0
buffer_load_dwordx4 v6, s[8:11], s50 offen offset:384 lds
s_add_u32 m0, s46, 81408
s_nop 0
buffer_load_dwordx4 v6, s[8:11], s50 offen offset:512 lds
s_add_u32 m0, s46, 85376
s_nop 0
buffer_load_dwordx4 v6, s[8:11], s50 offen offset:640 lds
s_add_u32 m0, s46, 89344
s_nop 0
buffer_load_dwordx4 v6, s[8:11], s50 offen offset:768 lds
s_add_u32 m0, s46, 93312
s_nop 0
buffer_load_dwordx4 v6, s[8:11], s50 offen offset:896 lds
s_add_u32 m0, s46, 97280
s_nop 0
buffer_load_dwordx4 v6, s[8:11], s50 offen offset:1024 lds
s_add_u32 m0, s46, 101248
s_nop 0
buffer_load_dwordx4 v6, s[8:11], s50 offen offset:1152 lds
s_add_u32 m0, s46, 105216
s_nop 0
buffer_load_dwordx4 v6, s[8:11], s50 offen offset:1280 lds
s_add_u32 m0, s46, 109184
s_nop 0
buffer_load_dwordx4 v6, s[8:11], s50 offen offset:1408 lds
s_add_u32 m0, s46, 113152
s_nop 0
buffer_load_dwordx4 v6, s[8:11], s50 offen offset:1536 lds
s_add_u32 m0, s46, 117120
s_nop 0
buffer_load_dwordx4 v6, s[8:11], s50 offen offset:1664 lds
s_add_u32 m0, s46, 121088
s_nop 0
buffer_load_dwordx4 v6, s[8:11], s50 offen offset:1792 lds
s_add_u32 m0, s46, 125056
s_nop 0
buffer_load_dwordx4 v6, s[8:11], s50 offen offset:1920 lds
v_lshrrev_b32 v92, 4, v1
v_and_b32 v93, 15, v1
s_and_b32 s52, s41, 1
s_lshr_b32 s53, s41, 1
s_mov_b32 s54, 0x3e0293ee
s_mov_b32 s55, 0
s_mov_b32 s56, 0
v_mov_b32 v97, 0xff7fffff
v_and_b32 v2, 7, v93
v_lshlrev_b32 v94, 7, v92
v_lshl_add_u32 v94, v2, 4, v94
v_and_b32 v2, 31, v1
v_lshlrev_b32 v95, 3, v2
v_lshrrev_b32 v2, 1, v92
v_lshlrev_b32 v96, 10, v2
v_and_b32 v2, 1, v92
v_lshl_add_u32 v96, v2, 9, v96
v_lshl_add_u32 v96, v93, 4, v96
s_lshl_b32 s43, s40, 13
s_lshl_b32 s44, s53, 12
s_add_u32 s43, s43, s44
s_lshl_b32 s44, s52, 8
s_add_u32 s43, s43, s44
s_add_u32 s43, s43, 134217728
v_add_u32 v96, s43, v96
s_lshl_b32 s43, s52, 4
v_add_u32 v98, s43, v93
v_lshlrev_b32 v2, 2, v92
v_sub_u32 v98, v98, v2
s_mov_b32 s28, 0
s_mov_b32 s29, -1
s_xor_b32 s44, s98, 1
s_lshl_b32 s44, s44, 13
s_lshl_b32 s43, s40, 7
s_add_u32 s43, s43, s44
s_add_u32 s43, s43, 69206016
v_and_b32 v2, 3, v1
v_bfe_u32 v3, v1, 2, 1
v_lshlrev_b32 v99, 12, v3
v_lshl_add_u32 v99, v2, 2, v99
v_add_u32 v99, s43, v99
s_xor_b32 s62, s98, 1
s_lshl_b32 s62, s62, 13
s_lshr_b32 s44, s47, 6
s_lshl_b32 s44, s44, 14
s_add_u32 s62, s62, s44
s_and_b32 s44, s47, 63
s_lshl_b32 s44, s44, 7
s_add_u32 s62, s62, s44
s_add_u32 s62, s62, 69222400
s_lshl_b32 s49, s47, 2
s_add_u32 s49, s49, 69255168
s_lshl_b32 s43, s41, 11
s_add_u32 s43, s43, 131072
v_add_u32 v101, s43, v7
s_lshl_b32 s43, s52, 10
s_add_u32 s43, s43, 131072
v_add_u32 v102, s43, v5
v_mov_b32 v16, 0
s_mov_b32 s50, 0
v_mov_b32 v104, 0x3f803f80
v_mov_b32 v105, 0x3f803f80
v_mov_b32 v106, 0x3f803f80
v_mov_b32 v107, 0x3f803f80
v_cmp_gt_i32 s[12:13], 0, v98
v_cmp_gt_i32 s[14:15], 1, v98
v_cmp_gt_i32 s[16:17], 2, v98
v_cmp_gt_i32 s[18:19], 3, v98
v_cmp_gt_i32 s[20:21], 16, v98
v_cmp_gt_i32 s[22:23], 17, v98
v_cmp_gt_i32 s[24:25], 18, v98
v_cmp_gt_i32 s[26:27], 19, v98
s_lshr_b32 s44, s47, 3
s_xor_b32 s44, s44, s98
s_and_b32 s44, s44, 1
s_lshl_b32 s44, s44, 13
s_lshl_b32 s58, s47, 18
s_add_u32 s58, s58, s44
s_add_u32 s58, s58, 0
s_lshr_b32 s44, s47, 4
s_xor_b32 s44, s44, s98
s_and_b32 s44, s44, 1
s_lshl_b32 s44, s44, 13
s_lshl_b32 s59, s47, 17
s_add_u32 s59, s59, s44
s_add_u32 s59, s59, 71303168
s_lshl_b32 s60, s41, 11
s_add_u32 s60, s60, 139264
s_lshl_b32 s61, s41, 10
s_add_u32 s61, s61, 155648
v_add_u32 v94, 155648, v94
s_lshl_b32 s43, s53, 11
s_add_u32 s43, s43, 156160
v_add_u32 v95, s43, v95
v_add_u32 v103, 139264, v5
s_lshl_b32 s43, s53, 12
s_add_u32 s43, s43, 147456
v_add_u32 v240, s43, v5
s_waitcnt vmcnt(0)
v_mov_b32 v68, v52
v_mov_b32 v69, v53
v_mov_b32 v70, v54
v_mov_b32 v71, v55
v_mov_b32 v72, v56
v_mov_b32 v73, v57
v_mov_b32 v74, v58
v_mov_b32 v75, v59
v_mov_b32 v76, v60
v_mov_b32 v77, v61
v_mov_b32 v78, v62
v_mov_b32 v79, v63
v_mov_b32 v80, v64
v_mov_b32 v81, v65
v_mov_b32 v82, v66
v_mov_b32 v83, v67
mega_kernel_q_loop:
s_barrier
s_cmp_gt_i32 s55, s42
s_cbranch_scc1 mega_kernel_q_kv1k
mega_kernel_q_kv1w:
buffer_load_dword v2, v99, s[84:87], 0 offen sc1
s_waitcnt vmcnt(0)
v_min_i32_dpp v2, v2, v2 quad_perm:[1,0,3,2] row_mask:0xf bank_mask:0xf
s_nop 1
v_min_i32_dpp v2, v2, v2 quad_perm:[2,3,0,1] row_mask:0xf bank_mask:0xf
s_nop 1
v_min_i32_dpp v2, v2, v2 row_ror:4 row_mask:0xf bank_mask:0xf
s_nop 0
v_readfirstlane_b32 s55, v2
s_cmp_gt_i32 s55, s42
s_cbranch_scc1 mega_kernel_q_kv1k
s_sleep 4
s_branch mega_kernel_q_kv1w
mega_kernel_q_kv1k:
ds_read_b128 v[20:23], v10 offset:0
ds_read_b128 v[24:27], v10 offset:2048
ds_read_b128 v[28:31], v11 offset:0
ds_read_b128 v[32:35], v11 offset:2048
ds_read_b128 v[36:39], v10 offset:4096
ds_read_b128 v[40:43], v10 offset:6144
s_add_u32 s51, s47, s42
s_bfe_u32 s57, s51, 0x40002
s_lshl_b32 s57, s57, 14
s_and_b32 s66, s51, 3
s_lshl_b32 s66, s66, 11
s_add_u32 s66, s66, s57
s_add_u32 s66, s66, s58
s_add_u32 s67, s66, 33554432
s_bfe_u32 s57, s51, 0x30003
s_lshl_b32 s57, s57, 14
s_and_b32 s68, s51, 7
s_lshl_b32 s68, s68, 10
s_add_u32 s68, s68, s57
s_add_u32 s68, s68, s59
s_add_u32 s50, s42, 2
s_min_u32 s50, s50, 63
s_lshl_b32 s50, s50, 16
s_cmp_gt_i32 s56, s42
s_cselect_b32 s30, 1, 0
s_add_u32 m0, s60, 0
s_waitcnt lgkmcnt(4)
v_mfma_f32_16x16x32_bf16 v[52:55], a[0:3], v[20:23], 0
ds_read_b128 v[44:47], v11 offset:4096
v_mfma_f32_16x16x32_bf16 v[56:59], a[4:7], v[20:23], 0
buffer_load_dwordx4 v5, s[84:87], s66 offen offset:0 sc1 lds
v_mfma_f32_16x16x32_bf16 v[60:63], a[0:3], v[24:27], 0
ds_read_b128 v[48:51], v11 offset:6144
v_mfma_f32_16x16x32_bf16 v[64:67], a[4:7], v[24:27], 0
s_add_u32 m0, s60, 0
s_waitcnt lgkmcnt(4)
v_mfma_f32_16x16x32_bf16 v[52:55], a[8:11], v[28:31], v[52:55]
ds_read_b128 v[20:23], v10 offset:8192
v_mfma_f32_16x16x32_bf16 v[56:59], a[12:15], v[28:31], v[56:59]
buffer_load_dwordx4 v5, s[84:87], s66 offen offset:1024 sc1 lds
v_mfma_f32_16x16x32_bf16 v[60:63], a[8:11], v[32:35], v[60:63]
ds_read_b128 v[24:27], v10 offset:10240
v_mfma_f32_16x16x32_bf16 v[64:67], a[12:15], v[32:35], v[64:67]
s_add_u32 m0, s60, 8192
s_waitcnt lgkmcnt(4)
v_mfma_f32_16x16x32_bf16 v[52:55], a[16:19], v[36:39], v[52:55]
ds_read_b128 v[28:31], v11 offset:8192
v_mfma_f32_16x16x32_bf16 v[56:59], a[20:23], v[36:39], v[56:59]
buffer_load_dwordx4 v5, s[84:87], s67 offen offset:0 sc1 lds
v_mfma_f32_16x16x32_bf16 v[60:63], a[16:19], v[40:43], v[60:63]
ds_read_b128 v[32:35], v11 offset:10240
v_mfma_f32_16x16x32_bf16 v[64:67], a[20:23], v[40:43], v[64:67]
s_add_u32 m0, s60, 8192
s_waitcnt lgkmcnt(4)
v_mfma_f32_16x16x32_bf16 v[52:55], a[24:27], v[44:47], v[52:55]
ds_read_b128 v[36:39], v10 offset:12288
v_mfma_f32_16x16x32_bf16 v[56:59], a[28:31], v[44:47], v[56:59]
buffer_load_dwordx4 v5, s[84:87], s67 offen offset:1024 sc1 lds
v_mfma_f32_16x16x32_bf16 v[60:63], a[24:27], v[48:51], v[60:63]
ds_read_b128 v[40:43], v10 offset:14336
v_mfma_f32_16x16x32_bf16 v[64:67], a[28:31], v[48:51], v[64:67]
s_waitcnt lgkmcnt(4)
v_mfma_f32_16x16x32_bf16 v[52:55], a[32:35], v[20:23], v[52:55]
ds_read_b128 v[44:47], v11 offset:12288
v_mfma_f32_16x16x32_bf16 v[56:59], a[36:39], v[20:23], v[56:59]
s_cmp_eq_u32 s30, 1
s_cbranch_scc0 mega_kernel_q_ke1
s_mov_b32 m0, s61
s_nop 0
buffer_load_dwordx4 v5, s[84:87], s68 offen sc1 lds
mega_kernel_q_ke1:
v_mfma_f32_16x16x32_bf16 v[60:63], a[32:35], v[24:27], v[60:63]
ds_read_b128 v[48:51], v11 offset:14336
v_mfma_f32_16x16x32_bf16 v[64:67], a[36:39], v[24:27], v[64:67]
s_add_u32 m0, s46, 0
s_waitcnt lgkmcnt(4)
v_mfma_f32_16x16x32_bf16 v[52:55], a[40:43], v[28:31], v[52:55]
ds_read_b128 v[20:23], v10 offset:16384
v_mfma_f32_16x16x32_bf16 v[56:59], a[44:47], v[28:31], v[56:59]
buffer_load_dwordx4 v6, s[8:11], s50 offen offset:0 lds
v_mfma_f32_16x16x32_bf16 v[60:63], a[40:43], v[32:35], v[60:63]
ds_read_b128 v[24:27], v10 offset:18432
v_mfma_f32_16x16x32_bf16 v[64:67], a[44:47], v[32:35], v[64:67]
s_add_u32 m0, s46, 3968
s_waitcnt lgkmcnt(4)
v_mfma_f32_16x16x32_bf16 v[52:55], a[48:51], v[36:39], v[52:55]
ds_read_b128 v[28:31], v11 offset:16384
v_mfma_f32_16x16x32_bf16 v[56:59], a[52:55], v[36:39], v[56:59]
buffer_load_dwordx4 v6, s[8:11], s50 offen offset:128 lds
v_mfma_f32_16x16x32_bf16 v[60:63], a[48:51], v[40:43], v[60:63]
ds_read_b128 v[32:35], v11 offset:18432
v_mfma_f32_16x16x32_bf16 v[64:67], a[52:55], v[40:43], v[64:67]
s_add_u32 m0, s46, 7936
s_waitcnt lgkmcnt(4)
v_mfma_f32_16x16x32_bf16 v[52:55], a[56:59], v[44:47], v[52:55]
ds_read_b128 v[36:39], v10 offset:20480
v_mfma_f32_16x16x32_bf16 v[56:59], a[60:63], v[44:47], v[56:59]
buffer_load_dwordx4 v6, s[8:11], s50 offen offset:256 lds
v_mfma_f32_16x16x32_bf16 v[60:63], a[56:59], v[48:51], v[60:63]
ds_read_b128 v[40:43], v10 offset:22528
v_mfma_f32_16x16x32_bf16 v[64:67], a[60:63], v[48:51], v[64:67]
s_add_u32 m0, s46, 11904
s_waitcnt lgkmcnt(4)
v_mfma_f32_16x16x32_bf16 v[52:55], a[64:67], v[20:23], v[52:55]
ds_read_b128 v[44:47], v11 offset:20480
v_mfma_f32_16x16x32_bf16 v[56:59], a[68:71], v[20:23], v[56:59]
buffer_load_dwordx4 v6, s[8:11], s50 offen offset:384 lds
v_mfma_f32_16x16x32_bf16 v[60:63], a[64:67], v[24:27], v[60:63]
ds_read_b128 v[48:51], v11 offset:22528
v_mfma_f32_16x16x32_bf16 v[64:67], a[68:71], v[24:27], v[64:67]
s_add_u32 m0, s46, 15872
s_waitcnt lgkmcnt(4)
v_mfma_f32_16x16x32_bf16 v[52:55], a[72:75], v[28:31], v[52:55]
ds_read_b128 v[20:23], v10 offset:24576
v_mfma_f32_16x16x32_bf16 v[56:59], a[76:79], v[28:31], v[56:59]
buffer_load_dwordx4 v6, s[8:11], s50 offen offset:512 lds
v_mfma_f32_16x16x32_bf16 v[60:63], a[72:75], v[32:35], v[60:63]
ds_read_b128 v[24:27], v10 offset:26624
v_mfma_f32_16x16x32_bf16 v[64:67], a[76:79], v[32:35], v[64:67]
s_add_u32 m0, s46, 19840
s_waitcnt lgkmcnt(4)
v_mfma_f32_16x16x32_bf16 v[52:55], a[80:83], v[36:39], v[52:55]
ds_read_b128 v[28:31], v11 offset:24576
v_mfma_f32_16x16x32_bf16 v[56:59], a[84:87], v[36:39], v[56:59]
buffer_load_dwordx4 v6, s[8:11], s50 offen offset:640 lds
v_mfma_f32_16x16x32_bf16 v[60:63], a[80:83], v[40:43], v[60:63]
ds_read_b128 v[32:35], v11 offset:26624
v_mfma_f32_16x16x32_bf16 v[64:67], a[84:87], v[40:43], v[64:67]
s_add_u32 m0, s46, 23808
s_waitcnt lgkmcnt(4)
v_mfma_f32_16x16x32_bf16 v[52:55], a[88:91], v[44:47], v[52:55]
ds_read_b128 v[36:39], v10 offset:28672
v_mfma_f32_16x16x32_bf16 v[56:59], a[92:95], v[44:47], v[56:59]
buffer_load_dwordx4 v6, s[8:11], s50 offen offset:768 lds
v_mfma_f32_16x16x32_bf16 v[60:63], a[88:91], v[48:51], v[60:63]
ds_read_b128 v[40:43], v10 offset:30720
v_mfma_f32_16x16x32_bf16 v[64:67], a[92:95], v[48:51], v[64:67]
s_add_u32 m0, s46, 27776
s_waitcnt lgkmcnt(4)
v_mfma_f32_16x16x32_bf16 v[52:55], a[96:99], v[20:23], v[52:55]
ds_read_b128 v[44:47], v11 offset:28672
v_mfma_f32_16x16x32_bf16 v[56:59], a[100:103], v[20:23], v[56:59]
buffer_load_dwordx4 v6, s[8:11], s50 offen offset:896 lds
v_mfma_f32_16x16x32_bf16 v[60:63], a[96:99], v[24:27], v[60:63]
ds_read_b128 v[48:51], v11 offset:30720
v_mfma_f32_16x16x32_bf16 v[64:67], a[100:103], v[24:27], v[64:67]
s_add_u32 m0, s46, 31744
s_waitcnt lgkmcnt(4)
v_mfma_f32_16x16x32_bf16 v[52:55], a[104:107], v[28:31], v[52:55]
ds_read_b128 v[20:23], v10 offset:32768
v_mfma_f32_16x16x32_bf16 v[56:59], a[108:111], v[28:31], v[56:59]
buffer_load_dwordx4 v6, s[8:11], s50 offen offset:1024 lds
v_mfma_f32_16x16x32_bf16 v[60:63], a[104:107], v[32:35], v[60:63]
ds_read_b128 v[24:27], v10 offset:34816
v_mfma_f32_16x16x32_bf16 v[64:67], a[108:111], v[32:35], v[64:67]
s_waitcnt vmcnt(13)
v_mov_b32 v17, s42
s_mov_b64 exec, 1
buffer_store_dword v17, v16, s[84:87], s49 offen sc1
s_mov_b64 exec, -1
s_add_u32 m0, s46, 35712
s_waitcnt lgkmcnt(4)
v_mfma_f32_16x16x32_bf16 v[52:55], a[112:115], v[36:39], v[52:55]
ds_read_b128 v[28:31], v11 offset:32768
v_mfma_f32_16x16x32_bf16 v[56:59], a[116:119], v[36:39], v[56:59]
buffer_load_dwordx4 v6, s[8:11], s50 offen offset:1152 lds
v_mfma_f32_16x16x32_bf16 v[60:63], a[112:115], v[40:43], v[60:63]
ds_read_b128 v[32:35], v11 offset:34816
v_mfma_f32_16x16x32_bf16 v[64:67], a[116:119], v[40:43], v[64:67]
v_mov_b32 v100, 0
s_mov_b64 exec, 1
buffer_atomic_add v100, v16, s[84:87], s62 offen sc0 sc1
s_mov_b64 exec, -1
s_add_u32 m0, s46, 39680
s_waitcnt lgkmcnt(4)
v_mfma_f32_16x16x32_bf16 v[52:55], a[120:123], v[44:47], v[52:55]
ds_read_b128 v[36:39], v10 offset:36864
v_mfma_f32_16x16x32_bf16 v[56:59], a[124:127], v[44:47], v[56:59]
buffer_load_dwordx4 v6, s[8:11], s50 offen offset:1280 lds
v_mfma_f32_16x16x32_bf16 v[60:63], a[120:123], v[48:51], v[60:63]
ds_read_b128 v[40:43], v10 offset:38912
v_mfma_f32_16x16x32_bf16 v[64:67], a[124:127], v[48:51], v[64:67]
s_add_u32 m0, s46, 43648
s_waitcnt lgkmcnt(4)
v_mfma_f32_16x16x32_bf16 v[52:55], a[128:131], v[20:23], v[52:55]
ds_read_b128 v[44:47], v11 offset:36864
v_mfma_f32_16x16x32_bf16 v[56:59], a[132:135], v[20:23], v[56:59]
buffer_load_dwordx4 v6, s[8:11], s50 offen offset:1408 lds
v_mfma_f32_16x16x32_bf16 v[60:63], a[128:131], v[24:27], v[60:63]
ds_read_b128 v[48:51], v11 offset:38912
v_mfma_f32_16x16x32_bf16 v[64:67], a[132:135], v[24:27], v[64:67]
s_add_u32 m0, s46, 47616
s_waitcnt lgkmcnt(4)
v_mfma_f32_16x16x32_bf16 v[52:55], a[136:139], v[28:31], v[52:55]
ds_read_b128 v[20:23], v10 offset:40960
v_mfma_f32_16x16x32_bf16 v[56:59], a[140:143], v[28:31], v[56:59]
buffer_load_dwordx4 v6, s[8:11], s50 offen offset:1536 lds
v_mfma_f32_16x16x32_bf16 v[60:63], a[136:139], v[32:35], v[60:63]
ds_read_b128 v[24:27], v10 offset:43008
v_mfma_f32_16x16x32_bf16 v[64:67], a[140:143], v[32:35], v[64:67]
s_add_u32 m0, s46, 51584
s_waitcnt lgkmcnt(4)
v_mfma_f32_16x16x32_bf16 v[52:55], a[144:147], v[36:39], v[52:55]
ds_read_b128 v[28:31], v11 offset:40960
v_mfma_f32_16x16x32_bf16 v[56:59], a[148:151], v[36:39], v[56:59]
buffer_load_dwordx4 v6, s[8:11], s50 offen offset:1664 lds
v_mfma_f32_16x16x32_bf16 v[60:63], a[144:147], v[40:43], v[60:63]
ds_read_b128 v[32:35], v11 offset:43008
v_mfma_f32_16x16x32_bf16 v[64:67], a[148:151], v[40:43], v[64:67]
s_add_u32 m0, s46, 55552
s_waitcnt lgkmcnt(4)
v_mfma_f32_16x16x32_bf16 v[52:55], a[152:155], v[44:47], v[52:55]
ds_read_b128 v[36:39], v10 offset:45056
v_mfma_f32_16x16x32_bf16 v[56:59], a[156:159], v[44:47], v[56:59]
buffer_load_dwordx4 v6, s[8:11], s50 offen offset:1792 lds
v_mfma_f32_16x16x32_bf16 v[60:63], a[152:155], v[48:51], v[60:63]
ds_read_b128 v[40:43], v10 offset:47104
v_mfma_f32_16x16x32_bf16 v[64:67], a[156:159], v[48:51], v[64:67]
s_add_u32 m0, s46, 59520
s_waitcnt lgkmcnt(4)
v_mfma_f32_16x16x32_bf16 v[52:55], a[160:163], v[20:23], v[52:55]
ds_read_b128 v[44:47], v11 offset:45056
v_mfma_f32_16x16x32_bf16 v[56:59], a[164:167], v[20:23], v[56:59]
buffer_load_dwordx4 v6, s[8:11], s50 offen offset:1920 lds
v_mfma_f32_16x16x32_bf16 v[60:63], a[160:163], v[24:27], v[60:63]
ds_read_b128 v[48:51], v11 offset:47104
v_mfma_f32_16x16x32_bf16 v[64:67], a[164:167], v[24:27], v[64:67]
s_waitcnt lgkmcnt(4)
v_mfma_f32_16x16x32_bf16 v[52:55], a[168:171], v[28:31], v[52:55]
ds_read_b128 v[20:23], v10 offset:49152
v_mfma_f32_16x16x32_bf16 v[56:59], a[172:175], v[28:31], v[56:59]
v_mfma_f32_16x16x32_bf16 v[60:63], a[168:171], v[32:35], v[60:63]
ds_read_b128 v[24:27], v10 offset:51200
v_mfma_f32_16x16x32_bf16 v[64:67], a[172:175], v[32:35], v[64:67]
v_cvt_pk_bf16_f32 v84, v68, v69
v_cvt_pk_bf16_f32 v85, v70, v71
s_waitcnt lgkmcnt(4)
v_mfma_f32_16x16x32_bf16 v[52:55], a[176:179], v[36:39], v[52:55]
ds_read_b128 v[28:31], v11 offset:49152
v_mfma_f32_16x16x32_bf16 v[56:59], a[180:183], v[36:39], v[56:59]
v_mfma_f32_16x16x32_bf16 v[60:63], a[176:179], v[40:43], v[60:63]
ds_read_b128 v[32:35], v11 offset:51200
v_mfma_f32_16x16x32_bf16 v[64:67], a[180:183], v[40:43], v[64:67]
v_cvt_pk_bf16_f32 v86, v72, v73
v_cvt_pk_bf16_f32 v87, v74, v75
s_waitcnt lgkmcnt(4)
v_mfma_f32_16x16x32_bf16 v[52:55], a[184:187], v[44:47], v[52:55]
ds_read_b128 v[36:39], v10 offset:53248
v_mfma_f32_16x16x32_bf16 v[56:59], a[188:191], v[44:47], v[56:59]
v_mfma_f32_16x16x32_bf16 v[60:63], a[184:187], v[48:51], v[60:63]
ds_read_b128 v[40:43], v10 offset:55296
v_mfma_f32_16x16x32_bf16 v[64:67], a[188:191], v[48:51], v[64:67]
v_cvt_pk_bf16_f32 v88, v76, v77
v_cvt_pk_bf16_f32 v89, v78, v79
s_waitcnt lgkmcnt(4)
v_mfma_f32_16x16x32_bf16 v[52:55], a[192:195], v[20:23], v[52:55]
ds_read_b128 v[44:47], v11 offset:53248
v_mfma_f32_16x16x32_bf16 v[56:59], a[196:199], v[20:23], v[56:59]
v_mfma_f32_16x16x32_bf16 v[60:63], a[192:195], v[24:27], v[60:63]
ds_read_b128 v[48:51], v11 offset:55296
v_mfma_f32_16x16x32_bf16 v[64:67], a[196:199], v[24:27], v[64:67]
v_cvt_pk_bf16_f32 v90, v80, v81
v_cvt_pk_bf16_f32 v91, v82, v83
s_waitcnt lgkmcnt(4)
v_mfma_f32_16x16x32_bf16 v[52:55], a[200:203], v[28:31], v[52:55]
ds_read_b128 v[20:23], v10 offset:57344
v_mfma_f32_16x16x32_bf16 v[56:59], a[204:207], v[28:31], v[56:59]
v_mfma_f32_16x16x32_bf16 v[60:63], a[200:203], v[32:35], v[60:63]
ds_read_b128 v[24:27], v10 offset:59392
v_mfma_f32_16x16x32_bf16 v[64:67], a[204:207], v[32:35], v[64:67]
s_waitcnt lgkmcnt(4)
v_mfma_f32_16x16x32_bf16 v[52:55], a[208:211], v[36:39], v[52:55]
ds_read_b128 v[28:31], v11 offset:57344
v_mfma_f32_16x16x32_bf16 v[56:59], a[212:215], v[36:39], v[56:59]
v_mfma_f32_16x16x32_bf16 v[60:63], a[208:211], v[40:43], v[60:63]
ds_read_b128 v[32:35], v11 offset:59392
v_mfma_f32_16x16x32_bf16 v[64:67], a[212:215], v[40:43], v[64:67]
s_waitcnt lgkmcnt(4)
v_mfma_f32_16x16x32_bf16 v[52:55], a[216:219], v[44:47], v[52:55]
ds_read_b128 v[36:39], v10 offset:61440
v_mfma_f32_16x16x32_bf16 v[56:59], a[220:223], v[44:47], v[56:59]
s_waitcnt vmcnt(6)
v_readfirstlane_b32 s56, v100
s_cmp_eq_u32 s30, 1
s_cbranch_scc1 mega_kernel_q_kf1
s_cmp_gt_i32 s56, s42
s_cbranch_scc0 mega_kernel_q_kf1
s_mov_b32 s30, 1
s_mov_b32 m0, s61
s_nop 0
buffer_load_dwordx4 v5, s[84:87], s68 offen sc1 lds
mega_kernel_q_kf1:
v_mfma_f32_16x16x32_bf16 v[60:63], a[216:219], v[48:51], v[60:63]
ds_read_b128 v[40:43], v10 offset:63488
v_mfma_f32_16x16x32_bf16 v[64:67], a[220:223], v[48:51], v[64:67]
s_waitcnt lgkmcnt(4)
v_mfma_f32_16x16x32_bf16 v[52:55], a[224:227], v[20:23], v[52:55]
ds_read_b128 v[44:47], v11 offset:61440
v_mfma_f32_16x16x32_bf16 v[56:59], a[228:231], v[20:23], v[56:59]
v_mfma_f32_16x16x32_bf16 v[60:63], a[224:227], v[24:27], v[60:63]
ds_read_b128 v[48:51], v11 offset:63488
v_mfma_f32_16x16x32_bf16 v[64:67], a[228:231], v[24:27], v[64:67]
s_waitcnt lgkmcnt(5)
v_mfma_f32_16x16x32_bf16 v[52:55], a[232:235], v[28:31], v[52:55]
v_mfma_f32_16x16x32_bf16 v[56:59], a[236:239], v[28:31], v[56:59]
s_waitcnt lgkmcnt(4)
v_mfma_f32_16x16x32_bf16 v[60:63], a[232:235], v[32:35], v[60:63]
v_mfma_f32_16x16x32_bf16 v[64:67], a[236:239], v[32:35], v[64:67]
s_waitcnt lgkmcnt(3)
v_mfma_f32_16x16x32_bf16 v[52:55], a[240:243], v[36:39], v[52:55]
v_mfma_f32_16x16x32_bf16 v[56:59], a[244:247], v[36:39], v[56:59]
s_waitcnt lgkmcnt(2)
v_mfma_f32_16x16x32_bf16 v[60:63], a[240:243], v[40:43], v[60:63]
v_mfma_f32_16x16x32_bf16 v[64:67], a[244:247], v[40:43], v[64:67]
ds_write_b128 v101, v[84:87]
ds_write_b128 v101, v[88:91] offset:1024
s_waitcnt lgkmcnt(1)
v_mfma_f32_16x16x32_bf16 v[68:71], a[248:251], v[44:47], v[52:55]
v_mfma_f32_16x16x32_bf16 v[72:75], a[252:255], v[44:47], v[56:59]
s_waitcnt lgkmcnt(0)
v_mfma_f32_16x16x32_bf16 v[76:79], a[248:251], v[48:51], v[60:63]
v_mfma_f32_16x16x32_bf16 v[80:83], a[252:255], v[48:51], v[64:67]
s_cmp_eq_u32 s30, 1
s_cbranch_scc1 mega_kernel_q_kl1
mega_kernel_q_kw1:
v_mov_b32 v100, 0
s_mov_b64 exec, 1
buffer_atomic_add v100, v16, s[84:87], s62 offen sc0 sc1
s_mov_b64 exec, -1
s_waitcnt vmcnt(0)
v_readfirstlane_b32 s56, v100
s_cmp_gt_i32 s56, s42
s_cbranch_scc0 mega_kernel_q_kw1
s_mov_b32 m0, s61
s_nop 0
buffer_load_dwordx4 v5, s[84:87], s68 offen sc1 lds
mega_kernel_q_kl1:
s_waitcnt lgkmcnt(0) vmcnt(0)
s_barrier
ds_read_b128 v[184:187], v102 offset:0
ds_read_b128 v[112:115], v103 offset:0
ds_read_b128 v[128:131], v103 offset:1024
ds_read_b128 v[188:191], v102 offset:2048
ds_read_b128 v[116:119], v103 offset:2048
ds_read_b128 v[132:135], v103 offset:3072
ds_read_b128 v[192:195], v102 offset:4096
ds_read_b128 v[120:123], v103 offset:4096
ds_read_b128 v[136:139], v103 offset:5120
ds_read_b128 v[196:199], v102 offset:6144
ds_read_b128 v[124:127], v103 offset:6144
ds_read_b128 v[140:143], v103 offset:7168
s_waitcnt lgkmcnt(9)
v_mfma_f32_16x16x32_bf16 v[200:203], v[112:115], v[184:187], 0
v_mfma_f32_16x16x32_bf16 v[204:207], v[128:131], v[184:187], 0
ds_read_b128 v[160:163], v94 offset:0
s_waitcnt lgkmcnt(7)
v_mfma_f32_16x16x32_bf16 v[200:203], v[116:119], v[188:191], v[200:203]
v_mfma_f32_16x16x32_bf16 v[204:207], v[132:135], v[188:191], v[204:207]
ds_read_b128 v[164:167], v94 offset:1024
s_waitcnt lgkmcnt(5)
v_mfma_f32_16x16x32_bf16 v[200:203], v[120:123], v[192:195], v[200:203]
v_mfma_f32_16x16x32_bf16 v[204:207], v[136:139], v[192:195], v[204:207]
ds_read_b128 v[168:171], v94 offset:2048
s_waitcnt lgkmcnt(3)
v_mfma_f32_16x16x32_bf16 v[200:203], v[124:127], v[196:199], v[200:203]
v_mfma_f32_16x16x32_bf16 v[204:207], v[140:143], v[196:199], v[204:207]
ds_read_b128 v[172:175], v94 offset:3072
s_waitcnt lgkmcnt(3)
v_mfma_f32_16x16x32_bf16 v[208:211], v[160:163], v[184:187], 0
ds_read_b128 v[144:147], v240 offset:0
ds_read_b64 v[176:177], v95 offset:0
s_waitcnt lgkmcnt(4)
v_mfma_f32_16x16x32_bf16 v[208:211], v[164:167], v[188:191], v[208:211]
ds_read_b128 v[148:151], v240 offset:1024
ds_read_b64 v[178:179], v95 offset:256
s_waitcnt lgkmcnt(5)
v_mfma_f32_16x16x32_bf16 v[208:211], v[168:171], v[192:195], v[208:211]
ds_read_b128 v[152:155], v240 offset:2048
ds_read_b64 v[180:181], v95 offset:1024
s_waitcnt lgkmcnt(6)
v_mfma_f32_16x16x32_bf16 v[208:211], v[172:175], v[196:199], v[208:211]
ds_read_b128 v[156:159], v240 offset:3072
ds_read_b64 v[182:183], v95 offset:1280
s_nop 3
v_cndmask_b32 v200, v200, v97, s[12:13]
v_cndmask_b32 v201, v201, v97, s[14:15]
v_cndmask_b32 v202, v202, v97, s[16:17]
v_cndmask_b32 v203, v203, v97, s[18:19]
v_cndmask_b32 v204, v204, v97, s[20:21]
v_cndmask_b32 v205, v205, v97, s[22:23]
v_cndmask_b32 v206, v206, v97, s[24:25]
v_cndmask_b32 v207, v207, v97, s[26:27]
v_cndmask_b32 v208, v208, v97, s[28:29]
v_cndmask_b32 v209, v209, v97, s[28:29]
v_cndmask_b32 v210, v210, v97, s[28:29]
v_cndmask_b32 v211, v211, v97, s[28:29]
v_max3_f32 v236, v200, v201, v202
v_max3_f32 v236, v236, v203, v204
v_max3_f32 v236, v236, v205, v206
v_max3_f32 v236, v236, v207, v208
v_max3_f32 v236, v236, v209, v210
v_max_f32 v237, v236, v211
v_max_f32 v236, v236, v211
s_nop 1
v_permlane16_swap_b32 v236, v237
s_nop 0
v_max_f32 v238, v236, v237
v_max_f32 v239, v236, v237
s_nop 1
v_permlane32_swap_b32 v238, v239
s_nop 0
v_max_f32 v236, v238, v239
v_mul_f32 v236, s54, v236
v_pk_fma_f32 v[200:201], v[200:201], s[54:55], v[236:237] op_sel_hi:[1,0,0] neg_lo:[0,0,1] neg_hi:[0,0,1]
v_pk_fma_f32 v[202:203], v[202:203], s[54:55], v[236:237] op_sel_hi:[1,0,0] neg_lo:[0,0,1] neg_hi:[0,0,1]
v_pk_fma_f32 v[204:205], v[204:205], s[54:55], v[236:237] op_sel_hi:[1,0,0] neg_lo:[0,0,1] neg_hi:[0,0,1]
v_pk_fma_f32 v[206:207], v[206:207], s[54:55], v[236:237] op_sel_hi:[1,0,0] neg_lo:[0,0,1] neg_hi:[0,0,1]
v_pk_fma_f32 v[208:209], v[208:209], s[54:55], v[236:237] op_sel_hi:[1,0,0] neg_lo:[0,0,1] neg_hi:[0,0,1]
v_pk_fma_f32 v[210:211], v[210:211], s[54:55], v[236:237] op_sel_hi:[1,0,0] neg_lo:[0,0,1] neg_hi:[0,0,1]
v_exp_f32 v200, v200
v_exp_f32 v201, v201
v_exp_f32 v202, v202
v_exp_f32 v203, v203
v_exp_f32 v204, v204
v_exp_f32 v205, v205
v_exp_f32 v206, v206
v_exp_f32 v207, v207
v_exp_f32 v208, v208
v_exp_f32 v209, v209
v_exp_f32 v210, v210
v_exp_f32 v211, v211
s_nop 0
v_cvt_pk_bf16_f32 v212, v200, v201
v_cvt_pk_bf16_f32 v213, v202, v203
v_cvt_pk_bf16_f32 v214, v204, v205
v_cvt_pk_bf16_f32 v215, v206, v207
v_cvt_pk_bf16_f32 v216, v208, v209
v_cvt_pk_bf16_f32 v217, v210, v211
s_waitcnt lgkmcnt(0)
s_nop 0
v_mfma_f32_16x16x32_bf16 v[108:111], v[104:107], v[212:215], 0
v_mfma_f32_16x16x32_bf16 v[220:223], v[144:147], v[212:215], 0
v_mfma_f32_16x16x32_bf16 v[224:227], v[148:151], v[212:215], 0
v_mfma_f32_16x16x32_bf16 v[228:231], v[152:155], v[212:215], 0
v_mfma_f32_16x16x32_bf16 v[232:235], v[156:159], v[212:215], 0
v_mfma_f32_16x16x16_bf16 v[108:111], v[104:105], v[216:217], v[108:111]
v_mfma_f32_16x16x16_bf16 v[220:223], v[176:177], v[216:217], v[220:223]
v_mfma_f32_16x16x16_bf16 v[224:227], v[178:179], v[216:217], v[224:227]
v_mfma_f32_16x16x16_bf16 v[228:231], v[180:181], v[216:217], v[228:231]
v_mfma_f32_16x16x16_bf16 v[232:235], v[182:183], v[216:217], v[232:235]
s_lshl_b32 s51, s42, 18
s_nop 2
v_rcp_f32 v238, v108
v_rcp_f32 v239, v109
s_nop 1
v_pk_mul_f32 v[220:221], v[220:221], v[238:239]
v_pk_mul_f32 v[222:223], v[222:223], v[238:239]
v_pk_mul_f32 v[224:225], v[224:225], v[238:239]
v_pk_mul_f32 v[226:227], v[226:227], v[238:239]
v_pk_mul_f32 v[228:229], v[228:229], v[238:239]
v_pk_mul_f32 v[230:231], v[230:231], v[238:239]
v_pk_mul_f32 v[232:233], v[232:233], v[238:239]
v_pk_mul_f32 v[234:235], v[234:235], v[238:239]
v_cvt_pk_bf16_f32 v200, v220, v221
v_cvt_pk_bf16_f32 v201, v222, v223
v_cvt_pk_bf16_f32 v202, v224, v225
v_cvt_pk_bf16_f32 v203, v226, v227
v_cvt_pk_bf16_f32 v204, v228, v229
v_cvt_pk_bf16_f32 v205, v230, v231
v_cvt_pk_bf16_f32 v206, v232, v233
v_cvt_pk_bf16_f32 v207, v234, v235
buffer_store_dwordx4 v[200:203], v96, s[84:87], s51 offen sc1
buffer_store_dwordx4 v[204:207], v96, s[84:87], s51 offen offset:2048 sc1
s_add_u32 s42, s42, 1
s_cmp_eq_u32 s42, 63
s_cbranch_scc1 mega_kernel_q_last
s_barrier
s_cmp_gt_i32 s55, s42
s_cbranch_scc1 mega_kernel_q_kv0k
mega_kernel_q_kv0w:
buffer_load_dword v2, v99, s[84:87], 0 offen sc1
s_waitcnt vmcnt(0)
v_min_i32_dpp v2, v2, v2 quad_perm:[1,0,3,2] row_mask:0xf bank_mask:0xf
s_nop 1
v_min_i32_dpp v2, v2, v2 quad_perm:[2,3,0,1] row_mask:0xf bank_mask:0xf
s_nop 1
v_min_i32_dpp v2, v2, v2 row_ror:4 row_mask:0xf bank_mask:0xf
s_nop 0
v_readfirstlane_b32 s55, v2
s_cmp_gt_i32 s55, s42
s_cbranch_scc1 mega_kernel_q_kv0k
s_sleep 4
s_branch mega_kernel_q_kv0w
mega_kernel_q_kv0k:
ds_read_b128 v[20:23], v8 offset:0
ds_read_b128 v[24:27], v8 offset:2048
ds_read_b128 v[28:31], v9 offset:0
ds_read_b128 v[32:35], v9 offset:2048
ds_read_b128 v[36:39], v8 offset:4096
ds_read_b128 v[40:43], v8 offset:6144
s_add_u32 s51, s47, s42
s_bfe_u32 s57, s51, 0x40002
s_lshl_b32 s57, s57, 14
s_and_b32 s66, s51, 3
s_lshl_b32 s66, s66, 11
s_add_u32 s66, s66, s57
s_add_u32 s66, s66, s58
s_add_u32 s67, s66, 33554432
s_bfe_u32 s57, s51, 0x30003
s_lshl_b32 s57, s57, 14
s_and_b32 s68, s51, 7
s_lshl_b32 s68, s68, 10
s_add_u32 s68, s68, s57
s_add_u32 s68, s68, s59
s_add_u32 s50, s42, 2
s_min_u32 s50, s50, 63
s_lshl_b32 s50, s50, 16
s_cmp_gt_i32 s56, s42
s_cselect_b32 s30, 1, 0
s_add_u32 m0, s60, 0
s_waitcnt lgkmcnt(4)
v_mfma_f32_16x16x32_bf16 v[52:55], a[0:3], v[20:23], 0
ds_read_b128 v[44:47], v9 offset:4096
v_mfma_f32_16x16x32_bf16 v[56:59], a[4:7], v[20:23], 0
buffer_load_dwordx4 v5, s[84:87], s66 offen offset:0 sc1 lds
v_mfma_f32_16x16x32_bf16 v[60:63], a[0:3], v[24:27], 0
ds_read_b128 v[48:51], v9 offset:6144
v_mfma_f32_16x16x32_bf16 v[64:67], a[4:7], v[24:27], 0
s_add_u32 m0, s60, 0
s_waitcnt lgkmcnt(4)
v_mfma_f32_16x16x32_bf16 v[52:55], a[8:11], v[28:31], v[52:55]
ds_read_b128 v[20:23], v8 offset:8192
v_mfma_f32_16x16x32_bf16 v[56:59], a[12:15], v[28:31], v[56:59]
buffer_load_dwordx4 v5, s[84:87], s66 offen offset:1024 sc1 lds
v_mfma_f32_16x16x32_bf16 v[60:63], a[8:11], v[32:35], v[60:63]
ds_read_b128 v[24:27], v8 offset:10240
v_mfma_f32_16x16x32_bf16 v[64:67], a[12:15], v[32:35], v[64:67]
s_add_u32 m0, s60, 8192
s_waitcnt lgkmcnt(4)
v_mfma_f32_16x16x32_bf16 v[52:55], a[16:19], v[36:39], v[52:55]
ds_read_b128 v[28:31], v9 offset:8192
v_mfma_f32_16x16x32_bf16 v[56:59], a[20:23], v[36:39], v[56:59]
buffer_load_dwordx4 v5, s[84:87], s67 offen offset:0 sc1 lds
v_mfma_f32_16x16x32_bf16 v[60:63], a[16:19], v[40:43], v[60:63]
ds_read_b128 v[32:35], v9 offset:10240
v_mfma_f32_16x16x32_bf16 v[64:67], a[20:23], v[40:43], v[64:67]
s_add_u32 m0, s60, 8192
s_waitcnt lgkmcnt(4)
v_mfma_f32_16x16x32_bf16 v[52:55], a[24:27], v[44:47], v[52:55]
ds_read_b128 v[36:39], v8 offset:12288
v_mfma_f32_16x16x32_bf16 v[56:59], a[28:31], v[44:47], v[56:59]
buffer_load_dwordx4 v5, s[84:87], s67 offen offset:1024 sc1 lds
v_mfma_f32_16x16x32_bf16 v[60:63], a[24:27], v[48:51], v[60:63]
ds_read_b128 v[40:43], v8 offset:14336
v_mfma_f32_16x16x32_bf16 v[64:67], a[28:31], v[48:51], v[64:67]
s_waitcnt lgkmcnt(4)
v_mfma_f32_16x16x32_bf16 v[52:55], a[32:35], v[20:23], v[52:55]
ds_read_b128 v[44:47], v9 offset:12288
v_mfma_f32_16x16x32_bf16 v[56:59], a[36:39], v[20:23], v[56:59]
s_cmp_eq_u32 s30, 1
s_cbranch_scc0 mega_kernel_q_ke0
s_mov_b32 m0, s61
s_nop 0
buffer_load_dwordx4 v5, s[84:87], s68 offen sc1 lds
mega_kernel_q_ke0:
v_mfma_f32_16x16x32_bf16 v[60:63], a[32:35], v[24:27], v[60:63]
ds_read_b128 v[48:51], v9 offset:14336
v_mfma_f32_16x16x32_bf16 v[64:67], a[36:39], v[24:27], v[64:67]
s_add_u32 m0, s46, 65536
s_waitcnt lgkmcnt(4)
v_mfma_f32_16x16x32_bf16 v[52:55], a[40:43], v[28:31], v[52:55]
ds_read_b128 v[20:23], v8 offset:16384
v_mfma_f32_16x16x32_bf16 v[56:59], a[44:47], v[28:31], v[56:59]
buffer_load_dwordx4 v6, s[8:11], s50 offen offset:0 lds
v_mfma_f32_16x16x32_bf16 v[60:63], a[40:43], v[32:35], v[60:63]
ds_read_b128 v[24:27], v8 offset:18432
v_mfma_f32_16x16x32_bf16 v[64:67], a[44:47], v[32:35], v[64:67]
s_add_u32 m0, s46, 69504
s_waitcnt lgkmcnt(4)
v_mfma_f32_16x16x32_bf16 v[52:55], a[48:51], v[36:39], v[52:55]
ds_read_b128 v[28:31], v9 offset:16384
v_mfma_f32_16x16x32_bf16 v[56:59], a[52:55], v[36:39], v[56:59]
buffer_load_dwordx4 v6, s[8:11], s50 offen offset:128 lds
v_mfma_f32_16x16x32_bf16 v[60:63], a[48:51], v[40:43], v[60:63]
ds_read_b128 v[32:35], v9 offset:18432
v_mfma_f32_16x16x32_bf16 v[64:67], a[52:55], v[40:43], v[64:67]
s_add_u32 m0, s46, 73472
s_waitcnt lgkmcnt(4)
v_mfma_f32_16x16x32_bf16 v[52:55], a[56:59], v[44:47], v[52:55]
ds_read_b128 v[36:39], v8 offset:20480
v_mfma_f32_16x16x32_bf16 v[56:59], a[60:63], v[44:47], v[56:59]
buffer_load_dwordx4 v6, s[8:11], s50 offen offset:256 lds
v_mfma_f32_16x16x32_bf16 v[60:63], a[56:59], v[48:51], v[60:63]
ds_read_b128 v[40:43], v8 offset:22528
v_mfma_f32_16x16x32_bf16 v[64:67], a[60:63], v[48:51], v[64:67]
s_add_u32 m0, s46, 77440
s_waitcnt lgkmcnt(4)
v_mfma_f32_16x16x32_bf16 v[52:55], a[64:67], v[20:23], v[52:55]
ds_read_b128 v[44:47], v9 offset:20480
v_mfma_f32_16x16x32_bf16 v[56:59], a[68:71], v[20:23], v[56:59]
buffer_load_dwordx4 v6, s[8:11], s50 offen offset:384 lds
v_mfma_f32_16x16x32_bf16 v[60:63], a[64:67], v[24:27], v[60:63]
ds_read_b128 v[48:51], v9 offset:22528
v_mfma_f32_16x16x32_bf16 v[64:67], a[68:71], v[24:27], v[64:67]
s_add_u32 m0, s46, 81408
s_waitcnt lgkmcnt(4)
v_mfma_f32_16x16x32_bf16 v[52:55], a[72:75], v[28:31], v[52:55]
ds_read_b128 v[20:23], v8 offset:24576
v_mfma_f32_16x16x32_bf16 v[56:59], a[76:79], v[28:31], v[56:59]
buffer_load_dwordx4 v6, s[8:11], s50 offen offset:512 lds
v_mfma_f32_16x16x32_bf16 v[60:63], a[72:75], v[32:35], v[60:63]
ds_read_b128 v[24:27], v8 offset:26624
v_mfma_f32_16x16x32_bf16 v[64:67], a[76:79], v[32:35], v[64:67]
s_add_u32 m0, s46, 85376
s_waitcnt lgkmcnt(4)
v_mfma_f32_16x16x32_bf16 v[52:55], a[80:83], v[36:39], v[52:55]
ds_read_b128 v[28:31], v9 offset:24576
v_mfma_f32_16x16x32_bf16 v[56:59], a[84:87], v[36:39], v[56:59]
buffer_load_dwordx4 v6, s[8:11], s50 offen offset:640 lds
v_mfma_f32_16x16x32_bf16 v[60:63], a[80:83], v[40:43], v[60:63]
ds_read_b128 v[32:35], v9 offset:26624
v_mfma_f32_16x16x32_bf16 v[64:67], a[84:87], v[40:43], v[64:67]
s_add_u32 m0, s46, 89344
s_waitcnt lgkmcnt(4)
v_mfma_f32_16x16x32_bf16 v[52:55], a[88:91], v[44:47], v[52:55]
ds_read_b128 v[36:39], v8 offset:28672
v_mfma_f32_16x16x32_bf16 v[56:59], a[92:95], v[44:47], v[56:59]
buffer_load_dwordx4 v6, s[8:11], s50 offen offset:768 lds
v_mfma_f32_16x16x32_bf16 v[60:63], a[88:91], v[48:51], v[60:63]
ds_read_b128 v[40:43], v8 offset:30720
v_mfma_f32_16x16x32_bf16 v[64:67], a[92:95], v[48:51], v[64:67]
s_add_u32 m0, s46, 93312
s_waitcnt lgkmcnt(4)
v_mfma_f32_16x16x32_bf16 v[52:55], a[96:99], v[20:23], v[52:55]
ds_read_b128 v[44:47], v9 offset:28672
v_mfma_f32_16x16x32_bf16 v[56:59], a[100:103], v[20:23], v[56:59]
buffer_load_dwordx4 v6, s[8:11], s50 offen offset:896 lds
v_mfma_f32_16x16x32_bf16 v[60:63], a[96:99], v[24:27], v[60:63]
ds_read_b128 v[48:51], v9 offset:30720
v_mfma_f32_16x16x32_bf16 v[64:67], a[100:103], v[24:27], v[64:67]
s_add_u32 m0, s46, 97280
s_waitcnt lgkmcnt(4)
v_mfma_f32_16x16x32_bf16 v[52:55], a[104:107], v[28:31], v[52:55]
ds_read_b128 v[20:23], v8 offset:32768
v_mfma_f32_16x16x32_bf16 v[56:59], a[108:111], v[28:31], v[56:59]
buffer_load_dwordx4 v6, s[8:11], s50 offen offset:1024 lds
v_mfma_f32_16x16x32_bf16 v[60:63], a[104:107], v[32:35], v[60:63]
ds_read_b128 v[24:27], v8 offset:34816
v_mfma_f32_16x16x32_bf16 v[64:67], a[108:111], v[32:35], v[64:67]
s_waitcnt vmcnt(13)
v_mov_b32 v17, s42
s_mov_b64 exec, 1
buffer_store_dword v17, v16, s[84:87], s49 offen sc1
s_mov_b64 exec, -1
s_add_u32 m0, s46, 101248
s_waitcnt lgkmcnt(4)
v_mfma_f32_16x16x32_bf16 v[52:55], a[112:115], v[36:39], v[52:55]
ds_read_b128 v[28:31], v9 offset:32768
v_mfma_f32_16x16x32_bf16 v[56:59], a[116:119], v[36:39], v[56:59]
buffer_load_dwordx4 v6, s[8:11], s50 offen offset:1152 lds
v_mfma_f32_16x16x32_bf16 v[60:63], a[112:115], v[40:43], v[60:63]
ds_read_b128 v[32:35], v9 offset:34816
v_mfma_f32_16x16x32_bf16 v[64:67], a[116:119], v[40:43], v[64:67]
v_mov_b32 v100, 0
s_mov_b64 exec, 1
buffer_atomic_add v100, v16, s[84:87], s62 offen sc0 sc1
s_mov_b64 exec, -1
s_add_u32 m0, s46, 105216
s_waitcnt lgkmcnt(4)
v_mfma_f32_16x16x32_bf16 v[52:55], a[120:123], v[44:47], v[52:55]
ds_read_b128 v[36:39], v8 offset:36864
v_mfma_f32_16x16x32_bf16 v[56:59], a[124:127], v[44:47], v[56:59]
buffer_load_dwordx4 v6, s[8:11], s50 offen offset:1280 lds
v_mfma_f32_16x16x32_bf16 v[60:63], a[120:123], v[48:51], v[60:63]
ds_read_b128 v[40:43], v8 offset:38912
v_mfma_f32_16x16x32_bf16 v[64:67], a[124:127], v[48:51], v[64:67]
s_add_u32 m0, s46, 109184
s_waitcnt lgkmcnt(4)
v_mfma_f32_16x16x32_bf16 v[52:55], a[128:131], v[20:23], v[52:55]
ds_read_b128 v[44:47], v9 offset:36864
v_mfma_f32_16x16x32_bf16 v[56:59], a[132:135], v[20:23], v[56:59]
buffer_load_dwordx4 v6, s[8:11], s50 offen offset:1408 lds
v_mfma_f32_16x16x32_bf16 v[60:63], a[128:131], v[24:27], v[60:63]
ds_read_b128 v[48:51], v9 offset:38912
v_mfma_f32_16x16x32_bf16 v[64:67], a[132:135], v[24:27], v[64:67]
s_add_u32 m0, s46, 113152
s_waitcnt lgkmcnt(4)
v_mfma_f32_16x16x32_bf16 v[52:55], a[136:139], v[28:31], v[52:55]
ds_read_b128 v[20:23], v8 offset:40960
v_mfma_f32_16x16x32_bf16 v[56:59], a[140:143], v[28:31], v[56:59]
buffer_load_dwordx4 v6, s[8:11], s50 offen offset:1536 lds
v_mfma_f32_16x16x32_bf16 v[60:63], a[136:139], v[32:35], v[60:63]
ds_read_b128 v[24:27], v8 offset:43008
v_mfma_f32_16x16x32_bf16 v[64:67], a[140:143], v[32:35], v[64:67]
s_add_u32 m0, s46, 117120
s_waitcnt lgkmcnt(4)
v_mfma_f32_16x16x32_bf16 v[52:55], a[144:147], v[36:39], v[52:55]
ds_read_b128 v[28:31], v9 offset:40960
v_mfma_f32_16x16x32_bf16 v[56:59], a[148:151], v[36:39], v[56:59]
buffer_load_dwordx4 v6, s[8:11], s50 offen offset:1664 lds
v_mfma_f32_16x16x32_bf16 v[60:63], a[144:147], v[40:43], v[60:63]
ds_read_b128 v[32:35], v9 offset:43008
v_mfma_f32_16x16x32_bf16 v[64:67], a[148:151], v[40:43], v[64:67]
s_add_u32 m0, s46, 121088
s_waitcnt lgkmcnt(4)
v_mfma_f32_16x16x32_bf16 v[52:55], a[152:155], v[44:47], v[52:55]
ds_read_b128 v[36:39], v8 offset:45056
v_mfma_f32_16x16x32_bf16 v[56:59], a[156:159], v[44:47], v[56:59]
buffer_load_dwordx4 v6, s[8:11], s50 offen offset:1792 lds
v_mfma_f32_16x16x32_bf16 v[60:63], a[152:155], v[48:51], v[60:63]
ds_read_b128 v[40:43], v8 offset:47104
v_mfma_f32_16x16x32_bf16 v[64:67], a[156:159], v[48:51], v[64:67]
s_add_u32 m0, s46, 125056
s_waitcnt lgkmcnt(4)
v_mfma_f32_16x16x32_bf16 v[52:55], a[160:163], v[20:23], v[52:55]
ds_read_b128 v[44:47], v9 offset:45056
v_mfma_f32_16x16x32_bf16 v[56:59], a[164:167], v[20:23], v[56:59]
buffer_load_dwordx4 v6, s[8:11], s50 offen offset:1920 lds
v_mfma_f32_16x16x32_bf16 v[60:63], a[160:163], v[24:27], v[60:63]
ds_read_b128 v[48:51], v9 offset:47104
v_mfma_f32_16x16x32_bf16 v[64:67], a[164:167], v[24:27], v[64:67]
s_waitcnt lgkmcnt(4)
v_mfma_f32_16x16x32_bf16 v[52:55], a[168:171], v[28:31], v[52:55]
ds_read_b128 v[20:23], v8 offset:49152
v_mfma_f32_16x16x32_bf16 v[56:59], a[172:175], v[28:31], v[56:59]
v_mfma_f32_16x16x32_bf16 v[60:63], a[168:171], v[32:35], v[60:63]
ds_read_b128 v[24:27], v8 offset:51200
v_mfma_f32_16x16x32_bf16 v[64:67], a[172:175], v[32:35], v[64:67]
v_cvt_pk_bf16_f32 v84, v68, v69
v_cvt_pk_bf16_f32 v85, v70, v71
s_waitcnt lgkmcnt(4)
v_mfma_f32_16x16x32_bf16 v[52:55], a[176:179], v[36:39], v[52:55]
ds_read_b128 v[28:31], v9 offset:49152
v_mfma_f32_16x16x32_bf16 v[56:59], a[180:183], v[36:39], v[56:59]
v_mfma_f32_16x16x32_bf16 v[60:63], a[176:179], v[40:43], v[60:63]
ds_read_b128 v[32:35], v9 offset:51200
v_mfma_f32_16x16x32_bf16 v[64:67], a[180:183], v[40:43], v[64:67]
v_cvt_pk_bf16_f32 v86, v72, v73
v_cvt_pk_bf16_f32 v87, v74, v75
s_waitcnt lgkmcnt(4)
v_mfma_f32_16x16x32_bf16 v[52:55], a[184:187], v[44:47], v[52:55]
ds_read_b128 v[36:39], v8 offset:53248
v_mfma_f32_16x16x32_bf16 v[56:59], a[188:191], v[44:47], v[56:59]
v_mfma_f32_16x16x32_bf16 v[60:63], a[184:187], v[48:51], v[60:63]
ds_read_b128 v[40:43], v8 offset:55296
v_mfma_f32_16x16x32_bf16 v[64:67], a[188:191], v[48:51], v[64:67]
v_cvt_pk_bf16_f32 v88, v76, v77
v_cvt_pk_bf16_f32 v89, v78, v79
s_waitcnt lgkmcnt(4)
v_mfma_f32_16x16x32_bf16 v[52:55], a[192:195], v[20:23], v[52:55]
ds_read_b128 v[44:47], v9 offset:53248
v_mfma_f32_16x16x32_bf16 v[56:59], a[196:199], v[20:23], v[56:59]
v_mfma_f32_16x16x32_bf16 v[60:63], a[192:195], v[24:27], v[60:63]
ds_read_b128 v[48:51], v9 offset:55296
v_mfma_f32_16x16x32_bf16 v[64:67], a[196:199], v[24:27], v[64:67]
v_cvt_pk_bf16_f32 v90, v80, v81
v_cvt_pk_bf16_f32 v91, v82, v83
s_waitcnt lgkmcnt(4)
v_mfma_f32_16x16x32_bf16 v[52:55], a[200:203], v[28:31], v[52:55]
ds_read_b128 v[20:23], v8 offset:57344
v_mfma_f32_16x16x32_bf16 v[56:59], a[204:207], v[28:31], v[56:59]
v_mfma_f32_16x16x32_bf16 v[60:63], a[200:203], v[32:35], v[60:63]
ds_read_b128 v[24:27], v8 offset:59392
v_mfma_f32_16x16x32_bf16 v[64:67], a[204:207], v[32:35], v[64:67]
s_waitcnt lgkmcnt(4)
v_mfma_f32_16x16x32_bf16 v[52:55], a[208:211], v[36:39], v[52:55]
ds_read_b128 v[28:31], v9 offset:57344
v_mfma_f32_16x16x32_bf16 v[56:59], a[212:215], v[36:39], v[56:59]
v_mfma_f32_16x16x32_bf16 v[60:63], a[208:211], v[40:43], v[60:63]
ds_read_b128 v[32:35], v9 offset:59392
v_mfma_f32_16x16x32_bf16 v[64:67], a[212:215], v[40:43], v[64:67]
s_waitcnt lgkmcnt(4)
v_mfma_f32_16x16x32_bf16 v[52:55], a[216:219], v[44:47], v[52:55]
ds_read_b128 v[36:39], v8 offset:61440
v_mfma_f32_16x16x32_bf16 v[56:59], a[220:223], v[44:47], v[56:59]
s_waitcnt vmcnt(6)
v_readfirstlane_b32 s56, v100
s_cmp_eq_u32 s30, 1
s_cbranch_scc1 mega_kernel_q_kf0
s_cmp_gt_i32 s56, s42
s_cbranch_scc0 mega_kernel_q_kf0
s_mov_b32 s30, 1
s_mov_b32 m0, s61
s_nop 0
buffer_load_dwordx4 v5, s[84:87], s68 offen sc1 lds
mega_kernel_q_kf0:
v_mfma_f32_16x16x32_bf16 v[60:63], a[216:219], v[48:51], v[60:63]
ds_read_b128 v[40:43], v8 offset:63488
v_mfma_f32_16x16x32_bf16 v[64:67], a[220:223], v[48:51], v[64:67]
s_waitcnt lgkmcnt(4)
v_mfma_f32_16x16x32_bf16 v[52:55], a[224:227], v[20:23], v[52:55]
ds_read_b128 v[44:47], v9 offset:61440
v_mfma_f32_16x16x32_bf16 v[56:59], a[228:231], v[20:23], v[56:59]
v_mfma_f32_16x16x32_bf16 v[60:63], a[224:227], v[24:27], v[60:63]
ds_read_b128 v[48:51], v9 offset:63488
v_mfma_f32_16x16x32_bf16 v[64:67], a[228:231], v[24:27], v[64:67]
s_waitcnt lgkmcnt(5)
v_mfma_f32_16x16x32_bf16 v[52:55], a[232:235], v[28:31], v[52:55]
v_mfma_f32_16x16x32_bf16 v[56:59], a[236:239], v[28:31], v[56:59]
s_waitcnt lgkmcnt(4)
v_mfma_f32_16x16x32_bf16 v[60:63], a[232:235], v[32:35], v[60:63]
v_mfma_f32_16x16x32_bf16 v[64:67], a[236:239], v[32:35], v[64:67]
s_waitcnt lgkmcnt(3)
v_mfma_f32_16x16x32_bf16 v[52:55], a[240:243], v[36:39], v[52:55]
v_mfma_f32_16x16x32_bf16 v[56:59], a[244:247], v[36:39], v[56:59]
s_waitcnt lgkmcnt(2)
v_mfma_f32_16x16x32_bf16 v[60:63], a[240:243], v[40:43], v[60:63]
v_mfma_f32_16x16x32_bf16 v[64:67], a[244:247], v[40:43], v[64:67]
ds_write_b128 v101, v[84:87]
ds_write_b128 v101, v[88:91] offset:1024
s_waitcnt lgkmcnt(1)
v_mfma_f32_16x16x32_bf16 v[68:71], a[248:251], v[44:47], v[52:55]
v_mfma_f32_16x16x32_bf16 v[72:75], a[252:255], v[44:47], v[56:59]
s_waitcnt lgkmcnt(0)
v_mfma_f32_16x16x32_bf16 v[76:79], a[248:251], v[48:51], v[60:63]
v_mfma_f32_16x16x32_bf16 v[80:83], a[252:255], v[48:51], v[64:67]
s_cmp_eq_u32 s30, 1
s_cbranch_scc1 mega_kernel_q_kl0
mega_kernel_q_kw0:
v_mov_b32 v100, 0
s_mov_b64 exec, 1
buffer_atomic_add v100, v16, s[84:87], s62 offen sc0 sc1
s_mov_b64 exec, -1
s_waitcnt vmcnt(0)
v_readfirstlane_b32 s56, v100
s_cmp_gt_i32 s56, s42
s_cbranch_scc0 mega_kernel_q_kw0
s_mov_b32 m0, s61
s_nop 0
buffer_load_dwordx4 v5, s[84:87], s68 offen sc1 lds
mega_kernel_q_kl0:
s_waitcnt lgkmcnt(0) vmcnt(0)
s_barrier
ds_read_b128 v[184:187], v102 offset:0
ds_read_b128 v[112:115], v103 offset:0
ds_read_b128 v[128:131], v103 offset:1024
ds_read_b128 v[188:191], v102 offset:2048
ds_read_b128 v[116:119], v103 offset:2048
ds_read_b128 v[132:135], v103 offset:3072
ds_read_b128 v[192:195], v102 offset:4096
ds_read_b128 v[120:123], v103 offset:4096
ds_read_b128 v[136:139], v103 offset:5120
ds_read_b128 v[196:199], v102 offset:6144
ds_read_b128 v[124:127], v103 offset:6144
ds_read_b128 v[140:143], v103 offset:7168
s_waitcnt lgkmcnt(9)
v_mfma_f32_16x16x32_bf16 v[200:203], v[112:115], v[184:187], 0
v_mfma_f32_16x16x32_bf16 v[204:207], v[128:131], v[184:187], 0
ds_read_b128 v[160:163], v94 offset:0
s_waitcnt lgkmcnt(7)
v_mfma_f32_16x16x32_bf16 v[200:203], v[116:119], v[188:191], v[200:203]
v_mfma_f32_16x16x32_bf16 v[204:207], v[132:135], v[188:191], v[204:207]
ds_read_b128 v[164:167], v94 offset:1024
s_waitcnt lgkmcnt(5)
v_mfma_f32_16x16x32_bf16 v[200:203], v[120:123], v[192:195], v[200:203]
v_mfma_f32_16x16x32_bf16 v[204:207], v[136:139], v[192:195], v[204:207]
ds_read_b128 v[168:171], v94 offset:2048
s_waitcnt lgkmcnt(3)
v_mfma_f32_16x16x32_bf16 v[200:203], v[124:127], v[196:199], v[200:203]
v_mfma_f32_16x16x32_bf16 v[204:207], v[140:143], v[196:199], v[204:207]
ds_read_b128 v[172:175], v94 offset:3072
s_waitcnt lgkmcnt(3)
v_mfma_f32_16x16x32_bf16 v[208:211], v[160:163], v[184:187], 0
ds_read_b128 v[144:147], v240 offset:0
ds_read_b64 v[176:177], v95 offset:0
s_waitcnt lgkmcnt(4)
v_mfma_f32_16x16x32_bf16 v[208:211], v[164:167], v[188:191], v[208:211]
ds_read_b128 v[148:151], v240 offset:1024
ds_read_b64 v[178:179], v95 offset:256
s_waitcnt lgkmcnt(5)
v_mfma_f32_16x16x32_bf16 v[208:211], v[168:171], v[192:195], v[208:211]
ds_read_b128 v[152:155], v240 offset:2048
ds_read_b64 v[180:181], v95 offset:1024
s_waitcnt lgkmcnt(6)
v_mfma_f32_16x16x32_bf16 v[208:211], v[172:175], v[196:199], v[208:211]
ds_read_b128 v[156:159], v240 offset:3072
ds_read_b64 v[182:183], v95 offset:1280
s_nop 3
v_cndmask_b32 v200, v200, v97, s[12:13]
v_cndmask_b32 v201, v201, v97, s[14:15]
v_cndmask_b32 v202, v202, v97, s[16:17]
v_cndmask_b32 v203, v203, v97, s[18:19]
v_cndmask_b32 v204, v204, v97, s[20:21]
v_cndmask_b32 v205, v205, v97, s[22:23]
v_cndmask_b32 v206, v206, v97, s[24:25]
v_cndmask_b32 v207, v207, v97, s[26:27]
v_cndmask_b32 v208, v208, v97, s[28:29]
v_cndmask_b32 v209, v209, v97, s[28:29]
v_cndmask_b32 v210, v210, v97, s[28:29]
v_cndmask_b32 v211, v211, v97, s[28:29]
v_max3_f32 v236, v200, v201, v202
v_max3_f32 v236, v236, v203, v204
v_max3_f32 v236, v236, v205, v206
v_max3_f32 v236, v236, v207, v208
v_max3_f32 v236, v236, v209, v210
v_max_f32 v237, v236, v211
v_max_f32 v236, v236, v211
s_nop 1
v_permlane16_swap_b32 v236, v237
s_nop 0
v_max_f32 v238, v236, v237
v_max_f32 v239, v236, v237
s_nop 1
v_permlane32_swap_b32 v238, v239
s_nop 0
v_max_f32 v236, v238, v239
v_mul_f32 v236, s54, v236
v_pk_fma_f32 v[200:201], v[200:201], s[54:55], v[236:237] op_sel_hi:[1,0,0] neg_lo:[0,0,1] neg_hi:[0,0,1]
v_pk_fma_f32 v[202:203], v[202:203], s[54:55], v[236:237] op_sel_hi:[1,0,0] neg_lo:[0,0,1] neg_hi:[0,0,1]
v_pk_fma_f32 v[204:205], v[204:205], s[54:55], v[236:237] op_sel_hi:[1,0,0] neg_lo:[0,0,1] neg_hi:[0,0,1]
v_pk_fma_f32 v[206:207], v[206:207], s[54:55], v[236:237] op_sel_hi:[1,0,0] neg_lo:[0,0,1] neg_hi:[0,0,1]
v_pk_fma_f32 v[208:209], v[208:209], s[54:55], v[236:237] op_sel_hi:[1,0,0] neg_lo:[0,0,1] neg_hi:[0,0,1]
v_pk_fma_f32 v[210:211], v[210:211], s[54:55], v[236:237] op_sel_hi:[1,0,0] neg_lo:[0,0,1] neg_hi:[0,0,1]
v_exp_f32 v200, v200
v_exp_f32 v201, v201
v_exp_f32 v202, v202
v_exp_f32 v203, v203
v_exp_f32 v204, v204
v_exp_f32 v205, v205
v_exp_f32 v206, v206
v_exp_f32 v207, v207
v_exp_f32 v208, v208
v_exp_f32 v209, v209
v_exp_f32 v210, v210
v_exp_f32 v211, v211
s_nop 0
v_cvt_pk_bf16_f32 v212, v200, v201
v_cvt_pk_bf16_f32 v213, v202, v203
v_cvt_pk_bf16_f32 v214, v204, v205
v_cvt_pk_bf16_f32 v215, v206, v207
v_cvt_pk_bf16_f32 v216, v208, v209
v_cvt_pk_bf16_f32 v217, v210, v211
s_waitcnt lgkmcnt(0)
s_nop 0
v_mfma_f32_16x16x32_bf16 v[108:111], v[104:107], v[212:215], 0
v_mfma_f32_16x16x32_bf16 v[220:223], v[144:147], v[212:215], 0
v_mfma_f32_16x16x32_bf16 v[224:227], v[148:151], v[212:215], 0
v_mfma_f32_16x16x32_bf16 v[228:231], v[152:155], v[212:215], 0
v_mfma_f32_16x16x32_bf16 v[232:235], v[156:159], v[212:215], 0
v_mfma_f32_16x16x16_bf16 v[108:111], v[104:105], v[216:217], v[108:111]
v_mfma_f32_16x16x16_bf16 v[220:223], v[176:177], v[216:217], v[220:223]
v_mfma_f32_16x16x16_bf16 v[224:227], v[178:179], v[216:217], v[224:227]
v_mfma_f32_16x16x16_bf16 v[228:231], v[180:181], v[216:217], v[228:231]
v_mfma_f32_16x16x16_bf16 v[232:235], v[182:183], v[216:217], v[232:235]
s_lshl_b32 s51, s42, 18
s_nop 2
v_rcp_f32 v238, v108
v_rcp_f32 v239, v109
s_nop 1
v_pk_mul_f32 v[220:221], v[220:221], v[238:239]
v_pk_mul_f32 v[222:223], v[222:223], v[238:239]
v_pk_mul_f32 v[224:225], v[224:225], v[238:239]
v_pk_mul_f32 v[226:227], v[226:227], v[238:239]
v_pk_mul_f32 v[228:229], v[228:229], v[238:239]
v_pk_mul_f32 v[230:231], v[230:231], v[238:239]
v_pk_mul_f32 v[232:233], v[232:233], v[238:239]
v_pk_mul_f32 v[234:235], v[234:235], v[238:239]
v_cvt_pk_bf16_f32 v200, v220, v221
v_cvt_pk_bf16_f32 v201, v222, v223
v_cvt_pk_bf16_f32 v202, v224, v225
v_cvt_pk_bf16_f32 v203, v226, v227
v_cvt_pk_bf16_f32 v204, v228, v229
v_cvt_pk_bf16_f32 v205, v230, v231
v_cvt_pk_bf16_f32 v206, v232, v233
v_cvt_pk_bf16_f32 v207, v234, v235
buffer_store_dwordx4 v[200:203], v96, s[84:87], s51 offen sc1
buffer_store_dwordx4 v[204:207], v96, s[84:87], s51 offen offset:2048 sc1
s_add_u32 s42, s42, 1
s_branch mega_kernel_q_loop
mega_kernel_q_last:
s_barrier
s_cmp_gt_i32 s55, s42
s_cbranch_scc1 mega_kernel_q_kv2k
mega_kernel_q_kv2w:
buffer_load_dword v2, v99, s[84:87], 0 offen sc1
s_waitcnt vmcnt(0)
v_min_i32_dpp v2, v2, v2 quad_perm:[1,0,3,2] row_mask:0xf bank_mask:0xf
s_nop 1
v_min_i32_dpp v2, v2, v2 quad_perm:[2,3,0,1] row_mask:0xf bank_mask:0xf
s_nop 1
v_min_i32_dpp v2, v2, v2 row_ror:4 row_mask:0xf bank_mask:0xf
s_nop 0
v_readfirstlane_b32 s55, v2
s_cmp_gt_i32 s55, s42
s_cbranch_scc1 mega_kernel_q_kv2k
s_sleep 4
s_branch mega_kernel_q_kv2w
mega_kernel_q_kv2k:
s_add_u32 s51, s47, s42
s_bfe_u32 s57, s51, 0x40002
s_lshl_b32 s57, s57, 14
s_and_b32 s66, s51, 3
s_lshl_b32 s66, s66, 11
s_add_u32 s66, s66, s57
s_add_u32 s66, s66, s58
s_add_u32 s67, s66, 33554432
s_bfe_u32 s57, s51, 0x30003
s_lshl_b32 s57, s57, 14
s_and_b32 s68, s51, 7
s_lshl_b32 s68, s68, 10
s_add_u32 s68, s68, s57
s_add_u32 s68, s68, s59
s_add_u32 s50, s42, 2
s_min_u32 s50, s50, 63
s_lshl_b32 s50, s50, 16
s_cmp_gt_i32 s56, s42
s_cselect_b32 s30, 1, 0
s_add_u32 m0, s60, 0
s_nop 0
buffer_load_dwordx4 v5, s[84:87], s66 offen offset:0 sc1 lds
s_add_u32 m0, s60, 0
s_nop 0
buffer_load_dwordx4 v5, s[84:87], s66 offen offset:1024 sc1 lds
s_add_u32 m0, s60, 8192
s_nop 0
buffer_load_dwordx4 v5, s[84:87], s67 offen offset:0 sc1 lds
s_add_u32 m0, s60, 8192
s_nop 0
buffer_load_dwordx4 v5, s[84:87], s67 offen offset:1024 sc1 lds
s_cmp_eq_u32 s30, 1
s_cbranch_scc0 mega_kernel_q_ke2
s_mov_b32 m0, s61
s_nop 0
buffer_load_dwordx4 v5, s[84:87], s68 offen sc1 lds
mega_kernel_q_ke2:
v_cvt_pk_bf16_f32 v84, v68, v69
v_cvt_pk_bf16_f32 v85, v70, v71
v_cvt_pk_bf16_f32 v86, v72, v73
v_cvt_pk_bf16_f32 v87, v74, v75
v_cvt_pk_bf16_f32 v88, v76, v77
v_cvt_pk_bf16_f32 v89, v78, v79
v_cvt_pk_bf16_f32 v90, v80, v81
v_cvt_pk_bf16_f32 v91, v82, v83
ds_write_b128 v101, v[84:87]
ds_write_b128 v101, v[88:91] offset:1024
s_waitcnt vmcnt(4)
v_mov_b32 v17, s42
s_mov_b64 exec, 1
buffer_store_dword v17, v16, s[84:87], s49 offen sc1
s_mov_b64 exec, -1
s_cmp_eq_u32 s30, 1
s_cbranch_scc1 mega_kernel_q_kl2
mega_kernel_q_kw2:
v_mov_b32 v100, 0
s_mov_b64 exec, 1
buffer_atomic_add v100, v16, s[84:87], s62 offen sc0 sc1
s_mov_b64 exec, -1
s_waitcnt vmcnt(0)
v_readfirstlane_b32 s56, v100
s_cmp_gt_i32 s56, s42
s_cbranch_scc0 mega_kernel_q_kw2
s_mov_b32 m0, s61
s_nop 0
buffer_load_dwordx4 v5, s[84:87], s68 offen sc1 lds
mega_kernel_q_kl2:
s_waitcnt lgkmcnt(0) vmcnt(0)
s_barrier
ds_read_b128 v[184:187], v102 offset:0
ds_read_b128 v[112:115], v103 offset:0
ds_read_b128 v[128:131], v103 offset:1024
ds_read_b128 v[188:191], v102 offset:2048
ds_read_b128 v[116:119], v103 offset:2048
ds_read_b128 v[132:135], v103 offset:3072
ds_read_b128 v[192:195], v102 offset:4096
ds_read_b128 v[120:123], v103 offset:4096
ds_read_b128 v[136:139], v103 offset:5120
ds_read_b128 v[196:199], v102 offset:6144
ds_read_b128 v[124:127], v103 offset:6144
ds_read_b128 v[140:143], v103 offset:7168
s_waitcnt lgkmcnt(9)
v_mfma_f32_16x16x32_bf16 v[200:203], v[112:115], v[184:187], 0
v_mfma_f32_16x16x32_bf16 v[204:207], v[128:131], v[184:187], 0
ds_read_b128 v[160:163], v94 offset:0
s_waitcnt lgkmcnt(7)
v_mfma_f32_16x16x32_bf16 v[200:203], v[116:119], v[188:191], v[200:203]
v_mfma_f32_16x16x32_bf16 v[204:207], v[132:135], v[188:191], v[204:207]
ds_read_b128 v[164:167], v94 offset:1024
s_waitcnt lgkmcnt(5)
v_mfma_f32_16x16x32_bf16 v[200:203], v[120:123], v[192:195], v[200:203]
v_mfma_f32_16x16x32_bf16 v[204:207], v[136:139], v[192:195], v[204:207]
ds_read_b128 v[168:171], v94 offset:2048
s_waitcnt lgkmcnt(3)
v_mfma_f32_16x16x32_bf16 v[200:203], v[124:127], v[196:199], v[200:203]
v_mfma_f32_16x16x32_bf16 v[204:207], v[140:143], v[196:199], v[204:207]
ds_read_b128 v[172:175], v94 offset:3072
s_waitcnt lgkmcnt(3)
v_mfma_f32_16x16x32_bf16 v[208:211], v[160:163], v[184:187], 0
ds_read_b128 v[144:147], v240 offset:0
ds_read_b64 v[176:177], v95 offset:0
s_waitcnt lgkmcnt(4)
v_mfma_f32_16x16x32_bf16 v[208:211], v[164:167], v[188:191], v[208:211]
ds_read_b128 v[148:151], v240 offset:1024
ds_read_b64 v[178:179], v95 offset:256
s_waitcnt lgkmcnt(5)
v_mfma_f32_16x16x32_bf16 v[208:211], v[168:171], v[192:195], v[208:211]
ds_read_b128 v[152:155], v240 offset:2048
ds_read_b64 v[180:181], v95 offset:1024
s_waitcnt lgkmcnt(6)
v_mfma_f32_16x16x32_bf16 v[208:211], v[172:175], v[196:199], v[208:211]
ds_read_b128 v[156:159], v240 offset:3072
ds_read_b64 v[182:183], v95 offset:1280
s_nop 3
v_cndmask_b32 v200, v200, v97, s[12:13]
v_cndmask_b32 v201, v201, v97, s[14:15]
v_cndmask_b32 v202, v202, v97, s[16:17]
v_cndmask_b32 v203, v203, v97, s[18:19]
v_cndmask_b32 v204, v204, v97, s[20:21]
v_cndmask_b32 v205, v205, v97, s[22:23]
v_cndmask_b32 v206, v206, v97, s[24:25]
v_cndmask_b32 v207, v207, v97, s[26:27]
v_cndmask_b32 v208, v208, v97, s[28:29]
v_cndmask_b32 v209, v209, v97, s[28:29]
v_cndmask_b32 v210, v210, v97, s[28:29]
v_cndmask_b32 v211, v211, v97, s[28:29]
v_max3_f32 v236, v200, v201, v202
v_max3_f32 v236, v236, v203, v204
v_max3_f32 v236, v236, v205, v206
v_max3_f32 v236, v236, v207, v208
v_max3_f32 v236, v236, v209, v210
v_max_f32 v237, v236, v211
v_max_f32 v236, v236, v211
s_nop 1
v_permlane16_swap_b32 v236, v237
s_nop 0
v_max_f32 v238, v236, v237
v_max_f32 v239, v236, v237
s_nop 1
v_permlane32_swap_b32 v238, v239
s_nop 0
v_max_f32 v236, v238, v239
v_mul_f32 v236, s54, v236
v_pk_fma_f32 v[200:201], v[200:201], s[54:55], v[236:237] op_sel_hi:[1,0,0] neg_lo:[0,0,1] neg_hi:[0,0,1]
v_pk_fma_f32 v[202:203], v[202:203], s[54:55], v[236:237] op_sel_hi:[1,0,0] neg_lo:[0,0,1] neg_hi:[0,0,1]
v_pk_fma_f32 v[204:205], v[204:205], s[54:55], v[236:237] op_sel_hi:[1,0,0] neg_lo:[0,0,1] neg_hi:[0,0,1]
v_pk_fma_f32 v[206:207], v[206:207], s[54:55], v[236:237] op_sel_hi:[1,0,0] neg_lo:[0,0,1] neg_hi:[0,0,1]
v_pk_fma_f32 v[208:209], v[208:209], s[54:55], v[236:237] op_sel_hi:[1,0,0] neg_lo:[0,0,1] neg_hi:[0,0,1]
v_pk_fma_f32 v[210:211], v[210:211], s[54:55], v[236:237] op_sel_hi:[1,0,0] neg_lo:[0,0,1] neg_hi:[0,0,1]
v_exp_f32 v200, v200
v_exp_f32 v201, v201
v_exp_f32 v202, v202
v_exp_f32 v203, v203
v_exp_f32 v204, v204
v_exp_f32 v205, v205
v_exp_f32 v206, v206
v_exp_f32 v207, v207
v_exp_f32 v208, v208
v_exp_f32 v209, v209
v_exp_f32 v210, v210
v_exp_f32 v211, v211
s_nop 0
v_cvt_pk_bf16_f32 v212, v200, v201
v_cvt_pk_bf16_f32 v213, v202, v203
v_cvt_pk_bf16_f32 v214, v204, v205
v_cvt_pk_bf16_f32 v215, v206, v207
v_cvt_pk_bf16_f32 v216, v208, v209
v_cvt_pk_bf16_f32 v217, v210, v211
s_waitcnt lgkmcnt(0)
s_nop 0
v_mfma_f32_16x16x32_bf16 v[108:111], v[104:107], v[212:215], 0
v_mfma_f32_16x16x32_bf16 v[220:223], v[144:147], v[212:215], 0
v_mfma_f32_16x16x32_bf16 v[224:227], v[148:151], v[212:215], 0
v_mfma_f32_16x16x32_bf16 v[228:231], v[152:155], v[212:215], 0
v_mfma_f32_16x16x32_bf16 v[232:235], v[156:159], v[212:215], 0
v_mfma_f32_16x16x16_bf16 v[108:111], v[104:105], v[216:217], v[108:111]
v_mfma_f32_16x16x16_bf16 v[220:223], v[176:177], v[216:217], v[220:223]
v_mfma_f32_16x16x16_bf16 v[224:227], v[178:179], v[216:217], v[224:227]
v_mfma_f32_16x16x16_bf16 v[228:231], v[180:181], v[216:217], v[228:231]
v_mfma_f32_16x16x16_bf16 v[232:235], v[182:183], v[216:217], v[232:235]
s_lshl_b32 s51, s42, 18
s_nop 2
v_rcp_f32 v238, v108
v_rcp_f32 v239, v109
s_nop 1
v_pk_mul_f32 v[220:221], v[220:221], v[238:239]
v_pk_mul_f32 v[222:223], v[222:223], v[238:239]
v_pk_mul_f32 v[224:225], v[224:225], v[238:239]
v_pk_mul_f32 v[226:227], v[226:227], v[238:239]
v_pk_mul_f32 v[228:229], v[228:229], v[238:239]
v_pk_mul_f32 v[230:231], v[230:231], v[238:239]
v_pk_mul_f32 v[232:233], v[232:233], v[238:239]
v_pk_mul_f32 v[234:235], v[234:235], v[238:239]
v_cvt_pk_bf16_f32 v200, v220, v221
v_cvt_pk_bf16_f32 v201, v222, v223
v_cvt_pk_bf16_f32 v202, v224, v225
v_cvt_pk_bf16_f32 v203, v226, v227
v_cvt_pk_bf16_f32 v204, v228, v229
v_cvt_pk_bf16_f32 v205, v230, v231
v_cvt_pk_bf16_f32 v206, v232, v233
v_cvt_pk_bf16_f32 v207, v234, v235
buffer_store_dwordx4 v[200:203], v96, s[84:87], s51 offen sc1
buffer_store_dwordx4 v[204:207], v96, s[84:87], s51 offen offset:2048 sc1
s_add_u32 s42, s42, 1
s_waitcnt vmcnt(0)
v_mov_b32 v17, s42
s_mov_b64 exec, 1
buffer_store_dword v17, v16, s[84:87], s49 offen sc1
s_mov_b64 exec, -1
mega_kernel_q_quit:
s_endpgm
mega_kernel_rd:
s_mov_b32 s93, s40
s_load_dwordx2 s[4:5], s[0:1], 56
s_mov_b32 s48, 0x3f7ec46d
s_mov_b32 s49, 0x3dc8bd36
s_mov_b32 s50, 0x3f7b14be
s_mov_b32 s51, 0x3e47c5c2
s_mov_b32 s52, 0x3f74fa0b
s_mov_b32 s53, 0x3e94a031
s_mov_b32 s54, 0x3f6c835e
s_mov_b32 s55, 0x3ec3ef15
s_mov_b32 s56, 0x3f61c598
s_mov_b32 s57, 0x3ef15aea
s_mov_b32 s58, 0x3f54db31
s_mov_b32 s59, 0x3f0e39da
s_mov_b32 s60, 0x3f45e403
s_mov_b32 s61, 0x3f226799
s_mov_b32 s62, 0x3f3504f3
s_mov_b32 s63, 0x3f3504f3
v_and_b32 v1, 31, v0
v_lshrrev_b32 v2, 5, v0
v_cvt_f32_u32 v3, v1
v_mul_u32_u24 v10, 8448, v2
v_lshl_add_u32 v4, v1, 3, v10
v_mul_u32_u24 v5, 264, v1
v_add_u32 v5, v5, v10
v_and_b32 v11, 7, v0
v_lshrrev_b32 v9, 3, v0
v_mul_u32_u24 v10, 8448, v11
v_lshl_add_u32 v6, v9, 3, v10
v_lshlrev_b32 v7, 3, v9
v_sub_u32 v7, v10, v7
v_add_u32 v7, 4096, v7
v_lshlrev_b32 v8, 14, v9
v_lshl_add_u32 v8, v11, 4, v8
v_mul_f32 v12, 0xba800000, v3
v_cos_f32 v82, v12
v_sin_f32 v83, v12
v_mul_f32 v12, 0xbb000000, v3
v_cos_f32 v84, v12
v_sin_f32 v85, v12
v_mul_f32 v12, 0xbb400000, v3
v_cos_f32 v86, v12
v_sin_f32 v87, v12
v_mul_f32 v12, 0xbb800000, v3
v_cos_f32 v88, v12
v_sin_f32 v89, v12
v_mul_f32 v12, 0xbba00000, v3
v_cos_f32 v90, v12
v_sin_f32 v91, v12
v_mul_f32 v12, 0xbbc00000, v3
v_cos_f32 v92, v12
v_sin_f32 v93, v12
v_mul_f32 v12, 0xbbe00000, v3
v_cos_f32 v94, v12
v_sin_f32 v95, v12
v_mul_f32 v12, 0xbc000000, v3
v_cos_f32 v96, v12
v_sin_f32 v97, v12
v_mul_f32 v12, 0xbc100000, v3
v_cos_f32 v98, v12
v_sin_f32 v99, v12
v_mul_f32 v12, 0xbc200000, v3
v_cos_f32 v100, v12
v_sin_f32 v101, v12
v_mul_f32 v12, 0xbc300000, v3
v_cos_f32 v102, v12
v_sin_f32 v103, v12
v_mul_f32 v12, 0xbc400000, v3
v_cos_f32 v104, v12
v_sin_f32 v105, v12
v_mul_f32 v12, 0xbc500000, v3
v_cos_f32 v106, v12
v_sin_f32 v107, v12
v_mul_f32 v12, 0xbc600000, v3
v_cos_f32 v108, v12
v_sin_f32 v109, v12
v_mul_f32 v12, 0xbc700000, v3
v_cos_f32 v110, v12
v_sin_f32 v111, v12
v_mul_f32 v12, 0xbc800000, v3
v_cos_f32 v112, v12
v_sin_f32 v113, v12
v_mul_f32 v12, 0xbc880000, v3
v_cos_f32 v114, v12
v_sin_f32 v115, v12
v_mul_f32 v12, 0xbc900000, v3
v_cos_f32 v116, v12
v_sin_f32 v117, v12
v_mul_f32 v12, 0xbc980000, v3
v_cos_f32 v118, v12
v_sin_f32 v119, v12
v_mul_f32 v12, 0xbca00000, v3
v_cos_f32 v120, v12
v_sin_f32 v121, v12
v_mul_f32 v12, 0xbca80000, v3
v_cos_f32 v122, v12
v_sin_f32 v123, v12
v_mul_f32 v12, 0xbcb00000, v3
v_cos_f32 v124, v12
v_sin_f32 v125, v12
v_mul_f32 v12, 0xbcb80000, v3
v_cos_f32 v126, v12
v_sin_f32 v127, v12
v_mul_f32 v12, 0xbcc00000, v3
v_cos_f32 v128, v12
v_sin_f32 v129, v12
v_mul_f32 v12, 0xbcc80000, v3
v_cos_f32 v130, v12
v_sin_f32 v131, v12
v_mul_f32 v12, 0xbcd00000, v3
v_cos_f32 v132, v12
v_sin_f32 v133, v12
v_mul_f32 v12, 0xbcd80000, v3
v_cos_f32 v134, v12
v_sin_f32 v135, v12
v_mul_f32 v12, 0xbce00000, v3
v_cos_f32 v136, v12
v_sin_f32 v137, v12
v_mul_f32 v12, 0xbce80000, v3
v_cos_f32 v138, v12
v_sin_f32 v139, v12
v_mul_f32 v12, 0xbcf00000, v3
v_cos_f32 v140, v12
v_sin_f32 v141, v12
v_mul_f32 v12, 0xbcf80000, v3
v_cos_f32 v142, v12
v_sin_f32 v143, v12
v_lshlrev_b32 v12, 12, v2
v_lshl_add_u32 v12, v1, 1, v12
s_waitcnt lgkmcnt(0)
s_mov_b32 s6, 4194304
s_mov_b32 s7, 0x00020000
v_mov_b32 v144, 0
v_mov_b32 v145, 0
v_mov_b32 v146, 0
v_mov_b32 v147, 0
v_mov_b32 v148, 0
v_mov_b32 v149, 0
v_mov_b32 v150, 0
v_mov_b32 v151, 0
v_mov_b32 v152, 0
v_mov_b32 v153, 0
v_mov_b32 v154, 0
v_mov_b32 v155, 0
v_mov_b32 v156, 0
v_mov_b32 v157, 0
v_mov_b32 v158, 0
v_mov_b32 v159, 0
v_mov_b32 v160, 0
v_mov_b32 v161, 0
v_mov_b32 v162, 0
v_mov_b32 v163, 0
v_mov_b32 v164, 0
v_mov_b32 v165, 0
v_mov_b32 v166, 0
v_mov_b32 v167, 0
v_mov_b32 v168, 0
v_mov_b32 v169, 0
v_mov_b32 v170, 0
v_mov_b32 v171, 0
v_mov_b32 v172, 0
v_mov_b32 v173, 0
v_mov_b32 v174, 0
v_mov_b32 v175, 0
v_mov_b32 v176, 0
v_mov_b32 v177, 0
v_mov_b32 v178, 0
v_mov_b32 v179, 0
v_mov_b32 v180, 0
v_mov_b32 v181, 0
v_mov_b32 v182, 0
v_mov_b32 v183, 0
v_mov_b32 v184, 0
v_mov_b32 v185, 0
v_mov_b32 v186, 0
v_mov_b32 v187, 0
v_mov_b32 v188, 0
v_mov_b32 v189, 0
v_mov_b32 v190, 0
v_mov_b32 v191, 0
v_mov_b32 v192, 0
v_mov_b32 v193, 0
v_mov_b32 v194, 0
v_mov_b32 v195, 0
v_mov_b32 v196, 0
v_mov_b32 v197, 0
v_mov_b32 v198, 0
v_mov_b32 v199, 0
v_mov_b32 v200, 0
v_mov_b32 v201, 0
v_mov_b32 v202, 0
v_mov_b32 v203, 0
v_mov_b32 v204, 0
v_mov_b32 v205, 0
v_mov_b32 v206, 0
v_mov_b32 v207, 0
s_cmp_lt_u32 s93, 128
s_cbranch_scc0 mega_kernel_f1_e
s_lshl_b32 s12, s93, 15
buffer_load_short_d16_hi v144, v12, s[4:7], s12 offen offset:0
buffer_load_short_d16_hi v145, v12, s[4:7], s12 offen offset:2048
buffer_load_short_d16_hi v176, v12, s[4:7], s12 offen offset:1024
buffer_load_short_d16_hi v177, v12, s[4:7], s12 offen offset:3072
buffer_load_short_d16_hi v146, v12, s[4:7], s12 offen offset:64
buffer_load_short_d16_hi v147, v12, s[4:7], s12 offen offset:2112
buffer_load_short_d16_hi v178, v12, s[4:7], s12 offen offset:1088
buffer_load_short_d16_hi v179, v12, s[4:7], s12 offen offset:3136
buffer_load_short_d16_hi v148, v12, s[4:7], s12 offen offset:128
buffer_load_short_d16_hi v149, v12, s[4:7], s12 offen offset:2176
buffer_load_short_d16_hi v180, v12, s[4:7], s12 offen offset:1152
buffer_load_short_d16_hi v181, v12, s[4:7], s12 offen offset:3200
buffer_load_short_d16_hi v150, v12, s[4:7], s12 offen offset:192
buffer_load_short_d16_hi v151, v12, s[4:7], s12 offen offset:2240
buffer_load_short_d16_hi v182, v12, s[4:7], s12 offen offset:1216
buffer_load_short_d16_hi v183, v12, s[4:7], s12 offen offset:3264
buffer_load_short_d16_hi v152, v12, s[4:7], s12 offen offset:256
buffer_load_short_d16_hi v153, v12, s[4:7], s12 offen offset:2304
buffer_load_short_d16_hi v184, v12, s[4:7], s12 offen offset:1280
buffer_load_short_d16_hi v185, v12, s[4:7], s12 offen offset:3328
buffer_load_short_d16_hi v154, v12, s[4:7], s12 offen offset:320
buffer_load_short_d16_hi v155, v12, s[4:7], s12 offen offset:2368
buffer_load_short_d16_hi v186, v12, s[4:7], s12 offen offset:1344
buffer_load_short_d16_hi v187, v12, s[4:7], s12 offen offset:3392
buffer_load_short_d16_hi v156, v12, s[4:7], s12 offen offset:384
buffer_load_short_d16_hi v157, v12, s[4:7], s12 offen offset:2432
buffer_load_short_d16_hi v188, v12, s[4:7], s12 offen offset:1408
buffer_load_short_d16_hi v189, v12, s[4:7], s12 offen offset:3456
buffer_load_short_d16_hi v158, v12, s[4:7], s12 offen offset:448
buffer_load_short_d16_hi v159, v12, s[4:7], s12 offen offset:2496
buffer_load_short_d16_hi v190, v12, s[4:7], s12 offen offset:1472
buffer_load_short_d16_hi v191, v12, s[4:7], s12 offen offset:3520
buffer_load_short_d16_hi v160, v12, s[4:7], s12 offen offset:512
buffer_load_short_d16_hi v161, v12, s[4:7], s12 offen offset:2560
buffer_load_short_d16_hi v192, v12, s[4:7], s12 offen offset:1536
buffer_load_short_d16_hi v193, v12, s[4:7], s12 offen offset:3584
buffer_load_short_d16_hi v162, v12, s[4:7], s12 offen offset:576
buffer_load_short_d16_hi v163, v12, s[4:7], s12 offen offset:2624
buffer_load_short_d16_hi v194, v12, s[4:7], s12 offen offset:1600
buffer_load_short_d16_hi v195, v12, s[4:7], s12 offen offset:3648
buffer_load_short_d16_hi v164, v12, s[4:7], s12 offen offset:640
buffer_load_short_d16_hi v165, v12, s[4:7], s12 offen offset:2688
buffer_load_short_d16_hi v196, v12, s[4:7], s12 offen offset:1664
buffer_load_short_d16_hi v197, v12, s[4:7], s12 offen offset:3712
buffer_load_short_d16_hi v166, v12, s[4:7], s12 offen offset:704
buffer_load_short_d16_hi v167, v12, s[4:7], s12 offen offset:2752
buffer_load_short_d16_hi v198, v12, s[4:7], s12 offen offset:1728
buffer_load_short_d16_hi v199, v12, s[4:7], s12 offen offset:3776
buffer_load_short_d16_hi v168, v12, s[4:7], s12 offen offset:768
buffer_load_short_d16_hi v169, v12, s[4:7], s12 offen offset:2816
buffer_load_short_d16_hi v200, v12, s[4:7], s12 offen offset:1792
buffer_load_short_d16_hi v201, v12, s[4:7], s12 offen offset:3840
buffer_load_short_d16_hi v170, v12, s[4:7], s12 offen offset:832
buffer_load_short_d16_hi v171, v12, s[4:7], s12 offen offset:2880
buffer_load_short_d16_hi v202, v12, s[4:7], s12 offen offset:1856
buffer_load_short_d16_hi v203, v12, s[4:7], s12 offen offset:3904
buffer_load_short_d16_hi v172, v12, s[4:7], s12 offen offset:896
buffer_load_short_d16_hi v173, v12, s[4:7], s12 offen offset:2944
buffer_load_short_d16_hi v204, v12, s[4:7], s12 offen offset:1920
buffer_load_short_d16_hi v205, v12, s[4:7], s12 offen offset:3968
buffer_load_short_d16_hi v174, v12, s[4:7], s12 offen offset:960
buffer_load_short_d16_hi v175, v12, s[4:7], s12 offen offset:3008
buffer_load_short_d16_hi v206, v12, s[4:7], s12 offen offset:1984
buffer_load_short_d16_hi v207, v12, s[4:7], s12 offen offset:4032
s_waitcnt vmcnt(0)
mega_kernel_f1_l:
s_add_u32 s21, s93, 32
s_cmp_lt_u32 s21, 128
s_cselect_b32 s22, s21, s93
s_waitcnt vmcnt(17)
v_pk_add_f32 v[48:49], v[144:145], v[176:177] neg_lo:[0,1] neg_hi:[0,1]
v_pk_add_f32 v[16:17], v[144:145], v[176:177]
v_pk_add_f32 v[14:15], v[146:147], v[178:179] neg_lo:[0,1] neg_hi:[0,1]
v_pk_add_f32 v[18:19], v[146:147], v[178:179]
v_pk_mul_f32 v[50:51], v[14:15], s[50:51] op_sel:[0,0] op_sel_hi:[0,1] neg_lo:[0,0] neg_hi:[0,1]
v_pk_fma_f32 v[50:51], v[14:15], s[50:51], v[50:51] op_sel:[1,1,0] op_sel_hi:[1,0,1] neg_lo:[0,0,0] neg_hi:[0,0,0]
v_pk_add_f32 v[14:15], v[148:149], v[180:181] neg_lo:[0,1] neg_hi:[0,1]
v_pk_add_f32 v[20:21], v[148:149], v[180:181]
v_pk_mul_f32 v[52:53], v[14:15], s[54:55] op_sel:[0,0] op_sel_hi:[0,1] neg_lo:[0,0] neg_hi:[0,1]
v_pk_fma_f32 v[52:53], v[14:15], s[54:55], v[52:53] op_sel:[1,1,0] op_sel_hi:[1,0,1] neg_lo:[0,0,0] neg_hi:[0,0,0]
v_pk_add_f32 v[14:15], v[150:151], v[182:183] neg_lo:[0,1] neg_hi:[0,1]
v_pk_add_f32 v[22:23], v[150:151], v[182:183]
v_pk_mul_f32 v[54:55], v[14:15], s[58:59] op_sel:[0,0] op_sel_hi:[0,1] neg_lo:[0,0] neg_hi:[0,1]
v_pk_fma_f32 v[54:55], v[14:15], s[58:59], v[54:55] op_sel:[1,1,0] op_sel_hi:[1,0,1] neg_lo:[0,0,0] neg_hi:[0,0,0]
v_pk_add_f32 v[14:15], v[152:153], v[184:185] neg_lo:[0,1] neg_hi:[0,1]
v_pk_add_f32 v[24:25], v[152:153], v[184:185]
v_pk_mul_f32 v[56:57], v[14:15], s[62:63] op_sel:[0,0] op_sel_hi:[0,1] neg_lo:[0,0] neg_hi:[0,1]
v_pk_fma_f32 v[56:57], v[14:15], s[62:63], v[56:57] op_sel:[1,1,0] op_sel_hi:[1,0,1] neg_lo:[0,0,0] neg_hi:[0,0,0]
v_pk_add_f32 v[14:15], v[154:155], v[186:187] neg_lo:[0,1] neg_hi:[0,1]
v_pk_add_f32 v[26:27], v[154:155], v[186:187]
v_pk_mul_f32 v[58:59], v[14:15], s[58:59] op_sel:[0,1] op_sel_hi:[0,0] neg_lo:[0,0] neg_hi:[0,1]
v_pk_fma_f32 v[58:59], v[14:15], s[58:59], v[58:59] op_sel:[1,0,0] op_sel_hi:[1,1,1] neg_lo:[0,0,0] neg_hi:[0,0,0]
v_pk_add_f32 v[14:15], v[156:157], v[188:189] neg_lo:[0,1] neg_hi:[0,1]
v_pk_add_f32 v[28:29], v[156:157], v[188:189]
v_pk_mul_f32 v[60:61], v[14:15], s[54:55] op_sel:[0,1] op_sel_hi:[0,0] neg_lo:[0,0] neg_hi:[0,1]
v_pk_fma_f32 v[60:61], v[14:15], s[54:55], v[60:61] op_sel:[1,0,0] op_sel_hi:[1,1,1] neg_lo:[0,0,0] neg_hi:[0,0,0]
v_pk_add_f32 v[14:15], v[158:159], v[190:191] neg_lo:[0,1] neg_hi:[0,1]
v_pk_add_f32 v[30:31], v[158:159], v[190:191]
v_pk_mul_f32 v[62:63], v[14:15], s[50:51] op_sel:[0,1] op_sel_hi:[0,0] neg_lo:[0,0] neg_hi:[0,1]
v_pk_fma_f32 v[62:63], v[14:15], s[50:51], v[62:63] op_sel:[1,0,0] op_sel_hi:[1,1,1] neg_lo:[0,0,0] neg_hi:[0,0,0]
v_pk_add_f32 v[64:65], v[160:161], v[192:193] op_sel:[1,1] op_sel_hi:[0,0] neg_lo:[0,1] neg_hi:[1,0]
v_pk_add_f32 v[32:33], v[160:161], v[192:193]
v_pk_add_f32 v[14:15], v[162:163], v[194:195] neg_lo:[0,1] neg_hi:[0,1]
v_pk_add_f32 v[34:35], v[162:163], v[194:195]
v_pk_mul_f32 v[66:67], v[14:15], s[50:51] op_sel:[0,1] op_sel_hi:[0,0] neg_lo:[0,1] neg_hi:[0,1]
v_pk_fma_f32 v[66:67], v[14:15], s[50:51], v[66:67] op_sel:[1,0,0] op_sel_hi:[1,1,1] neg_lo:[0,0,0] neg_hi:[0,1,0]
v_pk_add_f32 v[14:15], v[164:165], v[196:197] neg_lo:[0,1] neg_hi:[0,1]
v_pk_add_f32 v[36:37], v[164:165], v[196:197]
v_pk_mul_f32 v[68:69], v[14:15], s[54:55] op_sel:[0,1] op_sel_hi:[0,0] neg_lo:[0,1] neg_hi:[0,1]
v_pk_fma_f32 v[68:69], v[14:15], s[54:55], v[68:69] op_sel:[1,0,0] op_sel_hi:[1,1,1] neg_lo:[0,0,0] neg_hi:[0,1,0]
v_pk_add_f32 v[14:15], v[166:167], v[198:199] neg_lo:[0,1] neg_hi:[0,1]
v_pk_add_f32 v[38:39], v[166:167], v[198:199]
v_pk_mul_f32 v[70:71], v[14:15], s[58:59] op_sel:[0,1] op_sel_hi:[0,0] neg_lo:[0,1] neg_hi:[0,1]
v_pk_fma_f32 v[70:71], v[14:15], s[58:59], v[70:71] op_sel:[1,0,0] op_sel_hi:[1,1,1] neg_lo:[0,0,0] neg_hi:[0,1,0]
v_pk_add_f32 v[14:15], v[168:169], v[200:201] neg_lo:[0,1] neg_hi:[0,1]
v_pk_add_f32 v[40:41], v[168:169], v[200:201]
v_pk_mul_f32 v[72:73], v[14:15], s[62:63] op_sel:[0,0] op_sel_hi:[0,1] neg_lo:[0,1] neg_hi:[0,1]
v_pk_fma_f32 v[72:73], v[14:15], s[62:63], v[72:73] op_sel:[1,1,0] op_sel_hi:[1,0,1] neg_lo:[0,0,0] neg_hi:[0,1,0]
v_pk_add_f32 v[14:15], v[170:171], v[202:203] neg_lo:[0,1] neg_hi:[0,1]
v_pk_add_f32 v[42:43], v[170:171], v[202:203]
v_pk_mul_f32 v[74:75], v[14:15], s[58:59] op_sel:[0,0] op_sel_hi:[0,1] neg_lo:[0,1] neg_hi:[0,1]
v_pk_fma_f32 v[74:75], v[14:15], s[58:59], v[74:75] op_sel:[1,1,0] op_sel_hi:[1,0,1] neg_lo:[0,0,0] neg_hi:[0,1,0]
v_pk_add_f32 v[14:15], v[172:173], v[204:205] neg_lo:[0,1] neg_hi:[0,1]
v_pk_add_f32 v[44:45], v[172:173], v[204:205]
v_pk_mul_f32 v[76:77], v[14:15], s[54:55] op_sel:[0,0] op_sel_hi:[0,1] neg_lo:[0,1] neg_hi:[0,1]
v_pk_fma_f32 v[76:77], v[14:15], s[54:55], v[76:77] op_sel:[1,1,0] op_sel_hi:[1,0,1] neg_lo:[0,0,0] neg_hi:[0,1,0]
v_pk_add_f32 v[14:15], v[174:175], v[206:207] neg_lo:[0,1] neg_hi:[0,1]
v_pk_add_f32 v[46:47], v[174:175], v[206:207]
v_pk_mul_f32 v[78:79], v[14:15], s[50:51] op_sel:[0,0] op_sel_hi:[0,1] neg_lo:[0,1] neg_hi:[0,1]
v_pk_fma_f32 v[78:79], v[14:15], s[50:51], v[78:79] op_sel:[1,1,0] op_sel_hi:[1,0,1] neg_lo:[0,0,0] neg_hi:[0,1,0]
s_lshl_b32 s12, s22, 15
buffer_load_short_d16_hi v144, v12, s[4:7], s12 offen offset:0
buffer_load_short_d16_hi v145, v12, s[4:7], s12 offen offset:2048
buffer_load_short_d16_hi v176, v12, s[4:7], s12 offen offset:1024
buffer_load_short_d16_hi v177, v12, s[4:7], s12 offen offset:3072
buffer_load_short_d16_hi v146, v12, s[4:7], s12 offen offset:64
buffer_load_short_d16_hi v147, v12, s[4:7], s12 offen offset:2112
buffer_load_short_d16_hi v178, v12, s[4:7], s12 offen offset:1088
buffer_load_short_d16_hi v179, v12, s[4:7], s12 offen offset:3136
buffer_load_short_d16_hi v148, v12, s[4:7], s12 offen offset:128
buffer_load_short_d16_hi v149, v12, s[4:7], s12 offen offset:2176
buffer_load_short_d16_hi v180, v12, s[4:7], s12 offen offset:1152
buffer_load_short_d16_hi v181, v12, s[4:7], s12 offen offset:3200
buffer_load_short_d16_hi v150, v12, s[4:7], s12 offen offset:192
buffer_load_short_d16_hi v151, v12, s[4:7], s12 offen offset:2240
buffer_load_short_d16_hi v182, v12, s[4:7], s12 offen offset:1216
buffer_load_short_d16_hi v183, v12, s[4:7], s12 offen offset:3264
buffer_load_short_d16_hi v152, v12, s[4:7], s12 offen offset:256
buffer_load_short_d16_hi v153, v12, s[4:7], s12 offen offset:2304
buffer_load_short_d16_hi v184, v12, s[4:7], s12 offen offset:1280
buffer_load_short_d16_hi v185, v12, s[4:7], s12 offen offset:3328
buffer_load_short_d16_hi v154, v12, s[4:7], s12 offen offset:320
buffer_load_short_d16_hi v155, v12, s[4:7], s12 offen offset:2368
buffer_load_short_d16_hi v186, v12, s[4:7], s12 offen offset:1344
buffer_load_short_d16_hi v187, v12, s[4:7], s12 offen offset:3392
buffer_load_short_d16_hi v156, v12, s[4:7], s12 offen offset:384
buffer_load_short_d16_hi v157, v12, s[4:7], s12 offen offset:2432
buffer_load_short_d16_hi v188, v12, s[4:7], s12 offen offset:1408
buffer_load_short_d16_hi v189, v12, s[4:7], s12 offen offset:3456
buffer_load_short_d16_hi v158, v12, s[4:7], s12 offen offset:448
buffer_load_short_d16_hi v159, v12, s[4:7], s12 offen offset:2496
buffer_load_short_d16_hi v190, v12, s[4:7], s12 offen offset:1472
buffer_load_short_d16_hi v191, v12, s[4:7], s12 offen offset:3520
buffer_load_short_d16_hi v160, v12, s[4:7], s12 offen offset:512
buffer_load_short_d16_hi v161, v12, s[4:7], s12 offen offset:2560
buffer_load_short_d16_hi v192, v12, s[4:7], s12 offen offset:1536
buffer_load_short_d16_hi v193, v12, s[4:7], s12 offen offset:3584
buffer_load_short_d16_hi v162, v12, s[4:7], s12 offen offset:576
buffer_load_short_d16_hi v163, v12, s[4:7], s12 offen offset:2624
buffer_load_short_d16_hi v194, v12, s[4:7], s12 offen offset:1600
buffer_load_short_d16_hi v195, v12, s[4:7], s12 offen offset:3648
buffer_load_short_d16_hi v164, v12, s[4:7], s12 offen offset:640
buffer_load_short_d16_hi v165, v12, s[4:7], s12 offen offset:2688
buffer_load_short_d16_hi v196, v12, s[4:7], s12 offen offset:1664
buffer_load_short_d16_hi v197, v12, s[4:7], s12 offen offset:3712
buffer_load_short_d16_hi v166, v12, s[4:7], s12 offen offset:704
buffer_load_short_d16_hi v167, v12, s[4:7], s12 offen offset:2752
buffer_load_short_d16_hi v198, v12, s[4:7], s12 offen offset:1728
buffer_load_short_d16_hi v199, v12, s[4:7], s12 offen offset:3776
buffer_load_short_d16_hi v168, v12, s[4:7], s12 offen offset:768
buffer_load_short_d16_hi v169, v12, s[4:7], s12 offen offset:2816
buffer_load_short_d16_hi v200, v12, s[4:7], s12 offen offset:1792
buffer_load_short_d16_hi v201, v12, s[4:7], s12 offen offset:3840
buffer_load_short_d16_hi v170, v12, s[4:7], s12 offen offset:832
buffer_load_short_d16_hi v171, v12, s[4:7], s12 offen offset:2880
buffer_load_short_d16_hi v202, v12, s[4:7], s12 offen offset:1856
buffer_load_short_d16_hi v203, v12, s[4:7], s12 offen offset:3904
buffer_load_short_d16_hi v172, v12, s[4:7], s12 offen offset:896
buffer_load_short_d16_hi v173, v12, s[4:7], s12 offen offset:2944
buffer_load_short_d16_hi v204, v12, s[4:7], s12 offen offset:1920
buffer_load_short_d16_hi v205, v12, s[4:7], s12 offen offset:3968
buffer_load_short_d16_hi v174, v12, s[4:7], s12 offen offset:960
buffer_load_short_d16_hi v175, v12, s[4:7], s12 offen offset:3008
buffer_load_short_d16_hi v206, v12, s[4:7], s12 offen offset:1984
buffer_load_short_d16_hi v207, v12, s[4:7], s12 offen offset:4032
v_pk_add_f32 v[14:15], v[16:17], v[32:33] neg_lo:[0,1] neg_hi:[0,1]
v_pk_add_f32 v[16:17], v[16:17], v[32:33]
v_pk_add_f32 v[32:33], v[18:19], v[34:35] neg_lo:[0,1] neg_hi:[0,1]
v_pk_add_f32 v[18:19], v[18:19], v[34:35]
v_pk_mul_f32 v[34:35], v[32:33], s[54:55] op_sel:[0,0] op_sel_hi:[0,1] neg_lo:[0,0] neg_hi:[0,1]
v_pk_fma_f32 v[34:35], v[32:33], s[54:55], v[34:35] op_sel:[1,1,0] op_sel_hi:[1,0,1] neg_lo:[0,0,0] neg_hi:[0,0,0]
v_pk_add_f32 v[32:33], v[20:21], v[36:37] neg_lo:[0,1] neg_hi:[0,1]
v_pk_add_f32 v[20:21], v[20:21], v[36:37]
v_pk_mul_f32 v[36:37], v[32:33], s[62:63] op_sel:[0,0] op_sel_hi:[0,1] neg_lo:[0,0] neg_hi:[0,1]
v_pk_fma_f32 v[36:37], v[32:33], s[62:63], v[36:37] op_sel:[1,1,0] op_sel_hi:[1,0,1] neg_lo:[0,0,0] neg_hi:[0,0,0]
v_pk_add_f32 v[32:33], v[22:23], v[38:39] neg_lo:[0,1] neg_hi:[0,1]
v_pk_add_f32 v[22:23], v[22:23], v[38:39]
v_pk_mul_f32 v[38:39], v[32:33], s[54:55] op_sel:[0,1] op_sel_hi:[0,0] neg_lo:[0,0] neg_hi:[0,1]
v_pk_fma_f32 v[38:39], v[32:33], s[54:55], v[38:39] op_sel:[1,0,0] op_sel_hi:[1,1,1] neg_lo:[0,0,0] neg_hi:[0,0,0]
v_pk_add_f32 v[32:33], v[24:25], v[40:41] op_sel:[1,1] op_sel_hi:[0,0] neg_lo:[0,1] neg_hi:[1,0]
v_pk_add_f32 v[24:25], v[24:25], v[40:41]
v_pk_add_f32 v[40:41], v[26:27], v[42:43] neg_lo:[0,1] neg_hi:[0,1]
v_pk_add_f32 v[26:27], v[26:27], v[42:43]
v_pk_mul_f32 v[42:43], v[40:41], s[54:55] op_sel:[0,1] op_sel_hi:[0,0] neg_lo:[0,1] neg_hi:[0,1]
v_pk_fma_f32 v[42:43], v[40:41], s[54:55], v[42:43] op_sel:[1,0,0] op_sel_hi:[1,1,1] neg_lo:[0,0,0] neg_hi:[0,1,0]
v_pk_add_f32 v[40:41], v[28:29], v[44:45] neg_lo:[0,1] neg_hi:[0,1]
v_pk_add_f32 v[28:29], v[28:29], v[44:45]
v_pk_mul_f32 v[44:45], v[40:41], s[62:63] op_sel:[0,0] op_sel_hi:[0,1] neg_lo:[0,1] neg_hi:[0,1]
v_pk_fma_f32 v[44:45], v[40:41], s[62:63], v[44:45] op_sel:[1,1,0] op_sel_hi:[1,0,1] neg_lo:[0,0,0] neg_hi:[0,1,0]
v_pk_add_f32 v[40:41], v[30:31], v[46:47] neg_lo:[0,1] neg_hi:[0,1]
v_pk_add_f32 v[30:31], v[30:31], v[46:47]
v_pk_mul_f32 v[46:47], v[40:41], s[54:55] op_sel:[0,0] op_sel_hi:[0,1] neg_lo:[0,1] neg_hi:[0,1]
v_pk_fma_f32 v[46:47], v[40:41], s[54:55], v[46:47] op_sel:[1,1,0] op_sel_hi:[1,0,1] neg_lo:[0,0,0] neg_hi:[0,1,0]
v_pk_add_f32 v[40:41], v[48:49], v[64:65] neg_lo:[0,1] neg_hi:[0,1]
v_pk_add_f32 v[48:49], v[48:49], v[64:65]
v_pk_add_f32 v[64:65], v[50:51], v[66:67] neg_lo:[0,1] neg_hi:[0,1]
v_pk_add_f32 v[50:51], v[50:51], v[66:67]
v_pk_mul_f32 v[66:67], v[64:65], s[54:55] op_sel:[0,0] op_sel_hi:[0,1] neg_lo:[0,0] neg_hi:[0,1]
v_pk_fma_f32 v[66:67], v[64:65], s[54:55], v[66:67] op_sel:[1,1,0] op_sel_hi:[1,0,1] neg_lo:[0,0,0] neg_hi:[0,0,0]
v_pk_add_f32 v[64:65], v[52:53], v[68:69] neg_lo:[0,1] neg_hi:[0,1]
v_pk_add_f32 v[52:53], v[52:53], v[68:69]
v_pk_mul_f32 v[68:69], v[64:65], s[62:63] op_sel:[0,0] op_sel_hi:[0,1] neg_lo:[0,0] neg_hi:[0,1]
v_pk_fma_f32 v[68:69], v[64:65], s[62:63], v[68:69] op_sel:[1,1,0] op_sel_hi:[1,0,1] neg_lo:[0,0,0] neg_hi:[0,0,0]
v_pk_add_f32 v[64:65], v[54:55], v[70:71] neg_lo:[0,1] neg_hi:[0,1]
v_pk_add_f32 v[54:55], v[54:55], v[70:71]
v_pk_mul_f32 v[70:71], v[64:65], s[54:55] op_sel:[0,1] op_sel_hi:[0,0] neg_lo:[0,0] neg_hi:[0,1]
v_pk_fma_f32 v[70:71], v[64:65], s[54:55], v[70:71] op_sel:[1,0,0] op_sel_hi:[1,1,1] neg_lo:[0,0,0] neg_hi:[0,0,0]
v_pk_add_f32 v[64:65], v[56:57], v[72:73] op_sel:[1,1] op_sel_hi:[0,0] neg_lo:[0,1] neg_hi:[1,0]
v_pk_add_f32 v[56:57], v[56:57], v[72:73]
v_pk_add_f32 v[72:73], v[58:59], v[74:75] neg_lo:[0,1] neg_hi:[0,1]
v_pk_add_f32 v[58:59], v[58:59], v[74:75]
v_pk_mul_f32 v[74:75], v[72:73], s[54:55] op_sel:[0,1] op_sel_hi:[0,0] neg_lo:[0,1] neg_hi:[0,1]
v_pk_fma_f32 v[74:75], v[72:73], s[54:55], v[74:75] op_sel:[1,0,0] op_sel_hi:[1,1,1] neg_lo:[0,0,0] neg_hi:[0,1,0]
v_pk_add_f32 v[72:73], v[60:61], v[76:77] neg_lo:[0,1] neg_hi:[0,1]
v_pk_add_f32 v[60:61], v[60:61], v[76:77]
v_pk_mul_f32 v[76:77], v[72:73], s[62:63] op_sel:[0,0] op_sel_hi:[0,1] neg_lo:[0,1] neg_hi:[0,1]
v_pk_fma_f32 v[76:77], v[72:73], s[62:63], v[76:77] op_sel:[1,1,0] op_sel_hi:[1,0,1] neg_lo:[0,0,0] neg_hi:[0,1,0]
v_pk_add_f32 v[72:73], v[62:63], v[78:79] neg_lo:[0,1] neg_hi:[0,1]
v_pk_add_f32 v[62:63], v[62:63], v[78:79]
v_pk_mul_f32 v[78:79], v[72:73], s[54:55] op_sel:[0,0] op_sel_hi:[0,1] neg_lo:[0,1] neg_hi:[0,1]
v_pk_fma_f32 v[78:79], v[72:73], s[54:55], v[78:79] op_sel:[1,1,0] op_sel_hi:[1,0,1] neg_lo:[0,0,0] neg_hi:[0,1,0]
v_pk_add_f32 v[72:73], v[16:17], v[24:25] neg_lo:[0,1] neg_hi:[0,1]
v_pk_add_f32 v[16:17], v[16:17], v[24:25]
v_pk_add_f32 v[24:25], v[18:19], v[26:27] neg_lo:[0,1] neg_hi:[0,1]
v_pk_add_f32 v[18:19], v[18:19], v[26:27]
v_pk_mul_f32 v[26:27], v[24:25], s[62:63] op_sel:[0,0] op_sel_hi:[0,1] neg_lo:[0,0] neg_hi:[0,1]
v_pk_fma_f32 v[26:27], v[24:25], s[62:63], v[26:27] op_sel:[1,1,0] op_sel_hi:[1,0,1] neg_lo:[0,0,0] neg_hi:[0,0,0]
v_pk_add_f32 v[24:25], v[20:21], v[28:29] op_sel:[1,1] op_sel_hi:[0,0] neg_lo:[0,1] neg_hi:[1,0]
v_pk_add_f32 v[20:21], v[20:21], v[28:29]
v_pk_add_f32 v[28:29], v[22:23], v[30:31] neg_lo:[0,1] neg_hi:[0,1]
v_pk_add_f32 v[22:23], v[22:23], v[30:31]
v_pk_mul_f32 v[30:31], v[28:29], s[62:63] op_sel:[0,0] op_sel_hi:[0,1] neg_lo:[0,1] neg_hi:[0,1]
v_pk_fma_f32 v[30:31], v[28:29], s[62:63], v[30:31] op_sel:[1,1,0] op_sel_hi:[1,0,1] neg_lo:[0,0,0] neg_hi:[0,1,0]
v_pk_add_f32 v[28:29], v[14:15], v[32:33] neg_lo:[0,1] neg_hi:[0,1]
v_pk_add_f32 v[14:15], v[14:15], v[32:33]
v_pk_add_f32 v[32:33], v[34:35], v[42:43] neg_lo:[0,1] neg_hi:[0,1]
v_pk_add_f32 v[34:35], v[34:35], v[42:43]
v_pk_mul_f32 v[42:43], v[32:33], s[62:63] op_sel:[0,0] op_sel_hi:[0,1] neg_lo:[0,0] neg_hi:[0,1]
v_pk_fma_f32 v[42:43], v[32:33], s[62:63], v[42:43] op_sel:[1,1,0] op_sel_hi:[1,0,1] neg_lo:[0,0,0] neg_hi:[0,0,0]
v_pk_add_f32 v[32:33], v[36:37], v[44:45] op_sel:[1,1] op_sel_hi:[0,0] neg_lo:[0,1] neg_hi:[1,0]
v_pk_add_f32 v[36:37], v[36:37], v[44:45]
v_pk_add_f32 v[44:45], v[38:39], v[46:47] neg_lo:[0,1] neg_hi:[0,1]
v_pk_add_f32 v[38:39], v[38:39], v[46:47]
v_pk_mul_f32 v[46:47], v[44:45], s[62:63] op_sel:[0,0] op_sel_hi:[0,1] neg_lo:[0,1] neg_hi:[0,1]
v_pk_fma_f32 v[46:47], v[44:45], s[62:63], v[46:47] op_sel:[1,1,0] op_sel_hi:[1,0,1] neg_lo:[0,0,0] neg_hi:[0,1,0]
v_pk_add_f32 v[44:45], v[48:49], v[56:57] neg_lo:[0,1] neg_hi:[0,1]
v_pk_add_f32 v[48:49], v[48:49], v[56:57]
v_pk_add_f32 v[56:57], v[50:51], v[58:59] neg_lo:[0,1] neg_hi:[0,1]
v_pk_add_f32 v[50:51], v[50:51], v[58:59]
v_pk_mul_f32 v[58:59], v[56:57], s[62:63] op_sel:[0,0] op_sel_hi:[0,1] neg_lo:[0,0] neg_hi:[0,1]
v_pk_fma_f32 v[58:59], v[56:57], s[62:63], v[58:59] op_sel:[1,1,0] op_sel_hi:[1,0,1] neg_lo:[0,0,0] neg_hi:[0,0,0]
v_pk_add_f32 v[56:57], v[52:53], v[60:61] op_sel:[1,1] op_sel_hi:[0,0] neg_lo:[0,1] neg_hi:[1,0]
v_pk_add_f32 v[52:53], v[52:53], v[60:61]
v_pk_add_f32 v[60:61], v[54:55], v[62:63] neg_lo:[0,1] neg_hi:[0,1]
v_pk_add_f32 v[54:55], v[54:55], v[62:63]
v_pk_mul_f32 v[62:63], v[60:61], s[62:63] op_sel:[0,0] op_sel_hi:[0,1] neg_lo:[0,1] neg_hi:[0,1]
v_pk_fma_f32 v[62:63], v[60:61], s[62:63], v[62:63] op_sel:[1,1,0] op_sel_hi:[1,0,1] neg_lo:[0,0,0] neg_hi:[0,1,0]
v_pk_add_f32 v[60:61], v[40:41], v[64:65] neg_lo:[0,1] neg_hi:[0,1]
v_pk_add_f32 v[40:41], v[40:41], v[64:65]
v_pk_add_f32 v[64:65], v[66:67], v[74:75] neg_lo:[0,1] neg_hi:[0,1]
v_pk_add_f32 v[66:67], v[66:67], v[74:75]
v_pk_mul_f32 v[74:75], v[64:65], s[62:63] op_sel:[0,0] op_sel_hi:[0,1] neg_lo:[0,0] neg_hi:[0,1]
v_pk_fma_f32 v[74:75], v[64:65], s[62:63], v[74:75] op_sel:[1,1,0] op_sel_hi:[1,0,1] neg_lo:[0,0,0] neg_hi:[0,0,0]
v_pk_add_f32 v[64:65], v[68:69], v[76:77] op_sel:[1,1] op_sel_hi:[0,0] neg_lo:[0,1] neg_hi:[1,0]
v_pk_add_f32 v[68:69], v[68:69], v[76:77]
v_pk_add_f32 v[76:77], v[70:71], v[78:79] neg_lo:[0,1] neg_hi:[0,1]
v_pk_add_f32 v[70:71], v[70:71], v[78:79]
v_pk_mul_f32 v[78:79], v[76:77], s[62:63] op_sel:[0,0] op_sel_hi:[0,1] neg_lo:[0,1] neg_hi:[0,1]
v_pk_fma_f32 v[78:79], v[76:77], s[62:63], v[78:79] op_sel:[1,1,0] op_sel_hi:[1,0,1] neg_lo:[0,0,0] neg_hi:[0,1,0]
v_pk_add_f32 v[76:77], v[16:17], v[20:21] neg_lo:[0,1] neg_hi:[0,1]
v_pk_add_f32 v[16:17], v[16:17], v[20:21]
v_pk_add_f32 v[20:21], v[18:19], v[22:23] op_sel:[1,1] op_sel_hi:[0,0] neg_lo:[0,1] neg_hi:[1,0]
v_pk_add_f32 v[18:19], v[18:19], v[22:23]
v_pk_add_f32 v[22:23], v[72:73], v[24:25] neg_lo:[0,1] neg_hi:[0,1]
v_pk_add_f32 v[72:73], v[72:73], v[24:25]
v_pk_add_f32 v[24:25], v[26:27], v[30:31] op_sel:[1,1] op_sel_hi:[0,0] neg_lo:[0,1] neg_hi:[1,0]
v_pk_add_f32 v[26:27], v[26:27], v[30:31]
v_pk_add_f32 v[30:31], v[14:15], v[36:37] neg_lo:[0,1] neg_hi:[0,1]
v_pk_add_f32 v[14:15], v[14:15], v[36:37]
v_pk_add_f32 v[36:37], v[34:35], v[38:39] op_sel:[1,1] op_sel_hi:[0,0] neg_lo:[0,1] neg_hi:[1,0]
v_pk_add_f32 v[34:35], v[34:35], v[38:39]
v_pk_add_f32 v[38:39], v[28:29], v[32:33] neg_lo:[0,1] neg_hi:[0,1]
v_pk_add_f32 v[28:29], v[28:29], v[32:33]
v_pk_add_f32 v[32:33], v[42:43], v[46:47] op_sel:[1,1] op_sel_hi:[0,0] neg_lo:[0,1] neg_hi:[1,0]
v_pk_add_f32 v[42:43], v[42:43], v[46:47]
v_pk_add_f32 v[46:47], v[48:49], v[52:53] neg_lo:[0,1] neg_hi:[0,1]
v_pk_add_f32 v[48:49], v[48:49], v[52:53]
v_pk_add_f32 v[52:53], v[50:51], v[54:55] op_sel:[1,1] op_sel_hi:[0,0] neg_lo:[0,1] neg_hi:[1,0]
v_pk_add_f32 v[50:51], v[50:51], v[54:55]
v_pk_add_f32 v[54:55], v[44:45], v[56:57] neg_lo:[0,1] neg_hi:[0,1]
v_pk_add_f32 v[44:45], v[44:45], v[56:57]
v_pk_add_f32 v[56:57], v[58:59], v[62:63] op_sel:[1,1] op_sel_hi:[0,0] neg_lo:[0,1] neg_hi:[1,0]
v_pk_add_f32 v[58:59], v[58:59], v[62:63]
v_pk_add_f32 v[62:63], v[40:41], v[68:69] neg_lo:[0,1] neg_hi:[0,1]
v_pk_add_f32 v[40:41], v[40:41], v[68:69]
v_pk_add_f32 v[68:69], v[66:67], v[70:71] op_sel:[1,1] op_sel_hi:[0,0] neg_lo:[0,1] neg_hi:[1,0]
v_pk_add_f32 v[66:67], v[66:67], v[70:71]
v_pk_add_f32 v[70:71], v[60:61], v[64:65] neg_lo:[0,1] neg_hi:[0,1]
v_pk_add_f32 v[60:61], v[60:61], v[64:65]
v_pk_add_f32 v[64:65], v[74:75], v[78:79] op_sel:[1,1] op_sel_hi:[0,0] neg_lo:[0,1] neg_hi:[1,0]
v_pk_add_f32 v[74:75], v[74:75], v[78:79]
v_pk_add_f32 v[78:79], v[16:17], v[18:19] neg_lo:[0,1] neg_hi:[0,1]
v_pk_add_f32 v[16:17], v[16:17], v[18:19]
v_pk_add_f32 v[18:19], v[76:77], v[20:21] neg_lo:[0,1] neg_hi:[0,1]
v_pk_add_f32 v[76:77], v[76:77], v[20:21]
v_pk_add_f32 v[20:21], v[72:73], v[26:27] neg_lo:[0,1] neg_hi:[0,1]
v_pk_add_f32 v[72:73], v[72:73], v[26:27]
v_pk_add_f32 v[26:27], v[22:23], v[24:25] neg_lo:[0,1] neg_hi:[0,1]
v_pk_add_f32 v[22:23], v[22:23], v[24:25]
v_pk_add_f32 v[24:25], v[14:15], v[34:35] neg_lo:[0,1] neg_hi:[0,1]
v_pk_add_f32 v[14:15], v[14:15], v[34:35]
v_pk_add_f32 v[34:35], v[30:31], v[36:37] neg_lo:[0,1] neg_hi:[0,1]
v_pk_add_f32 v[30:31], v[30:31], v[36:37]
v_pk_add_f32 v[36:37], v[28:29], v[42:43] neg_lo:[0,1] neg_hi:[0,1]
v_pk_add_f32 v[28:29], v[28:29], v[42:43]
v_pk_add_f32 v[42:43], v[38:39], v[32:33] neg_lo:[0,1] neg_hi:[0,1]
v_pk_add_f32 v[38:39], v[38:39], v[32:33]
v_pk_add_f32 v[32:33], v[48:49], v[50:51] neg_lo:[0,1] neg_hi:[0,1]
v_pk_add_f32 v[48:49], v[48:49], v[50:51]
v_pk_add_f32 v[50:51], v[46:47], v[52:53] neg_lo:[0,1] neg_hi:[0,1]
v_pk_add_f32 v[46:47], v[46:47], v[52:53]
v_pk_add_f32 v[52:53], v[44:45], v[58:59] neg_lo:[0,1] neg_hi:[0,1]
v_pk_add_f32 v[44:45], v[44:45], v[58:59]
v_pk_add_f32 v[58:59], v[54:55], v[56:57] neg_lo:[0,1] neg_hi:[0,1]
v_pk_add_f32 v[54:55], v[54:55], v[56:57]
v_pk_add_f32 v[56:57], v[40:41], v[66:67] neg_lo:[0,1] neg_hi:[0,1]
v_pk_add_f32 v[40:41], v[40:41], v[66:67]
v_pk_add_f32 v[66:67], v[62:63], v[68:69] neg_lo:[0,1] neg_hi:[0,1]
v_pk_add_f32 v[62:63], v[62:63], v[68:69]
v_pk_add_f32 v[68:69], v[60:61], v[74:75] neg_lo:[0,1] neg_hi:[0,1]
v_pk_add_f32 v[60:61], v[60:61], v[74:75]
v_pk_add_f32 v[74:75], v[70:71], v[64:65] neg_lo:[0,1] neg_hi:[0,1]
v_pk_add_f32 v[70:71], v[70:71], v[64:65]
v_pk_mul_f32 v[64:65], v[48:49], v[82:83] op_sel:[0,0] op_sel_hi:[0,1] neg_lo:[0,0] neg_hi:[0,0]
v_pk_fma_f32 v[48:49], v[48:49], v[82:83], v[64:65] op_sel:[1,1,0] op_sel_hi:[1,0,1] neg_lo:[0,1,0] neg_hi:[0,0,0]
v_pk_mul_f32 v[64:65], v[14:15], v[84:85] op_sel:[0,0] op_sel_hi:[0,1] neg_lo:[0,0] neg_hi:[0,0]
v_pk_fma_f32 v[14:15], v[14:15], v[84:85], v[64:65] op_sel:[1,1,0] op_sel_hi:[1,0,1] neg_lo:[0,1,0] neg_hi:[0,0,0]
v_pk_mul_f32 v[64:65], v[40:41], v[86:87] op_sel:[0,0] op_sel_hi:[0,1] neg_lo:[0,0] neg_hi:[0,0]
v_pk_fma_f32 v[40:41], v[40:41], v[86:87], v[64:65] op_sel:[1,1,0] op_sel_hi:[1,0,1] neg_lo:[0,1,0] neg_hi:[0,0,0]
v_pk_mul_f32 v[64:65], v[72:73], v[88:89] op_sel:[0,0] op_sel_hi:[0,1] neg_lo:[0,0] neg_hi:[0,0]
v_pk_fma_f32 v[72:73], v[72:73], v[88:89], v[64:65] op_sel:[1,1,0] op_sel_hi:[1,0,1] neg_lo:[0,1,0] neg_hi:[0,0,0]
v_pk_mul_f32 v[64:65], v[44:45], v[90:91] op_sel:[0,0] op_sel_hi:[0,1] neg_lo:[0,0] neg_hi:[0,0]
v_pk_fma_f32 v[44:45], v[44:45], v[90:91], v[64:65] op_sel:[1,1,0] op_sel_hi:[1,0,1] neg_lo:[0,1,0] neg_hi:[0,0,0]
v_pk_mul_f32 v[64:65], v[28:29], v[92:93] op_sel:[0,0] op_sel_hi:[0,1] neg_lo:[0,0] neg_hi:[0,0]
v_pk_fma_f32 v[28:29], v[28:29], v[92:93], v[64:65] op_sel:[1,1,0] op_sel_hi:[1,0,1] neg_lo:[0,1,0] neg_hi:[0,0,0]
v_pk_mul_f32 v[64:65], v[60:61], v[94:95] op_sel:[0,0] op_sel_hi:[0,1] neg_lo:[0,0] neg_hi:[0,0]
v_pk_fma_f32 v[60:61], v[60:61], v[94:95], v[64:65] op_sel:[1,1,0] op_sel_hi:[1,0,1] neg_lo:[0,1,0] neg_hi:[0,0,0]
v_pk_mul_f32 v[64:65], v[76:77], v[96:97] op_sel:[0,0] op_sel_hi:[0,1] neg_lo:[0,0] neg_hi:[0,0]
v_pk_fma_f32 v[76:77], v[76:77], v[96:97], v[64:65] op_sel:[1,1,0] op_sel_hi:[1,0,1] neg_lo:[0,1,0] neg_hi:[0,0,0]
v_pk_mul_f32 v[64:65], v[46:47], v[98:99] op_sel:[0,0] op_sel_hi:[0,1] neg_lo:[0,0] neg_hi:[0,0]
v_pk_fma_f32 v[46:47], v[46:47], v[98:99], v[64:65] op_sel:[1,1,0] op_sel_hi:[1,0,1] neg_lo:[0,1,0] neg_hi:[0,0,0]
v_pk_mul_f32 v[64:65], v[30:31], v[100:101] op_sel:[0,0] op_sel_hi:[0,1] neg_lo:[0,0] neg_hi:[0,0]
v_pk_fma_f32 v[30:31], v[30:31], v[100:101], v[64:65] op_sel:[1,1,0] op_sel_hi:[1,0,1] neg_lo:[0,1,0] neg_hi:[0,0,0]
v_pk_mul_f32 v[64:65], v[62:63], v[102:103] op_sel:[0,0] op_sel_hi:[0,1] neg_lo:[0,0] neg_hi:[0,0]
v_pk_fma_f32 v[62:63], v[62:63], v[102:103], v[64:65] op_sel:[1,1,0] op_sel_hi:[1,0,1] neg_lo:[0,1,0] neg_hi:[0,0,0]
v_pk_mul_f32 v[64:65], v[22:23], v[104:105] op_sel:[0,0] op_sel_hi:[0,1] neg_lo:[0,0] neg_hi:[0,0]
v_pk_fma_f32 v[22:23], v[22:23], v[104:105], v[64:65] op_sel:[1,1,0] op_sel_hi:[1,0,1] neg_lo:[0,1,0] neg_hi:[0,0,0]
v_pk_mul_f32 v[64:65], v[54:55], v[106:107] op_sel:[0,0] op_sel_hi:[0,1] neg_lo:[0,0] neg_hi:[0,0]
v_pk_fma_f32 v[54:55], v[54:55], v[106:107], v[64:65] op_sel:[1,1,0] op_sel_hi:[1,0,1] neg_lo:[0,1,0] neg_hi:[0,0,0]
v_pk_mul_f32 v[64:65], v[38:39], v[108:109] op_sel:[0,0] op_sel_hi:[0,1] neg_lo:[0,0] neg_hi:[0,0]
v_pk_fma_f32 v[38:39], v[38:39], v[108:109], v[64:65] op_sel:[1,1,0] op_sel_hi:[1,0,1] neg_lo:[0,1,0] neg_hi:[0,0,0]
v_pk_mul_f32 v[64:65], v[70:71], v[110:111] op_sel:[0,0] op_sel_hi:[0,1] neg_lo:[0,0] neg_hi:[0,0]
v_pk_fma_f32 v[70:71], v[70:71], v[110:111], v[64:65] op_sel:[1,1,0] op_sel_hi:[1,0,1] neg_lo:[0,1,0] neg_hi:[0,0,0]
v_pk_mul_f32 v[64:65], v[78:79], v[112:113] op_sel:[0,0] op_sel_hi:[0,1] neg_lo:[0,0] neg_hi:[0,0]
v_pk_fma_f32 v[78:79], v[78:79], v[112:113], v[64:65] op_sel:[1,1,0] op_sel_hi:[1,0,1] neg_lo:[0,1,0] neg_hi:[0,0,0]
v_pk_mul_f32 v[64:65], v[32:33], v[114:115] op_sel:[0,0] op_sel_hi:[0,1] neg_lo:[0,0] neg_hi:[0,0]
v_pk_fma_f32 v[32:33], v[32:33], v[114:115], v[64:65] op_sel:[1,1,0] op_sel_hi:[1,0,1] neg_lo:[0,1,0] neg_hi:[0,0,0]
v_pk_mul_f32 v[64:65], v[24:25], v[116:117] op_sel:[0,0] op_sel_hi:[0,1] neg_lo:[0,0] neg_hi:[0,0]
v_pk_fma_f32 v[24:25], v[24:25], v[116:117], v[64:65] op_sel:[1,1,0] op_sel_hi:[1,0,1] neg_lo:[0,1,0] neg_hi:[0,0,0]
v_pk_mul_f32 v[64:65], v[56:57], v[118:119] op_sel:[0,0] op_sel_hi:[0,1] neg_lo:[0,0] neg_hi:[0,0]
v_pk_fma_f32 v[56:57], v[56:57], v[118:119], v[64:65] op_sel:[1,1,0] op_sel_hi:[1,0,1] neg_lo:[0,1,0] neg_hi:[0,0,0]
v_pk_mul_f32 v[64:65], v[20:21], v[120:121] op_sel:[0,0] op_sel_hi:[0,1] neg_lo:[0,0] neg_hi:[0,0]
v_pk_fma_f32 v[20:21], v[20:21], v[120:121], v[64:65] op_sel:[1,1,0] op_sel_hi:[1,0,1] neg_lo:[0,1,0] neg_hi:[0,0,0]
v_pk_mul_f32 v[64:65], v[52:53], v[122:123] op_sel:[0,0] op_sel_hi:[0,1] neg_lo:[0,0] neg_hi:[0,0]
v_pk_fma_f32 v[52:53], v[52:53], v[122:123], v[64:65] op_sel:[1,1,0] op_sel_hi:[1,0,1] neg_lo:[0,1,0] neg_hi:[0,0,0]
v_pk_mul_f32 v[64:65], v[36:37], v[124:125] op_sel:[0,0] op_sel_hi:[0,1] neg_lo:[0,0] neg_hi:[0,0]
v_pk_fma_f32 v[36:37], v[36:37], v[124:125], v[64:65] op_sel:[1,1,0] op_sel_hi:[1,0,1] neg_lo:[0,1,0] neg_hi:[0,0,0]
v_pk_mul_f32 v[64:65], v[68:69], v[126:127] op_sel:[0,0] op_sel_hi:[0,1] neg_lo:[0,0] neg_hi:[0,0]
v_pk_fma_f32 v[68:69], v[68:69], v[126:127], v[64:65] op_sel:[1,1,0] op_sel_hi:[1,0,1] neg_lo:[0,1,0] neg_hi:[0,0,0]
v_pk_mul_f32 v[64:65], v[18:19], v[128:129] op_sel:[0,0] op_sel_hi:[0,1] neg_lo:[0,0] neg_hi:[0,0]
v_pk_fma_f32 v[18:19], v[18:19], v[128:129], v[64:65] op_sel:[1,1,0] op_sel_hi:[1,0,1] neg_lo:[0,1,0] neg_hi:[0,0,0]
v_pk_mul_f32 v[64:65], v[50:51], v[130:131] op_sel:[0,0] op_sel_hi:[0,1] neg_lo:[0,0] neg_hi:[0,0]
v_pk_fma_f32 v[50:51], v[50:51], v[130:131], v[64:65] op_sel:[1,1,0] op_sel_hi:[1,0,1] neg_lo:[0,1,0] neg_hi:[0,0,0]
v_pk_mul_f32 v[64:65], v[34:35], v[132:133] op_sel:[0,0] op_sel_hi:[0,1] neg_lo:[0,0] neg_hi:[0,0]
v_pk_fma_f32 v[34:35], v[34:35], v[132:133], v[64:65] op_sel:[1,1,0] op_sel_hi:[1,0,1] neg_lo:[0,1,0] neg_hi:[0,0,0]
v_pk_mul_f32 v[64:65], v[66:67], v[134:135] op_sel:[0,0] op_sel_hi:[0,1] neg_lo:[0,0] neg_hi:[0,0]
v_pk_fma_f32 v[66:67], v[66:67], v[134:135], v[64:65] op_sel:[1,1,0] op_sel_hi:[1,0,1] neg_lo:[0,1,0] neg_hi:[0,0,0]
v_pk_mul_f32 v[64:65], v[26:27], v[136:137] op_sel:[0,0] op_sel_hi:[0,1] neg_lo:[0,0] neg_hi:[0,0]
v_pk_fma_f32 v[26:27], v[26:27], v[136:137], v[64:65] op_sel:[1,1,0] op_sel_hi:[1,0,1] neg_lo:[0,1,0] neg_hi:[0,0,0]
v_pk_mul_f32 v[64:65], v[58:59], v[138:139] op_sel:[0,0] op_sel_hi:[0,1] neg_lo:[0,0] neg_hi:[0,0]
v_pk_fma_f32 v[58:59], v[58:59], v[138:139], v[64:65] op_sel:[1,1,0] op_sel_hi:[1,0,1] neg_lo:[0,1,0] neg_hi:[0,0,0]
v_pk_mul_f32 v[64:65], v[42:43], v[140:141] op_sel:[0,0] op_sel_hi:[0,1] neg_lo:[0,0] neg_hi:[0,0]
v_pk_fma_f32 v[42:43], v[42:43], v[140:141], v[64:65] op_sel:[1,1,0] op_sel_hi:[1,0,1] neg_lo:[0,1,0] neg_hi:[0,0,0]
v_pk_mul_f32 v[64:65], v[74:75], v[142:143] op_sel:[0,0] op_sel_hi:[0,1] neg_lo:[0,0] neg_hi:[0,0]
v_pk_fma_f32 v[74:75], v[74:75], v[142:143], v[64:65] op_sel:[1,1,0] op_sel_hi:[1,0,1] neg_lo:[0,1,0] neg_hi:[0,0,0]
s_barrier
ds_write_b64 v4, v[16:17] offset:0
ds_write_b64 v4, v[48:49] offset:264
ds_write_b64 v4, v[14:15] offset:528
ds_write_b64 v4, v[40:41] offset:792
ds_write_b64 v4, v[72:73] offset:1056
ds_write_b64 v4, v[44:45] offset:1320
ds_write_b64 v4, v[28:29] offset:1584
ds_write_b64 v4, v[60:61] offset:1848
ds_write_b64 v4, v[76:77] offset:2112
ds_write_b64 v4, v[46:47] offset:2376
ds_write_b64 v4, v[30:31] offset:2640
ds_write_b64 v4, v[62:63] offset:2904
ds_write_b64 v4, v[22:23] offset:3168
ds_write_b64 v4, v[54:55] offset:3432
ds_write_b64 v4, v[38:39] offset:3696
ds_write_b64 v4, v[70:71] offset:3960
ds_write_b64 v4, v[78:79] offset:4224
ds_write_b64 v4, v[32:33] offset:4488
ds_write_b64 v4, v[24:25] offset:4752
ds_write_b64 v4, v[56:57] offset:5016
ds_write_b64 v4, v[20:21] offset:5280
ds_write_b64 v4, v[52:53] offset:5544
ds_write_b64 v4, v[36:37] offset:5808
ds_write_b64 v4, v[68:69] offset:6072
ds_write_b64 v4, v[18:19] offset:6336
ds_write_b64 v4, v[50:51] offset:6600
ds_write_b64 v4, v[34:35] offset:6864
ds_write_b64 v4, v[66:67] offset:7128
ds_write_b64 v4, v[26:27] offset:7392
ds_write_b64 v4, v[58:59] offset:7656
ds_write_b64 v4, v[42:43] offset:7920
ds_write_b64 v4, v[74:75] offset:8184
s_waitcnt lgkmcnt(0)
ds_read_b64 v[16:17], v5 offset:0
ds_read_b64 v[48:49], v5 offset:128
ds_read_b64 v[18:19], v5 offset:8
ds_read_b64 v[50:51], v5 offset:136
ds_read_b64 v[20:21], v5 offset:16
ds_read_b64 v[52:53], v5 offset:144
ds_read_b64 v[22:23], v5 offset:24
ds_read_b64 v[54:55], v5 offset:152
ds_read_b64 v[24:25], v5 offset:32
ds_read_b64 v[56:57], v5 offset:160
ds_read_b64 v[26:27], v5 offset:40
ds_read_b64 v[58:59], v5 offset:168
ds_read_b64 v[28:29], v5 offset:48
ds_read_b64 v[60:61], v5 offset:176
ds_read_b64 v[30:31], v5 offset:56
ds_read_b64 v[62:63], v5 offset:184
ds_read_b64 v[32:33], v5 offset:64
ds_read_b64 v[64:65], v5 offset:192
ds_read_b64 v[34:35], v5 offset:72
ds_read_b64 v[66:67], v5 offset:200
ds_read_b64 v[36:37], v5 offset:80
ds_read_b64 v[68:69], v5 offset:208
ds_read_b64 v[38:39], v5 offset:88
ds_read_b64 v[70:71], v5 offset:216
ds_read_b64 v[40:41], v5 offset:96
ds_read_b64 v[72:73], v5 offset:224
ds_read_b64 v[42:43], v5 offset:104
ds_read_b64 v[74:75], v5 offset:232
ds_read_b64 v[44:45], v5 offset:112
ds_read_b64 v[76:77], v5 offset:240
ds_read_b64 v[46:47], v5 offset:120
ds_read_b64 v[78:79], v5 offset:248
s_waitcnt lgkmcnt(0)
v_pk_add_f32 v[14:15], v[16:17], v[48:49] neg_lo:[0,1] neg_hi:[0,1]
v_pk_add_f32 v[16:17], v[16:17], v[48:49]
v_pk_add_f32 v[48:49], v[18:19], v[50:51] neg_lo:[0,1] neg_hi:[0,1]
v_pk_add_f32 v[18:19], v[18:19], v[50:51]
v_pk_mul_f32 v[50:51], v[48:49], s[50:51] op_sel:[0,0] op_sel_hi:[0,1] neg_lo:[0,0] neg_hi:[0,1]
v_pk_fma_f32 v[50:51], v[48:49], s[50:51], v[50:51] op_sel:[1,1,0] op_sel_hi:[1,0,1] neg_lo:[0,0,0] neg_hi:[0,0,0]
v_pk_add_f32 v[48:49], v[20:21], v[52:53] neg_lo:[0,1] neg_hi:[0,1]
v_pk_add_f32 v[20:21], v[20:21], v[52:53]
v_pk_mul_f32 v[52:53], v[48:49], s[54:55] op_sel:[0,0] op_sel_hi:[0,1] neg_lo:[0,0] neg_hi:[0,1]
v_pk_fma_f32 v[52:53], v[48:49], s[54:55], v[52:53] op_sel:[1,1,0] op_sel_hi:[1,0,1] neg_lo:[0,0,0] neg_hi:[0,0,0]
v_pk_add_f32 v[48:49], v[22:23], v[54:55] neg_lo:[0,1] neg_hi:[0,1]
v_pk_add_f32 v[22:23], v[22:23], v[54:55]
v_pk_mul_f32 v[54:55], v[48:49], s[58:59] op_sel:[0,0] op_sel_hi:[0,1] neg_lo:[0,0] neg_hi:[0,1]
v_pk_fma_f32 v[54:55], v[48:49], s[58:59], v[54:55] op_sel:[1,1,0] op_sel_hi:[1,0,1] neg_lo:[0,0,0] neg_hi:[0,0,0]
v_pk_add_f32 v[48:49], v[24:25], v[56:57] neg_lo:[0,1] neg_hi:[0,1]
v_pk_add_f32 v[24:25], v[24:25], v[56:57]
v_pk_mul_f32 v[56:57], v[48:49], s[62:63] op_sel:[0,0] op_sel_hi:[0,1] neg_lo:[0,0] neg_hi:[0,1]
v_pk_fma_f32 v[56:57], v[48:49], s[62:63], v[56:57] op_sel:[1,1,0] op_sel_hi:[1,0,1] neg_lo:[0,0,0] neg_hi:[0,0,0]
v_pk_add_f32 v[48:49], v[26:27], v[58:59] neg_lo:[0,1] neg_hi:[0,1]
v_pk_add_f32 v[26:27], v[26:27], v[58:59]
v_pk_mul_f32 v[58:59], v[48:49], s[58:59] op_sel:[0,1] op_sel_hi:[0,0] neg_lo:[0,0] neg_hi:[0,1]
v_pk_fma_f32 v[58:59], v[48:49], s[58:59], v[58:59] op_sel:[1,0,0] op_sel_hi:[1,1,1] neg_lo:[0,0,0] neg_hi:[0,0,0]
v_pk_add_f32 v[48:49], v[28:29], v[60:61] neg_lo:[0,1] neg_hi:[0,1]
v_pk_add_f32 v[28:29], v[28:29], v[60:61]
v_pk_mul_f32 v[60:61], v[48:49], s[54:55] op_sel:[0,1] op_sel_hi:[0,0] neg_lo:[0,0] neg_hi:[0,1]
v_pk_fma_f32 v[60:61], v[48:49], s[54:55], v[60:61] op_sel:[1,0,0] op_sel_hi:[1,1,1] neg_lo:[0,0,0] neg_hi:[0,0,0]
v_pk_add_f32 v[48:49], v[30:31], v[62:63] neg_lo:[0,1] neg_hi:[0,1]
v_pk_add_f32 v[30:31], v[30:31], v[62:63]
v_pk_mul_f32 v[62:63], v[48:49], s[50:51] op_sel:[0,1] op_sel_hi:[0,0] neg_lo:[0,0] neg_hi:[0,1]
v_pk_fma_f32 v[62:63], v[48:49], s[50:51], v[62:63] op_sel:[1,0,0] op_sel_hi:[1,1,1] neg_lo:[0,0,0] neg_hi:[0,0,0]
v_pk_add_f32 v[48:49], v[32:33], v[64:65] op_sel:[1,1] op_sel_hi:[0,0] neg_lo:[0,1] neg_hi:[1,0]
v_pk_add_f32 v[32:33], v[32:33], v[64:65]
v_pk_add_f32 v[64:65], v[34:35], v[66:67] neg_lo:[0,1] neg_hi:[0,1]
v_pk_add_f32 v[34:35], v[34:35], v[66:67]
v_pk_mul_f32 v[66:67], v[64:65], s[50:51] op_sel:[0,1] op_sel_hi:[0,0] neg_lo:[0,1] neg_hi:[0,1]
v_pk_fma_f32 v[66:67], v[64:65], s[50:51], v[66:67] op_sel:[1,0,0] op_sel_hi:[1,1,1] neg_lo:[0,0,0] neg_hi:[0,1,0]
v_pk_add_f32 v[64:65], v[36:37], v[68:69] neg_lo:[0,1] neg_hi:[0,1]
v_pk_add_f32 v[36:37], v[36:37], v[68:69]
v_pk_mul_f32 v[68:69], v[64:65], s[54:55] op_sel:[0,1] op_sel_hi:[0,0] neg_lo:[0,1] neg_hi:[0,1]
v_pk_fma_f32 v[68:69], v[64:65], s[54:55], v[68:69] op_sel:[1,0,0] op_sel_hi:[1,1,1] neg_lo:[0,0,0] neg_hi:[0,1,0]
v_pk_add_f32 v[64:65], v[38:39], v[70:71] neg_lo:[0,1] neg_hi:[0,1]
v_pk_add_f32 v[38:39], v[38:39], v[70:71]
v_pk_mul_f32 v[70:71], v[64:65], s[58:59] op_sel:[0,1] op_sel_hi:[0,0] neg_lo:[0,1] neg_hi:[0,1]
v_pk_fma_f32 v[70:71], v[64:65], s[58:59], v[70:71] op_sel:[1,0,0] op_sel_hi:[1,1,1] neg_lo:[0,0,0] neg_hi:[0,1,0]
v_pk_add_f32 v[64:65], v[40:41], v[72:73] neg_lo:[0,1] neg_hi:[0,1]
v_pk_add_f32 v[40:41], v[40:41], v[72:73]
v_pk_mul_f32 v[72:73], v[64:65], s[62:63] op_sel:[0,0] op_sel_hi:[0,1] neg_lo:[0,1] neg_hi:[0,1]
v_pk_fma_f32 v[72:73], v[64:65], s[62:63], v[72:73] op_sel:[1,1,0] op_sel_hi:[1,0,1] neg_lo:[0,0,0] neg_hi:[0,1,0]
v_pk_add_f32 v[64:65], v[42:43], v[74:75] neg_lo:[0,1] neg_hi:[0,1]
v_pk_add_f32 v[42:43], v[42:43], v[74:75]
v_pk_mul_f32 v[74:75], v[64:65], s[58:59] op_sel:[0,0] op_sel_hi:[0,1] neg_lo:[0,1] neg_hi:[0,1]
v_pk_fma_f32 v[74:75], v[64:65], s[58:59], v[74:75] op_sel:[1,1,0] op_sel_hi:[1,0,1] neg_lo:[0,0,0] neg_hi:[0,1,0]
v_pk_add_f32 v[64:65], v[44:45], v[76:77] neg_lo:[0,1] neg_hi:[0,1]
v_pk_add_f32 v[44:45], v[44:45], v[76:77]
v_pk_mul_f32 v[76:77], v[64:65], s[54:55] op_sel:[0,0] op_sel_hi:[0,1] neg_lo:[0,1] neg_hi:[0,1]
v_pk_fma_f32 v[76:77], v[64:65], s[54:55], v[76:77] op_sel:[1,1,0] op_sel_hi:[1,0,1] neg_lo:[0,0,0] neg_hi:[0,1,0]
v_pk_add_f32 v[64:65], v[46:47], v[78:79] neg_lo:[0,1] neg_hi:[0,1]
v_pk_add_f32 v[46:47], v[46:47], v[78:79]
v_pk_mul_f32 v[78:79], v[64:65], s[50:51] op_sel:[0,0] op_sel_hi:[0,1] neg_lo:[0,1] neg_hi:[0,1]
v_pk_fma_f32 v[78:79], v[64:65], s[50:51], v[78:79] op_sel:[1,1,0] op_sel_hi:[1,0,1] neg_lo:[0,0,0] neg_hi:[0,1,0]
v_pk_add_f32 v[64:65], v[16:17], v[32:33] neg_lo:[0,1] neg_hi:[0,1]
v_pk_add_f32 v[16:17], v[16:17], v[32:33]
v_pk_add_f32 v[32:33], v[18:19], v[34:35] neg_lo:[0,1] neg_hi:[0,1]
v_pk_add_f32 v[18:19], v[18:19], v[34:35]
v_pk_mul_f32 v[34:35], v[32:33], s[54:55] op_sel:[0,0] op_sel_hi:[0,1] neg_lo:[0,0] neg_hi:[0,1]
v_pk_fma_f32 v[34:35], v[32:33], s[54:55], v[34:35] op_sel:[1,1,0] op_sel_hi:[1,0,1] neg_lo:[0,0,0] neg_hi:[0,0,0]
v_pk_add_f32 v[32:33], v[20:21], v[36:37] neg_lo:[0,1] neg_hi:[0,1]
v_pk_add_f32 v[20:21], v[20:21], v[36:37]
v_pk_mul_f32 v[36:37], v[32:33], s[62:63] op_sel:[0,0] op_sel_hi:[0,1] neg_lo:[0,0] neg_hi:[0,1]
v_pk_fma_f32 v[36:37], v[32:33], s[62:63], v[36:37] op_sel:[1,1,0] op_sel_hi:[1,0,1] neg_lo:[0,0,0] neg_hi:[0,0,0]
v_pk_add_f32 v[32:33], v[22:23], v[38:39] neg_lo:[0,1] neg_hi:[0,1]
v_pk_add_f32 v[22:23], v[22:23], v[38:39]
v_pk_mul_f32 v[38:39], v[32:33], s[54:55] op_sel:[0,1] op_sel_hi:[0,0] neg_lo:[0,0] neg_hi:[0,1]
v_pk_fma_f32 v[38:39], v[32:33], s[54:55], v[38:39] op_sel:[1,0,0] op_sel_hi:[1,1,1] neg_lo:[0,0,0] neg_hi:[0,0,0]
v_pk_add_f32 v[32:33], v[24:25], v[40:41] op_sel:[1,1] op_sel_hi:[0,0] neg_lo:[0,1] neg_hi:[1,0]
v_pk_add_f32 v[24:25], v[24:25], v[40:41]
v_pk_add_f32 v[40:41], v[26:27], v[42:43] neg_lo:[0,1] neg_hi:[0,1]
v_pk_add_f32 v[26:27], v[26:27], v[42:43]
v_pk_mul_f32 v[42:43], v[40:41], s[54:55] op_sel:[0,1] op_sel_hi:[0,0] neg_lo:[0,1] neg_hi:[0,1]
v_pk_fma_f32 v[42:43], v[40:41], s[54:55], v[42:43] op_sel:[1,0,0] op_sel_hi:[1,1,1] neg_lo:[0,0,0] neg_hi:[0,1,0]
v_pk_add_f32 v[40:41], v[28:29], v[44:45] neg_lo:[0,1] neg_hi:[0,1]
v_pk_add_f32 v[28:29], v[28:29], v[44:45]
v_pk_mul_f32 v[44:45], v[40:41], s[62:63] op_sel:[0,0] op_sel_hi:[0,1] neg_lo:[0,1] neg_hi:[0,1]
v_pk_fma_f32 v[44:45], v[40:41], s[62:63], v[44:45] op_sel:[1,1,0] op_sel_hi:[1,0,1] neg_lo:[0,0,0] neg_hi:[0,1,0]
v_pk_add_f32 v[40:41], v[30:31], v[46:47] neg_lo:[0,1] neg_hi:[0,1]
v_pk_add_f32 v[30:31], v[30:31], v[46:47]
v_pk_mul_f32 v[46:47], v[40:41], s[54:55] op_sel:[0,0] op_sel_hi:[0,1] neg_lo:[0,1] neg_hi:[0,1]
v_pk_fma_f32 v[46:47], v[40:41], s[54:55], v[46:47] op_sel:[1,1,0] op_sel_hi:[1,0,1] neg_lo:[0,0,0] neg_hi:[0,1,0]
v_pk_add_f32 v[40:41], v[14:15], v[48:49] neg_lo:[0,1] neg_hi:[0,1]
v_pk_add_f32 v[14:15], v[14:15], v[48:49]
v_pk_add_f32 v[48:49], v[50:51], v[66:67] neg_lo:[0,1] neg_hi:[0,1]
v_pk_add_f32 v[50:51], v[50:51], v[66:67]
v_pk_mul_f32 v[66:67], v[48:49], s[54:55] op_sel:[0,0] op_sel_hi:[0,1] neg_lo:[0,0] neg_hi:[0,1]
v_pk_fma_f32 v[66:67], v[48:49], s[54:55], v[66:67] op_sel:[1,1,0] op_sel_hi:[1,0,1] neg_lo:[0,0,0] neg_hi:[0,0,0]
v_pk_add_f32 v[48:49], v[52:53], v[68:69] neg_lo:[0,1] neg_hi:[0,1]
v_pk_add_f32 v[52:53], v[52:53], v[68:69]
v_pk_mul_f32 v[68:69], v[48:49], s[62:63] op_sel:[0,0] op_sel_hi:[0,1] neg_lo:[0,0] neg_hi:[0,1]
v_pk_fma_f32 v[68:69], v[48:49], s[62:63], v[68:69] op_sel:[1,1,0] op_sel_hi:[1,0,1] neg_lo:[0,0,0] neg_hi:[0,0,0]
v_pk_add_f32 v[48:49], v[54:55], v[70:71] neg_lo:[0,1] neg_hi:[0,1]
v_pk_add_f32 v[54:55], v[54:55], v[70:71]
v_pk_mul_f32 v[70:71], v[48:49], s[54:55] op_sel:[0,1] op_sel_hi:[0,0] neg_lo:[0,0] neg_hi:[0,1]
v_pk_fma_f32 v[70:71], v[48:49], s[54:55], v[70:71] op_sel:[1,0,0] op_sel_hi:[1,1,1] neg_lo:[0,0,0] neg_hi:[0,0,0]
v_pk_add_f32 v[48:49], v[56:57], v[72:73] op_sel:[1,1] op_sel_hi:[0,0] neg_lo:[0,1] neg_hi:[1,0]
v_pk_add_f32 v[56:57], v[56:57], v[72:73]
v_pk_add_f32 v[72:73], v[58:59], v[74:75] neg_lo:[0,1] neg_hi:[0,1]
v_pk_add_f32 v[58:59], v[58:59], v[74:75]
v_pk_mul_f32 v[74:75], v[72:73], s[54:55] op_sel:[0,1] op_sel_hi:[0,0] neg_lo:[0,1] neg_hi:[0,1]
v_pk_fma_f32 v[74:75], v[72:73], s[54:55], v[74:75] op_sel:[1,0,0] op_sel_hi:[1,1,1] neg_lo:[0,0,0] neg_hi:[0,1,0]
v_pk_add_f32 v[72:73], v[60:61], v[76:77] neg_lo:[0,1] neg_hi:[0,1]
v_pk_add_f32 v[60:61], v[60:61], v[76:77]
v_pk_mul_f32 v[76:77], v[72:73], s[62:63] op_sel:[0,0] op_sel_hi:[0,1] neg_lo:[0,1] neg_hi:[0,1]
v_pk_fma_f32 v[76:77], v[72:73], s[62:63], v[76:77] op_sel:[1,1,0] op_sel_hi:[1,0,1] neg_lo:[0,0,0] neg_hi:[0,1,0]
v_pk_add_f32 v[72:73], v[62:63], v[78:79] neg_lo:[0,1] neg_hi:[0,1]
v_pk_add_f32 v[62:63], v[62:63], v[78:79]
v_pk_mul_f32 v[78:79], v[72:73], s[54:55] op_sel:[0,0] op_sel_hi:[0,1] neg_lo:[0,1] neg_hi:[0,1]
v_pk_fma_f32 v[78:79], v[72:73], s[54:55], v[78:79] op_sel:[1,1,0] op_sel_hi:[1,0,1] neg_lo:[0,0,0] neg_hi:[0,1,0]
v_pk_add_f32 v[72:73], v[16:17], v[24:25] neg_lo:[0,1] neg_hi:[0,1]
v_pk_add_f32 v[16:17], v[16:17], v[24:25]
v_pk_add_f32 v[24:25], v[18:19], v[26:27] neg_lo:[0,1] neg_hi:[0,1]
v_pk_add_f32 v[18:19], v[18:19], v[26:27]
v_pk_mul_f32 v[26:27], v[24:25], s[62:63] op_sel:[0,0] op_sel_hi:[0,1] neg_lo:[0,0] neg_hi:[0,1]
v_pk_fma_f32 v[26:27], v[24:25], s[62:63], v[26:27] op_sel:[1,1,0] op_sel_hi:[1,0,1] neg_lo:[0,0,0] neg_hi:[0,0,0]
v_pk_add_f32 v[24:25], v[20:21], v[28:29] op_sel:[1,1] op_sel_hi:[0,0] neg_lo:[0,1] neg_hi:[1,0]
v_pk_add_f32 v[20:21], v[20:21], v[28:29]
v_pk_add_f32 v[28:29], v[22:23], v[30:31] neg_lo:[0,1] neg_hi:[0,1]
v_pk_add_f32 v[22:23], v[22:23], v[30:31]
v_pk_mul_f32 v[30:31], v[28:29], s[62:63] op_sel:[0,0] op_sel_hi:[0,1] neg_lo:[0,1] neg_hi:[0,1]
v_pk_fma_f32 v[30:31], v[28:29], s[62:63], v[30:31] op_sel:[1,1,0] op_sel_hi:[1,0,1] neg_lo:[0,0,0] neg_hi:[0,1,0]
v_pk_add_f32 v[28:29], v[64:65], v[32:33] neg_lo:[0,1] neg_hi:[0,1]
v_pk_add_f32 v[64:65], v[64:65], v[32:33]
v_pk_add_f32 v[32:33], v[34:35], v[42:43] neg_lo:[0,1] neg_hi:[0,1]
v_pk_add_f32 v[34:35], v[34:35], v[42:43]
v_pk_mul_f32 v[42:43], v[32:33], s[62:63] op_sel:[0,0] op_sel_hi:[0,1] neg_lo:[0,0] neg_hi:[0,1]
v_pk_fma_f32 v[42:43], v[32:33], s[62:63], v[42:43] op_sel:[1,1,0] op_sel_hi:[1,0,1] neg_lo:[0,0,0] neg_hi:[0,0,0]
v_pk_add_f32 v[32:33], v[36:37], v[44:45] op_sel:[1,1] op_sel_hi:[0,0] neg_lo:[0,1] neg_hi:[1,0]
v_pk_add_f32 v[36:37], v[36:37], v[44:45]
v_pk_add_f32 v[44:45], v[38:39], v[46:47] neg_lo:[0,1] neg_hi:[0,1]
v_pk_add_f32 v[38:39], v[38:39], v[46:47]
v_pk_mul_f32 v[46:47], v[44:45], s[62:63] op_sel:[0,0] op_sel_hi:[0,1] neg_lo:[0,1] neg_hi:[0,1]
v_pk_fma_f32 v[46:47], v[44:45], s[62:63], v[46:47] op_sel:[1,1,0] op_sel_hi:[1,0,1] neg_lo:[0,0,0] neg_hi:[0,1,0]
v_pk_add_f32 v[44:45], v[14:15], v[56:57] neg_lo:[0,1] neg_hi:[0,1]
v_pk_add_f32 v[14:15], v[14:15], v[56:57]
v_pk_add_f32 v[56:57], v[50:51], v[58:59] neg_lo:[0,1] neg_hi:[0,1]
v_pk_add_f32 v[50:51], v[50:51], v[58:59]
v_pk_mul_f32 v[58:59], v[56:57], s[62:63] op_sel:[0,0] op_sel_hi:[0,1] neg_lo:[0,0] neg_hi:[0,1]
v_pk_fma_f32 v[58:59], v[56:57], s[62:63], v[58:59] op_sel:[1,1,0] op_sel_hi:[1,0,1] neg_lo:[0,0,0] neg_hi:[0,0,0]
v_pk_add_f32 v[56:57], v[52:53], v[60:61] op_sel:[1,1] op_sel_hi:[0,0] neg_lo:[0,1] neg_hi:[1,0]
v_pk_add_f32 v[52:53], v[52:53], v[60:61]
v_pk_add_f32 v[60:61], v[54:55], v[62:63] neg_lo:[0,1] neg_hi:[0,1]
v_pk_add_f32 v[54:55], v[54:55], v[62:63]
v_pk_mul_f32 v[62:63], v[60:61], s[62:63] op_sel:[0,0] op_sel_hi:[0,1] neg_lo:[0,1] neg_hi:[0,1]
v_pk_fma_f32 v[62:63], v[60:61], s[62:63], v[62:63] op_sel:[1,1,0] op_sel_hi:[1,0,1] neg_lo:[0,0,0] neg_hi:[0,1,0]
v_pk_add_f32 v[60:61], v[40:41], v[48:49] neg_lo:[0,1] neg_hi:[0,1]
v_pk_add_f32 v[40:41], v[40:41], v[48:49]
v_pk_add_f32 v[48:49], v[66:67], v[74:75] neg_lo:[0,1] neg_hi:[0,1]
v_pk_add_f32 v[66:67], v[66:67], v[74:75]
v_pk_mul_f32 v[74:75], v[48:49], s[62:63] op_sel:[0,0] op_sel_hi:[0,1] neg_lo:[0,0] neg_hi:[0,1]
v_pk_fma_f32 v[74:75], v[48:49], s[62:63], v[74:75] op_sel:[1,1,0] op_sel_hi:[1,0,1] neg_lo:[0,0,0] neg_hi:[0,0,0]
v_pk_add_f32 v[48:49], v[68:69], v[76:77] op_sel:[1,1] op_sel_hi:[0,0] neg_lo:[0,1] neg_hi:[1,0]
v_pk_add_f32 v[68:69], v[68:69], v[76:77]
v_pk_add_f32 v[76:77], v[70:71], v[78:79] neg_lo:[0,1] neg_hi:[0,1]
v_pk_add_f32 v[70:71], v[70:71], v[78:79]
v_pk_mul_f32 v[78:79], v[76:77], s[62:63] op_sel:[0,0] op_sel_hi:[0,1] neg_lo:[0,1] neg_hi:[0,1]
v_pk_fma_f32 v[78:79], v[76:77], s[62:63], v[78:79] op_sel:[1,1,0] op_sel_hi:[1,0,1] neg_lo:[0,0,0] neg_hi:[0,1,0]
v_pk_add_f32 v[76:77], v[16:17], v[20:21] neg_lo:[0,1] neg_hi:[0,1]
v_pk_add_f32 v[16:17], v[16:17], v[20:21]
v_pk_add_f32 v[20:21], v[18:19], v[22:23] op_sel:[1,1] op_sel_hi:[0,0] neg_lo:[0,1] neg_hi:[1,0]
v_pk_add_f32 v[18:19], v[18:19], v[22:23]
v_pk_add_f32 v[22:23], v[72:73], v[24:25] neg_lo:[0,1] neg_hi:[0,1]
v_pk_add_f32 v[72:73], v[72:73], v[24:25]
v_pk_add_f32 v[24:25], v[26:27], v[30:31] op_sel:[1,1] op_sel_hi:[0,0] neg_lo:[0,1] neg_hi:[1,0]
v_pk_add_f32 v[26:27], v[26:27], v[30:31]
v_pk_add_f32 v[30:31], v[64:65], v[36:37] neg_lo:[0,1] neg_hi:[0,1]
v_pk_add_f32 v[64:65], v[64:65], v[36:37]
v_pk_add_f32 v[36:37], v[34:35], v[38:39] op_sel:[1,1] op_sel_hi:[0,0] neg_lo:[0,1] neg_hi:[1,0]
v_pk_add_f32 v[34:35], v[34:35], v[38:39]
v_pk_add_f32 v[38:39], v[28:29], v[32:33] neg_lo:[0,1] neg_hi:[0,1]
v_pk_add_f32 v[28:29], v[28:29], v[32:33]
v_pk_add_f32 v[32:33], v[42:43], v[46:47] op_sel:[1,1] op_sel_hi:[0,0] neg_lo:[0,1] neg_hi:[1,0]
v_pk_add_f32 v[42:43], v[42:43], v[46:47]
v_pk_add_f32 v[46:47], v[14:15], v[52:53] neg_lo:[0,1] neg_hi:[0,1]
v_pk_add_f32 v[14:15], v[14:15], v[52:53]
v_pk_add_f32 v[52:53], v[50:51], v[54:55] op_sel:[1,1] op_sel_hi:[0,0] neg_lo:[0,1] neg_hi:[1,0]
v_pk_add_f32 v[50:51], v[50:51], v[54:55]
v_pk_add_f32 v[54:55], v[44:45], v[56:57] neg_lo:[0,1] neg_hi:[0,1]
v_pk_add_f32 v[44:45], v[44:45], v[56:57]
v_pk_add_f32 v[56:57], v[58:59], v[62:63] op_sel:[1,1] op_sel_hi:[0,0] neg_lo:[0,1] neg_hi:[1,0]
v_pk_add_f32 v[58:59], v[58:59], v[62:63]
v_pk_add_f32 v[62:63], v[40:41], v[68:69] neg_lo:[0,1] neg_hi:[0,1]
v_pk_add_f32 v[40:41], v[40:41], v[68:69]
v_pk_add_f32 v[68:69], v[66:67], v[70:71] op_sel:[1,1] op_sel_hi:[0,0] neg_lo:[0,1] neg_hi:[1,0]
v_pk_add_f32 v[66:67], v[66:67], v[70:71]
v_pk_add_f32 v[70:71], v[60:61], v[48:49] neg_lo:[0,1] neg_hi:[0,1]
v_pk_add_f32 v[60:61], v[60:61], v[48:49]
v_pk_add_f32 v[48:49], v[74:75], v[78:79] op_sel:[1,1] op_sel_hi:[0,0] neg_lo:[0,1] neg_hi:[1,0]
v_pk_add_f32 v[74:75], v[74:75], v[78:79]
v_pk_add_f32 v[78:79], v[16:17], v[18:19] neg_lo:[0,1] neg_hi:[0,1]
v_pk_add_f32 v[16:17], v[16:17], v[18:19]
v_pk_add_f32 v[18:19], v[76:77], v[20:21] neg_lo:[0,1] neg_hi:[0,1]
v_pk_add_f32 v[76:77], v[76:77], v[20:21]
v_pk_add_f32 v[20:21], v[72:73], v[26:27] neg_lo:[0,1] neg_hi:[0,1]
v_pk_add_f32 v[72:73], v[72:73], v[26:27]
v_pk_add_f32 v[26:27], v[22:23], v[24:25] neg_lo:[0,1] neg_hi:[0,1]
v_pk_add_f32 v[22:23], v[22:23], v[24:25]
v_pk_add_f32 v[24:25], v[64:65], v[34:35] neg_lo:[0,1] neg_hi:[0,1]
v_pk_add_f32 v[64:65], v[64:65], v[34:35]
v_pk_add_f32 v[34:35], v[30:31], v[36:37] neg_lo:[0,1] neg_hi:[0,1]
v_pk_add_f32 v[30:31], v[30:31], v[36:37]
v_pk_add_f32 v[36:37], v[28:29], v[42:43] neg_lo:[0,1] neg_hi:[0,1]
v_pk_add_f32 v[28:29], v[28:29], v[42:43]
v_pk_add_f32 v[42:43], v[38:39], v[32:33] neg_lo:[0,1] neg_hi:[0,1]
v_pk_add_f32 v[38:39], v[38:39], v[32:33]
v_pk_add_f32 v[32:33], v[14:15], v[50:51] neg_lo:[0,1] neg_hi:[0,1]
v_pk_add_f32 v[14:15], v[14:15], v[50:51]
v_pk_add_f32 v[50:51], v[46:47], v[52:53] neg_lo:[0,1] neg_hi:[0,1]
v_pk_add_f32 v[46:47], v[46:47], v[52:53]
v_pk_add_f32 v[52:53], v[44:45], v[58:59] neg_lo:[0,1] neg_hi:[0,1]
v_pk_add_f32 v[44:45], v[44:45], v[58:59]
v_pk_add_f32 v[58:59], v[54:55], v[56:57] neg_lo:[0,1] neg_hi:[0,1]
v_pk_add_f32 v[54:55], v[54:55], v[56:57]
v_pk_add_f32 v[56:57], v[40:41], v[66:67] neg_lo:[0,1] neg_hi:[0,1]
v_pk_add_f32 v[40:41], v[40:41], v[66:67]
v_pk_add_f32 v[66:67], v[62:63], v[68:69] neg_lo:[0,1] neg_hi:[0,1]
v_pk_add_f32 v[62:63], v[62:63], v[68:69]
v_pk_add_f32 v[68:69], v[60:61], v[74:75] neg_lo:[0,1] neg_hi:[0,1]
v_pk_add_f32 v[60:61], v[60:61], v[74:75]
v_pk_add_f32 v[74:75], v[70:71], v[48:49] neg_lo:[0,1] neg_hi:[0,1]
v_pk_add_f32 v[70:71], v[70:71], v[48:49]
ds_write_b64 v4, v[16:17] offset:0
ds_write_b64 v4, v[14:15] offset:256
ds_write_b64 v4, v[64:65] offset:512
ds_write_b64 v4, v[40:41] offset:768
ds_write_b64 v4, v[72:73] offset:1024
ds_write_b64 v4, v[44:45] offset:1280
ds_write_b64 v4, v[28:29] offset:1536
ds_write_b64 v4, v[60:61] offset:1792
ds_write_b64 v4, v[76:77] offset:2048
ds_write_b64 v4, v[46:47] offset:2304
ds_write_b64 v4, v[30:31] offset:2560
ds_write_b64 v4, v[62:63] offset:2816
ds_write_b64 v4, v[22:23] offset:3072
ds_write_b64 v4, v[54:55] offset:3328
ds_write_b64 v4, v[38:39] offset:3584
ds_write_b64 v4, v[70:71] offset:3840
ds_write_b64 v4, v[78:79] offset:4096
ds_write_b64 v4, v[32:33] offset:4352
ds_write_b64 v4, v[24:25] offset:4608
ds_write_b64 v4, v[56:57] offset:4864
ds_write_b64 v4, v[20:21] offset:5120
ds_write_b64 v4, v[52:53] offset:5376
ds_write_b64 v4, v[36:37] offset:5632
ds_write_b64 v4, v[68:69] offset:5888
ds_write_b64 v4, v[18:19] offset:6144
ds_write_b64 v4, v[50:51] offset:6400
ds_write_b64 v4, v[34:35] offset:6656
ds_write_b64 v4, v[66:67] offset:6912
ds_write_b64 v4, v[26:27] offset:7168
ds_write_b64 v4, v[58:59] offset:7424
ds_write_b64 v4, v[42:43] offset:7680
ds_write_b64 v4, v[74:75] offset:7936
ds_write_b64 v4, v[16:17] offset:8192
s_waitcnt lgkmcnt(0)
s_barrier
s_lshl_b32 s13, s93, 7
s_add_u32 s13, s13, 96468992
ds_read_b64 v[16:17], v6 offset:0
ds_read_b64 v[18:19], v7 offset:4096
ds_read_b64 v[20:21], v6 offset:256
ds_read_b64 v[22:23], v7 offset:3840
ds_read_b64 v[24:25], v6 offset:512
ds_read_b64 v[26:27], v7 offset:3584
ds_read_b64 v[28:29], v6 offset:768
ds_read_b64 v[30:31], v7 offset:3328
ds_read_b64 v[32:33], v6 offset:1024
ds_read_b64 v[34:35], v7 offset:3072
ds_read_b64 v[36:37], v6 offset:1280
ds_read_b64 v[38:39], v7 offset:2816
s_waitcnt lgkmcnt(10)
v_pk_add_f32 v[208:209], v[16:17], v[18:19] neg_hi:[0,1]
v_pk_add_f32 v[210:211], v[16:17], v[18:19] op_sel:[1,1] op_sel_hi:[0,0] neg_hi:[1,0]
ds_read_b64 v[40:41], v6 offset:1536
ds_read_b64 v[42:43], v7 offset:2560
buffer_store_dwordx4 v[208:211], v8, s[84:87], s13 offen sc1
s_add_u32 s13, s13, 524288
s_waitcnt lgkmcnt(10)
v_pk_add_f32 v[212:213], v[20:21], v[22:23] neg_hi:[0,1]
v_pk_add_f32 v[214:215], v[20:21], v[22:23] op_sel:[1,1] op_sel_hi:[0,0] neg_hi:[1,0]
ds_read_b64 v[44:45], v6 offset:1792
ds_read_b64 v[46:47], v7 offset:2304
buffer_store_dwordx4 v[212:215], v8, s[84:87], s13 offen sc1
s_add_u32 s13, s13, 524288
s_waitcnt lgkmcnt(10)
v_pk_add_f32 v[216:217], v[24:25], v[26:27] neg_hi:[0,1]
v_pk_add_f32 v[218:219], v[24:25], v[26:27] op_sel:[1,1] op_sel_hi:[0,0] neg_hi:[1,0]
ds_read_b64 v[16:17], v6 offset:2048
ds_read_b64 v[18:19], v7 offset:2048
buffer_store_dwordx4 v[216:219], v8, s[84:87], s13 offen sc1
s_add_u32 s13, s13, 524288
s_waitcnt lgkmcnt(10)
v_pk_add_f32 v[220:221], v[28:29], v[30:31] neg_hi:[0,1]
v_pk_add_f32 v[222:223], v[28:29], v[30:31] op_sel:[1,1] op_sel_hi:[0,0] neg_hi:[1,0]
ds_read_b64 v[20:21], v6 offset:2304
ds_read_b64 v[22:23], v7 offset:1792
buffer_store_dwordx4 v[220:223], v8, s[84:87], s13 offen sc1
s_add_u32 s13, s13, 524288
s_waitcnt lgkmcnt(10)
v_pk_add_f32 v[224:225], v[32:33], v[34:35] neg_hi:[0,1]
v_pk_add_f32 v[226:227], v[32:33], v[34:35] op_sel:[1,1] op_sel_hi:[0,0] neg_hi:[1,0]
ds_read_b64 v[24:25], v6 offset:2560
ds_read_b64 v[26:27], v7 offset:1536
buffer_store_dwordx4 v[224:227], v8, s[84:87], s13 offen sc1
s_add_u32 s13, s13, 524288
s_waitcnt lgkmcnt(10)
v_pk_add_f32 v[228:229], v[36:37], v[38:39] neg_hi:[0,1]
v_pk_add_f32 v[230:231], v[36:37], v[38:39] op_sel:[1,1] op_sel_hi:[0,0] neg_hi:[1,0]
ds_read_b64 v[28:29], v6 offset:2816
ds_read_b64 v[30:31], v7 offset:1280
buffer_store_dwordx4 v[228:231], v8, s[84:87], s13 offen sc1
s_add_u32 s13, s13, 524288
s_waitcnt lgkmcnt(10)
v_pk_add_f32 v[232:233], v[40:41], v[42:43] neg_hi:[0,1]
v_pk_add_f32 v[234:235], v[40:41], v[42:43] op_sel:[1,1] op_sel_hi:[0,0] neg_hi:[1,0]
ds_read_b64 v[32:33], v6 offset:3072
ds_read_b64 v[34:35], v7 offset:1024
buffer_store_dwordx4 v[232:235], v8, s[84:87], s13 offen sc1
s_add_u32 s13, s13, 524288
s_waitcnt lgkmcnt(10)
v_pk_add_f32 v[236:237], v[44:45], v[46:47] neg_hi:[0,1]
v_pk_add_f32 v[238:239], v[44:45], v[46:47] op_sel:[1,1] op_sel_hi:[0,0] neg_hi:[1,0]
ds_read_b64 v[36:37], v6 offset:3328
ds_read_b64 v[38:39], v7 offset:768
buffer_store_dwordx4 v[236:239], v8, s[84:87], s13 offen sc1
s_add_u32 s13, s13, 524288
s_waitcnt lgkmcnt(10)
v_pk_add_f32 v[208:209], v[16:17], v[18:19] neg_hi:[0,1]
v_pk_add_f32 v[210:211], v[16:17], v[18:19] op_sel:[1,1] op_sel_hi:[0,0] neg_hi:[1,0]
ds_read_b64 v[40:41], v6 offset:3584
ds_read_b64 v[42:43], v7 offset:512
buffer_store_dwordx4 v[208:211], v8, s[84:87], s13 offen sc1
s_add_u32 s13, s13, 524288
s_waitcnt lgkmcnt(10)
v_pk_add_f32 v[212:213], v[20:21], v[22:23] neg_hi:[0,1]
v_pk_add_f32 v[214:215], v[20:21], v[22:23] op_sel:[1,1] op_sel_hi:[0,0] neg_hi:[1,0]
ds_read_b64 v[44:45], v6 offset:3840
ds_read_b64 v[46:47], v7 offset:256
buffer_store_dwordx4 v[212:215], v8, s[84:87], s13 offen sc1
s_add_u32 s13, s13, 524288
s_waitcnt lgkmcnt(10)
v_pk_add_f32 v[216:217], v[24:25], v[26:27] neg_hi:[0,1]
v_pk_add_f32 v[218:219], v[24:25], v[26:27] op_sel:[1,1] op_sel_hi:[0,0] neg_hi:[1,0]
ds_read_b64 v[16:17], v6 offset:4096
ds_read_b64 v[18:19], v7 offset:0
buffer_store_dwordx4 v[216:219], v8, s[84:87], s13 offen sc1
s_add_u32 s13, s13, 524288
s_waitcnt lgkmcnt(10)
v_pk_add_f32 v[220:221], v[28:29], v[30:31] neg_hi:[0,1]
v_pk_add_f32 v[222:223], v[28:29], v[30:31] op_sel:[1,1] op_sel_hi:[0,0] neg_hi:[1,0]
buffer_store_dwordx4 v[220:223], v8, s[84:87], s13 offen sc1
s_add_u32 s13, s13, 524288
s_waitcnt lgkmcnt(8)
v_pk_add_f32 v[224:225], v[32:33], v[34:35] neg_hi:[0,1]
v_pk_add_f32 v[226:227], v[32:33], v[34:35] op_sel:[1,1] op_sel_hi:[0,0] neg_hi:[1,0]
buffer_store_dwordx4 v[224:227], v8, s[84:87], s13 offen sc1
s_add_u32 s13, s13, 524288
s_waitcnt lgkmcnt(6)
v_pk_add_f32 v[228:229], v[36:37], v[38:39] neg_hi:[0,1]
v_pk_add_f32 v[230:231], v[36:37], v[38:39] op_sel:[1,1] op_sel_hi:[0,0] neg_hi:[1,0]
buffer_store_dwordx4 v[228:231], v8, s[84:87], s13 offen sc1
s_add_u32 s13, s13, 524288
s_waitcnt lgkmcnt(4)
v_pk_add_f32 v[232:233], v[40:41], v[42:43] neg_hi:[0,1]
v_pk_add_f32 v[234:235], v[40:41], v[42:43] op_sel:[1,1] op_sel_hi:[0,0] neg_hi:[1,0]
buffer_store_dwordx4 v[232:235], v8, s[84:87], s13 offen sc1
s_add_u32 s13, s13, 524288
s_waitcnt lgkmcnt(2)
v_pk_add_f32 v[236:237], v[44:45], v[46:47] neg_hi:[0,1]
v_pk_add_f32 v[238:239], v[44:45], v[46:47] op_sel:[1,1] op_sel_hi:[0,0] neg_hi:[1,0]
buffer_store_dwordx4 v[236:239], v8, s[84:87], s13 offen sc1
s_add_u32 s13, s13, 524288
s_waitcnt lgkmcnt(0)
v_pk_add_f32 v[208:209], v[16:17], v[18:19] neg_hi:[0,1]
v_pk_add_f32 v[210:211], v[16:17], v[18:19] op_sel:[1,1] op_sel_hi:[0,0] neg_hi:[1,0]
v_cmp_eq_u32 vcc, 0, v9
s_nop 1
v_cndmask_b32 v13, -16, v8, vcc
buffer_store_dwordx4 v[208:211], v13, s[84:87], s13 offen sc1
s_add_u32 s13, s13, 524288
s_mov_b32 s93, s21
s_cmp_lt_u32 s93, 128
s_cbranch_scc1 mega_kernel_f1_l
mega_kernel_f1_e:
s_mov_b32 s93, s40
s_waitcnt vmcnt(0)
s_load_dwordx2 s[4:5], s[0:1], 64
s_load_dwordx2 s[8:9], s[0:1], 72
v_and_b32 v1, 63, v0
v_lshrrev_b32 v2, 6, v0
v_mul_u32_u24 v3, 1026, v2
v_lshl_add_u32 v3, v1, 1, v3
v_mul_u32_u24 v4, 65, v1
v_add_u32 v4, v4, v2
v_lshlrev_b32 v4, 2, v4
v_lshrrev_b32 v7, 4, v0
v_and_b32 v8, 15, v0
v_mul_u32_u24 v5, 65, v7
v_lshl_add_u32 v5, v8, 2, v5
v_lshlrev_b32 v5, 2, v5
v_lshlrev_b32 v6, 13, v7
v_lshl_add_u32 v6, v8, 4, v6
s_add_u32 s24, s84, 121634816
s_addc_u32 s25, s85, 0
s_mov_b32 s26, 4202496
s_mov_b32 s27, 0x00020000
s_waitcnt lgkmcnt(0)
s_mov_b32 s6, 2101248
s_mov_b32 s7, 0x00020000
s_mov_b32 s10, 2101248
s_mov_b32 s11, 0x00020000
s_cmp_lt_u32 s93, 288
s_cbranch_scc0 mega_kernel_f0_e
s_and_b32 s12, s93, 31
s_mul_i32 s12, s12, 65664
s_lshr_b32 s13, s93, 5
s_lshl_b32 s13, s13, 7
s_add_u32 s12, s12, s13
buffer_load_ushort v16, v3, s[4:7], s12 offen
buffer_load_ushort v32, v3, s[8:11], s12 offen
s_add_u32 s12, s12, 4104
buffer_load_ushort v17, v3, s[4:7], s12 offen
buffer_load_ushort v33, v3, s[8:11], s12 offen
s_add_u32 s12, s12, 4104
buffer_load_ushort v18, v3, s[4:7], s12 offen
buffer_load_ushort v34, v3, s[8:11], s12 offen
s_add_u32 s12, s12, 4104
buffer_load_ushort v19, v3, s[4:7], s12 offen
buffer_load_ushort v35, v3, s[8:11], s12 offen
s_add_u32 s12, s12, 4104
buffer_load_ushort v20, v3, s[4:7], s12 offen
buffer_load_ushort v36, v3, s[8:11], s12 offen
s_add_u32 s12, s12, 4104
buffer_load_ushort v21, v3, s[4:7], s12 offen
buffer_load_ushort v37, v3, s[8:11], s12 offen
s_add_u32 s12, s12, 4104
buffer_load_ushort v22, v3, s[4:7], s12 offen
buffer_load_ushort v38, v3, s[8:11], s12 offen
s_add_u32 s12, s12, 4104
buffer_load_ushort v23, v3, s[4:7], s12 offen
buffer_load_ushort v39, v3, s[8:11], s12 offen
s_add_u32 s12, s12, 4104
buffer_load_ushort v24, v3, s[4:7], s12 offen
buffer_load_ushort v40, v3, s[8:11], s12 offen
s_add_u32 s12, s12, 4104
buffer_load_ushort v25, v3, s[4:7], s12 offen
buffer_load_ushort v41, v3, s[8:11], s12 offen
s_add_u32 s12, s12, 4104
buffer_load_ushort v26, v3, s[4:7], s12 offen
buffer_load_ushort v42, v3, s[8:11], s12 offen
s_add_u32 s12, s12, 4104
buffer_load_ushort v27, v3, s[4:7], s12 offen
buffer_load_ushort v43, v3, s[8:11], s12 offen
s_add_u32 s12, s12, 4104
buffer_load_ushort v28, v3, s[4:7], s12 offen
buffer_load_ushort v44, v3, s[8:11], s12 offen
s_add_u32 s12, s12, 4104
buffer_load_ushort v29, v3, s[4:7], s12 offen
buffer_load_ushort v45, v3, s[8:11], s12 offen
s_add_u32 s12, s12, 4104
buffer_load_ushort v30, v3, s[4:7], s12 offen
buffer_load_ushort v46, v3, s[8:11], s12 offen
s_add_u32 s12, s12, 4104
buffer_load_ushort v31, v3, s[4:7], s12 offen
buffer_load_ushort v47, v3, s[8:11], s12 offen
s_add_u32 s12, s12, 4104
s_waitcnt vmcnt(0)
mega_kernel_f0_l:
s_add_u32 s21, s93, 32
s_cmp_lt_u32 s21, 288
s_cselect_b32 s22, s21, s93
s_waitcnt vmcnt(4)
v_lshl_or_b32 v48, v32, 16, v16
v_lshl_or_b32 v49, v33, 16, v17
v_lshl_or_b32 v50, v34, 16, v18
v_lshl_or_b32 v51, v35, 16, v19
v_lshl_or_b32 v52, v36, 16, v20
v_lshl_or_b32 v53, v37, 16, v21
v_lshl_or_b32 v54, v38, 16, v22
v_lshl_or_b32 v55, v39, 16, v23
v_lshl_or_b32 v56, v40, 16, v24
v_lshl_or_b32 v57, v41, 16, v25
v_lshl_or_b32 v58, v42, 16, v26
v_lshl_or_b32 v59, v43, 16, v27
v_lshl_or_b32 v60, v44, 16, v28
v_lshl_or_b32 v61, v45, 16, v29
v_lshl_or_b32 v62, v46, 16, v30
v_lshl_or_b32 v63, v47, 16, v31
s_and_b32 s12, s22, 31
s_mul_i32 s12, s12, 65664
s_lshr_b32 s13, s22, 5
s_lshl_b32 s13, s13, 7
s_add_u32 s12, s12, s13
buffer_load_ushort v16, v3, s[4:7], s12 offen
buffer_load_ushort v32, v3, s[8:11], s12 offen
s_add_u32 s12, s12, 4104
buffer_load_ushort v17, v3, s[4:7], s12 offen
buffer_load_ushort v33, v3, s[8:11], s12 offen
s_add_u32 s12, s12, 4104
buffer_load_ushort v18, v3, s[4:7], s12 offen
buffer_load_ushort v34, v3, s[8:11], s12 offen
s_add_u32 s12, s12, 4104
buffer_load_ushort v19, v3, s[4:7], s12 offen
buffer_load_ushort v35, v3, s[8:11], s12 offen
s_add_u32 s12, s12, 4104
buffer_load_ushort v20, v3, s[4:7], s12 offen
buffer_load_ushort v36, v3, s[8:11], s12 offen
s_add_u32 s12, s12, 4104
buffer_load_ushort v21, v3, s[4:7], s12 offen
buffer_load_ushort v37, v3, s[8:11], s12 offen
s_add_u32 s12, s12, 4104
buffer_load_ushort v22, v3, s[4:7], s12 offen
buffer_load_ushort v38, v3, s[8:11], s12 offen
s_add_u32 s12, s12, 4104
buffer_load_ushort v23, v3, s[4:7], s12 offen
buffer_load_ushort v39, v3, s[8:11], s12 offen
s_add_u32 s12, s12, 4104
buffer_load_ushort v24, v3, s[4:7], s12 offen
buffer_load_ushort v40, v3, s[8:11], s12 offen
s_add_u32 s12, s12, 4104
buffer_load_ushort v25, v3, s[4:7], s12 offen
buffer_load_ushort v41, v3, s[8:11], s12 offen
s_add_u32 s12, s12, 4104
buffer_load_ushort v26, v3, s[4:7], s12 offen
buffer_load_ushort v42, v3, s[8:11], s12 offen
s_add_u32 s12, s12, 4104
buffer_load_ushort v27, v3, s[4:7], s12 offen
buffer_load_ushort v43, v3, s[8:11], s12 offen
s_add_u32 s12, s12, 4104
buffer_load_ushort v28, v3, s[4:7], s12 offen
buffer_load_ushort v44, v3, s[8:11], s12 offen
s_add_u32 s12, s12, 4104
buffer_load_ushort v29, v3, s[4:7], s12 offen
buffer_load_ushort v45, v3, s[8:11], s12 offen
s_add_u32 s12, s12, 4104
buffer_load_ushort v30, v3, s[4:7], s12 offen
buffer_load_ushort v46, v3, s[8:11], s12 offen
s_add_u32 s12, s12, 4104
buffer_load_ushort v31, v3, s[4:7], s12 offen
buffer_load_ushort v47, v3, s[8:11], s12 offen
s_add_u32 s12, s12, 4104
s_barrier
ds_write_b32 v4, v48 offset:0
ds_write_b32 v4, v49 offset:16
ds_write_b32 v4, v50 offset:32
ds_write_b32 v4, v51 offset:48
ds_write_b32 v4, v52 offset:64
ds_write_b32 v4, v53 offset:80
ds_write_b32 v4, v54 offset:96
ds_write_b32 v4, v55 offset:112
ds_write_b32 v4, v56 offset:128
ds_write_b32 v4, v57 offset:144
ds_write_b32 v4, v58 offset:160
ds_write_b32 v4, v59 offset:176
s_waitcnt lgkmcnt(4)
ds_write_b32 v4, v60 offset:192
ds_write_b32 v4, v61 offset:208
ds_write_b32 v4, v62 offset:224
ds_write_b32 v4, v63 offset:240
s_waitcnt lgkmcnt(0)
s_barrier
ds_read2_b32 v[64:65], v5 offset0:0 offset1:1
ds_read_b32 v66, v5 offset:8
ds_read_b32 v67, v5 offset:12
ds_read_b32 v68, v5 offset:4160
ds_read_b32 v69, v5 offset:4164
ds_read_b32 v70, v5 offset:4168
ds_read_b32 v71, v5 offset:4172
ds_read_b32 v72, v5 offset:8320
ds_read_b32 v73, v5 offset:8324
ds_read_b32 v74, v5 offset:8328
ds_read_b32 v75, v5 offset:8332
ds_read_b32 v76, v5 offset:12480
ds_read_b32 v77, v5 offset:12484
ds_read_b32 v78, v5 offset:12488
ds_read_b32 v79, v5 offset:12492
s_and_b32 s14, s93, 31
s_lshl_b32 s14, s14, 8
s_lshr_b32 s15, s93, 5
s_lshl_b32 s15, s15, 19
s_add_u32 s14, s14, s15
s_waitcnt lgkmcnt(0)
buffer_store_dwordx4 v[64:67], v6, s[24:27], s14 offen sc1
s_add_u32 s14, s14, 131072
buffer_store_dwordx4 v[68:71], v6, s[24:27], s14 offen sc1
s_add_u32 s14, s14, 131072
buffer_store_dwordx4 v[72:75], v6, s[24:27], s14 offen sc1
s_add_u32 s14, s14, 131072
buffer_store_dwordx4 v[76:79], v6, s[24:27], s14 offen sc1
s_add_u32 s14, s14, 131072
s_mov_b32 s93, s21
s_cmp_lt_u32 s93, 288
s_cbranch_scc1 mega_kernel_f0_l
mega_kernel_f0_e:
v_and_b32 v3, 15, v0
v_lshlrev_b32 v3, 4, v3
s_branch mega_kernel_syd
mega_kernel_sydw:
s_sleep 4
mega_kernel_syd:
buffer_load_dword v2, v3, s[72:75], 0 offen sc1
s_waitcnt vmcnt(0)
s_cmp_eq_u32 s95, 1
s_cbranch_scc0 mega_kernel_sydf
v_readlane_b32 s76, v2, 14
s_mov_b32 s98, 0
s_cmp_eq_u32 s76, 64
s_cbranch_scc0 mega_kernel_sydw
s_branch mega_kernel_sydd
mega_kernel_sydf:
s_mov_b32 s77, 0
s_mov_b32 s78, 0
v_readlane_b32 s76, v2, 0
s_add_u32 s77, s77, s76
s_xor_b32 s76, s76, 32
s_or_b32 s78, s78, s76
v_readlane_b32 s76, v2, 1
s_add_u32 s77, s77, s76
s_xor_b32 s76, s76, 32
s_or_b32 s78, s78, s76
v_readlane_b32 s76, v2, 2
s_add_u32 s77, s77, s76
s_xor_b32 s76, s76, 32
s_or_b32 s78, s78, s76
v_readlane_b32 s76, v2, 3
s_add_u32 s77, s77, s76
s_xor_b32 s76, s76, 32
s_or_b32 s78, s78, s76
v_readlane_b32 s76, v2, 4
s_add_u32 s77, s77, s76
s_xor_b32 s76, s76, 32
s_or_b32 s78, s78, s76
v_readlane_b32 s76, v2, 5
s_add_u32 s77, s77, s76
s_xor_b32 s76, s76, 32
s_or_b32 s78, s78, s76
v_readlane_b32 s76, v2, 6
s_add_u32 s77, s77, s76
s_xor_b32 s76, s76, 32
s_or_b32 s78, s78, s76
v_readlane_b32 s76, v2, 7
s_add_u32 s77, s77, s76
s_xor_b32 s76, s76, 32
s_or_b32 s78, s78, s76
s_cmp_eq_u32 s77, 256
s_cbranch_scc0 mega_kernel_sydw
v_mov_b32 v252, v2
s_cmp_eq_u32 s78, 0
s_cbranch_scc0 mega_kernel_slowent
v_readlane_b32 s76, v2, 10
v_readlane_b32 s77, v2, 8
s_cmp_eq_u32 s76, 64
s_cbranch_scc0 mega_kernel_sydw
s_cmp_gt_u32 s77, 32
s_cselect_b32 s98, 1, 0
mega_kernel_sydd:
s_waitcnt vmcnt(0)
s_barrier
v_mov_b32 v1, 0
v_mov_b32 v2, 1
s_mov_b32 s82, 69259264
v_cmp_eq_u32 vcc, 0, v0
s_and_saveexec_b64 s[80:81], vcc
s_cbranch_execz mega_kernel_sg0
buffer_atomic_add v2, v1, s[84:87], s82 offen sc1
mega_kernel_sg0:
s_mov_b64 exec, s[80:81]
s_add_u32 s38, s40, 129
s_mov_b32 s39, 32
s_mov_b32 s37, 129
s_cmp_lt_u32 s38, 129
s_cbranch_scc1 mega_kernel_f2s
s_branch mega_kernel_f2e
mega_kernel_rk:
s_load_dwordx2 s[4:5], s[0:1], 24
s_load_dwordx2 s[8:9], s[0:1], 0
v_lshrrev_b32 v2, 6, v0
v_and_b32 v1, 63, v0
v_readfirstlane_b32 s41, v2
v_lshlrev_b32 v5, 4, v1
s_waitcnt lgkmcnt(0)
s_mov_b32 s6, 8388608
s_mov_b32 s7, 0x00020000
s_mov_b32 s10, 4194304
s_mov_b32 s11, 0x00020000
s_lshl_b32 s43, s40, 8
s_lshl_b32 s44, s41, 6
s_add_u32 s48, s43, s44
s_and_b32 s43, s48, 0x7ff
v_add_u32 v19, s43, v1
v_lshlrev_b32 v19, 7, v19
buffer_load_dword v250, v19, s[8:11], 0 offen
s_nop 0
v_lshrrev_b32 v2, 3, v1
s_lshl_b32 s43, s41, 3
v_add_u32 v2, s43, v2
v_bfe_u32 v3, v2, 1, 3
v_and_b32 v4, 7, v1
v_xor_b32 v3, v3, v4
v_lshlrev_b32 v6, 11, v2
v_lshl_add_u32 v6, v3, 4, v6
s_lshl_b32 s46, s41, 10
v_and_b32 v2, 15, v1
v_bfe_u32 v3, v2, 1, 3
v_lshrrev_b32 v4, 4, v1
v_xor_b32 v3, v3, v4
v_lshlrev_b32 v8, 7, v2
v_lshl_add_u32 v8, v3, 4, v8
v_xor_b32 v9, 64, v8
v_add_u32 v10, 0x10000, v8
v_add_u32 v11, 0x10000, v9
v_mov_b32 v7, v5
s_lshl_b32 s47, s40, 2
s_add_u32 s47, s47, s41
s_mov_b32 s42, 0
s_mov_b32 s50, 0
s_add_u32 m0, s46, 0
s_nop 0
buffer_load_dwordx4 v6, s[8:11], s50 offen offset:0 lds
s_add_u32 m0, s46, 3968
s_nop 0
buffer_load_dwordx4 v6, s[8:11], s50 offen offset:128 lds
s_add_u32 m0, s46, 7936
s_nop 0
buffer_load_dwordx4 v6, s[8:11], s50 offen offset:256 lds
s_add_u32 m0, s46, 11904
s_nop 0
buffer_load_dwordx4 v6, s[8:11], s50 offen offset:384 lds
s_add_u32 m0, s46, 15872
s_nop 0
buffer_load_dwordx4 v6, s[8:11], s50 offen offset:512 lds
s_add_u32 m0, s46, 19840
s_nop 0
buffer_load_dwordx4 v6, s[8:11], s50 offen offset:640 lds
s_add_u32 m0, s46, 23808
s_nop 0
buffer_load_dwordx4 v6, s[8:11], s50 offen offset:768 lds
s_add_u32 m0, s46, 27776
s_nop 0
buffer_load_dwordx4 v6, s[8:11], s50 offen offset:896 lds
s_add_u32 m0, s46, 31744
s_nop 0
buffer_load_dwordx4 v6, s[8:11], s50 offen offset:1024 lds
s_add_u32 m0, s46, 35712
s_nop 0
buffer_load_dwordx4 v6, s[8:11], s50 offen offset:1152 lds
s_add_u32 m0, s46, 39680
s_nop 0
buffer_load_dwordx4 v6, s[8:11], s50 offen offset:1280 lds
s_add_u32 m0, s46, 43648
s_nop 0
buffer_load_dwordx4 v6, s[8:11], s50 offen offset:1408 lds
s_add_u32 m0, s46, 47616
s_nop 0
buffer_load_dwordx4 v6, s[8:11], s50 offen offset:1536 lds
s_add_u32 m0, s46, 51584
s_nop 0
buffer_load_dwordx4 v6, s[8:11], s50 offen offset:1664 lds
s_add_u32 m0, s46, 55552
s_nop 0
buffer_load_dwordx4 v6, s[8:11], s50 offen offset:1792 lds
s_add_u32 m0, s46, 59520
s_nop 0
buffer_load_dwordx4 v6, s[8:11], s50 offen offset:1920 lds
v_lshrrev_b32 v2, 2, v1
v_and_b32 v3, 3, v1
v_lshlrev_b32 v16, 13, v2
v_lshl_add_u32 v16, v3, 4, v16
v_add_u32 v16, s48, v16
s_mul_i32 s45, s41, 24576
s_add_u32 s45, s45, 65536
v_bfe_u32 v17, v1, 2, 2
v_lshrrev_b32 v18, 4, v1
v_lshl_add_u32 v17, v18, 3, v17
v_lshlrev_b32 v17, 6, v17
v_lshl_add_u32 v17, v3, 4, v17
v_add_u32 v17, s45, v17
s_and_b32 s43, s40, 3
s_lshl_b32 s43, s43, 2
s_add_u32 s43, s43, s41
s_lshl_b32 s43, s43, 3
v_and_b32 v12, 7, v1
v_add_u32 v12, s43, v12
s_lshr_b32 s43, s40, 2
s_lshl_b32 s43, s43, 10
s_add_u32 s44, s43, 896
s_add_u32 s43, s43, 384
s_cmp_ge_u32 s40, 28
s_cselect_b32 s44, s44, s43
v_mov_b32 v13, s43
v_mov_b32 v14, s44
v_cmp_gt_u32 vcc, 32, v1
s_nop 1
v_cndmask_b32 v13, v14, v13, vcc
v_lshl_add_u32 v12, v12, 13, v13
s_mov_b32 s44, 0
buffer_load_dword v250, v12, s[4:7], s44 offen
s_add_u32 m0, s45, 0
s_mov_b32 s44, 0
buffer_load_dwordx4 v16, s[4:7], s44 offen lds
s_add_u32 m0, s45, 1024
s_mov_b32 s44, 131072
buffer_load_dwordx4 v16, s[4:7], s44 offen lds
s_add_u32 m0, s45, 2048
s_mov_b32 s44, 262144
buffer_load_dwordx4 v16, s[4:7], s44 offen lds
s_add_u32 m0, s45, 3072
s_mov_b32 s44, 393216
buffer_load_dwordx4 v16, s[4:7], s44 offen lds
s_add_u32 m0, s45, 4096
s_mov_b32 s44, 524288
buffer_load_dwordx4 v16, s[4:7], s44 offen lds
s_add_u32 m0, s45, 5120
s_mov_b32 s44, 655360
buffer_load_dwordx4 v16, s[4:7], s44 offen lds
s_add_u32 m0, s45, 6144
s_mov_b32 s44, 786432
buffer_load_dwordx4 v16, s[4:7], s44 offen lds
s_add_u32 m0, s45, 7168
s_mov_b32 s44, 917504
buffer_load_dwordx4 v16, s[4:7], s44 offen lds
s_mov_b32 s44, 1048576
buffer_load_dword v250, v12, s[4:7], s44 offen
s_add_u32 m0, s45, 8192
s_mov_b32 s44, 1048576
buffer_load_dwordx4 v16, s[4:7], s44 offen lds
s_add_u32 m0, s45, 9216
s_mov_b32 s44, 1179648
buffer_load_dwordx4 v16, s[4:7], s44 offen lds
s_add_u32 m0, s45, 10240
s_mov_b32 s44, 1310720
buffer_load_dwordx4 v16, s[4:7], s44 offen lds
s_add_u32 m0, s45, 11264
s_mov_b32 s44, 1441792
buffer_load_dwordx4 v16, s[4:7], s44 offen lds
s_add_u32 m0, s45, 12288
s_mov_b32 s44, 1572864
buffer_load_dwordx4 v16, s[4:7], s44 offen lds
s_add_u32 m0, s45, 13312
s_mov_b32 s44, 1703936
buffer_load_dwordx4 v16, s[4:7], s44 offen lds
s_add_u32 m0, s45, 14336
s_mov_b32 s44, 1835008
buffer_load_dwordx4 v16, s[4:7], s44 offen lds
s_add_u32 m0, s45, 15360
s_mov_b32 s44, 1966080
buffer_load_dwordx4 v16, s[4:7], s44 offen lds
s_mov_b32 s44, 2097152
buffer_load_dword v250, v12, s[4:7], s44 offen
s_add_u32 m0, s45, 16384
s_mov_b32 s44, 2097152
buffer_load_dwordx4 v16, s[4:7], s44 offen lds
s_add_u32 m0, s45, 17408
s_mov_b32 s44, 2228224
buffer_load_dwordx4 v16, s[4:7], s44 offen lds
s_add_u32 m0, s45, 18432
s_mov_b32 s44, 2359296
buffer_load_dwordx4 v16, s[4:7], s44 offen lds
s_add_u32 m0, s45, 19456
s_mov_b32 s44, 2490368
buffer_load_dwordx4 v16, s[4:7], s44 offen lds
s_add_u32 m0, s45, 20480
s_mov_b32 s44, 2621440
buffer_load_dwordx4 v16, s[4:7], s44 offen lds
s_add_u32 m0, s45, 21504
s_mov_b32 s44, 2752512
buffer_load_dwordx4 v16, s[4:7], s44 offen lds
s_add_u32 m0, s45, 22528
s_mov_b32 s44, 2883584
buffer_load_dwordx4 v16, s[4:7], s44 offen lds
s_add_u32 m0, s45, 23552
s_mov_b32 s44, 3014656
buffer_load_dwordx4 v16, s[4:7], s44 offen lds
s_waitcnt vmcnt(18)
s_barrier
ds_read_b64_tr_b16 a[0:1], v17 offset:0
ds_read_b64_tr_b16 a[2:3], v17 offset:256
ds_read_b64_tr_b16 a[4:5], v17 offset:8
ds_read_b64_tr_b16 a[6:7], v17 offset:264
ds_read_b64_tr_b16 a[8:9], v17 offset:2048
ds_read_b64_tr_b16 a[10:11], v17 offset:2304
ds_read_b64_tr_b16 a[12:13], v17 offset:2056
ds_read_b64_tr_b16 a[14:15], v17 offset:2312
s_waitcnt lgkmcnt(0)
ds_read_b64_tr_b16 a[16:17], v17 offset:4096
ds_read_b64_tr_b16 a[18:19], v17 offset:4352
ds_read_b64_tr_b16 a[20:21], v17 offset:4104
ds_read_b64_tr_b16 a[22:23], v17 offset:4360
ds_read_b64_tr_b16 a[24:25], v17 offset:6144
ds_read_b64_tr_b16 a[26:27], v17 offset:6400
ds_read_b64_tr_b16 a[28:29], v17 offset:6152
ds_read_b64_tr_b16 a[30:31], v17 offset:6408
s_waitcnt lgkmcnt(0)
ds_read_b128 v[20:23], v8 offset:0
ds_read_b128 v[24:27], v8 offset:2048
ds_read_b128 v[28:31], v9 offset:0
ds_read_b128 v[32:35], v9 offset:2048
ds_read_b128 v[36:39], v8 offset:4096
ds_read_b128 v[40:43], v8 offset:6144
ds_read_b128 v[44:47], v9 offset:4096
ds_read_b128 v[48:51], v9 offset:6144
s_mov_b32 s44, 3145728
buffer_load_dword v250, v12, s[4:7], s44 offen
s_add_u32 m0, s45, 0
s_mov_b32 s44, 3145728
buffer_load_dwordx4 v16, s[4:7], s44 offen lds
s_add_u32 m0, s45, 1024
s_mov_b32 s44, 3276800
buffer_load_dwordx4 v16, s[4:7], s44 offen lds
s_add_u32 m0, s45, 2048
s_mov_b32 s44, 3407872
buffer_load_dwordx4 v16, s[4:7], s44 offen lds
s_add_u32 m0, s45, 3072
s_mov_b32 s44, 3538944
buffer_load_dwordx4 v16, s[4:7], s44 offen lds
s_add_u32 m0, s45, 4096
s_mov_b32 s44, 3670016
buffer_load_dwordx4 v16, s[4:7], s44 offen lds
s_add_u32 m0, s45, 5120
s_mov_b32 s44, 3801088
buffer_load_dwordx4 v16, s[4:7], s44 offen lds
s_add_u32 m0, s45, 6144
s_mov_b32 s44, 3932160
buffer_load_dwordx4 v16, s[4:7], s44 offen lds
s_add_u32 m0, s45, 7168
s_mov_b32 s44, 4063232
buffer_load_dwordx4 v16, s[4:7], s44 offen lds
s_waitcnt lgkmcnt(0)
v_mfma_f32_16x16x32_bf16 v[52:55], a[0:3], v[20:23], 0
v_mfma_f32_16x16x32_bf16 v[56:59], a[4:7], v[20:23], 0
v_mfma_f32_16x16x32_bf16 v[60:63], a[0:3], v[24:27], 0
v_mfma_f32_16x16x32_bf16 v[64:67], a[4:7], v[24:27], 0
v_mfma_f32_16x16x32_bf16 v[52:55], a[8:11], v[28:31], v[52:55]
v_mfma_f32_16x16x32_bf16 v[56:59], a[12:15], v[28:31], v[56:59]
v_mfma_f32_16x16x32_bf16 v[60:63], a[8:11], v[32:35], v[60:63]
v_mfma_f32_16x16x32_bf16 v[64:67], a[12:15], v[32:35], v[64:67]
v_mfma_f32_16x16x32_bf16 v[52:55], a[16:19], v[36:39], v[52:55]
v_mfma_f32_16x16x32_bf16 v[56:59], a[20:23], v[36:39], v[56:59]
v_mfma_f32_16x16x32_bf16 v[60:63], a[16:19], v[40:43], v[60:63]
v_mfma_f32_16x16x32_bf16 v[64:67], a[20:23], v[40:43], v[64:67]
v_mfma_f32_16x16x32_bf16 v[52:55], a[24:27], v[44:47], v[52:55]
v_mfma_f32_16x16x32_bf16 v[56:59], a[28:31], v[44:47], v[56:59]
v_mfma_f32_16x16x32_bf16 v[60:63], a[24:27], v[48:51], v[60:63]
v_mfma_f32_16x16x32_bf16 v[64:67], a[28:31], v[48:51], v[64:67]
s_waitcnt vmcnt(18)
ds_read_b64_tr_b16 a[32:33], v17 offset:8192
ds_read_b64_tr_b16 a[34:35], v17 offset:8448
ds_read_b64_tr_b16 a[36:37], v17 offset:8200
ds_read_b64_tr_b16 a[38:39], v17 offset:8456
ds_read_b64_tr_b16 a[40:41], v17 offset:10240
ds_read_b64_tr_b16 a[42:43], v17 offset:10496
ds_read_b64_tr_b16 a[44:45], v17 offset:10248
ds_read_b64_tr_b16 a[46:47], v17 offset:10504
s_waitcnt lgkmcnt(0)
ds_read_b64_tr_b16 a[48:49], v17 offset:12288
ds_read_b64_tr_b16 a[50:51], v17 offset:12544
ds_read_b64_tr_b16 a[52:53], v17 offset:12296
ds_read_b64_tr_b16 a[54:55], v17 offset:12552
ds_read_b64_tr_b16 a[56:57], v17 offset:14336
ds_read_b64_tr_b16 a[58:59], v17 offset:14592
ds_read_b64_tr_b16 a[60:61], v17 offset:14344
ds_read_b64_tr_b16 a[62:63], v17 offset:14600
s_waitcnt lgkmcnt(0)
ds_read_b128 v[20:23], v8 offset:8192
ds_read_b128 v[24:27], v8 offset:10240
ds_read_b128 v[28:31], v9 offset:8192
ds_read_b128 v[32:35], v9 offset:10240
ds_read_b128 v[36:39], v8 offset:12288
ds_read_b128 v[40:43], v8 offset:14336
ds_read_b128 v[44:47], v9 offset:12288
ds_read_b128 v[48:51], v9 offset:14336
s_mov_b32 s44, 4194304
buffer_load_dword v250, v12, s[4:7], s44 offen
s_add_u32 m0, s45, 8192
s_mov_b32 s44, 4194304
buffer_load_dwordx4 v16, s[4:7], s44 offen lds
s_add_u32 m0, s45, 9216
s_mov_b32 s44, 4325376
buffer_load_dwordx4 v16, s[4:7], s44 offen lds
s_add_u32 m0, s45, 10240
s_mov_b32 s44, 4456448
buffer_load_dwordx4 v16, s[4:7], s44 offen lds
s_add_u32 m0, s45, 11264
s_mov_b32 s44, 4587520
buffer_load_dwordx4 v16, s[4:7], s44 offen lds
s_add_u32 m0, s45, 12288
s_mov_b32 s44, 4718592
buffer_load_dwordx4 v16, s[4:7], s44 offen lds
s_add_u32 m0, s45, 13312
s_mov_b32 s44, 4849664
buffer_load_dwordx4 v16, s[4:7], s44 offen lds
s_add_u32 m0, s45, 14336
s_mov_b32 s44, 4980736
buffer_load_dwordx4 v16, s[4:7], s44 offen lds
s_add_u32 m0, s45, 15360
s_mov_b32 s44, 5111808
buffer_load_dwordx4 v16, s[4:7], s44 offen lds
s_waitcnt lgkmcnt(0)
v_mfma_f32_16x16x32_bf16 v[52:55], a[32:35], v[20:23], v[52:55]
v_mfma_f32_16x16x32_bf16 v[56:59], a[36:39], v[20:23], v[56:59]
v_mfma_f32_16x16x32_bf16 v[60:63], a[32:35], v[24:27], v[60:63]
v_mfma_f32_16x16x32_bf16 v[64:67], a[36:39], v[24:27], v[64:67]
v_mfma_f32_16x16x32_bf16 v[52:55], a[40:43], v[28:31], v[52:55]
v_mfma_f32_16x16x32_bf16 v[56:59], a[44:47], v[28:31], v[56:59]
v_mfma_f32_16x16x32_bf16 v[60:63], a[40:43], v[32:35], v[60:63]
v_mfma_f32_16x16x32_bf16 v[64:67], a[44:47], v[32:35], v[64:67]
v_mfma_f32_16x16x32_bf16 v[52:55], a[48:51], v[36:39], v[52:55]
v_mfma_f32_16x16x32_bf16 v[56:59], a[52:55], v[36:39], v[56:59]
v_mfma_f32_16x16x32_bf16 v[60:63], a[48:51], v[40:43], v[60:63]
v_mfma_f32_16x16x32_bf16 v[64:67], a[52:55], v[40:43], v[64:67]
v_mfma_f32_16x16x32_bf16 v[52:55], a[56:59], v[44:47], v[52:55]
v_mfma_f32_16x16x32_bf16 v[56:59], a[60:63], v[44:47], v[56:59]
v_mfma_f32_16x16x32_bf16 v[60:63], a[56:59], v[48:51], v[60:63]
v_mfma_f32_16x16x32_bf16 v[64:67], a[60:63], v[48:51], v[64:67]
s_waitcnt vmcnt(18)
ds_read_b64_tr_b16 a[64:65], v17 offset:16384
ds_read_b64_tr_b16 a[66:67], v17 offset:16640
ds_read_b64_tr_b16 a[68:69], v17 offset:16392
ds_read_b64_tr_b16 a[70:71], v17 offset:16648
ds_read_b64_tr_b16 a[72:73], v17 offset:18432
ds_read_b64_tr_b16 a[74:75], v17 offset:18688
ds_read_b64_tr_b16 a[76:77], v17 offset:18440
ds_read_b64_tr_b16 a[78:79], v17 offset:18696
s_waitcnt lgkmcnt(0)
ds_read_b64_tr_b16 a[80:81], v17 offset:20480
ds_read_b64_tr_b16 a[82:83], v17 offset:20736
ds_read_b64_tr_b16 a[84:85], v17 offset:20488
ds_read_b64_tr_b16 a[86:87], v17 offset:20744
ds_read_b64_tr_b16 a[88:89], v17 offset:22528
ds_read_b64_tr_b16 a[90:91], v17 offset:22784
ds_read_b64_tr_b16 a[92:93], v17 offset:22536
ds_read_b64_tr_b16 a[94:95], v17 offset:22792
s_waitcnt lgkmcnt(0)
ds_read_b128 v[20:23], v8 offset:16384
ds_read_b128 v[24:27], v8 offset:18432
ds_read_b128 v[28:31], v9 offset:16384
ds_read_b128 v[32:35], v9 offset:18432
ds_read_b128 v[36:39], v8 offset:20480
ds_read_b128 v[40:43], v8 offset:22528
ds_read_b128 v[44:47], v9 offset:20480
ds_read_b128 v[48:51], v9 offset:22528
s_mov_b32 s44, 5242880
buffer_load_dword v250, v12, s[4:7], s44 offen
s_add_u32 m0, s45, 16384
s_mov_b32 s44, 5242880
buffer_load_dwordx4 v16, s[4:7], s44 offen lds
s_add_u32 m0, s45, 17408
s_mov_b32 s44, 5373952
buffer_load_dwordx4 v16, s[4:7], s44 offen lds
s_add_u32 m0, s45, 18432
s_mov_b32 s44, 5505024
buffer_load_dwordx4 v16, s[4:7], s44 offen lds
s_add_u32 m0, s45, 19456
s_mov_b32 s44, 5636096
buffer_load_dwordx4 v16, s[4:7], s44 offen lds
s_add_u32 m0, s45, 20480
s_mov_b32 s44, 5767168
buffer_load_dwordx4 v16, s[4:7], s44 offen lds
s_add_u32 m0, s45, 21504
s_mov_b32 s44, 5898240
buffer_load_dwordx4 v16, s[4:7], s44 offen lds
s_add_u32 m0, s45, 22528
s_mov_b32 s44, 6029312
buffer_load_dwordx4 v16, s[4:7], s44 offen lds
s_add_u32 m0, s45, 23552
s_mov_b32 s44, 6160384
buffer_load_dwordx4 v16, s[4:7], s44 offen lds
s_waitcnt lgkmcnt(0)
v_mfma_f32_16x16x32_bf16 v[52:55], a[64:67], v[20:23], v[52:55]
v_mfma_f32_16x16x32_bf16 v[56:59], a[68:71], v[20:23], v[56:59]
v_mfma_f32_16x16x32_bf16 v[60:63], a[64:67], v[24:27], v[60:63]
v_mfma_f32_16x16x32_bf16 v[64:67], a[68:71], v[24:27], v[64:67]
v_mfma_f32_16x16x32_bf16 v[52:55], a[72:75], v[28:31], v[52:55]
v_mfma_f32_16x16x32_bf16 v[56:59], a[76:79], v[28:31], v[56:59]
v_mfma_f32_16x16x32_bf16 v[60:63], a[72:75], v[32:35], v[60:63]
v_mfma_f32_16x16x32_bf16 v[64:67], a[76:79], v[32:35], v[64:67]
v_mfma_f32_16x16x32_bf16 v[52:55], a[80:83], v[36:39], v[52:55]
v_mfma_f32_16x16x32_bf16 v[56:59], a[84:87], v[36:39], v[56:59]
v_mfma_f32_16x16x32_bf16 v[60:63], a[80:83], v[40:43], v[60:63]
v_mfma_f32_16x16x32_bf16 v[64:67], a[84:87], v[40:43], v[64:67]
v_mfma_f32_16x16x32_bf16 v[52:55], a[88:91], v[44:47], v[52:55]
v_mfma_f32_16x16x32_bf16 v[56:59], a[92:95], v[44:47], v[56:59]
v_mfma_f32_16x16x32_bf16 v[60:63], a[88:91], v[48:51], v[60:63]
v_mfma_f32_16x16x32_bf16 v[64:67], a[92:95], v[48:51], v[64:67]
s_waitcnt vmcnt(18)
ds_read_b64_tr_b16 a[96:97], v17 offset:0
ds_read_b64_tr_b16 a[98:99], v17 offset:256
ds_read_b64_tr_b16 a[100:101], v17 offset:8
ds_read_b64_tr_b16 a[102:103], v17 offset:264
ds_read_b64_tr_b16 a[104:105], v17 offset:2048
ds_read_b64_tr_b16 a[106:107], v17 offset:2304
ds_read_b64_tr_b16 a[108:109], v17 offset:2056
ds_read_b64_tr_b16 a[110:111], v17 offset:2312
s_waitcnt lgkmcnt(0)
ds_read_b64_tr_b16 a[112:113], v17 offset:4096
ds_read_b64_tr_b16 a[114:115], v17 offset:4352
ds_read_b64_tr_b16 a[116:117], v17 offset:4104
ds_read_b64_tr_b16 a[118:119], v17 offset:4360
ds_read_b64_tr_b16 a[120:121], v17 offset:6144
ds_read_b64_tr_b16 a[122:123], v17 offset:6400
ds_read_b64_tr_b16 a[124:125], v17 offset:6152
ds_read_b64_tr_b16 a[126:127], v17 offset:6408
s_waitcnt lgkmcnt(0)
ds_read_b128 v[20:23], v8 offset:24576
ds_read_b128 v[24:27], v8 offset:26624
ds_read_b128 v[28:31], v9 offset:24576
ds_read_b128 v[32:35], v9 offset:26624
ds_read_b128 v[36:39], v8 offset:28672
ds_read_b128 v[40:43], v8 offset:30720
ds_read_b128 v[44:47], v9 offset:28672
ds_read_b128 v[48:51], v9 offset:30720
s_mov_b32 s44, 6291456
buffer_load_dword v250, v12, s[4:7], s44 offen
s_add_u32 m0, s45, 0
s_mov_b32 s44, 6291456
buffer_load_dwordx4 v16, s[4:7], s44 offen lds
s_add_u32 m0, s45, 1024
s_mov_b32 s44, 6422528
buffer_load_dwordx4 v16, s[4:7], s44 offen lds
s_add_u32 m0, s45, 2048
s_mov_b32 s44, 6553600
buffer_load_dwordx4 v16, s[4:7], s44 offen lds
s_add_u32 m0, s45, 3072
s_mov_b32 s44, 6684672
buffer_load_dwordx4 v16, s[4:7], s44 offen lds
s_add_u32 m0, s45, 4096
s_mov_b32 s44, 6815744
buffer_load_dwordx4 v16, s[4:7], s44 offen lds
s_add_u32 m0, s45, 5120
s_mov_b32 s44, 6946816
buffer_load_dwordx4 v16, s[4:7], s44 offen lds
s_add_u32 m0, s45, 6144
s_mov_b32 s44, 7077888
buffer_load_dwordx4 v16, s[4:7], s44 offen lds
s_add_u32 m0, s45, 7168
s_mov_b32 s44, 7208960
buffer_load_dwordx4 v16, s[4:7], s44 offen lds
s_waitcnt lgkmcnt(0)
v_mfma_f32_16x16x32_bf16 v[52:55], a[96:99], v[20:23], v[52:55]
v_mfma_f32_16x16x32_bf16 v[56:59], a[100:103], v[20:23], v[56:59]
v_mfma_f32_16x16x32_bf16 v[60:63], a[96:99], v[24:27], v[60:63]
v_mfma_f32_16x16x32_bf16 v[64:67], a[100:103], v[24:27], v[64:67]
v_mfma_f32_16x16x32_bf16 v[52:55], a[104:107], v[28:31], v[52:55]
v_mfma_f32_16x16x32_bf16 v[56:59], a[108:111], v[28:31], v[56:59]
v_mfma_f32_16x16x32_bf16 v[60:63], a[104:107], v[32:35], v[60:63]
v_mfma_f32_16x16x32_bf16 v[64:67], a[108:111], v[32:35], v[64:67]
v_mfma_f32_16x16x32_bf16 v[52:55], a[112:115], v[36:39], v[52:55]
v_mfma_f32_16x16x32_bf16 v[56:59], a[116:119], v[36:39], v[56:59]
v_mfma_f32_16x16x32_bf16 v[60:63], a[112:115], v[40:43], v[60:63]
v_mfma_f32_16x16x32_bf16 v[64:67], a[116:119], v[40:43], v[64:67]
v_mfma_f32_16x16x32_bf16 v[52:55], a[120:123], v[44:47], v[52:55]
v_mfma_f32_16x16x32_bf16 v[56:59], a[124:127], v[44:47], v[56:59]
v_mfma_f32_16x16x32_bf16 v[60:63], a[120:123], v[48:51], v[60:63]
v_mfma_f32_16x16x32_bf16 v[64:67], a[124:127], v[48:51], v[64:67]
s_waitcnt vmcnt(18)
ds_read_b64_tr_b16 a[128:129], v17 offset:8192
ds_read_b64_tr_b16 a[130:131], v17 offset:8448
ds_read_b64_tr_b16 a[132:133], v17 offset:8200
ds_read_b64_tr_b16 a[134:135], v17 offset:8456
ds_read_b64_tr_b16 a[136:137], v17 offset:10240
ds_read_b64_tr_b16 a[138:139], v17 offset:10496
ds_read_b64_tr_b16 a[140:141], v17 offset:10248
ds_read_b64_tr_b16 a[142:143], v17 offset:10504
s_waitcnt lgkmcnt(0)
ds_read_b64_tr_b16 a[144:145], v17 offset:12288
ds_read_b64_tr_b16 a[146:147], v17 offset:12544
ds_read_b64_tr_b16 a[148:149], v17 offset:12296
ds_read_b64_tr_b16 a[150:151], v17 offset:12552
ds_read_b64_tr_b16 a[152:153], v17 offset:14336
ds_read_b64_tr_b16 a[154:155], v17 offset:14592
ds_read_b64_tr_b16 a[156:157], v17 offset:14344
ds_read_b64_tr_b16 a[158:159], v17 offset:14600
s_waitcnt lgkmcnt(0)
ds_read_b128 v[20:23], v8 offset:32768
ds_read_b128 v[24:27], v8 offset:34816
ds_read_b128 v[28:31], v9 offset:32768
ds_read_b128 v[32:35], v9 offset:34816
ds_read_b128 v[36:39], v8 offset:36864
ds_read_b128 v[40:43], v8 offset:38912
ds_read_b128 v[44:47], v9 offset:36864
ds_read_b128 v[48:51], v9 offset:38912
s_mov_b32 s44, 7340032
buffer_load_dword v250, v12, s[4:7], s44 offen
s_add_u32 m0, s45, 8192
s_mov_b32 s44, 7340032
buffer_load_dwordx4 v16, s[4:7], s44 offen lds
s_add_u32 m0, s45, 9216
s_mov_b32 s44, 7471104
buffer_load_dwordx4 v16, s[4:7], s44 offen lds
s_add_u32 m0, s45, 10240
s_mov_b32 s44, 7602176
buffer_load_dwordx4 v16, s[4:7], s44 offen lds
s_add_u32 m0, s45, 11264
s_mov_b32 s44, 7733248
buffer_load_dwordx4 v16, s[4:7], s44 offen lds
s_add_u32 m0, s45, 12288
s_mov_b32 s44, 7864320
buffer_load_dwordx4 v16, s[4:7], s44 offen lds
s_add_u32 m0, s45, 13312
s_mov_b32 s44, 7995392
buffer_load_dwordx4 v16, s[4:7], s44 offen lds
s_add_u32 m0, s45, 14336
s_mov_b32 s44, 8126464
buffer_load_dwordx4 v16, s[4:7], s44 offen lds
s_add_u32 m0, s45, 15360
s_mov_b32 s44, 8257536
buffer_load_dwordx4 v16, s[4:7], s44 offen lds
s_waitcnt lgkmcnt(0)
v_mfma_f32_16x16x32_bf16 v[52:55], a[128:131], v[20:23], v[52:55]
v_mfma_f32_16x16x32_bf16 v[56:59], a[132:135], v[20:23], v[56:59]
v_mfma_f32_16x16x32_bf16 v[60:63], a[128:131], v[24:27], v[60:63]
v_mfma_f32_16x16x32_bf16 v[64:67], a[132:135], v[24:27], v[64:67]
v_mfma_f32_16x16x32_bf16 v[52:55], a[136:139], v[28:31], v[52:55]
v_mfma_f32_16x16x32_bf16 v[56:59], a[140:143], v[28:31], v[56:59]
v_mfma_f32_16x16x32_bf16 v[60:63], a[136:139], v[32:35], v[60:63]
v_mfma_f32_16x16x32_bf16 v[64:67], a[140:143], v[32:35], v[64:67]
v_mfma_f32_16x16x32_bf16 v[52:55], a[144:147], v[36:39], v[52:55]
v_mfma_f32_16x16x32_bf16 v[56:59], a[148:151], v[36:39], v[56:59]
v_mfma_f32_16x16x32_bf16 v[60:63], a[144:147], v[40:43], v[60:63]
v_mfma_f32_16x16x32_bf16 v[64:67], a[148:151], v[40:43], v[64:67]
v_mfma_f32_16x16x32_bf16 v[52:55], a[152:155], v[44:47], v[52:55]
v_mfma_f32_16x16x32_bf16 v[56:59], a[156:159], v[44:47], v[56:59]
v_mfma_f32_16x16x32_bf16 v[60:63], a[152:155], v[48:51], v[60:63]
v_mfma_f32_16x16x32_bf16 v[64:67], a[156:159], v[48:51], v[64:67]
s_waitcnt vmcnt(18)
ds_read_b64_tr_b16 a[160:161], v17 offset:16384
ds_read_b64_tr_b16 a[162:163], v17 offset:16640
ds_read_b64_tr_b16 a[164:165], v17 offset:16392
ds_read_b64_tr_b16 a[166:167], v17 offset:16648
ds_read_b64_tr_b16 a[168:169], v17 offset:18432
ds_read_b64_tr_b16 a[170:171], v17 offset:18688
ds_read_b64_tr_b16 a[172:173], v17 offset:18440
ds_read_b64_tr_b16 a[174:175], v17 offset:18696
s_waitcnt lgkmcnt(0)
ds_read_b64_tr_b16 a[176:177], v17 offset:20480
ds_read_b64_tr_b16 a[178:179], v17 offset:20736
ds_read_b64_tr_b16 a[180:181], v17 offset:20488
ds_read_b64_tr_b16 a[182:183], v17 offset:20744
ds_read_b64_tr_b16 a[184:185], v17 offset:22528
ds_read_b64_tr_b16 a[186:187], v17 offset:22784
ds_read_b64_tr_b16 a[188:189], v17 offset:22536
ds_read_b64_tr_b16 a[190:191], v17 offset:22792
s_waitcnt lgkmcnt(0)
ds_read_b128 v[20:23], v8 offset:40960
ds_read_b128 v[24:27], v8 offset:43008
ds_read_b128 v[28:31], v9 offset:40960
ds_read_b128 v[32:35], v9 offset:43008
ds_read_b128 v[36:39], v8 offset:45056
ds_read_b128 v[40:43], v8 offset:47104
ds_read_b128 v[44:47], v9 offset:45056
ds_read_b128 v[48:51], v9 offset:47104
s_waitcnt lgkmcnt(0)
v_mfma_f32_16x16x32_bf16 v[52:55], a[160:163], v[20:23], v[52:55]
v_mfma_f32_16x16x32_bf16 v[56:59], a[164:167], v[20:23], v[56:59]
v_mfma_f32_16x16x32_bf16 v[60:63], a[160:163], v[24:27], v[60:63]
v_mfma_f32_16x16x32_bf16 v[64:67], a[164:167], v[24:27], v[64:67]
v_mfma_f32_16x16x32_bf16 v[52:55], a[168:171], v[28:31], v[52:55]
v_mfma_f32_16x16x32_bf16 v[56:59], a[172:175], v[28:31], v[56:59]
v_mfma_f32_16x16x32_bf16 v[60:63], a[168:171], v[32:35], v[60:63]
v_mfma_f32_16x16x32_bf16 v[64:67], a[172:175], v[32:35], v[64:67]
v_mfma_f32_16x16x32_bf16 v[52:55], a[176:179], v[36:39], v[52:55]
v_mfma_f32_16x16x32_bf16 v[56:59], a[180:183], v[36:39], v[56:59]
v_mfma_f32_16x16x32_bf16 v[60:63], a[176:179], v[40:43], v[60:63]
v_mfma_f32_16x16x32_bf16 v[64:67], a[180:183], v[40:43], v[64:67]
v_mfma_f32_16x16x32_bf16 v[52:55], a[184:187], v[44:47], v[52:55]
v_mfma_f32_16x16x32_bf16 v[56:59], a[188:191], v[44:47], v[56:59]
v_mfma_f32_16x16x32_bf16 v[60:63], a[184:187], v[48:51], v[60:63]
v_mfma_f32_16x16x32_bf16 v[64:67], a[188:191], v[48:51], v[64:67]
s_waitcnt vmcnt(9)
ds_read_b64_tr_b16 a[192:193], v17 offset:0
ds_read_b64_tr_b16 a[194:195], v17 offset:256
ds_read_b64_tr_b16 a[196:197], v17 offset:8
ds_read_b64_tr_b16 a[198:199], v17 offset:264
ds_read_b64_tr_b16 a[200:201], v17 offset:2048
ds_read_b64_tr_b16 a[202:203], v17 offset:2304
ds_read_b64_tr_b16 a[204:205], v17 offset:2056
ds_read_b64_tr_b16 a[206:207], v17 offset:2312
s_waitcnt lgkmcnt(0)
ds_read_b64_tr_b16 a[208:209], v17 offset:4096
ds_read_b64_tr_b16 a[210:211], v17 offset:4352
ds_read_b64_tr_b16 a[212:213], v17 offset:4104
ds_read_b64_tr_b16 a[214:215], v17 offset:4360
ds_read_b64_tr_b16 a[216:217], v17 offset:6144
ds_read_b64_tr_b16 a[218:219], v17 offset:6400
ds_read_b64_tr_b16 a[220:221], v17 offset:6152
ds_read_b64_tr_b16 a[222:223], v17 offset:6408
s_waitcnt lgkmcnt(0)
ds_read_b128 v[20:23], v8 offset:49152
ds_read_b128 v[24:27], v8 offset:51200
ds_read_b128 v[28:31], v9 offset:49152
ds_read_b128 v[32:35], v9 offset:51200
ds_read_b128 v[36:39], v8 offset:53248
ds_read_b128 v[40:43], v8 offset:55296
ds_read_b128 v[44:47], v9 offset:53248
ds_read_b128 v[48:51], v9 offset:55296
s_waitcnt lgkmcnt(0)
v_mfma_f32_16x16x32_bf16 v[52:55], a[192:195], v[20:23], v[52:55]
v_mfma_f32_16x16x32_bf16 v[56:59], a[196:199], v[20:23], v[56:59]
v_mfma_f32_16x16x32_bf16 v[60:63], a[192:195], v[24:27], v[60:63]
v_mfma_f32_16x16x32_bf16 v[64:67], a[196:199], v[24:27], v[64:67]
v_mfma_f32_16x16x32_bf16 v[52:55], a[200:203], v[28:31], v[52:55]
v_mfma_f32_16x16x32_bf16 v[56:59], a[204:207], v[28:31], v[56:59]
v_mfma_f32_16x16x32_bf16 v[60:63], a[200:203], v[32:35], v[60:63]
v_mfma_f32_16x16x32_bf16 v[64:67], a[204:207], v[32:35], v[64:67]
v_mfma_f32_16x16x32_bf16 v[52:55], a[208:211], v[36:39], v[52:55]
v_mfma_f32_16x16x32_bf16 v[56:59], a[212:215], v[36:39], v[56:59]
v_mfma_f32_16x16x32_bf16 v[60:63], a[208:211], v[40:43], v[60:63]
v_mfma_f32_16x16x32_bf16 v[64:67], a[212:215], v[40:43], v[64:67]
v_mfma_f32_16x16x32_bf16 v[52:55], a[216:219], v[44:47], v[52:55]
v_mfma_f32_16x16x32_bf16 v[56:59], a[220:223], v[44:47], v[56:59]
v_mfma_f32_16x16x32_bf16 v[60:63], a[216:219], v[48:51], v[60:63]
v_mfma_f32_16x16x32_bf16 v[64:67], a[220:223], v[48:51], v[64:67]
s_waitcnt vmcnt(0)
ds_read_b64_tr_b16 a[224:225], v17 offset:8192
ds_read_b64_tr_b16 a[226:227], v17 offset:8448
ds_read_b64_tr_b16 a[228:229], v17 offset:8200
ds_read_b64_tr_b16 a[230:231], v17 offset:8456
ds_read_b64_tr_b16 a[232:233], v17 offset:10240
ds_read_b64_tr_b16 a[234:235], v17 offset:10496
ds_read_b64_tr_b16 a[236:237], v17 offset:10248
ds_read_b64_tr_b16 a[238:239], v17 offset:10504
s_waitcnt lgkmcnt(0)
ds_read_b64_tr_b16 a[240:241], v17 offset:12288
ds_read_b64_tr_b16 a[242:243], v17 offset:12544
ds_read_b64_tr_b16 a[244:245], v17 offset:12296
ds_read_b64_tr_b16 a[246:247], v17 offset:12552
ds_read_b64_tr_b16 a[248:249], v17 offset:14336
ds_read_b64_tr_b16 a[250:251], v17 offset:14592
ds_read_b64_tr_b16 a[252:253], v17 offset:14344
ds_read_b64_tr_b16 a[254:255], v17 offset:14600
s_waitcnt lgkmcnt(0)
ds_read_b128 v[20:23], v8 offset:57344
ds_read_b128 v[24:27], v8 offset:59392
ds_read_b128 v[28:31], v9 offset:57344
ds_read_b128 v[32:35], v9 offset:59392
ds_read_b128 v[36:39], v8 offset:61440
ds_read_b128 v[40:43], v8 offset:63488
ds_read_b128 v[44:47], v9 offset:61440
ds_read_b128 v[48:51], v9 offset:63488
s_waitcnt lgkmcnt(0)
v_mfma_f32_16x16x32_bf16 v[52:55], a[224:227], v[20:23], v[52:55]
v_mfma_f32_16x16x32_bf16 v[56:59], a[228:231], v[20:23], v[56:59]
v_mfma_f32_16x16x32_bf16 v[60:63], a[224:227], v[24:27], v[60:63]
v_mfma_f32_16x16x32_bf16 v[64:67], a[228:231], v[24:27], v[64:67]
v_mfma_f32_16x16x32_bf16 v[52:55], a[232:235], v[28:31], v[52:55]
v_mfma_f32_16x16x32_bf16 v[56:59], a[236:239], v[28:31], v[56:59]
v_mfma_f32_16x16x32_bf16 v[60:63], a[232:235], v[32:35], v[60:63]
v_mfma_f32_16x16x32_bf16 v[64:67], a[236:239], v[32:35], v[64:67]
v_mfma_f32_16x16x32_bf16 v[52:55], a[240:243], v[36:39], v[52:55]
v_mfma_f32_16x16x32_bf16 v[56:59], a[244:247], v[36:39], v[56:59]
v_mfma_f32_16x16x32_bf16 v[60:63], a[240:243], v[40:43], v[60:63]
v_mfma_f32_16x16x32_bf16 v[64:67], a[244:247], v[40:43], v[64:67]
v_mfma_f32_16x16x32_bf16 v[52:55], a[248:251], v[44:47], v[52:55]
v_mfma_f32_16x16x32_bf16 v[56:59], a[252:255], v[44:47], v[56:59]
v_mfma_f32_16x16x32_bf16 v[60:63], a[248:251], v[48:51], v[60:63]
v_mfma_f32_16x16x32_bf16 v[64:67], a[252:255], v[48:51], v[64:67]
s_barrier
s_mov_b32 s50, 0x10000
s_add_u32 m0, s46, 65536
s_nop 0
buffer_load_dwordx4 v6, s[8:11], s50 offen offset:0 lds
s_add_u32 m0, s46, 69504
s_nop 0
buffer_load_dwordx4 v6, s[8:11], s50 offen offset:128 lds
s_add_u32 m0, s46, 73472
s_nop 0
buffer_load_dwordx4 v6, s[8:11], s50 offen offset:256 lds
s_add_u32 m0, s46, 77440
s_nop 0
buffer_load_dwordx4 v6, s[8:11], s50 offen offset:384 lds
s_add_u32 m0, s46, 81408
s_nop 0
buffer_load_dwordx4 v6, s[8:11], s50 offen offset:512 lds
s_add_u32 m0, s46, 85376
s_nop 0
buffer_load_dwordx4 v6, s[8:11], s50 offen offset:640 lds
s_add_u32 m0, s46, 89344
s_nop 0
buffer_load_dwordx4 v6, s[8:11], s50 offen offset:768 lds
s_add_u32 m0, s46, 93312
s_nop 0
buffer_load_dwordx4 v6, s[8:11], s50 offen offset:896 lds
s_add_u32 m0, s46, 97280
s_nop 0
buffer_load_dwordx4 v6, s[8:11], s50 offen offset:1024 lds
s_add_u32 m0, s46, 101248
s_nop 0
buffer_load_dwordx4 v6, s[8:11], s50 offen offset:1152 lds
s_add_u32 m0, s46, 105216
s_nop 0
buffer_load_dwordx4 v6, s[8:11], s50 offen offset:1280 lds
s_add_u32 m0, s46, 109184
s_nop 0
buffer_load_dwordx4 v6, s[8:11], s50 offen offset:1408 lds
s_add_u32 m0, s46, 113152
s_nop 0
buffer_load_dwordx4 v6, s[8:11], s50 offen offset:1536 lds
s_add_u32 m0, s46, 117120
s_nop 0
buffer_load_dwordx4 v6, s[8:11], s50 offen offset:1664 lds
s_add_u32 m0, s46, 121088
s_nop 0
buffer_load_dwordx4 v6, s[8:11], s50 offen offset:1792 lds
s_add_u32 m0, s46, 125056
s_nop 0
buffer_load_dwordx4 v6, s[8:11], s50 offen offset:1920 lds
s_and_b32 s53, s47, 31
s_lshl_b32 s53, s53, 4
v_add_u32 v19, s53, v1
v_lshlrev_b32 v19, 7, v19
s_mov_b32 s42, 1
v_and_b32 v3, 15, v0
v_lshlrev_b32 v3, 4, v3
s_branch mega_kernel_syk
mega_kernel_sykw:
s_sleep 4
mega_kernel_syk:
buffer_load_dword v2, v3, s[72:75], 0 offen sc1
s_waitcnt vmcnt(0)
s_cmp_eq_u32 s95, 1
s_cbranch_scc0 mega_kernel_sykf
v_readlane_b32 s76, v2, 14
s_mov_b32 s98, 0
s_cmp_eq_u32 s76, 64
s_cbranch_scc0 mega_kernel_sykw
s_branch mega_kernel_sykd
mega_kernel_sykf:
s_mov_b32 s77, 0
s_mov_b32 s78, 0
v_readlane_b32 s76, v2, 0
s_add_u32 s77, s77, s76
s_xor_b32 s76, s76, 32
s_or_b32 s78, s78, s76
v_readlane_b32 s76, v2, 1
s_add_u32 s77, s77, s76
s_xor_b32 s76, s76, 32
s_or_b32 s78, s78, s76
v_readlane_b32 s76, v2, 2
s_add_u32 s77, s77, s76
s_xor_b32 s76, s76, 32
s_or_b32 s78, s78, s76
v_readlane_b32 s76, v2, 3
s_add_u32 s77, s77, s76
s_xor_b32 s76, s76, 32
s_or_b32 s78, s78, s76
v_readlane_b32 s76, v2, 4
s_add_u32 s77, s77, s76
s_xor_b32 s76, s76, 32
s_or_b32 s78, s78, s76
v_readlane_b32 s76, v2, 5
s_add_u32 s77, s77, s76
s_xor_b32 s76, s76, 32
s_or_b32 s78, s78, s76
v_readlane_b32 s76, v2, 6
s_add_u32 s77, s77, s76
s_xor_b32 s76, s76, 32
s_or_b32 s78, s78, s76
v_readlane_b32 s76, v2, 7
s_add_u32 s77, s77, s76
s_xor_b32 s76, s76, 32
s_or_b32 s78, s78, s76
s_cmp_eq_u32 s77, 256
s_cbranch_scc0 mega_kernel_sykw
v_mov_b32 v252, v2
s_cmp_eq_u32 s78, 0
s_cbranch_scc0 mega_kernel_slowent
v_readlane_b32 s76, v2, 10
v_readlane_b32 s77, v2, 8
s_cmp_eq_u32 s76, 64
s_cbranch_scc0 mega_kernel_sykw
s_cmp_gt_u32 s77, 32
s_cselect_b32 s98, 1, 0
mega_kernel_sykd:
s_lshr_b32 s44, s47, 3
s_xor_b32 s44, s44, s98
s_and_b32 s44, s44, 1
s_lshl_b32 s44, s44, 13
s_lshl_b32 s48, s47, 18
s_add_u32 s48, s48, s44
s_add_u32 s48, s48, 0
s_xor_b32 s44, s98, 1
s_lshl_b32 s44, s44, 13
s_lshl_b32 s49, s40, 7
s_add_u32 s49, s49, s44
s_lshl_b32 s44, s41, 2
s_add_u32 s49, s49, s44
s_add_u32 s49, s49, 69206016
v_mov_b32 v16, 0
v_cvt_pk_bf16_f32 v84, v52, v53
v_cvt_pk_bf16_f32 v85, v54, v55
v_cvt_pk_bf16_f32 v86, v56, v57
v_cvt_pk_bf16_f32 v87, v58, v59
v_cvt_pk_bf16_f32 v88, v60, v61
v_cvt_pk_bf16_f32 v89, v62, v63
v_cvt_pk_bf16_f32 v90, v64, v65
v_cvt_pk_bf16_f32 v91, v66, v67
s_add_u32 s51, s42, s47
s_sub_u32 s51, s51, 1
s_bfe_u32 s52, s51, 0x40002
s_lshl_b32 s52, s52, 14
s_and_b32 s51, s51, 3
s_lshl_b32 s51, s51, 11
s_add_u32 s51, s51, s52
s_add_u32 s51, s51, s48
buffer_store_dwordx4 v[84:87], v7, s[84:87], s51 offen sc1
buffer_store_dwordx4 v[88:91], v7, s[84:87], s51 offen offset:1024 sc1
s_waitcnt vmcnt(0)
v_mov_b32 v17, s42
s_mov_b64 exec, 1
buffer_store_dword v17, v16, s[84:87], s49 offen sc1
s_mov_b64 exec, -1
mega_kernel_k_loop:
s_waitcnt vmcnt(2)
s_barrier
s_add_u32 s50, s42, 1
s_min_u32 s50, s50, 63
s_lshl_b32 s50, s50, 16
ds_read_b128 v[20:23], v10 offset:0
ds_read_b128 v[24:27], v10 offset:2048
ds_read_b128 v[28:31], v11 offset:0
ds_read_b128 v[32:35], v11 offset:2048
ds_read_b128 v[36:39], v10 offset:4096
ds_read_b128 v[40:43], v10 offset:6144
s_waitcnt lgkmcnt(4)
v_mfma_f32_16x16x32_bf16 v[68:71], a[0:3], v[20:23], 0
ds_read_b128 v[44:47], v11 offset:4096
v_mfma_f32_16x16x32_bf16 v[72:75], a[4:7], v[20:23], 0
v_cvt_pk_bf16_f32 v84, v52, v53
v_cvt_pk_bf16_f32 v85, v54, v55
v_cvt_pk_bf16_f32 v86, v56, v57
v_mfma_f32_16x16x32_bf16 v[76:79], a[0:3], v[24:27], 0
ds_read_b128 v[48:51], v11 offset:6144
v_mfma_f32_16x16x32_bf16 v[80:83], a[4:7], v[24:27], 0
v_cvt_pk_bf16_f32 v87, v58, v59
v_cvt_pk_bf16_f32 v88, v60, v61
v_cvt_pk_bf16_f32 v89, v62, v63
s_waitcnt lgkmcnt(4)
v_mfma_f32_16x16x32_bf16 v[68:71], a[8:11], v[28:31], v[68:71]
ds_read_b128 v[20:23], v10 offset:8192
v_mfma_f32_16x16x32_bf16 v[72:75], a[12:15], v[28:31], v[72:75]
v_cvt_pk_bf16_f32 v90, v64, v65
v_cvt_pk_bf16_f32 v91, v66, v67
v_mfma_f32_16x16x32_bf16 v[76:79], a[8:11], v[32:35], v[76:79]
ds_read_b128 v[24:27], v10 offset:10240
v_mfma_f32_16x16x32_bf16 v[80:83], a[12:15], v[32:35], v[80:83]
s_add_u32 s51, s42, s47
s_sub_u32 s51, s51, 1
s_bfe_u32 s52, s51, 0x40002
s_lshl_b32 s52, s52, 14
s_waitcnt lgkmcnt(4)
v_mfma_f32_16x16x32_bf16 v[68:71], a[16:19], v[36:39], v[68:71]
ds_read_b128 v[28:31], v11 offset:8192
v_mfma_f32_16x16x32_bf16 v[72:75], a[20:23], v[36:39], v[72:75]
s_and_b32 s51, s51, 3
s_lshl_b32 s51, s51, 11
s_add_u32 s51, s51, s52
s_add_u32 s51, s51, s48
buffer_store_dwordx4 v[84:87], v7, s[84:87], s51 offen sc1
v_mfma_f32_16x16x32_bf16 v[76:79], a[16:19], v[40:43], v[76:79]
ds_read_b128 v[32:35], v11 offset:10240
v_mfma_f32_16x16x32_bf16 v[80:83], a[20:23], v[40:43], v[80:83]
buffer_store_dwordx4 v[88:91], v7, s[84:87], s51 offen offset:1024 sc1
s_waitcnt lgkmcnt(4)
v_mfma_f32_16x16x32_bf16 v[68:71], a[24:27], v[44:47], v[68:71]
ds_read_b128 v[36:39], v10 offset:12288
v_mfma_f32_16x16x32_bf16 v[72:75], a[28:31], v[44:47], v[72:75]
s_add_u32 m0, s46, 0
v_mfma_f32_16x16x32_bf16 v[76:79], a[24:27], v[48:51], v[76:79]
ds_read_b128 v[40:43], v10 offset:14336
v_mfma_f32_16x16x32_bf16 v[80:83], a[28:31], v[48:51], v[80:83]
buffer_load_dwordx4 v6, s[8:11], s50 offen offset:0 lds
s_waitcnt lgkmcnt(4)
v_mfma_f32_16x16x32_bf16 v[68:71], a[32:35], v[20:23], v[68:71]
ds_read_b128 v[44:47], v11 offset:12288
v_mfma_f32_16x16x32_bf16 v[72:75], a[36:39], v[20:23], v[72:75]
s_add_u32 m0, s46, 3968
v_mfma_f32_16x16x32_bf16 v[76:79], a[32:35], v[24:27], v[76:79]
ds_read_b128 v[48:51], v11 offset:14336
v_mfma_f32_16x16x32_bf16 v[80:83], a[36:39], v[24:27], v[80:83]
buffer_load_dwordx4 v6, s[8:11], s50 offen offset:128 lds
s_waitcnt lgkmcnt(4)
v_mfma_f32_16x16x32_bf16 v[68:71], a[40:43], v[28:31], v[68:71]
ds_read_b128 v[20:23], v10 offset:16384
v_mfma_f32_16x16x32_bf16 v[72:75], a[44:47], v[28:31], v[72:75]
s_add_u32 m0, s46, 7936
v_mfma_f32_16x16x32_bf16 v[76:79], a[40:43], v[32:35], v[76:79]
ds_read_b128 v[24:27], v10 offset:18432
v_mfma_f32_16x16x32_bf16 v[80:83], a[44:47], v[32:35], v[80:83]
buffer_load_dwordx4 v6, s[8:11], s50 offen offset:256 lds
s_waitcnt lgkmcnt(4)
v_mfma_f32_16x16x32_bf16 v[68:71], a[48:51], v[36:39], v[68:71]
ds_read_b128 v[28:31], v11 offset:16384
v_mfma_f32_16x16x32_bf16 v[72:75], a[52:55], v[36:39], v[72:75]
s_add_u32 m0, s46, 11904
v_mfma_f32_16x16x32_bf16 v[76:79], a[48:51], v[40:43], v[76:79]
ds_read_b128 v[32:35], v11 offset:18432
v_mfma_f32_16x16x32_bf16 v[80:83], a[52:55], v[40:43], v[80:83]
buffer_load_dwordx4 v6, s[8:11], s50 offen offset:384 lds
s_waitcnt lgkmcnt(4)
v_mfma_f32_16x16x32_bf16 v[68:71], a[56:59], v[44:47], v[68:71]
ds_read_b128 v[36:39], v10 offset:20480
v_mfma_f32_16x16x32_bf16 v[72:75], a[60:63], v[44:47], v[72:75]
s_add_u32 m0, s46, 15872
v_mfma_f32_16x16x32_bf16 v[76:79], a[56:59], v[48:51], v[76:79]
ds_read_b128 v[40:43], v10 offset:22528
v_mfma_f32_16x16x32_bf16 v[80:83], a[60:63], v[48:51], v[80:83]
buffer_load_dwordx4 v6, s[8:11], s50 offen offset:512 lds
s_waitcnt lgkmcnt(4)
v_mfma_f32_16x16x32_bf16 v[68:71], a[64:67], v[20:23], v[68:71]
ds_read_b128 v[44:47], v11 offset:20480
v_mfma_f32_16x16x32_bf16 v[72:75], a[68:71], v[20:23], v[72:75]
s_add_u32 m0, s46, 19840
v_mfma_f32_16x16x32_bf16 v[76:79], a[64:67], v[24:27], v[76:79]
ds_read_b128 v[48:51], v11 offset:22528
v_mfma_f32_16x16x32_bf16 v[80:83], a[68:71], v[24:27], v[80:83]
buffer_load_dwordx4 v6, s[8:11], s50 offen offset:640 lds
s_waitcnt lgkmcnt(4)
v_mfma_f32_16x16x32_bf16 v[68:71], a[72:75], v[28:31], v[68:71]
ds_read_b128 v[20:23], v10 offset:24576
v_mfma_f32_16x16x32_bf16 v[72:75], a[76:79], v[28:31], v[72:75]
s_add_u32 m0, s46, 23808
v_mfma_f32_16x16x32_bf16 v[76:79], a[72:75], v[32:35], v[76:79]
ds_read_b128 v[24:27], v10 offset:26624
v_mfma_f32_16x16x32_bf16 v[80:83], a[76:79], v[32:35], v[80:83]
buffer_load_dwordx4 v6, s[8:11], s50 offen offset:768 lds
s_waitcnt lgkmcnt(4)
v_mfma_f32_16x16x32_bf16 v[68:71], a[80:83], v[36:39], v[68:71]
ds_read_b128 v[28:31], v11 offset:24576
v_mfma_f32_16x16x32_bf16 v[72:75], a[84:87], v[36:39], v[72:75]
s_add_u32 m0, s46, 27776
v_mfma_f32_16x16x32_bf16 v[76:79], a[80:83], v[40:43], v[76:79]
ds_read_b128 v[32:35], v11 offset:26624
v_mfma_f32_16x16x32_bf16 v[80:83], a[84:87], v[40:43], v[80:83]
buffer_load_dwordx4 v6, s[8:11], s50 offen offset:896 lds
s_waitcnt lgkmcnt(4)
v_mfma_f32_16x16x32_bf16 v[68:71], a[88:91], v[44:47], v[68:71]
ds_read_b128 v[36:39], v10 offset:28672
v_mfma_f32_16x16x32_bf16 v[72:75], a[92:95], v[44:47], v[72:75]
s_add_u32 m0, s46, 31744
v_mfma_f32_16x16x32_bf16 v[76:79], a[88:91], v[48:51], v[76:79]
ds_read_b128 v[40:43], v10 offset:30720
v_mfma_f32_16x16x32_bf16 v[80:83], a[92:95], v[48:51], v[80:83]
buffer_load_dwordx4 v6, s[8:11], s50 offen offset:1024 lds
s_waitcnt lgkmcnt(4)
v_mfma_f32_16x16x32_bf16 v[68:71], a[96:99], v[20:23], v[68:71]
ds_read_b128 v[44:47], v11 offset:28672
v_mfma_f32_16x16x32_bf16 v[72:75], a[100:103], v[20:23], v[72:75]
s_add_u32 m0, s46, 35712
v_mfma_f32_16x16x32_bf16 v[76:79], a[96:99], v[24:27], v[76:79]
ds_read_b128 v[48:51], v11 offset:30720
v_mfma_f32_16x16x32_bf16 v[80:83], a[100:103], v[24:27], v[80:83]
buffer_load_dwordx4 v6, s[8:11], s50 offen offset:1152 lds
s_waitcnt lgkmcnt(4)
v_mfma_f32_16x16x32_bf16 v[68:71], a[104:107], v[28:31], v[68:71]
ds_read_b128 v[20:23], v10 offset:32768
v_mfma_f32_16x16x32_bf16 v[72:75], a[108:111], v[28:31], v[72:75]
s_add_u32 m0, s46, 39680
v_mfma_f32_16x16x32_bf16 v[76:79], a[104:107], v[32:35], v[76:79]
ds_read_b128 v[24:27], v10 offset:34816
v_mfma_f32_16x16x32_bf16 v[80:83], a[108:111], v[32:35], v[80:83]
buffer_load_dwordx4 v6, s[8:11], s50 offen offset:1280 lds
s_waitcnt lgkmcnt(4)
v_mfma_f32_16x16x32_bf16 v[68:71], a[112:115], v[36:39], v[68:71]
ds_read_b128 v[28:31], v11 offset:32768
v_mfma_f32_16x16x32_bf16 v[72:75], a[116:119], v[36:39], v[72:75]
s_add_u32 m0, s46, 43648
v_mfma_f32_16x16x32_bf16 v[76:79], a[112:115], v[40:43], v[76:79]
ds_read_b128 v[32:35], v11 offset:34816
v_mfma_f32_16x16x32_bf16 v[80:83], a[116:119], v[40:43], v[80:83]
buffer_load_dwordx4 v6, s[8:11], s50 offen offset:1408 lds
s_waitcnt lgkmcnt(4)
v_mfma_f32_16x16x32_bf16 v[68:71], a[120:123], v[44:47], v[68:71]
ds_read_b128 v[36:39], v10 offset:36864
v_mfma_f32_16x16x32_bf16 v[72:75], a[124:127], v[44:47], v[72:75]
s_add_u32 m0, s46, 47616
v_mfma_f32_16x16x32_bf16 v[76:79], a[120:123], v[48:51], v[76:79]
ds_read_b128 v[40:43], v10 offset:38912
v_mfma_f32_16x16x32_bf16 v[80:83], a[124:127], v[48:51], v[80:83]
buffer_load_dwordx4 v6, s[8:11], s50 offen offset:1536 lds
s_waitcnt lgkmcnt(4)
v_mfma_f32_16x16x32_bf16 v[68:71], a[128:131], v[20:23], v[68:71]
ds_read_b128 v[44:47], v11 offset:36864
v_mfma_f32_16x16x32_bf16 v[72:75], a[132:135], v[20:23], v[72:75]
s_add_u32 m0, s46, 51584
v_mfma_f32_16x16x32_bf16 v[76:79], a[128:131], v[24:27], v[76:79]
ds_read_b128 v[48:51], v11 offset:38912
v_mfma_f32_16x16x32_bf16 v[80:83], a[132:135], v[24:27], v[80:83]
buffer_load_dwordx4 v6, s[8:11], s50 offen offset:1664 lds
s_waitcnt lgkmcnt(4)
v_mfma_f32_16x16x32_bf16 v[68:71], a[136:139], v[28:31], v[68:71]
ds_read_b128 v[20:23], v10 offset:40960
v_mfma_f32_16x16x32_bf16 v[72:75], a[140:143], v[28:31], v[72:75]
s_add_u32 m0, s46, 55552
v_mfma_f32_16x16x32_bf16 v[76:79], a[136:139], v[32:35], v[76:79]
ds_read_b128 v[24:27], v10 offset:43008
v_mfma_f32_16x16x32_bf16 v[80:83], a[140:143], v[32:35], v[80:83]
buffer_load_dwordx4 v6, s[8:11], s50 offen offset:1792 lds
s_waitcnt lgkmcnt(4)
v_mfma_f32_16x16x32_bf16 v[68:71], a[144:147], v[36:39], v[68:71]
ds_read_b128 v[28:31], v11 offset:40960
v_mfma_f32_16x16x32_bf16 v[72:75], a[148:151], v[36:39], v[72:75]
s_add_u32 m0, s46, 59520
v_mfma_f32_16x16x32_bf16 v[76:79], a[144:147], v[40:43], v[76:79]
ds_read_b128 v[32:35], v11 offset:43008
v_mfma_f32_16x16x32_bf16 v[80:83], a[148:151], v[40:43], v[80:83]
buffer_load_dwordx4 v6, s[8:11], s50 offen offset:1920 lds
s_waitcnt lgkmcnt(4)
v_mfma_f32_16x16x32_bf16 v[68:71], a[152:155], v[44:47], v[68:71]
ds_read_b128 v[36:39], v10 offset:45056
v_mfma_f32_16x16x32_bf16 v[72:75], a[156:159], v[44:47], v[72:75]
v_mfma_f32_16x16x32_bf16 v[76:79], a[152:155], v[48:51], v[76:79]
ds_read_b128 v[40:43], v10 offset:47104
v_mfma_f32_16x16x32_bf16 v[80:83], a[156:159], v[48:51], v[80:83]
s_waitcnt lgkmcnt(4)
v_mfma_f32_16x16x32_bf16 v[68:71], a[160:163], v[20:23], v[68:71]
ds_read_b128 v[44:47], v11 offset:45056
v_mfma_f32_16x16x32_bf16 v[72:75], a[164:167], v[20:23], v[72:75]
v_mfma_f32_16x16x32_bf16 v[76:79], a[160:163], v[24:27], v[76:79]
ds_read_b128 v[48:51], v11 offset:47104
v_mfma_f32_16x16x32_bf16 v[80:83], a[164:167], v[24:27], v[80:83]
s_waitcnt lgkmcnt(4)
v_mfma_f32_16x16x32_bf16 v[68:71], a[168:171], v[28:31], v[68:71]
ds_read_b128 v[20:23], v10 offset:49152
v_mfma_f32_16x16x32_bf16 v[72:75], a[172:175], v[28:31], v[72:75]
s_waitcnt vmcnt(16)
v_mov_b32 v17, s42
s_mov_b64 exec, 1
buffer_store_dword v17, v16, s[84:87], s49 offen sc1
s_mov_b64 exec, -1
v_mfma_f32_16x16x32_bf16 v[76:79], a[168:171], v[32:35], v[76:79]
ds_read_b128 v[24:27], v10 offset:51200
v_mfma_f32_16x16x32_bf16 v[80:83], a[172:175], v[32:35], v[80:83]
s_waitcnt lgkmcnt(4)
v_mfma_f32_16x16x32_bf16 v[68:71], a[176:179], v[36:39], v[68:71]
ds_read_b128 v[28:31], v11 offset:49152
v_mfma_f32_16x16x32_bf16 v[72:75], a[180:183], v[36:39], v[72:75]
s_add_u32 s53, s42, 3
s_min_u32 s53, s53, 63
s_lshl_b32 s53, s53, 16
s_mov_b64 exec, 0xffff
buffer_load_dword v250, v19, s[8:11], s53 offen
s_mov_b64 exec, -1
v_mfma_f32_16x16x32_bf16 v[76:79], a[176:179], v[40:43], v[76:79]
ds_read_b128 v[32:35], v11 offset:51200
v_mfma_f32_16x16x32_bf16 v[80:83], a[180:183], v[40:43], v[80:83]
s_waitcnt lgkmcnt(4)
v_mfma_f32_16x16x32_bf16 v[68:71], a[184:187], v[44:47], v[68:71]
ds_read_b128 v[36:39], v10 offset:53248
v_mfma_f32_16x16x32_bf16 v[72:75], a[188:191], v[44:47], v[72:75]
v_mfma_f32_16x16x32_bf16 v[76:79], a[184:187], v[48:51], v[76:79]
ds_read_b128 v[40:43], v10 offset:55296
v_mfma_f32_16x16x32_bf16 v[80:83], a[188:191], v[48:51], v[80:83]
s_waitcnt lgkmcnt(4)
v_mfma_f32_16x16x32_bf16 v[68:71], a[192:195], v[20:23], v[68:71]
ds_read_b128 v[44:47], v11 offset:53248
v_mfma_f32_16x16x32_bf16 v[72:75], a[196:199], v[20:23], v[72:75]
v_mfma_f32_16x16x32_bf16 v[76:79], a[192:195], v[24:27], v[76:79]
ds_read_b128 v[48:51], v11 offset:55296
v_mfma_f32_16x16x32_bf16 v[80:83], a[196:199], v[24:27], v[80:83]
s_waitcnt lgkmcnt(4)
v_mfma_f32_16x16x32_bf16 v[68:71], a[200:203], v[28:31], v[68:71]
ds_read_b128 v[20:23], v10 offset:57344
v_mfma_f32_16x16x32_bf16 v[72:75], a[204:207], v[28:31], v[72:75]
v_mfma_f32_16x16x32_bf16 v[76:79], a[200:203], v[32:35], v[76:79]
ds_read_b128 v[24:27], v10 offset:59392
v_mfma_f32_16x16x32_bf16 v[80:83], a[204:207], v[32:35], v[80:83]
s_waitcnt lgkmcnt(4)
v_mfma_f32_16x16x32_bf16 v[68:71], a[208:211], v[36:39], v[68:71]
ds_read_b128 v[28:31], v11 offset:57344
v_mfma_f32_16x16x32_bf16 v[72:75], a[212:215], v[36:39], v[72:75]
v_mfma_f32_16x16x32_bf16 v[76:79], a[208:211], v[40:43], v[76:79]
ds_read_b128 v[32:35], v11 offset:59392
v_mfma_f32_16x16x32_bf16 v[80:83], a[212:215], v[40:43], v[80:83]
s_waitcnt lgkmcnt(4)
v_mfma_f32_16x16x32_bf16 v[68:71], a[216:219], v[44:47], v[68:71]
ds_read_b128 v[36:39], v10 offset:61440
v_mfma_f32_16x16x32_bf16 v[72:75], a[220:223], v[44:47], v[72:75]
v_mfma_f32_16x16x32_bf16 v[76:79], a[216:219], v[48:51], v[76:79]
ds_read_b128 v[40:43], v10 offset:63488
v_mfma_f32_16x16x32_bf16 v[80:83], a[220:223], v[48:51], v[80:83]
s_waitcnt lgkmcnt(4)
v_mfma_f32_16x16x32_bf16 v[68:71], a[224:227], v[20:23], v[68:71]
ds_read_b128 v[44:47], v11 offset:61440
v_mfma_f32_16x16x32_bf16 v[72:75], a[228:231], v[20:23], v[72:75]
v_mfma_f32_16x16x32_bf16 v[76:79], a[224:227], v[24:27], v[76:79]
ds_read_b128 v[48:51], v11 offset:63488
v_mfma_f32_16x16x32_bf16 v[80:83], a[228:231], v[24:27], v[80:83]
s_waitcnt lgkmcnt(5)
v_mfma_f32_16x16x32_bf16 v[68:71], a[232:235], v[28:31], v[68:71]
v_mfma_f32_16x16x32_bf16 v[72:75], a[236:239], v[28:31], v[72:75]
s_waitcnt lgkmcnt(4)
v_mfma_f32_16x16x32_bf16 v[76:79], a[232:235], v[32:35], v[76:79]
v_mfma_f32_16x16x32_bf16 v[80:83], a[236:239], v[32:35], v[80:83]
s_waitcnt lgkmcnt(3)
v_mfma_f32_16x16x32_bf16 v[68:71], a[240:243], v[36:39], v[68:71]
v_mfma_f32_16x16x32_bf16 v[72:75], a[244:247], v[36:39], v[72:75]
s_waitcnt lgkmcnt(2)
v_mfma_f32_16x16x32_bf16 v[76:79], a[240:243], v[40:43], v[76:79]
v_mfma_f32_16x16x32_bf16 v[80:83], a[244:247], v[40:43], v[80:83]
s_waitcnt lgkmcnt(1)
v_mfma_f32_16x16x32_bf16 v[68:71], a[248:251], v[44:47], v[68:71]
v_mfma_f32_16x16x32_bf16 v[72:75], a[252:255], v[44:47], v[72:75]
s_waitcnt lgkmcnt(0)
v_mfma_f32_16x16x32_bf16 v[76:79], a[248:251], v[48:51], v[76:79]
v_mfma_f32_16x16x32_bf16 v[80:83], a[252:255], v[48:51], v[80:83]
s_add_u32 s42, s42, 1
s_cmp_eq_u32 s42, 64
s_cbranch_scc1 mega_kernel_k_fin
s_waitcnt vmcnt(2)
s_barrier
s_add_u32 s50, s42, 1
s_min_u32 s50, s50, 63
s_lshl_b32 s50, s50, 16
ds_read_b128 v[20:23], v8 offset:0
ds_read_b128 v[24:27], v8 offset:2048
ds_read_b128 v[28:31], v9 offset:0
ds_read_b128 v[32:35], v9 offset:2048
ds_read_b128 v[36:39], v8 offset:4096
ds_read_b128 v[40:43], v8 offset:6144
s_waitcnt lgkmcnt(4)
v_mfma_f32_16x16x32_bf16 v[52:55], a[0:3], v[20:23], 0
ds_read_b128 v[44:47], v9 offset:4096
v_mfma_f32_16x16x32_bf16 v[56:59], a[4:7], v[20:23], 0
v_cvt_pk_bf16_f32 v84, v68, v69
v_cvt_pk_bf16_f32 v85, v70, v71
v_cvt_pk_bf16_f32 v86, v72, v73
v_mfma_f32_16x16x32_bf16 v[60:63], a[0:3], v[24:27], 0
ds_read_b128 v[48:51], v9 offset:6144
v_mfma_f32_16x16x32_bf16 v[64:67], a[4:7], v[24:27], 0
v_cvt_pk_bf16_f32 v87, v74, v75
v_cvt_pk_bf16_f32 v88, v76, v77
v_cvt_pk_bf16_f32 v89, v78, v79
s_waitcnt lgkmcnt(4)
v_mfma_f32_16x16x32_bf16 v[52:55], a[8:11], v[28:31], v[52:55]
ds_read_b128 v[20:23], v8 offset:8192
v_mfma_f32_16x16x32_bf16 v[56:59], a[12:15], v[28:31], v[56:59]
v_cvt_pk_bf16_f32 v90, v80, v81
v_cvt_pk_bf16_f32 v91, v82, v83
v_mfma_f32_16x16x32_bf16 v[60:63], a[8:11], v[32:35], v[60:63]
ds_read_b128 v[24:27], v8 offset:10240
v_mfma_f32_16x16x32_bf16 v[64:67], a[12:15], v[32:35], v[64:67]
s_add_u32 s51, s42, s47
s_sub_u32 s51, s51, 1
s_bfe_u32 s52, s51, 0x40002
s_lshl_b32 s52, s52, 14
s_waitcnt lgkmcnt(4)
v_mfma_f32_16x16x32_bf16 v[52:55], a[16:19], v[36:39], v[52:55]
ds_read_b128 v[28:31], v9 offset:8192
v_mfma_f32_16x16x32_bf16 v[56:59], a[20:23], v[36:39], v[56:59]
s_and_b32 s51, s51, 3
s_lshl_b32 s51, s51, 11
s_add_u32 s51, s51, s52
s_add_u32 s51, s51, s48
buffer_store_dwordx4 v[84:87], v7, s[84:87], s51 offen sc1
v_mfma_f32_16x16x32_bf16 v[60:63], a[16:19], v[40:43], v[60:63]
ds_read_b128 v[32:35], v9 offset:10240
v_mfma_f32_16x16x32_bf16 v[64:67], a[20:23], v[40:43], v[64:67]
buffer_store_dwordx4 v[88:91], v7, s[84:87], s51 offen offset:1024 sc1
s_waitcnt lgkmcnt(4)
v_mfma_f32_16x16x32_bf16 v[52:55], a[24:27], v[44:47], v[52:55]
ds_read_b128 v[36:39], v8 offset:12288
v_mfma_f32_16x16x32_bf16 v[56:59], a[28:31], v[44:47], v[56:59]
s_add_u32 m0, s46, 65536
v_mfma_f32_16x16x32_bf16 v[60:63], a[24:27], v[48:51], v[60:63]
ds_read_b128 v[40:43], v8 offset:14336
v_mfma_f32_16x16x32_bf16 v[64:67], a[28:31], v[48:51], v[64:67]
buffer_load_dwordx4 v6, s[8:11], s50 offen offset:0 lds
s_waitcnt lgkmcnt(4)
v_mfma_f32_16x16x32_bf16 v[52:55], a[32:35], v[20:23], v[52:55]
ds_read_b128 v[44:47], v9 offset:12288
v_mfma_f32_16x16x32_bf16 v[56:59], a[36:39], v[20:23], v[56:59]
s_add_u32 m0, s46, 69504
v_mfma_f32_16x16x32_bf16 v[60:63], a[32:35], v[24:27], v[60:63]
ds_read_b128 v[48:51], v9 offset:14336
v_mfma_f32_16x16x32_bf16 v[64:67], a[36:39], v[24:27], v[64:67]
buffer_load_dwordx4 v6, s[8:11], s50 offen offset:128 lds
s_waitcnt lgkmcnt(4)
v_mfma_f32_16x16x32_bf16 v[52:55], a[40:43], v[28:31], v[52:55]
ds_read_b128 v[20:23], v8 offset:16384
v_mfma_f32_16x16x32_bf16 v[56:59], a[44:47], v[28:31], v[56:59]
s_add_u32 m0, s46, 73472
v_mfma_f32_16x16x32_bf16 v[60:63], a[40:43], v[32:35], v[60:63]
ds_read_b128 v[24:27], v8 offset:18432
v_mfma_f32_16x16x32_bf16 v[64:67], a[44:47], v[32:35], v[64:67]
buffer_load_dwordx4 v6, s[8:11], s50 offen offset:256 lds
s_waitcnt lgkmcnt(4)
v_mfma_f32_16x16x32_bf16 v[52:55], a[48:51], v[36:39], v[52:55]
ds_read_b128 v[28:31], v9 offset:16384
v_mfma_f32_16x16x32_bf16 v[56:59], a[52:55], v[36:39], v[56:59]
s_add_u32 m0, s46, 77440
v_mfma_f32_16x16x32_bf16 v[60:63], a[48:51], v[40:43], v[60:63]
ds_read_b128 v[32:35], v9 offset:18432
v_mfma_f32_16x16x32_bf16 v[64:67], a[52:55], v[40:43], v[64:67]
buffer_load_dwordx4 v6, s[8:11], s50 offen offset:384 lds
s_waitcnt lgkmcnt(4)
v_mfma_f32_16x16x32_bf16 v[52:55], a[56:59], v[44:47], v[52:55]
ds_read_b128 v[36:39], v8 offset:20480
v_mfma_f32_16x16x32_bf16 v[56:59], a[60:63], v[44:47], v[56:59]
s_add_u32 m0, s46, 81408
v_mfma_f32_16x16x32_bf16 v[60:63], a[56:59], v[48:51], v[60:63]
ds_read_b128 v[40:43], v8 offset:22528
v_mfma_f32_16x16x32_bf16 v[64:67], a[60:63], v[48:51], v[64:67]
buffer_load_dwordx4 v6, s[8:11], s50 offen offset:512 lds
s_waitcnt lgkmcnt(4)
v_mfma_f32_16x16x32_bf16 v[52:55], a[64:67], v[20:23], v[52:55]
ds_read_b128 v[44:47], v9 offset:20480
v_mfma_f32_16x16x32_bf16 v[56:59], a[68:71], v[20:23], v[56:59]
s_add_u32 m0, s46, 85376
v_mfma_f32_16x16x32_bf16 v[60:63], a[64:67], v[24:27], v[60:63]
ds_read_b128 v[48:51], v9 offset:22528
v_mfma_f32_16x16x32_bf16 v[64:67], a[68:71], v[24:27], v[64:67]
buffer_load_dwordx4 v6, s[8:11], s50 offen offset:640 lds
s_waitcnt lgkmcnt(4)
v_mfma_f32_16x16x32_bf16 v[52:55], a[72:75], v[28:31], v[52:55]
ds_read_b128 v[20:23], v8 offset:24576
v_mfma_f32_16x16x32_bf16 v[56:59], a[76:79], v[28:31], v[56:59]
s_add_u32 m0, s46, 89344
v_mfma_f32_16x16x32_bf16 v[60:63], a[72:75], v[32:35], v[60:63]
ds_read_b128 v[24:27], v8 offset:26624
v_mfma_f32_16x16x32_bf16 v[64:67], a[76:79], v[32:35], v[64:67]
buffer_load_dwordx4 v6, s[8:11], s50 offen offset:768 lds
s_waitcnt lgkmcnt(4)
v_mfma_f32_16x16x32_bf16 v[52:55], a[80:83], v[36:39], v[52:55]
ds_read_b128 v[28:31], v9 offset:24576
v_mfma_f32_16x16x32_bf16 v[56:59], a[84:87], v[36:39], v[56:59]
s_add_u32 m0, s46, 93312
v_mfma_f32_16x16x32_bf16 v[60:63], a[80:83], v[40:43], v[60:63]
ds_read_b128 v[32:35], v9 offset:26624
v_mfma_f32_16x16x32_bf16 v[64:67], a[84:87], v[40:43], v[64:67]
buffer_load_dwordx4 v6, s[8:11], s50 offen offset:896 lds
s_waitcnt lgkmcnt(4)
v_mfma_f32_16x16x32_bf16 v[52:55], a[88:91], v[44:47], v[52:55]
ds_read_b128 v[36:39], v8 offset:28672
v_mfma_f32_16x16x32_bf16 v[56:59], a[92:95], v[44:47], v[56:59]
s_add_u32 m0, s46, 97280
v_mfma_f32_16x16x32_bf16 v[60:63], a[88:91], v[48:51], v[60:63]
ds_read_b128 v[40:43], v8 offset:30720
v_mfma_f32_16x16x32_bf16 v[64:67], a[92:95], v[48:51], v[64:67]
buffer_load_dwordx4 v6, s[8:11], s50 offen offset:1024 lds
s_waitcnt lgkmcnt(4)
v_mfma_f32_16x16x32_bf16 v[52:55], a[96:99], v[20:23], v[52:55]
ds_read_b128 v[44:47], v9 offset:28672
v_mfma_f32_16x16x32_bf16 v[56:59], a[100:103], v[20:23], v[56:59]
s_add_u32 m0, s46, 101248
v_mfma_f32_16x16x32_bf16 v[60:63], a[96:99], v[24:27], v[60:63]
ds_read_b128 v[48:51], v9 offset:30720
v_mfma_f32_16x16x32_bf16 v[64:67], a[100:103], v[24:27], v[64:67]
buffer_load_dwordx4 v6, s[8:11], s50 offen offset:1152 lds
s_waitcnt lgkmcnt(4)
v_mfma_f32_16x16x32_bf16 v[52:55], a[104:107], v[28:31], v[52:55]
ds_read_b128 v[20:23], v8 offset:32768
v_mfma_f32_16x16x32_bf16 v[56:59], a[108:111], v[28:31], v[56:59]
s_add_u32 m0, s46, 105216
v_mfma_f32_16x16x32_bf16 v[60:63], a[104:107], v[32:35], v[60:63]
ds_read_b128 v[24:27], v8 offset:34816
v_mfma_f32_16x16x32_bf16 v[64:67], a[108:111], v[32:35], v[64:67]
buffer_load_dwordx4 v6, s[8:11], s50 offen offset:1280 lds
s_waitcnt lgkmcnt(4)
v_mfma_f32_16x16x32_bf16 v[52:55], a[112:115], v[36:39], v[52:55]
ds_read_b128 v[28:31], v9 offset:32768
v_mfma_f32_16x16x32_bf16 v[56:59], a[116:119], v[36:39], v[56:59]
s_add_u32 m0, s46, 109184
v_mfma_f32_16x16x32_bf16 v[60:63], a[112:115], v[40:43], v[60:63]
ds_read_b128 v[32:35], v9 offset:34816
v_mfma_f32_16x16x32_bf16 v[64:67], a[116:119], v[40:43], v[64:67]
buffer_load_dwordx4 v6, s[8:11], s50 offen offset:1408 lds
s_waitcnt lgkmcnt(4)
v_mfma_f32_16x16x32_bf16 v[52:55], a[120:123], v[44:47], v[52:55]
ds_read_b128 v[36:39], v8 offset:36864
v_mfma_f32_16x16x32_bf16 v[56:59], a[124:127], v[44:47], v[56:59]
s_add_u32 m0, s46, 113152
v_mfma_f32_16x16x32_bf16 v[60:63], a[120:123], v[48:51], v[60:63]
ds_read_b128 v[40:43], v8 offset:38912
v_mfma_f32_16x16x32_bf16 v[64:67], a[124:127], v[48:51], v[64:67]
buffer_load_dwordx4 v6, s[8:11], s50 offen offset:1536 lds
s_waitcnt lgkmcnt(4)
v_mfma_f32_16x16x32_bf16 v[52:55], a[128:131], v[20:23], v[52:55]
ds_read_b128 v[44:47], v9 offset:36864
v_mfma_f32_16x16x32_bf16 v[56:59], a[132:135], v[20:23], v[56:59]
s_add_u32 m0, s46, 117120
v_mfma_f32_16x16x32_bf16 v[60:63], a[128:131], v[24:27], v[60:63]
ds_read_b128 v[48:51], v9 offset:38912
v_mfma_f32_16x16x32_bf16 v[64:67], a[132:135], v[24:27], v[64:67]
buffer_load_dwordx4 v6, s[8:11], s50 offen offset:1664 lds
s_waitcnt lgkmcnt(4)
v_mfma_f32_16x16x32_bf16 v[52:55], a[136:139], v[28:31], v[52:55]
ds_read_b128 v[20:23], v8 offset:40960
v_mfma_f32_16x16x32_bf16 v[56:59], a[140:143], v[28:31], v[56:59]
s_add_u32 m0, s46, 121088
v_mfma_f32_16x16x32_bf16 v[60:63], a[136:139], v[32:35], v[60:63]
ds_read_b128 v[24:27], v8 offset:43008
v_mfma_f32_16x16x32_bf16 v[64:67], a[140:143], v[32:35], v[64:67]
buffer_load_dwordx4 v6, s[8:11], s50 offen offset:1792 lds
s_waitcnt lgkmcnt(4)
v_mfma_f32_16x16x32_bf16 v[52:55], a[144:147], v[36:39], v[52:55]
ds_read_b128 v[28:31], v9 offset:40960
v_mfma_f32_16x16x32_bf16 v[56:59], a[148:151], v[36:39], v[56:59]
s_add_u32 m0, s46, 125056
v_mfma_f32_16x16x32_bf16 v[60:63], a[144:147], v[40:43], v[60:63]
ds_read_b128 v[32:35], v9 offset:43008
v_mfma_f32_16x16x32_bf16 v[64:67], a[148:151], v[40:43], v[64:67]
buffer_load_dwordx4 v6, s[8:11], s50 offen offset:1920 lds
s_waitcnt lgkmcnt(4)
v_mfma_f32_16x16x32_bf16 v[52:55], a[152:155], v[44:47], v[52:55]
ds_read_b128 v[36:39], v8 offset:45056
v_mfma_f32_16x16x32_bf16 v[56:59], a[156:159], v[44:47], v[56:59]
v_mfma_f32_16x16x32_bf16 v[60:63], a[152:155], v[48:51], v[60:63]
ds_read_b128 v[40:43], v8 offset:47104
v_mfma_f32_16x16x32_bf16 v[64:67], a[156:159], v[48:51], v[64:67]
s_waitcnt lgkmcnt(4)
v_mfma_f32_16x16x32_bf16 v[52:55], a[160:163], v[20:23], v[52:55]
ds_read_b128 v[44:47], v9 offset:45056
v_mfma_f32_16x16x32_bf16 v[56:59], a[164:167], v[20:23], v[56:59]
v_mfma_f32_16x16x32_bf16 v[60:63], a[160:163], v[24:27], v[60:63]
ds_read_b128 v[48:51], v9 offset:47104
v_mfma_f32_16x16x32_bf16 v[64:67], a[164:167], v[24:27], v[64:67]
s_waitcnt lgkmcnt(4)
v_mfma_f32_16x16x32_bf16 v[52:55], a[168:171], v[28:31], v[52:55]
ds_read_b128 v[20:23], v8 offset:49152
v_mfma_f32_16x16x32_bf16 v[56:59], a[172:175], v[28:31], v[56:59]
s_waitcnt vmcnt(16)
v_mov_b32 v17, s42
s_mov_b64 exec, 1
buffer_store_dword v17, v16, s[84:87], s49 offen sc1
s_mov_b64 exec, -1
v_mfma_f32_16x16x32_bf16 v[60:63], a[168:171], v[32:35], v[60:63]
ds_read_b128 v[24:27], v8 offset:51200
v_mfma_f32_16x16x32_bf16 v[64:67], a[172:175], v[32:35], v[64:67]
s_waitcnt lgkmcnt(4)
v_mfma_f32_16x16x32_bf16 v[52:55], a[176:179], v[36:39], v[52:55]
ds_read_b128 v[28:31], v9 offset:49152
v_mfma_f32_16x16x32_bf16 v[56:59], a[180:183], v[36:39], v[56:59]
s_add_u32 s53, s42, 3
s_min_u32 s53, s53, 63
s_lshl_b32 s53, s53, 16
s_mov_b64 exec, 0xffff
buffer_load_dword v250, v19, s[8:11], s53 offen
s_mov_b64 exec, -1
v_mfma_f32_16x16x32_bf16 v[60:63], a[176:179], v[40:43], v[60:63]
ds_read_b128 v[32:35], v9 offset:51200
v_mfma_f32_16x16x32_bf16 v[64:67], a[180:183], v[40:43], v[64:67]
s_waitcnt lgkmcnt(4)
v_mfma_f32_16x16x32_bf16 v[52:55], a[184:187], v[44:47], v[52:55]
ds_read_b128 v[36:39], v8 offset:53248
v_mfma_f32_16x16x32_bf16 v[56:59], a[188:191], v[44:47], v[56:59]
v_mfma_f32_16x16x32_bf16 v[60:63], a[184:187], v[48:51], v[60:63]
ds_read_b128 v[40:43], v8 offset:55296
v_mfma_f32_16x16x32_bf16 v[64:67], a[188:191], v[48:51], v[64:67]
s_waitcnt lgkmcnt(4)
v_mfma_f32_16x16x32_bf16 v[52:55], a[192:195], v[20:23], v[52:55]
ds_read_b128 v[44:47], v9 offset:53248
v_mfma_f32_16x16x32_bf16 v[56:59], a[196:199], v[20:23], v[56:59]
v_mfma_f32_16x16x32_bf16 v[60:63], a[192:195], v[24:27], v[60:63]
ds_read_b128 v[48:51], v9 offset:55296
v_mfma_f32_16x16x32_bf16 v[64:67], a[196:199], v[24:27], v[64:67]
s_waitcnt lgkmcnt(4)
v_mfma_f32_16x16x32_bf16 v[52:55], a[200:203], v[28:31], v[52:55]
ds_read_b128 v[20:23], v8 offset:57344
v_mfma_f32_16x16x32_bf16 v[56:59], a[204:207], v[28:31], v[56:59]
v_mfma_f32_16x16x32_bf16 v[60:63], a[200:203], v[32:35], v[60:63]
ds_read_b128 v[24:27], v8 offset:59392
v_mfma_f32_16x16x32_bf16 v[64:67], a[204:207], v[32:35], v[64:67]
s_waitcnt lgkmcnt(4)
v_mfma_f32_16x16x32_bf16 v[52:55], a[208:211], v[36:39], v[52:55]
ds_read_b128 v[28:31], v9 offset:57344
v_mfma_f32_16x16x32_bf16 v[56:59], a[212:215], v[36:39], v[56:59]
v_mfma_f32_16x16x32_bf16 v[60:63], a[208:211], v[40:43], v[60:63]
ds_read_b128 v[32:35], v9 offset:59392
v_mfma_f32_16x16x32_bf16 v[64:67], a[212:215], v[40:43], v[64:67]
s_waitcnt lgkmcnt(4)
v_mfma_f32_16x16x32_bf16 v[52:55], a[216:219], v[44:47], v[52:55]
ds_read_b128 v[36:39], v8 offset:61440
v_mfma_f32_16x16x32_bf16 v[56:59], a[220:223], v[44:47], v[56:59]
v_mfma_f32_16x16x32_bf16 v[60:63], a[216:219], v[48:51], v[60:63]
ds_read_b128 v[40:43], v8 offset:63488
v_mfma_f32_16x16x32_bf16 v[64:67], a[220:223], v[48:51], v[64:67]
s_waitcnt lgkmcnt(4)
v_mfma_f32_16x16x32_bf16 v[52:55], a[224:227], v[20:23], v[52:55]
ds_read_b128 v[44:47], v9 offset:61440
v_mfma_f32_16x16x32_bf16 v[56:59], a[228:231], v[20:23], v[56:59]
v_mfma_f32_16x16x32_bf16 v[60:63], a[224:227], v[24:27], v[60:63]
ds_read_b128 v[48:51], v9 offset:63488
v_mfma_f32_16x16x32_bf16 v[64:67], a[228:231], v[24:27], v[64:67]
s_waitcnt lgkmcnt(5)
v_mfma_f32_16x16x32_bf16 v[52:55], a[232:235], v[28:31], v[52:55]
v_mfma_f32_16x16x32_bf16 v[56:59], a[236:239], v[28:31], v[56:59]
s_waitcnt lgkmcnt(4)
v_mfma_f32_16x16x32_bf16 v[60:63], a[232:235], v[32:35], v[60:63]
v_mfma_f32_16x16x32_bf16 v[64:67], a[236:239], v[32:35], v[64:67]
s_waitcnt lgkmcnt(3)
v_mfma_f32_16x16x32_bf16 v[52:55], a[240:243], v[36:39], v[52:55]
v_mfma_f32_16x16x32_bf16 v[56:59], a[244:247], v[36:39], v[56:59]
s_waitcnt lgkmcnt(2)
v_mfma_f32_16x16x32_bf16 v[60:63], a[240:243], v[40:43], v[60:63]
v_mfma_f32_16x16x32_bf16 v[64:67], a[244:247], v[40:43], v[64:67]
s_waitcnt lgkmcnt(1)
v_mfma_f32_16x16x32_bf16 v[52:55], a[248:251], v[44:47], v[52:55]
v_mfma_f32_16x16x32_bf16 v[56:59], a[252:255], v[44:47], v[56:59]
s_waitcnt lgkmcnt(0)
v_mfma_f32_16x16x32_bf16 v[60:63], a[248:251], v[48:51], v[60:63]
v_mfma_f32_16x16x32_bf16 v[64:67], a[252:255], v[48:51], v[64:67]
s_add_u32 s42, s42, 1
s_branch mega_kernel_k_loop
mega_kernel_k_fin:
s_nop 11
v_cvt_pk_bf16_f32 v84, v68, v69
v_cvt_pk_bf16_f32 v85, v70, v71
v_cvt_pk_bf16_f32 v86, v72, v73
v_cvt_pk_bf16_f32 v87, v74, v75
v_cvt_pk_bf16_f32 v88, v76, v77
v_cvt_pk_bf16_f32 v89, v78, v79
v_cvt_pk_bf16_f32 v90, v80, v81
v_cvt_pk_bf16_f32 v91, v82, v83
s_add_u32 s51, s42, s47
s_sub_u32 s51, s51, 1
s_bfe_u32 s52, s51, 0x40002
s_lshl_b32 s52, s52, 14
s_and_b32 s51, s51, 3
s_lshl_b32 s51, s51, 11
s_add_u32 s51, s51, s52
s_add_u32 s51, s51, s48
buffer_store_dwordx4 v[84:87], v7, s[84:87], s51 offen sc1
buffer_store_dwordx4 v[88:91], v7, s[84:87], s51 offen offset:1024 sc1
s_waitcnt vmcnt(0)
v_mov_b32 v17, s42
s_mov_b64 exec, 1
buffer_store_dword v17, v16, s[84:87], s49 offen sc1
s_mov_b64 exec, -1
s_waitcnt vmcnt(0)
s_barrier
s_branch mega_kernel_fft
mega_kernel_rv:
s_load_dwordx2 s[4:5], s[0:1], 32
s_load_dwordx2 s[8:9], s[0:1], 0
v_lshrrev_b32 v2, 6, v0
v_and_b32 v1, 63, v0
v_readfirstlane_b32 s41, v2
v_lshlrev_b32 v5, 4, v1
s_waitcnt lgkmcnt(0)
s_mov_b32 s6, 8388608
s_mov_b32 s7, 0x00020000
s_mov_b32 s10, 4194304
s_mov_b32 s11, 0x00020000
s_lshl_b32 s43, s40, 8
s_lshl_b32 s44, s41, 6
s_add_u32 s48, s43, s44
s_and_b32 s43, s48, 0x7ff
v_add_u32 v19, s43, v1
v_lshlrev_b32 v19, 7, v19
buffer_load_dword v250, v19, s[8:11], 0 offen
s_nop 0
v_lshrrev_b32 v2, 3, v1
s_lshl_b32 s43, s41, 3
v_add_u32 v2, s43, v2
v_bfe_u32 v3, v2, 1, 3
v_and_b32 v4, 7, v1
v_xor_b32 v3, v3, v4
v_lshlrev_b32 v6, 11, v2
v_lshl_add_u32 v6, v3, 4, v6
s_lshl_b32 s46, s41, 10
v_and_b32 v2, 15, v1
v_bfe_u32 v3, v2, 1, 3
v_lshrrev_b32 v4, 4, v1
v_xor_b32 v3, v3, v4
v_lshlrev_b32 v8, 7, v2
v_lshl_add_u32 v8, v3, 4, v8
v_xor_b32 v9, 64, v8
v_add_u32 v10, 0x10000, v8
v_add_u32 v11, 0x10000, v9
v_mov_b32 v7, v5
s_lshl_b32 s47, s40, 2
s_add_u32 s47, s47, s41
s_mov_b32 s42, 0
s_mov_b32 s50, 0
s_add_u32 m0, s46, 0
s_nop 0
buffer_load_dwordx4 v6, s[8:11], s50 offen offset:0 lds
s_add_u32 m0, s46, 3968
s_nop 0
buffer_load_dwordx4 v6, s[8:11], s50 offen offset:128 lds
s_add_u32 m0, s46, 7936
s_nop 0
buffer_load_dwordx4 v6, s[8:11], s50 offen offset:256 lds
s_add_u32 m0, s46, 11904
s_nop 0
buffer_load_dwordx4 v6, s[8:11], s50 offen offset:384 lds
s_add_u32 m0, s46, 15872
s_nop 0
buffer_load_dwordx4 v6, s[8:11], s50 offen offset:512 lds
s_add_u32 m0, s46, 19840
s_nop 0
buffer_load_dwordx4 v6, s[8:11], s50 offen offset:640 lds
s_add_u32 m0, s46, 23808
s_nop 0
buffer_load_dwordx4 v6, s[8:11], s50 offen offset:768 lds
s_add_u32 m0, s46, 27776
s_nop 0
buffer_load_dwordx4 v6, s[8:11], s50 offen offset:896 lds
s_add_u32 m0, s46, 31744
s_nop 0
buffer_load_dwordx4 v6, s[8:11], s50 offen offset:1024 lds
s_add_u32 m0, s46, 35712
s_nop 0
buffer_load_dwordx4 v6, s[8:11], s50 offen offset:1152 lds
s_add_u32 m0, s46, 39680
s_nop 0
buffer_load_dwordx4 v6, s[8:11], s50 offen offset:1280 lds
s_add_u32 m0, s46, 43648
s_nop 0
buffer_load_dwordx4 v6, s[8:11], s50 offen offset:1408 lds
s_add_u32 m0, s46, 47616
s_nop 0
buffer_load_dwordx4 v6, s[8:11], s50 offen offset:1536 lds
s_add_u32 m0, s46, 51584
s_nop 0
buffer_load_dwordx4 v6, s[8:11], s50 offen offset:1664 lds
s_add_u32 m0, s46, 55552
s_nop 0
buffer_load_dwordx4 v6, s[8:11], s50 offen offset:1792 lds
s_add_u32 m0, s46, 59520
s_nop 0
buffer_load_dwordx4 v6, s[8:11], s50 offen offset:1920 lds
v_lshrrev_b32 v2, 2, v1
v_and_b32 v3, 3, v1
v_lshlrev_b32 v16, 13, v2
v_lshl_add_u32 v16, v3, 4, v16
v_add_u32 v16, s48, v16
s_mul_i32 s45, s41, 24576
s_add_u32 s45, s45, 65536
v_bfe_u32 v17, v1, 2, 2
v_lshrrev_b32 v18, 4, v1
v_lshl_add_u32 v17, v18, 3, v17
v_lshlrev_b32 v17, 6, v17
v_lshl_add_u32 v17, v3, 3, v17
v_add_u32 v17, s45, v17
s_and_b32 s43, s40, 3
s_lshl_b32 s43, s43, 2
s_add_u32 s43, s43, s41
s_lshl_b32 s43, s43, 3
v_and_b32 v12, 7, v1
v_add_u32 v12, s43, v12
s_lshr_b32 s43, s40, 2
s_lshl_b32 s43, s43, 10
s_add_u32 s44, s43, 896
s_add_u32 s43, s43, 384
s_cmp_ge_u32 s40, 28
s_cselect_b32 s44, s44, s43
v_mov_b32 v13, s43
v_mov_b32 v14, s44
v_cmp_gt_u32 vcc, 32, v1
s_nop 1
v_cndmask_b32 v13, v14, v13, vcc
v_lshl_add_u32 v12, v12, 13, v13
s_mov_b32 s44, 0
buffer_load_dword v250, v12, s[4:7], s44 offen
s_add_u32 m0, s45, 0
s_mov_b32 s44, 0
buffer_load_dwordx4 v16, s[4:7], s44 offen lds
s_add_u32 m0, s45, 1024
s_mov_b32 s44, 131072
buffer_load_dwordx4 v16, s[4:7], s44 offen lds
s_add_u32 m0, s45, 2048
s_mov_b32 s44, 262144
buffer_load_dwordx4 v16, s[4:7], s44 offen lds
s_add_u32 m0, s45, 3072
s_mov_b32 s44, 393216
buffer_load_dwordx4 v16, s[4:7], s44 offen lds
s_add_u32 m0, s45, 4096
s_mov_b32 s44, 524288
buffer_load_dwordx4 v16, s[4:7], s44 offen lds
s_add_u32 m0, s45, 5120
s_mov_b32 s44, 655360
buffer_load_dwordx4 v16, s[4:7], s44 offen lds
s_add_u32 m0, s45, 6144
s_mov_b32 s44, 786432
buffer_load_dwordx4 v16, s[4:7], s44 offen lds
s_add_u32 m0, s45, 7168
s_mov_b32 s44, 917504
buffer_load_dwordx4 v16, s[4:7], s44 offen lds
s_mov_b32 s44, 1048576
buffer_load_dword v250, v12, s[4:7], s44 offen
s_add_u32 m0, s45, 8192
s_mov_b32 s44, 1048576
buffer_load_dwordx4 v16, s[4:7], s44 offen lds
s_add_u32 m0, s45, 9216
s_mov_b32 s44, 1179648
buffer_load_dwordx4 v16, s[4:7], s44 offen lds
s_add_u32 m0, s45, 10240
s_mov_b32 s44, 1310720
buffer_load_dwordx4 v16, s[4:7], s44 offen lds
s_add_u32 m0, s45, 11264
s_mov_b32 s44, 1441792
buffer_load_dwordx4 v16, s[4:7], s44 offen lds
s_add_u32 m0, s45, 12288
s_mov_b32 s44, 1572864
buffer_load_dwordx4 v16, s[4:7], s44 offen lds
s_add_u32 m0, s45, 13312
s_mov_b32 s44, 1703936
buffer_load_dwordx4 v16, s[4:7], s44 offen lds
s_add_u32 m0, s45, 14336
s_mov_b32 s44, 1835008
buffer_load_dwordx4 v16, s[4:7], s44 offen lds
s_add_u32 m0, s45, 15360
s_mov_b32 s44, 1966080
buffer_load_dwordx4 v16, s[4:7], s44 offen lds
s_mov_b32 s44, 2097152
buffer_load_dword v250, v12, s[4:7], s44 offen
s_add_u32 m0, s45, 16384
s_mov_b32 s44, 2097152
buffer_load_dwordx4 v16, s[4:7], s44 offen lds
s_add_u32 m0, s45, 17408
s_mov_b32 s44, 2228224
buffer_load_dwordx4 v16, s[4:7], s44 offen lds
s_add_u32 m0, s45, 18432
s_mov_b32 s44, 2359296
buffer_load_dwordx4 v16, s[4:7], s44 offen lds
s_add_u32 m0, s45, 19456
s_mov_b32 s44, 2490368
buffer_load_dwordx4 v16, s[4:7], s44 offen lds
s_add_u32 m0, s45, 20480
s_mov_b32 s44, 2621440
buffer_load_dwordx4 v16, s[4:7], s44 offen lds
s_add_u32 m0, s45, 21504
s_mov_b32 s44, 2752512
buffer_load_dwordx4 v16, s[4:7], s44 offen lds
s_add_u32 m0, s45, 22528
s_mov_b32 s44, 2883584
buffer_load_dwordx4 v16, s[4:7], s44 offen lds
s_add_u32 m0, s45, 23552
s_mov_b32 s44, 3014656
buffer_load_dwordx4 v16, s[4:7], s44 offen lds
s_waitcnt vmcnt(18)
s_barrier
ds_read_b64_tr_b16 a[0:1], v17 offset:0
ds_read_b64_tr_b16 a[2:3], v17 offset:256
ds_read_b64_tr_b16 a[4:5], v17 offset:32
ds_read_b64_tr_b16 a[6:7], v17 offset:288
ds_read_b64_tr_b16 a[8:9], v17 offset:2048
ds_read_b64_tr_b16 a[10:11], v17 offset:2304
ds_read_b64_tr_b16 a[12:13], v17 offset:2080
ds_read_b64_tr_b16 a[14:15], v17 offset:2336
s_waitcnt lgkmcnt(0)
ds_read_b64_tr_b16 a[16:17], v17 offset:4096
ds_read_b64_tr_b16 a[18:19], v17 offset:4352
ds_read_b64_tr_b16 a[20:21], v17 offset:4128
ds_read_b64_tr_b16 a[22:23], v17 offset:4384
ds_read_b64_tr_b16 a[24:25], v17 offset:6144
ds_read_b64_tr_b16 a[26:27], v17 offset:6400
ds_read_b64_tr_b16 a[28:29], v17 offset:6176
ds_read_b64_tr_b16 a[30:31], v17 offset:6432
s_waitcnt lgkmcnt(0)
ds_read_b128 v[20:23], v8 offset:0
ds_read_b128 v[24:27], v8 offset:2048
ds_read_b128 v[28:31], v9 offset:0
ds_read_b128 v[32:35], v9 offset:2048
ds_read_b128 v[36:39], v8 offset:4096
ds_read_b128 v[40:43], v8 offset:6144
ds_read_b128 v[44:47], v9 offset:4096
ds_read_b128 v[48:51], v9 offset:6144
s_mov_b32 s44, 3145728
buffer_load_dword v250, v12, s[4:7], s44 offen
s_add_u32 m0, s45, 0
s_mov_b32 s44, 3145728
buffer_load_dwordx4 v16, s[4:7], s44 offen lds
s_add_u32 m0, s45, 1024
s_mov_b32 s44, 3276800
buffer_load_dwordx4 v16, s[4:7], s44 offen lds
s_add_u32 m0, s45, 2048
s_mov_b32 s44, 3407872
buffer_load_dwordx4 v16, s[4:7], s44 offen lds
s_add_u32 m0, s45, 3072
s_mov_b32 s44, 3538944
buffer_load_dwordx4 v16, s[4:7], s44 offen lds
s_add_u32 m0, s45, 4096
s_mov_b32 s44, 3670016
buffer_load_dwordx4 v16, s[4:7], s44 offen lds
s_add_u32 m0, s45, 5120
s_mov_b32 s44, 3801088
buffer_load_dwordx4 v16, s[4:7], s44 offen lds
s_add_u32 m0, s45, 6144
s_mov_b32 s44, 3932160
buffer_load_dwordx4 v16, s[4:7], s44 offen lds
s_add_u32 m0, s45, 7168
s_mov_b32 s44, 4063232
buffer_load_dwordx4 v16, s[4:7], s44 offen lds
s_waitcnt lgkmcnt(0)
v_mfma_f32_16x16x32_bf16 v[52:55], v[20:23], a[0:3], 0
v_mfma_f32_16x16x32_bf16 v[56:59], v[20:23], a[4:7], 0
v_mfma_f32_16x16x32_bf16 v[60:63], v[24:27], a[0:3], 0
v_mfma_f32_16x16x32_bf16 v[64:67], v[24:27], a[4:7], 0
v_mfma_f32_16x16x32_bf16 v[52:55], v[28:31], a[8:11], v[52:55]
v_mfma_f32_16x16x32_bf16 v[56:59], v[28:31], a[12:15], v[56:59]
v_mfma_f32_16x16x32_bf16 v[60:63], v[32:35], a[8:11], v[60:63]
v_mfma_f32_16x16x32_bf16 v[64:67], v[32:35], a[12:15], v[64:67]
v_mfma_f32_16x16x32_bf16 v[52:55], v[36:39], a[16:19], v[52:55]
v_mfma_f32_16x16x32_bf16 v[56:59], v[36:39], a[20:23], v[56:59]
v_mfma_f32_16x16x32_bf16 v[60:63], v[40:43], a[16:19], v[60:63]
v_mfma_f32_16x16x32_bf16 v[64:67], v[40:43], a[20:23], v[64:67]
v_mfma_f32_16x16x32_bf16 v[52:55], v[44:47], a[24:27], v[52:55]
v_mfma_f32_16x16x32_bf16 v[56:59], v[44:47], a[28:31], v[56:59]
v_mfma_f32_16x16x32_bf16 v[60:63], v[48:51], a[24:27], v[60:63]
v_mfma_f32_16x16x32_bf16 v[64:67], v[48:51], a[28:31], v[64:67]
s_waitcnt vmcnt(18)
ds_read_b64_tr_b16 a[32:33], v17 offset:8192
ds_read_b64_tr_b16 a[34:35], v17 offset:8448
ds_read_b64_tr_b16 a[36:37], v17 offset:8224
ds_read_b64_tr_b16 a[38:39], v17 offset:8480
ds_read_b64_tr_b16 a[40:41], v17 offset:10240
ds_read_b64_tr_b16 a[42:43], v17 offset:10496
ds_read_b64_tr_b16 a[44:45], v17 offset:10272
ds_read_b64_tr_b16 a[46:47], v17 offset:10528
s_waitcnt lgkmcnt(0)
ds_read_b64_tr_b16 a[48:49], v17 offset:12288
ds_read_b64_tr_b16 a[50:51], v17 offset:12544
ds_read_b64_tr_b16 a[52:53], v17 offset:12320
ds_read_b64_tr_b16 a[54:55], v17 offset:12576
ds_read_b64_tr_b16 a[56:57], v17 offset:14336
ds_read_b64_tr_b16 a[58:59], v17 offset:14592
ds_read_b64_tr_b16 a[60:61], v17 offset:14368
ds_read_b64_tr_b16 a[62:63], v17 offset:14624
s_waitcnt lgkmcnt(0)
ds_read_b128 v[20:23], v8 offset:8192
ds_read_b128 v[24:27], v8 offset:10240
ds_read_b128 v[28:31], v9 offset:8192
ds_read_b128 v[32:35], v9 offset:10240
ds_read_b128 v[36:39], v8 offset:12288
ds_read_b128 v[40:43], v8 offset:14336
ds_read_b128 v[44:47], v9 offset:12288
ds_read_b128 v[48:51], v9 offset:14336
s_mov_b32 s44, 4194304
buffer_load_dword v250, v12, s[4:7], s44 offen
s_add_u32 m0, s45, 8192
s_mov_b32 s44, 4194304
buffer_load_dwordx4 v16, s[4:7], s44 offen lds
s_add_u32 m0, s45, 9216
s_mov_b32 s44, 4325376
buffer_load_dwordx4 v16, s[4:7], s44 offen lds
s_add_u32 m0, s45, 10240
s_mov_b32 s44, 4456448
buffer_load_dwordx4 v16, s[4:7], s44 offen lds
s_add_u32 m0, s45, 11264
s_mov_b32 s44, 4587520
buffer_load_dwordx4 v16, s[4:7], s44 offen lds
s_add_u32 m0, s45, 12288
s_mov_b32 s44, 4718592
buffer_load_dwordx4 v16, s[4:7], s44 offen lds
s_add_u32 m0, s45, 13312
s_mov_b32 s44, 4849664
buffer_load_dwordx4 v16, s[4:7], s44 offen lds
s_add_u32 m0, s45, 14336
s_mov_b32 s44, 4980736
buffer_load_dwordx4 v16, s[4:7], s44 offen lds
s_add_u32 m0, s45, 15360
s_mov_b32 s44, 5111808
buffer_load_dwordx4 v16, s[4:7], s44 offen lds
s_waitcnt lgkmcnt(0)
v_mfma_f32_16x16x32_bf16 v[52:55], v[20:23], a[32:35], v[52:55]
v_mfma_f32_16x16x32_bf16 v[56:59], v[20:23], a[36:39], v[56:59]
v_mfma_f32_16x16x32_bf16 v[60:63], v[24:27], a[32:35], v[60:63]
v_mfma_f32_16x16x32_bf16 v[64:67], v[24:27], a[36:39], v[64:67]
v_mfma_f32_16x16x32_bf16 v[52:55], v[28:31], a[40:43], v[52:55]
v_mfma_f32_16x16x32_bf16 v[56:59], v[28:31], a[44:47], v[56:59]
v_mfma_f32_16x16x32_bf16 v[60:63], v[32:35], a[40:43], v[60:63]
v_mfma_f32_16x16x32_bf16 v[64:67], v[32:35], a[44:47], v[64:67]
v_mfma_f32_16x16x32_bf16 v[52:55], v[36:39], a[48:51], v[52:55]
v_mfma_f32_16x16x32_bf16 v[56:59], v[36:39], a[52:55], v[56:59]
v_mfma_f32_16x16x32_bf16 v[60:63], v[40:43], a[48:51], v[60:63]
v_mfma_f32_16x16x32_bf16 v[64:67], v[40:43], a[52:55], v[64:67]
v_mfma_f32_16x16x32_bf16 v[52:55], v[44:47], a[56:59], v[52:55]
v_mfma_f32_16x16x32_bf16 v[56:59], v[44:47], a[60:63], v[56:59]
v_mfma_f32_16x16x32_bf16 v[60:63], v[48:51], a[56:59], v[60:63]
v_mfma_f32_16x16x32_bf16 v[64:67], v[48:51], a[60:63], v[64:67]
s_waitcnt vmcnt(18)
ds_read_b64_tr_b16 a[64:65], v17 offset:16384
ds_read_b64_tr_b16 a[66:67], v17 offset:16640
ds_read_b64_tr_b16 a[68:69], v17 offset:16416
ds_read_b64_tr_b16 a[70:71], v17 offset:16672
ds_read_b64_tr_b16 a[72:73], v17 offset:18432
ds_read_b64_tr_b16 a[74:75], v17 offset:18688
ds_read_b64_tr_b16 a[76:77], v17 offset:18464
ds_read_b64_tr_b16 a[78:79], v17 offset:18720
s_waitcnt lgkmcnt(0)
ds_read_b64_tr_b16 a[80:81], v17 offset:20480
ds_read_b64_tr_b16 a[82:83], v17 offset:20736
ds_read_b64_tr_b16 a[84:85], v17 offset:20512
ds_read_b64_tr_b16 a[86:87], v17 offset:20768
ds_read_b64_tr_b16 a[88:89], v17 offset:22528
ds_read_b64_tr_b16 a[90:91], v17 offset:22784
ds_read_b64_tr_b16 a[92:93], v17 offset:22560
ds_read_b64_tr_b16 a[94:95], v17 offset:22816
s_waitcnt lgkmcnt(0)
ds_read_b128 v[20:23], v8 offset:16384
ds_read_b128 v[24:27], v8 offset:18432
ds_read_b128 v[28:31], v9 offset:16384
ds_read_b128 v[32:35], v9 offset:18432
ds_read_b128 v[36:39], v8 offset:20480
ds_read_b128 v[40:43], v8 offset:22528
ds_read_b128 v[44:47], v9 offset:20480
ds_read_b128 v[48:51], v9 offset:22528
s_mov_b32 s44, 5242880
buffer_load_dword v250, v12, s[4:7], s44 offen
s_add_u32 m0, s45, 16384
s_mov_b32 s44, 5242880
buffer_load_dwordx4 v16, s[4:7], s44 offen lds
s_add_u32 m0, s45, 17408
s_mov_b32 s44, 5373952
buffer_load_dwordx4 v16, s[4:7], s44 offen lds
s_add_u32 m0, s45, 18432
s_mov_b32 s44, 5505024
buffer_load_dwordx4 v16, s[4:7], s44 offen lds
s_add_u32 m0, s45, 19456
s_mov_b32 s44, 5636096
buffer_load_dwordx4 v16, s[4:7], s44 offen lds
s_add_u32 m0, s45, 20480
s_mov_b32 s44, 5767168
buffer_load_dwordx4 v16, s[4:7], s44 offen lds
s_add_u32 m0, s45, 21504
s_mov_b32 s44, 5898240
buffer_load_dwordx4 v16, s[4:7], s44 offen lds
s_add_u32 m0, s45, 22528
s_mov_b32 s44, 6029312
buffer_load_dwordx4 v16, s[4:7], s44 offen lds
s_add_u32 m0, s45, 23552
s_mov_b32 s44, 6160384
buffer_load_dwordx4 v16, s[4:7], s44 offen lds
s_waitcnt lgkmcnt(0)
v_mfma_f32_16x16x32_bf16 v[52:55], v[20:23], a[64:67], v[52:55]
v_mfma_f32_16x16x32_bf16 v[56:59], v[20:23], a[68:71], v[56:59]
v_mfma_f32_16x16x32_bf16 v[60:63], v[24:27], a[64:67], v[60:63]
v_mfma_f32_16x16x32_bf16 v[64:67], v[24:27], a[68:71], v[64:67]
v_mfma_f32_16x16x32_bf16 v[52:55], v[28:31], a[72:75], v[52:55]
v_mfma_f32_16x16x32_bf16 v[56:59], v[28:31], a[76:79], v[56:59]
v_mfma_f32_16x16x32_bf16 v[60:63], v[32:35], a[72:75], v[60:63]
v_mfma_f32_16x16x32_bf16 v[64:67], v[32:35], a[76:79], v[64:67]
v_mfma_f32_16x16x32_bf16 v[52:55], v[36:39], a[80:83], v[52:55]
v_mfma_f32_16x16x32_bf16 v[56:59], v[36:39], a[84:87], v[56:59]
v_mfma_f32_16x16x32_bf16 v[60:63], v[40:43], a[80:83], v[60:63]
v_mfma_f32_16x16x32_bf16 v[64:67], v[40:43], a[84:87], v[64:67]
v_mfma_f32_16x16x32_bf16 v[52:55], v[44:47], a[88:91], v[52:55]
v_mfma_f32_16x16x32_bf16 v[56:59], v[44:47], a[92:95], v[56:59]
v_mfma_f32_16x16x32_bf16 v[60:63], v[48:51], a[88:91], v[60:63]
v_mfma_f32_16x16x32_bf16 v[64:67], v[48:51], a[92:95], v[64:67]
s_waitcnt vmcnt(18)
ds_read_b64_tr_b16 a[96:97], v17 offset:0
ds_read_b64_tr_b16 a[98:99], v17 offset:256
ds_read_b64_tr_b16 a[100:101], v17 offset:32
ds_read_b64_tr_b16 a[102:103], v17 offset:288
ds_read_b64_tr_b16 a[104:105], v17 offset:2048
ds_read_b64_tr_b16 a[106:107], v17 offset:2304
ds_read_b64_tr_b16 a[108:109], v17 offset:2080
ds_read_b64_tr_b16 a[110:111], v17 offset:2336
s_waitcnt lgkmcnt(0)
ds_read_b64_tr_b16 a[112:113], v17 offset:4096
ds_read_b64_tr_b16 a[114:115], v17 offset:4352
ds_read_b64_tr_b16 a[116:117], v17 offset:4128
ds_read_b64_tr_b16 a[118:119], v17 offset:4384
ds_read_b64_tr_b16 a[120:121], v17 offset:6144
ds_read_b64_tr_b16 a[122:123], v17 offset:6400
ds_read_b64_tr_b16 a[124:125], v17 offset:6176
ds_read_b64_tr_b16 a[126:127], v17 offset:6432
s_waitcnt lgkmcnt(0)
ds_read_b128 v[20:23], v8 offset:24576
ds_read_b128 v[24:27], v8 offset:26624
ds_read_b128 v[28:31], v9 offset:24576
ds_read_b128 v[32:35], v9 offset:26624
ds_read_b128 v[36:39], v8 offset:28672
ds_read_b128 v[40:43], v8 offset:30720
ds_read_b128 v[44:47], v9 offset:28672
ds_read_b128 v[48:51], v9 offset:30720
s_mov_b32 s44, 6291456
buffer_load_dword v250, v12, s[4:7], s44 offen
s_add_u32 m0, s45, 0
s_mov_b32 s44, 6291456
buffer_load_dwordx4 v16, s[4:7], s44 offen lds
s_add_u32 m0, s45, 1024
s_mov_b32 s44, 6422528
buffer_load_dwordx4 v16, s[4:7], s44 offen lds
s_add_u32 m0, s45, 2048
s_mov_b32 s44, 6553600
buffer_load_dwordx4 v16, s[4:7], s44 offen lds
s_add_u32 m0, s45, 3072
s_mov_b32 s44, 6684672
buffer_load_dwordx4 v16, s[4:7], s44 offen lds
s_add_u32 m0, s45, 4096
s_mov_b32 s44, 6815744
buffer_load_dwordx4 v16, s[4:7], s44 offen lds
s_add_u32 m0, s45, 5120
s_mov_b32 s44, 6946816
buffer_load_dwordx4 v16, s[4:7], s44 offen lds
s_add_u32 m0, s45, 6144
s_mov_b32 s44, 7077888
buffer_load_dwordx4 v16, s[4:7], s44 offen lds
s_add_u32 m0, s45, 7168
s_mov_b32 s44, 7208960
buffer_load_dwordx4 v16, s[4:7], s44 offen lds
s_waitcnt lgkmcnt(0)
v_mfma_f32_16x16x32_bf16 v[52:55], v[20:23], a[96:99], v[52:55]
v_mfma_f32_16x16x32_bf16 v[56:59], v[20:23], a[100:103], v[56:59]
v_mfma_f32_16x16x32_bf16 v[60:63], v[24:27], a[96:99], v[60:63]
v_mfma_f32_16x16x32_bf16 v[64:67], v[24:27], a[100:103], v[64:67]
v_mfma_f32_16x16x32_bf16 v[52:55], v[28:31], a[104:107], v[52:55]
v_mfma_f32_16x16x32_bf16 v[56:59], v[28:31], a[108:111], v[56:59]
v_mfma_f32_16x16x32_bf16 v[60:63], v[32:35], a[104:107], v[60:63]
v_mfma_f32_16x16x32_bf16 v[64:67], v[32:35], a[108:111], v[64:67]
v_mfma_f32_16x16x32_bf16 v[52:55], v[36:39], a[112:115], v[52:55]
v_mfma_f32_16x16x32_bf16 v[56:59], v[36:39], a[116:119], v[56:59]
v_mfma_f32_16x16x32_bf16 v[60:63], v[40:43], a[112:115], v[60:63]
v_mfma_f32_16x16x32_bf16 v[64:67], v[40:43], a[116:119], v[64:67]
v_mfma_f32_16x16x32_bf16 v[52:55], v[44:47], a[120:123], v[52:55]
v_mfma_f32_16x16x32_bf16 v[56:59], v[44:47], a[124:127], v[56:59]
v_mfma_f32_16x16x32_bf16 v[60:63], v[48:51], a[120:123], v[60:63]
v_mfma_f32_16x16x32_bf16 v[64:67], v[48:51], a[124:127], v[64:67]
s_waitcnt vmcnt(18)
ds_read_b64_tr_b16 a[128:129], v17 offset:8192
ds_read_b64_tr_b16 a[130:131], v17 offset:8448
ds_read_b64_tr_b16 a[132:133], v17 offset:8224
ds_read_b64_tr_b16 a[134:135], v17 offset:8480
ds_read_b64_tr_b16 a[136:137], v17 offset:10240
ds_read_b64_tr_b16 a[138:139], v17 offset:10496
ds_read_b64_tr_b16 a[140:141], v17 offset:10272
ds_read_b64_tr_b16 a[142:143], v17 offset:10528
s_waitcnt lgkmcnt(0)
ds_read_b64_tr_b16 a[144:145], v17 offset:12288
ds_read_b64_tr_b16 a[146:147], v17 offset:12544
ds_read_b64_tr_b16 a[148:149], v17 offset:12320
ds_read_b64_tr_b16 a[150:151], v17 offset:12576
ds_read_b64_tr_b16 a[152:153], v17 offset:14336
ds_read_b64_tr_b16 a[154:155], v17 offset:14592
ds_read_b64_tr_b16 a[156:157], v17 offset:14368
ds_read_b64_tr_b16 a[158:159], v17 offset:14624
s_waitcnt lgkmcnt(0)
ds_read_b128 v[20:23], v8 offset:32768
ds_read_b128 v[24:27], v8 offset:34816
ds_read_b128 v[28:31], v9 offset:32768
ds_read_b128 v[32:35], v9 offset:34816
ds_read_b128 v[36:39], v8 offset:36864
ds_read_b128 v[40:43], v8 offset:38912
ds_read_b128 v[44:47], v9 offset:36864
ds_read_b128 v[48:51], v9 offset:38912
s_mov_b32 s44, 7340032
buffer_load_dword v250, v12, s[4:7], s44 offen
s_add_u32 m0, s45, 8192
s_mov_b32 s44, 7340032
buffer_load_dwordx4 v16, s[4:7], s44 offen lds
s_add_u32 m0, s45, 9216
s_mov_b32 s44, 7471104
buffer_load_dwordx4 v16, s[4:7], s44 offen lds
s_add_u32 m0, s45, 10240
s_mov_b32 s44, 7602176
buffer_load_dwordx4 v16, s[4:7], s44 offen lds
s_add_u32 m0, s45, 11264
s_mov_b32 s44, 7733248
buffer_load_dwordx4 v16, s[4:7], s44 offen lds
s_add_u32 m0, s45, 12288
s_mov_b32 s44, 7864320
buffer_load_dwordx4 v16, s[4:7], s44 offen lds
s_add_u32 m0, s45, 13312
s_mov_b32 s44, 7995392
buffer_load_dwordx4 v16, s[4:7], s44 offen lds
s_add_u32 m0, s45, 14336
s_mov_b32 s44, 8126464
buffer_load_dwordx4 v16, s[4:7], s44 offen lds
s_add_u32 m0, s45, 15360
s_mov_b32 s44, 8257536
buffer_load_dwordx4 v16, s[4:7], s44 offen lds
s_waitcnt lgkmcnt(0)
v_mfma_f32_16x16x32_bf16 v[52:55], v[20:23], a[128:131], v[52:55]
v_mfma_f32_16x16x32_bf16 v[56:59], v[20:23], a[132:135], v[56:59]
v_mfma_f32_16x16x32_bf16 v[60:63], v[24:27], a[128:131], v[60:63]
v_mfma_f32_16x16x32_bf16 v[64:67], v[24:27], a[132:135], v[64:67]
v_mfma_f32_16x16x32_bf16 v[52:55], v[28:31], a[136:139], v[52:55]
v_mfma_f32_16x16x32_bf16 v[56:59], v[28:31], a[140:143], v[56:59]
v_mfma_f32_16x16x32_bf16 v[60:63], v[32:35], a[136:139], v[60:63]
v_mfma_f32_16x16x32_bf16 v[64:67], v[32:35], a[140:143], v[64:67]
v_mfma_f32_16x16x32_bf16 v[52:55], v[36:39], a[144:147], v[52:55]
v_mfma_f32_16x16x32_bf16 v[56:59], v[36:39], a[148:151], v[56:59]
v_mfma_f32_16x16x32_bf16 v[60:63], v[40:43], a[144:147], v[60:63]
v_mfma_f32_16x16x32_bf16 v[64:67], v[40:43], a[148:151], v[64:67]
v_mfma_f32_16x16x32_bf16 v[52:55], v[44:47], a[152:155], v[52:55]
v_mfma_f32_16x16x32_bf16 v[56:59], v[44:47], a[156:159], v[56:59]
v_mfma_f32_16x16x32_bf16 v[60:63], v[48:51], a[152:155], v[60:63]
v_mfma_f32_16x16x32_bf16 v[64:67], v[48:51], a[156:159], v[64:67]
s_waitcnt vmcnt(18)
ds_read_b64_tr_b16 a[160:161], v17 offset:16384
ds_read_b64_tr_b16 a[162:163], v17 offset:16640
ds_read_b64_tr_b16 a[164:165], v17 offset:16416
ds_read_b64_tr_b16 a[166:167], v17 offset:16672
ds_read_b64_tr_b16 a[168:169], v17 offset:18432
ds_read_b64_tr_b16 a[170:171], v17 offset:18688
ds_read_b64_tr_b16 a[172:173], v17 offset:18464
ds_read_b64_tr_b16 a[174:175], v17 offset:18720
s_waitcnt lgkmcnt(0)
ds_read_b64_tr_b16 a[176:177], v17 offset:20480
ds_read_b64_tr_b16 a[178:179], v17 offset:20736
ds_read_b64_tr_b16 a[180:181], v17 offset:20512
ds_read_b64_tr_b16 a[182:183], v17 offset:20768
ds_read_b64_tr_b16 a[184:185], v17 offset:22528
ds_read_b64_tr_b16 a[186:187], v17 offset:22784
ds_read_b64_tr_b16 a[188:189], v17 offset:22560
ds_read_b64_tr_b16 a[190:191], v17 offset:22816
s_waitcnt lgkmcnt(0)
ds_read_b128 v[20:23], v8 offset:40960
ds_read_b128 v[24:27], v8 offset:43008
ds_read_b128 v[28:31], v9 offset:40960
ds_read_b128 v[32:35], v9 offset:43008
ds_read_b128 v[36:39], v8 offset:45056
ds_read_b128 v[40:43], v8 offset:47104
ds_read_b128 v[44:47], v9 offset:45056
ds_read_b128 v[48:51], v9 offset:47104
s_waitcnt lgkmcnt(0)
v_mfma_f32_16x16x32_bf16 v[52:55], v[20:23], a[160:163], v[52:55]
v_mfma_f32_16x16x32_bf16 v[56:59], v[20:23], a[164:167], v[56:59]
v_mfma_f32_16x16x32_bf16 v[60:63], v[24:27], a[160:163], v[60:63]
v_mfma_f32_16x16x32_bf16 v[64:67], v[24:27], a[164:167], v[64:67]
v_mfma_f32_16x16x32_bf16 v[52:55], v[28:31], a[168:171], v[52:55]
v_mfma_f32_16x16x32_bf16 v[56:59], v[28:31], a[172:175], v[56:59]
v_mfma_f32_16x16x32_bf16 v[60:63], v[32:35], a[168:171], v[60:63]
v_mfma_f32_16x16x32_bf16 v[64:67], v[32:35], a[172:175], v[64:67]
v_mfma_f32_16x16x32_bf16 v[52:55], v[36:39], a[176:179], v[52:55]
v_mfma_f32_16x16x32_bf16 v[56:59], v[36:39], a[180:183], v[56:59]
v_mfma_f32_16x16x32_bf16 v[60:63], v[40:43], a[176:179], v[60:63]
v_mfma_f32_16x16x32_bf16 v[64:67], v[40:43], a[180:183], v[64:67]
v_mfma_f32_16x16x32_bf16 v[52:55], v[44:47], a[184:187], v[52:55]
v_mfma_f32_16x16x32_bf16 v[56:59], v[44:47], a[188:191], v[56:59]
v_mfma_f32_16x16x32_bf16 v[60:63], v[48:51], a[184:187], v[60:63]
v_mfma_f32_16x16x32_bf16 v[64:67], v[48:51], a[188:191], v[64:67]
s_waitcnt vmcnt(9)
ds_read_b64_tr_b16 a[192:193], v17 offset:0
ds_read_b64_tr_b16 a[194:195], v17 offset:256
ds_read_b64_tr_b16 a[196:197], v17 offset:32
ds_read_b64_tr_b16 a[198:199], v17 offset:288
ds_read_b64_tr_b16 a[200:201], v17 offset:2048
ds_read_b64_tr_b16 a[202:203], v17 offset:2304
ds_read_b64_tr_b16 a[204:205], v17 offset:2080
ds_read_b64_tr_b16 a[206:207], v17 offset:2336
s_waitcnt lgkmcnt(0)
ds_read_b64_tr_b16 a[208:209], v17 offset:4096
ds_read_b64_tr_b16 a[210:211], v17 offset:4352
ds_read_b64_tr_b16 a[212:213], v17 offset:4128
ds_read_b64_tr_b16 a[214:215], v17 offset:4384
ds_read_b64_tr_b16 a[216:217], v17 offset:6144
ds_read_b64_tr_b16 a[218:219], v17 offset:6400
ds_read_b64_tr_b16 a[220:221], v17 offset:6176
ds_read_b64_tr_b16 a[222:223], v17 offset:6432
s_waitcnt lgkmcnt(0)
ds_read_b128 v[20:23], v8 offset:49152
ds_read_b128 v[24:27], v8 offset:51200
ds_read_b128 v[28:31], v9 offset:49152
ds_read_b128 v[32:35], v9 offset:51200
ds_read_b128 v[36:39], v8 offset:53248
ds_read_b128 v[40:43], v8 offset:55296
ds_read_b128 v[44:47], v9 offset:53248
ds_read_b128 v[48:51], v9 offset:55296
s_waitcnt lgkmcnt(0)
v_mfma_f32_16x16x32_bf16 v[52:55], v[20:23], a[192:195], v[52:55]
v_mfma_f32_16x16x32_bf16 v[56:59], v[20:23], a[196:199], v[56:59]
v_mfma_f32_16x16x32_bf16 v[60:63], v[24:27], a[192:195], v[60:63]
v_mfma_f32_16x16x32_bf16 v[64:67], v[24:27], a[196:199], v[64:67]
v_mfma_f32_16x16x32_bf16 v[52:55], v[28:31], a[200:203], v[52:55]
v_mfma_f32_16x16x32_bf16 v[56:59], v[28:31], a[204:207], v[56:59]
v_mfma_f32_16x16x32_bf16 v[60:63], v[32:35], a[200:203], v[60:63]
v_mfma_f32_16x16x32_bf16 v[64:67], v[32:35], a[204:207], v[64:67]
v_mfma_f32_16x16x32_bf16 v[52:55], v[36:39], a[208:211], v[52:55]
v_mfma_f32_16x16x32_bf16 v[56:59], v[36:39], a[212:215], v[56:59]
v_mfma_f32_16x16x32_bf16 v[60:63], v[40:43], a[208:211], v[60:63]
v_mfma_f32_16x16x32_bf16 v[64:67], v[40:43], a[212:215], v[64:67]
v_mfma_f32_16x16x32_bf16 v[52:55], v[44:47], a[216:219], v[52:55]
v_mfma_f32_16x16x32_bf16 v[56:59], v[44:47], a[220:223], v[56:59]
v_mfma_f32_16x16x32_bf16 v[60:63], v[48:51], a[216:219], v[60:63]
v_mfma_f32_16x16x32_bf16 v[64:67], v[48:51], a[220:223], v[64:67]
s_waitcnt vmcnt(0)
ds_read_b64_tr_b16 a[224:225], v17 offset:8192
ds_read_b64_tr_b16 a[226:227], v17 offset:8448
ds_read_b64_tr_b16 a[228:229], v17 offset:8224
ds_read_b64_tr_b16 a[230:231], v17 offset:8480
ds_read_b64_tr_b16 a[232:233], v17 offset:10240
ds_read_b64_tr_b16 a[234:235], v17 offset:10496
ds_read_b64_tr_b16 a[236:237], v17 offset:10272
ds_read_b64_tr_b16 a[238:239], v17 offset:10528
s_waitcnt lgkmcnt(0)
ds_read_b64_tr_b16 a[240:241], v17 offset:12288
ds_read_b64_tr_b16 a[242:243], v17 offset:12544
ds_read_b64_tr_b16 a[244:245], v17 offset:12320
ds_read_b64_tr_b16 a[246:247], v17 offset:12576
ds_read_b64_tr_b16 a[248:249], v17 offset:14336
ds_read_b64_tr_b16 a[250:251], v17 offset:14592
ds_read_b64_tr_b16 a[252:253], v17 offset:14368
ds_read_b64_tr_b16 a[254:255], v17 offset:14624
s_waitcnt lgkmcnt(0)
ds_read_b128 v[20:23], v8 offset:57344
ds_read_b128 v[24:27], v8 offset:59392
ds_read_b128 v[28:31], v9 offset:57344
ds_read_b128 v[32:35], v9 offset:59392
ds_read_b128 v[36:39], v8 offset:61440
ds_read_b128 v[40:43], v8 offset:63488
ds_read_b128 v[44:47], v9 offset:61440
ds_read_b128 v[48:51], v9 offset:63488
s_waitcnt lgkmcnt(0)
v_mfma_f32_16x16x32_bf16 v[52:55], v[20:23], a[224:227], v[52:55]
v_mfma_f32_16x16x32_bf16 v[56:59], v[20:23], a[228:231], v[56:59]
v_mfma_f32_16x16x32_bf16 v[60:63], v[24:27], a[224:227], v[60:63]
v_mfma_f32_16x16x32_bf16 v[64:67], v[24:27], a[228:231], v[64:67]
v_mfma_f32_16x16x32_bf16 v[52:55], v[28:31], a[232:235], v[52:55]
v_mfma_f32_16x16x32_bf16 v[56:59], v[28:31], a[236:239], v[56:59]
v_mfma_f32_16x16x32_bf16 v[60:63], v[32:35], a[232:235], v[60:63]
v_mfma_f32_16x16x32_bf16 v[64:67], v[32:35], a[236:239], v[64:67]
v_mfma_f32_16x16x32_bf16 v[52:55], v[36:39], a[240:243], v[52:55]
v_mfma_f32_16x16x32_bf16 v[56:59], v[36:39], a[244:247], v[56:59]
v_mfma_f32_16x16x32_bf16 v[60:63], v[40:43], a[240:243], v[60:63]
v_mfma_f32_16x16x32_bf16 v[64:67], v[40:43], a[244:247], v[64:67]
v_mfma_f32_16x16x32_bf16 v[52:55], v[44:47], a[248:251], v[52:55]
v_mfma_f32_16x16x32_bf16 v[56:59], v[44:47], a[252:255], v[56:59]
v_mfma_f32_16x16x32_bf16 v[60:63], v[48:51], a[248:251], v[60:63]
v_mfma_f32_16x16x32_bf16 v[64:67], v[48:51], a[252:255], v[64:67]
s_barrier
s_mov_b32 s50, 0x10000
s_add_u32 m0, s46, 65536
s_nop 0
buffer_load_dwordx4 v6, s[8:11], s50 offen offset:0 lds
s_add_u32 m0, s46, 69504
s_nop 0
buffer_load_dwordx4 v6, s[8:11], s50 offen offset:128 lds
s_add_u32 m0, s46, 73472
s_nop 0
buffer_load_dwordx4 v6, s[8:11], s50 offen offset:256 lds
s_add_u32 m0, s46, 77440
s_nop 0
buffer_load_dwordx4 v6, s[8:11], s50 offen offset:384 lds
s_add_u32 m0, s46, 81408
s_nop 0
buffer_load_dwordx4 v6, s[8:11], s50 offen offset:512 lds
s_add_u32 m0, s46, 85376
s_nop 0
buffer_load_dwordx4 v6, s[8:11], s50 offen offset:640 lds
s_add_u32 m0, s46, 89344
s_nop 0
buffer_load_dwordx4 v6, s[8:11], s50 offen offset:768 lds
s_add_u32 m0, s46, 93312
s_nop 0
buffer_load_dwordx4 v6, s[8:11], s50 offen offset:896 lds
s_add_u32 m0, s46, 97280
s_nop 0
buffer_load_dwordx4 v6, s[8:11], s50 offen offset:1024 lds
s_add_u32 m0, s46, 101248
s_nop 0
buffer_load_dwordx4 v6, s[8:11], s50 offen offset:1152 lds
s_add_u32 m0, s46, 105216
s_nop 0
buffer_load_dwordx4 v6, s[8:11], s50 offen offset:1280 lds
s_add_u32 m0, s46, 109184
s_nop 0
buffer_load_dwordx4 v6, s[8:11], s50 offen offset:1408 lds
s_add_u32 m0, s46, 113152
s_nop 0
buffer_load_dwordx4 v6, s[8:11], s50 offen offset:1536 lds
s_add_u32 m0, s46, 117120
s_nop 0
buffer_load_dwordx4 v6, s[8:11], s50 offen offset:1664 lds
s_add_u32 m0, s46, 121088
s_nop 0
buffer_load_dwordx4 v6, s[8:11], s50 offen offset:1792 lds
s_add_u32 m0, s46, 125056
s_nop 0
buffer_load_dwordx4 v6, s[8:11], s50 offen offset:1920 lds
s_and_b32 s53, s47, 31
s_lshl_b32 s53, s53, 4
v_add_u32 v19, s53, v1
v_lshlrev_b32 v19, 7, v19
s_mov_b32 s42, 1
v_and_b32 v3, 15, v0
v_lshlrev_b32 v3, 4, v3
s_branch mega_kernel_syv
mega_kernel_syvw:
s_sleep 4
mega_kernel_syv:
buffer_load_dword v2, v3, s[72:75], 0 offen sc1
s_waitcnt vmcnt(0)
s_cmp_eq_u32 s95, 1
s_cbranch_scc0 mega_kernel_syvf
v_readlane_b32 s76, v2, 14
s_mov_b32 s98, 0
s_cmp_eq_u32 s76, 64
s_cbranch_scc0 mega_kernel_syvw
s_branch mega_kernel_syvd
mega_kernel_syvf:
s_mov_b32 s77, 0
s_mov_b32 s78, 0
v_readlane_b32 s76, v2, 0
s_add_u32 s77, s77, s76
s_xor_b32 s76, s76, 32
s_or_b32 s78, s78, s76
v_readlane_b32 s76, v2, 1
s_add_u32 s77, s77, s76
s_xor_b32 s76, s76, 32
s_or_b32 s78, s78, s76
v_readlane_b32 s76, v2, 2
s_add_u32 s77, s77, s76
s_xor_b32 s76, s76, 32
s_or_b32 s78, s78, s76
v_readlane_b32 s76, v2, 3
s_add_u32 s77, s77, s76
s_xor_b32 s76, s76, 32
s_or_b32 s78, s78, s76
v_readlane_b32 s76, v2, 4
s_add_u32 s77, s77, s76
s_xor_b32 s76, s76, 32
s_or_b32 s78, s78, s76
v_readlane_b32 s76, v2, 5
s_add_u32 s77, s77, s76
s_xor_b32 s76, s76, 32
s_or_b32 s78, s78, s76
v_readlane_b32 s76, v2, 6
s_add_u32 s77, s77, s76
s_xor_b32 s76, s76, 32
s_or_b32 s78, s78, s76
v_readlane_b32 s76, v2, 7
s_add_u32 s77, s77, s76
s_xor_b32 s76, s76, 32
s_or_b32 s78, s78, s76
s_cmp_eq_u32 s77, 256
s_cbranch_scc0 mega_kernel_syvw
v_mov_b32 v252, v2
s_cmp_eq_u32 s78, 0
s_cbranch_scc0 mega_kernel_slowent
v_readlane_b32 s76, v2, 10
v_readlane_b32 s77, v2, 8
s_cmp_eq_u32 s76, 64
s_cbranch_scc0 mega_kernel_syvw
s_cmp_gt_u32 s77, 32
s_cselect_b32 s98, 1, 0
mega_kernel_syvd:
s_lshr_b32 s44, s47, 3
s_xor_b32 s44, s44, s98
s_and_b32 s44, s44, 1
s_lshl_b32 s44, s44, 13
s_lshl_b32 s48, s47, 18
s_add_u32 s48, s48, s44
s_add_u32 s48, s48, 33554432
s_xor_b32 s44, s98, 1
s_lshl_b32 s44, s44, 13
s_lshl_b32 s49, s40, 7
s_add_u32 s49, s49, s44
s_lshl_b32 s44, s41, 2
s_add_u32 s49, s49, s44
s_add_u32 s49, s49, 69210112
v_mov_b32 v16, 0
v_cvt_pk_bf16_f32 v84, v52, v53
v_cvt_pk_bf16_f32 v85, v54, v55
v_cvt_pk_bf16_f32 v86, v60, v61
v_cvt_pk_bf16_f32 v87, v62, v63
v_cvt_pk_bf16_f32 v88, v56, v57
v_cvt_pk_bf16_f32 v89, v58, v59
v_cvt_pk_bf16_f32 v90, v64, v65
v_cvt_pk_bf16_f32 v91, v66, v67
s_add_u32 s51, s42, s47
s_sub_u32 s51, s51, 1
s_bfe_u32 s52, s51, 0x40002
s_lshl_b32 s52, s52, 14
s_and_b32 s51, s51, 3
s_lshl_b32 s51, s51, 11
s_add_u32 s51, s51, s52
s_add_u32 s51, s51, s48
buffer_store_dwordx4 v[84:87], v7, s[84:87], s51 offen sc1
buffer_store_dwordx4 v[88:91], v7, s[84:87], s51 offen offset:1024 sc1
s_waitcnt vmcnt(0)
v_mov_b32 v17, s42
s_mov_b64 exec, 1
buffer_store_dword v17, v16, s[84:87], s49 offen sc1
s_mov_b64 exec, -1
mega_kernel_v_loop:
s_waitcnt vmcnt(2)
s_barrier
s_add_u32 s50, s42, 1
s_min_u32 s50, s50, 63
s_lshl_b32 s50, s50, 16
ds_read_b128 v[20:23], v10 offset:0
ds_read_b128 v[24:27], v10 offset:2048
ds_read_b128 v[28:31], v11 offset:0
ds_read_b128 v[32:35], v11 offset:2048
ds_read_b128 v[36:39], v10 offset:4096
ds_read_b128 v[40:43], v10 offset:6144
s_waitcnt lgkmcnt(4)
v_mfma_f32_16x16x32_bf16 v[68:71], v[20:23], a[0:3], 0
ds_read_b128 v[44:47], v11 offset:4096
v_mfma_f32_16x16x32_bf16 v[72:75], v[20:23], a[4:7], 0
v_cvt_pk_bf16_f32 v84, v52, v53
v_cvt_pk_bf16_f32 v85, v54, v55
v_cvt_pk_bf16_f32 v86, v60, v61
v_mfma_f32_16x16x32_bf16 v[76:79], v[24:27], a[0:3], 0
ds_read_b128 v[48:51], v11 offset:6144
v_mfma_f32_16x16x32_bf16 v[80:83], v[24:27], a[4:7], 0
v_cvt_pk_bf16_f32 v87, v62, v63
v_cvt_pk_bf16_f32 v88, v56, v57
v_cvt_pk_bf16_f32 v89, v58, v59
s_waitcnt lgkmcnt(4)
v_mfma_f32_16x16x32_bf16 v[68:71], v[28:31], a[8:11], v[68:71]
ds_read_b128 v[20:23], v10 offset:8192
v_mfma_f32_16x16x32_bf16 v[72:75], v[28:31], a[12:15], v[72:75]
v_cvt_pk_bf16_f32 v90, v64, v65
v_cvt_pk_bf16_f32 v91, v66, v67
v_mfma_f32_16x16x32_bf16 v[76:79], v[32:35], a[8:11], v[76:79]
ds_read_b128 v[24:27], v10 offset:10240
v_mfma_f32_16x16x32_bf16 v[80:83], v[32:35], a[12:15], v[80:83]
s_add_u32 s51, s42, s47
s_sub_u32 s51, s51, 1
s_bfe_u32 s52, s51, 0x40002
s_lshl_b32 s52, s52, 14
s_waitcnt lgkmcnt(4)
v_mfma_f32_16x16x32_bf16 v[68:71], v[36:39], a[16:19], v[68:71]
ds_read_b128 v[28:31], v11 offset:8192
v_mfma_f32_16x16x32_bf16 v[72:75], v[36:39], a[20:23], v[72:75]
s_and_b32 s51, s51, 3
s_lshl_b32 s51, s51, 11
s_add_u32 s51, s51, s52
s_add_u32 s51, s51, s48
buffer_store_dwordx4 v[84:87], v7, s[84:87], s51 offen sc1
v_mfma_f32_16x16x32_bf16 v[76:79], v[40:43], a[16:19], v[76:79]
ds_read_b128 v[32:35], v11 offset:10240
v_mfma_f32_16x16x32_bf16 v[80:83], v[40:43], a[20:23], v[80:83]
buffer_store_dwordx4 v[88:91], v7, s[84:87], s51 offen offset:1024 sc1
s_waitcnt lgkmcnt(4)
v_mfma_f32_16x16x32_bf16 v[68:71], v[44:47], a[24:27], v[68:71]
ds_read_b128 v[36:39], v10 offset:12288
v_mfma_f32_16x16x32_bf16 v[72:75], v[44:47], a[28:31], v[72:75]
s_add_u32 m0, s46, 0
v_mfma_f32_16x16x32_bf16 v[76:79], v[48:51], a[24:27], v[76:79]
ds_read_b128 v[40:43], v10 offset:14336
v_mfma_f32_16x16x32_bf16 v[80:83], v[48:51], a[28:31], v[80:83]
buffer_load_dwordx4 v6, s[8:11], s50 offen offset:0 lds
s_waitcnt lgkmcnt(4)
v_mfma_f32_16x16x32_bf16 v[68:71], v[20:23], a[32:35], v[68:71]
ds_read_b128 v[44:47], v11 offset:12288
v_mfma_f32_16x16x32_bf16 v[72:75], v[20:23], a[36:39], v[72:75]
s_add_u32 m0, s46, 3968
v_mfma_f32_16x16x32_bf16 v[76:79], v[24:27], a[32:35], v[76:79]
ds_read_b128 v[48:51], v11 offset:14336
v_mfma_f32_16x16x32_bf16 v[80:83], v[24:27], a[36:39], v[80:83]
buffer_load_dwordx4 v6, s[8:11], s50 offen offset:128 lds
s_waitcnt lgkmcnt(4)
v_mfma_f32_16x16x32_bf16 v[68:71], v[28:31], a[40:43], v[68:71]
ds_read_b128 v[20:23], v10 offset:16384
v_mfma_f32_16x16x32_bf16 v[72:75], v[28:31], a[44:47], v[72:75]
s_add_u32 m0, s46, 7936
v_mfma_f32_16x16x32_bf16 v[76:79], v[32:35], a[40:43], v[76:79]
ds_read_b128 v[24:27], v10 offset:18432
v_mfma_f32_16x16x32_bf16 v[80:83], v[32:35], a[44:47], v[80:83]
buffer_load_dwordx4 v6, s[8:11], s50 offen offset:256 lds
s_waitcnt lgkmcnt(4)
v_mfma_f32_16x16x32_bf16 v[68:71], v[36:39], a[48:51], v[68:71]
ds_read_b128 v[28:31], v11 offset:16384
v_mfma_f32_16x16x32_bf16 v[72:75], v[36:39], a[52:55], v[72:75]
s_add_u32 m0, s46, 11904
v_mfma_f32_16x16x32_bf16 v[76:79], v[40:43], a[48:51], v[76:79]
ds_read_b128 v[32:35], v11 offset:18432
v_mfma_f32_16x16x32_bf16 v[80:83], v[40:43], a[52:55], v[80:83]
buffer_load_dwordx4 v6, s[8:11], s50 offen offset:384 lds
s_waitcnt lgkmcnt(4)
v_mfma_f32_16x16x32_bf16 v[68:71], v[44:47], a[56:59], v[68:71]
ds_read_b128 v[36:39], v10 offset:20480
v_mfma_f32_16x16x32_bf16 v[72:75], v[44:47], a[60:63], v[72:75]
s_add_u32 m0, s46, 15872
v_mfma_f32_16x16x32_bf16 v[76:79], v[48:51], a[56:59], v[76:79]
ds_read_b128 v[40:43], v10 offset:22528
v_mfma_f32_16x16x32_bf16 v[80:83], v[48:51], a[60:63], v[80:83]
buffer_load_dwordx4 v6, s[8:11], s50 offen offset:512 lds
s_waitcnt lgkmcnt(4)
v_mfma_f32_16x16x32_bf16 v[68:71], v[20:23], a[64:67], v[68:71]
ds_read_b128 v[44:47], v11 offset:20480
v_mfma_f32_16x16x32_bf16 v[72:75], v[20:23], a[68:71], v[72:75]
s_add_u32 m0, s46, 19840
v_mfma_f32_16x16x32_bf16 v[76:79], v[24:27], a[64:67], v[76:79]
ds_read_b128 v[48:51], v11 offset:22528
v_mfma_f32_16x16x32_bf16 v[80:83], v[24:27], a[68:71], v[80:83]
buffer_load_dwordx4 v6, s[8:11], s50 offen offset:640 lds
s_waitcnt lgkmcnt(4)
v_mfma_f32_16x16x32_bf16 v[68:71], v[28:31], a[72:75], v[68:71]
ds_read_b128 v[20:23], v10 offset:24576
v_mfma_f32_16x16x32_bf16 v[72:75], v[28:31], a[76:79], v[72:75]
s_add_u32 m0, s46, 23808
v_mfma_f32_16x16x32_bf16 v[76:79], v[32:35], a[72:75], v[76:79]
ds_read_b128 v[24:27], v10 offset:26624
v_mfma_f32_16x16x32_bf16 v[80:83], v[32:35], a[76:79], v[80:83]
buffer_load_dwordx4 v6, s[8:11], s50 offen offset:768 lds
s_waitcnt lgkmcnt(4)
v_mfma_f32_16x16x32_bf16 v[68:71], v[36:39], a[80:83], v[68:71]
ds_read_b128 v[28:31], v11 offset:24576
v_mfma_f32_16x16x32_bf16 v[72:75], v[36:39], a[84:87], v[72:75]
s_add_u32 m0, s46, 27776
v_mfma_f32_16x16x32_bf16 v[76:79], v[40:43], a[80:83], v[76:79]
ds_read_b128 v[32:35], v11 offset:26624
v_mfma_f32_16x16x32_bf16 v[80:83], v[40:43], a[84:87], v[80:83]
buffer_load_dwordx4 v6, s[8:11], s50 offen offset:896 lds
s_waitcnt lgkmcnt(4)
v_mfma_f32_16x16x32_bf16 v[68:71], v[44:47], a[88:91], v[68:71]
ds_read_b128 v[36:39], v10 offset:28672
v_mfma_f32_16x16x32_bf16 v[72:75], v[44:47], a[92:95], v[72:75]
s_add_u32 m0, s46, 31744
v_mfma_f32_16x16x32_bf16 v[76:79], v[48:51], a[88:91], v[76:79]
ds_read_b128 v[40:43], v10 offset:30720
v_mfma_f32_16x16x32_bf16 v[80:83], v[48:51], a[92:95], v[80:83]
buffer_load_dwordx4 v6, s[8:11], s50 offen offset:1024 lds
s_waitcnt lgkmcnt(4)
v_mfma_f32_16x16x32_bf16 v[68:71], v[20:23], a[96:99], v[68:71]
ds_read_b128 v[44:47], v11 offset:28672
v_mfma_f32_16x16x32_bf16 v[72:75], v[20:23], a[100:103], v[72:75]
s_add_u32 m0, s46, 35712
v_mfma_f32_16x16x32_bf16 v[76:79], v[24:27], a[96:99], v[76:79]
ds_read_b128 v[48:51], v11 offset:30720
v_mfma_f32_16x16x32_bf16 v[80:83], v[24:27], a[100:103], v[80:83]
buffer_load_dwordx4 v6, s[8:11], s50 offen offset:1152 lds
s_waitcnt lgkmcnt(4)
v_mfma_f32_16x16x32_bf16 v[68:71], v[28:31], a[104:107], v[68:71]
ds_read_b128 v[20:23], v10 offset:32768
v_mfma_f32_16x16x32_bf16 v[72:75], v[28:31], a[108:111], v[72:75]
s_add_u32 m0, s46, 39680
v_mfma_f32_16x16x32_bf16 v[76:79], v[32:35], a[104:107], v[76:79]
ds_read_b128 v[24:27], v10 offset:34816
v_mfma_f32_16x16x32_bf16 v[80:83], v[32:35], a[108:111], v[80:83]
buffer_load_dwordx4 v6, s[8:11], s50 offen offset:1280 lds
s_waitcnt lgkmcnt(4)
v_mfma_f32_16x16x32_bf16 v[68:71], v[36:39], a[112:115], v[68:71]
ds_read_b128 v[28:31], v11 offset:32768
v_mfma_f32_16x16x32_bf16 v[72:75], v[36:39], a[116:119], v[72:75]
s_add_u32 m0, s46, 43648
v_mfma_f32_16x16x32_bf16 v[76:79], v[40:43], a[112:115], v[76:79]
ds_read_b128 v[32:35], v11 offset:34816
v_mfma_f32_16x16x32_bf16 v[80:83], v[40:43], a[116:119], v[80:83]
buffer_load_dwordx4 v6, s[8:11], s50 offen offset:1408 lds
s_waitcnt lgkmcnt(4)
v_mfma_f32_16x16x32_bf16 v[68:71], v[44:47], a[120:123], v[68:71]
ds_read_b128 v[36:39], v10 offset:36864
v_mfma_f32_16x16x32_bf16 v[72:75], v[44:47], a[124:127], v[72:75]
s_add_u32 m0, s46, 47616
v_mfma_f32_16x16x32_bf16 v[76:79], v[48:51], a[120:123], v[76:79]
ds_read_b128 v[40:43], v10 offset:38912
v_mfma_f32_16x16x32_bf16 v[80:83], v[48:51], a[124:127], v[80:83]
buffer_load_dwordx4 v6, s[8:11], s50 offen offset:1536 lds
s_waitcnt lgkmcnt(4)
v_mfma_f32_16x16x32_bf16 v[68:71], v[20:23], a[128:131], v[68:71]
ds_read_b128 v[44:47], v11 offset:36864
v_mfma_f32_16x16x32_bf16 v[72:75], v[20:23], a[132:135], v[72:75]
s_add_u32 m0, s46, 51584
v_mfma_f32_16x16x32_bf16 v[76:79], v[24:27], a[128:131], v[76:79]
ds_read_b128 v[48:51], v11 offset:38912
v_mfma_f32_16x16x32_bf16 v[80:83], v[24:27], a[132:135], v[80:83]
buffer_load_dwordx4 v6, s[8:11], s50 offen offset:1664 lds
s_waitcnt lgkmcnt(4)
v_mfma_f32_16x16x32_bf16 v[68:71], v[28:31], a[136:139], v[68:71]
ds_read_b128 v[20:23], v10 offset:40960
v_mfma_f32_16x16x32_bf16 v[72:75], v[28:31], a[140:143], v[72:75]
s_add_u32 m0, s46, 55552
v_mfma_f32_16x16x32_bf16 v[76:79], v[32:35], a[136:139], v[76:79]
ds_read_b128 v[24:27], v10 offset:43008
v_mfma_f32_16x16x32_bf16 v[80:83], v[32:35], a[140:143], v[80:83]
buffer_load_dwordx4 v6, s[8:11], s50 offen offset:1792 lds
s_waitcnt lgkmcnt(4)
v_mfma_f32_16x16x32_bf16 v[68:71], v[36:39], a[144:147], v[68:71]
ds_read_b128 v[28:31], v11 offset:40960
v_mfma_f32_16x16x32_bf16 v[72:75], v[36:39], a[148:151], v[72:75]
s_add_u32 m0, s46, 59520
v_mfma_f32_16x16x32_bf16 v[76:79], v[40:43], a[144:147], v[76:79]
ds_read_b128 v[32:35], v11 offset:43008
v_mfma_f32_16x16x32_bf16 v[80:83], v[40:43], a[148:151], v[80:83]
buffer_load_dwordx4 v6, s[8:11], s50 offen offset:1920 lds
s_waitcnt lgkmcnt(4)
v_mfma_f32_16x16x32_bf16 v[68:71], v[44:47], a[152:155], v[68:71]
ds_read_b128 v[36:39], v10 offset:45056
v_mfma_f32_16x16x32_bf16 v[72:75], v[44:47], a[156:159], v[72:75]
v_mfma_f32_16x16x32_bf16 v[76:79], v[48:51], a[152:155], v[76:79]
ds_read_b128 v[40:43], v10 offset:47104
v_mfma_f32_16x16x32_bf16 v[80:83], v[48:51], a[156:159], v[80:83]
s_waitcnt lgkmcnt(4)
v_mfma_f32_16x16x32_bf16 v[68:71], v[20:23], a[160:163], v[68:71]
ds_read_b128 v[44:47], v11 offset:45056
v_mfma_f32_16x16x32_bf16 v[72:75], v[20:23], a[164:167], v[72:75]
v_mfma_f32_16x16x32_bf16 v[76:79], v[24:27], a[160:163], v[76:79]
ds_read_b128 v[48:51], v11 offset:47104
v_mfma_f32_16x16x32_bf16 v[80:83], v[24:27], a[164:167], v[80:83]
s_waitcnt lgkmcnt(4)
v_mfma_f32_16x16x32_bf16 v[68:71], v[28:31], a[168:171], v[68:71]
ds_read_b128 v[20:23], v10 offset:49152
v_mfma_f32_16x16x32_bf16 v[72:75], v[28:31], a[172:175], v[72:75]
s_waitcnt vmcnt(16)
v_mov_b32 v17, s42
s_mov_b64 exec, 1
buffer_store_dword v17, v16, s[84:87], s49 offen sc1
s_mov_b64 exec, -1
v_mfma_f32_16x16x32_bf16 v[76:79], v[32:35], a[168:171], v[76:79]
ds_read_b128 v[24:27], v10 offset:51200
v_mfma_f32_16x16x32_bf16 v[80:83], v[32:35], a[172:175], v[80:83]
s_waitcnt lgkmcnt(4)
v_mfma_f32_16x16x32_bf16 v[68:71], v[36:39], a[176:179], v[68:71]
ds_read_b128 v[28:31], v11 offset:49152
v_mfma_f32_16x16x32_bf16 v[72:75], v[36:39], a[180:183], v[72:75]
s_add_u32 s53, s42, 3
s_min_u32 s53, s53, 63
s_lshl_b32 s53, s53, 16
s_mov_b64 exec, 0xffff
buffer_load_dword v250, v19, s[8:11], s53 offen
s_mov_b64 exec, -1
v_mfma_f32_16x16x32_bf16 v[76:79], v[40:43], a[176:179], v[76:79]
ds_read_b128 v[32:35], v11 offset:51200
v_mfma_f32_16x16x32_bf16 v[80:83], v[40:43], a[180:183], v[80:83]
s_waitcnt lgkmcnt(4)
v_mfma_f32_16x16x32_bf16 v[68:71], v[44:47], a[184:187], v[68:71]
ds_read_b128 v[36:39], v10 offset:53248
v_mfma_f32_16x16x32_bf16 v[72:75], v[44:47], a[188:191], v[72:75]
v_mfma_f32_16x16x32_bf16 v[76:79], v[48:51], a[184:187], v[76:79]
ds_read_b128 v[40:43], v10 offset:55296
v_mfma_f32_16x16x32_bf16 v[80:83], v[48:51], a[188:191], v[80:83]
s_waitcnt lgkmcnt(4)
v_mfma_f32_16x16x32_bf16 v[68:71], v[20:23], a[192:195], v[68:71]
ds_read_b128 v[44:47], v11 offset:53248
v_mfma_f32_16x16x32_bf16 v[72:75], v[20:23], a[196:199], v[72:75]
v_mfma_f32_16x16x32_bf16 v[76:79], v[24:27], a[192:195], v[76:79]
ds_read_b128 v[48:51], v11 offset:55296
v_mfma_f32_16x16x32_bf16 v[80:83], v[24:27], a[196:199], v[80:83]
s_waitcnt lgkmcnt(4)
v_mfma_f32_16x16x32_bf16 v[68:71], v[28:31], a[200:203], v[68:71]
ds_read_b128 v[20:23], v10 offset:57344
v_mfma_f32_16x16x32_bf16 v[72:75], v[28:31], a[204:207], v[72:75]
v_mfma_f32_16x16x32_bf16 v[76:79], v[32:35], a[200:203], v[76:79]
ds_read_b128 v[24:27], v10 offset:59392
v_mfma_f32_16x16x32_bf16 v[80:83], v[32:35], a[204:207], v[80:83]
s_waitcnt lgkmcnt(4)
v_mfma_f32_16x16x32_bf16 v[68:71], v[36:39], a[208:211], v[68:71]
ds_read_b128 v[28:31], v11 offset:57344
v_mfma_f32_16x16x32_bf16 v[72:75], v[36:39], a[212:215], v[72:75]
v_mfma_f32_16x16x32_bf16 v[76:79], v[40:43], a[208:211], v[76:79]
ds_read_b128 v[32:35], v11 offset:59392
v_mfma_f32_16x16x32_bf16 v[80:83], v[40:43], a[212:215], v[80:83]
s_waitcnt lgkmcnt(4)
v_mfma_f32_16x16x32_bf16 v[68:71], v[44:47], a[216:219], v[68:71]
ds_read_b128 v[36:39], v10 offset:61440
v_mfma_f32_16x16x32_bf16 v[72:75], v[44:47], a[220:223], v[72:75]
v_mfma_f32_16x16x32_bf16 v[76:79], v[48:51], a[216:219], v[76:79]
ds_read_b128 v[40:43], v10 offset:63488
v_mfma_f32_16x16x32_bf16 v[80:83], v[48:51], a[220:223], v[80:83]
s_waitcnt lgkmcnt(4)
v_mfma_f32_16x16x32_bf16 v[68:71], v[20:23], a[224:227], v[68:71]
ds_read_b128 v[44:47], v11 offset:61440
v_mfma_f32_16x16x32_bf16 v[72:75], v[20:23], a[228:231], v[72:75]
v_mfma_f32_16x16x32_bf16 v[76:79], v[24:27], a[224:227], v[76:79]
ds_read_b128 v[48:51], v11 offset:63488
v_mfma_f32_16x16x32_bf16 v[80:83], v[24:27], a[228:231], v[80:83]
s_waitcnt lgkmcnt(5)
v_mfma_f32_16x16x32_bf16 v[68:71], v[28:31], a[232:235], v[68:71]
v_mfma_f32_16x16x32_bf16 v[72:75], v[28:31], a[236:239], v[72:75]
s_waitcnt lgkmcnt(4)
v_mfma_f32_16x16x32_bf16 v[76:79], v[32:35], a[232:235], v[76:79]
v_mfma_f32_16x16x32_bf16 v[80:83], v[32:35], a[236:239], v[80:83]
s_waitcnt lgkmcnt(3)
v_mfma_f32_16x16x32_bf16 v[68:71], v[36:39], a[240:243], v[68:71]
v_mfma_f32_16x16x32_bf16 v[72:75], v[36:39], a[244:247], v[72:75]
s_waitcnt lgkmcnt(2)
v_mfma_f32_16x16x32_bf16 v[76:79], v[40:43], a[240:243], v[76:79]
v_mfma_f32_16x16x32_bf16 v[80:83], v[40:43], a[244:247], v[80:83]
s_waitcnt lgkmcnt(1)
v_mfma_f32_16x16x32_bf16 v[68:71], v[44:47], a[248:251], v[68:71]
v_mfma_f32_16x16x32_bf16 v[72:75], v[44:47], a[252:255], v[72:75]
s_waitcnt lgkmcnt(0)
v_mfma_f32_16x16x32_bf16 v[76:79], v[48:51], a[248:251], v[76:79]
v_mfma_f32_16x16x32_bf16 v[80:83], v[48:51], a[252:255], v[80:83]
s_add_u32 s42, s42, 1
s_cmp_eq_u32 s42, 64
s_cbranch_scc1 mega_kernel_v_fin
s_waitcnt vmcnt(2)
s_barrier
s_add_u32 s50, s42, 1
s_min_u32 s50, s50, 63
s_lshl_b32 s50, s50, 16
ds_read_b128 v[20:23], v8 offset:0
ds_read_b128 v[24:27], v8 offset:2048
ds_read_b128 v[28:31], v9 offset:0
ds_read_b128 v[32:35], v9 offset:2048
ds_read_b128 v[36:39], v8 offset:4096
ds_read_b128 v[40:43], v8 offset:6144
s_waitcnt lgkmcnt(4)
v_mfma_f32_16x16x32_bf16 v[52:55], v[20:23], a[0:3], 0
ds_read_b128 v[44:47], v9 offset:4096
v_mfma_f32_16x16x32_bf16 v[56:59], v[20:23], a[4:7], 0
v_cvt_pk_bf16_f32 v84, v68, v69
v_cvt_pk_bf16_f32 v85, v70, v71
v_cvt_pk_bf16_f32 v86, v76, v77
v_mfma_f32_16x16x32_bf16 v[60:63], v[24:27], a[0:3], 0
ds_read_b128 v[48:51], v9 offset:6144
v_mfma_f32_16x16x32_bf16 v[64:67], v[24:27], a[4:7], 0
v_cvt_pk_bf16_f32 v87, v78, v79
v_cvt_pk_bf16_f32 v88, v72, v73
v_cvt_pk_bf16_f32 v89, v74, v75
s_waitcnt lgkmcnt(4)
v_mfma_f32_16x16x32_bf16 v[52:55], v[28:31], a[8:11], v[52:55]
ds_read_b128 v[20:23], v8 offset:8192
v_mfma_f32_16x16x32_bf16 v[56:59], v[28:31], a[12:15], v[56:59]
v_cvt_pk_bf16_f32 v90, v80, v81
v_cvt_pk_bf16_f32 v91, v82, v83
v_mfma_f32_16x16x32_bf16 v[60:63], v[32:35], a[8:11], v[60:63]
ds_read_b128 v[24:27], v8 offset:10240
v_mfma_f32_16x16x32_bf16 v[64:67], v[32:35], a[12:15], v[64:67]
s_add_u32 s51, s42, s47
s_sub_u32 s51, s51, 1
s_bfe_u32 s52, s51, 0x40002
s_lshl_b32 s52, s52, 14
s_waitcnt lgkmcnt(4)
v_mfma_f32_16x16x32_bf16 v[52:55], v[36:39], a[16:19], v[52:55]
ds_read_b128 v[28:31], v9 offset:8192
v_mfma_f32_16x16x32_bf16 v[56:59], v[36:39], a[20:23], v[56:59]
s_and_b32 s51, s51, 3
s_lshl_b32 s51, s51, 11
s_add_u32 s51, s51, s52
s_add_u32 s51, s51, s48
buffer_store_dwordx4 v[84:87], v7, s[84:87], s51 offen sc1
v_mfma_f32_16x16x32_bf16 v[60:63], v[40:43], a[16:19], v[60:63]
ds_read_b128 v[32:35], v9 offset:10240
v_mfma_f32_16x16x32_bf16 v[64:67], v[40:43], a[20:23], v[64:67]
buffer_store_dwordx4 v[88:91], v7, s[84:87], s51 offen offset:1024 sc1
s_waitcnt lgkmcnt(4)
v_mfma_f32_16x16x32_bf16 v[52:55], v[44:47], a[24:27], v[52:55]
ds_read_b128 v[36:39], v8 offset:12288
v_mfma_f32_16x16x32_bf16 v[56:59], v[44:47], a[28:31], v[56:59]
s_add_u32 m0, s46, 65536
v_mfma_f32_16x16x32_bf16 v[60:63], v[48:51], a[24:27], v[60:63]
ds_read_b128 v[40:43], v8 offset:14336
v_mfma_f32_16x16x32_bf16 v[64:67], v[48:51], a[28:31], v[64:67]
buffer_load_dwordx4 v6, s[8:11], s50 offen offset:0 lds
s_waitcnt lgkmcnt(4)
v_mfma_f32_16x16x32_bf16 v[52:55], v[20:23], a[32:35], v[52:55]
ds_read_b128 v[44:47], v9 offset:12288
v_mfma_f32_16x16x32_bf16 v[56:59], v[20:23], a[36:39], v[56:59]
s_add_u32 m0, s46, 69504
v_mfma_f32_16x16x32_bf16 v[60:63], v[24:27], a[32:35], v[60:63]
ds_read_b128 v[48:51], v9 offset:14336
v_mfma_f32_16x16x32_bf16 v[64:67], v[24:27], a[36:39], v[64:67]
buffer_load_dwordx4 v6, s[8:11], s50 offen offset:128 lds
s_waitcnt lgkmcnt(4)
v_mfma_f32_16x16x32_bf16 v[52:55], v[28:31], a[40:43], v[52:55]
ds_read_b128 v[20:23], v8 offset:16384
v_mfma_f32_16x16x32_bf16 v[56:59], v[28:31], a[44:47], v[56:59]
s_add_u32 m0, s46, 73472
v_mfma_f32_16x16x32_bf16 v[60:63], v[32:35], a[40:43], v[60:63]
ds_read_b128 v[24:27], v8 offset:18432
v_mfma_f32_16x16x32_bf16 v[64:67], v[32:35], a[44:47], v[64:67]
buffer_load_dwordx4 v6, s[8:11], s50 offen offset:256 lds
s_waitcnt lgkmcnt(4)
v_mfma_f32_16x16x32_bf16 v[52:55], v[36:39], a[48:51], v[52:55]
ds_read_b128 v[28:31], v9 offset:16384
v_mfma_f32_16x16x32_bf16 v[56:59], v[36:39], a[52:55], v[56:59]
s_add_u32 m0, s46, 77440
v_mfma_f32_16x16x32_bf16 v[60:63], v[40:43], a[48:51], v[60:63]
ds_read_b128 v[32:35], v9 offset:18432
v_mfma_f32_16x16x32_bf16 v[64:67], v[40:43], a[52:55], v[64:67]
buffer_load_dwordx4 v6, s[8:11], s50 offen offset:384 lds
s_waitcnt lgkmcnt(4)
v_mfma_f32_16x16x32_bf16 v[52:55], v[44:47], a[56:59], v[52:55]
ds_read_b128 v[36:39], v8 offset:20480
v_mfma_f32_16x16x32_bf16 v[56:59], v[44:47], a[60:63], v[56:59]
s_add_u32 m0, s46, 81408
v_mfma_f32_16x16x32_bf16 v[60:63], v[48:51], a[56:59], v[60:63]
ds_read_b128 v[40:43], v8 offset:22528
v_mfma_f32_16x16x32_bf16 v[64:67], v[48:51], a[60:63], v[64:67]
buffer_load_dwordx4 v6, s[8:11], s50 offen offset:512 lds
s_waitcnt lgkmcnt(4)
v_mfma_f32_16x16x32_bf16 v[52:55], v[20:23], a[64:67], v[52:55]
ds_read_b128 v[44:47], v9 offset:20480
v_mfma_f32_16x16x32_bf16 v[56:59], v[20:23], a[68:71], v[56:59]
s_add_u32 m0, s46, 85376
v_mfma_f32_16x16x32_bf16 v[60:63], v[24:27], a[64:67], v[60:63]
ds_read_b128 v[48:51], v9 offset:22528
v_mfma_f32_16x16x32_bf16 v[64:67], v[24:27], a[68:71], v[64:67]
buffer_load_dwordx4 v6, s[8:11], s50 offen offset:640 lds
s_waitcnt lgkmcnt(4)
v_mfma_f32_16x16x32_bf16 v[52:55], v[28:31], a[72:75], v[52:55]
ds_read_b128 v[20:23], v8 offset:24576
v_mfma_f32_16x16x32_bf16 v[56:59], v[28:31], a[76:79], v[56:59]
s_add_u32 m0, s46, 89344
v_mfma_f32_16x16x32_bf16 v[60:63], v[32:35], a[72:75], v[60:63]
ds_read_b128 v[24:27], v8 offset:26624
v_mfma_f32_16x16x32_bf16 v[64:67], v[32:35], a[76:79], v[64:67]
buffer_load_dwordx4 v6, s[8:11], s50 offen offset:768 lds
s_waitcnt lgkmcnt(4)
v_mfma_f32_16x16x32_bf16 v[52:55], v[36:39], a[80:83], v[52:55]
ds_read_b128 v[28:31], v9 offset:24576
v_mfma_f32_16x16x32_bf16 v[56:59], v[36:39], a[84:87], v[56:59]
s_add_u32 m0, s46, 93312
v_mfma_f32_16x16x32_bf16 v[60:63], v[40:43], a[80:83], v[60:63]
ds_read_b128 v[32:35], v9 offset:26624
v_mfma_f32_16x16x32_bf16 v[64:67], v[40:43], a[84:87], v[64:67]
buffer_load_dwordx4 v6, s[8:11], s50 offen offset:896 lds
s_waitcnt lgkmcnt(4)
v_mfma_f32_16x16x32_bf16 v[52:55], v[44:47], a[88:91], v[52:55]
ds_read_b128 v[36:39], v8 offset:28672
v_mfma_f32_16x16x32_bf16 v[56:59], v[44:47], a[92:95], v[56:59]
s_add_u32 m0, s46, 97280
v_mfma_f32_16x16x32_bf16 v[60:63], v[48:51], a[88:91], v[60:63]
ds_read_b128 v[40:43], v8 offset:30720
v_mfma_f32_16x16x32_bf16 v[64:67], v[48:51], a[92:95], v[64:67]
buffer_load_dwordx4 v6, s[8:11], s50 offen offset:1024 lds
s_waitcnt lgkmcnt(4)
v_mfma_f32_16x16x32_bf16 v[52:55], v[20:23], a[96:99], v[52:55]
ds_read_b128 v[44:47], v9 offset:28672
v_mfma_f32_16x16x32_bf16 v[56:59], v[20:23], a[100:103], v[56:59]
s_add_u32 m0, s46, 101248
v_mfma_f32_16x16x32_bf16 v[60:63], v[24:27], a[96:99], v[60:63]
ds_read_b128 v[48:51], v9 offset:30720
v_mfma_f32_16x16x32_bf16 v[64:67], v[24:27], a[100:103], v[64:67]
buffer_load_dwordx4 v6, s[8:11], s50 offen offset:1152 lds
s_waitcnt lgkmcnt(4)
v_mfma_f32_16x16x32_bf16 v[52:55], v[28:31], a[104:107], v[52:55]
ds_read_b128 v[20:23], v8 offset:32768
v_mfma_f32_16x16x32_bf16 v[56:59], v[28:31], a[108:111], v[56:59]
s_add_u32 m0, s46, 105216
v_mfma_f32_16x16x32_bf16 v[60:63], v[32:35], a[104:107], v[60:63]
ds_read_b128 v[24:27], v8 offset:34816
v_mfma_f32_16x16x32_bf16 v[64:67], v[32:35], a[108:111], v[64:67]
buffer_load_dwordx4 v6, s[8:11], s50 offen offset:1280 lds
s_waitcnt lgkmcnt(4)
v_mfma_f32_16x16x32_bf16 v[52:55], v[36:39], a[112:115], v[52:55]
ds_read_b128 v[28:31], v9 offset:32768
v_mfma_f32_16x16x32_bf16 v[56:59], v[36:39], a[116:119], v[56:59]
s_add_u32 m0, s46, 109184
v_mfma_f32_16x16x32_bf16 v[60:63], v[40:43], a[112:115], v[60:63]
ds_read_b128 v[32:35], v9 offset:34816
v_mfma_f32_16x16x32_bf16 v[64:67], v[40:43], a[116:119], v[64:67]
buffer_load_dwordx4 v6, s[8:11], s50 offen offset:1408 lds
s_waitcnt lgkmcnt(4)
v_mfma_f32_16x16x32_bf16 v[52:55], v[44:47], a[120:123], v[52:55]
ds_read_b128 v[36:39], v8 offset:36864
v_mfma_f32_16x16x32_bf16 v[56:59], v[44:47], a[124:127], v[56:59]
s_add_u32 m0, s46, 113152
v_mfma_f32_16x16x32_bf16 v[60:63], v[48:51], a[120:123], v[60:63]
ds_read_b128 v[40:43], v8 offset:38912
v_mfma_f32_16x16x32_bf16 v[64:67], v[48:51], a[124:127], v[64:67]
buffer_load_dwordx4 v6, s[8:11], s50 offen offset:1536 lds
s_waitcnt lgkmcnt(4)
v_mfma_f32_16x16x32_bf16 v[52:55], v[20:23], a[128:131], v[52:55]
ds_read_b128 v[44:47], v9 offset:36864
v_mfma_f32_16x16x32_bf16 v[56:59], v[20:23], a[132:135], v[56:59]
s_add_u32 m0, s46, 117120
v_mfma_f32_16x16x32_bf16 v[60:63], v[24:27], a[128:131], v[60:63]
ds_read_b128 v[48:51], v9 offset:38912
v_mfma_f32_16x16x32_bf16 v[64:67], v[24:27], a[132:135], v[64:67]
buffer_load_dwordx4 v6, s[8:11], s50 offen offset:1664 lds
s_waitcnt lgkmcnt(4)
v_mfma_f32_16x16x32_bf16 v[52:55], v[28:31], a[136:139], v[52:55]
ds_read_b128 v[20:23], v8 offset:40960
v_mfma_f32_16x16x32_bf16 v[56:59], v[28:31], a[140:143], v[56:59]
s_add_u32 m0, s46, 121088
v_mfma_f32_16x16x32_bf16 v[60:63], v[32:35], a[136:139], v[60:63]
ds_read_b128 v[24:27], v8 offset:43008
v_mfma_f32_16x16x32_bf16 v[64:67], v[32:35], a[140:143], v[64:67]
buffer_load_dwordx4 v6, s[8:11], s50 offen offset:1792 lds
s_waitcnt lgkmcnt(4)
v_mfma_f32_16x16x32_bf16 v[52:55], v[36:39], a[144:147], v[52:55]
ds_read_b128 v[28:31], v9 offset:40960
v_mfma_f32_16x16x32_bf16 v[56:59], v[36:39], a[148:151], v[56:59]
s_add_u32 m0, s46, 125056
v_mfma_f32_16x16x32_bf16 v[60:63], v[40:43], a[144:147], v[60:63]
ds_read_b128 v[32:35], v9 offset:43008
v_mfma_f32_16x16x32_bf16 v[64:67], v[40:43], a[148:151], v[64:67]
buffer_load_dwordx4 v6, s[8:11], s50 offen offset:1920 lds
s_waitcnt lgkmcnt(4)
v_mfma_f32_16x16x32_bf16 v[52:55], v[44:47], a[152:155], v[52:55]
ds_read_b128 v[36:39], v8 offset:45056
v_mfma_f32_16x16x32_bf16 v[56:59], v[44:47], a[156:159], v[56:59]
v_mfma_f32_16x16x32_bf16 v[60:63], v[48:51], a[152:155], v[60:63]
ds_read_b128 v[40:43], v8 offset:47104
v_mfma_f32_16x16x32_bf16 v[64:67], v[48:51], a[156:159], v[64:67]
s_waitcnt lgkmcnt(4)
v_mfma_f32_16x16x32_bf16 v[52:55], v[20:23], a[160:163], v[52:55]
ds_read_b128 v[44:47], v9 offset:45056
v_mfma_f32_16x16x32_bf16 v[56:59], v[20:23], a[164:167], v[56:59]
v_mfma_f32_16x16x32_bf16 v[60:63], v[24:27], a[160:163], v[60:63]
ds_read_b128 v[48:51], v9 offset:47104
v_mfma_f32_16x16x32_bf16 v[64:67], v[24:27], a[164:167], v[64:67]
s_waitcnt lgkmcnt(4)
v_mfma_f32_16x16x32_bf16 v[52:55], v[28:31], a[168:171], v[52:55]
ds_read_b128 v[20:23], v8 offset:49152
v_mfma_f32_16x16x32_bf16 v[56:59], v[28:31], a[172:175], v[56:59]
s_waitcnt vmcnt(16)
v_mov_b32 v17, s42
s_mov_b64 exec, 1
buffer_store_dword v17, v16, s[84:87], s49 offen sc1
s_mov_b64 exec, -1
v_mfma_f32_16x16x32_bf16 v[60:63], v[32:35], a[168:171], v[60:63]
ds_read_b128 v[24:27], v8 offset:51200
v_mfma_f32_16x16x32_bf16 v[64:67], v[32:35], a[172:175], v[64:67]
s_waitcnt lgkmcnt(4)
v_mfma_f32_16x16x32_bf16 v[52:55], v[36:39], a[176:179], v[52:55]
ds_read_b128 v[28:31], v9 offset:49152
v_mfma_f32_16x16x32_bf16 v[56:59], v[36:39], a[180:183], v[56:59]
s_add_u32 s53, s42, 3
s_min_u32 s53, s53, 63
s_lshl_b32 s53, s53, 16
s_mov_b64 exec, 0xffff
buffer_load_dword v250, v19, s[8:11], s53 offen
s_mov_b64 exec, -1
v_mfma_f32_16x16x32_bf16 v[60:63], v[40:43], a[176:179], v[60:63]
ds_read_b128 v[32:35], v9 offset:51200
v_mfma_f32_16x16x32_bf16 v[64:67], v[40:43], a[180:183], v[64:67]
s_waitcnt lgkmcnt(4)
v_mfma_f32_16x16x32_bf16 v[52:55], v[44:47], a[184:187], v[52:55]
ds_read_b128 v[36:39], v8 offset:53248
v_mfma_f32_16x16x32_bf16 v[56:59], v[44:47], a[188:191], v[56:59]
v_mfma_f32_16x16x32_bf16 v[60:63], v[48:51], a[184:187], v[60:63]
ds_read_b128 v[40:43], v8 offset:55296
v_mfma_f32_16x16x32_bf16 v[64:67], v[48:51], a[188:191], v[64:67]
s_waitcnt lgkmcnt(4)
v_mfma_f32_16x16x32_bf16 v[52:55], v[20:23], a[192:195], v[52:55]
ds_read_b128 v[44:47], v9 offset:53248
v_mfma_f32_16x16x32_bf16 v[56:59], v[20:23], a[196:199], v[56:59]
v_mfma_f32_16x16x32_bf16 v[60:63], v[24:27], a[192:195], v[60:63]
ds_read_b128 v[48:51], v9 offset:55296
v_mfma_f32_16x16x32_bf16 v[64:67], v[24:27], a[196:199], v[64:67]
s_waitcnt lgkmcnt(4)
v_mfma_f32_16x16x32_bf16 v[52:55], v[28:31], a[200:203], v[52:55]
ds_read_b128 v[20:23], v8 offset:57344
v_mfma_f32_16x16x32_bf16 v[56:59], v[28:31], a[204:207], v[56:59]
v_mfma_f32_16x16x32_bf16 v[60:63], v[32:35], a[200:203], v[60:63]
ds_read_b128 v[24:27], v8 offset:59392
v_mfma_f32_16x16x32_bf16 v[64:67], v[32:35], a[204:207], v[64:67]
s_waitcnt lgkmcnt(4)
v_mfma_f32_16x16x32_bf16 v[52:55], v[36:39], a[208:211], v[52:55]
ds_read_b128 v[28:31], v9 offset:57344
v_mfma_f32_16x16x32_bf16 v[56:59], v[36:39], a[212:215], v[56:59]
v_mfma_f32_16x16x32_bf16 v[60:63], v[40:43], a[208:211], v[60:63]
ds_read_b128 v[32:35], v9 offset:59392
v_mfma_f32_16x16x32_bf16 v[64:67], v[40:43], a[212:215], v[64:67]
s_waitcnt lgkmcnt(4)
v_mfma_f32_16x16x32_bf16 v[52:55], v[44:47], a[216:219], v[52:55]
ds_read_b128 v[36:39], v8 offset:61440
v_mfma_f32_16x16x32_bf16 v[56:59], v[44:47], a[220:223], v[56:59]
v_mfma_f32_16x16x32_bf16 v[60:63], v[48:51], a[216:219], v[60:63]
ds_read_b128 v[40:43], v8 offset:63488
v_mfma_f32_16x16x32_bf16 v[64:67], v[48:51], a[220:223], v[64:67]
s_waitcnt lgkmcnt(4)
v_mfma_f32_16x16x32_bf16 v[52:55], v[20:23], a[224:227], v[52:55]
ds_read_b128 v[44:47], v9 offset:61440
v_mfma_f32_16x16x32_bf16 v[56:59], v[20:23], a[228:231], v[56:59]
v_mfma_f32_16x16x32_bf16 v[60:63], v[24:27], a[224:227], v[60:63]
ds_read_b128 v[48:51], v9 offset:63488
v_mfma_f32_16x16x32_bf16 v[64:67], v[24:27], a[228:231], v[64:67]
s_waitcnt lgkmcnt(5)
v_mfma_f32_16x16x32_bf16 v[52:55], v[28:31], a[232:235], v[52:55]
v_mfma_f32_16x16x32_bf16 v[56:59], v[28:31], a[236:239], v[56:59]
s_waitcnt lgkmcnt(4)
v_mfma_f32_16x16x32_bf16 v[60:63], v[32:35], a[232:235], v[60:63]
v_mfma_f32_16x16x32_bf16 v[64:67], v[32:35], a[236:239], v[64:67]
s_waitcnt lgkmcnt(3)
v_mfma_f32_16x16x32_bf16 v[52:55], v[36:39], a[240:243], v[52:55]
v_mfma_f32_16x16x32_bf16 v[56:59], v[36:39], a[244:247], v[56:59]
s_waitcnt lgkmcnt(2)
v_mfma_f32_16x16x32_bf16 v[60:63], v[40:43], a[240:243], v[60:63]
v_mfma_f32_16x16x32_bf16 v[64:67], v[40:43], a[244:247], v[64:67]
s_waitcnt lgkmcnt(1)
v_mfma_f32_16x16x32_bf16 v[52:55], v[44:47], a[248:251], v[52:55]
v_mfma_f32_16x16x32_bf16 v[56:59], v[44:47], a[252:255], v[56:59]
s_waitcnt lgkmcnt(0)
v_mfma_f32_16x16x32_bf16 v[60:63], v[48:51], a[248:251], v[60:63]
v_mfma_f32_16x16x32_bf16 v[64:67], v[48:51], a[252:255], v[64:67]
s_add_u32 s42, s42, 1
s_branch mega_kernel_v_loop
mega_kernel_v_fin:
s_nop 11
v_cvt_pk_bf16_f32 v84, v68, v69
v_cvt_pk_bf16_f32 v85, v70, v71
v_cvt_pk_bf16_f32 v86, v76, v77
v_cvt_pk_bf16_f32 v87, v78, v79
v_cvt_pk_bf16_f32 v88, v72, v73
v_cvt_pk_bf16_f32 v89, v74, v75
v_cvt_pk_bf16_f32 v90, v80, v81
v_cvt_pk_bf16_f32 v91, v82, v83
s_add_u32 s51, s42, s47
s_sub_u32 s51, s51, 1
s_bfe_u32 s52, s51, 0x40002
s_lshl_b32 s52, s52, 14
s_and_b32 s51, s51, 3
s_lshl_b32 s51, s51, 11
s_add_u32 s51, s51, s52
s_add_u32 s51, s51, s48
buffer_store_dwordx4 v[84:87], v7, s[84:87], s51 offen sc1
buffer_store_dwordx4 v[88:91], v7, s[84:87], s51 offen offset:1024 sc1
s_waitcnt vmcnt(0)
v_mov_b32 v17, s42
s_mov_b64 exec, 1
buffer_store_dword v17, v16, s[84:87], s49 offen sc1
s_mov_b64 exec, -1
s_waitcnt vmcnt(0)
s_barrier
mega_kernel_fft:
s_mov_b32 s38, s92
s_mov_b32 s39, 64
s_mov_b32 s37, 129
mega_kernel_f2s:
v_mov_b32 v1, 0
s_mov_b32 s82, 69259264
mega_kernel_w0:
s_sleep 8
buffer_load_dword v2, v1, s[84:87], s82 offen sc1
s_waitcnt vmcnt(0)
v_cmp_ne_u32 vcc, 31, v2
s_cbranch_vccnz mega_kernel_w0
s_mov_b32 s48, 0x3f7ec46d
s_mov_b32 s49, 0x3dc8bd36
s_mov_b32 s50, 0x3f7b14be
s_mov_b32 s51, 0x3e47c5c2
s_mov_b32 s52, 0x3f74fa0b
s_mov_b32 s53, 0x3e94a031
s_mov_b32 s54, 0x3f6c835e
s_mov_b32 s55, 0x3ec3ef15
s_mov_b32 s56, 0x3f61c598
s_mov_b32 s57, 0x3ef15aea
s_mov_b32 s58, 0x3f54db31
s_mov_b32 s59, 0x3f0e39da
s_mov_b32 s60, 0x3f45e403
s_mov_b32 s61, 0x3f226799
s_mov_b32 s62, 0x3f3504f3
s_mov_b32 s63, 0x3f3504f3
v_lshrrev_b32 v10, 6, v0
v_and_b32 v1, 63, v0
v_readfirstlane_b32 s16, v10
v_cvt_f32_u32 v2, v1
v_lshlrev_b32 v5, 3, v1
s_mul_i32 s17, s16, 16896
v_add_u32 v3, s17, v5
v_and_b32 v7, 1, v1
v_lshrrev_b32 v6, 1, v1
v_cvt_f32_u32 v8, v6
v_cvt_f32_u32 v10, v7
v_mul_u32_u24 v4, 528, v6
v_lshl_add_u32 v4, v7, 3, v4
v_add_u32 v4, s17, v4
v_lshlrev_b32 v11, 12, v7
v_lshl_add_u32 v11, v6, 2, v11
v_fma_f32 v9, v10, 2.0, -1.0
v_sub_f32 v7, 0, v9
v_mul_f32 v13, v10, v8
v_mul_f32 v13, 0x3a000000, v13
s_mov_b32 s18, 0xaaaaaaaa
s_mov_b32 s19, 0xaaaaaaaa
v_mul_f32 v12, 0xba000000, v2
v_cos_f32 v82, v12
v_sin_f32 v83, v12
v_mul_f32 v12, 0xba800000, v2
v_cos_f32 v84, v12
v_sin_f32 v85, v12
v_mul_f32 v12, 0xbac00000, v2
v_cos_f32 v86, v12
v_sin_f32 v87, v12
v_mul_f32 v12, 0xbb000000, v2
v_cos_f32 v88, v12
v_sin_f32 v89, v12
v_mul_f32 v12, 0xbb200000, v2
v_cos_f32 v90, v12
v_sin_f32 v91, v12
v_mul_f32 v12, 0xbb400000, v2
v_cos_f32 v92, v12
v_sin_f32 v93, v12
v_mul_f32 v12, 0xbb600000, v2
v_cos_f32 v94, v12
v_sin_f32 v95, v12
v_mul_f32 v12, 0xbb800000, v2
v_cos_f32 v96, v12
v_sin_f32 v97, v12
v_mul_f32 v12, 0xbb900000, v2
v_cos_f32 v98, v12
v_sin_f32 v99, v12
v_mul_f32 v12, 0xbba00000, v2
v_cos_f32 v100, v12
v_sin_f32 v101, v12
v_mul_f32 v12, 0xbbb00000, v2
v_cos_f32 v102, v12
v_sin_f32 v103, v12
v_mul_f32 v12, 0xbbc00000, v2
v_cos_f32 v104, v12
v_sin_f32 v105, v12
v_mul_f32 v12, 0xbbd00000, v2
v_cos_f32 v106, v12
v_sin_f32 v107, v12
v_mul_f32 v12, 0xbbe00000, v2
v_cos_f32 v108, v12
v_sin_f32 v109, v12
v_mul_f32 v12, 0xbbf00000, v2
v_cos_f32 v110, v12
v_sin_f32 v111, v12
v_mul_f32 v12, 0xbc000000, v2
v_cos_f32 v112, v12
v_sin_f32 v113, v12
v_mul_f32 v12, 0xbc080000, v2
v_cos_f32 v114, v12
v_sin_f32 v115, v12
v_mul_f32 v12, 0xbc100000, v2
v_cos_f32 v116, v12
v_sin_f32 v117, v12
v_mul_f32 v12, 0xbc180000, v2
v_cos_f32 v118, v12
v_sin_f32 v119, v12
v_mul_f32 v12, 0xbc200000, v2
v_cos_f32 v120, v12
v_sin_f32 v121, v12
v_mul_f32 v12, 0xbc280000, v2
v_cos_f32 v122, v12
v_sin_f32 v123, v12
v_mul_f32 v12, 0xbc300000, v2
v_cos_f32 v124, v12
v_sin_f32 v125, v12
v_mul_f32 v12, 0xbc380000, v2
v_cos_f32 v126, v12
v_sin_f32 v127, v12
v_mul_f32 v12, 0xbc400000, v2
v_cos_f32 v128, v12
v_sin_f32 v129, v12
v_mul_f32 v12, 0xbc480000, v2
v_cos_f32 v130, v12
v_sin_f32 v131, v12
v_mul_f32 v12, 0xbc500000, v2
v_cos_f32 v132, v12
v_sin_f32 v133, v12
v_mul_f32 v12, 0xbc580000, v2
v_cos_f32 v134, v12
v_sin_f32 v135, v12
v_mul_f32 v12, 0xbc600000, v2
v_cos_f32 v136, v12
v_sin_f32 v137, v12
v_mul_f32 v12, 0xbc680000, v2
v_cos_f32 v138, v12
v_sin_f32 v139, v12
v_mul_f32 v12, 0xbc700000, v2
v_cos_f32 v140, v12
v_sin_f32 v141, v12
v_mul_f32 v12, 0xbc780000, v2
v_cos_f32 v142, v12
v_sin_f32 v143, v12
v_mov_b32 v12, v13
v_fmac_f32 v12, 0x00000000, v8
v_cos_f32 v144, v12
v_sin_f32 v145, v12
v_mov_b32 v12, v13
v_fmac_f32 v12, 0x3a800000, v8
v_cos_f32 v146, v12
v_sin_f32 v147, v12
v_mov_b32 v12, v13
v_fmac_f32 v12, 0x3b000000, v8
v_cos_f32 v148, v12
v_sin_f32 v149, v12
v_mov_b32 v12, v13
v_fmac_f32 v12, 0x3b400000, v8
v_cos_f32 v150, v12
v_sin_f32 v151, v12
v_mov_b32 v12, v13
v_fmac_f32 v12, 0x3b800000, v8
v_cos_f32 v152, v12
v_sin_f32 v153, v12
v_mov_b32 v12, v13
v_fmac_f32 v12, 0x3ba00000, v8
v_cos_f32 v154, v12
v_sin_f32 v155, v12
v_mov_b32 v12, v13
v_fmac_f32 v12, 0x3bc00000, v8
v_cos_f32 v156, v12
v_sin_f32 v157, v12
v_mov_b32 v12, v13
v_fmac_f32 v12, 0x3be00000, v8
v_cos_f32 v158, v12
v_sin_f32 v159, v12
v_mov_b32 v12, v13
v_fmac_f32 v12, 0x3c000000, v8
v_cos_f32 v160, v12
v_sin_f32 v161, v12
v_mov_b32 v12, v13
v_fmac_f32 v12, 0x3c100000, v8
v_cos_f32 v162, v12
v_sin_f32 v163, v12
v_mov_b32 v12, v13
v_fmac_f32 v12, 0x3c200000, v8
v_cos_f32 v164, v12
v_sin_f32 v165, v12
v_mov_b32 v12, v13
v_fmac_f32 v12, 0x3c300000, v8
v_cos_f32 v166, v12
v_sin_f32 v167, v12
v_mov_b32 v12, v13
v_fmac_f32 v12, 0x3c400000, v8
v_cos_f32 v168, v12
v_sin_f32 v169, v12
v_mov_b32 v12, v13
v_fmac_f32 v12, 0x3c500000, v8
v_cos_f32 v170, v12
v_sin_f32 v171, v12
v_mov_b32 v12, v13
v_fmac_f32 v12, 0x3c600000, v8
v_cos_f32 v172, v12
v_sin_f32 v173, v12
v_mov_b32 v12, v13
v_fmac_f32 v12, 0x3c700000, v8
v_cos_f32 v174, v12
v_sin_f32 v175, v12
v_mov_b32 v12, v13
v_fmac_f32 v12, 0x3c800000, v8
v_cos_f32 v176, v12
v_sin_f32 v177, v12
v_mov_b32 v12, v13
v_fmac_f32 v12, 0x3c880000, v8
v_cos_f32 v178, v12
v_sin_f32 v179, v12
v_mov_b32 v12, v13
v_fmac_f32 v12, 0x3c900000, v8
v_cos_f32 v180, v12
v_sin_f32 v181, v12
v_mov_b32 v12, v13
v_fmac_f32 v12, 0x3c980000, v8
v_cos_f32 v182, v12
v_sin_f32 v183, v12
v_mov_b32 v12, v13
v_fmac_f32 v12, 0x3ca00000, v8
v_cos_f32 v184, v12
v_sin_f32 v185, v12
v_mov_b32 v12, v13
v_fmac_f32 v12, 0x3ca80000, v8
v_cos_f32 v186, v12
v_sin_f32 v187, v12
v_mov_b32 v12, v13
v_fmac_f32 v12, 0x3cb00000, v8
v_cos_f32 v188, v12
v_sin_f32 v189, v12
v_mov_b32 v12, v13
v_fmac_f32 v12, 0x3cb80000, v8
v_cos_f32 v190, v12
v_sin_f32 v191, v12
v_mov_b32 v12, v13
v_fmac_f32 v12, 0x3cc00000, v8
v_cos_f32 v192, v12
v_sin_f32 v193, v12
v_mov_b32 v12, v13
v_fmac_f32 v12, 0x3cc80000, v8
v_cos_f32 v194, v12
v_sin_f32 v195, v12
v_mov_b32 v12, v13
v_fmac_f32 v12, 0x3cd00000, v8
v_cos_f32 v196, v12
v_sin_f32 v197, v12
v_mov_b32 v12, v13
v_fmac_f32 v12, 0x3cd80000, v8
v_cos_f32 v198, v12
v_sin_f32 v199, v12
v_mov_b32 v12, v13
v_fmac_f32 v12, 0x3ce00000, v8
v_cos_f32 v200, v12
v_sin_f32 v201, v12
v_mov_b32 v12, v13
v_fmac_f32 v12, 0x3ce80000, v8
v_cos_f32 v202, v12
v_sin_f32 v203, v12
v_mov_b32 v12, v13
v_fmac_f32 v12, 0x3cf00000, v8
v_cos_f32 v204, v12
v_sin_f32 v205, v12
v_mov_b32 v12, v13
v_fmac_f32 v12, 0x3cf80000, v8
v_cos_f32 v206, v12
v_sin_f32 v207, v12
s_nop 0
v_mul_f32 v144, 0x34800000, v144
v_mul_f32 v145, 0x34800000, v145
v_mul_f32 v146, 0x34800000, v146
v_mul_f32 v147, 0x34800000, v147
v_mul_f32 v148, 0x34800000, v148
v_mul_f32 v149, 0x34800000, v149
v_mul_f32 v150, 0x34800000, v150
v_mul_f32 v151, 0x34800000, v151
v_mul_f32 v152, 0x34800000, v152
v_mul_f32 v153, 0x34800000, v153
v_mul_f32 v154, 0x34800000, v154
v_mul_f32 v155, 0x34800000, v155
v_mul_f32 v156, 0x34800000, v156
v_mul_f32 v157, 0x34800000, v157
v_mul_f32 v158, 0x34800000, v158
v_mul_f32 v159, 0x34800000, v159
v_mul_f32 v160, 0x34800000, v160
v_mul_f32 v161, 0x34800000, v161
v_mul_f32 v162, 0x34800000, v162
v_mul_f32 v163, 0x34800000, v163
v_mul_f32 v164, 0x34800000, v164
v_mul_f32 v165, 0x34800000, v165
v_mul_f32 v166, 0x34800000, v166
v_mul_f32 v167, 0x34800000, v167
v_mul_f32 v168, 0x34800000, v168
v_mul_f32 v169, 0x34800000, v169
v_mul_f32 v170, 0x34800000, v170
v_mul_f32 v171, 0x34800000, v171
v_mul_f32 v172, 0x34800000, v172
v_mul_f32 v173, 0x34800000, v173
v_mul_f32 v174, 0x34800000, v174
v_mul_f32 v175, 0x34800000, v175
v_mul_f32 v176, 0x34800000, v176
v_mul_f32 v177, 0x34800000, v177
v_mul_f32 v178, 0x34800000, v178
v_mul_f32 v179, 0x34800000, v179
v_mul_f32 v180, 0x34800000, v180
v_mul_f32 v181, 0x34800000, v181
v_mul_f32 v182, 0x34800000, v182
v_mul_f32 v183, 0x34800000, v183
v_mul_f32 v184, 0x34800000, v184
v_mul_f32 v185, 0x34800000, v185
v_mul_f32 v186, 0x34800000, v186
v_mul_f32 v187, 0x34800000, v187
v_mul_f32 v188, 0x34800000, v188
v_mul_f32 v189, 0x34800000, v189
v_mul_f32 v190, 0x34800000, v190
v_mul_f32 v191, 0x34800000, v191
v_mul_f32 v192, 0x34800000, v192
v_mul_f32 v193, 0x34800000, v193
v_mul_f32 v194, 0x34800000, v194
v_mul_f32 v195, 0x34800000, v195
v_mul_f32 v196, 0x34800000, v196
v_mul_f32 v197, 0x34800000, v197
v_mul_f32 v198, 0x34800000, v198
v_mul_f32 v199, 0x34800000, v199
v_mul_f32 v200, 0x34800000, v200
v_mul_f32 v201, 0x34800000, v201
v_mul_f32 v202, 0x34800000, v202
v_mul_f32 v203, 0x34800000, v203
v_mul_f32 v204, 0x34800000, v204
v_mul_f32 v205, 0x34800000, v205
v_mul_f32 v206, 0x34800000, v206
v_mul_f32 v207, 0x34800000, v207
s_cmp_lt_u32 s38, s37
s_cbranch_scc0 mega_kernel_f2_e
s_lshl_b32 s12, s38, 2
s_add_u32 s12, s12, s16
s_min_u32 s12, s12, 512
s_lshl_b32 s13, s12, 13
s_lshl_b32 s12, s12, 14
s_add_u32 s12, s12, 96468992
s_add_u32 s13, s13, 121634816
buffer_load_dwordx2 a[0:1], v5, s[84:87], s12 offen offset:0 sc1
buffer_load_dwordx2 a[2:3], v5, s[84:87], s12 offen offset:512 sc1
buffer_load_dwordx2 a[4:5], v5, s[84:87], s12 offen offset:1024 sc1
buffer_load_dwordx2 a[6:7], v5, s[84:87], s12 offen offset:1536 sc1
buffer_load_dwordx2 a[8:9], v5, s[84:87], s12 offen offset:2048 sc1
buffer_load_dwordx2 a[10:11], v5, s[84:87], s12 offen offset:2560 sc1
buffer_load_dwordx2 a[12:13], v5, s[84:87], s12 offen offset:3072 sc1
buffer_load_dwordx2 a[14:15], v5, s[84:87], s12 offen offset:3584 sc1
s_add_u32 s12, s12, 4096
buffer_load_dwordx2 a[16:17], v5, s[84:87], s12 offen offset:0 sc1
buffer_load_dwordx2 a[18:19], v5, s[84:87], s12 offen offset:512 sc1
buffer_load_dwordx2 a[20:21], v5, s[84:87], s12 offen offset:1024 sc1
buffer_load_dwordx2 a[22:23], v5, s[84:87], s12 offen offset:1536 sc1
buffer_load_dwordx2 a[24:25], v5, s[84:87], s12 offen offset:2048 sc1
buffer_load_dwordx2 a[26:27], v5, s[84:87], s12 offen offset:2560 sc1
buffer_load_dwordx2 a[28:29], v5, s[84:87], s12 offen offset:3072 sc1
buffer_load_dwordx2 a[30:31], v5, s[84:87], s12 offen offset:3584 sc1
s_add_u32 s12, s12, 4096
buffer_load_dwordx2 a[32:33], v5, s[84:87], s12 offen offset:0 sc1
buffer_load_dwordx2 a[34:35], v5, s[84:87], s12 offen offset:512 sc1
buffer_load_dwordx2 a[36:37], v5, s[84:87], s12 offen offset:1024 sc1
buffer_load_dwordx2 a[38:39], v5, s[84:87], s12 offen offset:1536 sc1
buffer_load_dwordx2 a[40:41], v5, s[84:87], s12 offen offset:2048 sc1
buffer_load_dwordx2 a[42:43], v5, s[84:87], s12 offen offset:2560 sc1
buffer_load_dwordx2 a[44:45], v5, s[84:87], s12 offen offset:3072 sc1
buffer_load_dwordx2 a[46:47], v5, s[84:87], s12 offen offset:3584 sc1
s_add_u32 s12, s12, 4096
buffer_load_dwordx2 a[48:49], v5, s[84:87], s12 offen offset:0 sc1
buffer_load_dwordx2 a[50:51], v5, s[84:87], s12 offen offset:512 sc1
buffer_load_dwordx2 a[52:53], v5, s[84:87], s12 offen offset:1024 sc1
buffer_load_dwordx2 a[54:55], v5, s[84:87], s12 offen offset:1536 sc1
buffer_load_dwordx2 a[56:57], v5, s[84:87], s12 offen offset:2048 sc1
buffer_load_dwordx2 a[58:59], v5, s[84:87], s12 offen offset:2560 sc1
buffer_load_dwordx2 a[60:61], v5, s[84:87], s12 offen offset:3072 sc1
buffer_load_dwordx2 a[62:63], v5, s[84:87], s12 offen offset:3584 sc1
s_add_u32 s12, s12, 4096
buffer_load_dword a64, v11, s[84:87], s13 offen offset:0 sc1
buffer_load_dword a65, v11, s[84:87], s13 offen offset:128 sc1
buffer_load_dword a66, v11, s[84:87], s13 offen offset:256 sc1
buffer_load_dword a67, v11, s[84:87], s13 offen offset:384 sc1
buffer_load_dword a68, v11, s[84:87], s13 offen offset:512 sc1
buffer_load_dword a69, v11, s[84:87], s13 offen offset:640 sc1
buffer_load_dword a70, v11, s[84:87], s13 offen offset:768 sc1
buffer_load_dword a71, v11, s[84:87], s13 offen offset:896 sc1
buffer_load_dword a72, v11, s[84:87], s13 offen offset:1024 sc1
buffer_load_dword a73, v11, s[84:87], s13 offen offset:1152 sc1
buffer_load_dword a74, v11, s[84:87], s13 offen offset:1280 sc1
buffer_load_dword a75, v11, s[84:87], s13 offen offset:1408 sc1
buffer_load_dword a76, v11, s[84:87], s13 offen offset:1536 sc1
buffer_load_dword a77, v11, s[84:87], s13 offen offset:1664 sc1
buffer_load_dword a78, v11, s[84:87], s13 offen offset:1792 sc1
buffer_load_dword a79, v11, s[84:87], s13 offen offset:1920 sc1
buffer_load_dword a80, v11, s[84:87], s13 offen offset:2048 sc1
buffer_load_dword a81, v11, s[84:87], s13 offen offset:2176 sc1
buffer_load_dword a82, v11, s[84:87], s13 offen offset:2304 sc1
buffer_load_dword a83, v11, s[84:87], s13 offen offset:2432 sc1
buffer_load_dword a84, v11, s[84:87], s13 offen offset:2560 sc1
buffer_load_dword a85, v11, s[84:87], s13 offen offset:2688 sc1
buffer_load_dword a86, v11, s[84:87], s13 offen offset:2816 sc1
buffer_load_dword a87, v11, s[84:87], s13 offen offset:2944 sc1
buffer_load_dword a88, v11, s[84:87], s13 offen offset:3072 sc1
buffer_load_dword a89, v11, s[84:87], s13 offen offset:3200 sc1
buffer_load_dword a90, v11, s[84:87], s13 offen offset:3328 sc1
buffer_load_dword a91, v11, s[84:87], s13 offen offset:3456 sc1
buffer_load_dword a92, v11, s[84:87], s13 offen offset:3584 sc1
buffer_load_dword a93, v11, s[84:87], s13 offen offset:3712 sc1
buffer_load_dword a94, v11, s[84:87], s13 offen offset:3840 sc1
buffer_load_dword a95, v11, s[84:87], s13 offen offset:3968 sc1
s_waitcnt vmcnt(0)
mega_kernel_f2_l:
s_add_u32 s21, s38, s39
s_cmp_lt_u32 s21, s37
s_cselect_b32 s22, s21, s38
s_waitcnt vmcnt(32)
v_accvgpr_read_b32 v16, a0
v_accvgpr_read_b32 v17, a1
v_accvgpr_read_b32 v18, a2
v_accvgpr_read_b32 v19, a3
v_accvgpr_read_b32 v20, a4
v_accvgpr_read_b32 v21, a5
v_accvgpr_read_b32 v22, a6
v_accvgpr_read_b32 v23, a7
v_accvgpr_read_b32 v24, a8
v_accvgpr_read_b32 v25, a9
v_accvgpr_read_b32 v26, a10
v_accvgpr_read_b32 v27, a11
v_accvgpr_read_b32 v28, a12
v_accvgpr_read_b32 v29, a13
v_accvgpr_read_b32 v30, a14
v_accvgpr_read_b32 v31, a15
v_accvgpr_read_b32 v32, a16
v_accvgpr_read_b32 v33, a17
v_accvgpr_read_b32 v34, a18
v_accvgpr_read_b32 v35, a19
v_accvgpr_read_b32 v36, a20
v_accvgpr_read_b32 v37, a21
v_accvgpr_read_b32 v38, a22
v_accvgpr_read_b32 v39, a23
v_accvgpr_read_b32 v40, a24
v_accvgpr_read_b32 v41, a25
v_accvgpr_read_b32 v42, a26
v_accvgpr_read_b32 v43, a27
v_accvgpr_read_b32 v44, a28
v_accvgpr_read_b32 v45, a29
v_accvgpr_read_b32 v46, a30
v_accvgpr_read_b32 v47, a31
v_accvgpr_read_b32 v48, a32
v_accvgpr_read_b32 v49, a33
v_accvgpr_read_b32 v50, a34
v_accvgpr_read_b32 v51, a35
v_accvgpr_read_b32 v52, a36
v_accvgpr_read_b32 v53, a37
v_accvgpr_read_b32 v54, a38
v_accvgpr_read_b32 v55, a39
v_accvgpr_read_b32 v56, a40
v_accvgpr_read_b32 v57, a41
v_accvgpr_read_b32 v58, a42
v_accvgpr_read_b32 v59, a43
v_accvgpr_read_b32 v60, a44
v_accvgpr_read_b32 v61, a45
v_accvgpr_read_b32 v62, a46
v_accvgpr_read_b32 v63, a47
v_accvgpr_read_b32 v64, a48
v_accvgpr_read_b32 v65, a49
v_accvgpr_read_b32 v66, a50
v_accvgpr_read_b32 v67, a51
v_accvgpr_read_b32 v68, a52
v_accvgpr_read_b32 v69, a53
v_accvgpr_read_b32 v70, a54
v_accvgpr_read_b32 v71, a55
v_accvgpr_read_b32 v72, a56
v_accvgpr_read_b32 v73, a57
v_accvgpr_read_b32 v74, a58
v_accvgpr_read_b32 v75, a59
v_accvgpr_read_b32 v76, a60
v_accvgpr_read_b32 v77, a61
v_accvgpr_read_b32 v78, a62
v_accvgpr_read_b32 v79, a63
v_accvgpr_read_b32 v208, a64
v_accvgpr_read_b32 v209, a65
v_accvgpr_read_b32 v210, a66
v_accvgpr_read_b32 v211, a67
v_accvgpr_read_b32 v212, a68
v_accvgpr_read_b32 v213, a69
v_accvgpr_read_b32 v214, a70
v_accvgpr_read_b32 v215, a71
v_accvgpr_read_b32 v216, a72
v_accvgpr_read_b32 v217, a73
v_accvgpr_read_b32 v218, a74
v_accvgpr_read_b32 v219, a75
v_accvgpr_read_b32 v220, a76
v_accvgpr_read_b32 v221, a77
v_accvgpr_read_b32 v222, a78
v_accvgpr_read_b32 v223, a79
v_accvgpr_read_b32 v224, a80
v_accvgpr_read_b32 v225, a81
v_accvgpr_read_b32 v226, a82
v_accvgpr_read_b32 v227, a83
v_accvgpr_read_b32 v228, a84
v_accvgpr_read_b32 v229, a85
v_accvgpr_read_b32 v230, a86
v_accvgpr_read_b32 v231, a87
v_accvgpr_read_b32 v232, a88
v_accvgpr_read_b32 v233, a89
v_accvgpr_read_b32 v234, a90
v_accvgpr_read_b32 v235, a91
v_accvgpr_read_b32 v236, a92
v_accvgpr_read_b32 v237, a93
v_accvgpr_read_b32 v238, a94
v_accvgpr_read_b32 v239, a95
s_lshl_b32 s12, s22, 2
s_add_u32 s12, s12, s16
s_min_u32 s12, s12, 512
s_lshl_b32 s13, s12, 13
s_lshl_b32 s12, s12, 14
s_add_u32 s12, s12, 96468992
s_add_u32 s13, s13, 121634816
buffer_load_dwordx2 a[0:1], v5, s[84:87], s12 offen offset:0 sc1
buffer_load_dwordx2 a[2:3], v5, s[84:87], s12 offen offset:512 sc1
buffer_load_dwordx2 a[4:5], v5, s[84:87], s12 offen offset:1024 sc1
buffer_load_dwordx2 a[6:7], v5, s[84:87], s12 offen offset:1536 sc1
buffer_load_dwordx2 a[8:9], v5, s[84:87], s12 offen offset:2048 sc1
buffer_load_dwordx2 a[10:11], v5, s[84:87], s12 offen offset:2560 sc1
buffer_load_dwordx2 a[12:13], v5, s[84:87], s12 offen offset:3072 sc1
buffer_load_dwordx2 a[14:15], v5, s[84:87], s12 offen offset:3584 sc1
s_add_u32 s12, s12, 4096
buffer_load_dwordx2 a[16:17], v5, s[84:87], s12 offen offset:0 sc1
buffer_load_dwordx2 a[18:19], v5, s[84:87], s12 offen offset:512 sc1
buffer_load_dwordx2 a[20:21], v5, s[84:87], s12 offen offset:1024 sc1
buffer_load_dwordx2 a[22:23], v5, s[84:87], s12 offen offset:1536 sc1
buffer_load_dwordx2 a[24:25], v5, s[84:87], s12 offen offset:2048 sc1
buffer_load_dwordx2 a[26:27], v5, s[84:87], s12 offen offset:2560 sc1
buffer_load_dwordx2 a[28:29], v5, s[84:87], s12 offen offset:3072 sc1
buffer_load_dwordx2 a[30:31], v5, s[84:87], s12 offen offset:3584 sc1
s_add_u32 s12, s12, 4096
buffer_load_dwordx2 a[32:33], v5, s[84:87], s12 offen offset:0 sc1
buffer_load_dwordx2 a[34:35], v5, s[84:87], s12 offen offset:512 sc1
buffer_load_dwordx2 a[36:37], v5, s[84:87], s12 offen offset:1024 sc1
buffer_load_dwordx2 a[38:39], v5, s[84:87], s12 offen offset:1536 sc1
buffer_load_dwordx2 a[40:41], v5, s[84:87], s12 offen offset:2048 sc1
buffer_load_dwordx2 a[42:43], v5, s[84:87], s12 offen offset:2560 sc1
buffer_load_dwordx2 a[44:45], v5, s[84:87], s12 offen offset:3072 sc1
buffer_load_dwordx2 a[46:47], v5, s[84:87], s12 offen offset:3584 sc1
s_add_u32 s12, s12, 4096
buffer_load_dwordx2 a[48:49], v5, s[84:87], s12 offen offset:0 sc1
buffer_load_dwordx2 a[50:51], v5, s[84:87], s12 offen offset:512 sc1
buffer_load_dwordx2 a[52:53], v5, s[84:87], s12 offen offset:1024 sc1
buffer_load_dwordx2 a[54:55], v5, s[84:87], s12 offen offset:1536 sc1
buffer_load_dwordx2 a[56:57], v5, s[84:87], s12 offen offset:2048 sc1
buffer_load_dwordx2 a[58:59], v5, s[84:87], s12 offen offset:2560 sc1
buffer_load_dwordx2 a[60:61], v5, s[84:87], s12 offen offset:3072 sc1
buffer_load_dwordx2 a[62:63], v5, s[84:87], s12 offen offset:3584 sc1
s_add_u32 s12, s12, 4096
buffer_load_dword a64, v11, s[84:87], s13 offen offset:0 sc1
buffer_load_dword a65, v11, s[84:87], s13 offen offset:128 sc1
buffer_load_dword a66, v11, s[84:87], s13 offen offset:256 sc1
buffer_load_dword a67, v11, s[84:87], s13 offen offset:384 sc1
buffer_load_dword a68, v11, s[84:87], s13 offen offset:512 sc1
buffer_load_dword a69, v11, s[84:87], s13 offen offset:640 sc1
buffer_load_dword a70, v11, s[84:87], s13 offen offset:768 sc1
buffer_load_dword a71, v11, s[84:87], s13 offen offset:896 sc1
buffer_load_dword a72, v11, s[84:87], s13 offen offset:1024 sc1
buffer_load_dword a73, v11, s[84:87], s13 offen offset:1152 sc1
buffer_load_dword a74, v11, s[84:87], s13 offen offset:1280 sc1
buffer_load_dword a75, v11, s[84:87], s13 offen offset:1408 sc1
buffer_load_dword a76, v11, s[84:87], s13 offen offset:1536 sc1
buffer_load_dword a77, v11, s[84:87], s13 offen offset:1664 sc1
buffer_load_dword a78, v11, s[84:87], s13 offen offset:1792 sc1
buffer_load_dword a79, v11, s[84:87], s13 offen offset:1920 sc1
buffer_load_dword a80, v11, s[84:87], s13 offen offset:2048 sc1
buffer_load_dword a81, v11, s[84:87], s13 offen offset:2176 sc1
buffer_load_dword a82, v11, s[84:87], s13 offen offset:2304 sc1
buffer_load_dword a83, v11, s[84:87], s13 offen offset:2432 sc1
buffer_load_dword a84, v11, s[84:87], s13 offen offset:2560 sc1
buffer_load_dword a85, v11, s[84:87], s13 offen offset:2688 sc1
buffer_load_dword a86, v11, s[84:87], s13 offen offset:2816 sc1
buffer_load_dword a87, v11, s[84:87], s13 offen offset:2944 sc1
buffer_load_dword a88, v11, s[84:87], s13 offen offset:3072 sc1
buffer_load_dword a89, v11, s[84:87], s13 offen offset:3200 sc1
buffer_load_dword a90, v11, s[84:87], s13 offen offset:3328 sc1
buffer_load_dword a91, v11, s[84:87], s13 offen offset:3456 sc1
buffer_load_dword a92, v11, s[84:87], s13 offen offset:3584 sc1
buffer_load_dword a93, v11, s[84:87], s13 offen offset:3712 sc1
buffer_load_dword a94, v11, s[84:87], s13 offen offset:3840 sc1
buffer_load_dword a95, v11, s[84:87], s13 offen offset:3968 sc1
v_pk_add_f32 v[14:15], v[16:17], v[48:49] neg_lo:[0,1] neg_hi:[0,1]
v_pk_add_f32 v[16:17], v[16:17], v[48:49]
v_pk_add_f32 v[48:49], v[18:19], v[50:51] neg_lo:[0,1] neg_hi:[0,1]
v_pk_add_f32 v[18:19], v[18:19], v[50:51]
v_pk_mul_f32 v[50:51], v[48:49], s[50:51] op_sel:[0,0] op_sel_hi:[0,1] neg_lo:[0,0] neg_hi:[0,1]
v_pk_fma_f32 v[50:51], v[48:49], s[50:51], v[50:51] op_sel:[1,1,0] op_sel_hi:[1,0,1] neg_lo:[0,0,0] neg_hi:[0,0,0]
v_pk_add_f32 v[48:49], v[20:21], v[52:53] neg_lo:[0,1] neg_hi:[0,1]
v_pk_add_f32 v[20:21], v[20:21], v[52:53]
v_pk_mul_f32 v[52:53], v[48:49], s[54:55] op_sel:[0,0] op_sel_hi:[0,1] neg_lo:[0,0] neg_hi:[0,1]
v_pk_fma_f32 v[52:53], v[48:49], s[54:55], v[52:53] op_sel:[1,1,0] op_sel_hi:[1,0,1] neg_lo:[0,0,0] neg_hi:[0,0,0]
v_pk_add_f32 v[48:49], v[22:23], v[54:55] neg_lo:[0,1] neg_hi:[0,1]
v_pk_add_f32 v[22:23], v[22:23], v[54:55]
v_pk_mul_f32 v[54:55], v[48:49], s[58:59] op_sel:[0,0] op_sel_hi:[0,1] neg_lo:[0,0] neg_hi:[0,1]
v_pk_fma_f32 v[54:55], v[48:49], s[58:59], v[54:55] op_sel:[1,1,0] op_sel_hi:[1,0,1] neg_lo:[0,0,0] neg_hi:[0,0,0]
v_pk_add_f32 v[48:49], v[24:25], v[56:57] neg_lo:[0,1] neg_hi:[0,1]
v_pk_add_f32 v[24:25], v[24:25], v[56:57]
v_pk_mul_f32 v[56:57], v[48:49], s[62:63] op_sel:[0,0] op_sel_hi:[0,1] neg_lo:[0,0] neg_hi:[0,1]
v_pk_fma_f32 v[56:57], v[48:49], s[62:63], v[56:57] op_sel:[1,1,0] op_sel_hi:[1,0,1] neg_lo:[0,0,0] neg_hi:[0,0,0]
v_pk_add_f32 v[48:49], v[26:27], v[58:59] neg_lo:[0,1] neg_hi:[0,1]
v_pk_add_f32 v[26:27], v[26:27], v[58:59]
v_pk_mul_f32 v[58:59], v[48:49], s[58:59] op_sel:[0,1] op_sel_hi:[0,0] neg_lo:[0,0] neg_hi:[0,1]
v_pk_fma_f32 v[58:59], v[48:49], s[58:59], v[58:59] op_sel:[1,0,0] op_sel_hi:[1,1,1] neg_lo:[0,0,0] neg_hi:[0,0,0]
v_pk_add_f32 v[48:49], v[28:29], v[60:61] neg_lo:[0,1] neg_hi:[0,1]
v_pk_add_f32 v[28:29], v[28:29], v[60:61]
v_pk_mul_f32 v[60:61], v[48:49], s[54:55] op_sel:[0,1] op_sel_hi:[0,0] neg_lo:[0,0] neg_hi:[0,1]
v_pk_fma_f32 v[60:61], v[48:49], s[54:55], v[60:61] op_sel:[1,0,0] op_sel_hi:[1,1,1] neg_lo:[0,0,0] neg_hi:[0,0,0]
v_pk_add_f32 v[48:49], v[30:31], v[62:63] neg_lo:[0,1] neg_hi:[0,1]
v_pk_add_f32 v[30:31], v[30:31], v[62:63]
v_pk_mul_f32 v[62:63], v[48:49], s[50:51] op_sel:[0,1] op_sel_hi:[0,0] neg_lo:[0,0] neg_hi:[0,1]
v_pk_fma_f32 v[62:63], v[48:49], s[50:51], v[62:63] op_sel:[1,0,0] op_sel_hi:[1,1,1] neg_lo:[0,0,0] neg_hi:[0,0,0]
v_pk_add_f32 v[48:49], v[32:33], v[64:65] op_sel:[1,1] op_sel_hi:[0,0] neg_lo:[0,1] neg_hi:[1,0]
v_pk_add_f32 v[32:33], v[32:33], v[64:65]
v_pk_add_f32 v[64:65], v[34:35], v[66:67] neg_lo:[0,1] neg_hi:[0,1]
v_pk_add_f32 v[34:35], v[34:35], v[66:67]
v_pk_mul_f32 v[66:67], v[64:65], s[50:51] op_sel:[0,1] op_sel_hi:[0,0] neg_lo:[0,1] neg_hi:[0,1]
v_pk_fma_f32 v[66:67], v[64:65], s[50:51], v[66:67] op_sel:[1,0,0] op_sel_hi:[1,1,1] neg_lo:[0,0,0] neg_hi:[0,1,0]
v_pk_add_f32 v[64:65], v[36:37], v[68:69] neg_lo:[0,1] neg_hi:[0,1]
v_pk_add_f32 v[36:37], v[36:37], v[68:69]
v_pk_mul_f32 v[68:69], v[64:65], s[54:55] op_sel:[0,1] op_sel_hi:[0,0] neg_lo:[0,1] neg_hi:[0,1]
v_pk_fma_f32 v[68:69], v[64:65], s[54:55], v[68:69] op_sel:[1,0,0] op_sel_hi:[1,1,1] neg_lo:[0,0,0] neg_hi:[0,1,0]
v_pk_add_f32 v[64:65], v[38:39], v[70:71] neg_lo:[0,1] neg_hi:[0,1]
v_pk_add_f32 v[38:39], v[38:39], v[70:71]
v_pk_mul_f32 v[70:71], v[64:65], s[58:59] op_sel:[0,1] op_sel_hi:[0,0] neg_lo:[0,1] neg_hi:[0,1]
v_pk_fma_f32 v[70:71], v[64:65], s[58:59], v[70:71] op_sel:[1,0,0] op_sel_hi:[1,1,1] neg_lo:[0,0,0] neg_hi:[0,1,0]
v_pk_add_f32 v[64:65], v[40:41], v[72:73] neg_lo:[0,1] neg_hi:[0,1]
v_pk_add_f32 v[40:41], v[40:41], v[72:73]
v_pk_mul_f32 v[72:73], v[64:65], s[62:63] op_sel:[0,0] op_sel_hi:[0,1] neg_lo:[0,1] neg_hi:[0,1]
v_pk_fma_f32 v[72:73], v[64:65], s[62:63], v[72:73] op_sel:[1,1,0] op_sel_hi:[1,0,1] neg_lo:[0,0,0] neg_hi:[0,1,0]
v_pk_add_f32 v[64:65], v[42:43], v[74:75] neg_lo:[0,1] neg_hi:[0,1]
v_pk_add_f32 v[42:43], v[42:43], v[74:75]
v_pk_mul_f32 v[74:75], v[64:65], s[58:59] op_sel:[0,0] op_sel_hi:[0,1] neg_lo:[0,1] neg_hi:[0,1]
v_pk_fma_f32 v[74:75], v[64:65], s[58:59], v[74:75] op_sel:[1,1,0] op_sel_hi:[1,0,1] neg_lo:[0,0,0] neg_hi:[0,1,0]
v_pk_add_f32 v[64:65], v[44:45], v[76:77] neg_lo:[0,1] neg_hi:[0,1]
v_pk_add_f32 v[44:45], v[44:45], v[76:77]
v_pk_mul_f32 v[76:77], v[64:65], s[54:55] op_sel:[0,0] op_sel_hi:[0,1] neg_lo:[0,1] neg_hi:[0,1]
v_pk_fma_f32 v[76:77], v[64:65], s[54:55], v[76:77] op_sel:[1,1,0] op_sel_hi:[1,0,1] neg_lo:[0,0,0] neg_hi:[0,1,0]
v_pk_add_f32 v[64:65], v[46:47], v[78:79] neg_lo:[0,1] neg_hi:[0,1]
v_pk_add_f32 v[46:47], v[46:47], v[78:79]
v_pk_mul_f32 v[78:79], v[64:65], s[50:51] op_sel:[0,0] op_sel_hi:[0,1] neg_lo:[0,1] neg_hi:[0,1]
v_pk_fma_f32 v[78:79], v[64:65], s[50:51], v[78:79] op_sel:[1,1,0] op_sel_hi:[1,0,1] neg_lo:[0,0,0] neg_hi:[0,1,0]
v_pk_add_f32 v[64:65], v[16:17], v[32:33] neg_lo:[0,1] neg_hi:[0,1]
v_pk_add_f32 v[16:17], v[16:17], v[32:33]
v_pk_add_f32 v[32:33], v[18:19], v[34:35] neg_lo:[0,1] neg_hi:[0,1]
v_pk_add_f32 v[18:19], v[18:19], v[34:35]
v_pk_mul_f32 v[34:35], v[32:33], s[54:55] op_sel:[0,0] op_sel_hi:[0,1] neg_lo:[0,0] neg_hi:[0,1]
v_pk_fma_f32 v[34:35], v[32:33], s[54:55], v[34:35] op_sel:[1,1,0] op_sel_hi:[1,0,1] neg_lo:[0,0,0] neg_hi:[0,0,0]
v_pk_add_f32 v[32:33], v[20:21], v[36:37] neg_lo:[0,1] neg_hi:[0,1]
v_pk_add_f32 v[20:21], v[20:21], v[36:37]
v_pk_mul_f32 v[36:37], v[32:33], s[62:63] op_sel:[0,0] op_sel_hi:[0,1] neg_lo:[0,0] neg_hi:[0,1]
v_pk_fma_f32 v[36:37], v[32:33], s[62:63], v[36:37] op_sel:[1,1,0] op_sel_hi:[1,0,1] neg_lo:[0,0,0] neg_hi:[0,0,0]
v_pk_add_f32 v[32:33], v[22:23], v[38:39] neg_lo:[0,1] neg_hi:[0,1]
v_pk_add_f32 v[22:23], v[22:23], v[38:39]
v_pk_mul_f32 v[38:39], v[32:33], s[54:55] op_sel:[0,1] op_sel_hi:[0,0] neg_lo:[0,0] neg_hi:[0,1]
v_pk_fma_f32 v[38:39], v[32:33], s[54:55], v[38:39] op_sel:[1,0,0] op_sel_hi:[1,1,1] neg_lo:[0,0,0] neg_hi:[0,0,0]
v_pk_add_f32 v[32:33], v[24:25], v[40:41] op_sel:[1,1] op_sel_hi:[0,0] neg_lo:[0,1] neg_hi:[1,0]
v_pk_add_f32 v[24:25], v[24:25], v[40:41]
v_pk_add_f32 v[40:41], v[26:27], v[42:43] neg_lo:[0,1] neg_hi:[0,1]
v_pk_add_f32 v[26:27], v[26:27], v[42:43]
v_pk_mul_f32 v[42:43], v[40:41], s[54:55] op_sel:[0,1] op_sel_hi:[0,0] neg_lo:[0,1] neg_hi:[0,1]
v_pk_fma_f32 v[42:43], v[40:41], s[54:55], v[42:43] op_sel:[1,0,0] op_sel_hi:[1,1,1] neg_lo:[0,0,0] neg_hi:[0,1,0]
v_pk_add_f32 v[40:41], v[28:29], v[44:45] neg_lo:[0,1] neg_hi:[0,1]
v_pk_add_f32 v[28:29], v[28:29], v[44:45]
v_pk_mul_f32 v[44:45], v[40:41], s[62:63] op_sel:[0,0] op_sel_hi:[0,1] neg_lo:[0,1] neg_hi:[0,1]
v_pk_fma_f32 v[44:45], v[40:41], s[62:63], v[44:45] op_sel:[1,1,0] op_sel_hi:[1,0,1] neg_lo:[0,0,0] neg_hi:[0,1,0]
v_pk_add_f32 v[40:41], v[30:31], v[46:47] neg_lo:[0,1] neg_hi:[0,1]
v_pk_add_f32 v[30:31], v[30:31], v[46:47]
v_pk_mul_f32 v[46:47], v[40:41], s[54:55] op_sel:[0,0] op_sel_hi:[0,1] neg_lo:[0,1] neg_hi:[0,1]
v_pk_fma_f32 v[46:47], v[40:41], s[54:55], v[46:47] op_sel:[1,1,0] op_sel_hi:[1,0,1] neg_lo:[0,0,0] neg_hi:[0,1,0]
v_pk_add_f32 v[40:41], v[14:15], v[48:49] neg_lo:[0,1] neg_hi:[0,1]
v_pk_add_f32 v[14:15], v[14:15], v[48:49]
v_pk_add_f32 v[48:49], v[50:51], v[66:67] neg_lo:[0,1] neg_hi:[0,1]
v_pk_add_f32 v[50:51], v[50:51], v[66:67]
v_pk_mul_f32 v[66:67], v[48:49], s[54:55] op_sel:[0,0] op_sel_hi:[0,1] neg_lo:[0,0] neg_hi:[0,1]
v_pk_fma_f32 v[66:67], v[48:49], s[54:55], v[66:67] op_sel:[1,1,0] op_sel_hi:[1,0,1] neg_lo:[0,0,0] neg_hi:[0,0,0]
v_pk_add_f32 v[48:49], v[52:53], v[68:69] neg_lo:[0,1] neg_hi:[0,1]
v_pk_add_f32 v[52:53], v[52:53], v[68:69]
v_pk_mul_f32 v[68:69], v[48:49], s[62:63] op_sel:[0,0] op_sel_hi:[0,1] neg_lo:[0,0] neg_hi:[0,1]
v_pk_fma_f32 v[68:69], v[48:49], s[62:63], v[68:69] op_sel:[1,1,0] op_sel_hi:[1,0,1] neg_lo:[0,0,0] neg_hi:[0,0,0]
v_pk_add_f32 v[48:49], v[54:55], v[70:71] neg_lo:[0,1] neg_hi:[0,1]
v_pk_add_f32 v[54:55], v[54:55], v[70:71]
v_pk_mul_f32 v[70:71], v[48:49], s[54:55] op_sel:[0,1] op_sel_hi:[0,0] neg_lo:[0,0] neg_hi:[0,1]
v_pk_fma_f32 v[70:71], v[48:49], s[54:55], v[70:71] op_sel:[1,0,0] op_sel_hi:[1,1,1] neg_lo:[0,0,0] neg_hi:[0,0,0]
v_pk_add_f32 v[48:49], v[56:57], v[72:73] op_sel:[1,1] op_sel_hi:[0,0] neg_lo:[0,1] neg_hi:[1,0]
v_pk_add_f32 v[56:57], v[56:57], v[72:73]
v_pk_add_f32 v[72:73], v[58:59], v[74:75] neg_lo:[0,1] neg_hi:[0,1]
v_pk_add_f32 v[58:59], v[58:59], v[74:75]
v_pk_mul_f32 v[74:75], v[72:73], s[54:55] op_sel:[0,1] op_sel_hi:[0,0] neg_lo:[0,1] neg_hi:[0,1]
v_pk_fma_f32 v[74:75], v[72:73], s[54:55], v[74:75] op_sel:[1,0,0] op_sel_hi:[1,1,1] neg_lo:[0,0,0] neg_hi:[0,1,0]
v_pk_add_f32 v[72:73], v[60:61], v[76:77] neg_lo:[0,1] neg_hi:[0,1]
v_pk_add_f32 v[60:61], v[60:61], v[76:77]
v_pk_mul_f32 v[76:77], v[72:73], s[62:63] op_sel:[0,0] op_sel_hi:[0,1] neg_lo:[0,1] neg_hi:[0,1]
v_pk_fma_f32 v[76:77], v[72:73], s[62:63], v[76:77] op_sel:[1,1,0] op_sel_hi:[1,0,1] neg_lo:[0,0,0] neg_hi:[0,1,0]
v_pk_add_f32 v[72:73], v[62:63], v[78:79] neg_lo:[0,1] neg_hi:[0,1]
v_pk_add_f32 v[62:63], v[62:63], v[78:79]
v_pk_mul_f32 v[78:79], v[72:73], s[54:55] op_sel:[0,0] op_sel_hi:[0,1] neg_lo:[0,1] neg_hi:[0,1]
v_pk_fma_f32 v[78:79], v[72:73], s[54:55], v[78:79] op_sel:[1,1,0] op_sel_hi:[1,0,1] neg_lo:[0,0,0] neg_hi:[0,1,0]
v_pk_add_f32 v[72:73], v[16:17], v[24:25] neg_lo:[0,1] neg_hi:[0,1]
v_pk_add_f32 v[16:17], v[16:17], v[24:25]
v_pk_add_f32 v[24:25], v[18:19], v[26:27] neg_lo:[0,1] neg_hi:[0,1]
v_pk_add_f32 v[18:19], v[18:19], v[26:27]
v_pk_mul_f32 v[26:27], v[24:25], s[62:63] op_sel:[0,0] op_sel_hi:[0,1] neg_lo:[0,0] neg_hi:[0,1]
v_pk_fma_f32 v[26:27], v[24:25], s[62:63], v[26:27] op_sel:[1,1,0] op_sel_hi:[1,0,1] neg_lo:[0,0,0] neg_hi:[0,0,0]
v_pk_add_f32 v[24:25], v[20:21], v[28:29] op_sel:[1,1] op_sel_hi:[0,0] neg_lo:[0,1] neg_hi:[1,0]
v_pk_add_f32 v[20:21], v[20:21], v[28:29]
v_pk_add_f32 v[28:29], v[22:23], v[30:31] neg_lo:[0,1] neg_hi:[0,1]
v_pk_add_f32 v[22:23], v[22:23], v[30:31]
v_pk_mul_f32 v[30:31], v[28:29], s[62:63] op_sel:[0,0] op_sel_hi:[0,1] neg_lo:[0,1] neg_hi:[0,1]
v_pk_fma_f32 v[30:31], v[28:29], s[62:63], v[30:31] op_sel:[1,1,0] op_sel_hi:[1,0,1] neg_lo:[0,0,0] neg_hi:[0,1,0]
v_pk_add_f32 v[28:29], v[64:65], v[32:33] neg_lo:[0,1] neg_hi:[0,1]
v_pk_add_f32 v[64:65], v[64:65], v[32:33]
v_pk_add_f32 v[32:33], v[34:35], v[42:43] neg_lo:[0,1] neg_hi:[0,1]
v_pk_add_f32 v[34:35], v[34:35], v[42:43]
v_pk_mul_f32 v[42:43], v[32:33], s[62:63] op_sel:[0,0] op_sel_hi:[0,1] neg_lo:[0,0] neg_hi:[0,1]
v_pk_fma_f32 v[42:43], v[32:33], s[62:63], v[42:43] op_sel:[1,1,0] op_sel_hi:[1,0,1] neg_lo:[0,0,0] neg_hi:[0,0,0]
v_pk_add_f32 v[32:33], v[36:37], v[44:45] op_sel:[1,1] op_sel_hi:[0,0] neg_lo:[0,1] neg_hi:[1,0]
v_pk_add_f32 v[36:37], v[36:37], v[44:45]
v_pk_add_f32 v[44:45], v[38:39], v[46:47] neg_lo:[0,1] neg_hi:[0,1]
v_pk_add_f32 v[38:39], v[38:39], v[46:47]
v_pk_mul_f32 v[46:47], v[44:45], s[62:63] op_sel:[0,0] op_sel_hi:[0,1] neg_lo:[0,1] neg_hi:[0,1]
v_pk_fma_f32 v[46:47], v[44:45], s[62:63], v[46:47] op_sel:[1,1,0] op_sel_hi:[1,0,1] neg_lo:[0,0,0] neg_hi:[0,1,0]
v_pk_add_f32 v[44:45], v[14:15], v[56:57] neg_lo:[0,1] neg_hi:[0,1]
v_pk_add_f32 v[14:15], v[14:15], v[56:57]
v_pk_add_f32 v[56:57], v[50:51], v[58:59] neg_lo:[0,1] neg_hi:[0,1]
v_pk_add_f32 v[50:51], v[50:51], v[58:59]
v_pk_mul_f32 v[58:59], v[56:57], s[62:63] op_sel:[0,0] op_sel_hi:[0,1] neg_lo:[0,0] neg_hi:[0,1]
v_pk_fma_f32 v[58:59], v[56:57], s[62:63], v[58:59] op_sel:[1,1,0] op_sel_hi:[1,0,1] neg_lo:[0,0,0] neg_hi:[0,0,0]
v_pk_add_f32 v[56:57], v[52:53], v[60:61] op_sel:[1,1] op_sel_hi:[0,0] neg_lo:[0,1] neg_hi:[1,0]
v_pk_add_f32 v[52:53], v[52:53], v[60:61]
v_pk_add_f32 v[60:61], v[54:55], v[62:63] neg_lo:[0,1] neg_hi:[0,1]
v_pk_add_f32 v[54:55], v[54:55], v[62:63]
v_pk_mul_f32 v[62:63], v[60:61], s[62:63] op_sel:[0,0] op_sel_hi:[0,1] neg_lo:[0,1] neg_hi:[0,1]
v_pk_fma_f32 v[62:63], v[60:61], s[62:63], v[62:63] op_sel:[1,1,0] op_sel_hi:[1,0,1] neg_lo:[0,0,0] neg_hi:[0,1,0]
v_pk_add_f32 v[60:61], v[40:41], v[48:49] neg_lo:[0,1] neg_hi:[0,1]
v_pk_add_f32 v[40:41], v[40:41], v[48:49]
v_pk_add_f32 v[48:49], v[66:67], v[74:75] neg_lo:[0,1] neg_hi:[0,1]
v_pk_add_f32 v[66:67], v[66:67], v[74:75]
v_pk_mul_f32 v[74:75], v[48:49], s[62:63] op_sel:[0,0] op_sel_hi:[0,1] neg_lo:[0,0] neg_hi:[0,1]
v_pk_fma_f32 v[74:75], v[48:49], s[62:63], v[74:75] op_sel:[1,1,0] op_sel_hi:[1,0,1] neg_lo:[0,0,0] neg_hi:[0,0,0]
v_pk_add_f32 v[48:49], v[68:69], v[76:77] op_sel:[1,1] op_sel_hi:[0,0] neg_lo:[0,1] neg_hi:[1,0]
v_pk_add_f32 v[68:69], v[68:69], v[76:77]
v_pk_add_f32 v[76:77], v[70:71], v[78:79] neg_lo:[0,1] neg_hi:[0,1]
v_pk_add_f32 v[70:71], v[70:71], v[78:79]
v_pk_mul_f32 v[78:79], v[76:77], s[62:63] op_sel:[0,0] op_sel_hi:[0,1] neg_lo:[0,1] neg_hi:[0,1]
v_pk_fma_f32 v[78:79], v[76:77], s[62:63], v[78:79] op_sel:[1,1,0] op_sel_hi:[1,0,1] neg_lo:[0,0,0] neg_hi:[0,1,0]
v_pk_add_f32 v[76:77], v[16:17], v[20:21] neg_lo:[0,1] neg_hi:[0,1]
v_pk_add_f32 v[16:17], v[16:17], v[20:21]
v_pk_add_f32 v[20:21], v[18:19], v[22:23] op_sel:[1,1] op_sel_hi:[0,0] neg_lo:[0,1] neg_hi:[1,0]
v_pk_add_f32 v[18:19], v[18:19], v[22:23]
v_pk_add_f32 v[22:23], v[72:73], v[24:25] neg_lo:[0,1] neg_hi:[0,1]
v_pk_add_f32 v[72:73], v[72:73], v[24:25]
v_pk_add_f32 v[24:25], v[26:27], v[30:31] op_sel:[1,1] op_sel_hi:[0,0] neg_lo:[0,1] neg_hi:[1,0]
v_pk_add_f32 v[26:27], v[26:27], v[30:31]
v_pk_add_f32 v[30:31], v[64:65], v[36:37] neg_lo:[0,1] neg_hi:[0,1]
v_pk_add_f32 v[64:65], v[64:65], v[36:37]
v_pk_add_f32 v[36:37], v[34:35], v[38:39] op_sel:[1,1] op_sel_hi:[0,0] neg_lo:[0,1] neg_hi:[1,0]
v_pk_add_f32 v[34:35], v[34:35], v[38:39]
v_pk_add_f32 v[38:39], v[28:29], v[32:33] neg_lo:[0,1] neg_hi:[0,1]
v_pk_add_f32 v[28:29], v[28:29], v[32:33]
v_pk_add_f32 v[32:33], v[42:43], v[46:47] op_sel:[1,1] op_sel_hi:[0,0] neg_lo:[0,1] neg_hi:[1,0]
v_pk_add_f32 v[42:43], v[42:43], v[46:47]
v_pk_add_f32 v[46:47], v[14:15], v[52:53] neg_lo:[0,1] neg_hi:[0,1]
v_pk_add_f32 v[14:15], v[14:15], v[52:53]
v_pk_add_f32 v[52:53], v[50:51], v[54:55] op_sel:[1,1] op_sel_hi:[0,0] neg_lo:[0,1] neg_hi:[1,0]
v_pk_add_f32 v[50:51], v[50:51], v[54:55]
v_pk_add_f32 v[54:55], v[44:45], v[56:57] neg_lo:[0,1] neg_hi:[0,1]
v_pk_add_f32 v[44:45], v[44:45], v[56:57]
v_pk_add_f32 v[56:57], v[58:59], v[62:63] op_sel:[1,1] op_sel_hi:[0,0] neg_lo:[0,1] neg_hi:[1,0]
v_pk_add_f32 v[58:59], v[58:59], v[62:63]
v_pk_add_f32 v[62:63], v[40:41], v[68:69] neg_lo:[0,1] neg_hi:[0,1]
v_pk_add_f32 v[40:41], v[40:41], v[68:69]
v_pk_add_f32 v[68:69], v[66:67], v[70:71] op_sel:[1,1] op_sel_hi:[0,0] neg_lo:[0,1] neg_hi:[1,0]
v_pk_add_f32 v[66:67], v[66:67], v[70:71]
v_pk_add_f32 v[70:71], v[60:61], v[48:49] neg_lo:[0,1] neg_hi:[0,1]
v_pk_add_f32 v[60:61], v[60:61], v[48:49]
v_pk_add_f32 v[48:49], v[74:75], v[78:79] op_sel:[1,1] op_sel_hi:[0,0] neg_lo:[0,1] neg_hi:[1,0]
v_pk_add_f32 v[74:75], v[74:75], v[78:79]
v_pk_add_f32 v[78:79], v[16:17], v[18:19] neg_lo:[0,1] neg_hi:[0,1]
v_pk_add_f32 v[16:17], v[16:17], v[18:19]
v_pk_add_f32 v[18:19], v[76:77], v[20:21] neg_lo:[0,1] neg_hi:[0,1]
v_pk_add_f32 v[76:77], v[76:77], v[20:21]
v_pk_add_f32 v[20:21], v[72:73], v[26:27] neg_lo:[0,1] neg_hi:[0,1]
v_pk_add_f32 v[72:73], v[72:73], v[26:27]
v_pk_add_f32 v[26:27], v[22:23], v[24:25] neg_lo:[0,1] neg_hi:[0,1]
v_pk_add_f32 v[22:23], v[22:23], v[24:25]
v_pk_add_f32 v[24:25], v[64:65], v[34:35] neg_lo:[0,1] neg_hi:[0,1]
v_pk_add_f32 v[64:65], v[64:65], v[34:35]
v_pk_add_f32 v[34:35], v[30:31], v[36:37] neg_lo:[0,1] neg_hi:[0,1]
v_pk_add_f32 v[30:31], v[30:31], v[36:37]
v_pk_add_f32 v[36:37], v[28:29], v[42:43] neg_lo:[0,1] neg_hi:[0,1]
v_pk_add_f32 v[28:29], v[28:29], v[42:43]
v_pk_add_f32 v[42:43], v[38:39], v[32:33] neg_lo:[0,1] neg_hi:[0,1]
v_pk_add_f32 v[38:39], v[38:39], v[32:33]
v_pk_add_f32 v[32:33], v[14:15], v[50:51] neg_lo:[0,1] neg_hi:[0,1]
v_pk_add_f32 v[14:15], v[14:15], v[50:51]
v_pk_add_f32 v[50:51], v[46:47], v[52:53] neg_lo:[0,1] neg_hi:[0,1]
v_pk_add_f32 v[46:47], v[46:47], v[52:53]
v_pk_add_f32 v[52:53], v[44:45], v[58:59] neg_lo:[0,1] neg_hi:[0,1]
v_pk_add_f32 v[44:45], v[44:45], v[58:59]
v_pk_add_f32 v[58:59], v[54:55], v[56:57] neg_lo:[0,1] neg_hi:[0,1]
v_pk_add_f32 v[54:55], v[54:55], v[56:57]
v_pk_add_f32 v[56:57], v[40:41], v[66:67] neg_lo:[0,1] neg_hi:[0,1]
v_pk_add_f32 v[40:41], v[40:41], v[66:67]
v_pk_add_f32 v[66:67], v[62:63], v[68:69] neg_lo:[0,1] neg_hi:[0,1]
v_pk_add_f32 v[62:63], v[62:63], v[68:69]
v_pk_add_f32 v[68:69], v[60:61], v[74:75] neg_lo:[0,1] neg_hi:[0,1]
v_pk_add_f32 v[60:61], v[60:61], v[74:75]
v_pk_add_f32 v[74:75], v[70:71], v[48:49] neg_lo:[0,1] neg_hi:[0,1]
v_pk_add_f32 v[70:71], v[70:71], v[48:49]
v_pk_mul_f32 v[48:49], v[14:15], v[82:83] op_sel:[0,0] op_sel_hi:[0,1] neg_lo:[0,0] neg_hi:[0,0]
v_pk_fma_f32 v[14:15], v[14:15], v[82:83], v[48:49] op_sel:[1,1,0] op_sel_hi:[1,0,1] neg_lo:[0,1,0] neg_hi:[0,0,0]
v_pk_mul_f32 v[48:49], v[64:65], v[84:85] op_sel:[0,0] op_sel_hi:[0,1] neg_lo:[0,0] neg_hi:[0,0]
v_pk_fma_f32 v[64:65], v[64:65], v[84:85], v[48:49] op_sel:[1,1,0] op_sel_hi:[1,0,1] neg_lo:[0,1,0] neg_hi:[0,0,0]
v_pk_mul_f32 v[48:49], v[40:41], v[86:87] op_sel:[0,0] op_sel_hi:[0,1] neg_lo:[0,0] neg_hi:[0,0]
v_pk_fma_f32 v[40:41], v[40:41], v[86:87], v[48:49] op_sel:[1,1,0] op_sel_hi:[1,0,1] neg_lo:[0,1,0] neg_hi:[0,0,0]
v_pk_mul_f32 v[48:49], v[72:73], v[88:89] op_sel:[0,0] op_sel_hi:[0,1] neg_lo:[0,0] neg_hi:[0,0]
v_pk_fma_f32 v[72:73], v[72:73], v[88:89], v[48:49] op_sel:[1,1,0] op_sel_hi:[1,0,1] neg_lo:[0,1,0] neg_hi:[0,0,0]
v_pk_mul_f32 v[48:49], v[44:45], v[90:91] op_sel:[0,0] op_sel_hi:[0,1] neg_lo:[0,0] neg_hi:[0,0]
v_pk_fma_f32 v[44:45], v[44:45], v[90:91], v[48:49] op_sel:[1,1,0] op_sel_hi:[1,0,1] neg_lo:[0,1,0] neg_hi:[0,0,0]
v_pk_mul_f32 v[48:49], v[28:29], v[92:93] op_sel:[0,0] op_sel_hi:[0,1] neg_lo:[0,0] neg_hi:[0,0]
v_pk_fma_f32 v[28:29], v[28:29], v[92:93], v[48:49] op_sel:[1,1,0] op_sel_hi:[1,0,1] neg_lo:[0,1,0] neg_hi:[0,0,0]
v_pk_mul_f32 v[48:49], v[60:61], v[94:95] op_sel:[0,0] op_sel_hi:[0,1] neg_lo:[0,0] neg_hi:[0,0]
v_pk_fma_f32 v[60:61], v[60:61], v[94:95], v[48:49] op_sel:[1,1,0] op_sel_hi:[1,0,1] neg_lo:[0,1,0] neg_hi:[0,0,0]
v_pk_mul_f32 v[48:49], v[76:77], v[96:97] op_sel:[0,0] op_sel_hi:[0,1] neg_lo:[0,0] neg_hi:[0,0]
v_pk_fma_f32 v[76:77], v[76:77], v[96:97], v[48:49] op_sel:[1,1,0] op_sel_hi:[1,0,1] neg_lo:[0,1,0] neg_hi:[0,0,0]
v_pk_mul_f32 v[48:49], v[46:47], v[98:99] op_sel:[0,0] op_sel_hi:[0,1] neg_lo:[0,0] neg_hi:[0,0]
v_pk_fma_f32 v[46:47], v[46:47], v[98:99], v[48:49] op_sel:[1,1,0] op_sel_hi:[1,0,1] neg_lo:[0,1,0] neg_hi:[0,0,0]
v_pk_mul_f32 v[48:49], v[30:31], v[100:101] op_sel:[0,0] op_sel_hi:[0,1] neg_lo:[0,0] neg_hi:[0,0]
v_pk_fma_f32 v[30:31], v[30:31], v[100:101], v[48:49] op_sel:[1,1,0] op_sel_hi:[1,0,1] neg_lo:[0,1,0] neg_hi:[0,0,0]
v_pk_mul_f32 v[48:49], v[62:63], v[102:103] op_sel:[0,0] op_sel_hi:[0,1] neg_lo:[0,0] neg_hi:[0,0]
v_pk_fma_f32 v[62:63], v[62:63], v[102:103], v[48:49] op_sel:[1,1,0] op_sel_hi:[1,0,1] neg_lo:[0,1,0] neg_hi:[0,0,0]
v_pk_mul_f32 v[48:49], v[22:23], v[104:105] op_sel:[0,0] op_sel_hi:[0,1] neg_lo:[0,0] neg_hi:[0,0]
v_pk_fma_f32 v[22:23], v[22:23], v[104:105], v[48:49] op_sel:[1,1,0] op_sel_hi:[1,0,1] neg_lo:[0,1,0] neg_hi:[0,0,0]
v_pk_mul_f32 v[48:49], v[54:55], v[106:107] op_sel:[0,0] op_sel_hi:[0,1] neg_lo:[0,0] neg_hi:[0,0]
v_pk_fma_f32 v[54:55], v[54:55], v[106:107], v[48:49] op_sel:[1,1,0] op_sel_hi:[1,0,1] neg_lo:[0,1,0] neg_hi:[0,0,0]
v_pk_mul_f32 v[48:49], v[38:39], v[108:109] op_sel:[0,0] op_sel_hi:[0,1] neg_lo:[0,0] neg_hi:[0,0]
v_pk_fma_f32 v[38:39], v[38:39], v[108:109], v[48:49] op_sel:[1,1,0] op_sel_hi:[1,0,1] neg_lo:[0,1,0] neg_hi:[0,0,0]
v_pk_mul_f32 v[48:49], v[70:71], v[110:111] op_sel:[0,0] op_sel_hi:[0,1] neg_lo:[0,0] neg_hi:[0,0]
v_pk_fma_f32 v[70:71], v[70:71], v[110:111], v[48:49] op_sel:[1,1,0] op_sel_hi:[1,0,1] neg_lo:[0,1,0] neg_hi:[0,0,0]
v_pk_mul_f32 v[48:49], v[78:79], v[112:113] op_sel:[0,0] op_sel_hi:[0,1] neg_lo:[0,0] neg_hi:[0,0]
v_pk_fma_f32 v[78:79], v[78:79], v[112:113], v[48:49] op_sel:[1,1,0] op_sel_hi:[1,0,1] neg_lo:[0,1,0] neg_hi:[0,0,0]
v_pk_mul_f32 v[48:49], v[32:33], v[114:115] op_sel:[0,0] op_sel_hi:[0,1] neg_lo:[0,0] neg_hi:[0,0]
v_pk_fma_f32 v[32:33], v[32:33], v[114:115], v[48:49] op_sel:[1,1,0] op_sel_hi:[1,0,1] neg_lo:[0,1,0] neg_hi:[0,0,0]
v_pk_mul_f32 v[48:49], v[24:25], v[116:117] op_sel:[0,0] op_sel_hi:[0,1] neg_lo:[0,0] neg_hi:[0,0]
v_pk_fma_f32 v[24:25], v[24:25], v[116:117], v[48:49] op_sel:[1,1,0] op_sel_hi:[1,0,1] neg_lo:[0,1,0] neg_hi:[0,0,0]
v_pk_mul_f32 v[48:49], v[56:57], v[118:119] op_sel:[0,0] op_sel_hi:[0,1] neg_lo:[0,0] neg_hi:[0,0]
v_pk_fma_f32 v[56:57], v[56:57], v[118:119], v[48:49] op_sel:[1,1,0] op_sel_hi:[1,0,1] neg_lo:[0,1,0] neg_hi:[0,0,0]
v_pk_mul_f32 v[48:49], v[20:21], v[120:121] op_sel:[0,0] op_sel_hi:[0,1] neg_lo:[0,0] neg_hi:[0,0]
v_pk_fma_f32 v[20:21], v[20:21], v[120:121], v[48:49] op_sel:[1,1,0] op_sel_hi:[1,0,1] neg_lo:[0,1,0] neg_hi:[0,0,0]
v_pk_mul_f32 v[48:49], v[52:53], v[122:123] op_sel:[0,0] op_sel_hi:[0,1] neg_lo:[0,0] neg_hi:[0,0]
v_pk_fma_f32 v[52:53], v[52:53], v[122:123], v[48:49] op_sel:[1,1,0] op_sel_hi:[1,0,1] neg_lo:[0,1,0] neg_hi:[0,0,0]
v_pk_mul_f32 v[48:49], v[36:37], v[124:125] op_sel:[0,0] op_sel_hi:[0,1] neg_lo:[0,0] neg_hi:[0,0]
v_pk_fma_f32 v[36:37], v[36:37], v[124:125], v[48:49] op_sel:[1,1,0] op_sel_hi:[1,0,1] neg_lo:[0,1,0] neg_hi:[0,0,0]
v_pk_mul_f32 v[48:49], v[68:69], v[126:127] op_sel:[0,0] op_sel_hi:[0,1] neg_lo:[0,0] neg_hi:[0,0]
v_pk_fma_f32 v[68:69], v[68:69], v[126:127], v[48:49] op_sel:[1,1,0] op_sel_hi:[1,0,1] neg_lo:[0,1,0] neg_hi:[0,0,0]
v_pk_mul_f32 v[48:49], v[18:19], v[128:129] op_sel:[0,0] op_sel_hi:[0,1] neg_lo:[0,0] neg_hi:[0,0]
v_pk_fma_f32 v[18:19], v[18:19], v[128:129], v[48:49] op_sel:[1,1,0] op_sel_hi:[1,0,1] neg_lo:[0,1,0] neg_hi:[0,0,0]
v_pk_mul_f32 v[48:49], v[50:51], v[130:131] op_sel:[0,0] op_sel_hi:[0,1] neg_lo:[0,0] neg_hi:[0,0]
v_pk_fma_f32 v[50:51], v[50:51], v[130:131], v[48:49] op_sel:[1,1,0] op_sel_hi:[1,0,1] neg_lo:[0,1,0] neg_hi:[0,0,0]
v_pk_mul_f32 v[48:49], v[34:35], v[132:133] op_sel:[0,0] op_sel_hi:[0,1] neg_lo:[0,0] neg_hi:[0,0]
v_pk_fma_f32 v[34:35], v[34:35], v[132:133], v[48:49] op_sel:[1,1,0] op_sel_hi:[1,0,1] neg_lo:[0,1,0] neg_hi:[0,0,0]
v_pk_mul_f32 v[48:49], v[66:67], v[134:135] op_sel:[0,0] op_sel_hi:[0,1] neg_lo:[0,0] neg_hi:[0,0]
v_pk_fma_f32 v[66:67], v[66:67], v[134:135], v[48:49] op_sel:[1,1,0] op_sel_hi:[1,0,1] neg_lo:[0,1,0] neg_hi:[0,0,0]
v_pk_mul_f32 v[48:49], v[26:27], v[136:137] op_sel:[0,0] op_sel_hi:[0,1] neg_lo:[0,0] neg_hi:[0,0]
v_pk_fma_f32 v[26:27], v[26:27], v[136:137], v[48:49] op_sel:[1,1,0] op_sel_hi:[1,0,1] neg_lo:[0,1,0] neg_hi:[0,0,0]
v_pk_mul_f32 v[48:49], v[58:59], v[138:139] op_sel:[0,0] op_sel_hi:[0,1] neg_lo:[0,0] neg_hi:[0,0]
v_pk_fma_f32 v[58:59], v[58:59], v[138:139], v[48:49] op_sel:[1,1,0] op_sel_hi:[1,0,1] neg_lo:[0,1,0] neg_hi:[0,0,0]
v_pk_mul_f32 v[48:49], v[42:43], v[140:141] op_sel:[0,0] op_sel_hi:[0,1] neg_lo:[0,0] neg_hi:[0,0]
v_pk_fma_f32 v[42:43], v[42:43], v[140:141], v[48:49] op_sel:[1,1,0] op_sel_hi:[1,0,1] neg_lo:[0,1,0] neg_hi:[0,0,0]
v_pk_mul_f32 v[48:49], v[74:75], v[142:143] op_sel:[0,0] op_sel_hi:[0,1] neg_lo:[0,0] neg_hi:[0,0]
v_pk_fma_f32 v[74:75], v[74:75], v[142:143], v[48:49] op_sel:[1,1,0] op_sel_hi:[1,0,1] neg_lo:[0,1,0] neg_hi:[0,0,0]
ds_write_b64 v3, v[16:17] offset:0
ds_write_b64 v3, v[14:15] offset:528
ds_write_b64 v3, v[64:65] offset:1056
ds_write_b64 v3, v[40:41] offset:1584
ds_write_b64 v3, v[72:73] offset:2112
ds_write_b64 v3, v[44:45] offset:2640
ds_write_b64 v3, v[28:29] offset:3168
ds_write_b64 v3, v[60:61] offset:3696
ds_write_b64 v3, v[76:77] offset:4224
ds_write_b64 v3, v[46:47] offset:4752
ds_write_b64 v3, v[30:31] offset:5280
ds_write_b64 v3, v[62:63] offset:5808
ds_write_b64 v3, v[22:23] offset:6336
ds_write_b64 v3, v[54:55] offset:6864
ds_write_b64 v3, v[38:39] offset:7392
ds_write_b64 v3, v[70:71] offset:7920
ds_write_b64 v3, v[78:79] offset:8448
ds_write_b64 v3, v[32:33] offset:8976
ds_write_b64 v3, v[24:25] offset:9504
ds_write_b64 v3, v[56:57] offset:10032
ds_write_b64 v3, v[20:21] offset:10560
ds_write_b64 v3, v[52:53] offset:11088
ds_write_b64 v3, v[36:37] offset:11616
ds_write_b64 v3, v[68:69] offset:12144
ds_write_b64 v3, v[18:19] offset:12672
ds_write_b64 v3, v[50:51] offset:13200
ds_write_b64 v3, v[34:35] offset:13728
ds_write_b64 v3, v[66:67] offset:14256
ds_write_b64 v3, v[26:27] offset:14784
ds_write_b64 v3, v[58:59] offset:15312
ds_write_b64 v3, v[42:43] offset:15840
ds_write_b64 v3, v[74:75] offset:16368
s_waitcnt lgkmcnt(0)
ds_read_b64 v[16:17], v4 offset:0
ds_read_b64 v[48:49], v4 offset:256
ds_read_b64 v[18:19], v4 offset:16
ds_read_b64 v[50:51], v4 offset:272
ds_read_b64 v[20:21], v4 offset:32
ds_read_b64 v[52:53], v4 offset:288
ds_read_b64 v[22:23], v4 offset:48
ds_read_b64 v[54:55], v4 offset:304
ds_read_b64 v[24:25], v4 offset:64
ds_read_b64 v[56:57], v4 offset:320
ds_read_b64 v[26:27], v4 offset:80
ds_read_b64 v[58:59], v4 offset:336
ds_read_b64 v[28:29], v4 offset:96
ds_read_b64 v[60:61], v4 offset:352
ds_read_b64 v[30:31], v4 offset:112
ds_read_b64 v[62:63], v4 offset:368
ds_read_b64 v[32:33], v4 offset:128
ds_read_b64 v[64:65], v4 offset:384
ds_read_b64 v[34:35], v4 offset:144
ds_read_b64 v[66:67], v4 offset:400
ds_read_b64 v[36:37], v4 offset:160
ds_read_b64 v[68:69], v4 offset:416
ds_read_b64 v[38:39], v4 offset:176
ds_read_b64 v[70:71], v4 offset:432
ds_read_b64 v[40:41], v4 offset:192
ds_read_b64 v[72:73], v4 offset:448
ds_read_b64 v[42:43], v4 offset:208
ds_read_b64 v[74:75], v4 offset:464
ds_read_b64 v[44:45], v4 offset:224
ds_read_b64 v[76:77], v4 offset:480
ds_read_b64 v[46:47], v4 offset:240
ds_read_b64 v[78:79], v4 offset:496
s_waitcnt lgkmcnt(0)
v_pk_add_f32 v[14:15], v[16:17], v[48:49] neg_lo:[0,1] neg_hi:[0,1]
v_pk_add_f32 v[16:17], v[16:17], v[48:49]
v_pk_add_f32 v[48:49], v[18:19], v[50:51] neg_lo:[0,1] neg_hi:[0,1]
v_pk_add_f32 v[18:19], v[18:19], v[50:51]
v_pk_mul_f32 v[50:51], v[48:49], s[50:51] op_sel:[0,0] op_sel_hi:[0,1] neg_lo:[0,0] neg_hi:[0,1]
v_pk_fma_f32 v[50:51], v[48:49], s[50:51], v[50:51] op_sel:[1,1,0] op_sel_hi:[1,0,1] neg_lo:[0,0,0] neg_hi:[0,0,0]
v_pk_add_f32 v[48:49], v[20:21], v[52:53] neg_lo:[0,1] neg_hi:[0,1]
v_pk_add_f32 v[20:21], v[20:21], v[52:53]
v_pk_mul_f32 v[52:53], v[48:49], s[54:55] op_sel:[0,0] op_sel_hi:[0,1] neg_lo:[0,0] neg_hi:[0,1]
v_pk_fma_f32 v[52:53], v[48:49], s[54:55], v[52:53] op_sel:[1,1,0] op_sel_hi:[1,0,1] neg_lo:[0,0,0] neg_hi:[0,0,0]
v_pk_add_f32 v[48:49], v[22:23], v[54:55] neg_lo:[0,1] neg_hi:[0,1]
v_pk_add_f32 v[22:23], v[22:23], v[54:55]
v_pk_mul_f32 v[54:55], v[48:49], s[58:59] op_sel:[0,0] op_sel_hi:[0,1] neg_lo:[0,0] neg_hi:[0,1]
v_pk_fma_f32 v[54:55], v[48:49], s[58:59], v[54:55] op_sel:[1,1,0] op_sel_hi:[1,0,1] neg_lo:[0,0,0] neg_hi:[0,0,0]
v_pk_add_f32 v[48:49], v[24:25], v[56:57] neg_lo:[0,1] neg_hi:[0,1]
v_pk_add_f32 v[24:25], v[24:25], v[56:57]
v_pk_mul_f32 v[56:57], v[48:49], s[62:63] op_sel:[0,0] op_sel_hi:[0,1] neg_lo:[0,0] neg_hi:[0,1]
v_pk_fma_f32 v[56:57], v[48:49], s[62:63], v[56:57] op_sel:[1,1,0] op_sel_hi:[1,0,1] neg_lo:[0,0,0] neg_hi:[0,0,0]
v_pk_add_f32 v[48:49], v[26:27], v[58:59] neg_lo:[0,1] neg_hi:[0,1]
v_pk_add_f32 v[26:27], v[26:27], v[58:59]
v_pk_mul_f32 v[58:59], v[48:49], s[58:59] op_sel:[0,1] op_sel_hi:[0,0] neg_lo:[0,0] neg_hi:[0,1]
v_pk_fma_f32 v[58:59], v[48:49], s[58:59], v[58:59] op_sel:[1,0,0] op_sel_hi:[1,1,1] neg_lo:[0,0,0] neg_hi:[0,0,0]
v_pk_add_f32 v[48:49], v[28:29], v[60:61] neg_lo:[0,1] neg_hi:[0,1]
v_pk_add_f32 v[28:29], v[28:29], v[60:61]
v_pk_mul_f32 v[60:61], v[48:49], s[54:55] op_sel:[0,1] op_sel_hi:[0,0] neg_lo:[0,0] neg_hi:[0,1]
v_pk_fma_f32 v[60:61], v[48:49], s[54:55], v[60:61] op_sel:[1,0,0] op_sel_hi:[1,1,1] neg_lo:[0,0,0] neg_hi:[0,0,0]
v_pk_add_f32 v[48:49], v[30:31], v[62:63] neg_lo:[0,1] neg_hi:[0,1]
v_pk_add_f32 v[30:31], v[30:31], v[62:63]
v_pk_mul_f32 v[62:63], v[48:49], s[50:51] op_sel:[0,1] op_sel_hi:[0,0] neg_lo:[0,0] neg_hi:[0,1]
v_pk_fma_f32 v[62:63], v[48:49], s[50:51], v[62:63] op_sel:[1,0,0] op_sel_hi:[1,1,1] neg_lo:[0,0,0] neg_hi:[0,0,0]
v_pk_add_f32 v[48:49], v[32:33], v[64:65] op_sel:[1,1] op_sel_hi:[0,0] neg_lo:[0,1] neg_hi:[1,0]
v_pk_add_f32 v[32:33], v[32:33], v[64:65]
v_pk_add_f32 v[64:65], v[34:35], v[66:67] neg_lo:[0,1] neg_hi:[0,1]
v_pk_add_f32 v[34:35], v[34:35], v[66:67]
v_pk_mul_f32 v[66:67], v[64:65], s[50:51] op_sel:[0,1] op_sel_hi:[0,0] neg_lo:[0,1] neg_hi:[0,1]
v_pk_fma_f32 v[66:67], v[64:65], s[50:51], v[66:67] op_sel:[1,0,0] op_sel_hi:[1,1,1] neg_lo:[0,0,0] neg_hi:[0,1,0]
v_pk_add_f32 v[64:65], v[36:37], v[68:69] neg_lo:[0,1] neg_hi:[0,1]
v_pk_add_f32 v[36:37], v[36:37], v[68:69]
v_pk_mul_f32 v[68:69], v[64:65], s[54:55] op_sel:[0,1] op_sel_hi:[0,0] neg_lo:[0,1] neg_hi:[0,1]
v_pk_fma_f32 v[68:69], v[64:65], s[54:55], v[68:69] op_sel:[1,0,0] op_sel_hi:[1,1,1] neg_lo:[0,0,0] neg_hi:[0,1,0]
v_pk_add_f32 v[64:65], v[38:39], v[70:71] neg_lo:[0,1] neg_hi:[0,1]
v_pk_add_f32 v[38:39], v[38:39], v[70:71]
v_pk_mul_f32 v[70:71], v[64:65], s[58:59] op_sel:[0,1] op_sel_hi:[0,0] neg_lo:[0,1] neg_hi:[0,1]
v_pk_fma_f32 v[70:71], v[64:65], s[58:59], v[70:71] op_sel:[1,0,0] op_sel_hi:[1,1,1] neg_lo:[0,0,0] neg_hi:[0,1,0]
v_pk_add_f32 v[64:65], v[40:41], v[72:73] neg_lo:[0,1] neg_hi:[0,1]
v_pk_add_f32 v[40:41], v[40:41], v[72:73]
v_pk_mul_f32 v[72:73], v[64:65], s[62:63] op_sel:[0,0] op_sel_hi:[0,1] neg_lo:[0,1] neg_hi:[0,1]
v_pk_fma_f32 v[72:73], v[64:65], s[62:63], v[72:73] op_sel:[1,1,0] op_sel_hi:[1,0,1] neg_lo:[0,0,0] neg_hi:[0,1,0]
v_pk_add_f32 v[64:65], v[42:43], v[74:75] neg_lo:[0,1] neg_hi:[0,1]
v_pk_add_f32 v[42:43], v[42:43], v[74:75]
v_pk_mul_f32 v[74:75], v[64:65], s[58:59] op_sel:[0,0] op_sel_hi:[0,1] neg_lo:[0,1] neg_hi:[0,1]
v_pk_fma_f32 v[74:75], v[64:65], s[58:59], v[74:75] op_sel:[1,1,0] op_sel_hi:[1,0,1] neg_lo:[0,0,0] neg_hi:[0,1,0]
v_pk_add_f32 v[64:65], v[44:45], v[76:77] neg_lo:[0,1] neg_hi:[0,1]
v_pk_add_f32 v[44:45], v[44:45], v[76:77]
v_pk_mul_f32 v[76:77], v[64:65], s[54:55] op_sel:[0,0] op_sel_hi:[0,1] neg_lo:[0,1] neg_hi:[0,1]
v_pk_fma_f32 v[76:77], v[64:65], s[54:55], v[76:77] op_sel:[1,1,0] op_sel_hi:[1,0,1] neg_lo:[0,0,0] neg_hi:[0,1,0]
v_pk_add_f32 v[64:65], v[46:47], v[78:79] neg_lo:[0,1] neg_hi:[0,1]
v_pk_add_f32 v[46:47], v[46:47], v[78:79]
v_pk_mul_f32 v[78:79], v[64:65], s[50:51] op_sel:[0,0] op_sel_hi:[0,1] neg_lo:[0,1] neg_hi:[0,1]
v_pk_fma_f32 v[78:79], v[64:65], s[50:51], v[78:79] op_sel:[1,1,0] op_sel_hi:[1,0,1] neg_lo:[0,0,0] neg_hi:[0,1,0]
v_pk_add_f32 v[64:65], v[16:17], v[32:33] neg_lo:[0,1] neg_hi:[0,1]
v_pk_add_f32 v[16:17], v[16:17], v[32:33]
v_pk_add_f32 v[32:33], v[18:19], v[34:35] neg_lo:[0,1] neg_hi:[0,1]
v_pk_add_f32 v[18:19], v[18:19], v[34:35]
v_pk_mul_f32 v[34:35], v[32:33], s[54:55] op_sel:[0,0] op_sel_hi:[0,1] neg_lo:[0,0] neg_hi:[0,1]
v_pk_fma_f32 v[34:35], v[32:33], s[54:55], v[34:35] op_sel:[1,1,0] op_sel_hi:[1,0,1] neg_lo:[0,0,0] neg_hi:[0,0,0]
v_pk_add_f32 v[32:33], v[20:21], v[36:37] neg_lo:[0,1] neg_hi:[0,1]
v_pk_add_f32 v[20:21], v[20:21], v[36:37]
v_pk_mul_f32 v[36:37], v[32:33], s[62:63] op_sel:[0,0] op_sel_hi:[0,1] neg_lo:[0,0] neg_hi:[0,1]
v_pk_fma_f32 v[36:37], v[32:33], s[62:63], v[36:37] op_sel:[1,1,0] op_sel_hi:[1,0,1] neg_lo:[0,0,0] neg_hi:[0,0,0]
v_pk_add_f32 v[32:33], v[22:23], v[38:39] neg_lo:[0,1] neg_hi:[0,1]
v_pk_add_f32 v[22:23], v[22:23], v[38:39]
v_pk_mul_f32 v[38:39], v[32:33], s[54:55] op_sel:[0,1] op_sel_hi:[0,0] neg_lo:[0,0] neg_hi:[0,1]
v_pk_fma_f32 v[38:39], v[32:33], s[54:55], v[38:39] op_sel:[1,0,0] op_sel_hi:[1,1,1] neg_lo:[0,0,0] neg_hi:[0,0,0]
v_pk_add_f32 v[32:33], v[24:25], v[40:41] op_sel:[1,1] op_sel_hi:[0,0] neg_lo:[0,1] neg_hi:[1,0]
v_pk_add_f32 v[24:25], v[24:25], v[40:41]
v_pk_add_f32 v[40:41], v[26:27], v[42:43] neg_lo:[0,1] neg_hi:[0,1]
v_pk_add_f32 v[26:27], v[26:27], v[42:43]
v_pk_mul_f32 v[42:43], v[40:41], s[54:55] op_sel:[0,1] op_sel_hi:[0,0] neg_lo:[0,1] neg_hi:[0,1]
v_pk_fma_f32 v[42:43], v[40:41], s[54:55], v[42:43] op_sel:[1,0,0] op_sel_hi:[1,1,1] neg_lo:[0,0,0] neg_hi:[0,1,0]
v_pk_add_f32 v[40:41], v[28:29], v[44:45] neg_lo:[0,1] neg_hi:[0,1]
v_pk_add_f32 v[28:29], v[28:29], v[44:45]
v_pk_mul_f32 v[44:45], v[40:41], s[62:63] op_sel:[0,0] op_sel_hi:[0,1] neg_lo:[0,1] neg_hi:[0,1]
v_pk_fma_f32 v[44:45], v[40:41], s[62:63], v[44:45] op_sel:[1,1,0] op_sel_hi:[1,0,1] neg_lo:[0,0,0] neg_hi:[0,1,0]
v_pk_add_f32 v[40:41], v[30:31], v[46:47] neg_lo:[0,1] neg_hi:[0,1]
v_pk_add_f32 v[30:31], v[30:31], v[46:47]
v_pk_mul_f32 v[46:47], v[40:41], s[54:55] op_sel:[0,0] op_sel_hi:[0,1] neg_lo:[0,1] neg_hi:[0,1]
v_pk_fma_f32 v[46:47], v[40:41], s[54:55], v[46:47] op_sel:[1,1,0] op_sel_hi:[1,0,1] neg_lo:[0,0,0] neg_hi:[0,1,0]
v_pk_add_f32 v[40:41], v[14:15], v[48:49] neg_lo:[0,1] neg_hi:[0,1]
v_pk_add_f32 v[14:15], v[14:15], v[48:49]
v_pk_add_f32 v[48:49], v[50:51], v[66:67] neg_lo:[0,1] neg_hi:[0,1]
v_pk_add_f32 v[50:51], v[50:51], v[66:67]
v_pk_mul_f32 v[66:67], v[48:49], s[54:55] op_sel:[0,0] op_sel_hi:[0,1] neg_lo:[0,0] neg_hi:[0,1]
v_pk_fma_f32 v[66:67], v[48:49], s[54:55], v[66:67] op_sel:[1,1,0] op_sel_hi:[1,0,1] neg_lo:[0,0,0] neg_hi:[0,0,0]
v_pk_add_f32 v[48:49], v[52:53], v[68:69] neg_lo:[0,1] neg_hi:[0,1]
v_pk_add_f32 v[52:53], v[52:53], v[68:69]
v_pk_mul_f32 v[68:69], v[48:49], s[62:63] op_sel:[0,0] op_sel_hi:[0,1] neg_lo:[0,0] neg_hi:[0,1]
v_pk_fma_f32 v[68:69], v[48:49], s[62:63], v[68:69] op_sel:[1,1,0] op_sel_hi:[1,0,1] neg_lo:[0,0,0] neg_hi:[0,0,0]
v_pk_add_f32 v[48:49], v[54:55], v[70:71] neg_lo:[0,1] neg_hi:[0,1]
v_pk_add_f32 v[54:55], v[54:55], v[70:71]
v_pk_mul_f32 v[70:71], v[48:49], s[54:55] op_sel:[0,1] op_sel_hi:[0,0] neg_lo:[0,0] neg_hi:[0,1]
v_pk_fma_f32 v[70:71], v[48:49], s[54:55], v[70:71] op_sel:[1,0,0] op_sel_hi:[1,1,1] neg_lo:[0,0,0] neg_hi:[0,0,0]
v_pk_add_f32 v[48:49], v[56:57], v[72:73] op_sel:[1,1] op_sel_hi:[0,0] neg_lo:[0,1] neg_hi:[1,0]
v_pk_add_f32 v[56:57], v[56:57], v[72:73]
v_pk_add_f32 v[72:73], v[58:59], v[74:75] neg_lo:[0,1] neg_hi:[0,1]
v_pk_add_f32 v[58:59], v[58:59], v[74:75]
v_pk_mul_f32 v[74:75], v[72:73], s[54:55] op_sel:[0,1] op_sel_hi:[0,0] neg_lo:[0,1] neg_hi:[0,1]
v_pk_fma_f32 v[74:75], v[72:73], s[54:55], v[74:75] op_sel:[1,0,0] op_sel_hi:[1,1,1] neg_lo:[0,0,0] neg_hi:[0,1,0]
v_pk_add_f32 v[72:73], v[60:61], v[76:77] neg_lo:[0,1] neg_hi:[0,1]
v_pk_add_f32 v[60:61], v[60:61], v[76:77]
v_pk_mul_f32 v[76:77], v[72:73], s[62:63] op_sel:[0,0] op_sel_hi:[0,1] neg_lo:[0,1] neg_hi:[0,1]
v_pk_fma_f32 v[76:77], v[72:73], s[62:63], v[76:77] op_sel:[1,1,0] op_sel_hi:[1,0,1] neg_lo:[0,0,0] neg_hi:[0,1,0]
v_pk_add_f32 v[72:73], v[62:63], v[78:79] neg_lo:[0,1] neg_hi:[0,1]
v_pk_add_f32 v[62:63], v[62:63], v[78:79]
v_pk_mul_f32 v[78:79], v[72:73], s[54:55] op_sel:[0,0] op_sel_hi:[0,1] neg_lo:[0,1] neg_hi:[0,1]
v_pk_fma_f32 v[78:79], v[72:73], s[54:55], v[78:79] op_sel:[1,1,0] op_sel_hi:[1,0,1] neg_lo:[0,0,0] neg_hi:[0,1,0]
v_pk_add_f32 v[72:73], v[16:17], v[24:25] neg_lo:[0,1] neg_hi:[0,1]
v_pk_add_f32 v[16:17], v[16:17], v[24:25]
v_pk_add_f32 v[24:25], v[18:19], v[26:27] neg_lo:[0,1] neg_hi:[0,1]
v_pk_add_f32 v[18:19], v[18:19], v[26:27]
v_pk_mul_f32 v[26:27], v[24:25], s[62:63] op_sel:[0,0] op_sel_hi:[0,1] neg_lo:[0,0] neg_hi:[0,1]
v_pk_fma_f32 v[26:27], v[24:25], s[62:63], v[26:27] op_sel:[1,1,0] op_sel_hi:[1,0,1] neg_lo:[0,0,0] neg_hi:[0,0,0]
v_pk_add_f32 v[24:25], v[20:21], v[28:29] op_sel:[1,1] op_sel_hi:[0,0] neg_lo:[0,1] neg_hi:[1,0]
v_pk_add_f32 v[20:21], v[20:21], v[28:29]
v_pk_add_f32 v[28:29], v[22:23], v[30:31] neg_lo:[0,1] neg_hi:[0,1]
v_pk_add_f32 v[22:23], v[22:23], v[30:31]
v_pk_mul_f32 v[30:31], v[28:29], s[62:63] op_sel:[0,0] op_sel_hi:[0,1] neg_lo:[0,1] neg_hi:[0,1]
v_pk_fma_f32 v[30:31], v[28:29], s[62:63], v[30:31] op_sel:[1,1,0] op_sel_hi:[1,0,1] neg_lo:[0,0,0] neg_hi:[0,1,0]
v_pk_add_f32 v[28:29], v[64:65], v[32:33] neg_lo:[0,1] neg_hi:[0,1]
v_pk_add_f32 v[64:65], v[64:65], v[32:33]
v_pk_add_f32 v[32:33], v[34:35], v[42:43] neg_lo:[0,1] neg_hi:[0,1]
v_pk_add_f32 v[34:35], v[34:35], v[42:43]
v_pk_mul_f32 v[42:43], v[32:33], s[62:63] op_sel:[0,0] op_sel_hi:[0,1] neg_lo:[0,0] neg_hi:[0,1]
v_pk_fma_f32 v[42:43], v[32:33], s[62:63], v[42:43] op_sel:[1,1,0] op_sel_hi:[1,0,1] neg_lo:[0,0,0] neg_hi:[0,0,0]
v_pk_add_f32 v[32:33], v[36:37], v[44:45] op_sel:[1,1] op_sel_hi:[0,0] neg_lo:[0,1] neg_hi:[1,0]
v_pk_add_f32 v[36:37], v[36:37], v[44:45]
v_pk_add_f32 v[44:45], v[38:39], v[46:47] neg_lo:[0,1] neg_hi:[0,1]
v_pk_add_f32 v[38:39], v[38:39], v[46:47]
v_pk_mul_f32 v[46:47], v[44:45], s[62:63] op_sel:[0,0] op_sel_hi:[0,1] neg_lo:[0,1] neg_hi:[0,1]
v_pk_fma_f32 v[46:47], v[44:45], s[62:63], v[46:47] op_sel:[1,1,0] op_sel_hi:[1,0,1] neg_lo:[0,0,0] neg_hi:[0,1,0]
v_pk_add_f32 v[44:45], v[14:15], v[56:57] neg_lo:[0,1] neg_hi:[0,1]
v_pk_add_f32 v[14:15], v[14:15], v[56:57]
v_pk_add_f32 v[56:57], v[50:51], v[58:59] neg_lo:[0,1] neg_hi:[0,1]
v_pk_add_f32 v[50:51], v[50:51], v[58:59]
v_pk_mul_f32 v[58:59], v[56:57], s[62:63] op_sel:[0,0] op_sel_hi:[0,1] neg_lo:[0,0] neg_hi:[0,1]
v_pk_fma_f32 v[58:59], v[56:57], s[62:63], v[58:59] op_sel:[1,1,0] op_sel_hi:[1,0,1] neg_lo:[0,0,0] neg_hi:[0,0,0]
v_pk_add_f32 v[56:57], v[52:53], v[60:61] op_sel:[1,1] op_sel_hi:[0,0] neg_lo:[0,1] neg_hi:[1,0]
v_pk_add_f32 v[52:53], v[52:53], v[60:61]
v_pk_add_f32 v[60:61], v[54:55], v[62:63] neg_lo:[0,1] neg_hi:[0,1]
v_pk_add_f32 v[54:55], v[54:55], v[62:63]
v_pk_mul_f32 v[62:63], v[60:61], s[62:63] op_sel:[0,0] op_sel_hi:[0,1] neg_lo:[0,1] neg_hi:[0,1]
v_pk_fma_f32 v[62:63], v[60:61], s[62:63], v[62:63] op_sel:[1,1,0] op_sel_hi:[1,0,1] neg_lo:[0,0,0] neg_hi:[0,1,0]
v_pk_add_f32 v[60:61], v[40:41], v[48:49] neg_lo:[0,1] neg_hi:[0,1]
v_pk_add_f32 v[40:41], v[40:41], v[48:49]
v_pk_add_f32 v[48:49], v[66:67], v[74:75] neg_lo:[0,1] neg_hi:[0,1]
v_pk_add_f32 v[66:67], v[66:67], v[74:75]
v_pk_mul_f32 v[74:75], v[48:49], s[62:63] op_sel:[0,0] op_sel_hi:[0,1] neg_lo:[0,0] neg_hi:[0,1]
v_pk_fma_f32 v[74:75], v[48:49], s[62:63], v[74:75] op_sel:[1,1,0] op_sel_hi:[1,0,1] neg_lo:[0,0,0] neg_hi:[0,0,0]
v_pk_add_f32 v[48:49], v[68:69], v[76:77] op_sel:[1,1] op_sel_hi:[0,0] neg_lo:[0,1] neg_hi:[1,0]
v_pk_add_f32 v[68:69], v[68:69], v[76:77]
v_pk_add_f32 v[76:77], v[70:71], v[78:79] neg_lo:[0,1] neg_hi:[0,1]
v_pk_add_f32 v[70:71], v[70:71], v[78:79]
v_pk_mul_f32 v[78:79], v[76:77], s[62:63] op_sel:[0,0] op_sel_hi:[0,1] neg_lo:[0,1] neg_hi:[0,1]
v_pk_fma_f32 v[78:79], v[76:77], s[62:63], v[78:79] op_sel:[1,1,0] op_sel_hi:[1,0,1] neg_lo:[0,0,0] neg_hi:[0,1,0]
v_pk_add_f32 v[76:77], v[16:17], v[20:21] neg_lo:[0,1] neg_hi:[0,1]
v_pk_add_f32 v[16:17], v[16:17], v[20:21]
v_pk_add_f32 v[20:21], v[18:19], v[22:23] op_sel:[1,1] op_sel_hi:[0,0] neg_lo:[0,1] neg_hi:[1,0]
v_pk_add_f32 v[18:19], v[18:19], v[22:23]
v_pk_add_f32 v[22:23], v[72:73], v[24:25] neg_lo:[0,1] neg_hi:[0,1]
v_pk_add_f32 v[72:73], v[72:73], v[24:25]
v_pk_add_f32 v[24:25], v[26:27], v[30:31] op_sel:[1,1] op_sel_hi:[0,0] neg_lo:[0,1] neg_hi:[1,0]
v_pk_add_f32 v[26:27], v[26:27], v[30:31]
v_pk_add_f32 v[30:31], v[64:65], v[36:37] neg_lo:[0,1] neg_hi:[0,1]
v_pk_add_f32 v[64:65], v[64:65], v[36:37]
v_pk_add_f32 v[36:37], v[34:35], v[38:39] op_sel:[1,1] op_sel_hi:[0,0] neg_lo:[0,1] neg_hi:[1,0]
v_pk_add_f32 v[34:35], v[34:35], v[38:39]
v_pk_add_f32 v[38:39], v[28:29], v[32:33] neg_lo:[0,1] neg_hi:[0,1]
v_pk_add_f32 v[28:29], v[28:29], v[32:33]
v_pk_add_f32 v[32:33], v[42:43], v[46:47] op_sel:[1,1] op_sel_hi:[0,0] neg_lo:[0,1] neg_hi:[1,0]
v_pk_add_f32 v[42:43], v[42:43], v[46:47]
v_pk_add_f32 v[46:47], v[14:15], v[52:53] neg_lo:[0,1] neg_hi:[0,1]
v_pk_add_f32 v[14:15], v[14:15], v[52:53]
v_pk_add_f32 v[52:53], v[50:51], v[54:55] op_sel:[1,1] op_sel_hi:[0,0] neg_lo:[0,1] neg_hi:[1,0]
v_pk_add_f32 v[50:51], v[50:51], v[54:55]
v_pk_add_f32 v[54:55], v[44:45], v[56:57] neg_lo:[0,1] neg_hi:[0,1]
v_pk_add_f32 v[44:45], v[44:45], v[56:57]
v_pk_add_f32 v[56:57], v[58:59], v[62:63] op_sel:[1,1] op_sel_hi:[0,0] neg_lo:[0,1] neg_hi:[1,0]
v_pk_add_f32 v[58:59], v[58:59], v[62:63]
v_pk_add_f32 v[62:63], v[40:41], v[68:69] neg_lo:[0,1] neg_hi:[0,1]
v_pk_add_f32 v[40:41], v[40:41], v[68:69]
v_pk_add_f32 v[68:69], v[66:67], v[70:71] op_sel:[1,1] op_sel_hi:[0,0] neg_lo:[0,1] neg_hi:[1,0]
v_pk_add_f32 v[66:67], v[66:67], v[70:71]
v_pk_add_f32 v[70:71], v[60:61], v[48:49] neg_lo:[0,1] neg_hi:[0,1]
v_pk_add_f32 v[60:61], v[60:61], v[48:49]
v_pk_add_f32 v[48:49], v[74:75], v[78:79] op_sel:[1,1] op_sel_hi:[0,0] neg_lo:[0,1] neg_hi:[1,0]
v_pk_add_f32 v[74:75], v[74:75], v[78:79]
v_pk_add_f32 v[78:79], v[16:17], v[18:19] neg_lo:[0,1] neg_hi:[0,1]
v_pk_add_f32 v[16:17], v[16:17], v[18:19]
v_pk_add_f32 v[18:19], v[76:77], v[20:21] neg_lo:[0,1] neg_hi:[0,1]
v_pk_add_f32 v[76:77], v[76:77], v[20:21]
v_pk_add_f32 v[20:21], v[72:73], v[26:27] neg_lo:[0,1] neg_hi:[0,1]
v_pk_add_f32 v[72:73], v[72:73], v[26:27]
v_pk_add_f32 v[26:27], v[22:23], v[24:25] neg_lo:[0,1] neg_hi:[0,1]
v_pk_add_f32 v[22:23], v[22:23], v[24:25]
v_pk_add_f32 v[24:25], v[64:65], v[34:35] neg_lo:[0,1] neg_hi:[0,1]
v_pk_add_f32 v[64:65], v[64:65], v[34:35]
v_pk_add_f32 v[34:35], v[30:31], v[36:37] neg_lo:[0,1] neg_hi:[0,1]
v_pk_add_f32 v[30:31], v[30:31], v[36:37]
v_pk_add_f32 v[36:37], v[28:29], v[42:43] neg_lo:[0,1] neg_hi:[0,1]
v_pk_add_f32 v[28:29], v[28:29], v[42:43]
v_pk_add_f32 v[42:43], v[38:39], v[32:33] neg_lo:[0,1] neg_hi:[0,1]
v_pk_add_f32 v[38:39], v[38:39], v[32:33]
v_pk_add_f32 v[32:33], v[14:15], v[50:51] neg_lo:[0,1] neg_hi:[0,1]
v_pk_add_f32 v[14:15], v[14:15], v[50:51]
v_pk_add_f32 v[50:51], v[46:47], v[52:53] neg_lo:[0,1] neg_hi:[0,1]
v_pk_add_f32 v[46:47], v[46:47], v[52:53]
v_pk_add_f32 v[52:53], v[44:45], v[58:59] neg_lo:[0,1] neg_hi:[0,1]
v_pk_add_f32 v[44:45], v[44:45], v[58:59]
v_pk_add_f32 v[58:59], v[54:55], v[56:57] neg_lo:[0,1] neg_hi:[0,1]
v_pk_add_f32 v[54:55], v[54:55], v[56:57]
v_pk_add_f32 v[56:57], v[40:41], v[66:67] neg_lo:[0,1] neg_hi:[0,1]
v_pk_add_f32 v[40:41], v[40:41], v[66:67]
v_pk_add_f32 v[66:67], v[62:63], v[68:69] neg_lo:[0,1] neg_hi:[0,1]
v_pk_add_f32 v[62:63], v[62:63], v[68:69]
v_pk_add_f32 v[68:69], v[60:61], v[74:75] neg_lo:[0,1] neg_hi:[0,1]
v_pk_add_f32 v[60:61], v[60:61], v[74:75]
v_pk_add_f32 v[74:75], v[70:71], v[48:49] neg_lo:[0,1] neg_hi:[0,1]
v_pk_add_f32 v[70:71], v[70:71], v[48:49]
s_mov_b64 exec, s[18:19]
v_pk_add_f32 v[16:17], v[16:17], 0 neg_lo:[1,0] neg_hi:[1,0]
v_pk_mul_f32 v[48:49], v[14:15], s[48:49] op_sel:[0,0] op_sel_hi:[0,1] neg_lo:[0,1] neg_hi:[0,0]
v_pk_fma_f32 v[14:15], v[14:15], s[48:49], v[48:49] op_sel:[1,1,0] op_sel_hi:[1,0,1] neg_lo:[0,1,0] neg_hi:[0,1,0]
v_pk_mul_f32 v[48:49], v[64:65], s[50:51] op_sel:[0,0] op_sel_hi:[0,1] neg_lo:[0,1] neg_hi:[0,0]
v_pk_fma_f32 v[64:65], v[64:65], s[50:51], v[48:49] op_sel:[1,1,0] op_sel_hi:[1,0,1] neg_lo:[0,1,0] neg_hi:[0,1,0]
v_pk_mul_f32 v[48:49], v[40:41], s[52:53] op_sel:[0,0] op_sel_hi:[0,1] neg_lo:[0,1] neg_hi:[0,0]
v_pk_fma_f32 v[40:41], v[40:41], s[52:53], v[48:49] op_sel:[1,1,0] op_sel_hi:[1,0,1] neg_lo:[0,1,0] neg_hi:[0,1,0]
v_pk_mul_f32 v[48:49], v[72:73], s[54:55] op_sel:[0,0] op_sel_hi:[0,1] neg_lo:[0,1] neg_hi:[0,0]
v_pk_fma_f32 v[72:73], v[72:73], s[54:55], v[48:49] op_sel:[1,1,0] op_sel_hi:[1,0,1] neg_lo:[0,1,0] neg_hi:[0,1,0]
v_pk_mul_f32 v[48:49], v[44:45], s[56:57] op_sel:[0,0] op_sel_hi:[0,1] neg_lo:[0,1] neg_hi:[0,0]
v_pk_fma_f32 v[44:45], v[44:45], s[56:57], v[48:49] op_sel:[1,1,0] op_sel_hi:[1,0,1] neg_lo:[0,1,0] neg_hi:[0,1,0]
v_pk_mul_f32 v[48:49], v[28:29], s[58:59] op_sel:[0,0] op_sel_hi:[0,1] neg_lo:[0,1] neg_hi:[0,0]
v_pk_fma_f32 v[28:29], v[28:29], s[58:59], v[48:49] op_sel:[1,1,0] op_sel_hi:[1,0,1] neg_lo:[0,1,0] neg_hi:[0,1,0]
v_pk_mul_f32 v[48:49], v[60:61], s[60:61] op_sel:[0,0] op_sel_hi:[0,1] neg_lo:[0,1] neg_hi:[0,0]
v_pk_fma_f32 v[60:61], v[60:61], s[60:61], v[48:49] op_sel:[1,1,0] op_sel_hi:[1,0,1] neg_lo:[0,1,0] neg_hi:[0,1,0]
v_pk_mul_f32 v[48:49], v[76:77], s[62:63] op_sel:[0,0] op_sel_hi:[0,1] neg_lo:[0,1] neg_hi:[0,0]
v_pk_fma_f32 v[76:77], v[76:77], s[62:63], v[48:49] op_sel:[1,1,0] op_sel_hi:[1,0,1] neg_lo:[0,1,0] neg_hi:[0,1,0]
v_pk_mul_f32 v[48:49], v[46:47], s[60:61] op_sel:[0,1] op_sel_hi:[0,0] neg_lo:[0,1] neg_hi:[0,0]
v_pk_fma_f32 v[46:47], v[46:47], s[60:61], v[48:49] op_sel:[1,0,0] op_sel_hi:[1,1,1] neg_lo:[0,1,0] neg_hi:[0,1,0]
v_pk_mul_f32 v[48:49], v[30:31], s[58:59] op_sel:[0,1] op_sel_hi:[0,0] neg_lo:[0,1] neg_hi:[0,0]
v_pk_fma_f32 v[30:31], v[30:31], s[58:59], v[48:49] op_sel:[1,0,0] op_sel_hi:[1,1,1] neg_lo:[0,1,0] neg_hi:[0,1,0]
v_pk_mul_f32 v[48:49], v[62:63], s[56:57] op_sel:[0,1] op_sel_hi:[0,0] neg_lo:[0,1] neg_hi:[0,0]
v_pk_fma_f32 v[62:63], v[62:63], s[56:57], v[48:49] op_sel:[1,0,0] op_sel_hi:[1,1,1] neg_lo:[0,1,0] neg_hi:[0,1,0]
v_pk_mul_f32 v[48:49], v[22:23], s[54:55] op_sel:[0,1] op_sel_hi:[0,0] neg_lo:[0,1] neg_hi:[0,0]
v_pk_fma_f32 v[22:23], v[22:23], s[54:55], v[48:49] op_sel:[1,0,0] op_sel_hi:[1,1,1] neg_lo:[0,1,0] neg_hi:[0,1,0]
v_pk_mul_f32 v[48:49], v[54:55], s[52:53] op_sel:[0,1] op_sel_hi:[0,0] neg_lo:[0,1] neg_hi:[0,0]
v_pk_fma_f32 v[54:55], v[54:55], s[52:53], v[48:49] op_sel:[1,0,0] op_sel_hi:[1,1,1] neg_lo:[0,1,0] neg_hi:[0,1,0]
v_pk_mul_f32 v[48:49], v[38:39], s[50:51] op_sel:[0,1] op_sel_hi:[0,0] neg_lo:[0,1] neg_hi:[0,0]
v_pk_fma_f32 v[38:39], v[38:39], s[50:51], v[48:49] op_sel:[1,0,0] op_sel_hi:[1,1,1] neg_lo:[0,1,0] neg_hi:[0,1,0]
v_pk_mul_f32 v[48:49], v[70:71], s[48:49] op_sel:[0,1] op_sel_hi:[0,0] neg_lo:[0,1] neg_hi:[0,0]
v_pk_fma_f32 v[70:71], v[70:71], s[48:49], v[48:49] op_sel:[1,0,0] op_sel_hi:[1,1,1] neg_lo:[0,1,0] neg_hi:[0,1,0]
v_pk_add_f32 v[78:79], v[78:79], 0 op_sel:[1,0] op_sel_hi:[0,0] neg_lo:[1,0] neg_hi:[0,0]
v_pk_mul_f32 v[48:49], v[32:33], s[48:49] op_sel:[0,1] op_sel_hi:[0,0] neg_lo:[0,0] neg_hi:[0,0]
v_pk_fma_f32 v[32:33], v[32:33], s[48:49], v[48:49] op_sel:[1,0,0] op_sel_hi:[1,1,1] neg_lo:[0,1,0] neg_hi:[0,0,0]
v_pk_mul_f32 v[48:49], v[24:25], s[50:51] op_sel:[0,1] op_sel_hi:[0,0] neg_lo:[0,0] neg_hi:[0,0]
v_pk_fma_f32 v[24:25], v[24:25], s[50:51], v[48:49] op_sel:[1,0,0] op_sel_hi:[1,1,1] neg_lo:[0,1,0] neg_hi:[0,0,0]
v_pk_mul_f32 v[48:49], v[56:57], s[52:53] op_sel:[0,1] op_sel_hi:[0,0] neg_lo:[0,0] neg_hi:[0,0]
v_pk_fma_f32 v[56:57], v[56:57], s[52:53], v[48:49] op_sel:[1,0,0] op_sel_hi:[1,1,1] neg_lo:[0,1,0] neg_hi:[0,0,0]
v_pk_mul_f32 v[48:49], v[20:21], s[54:55] op_sel:[0,1] op_sel_hi:[0,0] neg_lo:[0,0] neg_hi:[0,0]
v_pk_fma_f32 v[20:21], v[20:21], s[54:55], v[48:49] op_sel:[1,0,0] op_sel_hi:[1,1,1] neg_lo:[0,1,0] neg_hi:[0,0,0]
v_pk_mul_f32 v[48:49], v[52:53], s[56:57] op_sel:[0,1] op_sel_hi:[0,0] neg_lo:[0,0] neg_hi:[0,0]
v_pk_fma_f32 v[52:53], v[52:53], s[56:57], v[48:49] op_sel:[1,0,0] op_sel_hi:[1,1,1] neg_lo:[0,1,0] neg_hi:[0,0,0]
v_pk_mul_f32 v[48:49], v[36:37], s[58:59] op_sel:[0,1] op_sel_hi:[0,0] neg_lo:[0,0] neg_hi:[0,0]
v_pk_fma_f32 v[36:37], v[36:37], s[58:59], v[48:49] op_sel:[1,0,0] op_sel_hi:[1,1,1] neg_lo:[0,1,0] neg_hi:[0,0,0]
v_pk_mul_f32 v[48:49], v[68:69], s[60:61] op_sel:[0,1] op_sel_hi:[0,0] neg_lo:[0,0] neg_hi:[0,0]
v_pk_fma_f32 v[68:69], v[68:69], s[60:61], v[48:49] op_sel:[1,0,0] op_sel_hi:[1,1,1] neg_lo:[0,1,0] neg_hi:[0,0,0]
v_pk_mul_f32 v[48:49], v[18:19], s[62:63] op_sel:[0,0] op_sel_hi:[0,1] neg_lo:[0,0] neg_hi:[0,0]
v_pk_fma_f32 v[18:19], v[18:19], s[62:63], v[48:49] op_sel:[1,1,0] op_sel_hi:[1,0,1] neg_lo:[0,1,0] neg_hi:[0,0,0]
v_pk_mul_f32 v[48:49], v[50:51], s[60:61] op_sel:[0,0] op_sel_hi:[0,1] neg_lo:[0,0] neg_hi:[0,0]
v_pk_fma_f32 v[50:51], v[50:51], s[60:61], v[48:49] op_sel:[1,1,0] op_sel_hi:[1,0,1] neg_lo:[0,1,0] neg_hi:[0,0,0]
v_pk_mul_f32 v[48:49], v[34:35], s[58:59] op_sel:[0,0] op_sel_hi:[0,1] neg_lo:[0,0] neg_hi:[0,0]
v_pk_fma_f32 v[34:35], v[34:35], s[58:59], v[48:49] op_sel:[1,1,0] op_sel_hi:[1,0,1] neg_lo:[0,1,0] neg_hi:[0,0,0]
v_pk_mul_f32 v[48:49], v[66:67], s[56:57] op_sel:[0,0] op_sel_hi:[0,1] neg_lo:[0,0] neg_hi:[0,0]
v_pk_fma_f32 v[66:67], v[66:67], s[56:57], v[48:49] op_sel:[1,1,0] op_sel_hi:[1,0,1] neg_lo:[0,1,0] neg_hi:[0,0,0]
v_pk_mul_f32 v[48:49], v[26:27], s[54:55] op_sel:[0,0] op_sel_hi:[0,1] neg_lo:[0,0] neg_hi:[0,0]
v_pk_fma_f32 v[26:27], v[26:27], s[54:55], v[48:49] op_sel:[1,1,0] op_sel_hi:[1,0,1] neg_lo:[0,1,0] neg_hi:[0,0,0]
v_pk_mul_f32 v[48:49], v[58:59], s[52:53] op_sel:[0,0] op_sel_hi:[0,1] neg_lo:[0,0] neg_hi:[0,0]
v_pk_fma_f32 v[58:59], v[58:59], s[52:53], v[48:49] op_sel:[1,1,0] op_sel_hi:[1,0,1] neg_lo:[0,1,0] neg_hi:[0,0,0]
v_pk_mul_f32 v[48:49], v[42:43], s[50:51] op_sel:[0,0] op_sel_hi:[0,1] neg_lo:[0,0] neg_hi:[0,0]
v_pk_fma_f32 v[42:43], v[42:43], s[50:51], v[48:49] op_sel:[1,1,0] op_sel_hi:[1,0,1] neg_lo:[0,1,0] neg_hi:[0,0,0]
v_pk_mul_f32 v[48:49], v[74:75], s[48:49] op_sel:[0,0] op_sel_hi:[0,1] neg_lo:[0,0] neg_hi:[0,0]
v_pk_fma_f32 v[74:75], v[74:75], s[48:49], v[48:49] op_sel:[1,1,0] op_sel_hi:[1,0,1] neg_lo:[0,1,0] neg_hi:[0,0,0]
s_mov_b64 exec, -1
v_fmac_f32_dpp v16, v16, v9 quad_perm:[1,0,3,2] row_mask:0xf bank_mask:0xf
v_fmac_f32_dpp v17, v17, v9 quad_perm:[1,0,3,2] row_mask:0xf bank_mask:0xf
v_fmac_f32_dpp v14, v14, v9 quad_perm:[1,0,3,2] row_mask:0xf bank_mask:0xf
v_fmac_f32_dpp v15, v15, v9 quad_perm:[1,0,3,2] row_mask:0xf bank_mask:0xf
v_fmac_f32_dpp v64, v64, v9 quad_perm:[1,0,3,2] row_mask:0xf bank_mask:0xf
v_fmac_f32_dpp v65, v65, v9 quad_perm:[1,0,3,2] row_mask:0xf bank_mask:0xf
v_fmac_f32_dpp v40, v40, v9 quad_perm:[1,0,3,2] row_mask:0xf bank_mask:0xf
v_fmac_f32_dpp v41, v41, v9 quad_perm:[1,0,3,2] row_mask:0xf bank_mask:0xf
v_fmac_f32_dpp v72, v72, v9 quad_perm:[1,0,3,2] row_mask:0xf bank_mask:0xf
v_fmac_f32_dpp v73, v73, v9 quad_perm:[1,0,3,2] row_mask:0xf bank_mask:0xf
v_fmac_f32_dpp v44, v44, v9 quad_perm:[1,0,3,2] row_mask:0xf bank_mask:0xf
v_fmac_f32_dpp v45, v45, v9 quad_perm:[1,0,3,2] row_mask:0xf bank_mask:0xf
v_fmac_f32_dpp v28, v28, v9 quad_perm:[1,0,3,2] row_mask:0xf bank_mask:0xf
v_fmac_f32_dpp v29, v29, v9 quad_perm:[1,0,3,2] row_mask:0xf bank_mask:0xf
v_fmac_f32_dpp v60, v60, v9 quad_perm:[1,0,3,2] row_mask:0xf bank_mask:0xf
v_fmac_f32_dpp v61, v61, v9 quad_perm:[1,0,3,2] row_mask:0xf bank_mask:0xf
v_fmac_f32_dpp v76, v76, v9 quad_perm:[1,0,3,2] row_mask:0xf bank_mask:0xf
v_fmac_f32_dpp v77, v77, v9 quad_perm:[1,0,3,2] row_mask:0xf bank_mask:0xf
v_fmac_f32_dpp v46, v46, v9 quad_perm:[1,0,3,2] row_mask:0xf bank_mask:0xf
v_fmac_f32_dpp v47, v47, v9 quad_perm:[1,0,3,2] row_mask:0xf bank_mask:0xf
v_fmac_f32_dpp v30, v30, v9 quad_perm:[1,0,3,2] row_mask:0xf bank_mask:0xf
v_fmac_f32_dpp v31, v31, v9 quad_perm:[1,0,3,2] row_mask:0xf bank_mask:0xf
v_fmac_f32_dpp v62, v62, v9 quad_perm:[1,0,3,2] row_mask:0xf bank_mask:0xf
v_fmac_f32_dpp v63, v63, v9 quad_perm:[1,0,3,2] row_mask:0xf bank_mask:0xf
v_fmac_f32_dpp v22, v22, v9 quad_perm:[1,0,3,2] row_mask:0xf bank_mask:0xf
v_fmac_f32_dpp v23, v23, v9 quad_perm:[1,0,3,2] row_mask:0xf bank_mask:0xf
v_fmac_f32_dpp v54, v54, v9 quad_perm:[1,0,3,2] row_mask:0xf bank_mask:0xf
v_fmac_f32_dpp v55, v55, v9 quad_perm:[1,0,3,2] row_mask:0xf bank_mask:0xf
v_fmac_f32_dpp v38, v38, v9 quad_perm:[1,0,3,2] row_mask:0xf bank_mask:0xf
v_fmac_f32_dpp v39, v39, v9 quad_perm:[1,0,3,2] row_mask:0xf bank_mask:0xf
v_fmac_f32_dpp v70, v70, v9 quad_perm:[1,0,3,2] row_mask:0xf bank_mask:0xf
v_fmac_f32_dpp v71, v71, v9 quad_perm:[1,0,3,2] row_mask:0xf bank_mask:0xf
v_fmac_f32_dpp v78, v78, v9 quad_perm:[1,0,3,2] row_mask:0xf bank_mask:0xf
v_fmac_f32_dpp v79, v79, v9 quad_perm:[1,0,3,2] row_mask:0xf bank_mask:0xf
v_fmac_f32_dpp v32, v32, v9 quad_perm:[1,0,3,2] row_mask:0xf bank_mask:0xf
v_fmac_f32_dpp v33, v33, v9 quad_perm:[1,0,3,2] row_mask:0xf bank_mask:0xf
v_fmac_f32_dpp v24, v24, v9 quad_perm:[1,0,3,2] row_mask:0xf bank_mask:0xf
v_fmac_f32_dpp v25, v25, v9 quad_perm:[1,0,3,2] row_mask:0xf bank_mask:0xf
v_fmac_f32_dpp v56, v56, v9 quad_perm:[1,0,3,2] row_mask:0xf bank_mask:0xf
v_fmac_f32_dpp v57, v57, v9 quad_perm:[1,0,3,2] row_mask:0xf bank_mask:0xf
v_fmac_f32_dpp v20, v20, v9 quad_perm:[1,0,3,2] row_mask:0xf bank_mask:0xf
v_fmac_f32_dpp v21, v21, v9 quad_perm:[1,0,3,2] row_mask:0xf bank_mask:0xf
v_fmac_f32_dpp v52, v52, v9 quad_perm:[1,0,3,2] row_mask:0xf bank_mask:0xf
v_fmac_f32_dpp v53, v53, v9 quad_perm:[1,0,3,2] row_mask:0xf bank_mask:0xf
v_fmac_f32_dpp v36, v36, v9 quad_perm:[1,0,3,2] row_mask:0xf bank_mask:0xf
v_fmac_f32_dpp v37, v37, v9 quad_perm:[1,0,3,2] row_mask:0xf bank_mask:0xf
v_fmac_f32_dpp v68, v68, v9 quad_perm:[1,0,3,2] row_mask:0xf bank_mask:0xf
v_fmac_f32_dpp v69, v69, v9 quad_perm:[1,0,3,2] row_mask:0xf bank_mask:0xf
v_fmac_f32_dpp v18, v18, v9 quad_perm:[1,0,3,2] row_mask:0xf bank_mask:0xf
v_fmac_f32_dpp v19, v19, v9 quad_perm:[1,0,3,2] row_mask:0xf bank_mask:0xf
v_fmac_f32_dpp v50, v50, v9 quad_perm:[1,0,3,2] row_mask:0xf bank_mask:0xf
v_fmac_f32_dpp v51, v51, v9 quad_perm:[1,0,3,2] row_mask:0xf bank_mask:0xf
v_fmac_f32_dpp v34, v34, v9 quad_perm:[1,0,3,2] row_mask:0xf bank_mask:0xf
v_fmac_f32_dpp v35, v35, v9 quad_perm:[1,0,3,2] row_mask:0xf bank_mask:0xf
v_fmac_f32_dpp v66, v66, v9 quad_perm:[1,0,3,2] row_mask:0xf bank_mask:0xf
v_fmac_f32_dpp v67, v67, v9 quad_perm:[1,0,3,2] row_mask:0xf bank_mask:0xf
v_fmac_f32_dpp v26, v26, v9 quad_perm:[1,0,3,2] row_mask:0xf bank_mask:0xf
v_fmac_f32_dpp v27, v27, v9 quad_perm:[1,0,3,2] row_mask:0xf bank_mask:0xf
v_fmac_f32_dpp v58, v58, v9 quad_perm:[1,0,3,2] row_mask:0xf bank_mask:0xf
v_fmac_f32_dpp v59, v59, v9 quad_perm:[1,0,3,2] row_mask:0xf bank_mask:0xf
v_fmac_f32_dpp v42, v42, v9 quad_perm:[1,0,3,2] row_mask:0xf bank_mask:0xf
v_fmac_f32_dpp v43, v43, v9 quad_perm:[1,0,3,2] row_mask:0xf bank_mask:0xf
v_fmac_f32_dpp v74, v74, v9 quad_perm:[1,0,3,2] row_mask:0xf bank_mask:0xf
v_fmac_f32_dpp v75, v75, v9 quad_perm:[1,0,3,2] row_mask:0xf bank_mask:0xf
v_lshlrev_b32 v240, 16, v208
v_and_b32 v241, 0xffff0000, v208
v_pk_mul_f32 v[48:49], v[16:17], v[240:241] op_sel:[0,0] op_sel_hi:[0,1] neg_lo:[0,0] neg_hi:[0,0]
v_pk_fma_f32 v[16:17], v[16:17], v[240:241], v[48:49] op_sel:[1,1,0] op_sel_hi:[1,0,1] neg_lo:[0,1,0] neg_hi:[0,0,0]
v_lshlrev_b32 v240, 16, v209
v_and_b32 v241, 0xffff0000, v209
v_pk_mul_f32 v[48:49], v[14:15], v[240:241] op_sel:[0,0] op_sel_hi:[0,1] neg_lo:[0,0] neg_hi:[0,0]
v_pk_fma_f32 v[14:15], v[14:15], v[240:241], v[48:49] op_sel:[1,1,0] op_sel_hi:[1,0,1] neg_lo:[0,1,0] neg_hi:[0,0,0]
v_lshlrev_b32 v240, 16, v210
v_and_b32 v241, 0xffff0000, v210
v_pk_mul_f32 v[48:49], v[64:65], v[240:241] op_sel:[0,0] op_sel_hi:[0,1] neg_lo:[0,0] neg_hi:[0,0]
v_pk_fma_f32 v[64:65], v[64:65], v[240:241], v[48:49] op_sel:[1,1,0] op_sel_hi:[1,0,1] neg_lo:[0,1,0] neg_hi:[0,0,0]
v_lshlrev_b32 v240, 16, v211
v_and_b32 v241, 0xffff0000, v211
v_pk_mul_f32 v[48:49], v[40:41], v[240:241] op_sel:[0,0] op_sel_hi:[0,1] neg_lo:[0,0] neg_hi:[0,0]
v_pk_fma_f32 v[40:41], v[40:41], v[240:241], v[48:49] op_sel:[1,1,0] op_sel_hi:[1,0,1] neg_lo:[0,1,0] neg_hi:[0,0,0]
v_lshlrev_b32 v240, 16, v212
v_and_b32 v241, 0xffff0000, v212
v_pk_mul_f32 v[48:49], v[72:73], v[240:241] op_sel:[0,0] op_sel_hi:[0,1] neg_lo:[0,0] neg_hi:[0,0]
v_pk_fma_f32 v[72:73], v[72:73], v[240:241], v[48:49] op_sel:[1,1,0] op_sel_hi:[1,0,1] neg_lo:[0,1,0] neg_hi:[0,0,0]
v_lshlrev_b32 v240, 16, v213
v_and_b32 v241, 0xffff0000, v213
v_pk_mul_f32 v[48:49], v[44:45], v[240:241] op_sel:[0,0] op_sel_hi:[0,1] neg_lo:[0,0] neg_hi:[0,0]
v_pk_fma_f32 v[44:45], v[44:45], v[240:241], v[48:49] op_sel:[1,1,0] op_sel_hi:[1,0,1] neg_lo:[0,1,0] neg_hi:[0,0,0]
v_lshlrev_b32 v240, 16, v214
v_and_b32 v241, 0xffff0000, v214
v_pk_mul_f32 v[48:49], v[28:29], v[240:241] op_sel:[0,0] op_sel_hi:[0,1] neg_lo:[0,0] neg_hi:[0,0]
v_pk_fma_f32 v[28:29], v[28:29], v[240:241], v[48:49] op_sel:[1,1,0] op_sel_hi:[1,0,1] neg_lo:[0,1,0] neg_hi:[0,0,0]
v_lshlrev_b32 v240, 16, v215
v_and_b32 v241, 0xffff0000, v215
v_pk_mul_f32 v[48:49], v[60:61], v[240:241] op_sel:[0,0] op_sel_hi:[0,1] neg_lo:[0,0] neg_hi:[0,0]
v_pk_fma_f32 v[60:61], v[60:61], v[240:241], v[48:49] op_sel:[1,1,0] op_sel_hi:[1,0,1] neg_lo:[0,1,0] neg_hi:[0,0,0]
v_lshlrev_b32 v240, 16, v216
v_and_b32 v241, 0xffff0000, v216
v_pk_mul_f32 v[48:49], v[76:77], v[240:241] op_sel:[0,0] op_sel_hi:[0,1] neg_lo:[0,0] neg_hi:[0,0]
v_pk_fma_f32 v[76:77], v[76:77], v[240:241], v[48:49] op_sel:[1,1,0] op_sel_hi:[1,0,1] neg_lo:[0,1,0] neg_hi:[0,0,0]
v_lshlrev_b32 v240, 16, v217
v_and_b32 v241, 0xffff0000, v217
v_pk_mul_f32 v[48:49], v[46:47], v[240:241] op_sel:[0,0] op_sel_hi:[0,1] neg_lo:[0,0] neg_hi:[0,0]
v_pk_fma_f32 v[46:47], v[46:47], v[240:241], v[48:49] op_sel:[1,1,0] op_sel_hi:[1,0,1] neg_lo:[0,1,0] neg_hi:[0,0,0]
v_lshlrev_b32 v240, 16, v218
v_and_b32 v241, 0xffff0000, v218
v_pk_mul_f32 v[48:49], v[30:31], v[240:241] op_sel:[0,0] op_sel_hi:[0,1] neg_lo:[0,0] neg_hi:[0,0]
v_pk_fma_f32 v[30:31], v[30:31], v[240:241], v[48:49] op_sel:[1,1,0] op_sel_hi:[1,0,1] neg_lo:[0,1,0] neg_hi:[0,0,0]
v_lshlrev_b32 v240, 16, v219
v_and_b32 v241, 0xffff0000, v219
v_pk_mul_f32 v[48:49], v[62:63], v[240:241] op_sel:[0,0] op_sel_hi:[0,1] neg_lo:[0,0] neg_hi:[0,0]
v_pk_fma_f32 v[62:63], v[62:63], v[240:241], v[48:49] op_sel:[1,1,0] op_sel_hi:[1,0,1] neg_lo:[0,1,0] neg_hi:[0,0,0]
v_lshlrev_b32 v240, 16, v220
v_and_b32 v241, 0xffff0000, v220
v_pk_mul_f32 v[48:49], v[22:23], v[240:241] op_sel:[0,0] op_sel_hi:[0,1] neg_lo:[0,0] neg_hi:[0,0]
v_pk_fma_f32 v[22:23], v[22:23], v[240:241], v[48:49] op_sel:[1,1,0] op_sel_hi:[1,0,1] neg_lo:[0,1,0] neg_hi:[0,0,0]
v_lshlrev_b32 v240, 16, v221
v_and_b32 v241, 0xffff0000, v221
v_pk_mul_f32 v[48:49], v[54:55], v[240:241] op_sel:[0,0] op_sel_hi:[0,1] neg_lo:[0,0] neg_hi:[0,0]
v_pk_fma_f32 v[54:55], v[54:55], v[240:241], v[48:49] op_sel:[1,1,0] op_sel_hi:[1,0,1] neg_lo:[0,1,0] neg_hi:[0,0,0]
v_lshlrev_b32 v240, 16, v222
v_and_b32 v241, 0xffff0000, v222
v_pk_mul_f32 v[48:49], v[38:39], v[240:241] op_sel:[0,0] op_sel_hi:[0,1] neg_lo:[0,0] neg_hi:[0,0]
v_pk_fma_f32 v[38:39], v[38:39], v[240:241], v[48:49] op_sel:[1,1,0] op_sel_hi:[1,0,1] neg_lo:[0,1,0] neg_hi:[0,0,0]
v_lshlrev_b32 v240, 16, v223
v_and_b32 v241, 0xffff0000, v223
v_pk_mul_f32 v[48:49], v[70:71], v[240:241] op_sel:[0,0] op_sel_hi:[0,1] neg_lo:[0,0] neg_hi:[0,0]
v_pk_fma_f32 v[70:71], v[70:71], v[240:241], v[48:49] op_sel:[1,1,0] op_sel_hi:[1,0,1] neg_lo:[0,1,0] neg_hi:[0,0,0]
v_lshlrev_b32 v240, 16, v224
v_and_b32 v241, 0xffff0000, v224
v_pk_mul_f32 v[48:49], v[78:79], v[240:241] op_sel:[0,0] op_sel_hi:[0,1] neg_lo:[0,0] neg_hi:[0,0]
v_pk_fma_f32 v[78:79], v[78:79], v[240:241], v[48:49] op_sel:[1,1,0] op_sel_hi:[1,0,1] neg_lo:[0,1,0] neg_hi:[0,0,0]
v_lshlrev_b32 v240, 16, v225
v_and_b32 v241, 0xffff0000, v225
v_pk_mul_f32 v[48:49], v[32:33], v[240:241] op_sel:[0,0] op_sel_hi:[0,1] neg_lo:[0,0] neg_hi:[0,0]
v_pk_fma_f32 v[32:33], v[32:33], v[240:241], v[48:49] op_sel:[1,1,0] op_sel_hi:[1,0,1] neg_lo:[0,1,0] neg_hi:[0,0,0]
v_lshlrev_b32 v240, 16, v226
v_and_b32 v241, 0xffff0000, v226
v_pk_mul_f32 v[48:49], v[24:25], v[240:241] op_sel:[0,0] op_sel_hi:[0,1] neg_lo:[0,0] neg_hi:[0,0]
v_pk_fma_f32 v[24:25], v[24:25], v[240:241], v[48:49] op_sel:[1,1,0] op_sel_hi:[1,0,1] neg_lo:[0,1,0] neg_hi:[0,0,0]
v_lshlrev_b32 v240, 16, v227
v_and_b32 v241, 0xffff0000, v227
v_pk_mul_f32 v[48:49], v[56:57], v[240:241] op_sel:[0,0] op_sel_hi:[0,1] neg_lo:[0,0] neg_hi:[0,0]
v_pk_fma_f32 v[56:57], v[56:57], v[240:241], v[48:49] op_sel:[1,1,0] op_sel_hi:[1,0,1] neg_lo:[0,1,0] neg_hi:[0,0,0]
v_lshlrev_b32 v240, 16, v228
v_and_b32 v241, 0xffff0000, v228
v_pk_mul_f32 v[48:49], v[20:21], v[240:241] op_sel:[0,0] op_sel_hi:[0,1] neg_lo:[0,0] neg_hi:[0,0]
v_pk_fma_f32 v[20:21], v[20:21], v[240:241], v[48:49] op_sel:[1,1,0] op_sel_hi:[1,0,1] neg_lo:[0,1,0] neg_hi:[0,0,0]
v_lshlrev_b32 v240, 16, v229
v_and_b32 v241, 0xffff0000, v229
v_pk_mul_f32 v[48:49], v[52:53], v[240:241] op_sel:[0,0] op_sel_hi:[0,1] neg_lo:[0,0] neg_hi:[0,0]
v_pk_fma_f32 v[52:53], v[52:53], v[240:241], v[48:49] op_sel:[1,1,0] op_sel_hi:[1,0,1] neg_lo:[0,1,0] neg_hi:[0,0,0]
v_lshlrev_b32 v240, 16, v230
v_and_b32 v241, 0xffff0000, v230
v_pk_mul_f32 v[48:49], v[36:37], v[240:241] op_sel:[0,0] op_sel_hi:[0,1] neg_lo:[0,0] neg_hi:[0,0]
v_pk_fma_f32 v[36:37], v[36:37], v[240:241], v[48:49] op_sel:[1,1,0] op_sel_hi:[1,0,1] neg_lo:[0,1,0] neg_hi:[0,0,0]
v_lshlrev_b32 v240, 16, v231
v_and_b32 v241, 0xffff0000, v231
v_pk_mul_f32 v[48:49], v[68:69], v[240:241] op_sel:[0,0] op_sel_hi:[0,1] neg_lo:[0,0] neg_hi:[0,0]
v_pk_fma_f32 v[68:69], v[68:69], v[240:241], v[48:49] op_sel:[1,1,0] op_sel_hi:[1,0,1] neg_lo:[0,1,0] neg_hi:[0,0,0]
v_lshlrev_b32 v240, 16, v232
v_and_b32 v241, 0xffff0000, v232
v_pk_mul_f32 v[48:49], v[18:19], v[240:241] op_sel:[0,0] op_sel_hi:[0,1] neg_lo:[0,0] neg_hi:[0,0]
v_pk_fma_f32 v[18:19], v[18:19], v[240:241], v[48:49] op_sel:[1,1,0] op_sel_hi:[1,0,1] neg_lo:[0,1,0] neg_hi:[0,0,0]
v_lshlrev_b32 v240, 16, v233
v_and_b32 v241, 0xffff0000, v233
v_pk_mul_f32 v[48:49], v[50:51], v[240:241] op_sel:[0,0] op_sel_hi:[0,1] neg_lo:[0,0] neg_hi:[0,0]
v_pk_fma_f32 v[50:51], v[50:51], v[240:241], v[48:49] op_sel:[1,1,0] op_sel_hi:[1,0,1] neg_lo:[0,1,0] neg_hi:[0,0,0]
v_lshlrev_b32 v240, 16, v234
v_and_b32 v241, 0xffff0000, v234
v_pk_mul_f32 v[48:49], v[34:35], v[240:241] op_sel:[0,0] op_sel_hi:[0,1] neg_lo:[0,0] neg_hi:[0,0]
v_pk_fma_f32 v[34:35], v[34:35], v[240:241], v[48:49] op_sel:[1,1,0] op_sel_hi:[1,0,1] neg_lo:[0,1,0] neg_hi:[0,0,0]
v_lshlrev_b32 v240, 16, v235
v_and_b32 v241, 0xffff0000, v235
v_pk_mul_f32 v[48:49], v[66:67], v[240:241] op_sel:[0,0] op_sel_hi:[0,1] neg_lo:[0,0] neg_hi:[0,0]
v_pk_fma_f32 v[66:67], v[66:67], v[240:241], v[48:49] op_sel:[1,1,0] op_sel_hi:[1,0,1] neg_lo:[0,1,0] neg_hi:[0,0,0]
v_lshlrev_b32 v240, 16, v236
v_and_b32 v241, 0xffff0000, v236
v_pk_mul_f32 v[48:49], v[26:27], v[240:241] op_sel:[0,0] op_sel_hi:[0,1] neg_lo:[0,0] neg_hi:[0,0]
v_pk_fma_f32 v[26:27], v[26:27], v[240:241], v[48:49] op_sel:[1,1,0] op_sel_hi:[1,0,1] neg_lo:[0,1,0] neg_hi:[0,0,0]
v_lshlrev_b32 v240, 16, v237
v_and_b32 v241, 0xffff0000, v237
v_pk_mul_f32 v[48:49], v[58:59], v[240:241] op_sel:[0,0] op_sel_hi:[0,1] neg_lo:[0,0] neg_hi:[0,0]
v_pk_fma_f32 v[58:59], v[58:59], v[240:241], v[48:49] op_sel:[1,1,0] op_sel_hi:[1,0,1] neg_lo:[0,1,0] neg_hi:[0,0,0]
v_lshlrev_b32 v240, 16, v238
v_and_b32 v241, 0xffff0000, v238
v_pk_mul_f32 v[48:49], v[42:43], v[240:241] op_sel:[0,0] op_sel_hi:[0,1] neg_lo:[0,0] neg_hi:[0,0]
v_pk_fma_f32 v[42:43], v[42:43], v[240:241], v[48:49] op_sel:[1,1,0] op_sel_hi:[1,0,1] neg_lo:[0,1,0] neg_hi:[0,0,0]
v_lshlrev_b32 v240, 16, v239
v_and_b32 v241, 0xffff0000, v239
v_pk_mul_f32 v[48:49], v[74:75], v[240:241] op_sel:[0,0] op_sel_hi:[0,1] neg_lo:[0,0] neg_hi:[0,0]
v_pk_fma_f32 v[74:75], v[74:75], v[240:241], v[48:49] op_sel:[1,1,0] op_sel_hi:[1,0,1] neg_lo:[0,1,0] neg_hi:[0,0,0]
v_fmac_f32_dpp v16, v16, v7 quad_perm:[1,0,3,2] row_mask:0xf bank_mask:0xf
v_fmac_f32_dpp v17, v17, v7 quad_perm:[1,0,3,2] row_mask:0xf bank_mask:0xf
v_fmac_f32_dpp v14, v14, v7 quad_perm:[1,0,3,2] row_mask:0xf bank_mask:0xf
v_fmac_f32_dpp v15, v15, v7 quad_perm:[1,0,3,2] row_mask:0xf bank_mask:0xf
v_fmac_f32_dpp v64, v64, v7 quad_perm:[1,0,3,2] row_mask:0xf bank_mask:0xf
v_fmac_f32_dpp v65, v65, v7 quad_perm:[1,0,3,2] row_mask:0xf bank_mask:0xf
v_fmac_f32_dpp v40, v40, v7 quad_perm:[1,0,3,2] row_mask:0xf bank_mask:0xf
v_fmac_f32_dpp v41, v41, v7 quad_perm:[1,0,3,2] row_mask:0xf bank_mask:0xf
v_fmac_f32_dpp v72, v72, v7 quad_perm:[1,0,3,2] row_mask:0xf bank_mask:0xf
v_fmac_f32_dpp v73, v73, v7 quad_perm:[1,0,3,2] row_mask:0xf bank_mask:0xf
v_fmac_f32_dpp v44, v44, v7 quad_perm:[1,0,3,2] row_mask:0xf bank_mask:0xf
v_fmac_f32_dpp v45, v45, v7 quad_perm:[1,0,3,2] row_mask:0xf bank_mask:0xf
v_fmac_f32_dpp v28, v28, v7 quad_perm:[1,0,3,2] row_mask:0xf bank_mask:0xf
v_fmac_f32_dpp v29, v29, v7 quad_perm:[1,0,3,2] row_mask:0xf bank_mask:0xf
v_fmac_f32_dpp v60, v60, v7 quad_perm:[1,0,3,2] row_mask:0xf bank_mask:0xf
v_fmac_f32_dpp v61, v61, v7 quad_perm:[1,0,3,2] row_mask:0xf bank_mask:0xf
v_fmac_f32_dpp v76, v76, v7 quad_perm:[1,0,3,2] row_mask:0xf bank_mask:0xf
v_fmac_f32_dpp v77, v77, v7 quad_perm:[1,0,3,2] row_mask:0xf bank_mask:0xf
v_fmac_f32_dpp v46, v46, v7 quad_perm:[1,0,3,2] row_mask:0xf bank_mask:0xf
v_fmac_f32_dpp v47, v47, v7 quad_perm:[1,0,3,2] row_mask:0xf bank_mask:0xf
v_fmac_f32_dpp v30, v30, v7 quad_perm:[1,0,3,2] row_mask:0xf bank_mask:0xf
v_fmac_f32_dpp v31, v31, v7 quad_perm:[1,0,3,2] row_mask:0xf bank_mask:0xf
v_fmac_f32_dpp v62, v62, v7 quad_perm:[1,0,3,2] row_mask:0xf bank_mask:0xf
v_fmac_f32_dpp v63, v63, v7 quad_perm:[1,0,3,2] row_mask:0xf bank_mask:0xf
v_fmac_f32_dpp v22, v22, v7 quad_perm:[1,0,3,2] row_mask:0xf bank_mask:0xf
v_fmac_f32_dpp v23, v23, v7 quad_perm:[1,0,3,2] row_mask:0xf bank_mask:0xf
v_fmac_f32_dpp v54, v54, v7 quad_perm:[1,0,3,2] row_mask:0xf bank_mask:0xf
v_fmac_f32_dpp v55, v55, v7 quad_perm:[1,0,3,2] row_mask:0xf bank_mask:0xf
v_fmac_f32_dpp v38, v38, v7 quad_perm:[1,0,3,2] row_mask:0xf bank_mask:0xf
v_fmac_f32_dpp v39, v39, v7 quad_perm:[1,0,3,2] row_mask:0xf bank_mask:0xf
v_fmac_f32_dpp v70, v70, v7 quad_perm:[1,0,3,2] row_mask:0xf bank_mask:0xf
v_fmac_f32_dpp v71, v71, v7 quad_perm:[1,0,3,2] row_mask:0xf bank_mask:0xf
v_fmac_f32_dpp v78, v78, v7 quad_perm:[1,0,3,2] row_mask:0xf bank_mask:0xf
v_fmac_f32_dpp v79, v79, v7 quad_perm:[1,0,3,2] row_mask:0xf bank_mask:0xf
v_fmac_f32_dpp v32, v32, v7 quad_perm:[1,0,3,2] row_mask:0xf bank_mask:0xf
v_fmac_f32_dpp v33, v33, v7 quad_perm:[1,0,3,2] row_mask:0xf bank_mask:0xf
v_fmac_f32_dpp v24, v24, v7 quad_perm:[1,0,3,2] row_mask:0xf bank_mask:0xf
v_fmac_f32_dpp v25, v25, v7 quad_perm:[1,0,3,2] row_mask:0xf bank_mask:0xf
v_fmac_f32_dpp v56, v56, v7 quad_perm:[1,0,3,2] row_mask:0xf bank_mask:0xf
v_fmac_f32_dpp v57, v57, v7 quad_perm:[1,0,3,2] row_mask:0xf bank_mask:0xf
v_fmac_f32_dpp v20, v20, v7 quad_perm:[1,0,3,2] row_mask:0xf bank_mask:0xf
v_fmac_f32_dpp v21, v21, v7 quad_perm:[1,0,3,2] row_mask:0xf bank_mask:0xf
v_fmac_f32_dpp v52, v52, v7 quad_perm:[1,0,3,2] row_mask:0xf bank_mask:0xf
v_fmac_f32_dpp v53, v53, v7 quad_perm:[1,0,3,2] row_mask:0xf bank_mask:0xf
v_fmac_f32_dpp v36, v36, v7 quad_perm:[1,0,3,2] row_mask:0xf bank_mask:0xf
v_fmac_f32_dpp v37, v37, v7 quad_perm:[1,0,3,2] row_mask:0xf bank_mask:0xf
v_fmac_f32_dpp v68, v68, v7 quad_perm:[1,0,3,2] row_mask:0xf bank_mask:0xf
v_fmac_f32_dpp v69, v69, v7 quad_perm:[1,0,3,2] row_mask:0xf bank_mask:0xf
v_fmac_f32_dpp v18, v18, v7 quad_perm:[1,0,3,2] row_mask:0xf bank_mask:0xf
v_fmac_f32_dpp v19, v19, v7 quad_perm:[1,0,3,2] row_mask:0xf bank_mask:0xf
v_fmac_f32_dpp v50, v50, v7 quad_perm:[1,0,3,2] row_mask:0xf bank_mask:0xf
v_fmac_f32_dpp v51, v51, v7 quad_perm:[1,0,3,2] row_mask:0xf bank_mask:0xf
v_fmac_f32_dpp v34, v34, v7 quad_perm:[1,0,3,2] row_mask:0xf bank_mask:0xf
v_fmac_f32_dpp v35, v35, v7 quad_perm:[1,0,3,2] row_mask:0xf bank_mask:0xf
v_fmac_f32_dpp v66, v66, v7 quad_perm:[1,0,3,2] row_mask:0xf bank_mask:0xf
v_fmac_f32_dpp v67, v67, v7 quad_perm:[1,0,3,2] row_mask:0xf bank_mask:0xf
v_fmac_f32_dpp v26, v26, v7 quad_perm:[1,0,3,2] row_mask:0xf bank_mask:0xf
v_fmac_f32_dpp v27, v27, v7 quad_perm:[1,0,3,2] row_mask:0xf bank_mask:0xf
v_fmac_f32_dpp v58, v58, v7 quad_perm:[1,0,3,2] row_mask:0xf bank_mask:0xf
v_fmac_f32_dpp v59, v59, v7 quad_perm:[1,0,3,2] row_mask:0xf bank_mask:0xf
v_fmac_f32_dpp v42, v42, v7 quad_perm:[1,0,3,2] row_mask:0xf bank_mask:0xf
v_fmac_f32_dpp v43, v43, v7 quad_perm:[1,0,3,2] row_mask:0xf bank_mask:0xf
v_fmac_f32_dpp v74, v74, v7 quad_perm:[1,0,3,2] row_mask:0xf bank_mask:0xf
v_fmac_f32_dpp v75, v75, v7 quad_perm:[1,0,3,2] row_mask:0xf bank_mask:0xf
s_mov_b64 exec, s[18:19]
v_pk_add_f32 v[16:17], v[16:17], 0 neg_lo:[1,0] neg_hi:[1,0]
v_pk_mul_f32 v[48:49], v[14:15], s[48:49] op_sel:[0,0] op_sel_hi:[0,1] neg_lo:[0,1] neg_hi:[0,1]
v_pk_fma_f32 v[14:15], v[14:15], s[48:49], v[48:49] op_sel:[1,1,0] op_sel_hi:[1,0,1] neg_lo:[0,0,0] neg_hi:[0,1,0]
v_pk_mul_f32 v[48:49], v[64:65], s[50:51] op_sel:[0,0] op_sel_hi:[0,1] neg_lo:[0,1] neg_hi:[0,1]
v_pk_fma_f32 v[64:65], v[64:65], s[50:51], v[48:49] op_sel:[1,1,0] op_sel_hi:[1,0,1] neg_lo:[0,0,0] neg_hi:[0,1,0]
v_pk_mul_f32 v[48:49], v[40:41], s[52:53] op_sel:[0,0] op_sel_hi:[0,1] neg_lo:[0,1] neg_hi:[0,1]
v_pk_fma_f32 v[40:41], v[40:41], s[52:53], v[48:49] op_sel:[1,1,0] op_sel_hi:[1,0,1] neg_lo:[0,0,0] neg_hi:[0,1,0]
v_pk_mul_f32 v[48:49], v[72:73], s[54:55] op_sel:[0,0] op_sel_hi:[0,1] neg_lo:[0,1] neg_hi:[0,1]
v_pk_fma_f32 v[72:73], v[72:73], s[54:55], v[48:49] op_sel:[1,1,0] op_sel_hi:[1,0,1] neg_lo:[0,0,0] neg_hi:[0,1,0]
v_pk_mul_f32 v[48:49], v[44:45], s[56:57] op_sel:[0,0] op_sel_hi:[0,1] neg_lo:[0,1] neg_hi:[0,1]
v_pk_fma_f32 v[44:45], v[44:45], s[56:57], v[48:49] op_sel:[1,1,0] op_sel_hi:[1,0,1] neg_lo:[0,0,0] neg_hi:[0,1,0]
v_pk_mul_f32 v[48:49], v[28:29], s[58:59] op_sel:[0,0] op_sel_hi:[0,1] neg_lo:[0,1] neg_hi:[0,1]
v_pk_fma_f32 v[28:29], v[28:29], s[58:59], v[48:49] op_sel:[1,1,0] op_sel_hi:[1,0,1] neg_lo:[0,0,0] neg_hi:[0,1,0]
v_pk_mul_f32 v[48:49], v[60:61], s[60:61] op_sel:[0,0] op_sel_hi:[0,1] neg_lo:[0,1] neg_hi:[0,1]
v_pk_fma_f32 v[60:61], v[60:61], s[60:61], v[48:49] op_sel:[1,1,0] op_sel_hi:[1,0,1] neg_lo:[0,0,0] neg_hi:[0,1,0]
v_pk_mul_f32 v[48:49], v[76:77], s[62:63] op_sel:[0,0] op_sel_hi:[0,1] neg_lo:[0,1] neg_hi:[0,1]
v_pk_fma_f32 v[76:77], v[76:77], s[62:63], v[48:49] op_sel:[1,1,0] op_sel_hi:[1,0,1] neg_lo:[0,0,0] neg_hi:[0,1,0]
v_pk_mul_f32 v[48:49], v[46:47], s[60:61] op_sel:[0,1] op_sel_hi:[0,0] neg_lo:[0,1] neg_hi:[0,1]
v_pk_fma_f32 v[46:47], v[46:47], s[60:61], v[48:49] op_sel:[1,0,0] op_sel_hi:[1,1,1] neg_lo:[0,0,0] neg_hi:[0,1,0]
v_pk_mul_f32 v[48:49], v[30:31], s[58:59] op_sel:[0,1] op_sel_hi:[0,0] neg_lo:[0,1] neg_hi:[0,1]
v_pk_fma_f32 v[30:31], v[30:31], s[58:59], v[48:49] op_sel:[1,0,0] op_sel_hi:[1,1,1] neg_lo:[0,0,0] neg_hi:[0,1,0]
v_pk_mul_f32 v[48:49], v[62:63], s[56:57] op_sel:[0,1] op_sel_hi:[0,0] neg_lo:[0,1] neg_hi:[0,1]
v_pk_fma_f32 v[62:63], v[62:63], s[56:57], v[48:49] op_sel:[1,0,0] op_sel_hi:[1,1,1] neg_lo:[0,0,0] neg_hi:[0,1,0]
v_pk_mul_f32 v[48:49], v[22:23], s[54:55] op_sel:[0,1] op_sel_hi:[0,0] neg_lo:[0,1] neg_hi:[0,1]
v_pk_fma_f32 v[22:23], v[22:23], s[54:55], v[48:49] op_sel:[1,0,0] op_sel_hi:[1,1,1] neg_lo:[0,0,0] neg_hi:[0,1,0]
v_pk_mul_f32 v[48:49], v[54:55], s[52:53] op_sel:[0,1] op_sel_hi:[0,0] neg_lo:[0,1] neg_hi:[0,1]
v_pk_fma_f32 v[54:55], v[54:55], s[52:53], v[48:49] op_sel:[1,0,0] op_sel_hi:[1,1,1] neg_lo:[0,0,0] neg_hi:[0,1,0]
v_pk_mul_f32 v[48:49], v[38:39], s[50:51] op_sel:[0,1] op_sel_hi:[0,0] neg_lo:[0,1] neg_hi:[0,1]
v_pk_fma_f32 v[38:39], v[38:39], s[50:51], v[48:49] op_sel:[1,0,0] op_sel_hi:[1,1,1] neg_lo:[0,0,0] neg_hi:[0,1,0]
v_pk_mul_f32 v[48:49], v[70:71], s[48:49] op_sel:[0,1] op_sel_hi:[0,0] neg_lo:[0,1] neg_hi:[0,1]
v_pk_fma_f32 v[70:71], v[70:71], s[48:49], v[48:49] op_sel:[1,0,0] op_sel_hi:[1,1,1] neg_lo:[0,0,0] neg_hi:[0,1,0]
v_pk_add_f32 v[78:79], v[78:79], 0 op_sel:[1,0] op_sel_hi:[0,0] neg_lo:[0,0] neg_hi:[1,0]
v_pk_mul_f32 v[48:49], v[32:33], s[48:49] op_sel:[0,1] op_sel_hi:[0,0] neg_lo:[0,0] neg_hi:[0,1]
v_pk_fma_f32 v[32:33], v[32:33], s[48:49], v[48:49] op_sel:[1,0,0] op_sel_hi:[1,1,1] neg_lo:[0,0,0] neg_hi:[0,0,0]
v_pk_mul_f32 v[48:49], v[24:25], s[50:51] op_sel:[0,1] op_sel_hi:[0,0] neg_lo:[0,0] neg_hi:[0,1]
v_pk_fma_f32 v[24:25], v[24:25], s[50:51], v[48:49] op_sel:[1,0,0] op_sel_hi:[1,1,1] neg_lo:[0,0,0] neg_hi:[0,0,0]
v_pk_mul_f32 v[48:49], v[56:57], s[52:53] op_sel:[0,1] op_sel_hi:[0,0] neg_lo:[0,0] neg_hi:[0,1]
v_pk_fma_f32 v[56:57], v[56:57], s[52:53], v[48:49] op_sel:[1,0,0] op_sel_hi:[1,1,1] neg_lo:[0,0,0] neg_hi:[0,0,0]
v_pk_mul_f32 v[48:49], v[20:21], s[54:55] op_sel:[0,1] op_sel_hi:[0,0] neg_lo:[0,0] neg_hi:[0,1]
v_pk_fma_f32 v[20:21], v[20:21], s[54:55], v[48:49] op_sel:[1,0,0] op_sel_hi:[1,1,1] neg_lo:[0,0,0] neg_hi:[0,0,0]
v_pk_mul_f32 v[48:49], v[52:53], s[56:57] op_sel:[0,1] op_sel_hi:[0,0] neg_lo:[0,0] neg_hi:[0,1]
v_pk_fma_f32 v[52:53], v[52:53], s[56:57], v[48:49] op_sel:[1,0,0] op_sel_hi:[1,1,1] neg_lo:[0,0,0] neg_hi:[0,0,0]
v_pk_mul_f32 v[48:49], v[36:37], s[58:59] op_sel:[0,1] op_sel_hi:[0,0] neg_lo:[0,0] neg_hi:[0,1]
v_pk_fma_f32 v[36:37], v[36:37], s[58:59], v[48:49] op_sel:[1,0,0] op_sel_hi:[1,1,1] neg_lo:[0,0,0] neg_hi:[0,0,0]
v_pk_mul_f32 v[48:49], v[68:69], s[60:61] op_sel:[0,1] op_sel_hi:[0,0] neg_lo:[0,0] neg_hi:[0,1]
v_pk_fma_f32 v[68:69], v[68:69], s[60:61], v[48:49] op_sel:[1,0,0] op_sel_hi:[1,1,1] neg_lo:[0,0,0] neg_hi:[0,0,0]
v_pk_mul_f32 v[48:49], v[18:19], s[62:63] op_sel:[0,0] op_sel_hi:[0,1] neg_lo:[0,0] neg_hi:[0,1]
v_pk_fma_f32 v[18:19], v[18:19], s[62:63], v[48:49] op_sel:[1,1,0] op_sel_hi:[1,0,1] neg_lo:[0,0,0] neg_hi:[0,0,0]
v_pk_mul_f32 v[48:49], v[50:51], s[60:61] op_sel:[0,0] op_sel_hi:[0,1] neg_lo:[0,0] neg_hi:[0,1]
v_pk_fma_f32 v[50:51], v[50:51], s[60:61], v[48:49] op_sel:[1,1,0] op_sel_hi:[1,0,1] neg_lo:[0,0,0] neg_hi:[0,0,0]
v_pk_mul_f32 v[48:49], v[34:35], s[58:59] op_sel:[0,0] op_sel_hi:[0,1] neg_lo:[0,0] neg_hi:[0,1]
v_pk_fma_f32 v[34:35], v[34:35], s[58:59], v[48:49] op_sel:[1,1,0] op_sel_hi:[1,0,1] neg_lo:[0,0,0] neg_hi:[0,0,0]
v_pk_mul_f32 v[48:49], v[66:67], s[56:57] op_sel:[0,0] op_sel_hi:[0,1] neg_lo:[0,0] neg_hi:[0,1]
v_pk_fma_f32 v[66:67], v[66:67], s[56:57], v[48:49] op_sel:[1,1,0] op_sel_hi:[1,0,1] neg_lo:[0,0,0] neg_hi:[0,0,0]
v_pk_mul_f32 v[48:49], v[26:27], s[54:55] op_sel:[0,0] op_sel_hi:[0,1] neg_lo:[0,0] neg_hi:[0,1]
v_pk_fma_f32 v[26:27], v[26:27], s[54:55], v[48:49] op_sel:[1,1,0] op_sel_hi:[1,0,1] neg_lo:[0,0,0] neg_hi:[0,0,0]
v_pk_mul_f32 v[48:49], v[58:59], s[52:53] op_sel:[0,0] op_sel_hi:[0,1] neg_lo:[0,0] neg_hi:[0,1]
v_pk_fma_f32 v[58:59], v[58:59], s[52:53], v[48:49] op_sel:[1,1,0] op_sel_hi:[1,0,1] neg_lo:[0,0,0] neg_hi:[0,0,0]
v_pk_mul_f32 v[48:49], v[42:43], s[50:51] op_sel:[0,0] op_sel_hi:[0,1] neg_lo:[0,0] neg_hi:[0,1]
v_pk_fma_f32 v[42:43], v[42:43], s[50:51], v[48:49] op_sel:[1,1,0] op_sel_hi:[1,0,1] neg_lo:[0,0,0] neg_hi:[0,0,0]
v_pk_mul_f32 v[48:49], v[74:75], s[48:49] op_sel:[0,0] op_sel_hi:[0,1] neg_lo:[0,0] neg_hi:[0,1]
v_pk_fma_f32 v[74:75], v[74:75], s[48:49], v[48:49] op_sel:[1,1,0] op_sel_hi:[1,0,1] neg_lo:[0,0,0] neg_hi:[0,0,0]
s_mov_b64 exec, -1
v_pk_add_f32 v[48:49], v[16:17], v[78:79] neg_lo:[0,1] neg_hi:[0,1]
v_pk_add_f32 v[16:17], v[16:17], v[78:79]
v_pk_add_f32 v[78:79], v[14:15], v[32:33] neg_lo:[0,1] neg_hi:[0,1]
v_pk_add_f32 v[14:15], v[14:15], v[32:33]
v_pk_mul_f32 v[32:33], v[78:79], s[50:51] op_sel:[0,0] op_sel_hi:[0,1] neg_lo:[0,0] neg_hi:[0,0]
v_pk_fma_f32 v[32:33], v[78:79], s[50:51], v[32:33] op_sel:[1,1,0] op_sel_hi:[1,0,1] neg_lo:[0,1,0] neg_hi:[0,0,0]
v_pk_add_f32 v[78:79], v[64:65], v[24:25] neg_lo:[0,1] neg_hi:[0,1]
v_pk_add_f32 v[64:65], v[64:65], v[24:25]
v_pk_mul_f32 v[24:25], v[78:79], s[54:55] op_sel:[0,0] op_sel_hi:[0,1] neg_lo:[0,0] neg_hi:[0,0]
v_pk_fma_f32 v[24:25], v[78:79], s[54:55], v[24:25] op_sel:[1,1,0] op_sel_hi:[1,0,1] neg_lo:[0,1,0] neg_hi:[0,0,0]
v_pk_add_f32 v[78:79], v[40:41], v[56:57] neg_lo:[0,1] neg_hi:[0,1]
v_pk_add_f32 v[40:41], v[40:41], v[56:57]
v_pk_mul_f32 v[56:57], v[78:79], s[58:59] op_sel:[0,0] op_sel_hi:[0,1] neg_lo:[0,0] neg_hi:[0,0]
v_pk_fma_f32 v[56:57], v[78:79], s[58:59], v[56:57] op_sel:[1,1,0] op_sel_hi:[1,0,1] neg_lo:[0,1,0] neg_hi:[0,0,0]
v_pk_add_f32 v[78:79], v[72:73], v[20:21] neg_lo:[0,1] neg_hi:[0,1]
v_pk_add_f32 v[72:73], v[72:73], v[20:21]
v_pk_mul_f32 v[20:21], v[78:79], s[62:63] op_sel:[0,0] op_sel_hi:[0,1] neg_lo:[0,0] neg_hi:[0,0]
v_pk_fma_f32 v[20:21], v[78:79], s[62:63], v[20:21] op_sel:[1,1,0] op_sel_hi:[1,0,1] neg_lo:[0,1,0] neg_hi:[0,0,0]
v_pk_add_f32 v[78:79], v[44:45], v[52:53] neg_lo:[0,1] neg_hi:[0,1]
v_pk_add_f32 v[44:45], v[44:45], v[52:53]
v_pk_mul_f32 v[52:53], v[78:79], s[58:59] op_sel:[0,1] op_sel_hi:[0,0] neg_lo:[0,0] neg_hi:[0,0]
v_pk_fma_f32 v[52:53], v[78:79], s[58:59], v[52:53] op_sel:[1,0,0] op_sel_hi:[1,1,1] neg_lo:[0,1,0] neg_hi:[0,0,0]
v_pk_add_f32 v[78:79], v[28:29], v[36:37] neg_lo:[0,1] neg_hi:[0,1]
v_pk_add_f32 v[28:29], v[28:29], v[36:37]
v_pk_mul_f32 v[36:37], v[78:79], s[54:55] op_sel:[0,1] op_sel_hi:[0,0] neg_lo:[0,0] neg_hi:[0,0]
v_pk_fma_f32 v[36:37], v[78:79], s[54:55], v[36:37] op_sel:[1,0,0] op_sel_hi:[1,1,1] neg_lo:[0,1,0] neg_hi:[0,0,0]
v_pk_add_f32 v[78:79], v[60:61], v[68:69] neg_lo:[0,1] neg_hi:[0,1]
v_pk_add_f32 v[60:61], v[60:61], v[68:69]
v_pk_mul_f32 v[68:69], v[78:79], s[50:51] op_sel:[0,1] op_sel_hi:[0,0] neg_lo:[0,0] neg_hi:[0,0]
v_pk_fma_f32 v[68:69], v[78:79], s[50:51], v[68:69] op_sel:[1,0,0] op_sel_hi:[1,1,1] neg_lo:[0,1,0] neg_hi:[0,0,0]
v_pk_add_f32 v[78:79], v[76:77], v[18:19] op_sel:[1,1] op_sel_hi:[0,0] neg_lo:[1,0] neg_hi:[0,1]
v_pk_add_f32 v[76:77], v[76:77], v[18:19]
v_pk_add_f32 v[18:19], v[46:47], v[50:51] neg_lo:[0,1] neg_hi:[0,1]
v_pk_add_f32 v[46:47], v[46:47], v[50:51]
v_pk_mul_f32 v[50:51], v[18:19], s[50:51] op_sel:[0,1] op_sel_hi:[0,0] neg_lo:[0,1] neg_hi:[0,0]
v_pk_fma_f32 v[50:51], v[18:19], s[50:51], v[50:51] op_sel:[1,0,0] op_sel_hi:[1,1,1] neg_lo:[0,1,0] neg_hi:[0,1,0]
v_pk_add_f32 v[18:19], v[30:31], v[34:35] neg_lo:[0,1] neg_hi:[0,1]
v_pk_add_f32 v[30:31], v[30:31], v[34:35]
v_pk_mul_f32 v[34:35], v[18:19], s[54:55] op_sel:[0,1] op_sel_hi:[0,0] neg_lo:[0,1] neg_hi:[0,0]
v_pk_fma_f32 v[34:35], v[18:19], s[54:55], v[34:35] op_sel:[1,0,0] op_sel_hi:[1,1,1] neg_lo:[0,1,0] neg_hi:[0,1,0]
v_pk_add_f32 v[18:19], v[62:63], v[66:67] neg_lo:[0,1] neg_hi:[0,1]
v_pk_add_f32 v[62:63], v[62:63], v[66:67]
v_pk_mul_f32 v[66:67], v[18:19], s[58:59] op_sel:[0,1] op_sel_hi:[0,0] neg_lo:[0,1] neg_hi:[0,0]
v_pk_fma_f32 v[66:67], v[18:19], s[58:59], v[66:67] op_sel:[1,0,0] op_sel_hi:[1,1,1] neg_lo:[0,1,0] neg_hi:[0,1,0]
v_pk_add_f32 v[18:19], v[22:23], v[26:27] neg_lo:[0,1] neg_hi:[0,1]
v_pk_add_f32 v[22:23], v[22:23], v[26:27]
v_pk_mul_f32 v[26:27], v[18:19], s[62:63] op_sel:[0,0] op_sel_hi:[0,1] neg_lo:[0,1] neg_hi:[0,0]
v_pk_fma_f32 v[26:27], v[18:19], s[62:63], v[26:27] op_sel:[1,1,0] op_sel_hi:[1,0,1] neg_lo:[0,1,0] neg_hi:[0,1,0]
v_pk_add_f32 v[18:19], v[54:55], v[58:59] neg_lo:[0,1] neg_hi:[0,1]
v_pk_add_f32 v[54:55], v[54:55], v[58:59]
v_pk_mul_f32 v[58:59], v[18:19], s[58:59] op_sel:[0,0] op_sel_hi:[0,1] neg_lo:[0,1] neg_hi:[0,0]
v_pk_fma_f32 v[58:59], v[18:19], s[58:59], v[58:59] op_sel:[1,1,0] op_sel_hi:[1,0,1] neg_lo:[0,1,0] neg_hi:[0,1,0]
v_pk_add_f32 v[18:19], v[38:39], v[42:43] neg_lo:[0,1] neg_hi:[0,1]
v_pk_add_f32 v[38:39], v[38:39], v[42:43]
v_pk_mul_f32 v[42:43], v[18:19], s[54:55] op_sel:[0,0] op_sel_hi:[0,1] neg_lo:[0,1] neg_hi:[0,0]
v_pk_fma_f32 v[42:43], v[18:19], s[54:55], v[42:43] op_sel:[1,1,0] op_sel_hi:[1,0,1] neg_lo:[0,1,0] neg_hi:[0,1,0]
v_pk_add_f32 v[18:19], v[70:71], v[74:75] neg_lo:[0,1] neg_hi:[0,1]
v_pk_add_f32 v[70:71], v[70:71], v[74:75]
v_pk_mul_f32 v[74:75], v[18:19], s[50:51] op_sel:[0,0] op_sel_hi:[0,1] neg_lo:[0,1] neg_hi:[0,0]
v_pk_fma_f32 v[74:75], v[18:19], s[50:51], v[74:75] op_sel:[1,1,0] op_sel_hi:[1,0,1] neg_lo:[0,1,0] neg_hi:[0,1,0]
v_pk_add_f32 v[18:19], v[16:17], v[76:77] neg_lo:[0,1] neg_hi:[0,1]
v_pk_add_f32 v[16:17], v[16:17], v[76:77]
v_pk_add_f32 v[76:77], v[14:15], v[46:47] neg_lo:[0,1] neg_hi:[0,1]
v_pk_add_f32 v[14:15], v[14:15], v[46:47]
v_pk_mul_f32 v[46:47], v[76:77], s[54:55] op_sel:[0,0] op_sel_hi:[0,1] neg_lo:[0,0] neg_hi:[0,0]
v_pk_fma_f32 v[46:47], v[76:77], s[54:55], v[46:47] op_sel:[1,1,0] op_sel_hi:[1,0,1] neg_lo:[0,1,0] neg_hi:[0,0,0]
v_pk_add_f32 v[76:77], v[64:65], v[30:31] neg_lo:[0,1] neg_hi:[0,1]
v_pk_add_f32 v[64:65], v[64:65], v[30:31]
v_pk_mul_f32 v[30:31], v[76:77], s[62:63] op_sel:[0,0] op_sel_hi:[0,1] neg_lo:[0,0] neg_hi:[0,0]
v_pk_fma_f32 v[30:31], v[76:77], s[62:63], v[30:31] op_sel:[1,1,0] op_sel_hi:[1,0,1] neg_lo:[0,1,0] neg_hi:[0,0,0]
v_pk_add_f32 v[76:77], v[40:41], v[62:63] neg_lo:[0,1] neg_hi:[0,1]
v_pk_add_f32 v[40:41], v[40:41], v[62:63]
v_pk_mul_f32 v[62:63], v[76:77], s[54:55] op_sel:[0,1] op_sel_hi:[0,0] neg_lo:[0,0] neg_hi:[0,0]
v_pk_fma_f32 v[62:63], v[76:77], s[54:55], v[62:63] op_sel:[1,0,0] op_sel_hi:[1,1,1] neg_lo:[0,1,0] neg_hi:[0,0,0]
v_pk_add_f32 v[76:77], v[72:73], v[22:23] op_sel:[1,1] op_sel_hi:[0,0] neg_lo:[1,0] neg_hi:[0,1]
v_pk_add_f32 v[72:73], v[72:73], v[22:23]
v_pk_add_f32 v[22:23], v[44:45], v[54:55] neg_lo:[0,1] neg_hi:[0,1]
v_pk_add_f32 v[44:45], v[44:45], v[54:55]
v_pk_mul_f32 v[54:55], v[22:23], s[54:55] op_sel:[0,1] op_sel_hi:[0,0] neg_lo:[0,1] neg_hi:[0,0]
v_pk_fma_f32 v[54:55], v[22:23], s[54:55], v[54:55] op_sel:[1,0,0] op_sel_hi:[1,1,1] neg_lo:[0,1,0] neg_hi:[0,1,0]
v_pk_add_f32 v[22:23], v[28:29], v[38:39] neg_lo:[0,1] neg_hi:[0,1]
v_pk_add_f32 v[28:29], v[28:29], v[38:39]
v_pk_mul_f32 v[38:39], v[22:23], s[62:63] op_sel:[0,0] op_sel_hi:[0,1] neg_lo:[0,1] neg_hi:[0,0]
v_pk_fma_f32 v[38:39], v[22:23], s[62:63], v[38:39] op_sel:[1,1,0] op_sel_hi:[1,0,1] neg_lo:[0,1,0] neg_hi:[0,1,0]
v_pk_add_f32 v[22:23], v[60:61], v[70:71] neg_lo:[0,1] neg_hi:[0,1]
v_pk_add_f32 v[60:61], v[60:61], v[70:71]
v_pk_mul_f32 v[70:71], v[22:23], s[54:55] op_sel:[0,0] op_sel_hi:[0,1] neg_lo:[0,1] neg_hi:[0,0]
v_pk_fma_f32 v[70:71], v[22:23], s[54:55], v[70:71] op_sel:[1,1,0] op_sel_hi:[1,0,1] neg_lo:[0,1,0] neg_hi:[0,1,0]
v_pk_add_f32 v[22:23], v[48:49], v[78:79] neg_lo:[0,1] neg_hi:[0,1]
v_pk_add_f32 v[48:49], v[48:49], v[78:79]
v_pk_add_f32 v[78:79], v[32:33], v[50:51] neg_lo:[0,1] neg_hi:[0,1]
v_pk_add_f32 v[32:33], v[32:33], v[50:51]
v_pk_mul_f32 v[50:51], v[78:79], s[54:55] op_sel:[0,0] op_sel_hi:[0,1] neg_lo:[0,0] neg_hi:[0,0]
v_pk_fma_f32 v[50:51], v[78:79], s[54:55], v[50:51] op_sel:[1,1,0] op_sel_hi:[1,0,1] neg_lo:[0,1,0] neg_hi:[0,0,0]
v_pk_add_f32 v[78:79], v[24:25], v[34:35] neg_lo:[0,1] neg_hi:[0,1]
v_pk_add_f32 v[24:25], v[24:25], v[34:35]
v_pk_mul_f32 v[34:35], v[78:79], s[62:63] op_sel:[0,0] op_sel_hi:[0,1] neg_lo:[0,0] neg_hi:[0,0]
v_pk_fma_f32 v[34:35], v[78:79], s[62:63], v[34:35] op_sel:[1,1,0] op_sel_hi:[1,0,1] neg_lo:[0,1,0] neg_hi:[0,0,0]
v_pk_add_f32 v[78:79], v[56:57], v[66:67] neg_lo:[0,1] neg_hi:[0,1]
v_pk_add_f32 v[56:57], v[56:57], v[66:67]
v_pk_mul_f32 v[66:67], v[78:79], s[54:55] op_sel:[0,1] op_sel_hi:[0,0] neg_lo:[0,0] neg_hi:[0,0]
v_pk_fma_f32 v[66:67], v[78:79], s[54:55], v[66:67] op_sel:[1,0,0] op_sel_hi:[1,1,1] neg_lo:[0,1,0] neg_hi:[0,0,0]
v_pk_add_f32 v[78:79], v[20:21], v[26:27] op_sel:[1,1] op_sel_hi:[0,0] neg_lo:[1,0] neg_hi:[0,1]
v_pk_add_f32 v[20:21], v[20:21], v[26:27]
v_pk_add_f32 v[26:27], v[52:53], v[58:59] neg_lo:[0,1] neg_hi:[0,1]
v_pk_add_f32 v[52:53], v[52:53], v[58:59]
v_pk_mul_f32 v[58:59], v[26:27], s[54:55] op_sel:[0,1] op_sel_hi:[0,0] neg_lo:[0,1] neg_hi:[0,0]
v_pk_fma_f32 v[58:59], v[26:27], s[54:55], v[58:59] op_sel:[1,0,0] op_sel_hi:[1,1,1] neg_lo:[0,1,0] neg_hi:[0,1,0]
v_pk_add_f32 v[26:27], v[36:37], v[42:43] neg_lo:[0,1] neg_hi:[0,1]
v_pk_add_f32 v[36:37], v[36:37], v[42:43]
v_pk_mul_f32 v[42:43], v[26:27], s[62:63] op_sel:[0,0] op_sel_hi:[0,1] neg_lo:[0,1] neg_hi:[0,0]
v_pk_fma_f32 v[42:43], v[26:27], s[62:63], v[42:43] op_sel:[1,1,0] op_sel_hi:[1,0,1] neg_lo:[0,1,0] neg_hi:[0,1,0]
v_pk_add_f32 v[26:27], v[68:69], v[74:75] neg_lo:[0,1] neg_hi:[0,1]
v_pk_add_f32 v[68:69], v[68:69], v[74:75]
v_pk_mul_f32 v[74:75], v[26:27], s[54:55] op_sel:[0,0] op_sel_hi:[0,1] neg_lo:[0,1] neg_hi:[0,0]
v_pk_fma_f32 v[74:75], v[26:27], s[54:55], v[74:75] op_sel:[1,1,0] op_sel_hi:[1,0,1] neg_lo:[0,1,0] neg_hi:[0,1,0]
v_pk_add_f32 v[26:27], v[16:17], v[72:73] neg_lo:[0,1] neg_hi:[0,1]
v_pk_add_f32 v[16:17], v[16:17], v[72:73]
v_pk_add_f32 v[72:73], v[14:15], v[44:45] neg_lo:[0,1] neg_hi:[0,1]
v_pk_add_f32 v[14:15], v[14:15], v[44:45]
v_pk_mul_f32 v[44:45], v[72:73], s[62:63] op_sel:[0,0] op_sel_hi:[0,1] neg_lo:[0,0] neg_hi:[0,0]
v_pk_fma_f32 v[44:45], v[72:73], s[62:63], v[44:45] op_sel:[1,1,0] op_sel_hi:[1,0,1] neg_lo:[0,1,0] neg_hi:[0,0,0]
v_pk_add_f32 v[72:73], v[64:65], v[28:29] op_sel:[1,1] op_sel_hi:[0,0] neg_lo:[1,0] neg_hi:[0,1]
v_pk_add_f32 v[64:65], v[64:65], v[28:29]
v_pk_add_f32 v[28:29], v[40:41], v[60:61] neg_lo:[0,1] neg_hi:[0,1]
v_pk_add_f32 v[40:41], v[40:41], v[60:61]
v_pk_mul_f32 v[60:61], v[28:29], s[62:63] op_sel:[0,0] op_sel_hi:[0,1] neg_lo:[0,1] neg_hi:[0,0]
v_pk_fma_f32 v[60:61], v[28:29], s[62:63], v[60:61] op_sel:[1,1,0] op_sel_hi:[1,0,1] neg_lo:[0,1,0] neg_hi:[0,1,0]
v_pk_add_f32 v[28:29], v[18:19], v[76:77] neg_lo:[0,1] neg_hi:[0,1]
v_pk_add_f32 v[18:19], v[18:19], v[76:77]
v_pk_add_f32 v[76:77], v[46:47], v[54:55] neg_lo:[0,1] neg_hi:[0,1]
v_pk_add_f32 v[46:47], v[46:47], v[54:55]
v_pk_mul_f32 v[54:55], v[76:77], s[62:63] op_sel:[0,0] op_sel_hi:[0,1] neg_lo:[0,0] neg_hi:[0,0]
v_pk_fma_f32 v[54:55], v[76:77], s[62:63], v[54:55] op_sel:[1,1,0] op_sel_hi:[1,0,1] neg_lo:[0,1,0] neg_hi:[0,0,0]
v_pk_add_f32 v[76:77], v[30:31], v[38:39] op_sel:[1,1] op_sel_hi:[0,0] neg_lo:[1,0] neg_hi:[0,1]
v_pk_add_f32 v[30:31], v[30:31], v[38:39]
v_pk_add_f32 v[38:39], v[62:63], v[70:71] neg_lo:[0,1] neg_hi:[0,1]
v_pk_add_f32 v[62:63], v[62:63], v[70:71]
v_pk_mul_f32 v[70:71], v[38:39], s[62:63] op_sel:[0,0] op_sel_hi:[0,1] neg_lo:[0,1] neg_hi:[0,0]
v_pk_fma_f32 v[70:71], v[38:39], s[62:63], v[70:71] op_sel:[1,1,0] op_sel_hi:[1,0,1] neg_lo:[0,1,0] neg_hi:[0,1,0]
v_pk_add_f32 v[38:39], v[48:49], v[20:21] neg_lo:[0,1] neg_hi:[0,1]
v_pk_add_f32 v[48:49], v[48:49], v[20:21]
v_pk_add_f32 v[20:21], v[32:33], v[52:53] neg_lo:[0,1] neg_hi:[0,1]
v_pk_add_f32 v[32:33], v[32:33], v[52:53]
v_pk_mul_f32 v[52:53], v[20:21], s[62:63] op_sel:[0,0] op_sel_hi:[0,1] neg_lo:[0,0] neg_hi:[0,0]
v_pk_fma_f32 v[52:53], v[20:21], s[62:63], v[52:53] op_sel:[1,1,0] op_sel_hi:[1,0,1] neg_lo:[0,1,0] neg_hi:[0,0,0]
v_pk_add_f32 v[20:21], v[24:25], v[36:37] op_sel:[1,1] op_sel_hi:[0,0] neg_lo:[1,0] neg_hi:[0,1]
v_pk_add_f32 v[24:25], v[24:25], v[36:37]
v_pk_add_f32 v[36:37], v[56:57], v[68:69] neg_lo:[0,1] neg_hi:[0,1]
v_pk_add_f32 v[56:57], v[56:57], v[68:69]
v_pk_mul_f32 v[68:69], v[36:37], s[62:63] op_sel:[0,0] op_sel_hi:[0,1] neg_lo:[0,1] neg_hi:[0,0]
v_pk_fma_f32 v[68:69], v[36:37], s[62:63], v[68:69] op_sel:[1,1,0] op_sel_hi:[1,0,1] neg_lo:[0,1,0] neg_hi:[0,1,0]
v_pk_add_f32 v[36:37], v[22:23], v[78:79] neg_lo:[0,1] neg_hi:[0,1]
v_pk_add_f32 v[22:23], v[22:23], v[78:79]
v_pk_add_f32 v[78:79], v[50:51], v[58:59] neg_lo:[0,1] neg_hi:[0,1]
v_pk_add_f32 v[50:51], v[50:51], v[58:59]
v_pk_mul_f32 v[58:59], v[78:79], s[62:63] op_sel:[0,0] op_sel_hi:[0,1] neg_lo:[0,0] neg_hi:[0,0]
v_pk_fma_f32 v[58:59], v[78:79], s[62:63], v[58:59] op_sel:[1,1,0] op_sel_hi:[1,0,1] neg_lo:[0,1,0] neg_hi:[0,0,0]
v_pk_add_f32 v[78:79], v[34:35], v[42:43] op_sel:[1,1] op_sel_hi:[0,0] neg_lo:[1,0] neg_hi:[0,1]
v_pk_add_f32 v[34:35], v[34:35], v[42:43]
v_pk_add_f32 v[42:43], v[66:67], v[74:75] neg_lo:[0,1] neg_hi:[0,1]
v_pk_add_f32 v[66:67], v[66:67], v[74:75]
v_pk_mul_f32 v[74:75], v[42:43], s[62:63] op_sel:[0,0] op_sel_hi:[0,1] neg_lo:[0,1] neg_hi:[0,0]
v_pk_fma_f32 v[74:75], v[42:43], s[62:63], v[74:75] op_sel:[1,1,0] op_sel_hi:[1,0,1] neg_lo:[0,1,0] neg_hi:[0,1,0]
v_pk_add_f32 v[42:43], v[16:17], v[64:65] neg_lo:[0,1] neg_hi:[0,1]
v_pk_add_f32 v[16:17], v[16:17], v[64:65]
v_pk_add_f32 v[64:65], v[14:15], v[40:41] op_sel:[1,1] op_sel_hi:[0,0] neg_lo:[1,0] neg_hi:[0,1]
v_pk_add_f32 v[14:15], v[14:15], v[40:41]
v_pk_add_f32 v[40:41], v[26:27], v[72:73] neg_lo:[0,1] neg_hi:[0,1]
v_pk_add_f32 v[26:27], v[26:27], v[72:73]
v_pk_add_f32 v[72:73], v[44:45], v[60:61] op_sel:[1,1] op_sel_hi:[0,0] neg_lo:[1,0] neg_hi:[0,1]
v_pk_add_f32 v[44:45], v[44:45], v[60:61]
v_pk_add_f32 v[60:61], v[18:19], v[30:31] neg_lo:[0,1] neg_hi:[0,1]
v_pk_add_f32 v[18:19], v[18:19], v[30:31]
v_pk_add_f32 v[30:31], v[46:47], v[62:63] op_sel:[1,1] op_sel_hi:[0,0] neg_lo:[1,0] neg_hi:[0,1]
v_pk_add_f32 v[46:47], v[46:47], v[62:63]
v_pk_add_f32 v[62:63], v[28:29], v[76:77] neg_lo:[0,1] neg_hi:[0,1]
v_pk_add_f32 v[28:29], v[28:29], v[76:77]
v_pk_add_f32 v[76:77], v[54:55], v[70:71] op_sel:[1,1] op_sel_hi:[0,0] neg_lo:[1,0] neg_hi:[0,1]
v_pk_add_f32 v[54:55], v[54:55], v[70:71]
v_pk_add_f32 v[70:71], v[48:49], v[24:25] neg_lo:[0,1] neg_hi:[0,1]
v_pk_add_f32 v[48:49], v[48:49], v[24:25]
v_pk_add_f32 v[24:25], v[32:33], v[56:57] op_sel:[1,1] op_sel_hi:[0,0] neg_lo:[1,0] neg_hi:[0,1]
v_pk_add_f32 v[32:33], v[32:33], v[56:57]
v_pk_add_f32 v[56:57], v[38:39], v[20:21] neg_lo:[0,1] neg_hi:[0,1]
v_pk_add_f32 v[38:39], v[38:39], v[20:21]
v_pk_add_f32 v[20:21], v[52:53], v[68:69] op_sel:[1,1] op_sel_hi:[0,0] neg_lo:[1,0] neg_hi:[0,1]
v_pk_add_f32 v[52:53], v[52:53], v[68:69]
v_pk_add_f32 v[68:69], v[22:23], v[34:35] neg_lo:[0,1] neg_hi:[0,1]
v_pk_add_f32 v[22:23], v[22:23], v[34:35]
v_pk_add_f32 v[34:35], v[50:51], v[66:67] op_sel:[1,1] op_sel_hi:[0,0] neg_lo:[1,0] neg_hi:[0,1]
v_pk_add_f32 v[50:51], v[50:51], v[66:67]
v_pk_add_f32 v[66:67], v[36:37], v[78:79] neg_lo:[0,1] neg_hi:[0,1]
v_pk_add_f32 v[36:37], v[36:37], v[78:79]
v_pk_add_f32 v[78:79], v[58:59], v[74:75] op_sel:[1,1] op_sel_hi:[0,0] neg_lo:[1,0] neg_hi:[0,1]
v_pk_add_f32 v[58:59], v[58:59], v[74:75]
v_pk_add_f32 v[74:75], v[16:17], v[14:15] neg_lo:[0,1] neg_hi:[0,1]
v_pk_add_f32 v[16:17], v[16:17], v[14:15]
v_pk_add_f32 v[14:15], v[42:43], v[64:65] neg_lo:[0,1] neg_hi:[0,1]
v_pk_add_f32 v[42:43], v[42:43], v[64:65]
v_pk_add_f32 v[64:65], v[26:27], v[44:45] neg_lo:[0,1] neg_hi:[0,1]
v_pk_add_f32 v[26:27], v[26:27], v[44:45]
v_pk_add_f32 v[44:45], v[40:41], v[72:73] neg_lo:[0,1] neg_hi:[0,1]
v_pk_add_f32 v[40:41], v[40:41], v[72:73]
v_pk_add_f32 v[72:73], v[18:19], v[46:47] neg_lo:[0,1] neg_hi:[0,1]
v_pk_add_f32 v[18:19], v[18:19], v[46:47]
v_pk_add_f32 v[46:47], v[60:61], v[30:31] neg_lo:[0,1] neg_hi:[0,1]
v_pk_add_f32 v[60:61], v[60:61], v[30:31]
v_pk_add_f32 v[30:31], v[28:29], v[54:55] neg_lo:[0,1] neg_hi:[0,1]
v_pk_add_f32 v[28:29], v[28:29], v[54:55]
v_pk_add_f32 v[54:55], v[62:63], v[76:77] neg_lo:[0,1] neg_hi:[0,1]
v_pk_add_f32 v[62:63], v[62:63], v[76:77]
v_pk_add_f32 v[76:77], v[48:49], v[32:33] neg_lo:[0,1] neg_hi:[0,1]
v_pk_add_f32 v[48:49], v[48:49], v[32:33]
v_pk_add_f32 v[32:33], v[70:71], v[24:25] neg_lo:[0,1] neg_hi:[0,1]
v_pk_add_f32 v[70:71], v[70:71], v[24:25]
v_pk_add_f32 v[24:25], v[38:39], v[52:53] neg_lo:[0,1] neg_hi:[0,1]
v_pk_add_f32 v[38:39], v[38:39], v[52:53]
v_pk_add_f32 v[52:53], v[56:57], v[20:21] neg_lo:[0,1] neg_hi:[0,1]
v_pk_add_f32 v[56:57], v[56:57], v[20:21]
v_pk_add_f32 v[20:21], v[22:23], v[50:51] neg_lo:[0,1] neg_hi:[0,1]
v_pk_add_f32 v[22:23], v[22:23], v[50:51]
v_pk_add_f32 v[50:51], v[68:69], v[34:35] neg_lo:[0,1] neg_hi:[0,1]
v_pk_add_f32 v[68:69], v[68:69], v[34:35]
v_pk_add_f32 v[34:35], v[36:37], v[58:59] neg_lo:[0,1] neg_hi:[0,1]
v_pk_add_f32 v[36:37], v[36:37], v[58:59]
v_pk_add_f32 v[58:59], v[66:67], v[78:79] neg_lo:[0,1] neg_hi:[0,1]
v_pk_add_f32 v[66:67], v[66:67], v[78:79]
v_pk_mul_f32 v[78:79], v[16:17], v[144:145] op_sel:[0,0] op_sel_hi:[0,1] neg_lo:[0,0] neg_hi:[0,0]
v_pk_fma_f32 v[16:17], v[16:17], v[144:145], v[78:79] op_sel:[1,1,0] op_sel_hi:[1,0,1] neg_lo:[0,1,0] neg_hi:[0,0,0]
v_pk_mul_f32 v[78:79], v[48:49], v[146:147] op_sel:[0,0] op_sel_hi:[0,1] neg_lo:[0,0] neg_hi:[0,0]
v_pk_fma_f32 v[48:49], v[48:49], v[146:147], v[78:79] op_sel:[1,1,0] op_sel_hi:[1,0,1] neg_lo:[0,1,0] neg_hi:[0,0,0]
v_pk_mul_f32 v[78:79], v[18:19], v[148:149] op_sel:[0,0] op_sel_hi:[0,1] neg_lo:[0,0] neg_hi:[0,0]
v_pk_fma_f32 v[18:19], v[18:19], v[148:149], v[78:79] op_sel:[1,1,0] op_sel_hi:[1,0,1] neg_lo:[0,1,0] neg_hi:[0,0,0]
v_pk_mul_f32 v[78:79], v[22:23], v[150:151] op_sel:[0,0] op_sel_hi:[0,1] neg_lo:[0,0] neg_hi:[0,0]
v_pk_fma_f32 v[22:23], v[22:23], v[150:151], v[78:79] op_sel:[1,1,0] op_sel_hi:[1,0,1] neg_lo:[0,1,0] neg_hi:[0,0,0]
v_pk_mul_f32 v[78:79], v[26:27], v[152:153] op_sel:[0,0] op_sel_hi:[0,1] neg_lo:[0,0] neg_hi:[0,0]
v_pk_fma_f32 v[26:27], v[26:27], v[152:153], v[78:79] op_sel:[1,1,0] op_sel_hi:[1,0,1] neg_lo:[0,1,0] neg_hi:[0,0,0]
v_pk_mul_f32 v[78:79], v[38:39], v[154:155] op_sel:[0,0] op_sel_hi:[0,1] neg_lo:[0,0] neg_hi:[0,0]
v_pk_fma_f32 v[38:39], v[38:39], v[154:155], v[78:79] op_sel:[1,1,0] op_sel_hi:[1,0,1] neg_lo:[0,1,0] neg_hi:[0,0,0]
v_pk_mul_f32 v[78:79], v[28:29], v[156:157] op_sel:[0,0] op_sel_hi:[0,1] neg_lo:[0,0] neg_hi:[0,0]
v_pk_fma_f32 v[28:29], v[28:29], v[156:157], v[78:79] op_sel:[1,1,0] op_sel_hi:[1,0,1] neg_lo:[0,1,0] neg_hi:[0,0,0]
v_pk_mul_f32 v[78:79], v[36:37], v[158:159] op_sel:[0,0] op_sel_hi:[0,1] neg_lo:[0,0] neg_hi:[0,0]
v_pk_fma_f32 v[36:37], v[36:37], v[158:159], v[78:79] op_sel:[1,1,0] op_sel_hi:[1,0,1] neg_lo:[0,1,0] neg_hi:[0,0,0]
v_pk_mul_f32 v[78:79], v[42:43], v[160:161] op_sel:[0,0] op_sel_hi:[0,1] neg_lo:[0,0] neg_hi:[0,0]
v_pk_fma_f32 v[42:43], v[42:43], v[160:161], v[78:79] op_sel:[1,1,0] op_sel_hi:[1,0,1] neg_lo:[0,1,0] neg_hi:[0,0,0]
v_pk_mul_f32 v[78:79], v[70:71], v[162:163] op_sel:[0,0] op_sel_hi:[0,1] neg_lo:[0,0] neg_hi:[0,0]
v_pk_fma_f32 v[70:71], v[70:71], v[162:163], v[78:79] op_sel:[1,1,0] op_sel_hi:[1,0,1] neg_lo:[0,1,0] neg_hi:[0,0,0]
v_pk_mul_f32 v[78:79], v[60:61], v[164:165] op_sel:[0,0] op_sel_hi:[0,1] neg_lo:[0,0] neg_hi:[0,0]
v_pk_fma_f32 v[60:61], v[60:61], v[164:165], v[78:79] op_sel:[1,1,0] op_sel_hi:[1,0,1] neg_lo:[0,1,0] neg_hi:[0,0,0]
v_pk_mul_f32 v[78:79], v[68:69], v[166:167] op_sel:[0,0] op_sel_hi:[0,1] neg_lo:[0,0] neg_hi:[0,0]
v_pk_fma_f32 v[68:69], v[68:69], v[166:167], v[78:79] op_sel:[1,1,0] op_sel_hi:[1,0,1] neg_lo:[0,1,0] neg_hi:[0,0,0]
v_pk_mul_f32 v[78:79], v[40:41], v[168:169] op_sel:[0,0] op_sel_hi:[0,1] neg_lo:[0,0] neg_hi:[0,0]
v_pk_fma_f32 v[40:41], v[40:41], v[168:169], v[78:79] op_sel:[1,1,0] op_sel_hi:[1,0,1] neg_lo:[0,1,0] neg_hi:[0,0,0]
v_pk_mul_f32 v[78:79], v[56:57], v[170:171] op_sel:[0,0] op_sel_hi:[0,1] neg_lo:[0,0] neg_hi:[0,0]
v_pk_fma_f32 v[56:57], v[56:57], v[170:171], v[78:79] op_sel:[1,1,0] op_sel_hi:[1,0,1] neg_lo:[0,1,0] neg_hi:[0,0,0]
v_pk_mul_f32 v[78:79], v[62:63], v[172:173] op_sel:[0,0] op_sel_hi:[0,1] neg_lo:[0,0] neg_hi:[0,0]
v_pk_fma_f32 v[62:63], v[62:63], v[172:173], v[78:79] op_sel:[1,1,0] op_sel_hi:[1,0,1] neg_lo:[0,1,0] neg_hi:[0,0,0]
v_pk_mul_f32 v[78:79], v[66:67], v[174:175] op_sel:[0,0] op_sel_hi:[0,1] neg_lo:[0,0] neg_hi:[0,0]
v_pk_fma_f32 v[66:67], v[66:67], v[174:175], v[78:79] op_sel:[1,1,0] op_sel_hi:[1,0,1] neg_lo:[0,1,0] neg_hi:[0,0,0]
v_pk_mul_f32 v[78:79], v[74:75], v[176:177] op_sel:[0,0] op_sel_hi:[0,1] neg_lo:[0,0] neg_hi:[0,0]
v_pk_fma_f32 v[74:75], v[74:75], v[176:177], v[78:79] op_sel:[1,1,0] op_sel_hi:[1,0,1] neg_lo:[0,1,0] neg_hi:[0,0,0]
v_pk_mul_f32 v[78:79], v[76:77], v[178:179] op_sel:[0,0] op_sel_hi:[0,1] neg_lo:[0,0] neg_hi:[0,0]
v_pk_fma_f32 v[76:77], v[76:77], v[178:179], v[78:79] op_sel:[1,1,0] op_sel_hi:[1,0,1] neg_lo:[0,1,0] neg_hi:[0,0,0]
v_pk_mul_f32 v[78:79], v[72:73], v[180:181] op_sel:[0,0] op_sel_hi:[0,1] neg_lo:[0,0] neg_hi:[0,0]
v_pk_fma_f32 v[72:73], v[72:73], v[180:181], v[78:79] op_sel:[1,1,0] op_sel_hi:[1,0,1] neg_lo:[0,1,0] neg_hi:[0,0,0]
v_pk_mul_f32 v[78:79], v[20:21], v[182:183] op_sel:[0,0] op_sel_hi:[0,1] neg_lo:[0,0] neg_hi:[0,0]
v_pk_fma_f32 v[20:21], v[20:21], v[182:183], v[78:79] op_sel:[1,1,0] op_sel_hi:[1,0,1] neg_lo:[0,1,0] neg_hi:[0,0,0]
v_pk_mul_f32 v[78:79], v[64:65], v[184:185] op_sel:[0,0] op_sel_hi:[0,1] neg_lo:[0,0] neg_hi:[0,0]
v_pk_fma_f32 v[64:65], v[64:65], v[184:185], v[78:79] op_sel:[1,1,0] op_sel_hi:[1,0,1] neg_lo:[0,1,0] neg_hi:[0,0,0]
v_pk_mul_f32 v[78:79], v[24:25], v[186:187] op_sel:[0,0] op_sel_hi:[0,1] neg_lo:[0,0] neg_hi:[0,0]
v_pk_fma_f32 v[24:25], v[24:25], v[186:187], v[78:79] op_sel:[1,1,0] op_sel_hi:[1,0,1] neg_lo:[0,1,0] neg_hi:[0,0,0]
v_pk_mul_f32 v[78:79], v[30:31], v[188:189] op_sel:[0,0] op_sel_hi:[0,1] neg_lo:[0,0] neg_hi:[0,0]
v_pk_fma_f32 v[30:31], v[30:31], v[188:189], v[78:79] op_sel:[1,1,0] op_sel_hi:[1,0,1] neg_lo:[0,1,0] neg_hi:[0,0,0]
v_pk_mul_f32 v[78:79], v[34:35], v[190:191] op_sel:[0,0] op_sel_hi:[0,1] neg_lo:[0,0] neg_hi:[0,0]
v_pk_fma_f32 v[34:35], v[34:35], v[190:191], v[78:79] op_sel:[1,1,0] op_sel_hi:[1,0,1] neg_lo:[0,1,0] neg_hi:[0,0,0]
v_pk_mul_f32 v[78:79], v[14:15], v[192:193] op_sel:[0,0] op_sel_hi:[0,1] neg_lo:[0,0] neg_hi:[0,0]
v_pk_fma_f32 v[14:15], v[14:15], v[192:193], v[78:79] op_sel:[1,1,0] op_sel_hi:[1,0,1] neg_lo:[0,1,0] neg_hi:[0,0,0]
v_pk_mul_f32 v[78:79], v[32:33], v[194:195] op_sel:[0,0] op_sel_hi:[0,1] neg_lo:[0,0] neg_hi:[0,0]
v_pk_fma_f32 v[32:33], v[32:33], v[194:195], v[78:79] op_sel:[1,1,0] op_sel_hi:[1,0,1] neg_lo:[0,1,0] neg_hi:[0,0,0]
v_pk_mul_f32 v[78:79], v[46:47], v[196:197] op_sel:[0,0] op_sel_hi:[0,1] neg_lo:[0,0] neg_hi:[0,0]
v_pk_fma_f32 v[46:47], v[46:47], v[196:197], v[78:79] op_sel:[1,1,0] op_sel_hi:[1,0,1] neg_lo:[0,1,0] neg_hi:[0,0,0]
v_pk_mul_f32 v[78:79], v[50:51], v[198:199] op_sel:[0,0] op_sel_hi:[0,1] neg_lo:[0,0] neg_hi:[0,0]
v_pk_fma_f32 v[50:51], v[50:51], v[198:199], v[78:79] op_sel:[1,1,0] op_sel_hi:[1,0,1] neg_lo:[0,1,0] neg_hi:[0,0,0]
v_pk_mul_f32 v[78:79], v[44:45], v[200:201] op_sel:[0,0] op_sel_hi:[0,1] neg_lo:[0,0] neg_hi:[0,0]
v_pk_fma_f32 v[44:45], v[44:45], v[200:201], v[78:79] op_sel:[1,1,0] op_sel_hi:[1,0,1] neg_lo:[0,1,0] neg_hi:[0,0,0]
v_pk_mul_f32 v[78:79], v[52:53], v[202:203] op_sel:[0,0] op_sel_hi:[0,1] neg_lo:[0,0] neg_hi:[0,0]
v_pk_fma_f32 v[52:53], v[52:53], v[202:203], v[78:79] op_sel:[1,1,0] op_sel_hi:[1,0,1] neg_lo:[0,1,0] neg_hi:[0,0,0]
v_pk_mul_f32 v[78:79], v[54:55], v[204:205] op_sel:[0,0] op_sel_hi:[0,1] neg_lo:[0,0] neg_hi:[0,0]
v_pk_fma_f32 v[54:55], v[54:55], v[204:205], v[78:79] op_sel:[1,1,0] op_sel_hi:[1,0,1] neg_lo:[0,1,0] neg_hi:[0,0,0]
v_pk_mul_f32 v[78:79], v[58:59], v[206:207] op_sel:[0,0] op_sel_hi:[0,1] neg_lo:[0,0] neg_hi:[0,0]
v_pk_fma_f32 v[58:59], v[58:59], v[206:207], v[78:79] op_sel:[1,1,0] op_sel_hi:[1,0,1] neg_lo:[0,1,0] neg_hi:[0,0,0]
ds_write_b64 v4, v[16:17] offset:0
ds_write_b64 v4, v[48:49] offset:16
ds_write_b64 v4, v[18:19] offset:32
ds_write_b64 v4, v[22:23] offset:48
ds_write_b64 v4, v[26:27] offset:64
ds_write_b64 v4, v[38:39] offset:80
ds_write_b64 v4, v[28:29] offset:96
ds_write_b64 v4, v[36:37] offset:112
ds_write_b64 v4, v[42:43] offset:128
ds_write_b64 v4, v[70:71] offset:144
ds_write_b64 v4, v[60:61] offset:160
ds_write_b64 v4, v[68:69] offset:176
ds_write_b64 v4, v[40:41] offset:192
ds_write_b64 v4, v[56:57] offset:208
ds_write_b64 v4, v[62:63] offset:224
ds_write_b64 v4, v[66:67] offset:240
ds_write_b64 v4, v[74:75] offset:256
ds_write_b64 v4, v[76:77] offset:272
ds_write_b64 v4, v[72:73] offset:288
ds_write_b64 v4, v[20:21] offset:304
ds_write_b64 v4, v[64:65] offset:320
ds_write_b64 v4, v[24:25] offset:336
ds_write_b64 v4, v[30:31] offset:352
ds_write_b64 v4, v[34:35] offset:368
ds_write_b64 v4, v[14:15] offset:384
ds_write_b64 v4, v[32:33] offset:400
ds_write_b64 v4, v[46:47] offset:416
ds_write_b64 v4, v[50:51] offset:432
ds_write_b64 v4, v[44:45] offset:448
ds_write_b64 v4, v[52:53] offset:464
ds_write_b64 v4, v[54:55] offset:480
ds_write_b64 v4, v[58:59] offset:496
s_waitcnt lgkmcnt(0)
ds_read_b64 v[16:17], v3 offset:0
ds_read_b64 v[48:49], v3 offset:8448
ds_read_b64 v[18:19], v3 offset:528
ds_read_b64 v[50:51], v3 offset:8976
ds_read_b64 v[20:21], v3 offset:1056
ds_read_b64 v[52:53], v3 offset:9504
ds_read_b64 v[22:23], v3 offset:1584
ds_read_b64 v[54:55], v3 offset:10032
ds_read_b64 v[24:25], v3 offset:2112
ds_read_b64 v[56:57], v3 offset:10560
ds_read_b64 v[26:27], v3 offset:2640
ds_read_b64 v[58:59], v3 offset:11088
ds_read_b64 v[28:29], v3 offset:3168
ds_read_b64 v[60:61], v3 offset:11616
ds_read_b64 v[30:31], v3 offset:3696
ds_read_b64 v[62:63], v3 offset:12144
ds_read_b64 v[32:33], v3 offset:4224
ds_read_b64 v[64:65], v3 offset:12672
ds_read_b64 v[34:35], v3 offset:4752
ds_read_b64 v[66:67], v3 offset:13200
ds_read_b64 v[36:37], v3 offset:5280
ds_read_b64 v[68:69], v3 offset:13728
ds_read_b64 v[38:39], v3 offset:5808
ds_read_b64 v[70:71], v3 offset:14256
ds_read_b64 v[40:41], v3 offset:6336
ds_read_b64 v[72:73], v3 offset:14784
ds_read_b64 v[42:43], v3 offset:6864
ds_read_b64 v[74:75], v3 offset:15312
ds_read_b64 v[44:45], v3 offset:7392
ds_read_b64 v[76:77], v3 offset:15840
ds_read_b64 v[46:47], v3 offset:7920
ds_read_b64 v[78:79], v3 offset:16368
s_waitcnt lgkmcnt(0)
v_pk_add_f32 v[14:15], v[16:17], v[48:49] neg_lo:[0,1] neg_hi:[0,1]
v_pk_add_f32 v[16:17], v[16:17], v[48:49]
v_pk_add_f32 v[48:49], v[18:19], v[50:51] neg_lo:[0,1] neg_hi:[0,1]
v_pk_add_f32 v[18:19], v[18:19], v[50:51]
v_pk_mul_f32 v[50:51], v[48:49], s[50:51] op_sel:[0,0] op_sel_hi:[0,1] neg_lo:[0,0] neg_hi:[0,0]
v_pk_fma_f32 v[50:51], v[48:49], s[50:51], v[50:51] op_sel:[1,1,0] op_sel_hi:[1,0,1] neg_lo:[0,1,0] neg_hi:[0,0,0]
v_pk_add_f32 v[48:49], v[20:21], v[52:53] neg_lo:[0,1] neg_hi:[0,1]
v_pk_add_f32 v[20:21], v[20:21], v[52:53]
v_pk_mul_f32 v[52:53], v[48:49], s[54:55] op_sel:[0,0] op_sel_hi:[0,1] neg_lo:[0,0] neg_hi:[0,0]
v_pk_fma_f32 v[52:53], v[48:49], s[54:55], v[52:53] op_sel:[1,1,0] op_sel_hi:[1,0,1] neg_lo:[0,1,0] neg_hi:[0,0,0]
v_pk_add_f32 v[48:49], v[22:23], v[54:55] neg_lo:[0,1] neg_hi:[0,1]
v_pk_add_f32 v[22:23], v[22:23], v[54:55]
v_pk_mul_f32 v[54:55], v[48:49], s[58:59] op_sel:[0,0] op_sel_hi:[0,1] neg_lo:[0,0] neg_hi:[0,0]
v_pk_fma_f32 v[54:55], v[48:49], s[58:59], v[54:55] op_sel:[1,1,0] op_sel_hi:[1,0,1] neg_lo:[0,1,0] neg_hi:[0,0,0]
v_pk_add_f32 v[48:49], v[24:25], v[56:57] neg_lo:[0,1] neg_hi:[0,1]
v_pk_add_f32 v[24:25], v[24:25], v[56:57]
v_pk_mul_f32 v[56:57], v[48:49], s[62:63] op_sel:[0,0] op_sel_hi:[0,1] neg_lo:[0,0] neg_hi:[0,0]
v_pk_fma_f32 v[56:57], v[48:49], s[62:63], v[56:57] op_sel:[1,1,0] op_sel_hi:[1,0,1] neg_lo:[0,1,0] neg_hi:[0,0,0]
v_pk_add_f32 v[48:49], v[26:27], v[58:59] neg_lo:[0,1] neg_hi:[0,1]
v_pk_add_f32 v[26:27], v[26:27], v[58:59]
v_pk_mul_f32 v[58:59], v[48:49], s[58:59] op_sel:[0,1] op_sel_hi:[0,0] neg_lo:[0,0] neg_hi:[0,0]
v_pk_fma_f32 v[58:59], v[48:49], s[58:59], v[58:59] op_sel:[1,0,0] op_sel_hi:[1,1,1] neg_lo:[0,1,0] neg_hi:[0,0,0]
v_pk_add_f32 v[48:49], v[28:29], v[60:61] neg_lo:[0,1] neg_hi:[0,1]
v_pk_add_f32 v[28:29], v[28:29], v[60:61]
v_pk_mul_f32 v[60:61], v[48:49], s[54:55] op_sel:[0,1] op_sel_hi:[0,0] neg_lo:[0,0] neg_hi:[0,0]
v_pk_fma_f32 v[60:61], v[48:49], s[54:55], v[60:61] op_sel:[1,0,0] op_sel_hi:[1,1,1] neg_lo:[0,1,0] neg_hi:[0,0,0]
v_pk_add_f32 v[48:49], v[30:31], v[62:63] neg_lo:[0,1] neg_hi:[0,1]
v_pk_add_f32 v[30:31], v[30:31], v[62:63]
v_pk_mul_f32 v[62:63], v[48:49], s[50:51] op_sel:[0,1] op_sel_hi:[0,0] neg_lo:[0,0] neg_hi:[0,0]
v_pk_fma_f32 v[62:63], v[48:49], s[50:51], v[62:63] op_sel:[1,0,0] op_sel_hi:[1,1,1] neg_lo:[0,1,0] neg_hi:[0,0,0]
v_pk_add_f32 v[48:49], v[32:33], v[64:65] op_sel:[1,1] op_sel_hi:[0,0] neg_lo:[1,0] neg_hi:[0,1]
v_pk_add_f32 v[32:33], v[32:33], v[64:65]
v_pk_add_f32 v[64:65], v[34:35], v[66:67] neg_lo:[0,1] neg_hi:[0,1]
v_pk_add_f32 v[34:35], v[34:35], v[66:67]
v_pk_mul_f32 v[66:67], v[64:65], s[50:51] op_sel:[0,1] op_sel_hi:[0,0] neg_lo:[0,1] neg_hi:[0,0]
v_pk_fma_f32 v[66:67], v[64:65], s[50:51], v[66:67] op_sel:[1,0,0] op_sel_hi:[1,1,1] neg_lo:[0,1,0] neg_hi:[0,1,0]
v_pk_add_f32 v[64:65], v[36:37], v[68:69] neg_lo:[0,1] neg_hi:[0,1]
v_pk_add_f32 v[36:37], v[36:37], v[68:69]
v_pk_mul_f32 v[68:69], v[64:65], s[54:55] op_sel:[0,1] op_sel_hi:[0,0] neg_lo:[0,1] neg_hi:[0,0]
v_pk_fma_f32 v[68:69], v[64:65], s[54:55], v[68:69] op_sel:[1,0,0] op_sel_hi:[1,1,1] neg_lo:[0,1,0] neg_hi:[0,1,0]
v_pk_add_f32 v[64:65], v[38:39], v[70:71] neg_lo:[0,1] neg_hi:[0,1]
v_pk_add_f32 v[38:39], v[38:39], v[70:71]
v_pk_mul_f32 v[70:71], v[64:65], s[58:59] op_sel:[0,1] op_sel_hi:[0,0] neg_lo:[0,1] neg_hi:[0,0]
v_pk_fma_f32 v[70:71], v[64:65], s[58:59], v[70:71] op_sel:[1,0,0] op_sel_hi:[1,1,1] neg_lo:[0,1,0] neg_hi:[0,1,0]
v_pk_add_f32 v[64:65], v[40:41], v[72:73] neg_lo:[0,1] neg_hi:[0,1]
v_pk_add_f32 v[40:41], v[40:41], v[72:73]
v_pk_mul_f32 v[72:73], v[64:65], s[62:63] op_sel:[0,0] op_sel_hi:[0,1] neg_lo:[0,1] neg_hi:[0,0]
v_pk_fma_f32 v[72:73], v[64:65], s[62:63], v[72:73] op_sel:[1,1,0] op_sel_hi:[1,0,1] neg_lo:[0,1,0] neg_hi:[0,1,0]
v_pk_add_f32 v[64:65], v[42:43], v[74:75] neg_lo:[0,1] neg_hi:[0,1]
v_pk_add_f32 v[42:43], v[42:43], v[74:75]
v_pk_mul_f32 v[74:75], v[64:65], s[58:59] op_sel:[0,0] op_sel_hi:[0,1] neg_lo:[0,1] neg_hi:[0,0]
v_pk_fma_f32 v[74:75], v[64:65], s[58:59], v[74:75] op_sel:[1,1,0] op_sel_hi:[1,0,1] neg_lo:[0,1,0] neg_hi:[0,1,0]
v_pk_add_f32 v[64:65], v[44:45], v[76:77] neg_lo:[0,1] neg_hi:[0,1]
v_pk_add_f32 v[44:45], v[44:45], v[76:77]
v_pk_mul_f32 v[76:77], v[64:65], s[54:55] op_sel:[0,0] op_sel_hi:[0,1] neg_lo:[0,1] neg_hi:[0,0]
v_pk_fma_f32 v[76:77], v[64:65], s[54:55], v[76:77] op_sel:[1,1,0] op_sel_hi:[1,0,1] neg_lo:[0,1,0] neg_hi:[0,1,0]
v_pk_add_f32 v[64:65], v[46:47], v[78:79] neg_lo:[0,1] neg_hi:[0,1]
v_pk_add_f32 v[46:47], v[46:47], v[78:79]
v_pk_mul_f32 v[78:79], v[64:65], s[50:51] op_sel:[0,0] op_sel_hi:[0,1] neg_lo:[0,1] neg_hi:[0,0]
v_pk_fma_f32 v[78:79], v[64:65], s[50:51], v[78:79] op_sel:[1,1,0] op_sel_hi:[1,0,1] neg_lo:[0,1,0] neg_hi:[0,1,0]
v_pk_add_f32 v[64:65], v[16:17], v[32:33] neg_lo:[0,1] neg_hi:[0,1]
v_pk_add_f32 v[16:17], v[16:17], v[32:33]
v_pk_add_f32 v[32:33], v[18:19], v[34:35] neg_lo:[0,1] neg_hi:[0,1]
v_pk_add_f32 v[18:19], v[18:19], v[34:35]
v_pk_mul_f32 v[34:35], v[32:33], s[54:55] op_sel:[0,0] op_sel_hi:[0,1] neg_lo:[0,0] neg_hi:[0,0]
v_pk_fma_f32 v[34:35], v[32:33], s[54:55], v[34:35] op_sel:[1,1,0] op_sel_hi:[1,0,1] neg_lo:[0,1,0] neg_hi:[0,0,0]
v_pk_add_f32 v[32:33], v[20:21], v[36:37] neg_lo:[0,1] neg_hi:[0,1]
v_pk_add_f32 v[20:21], v[20:21], v[36:37]
v_pk_mul_f32 v[36:37], v[32:33], s[62:63] op_sel:[0,0] op_sel_hi:[0,1] neg_lo:[0,0] neg_hi:[0,0]
v_pk_fma_f32 v[36:37], v[32:33], s[62:63], v[36:37] op_sel:[1,1,0] op_sel_hi:[1,0,1] neg_lo:[0,1,0] neg_hi:[0,0,0]
v_pk_add_f32 v[32:33], v[22:23], v[38:39] neg_lo:[0,1] neg_hi:[0,1]
v_pk_add_f32 v[22:23], v[22:23], v[38:39]
v_pk_mul_f32 v[38:39], v[32:33], s[54:55] op_sel:[0,1] op_sel_hi:[0,0] neg_lo:[0,0] neg_hi:[0,0]
v_pk_fma_f32 v[38:39], v[32:33], s[54:55], v[38:39] op_sel:[1,0,0] op_sel_hi:[1,1,1] neg_lo:[0,1,0] neg_hi:[0,0,0]
v_pk_add_f32 v[32:33], v[24:25], v[40:41] op_sel:[1,1] op_sel_hi:[0,0] neg_lo:[1,0] neg_hi:[0,1]
v_pk_add_f32 v[24:25], v[24:25], v[40:41]
v_pk_add_f32 v[40:41], v[26:27], v[42:43] neg_lo:[0,1] neg_hi:[0,1]
v_pk_add_f32 v[26:27], v[26:27], v[42:43]
v_pk_mul_f32 v[42:43], v[40:41], s[54:55] op_sel:[0,1] op_sel_hi:[0,0] neg_lo:[0,1] neg_hi:[0,0]
v_pk_fma_f32 v[42:43], v[40:41], s[54:55], v[42:43] op_sel:[1,0,0] op_sel_hi:[1,1,1] neg_lo:[0,1,0] neg_hi:[0,1,0]
v_pk_add_f32 v[40:41], v[28:29], v[44:45] neg_lo:[0,1] neg_hi:[0,1]
v_pk_add_f32 v[28:29], v[28:29], v[44:45]
v_pk_mul_f32 v[44:45], v[40:41], s[62:63] op_sel:[0,0] op_sel_hi:[0,1] neg_lo:[0,1] neg_hi:[0,0]
v_pk_fma_f32 v[44:45], v[40:41], s[62:63], v[44:45] op_sel:[1,1,0] op_sel_hi:[1,0,1] neg_lo:[0,1,0] neg_hi:[0,1,0]
v_pk_add_f32 v[40:41], v[30:31], v[46:47] neg_lo:[0,1] neg_hi:[0,1]
v_pk_add_f32 v[30:31], v[30:31], v[46:47]
v_pk_mul_f32 v[46:47], v[40:41], s[54:55] op_sel:[0,0] op_sel_hi:[0,1] neg_lo:[0,1] neg_hi:[0,0]
v_pk_fma_f32 v[46:47], v[40:41], s[54:55], v[46:47] op_sel:[1,1,0] op_sel_hi:[1,0,1] neg_lo:[0,1,0] neg_hi:[0,1,0]
v_pk_add_f32 v[40:41], v[14:15], v[48:49] neg_lo:[0,1] neg_hi:[0,1]
v_pk_add_f32 v[14:15], v[14:15], v[48:49]
v_pk_add_f32 v[48:49], v[50:51], v[66:67] neg_lo:[0,1] neg_hi:[0,1]
v_pk_add_f32 v[50:51], v[50:51], v[66:67]
v_pk_mul_f32 v[66:67], v[48:49], s[54:55] op_sel:[0,0] op_sel_hi:[0,1] neg_lo:[0,0] neg_hi:[0,0]
v_pk_fma_f32 v[66:67], v[48:49], s[54:55], v[66:67] op_sel:[1,1,0] op_sel_hi:[1,0,1] neg_lo:[0,1,0] neg_hi:[0,0,0]
v_pk_add_f32 v[48:49], v[52:53], v[68:69] neg_lo:[0,1] neg_hi:[0,1]
v_pk_add_f32 v[52:53], v[52:53], v[68:69]
v_pk_mul_f32 v[68:69], v[48:49], s[62:63] op_sel:[0,0] op_sel_hi:[0,1] neg_lo:[0,0] neg_hi:[0,0]
v_pk_fma_f32 v[68:69], v[48:49], s[62:63], v[68:69] op_sel:[1,1,0] op_sel_hi:[1,0,1] neg_lo:[0,1,0] neg_hi:[0,0,0]
v_pk_add_f32 v[48:49], v[54:55], v[70:71] neg_lo:[0,1] neg_hi:[0,1]
v_pk_add_f32 v[54:55], v[54:55], v[70:71]
v_pk_mul_f32 v[70:71], v[48:49], s[54:55] op_sel:[0,1] op_sel_hi:[0,0] neg_lo:[0,0] neg_hi:[0,0]
v_pk_fma_f32 v[70:71], v[48:49], s[54:55], v[70:71] op_sel:[1,0,0] op_sel_hi:[1,1,1] neg_lo:[0,1,0] neg_hi:[0,0,0]
v_pk_add_f32 v[48:49], v[56:57], v[72:73] op_sel:[1,1] op_sel_hi:[0,0] neg_lo:[1,0] neg_hi:[0,1]
v_pk_add_f32 v[56:57], v[56:57], v[72:73]
v_pk_add_f32 v[72:73], v[58:59], v[74:75] neg_lo:[0,1] neg_hi:[0,1]
v_pk_add_f32 v[58:59], v[58:59], v[74:75]
v_pk_mul_f32 v[74:75], v[72:73], s[54:55] op_sel:[0,1] op_sel_hi:[0,0] neg_lo:[0,1] neg_hi:[0,0]
v_pk_fma_f32 v[74:75], v[72:73], s[54:55], v[74:75] op_sel:[1,0,0] op_sel_hi:[1,1,1] neg_lo:[0,1,0] neg_hi:[0,1,0]
v_pk_add_f32 v[72:73], v[60:61], v[76:77] neg_lo:[0,1] neg_hi:[0,1]
v_pk_add_f32 v[60:61], v[60:61], v[76:77]
v_pk_mul_f32 v[76:77], v[72:73], s[62:63] op_sel:[0,0] op_sel_hi:[0,1] neg_lo:[0,1] neg_hi:[0,0]
v_pk_fma_f32 v[76:77], v[72:73], s[62:63], v[76:77] op_sel:[1,1,0] op_sel_hi:[1,0,1] neg_lo:[0,1,0] neg_hi:[0,1,0]
v_pk_add_f32 v[72:73], v[62:63], v[78:79] neg_lo:[0,1] neg_hi:[0,1]
v_pk_add_f32 v[62:63], v[62:63], v[78:79]
v_pk_mul_f32 v[78:79], v[72:73], s[54:55] op_sel:[0,0] op_sel_hi:[0,1] neg_lo:[0,1] neg_hi:[0,0]
v_pk_fma_f32 v[78:79], v[72:73], s[54:55], v[78:79] op_sel:[1,1,0] op_sel_hi:[1,0,1] neg_lo:[0,1,0] neg_hi:[0,1,0]
v_pk_add_f32 v[72:73], v[16:17], v[24:25] neg_lo:[0,1] neg_hi:[0,1]
v_pk_add_f32 v[16:17], v[16:17], v[24:25]
v_pk_add_f32 v[24:25], v[18:19], v[26:27] neg_lo:[0,1] neg_hi:[0,1]
v_pk_add_f32 v[18:19], v[18:19], v[26:27]
v_pk_mul_f32 v[26:27], v[24:25], s[62:63] op_sel:[0,0] op_sel_hi:[0,1] neg_lo:[0,0] neg_hi:[0,0]
v_pk_fma_f32 v[26:27], v[24:25], s[62:63], v[26:27] op_sel:[1,1,0] op_sel_hi:[1,0,1] neg_lo:[0,1,0] neg_hi:[0,0,0]
v_pk_add_f32 v[24:25], v[20:21], v[28:29] op_sel:[1,1] op_sel_hi:[0,0] neg_lo:[1,0] neg_hi:[0,1]
v_pk_add_f32 v[20:21], v[20:21], v[28:29]
v_pk_add_f32 v[28:29], v[22:23], v[30:31] neg_lo:[0,1] neg_hi:[0,1]
v_pk_add_f32 v[22:23], v[22:23], v[30:31]
v_pk_mul_f32 v[30:31], v[28:29], s[62:63] op_sel:[0,0] op_sel_hi:[0,1] neg_lo:[0,1] neg_hi:[0,0]
v_pk_fma_f32 v[30:31], v[28:29], s[62:63], v[30:31] op_sel:[1,1,0] op_sel_hi:[1,0,1] neg_lo:[0,1,0] neg_hi:[0,1,0]
v_pk_add_f32 v[28:29], v[64:65], v[32:33] neg_lo:[0,1] neg_hi:[0,1]
v_pk_add_f32 v[64:65], v[64:65], v[32:33]
v_pk_add_f32 v[32:33], v[34:35], v[42:43] neg_lo:[0,1] neg_hi:[0,1]
v_pk_add_f32 v[34:35], v[34:35], v[42:43]
v_pk_mul_f32 v[42:43], v[32:33], s[62:63] op_sel:[0,0] op_sel_hi:[0,1] neg_lo:[0,0] neg_hi:[0,0]
v_pk_fma_f32 v[42:43], v[32:33], s[62:63], v[42:43] op_sel:[1,1,0] op_sel_hi:[1,0,1] neg_lo:[0,1,0] neg_hi:[0,0,0]
v_pk_add_f32 v[32:33], v[36:37], v[44:45] op_sel:[1,1] op_sel_hi:[0,0] neg_lo:[1,0] neg_hi:[0,1]
v_pk_add_f32 v[36:37], v[36:37], v[44:45]
v_pk_add_f32 v[44:45], v[38:39], v[46:47] neg_lo:[0,1] neg_hi:[0,1]
v_pk_add_f32 v[38:39], v[38:39], v[46:47]
v_pk_mul_f32 v[46:47], v[44:45], s[62:63] op_sel:[0,0] op_sel_hi:[0,1] neg_lo:[0,1] neg_hi:[0,0]
v_pk_fma_f32 v[46:47], v[44:45], s[62:63], v[46:47] op_sel:[1,1,0] op_sel_hi:[1,0,1] neg_lo:[0,1,0] neg_hi:[0,1,0]
v_pk_add_f32 v[44:45], v[14:15], v[56:57] neg_lo:[0,1] neg_hi:[0,1]
v_pk_add_f32 v[14:15], v[14:15], v[56:57]
v_pk_add_f32 v[56:57], v[50:51], v[58:59] neg_lo:[0,1] neg_hi:[0,1]
v_pk_add_f32 v[50:51], v[50:51], v[58:59]
v_pk_mul_f32 v[58:59], v[56:57], s[62:63] op_sel:[0,0] op_sel_hi:[0,1] neg_lo:[0,0] neg_hi:[0,0]
v_pk_fma_f32 v[58:59], v[56:57], s[62:63], v[58:59] op_sel:[1,1,0] op_sel_hi:[1,0,1] neg_lo:[0,1,0] neg_hi:[0,0,0]
v_pk_add_f32 v[56:57], v[52:53], v[60:61] op_sel:[1,1] op_sel_hi:[0,0] neg_lo:[1,0] neg_hi:[0,1]
v_pk_add_f32 v[52:53], v[52:53], v[60:61]
v_pk_add_f32 v[60:61], v[54:55], v[62:63] neg_lo:[0,1] neg_hi:[0,1]
v_pk_add_f32 v[54:55], v[54:55], v[62:63]
v_pk_mul_f32 v[62:63], v[60:61], s[62:63] op_sel:[0,0] op_sel_hi:[0,1] neg_lo:[0,1] neg_hi:[0,0]
v_pk_fma_f32 v[62:63], v[60:61], s[62:63], v[62:63] op_sel:[1,1,0] op_sel_hi:[1,0,1] neg_lo:[0,1,0] neg_hi:[0,1,0]
v_pk_add_f32 v[60:61], v[40:41], v[48:49] neg_lo:[0,1] neg_hi:[0,1]
v_pk_add_f32 v[40:41], v[40:41], v[48:49]
v_pk_add_f32 v[48:49], v[66:67], v[74:75] neg_lo:[0,1] neg_hi:[0,1]
v_pk_add_f32 v[66:67], v[66:67], v[74:75]
v_pk_mul_f32 v[74:75], v[48:49], s[62:63] op_sel:[0,0] op_sel_hi:[0,1] neg_lo:[0,0] neg_hi:[0,0]
v_pk_fma_f32 v[74:75], v[48:49], s[62:63], v[74:75] op_sel:[1,1,0] op_sel_hi:[1,0,1] neg_lo:[0,1,0] neg_hi:[0,0,0]
v_pk_add_f32 v[48:49], v[68:69], v[76:77] op_sel:[1,1] op_sel_hi:[0,0] neg_lo:[1,0] neg_hi:[0,1]
v_pk_add_f32 v[68:69], v[68:69], v[76:77]
v_pk_add_f32 v[76:77], v[70:71], v[78:79] neg_lo:[0,1] neg_hi:[0,1]
v_pk_add_f32 v[70:71], v[70:71], v[78:79]
v_pk_mul_f32 v[78:79], v[76:77], s[62:63] op_sel:[0,0] op_sel_hi:[0,1] neg_lo:[0,1] neg_hi:[0,0]
v_pk_fma_f32 v[78:79], v[76:77], s[62:63], v[78:79] op_sel:[1,1,0] op_sel_hi:[1,0,1] neg_lo:[0,1,0] neg_hi:[0,1,0]
v_pk_add_f32 v[76:77], v[16:17], v[20:21] neg_lo:[0,1] neg_hi:[0,1]
v_pk_add_f32 v[16:17], v[16:17], v[20:21]
v_pk_add_f32 v[20:21], v[18:19], v[22:23] op_sel:[1,1] op_sel_hi:[0,0] neg_lo:[1,0] neg_hi:[0,1]
v_pk_add_f32 v[18:19], v[18:19], v[22:23]
v_pk_add_f32 v[22:23], v[72:73], v[24:25] neg_lo:[0,1] neg_hi:[0,1]
v_pk_add_f32 v[72:73], v[72:73], v[24:25]
v_pk_add_f32 v[24:25], v[26:27], v[30:31] op_sel:[1,1] op_sel_hi:[0,0] neg_lo:[1,0] neg_hi:[0,1]
v_pk_add_f32 v[26:27], v[26:27], v[30:31]
v_pk_add_f32 v[30:31], v[64:65], v[36:37] neg_lo:[0,1] neg_hi:[0,1]
v_pk_add_f32 v[64:65], v[64:65], v[36:37]
v_pk_add_f32 v[36:37], v[34:35], v[38:39] op_sel:[1,1] op_sel_hi:[0,0] neg_lo:[1,0] neg_hi:[0,1]
v_pk_add_f32 v[34:35], v[34:35], v[38:39]
v_pk_add_f32 v[38:39], v[28:29], v[32:33] neg_lo:[0,1] neg_hi:[0,1]
v_pk_add_f32 v[28:29], v[28:29], v[32:33]
v_pk_add_f32 v[32:33], v[42:43], v[46:47] op_sel:[1,1] op_sel_hi:[0,0] neg_lo:[1,0] neg_hi:[0,1]
v_pk_add_f32 v[42:43], v[42:43], v[46:47]
v_pk_add_f32 v[46:47], v[14:15], v[52:53] neg_lo:[0,1] neg_hi:[0,1]
v_pk_add_f32 v[14:15], v[14:15], v[52:53]
v_pk_add_f32 v[52:53], v[50:51], v[54:55] op_sel:[1,1] op_sel_hi:[0,0] neg_lo:[1,0] neg_hi:[0,1]
v_pk_add_f32 v[50:51], v[50:51], v[54:55]
v_pk_add_f32 v[54:55], v[44:45], v[56:57] neg_lo:[0,1] neg_hi:[0,1]
v_pk_add_f32 v[44:45], v[44:45], v[56:57]
v_pk_add_f32 v[56:57], v[58:59], v[62:63] op_sel:[1,1] op_sel_hi:[0,0] neg_lo:[1,0] neg_hi:[0,1]
v_pk_add_f32 v[58:59], v[58:59], v[62:63]
v_pk_add_f32 v[62:63], v[40:41], v[68:69] neg_lo:[0,1] neg_hi:[0,1]
v_pk_add_f32 v[40:41], v[40:41], v[68:69]
v_pk_add_f32 v[68:69], v[66:67], v[70:71] op_sel:[1,1] op_sel_hi:[0,0] neg_lo:[1,0] neg_hi:[0,1]
v_pk_add_f32 v[66:67], v[66:67], v[70:71]
v_pk_add_f32 v[70:71], v[60:61], v[48:49] neg_lo:[0,1] neg_hi:[0,1]
v_pk_add_f32 v[60:61], v[60:61], v[48:49]
v_pk_add_f32 v[48:49], v[74:75], v[78:79] op_sel:[1,1] op_sel_hi:[0,0] neg_lo:[1,0] neg_hi:[0,1]
v_pk_add_f32 v[74:75], v[74:75], v[78:79]
v_pk_add_f32 v[78:79], v[16:17], v[18:19] neg_lo:[0,1] neg_hi:[0,1]
v_pk_add_f32 v[16:17], v[16:17], v[18:19]
v_pk_add_f32 v[18:19], v[76:77], v[20:21] neg_lo:[0,1] neg_hi:[0,1]
v_pk_add_f32 v[76:77], v[76:77], v[20:21]
v_pk_add_f32 v[20:21], v[72:73], v[26:27] neg_lo:[0,1] neg_hi:[0,1]
v_pk_add_f32 v[72:73], v[72:73], v[26:27]
v_pk_add_f32 v[26:27], v[22:23], v[24:25] neg_lo:[0,1] neg_hi:[0,1]
v_pk_add_f32 v[22:23], v[22:23], v[24:25]
v_pk_add_f32 v[24:25], v[64:65], v[34:35] neg_lo:[0,1] neg_hi:[0,1]
v_pk_add_f32 v[64:65], v[64:65], v[34:35]
v_pk_add_f32 v[34:35], v[30:31], v[36:37] neg_lo:[0,1] neg_hi:[0,1]
v_pk_add_f32 v[30:31], v[30:31], v[36:37]
v_pk_add_f32 v[36:37], v[28:29], v[42:43] neg_lo:[0,1] neg_hi:[0,1]
v_pk_add_f32 v[28:29], v[28:29], v[42:43]
v_pk_add_f32 v[42:43], v[38:39], v[32:33] neg_lo:[0,1] neg_hi:[0,1]
v_pk_add_f32 v[38:39], v[38:39], v[32:33]
v_pk_add_f32 v[32:33], v[14:15], v[50:51] neg_lo:[0,1] neg_hi:[0,1]
v_pk_add_f32 v[14:15], v[14:15], v[50:51]
v_pk_add_f32 v[50:51], v[46:47], v[52:53] neg_lo:[0,1] neg_hi:[0,1]
v_pk_add_f32 v[46:47], v[46:47], v[52:53]
v_pk_add_f32 v[52:53], v[44:45], v[58:59] neg_lo:[0,1] neg_hi:[0,1]
v_pk_add_f32 v[44:45], v[44:45], v[58:59]
v_pk_add_f32 v[58:59], v[54:55], v[56:57] neg_lo:[0,1] neg_hi:[0,1]
v_pk_add_f32 v[54:55], v[54:55], v[56:57]
v_pk_add_f32 v[56:57], v[40:41], v[66:67] neg_lo:[0,1] neg_hi:[0,1]
v_pk_add_f32 v[40:41], v[40:41], v[66:67]
v_pk_add_f32 v[66:67], v[62:63], v[68:69] neg_lo:[0,1] neg_hi:[0,1]
v_pk_add_f32 v[62:63], v[62:63], v[68:69]
v_pk_add_f32 v[68:69], v[60:61], v[74:75] neg_lo:[0,1] neg_hi:[0,1]
v_pk_add_f32 v[60:61], v[60:61], v[74:75]
v_pk_add_f32 v[74:75], v[70:71], v[48:49] neg_lo:[0,1] neg_hi:[0,1]
v_pk_add_f32 v[70:71], v[70:71], v[48:49]
s_lshl_b32 s12, s38, 2
s_add_u32 s12, s12, s16
s_min_u32 s12, s12, 512
s_lshl_b32 s12, s12, 14
s_add_u32 s12, s12, 109051904
buffer_store_dwordx2 v[16:17], v5, s[84:87], s12 offen offset:0 sc1
buffer_store_dwordx2 v[14:15], v5, s[84:87], s12 offen offset:512 sc1
buffer_store_dwordx2 v[64:65], v5, s[84:87], s12 offen offset:1024 sc1
buffer_store_dwordx2 v[40:41], v5, s[84:87], s12 offen offset:1536 sc1
buffer_store_dwordx2 v[72:73], v5, s[84:87], s12 offen offset:2048 sc1
buffer_store_dwordx2 v[44:45], v5, s[84:87], s12 offen offset:2560 sc1
buffer_store_dwordx2 v[28:29], v5, s[84:87], s12 offen offset:3072 sc1
buffer_store_dwordx2 v[60:61], v5, s[84:87], s12 offen offset:3584 sc1
s_add_u32 s12, s12, 4096
buffer_store_dwordx2 v[76:77], v5, s[84:87], s12 offen offset:0 sc1
buffer_store_dwordx2 v[46:47], v5, s[84:87], s12 offen offset:512 sc1
buffer_store_dwordx2 v[30:31], v5, s[84:87], s12 offen offset:1024 sc1
buffer_store_dwordx2 v[62:63], v5, s[84:87], s12 offen offset:1536 sc1
buffer_store_dwordx2 v[22:23], v5, s[84:87], s12 offen offset:2048 sc1
buffer_store_dwordx2 v[54:55], v5, s[84:87], s12 offen offset:2560 sc1
buffer_store_dwordx2 v[38:39], v5, s[84:87], s12 offen offset:3072 sc1
buffer_store_dwordx2 v[70:71], v5, s[84:87], s12 offen offset:3584 sc1
s_add_u32 s12, s12, 4096
buffer_store_dwordx2 v[78:79], v5, s[84:87], s12 offen offset:0 sc1
buffer_store_dwordx2 v[32:33], v5, s[84:87], s12 offen offset:512 sc1
buffer_store_dwordx2 v[24:25], v5, s[84:87], s12 offen offset:1024 sc1
buffer_store_dwordx2 v[56:57], v5, s[84:87], s12 offen offset:1536 sc1
buffer_store_dwordx2 v[20:21], v5, s[84:87], s12 offen offset:2048 sc1
buffer_store_dwordx2 v[52:53], v5, s[84:87], s12 offen offset:2560 sc1
buffer_store_dwordx2 v[36:37], v5, s[84:87], s12 offen offset:3072 sc1
buffer_store_dwordx2 v[68:69], v5, s[84:87], s12 offen offset:3584 sc1
s_add_u32 s12, s12, 4096
buffer_store_dwordx2 v[18:19], v5, s[84:87], s12 offen offset:0 sc1
buffer_store_dwordx2 v[50:51], v5, s[84:87], s12 offen offset:512 sc1
buffer_store_dwordx2 v[34:35], v5, s[84:87], s12 offen offset:1024 sc1
buffer_store_dwordx2 v[66:67], v5, s[84:87], s12 offen offset:1536 sc1
buffer_store_dwordx2 v[26:27], v5, s[84:87], s12 offen offset:2048 sc1
buffer_store_dwordx2 v[58:59], v5, s[84:87], s12 offen offset:2560 sc1
buffer_store_dwordx2 v[42:43], v5, s[84:87], s12 offen offset:3072 sc1
buffer_store_dwordx2 v[74:75], v5, s[84:87], s12 offen offset:3584 sc1
s_add_u32 s12, s12, 4096
s_mov_b32 s38, s21
s_cmp_lt_u32 s38, s37
s_cbranch_scc1 mega_kernel_f2_l
mega_kernel_f2_e:
mega_kernel_f2e:
s_waitcnt vmcnt(0)
s_barrier
v_mov_b32 v1, 0
v_mov_b32 v2, 1
s_mov_b32 s82, 69259392
v_cmp_eq_u32 vcc, 0, v0
s_and_saveexec_b64 s[80:81], vcc
s_cbranch_execz mega_kernel_sg1
buffer_atomic_add v2, v1, s[84:87], s82 offen sc1
mega_kernel_sg1:
s_mov_b64 exec, s[80:81]
s_mov_b32 s64, 0
s_mov_b32 s65, 62
s_mov_b32 s66, 0
s_mov_b32 s67, 0
s_cmp_eq_u32 s91, 3
s_cbranch_scc1 mega_kernel_out
v_mov_b32 v1, 0
s_mov_b32 s82, 69259392
mega_kernel_w1:
s_sleep 8
buffer_load_dword v2, v1, s[84:87], s82 offen sc1
s_waitcnt vmcnt(0)
v_cmp_ne_u32 vcc, 95, v2
s_cbranch_vccnz mega_kernel_w1
s_mov_b32 s93, s92
s_load_dwordx2 s[4:5], s[0:1], 80
s_mov_b32 s48, 0x3f7ec46d
s_mov_b32 s49, 0x3dc8bd36
s_mov_b32 s50, 0x3f7b14be
s_mov_b32 s51, 0x3e47c5c2
s_mov_b32 s52, 0x3f74fa0b
s_mov_b32 s53, 0x3e94a031
s_mov_b32 s54, 0x3f6c835e
s_mov_b32 s55, 0x3ec3ef15
s_mov_b32 s56, 0x3f61c598
s_mov_b32 s57, 0x3ef15aea
s_mov_b32 s58, 0x3f54db31
s_mov_b32 s59, 0x3f0e39da
s_mov_b32 s60, 0x3f45e403
s_mov_b32 s61, 0x3f226799
s_mov_b32 s62, 0x3f3504f3
s_mov_b32 s63, 0x3f3504f3
v_and_b32 v1, 31, v0
v_lshrrev_b32 v2, 5, v0
v_cvt_f32_u32 v3, v1
v_mul_u32_u24 v10, 8448, v2
v_lshl_add_u32 v4, v1, 3, v10
v_mul_u32_u24 v5, 264, v1
v_add_u32 v5, v5, v10
v_and_b32 v11, 7, v0
v_lshrrev_b32 v9, 3, v0
v_mul_u32_u24 v10, 8448, v11
v_lshl_add_u32 v6, v9, 3, v10
v_lshlrev_b32 v7, 3, v9
v_sub_u32 v7, v10, v7
v_add_u32 v7, 4096, v7
v_lshlrev_b32 v8, 14, v9
v_lshl_add_u32 v8, v11, 4, v8
v_mul_f32 v12, 0x3a800000, v3
v_cos_f32 v82, v12
v_sin_f32 v83, v12
v_mul_f32 v12, 0x3b000000, v3
v_cos_f32 v84, v12
v_sin_f32 v85, v12
v_mul_f32 v12, 0x3b400000, v3
v_cos_f32 v86, v12
v_sin_f32 v87, v12
v_mul_f32 v12, 0x3b800000, v3
v_cos_f32 v88, v12
v_sin_f32 v89, v12
v_mul_f32 v12, 0x3ba00000, v3
v_cos_f32 v90, v12
v_sin_f32 v91, v12
v_mul_f32 v12, 0x3bc00000, v3
v_cos_f32 v92, v12
v_sin_f32 v93, v12
v_mul_f32 v12, 0x3be00000, v3
v_cos_f32 v94, v12
v_sin_f32 v95, v12
v_mul_f32 v12, 0x3c000000, v3
v_cos_f32 v96, v12
v_sin_f32 v97, v12
v_mul_f32 v12, 0x3c100000, v3
v_cos_f32 v98, v12
v_sin_f32 v99, v12
v_mul_f32 v12, 0x3c200000, v3
v_cos_f32 v100, v12
v_sin_f32 v101, v12
v_mul_f32 v12, 0x3c300000, v3
v_cos_f32 v102, v12
v_sin_f32 v103, v12
v_mul_f32 v12, 0x3c400000, v3
v_cos_f32 v104, v12
v_sin_f32 v105, v12
v_mul_f32 v12, 0x3c500000, v3
v_cos_f32 v106, v12
v_sin_f32 v107, v12
v_mul_f32 v12, 0x3c600000, v3
v_cos_f32 v108, v12
v_sin_f32 v109, v12
v_mul_f32 v12, 0x3c700000, v3
v_cos_f32 v110, v12
v_sin_f32 v111, v12
v_mul_f32 v12, 0x3c800000, v3
v_cos_f32 v112, v12
v_sin_f32 v113, v12
v_mul_f32 v12, 0x3c880000, v3
v_cos_f32 v114, v12
v_sin_f32 v115, v12
v_mul_f32 v12, 0x3c900000, v3
v_cos_f32 v116, v12
v_sin_f32 v117, v12
v_mul_f32 v12, 0x3c980000, v3
v_cos_f32 v118, v12
v_sin_f32 v119, v12
v_mul_f32 v12, 0x3ca00000, v3
v_cos_f32 v120, v12
v_sin_f32 v121, v12
v_mul_f32 v12, 0x3ca80000, v3
v_cos_f32 v122, v12
v_sin_f32 v123, v12
v_mul_f32 v12, 0x3cb00000, v3
v_cos_f32 v124, v12
v_sin_f32 v125, v12
v_mul_f32 v12, 0x3cb80000, v3
v_cos_f32 v126, v12
v_sin_f32 v127, v12
v_mul_f32 v12, 0x3cc00000, v3
v_cos_f32 v128, v12
v_sin_f32 v129, v12
v_mul_f32 v12, 0x3cc80000, v3
v_cos_f32 v130, v12
v_sin_f32 v131, v12
v_mul_f32 v12, 0x3cd00000, v3
v_cos_f32 v132, v12
v_sin_f32 v133, v12
v_mul_f32 v12, 0x3cd80000, v3
v_cos_f32 v134, v12
v_sin_f32 v135, v12
v_mul_f32 v12, 0x3ce00000, v3
v_cos_f32 v136, v12
v_sin_f32 v137, v12
v_mul_f32 v12, 0x3ce80000, v3
v_cos_f32 v138, v12
v_sin_f32 v139, v12
v_mul_f32 v12, 0x3cf00000, v3
v_cos_f32 v140, v12
v_sin_f32 v141, v12
v_mul_f32 v12, 0x3cf80000, v3
v_cos_f32 v142, v12
v_sin_f32 v143, v12
v_lshlrev_b32 v12, 2, v1
v_sub_u32 v12, v4, v12
v_and_b32 v10, 127, v0
v_lshrrev_b32 v11, 7, v0
v_lshlrev_b32 v2, 5, v10
v_lshl_add_u32 v2, v11, 12, v2
v_lshlrev_b32 v3, 4, v10
v_lshl_add_u32 v3, v11, 12, v3
v_add_u32 v3, 2048, v3
v_cmp_eq_u32 s[14:15], 0, v9
s_waitcnt lgkmcnt(0)
s_mov_b32 s6, 8388608
s_mov_b32 s7, 0x00020000
s_cmp_lt_u32 s93, 128
s_cbranch_scc0 mega_kernel_f3_e
s_lshl_b32 s12, s93, 7
s_add_u32 s12, s12, 109051904
buffer_load_dwordx4 v[144:147], v8, s[84:87], s12 offen sc1
s_add_u32 s12, s12, 524288
buffer_load_dwordx4 v[148:151], v8, s[84:87], s12 offen sc1
s_add_u32 s12, s12, 524288
buffer_load_dwordx4 v[152:155], v8, s[84:87], s12 offen sc1
s_add_u32 s12, s12, 524288
buffer_load_dwordx4 v[156:159], v8, s[84:87], s12 offen sc1
s_add_u32 s12, s12, 524288
buffer_load_dwordx4 v[160:163], v8, s[84:87], s12 offen sc1
s_add_u32 s12, s12, 524288
buffer_load_dwordx4 v[164:167], v8, s[84:87], s12 offen sc1
s_add_u32 s12, s12, 524288
buffer_load_dwordx4 v[168:171], v8, s[84:87], s12 offen sc1
s_add_u32 s12, s12, 524288
buffer_load_dwordx4 v[172:175], v8, s[84:87], s12 offen sc1
s_add_u32 s12, s12, 524288
buffer_load_dwordx4 v[176:179], v8, s[84:87], s12 offen sc1
s_add_u32 s12, s12, 524288
buffer_load_dwordx4 v[180:183], v8, s[84:87], s12 offen sc1
s_add_u32 s12, s12, 524288
buffer_load_dwordx4 v[184:187], v8, s[84:87], s12 offen sc1
s_add_u32 s12, s12, 524288
buffer_load_dwordx4 v[188:191], v8, s[84:87], s12 offen sc1
s_add_u32 s12, s12, 524288
buffer_load_dwordx4 v[192:195], v8, s[84:87], s12 offen sc1
s_add_u32 s12, s12, 524288
buffer_load_dwordx4 v[196:199], v8, s[84:87], s12 offen sc1
s_add_u32 s12, s12, 524288
buffer_load_dwordx4 v[200:203], v8, s[84:87], s12 offen sc1
s_add_u32 s12, s12, 524288
buffer_load_dwordx4 v[204:207], v8, s[84:87], s12 offen sc1
s_add_u32 s12, s12, 524288
buffer_load_dwordx4 v[208:211], v8, s[84:87], s12 offen sc1
s_add_u32 s12, s12, 524288
s_waitcnt vmcnt(0)
mega_kernel_f3_l:
s_add_u32 s21, s93, 64
s_cmp_lt_u32 s21, 128
s_cselect_b32 s22, s21, s93
s_waitcnt vmcnt(8)
s_barrier
v_cndmask_b32 v145, v145, 0, s[14:15]
v_cndmask_b32 v147, v147, 0, s[14:15]
v_cndmask_b32 v209, v209, 0, s[14:15]
v_cndmask_b32 v211, v211, 0, s[14:15]
v_pk_add_f32 v[16:17], v[144:145], v[146:147] op_sel:[0,1] op_sel_hi:[1,0] neg_lo:[0,1]
v_pk_add_f32 v[18:19], v[144:145], v[146:147] op_sel:[0,1] op_sel_hi:[1,0] neg_hi:[1,0]
ds_write_b64 v6, v[16:17] offset:0
ds_write_b64 v7, v[18:19] offset:4096
v_pk_add_f32 v[20:21], v[148:149], v[150:151] op_sel:[0,1] op_sel_hi:[1,0] neg_lo:[0,1]
v_pk_add_f32 v[22:23], v[148:149], v[150:151] op_sel:[0,1] op_sel_hi:[1,0] neg_hi:[1,0]
ds_write_b64 v6, v[20:21] offset:256
ds_write_b64 v7, v[22:23] offset:3840
v_pk_add_f32 v[24:25], v[152:153], v[154:155] op_sel:[0,1] op_sel_hi:[1,0] neg_lo:[0,1]
v_pk_add_f32 v[26:27], v[152:153], v[154:155] op_sel:[0,1] op_sel_hi:[1,0] neg_hi:[1,0]
ds_write_b64 v6, v[24:25] offset:512
ds_write_b64 v7, v[26:27] offset:3584
v_pk_add_f32 v[28:29], v[156:157], v[158:159] op_sel:[0,1] op_sel_hi:[1,0] neg_lo:[0,1]
v_pk_add_f32 v[30:31], v[156:157], v[158:159] op_sel:[0,1] op_sel_hi:[1,0] neg_hi:[1,0]
ds_write_b64 v6, v[28:29] offset:768
ds_write_b64 v7, v[30:31] offset:3328
v_pk_add_f32 v[32:33], v[160:161], v[162:163] op_sel:[0,1] op_sel_hi:[1,0] neg_lo:[0,1]
v_pk_add_f32 v[34:35], v[160:161], v[162:163] op_sel:[0,1] op_sel_hi:[1,0] neg_hi:[1,0]
ds_write_b64 v6, v[32:33] offset:1024
ds_write_b64 v7, v[34:35] offset:3072
v_pk_add_f32 v[36:37], v[164:165], v[166:167] op_sel:[0,1] op_sel_hi:[1,0] neg_lo:[0,1]
v_pk_add_f32 v[38:39], v[164:165], v[166:167] op_sel:[0,1] op_sel_hi:[1,0] neg_hi:[1,0]
ds_write_b64 v6, v[36:37] offset:1280
ds_write_b64 v7, v[38:39] offset:2816
v_pk_add_f32 v[40:41], v[168:169], v[170:171] op_sel:[0,1] op_sel_hi:[1,0] neg_lo:[0,1]
v_pk_add_f32 v[42:43], v[168:169], v[170:171] op_sel:[0,1] op_sel_hi:[1,0] neg_hi:[1,0]
ds_write_b64 v6, v[40:41] offset:1536
ds_write_b64 v7, v[42:43] offset:2560
v_pk_add_f32 v[44:45], v[172:173], v[174:175] op_sel:[0,1] op_sel_hi:[1,0] neg_lo:[0,1]
v_pk_add_f32 v[46:47], v[172:173], v[174:175] op_sel:[0,1] op_sel_hi:[1,0] neg_hi:[1,0]
ds_write_b64 v6, v[44:45] offset:1792
ds_write_b64 v7, v[46:47] offset:2304
v_pk_add_f32 v[48:49], v[176:177], v[178:179] op_sel:[0,1] op_sel_hi:[1,0] neg_lo:[0,1]
v_pk_add_f32 v[50:51], v[176:177], v[178:179] op_sel:[0,1] op_sel_hi:[1,0] neg_hi:[1,0]
ds_write_b64 v6, v[48:49] offset:2048
ds_write_b64 v7, v[50:51] offset:2048
v_pk_add_f32 v[52:53], v[180:181], v[182:183] op_sel:[0,1] op_sel_hi:[1,0] neg_lo:[0,1]
v_pk_add_f32 v[54:55], v[180:181], v[182:183] op_sel:[0,1] op_sel_hi:[1,0] neg_hi:[1,0]
ds_write_b64 v6, v[52:53] offset:2304
ds_write_b64 v7, v[54:55] offset:1792
v_pk_add_f32 v[56:57], v[184:185], v[186:187] op_sel:[0,1] op_sel_hi:[1,0] neg_lo:[0,1]
v_pk_add_f32 v[58:59], v[184:185], v[186:187] op_sel:[0,1] op_sel_hi:[1,0] neg_hi:[1,0]
ds_write_b64 v6, v[56:57] offset:2560
ds_write_b64 v7, v[58:59] offset:1536
v_pk_add_f32 v[60:61], v[188:189], v[190:191] op_sel:[0,1] op_sel_hi:[1,0] neg_lo:[0,1]
v_pk_add_f32 v[62:63], v[188:189], v[190:191] op_sel:[0,1] op_sel_hi:[1,0] neg_hi:[1,0]
ds_write_b64 v6, v[60:61] offset:2816
ds_write_b64 v7, v[62:63] offset:1280
v_pk_add_f32 v[64:65], v[192:193], v[194:195] op_sel:[0,1] op_sel_hi:[1,0] neg_lo:[0,1]
v_pk_add_f32 v[66:67], v[192:193], v[194:195] op_sel:[0,1] op_sel_hi:[1,0] neg_hi:[1,0]
ds_write_b64 v6, v[64:65] offset:3072
ds_write_b64 v7, v[66:67] offset:1024
v_pk_add_f32 v[68:69], v[196:197], v[198:199] op_sel:[0,1] op_sel_hi:[1,0] neg_lo:[0,1]
v_pk_add_f32 v[70:71], v[196:197], v[198:199] op_sel:[0,1] op_sel_hi:[1,0] neg_hi:[1,0]
ds_write_b64 v6, v[68:69] offset:3328
ds_write_b64 v7, v[70:71] offset:768
v_pk_add_f32 v[72:73], v[200:201], v[202:203] op_sel:[0,1] op_sel_hi:[1,0] neg_lo:[0,1]
v_pk_add_f32 v[74:75], v[200:201], v[202:203] op_sel:[0,1] op_sel_hi:[1,0] neg_hi:[1,0]
ds_write_b64 v6, v[72:73] offset:3584
ds_write_b64 v7, v[74:75] offset:512
s_waitcnt lgkmcnt(8)
v_pk_add_f32 v[76:77], v[204:205], v[206:207] op_sel:[0,1] op_sel_hi:[1,0] neg_lo:[0,1]
v_pk_add_f32 v[78:79], v[204:205], v[206:207] op_sel:[0,1] op_sel_hi:[1,0] neg_hi:[1,0]
ds_write_b64 v6, v[76:77] offset:3840
ds_write_b64 v7, v[78:79] offset:256
v_pk_add_f32 v[16:17], v[208:209], v[210:211] op_sel:[0,1] op_sel_hi:[1,0] neg_lo:[0,1]
v_pk_add_f32 v[18:19], v[208:209], v[210:211] op_sel:[0,1] op_sel_hi:[1,0] neg_hi:[1,0]
s_mov_b64 exec, s[14:15]
ds_write_b64 v6, v[16:17] offset:4096
s_mov_b64 exec, -1
s_lshl_b32 s12, s22, 7
s_add_u32 s12, s12, 109051904
buffer_load_dwordx4 v[144:147], v8, s[84:87], s12 offen sc1
s_add_u32 s12, s12, 524288
buffer_load_dwordx4 v[148:151], v8, s[84:87], s12 offen sc1
s_add_u32 s12, s12, 524288
buffer_load_dwordx4 v[152:155], v8, s[84:87], s12 offen sc1
s_add_u32 s12, s12, 524288
buffer_load_dwordx4 v[156:159], v8, s[84:87], s12 offen sc1
s_add_u32 s12, s12, 524288
buffer_load_dwordx4 v[160:163], v8, s[84:87], s12 offen sc1
s_add_u32 s12, s12, 524288
buffer_load_dwordx4 v[164:167], v8, s[84:87], s12 offen sc1
s_add_u32 s12, s12, 524288
buffer_load_dwordx4 v[168:171], v8, s[84:87], s12 offen sc1
s_add_u32 s12, s12, 524288
buffer_load_dwordx4 v[172:175], v8, s[84:87], s12 offen sc1
s_add_u32 s12, s12, 524288
buffer_load_dwordx4 v[176:179], v8, s[84:87], s12 offen sc1
s_add_u32 s12, s12, 524288
buffer_load_dwordx4 v[180:183], v8, s[84:87], s12 offen sc1
s_add_u32 s12, s12, 524288
buffer_load_dwordx4 v[184:187], v8, s[84:87], s12 offen sc1
s_add_u32 s12, s12, 524288
buffer_load_dwordx4 v[188:191], v8, s[84:87], s12 offen sc1
s_add_u32 s12, s12, 524288
buffer_load_dwordx4 v[192:195], v8, s[84:87], s12 offen sc1
s_add_u32 s12, s12, 524288
buffer_load_dwordx4 v[196:199], v8, s[84:87], s12 offen sc1
s_add_u32 s12, s12, 524288
buffer_load_dwordx4 v[200:203], v8, s[84:87], s12 offen sc1
s_add_u32 s12, s12, 524288
buffer_load_dwordx4 v[204:207], v8, s[84:87], s12 offen sc1
s_add_u32 s12, s12, 524288
buffer_load_dwordx4 v[208:211], v8, s[84:87], s12 offen sc1
s_add_u32 s12, s12, 524288
s_waitcnt lgkmcnt(0)
s_barrier
ds_read_b64 v[16:17], v4 offset:0
ds_read_b64 v[48:49], v4 offset:4096
ds_read_b64 v[18:19], v4 offset:256
ds_read_b64 v[50:51], v4 offset:4352
ds_read_b64 v[20:21], v4 offset:512
ds_read_b64 v[52:53], v4 offset:4608
ds_read_b64 v[22:23], v4 offset:768
ds_read_b64 v[54:55], v4 offset:4864
ds_read_b64 v[24:25], v4 offset:1024
ds_read_b64 v[56:57], v4 offset:5120
ds_read_b64 v[26:27], v4 offset:1280
ds_read_b64 v[58:59], v4 offset:5376
ds_read_b64 v[28:29], v4 offset:1536
ds_read_b64 v[60:61], v4 offset:5632
ds_read_b64 v[30:31], v4 offset:1792
ds_read_b64 v[62:63], v4 offset:5888
ds_read_b64 v[32:33], v4 offset:2048
ds_read_b64 v[64:65], v4 offset:6144
ds_read_b64 v[34:35], v4 offset:2304
ds_read_b64 v[66:67], v4 offset:6400
ds_read_b64 v[36:37], v4 offset:2560
ds_read_b64 v[68:69], v4 offset:6656
ds_read_b64 v[38:39], v4 offset:2816
ds_read_b64 v[70:71], v4 offset:6912
ds_read_b64 v[40:41], v4 offset:3072
ds_read_b64 v[72:73], v4 offset:7168
ds_read_b64 v[42:43], v4 offset:3328
ds_read_b64 v[74:75], v4 offset:7424
ds_read_b64 v[44:45], v4 offset:3584
ds_read_b64 v[76:77], v4 offset:7680
ds_read_b64 v[46:47], v4 offset:3840
ds_read_b64 v[78:79], v4 offset:7936
s_waitcnt lgkmcnt(0)
v_pk_add_f32 v[14:15], v[16:17], v[48:49] neg_lo:[0,1] neg_hi:[0,1]
v_pk_add_f32 v[16:17], v[16:17], v[48:49]
v_pk_add_f32 v[48:49], v[18:19], v[50:51] neg_lo:[0,1] neg_hi:[0,1]
v_pk_add_f32 v[18:19], v[18:19], v[50:51]
v_pk_mul_f32 v[50:51], v[48:49], s[50:51] op_sel:[0,0] op_sel_hi:[0,1] neg_lo:[0,0] neg_hi:[0,0]
v_pk_fma_f32 v[50:51], v[48:49], s[50:51], v[50:51] op_sel:[1,1,0] op_sel_hi:[1,0,1] neg_lo:[0,1,0] neg_hi:[0,0,0]
v_pk_add_f32 v[48:49], v[20:21], v[52:53] neg_lo:[0,1] neg_hi:[0,1]
v_pk_add_f32 v[20:21], v[20:21], v[52:53]
v_pk_mul_f32 v[52:53], v[48:49], s[54:55] op_sel:[0,0] op_sel_hi:[0,1] neg_lo:[0,0] neg_hi:[0,0]
v_pk_fma_f32 v[52:53], v[48:49], s[54:55], v[52:53] op_sel:[1,1,0] op_sel_hi:[1,0,1] neg_lo:[0,1,0] neg_hi:[0,0,0]
v_pk_add_f32 v[48:49], v[22:23], v[54:55] neg_lo:[0,1] neg_hi:[0,1]
v_pk_add_f32 v[22:23], v[22:23], v[54:55]
v_pk_mul_f32 v[54:55], v[48:49], s[58:59] op_sel:[0,0] op_sel_hi:[0,1] neg_lo:[0,0] neg_hi:[0,0]
v_pk_fma_f32 v[54:55], v[48:49], s[58:59], v[54:55] op_sel:[1,1,0] op_sel_hi:[1,0,1] neg_lo:[0,1,0] neg_hi:[0,0,0]
v_pk_add_f32 v[48:49], v[24:25], v[56:57] neg_lo:[0,1] neg_hi:[0,1]
v_pk_add_f32 v[24:25], v[24:25], v[56:57]
v_pk_mul_f32 v[56:57], v[48:49], s[62:63] op_sel:[0,0] op_sel_hi:[0,1] neg_lo:[0,0] neg_hi:[0,0]
v_pk_fma_f32 v[56:57], v[48:49], s[62:63], v[56:57] op_sel:[1,1,0] op_sel_hi:[1,0,1] neg_lo:[0,1,0] neg_hi:[0,0,0]
v_pk_add_f32 v[48:49], v[26:27], v[58:59] neg_lo:[0,1] neg_hi:[0,1]
v_pk_add_f32 v[26:27], v[26:27], v[58:59]
v_pk_mul_f32 v[58:59], v[48:49], s[58:59] op_sel:[0,1] op_sel_hi:[0,0] neg_lo:[0,0] neg_hi:[0,0]
v_pk_fma_f32 v[58:59], v[48:49], s[58:59], v[58:59] op_sel:[1,0,0] op_sel_hi:[1,1,1] neg_lo:[0,1,0] neg_hi:[0,0,0]
v_pk_add_f32 v[48:49], v[28:29], v[60:61] neg_lo:[0,1] neg_hi:[0,1]
v_pk_add_f32 v[28:29], v[28:29], v[60:61]
v_pk_mul_f32 v[60:61], v[48:49], s[54:55] op_sel:[0,1] op_sel_hi:[0,0] neg_lo:[0,0] neg_hi:[0,0]
v_pk_fma_f32 v[60:61], v[48:49], s[54:55], v[60:61] op_sel:[1,0,0] op_sel_hi:[1,1,1] neg_lo:[0,1,0] neg_hi:[0,0,0]
v_pk_add_f32 v[48:49], v[30:31], v[62:63] neg_lo:[0,1] neg_hi:[0,1]
v_pk_add_f32 v[30:31], v[30:31], v[62:63]
v_pk_mul_f32 v[62:63], v[48:49], s[50:51] op_sel:[0,1] op_sel_hi:[0,0] neg_lo:[0,0] neg_hi:[0,0]
v_pk_fma_f32 v[62:63], v[48:49], s[50:51], v[62:63] op_sel:[1,0,0] op_sel_hi:[1,1,1] neg_lo:[0,1,0] neg_hi:[0,0,0]
v_pk_add_f32 v[48:49], v[32:33], v[64:65] op_sel:[1,1] op_sel_hi:[0,0] neg_lo:[1,0] neg_hi:[0,1]
v_pk_add_f32 v[32:33], v[32:33], v[64:65]
v_pk_add_f32 v[64:65], v[34:35], v[66:67] neg_lo:[0,1] neg_hi:[0,1]
v_pk_add_f32 v[34:35], v[34:35], v[66:67]
v_pk_mul_f32 v[66:67], v[64:65], s[50:51] op_sel:[0,1] op_sel_hi:[0,0] neg_lo:[0,1] neg_hi:[0,0]
v_pk_fma_f32 v[66:67], v[64:65], s[50:51], v[66:67] op_sel:[1,0,0] op_sel_hi:[1,1,1] neg_lo:[0,1,0] neg_hi:[0,1,0]
v_pk_add_f32 v[64:65], v[36:37], v[68:69] neg_lo:[0,1] neg_hi:[0,1]
v_pk_add_f32 v[36:37], v[36:37], v[68:69]
v_pk_mul_f32 v[68:69], v[64:65], s[54:55] op_sel:[0,1] op_sel_hi:[0,0] neg_lo:[0,1] neg_hi:[0,0]
v_pk_fma_f32 v[68:69], v[64:65], s[54:55], v[68:69] op_sel:[1,0,0] op_sel_hi:[1,1,1] neg_lo:[0,1,0] neg_hi:[0,1,0]
v_pk_add_f32 v[64:65], v[38:39], v[70:71] neg_lo:[0,1] neg_hi:[0,1]
v_pk_add_f32 v[38:39], v[38:39], v[70:71]
v_pk_mul_f32 v[70:71], v[64:65], s[58:59] op_sel:[0,1] op_sel_hi:[0,0] neg_lo:[0,1] neg_hi:[0,0]
v_pk_fma_f32 v[70:71], v[64:65], s[58:59], v[70:71] op_sel:[1,0,0] op_sel_hi:[1,1,1] neg_lo:[0,1,0] neg_hi:[0,1,0]
v_pk_add_f32 v[64:65], v[40:41], v[72:73] neg_lo:[0,1] neg_hi:[0,1]
v_pk_add_f32 v[40:41], v[40:41], v[72:73]
v_pk_mul_f32 v[72:73], v[64:65], s[62:63] op_sel:[0,0] op_sel_hi:[0,1] neg_lo:[0,1] neg_hi:[0,0]
v_pk_fma_f32 v[72:73], v[64:65], s[62:63], v[72:73] op_sel:[1,1,0] op_sel_hi:[1,0,1] neg_lo:[0,1,0] neg_hi:[0,1,0]
v_pk_add_f32 v[64:65], v[42:43], v[74:75] neg_lo:[0,1] neg_hi:[0,1]
v_pk_add_f32 v[42:43], v[42:43], v[74:75]
v_pk_mul_f32 v[74:75], v[64:65], s[58:59] op_sel:[0,0] op_sel_hi:[0,1] neg_lo:[0,1] neg_hi:[0,0]
v_pk_fma_f32 v[74:75], v[64:65], s[58:59], v[74:75] op_sel:[1,1,0] op_sel_hi:[1,0,1] neg_lo:[0,1,0] neg_hi:[0,1,0]
v_pk_add_f32 v[64:65], v[44:45], v[76:77] neg_lo:[0,1] neg_hi:[0,1]
v_pk_add_f32 v[44:45], v[44:45], v[76:77]
v_pk_mul_f32 v[76:77], v[64:65], s[54:55] op_sel:[0,0] op_sel_hi:[0,1] neg_lo:[0,1] neg_hi:[0,0]
v_pk_fma_f32 v[76:77], v[64:65], s[54:55], v[76:77] op_sel:[1,1,0] op_sel_hi:[1,0,1] neg_lo:[0,1,0] neg_hi:[0,1,0]
v_pk_add_f32 v[64:65], v[46:47], v[78:79] neg_lo:[0,1] neg_hi:[0,1]
v_pk_add_f32 v[46:47], v[46:47], v[78:79]
v_pk_mul_f32 v[78:79], v[64:65], s[50:51] op_sel:[0,0] op_sel_hi:[0,1] neg_lo:[0,1] neg_hi:[0,0]
v_pk_fma_f32 v[78:79], v[64:65], s[50:51], v[78:79] op_sel:[1,1,0] op_sel_hi:[1,0,1] neg_lo:[0,1,0] neg_hi:[0,1,0]
v_pk_add_f32 v[64:65], v[16:17], v[32:33] neg_lo:[0,1] neg_hi:[0,1]
v_pk_add_f32 v[16:17], v[16:17], v[32:33]
v_pk_add_f32 v[32:33], v[18:19], v[34:35] neg_lo:[0,1] neg_hi:[0,1]
v_pk_add_f32 v[18:19], v[18:19], v[34:35]
v_pk_mul_f32 v[34:35], v[32:33], s[54:55] op_sel:[0,0] op_sel_hi:[0,1] neg_lo:[0,0] neg_hi:[0,0]
v_pk_fma_f32 v[34:35], v[32:33], s[54:55], v[34:35] op_sel:[1,1,0] op_sel_hi:[1,0,1] neg_lo:[0,1,0] neg_hi:[0,0,0]
v_pk_add_f32 v[32:33], v[20:21], v[36:37] neg_lo:[0,1] neg_hi:[0,1]
v_pk_add_f32 v[20:21], v[20:21], v[36:37]
v_pk_mul_f32 v[36:37], v[32:33], s[62:63] op_sel:[0,0] op_sel_hi:[0,1] neg_lo:[0,0] neg_hi:[0,0]
v_pk_fma_f32 v[36:37], v[32:33], s[62:63], v[36:37] op_sel:[1,1,0] op_sel_hi:[1,0,1] neg_lo:[0,1,0] neg_hi:[0,0,0]
v_pk_add_f32 v[32:33], v[22:23], v[38:39] neg_lo:[0,1] neg_hi:[0,1]
v_pk_add_f32 v[22:23], v[22:23], v[38:39]
v_pk_mul_f32 v[38:39], v[32:33], s[54:55] op_sel:[0,1] op_sel_hi:[0,0] neg_lo:[0,0] neg_hi:[0,0]
v_pk_fma_f32 v[38:39], v[32:33], s[54:55], v[38:39] op_sel:[1,0,0] op_sel_hi:[1,1,1] neg_lo:[0,1,0] neg_hi:[0,0,0]
v_pk_add_f32 v[32:33], v[24:25], v[40:41] op_sel:[1,1] op_sel_hi:[0,0] neg_lo:[1,0] neg_hi:[0,1]
v_pk_add_f32 v[24:25], v[24:25], v[40:41]
v_pk_add_f32 v[40:41], v[26:27], v[42:43] neg_lo:[0,1] neg_hi:[0,1]
v_pk_add_f32 v[26:27], v[26:27], v[42:43]
v_pk_mul_f32 v[42:43], v[40:41], s[54:55] op_sel:[0,1] op_sel_hi:[0,0] neg_lo:[0,1] neg_hi:[0,0]
v_pk_fma_f32 v[42:43], v[40:41], s[54:55], v[42:43] op_sel:[1,0,0] op_sel_hi:[1,1,1] neg_lo:[0,1,0] neg_hi:[0,1,0]
v_pk_add_f32 v[40:41], v[28:29], v[44:45] neg_lo:[0,1] neg_hi:[0,1]
v_pk_add_f32 v[28:29], v[28:29], v[44:45]
v_pk_mul_f32 v[44:45], v[40:41], s[62:63] op_sel:[0,0] op_sel_hi:[0,1] neg_lo:[0,1] neg_hi:[0,0]
v_pk_fma_f32 v[44:45], v[40:41], s[62:63], v[44:45] op_sel:[1,1,0] op_sel_hi:[1,0,1] neg_lo:[0,1,0] neg_hi:[0,1,0]
v_pk_add_f32 v[40:41], v[30:31], v[46:47] neg_lo:[0,1] neg_hi:[0,1]
v_pk_add_f32 v[30:31], v[30:31], v[46:47]
v_pk_mul_f32 v[46:47], v[40:41], s[54:55] op_sel:[0,0] op_sel_hi:[0,1] neg_lo:[0,1] neg_hi:[0,0]
v_pk_fma_f32 v[46:47], v[40:41], s[54:55], v[46:47] op_sel:[1,1,0] op_sel_hi:[1,0,1] neg_lo:[0,1,0] neg_hi:[0,1,0]
v_pk_add_f32 v[40:41], v[14:15], v[48:49] neg_lo:[0,1] neg_hi:[0,1]
v_pk_add_f32 v[14:15], v[14:15], v[48:49]
v_pk_add_f32 v[48:49], v[50:51], v[66:67] neg_lo:[0,1] neg_hi:[0,1]
v_pk_add_f32 v[50:51], v[50:51], v[66:67]
v_pk_mul_f32 v[66:67], v[48:49], s[54:55] op_sel:[0,0] op_sel_hi:[0,1] neg_lo:[0,0] neg_hi:[0,0]
v_pk_fma_f32 v[66:67], v[48:49], s[54:55], v[66:67] op_sel:[1,1,0] op_sel_hi:[1,0,1] neg_lo:[0,1,0] neg_hi:[0,0,0]
v_pk_add_f32 v[48:49], v[52:53], v[68:69] neg_lo:[0,1] neg_hi:[0,1]
v_pk_add_f32 v[52:53], v[52:53], v[68:69]
v_pk_mul_f32 v[68:69], v[48:49], s[62:63] op_sel:[0,0] op_sel_hi:[0,1] neg_lo:[0,0] neg_hi:[0,0]
v_pk_fma_f32 v[68:69], v[48:49], s[62:63], v[68:69] op_sel:[1,1,0] op_sel_hi:[1,0,1] neg_lo:[0,1,0] neg_hi:[0,0,0]
v_pk_add_f32 v[48:49], v[54:55], v[70:71] neg_lo:[0,1] neg_hi:[0,1]
v_pk_add_f32 v[54:55], v[54:55], v[70:71]
v_pk_mul_f32 v[70:71], v[48:49], s[54:55] op_sel:[0,1] op_sel_hi:[0,0] neg_lo:[0,0] neg_hi:[0,0]
v_pk_fma_f32 v[70:71], v[48:49], s[54:55], v[70:71] op_sel:[1,0,0] op_sel_hi:[1,1,1] neg_lo:[0,1,0] neg_hi:[0,0,0]
v_pk_add_f32 v[48:49], v[56:57], v[72:73] op_sel:[1,1] op_sel_hi:[0,0] neg_lo:[1,0] neg_hi:[0,1]
v_pk_add_f32 v[56:57], v[56:57], v[72:73]
v_pk_add_f32 v[72:73], v[58:59], v[74:75] neg_lo:[0,1] neg_hi:[0,1]
v_pk_add_f32 v[58:59], v[58:59], v[74:75]
v_pk_mul_f32 v[74:75], v[72:73], s[54:55] op_sel:[0,1] op_sel_hi:[0,0] neg_lo:[0,1] neg_hi:[0,0]
v_pk_fma_f32 v[74:75], v[72:73], s[54:55], v[74:75] op_sel:[1,0,0] op_sel_hi:[1,1,1] neg_lo:[0,1,0] neg_hi:[0,1,0]
v_pk_add_f32 v[72:73], v[60:61], v[76:77] neg_lo:[0,1] neg_hi:[0,1]
v_pk_add_f32 v[60:61], v[60:61], v[76:77]
v_pk_mul_f32 v[76:77], v[72:73], s[62:63] op_sel:[0,0] op_sel_hi:[0,1] neg_lo:[0,1] neg_hi:[0,0]
v_pk_fma_f32 v[76:77], v[72:73], s[62:63], v[76:77] op_sel:[1,1,0] op_sel_hi:[1,0,1] neg_lo:[0,1,0] neg_hi:[0,1,0]
v_pk_add_f32 v[72:73], v[62:63], v[78:79] neg_lo:[0,1] neg_hi:[0,1]
v_pk_add_f32 v[62:63], v[62:63], v[78:79]
v_pk_mul_f32 v[78:79], v[72:73], s[54:55] op_sel:[0,0] op_sel_hi:[0,1] neg_lo:[0,1] neg_hi:[0,0]
v_pk_fma_f32 v[78:79], v[72:73], s[54:55], v[78:79] op_sel:[1,1,0] op_sel_hi:[1,0,1] neg_lo:[0,1,0] neg_hi:[0,1,0]
v_pk_add_f32 v[72:73], v[16:17], v[24:25] neg_lo:[0,1] neg_hi:[0,1]
v_pk_add_f32 v[16:17], v[16:17], v[24:25]
v_pk_add_f32 v[24:25], v[18:19], v[26:27] neg_lo:[0,1] neg_hi:[0,1]
v_pk_add_f32 v[18:19], v[18:19], v[26:27]
v_pk_mul_f32 v[26:27], v[24:25], s[62:63] op_sel:[0,0] op_sel_hi:[0,1] neg_lo:[0,0] neg_hi:[0,0]
v_pk_fma_f32 v[26:27], v[24:25], s[62:63], v[26:27] op_sel:[1,1,0] op_sel_hi:[1,0,1] neg_lo:[0,1,0] neg_hi:[0,0,0]
v_pk_add_f32 v[24:25], v[20:21], v[28:29] op_sel:[1,1] op_sel_hi:[0,0] neg_lo:[1,0] neg_hi:[0,1]
v_pk_add_f32 v[20:21], v[20:21], v[28:29]
v_pk_add_f32 v[28:29], v[22:23], v[30:31] neg_lo:[0,1] neg_hi:[0,1]
v_pk_add_f32 v[22:23], v[22:23], v[30:31]
v_pk_mul_f32 v[30:31], v[28:29], s[62:63] op_sel:[0,0] op_sel_hi:[0,1] neg_lo:[0,1] neg_hi:[0,0]
v_pk_fma_f32 v[30:31], v[28:29], s[62:63], v[30:31] op_sel:[1,1,0] op_sel_hi:[1,0,1] neg_lo:[0,1,0] neg_hi:[0,1,0]
v_pk_add_f32 v[28:29], v[64:65], v[32:33] neg_lo:[0,1] neg_hi:[0,1]
v_pk_add_f32 v[64:65], v[64:65], v[32:33]
v_pk_add_f32 v[32:33], v[34:35], v[42:43] neg_lo:[0,1] neg_hi:[0,1]
v_pk_add_f32 v[34:35], v[34:35], v[42:43]
v_pk_mul_f32 v[42:43], v[32:33], s[62:63] op_sel:[0,0] op_sel_hi:[0,1] neg_lo:[0,0] neg_hi:[0,0]
v_pk_fma_f32 v[42:43], v[32:33], s[62:63], v[42:43] op_sel:[1,1,0] op_sel_hi:[1,0,1] neg_lo:[0,1,0] neg_hi:[0,0,0]
v_pk_add_f32 v[32:33], v[36:37], v[44:45] op_sel:[1,1] op_sel_hi:[0,0] neg_lo:[1,0] neg_hi:[0,1]
v_pk_add_f32 v[36:37], v[36:37], v[44:45]
v_pk_add_f32 v[44:45], v[38:39], v[46:47] neg_lo:[0,1] neg_hi:[0,1]
v_pk_add_f32 v[38:39], v[38:39], v[46:47]
v_pk_mul_f32 v[46:47], v[44:45], s[62:63] op_sel:[0,0] op_sel_hi:[0,1] neg_lo:[0,1] neg_hi:[0,0]
v_pk_fma_f32 v[46:47], v[44:45], s[62:63], v[46:47] op_sel:[1,1,0] op_sel_hi:[1,0,1] neg_lo:[0,1,0] neg_hi:[0,1,0]
v_pk_add_f32 v[44:45], v[14:15], v[56:57] neg_lo:[0,1] neg_hi:[0,1]
v_pk_add_f32 v[14:15], v[14:15], v[56:57]
v_pk_add_f32 v[56:57], v[50:51], v[58:59] neg_lo:[0,1] neg_hi:[0,1]
v_pk_add_f32 v[50:51], v[50:51], v[58:59]
v_pk_mul_f32 v[58:59], v[56:57], s[62:63] op_sel:[0,0] op_sel_hi:[0,1] neg_lo:[0,0] neg_hi:[0,0]
v_pk_fma_f32 v[58:59], v[56:57], s[62:63], v[58:59] op_sel:[1,1,0] op_sel_hi:[1,0,1] neg_lo:[0,1,0] neg_hi:[0,0,0]
v_pk_add_f32 v[56:57], v[52:53], v[60:61] op_sel:[1,1] op_sel_hi:[0,0] neg_lo:[1,0] neg_hi:[0,1]
v_pk_add_f32 v[52:53], v[52:53], v[60:61]
v_pk_add_f32 v[60:61], v[54:55], v[62:63] neg_lo:[0,1] neg_hi:[0,1]
v_pk_add_f32 v[54:55], v[54:55], v[62:63]
v_pk_mul_f32 v[62:63], v[60:61], s[62:63] op_sel:[0,0] op_sel_hi:[0,1] neg_lo:[0,1] neg_hi:[0,0]
v_pk_fma_f32 v[62:63], v[60:61], s[62:63], v[62:63] op_sel:[1,1,0] op_sel_hi:[1,0,1] neg_lo:[0,1,0] neg_hi:[0,1,0]
v_pk_add_f32 v[60:61], v[40:41], v[48:49] neg_lo:[0,1] neg_hi:[0,1]
v_pk_add_f32 v[40:41], v[40:41], v[48:49]
v_pk_add_f32 v[48:49], v[66:67], v[74:75] neg_lo:[0,1] neg_hi:[0,1]
v_pk_add_f32 v[66:67], v[66:67], v[74:75]
v_pk_mul_f32 v[74:75], v[48:49], s[62:63] op_sel:[0,0] op_sel_hi:[0,1] neg_lo:[0,0] neg_hi:[0,0]
v_pk_fma_f32 v[74:75], v[48:49], s[62:63], v[74:75] op_sel:[1,1,0] op_sel_hi:[1,0,1] neg_lo:[0,1,0] neg_hi:[0,0,0]
v_pk_add_f32 v[48:49], v[68:69], v[76:77] op_sel:[1,1] op_sel_hi:[0,0] neg_lo:[1,0] neg_hi:[0,1]
v_pk_add_f32 v[68:69], v[68:69], v[76:77]
v_pk_add_f32 v[76:77], v[70:71], v[78:79] neg_lo:[0,1] neg_hi:[0,1]
v_pk_add_f32 v[70:71], v[70:71], v[78:79]
v_pk_mul_f32 v[78:79], v[76:77], s[62:63] op_sel:[0,0] op_sel_hi:[0,1] neg_lo:[0,1] neg_hi:[0,0]
v_pk_fma_f32 v[78:79], v[76:77], s[62:63], v[78:79] op_sel:[1,1,0] op_sel_hi:[1,0,1] neg_lo:[0,1,0] neg_hi:[0,1,0]
v_pk_add_f32 v[76:77], v[16:17], v[20:21] neg_lo:[0,1] neg_hi:[0,1]
v_pk_add_f32 v[16:17], v[16:17], v[20:21]
v_pk_add_f32 v[20:21], v[18:19], v[22:23] op_sel:[1,1] op_sel_hi:[0,0] neg_lo:[1,0] neg_hi:[0,1]
v_pk_add_f32 v[18:19], v[18:19], v[22:23]
v_pk_add_f32 v[22:23], v[72:73], v[24:25] neg_lo:[0,1] neg_hi:[0,1]
v_pk_add_f32 v[72:73], v[72:73], v[24:25]
v_pk_add_f32 v[24:25], v[26:27], v[30:31] op_sel:[1,1] op_sel_hi:[0,0] neg_lo:[1,0] neg_hi:[0,1]
v_pk_add_f32 v[26:27], v[26:27], v[30:31]
v_pk_add_f32 v[30:31], v[64:65], v[36:37] neg_lo:[0,1] neg_hi:[0,1]
v_pk_add_f32 v[64:65], v[64:65], v[36:37]
v_pk_add_f32 v[36:37], v[34:35], v[38:39] op_sel:[1,1] op_sel_hi:[0,0] neg_lo:[1,0] neg_hi:[0,1]
v_pk_add_f32 v[34:35], v[34:35], v[38:39]
v_pk_add_f32 v[38:39], v[28:29], v[32:33] neg_lo:[0,1] neg_hi:[0,1]
v_pk_add_f32 v[28:29], v[28:29], v[32:33]
v_pk_add_f32 v[32:33], v[42:43], v[46:47] op_sel:[1,1] op_sel_hi:[0,0] neg_lo:[1,0] neg_hi:[0,1]
v_pk_add_f32 v[42:43], v[42:43], v[46:47]
v_pk_add_f32 v[46:47], v[14:15], v[52:53] neg_lo:[0,1] neg_hi:[0,1]
v_pk_add_f32 v[14:15], v[14:15], v[52:53]
v_pk_add_f32 v[52:53], v[50:51], v[54:55] op_sel:[1,1] op_sel_hi:[0,0] neg_lo:[1,0] neg_hi:[0,1]
v_pk_add_f32 v[50:51], v[50:51], v[54:55]
v_pk_add_f32 v[54:55], v[44:45], v[56:57] neg_lo:[0,1] neg_hi:[0,1]
v_pk_add_f32 v[44:45], v[44:45], v[56:57]
v_pk_add_f32 v[56:57], v[58:59], v[62:63] op_sel:[1,1] op_sel_hi:[0,0] neg_lo:[1,0] neg_hi:[0,1]
v_pk_add_f32 v[58:59], v[58:59], v[62:63]
v_pk_add_f32 v[62:63], v[40:41], v[68:69] neg_lo:[0,1] neg_hi:[0,1]
v_pk_add_f32 v[40:41], v[40:41], v[68:69]
v_pk_add_f32 v[68:69], v[66:67], v[70:71] op_sel:[1,1] op_sel_hi:[0,0] neg_lo:[1,0] neg_hi:[0,1]
v_pk_add_f32 v[66:67], v[66:67], v[70:71]
v_pk_add_f32 v[70:71], v[60:61], v[48:49] neg_lo:[0,1] neg_hi:[0,1]
v_pk_add_f32 v[60:61], v[60:61], v[48:49]
v_pk_add_f32 v[48:49], v[74:75], v[78:79] op_sel:[1,1] op_sel_hi:[0,0] neg_lo:[1,0] neg_hi:[0,1]
v_pk_add_f32 v[74:75], v[74:75], v[78:79]
v_pk_add_f32 v[78:79], v[16:17], v[18:19] neg_lo:[0,1] neg_hi:[0,1]
v_pk_add_f32 v[16:17], v[16:17], v[18:19]
v_pk_add_f32 v[18:19], v[76:77], v[20:21] neg_lo:[0,1] neg_hi:[0,1]
v_pk_add_f32 v[76:77], v[76:77], v[20:21]
v_pk_add_f32 v[20:21], v[72:73], v[26:27] neg_lo:[0,1] neg_hi:[0,1]
v_pk_add_f32 v[72:73], v[72:73], v[26:27]
v_pk_add_f32 v[26:27], v[22:23], v[24:25] neg_lo:[0,1] neg_hi:[0,1]
v_pk_add_f32 v[22:23], v[22:23], v[24:25]
v_pk_add_f32 v[24:25], v[64:65], v[34:35] neg_lo:[0,1] neg_hi:[0,1]
v_pk_add_f32 v[64:65], v[64:65], v[34:35]
v_pk_add_f32 v[34:35], v[30:31], v[36:37] neg_lo:[0,1] neg_hi:[0,1]
v_pk_add_f32 v[30:31], v[30:31], v[36:37]
v_pk_add_f32 v[36:37], v[28:29], v[42:43] neg_lo:[0,1] neg_hi:[0,1]
v_pk_add_f32 v[28:29], v[28:29], v[42:43]
v_pk_add_f32 v[42:43], v[38:39], v[32:33] neg_lo:[0,1] neg_hi:[0,1]
v_pk_add_f32 v[38:39], v[38:39], v[32:33]
v_pk_add_f32 v[32:33], v[14:15], v[50:51] neg_lo:[0,1] neg_hi:[0,1]
v_pk_add_f32 v[14:15], v[14:15], v[50:51]
v_pk_add_f32 v[50:51], v[46:47], v[52:53] neg_lo:[0,1] neg_hi:[0,1]
v_pk_add_f32 v[46:47], v[46:47], v[52:53]
v_pk_add_f32 v[52:53], v[44:45], v[58:59] neg_lo:[0,1] neg_hi:[0,1]
v_pk_add_f32 v[44:45], v[44:45], v[58:59]
v_pk_add_f32 v[58:59], v[54:55], v[56:57] neg_lo:[0,1] neg_hi:[0,1]
v_pk_add_f32 v[54:55], v[54:55], v[56:57]
v_pk_add_f32 v[56:57], v[40:41], v[66:67] neg_lo:[0,1] neg_hi:[0,1]
v_pk_add_f32 v[40:41], v[40:41], v[66:67]
v_pk_add_f32 v[66:67], v[62:63], v[68:69] neg_lo:[0,1] neg_hi:[0,1]
v_pk_add_f32 v[62:63], v[62:63], v[68:69]
v_pk_add_f32 v[68:69], v[60:61], v[74:75] neg_lo:[0,1] neg_hi:[0,1]
v_pk_add_f32 v[60:61], v[60:61], v[74:75]
v_pk_add_f32 v[74:75], v[70:71], v[48:49] neg_lo:[0,1] neg_hi:[0,1]
v_pk_add_f32 v[70:71], v[70:71], v[48:49]
v_pk_mul_f32 v[48:49], v[14:15], v[82:83] op_sel:[0,0] op_sel_hi:[0,1] neg_lo:[0,0] neg_hi:[0,0]
v_pk_fma_f32 v[14:15], v[14:15], v[82:83], v[48:49] op_sel:[1,1,0] op_sel_hi:[1,0,1] neg_lo:[0,1,0] neg_hi:[0,0,0]
v_pk_mul_f32 v[48:49], v[64:65], v[84:85] op_sel:[0,0] op_sel_hi:[0,1] neg_lo:[0,0] neg_hi:[0,0]
v_pk_fma_f32 v[64:65], v[64:65], v[84:85], v[48:49] op_sel:[1,1,0] op_sel_hi:[1,0,1] neg_lo:[0,1,0] neg_hi:[0,0,0]
v_pk_mul_f32 v[48:49], v[40:41], v[86:87] op_sel:[0,0] op_sel_hi:[0,1] neg_lo:[0,0] neg_hi:[0,0]
v_pk_fma_f32 v[40:41], v[40:41], v[86:87], v[48:49] op_sel:[1,1,0] op_sel_hi:[1,0,1] neg_lo:[0,1,0] neg_hi:[0,0,0]
v_pk_mul_f32 v[48:49], v[72:73], v[88:89] op_sel:[0,0] op_sel_hi:[0,1] neg_lo:[0,0] neg_hi:[0,0]
v_pk_fma_f32 v[72:73], v[72:73], v[88:89], v[48:49] op_sel:[1,1,0] op_sel_hi:[1,0,1] neg_lo:[0,1,0] neg_hi:[0,0,0]
v_pk_mul_f32 v[48:49], v[44:45], v[90:91] op_sel:[0,0] op_sel_hi:[0,1] neg_lo:[0,0] neg_hi:[0,0]
v_pk_fma_f32 v[44:45], v[44:45], v[90:91], v[48:49] op_sel:[1,1,0] op_sel_hi:[1,0,1] neg_lo:[0,1,0] neg_hi:[0,0,0]
v_pk_mul_f32 v[48:49], v[28:29], v[92:93] op_sel:[0,0] op_sel_hi:[0,1] neg_lo:[0,0] neg_hi:[0,0]
v_pk_fma_f32 v[28:29], v[28:29], v[92:93], v[48:49] op_sel:[1,1,0] op_sel_hi:[1,0,1] neg_lo:[0,1,0] neg_hi:[0,0,0]
v_pk_mul_f32 v[48:49], v[60:61], v[94:95] op_sel:[0,0] op_sel_hi:[0,1] neg_lo:[0,0] neg_hi:[0,0]
v_pk_fma_f32 v[60:61], v[60:61], v[94:95], v[48:49] op_sel:[1,1,0] op_sel_hi:[1,0,1] neg_lo:[0,1,0] neg_hi:[0,0,0]
v_pk_mul_f32 v[48:49], v[76:77], v[96:97] op_sel:[0,0] op_sel_hi:[0,1] neg_lo:[0,0] neg_hi:[0,0]
v_pk_fma_f32 v[76:77], v[76:77], v[96:97], v[48:49] op_sel:[1,1,0] op_sel_hi:[1,0,1] neg_lo:[0,1,0] neg_hi:[0,0,0]
v_pk_mul_f32 v[48:49], v[46:47], v[98:99] op_sel:[0,0] op_sel_hi:[0,1] neg_lo:[0,0] neg_hi:[0,0]
v_pk_fma_f32 v[46:47], v[46:47], v[98:99], v[48:49] op_sel:[1,1,0] op_sel_hi:[1,0,1] neg_lo:[0,1,0] neg_hi:[0,0,0]
v_pk_mul_f32 v[48:49], v[30:31], v[100:101] op_sel:[0,0] op_sel_hi:[0,1] neg_lo:[0,0] neg_hi:[0,0]
v_pk_fma_f32 v[30:31], v[30:31], v[100:101], v[48:49] op_sel:[1,1,0] op_sel_hi:[1,0,1] neg_lo:[0,1,0] neg_hi:[0,0,0]
v_pk_mul_f32 v[48:49], v[62:63], v[102:103] op_sel:[0,0] op_sel_hi:[0,1] neg_lo:[0,0] neg_hi:[0,0]
v_pk_fma_f32 v[62:63], v[62:63], v[102:103], v[48:49] op_sel:[1,1,0] op_sel_hi:[1,0,1] neg_lo:[0,1,0] neg_hi:[0,0,0]
v_pk_mul_f32 v[48:49], v[22:23], v[104:105] op_sel:[0,0] op_sel_hi:[0,1] neg_lo:[0,0] neg_hi:[0,0]
v_pk_fma_f32 v[22:23], v[22:23], v[104:105], v[48:49] op_sel:[1,1,0] op_sel_hi:[1,0,1] neg_lo:[0,1,0] neg_hi:[0,0,0]
v_pk_mul_f32 v[48:49], v[54:55], v[106:107] op_sel:[0,0] op_sel_hi:[0,1] neg_lo:[0,0] neg_hi:[0,0]
v_pk_fma_f32 v[54:55], v[54:55], v[106:107], v[48:49] op_sel:[1,1,0] op_sel_hi:[1,0,1] neg_lo:[0,1,0] neg_hi:[0,0,0]
v_pk_mul_f32 v[48:49], v[38:39], v[108:109] op_sel:[0,0] op_sel_hi:[0,1] neg_lo:[0,0] neg_hi:[0,0]
v_pk_fma_f32 v[38:39], v[38:39], v[108:109], v[48:49] op_sel:[1,1,0] op_sel_hi:[1,0,1] neg_lo:[0,1,0] neg_hi:[0,0,0]
v_pk_mul_f32 v[48:49], v[70:71], v[110:111] op_sel:[0,0] op_sel_hi:[0,1] neg_lo:[0,0] neg_hi:[0,0]
v_pk_fma_f32 v[70:71], v[70:71], v[110:111], v[48:49] op_sel:[1,1,0] op_sel_hi:[1,0,1] neg_lo:[0,1,0] neg_hi:[0,0,0]
v_pk_mul_f32 v[48:49], v[78:79], v[112:113] op_sel:[0,0] op_sel_hi:[0,1] neg_lo:[0,0] neg_hi:[0,0]
v_pk_fma_f32 v[78:79], v[78:79], v[112:113], v[48:49] op_sel:[1,1,0] op_sel_hi:[1,0,1] neg_lo:[0,1,0] neg_hi:[0,0,0]
v_pk_mul_f32 v[48:49], v[32:33], v[114:115] op_sel:[0,0] op_sel_hi:[0,1] neg_lo:[0,0] neg_hi:[0,0]
v_pk_fma_f32 v[32:33], v[32:33], v[114:115], v[48:49] op_sel:[1,1,0] op_sel_hi:[1,0,1] neg_lo:[0,1,0] neg_hi:[0,0,0]
v_pk_mul_f32 v[48:49], v[24:25], v[116:117] op_sel:[0,0] op_sel_hi:[0,1] neg_lo:[0,0] neg_hi:[0,0]
v_pk_fma_f32 v[24:25], v[24:25], v[116:117], v[48:49] op_sel:[1,1,0] op_sel_hi:[1,0,1] neg_lo:[0,1,0] neg_hi:[0,0,0]
v_pk_mul_f32 v[48:49], v[56:57], v[118:119] op_sel:[0,0] op_sel_hi:[0,1] neg_lo:[0,0] neg_hi:[0,0]
v_pk_fma_f32 v[56:57], v[56:57], v[118:119], v[48:49] op_sel:[1,1,0] op_sel_hi:[1,0,1] neg_lo:[0,1,0] neg_hi:[0,0,0]
v_pk_mul_f32 v[48:49], v[20:21], v[120:121] op_sel:[0,0] op_sel_hi:[0,1] neg_lo:[0,0] neg_hi:[0,0]
v_pk_fma_f32 v[20:21], v[20:21], v[120:121], v[48:49] op_sel:[1,1,0] op_sel_hi:[1,0,1] neg_lo:[0,1,0] neg_hi:[0,0,0]
v_pk_mul_f32 v[48:49], v[52:53], v[122:123] op_sel:[0,0] op_sel_hi:[0,1] neg_lo:[0,0] neg_hi:[0,0]
v_pk_fma_f32 v[52:53], v[52:53], v[122:123], v[48:49] op_sel:[1,1,0] op_sel_hi:[1,0,1] neg_lo:[0,1,0] neg_hi:[0,0,0]
v_pk_mul_f32 v[48:49], v[36:37], v[124:125] op_sel:[0,0] op_sel_hi:[0,1] neg_lo:[0,0] neg_hi:[0,0]
v_pk_fma_f32 v[36:37], v[36:37], v[124:125], v[48:49] op_sel:[1,1,0] op_sel_hi:[1,0,1] neg_lo:[0,1,0] neg_hi:[0,0,0]
v_pk_mul_f32 v[48:49], v[68:69], v[126:127] op_sel:[0,0] op_sel_hi:[0,1] neg_lo:[0,0] neg_hi:[0,0]
v_pk_fma_f32 v[68:69], v[68:69], v[126:127], v[48:49] op_sel:[1,1,0] op_sel_hi:[1,0,1] neg_lo:[0,1,0] neg_hi:[0,0,0]
v_pk_mul_f32 v[48:49], v[18:19], v[128:129] op_sel:[0,0] op_sel_hi:[0,1] neg_lo:[0,0] neg_hi:[0,0]
v_pk_fma_f32 v[18:19], v[18:19], v[128:129], v[48:49] op_sel:[1,1,0] op_sel_hi:[1,0,1] neg_lo:[0,1,0] neg_hi:[0,0,0]
v_pk_mul_f32 v[48:49], v[50:51], v[130:131] op_sel:[0,0] op_sel_hi:[0,1] neg_lo:[0,0] neg_hi:[0,0]
v_pk_fma_f32 v[50:51], v[50:51], v[130:131], v[48:49] op_sel:[1,1,0] op_sel_hi:[1,0,1] neg_lo:[0,1,0] neg_hi:[0,0,0]
v_pk_mul_f32 v[48:49], v[34:35], v[132:133] op_sel:[0,0] op_sel_hi:[0,1] neg_lo:[0,0] neg_hi:[0,0]
v_pk_fma_f32 v[34:35], v[34:35], v[132:133], v[48:49] op_sel:[1,1,0] op_sel_hi:[1,0,1] neg_lo:[0,1,0] neg_hi:[0,0,0]
v_pk_mul_f32 v[48:49], v[66:67], v[134:135] op_sel:[0,0] op_sel_hi:[0,1] neg_lo:[0,0] neg_hi:[0,0]
v_pk_fma_f32 v[66:67], v[66:67], v[134:135], v[48:49] op_sel:[1,1,0] op_sel_hi:[1,0,1] neg_lo:[0,1,0] neg_hi:[0,0,0]
v_pk_mul_f32 v[48:49], v[26:27], v[136:137] op_sel:[0,0] op_sel_hi:[0,1] neg_lo:[0,0] neg_hi:[0,0]
v_pk_fma_f32 v[26:27], v[26:27], v[136:137], v[48:49] op_sel:[1,1,0] op_sel_hi:[1,0,1] neg_lo:[0,1,0] neg_hi:[0,0,0]
v_pk_mul_f32 v[48:49], v[58:59], v[138:139] op_sel:[0,0] op_sel_hi:[0,1] neg_lo:[0,0] neg_hi:[0,0]
v_pk_fma_f32 v[58:59], v[58:59], v[138:139], v[48:49] op_sel:[1,1,0] op_sel_hi:[1,0,1] neg_lo:[0,1,0] neg_hi:[0,0,0]
v_pk_mul_f32 v[48:49], v[42:43], v[140:141] op_sel:[0,0] op_sel_hi:[0,1] neg_lo:[0,0] neg_hi:[0,0]
v_pk_fma_f32 v[42:43], v[42:43], v[140:141], v[48:49] op_sel:[1,1,0] op_sel_hi:[1,0,1] neg_lo:[0,1,0] neg_hi:[0,0,0]
v_pk_mul_f32 v[48:49], v[74:75], v[142:143] op_sel:[0,0] op_sel_hi:[0,1] neg_lo:[0,0] neg_hi:[0,0]
v_pk_fma_f32 v[74:75], v[74:75], v[142:143], v[48:49] op_sel:[1,1,0] op_sel_hi:[1,0,1] neg_lo:[0,1,0] neg_hi:[0,0,0]
ds_write_b64 v4, v[16:17] offset:0
ds_write_b64 v4, v[14:15] offset:264
ds_write_b64 v4, v[64:65] offset:528
ds_write_b64 v4, v[40:41] offset:792
ds_write_b64 v4, v[72:73] offset:1056
ds_write_b64 v4, v[44:45] offset:1320
ds_write_b64 v4, v[28:29] offset:1584
ds_write_b64 v4, v[60:61] offset:1848
ds_write_b64 v4, v[76:77] offset:2112
ds_write_b64 v4, v[46:47] offset:2376
ds_write_b64 v4, v[30:31] offset:2640
ds_write_b64 v4, v[62:63] offset:2904
ds_write_b64 v4, v[22:23] offset:3168
ds_write_b64 v4, v[54:55] offset:3432
ds_write_b64 v4, v[38:39] offset:3696
ds_write_b64 v4, v[70:71] offset:3960
ds_write_b64 v4, v[78:79] offset:4224
ds_write_b64 v4, v[32:33] offset:4488
ds_write_b64 v4, v[24:25] offset:4752
ds_write_b64 v4, v[56:57] offset:5016
ds_write_b64 v4, v[20:21] offset:5280
ds_write_b64 v4, v[52:53] offset:5544
ds_write_b64 v4, v[36:37] offset:5808
ds_write_b64 v4, v[68:69] offset:6072
ds_write_b64 v4, v[18:19] offset:6336
ds_write_b64 v4, v[50:51] offset:6600
ds_write_b64 v4, v[34:35] offset:6864
ds_write_b64 v4, v[66:67] offset:7128
ds_write_b64 v4, v[26:27] offset:7392
ds_write_b64 v4, v[58:59] offset:7656
ds_write_b64 v4, v[42:43] offset:7920
ds_write_b64 v4, v[74:75] offset:8184
s_waitcnt lgkmcnt(0)
ds_read_b64 v[16:17], v5 offset:0
ds_read_b64 v[48:49], v5 offset:128
ds_read_b64 v[18:19], v5 offset:8
ds_read_b64 v[50:51], v5 offset:136
ds_read_b64 v[20:21], v5 offset:16
ds_read_b64 v[52:53], v5 offset:144
ds_read_b64 v[22:23], v5 offset:24
ds_read_b64 v[54:55], v5 offset:152
ds_read_b64 v[24:25], v5 offset:32
ds_read_b64 v[56:57], v5 offset:160
ds_read_b64 v[26:27], v5 offset:40
ds_read_b64 v[58:59], v5 offset:168
ds_read_b64 v[28:29], v5 offset:48
ds_read_b64 v[60:61], v5 offset:176
ds_read_b64 v[30:31], v5 offset:56
ds_read_b64 v[62:63], v5 offset:184
ds_read_b64 v[32:33], v5 offset:64
ds_read_b64 v[64:65], v5 offset:192
ds_read_b64 v[34:35], v5 offset:72
ds_read_b64 v[66:67], v5 offset:200
ds_read_b64 v[36:37], v5 offset:80
ds_read_b64 v[68:69], v5 offset:208
ds_read_b64 v[38:39], v5 offset:88
ds_read_b64 v[70:71], v5 offset:216
ds_read_b64 v[40:41], v5 offset:96
ds_read_b64 v[72:73], v5 offset:224
ds_read_b64 v[42:43], v5 offset:104
ds_read_b64 v[74:75], v5 offset:232
ds_read_b64 v[44:45], v5 offset:112
ds_read_b64 v[76:77], v5 offset:240
ds_read_b64 v[46:47], v5 offset:120
ds_read_b64 v[78:79], v5 offset:248
s_waitcnt lgkmcnt(0)
v_pk_add_f32 v[14:15], v[16:17], v[48:49] neg_lo:[0,1] neg_hi:[0,1]
v_pk_add_f32 v[16:17], v[16:17], v[48:49]
v_pk_add_f32 v[48:49], v[18:19], v[50:51] neg_lo:[0,1] neg_hi:[0,1]
v_pk_add_f32 v[18:19], v[18:19], v[50:51]
v_pk_mul_f32 v[50:51], v[48:49], s[50:51] op_sel:[0,0] op_sel_hi:[0,1] neg_lo:[0,0] neg_hi:[0,0]
v_pk_fma_f32 v[50:51], v[48:49], s[50:51], v[50:51] op_sel:[1,1,0] op_sel_hi:[1,0,1] neg_lo:[0,1,0] neg_hi:[0,0,0]
v_pk_add_f32 v[48:49], v[20:21], v[52:53] neg_lo:[0,1] neg_hi:[0,1]
v_pk_add_f32 v[20:21], v[20:21], v[52:53]
v_pk_mul_f32 v[52:53], v[48:49], s[54:55] op_sel:[0,0] op_sel_hi:[0,1] neg_lo:[0,0] neg_hi:[0,0]
v_pk_fma_f32 v[52:53], v[48:49], s[54:55], v[52:53] op_sel:[1,1,0] op_sel_hi:[1,0,1] neg_lo:[0,1,0] neg_hi:[0,0,0]
v_pk_add_f32 v[48:49], v[22:23], v[54:55] neg_lo:[0,1] neg_hi:[0,1]
v_pk_add_f32 v[22:23], v[22:23], v[54:55]
v_pk_mul_f32 v[54:55], v[48:49], s[58:59] op_sel:[0,0] op_sel_hi:[0,1] neg_lo:[0,0] neg_hi:[0,0]
v_pk_fma_f32 v[54:55], v[48:49], s[58:59], v[54:55] op_sel:[1,1,0] op_sel_hi:[1,0,1] neg_lo:[0,1,0] neg_hi:[0,0,0]
v_pk_add_f32 v[48:49], v[24:25], v[56:57] neg_lo:[0,1] neg_hi:[0,1]
v_pk_add_f32 v[24:25], v[24:25], v[56:57]
v_pk_mul_f32 v[56:57], v[48:49], s[62:63] op_sel:[0,0] op_sel_hi:[0,1] neg_lo:[0,0] neg_hi:[0,0]
v_pk_fma_f32 v[56:57], v[48:49], s[62:63], v[56:57] op_sel:[1,1,0] op_sel_hi:[1,0,1] neg_lo:[0,1,0] neg_hi:[0,0,0]
v_pk_add_f32 v[48:49], v[26:27], v[58:59] neg_lo:[0,1] neg_hi:[0,1]
v_pk_add_f32 v[26:27], v[26:27], v[58:59]
v_pk_mul_f32 v[58:59], v[48:49], s[58:59] op_sel:[0,1] op_sel_hi:[0,0] neg_lo:[0,0] neg_hi:[0,0]
v_pk_fma_f32 v[58:59], v[48:49], s[58:59], v[58:59] op_sel:[1,0,0] op_sel_hi:[1,1,1] neg_lo:[0,1,0] neg_hi:[0,0,0]
v_pk_add_f32 v[48:49], v[28:29], v[60:61] neg_lo:[0,1] neg_hi:[0,1]
v_pk_add_f32 v[28:29], v[28:29], v[60:61]
v_pk_mul_f32 v[60:61], v[48:49], s[54:55] op_sel:[0,1] op_sel_hi:[0,0] neg_lo:[0,0] neg_hi:[0,0]
v_pk_fma_f32 v[60:61], v[48:49], s[54:55], v[60:61] op_sel:[1,0,0] op_sel_hi:[1,1,1] neg_lo:[0,1,0] neg_hi:[0,0,0]
v_pk_add_f32 v[48:49], v[30:31], v[62:63] neg_lo:[0,1] neg_hi:[0,1]
v_pk_add_f32 v[30:31], v[30:31], v[62:63]
v_pk_mul_f32 v[62:63], v[48:49], s[50:51] op_sel:[0,1] op_sel_hi:[0,0] neg_lo:[0,0] neg_hi:[0,0]
v_pk_fma_f32 v[62:63], v[48:49], s[50:51], v[62:63] op_sel:[1,0,0] op_sel_hi:[1,1,1] neg_lo:[0,1,0] neg_hi:[0,0,0]
v_pk_add_f32 v[48:49], v[32:33], v[64:65] op_sel:[1,1] op_sel_hi:[0,0] neg_lo:[1,0] neg_hi:[0,1]
v_pk_add_f32 v[32:33], v[32:33], v[64:65]
v_pk_add_f32 v[64:65], v[34:35], v[66:67] neg_lo:[0,1] neg_hi:[0,1]
v_pk_add_f32 v[34:35], v[34:35], v[66:67]
v_pk_mul_f32 v[66:67], v[64:65], s[50:51] op_sel:[0,1] op_sel_hi:[0,0] neg_lo:[0,1] neg_hi:[0,0]
v_pk_fma_f32 v[66:67], v[64:65], s[50:51], v[66:67] op_sel:[1,0,0] op_sel_hi:[1,1,1] neg_lo:[0,1,0] neg_hi:[0,1,0]
v_pk_add_f32 v[64:65], v[36:37], v[68:69] neg_lo:[0,1] neg_hi:[0,1]
v_pk_add_f32 v[36:37], v[36:37], v[68:69]
v_pk_mul_f32 v[68:69], v[64:65], s[54:55] op_sel:[0,1] op_sel_hi:[0,0] neg_lo:[0,1] neg_hi:[0,0]
v_pk_fma_f32 v[68:69], v[64:65], s[54:55], v[68:69] op_sel:[1,0,0] op_sel_hi:[1,1,1] neg_lo:[0,1,0] neg_hi:[0,1,0]
v_pk_add_f32 v[64:65], v[38:39], v[70:71] neg_lo:[0,1] neg_hi:[0,1]
v_pk_add_f32 v[38:39], v[38:39], v[70:71]
v_pk_mul_f32 v[70:71], v[64:65], s[58:59] op_sel:[0,1] op_sel_hi:[0,0] neg_lo:[0,1] neg_hi:[0,0]
v_pk_fma_f32 v[70:71], v[64:65], s[58:59], v[70:71] op_sel:[1,0,0] op_sel_hi:[1,1,1] neg_lo:[0,1,0] neg_hi:[0,1,0]
v_pk_add_f32 v[64:65], v[40:41], v[72:73] neg_lo:[0,1] neg_hi:[0,1]
v_pk_add_f32 v[40:41], v[40:41], v[72:73]
v_pk_mul_f32 v[72:73], v[64:65], s[62:63] op_sel:[0,0] op_sel_hi:[0,1] neg_lo:[0,1] neg_hi:[0,0]
v_pk_fma_f32 v[72:73], v[64:65], s[62:63], v[72:73] op_sel:[1,1,0] op_sel_hi:[1,0,1] neg_lo:[0,1,0] neg_hi:[0,1,0]
v_pk_add_f32 v[64:65], v[42:43], v[74:75] neg_lo:[0,1] neg_hi:[0,1]
v_pk_add_f32 v[42:43], v[42:43], v[74:75]
v_pk_mul_f32 v[74:75], v[64:65], s[58:59] op_sel:[0,0] op_sel_hi:[0,1] neg_lo:[0,1] neg_hi:[0,0]
v_pk_fma_f32 v[74:75], v[64:65], s[58:59], v[74:75] op_sel:[1,1,0] op_sel_hi:[1,0,1] neg_lo:[0,1,0] neg_hi:[0,1,0]
v_pk_add_f32 v[64:65], v[44:45], v[76:77] neg_lo:[0,1] neg_hi:[0,1]
v_pk_add_f32 v[44:45], v[44:45], v[76:77]
v_pk_mul_f32 v[76:77], v[64:65], s[54:55] op_sel:[0,0] op_sel_hi:[0,1] neg_lo:[0,1] neg_hi:[0,0]
v_pk_fma_f32 v[76:77], v[64:65], s[54:55], v[76:77] op_sel:[1,1,0] op_sel_hi:[1,0,1] neg_lo:[0,1,0] neg_hi:[0,1,0]
v_pk_add_f32 v[64:65], v[46:47], v[78:79] neg_lo:[0,1] neg_hi:[0,1]
v_pk_add_f32 v[46:47], v[46:47], v[78:79]
v_pk_mul_f32 v[78:79], v[64:65], s[50:51] op_sel:[0,0] op_sel_hi:[0,1] neg_lo:[0,1] neg_hi:[0,0]
v_pk_fma_f32 v[78:79], v[64:65], s[50:51], v[78:79] op_sel:[1,1,0] op_sel_hi:[1,0,1] neg_lo:[0,1,0] neg_hi:[0,1,0]
v_pk_add_f32 v[64:65], v[16:17], v[32:33] neg_lo:[0,1] neg_hi:[0,1]
v_pk_add_f32 v[16:17], v[16:17], v[32:33]
v_pk_add_f32 v[32:33], v[18:19], v[34:35] neg_lo:[0,1] neg_hi:[0,1]
v_pk_add_f32 v[18:19], v[18:19], v[34:35]
v_pk_mul_f32 v[34:35], v[32:33], s[54:55] op_sel:[0,0] op_sel_hi:[0,1] neg_lo:[0,0] neg_hi:[0,0]
v_pk_fma_f32 v[34:35], v[32:33], s[54:55], v[34:35] op_sel:[1,1,0] op_sel_hi:[1,0,1] neg_lo:[0,1,0] neg_hi:[0,0,0]
v_pk_add_f32 v[32:33], v[20:21], v[36:37] neg_lo:[0,1] neg_hi:[0,1]
v_pk_add_f32 v[20:21], v[20:21], v[36:37]
v_pk_mul_f32 v[36:37], v[32:33], s[62:63] op_sel:[0,0] op_sel_hi:[0,1] neg_lo:[0,0] neg_hi:[0,0]
v_pk_fma_f32 v[36:37], v[32:33], s[62:63], v[36:37] op_sel:[1,1,0] op_sel_hi:[1,0,1] neg_lo:[0,1,0] neg_hi:[0,0,0]
v_pk_add_f32 v[32:33], v[22:23], v[38:39] neg_lo:[0,1] neg_hi:[0,1]
v_pk_add_f32 v[22:23], v[22:23], v[38:39]
v_pk_mul_f32 v[38:39], v[32:33], s[54:55] op_sel:[0,1] op_sel_hi:[0,0] neg_lo:[0,0] neg_hi:[0,0]
v_pk_fma_f32 v[38:39], v[32:33], s[54:55], v[38:39] op_sel:[1,0,0] op_sel_hi:[1,1,1] neg_lo:[0,1,0] neg_hi:[0,0,0]
v_pk_add_f32 v[32:33], v[24:25], v[40:41] op_sel:[1,1] op_sel_hi:[0,0] neg_lo:[1,0] neg_hi:[0,1]
v_pk_add_f32 v[24:25], v[24:25], v[40:41]
v_pk_add_f32 v[40:41], v[26:27], v[42:43] neg_lo:[0,1] neg_hi:[0,1]
v_pk_add_f32 v[26:27], v[26:27], v[42:43]
v_pk_mul_f32 v[42:43], v[40:41], s[54:55] op_sel:[0,1] op_sel_hi:[0,0] neg_lo:[0,1] neg_hi:[0,0]
v_pk_fma_f32 v[42:43], v[40:41], s[54:55], v[42:43] op_sel:[1,0,0] op_sel_hi:[1,1,1] neg_lo:[0,1,0] neg_hi:[0,1,0]
v_pk_add_f32 v[40:41], v[28:29], v[44:45] neg_lo:[0,1] neg_hi:[0,1]
v_pk_add_f32 v[28:29], v[28:29], v[44:45]
v_pk_mul_f32 v[44:45], v[40:41], s[62:63] op_sel:[0,0] op_sel_hi:[0,1] neg_lo:[0,1] neg_hi:[0,0]
v_pk_fma_f32 v[44:45], v[40:41], s[62:63], v[44:45] op_sel:[1,1,0] op_sel_hi:[1,0,1] neg_lo:[0,1,0] neg_hi:[0,1,0]
v_pk_add_f32 v[40:41], v[30:31], v[46:47] neg_lo:[0,1] neg_hi:[0,1]
v_pk_add_f32 v[30:31], v[30:31], v[46:47]
v_pk_mul_f32 v[46:47], v[40:41], s[54:55] op_sel:[0,0] op_sel_hi:[0,1] neg_lo:[0,1] neg_hi:[0,0]
v_pk_fma_f32 v[46:47], v[40:41], s[54:55], v[46:47] op_sel:[1,1,0] op_sel_hi:[1,0,1] neg_lo:[0,1,0] neg_hi:[0,1,0]
v_pk_add_f32 v[40:41], v[14:15], v[48:49] neg_lo:[0,1] neg_hi:[0,1]
v_pk_add_f32 v[14:15], v[14:15], v[48:49]
v_pk_add_f32 v[48:49], v[50:51], v[66:67] neg_lo:[0,1] neg_hi:[0,1]
v_pk_add_f32 v[50:51], v[50:51], v[66:67]
v_pk_mul_f32 v[66:67], v[48:49], s[54:55] op_sel:[0,0] op_sel_hi:[0,1] neg_lo:[0,0] neg_hi:[0,0]
v_pk_fma_f32 v[66:67], v[48:49], s[54:55], v[66:67] op_sel:[1,1,0] op_sel_hi:[1,0,1] neg_lo:[0,1,0] neg_hi:[0,0,0]
v_pk_add_f32 v[48:49], v[52:53], v[68:69] neg_lo:[0,1] neg_hi:[0,1]
v_pk_add_f32 v[52:53], v[52:53], v[68:69]
v_pk_mul_f32 v[68:69], v[48:49], s[62:63] op_sel:[0,0] op_sel_hi:[0,1] neg_lo:[0,0] neg_hi:[0,0]
v_pk_fma_f32 v[68:69], v[48:49], s[62:63], v[68:69] op_sel:[1,1,0] op_sel_hi:[1,0,1] neg_lo:[0,1,0] neg_hi:[0,0,0]
v_pk_add_f32 v[48:49], v[54:55], v[70:71] neg_lo:[0,1] neg_hi:[0,1]
v_pk_add_f32 v[54:55], v[54:55], v[70:71]
v_pk_mul_f32 v[70:71], v[48:49], s[54:55] op_sel:[0,1] op_sel_hi:[0,0] neg_lo:[0,0] neg_hi:[0,0]
v_pk_fma_f32 v[70:71], v[48:49], s[54:55], v[70:71] op_sel:[1,0,0] op_sel_hi:[1,1,1] neg_lo:[0,1,0] neg_hi:[0,0,0]
v_pk_add_f32 v[48:49], v[56:57], v[72:73] op_sel:[1,1] op_sel_hi:[0,0] neg_lo:[1,0] neg_hi:[0,1]
v_pk_add_f32 v[56:57], v[56:57], v[72:73]
v_pk_add_f32 v[72:73], v[58:59], v[74:75] neg_lo:[0,1] neg_hi:[0,1]
v_pk_add_f32 v[58:59], v[58:59], v[74:75]
v_pk_mul_f32 v[74:75], v[72:73], s[54:55] op_sel:[0,1] op_sel_hi:[0,0] neg_lo:[0,1] neg_hi:[0,0]
v_pk_fma_f32 v[74:75], v[72:73], s[54:55], v[74:75] op_sel:[1,0,0] op_sel_hi:[1,1,1] neg_lo:[0,1,0] neg_hi:[0,1,0]
v_pk_add_f32 v[72:73], v[60:61], v[76:77] neg_lo:[0,1] neg_hi:[0,1]
v_pk_add_f32 v[60:61], v[60:61], v[76:77]
v_pk_mul_f32 v[76:77], v[72:73], s[62:63] op_sel:[0,0] op_sel_hi:[0,1] neg_lo:[0,1] neg_hi:[0,0]
v_pk_fma_f32 v[76:77], v[72:73], s[62:63], v[76:77] op_sel:[1,1,0] op_sel_hi:[1,0,1] neg_lo:[0,1,0] neg_hi:[0,1,0]
v_pk_add_f32 v[72:73], v[62:63], v[78:79] neg_lo:[0,1] neg_hi:[0,1]
v_pk_add_f32 v[62:63], v[62:63], v[78:79]
v_pk_mul_f32 v[78:79], v[72:73], s[54:55] op_sel:[0,0] op_sel_hi:[0,1] neg_lo:[0,1] neg_hi:[0,0]
v_pk_fma_f32 v[78:79], v[72:73], s[54:55], v[78:79] op_sel:[1,1,0] op_sel_hi:[1,0,1] neg_lo:[0,1,0] neg_hi:[0,1,0]
v_pk_add_f32 v[72:73], v[16:17], v[24:25] neg_lo:[0,1] neg_hi:[0,1]
v_pk_add_f32 v[16:17], v[16:17], v[24:25]
v_pk_add_f32 v[24:25], v[18:19], v[26:27] neg_lo:[0,1] neg_hi:[0,1]
v_pk_add_f32 v[18:19], v[18:19], v[26:27]
v_pk_mul_f32 v[26:27], v[24:25], s[62:63] op_sel:[0,0] op_sel_hi:[0,1] neg_lo:[0,0] neg_hi:[0,0]
v_pk_fma_f32 v[26:27], v[24:25], s[62:63], v[26:27] op_sel:[1,1,0] op_sel_hi:[1,0,1] neg_lo:[0,1,0] neg_hi:[0,0,0]
v_pk_add_f32 v[24:25], v[20:21], v[28:29] op_sel:[1,1] op_sel_hi:[0,0] neg_lo:[1,0] neg_hi:[0,1]
v_pk_add_f32 v[20:21], v[20:21], v[28:29]
v_pk_add_f32 v[28:29], v[22:23], v[30:31] neg_lo:[0,1] neg_hi:[0,1]
v_pk_add_f32 v[22:23], v[22:23], v[30:31]
v_pk_mul_f32 v[30:31], v[28:29], s[62:63] op_sel:[0,0] op_sel_hi:[0,1] neg_lo:[0,1] neg_hi:[0,0]
v_pk_fma_f32 v[30:31], v[28:29], s[62:63], v[30:31] op_sel:[1,1,0] op_sel_hi:[1,0,1] neg_lo:[0,1,0] neg_hi:[0,1,0]
v_pk_add_f32 v[28:29], v[64:65], v[32:33] neg_lo:[0,1] neg_hi:[0,1]
v_pk_add_f32 v[64:65], v[64:65], v[32:33]
v_pk_add_f32 v[32:33], v[34:35], v[42:43] neg_lo:[0,1] neg_hi:[0,1]
v_pk_add_f32 v[34:35], v[34:35], v[42:43]
v_pk_mul_f32 v[42:43], v[32:33], s[62:63] op_sel:[0,0] op_sel_hi:[0,1] neg_lo:[0,0] neg_hi:[0,0]
v_pk_fma_f32 v[42:43], v[32:33], s[62:63], v[42:43] op_sel:[1,1,0] op_sel_hi:[1,0,1] neg_lo:[0,1,0] neg_hi:[0,0,0]
v_pk_add_f32 v[32:33], v[36:37], v[44:45] op_sel:[1,1] op_sel_hi:[0,0] neg_lo:[1,0] neg_hi:[0,1]
v_pk_add_f32 v[36:37], v[36:37], v[44:45]
v_pk_add_f32 v[44:45], v[38:39], v[46:47] neg_lo:[0,1] neg_hi:[0,1]
v_pk_add_f32 v[38:39], v[38:39], v[46:47]
v_pk_mul_f32 v[46:47], v[44:45], s[62:63] op_sel:[0,0] op_sel_hi:[0,1] neg_lo:[0,1] neg_hi:[0,0]
v_pk_fma_f32 v[46:47], v[44:45], s[62:63], v[46:47] op_sel:[1,1,0] op_sel_hi:[1,0,1] neg_lo:[0,1,0] neg_hi:[0,1,0]
v_pk_add_f32 v[44:45], v[14:15], v[56:57] neg_lo:[0,1] neg_hi:[0,1]
v_pk_add_f32 v[14:15], v[14:15], v[56:57]
v_pk_add_f32 v[56:57], v[50:51], v[58:59] neg_lo:[0,1] neg_hi:[0,1]
v_pk_add_f32 v[50:51], v[50:51], v[58:59]
v_pk_mul_f32 v[58:59], v[56:57], s[62:63] op_sel:[0,0] op_sel_hi:[0,1] neg_lo:[0,0] neg_hi:[0,0]
v_pk_fma_f32 v[58:59], v[56:57], s[62:63], v[58:59] op_sel:[1,1,0] op_sel_hi:[1,0,1] neg_lo:[0,1,0] neg_hi:[0,0,0]
v_pk_add_f32 v[56:57], v[52:53], v[60:61] op_sel:[1,1] op_sel_hi:[0,0] neg_lo:[1,0] neg_hi:[0,1]
v_pk_add_f32 v[52:53], v[52:53], v[60:61]
v_pk_add_f32 v[60:61], v[54:55], v[62:63] neg_lo:[0,1] neg_hi:[0,1]
v_pk_add_f32 v[54:55], v[54:55], v[62:63]
v_pk_mul_f32 v[62:63], v[60:61], s[62:63] op_sel:[0,0] op_sel_hi:[0,1] neg_lo:[0,1] neg_hi:[0,0]
v_pk_fma_f32 v[62:63], v[60:61], s[62:63], v[62:63] op_sel:[1,1,0] op_sel_hi:[1,0,1] neg_lo:[0,1,0] neg_hi:[0,1,0]
v_pk_add_f32 v[60:61], v[40:41], v[48:49] neg_lo:[0,1] neg_hi:[0,1]
v_pk_add_f32 v[40:41], v[40:41], v[48:49]
v_pk_add_f32 v[48:49], v[66:67], v[74:75] neg_lo:[0,1] neg_hi:[0,1]
v_pk_add_f32 v[66:67], v[66:67], v[74:75]
v_pk_mul_f32 v[74:75], v[48:49], s[62:63] op_sel:[0,0] op_sel_hi:[0,1] neg_lo:[0,0] neg_hi:[0,0]
v_pk_fma_f32 v[74:75], v[48:49], s[62:63], v[74:75] op_sel:[1,1,0] op_sel_hi:[1,0,1] neg_lo:[0,1,0] neg_hi:[0,0,0]
v_pk_add_f32 v[48:49], v[68:69], v[76:77] op_sel:[1,1] op_sel_hi:[0,0] neg_lo:[1,0] neg_hi:[0,1]
v_pk_add_f32 v[68:69], v[68:69], v[76:77]
v_pk_add_f32 v[76:77], v[70:71], v[78:79] neg_lo:[0,1] neg_hi:[0,1]
v_pk_add_f32 v[70:71], v[70:71], v[78:79]
v_pk_mul_f32 v[78:79], v[76:77], s[62:63] op_sel:[0,0] op_sel_hi:[0,1] neg_lo:[0,1] neg_hi:[0,0]
v_pk_fma_f32 v[78:79], v[76:77], s[62:63], v[78:79] op_sel:[1,1,0] op_sel_hi:[1,0,1] neg_lo:[0,1,0] neg_hi:[0,1,0]
v_pk_add_f32 v[76:77], v[16:17], v[20:21] neg_lo:[0,1] neg_hi:[0,1]
v_pk_add_f32 v[16:17], v[16:17], v[20:21]
v_pk_add_f32 v[20:21], v[18:19], v[22:23] op_sel:[1,1] op_sel_hi:[0,0] neg_lo:[1,0] neg_hi:[0,1]
v_pk_add_f32 v[18:19], v[18:19], v[22:23]
v_pk_add_f32 v[22:23], v[72:73], v[24:25] neg_lo:[0,1] neg_hi:[0,1]
v_pk_add_f32 v[72:73], v[72:73], v[24:25]
v_pk_add_f32 v[24:25], v[26:27], v[30:31] op_sel:[1,1] op_sel_hi:[0,0] neg_lo:[1,0] neg_hi:[0,1]
v_pk_add_f32 v[26:27], v[26:27], v[30:31]
v_pk_add_f32 v[30:31], v[64:65], v[36:37] neg_lo:[0,1] neg_hi:[0,1]
v_pk_add_f32 v[64:65], v[64:65], v[36:37]
v_pk_add_f32 v[36:37], v[34:35], v[38:39] op_sel:[1,1] op_sel_hi:[0,0] neg_lo:[1,0] neg_hi:[0,1]
v_pk_add_f32 v[34:35], v[34:35], v[38:39]
v_pk_add_f32 v[38:39], v[28:29], v[32:33] neg_lo:[0,1] neg_hi:[0,1]
v_pk_add_f32 v[28:29], v[28:29], v[32:33]
v_pk_add_f32 v[32:33], v[42:43], v[46:47] op_sel:[1,1] op_sel_hi:[0,0] neg_lo:[1,0] neg_hi:[0,1]
v_pk_add_f32 v[42:43], v[42:43], v[46:47]
v_pk_add_f32 v[46:47], v[14:15], v[52:53] neg_lo:[0,1] neg_hi:[0,1]
v_pk_add_f32 v[14:15], v[14:15], v[52:53]
v_pk_add_f32 v[52:53], v[50:51], v[54:55] op_sel:[1,1] op_sel_hi:[0,0] neg_lo:[1,0] neg_hi:[0,1]
v_pk_add_f32 v[50:51], v[50:51], v[54:55]
v_pk_add_f32 v[54:55], v[44:45], v[56:57] neg_lo:[0,1] neg_hi:[0,1]
v_pk_add_f32 v[44:45], v[44:45], v[56:57]
v_pk_add_f32 v[56:57], v[58:59], v[62:63] op_sel:[1,1] op_sel_hi:[0,0] neg_lo:[1,0] neg_hi:[0,1]
v_pk_add_f32 v[58:59], v[58:59], v[62:63]
v_pk_add_f32 v[62:63], v[40:41], v[68:69] neg_lo:[0,1] neg_hi:[0,1]
v_pk_add_f32 v[40:41], v[40:41], v[68:69]
v_pk_add_f32 v[68:69], v[66:67], v[70:71] op_sel:[1,1] op_sel_hi:[0,0] neg_lo:[1,0] neg_hi:[0,1]
v_pk_add_f32 v[66:67], v[66:67], v[70:71]
v_pk_add_f32 v[70:71], v[60:61], v[48:49] neg_lo:[0,1] neg_hi:[0,1]
v_pk_add_f32 v[60:61], v[60:61], v[48:49]
v_pk_add_f32 v[48:49], v[74:75], v[78:79] op_sel:[1,1] op_sel_hi:[0,0] neg_lo:[1,0] neg_hi:[0,1]
v_pk_add_f32 v[74:75], v[74:75], v[78:79]
v_pk_add_f32 v[78:79], v[16:17], v[18:19] neg_lo:[0,1] neg_hi:[0,1]
v_pk_add_f32 v[16:17], v[16:17], v[18:19]
v_pk_add_f32 v[18:19], v[76:77], v[20:21] neg_lo:[0,1] neg_hi:[0,1]
v_pk_add_f32 v[76:77], v[76:77], v[20:21]
v_pk_add_f32 v[20:21], v[72:73], v[26:27] neg_lo:[0,1] neg_hi:[0,1]
v_pk_add_f32 v[72:73], v[72:73], v[26:27]
v_pk_add_f32 v[26:27], v[22:23], v[24:25] neg_lo:[0,1] neg_hi:[0,1]
v_pk_add_f32 v[22:23], v[22:23], v[24:25]
v_pk_add_f32 v[24:25], v[64:65], v[34:35] neg_lo:[0,1] neg_hi:[0,1]
v_pk_add_f32 v[64:65], v[64:65], v[34:35]
v_pk_add_f32 v[34:35], v[30:31], v[36:37] neg_lo:[0,1] neg_hi:[0,1]
v_pk_add_f32 v[30:31], v[30:31], v[36:37]
v_pk_add_f32 v[36:37], v[28:29], v[42:43] neg_lo:[0,1] neg_hi:[0,1]
v_pk_add_f32 v[28:29], v[28:29], v[42:43]
v_pk_add_f32 v[42:43], v[38:39], v[32:33] neg_lo:[0,1] neg_hi:[0,1]
v_pk_add_f32 v[38:39], v[38:39], v[32:33]
v_pk_add_f32 v[32:33], v[14:15], v[50:51] neg_lo:[0,1] neg_hi:[0,1]
v_pk_add_f32 v[14:15], v[14:15], v[50:51]
v_pk_add_f32 v[50:51], v[46:47], v[52:53] neg_lo:[0,1] neg_hi:[0,1]
v_pk_add_f32 v[46:47], v[46:47], v[52:53]
v_pk_add_f32 v[52:53], v[44:45], v[58:59] neg_lo:[0,1] neg_hi:[0,1]
v_pk_add_f32 v[44:45], v[44:45], v[58:59]
v_pk_add_f32 v[58:59], v[54:55], v[56:57] neg_lo:[0,1] neg_hi:[0,1]
v_pk_add_f32 v[54:55], v[54:55], v[56:57]
v_pk_add_f32 v[56:57], v[40:41], v[66:67] neg_lo:[0,1] neg_hi:[0,1]
v_pk_add_f32 v[40:41], v[40:41], v[66:67]
v_pk_add_f32 v[66:67], v[62:63], v[68:69] neg_lo:[0,1] neg_hi:[0,1]
v_pk_add_f32 v[62:63], v[62:63], v[68:69]
v_pk_add_f32 v[68:69], v[60:61], v[74:75] neg_lo:[0,1] neg_hi:[0,1]
v_pk_add_f32 v[60:61], v[60:61], v[74:75]
v_pk_add_f32 v[74:75], v[70:71], v[48:49] neg_lo:[0,1] neg_hi:[0,1]
v_pk_add_f32 v[70:71], v[70:71], v[48:49]
ds_write2st64_b32 v12, v16, v17 offset0:0 offset1:16
ds_write_b32 v12, v14 offset:128
ds_write_b32 v12, v15 offset:4224
ds_write_b32 v12, v64 offset:256
ds_write_b32 v12, v65 offset:4352
ds_write_b32 v12, v40 offset:384
ds_write_b32 v12, v41 offset:4480
ds_write_b32 v12, v72 offset:512
ds_write_b32 v12, v73 offset:4608
ds_write_b32 v12, v44 offset:640
ds_write_b32 v12, v45 offset:4736
ds_write_b32 v12, v28 offset:768
ds_write_b32 v12, v29 offset:4864
ds_write_b32 v12, v60 offset:896
ds_write_b32 v12, v61 offset:4992
ds_write_b32 v12, v76 offset:1024
ds_write_b32 v12, v77 offset:5120
ds_write_b32 v12, v46 offset:1152
ds_write_b32 v12, v47 offset:5248
ds_write_b32 v12, v30 offset:1280
ds_write_b32 v12, v31 offset:5376
ds_write_b32 v12, v62 offset:1408
ds_write_b32 v12, v63 offset:5504
ds_write_b32 v12, v22 offset:1536
ds_write_b32 v12, v23 offset:5632
ds_write_b32 v12, v54 offset:1664
ds_write_b32 v12, v55 offset:5760
ds_write_b32 v12, v38 offset:1792
ds_write_b32 v12, v39 offset:5888
ds_write_b32 v12, v70 offset:1920
ds_write_b32 v12, v71 offset:6016
ds_write_b32 v12, v78 offset:2048
ds_write_b32 v12, v79 offset:6144
ds_write_b32 v12, v32 offset:2176
ds_write_b32 v12, v33 offset:6272
ds_write_b32 v12, v24 offset:2304
ds_write_b32 v12, v25 offset:6400
ds_write_b32 v12, v56 offset:2432
ds_write_b32 v12, v57 offset:6528
ds_write_b32 v12, v20 offset:2560
ds_write_b32 v12, v21 offset:6656
ds_write_b32 v12, v52 offset:2688
ds_write_b32 v12, v53 offset:6784
ds_write_b32 v12, v36 offset:2816
ds_write_b32 v12, v37 offset:6912
ds_write_b32 v12, v68 offset:2944
ds_write_b32 v12, v69 offset:7040
ds_write_b32 v12, v18 offset:3072
ds_write_b32 v12, v19 offset:7168
ds_write_b32 v12, v50 offset:3200
ds_write_b32 v12, v51 offset:7296
ds_write_b32 v12, v34 offset:3328
ds_write_b32 v12, v35 offset:7424
ds_write_b32 v12, v66 offset:3456
ds_write_b32 v12, v67 offset:7552
ds_write_b32 v12, v26 offset:3584
ds_write_b32 v12, v27 offset:7680
ds_write_b32 v12, v58 offset:3712
ds_write_b32 v12, v59 offset:7808
ds_write_b32 v12, v42 offset:3840
ds_write_b32 v12, v43 offset:7936
ds_write_b32 v12, v74 offset:3968
ds_write_b32 v12, v75 offset:8064
s_waitcnt lgkmcnt(0)
s_barrier
s_lshl_b32 s13, s93, 16
ds_read_b128 v[16:19], v2 offset:0
ds_read_b128 v[20:23], v2 offset:16
ds_read_b128 v[24:27], v2 offset:8448
ds_read_b128 v[28:31], v2 offset:8464
ds_read_b128 v[32:35], v2 offset:16896
ds_read_b128 v[36:39], v2 offset:16912
ds_read_b128 v[40:43], v2 offset:25344
ds_read_b128 v[44:47], v2 offset:25360
ds_read_b128 v[48:51], v2 offset:33792
ds_read_b128 v[52:55], v2 offset:33808
ds_read_b128 v[56:59], v2 offset:42240
ds_read_b128 v[60:63], v2 offset:42256
ds_read_b128 v[64:67], v2 offset:50688
ds_read_b128 v[68:71], v2 offset:50704
s_waitcnt lgkmcnt(12)
ds_read_b128 v[72:75], v2 offset:59136
ds_read_b128 v[76:79], v2 offset:59152
s_waitcnt lgkmcnt(14)
v_cvt_pk_bf16_f32 v216, v16, v17
v_cvt_pk_bf16_f32 v217, v18, v19
v_cvt_pk_bf16_f32 v218, v20, v21
v_cvt_pk_bf16_f32 v219, v22, v23
buffer_store_dwordx4 v[216:219], v3, s[4:7], s13 offen
s_add_u32 s13, s13, 8192
s_waitcnt lgkmcnt(12)
v_cvt_pk_bf16_f32 v220, v24, v25
v_cvt_pk_bf16_f32 v221, v26, v27
v_cvt_pk_bf16_f32 v222, v28, v29
v_cvt_pk_bf16_f32 v223, v30, v31
buffer_store_dwordx4 v[220:223], v3, s[4:7], s13 offen
s_add_u32 s13, s13, 8192
s_waitcnt lgkmcnt(10)
v_cvt_pk_bf16_f32 v224, v32, v33
v_cvt_pk_bf16_f32 v225, v34, v35
v_cvt_pk_bf16_f32 v226, v36, v37
v_cvt_pk_bf16_f32 v227, v38, v39
buffer_store_dwordx4 v[224:227], v3, s[4:7], s13 offen
s_add_u32 s13, s13, 8192
s_waitcnt lgkmcnt(8)
v_cvt_pk_bf16_f32 v228, v40, v41
v_cvt_pk_bf16_f32 v229, v42, v43
v_cvt_pk_bf16_f32 v230, v44, v45
v_cvt_pk_bf16_f32 v231, v46, v47
buffer_store_dwordx4 v[228:231], v3, s[4:7], s13 offen
s_add_u32 s13, s13, 8192
s_waitcnt lgkmcnt(6)
v_cvt_pk_bf16_f32 v232, v48, v49
v_cvt_pk_bf16_f32 v233, v50, v51
v_cvt_pk_bf16_f32 v234, v52, v53
v_cvt_pk_bf16_f32 v235, v54, v55
buffer_store_dwordx4 v[232:235], v3, s[4:7], s13 offen
s_add_u32 s13, s13, 8192
s_waitcnt lgkmcnt(4)
v_cvt_pk_bf16_f32 v236, v56, v57
v_cvt_pk_bf16_f32 v237, v58, v59
v_cvt_pk_bf16_f32 v238, v60, v61
v_cvt_pk_bf16_f32 v239, v62, v63
buffer_store_dwordx4 v[236:239], v3, s[4:7], s13 offen
s_add_u32 s13, s13, 8192
s_waitcnt lgkmcnt(2)
v_cvt_pk_bf16_f32 v240, v64, v65
v_cvt_pk_bf16_f32 v241, v66, v67
v_cvt_pk_bf16_f32 v242, v68, v69
v_cvt_pk_bf16_f32 v243, v70, v71
buffer_store_dwordx4 v[240:243], v3, s[4:7], s13 offen
s_add_u32 s13, s13, 8192
s_waitcnt lgkmcnt(0)
v_cvt_pk_bf16_f32 v244, v72, v73
v_cvt_pk_bf16_f32 v245, v74, v75
v_cvt_pk_bf16_f32 v246, v76, v77
v_cvt_pk_bf16_f32 v247, v78, v79
buffer_store_dwordx4 v[244:247], v3, s[4:7], s13 offen
s_add_u32 s13, s13, 8192
s_mov_b32 s93, s21
s_cmp_lt_u32 s93, 128
s_cbranch_scc1 mega_kernel_f3_l
mega_kernel_f3_e:
s_add_u32 s64, s91, 62
s_add_u32 s65, s91, 63
s_mov_b32 s66, 262144
s_mov_b32 s67, 1
s_waitcnt vmcnt(0)
s_barrier
mega_kernel_out:
s_load_dwordx2 s[4:5], s[0:1], 40
s_load_dwordx2 s[8:9], s[0:1], 80
v_lshrrev_b32 v2, 6, v0
v_and_b32 v1, 63, v0
v_readfirstlane_b32 s41, v2
v_lshlrev_b32 v5, 4, v1
s_waitcnt lgkmcnt(0)
s_mov_b32 s6, 8388608
s_mov_b32 s7, 0x00020000
s_mov_b32 s10, 8388608
s_mov_b32 s11, 0x00020000
s_and_b32 s58, s40, 1
s_lshr_b32 s59, s40, 1
s_lshl_b32 s43, s58, 22
s_lshl_b32 s44, s41, 20
s_add_u32 s43, s43, s44
s_lshl_b32 s44, s59, 7
s_add_u32 s48, s43, s44
s_and_b32 s56, s59, 7
s_lshl_b32 s56, s56, 6
v_lshrrev_b32 v2, 3, v1
v_and_b32 v3, 7, v1
v_lshlrev_b32 v16, 11, v2
v_lshl_add_u32 v16, v3, 4, v16
v_add_u32 v16, s48, v16
v_and_b32 v3, 3, v1
s_lshl_b32 s45, s41, 15
v_bfe_u32 v17, v1, 2, 2
v_lshrrev_b32 v18, 5, v1
v_mul_u32_u24 v18, 4, v18
v_add_u32 v17, v17, v18
v_lshlrev_b32 v17, 7, v17
v_bfe_u32 v18, v1, 4, 1
v_lshl_add_u32 v17, v18, 5, v17
v_lshl_add_u32 v17, v3, 3, v17
v_add_u32 v17, s45, v17
s_add_u32 m0, s45, 0
s_add_u32 s44, s56, 0
s_and_b32 s44, s44, 511
s_lshl_b32 s44, s44, 11
buffer_load_dwordx4 v16, s[4:7], s44 offen lds
s_add_u32 m0, s45, 1024
s_add_u32 s44, s56, 8
s_and_b32 s44, s44, 511
s_lshl_b32 s44, s44, 11
buffer_load_dwordx4 v16, s[4:7], s44 offen lds
s_add_u32 m0, s45, 2048
s_add_u32 s44, s56, 16
s_and_b32 s44, s44, 511
s_lshl_b32 s44, s44, 11
buffer_load_dwordx4 v16, s[4:7], s44 offen lds
s_add_u32 m0, s45, 3072
s_add_u32 s44, s56, 24
s_and_b32 s44, s44, 511
s_lshl_b32 s44, s44, 11
buffer_load_dwordx4 v16, s[4:7], s44 offen lds
s_add_u32 m0, s45, 4096
s_add_u32 s44, s56, 32
s_and_b32 s44, s44, 511
s_lshl_b32 s44, s44, 11
buffer_load_dwordx4 v16, s[4:7], s44 offen lds
s_add_u32 m0, s45, 5120
s_add_u32 s44, s56, 40
s_and_b32 s44, s44, 511
s_lshl_b32 s44, s44, 11
buffer_load_dwordx4 v16, s[4:7], s44 offen lds
s_add_u32 m0, s45, 6144
s_add_u32 s44, s56, 48
s_and_b32 s44, s44, 511
s_lshl_b32 s44, s44, 11
buffer_load_dwordx4 v16, s[4:7], s44 offen lds
s_add_u32 m0, s45, 7168
s_add_u32 s44, s56, 56
s_and_b32 s44, s44, 511
s_lshl_b32 s44, s44, 11
buffer_load_dwordx4 v16, s[4:7], s44 offen lds
s_add_u32 m0, s45, 8192
s_add_u32 s44, s56, 64
s_and_b32 s44, s44, 511
s_lshl_b32 s44, s44, 11
buffer_load_dwordx4 v16, s[4:7], s44 offen lds
s_add_u32 m0, s45, 9216
s_add_u32 s44, s56, 72
s_and_b32 s44, s44, 511
s_lshl_b32 s44, s44, 11
buffer_load_dwordx4 v16, s[4:7], s44 offen lds
s_add_u32 m0, s45, 10240
s_add_u32 s44, s56, 80
s_and_b32 s44, s44, 511
s_lshl_b32 s44, s44, 11
buffer_load_dwordx4 v16, s[4:7], s44 offen lds
s_add_u32 m0, s45, 11264
s_add_u32 s44, s56, 88
s_and_b32 s44, s44, 511
s_lshl_b32 s44, s44, 11
buffer_load_dwordx4 v16, s[4:7], s44 offen lds
s_add_u32 m0, s45, 12288
s_add_u32 s44, s56, 96
s_and_b32 s44, s44, 511
s_lshl_b32 s44, s44, 11
buffer_load_dwordx4 v16, s[4:7], s44 offen lds
s_add_u32 m0, s45, 13312
s_add_u32 s44, s56, 104
s_and_b32 s44, s44, 511
s_lshl_b32 s44, s44, 11
buffer_load_dwordx4 v16, s[4:7], s44 offen lds
s_add_u32 m0, s45, 14336
s_add_u32 s44, s56, 112
s_and_b32 s44, s44, 511
s_lshl_b32 s44, s44, 11
buffer_load_dwordx4 v16, s[4:7], s44 offen lds
s_add_u32 m0, s45, 15360
s_add_u32 s44, s56, 120
s_and_b32 s44, s44, 511
s_lshl_b32 s44, s44, 11
buffer_load_dwordx4 v16, s[4:7], s44 offen lds
s_add_u32 m0, s45, 16384
s_add_u32 s44, s56, 128
s_and_b32 s44, s44, 511
s_lshl_b32 s44, s44, 11
buffer_load_dwordx4 v16, s[4:7], s44 offen lds
s_add_u32 m0, s45, 17408
s_add_u32 s44, s56, 136
s_and_b32 s44, s44, 511
s_lshl_b32 s44, s44, 11
buffer_load_dwordx4 v16, s[4:7], s44 offen lds
s_add_u32 m0, s45, 18432
s_add_u32 s44, s56, 144
s_and_b32 s44, s44, 511
s_lshl_b32 s44, s44, 11
buffer_load_dwordx4 v16, s[4:7], s44 offen lds
s_add_u32 m0, s45, 19456
s_add_u32 s44, s56, 152
s_and_b32 s44, s44, 511
s_lshl_b32 s44, s44, 11
buffer_load_dwordx4 v16, s[4:7], s44 offen lds
s_add_u32 m0, s45, 20480
s_add_u32 s44, s56, 160
s_and_b32 s44, s44, 511
s_lshl_b32 s44, s44, 11
buffer_load_dwordx4 v16, s[4:7], s44 offen lds
s_add_u32 m0, s45, 21504
s_add_u32 s44, s56, 168
s_and_b32 s44, s44, 511
s_lshl_b32 s44, s44, 11
buffer_load_dwordx4 v16, s[4:7], s44 offen lds
s_add_u32 m0, s45, 22528
s_add_u32 s44, s56, 176
s_and_b32 s44, s44, 511
s_lshl_b32 s44, s44, 11
buffer_load_dwordx4 v16, s[4:7], s44 offen lds
s_add_u32 m0, s45, 23552
s_add_u32 s44, s56, 184
s_and_b32 s44, s44, 511
s_lshl_b32 s44, s44, 11
buffer_load_dwordx4 v16, s[4:7], s44 offen lds
s_add_u32 m0, s45, 24576
s_add_u32 s44, s56, 192
s_and_b32 s44, s44, 511
s_lshl_b32 s44, s44, 11
buffer_load_dwordx4 v16, s[4:7], s44 offen lds
s_add_u32 m0, s45, 25600
s_add_u32 s44, s56, 200
s_and_b32 s44, s44, 511
s_lshl_b32 s44, s44, 11
buffer_load_dwordx4 v16, s[4:7], s44 offen lds
s_add_u32 m0, s45, 26624
s_add_u32 s44, s56, 208
s_and_b32 s44, s44, 511
s_lshl_b32 s44, s44, 11
buffer_load_dwordx4 v16, s[4:7], s44 offen lds
s_add_u32 m0, s45, 27648
s_add_u32 s44, s56, 216
s_and_b32 s44, s44, 511
s_lshl_b32 s44, s44, 11
buffer_load_dwordx4 v16, s[4:7], s44 offen lds
s_add_u32 m0, s45, 28672
s_add_u32 s44, s56, 224
s_and_b32 s44, s44, 511
s_lshl_b32 s44, s44, 11
buffer_load_dwordx4 v16, s[4:7], s44 offen lds
s_add_u32 m0, s45, 29696
s_add_u32 s44, s56, 232
s_and_b32 s44, s44, 511
s_lshl_b32 s44, s44, 11
buffer_load_dwordx4 v16, s[4:7], s44 offen lds
s_add_u32 m0, s45, 30720
s_add_u32 s44, s56, 240
s_and_b32 s44, s44, 511
s_lshl_b32 s44, s44, 11
buffer_load_dwordx4 v16, s[4:7], s44 offen lds
s_add_u32 m0, s45, 31744
s_add_u32 s44, s56, 248
s_and_b32 s44, s44, 511
s_lshl_b32 s44, s44, 11
buffer_load_dwordx4 v16, s[4:7], s44 offen lds
s_waitcnt vmcnt(16)
ds_read_b64_tr_b16 a[0:1], v17 offset:0
ds_read_b64_tr_b16 a[2:3], v17 offset:2048
ds_read_b64_tr_b16 a[4:5], v17 offset:64
ds_read_b64_tr_b16 a[6:7], v17 offset:2112
ds_read_b64_tr_b16 a[8:9], v17 offset:1024
ds_read_b64_tr_b16 a[10:11], v17 offset:3072
ds_read_b64_tr_b16 a[12:13], v17 offset:1088
ds_read_b64_tr_b16 a[14:15], v17 offset:3136
s_waitcnt lgkmcnt(0)
ds_read_b64_tr_b16 a[16:17], v17 offset:4096
ds_read_b64_tr_b16 a[18:19], v17 offset:6144
ds_read_b64_tr_b16 a[20:21], v17 offset:4160
ds_read_b64_tr_b16 a[22:23], v17 offset:6208
ds_read_b64_tr_b16 a[24:25], v17 offset:5120
ds_read_b64_tr_b16 a[26:27], v17 offset:7168
ds_read_b64_tr_b16 a[28:29], v17 offset:5184
ds_read_b64_tr_b16 a[30:31], v17 offset:7232
s_waitcnt lgkmcnt(0)
ds_read_b64_tr_b16 a[32:33], v17 offset:8192
ds_read_b64_tr_b16 a[34:35], v17 offset:10240
ds_read_b64_tr_b16 a[36:37], v17 offset:8256
ds_read_b64_tr_b16 a[38:39], v17 offset:10304
ds_read_b64_tr_b16 a[40:41], v17 offset:9216
ds_read_b64_tr_b16 a[42:43], v17 offset:11264
ds_read_b64_tr_b16 a[44:45], v17 offset:9280
ds_read_b64_tr_b16 a[46:47], v17 offset:11328
s_waitcnt lgkmcnt(0)
ds_read_b64_tr_b16 a[48:49], v17 offset:12288
ds_read_b64_tr_b16 a[50:51], v17 offset:14336
ds_read_b64_tr_b16 a[52:53], v17 offset:12352
ds_read_b64_tr_b16 a[54:55], v17 offset:14400
ds_read_b64_tr_b16 a[56:57], v17 offset:13312
ds_read_b64_tr_b16 a[58:59], v17 offset:15360
ds_read_b64_tr_b16 a[60:61], v17 offset:13376
ds_read_b64_tr_b16 a[62:63], v17 offset:15424
s_waitcnt lgkmcnt(0)
s_add_u32 m0, s45, 0
s_add_u32 s44, s56, 256
s_and_b32 s44, s44, 511
s_lshl_b32 s44, s44, 11
buffer_load_dwordx4 v16, s[4:7], s44 offen lds
s_add_u32 m0, s45, 1024
s_add_u32 s44, s56, 264
s_and_b32 s44, s44, 511
s_lshl_b32 s44, s44, 11
buffer_load_dwordx4 v16, s[4:7], s44 offen lds
s_add_u32 m0, s45, 2048
s_add_u32 s44, s56, 272
s_and_b32 s44, s44, 511
s_lshl_b32 s44, s44, 11
buffer_load_dwordx4 v16, s[4:7], s44 offen lds
s_add_u32 m0, s45, 3072
s_add_u32 s44, s56, 280
s_and_b32 s44, s44, 511
s_lshl_b32 s44, s44, 11
buffer_load_dwordx4 v16, s[4:7], s44 offen lds
s_add_u32 m0, s45, 4096
s_add_u32 s44, s56, 288
s_and_b32 s44, s44, 511
s_lshl_b32 s44, s44, 11
buffer_load_dwordx4 v16, s[4:7], s44 offen lds
s_add_u32 m0, s45, 5120
s_add_u32 s44, s56, 296
s_and_b32 s44, s44, 511
s_lshl_b32 s44, s44, 11
buffer_load_dwordx4 v16, s[4:7], s44 offen lds
s_add_u32 m0, s45, 6144
s_add_u32 s44, s56, 304
s_and_b32 s44, s44, 511
s_lshl_b32 s44, s44, 11
buffer_load_dwordx4 v16, s[4:7], s44 offen lds
s_add_u32 m0, s45, 7168
s_add_u32 s44, s56, 312
s_and_b32 s44, s44, 511
s_lshl_b32 s44, s44, 11
buffer_load_dwordx4 v16, s[4:7], s44 offen lds
s_add_u32 m0, s45, 8192
s_add_u32 s44, s56, 320
s_and_b32 s44, s44, 511
s_lshl_b32 s44, s44, 11
buffer_load_dwordx4 v16, s[4:7], s44 offen lds
s_add_u32 m0, s45, 9216
s_add_u32 s44, s56, 328
s_and_b32 s44, s44, 511
s_lshl_b32 s44, s44, 11
buffer_load_dwordx4 v16, s[4:7], s44 offen lds
s_add_u32 m0, s45, 10240
s_add_u32 s44, s56, 336
s_and_b32 s44, s44, 511
s_lshl_b32 s44, s44, 11
buffer_load_dwordx4 v16, s[4:7], s44 offen lds
s_add_u32 m0, s45, 11264
s_add_u32 s44, s56, 344
s_and_b32 s44, s44, 511
s_lshl_b32 s44, s44, 11
buffer_load_dwordx4 v16, s[4:7], s44 offen lds
s_add_u32 m0, s45, 12288
s_add_u32 s44, s56, 352
s_and_b32 s44, s44, 511
s_lshl_b32 s44, s44, 11
buffer_load_dwordx4 v16, s[4:7], s44 offen lds
s_add_u32 m0, s45, 13312
s_add_u32 s44, s56, 360
s_and_b32 s44, s44, 511
s_lshl_b32 s44, s44, 11
buffer_load_dwordx4 v16, s[4:7], s44 offen lds
s_add_u32 m0, s45, 14336
s_add_u32 s44, s56, 368
s_and_b32 s44, s44, 511
s_lshl_b32 s44, s44, 11
buffer_load_dwordx4 v16, s[4:7], s44 offen lds
s_add_u32 m0, s45, 15360
s_add_u32 s44, s56, 376
s_and_b32 s44, s44, 511
s_lshl_b32 s44, s44, 11
buffer_load_dwordx4 v16, s[4:7], s44 offen lds
s_waitcnt vmcnt(16)
ds_read_b64_tr_b16 a[64:65], v17 offset:16384
ds_read_b64_tr_b16 a[66:67], v17 offset:18432
ds_read_b64_tr_b16 a[68:69], v17 offset:16448
ds_read_b64_tr_b16 a[70:71], v17 offset:18496
ds_read_b64_tr_b16 a[72:73], v17 offset:17408
ds_read_b64_tr_b16 a[74:75], v17 offset:19456
ds_read_b64_tr_b16 a[76:77], v17 offset:17472
ds_read_b64_tr_b16 a[78:79], v17 offset:19520
s_waitcnt lgkmcnt(0)
ds_read_b64_tr_b16 a[80:81], v17 offset:20480
ds_read_b64_tr_b16 a[82:83], v17 offset:22528
ds_read_b64_tr_b16 a[84:85], v17 offset:20544
ds_read_b64_tr_b16 a[86:87], v17 offset:22592
ds_read_b64_tr_b16 a[88:89], v17 offset:21504
ds_read_b64_tr_b16 a[90:91], v17 offset:23552
ds_read_b64_tr_b16 a[92:93], v17 offset:21568
ds_read_b64_tr_b16 a[94:95], v17 offset:23616
s_waitcnt lgkmcnt(0)
ds_read_b64_tr_b16 a[96:97], v17 offset:24576
ds_read_b64_tr_b16 a[98:99], v17 offset:26624
ds_read_b64_tr_b16 a[100:101], v17 offset:24640
ds_read_b64_tr_b16 a[102:103], v17 offset:26688
ds_read_b64_tr_b16 a[104:105], v17 offset:25600
ds_read_b64_tr_b16 a[106:107], v17 offset:27648
ds_read_b64_tr_b16 a[108:109], v17 offset:25664
ds_read_b64_tr_b16 a[110:111], v17 offset:27712
s_waitcnt lgkmcnt(0)
ds_read_b64_tr_b16 a[112:113], v17 offset:28672
ds_read_b64_tr_b16 a[114:115], v17 offset:30720
ds_read_b64_tr_b16 a[116:117], v17 offset:28736
ds_read_b64_tr_b16 a[118:119], v17 offset:30784
ds_read_b64_tr_b16 a[120:121], v17 offset:29696
ds_read_b64_tr_b16 a[122:123], v17 offset:31744
ds_read_b64_tr_b16 a[124:125], v17 offset:29760
ds_read_b64_tr_b16 a[126:127], v17 offset:31808
s_waitcnt lgkmcnt(0)
s_add_u32 m0, s45, 16384
s_add_u32 s44, s56, 384
s_and_b32 s44, s44, 511
s_lshl_b32 s44, s44, 11
buffer_load_dwordx4 v16, s[4:7], s44 offen lds
s_add_u32 m0, s45, 17408
s_add_u32 s44, s56, 392
s_and_b32 s44, s44, 511
s_lshl_b32 s44, s44, 11
buffer_load_dwordx4 v16, s[4:7], s44 offen lds
s_add_u32 m0, s45, 18432
s_add_u32 s44, s56, 400
s_and_b32 s44, s44, 511
s_lshl_b32 s44, s44, 11
buffer_load_dwordx4 v16, s[4:7], s44 offen lds
s_add_u32 m0, s45, 19456
s_add_u32 s44, s56, 408
s_and_b32 s44, s44, 511
s_lshl_b32 s44, s44, 11
buffer_load_dwordx4 v16, s[4:7], s44 offen lds
s_add_u32 m0, s45, 20480
s_add_u32 s44, s56, 416
s_and_b32 s44, s44, 511
s_lshl_b32 s44, s44, 11
buffer_load_dwordx4 v16, s[4:7], s44 offen lds
s_add_u32 m0, s45, 21504
s_add_u32 s44, s56, 424
s_and_b32 s44, s44, 511
s_lshl_b32 s44, s44, 11
buffer_load_dwordx4 v16, s[4:7], s44 offen lds
s_add_u32 m0, s45, 22528
s_add_u32 s44, s56, 432
s_and_b32 s44, s44, 511
s_lshl_b32 s44, s44, 11
buffer_load_dwordx4 v16, s[4:7], s44 offen lds
s_add_u32 m0, s45, 23552
s_add_u32 s44, s56, 440
s_and_b32 s44, s44, 511
s_lshl_b32 s44, s44, 11
buffer_load_dwordx4 v16, s[4:7], s44 offen lds
s_add_u32 m0, s45, 24576
s_add_u32 s44, s56, 448
s_and_b32 s44, s44, 511
s_lshl_b32 s44, s44, 11
buffer_load_dwordx4 v16, s[4:7], s44 offen lds
s_add_u32 m0, s45, 25600
s_add_u32 s44, s56, 456
s_and_b32 s44, s44, 511
s_lshl_b32 s44, s44, 11
buffer_load_dwordx4 v16, s[4:7], s44 offen lds
s_add_u32 m0, s45, 26624
s_add_u32 s44, s56, 464
s_and_b32 s44, s44, 511
s_lshl_b32 s44, s44, 11
buffer_load_dwordx4 v16, s[4:7], s44 offen lds
s_add_u32 m0, s45, 27648
s_add_u32 s44, s56, 472
s_and_b32 s44, s44, 511
s_lshl_b32 s44, s44, 11
buffer_load_dwordx4 v16, s[4:7], s44 offen lds
s_add_u32 m0, s45, 28672
s_add_u32 s44, s56, 480
s_and_b32 s44, s44, 511
s_lshl_b32 s44, s44, 11
buffer_load_dwordx4 v16, s[4:7], s44 offen lds
s_add_u32 m0, s45, 29696
s_add_u32 s44, s56, 488
s_and_b32 s44, s44, 511
s_lshl_b32 s44, s44, 11
buffer_load_dwordx4 v16, s[4:7], s44 offen lds
s_add_u32 m0, s45, 30720
s_add_u32 s44, s56, 496
s_and_b32 s44, s44, 511
s_lshl_b32 s44, s44, 11
buffer_load_dwordx4 v16, s[4:7], s44 offen lds
s_add_u32 m0, s45, 31744
s_add_u32 s44, s56, 504
s_and_b32 s44, s44, 511
s_lshl_b32 s44, s44, 11
buffer_load_dwordx4 v16, s[4:7], s44 offen lds
s_waitcnt vmcnt(16)
ds_read_b64_tr_b16 a[128:129], v17 offset:0
ds_read_b64_tr_b16 a[130:131], v17 offset:2048
ds_read_b64_tr_b16 a[132:133], v17 offset:64
ds_read_b64_tr_b16 a[134:135], v17 offset:2112
ds_read_b64_tr_b16 a[136:137], v17 offset:1024
ds_read_b64_tr_b16 a[138:139], v17 offset:3072
ds_read_b64_tr_b16 a[140:141], v17 offset:1088
ds_read_b64_tr_b16 a[142:143], v17 offset:3136
s_waitcnt lgkmcnt(0)
ds_read_b64_tr_b16 a[144:145], v17 offset:4096
ds_read_b64_tr_b16 a[146:147], v17 offset:6144
ds_read_b64_tr_b16 a[148:149], v17 offset:4160
ds_read_b64_tr_b16 a[150:151], v17 offset:6208
ds_read_b64_tr_b16 a[152:153], v17 offset:5120
ds_read_b64_tr_b16 a[154:155], v17 offset:7168
ds_read_b64_tr_b16 a[156:157], v17 offset:5184
ds_read_b64_tr_b16 a[158:159], v17 offset:7232
s_waitcnt lgkmcnt(0)
ds_read_b64_tr_b16 a[160:161], v17 offset:8192
ds_read_b64_tr_b16 a[162:163], v17 offset:10240
ds_read_b64_tr_b16 a[164:165], v17 offset:8256
ds_read_b64_tr_b16 a[166:167], v17 offset:10304
ds_read_b64_tr_b16 a[168:169], v17 offset:9216
ds_read_b64_tr_b16 a[170:171], v17 offset:11264
ds_read_b64_tr_b16 a[172:173], v17 offset:9280
ds_read_b64_tr_b16 a[174:175], v17 offset:11328
s_waitcnt lgkmcnt(0)
ds_read_b64_tr_b16 a[176:177], v17 offset:12288
ds_read_b64_tr_b16 a[178:179], v17 offset:14336
ds_read_b64_tr_b16 a[180:181], v17 offset:12352
ds_read_b64_tr_b16 a[182:183], v17 offset:14400
ds_read_b64_tr_b16 a[184:185], v17 offset:13312
ds_read_b64_tr_b16 a[186:187], v17 offset:15360
ds_read_b64_tr_b16 a[188:189], v17 offset:13376
ds_read_b64_tr_b16 a[190:191], v17 offset:15424
s_waitcnt lgkmcnt(0)
s_waitcnt vmcnt(0)
ds_read_b64_tr_b16 a[192:193], v17 offset:16384
ds_read_b64_tr_b16 a[194:195], v17 offset:18432
ds_read_b64_tr_b16 a[196:197], v17 offset:16448
ds_read_b64_tr_b16 a[198:199], v17 offset:18496
ds_read_b64_tr_b16 a[200:201], v17 offset:17408
ds_read_b64_tr_b16 a[202:203], v17 offset:19456
ds_read_b64_tr_b16 a[204:205], v17 offset:17472
ds_read_b64_tr_b16 a[206:207], v17 offset:19520
s_waitcnt lgkmcnt(0)
ds_read_b64_tr_b16 a[208:209], v17 offset:20480
ds_read_b64_tr_b16 a[210:211], v17 offset:22528
ds_read_b64_tr_b16 a[212:213], v17 offset:20544
ds_read_b64_tr_b16 a[214:215], v17 offset:22592
ds_read_b64_tr_b16 a[216:217], v17 offset:21504
ds_read_b64_tr_b16 a[218:219], v17 offset:23552
ds_read_b64_tr_b16 a[220:221], v17 offset:21568
ds_read_b64_tr_b16 a[222:223], v17 offset:23616
s_waitcnt lgkmcnt(0)
ds_read_b64_tr_b16 a[224:225], v17 offset:24576
ds_read_b64_tr_b16 a[226:227], v17 offset:26624
ds_read_b64_tr_b16 a[228:229], v17 offset:24640
ds_read_b64_tr_b16 a[230:231], v17 offset:26688
ds_read_b64_tr_b16 a[232:233], v17 offset:25600
ds_read_b64_tr_b16 a[234:235], v17 offset:27648
ds_read_b64_tr_b16 a[236:237], v17 offset:25664
ds_read_b64_tr_b16 a[238:239], v17 offset:27712
s_waitcnt lgkmcnt(0)
ds_read_b64_tr_b16 a[240:241], v17 offset:28672
ds_read_b64_tr_b16 a[242:243], v17 offset:30720
ds_read_b64_tr_b16 a[244:245], v17 offset:28736
ds_read_b64_tr_b16 a[246:247], v17 offset:30784
ds_read_b64_tr_b16 a[248:249], v17 offset:29696
ds_read_b64_tr_b16 a[250:251], v17 offset:31744
ds_read_b64_tr_b16 a[252:253], v17 offset:29760
ds_read_b64_tr_b16 a[254:255], v17 offset:31808
s_waitcnt lgkmcnt(0)
s_barrier
s_lshl_b32 s56, s56, 6
s_lshl_b32 s43, s58, 17
s_lshl_b32 s44, s41, 15
s_add_u32 s43, s43, s44
s_add_u32 s43, s43, 134217728
v_add_u32 v6, s43, v5
v_and_b32 v2, 15, v1
v_lshlrev_b32 v7, 2, v2
s_lshl_b32 s43, s58, 8
s_lshl_b32 s44, s41, 6
s_add_u32 s43, s43, s44
s_add_u32 s43, s43, 69255168
v_add_u32 v7, s43, v7
s_mul_i32 s43, s41, 8704
v_lshrrev_b32 v2, 5, v1
v_lshl_add_u32 v8, v2, 5, v5
v_add_u32 v8, s43, v8
v_and_b32 v2, 7, v1
v_mul_u32_u24 v9, 544, v2
v_lshrrev_b32 v3, 3, v1
v_lshl_add_u32 v9, v3, 4, v9
s_lshl_b32 s43, s41, 7
v_add_u32 v9, s43, v9
s_mul_i32 s43, s58, 4352
s_sub_u32 s44, 4352, s43
v_add_u32 v10, s44, v9
v_add_u32 v9, s43, v9
s_lshl_b32 s43, s41, 15
s_lshl_b32 s44, s40, 6
s_add_u32 s43, s43, s44
v_lshlrev_b32 v11, 12, v3
v_and_b32 v2, 7, v1
v_lshl_add_u32 v11, v2, 3, v11
v_add_u32 v11, s43, v11
s_lshl_b32 s43, s40, 13
s_lshl_b32 s44, s41, 10
s_add_u32 s43, s43, s44
s_add_u32 s43, s43, 67633152
s_add_u32 s43, s43, s66
v_add_u32 v13, s43, v5
v_xor_b32 v12, 8192, v13
s_mov_b32 s42, s64
s_mov_b32 s52, 0
s_mov_b32 s53, 0
s_mov_b32 s57, 0
mega_kernel_o_cold:
s_cmp_gt_i32 s52, s42
s_cbranch_scc1 mega_kernel_o_fk
mega_kernel_o_fw:
buffer_load_dword v2, v7, s[84:87], 0 offen sc1
s_waitcnt vmcnt(0)
v_min_i32_dpp v2, v2, v2 quad_perm:[1,0,3,2] row_mask:0xf bank_mask:0xf
s_nop 1
v_min_i32_dpp v2, v2, v2 quad_perm:[2,3,0,1] row_mask:0xf bank_mask:0xf
s_nop 1
v_min_i32_dpp v2, v2, v2 row_ror:4 row_mask:0xf bank_mask:0xf
s_nop 1
v_min_i32_dpp v2, v2, v2 row_ror:8 row_mask:0xf bank_mask:0xf
s_nop 0
v_readfirstlane_b32 s52, v2
s_min_i32 s52, s52, s65
s_cmp_gt_i32 s52, s42
s_cbranch_scc1 mega_kernel_o_fk
s_sleep 2
s_add_u32 s43, s52, 2
s_cmp_gt_i32 s43, s42
s_cbranch_scc1 mega_kernel_o_fw
s_sleep 48
s_branch mega_kernel_o_fw
mega_kernel_o_fk:
s_lshl_b32 s50, s42, 18
s_add_u32 s51, s56, 0
s_and_b32 s51, s51, 0x7fff
s_add_u32 s51, s51, s50
buffer_load_dwordx4 v[96:99], v6, s[84:87], s51 offen offset:0 sc1
buffer_load_dwordx4 v[100:103], v6, s[84:87], s51 offen offset:1024 sc1
buffer_load_dwordx4 v[104:107], v6, s[84:87], s51 offen offset:2048 sc1
buffer_load_dwordx4 v[108:111], v6, s[84:87], s51 offen offset:3072 sc1
s_add_u32 s51, s56, 4096
s_and_b32 s51, s51, 0x7fff
s_add_u32 s51, s51, s50
buffer_load_dwordx4 v[112:115], v6, s[84:87], s51 offen offset:0 sc1
buffer_load_dwordx4 v[116:119], v6, s[84:87], s51 offen offset:1024 sc1
buffer_load_dwordx4 v[120:123], v6, s[84:87], s51 offen offset:2048 sc1
buffer_load_dwordx4 v[124:127], v6, s[84:87], s51 offen offset:3072 sc1
s_add_u32 s51, s56, 8192
s_and_b32 s51, s51, 0x7fff
s_add_u32 s51, s51, s50
buffer_load_dwordx4 v[128:131], v6, s[84:87], s51 offen offset:0 sc1
buffer_load_dwordx4 v[132:135], v6, s[84:87], s51 offen offset:1024 sc1
buffer_load_dwordx4 v[136:139], v6, s[84:87], s51 offen offset:2048 sc1
buffer_load_dwordx4 v[140:143], v6, s[84:87], s51 offen offset:3072 sc1
s_add_u32 s51, s56, 12288
s_and_b32 s51, s51, 0x7fff
s_add_u32 s51, s51, s50
buffer_load_dwordx4 v[144:147], v6, s[84:87], s51 offen offset:0 sc1
buffer_load_dwordx4 v[148:151], v6, s[84:87], s51 offen offset:1024 sc1
buffer_load_dwordx4 v[152:155], v6, s[84:87], s51 offen offset:2048 sc1
buffer_load_dwordx4 v[156:159], v6, s[84:87], s51 offen offset:3072 sc1
s_add_u32 s51, s56, 16384
s_and_b32 s51, s51, 0x7fff
s_add_u32 s51, s51, s50
buffer_load_dwordx4 v[160:163], v6, s[84:87], s51 offen offset:0 sc1
buffer_load_dwordx4 v[164:167], v6, s[84:87], s51 offen offset:1024 sc1
buffer_load_dwordx4 v[168:171], v6, s[84:87], s51 offen offset:2048 sc1
buffer_load_dwordx4 v[172:175], v6, s[84:87], s51 offen offset:3072 sc1
s_add_u32 s51, s56, 20480
s_and_b32 s51, s51, 0x7fff
s_add_u32 s51, s51, s50
buffer_load_dwordx4 v[176:179], v6, s[84:87], s51 offen offset:0 sc1
buffer_load_dwordx4 v[180:183], v6, s[84:87], s51 offen offset:1024 sc1
buffer_load_dwordx4 v[184:187], v6, s[84:87], s51 offen offset:2048 sc1
buffer_load_dwordx4 v[188:191], v6, s[84:87], s51 offen offset:3072 sc1
s_add_u32 s51, s56, 24576
s_and_b32 s51, s51, 0x7fff
s_add_u32 s51, s51, s50
buffer_load_dwordx4 v[192:195], v6, s[84:87], s51 offen offset:0 sc1
buffer_load_dwordx4 v[196:199], v6, s[84:87], s51 offen offset:1024 sc1
buffer_load_dwordx4 v[200:203], v6, s[84:87], s51 offen offset:2048 sc1
buffer_load_dwordx4 v[204:207], v6, s[84:87], s51 offen offset:3072 sc1
s_add_u32 s51, s56, 28672
s_and_b32 s51, s51, 0x7fff
s_add_u32 s51, s51, s50
buffer_load_dwordx4 v[208:211], v6, s[84:87], s51 offen offset:0 sc1
buffer_load_dwordx4 v[212:215], v6, s[84:87], s51 offen offset:1024 sc1
buffer_load_dwordx4 v[216:219], v6, s[84:87], s51 offen offset:2048 sc1
buffer_load_dwordx4 v[220:223], v6, s[84:87], s51 offen offset:3072 sc1
mega_kernel_o_w0:
s_add_u32 s54, s42, 1
s_sub_u32 s62, s42, 1
s_lshl_b32 s50, s54, 18
s_cmp_gt_i32 s52, s54
s_cbranch_scc0 mega_kernel_o_n0
s_waitcnt vmcnt(31)
v_mfma_f32_32x32x16_bf16 v[20:35], a[0:3], v[96:99], 0
v_mfma_f32_32x32x16_bf16 v[36:51], a[4:7], v[96:99], 0
s_add_u32 s51, s56, 0
s_and_b32 s51, s51, 0x7fff
s_add_u32 s51, s51, s50
buffer_load_dwordx4 v[96:99], v6, s[84:87], s51 offen offset:0 sc1
s_waitcnt vmcnt(31)
v_mfma_f32_32x32x16_bf16 v[20:35], a[8:11], v[100:103], v[20:35]
v_mfma_f32_32x32x16_bf16 v[36:51], a[12:15], v[100:103], v[36:51]
buffer_load_dwordx4 v[100:103], v6, s[84:87], s51 offen offset:1024 sc1
s_waitcnt vmcnt(31)
v_mfma_f32_32x32x16_bf16 v[20:35], a[16:19], v[104:107], v[20:35]
v_mfma_f32_32x32x16_bf16 v[36:51], a[20:23], v[104:107], v[36:51]
buffer_load_dwordx4 v[104:107], v6, s[84:87], s51 offen offset:2048 sc1
s_waitcnt vmcnt(31)
v_mfma_f32_32x32x16_bf16 v[20:35], a[24:27], v[108:111], v[20:35]
v_mfma_f32_32x32x16_bf16 v[36:51], a[28:31], v[108:111], v[36:51]
buffer_load_dwordx4 v[108:111], v6, s[84:87], s51 offen offset:3072 sc1
s_waitcnt vmcnt(31)
v_mfma_f32_32x32x16_bf16 v[20:35], a[32:35], v[112:115], v[20:35]
v_mfma_f32_32x32x16_bf16 v[36:51], a[36:39], v[112:115], v[36:51]
s_add_u32 s51, s56, 4096
s_and_b32 s51, s51, 0x7fff
s_add_u32 s51, s51, s50
buffer_load_dwordx4 v[112:115], v6, s[84:87], s51 offen offset:0 sc1
s_waitcnt vmcnt(31)
v_mfma_f32_32x32x16_bf16 v[20:35], a[40:43], v[116:119], v[20:35]
v_mfma_f32_32x32x16_bf16 v[36:51], a[44:47], v[116:119], v[36:51]
buffer_load_dwordx4 v[116:119], v6, s[84:87], s51 offen offset:1024 sc1
s_waitcnt vmcnt(31)
v_mfma_f32_32x32x16_bf16 v[20:35], a[48:51], v[120:123], v[20:35]
v_mfma_f32_32x32x16_bf16 v[36:51], a[52:55], v[120:123], v[36:51]
buffer_load_dwordx4 v[120:123], v6, s[84:87], s51 offen offset:2048 sc1
s_waitcnt vmcnt(31)
v_mfma_f32_32x32x16_bf16 v[20:35], a[56:59], v[124:127], v[20:35]
v_mfma_f32_32x32x16_bf16 v[36:51], a[60:63], v[124:127], v[36:51]
buffer_load_dwordx4 v[124:127], v6, s[84:87], s51 offen offset:3072 sc1
s_waitcnt vmcnt(31)
v_mfma_f32_32x32x16_bf16 v[20:35], a[64:67], v[128:131], v[20:35]
v_mfma_f32_32x32x16_bf16 v[36:51], a[68:71], v[128:131], v[36:51]
s_add_u32 s51, s56, 8192
s_and_b32 s51, s51, 0x7fff
s_add_u32 s51, s51, s50
buffer_load_dwordx4 v[128:131], v6, s[84:87], s51 offen offset:0 sc1
s_waitcnt vmcnt(31)
v_mfma_f32_32x32x16_bf16 v[20:35], a[72:75], v[132:135], v[20:35]
v_mfma_f32_32x32x16_bf16 v[36:51], a[76:79], v[132:135], v[36:51]
buffer_load_dwordx4 v[132:135], v6, s[84:87], s51 offen offset:1024 sc1
s_waitcnt vmcnt(31)
v_mfma_f32_32x32x16_bf16 v[20:35], a[80:83], v[136:139], v[20:35]
v_mfma_f32_32x32x16_bf16 v[36:51], a[84:87], v[136:139], v[36:51]
buffer_load_dwordx4 v[136:139], v6, s[84:87], s51 offen offset:2048 sc1
s_waitcnt vmcnt(31)
v_mfma_f32_32x32x16_bf16 v[20:35], a[88:91], v[140:143], v[20:35]
v_mfma_f32_32x32x16_bf16 v[36:51], a[92:95], v[140:143], v[36:51]
buffer_load_dwordx4 v[140:143], v6, s[84:87], s51 offen offset:3072 sc1
s_waitcnt vmcnt(31)
v_mfma_f32_32x32x16_bf16 v[20:35], a[96:99], v[144:147], v[20:35]
v_mfma_f32_32x32x16_bf16 v[36:51], a[100:103], v[144:147], v[36:51]
s_add_u32 s51, s56, 12288
s_and_b32 s51, s51, 0x7fff
s_add_u32 s51, s51, s50
buffer_load_dwordx4 v[144:147], v6, s[84:87], s51 offen offset:0 sc1
s_waitcnt vmcnt(31)
v_mfma_f32_32x32x16_bf16 v[20:35], a[104:107], v[148:151], v[20:35]
v_mfma_f32_32x32x16_bf16 v[36:51], a[108:111], v[148:151], v[36:51]
buffer_load_dwordx4 v[148:151], v6, s[84:87], s51 offen offset:1024 sc1
s_waitcnt vmcnt(31)
v_mfma_f32_32x32x16_bf16 v[20:35], a[112:115], v[152:155], v[20:35]
v_mfma_f32_32x32x16_bf16 v[36:51], a[116:119], v[152:155], v[36:51]
buffer_load_dwordx4 v[152:155], v6, s[84:87], s51 offen offset:2048 sc1
s_waitcnt vmcnt(31)
v_mfma_f32_32x32x16_bf16 v[20:35], a[120:123], v[156:159], v[20:35]
v_mfma_f32_32x32x16_bf16 v[36:51], a[124:127], v[156:159], v[36:51]
buffer_load_dwordx4 v[156:159], v6, s[84:87], s51 offen offset:3072 sc1
s_waitcnt vmcnt(31)
v_mfma_f32_32x32x16_bf16 v[20:35], a[128:131], v[160:163], v[20:35]
v_mfma_f32_32x32x16_bf16 v[36:51], a[132:135], v[160:163], v[36:51]
s_add_u32 s51, s56, 16384
s_and_b32 s51, s51, 0x7fff
s_add_u32 s51, s51, s50
buffer_load_dwordx4 v[160:163], v6, s[84:87], s51 offen offset:0 sc1
s_waitcnt vmcnt(31)
v_mfma_f32_32x32x16_bf16 v[20:35], a[136:139], v[164:167], v[20:35]
v_mfma_f32_32x32x16_bf16 v[36:51], a[140:143], v[164:167], v[36:51]
buffer_load_dwordx4 v[164:167], v6, s[84:87], s51 offen offset:1024 sc1
s_waitcnt vmcnt(31)
v_mfma_f32_32x32x16_bf16 v[20:35], a[144:147], v[168:171], v[20:35]
v_mfma_f32_32x32x16_bf16 v[36:51], a[148:151], v[168:171], v[36:51]
buffer_load_dwordx4 v[168:171], v6, s[84:87], s51 offen offset:2048 sc1
s_waitcnt vmcnt(31)
v_mfma_f32_32x32x16_bf16 v[20:35], a[152:155], v[172:175], v[20:35]
v_mfma_f32_32x32x16_bf16 v[36:51], a[156:159], v[172:175], v[36:51]
buffer_load_dwordx4 v[172:175], v6, s[84:87], s51 offen offset:3072 sc1
s_waitcnt vmcnt(31)
v_mfma_f32_32x32x16_bf16 v[20:35], a[160:163], v[176:179], v[20:35]
v_mfma_f32_32x32x16_bf16 v[36:51], a[164:167], v[176:179], v[36:51]
s_add_u32 s51, s56, 20480
s_and_b32 s51, s51, 0x7fff
s_add_u32 s51, s51, s50
buffer_load_dwordx4 v[176:179], v6, s[84:87], s51 offen offset:0 sc1
s_waitcnt vmcnt(31)
v_mfma_f32_32x32x16_bf16 v[20:35], a[168:171], v[180:183], v[20:35]
v_mfma_f32_32x32x16_bf16 v[36:51], a[172:175], v[180:183], v[36:51]
buffer_load_dwordx4 v[180:183], v6, s[84:87], s51 offen offset:1024 sc1
s_waitcnt vmcnt(31)
v_mfma_f32_32x32x16_bf16 v[20:35], a[176:179], v[184:187], v[20:35]
v_mfma_f32_32x32x16_bf16 v[36:51], a[180:183], v[184:187], v[36:51]
buffer_load_dwordx4 v[184:187], v6, s[84:87], s51 offen offset:2048 sc1
s_waitcnt vmcnt(31)
v_mfma_f32_32x32x16_bf16 v[20:35], a[184:187], v[188:191], v[20:35]
v_mfma_f32_32x32x16_bf16 v[36:51], a[188:191], v[188:191], v[36:51]
buffer_load_dwordx4 v[188:191], v6, s[84:87], s51 offen offset:3072 sc1
s_waitcnt vmcnt(31)
v_mfma_f32_32x32x16_bf16 v[20:35], a[192:195], v[192:195], v[20:35]
v_mfma_f32_32x32x16_bf16 v[36:51], a[196:199], v[192:195], v[36:51]
s_add_u32 s51, s56, 24576
s_and_b32 s51, s51, 0x7fff
s_add_u32 s51, s51, s50
buffer_load_dwordx4 v[192:195], v6, s[84:87], s51 offen offset:0 sc1
s_waitcnt vmcnt(31)
v_mfma_f32_32x32x16_bf16 v[20:35], a[200:203], v[196:199], v[20:35]
v_mfma_f32_32x32x16_bf16 v[36:51], a[204:207], v[196:199], v[36:51]
buffer_load_dwordx4 v[196:199], v6, s[84:87], s51 offen offset:1024 sc1
s_waitcnt vmcnt(31)
v_mfma_f32_32x32x16_bf16 v[20:35], a[208:211], v[200:203], v[20:35]
v_mfma_f32_32x32x16_bf16 v[36:51], a[212:215], v[200:203], v[36:51]
buffer_load_dwordx4 v[200:203], v6, s[84:87], s51 offen offset:2048 sc1
s_waitcnt vmcnt(31)
v_mfma_f32_32x32x16_bf16 v[20:35], a[216:219], v[204:207], v[20:35]
v_mfma_f32_32x32x16_bf16 v[36:51], a[220:223], v[204:207], v[36:51]
buffer_load_dwordx4 v[204:207], v6, s[84:87], s51 offen offset:3072 sc1
s_waitcnt vmcnt(31)
v_mfma_f32_32x32x16_bf16 v[20:35], a[224:227], v[208:211], v[20:35]
v_mfma_f32_32x32x16_bf16 v[36:51], a[228:231], v[208:211], v[36:51]
s_add_u32 s51, s56, 28672
s_and_b32 s51, s51, 0x7fff
s_add_u32 s51, s51, s50
buffer_load_dwordx4 v[208:211], v6, s[84:87], s51 offen offset:0 sc1
s_waitcnt vmcnt(31)
v_mfma_f32_32x32x16_bf16 v[20:35], a[232:235], v[212:215], v[20:35]
v_mfma_f32_32x32x16_bf16 v[36:51], a[236:239], v[212:215], v[36:51]
buffer_load_dwordx4 v[212:215], v6, s[84:87], s51 offen offset:1024 sc1
s_waitcnt vmcnt(31)
v_mfma_f32_32x32x16_bf16 v[20:35], a[240:243], v[216:219], v[20:35]
v_mfma_f32_32x32x16_bf16 v[36:51], a[244:247], v[216:219], v[36:51]
buffer_load_dwordx4 v[216:219], v6, s[84:87], s51 offen offset:2048 sc1
s_waitcnt vmcnt(31)
v_mfma_f32_32x32x16_bf16 v[224:239], a[248:251], v[220:223], v[20:35]
v_mfma_f32_32x32x16_bf16 v[240:255], a[252:255], v[220:223], v[36:51]
buffer_load_dwordx4 v[220:223], v6, s[84:87], s51 offen offset:3072 sc1
s_add_u32 s42, s42, 1
s_branch mega_kernel_o_w1
mega_kernel_o_n0:
s_waitcnt vmcnt(31)
v_mfma_f32_32x32x16_bf16 v[20:35], a[0:3], v[96:99], 0
v_mfma_f32_32x32x16_bf16 v[36:51], a[4:7], v[96:99], 0
s_waitcnt vmcnt(30)
v_mfma_f32_32x32x16_bf16 v[20:35], a[8:11], v[100:103], v[20:35]
v_mfma_f32_32x32x16_bf16 v[36:51], a[12:15], v[100:103], v[36:51]
s_waitcnt vmcnt(29)
v_mfma_f32_32x32x16_bf16 v[20:35], a[16:19], v[104:107], v[20:35]
v_mfma_f32_32x32x16_bf16 v[36:51], a[20:23], v[104:107], v[36:51]
s_waitcnt vmcnt(28)
v_mfma_f32_32x32x16_bf16 v[20:35], a[24:27], v[108:111], v[20:35]
v_mfma_f32_32x32x16_bf16 v[36:51], a[28:31], v[108:111], v[36:51]
s_waitcnt vmcnt(27)
v_mfma_f32_32x32x16_bf16 v[20:35], a[32:35], v[112:115], v[20:35]
v_mfma_f32_32x32x16_bf16 v[36:51], a[36:39], v[112:115], v[36:51]
s_waitcnt vmcnt(26)
v_mfma_f32_32x32x16_bf16 v[20:35], a[40:43], v[116:119], v[20:35]
v_mfma_f32_32x32x16_bf16 v[36:51], a[44:47], v[116:119], v[36:51]
s_waitcnt vmcnt(25)
v_mfma_f32_32x32x16_bf16 v[20:35], a[48:51], v[120:123], v[20:35]
v_mfma_f32_32x32x16_bf16 v[36:51], a[52:55], v[120:123], v[36:51]
s_waitcnt vmcnt(24)
v_mfma_f32_32x32x16_bf16 v[20:35], a[56:59], v[124:127], v[20:35]
v_mfma_f32_32x32x16_bf16 v[36:51], a[60:63], v[124:127], v[36:51]
s_waitcnt vmcnt(23)
v_mfma_f32_32x32x16_bf16 v[20:35], a[64:67], v[128:131], v[20:35]
v_mfma_f32_32x32x16_bf16 v[36:51], a[68:71], v[128:131], v[36:51]
s_waitcnt vmcnt(22)
v_mfma_f32_32x32x16_bf16 v[20:35], a[72:75], v[132:135], v[20:35]
v_mfma_f32_32x32x16_bf16 v[36:51], a[76:79], v[132:135], v[36:51]
s_waitcnt vmcnt(21)
v_mfma_f32_32x32x16_bf16 v[20:35], a[80:83], v[136:139], v[20:35]
v_mfma_f32_32x32x16_bf16 v[36:51], a[84:87], v[136:139], v[36:51]
s_waitcnt vmcnt(20)
v_mfma_f32_32x32x16_bf16 v[20:35], a[88:91], v[140:143], v[20:35]
v_mfma_f32_32x32x16_bf16 v[36:51], a[92:95], v[140:143], v[36:51]
s_waitcnt vmcnt(19)
v_mfma_f32_32x32x16_bf16 v[20:35], a[96:99], v[144:147], v[20:35]
v_mfma_f32_32x32x16_bf16 v[36:51], a[100:103], v[144:147], v[36:51]
s_waitcnt vmcnt(18)
v_mfma_f32_32x32x16_bf16 v[20:35], a[104:107], v[148:151], v[20:35]
v_mfma_f32_32x32x16_bf16 v[36:51], a[108:111], v[148:151], v[36:51]
s_waitcnt vmcnt(17)
v_mfma_f32_32x32x16_bf16 v[20:35], a[112:115], v[152:155], v[20:35]
v_mfma_f32_32x32x16_bf16 v[36:51], a[116:119], v[152:155], v[36:51]
s_waitcnt vmcnt(16)
v_mfma_f32_32x32x16_bf16 v[20:35], a[120:123], v[156:159], v[20:35]
v_mfma_f32_32x32x16_bf16 v[36:51], a[124:127], v[156:159], v[36:51]
s_waitcnt vmcnt(15)
v_mfma_f32_32x32x16_bf16 v[20:35], a[128:131], v[160:163], v[20:35]
v_mfma_f32_32x32x16_bf16 v[36:51], a[132:135], v[160:163], v[36:51]
s_waitcnt vmcnt(14)
v_mfma_f32_32x32x16_bf16 v[20:35], a[136:139], v[164:167], v[20:35]
v_mfma_f32_32x32x16_bf16 v[36:51], a[140:143], v[164:167], v[36:51]
s_waitcnt vmcnt(13)
v_mfma_f32_32x32x16_bf16 v[20:35], a[144:147], v[168:171], v[20:35]
v_mfma_f32_32x32x16_bf16 v[36:51], a[148:151], v[168:171], v[36:51]
s_waitcnt vmcnt(12)
v_mfma_f32_32x32x16_bf16 v[20:35], a[152:155], v[172:175], v[20:35]
v_mfma_f32_32x32x16_bf16 v[36:51], a[156:159], v[172:175], v[36:51]
s_waitcnt vmcnt(11)
v_mfma_f32_32x32x16_bf16 v[20:35], a[160:163], v[176:179], v[20:35]
v_mfma_f32_32x32x16_bf16 v[36:51], a[164:167], v[176:179], v[36:51]
buffer_load_dword v15, v7, s[84:87], 0 offen sc1
s_waitcnt vmcnt(10)
v_mfma_f32_32x32x16_bf16 v[20:35], a[168:171], v[180:183], v[20:35]
v_mfma_f32_32x32x16_bf16 v[36:51], a[172:175], v[180:183], v[36:51]
s_waitcnt vmcnt(9)
v_mfma_f32_32x32x16_bf16 v[20:35], a[176:179], v[184:187], v[20:35]
v_mfma_f32_32x32x16_bf16 v[36:51], a[180:183], v[184:187], v[36:51]
s_waitcnt vmcnt(8)
v_mfma_f32_32x32x16_bf16 v[20:35], a[184:187], v[188:191], v[20:35]
v_mfma_f32_32x32x16_bf16 v[36:51], a[188:191], v[188:191], v[36:51]
s_waitcnt vmcnt(7)
v_mfma_f32_32x32x16_bf16 v[20:35], a[192:195], v[192:195], v[20:35]
v_mfma_f32_32x32x16_bf16 v[36:51], a[196:199], v[192:195], v[36:51]
s_waitcnt vmcnt(6)
v_mfma_f32_32x32x16_bf16 v[20:35], a[200:203], v[196:199], v[20:35]
v_mfma_f32_32x32x16_bf16 v[36:51], a[204:207], v[196:199], v[36:51]
s_waitcnt vmcnt(5)
v_mfma_f32_32x32x16_bf16 v[20:35], a[208:211], v[200:203], v[20:35]
v_mfma_f32_32x32x16_bf16 v[36:51], a[212:215], v[200:203], v[36:51]
s_waitcnt vmcnt(4)
v_mfma_f32_32x32x16_bf16 v[20:35], a[216:219], v[204:207], v[20:35]
v_mfma_f32_32x32x16_bf16 v[36:51], a[220:223], v[204:207], v[36:51]
s_waitcnt vmcnt(3)
v_mfma_f32_32x32x16_bf16 v[20:35], a[224:227], v[208:211], v[20:35]
v_mfma_f32_32x32x16_bf16 v[36:51], a[228:231], v[208:211], v[36:51]
s_waitcnt vmcnt(2)
v_mfma_f32_32x32x16_bf16 v[20:35], a[232:235], v[212:215], v[20:35]
v_mfma_f32_32x32x16_bf16 v[36:51], a[236:239], v[212:215], v[36:51]
s_waitcnt vmcnt(1)
v_mfma_f32_32x32x16_bf16 v[20:35], a[240:243], v[216:219], v[20:35]
v_mfma_f32_32x32x16_bf16 v[36:51], a[244:247], v[216:219], v[36:51]
s_waitcnt vmcnt(0)
v_mfma_f32_32x32x16_bf16 v[224:239], a[248:251], v[220:223], v[20:35]
v_mfma_f32_32x32x16_bf16 v[240:255], a[252:255], v[220:223], v[36:51]
s_branch mega_kernel_o_imm
mega_kernel_o_w1:
s_add_u32 s54, s42, 1
s_sub_u32 s62, s42, 1
s_lshl_b32 s50, s54, 18
s_cmp_gt_i32 s52, s54
s_cbranch_scc0 mega_kernel_o_n1
s_waitcnt vmcnt(31)
v_mfma_f32_32x32x16_bf16 v[20:35], a[0:3], v[96:99], 0
v_mfma_f32_32x32x16_bf16 v[36:51], a[4:7], v[96:99], 0
s_add_u32 s51, s56, 0
s_and_b32 s51, s51, 0x7fff
s_add_u32 s51, s51, s50
buffer_load_dwordx4 v[96:99], v6, s[84:87], s51 offen offset:0 sc1
s_waitcnt vmcnt(31)
v_mfma_f32_32x32x16_bf16 v[20:35], a[8:11], v[100:103], v[20:35]
v_mfma_f32_32x32x16_bf16 v[36:51], a[12:15], v[100:103], v[36:51]
buffer_load_dwordx4 v[100:103], v6, s[84:87], s51 offen offset:1024 sc1
v_add_u32 v2, s53, v8
v_add_u32 v3, s53, v9
v_add_u32 v4, s53, v10
s_waitcnt vmcnt(31)
v_mfma_f32_32x32x16_bf16 v[20:35], a[16:19], v[104:107], v[20:35]
v_mfma_f32_32x32x16_bf16 v[36:51], a[20:23], v[104:107], v[36:51]
buffer_load_dwordx4 v[104:107], v6, s[84:87], s51 offen offset:2048 sc1
ds_write_b128 v2, v[224:227] offset:0
ds_write_b128 v2, v[228:231] offset:1088
s_waitcnt vmcnt(31)
v_mfma_f32_32x32x16_bf16 v[20:35], a[24:27], v[108:111], v[20:35]
v_mfma_f32_32x32x16_bf16 v[36:51], a[28:31], v[108:111], v[36:51]
buffer_load_dwordx4 v[108:111], v6, s[84:87], s51 offen offset:3072 sc1
ds_write_b128 v2, v[232:235] offset:2176
ds_write_b128 v2, v[236:239] offset:3264
s_waitcnt vmcnt(31)
v_mfma_f32_32x32x16_bf16 v[20:35], a[32:35], v[112:115], v[20:35]
v_mfma_f32_32x32x16_bf16 v[36:51], a[36:39], v[112:115], v[36:51]
s_add_u32 s51, s56, 4096
s_and_b32 s51, s51, 0x7fff
s_add_u32 s51, s51, s50
buffer_load_dwordx4 v[112:115], v6, s[84:87], s51 offen offset:0 sc1
ds_write_b128 v2, v[240:243] offset:4352
ds_write_b128 v2, v[244:247] offset:5440
s_waitcnt vmcnt(31)
v_mfma_f32_32x32x16_bf16 v[20:35], a[40:43], v[116:119], v[20:35]
v_mfma_f32_32x32x16_bf16 v[36:51], a[44:47], v[116:119], v[36:51]
buffer_load_dwordx4 v[116:119], v6, s[84:87], s51 offen offset:1024 sc1
ds_write_b128 v2, v[248:251] offset:6528
ds_write_b128 v2, v[252:255] offset:7616
s_waitcnt vmcnt(31)
v_mfma_f32_32x32x16_bf16 v[20:35], a[48:51], v[120:123], v[20:35]
v_mfma_f32_32x32x16_bf16 v[36:51], a[52:55], v[120:123], v[36:51]
buffer_load_dwordx4 v[120:123], v6, s[84:87], s51 offen offset:2048 sc1
s_waitcnt vmcnt(31)
v_mfma_f32_32x32x16_bf16 v[20:35], a[56:59], v[124:127], v[20:35]
v_mfma_f32_32x32x16_bf16 v[36:51], a[60:63], v[124:127], v[36:51]
buffer_load_dwordx4 v[124:127], v6, s[84:87], s51 offen offset:3072 sc1
s_waitcnt lgkmcnt(0)
s_barrier
ds_read_b128 v[52:55], v4 offset:0
ds_read_b128 v[56:59], v4 offset:8704
ds_read_b128 v[60:63], v4 offset:17408
ds_read_b128 v[64:67], v4 offset:26112
s_waitcnt vmcnt(31)
v_mfma_f32_32x32x16_bf16 v[20:35], a[64:67], v[128:131], v[20:35]
v_mfma_f32_32x32x16_bf16 v[36:51], a[68:71], v[128:131], v[36:51]
s_add_u32 s51, s56, 8192
s_and_b32 s51, s51, 0x7fff
s_add_u32 s51, s51, s50
buffer_load_dwordx4 v[128:131], v6, s[84:87], s51 offen offset:0 sc1
ds_read_b128 v[68:71], v3 offset:0
ds_read_b128 v[72:75], v3 offset:8704
ds_read_b128 v[76:79], v3 offset:17408
ds_read_b128 v[80:83], v3 offset:26112
s_sub_u32 s53, 34816, s53
s_bfe_u32 s61, s62, 0x10001
s_xor_b32 s61, s61, s67
s_and_b32 s60, s62, 1
s_lshl_b32 s60, s60, 12
s_waitcnt vmcnt(31)
v_mfma_f32_32x32x16_bf16 v[20:35], a[72:75], v[132:135], v[20:35]
v_mfma_f32_32x32x16_bf16 v[36:51], a[76:79], v[132:135], v[36:51]
buffer_load_dwordx4 v[132:135], v6, s[84:87], s51 offen offset:1024 sc1
s_waitcnt vmcnt(31)
v_mfma_f32_32x32x16_bf16 v[20:35], a[80:83], v[136:139], v[20:35]
v_mfma_f32_32x32x16_bf16 v[36:51], a[84:87], v[136:139], v[36:51]
buffer_load_dwordx4 v[136:139], v6, s[84:87], s51 offen offset:2048 sc1
s_waitcnt lgkmcnt(4)
v_add_f32 v52, v52, v56
v_add_f32 v60, v60, v64
v_add_f32 v53, v53, v57
v_add_f32 v61, v61, v65
v_add_f32 v54, v54, v58
v_add_f32 v62, v62, v66
v_add_f32 v55, v55, v59
v_add_f32 v63, v63, v67
s_waitcnt vmcnt(31)
v_mfma_f32_32x32x16_bf16 v[20:35], a[88:91], v[140:143], v[20:35]
v_mfma_f32_32x32x16_bf16 v[36:51], a[92:95], v[140:143], v[36:51]
buffer_load_dwordx4 v[140:143], v6, s[84:87], s51 offen offset:3072 sc1
v_add_f32 v52, v52, v60
v_add_f32 v53, v53, v61
v_add_f32 v54, v54, v62
v_add_f32 v55, v55, v63
v_and_or_b32 v52, v52, -2, s61
s_cmp_eq_u32 s95, 0
s_cbranch_scc1 mega_kernel_o_sa1
buffer_store_dwordx4 v[52:55], v12, s[84:87], s60 offen sc1
s_branch mega_kernel_o_sb1
mega_kernel_o_sa1:
buffer_store_dwordx4 v[52:55], v12, s[84:87], s60 offen
mega_kernel_o_sb1:
s_waitcnt vmcnt(31)
v_mfma_f32_32x32x16_bf16 v[20:35], a[96:99], v[144:147], v[20:35]
v_mfma_f32_32x32x16_bf16 v[36:51], a[100:103], v[144:147], v[36:51]
s_add_u32 s51, s56, 12288
s_and_b32 s51, s51, 0x7fff
s_add_u32 s51, s51, s50
buffer_load_dwordx4 v[144:147], v6, s[84:87], s51 offen offset:0 sc1
s_waitcnt lgkmcnt(0)
v_add_f32 v68, v68, v72
v_add_f32 v76, v76, v80
v_add_f32 v69, v69, v73
v_add_f32 v77, v77, v81
v_add_f32 v70, v70, v74
v_add_f32 v78, v78, v82
v_add_f32 v71, v71, v75
v_add_f32 v79, v79, v83
s_waitcnt vmcnt(31)
v_mfma_f32_32x32x16_bf16 v[20:35], a[104:107], v[148:151], v[20:35]
v_mfma_f32_32x32x16_bf16 v[36:51], a[108:111], v[148:151], v[36:51]
buffer_load_dwordx4 v[148:151], v6, s[84:87], s51 offen offset:1024 sc1
v_add_f32 v84, v68, v76
v_add_f32 v85, v69, v77
v_add_f32 v86, v70, v78
v_add_f32 v87, v71, v79
s_waitcnt vmcnt(31)
v_mfma_f32_32x32x16_bf16 v[20:35], a[112:115], v[152:155], v[20:35]
v_mfma_f32_32x32x16_bf16 v[36:51], a[116:119], v[152:155], v[36:51]
buffer_load_dwordx4 v[152:155], v6, s[84:87], s51 offen offset:2048 sc1
s_waitcnt vmcnt(31)
v_mfma_f32_32x32x16_bf16 v[20:35], a[120:123], v[156:159], v[20:35]
v_mfma_f32_32x32x16_bf16 v[36:51], a[124:127], v[156:159], v[36:51]
buffer_load_dwordx4 v[156:159], v6, s[84:87], s51 offen offset:3072 sc1
s_waitcnt vmcnt(31)
v_mfma_f32_32x32x16_bf16 v[20:35], a[128:131], v[160:163], v[20:35]
v_mfma_f32_32x32x16_bf16 v[36:51], a[132:135], v[160:163], v[36:51]
s_add_u32 s51, s56, 16384
s_and_b32 s51, s51, 0x7fff
s_add_u32 s51, s51, s50
buffer_load_dwordx4 v[160:163], v6, s[84:87], s51 offen offset:0 sc1
s_waitcnt vmcnt(31)
v_mfma_f32_32x32x16_bf16 v[20:35], a[136:139], v[164:167], v[20:35]
v_mfma_f32_32x32x16_bf16 v[36:51], a[140:143], v[164:167], v[36:51]
buffer_load_dwordx4 v[164:167], v6, s[84:87], s51 offen offset:1024 sc1
s_waitcnt vmcnt(31)
v_mfma_f32_32x32x16_bf16 v[20:35], a[144:147], v[168:171], v[20:35]
v_mfma_f32_32x32x16_bf16 v[36:51], a[148:151], v[168:171], v[36:51]
buffer_load_dwordx4 v[168:171], v6, s[84:87], s51 offen offset:2048 sc1
s_waitcnt vmcnt(31)
v_mfma_f32_32x32x16_bf16 v[20:35], a[152:155], v[172:175], v[20:35]
v_mfma_f32_32x32x16_bf16 v[36:51], a[156:159], v[172:175], v[36:51]
buffer_load_dwordx4 v[172:175], v6, s[84:87], s51 offen offset:3072 sc1
s_waitcnt vmcnt(31)
v_mfma_f32_32x32x16_bf16 v[20:35], a[160:163], v[176:179], v[20:35]
v_mfma_f32_32x32x16_bf16 v[36:51], a[164:167], v[176:179], v[36:51]
s_add_u32 s51, s56, 20480
s_and_b32 s51, s51, 0x7fff
s_add_u32 s51, s51, s50
buffer_load_dwordx4 v[176:179], v6, s[84:87], s51 offen offset:0 sc1
s_waitcnt vmcnt(31)
v_mfma_f32_32x32x16_bf16 v[20:35], a[168:171], v[180:183], v[20:35]
v_mfma_f32_32x32x16_bf16 v[36:51], a[172:175], v[180:183], v[36:51]
buffer_load_dwordx4 v[180:183], v6, s[84:87], s51 offen offset:1024 sc1
s_waitcnt vmcnt(31)
v_mfma_f32_32x32x16_bf16 v[20:35], a[176:179], v[184:187], v[20:35]
v_mfma_f32_32x32x16_bf16 v[36:51], a[180:183], v[184:187], v[36:51]
buffer_load_dwordx4 v[184:187], v6, s[84:87], s51 offen offset:2048 sc1
s_waitcnt vmcnt(31)
v_mfma_f32_32x32x16_bf16 v[20:35], a[184:187], v[188:191], v[20:35]
v_mfma_f32_32x32x16_bf16 v[36:51], a[188:191], v[188:191], v[36:51]
buffer_load_dwordx4 v[188:191], v6, s[84:87], s51 offen offset:3072 sc1
s_waitcnt vmcnt(31)
v_mfma_f32_32x32x16_bf16 v[20:35], a[192:195], v[192:195], v[20:35]
v_mfma_f32_32x32x16_bf16 v[36:51], a[196:199], v[192:195], v[36:51]
s_add_u32 s51, s56, 24576
s_and_b32 s51, s51, 0x7fff
s_add_u32 s51, s51, s50
buffer_load_dwordx4 v[192:195], v6, s[84:87], s51 offen offset:0 sc1
s_waitcnt vmcnt(31)
v_mfma_f32_32x32x16_bf16 v[20:35], a[200:203], v[196:199], v[20:35]
v_mfma_f32_32x32x16_bf16 v[36:51], a[204:207], v[196:199], v[36:51]
buffer_load_dwordx4 v[196:199], v6, s[84:87], s51 offen offset:1024 sc1
s_waitcnt vmcnt(31)
v_mfma_f32_32x32x16_bf16 v[20:35], a[208:211], v[200:203], v[20:35]
v_mfma_f32_32x32x16_bf16 v[36:51], a[212:215], v[200:203], v[36:51]
buffer_load_dwordx4 v[200:203], v6, s[84:87], s51 offen offset:2048 sc1
s_waitcnt vmcnt(31)
v_mfma_f32_32x32x16_bf16 v[20:35], a[216:219], v[204:207], v[20:35]
v_mfma_f32_32x32x16_bf16 v[36:51], a[220:223], v[204:207], v[36:51]
buffer_load_dwordx4 v[204:207], v6, s[84:87], s51 offen offset:3072 sc1
s_and_b32 s60, s62, 1
s_lshl_b32 s60, s60, 12
buffer_load_dwordx4 v[88:91], v13, s[84:87], s60 offen sc1
s_waitcnt vmcnt(31)
v_mfma_f32_32x32x16_bf16 v[20:35], a[224:227], v[208:211], v[20:35]
v_mfma_f32_32x32x16_bf16 v[36:51], a[228:231], v[208:211], v[36:51]
s_add_u32 s51, s56, 28672
s_and_b32 s51, s51, 0x7fff
s_add_u32 s51, s51, s50
buffer_load_dwordx4 v[208:211], v6, s[84:87], s51 offen offset:0 sc1
s_waitcnt vmcnt(31)
v_mfma_f32_32x32x16_bf16 v[20:35], a[232:235], v[212:215], v[20:35]
v_mfma_f32_32x32x16_bf16 v[36:51], a[236:239], v[212:215], v[36:51]
buffer_load_dwordx4 v[212:215], v6, s[84:87], s51 offen offset:1024 sc1
s_waitcnt vmcnt(31)
v_mfma_f32_32x32x16_bf16 v[20:35], a[240:243], v[216:219], v[20:35]
v_mfma_f32_32x32x16_bf16 v[36:51], a[244:247], v[216:219], v[36:51]
buffer_load_dwordx4 v[216:219], v6, s[84:87], s51 offen offset:2048 sc1
s_waitcnt vmcnt(31)
v_mfma_f32_32x32x16_bf16 v[224:239], a[248:251], v[220:223], v[20:35]
v_mfma_f32_32x32x16_bf16 v[240:255], a[252:255], v[220:223], v[36:51]
buffer_load_dwordx4 v[220:223], v6, s[84:87], s51 offen offset:3072 sc1
s_bfe_u32 s61, s62, 0x10001
s_xor_b32 s61, s61, s67
s_waitcnt vmcnt(4)
mega_kernel_o_f1c:
v_and_b32 v14, 1, v88
v_cmp_ne_u32 vcc, s61, v14
s_cbranch_vccz mega_kernel_o_f1k
s_and_b32 s60, s62, 1
s_lshl_b32 s60, s60, 12
buffer_load_dwordx4 v[88:91], v13, s[84:87], s60 offen sc1
s_waitcnt vmcnt(0)
s_branch mega_kernel_o_f1c
mega_kernel_o_f1k:
v_pk_add_f32 v[88:89], v[88:89], v[84:85]
v_pk_add_f32 v[90:91], v[90:91], v[86:87]
s_lshl_b32 s60, s62, 17
v_cvt_pk_bf16_f32 v92, v88, v89
v_cvt_pk_bf16_f32 v93, v90, v91
buffer_store_dwordx2 v[92:93], v11, s[8:11], s60 offen
s_add_u32 s42, s42, 1
s_branch mega_kernel_o_w1
mega_kernel_o_n1:
s_waitcnt vmcnt(31)
v_mfma_f32_32x32x16_bf16 v[20:35], a[0:3], v[96:99], 0
v_mfma_f32_32x32x16_bf16 v[36:51], a[4:7], v[96:99], 0
s_waitcnt vmcnt(30)
v_mfma_f32_32x32x16_bf16 v[20:35], a[8:11], v[100:103], v[20:35]
v_mfma_f32_32x32x16_bf16 v[36:51], a[12:15], v[100:103], v[36:51]
v_add_u32 v2, s53, v8
v_add_u32 v3, s53, v9
v_add_u32 v4, s53, v10
s_waitcnt vmcnt(29)
v_mfma_f32_32x32x16_bf16 v[20:35], a[16:19], v[104:107], v[20:35]
v_mfma_f32_32x32x16_bf16 v[36:51], a[20:23], v[104:107], v[36:51]
ds_write_b128 v2, v[224:227] offset:0
ds_write_b128 v2, v[228:231] offset:1088
s_waitcnt vmcnt(28)
v_mfma_f32_32x32x16_bf16 v[20:35], a[24:27], v[108:111], v[20:35]
v_mfma_f32_32x32x16_bf16 v[36:51], a[28:31], v[108:111], v[36:51]
ds_write_b128 v2, v[232:235] offset:2176
ds_write_b128 v2, v[236:239] offset:3264
s_waitcnt vmcnt(27)
v_mfma_f32_32x32x16_bf16 v[20:35], a[32:35], v[112:115], v[20:35]
v_mfma_f32_32x32x16_bf16 v[36:51], a[36:39], v[112:115], v[36:51]
ds_write_b128 v2, v[240:243] offset:4352
ds_write_b128 v2, v[244:247] offset:5440
s_waitcnt vmcnt(26)
v_mfma_f32_32x32x16_bf16 v[20:35], a[40:43], v[116:119], v[20:35]
v_mfma_f32_32x32x16_bf16 v[36:51], a[44:47], v[116:119], v[36:51]
ds_write_b128 v2, v[248:251] offset:6528
ds_write_b128 v2, v[252:255] offset:7616
s_waitcnt vmcnt(25)
v_mfma_f32_32x32x16_bf16 v[20:35], a[48:51], v[120:123], v[20:35]
v_mfma_f32_32x32x16_bf16 v[36:51], a[52:55], v[120:123], v[36:51]
s_waitcnt vmcnt(24)
v_mfma_f32_32x32x16_bf16 v[20:35], a[56:59], v[124:127], v[20:35]
v_mfma_f32_32x32x16_bf16 v[36:51], a[60:63], v[124:127], v[36:51]
s_waitcnt lgkmcnt(0)
s_barrier
ds_read_b128 v[52:55], v4 offset:0
ds_read_b128 v[56:59], v4 offset:8704
ds_read_b128 v[60:63], v4 offset:17408
ds_read_b128 v[64:67], v4 offset:26112
s_waitcnt vmcnt(23)
v_mfma_f32_32x32x16_bf16 v[20:35], a[64:67], v[128:131], v[20:35]
v_mfma_f32_32x32x16_bf16 v[36:51], a[68:71], v[128:131], v[36:51]
ds_read_b128 v[68:71], v3 offset:0
ds_read_b128 v[72:75], v3 offset:8704
ds_read_b128 v[76:79], v3 offset:17408
ds_read_b128 v[80:83], v3 offset:26112
s_sub_u32 s53, 34816, s53
s_bfe_u32 s61, s62, 0x10001
s_xor_b32 s61, s61, s67
s_and_b32 s60, s62, 1
s_lshl_b32 s60, s60, 12
s_waitcnt vmcnt(22)
v_mfma_f32_32x32x16_bf16 v[20:35], a[72:75], v[132:135], v[20:35]
v_mfma_f32_32x32x16_bf16 v[36:51], a[76:79], v[132:135], v[36:51]
s_waitcnt vmcnt(21)
v_mfma_f32_32x32x16_bf16 v[20:35], a[80:83], v[136:139], v[20:35]
v_mfma_f32_32x32x16_bf16 v[36:51], a[84:87], v[136:139], v[36:51]
s_waitcnt lgkmcnt(4)
v_add_f32 v52, v52, v56
v_add_f32 v60, v60, v64
v_add_f32 v53, v53, v57
v_add_f32 v61, v61, v65
v_add_f32 v54, v54, v58
v_add_f32 v62, v62, v66
v_add_f32 v55, v55, v59
v_add_f32 v63, v63, v67
s_waitcnt vmcnt(20)
v_mfma_f32_32x32x16_bf16 v[20:35], a[88:91], v[140:143], v[20:35]
v_mfma_f32_32x32x16_bf16 v[36:51], a[92:95], v[140:143], v[36:51]
v_add_f32 v52, v52, v60
v_add_f32 v53, v53, v61
v_add_f32 v54, v54, v62
v_add_f32 v55, v55, v63
v_and_or_b32 v52, v52, -2, s61
s_cmp_eq_u32 s95, 0
s_cbranch_scc1 mega_kernel_o_sa2
buffer_store_dwordx4 v[52:55], v12, s[84:87], s60 offen sc1
s_branch mega_kernel_o_sb2
mega_kernel_o_sa2:
buffer_store_dwordx4 v[52:55], v12, s[84:87], s60 offen
mega_kernel_o_sb2:
s_waitcnt vmcnt(19)
v_mfma_f32_32x32x16_bf16 v[20:35], a[96:99], v[144:147], v[20:35]
v_mfma_f32_32x32x16_bf16 v[36:51], a[100:103], v[144:147], v[36:51]
s_waitcnt lgkmcnt(0)
v_add_f32 v68, v68, v72
v_add_f32 v76, v76, v80
v_add_f32 v69, v69, v73
v_add_f32 v77, v77, v81
v_add_f32 v70, v70, v74
v_add_f32 v78, v78, v82
v_add_f32 v71, v71, v75
v_add_f32 v79, v79, v83
s_waitcnt vmcnt(18)
v_mfma_f32_32x32x16_bf16 v[20:35], a[104:107], v[148:151], v[20:35]
v_mfma_f32_32x32x16_bf16 v[36:51], a[108:111], v[148:151], v[36:51]
v_add_f32 v84, v68, v76
v_add_f32 v85, v69, v77
v_add_f32 v86, v70, v78
v_add_f32 v87, v71, v79
s_waitcnt vmcnt(17)
v_mfma_f32_32x32x16_bf16 v[20:35], a[112:115], v[152:155], v[20:35]
v_mfma_f32_32x32x16_bf16 v[36:51], a[116:119], v[152:155], v[36:51]
s_waitcnt vmcnt(16)
v_mfma_f32_32x32x16_bf16 v[20:35], a[120:123], v[156:159], v[20:35]
v_mfma_f32_32x32x16_bf16 v[36:51], a[124:127], v[156:159], v[36:51]
s_waitcnt vmcnt(15)
v_mfma_f32_32x32x16_bf16 v[20:35], a[128:131], v[160:163], v[20:35]
v_mfma_f32_32x32x16_bf16 v[36:51], a[132:135], v[160:163], v[36:51]
s_waitcnt vmcnt(14)
v_mfma_f32_32x32x16_bf16 v[20:35], a[136:139], v[164:167], v[20:35]
v_mfma_f32_32x32x16_bf16 v[36:51], a[140:143], v[164:167], v[36:51]
s_waitcnt vmcnt(13)
v_mfma_f32_32x32x16_bf16 v[20:35], a[144:147], v[168:171], v[20:35]
v_mfma_f32_32x32x16_bf16 v[36:51], a[148:151], v[168:171], v[36:51]
s_waitcnt vmcnt(12)
v_mfma_f32_32x32x16_bf16 v[20:35], a[152:155], v[172:175], v[20:35]
v_mfma_f32_32x32x16_bf16 v[36:51], a[156:159], v[172:175], v[36:51]
s_waitcnt vmcnt(11)
v_mfma_f32_32x32x16_bf16 v[20:35], a[160:163], v[176:179], v[20:35]
v_mfma_f32_32x32x16_bf16 v[36:51], a[164:167], v[176:179], v[36:51]
buffer_load_dword v15, v7, s[84:87], 0 offen sc1
s_waitcnt vmcnt(10)
v_mfma_f32_32x32x16_bf16 v[20:35], a[168:171], v[180:183], v[20:35]
v_mfma_f32_32x32x16_bf16 v[36:51], a[172:175], v[180:183], v[36:51]
s_waitcnt vmcnt(9)
v_mfma_f32_32x32x16_bf16 v[20:35], a[176:179], v[184:187], v[20:35]
v_mfma_f32_32x32x16_bf16 v[36:51], a[180:183], v[184:187], v[36:51]
s_waitcnt vmcnt(8)
v_mfma_f32_32x32x16_bf16 v[20:35], a[184:187], v[188:191], v[20:35]
v_mfma_f32_32x32x16_bf16 v[36:51], a[188:191], v[188:191], v[36:51]
s_waitcnt vmcnt(7)
v_mfma_f32_32x32x16_bf16 v[20:35], a[192:195], v[192:195], v[20:35]
v_mfma_f32_32x32x16_bf16 v[36:51], a[196:199], v[192:195], v[36:51]
s_waitcnt vmcnt(6)
v_mfma_f32_32x32x16_bf16 v[20:35], a[200:203], v[196:199], v[20:35]
v_mfma_f32_32x32x16_bf16 v[36:51], a[204:207], v[196:199], v[36:51]
s_waitcnt vmcnt(5)
v_mfma_f32_32x32x16_bf16 v[20:35], a[208:211], v[200:203], v[20:35]
v_mfma_f32_32x32x16_bf16 v[36:51], a[212:215], v[200:203], v[36:51]
s_waitcnt vmcnt(4)
v_mfma_f32_32x32x16_bf16 v[20:35], a[216:219], v[204:207], v[20:35]
v_mfma_f32_32x32x16_bf16 v[36:51], a[220:223], v[204:207], v[36:51]
s_and_b32 s60, s62, 1
s_lshl_b32 s60, s60, 12
buffer_load_dwordx4 v[88:91], v13, s[84:87], s60 offen sc1
s_waitcnt vmcnt(3)
v_mfma_f32_32x32x16_bf16 v[20:35], a[224:227], v[208:211], v[20:35]
v_mfma_f32_32x32x16_bf16 v[36:51], a[228:231], v[208:211], v[36:51]
s_waitcnt vmcnt(2)
v_mfma_f32_32x32x16_bf16 v[20:35], a[232:235], v[212:215], v[20:35]
v_mfma_f32_32x32x16_bf16 v[36:51], a[236:239], v[212:215], v[36:51]
s_waitcnt vmcnt(1)
v_mfma_f32_32x32x16_bf16 v[20:35], a[240:243], v[216:219], v[20:35]
v_mfma_f32_32x32x16_bf16 v[36:51], a[244:247], v[216:219], v[36:51]
s_waitcnt vmcnt(0)
v_mfma_f32_32x32x16_bf16 v[224:239], a[248:251], v[220:223], v[20:35]
v_mfma_f32_32x32x16_bf16 v[240:255], a[252:255], v[220:223], v[36:51]
s_bfe_u32 s61, s62, 0x10001
s_xor_b32 s61, s61, s67
s_waitcnt vmcnt(0)
mega_kernel_o_f0c:
v_and_b32 v14, 1, v88
v_cmp_ne_u32 vcc, s61, v14
s_cbranch_vccz mega_kernel_o_f0k
s_and_b32 s60, s62, 1
s_lshl_b32 s60, s60, 12
buffer_load_dwordx4 v[88:91], v13, s[84:87], s60 offen sc1
s_waitcnt vmcnt(0)
s_branch mega_kernel_o_f0c
mega_kernel_o_f0k:
v_pk_add_f32 v[88:89], v[88:89], v[84:85]
v_pk_add_f32 v[90:91], v[90:91], v[86:87]
s_lshl_b32 s60, s62, 17
v_cvt_pk_bf16_f32 v92, v88, v89
v_cvt_pk_bf16_f32 v93, v90, v91
buffer_store_dwordx2 v[92:93], v11, s[8:11], s60 offen
mega_kernel_o_imm:
s_waitcnt vmcnt(1)
v_min_i32_dpp v15, v15, v15 quad_perm:[1,0,3,2] row_mask:0xf bank_mask:0xf
s_nop 1
v_min_i32_dpp v15, v15, v15 quad_perm:[2,3,0,1] row_mask:0xf bank_mask:0xf
s_nop 1
v_min_i32_dpp v15, v15, v15 row_ror:4 row_mask:0xf bank_mask:0xf
s_nop 1
v_min_i32_dpp v15, v15, v15 row_ror:8 row_mask:0xf bank_mask:0xf
s_nop 0
v_readfirstlane_b32 s52, v15
s_min_i32 s52, s52, s65
s_cmp_gt_i32 s52, s54
s_cbranch_scc0 mega_kernel_o_im2
s_add_u32 s51, s56, 0
s_and_b32 s51, s51, 0x7fff
s_add_u32 s51, s51, s50
buffer_load_dwordx4 v[96:99], v6, s[84:87], s51 offen offset:0 sc1
buffer_load_dwordx4 v[100:103], v6, s[84:87], s51 offen offset:1024 sc1
buffer_load_dwordx4 v[104:107], v6, s[84:87], s51 offen offset:2048 sc1
buffer_load_dwordx4 v[108:111], v6, s[84:87], s51 offen offset:3072 sc1
s_add_u32 s51, s56, 4096
s_and_b32 s51, s51, 0x7fff
s_add_u32 s51, s51, s50
buffer_load_dwordx4 v[112:115], v6, s[84:87], s51 offen offset:0 sc1
buffer_load_dwordx4 v[116:119], v6, s[84:87], s51 offen offset:1024 sc1
buffer_load_dwordx4 v[120:123], v6, s[84:87], s51 offen offset:2048 sc1
buffer_load_dwordx4 v[124:127], v6, s[84:87], s51 offen offset:3072 sc1
s_add_u32 s51, s56, 8192
s_and_b32 s51, s51, 0x7fff
s_add_u32 s51, s51, s50
buffer_load_dwordx4 v[128:131], v6, s[84:87], s51 offen offset:0 sc1
buffer_load_dwordx4 v[132:135], v6, s[84:87], s51 offen offset:1024 sc1
buffer_load_dwordx4 v[136:139], v6, s[84:87], s51 offen offset:2048 sc1
buffer_load_dwordx4 v[140:143], v6, s[84:87], s51 offen offset:3072 sc1
s_add_u32 s51, s56, 12288
s_and_b32 s51, s51, 0x7fff
s_add_u32 s51, s51, s50
buffer_load_dwordx4 v[144:147], v6, s[84:87], s51 offen offset:0 sc1
buffer_load_dwordx4 v[148:151], v6, s[84:87], s51 offen offset:1024 sc1
buffer_load_dwordx4 v[152:155], v6, s[84:87], s51 offen offset:2048 sc1
buffer_load_dwordx4 v[156:159], v6, s[84:87], s51 offen offset:3072 sc1
s_add_u32 s51, s56, 16384
s_and_b32 s51, s51, 0x7fff
s_add_u32 s51, s51, s50
buffer_load_dwordx4 v[160:163], v6, s[84:87], s51 offen offset:0 sc1
buffer_load_dwordx4 v[164:167], v6, s[84:87], s51 offen offset:1024 sc1
buffer_load_dwordx4 v[168:171], v6, s[84:87], s51 offen offset:2048 sc1
buffer_load_dwordx4 v[172:175], v6, s[84:87], s51 offen offset:3072 sc1
s_add_u32 s51, s56, 20480
s_and_b32 s51, s51, 0x7fff
s_add_u32 s51, s51, s50
buffer_load_dwordx4 v[176:179], v6, s[84:87], s51 offen offset:0 sc1
buffer_load_dwordx4 v[180:183], v6, s[84:87], s51 offen offset:1024 sc1
buffer_load_dwordx4 v[184:187], v6, s[84:87], s51 offen offset:2048 sc1
buffer_load_dwordx4 v[188:191], v6, s[84:87], s51 offen offset:3072 sc1
s_add_u32 s51, s56, 24576
s_and_b32 s51, s51, 0x7fff
s_add_u32 s51, s51, s50
buffer_load_dwordx4 v[192:195], v6, s[84:87], s51 offen offset:0 sc1
buffer_load_dwordx4 v[196:199], v6, s[84:87], s51 offen offset:1024 sc1
buffer_load_dwordx4 v[200:203], v6, s[84:87], s51 offen offset:2048 sc1
buffer_load_dwordx4 v[204:207], v6, s[84:87], s51 offen offset:3072 sc1
s_add_u32 s51, s56, 28672
s_and_b32 s51, s51, 0x7fff
s_add_u32 s51, s51, s50
buffer_load_dwordx4 v[208:211], v6, s[84:87], s51 offen offset:0 sc1
buffer_load_dwordx4 v[212:215], v6, s[84:87], s51 offen offset:1024 sc1
buffer_load_dwordx4 v[216:219], v6, s[84:87], s51 offen offset:2048 sc1
buffer_load_dwordx4 v[220:223], v6, s[84:87], s51 offen offset:3072 sc1
s_add_u32 s42, s42, 1
s_branch mega_kernel_o_w1
mega_kernel_o_im2:
v_add_u32 v2, s53, v8
v_add_u32 v3, s53, v9
v_add_u32 v4, s53, v10
ds_write_b128 v2, v[224:227] offset:0
ds_write_b128 v2, v[228:231] offset:1088
ds_write_b128 v2, v[232:235] offset:2176
ds_write_b128 v2, v[236:239] offset:3264
ds_write_b128 v2, v[240:243] offset:4352
ds_write_b128 v2, v[244:247] offset:5440
ds_write_b128 v2, v[248:251] offset:6528
ds_write_b128 v2, v[252:255] offset:7616
s_waitcnt lgkmcnt(0)
s_barrier
ds_read_b128 v[52:55], v4 offset:0
ds_read_b128 v[56:59], v4 offset:8704
ds_read_b128 v[60:63], v4 offset:17408
ds_read_b128 v[64:67], v4 offset:26112
ds_read_b128 v[68:71], v3 offset:0
ds_read_b128 v[72:75], v3 offset:8704
ds_read_b128 v[76:79], v3 offset:17408
ds_read_b128 v[80:83], v3 offset:26112
s_sub_u32 s53, 34816, s53
s_bfe_u32 s61, s42, 0x10001
s_xor_b32 s61, s61, s67
s_and_b32 s60, s42, 1
s_lshl_b32 s60, s60, 12
s_waitcnt lgkmcnt(4)
v_add_f32 v52, v52, v56
v_add_f32 v60, v60, v64
v_add_f32 v53, v53, v57
v_add_f32 v61, v61, v65
v_add_f32 v54, v54, v58
v_add_f32 v62, v62, v66
v_add_f32 v55, v55, v59
v_add_f32 v63, v63, v67
v_add_f32 v52, v52, v60
v_add_f32 v53, v53, v61
v_add_f32 v54, v54, v62
v_add_f32 v55, v55, v63
v_and_or_b32 v52, v52, -2, s61
s_cmp_eq_u32 s95, 0
s_cbranch_scc1 mega_kernel_o_sa3
buffer_store_dwordx4 v[52:55], v12, s[84:87], s60 offen sc1
s_branch mega_kernel_o_sb3
mega_kernel_o_sa3:
buffer_store_dwordx4 v[52:55], v12, s[84:87], s60 offen
mega_kernel_o_sb3:
s_waitcnt lgkmcnt(0)
v_add_f32 v68, v68, v72
v_add_f32 v76, v76, v80
v_add_f32 v69, v69, v73
v_add_f32 v77, v77, v81
v_add_f32 v70, v70, v74
v_add_f32 v78, v78, v82
v_add_f32 v71, v71, v75
v_add_f32 v79, v79, v83
v_add_f32 v84, v68, v76
v_add_f32 v85, v69, v77
v_add_f32 v86, v70, v78
v_add_f32 v87, v71, v79
s_and_b32 s60, s42, 1
s_lshl_b32 s60, s60, 12
buffer_load_dwordx4 v[88:91], v13, s[84:87], s60 offen sc1
s_bfe_u32 s61, s42, 0x10001
s_xor_b32 s61, s61, s67
s_waitcnt vmcnt(0)
mega_kernel_o_f2c:
v_and_b32 v14, 1, v88
v_cmp_ne_u32 vcc, s61, v14
s_cbranch_vccz mega_kernel_o_f2k
s_and_b32 s60, s42, 1
s_lshl_b32 s60, s60, 12
buffer_load_dwordx4 v[88:91], v13, s[84:87], s60 offen sc1
s_waitcnt vmcnt(0)
s_branch mega_kernel_o_f2c
mega_kernel_o_f2k:
v_pk_add_f32 v[88:89], v[88:89], v[84:85]
v_pk_add_f32 v[90:91], v[90:91], v[86:87]
s_lshl_b32 s60, s42, 17
v_cvt_pk_bf16_f32 v92, v88, v89
v_cvt_pk_bf16_f32 v93, v90, v91
buffer_store_dwordx2 v[92:93], v11, s[8:11], s60 offen
s_add_u32 s42, s42, 1
s_cmp_lt_u32 s42, s65
s_cbranch_scc1 mega_kernel_o_cold
mega_kernel_o_quit:
s_endpgm
mega_kernel_exit:
s_endpgm
mega_kernel_recf:
s_load_dwordx2 s[20:21], s[0:1], 8
s_load_dwordx2 s[16:17], s[0:1], 40
s_load_dwordx2 s[4:5], s[0:1], 16
s_load_dwordx2 s[8:9], s[0:1], 24
s_load_dwordx2 s[12:13], s[0:1], 32
v_lshrrev_b32 v4, 6, v0
v_and_b32 v1, 63, v0
v_readfirstlane_b32 s24, v4
v_lshrrev_b32 v2, 4, v1
v_and_b32 v3, 15, v1
v_lshlrev_b32 v17, 4, v1
s_lshr_b32 s28, s31, 2
s_lshl_b32 s25, s30, 3
s_add_u32 s25, s25, s28
s_and_b32 s26, s31, 3
s_waitcnt lgkmcnt(0)
s_mov_b32 s22, 16384
s_mov_b32 s23, 0x00020000
s_mov_b32 s18, 8388608
s_mov_b32 s19, 0x00020000
s_mov_b32 s6, 8388608
s_mov_b32 s7, 0x00020000
s_mov_b32 s10, 8388608
s_mov_b32 s11, 0x00020000
s_mov_b32 s14, 8388608
s_mov_b32 s15, 0x00020000
s_lshl_b32 s28, s25, 8
s_lshr_b32 s29, s26, 0
s_lshl_b32 s29, s29, 6
s_add_u32 s28, s28, s29
s_lshl_b32 s29, s24, 21
s_add_u32 s28, s28, s29
v_lshrrev_b32 v4, 2, v1
v_and_b32 v5, 3, v1
v_lshlrev_b32 v40, 13, v4
v_lshl_add_u32 v40, v5, 4, v40
v_add_u32 v40, s28, v40
s_lshl_b32 s28, s30, 21
s_lshl_b32 s29, s24, 19
s_add_u32 s28, s28, s29
s_lshr_b32 s29, s31, 0
s_lshl_b32 s29, s29, 6
s_add_u32 s28, s28, s29
v_lshlrev_b32 v41, 11, v4
v_lshl_add_u32 v41, v5, 4, v41
v_add_u32 v41, s28, v41
s_lshl_b32 s47, s24, 15
s_add_u32 s47, s47, 32768
s_lshl_b32 s28, s31, 18
s_lshl_b32 s29, s24, 16
s_add_u32 s28, s28, s29
s_lshl_b32 s29, s30, 11
s_add_u32 s28, s28, s29
v_lshlrev_b32 v48, 13, v2
v_lshl_add_u32 v48, v3, 7, v48
v_add_u32 v48, s28, v48
s_lshl_b32 s28, s30, 21
s_lshl_b32 s29, s31, 16
s_add_u32 s28, s28, s29
s_lshl_b32 s29, s24, 14
s_add_u32 s28, s28, s29
v_lshlrev_b32 v49, 7, v1
v_add_u32 v49, s28, v49
s_and_b32 s76, s31, 1
s_mul_i32 s76, s76, 8
s_and_b32 s28, s31, 15
s_lshl_b32 s28, s28, 4
s_lshl_b32 s29, s24, 8
s_add_u32 s28, s28, s29
v_add_u32 v53, s28, v3
s_lshr_b32 s28, s31, 4
s_lshl_b32 s28, s28, 10
s_add_u32 s28, s28, 384
v_mov_b32 v54, s28
v_mov_b32 v55, 1920
v_cmp_gt_u32 vcc, 32, v1
s_nop 1
v_cndmask_b32 v54, v55, v54, vcc
s_lshl_b32 s29, s30, 11
v_lshl_add_u32 v51, v53, 13, v54
v_add_u32 v51, s29, v51
s_lshl_b32 s29, s30, 21
v_lshl_add_u32 v52, v53, 11, v54
v_add_u32 v52, s29, v52
buffer_load_dword v50, v51, s[8:11], 0 offen
s_xor_b32 s29, s76, 0
s_lshl_b32 s28, s29, 10
s_add_u32 s28, s28, s47
s_add_u32 m0, s28, 0
s_lshl_b32 s29, s29, 17
buffer_load_dwordx4 v40, s[8:11], s29 offen lds
s_xor_b32 s29, s76, 1
s_lshl_b32 s28, s29, 10
s_add_u32 s28, s28, s47
s_add_u32 m0, s28, 0
s_lshl_b32 s29, s29, 17
buffer_load_dwordx4 v40, s[8:11], s29 offen lds
s_xor_b32 s29, s76, 2
s_lshl_b32 s28, s29, 10
s_add_u32 s28, s28, s47
s_add_u32 m0, s28, 0
s_lshl_b32 s29, s29, 17
buffer_load_dwordx4 v40, s[8:11], s29 offen lds
s_xor_b32 s29, s76, 3
s_lshl_b32 s28, s29, 10
s_add_u32 s28, s28, s47
s_add_u32 m0, s28, 0
s_lshl_b32 s29, s29, 17
buffer_load_dwordx4 v40, s[8:11], s29 offen lds
s_xor_b32 s29, s76, 4
s_lshl_b32 s28, s29, 10
s_add_u32 s28, s28, s47
s_add_u32 m0, s28, 0
s_lshl_b32 s29, s29, 17
buffer_load_dwordx4 v40, s[8:11], s29 offen lds
s_xor_b32 s29, s76, 5
s_lshl_b32 s28, s29, 10
s_add_u32 s28, s28, s47
s_add_u32 m0, s28, 0
s_lshl_b32 s29, s29, 17
buffer_load_dwordx4 v40, s[8:11], s29 offen lds
s_xor_b32 s29, s76, 6
s_lshl_b32 s28, s29, 10
s_add_u32 s28, s28, s47
s_add_u32 m0, s28, 0
s_lshl_b32 s29, s29, 17
buffer_load_dwordx4 v40, s[8:11], s29 offen lds
s_xor_b32 s29, s76, 7
s_lshl_b32 s28, s29, 10
s_add_u32 s28, s28, s47
s_add_u32 m0, s28, 0
s_lshl_b32 s29, s29, 17
buffer_load_dwordx4 v40, s[8:11], s29 offen lds
s_xor_b32 s29, s76, 8
s_lshl_b32 s28, s29, 10
s_add_u32 s28, s28, s47
s_add_u32 m0, s28, 0
s_lshl_b32 s29, s29, 17
buffer_load_dwordx4 v40, s[8:11], s29 offen lds
s_xor_b32 s29, s76, 9
s_lshl_b32 s28, s29, 10
s_add_u32 s28, s28, s47
s_add_u32 m0, s28, 0
s_lshl_b32 s29, s29, 17
buffer_load_dwordx4 v40, s[8:11], s29 offen lds
s_xor_b32 s29, s76, 10
s_lshl_b32 s28, s29, 10
s_add_u32 s28, s28, s47
s_add_u32 m0, s28, 0
s_lshl_b32 s29, s29, 17
buffer_load_dwordx4 v40, s[8:11], s29 offen lds
s_xor_b32 s29, s76, 11
s_lshl_b32 s28, s29, 10
s_add_u32 s28, s28, s47
s_add_u32 m0, s28, 0
s_lshl_b32 s29, s29, 17
buffer_load_dwordx4 v40, s[8:11], s29 offen lds
s_xor_b32 s29, s76, 12
s_lshl_b32 s28, s29, 10
s_add_u32 s28, s28, s47
s_add_u32 m0, s28, 0
s_lshl_b32 s29, s29, 17
buffer_load_dwordx4 v40, s[8:11], s29 offen lds
s_xor_b32 s29, s76, 13
s_lshl_b32 s28, s29, 10
s_add_u32 s28, s28, s47
s_add_u32 m0, s28, 0
s_lshl_b32 s29, s29, 17
buffer_load_dwordx4 v40, s[8:11], s29 offen lds
s_xor_b32 s29, s76, 14
s_lshl_b32 s28, s29, 10
s_add_u32 s28, s28, s47
s_add_u32 m0, s28, 0
s_lshl_b32 s29, s29, 17
buffer_load_dwordx4 v40, s[8:11], s29 offen lds
s_xor_b32 s29, s76, 15
s_lshl_b32 s28, s29, 10
s_add_u32 s28, s28, s47
s_add_u32 m0, s28, 0
s_lshl_b32 s29, s29, 17
buffer_load_dwordx4 v40, s[8:11], s29 offen lds
buffer_load_dword v50, v51, s[12:15], 0 offen
s_xor_b32 s29, s76, 0
s_lshl_b32 s28, s29, 10
s_add_u32 s28, s28, s47
s_add_u32 m0, s28, 16384
s_lshl_b32 s29, s29, 17
buffer_load_dwordx4 v40, s[12:15], s29 offen lds
s_xor_b32 s29, s76, 1
s_lshl_b32 s28, s29, 10
s_add_u32 s28, s28, s47
s_add_u32 m0, s28, 16384
s_lshl_b32 s29, s29, 17
buffer_load_dwordx4 v40, s[12:15], s29 offen lds
s_xor_b32 s29, s76, 2
s_lshl_b32 s28, s29, 10
s_add_u32 s28, s28, s47
s_add_u32 m0, s28, 16384
s_lshl_b32 s29, s29, 17
buffer_load_dwordx4 v40, s[12:15], s29 offen lds
s_xor_b32 s29, s76, 3
s_lshl_b32 s28, s29, 10
s_add_u32 s28, s28, s47
s_add_u32 m0, s28, 16384
s_lshl_b32 s29, s29, 17
buffer_load_dwordx4 v40, s[12:15], s29 offen lds
s_xor_b32 s29, s76, 4
s_lshl_b32 s28, s29, 10
s_add_u32 s28, s28, s47
s_add_u32 m0, s28, 16384
s_lshl_b32 s29, s29, 17
buffer_load_dwordx4 v40, s[12:15], s29 offen lds
s_xor_b32 s29, s76, 5
s_lshl_b32 s28, s29, 10
s_add_u32 s28, s28, s47
s_add_u32 m0, s28, 16384
s_lshl_b32 s29, s29, 17
buffer_load_dwordx4 v40, s[12:15], s29 offen lds
s_xor_b32 s29, s76, 6
s_lshl_b32 s28, s29, 10
s_add_u32 s28, s28, s47
s_add_u32 m0, s28, 16384
s_lshl_b32 s29, s29, 17
buffer_load_dwordx4 v40, s[12:15], s29 offen lds
s_xor_b32 s29, s76, 7
s_lshl_b32 s28, s29, 10
s_add_u32 s28, s28, s47
s_add_u32 m0, s28, 16384
s_lshl_b32 s29, s29, 17
buffer_load_dwordx4 v40, s[12:15], s29 offen lds
s_xor_b32 s29, s76, 8
s_lshl_b32 s28, s29, 10
s_add_u32 s28, s28, s47
s_add_u32 m0, s28, 16384
s_lshl_b32 s29, s29, 17
buffer_load_dwordx4 v40, s[12:15], s29 offen lds
s_xor_b32 s29, s76, 9
s_lshl_b32 s28, s29, 10
s_add_u32 s28, s28, s47
s_add_u32 m0, s28, 16384
s_lshl_b32 s29, s29, 17
buffer_load_dwordx4 v40, s[12:15], s29 offen lds
s_xor_b32 s29, s76, 10
s_lshl_b32 s28, s29, 10
s_add_u32 s28, s28, s47
s_add_u32 m0, s28, 16384
s_lshl_b32 s29, s29, 17
buffer_load_dwordx4 v40, s[12:15], s29 offen lds
s_xor_b32 s29, s76, 11
s_lshl_b32 s28, s29, 10
s_add_u32 s28, s28, s47
s_add_u32 m0, s28, 16384
s_lshl_b32 s29, s29, 17
buffer_load_dwordx4 v40, s[12:15], s29 offen lds
s_xor_b32 s29, s76, 12
s_lshl_b32 s28, s29, 10
s_add_u32 s28, s28, s47
s_add_u32 m0, s28, 16384
s_lshl_b32 s29, s29, 17
buffer_load_dwordx4 v40, s[12:15], s29 offen lds
s_xor_b32 s29, s76, 13
s_lshl_b32 s28, s29, 10
s_add_u32 s28, s28, s47
s_add_u32 m0, s28, 16384
s_lshl_b32 s29, s29, 17
buffer_load_dwordx4 v40, s[12:15], s29 offen lds
s_xor_b32 s29, s76, 14
s_lshl_b32 s28, s29, 10
s_add_u32 s28, s28, s47
s_add_u32 m0, s28, 16384
s_lshl_b32 s29, s29, 17
buffer_load_dwordx4 v40, s[12:15], s29 offen lds
s_xor_b32 s29, s76, 15
s_lshl_b32 s28, s29, 10
s_add_u32 s28, s28, s47
s_add_u32 m0, s28, 16384
s_lshl_b32 s29, s29, 17
buffer_load_dwordx4 v40, s[12:15], s29 offen lds
s_mov_b32 s40, 0x00ff00ff
s_mov_b32 s41, 0x00ff00ff
s_mov_b32 s48, 0xff00ff00
s_mov_b32 s49, 0xff00ff00
s_mov_b32 s42, 0
s_mov_b32 s43, 0x00ff00ff
s_mov_b32 s32, 0x3e0293ee
v_mov_b32 v23, 0xff800000
v_mov_b32 v6, 0x4444
v_mov_b32 v4, 0xeeee
v_cndmask_b32 v6, v6, v4, s[48:49]
v_mov_b32 v28, -1
v_mov_b32 v29, -1
v_mov_b32 v30, -1
v_mov_b32 v31, -1
s_mul_i32 s28, s24, 4096
v_add_u32 v7, s28, v17
v_and_b32 v4, 7, v1
v_lshlrev_b32 v8, 11, v4
v_lshrrev_b32 v5, 3, v1
v_lshl_add_u32 v8, v5, 4, v8
s_lshl_b32 s28, s24, 9
v_add_u32 v8, s28, v8
s_lshl_b32 s28, s31, 9
s_lshr_b32 s29, s31, 3
s_mul_i32 s29, s29, 0
s_add_u32 s28, s28, s29
v_lshlrev_b32 v9, 3, v1
v_add_u32 v9, s28, v9
v_and_b32 v4, 7, v3
v_lshlrev_b32 v11, 7, v2
v_lshl_add_u32 v11, v4, 4, v11
v_add_u32 v22, 0, v11
s_add_u32 s28, s28, 24576
v_add_u32 v11, s28, v11
v_and_b32 v5, 1, v2
v_lshlrev_b32 v10, 7, v5
v_lshl_add_u32 v10, v4, 4, v10
v_add_u32 v10, 1024, v10
s_xor_b32 s37, s31, 1
s_mul_i32 s37, s37, 2048
s_add_u32 s37, s37, 49152
s_xor_b32 s38, s31, 2
s_mul_i32 s38, s38, 2048
s_add_u32 s38, s38, 49152
s_xor_b32 s39, s31, 3
s_mul_i32 s39, s39, 2048
s_add_u32 s39, s39, 49152
v_and_b32 v4, 1, v2
v_mul_u32_u24 v14, 576, v4
v_lshrrev_b32 v5, 1, v2
v_lshl_add_u32 v5, v5, 4, v3
v_lshl_add_u32 v14, v5, 2, v14
s_mul_i32 s28, s24, 1152
s_add_u32 s28, s28, 13312
v_add_u32 v18, s28, v14
s_mul_i32 s28, s24, 2304
v_add_u32 v14, s28, v14
v_add_u32 v15, 1152, v14
v_mul_u32_u24 v16, 144, v3
v_lshl_add_u32 v16, v2, 5, v16
v_bfe_u32 v4, v1, 1, 3
v_mul_u32_u24 v19, 144, v4
v_lshl_add_u32 v19, v2, 5, v19
v_and_b32 v4, 1, v1
v_lshl_add_u32 v19, v4, 4, v19
v_add_u32 v19, 13312, v19
s_lshl_b32 s28, s24, 10
s_add_u32 s28, s28, 9216
v_add_u32 v20, s28, v17
v_and_b32 v4, 31, v1
v_lshlrev_b32 v21, 3, v4
v_add_u32 v21, 17920, v21
v_lshrrev_b32 v4, 2, v3
v_and_b32 v42, 1, v4
v_lshrrev_b32 v43, 1, v4
v_lshrrev_b32 v44, 1, v2
v_and_b32 v45, 1, v2
v_lshl_add_u32 v46, v44, 4, v42
v_lshl_add_u32 v46, v45, 2, v46
v_lshl_add_u32 v46, v43, 3, v46
v_lshl_add_u32 v47, v44, 3, v42
v_lshl_add_u32 v47, v45, 4, v47
v_lshl_add_u32 v47, v43, 2, v47
v_and_b32 v5, 3, v3
v_lshlrev_b32 v5, 3, v5
v_lshl_add_u32 v46, v46, 6, v5
v_lshl_add_u32 v47, v47, 6, v5
s_and_b32 s28, s31, 0
s_lshl_b32 s28, s28, 6
s_add_u32 s28, s28, s47
v_add_u32 v46, s28, v46
v_add_u32 v47, s28, v47
s_waitcnt vmcnt(17)
ds_read_b64_tr_b16 a[64:65], v46 offset:0
ds_read_b64_tr_b16 a[66:67], v46 offset:128
ds_read_b64_tr_b16 a[68:69], v46 offset:2048
ds_read_b64_tr_b16 a[70:71], v46 offset:2176
ds_read_b64_tr_b16 a[72:73], v46 offset:4096
ds_read_b64_tr_b16 a[74:75], v46 offset:4224
ds_read_b64_tr_b16 a[76:77], v46 offset:6144
ds_read_b64_tr_b16 a[78:79], v46 offset:6272
s_waitcnt lgkmcnt(0)
ds_read_b64_tr_b16 a[80:81], v46 offset:8192
ds_read_b64_tr_b16 a[82:83], v46 offset:8320
ds_read_b64_tr_b16 a[84:85], v46 offset:10240
ds_read_b64_tr_b16 a[86:87], v46 offset:10368
ds_read_b64_tr_b16 a[88:89], v46 offset:12288
ds_read_b64_tr_b16 a[90:91], v46 offset:12416
ds_read_b64_tr_b16 a[92:93], v46 offset:14336
ds_read_b64_tr_b16 a[94:95], v46 offset:14464
s_waitcnt lgkmcnt(0)
ds_read_b64_tr_b16 a[96:97], v46 offset:32
ds_read_b64_tr_b16 a[98:99], v46 offset:160
ds_read_b64_tr_b16 a[100:101], v46 offset:2080
ds_read_b64_tr_b16 a[102:103], v46 offset:2208
ds_read_b64_tr_b16 a[104:105], v46 offset:4128
ds_read_b64_tr_b16 a[106:107], v46 offset:4256
ds_read_b64_tr_b16 a[108:109], v46 offset:6176
ds_read_b64_tr_b16 a[110:111], v46 offset:6304
s_waitcnt lgkmcnt(0)
ds_read_b64_tr_b16 a[112:113], v46 offset:8224
ds_read_b64_tr_b16 a[114:115], v46 offset:8352
ds_read_b64_tr_b16 a[116:117], v46 offset:10272
ds_read_b64_tr_b16 a[118:119], v46 offset:10400
ds_read_b64_tr_b16 a[120:121], v46 offset:12320
ds_read_b64_tr_b16 a[122:123], v46 offset:12448
ds_read_b64_tr_b16 a[124:125], v46 offset:14368
ds_read_b64_tr_b16 a[126:127], v46 offset:14496
s_waitcnt lgkmcnt(0)
buffer_load_dword v50, v51, s[4:7], 0 offen
s_xor_b32 s29, s76, 0
s_lshl_b32 s28, s29, 10
s_add_u32 s28, s28, s47
s_add_u32 m0, s28, 0
s_lshl_b32 s29, s29, 17
buffer_load_dwordx4 v40, s[4:7], s29 offen lds
s_xor_b32 s29, s76, 1
s_lshl_b32 s28, s29, 10
s_add_u32 s28, s28, s47
s_add_u32 m0, s28, 0
s_lshl_b32 s29, s29, 17
buffer_load_dwordx4 v40, s[4:7], s29 offen lds
s_xor_b32 s29, s76, 2
s_lshl_b32 s28, s29, 10
s_add_u32 s28, s28, s47
s_add_u32 m0, s28, 0
s_lshl_b32 s29, s29, 17
buffer_load_dwordx4 v40, s[4:7], s29 offen lds
s_xor_b32 s29, s76, 3
s_lshl_b32 s28, s29, 10
s_add_u32 s28, s28, s47
s_add_u32 m0, s28, 0
s_lshl_b32 s29, s29, 17
buffer_load_dwordx4 v40, s[4:7], s29 offen lds
s_xor_b32 s29, s76, 4
s_lshl_b32 s28, s29, 10
s_add_u32 s28, s28, s47
s_add_u32 m0, s28, 0
s_lshl_b32 s29, s29, 17
buffer_load_dwordx4 v40, s[4:7], s29 offen lds
s_xor_b32 s29, s76, 5
s_lshl_b32 s28, s29, 10
s_add_u32 s28, s28, s47
s_add_u32 m0, s28, 0
s_lshl_b32 s29, s29, 17
buffer_load_dwordx4 v40, s[4:7], s29 offen lds
s_xor_b32 s29, s76, 6
s_lshl_b32 s28, s29, 10
s_add_u32 s28, s28, s47
s_add_u32 m0, s28, 0
s_lshl_b32 s29, s29, 17
buffer_load_dwordx4 v40, s[4:7], s29 offen lds
s_xor_b32 s29, s76, 7
s_lshl_b32 s28, s29, 10
s_add_u32 s28, s28, s47
s_add_u32 m0, s28, 0
s_lshl_b32 s29, s29, 17
buffer_load_dwordx4 v40, s[4:7], s29 offen lds
s_xor_b32 s29, s76, 8
s_lshl_b32 s28, s29, 10
s_add_u32 s28, s28, s47
s_add_u32 m0, s28, 0
s_lshl_b32 s29, s29, 17
buffer_load_dwordx4 v40, s[4:7], s29 offen lds
s_xor_b32 s29, s76, 9
s_lshl_b32 s28, s29, 10
s_add_u32 s28, s28, s47
s_add_u32 m0, s28, 0
s_lshl_b32 s29, s29, 17
buffer_load_dwordx4 v40, s[4:7], s29 offen lds
s_xor_b32 s29, s76, 10
s_lshl_b32 s28, s29, 10
s_add_u32 s28, s28, s47
s_add_u32 m0, s28, 0
s_lshl_b32 s29, s29, 17
buffer_load_dwordx4 v40, s[4:7], s29 offen lds
s_xor_b32 s29, s76, 11
s_lshl_b32 s28, s29, 10
s_add_u32 s28, s28, s47
s_add_u32 m0, s28, 0
s_lshl_b32 s29, s29, 17
buffer_load_dwordx4 v40, s[4:7], s29 offen lds
s_xor_b32 s29, s76, 12
s_lshl_b32 s28, s29, 10
s_add_u32 s28, s28, s47
s_add_u32 m0, s28, 0
s_lshl_b32 s29, s29, 17
buffer_load_dwordx4 v40, s[4:7], s29 offen lds
s_xor_b32 s29, s76, 13
s_lshl_b32 s28, s29, 10
s_add_u32 s28, s28, s47
s_add_u32 m0, s28, 0
s_lshl_b32 s29, s29, 17
buffer_load_dwordx4 v40, s[4:7], s29 offen lds
s_xor_b32 s29, s76, 14
s_lshl_b32 s28, s29, 10
s_add_u32 s28, s28, s47
s_add_u32 m0, s28, 0
s_lshl_b32 s29, s29, 17
buffer_load_dwordx4 v40, s[4:7], s29 offen lds
s_xor_b32 s29, s76, 15
s_lshl_b32 s28, s29, 10
s_add_u32 s28, s28, s47
s_add_u32 m0, s28, 0
s_lshl_b32 s29, s29, 17
buffer_load_dwordx4 v40, s[4:7], s29 offen lds
s_waitcnt vmcnt(17)
ds_read_b64_tr_b16 a[128:129], v46 offset:16384
ds_read_b64_tr_b16 a[130:131], v46 offset:16512
ds_read_b64_tr_b16 a[132:133], v46 offset:18432
ds_read_b64_tr_b16 a[134:135], v46 offset:18560
ds_read_b64_tr_b16 a[136:137], v46 offset:20480
ds_read_b64_tr_b16 a[138:139], v46 offset:20608
ds_read_b64_tr_b16 a[140:141], v46 offset:22528
ds_read_b64_tr_b16 a[142:143], v46 offset:22656
s_waitcnt lgkmcnt(0)
ds_read_b64_tr_b16 a[144:145], v46 offset:24576
ds_read_b64_tr_b16 a[146:147], v46 offset:24704
ds_read_b64_tr_b16 a[148:149], v46 offset:26624
ds_read_b64_tr_b16 a[150:151], v46 offset:26752
ds_read_b64_tr_b16 a[152:153], v46 offset:28672
ds_read_b64_tr_b16 a[154:155], v46 offset:28800
ds_read_b64_tr_b16 a[156:157], v46 offset:30720
ds_read_b64_tr_b16 a[158:159], v46 offset:30848
s_waitcnt lgkmcnt(0)
ds_read_b64_tr_b16 a[160:161], v46 offset:16416
ds_read_b64_tr_b16 a[162:163], v46 offset:16544
ds_read_b64_tr_b16 a[164:165], v46 offset:18464
ds_read_b64_tr_b16 a[166:167], v46 offset:18592
ds_read_b64_tr_b16 a[168:169], v46 offset:20512
ds_read_b64_tr_b16 a[170:171], v46 offset:20640
ds_read_b64_tr_b16 a[172:173], v46 offset:22560
ds_read_b64_tr_b16 a[174:175], v46 offset:22688
s_waitcnt lgkmcnt(0)
ds_read_b64_tr_b16 a[176:177], v46 offset:24608
ds_read_b64_tr_b16 a[178:179], v46 offset:24736
ds_read_b64_tr_b16 a[180:181], v46 offset:26656
ds_read_b64_tr_b16 a[182:183], v46 offset:26784
ds_read_b64_tr_b16 a[184:185], v46 offset:28704
ds_read_b64_tr_b16 a[186:187], v46 offset:28832
ds_read_b64_tr_b16 a[188:189], v46 offset:30752
ds_read_b64_tr_b16 a[190:191], v46 offset:30880
s_waitcnt lgkmcnt(0)
buffer_load_dword v50, v52, s[16:19], 0 offen
s_xor_b32 s29, s76, 0
s_lshl_b32 s28, s29, 10
s_add_u32 s28, s28, s47
s_add_u32 m0, s28, 16384
s_lshl_b32 s29, s29, 15
buffer_load_dwordx4 v41, s[16:19], s29 offen lds
s_xor_b32 s29, s76, 1
s_lshl_b32 s28, s29, 10
s_add_u32 s28, s28, s47
s_add_u32 m0, s28, 16384
s_lshl_b32 s29, s29, 15
buffer_load_dwordx4 v41, s[16:19], s29 offen lds
s_xor_b32 s29, s76, 2
s_lshl_b32 s28, s29, 10
s_add_u32 s28, s28, s47
s_add_u32 m0, s28, 16384
s_lshl_b32 s29, s29, 15
buffer_load_dwordx4 v41, s[16:19], s29 offen lds
s_xor_b32 s29, s76, 3
s_lshl_b32 s28, s29, 10
s_add_u32 s28, s28, s47
s_add_u32 m0, s28, 16384
s_lshl_b32 s29, s29, 15
buffer_load_dwordx4 v41, s[16:19], s29 offen lds
s_xor_b32 s29, s76, 4
s_lshl_b32 s28, s29, 10
s_add_u32 s28, s28, s47
s_add_u32 m0, s28, 16384
s_lshl_b32 s29, s29, 15
buffer_load_dwordx4 v41, s[16:19], s29 offen lds
s_xor_b32 s29, s76, 5
s_lshl_b32 s28, s29, 10
s_add_u32 s28, s28, s47
s_add_u32 m0, s28, 16384
s_lshl_b32 s29, s29, 15
buffer_load_dwordx4 v41, s[16:19], s29 offen lds
s_xor_b32 s29, s76, 6
s_lshl_b32 s28, s29, 10
s_add_u32 s28, s28, s47
s_add_u32 m0, s28, 16384
s_lshl_b32 s29, s29, 15
buffer_load_dwordx4 v41, s[16:19], s29 offen lds
s_xor_b32 s29, s76, 7
s_lshl_b32 s28, s29, 10
s_add_u32 s28, s28, s47
s_add_u32 m0, s28, 16384
s_lshl_b32 s29, s29, 15
buffer_load_dwordx4 v41, s[16:19], s29 offen lds
s_xor_b32 s29, s76, 8
s_lshl_b32 s28, s29, 10
s_add_u32 s28, s28, s47
s_add_u32 m0, s28, 16384
s_lshl_b32 s29, s29, 15
buffer_load_dwordx4 v41, s[16:19], s29 offen lds
s_xor_b32 s29, s76, 9
s_lshl_b32 s28, s29, 10
s_add_u32 s28, s28, s47
s_add_u32 m0, s28, 16384
s_lshl_b32 s29, s29, 15
buffer_load_dwordx4 v41, s[16:19], s29 offen lds
s_xor_b32 s29, s76, 10
s_lshl_b32 s28, s29, 10
s_add_u32 s28, s28, s47
s_add_u32 m0, s28, 16384
s_lshl_b32 s29, s29, 15
buffer_load_dwordx4 v41, s[16:19], s29 offen lds
s_xor_b32 s29, s76, 11
s_lshl_b32 s28, s29, 10
s_add_u32 s28, s28, s47
s_add_u32 m0, s28, 16384
s_lshl_b32 s29, s29, 15
buffer_load_dwordx4 v41, s[16:19], s29 offen lds
s_xor_b32 s29, s76, 12
s_lshl_b32 s28, s29, 10
s_add_u32 s28, s28, s47
s_add_u32 m0, s28, 16384
s_lshl_b32 s29, s29, 15
buffer_load_dwordx4 v41, s[16:19], s29 offen lds
s_xor_b32 s29, s76, 13
s_lshl_b32 s28, s29, 10
s_add_u32 s28, s28, s47
s_add_u32 m0, s28, 16384
s_lshl_b32 s29, s29, 15
buffer_load_dwordx4 v41, s[16:19], s29 offen lds
s_xor_b32 s29, s76, 14
s_lshl_b32 s28, s29, 10
s_add_u32 s28, s28, s47
s_add_u32 m0, s28, 16384
s_lshl_b32 s29, s29, 15
buffer_load_dwordx4 v41, s[16:19], s29 offen lds
s_xor_b32 s29, s76, 15
s_lshl_b32 s28, s29, 10
s_add_u32 s28, s28, s47
s_add_u32 m0, s28, 16384
s_lshl_b32 s29, s29, 15
buffer_load_dwordx4 v41, s[16:19], s29 offen lds
s_waitcnt vmcnt(17)
ds_read_b64_tr_b16 a[0:1], v46 offset:0
ds_read_b64_tr_b16 a[2:3], v46 offset:128
ds_read_b64_tr_b16 a[4:5], v46 offset:2048
ds_read_b64_tr_b16 a[6:7], v46 offset:2176
ds_read_b64_tr_b16 a[8:9], v46 offset:4096
ds_read_b64_tr_b16 a[10:11], v46 offset:4224
ds_read_b64_tr_b16 a[12:13], v46 offset:6144
ds_read_b64_tr_b16 a[14:15], v46 offset:6272
s_waitcnt lgkmcnt(0)
ds_read_b64_tr_b16 a[16:17], v46 offset:8192
ds_read_b64_tr_b16 a[18:19], v46 offset:8320
ds_read_b64_tr_b16 a[20:21], v46 offset:10240
ds_read_b64_tr_b16 a[22:23], v46 offset:10368
ds_read_b64_tr_b16 a[24:25], v46 offset:12288
ds_read_b64_tr_b16 a[26:27], v46 offset:12416
ds_read_b64_tr_b16 a[28:29], v46 offset:14336
ds_read_b64_tr_b16 a[30:31], v46 offset:14464
s_waitcnt lgkmcnt(0)
ds_read_b64_tr_b16 a[32:33], v46 offset:32
ds_read_b64_tr_b16 a[34:35], v46 offset:160
ds_read_b64_tr_b16 a[36:37], v46 offset:2080
ds_read_b64_tr_b16 a[38:39], v46 offset:2208
ds_read_b64_tr_b16 a[40:41], v46 offset:4128
ds_read_b64_tr_b16 a[42:43], v46 offset:4256
ds_read_b64_tr_b16 a[44:45], v46 offset:6176
ds_read_b64_tr_b16 a[46:47], v46 offset:6304
s_waitcnt lgkmcnt(0)
ds_read_b64_tr_b16 a[48:49], v46 offset:8224
ds_read_b64_tr_b16 a[50:51], v46 offset:8352
ds_read_b64_tr_b16 a[52:53], v46 offset:10272
ds_read_b64_tr_b16 a[54:55], v46 offset:10400
ds_read_b64_tr_b16 a[56:57], v46 offset:12320
ds_read_b64_tr_b16 a[58:59], v46 offset:12448
ds_read_b64_tr_b16 a[60:61], v46 offset:14368
ds_read_b64_tr_b16 a[62:63], v46 offset:14496
s_waitcnt lgkmcnt(0)
s_waitcnt vmcnt(0)
ds_read_b64_tr_b16 a[192:193], v47 offset:16384
ds_read_b64_tr_b16 a[194:195], v47 offset:16512
ds_read_b64_tr_b16 a[196:197], v47 offset:18432
ds_read_b64_tr_b16 a[198:199], v47 offset:18560
ds_read_b64_tr_b16 a[200:201], v47 offset:20480
ds_read_b64_tr_b16 a[202:203], v47 offset:20608
ds_read_b64_tr_b16 a[204:205], v47 offset:22528
ds_read_b64_tr_b16 a[206:207], v47 offset:22656
s_waitcnt lgkmcnt(0)
ds_read_b64_tr_b16 a[208:209], v47 offset:24576
ds_read_b64_tr_b16 a[210:211], v47 offset:24704
ds_read_b64_tr_b16 a[212:213], v47 offset:26624
ds_read_b64_tr_b16 a[214:215], v47 offset:26752
ds_read_b64_tr_b16 a[216:217], v47 offset:28672
ds_read_b64_tr_b16 a[218:219], v47 offset:28800
ds_read_b64_tr_b16 a[220:221], v47 offset:30720
ds_read_b64_tr_b16 a[222:223], v47 offset:30848
s_waitcnt lgkmcnt(0)
ds_read_b64_tr_b16 a[224:225], v47 offset:16416
ds_read_b64_tr_b16 a[226:227], v47 offset:16544
ds_read_b64_tr_b16 a[228:229], v47 offset:18464
ds_read_b64_tr_b16 a[230:231], v47 offset:18592
ds_read_b64_tr_b16 a[232:233], v47 offset:20512
ds_read_b64_tr_b16 a[234:235], v47 offset:20640
ds_read_b64_tr_b16 a[236:237], v47 offset:22560
ds_read_b64_tr_b16 a[238:239], v47 offset:22688
s_waitcnt lgkmcnt(0)
ds_read_b64_tr_b16 a[240:241], v47 offset:24608
ds_read_b64_tr_b16 a[242:243], v47 offset:24736
ds_read_b64_tr_b16 a[244:245], v47 offset:26656
ds_read_b64_tr_b16 a[246:247], v47 offset:26784
ds_read_b64_tr_b16 a[248:249], v47 offset:28704
ds_read_b64_tr_b16 a[250:251], v47 offset:28832
ds_read_b64_tr_b16 a[252:253], v47 offset:30752
ds_read_b64_tr_b16 a[254:255], v47 offset:30880
s_waitcnt lgkmcnt(0)
v_and_b32 v5, 15, v0
v_lshlrev_b32 v5, 4, v5
s_branch mega_kernel_syr
mega_kernel_syrw:
s_sleep 4
mega_kernel_syr:
buffer_load_dword v4, v5, s[72:75], 0 offen sc1
s_waitcnt vmcnt(0)
s_cmp_eq_u32 s95, 1
s_cbranch_scc0 mega_kernel_syrf
v_readlane_b32 s76, v4, 14
s_mov_b32 s98, 0
s_cmp_eq_u32 s76, 64
s_cbranch_scc0 mega_kernel_syrw
s_branch mega_kernel_syrd
mega_kernel_syrf:
s_mov_b32 s77, 0
s_mov_b32 s78, 0
v_readlane_b32 s76, v4, 0
s_add_u32 s77, s77, s76
s_xor_b32 s76, s76, 32
s_or_b32 s78, s78, s76
v_readlane_b32 s76, v4, 1
s_add_u32 s77, s77, s76
s_xor_b32 s76, s76, 32
s_or_b32 s78, s78, s76
v_readlane_b32 s76, v4, 2
s_add_u32 s77, s77, s76
s_xor_b32 s76, s76, 32
s_or_b32 s78, s78, s76
v_readlane_b32 s76, v4, 3
s_add_u32 s77, s77, s76
s_xor_b32 s76, s76, 32
s_or_b32 s78, s78, s76
v_readlane_b32 s76, v4, 4
s_add_u32 s77, s77, s76
s_xor_b32 s76, s76, 32
s_or_b32 s78, s78, s76
v_readlane_b32 s76, v4, 5
s_add_u32 s77, s77, s76
s_xor_b32 s76, s76, 32
s_or_b32 s78, s78, s76
v_readlane_b32 s76, v4, 6
s_add_u32 s77, s77, s76
s_xor_b32 s76, s76, 32
s_or_b32 s78, s78, s76
v_readlane_b32 s76, v4, 7
s_add_u32 s77, s77, s76
s_xor_b32 s76, s76, 32
s_or_b32 s78, s78, s76
s_cmp_eq_u32 s77, 256
s_cbranch_scc0 mega_kernel_syrw
v_mov_b32 v252, v4
s_cmp_eq_u32 s78, 0
s_cbranch_scc0 mega_kernel_slowent
v_readlane_b32 s76, v4, 10
v_readlane_b32 s77, v4, 8
s_cmp_eq_u32 s76, 64
s_cbranch_scc0 mega_kernel_syrw
s_cmp_gt_u32 s77, 32
s_cselect_b32 s98, 1, 0
mega_kernel_syrd:
s_lshr_b32 s28, s31, 3
s_lshl_b32 s28, s28, 14
s_lshl_b32 s29, s98, 13
s_add_u32 s28, s28, s29
s_and_b32 s29, s31, 7
s_lshl_b32 s29, s29, 10
s_add_u32 s28, s28, s29
s_lshl_b32 s29, s30, 16
s_add_u32 s28, s28, s29
s_add_u32 s28, s28, 67108864
v_add_u32 v12, s28, v17
v_xor_b32 v25, 0x10000, v12
v_xor_b32 v26, 0x20000, v12
v_xor_b32 v27, 0x30000, v12
v_add_u32 v25, 0, v25
v_add_u32 v26, 0, v26
v_add_u32 v27, 0, v27
s_lshl_b32 s28, s25, 2
s_add_u32 s28, s28, s26
s_mov_b32 s82, s28
s_lshr_b32 s29, s28, 3
s_xor_b32 s29, s29, s98
s_and_b32 s29, s29, 1
s_lshl_b32 s29, s29, 13
s_lshl_b32 s76, s28, 18
s_add_u32 s76, s76, s29
s_mov_b32 s83, s76
v_add_u32 v240, s76, v17
v_add_u32 v241, 33554432, v240
s_lshr_b32 s29, s28, 4
s_xor_b32 s29, s29, s98
s_and_b32 s29, s29, 1
s_lshl_b32 s29, s29, 13
s_lshl_b32 s79, s28, 17
s_add_u32 s79, s79, s29
s_add_u32 s79, s79, 71303168
s_xor_b32 s29, s98, 1
s_lshl_b32 s29, s29, 13
s_lshl_b32 s28, s25, 7
s_add_u32 s28, s28, s29
s_add_u32 s28, s28, 69206016
v_and_b32 v4, 1, v1
v_lshlrev_b32 v24, 12, v4
v_add_u32 v24, s28, v24
s_lshl_b32 s29, s26, 2
v_add_u32 v24, s29, v24
s_xor_b32 s81, s98, 1
s_lshl_b32 s81, s81, 13
s_lshr_b32 s29, s82, 6
s_lshl_b32 s29, s29, 14
s_add_u32 s81, s81, s29
s_and_b32 s29, s82, 63
s_lshl_b32 s29, s29, 7
s_add_u32 s81, s81, s29
s_add_u32 s81, s81, 69222400
v_mov_b32 v220, 0x3f803f80
v_mov_b32 v221, 0x3f803f80
v_mov_b32 v222, 0x3f803f80
v_mov_b32 v223, 0x3f803f80
v_mov_b32 v228, 0
s_mov_b32 s27, 0
s_mov_b32 s46, 0
s_mov_b32 s89, 0
s_mov_b32 s88, 0
s_mov_b32 s44, 18432
s_mov_b32 s45, 18432
s_cmp_eq_u32 s24, 3
s_cbranch_scc0 mega_kernel_rf_pfi
s_mov_b32 s76, 0
s_cmp_gt_i32 s46, s76
s_cbranch_scc1 mega_kernel_rf_pf0ok
mega_kernel_rf_pf0w:
buffer_load_dword v4, v24, s[84:87], 0 offen sc1
s_waitcnt vmcnt(0)
v_readlane_b32 s46, v4, 0
v_readlane_b32 s28, v4, 1
s_nop 1
s_min_i32 s46, s46, s28
s_cmp_gt_i32 s46, s76
s_cbranch_scc0 mega_kernel_rf_pf0w
mega_kernel_rf_pf0ok:
s_add_u32 s77, s76, s82
s_bfe_u32 s28, s77, 0x40002
s_lshl_b32 s28, s28, 14
s_and_b32 s77, s77, 3
s_lshl_b32 s77, s77, 11
s_add_u32 s28, s28, s77
s_add_u32 m0, s45, 0
s_nop 0
buffer_load_dwordx4 v240, s[84:87], s28 offen offset:0 sc1 lds
s_add_u32 m0, s45, 0
s_nop 0
buffer_load_dwordx4 v240, s[84:87], s28 offen offset:1024 sc1 lds
s_add_u32 m0, s45, 2048
s_nop 0
buffer_load_dwordx4 v241, s[84:87], s28 offen offset:0 sc1 lds
s_add_u32 m0, s45, 2048
s_nop 0
buffer_load_dwordx4 v241, s[84:87], s28 offen offset:1024 sc1 lds
s_add_u32 s45, s45, 4096
s_cmp_eq_u32 s45, 30720
s_cselect_b32 s45, 18432, s45
s_waitcnt vmcnt(0) lgkmcnt(0)
mega_kernel_rf_pfi:
v_mov_b32 v96, 0
v_mov_b32 v97, 0
v_mov_b32 v98, 0
v_mov_b32 v99, 0
v_mov_b32 v100, 0
v_mov_b32 v101, 0
v_mov_b32 v102, 0
v_mov_b32 v103, 0
v_mov_b32 v104, 0
v_mov_b32 v105, 0
v_mov_b32 v106, 0
v_mov_b32 v107, 0
v_mov_b32 v108, 0
v_mov_b32 v109, 0
v_mov_b32 v110, 0
v_mov_b32 v111, 0
v_mov_b32 v112, 0
v_mov_b32 v113, 0
v_mov_b32 v114, 0
v_mov_b32 v115, 0
v_mov_b32 v116, 0
v_mov_b32 v117, 0
v_mov_b32 v118, 0
v_mov_b32 v119, 0
s_barrier
s_and_b32 s29, s27, 1
s_lshl_b32 s33, s29, 17
s_lshl_b32 s28, s30, 18
s_add_u32 s33, s33, s28
s_add_u32 s33, s33, 68157440
s_xor_b32 s34, s33, 131072
s_lshl_b32 s35, s29, 18
s_bfe_u32 s47, s27, 0x10001
s_branch mega_kernel_rf_first
mega_kernel_rf_loop:
buffer_load_dwordx4 v[32:35], v7, s[84:87], s33 offen offset:0 sc1
v_add_u32 v5, s44, v17
ds_read_b128 v[156:159], v5 offset:0
ds_read_b128 v[160:163], v5 offset:1024
ds_read_b128 v[164:167], v5 offset:2048
ds_read_b128 v[168:171], v5 offset:3072
s_nop 4
buffer_load_dwordx4 v[36:39], v7, s[84:87], s33 offen offset:1024 sc1
s_nop 9
buffer_load_dwordx4 v[40:43], v7, s[84:87], s33 offen offset:2048 sc1
s_nop 9
buffer_load_dwordx4 v[44:47], v7, s[84:87], s33 offen offset:3072 sc1
s_waitcnt vmcnt(3)
v_max_u32 v4, v32, v34
v_cmp_eq_u32 vcc, -1, v4
s_cbranch_vccnz mega_kernel_rf_pa_15_0f
v_smfmac_f32_16x16x64_bf16 v[96:99], v[32:35], a[0:7], v6
v_smfmac_f32_16x16x64_bf16 v[100:103], v[32:35], a[32:39], v6
v_smfmac_f32_16x16x64_bf16 v[104:107], v[32:35], a[64:71], v6
s_waitcnt vmcnt(2)
v_max_u32 v4, v36, v38
v_cmp_eq_u32 vcc, -1, v4
v_smfmac_f32_16x16x64_bf16 v[108:111], v[32:35], a[96:103], v6
s_cbranch_vccnz mega_kernel_rf_pa_14_1f
v_smfmac_f32_16x16x64_bf16 v[96:99], v[36:39], a[8:15], v6
v_smfmac_f32_16x16x64_bf16 v[100:103], v[36:39], a[40:47], v6
v_smfmac_f32_16x16x64_bf16 v[104:107], v[36:39], a[72:79], v6
s_waitcnt vmcnt(1)
v_max_u32 v4, v40, v42
v_cmp_eq_u32 vcc, -1, v4
v_smfmac_f32_16x16x64_bf16 v[108:111], v[36:39], a[104:111], v6
s_cbranch_vccnz mega_kernel_rf_pa_12_2f
v_smfmac_f32_16x16x64_bf16 v[96:99], v[40:43], a[16:23], v6
v_smfmac_f32_16x16x64_bf16 v[100:103], v[40:43], a[48:55], v6
v_smfmac_f32_16x16x64_bf16 v[104:107], v[40:43], a[80:87], v6
s_waitcnt vmcnt(0)
v_max_u32 v4, v44, v46
v_cmp_eq_u32 vcc, -1, v4
v_smfmac_f32_16x16x64_bf16 v[108:111], v[40:43], a[112:119], v6
s_cbranch_vccnz mega_kernel_rf_pa_8_3f
v_smfmac_f32_16x16x64_bf16 v[96:99], v[44:47], a[24:31], v6
v_smfmac_f32_16x16x64_bf16 v[100:103], v[44:47], a[56:63], v6
v_smfmac_f32_16x16x64_bf16 v[104:107], v[44:47], a[88:95], v6
v_smfmac_f32_16x16x64_bf16 v[108:111], v[44:47], a[120:127], v6
mega_kernel_rf_pa_d:
mega_kernel_rf_adone:
s_nop 5
v_permlane32_swap_b32 v96, v100
v_permlane32_swap_b32 v97, v101
v_permlane32_swap_b32 v98, v102
v_permlane32_swap_b32 v99, v103
v_pk_add_f32 v[96:97], v[96:97], v[100:101]
v_pk_add_f32 v[98:99], v[98:99], v[102:103]
ds_write2_b32 v14, v96, v97 offset0:0 offset1:36
ds_write2_b32 v14, v98, v99 offset0:72 offset1:108
v_permlane32_swap_b32 v104, v108
v_permlane32_swap_b32 v105, v109
v_permlane32_swap_b32 v106, v110
v_permlane32_swap_b32 v107, v111
v_pk_add_f32 v[104:105], v[104:105], v[108:109]
v_pk_add_f32 v[106:107], v[106:107], v[110:111]
ds_write2_b32 v15, v104, v105 offset0:0 offset1:36
ds_write2_b32 v15, v106, v107 offset0:72 offset1:108
v_smfmac_f32_16x16x64_bf16 v[112:115], v[32:35], a[128:135], v6
v_smfmac_f32_16x16x64_bf16 v[116:119], v[32:35], a[160:167], v6
v_smfmac_f32_16x16x64_bf16 v[112:115], v[36:39], a[136:143], v6
v_smfmac_f32_16x16x64_bf16 v[116:119], v[36:39], a[168:175], v6
s_waitcnt lgkmcnt(0)
s_barrier
s_cmp_lg_u32 s24, 0
s_cbranch_scc1 mega_kernel_rf_side
ds_read_b128 v[120:123], v16 offset:0
ds_read_b128 v[124:127], v16 offset:16
ds_read_b128 v[128:131], v16 offset:2304
ds_read_b128 v[132:135], v16 offset:2320
ds_read_b128 v[136:139], v16 offset:4608
ds_read_b128 v[140:143], v16 offset:4624
ds_read_b128 v[144:147], v16 offset:6912
ds_read_b128 v[148:151], v16 offset:6928
v_smfmac_f32_16x16x64_bf16 v[112:115], v[40:43], a[144:151], v6
v_smfmac_f32_16x16x64_bf16 v[116:119], v[40:43], a[176:183], v6
v_smfmac_f32_16x16x64_bf16 v[112:115], v[44:47], a[152:159], v6
v_smfmac_f32_16x16x64_bf16 v[116:119], v[44:47], a[184:191], v6
s_mul_i32 s28, s31, 2048
s_add_u32 s28, s28, s33
s_add_u32 s28, s28, 49152
s_add_u32 s76, s37, s33
s_add_u32 s77, s38, s33
s_add_u32 s78, s39, s33
s_waitcnt lgkmcnt(4)
v_pk_add_f32 v[120:121], v[120:121], v[128:129]
v_pk_add_f32 v[122:123], v[122:123], v[130:131]
v_pk_add_f32 v[124:125], v[124:125], v[132:133]
v_pk_add_f32 v[126:127], v[126:127], v[134:135]
s_waitcnt lgkmcnt(0)
v_pk_add_f32 v[136:137], v[136:137], v[144:145]
v_pk_add_f32 v[138:139], v[138:139], v[146:147]
v_pk_add_f32 v[140:141], v[140:141], v[148:149]
v_pk_add_f32 v[142:143], v[142:143], v[150:151]
v_pk_add_f32 v[120:121], v[120:121], v[136:137]
v_pk_add_f32 v[122:123], v[122:123], v[138:139]
v_pk_add_f32 v[124:125], v[124:125], v[140:141]
v_pk_add_f32 v[126:127], v[126:127], v[142:143]
v_cvt_pk_bf16_f32 v152, v120, v121
v_cvt_pk_bf16_f32 v153, v122, v123
v_cvt_pk_bf16_f32 v154, v124, v125
v_cvt_pk_bf16_f32 v155, v126, v127
s_nop 1
v_mfma_f32_16x16x32_bf16 v[176:179], v[160:163], v[152:155], 0
v_mfma_f32_16x16x32_bf16 v[172:175], v[156:159], v[152:155], 0
v_mfma_f32_16x16x32_bf16 v[180:183], v[152:155], v[152:155], 0
s_cmp_eq_u32 s27, 63
s_cbranch_scc1 mega_kernel_rf_w0last
s_nop 4
v_mov_b32_dpp v172, v176 row_shr:8 row_mask:0xf bank_mask:0xc
v_mov_b32_dpp v173, v177 row_shr:8 row_mask:0xf bank_mask:0xc
v_mov_b32_dpp v174, v178 row_shr:8 row_mask:0xf bank_mask:0xc
v_mov_b32_dpp v175, v179 row_shr:8 row_mask:0xf bank_mask:0xc
v_min_u32 v180, -2, v180
v_min_u32 v172, -2, v172
s_mov_b64 exec, s[42:43]
buffer_store_dwordx4 v[180:183], v10, s[84:87], s28 offen
s_mov_b64 exec, -1
buffer_store_dwordx4 v[172:175], v17, s[84:87], s28 offen
v_permlane32_swap_b32 v112, v116
v_permlane32_swap_b32 v113, v117
v_permlane32_swap_b32 v114, v118
v_permlane32_swap_b32 v115, v119
v_pk_add_f32 v[112:113], v[112:113], v[116:117]
v_pk_add_f32 v[114:115], v[114:115], v[118:119]
ds_write_b128 v20, v[112:115]
s_waitcnt lgkmcnt(0)
s_barrier
v_mov_b32 v96, 0
v_mov_b32 v97, 0
v_mov_b32 v98, 0
v_mov_b32 v99, 0
v_mov_b32 v100, 0
v_mov_b32 v101, 0
v_mov_b32 v102, 0
v_mov_b32 v103, 0
v_cndmask_b32 v176, v23, v180, s[42:43]
v_cndmask_b32 v177, v23, v181, s[42:43]
v_cndmask_b32 v178, v23, v182, s[42:43]
v_cndmask_b32 v179, v23, v183, s[42:43]
buffer_load_dwordx4 v[184:187], v17, s[84:87], s76 offen sc1
buffer_load_dwordx4 v[188:191], v10, s[84:87], s76 offen sc1
buffer_load_dwordx4 v[192:195], v17, s[84:87], s77 offen sc1
buffer_load_dwordx4 v[196:199], v10, s[84:87], s77 offen sc1
buffer_load_dwordx4 v[200:203], v17, s[84:87], s78 offen sc1
buffer_load_dwordx4 v[204:207], v10, s[84:87], s78 offen sc1
s_nop 15
s_nop 7
buffer_load_dwordx4 v[184:187], v17, s[84:87], s76 offen sc1
buffer_load_dwordx4 v[188:191], v10, s[84:87], s76 offen sc1
buffer_load_dwordx4 v[192:195], v17, s[84:87], s77 offen sc1
buffer_load_dwordx4 v[196:199], v10, s[84:87], s77 offen sc1
buffer_load_dwordx4 v[200:203], v17, s[84:87], s78 offen sc1
buffer_load_dwordx4 v[204:207], v10, s[84:87], s78 offen sc1
mega_kernel_rf_p2:
s_waitcnt vmcnt(6)
v_max3_u32 v4, v184, v188, v192
v_max3_u32 v5, v196, v200, v204
v_max_u32 v4, v4, v5
v_cmp_eq_u32 vcc, -1, v4
s_cbranch_vccnz mega_kernel_rf_p2r
v_pk_add_f32 v[176:177], v[176:177], v[188:189]
v_pk_add_f32 v[124:125], v[196:197], v[204:205]
v_pk_add_f32 v[178:179], v[178:179], v[190:191]
v_pk_add_f32 v[126:127], v[198:199], v[206:207]
v_pk_add_f32 v[172:173], v[172:173], v[184:185]
v_pk_add_f32 v[120:121], v[192:193], v[200:201]
v_pk_add_f32 v[174:175], v[174:175], v[186:187]
v_pk_add_f32 v[122:123], v[194:195], v[202:203]
v_pk_add_f32 v[176:177], v[176:177], v[124:125]
v_pk_add_f32 v[178:179], v[178:179], v[126:127]
v_pk_add_f32 v[172:173], v[172:173], v[120:121]
v_pk_add_f32 v[174:175], v[174:175], v[122:123]
v_max3_f32 v232, v172, v173, v174
v_max3_f32 v233, v176, v177, v178
v_max3_f32 v232, v232, v175, v179
v_max_f32 v234, v232, v233
s_barrier
ds_read2_b64 v[208:211], v21 offset0:0 offset1:32
v_max_f32_dpp v232, v234, v234 row_ror:8 row_mask:0xf bank_mask:0xf
v_max_f32_dpp v233, v234, v234 row_ror:8 row_mask:0xf bank_mask:0xf
s_nop 1
v_permlane16_swap_b32 v232, v233
s_nop 0
v_max_f32 v234, v232, v233
v_max_f32 v235, v232, v233
s_nop 1
v_permlane32_swap_b32 v234, v235
s_nop 0
v_max_f32 v232, v234, v235
v_mul_f32 v232, s32, v232
v_pk_fma_f32 v[176:177], v[176:177], s[32:33], v[232:233] op_sel_hi:[1,0,0] neg_lo:[0,0,1] neg_hi:[0,0,1]
v_pk_fma_f32 v[178:179], v[178:179], s[32:33], v[232:233] op_sel_hi:[1,0,0] neg_lo:[0,0,1] neg_hi:[0,0,1]
v_pk_fma_f32 v[172:173], v[172:173], s[32:33], v[232:233] op_sel_hi:[1,0,0] neg_lo:[0,0,1] neg_hi:[0,0,1]
v_pk_fma_f32 v[174:175], v[174:175], s[32:33], v[232:233] op_sel_hi:[1,0,0] neg_lo:[0,0,1] neg_hi:[0,0,1]
v_exp_f32 v176, v176
v_exp_f32 v177, v177
v_exp_f32 v178, v178
v_exp_f32 v179, v179
v_exp_f32 v172, v172
v_cvt_pk_bf16_f32 v216, v176, v177
v_cvt_pk_bf16_f32 v217, v178, v179
v_exp_f32 v173, v173
v_exp_f32 v174, v174
v_mfma_f32_16x16x16_bf16 v[224:227], v[220:221], v[216:217], 0
v_exp_f32 v175, v175
v_cvt_pk_bf16_f32 v212, v172, v173
s_waitcnt lgkmcnt(0)
v_mfma_f32_16x16x16_bf16 v[120:123], v[208:209], v[216:217], 0
v_cvt_pk_bf16_f32 v213, v174, v175
v_mfma_f32_16x16x16_bf16 v[124:127], v[210:211], v[216:217], 0
v_mov_b32_dpp v214, v212 row_ror:8 row_mask:0xf bank_mask:0xf
v_mov_b32_dpp v215, v213 row_ror:8 row_mask:0xf bank_mask:0xf
s_nop 1
v_mfma_f32_16x16x32_bf16 v[224:227], v[220:223], v[212:215], v[224:227]
v_mfma_f32_16x16x32_bf16 v[120:123], v[164:167], v[212:215], v[120:123]
v_mfma_f32_16x16x32_bf16 v[124:127], v[168:171], v[212:215], v[124:127]
s_add_u32 s29, s33, 24576
s_nop 4
v_rcp_f32 v234, v224
s_nop 0
v_pk_mul_f32 v[120:121], v[120:121], v[234:235] op_sel_hi:[1,0]
v_pk_mul_f32 v[122:123], v[122:123], v[234:235] op_sel_hi:[1,0]
v_pk_mul_f32 v[124:125], v[124:125], v[234:235] op_sel_hi:[1,0]
v_pk_mul_f32 v[126:127], v[126:127], v[234:235] op_sel_hi:[1,0]
v_cvt_pk_bf16_f32 v212, v120, v121
v_cvt_pk_bf16_f32 v213, v122, v123
v_cvt_pk_bf16_f32 v214, v124, v125
v_cvt_pk_bf16_f32 v215, v126, v127
v_min_u32 v212, -2, v212
s_mov_b64 exec, s[40:41]
buffer_store_dwordx4 v[212:215], v11, s[84:87], s33 offen
s_mov_b64 exec, -1
mega_kernel_rf_b3:
s_barrier
s_nop 15
s_nop 7
buffer_load_dwordx4 v[32:35], v7, s[84:87], s29 offen offset:0 sc1
s_nop 9
buffer_load_dwordx4 v[36:39], v7, s[84:87], s29 offen offset:1024 sc1
s_nop 9
buffer_load_dwordx4 v[40:43], v7, s[84:87], s29 offen offset:2048 sc1
s_nop 9
buffer_load_dwordx4 v[44:47], v7, s[84:87], s29 offen offset:3072 sc1
mega_kernel_rf_pc_15_0:
s_waitcnt vmcnt(3)
v_cmp_eq_u32 vcc, -1, v32
s_cbranch_vccnz mega_kernel_rf_pc_15_0f
v_smfmac_f32_16x16x64_bf16 v[96:99], v[32:35], a[192:199], v6
v_smfmac_f32_16x16x64_bf16 v[100:103], v[32:35], a[224:231], v6
mega_kernel_rf_pc_14_1:
s_waitcnt vmcnt(2)
v_cmp_eq_u32 vcc, -1, v36
s_cbranch_vccnz mega_kernel_rf_pc_14_1f
v_smfmac_f32_16x16x64_bf16 v[96:99], v[36:39], a[200:207], v6
v_smfmac_f32_16x16x64_bf16 v[100:103], v[36:39], a[232:239], v6
mega_kernel_rf_pc_12_2:
s_waitcnt vmcnt(1)
v_cmp_eq_u32 vcc, -1, v40
s_cbranch_vccnz mega_kernel_rf_pc_12_2f
v_smfmac_f32_16x16x64_bf16 v[96:99], v[40:43], a[208:215], v6
v_smfmac_f32_16x16x64_bf16 v[100:103], v[40:43], a[240:247], v6
mega_kernel_rf_pc_8_3:
s_waitcnt vmcnt(0)
v_cmp_eq_u32 vcc, -1, v44
s_cbranch_vccnz mega_kernel_rf_pc_8_3f
v_smfmac_f32_16x16x64_bf16 v[96:99], v[44:47], a[216:223], v6
v_smfmac_f32_16x16x64_bf16 v[100:103], v[44:47], a[248:255], v6
mega_kernel_rf_pc_d:
s_nop 7
v_permlane32_swap_b32 v96, v100
v_permlane32_swap_b32 v97, v101
v_permlane32_swap_b32 v98, v102
v_permlane32_swap_b32 v99, v103
v_pk_add_f32 v[96:97], v[96:97], v[100:101]
v_pk_add_f32 v[98:99], v[98:99], v[102:103]
ds_write2_b32 v18, v96, v97 offset0:0 offset1:36
ds_write2_b32 v18, v98, v99 offset0:72 offset1:108
s_waitcnt lgkmcnt(0)
s_barrier
s_cmp_lg_u32 s24, 0
s_cbranch_scc1 mega_kernel_rf_x1
ds_read_b128 v[120:123], v19 offset:0
ds_read_b128 v[124:127], v19 offset:1152
ds_read_b128 v[128:131], v19 offset:2304
ds_read_b128 v[132:135], v19 offset:3456
s_waitcnt lgkmcnt(2)
v_pk_add_f32 v[120:121], v[120:121], v[124:125]
v_pk_add_f32 v[122:123], v[122:123], v[126:127]
s_waitcnt lgkmcnt(0)
v_pk_add_f32 v[128:129], v[128:129], v[132:133]
v_pk_add_f32 v[130:131], v[130:131], v[134:135]
v_pk_add_f32 v[120:121], v[120:121], v[128:129]
v_pk_add_f32 v[122:123], v[122:123], v[130:131]
v_and_or_b32 v120, v120, -2, s47
v_and_or_b32 v121, v121, -2, s47
v_and_or_b32 v122, v122, -2, s47
v_and_or_b32 v123, v123, -2, s47
buffer_store_dwordx4 v[120:123], v12, s[84:87], s35 offen sc1
s_xor_b32 s76, s47, 1
v_mov_b32 v48, s76
v_mov_b32 v49, s76
v_mov_b32 v50, s76
v_mov_b32 v51, s76
v_mov_b32 v52, s76
v_mov_b32 v53, s76
v_mov_b32 v54, s76
v_mov_b32 v55, s76
v_mov_b32 v56, s76
v_mov_b32 v57, s76
v_mov_b32 v58, s76
v_mov_b32 v59, s76
v_mov_b32 v96, 0
v_mov_b32 v97, 0
v_mov_b32 v98, 0
v_mov_b32 v99, 0
v_mov_b32 v100, 0
v_mov_b32 v101, 0
v_mov_b32 v102, 0
v_mov_b32 v103, 0
v_mov_b32 v104, 0
v_mov_b32 v105, 0
v_mov_b32 v106, 0
v_mov_b32 v107, 0
v_mov_b32 v108, 0
v_mov_b32 v109, 0
v_mov_b32 v110, 0
v_mov_b32 v111, 0
v_mov_b32 v112, 0
v_mov_b32 v113, 0
v_mov_b32 v114, 0
v_mov_b32 v115, 0
v_mov_b32 v116, 0
v_mov_b32 v117, 0
v_mov_b32 v118, 0
v_mov_b32 v119, 0
s_nop 15
s_cmp_eq_u32 s47, 1
s_cbranch_scc1 mega_kernel_rf_p4_1
mega_kernel_rf_p4_0:
buffer_load_dwordx4 v[48:51], v25, s[84:87], s35 offen sc1
buffer_load_dwordx4 v[52:55], v26, s[84:87], s35 offen sc1
buffer_load_dwordx4 v[56:59], v27, s[84:87], s35 offen sc1
s_waitcnt vmcnt(36)
s_nop 1
v_bitop3_b32 v4, v48, v49, v50 bitop3:0xfe
v_bitop3_b32 v5, v54, v55, v56 bitop3:0xfe
v_bitop3_b32 v4, v4, v51, v52 bitop3:0xfe
v_bitop3_b32 v5, v5, v57, v58 bitop3:0xfe
v_bitop3_b32 v4, v4, v53, v59 bitop3:0xfe
v_bitop3_b32 v4, v4, v5, 1 bitop3:0xa8
v_cmp_ne_u32 vcc, 0, v4
s_cbranch_vccnz mega_kernel_rf_p4_0
s_branch mega_kernel_rf_p4d
mega_kernel_rf_p4_1:
buffer_load_dwordx4 v[48:51], v25, s[84:87], s35 offen sc1
buffer_load_dwordx4 v[52:55], v26, s[84:87], s35 offen sc1
buffer_load_dwordx4 v[56:59], v27, s[84:87], s35 offen sc1
s_waitcnt vmcnt(36)
s_nop 1
v_bitop3_b32 v4, v48, v49, v50 bitop3:0x80
v_bitop3_b32 v5, v54, v55, v56 bitop3:0x80
v_bitop3_b32 v4, v4, v51, v52 bitop3:0x80
v_bitop3_b32 v5, v5, v57, v58 bitop3:0x80
v_bitop3_b32 v4, v4, v53, v59 bitop3:0x80
v_bitop3_b32 v4, v4, v5, 1 bitop3:0x80
v_cmp_ne_u32 vcc, 1, v4
s_cbranch_vccnz mega_kernel_rf_p4_1
mega_kernel_rf_p4d:
v_pk_add_f32 v[120:121], v[120:121], v[48:49]
v_pk_add_f32 v[124:125], v[52:53], v[56:57]
v_pk_add_f32 v[122:123], v[122:123], v[50:51]
v_pk_add_f32 v[126:127], v[54:55], v[58:59]
v_pk_add_f32 v[120:121], v[120:121], v[124:125]
v_pk_add_f32 v[122:123], v[122:123], v[126:127]
v_cvt_pk_bf16_f32 v212, v120, v121
v_cvt_pk_bf16_f32 v213, v122, v123
v_min_u32 v212, -2, v212
buffer_store_dwordx2 v[212:213], v9, s[84:87], s34 offen
mega_kernel_rf_b5:
s_add_u32 s27, s27, 1
s_add_u32 s44, s44, 4096
s_cmp_eq_u32 s44, 30720
s_cselect_b32 s44, 18432, s44
s_mov_b32 s28, s33
s_mov_b32 s33, s34
s_mov_b32 s34, s28
s_xor_b32 s35, s35, 262144
s_bfe_u32 s47, s27, 0x10001
s_barrier
s_nop 15
s_nop 7
s_branch mega_kernel_rf_loop
mega_kernel_rf_x1:
s_cmp_eq_u32 s24, 1
s_cbranch_scc0 mega_kernel_rf_x2
s_add_u32 s76, s27, 1
v_mov_b32 v5, s76
s_mov_b64 exec, 1
buffer_store_dword v5, v228, s[84:87], s81 offen sc1
s_mov_b64 exec, -1
mega_kernel_rf_x2:
s_cmp_eq_u32 s24, 3
s_cbranch_scc0 mega_kernel_rf_x4
s_cmp_eq_u32 s36, 1
s_cbranch_scc0 mega_kernel_rf_x5
s_add_u32 s76, s27, 1
s_cmp_gt_i32 s46, s76
s_cbranch_scc1 mega_kernel_rf_pf1ok
mega_kernel_rf_pf1w:
buffer_load_dword v4, v24, s[84:87], 0 offen sc1
s_waitcnt vmcnt(0)
v_readlane_b32 s46, v4, 0
v_readlane_b32 s28, v4, 1
s_nop 1
s_min_i32 s46, s46, s28
s_cmp_gt_i32 s46, s76
s_cbranch_scc0 mega_kernel_rf_pf1w
mega_kernel_rf_pf1ok:
s_add_u32 s77, s76, s82
s_bfe_u32 s28, s77, 0x40002
s_lshl_b32 s28, s28, 14
s_and_b32 s77, s77, 3
s_lshl_b32 s77, s77, 11
s_add_u32 s28, s28, s77
s_add_u32 m0, s45, 0
s_nop 0
buffer_load_dwordx4 v240, s[84:87], s28 offen offset:0 sc1 lds
s_add_u32 m0, s45, 0
s_nop 0
buffer_load_dwordx4 v240, s[84:87], s28 offen offset:1024 sc1 lds
s_add_u32 m0, s45, 2048
s_nop 0
buffer_load_dwordx4 v241, s[84:87], s28 offen offset:0 sc1 lds
s_add_u32 m0, s45, 2048
s_nop 0
buffer_load_dwordx4 v241, s[84:87], s28 offen offset:1024 sc1 lds
s_add_u32 s45, s45, 4096
s_cmp_eq_u32 s45, 30720
s_cselect_b32 s45, 18432, s45
s_waitcnt vmcnt(0)
mega_kernel_rf_x5:
s_add_u32 s76, s27, 3
s_min_u32 s76, s76, 63
s_cmp_gt_i32 s46, s76
s_cbranch_scc1 mega_kernel_rf_pf2ok
mega_kernel_rf_pf2w:
buffer_load_dword v4, v24, s[84:87], 0 offen sc1
s_waitcnt vmcnt(0)
v_readlane_b32 s46, v4, 0
v_readlane_b32 s28, v4, 1
s_nop 1
s_min_i32 s46, s46, s28
s_cmp_gt_i32 s46, s76
s_cbranch_scc0 mega_kernel_rf_x6
mega_kernel_rf_pf2ok:
mega_kernel_rf_x6:
s_add_u32 s76, s27, 2
s_cmp_lt_u32 s76, 63
s_cbranch_scc0 mega_kernel_rf_x4
s_cmp_gt_i32 s46, s76
s_cbranch_scc0 mega_kernel_rf_x4
s_cmp_eq_u32 s88, s76
s_cbranch_scc1 mega_kernel_rf_x7
s_add_u32 s77, s76, s82
s_bfe_u32 s28, s77, 0x40002
s_lshl_b32 s28, s28, 14
s_and_b32 s77, s77, 3
s_lshl_b32 s77, s77, 11
s_add_u32 s28, s28, s77
s_add_u32 s28, s28, s83
s_buffer_load_dword s78, s[84:87], s28 offset:0
s_buffer_load_dword s78, s[84:87], s28 offset:128
s_buffer_load_dword s78, s[84:87], s28 offset:256
s_buffer_load_dword s78, s[84:87], s28 offset:384
s_buffer_load_dword s78, s[84:87], s28 offset:512
s_buffer_load_dword s78, s[84:87], s28 offset:640
s_buffer_load_dword s78, s[84:87], s28 offset:768
s_buffer_load_dword s78, s[84:87], s28 offset:896
s_buffer_load_dword s78, s[84:87], s28 offset:1024
s_buffer_load_dword s78, s[84:87], s28 offset:1152
s_buffer_load_dword s78, s[84:87], s28 offset:1280
s_buffer_load_dword s78, s[84:87], s28 offset:1408
s_buffer_load_dword s78, s[84:87], s28 offset:1536
s_buffer_load_dword s78, s[84:87], s28 offset:1664
s_buffer_load_dword s78, s[84:87], s28 offset:1792
s_buffer_load_dword s78, s[84:87], s28 offset:1920
mega_kernel_rf_x7:
s_add_u32 s77, s76, s82
s_bfe_u32 s28, s77, 0x40002
s_lshl_b32 s28, s28, 14
s_and_b32 s77, s77, 3
s_lshl_b32 s77, s77, 11
s_add_u32 s28, s28, s77
s_add_u32 s28, s28, s83
s_add_u32 s28, s28, 33554432
s_buffer_load_dword s78, s[84:87], s28 offset:0
s_buffer_load_dword s78, s[84:87], s28 offset:128
s_buffer_load_dword s78, s[84:87], s28 offset:256
s_buffer_load_dword s78, s[84:87], s28 offset:384
s_buffer_load_dword s78, s[84:87], s28 offset:512
s_buffer_load_dword s78, s[84:87], s28 offset:640
s_buffer_load_dword s78, s[84:87], s28 offset:768
s_buffer_load_dword s78, s[84:87], s28 offset:896
s_buffer_load_dword s78, s[84:87], s28 offset:1024
s_buffer_load_dword s78, s[84:87], s28 offset:1152
s_buffer_load_dword s78, s[84:87], s28 offset:1280
s_buffer_load_dword s78, s[84:87], s28 offset:1408
s_buffer_load_dword s78, s[84:87], s28 offset:1536
s_buffer_load_dword s78, s[84:87], s28 offset:1664
s_buffer_load_dword s78, s[84:87], s28 offset:1792
s_buffer_load_dword s78, s[84:87], s28 offset:1920
s_mov_b32 s89, s76
mega_kernel_rf_x4:
v_mov_b32 v96, 0
v_mov_b32 v97, 0
v_mov_b32 v98, 0
v_mov_b32 v99, 0
v_mov_b32 v100, 0
v_mov_b32 v101, 0
v_mov_b32 v102, 0
v_mov_b32 v103, 0
v_mov_b32 v104, 0
v_mov_b32 v105, 0
v_mov_b32 v106, 0
v_mov_b32 v107, 0
v_mov_b32 v108, 0
v_mov_b32 v109, 0
v_mov_b32 v110, 0
v_mov_b32 v111, 0
v_mov_b32 v112, 0
v_mov_b32 v113, 0
v_mov_b32 v114, 0
v_mov_b32 v115, 0
v_mov_b32 v116, 0
v_mov_b32 v117, 0
v_mov_b32 v118, 0
v_mov_b32 v119, 0
s_branch mega_kernel_rf_b5
mega_kernel_rf_p2r:
buffer_load_dwordx4 v[184:187], v17, s[84:87], s76 offen sc1
buffer_load_dwordx4 v[188:191], v10, s[84:87], s76 offen sc1
buffer_load_dwordx4 v[192:195], v17, s[84:87], s77 offen sc1
buffer_load_dwordx4 v[196:199], v10, s[84:87], s77 offen sc1
buffer_load_dwordx4 v[200:203], v17, s[84:87], s78 offen sc1
buffer_load_dwordx4 v[204:207], v10, s[84:87], s78 offen sc1
s_branch mega_kernel_rf_p2
mega_kernel_rf_pa_1_0f:
s_mov_b64 exec, vcc
buffer_load_dwordx4 v[32:35], v7, s[84:87], s33 offen offset:0 sc1
s_mov_b64 exec, -1
s_branch mega_kernel_rf_pa_1_0
mega_kernel_rf_pa_1_0:
s_waitcnt vmcnt(0)
v_max_u32 v4, v32, v34
v_cmp_eq_u32 vcc, -1, v4
s_cbranch_vccnz mega_kernel_rf_pa_1_0f
v_smfmac_f32_16x16x64_bf16 v[96:99], v[32:35], a[0:7], v6
v_smfmac_f32_16x16x64_bf16 v[100:103], v[32:35], a[32:39], v6
v_smfmac_f32_16x16x64_bf16 v[104:107], v[32:35], a[64:71], v6
v_smfmac_f32_16x16x64_bf16 v[108:111], v[32:35], a[96:103], v6
s_branch mega_kernel_rf_pa_d
mega_kernel_rf_pa_2_1f:
s_mov_b64 exec, vcc
buffer_load_dwordx4 v[36:39], v7, s[84:87], s33 offen offset:1024 sc1
s_mov_b64 exec, -1
s_branch mega_kernel_rf_pa_2_1
mega_kernel_rf_pa_2_1:
s_waitcnt vmcnt(0)
v_max_u32 v4, v36, v38
v_cmp_eq_u32 vcc, -1, v4
s_cbranch_vccnz mega_kernel_rf_pa_2_1f
v_smfmac_f32_16x16x64_bf16 v[96:99], v[36:39], a[8:15], v6
v_smfmac_f32_16x16x64_bf16 v[100:103], v[36:39], a[40:47], v6
v_smfmac_f32_16x16x64_bf16 v[104:107], v[36:39], a[72:79], v6
v_smfmac_f32_16x16x64_bf16 v[108:111], v[36:39], a[104:111], v6
s_branch mega_kernel_rf_pa_d
mega_kernel_rf_pa_3_0f:
s_mov_b64 exec, vcc
buffer_load_dwordx4 v[32:35], v7, s[84:87], s33 offen offset:0 sc1
s_mov_b64 exec, -1
s_branch mega_kernel_rf_pa_3_1
mega_kernel_rf_pa_3_0:
s_waitcnt vmcnt(1)
v_max_u32 v4, v32, v34
v_cmp_eq_u32 vcc, -1, v4
s_cbranch_vccnz mega_kernel_rf_pa_3_0f
v_smfmac_f32_16x16x64_bf16 v[96:99], v[32:35], a[0:7], v6
v_smfmac_f32_16x16x64_bf16 v[100:103], v[32:35], a[32:39], v6
v_smfmac_f32_16x16x64_bf16 v[104:107], v[32:35], a[64:71], v6
v_smfmac_f32_16x16x64_bf16 v[108:111], v[32:35], a[96:103], v6
s_branch mega_kernel_rf_pa_2_1
mega_kernel_rf_pa_3_1f:
s_mov_b64 exec, vcc
buffer_load_dwordx4 v[36:39], v7, s[84:87], s33 offen offset:1024 sc1
s_mov_b64 exec, -1
s_branch mega_kernel_rf_pa_3_0
mega_kernel_rf_pa_3_1:
s_waitcnt vmcnt(1)
v_max_u32 v4, v36, v38
v_cmp_eq_u32 vcc, -1, v4
s_cbranch_vccnz mega_kernel_rf_pa_3_1f
v_smfmac_f32_16x16x64_bf16 v[96:99], v[36:39], a[8:15], v6
v_smfmac_f32_16x16x64_bf16 v[100:103], v[36:39], a[40:47], v6
v_smfmac_f32_16x16x64_bf16 v[104:107], v[36:39], a[72:79], v6
v_smfmac_f32_16x16x64_bf16 v[108:111], v[36:39], a[104:111], v6
s_branch mega_kernel_rf_pa_1_0
mega_kernel_rf_pa_4_2f:
s_mov_b64 exec, vcc
buffer_load_dwordx4 v[40:43], v7, s[84:87], s33 offen offset:2048 sc1
s_mov_b64 exec, -1
s_branch mega_kernel_rf_pa_4_2
mega_kernel_rf_pa_4_2:
s_waitcnt vmcnt(0)
v_max_u32 v4, v40, v42
v_cmp_eq_u32 vcc, -1, v4
s_cbranch_vccnz mega_kernel_rf_pa_4_2f
v_smfmac_f32_16x16x64_bf16 v[96:99], v[40:43], a[16:23], v6
v_smfmac_f32_16x16x64_bf16 v[100:103], v[40:43], a[48:55], v6
v_smfmac_f32_16x16x64_bf16 v[104:107], v[40:43], a[80:87], v6
v_smfmac_f32_16x16x64_bf16 v[108:111], v[40:43], a[112:119], v6
s_branch mega_kernel_rf_pa_d
mega_kernel_rf_pa_5_0f:
s_mov_b64 exec, vcc
buffer_load_dwordx4 v[32:35], v7, s[84:87], s33 offen offset:0 sc1
s_mov_b64 exec, -1
s_branch mega_kernel_rf_pa_5_2
mega_kernel_rf_pa_5_0:
s_waitcnt vmcnt(1)
v_max_u32 v4, v32, v34
v_cmp_eq_u32 vcc, -1, v4
s_cbranch_vccnz mega_kernel_rf_pa_5_0f
v_smfmac_f32_16x16x64_bf16 v[96:99], v[32:35], a[0:7], v6
v_smfmac_f32_16x16x64_bf16 v[100:103], v[32:35], a[32:39], v6
v_smfmac_f32_16x16x64_bf16 v[104:107], v[32:35], a[64:71], v6
v_smfmac_f32_16x16x64_bf16 v[108:111], v[32:35], a[96:103], v6
s_branch mega_kernel_rf_pa_4_2
mega_kernel_rf_pa_5_2f:
s_mov_b64 exec, vcc
buffer_load_dwordx4 v[40:43], v7, s[84:87], s33 offen offset:2048 sc1
s_mov_b64 exec, -1
s_branch mega_kernel_rf_pa_5_0
mega_kernel_rf_pa_5_2:
s_waitcnt vmcnt(1)
v_max_u32 v4, v40, v42
v_cmp_eq_u32 vcc, -1, v4
s_cbranch_vccnz mega_kernel_rf_pa_5_2f
v_smfmac_f32_16x16x64_bf16 v[96:99], v[40:43], a[16:23], v6
v_smfmac_f32_16x16x64_bf16 v[100:103], v[40:43], a[48:55], v6
v_smfmac_f32_16x16x64_bf16 v[104:107], v[40:43], a[80:87], v6
v_smfmac_f32_16x16x64_bf16 v[108:111], v[40:43], a[112:119], v6
s_branch mega_kernel_rf_pa_1_0
mega_kernel_rf_pa_6_1f:
s_mov_b64 exec, vcc
buffer_load_dwordx4 v[36:39], v7, s[84:87], s33 offen offset:1024 sc1
s_mov_b64 exec, -1
s_branch mega_kernel_rf_pa_6_2
mega_kernel_rf_pa_6_1:
s_waitcnt vmcnt(1)
v_max_u32 v4, v36, v38
v_cmp_eq_u32 vcc, -1, v4
s_cbranch_vccnz mega_kernel_rf_pa_6_1f
v_smfmac_f32_16x16x64_bf16 v[96:99], v[36:39], a[8:15], v6
v_smfmac_f32_16x16x64_bf16 v[100:103], v[36:39], a[40:47], v6
v_smfmac_f32_16x16x64_bf16 v[104:107], v[36:39], a[72:79], v6
v_smfmac_f32_16x16x64_bf16 v[108:111], v[36:39], a[104:111], v6
s_branch mega_kernel_rf_pa_4_2
mega_kernel_rf_pa_6_2f:
s_mov_b64 exec, vcc
buffer_load_dwordx4 v[40:43], v7, s[84:87], s33 offen offset:2048 sc1
s_mov_b64 exec, -1
s_branch mega_kernel_rf_pa_6_1
mega_kernel_rf_pa_6_2:
s_waitcnt vmcnt(1)
v_max_u32 v4, v40, v42
v_cmp_eq_u32 vcc, -1, v4
s_cbranch_vccnz mega_kernel_rf_pa_6_2f
v_smfmac_f32_16x16x64_bf16 v[96:99], v[40:43], a[16:23], v6
v_smfmac_f32_16x16x64_bf16 v[100:103], v[40:43], a[48:55], v6
v_smfmac_f32_16x16x64_bf16 v[104:107], v[40:43], a[80:87], v6
v_smfmac_f32_16x16x64_bf16 v[108:111], v[40:43], a[112:119], v6
s_branch mega_kernel_rf_pa_2_1
mega_kernel_rf_pa_7_0f:
s_mov_b64 exec, vcc
buffer_load_dwordx4 v[32:35], v7, s[84:87], s33 offen offset:0 sc1
s_mov_b64 exec, -1
s_branch mega_kernel_rf_pa_7_1
mega_kernel_rf_pa_7_0:
s_waitcnt vmcnt(2)
v_max_u32 v4, v32, v34
v_cmp_eq_u32 vcc, -1, v4
s_cbranch_vccnz mega_kernel_rf_pa_7_0f
v_smfmac_f32_16x16x64_bf16 v[96:99], v[32:35], a[0:7], v6
v_smfmac_f32_16x16x64_bf16 v[100:103], v[32:35], a[32:39], v6
v_smfmac_f32_16x16x64_bf16 v[104:107], v[32:35], a[64:71], v6
v_smfmac_f32_16x16x64_bf16 v[108:111], v[32:35], a[96:103], v6
s_branch mega_kernel_rf_pa_6_1
mega_kernel_rf_pa_7_1f:
s_mov_b64 exec, vcc
buffer_load_dwordx4 v[36:39], v7, s[84:87], s33 offen offset:1024 sc1
s_mov_b64 exec, -1
s_branch mega_kernel_rf_pa_7_2
mega_kernel_rf_pa_7_1:
s_waitcnt vmcnt(2)
v_max_u32 v4, v36, v38
v_cmp_eq_u32 vcc, -1, v4
s_cbranch_vccnz mega_kernel_rf_pa_7_1f
v_smfmac_f32_16x16x64_bf16 v[96:99], v[36:39], a[8:15], v6
v_smfmac_f32_16x16x64_bf16 v[100:103], v[36:39], a[40:47], v6
v_smfmac_f32_16x16x64_bf16 v[104:107], v[36:39], a[72:79], v6
v_smfmac_f32_16x16x64_bf16 v[108:111], v[36:39], a[104:111], v6
s_branch mega_kernel_rf_pa_5_2
mega_kernel_rf_pa_7_2f:
s_mov_b64 exec, vcc
buffer_load_dwordx4 v[40:43], v7, s[84:87], s33 offen offset:2048 sc1
s_mov_b64 exec, -1
s_branch mega_kernel_rf_pa_7_0
mega_kernel_rf_pa_7_2:
s_waitcnt vmcnt(2)
v_max_u32 v4, v40, v42
v_cmp_eq_u32 vcc, -1, v4
s_cbranch_vccnz mega_kernel_rf_pa_7_2f
v_smfmac_f32_16x16x64_bf16 v[96:99], v[40:43], a[16:23], v6
v_smfmac_f32_16x16x64_bf16 v[100:103], v[40:43], a[48:55], v6
v_smfmac_f32_16x16x64_bf16 v[104:107], v[40:43], a[80:87], v6
v_smfmac_f32_16x16x64_bf16 v[108:111], v[40:43], a[112:119], v6
s_branch mega_kernel_rf_pa_3_0
mega_kernel_rf_pa_8_3f:
s_mov_b64 exec, vcc
buffer_load_dwordx4 v[44:47], v7, s[84:87], s33 offen offset:3072 sc1
s_mov_b64 exec, -1
s_branch mega_kernel_rf_pa_8_3
mega_kernel_rf_pa_8_3:
s_waitcnt vmcnt(0)
v_max_u32 v4, v44, v46
v_cmp_eq_u32 vcc, -1, v4
s_cbranch_vccnz mega_kernel_rf_pa_8_3f
v_smfmac_f32_16x16x64_bf16 v[96:99], v[44:47], a[24:31], v6
v_smfmac_f32_16x16x64_bf16 v[100:103], v[44:47], a[56:63], v6
v_smfmac_f32_16x16x64_bf16 v[104:107], v[44:47], a[88:95], v6
v_smfmac_f32_16x16x64_bf16 v[108:111], v[44:47], a[120:127], v6
s_branch mega_kernel_rf_pa_d
mega_kernel_rf_pa_9_0f:
s_mov_b64 exec, vcc
buffer_load_dwordx4 v[32:35], v7, s[84:87], s33 offen offset:0 sc1
s_mov_b64 exec, -1
s_branch mega_kernel_rf_pa_9_3
mega_kernel_rf_pa_9_0:
s_waitcnt vmcnt(1)
v_max_u32 v4, v32, v34
v_cmp_eq_u32 vcc, -1, v4
s_cbranch_vccnz mega_kernel_rf_pa_9_0f
v_smfmac_f32_16x16x64_bf16 v[96:99], v[32:35], a[0:7], v6
v_smfmac_f32_16x16x64_bf16 v[100:103], v[32:35], a[32:39], v6
v_smfmac_f32_16x16x64_bf16 v[104:107], v[32:35], a[64:71], v6
v_smfmac_f32_16x16x64_bf16 v[108:111], v[32:35], a[96:103], v6
s_branch mega_kernel_rf_pa_8_3
mega_kernel_rf_pa_9_3f:
s_mov_b64 exec, vcc
buffer_load_dwordx4 v[44:47], v7, s[84:87], s33 offen offset:3072 sc1
s_mov_b64 exec, -1
s_branch mega_kernel_rf_pa_9_0
mega_kernel_rf_pa_9_3:
s_waitcnt vmcnt(1)
v_max_u32 v4, v44, v46
v_cmp_eq_u32 vcc, -1, v4
s_cbranch_vccnz mega_kernel_rf_pa_9_3f
v_smfmac_f32_16x16x64_bf16 v[96:99], v[44:47], a[24:31], v6
v_smfmac_f32_16x16x64_bf16 v[100:103], v[44:47], a[56:63], v6
v_smfmac_f32_16x16x64_bf16 v[104:107], v[44:47], a[88:95], v6
v_smfmac_f32_16x16x64_bf16 v[108:111], v[44:47], a[120:127], v6
s_branch mega_kernel_rf_pa_1_0
mega_kernel_rf_pa_10_1f:
s_mov_b64 exec, vcc
buffer_load_dwordx4 v[36:39], v7, s[84:87], s33 offen offset:1024 sc1
s_mov_b64 exec, -1
s_branch mega_kernel_rf_pa_10_3
mega_kernel_rf_pa_10_1:
s_waitcnt vmcnt(1)
v_max_u32 v4, v36, v38
v_cmp_eq_u32 vcc, -1, v4
s_cbranch_vccnz mega_kernel_rf_pa_10_1f
v_smfmac_f32_16x16x64_bf16 v[96:99], v[36:39], a[8:15], v6
v_smfmac_f32_16x16x64_bf16 v[100:103], v[36:39], a[40:47], v6
v_smfmac_f32_16x16x64_bf16 v[104:107], v[36:39], a[72:79], v6
v_smfmac_f32_16x16x64_bf16 v[108:111], v[36:39], a[104:111], v6
s_branch mega_kernel_rf_pa_8_3
mega_kernel_rf_pa_10_3f:
s_mov_b64 exec, vcc
buffer_load_dwordx4 v[44:47], v7, s[84:87], s33 offen offset:3072 sc1
s_mov_b64 exec, -1
s_branch mega_kernel_rf_pa_10_1
mega_kernel_rf_pa_10_3:
s_waitcnt vmcnt(1)
v_max_u32 v4, v44, v46
v_cmp_eq_u32 vcc, -1, v4
s_cbranch_vccnz mega_kernel_rf_pa_10_3f
v_smfmac_f32_16x16x64_bf16 v[96:99], v[44:47], a[24:31], v6
v_smfmac_f32_16x16x64_bf16 v[100:103], v[44:47], a[56:63], v6
v_smfmac_f32_16x16x64_bf16 v[104:107], v[44:47], a[88:95], v6
v_smfmac_f32_16x16x64_bf16 v[108:111], v[44:47], a[120:127], v6
s_branch mega_kernel_rf_pa_2_1
mega_kernel_rf_pa_11_0f:
s_mov_b64 exec, vcc
buffer_load_dwordx4 v[32:35], v7, s[84:87], s33 offen offset:0 sc1
s_mov_b64 exec, -1
s_branch mega_kernel_rf_pa_11_1
mega_kernel_rf_pa_11_0:
s_waitcnt vmcnt(2)
v_max_u32 v4, v32, v34
v_cmp_eq_u32 vcc, -1, v4
s_cbranch_vccnz mega_kernel_rf_pa_11_0f
v_smfmac_f32_16x16x64_bf16 v[96:99], v[32:35], a[0:7], v6
v_smfmac_f32_16x16x64_bf16 v[100:103], v[32:35], a[32:39], v6
v_smfmac_f32_16x16x64_bf16 v[104:107], v[32:35], a[64:71], v6
v_smfmac_f32_16x16x64_bf16 v[108:111], v[32:35], a[96:103], v6
s_branch mega_kernel_rf_pa_10_1
mega_kernel_rf_pa_11_1f:
s_mov_b64 exec, vcc
buffer_load_dwordx4 v[36:39], v7, s[84:87], s33 offen offset:1024 sc1
s_mov_b64 exec, -1
s_branch mega_kernel_rf_pa_11_3
mega_kernel_rf_pa_11_1:
s_waitcnt vmcnt(2)
v_max_u32 v4, v36, v38
v_cmp_eq_u32 vcc, -1, v4
s_cbranch_vccnz mega_kernel_rf_pa_11_1f
v_smfmac_f32_16x16x64_bf16 v[96:99], v[36:39], a[8:15], v6
v_smfmac_f32_16x16x64_bf16 v[100:103], v[36:39], a[40:47], v6
v_smfmac_f32_16x16x64_bf16 v[104:107], v[36:39], a[72:79], v6
v_smfmac_f32_16x16x64_bf16 v[108:111], v[36:39], a[104:111], v6
s_branch mega_kernel_rf_pa_9_3
mega_kernel_rf_pa_11_3f:
s_mov_b64 exec, vcc
buffer_load_dwordx4 v[44:47], v7, s[84:87], s33 offen offset:3072 sc1
s_mov_b64 exec, -1
s_branch mega_kernel_rf_pa_11_0
mega_kernel_rf_pa_11_3:
s_waitcnt vmcnt(2)
v_max_u32 v4, v44, v46
v_cmp_eq_u32 vcc, -1, v4
s_cbranch_vccnz mega_kernel_rf_pa_11_3f
v_smfmac_f32_16x16x64_bf16 v[96:99], v[44:47], a[24:31], v6
v_smfmac_f32_16x16x64_bf16 v[100:103], v[44:47], a[56:63], v6
v_smfmac_f32_16x16x64_bf16 v[104:107], v[44:47], a[88:95], v6
v_smfmac_f32_16x16x64_bf16 v[108:111], v[44:47], a[120:127], v6
s_branch mega_kernel_rf_pa_3_0
mega_kernel_rf_pa_12_2f:
s_mov_b64 exec, vcc
buffer_load_dwordx4 v[40:43], v7, s[84:87], s33 offen offset:2048 sc1
s_mov_b64 exec, -1
s_branch mega_kernel_rf_pa_12_3
mega_kernel_rf_pa_12_2:
s_waitcnt vmcnt(1)
v_max_u32 v4, v40, v42
v_cmp_eq_u32 vcc, -1, v4
s_cbranch_vccnz mega_kernel_rf_pa_12_2f
v_smfmac_f32_16x16x64_bf16 v[96:99], v[40:43], a[16:23], v6
v_smfmac_f32_16x16x64_bf16 v[100:103], v[40:43], a[48:55], v6
v_smfmac_f32_16x16x64_bf16 v[104:107], v[40:43], a[80:87], v6
v_smfmac_f32_16x16x64_bf16 v[108:111], v[40:43], a[112:119], v6
s_branch mega_kernel_rf_pa_8_3
mega_kernel_rf_pa_12_3f:
s_mov_b64 exec, vcc
buffer_load_dwordx4 v[44:47], v7, s[84:87], s33 offen offset:3072 sc1
s_mov_b64 exec, -1
s_branch mega_kernel_rf_pa_12_2
mega_kernel_rf_pa_12_3:
s_waitcnt vmcnt(1)
v_max_u32 v4, v44, v46
v_cmp_eq_u32 vcc, -1, v4
s_cbranch_vccnz mega_kernel_rf_pa_12_3f
v_smfmac_f32_16x16x64_bf16 v[96:99], v[44:47], a[24:31], v6
v_smfmac_f32_16x16x64_bf16 v[100:103], v[44:47], a[56:63], v6
v_smfmac_f32_16x16x64_bf16 v[104:107], v[44:47], a[88:95], v6
v_smfmac_f32_16x16x64_bf16 v[108:111], v[44:47], a[120:127], v6
s_branch mega_kernel_rf_pa_4_2
mega_kernel_rf_pa_13_0f:
s_mov_b64 exec, vcc
buffer_load_dwordx4 v[32:35], v7, s[84:87], s33 offen offset:0 sc1
s_mov_b64 exec, -1
s_branch mega_kernel_rf_pa_13_2
mega_kernel_rf_pa_13_0:
s_waitcnt vmcnt(2)
v_max_u32 v4, v32, v34
v_cmp_eq_u32 vcc, -1, v4
s_cbranch_vccnz mega_kernel_rf_pa_13_0f
v_smfmac_f32_16x16x64_bf16 v[96:99], v[32:35], a[0:7], v6
v_smfmac_f32_16x16x64_bf16 v[100:103], v[32:35], a[32:39], v6
v_smfmac_f32_16x16x64_bf16 v[104:107], v[32:35], a[64:71], v6
v_smfmac_f32_16x16x64_bf16 v[108:111], v[32:35], a[96:103], v6
s_branch mega_kernel_rf_pa_12_2
mega_kernel_rf_pa_13_2f:
s_mov_b64 exec, vcc
buffer_load_dwordx4 v[40:43], v7, s[84:87], s33 offen offset:2048 sc1
s_mov_b64 exec, -1
s_branch mega_kernel_rf_pa_13_3
mega_kernel_rf_pa_13_2:
s_waitcnt vmcnt(2)
v_max_u32 v4, v40, v42
v_cmp_eq_u32 vcc, -1, v4
s_cbranch_vccnz mega_kernel_rf_pa_13_2f
v_smfmac_f32_16x16x64_bf16 v[96:99], v[40:43], a[16:23], v6
v_smfmac_f32_16x16x64_bf16 v[100:103], v[40:43], a[48:55], v6
v_smfmac_f32_16x16x64_bf16 v[104:107], v[40:43], a[80:87], v6
v_smfmac_f32_16x16x64_bf16 v[108:111], v[40:43], a[112:119], v6
s_branch mega_kernel_rf_pa_9_3
mega_kernel_rf_pa_13_3f:
s_mov_b64 exec, vcc
buffer_load_dwordx4 v[44:47], v7, s[84:87], s33 offen offset:3072 sc1
s_mov_b64 exec, -1
s_branch mega_kernel_rf_pa_13_0
mega_kernel_rf_pa_13_3:
s_waitcnt vmcnt(2)
v_max_u32 v4, v44, v46
v_cmp_eq_u32 vcc, -1, v4
s_cbranch_vccnz mega_kernel_rf_pa_13_3f
v_smfmac_f32_16x16x64_bf16 v[96:99], v[44:47], a[24:31], v6
v_smfmac_f32_16x16x64_bf16 v[100:103], v[44:47], a[56:63], v6
v_smfmac_f32_16x16x64_bf16 v[104:107], v[44:47], a[88:95], v6
v_smfmac_f32_16x16x64_bf16 v[108:111], v[44:47], a[120:127], v6
s_branch mega_kernel_rf_pa_5_0
mega_kernel_rf_pa_14_1f:
s_mov_b64 exec, vcc
buffer_load_dwordx4 v[36:39], v7, s[84:87], s33 offen offset:1024 sc1
s_mov_b64 exec, -1
s_branch mega_kernel_rf_pa_14_2
mega_kernel_rf_pa_14_1:
s_waitcnt vmcnt(2)
v_max_u32 v4, v36, v38
v_cmp_eq_u32 vcc, -1, v4
s_cbranch_vccnz mega_kernel_rf_pa_14_1f
v_smfmac_f32_16x16x64_bf16 v[96:99], v[36:39], a[8:15], v6
v_smfmac_f32_16x16x64_bf16 v[100:103], v[36:39], a[40:47], v6
v_smfmac_f32_16x16x64_bf16 v[104:107], v[36:39], a[72:79], v6
v_smfmac_f32_16x16x64_bf16 v[108:111], v[36:39], a[104:111], v6
s_branch mega_kernel_rf_pa_12_2
mega_kernel_rf_pa_14_2f:
s_mov_b64 exec, vcc
buffer_load_dwordx4 v[40:43], v7, s[84:87], s33 offen offset:2048 sc1
s_mov_b64 exec, -1
s_branch mega_kernel_rf_pa_14_3
mega_kernel_rf_pa_14_2:
s_waitcnt vmcnt(2)
v_max_u32 v4, v40, v42
v_cmp_eq_u32 vcc, -1, v4
s_cbranch_vccnz mega_kernel_rf_pa_14_2f
v_smfmac_f32_16x16x64_bf16 v[96:99], v[40:43], a[16:23], v6
v_smfmac_f32_16x16x64_bf16 v[100:103], v[40:43], a[48:55], v6
v_smfmac_f32_16x16x64_bf16 v[104:107], v[40:43], a[80:87], v6
v_smfmac_f32_16x16x64_bf16 v[108:111], v[40:43], a[112:119], v6
s_branch mega_kernel_rf_pa_10_3
mega_kernel_rf_pa_14_3f:
s_mov_b64 exec, vcc
buffer_load_dwordx4 v[44:47], v7, s[84:87], s33 offen offset:3072 sc1
s_mov_b64 exec, -1
s_branch mega_kernel_rf_pa_14_1
mega_kernel_rf_pa_14_3:
s_waitcnt vmcnt(2)
v_max_u32 v4, v44, v46
v_cmp_eq_u32 vcc, -1, v4
s_cbranch_vccnz mega_kernel_rf_pa_14_3f
v_smfmac_f32_16x16x64_bf16 v[96:99], v[44:47], a[24:31], v6
v_smfmac_f32_16x16x64_bf16 v[100:103], v[44:47], a[56:63], v6
v_smfmac_f32_16x16x64_bf16 v[104:107], v[44:47], a[88:95], v6
v_smfmac_f32_16x16x64_bf16 v[108:111], v[44:47], a[120:127], v6
s_branch mega_kernel_rf_pa_6_1
mega_kernel_rf_pa_15_0f:
s_mov_b64 exec, vcc
buffer_load_dwordx4 v[32:35], v7, s[84:87], s33 offen offset:0 sc1
s_mov_b64 exec, -1
s_branch mega_kernel_rf_pa_15_1
mega_kernel_rf_pa_15_0:
s_waitcnt vmcnt(3)
v_max_u32 v4, v32, v34
v_cmp_eq_u32 vcc, -1, v4
s_cbranch_vccnz mega_kernel_rf_pa_15_0f
v_smfmac_f32_16x16x64_bf16 v[96:99], v[32:35], a[0:7], v6
v_smfmac_f32_16x16x64_bf16 v[100:103], v[32:35], a[32:39], v6
v_smfmac_f32_16x16x64_bf16 v[104:107], v[32:35], a[64:71], v6
v_smfmac_f32_16x16x64_bf16 v[108:111], v[32:35], a[96:103], v6
s_branch mega_kernel_rf_pa_14_1
mega_kernel_rf_pa_15_1f:
s_mov_b64 exec, vcc
buffer_load_dwordx4 v[36:39], v7, s[84:87], s33 offen offset:1024 sc1
s_mov_b64 exec, -1
s_branch mega_kernel_rf_pa_15_2
mega_kernel_rf_pa_15_1:
s_waitcnt vmcnt(3)
v_max_u32 v4, v36, v38
v_cmp_eq_u32 vcc, -1, v4
s_cbranch_vccnz mega_kernel_rf_pa_15_1f
v_smfmac_f32_16x16x64_bf16 v[96:99], v[36:39], a[8:15], v6
v_smfmac_f32_16x16x64_bf16 v[100:103], v[36:39], a[40:47], v6
v_smfmac_f32_16x16x64_bf16 v[104:107], v[36:39], a[72:79], v6
v_smfmac_f32_16x16x64_bf16 v[108:111], v[36:39], a[104:111], v6
s_branch mega_kernel_rf_pa_13_2
mega_kernel_rf_pa_15_2f:
s_mov_b64 exec, vcc
buffer_load_dwordx4 v[40:43], v7, s[84:87], s33 offen offset:2048 sc1
s_mov_b64 exec, -1
s_branch mega_kernel_rf_pa_15_3
mega_kernel_rf_pa_15_2:
s_waitcnt vmcnt(3)
v_max_u32 v4, v40, v42
v_cmp_eq_u32 vcc, -1, v4
s_cbranch_vccnz mega_kernel_rf_pa_15_2f
v_smfmac_f32_16x16x64_bf16 v[96:99], v[40:43], a[16:23], v6
v_smfmac_f32_16x16x64_bf16 v[100:103], v[40:43], a[48:55], v6
v_smfmac_f32_16x16x64_bf16 v[104:107], v[40:43], a[80:87], v6
v_smfmac_f32_16x16x64_bf16 v[108:111], v[40:43], a[112:119], v6
s_branch mega_kernel_rf_pa_11_3
mega_kernel_rf_pa_15_3f:
s_mov_b64 exec, vcc
buffer_load_dwordx4 v[44:47], v7, s[84:87], s33 offen offset:3072 sc1
s_mov_b64 exec, -1
s_branch mega_kernel_rf_pa_15_0
mega_kernel_rf_pa_15_3:
s_waitcnt vmcnt(3)
v_max_u32 v4, v44, v46
v_cmp_eq_u32 vcc, -1, v4
s_cbranch_vccnz mega_kernel_rf_pa_15_3f
v_smfmac_f32_16x16x64_bf16 v[96:99], v[44:47], a[24:31], v6
v_smfmac_f32_16x16x64_bf16 v[100:103], v[44:47], a[56:63], v6
v_smfmac_f32_16x16x64_bf16 v[104:107], v[44:47], a[88:95], v6
v_smfmac_f32_16x16x64_bf16 v[108:111], v[44:47], a[120:127], v6
s_branch mega_kernel_rf_pa_7_0
mega_kernel_rf_pc_1_0f:
s_mov_b64 exec, vcc
buffer_load_dwordx4 v[32:35], v7, s[84:87], s29 offen offset:0 sc1
s_mov_b64 exec, -1
s_branch mega_kernel_rf_pc_1_0
mega_kernel_rf_pc_1_0:
s_waitcnt vmcnt(0)
v_cmp_eq_u32 vcc, -1, v32
s_cbranch_vccnz mega_kernel_rf_pc_1_0f
v_smfmac_f32_16x16x64_bf16 v[96:99], v[32:35], a[192:199], v6
v_smfmac_f32_16x16x64_bf16 v[100:103], v[32:35], a[224:231], v6
s_branch mega_kernel_rf_pc_d
mega_kernel_rf_pc_2_1f:
s_mov_b64 exec, vcc
buffer_load_dwordx4 v[36:39], v7, s[84:87], s29 offen offset:1024 sc1
s_mov_b64 exec, -1
s_branch mega_kernel_rf_pc_2_1
mega_kernel_rf_pc_2_1:
s_waitcnt vmcnt(0)
v_cmp_eq_u32 vcc, -1, v36
s_cbranch_vccnz mega_kernel_rf_pc_2_1f
v_smfmac_f32_16x16x64_bf16 v[96:99], v[36:39], a[200:207], v6
v_smfmac_f32_16x16x64_bf16 v[100:103], v[36:39], a[232:239], v6
s_branch mega_kernel_rf_pc_d
mega_kernel_rf_pc_3_0f:
s_mov_b64 exec, vcc
buffer_load_dwordx4 v[32:35], v7, s[84:87], s29 offen offset:0 sc1
s_mov_b64 exec, -1
s_branch mega_kernel_rf_pc_3_1
mega_kernel_rf_pc_3_0:
s_waitcnt vmcnt(1)
v_cmp_eq_u32 vcc, -1, v32
s_cbranch_vccnz mega_kernel_rf_pc_3_0f
v_smfmac_f32_16x16x64_bf16 v[96:99], v[32:35], a[192:199], v6
v_smfmac_f32_16x16x64_bf16 v[100:103], v[32:35], a[224:231], v6
s_branch mega_kernel_rf_pc_2_1
mega_kernel_rf_pc_3_1f:
s_mov_b64 exec, vcc
buffer_load_dwordx4 v[36:39], v7, s[84:87], s29 offen offset:1024 sc1
s_mov_b64 exec, -1
s_branch mega_kernel_rf_pc_3_0
mega_kernel_rf_pc_3_1:
s_waitcnt vmcnt(1)
v_cmp_eq_u32 vcc, -1, v36
s_cbranch_vccnz mega_kernel_rf_pc_3_1f
v_smfmac_f32_16x16x64_bf16 v[96:99], v[36:39], a[200:207], v6
v_smfmac_f32_16x16x64_bf16 v[100:103], v[36:39], a[232:239], v6
s_branch mega_kernel_rf_pc_1_0
mega_kernel_rf_pc_4_2f:
s_mov_b64 exec, vcc
buffer_load_dwordx4 v[40:43], v7, s[84:87], s29 offen offset:2048 sc1
s_mov_b64 exec, -1
s_branch mega_kernel_rf_pc_4_2
mega_kernel_rf_pc_4_2:
s_waitcnt vmcnt(0)
v_cmp_eq_u32 vcc, -1, v40
s_cbranch_vccnz mega_kernel_rf_pc_4_2f
v_smfmac_f32_16x16x64_bf16 v[96:99], v[40:43], a[208:215], v6
v_smfmac_f32_16x16x64_bf16 v[100:103], v[40:43], a[240:247], v6
s_branch mega_kernel_rf_pc_d
mega_kernel_rf_pc_5_0f:
s_mov_b64 exec, vcc
buffer_load_dwordx4 v[32:35], v7, s[84:87], s29 offen offset:0 sc1
s_mov_b64 exec, -1
s_branch mega_kernel_rf_pc_5_2
mega_kernel_rf_pc_5_0:
s_waitcnt vmcnt(1)
v_cmp_eq_u32 vcc, -1, v32
s_cbranch_vccnz mega_kernel_rf_pc_5_0f
v_smfmac_f32_16x16x64_bf16 v[96:99], v[32:35], a[192:199], v6
v_smfmac_f32_16x16x64_bf16 v[100:103], v[32:35], a[224:231], v6
s_branch mega_kernel_rf_pc_4_2
mega_kernel_rf_pc_5_2f:
s_mov_b64 exec, vcc
buffer_load_dwordx4 v[40:43], v7, s[84:87], s29 offen offset:2048 sc1
s_mov_b64 exec, -1
s_branch mega_kernel_rf_pc_5_0
mega_kernel_rf_pc_5_2:
s_waitcnt vmcnt(1)
v_cmp_eq_u32 vcc, -1, v40
s_cbranch_vccnz mega_kernel_rf_pc_5_2f
v_smfmac_f32_16x16x64_bf16 v[96:99], v[40:43], a[208:215], v6
v_smfmac_f32_16x16x64_bf16 v[100:103], v[40:43], a[240:247], v6
s_branch mega_kernel_rf_pc_1_0
mega_kernel_rf_pc_6_1f:
s_mov_b64 exec, vcc
buffer_load_dwordx4 v[36:39], v7, s[84:87], s29 offen offset:1024 sc1
s_mov_b64 exec, -1
s_branch mega_kernel_rf_pc_6_2
mega_kernel_rf_pc_6_1:
s_waitcnt vmcnt(1)
v_cmp_eq_u32 vcc, -1, v36
s_cbranch_vccnz mega_kernel_rf_pc_6_1f
v_smfmac_f32_16x16x64_bf16 v[96:99], v[36:39], a[200:207], v6
v_smfmac_f32_16x16x64_bf16 v[100:103], v[36:39], a[232:239], v6
s_branch mega_kernel_rf_pc_4_2
mega_kernel_rf_pc_6_2f:
s_mov_b64 exec, vcc
buffer_load_dwordx4 v[40:43], v7, s[84:87], s29 offen offset:2048 sc1
s_mov_b64 exec, -1
s_branch mega_kernel_rf_pc_6_1
mega_kernel_rf_pc_6_2:
s_waitcnt vmcnt(1)
v_cmp_eq_u32 vcc, -1, v40
s_cbranch_vccnz mega_kernel_rf_pc_6_2f
v_smfmac_f32_16x16x64_bf16 v[96:99], v[40:43], a[208:215], v6
v_smfmac_f32_16x16x64_bf16 v[100:103], v[40:43], a[240:247], v6
s_branch mega_kernel_rf_pc_2_1
mega_kernel_rf_pc_7_0f:
s_mov_b64 exec, vcc
buffer_load_dwordx4 v[32:35], v7, s[84:87], s29 offen offset:0 sc1
s_mov_b64 exec, -1
s_branch mega_kernel_rf_pc_7_1
mega_kernel_rf_pc_7_0:
s_waitcnt vmcnt(2)
v_cmp_eq_u32 vcc, -1, v32
s_cbranch_vccnz mega_kernel_rf_pc_7_0f
v_smfmac_f32_16x16x64_bf16 v[96:99], v[32:35], a[192:199], v6
v_smfmac_f32_16x16x64_bf16 v[100:103], v[32:35], a[224:231], v6
s_branch mega_kernel_rf_pc_6_1
mega_kernel_rf_pc_7_1f:
s_mov_b64 exec, vcc
buffer_load_dwordx4 v[36:39], v7, s[84:87], s29 offen offset:1024 sc1
s_mov_b64 exec, -1
s_branch mega_kernel_rf_pc_7_2
mega_kernel_rf_pc_7_1:
s_waitcnt vmcnt(2)
v_cmp_eq_u32 vcc, -1, v36
s_cbranch_vccnz mega_kernel_rf_pc_7_1f
v_smfmac_f32_16x16x64_bf16 v[96:99], v[36:39], a[200:207], v6
v_smfmac_f32_16x16x64_bf16 v[100:103], v[36:39], a[232:239], v6
s_branch mega_kernel_rf_pc_5_2
mega_kernel_rf_pc_7_2f:
s_mov_b64 exec, vcc
buffer_load_dwordx4 v[40:43], v7, s[84:87], s29 offen offset:2048 sc1
s_mov_b64 exec, -1
s_branch mega_kernel_rf_pc_7_0
mega_kernel_rf_pc_7_2:
s_waitcnt vmcnt(2)
v_cmp_eq_u32 vcc, -1, v40
s_cbranch_vccnz mega_kernel_rf_pc_7_2f
v_smfmac_f32_16x16x64_bf16 v[96:99], v[40:43], a[208:215], v6
v_smfmac_f32_16x16x64_bf16 v[100:103], v[40:43], a[240:247], v6
s_branch mega_kernel_rf_pc_3_0
mega_kernel_rf_pc_8_3f:
s_mov_b64 exec, vcc
buffer_load_dwordx4 v[44:47], v7, s[84:87], s29 offen offset:3072 sc1
s_mov_b64 exec, -1
s_branch mega_kernel_rf_pc_8_3
mega_kernel_rf_pc_9_0f:
s_mov_b64 exec, vcc
buffer_load_dwordx4 v[32:35], v7, s[84:87], s29 offen offset:0 sc1
s_mov_b64 exec, -1
s_branch mega_kernel_rf_pc_9_3
mega_kernel_rf_pc_9_0:
s_waitcnt vmcnt(1)
v_cmp_eq_u32 vcc, -1, v32
s_cbranch_vccnz mega_kernel_rf_pc_9_0f
v_smfmac_f32_16x16x64_bf16 v[96:99], v[32:35], a[192:199], v6
v_smfmac_f32_16x16x64_bf16 v[100:103], v[32:35], a[224:231], v6
s_branch mega_kernel_rf_pc_8_3
mega_kernel_rf_pc_9_3f:
s_mov_b64 exec, vcc
buffer_load_dwordx4 v[44:47], v7, s[84:87], s29 offen offset:3072 sc1
s_mov_b64 exec, -1
s_branch mega_kernel_rf_pc_9_0
mega_kernel_rf_pc_9_3:
s_waitcnt vmcnt(1)
v_cmp_eq_u32 vcc, -1, v44
s_cbranch_vccnz mega_kernel_rf_pc_9_3f
v_smfmac_f32_16x16x64_bf16 v[96:99], v[44:47], a[216:223], v6
v_smfmac_f32_16x16x64_bf16 v[100:103], v[44:47], a[248:255], v6
s_branch mega_kernel_rf_pc_1_0
mega_kernel_rf_pc_10_1f:
s_mov_b64 exec, vcc
buffer_load_dwordx4 v[36:39], v7, s[84:87], s29 offen offset:1024 sc1
s_mov_b64 exec, -1
s_branch mega_kernel_rf_pc_10_3
mega_kernel_rf_pc_10_1:
s_waitcnt vmcnt(1)
v_cmp_eq_u32 vcc, -1, v36
s_cbranch_vccnz mega_kernel_rf_pc_10_1f
v_smfmac_f32_16x16x64_bf16 v[96:99], v[36:39], a[200:207], v6
v_smfmac_f32_16x16x64_bf16 v[100:103], v[36:39], a[232:239], v6
s_branch mega_kernel_rf_pc_8_3
mega_kernel_rf_pc_10_3f:
s_mov_b64 exec, vcc
buffer_load_dwordx4 v[44:47], v7, s[84:87], s29 offen offset:3072 sc1
s_mov_b64 exec, -1
s_branch mega_kernel_rf_pc_10_1
mega_kernel_rf_pc_10_3:
s_waitcnt vmcnt(1)
v_cmp_eq_u32 vcc, -1, v44
s_cbranch_vccnz mega_kernel_rf_pc_10_3f
v_smfmac_f32_16x16x64_bf16 v[96:99], v[44:47], a[216:223], v6
v_smfmac_f32_16x16x64_bf16 v[100:103], v[44:47], a[248:255], v6
s_branch mega_kernel_rf_pc_2_1
mega_kernel_rf_pc_11_0f:
s_mov_b64 exec, vcc
buffer_load_dwordx4 v[32:35], v7, s[84:87], s29 offen offset:0 sc1
s_mov_b64 exec, -1
s_branch mega_kernel_rf_pc_11_1
mega_kernel_rf_pc_11_0:
s_waitcnt vmcnt(2)
v_cmp_eq_u32 vcc, -1, v32
s_cbranch_vccnz mega_kernel_rf_pc_11_0f
v_smfmac_f32_16x16x64_bf16 v[96:99], v[32:35], a[192:199], v6
v_smfmac_f32_16x16x64_bf16 v[100:103], v[32:35], a[224:231], v6
s_branch mega_kernel_rf_pc_10_1
mega_kernel_rf_pc_11_1f:
s_mov_b64 exec, vcc
buffer_load_dwordx4 v[36:39], v7, s[84:87], s29 offen offset:1024 sc1
s_mov_b64 exec, -1
s_branch mega_kernel_rf_pc_11_3
mega_kernel_rf_pc_11_1:
s_waitcnt vmcnt(2)
v_cmp_eq_u32 vcc, -1, v36
s_cbranch_vccnz mega_kernel_rf_pc_11_1f
v_smfmac_f32_16x16x64_bf16 v[96:99], v[36:39], a[200:207], v6
v_smfmac_f32_16x16x64_bf16 v[100:103], v[36:39], a[232:239], v6
s_branch mega_kernel_rf_pc_9_3
mega_kernel_rf_pc_11_3f:
s_mov_b64 exec, vcc
buffer_load_dwordx4 v[44:47], v7, s[84:87], s29 offen offset:3072 sc1
s_mov_b64 exec, -1
s_branch mega_kernel_rf_pc_11_0
mega_kernel_rf_pc_11_3:
s_waitcnt vmcnt(2)
v_cmp_eq_u32 vcc, -1, v44
s_cbranch_vccnz mega_kernel_rf_pc_11_3f
v_smfmac_f32_16x16x64_bf16 v[96:99], v[44:47], a[216:223], v6
v_smfmac_f32_16x16x64_bf16 v[100:103], v[44:47], a[248:255], v6
s_branch mega_kernel_rf_pc_3_0
mega_kernel_rf_pc_12_2f:
s_mov_b64 exec, vcc
buffer_load_dwordx4 v[40:43], v7, s[84:87], s29 offen offset:2048 sc1
s_mov_b64 exec, -1
s_branch mega_kernel_rf_pc_12_3
mega_kernel_rf_pc_12_3f:
s_mov_b64 exec, vcc
buffer_load_dwordx4 v[44:47], v7, s[84:87], s29 offen offset:3072 sc1
s_mov_b64 exec, -1
s_branch mega_kernel_rf_pc_12_2
mega_kernel_rf_pc_12_3:
s_waitcnt vmcnt(1)
v_cmp_eq_u32 vcc, -1, v44
s_cbranch_vccnz mega_kernel_rf_pc_12_3f
v_smfmac_f32_16x16x64_bf16 v[96:99], v[44:47], a[216:223], v6
v_smfmac_f32_16x16x64_bf16 v[100:103], v[44:47], a[248:255], v6
s_branch mega_kernel_rf_pc_4_2
mega_kernel_rf_pc_13_0f:
s_mov_b64 exec, vcc
buffer_load_dwordx4 v[32:35], v7, s[84:87], s29 offen offset:0 sc1
s_mov_b64 exec, -1
s_branch mega_kernel_rf_pc_13_2
mega_kernel_rf_pc_13_0:
s_waitcnt vmcnt(2)
v_cmp_eq_u32 vcc, -1, v32
s_cbranch_vccnz mega_kernel_rf_pc_13_0f
v_smfmac_f32_16x16x64_bf16 v[96:99], v[32:35], a[192:199], v6
v_smfmac_f32_16x16x64_bf16 v[100:103], v[32:35], a[224:231], v6
s_branch mega_kernel_rf_pc_12_2
mega_kernel_rf_pc_13_2f:
s_mov_b64 exec, vcc
buffer_load_dwordx4 v[40:43], v7, s[84:87], s29 offen offset:2048 sc1
s_mov_b64 exec, -1
s_branch mega_kernel_rf_pc_13_3
mega_kernel_rf_pc_13_2:
s_waitcnt vmcnt(2)
v_cmp_eq_u32 vcc, -1, v40
s_cbranch_vccnz mega_kernel_rf_pc_13_2f
v_smfmac_f32_16x16x64_bf16 v[96:99], v[40:43], a[208:215], v6
v_smfmac_f32_16x16x64_bf16 v[100:103], v[40:43], a[240:247], v6
s_branch mega_kernel_rf_pc_9_3
mega_kernel_rf_pc_13_3f:
s_mov_b64 exec, vcc
buffer_load_dwordx4 v[44:47], v7, s[84:87], s29 offen offset:3072 sc1
s_mov_b64 exec, -1
s_branch mega_kernel_rf_pc_13_0
mega_kernel_rf_pc_13_3:
s_waitcnt vmcnt(2)
v_cmp_eq_u32 vcc, -1, v44
s_cbranch_vccnz mega_kernel_rf_pc_13_3f
v_smfmac_f32_16x16x64_bf16 v[96:99], v[44:47], a[216:223], v6
v_smfmac_f32_16x16x64_bf16 v[100:103], v[44:47], a[248:255], v6
s_branch mega_kernel_rf_pc_5_0
mega_kernel_rf_pc_14_1f:
s_mov_b64 exec, vcc
buffer_load_dwordx4 v[36:39], v7, s[84:87], s29 offen offset:1024 sc1
s_mov_b64 exec, -1
s_branch mega_kernel_rf_pc_14_2
mega_kernel_rf_pc_14_2f:
s_mov_b64 exec, vcc
buffer_load_dwordx4 v[40:43], v7, s[84:87], s29 offen offset:2048 sc1
s_mov_b64 exec, -1
s_branch mega_kernel_rf_pc_14_3
mega_kernel_rf_pc_14_2:
s_waitcnt vmcnt(2)
v_cmp_eq_u32 vcc, -1, v40
s_cbranch_vccnz mega_kernel_rf_pc_14_2f
v_smfmac_f32_16x16x64_bf16 v[96:99], v[40:43], a[208:215], v6
v_smfmac_f32_16x16x64_bf16 v[100:103], v[40:43], a[240:247], v6
s_branch mega_kernel_rf_pc_10_3
mega_kernel_rf_pc_14_3f:
s_mov_b64 exec, vcc
buffer_load_dwordx4 v[44:47], v7, s[84:87], s29 offen offset:3072 sc1
s_mov_b64 exec, -1
s_branch mega_kernel_rf_pc_14_1
mega_kernel_rf_pc_14_3:
s_waitcnt vmcnt(2)
v_cmp_eq_u32 vcc, -1, v44
s_cbranch_vccnz mega_kernel_rf_pc_14_3f
v_smfmac_f32_16x16x64_bf16 v[96:99], v[44:47], a[216:223], v6
v_smfmac_f32_16x16x64_bf16 v[100:103], v[44:47], a[248:255], v6
s_branch mega_kernel_rf_pc_6_1
mega_kernel_rf_pc_15_0f:
s_mov_b64 exec, vcc
buffer_load_dwordx4 v[32:35], v7, s[84:87], s29 offen offset:0 sc1
s_mov_b64 exec, -1
s_branch mega_kernel_rf_pc_15_1
mega_kernel_rf_pc_15_1f:
s_mov_b64 exec, vcc
buffer_load_dwordx4 v[36:39], v7, s[84:87], s29 offen offset:1024 sc1
s_mov_b64 exec, -1
s_branch mega_kernel_rf_pc_15_2
mega_kernel_rf_pc_15_1:
s_waitcnt vmcnt(3)
v_cmp_eq_u32 vcc, -1, v36
s_cbranch_vccnz mega_kernel_rf_pc_15_1f
v_smfmac_f32_16x16x64_bf16 v[96:99], v[36:39], a[200:207], v6
v_smfmac_f32_16x16x64_bf16 v[100:103], v[36:39], a[232:239], v6
s_branch mega_kernel_rf_pc_13_2
mega_kernel_rf_pc_15_2f:
s_mov_b64 exec, vcc
buffer_load_dwordx4 v[40:43], v7, s[84:87], s29 offen offset:2048 sc1
s_mov_b64 exec, -1
s_branch mega_kernel_rf_pc_15_3
mega_kernel_rf_pc_15_2:
s_waitcnt vmcnt(3)
v_cmp_eq_u32 vcc, -1, v40
s_cbranch_vccnz mega_kernel_rf_pc_15_2f
v_smfmac_f32_16x16x64_bf16 v[96:99], v[40:43], a[208:215], v6
v_smfmac_f32_16x16x64_bf16 v[100:103], v[40:43], a[240:247], v6
s_branch mega_kernel_rf_pc_11_3
mega_kernel_rf_pc_15_3f:
s_mov_b64 exec, vcc
buffer_load_dwordx4 v[44:47], v7, s[84:87], s29 offen offset:3072 sc1
s_mov_b64 exec, -1
s_branch mega_kernel_rf_pc_15_0
mega_kernel_rf_pc_15_3:
s_waitcnt vmcnt(3)
v_cmp_eq_u32 vcc, -1, v44
s_cbranch_vccnz mega_kernel_rf_pc_15_3f
v_smfmac_f32_16x16x64_bf16 v[96:99], v[44:47], a[216:223], v6
v_smfmac_f32_16x16x64_bf16 v[100:103], v[44:47], a[248:255], v6
s_branch mega_kernel_rf_pc_7_0
mega_kernel_rf_w0last:
s_nop 7
v_permlane32_swap_b32 v112, v116
v_permlane32_swap_b32 v113, v117
v_permlane32_swap_b32 v114, v118
v_permlane32_swap_b32 v115, v119
v_pk_add_f32 v[112:113], v[112:113], v[116:117]
v_pk_add_f32 v[114:115], v[114:115], v[118:119]
ds_write_b128 v20, v[112:115]
s_waitcnt lgkmcnt(0)
s_barrier
s_branch mega_kernel_rf_end
mega_kernel_rf_side:
s_cmp_eq_u32 s24, 3
s_cbranch_scc1 mega_kernel_rf_sd3
s_cmp_eq_u32 s24, 2
s_cbranch_scc0 mega_kernel_rf_sd4
s_mov_b64 exec, s[40:41]
buffer_store_dwordx4 v[28:31], v11, s[84:87], s34 offen
s_mov_b64 exec, -1
buffer_store_dwordx2 v[28:29], v9, s[84:87], s34 offen
s_mul_i32 s28, s31, 2048
s_add_u32 s28, s28, s34
s_add_u32 s28, s28, 49152
buffer_store_dwordx4 v[28:31], v17, s[84:87], s28 offen
buffer_store_dwordx4 v[28:31], v10, s[84:87], s28 offen
s_branch mega_kernel_rf_sd4
mega_kernel_rf_sd3:
s_mov_b32 s36, 0
s_add_u32 s76, s27, 1
s_cmp_lt_u32 s76, 63
s_cbranch_scc0 mega_kernel_rf_sd4
s_cmp_ge_u32 s76, 0
s_cbranch_scc0 mega_kernel_rf_sd4
s_cmp_gt_i32 s46, s76
s_cselect_b32 s36, 0, 1
s_cbranch_scc0 mega_kernel_rf_sd4
s_add_u32 s77, s76, s82
s_bfe_u32 s28, s77, 0x40002
s_lshl_b32 s28, s28, 14
s_and_b32 s77, s77, 3
s_lshl_b32 s77, s77, 11
s_add_u32 s28, s28, s77
s_add_u32 m0, s45, 0
s_nop 0
buffer_load_dwordx4 v240, s[84:87], s28 offen offset:0 sc1 lds
s_add_u32 m0, s45, 0
s_nop 0
buffer_load_dwordx4 v240, s[84:87], s28 offen offset:1024 sc1 lds
s_add_u32 m0, s45, 2048
s_nop 0
buffer_load_dwordx4 v241, s[84:87], s28 offen offset:0 sc1 lds
s_add_u32 m0, s45, 2048
s_nop 0
buffer_load_dwordx4 v241, s[84:87], s28 offen offset:1024 sc1 lds
s_add_u32 s45, s45, 4096
s_cmp_eq_u32 s45, 30720
s_cselect_b32 s45, 18432, s45
mega_kernel_rf_sd4:
v_smfmac_f32_16x16x64_bf16 v[112:115], v[40:43], a[144:151], v6
v_smfmac_f32_16x16x64_bf16 v[116:119], v[40:43], a[176:183], v6
v_smfmac_f32_16x16x64_bf16 v[112:115], v[44:47], a[152:159], v6
v_smfmac_f32_16x16x64_bf16 v[116:119], v[44:47], a[184:191], v6
s_nop 7
v_permlane32_swap_b32 v112, v116
v_permlane32_swap_b32 v113, v117
v_permlane32_swap_b32 v114, v118
v_permlane32_swap_b32 v115, v119
v_pk_add_f32 v[112:113], v[112:113], v[116:117]
v_pk_add_f32 v[114:115], v[114:115], v[118:119]
ds_write_b128 v20, v[112:115]
v_mov_b32 v96, 0
v_mov_b32 v97, 0
v_mov_b32 v98, 0
v_mov_b32 v99, 0
v_mov_b32 v100, 0
v_mov_b32 v101, 0
v_mov_b32 v102, 0
v_mov_b32 v103, 0
s_cmp_eq_u32 s24, 1
s_cbranch_scc0 mega_kernel_rf_s1
s_waitcnt lgkmcnt(0)
ds_read_b128 v[120:123], v16 offset:0
ds_read_b128 v[124:127], v16 offset:16
ds_read_b128 v[128:131], v16 offset:2304
ds_read_b128 v[132:135], v16 offset:2320
ds_read_b128 v[136:139], v16 offset:4608
ds_read_b128 v[140:143], v16 offset:4624
ds_read_b128 v[144:147], v16 offset:6912
ds_read_b128 v[148:151], v16 offset:6928
s_waitcnt lgkmcnt(4)
v_pk_add_f32 v[120:121], v[120:121], v[128:129]
v_pk_add_f32 v[122:123], v[122:123], v[130:131]
v_pk_add_f32 v[124:125], v[124:125], v[132:133]
v_pk_add_f32 v[126:127], v[126:127], v[134:135]
s_waitcnt lgkmcnt(0)
v_pk_add_f32 v[136:137], v[136:137], v[144:145]
v_pk_add_f32 v[138:139], v[138:139], v[146:147]
v_pk_add_f32 v[140:141], v[140:141], v[148:149]
v_pk_add_f32 v[142:143], v[142:143], v[150:151]
v_pk_add_f32 v[120:121], v[120:121], v[136:137]
v_pk_add_f32 v[122:123], v[122:123], v[138:139]
v_pk_add_f32 v[124:125], v[124:125], v[140:141]
v_pk_add_f32 v[126:127], v[126:127], v[142:143]
v_cvt_pk_bf16_f32 v244, v120, v121
v_cvt_pk_bf16_f32 v245, v122, v123
v_cvt_pk_bf16_f32 v246, v124, v125
v_cvt_pk_bf16_f32 v247, v126, v127
mega_kernel_rf_s1:
v_add_u32 v5, 9216, v17
s_waitcnt lgkmcnt(0)
s_barrier
s_cmp_eq_u32 s24, 2
s_cbranch_scc1 mega_kernel_rf_s2
s_cmp_eq_u32 s24, 3
s_cbranch_scc0 mega_kernel_rf_s3
s_add_u32 s76, s27, 2
s_cmp_lt_u32 s76, 63
s_cbranch_scc0 mega_kernel_rf_s3
s_cmp_gt_i32 s46, s76
s_cbranch_scc0 mega_kernel_rf_s3
s_add_u32 s77, s76, s82
s_bfe_u32 s28, s77, 0x40002
s_lshl_b32 s28, s28, 14
s_and_b32 s77, s77, 3
s_lshl_b32 s77, s77, 11
s_add_u32 s28, s28, s77
s_add_u32 s28, s28, s83
s_buffer_load_dword s78, s[84:87], s28 offset:0
s_buffer_load_dword s78, s[84:87], s28 offset:128
s_buffer_load_dword s78, s[84:87], s28 offset:256
s_buffer_load_dword s78, s[84:87], s28 offset:384
s_buffer_load_dword s78, s[84:87], s28 offset:512
s_buffer_load_dword s78, s[84:87], s28 offset:640
s_buffer_load_dword s78, s[84:87], s28 offset:768
s_buffer_load_dword s78, s[84:87], s28 offset:896
s_buffer_load_dword s78, s[84:87], s28 offset:1024
s_buffer_load_dword s78, s[84:87], s28 offset:1152
s_buffer_load_dword s78, s[84:87], s28 offset:1280
s_buffer_load_dword s78, s[84:87], s28 offset:1408
s_buffer_load_dword s78, s[84:87], s28 offset:1536
s_buffer_load_dword s78, s[84:87], s28 offset:1664
s_buffer_load_dword s78, s[84:87], s28 offset:1792
s_buffer_load_dword s78, s[84:87], s28 offset:1920
s_mov_b32 s88, s76
s_branch mega_kernel_rf_s3
mega_kernel_rf_s2:
ds_read_b128 v[120:123], v5 offset:0
ds_read_b128 v[124:127], v5 offset:1024
ds_read_b128 v[128:131], v5 offset:2048
ds_read_b128 v[132:135], v5 offset:3072
v_lshrrev_b32 v5, 1, v17
s_waitcnt lgkmcnt(2)
v_pk_add_f32 v[120:121], v[120:121], v[124:125]
v_pk_add_f32 v[122:123], v[122:123], v[126:127]
s_waitcnt lgkmcnt(0)
v_pk_add_f32 v[128:129], v[128:129], v[132:133]
v_pk_add_f32 v[130:131], v[130:131], v[134:135]
v_pk_add_f32 v[120:121], v[120:121], v[128:129]
v_pk_add_f32 v[122:123], v[122:123], v[130:131]
v_cvt_pk_bf16_f32 v244, v120, v121
v_cvt_pk_bf16_f32 v245, v122, v123
ds_write_b64 v5, v[244:245] offset:17920
s_waitcnt lgkmcnt(0) vmcnt(0)
mega_kernel_rf_s3:
s_cmp_eq_u32 s27, 63
s_cbranch_scc1 mega_kernel_rf_slast
s_add_u32 s29, s33, 24576
s_barrier
s_cmp_eq_u32 s24, 3
s_cbranch_scc1 mega_kernel_rf_y3
s_add_u32 s77, s27, s82
s_bfe_u32 s28, s77, 0x30003
s_lshl_b32 s28, s28, 14
s_and_b32 s77, s77, 7
s_lshl_b32 s77, s77, 10
s_add_u32 s28, s28, s77
s_add_u32 s28, s28, s79
s_cmp_eq_u32 s24, 2
s_cbranch_scc1 mega_kernel_rf_kv2a
s_mov_b64 exec, s[48:49]
buffer_store_dwordx4 v[244:247], v22, s[84:87], s28 offen sc1
s_mov_b64 exec, -1
s_branch mega_kernel_rf_kvda
mega_kernel_rf_kv2a:
v_lshlrev_b32 v4, 3, v1
buffer_store_dwordx2 v[244:245], v4, s[84:87], s28 offen offset:512 sc1
mega_kernel_rf_kvda:
s_branch mega_kernel_rf_y4
mega_kernel_rf_y3:
s_add_u32 s76, s27, 2
s_cmp_lt_u32 s76, 63
s_cbranch_scc0 mega_kernel_rf_y4
mega_kernel_rf_y4:
s_branch mega_kernel_rf_b3
mega_kernel_rf_first:
buffer_load_dwordx4 v[32:35], v8, s[20:23], 0 offen offset:0
buffer_load_dwordx4 v[36:39], v8, s[20:23], 0 offen offset:128
buffer_load_dwordx4 v[40:43], v8, s[20:23], 0 offen offset:256
buffer_load_dwordx4 v[44:47], v8, s[20:23], 0 offen offset:384
v_add_u32 v5, s44, v17
ds_read_b128 v[156:159], v5 offset:0
ds_read_b128 v[160:163], v5 offset:1024
ds_read_b128 v[164:167], v5 offset:2048
ds_read_b128 v[168:171], v5 offset:3072
s_waitcnt vmcnt(0)
v_smfmac_f32_16x16x64_bf16 v[96:99], v[32:35], a[0:7], v6
v_smfmac_f32_16x16x64_bf16 v[100:103], v[32:35], a[32:39], v6
v_smfmac_f32_16x16x64_bf16 v[104:107], v[32:35], a[64:71], v6
v_smfmac_f32_16x16x64_bf16 v[108:111], v[32:35], a[96:103], v6
v_smfmac_f32_16x16x64_bf16 v[96:99], v[36:39], a[8:15], v6
v_smfmac_f32_16x16x64_bf16 v[100:103], v[36:39], a[40:47], v6
v_smfmac_f32_16x16x64_bf16 v[104:107], v[36:39], a[72:79], v6
v_smfmac_f32_16x16x64_bf16 v[108:111], v[36:39], a[104:111], v6
v_smfmac_f32_16x16x64_bf16 v[96:99], v[40:43], a[16:23], v6
v_smfmac_f32_16x16x64_bf16 v[100:103], v[40:43], a[48:55], v6
v_smfmac_f32_16x16x64_bf16 v[104:107], v[40:43], a[80:87], v6
v_smfmac_f32_16x16x64_bf16 v[108:111], v[40:43], a[112:119], v6
v_smfmac_f32_16x16x64_bf16 v[96:99], v[44:47], a[24:31], v6
v_smfmac_f32_16x16x64_bf16 v[100:103], v[44:47], a[56:63], v6
v_smfmac_f32_16x16x64_bf16 v[104:107], v[44:47], a[88:95], v6
v_smfmac_f32_16x16x64_bf16 v[108:111], v[44:47], a[120:127], v6
s_nop 1
s_branch mega_kernel_rf_adone
mega_kernel_rf_slast:
s_cmp_eq_u32 s24, 3
s_cbranch_scc1 mega_kernel_rf_end
s_add_u32 s77, s27, s82
s_bfe_u32 s28, s77, 0x30003
s_lshl_b32 s28, s28, 14
s_and_b32 s77, s77, 7
s_lshl_b32 s77, s77, 10
s_add_u32 s28, s28, s77
s_add_u32 s28, s28, s79
s_cmp_eq_u32 s24, 2
s_cbranch_scc1 mega_kernel_rf_kv2b
s_mov_b64 exec, s[48:49]
buffer_store_dwordx4 v[244:247], v22, s[84:87], s28 offen sc1
s_mov_b64 exec, -1
s_branch mega_kernel_rf_kvdb
mega_kernel_rf_kv2b:
v_lshlrev_b32 v4, 3, v1
buffer_store_dwordx2 v[244:245], v4, s[84:87], s28 offen offset:512 sc1
mega_kernel_rf_kvdb:
s_waitcnt vmcnt(0)
s_barrier
s_mov_b32 s76, 64
s_cmp_eq_u32 s24, 1
s_cbranch_scc0 mega_kernel_rf_end
v_mov_b32 v5, s76
s_mov_b64 exec, 1
buffer_store_dword v5, v228, s[84:87], s81 offen sc1
s_mov_b64 exec, -1
mega_kernel_rf_end:
s_endpgm
mega_kernel_recs:
s_load_dwordx2 s[20:21], s[0:1], 8
s_load_dwordx2 s[16:17], s[0:1], 40
s_load_dwordx2 s[4:5], s[0:1], 16
s_load_dwordx2 s[8:9], s[0:1], 24
s_load_dwordx2 s[12:13], s[0:1], 32
v_lshrrev_b32 v4, 6, v0
v_and_b32 v1, 63, v0
v_readfirstlane_b32 s24, v4
v_lshrrev_b32 v2, 4, v1
v_and_b32 v3, 15, v1
v_lshlrev_b32 v17, 4, v1
s_lshr_b32 s28, s31, 2
s_lshl_b32 s25, s30, 3
s_add_u32 s25, s25, s28
s_and_b32 s26, s31, 3
s_waitcnt lgkmcnt(0)
s_mov_b32 s22, 16384
s_mov_b32 s23, 0x00020000
s_mov_b32 s18, 8388608
s_mov_b32 s19, 0x00020000
s_mov_b32 s6, 8388608
s_mov_b32 s7, 0x00020000
s_mov_b32 s10, 8388608
s_mov_b32 s11, 0x00020000
s_mov_b32 s14, 8388608
s_mov_b32 s15, 0x00020000
s_lshl_b32 s28, s25, 8
s_lshr_b32 s29, s26, 0
s_lshl_b32 s29, s29, 6
s_add_u32 s28, s28, s29
s_lshl_b32 s29, s24, 21
s_add_u32 s28, s28, s29
v_lshrrev_b32 v4, 2, v1
v_and_b32 v5, 3, v1
v_lshlrev_b32 v40, 13, v4
v_lshl_add_u32 v40, v5, 4, v40
v_add_u32 v40, s28, v40
s_lshl_b32 s28, s30, 21
s_lshl_b32 s29, s24, 19
s_add_u32 s28, s28, s29
s_lshr_b32 s29, s31, 0
s_lshl_b32 s29, s29, 6
s_add_u32 s28, s28, s29
v_lshlrev_b32 v41, 11, v4
v_lshl_add_u32 v41, v5, 4, v41
v_add_u32 v41, s28, v41
s_lshl_b32 s47, s24, 15
s_add_u32 s47, s47, 32768
s_lshl_b32 s28, s31, 18
s_lshl_b32 s29, s24, 16
s_add_u32 s28, s28, s29
s_lshl_b32 s29, s30, 11
s_add_u32 s28, s28, s29
v_lshlrev_b32 v48, 13, v2
v_lshl_add_u32 v48, v3, 7, v48
v_add_u32 v48, s28, v48
s_lshl_b32 s28, s30, 21
s_lshl_b32 s29, s31, 16
s_add_u32 s28, s28, s29
s_lshl_b32 s29, s24, 14
s_add_u32 s28, s28, s29
v_lshlrev_b32 v49, 7, v1
v_add_u32 v49, s28, v49
s_and_b32 s76, s31, 1
s_mul_i32 s76, s76, 8
s_and_b32 s28, s31, 15
s_lshl_b32 s28, s28, 4
s_lshl_b32 s29, s24, 8
s_add_u32 s28, s28, s29
v_add_u32 v53, s28, v3
s_lshr_b32 s28, s31, 4
s_lshl_b32 s28, s28, 10
s_add_u32 s28, s28, 384
v_mov_b32 v54, s28
v_mov_b32 v55, 1920
v_cmp_gt_u32 vcc, 32, v1
s_nop 1
v_cndmask_b32 v54, v55, v54, vcc
s_lshl_b32 s29, s30, 11
v_lshl_add_u32 v51, v53, 13, v54
v_add_u32 v51, s29, v51
s_lshl_b32 s29, s30, 21
v_lshl_add_u32 v52, v53, 11, v54
v_add_u32 v52, s29, v52
buffer_load_dword v50, v51, s[8:11], 0 offen
s_xor_b32 s29, s76, 0
s_lshl_b32 s28, s29, 10
s_add_u32 s28, s28, s47
s_add_u32 m0, s28, 0
s_lshl_b32 s29, s29, 17
buffer_load_dwordx4 v40, s[8:11], s29 offen lds
s_xor_b32 s29, s76, 1
s_lshl_b32 s28, s29, 10
s_add_u32 s28, s28, s47
s_add_u32 m0, s28, 0
s_lshl_b32 s29, s29, 17
buffer_load_dwordx4 v40, s[8:11], s29 offen lds
s_xor_b32 s29, s76, 2
s_lshl_b32 s28, s29, 10
s_add_u32 s28, s28, s47
s_add_u32 m0, s28, 0
s_lshl_b32 s29, s29, 17
buffer_load_dwordx4 v40, s[8:11], s29 offen lds
s_xor_b32 s29, s76, 3
s_lshl_b32 s28, s29, 10
s_add_u32 s28, s28, s47
s_add_u32 m0, s28, 0
s_lshl_b32 s29, s29, 17
buffer_load_dwordx4 v40, s[8:11], s29 offen lds
s_xor_b32 s29, s76, 4
s_lshl_b32 s28, s29, 10
s_add_u32 s28, s28, s47
s_add_u32 m0, s28, 0
s_lshl_b32 s29, s29, 17
buffer_load_dwordx4 v40, s[8:11], s29 offen lds
s_xor_b32 s29, s76, 5
s_lshl_b32 s28, s29, 10
s_add_u32 s28, s28, s47
s_add_u32 m0, s28, 0
s_lshl_b32 s29, s29, 17
buffer_load_dwordx4 v40, s[8:11], s29 offen lds
s_xor_b32 s29, s76, 6
s_lshl_b32 s28, s29, 10
s_add_u32 s28, s28, s47
s_add_u32 m0, s28, 0
s_lshl_b32 s29, s29, 17
buffer_load_dwordx4 v40, s[8:11], s29 offen lds
s_xor_b32 s29, s76, 7
s_lshl_b32 s28, s29, 10
s_add_u32 s28, s28, s47
s_add_u32 m0, s28, 0
s_lshl_b32 s29, s29, 17
buffer_load_dwordx4 v40, s[8:11], s29 offen lds
s_xor_b32 s29, s76, 8
s_lshl_b32 s28, s29, 10
s_add_u32 s28, s28, s47
s_add_u32 m0, s28, 0
s_lshl_b32 s29, s29, 17
buffer_load_dwordx4 v40, s[8:11], s29 offen lds
s_xor_b32 s29, s76, 9
s_lshl_b32 s28, s29, 10
s_add_u32 s28, s28, s47
s_add_u32 m0, s28, 0
s_lshl_b32 s29, s29, 17
buffer_load_dwordx4 v40, s[8:11], s29 offen lds
s_xor_b32 s29, s76, 10
s_lshl_b32 s28, s29, 10
s_add_u32 s28, s28, s47
s_add_u32 m0, s28, 0
s_lshl_b32 s29, s29, 17
buffer_load_dwordx4 v40, s[8:11], s29 offen lds
s_xor_b32 s29, s76, 11
s_lshl_b32 s28, s29, 10
s_add_u32 s28, s28, s47
s_add_u32 m0, s28, 0
s_lshl_b32 s29, s29, 17
buffer_load_dwordx4 v40, s[8:11], s29 offen lds
s_xor_b32 s29, s76, 12
s_lshl_b32 s28, s29, 10
s_add_u32 s28, s28, s47
s_add_u32 m0, s28, 0
s_lshl_b32 s29, s29, 17
buffer_load_dwordx4 v40, s[8:11], s29 offen lds
s_xor_b32 s29, s76, 13
s_lshl_b32 s28, s29, 10
s_add_u32 s28, s28, s47
s_add_u32 m0, s28, 0
s_lshl_b32 s29, s29, 17
buffer_load_dwordx4 v40, s[8:11], s29 offen lds
s_xor_b32 s29, s76, 14
s_lshl_b32 s28, s29, 10
s_add_u32 s28, s28, s47
s_add_u32 m0, s28, 0
s_lshl_b32 s29, s29, 17
buffer_load_dwordx4 v40, s[8:11], s29 offen lds
s_xor_b32 s29, s76, 15
s_lshl_b32 s28, s29, 10
s_add_u32 s28, s28, s47
s_add_u32 m0, s28, 0
s_lshl_b32 s29, s29, 17
buffer_load_dwordx4 v40, s[8:11], s29 offen lds
buffer_load_dword v50, v51, s[12:15], 0 offen
s_xor_b32 s29, s76, 0
s_lshl_b32 s28, s29, 10
s_add_u32 s28, s28, s47
s_add_u32 m0, s28, 16384
s_lshl_b32 s29, s29, 17
buffer_load_dwordx4 v40, s[12:15], s29 offen lds
s_xor_b32 s29, s76, 1
s_lshl_b32 s28, s29, 10
s_add_u32 s28, s28, s47
s_add_u32 m0, s28, 16384
s_lshl_b32 s29, s29, 17
buffer_load_dwordx4 v40, s[12:15], s29 offen lds
s_xor_b32 s29, s76, 2
s_lshl_b32 s28, s29, 10
s_add_u32 s28, s28, s47
s_add_u32 m0, s28, 16384
s_lshl_b32 s29, s29, 17
buffer_load_dwordx4 v40, s[12:15], s29 offen lds
s_xor_b32 s29, s76, 3
s_lshl_b32 s28, s29, 10
s_add_u32 s28, s28, s47
s_add_u32 m0, s28, 16384
s_lshl_b32 s29, s29, 17
buffer_load_dwordx4 v40, s[12:15], s29 offen lds
s_xor_b32 s29, s76, 4
s_lshl_b32 s28, s29, 10
s_add_u32 s28, s28, s47
s_add_u32 m0, s28, 16384
s_lshl_b32 s29, s29, 17
buffer_load_dwordx4 v40, s[12:15], s29 offen lds
s_xor_b32 s29, s76, 5
s_lshl_b32 s28, s29, 10
s_add_u32 s28, s28, s47
s_add_u32 m0, s28, 16384
s_lshl_b32 s29, s29, 17
buffer_load_dwordx4 v40, s[12:15], s29 offen lds
s_xor_b32 s29, s76, 6
s_lshl_b32 s28, s29, 10
s_add_u32 s28, s28, s47
s_add_u32 m0, s28, 16384
s_lshl_b32 s29, s29, 17
buffer_load_dwordx4 v40, s[12:15], s29 offen lds
s_xor_b32 s29, s76, 7
s_lshl_b32 s28, s29, 10
s_add_u32 s28, s28, s47
s_add_u32 m0, s28, 16384
s_lshl_b32 s29, s29, 17
buffer_load_dwordx4 v40, s[12:15], s29 offen lds
s_xor_b32 s29, s76, 8
s_lshl_b32 s28, s29, 10
s_add_u32 s28, s28, s47
s_add_u32 m0, s28, 16384
s_lshl_b32 s29, s29, 17
buffer_load_dwordx4 v40, s[12:15], s29 offen lds
s_xor_b32 s29, s76, 9
s_lshl_b32 s28, s29, 10
s_add_u32 s28, s28, s47
s_add_u32 m0, s28, 16384
s_lshl_b32 s29, s29, 17
buffer_load_dwordx4 v40, s[12:15], s29 offen lds
s_xor_b32 s29, s76, 10
s_lshl_b32 s28, s29, 10
s_add_u32 s28, s28, s47
s_add_u32 m0, s28, 16384
s_lshl_b32 s29, s29, 17
buffer_load_dwordx4 v40, s[12:15], s29 offen lds
s_xor_b32 s29, s76, 11
s_lshl_b32 s28, s29, 10
s_add_u32 s28, s28, s47
s_add_u32 m0, s28, 16384
s_lshl_b32 s29, s29, 17
buffer_load_dwordx4 v40, s[12:15], s29 offen lds
s_xor_b32 s29, s76, 12
s_lshl_b32 s28, s29, 10
s_add_u32 s28, s28, s47
s_add_u32 m0, s28, 16384
s_lshl_b32 s29, s29, 17
buffer_load_dwordx4 v40, s[12:15], s29 offen lds
s_xor_b32 s29, s76, 13
s_lshl_b32 s28, s29, 10
s_add_u32 s28, s28, s47
s_add_u32 m0, s28, 16384
s_lshl_b32 s29, s29, 17
buffer_load_dwordx4 v40, s[12:15], s29 offen lds
s_xor_b32 s29, s76, 14
s_lshl_b32 s28, s29, 10
s_add_u32 s28, s28, s47
s_add_u32 m0, s28, 16384
s_lshl_b32 s29, s29, 17
buffer_load_dwordx4 v40, s[12:15], s29 offen lds
s_xor_b32 s29, s76, 15
s_lshl_b32 s28, s29, 10
s_add_u32 s28, s28, s47
s_add_u32 m0, s28, 16384
s_lshl_b32 s29, s29, 17
buffer_load_dwordx4 v40, s[12:15], s29 offen lds
s_mov_b32 s40, 0x00ff00ff
s_mov_b32 s41, 0x00ff00ff
s_mov_b32 s48, 0xff00ff00
s_mov_b32 s49, 0xff00ff00
s_mov_b32 s42, 0
s_mov_b32 s43, 0x00ff00ff
s_mov_b32 s32, 0x3e0293ee
v_mov_b32 v23, 0xff800000
v_mov_b32 v6, 0x4444
v_mov_b32 v4, 0xeeee
v_cndmask_b32 v6, v6, v4, s[48:49]
v_mov_b32 v28, -1
v_mov_b32 v29, -1
v_mov_b32 v30, -1
v_mov_b32 v31, -1
s_mul_i32 s28, s24, 4096
v_add_u32 v7, s28, v17
v_and_b32 v4, 7, v1
v_lshlrev_b32 v8, 11, v4
v_lshrrev_b32 v5, 3, v1
v_lshl_add_u32 v8, v5, 4, v8
s_lshl_b32 s28, s24, 9
v_add_u32 v8, s28, v8
s_lshl_b32 s28, s31, 9
s_lshr_b32 s29, s31, 3
s_mul_i32 s29, s29, 0
s_add_u32 s28, s28, s29
v_lshlrev_b32 v9, 3, v1
v_add_u32 v9, s28, v9
v_and_b32 v4, 7, v3
v_lshlrev_b32 v11, 7, v2
v_lshl_add_u32 v11, v4, 4, v11
v_add_u32 v22, 0, v11
s_add_u32 s28, s28, 24576
v_add_u32 v11, s28, v11
v_and_b32 v5, 1, v2
v_lshlrev_b32 v10, 7, v5
v_lshl_add_u32 v10, v4, 4, v10
v_add_u32 v10, 1024, v10
s_xor_b32 s37, s31, 1
s_mul_i32 s37, s37, 2048
s_add_u32 s37, s37, 49152
s_xor_b32 s38, s31, 2
s_mul_i32 s38, s38, 2048
s_add_u32 s38, s38, 49152
s_xor_b32 s39, s31, 3
s_mul_i32 s39, s39, 2048
s_add_u32 s39, s39, 49152
v_and_b32 v4, 1, v2
v_mul_u32_u24 v14, 576, v4
v_lshrrev_b32 v5, 1, v2
v_lshl_add_u32 v5, v5, 4, v3
v_lshl_add_u32 v14, v5, 2, v14
s_mul_i32 s28, s24, 1152
s_add_u32 s28, s28, 13312
v_add_u32 v18, s28, v14
s_mul_i32 s28, s24, 2304
v_add_u32 v14, s28, v14
v_add_u32 v15, 1152, v14
v_mul_u32_u24 v16, 144, v3
v_lshl_add_u32 v16, v2, 5, v16
v_bfe_u32 v4, v1, 1, 3
v_mul_u32_u24 v19, 144, v4
v_lshl_add_u32 v19, v2, 5, v19
v_and_b32 v4, 1, v1
v_lshl_add_u32 v19, v4, 4, v19
v_add_u32 v19, 13312, v19
s_lshl_b32 s28, s24, 10
s_add_u32 s28, s28, 9216
v_add_u32 v20, s28, v17
v_and_b32 v4, 31, v1
v_lshlrev_b32 v21, 3, v4
v_add_u32 v21, 17920, v21
v_lshrrev_b32 v4, 2, v3
v_and_b32 v42, 1, v4
v_lshrrev_b32 v43, 1, v4
v_lshrrev_b32 v44, 1, v2
v_and_b32 v45, 1, v2
v_lshl_add_u32 v46, v44, 4, v42
v_lshl_add_u32 v46, v45, 2, v46
v_lshl_add_u32 v46, v43, 3, v46
v_lshl_add_u32 v47, v44, 3, v42
v_lshl_add_u32 v47, v45, 4, v47
v_lshl_add_u32 v47, v43, 2, v47
v_and_b32 v5, 3, v3
v_lshlrev_b32 v5, 3, v5
v_lshl_add_u32 v46, v46, 6, v5
v_lshl_add_u32 v47, v47, 6, v5
s_and_b32 s28, s31, 0
s_lshl_b32 s28, s28, 6
s_add_u32 s28, s28, s47
v_add_u32 v46, s28, v46
v_add_u32 v47, s28, v47
s_waitcnt vmcnt(17)
ds_read_b64_tr_b16 a[64:65], v46 offset:0
ds_read_b64_tr_b16 a[66:67], v46 offset:128
ds_read_b64_tr_b16 a[68:69], v46 offset:2048
ds_read_b64_tr_b16 a[70:71], v46 offset:2176
ds_read_b64_tr_b16 a[72:73], v46 offset:4096
ds_read_b64_tr_b16 a[74:75], v46 offset:4224
ds_read_b64_tr_b16 a[76:77], v46 offset:6144
ds_read_b64_tr_b16 a[78:79], v46 offset:6272
s_waitcnt lgkmcnt(0)
ds_read_b64_tr_b16 a[80:81], v46 offset:8192
ds_read_b64_tr_b16 a[82:83], v46 offset:8320
ds_read_b64_tr_b16 a[84:85], v46 offset:10240
ds_read_b64_tr_b16 a[86:87], v46 offset:10368
ds_read_b64_tr_b16 a[88:89], v46 offset:12288
ds_read_b64_tr_b16 a[90:91], v46 offset:12416
ds_read_b64_tr_b16 a[92:93], v46 offset:14336
ds_read_b64_tr_b16 a[94:95], v46 offset:14464
s_waitcnt lgkmcnt(0)
ds_read_b64_tr_b16 a[96:97], v46 offset:32
ds_read_b64_tr_b16 a[98:99], v46 offset:160
ds_read_b64_tr_b16 a[100:101], v46 offset:2080
ds_read_b64_tr_b16 a[102:103], v46 offset:2208
ds_read_b64_tr_b16 a[104:105], v46 offset:4128
ds_read_b64_tr_b16 a[106:107], v46 offset:4256
ds_read_b64_tr_b16 a[108:109], v46 offset:6176
ds_read_b64_tr_b16 a[110:111], v46 offset:6304
s_waitcnt lgkmcnt(0)
ds_read_b64_tr_b16 a[112:113], v46 offset:8224
ds_read_b64_tr_b16 a[114:115], v46 offset:8352
ds_read_b64_tr_b16 a[116:117], v46 offset:10272
ds_read_b64_tr_b16 a[118:119], v46 offset:10400
ds_read_b64_tr_b16 a[120:121], v46 offset:12320
ds_read_b64_tr_b16 a[122:123], v46 offset:12448
ds_read_b64_tr_b16 a[124:125], v46 offset:14368
ds_read_b64_tr_b16 a[126:127], v46 offset:14496
s_waitcnt lgkmcnt(0)
buffer_load_dword v50, v51, s[4:7], 0 offen
s_xor_b32 s29, s76, 0
s_lshl_b32 s28, s29, 10
s_add_u32 s28, s28, s47
s_add_u32 m0, s28, 0
s_lshl_b32 s29, s29, 17
buffer_load_dwordx4 v40, s[4:7], s29 offen lds
s_xor_b32 s29, s76, 1
s_lshl_b32 s28, s29, 10
s_add_u32 s28, s28, s47
s_add_u32 m0, s28, 0
s_lshl_b32 s29, s29, 17
buffer_load_dwordx4 v40, s[4:7], s29 offen lds
s_xor_b32 s29, s76, 2
s_lshl_b32 s28, s29, 10
s_add_u32 s28, s28, s47
s_add_u32 m0, s28, 0
s_lshl_b32 s29, s29, 17
buffer_load_dwordx4 v40, s[4:7], s29 offen lds
s_xor_b32 s29, s76, 3
s_lshl_b32 s28, s29, 10
s_add_u32 s28, s28, s47
s_add_u32 m0, s28, 0
s_lshl_b32 s29, s29, 17
buffer_load_dwordx4 v40, s[4:7], s29 offen lds
s_xor_b32 s29, s76, 4
s_lshl_b32 s28, s29, 10
s_add_u32 s28, s28, s47
s_add_u32 m0, s28, 0
s_lshl_b32 s29, s29, 17
buffer_load_dwordx4 v40, s[4:7], s29 offen lds
s_xor_b32 s29, s76, 5
s_lshl_b32 s28, s29, 10
s_add_u32 s28, s28, s47
s_add_u32 m0, s28, 0
s_lshl_b32 s29, s29, 17
buffer_load_dwordx4 v40, s[4:7], s29 offen lds
s_xor_b32 s29, s76, 6
s_lshl_b32 s28, s29, 10
s_add_u32 s28, s28, s47
s_add_u32 m0, s28, 0
s_lshl_b32 s29, s29, 17
buffer_load_dwordx4 v40, s[4:7], s29 offen lds
s_xor_b32 s29, s76, 7
s_lshl_b32 s28, s29, 10
s_add_u32 s28, s28, s47
s_add_u32 m0, s28, 0
s_lshl_b32 s29, s29, 17
buffer_load_dwordx4 v40, s[4:7], s29 offen lds
s_xor_b32 s29, s76, 8
s_lshl_b32 s28, s29, 10
s_add_u32 s28, s28, s47
s_add_u32 m0, s28, 0
s_lshl_b32 s29, s29, 17
buffer_load_dwordx4 v40, s[4:7], s29 offen lds
s_xor_b32 s29, s76, 9
s_lshl_b32 s28, s29, 10
s_add_u32 s28, s28, s47
s_add_u32 m0, s28, 0
s_lshl_b32 s29, s29, 17
buffer_load_dwordx4 v40, s[4:7], s29 offen lds
s_xor_b32 s29, s76, 10
s_lshl_b32 s28, s29, 10
s_add_u32 s28, s28, s47
s_add_u32 m0, s28, 0
s_lshl_b32 s29, s29, 17
buffer_load_dwordx4 v40, s[4:7], s29 offen lds
s_xor_b32 s29, s76, 11
s_lshl_b32 s28, s29, 10
s_add_u32 s28, s28, s47
s_add_u32 m0, s28, 0
s_lshl_b32 s29, s29, 17
buffer_load_dwordx4 v40, s[4:7], s29 offen lds
s_xor_b32 s29, s76, 12
s_lshl_b32 s28, s29, 10
s_add_u32 s28, s28, s47
s_add_u32 m0, s28, 0
s_lshl_b32 s29, s29, 17
buffer_load_dwordx4 v40, s[4:7], s29 offen lds
s_xor_b32 s29, s76, 13
s_lshl_b32 s28, s29, 10
s_add_u32 s28, s28, s47
s_add_u32 m0, s28, 0
s_lshl_b32 s29, s29, 17
buffer_load_dwordx4 v40, s[4:7], s29 offen lds
s_xor_b32 s29, s76, 14
s_lshl_b32 s28, s29, 10
s_add_u32 s28, s28, s47
s_add_u32 m0, s28, 0
s_lshl_b32 s29, s29, 17
buffer_load_dwordx4 v40, s[4:7], s29 offen lds
s_xor_b32 s29, s76, 15
s_lshl_b32 s28, s29, 10
s_add_u32 s28, s28, s47
s_add_u32 m0, s28, 0
s_lshl_b32 s29, s29, 17
buffer_load_dwordx4 v40, s[4:7], s29 offen lds
s_waitcnt vmcnt(17)
ds_read_b64_tr_b16 a[128:129], v46 offset:16384
ds_read_b64_tr_b16 a[130:131], v46 offset:16512
ds_read_b64_tr_b16 a[132:133], v46 offset:18432
ds_read_b64_tr_b16 a[134:135], v46 offset:18560
ds_read_b64_tr_b16 a[136:137], v46 offset:20480
ds_read_b64_tr_b16 a[138:139], v46 offset:20608
ds_read_b64_tr_b16 a[140:141], v46 offset:22528
ds_read_b64_tr_b16 a[142:143], v46 offset:22656
s_waitcnt lgkmcnt(0)
ds_read_b64_tr_b16 a[144:145], v46 offset:24576
ds_read_b64_tr_b16 a[146:147], v46 offset:24704
ds_read_b64_tr_b16 a[148:149], v46 offset:26624
ds_read_b64_tr_b16 a[150:151], v46 offset:26752
ds_read_b64_tr_b16 a[152:153], v46 offset:28672
ds_read_b64_tr_b16 a[154:155], v46 offset:28800
ds_read_b64_tr_b16 a[156:157], v46 offset:30720
ds_read_b64_tr_b16 a[158:159], v46 offset:30848
s_waitcnt lgkmcnt(0)
ds_read_b64_tr_b16 a[160:161], v46 offset:16416
ds_read_b64_tr_b16 a[162:163], v46 offset:16544
ds_read_b64_tr_b16 a[164:165], v46 offset:18464
ds_read_b64_tr_b16 a[166:167], v46 offset:18592
ds_read_b64_tr_b16 a[168:169], v46 offset:20512
ds_read_b64_tr_b16 a[170:171], v46 offset:20640
ds_read_b64_tr_b16 a[172:173], v46 offset:22560
ds_read_b64_tr_b16 a[174:175], v46 offset:22688
s_waitcnt lgkmcnt(0)
ds_read_b64_tr_b16 a[176:177], v46 offset:24608
ds_read_b64_tr_b16 a[178:179], v46 offset:24736
ds_read_b64_tr_b16 a[180:181], v46 offset:26656
ds_read_b64_tr_b16 a[182:183], v46 offset:26784
ds_read_b64_tr_b16 a[184:185], v46 offset:28704
ds_read_b64_tr_b16 a[186:187], v46 offset:28832
ds_read_b64_tr_b16 a[188:189], v46 offset:30752
ds_read_b64_tr_b16 a[190:191], v46 offset:30880
s_waitcnt lgkmcnt(0)
buffer_load_dword v50, v52, s[16:19], 0 offen
s_xor_b32 s29, s76, 0
s_lshl_b32 s28, s29, 10
s_add_u32 s28, s28, s47
s_add_u32 m0, s28, 16384
s_lshl_b32 s29, s29, 15
buffer_load_dwordx4 v41, s[16:19], s29 offen lds
s_xor_b32 s29, s76, 1
s_lshl_b32 s28, s29, 10
s_add_u32 s28, s28, s47
s_add_u32 m0, s28, 16384
s_lshl_b32 s29, s29, 15
buffer_load_dwordx4 v41, s[16:19], s29 offen lds
s_xor_b32 s29, s76, 2
s_lshl_b32 s28, s29, 10
s_add_u32 s28, s28, s47
s_add_u32 m0, s28, 16384
s_lshl_b32 s29, s29, 15
buffer_load_dwordx4 v41, s[16:19], s29 offen lds
s_xor_b32 s29, s76, 3
s_lshl_b32 s28, s29, 10
s_add_u32 s28, s28, s47
s_add_u32 m0, s28, 16384
s_lshl_b32 s29, s29, 15
buffer_load_dwordx4 v41, s[16:19], s29 offen lds
s_xor_b32 s29, s76, 4
s_lshl_b32 s28, s29, 10
s_add_u32 s28, s28, s47
s_add_u32 m0, s28, 16384
s_lshl_b32 s29, s29, 15
buffer_load_dwordx4 v41, s[16:19], s29 offen lds
s_xor_b32 s29, s76, 5
s_lshl_b32 s28, s29, 10
s_add_u32 s28, s28, s47
s_add_u32 m0, s28, 16384
s_lshl_b32 s29, s29, 15
buffer_load_dwordx4 v41, s[16:19], s29 offen lds
s_xor_b32 s29, s76, 6
s_lshl_b32 s28, s29, 10
s_add_u32 s28, s28, s47
s_add_u32 m0, s28, 16384
s_lshl_b32 s29, s29, 15
buffer_load_dwordx4 v41, s[16:19], s29 offen lds
s_xor_b32 s29, s76, 7
s_lshl_b32 s28, s29, 10
s_add_u32 s28, s28, s47
s_add_u32 m0, s28, 16384
s_lshl_b32 s29, s29, 15
buffer_load_dwordx4 v41, s[16:19], s29 offen lds
s_xor_b32 s29, s76, 8
s_lshl_b32 s28, s29, 10
s_add_u32 s28, s28, s47
s_add_u32 m0, s28, 16384
s_lshl_b32 s29, s29, 15
buffer_load_dwordx4 v41, s[16:19], s29 offen lds
s_xor_b32 s29, s76, 9
s_lshl_b32 s28, s29, 10
s_add_u32 s28, s28, s47
s_add_u32 m0, s28, 16384
s_lshl_b32 s29, s29, 15
buffer_load_dwordx4 v41, s[16:19], s29 offen lds
s_xor_b32 s29, s76, 10
s_lshl_b32 s28, s29, 10
s_add_u32 s28, s28, s47
s_add_u32 m0, s28, 16384
s_lshl_b32 s29, s29, 15
buffer_load_dwordx4 v41, s[16:19], s29 offen lds
s_xor_b32 s29, s76, 11
s_lshl_b32 s28, s29, 10
s_add_u32 s28, s28, s47
s_add_u32 m0, s28, 16384
s_lshl_b32 s29, s29, 15
buffer_load_dwordx4 v41, s[16:19], s29 offen lds
s_xor_b32 s29, s76, 12
s_lshl_b32 s28, s29, 10
s_add_u32 s28, s28, s47
s_add_u32 m0, s28, 16384
s_lshl_b32 s29, s29, 15
buffer_load_dwordx4 v41, s[16:19], s29 offen lds
s_xor_b32 s29, s76, 13
s_lshl_b32 s28, s29, 10
s_add_u32 s28, s28, s47
s_add_u32 m0, s28, 16384
s_lshl_b32 s29, s29, 15
buffer_load_dwordx4 v41, s[16:19], s29 offen lds
s_xor_b32 s29, s76, 14
s_lshl_b32 s28, s29, 10
s_add_u32 s28, s28, s47
s_add_u32 m0, s28, 16384
s_lshl_b32 s29, s29, 15
buffer_load_dwordx4 v41, s[16:19], s29 offen lds
s_xor_b32 s29, s76, 15
s_lshl_b32 s28, s29, 10
s_add_u32 s28, s28, s47
s_add_u32 m0, s28, 16384
s_lshl_b32 s29, s29, 15
buffer_load_dwordx4 v41, s[16:19], s29 offen lds
s_waitcnt vmcnt(17)
ds_read_b64_tr_b16 a[0:1], v46 offset:0
ds_read_b64_tr_b16 a[2:3], v46 offset:128
ds_read_b64_tr_b16 a[4:5], v46 offset:2048
ds_read_b64_tr_b16 a[6:7], v46 offset:2176
ds_read_b64_tr_b16 a[8:9], v46 offset:4096
ds_read_b64_tr_b16 a[10:11], v46 offset:4224
ds_read_b64_tr_b16 a[12:13], v46 offset:6144
ds_read_b64_tr_b16 a[14:15], v46 offset:6272
s_waitcnt lgkmcnt(0)
ds_read_b64_tr_b16 a[16:17], v46 offset:8192
ds_read_b64_tr_b16 a[18:19], v46 offset:8320
ds_read_b64_tr_b16 a[20:21], v46 offset:10240
ds_read_b64_tr_b16 a[22:23], v46 offset:10368
ds_read_b64_tr_b16 a[24:25], v46 offset:12288
ds_read_b64_tr_b16 a[26:27], v46 offset:12416
ds_read_b64_tr_b16 a[28:29], v46 offset:14336
ds_read_b64_tr_b16 a[30:31], v46 offset:14464
s_waitcnt lgkmcnt(0)
ds_read_b64_tr_b16 a[32:33], v46 offset:32
ds_read_b64_tr_b16 a[34:35], v46 offset:160
ds_read_b64_tr_b16 a[36:37], v46 offset:2080
ds_read_b64_tr_b16 a[38:39], v46 offset:2208
ds_read_b64_tr_b16 a[40:41], v46 offset:4128
ds_read_b64_tr_b16 a[42:43], v46 offset:4256
ds_read_b64_tr_b16 a[44:45], v46 offset:6176
ds_read_b64_tr_b16 a[46:47], v46 offset:6304
s_waitcnt lgkmcnt(0)
ds_read_b64_tr_b16 a[48:49], v46 offset:8224
ds_read_b64_tr_b16 a[50:51], v46 offset:8352
ds_read_b64_tr_b16 a[52:53], v46 offset:10272
ds_read_b64_tr_b16 a[54:55], v46 offset:10400
ds_read_b64_tr_b16 a[56:57], v46 offset:12320
ds_read_b64_tr_b16 a[58:59], v46 offset:12448
ds_read_b64_tr_b16 a[60:61], v46 offset:14368
ds_read_b64_tr_b16 a[62:63], v46 offset:14496
s_waitcnt lgkmcnt(0)
s_waitcnt vmcnt(0)
ds_read_b64_tr_b16 a[192:193], v47 offset:16384
ds_read_b64_tr_b16 a[194:195], v47 offset:16512
ds_read_b64_tr_b16 a[196:197], v47 offset:18432
ds_read_b64_tr_b16 a[198:199], v47 offset:18560
ds_read_b64_tr_b16 a[200:201], v47 offset:20480
ds_read_b64_tr_b16 a[202:203], v47 offset:20608
ds_read_b64_tr_b16 a[204:205], v47 offset:22528
ds_read_b64_tr_b16 a[206:207], v47 offset:22656
s_waitcnt lgkmcnt(0)
ds_read_b64_tr_b16 a[208:209], v47 offset:24576
ds_read_b64_tr_b16 a[210:211], v47 offset:24704
ds_read_b64_tr_b16 a[212:213], v47 offset:26624
ds_read_b64_tr_b16 a[214:215], v47 offset:26752
ds_read_b64_tr_b16 a[216:217], v47 offset:28672
ds_read_b64_tr_b16 a[218:219], v47 offset:28800
ds_read_b64_tr_b16 a[220:221], v47 offset:30720
ds_read_b64_tr_b16 a[222:223], v47 offset:30848
s_waitcnt lgkmcnt(0)
ds_read_b64_tr_b16 a[224:225], v47 offset:16416
ds_read_b64_tr_b16 a[226:227], v47 offset:16544
ds_read_b64_tr_b16 a[228:229], v47 offset:18464
ds_read_b64_tr_b16 a[230:231], v47 offset:18592
ds_read_b64_tr_b16 a[232:233], v47 offset:20512
ds_read_b64_tr_b16 a[234:235], v47 offset:20640
ds_read_b64_tr_b16 a[236:237], v47 offset:22560
ds_read_b64_tr_b16 a[238:239], v47 offset:22688
s_waitcnt lgkmcnt(0)
ds_read_b64_tr_b16 a[240:241], v47 offset:24608
ds_read_b64_tr_b16 a[242:243], v47 offset:24736
ds_read_b64_tr_b16 a[244:245], v47 offset:26656
ds_read_b64_tr_b16 a[246:247], v47 offset:26784
ds_read_b64_tr_b16 a[248:249], v47 offset:28704
ds_read_b64_tr_b16 a[250:251], v47 offset:28832
ds_read_b64_tr_b16 a[252:253], v47 offset:30752
ds_read_b64_tr_b16 a[254:255], v47 offset:30880
s_waitcnt lgkmcnt(0)
v_and_b32 v5, 15, v0
v_lshlrev_b32 v5, 4, v5
s_branch mega_kernel_sys
mega_kernel_sysw:
s_sleep 4
mega_kernel_sys:
buffer_load_dword v4, v5, s[72:75], 0 offen sc1
s_waitcnt vmcnt(0)
s_cmp_eq_u32 s95, 1
s_cbranch_scc0 mega_kernel_sysf
v_readlane_b32 s76, v4, 14
s_mov_b32 s98, 0
s_cmp_eq_u32 s76, 64
s_cbranch_scc0 mega_kernel_sysw
s_branch mega_kernel_sysd
mega_kernel_sysf:
s_mov_b32 s77, 0
s_mov_b32 s78, 0
v_readlane_b32 s76, v4, 0
s_add_u32 s77, s77, s76
s_xor_b32 s76, s76, 32
s_or_b32 s78, s78, s76
v_readlane_b32 s76, v4, 1
s_add_u32 s77, s77, s76
s_xor_b32 s76, s76, 32
s_or_b32 s78, s78, s76
v_readlane_b32 s76, v4, 2
s_add_u32 s77, s77, s76
s_xor_b32 s76, s76, 32
s_or_b32 s78, s78, s76
v_readlane_b32 s76, v4, 3
s_add_u32 s77, s77, s76
s_xor_b32 s76, s76, 32
s_or_b32 s78, s78, s76
v_readlane_b32 s76, v4, 4
s_add_u32 s77, s77, s76
s_xor_b32 s76, s76, 32
s_or_b32 s78, s78, s76
v_readlane_b32 s76, v4, 5
s_add_u32 s77, s77, s76
s_xor_b32 s76, s76, 32
s_or_b32 s78, s78, s76
v_readlane_b32 s76, v4, 6
s_add_u32 s77, s77, s76
s_xor_b32 s76, s76, 32
s_or_b32 s78, s78, s76
v_readlane_b32 s76, v4, 7
s_add_u32 s77, s77, s76
s_xor_b32 s76, s76, 32
s_or_b32 s78, s78, s76
s_cmp_eq_u32 s77, 256
s_cbranch_scc0 mega_kernel_sysw
v_mov_b32 v252, v4
s_cmp_eq_u32 s78, 0
s_cbranch_scc0 mega_kernel_slowent
v_readlane_b32 s76, v4, 10
v_readlane_b32 s77, v4, 8
s_cmp_eq_u32 s76, 64
s_cbranch_scc0 mega_kernel_sysw
s_cmp_gt_u32 s77, 32
s_cselect_b32 s98, 1, 0
mega_kernel_sysd:
s_lshr_b32 s28, s31, 3
s_lshl_b32 s28, s28, 14
s_lshl_b32 s29, s98, 13
s_add_u32 s28, s28, s29
s_and_b32 s29, s31, 7
s_lshl_b32 s29, s29, 10
s_add_u32 s28, s28, s29
s_lshl_b32 s29, s30, 16
s_add_u32 s28, s28, s29
s_add_u32 s28, s28, 67108864
v_add_u32 v12, s28, v17
v_xor_b32 v25, 0x10000, v12
v_xor_b32 v26, 0x20000, v12
v_xor_b32 v27, 0x30000, v12
v_add_u32 v25, 0, v25
v_add_u32 v26, 0, v26
v_add_u32 v27, 0, v27
s_lshl_b32 s28, s25, 2
s_add_u32 s28, s28, s26
s_mov_b32 s82, s28
s_lshr_b32 s29, s28, 3
s_xor_b32 s29, s29, s98
s_and_b32 s29, s29, 1
s_lshl_b32 s29, s29, 13
s_lshl_b32 s76, s28, 18
s_add_u32 s76, s76, s29
s_mov_b32 s83, s76
v_add_u32 v240, s76, v17
v_add_u32 v241, 33554432, v240
s_lshr_b32 s29, s28, 4
s_xor_b32 s29, s29, s98
s_and_b32 s29, s29, 1
s_lshl_b32 s29, s29, 13
s_lshl_b32 s79, s28, 17
s_add_u32 s79, s79, s29
s_add_u32 s79, s79, 71303168
s_xor_b32 s29, s98, 1
s_lshl_b32 s29, s29, 13
s_lshl_b32 s28, s25, 7
s_add_u32 s28, s28, s29
s_add_u32 s28, s28, 69206016
v_and_b32 v4, 1, v1
v_lshlrev_b32 v24, 12, v4
v_add_u32 v24, s28, v24
s_lshl_b32 s29, s26, 2
v_add_u32 v24, s29, v24
s_xor_b32 s81, s98, 1
s_lshl_b32 s81, s81, 13
s_lshr_b32 s29, s82, 6
s_lshl_b32 s29, s29, 14
s_add_u32 s81, s81, s29
s_and_b32 s29, s82, 63
s_lshl_b32 s29, s29, 7
s_add_u32 s81, s81, s29
s_add_u32 s81, s81, 69222400
v_mov_b32 v220, 0x3f803f80
v_mov_b32 v221, 0x3f803f80
v_mov_b32 v222, 0x3f803f80
v_mov_b32 v223, 0x3f803f80
v_mov_b32 v228, 0
s_mov_b32 s27, 0
s_mov_b32 s46, 0
s_mov_b32 s89, 0
s_mov_b32 s88, 0
s_mov_b32 s44, 18432
s_mov_b32 s45, 18432
s_cmp_eq_u32 s24, 3
s_cbranch_scc0 mega_kernel_rs_pfi
s_mov_b32 s76, 0
s_cmp_gt_i32 s46, s76
s_cbranch_scc1 mega_kernel_rs_pf0ok
mega_kernel_rs_pf0w:
buffer_load_dword v4, v24, s[84:87], 0 offen sc1
s_waitcnt vmcnt(0)
v_readlane_b32 s46, v4, 0
v_readlane_b32 s28, v4, 1
s_nop 1
s_min_i32 s46, s46, s28
s_cmp_gt_i32 s46, s76
s_cbranch_scc0 mega_kernel_rs_pf0w
mega_kernel_rs_pf0ok:
s_add_u32 s77, s76, s82
s_bfe_u32 s28, s77, 0x40002
s_lshl_b32 s28, s28, 14
s_and_b32 s77, s77, 3
s_lshl_b32 s77, s77, 11
s_add_u32 s28, s28, s77
s_add_u32 m0, s45, 0
s_nop 0
buffer_load_dwordx4 v240, s[84:87], s28 offen offset:0 sc1 lds
s_add_u32 m0, s45, 0
s_nop 0
buffer_load_dwordx4 v240, s[84:87], s28 offen offset:1024 sc1 lds
s_add_u32 m0, s45, 2048
s_nop 0
buffer_load_dwordx4 v241, s[84:87], s28 offen offset:0 sc1 lds
s_add_u32 m0, s45, 2048
s_nop 0
buffer_load_dwordx4 v241, s[84:87], s28 offen offset:1024 sc1 lds
s_add_u32 s45, s45, 4096
s_cmp_eq_u32 s45, 30720
s_cselect_b32 s45, 18432, s45
s_waitcnt vmcnt(0) lgkmcnt(0)
mega_kernel_rs_pfi:
v_mov_b32 v96, 0
v_mov_b32 v97, 0
v_mov_b32 v98, 0
v_mov_b32 v99, 0
v_mov_b32 v100, 0
v_mov_b32 v101, 0
v_mov_b32 v102, 0
v_mov_b32 v103, 0
v_mov_b32 v104, 0
v_mov_b32 v105, 0
v_mov_b32 v106, 0
v_mov_b32 v107, 0
v_mov_b32 v108, 0
v_mov_b32 v109, 0
v_mov_b32 v110, 0
v_mov_b32 v111, 0
v_mov_b32 v112, 0
v_mov_b32 v113, 0
v_mov_b32 v114, 0
v_mov_b32 v115, 0
v_mov_b32 v116, 0
v_mov_b32 v117, 0
v_mov_b32 v118, 0
v_mov_b32 v119, 0
s_barrier
s_and_b32 s29, s27, 1
s_lshl_b32 s33, s29, 17
s_lshl_b32 s28, s30, 18
s_add_u32 s33, s33, s28
s_add_u32 s33, s33, 68157440
s_xor_b32 s34, s33, 131072
s_lshl_b32 s35, s29, 18
s_bfe_u32 s47, s27, 0x10001
s_branch mega_kernel_rs_first
mega_kernel_rs_loop:
buffer_load_dwordx4 v[32:35], v7, s[84:87], s33 offen offset:0 sc1
v_add_u32 v5, s44, v17
ds_read_b128 v[156:159], v5 offset:0
ds_read_b128 v[160:163], v5 offset:1024
ds_read_b128 v[164:167], v5 offset:2048
ds_read_b128 v[168:171], v5 offset:3072
s_nop 4
buffer_load_dwordx4 v[36:39], v7, s[84:87], s33 offen offset:1024 sc1
s_nop 9
buffer_load_dwordx4 v[40:43], v7, s[84:87], s33 offen offset:2048 sc1
s_nop 9
buffer_load_dwordx4 v[44:47], v7, s[84:87], s33 offen offset:3072 sc1
s_waitcnt vmcnt(3)
v_max_u32 v4, v32, v34
v_cmp_eq_u32 vcc, -1, v4
s_cbranch_vccnz mega_kernel_rs_pa_15_0f
v_smfmac_f32_16x16x64_bf16 v[96:99], v[32:35], a[0:7], v6
v_smfmac_f32_16x16x64_bf16 v[100:103], v[32:35], a[32:39], v6
v_smfmac_f32_16x16x64_bf16 v[104:107], v[32:35], a[64:71], v6
s_waitcnt vmcnt(2)
v_max_u32 v4, v36, v38
v_cmp_eq_u32 vcc, -1, v4
v_smfmac_f32_16x16x64_bf16 v[108:111], v[32:35], a[96:103], v6
s_cbranch_vccnz mega_kernel_rs_pa_14_1f
v_smfmac_f32_16x16x64_bf16 v[96:99], v[36:39], a[8:15], v6
v_smfmac_f32_16x16x64_bf16 v[100:103], v[36:39], a[40:47], v6
v_smfmac_f32_16x16x64_bf16 v[104:107], v[36:39], a[72:79], v6
s_waitcnt vmcnt(1)
v_max_u32 v4, v40, v42
v_cmp_eq_u32 vcc, -1, v4
v_smfmac_f32_16x16x64_bf16 v[108:111], v[36:39], a[104:111], v6
s_cbranch_vccnz mega_kernel_rs_pa_12_2f
v_smfmac_f32_16x16x64_bf16 v[96:99], v[40:43], a[16:23], v6
v_smfmac_f32_16x16x64_bf16 v[100:103], v[40:43], a[48:55], v6
v_smfmac_f32_16x16x64_bf16 v[104:107], v[40:43], a[80:87], v6
s_waitcnt vmcnt(0)
v_max_u32 v4, v44, v46
v_cmp_eq_u32 vcc, -1, v4
v_smfmac_f32_16x16x64_bf16 v[108:111], v[40:43], a[112:119], v6
s_cbranch_vccnz mega_kernel_rs_pa_8_3f
v_smfmac_f32_16x16x64_bf16 v[96:99], v[44:47], a[24:31], v6
v_smfmac_f32_16x16x64_bf16 v[100:103], v[44:47], a[56:63], v6
v_smfmac_f32_16x16x64_bf16 v[104:107], v[44:47], a[88:95], v6
v_smfmac_f32_16x16x64_bf16 v[108:111], v[44:47], a[120:127], v6
mega_kernel_rs_pa_d:
mega_kernel_rs_adone:
s_nop 5
v_permlane32_swap_b32 v96, v100
v_permlane32_swap_b32 v97, v101
v_permlane32_swap_b32 v98, v102
v_permlane32_swap_b32 v99, v103
v_pk_add_f32 v[96:97], v[96:97], v[100:101]
v_pk_add_f32 v[98:99], v[98:99], v[102:103]
ds_write2_b32 v14, v96, v97 offset0:0 offset1:36
ds_write2_b32 v14, v98, v99 offset0:72 offset1:108
v_permlane32_swap_b32 v104, v108
v_permlane32_swap_b32 v105, v109
v_permlane32_swap_b32 v106, v110
v_permlane32_swap_b32 v107, v111
v_pk_add_f32 v[104:105], v[104:105], v[108:109]
v_pk_add_f32 v[106:107], v[106:107], v[110:111]
ds_write2_b32 v15, v104, v105 offset0:0 offset1:36
ds_write2_b32 v15, v106, v107 offset0:72 offset1:108
v_smfmac_f32_16x16x64_bf16 v[112:115], v[32:35], a[128:135], v6
v_smfmac_f32_16x16x64_bf16 v[116:119], v[32:35], a[160:167], v6
v_smfmac_f32_16x16x64_bf16 v[112:115], v[36:39], a[136:143], v6
v_smfmac_f32_16x16x64_bf16 v[116:119], v[36:39], a[168:175], v6
s_waitcnt lgkmcnt(0)
s_barrier
s_cmp_lg_u32 s24, 0
s_cbranch_scc1 mega_kernel_rs_side
ds_read_b128 v[120:123], v16 offset:0
ds_read_b128 v[124:127], v16 offset:16
ds_read_b128 v[128:131], v16 offset:2304
ds_read_b128 v[132:135], v16 offset:2320
ds_read_b128 v[136:139], v16 offset:4608
ds_read_b128 v[140:143], v16 offset:4624
ds_read_b128 v[144:147], v16 offset:6912
ds_read_b128 v[148:151], v16 offset:6928
v_smfmac_f32_16x16x64_bf16 v[112:115], v[40:43], a[144:151], v6
v_smfmac_f32_16x16x64_bf16 v[116:119], v[40:43], a[176:183], v6
v_smfmac_f32_16x16x64_bf16 v[112:115], v[44:47], a[152:159], v6
v_smfmac_f32_16x16x64_bf16 v[116:119], v[44:47], a[184:191], v6
s_mul_i32 s28, s31, 2048
s_add_u32 s28, s28, s33
s_add_u32 s28, s28, 49152
s_add_u32 s76, s37, s33
s_add_u32 s77, s38, s33
s_add_u32 s78, s39, s33
s_waitcnt lgkmcnt(4)
v_pk_add_f32 v[120:121], v[120:121], v[128:129]
v_pk_add_f32 v[122:123], v[122:123], v[130:131]
v_pk_add_f32 v[124:125], v[124:125], v[132:133]
v_pk_add_f32 v[126:127], v[126:127], v[134:135]
s_waitcnt lgkmcnt(0)
v_pk_add_f32 v[136:137], v[136:137], v[144:145]
v_pk_add_f32 v[138:139], v[138:139], v[146:147]
v_pk_add_f32 v[140:141], v[140:141], v[148:149]
v_pk_add_f32 v[142:143], v[142:143], v[150:151]
v_pk_add_f32 v[120:121], v[120:121], v[136:137]
v_pk_add_f32 v[122:123], v[122:123], v[138:139]
v_pk_add_f32 v[124:125], v[124:125], v[140:141]
v_pk_add_f32 v[126:127], v[126:127], v[142:143]
v_cvt_pk_bf16_f32 v152, v120, v121
v_cvt_pk_bf16_f32 v153, v122, v123
v_cvt_pk_bf16_f32 v154, v124, v125
v_cvt_pk_bf16_f32 v155, v126, v127
s_nop 1
v_mfma_f32_16x16x32_bf16 v[176:179], v[160:163], v[152:155], 0
v_mfma_f32_16x16x32_bf16 v[172:175], v[156:159], v[152:155], 0
v_mfma_f32_16x16x32_bf16 v[180:183], v[152:155], v[152:155], 0
s_cmp_eq_u32 s27, 63
s_cbranch_scc1 mega_kernel_rs_w0last
s_nop 4
v_mov_b32_dpp v172, v176 row_shr:8 row_mask:0xf bank_mask:0xc
v_mov_b32_dpp v173, v177 row_shr:8 row_mask:0xf bank_mask:0xc
v_mov_b32_dpp v174, v178 row_shr:8 row_mask:0xf bank_mask:0xc
v_mov_b32_dpp v175, v179 row_shr:8 row_mask:0xf bank_mask:0xc
v_min_u32 v180, -2, v180
v_min_u32 v172, -2, v172
s_mov_b64 exec, s[42:43]
buffer_store_dwordx4 v[180:183], v10, s[84:87], s28 offen sc1
s_mov_b64 exec, -1
buffer_store_dwordx4 v[172:175], v17, s[84:87], s28 offen sc1
v_permlane32_swap_b32 v112, v116
v_permlane32_swap_b32 v113, v117
v_permlane32_swap_b32 v114, v118
v_permlane32_swap_b32 v115, v119
v_pk_add_f32 v[112:113], v[112:113], v[116:117]
v_pk_add_f32 v[114:115], v[114:115], v[118:119]
ds_write_b128 v20, v[112:115]
s_waitcnt lgkmcnt(0)
s_barrier
v_mov_b32 v96, 0
v_mov_b32 v97, 0
v_mov_b32 v98, 0
v_mov_b32 v99, 0
v_mov_b32 v100, 0
v_mov_b32 v101, 0
v_mov_b32 v102, 0
v_mov_b32 v103, 0
v_cndmask_b32 v176, v23, v180, s[42:43]
v_cndmask_b32 v177, v23, v181, s[42:43]
v_cndmask_b32 v178, v23, v182, s[42:43]
v_cndmask_b32 v179, v23, v183, s[42:43]
buffer_load_dwordx4 v[184:187], v17, s[84:87], s76 offen sc1
buffer_load_dwordx4 v[188:191], v10, s[84:87], s76 offen sc1
buffer_load_dwordx4 v[192:195], v17, s[84:87], s77 offen sc1
buffer_load_dwordx4 v[196:199], v10, s[84:87], s77 offen sc1
buffer_load_dwordx4 v[200:203], v17, s[84:87], s78 offen sc1
buffer_load_dwordx4 v[204:207], v10, s[84:87], s78 offen sc1
s_nop 15
s_nop 7
buffer_load_dwordx4 v[184:187], v17, s[84:87], s76 offen sc1
buffer_load_dwordx4 v[188:191], v10, s[84:87], s76 offen sc1
buffer_load_dwordx4 v[192:195], v17, s[84:87], s77 offen sc1
buffer_load_dwordx4 v[196:199], v10, s[84:87], s77 offen sc1
buffer_load_dwordx4 v[200:203], v17, s[84:87], s78 offen sc1
buffer_load_dwordx4 v[204:207], v10, s[84:87], s78 offen sc1
mega_kernel_rs_p2:
s_waitcnt vmcnt(6)
v_max3_u32 v4, v184, v188, v192
v_max3_u32 v5, v196, v200, v204
v_max_u32 v4, v4, v5
v_cmp_eq_u32 vcc, -1, v4
s_cbranch_vccnz mega_kernel_rs_p2r
v_pk_add_f32 v[176:177], v[176:177], v[188:189]
v_pk_add_f32 v[124:125], v[196:197], v[204:205]
v_pk_add_f32 v[178:179], v[178:179], v[190:191]
v_pk_add_f32 v[126:127], v[198:199], v[206:207]
v_pk_add_f32 v[172:173], v[172:173], v[184:185]
v_pk_add_f32 v[120:121], v[192:193], v[200:201]
v_pk_add_f32 v[174:175], v[174:175], v[186:187]
v_pk_add_f32 v[122:123], v[194:195], v[202:203]
v_pk_add_f32 v[176:177], v[176:177], v[124:125]
v_pk_add_f32 v[178:179], v[178:179], v[126:127]
v_pk_add_f32 v[172:173], v[172:173], v[120:121]
v_pk_add_f32 v[174:175], v[174:175], v[122:123]
v_max3_f32 v232, v172, v173, v174
v_max3_f32 v233, v176, v177, v178
v_max3_f32 v232, v232, v175, v179
v_max_f32 v234, v232, v233
s_barrier
ds_read2_b64 v[208:211], v21 offset0:0 offset1:32
v_max_f32_dpp v232, v234, v234 row_ror:8 row_mask:0xf bank_mask:0xf
v_max_f32_dpp v233, v234, v234 row_ror:8 row_mask:0xf bank_mask:0xf
s_nop 1
v_permlane16_swap_b32 v232, v233
s_nop 0
v_max_f32 v234, v232, v233
v_max_f32 v235, v232, v233
s_nop 1
v_permlane32_swap_b32 v234, v235
s_nop 0
v_max_f32 v232, v234, v235
v_mul_f32 v232, s32, v232
v_pk_fma_f32 v[176:177], v[176:177], s[32:33], v[232:233] op_sel_hi:[1,0,0] neg_lo:[0,0,1] neg_hi:[0,0,1]
v_pk_fma_f32 v[178:179], v[178:179], s[32:33], v[232:233] op_sel_hi:[1,0,0] neg_lo:[0,0,1] neg_hi:[0,0,1]
v_pk_fma_f32 v[172:173], v[172:173], s[32:33], v[232:233] op_sel_hi:[1,0,0] neg_lo:[0,0,1] neg_hi:[0,0,1]
v_pk_fma_f32 v[174:175], v[174:175], s[32:33], v[232:233] op_sel_hi:[1,0,0] neg_lo:[0,0,1] neg_hi:[0,0,1]
v_exp_f32 v176, v176
v_exp_f32 v177, v177
v_exp_f32 v178, v178
v_exp_f32 v179, v179
v_exp_f32 v172, v172
v_cvt_pk_bf16_f32 v216, v176, v177
v_cvt_pk_bf16_f32 v217, v178, v179
v_exp_f32 v173, v173
v_exp_f32 v174, v174
v_mfma_f32_16x16x16_bf16 v[224:227], v[220:221], v[216:217], 0
v_exp_f32 v175, v175
v_cvt_pk_bf16_f32 v212, v172, v173
s_waitcnt lgkmcnt(0)
v_mfma_f32_16x16x16_bf16 v[120:123], v[208:209], v[216:217], 0
v_cvt_pk_bf16_f32 v213, v174, v175
v_mfma_f32_16x16x16_bf16 v[124:127], v[210:211], v[216:217], 0
v_mov_b32_dpp v214, v212 row_ror:8 row_mask:0xf bank_mask:0xf
v_mov_b32_dpp v215, v213 row_ror:8 row_mask:0xf bank_mask:0xf
s_nop 1
v_mfma_f32_16x16x32_bf16 v[224:227], v[220:223], v[212:215], v[224:227]
v_mfma_f32_16x16x32_bf16 v[120:123], v[164:167], v[212:215], v[120:123]
v_mfma_f32_16x16x32_bf16 v[124:127], v[168:171], v[212:215], v[124:127]
s_add_u32 s29, s33, 24576
s_nop 4
v_rcp_f32 v234, v224
s_nop 0
v_pk_mul_f32 v[120:121], v[120:121], v[234:235] op_sel_hi:[1,0]
v_pk_mul_f32 v[122:123], v[122:123], v[234:235] op_sel_hi:[1,0]
v_pk_mul_f32 v[124:125], v[124:125], v[234:235] op_sel_hi:[1,0]
v_pk_mul_f32 v[126:127], v[126:127], v[234:235] op_sel_hi:[1,0]
v_cvt_pk_bf16_f32 v212, v120, v121
v_cvt_pk_bf16_f32 v213, v122, v123
v_cvt_pk_bf16_f32 v214, v124, v125
v_cvt_pk_bf16_f32 v215, v126, v127
v_min_u32 v212, -2, v212
s_mov_b64 exec, s[40:41]
buffer_store_dwordx4 v[212:215], v11, s[84:87], s33 offen sc1
s_mov_b64 exec, -1
mega_kernel_rs_b3:
s_barrier
s_nop 15
s_nop 7
buffer_load_dwordx4 v[32:35], v7, s[84:87], s29 offen offset:0 sc1
s_nop 9
buffer_load_dwordx4 v[36:39], v7, s[84:87], s29 offen offset:1024 sc1
s_nop 9
buffer_load_dwordx4 v[40:43], v7, s[84:87], s29 offen offset:2048 sc1
s_nop 9
buffer_load_dwordx4 v[44:47], v7, s[84:87], s29 offen offset:3072 sc1
mega_kernel_rs_pc_15_0:
s_waitcnt vmcnt(3)
v_cmp_eq_u32 vcc, -1, v32
s_cbranch_vccnz mega_kernel_rs_pc_15_0f
v_smfmac_f32_16x16x64_bf16 v[96:99], v[32:35], a[192:199], v6
v_smfmac_f32_16x16x64_bf16 v[100:103], v[32:35], a[224:231], v6
mega_kernel_rs_pc_14_1:
s_waitcnt vmcnt(2)
v_cmp_eq_u32 vcc, -1, v36
s_cbranch_vccnz mega_kernel_rs_pc_14_1f
v_smfmac_f32_16x16x64_bf16 v[96:99], v[36:39], a[200:207], v6
v_smfmac_f32_16x16x64_bf16 v[100:103], v[36:39], a[232:239], v6
mega_kernel_rs_pc_12_2:
s_waitcnt vmcnt(1)
v_cmp_eq_u32 vcc, -1, v40
s_cbranch_vccnz mega_kernel_rs_pc_12_2f
v_smfmac_f32_16x16x64_bf16 v[96:99], v[40:43], a[208:215], v6
v_smfmac_f32_16x16x64_bf16 v[100:103], v[40:43], a[240:247], v6
mega_kernel_rs_pc_8_3:
s_waitcnt vmcnt(0)
v_cmp_eq_u32 vcc, -1, v44
s_cbranch_vccnz mega_kernel_rs_pc_8_3f
v_smfmac_f32_16x16x64_bf16 v[96:99], v[44:47], a[216:223], v6
v_smfmac_f32_16x16x64_bf16 v[100:103], v[44:47], a[248:255], v6
mega_kernel_rs_pc_d:
s_nop 7
v_permlane32_swap_b32 v96, v100
v_permlane32_swap_b32 v97, v101
v_permlane32_swap_b32 v98, v102
v_permlane32_swap_b32 v99, v103
v_pk_add_f32 v[96:97], v[96:97], v[100:101]
v_pk_add_f32 v[98:99], v[98:99], v[102:103]
ds_write2_b32 v18, v96, v97 offset0:0 offset1:36
ds_write2_b32 v18, v98, v99 offset0:72 offset1:108
s_waitcnt lgkmcnt(0)
s_barrier
s_cmp_lg_u32 s24, 0
s_cbranch_scc1 mega_kernel_rs_x1
ds_read_b128 v[120:123], v19 offset:0
ds_read_b128 v[124:127], v19 offset:1152
ds_read_b128 v[128:131], v19 offset:2304
ds_read_b128 v[132:135], v19 offset:3456
s_waitcnt lgkmcnt(2)
v_pk_add_f32 v[120:121], v[120:121], v[124:125]
v_pk_add_f32 v[122:123], v[122:123], v[126:127]
s_waitcnt lgkmcnt(0)
v_pk_add_f32 v[128:129], v[128:129], v[132:133]
v_pk_add_f32 v[130:131], v[130:131], v[134:135]
v_pk_add_f32 v[120:121], v[120:121], v[128:129]
v_pk_add_f32 v[122:123], v[122:123], v[130:131]
v_and_or_b32 v120, v120, -2, s47
v_and_or_b32 v121, v121, -2, s47
v_and_or_b32 v122, v122, -2, s47
v_and_or_b32 v123, v123, -2, s47
buffer_store_dwordx4 v[120:123], v12, s[84:87], s35 offen sc1
s_xor_b32 s76, s47, 1
v_mov_b32 v48, s76
v_mov_b32 v49, s76
v_mov_b32 v50, s76
v_mov_b32 v51, s76
v_mov_b32 v52, s76
v_mov_b32 v53, s76
v_mov_b32 v54, s76
v_mov_b32 v55, s76
v_mov_b32 v56, s76
v_mov_b32 v57, s76
v_mov_b32 v58, s76
v_mov_b32 v59, s76
v_mov_b32 v96, 0
v_mov_b32 v97, 0
v_mov_b32 v98, 0
v_mov_b32 v99, 0
v_mov_b32 v100, 0
v_mov_b32 v101, 0
v_mov_b32 v102, 0
v_mov_b32 v103, 0
v_mov_b32 v104, 0
v_mov_b32 v105, 0
v_mov_b32 v106, 0
v_mov_b32 v107, 0
v_mov_b32 v108, 0
v_mov_b32 v109, 0
v_mov_b32 v110, 0
v_mov_b32 v111, 0
v_mov_b32 v112, 0
v_mov_b32 v113, 0
v_mov_b32 v114, 0
v_mov_b32 v115, 0
v_mov_b32 v116, 0
v_mov_b32 v117, 0
v_mov_b32 v118, 0
v_mov_b32 v119, 0
s_nop 15
s_cmp_eq_u32 s47, 1
s_cbranch_scc1 mega_kernel_rs_p4_1
mega_kernel_rs_p4_0:
buffer_load_dwordx4 v[48:51], v25, s[84:87], s35 offen sc1
buffer_load_dwordx4 v[52:55], v26, s[84:87], s35 offen sc1
buffer_load_dwordx4 v[56:59], v27, s[84:87], s35 offen sc1
s_waitcnt vmcnt(36)
s_nop 1
v_bitop3_b32 v4, v48, v49, v50 bitop3:0xfe
v_bitop3_b32 v5, v54, v55, v56 bitop3:0xfe
v_bitop3_b32 v4, v4, v51, v52 bitop3:0xfe
v_bitop3_b32 v5, v5, v57, v58 bitop3:0xfe
v_bitop3_b32 v4, v4, v53, v59 bitop3:0xfe
v_bitop3_b32 v4, v4, v5, 1 bitop3:0xa8
v_cmp_ne_u32 vcc, 0, v4
s_cbranch_vccnz mega_kernel_rs_p4_0
s_branch mega_kernel_rs_p4d
mega_kernel_rs_p4_1:
buffer_load_dwordx4 v[48:51], v25, s[84:87], s35 offen sc1
buffer_load_dwordx4 v[52:55], v26, s[84:87], s35 offen sc1
buffer_load_dwordx4 v[56:59], v27, s[84:87], s35 offen sc1
s_waitcnt vmcnt(36)
s_nop 1
v_bitop3_b32 v4, v48, v49, v50 bitop3:0x80
v_bitop3_b32 v5, v54, v55, v56 bitop3:0x80
v_bitop3_b32 v4, v4, v51, v52 bitop3:0x80
v_bitop3_b32 v5, v5, v57, v58 bitop3:0x80
v_bitop3_b32 v4, v4, v53, v59 bitop3:0x80
v_bitop3_b32 v4, v4, v5, 1 bitop3:0x80
v_cmp_ne_u32 vcc, 1, v4
s_cbranch_vccnz mega_kernel_rs_p4_1
mega_kernel_rs_p4d:
v_pk_add_f32 v[120:121], v[120:121], v[48:49]
v_pk_add_f32 v[124:125], v[52:53], v[56:57]
v_pk_add_f32 v[122:123], v[122:123], v[50:51]
v_pk_add_f32 v[126:127], v[54:55], v[58:59]
v_pk_add_f32 v[120:121], v[120:121], v[124:125]
v_pk_add_f32 v[122:123], v[122:123], v[126:127]
v_cvt_pk_bf16_f32 v212, v120, v121
v_cvt_pk_bf16_f32 v213, v122, v123
v_min_u32 v212, -2, v212
buffer_store_dwordx2 v[212:213], v9, s[84:87], s34 offen sc1
mega_kernel_rs_b5:
s_add_u32 s27, s27, 1
s_add_u32 s44, s44, 4096
s_cmp_eq_u32 s44, 30720
s_cselect_b32 s44, 18432, s44
s_mov_b32 s28, s33
s_mov_b32 s33, s34
s_mov_b32 s34, s28
s_xor_b32 s35, s35, 262144
s_bfe_u32 s47, s27, 0x10001
s_barrier
s_nop 15
s_nop 7
s_branch mega_kernel_rs_loop
mega_kernel_rs_x1:
s_cmp_eq_u32 s24, 1
s_cbranch_scc0 mega_kernel_rs_x2
s_add_u32 s76, s27, 1
v_mov_b32 v5, s76
s_mov_b64 exec, 1
buffer_store_dword v5, v228, s[84:87], s81 offen sc1
s_mov_b64 exec, -1
mega_kernel_rs_x2:
s_cmp_eq_u32 s24, 3
s_cbranch_scc0 mega_kernel_rs_x4
s_cmp_eq_u32 s36, 1
s_cbranch_scc0 mega_kernel_rs_x5
s_add_u32 s76, s27, 1
s_cmp_gt_i32 s46, s76
s_cbranch_scc1 mega_kernel_rs_pf1ok
mega_kernel_rs_pf1w:
buffer_load_dword v4, v24, s[84:87], 0 offen sc1
s_waitcnt vmcnt(0)
v_readlane_b32 s46, v4, 0
v_readlane_b32 s28, v4, 1
s_nop 1
s_min_i32 s46, s46, s28
s_cmp_gt_i32 s46, s76
s_cbranch_scc0 mega_kernel_rs_pf1w
mega_kernel_rs_pf1ok:
s_add_u32 s77, s76, s82
s_bfe_u32 s28, s77, 0x40002
s_lshl_b32 s28, s28, 14
s_and_b32 s77, s77, 3
s_lshl_b32 s77, s77, 11
s_add_u32 s28, s28, s77
s_add_u32 m0, s45, 0
s_nop 0
buffer_load_dwordx4 v240, s[84:87], s28 offen offset:0 sc1 lds
s_add_u32 m0, s45, 0
s_nop 0
buffer_load_dwordx4 v240, s[84:87], s28 offen offset:1024 sc1 lds
s_add_u32 m0, s45, 2048
s_nop 0
buffer_load_dwordx4 v241, s[84:87], s28 offen offset:0 sc1 lds
s_add_u32 m0, s45, 2048
s_nop 0
buffer_load_dwordx4 v241, s[84:87], s28 offen offset:1024 sc1 lds
s_add_u32 s45, s45, 4096
s_cmp_eq_u32 s45, 30720
s_cselect_b32 s45, 18432, s45
s_waitcnt vmcnt(0)
mega_kernel_rs_x5:
s_add_u32 s76, s27, 3
s_min_u32 s76, s76, 63
s_cmp_gt_i32 s46, s76
s_cbranch_scc1 mega_kernel_rs_pf2ok
mega_kernel_rs_pf2w:
buffer_load_dword v4, v24, s[84:87], 0 offen sc1
s_waitcnt vmcnt(0)
v_readlane_b32 s46, v4, 0
v_readlane_b32 s28, v4, 1
s_nop 1
s_min_i32 s46, s46, s28
s_cmp_gt_i32 s46, s76
s_cbranch_scc0 mega_kernel_rs_x6
mega_kernel_rs_pf2ok:
mega_kernel_rs_x6:
s_add_u32 s76, s27, 2
s_cmp_lt_u32 s76, 63
s_cbranch_scc0 mega_kernel_rs_x4
s_cmp_gt_i32 s46, s76
s_cbranch_scc0 mega_kernel_rs_x4
s_cmp_eq_u32 s88, s76
s_cbranch_scc1 mega_kernel_rs_x7
s_add_u32 s77, s76, s82
s_bfe_u32 s28, s77, 0x40002
s_lshl_b32 s28, s28, 14
s_and_b32 s77, s77, 3
s_lshl_b32 s77, s77, 11
s_add_u32 s28, s28, s77
s_add_u32 s28, s28, s83
s_buffer_load_dword s78, s[84:87], s28 offset:0
s_buffer_load_dword s78, s[84:87], s28 offset:128
s_buffer_load_dword s78, s[84:87], s28 offset:256
s_buffer_load_dword s78, s[84:87], s28 offset:384
s_buffer_load_dword s78, s[84:87], s28 offset:512
s_buffer_load_dword s78, s[84:87], s28 offset:640
s_buffer_load_dword s78, s[84:87], s28 offset:768
s_buffer_load_dword s78, s[84:87], s28 offset:896
s_buffer_load_dword s78, s[84:87], s28 offset:1024
s_buffer_load_dword s78, s[84:87], s28 offset:1152
s_buffer_load_dword s78, s[84:87], s28 offset:1280
s_buffer_load_dword s78, s[84:87], s28 offset:1408
s_buffer_load_dword s78, s[84:87], s28 offset:1536
s_buffer_load_dword s78, s[84:87], s28 offset:1664
s_buffer_load_dword s78, s[84:87], s28 offset:1792
s_buffer_load_dword s78, s[84:87], s28 offset:1920
mega_kernel_rs_x7:
s_add_u32 s77, s76, s82
s_bfe_u32 s28, s77, 0x40002
s_lshl_b32 s28, s28, 14
s_and_b32 s77, s77, 3
s_lshl_b32 s77, s77, 11
s_add_u32 s28, s28, s77
s_add_u32 s28, s28, s83
s_add_u32 s28, s28, 33554432
s_buffer_load_dword s78, s[84:87], s28 offset:0
s_buffer_load_dword s78, s[84:87], s28 offset:128
s_buffer_load_dword s78, s[84:87], s28 offset:256
s_buffer_load_dword s78, s[84:87], s28 offset:384
s_buffer_load_dword s78, s[84:87], s28 offset:512
s_buffer_load_dword s78, s[84:87], s28 offset:640
s_buffer_load_dword s78, s[84:87], s28 offset:768
s_buffer_load_dword s78, s[84:87], s28 offset:896
s_buffer_load_dword s78, s[84:87], s28 offset:1024
s_buffer_load_dword s78, s[84:87], s28 offset:1152
s_buffer_load_dword s78, s[84:87], s28 offset:1280
s_buffer_load_dword s78, s[84:87], s28 offset:1408
s_buffer_load_dword s78, s[84:87], s28 offset:1536
s_buffer_load_dword s78, s[84:87], s28 offset:1664
s_buffer_load_dword s78, s[84:87], s28 offset:1792
s_buffer_load_dword s78, s[84:87], s28 offset:1920
s_mov_b32 s89, s76
mega_kernel_rs_x4:
v_mov_b32 v96, 0
v_mov_b32 v97, 0
v_mov_b32 v98, 0
v_mov_b32 v99, 0
v_mov_b32 v100, 0
v_mov_b32 v101, 0
v_mov_b32 v102, 0
v_mov_b32 v103, 0
v_mov_b32 v104, 0
v_mov_b32 v105, 0
v_mov_b32 v106, 0
v_mov_b32 v107, 0
v_mov_b32 v108, 0
v_mov_b32 v109, 0
v_mov_b32 v110, 0
v_mov_b32 v111, 0
v_mov_b32 v112, 0
v_mov_b32 v113, 0
v_mov_b32 v114, 0
v_mov_b32 v115, 0
v_mov_b32 v116, 0
v_mov_b32 v117, 0
v_mov_b32 v118, 0
v_mov_b32 v119, 0
s_branch mega_kernel_rs_b5
mega_kernel_rs_p2r:
buffer_load_dwordx4 v[184:187], v17, s[84:87], s76 offen sc1
buffer_load_dwordx4 v[188:191], v10, s[84:87], s76 offen sc1
buffer_load_dwordx4 v[192:195], v17, s[84:87], s77 offen sc1
buffer_load_dwordx4 v[196:199], v10, s[84:87], s77 offen sc1
buffer_load_dwordx4 v[200:203], v17, s[84:87], s78 offen sc1
buffer_load_dwordx4 v[204:207], v10, s[84:87], s78 offen sc1
s_branch mega_kernel_rs_p2
mega_kernel_rs_pa_1_0f:
s_mov_b64 exec, vcc
buffer_load_dwordx4 v[32:35], v7, s[84:87], s33 offen offset:0 sc1
s_mov_b64 exec, -1
s_branch mega_kernel_rs_pa_1_0
mega_kernel_rs_pa_1_0:
s_waitcnt vmcnt(0)
v_max_u32 v4, v32, v34
v_cmp_eq_u32 vcc, -1, v4
s_cbranch_vccnz mega_kernel_rs_pa_1_0f
v_smfmac_f32_16x16x64_bf16 v[96:99], v[32:35], a[0:7], v6
v_smfmac_f32_16x16x64_bf16 v[100:103], v[32:35], a[32:39], v6
v_smfmac_f32_16x16x64_bf16 v[104:107], v[32:35], a[64:71], v6
v_smfmac_f32_16x16x64_bf16 v[108:111], v[32:35], a[96:103], v6
s_branch mega_kernel_rs_pa_d
mega_kernel_rs_pa_2_1f:
s_mov_b64 exec, vcc
buffer_load_dwordx4 v[36:39], v7, s[84:87], s33 offen offset:1024 sc1
s_mov_b64 exec, -1
s_branch mega_kernel_rs_pa_2_1
mega_kernel_rs_pa_2_1:
s_waitcnt vmcnt(0)
v_max_u32 v4, v36, v38
v_cmp_eq_u32 vcc, -1, v4
s_cbranch_vccnz mega_kernel_rs_pa_2_1f
v_smfmac_f32_16x16x64_bf16 v[96:99], v[36:39], a[8:15], v6
v_smfmac_f32_16x16x64_bf16 v[100:103], v[36:39], a[40:47], v6
v_smfmac_f32_16x16x64_bf16 v[104:107], v[36:39], a[72:79], v6
v_smfmac_f32_16x16x64_bf16 v[108:111], v[36:39], a[104:111], v6
s_branch mega_kernel_rs_pa_d
mega_kernel_rs_pa_3_0f:
s_mov_b64 exec, vcc
buffer_load_dwordx4 v[32:35], v7, s[84:87], s33 offen offset:0 sc1
s_mov_b64 exec, -1
s_branch mega_kernel_rs_pa_3_1
mega_kernel_rs_pa_3_0:
s_waitcnt vmcnt(1)
v_max_u32 v4, v32, v34
v_cmp_eq_u32 vcc, -1, v4
s_cbranch_vccnz mega_kernel_rs_pa_3_0f
v_smfmac_f32_16x16x64_bf16 v[96:99], v[32:35], a[0:7], v6
v_smfmac_f32_16x16x64_bf16 v[100:103], v[32:35], a[32:39], v6
v_smfmac_f32_16x16x64_bf16 v[104:107], v[32:35], a[64:71], v6
v_smfmac_f32_16x16x64_bf16 v[108:111], v[32:35], a[96:103], v6
s_branch mega_kernel_rs_pa_2_1
mega_kernel_rs_pa_3_1f:
s_mov_b64 exec, vcc
buffer_load_dwordx4 v[36:39], v7, s[84:87], s33 offen offset:1024 sc1
s_mov_b64 exec, -1
s_branch mega_kernel_rs_pa_3_0
mega_kernel_rs_pa_3_1:
s_waitcnt vmcnt(1)
v_max_u32 v4, v36, v38
v_cmp_eq_u32 vcc, -1, v4
s_cbranch_vccnz mega_kernel_rs_pa_3_1f
v_smfmac_f32_16x16x64_bf16 v[96:99], v[36:39], a[8:15], v6
v_smfmac_f32_16x16x64_bf16 v[100:103], v[36:39], a[40:47], v6
v_smfmac_f32_16x16x64_bf16 v[104:107], v[36:39], a[72:79], v6
v_smfmac_f32_16x16x64_bf16 v[108:111], v[36:39], a[104:111], v6
s_branch mega_kernel_rs_pa_1_0
mega_kernel_rs_pa_4_2f:
s_mov_b64 exec, vcc
buffer_load_dwordx4 v[40:43], v7, s[84:87], s33 offen offset:2048 sc1
s_mov_b64 exec, -1
s_branch mega_kernel_rs_pa_4_2
mega_kernel_rs_pa_4_2:
s_waitcnt vmcnt(0)
v_max_u32 v4, v40, v42
v_cmp_eq_u32 vcc, -1, v4
s_cbranch_vccnz mega_kernel_rs_pa_4_2f
v_smfmac_f32_16x16x64_bf16 v[96:99], v[40:43], a[16:23], v6
v_smfmac_f32_16x16x64_bf16 v[100:103], v[40:43], a[48:55], v6
v_smfmac_f32_16x16x64_bf16 v[104:107], v[40:43], a[80:87], v6
v_smfmac_f32_16x16x64_bf16 v[108:111], v[40:43], a[112:119], v6
s_branch mega_kernel_rs_pa_d
mega_kernel_rs_pa_5_0f:
s_mov_b64 exec, vcc
buffer_load_dwordx4 v[32:35], v7, s[84:87], s33 offen offset:0 sc1
s_mov_b64 exec, -1
s_branch mega_kernel_rs_pa_5_2
mega_kernel_rs_pa_5_0:
s_waitcnt vmcnt(1)
v_max_u32 v4, v32, v34
v_cmp_eq_u32 vcc, -1, v4
s_cbranch_vccnz mega_kernel_rs_pa_5_0f
v_smfmac_f32_16x16x64_bf16 v[96:99], v[32:35], a[0:7], v6
v_smfmac_f32_16x16x64_bf16 v[100:103], v[32:35], a[32:39], v6
v_smfmac_f32_16x16x64_bf16 v[104:107], v[32:35], a[64:71], v6
v_smfmac_f32_16x16x64_bf16 v[108:111], v[32:35], a[96:103], v6
s_branch mega_kernel_rs_pa_4_2
mega_kernel_rs_pa_5_2f:
s_mov_b64 exec, vcc
buffer_load_dwordx4 v[40:43], v7, s[84:87], s33 offen offset:2048 sc1
s_mov_b64 exec, -1
s_branch mega_kernel_rs_pa_5_0
mega_kernel_rs_pa_5_2:
s_waitcnt vmcnt(1)
v_max_u32 v4, v40, v42
v_cmp_eq_u32 vcc, -1, v4
s_cbranch_vccnz mega_kernel_rs_pa_5_2f
v_smfmac_f32_16x16x64_bf16 v[96:99], v[40:43], a[16:23], v6
v_smfmac_f32_16x16x64_bf16 v[100:103], v[40:43], a[48:55], v6
v_smfmac_f32_16x16x64_bf16 v[104:107], v[40:43], a[80:87], v6
v_smfmac_f32_16x16x64_bf16 v[108:111], v[40:43], a[112:119], v6
s_branch mega_kernel_rs_pa_1_0
mega_kernel_rs_pa_6_1f:
s_mov_b64 exec, vcc
buffer_load_dwordx4 v[36:39], v7, s[84:87], s33 offen offset:1024 sc1
s_mov_b64 exec, -1
s_branch mega_kernel_rs_pa_6_2
mega_kernel_rs_pa_6_1:
s_waitcnt vmcnt(1)
v_max_u32 v4, v36, v38
v_cmp_eq_u32 vcc, -1, v4
s_cbranch_vccnz mega_kernel_rs_pa_6_1f
v_smfmac_f32_16x16x64_bf16 v[96:99], v[36:39], a[8:15], v6
v_smfmac_f32_16x16x64_bf16 v[100:103], v[36:39], a[40:47], v6
v_smfmac_f32_16x16x64_bf16 v[104:107], v[36:39], a[72:79], v6
v_smfmac_f32_16x16x64_bf16 v[108:111], v[36:39], a[104:111], v6
s_branch mega_kernel_rs_pa_4_2
mega_kernel_rs_pa_6_2f:
s_mov_b64 exec, vcc
buffer_load_dwordx4 v[40:43], v7, s[84:87], s33 offen offset:2048 sc1
s_mov_b64 exec, -1
s_branch mega_kernel_rs_pa_6_1
mega_kernel_rs_pa_6_2:
s_waitcnt vmcnt(1)
v_max_u32 v4, v40, v42
v_cmp_eq_u32 vcc, -1, v4
s_cbranch_vccnz mega_kernel_rs_pa_6_2f
v_smfmac_f32_16x16x64_bf16 v[96:99], v[40:43], a[16:23], v6
v_smfmac_f32_16x16x64_bf16 v[100:103], v[40:43], a[48:55], v6
v_smfmac_f32_16x16x64_bf16 v[104:107], v[40:43], a[80:87], v6
v_smfmac_f32_16x16x64_bf16 v[108:111], v[40:43], a[112:119], v6
s_branch mega_kernel_rs_pa_2_1
mega_kernel_rs_pa_7_0f:
s_mov_b64 exec, vcc
buffer_load_dwordx4 v[32:35], v7, s[84:87], s33 offen offset:0 sc1
s_mov_b64 exec, -1
s_branch mega_kernel_rs_pa_7_1
mega_kernel_rs_pa_7_0:
s_waitcnt vmcnt(2)
v_max_u32 v4, v32, v34
v_cmp_eq_u32 vcc, -1, v4
s_cbranch_vccnz mega_kernel_rs_pa_7_0f
v_smfmac_f32_16x16x64_bf16 v[96:99], v[32:35], a[0:7], v6
v_smfmac_f32_16x16x64_bf16 v[100:103], v[32:35], a[32:39], v6
v_smfmac_f32_16x16x64_bf16 v[104:107], v[32:35], a[64:71], v6
v_smfmac_f32_16x16x64_bf16 v[108:111], v[32:35], a[96:103], v6
s_branch mega_kernel_rs_pa_6_1
mega_kernel_rs_pa_7_1f:
s_mov_b64 exec, vcc
buffer_load_dwordx4 v[36:39], v7, s[84:87], s33 offen offset:1024 sc1
s_mov_b64 exec, -1
s_branch mega_kernel_rs_pa_7_2
mega_kernel_rs_pa_7_1:
s_waitcnt vmcnt(2)
v_max_u32 v4, v36, v38
v_cmp_eq_u32 vcc, -1, v4
s_cbranch_vccnz mega_kernel_rs_pa_7_1f
v_smfmac_f32_16x16x64_bf16 v[96:99], v[36:39], a[8:15], v6
v_smfmac_f32_16x16x64_bf16 v[100:103], v[36:39], a[40:47], v6
v_smfmac_f32_16x16x64_bf16 v[104:107], v[36:39], a[72:79], v6
v_smfmac_f32_16x16x64_bf16 v[108:111], v[36:39], a[104:111], v6
s_branch mega_kernel_rs_pa_5_2
mega_kernel_rs_pa_7_2f:
s_mov_b64 exec, vcc
buffer_load_dwordx4 v[40:43], v7, s[84:87], s33 offen offset:2048 sc1
s_mov_b64 exec, -1
s_branch mega_kernel_rs_pa_7_0
mega_kernel_rs_pa_7_2:
s_waitcnt vmcnt(2)
v_max_u32 v4, v40, v42
v_cmp_eq_u32 vcc, -1, v4
s_cbranch_vccnz mega_kernel_rs_pa_7_2f
v_smfmac_f32_16x16x64_bf16 v[96:99], v[40:43], a[16:23], v6
v_smfmac_f32_16x16x64_bf16 v[100:103], v[40:43], a[48:55], v6
v_smfmac_f32_16x16x64_bf16 v[104:107], v[40:43], a[80:87], v6
v_smfmac_f32_16x16x64_bf16 v[108:111], v[40:43], a[112:119], v6
s_branch mega_kernel_rs_pa_3_0
mega_kernel_rs_pa_8_3f:
s_mov_b64 exec, vcc
buffer_load_dwordx4 v[44:47], v7, s[84:87], s33 offen offset:3072 sc1
s_mov_b64 exec, -1
s_branch mega_kernel_rs_pa_8_3
mega_kernel_rs_pa_8_3:
s_waitcnt vmcnt(0)
v_max_u32 v4, v44, v46
v_cmp_eq_u32 vcc, -1, v4
s_cbranch_vccnz mega_kernel_rs_pa_8_3f
v_smfmac_f32_16x16x64_bf16 v[96:99], v[44:47], a[24:31], v6
v_smfmac_f32_16x16x64_bf16 v[100:103], v[44:47], a[56:63], v6
v_smfmac_f32_16x16x64_bf16 v[104:107], v[44:47], a[88:95], v6
v_smfmac_f32_16x16x64_bf16 v[108:111], v[44:47], a[120:127], v6
s_branch mega_kernel_rs_pa_d
mega_kernel_rs_pa_9_0f:
s_mov_b64 exec, vcc
buffer_load_dwordx4 v[32:35], v7, s[84:87], s33 offen offset:0 sc1
s_mov_b64 exec, -1
s_branch mega_kernel_rs_pa_9_3
mega_kernel_rs_pa_9_0:
s_waitcnt vmcnt(1)
v_max_u32 v4, v32, v34
v_cmp_eq_u32 vcc, -1, v4
s_cbranch_vccnz mega_kernel_rs_pa_9_0f
v_smfmac_f32_16x16x64_bf16 v[96:99], v[32:35], a[0:7], v6
v_smfmac_f32_16x16x64_bf16 v[100:103], v[32:35], a[32:39], v6
v_smfmac_f32_16x16x64_bf16 v[104:107], v[32:35], a[64:71], v6
v_smfmac_f32_16x16x64_bf16 v[108:111], v[32:35], a[96:103], v6
s_branch mega_kernel_rs_pa_8_3
mega_kernel_rs_pa_9_3f:
s_mov_b64 exec, vcc
buffer_load_dwordx4 v[44:47], v7, s[84:87], s33 offen offset:3072 sc1
s_mov_b64 exec, -1
s_branch mega_kernel_rs_pa_9_0
mega_kernel_rs_pa_9_3:
s_waitcnt vmcnt(1)
v_max_u32 v4, v44, v46
v_cmp_eq_u32 vcc, -1, v4
s_cbranch_vccnz mega_kernel_rs_pa_9_3f
v_smfmac_f32_16x16x64_bf16 v[96:99], v[44:47], a[24:31], v6
v_smfmac_f32_16x16x64_bf16 v[100:103], v[44:47], a[56:63], v6
v_smfmac_f32_16x16x64_bf16 v[104:107], v[44:47], a[88:95], v6
v_smfmac_f32_16x16x64_bf16 v[108:111], v[44:47], a[120:127], v6
s_branch mega_kernel_rs_pa_1_0
mega_kernel_rs_pa_10_1f:
s_mov_b64 exec, vcc
buffer_load_dwordx4 v[36:39], v7, s[84:87], s33 offen offset:1024 sc1
s_mov_b64 exec, -1
s_branch mega_kernel_rs_pa_10_3
mega_kernel_rs_pa_10_1:
s_waitcnt vmcnt(1)
v_max_u32 v4, v36, v38
v_cmp_eq_u32 vcc, -1, v4
s_cbranch_vccnz mega_kernel_rs_pa_10_1f
v_smfmac_f32_16x16x64_bf16 v[96:99], v[36:39], a[8:15], v6
v_smfmac_f32_16x16x64_bf16 v[100:103], v[36:39], a[40:47], v6
v_smfmac_f32_16x16x64_bf16 v[104:107], v[36:39], a[72:79], v6
v_smfmac_f32_16x16x64_bf16 v[108:111], v[36:39], a[104:111], v6
s_branch mega_kernel_rs_pa_8_3
mega_kernel_rs_pa_10_3f:
s_mov_b64 exec, vcc
buffer_load_dwordx4 v[44:47], v7, s[84:87], s33 offen offset:3072 sc1
s_mov_b64 exec, -1
s_branch mega_kernel_rs_pa_10_1
mega_kernel_rs_pa_10_3:
s_waitcnt vmcnt(1)
v_max_u32 v4, v44, v46
v_cmp_eq_u32 vcc, -1, v4
s_cbranch_vccnz mega_kernel_rs_pa_10_3f
v_smfmac_f32_16x16x64_bf16 v[96:99], v[44:47], a[24:31], v6
v_smfmac_f32_16x16x64_bf16 v[100:103], v[44:47], a[56:63], v6
v_smfmac_f32_16x16x64_bf16 v[104:107], v[44:47], a[88:95], v6
v_smfmac_f32_16x16x64_bf16 v[108:111], v[44:47], a[120:127], v6
s_branch mega_kernel_rs_pa_2_1
mega_kernel_rs_pa_11_0f:
s_mov_b64 exec, vcc
buffer_load_dwordx4 v[32:35], v7, s[84:87], s33 offen offset:0 sc1
s_mov_b64 exec, -1
s_branch mega_kernel_rs_pa_11_1
mega_kernel_rs_pa_11_0:
s_waitcnt vmcnt(2)
v_max_u32 v4, v32, v34
v_cmp_eq_u32 vcc, -1, v4
s_cbranch_vccnz mega_kernel_rs_pa_11_0f
v_smfmac_f32_16x16x64_bf16 v[96:99], v[32:35], a[0:7], v6
v_smfmac_f32_16x16x64_bf16 v[100:103], v[32:35], a[32:39], v6
v_smfmac_f32_16x16x64_bf16 v[104:107], v[32:35], a[64:71], v6
v_smfmac_f32_16x16x64_bf16 v[108:111], v[32:35], a[96:103], v6
s_branch mega_kernel_rs_pa_10_1
mega_kernel_rs_pa_11_1f:
s_mov_b64 exec, vcc
buffer_load_dwordx4 v[36:39], v7, s[84:87], s33 offen offset:1024 sc1
s_mov_b64 exec, -1
s_branch mega_kernel_rs_pa_11_3
mega_kernel_rs_pa_11_1:
s_waitcnt vmcnt(2)
v_max_u32 v4, v36, v38
v_cmp_eq_u32 vcc, -1, v4
s_cbranch_vccnz mega_kernel_rs_pa_11_1f
v_smfmac_f32_16x16x64_bf16 v[96:99], v[36:39], a[8:15], v6
v_smfmac_f32_16x16x64_bf16 v[100:103], v[36:39], a[40:47], v6
v_smfmac_f32_16x16x64_bf16 v[104:107], v[36:39], a[72:79], v6
v_smfmac_f32_16x16x64_bf16 v[108:111], v[36:39], a[104:111], v6
s_branch mega_kernel_rs_pa_9_3
mega_kernel_rs_pa_11_3f:
s_mov_b64 exec, vcc
buffer_load_dwordx4 v[44:47], v7, s[84:87], s33 offen offset:3072 sc1
s_mov_b64 exec, -1
s_branch mega_kernel_rs_pa_11_0
mega_kernel_rs_pa_11_3:
s_waitcnt vmcnt(2)
v_max_u32 v4, v44, v46
v_cmp_eq_u32 vcc, -1, v4
s_cbranch_vccnz mega_kernel_rs_pa_11_3f
v_smfmac_f32_16x16x64_bf16 v[96:99], v[44:47], a[24:31], v6
v_smfmac_f32_16x16x64_bf16 v[100:103], v[44:47], a[56:63], v6
v_smfmac_f32_16x16x64_bf16 v[104:107], v[44:47], a[88:95], v6
v_smfmac_f32_16x16x64_bf16 v[108:111], v[44:47], a[120:127], v6
s_branch mega_kernel_rs_pa_3_0
mega_kernel_rs_pa_12_2f:
s_mov_b64 exec, vcc
buffer_load_dwordx4 v[40:43], v7, s[84:87], s33 offen offset:2048 sc1
s_mov_b64 exec, -1
s_branch mega_kernel_rs_pa_12_3
mega_kernel_rs_pa_12_2:
s_waitcnt vmcnt(1)
v_max_u32 v4, v40, v42
v_cmp_eq_u32 vcc, -1, v4
s_cbranch_vccnz mega_kernel_rs_pa_12_2f
v_smfmac_f32_16x16x64_bf16 v[96:99], v[40:43], a[16:23], v6
v_smfmac_f32_16x16x64_bf16 v[100:103], v[40:43], a[48:55], v6
v_smfmac_f32_16x16x64_bf16 v[104:107], v[40:43], a[80:87], v6
v_smfmac_f32_16x16x64_bf16 v[108:111], v[40:43], a[112:119], v6
s_branch mega_kernel_rs_pa_8_3
mega_kernel_rs_pa_12_3f:
s_mov_b64 exec, vcc
buffer_load_dwordx4 v[44:47], v7, s[84:87], s33 offen offset:3072 sc1
s_mov_b64 exec, -1
s_branch mega_kernel_rs_pa_12_2
mega_kernel_rs_pa_12_3:
s_waitcnt vmcnt(1)
v_max_u32 v4, v44, v46
v_cmp_eq_u32 vcc, -1, v4
s_cbranch_vccnz mega_kernel_rs_pa_12_3f
v_smfmac_f32_16x16x64_bf16 v[96:99], v[44:47], a[24:31], v6
v_smfmac_f32_16x16x64_bf16 v[100:103], v[44:47], a[56:63], v6
v_smfmac_f32_16x16x64_bf16 v[104:107], v[44:47], a[88:95], v6
v_smfmac_f32_16x16x64_bf16 v[108:111], v[44:47], a[120:127], v6
s_branch mega_kernel_rs_pa_4_2
mega_kernel_rs_pa_13_0f:
s_mov_b64 exec, vcc
buffer_load_dwordx4 v[32:35], v7, s[84:87], s33 offen offset:0 sc1
s_mov_b64 exec, -1
s_branch mega_kernel_rs_pa_13_2
mega_kernel_rs_pa_13_0:
s_waitcnt vmcnt(2)
v_max_u32 v4, v32, v34
v_cmp_eq_u32 vcc, -1, v4
s_cbranch_vccnz mega_kernel_rs_pa_13_0f
v_smfmac_f32_16x16x64_bf16 v[96:99], v[32:35], a[0:7], v6
v_smfmac_f32_16x16x64_bf16 v[100:103], v[32:35], a[32:39], v6
v_smfmac_f32_16x16x64_bf16 v[104:107], v[32:35], a[64:71], v6
v_smfmac_f32_16x16x64_bf16 v[108:111], v[32:35], a[96:103], v6
s_branch mega_kernel_rs_pa_12_2
mega_kernel_rs_pa_13_2f:
s_mov_b64 exec, vcc
buffer_load_dwordx4 v[40:43], v7, s[84:87], s33 offen offset:2048 sc1
s_mov_b64 exec, -1
s_branch mega_kernel_rs_pa_13_3
mega_kernel_rs_pa_13_2:
s_waitcnt vmcnt(2)
v_max_u32 v4, v40, v42
v_cmp_eq_u32 vcc, -1, v4
s_cbranch_vccnz mega_kernel_rs_pa_13_2f
v_smfmac_f32_16x16x64_bf16 v[96:99], v[40:43], a[16:23], v6
v_smfmac_f32_16x16x64_bf16 v[100:103], v[40:43], a[48:55], v6
v_smfmac_f32_16x16x64_bf16 v[104:107], v[40:43], a[80:87], v6
v_smfmac_f32_16x16x64_bf16 v[108:111], v[40:43], a[112:119], v6
s_branch mega_kernel_rs_pa_9_3
mega_kernel_rs_pa_13_3f:
s_mov_b64 exec, vcc
buffer_load_dwordx4 v[44:47], v7, s[84:87], s33 offen offset:3072 sc1
s_mov_b64 exec, -1
s_branch mega_kernel_rs_pa_13_0
mega_kernel_rs_pa_13_3:
s_waitcnt vmcnt(2)
v_max_u32 v4, v44, v46
v_cmp_eq_u32 vcc, -1, v4
s_cbranch_vccnz mega_kernel_rs_pa_13_3f
v_smfmac_f32_16x16x64_bf16 v[96:99], v[44:47], a[24:31], v6
v_smfmac_f32_16x16x64_bf16 v[100:103], v[44:47], a[56:63], v6
v_smfmac_f32_16x16x64_bf16 v[104:107], v[44:47], a[88:95], v6
v_smfmac_f32_16x16x64_bf16 v[108:111], v[44:47], a[120:127], v6
s_branch mega_kernel_rs_pa_5_0
mega_kernel_rs_pa_14_1f:
s_mov_b64 exec, vcc
buffer_load_dwordx4 v[36:39], v7, s[84:87], s33 offen offset:1024 sc1
s_mov_b64 exec, -1
s_branch mega_kernel_rs_pa_14_2
mega_kernel_rs_pa_14_1:
s_waitcnt vmcnt(2)
v_max_u32 v4, v36, v38
v_cmp_eq_u32 vcc, -1, v4
s_cbranch_vccnz mega_kernel_rs_pa_14_1f
v_smfmac_f32_16x16x64_bf16 v[96:99], v[36:39], a[8:15], v6
v_smfmac_f32_16x16x64_bf16 v[100:103], v[36:39], a[40:47], v6
v_smfmac_f32_16x16x64_bf16 v[104:107], v[36:39], a[72:79], v6
v_smfmac_f32_16x16x64_bf16 v[108:111], v[36:39], a[104:111], v6
s_branch mega_kernel_rs_pa_12_2
mega_kernel_rs_pa_14_2f:
s_mov_b64 exec, vcc
buffer_load_dwordx4 v[40:43], v7, s[84:87], s33 offen offset:2048 sc1
s_mov_b64 exec, -1
s_branch mega_kernel_rs_pa_14_3
mega_kernel_rs_pa_14_2:
s_waitcnt vmcnt(2)
v_max_u32 v4, v40, v42
v_cmp_eq_u32 vcc, -1, v4
s_cbranch_vccnz mega_kernel_rs_pa_14_2f
v_smfmac_f32_16x16x64_bf16 v[96:99], v[40:43], a[16:23], v6
v_smfmac_f32_16x16x64_bf16 v[100:103], v[40:43], a[48:55], v6
v_smfmac_f32_16x16x64_bf16 v[104:107], v[40:43], a[80:87], v6
v_smfmac_f32_16x16x64_bf16 v[108:111], v[40:43], a[112:119], v6
s_branch mega_kernel_rs_pa_10_3
mega_kernel_rs_pa_14_3f:
s_mov_b64 exec, vcc
buffer_load_dwordx4 v[44:47], v7, s[84:87], s33 offen offset:3072 sc1
s_mov_b64 exec, -1
s_branch mega_kernel_rs_pa_14_1
mega_kernel_rs_pa_14_3:
s_waitcnt vmcnt(2)
v_max_u32 v4, v44, v46
v_cmp_eq_u32 vcc, -1, v4
s_cbranch_vccnz mega_kernel_rs_pa_14_3f
v_smfmac_f32_16x16x64_bf16 v[96:99], v[44:47], a[24:31], v6
v_smfmac_f32_16x16x64_bf16 v[100:103], v[44:47], a[56:63], v6
v_smfmac_f32_16x16x64_bf16 v[104:107], v[44:47], a[88:95], v6
v_smfmac_f32_16x16x64_bf16 v[108:111], v[44:47], a[120:127], v6
s_branch mega_kernel_rs_pa_6_1
mega_kernel_rs_pa_15_0f:
s_mov_b64 exec, vcc
buffer_load_dwordx4 v[32:35], v7, s[84:87], s33 offen offset:0 sc1
s_mov_b64 exec, -1
s_branch mega_kernel_rs_pa_15_1
mega_kernel_rs_pa_15_0:
s_waitcnt vmcnt(3)
v_max_u32 v4, v32, v34
v_cmp_eq_u32 vcc, -1, v4
s_cbranch_vccnz mega_kernel_rs_pa_15_0f
v_smfmac_f32_16x16x64_bf16 v[96:99], v[32:35], a[0:7], v6
v_smfmac_f32_16x16x64_bf16 v[100:103], v[32:35], a[32:39], v6
v_smfmac_f32_16x16x64_bf16 v[104:107], v[32:35], a[64:71], v6
v_smfmac_f32_16x16x64_bf16 v[108:111], v[32:35], a[96:103], v6
s_branch mega_kernel_rs_pa_14_1
mega_kernel_rs_pa_15_1f:
s_mov_b64 exec, vcc
buffer_load_dwordx4 v[36:39], v7, s[84:87], s33 offen offset:1024 sc1
s_mov_b64 exec, -1
s_branch mega_kernel_rs_pa_15_2
mega_kernel_rs_pa_15_1:
s_waitcnt vmcnt(3)
v_max_u32 v4, v36, v38
v_cmp_eq_u32 vcc, -1, v4
s_cbranch_vccnz mega_kernel_rs_pa_15_1f
v_smfmac_f32_16x16x64_bf16 v[96:99], v[36:39], a[8:15], v6
v_smfmac_f32_16x16x64_bf16 v[100:103], v[36:39], a[40:47], v6
v_smfmac_f32_16x16x64_bf16 v[104:107], v[36:39], a[72:79], v6
v_smfmac_f32_16x16x64_bf16 v[108:111], v[36:39], a[104:111], v6
s_branch mega_kernel_rs_pa_13_2
mega_kernel_rs_pa_15_2f:
s_mov_b64 exec, vcc
buffer_load_dwordx4 v[40:43], v7, s[84:87], s33 offen offset:2048 sc1
s_mov_b64 exec, -1
s_branch mega_kernel_rs_pa_15_3
mega_kernel_rs_pa_15_2:
s_waitcnt vmcnt(3)
v_max_u32 v4, v40, v42
v_cmp_eq_u32 vcc, -1, v4
s_cbranch_vccnz mega_kernel_rs_pa_15_2f
v_smfmac_f32_16x16x64_bf16 v[96:99], v[40:43], a[16:23], v6
v_smfmac_f32_16x16x64_bf16 v[100:103], v[40:43], a[48:55], v6
v_smfmac_f32_16x16x64_bf16 v[104:107], v[40:43], a[80:87], v6
v_smfmac_f32_16x16x64_bf16 v[108:111], v[40:43], a[112:119], v6
s_branch mega_kernel_rs_pa_11_3
mega_kernel_rs_pa_15_3f:
s_mov_b64 exec, vcc
buffer_load_dwordx4 v[44:47], v7, s[84:87], s33 offen offset:3072 sc1
s_mov_b64 exec, -1
s_branch mega_kernel_rs_pa_15_0
mega_kernel_rs_pa_15_3:
s_waitcnt vmcnt(3)
v_max_u32 v4, v44, v46
v_cmp_eq_u32 vcc, -1, v4
s_cbranch_vccnz mega_kernel_rs_pa_15_3f
v_smfmac_f32_16x16x64_bf16 v[96:99], v[44:47], a[24:31], v6
v_smfmac_f32_16x16x64_bf16 v[100:103], v[44:47], a[56:63], v6
v_smfmac_f32_16x16x64_bf16 v[104:107], v[44:47], a[88:95], v6
v_smfmac_f32_16x16x64_bf16 v[108:111], v[44:47], a[120:127], v6
s_branch mega_kernel_rs_pa_7_0
mega_kernel_rs_pc_1_0f:
s_mov_b64 exec, vcc
buffer_load_dwordx4 v[32:35], v7, s[84:87], s29 offen offset:0 sc1
s_mov_b64 exec, -1
s_branch mega_kernel_rs_pc_1_0
mega_kernel_rs_pc_1_0:
s_waitcnt vmcnt(0)
v_cmp_eq_u32 vcc, -1, v32
s_cbranch_vccnz mega_kernel_rs_pc_1_0f
v_smfmac_f32_16x16x64_bf16 v[96:99], v[32:35], a[192:199], v6
v_smfmac_f32_16x16x64_bf16 v[100:103], v[32:35], a[224:231], v6
s_branch mega_kernel_rs_pc_d
mega_kernel_rs_pc_2_1f:
s_mov_b64 exec, vcc
buffer_load_dwordx4 v[36:39], v7, s[84:87], s29 offen offset:1024 sc1
s_mov_b64 exec, -1
s_branch mega_kernel_rs_pc_2_1
mega_kernel_rs_pc_2_1:
s_waitcnt vmcnt(0)
v_cmp_eq_u32 vcc, -1, v36
s_cbranch_vccnz mega_kernel_rs_pc_2_1f
v_smfmac_f32_16x16x64_bf16 v[96:99], v[36:39], a[200:207], v6
v_smfmac_f32_16x16x64_bf16 v[100:103], v[36:39], a[232:239], v6
s_branch mega_kernel_rs_pc_d
mega_kernel_rs_pc_3_0f:
s_mov_b64 exec, vcc
buffer_load_dwordx4 v[32:35], v7, s[84:87], s29 offen offset:0 sc1
s_mov_b64 exec, -1
s_branch mega_kernel_rs_pc_3_1
mega_kernel_rs_pc_3_0:
s_waitcnt vmcnt(1)
v_cmp_eq_u32 vcc, -1, v32
s_cbranch_vccnz mega_kernel_rs_pc_3_0f
v_smfmac_f32_16x16x64_bf16 v[96:99], v[32:35], a[192:199], v6
v_smfmac_f32_16x16x64_bf16 v[100:103], v[32:35], a[224:231], v6
s_branch mega_kernel_rs_pc_2_1
mega_kernel_rs_pc_3_1f:
s_mov_b64 exec, vcc
buffer_load_dwordx4 v[36:39], v7, s[84:87], s29 offen offset:1024 sc1
s_mov_b64 exec, -1
s_branch mega_kernel_rs_pc_3_0
mega_kernel_rs_pc_3_1:
s_waitcnt vmcnt(1)
v_cmp_eq_u32 vcc, -1, v36
s_cbranch_vccnz mega_kernel_rs_pc_3_1f
v_smfmac_f32_16x16x64_bf16 v[96:99], v[36:39], a[200:207], v6
v_smfmac_f32_16x16x64_bf16 v[100:103], v[36:39], a[232:239], v6
s_branch mega_kernel_rs_pc_1_0
mega_kernel_rs_pc_4_2f:
s_mov_b64 exec, vcc
buffer_load_dwordx4 v[40:43], v7, s[84:87], s29 offen offset:2048 sc1
s_mov_b64 exec, -1
s_branch mega_kernel_rs_pc_4_2
mega_kernel_rs_pc_4_2:
s_waitcnt vmcnt(0)
v_cmp_eq_u32 vcc, -1, v40
s_cbranch_vccnz mega_kernel_rs_pc_4_2f
v_smfmac_f32_16x16x64_bf16 v[96:99], v[40:43], a[208:215], v6
v_smfmac_f32_16x16x64_bf16 v[100:103], v[40:43], a[240:247], v6
s_branch mega_kernel_rs_pc_d
mega_kernel_rs_pc_5_0f:
s_mov_b64 exec, vcc
buffer_load_dwordx4 v[32:35], v7, s[84:87], s29 offen offset:0 sc1
s_mov_b64 exec, -1
s_branch mega_kernel_rs_pc_5_2
mega_kernel_rs_pc_5_0:
s_waitcnt vmcnt(1)
v_cmp_eq_u32 vcc, -1, v32
s_cbranch_vccnz mega_kernel_rs_pc_5_0f
v_smfmac_f32_16x16x64_bf16 v[96:99], v[32:35], a[192:199], v6
v_smfmac_f32_16x16x64_bf16 v[100:103], v[32:35], a[224:231], v6
s_branch mega_kernel_rs_pc_4_2
mega_kernel_rs_pc_5_2f:
s_mov_b64 exec, vcc
buffer_load_dwordx4 v[40:43], v7, s[84:87], s29 offen offset:2048 sc1
s_mov_b64 exec, -1
s_branch mega_kernel_rs_pc_5_0
mega_kernel_rs_pc_5_2:
s_waitcnt vmcnt(1)
v_cmp_eq_u32 vcc, -1, v40
s_cbranch_vccnz mega_kernel_rs_pc_5_2f
v_smfmac_f32_16x16x64_bf16 v[96:99], v[40:43], a[208:215], v6
v_smfmac_f32_16x16x64_bf16 v[100:103], v[40:43], a[240:247], v6
s_branch mega_kernel_rs_pc_1_0
mega_kernel_rs_pc_6_1f:
s_mov_b64 exec, vcc
buffer_load_dwordx4 v[36:39], v7, s[84:87], s29 offen offset:1024 sc1
s_mov_b64 exec, -1
s_branch mega_kernel_rs_pc_6_2
mega_kernel_rs_pc_6_1:
s_waitcnt vmcnt(1)
v_cmp_eq_u32 vcc, -1, v36
s_cbranch_vccnz mega_kernel_rs_pc_6_1f
v_smfmac_f32_16x16x64_bf16 v[96:99], v[36:39], a[200:207], v6
v_smfmac_f32_16x16x64_bf16 v[100:103], v[36:39], a[232:239], v6
s_branch mega_kernel_rs_pc_4_2
mega_kernel_rs_pc_6_2f:
s_mov_b64 exec, vcc
buffer_load_dwordx4 v[40:43], v7, s[84:87], s29 offen offset:2048 sc1
s_mov_b64 exec, -1
s_branch mega_kernel_rs_pc_6_1
mega_kernel_rs_pc_6_2:
s_waitcnt vmcnt(1)
v_cmp_eq_u32 vcc, -1, v40
s_cbranch_vccnz mega_kernel_rs_pc_6_2f
v_smfmac_f32_16x16x64_bf16 v[96:99], v[40:43], a[208:215], v6
v_smfmac_f32_16x16x64_bf16 v[100:103], v[40:43], a[240:247], v6
s_branch mega_kernel_rs_pc_2_1
mega_kernel_rs_pc_7_0f:
s_mov_b64 exec, vcc
buffer_load_dwordx4 v[32:35], v7, s[84:87], s29 offen offset:0 sc1
s_mov_b64 exec, -1
s_branch mega_kernel_rs_pc_7_1
mega_kernel_rs_pc_7_0:
s_waitcnt vmcnt(2)
v_cmp_eq_u32 vcc, -1, v32
s_cbranch_vccnz mega_kernel_rs_pc_7_0f
v_smfmac_f32_16x16x64_bf16 v[96:99], v[32:35], a[192:199], v6
v_smfmac_f32_16x16x64_bf16 v[100:103], v[32:35], a[224:231], v6
s_branch mega_kernel_rs_pc_6_1
mega_kernel_rs_pc_7_1f:
s_mov_b64 exec, vcc
buffer_load_dwordx4 v[36:39], v7, s[84:87], s29 offen offset:1024 sc1
s_mov_b64 exec, -1
s_branch mega_kernel_rs_pc_7_2
mega_kernel_rs_pc_7_1:
s_waitcnt vmcnt(2)
v_cmp_eq_u32 vcc, -1, v36
s_cbranch_vccnz mega_kernel_rs_pc_7_1f
v_smfmac_f32_16x16x64_bf16 v[96:99], v[36:39], a[200:207], v6
v_smfmac_f32_16x16x64_bf16 v[100:103], v[36:39], a[232:239], v6
s_branch mega_kernel_rs_pc_5_2
mega_kernel_rs_pc_7_2f:
s_mov_b64 exec, vcc
buffer_load_dwordx4 v[40:43], v7, s[84:87], s29 offen offset:2048 sc1
s_mov_b64 exec, -1
s_branch mega_kernel_rs_pc_7_0
mega_kernel_rs_pc_7_2:
s_waitcnt vmcnt(2)
v_cmp_eq_u32 vcc, -1, v40
s_cbranch_vccnz mega_kernel_rs_pc_7_2f
v_smfmac_f32_16x16x64_bf16 v[96:99], v[40:43], a[208:215], v6
v_smfmac_f32_16x16x64_bf16 v[100:103], v[40:43], a[240:247], v6
s_branch mega_kernel_rs_pc_3_0
mega_kernel_rs_pc_8_3f:
s_mov_b64 exec, vcc
buffer_load_dwordx4 v[44:47], v7, s[84:87], s29 offen offset:3072 sc1
s_mov_b64 exec, -1
s_branch mega_kernel_rs_pc_8_3
mega_kernel_rs_pc_9_0f:
s_mov_b64 exec, vcc
buffer_load_dwordx4 v[32:35], v7, s[84:87], s29 offen offset:0 sc1
s_mov_b64 exec, -1
s_branch mega_kernel_rs_pc_9_3
mega_kernel_rs_pc_9_0:
s_waitcnt vmcnt(1)
v_cmp_eq_u32 vcc, -1, v32
s_cbranch_vccnz mega_kernel_rs_pc_9_0f
v_smfmac_f32_16x16x64_bf16 v[96:99], v[32:35], a[192:199], v6
v_smfmac_f32_16x16x64_bf16 v[100:103], v[32:35], a[224:231], v6
s_branch mega_kernel_rs_pc_8_3
mega_kernel_rs_pc_9_3f:
s_mov_b64 exec, vcc
buffer_load_dwordx4 v[44:47], v7, s[84:87], s29 offen offset:3072 sc1
s_mov_b64 exec, -1
s_branch mega_kernel_rs_pc_9_0
mega_kernel_rs_pc_9_3:
s_waitcnt vmcnt(1)
v_cmp_eq_u32 vcc, -1, v44
s_cbranch_vccnz mega_kernel_rs_pc_9_3f
v_smfmac_f32_16x16x64_bf16 v[96:99], v[44:47], a[216:223], v6
v_smfmac_f32_16x16x64_bf16 v[100:103], v[44:47], a[248:255], v6
s_branch mega_kernel_rs_pc_1_0
mega_kernel_rs_pc_10_1f:
s_mov_b64 exec, vcc
buffer_load_dwordx4 v[36:39], v7, s[84:87], s29 offen offset:1024 sc1
s_mov_b64 exec, -1
s_branch mega_kernel_rs_pc_10_3
mega_kernel_rs_pc_10_1:
s_waitcnt vmcnt(1)
v_cmp_eq_u32 vcc, -1, v36
s_cbranch_vccnz mega_kernel_rs_pc_10_1f
v_smfmac_f32_16x16x64_bf16 v[96:99], v[36:39], a[200:207], v6
v_smfmac_f32_16x16x64_bf16 v[100:103], v[36:39], a[232:239], v6
s_branch mega_kernel_rs_pc_8_3
mega_kernel_rs_pc_10_3f:
s_mov_b64 exec, vcc
buffer_load_dwordx4 v[44:47], v7, s[84:87], s29 offen offset:3072 sc1
s_mov_b64 exec, -1
s_branch mega_kernel_rs_pc_10_1
mega_kernel_rs_pc_10_3:
s_waitcnt vmcnt(1)
v_cmp_eq_u32 vcc, -1, v44
s_cbranch_vccnz mega_kernel_rs_pc_10_3f
v_smfmac_f32_16x16x64_bf16 v[96:99], v[44:47], a[216:223], v6
v_smfmac_f32_16x16x64_bf16 v[100:103], v[44:47], a[248:255], v6
s_branch mega_kernel_rs_pc_2_1
mega_kernel_rs_pc_11_0f:
s_mov_b64 exec, vcc
buffer_load_dwordx4 v[32:35], v7, s[84:87], s29 offen offset:0 sc1
s_mov_b64 exec, -1
s_branch mega_kernel_rs_pc_11_1
mega_kernel_rs_pc_11_0:
s_waitcnt vmcnt(2)
v_cmp_eq_u32 vcc, -1, v32
s_cbranch_vccnz mega_kernel_rs_pc_11_0f
v_smfmac_f32_16x16x64_bf16 v[96:99], v[32:35], a[192:199], v6
v_smfmac_f32_16x16x64_bf16 v[100:103], v[32:35], a[224:231], v6
s_branch mega_kernel_rs_pc_10_1
mega_kernel_rs_pc_11_1f:
s_mov_b64 exec, vcc
buffer_load_dwordx4 v[36:39], v7, s[84:87], s29 offen offset:1024 sc1
s_mov_b64 exec, -1
s_branch mega_kernel_rs_pc_11_3
mega_kernel_rs_pc_11_1:
s_waitcnt vmcnt(2)
v_cmp_eq_u32 vcc, -1, v36
s_cbranch_vccnz mega_kernel_rs_pc_11_1f
v_smfmac_f32_16x16x64_bf16 v[96:99], v[36:39], a[200:207], v6
v_smfmac_f32_16x16x64_bf16 v[100:103], v[36:39], a[232:239], v6
s_branch mega_kernel_rs_pc_9_3
mega_kernel_rs_pc_11_3f:
s_mov_b64 exec, vcc
buffer_load_dwordx4 v[44:47], v7, s[84:87], s29 offen offset:3072 sc1
s_mov_b64 exec, -1
s_branch mega_kernel_rs_pc_11_0
mega_kernel_rs_pc_11_3:
s_waitcnt vmcnt(2)
v_cmp_eq_u32 vcc, -1, v44
s_cbranch_vccnz mega_kernel_rs_pc_11_3f
v_smfmac_f32_16x16x64_bf16 v[96:99], v[44:47], a[216:223], v6
v_smfmac_f32_16x16x64_bf16 v[100:103], v[44:47], a[248:255], v6
s_branch mega_kernel_rs_pc_3_0
mega_kernel_rs_pc_12_2f:
s_mov_b64 exec, vcc
buffer_load_dwordx4 v[40:43], v7, s[84:87], s29 offen offset:2048 sc1
s_mov_b64 exec, -1
s_branch mega_kernel_rs_pc_12_3
mega_kernel_rs_pc_12_3f:
s_mov_b64 exec, vcc
buffer_load_dwordx4 v[44:47], v7, s[84:87], s29 offen offset:3072 sc1
s_mov_b64 exec, -1
s_branch mega_kernel_rs_pc_12_2
mega_kernel_rs_pc_12_3:
s_waitcnt vmcnt(1)
v_cmp_eq_u32 vcc, -1, v44
s_cbranch_vccnz mega_kernel_rs_pc_12_3f
v_smfmac_f32_16x16x64_bf16 v[96:99], v[44:47], a[216:223], v6
v_smfmac_f32_16x16x64_bf16 v[100:103], v[44:47], a[248:255], v6
s_branch mega_kernel_rs_pc_4_2
mega_kernel_rs_pc_13_0f:
s_mov_b64 exec, vcc
buffer_load_dwordx4 v[32:35], v7, s[84:87], s29 offen offset:0 sc1
s_mov_b64 exec, -1
s_branch mega_kernel_rs_pc_13_2
mega_kernel_rs_pc_13_0:
s_waitcnt vmcnt(2)
v_cmp_eq_u32 vcc, -1, v32
s_cbranch_vccnz mega_kernel_rs_pc_13_0f
v_smfmac_f32_16x16x64_bf16 v[96:99], v[32:35], a[192:199], v6
v_smfmac_f32_16x16x64_bf16 v[100:103], v[32:35], a[224:231], v6
s_branch mega_kernel_rs_pc_12_2
mega_kernel_rs_pc_13_2f:
s_mov_b64 exec, vcc
buffer_load_dwordx4 v[40:43], v7, s[84:87], s29 offen offset:2048 sc1
s_mov_b64 exec, -1
s_branch mega_kernel_rs_pc_13_3
mega_kernel_rs_pc_13_2:
s_waitcnt vmcnt(2)
v_cmp_eq_u32 vcc, -1, v40
s_cbranch_vccnz mega_kernel_rs_pc_13_2f
v_smfmac_f32_16x16x64_bf16 v[96:99], v[40:43], a[208:215], v6
v_smfmac_f32_16x16x64_bf16 v[100:103], v[40:43], a[240:247], v6
s_branch mega_kernel_rs_pc_9_3
mega_kernel_rs_pc_13_3f:
s_mov_b64 exec, vcc
buffer_load_dwordx4 v[44:47], v7, s[84:87], s29 offen offset:3072 sc1
s_mov_b64 exec, -1
s_branch mega_kernel_rs_pc_13_0
mega_kernel_rs_pc_13_3:
s_waitcnt vmcnt(2)
v_cmp_eq_u32 vcc, -1, v44
s_cbranch_vccnz mega_kernel_rs_pc_13_3f
v_smfmac_f32_16x16x64_bf16 v[96:99], v[44:47], a[216:223], v6
v_smfmac_f32_16x16x64_bf16 v[100:103], v[44:47], a[248:255], v6
s_branch mega_kernel_rs_pc_5_0
mega_kernel_rs_pc_14_1f:
s_mov_b64 exec, vcc
buffer_load_dwordx4 v[36:39], v7, s[84:87], s29 offen offset:1024 sc1
s_mov_b64 exec, -1
s_branch mega_kernel_rs_pc_14_2
mega_kernel_rs_pc_14_2f:
s_mov_b64 exec, vcc
buffer_load_dwordx4 v[40:43], v7, s[84:87], s29 offen offset:2048 sc1
s_mov_b64 exec, -1
s_branch mega_kernel_rs_pc_14_3
mega_kernel_rs_pc_14_2:
s_waitcnt vmcnt(2)
v_cmp_eq_u32 vcc, -1, v40
s_cbranch_vccnz mega_kernel_rs_pc_14_2f
v_smfmac_f32_16x16x64_bf16 v[96:99], v[40:43], a[208:215], v6
v_smfmac_f32_16x16x64_bf16 v[100:103], v[40:43], a[240:247], v6
s_branch mega_kernel_rs_pc_10_3
mega_kernel_rs_pc_14_3f:
s_mov_b64 exec, vcc
buffer_load_dwordx4 v[44:47], v7, s[84:87], s29 offen offset:3072 sc1
s_mov_b64 exec, -1
s_branch mega_kernel_rs_pc_14_1
mega_kernel_rs_pc_14_3:
s_waitcnt vmcnt(2)
v_cmp_eq_u32 vcc, -1, v44
s_cbranch_vccnz mega_kernel_rs_pc_14_3f
v_smfmac_f32_16x16x64_bf16 v[96:99], v[44:47], a[216:223], v6
v_smfmac_f32_16x16x64_bf16 v[100:103], v[44:47], a[248:255], v6
s_branch mega_kernel_rs_pc_6_1
mega_kernel_rs_pc_15_0f:
s_mov_b64 exec, vcc
buffer_load_dwordx4 v[32:35], v7, s[84:87], s29 offen offset:0 sc1
s_mov_b64 exec, -1
s_branch mega_kernel_rs_pc_15_1
mega_kernel_rs_pc_15_1f:
s_mov_b64 exec, vcc
buffer_load_dwordx4 v[36:39], v7, s[84:87], s29 offen offset:1024 sc1
s_mov_b64 exec, -1
s_branch mega_kernel_rs_pc_15_2
mega_kernel_rs_pc_15_1:
s_waitcnt vmcnt(3)
v_cmp_eq_u32 vcc, -1, v36
s_cbranch_vccnz mega_kernel_rs_pc_15_1f
v_smfmac_f32_16x16x64_bf16 v[96:99], v[36:39], a[200:207], v6
v_smfmac_f32_16x16x64_bf16 v[100:103], v[36:39], a[232:239], v6
s_branch mega_kernel_rs_pc_13_2
mega_kernel_rs_pc_15_2f:
s_mov_b64 exec, vcc
buffer_load_dwordx4 v[40:43], v7, s[84:87], s29 offen offset:2048 sc1
s_mov_b64 exec, -1
s_branch mega_kernel_rs_pc_15_3
mega_kernel_rs_pc_15_2:
s_waitcnt vmcnt(3)
v_cmp_eq_u32 vcc, -1, v40
s_cbranch_vccnz mega_kernel_rs_pc_15_2f
v_smfmac_f32_16x16x64_bf16 v[96:99], v[40:43], a[208:215], v6
v_smfmac_f32_16x16x64_bf16 v[100:103], v[40:43], a[240:247], v6
s_branch mega_kernel_rs_pc_11_3
mega_kernel_rs_pc_15_3f:
s_mov_b64 exec, vcc
buffer_load_dwordx4 v[44:47], v7, s[84:87], s29 offen offset:3072 sc1
s_mov_b64 exec, -1
s_branch mega_kernel_rs_pc_15_0
mega_kernel_rs_pc_15_3:
s_waitcnt vmcnt(3)
v_cmp_eq_u32 vcc, -1, v44
s_cbranch_vccnz mega_kernel_rs_pc_15_3f
v_smfmac_f32_16x16x64_bf16 v[96:99], v[44:47], a[216:223], v6
v_smfmac_f32_16x16x64_bf16 v[100:103], v[44:47], a[248:255], v6
s_branch mega_kernel_rs_pc_7_0
mega_kernel_rs_w0last:
s_nop 7
v_permlane32_swap_b32 v112, v116
v_permlane32_swap_b32 v113, v117
v_permlane32_swap_b32 v114, v118
v_permlane32_swap_b32 v115, v119
v_pk_add_f32 v[112:113], v[112:113], v[116:117]
v_pk_add_f32 v[114:115], v[114:115], v[118:119]
ds_write_b128 v20, v[112:115]
s_waitcnt lgkmcnt(0)
s_barrier
s_branch mega_kernel_rs_end
mega_kernel_rs_side:
s_cmp_eq_u32 s24, 3
s_cbranch_scc1 mega_kernel_rs_sd3
s_cmp_eq_u32 s24, 2
s_cbranch_scc0 mega_kernel_rs_sd4
s_mov_b64 exec, s[40:41]
buffer_store_dwordx4 v[28:31], v11, s[84:87], s34 offen sc1
s_mov_b64 exec, -1
buffer_store_dwordx2 v[28:29], v9, s[84:87], s34 offen sc1
s_mul_i32 s28, s31, 2048
s_add_u32 s28, s28, s34
s_add_u32 s28, s28, 49152
buffer_store_dwordx4 v[28:31], v17, s[84:87], s28 offen sc1
buffer_store_dwordx4 v[28:31], v10, s[84:87], s28 offen sc1
s_branch mega_kernel_rs_sd4
mega_kernel_rs_sd3:
s_mov_b32 s36, 0
s_add_u32 s76, s27, 1
s_cmp_lt_u32 s76, 63
s_cbranch_scc0 mega_kernel_rs_sd4
s_cmp_ge_u32 s76, 0
s_cbranch_scc0 mega_kernel_rs_sd4
s_cmp_gt_i32 s46, s76
s_cselect_b32 s36, 0, 1
s_cbranch_scc0 mega_kernel_rs_sd4
s_add_u32 s77, s76, s82
s_bfe_u32 s28, s77, 0x40002
s_lshl_b32 s28, s28, 14
s_and_b32 s77, s77, 3
s_lshl_b32 s77, s77, 11
s_add_u32 s28, s28, s77
s_add_u32 m0, s45, 0
s_nop 0
buffer_load_dwordx4 v240, s[84:87], s28 offen offset:0 sc1 lds
s_add_u32 m0, s45, 0
s_nop 0
buffer_load_dwordx4 v240, s[84:87], s28 offen offset:1024 sc1 lds
s_add_u32 m0, s45, 2048
s_nop 0
buffer_load_dwordx4 v241, s[84:87], s28 offen offset:0 sc1 lds
s_add_u32 m0, s45, 2048
s_nop 0
buffer_load_dwordx4 v241, s[84:87], s28 offen offset:1024 sc1 lds
s_add_u32 s45, s45, 4096
s_cmp_eq_u32 s45, 30720
s_cselect_b32 s45, 18432, s45
mega_kernel_rs_sd4:
v_smfmac_f32_16x16x64_bf16 v[112:115], v[40:43], a[144:151], v6
v_smfmac_f32_16x16x64_bf16 v[116:119], v[40:43], a[176:183], v6
v_smfmac_f32_16x16x64_bf16 v[112:115], v[44:47], a[152:159], v6
v_smfmac_f32_16x16x64_bf16 v[116:119], v[44:47], a[184:191], v6
s_nop 7
v_permlane32_swap_b32 v112, v116
v_permlane32_swap_b32 v113, v117
v_permlane32_swap_b32 v114, v118
v_permlane32_swap_b32 v115, v119
v_pk_add_f32 v[112:113], v[112:113], v[116:117]
v_pk_add_f32 v[114:115], v[114:115], v[118:119]
ds_write_b128 v20, v[112:115]
v_mov_b32 v96, 0
v_mov_b32 v97, 0
v_mov_b32 v98, 0
v_mov_b32 v99, 0
v_mov_b32 v100, 0
v_mov_b32 v101, 0
v_mov_b32 v102, 0
v_mov_b32 v103, 0
s_cmp_eq_u32 s24, 1
s_cbranch_scc0 mega_kernel_rs_s1
s_waitcnt lgkmcnt(0)
ds_read_b128 v[120:123], v16 offset:0
ds_read_b128 v[124:127], v16 offset:16
ds_read_b128 v[128:131], v16 offset:2304
ds_read_b128 v[132:135], v16 offset:2320
ds_read_b128 v[136:139], v16 offset:4608
ds_read_b128 v[140:143], v16 offset:4624
ds_read_b128 v[144:147], v16 offset:6912
ds_read_b128 v[148:151], v16 offset:6928
s_waitcnt lgkmcnt(4)
v_pk_add_f32 v[120:121], v[120:121], v[128:129]
v_pk_add_f32 v[122:123], v[122:123], v[130:131]
v_pk_add_f32 v[124:125], v[124:125], v[132:133]
v_pk_add_f32 v[126:127], v[126:127], v[134:135]
s_waitcnt lgkmcnt(0)
v_pk_add_f32 v[136:137], v[136:137], v[144:145]
v_pk_add_f32 v[138:139], v[138:139], v[146:147]
v_pk_add_f32 v[140:141], v[140:141], v[148:149]
v_pk_add_f32 v[142:143], v[142:143], v[150:151]
v_pk_add_f32 v[120:121], v[120:121], v[136:137]
v_pk_add_f32 v[122:123], v[122:123], v[138:139]
v_pk_add_f32 v[124:125], v[124:125], v[140:141]
v_pk_add_f32 v[126:127], v[126:127], v[142:143]
v_cvt_pk_bf16_f32 v244, v120, v121
v_cvt_pk_bf16_f32 v245, v122, v123
v_cvt_pk_bf16_f32 v246, v124, v125
v_cvt_pk_bf16_f32 v247, v126, v127
mega_kernel_rs_s1:
v_add_u32 v5, 9216, v17
s_waitcnt lgkmcnt(0)
s_barrier
s_cmp_eq_u32 s24, 2
s_cbranch_scc1 mega_kernel_rs_s2
s_cmp_eq_u32 s24, 3
s_cbranch_scc0 mega_kernel_rs_s3
s_add_u32 s76, s27, 2
s_cmp_lt_u32 s76, 63
s_cbranch_scc0 mega_kernel_rs_s3
s_cmp_gt_i32 s46, s76
s_cbranch_scc0 mega_kernel_rs_s3
s_add_u32 s77, s76, s82
s_bfe_u32 s28, s77, 0x40002
s_lshl_b32 s28, s28, 14
s_and_b32 s77, s77, 3
s_lshl_b32 s77, s77, 11
s_add_u32 s28, s28, s77
s_add_u32 s28, s28, s83
s_buffer_load_dword s78, s[84:87], s28 offset:0
s_buffer_load_dword s78, s[84:87], s28 offset:128
s_buffer_load_dword s78, s[84:87], s28 offset:256
s_buffer_load_dword s78, s[84:87], s28 offset:384
s_buffer_load_dword s78, s[84:87], s28 offset:512
s_buffer_load_dword s78, s[84:87], s28 offset:640
s_buffer_load_dword s78, s[84:87], s28 offset:768
s_buffer_load_dword s78, s[84:87], s28 offset:896
s_buffer_load_dword s78, s[84:87], s28 offset:1024
s_buffer_load_dword s78, s[84:87], s28 offset:1152
s_buffer_load_dword s78, s[84:87], s28 offset:1280
s_buffer_load_dword s78, s[84:87], s28 offset:1408
s_buffer_load_dword s78, s[84:87], s28 offset:1536
s_buffer_load_dword s78, s[84:87], s28 offset:1664
s_buffer_load_dword s78, s[84:87], s28 offset:1792
s_buffer_load_dword s78, s[84:87], s28 offset:1920
s_mov_b32 s88, s76
s_branch mega_kernel_rs_s3
mega_kernel_rs_s2:
ds_read_b128 v[120:123], v5 offset:0
ds_read_b128 v[124:127], v5 offset:1024
ds_read_b128 v[128:131], v5 offset:2048
ds_read_b128 v[132:135], v5 offset:3072
v_lshrrev_b32 v5, 1, v17
s_waitcnt lgkmcnt(2)
v_pk_add_f32 v[120:121], v[120:121], v[124:125]
v_pk_add_f32 v[122:123], v[122:123], v[126:127]
s_waitcnt lgkmcnt(0)
v_pk_add_f32 v[128:129], v[128:129], v[132:133]
v_pk_add_f32 v[130:131], v[130:131], v[134:135]
v_pk_add_f32 v[120:121], v[120:121], v[128:129]
v_pk_add_f32 v[122:123], v[122:123], v[130:131]
v_cvt_pk_bf16_f32 v244, v120, v121
v_cvt_pk_bf16_f32 v245, v122, v123
ds_write_b64 v5, v[244:245] offset:17920
s_waitcnt lgkmcnt(0) vmcnt(0)
mega_kernel_rs_s3:
s_cmp_eq_u32 s27, 63
s_cbranch_scc1 mega_kernel_rs_slast
s_add_u32 s29, s33, 24576
s_barrier
s_cmp_eq_u32 s24, 3
s_cbranch_scc1 mega_kernel_rs_y3
s_add_u32 s77, s27, s82
s_bfe_u32 s28, s77, 0x30003
s_lshl_b32 s28, s28, 14
s_and_b32 s77, s77, 7
s_lshl_b32 s77, s77, 10
s_add_u32 s28, s28, s77
s_add_u32 s28, s28, s79
s_cmp_eq_u32 s24, 2
s_cbranch_scc1 mega_kernel_rs_kv2a
s_mov_b64 exec, s[48:49]
buffer_store_dwordx4 v[244:247], v22, s[84:87], s28 offen sc1
s_mov_b64 exec, -1
s_branch mega_kernel_rs_kvda
mega_kernel_rs_kv2a:
v_lshlrev_b32 v4, 3, v1
buffer_store_dwordx2 v[244:245], v4, s[84:87], s28 offen offset:512 sc1
mega_kernel_rs_kvda:
s_branch mega_kernel_rs_y4
mega_kernel_rs_y3:
s_add_u32 s76, s27, 2
s_cmp_lt_u32 s76, 63
s_cbranch_scc0 mega_kernel_rs_y4
mega_kernel_rs_y4:
s_branch mega_kernel_rs_b3
mega_kernel_rs_first:
buffer_load_dwordx4 v[32:35], v8, s[20:23], 0 offen offset:0
buffer_load_dwordx4 v[36:39], v8, s[20:23], 0 offen offset:128
buffer_load_dwordx4 v[40:43], v8, s[20:23], 0 offen offset:256
buffer_load_dwordx4 v[44:47], v8, s[20:23], 0 offen offset:384
v_add_u32 v5, s44, v17
ds_read_b128 v[156:159], v5 offset:0
ds_read_b128 v[160:163], v5 offset:1024
ds_read_b128 v[164:167], v5 offset:2048
ds_read_b128 v[168:171], v5 offset:3072
s_waitcnt vmcnt(0)
v_smfmac_f32_16x16x64_bf16 v[96:99], v[32:35], a[0:7], v6
v_smfmac_f32_16x16x64_bf16 v[100:103], v[32:35], a[32:39], v6
v_smfmac_f32_16x16x64_bf16 v[104:107], v[32:35], a[64:71], v6
v_smfmac_f32_16x16x64_bf16 v[108:111], v[32:35], a[96:103], v6
v_smfmac_f32_16x16x64_bf16 v[96:99], v[36:39], a[8:15], v6
v_smfmac_f32_16x16x64_bf16 v[100:103], v[36:39], a[40:47], v6
v_smfmac_f32_16x16x64_bf16 v[104:107], v[36:39], a[72:79], v6
v_smfmac_f32_16x16x64_bf16 v[108:111], v[36:39], a[104:111], v6
v_smfmac_f32_16x16x64_bf16 v[96:99], v[40:43], a[16:23], v6
v_smfmac_f32_16x16x64_bf16 v[100:103], v[40:43], a[48:55], v6
v_smfmac_f32_16x16x64_bf16 v[104:107], v[40:43], a[80:87], v6
v_smfmac_f32_16x16x64_bf16 v[108:111], v[40:43], a[112:119], v6
v_smfmac_f32_16x16x64_bf16 v[96:99], v[44:47], a[24:31], v6
v_smfmac_f32_16x16x64_bf16 v[100:103], v[44:47], a[56:63], v6
v_smfmac_f32_16x16x64_bf16 v[104:107], v[44:47], a[88:95], v6
v_smfmac_f32_16x16x64_bf16 v[108:111], v[44:47], a[120:127], v6
s_nop 1
s_branch mega_kernel_rs_adone
mega_kernel_rs_slast:
s_cmp_eq_u32 s24, 3
s_cbranch_scc1 mega_kernel_rs_end
s_add_u32 s77, s27, s82
s_bfe_u32 s28, s77, 0x30003
s_lshl_b32 s28, s28, 14
s_and_b32 s77, s77, 7
s_lshl_b32 s77, s77, 10
s_add_u32 s28, s28, s77
s_add_u32 s28, s28, s79
s_cmp_eq_u32 s24, 2
s_cbranch_scc1 mega_kernel_rs_kv2b
s_mov_b64 exec, s[48:49]
buffer_store_dwordx4 v[244:247], v22, s[84:87], s28 offen sc1
s_mov_b64 exec, -1
s_branch mega_kernel_rs_kvdb
mega_kernel_rs_kv2b:
v_lshlrev_b32 v4, 3, v1
buffer_store_dwordx2 v[244:245], v4, s[84:87], s28 offen offset:512 sc1
mega_kernel_rs_kvdb:
s_waitcnt vmcnt(0)
s_barrier
s_mov_b32 s76, 64
s_cmp_eq_u32 s24, 1
s_cbranch_scc0 mega_kernel_rs_end
v_mov_b32 v5, s76
s_mov_b64 exec, 1
buffer_store_dword v5, v228, s[84:87], s81 offen sc1
s_mov_b64 exec, -1
mega_kernel_rs_end:
s_endpgm
.section .rodata,"a"
.p2align 6
.amdhsa_kernel mega_kernel
  .amdhsa_next_free_vgpr 512
  .amdhsa_next_free_sgpr 102
  .amdhsa_accum_offset 256
  .amdhsa_group_segment_fixed_size 0
  .amdhsa_kernarg_size 104
  .amdhsa_user_sgpr_count 2
  .amdhsa_user_sgpr_kernarg_segment_ptr 1
  .amdhsa_system_sgpr_workgroup_id_x 1
.end_amdhsa_kernel
```

```asm
; @launch kernel=mega_kernel grid=(256,1,1) block=(256,1,1) lds=163840
.amdgcn_target "amdgcn-amd-amdhsa--gfx950"
.text
.globl mega_kernel
.p2align 8
.type mega_kernel,@function
mega_kernel:
s_cmp_ge_u32 s2, 256
s_cbranch_scc1 mega_kernel_exit
s_load_dwordx2 s[84:85], s[0:1], 96
s_load_dwordx2 s[72:73], s[0:1], 88
s_getreg_b32 s90, hwreg(HW_REG_XCC_ID)
s_and_b32 s90, s90, 7
v_mov_b32 v1, 0
v_mov_b32 v2, 1
s_lshl_b32 s91, s90, 4
s_mov_b32 s95, 0
s_mov_b32 s99, 0
s_waitcnt lgkmcnt(0)
s_mov_b32 s86, 268435456
s_mov_b32 s87, 0x00020000
s_mov_b32 s74, 256
s_mov_b32 s75, 0x00020000
v_cmp_eq_u32 vcc, 0, v0
s_and_saveexec_b64 s[88:89], vcc
s_cbranch_execz mega_kernel_tkd
s_lshl_b32 s92, s2, 13
s_add_u32 s92, s92, 167772160
buffer_atomic_add v2, v1, s[72:75], s91 offen sc0
buffer_load_dword v251, v1, s[84:87], s92 offen offset:2048 sc1
s_waitcnt vmcnt(1)
ds_write_b32 v1, v2
s_waitcnt lgkmcnt(0)
mega_kernel_tkd:
s_mov_b64 exec, s[88:89]
s_barrier
ds_read_b32 v2, v1
s_waitcnt lgkmcnt(0)
v_readfirstlane_b32 s96, v2
s_barrier
s_cmp_lt_u32 s96, 32
s_cbranch_scc1 mega_kernel_spec
v_and_b32 v3, 15, v0
v_lshlrev_b32 v3, 4, v3
s_branch mega_kernel_syx
mega_kernel_syxw:
s_sleep 4
mega_kernel_syx:
buffer_load_dword v2, v3, s[72:75], 0 offen sc1
s_waitcnt vmcnt(0)
s_cmp_eq_u32 s95, 1
s_cbranch_scc0 mega_kernel_syxf
v_readlane_b32 s76, v2, 14
s_mov_b32 s98, 0
s_cmp_eq_u32 s76, 64
s_cbranch_scc0 mega_kernel_syxw
s_branch mega_kernel_syxd
mega_kernel_syxf:
s_mov_b32 s77, 0
s_mov_b32 s78, 0
v_readlane_b32 s76, v2, 0
s_add_u32 s77, s77, s76
s_xor_b32 s76, s76, 32
s_or_b32 s78, s78, s76
v_readlane_b32 s76, v2, 1
s_add_u32 s77, s77, s76
s_xor_b32 s76, s76, 32
s_or_b32 s78, s78, s76
v_readlane_b32 s76, v2, 2
s_add_u32 s77, s77, s76
s_xor_b32 s76, s76, 32
s_or_b32 s78, s78, s76
v_readlane_b32 s76, v2, 3
s_add_u32 s77, s77, s76
s_xor_b32 s76, s76, 32
s_or_b32 s78, s78, s76
v_readlane_b32 s76, v2, 4
s_add_u32 s77, s77, s76
s_xor_b32 s76, s76, 32
s_or_b32 s78, s78, s76
v_readlane_b32 s76, v2, 5
s_add_u32 s77, s77, s76
s_xor_b32 s76, s76, 32
s_or_b32 s78, s78, s76
v_readlane_b32 s76, v2, 6
s_add_u32 s77, s77, s76
s_xor_b32 s76, s76, 32
s_or_b32 s78, s78, s76
v_readlane_b32 s76, v2, 7
s_add_u32 s77, s77, s76
s_xor_b32 s76, s76, 32
s_or_b32 s78, s78, s76
s_cmp_eq_u32 s77, 256
s_cbranch_scc0 mega_kernel_syxw
v_mov_b32 v252, v2
s_cmp_eq_u32 s78, 0
s_cbranch_scc0 mega_kernel_slowent
v_readlane_b32 s76, v2, 10
v_readlane_b32 s77, v2, 8
s_cmp_eq_u32 s76, 64
s_cbranch_scc0 mega_kernel_syxw
s_cmp_gt_u32 s77, 32
s_cselect_b32 s98, 1, 0
mega_kernel_syxd:
mega_kernel_slowent:
s_mov_b64 exec, -1
s_waitcnt vmcnt(0) lgkmcnt(0)
s_barrier
s_mov_b32 s97, s96
v_readlane_b32 s76, v252, 0
s_cmp_gt_u32 s90, 0
s_cselect_b32 s76, s76, 0
s_add_u32 s97, s97, s76
v_readlane_b32 s76, v252, 1
s_cmp_gt_u32 s90, 1
s_cselect_b32 s76, s76, 0
s_add_u32 s97, s97, s76
v_readlane_b32 s76, v252, 2
s_cmp_gt_u32 s90, 2
s_cselect_b32 s76, s76, 0
s_add_u32 s97, s97, s76
v_readlane_b32 s76, v252, 3
s_cmp_gt_u32 s90, 3
s_cselect_b32 s76, s76, 0
s_add_u32 s97, s97, s76
v_readlane_b32 s76, v252, 4
s_cmp_gt_u32 s90, 4
s_cselect_b32 s76, s76, 0
s_add_u32 s97, s97, s76
v_readlane_b32 s76, v252, 5
s_cmp_gt_u32 s90, 5
s_cselect_b32 s76, s76, 0
s_add_u32 s97, s97, s76
v_readlane_b32 s76, v252, 6
s_cmp_gt_u32 s90, 6
s_cselect_b32 s76, s76, 0
s_add_u32 s97, s97, s76
v_mov_b32 v1, 0
v_mov_b32 v2, 1
v_cmp_eq_u32 vcc, 0, v0
s_and_saveexec_b64 s[88:89], vcc
s_cbranch_execz mega_kernel_sb1
buffer_atomic_add v2, v1, s[72:75], 0 offen offset:192 sc1
mega_kernel_sb1:
s_mov_b64 exec, s[88:89]
mega_kernel_sb2:
s_sleep 4
buffer_load_dword v2, v1, s[72:75], 0 offen offset:192 sc1
s_waitcnt vmcnt(0)
v_cmp_ne_u32 vcc, 256, v2
s_cbranch_vccnz mega_kernel_sb2
s_mov_b32 s95, 1
s_lshr_b32 s30, s97, 5
s_and_b32 s31, s97, 31
s_cmp_lt_u32 s97, 128
s_cbranch_scc1 mega_kernel_recs
s_sub_u32 s94, s97, 128
s_branch mega_kernel_bulk
mega_kernel_spec:
s_mov_b32 s30, s90
s_mov_b32 s31, s96
s_cmp_lt_u32 s90, 4
s_cbranch_scc1 mega_kernel_recf
s_sub_u32 s94, s90, 4
s_lshl_b32 s94, s94, 5
s_add_u32 s94, s94, s96
mega_kernel_bulk:
s_lshr_b32 s91, s94, 5
s_and_b32 s40, s94, 31
s_and_b32 s92, s91, 1
s_lshl_b32 s92, s92, 5
s_add_u32 s92, s92, s40
s_cmp_eq_u32 s91, 0
s_cbranch_scc1 mega_kernel_rk
s_cmp_eq_u32 s91, 1
s_cbranch_scc1 mega_kernel_rv
v_mov_b32 v8, -1
v_mov_b32 v9, -1
v_mov_b32 v10, -1
v_mov_b32 v11, -1
v_lshlrev_b32 v1, 4, v0
v_mov_b32 v2, 0
v_cmp_gt_u32 vcc, 64, v0
s_cbranch_vccz mega_kernel_nv
s_cmp_eq_u32 s95, 0
s_cbranch_scc0 mega_kernel_nv
s_lshr_b32 s60, s2, 1
s_lshl_b32 s60, s60, 14
s_and_b32 s61, s92, 1
s_lshl_b32 s66, s61, 13
s_add_u32 s60, s60, s66
s_and_b32 s66, s2, 1
s_lshl_b32 s66, s66, 10
s_add_u32 s60, s60, s66
s_add_u32 s60, s60, 167772160
s_mov_b32 s66, 0x7fffffff
s_mov_b32 s67, 0x7fffffff
s_mov_b64 exec, 0xff
s_waitcnt vmcnt(0)
s_memtime s[62:63]
s_waitcnt lgkmcnt(0)
buffer_store_dwordx4 v[8:11], v1, s[84:87], s60 offen offset:0 sc1
s_waitcnt vmcnt(0)
s_memtime s[64:65]
s_xor_b32 s60, s60, 8192
s_waitcnt lgkmcnt(0)
s_sub_u32 s64, s64, s62
s_min_u32 s66, s66, s64
s_memtime s[62:63]
s_waitcnt lgkmcnt(0)
buffer_store_dwordx4 v[8:11], v1, s[84:87], s60 offen offset:0 sc1
s_waitcnt vmcnt(0)
s_memtime s[64:65]
s_xor_b32 s60, s60, 8192
s_waitcnt lgkmcnt(0)
s_sub_u32 s64, s64, s62
s_min_u32 s67, s67, s64
s_memtime s[62:63]
s_waitcnt lgkmcnt(0)
buffer_store_dwordx4 v[8:11], v1, s[84:87], s60 offen offset:256 sc1
s_waitcnt vmcnt(0)
s_memtime s[64:65]
s_xor_b32 s60, s60, 8192
s_waitcnt lgkmcnt(0)
s_sub_u32 s64, s64, s62
s_min_u32 s66, s66, s64
s_memtime s[62:63]
s_waitcnt lgkmcnt(0)
buffer_store_dwordx4 v[8:11], v1, s[84:87], s60 offen offset:256 sc1
s_waitcnt vmcnt(0)
s_memtime s[64:65]
s_xor_b32 s60, s60, 8192
s_waitcnt lgkmcnt(0)
s_sub_u32 s64, s64, s62
s_min_u32 s67, s67, s64
s_cmp_lt_u32 s67, s66
s_cselect_b32 s60, 1, 0
s_xor_b32 s60, s60, s61
s_lshr_b32 s61, s90, 2
s_xor_b32 s60, s60, s61
v_mov_b32 v3, s60
s_mov_b64 exec, 1
buffer_atomic_add v3, v2, s[72:75], 0 offen offset:128 sc1
s_mov_b64 exec, -1
mega_kernel_nv:
s_barrier
s_lshl_b32 s60, s92, 12
s_add_u32 s60, s60, 67108864
buffer_store_dwordx4 v[8:11], v1, s[84:87], s60 offen sc1
s_add_u32 s60, s60, 262144
buffer_store_dwordx4 v[8:11], v1, s[84:87], s60 offen sc1
s_add_u32 s60, s60, 262144
buffer_store_dwordx4 v[8:11], v1, s[84:87], s60 offen sc1
s_add_u32 s60, s60, 262144
buffer_store_dwordx4 v[8:11], v1, s[84:87], s60 offen sc1
s_add_u32 s60, s60, 262144
buffer_store_dwordx4 v[8:11], v1, s[84:87], s60 offen sc1
s_add_u32 s60, s60, 262144
buffer_store_dwordx4 v[8:11], v1, s[84:87], s60 offen sc1
s_add_u32 s60, s60, 262144
buffer_store_dwordx4 v[8:11], v1, s[84:87], s60 offen sc1
s_add_u32 s60, s60, 262144
buffer_store_dwordx4 v[8:11], v1, s[84:87], s60 offen sc1
s_add_u32 s60, s60, 262144
s_lshr_b32 s62, s92, 1
s_and_b32 s63, s92, 1
s_add_u32 s63, s63, s62
s_lshl_b32 s62, s62, 19
s_and_b32 s64, s63, 14
s_lshl_b32 s64, s64, 13
s_add_u32 s62, s62, s64
s_and_b32 s64, s63, 1
s_lshl_b32 s64, s64, 12
s_add_u32 s62, s62, s64
s_add_u32 s62, s62, 150994944
s_add_u32 s62, s62, 8192
s_cmp_lt_u32 s92, 16
s_cbranch_scc0 mega_kernel_pz
buffer_store_dwordx4 v[8:11], v1, s[84:87], s60 offen sc1
mega_kernel_pz:
s_waitcnt vmcnt(0)
s_barrier
v_mov_b32 v3, 1
s_lshl_b32 s62, s95, 6
v_cmp_eq_u32 vcc, 0, v0
s_and_saveexec_b64 s[60:61], vcc
s_cbranch_execz mega_kernel_xps
buffer_atomic_add v3, v2, s[72:75], s62 offen offset:160 sc1
mega_kernel_xps:
s_mov_b64 exec, s[60:61]
s_cmp_eq_u32 s91, 2
s_cbranch_scc0 mega_kernel_rd
v_and_b32 v3, 15, v0
v_lshlrev_b32 v3, 4, v3
s_branch mega_kernel_syc
mega_kernel_sycw:
s_sleep 4
mega_kernel_syc:
buffer_load_dword v2, v3, s[72:75], 0 offen sc1
s_waitcnt vmcnt(0)
s_cmp_eq_u32 s95, 1
s_cbranch_scc0 mega_kernel_sycf
v_readlane_b32 s76, v2, 14
s_mov_b32 s98, 0
s_cmp_eq_u32 s76, 64
s_cbranch_scc0 mega_kernel_sycw
s_branch mega_kernel_sycd
mega_kernel_sycf:
s_mov_b32 s77, 0
s_mov_b32 s78, 0
v_readlane_b32 s76, v2, 0
s_add_u32 s77, s77, s76
s_xor_b32 s76, s76, 32
s_or_b32 s78, s78, s76
v_readlane_b32 s76, v2, 1
s_add_u32 s77, s77, s76
s_xor_b32 s76, s76, 32
s_or_b32 s78, s78, s76
v_readlane_b32 s76, v2, 2
s_add_u32 s77, s77, s76
s_xor_b32 s76, s76, 32
s_or_b32 s78, s78, s76
v_readlane_b32 s76, v2, 3
s_add_u32 s77, s77, s76
s_xor_b32 s76, s76, 32
s_or_b32 s78, s78, s76
v_readlane_b32 s76, v2, 4
s_add_u32 s77, s77, s76
s_xor_b32 s76, s76, 32
s_or_b32 s78, s78, s76
v_readlane_b32 s76, v2, 5
s_add_u32 s77, s77, s76
s_xor_b32 s76, s76, 32
s_or_b32 s78, s78, s76
v_readlane_b32 s76, v2, 6
s_add_u32 s77, s77, s76
s_xor_b32 s76, s76, 32
s_or_b32 s78, s78, s76
v_readlane_b32 s76, v2, 7
s_add_u32 s77, s77, s76
s_xor_b32 s76, s76, 32
s_or_b32 s78, s78, s76
s_cmp_eq_u32 s77, 256
s_cbranch_scc0 mega_kernel_sycw
v_mov_b32 v252, v2
s_cmp_eq_u32 s78, 0
s_cbranch_scc0 mega_kernel_slowent
v_readlane_b32 s76, v2, 10
v_readlane_b32 s77, v2, 8
s_cmp_eq_u32 s76, 64
s_cbranch_scc0 mega_kernel_sycw
s_cmp_gt_u32 s77, 32
s_cselect_b32 s98, 1, 0
mega_kernel_sycd:
s_load_dwordx2 s[4:5], s[0:1], 16
s_load_dwordx2 s[8:9], s[0:1], 0
v_lshrrev_b32 v2, 6, v0
v_and_b32 v1, 63, v0
v_readfirstlane_b32 s41, v2
v_lshlrev_b32 v5, 4, v1
s_waitcnt lgkmcnt(0)
s_mov_b32 s6, 8388608
s_mov_b32 s7, 0x00020000
s_mov_b32 s10, 4194304
s_mov_b32 s11, 0x00020000
s_lshl_b32 s43, s40, 8
s_lshl_b32 s44, s41, 6
s_add_u32 s48, s43, s44
s_and_b32 s43, s48, 0x7ff
v_add_u32 v19, s43, v1
v_lshlrev_b32 v19, 7, v19
buffer_load_dword v250, v19, s[8:11], 0 offen
s_nop 0
v_lshrrev_b32 v2, 3, v1
s_lshl_b32 s43, s41, 3
v_add_u32 v2, s43, v2
v_bfe_u32 v3, v2, 1, 3
v_and_b32 v4, 7, v1
v_xor_b32 v3, v3, v4
v_lshlrev_b32 v6, 11, v2
v_lshl_add_u32 v6, v3, 4, v6
s_lshl_b32 s46, s41, 10
v_and_b32 v2, 15, v1
v_bfe_u32 v3, v2, 1, 3
v_lshrrev_b32 v4, 4, v1
v_xor_b32 v3, v3, v4
v_lshlrev_b32 v8, 7, v2
v_lshl_add_u32 v8, v3, 4, v8
v_xor_b32 v9, 64, v8
v_add_u32 v10, 0x10000, v8
v_add_u32 v11, 0x10000, v9
v_mov_b32 v7, v5
s_lshl_b32 s47, s40, 2
s_add_u32 s47, s47, s41
s_mov_b32 s42, 0
s_mov_b32 s50, 0
s_add_u32 m0, s46, 0
s_nop 0
buffer_load_dwordx4 v6, s[8:11], s50 offen offset:0 lds
s_add_u32 m0, s46, 3968
s_nop 0
buffer_load_dwordx4 v6, s[8:11], s50 offen offset:128 lds
s_add_u32 m0, s46, 7936
s_nop 0
buffer_load_dwordx4 v6, s[8:11], s50 offen offset:256 lds
s_add_u32 m0, s46, 11904
s_nop 0
buffer_load_dwordx4 v6, s[8:11], s50 offen offset:384 lds
s_add_u32 m0, s46, 15872
s_nop 0
buffer_load_dwordx4 v6, s[8:11], s50 offen offset:512 lds
s_add_u32 m0, s46, 19840
s_nop 0
buffer_load_dwordx4 v6, s[8:11], s50 offen offset:640 lds
s_add_u32 m0, s46, 23808
s_nop 0
buffer_load_dwordx4 v6, s[8:11], s50 offen offset:768 lds
s_add_u32 m0, s46, 27776
s_nop 0
buffer_load_dwordx4 v6, s[8:11], s50 offen offset:896 lds
s_add_u32 m0, s46, 31744
s_nop 0
buffer_load_dwordx4 v6, s[8:11], s50 offen offset:1024 lds
s_add_u32 m0, s46, 35712
s_nop 0
buffer_load_dwordx4 v6, s[8:11], s50 offen offset:1152 lds
s_add_u32 m0, s46, 39680
s_nop 0
buffer_load_dwordx4 v6, s[8:11], s50 offen offset:1280 lds
s_add_u32 m0, s46, 43648
s_nop 0
buffer_load_dwordx4 v6, s[8:11], s50 offen offset:1408 lds
s_add_u32 m0, s46, 47616
s_nop 0
buffer_load_dwordx4 v6, s[8:11], s50 offen offset:1536 lds
s_add_u32 m0, s46, 51584
s_nop 0
buffer_load_dwordx4 v6, s[8:11], s50 offen offset:1664 lds
s_add_u32 m0, s46, 55552
s_nop 0
buffer_load_dwordx4 v6, s[8:11], s50 offen offset:1792 lds
s_add_u32 m0, s46, 59520
s_nop 0
buffer_load_dwordx4 v6, s[8:11], s50 offen offset:1920 lds
v_lshrrev_b32 v2, 2, v1
v_and_b32 v3, 3, v1
v_lshlrev_b32 v16, 13, v2
v_lshl_add_u32 v16, v3, 4, v16
v_add_u32 v16, s48, v16
s_mul_i32 s45, s41, 24576
s_add_u32 s45, s45, 65536
v_bfe_u32 v17, v1, 2, 2
v_lshrrev_b32 v18, 4, v1
v_lshl_add_u32 v17, v18, 3, v17
v_lshlrev_b32 v17, 6, v17
v_lshl_add_u32 v17, v3, 4, v17
v_add_u32 v17, s45, v17
s_and_b32 s43, s40, 3
s_lshl_b32 s43, s43, 2
s_add_u32 s43, s43, s41
s_lshl_b32 s43, s43, 3
v_and_b32 v12, 7, v1
v_add_u32 v12, s43, v12
s_lshr_b32 s43, s40, 2
s_lshl_b32 s43, s43, 10
s_add_u32 s44, s43, 896
s_add_u32 s43, s43, 384
s_cmp_ge_u32 s40, 28
s_cselect_b32 s44, s44, s43
v_mov_b32 v13, s43
v_mov_b32 v14, s44
v_cmp_gt_u32 vcc, 32, v1
s_nop 1
v_cndmask_b32 v13, v14, v13, vcc
v_lshl_add_u32 v12, v12, 13, v13
s_mov_b32 s44, 0
buffer_load_dword v250, v12, s[4:7], s44 offen
s_add_u32 m0, s45, 0
s_mov_b32 s44, 0
buffer_load_dwordx4 v16, s[4:7], s44 offen lds
s_add_u32 m0, s45, 1024
s_mov_b32 s44, 131072
buffer_load_dwordx4 v16, s[4:7], s44 offen lds
s_add_u32 m0, s45, 2048
s_mov_b32 s44, 262144
buffer_load_dwordx4 v16, s[4:7], s44 offen lds
s_add_u32 m0, s45, 3072
s_mov_b32 s44, 393216
buffer_load_dwordx4 v16, s[4:7], s44 offen lds
s_add_u32 m0, s45, 4096
s_mov_b32 s44, 524288
buffer_load_dwordx4 v16, s[4:7], s44 offen lds
s_add_u32 m0, s45, 5120
s_mov_b32 s44, 655360
buffer_load_dwordx4 v16, s[4:7], s44 offen lds
s_add_u32 m0, s45, 6144
s_mov_b32 s44, 786432
buffer_load_dwordx4 v16, s[4:7], s44 offen lds
s_add_u32 m0, s45, 7168
s_mov_b32 s44, 917504
buffer_load_dwordx4 v16, s[4:7], s44 offen lds
s_mov_b32 s44, 1048576
buffer_load_dword v250, v12, s[4:7], s44 offen
s_add_u32 m0, s45, 8192
s_mov_b32 s44, 1048576
buffer_load_dwordx4 v16, s[4:7], s44 offen lds
s_add_u32 m0, s45, 9216
s_mov_b32 s44, 1179648
buffer_load_dwordx4 v16, s[4:7], s44 offen lds
s_add_u32 m0, s45, 10240
s_mov_b32 s44, 1310720
buffer_load_dwordx4 v16, s[4:7], s44 offen lds
s_add_u32 m0, s45, 11264
s_mov_b32 s44, 1441792
buffer_load_dwordx4 v16, s[4:7], s44 offen lds
s_add_u32 m0, s45, 12288
s_mov_b32 s44, 1572864
buffer_load_dwordx4 v16, s[4:7], s44 offen lds
s_add_u32 m0, s45, 13312
s_mov_b32 s44, 1703936
buffer_load_dwordx4 v16, s[4:7], s44 offen lds
s_add_u32 m0, s45, 14336
s_mov_b32 s44, 1835008
buffer_load_dwordx4 v16, s[4:7], s44 offen lds
s_add_u32 m0, s45, 15360
s_mov_b32 s44, 1966080
buffer_load_dwordx4 v16, s[4:7], s44 offen lds
s_mov_b32 s44, 2097152
buffer_load_dword v250, v12, s[4:7], s44 offen
s_add_u32 m0, s45, 16384
s_mov_b32 s44, 2097152
buffer_load_dwordx4 v16, s[4:7], s44 offen lds
s_add_u32 m0, s45, 17408
s_mov_b32 s44, 2228224
buffer_load_dwordx4 v16, s[4:7], s44 offen lds
s_add_u32 m0, s45, 18432
s_mov_b32 s44, 2359296
buffer_load_dwordx4 v16, s[4:7], s44 offen lds
s_add_u32 m0, s45, 19456
s_mov_b32 s44, 2490368
buffer_load_dwordx4 v16, s[4:7], s44 offen lds
s_add_u32 m0, s45, 20480
s_mov_b32 s44, 2621440
buffer_load_dwordx4 v16, s[4:7], s44 offen lds
s_add_u32 m0, s45, 21504
s_mov_b32 s44, 2752512
buffer_load_dwordx4 v16, s[4:7], s44 offen lds
s_add_u32 m0, s45, 22528
s_mov_b32 s44, 2883584
buffer_load_dwordx4 v16, s[4:7], s44 offen lds
s_add_u32 m0, s45, 23552
s_mov_b32 s44, 3014656
buffer_load_dwordx4 v16, s[4:7], s44 offen lds
s_waitcnt vmcnt(18)
s_barrier
ds_read_b64_tr_b16 a[0:1], v17 offset:0
ds_read_b64_tr_b16 a[2:3], v17 offset:256
ds_read_b64_tr_b16 a[4:5], v17 offset:8
ds_read_b64_tr_b16 a[6:7], v17 offset:264
ds_read_b64_tr_b16 a[8:9], v17 offset:2048
ds_read_b64_tr_b16 a[10:11], v17 offset:2304
ds_read_b64_tr_b16 a[12:13], v17 offset:2056
ds_read_b64_tr_b16 a[14:15], v17 offset:2312
s_waitcnt lgkmcnt(0)
ds_read_b64_tr_b16 a[16:17], v17 offset:4096
ds_read_b64_tr_b16 a[18:19], v17 offset:4352
ds_read_b64_tr_b16 a[20:21], v17 offset:4104
ds_read_b64_tr_b16 a[22:23], v17 offset:4360
ds_read_b64_tr_b16 a[24:25], v17 offset:6144
ds_read_b64_tr_b16 a[26:27], v17 offset:6400
ds_read_b64_tr_b16 a[28:29], v17 offset:6152
ds_read_b64_tr_b16 a[30:31], v17 offset:6408
s_waitcnt lgkmcnt(0)
ds_read_b128 v[20:23], v8 offset:0
ds_read_b128 v[24:27], v8 offset:2048
ds_read_b128 v[28:31], v9 offset:0
ds_read_b128 v[32:35], v9 offset:2048
ds_read_b128 v[36:39], v8 offset:4096
ds_read_b128 v[40:43], v8 offset:6144
ds_read_b128 v[44:47], v9 offset:4096
ds_read_b128 v[48:51], v9 offset:6144
s_mov_b32 s44, 3145728
buffer_load_dword v250, v12, s[4:7], s44 offen
s_add_u32 m0, s45, 0
s_mov_b32 s44, 3145728
buffer_load_dwordx4 v16, s[4:7], s44 offen lds
s_add_u32 m0, s45, 1024
s_mov_b32 s44, 3276800
buffer_load_dwordx4 v16, s[4:7], s44 offen lds
s_add_u32 m0, s45, 2048
s_mov_b32 s44, 3407872
buffer_load_dwordx4 v16, s[4:7], s44 offen lds
s_add_u32 m0, s45, 3072
s_mov_b32 s44, 3538944
buffer_load_dwordx4 v16, s[4:7], s44 offen lds
s_add_u32 m0, s45, 4096
s_mov_b32 s44, 3670016
buffer_load_dwordx4 v16, s[4:7], s44 offen lds
s_add_u32 m0, s45, 5120
s_mov_b32 s44, 3801088
buffer_load_dwordx4 v16, s[4:7], s44 offen lds
s_add_u32 m0, s45, 6144
s_mov_b32 s44, 3932160
buffer_load_dwordx4 v16, s[4:7], s44 offen lds
s_add_u32 m0, s45, 7168
s_mov_b32 s44, 4063232
buffer_load_dwordx4 v16, s[4:7], s44 offen lds
s_waitcnt lgkmcnt(0)
v_mfma_f32_16x16x32_bf16 v[52:55], a[0:3], v[20:23], 0
v_mfma_f32_16x16x32_bf16 v[56:59], a[4:7], v[20:23], 0
v_mfma_f32_16x16x32_bf16 v[60:63], a[0:3], v[24:27], 0
v_mfma_f32_16x16x32_bf16 v[64:67], a[4:7], v[24:27], 0
v_mfma_f32_16x16x32_bf16 v[52:55], a[8:11], v[28:31], v[52:55]
v_mfma_f32_16x16x32_bf16 v[56:59], a[12:15], v[28:31], v[56:59]
v_mfma_f32_16x16x32_bf16 v[60:63], a[8:11], v[32:35], v[60:63]
v_mfma_f32_16x16x32_bf16 v[64:67], a[12:15], v[32:35], v[64:67]
v_mfma_f32_16x16x32_bf16 v[52:55], a[16:19], v[36:39], v[52:55]
v_mfma_f32_16x16x32_bf16 v[56:59], a[20:23], v[36:39], v[56:59]
v_mfma_f32_16x16x32_bf16 v[60:63], a[16:19], v[40:43], v[60:63]
v_mfma_f32_16x16x32_bf16 v[64:67], a[20:23], v[40:43], v[64:67]
v_mfma_f32_16x16x32_bf16 v[52:55], a[24:27], v[44:47], v[52:55]
v_mfma_f32_16x16x32_bf16 v[56:59], a[28:31], v[44:47], v[56:59]
v_mfma_f32_16x16x32_bf16 v[60:63], a[24:27], v[48:51], v[60:63]
v_mfma_f32_16x16x32_bf16 v[64:67], a[28:31], v[48:51], v[64:67]
s_waitcnt vmcnt(18)
ds_read_b64_tr_b16 a[32:33], v17 offset:8192
ds_read_b64_tr_b16 a[34:35], v17 offset:8448
ds_read_b64_tr_b16 a[36:37], v17 offset:8200
ds_read_b64_tr_b16 a[38:39], v17 offset:8456
ds_read_b64_tr_b16 a[40:41], v17 offset:10240
ds_read_b64_tr_b16 a[42:43], v17 offset:10496
ds_read_b64_tr_b16 a[44:45], v17 offset:10248
ds_read_b64_tr_b16 a[46:47], v17 offset:10504
s_waitcnt lgkmcnt(0)
ds_read_b64_tr_b16 a[48:49], v17 offset:12288
ds_read_b64_tr_b16 a[50:51], v17 offset:12544
ds_read_b64_tr_b16 a[52:53], v17 offset:12296
ds_read_b64_tr_b16 a[54:55], v17 offset:12552
ds_read_b64_tr_b16 a[56:57], v17 offset:14336
ds_read_b64_tr_b16 a[58:59], v17 offset:14592
ds_read_b64_tr_b16 a[60:61], v17 offset:14344
ds_read_b64_tr_b16 a[62:63], v17 offset:14600
s_waitcnt lgkmcnt(0)
ds_read_b128 v[20:23], v8 offset:8192
ds_read_b128 v[24:27], v8 offset:10240
ds_read_b128 v[28:31], v9 offset:8192
ds_read_b128 v[32:35], v9 offset:10240
ds_read_b128 v[36:39], v8 offset:12288
ds_read_b128 v[40:43], v8 offset:14336
ds_read_b128 v[44:47], v9 offset:12288
ds_read_b128 v[48:51], v9 offset:14336
s_mov_b32 s44, 4194304
buffer_load_dword v250, v12, s[4:7], s44 offen
s_add_u32 m0, s45, 8192
s_mov_b32 s44, 4194304
buffer_load_dwordx4 v16, s[4:7], s44 offen lds
s_add_u32 m0, s45, 9216
s_mov_b32 s44, 4325376
buffer_load_dwordx4 v16, s[4:7], s44 offen lds
s_add_u32 m0, s45, 10240
s_mov_b32 s44, 4456448
buffer_load_dwordx4 v16, s[4:7], s44 offen lds
s_add_u32 m0, s45, 11264
s_mov_b32 s44, 4587520
buffer_load_dwordx4 v16, s[4:7], s44 offen lds
s_add_u32 m0, s45, 12288
s_mov_b32 s44, 4718592
buffer_load_dwordx4 v16, s[4:7], s44 offen lds
s_add_u32 m0, s45, 13312
s_mov_b32 s44, 4849664
buffer_load_dwordx4 v16, s[4:7], s44 offen lds
s_add_u32 m0, s45, 14336
s_mov_b32 s44, 4980736
buffer_load_dwordx4 v16, s[4:7], s44 offen lds
s_add_u32 m0, s45, 15360
s_mov_b32 s44, 5111808
buffer_load_dwordx4 v16, s[4:7], s44 offen lds
s_waitcnt lgkmcnt(0)
v_mfma_f32_16x16x32_bf16 v[52:55], a[32:35], v[20:23], v[52:55]
v_mfma_f32_16x16x32_bf16 v[56:59], a[36:39], v[20:23], v[56:59]
v_mfma_f32_16x16x32_bf16 v[60:63], a[32:35], v[24:27], v[60:63]
v_mfma_f32_16x16x32_bf16 v[64:67], a[36:39], v[24:27], v[64:67]
v_mfma_f32_16x16x32_bf16 v[52:55], a[40:43], v[28:31], v[52:55]
v_mfma_f32_16x16x32_bf16 v[56:59], a[44:47], v[28:31], v[56:59]
v_mfma_f32_16x16x32_bf16 v[60:63], a[40:43], v[32:35], v[60:63]
v_mfma_f32_16x16x32_bf16 v[64:67], a[44:47], v[32:35], v[64:67]
v_mfma_f32_16x16x32_bf16 v[52:55], a[48:51], v[36:39], v[52:55]
v_mfma_f32_16x16x32_bf16 v[56:59], a[52:55], v[36:39], v[56:59]
v_mfma_f32_16x16x32_bf16 v[60:63], a[48:51], v[40:43], v[60:63]
v_mfma_f32_16x16x32_bf16 v[64:67], a[52:55], v[40:43], v[64:67]
v_mfma_f32_16x16x32_bf16 v[52:55], a[56:59], v[44:47], v[52:55]
v_mfma_f32_16x16x32_bf16 v[56:59], a[60:63], v[44:47], v[56:59]
v_mfma_f32_16x16x32_bf16 v[60:63], a[56:59], v[48:51], v[60:63]
v_mfma_f32_16x16x32_bf16 v[64:67], a[60:63], v[48:51], v[64:67]
s_waitcnt vmcnt(18)
ds_read_b64_tr_b16 a[64:65], v17 offset:16384
ds_read_b64_tr_b16 a[66:67], v17 offset:16640
ds_read_b64_tr_b16 a[68:69], v17 offset:16392
ds_read_b64_tr_b16 a[70:71], v17 offset:16648
ds_read_b64_tr_b16 a[72:73], v17 offset:18432
ds_read_b64_tr_b16 a[74:75], v17 offset:18688
ds_read_b64_tr_b16 a[76:77], v17 offset:18440
ds_read_b64_tr_b16 a[78:79], v17 offset:18696
s_waitcnt lgkmcnt(0)
ds_read_b64_tr_b16 a[80:81], v17 offset:20480
ds_read_b64_tr_b16 a[82:83], v17 offset:20736
ds_read_b64_tr_b16 a[84:85], v17 offset:20488
ds_read_b64_tr_b16 a[86:87], v17 offset:20744
ds_read_b64_tr_b16 a[88:89], v17 offset:22528
ds_read_b64_tr_b16 a[90:91], v17 offset:22784
ds_read_b64_tr_b16 a[92:93], v17 offset:22536
ds_read_b64_tr_b16 a[94:95], v17 offset:22792
s_waitcnt lgkmcnt(0)
ds_read_b128 v[20:23], v8 offset:16384
ds_read_b128 v[24:27], v8 offset:18432
ds_read_b128 v[28:31], v9 offset:16384
ds_read_b128 v[32:35], v9 offset:18432
ds_read_b128 v[36:39], v8 offset:20480
ds_read_b128 v[40:43], v8 offset:22528
ds_read_b128 v[44:47], v9 offset:20480
ds_read_b128 v[48:51], v9 offset:22528
s_mov_b32 s44, 5242880
buffer_load_dword v250, v12, s[4:7], s44 offen
s_add_u32 m0, s45, 16384
s_mov_b32 s44, 5242880
buffer_load_dwordx4 v16, s[4:7], s44 offen lds
s_add_u32 m0, s45, 17408
s_mov_b32 s44, 5373952
buffer_load_dwordx4 v16, s[4:7], s44 offen lds
s_add_u32 m0, s45, 18432
s_mov_b32 s44, 5505024
buffer_load_dwordx4 v16, s[4:7], s44 offen lds
s_add_u32 m0, s45, 19456
s_mov_b32 s44, 5636096
buffer_load_dwordx4 v16, s[4:7], s44 offen lds
s_add_u32 m0, s45, 20480
s_mov_b32 s44, 5767168
buffer_load_dwordx4 v16, s[4:7], s44 offen lds
s_add_u32 m0, s45, 21504
s_mov_b32 s44, 5898240
buffer_load_dwordx4 v16, s[4:7], s44 offen lds
s_add_u32 m0, s45, 22528
s_mov_b32 s44, 6029312
buffer_load_dwordx4 v16, s[4:7], s44 offen lds
s_add_u32 m0, s45, 23552
s_mov_b32 s44, 6160384
buffer_load_dwordx4 v16, s[4:7], s44 offen lds
s_waitcnt lgkmcnt(0)
v_mfma_f32_16x16x32_bf16 v[52:55], a[64:67], v[20:23], v[52:55]
v_mfma_f32_16x16x32_bf16 v[56:59], a[68:71], v[20:23], v[56:59]
v_mfma_f32_16x16x32_bf16 v[60:63], a[64:67], v[24:27], v[60:63]
v_mfma_f32_16x16x32_bf16 v[64:67], a[68:71], v[24:27], v[64:67]
v_mfma_f32_16x16x32_bf16 v[52:55], a[72:75], v[28:31], v[52:55]
v_mfma_f32_16x16x32_bf16 v[56:59], a[76:79], v[28:31], v[56:59]
v_mfma_f32_16x16x32_bf16 v[60:63], a[72:75], v[32:35], v[60:63]
v_mfma_f32_16x16x32_bf16 v[64:67], a[76:79], v[32:35], v[64:67]
v_mfma_f32_16x16x32_bf16 v[52:55], a[80:83], v[36:39], v[52:55]
v_mfma_f32_16x16x32_bf16 v[56:59], a[84:87], v[36:39], v[56:59]
v_mfma_f32_16x16x32_bf16 v[60:63], a[80:83], v[40:43], v[60:63]
v_mfma_f32_16x16x32_bf16 v[64:67], a[84:87], v[40:43], v[64:67]
v_mfma_f32_16x16x32_bf16 v[52:55], a[88:91], v[44:47], v[52:55]
v_mfma_f32_16x16x32_bf16 v[56:59], a[92:95], v[44:47], v[56:59]
v_mfma_f32_16x16x32_bf16 v[60:63], a[88:91], v[48:51], v[60:63]
v_mfma_f32_16x16x32_bf16 v[64:67], a[92:95], v[48:51], v[64:67]
s_waitcnt vmcnt(18)
ds_read_b64_tr_b16 a[96:97], v17 offset:0
ds_read_b64_tr_b16 a[98:99], v17 offset:256
ds_read_b64_tr_b16 a[100:101], v17 offset:8
ds_read_b64_tr_b16 a[102:103], v17 offset:264
ds_read_b64_tr_b16 a[104:105], v17 offset:2048
ds_read_b64_tr_b16 a[106:107], v17 offset:2304
ds_read_b64_tr_b16 a[108:109], v17 offset:2056
ds_read_b64_tr_b16 a[110:111], v17 offset:2312
s_waitcnt lgkmcnt(0)
ds_read_b64_tr_b16 a[112:113], v17 offset:4096
ds_read_b64_tr_b16 a[114:115], v17 offset:4352
ds_read_b64_tr_b16 a[116:117], v17 offset:4104
ds_read_b64_tr_b16 a[118:119], v17 offset:4360
ds_read_b64_tr_b16 a[120:121], v17 offset:6144
ds_read_b64_tr_b16 a[122:123], v17 offset:6400
ds_read_b64_tr_b16 a[124:125], v17 offset:6152
ds_read_b64_tr_b16 a[126:127], v17 offset:6408
s_waitcnt lgkmcnt(0)
ds_read_b128 v[20:23], v8 offset:24576
ds_read_b128 v[24:27], v8 offset:26624
ds_read_b128 v[28:31], v9 offset:24576
ds_read_b128 v[32:35], v9 offset:26624
ds_read_b128 v[36:39], v8 offset:28672
ds_read_b128 v[40:43], v8 offset:30720
ds_read_b128 v[44:47], v9 offset:28672
ds_read_b128 v[48:51], v9 offset:30720
s_mov_b32 s44, 6291456
buffer_load_dword v250, v12, s[4:7], s44 offen
s_add_u32 m0, s45, 0
s_mov_b32 s44, 6291456
buffer_load_dwordx4 v16, s[4:7], s44 offen lds
s_add_u32 m0, s45, 1024
s_mov_b32 s44, 6422528
buffer_load_dwordx4 v16, s[4:7], s44 offen lds
s_add_u32 m0, s45, 2048
s_mov_b32 s44, 6553600
buffer_load_dwordx4 v16, s[4:7], s44 offen lds
s_add_u32 m0, s45, 3072
s_mov_b32 s44, 6684672
buffer_load_dwordx4 v16, s[4:7], s44 offen lds
s_add_u32 m0, s45, 4096
s_mov_b32 s44, 6815744
buffer_load_dwordx4 v16, s[4:7], s44 offen lds
s_add_u32 m0, s45, 5120
s_mov_b32 s44, 6946816
buffer_load_dwordx4 v16, s[4:7], s44 offen lds
s_add_u32 m0, s45, 6144
s_mov_b32 s44, 7077888
buffer_load_dwordx4 v16, s[4:7], s44 offen lds
s_add_u32 m0, s45, 7168
s_mov_b32 s44, 7208960
buffer_load_dwordx4 v16, s[4:7], s44 offen lds
s_waitcnt lgkmcnt(0)
v_mfma_f32_16x16x32_bf16 v[52:55], a[96:99], v[20:23], v[52:55]
v_mfma_f32_16x16x32_bf16 v[56:59], a[100:103], v[20:23], v[56:59]
v_mfma_f32_16x16x32_bf16 v[60:63], a[96:99], v[24:27], v[60:63]
v_mfma_f32_16x16x32_bf16 v[64:67], a[100:103], v[24:27], v[64:67]
v_mfma_f32_16x16x32_bf16 v[52:55], a[104:107], v[28:31], v[52:55]
v_mfma_f32_16x16x32_bf16 v[56:59], a[108:111], v[28:31], v[56:59]
v_mfma_f32_16x16x32_bf16 v[60:63], a[104:107], v[32:35], v[60:63]
v_mfma_f32_16x16x32_bf16 v[64:67], a[108:111], v[32:35], v[64:67]
v_mfma_f32_16x16x32_bf16 v[52:55], a[112:115], v[36:39], v[52:55]
v_mfma_f32_16x16x32_bf16 v[56:59], a[116:119], v[36:39], v[56:59]
v_mfma_f32_16x16x32_bf16 v[60:63], a[112:115], v[40:43], v[60:63]
v_mfma_f32_16x16x32_bf16 v[64:67], a[116:119], v[40:43], v[64:67]
v_mfma_f32_16x16x32_bf16 v[52:55], a[120:123], v[44:47], v[52:55]
v_mfma_f32_16x16x32_bf16 v[56:59], a[124:127], v[44:47], v[56:59]
v_mfma_f32_16x16x32_bf16 v[60:63], a[120:123], v[48:51], v[60:63]
v_mfma_f32_16x16x32_bf16 v[64:67], a[124:127], v[48:51], v[64:67]
s_waitcnt vmcnt(18)
ds_read_b64_tr_b16 a[128:129], v17 offset:8192
ds_read_b64_tr_b16 a[130:131], v17 offset:8448
ds_read_b64_tr_b16 a[132:133], v17 offset:8200
ds_read_b64_tr_b16 a[134:135], v17 offset:8456
ds_read_b64_tr_b16 a[136:137], v17 offset:10240
ds_read_b64_tr_b16 a[138:139], v17 offset:10496
ds_read_b64_tr_b16 a[140:141], v17 offset:10248
ds_read_b64_tr_b16 a[142:143], v17 offset:10504
s_waitcnt lgkmcnt(0)
ds_read_b64_tr_b16 a[144:145], v17 offset:12288
ds_read_b64_tr_b16 a[146:147], v17 offset:12544
ds_read_b64_tr_b16 a[148:149], v17 offset:12296
ds_read_b64_tr_b16 a[150:151], v17 offset:12552
ds_read_b64_tr_b16 a[152:153], v17 offset:14336
ds_read_b64_tr_b16 a[154:155], v17 offset:14592
ds_read_b64_tr_b16 a[156:157], v17 offset:14344
ds_read_b64_tr_b16 a[158:159], v17 offset:14600
s_waitcnt lgkmcnt(0)
ds_read_b128 v[20:23], v8 offset:32768
ds_read_b128 v[24:27], v8 offset:34816
ds_read_b128 v[28:31], v9 offset:32768
ds_read_b128 v[32:35], v9 offset:34816
ds_read_b128 v[36:39], v8 offset:36864
ds_read_b128 v[40:43], v8 offset:38912
ds_read_b128 v[44:47], v9 offset:36864
ds_read_b128 v[48:51], v9 offset:38912
s_mov_b32 s44, 7340032
buffer_load_dword v250, v12, s[4:7], s44 offen
s_add_u32 m0, s45, 8192
s_mov_b32 s44, 7340032
buffer_load_dwordx4 v16, s[4:7], s44 offen lds
s_add_u32 m0, s45, 9216
s_mov_b32 s44, 7471104
buffer_load_dwordx4 v16, s[4:7], s44 offen lds
s_add_u32 m0, s45, 10240
s_mov_b32 s44, 7602176
buffer_load_dwordx4 v16, s[4:7], s44 offen lds
s_add_u32 m0, s45, 11264
s_mov_b32 s44, 7733248
buffer_load_dwordx4 v16, s[4:7], s44 offen lds
s_add_u32 m0, s45, 12288
s_mov_b32 s44, 7864320
buffer_load_dwordx4 v16, s[4:7], s44 offen lds
s_add_u32 m0, s45, 13312
s_mov_b32 s44, 7995392
buffer_load_dwordx4 v16, s[4:7], s44 offen lds
s_add_u32 m0, s45, 14336
s_mov_b32 s44, 8126464
buffer_load_dwordx4 v16, s[4:7], s44 offen lds
s_add_u32 m0, s45, 15360
s_mov_b32 s44, 8257536
buffer_load_dwordx4 v16, s[4:7], s44 offen lds
s_waitcnt lgkmcnt(0)
v_mfma_f32_16x16x32_bf16 v[52:55], a[128:131], v[20:23], v[52:55]
v_mfma_f32_16x16x32_bf16 v[56:59], a[132:135], v[20:23], v[56:59]
v_mfma_f32_16x16x32_bf16 v[60:63], a[128:131], v[24:27], v[60:63]
v_mfma_f32_16x16x32_bf16 v[64:67], a[132:135], v[24:27], v[64:67]
v_mfma_f32_16x16x32_bf16 v[52:55], a[136:139], v[28:31], v[52:55]
v_mfma_f32_16x16x32_bf16 v[56:59], a[140:143], v[28:31], v[56:59]
v_mfma_f32_16x16x32_bf16 v[60:63], a[136:139], v[32:35], v[60:63]
v_mfma_f32_16x16x32_bf16 v[64:67], a[140:143], v[32:35], v[64:67]
v_mfma_f32_16x16x32_bf16 v[52:55], a[144:147], v[36:39], v[52:55]
v_mfma_f32_16x16x32_bf16 v[56:59], a[148:151], v[36:39], v[56:59]
v_mfma_f32_16x16x32_bf16 v[60:63], a[144:147], v[40:43], v[60:63]
v_mfma_f32_16x16x32_bf16 v[64:67], a[148:151], v[40:43], v[64:67]
v_mfma_f32_16x16x32_bf16 v[52:55], a[152:155], v[44:47], v[52:55]
v_mfma_f32_16x16x32_bf16 v[56:59], a[156:159], v[44:47], v[56:59]
v_mfma_f32_16x16x32_bf16 v[60:63], a[152:155], v[48:51], v[60:63]
v_mfma_f32_16x16x32_bf16 v[64:67], a[156:159], v[48:51], v[64:67]
s_waitcnt vmcnt(18)
ds_read_b64_tr_b16 a[160:161], v17 offset:16384
ds_read_b64_tr_b16 a[162:163], v17 offset:16640
ds_read_b64_tr_b16 a[164:165], v17 offset:16392
ds_read_b64_tr_b16 a[166:167], v17 offset:16648
ds_read_b64_tr_b16 a[168:169], v17 offset:18432
ds_read_b64_tr_b16 a[170:171], v17 offset:18688
ds_read_b64_tr_b16 a[172:173], v17 offset:18440
ds_read_b64_tr_b16 a[174:175], v17 offset:18696
s_waitcnt lgkmcnt(0)
ds_read_b64_tr_b16 a[176:177], v17 offset:20480
ds_read_b64_tr_b16 a[178:179], v17 offset:20736
ds_read_b64_tr_b16 a[180:181], v17 offset:20488
ds_read_b64_tr_b16 a[182:183], v17 offset:20744
ds_read_b64_tr_b16 a[184:185], v17 offset:22528
ds_read_b64_tr_b16 a[186:187], v17 offset:22784
ds_read_b64_tr_b16 a[188:189], v17 offset:22536
ds_read_b64_tr_b16 a[190:191], v17 offset:22792
s_waitcnt lgkmcnt(0)
ds_read_b128 v[20:23], v8 offset:40960
ds_read_b128 v[24:27], v8 offset:43008
ds_read_b128 v[28:31], v9 offset:40960
ds_read_b128 v[32:35], v9 offset:43008
ds_read_b128 v[36:39], v8 offset:45056
ds_read_b128 v[40:43], v8 offset:47104
ds_read_b128 v[44:47], v9 offset:45056
ds_read_b128 v[48:51], v9 offset:47104
s_waitcnt lgkmcnt(0)
v_mfma_f32_16x16x32_bf16 v[52:55], a[160:163], v[20:23], v[52:55]
v_mfma_f32_16x16x32_bf16 v[56:59], a[164:167], v[20:23], v[56:59]
v_mfma_f32_16x16x32_bf16 v[60:63], a[160:163], v[24:27], v[60:63]
v_mfma_f32_16x16x32_bf16 v[64:67], a[164:167], v[24:27], v[64:67]
v_mfma_f32_16x16x32_bf16 v[52:55], a[168:171], v[28:31], v[52:55]
v_mfma_f32_16x16x32_bf16 v[56:59], a[172:175], v[28:31], v[56:59]
v_mfma_f32_16x16x32_bf16 v[60:63], a[168:171], v[32:35], v[60:63]
v_mfma_f32_16x16x32_bf16 v[64:67], a[172:175], v[32:35], v[64:67]
v_mfma_f32_16x16x32_bf16 v[52:55], a[176:179], v[36:39], v[52:55]
v_mfma_f32_16x16x32_bf16 v[56:59], a[180:183], v[36:39], v[56:59]
v_mfma_f32_16x16x32_bf16 v[60:63], a[176:179], v[40:43], v[60:63]
v_mfma_f32_16x16x32_bf16 v[64:67], a[180:183], v[40:43], v[64:67]
v_mfma_f32_16x16x32_bf16 v[52:55], a[184:187], v[44:47], v[52:55]
v_mfma_f32_16x16x32_bf16 v[56:59], a[188:191], v[44:47], v[56:59]
v_mfma_f32_16x16x32_bf16 v[60:63], a[184:187], v[48:51], v[60:63]
v_mfma_f32_16x16x32_bf16 v[64:67], a[188:191], v[48:51], v[64:67]
s_waitcnt vmcnt(9)
ds_read_b64_tr_b16 a[192:193], v17 offset:0
ds_read_b64_tr_b16 a[194:195], v17 offset:256
ds_read_b64_tr_b16 a[196:197], v17 offset:8
ds_read_b64_tr_b16 a[198:199], v17 offset:264
ds_read_b64_tr_b16 a[200:201], v17 offset:2048
ds_read_b64_tr_b16 a[202:203], v17 offset:2304
ds_read_b64_tr_b16 a[204:205], v17 offset:2056
ds_read_b64_tr_b16 a[206:207], v17 offset:2312
s_waitcnt lgkmcnt(0)
ds_read_b64_tr_b16 a[208:209], v17 offset:4096
ds_read_b64_tr_b16 a[210:211], v17 offset:4352
ds_read_b64_tr_b16 a[212:213], v17 offset:4104
ds_read_b64_tr_b16 a[214:215], v17 offset:4360
ds_read_b64_tr_b16 a[216:217], v17 offset:6144
ds_read_b64_tr_b16 a[218:219], v17 offset:6400
ds_read_b64_tr_b16 a[220:221], v17 offset:6152
ds_read_b64_tr_b16 a[222:223], v17 offset:6408
s_waitcnt lgkmcnt(0)
ds_read_b128 v[20:23], v8 offset:49152
ds_read_b128 v[24:27], v8 offset:51200
ds_read_b128 v[28:31], v9 offset:49152
ds_read_b128 v[32:35], v9 offset:51200
ds_read_b128 v[36:39], v8 offset:53248
ds_read_b128 v[40:43], v8 offset:55296
ds_read_b128 v[44:47], v9 offset:53248
ds_read_b128 v[48:51], v9 offset:55296
s_waitcnt lgkmcnt(0)
v_mfma_f32_16x16x32_bf16 v[52:55], a[192:195], v[20:23], v[52:55]
v_mfma_f32_16x16x32_bf16 v[56:59], a[196:199], v[20:23], v[56:59]
v_mfma_f32_16x16x32_bf16 v[60:63], a[192:195], v[24:27], v[60:63]
v_mfma_f32_16x16x32_bf16 v[64:67], a[196:199], v[24:27], v[64:67]
v_mfma_f32_16x16x32_bf16 v[52:55], a[200:203], v[28:31], v[52:55]
v_mfma_f32_16x16x32_bf16 v[56:59], a[204:207], v[28:31], v[56:59]
v_mfma_f32_16x16x32_bf16 v[60:63], a[200:203], v[32:35], v[60:63]
v_mfma_f32_16x16x32_bf16 v[64:67], a[204:207], v[32:35], v[64:67]
v_mfma_f32_16x16x32_bf16 v[52:55], a[208:211], v[36:39], v[52:55]
v_mfma_f32_16x16x32_bf16 v[56:59], a[212:215], v[36:39], v[56:59]
v_mfma_f32_16x16x32_bf16 v[60:63], a[208:211], v[40:43], v[60:63]
v_mfma_f32_16x16x32_bf16 v[64:67], a[212:215], v[40:43], v[64:67]
v_mfma_f32_16x16x32_bf16 v[52:55], a[216:219], v[44:47], v[52:55]
v_mfma_f32_16x16x32_bf16 v[56:59], a[220:223], v[44:47], v[56:59]
v_mfma_f32_16x16x32_bf16 v[60:63], a[216:219], v[48:51], v[60:63]
v_mfma_f32_16x16x32_bf16 v[64:67], a[220:223], v[48:51], v[64:67]
s_waitcnt vmcnt(0)
ds_read_b64_tr_b16 a[224:225], v17 offset:8192
ds_read_b64_tr_b16 a[226:227], v17 offset:8448
ds_read_b64_tr_b16 a[228:229], v17 offset:8200
ds_read_b64_tr_b16 a[230:231], v17 offset:8456
ds_read_b64_tr_b16 a[232:233], v17 offset:10240
ds_read_b64_tr_b16 a[234:235], v17 offset:10496
ds_read_b64_tr_b16 a[236:237], v17 offset:10248
ds_read_b64_tr_b16 a[238:239], v17 offset:10504
s_waitcnt lgkmcnt(0)
ds_read_b64_tr_b16 a[240:241], v17 offset:12288
ds_read_b64_tr_b16 a[242:243], v17 offset:12544
ds_read_b64_tr_b16 a[244:245], v17 offset:12296
ds_read_b64_tr_b16 a[246:247], v17 offset:12552
ds_read_b64_tr_b16 a[248:249], v17 offset:14336
ds_read_b64_tr_b16 a[250:251], v17 offset:14592
ds_read_b64_tr_b16 a[252:253], v17 offset:14344
ds_read_b64_tr_b16 a[254:255], v17 offset:14600
s_waitcnt lgkmcnt(0)
ds_read_b128 v[20:23], v8 offset:57344
ds_read_b128 v[24:27], v8 offset:59392
ds_read_b128 v[28:31], v9 offset:57344
ds_read_b128 v[32:35], v9 offset:59392
ds_read_b128 v[36:39], v8 offset:61440
ds_read_b128 v[40:43], v8 offset:63488
ds_read_b128 v[44:47], v9 offset:61440
ds_read_b128 v[48:51], v9 offset:63488
s_waitcnt lgkmcnt(0)
v_mfma_f32_16x16x32_bf16 v[52:55], a[224:227], v[20:23], v[52:55]
v_mfma_f32_16x16x32_bf16 v[56:59], a[228:231], v[20:23], v[56:59]
v_mfma_f32_16x16x32_bf16 v[60:63], a[224:227], v[24:27], v[60:63]
v_mfma_f32_16x16x32_bf16 v[64:67], a[228:231], v[24:27], v[64:67]
v_mfma_f32_16x16x32_bf16 v[52:55], a[232:235], v[28:31], v[52:55]
v_mfma_f32_16x16x32_bf16 v[56:59], a[236:239], v[28:31], v[56:59]
v_mfma_f32_16x16x32_bf16 v[60:63], a[232:235], v[32:35], v[60:63]
v_mfma_f32_16x16x32_bf16 v[64:67], a[236:239], v[32:35], v[64:67]
v_mfma_f32_16x16x32_bf16 v[52:55], a[240:243], v[36:39], v[52:55]
v_mfma_f32_16x16x32_bf16 v[56:59], a[244:247], v[36:39], v[56:59]
v_mfma_f32_16x16x32_bf16 v[60:63], a[240:243], v[40:43], v[60:63]
v_mfma_f32_16x16x32_bf16 v[64:67], a[244:247], v[40:43], v[64:67]
v_mfma_f32_16x16x32_bf16 v[52:55], a[248:251], v[44:47], v[52:55]
v_mfma_f32_16x16x32_bf16 v[56:59], a[252:255], v[44:47], v[56:59]
v_mfma_f32_16x16x32_bf16 v[60:63], a[248:251], v[48:51], v[60:63]
v_mfma_f32_16x16x32_bf16 v[64:67], a[252:255], v[48:51], v[64:67]
s_barrier
s_mov_b32 s50, 0x10000
s_add_u32 m0, s46, 65536
s_nop 0
buffer_load_dwordx4 v6, s[8:11], s50 offen offset:0 lds
s_add_u32 m0, s46, 69504
s_nop 0
buffer_load_dwordx4 v6, s[8:11], s50 offen offset:128 lds
s_add_u32 m0, s46, 73472
s_nop 0
buffer_load_dwordx4 v6, s[8:11], s50 offen offset:256 lds
s_add_u32 m0, s46, 77440
s_nop 0
buffer_load_dwordx4 v6, s[8:11], s50 offen offset:384 lds
s_add_u32 m0, s46, 81408
s_nop 0
buffer_load_dwordx4 v6, s[8:11], s50 offen offset:512 lds
s_add_u32 m0, s46, 85376
s_nop 0
buffer_load_dwordx4 v6, s[8:11], s50 offen offset:640 lds
s_add_u32 m0, s46, 89344
s_nop 0
buffer_load_dwordx4 v6, s[8:11], s50 offen offset:768 lds
s_add_u32 m0, s46, 93312
s_nop 0
buffer_load_dwordx4 v6, s[8:11], s50 offen offset:896 lds
s_add_u32 m0, s46, 97280
s_nop 0
buffer_load_dwordx4 v6, s[8:11], s50 offen offset:1024 lds
s_add_u32 m0, s46, 101248
s_nop 0
buffer_load_dwordx4 v6, s[8:11], s50 offen offset:1152 lds
s_add_u32 m0, s46, 105216
s_nop 0
buffer_load_dwordx4 v6, s[8:11], s50 offen offset:1280 lds
s_add_u32 m0, s46, 109184
s_nop 0
buffer_load_dwordx4 v6, s[8:11], s50 offen offset:1408 lds
s_add_u32 m0, s46, 113152
s_nop 0
buffer_load_dwordx4 v6, s[8:11], s50 offen offset:1536 lds
s_add_u32 m0, s46, 117120
s_nop 0
buffer_load_dwordx4 v6, s[8:11], s50 offen offset:1664 lds
s_add_u32 m0, s46, 121088
s_nop 0
buffer_load_dwordx4 v6, s[8:11], s50 offen offset:1792 lds
s_add_u32 m0, s46, 125056
s_nop 0
buffer_load_dwordx4 v6, s[8:11], s50 offen offset:1920 lds
v_lshrrev_b32 v92, 4, v1
v_and_b32 v93, 15, v1
s_and_b32 s52, s41, 1
s_lshr_b32 s53, s41, 1
s_mov_b32 s54, 0x3e0293ee
s_mov_b32 s55, 0
s_mov_b32 s56, 0
v_mov_b32 v97, 0xff7fffff
v_and_b32 v2, 7, v93
v_lshlrev_b32 v94, 7, v92
v_lshl_add_u32 v94, v2, 4, v94
v_and_b32 v2, 31, v1
v_lshlrev_b32 v95, 3, v2
v_lshrrev_b32 v2, 1, v92
v_lshlrev_b32 v96, 10, v2
v_and_b32 v2, 1, v92
v_lshl_add_u32 v96, v2, 9, v96
v_lshl_add_u32 v96, v93, 4, v96
s_lshl_b32 s43, s40, 13
s_lshl_b32 s44, s53, 12
s_add_u32 s43, s43, s44
s_lshl_b32 s44, s52, 8
s_add_u32 s43, s43, s44
s_add_u32 s43, s43, 134217728
v_add_u32 v96, s43, v96
s_lshl_b32 s43, s52, 4
v_add_u32 v98, s43, v93
v_lshlrev_b32 v2, 2, v92
v_sub_u32 v98, v98, v2
s_mov_b32 s28, 0
s_mov_b32 s29, -1
s_xor_b32 s44, s98, 1
s_lshl_b32 s44, s44, 13
s_lshl_b32 s43, s40, 7
s_add_u32 s43, s43, s44
s_add_u32 s43, s43, 69206016
v_and_b32 v2, 3, v1
v_bfe_u32 v3, v1, 2, 1
v_lshlrev_b32 v99, 12, v3
v_lshl_add_u32 v99, v2, 2, v99
v_add_u32 v99, s43, v99
s_xor_b32 s62, s98, 1
s_lshl_b32 s62, s62, 13
s_lshr_b32 s44, s47, 6
s_lshl_b32 s44, s44, 14
s_add_u32 s62, s62, s44
s_and_b32 s44, s47, 63
s_lshl_b32 s44, s44, 7
s_add_u32 s62, s62, s44
s_add_u32 s62, s62, 69222400
s_lshl_b32 s49, s40, 7
s_lshl_b32 s44, s41, 2
s_add_u32 s49, s49, s44
s_lshl_b32 s44, s98, 13
s_add_u32 s49, s49, s44
s_add_u32 s49, s49, 69255168
s_lshl_b32 s43, s41, 11
s_add_u32 s43, s43, 131072
v_add_u32 v101, s43, v7
s_lshl_b32 s43, s52, 10
s_add_u32 s43, s43, 131072
v_add_u32 v102, s43, v5
v_mov_b32 v16, 0
s_mov_b32 s50, 0
v_mov_b32 v104, 0x3f803f80
v_mov_b32 v105, 0x3f803f80
v_mov_b32 v106, 0x3f803f80
v_mov_b32 v107, 0x3f803f80
v_cmp_gt_i32 s[12:13], 0, v98
v_cmp_gt_i32 s[14:15], 1, v98
v_cmp_gt_i32 s[16:17], 2, v98
v_cmp_gt_i32 s[18:19], 3, v98
v_cmp_gt_i32 s[20:21], 16, v98
v_cmp_gt_i32 s[22:23], 17, v98
v_cmp_gt_i32 s[24:25], 18, v98
v_cmp_gt_i32 s[26:27], 19, v98
s_lshr_b32 s44, s47, 3
s_xor_b32 s44, s44, s98
s_and_b32 s44, s44, 1
s_lshl_b32 s44, s44, 13
s_lshl_b32 s58, s47, 18
s_add_u32 s58, s58, s44
s_add_u32 s58, s58, 0
s_lshr_b32 s44, s47, 4
s_xor_b32 s44, s44, s98
s_and_b32 s44, s44, 1
s_lshl_b32 s44, s44, 13
s_lshl_b32 s59, s47, 17
s_add_u32 s59, s59, s44
s_add_u32 s59, s59, 71303168
s_lshl_b32 s60, s41, 11
s_add_u32 s60, s60, 139264
s_lshl_b32 s61, s41, 10
s_add_u32 s61, s61, 155648
v_add_u32 v94, 155648, v94
s_lshl_b32 s43, s53, 11
s_add_u32 s43, s43, 156160
v_add_u32 v95, s43, v95
v_add_u32 v103, 139264, v5
s_lshl_b32 s43, s53, 12
s_add_u32 s43, s43, 147456
v_add_u32 v240, s43, v5
s_waitcnt vmcnt(0)
v_mov_b32 v68, v52
v_mov_b32 v69, v53
v_mov_b32 v70, v54
v_mov_b32 v71, v55
v_mov_b32 v72, v56
v_mov_b32 v73, v57
v_mov_b32 v74, v58
v_mov_b32 v75, v59
v_mov_b32 v76, v60
v_mov_b32 v77, v61
v_mov_b32 v78, v62
v_mov_b32 v79, v63
v_mov_b32 v80, v64
v_mov_b32 v81, v65
v_mov_b32 v82, v66
v_mov_b32 v83, v67
mega_kernel_q_loop:
s_barrier
s_cmp_gt_i32 s55, s42
s_cbranch_scc1 mega_kernel_q_kv1k
mega_kernel_q_kv1w:
buffer_load_dword v2, v99, s[84:87], 0 offen sc1
s_waitcnt vmcnt(0)
v_min_i32_dpp v2, v2, v2 quad_perm:[1,0,3,2] row_mask:0xf bank_mask:0xf
s_nop 1
v_min_i32_dpp v2, v2, v2 quad_perm:[2,3,0,1] row_mask:0xf bank_mask:0xf
s_nop 1
v_min_i32_dpp v2, v2, v2 row_ror:4 row_mask:0xf bank_mask:0xf
s_nop 0
v_readfirstlane_b32 s55, v2
s_cmp_gt_i32 s55, s42
s_cbranch_scc1 mega_kernel_q_kv1k
s_sleep 4
s_branch mega_kernel_q_kv1w
mega_kernel_q_kv1k:
ds_read_b128 v[20:23], v10 offset:0
ds_read_b128 v[24:27], v10 offset:2048
ds_read_b128 v[28:31], v11 offset:0
ds_read_b128 v[32:35], v11 offset:2048
ds_read_b128 v[36:39], v10 offset:4096
ds_read_b128 v[40:43], v10 offset:6144
s_add_u32 s51, s47, s42
s_bfe_u32 s57, s51, 0x40002
s_lshl_b32 s57, s57, 14
s_and_b32 s66, s51, 3
s_lshl_b32 s66, s66, 11
s_add_u32 s66, s66, s57
s_add_u32 s66, s66, s58
s_add_u32 s67, s66, 33554432
s_bfe_u32 s57, s51, 0x30003
s_lshl_b32 s57, s57, 14
s_and_b32 s68, s51, 7
s_lshl_b32 s68, s68, 10
s_add_u32 s68, s68, s57
s_add_u32 s68, s68, s59
s_add_u32 s50, s42, 2
s_min_u32 s50, s50, 63
s_lshl_b32 s50, s50, 16
s_cmp_gt_i32 s56, s42
s_cselect_b32 s30, 1, 0
s_add_u32 m0, s60, 0
s_waitcnt lgkmcnt(4)
v_mfma_f32_16x16x32_bf16 v[52:55], a[0:3], v[20:23], 0
ds_read_b128 v[44:47], v11 offset:4096
v_mfma_f32_16x16x32_bf16 v[56:59], a[4:7], v[20:23], 0
buffer_load_dwordx4 v5, s[84:87], s66 offen offset:0 sc1 lds
v_mfma_f32_16x16x32_bf16 v[60:63], a[0:3], v[24:27], 0
ds_read_b128 v[48:51], v11 offset:6144
v_mfma_f32_16x16x32_bf16 v[64:67], a[4:7], v[24:27], 0
s_add_u32 m0, s60, 0
s_waitcnt lgkmcnt(4)
v_mfma_f32_16x16x32_bf16 v[52:55], a[8:11], v[28:31], v[52:55]
ds_read_b128 v[20:23], v10 offset:8192
v_mfma_f32_16x16x32_bf16 v[56:59], a[12:15], v[28:31], v[56:59]
buffer_load_dwordx4 v5, s[84:87], s66 offen offset:1024 sc1 lds
v_mfma_f32_16x16x32_bf16 v[60:63], a[8:11], v[32:35], v[60:63]
ds_read_b128 v[24:27], v10 offset:10240
v_mfma_f32_16x16x32_bf16 v[64:67], a[12:15], v[32:35], v[64:67]
s_add_u32 m0, s60, 8192
s_waitcnt lgkmcnt(4)
v_mfma_f32_16x16x32_bf16 v[52:55], a[16:19], v[36:39], v[52:55]
ds_read_b128 v[28:31], v11 offset:8192
v_mfma_f32_16x16x32_bf16 v[56:59], a[20:23], v[36:39], v[56:59]
buffer_load_dwordx4 v5, s[84:87], s67 offen offset:0 sc1 lds
v_mfma_f32_16x16x32_bf16 v[60:63], a[16:19], v[40:43], v[60:63]
ds_read_b128 v[32:35], v11 offset:10240
v_mfma_f32_16x16x32_bf16 v[64:67], a[20:23], v[40:43], v[64:67]
s_add_u32 m0, s60, 8192
s_waitcnt lgkmcnt(4)
v_mfma_f32_16x16x32_bf16 v[52:55], a[24:27], v[44:47], v[52:55]
ds_read_b128 v[36:39], v10 offset:12288
v_mfma_f32_16x16x32_bf16 v[56:59], a[28:31], v[44:47], v[56:59]
buffer_load_dwordx4 v5, s[84:87], s67 offen offset:1024 sc1 lds
v_mfma_f32_16x16x32_bf16 v[60:63], a[24:27], v[48:51], v[60:63]
ds_read_b128 v[40:43], v10 offset:14336
v_mfma_f32_16x16x32_bf16 v[64:67], a[28:31], v[48:51], v[64:67]
s_waitcnt lgkmcnt(4)
v_mfma_f32_16x16x32_bf16 v[52:55], a[32:35], v[20:23], v[52:55]
ds_read_b128 v[44:47], v11 offset:12288
v_mfma_f32_16x16x32_bf16 v[56:59], a[36:39], v[20:23], v[56:59]
s_cmp_eq_u32 s30, 1
s_cbranch_scc0 mega_kernel_q_ke1
s_mov_b32 m0, s61
s_nop 0
buffer_load_dwordx4 v5, s[84:87], s68 offen sc1 lds
mega_kernel_q_ke1:
v_mfma_f32_16x16x32_bf16 v[60:63], a[32:35], v[24:27], v[60:63]
ds_read_b128 v[48:51], v11 offset:14336
v_mfma_f32_16x16x32_bf16 v[64:67], a[36:39], v[24:27], v[64:67]
s_add_u32 m0, s46, 0
s_waitcnt lgkmcnt(4)
v_mfma_f32_16x16x32_bf16 v[52:55], a[40:43], v[28:31], v[52:55]
ds_read_b128 v[20:23], v10 offset:16384
v_mfma_f32_16x16x32_bf16 v[56:59], a[44:47], v[28:31], v[56:59]
buffer_load_dwordx4 v6, s[8:11], s50 offen offset:0 lds
v_mfma_f32_16x16x32_bf16 v[60:63], a[40:43], v[32:35], v[60:63]
ds_read_b128 v[24:27], v10 offset:18432
v_mfma_f32_16x16x32_bf16 v[64:67], a[44:47], v[32:35], v[64:67]
s_add_u32 m0, s46, 3968
s_waitcnt lgkmcnt(4)
v_mfma_f32_16x16x32_bf16 v[52:55], a[48:51], v[36:39], v[52:55]
ds_read_b128 v[28:31], v11 offset:16384
v_mfma_f32_16x16x32_bf16 v[56:59], a[52:55], v[36:39], v[56:59]
buffer_load_dwordx4 v6, s[8:11], s50 offen offset:128 lds
v_mfma_f32_16x16x32_bf16 v[60:63], a[48:51], v[40:43], v[60:63]
ds_read_b128 v[32:35], v11 offset:18432
v_mfma_f32_16x16x32_bf16 v[64:67], a[52:55], v[40:43], v[64:67]
s_add_u32 m0, s46, 7936
s_waitcnt lgkmcnt(4)
v_mfma_f32_16x16x32_bf16 v[52:55], a[56:59], v[44:47], v[52:55]
ds_read_b128 v[36:39], v10 offset:20480
v_mfma_f32_16x16x32_bf16 v[56:59], a[60:63], v[44:47], v[56:59]
buffer_load_dwordx4 v6, s[8:11], s50 offen offset:256 lds
v_mfma_f32_16x16x32_bf16 v[60:63], a[56:59], v[48:51], v[60:63]
ds_read_b128 v[40:43], v10 offset:22528
v_mfma_f32_16x16x32_bf16 v[64:67], a[60:63], v[48:51], v[64:67]
s_add_u32 m0, s46, 11904
s_waitcnt lgkmcnt(4)
v_mfma_f32_16x16x32_bf16 v[52:55], a[64:67], v[20:23], v[52:55]
ds_read_b128 v[44:47], v11 offset:20480
v_mfma_f32_16x16x32_bf16 v[56:59], a[68:71], v[20:23], v[56:59]
buffer_load_dwordx4 v6, s[8:11], s50 offen offset:384 lds
v_mfma_f32_16x16x32_bf16 v[60:63], a[64:67], v[24:27], v[60:63]
ds_read_b128 v[48:51], v11 offset:22528
v_mfma_f32_16x16x32_bf16 v[64:67], a[68:71], v[24:27], v[64:67]
s_add_u32 m0, s46, 15872
s_waitcnt lgkmcnt(4)
v_mfma_f32_16x16x32_bf16 v[52:55], a[72:75], v[28:31], v[52:55]
ds_read_b128 v[20:23], v10 offset:24576
v_mfma_f32_16x16x32_bf16 v[56:59], a[76:79], v[28:31], v[56:59]
buffer_load_dwordx4 v6, s[8:11], s50 offen offset:512 lds
v_mfma_f32_16x16x32_bf16 v[60:63], a[72:75], v[32:35], v[60:63]
ds_read_b128 v[24:27], v10 offset:26624
v_mfma_f32_16x16x32_bf16 v[64:67], a[76:79], v[32:35], v[64:67]
s_add_u32 m0, s46, 19840
s_waitcnt lgkmcnt(4)
v_mfma_f32_16x16x32_bf16 v[52:55], a[80:83], v[36:39], v[52:55]
ds_read_b128 v[28:31], v11 offset:24576
v_mfma_f32_16x16x32_bf16 v[56:59], a[84:87], v[36:39], v[56:59]
buffer_load_dwordx4 v6, s[8:11], s50 offen offset:640 lds
v_mfma_f32_16x16x32_bf16 v[60:63], a[80:83], v[40:43], v[60:63]
ds_read_b128 v[32:35], v11 offset:26624
v_mfma_f32_16x16x32_bf16 v[64:67], a[84:87], v[40:43], v[64:67]
s_add_u32 m0, s46, 23808
s_waitcnt lgkmcnt(4)
v_mfma_f32_16x16x32_bf16 v[52:55], a[88:91], v[44:47], v[52:55]
ds_read_b128 v[36:39], v10 offset:28672
v_mfma_f32_16x16x32_bf16 v[56:59], a[92:95], v[44:47], v[56:59]
buffer_load_dwordx4 v6, s[8:11], s50 offen offset:768 lds
v_mfma_f32_16x16x32_bf16 v[60:63], a[88:91], v[48:51], v[60:63]
ds_read_b128 v[40:43], v10 offset:30720
v_mfma_f32_16x16x32_bf16 v[64:67], a[92:95], v[48:51], v[64:67]
s_add_u32 m0, s46, 27776
s_waitcnt lgkmcnt(4)
v_mfma_f32_16x16x32_bf16 v[52:55], a[96:99], v[20:23], v[52:55]
ds_read_b128 v[44:47], v11 offset:28672
v_mfma_f32_16x16x32_bf16 v[56:59], a[100:103], v[20:23], v[56:59]
buffer_load_dwordx4 v6, s[8:11], s50 offen offset:896 lds
v_mfma_f32_16x16x32_bf16 v[60:63], a[96:99], v[24:27], v[60:63]
ds_read_b128 v[48:51], v11 offset:30720
v_mfma_f32_16x16x32_bf16 v[64:67], a[100:103], v[24:27], v[64:67]
s_add_u32 m0, s46, 31744
s_waitcnt lgkmcnt(4)
v_mfma_f32_16x16x32_bf16 v[52:55], a[104:107], v[28:31], v[52:55]
ds_read_b128 v[20:23], v10 offset:32768
v_mfma_f32_16x16x32_bf16 v[56:59], a[108:111], v[28:31], v[56:59]
buffer_load_dwordx4 v6, s[8:11], s50 offen offset:1024 lds
v_mfma_f32_16x16x32_bf16 v[60:63], a[104:107], v[32:35], v[60:63]
ds_read_b128 v[24:27], v10 offset:34816
v_mfma_f32_16x16x32_bf16 v[64:67], a[108:111], v[32:35], v[64:67]
s_waitcnt vmcnt(13)
v_mov_b32 v17, s42
s_mov_b64 exec, 1
buffer_store_dword v17, v16, s[84:87], s49 offen sc1
s_mov_b64 exec, -1
s_add_u32 m0, s46, 35712
s_waitcnt lgkmcnt(4)
v_mfma_f32_16x16x32_bf16 v[52:55], a[112:115], v[36:39], v[52:55]
ds_read_b128 v[28:31], v11 offset:32768
v_mfma_f32_16x16x32_bf16 v[56:59], a[116:119], v[36:39], v[56:59]
buffer_load_dwordx4 v6, s[8:11], s50 offen offset:1152 lds
v_mfma_f32_16x16x32_bf16 v[60:63], a[112:115], v[40:43], v[60:63]
ds_read_b128 v[32:35], v11 offset:34816
v_mfma_f32_16x16x32_bf16 v[64:67], a[116:119], v[40:43], v[64:67]
v_mov_b32 v100, 0
s_mov_b64 exec, 1
buffer_atomic_add v100, v16, s[84:87], s62 offen sc0 sc1
s_mov_b64 exec, -1
s_add_u32 m0, s46, 39680
s_waitcnt lgkmcnt(4)
v_mfma_f32_16x16x32_bf16 v[52:55], a[120:123], v[44:47], v[52:55]
ds_read_b128 v[36:39], v10 offset:36864
v_mfma_f32_16x16x32_bf16 v[56:59], a[124:127], v[44:47], v[56:59]
buffer_load_dwordx4 v6, s[8:11], s50 offen offset:1280 lds
v_mfma_f32_16x16x32_bf16 v[60:63], a[120:123], v[48:51], v[60:63]
ds_read_b128 v[40:43], v10 offset:38912
v_mfma_f32_16x16x32_bf16 v[64:67], a[124:127], v[48:51], v[64:67]
s_add_u32 m0, s46, 43648
s_waitcnt lgkmcnt(4)
v_mfma_f32_16x16x32_bf16 v[52:55], a[128:131], v[20:23], v[52:55]
ds_read_b128 v[44:47], v11 offset:36864
v_mfma_f32_16x16x32_bf16 v[56:59], a[132:135], v[20:23], v[56:59]
buffer_load_dwordx4 v6, s[8:11], s50 offen offset:1408 lds
v_mfma_f32_16x16x32_bf16 v[60:63], a[128:131], v[24:27], v[60:63]
ds_read_b128 v[48:51], v11 offset:38912
v_mfma_f32_16x16x32_bf16 v[64:67], a[132:135], v[24:27], v[64:67]
s_add_u32 m0, s46, 47616
s_waitcnt lgkmcnt(4)
v_mfma_f32_16x16x32_bf16 v[52:55], a[136:139], v[28:31], v[52:55]
ds_read_b128 v[20:23], v10 offset:40960
v_mfma_f32_16x16x32_bf16 v[56:59], a[140:143], v[28:31], v[56:59]
buffer_load_dwordx4 v6, s[8:11], s50 offen offset:1536 lds
v_mfma_f32_16x16x32_bf16 v[60:63], a[136:139], v[32:35], v[60:63]
ds_read_b128 v[24:27], v10 offset:43008
v_mfma_f32_16x16x32_bf16 v[64:67], a[140:143], v[32:35], v[64:67]
s_add_u32 m0, s46, 51584
s_waitcnt lgkmcnt(4)
v_mfma_f32_16x16x32_bf16 v[52:55], a[144:147], v[36:39], v[52:55]
ds_read_b128 v[28:31], v11 offset:40960
v_mfma_f32_16x16x32_bf16 v[56:59], a[148:151], v[36:39], v[56:59]
buffer_load_dwordx4 v6, s[8:11], s50 offen offset:1664 lds
v_mfma_f32_16x16x32_bf16 v[60:63], a[144:147], v[40:43], v[60:63]
ds_read_b128 v[32:35], v11 offset:43008
v_mfma_f32_16x16x32_bf16 v[64:67], a[148:151], v[40:43], v[64:67]
s_add_u32 m0, s46, 55552
s_waitcnt lgkmcnt(4)
v_mfma_f32_16x16x32_bf16 v[52:55], a[152:155], v[44:47], v[52:55]
ds_read_b128 v[36:39], v10 offset:45056
v_mfma_f32_16x16x32_bf16 v[56:59], a[156:159], v[44:47], v[56:59]
buffer_load_dwordx4 v6, s[8:11], s50 offen offset:1792 lds
v_mfma_f32_16x16x32_bf16 v[60:63], a[152:155], v[48:51], v[60:63]
ds_read_b128 v[40:43], v10 offset:47104
v_mfma_f32_16x16x32_bf16 v[64:67], a[156:159], v[48:51], v[64:67]
s_add_u32 m0, s46, 59520
s_waitcnt lgkmcnt(4)
v_mfma_f32_16x16x32_bf16 v[52:55], a[160:163], v[20:23], v[52:55]
ds_read_b128 v[44:47], v11 offset:45056
v_mfma_f32_16x16x32_bf16 v[56:59], a[164:167], v[20:23], v[56:59]
buffer_load_dwordx4 v6, s[8:11], s50 offen offset:1920 lds
v_mfma_f32_16x16x32_bf16 v[60:63], a[160:163], v[24:27], v[60:63]
ds_read_b128 v[48:51], v11 offset:47104
v_mfma_f32_16x16x32_bf16 v[64:67], a[164:167], v[24:27], v[64:67]
s_waitcnt lgkmcnt(4)
v_mfma_f32_16x16x32_bf16 v[52:55], a[168:171], v[28:31], v[52:55]
ds_read_b128 v[20:23], v10 offset:49152
v_mfma_f32_16x16x32_bf16 v[56:59], a[172:175], v[28:31], v[56:59]
v_mfma_f32_16x16x32_bf16 v[60:63], a[168:171], v[32:35], v[60:63]
ds_read_b128 v[24:27], v10 offset:51200
v_mfma_f32_16x16x32_bf16 v[64:67], a[172:175], v[32:35], v[64:67]
v_cvt_pk_bf16_f32 v84, v68, v69
v_cvt_pk_bf16_f32 v85, v70, v71
s_waitcnt lgkmcnt(4)
v_mfma_f32_16x16x32_bf16 v[52:55], a[176:179], v[36:39], v[52:55]
ds_read_b128 v[28:31], v11 offset:49152
v_mfma_f32_16x16x32_bf16 v[56:59], a[180:183], v[36:39], v[56:59]
v_mfma_f32_16x16x32_bf16 v[60:63], a[176:179], v[40:43], v[60:63]
ds_read_b128 v[32:35], v11 offset:51200
v_mfma_f32_16x16x32_bf16 v[64:67], a[180:183], v[40:43], v[64:67]
v_cvt_pk_bf16_f32 v86, v72, v73
v_cvt_pk_bf16_f32 v87, v74, v75
s_waitcnt lgkmcnt(4)
v_mfma_f32_16x16x32_bf16 v[52:55], a[184:187], v[44:47], v[52:55]
ds_read_b128 v[36:39], v10 offset:53248
v_mfma_f32_16x16x32_bf16 v[56:59], a[188:191], v[44:47], v[56:59]
v_mfma_f32_16x16x32_bf16 v[60:63], a[184:187], v[48:51], v[60:63]
ds_read_b128 v[40:43], v10 offset:55296
v_mfma_f32_16x16x32_bf16 v[64:67], a[188:191], v[48:51], v[64:67]
v_cvt_pk_bf16_f32 v88, v76, v77
v_cvt_pk_bf16_f32 v89, v78, v79
s_waitcnt lgkmcnt(4)
v_mfma_f32_16x16x32_bf16 v[52:55], a[192:195], v[20:23], v[52:55]
ds_read_b128 v[44:47], v11 offset:53248
v_mfma_f32_16x16x32_bf16 v[56:59], a[196:199], v[20:23], v[56:59]
v_mfma_f32_16x16x32_bf16 v[60:63], a[192:195], v[24:27], v[60:63]
ds_read_b128 v[48:51], v11 offset:55296
v_mfma_f32_16x16x32_bf16 v[64:67], a[196:199], v[24:27], v[64:67]
v_cvt_pk_bf16_f32 v90, v80, v81
v_cvt_pk_bf16_f32 v91, v82, v83
s_waitcnt lgkmcnt(4)
v_mfma_f32_16x16x32_bf16 v[52:55], a[200:203], v[28:31], v[52:55]
ds_read_b128 v[20:23], v10 offset:57344
v_mfma_f32_16x16x32_bf16 v[56:59], a[204:207], v[28:31], v[56:59]
v_mfma_f32_16x16x32_bf16 v[60:63], a[200:203], v[32:35], v[60:63]
ds_read_b128 v[24:27], v10 offset:59392
v_mfma_f32_16x16x32_bf16 v[64:67], a[204:207], v[32:35], v[64:67]
s_waitcnt lgkmcnt(4)
v_mfma_f32_16x16x32_bf16 v[52:55], a[208:211], v[36:39], v[52:55]
ds_read_b128 v[28:31], v11 offset:57344
v_mfma_f32_16x16x32_bf16 v[56:59], a[212:215], v[36:39], v[56:59]
v_mfma_f32_16x16x32_bf16 v[60:63], a[208:211], v[40:43], v[60:63]
ds_read_b128 v[32:35], v11 offset:59392
v_mfma_f32_16x16x32_bf16 v[64:67], a[212:215], v[40:43], v[64:67]
s_waitcnt lgkmcnt(4)
v_mfma_f32_16x16x32_bf16 v[52:55], a[216:219], v[44:47], v[52:55]
ds_read_b128 v[36:39], v10 offset:61440
v_mfma_f32_16x16x32_bf16 v[56:59], a[220:223], v[44:47], v[56:59]
s_waitcnt vmcnt(6)
v_readfirstlane_b32 s56, v100
s_cmp_eq_u32 s30, 1
s_cbranch_scc1 mega_kernel_q_kf1
s_cmp_gt_i32 s56, s42
s_cbranch_scc0 mega_kernel_q_kf1
s_mov_b32 s30, 1
s_mov_b32 m0, s61
s_nop 0
buffer_load_dwordx4 v5, s[84:87], s68 offen sc1 lds
mega_kernel_q_kf1:
v_mfma_f32_16x16x32_bf16 v[60:63], a[216:219], v[48:51], v[60:63]
ds_read_b128 v[40:43], v10 offset:63488
v_mfma_f32_16x16x32_bf16 v[64:67], a[220:223], v[48:51], v[64:67]
s_waitcnt lgkmcnt(4)
v_mfma_f32_16x16x32_bf16 v[52:55], a[224:227], v[20:23], v[52:55]
ds_read_b128 v[44:47], v11 offset:61440
v_mfma_f32_16x16x32_bf16 v[56:59], a[228:231], v[20:23], v[56:59]
v_mfma_f32_16x16x32_bf16 v[60:63], a[224:227], v[24:27], v[60:63]
ds_read_b128 v[48:51], v11 offset:63488
v_mfma_f32_16x16x32_bf16 v[64:67], a[228:231], v[24:27], v[64:67]
s_waitcnt lgkmcnt(5)
v_mfma_f32_16x16x32_bf16 v[52:55], a[232:235], v[28:31], v[52:55]
v_mfma_f32_16x16x32_bf16 v[56:59], a[236:239], v[28:31], v[56:59]
s_waitcnt lgkmcnt(4)
v_mfma_f32_16x16x32_bf16 v[60:63], a[232:235], v[32:35], v[60:63]
v_mfma_f32_16x16x32_bf16 v[64:67], a[236:239], v[32:35], v[64:67]
s_waitcnt lgkmcnt(3)
v_mfma_f32_16x16x32_bf16 v[52:55], a[240:243], v[36:39], v[52:55]
v_mfma_f32_16x16x32_bf16 v[56:59], a[244:247], v[36:39], v[56:59]
s_waitcnt lgkmcnt(2)
v_mfma_f32_16x16x32_bf16 v[60:63], a[240:243], v[40:43], v[60:63]
v_mfma_f32_16x16x32_bf16 v[64:67], a[244:247], v[40:43], v[64:67]
ds_write_b128 v101, v[84:87]
ds_write_b128 v101, v[88:91] offset:1024
s_waitcnt lgkmcnt(1)
v_mfma_f32_16x16x32_bf16 v[68:71], a[248:251], v[44:47], v[52:55]
v_mfma_f32_16x16x32_bf16 v[72:75], a[252:255], v[44:47], v[56:59]
s_waitcnt lgkmcnt(0)
v_mfma_f32_16x16x32_bf16 v[76:79], a[248:251], v[48:51], v[60:63]
v_mfma_f32_16x16x32_bf16 v[80:83], a[252:255], v[48:51], v[64:67]
s_cmp_eq_u32 s30, 1
s_cbranch_scc1 mega_kernel_q_kl1
mega_kernel_q_kw1:
v_mov_b32 v100, 0
s_mov_b64 exec, 1
buffer_atomic_add v100, v16, s[84:87], s62 offen sc0 sc1
s_mov_b64 exec, -1
s_waitcnt vmcnt(0)
v_readfirstlane_b32 s56, v100
s_cmp_gt_i32 s56, s42
s_cbranch_scc0 mega_kernel_q_kw1
s_mov_b32 m0, s61
s_nop 0
buffer_load_dwordx4 v5, s[84:87], s68 offen sc1 lds
mega_kernel_q_kl1:
s_waitcnt lgkmcnt(0) vmcnt(0)
s_barrier
ds_read_b128 v[184:187], v102 offset:0
ds_read_b128 v[112:115], v103 offset:0
ds_read_b128 v[128:131], v103 offset:1024
ds_read_b128 v[188:191], v102 offset:2048
ds_read_b128 v[116:119], v103 offset:2048
ds_read_b128 v[132:135], v103 offset:3072
ds_read_b128 v[192:195], v102 offset:4096
ds_read_b128 v[120:123], v103 offset:4096
ds_read_b128 v[136:139], v103 offset:5120
ds_read_b128 v[196:199], v102 offset:6144
ds_read_b128 v[124:127], v103 offset:6144
ds_read_b128 v[140:143], v103 offset:7168
s_waitcnt lgkmcnt(9)
v_mfma_f32_16x16x32_bf16 v[200:203], v[112:115], v[184:187], 0
v_mfma_f32_16x16x32_bf16 v[204:207], v[128:131], v[184:187], 0
ds_read_b128 v[160:163], v94 offset:0
s_waitcnt lgkmcnt(7)
v_mfma_f32_16x16x32_bf16 v[200:203], v[116:119], v[188:191], v[200:203]
v_mfma_f32_16x16x32_bf16 v[204:207], v[132:135], v[188:191], v[204:207]
ds_read_b128 v[164:167], v94 offset:1024
s_waitcnt lgkmcnt(5)
v_mfma_f32_16x16x32_bf16 v[200:203], v[120:123], v[192:195], v[200:203]
v_mfma_f32_16x16x32_bf16 v[204:207], v[136:139], v[192:195], v[204:207]
ds_read_b128 v[168:171], v94 offset:2048
s_waitcnt lgkmcnt(3)
v_mfma_f32_16x16x32_bf16 v[200:203], v[124:127], v[196:199], v[200:203]
v_mfma_f32_16x16x32_bf16 v[204:207], v[140:143], v[196:199], v[204:207]
ds_read_b128 v[172:175], v94 offset:3072
s_waitcnt lgkmcnt(3)
v_mfma_f32_16x16x32_bf16 v[208:211], v[160:163], v[184:187], 0
ds_read_b128 v[144:147], v240 offset:0
ds_read_b64 v[176:177], v95 offset:0
s_waitcnt lgkmcnt(4)
v_mfma_f32_16x16x32_bf16 v[208:211], v[164:167], v[188:191], v[208:211]
ds_read_b128 v[148:151], v240 offset:1024
ds_read_b64 v[178:179], v95 offset:256
s_waitcnt lgkmcnt(5)
v_mfma_f32_16x16x32_bf16 v[208:211], v[168:171], v[192:195], v[208:211]
ds_read_b128 v[152:155], v240 offset:2048
ds_read_b64 v[180:181], v95 offset:1024
s_waitcnt lgkmcnt(6)
v_mfma_f32_16x16x32_bf16 v[208:211], v[172:175], v[196:199], v[208:211]
ds_read_b128 v[156:159], v240 offset:3072
ds_read_b64 v[182:183], v95 offset:1280
s_nop 3
v_cndmask_b32 v200, v200, v97, s[12:13]
v_cndmask_b32 v201, v201, v97, s[14:15]
v_cndmask_b32 v202, v202, v97, s[16:17]
v_cndmask_b32 v203, v203, v97, s[18:19]
v_cndmask_b32 v204, v204, v97, s[20:21]
v_cndmask_b32 v205, v205, v97, s[22:23]
v_cndmask_b32 v206, v206, v97, s[24:25]
v_cndmask_b32 v207, v207, v97, s[26:27]
v_cndmask_b32 v208, v208, v97, s[28:29]
v_cndmask_b32 v209, v209, v97, s[28:29]
v_cndmask_b32 v210, v210, v97, s[28:29]
v_cndmask_b32 v211, v211, v97, s[28:29]
v_max3_f32 v236, v200, v201, v202
v_max3_f32 v236, v236, v203, v204
v_max3_f32 v236, v236, v205, v206
v_max3_f32 v236, v236, v207, v208
v_max3_f32 v236, v236, v209, v210
v_max_f32 v237, v236, v211
v_max_f32 v236, v236, v211
s_nop 1
v_permlane16_swap_b32 v236, v237
s_nop 0
v_max_f32 v238, v236, v237
v_max_f32 v239, v236, v237
s_nop 1
v_permlane32_swap_b32 v238, v239
s_nop 0
v_max_f32 v236, v238, v239
v_mul_f32 v236, s54, v236
v_pk_fma_f32 v[200:201], v[200:201], s[54:55], v[236:237] op_sel_hi:[1,0,0] neg_lo:[0,0,1] neg_hi:[0,0,1]
v_pk_fma_f32 v[202:203], v[202:203], s[54:55], v[236:237] op_sel_hi:[1,0,0] neg_lo:[0,0,1] neg_hi:[0,0,1]
v_pk_fma_f32 v[204:205], v[204:205], s[54:55], v[236:237] op_sel_hi:[1,0,0] neg_lo:[0,0,1] neg_hi:[0,0,1]
v_pk_fma_f32 v[206:207], v[206:207], s[54:55], v[236:237] op_sel_hi:[1,0,0] neg_lo:[0,0,1] neg_hi:[0,0,1]
v_pk_fma_f32 v[208:209], v[208:209], s[54:55], v[236:237] op_sel_hi:[1,0,0] neg_lo:[0,0,1] neg_hi:[0,0,1]
v_pk_fma_f32 v[210:211], v[210:211], s[54:55], v[236:237] op_sel_hi:[1,0,0] neg_lo:[0,0,1] neg_hi:[0,0,1]
v_exp_f32 v200, v200
v_exp_f32 v201, v201
v_exp_f32 v202, v202
v_exp_f32 v203, v203
v_exp_f32 v204, v204
v_exp_f32 v205, v205
v_exp_f32 v206, v206
v_exp_f32 v207, v207
v_exp_f32 v208, v208
v_exp_f32 v209, v209
v_exp_f32 v210, v210
v_exp_f32 v211, v211
s_nop 0
v_cvt_pk_bf16_f32 v212, v200, v201
v_cvt_pk_bf16_f32 v213, v202, v203
v_cvt_pk_bf16_f32 v214, v204, v205
v_cvt_pk_bf16_f32 v215, v206, v207
v_cvt_pk_bf16_f32 v216, v208, v209
v_cvt_pk_bf16_f32 v217, v210, v211
s_waitcnt lgkmcnt(0)
s_nop 0
v_mfma_f32_16x16x32_bf16 v[108:111], v[104:107], v[212:215], 0
v_mfma_f32_16x16x32_bf16 v[220:223], v[144:147], v[212:215], 0
v_mfma_f32_16x16x32_bf16 v[224:227], v[148:151], v[212:215], 0
v_mfma_f32_16x16x32_bf16 v[228:231], v[152:155], v[212:215], 0
v_mfma_f32_16x16x32_bf16 v[232:235], v[156:159], v[212:215], 0
v_mfma_f32_16x16x16_bf16 v[108:111], v[104:105], v[216:217], v[108:111]
v_mfma_f32_16x16x16_bf16 v[220:223], v[176:177], v[216:217], v[220:223]
v_mfma_f32_16x16x16_bf16 v[224:227], v[178:179], v[216:217], v[224:227]
v_mfma_f32_16x16x16_bf16 v[228:231], v[180:181], v[216:217], v[228:231]
v_mfma_f32_16x16x16_bf16 v[232:235], v[182:183], v[216:217], v[232:235]
s_lshl_b32 s51, s42, 18
s_nop 2
v_rcp_f32 v238, v108
v_rcp_f32 v239, v109
s_nop 1
v_pk_mul_f32 v[220:221], v[220:221], v[238:239]
v_pk_mul_f32 v[222:223], v[222:223], v[238:239]
v_pk_mul_f32 v[224:225], v[224:225], v[238:239]
v_pk_mul_f32 v[226:227], v[226:227], v[238:239]
v_pk_mul_f32 v[228:229], v[228:229], v[238:239]
v_pk_mul_f32 v[230:231], v[230:231], v[238:239]
v_pk_mul_f32 v[232:233], v[232:233], v[238:239]
v_pk_mul_f32 v[234:235], v[234:235], v[238:239]
v_cvt_pk_bf16_f32 v200, v220, v221
v_cvt_pk_bf16_f32 v201, v222, v223
v_cvt_pk_bf16_f32 v202, v224, v225
v_cvt_pk_bf16_f32 v203, v226, v227
v_cvt_pk_bf16_f32 v204, v228, v229
v_cvt_pk_bf16_f32 v205, v230, v231
v_cvt_pk_bf16_f32 v206, v232, v233
v_cvt_pk_bf16_f32 v207, v234, v235
buffer_store_dwordx4 v[200:203], v96, s[84:87], s51 offen sc1
buffer_store_dwordx4 v[204:207], v96, s[84:87], s51 offen offset:2048 sc1
s_add_u32 s42, s42, 1
s_barrier
s_cmp_gt_i32 s55, s42
s_cbranch_scc1 mega_kernel_q_kv0k
mega_kernel_q_kv0w:
buffer_load_dword v2, v99, s[84:87], 0 offen sc1
s_waitcnt vmcnt(0)
v_min_i32_dpp v2, v2, v2 quad_perm:[1,0,3,2] row_mask:0xf bank_mask:0xf
s_nop 1
v_min_i32_dpp v2, v2, v2 quad_perm:[2,3,0,1] row_mask:0xf bank_mask:0xf
s_nop 1
v_min_i32_dpp v2, v2, v2 row_ror:4 row_mask:0xf bank_mask:0xf
s_nop 0
v_readfirstlane_b32 s55, v2
s_cmp_gt_i32 s55, s42
s_cbranch_scc1 mega_kernel_q_kv0k
s_sleep 4
s_branch mega_kernel_q_kv0w
mega_kernel_q_kv0k:
s_cmp_eq_u32 s42, 63
s_cbranch_scc0 mega_kernel_q_nl
s_add_u32 s51, s47, s42
s_bfe_u32 s57, s51, 0x40002
s_lshl_b32 s57, s57, 14
s_and_b32 s66, s51, 3
s_lshl_b32 s66, s66, 11
s_add_u32 s66, s66, s57
s_add_u32 s66, s66, s58
s_add_u32 s67, s66, 33554432
s_bfe_u32 s57, s51, 0x30003
s_lshl_b32 s57, s57, 14
s_and_b32 s68, s51, 7
s_lshl_b32 s68, s68, 10
s_add_u32 s68, s68, s57
s_add_u32 s68, s68, s59
s_add_u32 s50, s42, 2
s_min_u32 s50, s50, 63
s_lshl_b32 s50, s50, 16
s_cmp_gt_i32 s56, s42
s_cselect_b32 s30, 1, 0
s_add_u32 m0, s60, 0
s_nop 0
buffer_load_dwordx4 v5, s[84:87], s66 offen offset:0 sc1 lds
s_add_u32 m0, s60, 0
s_nop 0
buffer_load_dwordx4 v5, s[84:87], s66 offen offset:1024 sc1 lds
s_add_u32 m0, s60, 8192
s_nop 0
buffer_load_dwordx4 v5, s[84:87], s67 offen offset:0 sc1 lds
s_add_u32 m0, s60, 8192
s_nop 0
buffer_load_dwordx4 v5, s[84:87], s67 offen offset:1024 sc1 lds
s_cmp_eq_u32 s30, 1
s_cbranch_scc0 mega_kernel_q_ke2
s_mov_b32 m0, s61
s_nop 0
buffer_load_dwordx4 v5, s[84:87], s68 offen sc1 lds
mega_kernel_q_ke2:
v_cvt_pk_bf16_f32 v84, v68, v69
v_cvt_pk_bf16_f32 v85, v70, v71
v_cvt_pk_bf16_f32 v86, v72, v73
v_cvt_pk_bf16_f32 v87, v74, v75
v_cvt_pk_bf16_f32 v88, v76, v77
v_cvt_pk_bf16_f32 v89, v78, v79
v_cvt_pk_bf16_f32 v90, v80, v81
v_cvt_pk_bf16_f32 v91, v82, v83
ds_write_b128 v101, v[84:87]
ds_write_b128 v101, v[88:91] offset:1024
s_waitcnt vmcnt(4)
v_mov_b32 v17, s42
s_mov_b64 exec, 1
buffer_store_dword v17, v16, s[84:87], s49 offen sc1
s_mov_b64 exec, -1
s_branch mega_kernel_q_jl
mega_kernel_q_nl:
ds_read_b128 v[20:23], v8 offset:0
ds_read_b128 v[24:27], v8 offset:2048
ds_read_b128 v[28:31], v9 offset:0
ds_read_b128 v[32:35], v9 offset:2048
ds_read_b128 v[36:39], v8 offset:4096
ds_read_b128 v[40:43], v8 offset:6144
s_add_u32 s51, s47, s42
s_bfe_u32 s57, s51, 0x40002
s_lshl_b32 s57, s57, 14
s_and_b32 s66, s51, 3
s_lshl_b32 s66, s66, 11
s_add_u32 s66, s66, s57
s_add_u32 s66, s66, s58
s_add_u32 s67, s66, 33554432
s_bfe_u32 s57, s51, 0x30003
s_lshl_b32 s57, s57, 14
s_and_b32 s68, s51, 7
s_lshl_b32 s68, s68, 10
s_add_u32 s68, s68, s57
s_add_u32 s68, s68, s59
s_add_u32 s50, s42, 2
s_min_u32 s50, s50, 63
s_lshl_b32 s50, s50, 16
s_cmp_gt_i32 s56, s42
s_cselect_b32 s30, 1, 0
s_add_u32 m0, s60, 0
s_waitcnt lgkmcnt(4)
v_mfma_f32_16x16x32_bf16 v[52:55], a[0:3], v[20:23], 0
ds_read_b128 v[44:47], v9 offset:4096
v_mfma_f32_16x16x32_bf16 v[56:59], a[4:7], v[20:23], 0
buffer_load_dwordx4 v5, s[84:87], s66 offen offset:0 sc1 lds
v_mfma_f32_16x16x32_bf16 v[60:63], a[0:3], v[24:27], 0
ds_read_b128 v[48:51], v9 offset:6144
v_mfma_f32_16x16x32_bf16 v[64:67], a[4:7], v[24:27], 0
s_add_u32 m0, s60, 0
s_waitcnt lgkmcnt(4)
v_mfma_f32_16x16x32_bf16 v[52:55], a[8:11], v[28:31], v[52:55]
ds_read_b128 v[20:23], v8 offset:8192
v_mfma_f32_16x16x32_bf16 v[56:59], a[12:15], v[28:31], v[56:59]
buffer_load_dwordx4 v5, s[84:87], s66 offen offset:1024 sc1 lds
v_mfma_f32_16x16x32_bf16 v[60:63], a[8:11], v[32:35], v[60:63]
ds_read_b128 v[24:27], v8 offset:10240
v_mfma_f32_16x16x32_bf16 v[64:67], a[12:15], v[32:35], v[64:67]
s_add_u32 m0, s60, 8192
s_waitcnt lgkmcnt(4)
v_mfma_f32_16x16x32_bf16 v[52:55], a[16:19], v[36:39], v[52:55]
ds_read_b128 v[28:31], v9 offset:8192
v_mfma_f32_16x16x32_bf16 v[56:59], a[20:23], v[36:39], v[56:59]
buffer_load_dwordx4 v5, s[84:87], s67 offen offset:0 sc1 lds
v_mfma_f32_16x16x32_bf16 v[60:63], a[16:19], v[40:43], v[60:63]
ds_read_b128 v[32:35], v9 offset:10240
v_mfma_f32_16x16x32_bf16 v[64:67], a[20:23], v[40:43], v[64:67]
s_add_u32 m0, s60, 8192
s_waitcnt lgkmcnt(4)
v_mfma_f32_16x16x32_bf16 v[52:55], a[24:27], v[44:47], v[52:55]
ds_read_b128 v[36:39], v8 offset:12288
v_mfma_f32_16x16x32_bf16 v[56:59], a[28:31], v[44:47], v[56:59]
buffer_load_dwordx4 v5, s[84:87], s67 offen offset:1024 sc1 lds
v_mfma_f32_16x16x32_bf16 v[60:63], a[24:27], v[48:51], v[60:63]
ds_read_b128 v[40:43], v8 offset:14336
v_mfma_f32_16x16x32_bf16 v[64:67], a[28:31], v[48:51], v[64:67]
s_waitcnt lgkmcnt(4)
v_mfma_f32_16x16x32_bf16 v[52:55], a[32:35], v[20:23], v[52:55]
ds_read_b128 v[44:47], v9 offset:12288
v_mfma_f32_16x16x32_bf16 v[56:59], a[36:39], v[20:23], v[56:59]
s_cmp_eq_u32 s30, 1
s_cbranch_scc0 mega_kernel_q_ke0
s_mov_b32 m0, s61
s_nop 0
buffer_load_dwordx4 v5, s[84:87], s68 offen sc1 lds
mega_kernel_q_ke0:
v_mfma_f32_16x16x32_bf16 v[60:63], a[32:35], v[24:27], v[60:63]
ds_read_b128 v[48:51], v9 offset:14336
v_mfma_f32_16x16x32_bf16 v[64:67], a[36:39], v[24:27], v[64:67]
s_add_u32 m0, s46, 65536
s_waitcnt lgkmcnt(4)
v_mfma_f32_16x16x32_bf16 v[52:55], a[40:43], v[28:31], v[52:55]
ds_read_b128 v[20:23], v8 offset:16384
v_mfma_f32_16x16x32_bf16 v[56:59], a[44:47], v[28:31], v[56:59]
buffer_load_dwordx4 v6, s[8:11], s50 offen offset:0 lds
v_mfma_f32_16x16x32_bf16 v[60:63], a[40:43], v[32:35], v[60:63]
ds_read_b128 v[24:27], v8 offset:18432
v_mfma_f32_16x16x32_bf16 v[64:67], a[44:47], v[32:35], v[64:67]
s_add_u32 m0, s46, 69504
s_waitcnt lgkmcnt(4)
v_mfma_f32_16x16x32_bf16 v[52:55], a[48:51], v[36:39], v[52:55]
ds_read_b128 v[28:31], v9 offset:16384
v_mfma_f32_16x16x32_bf16 v[56:59], a[52:55], v[36:39], v[56:59]
buffer_load_dwordx4 v6, s[8:11], s50 offen offset:128 lds
v_mfma_f32_16x16x32_bf16 v[60:63], a[48:51], v[40:43], v[60:63]
ds_read_b128 v[32:35], v9 offset:18432
v_mfma_f32_16x16x32_bf16 v[64:67], a[52:55], v[40:43], v[64:67]
s_add_u32 m0, s46, 73472
s_waitcnt lgkmcnt(4)
v_mfma_f32_16x16x32_bf16 v[52:55], a[56:59], v[44:47], v[52:55]
ds_read_b128 v[36:39], v8 offset:20480
v_mfma_f32_16x16x32_bf16 v[56:59], a[60:63], v[44:47], v[56:59]
buffer_load_dwordx4 v6, s[8:11], s50 offen offset:256 lds
v_mfma_f32_16x16x32_bf16 v[60:63], a[56:59], v[48:51], v[60:63]
ds_read_b128 v[40:43], v8 offset:22528
v_mfma_f32_16x16x32_bf16 v[64:67], a[60:63], v[48:51], v[64:67]
s_add_u32 m0, s46, 77440
s_waitcnt lgkmcnt(4)
v_mfma_f32_16x16x32_bf16 v[52:55], a[64:67], v[20:23], v[52:55]
ds_read_b128 v[44:47], v9 offset:20480
v_mfma_f32_16x16x32_bf16 v[56:59], a[68:71], v[20:23], v[56:59]
buffer_load_dwordx4 v6, s[8:11], s50 offen offset:384 lds
v_mfma_f32_16x16x32_bf16 v[60:63], a[64:67], v[24:27], v[60:63]
ds_read_b128 v[48:51], v9 offset:22528
v_mfma_f32_16x16x32_bf16 v[64:67], a[68:71], v[24:27], v[64:67]
s_add_u32 m0, s46, 81408
s_waitcnt lgkmcnt(4)
v_mfma_f32_16x16x32_bf16 v[52:55], a[72:75], v[28:31], v[52:55]
ds_read_b128 v[20:23], v8 offset:24576
v_mfma_f32_16x16x32_bf16 v[56:59], a[76:79], v[28:31], v[56:59]
buffer_load_dwordx4 v6, s[8:11], s50 offen offset:512 lds
v_mfma_f32_16x16x32_bf16 v[60:63], a[72:75], v[32:35], v[60:63]
ds_read_b128 v[24:27], v8 offset:26624
v_mfma_f32_16x16x32_bf16 v[64:67], a[76:79], v[32:35], v[64:67]
s_add_u32 m0, s46, 85376
s_waitcnt lgkmcnt(4)
v_mfma_f32_16x16x32_bf16 v[52:55], a[80:83], v[36:39], v[52:55]
ds_read_b128 v[28:31], v9 offset:24576
v_mfma_f32_16x16x32_bf16 v[56:59], a[84:87], v[36:39], v[56:59]
buffer_load_dwordx4 v6, s[8:11], s50 offen offset:640 lds
v_mfma_f32_16x16x32_bf16 v[60:63], a[80:83], v[40:43], v[60:63]
ds_read_b128 v[32:35], v9 offset:26624
v_mfma_f32_16x16x32_bf16 v[64:67], a[84:87], v[40:43], v[64:67]
s_add_u32 m0, s46, 89344
s_waitcnt lgkmcnt(4)
v_mfma_f32_16x16x32_bf16 v[52:55], a[88:91], v[44:47], v[52:55]
ds_read_b128 v[36:39], v8 offset:28672
v_mfma_f32_16x16x32_bf16 v[56:59], a[92:95], v[44:47], v[56:59]
buffer_load_dwordx4 v6, s[8:11], s50 offen offset:768 lds
v_mfma_f32_16x16x32_bf16 v[60:63], a[88:91], v[48:51], v[60:63]
ds_read_b128 v[40:43], v8 offset:30720
v_mfma_f32_16x16x32_bf16 v[64:67], a[92:95], v[48:51], v[64:67]
s_add_u32 m0, s46, 93312
s_waitcnt lgkmcnt(4)
v_mfma_f32_16x16x32_bf16 v[52:55], a[96:99], v[20:23], v[52:55]
ds_read_b128 v[44:47], v9 offset:28672
v_mfma_f32_16x16x32_bf16 v[56:59], a[100:103], v[20:23], v[56:59]
buffer_load_dwordx4 v6, s[8:11], s50 offen offset:896 lds
v_mfma_f32_16x16x32_bf16 v[60:63], a[96:99], v[24:27], v[60:63]
ds_read_b128 v[48:51], v9 offset:30720
v_mfma_f32_16x16x32_bf16 v[64:67], a[100:103], v[24:27], v[64:67]
s_add_u32 m0, s46, 97280
s_waitcnt lgkmcnt(4)
v_mfma_f32_16x16x32_bf16 v[52:55], a[104:107], v[28:31], v[52:55]
ds_read_b128 v[20:23], v8 offset:32768
v_mfma_f32_16x16x32_bf16 v[56:59], a[108:111], v[28:31], v[56:59]
buffer_load_dwordx4 v6, s[8:11], s50 offen offset:1024 lds
v_mfma_f32_16x16x32_bf16 v[60:63], a[104:107], v[32:35], v[60:63]
ds_read_b128 v[24:27], v8 offset:34816
v_mfma_f32_16x16x32_bf16 v[64:67], a[108:111], v[32:35], v[64:67]
s_waitcnt vmcnt(13)
v_mov_b32 v17, s42
s_mov_b64 exec, 1
buffer_store_dword v17, v16, s[84:87], s49 offen sc1
s_mov_b64 exec, -1
s_add_u32 m0, s46, 101248
s_waitcnt lgkmcnt(4)
v_mfma_f32_16x16x32_bf16 v[52:55], a[112:115], v[36:39], v[52:55]
ds_read_b128 v[28:31], v9 offset:32768
v_mfma_f32_16x16x32_bf16 v[56:59], a[116:119], v[36:39], v[56:59]
buffer_load_dwordx4 v6, s[8:11], s50 offen offset:1152 lds
v_mfma_f32_16x16x32_bf16 v[60:63], a[112:115], v[40:43], v[60:63]
ds_read_b128 v[32:35], v9 offset:34816
v_mfma_f32_16x16x32_bf16 v[64:67], a[116:119], v[40:43], v[64:67]
v_mov_b32 v100, 0
s_mov_b64 exec, 1
buffer_atomic_add v100, v16, s[84:87], s62 offen sc0 sc1
s_mov_b64 exec, -1
s_add_u32 m0, s46, 105216
s_waitcnt lgkmcnt(4)
v_mfma_f32_16x16x32_bf16 v[52:55], a[120:123], v[44:47], v[52:55]
ds_read_b128 v[36:39], v8 offset:36864
v_mfma_f32_16x16x32_bf16 v[56:59], a[124:127], v[44:47], v[56:59]
buffer_load_dwordx4 v6, s[8:11], s50 offen offset:1280 lds
v_mfma_f32_16x16x32_bf16 v[60:63], a[120:123], v[48:51], v[60:63]
ds_read_b128 v[40:43], v8 offset:38912
v_mfma_f32_16x16x32_bf16 v[64:67], a[124:127], v[48:51], v[64:67]
s_add_u32 m0, s46, 109184
s_waitcnt lgkmcnt(4)
v_mfma_f32_16x16x32_bf16 v[52:55], a[128:131], v[20:23], v[52:55]
ds_read_b128 v[44:47], v9 offset:36864
v_mfma_f32_16x16x32_bf16 v[56:59], a[132:135], v[20:23], v[56:59]
buffer_load_dwordx4 v6, s[8:11], s50 offen offset:1408 lds
v_mfma_f32_16x16x32_bf16 v[60:63], a[128:131], v[24:27], v[60:63]
ds_read_b128 v[48:51], v9 offset:38912
v_mfma_f32_16x16x32_bf16 v[64:67], a[132:135], v[24:27], v[64:67]
s_add_u32 m0, s46, 113152
s_waitcnt lgkmcnt(4)
v_mfma_f32_16x16x32_bf16 v[52:55], a[136:139], v[28:31], v[52:55]
ds_read_b128 v[20:23], v8 offset:40960
v_mfma_f32_16x16x32_bf16 v[56:59], a[140:143], v[28:31], v[56:59]
buffer_load_dwordx4 v6, s[8:11], s50 offen offset:1536 lds
v_mfma_f32_16x16x32_bf16 v[60:63], a[136:139], v[32:35], v[60:63]
ds_read_b128 v[24:27], v8 offset:43008
v_mfma_f32_16x16x32_bf16 v[64:67], a[140:143], v[32:35], v[64:67]
s_add_u32 m0, s46, 117120
s_waitcnt lgkmcnt(4)
v_mfma_f32_16x16x32_bf16 v[52:55], a[144:147], v[36:39], v[52:55]
ds_read_b128 v[28:31], v9 offset:40960
v_mfma_f32_16x16x32_bf16 v[56:59], a[148:151], v[36:39], v[56:59]
buffer_load_dwordx4 v6, s[8:11], s50 offen offset:1664 lds
v_mfma_f32_16x16x32_bf16 v[60:63], a[144:147], v[40:43], v[60:63]
ds_read_b128 v[32:35], v9 offset:43008
v_mfma_f32_16x16x32_bf16 v[64:67], a[148:151], v[40:43], v[64:67]
s_add_u32 m0, s46, 121088
s_waitcnt lgkmcnt(4)
v_mfma_f32_16x16x32_bf16 v[52:55], a[152:155], v[44:47], v[52:55]
ds_read_b128 v[36:39], v8 offset:45056
v_mfma_f32_16x16x32_bf16 v[56:59], a[156:159], v[44:47], v[56:59]
buffer_load_dwordx4 v6, s[8:11], s50 offen offset:1792 lds
v_mfma_f32_16x16x32_bf16 v[60:63], a[152:155], v[48:51], v[60:63]
ds_read_b128 v[40:43], v8 offset:47104
v_mfma_f32_16x16x32_bf16 v[64:67], a[156:159], v[48:51], v[64:67]
s_add_u32 m0, s46, 125056
s_waitcnt lgkmcnt(4)
v_mfma_f32_16x16x32_bf16 v[52:55], a[160:163], v[20:23], v[52:55]
ds_read_b128 v[44:47], v9 offset:45056
v_mfma_f32_16x16x32_bf16 v[56:59], a[164:167], v[20:23], v[56:59]
buffer_load_dwordx4 v6, s[8:11], s50 offen offset:1920 lds
v_mfma_f32_16x16x32_bf16 v[60:63], a[160:163], v[24:27], v[60:63]
ds_read_b128 v[48:51], v9 offset:47104
v_mfma_f32_16x16x32_bf16 v[64:67], a[164:167], v[24:27], v[64:67]
s_waitcnt lgkmcnt(4)
v_mfma_f32_16x16x32_bf16 v[52:55], a[168:171], v[28:31], v[52:55]
ds_read_b128 v[20:23], v8 offset:49152
v_mfma_f32_16x16x32_bf16 v[56:59], a[172:175], v[28:31], v[56:59]
v_mfma_f32_16x16x32_bf16 v[60:63], a[168:171], v[32:35], v[60:63]
ds_read_b128 v[24:27], v8 offset:51200
v_mfma_f32_16x16x32_bf16 v[64:67], a[172:175], v[32:35], v[64:67]
v_cvt_pk_bf16_f32 v84, v68, v69
v_cvt_pk_bf16_f32 v85, v70, v71
s_waitcnt lgkmcnt(4)
v_mfma_f32_16x16x32_bf16 v[52:55], a[176:179], v[36:39], v[52:55]
ds_read_b128 v[28:31], v9 offset:49152
v_mfma_f32_16x16x32_bf16 v[56:59], a[180:183], v[36:39], v[56:59]
v_mfma_f32_16x16x32_bf16 v[60:63], a[176:179], v[40:43], v[60:63]
ds_read_b128 v[32:35], v9 offset:51200
v_mfma_f32_16x16x32_bf16 v[64:67], a[180:183], v[40:43], v[64:67]
v_cvt_pk_bf16_f32 v86, v72, v73
v_cvt_pk_bf16_f32 v87, v74, v75
s_waitcnt lgkmcnt(4)
v_mfma_f32_16x16x32_bf16 v[52:55], a[184:187], v[44:47], v[52:55]
ds_read_b128 v[36:39], v8 offset:53248
v_mfma_f32_16x16x32_bf16 v[56:59], a[188:191], v[44:47], v[56:59]
v_mfma_f32_16x16x32_bf16 v[60:63], a[184:187], v[48:51], v[60:63]
ds_read_b128 v[40:43], v8 offset:55296
v_mfma_f32_16x16x32_bf16 v[64:67], a[188:191], v[48:51], v[64:67]
v_cvt_pk_bf16_f32 v88, v76, v77
v_cvt_pk_bf16_f32 v89, v78, v79
s_waitcnt lgkmcnt(4)
v_mfma_f32_16x16x32_bf16 v[52:55], a[192:195], v[20:23], v[52:55]
ds_read_b128 v[44:47], v9 offset:53248
v_mfma_f32_16x16x32_bf16 v[56:59], a[196:199], v[20:23], v[56:59]
v_mfma_f32_16x16x32_bf16 v[60:63], a[192:195], v[24:27], v[60:63]
ds_read_b128 v[48:51], v9 offset:55296
v_mfma_f32_16x16x32_bf16 v[64:67], a[196:199], v[24:27], v[64:67]
v_cvt_pk_bf16_f32 v90, v80, v81
v_cvt_pk_bf16_f32 v91, v82, v83
s_waitcnt lgkmcnt(4)
v_mfma_f32_16x16x32_bf16 v[52:55], a[200:203], v[28:31], v[52:55]
ds_read_b128 v[20:23], v8 offset:57344
v_mfma_f32_16x16x32_bf16 v[56:59], a[204:207], v[28:31], v[56:59]
v_mfma_f32_16x16x32_bf16 v[60:63], a[200:203], v[32:35], v[60:63]
ds_read_b128 v[24:27], v8 offset:59392
v_mfma_f32_16x16x32_bf16 v[64:67], a[204:207], v[32:35], v[64:67]
s_waitcnt lgkmcnt(4)
v_mfma_f32_16x16x32_bf16 v[52:55], a[208:211], v[36:39], v[52:55]
ds_read_b128 v[28:31], v9 offset:57344
v_mfma_f32_16x16x32_bf16 v[56:59], a[212:215], v[36:39], v[56:59]
v_mfma_f32_16x16x32_bf16 v[60:63], a[208:211], v[40:43], v[60:63]
ds_read_b128 v[32:35], v9 offset:59392
v_mfma_f32_16x16x32_bf16 v[64:67], a[212:215], v[40:43], v[64:67]
s_waitcnt lgkmcnt(4)
v_mfma_f32_16x16x32_bf16 v[52:55], a[216:219], v[44:47], v[52:55]
ds_read_b128 v[36:39], v8 offset:61440
v_mfma_f32_16x16x32_bf16 v[56:59], a[220:223], v[44:47], v[56:59]
s_waitcnt vmcnt(6)
v_readfirstlane_b32 s56, v100
s_cmp_eq_u32 s30, 1
s_cbranch_scc1 mega_kernel_q_kf0
s_cmp_gt_i32 s56, s42
s_cbranch_scc0 mega_kernel_q_kf0
s_mov_b32 s30, 1
s_mov_b32 m0, s61
s_nop 0
buffer_load_dwordx4 v5, s[84:87], s68 offen sc1 lds
mega_kernel_q_kf0:
v_mfma_f32_16x16x32_bf16 v[60:63], a[216:219], v[48:51], v[60:63]
ds_read_b128 v[40:43], v8 offset:63488
v_mfma_f32_16x16x32_bf16 v[64:67], a[220:223], v[48:51], v[64:67]
s_waitcnt lgkmcnt(4)
v_mfma_f32_16x16x32_bf16 v[52:55], a[224:227], v[20:23], v[52:55]
ds_read_b128 v[44:47], v9 offset:61440
v_mfma_f32_16x16x32_bf16 v[56:59], a[228:231], v[20:23], v[56:59]
v_mfma_f32_16x16x32_bf16 v[60:63], a[224:227], v[24:27], v[60:63]
ds_read_b128 v[48:51], v9 offset:63488
v_mfma_f32_16x16x32_bf16 v[64:67], a[228:231], v[24:27], v[64:67]
s_waitcnt lgkmcnt(5)
v_mfma_f32_16x16x32_bf16 v[52:55], a[232:235], v[28:31], v[52:55]
v_mfma_f32_16x16x32_bf16 v[56:59], a[236:239], v[28:31], v[56:59]
s_waitcnt lgkmcnt(4)
v_mfma_f32_16x16x32_bf16 v[60:63], a[232:235], v[32:35], v[60:63]
v_mfma_f32_16x16x32_bf16 v[64:67], a[236:239], v[32:35], v[64:67]
s_waitcnt lgkmcnt(3)
v_mfma_f32_16x16x32_bf16 v[52:55], a[240:243], v[36:39], v[52:55]
v_mfma_f32_16x16x32_bf16 v[56:59], a[244:247], v[36:39], v[56:59]
s_waitcnt lgkmcnt(2)
v_mfma_f32_16x16x32_bf16 v[60:63], a[240:243], v[40:43], v[60:63]
v_mfma_f32_16x16x32_bf16 v[64:67], a[244:247], v[40:43], v[64:67]
ds_write_b128 v101, v[84:87]
ds_write_b128 v101, v[88:91] offset:1024
s_waitcnt lgkmcnt(1)
v_mfma_f32_16x16x32_bf16 v[68:71], a[248:251], v[44:47], v[52:55]
v_mfma_f32_16x16x32_bf16 v[72:75], a[252:255], v[44:47], v[56:59]
s_waitcnt lgkmcnt(0)
v_mfma_f32_16x16x32_bf16 v[76:79], a[248:251], v[48:51], v[60:63]
v_mfma_f32_16x16x32_bf16 v[80:83], a[252:255], v[48:51], v[64:67]
mega_kernel_q_jl:
s_cmp_eq_u32 s30, 1
s_cbranch_scc1 mega_kernel_q_kl0
mega_kernel_q_kw0:
v_mov_b32 v100, 0
s_mov_b64 exec, 1
buffer_atomic_add v100, v16, s[84:87], s62 offen sc0 sc1
s_mov_b64 exec, -1
s_waitcnt vmcnt(0)
v_readfirstlane_b32 s56, v100
s_cmp_gt_i32 s56, s42
s_cbranch_scc0 mega_kernel_q_kw0
s_mov_b32 m0, s61
s_nop 0
buffer_load_dwordx4 v5, s[84:87], s68 offen sc1 lds
mega_kernel_q_kl0:
s_waitcnt lgkmcnt(0) vmcnt(0)
s_barrier
ds_read_b128 v[184:187], v102 offset:0
ds_read_b128 v[112:115], v103 offset:0
ds_read_b128 v[128:131], v103 offset:1024
ds_read_b128 v[188:191], v102 offset:2048
ds_read_b128 v[116:119], v103 offset:2048
ds_read_b128 v[132:135], v103 offset:3072
ds_read_b128 v[192:195], v102 offset:4096
ds_read_b128 v[120:123], v103 offset:4096
ds_read_b128 v[136:139], v103 offset:5120
ds_read_b128 v[196:199], v102 offset:6144
ds_read_b128 v[124:127], v103 offset:6144
ds_read_b128 v[140:143], v103 offset:7168
s_waitcnt lgkmcnt(9)
v_mfma_f32_16x16x32_bf16 v[200:203], v[112:115], v[184:187], 0
v_mfma_f32_16x16x32_bf16 v[204:207], v[128:131], v[184:187], 0
ds_read_b128 v[160:163], v94 offset:0
s_waitcnt lgkmcnt(7)
v_mfma_f32_16x16x32_bf16 v[200:203], v[116:119], v[188:191], v[200:203]
v_mfma_f32_16x16x32_bf16 v[204:207], v[132:135], v[188:191], v[204:207]
ds_read_b128 v[164:167], v94 offset:1024
s_waitcnt lgkmcnt(5)
v_mfma_f32_16x16x32_bf16 v[200:203], v[120:123], v[192:195], v[200:203]
v_mfma_f32_16x16x32_bf16 v[204:207], v[136:139], v[192:195], v[204:207]
ds_read_b128 v[168:171], v94 offset:2048
s_waitcnt lgkmcnt(3)
v_mfma_f32_16x16x32_bf16 v[200:203], v[124:127], v[196:199], v[200:203]
v_mfma_f32_16x16x32_bf16 v[204:207], v[140:143], v[196:199], v[204:207]
ds_read_b128 v[172:175], v94 offset:3072
s_waitcnt lgkmcnt(3)
v_mfma_f32_16x16x32_bf16 v[208:211], v[160:163], v[184:187], 0
ds_read_b128 v[144:147], v240 offset:0
ds_read_b64 v[176:177], v95 offset:0
s_waitcnt lgkmcnt(4)
v_mfma_f32_16x16x32_bf16 v[208:211], v[164:167], v[188:191], v[208:211]
ds_read_b128 v[148:151], v240 offset:1024
ds_read_b64 v[178:179], v95 offset:256
s_waitcnt lgkmcnt(5)
v_mfma_f32_16x16x32_bf16 v[208:211], v[168:171], v[192:195], v[208:211]
ds_read_b128 v[152:155], v240 offset:2048
ds_read_b64 v[180:181], v95 offset:1024
s_waitcnt lgkmcnt(6)
v_mfma_f32_16x16x32_bf16 v[208:211], v[172:175], v[196:199], v[208:211]
ds_read_b128 v[156:159], v240 offset:3072
ds_read_b64 v[182:183], v95 offset:1280
s_nop 3
v_cndmask_b32 v200, v200, v97, s[12:13]
v_cndmask_b32 v201, v201, v97, s[14:15]
v_cndmask_b32 v202, v202, v97, s[16:17]
v_cndmask_b32 v203, v203, v97, s[18:19]
v_cndmask_b32 v204, v204, v97, s[20:21]
v_cndmask_b32 v205, v205, v97, s[22:23]
v_cndmask_b32 v206, v206, v97, s[24:25]
v_cndmask_b32 v207, v207, v97, s[26:27]
v_cndmask_b32 v208, v208, v97, s[28:29]
v_cndmask_b32 v209, v209, v97, s[28:29]
v_cndmask_b32 v210, v210, v97, s[28:29]
v_cndmask_b32 v211, v211, v97, s[28:29]
v_max3_f32 v236, v200, v201, v202
v_max3_f32 v236, v236, v203, v204
v_max3_f32 v236, v236, v205, v206
v_max3_f32 v236, v236, v207, v208
v_max3_f32 v236, v236, v209, v210
v_max_f32 v237, v236, v211
v_max_f32 v236, v236, v211
s_nop 1
v_permlane16_swap_b32 v236, v237
s_nop 0
v_max_f32 v238, v236, v237
v_max_f32 v239, v236, v237
s_nop 1
v_permlane32_swap_b32 v238, v239
s_nop 0
v_max_f32 v236, v238, v239
v_mul_f32 v236, s54, v236
v_pk_fma_f32 v[200:201], v[200:201], s[54:55], v[236:237] op_sel_hi:[1,0,0] neg_lo:[0,0,1] neg_hi:[0,0,1]
v_pk_fma_f32 v[202:203], v[202:203], s[54:55], v[236:237] op_sel_hi:[1,0,0] neg_lo:[0,0,1] neg_hi:[0,0,1]
v_pk_fma_f32 v[204:205], v[204:205], s[54:55], v[236:237] op_sel_hi:[1,0,0] neg_lo:[0,0,1] neg_hi:[0,0,1]
v_pk_fma_f32 v[206:207], v[206:207], s[54:55], v[236:237] op_sel_hi:[1,0,0] neg_lo:[0,0,1] neg_hi:[0,0,1]
v_pk_fma_f32 v[208:209], v[208:209], s[54:55], v[236:237] op_sel_hi:[1,0,0] neg_lo:[0,0,1] neg_hi:[0,0,1]
v_pk_fma_f32 v[210:211], v[210:211], s[54:55], v[236:237] op_sel_hi:[1,0,0] neg_lo:[0,0,1] neg_hi:[0,0,1]
v_exp_f32 v200, v200
v_exp_f32 v201, v201
v_exp_f32 v202, v202
v_exp_f32 v203, v203
v_exp_f32 v204, v204
v_exp_f32 v205, v205
v_exp_f32 v206, v206
v_exp_f32 v207, v207
v_exp_f32 v208, v208
v_exp_f32 v209, v209
v_exp_f32 v210, v210
v_exp_f32 v211, v211
s_nop 0
v_cvt_pk_bf16_f32 v212, v200, v201
v_cvt_pk_bf16_f32 v213, v202, v203
v_cvt_pk_bf16_f32 v214, v204, v205
v_cvt_pk_bf16_f32 v215, v206, v207
v_cvt_pk_bf16_f32 v216, v208, v209
v_cvt_pk_bf16_f32 v217, v210, v211
s_waitcnt lgkmcnt(0)
s_nop 0
v_mfma_f32_16x16x32_bf16 v[108:111], v[104:107], v[212:215], 0
v_mfma_f32_16x16x32_bf16 v[220:223], v[144:147], v[212:215], 0
v_mfma_f32_16x16x32_bf16 v[224:227], v[148:151], v[212:215], 0
v_mfma_f32_16x16x32_bf16 v[228:231], v[152:155], v[212:215], 0
v_mfma_f32_16x16x32_bf16 v[232:235], v[156:159], v[212:215], 0
v_mfma_f32_16x16x16_bf16 v[108:111], v[104:105], v[216:217], v[108:111]
v_mfma_f32_16x16x16_bf16 v[220:223], v[176:177], v[216:217], v[220:223]
v_mfma_f32_16x16x16_bf16 v[224:227], v[178:179], v[216:217], v[224:227]
v_mfma_f32_16x16x16_bf16 v[228:231], v[180:181], v[216:217], v[228:231]
v_mfma_f32_16x16x16_bf16 v[232:235], v[182:183], v[216:217], v[232:235]
s_lshl_b32 s51, s42, 18
s_nop 2
v_rcp_f32 v238, v108
v_rcp_f32 v239, v109
s_nop 1
v_pk_mul_f32 v[220:221], v[220:221], v[238:239]
v_pk_mul_f32 v[222:223], v[222:223], v[238:239]
v_pk_mul_f32 v[224:225], v[224:225], v[238:239]
v_pk_mul_f32 v[226:227], v[226:227], v[238:239]
v_pk_mul_f32 v[228:229], v[228:229], v[238:239]
v_pk_mul_f32 v[230:231], v[230:231], v[238:239]
v_pk_mul_f32 v[232:233], v[232:233], v[238:239]
v_pk_mul_f32 v[234:235], v[234:235], v[238:239]
v_cvt_pk_bf16_f32 v200, v220, v221
v_cvt_pk_bf16_f32 v201, v222, v223
v_cvt_pk_bf16_f32 v202, v224, v225
v_cvt_pk_bf16_f32 v203, v226, v227
v_cvt_pk_bf16_f32 v204, v228, v229
v_cvt_pk_bf16_f32 v205, v230, v231
v_cvt_pk_bf16_f32 v206, v232, v233
v_cvt_pk_bf16_f32 v207, v234, v235
buffer_store_dwordx4 v[200:203], v96, s[84:87], s51 offen sc1
buffer_store_dwordx4 v[204:207], v96, s[84:87], s51 offen offset:2048 sc1
s_add_u32 s42, s42, 1
s_cmp_lt_u32 s42, 64
s_cbranch_scc1 mega_kernel_q_loop
s_waitcnt vmcnt(0)
v_mov_b32 v17, s42
s_mov_b64 exec, 1
buffer_store_dword v17, v16, s[84:87], s49 offen sc1
s_mov_b64 exec, -1
mega_kernel_q_quit:
s_endpgm
mega_kernel_rd:
s_mov_b32 s93, s40
s_load_dwordx2 s[4:5], s[0:1], 56
s_mov_b32 s48, 0x3f7ec46d
s_mov_b32 s49, 0x3dc8bd36
s_mov_b32 s50, 0x3f7b14be
s_mov_b32 s51, 0x3e47c5c2
s_mov_b32 s52, 0x3f74fa0b
s_mov_b32 s53, 0x3e94a031
s_mov_b32 s54, 0x3f6c835e
s_mov_b32 s55, 0x3ec3ef15
s_mov_b32 s56, 0x3f61c598
s_mov_b32 s57, 0x3ef15aea
s_mov_b32 s58, 0x3f54db31
s_mov_b32 s59, 0x3f0e39da
s_mov_b32 s60, 0x3f45e403
s_mov_b32 s61, 0x3f226799
s_mov_b32 s62, 0x3f3504f3
s_mov_b32 s63, 0x3f3504f3
v_and_b32 v1, 31, v0
v_lshrrev_b32 v2, 5, v0
v_cvt_f32_u32 v3, v1
v_mul_u32_u24 v10, 8448, v2
v_lshl_add_u32 v4, v1, 3, v10
v_mul_u32_u24 v5, 264, v1
v_add_u32 v5, v5, v10
v_and_b32 v11, 7, v0
v_lshrrev_b32 v9, 3, v0
v_mul_u32_u24 v10, 8448, v11
v_lshl_add_u32 v6, v9, 3, v10
v_lshlrev_b32 v7, 3, v9
v_sub_u32 v7, v10, v7
v_add_u32 v7, 4096, v7
v_lshlrev_b32 v8, 14, v9
v_lshl_add_u32 v8, v11, 4, v8
v_mul_f32 v12, 0xba800000, v3
v_cos_f32 v82, v12
v_sin_f32 v83, v12
v_mul_f32 v12, 0xbb000000, v3
v_cos_f32 v84, v12
v_sin_f32 v85, v12
v_mul_f32 v12, 0xbb400000, v3
v_cos_f32 v86, v12
v_sin_f32 v87, v12
v_mul_f32 v12, 0xbb800000, v3
v_cos_f32 v88, v12
v_sin_f32 v89, v12
v_mul_f32 v12, 0xbba00000, v3
v_cos_f32 v90, v12
v_sin_f32 v91, v12
v_mul_f32 v12, 0xbbc00000, v3
v_cos_f32 v92, v12
v_sin_f32 v93, v12
v_mul_f32 v12, 0xbbe00000, v3
v_cos_f32 v94, v12
v_sin_f32 v95, v12
v_mul_f32 v12, 0xbc000000, v3
v_cos_f32 v96, v12
v_sin_f32 v97, v12
v_mul_f32 v12, 0xbc100000, v3
v_cos_f32 v98, v12
v_sin_f32 v99, v12
v_mul_f32 v12, 0xbc200000, v3
v_cos_f32 v100, v12
v_sin_f32 v101, v12
v_mul_f32 v12, 0xbc300000, v3
v_cos_f32 v102, v12
v_sin_f32 v103, v12
v_mul_f32 v12, 0xbc400000, v3
v_cos_f32 v104, v12
v_sin_f32 v105, v12
v_mul_f32 v12, 0xbc500000, v3
v_cos_f32 v106, v12
v_sin_f32 v107, v12
v_mul_f32 v12, 0xbc600000, v3
v_cos_f32 v108, v12
v_sin_f32 v109, v12
v_mul_f32 v12, 0xbc700000, v3
v_cos_f32 v110, v12
v_sin_f32 v111, v12
v_mul_f32 v12, 0xbc800000, v3
v_cos_f32 v112, v12
v_sin_f32 v113, v12
v_mul_f32 v12, 0xbc880000, v3
v_cos_f32 v114, v12
v_sin_f32 v115, v12
v_mul_f32 v12, 0xbc900000, v3
v_cos_f32 v116, v12
v_sin_f32 v117, v12
v_mul_f32 v12, 0xbc980000, v3
v_cos_f32 v118, v12
v_sin_f32 v119, v12
v_mul_f32 v12, 0xbca00000, v3
v_cos_f32 v120, v12
v_sin_f32 v121, v12
v_mul_f32 v12, 0xbca80000, v3
v_cos_f32 v122, v12
v_sin_f32 v123, v12
v_mul_f32 v12, 0xbcb00000, v3
v_cos_f32 v124, v12
v_sin_f32 v125, v12
v_mul_f32 v12, 0xbcb80000, v3
v_cos_f32 v126, v12
v_sin_f32 v127, v12
v_mul_f32 v12, 0xbcc00000, v3
v_cos_f32 v128, v12
v_sin_f32 v129, v12
v_mul_f32 v12, 0xbcc80000, v3
v_cos_f32 v130, v12
v_sin_f32 v131, v12
v_mul_f32 v12, 0xbcd00000, v3
v_cos_f32 v132, v12
v_sin_f32 v133, v12
v_mul_f32 v12, 0xbcd80000, v3
v_cos_f32 v134, v12
v_sin_f32 v135, v12
v_mul_f32 v12, 0xbce00000, v3
v_cos_f32 v136, v12
v_sin_f32 v137, v12
v_mul_f32 v12, 0xbce80000, v3
v_cos_f32 v138, v12
v_sin_f32 v139, v12
v_mul_f32 v12, 0xbcf00000, v3
v_cos_f32 v140, v12
v_sin_f32 v141, v12
v_mul_f32 v12, 0xbcf80000, v3
v_cos_f32 v142, v12
v_sin_f32 v143, v12
v_lshlrev_b32 v12, 12, v2
v_lshl_add_u32 v12, v1, 1, v12
s_waitcnt lgkmcnt(0)
s_mov_b32 s6, 4194304
s_mov_b32 s7, 0x00020000
v_mov_b32 v144, 0
v_mov_b32 v145, 0
v_mov_b32 v146, 0
v_mov_b32 v147, 0
v_mov_b32 v148, 0
v_mov_b32 v149, 0
v_mov_b32 v150, 0
v_mov_b32 v151, 0
v_mov_b32 v152, 0
v_mov_b32 v153, 0
v_mov_b32 v154, 0
v_mov_b32 v155, 0
v_mov_b32 v156, 0
v_mov_b32 v157, 0
v_mov_b32 v158, 0
v_mov_b32 v159, 0
v_mov_b32 v160, 0
v_mov_b32 v161, 0
v_mov_b32 v162, 0
v_mov_b32 v163, 0
v_mov_b32 v164, 0
v_mov_b32 v165, 0
v_mov_b32 v166, 0
v_mov_b32 v167, 0
v_mov_b32 v168, 0
v_mov_b32 v169, 0
v_mov_b32 v170, 0
v_mov_b32 v171, 0
v_mov_b32 v172, 0
v_mov_b32 v173, 0
v_mov_b32 v174, 0
v_mov_b32 v175, 0
v_mov_b32 v176, 0
v_mov_b32 v177, 0
v_mov_b32 v178, 0
v_mov_b32 v179, 0
v_mov_b32 v180, 0
v_mov_b32 v181, 0
v_mov_b32 v182, 0
v_mov_b32 v183, 0
v_mov_b32 v184, 0
v_mov_b32 v185, 0
v_mov_b32 v186, 0
v_mov_b32 v187, 0
v_mov_b32 v188, 0
v_mov_b32 v189, 0
v_mov_b32 v190, 0
v_mov_b32 v191, 0
v_mov_b32 v192, 0
v_mov_b32 v193, 0
v_mov_b32 v194, 0
v_mov_b32 v195, 0
v_mov_b32 v196, 0
v_mov_b32 v197, 0
v_mov_b32 v198, 0
v_mov_b32 v199, 0
v_mov_b32 v200, 0
v_mov_b32 v201, 0
v_mov_b32 v202, 0
v_mov_b32 v203, 0
v_mov_b32 v204, 0
v_mov_b32 v205, 0
v_mov_b32 v206, 0
v_mov_b32 v207, 0
s_cmp_lt_u32 s93, 128
s_cbranch_scc0 mega_kernel_f1_e
s_lshl_b32 s12, s93, 15
buffer_load_short_d16_hi v144, v12, s[4:7], s12 offen offset:0
buffer_load_short_d16_hi v145, v12, s[4:7], s12 offen offset:2048
buffer_load_short_d16_hi v176, v12, s[4:7], s12 offen offset:1024
buffer_load_short_d16_hi v177, v12, s[4:7], s12 offen offset:3072
buffer_load_short_d16_hi v146, v12, s[4:7], s12 offen offset:64
buffer_load_short_d16_hi v147, v12, s[4:7], s12 offen offset:2112
buffer_load_short_d16_hi v178, v12, s[4:7], s12 offen offset:1088
buffer_load_short_d16_hi v179, v12, s[4:7], s12 offen offset:3136
buffer_load_short_d16_hi v148, v12, s[4:7], s12 offen offset:128
buffer_load_short_d16_hi v149, v12, s[4:7], s12 offen offset:2176
buffer_load_short_d16_hi v180, v12, s[4:7], s12 offen offset:1152
buffer_load_short_d16_hi v181, v12, s[4:7], s12 offen offset:3200
buffer_load_short_d16_hi v150, v12, s[4:7], s12 offen offset:192
buffer_load_short_d16_hi v151, v12, s[4:7], s12 offen offset:2240
buffer_load_short_d16_hi v182, v12, s[4:7], s12 offen offset:1216
buffer_load_short_d16_hi v183, v12, s[4:7], s12 offen offset:3264
buffer_load_short_d16_hi v152, v12, s[4:7], s12 offen offset:256
buffer_load_short_d16_hi v153, v12, s[4:7], s12 offen offset:2304
buffer_load_short_d16_hi v184, v12, s[4:7], s12 offen offset:1280
buffer_load_short_d16_hi v185, v12, s[4:7], s12 offen offset:3328
buffer_load_short_d16_hi v154, v12, s[4:7], s12 offen offset:320
buffer_load_short_d16_hi v155, v12, s[4:7], s12 offen offset:2368
buffer_load_short_d16_hi v186, v12, s[4:7], s12 offen offset:1344
buffer_load_short_d16_hi v187, v12, s[4:7], s12 offen offset:3392
buffer_load_short_d16_hi v156, v12, s[4:7], s12 offen offset:384
buffer_load_short_d16_hi v157, v12, s[4:7], s12 offen offset:2432
buffer_load_short_d16_hi v188, v12, s[4:7], s12 offen offset:1408
buffer_load_short_d16_hi v189, v12, s[4:7], s12 offen offset:3456
buffer_load_short_d16_hi v158, v12, s[4:7], s12 offen offset:448
buffer_load_short_d16_hi v159, v12, s[4:7], s12 offen offset:2496
buffer_load_short_d16_hi v190, v12, s[4:7], s12 offen offset:1472
buffer_load_short_d16_hi v191, v12, s[4:7], s12 offen offset:3520
buffer_load_short_d16_hi v160, v12, s[4:7], s12 offen offset:512
buffer_load_short_d16_hi v161, v12, s[4:7], s12 offen offset:2560
buffer_load_short_d16_hi v192, v12, s[4:7], s12 offen offset:1536
buffer_load_short_d16_hi v193, v12, s[4:7], s12 offen offset:3584
buffer_load_short_d16_hi v162, v12, s[4:7], s12 offen offset:576
buffer_load_short_d16_hi v163, v12, s[4:7], s12 offen offset:2624
buffer_load_short_d16_hi v194, v12, s[4:7], s12 offen offset:1600
buffer_load_short_d16_hi v195, v12, s[4:7], s12 offen offset:3648
buffer_load_short_d16_hi v164, v12, s[4:7], s12 offen offset:640
buffer_load_short_d16_hi v165, v12, s[4:7], s12 offen offset:2688
buffer_load_short_d16_hi v196, v12, s[4:7], s12 offen offset:1664
buffer_load_short_d16_hi v197, v12, s[4:7], s12 offen offset:3712
buffer_load_short_d16_hi v166, v12, s[4:7], s12 offen offset:704
buffer_load_short_d16_hi v167, v12, s[4:7], s12 offen offset:2752
buffer_load_short_d16_hi v198, v12, s[4:7], s12 offen offset:1728
buffer_load_short_d16_hi v199, v12, s[4:7], s12 offen offset:3776
buffer_load_short_d16_hi v168, v12, s[4:7], s12 offen offset:768
buffer_load_short_d16_hi v169, v12, s[4:7], s12 offen offset:2816
buffer_load_short_d16_hi v200, v12, s[4:7], s12 offen offset:1792
buffer_load_short_d16_hi v201, v12, s[4:7], s12 offen offset:3840
buffer_load_short_d16_hi v170, v12, s[4:7], s12 offen offset:832
buffer_load_short_d16_hi v171, v12, s[4:7], s12 offen offset:2880
buffer_load_short_d16_hi v202, v12, s[4:7], s12 offen offset:1856
buffer_load_short_d16_hi v203, v12, s[4:7], s12 offen offset:3904
buffer_load_short_d16_hi v172, v12, s[4:7], s12 offen offset:896
buffer_load_short_d16_hi v173, v12, s[4:7], s12 offen offset:2944
buffer_load_short_d16_hi v204, v12, s[4:7], s12 offen offset:1920
buffer_load_short_d16_hi v205, v12, s[4:7], s12 offen offset:3968
buffer_load_short_d16_hi v174, v12, s[4:7], s12 offen offset:960
buffer_load_short_d16_hi v175, v12, s[4:7], s12 offen offset:3008
buffer_load_short_d16_hi v206, v12, s[4:7], s12 offen offset:1984
buffer_load_short_d16_hi v207, v12, s[4:7], s12 offen offset:4032
s_waitcnt vmcnt(0)
mega_kernel_f1_l:
s_add_u32 s21, s93, 32
s_cmp_lt_u32 s21, 128
s_cselect_b32 s22, s21, s93
s_waitcnt vmcnt(17)
v_pk_add_f32 v[48:49], v[144:145], v[176:177] neg_lo:[0,1] neg_hi:[0,1]
v_pk_add_f32 v[16:17], v[144:145], v[176:177]
v_pk_add_f32 v[14:15], v[146:147], v[178:179] neg_lo:[0,1] neg_hi:[0,1]
v_pk_add_f32 v[18:19], v[146:147], v[178:179]
v_pk_mul_f32 v[50:51], v[14:15], s[50:51] op_sel:[0,0] op_sel_hi:[0,1] neg_lo:[0,0] neg_hi:[0,1]
v_pk_fma_f32 v[50:51], v[14:15], s[50:51], v[50:51] op_sel:[1,1,0] op_sel_hi:[1,0,1] neg_lo:[0,0,0] neg_hi:[0,0,0]
v_pk_add_f32 v[14:15], v[148:149], v[180:181] neg_lo:[0,1] neg_hi:[0,1]
v_pk_add_f32 v[20:21], v[148:149], v[180:181]
v_pk_mul_f32 v[52:53], v[14:15], s[54:55] op_sel:[0,0] op_sel_hi:[0,1] neg_lo:[0,0] neg_hi:[0,1]
v_pk_fma_f32 v[52:53], v[14:15], s[54:55], v[52:53] op_sel:[1,1,0] op_sel_hi:[1,0,1] neg_lo:[0,0,0] neg_hi:[0,0,0]
v_pk_add_f32 v[14:15], v[150:151], v[182:183] neg_lo:[0,1] neg_hi:[0,1]
v_pk_add_f32 v[22:23], v[150:151], v[182:183]
v_pk_mul_f32 v[54:55], v[14:15], s[58:59] op_sel:[0,0] op_sel_hi:[0,1] neg_lo:[0,0] neg_hi:[0,1]
v_pk_fma_f32 v[54:55], v[14:15], s[58:59], v[54:55] op_sel:[1,1,0] op_sel_hi:[1,0,1] neg_lo:[0,0,0] neg_hi:[0,0,0]
v_pk_add_f32 v[14:15], v[152:153], v[184:185] neg_lo:[0,1] neg_hi:[0,1]
v_pk_add_f32 v[24:25], v[152:153], v[184:185]
v_pk_mul_f32 v[56:57], v[14:15], s[62:63] op_sel:[0,0] op_sel_hi:[0,1] neg_lo:[0,0] neg_hi:[0,1]
v_pk_fma_f32 v[56:57], v[14:15], s[62:63], v[56:57] op_sel:[1,1,0] op_sel_hi:[1,0,1] neg_lo:[0,0,0] neg_hi:[0,0,0]
v_pk_add_f32 v[14:15], v[154:155], v[186:187] neg_lo:[0,1] neg_hi:[0,1]
v_pk_add_f32 v[26:27], v[154:155], v[186:187]
v_pk_mul_f32 v[58:59], v[14:15], s[58:59] op_sel:[0,1] op_sel_hi:[0,0] neg_lo:[0,0] neg_hi:[0,1]
v_pk_fma_f32 v[58:59], v[14:15], s[58:59], v[58:59] op_sel:[1,0,0] op_sel_hi:[1,1,1] neg_lo:[0,0,0] neg_hi:[0,0,0]
v_pk_add_f32 v[14:15], v[156:157], v[188:189] neg_lo:[0,1] neg_hi:[0,1]
v_pk_add_f32 v[28:29], v[156:157], v[188:189]
v_pk_mul_f32 v[60:61], v[14:15], s[54:55] op_sel:[0,1] op_sel_hi:[0,0] neg_lo:[0,0] neg_hi:[0,1]
v_pk_fma_f32 v[60:61], v[14:15], s[54:55], v[60:61] op_sel:[1,0,0] op_sel_hi:[1,1,1] neg_lo:[0,0,0] neg_hi:[0,0,0]
v_pk_add_f32 v[14:15], v[158:159], v[190:191] neg_lo:[0,1] neg_hi:[0,1]
v_pk_add_f32 v[30:31], v[158:159], v[190:191]
v_pk_mul_f32 v[62:63], v[14:15], s[50:51] op_sel:[0,1] op_sel_hi:[0,0] neg_lo:[0,0] neg_hi:[0,1]
v_pk_fma_f32 v[62:63], v[14:15], s[50:51], v[62:63] op_sel:[1,0,0] op_sel_hi:[1,1,1] neg_lo:[0,0,0] neg_hi:[0,0,0]
v_pk_add_f32 v[64:65], v[160:161], v[192:193] op_sel:[1,1] op_sel_hi:[0,0] neg_lo:[0,1] neg_hi:[1,0]
v_pk_add_f32 v[32:33], v[160:161], v[192:193]
v_pk_add_f32 v[14:15], v[162:163], v[194:195] neg_lo:[0,1] neg_hi:[0,1]
v_pk_add_f32 v[34:35], v[162:163], v[194:195]
v_pk_mul_f32 v[66:67], v[14:15], s[50:51] op_sel:[0,1] op_sel_hi:[0,0] neg_lo:[0,1] neg_hi:[0,1]
v_pk_fma_f32 v[66:67], v[14:15], s[50:51], v[66:67] op_sel:[1,0,0] op_sel_hi:[1,1,1] neg_lo:[0,0,0] neg_hi:[0,1,0]
v_pk_add_f32 v[14:15], v[164:165], v[196:197] neg_lo:[0,1] neg_hi:[0,1]
v_pk_add_f32 v[36:37], v[164:165], v[196:197]
v_pk_mul_f32 v[68:69], v[14:15], s[54:55] op_sel:[0,1] op_sel_hi:[0,0] neg_lo:[0,1] neg_hi:[0,1]
v_pk_fma_f32 v[68:69], v[14:15], s[54:55], v[68:69] op_sel:[1,0,0] op_sel_hi:[1,1,1] neg_lo:[0,0,0] neg_hi:[0,1,0]
v_pk_add_f32 v[14:15], v[166:167], v[198:199] neg_lo:[0,1] neg_hi:[0,1]
v_pk_add_f32 v[38:39], v[166:167], v[198:199]
v_pk_mul_f32 v[70:71], v[14:15], s[58:59] op_sel:[0,1] op_sel_hi:[0,0] neg_lo:[0,1] neg_hi:[0,1]
v_pk_fma_f32 v[70:71], v[14:15], s[58:59], v[70:71] op_sel:[1,0,0] op_sel_hi:[1,1,1] neg_lo:[0,0,0] neg_hi:[0,1,0]
v_pk_add_f32 v[14:15], v[168:169], v[200:201] neg_lo:[0,1] neg_hi:[0,1]
v_pk_add_f32 v[40:41], v[168:169], v[200:201]
v_pk_mul_f32 v[72:73], v[14:15], s[62:63] op_sel:[0,0] op_sel_hi:[0,1] neg_lo:[0,1] neg_hi:[0,1]
v_pk_fma_f32 v[72:73], v[14:15], s[62:63], v[72:73] op_sel:[1,1,0] op_sel_hi:[1,0,1] neg_lo:[0,0,0] neg_hi:[0,1,0]
v_pk_add_f32 v[14:15], v[170:171], v[202:203] neg_lo:[0,1] neg_hi:[0,1]
v_pk_add_f32 v[42:43], v[170:171], v[202:203]
v_pk_mul_f32 v[74:75], v[14:15], s[58:59] op_sel:[0,0] op_sel_hi:[0,1] neg_lo:[0,1] neg_hi:[0,1]
v_pk_fma_f32 v[74:75], v[14:15], s[58:59], v[74:75] op_sel:[1,1,0] op_sel_hi:[1,0,1] neg_lo:[0,0,0] neg_hi:[0,1,0]
v_pk_add_f32 v[14:15], v[172:173], v[204:205] neg_lo:[0,1] neg_hi:[0,1]
v_pk_add_f32 v[44:45], v[172:173], v[204:205]
v_pk_mul_f32 v[76:77], v[14:15], s[54:55] op_sel:[0,0] op_sel_hi:[0,1] neg_lo:[0,1] neg_hi:[0,1]
v_pk_fma_f32 v[76:77], v[14:15], s[54:55], v[76:77] op_sel:[1,1,0] op_sel_hi:[1,0,1] neg_lo:[0,0,0] neg_hi:[0,1,0]
v_pk_add_f32 v[14:15], v[174:175], v[206:207] neg_lo:[0,1] neg_hi:[0,1]
v_pk_add_f32 v[46:47], v[174:175], v[206:207]
v_pk_mul_f32 v[78:79], v[14:15], s[50:51] op_sel:[0,0] op_sel_hi:[0,1] neg_lo:[0,1] neg_hi:[0,1]
v_pk_fma_f32 v[78:79], v[14:15], s[50:51], v[78:79] op_sel:[1,1,0] op_sel_hi:[1,0,1] neg_lo:[0,0,0] neg_hi:[0,1,0]
s_lshl_b32 s12, s22, 15
buffer_load_short_d16_hi v144, v12, s[4:7], s12 offen offset:0
buffer_load_short_d16_hi v145, v12, s[4:7], s12 offen offset:2048
buffer_load_short_d16_hi v176, v12, s[4:7], s12 offen offset:1024
buffer_load_short_d16_hi v177, v12, s[4:7], s12 offen offset:3072
buffer_load_short_d16_hi v146, v12, s[4:7], s12 offen offset:64
buffer_load_short_d16_hi v147, v12, s[4:7], s12 offen offset:2112
buffer_load_short_d16_hi v178, v12, s[4:7], s12 offen offset:1088
buffer_load_short_d16_hi v179, v12, s[4:7], s12 offen offset:3136
buffer_load_short_d16_hi v148, v12, s[4:7], s12 offen offset:128
buffer_load_short_d16_hi v149, v12, s[4:7], s12 offen offset:2176
buffer_load_short_d16_hi v180, v12, s[4:7], s12 offen offset:1152
buffer_load_short_d16_hi v181, v12, s[4:7], s12 offen offset:3200
buffer_load_short_d16_hi v150, v12, s[4:7], s12 offen offset:192
buffer_load_short_d16_hi v151, v12, s[4:7], s12 offen offset:2240
buffer_load_short_d16_hi v182, v12, s[4:7], s12 offen offset:1216
buffer_load_short_d16_hi v183, v12, s[4:7], s12 offen offset:3264
buffer_load_short_d16_hi v152, v12, s[4:7], s12 offen offset:256
buffer_load_short_d16_hi v153, v12, s[4:7], s12 offen offset:2304
buffer_load_short_d16_hi v184, v12, s[4:7], s12 offen offset:1280
buffer_load_short_d16_hi v185, v12, s[4:7], s12 offen offset:3328
buffer_load_short_d16_hi v154, v12, s[4:7], s12 offen offset:320
buffer_load_short_d16_hi v155, v12, s[4:7], s12 offen offset:2368
buffer_load_short_d16_hi v186, v12, s[4:7], s12 offen offset:1344
buffer_load_short_d16_hi v187, v12, s[4:7], s12 offen offset:3392
buffer_load_short_d16_hi v156, v12, s[4:7], s12 offen offset:384
buffer_load_short_d16_hi v157, v12, s[4:7], s12 offen offset:2432
buffer_load_short_d16_hi v188, v12, s[4:7], s12 offen offset:1408
buffer_load_short_d16_hi v189, v12, s[4:7], s12 offen offset:3456
buffer_load_short_d16_hi v158, v12, s[4:7], s12 offen offset:448
buffer_load_short_d16_hi v159, v12, s[4:7], s12 offen offset:2496
buffer_load_short_d16_hi v190, v12, s[4:7], s12 offen offset:1472
buffer_load_short_d16_hi v191, v12, s[4:7], s12 offen offset:3520
buffer_load_short_d16_hi v160, v12, s[4:7], s12 offen offset:512
buffer_load_short_d16_hi v161, v12, s[4:7], s12 offen offset:2560
buffer_load_short_d16_hi v192, v12, s[4:7], s12 offen offset:1536
buffer_load_short_d16_hi v193, v12, s[4:7], s12 offen offset:3584
buffer_load_short_d16_hi v162, v12, s[4:7], s12 offen offset:576
buffer_load_short_d16_hi v163, v12, s[4:7], s12 offen offset:2624
buffer_load_short_d16_hi v194, v12, s[4:7], s12 offen offset:1600
buffer_load_short_d16_hi v195, v12, s[4:7], s12 offen offset:3648
buffer_load_short_d16_hi v164, v12, s[4:7], s12 offen offset:640
buffer_load_short_d16_hi v165, v12, s[4:7], s12 offen offset:2688
buffer_load_short_d16_hi v196, v12, s[4:7], s12 offen offset:1664
buffer_load_short_d16_hi v197, v12, s[4:7], s12 offen offset:3712
buffer_load_short_d16_hi v166, v12, s[4:7], s12 offen offset:704
buffer_load_short_d16_hi v167, v12, s[4:7], s12 offen offset:2752
buffer_load_short_d16_hi v198, v12, s[4:7], s12 offen offset:1728
buffer_load_short_d16_hi v199, v12, s[4:7], s12 offen offset:3776
buffer_load_short_d16_hi v168, v12, s[4:7], s12 offen offset:768
buffer_load_short_d16_hi v169, v12, s[4:7], s12 offen offset:2816
buffer_load_short_d16_hi v200, v12, s[4:7], s12 offen offset:1792
buffer_load_short_d16_hi v201, v12, s[4:7], s12 offen offset:3840
buffer_load_short_d16_hi v170, v12, s[4:7], s12 offen offset:832
buffer_load_short_d16_hi v171, v12, s[4:7], s12 offen offset:2880
buffer_load_short_d16_hi v202, v12, s[4:7], s12 offen offset:1856
buffer_load_short_d16_hi v203, v12, s[4:7], s12 offen offset:3904
buffer_load_short_d16_hi v172, v12, s[4:7], s12 offen offset:896
buffer_load_short_d16_hi v173, v12, s[4:7], s12 offen offset:2944
buffer_load_short_d16_hi v204, v12, s[4:7], s12 offen offset:1920
buffer_load_short_d16_hi v205, v12, s[4:7], s12 offen offset:3968
buffer_load_short_d16_hi v174, v12, s[4:7], s12 offen offset:960
buffer_load_short_d16_hi v175, v12, s[4:7], s12 offen offset:3008
buffer_load_short_d16_hi v206, v12, s[4:7], s12 offen offset:1984
buffer_load_short_d16_hi v207, v12, s[4:7], s12 offen offset:4032
v_pk_add_f32 v[14:15], v[16:17], v[32:33] neg_lo:[0,1] neg_hi:[0,1]
v_pk_add_f32 v[16:17], v[16:17], v[32:33]
v_pk_add_f32 v[32:33], v[18:19], v[34:35] neg_lo:[0,1] neg_hi:[0,1]
v_pk_add_f32 v[18:19], v[18:19], v[34:35]
v_pk_mul_f32 v[34:35], v[32:33], s[54:55] op_sel:[0,0] op_sel_hi:[0,1] neg_lo:[0,0] neg_hi:[0,1]
v_pk_fma_f32 v[34:35], v[32:33], s[54:55], v[34:35] op_sel:[1,1,0] op_sel_hi:[1,0,1] neg_lo:[0,0,0] neg_hi:[0,0,0]
v_pk_add_f32 v[32:33], v[20:21], v[36:37] neg_lo:[0,1] neg_hi:[0,1]
v_pk_add_f32 v[20:21], v[20:21], v[36:37]
v_pk_mul_f32 v[36:37], v[32:33], s[62:63] op_sel:[0,0] op_sel_hi:[0,1] neg_lo:[0,0] neg_hi:[0,1]
v_pk_fma_f32 v[36:37], v[32:33], s[62:63], v[36:37] op_sel:[1,1,0] op_sel_hi:[1,0,1] neg_lo:[0,0,0] neg_hi:[0,0,0]
v_pk_add_f32 v[32:33], v[22:23], v[38:39] neg_lo:[0,1] neg_hi:[0,1]
v_pk_add_f32 v[22:23], v[22:23], v[38:39]
v_pk_mul_f32 v[38:39], v[32:33], s[54:55] op_sel:[0,1] op_sel_hi:[0,0] neg_lo:[0,0] neg_hi:[0,1]
v_pk_fma_f32 v[38:39], v[32:33], s[54:55], v[38:39] op_sel:[1,0,0] op_sel_hi:[1,1,1] neg_lo:[0,0,0] neg_hi:[0,0,0]
v_pk_add_f32 v[32:33], v[24:25], v[40:41] op_sel:[1,1] op_sel_hi:[0,0] neg_lo:[0,1] neg_hi:[1,0]
v_pk_add_f32 v[24:25], v[24:25], v[40:41]
v_pk_add_f32 v[40:41], v[26:27], v[42:43] neg_lo:[0,1] neg_hi:[0,1]
v_pk_add_f32 v[26:27], v[26:27], v[42:43]
v_pk_mul_f32 v[42:43], v[40:41], s[54:55] op_sel:[0,1] op_sel_hi:[0,0] neg_lo:[0,1] neg_hi:[0,1]
v_pk_fma_f32 v[42:43], v[40:41], s[54:55], v[42:43] op_sel:[1,0,0] op_sel_hi:[1,1,1] neg_lo:[0,0,0] neg_hi:[0,1,0]
v_pk_add_f32 v[40:41], v[28:29], v[44:45] neg_lo:[0,1] neg_hi:[0,1]
v_pk_add_f32 v[28:29], v[28:29], v[44:45]
v_pk_mul_f32 v[44:45], v[40:41], s[62:63] op_sel:[0,0] op_sel_hi:[0,1] neg_lo:[0,1] neg_hi:[0,1]
v_pk_fma_f32 v[44:45], v[40:41], s[62:63], v[44:45] op_sel:[1,1,0] op_sel_hi:[1,0,1] neg_lo:[0,0,0] neg_hi:[0,1,0]
v_pk_add_f32 v[40:41], v[30:31], v[46:47] neg_lo:[0,1] neg_hi:[0,1]
v_pk_add_f32 v[30:31], v[30:31], v[46:47]
v_pk_mul_f32 v[46:47], v[40:41], s[54:55] op_sel:[0,0] op_sel_hi:[0,1] neg_lo:[0,1] neg_hi:[0,1]
v_pk_fma_f32 v[46:47], v[40:41], s[54:55], v[46:47] op_sel:[1,1,0] op_sel_hi:[1,0,1] neg_lo:[0,0,0] neg_hi:[0,1,0]
v_pk_add_f32 v[40:41], v[48:49], v[64:65] neg_lo:[0,1] neg_hi:[0,1]
v_pk_add_f32 v[48:49], v[48:49], v[64:65]
v_pk_add_f32 v[64:65], v[50:51], v[66:67] neg_lo:[0,1] neg_hi:[0,1]
v_pk_add_f32 v[50:51], v[50:51], v[66:67]
v_pk_mul_f32 v[66:67], v[64:65], s[54:55] op_sel:[0,0] op_sel_hi:[0,1] neg_lo:[0,0] neg_hi:[0,1]
v_pk_fma_f32 v[66:67], v[64:65], s[54:55], v[66:67] op_sel:[1,1,0] op_sel_hi:[1,0,1] neg_lo:[0,0,0] neg_hi:[0,0,0]
v_pk_add_f32 v[64:65], v[52:53], v[68:69] neg_lo:[0,1] neg_hi:[0,1]
v_pk_add_f32 v[52:53], v[52:53], v[68:69]
v_pk_mul_f32 v[68:69], v[64:65], s[62:63] op_sel:[0,0] op_sel_hi:[0,1] neg_lo:[0,0] neg_hi:[0,1]
v_pk_fma_f32 v[68:69], v[64:65], s[62:63], v[68:69] op_sel:[1,1,0] op_sel_hi:[1,0,1] neg_lo:[0,0,0] neg_hi:[0,0,0]
v_pk_add_f32 v[64:65], v[54:55], v[70:71] neg_lo:[0,1] neg_hi:[0,1]
v_pk_add_f32 v[54:55], v[54:55], v[70:71]
v_pk_mul_f32 v[70:71], v[64:65], s[54:55] op_sel:[0,1] op_sel_hi:[0,0] neg_lo:[0,0] neg_hi:[0,1]
v_pk_fma_f32 v[70:71], v[64:65], s[54:55], v[70:71] op_sel:[1,0,0] op_sel_hi:[1,1,1] neg_lo:[0,0,0] neg_hi:[0,0,0]
v_pk_add_f32 v[64:65], v[56:57], v[72:73] op_sel:[1,1] op_sel_hi:[0,0] neg_lo:[0,1] neg_hi:[1,0]
v_pk_add_f32 v[56:57], v[56:57], v[72:73]
v_pk_add_f32 v[72:73], v[58:59], v[74:75] neg_lo:[0,1] neg_hi:[0,1]
v_pk_add_f32 v[58:59], v[58:59], v[74:75]
v_pk_mul_f32 v[74:75], v[72:73], s[54:55] op_sel:[0,1] op_sel_hi:[0,0] neg_lo:[0,1] neg_hi:[0,1]
v_pk_fma_f32 v[74:75], v[72:73], s[54:55], v[74:75] op_sel:[1,0,0] op_sel_hi:[1,1,1] neg_lo:[0,0,0] neg_hi:[0,1,0]
v_pk_add_f32 v[72:73], v[60:61], v[76:77] neg_lo:[0,1] neg_hi:[0,1]
v_pk_add_f32 v[60:61], v[60:61], v[76:77]
v_pk_mul_f32 v[76:77], v[72:73], s[62:63] op_sel:[0,0] op_sel_hi:[0,1] neg_lo:[0,1] neg_hi:[0,1]
v_pk_fma_f32 v[76:77], v[72:73], s[62:63], v[76:77] op_sel:[1,1,0] op_sel_hi:[1,0,1] neg_lo:[0,0,0] neg_hi:[0,1,0]
v_pk_add_f32 v[72:73], v[62:63], v[78:79] neg_lo:[0,1] neg_hi:[0,1]
v_pk_add_f32 v[62:63], v[62:63], v[78:79]
v_pk_mul_f32 v[78:79], v[72:73], s[54:55] op_sel:[0,0] op_sel_hi:[0,1] neg_lo:[0,1] neg_hi:[0,1]
v_pk_fma_f32 v[78:79], v[72:73], s[54:55], v[78:79] op_sel:[1,1,0] op_sel_hi:[1,0,1] neg_lo:[0,0,0] neg_hi:[0,1,0]
v_pk_add_f32 v[72:73], v[16:17], v[24:25] neg_lo:[0,1] neg_hi:[0,1]
v_pk_add_f32 v[16:17], v[16:17], v[24:25]
v_pk_add_f32 v[24:25], v[18:19], v[26:27] neg_lo:[0,1] neg_hi:[0,1]
v_pk_add_f32 v[18:19], v[18:19], v[26:27]
v_pk_mul_f32 v[26:27], v[24:25], s[62:63] op_sel:[0,0] op_sel_hi:[0,1] neg_lo:[0,0] neg_hi:[0,1]
v_pk_fma_f32 v[26:27], v[24:25], s[62:63], v[26:27] op_sel:[1,1,0] op_sel_hi:[1,0,1] neg_lo:[0,0,0] neg_hi:[0,0,0]
v_pk_add_f32 v[24:25], v[20:21], v[28:29] op_sel:[1,1] op_sel_hi:[0,0] neg_lo:[0,1] neg_hi:[1,0]
v_pk_add_f32 v[20:21], v[20:21], v[28:29]
v_pk_add_f32 v[28:29], v[22:23], v[30:31] neg_lo:[0,1] neg_hi:[0,1]
v_pk_add_f32 v[22:23], v[22:23], v[30:31]
v_pk_mul_f32 v[30:31], v[28:29], s[62:63] op_sel:[0,0] op_sel_hi:[0,1] neg_lo:[0,1] neg_hi:[0,1]
v_pk_fma_f32 v[30:31], v[28:29], s[62:63], v[30:31] op_sel:[1,1,0] op_sel_hi:[1,0,1] neg_lo:[0,0,0] neg_hi:[0,1,0]
v_pk_add_f32 v[28:29], v[14:15], v[32:33] neg_lo:[0,1] neg_hi:[0,1]
v_pk_add_f32 v[14:15], v[14:15], v[32:33]
v_pk_add_f32 v[32:33], v[34:35], v[42:43] neg_lo:[0,1] neg_hi:[0,1]
v_pk_add_f32 v[34:35], v[34:35], v[42:43]
v_pk_mul_f32 v[42:43], v[32:33], s[62:63] op_sel:[0,0] op_sel_hi:[0,1] neg_lo:[0,0] neg_hi:[0,1]
v_pk_fma_f32 v[42:43], v[32:33], s[62:63], v[42:43] op_sel:[1,1,0] op_sel_hi:[1,0,1] neg_lo:[0,0,0] neg_hi:[0,0,0]
v_pk_add_f32 v[32:33], v[36:37], v[44:45] op_sel:[1,1] op_sel_hi:[0,0] neg_lo:[0,1] neg_hi:[1,0]
v_pk_add_f32 v[36:37], v[36:37], v[44:45]
v_pk_add_f32 v[44:45], v[38:39], v[46:47] neg_lo:[0,1] neg_hi:[0,1]
v_pk_add_f32 v[38:39], v[38:39], v[46:47]
v_pk_mul_f32 v[46:47], v[44:45], s[62:63] op_sel:[0,0] op_sel_hi:[0,1] neg_lo:[0,1] neg_hi:[0,1]
v_pk_fma_f32 v[46:47], v[44:45], s[62:63], v[46:47] op_sel:[1,1,0] op_sel_hi:[1,0,1] neg_lo:[0,0,0] neg_hi:[0,1,0]
v_pk_add_f32 v[44:45], v[48:49], v[56:57] neg_lo:[0,1] neg_hi:[0,1]
v_pk_add_f32 v[48:49], v[48:49], v[56:57]
v_pk_add_f32 v[56:57], v[50:51], v[58:59] neg_lo:[0,1] neg_hi:[0,1]
v_pk_add_f32 v[50:51], v[50:51], v[58:59]
v_pk_mul_f32 v[58:59], v[56:57], s[62:63] op_sel:[0,0] op_sel_hi:[0,1] neg_lo:[0,0] neg_hi:[0,1]
v_pk_fma_f32 v[58:59], v[56:57], s[62:63], v[58:59] op_sel:[1,1,0] op_sel_hi:[1,0,1] neg_lo:[0,0,0] neg_hi:[0,0,0]
v_pk_add_f32 v[56:57], v[52:53], v[60:61] op_sel:[1,1] op_sel_hi:[0,0] neg_lo:[0,1] neg_hi:[1,0]
v_pk_add_f32 v[52:53], v[52:53], v[60:61]
v_pk_add_f32 v[60:61], v[54:55], v[62:63] neg_lo:[0,1] neg_hi:[0,1]
v_pk_add_f32 v[54:55], v[54:55], v[62:63]
v_pk_mul_f32 v[62:63], v[60:61], s[62:63] op_sel:[0,0] op_sel_hi:[0,1] neg_lo:[0,1] neg_hi:[0,1]
v_pk_fma_f32 v[62:63], v[60:61], s[62:63], v[62:63] op_sel:[1,1,0] op_sel_hi:[1,0,1] neg_lo:[0,0,0] neg_hi:[0,1,0]
v_pk_add_f32 v[60:61], v[40:41], v[64:65] neg_lo:[0,1] neg_hi:[0,1]
v_pk_add_f32 v[40:41], v[40:41], v[64:65]
v_pk_add_f32 v[64:65], v[66:67], v[74:75] neg_lo:[0,1] neg_hi:[0,1]
v_pk_add_f32 v[66:67], v[66:67], v[74:75]
v_pk_mul_f32 v[74:75], v[64:65], s[62:63] op_sel:[0,0] op_sel_hi:[0,1] neg_lo:[0,0] neg_hi:[0,1]
v_pk_fma_f32 v[74:75], v[64:65], s[62:63], v[74:75] op_sel:[1,1,0] op_sel_hi:[1,0,1] neg_lo:[0,0,0] neg_hi:[0,0,0]
v_pk_add_f32 v[64:65], v[68:69], v[76:77] op_sel:[1,1] op_sel_hi:[0,0] neg_lo:[0,1] neg_hi:[1,0]
v_pk_add_f32 v[68:69], v[68:69], v[76:77]
v_pk_add_f32 v[76:77], v[70:71], v[78:79] neg_lo:[0,1] neg_hi:[0,1]
v_pk_add_f32 v[70:71], v[70:71], v[78:79]
v_pk_mul_f32 v[78:79], v[76:77], s[62:63] op_sel:[0,0] op_sel_hi:[0,1] neg_lo:[0,1] neg_hi:[0,1]
v_pk_fma_f32 v[78:79], v[76:77], s[62:63], v[78:79] op_sel:[1,1,0] op_sel_hi:[1,0,1] neg_lo:[0,0,0] neg_hi:[0,1,0]
v_pk_add_f32 v[76:77], v[16:17], v[20:21] neg_lo:[0,1] neg_hi:[0,1]
v_pk_add_f32 v[16:17], v[16:17], v[20:21]
v_pk_add_f32 v[20:21], v[18:19], v[22:23] op_sel:[1,1] op_sel_hi:[0,0] neg_lo:[0,1] neg_hi:[1,0]
v_pk_add_f32 v[18:19], v[18:19], v[22:23]
v_pk_add_f32 v[22:23], v[72:73], v[24:25] neg_lo:[0,1] neg_hi:[0,1]
v_pk_add_f32 v[72:73], v[72:73], v[24:25]
v_pk_add_f32 v[24:25], v[26:27], v[30:31] op_sel:[1,1] op_sel_hi:[0,0] neg_lo:[0,1] neg_hi:[1,0]
v_pk_add_f32 v[26:27], v[26:27], v[30:31]
v_pk_add_f32 v[30:31], v[14:15], v[36:37] neg_lo:[0,1] neg_hi:[0,1]
v_pk_add_f32 v[14:15], v[14:15], v[36:37]
v_pk_add_f32 v[36:37], v[34:35], v[38:39] op_sel:[1,1] op_sel_hi:[0,0] neg_lo:[0,1] neg_hi:[1,0]
v_pk_add_f32 v[34:35], v[34:35], v[38:39]
v_pk_add_f32 v[38:39], v[28:29], v[32:33] neg_lo:[0,1] neg_hi:[0,1]
v_pk_add_f32 v[28:29], v[28:29], v[32:33]
v_pk_add_f32 v[32:33], v[42:43], v[46:47] op_sel:[1,1] op_sel_hi:[0,0] neg_lo:[0,1] neg_hi:[1,0]
v_pk_add_f32 v[42:43], v[42:43], v[46:47]
v_pk_add_f32 v[46:47], v[48:49], v[52:53] neg_lo:[0,1] neg_hi:[0,1]
v_pk_add_f32 v[48:49], v[48:49], v[52:53]
v_pk_add_f32 v[52:53], v[50:51], v[54:55] op_sel:[1,1] op_sel_hi:[0,0] neg_lo:[0,1] neg_hi:[1,0]
v_pk_add_f32 v[50:51], v[50:51], v[54:55]
v_pk_add_f32 v[54:55], v[44:45], v[56:57] neg_lo:[0,1] neg_hi:[0,1]
v_pk_add_f32 v[44:45], v[44:45], v[56:57]
v_pk_add_f32 v[56:57], v[58:59], v[62:63] op_sel:[1,1] op_sel_hi:[0,0] neg_lo:[0,1] neg_hi:[1,0]
v_pk_add_f32 v[58:59], v[58:59], v[62:63]
v_pk_add_f32 v[62:63], v[40:41], v[68:69] neg_lo:[0,1] neg_hi:[0,1]
v_pk_add_f32 v[40:41], v[40:41], v[68:69]
v_pk_add_f32 v[68:69], v[66:67], v[70:71] op_sel:[1,1] op_sel_hi:[0,0] neg_lo:[0,1] neg_hi:[1,0]
v_pk_add_f32 v[66:67], v[66:67], v[70:71]
v_pk_add_f32 v[70:71], v[60:61], v[64:65] neg_lo:[0,1] neg_hi:[0,1]
v_pk_add_f32 v[60:61], v[60:61], v[64:65]
v_pk_add_f32 v[64:65], v[74:75], v[78:79] op_sel:[1,1] op_sel_hi:[0,0] neg_lo:[0,1] neg_hi:[1,0]
v_pk_add_f32 v[74:75], v[74:75], v[78:79]
v_pk_add_f32 v[78:79], v[16:17], v[18:19] neg_lo:[0,1] neg_hi:[0,1]
v_pk_add_f32 v[16:17], v[16:17], v[18:19]
v_pk_add_f32 v[18:19], v[76:77], v[20:21] neg_lo:[0,1] neg_hi:[0,1]
v_pk_add_f32 v[76:77], v[76:77], v[20:21]
v_pk_add_f32 v[20:21], v[72:73], v[26:27] neg_lo:[0,1] neg_hi:[0,1]
v_pk_add_f32 v[72:73], v[72:73], v[26:27]
v_pk_add_f32 v[26:27], v[22:23], v[24:25] neg_lo:[0,1] neg_hi:[0,1]
v_pk_add_f32 v[22:23], v[22:23], v[24:25]
v_pk_add_f32 v[24:25], v[14:15], v[34:35] neg_lo:[0,1] neg_hi:[0,1]
v_pk_add_f32 v[14:15], v[14:15], v[34:35]
v_pk_add_f32 v[34:35], v[30:31], v[36:37] neg_lo:[0,1] neg_hi:[0,1]
v_pk_add_f32 v[30:31], v[30:31], v[36:37]
v_pk_add_f32 v[36:37], v[28:29], v[42:43] neg_lo:[0,1] neg_hi:[0,1]
v_pk_add_f32 v[28:29], v[28:29], v[42:43]
v_pk_add_f32 v[42:43], v[38:39], v[32:33] neg_lo:[0,1] neg_hi:[0,1]
v_pk_add_f32 v[38:39], v[38:39], v[32:33]
v_pk_add_f32 v[32:33], v[48:49], v[50:51] neg_lo:[0,1] neg_hi:[0,1]
v_pk_add_f32 v[48:49], v[48:49], v[50:51]
v_pk_add_f32 v[50:51], v[46:47], v[52:53] neg_lo:[0,1] neg_hi:[0,1]
v_pk_add_f32 v[46:47], v[46:47], v[52:53]
v_pk_add_f32 v[52:53], v[44:45], v[58:59] neg_lo:[0,1] neg_hi:[0,1]
v_pk_add_f32 v[44:45], v[44:45], v[58:59]
v_pk_add_f32 v[58:59], v[54:55], v[56:57] neg_lo:[0,1] neg_hi:[0,1]
v_pk_add_f32 v[54:55], v[54:55], v[56:57]
v_pk_add_f32 v[56:57], v[40:41], v[66:67] neg_lo:[0,1] neg_hi:[0,1]
v_pk_add_f32 v[40:41], v[40:41], v[66:67]
v_pk_add_f32 v[66:67], v[62:63], v[68:69] neg_lo:[0,1] neg_hi:[0,1]
v_pk_add_f32 v[62:63], v[62:63], v[68:69]
v_pk_add_f32 v[68:69], v[60:61], v[74:75] neg_lo:[0,1] neg_hi:[0,1]
v_pk_add_f32 v[60:61], v[60:61], v[74:75]
v_pk_add_f32 v[74:75], v[70:71], v[64:65] neg_lo:[0,1] neg_hi:[0,1]
v_pk_add_f32 v[70:71], v[70:71], v[64:65]
v_pk_mul_f32 v[64:65], v[48:49], v[82:83] op_sel:[0,0] op_sel_hi:[0,1] neg_lo:[0,0] neg_hi:[0,0]
v_pk_fma_f32 v[48:49], v[48:49], v[82:83], v[64:65] op_sel:[1,1,0] op_sel_hi:[1,0,1] neg_lo:[0,1,0] neg_hi:[0,0,0]
v_pk_mul_f32 v[64:65], v[14:15], v[84:85] op_sel:[0,0] op_sel_hi:[0,1] neg_lo:[0,0] neg_hi:[0,0]
v_pk_fma_f32 v[14:15], v[14:15], v[84:85], v[64:65] op_sel:[1,1,0] op_sel_hi:[1,0,1] neg_lo:[0,1,0] neg_hi:[0,0,0]
v_pk_mul_f32 v[64:65], v[40:41], v[86:87] op_sel:[0,0] op_sel_hi:[0,1] neg_lo:[0,0] neg_hi:[0,0]
v_pk_fma_f32 v[40:41], v[40:41], v[86:87], v[64:65] op_sel:[1,1,0] op_sel_hi:[1,0,1] neg_lo:[0,1,0] neg_hi:[0,0,0]
v_pk_mul_f32 v[64:65], v[72:73], v[88:89] op_sel:[0,0] op_sel_hi:[0,1] neg_lo:[0,0] neg_hi:[0,0]
v_pk_fma_f32 v[72:73], v[72:73], v[88:89], v[64:65] op_sel:[1,1,0] op_sel_hi:[1,0,1] neg_lo:[0,1,0] neg_hi:[0,0,0]
v_pk_mul_f32 v[64:65], v[44:45], v[90:91] op_sel:[0,0] op_sel_hi:[0,1] neg_lo:[0,0] neg_hi:[0,0]
v_pk_fma_f32 v[44:45], v[44:45], v[90:91], v[64:65] op_sel:[1,1,0] op_sel_hi:[1,0,1] neg_lo:[0,1,0] neg_hi:[0,0,0]
v_pk_mul_f32 v[64:65], v[28:29], v[92:93] op_sel:[0,0] op_sel_hi:[0,1] neg_lo:[0,0] neg_hi:[0,0]
v_pk_fma_f32 v[28:29], v[28:29], v[92:93], v[64:65] op_sel:[1,1,0] op_sel_hi:[1,0,1] neg_lo:[0,1,0] neg_hi:[0,0,0]
v_pk_mul_f32 v[64:65], v[60:61], v[94:95] op_sel:[0,0] op_sel_hi:[0,1] neg_lo:[0,0] neg_hi:[0,0]
v_pk_fma_f32 v[60:61], v[60:61], v[94:95], v[64:65] op_sel:[1,1,0] op_sel_hi:[1,0,1] neg_lo:[0,1,0] neg_hi:[0,0,0]
v_pk_mul_f32 v[64:65], v[76:77], v[96:97] op_sel:[0,0] op_sel_hi:[0,1] neg_lo:[0,0] neg_hi:[0,0]
v_pk_fma_f32 v[76:77], v[76:77], v[96:97], v[64:65] op_sel:[1,1,0] op_sel_hi:[1,0,1] neg_lo:[0,1,0] neg_hi:[0,0,0]
v_pk_mul_f32 v[64:65], v[46:47], v[98:99] op_sel:[0,0] op_sel_hi:[0,1] neg_lo:[0,0] neg_hi:[0,0]
v_pk_fma_f32 v[46:47], v[46:47], v[98:99], v[64:65] op_sel:[1,1,0] op_sel_hi:[1,0,1] neg_lo:[0,1,0] neg_hi:[0,0,0]
v_pk_mul_f32 v[64:65], v[30:31], v[100:101] op_sel:[0,0] op_sel_hi:[0,1] neg_lo:[0,0] neg_hi:[0,0]
v_pk_fma_f32 v[30:31], v[30:31], v[100:101], v[64:65] op_sel:[1,1,0] op_sel_hi:[1,0,1] neg_lo:[0,1,0] neg_hi:[0,0,0]
v_pk_mul_f32 v[64:65], v[62:63], v[102:103] op_sel:[0,0] op_sel_hi:[0,1] neg_lo:[0,0] neg_hi:[0,0]
v_pk_fma_f32 v[62:63], v[62:63], v[102:103], v[64:65] op_sel:[1,1,0] op_sel_hi:[1,0,1] neg_lo:[0,1,0] neg_hi:[0,0,0]
v_pk_mul_f32 v[64:65], v[22:23], v[104:105] op_sel:[0,0] op_sel_hi:[0,1] neg_lo:[0,0] neg_hi:[0,0]
v_pk_fma_f32 v[22:23], v[22:23], v[104:105], v[64:65] op_sel:[1,1,0] op_sel_hi:[1,0,1] neg_lo:[0,1,0] neg_hi:[0,0,0]
v_pk_mul_f32 v[64:65], v[54:55], v[106:107] op_sel:[0,0] op_sel_hi:[0,1] neg_lo:[0,0] neg_hi:[0,0]
v_pk_fma_f32 v[54:55], v[54:55], v[106:107], v[64:65] op_sel:[1,1,0] op_sel_hi:[1,0,1] neg_lo:[0,1,0] neg_hi:[0,0,0]
v_pk_mul_f32 v[64:65], v[38:39], v[108:109] op_sel:[0,0] op_sel_hi:[0,1] neg_lo:[0,0] neg_hi:[0,0]
v_pk_fma_f32 v[38:39], v[38:39], v[108:109], v[64:65] op_sel:[1,1,0] op_sel_hi:[1,0,1] neg_lo:[0,1,0] neg_hi:[0,0,0]
v_pk_mul_f32 v[64:65], v[70:71], v[110:111] op_sel:[0,0] op_sel_hi:[0,1] neg_lo:[0,0] neg_hi:[0,0]
v_pk_fma_f32 v[70:71], v[70:71], v[110:111], v[64:65] op_sel:[1,1,0] op_sel_hi:[1,0,1] neg_lo:[0,1,0] neg_hi:[0,0,0]
v_pk_mul_f32 v[64:65], v[78:79], v[112:113] op_sel:[0,0] op_sel_hi:[0,1] neg_lo:[0,0] neg_hi:[0,0]
v_pk_fma_f32 v[78:79], v[78:79], v[112:113], v[64:65] op_sel:[1,1,0] op_sel_hi:[1,0,1] neg_lo:[0,1,0] neg_hi:[0,0,0]
v_pk_mul_f32 v[64:65], v[32:33], v[114:115] op_sel:[0,0] op_sel_hi:[0,1] neg_lo:[0,0] neg_hi:[0,0]
v_pk_fma_f32 v[32:33], v[32:33], v[114:115], v[64:65] op_sel:[1,1,0] op_sel_hi:[1,0,1] neg_lo:[0,1,0] neg_hi:[0,0,0]
v_pk_mul_f32 v[64:65], v[24:25], v[116:117] op_sel:[0,0] op_sel_hi:[0,1] neg_lo:[0,0] neg_hi:[0,0]
v_pk_fma_f32 v[24:25], v[24:25], v[116:117], v[64:65] op_sel:[1,1,0] op_sel_hi:[1,0,1] neg_lo:[0,1,0] neg_hi:[0,0,0]
v_pk_mul_f32 v[64:65], v[56:57], v[118:119] op_sel:[0,0] op_sel_hi:[0,1] neg_lo:[0,0] neg_hi:[0,0]
v_pk_fma_f32 v[56:57], v[56:57], v[118:119], v[64:65] op_sel:[1,1,0] op_sel_hi:[1,0,1] neg_lo:[0,1,0] neg_hi:[0,0,0]
v_pk_mul_f32 v[64:65], v[20:21], v[120:121] op_sel:[0,0] op_sel_hi:[0,1] neg_lo:[0,0] neg_hi:[0,0]
v_pk_fma_f32 v[20:21], v[20:21], v[120:121], v[64:65] op_sel:[1,1,0] op_sel_hi:[1,0,1] neg_lo:[0,1,0] neg_hi:[0,0,0]
v_pk_mul_f32 v[64:65], v[52:53], v[122:123] op_sel:[0,0] op_sel_hi:[0,1] neg_lo:[0,0] neg_hi:[0,0]
v_pk_fma_f32 v[52:53], v[52:53], v[122:123], v[64:65] op_sel:[1,1,0] op_sel_hi:[1,0,1] neg_lo:[0,1,0] neg_hi:[0,0,0]
v_pk_mul_f32 v[64:65], v[36:37], v[124:125] op_sel:[0,0] op_sel_hi:[0,1] neg_lo:[0,0] neg_hi:[0,0]
v_pk_fma_f32 v[36:37], v[36:37], v[124:125], v[64:65] op_sel:[1,1,0] op_sel_hi:[1,0,1] neg_lo:[0,1,0] neg_hi:[0,0,0]
v_pk_mul_f32 v[64:65], v[68:69], v[126:127] op_sel:[0,0] op_sel_hi:[0,1] neg_lo:[0,0] neg_hi:[0,0]
v_pk_fma_f32 v[68:69], v[68:69], v[126:127], v[64:65] op_sel:[1,1,0] op_sel_hi:[1,0,1] neg_lo:[0,1,0] neg_hi:[0,0,0]
v_pk_mul_f32 v[64:65], v[18:19], v[128:129] op_sel:[0,0] op_sel_hi:[0,1] neg_lo:[0,0] neg_hi:[0,0]
v_pk_fma_f32 v[18:19], v[18:19], v[128:129], v[64:65] op_sel:[1,1,0] op_sel_hi:[1,0,1] neg_lo:[0,1,0] neg_hi:[0,0,0]
v_pk_mul_f32 v[64:65], v[50:51], v[130:131] op_sel:[0,0] op_sel_hi:[0,1] neg_lo:[0,0] neg_hi:[0,0]
v_pk_fma_f32 v[50:51], v[50:51], v[130:131], v[64:65] op_sel:[1,1,0] op_sel_hi:[1,0,1] neg_lo:[0,1,0] neg_hi:[0,0,0]
v_pk_mul_f32 v[64:65], v[34:35], v[132:133] op_sel:[0,0] op_sel_hi:[0,1] neg_lo:[0,0] neg_hi:[0,0]
v_pk_fma_f32 v[34:35], v[34:35], v[132:133], v[64:65] op_sel:[1,1,0] op_sel_hi:[1,0,1] neg_lo:[0,1,0] neg_hi:[0,0,0]
v_pk_mul_f32 v[64:65], v[66:67], v[134:135] op_sel:[0,0] op_sel_hi:[0,1] neg_lo:[0,0] neg_hi:[0,0]
v_pk_fma_f32 v[66:67], v[66:67], v[134:135], v[64:65] op_sel:[1,1,0] op_sel_hi:[1,0,1] neg_lo:[0,1,0] neg_hi:[0,0,0]
v_pk_mul_f32 v[64:65], v[26:27], v[136:137] op_sel:[0,0] op_sel_hi:[0,1] neg_lo:[0,0] neg_hi:[0,0]
v_pk_fma_f32 v[26:27], v[26:27], v[136:137], v[64:65] op_sel:[1,1,0] op_sel_hi:[1,0,1] neg_lo:[0,1,0] neg_hi:[0,0,0]
v_pk_mul_f32 v[64:65], v[58:59], v[138:139] op_sel:[0,0] op_sel_hi:[0,1] neg_lo:[0,0] neg_hi:[0,0]
v_pk_fma_f32 v[58:59], v[58:59], v[138:139], v[64:65] op_sel:[1,1,0] op_sel_hi:[1,0,1] neg_lo:[0,1,0] neg_hi:[0,0,0]
v_pk_mul_f32 v[64:65], v[42:43], v[140:141] op_sel:[0,0] op_sel_hi:[0,1] neg_lo:[0,0] neg_hi:[0,0]
v_pk_fma_f32 v[42:43], v[42:43], v[140:141], v[64:65] op_sel:[1,1,0] op_sel_hi:[1,0,1] neg_lo:[0,1,0] neg_hi:[0,0,0]
v_pk_mul_f32 v[64:65], v[74:75], v[142:143] op_sel:[0,0] op_sel_hi:[0,1] neg_lo:[0,0] neg_hi:[0,0]
v_pk_fma_f32 v[74:75], v[74:75], v[142:143], v[64:65] op_sel:[1,1,0] op_sel_hi:[1,0,1] neg_lo:[0,1,0] neg_hi:[0,0,0]
s_barrier
ds_write_b64 v4, v[16:17] offset:0
ds_write_b64 v4, v[48:49] offset:264
ds_write_b64 v4, v[14:15] offset:528
ds_write_b64 v4, v[40:41] offset:792
ds_write_b64 v4, v[72:73] offset:1056
ds_write_b64 v4, v[44:45] offset:1320
ds_write_b64 v4, v[28:29] offset:1584
ds_write_b64 v4, v[60:61] offset:1848
ds_write_b64 v4, v[76:77] offset:2112
ds_write_b64 v4, v[46:47] offset:2376
ds_write_b64 v4, v[30:31] offset:2640
ds_write_b64 v4, v[62:63] offset:2904
ds_write_b64 v4, v[22:23] offset:3168
ds_write_b64 v4, v[54:55] offset:3432
ds_write_b64 v4, v[38:39] offset:3696
ds_write_b64 v4, v[70:71] offset:3960
ds_write_b64 v4, v[78:79] offset:4224
ds_write_b64 v4, v[32:33] offset:4488
ds_write_b64 v4, v[24:25] offset:4752
ds_write_b64 v4, v[56:57] offset:5016
ds_write_b64 v4, v[20:21] offset:5280
ds_write_b64 v4, v[52:53] offset:5544
ds_write_b64 v4, v[36:37] offset:5808
ds_write_b64 v4, v[68:69] offset:6072
ds_write_b64 v4, v[18:19] offset:6336
ds_write_b64 v4, v[50:51] offset:6600
ds_write_b64 v4, v[34:35] offset:6864
ds_write_b64 v4, v[66:67] offset:7128
ds_write_b64 v4, v[26:27] offset:7392
ds_write_b64 v4, v[58:59] offset:7656
ds_write_b64 v4, v[42:43] offset:7920
ds_write_b64 v4, v[74:75] offset:8184
s_waitcnt lgkmcnt(0)
ds_read_b64 v[16:17], v5 offset:0
ds_read_b64 v[48:49], v5 offset:128
ds_read_b64 v[18:19], v5 offset:8
ds_read_b64 v[50:51], v5 offset:136
ds_read_b64 v[20:21], v5 offset:16
ds_read_b64 v[52:53], v5 offset:144
ds_read_b64 v[22:23], v5 offset:24
ds_read_b64 v[54:55], v5 offset:152
ds_read_b64 v[24:25], v5 offset:32
ds_read_b64 v[56:57], v5 offset:160
ds_read_b64 v[26:27], v5 offset:40
ds_read_b64 v[58:59], v5 offset:168
ds_read_b64 v[28:29], v5 offset:48
ds_read_b64 v[60:61], v5 offset:176
ds_read_b64 v[30:31], v5 offset:56
ds_read_b64 v[62:63], v5 offset:184
ds_read_b64 v[32:33], v5 offset:64
ds_read_b64 v[64:65], v5 offset:192
ds_read_b64 v[34:35], v5 offset:72
ds_read_b64 v[66:67], v5 offset:200
ds_read_b64 v[36:37], v5 offset:80
ds_read_b64 v[68:69], v5 offset:208
ds_read_b64 v[38:39], v5 offset:88
ds_read_b64 v[70:71], v5 offset:216
ds_read_b64 v[40:41], v5 offset:96
ds_read_b64 v[72:73], v5 offset:224
ds_read_b64 v[42:43], v5 offset:104
ds_read_b64 v[74:75], v5 offset:232
ds_read_b64 v[44:45], v5 offset:112
ds_read_b64 v[76:77], v5 offset:240
ds_read_b64 v[46:47], v5 offset:120
ds_read_b64 v[78:79], v5 offset:248
s_waitcnt lgkmcnt(0)
v_pk_add_f32 v[14:15], v[16:17], v[48:49] neg_lo:[0,1] neg_hi:[0,1]
v_pk_add_f32 v[16:17], v[16:17], v[48:49]
v_pk_add_f32 v[48:49], v[18:19], v[50:51] neg_lo:[0,1] neg_hi:[0,1]
v_pk_add_f32 v[18:19], v[18:19], v[50:51]
v_pk_mul_f32 v[50:51], v[48:49], s[50:51] op_sel:[0,0] op_sel_hi:[0,1] neg_lo:[0,0] neg_hi:[0,1]
v_pk_fma_f32 v[50:51], v[48:49], s[50:51], v[50:51] op_sel:[1,1,0] op_sel_hi:[1,0,1] neg_lo:[0,0,0] neg_hi:[0,0,0]
v_pk_add_f32 v[48:49], v[20:21], v[52:53] neg_lo:[0,1] neg_hi:[0,1]
v_pk_add_f32 v[20:21], v[20:21], v[52:53]
v_pk_mul_f32 v[52:53], v[48:49], s[54:55] op_sel:[0,0] op_sel_hi:[0,1] neg_lo:[0,0] neg_hi:[0,1]
v_pk_fma_f32 v[52:53], v[48:49], s[54:55], v[52:53] op_sel:[1,1,0] op_sel_hi:[1,0,1] neg_lo:[0,0,0] neg_hi:[0,0,0]
v_pk_add_f32 v[48:49], v[22:23], v[54:55] neg_lo:[0,1] neg_hi:[0,1]
v_pk_add_f32 v[22:23], v[22:23], v[54:55]
v_pk_mul_f32 v[54:55], v[48:49], s[58:59] op_sel:[0,0] op_sel_hi:[0,1] neg_lo:[0,0] neg_hi:[0,1]
v_pk_fma_f32 v[54:55], v[48:49], s[58:59], v[54:55] op_sel:[1,1,0] op_sel_hi:[1,0,1] neg_lo:[0,0,0] neg_hi:[0,0,0]
v_pk_add_f32 v[48:49], v[24:25], v[56:57] neg_lo:[0,1] neg_hi:[0,1]
v_pk_add_f32 v[24:25], v[24:25], v[56:57]
v_pk_mul_f32 v[56:57], v[48:49], s[62:63] op_sel:[0,0] op_sel_hi:[0,1] neg_lo:[0,0] neg_hi:[0,1]
v_pk_fma_f32 v[56:57], v[48:49], s[62:63], v[56:57] op_sel:[1,1,0] op_sel_hi:[1,0,1] neg_lo:[0,0,0] neg_hi:[0,0,0]
v_pk_add_f32 v[48:49], v[26:27], v[58:59] neg_lo:[0,1] neg_hi:[0,1]
v_pk_add_f32 v[26:27], v[26:27], v[58:59]
v_pk_mul_f32 v[58:59], v[48:49], s[58:59] op_sel:[0,1] op_sel_hi:[0,0] neg_lo:[0,0] neg_hi:[0,1]
v_pk_fma_f32 v[58:59], v[48:49], s[58:59], v[58:59] op_sel:[1,0,0] op_sel_hi:[1,1,1] neg_lo:[0,0,0] neg_hi:[0,0,0]
v_pk_add_f32 v[48:49], v[28:29], v[60:61] neg_lo:[0,1] neg_hi:[0,1]
v_pk_add_f32 v[28:29], v[28:29], v[60:61]
v_pk_mul_f32 v[60:61], v[48:49], s[54:55] op_sel:[0,1] op_sel_hi:[0,0] neg_lo:[0,0] neg_hi:[0,1]
v_pk_fma_f32 v[60:61], v[48:49], s[54:55], v[60:61] op_sel:[1,0,0] op_sel_hi:[1,1,1] neg_lo:[0,0,0] neg_hi:[0,0,0]
v_pk_add_f32 v[48:49], v[30:31], v[62:63] neg_lo:[0,1] neg_hi:[0,1]
v_pk_add_f32 v[30:31], v[30:31], v[62:63]
v_pk_mul_f32 v[62:63], v[48:49], s[50:51] op_sel:[0,1] op_sel_hi:[0,0] neg_lo:[0,0] neg_hi:[0,1]
v_pk_fma_f32 v[62:63], v[48:49], s[50:51], v[62:63] op_sel:[1,0,0] op_sel_hi:[1,1,1] neg_lo:[0,0,0] neg_hi:[0,0,0]
v_pk_add_f32 v[48:49], v[32:33], v[64:65] op_sel:[1,1] op_sel_hi:[0,0] neg_lo:[0,1] neg_hi:[1,0]
v_pk_add_f32 v[32:33], v[32:33], v[64:65]
v_pk_add_f32 v[64:65], v[34:35], v[66:67] neg_lo:[0,1] neg_hi:[0,1]
v_pk_add_f32 v[34:35], v[34:35], v[66:67]
v_pk_mul_f32 v[66:67], v[64:65], s[50:51] op_sel:[0,1] op_sel_hi:[0,0] neg_lo:[0,1] neg_hi:[0,1]
v_pk_fma_f32 v[66:67], v[64:65], s[50:51], v[66:67] op_sel:[1,0,0] op_sel_hi:[1,1,1] neg_lo:[0,0,0] neg_hi:[0,1,0]
v_pk_add_f32 v[64:65], v[36:37], v[68:69] neg_lo:[0,1] neg_hi:[0,1]
v_pk_add_f32 v[36:37], v[36:37], v[68:69]
v_pk_mul_f32 v[68:69], v[64:65], s[54:55] op_sel:[0,1] op_sel_hi:[0,0] neg_lo:[0,1] neg_hi:[0,1]
v_pk_fma_f32 v[68:69], v[64:65], s[54:55], v[68:69] op_sel:[1,0,0] op_sel_hi:[1,1,1] neg_lo:[0,0,0] neg_hi:[0,1,0]
v_pk_add_f32 v[64:65], v[38:39], v[70:71] neg_lo:[0,1] neg_hi:[0,1]
v_pk_add_f32 v[38:39], v[38:39], v[70:71]
v_pk_mul_f32 v[70:71], v[64:65], s[58:59] op_sel:[0,1] op_sel_hi:[0,0] neg_lo:[0,1] neg_hi:[0,1]
v_pk_fma_f32 v[70:71], v[64:65], s[58:59], v[70:71] op_sel:[1,0,0] op_sel_hi:[1,1,1] neg_lo:[0,0,0] neg_hi:[0,1,0]
v_pk_add_f32 v[64:65], v[40:41], v[72:73] neg_lo:[0,1] neg_hi:[0,1]
v_pk_add_f32 v[40:41], v[40:41], v[72:73]
v_pk_mul_f32 v[72:73], v[64:65], s[62:63] op_sel:[0,0] op_sel_hi:[0,1] neg_lo:[0,1] neg_hi:[0,1]
v_pk_fma_f32 v[72:73], v[64:65], s[62:63], v[72:73] op_sel:[1,1,0] op_sel_hi:[1,0,1] neg_lo:[0,0,0] neg_hi:[0,1,0]
v_pk_add_f32 v[64:65], v[42:43], v[74:75] neg_lo:[0,1] neg_hi:[0,1]
v_pk_add_f32 v[42:43], v[42:43], v[74:75]
v_pk_mul_f32 v[74:75], v[64:65], s[58:59] op_sel:[0,0] op_sel_hi:[0,1] neg_lo:[0,1] neg_hi:[0,1]
v_pk_fma_f32 v[74:75], v[64:65], s[58:59], v[74:75] op_sel:[1,1,0] op_sel_hi:[1,0,1] neg_lo:[0,0,0] neg_hi:[0,1,0]
v_pk_add_f32 v[64:65], v[44:45], v[76:77] neg_lo:[0,1] neg_hi:[0,1]
v_pk_add_f32 v[44:45], v[44:45], v[76:77]
v_pk_mul_f32 v[76:77], v[64:65], s[54:55] op_sel:[0,0] op_sel_hi:[0,1] neg_lo:[0,1] neg_hi:[0,1]
v_pk_fma_f32 v[76:77], v[64:65], s[54:55], v[76:77] op_sel:[1,1,0] op_sel_hi:[1,0,1] neg_lo:[0,0,0] neg_hi:[0,1,0]
v_pk_add_f32 v[64:65], v[46:47], v[78:79] neg_lo:[0,1] neg_hi:[0,1]
v_pk_add_f32 v[46:47], v[46:47], v[78:79]
v_pk_mul_f32 v[78:79], v[64:65], s[50:51] op_sel:[0,0] op_sel_hi:[0,1] neg_lo:[0,1] neg_hi:[0,1]
v_pk_fma_f32 v[78:79], v[64:65], s[50:51], v[78:79] op_sel:[1,1,0] op_sel_hi:[1,0,1] neg_lo:[0,0,0] neg_hi:[0,1,0]
v_pk_add_f32 v[64:65], v[16:17], v[32:33] neg_lo:[0,1] neg_hi:[0,1]
v_pk_add_f32 v[16:17], v[16:17], v[32:33]
v_pk_add_f32 v[32:33], v[18:19], v[34:35] neg_lo:[0,1] neg_hi:[0,1]
v_pk_add_f32 v[18:19], v[18:19], v[34:35]
v_pk_mul_f32 v[34:35], v[32:33], s[54:55] op_sel:[0,0] op_sel_hi:[0,1] neg_lo:[0,0] neg_hi:[0,1]
v_pk_fma_f32 v[34:35], v[32:33], s[54:55], v[34:35] op_sel:[1,1,0] op_sel_hi:[1,0,1] neg_lo:[0,0,0] neg_hi:[0,0,0]
v_pk_add_f32 v[32:33], v[20:21], v[36:37] neg_lo:[0,1] neg_hi:[0,1]
v_pk_add_f32 v[20:21], v[20:21], v[36:37]
v_pk_mul_f32 v[36:37], v[32:33], s[62:63] op_sel:[0,0] op_sel_hi:[0,1] neg_lo:[0,0] neg_hi:[0,1]
v_pk_fma_f32 v[36:37], v[32:33], s[62:63], v[36:37] op_sel:[1,1,0] op_sel_hi:[1,0,1] neg_lo:[0,0,0] neg_hi:[0,0,0]
v_pk_add_f32 v[32:33], v[22:23], v[38:39] neg_lo:[0,1] neg_hi:[0,1]
v_pk_add_f32 v[22:23], v[22:23], v[38:39]
v_pk_mul_f32 v[38:39], v[32:33], s[54:55] op_sel:[0,1] op_sel_hi:[0,0] neg_lo:[0,0] neg_hi:[0,1]
v_pk_fma_f32 v[38:39], v[32:33], s[54:55], v[38:39] op_sel:[1,0,0] op_sel_hi:[1,1,1] neg_lo:[0,0,0] neg_hi:[0,0,0]
v_pk_add_f32 v[32:33], v[24:25], v[40:41] op_sel:[1,1] op_sel_hi:[0,0] neg_lo:[0,1] neg_hi:[1,0]
v_pk_add_f32 v[24:25], v[24:25], v[40:41]
v_pk_add_f32 v[40:41], v[26:27], v[42:43] neg_lo:[0,1] neg_hi:[0,1]
v_pk_add_f32 v[26:27], v[26:27], v[42:43]
v_pk_mul_f32 v[42:43], v[40:41], s[54:55] op_sel:[0,1] op_sel_hi:[0,0] neg_lo:[0,1] neg_hi:[0,1]
v_pk_fma_f32 v[42:43], v[40:41], s[54:55], v[42:43] op_sel:[1,0,0] op_sel_hi:[1,1,1] neg_lo:[0,0,0] neg_hi:[0,1,0]
v_pk_add_f32 v[40:41], v[28:29], v[44:45] neg_lo:[0,1] neg_hi:[0,1]
v_pk_add_f32 v[28:29], v[28:29], v[44:45]
v_pk_mul_f32 v[44:45], v[40:41], s[62:63] op_sel:[0,0] op_sel_hi:[0,1] neg_lo:[0,1] neg_hi:[0,1]
v_pk_fma_f32 v[44:45], v[40:41], s[62:63], v[44:45] op_sel:[1,1,0] op_sel_hi:[1,0,1] neg_lo:[0,0,0] neg_hi:[0,1,0]
v_pk_add_f32 v[40:41], v[30:31], v[46:47] neg_lo:[0,1] neg_hi:[0,1]
v_pk_add_f32 v[30:31], v[30:31], v[46:47]
v_pk_mul_f32 v[46:47], v[40:41], s[54:55] op_sel:[0,0] op_sel_hi:[0,1] neg_lo:[0,1] neg_hi:[0,1]
v_pk_fma_f32 v[46:47], v[40:41], s[54:55], v[46:47] op_sel:[1,1,0] op_sel_hi:[1,0,1] neg_lo:[0,0,0] neg_hi:[0,1,0]
v_pk_add_f32 v[40:41], v[14:15], v[48:49] neg_lo:[0,1] neg_hi:[0,1]
v_pk_add_f32 v[14:15], v[14:15], v[48:49]
v_pk_add_f32 v[48:49], v[50:51], v[66:67] neg_lo:[0,1] neg_hi:[0,1]
v_pk_add_f32 v[50:51], v[50:51], v[66:67]
v_pk_mul_f32 v[66:67], v[48:49], s[54:55] op_sel:[0,0] op_sel_hi:[0,1] neg_lo:[0,0] neg_hi:[0,1]
v_pk_fma_f32 v[66:67], v[48:49], s[54:55], v[66:67] op_sel:[1,1,0] op_sel_hi:[1,0,1] neg_lo:[0,0,0] neg_hi:[0,0,0]
v_pk_add_f32 v[48:49], v[52:53], v[68:69] neg_lo:[0,1] neg_hi:[0,1]
v_pk_add_f32 v[52:53], v[52:53], v[68:69]
v_pk_mul_f32 v[68:69], v[48:49], s[62:63] op_sel:[0,0] op_sel_hi:[0,1] neg_lo:[0,0] neg_hi:[0,1]
v_pk_fma_f32 v[68:69], v[48:49], s[62:63], v[68:69] op_sel:[1,1,0] op_sel_hi:[1,0,1] neg_lo:[0,0,0] neg_hi:[0,0,0]
v_pk_add_f32 v[48:49], v[54:55], v[70:71] neg_lo:[0,1] neg_hi:[0,1]
v_pk_add_f32 v[54:55], v[54:55], v[70:71]
v_pk_mul_f32 v[70:71], v[48:49], s[54:55] op_sel:[0,1] op_sel_hi:[0,0] neg_lo:[0,0] neg_hi:[0,1]
v_pk_fma_f32 v[70:71], v[48:49], s[54:55], v[70:71] op_sel:[1,0,0] op_sel_hi:[1,1,1] neg_lo:[0,0,0] neg_hi:[0,0,0]
v_pk_add_f32 v[48:49], v[56:57], v[72:73] op_sel:[1,1] op_sel_hi:[0,0] neg_lo:[0,1] neg_hi:[1,0]
v_pk_add_f32 v[56:57], v[56:57], v[72:73]
v_pk_add_f32 v[72:73], v[58:59], v[74:75] neg_lo:[0,1] neg_hi:[0,1]
v_pk_add_f32 v[58:59], v[58:59], v[74:75]
v_pk_mul_f32 v[74:75], v[72:73], s[54:55] op_sel:[0,1] op_sel_hi:[0,0] neg_lo:[0,1] neg_hi:[0,1]
v_pk_fma_f32 v[74:75], v[72:73], s[54:55], v[74:75] op_sel:[1,0,0] op_sel_hi:[1,1,1] neg_lo:[0,0,0] neg_hi:[0,1,0]
v_pk_add_f32 v[72:73], v[60:61], v[76:77] neg_lo:[0,1] neg_hi:[0,1]
v_pk_add_f32 v[60:61], v[60:61], v[76:77]
v_pk_mul_f32 v[76:77], v[72:73], s[62:63] op_sel:[0,0] op_sel_hi:[0,1] neg_lo:[0,1] neg_hi:[0,1]
v_pk_fma_f32 v[76:77], v[72:73], s[62:63], v[76:77] op_sel:[1,1,0] op_sel_hi:[1,0,1] neg_lo:[0,0,0] neg_hi:[0,1,0]
v_pk_add_f32 v[72:73], v[62:63], v[78:79] neg_lo:[0,1] neg_hi:[0,1]
v_pk_add_f32 v[62:63], v[62:63], v[78:79]
v_pk_mul_f32 v[78:79], v[72:73], s[54:55] op_sel:[0,0] op_sel_hi:[0,1] neg_lo:[0,1] neg_hi:[0,1]
v_pk_fma_f32 v[78:79], v[72:73], s[54:55], v[78:79] op_sel:[1,1,0] op_sel_hi:[1,0,1] neg_lo:[0,0,0] neg_hi:[0,1,0]
v_pk_add_f32 v[72:73], v[16:17], v[24:25] neg_lo:[0,1] neg_hi:[0,1]
v_pk_add_f32 v[16:17], v[16:17], v[24:25]
v_pk_add_f32 v[24:25], v[18:19], v[26:27] neg_lo:[0,1] neg_hi:[0,1]
v_pk_add_f32 v[18:19], v[18:19], v[26:27]
v_pk_mul_f32 v[26:27], v[24:25], s[62:63] op_sel:[0,0] op_sel_hi:[0,1] neg_lo:[0,0] neg_hi:[0,1]
v_pk_fma_f32 v[26:27], v[24:25], s[62:63], v[26:27] op_sel:[1,1,0] op_sel_hi:[1,0,1] neg_lo:[0,0,0] neg_hi:[0,0,0]
v_pk_add_f32 v[24:25], v[20:21], v[28:29] op_sel:[1,1] op_sel_hi:[0,0] neg_lo:[0,1] neg_hi:[1,0]
v_pk_add_f32 v[20:21], v[20:21], v[28:29]
v_pk_add_f32 v[28:29], v[22:23], v[30:31] neg_lo:[0,1] neg_hi:[0,1]
v_pk_add_f32 v[22:23], v[22:23], v[30:31]
v_pk_mul_f32 v[30:31], v[28:29], s[62:63] op_sel:[0,0] op_sel_hi:[0,1] neg_lo:[0,1] neg_hi:[0,1]
v_pk_fma_f32 v[30:31], v[28:29], s[62:63], v[30:31] op_sel:[1,1,0] op_sel_hi:[1,0,1] neg_lo:[0,0,0] neg_hi:[0,1,0]
v_pk_add_f32 v[28:29], v[64:65], v[32:33] neg_lo:[0,1] neg_hi:[0,1]
v_pk_add_f32 v[64:65], v[64:65], v[32:33]
v_pk_add_f32 v[32:33], v[34:35], v[42:43] neg_lo:[0,1] neg_hi:[0,1]
v_pk_add_f32 v[34:35], v[34:35], v[42:43]
v_pk_mul_f32 v[42:43], v[32:33], s[62:63] op_sel:[0,0] op_sel_hi:[0,1] neg_lo:[0,0] neg_hi:[0,1]
v_pk_fma_f32 v[42:43], v[32:33], s[62:63], v[42:43] op_sel:[1,1,0] op_sel_hi:[1,0,1] neg_lo:[0,0,0] neg_hi:[0,0,0]
v_pk_add_f32 v[32:33], v[36:37], v[44:45] op_sel:[1,1] op_sel_hi:[0,0] neg_lo:[0,1] neg_hi:[1,0]
v_pk_add_f32 v[36:37], v[36:37], v[44:45]
v_pk_add_f32 v[44:45], v[38:39], v[46:47] neg_lo:[0,1] neg_hi:[0,1]
v_pk_add_f32 v[38:39], v[38:39], v[46:47]
v_pk_mul_f32 v[46:47], v[44:45], s[62:63] op_sel:[0,0] op_sel_hi:[0,1] neg_lo:[0,1] neg_hi:[0,1]
v_pk_fma_f32 v[46:47], v[44:45], s[62:63], v[46:47] op_sel:[1,1,0] op_sel_hi:[1,0,1] neg_lo:[0,0,0] neg_hi:[0,1,0]
v_pk_add_f32 v[44:45], v[14:15], v[56:57] neg_lo:[0,1] neg_hi:[0,1]
v_pk_add_f32 v[14:15], v[14:15], v[56:57]
v_pk_add_f32 v[56:57], v[50:51], v[58:59] neg_lo:[0,1] neg_hi:[0,1]
v_pk_add_f32 v[50:51], v[50:51], v[58:59]
v_pk_mul_f32 v[58:59], v[56:57], s[62:63] op_sel:[0,0] op_sel_hi:[0,1] neg_lo:[0,0] neg_hi:[0,1]
v_pk_fma_f32 v[58:59], v[56:57], s[62:63], v[58:59] op_sel:[1,1,0] op_sel_hi:[1,0,1] neg_lo:[0,0,0] neg_hi:[0,0,0]
v_pk_add_f32 v[56:57], v[52:53], v[60:61] op_sel:[1,1] op_sel_hi:[0,0] neg_lo:[0,1] neg_hi:[1,0]
v_pk_add_f32 v[52:53], v[52:53], v[60:61]
v_pk_add_f32 v[60:61], v[54:55], v[62:63] neg_lo:[0,1] neg_hi:[0,1]
v_pk_add_f32 v[54:55], v[54:55], v[62:63]
v_pk_mul_f32 v[62:63], v[60:61], s[62:63] op_sel:[0,0] op_sel_hi:[0,1] neg_lo:[0,1] neg_hi:[0,1]
v_pk_fma_f32 v[62:63], v[60:61], s[62:63], v[62:63] op_sel:[1,1,0] op_sel_hi:[1,0,1] neg_lo:[0,0,0] neg_hi:[0,1,0]
v_pk_add_f32 v[60:61], v[40:41], v[48:49] neg_lo:[0,1] neg_hi:[0,1]
v_pk_add_f32 v[40:41], v[40:41], v[48:49]
v_pk_add_f32 v[48:49], v[66:67], v[74:75] neg_lo:[0,1] neg_hi:[0,1]
v_pk_add_f32 v[66:67], v[66:67], v[74:75]
v_pk_mul_f32 v[74:75], v[48:49], s[62:63] op_sel:[0,0] op_sel_hi:[0,1] neg_lo:[0,0] neg_hi:[0,1]
v_pk_fma_f32 v[74:75], v[48:49], s[62:63], v[74:75] op_sel:[1,1,0] op_sel_hi:[1,0,1] neg_lo:[0,0,0] neg_hi:[0,0,0]
v_pk_add_f32 v[48:49], v[68:69], v[76:77] op_sel:[1,1] op_sel_hi:[0,0] neg_lo:[0,1] neg_hi:[1,0]
v_pk_add_f32 v[68:69], v[68:69], v[76:77]
v_pk_add_f32 v[76:77], v[70:71], v[78:79] neg_lo:[0,1] neg_hi:[0,1]
v_pk_add_f32 v[70:71], v[70:71], v[78:79]
v_pk_mul_f32 v[78:79], v[76:77], s[62:63] op_sel:[0,0] op_sel_hi:[0,1] neg_lo:[0,1] neg_hi:[0,1]
v_pk_fma_f32 v[78:79], v[76:77], s[62:63], v[78:79] op_sel:[1,1,0] op_sel_hi:[1,0,1] neg_lo:[0,0,0] neg_hi:[0,1,0]
v_pk_add_f32 v[76:77], v[16:17], v[20:21] neg_lo:[0,1] neg_hi:[0,1]
v_pk_add_f32 v[16:17], v[16:17], v[20:21]
v_pk_add_f32 v[20:21], v[18:19], v[22:23] op_sel:[1,1] op_sel_hi:[0,0] neg_lo:[0,1] neg_hi:[1,0]
v_pk_add_f32 v[18:19], v[18:19], v[22:23]
v_pk_add_f32 v[22:23], v[72:73], v[24:25] neg_lo:[0,1] neg_hi:[0,1]
v_pk_add_f32 v[72:73], v[72:73], v[24:25]
v_pk_add_f32 v[24:25], v[26:27], v[30:31] op_sel:[1,1] op_sel_hi:[0,0] neg_lo:[0,1] neg_hi:[1,0]
v_pk_add_f32 v[26:27], v[26:27], v[30:31]
v_pk_add_f32 v[30:31], v[64:65], v[36:37] neg_lo:[0,1] neg_hi:[0,1]
v_pk_add_f32 v[64:65], v[64:65], v[36:37]
v_pk_add_f32 v[36:37], v[34:35], v[38:39] op_sel:[1,1] op_sel_hi:[0,0] neg_lo:[0,1] neg_hi:[1,0]
v_pk_add_f32 v[34:35], v[34:35], v[38:39]
v_pk_add_f32 v[38:39], v[28:29], v[32:33] neg_lo:[0,1] neg_hi:[0,1]
v_pk_add_f32 v[28:29], v[28:29], v[32:33]
v_pk_add_f32 v[32:33], v[42:43], v[46:47] op_sel:[1,1] op_sel_hi:[0,0] neg_lo:[0,1] neg_hi:[1,0]
v_pk_add_f32 v[42:43], v[42:43], v[46:47]
v_pk_add_f32 v[46:47], v[14:15], v[52:53] neg_lo:[0,1] neg_hi:[0,1]
v_pk_add_f32 v[14:15], v[14:15], v[52:53]
v_pk_add_f32 v[52:53], v[50:51], v[54:55] op_sel:[1,1] op_sel_hi:[0,0] neg_lo:[0,1] neg_hi:[1,0]
v_pk_add_f32 v[50:51], v[50:51], v[54:55]
v_pk_add_f32 v[54:55], v[44:45], v[56:57] neg_lo:[0,1] neg_hi:[0,1]
v_pk_add_f32 v[44:45], v[44:45], v[56:57]
v_pk_add_f32 v[56:57], v[58:59], v[62:63] op_sel:[1,1] op_sel_hi:[0,0] neg_lo:[0,1] neg_hi:[1,0]
v_pk_add_f32 v[58:59], v[58:59], v[62:63]
v_pk_add_f32 v[62:63], v[40:41], v[68:69] neg_lo:[0,1] neg_hi:[0,1]
v_pk_add_f32 v[40:41], v[40:41], v[68:69]
v_pk_add_f32 v[68:69], v[66:67], v[70:71] op_sel:[1,1] op_sel_hi:[0,0] neg_lo:[0,1] neg_hi:[1,0]
v_pk_add_f32 v[66:67], v[66:67], v[70:71]
v_pk_add_f32 v[70:71], v[60:61], v[48:49] neg_lo:[0,1] neg_hi:[0,1]
v_pk_add_f32 v[60:61], v[60:61], v[48:49]
v_pk_add_f32 v[48:49], v[74:75], v[78:79] op_sel:[1,1] op_sel_hi:[0,0] neg_lo:[0,1] neg_hi:[1,0]
v_pk_add_f32 v[74:75], v[74:75], v[78:79]
v_pk_add_f32 v[78:79], v[16:17], v[18:19] neg_lo:[0,1] neg_hi:[0,1]
v_pk_add_f32 v[16:17], v[16:17], v[18:19]
v_pk_add_f32 v[18:19], v[76:77], v[20:21] neg_lo:[0,1] neg_hi:[0,1]
v_pk_add_f32 v[76:77], v[76:77], v[20:21]
v_pk_add_f32 v[20:21], v[72:73], v[26:27] neg_lo:[0,1] neg_hi:[0,1]
v_pk_add_f32 v[72:73], v[72:73], v[26:27]
v_pk_add_f32 v[26:27], v[22:23], v[24:25] neg_lo:[0,1] neg_hi:[0,1]
v_pk_add_f32 v[22:23], v[22:23], v[24:25]
v_pk_add_f32 v[24:25], v[64:65], v[34:35] neg_lo:[0,1] neg_hi:[0,1]
v_pk_add_f32 v[64:65], v[64:65], v[34:35]
v_pk_add_f32 v[34:35], v[30:31], v[36:37] neg_lo:[0,1] neg_hi:[0,1]
v_pk_add_f32 v[30:31], v[30:31], v[36:37]
v_pk_add_f32 v[36:37], v[28:29], v[42:43] neg_lo:[0,1] neg_hi:[0,1]
v_pk_add_f32 v[28:29], v[28:29], v[42:43]
v_pk_add_f32 v[42:43], v[38:39], v[32:33] neg_lo:[0,1] neg_hi:[0,1]
v_pk_add_f32 v[38:39], v[38:39], v[32:33]
v_pk_add_f32 v[32:33], v[14:15], v[50:51] neg_lo:[0,1] neg_hi:[0,1]
v_pk_add_f32 v[14:15], v[14:15], v[50:51]
v_pk_add_f32 v[50:51], v[46:47], v[52:53] neg_lo:[0,1] neg_hi:[0,1]
v_pk_add_f32 v[46:47], v[46:47], v[52:53]
v_pk_add_f32 v[52:53], v[44:45], v[58:59] neg_lo:[0,1] neg_hi:[0,1]
v_pk_add_f32 v[44:45], v[44:45], v[58:59]
v_pk_add_f32 v[58:59], v[54:55], v[56:57] neg_lo:[0,1] neg_hi:[0,1]
v_pk_add_f32 v[54:55], v[54:55], v[56:57]
v_pk_add_f32 v[56:57], v[40:41], v[66:67] neg_lo:[0,1] neg_hi:[0,1]
v_pk_add_f32 v[40:41], v[40:41], v[66:67]
v_pk_add_f32 v[66:67], v[62:63], v[68:69] neg_lo:[0,1] neg_hi:[0,1]
v_pk_add_f32 v[62:63], v[62:63], v[68:69]
v_pk_add_f32 v[68:69], v[60:61], v[74:75] neg_lo:[0,1] neg_hi:[0,1]
v_pk_add_f32 v[60:61], v[60:61], v[74:75]
v_pk_add_f32 v[74:75], v[70:71], v[48:49] neg_lo:[0,1] neg_hi:[0,1]
v_pk_add_f32 v[70:71], v[70:71], v[48:49]
ds_write_b64 v4, v[16:17] offset:0
ds_write_b64 v4, v[14:15] offset:256
ds_write_b64 v4, v[64:65] offset:512
ds_write_b64 v4, v[40:41] offset:768
ds_write_b64 v4, v[72:73] offset:1024
ds_write_b64 v4, v[44:45] offset:1280
ds_write_b64 v4, v[28:29] offset:1536
ds_write_b64 v4, v[60:61] offset:1792
ds_write_b64 v4, v[76:77] offset:2048
ds_write_b64 v4, v[46:47] offset:2304
ds_write_b64 v4, v[30:31] offset:2560
ds_write_b64 v4, v[62:63] offset:2816
ds_write_b64 v4, v[22:23] offset:3072
ds_write_b64 v4, v[54:55] offset:3328
ds_write_b64 v4, v[38:39] offset:3584
ds_write_b64 v4, v[70:71] offset:3840
ds_write_b64 v4, v[78:79] offset:4096
ds_write_b64 v4, v[32:33] offset:4352
ds_write_b64 v4, v[24:25] offset:4608
ds_write_b64 v4, v[56:57] offset:4864
ds_write_b64 v4, v[20:21] offset:5120
ds_write_b64 v4, v[52:53] offset:5376
ds_write_b64 v4, v[36:37] offset:5632
ds_write_b64 v4, v[68:69] offset:5888
ds_write_b64 v4, v[18:19] offset:6144
ds_write_b64 v4, v[50:51] offset:6400
ds_write_b64 v4, v[34:35] offset:6656
ds_write_b64 v4, v[66:67] offset:6912
ds_write_b64 v4, v[26:27] offset:7168
ds_write_b64 v4, v[58:59] offset:7424
ds_write_b64 v4, v[42:43] offset:7680
ds_write_b64 v4, v[74:75] offset:7936
ds_write_b64 v4, v[16:17] offset:8192
s_waitcnt lgkmcnt(0)
s_barrier
s_lshl_b32 s13, s93, 7
s_add_u32 s13, s13, 96468992
ds_read_b64 v[16:17], v6 offset:0
ds_read_b64 v[18:19], v7 offset:4096
ds_read_b64 v[20:21], v6 offset:256
ds_read_b64 v[22:23], v7 offset:3840
ds_read_b64 v[24:25], v6 offset:512
ds_read_b64 v[26:27], v7 offset:3584
ds_read_b64 v[28:29], v6 offset:768
ds_read_b64 v[30:31], v7 offset:3328
ds_read_b64 v[32:33], v6 offset:1024
ds_read_b64 v[34:35], v7 offset:3072
ds_read_b64 v[36:37], v6 offset:1280
ds_read_b64 v[38:39], v7 offset:2816
s_waitcnt lgkmcnt(10)
v_pk_add_f32 v[208:209], v[16:17], v[18:19] neg_hi:[0,1]
v_pk_add_f32 v[210:211], v[16:17], v[18:19] op_sel:[1,1] op_sel_hi:[0,0] neg_hi:[1,0]
ds_read_b64 v[40:41], v6 offset:1536
ds_read_b64 v[42:43], v7 offset:2560
buffer_store_dwordx4 v[208:211], v8, s[84:87], s13 offen sc1
s_add_u32 s13, s13, 524288
s_waitcnt lgkmcnt(10)
v_pk_add_f32 v[212:213], v[20:21], v[22:23] neg_hi:[0,1]
v_pk_add_f32 v[214:215], v[20:21], v[22:23] op_sel:[1,1] op_sel_hi:[0,0] neg_hi:[1,0]
ds_read_b64 v[44:45], v6 offset:1792
ds_read_b64 v[46:47], v7 offset:2304
buffer_store_dwordx4 v[212:215], v8, s[84:87], s13 offen sc1
s_add_u32 s13, s13, 524288
s_waitcnt lgkmcnt(10)
v_pk_add_f32 v[216:217], v[24:25], v[26:27] neg_hi:[0,1]
v_pk_add_f32 v[218:219], v[24:25], v[26:27] op_sel:[1,1] op_sel_hi:[0,0] neg_hi:[1,0]
ds_read_b64 v[16:17], v6 offset:2048
ds_read_b64 v[18:19], v7 offset:2048
buffer_store_dwordx4 v[216:219], v8, s[84:87], s13 offen sc1
s_add_u32 s13, s13, 524288
s_waitcnt lgkmcnt(10)
v_pk_add_f32 v[220:221], v[28:29], v[30:31] neg_hi:[0,1]
v_pk_add_f32 v[222:223], v[28:29], v[30:31] op_sel:[1,1] op_sel_hi:[0,0] neg_hi:[1,0]
ds_read_b64 v[20:21], v6 offset:2304
ds_read_b64 v[22:23], v7 offset:1792
buffer_store_dwordx4 v[220:223], v8, s[84:87], s13 offen sc1
s_add_u32 s13, s13, 524288
s_waitcnt lgkmcnt(10)
v_pk_add_f32 v[224:225], v[32:33], v[34:35] neg_hi:[0,1]
v_pk_add_f32 v[226:227], v[32:33], v[34:35] op_sel:[1,1] op_sel_hi:[0,0] neg_hi:[1,0]
ds_read_b64 v[24:25], v6 offset:2560
ds_read_b64 v[26:27], v7 offset:1536
buffer_store_dwordx4 v[224:227], v8, s[84:87], s13 offen sc1
s_add_u32 s13, s13, 524288
s_waitcnt lgkmcnt(10)
v_pk_add_f32 v[228:229], v[36:37], v[38:39] neg_hi:[0,1]
v_pk_add_f32 v[230:231], v[36:37], v[38:39] op_sel:[1,1] op_sel_hi:[0,0] neg_hi:[1,0]
ds_read_b64 v[28:29], v6 offset:2816
ds_read_b64 v[30:31], v7 offset:1280
buffer_store_dwordx4 v[228:231], v8, s[84:87], s13 offen sc1
s_add_u32 s13, s13, 524288
s_waitcnt lgkmcnt(10)
v_pk_add_f32 v[232:233], v[40:41], v[42:43] neg_hi:[0,1]
v_pk_add_f32 v[234:235], v[40:41], v[42:43] op_sel:[1,1] op_sel_hi:[0,0] neg_hi:[1,0]
ds_read_b64 v[32:33], v6 offset:3072
ds_read_b64 v[34:35], v7 offset:1024
buffer_store_dwordx4 v[232:235], v8, s[84:87], s13 offen sc1
s_add_u32 s13, s13, 524288
s_waitcnt lgkmcnt(10)
v_pk_add_f32 v[236:237], v[44:45], v[46:47] neg_hi:[0,1]
v_pk_add_f32 v[238:239], v[44:45], v[46:47] op_sel:[1,1] op_sel_hi:[0,0] neg_hi:[1,0]
ds_read_b64 v[36:37], v6 offset:3328
ds_read_b64 v[38:39], v7 offset:768
buffer_store_dwordx4 v[236:239], v8, s[84:87], s13 offen sc1
s_add_u32 s13, s13, 524288
s_waitcnt lgkmcnt(10)
v_pk_add_f32 v[208:209], v[16:17], v[18:19] neg_hi:[0,1]
v_pk_add_f32 v[210:211], v[16:17], v[18:19] op_sel:[1,1] op_sel_hi:[0,0] neg_hi:[1,0]
ds_read_b64 v[40:41], v6 offset:3584
ds_read_b64 v[42:43], v7 offset:512
buffer_store_dwordx4 v[208:211], v8, s[84:87], s13 offen sc1
s_add_u32 s13, s13, 524288
s_waitcnt lgkmcnt(10)
v_pk_add_f32 v[212:213], v[20:21], v[22:23] neg_hi:[0,1]
v_pk_add_f32 v[214:215], v[20:21], v[22:23] op_sel:[1,1] op_sel_hi:[0,0] neg_hi:[1,0]
ds_read_b64 v[44:45], v6 offset:3840
ds_read_b64 v[46:47], v7 offset:256
buffer_store_dwordx4 v[212:215], v8, s[84:87], s13 offen sc1
s_add_u32 s13, s13, 524288
s_waitcnt lgkmcnt(10)
v_pk_add_f32 v[216:217], v[24:25], v[26:27] neg_hi:[0,1]
v_pk_add_f32 v[218:219], v[24:25], v[26:27] op_sel:[1,1] op_sel_hi:[0,0] neg_hi:[1,0]
ds_read_b64 v[16:17], v6 offset:4096
ds_read_b64 v[18:19], v7 offset:0
buffer_store_dwordx4 v[216:219], v8, s[84:87], s13 offen sc1
s_add_u32 s13, s13, 524288
s_waitcnt lgkmcnt(10)
v_pk_add_f32 v[220:221], v[28:29], v[30:31] neg_hi:[0,1]
v_pk_add_f32 v[222:223], v[28:29], v[30:31] op_sel:[1,1] op_sel_hi:[0,0] neg_hi:[1,0]
buffer_store_dwordx4 v[220:223], v8, s[84:87], s13 offen sc1
s_add_u32 s13, s13, 524288
s_waitcnt lgkmcnt(8)
v_pk_add_f32 v[224:225], v[32:33], v[34:35] neg_hi:[0,1]
v_pk_add_f32 v[226:227], v[32:33], v[34:35] op_sel:[1,1] op_sel_hi:[0,0] neg_hi:[1,0]
buffer_store_dwordx4 v[224:227], v8, s[84:87], s13 offen sc1
s_add_u32 s13, s13, 524288
s_waitcnt lgkmcnt(6)
v_pk_add_f32 v[228:229], v[36:37], v[38:39] neg_hi:[0,1]
v_pk_add_f32 v[230:231], v[36:37], v[38:39] op_sel:[1,1] op_sel_hi:[0,0] neg_hi:[1,0]
buffer_store_dwordx4 v[228:231], v8, s[84:87], s13 offen sc1
s_add_u32 s13, s13, 524288
s_waitcnt lgkmcnt(4)
v_pk_add_f32 v[232:233], v[40:41], v[42:43] neg_hi:[0,1]
v_pk_add_f32 v[234:235], v[40:41], v[42:43] op_sel:[1,1] op_sel_hi:[0,0] neg_hi:[1,0]
buffer_store_dwordx4 v[232:235], v8, s[84:87], s13 offen sc1
s_add_u32 s13, s13, 524288
s_waitcnt lgkmcnt(2)
v_pk_add_f32 v[236:237], v[44:45], v[46:47] neg_hi:[0,1]
v_pk_add_f32 v[238:239], v[44:45], v[46:47] op_sel:[1,1] op_sel_hi:[0,0] neg_hi:[1,0]
buffer_store_dwordx4 v[236:239], v8, s[84:87], s13 offen sc1
s_add_u32 s13, s13, 524288
s_waitcnt lgkmcnt(0)
v_pk_add_f32 v[208:209], v[16:17], v[18:19] neg_hi:[0,1]
v_pk_add_f32 v[210:211], v[16:17], v[18:19] op_sel:[1,1] op_sel_hi:[0,0] neg_hi:[1,0]
v_cmp_eq_u32 vcc, 0, v9
s_nop 1
v_cndmask_b32 v13, -16, v8, vcc
buffer_store_dwordx4 v[208:211], v13, s[84:87], s13 offen sc1
s_add_u32 s13, s13, 524288
s_mov_b32 s93, s21
s_cmp_lt_u32 s93, 128
s_cbranch_scc1 mega_kernel_f1_l
mega_kernel_f1_e:
s_mov_b32 s93, s40
s_waitcnt vmcnt(0)
s_load_dwordx2 s[4:5], s[0:1], 64
s_load_dwordx2 s[8:9], s[0:1], 72
v_and_b32 v1, 63, v0
v_lshrrev_b32 v2, 6, v0
v_mul_u32_u24 v3, 1026, v2
v_lshl_add_u32 v3, v1, 1, v3
v_mul_u32_u24 v4, 65, v1
v_add_u32 v4, v4, v2
v_lshlrev_b32 v4, 2, v4
v_lshrrev_b32 v7, 4, v0
v_and_b32 v8, 15, v0
v_mul_u32_u24 v5, 65, v7
v_lshl_add_u32 v5, v8, 2, v5
v_lshlrev_b32 v5, 2, v5
v_lshlrev_b32 v6, 13, v7
v_lshl_add_u32 v6, v8, 4, v6
s_add_u32 s24, s84, 121634816
s_addc_u32 s25, s85, 0
s_mov_b32 s26, 4202496
s_mov_b32 s27, 0x00020000
s_waitcnt lgkmcnt(0)
s_mov_b32 s6, 2101248
s_mov_b32 s7, 0x00020000
s_mov_b32 s10, 2101248
s_mov_b32 s11, 0x00020000
s_cmp_lt_u32 s93, 288
s_cbranch_scc0 mega_kernel_f0_e
s_and_b32 s12, s93, 31
s_mul_i32 s12, s12, 65664
s_lshr_b32 s13, s93, 5
s_lshl_b32 s13, s13, 7
s_add_u32 s12, s12, s13
buffer_load_ushort v16, v3, s[4:7], s12 offen
buffer_load_ushort v32, v3, s[8:11], s12 offen
s_add_u32 s12, s12, 4104
buffer_load_ushort v17, v3, s[4:7], s12 offen
buffer_load_ushort v33, v3, s[8:11], s12 offen
s_add_u32 s12, s12, 4104
buffer_load_ushort v18, v3, s[4:7], s12 offen
buffer_load_ushort v34, v3, s[8:11], s12 offen
s_add_u32 s12, s12, 4104
buffer_load_ushort v19, v3, s[4:7], s12 offen
buffer_load_ushort v35, v3, s[8:11], s12 offen
s_add_u32 s12, s12, 4104
buffer_load_ushort v20, v3, s[4:7], s12 offen
buffer_load_ushort v36, v3, s[8:11], s12 offen
s_add_u32 s12, s12, 4104
buffer_load_ushort v21, v3, s[4:7], s12 offen
buffer_load_ushort v37, v3, s[8:11], s12 offen
s_add_u32 s12, s12, 4104
buffer_load_ushort v22, v3, s[4:7], s12 offen
buffer_load_ushort v38, v3, s[8:11], s12 offen
s_add_u32 s12, s12, 4104
buffer_load_ushort v23, v3, s[4:7], s12 offen
buffer_load_ushort v39, v3, s[8:11], s12 offen
s_add_u32 s12, s12, 4104
buffer_load_ushort v24, v3, s[4:7], s12 offen
buffer_load_ushort v40, v3, s[8:11], s12 offen
s_add_u32 s12, s12, 4104
buffer_load_ushort v25, v3, s[4:7], s12 offen
buffer_load_ushort v41, v3, s[8:11], s12 offen
s_add_u32 s12, s12, 4104
buffer_load_ushort v26, v3, s[4:7], s12 offen
buffer_load_ushort v42, v3, s[8:11], s12 offen
s_add_u32 s12, s12, 4104
buffer_load_ushort v27, v3, s[4:7], s12 offen
buffer_load_ushort v43, v3, s[8:11], s12 offen
s_add_u32 s12, s12, 4104
buffer_load_ushort v28, v3, s[4:7], s12 offen
buffer_load_ushort v44, v3, s[8:11], s12 offen
s_add_u32 s12, s12, 4104
buffer_load_ushort v29, v3, s[4:7], s12 offen
buffer_load_ushort v45, v3, s[8:11], s12 offen
s_add_u32 s12, s12, 4104
buffer_load_ushort v30, v3, s[4:7], s12 offen
buffer_load_ushort v46, v3, s[8:11], s12 offen
s_add_u32 s12, s12, 4104
buffer_load_ushort v31, v3, s[4:7], s12 offen
buffer_load_ushort v47, v3, s[8:11], s12 offen
s_add_u32 s12, s12, 4104
s_waitcnt vmcnt(0)
mega_kernel_f0_l:
s_add_u32 s21, s93, 32
s_cmp_lt_u32 s21, 288
s_cselect_b32 s22, s21, s93
s_waitcnt vmcnt(4)
v_lshl_or_b32 v48, v32, 16, v16
v_lshl_or_b32 v49, v33, 16, v17
v_lshl_or_b32 v50, v34, 16, v18
v_lshl_or_b32 v51, v35, 16, v19
v_lshl_or_b32 v52, v36, 16, v20
v_lshl_or_b32 v53, v37, 16, v21
v_lshl_or_b32 v54, v38, 16, v22
v_lshl_or_b32 v55, v39, 16, v23
v_lshl_or_b32 v56, v40, 16, v24
v_lshl_or_b32 v57, v41, 16, v25
v_lshl_or_b32 v58, v42, 16, v26
v_lshl_or_b32 v59, v43, 16, v27
v_lshl_or_b32 v60, v44, 16, v28
v_lshl_or_b32 v61, v45, 16, v29
v_lshl_or_b32 v62, v46, 16, v30
v_lshl_or_b32 v63, v47, 16, v31
s_and_b32 s12, s22, 31
s_mul_i32 s12, s12, 65664
s_lshr_b32 s13, s22, 5
s_lshl_b32 s13, s13, 7
s_add_u32 s12, s12, s13
buffer_load_ushort v16, v3, s[4:7], s12 offen
buffer_load_ushort v32, v3, s[8:11], s12 offen
s_add_u32 s12, s12, 4104
buffer_load_ushort v17, v3, s[4:7], s12 offen
buffer_load_ushort v33, v3, s[8:11], s12 offen
s_add_u32 s12, s12, 4104
buffer_load_ushort v18, v3, s[4:7], s12 offen
buffer_load_ushort v34, v3, s[8:11], s12 offen
s_add_u32 s12, s12, 4104
buffer_load_ushort v19, v3, s[4:7], s12 offen
buffer_load_ushort v35, v3, s[8:11], s12 offen
s_add_u32 s12, s12, 4104
buffer_load_ushort v20, v3, s[4:7], s12 offen
buffer_load_ushort v36, v3, s[8:11], s12 offen
s_add_u32 s12, s12, 4104
buffer_load_ushort v21, v3, s[4:7], s12 offen
buffer_load_ushort v37, v3, s[8:11], s12 offen
s_add_u32 s12, s12, 4104
buffer_load_ushort v22, v3, s[4:7], s12 offen
buffer_load_ushort v38, v3, s[8:11], s12 offen
s_add_u32 s12, s12, 4104
buffer_load_ushort v23, v3, s[4:7], s12 offen
buffer_load_ushort v39, v3, s[8:11], s12 offen
s_add_u32 s12, s12, 4104
buffer_load_ushort v24, v3, s[4:7], s12 offen
buffer_load_ushort v40, v3, s[8:11], s12 offen
s_add_u32 s12, s12, 4104
buffer_load_ushort v25, v3, s[4:7], s12 offen
buffer_load_ushort v41, v3, s[8:11], s12 offen
s_add_u32 s12, s12, 4104
buffer_load_ushort v26, v3, s[4:7], s12 offen
buffer_load_ushort v42, v3, s[8:11], s12 offen
s_add_u32 s12, s12, 4104
buffer_load_ushort v27, v3, s[4:7], s12 offen
buffer_load_ushort v43, v3, s[8:11], s12 offen
s_add_u32 s12, s12, 4104
buffer_load_ushort v28, v3, s[4:7], s12 offen
buffer_load_ushort v44, v3, s[8:11], s12 offen
s_add_u32 s12, s12, 4104
buffer_load_ushort v29, v3, s[4:7], s12 offen
buffer_load_ushort v45, v3, s[8:11], s12 offen
s_add_u32 s12, s12, 4104
buffer_load_ushort v30, v3, s[4:7], s12 offen
buffer_load_ushort v46, v3, s[8:11], s12 offen
s_add_u32 s12, s12, 4104
buffer_load_ushort v31, v3, s[4:7], s12 offen
buffer_load_ushort v47, v3, s[8:11], s12 offen
s_add_u32 s12, s12, 4104
s_barrier
ds_write_b32 v4, v48 offset:0
ds_write_b32 v4, v49 offset:16
ds_write_b32 v4, v50 offset:32
ds_write_b32 v4, v51 offset:48
ds_write_b32 v4, v52 offset:64
ds_write_b32 v4, v53 offset:80
ds_write_b32 v4, v54 offset:96
ds_write_b32 v4, v55 offset:112
ds_write_b32 v4, v56 offset:128
ds_write_b32 v4, v57 offset:144
ds_write_b32 v4, v58 offset:160
ds_write_b32 v4, v59 offset:176
s_waitcnt lgkmcnt(4)
ds_write_b32 v4, v60 offset:192
ds_write_b32 v4, v61 offset:208
ds_write_b32 v4, v62 offset:224
ds_write_b32 v4, v63 offset:240
s_waitcnt lgkmcnt(0)
s_barrier
ds_read2_b32 v[64:65], v5 offset0:0 offset1:1
ds_read_b32 v66, v5 offset:8
ds_read_b32 v67, v5 offset:12
ds_read_b32 v68, v5 offset:4160
ds_read_b32 v69, v5 offset:4164
ds_read_b32 v70, v5 offset:4168
ds_read_b32 v71, v5 offset:4172
ds_read_b32 v72, v5 offset:8320
ds_read_b32 v73, v5 offset:8324
ds_read_b32 v74, v5 offset:8328
ds_read_b32 v75, v5 offset:8332
ds_read_b32 v76, v5 offset:12480
ds_read_b32 v77, v5 offset:12484
ds_read_b32 v78, v5 offset:12488
ds_read_b32 v79, v5 offset:12492
s_and_b32 s14, s93, 31
s_lshl_b32 s14, s14, 8
s_lshr_b32 s15, s93, 5
s_lshl_b32 s15, s15, 19
s_add_u32 s14, s14, s15
s_waitcnt lgkmcnt(0)
buffer_store_dwordx4 v[64:67], v6, s[24:27], s14 offen sc1
s_add_u32 s14, s14, 131072
buffer_store_dwordx4 v[68:71], v6, s[24:27], s14 offen sc1
s_add_u32 s14, s14, 131072
buffer_store_dwordx4 v[72:75], v6, s[24:27], s14 offen sc1
s_add_u32 s14, s14, 131072
buffer_store_dwordx4 v[76:79], v6, s[24:27], s14 offen sc1
s_add_u32 s14, s14, 131072
s_mov_b32 s93, s21
s_cmp_lt_u32 s93, 288
s_cbranch_scc1 mega_kernel_f0_l
mega_kernel_f0_e:
v_and_b32 v3, 15, v0
v_lshlrev_b32 v3, 4, v3
s_branch mega_kernel_syd
mega_kernel_sydw:
s_sleep 4
mega_kernel_syd:
buffer_load_dword v2, v3, s[72:75], 0 offen sc1
s_waitcnt vmcnt(0)
s_cmp_eq_u32 s95, 1
s_cbranch_scc0 mega_kernel_sydf
v_readlane_b32 s76, v2, 14
s_mov_b32 s98, 0
s_cmp_eq_u32 s76, 64
s_cbranch_scc0 mega_kernel_sydw
s_branch mega_kernel_sydd
mega_kernel_sydf:
s_mov_b32 s77, 0
s_mov_b32 s78, 0
v_readlane_b32 s76, v2, 0
s_add_u32 s77, s77, s76
s_xor_b32 s76, s76, 32
s_or_b32 s78, s78, s76
v_readlane_b32 s76, v2, 1
s_add_u32 s77, s77, s76
s_xor_b32 s76, s76, 32
s_or_b32 s78, s78, s76
v_readlane_b32 s76, v2, 2
s_add_u32 s77, s77, s76
s_xor_b32 s76, s76, 32
s_or_b32 s78, s78, s76
v_readlane_b32 s76, v2, 3
s_add_u32 s77, s77, s76
s_xor_b32 s76, s76, 32
s_or_b32 s78, s78, s76
v_readlane_b32 s76, v2, 4
s_add_u32 s77, s77, s76
s_xor_b32 s76, s76, 32
s_or_b32 s78, s78, s76
v_readlane_b32 s76, v2, 5
s_add_u32 s77, s77, s76
s_xor_b32 s76, s76, 32
s_or_b32 s78, s78, s76
v_readlane_b32 s76, v2, 6
s_add_u32 s77, s77, s76
s_xor_b32 s76, s76, 32
s_or_b32 s78, s78, s76
v_readlane_b32 s76, v2, 7
s_add_u32 s77, s77, s76
s_xor_b32 s76, s76, 32
s_or_b32 s78, s78, s76
s_cmp_eq_u32 s77, 256
s_cbranch_scc0 mega_kernel_sydw
v_mov_b32 v252, v2
s_cmp_eq_u32 s78, 0
s_cbranch_scc0 mega_kernel_slowent
v_readlane_b32 s76, v2, 10
v_readlane_b32 s77, v2, 8
s_cmp_eq_u32 s76, 64
s_cbranch_scc0 mega_kernel_sydw
s_cmp_gt_u32 s77, 32
s_cselect_b32 s98, 1, 0
mega_kernel_sydd:
s_waitcnt vmcnt(0)
s_barrier
v_mov_b32 v1, 0
v_mov_b32 v2, 1
s_mov_b32 s82, 69259264
v_cmp_eq_u32 vcc, 0, v0
s_and_saveexec_b64 s[80:81], vcc
s_cbranch_execz mega_kernel_sg0
buffer_atomic_add v2, v1, s[84:87], s82 offen sc1
mega_kernel_sg0:
s_mov_b64 exec, s[80:81]
s_add_u32 s38, s40, 129
s_mov_b32 s39, 32
s_mov_b32 s37, 129
s_cmp_lt_u32 s38, 129
s_cbranch_scc1 mega_kernel_f2s
s_branch mega_kernel_f2e
mega_kernel_rk:
s_load_dwordx2 s[4:5], s[0:1], 24
s_load_dwordx2 s[8:9], s[0:1], 0
v_lshrrev_b32 v2, 6, v0
v_and_b32 v1, 63, v0
v_readfirstlane_b32 s41, v2
v_lshlrev_b32 v5, 4, v1
s_waitcnt lgkmcnt(0)
s_mov_b32 s6, 8388608
s_mov_b32 s7, 0x00020000
s_mov_b32 s10, 4194304
s_mov_b32 s11, 0x00020000
s_lshl_b32 s43, s40, 8
s_lshl_b32 s44, s41, 6
s_add_u32 s48, s43, s44
s_and_b32 s43, s48, 0x7ff
v_add_u32 v19, s43, v1
v_lshlrev_b32 v19, 7, v19
buffer_load_dword v250, v19, s[8:11], 0 offen
s_nop 0
v_lshrrev_b32 v2, 3, v1
s_lshl_b32 s43, s41, 3
v_add_u32 v2, s43, v2
v_bfe_u32 v3, v2, 1, 3
v_and_b32 v4, 7, v1
v_xor_b32 v3, v3, v4
v_lshlrev_b32 v6, 11, v2
v_lshl_add_u32 v6, v3, 4, v6
s_lshl_b32 s46, s41, 10
v_and_b32 v2, 15, v1
v_bfe_u32 v3, v2, 1, 3
v_lshrrev_b32 v4, 4, v1
v_xor_b32 v3, v3, v4
v_lshlrev_b32 v8, 7, v2
v_lshl_add_u32 v8, v3, 4, v8
v_xor_b32 v9, 64, v8
v_add_u32 v10, 0x10000, v8
v_add_u32 v11, 0x10000, v9
v_mov_b32 v7, v5
s_lshl_b32 s47, s40, 2
s_add_u32 s47, s47, s41
s_mov_b32 s42, 0
s_mov_b32 s50, 0
s_add_u32 m0, s46, 0
s_nop 0
buffer_load_dwordx4 v6, s[8:11], s50 offen offset:0 lds
s_add_u32 m0, s46, 3968
s_nop 0
buffer_load_dwordx4 v6, s[8:11], s50 offen offset:128 lds
s_add_u32 m0, s46, 7936
s_nop 0
buffer_load_dwordx4 v6, s[8:11], s50 offen offset:256 lds
s_add_u32 m0, s46, 11904
s_nop 0
buffer_load_dwordx4 v6, s[8:11], s50 offen offset:384 lds
s_add_u32 m0, s46, 15872
s_nop 0
buffer_load_dwordx4 v6, s[8:11], s50 offen offset:512 lds
s_add_u32 m0, s46, 19840
s_nop 0
buffer_load_dwordx4 v6, s[8:11], s50 offen offset:640 lds
s_add_u32 m0, s46, 23808
s_nop 0
buffer_load_dwordx4 v6, s[8:11], s50 offen offset:768 lds
s_add_u32 m0, s46, 27776
s_nop 0
buffer_load_dwordx4 v6, s[8:11], s50 offen offset:896 lds
s_add_u32 m0, s46, 31744
s_nop 0
buffer_load_dwordx4 v6, s[8:11], s50 offen offset:1024 lds
s_add_u32 m0, s46, 35712
s_nop 0
buffer_load_dwordx4 v6, s[8:11], s50 offen offset:1152 lds
s_add_u32 m0, s46, 39680
s_nop 0
buffer_load_dwordx4 v6, s[8:11], s50 offen offset:1280 lds
s_add_u32 m0, s46, 43648
s_nop 0
buffer_load_dwordx4 v6, s[8:11], s50 offen offset:1408 lds
s_add_u32 m0, s46, 47616
s_nop 0
buffer_load_dwordx4 v6, s[8:11], s50 offen offset:1536 lds
s_add_u32 m0, s46, 51584
s_nop 0
buffer_load_dwordx4 v6, s[8:11], s50 offen offset:1664 lds
s_add_u32 m0, s46, 55552
s_nop 0
buffer_load_dwordx4 v6, s[8:11], s50 offen offset:1792 lds
s_add_u32 m0, s46, 59520
s_nop 0
buffer_load_dwordx4 v6, s[8:11], s50 offen offset:1920 lds
v_lshrrev_b32 v2, 2, v1
v_and_b32 v3, 3, v1
v_lshlrev_b32 v16, 13, v2
v_lshl_add_u32 v16, v3, 4, v16
v_add_u32 v16, s48, v16
s_mul_i32 s45, s41, 24576
s_add_u32 s45, s45, 65536
v_bfe_u32 v17, v1, 2, 2
v_lshrrev_b32 v18, 4, v1
v_lshl_add_u32 v17, v18, 3, v17
v_lshlrev_b32 v17, 6, v17
v_lshl_add_u32 v17, v3, 4, v17
v_add_u32 v17, s45, v17
s_and_b32 s43, s40, 3
s_lshl_b32 s43, s43, 2
s_add_u32 s43, s43, s41
s_lshl_b32 s43, s43, 3
v_and_b32 v12, 7, v1
v_add_u32 v12, s43, v12
s_lshr_b32 s43, s40, 2
s_lshl_b32 s43, s43, 10
s_add_u32 s44, s43, 896
s_add_u32 s43, s43, 384
s_cmp_ge_u32 s40, 28
s_cselect_b32 s44, s44, s43
v_mov_b32 v13, s43
v_mov_b32 v14, s44
v_cmp_gt_u32 vcc, 32, v1
s_nop 1
v_cndmask_b32 v13, v14, v13, vcc
v_lshl_add_u32 v12, v12, 13, v13
s_mov_b32 s44, 0
buffer_load_dword v250, v12, s[4:7], s44 offen
s_add_u32 m0, s45, 0
s_mov_b32 s44, 0
buffer_load_dwordx4 v16, s[4:7], s44 offen lds
s_add_u32 m0, s45, 1024
s_mov_b32 s44, 131072
buffer_load_dwordx4 v16, s[4:7], s44 offen lds
s_add_u32 m0, s45, 2048
s_mov_b32 s44, 262144
buffer_load_dwordx4 v16, s[4:7], s44 offen lds
s_add_u32 m0, s45, 3072
s_mov_b32 s44, 393216
buffer_load_dwordx4 v16, s[4:7], s44 offen lds
s_add_u32 m0, s45, 4096
s_mov_b32 s44, 524288
buffer_load_dwordx4 v16, s[4:7], s44 offen lds
s_add_u32 m0, s45, 5120
s_mov_b32 s44, 655360
buffer_load_dwordx4 v16, s[4:7], s44 offen lds
s_add_u32 m0, s45, 6144
s_mov_b32 s44, 786432
buffer_load_dwordx4 v16, s[4:7], s44 offen lds
s_add_u32 m0, s45, 7168
s_mov_b32 s44, 917504
buffer_load_dwordx4 v16, s[4:7], s44 offen lds
s_mov_b32 s44, 1048576
buffer_load_dword v250, v12, s[4:7], s44 offen
s_add_u32 m0, s45, 8192
s_mov_b32 s44, 1048576
buffer_load_dwordx4 v16, s[4:7], s44 offen lds
s_add_u32 m0, s45, 9216
s_mov_b32 s44, 1179648
buffer_load_dwordx4 v16, s[4:7], s44 offen lds
s_add_u32 m0, s45, 10240
s_mov_b32 s44, 1310720
buffer_load_dwordx4 v16, s[4:7], s44 offen lds
s_add_u32 m0, s45, 11264
s_mov_b32 s44, 1441792
buffer_load_dwordx4 v16, s[4:7], s44 offen lds
s_add_u32 m0, s45, 12288
s_mov_b32 s44, 1572864
buffer_load_dwordx4 v16, s[4:7], s44 offen lds
s_add_u32 m0, s45, 13312
s_mov_b32 s44, 1703936
buffer_load_dwordx4 v16, s[4:7], s44 offen lds
s_add_u32 m0, s45, 14336
s_mov_b32 s44, 1835008
buffer_load_dwordx4 v16, s[4:7], s44 offen lds
s_add_u32 m0, s45, 15360
s_mov_b32 s44, 1966080
buffer_load_dwordx4 v16, s[4:7], s44 offen lds
s_mov_b32 s44, 2097152
buffer_load_dword v250, v12, s[4:7], s44 offen
s_add_u32 m0, s45, 16384
s_mov_b32 s44, 2097152
buffer_load_dwordx4 v16, s[4:7], s44 offen lds
s_add_u32 m0, s45, 17408
s_mov_b32 s44, 2228224
buffer_load_dwordx4 v16, s[4:7], s44 offen lds
s_add_u32 m0, s45, 18432
s_mov_b32 s44, 2359296
buffer_load_dwordx4 v16, s[4:7], s44 offen lds
s_add_u32 m0, s45, 19456
s_mov_b32 s44, 2490368
buffer_load_dwordx4 v16, s[4:7], s44 offen lds
s_add_u32 m0, s45, 20480
s_mov_b32 s44, 2621440
buffer_load_dwordx4 v16, s[4:7], s44 offen lds
s_add_u32 m0, s45, 21504
s_mov_b32 s44, 2752512
buffer_load_dwordx4 v16, s[4:7], s44 offen lds
s_add_u32 m0, s45, 22528
s_mov_b32 s44, 2883584
buffer_load_dwordx4 v16, s[4:7], s44 offen lds
s_add_u32 m0, s45, 23552
s_mov_b32 s44, 3014656
buffer_load_dwordx4 v16, s[4:7], s44 offen lds
s_waitcnt vmcnt(18)
s_barrier
ds_read_b64_tr_b16 a[0:1], v17 offset:0
ds_read_b64_tr_b16 a[2:3], v17 offset:256
ds_read_b64_tr_b16 a[4:5], v17 offset:8
ds_read_b64_tr_b16 a[6:7], v17 offset:264
ds_read_b64_tr_b16 a[8:9], v17 offset:2048
ds_read_b64_tr_b16 a[10:11], v17 offset:2304
ds_read_b64_tr_b16 a[12:13], v17 offset:2056
ds_read_b64_tr_b16 a[14:15], v17 offset:2312
s_waitcnt lgkmcnt(0)
ds_read_b64_tr_b16 a[16:17], v17 offset:4096
ds_read_b64_tr_b16 a[18:19], v17 offset:4352
ds_read_b64_tr_b16 a[20:21], v17 offset:4104
ds_read_b64_tr_b16 a[22:23], v17 offset:4360
ds_read_b64_tr_b16 a[24:25], v17 offset:6144
ds_read_b64_tr_b16 a[26:27], v17 offset:6400
ds_read_b64_tr_b16 a[28:29], v17 offset:6152
ds_read_b64_tr_b16 a[30:31], v17 offset:6408
s_waitcnt lgkmcnt(0)
ds_read_b128 v[20:23], v8 offset:0
ds_read_b128 v[24:27], v8 offset:2048
ds_read_b128 v[28:31], v9 offset:0
ds_read_b128 v[32:35], v9 offset:2048
ds_read_b128 v[36:39], v8 offset:4096
ds_read_b128 v[40:43], v8 offset:6144
ds_read_b128 v[44:47], v9 offset:4096
ds_read_b128 v[48:51], v9 offset:6144
s_mov_b32 s44, 3145728
buffer_load_dword v250, v12, s[4:7], s44 offen
s_add_u32 m0, s45, 0
s_mov_b32 s44, 3145728
buffer_load_dwordx4 v16, s[4:7], s44 offen lds
s_add_u32 m0, s45, 1024
s_mov_b32 s44, 3276800
buffer_load_dwordx4 v16, s[4:7], s44 offen lds
s_add_u32 m0, s45, 2048
s_mov_b32 s44, 3407872
buffer_load_dwordx4 v16, s[4:7], s44 offen lds
s_add_u32 m0, s45, 3072
s_mov_b32 s44, 3538944
buffer_load_dwordx4 v16, s[4:7], s44 offen lds
s_add_u32 m0, s45, 4096
s_mov_b32 s44, 3670016
buffer_load_dwordx4 v16, s[4:7], s44 offen lds
s_add_u32 m0, s45, 5120
s_mov_b32 s44, 3801088
buffer_load_dwordx4 v16, s[4:7], s44 offen lds
s_add_u32 m0, s45, 6144
s_mov_b32 s44, 3932160
buffer_load_dwordx4 v16, s[4:7], s44 offen lds
s_add_u32 m0, s45, 7168
s_mov_b32 s44, 4063232
buffer_load_dwordx4 v16, s[4:7], s44 offen lds
s_waitcnt lgkmcnt(0)
v_mfma_f32_16x16x32_bf16 v[52:55], a[0:3], v[20:23], 0
v_mfma_f32_16x16x32_bf16 v[56:59], a[4:7], v[20:23], 0
v_mfma_f32_16x16x32_bf16 v[60:63], a[0:3], v[24:27], 0
v_mfma_f32_16x16x32_bf16 v[64:67], a[4:7], v[24:27], 0
v_mfma_f32_16x16x32_bf16 v[52:55], a[8:11], v[28:31], v[52:55]
v_mfma_f32_16x16x32_bf16 v[56:59], a[12:15], v[28:31], v[56:59]
v_mfma_f32_16x16x32_bf16 v[60:63], a[8:11], v[32:35], v[60:63]
v_mfma_f32_16x16x32_bf16 v[64:67], a[12:15], v[32:35], v[64:67]
v_mfma_f32_16x16x32_bf16 v[52:55], a[16:19], v[36:39], v[52:55]
v_mfma_f32_16x16x32_bf16 v[56:59], a[20:23], v[36:39], v[56:59]
v_mfma_f32_16x16x32_bf16 v[60:63], a[16:19], v[40:43], v[60:63]
v_mfma_f32_16x16x32_bf16 v[64:67], a[20:23], v[40:43], v[64:67]
v_mfma_f32_16x16x32_bf16 v[52:55], a[24:27], v[44:47], v[52:55]
v_mfma_f32_16x16x32_bf16 v[56:59], a[28:31], v[44:47], v[56:59]
v_mfma_f32_16x16x32_bf16 v[60:63], a[24:27], v[48:51], v[60:63]
v_mfma_f32_16x16x32_bf16 v[64:67], a[28:31], v[48:51], v[64:67]
s_waitcnt vmcnt(18)
ds_read_b64_tr_b16 a[32:33], v17 offset:8192
ds_read_b64_tr_b16 a[34:35], v17 offset:8448
ds_read_b64_tr_b16 a[36:37], v17 offset:8200
ds_read_b64_tr_b16 a[38:39], v17 offset:8456
ds_read_b64_tr_b16 a[40:41], v17 offset:10240
ds_read_b64_tr_b16 a[42:43], v17 offset:10496
ds_read_b64_tr_b16 a[44:45], v17 offset:10248
ds_read_b64_tr_b16 a[46:47], v17 offset:10504
s_waitcnt lgkmcnt(0)
ds_read_b64_tr_b16 a[48:49], v17 offset:12288
ds_read_b64_tr_b16 a[50:51], v17 offset:12544
ds_read_b64_tr_b16 a[52:53], v17 offset:12296
ds_read_b64_tr_b16 a[54:55], v17 offset:12552
ds_read_b64_tr_b16 a[56:57], v17 offset:14336
ds_read_b64_tr_b16 a[58:59], v17 offset:14592
ds_read_b64_tr_b16 a[60:61], v17 offset:14344
ds_read_b64_tr_b16 a[62:63], v17 offset:14600
s_waitcnt lgkmcnt(0)
ds_read_b128 v[20:23], v8 offset:8192
ds_read_b128 v[24:27], v8 offset:10240
ds_read_b128 v[28:31], v9 offset:8192
ds_read_b128 v[32:35], v9 offset:10240
ds_read_b128 v[36:39], v8 offset:12288
ds_read_b128 v[40:43], v8 offset:14336
ds_read_b128 v[44:47], v9 offset:12288
ds_read_b128 v[48:51], v9 offset:14336
s_mov_b32 s44, 4194304
buffer_load_dword v250, v12, s[4:7], s44 offen
s_add_u32 m0, s45, 8192
s_mov_b32 s44, 4194304
buffer_load_dwordx4 v16, s[4:7], s44 offen lds
s_add_u32 m0, s45, 9216
s_mov_b32 s44, 4325376
buffer_load_dwordx4 v16, s[4:7], s44 offen lds
s_add_u32 m0, s45, 10240
s_mov_b32 s44, 4456448
buffer_load_dwordx4 v16, s[4:7], s44 offen lds
s_add_u32 m0, s45, 11264
s_mov_b32 s44, 4587520
buffer_load_dwordx4 v16, s[4:7], s44 offen lds
s_add_u32 m0, s45, 12288
s_mov_b32 s44, 4718592
buffer_load_dwordx4 v16, s[4:7], s44 offen lds
s_add_u32 m0, s45, 13312
s_mov_b32 s44, 4849664
buffer_load_dwordx4 v16, s[4:7], s44 offen lds
s_add_u32 m0, s45, 14336
s_mov_b32 s44, 4980736
buffer_load_dwordx4 v16, s[4:7], s44 offen lds
s_add_u32 m0, s45, 15360
s_mov_b32 s44, 5111808
buffer_load_dwordx4 v16, s[4:7], s44 offen lds
s_waitcnt lgkmcnt(0)
v_mfma_f32_16x16x32_bf16 v[52:55], a[32:35], v[20:23], v[52:55]
v_mfma_f32_16x16x32_bf16 v[56:59], a[36:39], v[20:23], v[56:59]
v_mfma_f32_16x16x32_bf16 v[60:63], a[32:35], v[24:27], v[60:63]
v_mfma_f32_16x16x32_bf16 v[64:67], a[36:39], v[24:27], v[64:67]
v_mfma_f32_16x16x32_bf16 v[52:55], a[40:43], v[28:31], v[52:55]
v_mfma_f32_16x16x32_bf16 v[56:59], a[44:47], v[28:31], v[56:59]
v_mfma_f32_16x16x32_bf16 v[60:63], a[40:43], v[32:35], v[60:63]
v_mfma_f32_16x16x32_bf16 v[64:67], a[44:47], v[32:35], v[64:67]
v_mfma_f32_16x16x32_bf16 v[52:55], a[48:51], v[36:39], v[52:55]
v_mfma_f32_16x16x32_bf16 v[56:59], a[52:55], v[36:39], v[56:59]
v_mfma_f32_16x16x32_bf16 v[60:63], a[48:51], v[40:43], v[60:63]
v_mfma_f32_16x16x32_bf16 v[64:67], a[52:55], v[40:43], v[64:67]
v_mfma_f32_16x16x32_bf16 v[52:55], a[56:59], v[44:47], v[52:55]
v_mfma_f32_16x16x32_bf16 v[56:59], a[60:63], v[44:47], v[56:59]
v_mfma_f32_16x16x32_bf16 v[60:63], a[56:59], v[48:51], v[60:63]
v_mfma_f32_16x16x32_bf16 v[64:67], a[60:63], v[48:51], v[64:67]
s_waitcnt vmcnt(18)
ds_read_b64_tr_b16 a[64:65], v17 offset:16384
ds_read_b64_tr_b16 a[66:67], v17 offset:16640
ds_read_b64_tr_b16 a[68:69], v17 offset:16392
ds_read_b64_tr_b16 a[70:71], v17 offset:16648
ds_read_b64_tr_b16 a[72:73], v17 offset:18432
ds_read_b64_tr_b16 a[74:75], v17 offset:18688
ds_read_b64_tr_b16 a[76:77], v17 offset:18440
ds_read_b64_tr_b16 a[78:79], v17 offset:18696
s_waitcnt lgkmcnt(0)
ds_read_b64_tr_b16 a[80:81], v17 offset:20480
ds_read_b64_tr_b16 a[82:83], v17 offset:20736
ds_read_b64_tr_b16 a[84:85], v17 offset:20488
ds_read_b64_tr_b16 a[86:87], v17 offset:20744
ds_read_b64_tr_b16 a[88:89], v17 offset:22528
ds_read_b64_tr_b16 a[90:91], v17 offset:22784
ds_read_b64_tr_b16 a[92:93], v17 offset:22536
ds_read_b64_tr_b16 a[94:95], v17 offset:22792
s_waitcnt lgkmcnt(0)
ds_read_b128 v[20:23], v8 offset:16384
ds_read_b128 v[24:27], v8 offset:18432
ds_read_b128 v[28:31], v9 offset:16384
ds_read_b128 v[32:35], v9 offset:18432
ds_read_b128 v[36:39], v8 offset:20480
ds_read_b128 v[40:43], v8 offset:22528
ds_read_b128 v[44:47], v9 offset:20480
ds_read_b128 v[48:51], v9 offset:22528
s_mov_b32 s44, 5242880
buffer_load_dword v250, v12, s[4:7], s44 offen
s_add_u32 m0, s45, 16384
s_mov_b32 s44, 5242880
buffer_load_dwordx4 v16, s[4:7], s44 offen lds
s_add_u32 m0, s45, 17408
s_mov_b32 s44, 5373952
buffer_load_dwordx4 v16, s[4:7], s44 offen lds
s_add_u32 m0, s45, 18432
s_mov_b32 s44, 5505024
buffer_load_dwordx4 v16, s[4:7], s44 offen lds
s_add_u32 m0, s45, 19456
s_mov_b32 s44, 5636096
buffer_load_dwordx4 v16, s[4:7], s44 offen lds
s_add_u32 m0, s45, 20480
s_mov_b32 s44, 5767168
buffer_load_dwordx4 v16, s[4:7], s44 offen lds
s_add_u32 m0, s45, 21504
s_mov_b32 s44, 5898240
buffer_load_dwordx4 v16, s[4:7], s44 offen lds
s_add_u32 m0, s45, 22528
s_mov_b32 s44, 6029312
buffer_load_dwordx4 v16, s[4:7], s44 offen lds
s_add_u32 m0, s45, 23552
s_mov_b32 s44, 6160384
buffer_load_dwordx4 v16, s[4:7], s44 offen lds
s_waitcnt lgkmcnt(0)
v_mfma_f32_16x16x32_bf16 v[52:55], a[64:67], v[20:23], v[52:55]
v_mfma_f32_16x16x32_bf16 v[56:59], a[68:71], v[20:23], v[56:59]
v_mfma_f32_16x16x32_bf16 v[60:63], a[64:67], v[24:27], v[60:63]
v_mfma_f32_16x16x32_bf16 v[64:67], a[68:71], v[24:27], v[64:67]
v_mfma_f32_16x16x32_bf16 v[52:55], a[72:75], v[28:31], v[52:55]
v_mfma_f32_16x16x32_bf16 v[56:59], a[76:79], v[28:31], v[56:59]
v_mfma_f32_16x16x32_bf16 v[60:63], a[72:75], v[32:35], v[60:63]
v_mfma_f32_16x16x32_bf16 v[64:67], a[76:79], v[32:35], v[64:67]
v_mfma_f32_16x16x32_bf16 v[52:55], a[80:83], v[36:39], v[52:55]
v_mfma_f32_16x16x32_bf16 v[56:59], a[84:87], v[36:39], v[56:59]
v_mfma_f32_16x16x32_bf16 v[60:63], a[80:83], v[40:43], v[60:63]
v_mfma_f32_16x16x32_bf16 v[64:67], a[84:87], v[40:43], v[64:67]
v_mfma_f32_16x16x32_bf16 v[52:55], a[88:91], v[44:47], v[52:55]
v_mfma_f32_16x16x32_bf16 v[56:59], a[92:95], v[44:47], v[56:59]
v_mfma_f32_16x16x32_bf16 v[60:63], a[88:91], v[48:51], v[60:63]
v_mfma_f32_16x16x32_bf16 v[64:67], a[92:95], v[48:51], v[64:67]
s_waitcnt vmcnt(18)
ds_read_b64_tr_b16 a[96:97], v17 offset:0
ds_read_b64_tr_b16 a[98:99], v17 offset:256
ds_read_b64_tr_b16 a[100:101], v17 offset:8
ds_read_b64_tr_b16 a[102:103], v17 offset:264
ds_read_b64_tr_b16 a[104:105], v17 offset:2048
ds_read_b64_tr_b16 a[106:107], v17 offset:2304
ds_read_b64_tr_b16 a[108:109], v17 offset:2056
ds_read_b64_tr_b16 a[110:111], v17 offset:2312
s_waitcnt lgkmcnt(0)
ds_read_b64_tr_b16 a[112:113], v17 offset:4096
ds_read_b64_tr_b16 a[114:115], v17 offset:4352
ds_read_b64_tr_b16 a[116:117], v17 offset:4104
ds_read_b64_tr_b16 a[118:119], v17 offset:4360
ds_read_b64_tr_b16 a[120:121], v17 offset:6144
ds_read_b64_tr_b16 a[122:123], v17 offset:6400
ds_read_b64_tr_b16 a[124:125], v17 offset:6152
ds_read_b64_tr_b16 a[126:127], v17 offset:6408
s_waitcnt lgkmcnt(0)
ds_read_b128 v[20:23], v8 offset:24576
ds_read_b128 v[24:27], v8 offset:26624
ds_read_b128 v[28:31], v9 offset:24576
ds_read_b128 v[32:35], v9 offset:26624
ds_read_b128 v[36:39], v8 offset:28672
ds_read_b128 v[40:43], v8 offset:30720
ds_read_b128 v[44:47], v9 offset:28672
ds_read_b128 v[48:51], v9 offset:30720
s_mov_b32 s44, 6291456
buffer_load_dword v250, v12, s[4:7], s44 offen
s_add_u32 m0, s45, 0
s_mov_b32 s44, 6291456
buffer_load_dwordx4 v16, s[4:7], s44 offen lds
s_add_u32 m0, s45, 1024
s_mov_b32 s44, 6422528
buffer_load_dwordx4 v16, s[4:7], s44 offen lds
s_add_u32 m0, s45, 2048
s_mov_b32 s44, 6553600
buffer_load_dwordx4 v16, s[4:7], s44 offen lds
s_add_u32 m0, s45, 3072
s_mov_b32 s44, 6684672
buffer_load_dwordx4 v16, s[4:7], s44 offen lds
s_add_u32 m0, s45, 4096
s_mov_b32 s44, 6815744
buffer_load_dwordx4 v16, s[4:7], s44 offen lds
s_add_u32 m0, s45, 5120
s_mov_b32 s44, 6946816
buffer_load_dwordx4 v16, s[4:7], s44 offen lds
s_add_u32 m0, s45, 6144
s_mov_b32 s44, 7077888
buffer_load_dwordx4 v16, s[4:7], s44 offen lds
s_add_u32 m0, s45, 7168
s_mov_b32 s44, 7208960
buffer_load_dwordx4 v16, s[4:7], s44 offen lds
s_waitcnt lgkmcnt(0)
v_mfma_f32_16x16x32_bf16 v[52:55], a[96:99], v[20:23], v[52:55]
v_mfma_f32_16x16x32_bf16 v[56:59], a[100:103], v[20:23], v[56:59]
v_mfma_f32_16x16x32_bf16 v[60:63], a[96:99], v[24:27], v[60:63]
v_mfma_f32_16x16x32_bf16 v[64:67], a[100:103], v[24:27], v[64:67]
v_mfma_f32_16x16x32_bf16 v[52:55], a[104:107], v[28:31], v[52:55]
v_mfma_f32_16x16x32_bf16 v[56:59], a[108:111], v[28:31], v[56:59]
v_mfma_f32_16x16x32_bf16 v[60:63], a[104:107], v[32:35], v[60:63]
v_mfma_f32_16x16x32_bf16 v[64:67], a[108:111], v[32:35], v[64:67]
v_mfma_f32_16x16x32_bf16 v[52:55], a[112:115], v[36:39], v[52:55]
v_mfma_f32_16x16x32_bf16 v[56:59], a[116:119], v[36:39], v[56:59]
v_mfma_f32_16x16x32_bf16 v[60:63], a[112:115], v[40:43], v[60:63]
v_mfma_f32_16x16x32_bf16 v[64:67], a[116:119], v[40:43], v[64:67]
v_mfma_f32_16x16x32_bf16 v[52:55], a[120:123], v[44:47], v[52:55]
v_mfma_f32_16x16x32_bf16 v[56:59], a[124:127], v[44:47], v[56:59]
v_mfma_f32_16x16x32_bf16 v[60:63], a[120:123], v[48:51], v[60:63]
v_mfma_f32_16x16x32_bf16 v[64:67], a[124:127], v[48:51], v[64:67]
s_waitcnt vmcnt(18)
ds_read_b64_tr_b16 a[128:129], v17 offset:8192
ds_read_b64_tr_b16 a[130:131], v17 offset:8448
ds_read_b64_tr_b16 a[132:133], v17 offset:8200
ds_read_b64_tr_b16 a[134:135], v17 offset:8456
ds_read_b64_tr_b16 a[136:137], v17 offset:10240
ds_read_b64_tr_b16 a[138:139], v17 offset:10496
ds_read_b64_tr_b16 a[140:141], v17 offset:10248
ds_read_b64_tr_b16 a[142:143], v17 offset:10504
s_waitcnt lgkmcnt(0)
ds_read_b64_tr_b16 a[144:145], v17 offset:12288
ds_read_b64_tr_b16 a[146:147], v17 offset:12544
ds_read_b64_tr_b16 a[148:149], v17 offset:12296
ds_read_b64_tr_b16 a[150:151], v17 offset:12552
ds_read_b64_tr_b16 a[152:153], v17 offset:14336
ds_read_b64_tr_b16 a[154:155], v17 offset:14592
ds_read_b64_tr_b16 a[156:157], v17 offset:14344
ds_read_b64_tr_b16 a[158:159], v17 offset:14600
s_waitcnt lgkmcnt(0)
ds_read_b128 v[20:23], v8 offset:32768
ds_read_b128 v[24:27], v8 offset:34816
ds_read_b128 v[28:31], v9 offset:32768
ds_read_b128 v[32:35], v9 offset:34816
ds_read_b128 v[36:39], v8 offset:36864
ds_read_b128 v[40:43], v8 offset:38912
ds_read_b128 v[44:47], v9 offset:36864
ds_read_b128 v[48:51], v9 offset:38912
s_mov_b32 s44, 7340032
buffer_load_dword v250, v12, s[4:7], s44 offen
s_add_u32 m0, s45, 8192
s_mov_b32 s44, 7340032
buffer_load_dwordx4 v16, s[4:7], s44 offen lds
s_add_u32 m0, s45, 9216
s_mov_b32 s44, 7471104
buffer_load_dwordx4 v16, s[4:7], s44 offen lds
s_add_u32 m0, s45, 10240
s_mov_b32 s44, 7602176
buffer_load_dwordx4 v16, s[4:7], s44 offen lds
s_add_u32 m0, s45, 11264
s_mov_b32 s44, 7733248
buffer_load_dwordx4 v16, s[4:7], s44 offen lds
s_add_u32 m0, s45, 12288
s_mov_b32 s44, 7864320
buffer_load_dwordx4 v16, s[4:7], s44 offen lds
s_add_u32 m0, s45, 13312
s_mov_b32 s44, 7995392
buffer_load_dwordx4 v16, s[4:7], s44 offen lds
s_add_u32 m0, s45, 14336
s_mov_b32 s44, 8126464
buffer_load_dwordx4 v16, s[4:7], s44 offen lds
s_add_u32 m0, s45, 15360
s_mov_b32 s44, 8257536
buffer_load_dwordx4 v16, s[4:7], s44 offen lds
s_waitcnt lgkmcnt(0)
v_mfma_f32_16x16x32_bf16 v[52:55], a[128:131], v[20:23], v[52:55]
v_mfma_f32_16x16x32_bf16 v[56:59], a[132:135], v[20:23], v[56:59]
v_mfma_f32_16x16x32_bf16 v[60:63], a[128:131], v[24:27], v[60:63]
v_mfma_f32_16x16x32_bf16 v[64:67], a[132:135], v[24:27], v[64:67]
v_mfma_f32_16x16x32_bf16 v[52:55], a[136:139], v[28:31], v[52:55]
v_mfma_f32_16x16x32_bf16 v[56:59], a[140:143], v[28:31], v[56:59]
v_mfma_f32_16x16x32_bf16 v[60:63], a[136:139], v[32:35], v[60:63]
v_mfma_f32_16x16x32_bf16 v[64:67], a[140:143], v[32:35], v[64:67]
v_mfma_f32_16x16x32_bf16 v[52:55], a[144:147], v[36:39], v[52:55]
v_mfma_f32_16x16x32_bf16 v[56:59], a[148:151], v[36:39], v[56:59]
v_mfma_f32_16x16x32_bf16 v[60:63], a[144:147], v[40:43], v[60:63]
v_mfma_f32_16x16x32_bf16 v[64:67], a[148:151], v[40:43], v[64:67]
v_mfma_f32_16x16x32_bf16 v[52:55], a[152:155], v[44:47], v[52:55]
v_mfma_f32_16x16x32_bf16 v[56:59], a[156:159], v[44:47], v[56:59]
v_mfma_f32_16x16x32_bf16 v[60:63], a[152:155], v[48:51], v[60:63]
v_mfma_f32_16x16x32_bf16 v[64:67], a[156:159], v[48:51], v[64:67]
s_waitcnt vmcnt(18)
ds_read_b64_tr_b16 a[160:161], v17 offset:16384
ds_read_b64_tr_b16 a[162:163], v17 offset:16640
ds_read_b64_tr_b16 a[164:165], v17 offset:16392
ds_read_b64_tr_b16 a[166:167], v17 offset:16648
ds_read_b64_tr_b16 a[168:169], v17 offset:18432
ds_read_b64_tr_b16 a[170:171], v17 offset:18688
ds_read_b64_tr_b16 a[172:173], v17 offset:18440
ds_read_b64_tr_b16 a[174:175], v17 offset:18696
s_waitcnt lgkmcnt(0)
ds_read_b64_tr_b16 a[176:177], v17 offset:20480
ds_read_b64_tr_b16 a[178:179], v17 offset:20736
ds_read_b64_tr_b16 a[180:181], v17 offset:20488
ds_read_b64_tr_b16 a[182:183], v17 offset:20744
ds_read_b64_tr_b16 a[184:185], v17 offset:22528
ds_read_b64_tr_b16 a[186:187], v17 offset:22784
ds_read_b64_tr_b16 a[188:189], v17 offset:22536
ds_read_b64_tr_b16 a[190:191], v17 offset:22792
s_waitcnt lgkmcnt(0)
ds_read_b128 v[20:23], v8 offset:40960
ds_read_b128 v[24:27], v8 offset:43008
ds_read_b128 v[28:31], v9 offset:40960
ds_read_b128 v[32:35], v9 offset:43008
ds_read_b128 v[36:39], v8 offset:45056
ds_read_b128 v[40:43], v8 offset:47104
ds_read_b128 v[44:47], v9 offset:45056
ds_read_b128 v[48:51], v9 offset:47104
s_waitcnt lgkmcnt(0)
v_mfma_f32_16x16x32_bf16 v[52:55], a[160:163], v[20:23], v[52:55]
v_mfma_f32_16x16x32_bf16 v[56:59], a[164:167], v[20:23], v[56:59]
v_mfma_f32_16x16x32_bf16 v[60:63], a[160:163], v[24:27], v[60:63]
v_mfma_f32_16x16x32_bf16 v[64:67], a[164:167], v[24:27], v[64:67]
v_mfma_f32_16x16x32_bf16 v[52:55], a[168:171], v[28:31], v[52:55]
v_mfma_f32_16x16x32_bf16 v[56:59], a[172:175], v[28:31], v[56:59]
v_mfma_f32_16x16x32_bf16 v[60:63], a[168:171], v[32:35], v[60:63]
v_mfma_f32_16x16x32_bf16 v[64:67], a[172:175], v[32:35], v[64:67]
v_mfma_f32_16x16x32_bf16 v[52:55], a[176:179], v[36:39], v[52:55]
v_mfma_f32_16x16x32_bf16 v[56:59], a[180:183], v[36:39], v[56:59]
v_mfma_f32_16x16x32_bf16 v[60:63], a[176:179], v[40:43], v[60:63]
v_mfma_f32_16x16x32_bf16 v[64:67], a[180:183], v[40:43], v[64:67]
v_mfma_f32_16x16x32_bf16 v[52:55], a[184:187], v[44:47], v[52:55]
v_mfma_f32_16x16x32_bf16 v[56:59], a[188:191], v[44:47], v[56:59]
v_mfma_f32_16x16x32_bf16 v[60:63], a[184:187], v[48:51], v[60:63]
v_mfma_f32_16x16x32_bf16 v[64:67], a[188:191], v[48:51], v[64:67]
s_waitcnt vmcnt(9)
ds_read_b64_tr_b16 a[192:193], v17 offset:0
ds_read_b64_tr_b16 a[194:195], v17 offset:256
ds_read_b64_tr_b16 a[196:197], v17 offset:8
ds_read_b64_tr_b16 a[198:199], v17 offset:264
ds_read_b64_tr_b16 a[200:201], v17 offset:2048
ds_read_b64_tr_b16 a[202:203], v17 offset:2304
ds_read_b64_tr_b16 a[204:205], v17 offset:2056
ds_read_b64_tr_b16 a[206:207], v17 offset:2312
s_waitcnt lgkmcnt(0)
ds_read_b64_tr_b16 a[208:209], v17 offset:4096
ds_read_b64_tr_b16 a[210:211], v17 offset:4352
ds_read_b64_tr_b16 a[212:213], v17 offset:4104
ds_read_b64_tr_b16 a[214:215], v17 offset:4360
ds_read_b64_tr_b16 a[216:217], v17 offset:6144
ds_read_b64_tr_b16 a[218:219], v17 offset:6400
ds_read_b64_tr_b16 a[220:221], v17 offset:6152
ds_read_b64_tr_b16 a[222:223], v17 offset:6408
s_waitcnt lgkmcnt(0)
ds_read_b128 v[20:23], v8 offset:49152
ds_read_b128 v[24:27], v8 offset:51200
ds_read_b128 v[28:31], v9 offset:49152
ds_read_b128 v[32:35], v9 offset:51200
ds_read_b128 v[36:39], v8 offset:53248
ds_read_b128 v[40:43], v8 offset:55296
ds_read_b128 v[44:47], v9 offset:53248
ds_read_b128 v[48:51], v9 offset:55296
s_waitcnt lgkmcnt(0)
v_mfma_f32_16x16x32_bf16 v[52:55], a[192:195], v[20:23], v[52:55]
v_mfma_f32_16x16x32_bf16 v[56:59], a[196:199], v[20:23], v[56:59]
v_mfma_f32_16x16x32_bf16 v[60:63], a[192:195], v[24:27], v[60:63]
v_mfma_f32_16x16x32_bf16 v[64:67], a[196:199], v[24:27], v[64:67]
v_mfma_f32_16x16x32_bf16 v[52:55], a[200:203], v[28:31], v[52:55]
v_mfma_f32_16x16x32_bf16 v[56:59], a[204:207], v[28:31], v[56:59]
v_mfma_f32_16x16x32_bf16 v[60:63], a[200:203], v[32:35], v[60:63]
v_mfma_f32_16x16x32_bf16 v[64:67], a[204:207], v[32:35], v[64:67]
v_mfma_f32_16x16x32_bf16 v[52:55], a[208:211], v[36:39], v[52:55]
v_mfma_f32_16x16x32_bf16 v[56:59], a[212:215], v[36:39], v[56:59]
v_mfma_f32_16x16x32_bf16 v[60:63], a[208:211], v[40:43], v[60:63]
v_mfma_f32_16x16x32_bf16 v[64:67], a[212:215], v[40:43], v[64:67]
v_mfma_f32_16x16x32_bf16 v[52:55], a[216:219], v[44:47], v[52:55]
v_mfma_f32_16x16x32_bf16 v[56:59], a[220:223], v[44:47], v[56:59]
v_mfma_f32_16x16x32_bf16 v[60:63], a[216:219], v[48:51], v[60:63]
v_mfma_f32_16x16x32_bf16 v[64:67], a[220:223], v[48:51], v[64:67]
s_waitcnt vmcnt(0)
ds_read_b64_tr_b16 a[224:225], v17 offset:8192
ds_read_b64_tr_b16 a[226:227], v17 offset:8448
ds_read_b64_tr_b16 a[228:229], v17 offset:8200
ds_read_b64_tr_b16 a[230:231], v17 offset:8456
ds_read_b64_tr_b16 a[232:233], v17 offset:10240
ds_read_b64_tr_b16 a[234:235], v17 offset:10496
ds_read_b64_tr_b16 a[236:237], v17 offset:10248
ds_read_b64_tr_b16 a[238:239], v17 offset:10504
s_waitcnt lgkmcnt(0)
ds_read_b64_tr_b16 a[240:241], v17 offset:12288
ds_read_b64_tr_b16 a[242:243], v17 offset:12544
ds_read_b64_tr_b16 a[244:245], v17 offset:12296
ds_read_b64_tr_b16 a[246:247], v17 offset:12552
ds_read_b64_tr_b16 a[248:249], v17 offset:14336
ds_read_b64_tr_b16 a[250:251], v17 offset:14592
ds_read_b64_tr_b16 a[252:253], v17 offset:14344
ds_read_b64_tr_b16 a[254:255], v17 offset:14600
s_waitcnt lgkmcnt(0)
ds_read_b128 v[20:23], v8 offset:57344
ds_read_b128 v[24:27], v8 offset:59392
ds_read_b128 v[28:31], v9 offset:57344
ds_read_b128 v[32:35], v9 offset:59392
ds_read_b128 v[36:39], v8 offset:61440
ds_read_b128 v[40:43], v8 offset:63488
ds_read_b128 v[44:47], v9 offset:61440
ds_read_b128 v[48:51], v9 offset:63488
s_waitcnt lgkmcnt(0)
v_mfma_f32_16x16x32_bf16 v[52:55], a[224:227], v[20:23], v[52:55]
v_mfma_f32_16x16x32_bf16 v[56:59], a[228:231], v[20:23], v[56:59]
v_mfma_f32_16x16x32_bf16 v[60:63], a[224:227], v[24:27], v[60:63]
v_mfma_f32_16x16x32_bf16 v[64:67], a[228:231], v[24:27], v[64:67]
v_mfma_f32_16x16x32_bf16 v[52:55], a[232:235], v[28:31], v[52:55]
v_mfma_f32_16x16x32_bf16 v[56:59], a[236:239], v[28:31], v[56:59]
v_mfma_f32_16x16x32_bf16 v[60:63], a[232:235], v[32:35], v[60:63]
v_mfma_f32_16x16x32_bf16 v[64:67], a[236:239], v[32:35], v[64:67]
v_mfma_f32_16x16x32_bf16 v[52:55], a[240:243], v[36:39], v[52:55]
v_mfma_f32_16x16x32_bf16 v[56:59], a[244:247], v[36:39], v[56:59]
v_mfma_f32_16x16x32_bf16 v[60:63], a[240:243], v[40:43], v[60:63]
v_mfma_f32_16x16x32_bf16 v[64:67], a[244:247], v[40:43], v[64:67]
v_mfma_f32_16x16x32_bf16 v[52:55], a[248:251], v[44:47], v[52:55]
v_mfma_f32_16x16x32_bf16 v[56:59], a[252:255], v[44:47], v[56:59]
v_mfma_f32_16x16x32_bf16 v[60:63], a[248:251], v[48:51], v[60:63]
v_mfma_f32_16x16x32_bf16 v[64:67], a[252:255], v[48:51], v[64:67]
s_barrier
s_mov_b32 s50, 0x10000
s_add_u32 m0, s46, 65536
s_nop 0
buffer_load_dwordx4 v6, s[8:11], s50 offen offset:0 lds
s_add_u32 m0, s46, 69504
s_nop 0
buffer_load_dwordx4 v6, s[8:11], s50 offen offset:128 lds
s_add_u32 m0, s46, 73472
s_nop 0
buffer_load_dwordx4 v6, s[8:11], s50 offen offset:256 lds
s_add_u32 m0, s46, 77440
s_nop 0
buffer_load_dwordx4 v6, s[8:11], s50 offen offset:384 lds
s_add_u32 m0, s46, 81408
s_nop 0
buffer_load_dwordx4 v6, s[8:11], s50 offen offset:512 lds
s_add_u32 m0, s46, 85376
s_nop 0
buffer_load_dwordx4 v6, s[8:11], s50 offen offset:640 lds
s_add_u32 m0, s46, 89344
s_nop 0
buffer_load_dwordx4 v6, s[8:11], s50 offen offset:768 lds
s_add_u32 m0, s46, 93312
s_nop 0
buffer_load_dwordx4 v6, s[8:11], s50 offen offset:896 lds
s_add_u32 m0, s46, 97280
s_nop 0
buffer_load_dwordx4 v6, s[8:11], s50 offen offset:1024 lds
s_add_u32 m0, s46, 101248
s_nop 0
buffer_load_dwordx4 v6, s[8:11], s50 offen offset:1152 lds
s_add_u32 m0, s46, 105216
s_nop 0
buffer_load_dwordx4 v6, s[8:11], s50 offen offset:1280 lds
s_add_u32 m0, s46, 109184
s_nop 0
buffer_load_dwordx4 v6, s[8:11], s50 offen offset:1408 lds
s_add_u32 m0, s46, 113152
s_nop 0
buffer_load_dwordx4 v6, s[8:11], s50 offen offset:1536 lds
s_add_u32 m0, s46, 117120
s_nop 0
buffer_load_dwordx4 v6, s[8:11], s50 offen offset:1664 lds
s_add_u32 m0, s46, 121088
s_nop 0
buffer_load_dwordx4 v6, s[8:11], s50 offen offset:1792 lds
s_add_u32 m0, s46, 125056
s_nop 0
buffer_load_dwordx4 v6, s[8:11], s50 offen offset:1920 lds
s_and_b32 s53, s47, 31
s_lshl_b32 s53, s53, 4
v_add_u32 v19, s53, v1
v_lshlrev_b32 v19, 7, v19
s_mov_b32 s42, 1
v_and_b32 v3, 15, v0
v_lshlrev_b32 v3, 4, v3
s_branch mega_kernel_syk
mega_kernel_sykw:
s_sleep 4
mega_kernel_syk:
buffer_load_dword v2, v3, s[72:75], 0 offen sc1
s_waitcnt vmcnt(0)
s_cmp_eq_u32 s95, 1
s_cbranch_scc0 mega_kernel_sykf
v_readlane_b32 s76, v2, 14
s_mov_b32 s98, 0
s_cmp_eq_u32 s76, 64
s_cbranch_scc0 mega_kernel_sykw
s_branch mega_kernel_sykd
mega_kernel_sykf:
s_mov_b32 s77, 0
s_mov_b32 s78, 0
v_readlane_b32 s76, v2, 0
s_add_u32 s77, s77, s76
s_xor_b32 s76, s76, 32
s_or_b32 s78, s78, s76
v_readlane_b32 s76, v2, 1
s_add_u32 s77, s77, s76
s_xor_b32 s76, s76, 32
s_or_b32 s78, s78, s76
v_readlane_b32 s76, v2, 2
s_add_u32 s77, s77, s76
s_xor_b32 s76, s76, 32
s_or_b32 s78, s78, s76
v_readlane_b32 s76, v2, 3
s_add_u32 s77, s77, s76
s_xor_b32 s76, s76, 32
s_or_b32 s78, s78, s76
v_readlane_b32 s76, v2, 4
s_add_u32 s77, s77, s76
s_xor_b32 s76, s76, 32
s_or_b32 s78, s78, s76
v_readlane_b32 s76, v2, 5
s_add_u32 s77, s77, s76
s_xor_b32 s76, s76, 32
s_or_b32 s78, s78, s76
v_readlane_b32 s76, v2, 6
s_add_u32 s77, s77, s76
s_xor_b32 s76, s76, 32
s_or_b32 s78, s78, s76
v_readlane_b32 s76, v2, 7
s_add_u32 s77, s77, s76
s_xor_b32 s76, s76, 32
s_or_b32 s78, s78, s76
s_cmp_eq_u32 s77, 256
s_cbranch_scc0 mega_kernel_sykw
v_mov_b32 v252, v2
s_cmp_eq_u32 s78, 0
s_cbranch_scc0 mega_kernel_slowent
v_readlane_b32 s76, v2, 10
v_readlane_b32 s77, v2, 8
s_cmp_eq_u32 s76, 64
s_cbranch_scc0 mega_kernel_sykw
s_cmp_gt_u32 s77, 32
s_cselect_b32 s98, 1, 0
mega_kernel_sykd:
s_lshr_b32 s44, s47, 3
s_xor_b32 s44, s44, s98
s_and_b32 s44, s44, 1
s_lshl_b32 s44, s44, 13
s_lshl_b32 s48, s47, 18
s_add_u32 s48, s48, s44
s_add_u32 s48, s48, 0
s_xor_b32 s44, s98, 1
s_lshl_b32 s44, s44, 13
s_lshl_b32 s49, s40, 7
s_add_u32 s49, s49, s44
s_lshl_b32 s44, s41, 2
s_add_u32 s49, s49, s44
s_add_u32 s49, s49, 69206016
v_mov_b32 v16, 0
v_cvt_pk_bf16_f32 v84, v52, v53
v_cvt_pk_bf16_f32 v85, v54, v55
v_cvt_pk_bf16_f32 v86, v56, v57
v_cvt_pk_bf16_f32 v87, v58, v59
v_cvt_pk_bf16_f32 v88, v60, v61
v_cvt_pk_bf16_f32 v89, v62, v63
v_cvt_pk_bf16_f32 v90, v64, v65
v_cvt_pk_bf16_f32 v91, v66, v67
s_add_u32 s51, s42, s47
s_sub_u32 s51, s51, 1
s_bfe_u32 s52, s51, 0x40002
s_lshl_b32 s52, s52, 14
s_and_b32 s51, s51, 3
s_lshl_b32 s51, s51, 11
s_add_u32 s51, s51, s52
s_add_u32 s51, s51, s48
buffer_store_dwordx4 v[84:87], v7, s[84:87], s51 offen sc1
buffer_store_dwordx4 v[88:91], v7, s[84:87], s51 offen offset:1024 sc1
s_waitcnt vmcnt(0)
v_mov_b32 v17, s42
s_mov_b64 exec, 1
buffer_store_dword v17, v16, s[84:87], s49 offen sc1
s_mov_b64 exec, -1
mega_kernel_k_loop:
s_waitcnt vmcnt(2)
s_barrier
s_add_u32 s50, s42, 1
s_min_u32 s50, s50, 63
s_lshl_b32 s50, s50, 16
ds_read_b128 v[20:23], v10 offset:0
ds_read_b128 v[24:27], v10 offset:2048
ds_read_b128 v[28:31], v11 offset:0
ds_read_b128 v[32:35], v11 offset:2048
ds_read_b128 v[36:39], v10 offset:4096
ds_read_b128 v[40:43], v10 offset:6144
s_waitcnt lgkmcnt(4)
v_mfma_f32_16x16x32_bf16 v[68:71], a[0:3], v[20:23], 0
ds_read_b128 v[44:47], v11 offset:4096
v_mfma_f32_16x16x32_bf16 v[72:75], a[4:7], v[20:23], 0
v_cvt_pk_bf16_f32 v84, v52, v53
v_cvt_pk_bf16_f32 v85, v54, v55
v_cvt_pk_bf16_f32 v86, v56, v57
v_mfma_f32_16x16x32_bf16 v[76:79], a[0:3], v[24:27], 0
ds_read_b128 v[48:51], v11 offset:6144
v_mfma_f32_16x16x32_bf16 v[80:83], a[4:7], v[24:27], 0
v_cvt_pk_bf16_f32 v87, v58, v59
v_cvt_pk_bf16_f32 v88, v60, v61
v_cvt_pk_bf16_f32 v89, v62, v63
s_waitcnt lgkmcnt(4)
v_mfma_f32_16x16x32_bf16 v[68:71], a[8:11], v[28:31], v[68:71]
ds_read_b128 v[20:23], v10 offset:8192
v_mfma_f32_16x16x32_bf16 v[72:75], a[12:15], v[28:31], v[72:75]
v_cvt_pk_bf16_f32 v90, v64, v65
v_cvt_pk_bf16_f32 v91, v66, v67
v_mfma_f32_16x16x32_bf16 v[76:79], a[8:11], v[32:35], v[76:79]
ds_read_b128 v[24:27], v10 offset:10240
v_mfma_f32_16x16x32_bf16 v[80:83], a[12:15], v[32:35], v[80:83]
s_add_u32 s51, s42, s47
s_sub_u32 s51, s51, 1
s_bfe_u32 s52, s51, 0x40002
s_lshl_b32 s52, s52, 14
s_waitcnt lgkmcnt(4)
v_mfma_f32_16x16x32_bf16 v[68:71], a[16:19], v[36:39], v[68:71]
ds_read_b128 v[28:31], v11 offset:8192
v_mfma_f32_16x16x32_bf16 v[72:75], a[20:23], v[36:39], v[72:75]
s_and_b32 s51, s51, 3
s_lshl_b32 s51, s51, 11
s_add_u32 s51, s51, s52
s_add_u32 s51, s51, s48
buffer_store_dwordx4 v[84:87], v7, s[84:87], s51 offen sc1
v_mfma_f32_16x16x32_bf16 v[76:79], a[16:19], v[40:43], v[76:79]
ds_read_b128 v[32:35], v11 offset:10240
v_mfma_f32_16x16x32_bf16 v[80:83], a[20:23], v[40:43], v[80:83]
buffer_store_dwordx4 v[88:91], v7, s[84:87], s51 offen offset:1024 sc1
s_waitcnt lgkmcnt(4)
v_mfma_f32_16x16x32_bf16 v[68:71], a[24:27], v[44:47], v[68:71]
ds_read_b128 v[36:39], v10 offset:12288
v_mfma_f32_16x16x32_bf16 v[72:75], a[28:31], v[44:47], v[72:75]
s_add_u32 m0, s46, 0
v_mfma_f32_16x16x32_bf16 v[76:79], a[24:27], v[48:51], v[76:79]
ds_read_b128 v[40:43], v10 offset:14336
v_mfma_f32_16x16x32_bf16 v[80:83], a[28:31], v[48:51], v[80:83]
buffer_load_dwordx4 v6, s[8:11], s50 offen offset:0 lds
s_waitcnt lgkmcnt(4)
v_mfma_f32_16x16x32_bf16 v[68:71], a[32:35], v[20:23], v[68:71]
ds_read_b128 v[44:47], v11 offset:12288
v_mfma_f32_16x16x32_bf16 v[72:75], a[36:39], v[20:23], v[72:75]
s_add_u32 m0, s46, 3968
v_mfma_f32_16x16x32_bf16 v[76:79], a[32:35], v[24:27], v[76:79]
ds_read_b128 v[48:51], v11 offset:14336
v_mfma_f32_16x16x32_bf16 v[80:83], a[36:39], v[24:27], v[80:83]
buffer_load_dwordx4 v6, s[8:11], s50 offen offset:128 lds
s_waitcnt lgkmcnt(4)
v_mfma_f32_16x16x32_bf16 v[68:71], a[40:43], v[28:31], v[68:71]
ds_read_b128 v[20:23], v10 offset:16384
v_mfma_f32_16x16x32_bf16 v[72:75], a[44:47], v[28:31], v[72:75]
s_add_u32 m0, s46, 7936
v_mfma_f32_16x16x32_bf16 v[76:79], a[40:43], v[32:35], v[76:79]
ds_read_b128 v[24:27], v10 offset:18432
v_mfma_f32_16x16x32_bf16 v[80:83], a[44:47], v[32:35], v[80:83]
buffer_load_dwordx4 v6, s[8:11], s50 offen offset:256 lds
s_waitcnt lgkmcnt(4)
v_mfma_f32_16x16x32_bf16 v[68:71], a[48:51], v[36:39], v[68:71]
ds_read_b128 v[28:31], v11 offset:16384
v_mfma_f32_16x16x32_bf16 v[72:75], a[52:55], v[36:39], v[72:75]
s_add_u32 m0, s46, 11904
v_mfma_f32_16x16x32_bf16 v[76:79], a[48:51], v[40:43], v[76:79]
ds_read_b128 v[32:35], v11 offset:18432
v_mfma_f32_16x16x32_bf16 v[80:83], a[52:55], v[40:43], v[80:83]
buffer_load_dwordx4 v6, s[8:11], s50 offen offset:384 lds
s_waitcnt lgkmcnt(4)
v_mfma_f32_16x16x32_bf16 v[68:71], a[56:59], v[44:47], v[68:71]
ds_read_b128 v[36:39], v10 offset:20480
v_mfma_f32_16x16x32_bf16 v[72:75], a[60:63], v[44:47], v[72:75]
s_add_u32 m0, s46, 15872
v_mfma_f32_16x16x32_bf16 v[76:79], a[56:59], v[48:51], v[76:79]
ds_read_b128 v[40:43], v10 offset:22528
v_mfma_f32_16x16x32_bf16 v[80:83], a[60:63], v[48:51], v[80:83]
buffer_load_dwordx4 v6, s[8:11], s50 offen offset:512 lds
s_waitcnt lgkmcnt(4)
v_mfma_f32_16x16x32_bf16 v[68:71], a[64:67], v[20:23], v[68:71]
ds_read_b128 v[44:47], v11 offset:20480
v_mfma_f32_16x16x32_bf16 v[72:75], a[68:71], v[20:23], v[72:75]
s_add_u32 m0, s46, 19840
v_mfma_f32_16x16x32_bf16 v[76:79], a[64:67], v[24:27], v[76:79]
ds_read_b128 v[48:51], v11 offset:22528
v_mfma_f32_16x16x32_bf16 v[80:83], a[68:71], v[24:27], v[80:83]
buffer_load_dwordx4 v6, s[8:11], s50 offen offset:640 lds
s_waitcnt lgkmcnt(4)
v_mfma_f32_16x16x32_bf16 v[68:71], a[72:75], v[28:31], v[68:71]
ds_read_b128 v[20:23], v10 offset:24576
v_mfma_f32_16x16x32_bf16 v[72:75], a[76:79], v[28:31], v[72:75]
s_add_u32 m0, s46, 23808
v_mfma_f32_16x16x32_bf16 v[76:79], a[72:75], v[32:35], v[76:79]
ds_read_b128 v[24:27], v10 offset:26624
v_mfma_f32_16x16x32_bf16 v[80:83], a[76:79], v[32:35], v[80:83]
buffer_load_dwordx4 v6, s[8:11], s50 offen offset:768 lds
s_waitcnt lgkmcnt(4)
v_mfma_f32_16x16x32_bf16 v[68:71], a[80:83], v[36:39], v[68:71]
ds_read_b128 v[28:31], v11 offset:24576
v_mfma_f32_16x16x32_bf16 v[72:75], a[84:87], v[36:39], v[72:75]
s_add_u32 m0, s46, 27776
v_mfma_f32_16x16x32_bf16 v[76:79], a[80:83], v[40:43], v[76:79]
ds_read_b128 v[32:35], v11 offset:26624
v_mfma_f32_16x16x32_bf16 v[80:83], a[84:87], v[40:43], v[80:83]
buffer_load_dwordx4 v6, s[8:11], s50 offen offset:896 lds
s_waitcnt lgkmcnt(4)
v_mfma_f32_16x16x32_bf16 v[68:71], a[88:91], v[44:47], v[68:71]
ds_read_b128 v[36:39], v10 offset:28672
v_mfma_f32_16x16x32_bf16 v[72:75], a[92:95], v[44:47], v[72:75]
s_add_u32 m0, s46, 31744
v_mfma_f32_16x16x32_bf16 v[76:79], a[88:91], v[48:51], v[76:79]
ds_read_b128 v[40:43], v10 offset:30720
v_mfma_f32_16x16x32_bf16 v[80:83], a[92:95], v[48:51], v[80:83]
buffer_load_dwordx4 v6, s[8:11], s50 offen offset:1024 lds
s_waitcnt lgkmcnt(4)
v_mfma_f32_16x16x32_bf16 v[68:71], a[96:99], v[20:23], v[68:71]
ds_read_b128 v[44:47], v11 offset:28672
v_mfma_f32_16x16x32_bf16 v[72:75], a[100:103], v[20:23], v[72:75]
s_add_u32 m0, s46, 35712
v_mfma_f32_16x16x32_bf16 v[76:79], a[96:99], v[24:27], v[76:79]
ds_read_b128 v[48:51], v11 offset:30720
v_mfma_f32_16x16x32_bf16 v[80:83], a[100:103], v[24:27], v[80:83]
buffer_load_dwordx4 v6, s[8:11], s50 offen offset:1152 lds
s_waitcnt lgkmcnt(4)
v_mfma_f32_16x16x32_bf16 v[68:71], a[104:107], v[28:31], v[68:71]
ds_read_b128 v[20:23], v10 offset:32768
v_mfma_f32_16x16x32_bf16 v[72:75], a[108:111], v[28:31], v[72:75]
s_add_u32 m0, s46, 39680
v_mfma_f32_16x16x32_bf16 v[76:79], a[104:107], v[32:35], v[76:79]
ds_read_b128 v[24:27], v10 offset:34816
v_mfma_f32_16x16x32_bf16 v[80:83], a[108:111], v[32:35], v[80:83]
buffer_load_dwordx4 v6, s[8:11], s50 offen offset:1280 lds
s_waitcnt lgkmcnt(4)
v_mfma_f32_16x16x32_bf16 v[68:71], a[112:115], v[36:39], v[68:71]
ds_read_b128 v[28:31], v11 offset:32768
v_mfma_f32_16x16x32_bf16 v[72:75], a[116:119], v[36:39], v[72:75]
s_add_u32 m0, s46, 43648
v_mfma_f32_16x16x32_bf16 v[76:79], a[112:115], v[40:43], v[76:79]
ds_read_b128 v[32:35], v11 offset:34816
v_mfma_f32_16x16x32_bf16 v[80:83], a[116:119], v[40:43], v[80:83]
buffer_load_dwordx4 v6, s[8:11], s50 offen offset:1408 lds
s_waitcnt lgkmcnt(4)
v_mfma_f32_16x16x32_bf16 v[68:71], a[120:123], v[44:47], v[68:71]
ds_read_b128 v[36:39], v10 offset:36864
v_mfma_f32_16x16x32_bf16 v[72:75], a[124:127], v[44:47], v[72:75]
s_add_u32 m0, s46, 47616
v_mfma_f32_16x16x32_bf16 v[76:79], a[120:123], v[48:51], v[76:79]
ds_read_b128 v[40:43], v10 offset:38912
v_mfma_f32_16x16x32_bf16 v[80:83], a[124:127], v[48:51], v[80:83]
buffer_load_dwordx4 v6, s[8:11], s50 offen offset:1536 lds
s_waitcnt lgkmcnt(4)
v_mfma_f32_16x16x32_bf16 v[68:71], a[128:131], v[20:23], v[68:71]
ds_read_b128 v[44:47], v11 offset:36864
v_mfma_f32_16x16x32_bf16 v[72:75], a[132:135], v[20:23], v[72:75]
s_add_u32 m0, s46, 51584
v_mfma_f32_16x16x32_bf16 v[76:79], a[128:131], v[24:27], v[76:79]
ds_read_b128 v[48:51], v11 offset:38912
v_mfma_f32_16x16x32_bf16 v[80:83], a[132:135], v[24:27], v[80:83]
buffer_load_dwordx4 v6, s[8:11], s50 offen offset:1664 lds
s_waitcnt lgkmcnt(4)
v_mfma_f32_16x16x32_bf16 v[68:71], a[136:139], v[28:31], v[68:71]
ds_read_b128 v[20:23], v10 offset:40960
v_mfma_f32_16x16x32_bf16 v[72:75], a[140:143], v[28:31], v[72:75]
s_add_u32 m0, s46, 55552
v_mfma_f32_16x16x32_bf16 v[76:79], a[136:139], v[32:35], v[76:79]
ds_read_b128 v[24:27], v10 offset:43008
v_mfma_f32_16x16x32_bf16 v[80:83], a[140:143], v[32:35], v[80:83]
buffer_load_dwordx4 v6, s[8:11], s50 offen offset:1792 lds
s_waitcnt lgkmcnt(4)
v_mfma_f32_16x16x32_bf16 v[68:71], a[144:147], v[36:39], v[68:71]
ds_read_b128 v[28:31], v11 offset:40960
v_mfma_f32_16x16x32_bf16 v[72:75], a[148:151], v[36:39], v[72:75]
s_add_u32 m0, s46, 59520
v_mfma_f32_16x16x32_bf16 v[76:79], a[144:147], v[40:43], v[76:79]
ds_read_b128 v[32:35], v11 offset:43008
v_mfma_f32_16x16x32_bf16 v[80:83], a[148:151], v[40:43], v[80:83]
buffer_load_dwordx4 v6, s[8:11], s50 offen offset:1920 lds
s_waitcnt lgkmcnt(4)
v_mfma_f32_16x16x32_bf16 v[68:71], a[152:155], v[44:47], v[68:71]
ds_read_b128 v[36:39], v10 offset:45056
v_mfma_f32_16x16x32_bf16 v[72:75], a[156:159], v[44:47], v[72:75]
v_mfma_f32_16x16x32_bf16 v[76:79], a[152:155], v[48:51], v[76:79]
ds_read_b128 v[40:43], v10 offset:47104
v_mfma_f32_16x16x32_bf16 v[80:83], a[156:159], v[48:51], v[80:83]
s_waitcnt lgkmcnt(4)
v_mfma_f32_16x16x32_bf16 v[68:71], a[160:163], v[20:23], v[68:71]
ds_read_b128 v[44:47], v11 offset:45056
v_mfma_f32_16x16x32_bf16 v[72:75], a[164:167], v[20:23], v[72:75]
v_mfma_f32_16x16x32_bf16 v[76:79], a[160:163], v[24:27], v[76:79]
ds_read_b128 v[48:51], v11 offset:47104
v_mfma_f32_16x16x32_bf16 v[80:83], a[164:167], v[24:27], v[80:83]
s_waitcnt lgkmcnt(4)
v_mfma_f32_16x16x32_bf16 v[68:71], a[168:171], v[28:31], v[68:71]
ds_read_b128 v[20:23], v10 offset:49152
v_mfma_f32_16x16x32_bf16 v[72:75], a[172:175], v[28:31], v[72:75]
s_waitcnt vmcnt(16)
v_mov_b32 v17, s42
s_mov_b64 exec, 1
buffer_store_dword v17, v16, s[84:87], s49 offen sc1
s_mov_b64 exec, -1
v_mfma_f32_16x16x32_bf16 v[76:79], a[168:171], v[32:35], v[76:79]
ds_read_b128 v[24:27], v10 offset:51200
v_mfma_f32_16x16x32_bf16 v[80:83], a[172:175], v[32:35], v[80:83]
s_waitcnt lgkmcnt(4)
v_mfma_f32_16x16x32_bf16 v[68:71], a[176:179], v[36:39], v[68:71]
ds_read_b128 v[28:31], v11 offset:49152
v_mfma_f32_16x16x32_bf16 v[72:75], a[180:183], v[36:39], v[72:75]
s_add_u32 s53, s42, 3
s_min_u32 s53, s53, 63
s_lshl_b32 s53, s53, 16
s_mov_b64 exec, 0xffff
buffer_load_dword v250, v19, s[8:11], s53 offen
s_mov_b64 exec, -1
v_mfma_f32_16x16x32_bf16 v[76:79], a[176:179], v[40:43], v[76:79]
ds_read_b128 v[32:35], v11 offset:51200
v_mfma_f32_16x16x32_bf16 v[80:83], a[180:183], v[40:43], v[80:83]
s_waitcnt lgkmcnt(4)
v_mfma_f32_16x16x32_bf16 v[68:71], a[184:187], v[44:47], v[68:71]
ds_read_b128 v[36:39], v10 offset:53248
v_mfma_f32_16x16x32_bf16 v[72:75], a[188:191], v[44:47], v[72:75]
v_mfma_f32_16x16x32_bf16 v[76:79], a[184:187], v[48:51], v[76:79]
ds_read_b128 v[40:43], v10 offset:55296
v_mfma_f32_16x16x32_bf16 v[80:83], a[188:191], v[48:51], v[80:83]
s_waitcnt lgkmcnt(4)
v_mfma_f32_16x16x32_bf16 v[68:71], a[192:195], v[20:23], v[68:71]
ds_read_b128 v[44:47], v11 offset:53248
v_mfma_f32_16x16x32_bf16 v[72:75], a[196:199], v[20:23], v[72:75]
v_mfma_f32_16x16x32_bf16 v[76:79], a[192:195], v[24:27], v[76:79]
ds_read_b128 v[48:51], v11 offset:55296
v_mfma_f32_16x16x32_bf16 v[80:83], a[196:199], v[24:27], v[80:83]
s_waitcnt lgkmcnt(4)
v_mfma_f32_16x16x32_bf16 v[68:71], a[200:203], v[28:31], v[68:71]
ds_read_b128 v[20:23], v10 offset:57344
v_mfma_f32_16x16x32_bf16 v[72:75], a[204:207], v[28:31], v[72:75]
v_mfma_f32_16x16x32_bf16 v[76:79], a[200:203], v[32:35], v[76:79]
ds_read_b128 v[24:27], v10 offset:59392
v_mfma_f32_16x16x32_bf16 v[80:83], a[204:207], v[32:35], v[80:83]
s_waitcnt lgkmcnt(4)
v_mfma_f32_16x16x32_bf16 v[68:71], a[208:211], v[36:39], v[68:71]
ds_read_b128 v[28:31], v11 offset:57344
v_mfma_f32_16x16x32_bf16 v[72:75], a[212:215], v[36:39], v[72:75]
v_mfma_f32_16x16x32_bf16 v[76:79], a[208:211], v[40:43], v[76:79]
ds_read_b128 v[32:35], v11 offset:59392
v_mfma_f32_16x16x32_bf16 v[80:83], a[212:215], v[40:43], v[80:83]
s_waitcnt lgkmcnt(4)
v_mfma_f32_16x16x32_bf16 v[68:71], a[216:219], v[44:47], v[68:71]
ds_read_b128 v[36:39], v10 offset:61440
v_mfma_f32_16x16x32_bf16 v[72:75], a[220:223], v[44:47], v[72:75]
v_mfma_f32_16x16x32_bf16 v[76:79], a[216:219], v[48:51], v[76:79]
ds_read_b128 v[40:43], v10 offset:63488
v_mfma_f32_16x16x32_bf16 v[80:83], a[220:223], v[48:51], v[80:83]
s_waitcnt lgkmcnt(4)
v_mfma_f32_16x16x32_bf16 v[68:71], a[224:227], v[20:23], v[68:71]
ds_read_b128 v[44:47], v11 offset:61440
v_mfma_f32_16x16x32_bf16 v[72:75], a[228:231], v[20:23], v[72:75]
v_mfma_f32_16x16x32_bf16 v[76:79], a[224:227], v[24:27], v[76:79]
ds_read_b128 v[48:51], v11 offset:63488
v_mfma_f32_16x16x32_bf16 v[80:83], a[228:231], v[24:27], v[80:83]
s_waitcnt lgkmcnt(5)
v_mfma_f32_16x16x32_bf16 v[68:71], a[232:235], v[28:31], v[68:71]
v_mfma_f32_16x16x32_bf16 v[72:75], a[236:239], v[28:31], v[72:75]
s_waitcnt lgkmcnt(4)
v_mfma_f32_16x16x32_bf16 v[76:79], a[232:235], v[32:35], v[76:79]
v_mfma_f32_16x16x32_bf16 v[80:83], a[236:239], v[32:35], v[80:83]
s_waitcnt lgkmcnt(3)
v_mfma_f32_16x16x32_bf16 v[68:71], a[240:243], v[36:39], v[68:71]
v_mfma_f32_16x16x32_bf16 v[72:75], a[244:247], v[36:39], v[72:75]
s_waitcnt lgkmcnt(2)
v_mfma_f32_16x16x32_bf16 v[76:79], a[240:243], v[40:43], v[76:79]
v_mfma_f32_16x16x32_bf16 v[80:83], a[244:247], v[40:43], v[80:83]
s_waitcnt lgkmcnt(1)
v_mfma_f32_16x16x32_bf16 v[68:71], a[248:251], v[44:47], v[68:71]
v_mfma_f32_16x16x32_bf16 v[72:75], a[252:255], v[44:47], v[72:75]
s_waitcnt lgkmcnt(0)
v_mfma_f32_16x16x32_bf16 v[76:79], a[248:251], v[48:51], v[76:79]
v_mfma_f32_16x16x32_bf16 v[80:83], a[252:255], v[48:51], v[80:83]
s_add_u32 s42, s42, 1
s_cmp_eq_u32 s42, 64
s_cbranch_scc1 mega_kernel_k_fin
s_waitcnt vmcnt(2)
s_barrier
s_add_u32 s50, s42, 1
s_min_u32 s50, s50, 63
s_lshl_b32 s50, s50, 16
ds_read_b128 v[20:23], v8 offset:0
ds_read_b128 v[24:27], v8 offset:2048
ds_read_b128 v[28:31], v9 offset:0
ds_read_b128 v[32:35], v9 offset:2048
ds_read_b128 v[36:39], v8 offset:4096
ds_read_b128 v[40:43], v8 offset:6144
s_waitcnt lgkmcnt(4)
v_mfma_f32_16x16x32_bf16 v[52:55], a[0:3], v[20:23], 0
ds_read_b128 v[44:47], v9 offset:4096
v_mfma_f32_16x16x32_bf16 v[56:59], a[4:7], v[20:23], 0
v_cvt_pk_bf16_f32 v84, v68, v69
v_cvt_pk_bf16_f32 v85, v70, v71
v_cvt_pk_bf16_f32 v86, v72, v73
v_mfma_f32_16x16x32_bf16 v[60:63], a[0:3], v[24:27], 0
ds_read_b128 v[48:51], v9 offset:6144
v_mfma_f32_16x16x32_bf16 v[64:67], a[4:7], v[24:27], 0
v_cvt_pk_bf16_f32 v87, v74, v75
v_cvt_pk_bf16_f32 v88, v76, v77
v_cvt_pk_bf16_f32 v89, v78, v79
s_waitcnt lgkmcnt(4)
v_mfma_f32_16x16x32_bf16 v[52:55], a[8:11], v[28:31], v[52:55]
ds_read_b128 v[20:23], v8 offset:8192
v_mfma_f32_16x16x32_bf16 v[56:59], a[12:15], v[28:31], v[56:59]
v_cvt_pk_bf16_f32 v90, v80, v81
v_cvt_pk_bf16_f32 v91, v82, v83
v_mfma_f32_16x16x32_bf16 v[60:63], a[8:11], v[32:35], v[60:63]
ds_read_b128 v[24:27], v8 offset:10240
v_mfma_f32_16x16x32_bf16 v[64:67], a[12:15], v[32:35], v[64:67]
s_add_u32 s51, s42, s47
s_sub_u32 s51, s51, 1
s_bfe_u32 s52, s51, 0x40002
s_lshl_b32 s52, s52, 14
s_waitcnt lgkmcnt(4)
v_mfma_f32_16x16x32_bf16 v[52:55], a[16:19], v[36:39], v[52:55]
ds_read_b128 v[28:31], v9 offset:8192
v_mfma_f32_16x16x32_bf16 v[56:59], a[20:23], v[36:39], v[56:59]
s_and_b32 s51, s51, 3
s_lshl_b32 s51, s51, 11
s_add_u32 s51, s51, s52
s_add_u32 s51, s51, s48
buffer_store_dwordx4 v[84:87], v7, s[84:87], s51 offen sc1
v_mfma_f32_16x16x32_bf16 v[60:63], a[16:19], v[40:43], v[60:63]
ds_read_b128 v[32:35], v9 offset:10240
v_mfma_f32_16x16x32_bf16 v[64:67], a[20:23], v[40:43], v[64:67]
buffer_store_dwordx4 v[88:91], v7, s[84:87], s51 offen offset:1024 sc1
s_waitcnt lgkmcnt(4)
v_mfma_f32_16x16x32_bf16 v[52:55], a[24:27], v[44:47], v[52:55]
ds_read_b128 v[36:39], v8 offset:12288
v_mfma_f32_16x16x32_bf16 v[56:59], a[28:31], v[44:47], v[56:59]
s_add_u32 m0, s46, 65536
v_mfma_f32_16x16x32_bf16 v[60:63], a[24:27], v[48:51], v[60:63]
ds_read_b128 v[40:43], v8 offset:14336
v_mfma_f32_16x16x32_bf16 v[64:67], a[28:31], v[48:51], v[64:67]
buffer_load_dwordx4 v6, s[8:11], s50 offen offset:0 lds
s_waitcnt lgkmcnt(4)
v_mfma_f32_16x16x32_bf16 v[52:55], a[32:35], v[20:23], v[52:55]
ds_read_b128 v[44:47], v9 offset:12288
v_mfma_f32_16x16x32_bf16 v[56:59], a[36:39], v[20:23], v[56:59]
s_add_u32 m0, s46, 69504
v_mfma_f32_16x16x32_bf16 v[60:63], a[32:35], v[24:27], v[60:63]
ds_read_b128 v[48:51], v9 offset:14336
v_mfma_f32_16x16x32_bf16 v[64:67], a[36:39], v[24:27], v[64:67]
buffer_load_dwordx4 v6, s[8:11], s50 offen offset:128 lds
s_waitcnt lgkmcnt(4)
v_mfma_f32_16x16x32_bf16 v[52:55], a[40:43], v[28:31], v[52:55]
ds_read_b128 v[20:23], v8 offset:16384
v_mfma_f32_16x16x32_bf16 v[56:59], a[44:47], v[28:31], v[56:59]
s_add_u32 m0, s46, 73472
v_mfma_f32_16x16x32_bf16 v[60:63], a[40:43], v[32:35], v[60:63]
ds_read_b128 v[24:27], v8 offset:18432
v_mfma_f32_16x16x32_bf16 v[64:67], a[44:47], v[32:35], v[64:67]
buffer_load_dwordx4 v6, s[8:11], s50 offen offset:256 lds
s_waitcnt lgkmcnt(4)
v_mfma_f32_16x16x32_bf16 v[52:55], a[48:51], v[36:39], v[52:55]
ds_read_b128 v[28:31], v9 offset:16384
v_mfma_f32_16x16x32_bf16 v[56:59], a[52:55], v[36:39], v[56:59]
s_add_u32 m0, s46, 77440
v_mfma_f32_16x16x32_bf16 v[60:63], a[48:51], v[40:43], v[60:63]
ds_read_b128 v[32:35], v9 offset:18432
v_mfma_f32_16x16x32_bf16 v[64:67], a[52:55], v[40:43], v[64:67]
buffer_load_dwordx4 v6, s[8:11], s50 offen offset:384 lds
s_waitcnt lgkmcnt(4)
v_mfma_f32_16x16x32_bf16 v[52:55], a[56:59], v[44:47], v[52:55]
ds_read_b128 v[36:39], v8 offset:20480
v_mfma_f32_16x16x32_bf16 v[56:59], a[60:63], v[44:47], v[56:59]
s_add_u32 m0, s46, 81408
v_mfma_f32_16x16x32_bf16 v[60:63], a[56:59], v[48:51], v[60:63]
ds_read_b128 v[40:43], v8 offset:22528
v_mfma_f32_16x16x32_bf16 v[64:67], a[60:63], v[48:51], v[64:67]
buffer_load_dwordx4 v6, s[8:11], s50 offen offset:512 lds
s_waitcnt lgkmcnt(4)
v_mfma_f32_16x16x32_bf16 v[52:55], a[64:67], v[20:23], v[52:55]
ds_read_b128 v[44:47], v9 offset:20480
v_mfma_f32_16x16x32_bf16 v[56:59], a[68:71], v[20:23], v[56:59]
s_add_u32 m0, s46, 85376
v_mfma_f32_16x16x32_bf16 v[60:63], a[64:67], v[24:27], v[60:63]
ds_read_b128 v[48:51], v9 offset:22528
v_mfma_f32_16x16x32_bf16 v[64:67], a[68:71], v[24:27], v[64:67]
buffer_load_dwordx4 v6, s[8:11], s50 offen offset:640 lds
s_waitcnt lgkmcnt(4)
v_mfma_f32_16x16x32_bf16 v[52:55], a[72:75], v[28:31], v[52:55]
ds_read_b128 v[20:23], v8 offset:24576
v_mfma_f32_16x16x32_bf16 v[56:59], a[76:79], v[28:31], v[56:59]
s_add_u32 m0, s46, 89344
v_mfma_f32_16x16x32_bf16 v[60:63], a[72:75], v[32:35], v[60:63]
ds_read_b128 v[24:27], v8 offset:26624
v_mfma_f32_16x16x32_bf16 v[64:67], a[76:79], v[32:35], v[64:67]
buffer_load_dwordx4 v6, s[8:11], s50 offen offset:768 lds
s_waitcnt lgkmcnt(4)
v_mfma_f32_16x16x32_bf16 v[52:55], a[80:83], v[36:39], v[52:55]
ds_read_b128 v[28:31], v9 offset:24576
v_mfma_f32_16x16x32_bf16 v[56:59], a[84:87], v[36:39], v[56:59]
s_add_u32 m0, s46, 93312
v_mfma_f32_16x16x32_bf16 v[60:63], a[80:83], v[40:43], v[60:63]
ds_read_b128 v[32:35], v9 offset:26624
v_mfma_f32_16x16x32_bf16 v[64:67], a[84:87], v[40:43], v[64:67]
buffer_load_dwordx4 v6, s[8:11], s50 offen offset:896 lds
s_waitcnt lgkmcnt(4)
v_mfma_f32_16x16x32_bf16 v[52:55], a[88:91], v[44:47], v[52:55]
ds_read_b128 v[36:39], v8 offset:28672
v_mfma_f32_16x16x32_bf16 v[56:59], a[92:95], v[44:47], v[56:59]
s_add_u32 m0, s46, 97280
v_mfma_f32_16x16x32_bf16 v[60:63], a[88:91], v[48:51], v[60:63]
ds_read_b128 v[40:43], v8 offset:30720
v_mfma_f32_16x16x32_bf16 v[64:67], a[92:95], v[48:51], v[64:67]
buffer_load_dwordx4 v6, s[8:11], s50 offen offset:1024 lds
s_waitcnt lgkmcnt(4)
v_mfma_f32_16x16x32_bf16 v[52:55], a[96:99], v[20:23], v[52:55]
ds_read_b128 v[44:47], v9 offset:28672
v_mfma_f32_16x16x32_bf16 v[56:59], a[100:103], v[20:23], v[56:59]
s_add_u32 m0, s46, 101248
v_mfma_f32_16x16x32_bf16 v[60:63], a[96:99], v[24:27], v[60:63]
ds_read_b128 v[48:51], v9 offset:30720
v_mfma_f32_16x16x32_bf16 v[64:67], a[100:103], v[24:27], v[64:67]
buffer_load_dwordx4 v6, s[8:11], s50 offen offset:1152 lds
s_waitcnt lgkmcnt(4)
v_mfma_f32_16x16x32_bf16 v[52:55], a[104:107], v[28:31], v[52:55]
ds_read_b128 v[20:23], v8 offset:32768
v_mfma_f32_16x16x32_bf16 v[56:59], a[108:111], v[28:31], v[56:59]
s_add_u32 m0, s46, 105216
v_mfma_f32_16x16x32_bf16 v[60:63], a[104:107], v[32:35], v[60:63]
ds_read_b128 v[24:27], v8 offset:34816
v_mfma_f32_16x16x32_bf16 v[64:67], a[108:111], v[32:35], v[64:67]
buffer_load_dwordx4 v6, s[8:11], s50 offen offset:1280 lds
s_waitcnt lgkmcnt(4)
v_mfma_f32_16x16x32_bf16 v[52:55], a[112:115], v[36:39], v[52:55]
ds_read_b128 v[28:31], v9 offset:32768
v_mfma_f32_16x16x32_bf16 v[56:59], a[116:119], v[36:39], v[56:59]
s_add_u32 m0, s46, 109184
v_mfma_f32_16x16x32_bf16 v[60:63], a[112:115], v[40:43], v[60:63]
ds_read_b128 v[32:35], v9 offset:34816
v_mfma_f32_16x16x32_bf16 v[64:67], a[116:119], v[40:43], v[64:67]
buffer_load_dwordx4 v6, s[8:11], s50 offen offset:1408 lds
s_waitcnt lgkmcnt(4)
v_mfma_f32_16x16x32_bf16 v[52:55], a[120:123], v[44:47], v[52:55]
ds_read_b128 v[36:39], v8 offset:36864
v_mfma_f32_16x16x32_bf16 v[56:59], a[124:127], v[44:47], v[56:59]
s_add_u32 m0, s46, 113152
v_mfma_f32_16x16x32_bf16 v[60:63], a[120:123], v[48:51], v[60:63]
ds_read_b128 v[40:43], v8 offset:38912
v_mfma_f32_16x16x32_bf16 v[64:67], a[124:127], v[48:51], v[64:67]
buffer_load_dwordx4 v6, s[8:11], s50 offen offset:1536 lds
s_waitcnt lgkmcnt(4)
v_mfma_f32_16x16x32_bf16 v[52:55], a[128:131], v[20:23], v[52:55]
ds_read_b128 v[44:47], v9 offset:36864
v_mfma_f32_16x16x32_bf16 v[56:59], a[132:135], v[20:23], v[56:59]
s_add_u32 m0, s46, 117120
v_mfma_f32_16x16x32_bf16 v[60:63], a[128:131], v[24:27], v[60:63]
ds_read_b128 v[48:51], v9 offset:38912
v_mfma_f32_16x16x32_bf16 v[64:67], a[132:135], v[24:27], v[64:67]
buffer_load_dwordx4 v6, s[8:11], s50 offen offset:1664 lds
s_waitcnt lgkmcnt(4)
v_mfma_f32_16x16x32_bf16 v[52:55], a[136:139], v[28:31], v[52:55]
ds_read_b128 v[20:23], v8 offset:40960
v_mfma_f32_16x16x32_bf16 v[56:59], a[140:143], v[28:31], v[56:59]
s_add_u32 m0, s46, 121088
v_mfma_f32_16x16x32_bf16 v[60:63], a[136:139], v[32:35], v[60:63]
ds_read_b128 v[24:27], v8 offset:43008
v_mfma_f32_16x16x32_bf16 v[64:67], a[140:143], v[32:35], v[64:67]
buffer_load_dwordx4 v6, s[8:11], s50 offen offset:1792 lds
s_waitcnt lgkmcnt(4)
v_mfma_f32_16x16x32_bf16 v[52:55], a[144:147], v[36:39], v[52:55]
ds_read_b128 v[28:31], v9 offset:40960
v_mfma_f32_16x16x32_bf16 v[56:59], a[148:151], v[36:39], v[56:59]
s_add_u32 m0, s46, 125056
v_mfma_f32_16x16x32_bf16 v[60:63], a[144:147], v[40:43], v[60:63]
ds_read_b128 v[32:35], v9 offset:43008
v_mfma_f32_16x16x32_bf16 v[64:67], a[148:151], v[40:43], v[64:67]
buffer_load_dwordx4 v6, s[8:11], s50 offen offset:1920 lds
s_waitcnt lgkmcnt(4)
v_mfma_f32_16x16x32_bf16 v[52:55], a[152:155], v[44:47], v[52:55]
ds_read_b128 v[36:39], v8 offset:45056
v_mfma_f32_16x16x32_bf16 v[56:59], a[156:159], v[44:47], v[56:59]
v_mfma_f32_16x16x32_bf16 v[60:63], a[152:155], v[48:51], v[60:63]
ds_read_b128 v[40:43], v8 offset:47104
v_mfma_f32_16x16x32_bf16 v[64:67], a[156:159], v[48:51], v[64:67]
s_waitcnt lgkmcnt(4)
v_mfma_f32_16x16x32_bf16 v[52:55], a[160:163], v[20:23], v[52:55]
ds_read_b128 v[44:47], v9 offset:45056
v_mfma_f32_16x16x32_bf16 v[56:59], a[164:167], v[20:23], v[56:59]
v_mfma_f32_16x16x32_bf16 v[60:63], a[160:163], v[24:27], v[60:63]
ds_read_b128 v[48:51], v9 offset:47104
v_mfma_f32_16x16x32_bf16 v[64:67], a[164:167], v[24:27], v[64:67]
s_waitcnt lgkmcnt(4)
v_mfma_f32_16x16x32_bf16 v[52:55], a[168:171], v[28:31], v[52:55]
ds_read_b128 v[20:23], v8 offset:49152
v_mfma_f32_16x16x32_bf16 v[56:59], a[172:175], v[28:31], v[56:59]
s_waitcnt vmcnt(16)
v_mov_b32 v17, s42
s_mov_b64 exec, 1
buffer_store_dword v17, v16, s[84:87], s49 offen sc1
s_mov_b64 exec, -1
v_mfma_f32_16x16x32_bf16 v[60:63], a[168:171], v[32:35], v[60:63]
ds_read_b128 v[24:27], v8 offset:51200
v_mfma_f32_16x16x32_bf16 v[64:67], a[172:175], v[32:35], v[64:67]
s_waitcnt lgkmcnt(4)
v_mfma_f32_16x16x32_bf16 v[52:55], a[176:179], v[36:39], v[52:55]
ds_read_b128 v[28:31], v9 offset:49152
v_mfma_f32_16x16x32_bf16 v[56:59], a[180:183], v[36:39], v[56:59]
s_add_u32 s53, s42, 3
s_min_u32 s53, s53, 63
s_lshl_b32 s53, s53, 16
s_mov_b64 exec, 0xffff
buffer_load_dword v250, v19, s[8:11], s53 offen
s_mov_b64 exec, -1
v_mfma_f32_16x16x32_bf16 v[60:63], a[176:179], v[40:43], v[60:63]
ds_read_b128 v[32:35], v9 offset:51200
v_mfma_f32_16x16x32_bf16 v[64:67], a[180:183], v[40:43], v[64:67]
s_waitcnt lgkmcnt(4)
v_mfma_f32_16x16x32_bf16 v[52:55], a[184:187], v[44:47], v[52:55]
ds_read_b128 v[36:39], v8 offset:53248
v_mfma_f32_16x16x32_bf16 v[56:59], a[188:191], v[44:47], v[56:59]
v_mfma_f32_16x16x32_bf16 v[60:63], a[184:187], v[48:51], v[60:63]
ds_read_b128 v[40:43], v8 offset:55296
v_mfma_f32_16x16x32_bf16 v[64:67], a[188:191], v[48:51], v[64:67]
s_waitcnt lgkmcnt(4)
v_mfma_f32_16x16x32_bf16 v[52:55], a[192:195], v[20:23], v[52:55]
ds_read_b128 v[44:47], v9 offset:53248
v_mfma_f32_16x16x32_bf16 v[56:59], a[196:199], v[20:23], v[56:59]
v_mfma_f32_16x16x32_bf16 v[60:63], a[192:195], v[24:27], v[60:63]
ds_read_b128 v[48:51], v9 offset:55296
v_mfma_f32_16x16x32_bf16 v[64:67], a[196:199], v[24:27], v[64:67]
s_waitcnt lgkmcnt(4)
v_mfma_f32_16x16x32_bf16 v[52:55], a[200:203], v[28:31], v[52:55]
ds_read_b128 v[20:23], v8 offset:57344
v_mfma_f32_16x16x32_bf16 v[56:59], a[204:207], v[28:31], v[56:59]
v_mfma_f32_16x16x32_bf16 v[60:63], a[200:203], v[32:35], v[60:63]
ds_read_b128 v[24:27], v8 offset:59392
v_mfma_f32_16x16x32_bf16 v[64:67], a[204:207], v[32:35], v[64:67]
s_waitcnt lgkmcnt(4)
v_mfma_f32_16x16x32_bf16 v[52:55], a[208:211], v[36:39], v[52:55]
ds_read_b128 v[28:31], v9 offset:57344
v_mfma_f32_16x16x32_bf16 v[56:59], a[212:215], v[36:39], v[56:59]
v_mfma_f32_16x16x32_bf16 v[60:63], a[208:211], v[40:43], v[60:63]
ds_read_b128 v[32:35], v9 offset:59392
v_mfma_f32_16x16x32_bf16 v[64:67], a[212:215], v[40:43], v[64:67]
s_waitcnt lgkmcnt(4)
v_mfma_f32_16x16x32_bf16 v[52:55], a[216:219], v[44:47], v[52:55]
ds_read_b128 v[36:39], v8 offset:61440
v_mfma_f32_16x16x32_bf16 v[56:59], a[220:223], v[44:47], v[56:59]
v_mfma_f32_16x16x32_bf16 v[60:63], a[216:219], v[48:51], v[60:63]
ds_read_b128 v[40:43], v8 offset:63488
v_mfma_f32_16x16x32_bf16 v[64:67], a[220:223], v[48:51], v[64:67]
s_waitcnt lgkmcnt(4)
v_mfma_f32_16x16x32_bf16 v[52:55], a[224:227], v[20:23], v[52:55]
ds_read_b128 v[44:47], v9 offset:61440
v_mfma_f32_16x16x32_bf16 v[56:59], a[228:231], v[20:23], v[56:59]
v_mfma_f32_16x16x32_bf16 v[60:63], a[224:227], v[24:27], v[60:63]
ds_read_b128 v[48:51], v9 offset:63488
v_mfma_f32_16x16x32_bf16 v[64:67], a[228:231], v[24:27], v[64:67]
s_waitcnt lgkmcnt(5)
v_mfma_f32_16x16x32_bf16 v[52:55], a[232:235], v[28:31], v[52:55]
v_mfma_f32_16x16x32_bf16 v[56:59], a[236:239], v[28:31], v[56:59]
s_waitcnt lgkmcnt(4)
v_mfma_f32_16x16x32_bf16 v[60:63], a[232:235], v[32:35], v[60:63]
v_mfma_f32_16x16x32_bf16 v[64:67], a[236:239], v[32:35], v[64:67]
s_waitcnt lgkmcnt(3)
v_mfma_f32_16x16x32_bf16 v[52:55], a[240:243], v[36:39], v[52:55]
v_mfma_f32_16x16x32_bf16 v[56:59], a[244:247], v[36:39], v[56:59]
s_waitcnt lgkmcnt(2)
v_mfma_f32_16x16x32_bf16 v[60:63], a[240:243], v[40:43], v[60:63]
v_mfma_f32_16x16x32_bf16 v[64:67], a[244:247], v[40:43], v[64:67]
s_waitcnt lgkmcnt(1)
v_mfma_f32_16x16x32_bf16 v[52:55], a[248:251], v[44:47], v[52:55]
v_mfma_f32_16x16x32_bf16 v[56:59], a[252:255], v[44:47], v[56:59]
s_waitcnt lgkmcnt(0)
v_mfma_f32_16x16x32_bf16 v[60:63], a[248:251], v[48:51], v[60:63]
v_mfma_f32_16x16x32_bf16 v[64:67], a[252:255], v[48:51], v[64:67]
s_add_u32 s42, s42, 1
s_branch mega_kernel_k_loop
mega_kernel_k_fin:
s_nop 11
v_cvt_pk_bf16_f32 v84, v68, v69
v_cvt_pk_bf16_f32 v85, v70, v71
v_cvt_pk_bf16_f32 v86, v72, v73
v_cvt_pk_bf16_f32 v87, v74, v75
v_cvt_pk_bf16_f32 v88, v76, v77
v_cvt_pk_bf16_f32 v89, v78, v79
v_cvt_pk_bf16_f32 v90, v80, v81
v_cvt_pk_bf16_f32 v91, v82, v83
s_add_u32 s51, s42, s47
s_sub_u32 s51, s51, 1
s_bfe_u32 s52, s51, 0x40002
s_lshl_b32 s52, s52, 14
s_and_b32 s51, s51, 3
s_lshl_b32 s51, s51, 11
s_add_u32 s51, s51, s52
s_add_u32 s51, s51, s48
buffer_store_dwordx4 v[84:87], v7, s[84:87], s51 offen sc1
buffer_store_dwordx4 v[88:91], v7, s[84:87], s51 offen offset:1024 sc1
s_waitcnt vmcnt(0)
v_mov_b32 v17, s42
s_mov_b64 exec, 1
buffer_store_dword v17, v16, s[84:87], s49 offen sc1
s_mov_b64 exec, -1
s_waitcnt vmcnt(0)
s_barrier
s_branch mega_kernel_fft
mega_kernel_rv:
s_load_dwordx2 s[4:5], s[0:1], 32
s_load_dwordx2 s[8:9], s[0:1], 0
v_lshrrev_b32 v2, 6, v0
v_and_b32 v1, 63, v0
v_readfirstlane_b32 s41, v2
v_lshlrev_b32 v5, 4, v1
s_waitcnt lgkmcnt(0)
s_mov_b32 s6, 8388608
s_mov_b32 s7, 0x00020000
s_mov_b32 s10, 4194304
s_mov_b32 s11, 0x00020000
s_lshl_b32 s43, s40, 8
s_lshl_b32 s44, s41, 6
s_add_u32 s48, s43, s44
s_and_b32 s43, s48, 0x7ff
v_add_u32 v19, s43, v1
v_lshlrev_b32 v19, 7, v19
buffer_load_dword v250, v19, s[8:11], 0 offen
s_nop 0
v_lshrrev_b32 v2, 3, v1
s_lshl_b32 s43, s41, 3
v_add_u32 v2, s43, v2
v_bfe_u32 v3, v2, 1, 3
v_and_b32 v4, 7, v1
v_xor_b32 v3, v3, v4
v_lshlrev_b32 v6, 11, v2
v_lshl_add_u32 v6, v3, 4, v6
s_lshl_b32 s46, s41, 10
v_and_b32 v2, 15, v1
v_bfe_u32 v3, v2, 1, 3
v_lshrrev_b32 v4, 4, v1
v_xor_b32 v3, v3, v4
v_lshlrev_b32 v8, 7, v2
v_lshl_add_u32 v8, v3, 4, v8
v_xor_b32 v9, 64, v8
v_add_u32 v10, 0x10000, v8
v_add_u32 v11, 0x10000, v9
v_mov_b32 v7, v5
s_lshl_b32 s47, s40, 2
s_add_u32 s47, s47, s41
s_mov_b32 s42, 0
s_mov_b32 s50, 0
s_add_u32 m0, s46, 0
s_nop 0
buffer_load_dwordx4 v6, s[8:11], s50 offen offset:0 lds
s_add_u32 m0, s46, 3968
s_nop 0
buffer_load_dwordx4 v6, s[8:11], s50 offen offset:128 lds
s_add_u32 m0, s46, 7936
s_nop 0
buffer_load_dwordx4 v6, s[8:11], s50 offen offset:256 lds
s_add_u32 m0, s46, 11904
s_nop 0
buffer_load_dwordx4 v6, s[8:11], s50 offen offset:384 lds
s_add_u32 m0, s46, 15872
s_nop 0
buffer_load_dwordx4 v6, s[8:11], s50 offen offset:512 lds
s_add_u32 m0, s46, 19840
s_nop 0
buffer_load_dwordx4 v6, s[8:11], s50 offen offset:640 lds
s_add_u32 m0, s46, 23808
s_nop 0
buffer_load_dwordx4 v6, s[8:11], s50 offen offset:768 lds
s_add_u32 m0, s46, 27776
s_nop 0
buffer_load_dwordx4 v6, s[8:11], s50 offen offset:896 lds
s_add_u32 m0, s46, 31744
s_nop 0
buffer_load_dwordx4 v6, s[8:11], s50 offen offset:1024 lds
s_add_u32 m0, s46, 35712
s_nop 0
buffer_load_dwordx4 v6, s[8:11], s50 offen offset:1152 lds
s_add_u32 m0, s46, 39680
s_nop 0
buffer_load_dwordx4 v6, s[8:11], s50 offen offset:1280 lds
s_add_u32 m0, s46, 43648
s_nop 0
buffer_load_dwordx4 v6, s[8:11], s50 offen offset:1408 lds
s_add_u32 m0, s46, 47616
s_nop 0
buffer_load_dwordx4 v6, s[8:11], s50 offen offset:1536 lds
s_add_u32 m0, s46, 51584
s_nop 0
buffer_load_dwordx4 v6, s[8:11], s50 offen offset:1664 lds
s_add_u32 m0, s46, 55552
s_nop 0
buffer_load_dwordx4 v6, s[8:11], s50 offen offset:1792 lds
s_add_u32 m0, s46, 59520
s_nop 0
buffer_load_dwordx4 v6, s[8:11], s50 offen offset:1920 lds
v_lshrrev_b32 v2, 2, v1
v_and_b32 v3, 3, v1
v_lshlrev_b32 v16, 13, v2
v_lshl_add_u32 v16, v3, 4, v16
v_add_u32 v16, s48, v16
s_mul_i32 s45, s41, 24576
s_add_u32 s45, s45, 65536
v_bfe_u32 v17, v1, 2, 2
v_lshrrev_b32 v18, 4, v1
v_lshl_add_u32 v17, v18, 3, v17
v_lshlrev_b32 v17, 6, v17
v_lshl_add_u32 v17, v3, 3, v17
v_add_u32 v17, s45, v17
s_and_b32 s43, s40, 3
s_lshl_b32 s43, s43, 2
s_add_u32 s43, s43, s41
s_lshl_b32 s43, s43, 3
v_and_b32 v12, 7, v1
v_add_u32 v12, s43, v12
s_lshr_b32 s43, s40, 2
s_lshl_b32 s43, s43, 10
s_add_u32 s44, s43, 896
s_add_u32 s43, s43, 384
s_cmp_ge_u32 s40, 28
s_cselect_b32 s44, s44, s43
v_mov_b32 v13, s43
v_mov_b32 v14, s44
v_cmp_gt_u32 vcc, 32, v1
s_nop 1
v_cndmask_b32 v13, v14, v13, vcc
v_lshl_add_u32 v12, v12, 13, v13
s_mov_b32 s44, 0
buffer_load_dword v250, v12, s[4:7], s44 offen
s_add_u32 m0, s45, 0
s_mov_b32 s44, 0
buffer_load_dwordx4 v16, s[4:7], s44 offen lds
s_add_u32 m0, s45, 1024
s_mov_b32 s44, 131072
buffer_load_dwordx4 v16, s[4:7], s44 offen lds
s_add_u32 m0, s45, 2048
s_mov_b32 s44, 262144
buffer_load_dwordx4 v16, s[4:7], s44 offen lds
s_add_u32 m0, s45, 3072
s_mov_b32 s44, 393216
buffer_load_dwordx4 v16, s[4:7], s44 offen lds
s_add_u32 m0, s45, 4096
s_mov_b32 s44, 524288
buffer_load_dwordx4 v16, s[4:7], s44 offen lds
s_add_u32 m0, s45, 5120
s_mov_b32 s44, 655360
buffer_load_dwordx4 v16, s[4:7], s44 offen lds
s_add_u32 m0, s45, 6144
s_mov_b32 s44, 786432
buffer_load_dwordx4 v16, s[4:7], s44 offen lds
s_add_u32 m0, s45, 7168
s_mov_b32 s44, 917504
buffer_load_dwordx4 v16, s[4:7], s44 offen lds
s_mov_b32 s44, 1048576
buffer_load_dword v250, v12, s[4:7], s44 offen
s_add_u32 m0, s45, 8192
s_mov_b32 s44, 1048576
buffer_load_dwordx4 v16, s[4:7], s44 offen lds
s_add_u32 m0, s45, 9216
s_mov_b32 s44, 1179648
buffer_load_dwordx4 v16, s[4:7], s44 offen lds
s_add_u32 m0, s45, 10240
s_mov_b32 s44, 1310720
buffer_load_dwordx4 v16, s[4:7], s44 offen lds
s_add_u32 m0, s45, 11264
s_mov_b32 s44, 1441792
buffer_load_dwordx4 v16, s[4:7], s44 offen lds
s_add_u32 m0, s45, 12288
s_mov_b32 s44, 1572864
buffer_load_dwordx4 v16, s[4:7], s44 offen lds
s_add_u32 m0, s45, 13312
s_mov_b32 s44, 1703936
buffer_load_dwordx4 v16, s[4:7], s44 offen lds
s_add_u32 m0, s45, 14336
s_mov_b32 s44, 1835008
buffer_load_dwordx4 v16, s[4:7], s44 offen lds
s_add_u32 m0, s45, 15360
s_mov_b32 s44, 1966080
buffer_load_dwordx4 v16, s[4:7], s44 offen lds
s_mov_b32 s44, 2097152
buffer_load_dword v250, v12, s[4:7], s44 offen
s_add_u32 m0, s45, 16384
s_mov_b32 s44, 2097152
buffer_load_dwordx4 v16, s[4:7], s44 offen lds
s_add_u32 m0, s45, 17408
s_mov_b32 s44, 2228224
buffer_load_dwordx4 v16, s[4:7], s44 offen lds
s_add_u32 m0, s45, 18432
s_mov_b32 s44, 2359296
buffer_load_dwordx4 v16, s[4:7], s44 offen lds
s_add_u32 m0, s45, 19456
s_mov_b32 s44, 2490368
buffer_load_dwordx4 v16, s[4:7], s44 offen lds
s_add_u32 m0, s45, 20480
s_mov_b32 s44, 2621440
buffer_load_dwordx4 v16, s[4:7], s44 offen lds
s_add_u32 m0, s45, 21504
s_mov_b32 s44, 2752512
buffer_load_dwordx4 v16, s[4:7], s44 offen lds
s_add_u32 m0, s45, 22528
s_mov_b32 s44, 2883584
buffer_load_dwordx4 v16, s[4:7], s44 offen lds
s_add_u32 m0, s45, 23552
s_mov_b32 s44, 3014656
buffer_load_dwordx4 v16, s[4:7], s44 offen lds
s_waitcnt vmcnt(18)
s_barrier
ds_read_b64_tr_b16 a[0:1], v17 offset:0
ds_read_b64_tr_b16 a[2:3], v17 offset:256
ds_read_b64_tr_b16 a[4:5], v17 offset:32
ds_read_b64_tr_b16 a[6:7], v17 offset:288
ds_read_b64_tr_b16 a[8:9], v17 offset:2048
ds_read_b64_tr_b16 a[10:11], v17 offset:2304
ds_read_b64_tr_b16 a[12:13], v17 offset:2080
ds_read_b64_tr_b16 a[14:15], v17 offset:2336
s_waitcnt lgkmcnt(0)
ds_read_b64_tr_b16 a[16:17], v17 offset:4096
ds_read_b64_tr_b16 a[18:19], v17 offset:4352
ds_read_b64_tr_b16 a[20:21], v17 offset:4128
ds_read_b64_tr_b16 a[22:23], v17 offset:4384
ds_read_b64_tr_b16 a[24:25], v17 offset:6144
ds_read_b64_tr_b16 a[26:27], v17 offset:6400
ds_read_b64_tr_b16 a[28:29], v17 offset:6176
ds_read_b64_tr_b16 a[30:31], v17 offset:6432
s_waitcnt lgkmcnt(0)
ds_read_b128 v[20:23], v8 offset:0
ds_read_b128 v[24:27], v8 offset:2048
ds_read_b128 v[28:31], v9 offset:0
ds_read_b128 v[32:35], v9 offset:2048
ds_read_b128 v[36:39], v8 offset:4096
ds_read_b128 v[40:43], v8 offset:6144
ds_read_b128 v[44:47], v9 offset:4096
ds_read_b128 v[48:51], v9 offset:6144
s_mov_b32 s44, 3145728
buffer_load_dword v250, v12, s[4:7], s44 offen
s_add_u32 m0, s45, 0
s_mov_b32 s44, 3145728
buffer_load_dwordx4 v16, s[4:7], s44 offen lds
s_add_u32 m0, s45, 1024
s_mov_b32 s44, 3276800
buffer_load_dwordx4 v16, s[4:7], s44 offen lds
s_add_u32 m0, s45, 2048
s_mov_b32 s44, 3407872
buffer_load_dwordx4 v16, s[4:7], s44 offen lds
s_add_u32 m0, s45, 3072
s_mov_b32 s44, 3538944
buffer_load_dwordx4 v16, s[4:7], s44 offen lds
s_add_u32 m0, s45, 4096
s_mov_b32 s44, 3670016
buffer_load_dwordx4 v16, s[4:7], s44 offen lds
s_add_u32 m0, s45, 5120
s_mov_b32 s44, 3801088
buffer_load_dwordx4 v16, s[4:7], s44 offen lds
s_add_u32 m0, s45, 6144
s_mov_b32 s44, 3932160
buffer_load_dwordx4 v16, s[4:7], s44 offen lds
s_add_u32 m0, s45, 7168
s_mov_b32 s44, 4063232
buffer_load_dwordx4 v16, s[4:7], s44 offen lds
s_waitcnt lgkmcnt(0)
v_mfma_f32_16x16x32_bf16 v[52:55], v[20:23], a[0:3], 0
v_mfma_f32_16x16x32_bf16 v[56:59], v[20:23], a[4:7], 0
v_mfma_f32_16x16x32_bf16 v[60:63], v[24:27], a[0:3], 0
v_mfma_f32_16x16x32_bf16 v[64:67], v[24:27], a[4:7], 0
v_mfma_f32_16x16x32_bf16 v[52:55], v[28:31], a[8:11], v[52:55]
v_mfma_f32_16x16x32_bf16 v[56:59], v[28:31], a[12:15], v[56:59]
v_mfma_f32_16x16x32_bf16 v[60:63], v[32:35], a[8:11], v[60:63]
v_mfma_f32_16x16x32_bf16 v[64:67], v[32:35], a[12:15], v[64:67]
v_mfma_f32_16x16x32_bf16 v[52:55], v[36:39], a[16:19], v[52:55]
v_mfma_f32_16x16x32_bf16 v[56:59], v[36:39], a[20:23], v[56:59]
v_mfma_f32_16x16x32_bf16 v[60:63], v[40:43], a[16:19], v[60:63]
v_mfma_f32_16x16x32_bf16 v[64:67], v[40:43], a[20:23], v[64:67]
v_mfma_f32_16x16x32_bf16 v[52:55], v[44:47], a[24:27], v[52:55]
v_mfma_f32_16x16x32_bf16 v[56:59], v[44:47], a[28:31], v[56:59]
v_mfma_f32_16x16x32_bf16 v[60:63], v[48:51], a[24:27], v[60:63]
v_mfma_f32_16x16x32_bf16 v[64:67], v[48:51], a[28:31], v[64:67]
s_waitcnt vmcnt(18)
ds_read_b64_tr_b16 a[32:33], v17 offset:8192
ds_read_b64_tr_b16 a[34:35], v17 offset:8448
ds_read_b64_tr_b16 a[36:37], v17 offset:8224
ds_read_b64_tr_b16 a[38:39], v17 offset:8480
ds_read_b64_tr_b16 a[40:41], v17 offset:10240
ds_read_b64_tr_b16 a[42:43], v17 offset:10496
ds_read_b64_tr_b16 a[44:45], v17 offset:10272
ds_read_b64_tr_b16 a[46:47], v17 offset:10528
s_waitcnt lgkmcnt(0)
ds_read_b64_tr_b16 a[48:49], v17 offset:12288
ds_read_b64_tr_b16 a[50:51], v17 offset:12544
ds_read_b64_tr_b16 a[52:53], v17 offset:12320
ds_read_b64_tr_b16 a[54:55], v17 offset:12576
ds_read_b64_tr_b16 a[56:57], v17 offset:14336
ds_read_b64_tr_b16 a[58:59], v17 offset:14592
ds_read_b64_tr_b16 a[60:61], v17 offset:14368
ds_read_b64_tr_b16 a[62:63], v17 offset:14624
s_waitcnt lgkmcnt(0)
ds_read_b128 v[20:23], v8 offset:8192
ds_read_b128 v[24:27], v8 offset:10240
ds_read_b128 v[28:31], v9 offset:8192
ds_read_b128 v[32:35], v9 offset:10240
ds_read_b128 v[36:39], v8 offset:12288
ds_read_b128 v[40:43], v8 offset:14336
ds_read_b128 v[44:47], v9 offset:12288
ds_read_b128 v[48:51], v9 offset:14336
s_mov_b32 s44, 4194304
buffer_load_dword v250, v12, s[4:7], s44 offen
s_add_u32 m0, s45, 8192
s_mov_b32 s44, 4194304
buffer_load_dwordx4 v16, s[4:7], s44 offen lds
s_add_u32 m0, s45, 9216
s_mov_b32 s44, 4325376
buffer_load_dwordx4 v16, s[4:7], s44 offen lds
s_add_u32 m0, s45, 10240
s_mov_b32 s44, 4456448
buffer_load_dwordx4 v16, s[4:7], s44 offen lds
s_add_u32 m0, s45, 11264
s_mov_b32 s44, 4587520
buffer_load_dwordx4 v16, s[4:7], s44 offen lds
s_add_u32 m0, s45, 12288
s_mov_b32 s44, 4718592
buffer_load_dwordx4 v16, s[4:7], s44 offen lds
s_add_u32 m0, s45, 13312
s_mov_b32 s44, 4849664
buffer_load_dwordx4 v16, s[4:7], s44 offen lds
s_add_u32 m0, s45, 14336
s_mov_b32 s44, 4980736
buffer_load_dwordx4 v16, s[4:7], s44 offen lds
s_add_u32 m0, s45, 15360
s_mov_b32 s44, 5111808
buffer_load_dwordx4 v16, s[4:7], s44 offen lds
s_waitcnt lgkmcnt(0)
v_mfma_f32_16x16x32_bf16 v[52:55], v[20:23], a[32:35], v[52:55]
v_mfma_f32_16x16x32_bf16 v[56:59], v[20:23], a[36:39], v[56:59]
v_mfma_f32_16x16x32_bf16 v[60:63], v[24:27], a[32:35], v[60:63]
v_mfma_f32_16x16x32_bf16 v[64:67], v[24:27], a[36:39], v[64:67]
v_mfma_f32_16x16x32_bf16 v[52:55], v[28:31], a[40:43], v[52:55]
v_mfma_f32_16x16x32_bf16 v[56:59], v[28:31], a[44:47], v[56:59]
v_mfma_f32_16x16x32_bf16 v[60:63], v[32:35], a[40:43], v[60:63]
v_mfma_f32_16x16x32_bf16 v[64:67], v[32:35], a[44:47], v[64:67]
v_mfma_f32_16x16x32_bf16 v[52:55], v[36:39], a[48:51], v[52:55]
v_mfma_f32_16x16x32_bf16 v[56:59], v[36:39], a[52:55], v[56:59]
v_mfma_f32_16x16x32_bf16 v[60:63], v[40:43], a[48:51], v[60:63]
v_mfma_f32_16x16x32_bf16 v[64:67], v[40:43], a[52:55], v[64:67]
v_mfma_f32_16x16x32_bf16 v[52:55], v[44:47], a[56:59], v[52:55]
v_mfma_f32_16x16x32_bf16 v[56:59], v[44:47], a[60:63], v[56:59]
v_mfma_f32_16x16x32_bf16 v[60:63], v[48:51], a[56:59], v[60:63]
v_mfma_f32_16x16x32_bf16 v[64:67], v[48:51], a[60:63], v[64:67]
s_waitcnt vmcnt(18)
ds_read_b64_tr_b16 a[64:65], v17 offset:16384
ds_read_b64_tr_b16 a[66:67], v17 offset:16640
ds_read_b64_tr_b16 a[68:69], v17 offset:16416
ds_read_b64_tr_b16 a[70:71], v17 offset:16672
ds_read_b64_tr_b16 a[72:73], v17 offset:18432
ds_read_b64_tr_b16 a[74:75], v17 offset:18688
ds_read_b64_tr_b16 a[76:77], v17 offset:18464
ds_read_b64_tr_b16 a[78:79], v17 offset:18720
s_waitcnt lgkmcnt(0)
ds_read_b64_tr_b16 a[80:81], v17 offset:20480
ds_read_b64_tr_b16 a[82:83], v17 offset:20736
ds_read_b64_tr_b16 a[84:85], v17 offset:20512
ds_read_b64_tr_b16 a[86:87], v17 offset:20768
ds_read_b64_tr_b16 a[88:89], v17 offset:22528
ds_read_b64_tr_b16 a[90:91], v17 offset:22784
ds_read_b64_tr_b16 a[92:93], v17 offset:22560
ds_read_b64_tr_b16 a[94:95], v17 offset:22816
s_waitcnt lgkmcnt(0)
ds_read_b128 v[20:23], v8 offset:16384
ds_read_b128 v[24:27], v8 offset:18432
ds_read_b128 v[28:31], v9 offset:16384
ds_read_b128 v[32:35], v9 offset:18432
ds_read_b128 v[36:39], v8 offset:20480
ds_read_b128 v[40:43], v8 offset:22528
ds_read_b128 v[44:47], v9 offset:20480
ds_read_b128 v[48:51], v9 offset:22528
s_mov_b32 s44, 5242880
buffer_load_dword v250, v12, s[4:7], s44 offen
s_add_u32 m0, s45, 16384
s_mov_b32 s44, 5242880
buffer_load_dwordx4 v16, s[4:7], s44 offen lds
s_add_u32 m0, s45, 17408
s_mov_b32 s44, 5373952
buffer_load_dwordx4 v16, s[4:7], s44 offen lds
s_add_u32 m0, s45, 18432
s_mov_b32 s44, 5505024
buffer_load_dwordx4 v16, s[4:7], s44 offen lds
s_add_u32 m0, s45, 19456
s_mov_b32 s44, 5636096
buffer_load_dwordx4 v16, s[4:7], s44 offen lds
s_add_u32 m0, s45, 20480
s_mov_b32 s44, 5767168
buffer_load_dwordx4 v16, s[4:7], s44 offen lds
s_add_u32 m0, s45, 21504
s_mov_b32 s44, 5898240
buffer_load_dwordx4 v16, s[4:7], s44 offen lds
s_add_u32 m0, s45, 22528
s_mov_b32 s44, 6029312
buffer_load_dwordx4 v16, s[4:7], s44 offen lds
s_add_u32 m0, s45, 23552
s_mov_b32 s44, 6160384
buffer_load_dwordx4 v16, s[4:7], s44 offen lds
s_waitcnt lgkmcnt(0)
v_mfma_f32_16x16x32_bf16 v[52:55], v[20:23], a[64:67], v[52:55]
v_mfma_f32_16x16x32_bf16 v[56:59], v[20:23], a[68:71], v[56:59]
v_mfma_f32_16x16x32_bf16 v[60:63], v[24:27], a[64:67], v[60:63]
v_mfma_f32_16x16x32_bf16 v[64:67], v[24:27], a[68:71], v[64:67]
v_mfma_f32_16x16x32_bf16 v[52:55], v[28:31], a[72:75], v[52:55]
v_mfma_f32_16x16x32_bf16 v[56:59], v[28:31], a[76:79], v[56:59]
v_mfma_f32_16x16x32_bf16 v[60:63], v[32:35], a[72:75], v[60:63]
v_mfma_f32_16x16x32_bf16 v[64:67], v[32:35], a[76:79], v[64:67]
v_mfma_f32_16x16x32_bf16 v[52:55], v[36:39], a[80:83], v[52:55]
v_mfma_f32_16x16x32_bf16 v[56:59], v[36:39], a[84:87], v[56:59]
v_mfma_f32_16x16x32_bf16 v[60:63], v[40:43], a[80:83], v[60:63]
v_mfma_f32_16x16x32_bf16 v[64:67], v[40:43], a[84:87], v[64:67]
v_mfma_f32_16x16x32_bf16 v[52:55], v[44:47], a[88:91], v[52:55]
v_mfma_f32_16x16x32_bf16 v[56:59], v[44:47], a[92:95], v[56:59]
v_mfma_f32_16x16x32_bf16 v[60:63], v[48:51], a[88:91], v[60:63]
v_mfma_f32_16x16x32_bf16 v[64:67], v[48:51], a[92:95], v[64:67]
s_waitcnt vmcnt(18)
ds_read_b64_tr_b16 a[96:97], v17 offset:0
ds_read_b64_tr_b16 a[98:99], v17 offset:256
ds_read_b64_tr_b16 a[100:101], v17 offset:32
ds_read_b64_tr_b16 a[102:103], v17 offset:288
ds_read_b64_tr_b16 a[104:105], v17 offset:2048
ds_read_b64_tr_b16 a[106:107], v17 offset:2304
ds_read_b64_tr_b16 a[108:109], v17 offset:2080
ds_read_b64_tr_b16 a[110:111], v17 offset:2336
s_waitcnt lgkmcnt(0)
ds_read_b64_tr_b16 a[112:113], v17 offset:4096
ds_read_b64_tr_b16 a[114:115], v17 offset:4352
ds_read_b64_tr_b16 a[116:117], v17 offset:4128
ds_read_b64_tr_b16 a[118:119], v17 offset:4384
ds_read_b64_tr_b16 a[120:121], v17 offset:6144
ds_read_b64_tr_b16 a[122:123], v17 offset:6400
ds_read_b64_tr_b16 a[124:125], v17 offset:6176
ds_read_b64_tr_b16 a[126:127], v17 offset:6432
s_waitcnt lgkmcnt(0)
ds_read_b128 v[20:23], v8 offset:24576
ds_read_b128 v[24:27], v8 offset:26624
ds_read_b128 v[28:31], v9 offset:24576
ds_read_b128 v[32:35], v9 offset:26624
ds_read_b128 v[36:39], v8 offset:28672
ds_read_b128 v[40:43], v8 offset:30720
ds_read_b128 v[44:47], v9 offset:28672
ds_read_b128 v[48:51], v9 offset:30720
s_mov_b32 s44, 6291456
buffer_load_dword v250, v12, s[4:7], s44 offen
s_add_u32 m0, s45, 0
s_mov_b32 s44, 6291456
buffer_load_dwordx4 v16, s[4:7], s44 offen lds
s_add_u32 m0, s45, 1024
s_mov_b32 s44, 6422528
buffer_load_dwordx4 v16, s[4:7], s44 offen lds
s_add_u32 m0, s45, 2048
s_mov_b32 s44, 6553600
buffer_load_dwordx4 v16, s[4:7], s44 offen lds
s_add_u32 m0, s45, 3072
s_mov_b32 s44, 6684672
buffer_load_dwordx4 v16, s[4:7], s44 offen lds
s_add_u32 m0, s45, 4096
s_mov_b32 s44, 6815744
buffer_load_dwordx4 v16, s[4:7], s44 offen lds
s_add_u32 m0, s45, 5120
s_mov_b32 s44, 6946816
buffer_load_dwordx4 v16, s[4:7], s44 offen lds
s_add_u32 m0, s45, 6144
s_mov_b32 s44, 7077888
buffer_load_dwordx4 v16, s[4:7], s44 offen lds
s_add_u32 m0, s45, 7168
s_mov_b32 s44, 7208960
buffer_load_dwordx4 v16, s[4:7], s44 offen lds
s_waitcnt lgkmcnt(0)
v_mfma_f32_16x16x32_bf16 v[52:55], v[20:23], a[96:99], v[52:55]
v_mfma_f32_16x16x32_bf16 v[56:59], v[20:23], a[100:103], v[56:59]
v_mfma_f32_16x16x32_bf16 v[60:63], v[24:27], a[96:99], v[60:63]
v_mfma_f32_16x16x32_bf16 v[64:67], v[24:27], a[100:103], v[64:67]
v_mfma_f32_16x16x32_bf16 v[52:55], v[28:31], a[104:107], v[52:55]
v_mfma_f32_16x16x32_bf16 v[56:59], v[28:31], a[108:111], v[56:59]
v_mfma_f32_16x16x32_bf16 v[60:63], v[32:35], a[104:107], v[60:63]
v_mfma_f32_16x16x32_bf16 v[64:67], v[32:35], a[108:111], v[64:67]
v_mfma_f32_16x16x32_bf16 v[52:55], v[36:39], a[112:115], v[52:55]
v_mfma_f32_16x16x32_bf16 v[56:59], v[36:39], a[116:119], v[56:59]
v_mfma_f32_16x16x32_bf16 v[60:63], v[40:43], a[112:115], v[60:63]
v_mfma_f32_16x16x32_bf16 v[64:67], v[40:43], a[116:119], v[64:67]
v_mfma_f32_16x16x32_bf16 v[52:55], v[44:47], a[120:123], v[52:55]
v_mfma_f32_16x16x32_bf16 v[56:59], v[44:47], a[124:127], v[56:59]
v_mfma_f32_16x16x32_bf16 v[60:63], v[48:51], a[120:123], v[60:63]
v_mfma_f32_16x16x32_bf16 v[64:67], v[48:51], a[124:127], v[64:67]
s_waitcnt vmcnt(18)
ds_read_b64_tr_b16 a[128:129], v17 offset:8192
ds_read_b64_tr_b16 a[130:131], v17 offset:8448
ds_read_b64_tr_b16 a[132:133], v17 offset:8224
ds_read_b64_tr_b16 a[134:135], v17 offset:8480
ds_read_b64_tr_b16 a[136:137], v17 offset:10240
ds_read_b64_tr_b16 a[138:139], v17 offset:10496
ds_read_b64_tr_b16 a[140:141], v17 offset:10272
ds_read_b64_tr_b16 a[142:143], v17 offset:10528
s_waitcnt lgkmcnt(0)
ds_read_b64_tr_b16 a[144:145], v17 offset:12288
ds_read_b64_tr_b16 a[146:147], v17 offset:12544
ds_read_b64_tr_b16 a[148:149], v17 offset:12320
ds_read_b64_tr_b16 a[150:151], v17 offset:12576
ds_read_b64_tr_b16 a[152:153], v17 offset:14336
ds_read_b64_tr_b16 a[154:155], v17 offset:14592
ds_read_b64_tr_b16 a[156:157], v17 offset:14368
ds_read_b64_tr_b16 a[158:159], v17 offset:14624
s_waitcnt lgkmcnt(0)
ds_read_b128 v[20:23], v8 offset:32768
ds_read_b128 v[24:27], v8 offset:34816
ds_read_b128 v[28:31], v9 offset:32768
ds_read_b128 v[32:35], v9 offset:34816
ds_read_b128 v[36:39], v8 offset:36864
ds_read_b128 v[40:43], v8 offset:38912
ds_read_b128 v[44:47], v9 offset:36864
ds_read_b128 v[48:51], v9 offset:38912
s_mov_b32 s44, 7340032
buffer_load_dword v250, v12, s[4:7], s44 offen
s_add_u32 m0, s45, 8192
s_mov_b32 s44, 7340032
buffer_load_dwordx4 v16, s[4:7], s44 offen lds
s_add_u32 m0, s45, 9216
s_mov_b32 s44, 7471104
buffer_load_dwordx4 v16, s[4:7], s44 offen lds
s_add_u32 m0, s45, 10240
s_mov_b32 s44, 7602176
buffer_load_dwordx4 v16, s[4:7], s44 offen lds
s_add_u32 m0, s45, 11264
s_mov_b32 s44, 7733248
buffer_load_dwordx4 v16, s[4:7], s44 offen lds
s_add_u32 m0, s45, 12288
s_mov_b32 s44, 7864320
buffer_load_dwordx4 v16, s[4:7], s44 offen lds
s_add_u32 m0, s45, 13312
s_mov_b32 s44, 7995392
buffer_load_dwordx4 v16, s[4:7], s44 offen lds
s_add_u32 m0, s45, 14336
s_mov_b32 s44, 8126464
buffer_load_dwordx4 v16, s[4:7], s44 offen lds
s_add_u32 m0, s45, 15360
s_mov_b32 s44, 8257536
buffer_load_dwordx4 v16, s[4:7], s44 offen lds
s_waitcnt lgkmcnt(0)
v_mfma_f32_16x16x32_bf16 v[52:55], v[20:23], a[128:131], v[52:55]
v_mfma_f32_16x16x32_bf16 v[56:59], v[20:23], a[132:135], v[56:59]
v_mfma_f32_16x16x32_bf16 v[60:63], v[24:27], a[128:131], v[60:63]
v_mfma_f32_16x16x32_bf16 v[64:67], v[24:27], a[132:135], v[64:67]
v_mfma_f32_16x16x32_bf16 v[52:55], v[28:31], a[136:139], v[52:55]
v_mfma_f32_16x16x32_bf16 v[56:59], v[28:31], a[140:143], v[56:59]
v_mfma_f32_16x16x32_bf16 v[60:63], v[32:35], a[136:139], v[60:63]
v_mfma_f32_16x16x32_bf16 v[64:67], v[32:35], a[140:143], v[64:67]
v_mfma_f32_16x16x32_bf16 v[52:55], v[36:39], a[144:147], v[52:55]
v_mfma_f32_16x16x32_bf16 v[56:59], v[36:39], a[148:151], v[56:59]
v_mfma_f32_16x16x32_bf16 v[60:63], v[40:43], a[144:147], v[60:63]
v_mfma_f32_16x16x32_bf16 v[64:67], v[40:43], a[148:151], v[64:67]
v_mfma_f32_16x16x32_bf16 v[52:55], v[44:47], a[152:155], v[52:55]
v_mfma_f32_16x16x32_bf16 v[56:59], v[44:47], a[156:159], v[56:59]
v_mfma_f32_16x16x32_bf16 v[60:63], v[48:51], a[152:155], v[60:63]
v_mfma_f32_16x16x32_bf16 v[64:67], v[48:51], a[156:159], v[64:67]
s_waitcnt vmcnt(18)
ds_read_b64_tr_b16 a[160:161], v17 offset:16384
ds_read_b64_tr_b16 a[162:163], v17 offset:16640
ds_read_b64_tr_b16 a[164:165], v17 offset:16416
ds_read_b64_tr_b16 a[166:167], v17 offset:16672
ds_read_b64_tr_b16 a[168:169], v17 offset:18432
ds_read_b64_tr_b16 a[170:171], v17 offset:18688
ds_read_b64_tr_b16 a[172:173], v17 offset:18464
ds_read_b64_tr_b16 a[174:175], v17 offset:18720
s_waitcnt lgkmcnt(0)
ds_read_b64_tr_b16 a[176:177], v17 offset:20480
ds_read_b64_tr_b16 a[178:179], v17 offset:20736
ds_read_b64_tr_b16 a[180:181], v17 offset:20512
ds_read_b64_tr_b16 a[182:183], v17 offset:20768
ds_read_b64_tr_b16 a[184:185], v17 offset:22528
ds_read_b64_tr_b16 a[186:187], v17 offset:22784
ds_read_b64_tr_b16 a[188:189], v17 offset:22560
ds_read_b64_tr_b16 a[190:191], v17 offset:22816
s_waitcnt lgkmcnt(0)
ds_read_b128 v[20:23], v8 offset:40960
ds_read_b128 v[24:27], v8 offset:43008
ds_read_b128 v[28:31], v9 offset:40960
ds_read_b128 v[32:35], v9 offset:43008
ds_read_b128 v[36:39], v8 offset:45056
ds_read_b128 v[40:43], v8 offset:47104
ds_read_b128 v[44:47], v9 offset:45056
ds_read_b128 v[48:51], v9 offset:47104
s_waitcnt lgkmcnt(0)
v_mfma_f32_16x16x32_bf16 v[52:55], v[20:23], a[160:163], v[52:55]
v_mfma_f32_16x16x32_bf16 v[56:59], v[20:23], a[164:167], v[56:59]
v_mfma_f32_16x16x32_bf16 v[60:63], v[24:27], a[160:163], v[60:63]
v_mfma_f32_16x16x32_bf16 v[64:67], v[24:27], a[164:167], v[64:67]
v_mfma_f32_16x16x32_bf16 v[52:55], v[28:31], a[168:171], v[52:55]
v_mfma_f32_16x16x32_bf16 v[56:59], v[28:31], a[172:175], v[56:59]
v_mfma_f32_16x16x32_bf16 v[60:63], v[32:35], a[168:171], v[60:63]
v_mfma_f32_16x16x32_bf16 v[64:67], v[32:35], a[172:175], v[64:67]
v_mfma_f32_16x16x32_bf16 v[52:55], v[36:39], a[176:179], v[52:55]
v_mfma_f32_16x16x32_bf16 v[56:59], v[36:39], a[180:183], v[56:59]
v_mfma_f32_16x16x32_bf16 v[60:63], v[40:43], a[176:179], v[60:63]
v_mfma_f32_16x16x32_bf16 v[64:67], v[40:43], a[180:183], v[64:67]
v_mfma_f32_16x16x32_bf16 v[52:55], v[44:47], a[184:187], v[52:55]
v_mfma_f32_16x16x32_bf16 v[56:59], v[44:47], a[188:191], v[56:59]
v_mfma_f32_16x16x32_bf16 v[60:63], v[48:51], a[184:187], v[60:63]
v_mfma_f32_16x16x32_bf16 v[64:67], v[48:51], a[188:191], v[64:67]
s_waitcnt vmcnt(9)
ds_read_b64_tr_b16 a[192:193], v17 offset:0
ds_read_b64_tr_b16 a[194:195], v17 offset:256
ds_read_b64_tr_b16 a[196:197], v17 offset:32
ds_read_b64_tr_b16 a[198:199], v17 offset:288
ds_read_b64_tr_b16 a[200:201], v17 offset:2048
ds_read_b64_tr_b16 a[202:203], v17 offset:2304
ds_read_b64_tr_b16 a[204:205], v17 offset:2080
ds_read_b64_tr_b16 a[206:207], v17 offset:2336
s_waitcnt lgkmcnt(0)
ds_read_b64_tr_b16 a[208:209], v17 offset:4096
ds_read_b64_tr_b16 a[210:211], v17 offset:4352
ds_read_b64_tr_b16 a[212:213], v17 offset:4128
ds_read_b64_tr_b16 a[214:215], v17 offset:4384
ds_read_b64_tr_b16 a[216:217], v17 offset:6144
ds_read_b64_tr_b16 a[218:219], v17 offset:6400
ds_read_b64_tr_b16 a[220:221], v17 offset:6176
ds_read_b64_tr_b16 a[222:223], v17 offset:6432
s_waitcnt lgkmcnt(0)
ds_read_b128 v[20:23], v8 offset:49152
ds_read_b128 v[24:27], v8 offset:51200
ds_read_b128 v[28:31], v9 offset:49152
ds_read_b128 v[32:35], v9 offset:51200
ds_read_b128 v[36:39], v8 offset:53248
ds_read_b128 v[40:43], v8 offset:55296
ds_read_b128 v[44:47], v9 offset:53248
ds_read_b128 v[48:51], v9 offset:55296
s_waitcnt lgkmcnt(0)
v_mfma_f32_16x16x32_bf16 v[52:55], v[20:23], a[192:195], v[52:55]
v_mfma_f32_16x16x32_bf16 v[56:59], v[20:23], a[196:199], v[56:59]
v_mfma_f32_16x16x32_bf16 v[60:63], v[24:27], a[192:195], v[60:63]
v_mfma_f32_16x16x32_bf16 v[64:67], v[24:27], a[196:199], v[64:67]
v_mfma_f32_16x16x32_bf16 v[52:55], v[28:31], a[200:203], v[52:55]
v_mfma_f32_16x16x32_bf16 v[56:59], v[28:31], a[204:207], v[56:59]
v_mfma_f32_16x16x32_bf16 v[60:63], v[32:35], a[200:203], v[60:63]
v_mfma_f32_16x16x32_bf16 v[64:67], v[32:35], a[204:207], v[64:67]
v_mfma_f32_16x16x32_bf16 v[52:55], v[36:39], a[208:211], v[52:55]
v_mfma_f32_16x16x32_bf16 v[56:59], v[36:39], a[212:215], v[56:59]
v_mfma_f32_16x16x32_bf16 v[60:63], v[40:43], a[208:211], v[60:63]
v_mfma_f32_16x16x32_bf16 v[64:67], v[40:43], a[212:215], v[64:67]
v_mfma_f32_16x16x32_bf16 v[52:55], v[44:47], a[216:219], v[52:55]
v_mfma_f32_16x16x32_bf16 v[56:59], v[44:47], a[220:223], v[56:59]
v_mfma_f32_16x16x32_bf16 v[60:63], v[48:51], a[216:219], v[60:63]
v_mfma_f32_16x16x32_bf16 v[64:67], v[48:51], a[220:223], v[64:67]
s_waitcnt vmcnt(0)
ds_read_b64_tr_b16 a[224:225], v17 offset:8192
ds_read_b64_tr_b16 a[226:227], v17 offset:8448
ds_read_b64_tr_b16 a[228:229], v17 offset:8224
ds_read_b64_tr_b16 a[230:231], v17 offset:8480
ds_read_b64_tr_b16 a[232:233], v17 offset:10240
ds_read_b64_tr_b16 a[234:235], v17 offset:10496
ds_read_b64_tr_b16 a[236:237], v17 offset:10272
ds_read_b64_tr_b16 a[238:239], v17 offset:10528
s_waitcnt lgkmcnt(0)
ds_read_b64_tr_b16 a[240:241], v17 offset:12288
ds_read_b64_tr_b16 a[242:243], v17 offset:12544
ds_read_b64_tr_b16 a[244:245], v17 offset:12320
ds_read_b64_tr_b16 a[246:247], v17 offset:12576
ds_read_b64_tr_b16 a[248:249], v17 offset:14336
ds_read_b64_tr_b16 a[250:251], v17 offset:14592
ds_read_b64_tr_b16 a[252:253], v17 offset:14368
ds_read_b64_tr_b16 a[254:255], v17 offset:14624
s_waitcnt lgkmcnt(0)
ds_read_b128 v[20:23], v8 offset:57344
ds_read_b128 v[24:27], v8 offset:59392
ds_read_b128 v[28:31], v9 offset:57344
ds_read_b128 v[32:35], v9 offset:59392
ds_read_b128 v[36:39], v8 offset:61440
ds_read_b128 v[40:43], v8 offset:63488
ds_read_b128 v[44:47], v9 offset:61440
ds_read_b128 v[48:51], v9 offset:63488
s_waitcnt lgkmcnt(0)
v_mfma_f32_16x16x32_bf16 v[52:55], v[20:23], a[224:227], v[52:55]
v_mfma_f32_16x16x32_bf16 v[56:59], v[20:23], a[228:231], v[56:59]
v_mfma_f32_16x16x32_bf16 v[60:63], v[24:27], a[224:227], v[60:63]
v_mfma_f32_16x16x32_bf16 v[64:67], v[24:27], a[228:231], v[64:67]
v_mfma_f32_16x16x32_bf16 v[52:55], v[28:31], a[232:235], v[52:55]
v_mfma_f32_16x16x32_bf16 v[56:59], v[28:31], a[236:239], v[56:59]
v_mfma_f32_16x16x32_bf16 v[60:63], v[32:35], a[232:235], v[60:63]
v_mfma_f32_16x16x32_bf16 v[64:67], v[32:35], a[236:239], v[64:67]
v_mfma_f32_16x16x32_bf16 v[52:55], v[36:39], a[240:243], v[52:55]
v_mfma_f32_16x16x32_bf16 v[56:59], v[36:39], a[244:247], v[56:59]
v_mfma_f32_16x16x32_bf16 v[60:63], v[40:43], a[240:243], v[60:63]
v_mfma_f32_16x16x32_bf16 v[64:67], v[40:43], a[244:247], v[64:67]
v_mfma_f32_16x16x32_bf16 v[52:55], v[44:47], a[248:251], v[52:55]
v_mfma_f32_16x16x32_bf16 v[56:59], v[44:47], a[252:255], v[56:59]
v_mfma_f32_16x16x32_bf16 v[60:63], v[48:51], a[248:251], v[60:63]
v_mfma_f32_16x16x32_bf16 v[64:67], v[48:51], a[252:255], v[64:67]
s_barrier
s_mov_b32 s50, 0x10000
s_add_u32 m0, s46, 65536
s_nop 0
buffer_load_dwordx4 v6, s[8:11], s50 offen offset:0 lds
s_add_u32 m0, s46, 69504
s_nop 0
buffer_load_dwordx4 v6, s[8:11], s50 offen offset:128 lds
s_add_u32 m0, s46, 73472
s_nop 0
buffer_load_dwordx4 v6, s[8:11], s50 offen offset:256 lds
s_add_u32 m0, s46, 77440
s_nop 0
buffer_load_dwordx4 v6, s[8:11], s50 offen offset:384 lds
s_add_u32 m0, s46, 81408
s_nop 0
buffer_load_dwordx4 v6, s[8:11], s50 offen offset:512 lds
s_add_u32 m0, s46, 85376
s_nop 0
buffer_load_dwordx4 v6, s[8:11], s50 offen offset:640 lds
s_add_u32 m0, s46, 89344
s_nop 0
buffer_load_dwordx4 v6, s[8:11], s50 offen offset:768 lds
s_add_u32 m0, s46, 93312
s_nop 0
buffer_load_dwordx4 v6, s[8:11], s50 offen offset:896 lds
s_add_u32 m0, s46, 97280
s_nop 0
buffer_load_dwordx4 v6, s[8:11], s50 offen offset:1024 lds
s_add_u32 m0, s46, 101248
s_nop 0
buffer_load_dwordx4 v6, s[8:11], s50 offen offset:1152 lds
s_add_u32 m0, s46, 105216
s_nop 0
buffer_load_dwordx4 v6, s[8:11], s50 offen offset:1280 lds
s_add_u32 m0, s46, 109184
s_nop 0
buffer_load_dwordx4 v6, s[8:11], s50 offen offset:1408 lds
s_add_u32 m0, s46, 113152
s_nop 0
buffer_load_dwordx4 v6, s[8:11], s50 offen offset:1536 lds
s_add_u32 m0, s46, 117120
s_nop 0
buffer_load_dwordx4 v6, s[8:11], s50 offen offset:1664 lds
s_add_u32 m0, s46, 121088
s_nop 0
buffer_load_dwordx4 v6, s[8:11], s50 offen offset:1792 lds
s_add_u32 m0, s46, 125056
s_nop 0
buffer_load_dwordx4 v6, s[8:11], s50 offen offset:1920 lds
s_and_b32 s53, s47, 31
s_lshl_b32 s53, s53, 4
v_add_u32 v19, s53, v1
v_lshlrev_b32 v19, 7, v19
s_mov_b32 s42, 1
v_and_b32 v3, 15, v0
v_lshlrev_b32 v3, 4, v3
s_branch mega_kernel_syv
mega_kernel_syvw:
s_sleep 4
mega_kernel_syv:
buffer_load_dword v2, v3, s[72:75], 0 offen sc1
s_waitcnt vmcnt(0)
s_cmp_eq_u32 s95, 1
s_cbranch_scc0 mega_kernel_syvf
v_readlane_b32 s76, v2, 14
s_mov_b32 s98, 0
s_cmp_eq_u32 s76, 64
s_cbranch_scc0 mega_kernel_syvw
s_branch mega_kernel_syvd
mega_kernel_syvf:
s_mov_b32 s77, 0
s_mov_b32 s78, 0
v_readlane_b32 s76, v2, 0
s_add_u32 s77, s77, s76
s_xor_b32 s76, s76, 32
s_or_b32 s78, s78, s76
v_readlane_b32 s76, v2, 1
s_add_u32 s77, s77, s76
s_xor_b32 s76, s76, 32
s_or_b32 s78, s78, s76
v_readlane_b32 s76, v2, 2
s_add_u32 s77, s77, s76
s_xor_b32 s76, s76, 32
s_or_b32 s78, s78, s76
v_readlane_b32 s76, v2, 3
s_add_u32 s77, s77, s76
s_xor_b32 s76, s76, 32
s_or_b32 s78, s78, s76
v_readlane_b32 s76, v2, 4
s_add_u32 s77, s77, s76
s_xor_b32 s76, s76, 32
s_or_b32 s78, s78, s76
v_readlane_b32 s76, v2, 5
s_add_u32 s77, s77, s76
s_xor_b32 s76, s76, 32
s_or_b32 s78, s78, s76
v_readlane_b32 s76, v2, 6
s_add_u32 s77, s77, s76
s_xor_b32 s76, s76, 32
s_or_b32 s78, s78, s76
v_readlane_b32 s76, v2, 7
s_add_u32 s77, s77, s76
s_xor_b32 s76, s76, 32
s_or_b32 s78, s78, s76
s_cmp_eq_u32 s77, 256
s_cbranch_scc0 mega_kernel_syvw
v_mov_b32 v252, v2
s_cmp_eq_u32 s78, 0
s_cbranch_scc0 mega_kernel_slowent
v_readlane_b32 s76, v2, 10
v_readlane_b32 s77, v2, 8
s_cmp_eq_u32 s76, 64
s_cbranch_scc0 mega_kernel_syvw
s_cmp_gt_u32 s77, 32
s_cselect_b32 s98, 1, 0
mega_kernel_syvd:
s_lshr_b32 s44, s47, 3
s_xor_b32 s44, s44, s98
s_and_b32 s44, s44, 1
s_lshl_b32 s44, s44, 13
s_lshl_b32 s48, s47, 18
s_add_u32 s48, s48, s44
s_add_u32 s48, s48, 33554432
s_xor_b32 s44, s98, 1
s_lshl_b32 s44, s44, 13
s_lshl_b32 s49, s40, 7
s_add_u32 s49, s49, s44
s_lshl_b32 s44, s41, 2
s_add_u32 s49, s49, s44
s_add_u32 s49, s49, 69210112
v_mov_b32 v16, 0
v_cvt_pk_bf16_f32 v84, v52, v53
v_cvt_pk_bf16_f32 v85, v54, v55
v_cvt_pk_bf16_f32 v86, v60, v61
v_cvt_pk_bf16_f32 v87, v62, v63
v_cvt_pk_bf16_f32 v88, v56, v57
v_cvt_pk_bf16_f32 v89, v58, v59
v_cvt_pk_bf16_f32 v90, v64, v65
v_cvt_pk_bf16_f32 v91, v66, v67
s_add_u32 s51, s42, s47
s_sub_u32 s51, s51, 1
s_bfe_u32 s52, s51, 0x40002
s_lshl_b32 s52, s52, 14
s_and_b32 s51, s51, 3
s_lshl_b32 s51, s51, 11
s_add_u32 s51, s51, s52
s_add_u32 s51, s51, s48
buffer_store_dwordx4 v[84:87], v7, s[84:87], s51 offen sc1
buffer_store_dwordx4 v[88:91], v7, s[84:87], s51 offen offset:1024 sc1
s_waitcnt vmcnt(0)
v_mov_b32 v17, s42
s_mov_b64 exec, 1
buffer_store_dword v17, v16, s[84:87], s49 offen sc1
s_mov_b64 exec, -1
mega_kernel_v_loop:
s_waitcnt vmcnt(2)
s_barrier
s_add_u32 s50, s42, 1
s_min_u32 s50, s50, 63
s_lshl_b32 s50, s50, 16
ds_read_b128 v[20:23], v10 offset:0
ds_read_b128 v[24:27], v10 offset:2048
ds_read_b128 v[28:31], v11 offset:0
ds_read_b128 v[32:35], v11 offset:2048
ds_read_b128 v[36:39], v10 offset:4096
ds_read_b128 v[40:43], v10 offset:6144
s_waitcnt lgkmcnt(4)
v_mfma_f32_16x16x32_bf16 v[68:71], v[20:23], a[0:3], 0
ds_read_b128 v[44:47], v11 offset:4096
v_mfma_f32_16x16x32_bf16 v[72:75], v[20:23], a[4:7], 0
v_cvt_pk_bf16_f32 v84, v52, v53
v_cvt_pk_bf16_f32 v85, v54, v55
v_cvt_pk_bf16_f32 v86, v60, v61
v_mfma_f32_16x16x32_bf16 v[76:79], v[24:27], a[0:3], 0
ds_read_b128 v[48:51], v11 offset:6144
v_mfma_f32_16x16x32_bf16 v[80:83], v[24:27], a[4:7], 0
v_cvt_pk_bf16_f32 v87, v62, v63
v_cvt_pk_bf16_f32 v88, v56, v57
v_cvt_pk_bf16_f32 v89, v58, v59
s_waitcnt lgkmcnt(4)
v_mfma_f32_16x16x32_bf16 v[68:71], v[28:31], a[8:11], v[68:71]
ds_read_b128 v[20:23], v10 offset:8192
v_mfma_f32_16x16x32_bf16 v[72:75], v[28:31], a[12:15], v[72:75]
v_cvt_pk_bf16_f32 v90, v64, v65
v_cvt_pk_bf16_f32 v91, v66, v67
v_mfma_f32_16x16x32_bf16 v[76:79], v[32:35], a[8:11], v[76:79]
ds_read_b128 v[24:27], v10 offset:10240
v_mfma_f32_16x16x32_bf16 v[80:83], v[32:35], a[12:15], v[80:83]
s_add_u32 s51, s42, s47
s_sub_u32 s51, s51, 1
s_bfe_u32 s52, s51, 0x40002
s_lshl_b32 s52, s52, 14
s_waitcnt lgkmcnt(4)
v_mfma_f32_16x16x32_bf16 v[68:71], v[36:39], a[16:19], v[68:71]
ds_read_b128 v[28:31], v11 offset:8192
v_mfma_f32_16x16x32_bf16 v[72:75], v[36:39], a[20:23], v[72:75]
s_and_b32 s51, s51, 3
s_lshl_b32 s51, s51, 11
s_add_u32 s51, s51, s52
s_add_u32 s51, s51, s48
buffer_store_dwordx4 v[84:87], v7, s[84:87], s51 offen sc1
v_mfma_f32_16x16x32_bf16 v[76:79], v[40:43], a[16:19], v[76:79]
ds_read_b128 v[32:35], v11 offset:10240
v_mfma_f32_16x16x32_bf16 v[80:83], v[40:43], a[20:23], v[80:83]
buffer_store_dwordx4 v[88:91], v7, s[84:87], s51 offen offset:1024 sc1
s_waitcnt lgkmcnt(4)
v_mfma_f32_16x16x32_bf16 v[68:71], v[44:47], a[24:27], v[68:71]
ds_read_b128 v[36:39], v10 offset:12288
v_mfma_f32_16x16x32_bf16 v[72:75], v[44:47], a[28:31], v[72:75]
s_add_u32 m0, s46, 0
v_mfma_f32_16x16x32_bf16 v[76:79], v[48:51], a[24:27], v[76:79]
ds_read_b128 v[40:43], v10 offset:14336
v_mfma_f32_16x16x32_bf16 v[80:83], v[48:51], a[28:31], v[80:83]
buffer_load_dwordx4 v6, s[8:11], s50 offen offset:0 lds
s_waitcnt lgkmcnt(4)
v_mfma_f32_16x16x32_bf16 v[68:71], v[20:23], a[32:35], v[68:71]
ds_read_b128 v[44:47], v11 offset:12288
v_mfma_f32_16x16x32_bf16 v[72:75], v[20:23], a[36:39], v[72:75]
s_add_u32 m0, s46, 3968
v_mfma_f32_16x16x32_bf16 v[76:79], v[24:27], a[32:35], v[76:79]
ds_read_b128 v[48:51], v11 offset:14336
v_mfma_f32_16x16x32_bf16 v[80:83], v[24:27], a[36:39], v[80:83]
buffer_load_dwordx4 v6, s[8:11], s50 offen offset:128 lds
s_waitcnt lgkmcnt(4)
v_mfma_f32_16x16x32_bf16 v[68:71], v[28:31], a[40:43], v[68:71]
ds_read_b128 v[20:23], v10 offset:16384
v_mfma_f32_16x16x32_bf16 v[72:75], v[28:31], a[44:47], v[72:75]
s_add_u32 m0, s46, 7936
v_mfma_f32_16x16x32_bf16 v[76:79], v[32:35], a[40:43], v[76:79]
ds_read_b128 v[24:27], v10 offset:18432
v_mfma_f32_16x16x32_bf16 v[80:83], v[32:35], a[44:47], v[80:83]
buffer_load_dwordx4 v6, s[8:11], s50 offen offset:256 lds
s_waitcnt lgkmcnt(4)
v_mfma_f32_16x16x32_bf16 v[68:71], v[36:39], a[48:51], v[68:71]
ds_read_b128 v[28:31], v11 offset:16384
v_mfma_f32_16x16x32_bf16 v[72:75], v[36:39], a[52:55], v[72:75]
s_add_u32 m0, s46, 11904
v_mfma_f32_16x16x32_bf16 v[76:79], v[40:43], a[48:51], v[76:79]
ds_read_b128 v[32:35], v11 offset:18432
v_mfma_f32_16x16x32_bf16 v[80:83], v[40:43], a[52:55], v[80:83]
buffer_load_dwordx4 v6, s[8:11], s50 offen offset:384 lds
s_waitcnt lgkmcnt(4)
v_mfma_f32_16x16x32_bf16 v[68:71], v[44:47], a[56:59], v[68:71]
ds_read_b128 v[36:39], v10 offset:20480
v_mfma_f32_16x16x32_bf16 v[72:75], v[44:47], a[60:63], v[72:75]
s_add_u32 m0, s46, 15872
v_mfma_f32_16x16x32_bf16 v[76:79], v[48:51], a[56:59], v[76:79]
ds_read_b128 v[40:43], v10 offset:22528
v_mfma_f32_16x16x32_bf16 v[80:83], v[48:51], a[60:63], v[80:83]
buffer_load_dwordx4 v6, s[8:11], s50 offen offset:512 lds
s_waitcnt lgkmcnt(4)
v_mfma_f32_16x16x32_bf16 v[68:71], v[20:23], a[64:67], v[68:71]
ds_read_b128 v[44:47], v11 offset:20480
v_mfma_f32_16x16x32_bf16 v[72:75], v[20:23], a[68:71], v[72:75]
s_add_u32 m0, s46, 19840
v_mfma_f32_16x16x32_bf16 v[76:79], v[24:27], a[64:67], v[76:79]
ds_read_b128 v[48:51], v11 offset:22528
v_mfma_f32_16x16x32_bf16 v[80:83], v[24:27], a[68:71], v[80:83]
buffer_load_dwordx4 v6, s[8:11], s50 offen offset:640 lds
s_waitcnt lgkmcnt(4)
v_mfma_f32_16x16x32_bf16 v[68:71], v[28:31], a[72:75], v[68:71]
ds_read_b128 v[20:23], v10 offset:24576
v_mfma_f32_16x16x32_bf16 v[72:75], v[28:31], a[76:79], v[72:75]
s_add_u32 m0, s46, 23808
v_mfma_f32_16x16x32_bf16 v[76:79], v[32:35], a[72:75], v[76:79]
ds_read_b128 v[24:27], v10 offset:26624
v_mfma_f32_16x16x32_bf16 v[80:83], v[32:35], a[76:79], v[80:83]
buffer_load_dwordx4 v6, s[8:11], s50 offen offset:768 lds
s_waitcnt lgkmcnt(4)
v_mfma_f32_16x16x32_bf16 v[68:71], v[36:39], a[80:83], v[68:71]
ds_read_b128 v[28:31], v11 offset:24576
v_mfma_f32_16x16x32_bf16 v[72:75], v[36:39], a[84:87], v[72:75]
s_add_u32 m0, s46, 27776
v_mfma_f32_16x16x32_bf16 v[76:79], v[40:43], a[80:83], v[76:79]
ds_read_b128 v[32:35], v11 offset:26624
v_mfma_f32_16x16x32_bf16 v[80:83], v[40:43], a[84:87], v[80:83]
buffer_load_dwordx4 v6, s[8:11], s50 offen offset:896 lds
s_waitcnt lgkmcnt(4)
v_mfma_f32_16x16x32_bf16 v[68:71], v[44:47], a[88:91], v[68:71]
ds_read_b128 v[36:39], v10 offset:28672
v_mfma_f32_16x16x32_bf16 v[72:75], v[44:47], a[92:95], v[72:75]
s_add_u32 m0, s46, 31744
v_mfma_f32_16x16x32_bf16 v[76:79], v[48:51], a[88:91], v[76:79]
ds_read_b128 v[40:43], v10 offset:30720
v_mfma_f32_16x16x32_bf16 v[80:83], v[48:51], a[92:95], v[80:83]
buffer_load_dwordx4 v6, s[8:11], s50 offen offset:1024 lds
s_waitcnt lgkmcnt(4)
v_mfma_f32_16x16x32_bf16 v[68:71], v[20:23], a[96:99], v[68:71]
ds_read_b128 v[44:47], v11 offset:28672
v_mfma_f32_16x16x32_bf16 v[72:75], v[20:23], a[100:103], v[72:75]
s_add_u32 m0, s46, 35712
v_mfma_f32_16x16x32_bf16 v[76:79], v[24:27], a[96:99], v[76:79]
ds_read_b128 v[48:51], v11 offset:30720
v_mfma_f32_16x16x32_bf16 v[80:83], v[24:27], a[100:103], v[80:83]
buffer_load_dwordx4 v6, s[8:11], s50 offen offset:1152 lds
s_waitcnt lgkmcnt(4)
v_mfma_f32_16x16x32_bf16 v[68:71], v[28:31], a[104:107], v[68:71]
ds_read_b128 v[20:23], v10 offset:32768
v_mfma_f32_16x16x32_bf16 v[72:75], v[28:31], a[108:111], v[72:75]
s_add_u32 m0, s46, 39680
v_mfma_f32_16x16x32_bf16 v[76:79], v[32:35], a[104:107], v[76:79]
ds_read_b128 v[24:27], v10 offset:34816
v_mfma_f32_16x16x32_bf16 v[80:83], v[32:35], a[108:111], v[80:83]
buffer_load_dwordx4 v6, s[8:11], s50 offen offset:1280 lds
s_waitcnt lgkmcnt(4)
v_mfma_f32_16x16x32_bf16 v[68:71], v[36:39], a[112:115], v[68:71]
ds_read_b128 v[28:31], v11 offset:32768
v_mfma_f32_16x16x32_bf16 v[72:75], v[36:39], a[116:119], v[72:75]
s_add_u32 m0, s46, 43648
v_mfma_f32_16x16x32_bf16 v[76:79], v[40:43], a[112:115], v[76:79]
ds_read_b128 v[32:35], v11 offset:34816
v_mfma_f32_16x16x32_bf16 v[80:83], v[40:43], a[116:119], v[80:83]
buffer_load_dwordx4 v6, s[8:11], s50 offen offset:1408 lds
s_waitcnt lgkmcnt(4)
v_mfma_f32_16x16x32_bf16 v[68:71], v[44:47], a[120:123], v[68:71]
ds_read_b128 v[36:39], v10 offset:36864
v_mfma_f32_16x16x32_bf16 v[72:75], v[44:47], a[124:127], v[72:75]
s_add_u32 m0, s46, 47616
v_mfma_f32_16x16x32_bf16 v[76:79], v[48:51], a[120:123], v[76:79]
ds_read_b128 v[40:43], v10 offset:38912
v_mfma_f32_16x16x32_bf16 v[80:83], v[48:51], a[124:127], v[80:83]
buffer_load_dwordx4 v6, s[8:11], s50 offen offset:1536 lds
s_waitcnt lgkmcnt(4)
v_mfma_f32_16x16x32_bf16 v[68:71], v[20:23], a[128:131], v[68:71]
ds_read_b128 v[44:47], v11 offset:36864
v_mfma_f32_16x16x32_bf16 v[72:75], v[20:23], a[132:135], v[72:75]
s_add_u32 m0, s46, 51584
v_mfma_f32_16x16x32_bf16 v[76:79], v[24:27], a[128:131], v[76:79]
ds_read_b128 v[48:51], v11 offset:38912
v_mfma_f32_16x16x32_bf16 v[80:83], v[24:27], a[132:135], v[80:83]
buffer_load_dwordx4 v6, s[8:11], s50 offen offset:1664 lds
s_waitcnt lgkmcnt(4)
v_mfma_f32_16x16x32_bf16 v[68:71], v[28:31], a[136:139], v[68:71]
ds_read_b128 v[20:23], v10 offset:40960
v_mfma_f32_16x16x32_bf16 v[72:75], v[28:31], a[140:143], v[72:75]
s_add_u32 m0, s46, 55552
v_mfma_f32_16x16x32_bf16 v[76:79], v[32:35], a[136:139], v[76:79]
ds_read_b128 v[24:27], v10 offset:43008
v_mfma_f32_16x16x32_bf16 v[80:83], v[32:35], a[140:143], v[80:83]
buffer_load_dwordx4 v6, s[8:11], s50 offen offset:1792 lds
s_waitcnt lgkmcnt(4)
v_mfma_f32_16x16x32_bf16 v[68:71], v[36:39], a[144:147], v[68:71]
ds_read_b128 v[28:31], v11 offset:40960
v_mfma_f32_16x16x32_bf16 v[72:75], v[36:39], a[148:151], v[72:75]
s_add_u32 m0, s46, 59520
v_mfma_f32_16x16x32_bf16 v[76:79], v[40:43], a[144:147], v[76:79]
ds_read_b128 v[32:35], v11 offset:43008
v_mfma_f32_16x16x32_bf16 v[80:83], v[40:43], a[148:151], v[80:83]
buffer_load_dwordx4 v6, s[8:11], s50 offen offset:1920 lds
s_waitcnt lgkmcnt(4)
v_mfma_f32_16x16x32_bf16 v[68:71], v[44:47], a[152:155], v[68:71]
ds_read_b128 v[36:39], v10 offset:45056
v_mfma_f32_16x16x32_bf16 v[72:75], v[44:47], a[156:159], v[72:75]
v_mfma_f32_16x16x32_bf16 v[76:79], v[48:51], a[152:155], v[76:79]
ds_read_b128 v[40:43], v10 offset:47104
v_mfma_f32_16x16x32_bf16 v[80:83], v[48:51], a[156:159], v[80:83]
s_waitcnt lgkmcnt(4)
v_mfma_f32_16x16x32_bf16 v[68:71], v[20:23], a[160:163], v[68:71]
ds_read_b128 v[44:47], v11 offset:45056
v_mfma_f32_16x16x32_bf16 v[72:75], v[20:23], a[164:167], v[72:75]
v_mfma_f32_16x16x32_bf16 v[76:79], v[24:27], a[160:163], v[76:79]
ds_read_b128 v[48:51], v11 offset:47104
v_mfma_f32_16x16x32_bf16 v[80:83], v[24:27], a[164:167], v[80:83]
s_waitcnt lgkmcnt(4)
v_mfma_f32_16x16x32_bf16 v[68:71], v[28:31], a[168:171], v[68:71]
ds_read_b128 v[20:23], v10 offset:49152
v_mfma_f32_16x16x32_bf16 v[72:75], v[28:31], a[172:175], v[72:75]
s_waitcnt vmcnt(16)
v_mov_b32 v17, s42
s_mov_b64 exec, 1
buffer_store_dword v17, v16, s[84:87], s49 offen sc1
s_mov_b64 exec, -1
v_mfma_f32_16x16x32_bf16 v[76:79], v[32:35], a[168:171], v[76:79]
ds_read_b128 v[24:27], v10 offset:51200
v_mfma_f32_16x16x32_bf16 v[80:83], v[32:35], a[172:175], v[80:83]
s_waitcnt lgkmcnt(4)
v_mfma_f32_16x16x32_bf16 v[68:71], v[36:39], a[176:179], v[68:71]
ds_read_b128 v[28:31], v11 offset:49152
v_mfma_f32_16x16x32_bf16 v[72:75], v[36:39], a[180:183], v[72:75]
s_add_u32 s53, s42, 3
s_min_u32 s53, s53, 63
s_lshl_b32 s53, s53, 16
s_mov_b64 exec, 0xffff
buffer_load_dword v250, v19, s[8:11], s53 offen
s_mov_b64 exec, -1
v_mfma_f32_16x16x32_bf16 v[76:79], v[40:43], a[176:179], v[76:79]
ds_read_b128 v[32:35], v11 offset:51200
v_mfma_f32_16x16x32_bf16 v[80:83], v[40:43], a[180:183], v[80:83]
s_waitcnt lgkmcnt(4)
v_mfma_f32_16x16x32_bf16 v[68:71], v[44:47], a[184:187], v[68:71]
ds_read_b128 v[36:39], v10 offset:53248
v_mfma_f32_16x16x32_bf16 v[72:75], v[44:47], a[188:191], v[72:75]
v_mfma_f32_16x16x32_bf16 v[76:79], v[48:51], a[184:187], v[76:79]
ds_read_b128 v[40:43], v10 offset:55296
v_mfma_f32_16x16x32_bf16 v[80:83], v[48:51], a[188:191], v[80:83]
s_waitcnt lgkmcnt(4)
v_mfma_f32_16x16x32_bf16 v[68:71], v[20:23], a[192:195], v[68:71]
ds_read_b128 v[44:47], v11 offset:53248
v_mfma_f32_16x16x32_bf16 v[72:75], v[20:23], a[196:199], v[72:75]
v_mfma_f32_16x16x32_bf16 v[76:79], v[24:27], a[192:195], v[76:79]
ds_read_b128 v[48:51], v11 offset:55296
v_mfma_f32_16x16x32_bf16 v[80:83], v[24:27], a[196:199], v[80:83]
s_waitcnt lgkmcnt(4)
v_mfma_f32_16x16x32_bf16 v[68:71], v[28:31], a[200:203], v[68:71]
ds_read_b128 v[20:23], v10 offset:57344
v_mfma_f32_16x16x32_bf16 v[72:75], v[28:31], a[204:207], v[72:75]
v_mfma_f32_16x16x32_bf16 v[76:79], v[32:35], a[200:203], v[76:79]
ds_read_b128 v[24:27], v10 offset:59392
v_mfma_f32_16x16x32_bf16 v[80:83], v[32:35], a[204:207], v[80:83]
s_waitcnt lgkmcnt(4)
v_mfma_f32_16x16x32_bf16 v[68:71], v[36:39], a[208:211], v[68:71]
ds_read_b128 v[28:31], v11 offset:57344
v_mfma_f32_16x16x32_bf16 v[72:75], v[36:39], a[212:215], v[72:75]
v_mfma_f32_16x16x32_bf16 v[76:79], v[40:43], a[208:211], v[76:79]
ds_read_b128 v[32:35], v11 offset:59392
v_mfma_f32_16x16x32_bf16 v[80:83], v[40:43], a[212:215], v[80:83]
s_waitcnt lgkmcnt(4)
v_mfma_f32_16x16x32_bf16 v[68:71], v[44:47], a[216:219], v[68:71]
ds_read_b128 v[36:39], v10 offset:61440
v_mfma_f32_16x16x32_bf16 v[72:75], v[44:47], a[220:223], v[72:75]
v_mfma_f32_16x16x32_bf16 v[76:79], v[48:51], a[216:219], v[76:79]
ds_read_b128 v[40:43], v10 offset:63488
v_mfma_f32_16x16x32_bf16 v[80:83], v[48:51], a[220:223], v[80:83]
s_waitcnt lgkmcnt(4)
v_mfma_f32_16x16x32_bf16 v[68:71], v[20:23], a[224:227], v[68:71]
ds_read_b128 v[44:47], v11 offset:61440
v_mfma_f32_16x16x32_bf16 v[72:75], v[20:23], a[228:231], v[72:75]
v_mfma_f32_16x16x32_bf16 v[76:79], v[24:27], a[224:227], v[76:79]
ds_read_b128 v[48:51], v11 offset:63488
v_mfma_f32_16x16x32_bf16 v[80:83], v[24:27], a[228:231], v[80:83]
s_waitcnt lgkmcnt(5)
v_mfma_f32_16x16x32_bf16 v[68:71], v[28:31], a[232:235], v[68:71]
v_mfma_f32_16x16x32_bf16 v[72:75], v[28:31], a[236:239], v[72:75]
s_waitcnt lgkmcnt(4)
v_mfma_f32_16x16x32_bf16 v[76:79], v[32:35], a[232:235], v[76:79]
v_mfma_f32_16x16x32_bf16 v[80:83], v[32:35], a[236:239], v[80:83]
s_waitcnt lgkmcnt(3)
v_mfma_f32_16x16x32_bf16 v[68:71], v[36:39], a[240:243], v[68:71]
v_mfma_f32_16x16x32_bf16 v[72:75], v[36:39], a[244:247], v[72:75]
s_waitcnt lgkmcnt(2)
v_mfma_f32_16x16x32_bf16 v[76:79], v[40:43], a[240:243], v[76:79]
v_mfma_f32_16x16x32_bf16 v[80:83], v[40:43], a[244:247], v[80:83]
s_waitcnt lgkmcnt(1)
v_mfma_f32_16x16x32_bf16 v[68:71], v[44:47], a[248:251], v[68:71]
v_mfma_f32_16x16x32_bf16 v[72:75], v[44:47], a[252:255], v[72:75]
s_waitcnt lgkmcnt(0)
v_mfma_f32_16x16x32_bf16 v[76:79], v[48:51], a[248:251], v[76:79]
v_mfma_f32_16x16x32_bf16 v[80:83], v[48:51], a[252:255], v[80:83]
s_add_u32 s42, s42, 1
s_cmp_eq_u32 s42, 64
s_cbranch_scc1 mega_kernel_v_fin
s_waitcnt vmcnt(2)
s_barrier
s_add_u32 s50, s42, 1
s_min_u32 s50, s50, 63
s_lshl_b32 s50, s50, 16
ds_read_b128 v[20:23], v8 offset:0
ds_read_b128 v[24:27], v8 offset:2048
ds_read_b128 v[28:31], v9 offset:0
ds_read_b128 v[32:35], v9 offset:2048
ds_read_b128 v[36:39], v8 offset:4096
ds_read_b128 v[40:43], v8 offset:6144
s_waitcnt lgkmcnt(4)
v_mfma_f32_16x16x32_bf16 v[52:55], v[20:23], a[0:3], 0
ds_read_b128 v[44:47], v9 offset:4096
v_mfma_f32_16x16x32_bf16 v[56:59], v[20:23], a[4:7], 0
v_cvt_pk_bf16_f32 v84, v68, v69
v_cvt_pk_bf16_f32 v85, v70, v71
v_cvt_pk_bf16_f32 v86, v76, v77
v_mfma_f32_16x16x32_bf16 v[60:63], v[24:27], a[0:3], 0
ds_read_b128 v[48:51], v9 offset:6144
v_mfma_f32_16x16x32_bf16 v[64:67], v[24:27], a[4:7], 0
v_cvt_pk_bf16_f32 v87, v78, v79
v_cvt_pk_bf16_f32 v88, v72, v73
v_cvt_pk_bf16_f32 v89, v74, v75
s_waitcnt lgkmcnt(4)
v_mfma_f32_16x16x32_bf16 v[52:55], v[28:31], a[8:11], v[52:55]
ds_read_b128 v[20:23], v8 offset:8192
v_mfma_f32_16x16x32_bf16 v[56:59], v[28:31], a[12:15], v[56:59]
v_cvt_pk_bf16_f32 v90, v80, v81
v_cvt_pk_bf16_f32 v91, v82, v83
v_mfma_f32_16x16x32_bf16 v[60:63], v[32:35], a[8:11], v[60:63]
ds_read_b128 v[24:27], v8 offset:10240
v_mfma_f32_16x16x32_bf16 v[64:67], v[32:35], a[12:15], v[64:67]
s_add_u32 s51, s42, s47
s_sub_u32 s51, s51, 1
s_bfe_u32 s52, s51, 0x40002
s_lshl_b32 s52, s52, 14
s_waitcnt lgkmcnt(4)
v_mfma_f32_16x16x32_bf16 v[52:55], v[36:39], a[16:19], v[52:55]
ds_read_b128 v[28:31], v9 offset:8192
v_mfma_f32_16x16x32_bf16 v[56:59], v[36:39], a[20:23], v[56:59]
s_and_b32 s51, s51, 3
s_lshl_b32 s51, s51, 11
s_add_u32 s51, s51, s52
s_add_u32 s51, s51, s48
buffer_store_dwordx4 v[84:87], v7, s[84:87], s51 offen sc1
v_mfma_f32_16x16x32_bf16 v[60:63], v[40:43], a[16:19], v[60:63]
ds_read_b128 v[32:35], v9 offset:10240
v_mfma_f32_16x16x32_bf16 v[64:67], v[40:43], a[20:23], v[64:67]
buffer_store_dwordx4 v[88:91], v7, s[84:87], s51 offen offset:1024 sc1
s_waitcnt lgkmcnt(4)
v_mfma_f32_16x16x32_bf16 v[52:55], v[44:47], a[24:27], v[52:55]
ds_read_b128 v[36:39], v8 offset:12288
v_mfma_f32_16x16x32_bf16 v[56:59], v[44:47], a[28:31], v[56:59]
s_add_u32 m0, s46, 65536
v_mfma_f32_16x16x32_bf16 v[60:63], v[48:51], a[24:27], v[60:63]
ds_read_b128 v[40:43], v8 offset:14336
v_mfma_f32_16x16x32_bf16 v[64:67], v[48:51], a[28:31], v[64:67]
buffer_load_dwordx4 v6, s[8:11], s50 offen offset:0 lds
s_waitcnt lgkmcnt(4)
v_mfma_f32_16x16x32_bf16 v[52:55], v[20:23], a[32:35], v[52:55]
ds_read_b128 v[44:47], v9 offset:12288
v_mfma_f32_16x16x32_bf16 v[56:59], v[20:23], a[36:39], v[56:59]
s_add_u32 m0, s46, 69504
v_mfma_f32_16x16x32_bf16 v[60:63], v[24:27], a[32:35], v[60:63]
ds_read_b128 v[48:51], v9 offset:14336
v_mfma_f32_16x16x32_bf16 v[64:67], v[24:27], a[36:39], v[64:67]
buffer_load_dwordx4 v6, s[8:11], s50 offen offset:128 lds
s_waitcnt lgkmcnt(4)
v_mfma_f32_16x16x32_bf16 v[52:55], v[28:31], a[40:43], v[52:55]
ds_read_b128 v[20:23], v8 offset:16384
v_mfma_f32_16x16x32_bf16 v[56:59], v[28:31], a[44:47], v[56:59]
s_add_u32 m0, s46, 73472
v_mfma_f32_16x16x32_bf16 v[60:63], v[32:35], a[40:43], v[60:63]
ds_read_b128 v[24:27], v8 offset:18432
v_mfma_f32_16x16x32_bf16 v[64:67], v[32:35], a[44:47], v[64:67]
buffer_load_dwordx4 v6, s[8:11], s50 offen offset:256 lds
s_waitcnt lgkmcnt(4)
v_mfma_f32_16x16x32_bf16 v[52:55], v[36:39], a[48:51], v[52:55]
ds_read_b128 v[28:31], v9 offset:16384
v_mfma_f32_16x16x32_bf16 v[56:59], v[36:39], a[52:55], v[56:59]
s_add_u32 m0, s46, 77440
v_mfma_f32_16x16x32_bf16 v[60:63], v[40:43], a[48:51], v[60:63]
ds_read_b128 v[32:35], v9 offset:18432
v_mfma_f32_16x16x32_bf16 v[64:67], v[40:43], a[52:55], v[64:67]
buffer_load_dwordx4 v6, s[8:11], s50 offen offset:384 lds
s_waitcnt lgkmcnt(4)
v_mfma_f32_16x16x32_bf16 v[52:55], v[44:47], a[56:59], v[52:55]
ds_read_b128 v[36:39], v8 offset:20480
v_mfma_f32_16x16x32_bf16 v[56:59], v[44:47], a[60:63], v[56:59]
s_add_u32 m0, s46, 81408
v_mfma_f32_16x16x32_bf16 v[60:63], v[48:51], a[56:59], v[60:63]
ds_read_b128 v[40:43], v8 offset:22528
v_mfma_f32_16x16x32_bf16 v[64:67], v[48:51], a[60:63], v[64:67]
buffer_load_dwordx4 v6, s[8:11], s50 offen offset:512 lds
s_waitcnt lgkmcnt(4)
v_mfma_f32_16x16x32_bf16 v[52:55], v[20:23], a[64:67], v[52:55]
ds_read_b128 v[44:47], v9 offset:20480
v_mfma_f32_16x16x32_bf16 v[56:59], v[20:23], a[68:71], v[56:59]
s_add_u32 m0, s46, 85376
v_mfma_f32_16x16x32_bf16 v[60:63], v[24:27], a[64:67], v[60:63]
ds_read_b128 v[48:51], v9 offset:22528
v_mfma_f32_16x16x32_bf16 v[64:67], v[24:27], a[68:71], v[64:67]
buffer_load_dwordx4 v6, s[8:11], s50 offen offset:640 lds
s_waitcnt lgkmcnt(4)
v_mfma_f32_16x16x32_bf16 v[52:55], v[28:31], a[72:75], v[52:55]
ds_read_b128 v[20:23], v8 offset:24576
v_mfma_f32_16x16x32_bf16 v[56:59], v[28:31], a[76:79], v[56:59]
s_add_u32 m0, s46, 89344
v_mfma_f32_16x16x32_bf16 v[60:63], v[32:35], a[72:75], v[60:63]
ds_read_b128 v[24:27], v8 offset:26624
v_mfma_f32_16x16x32_bf16 v[64:67], v[32:35], a[76:79], v[64:67]
buffer_load_dwordx4 v6, s[8:11], s50 offen offset:768 lds
s_waitcnt lgkmcnt(4)
v_mfma_f32_16x16x32_bf16 v[52:55], v[36:39], a[80:83], v[52:55]
ds_read_b128 v[28:31], v9 offset:24576
v_mfma_f32_16x16x32_bf16 v[56:59], v[36:39], a[84:87], v[56:59]
s_add_u32 m0, s46, 93312
v_mfma_f32_16x16x32_bf16 v[60:63], v[40:43], a[80:83], v[60:63]
ds_read_b128 v[32:35], v9 offset:26624
v_mfma_f32_16x16x32_bf16 v[64:67], v[40:43], a[84:87], v[64:67]
buffer_load_dwordx4 v6, s[8:11], s50 offen offset:896 lds
s_waitcnt lgkmcnt(4)
v_mfma_f32_16x16x32_bf16 v[52:55], v[44:47], a[88:91], v[52:55]
ds_read_b128 v[36:39], v8 offset:28672
v_mfma_f32_16x16x32_bf16 v[56:59], v[44:47], a[92:95], v[56:59]
s_add_u32 m0, s46, 97280
v_mfma_f32_16x16x32_bf16 v[60:63], v[48:51], a[88:91], v[60:63]
ds_read_b128 v[40:43], v8 offset:30720
v_mfma_f32_16x16x32_bf16 v[64:67], v[48:51], a[92:95], v[64:67]
buffer_load_dwordx4 v6, s[8:11], s50 offen offset:1024 lds
s_waitcnt lgkmcnt(4)
v_mfma_f32_16x16x32_bf16 v[52:55], v[20:23], a[96:99], v[52:55]
ds_read_b128 v[44:47], v9 offset:28672
v_mfma_f32_16x16x32_bf16 v[56:59], v[20:23], a[100:103], v[56:59]
s_add_u32 m0, s46, 101248
v_mfma_f32_16x16x32_bf16 v[60:63], v[24:27], a[96:99], v[60:63]
ds_read_b128 v[48:51], v9 offset:30720
v_mfma_f32_16x16x32_bf16 v[64:67], v[24:27], a[100:103], v[64:67]
buffer_load_dwordx4 v6, s[8:11], s50 offen offset:1152 lds
s_waitcnt lgkmcnt(4)
v_mfma_f32_16x16x32_bf16 v[52:55], v[28:31], a[104:107], v[52:55]
ds_read_b128 v[20:23], v8 offset:32768
v_mfma_f32_16x16x32_bf16 v[56:59], v[28:31], a[108:111], v[56:59]
s_add_u32 m0, s46, 105216
v_mfma_f32_16x16x32_bf16 v[60:63], v[32:35], a[104:107], v[60:63]
ds_read_b128 v[24:27], v8 offset:34816
v_mfma_f32_16x16x32_bf16 v[64:67], v[32:35], a[108:111], v[64:67]
buffer_load_dwordx4 v6, s[8:11], s50 offen offset:1280 lds
s_waitcnt lgkmcnt(4)
v_mfma_f32_16x16x32_bf16 v[52:55], v[36:39], a[112:115], v[52:55]
ds_read_b128 v[28:31], v9 offset:32768
v_mfma_f32_16x16x32_bf16 v[56:59], v[36:39], a[116:119], v[56:59]
s_add_u32 m0, s46, 109184
v_mfma_f32_16x16x32_bf16 v[60:63], v[40:43], a[112:115], v[60:63]
ds_read_b128 v[32:35], v9 offset:34816
v_mfma_f32_16x16x32_bf16 v[64:67], v[40:43], a[116:119], v[64:67]
buffer_load_dwordx4 v6, s[8:11], s50 offen offset:1408 lds
s_waitcnt lgkmcnt(4)
v_mfma_f32_16x16x32_bf16 v[52:55], v[44:47], a[120:123], v[52:55]
ds_read_b128 v[36:39], v8 offset:36864
v_mfma_f32_16x16x32_bf16 v[56:59], v[44:47], a[124:127], v[56:59]
s_add_u32 m0, s46, 113152
v_mfma_f32_16x16x32_bf16 v[60:63], v[48:51], a[120:123], v[60:63]
ds_read_b128 v[40:43], v8 offset:38912
v_mfma_f32_16x16x32_bf16 v[64:67], v[48:51], a[124:127], v[64:67]
buffer_load_dwordx4 v6, s[8:11], s50 offen offset:1536 lds
s_waitcnt lgkmcnt(4)
v_mfma_f32_16x16x32_bf16 v[52:55], v[20:23], a[128:131], v[52:55]
ds_read_b128 v[44:47], v9 offset:36864
v_mfma_f32_16x16x32_bf16 v[56:59], v[20:23], a[132:135], v[56:59]
s_add_u32 m0, s46, 117120
v_mfma_f32_16x16x32_bf16 v[60:63], v[24:27], a[128:131], v[60:63]
ds_read_b128 v[48:51], v9 offset:38912
v_mfma_f32_16x16x32_bf16 v[64:67], v[24:27], a[132:135], v[64:67]
buffer_load_dwordx4 v6, s[8:11], s50 offen offset:1664 lds
s_waitcnt lgkmcnt(4)
v_mfma_f32_16x16x32_bf16 v[52:55], v[28:31], a[136:139], v[52:55]
ds_read_b128 v[20:23], v8 offset:40960
v_mfma_f32_16x16x32_bf16 v[56:59], v[28:31], a[140:143], v[56:59]
s_add_u32 m0, s46, 121088
v_mfma_f32_16x16x32_bf16 v[60:63], v[32:35], a[136:139], v[60:63]
ds_read_b128 v[24:27], v8 offset:43008
v_mfma_f32_16x16x32_bf16 v[64:67], v[32:35], a[140:143], v[64:67]
buffer_load_dwordx4 v6, s[8:11], s50 offen offset:1792 lds
s_waitcnt lgkmcnt(4)
v_mfma_f32_16x16x32_bf16 v[52:55], v[36:39], a[144:147], v[52:55]
ds_read_b128 v[28:31], v9 offset:40960
v_mfma_f32_16x16x32_bf16 v[56:59], v[36:39], a[148:151], v[56:59]
s_add_u32 m0, s46, 125056
v_mfma_f32_16x16x32_bf16 v[60:63], v[40:43], a[144:147], v[60:63]
ds_read_b128 v[32:35], v9 offset:43008
v_mfma_f32_16x16x32_bf16 v[64:67], v[40:43], a[148:151], v[64:67]
buffer_load_dwordx4 v6, s[8:11], s50 offen offset:1920 lds
s_waitcnt lgkmcnt(4)
v_mfma_f32_16x16x32_bf16 v[52:55], v[44:47], a[152:155], v[52:55]
ds_read_b128 v[36:39], v8 offset:45056
v_mfma_f32_16x16x32_bf16 v[56:59], v[44:47], a[156:159], v[56:59]
v_mfma_f32_16x16x32_bf16 v[60:63], v[48:51], a[152:155], v[60:63]
ds_read_b128 v[40:43], v8 offset:47104
v_mfma_f32_16x16x32_bf16 v[64:67], v[48:51], a[156:159], v[64:67]
s_waitcnt lgkmcnt(4)
v_mfma_f32_16x16x32_bf16 v[52:55], v[20:23], a[160:163], v[52:55]
ds_read_b128 v[44:47], v9 offset:45056
v_mfma_f32_16x16x32_bf16 v[56:59], v[20:23], a[164:167], v[56:59]
v_mfma_f32_16x16x32_bf16 v[60:63], v[24:27], a[160:163], v[60:63]
ds_read_b128 v[48:51], v9 offset:47104
v_mfma_f32_16x16x32_bf16 v[64:67], v[24:27], a[164:167], v[64:67]
s_waitcnt lgkmcnt(4)
v_mfma_f32_16x16x32_bf16 v[52:55], v[28:31], a[168:171], v[52:55]
ds_read_b128 v[20:23], v8 offset:49152
v_mfma_f32_16x16x32_bf16 v[56:59], v[28:31], a[172:175], v[56:59]
s_waitcnt vmcnt(16)
v_mov_b32 v17, s42
s_mov_b64 exec, 1
buffer_store_dword v17, v16, s[84:87], s49 offen sc1
s_mov_b64 exec, -1
v_mfma_f32_16x16x32_bf16 v[60:63], v[32:35], a[168:171], v[60:63]
ds_read_b128 v[24:27], v8 offset:51200
v_mfma_f32_16x16x32_bf16 v[64:67], v[32:35], a[172:175], v[64:67]
s_waitcnt lgkmcnt(4)
v_mfma_f32_16x16x32_bf16 v[52:55], v[36:39], a[176:179], v[52:55]
ds_read_b128 v[28:31], v9 offset:49152
v_mfma_f32_16x16x32_bf16 v[56:59], v[36:39], a[180:183], v[56:59]
s_add_u32 s53, s42, 3
s_min_u32 s53, s53, 63
s_lshl_b32 s53, s53, 16
s_mov_b64 exec, 0xffff
buffer_load_dword v250, v19, s[8:11], s53 offen
s_mov_b64 exec, -1
v_mfma_f32_16x16x32_bf16 v[60:63], v[40:43], a[176:179], v[60:63]
ds_read_b128 v[32:35], v9 offset:51200
v_mfma_f32_16x16x32_bf16 v[64:67], v[40:43], a[180:183], v[64:67]
s_waitcnt lgkmcnt(4)
v_mfma_f32_16x16x32_bf16 v[52:55], v[44:47], a[184:187], v[52:55]
ds_read_b128 v[36:39], v8 offset:53248
v_mfma_f32_16x16x32_bf16 v[56:59], v[44:47], a[188:191], v[56:59]
v_mfma_f32_16x16x32_bf16 v[60:63], v[48:51], a[184:187], v[60:63]
ds_read_b128 v[40:43], v8 offset:55296
v_mfma_f32_16x16x32_bf16 v[64:67], v[48:51], a[188:191], v[64:67]
s_waitcnt lgkmcnt(4)
v_mfma_f32_16x16x32_bf16 v[52:55], v[20:23], a[192:195], v[52:55]
ds_read_b128 v[44:47], v9 offset:53248
v_mfma_f32_16x16x32_bf16 v[56:59], v[20:23], a[196:199], v[56:59]
v_mfma_f32_16x16x32_bf16 v[60:63], v[24:27], a[192:195], v[60:63]
ds_read_b128 v[48:51], v9 offset:55296
v_mfma_f32_16x16x32_bf16 v[64:67], v[24:27], a[196:199], v[64:67]
s_waitcnt lgkmcnt(4)
v_mfma_f32_16x16x32_bf16 v[52:55], v[28:31], a[200:203], v[52:55]
ds_read_b128 v[20:23], v8 offset:57344
v_mfma_f32_16x16x32_bf16 v[56:59], v[28:31], a[204:207], v[56:59]
v_mfma_f32_16x16x32_bf16 v[60:63], v[32:35], a[200:203], v[60:63]
ds_read_b128 v[24:27], v8 offset:59392
v_mfma_f32_16x16x32_bf16 v[64:67], v[32:35], a[204:207], v[64:67]
s_waitcnt lgkmcnt(4)
v_mfma_f32_16x16x32_bf16 v[52:55], v[36:39], a[208:211], v[52:55]
ds_read_b128 v[28:31], v9 offset:57344
v_mfma_f32_16x16x32_bf16 v[56:59], v[36:39], a[212:215], v[56:59]
v_mfma_f32_16x16x32_bf16 v[60:63], v[40:43], a[208:211], v[60:63]
ds_read_b128 v[32:35], v9 offset:59392
v_mfma_f32_16x16x32_bf16 v[64:67], v[40:43], a[212:215], v[64:67]
s_waitcnt lgkmcnt(4)
v_mfma_f32_16x16x32_bf16 v[52:55], v[44:47], a[216:219], v[52:55]
ds_read_b128 v[36:39], v8 offset:61440
v_mfma_f32_16x16x32_bf16 v[56:59], v[44:47], a[220:223], v[56:59]
v_mfma_f32_16x16x32_bf16 v[60:63], v[48:51], a[216:219], v[60:63]
ds_read_b128 v[40:43], v8 offset:63488
v_mfma_f32_16x16x32_bf16 v[64:67], v[48:51], a[220:223], v[64:67]
s_waitcnt lgkmcnt(4)
v_mfma_f32_16x16x32_bf16 v[52:55], v[20:23], a[224:227], v[52:55]
ds_read_b128 v[44:47], v9 offset:61440
v_mfma_f32_16x16x32_bf16 v[56:59], v[20:23], a[228:231], v[56:59]
v_mfma_f32_16x16x32_bf16 v[60:63], v[24:27], a[224:227], v[60:63]
ds_read_b128 v[48:51], v9 offset:63488
v_mfma_f32_16x16x32_bf16 v[64:67], v[24:27], a[228:231], v[64:67]
s_waitcnt lgkmcnt(5)
v_mfma_f32_16x16x32_bf16 v[52:55], v[28:31], a[232:235], v[52:55]
v_mfma_f32_16x16x32_bf16 v[56:59], v[28:31], a[236:239], v[56:59]
s_waitcnt lgkmcnt(4)
v_mfma_f32_16x16x32_bf16 v[60:63], v[32:35], a[232:235], v[60:63]
v_mfma_f32_16x16x32_bf16 v[64:67], v[32:35], a[236:239], v[64:67]
s_waitcnt lgkmcnt(3)
v_mfma_f32_16x16x32_bf16 v[52:55], v[36:39], a[240:243], v[52:55]
v_mfma_f32_16x16x32_bf16 v[56:59], v[36:39], a[244:247], v[56:59]
s_waitcnt lgkmcnt(2)
v_mfma_f32_16x16x32_bf16 v[60:63], v[40:43], a[240:243], v[60:63]
v_mfma_f32_16x16x32_bf16 v[64:67], v[40:43], a[244:247], v[64:67]
s_waitcnt lgkmcnt(1)
v_mfma_f32_16x16x32_bf16 v[52:55], v[44:47], a[248:251], v[52:55]
v_mfma_f32_16x16x32_bf16 v[56:59], v[44:47], a[252:255], v[56:59]
s_waitcnt lgkmcnt(0)
v_mfma_f32_16x16x32_bf16 v[60:63], v[48:51], a[248:251], v[60:63]
v_mfma_f32_16x16x32_bf16 v[64:67], v[48:51], a[252:255], v[64:67]
s_add_u32 s42, s42, 1
s_branch mega_kernel_v_loop
mega_kernel_v_fin:
s_nop 11
v_cvt_pk_bf16_f32 v84, v68, v69
v_cvt_pk_bf16_f32 v85, v70, v71
v_cvt_pk_bf16_f32 v86, v76, v77
v_cvt_pk_bf16_f32 v87, v78, v79
v_cvt_pk_bf16_f32 v88, v72, v73
v_cvt_pk_bf16_f32 v89, v74, v75
v_cvt_pk_bf16_f32 v90, v80, v81
v_cvt_pk_bf16_f32 v91, v82, v83
s_add_u32 s51, s42, s47
s_sub_u32 s51, s51, 1
s_bfe_u32 s52, s51, 0x40002
s_lshl_b32 s52, s52, 14
s_and_b32 s51, s51, 3
s_lshl_b32 s51, s51, 11
s_add_u32 s51, s51, s52
s_add_u32 s51, s51, s48
buffer_store_dwordx4 v[84:87], v7, s[84:87], s51 offen sc1
buffer_store_dwordx4 v[88:91], v7, s[84:87], s51 offen offset:1024 sc1
s_waitcnt vmcnt(0)
v_mov_b32 v17, s42
s_mov_b64 exec, 1
buffer_store_dword v17, v16, s[84:87], s49 offen sc1
s_mov_b64 exec, -1
s_waitcnt vmcnt(0)
s_barrier
mega_kernel_fft:
s_mov_b32 s38, s92
s_mov_b32 s39, 64
s_mov_b32 s37, 129
mega_kernel_f2s:
v_mov_b32 v1, 0
s_mov_b32 s82, 69259264
mega_kernel_w0:
s_sleep 8
buffer_load_dword v2, v1, s[84:87], s82 offen sc1
s_waitcnt vmcnt(0)
v_cmp_ne_u32 vcc, 31, v2
s_cbranch_vccnz mega_kernel_w0
s_mov_b32 s48, 0x3f7ec46d
s_mov_b32 s49, 0x3dc8bd36
s_mov_b32 s50, 0x3f7b14be
s_mov_b32 s51, 0x3e47c5c2
s_mov_b32 s52, 0x3f74fa0b
s_mov_b32 s53, 0x3e94a031
s_mov_b32 s54, 0x3f6c835e
s_mov_b32 s55, 0x3ec3ef15
s_mov_b32 s56, 0x3f61c598
s_mov_b32 s57, 0x3ef15aea
s_mov_b32 s58, 0x3f54db31
s_mov_b32 s59, 0x3f0e39da
s_mov_b32 s60, 0x3f45e403
s_mov_b32 s61, 0x3f226799
s_mov_b32 s62, 0x3f3504f3
s_mov_b32 s63, 0x3f3504f3
v_lshrrev_b32 v10, 6, v0
v_and_b32 v1, 63, v0
v_readfirstlane_b32 s16, v10
v_cvt_f32_u32 v2, v1
v_lshlrev_b32 v5, 3, v1
s_mul_i32 s17, s16, 16896
v_add_u32 v3, s17, v5
v_and_b32 v7, 1, v1
v_lshrrev_b32 v6, 1, v1
v_cvt_f32_u32 v8, v6
v_cvt_f32_u32 v10, v7
v_mul_u32_u24 v4, 528, v6
v_lshl_add_u32 v4, v7, 3, v4
v_add_u32 v4, s17, v4
v_lshlrev_b32 v11, 12, v7
v_lshl_add_u32 v11, v6, 2, v11
v_fma_f32 v9, v10, 2.0, -1.0
v_sub_f32 v7, 0, v9
v_mul_f32 v13, v10, v8
v_mul_f32 v13, 0x3a000000, v13
s_mov_b32 s18, 0xaaaaaaaa
s_mov_b32 s19, 0xaaaaaaaa
v_mul_f32 v12, 0xba000000, v2
v_cos_f32 v82, v12
v_sin_f32 v83, v12
v_mul_f32 v12, 0xba800000, v2
v_cos_f32 v84, v12
v_sin_f32 v85, v12
v_mul_f32 v12, 0xbac00000, v2
v_cos_f32 v86, v12
v_sin_f32 v87, v12
v_mul_f32 v12, 0xbb000000, v2
v_cos_f32 v88, v12
v_sin_f32 v89, v12
v_mul_f32 v12, 0xbb200000, v2
v_cos_f32 v90, v12
v_sin_f32 v91, v12
v_mul_f32 v12, 0xbb400000, v2
v_cos_f32 v92, v12
v_sin_f32 v93, v12
v_mul_f32 v12, 0xbb600000, v2
v_cos_f32 v94, v12
v_sin_f32 v95, v12
v_mul_f32 v12, 0xbb800000, v2
v_cos_f32 v96, v12
v_sin_f32 v97, v12
v_mul_f32 v12, 0xbb900000, v2
v_cos_f32 v98, v12
v_sin_f32 v99, v12
v_mul_f32 v12, 0xbba00000, v2
v_cos_f32 v100, v12
v_sin_f32 v101, v12
v_mul_f32 v12, 0xbbb00000, v2
v_cos_f32 v102, v12
v_sin_f32 v103, v12
v_mul_f32 v12, 0xbbc00000, v2
v_cos_f32 v104, v12
v_sin_f32 v105, v12
v_mul_f32 v12, 0xbbd00000, v2
v_cos_f32 v106, v12
v_sin_f32 v107, v12
v_mul_f32 v12, 0xbbe00000, v2
v_cos_f32 v108, v12
v_sin_f32 v109, v12
v_mul_f32 v12, 0xbbf00000, v2
v_cos_f32 v110, v12
v_sin_f32 v111, v12
v_mul_f32 v12, 0xbc000000, v2
v_cos_f32 v112, v12
v_sin_f32 v113, v12
v_mul_f32 v12, 0xbc080000, v2
v_cos_f32 v114, v12
v_sin_f32 v115, v12
v_mul_f32 v12, 0xbc100000, v2
v_cos_f32 v116, v12
v_sin_f32 v117, v12
v_mul_f32 v12, 0xbc180000, v2
v_cos_f32 v118, v12
v_sin_f32 v119, v12
v_mul_f32 v12, 0xbc200000, v2
v_cos_f32 v120, v12
v_sin_f32 v121, v12
v_mul_f32 v12, 0xbc280000, v2
v_cos_f32 v122, v12
v_sin_f32 v123, v12
v_mul_f32 v12, 0xbc300000, v2
v_cos_f32 v124, v12
v_sin_f32 v125, v12
v_mul_f32 v12, 0xbc380000, v2
v_cos_f32 v126, v12
v_sin_f32 v127, v12
v_mul_f32 v12, 0xbc400000, v2
v_cos_f32 v128, v12
v_sin_f32 v129, v12
v_mul_f32 v12, 0xbc480000, v2
v_cos_f32 v130, v12
v_sin_f32 v131, v12
v_mul_f32 v12, 0xbc500000, v2
v_cos_f32 v132, v12
v_sin_f32 v133, v12
v_mul_f32 v12, 0xbc580000, v2
v_cos_f32 v134, v12
v_sin_f32 v135, v12
v_mul_f32 v12, 0xbc600000, v2
v_cos_f32 v136, v12
v_sin_f32 v137, v12
v_mul_f32 v12, 0xbc680000, v2
v_cos_f32 v138, v12
v_sin_f32 v139, v12
v_mul_f32 v12, 0xbc700000, v2
v_cos_f32 v140, v12
v_sin_f32 v141, v12
v_mul_f32 v12, 0xbc780000, v2
v_cos_f32 v142, v12
v_sin_f32 v143, v12
v_mov_b32 v12, v13
v_fmac_f32 v12, 0x00000000, v8
v_cos_f32 v144, v12
v_sin_f32 v145, v12
v_mov_b32 v12, v13
v_fmac_f32 v12, 0x3a800000, v8
v_cos_f32 v146, v12
v_sin_f32 v147, v12
v_mov_b32 v12, v13
v_fmac_f32 v12, 0x3b000000, v8
v_cos_f32 v148, v12
v_sin_f32 v149, v12
v_mov_b32 v12, v13
v_fmac_f32 v12, 0x3b400000, v8
v_cos_f32 v150, v12
v_sin_f32 v151, v12
v_mov_b32 v12, v13
v_fmac_f32 v12, 0x3b800000, v8
v_cos_f32 v152, v12
v_sin_f32 v153, v12
v_mov_b32 v12, v13
v_fmac_f32 v12, 0x3ba00000, v8
v_cos_f32 v154, v12
v_sin_f32 v155, v12
v_mov_b32 v12, v13
v_fmac_f32 v12, 0x3bc00000, v8
v_cos_f32 v156, v12
v_sin_f32 v157, v12
v_mov_b32 v12, v13
v_fmac_f32 v12, 0x3be00000, v8
v_cos_f32 v158, v12
v_sin_f32 v159, v12
v_mov_b32 v12, v13
v_fmac_f32 v12, 0x3c000000, v8
v_cos_f32 v160, v12
v_sin_f32 v161, v12
v_mov_b32 v12, v13
v_fmac_f32 v12, 0x3c100000, v8
v_cos_f32 v162, v12
v_sin_f32 v163, v12
v_mov_b32 v12, v13
v_fmac_f32 v12, 0x3c200000, v8
v_cos_f32 v164, v12
v_sin_f32 v165, v12
v_mov_b32 v12, v13
v_fmac_f32 v12, 0x3c300000, v8
v_cos_f32 v166, v12
v_sin_f32 v167, v12
v_mov_b32 v12, v13
v_fmac_f32 v12, 0x3c400000, v8
v_cos_f32 v168, v12
v_sin_f32 v169, v12
v_mov_b32 v12, v13
v_fmac_f32 v12, 0x3c500000, v8
v_cos_f32 v170, v12
v_sin_f32 v171, v12
v_mov_b32 v12, v13
v_fmac_f32 v12, 0x3c600000, v8
v_cos_f32 v172, v12
v_sin_f32 v173, v12
v_mov_b32 v12, v13
v_fmac_f32 v12, 0x3c700000, v8
v_cos_f32 v174, v12
v_sin_f32 v175, v12
v_mov_b32 v12, v13
v_fmac_f32 v12, 0x3c800000, v8
v_cos_f32 v176, v12
v_sin_f32 v177, v12
v_mov_b32 v12, v13
v_fmac_f32 v12, 0x3c880000, v8
v_cos_f32 v178, v12
v_sin_f32 v179, v12
v_mov_b32 v12, v13
v_fmac_f32 v12, 0x3c900000, v8
v_cos_f32 v180, v12
v_sin_f32 v181, v12
v_mov_b32 v12, v13
v_fmac_f32 v12, 0x3c980000, v8
v_cos_f32 v182, v12
v_sin_f32 v183, v12
v_mov_b32 v12, v13
v_fmac_f32 v12, 0x3ca00000, v8
v_cos_f32 v184, v12
v_sin_f32 v185, v12
v_mov_b32 v12, v13
v_fmac_f32 v12, 0x3ca80000, v8
v_cos_f32 v186, v12
v_sin_f32 v187, v12
v_mov_b32 v12, v13
v_fmac_f32 v12, 0x3cb00000, v8
v_cos_f32 v188, v12
v_sin_f32 v189, v12
v_mov_b32 v12, v13
v_fmac_f32 v12, 0x3cb80000, v8
v_cos_f32 v190, v12
v_sin_f32 v191, v12
v_mov_b32 v12, v13
v_fmac_f32 v12, 0x3cc00000, v8
v_cos_f32 v192, v12
v_sin_f32 v193, v12
v_mov_b32 v12, v13
v_fmac_f32 v12, 0x3cc80000, v8
v_cos_f32 v194, v12
v_sin_f32 v195, v12
v_mov_b32 v12, v13
v_fmac_f32 v12, 0x3cd00000, v8
v_cos_f32 v196, v12
v_sin_f32 v197, v12
v_mov_b32 v12, v13
v_fmac_f32 v12, 0x3cd80000, v8
v_cos_f32 v198, v12
v_sin_f32 v199, v12
v_mov_b32 v12, v13
v_fmac_f32 v12, 0x3ce00000, v8
v_cos_f32 v200, v12
v_sin_f32 v201, v12
v_mov_b32 v12, v13
v_fmac_f32 v12, 0x3ce80000, v8
v_cos_f32 v202, v12
v_sin_f32 v203, v12
v_mov_b32 v12, v13
v_fmac_f32 v12, 0x3cf00000, v8
v_cos_f32 v204, v12
v_sin_f32 v205, v12
v_mov_b32 v12, v13
v_fmac_f32 v12, 0x3cf80000, v8
v_cos_f32 v206, v12
v_sin_f32 v207, v12
s_nop 0
v_mul_f32 v144, 0x34800000, v144
v_mul_f32 v145, 0x34800000, v145
v_mul_f32 v146, 0x34800000, v146
v_mul_f32 v147, 0x34800000, v147
v_mul_f32 v148, 0x34800000, v148
v_mul_f32 v149, 0x34800000, v149
v_mul_f32 v150, 0x34800000, v150
v_mul_f32 v151, 0x34800000, v151
v_mul_f32 v152, 0x34800000, v152
v_mul_f32 v153, 0x34800000, v153
v_mul_f32 v154, 0x34800000, v154
v_mul_f32 v155, 0x34800000, v155
v_mul_f32 v156, 0x34800000, v156
v_mul_f32 v157, 0x34800000, v157
v_mul_f32 v158, 0x34800000, v158
v_mul_f32 v159, 0x34800000, v159
v_mul_f32 v160, 0x34800000, v160
v_mul_f32 v161, 0x34800000, v161
v_mul_f32 v162, 0x34800000, v162
v_mul_f32 v163, 0x34800000, v163
v_mul_f32 v164, 0x34800000, v164
v_mul_f32 v165, 0x34800000, v165
v_mul_f32 v166, 0x34800000, v166
v_mul_f32 v167, 0x34800000, v167
v_mul_f32 v168, 0x34800000, v168
v_mul_f32 v169, 0x34800000, v169
v_mul_f32 v170, 0x34800000, v170
v_mul_f32 v171, 0x34800000, v171
v_mul_f32 v172, 0x34800000, v172
v_mul_f32 v173, 0x34800000, v173
v_mul_f32 v174, 0x34800000, v174
v_mul_f32 v175, 0x34800000, v175
v_mul_f32 v176, 0x34800000, v176
v_mul_f32 v177, 0x34800000, v177
v_mul_f32 v178, 0x34800000, v178
v_mul_f32 v179, 0x34800000, v179
v_mul_f32 v180, 0x34800000, v180
v_mul_f32 v181, 0x34800000, v181
v_mul_f32 v182, 0x34800000, v182
v_mul_f32 v183, 0x34800000, v183
v_mul_f32 v184, 0x34800000, v184
v_mul_f32 v185, 0x34800000, v185
v_mul_f32 v186, 0x34800000, v186
v_mul_f32 v187, 0x34800000, v187
v_mul_f32 v188, 0x34800000, v188
v_mul_f32 v189, 0x34800000, v189
v_mul_f32 v190, 0x34800000, v190
v_mul_f32 v191, 0x34800000, v191
v_mul_f32 v192, 0x34800000, v192
v_mul_f32 v193, 0x34800000, v193
v_mul_f32 v194, 0x34800000, v194
v_mul_f32 v195, 0x34800000, v195
v_mul_f32 v196, 0x34800000, v196
v_mul_f32 v197, 0x34800000, v197
v_mul_f32 v198, 0x34800000, v198
v_mul_f32 v199, 0x34800000, v199
v_mul_f32 v200, 0x34800000, v200
v_mul_f32 v201, 0x34800000, v201
v_mul_f32 v202, 0x34800000, v202
v_mul_f32 v203, 0x34800000, v203
v_mul_f32 v204, 0x34800000, v204
v_mul_f32 v205, 0x34800000, v205
v_mul_f32 v206, 0x34800000, v206
v_mul_f32 v207, 0x34800000, v207
s_cmp_lt_u32 s38, s37
s_cbranch_scc0 mega_kernel_f2_e
s_lshl_b32 s12, s38, 2
s_add_u32 s12, s12, s16
s_min_u32 s12, s12, 512
s_lshl_b32 s13, s12, 13
s_lshl_b32 s12, s12, 14
s_add_u32 s12, s12, 96468992
s_add_u32 s13, s13, 121634816
buffer_load_dwordx2 a[0:1], v5, s[84:87], s12 offen offset:0 sc1
buffer_load_dwordx2 a[2:3], v5, s[84:87], s12 offen offset:512 sc1
buffer_load_dwordx2 a[4:5], v5, s[84:87], s12 offen offset:1024 sc1
buffer_load_dwordx2 a[6:7], v5, s[84:87], s12 offen offset:1536 sc1
buffer_load_dwordx2 a[8:9], v5, s[84:87], s12 offen offset:2048 sc1
buffer_load_dwordx2 a[10:11], v5, s[84:87], s12 offen offset:2560 sc1
buffer_load_dwordx2 a[12:13], v5, s[84:87], s12 offen offset:3072 sc1
buffer_load_dwordx2 a[14:15], v5, s[84:87], s12 offen offset:3584 sc1
s_add_u32 s12, s12, 4096
buffer_load_dwordx2 a[16:17], v5, s[84:87], s12 offen offset:0 sc1
buffer_load_dwordx2 a[18:19], v5, s[84:87], s12 offen offset:512 sc1
buffer_load_dwordx2 a[20:21], v5, s[84:87], s12 offen offset:1024 sc1
buffer_load_dwordx2 a[22:23], v5, s[84:87], s12 offen offset:1536 sc1
buffer_load_dwordx2 a[24:25], v5, s[84:87], s12 offen offset:2048 sc1
buffer_load_dwordx2 a[26:27], v5, s[84:87], s12 offen offset:2560 sc1
buffer_load_dwordx2 a[28:29], v5, s[84:87], s12 offen offset:3072 sc1
buffer_load_dwordx2 a[30:31], v5, s[84:87], s12 offen offset:3584 sc1
s_add_u32 s12, s12, 4096
buffer_load_dwordx2 a[32:33], v5, s[84:87], s12 offen offset:0 sc1
buffer_load_dwordx2 a[34:35], v5, s[84:87], s12 offen offset:512 sc1
buffer_load_dwordx2 a[36:37], v5, s[84:87], s12 offen offset:1024 sc1
buffer_load_dwordx2 a[38:39], v5, s[84:87], s12 offen offset:1536 sc1
buffer_load_dwordx2 a[40:41], v5, s[84:87], s12 offen offset:2048 sc1
buffer_load_dwordx2 a[42:43], v5, s[84:87], s12 offen offset:2560 sc1
buffer_load_dwordx2 a[44:45], v5, s[84:87], s12 offen offset:3072 sc1
buffer_load_dwordx2 a[46:47], v5, s[84:87], s12 offen offset:3584 sc1
s_add_u32 s12, s12, 4096
buffer_load_dwordx2 a[48:49], v5, s[84:87], s12 offen offset:0 sc1
buffer_load_dwordx2 a[50:51], v5, s[84:87], s12 offen offset:512 sc1
buffer_load_dwordx2 a[52:53], v5, s[84:87], s12 offen offset:1024 sc1
buffer_load_dwordx2 a[54:55], v5, s[84:87], s12 offen offset:1536 sc1
buffer_load_dwordx2 a[56:57], v5, s[84:87], s12 offen offset:2048 sc1
buffer_load_dwordx2 a[58:59], v5, s[84:87], s12 offen offset:2560 sc1
buffer_load_dwordx2 a[60:61], v5, s[84:87], s12 offen offset:3072 sc1
buffer_load_dwordx2 a[62:63], v5, s[84:87], s12 offen offset:3584 sc1
s_add_u32 s12, s12, 4096
buffer_load_dword a64, v11, s[84:87], s13 offen offset:0 sc1
buffer_load_dword a65, v11, s[84:87], s13 offen offset:128 sc1
buffer_load_dword a66, v11, s[84:87], s13 offen offset:256 sc1
buffer_load_dword a67, v11, s[84:87], s13 offen offset:384 sc1
buffer_load_dword a68, v11, s[84:87], s13 offen offset:512 sc1
buffer_load_dword a69, v11, s[84:87], s13 offen offset:640 sc1
buffer_load_dword a70, v11, s[84:87], s13 offen offset:768 sc1
buffer_load_dword a71, v11, s[84:87], s13 offen offset:896 sc1
buffer_load_dword a72, v11, s[84:87], s13 offen offset:1024 sc1
buffer_load_dword a73, v11, s[84:87], s13 offen offset:1152 sc1
buffer_load_dword a74, v11, s[84:87], s13 offen offset:1280 sc1
buffer_load_dword a75, v11, s[84:87], s13 offen offset:1408 sc1
buffer_load_dword a76, v11, s[84:87], s13 offen offset:1536 sc1
buffer_load_dword a77, v11, s[84:87], s13 offen offset:1664 sc1
buffer_load_dword a78, v11, s[84:87], s13 offen offset:1792 sc1
buffer_load_dword a79, v11, s[84:87], s13 offen offset:1920 sc1
buffer_load_dword a80, v11, s[84:87], s13 offen offset:2048 sc1
buffer_load_dword a81, v11, s[84:87], s13 offen offset:2176 sc1
buffer_load_dword a82, v11, s[84:87], s13 offen offset:2304 sc1
buffer_load_dword a83, v11, s[84:87], s13 offen offset:2432 sc1
buffer_load_dword a84, v11, s[84:87], s13 offen offset:2560 sc1
buffer_load_dword a85, v11, s[84:87], s13 offen offset:2688 sc1
buffer_load_dword a86, v11, s[84:87], s13 offen offset:2816 sc1
buffer_load_dword a87, v11, s[84:87], s13 offen offset:2944 sc1
buffer_load_dword a88, v11, s[84:87], s13 offen offset:3072 sc1
buffer_load_dword a89, v11, s[84:87], s13 offen offset:3200 sc1
buffer_load_dword a90, v11, s[84:87], s13 offen offset:3328 sc1
buffer_load_dword a91, v11, s[84:87], s13 offen offset:3456 sc1
buffer_load_dword a92, v11, s[84:87], s13 offen offset:3584 sc1
buffer_load_dword a93, v11, s[84:87], s13 offen offset:3712 sc1
buffer_load_dword a94, v11, s[84:87], s13 offen offset:3840 sc1
buffer_load_dword a95, v11, s[84:87], s13 offen offset:3968 sc1
s_waitcnt vmcnt(0)
mega_kernel_f2_l:
s_add_u32 s21, s38, s39
s_cmp_lt_u32 s21, s37
s_cselect_b32 s22, s21, s38
s_waitcnt vmcnt(32)
v_accvgpr_read_b32 v16, a0
v_accvgpr_read_b32 v17, a1
v_accvgpr_read_b32 v18, a2
v_accvgpr_read_b32 v19, a3
v_accvgpr_read_b32 v20, a4
v_accvgpr_read_b32 v21, a5
v_accvgpr_read_b32 v22, a6
v_accvgpr_read_b32 v23, a7
v_accvgpr_read_b32 v24, a8
v_accvgpr_read_b32 v25, a9
v_accvgpr_read_b32 v26, a10
v_accvgpr_read_b32 v27, a11
v_accvgpr_read_b32 v28, a12
v_accvgpr_read_b32 v29, a13
v_accvgpr_read_b32 v30, a14
v_accvgpr_read_b32 v31, a15
v_accvgpr_read_b32 v32, a16
v_accvgpr_read_b32 v33, a17
v_accvgpr_read_b32 v34, a18
v_accvgpr_read_b32 v35, a19
v_accvgpr_read_b32 v36, a20
v_accvgpr_read_b32 v37, a21
v_accvgpr_read_b32 v38, a22
v_accvgpr_read_b32 v39, a23
v_accvgpr_read_b32 v40, a24
v_accvgpr_read_b32 v41, a25
v_accvgpr_read_b32 v42, a26
v_accvgpr_read_b32 v43, a27
v_accvgpr_read_b32 v44, a28
v_accvgpr_read_b32 v45, a29
v_accvgpr_read_b32 v46, a30
v_accvgpr_read_b32 v47, a31
v_accvgpr_read_b32 v48, a32
v_accvgpr_read_b32 v49, a33
v_accvgpr_read_b32 v50, a34
v_accvgpr_read_b32 v51, a35
v_accvgpr_read_b32 v52, a36
v_accvgpr_read_b32 v53, a37
v_accvgpr_read_b32 v54, a38
v_accvgpr_read_b32 v55, a39
v_accvgpr_read_b32 v56, a40
v_accvgpr_read_b32 v57, a41
v_accvgpr_read_b32 v58, a42
v_accvgpr_read_b32 v59, a43
v_accvgpr_read_b32 v60, a44
v_accvgpr_read_b32 v61, a45
v_accvgpr_read_b32 v62, a46
v_accvgpr_read_b32 v63, a47
v_accvgpr_read_b32 v64, a48
v_accvgpr_read_b32 v65, a49
v_accvgpr_read_b32 v66, a50
v_accvgpr_read_b32 v67, a51
v_accvgpr_read_b32 v68, a52
v_accvgpr_read_b32 v69, a53
v_accvgpr_read_b32 v70, a54
v_accvgpr_read_b32 v71, a55
v_accvgpr_read_b32 v72, a56
v_accvgpr_read_b32 v73, a57
v_accvgpr_read_b32 v74, a58
v_accvgpr_read_b32 v75, a59
v_accvgpr_read_b32 v76, a60
v_accvgpr_read_b32 v77, a61
v_accvgpr_read_b32 v78, a62
v_accvgpr_read_b32 v79, a63
v_accvgpr_read_b32 v208, a64
v_accvgpr_read_b32 v209, a65
v_accvgpr_read_b32 v210, a66
v_accvgpr_read_b32 v211, a67
v_accvgpr_read_b32 v212, a68
v_accvgpr_read_b32 v213, a69
v_accvgpr_read_b32 v214, a70
v_accvgpr_read_b32 v215, a71
v_accvgpr_read_b32 v216, a72
v_accvgpr_read_b32 v217, a73
v_accvgpr_read_b32 v218, a74
v_accvgpr_read_b32 v219, a75
v_accvgpr_read_b32 v220, a76
v_accvgpr_read_b32 v221, a77
v_accvgpr_read_b32 v222, a78
v_accvgpr_read_b32 v223, a79
v_accvgpr_read_b32 v224, a80
v_accvgpr_read_b32 v225, a81
v_accvgpr_read_b32 v226, a82
v_accvgpr_read_b32 v227, a83
v_accvgpr_read_b32 v228, a84
v_accvgpr_read_b32 v229, a85
v_accvgpr_read_b32 v230, a86
v_accvgpr_read_b32 v231, a87
v_accvgpr_read_b32 v232, a88
v_accvgpr_read_b32 v233, a89
v_accvgpr_read_b32 v234, a90
v_accvgpr_read_b32 v235, a91
v_accvgpr_read_b32 v236, a92
v_accvgpr_read_b32 v237, a93
v_accvgpr_read_b32 v238, a94
v_accvgpr_read_b32 v239, a95
s_lshl_b32 s12, s22, 2
s_add_u32 s12, s12, s16
s_min_u32 s12, s12, 512
s_lshl_b32 s13, s12, 13
s_lshl_b32 s12, s12, 14
s_add_u32 s12, s12, 96468992
s_add_u32 s13, s13, 121634816
buffer_load_dwordx2 a[0:1], v5, s[84:87], s12 offen offset:0 sc1
buffer_load_dwordx2 a[2:3], v5, s[84:87], s12 offen offset:512 sc1
buffer_load_dwordx2 a[4:5], v5, s[84:87], s12 offen offset:1024 sc1
buffer_load_dwordx2 a[6:7], v5, s[84:87], s12 offen offset:1536 sc1
buffer_load_dwordx2 a[8:9], v5, s[84:87], s12 offen offset:2048 sc1
buffer_load_dwordx2 a[10:11], v5, s[84:87], s12 offen offset:2560 sc1
buffer_load_dwordx2 a[12:13], v5, s[84:87], s12 offen offset:3072 sc1
buffer_load_dwordx2 a[14:15], v5, s[84:87], s12 offen offset:3584 sc1
s_add_u32 s12, s12, 4096
buffer_load_dwordx2 a[16:17], v5, s[84:87], s12 offen offset:0 sc1
buffer_load_dwordx2 a[18:19], v5, s[84:87], s12 offen offset:512 sc1
buffer_load_dwordx2 a[20:21], v5, s[84:87], s12 offen offset:1024 sc1
buffer_load_dwordx2 a[22:23], v5, s[84:87], s12 offen offset:1536 sc1
buffer_load_dwordx2 a[24:25], v5, s[84:87], s12 offen offset:2048 sc1
buffer_load_dwordx2 a[26:27], v5, s[84:87], s12 offen offset:2560 sc1
buffer_load_dwordx2 a[28:29], v5, s[84:87], s12 offen offset:3072 sc1
buffer_load_dwordx2 a[30:31], v5, s[84:87], s12 offen offset:3584 sc1
s_add_u32 s12, s12, 4096
buffer_load_dwordx2 a[32:33], v5, s[84:87], s12 offen offset:0 sc1
buffer_load_dwordx2 a[34:35], v5, s[84:87], s12 offen offset:512 sc1
buffer_load_dwordx2 a[36:37], v5, s[84:87], s12 offen offset:1024 sc1
buffer_load_dwordx2 a[38:39], v5, s[84:87], s12 offen offset:1536 sc1
buffer_load_dwordx2 a[40:41], v5, s[84:87], s12 offen offset:2048 sc1
buffer_load_dwordx2 a[42:43], v5, s[84:87], s12 offen offset:2560 sc1
buffer_load_dwordx2 a[44:45], v5, s[84:87], s12 offen offset:3072 sc1
buffer_load_dwordx2 a[46:47], v5, s[84:87], s12 offen offset:3584 sc1
s_add_u32 s12, s12, 4096
buffer_load_dwordx2 a[48:49], v5, s[84:87], s12 offen offset:0 sc1
buffer_load_dwordx2 a[50:51], v5, s[84:87], s12 offen offset:512 sc1
buffer_load_dwordx2 a[52:53], v5, s[84:87], s12 offen offset:1024 sc1
buffer_load_dwordx2 a[54:55], v5, s[84:87], s12 offen offset:1536 sc1
buffer_load_dwordx2 a[56:57], v5, s[84:87], s12 offen offset:2048 sc1
buffer_load_dwordx2 a[58:59], v5, s[84:87], s12 offen offset:2560 sc1
buffer_load_dwordx2 a[60:61], v5, s[84:87], s12 offen offset:3072 sc1
buffer_load_dwordx2 a[62:63], v5, s[84:87], s12 offen offset:3584 sc1
s_add_u32 s12, s12, 4096
buffer_load_dword a64, v11, s[84:87], s13 offen offset:0 sc1
buffer_load_dword a65, v11, s[84:87], s13 offen offset:128 sc1
buffer_load_dword a66, v11, s[84:87], s13 offen offset:256 sc1
buffer_load_dword a67, v11, s[84:87], s13 offen offset:384 sc1
buffer_load_dword a68, v11, s[84:87], s13 offen offset:512 sc1
buffer_load_dword a69, v11, s[84:87], s13 offen offset:640 sc1
buffer_load_dword a70, v11, s[84:87], s13 offen offset:768 sc1
buffer_load_dword a71, v11, s[84:87], s13 offen offset:896 sc1
buffer_load_dword a72, v11, s[84:87], s13 offen offset:1024 sc1
buffer_load_dword a73, v11, s[84:87], s13 offen offset:1152 sc1
buffer_load_dword a74, v11, s[84:87], s13 offen offset:1280 sc1
buffer_load_dword a75, v11, s[84:87], s13 offen offset:1408 sc1
buffer_load_dword a76, v11, s[84:87], s13 offen offset:1536 sc1
buffer_load_dword a77, v11, s[84:87], s13 offen offset:1664 sc1
buffer_load_dword a78, v11, s[84:87], s13 offen offset:1792 sc1
buffer_load_dword a79, v11, s[84:87], s13 offen offset:1920 sc1
buffer_load_dword a80, v11, s[84:87], s13 offen offset:2048 sc1
buffer_load_dword a81, v11, s[84:87], s13 offen offset:2176 sc1
buffer_load_dword a82, v11, s[84:87], s13 offen offset:2304 sc1
buffer_load_dword a83, v11, s[84:87], s13 offen offset:2432 sc1
buffer_load_dword a84, v11, s[84:87], s13 offen offset:2560 sc1
buffer_load_dword a85, v11, s[84:87], s13 offen offset:2688 sc1
buffer_load_dword a86, v11, s[84:87], s13 offen offset:2816 sc1
buffer_load_dword a87, v11, s[84:87], s13 offen offset:2944 sc1
buffer_load_dword a88, v11, s[84:87], s13 offen offset:3072 sc1
buffer_load_dword a89, v11, s[84:87], s13 offen offset:3200 sc1
buffer_load_dword a90, v11, s[84:87], s13 offen offset:3328 sc1
buffer_load_dword a91, v11, s[84:87], s13 offen offset:3456 sc1
buffer_load_dword a92, v11, s[84:87], s13 offen offset:3584 sc1
buffer_load_dword a93, v11, s[84:87], s13 offen offset:3712 sc1
buffer_load_dword a94, v11, s[84:87], s13 offen offset:3840 sc1
buffer_load_dword a95, v11, s[84:87], s13 offen offset:3968 sc1
v_pk_add_f32 v[14:15], v[16:17], v[48:49] neg_lo:[0,1] neg_hi:[0,1]
v_pk_add_f32 v[16:17], v[16:17], v[48:49]
v_pk_add_f32 v[48:49], v[18:19], v[50:51] neg_lo:[0,1] neg_hi:[0,1]
v_pk_add_f32 v[18:19], v[18:19], v[50:51]
v_pk_mul_f32 v[50:51], v[48:49], s[50:51] op_sel:[0,0] op_sel_hi:[0,1] neg_lo:[0,0] neg_hi:[0,1]
v_pk_fma_f32 v[50:51], v[48:49], s[50:51], v[50:51] op_sel:[1,1,0] op_sel_hi:[1,0,1] neg_lo:[0,0,0] neg_hi:[0,0,0]
v_pk_add_f32 v[48:49], v[20:21], v[52:53] neg_lo:[0,1] neg_hi:[0,1]
v_pk_add_f32 v[20:21], v[20:21], v[52:53]
v_pk_mul_f32 v[52:53], v[48:49], s[54:55] op_sel:[0,0] op_sel_hi:[0,1] neg_lo:[0,0] neg_hi:[0,1]
v_pk_fma_f32 v[52:53], v[48:49], s[54:55], v[52:53] op_sel:[1,1,0] op_sel_hi:[1,0,1] neg_lo:[0,0,0] neg_hi:[0,0,0]
v_pk_add_f32 v[48:49], v[22:23], v[54:55] neg_lo:[0,1] neg_hi:[0,1]
v_pk_add_f32 v[22:23], v[22:23], v[54:55]
v_pk_mul_f32 v[54:55], v[48:49], s[58:59] op_sel:[0,0] op_sel_hi:[0,1] neg_lo:[0,0] neg_hi:[0,1]
v_pk_fma_f32 v[54:55], v[48:49], s[58:59], v[54:55] op_sel:[1,1,0] op_sel_hi:[1,0,1] neg_lo:[0,0,0] neg_hi:[0,0,0]
v_pk_add_f32 v[48:49], v[24:25], v[56:57] neg_lo:[0,1] neg_hi:[0,1]
v_pk_add_f32 v[24:25], v[24:25], v[56:57]
v_pk_mul_f32 v[56:57], v[48:49], s[62:63] op_sel:[0,0] op_sel_hi:[0,1] neg_lo:[0,0] neg_hi:[0,1]
v_pk_fma_f32 v[56:57], v[48:49], s[62:63], v[56:57] op_sel:[1,1,0] op_sel_hi:[1,0,1] neg_lo:[0,0,0] neg_hi:[0,0,0]
v_pk_add_f32 v[48:49], v[26:27], v[58:59] neg_lo:[0,1] neg_hi:[0,1]
v_pk_add_f32 v[26:27], v[26:27], v[58:59]
v_pk_mul_f32 v[58:59], v[48:49], s[58:59] op_sel:[0,1] op_sel_hi:[0,0] neg_lo:[0,0] neg_hi:[0,1]
v_pk_fma_f32 v[58:59], v[48:49], s[58:59], v[58:59] op_sel:[1,0,0] op_sel_hi:[1,1,1] neg_lo:[0,0,0] neg_hi:[0,0,0]
v_pk_add_f32 v[48:49], v[28:29], v[60:61] neg_lo:[0,1] neg_hi:[0,1]
v_pk_add_f32 v[28:29], v[28:29], v[60:61]
v_pk_mul_f32 v[60:61], v[48:49], s[54:55] op_sel:[0,1] op_sel_hi:[0,0] neg_lo:[0,0] neg_hi:[0,1]
v_pk_fma_f32 v[60:61], v[48:49], s[54:55], v[60:61] op_sel:[1,0,0] op_sel_hi:[1,1,1] neg_lo:[0,0,0] neg_hi:[0,0,0]
v_pk_add_f32 v[48:49], v[30:31], v[62:63] neg_lo:[0,1] neg_hi:[0,1]
v_pk_add_f32 v[30:31], v[30:31], v[62:63]
v_pk_mul_f32 v[62:63], v[48:49], s[50:51] op_sel:[0,1] op_sel_hi:[0,0] neg_lo:[0,0] neg_hi:[0,1]
v_pk_fma_f32 v[62:63], v[48:49], s[50:51], v[62:63] op_sel:[1,0,0] op_sel_hi:[1,1,1] neg_lo:[0,0,0] neg_hi:[0,0,0]
v_pk_add_f32 v[48:49], v[32:33], v[64:65] op_sel:[1,1] op_sel_hi:[0,0] neg_lo:[0,1] neg_hi:[1,0]
v_pk_add_f32 v[32:33], v[32:33], v[64:65]
v_pk_add_f32 v[64:65], v[34:35], v[66:67] neg_lo:[0,1] neg_hi:[0,1]
v_pk_add_f32 v[34:35], v[34:35], v[66:67]
v_pk_mul_f32 v[66:67], v[64:65], s[50:51] op_sel:[0,1] op_sel_hi:[0,0] neg_lo:[0,1] neg_hi:[0,1]
v_pk_fma_f32 v[66:67], v[64:65], s[50:51], v[66:67] op_sel:[1,0,0] op_sel_hi:[1,1,1] neg_lo:[0,0,0] neg_hi:[0,1,0]
v_pk_add_f32 v[64:65], v[36:37], v[68:69] neg_lo:[0,1] neg_hi:[0,1]
v_pk_add_f32 v[36:37], v[36:37], v[68:69]
v_pk_mul_f32 v[68:69], v[64:65], s[54:55] op_sel:[0,1] op_sel_hi:[0,0] neg_lo:[0,1] neg_hi:[0,1]
v_pk_fma_f32 v[68:69], v[64:65], s[54:55], v[68:69] op_sel:[1,0,0] op_sel_hi:[1,1,1] neg_lo:[0,0,0] neg_hi:[0,1,0]
v_pk_add_f32 v[64:65], v[38:39], v[70:71] neg_lo:[0,1] neg_hi:[0,1]
v_pk_add_f32 v[38:39], v[38:39], v[70:71]
v_pk_mul_f32 v[70:71], v[64:65], s[58:59] op_sel:[0,1] op_sel_hi:[0,0] neg_lo:[0,1] neg_hi:[0,1]
v_pk_fma_f32 v[70:71], v[64:65], s[58:59], v[70:71] op_sel:[1,0,0] op_sel_hi:[1,1,1] neg_lo:[0,0,0] neg_hi:[0,1,0]
v_pk_add_f32 v[64:65], v[40:41], v[72:73] neg_lo:[0,1] neg_hi:[0,1]
v_pk_add_f32 v[40:41], v[40:41], v[72:73]
v_pk_mul_f32 v[72:73], v[64:65], s[62:63] op_sel:[0,0] op_sel_hi:[0,1] neg_lo:[0,1] neg_hi:[0,1]
v_pk_fma_f32 v[72:73], v[64:65], s[62:63], v[72:73] op_sel:[1,1,0] op_sel_hi:[1,0,1] neg_lo:[0,0,0] neg_hi:[0,1,0]
v_pk_add_f32 v[64:65], v[42:43], v[74:75] neg_lo:[0,1] neg_hi:[0,1]
v_pk_add_f32 v[42:43], v[42:43], v[74:75]
v_pk_mul_f32 v[74:75], v[64:65], s[58:59] op_sel:[0,0] op_sel_hi:[0,1] neg_lo:[0,1] neg_hi:[0,1]
v_pk_fma_f32 v[74:75], v[64:65], s[58:59], v[74:75] op_sel:[1,1,0] op_sel_hi:[1,0,1] neg_lo:[0,0,0] neg_hi:[0,1,0]
v_pk_add_f32 v[64:65], v[44:45], v[76:77] neg_lo:[0,1] neg_hi:[0,1]
v_pk_add_f32 v[44:45], v[44:45], v[76:77]
v_pk_mul_f32 v[76:77], v[64:65], s[54:55] op_sel:[0,0] op_sel_hi:[0,1] neg_lo:[0,1] neg_hi:[0,1]
v_pk_fma_f32 v[76:77], v[64:65], s[54:55], v[76:77] op_sel:[1,1,0] op_sel_hi:[1,0,1] neg_lo:[0,0,0] neg_hi:[0,1,0]
v_pk_add_f32 v[64:65], v[46:47], v[78:79] neg_lo:[0,1] neg_hi:[0,1]
v_pk_add_f32 v[46:47], v[46:47], v[78:79]
v_pk_mul_f32 v[78:79], v[64:65], s[50:51] op_sel:[0,0] op_sel_hi:[0,1] neg_lo:[0,1] neg_hi:[0,1]
v_pk_fma_f32 v[78:79], v[64:65], s[50:51], v[78:79] op_sel:[1,1,0] op_sel_hi:[1,0,1] neg_lo:[0,0,0] neg_hi:[0,1,0]
v_pk_add_f32 v[64:65], v[16:17], v[32:33] neg_lo:[0,1] neg_hi:[0,1]
v_pk_add_f32 v[16:17], v[16:17], v[32:33]
v_pk_add_f32 v[32:33], v[18:19], v[34:35] neg_lo:[0,1] neg_hi:[0,1]
v_pk_add_f32 v[18:19], v[18:19], v[34:35]
v_pk_mul_f32 v[34:35], v[32:33], s[54:55] op_sel:[0,0] op_sel_hi:[0,1] neg_lo:[0,0] neg_hi:[0,1]
v_pk_fma_f32 v[34:35], v[32:33], s[54:55], v[34:35] op_sel:[1,1,0] op_sel_hi:[1,0,1] neg_lo:[0,0,0] neg_hi:[0,0,0]
v_pk_add_f32 v[32:33], v[20:21], v[36:37] neg_lo:[0,1] neg_hi:[0,1]
v_pk_add_f32 v[20:21], v[20:21], v[36:37]
v_pk_mul_f32 v[36:37], v[32:33], s[62:63] op_sel:[0,0] op_sel_hi:[0,1] neg_lo:[0,0] neg_hi:[0,1]
v_pk_fma_f32 v[36:37], v[32:33], s[62:63], v[36:37] op_sel:[1,1,0] op_sel_hi:[1,0,1] neg_lo:[0,0,0] neg_hi:[0,0,0]
v_pk_add_f32 v[32:33], v[22:23], v[38:39] neg_lo:[0,1] neg_hi:[0,1]
v_pk_add_f32 v[22:23], v[22:23], v[38:39]
v_pk_mul_f32 v[38:39], v[32:33], s[54:55] op_sel:[0,1] op_sel_hi:[0,0] neg_lo:[0,0] neg_hi:[0,1]
v_pk_fma_f32 v[38:39], v[32:33], s[54:55], v[38:39] op_sel:[1,0,0] op_sel_hi:[1,1,1] neg_lo:[0,0,0] neg_hi:[0,0,0]
v_pk_add_f32 v[32:33], v[24:25], v[40:41] op_sel:[1,1] op_sel_hi:[0,0] neg_lo:[0,1] neg_hi:[1,0]
v_pk_add_f32 v[24:25], v[24:25], v[40:41]
v_pk_add_f32 v[40:41], v[26:27], v[42:43] neg_lo:[0,1] neg_hi:[0,1]
v_pk_add_f32 v[26:27], v[26:27], v[42:43]
v_pk_mul_f32 v[42:43], v[40:41], s[54:55] op_sel:[0,1] op_sel_hi:[0,0] neg_lo:[0,1] neg_hi:[0,1]
v_pk_fma_f32 v[42:43], v[40:41], s[54:55], v[42:43] op_sel:[1,0,0] op_sel_hi:[1,1,1] neg_lo:[0,0,0] neg_hi:[0,1,0]
v_pk_add_f32 v[40:41], v[28:29], v[44:45] neg_lo:[0,1] neg_hi:[0,1]
v_pk_add_f32 v[28:29], v[28:29], v[44:45]
v_pk_mul_f32 v[44:45], v[40:41], s[62:63] op_sel:[0,0] op_sel_hi:[0,1] neg_lo:[0,1] neg_hi:[0,1]
v_pk_fma_f32 v[44:45], v[40:41], s[62:63], v[44:45] op_sel:[1,1,0] op_sel_hi:[1,0,1] neg_lo:[0,0,0] neg_hi:[0,1,0]
v_pk_add_f32 v[40:41], v[30:31], v[46:47] neg_lo:[0,1] neg_hi:[0,1]
v_pk_add_f32 v[30:31], v[30:31], v[46:47]
v_pk_mul_f32 v[46:47], v[40:41], s[54:55] op_sel:[0,0] op_sel_hi:[0,1] neg_lo:[0,1] neg_hi:[0,1]
v_pk_fma_f32 v[46:47], v[40:41], s[54:55], v[46:47] op_sel:[1,1,0] op_sel_hi:[1,0,1] neg_lo:[0,0,0] neg_hi:[0,1,0]
v_pk_add_f32 v[40:41], v[14:15], v[48:49] neg_lo:[0,1] neg_hi:[0,1]
v_pk_add_f32 v[14:15], v[14:15], v[48:49]
v_pk_add_f32 v[48:49], v[50:51], v[66:67] neg_lo:[0,1] neg_hi:[0,1]
v_pk_add_f32 v[50:51], v[50:51], v[66:67]
v_pk_mul_f32 v[66:67], v[48:49], s[54:55] op_sel:[0,0] op_sel_hi:[0,1] neg_lo:[0,0] neg_hi:[0,1]
v_pk_fma_f32 v[66:67], v[48:49], s[54:55], v[66:67] op_sel:[1,1,0] op_sel_hi:[1,0,1] neg_lo:[0,0,0] neg_hi:[0,0,0]
v_pk_add_f32 v[48:49], v[52:53], v[68:69] neg_lo:[0,1] neg_hi:[0,1]
v_pk_add_f32 v[52:53], v[52:53], v[68:69]
v_pk_mul_f32 v[68:69], v[48:49], s[62:63] op_sel:[0,0] op_sel_hi:[0,1] neg_lo:[0,0] neg_hi:[0,1]
v_pk_fma_f32 v[68:69], v[48:49], s[62:63], v[68:69] op_sel:[1,1,0] op_sel_hi:[1,0,1] neg_lo:[0,0,0] neg_hi:[0,0,0]
v_pk_add_f32 v[48:49], v[54:55], v[70:71] neg_lo:[0,1] neg_hi:[0,1]
v_pk_add_f32 v[54:55], v[54:55], v[70:71]
v_pk_mul_f32 v[70:71], v[48:49], s[54:55] op_sel:[0,1] op_sel_hi:[0,0] neg_lo:[0,0] neg_hi:[0,1]
v_pk_fma_f32 v[70:71], v[48:49], s[54:55], v[70:71] op_sel:[1,0,0] op_sel_hi:[1,1,1] neg_lo:[0,0,0] neg_hi:[0,0,0]
v_pk_add_f32 v[48:49], v[56:57], v[72:73] op_sel:[1,1] op_sel_hi:[0,0] neg_lo:[0,1] neg_hi:[1,0]
v_pk_add_f32 v[56:57], v[56:57], v[72:73]
v_pk_add_f32 v[72:73], v[58:59], v[74:75] neg_lo:[0,1] neg_hi:[0,1]
v_pk_add_f32 v[58:59], v[58:59], v[74:75]
v_pk_mul_f32 v[74:75], v[72:73], s[54:55] op_sel:[0,1] op_sel_hi:[0,0] neg_lo:[0,1] neg_hi:[0,1]
v_pk_fma_f32 v[74:75], v[72:73], s[54:55], v[74:75] op_sel:[1,0,0] op_sel_hi:[1,1,1] neg_lo:[0,0,0] neg_hi:[0,1,0]
v_pk_add_f32 v[72:73], v[60:61], v[76:77] neg_lo:[0,1] neg_hi:[0,1]
v_pk_add_f32 v[60:61], v[60:61], v[76:77]
v_pk_mul_f32 v[76:77], v[72:73], s[62:63] op_sel:[0,0] op_sel_hi:[0,1] neg_lo:[0,1] neg_hi:[0,1]
v_pk_fma_f32 v[76:77], v[72:73], s[62:63], v[76:77] op_sel:[1,1,0] op_sel_hi:[1,0,1] neg_lo:[0,0,0] neg_hi:[0,1,0]
v_pk_add_f32 v[72:73], v[62:63], v[78:79] neg_lo:[0,1] neg_hi:[0,1]
v_pk_add_f32 v[62:63], v[62:63], v[78:79]
v_pk_mul_f32 v[78:79], v[72:73], s[54:55] op_sel:[0,0] op_sel_hi:[0,1] neg_lo:[0,1] neg_hi:[0,1]
v_pk_fma_f32 v[78:79], v[72:73], s[54:55], v[78:79] op_sel:[1,1,0] op_sel_hi:[1,0,1] neg_lo:[0,0,0] neg_hi:[0,1,0]
v_pk_add_f32 v[72:73], v[16:17], v[24:25] neg_lo:[0,1] neg_hi:[0,1]
v_pk_add_f32 v[16:17], v[16:17], v[24:25]
v_pk_add_f32 v[24:25], v[18:19], v[26:27] neg_lo:[0,1] neg_hi:[0,1]
v_pk_add_f32 v[18:19], v[18:19], v[26:27]
v_pk_mul_f32 v[26:27], v[24:25], s[62:63] op_sel:[0,0] op_sel_hi:[0,1] neg_lo:[0,0] neg_hi:[0,1]
v_pk_fma_f32 v[26:27], v[24:25], s[62:63], v[26:27] op_sel:[1,1,0] op_sel_hi:[1,0,1] neg_lo:[0,0,0] neg_hi:[0,0,0]
v_pk_add_f32 v[24:25], v[20:21], v[28:29] op_sel:[1,1] op_sel_hi:[0,0] neg_lo:[0,1] neg_hi:[1,0]
v_pk_add_f32 v[20:21], v[20:21], v[28:29]
v_pk_add_f32 v[28:29], v[22:23], v[30:31] neg_lo:[0,1] neg_hi:[0,1]
v_pk_add_f32 v[22:23], v[22:23], v[30:31]
v_pk_mul_f32 v[30:31], v[28:29], s[62:63] op_sel:[0,0] op_sel_hi:[0,1] neg_lo:[0,1] neg_hi:[0,1]
v_pk_fma_f32 v[30:31], v[28:29], s[62:63], v[30:31] op_sel:[1,1,0] op_sel_hi:[1,0,1] neg_lo:[0,0,0] neg_hi:[0,1,0]
v_pk_add_f32 v[28:29], v[64:65], v[32:33] neg_lo:[0,1] neg_hi:[0,1]
v_pk_add_f32 v[64:65], v[64:65], v[32:33]
v_pk_add_f32 v[32:33], v[34:35], v[42:43] neg_lo:[0,1] neg_hi:[0,1]
v_pk_add_f32 v[34:35], v[34:35], v[42:43]
v_pk_mul_f32 v[42:43], v[32:33], s[62:63] op_sel:[0,0] op_sel_hi:[0,1] neg_lo:[0,0] neg_hi:[0,1]
v_pk_fma_f32 v[42:43], v[32:33], s[62:63], v[42:43] op_sel:[1,1,0] op_sel_hi:[1,0,1] neg_lo:[0,0,0] neg_hi:[0,0,0]
v_pk_add_f32 v[32:33], v[36:37], v[44:45] op_sel:[1,1] op_sel_hi:[0,0] neg_lo:[0,1] neg_hi:[1,0]
v_pk_add_f32 v[36:37], v[36:37], v[44:45]
v_pk_add_f32 v[44:45], v[38:39], v[46:47] neg_lo:[0,1] neg_hi:[0,1]
v_pk_add_f32 v[38:39], v[38:39], v[46:47]
v_pk_mul_f32 v[46:47], v[44:45], s[62:63] op_sel:[0,0] op_sel_hi:[0,1] neg_lo:[0,1] neg_hi:[0,1]
v_pk_fma_f32 v[46:47], v[44:45], s[62:63], v[46:47] op_sel:[1,1,0] op_sel_hi:[1,0,1] neg_lo:[0,0,0] neg_hi:[0,1,0]
v_pk_add_f32 v[44:45], v[14:15], v[56:57] neg_lo:[0,1] neg_hi:[0,1]
v_pk_add_f32 v[14:15], v[14:15], v[56:57]
v_pk_add_f32 v[56:57], v[50:51], v[58:59] neg_lo:[0,1] neg_hi:[0,1]
v_pk_add_f32 v[50:51], v[50:51], v[58:59]
v_pk_mul_f32 v[58:59], v[56:57], s[62:63] op_sel:[0,0] op_sel_hi:[0,1] neg_lo:[0,0] neg_hi:[0,1]
v_pk_fma_f32 v[58:59], v[56:57], s[62:63], v[58:59] op_sel:[1,1,0] op_sel_hi:[1,0,1] neg_lo:[0,0,0] neg_hi:[0,0,0]
v_pk_add_f32 v[56:57], v[52:53], v[60:61] op_sel:[1,1] op_sel_hi:[0,0] neg_lo:[0,1] neg_hi:[1,0]
v_pk_add_f32 v[52:53], v[52:53], v[60:61]
v_pk_add_f32 v[60:61], v[54:55], v[62:63] neg_lo:[0,1] neg_hi:[0,1]
v_pk_add_f32 v[54:55], v[54:55], v[62:63]
v_pk_mul_f32 v[62:63], v[60:61], s[62:63] op_sel:[0,0] op_sel_hi:[0,1] neg_lo:[0,1] neg_hi:[0,1]
v_pk_fma_f32 v[62:63], v[60:61], s[62:63], v[62:63] op_sel:[1,1,0] op_sel_hi:[1,0,1] neg_lo:[0,0,0] neg_hi:[0,1,0]
v_pk_add_f32 v[60:61], v[40:41], v[48:49] neg_lo:[0,1] neg_hi:[0,1]
v_pk_add_f32 v[40:41], v[40:41], v[48:49]
v_pk_add_f32 v[48:49], v[66:67], v[74:75] neg_lo:[0,1] neg_hi:[0,1]
v_pk_add_f32 v[66:67], v[66:67], v[74:75]
v_pk_mul_f32 v[74:75], v[48:49], s[62:63] op_sel:[0,0] op_sel_hi:[0,1] neg_lo:[0,0] neg_hi:[0,1]
v_pk_fma_f32 v[74:75], v[48:49], s[62:63], v[74:75] op_sel:[1,1,0] op_sel_hi:[1,0,1] neg_lo:[0,0,0] neg_hi:[0,0,0]
v_pk_add_f32 v[48:49], v[68:69], v[76:77] op_sel:[1,1] op_sel_hi:[0,0] neg_lo:[0,1] neg_hi:[1,0]
v_pk_add_f32 v[68:69], v[68:69], v[76:77]
v_pk_add_f32 v[76:77], v[70:71], v[78:79] neg_lo:[0,1] neg_hi:[0,1]
v_pk_add_f32 v[70:71], v[70:71], v[78:79]
v_pk_mul_f32 v[78:79], v[76:77], s[62:63] op_sel:[0,0] op_sel_hi:[0,1] neg_lo:[0,1] neg_hi:[0,1]
v_pk_fma_f32 v[78:79], v[76:77], s[62:63], v[78:79] op_sel:[1,1,0] op_sel_hi:[1,0,1] neg_lo:[0,0,0] neg_hi:[0,1,0]
v_pk_add_f32 v[76:77], v[16:17], v[20:21] neg_lo:[0,1] neg_hi:[0,1]
v_pk_add_f32 v[16:17], v[16:17], v[20:21]
v_pk_add_f32 v[20:21], v[18:19], v[22:23] op_sel:[1,1] op_sel_hi:[0,0] neg_lo:[0,1] neg_hi:[1,0]
v_pk_add_f32 v[18:19], v[18:19], v[22:23]
v_pk_add_f32 v[22:23], v[72:73], v[24:25] neg_lo:[0,1] neg_hi:[0,1]
v_pk_add_f32 v[72:73], v[72:73], v[24:25]
v_pk_add_f32 v[24:25], v[26:27], v[30:31] op_sel:[1,1] op_sel_hi:[0,0] neg_lo:[0,1] neg_hi:[1,0]
v_pk_add_f32 v[26:27], v[26:27], v[30:31]
v_pk_add_f32 v[30:31], v[64:65], v[36:37] neg_lo:[0,1] neg_hi:[0,1]
v_pk_add_f32 v[64:65], v[64:65], v[36:37]
v_pk_add_f32 v[36:37], v[34:35], v[38:39] op_sel:[1,1] op_sel_hi:[0,0] neg_lo:[0,1] neg_hi:[1,0]
v_pk_add_f32 v[34:35], v[34:35], v[38:39]
v_pk_add_f32 v[38:39], v[28:29], v[32:33] neg_lo:[0,1] neg_hi:[0,1]
v_pk_add_f32 v[28:29], v[28:29], v[32:33]
v_pk_add_f32 v[32:33], v[42:43], v[46:47] op_sel:[1,1] op_sel_hi:[0,0] neg_lo:[0,1] neg_hi:[1,0]
v_pk_add_f32 v[42:43], v[42:43], v[46:47]
v_pk_add_f32 v[46:47], v[14:15], v[52:53] neg_lo:[0,1] neg_hi:[0,1]
v_pk_add_f32 v[14:15], v[14:15], v[52:53]
v_pk_add_f32 v[52:53], v[50:51], v[54:55] op_sel:[1,1] op_sel_hi:[0,0] neg_lo:[0,1] neg_hi:[1,0]
v_pk_add_f32 v[50:51], v[50:51], v[54:55]
v_pk_add_f32 v[54:55], v[44:45], v[56:57] neg_lo:[0,1] neg_hi:[0,1]
v_pk_add_f32 v[44:45], v[44:45], v[56:57]
v_pk_add_f32 v[56:57], v[58:59], v[62:63] op_sel:[1,1] op_sel_hi:[0,0] neg_lo:[0,1] neg_hi:[1,0]
v_pk_add_f32 v[58:59], v[58:59], v[62:63]
v_pk_add_f32 v[62:63], v[40:41], v[68:69] neg_lo:[0,1] neg_hi:[0,1]
v_pk_add_f32 v[40:41], v[40:41], v[68:69]
v_pk_add_f32 v[68:69], v[66:67], v[70:71] op_sel:[1,1] op_sel_hi:[0,0] neg_lo:[0,1] neg_hi:[1,0]
v_pk_add_f32 v[66:67], v[66:67], v[70:71]
v_pk_add_f32 v[70:71], v[60:61], v[48:49] neg_lo:[0,1] neg_hi:[0,1]
v_pk_add_f32 v[60:61], v[60:61], v[48:49]
v_pk_add_f32 v[48:49], v[74:75], v[78:79] op_sel:[1,1] op_sel_hi:[0,0] neg_lo:[0,1] neg_hi:[1,0]
v_pk_add_f32 v[74:75], v[74:75], v[78:79]
v_pk_add_f32 v[78:79], v[16:17], v[18:19] neg_lo:[0,1] neg_hi:[0,1]
v_pk_add_f32 v[16:17], v[16:17], v[18:19]
v_pk_add_f32 v[18:19], v[76:77], v[20:21] neg_lo:[0,1] neg_hi:[0,1]
v_pk_add_f32 v[76:77], v[76:77], v[20:21]
v_pk_add_f32 v[20:21], v[72:73], v[26:27] neg_lo:[0,1] neg_hi:[0,1]
v_pk_add_f32 v[72:73], v[72:73], v[26:27]
v_pk_add_f32 v[26:27], v[22:23], v[24:25] neg_lo:[0,1] neg_hi:[0,1]
v_pk_add_f32 v[22:23], v[22:23], v[24:25]
v_pk_add_f32 v[24:25], v[64:65], v[34:35] neg_lo:[0,1] neg_hi:[0,1]
v_pk_add_f32 v[64:65], v[64:65], v[34:35]
v_pk_add_f32 v[34:35], v[30:31], v[36:37] neg_lo:[0,1] neg_hi:[0,1]
v_pk_add_f32 v[30:31], v[30:31], v[36:37]
v_pk_add_f32 v[36:37], v[28:29], v[42:43] neg_lo:[0,1] neg_hi:[0,1]
v_pk_add_f32 v[28:29], v[28:29], v[42:43]
v_pk_add_f32 v[42:43], v[38:39], v[32:33] neg_lo:[0,1] neg_hi:[0,1]
v_pk_add_f32 v[38:39], v[38:39], v[32:33]
v_pk_add_f32 v[32:33], v[14:15], v[50:51] neg_lo:[0,1] neg_hi:[0,1]
v_pk_add_f32 v[14:15], v[14:15], v[50:51]
v_pk_add_f32 v[50:51], v[46:47], v[52:53] neg_lo:[0,1] neg_hi:[0,1]
v_pk_add_f32 v[46:47], v[46:47], v[52:53]
v_pk_add_f32 v[52:53], v[44:45], v[58:59] neg_lo:[0,1] neg_hi:[0,1]
v_pk_add_f32 v[44:45], v[44:45], v[58:59]
v_pk_add_f32 v[58:59], v[54:55], v[56:57] neg_lo:[0,1] neg_hi:[0,1]
v_pk_add_f32 v[54:55], v[54:55], v[56:57]
v_pk_add_f32 v[56:57], v[40:41], v[66:67] neg_lo:[0,1] neg_hi:[0,1]
v_pk_add_f32 v[40:41], v[40:41], v[66:67]
v_pk_add_f32 v[66:67], v[62:63], v[68:69] neg_lo:[0,1] neg_hi:[0,1]
v_pk_add_f32 v[62:63], v[62:63], v[68:69]
v_pk_add_f32 v[68:69], v[60:61], v[74:75] neg_lo:[0,1] neg_hi:[0,1]
v_pk_add_f32 v[60:61], v[60:61], v[74:75]
v_pk_add_f32 v[74:75], v[70:71], v[48:49] neg_lo:[0,1] neg_hi:[0,1]
v_pk_add_f32 v[70:71], v[70:71], v[48:49]
v_pk_mul_f32 v[48:49], v[14:15], v[82:83] op_sel:[0,0] op_sel_hi:[0,1] neg_lo:[0,0] neg_hi:[0,0]
v_pk_fma_f32 v[14:15], v[14:15], v[82:83], v[48:49] op_sel:[1,1,0] op_sel_hi:[1,0,1] neg_lo:[0,1,0] neg_hi:[0,0,0]
v_pk_mul_f32 v[48:49], v[64:65], v[84:85] op_sel:[0,0] op_sel_hi:[0,1] neg_lo:[0,0] neg_hi:[0,0]
v_pk_fma_f32 v[64:65], v[64:65], v[84:85], v[48:49] op_sel:[1,1,0] op_sel_hi:[1,0,1] neg_lo:[0,1,0] neg_hi:[0,0,0]
v_pk_mul_f32 v[48:49], v[40:41], v[86:87] op_sel:[0,0] op_sel_hi:[0,1] neg_lo:[0,0] neg_hi:[0,0]
v_pk_fma_f32 v[40:41], v[40:41], v[86:87], v[48:49] op_sel:[1,1,0] op_sel_hi:[1,0,1] neg_lo:[0,1,0] neg_hi:[0,0,0]
v_pk_mul_f32 v[48:49], v[72:73], v[88:89] op_sel:[0,0] op_sel_hi:[0,1] neg_lo:[0,0] neg_hi:[0,0]
v_pk_fma_f32 v[72:73], v[72:73], v[88:89], v[48:49] op_sel:[1,1,0] op_sel_hi:[1,0,1] neg_lo:[0,1,0] neg_hi:[0,0,0]
v_pk_mul_f32 v[48:49], v[44:45], v[90:91] op_sel:[0,0] op_sel_hi:[0,1] neg_lo:[0,0] neg_hi:[0,0]
v_pk_fma_f32 v[44:45], v[44:45], v[90:91], v[48:49] op_sel:[1,1,0] op_sel_hi:[1,0,1] neg_lo:[0,1,0] neg_hi:[0,0,0]
v_pk_mul_f32 v[48:49], v[28:29], v[92:93] op_sel:[0,0] op_sel_hi:[0,1] neg_lo:[0,0] neg_hi:[0,0]
v_pk_fma_f32 v[28:29], v[28:29], v[92:93], v[48:49] op_sel:[1,1,0] op_sel_hi:[1,0,1] neg_lo:[0,1,0] neg_hi:[0,0,0]
v_pk_mul_f32 v[48:49], v[60:61], v[94:95] op_sel:[0,0] op_sel_hi:[0,1] neg_lo:[0,0] neg_hi:[0,0]
v_pk_fma_f32 v[60:61], v[60:61], v[94:95], v[48:49] op_sel:[1,1,0] op_sel_hi:[1,0,1] neg_lo:[0,1,0] neg_hi:[0,0,0]
v_pk_mul_f32 v[48:49], v[76:77], v[96:97] op_sel:[0,0] op_sel_hi:[0,1] neg_lo:[0,0] neg_hi:[0,0]
v_pk_fma_f32 v[76:77], v[76:77], v[96:97], v[48:49] op_sel:[1,1,0] op_sel_hi:[1,0,1] neg_lo:[0,1,0] neg_hi:[0,0,0]
v_pk_mul_f32 v[48:49], v[46:47], v[98:99] op_sel:[0,0] op_sel_hi:[0,1] neg_lo:[0,0] neg_hi:[0,0]
v_pk_fma_f32 v[46:47], v[46:47], v[98:99], v[48:49] op_sel:[1,1,0] op_sel_hi:[1,0,1] neg_lo:[0,1,0] neg_hi:[0,0,0]
v_pk_mul_f32 v[48:49], v[30:31], v[100:101] op_sel:[0,0] op_sel_hi:[0,1] neg_lo:[0,0] neg_hi:[0,0]
v_pk_fma_f32 v[30:31], v[30:31], v[100:101], v[48:49] op_sel:[1,1,0] op_sel_hi:[1,0,1] neg_lo:[0,1,0] neg_hi:[0,0,0]
v_pk_mul_f32 v[48:49], v[62:63], v[102:103] op_sel:[0,0] op_sel_hi:[0,1] neg_lo:[0,0] neg_hi:[0,0]
v_pk_fma_f32 v[62:63], v[62:63], v[102:103], v[48:49] op_sel:[1,1,0] op_sel_hi:[1,0,1] neg_lo:[0,1,0] neg_hi:[0,0,0]
v_pk_mul_f32 v[48:49], v[22:23], v[104:105] op_sel:[0,0] op_sel_hi:[0,1] neg_lo:[0,0] neg_hi:[0,0]
v_pk_fma_f32 v[22:23], v[22:23], v[104:105], v[48:49] op_sel:[1,1,0] op_sel_hi:[1,0,1] neg_lo:[0,1,0] neg_hi:[0,0,0]
v_pk_mul_f32 v[48:49], v[54:55], v[106:107] op_sel:[0,0] op_sel_hi:[0,1] neg_lo:[0,0] neg_hi:[0,0]
v_pk_fma_f32 v[54:55], v[54:55], v[106:107], v[48:49] op_sel:[1,1,0] op_sel_hi:[1,0,1] neg_lo:[0,1,0] neg_hi:[0,0,0]
v_pk_mul_f32 v[48:49], v[38:39], v[108:109] op_sel:[0,0] op_sel_hi:[0,1] neg_lo:[0,0] neg_hi:[0,0]
v_pk_fma_f32 v[38:39], v[38:39], v[108:109], v[48:49] op_sel:[1,1,0] op_sel_hi:[1,0,1] neg_lo:[0,1,0] neg_hi:[0,0,0]
v_pk_mul_f32 v[48:49], v[70:71], v[110:111] op_sel:[0,0] op_sel_hi:[0,1] neg_lo:[0,0] neg_hi:[0,0]
v_pk_fma_f32 v[70:71], v[70:71], v[110:111], v[48:49] op_sel:[1,1,0] op_sel_hi:[1,0,1] neg_lo:[0,1,0] neg_hi:[0,0,0]
v_pk_mul_f32 v[48:49], v[78:79], v[112:113] op_sel:[0,0] op_sel_hi:[0,1] neg_lo:[0,0] neg_hi:[0,0]
v_pk_fma_f32 v[78:79], v[78:79], v[112:113], v[48:49] op_sel:[1,1,0] op_sel_hi:[1,0,1] neg_lo:[0,1,0] neg_hi:[0,0,0]
v_pk_mul_f32 v[48:49], v[32:33], v[114:115] op_sel:[0,0] op_sel_hi:[0,1] neg_lo:[0,0] neg_hi:[0,0]
v_pk_fma_f32 v[32:33], v[32:33], v[114:115], v[48:49] op_sel:[1,1,0] op_sel_hi:[1,0,1] neg_lo:[0,1,0] neg_hi:[0,0,0]
v_pk_mul_f32 v[48:49], v[24:25], v[116:117] op_sel:[0,0] op_sel_hi:[0,1] neg_lo:[0,0] neg_hi:[0,0]
v_pk_fma_f32 v[24:25], v[24:25], v[116:117], v[48:49] op_sel:[1,1,0] op_sel_hi:[1,0,1] neg_lo:[0,1,0] neg_hi:[0,0,0]
v_pk_mul_f32 v[48:49], v[56:57], v[118:119] op_sel:[0,0] op_sel_hi:[0,1] neg_lo:[0,0] neg_hi:[0,0]
v_pk_fma_f32 v[56:57], v[56:57], v[118:119], v[48:49] op_sel:[1,1,0] op_sel_hi:[1,0,1] neg_lo:[0,1,0] neg_hi:[0,0,0]
v_pk_mul_f32 v[48:49], v[20:21], v[120:121] op_sel:[0,0] op_sel_hi:[0,1] neg_lo:[0,0] neg_hi:[0,0]
v_pk_fma_f32 v[20:21], v[20:21], v[120:121], v[48:49] op_sel:[1,1,0] op_sel_hi:[1,0,1] neg_lo:[0,1,0] neg_hi:[0,0,0]
v_pk_mul_f32 v[48:49], v[52:53], v[122:123] op_sel:[0,0] op_sel_hi:[0,1] neg_lo:[0,0] neg_hi:[0,0]
v_pk_fma_f32 v[52:53], v[52:53], v[122:123], v[48:49] op_sel:[1,1,0] op_sel_hi:[1,0,1] neg_lo:[0,1,0] neg_hi:[0,0,0]
v_pk_mul_f32 v[48:49], v[36:37], v[124:125] op_sel:[0,0] op_sel_hi:[0,1] neg_lo:[0,0] neg_hi:[0,0]
v_pk_fma_f32 v[36:37], v[36:37], v[124:125], v[48:49] op_sel:[1,1,0] op_sel_hi:[1,0,1] neg_lo:[0,1,0] neg_hi:[0,0,0]
v_pk_mul_f32 v[48:49], v[68:69], v[126:127] op_sel:[0,0] op_sel_hi:[0,1] neg_lo:[0,0] neg_hi:[0,0]
v_pk_fma_f32 v[68:69], v[68:69], v[126:127], v[48:49] op_sel:[1,1,0] op_sel_hi:[1,0,1] neg_lo:[0,1,0] neg_hi:[0,0,0]
v_pk_mul_f32 v[48:49], v[18:19], v[128:129] op_sel:[0,0] op_sel_hi:[0,1] neg_lo:[0,0] neg_hi:[0,0]
v_pk_fma_f32 v[18:19], v[18:19], v[128:129], v[48:49] op_sel:[1,1,0] op_sel_hi:[1,0,1] neg_lo:[0,1,0] neg_hi:[0,0,0]
v_pk_mul_f32 v[48:49], v[50:51], v[130:131] op_sel:[0,0] op_sel_hi:[0,1] neg_lo:[0,0] neg_hi:[0,0]
v_pk_fma_f32 v[50:51], v[50:51], v[130:131], v[48:49] op_sel:[1,1,0] op_sel_hi:[1,0,1] neg_lo:[0,1,0] neg_hi:[0,0,0]
v_pk_mul_f32 v[48:49], v[34:35], v[132:133] op_sel:[0,0] op_sel_hi:[0,1] neg_lo:[0,0] neg_hi:[0,0]
v_pk_fma_f32 v[34:35], v[34:35], v[132:133], v[48:49] op_sel:[1,1,0] op_sel_hi:[1,0,1] neg_lo:[0,1,0] neg_hi:[0,0,0]
v_pk_mul_f32 v[48:49], v[66:67], v[134:135] op_sel:[0,0] op_sel_hi:[0,1] neg_lo:[0,0] neg_hi:[0,0]
v_pk_fma_f32 v[66:67], v[66:67], v[134:135], v[48:49] op_sel:[1,1,0] op_sel_hi:[1,0,1] neg_lo:[0,1,0] neg_hi:[0,0,0]
v_pk_mul_f32 v[48:49], v[26:27], v[136:137] op_sel:[0,0] op_sel_hi:[0,1] neg_lo:[0,0] neg_hi:[0,0]
v_pk_fma_f32 v[26:27], v[26:27], v[136:137], v[48:49] op_sel:[1,1,0] op_sel_hi:[1,0,1] neg_lo:[0,1,0] neg_hi:[0,0,0]
v_pk_mul_f32 v[48:49], v[58:59], v[138:139] op_sel:[0,0] op_sel_hi:[0,1] neg_lo:[0,0] neg_hi:[0,0]
v_pk_fma_f32 v[58:59], v[58:59], v[138:139], v[48:49] op_sel:[1,1,0] op_sel_hi:[1,0,1] neg_lo:[0,1,0] neg_hi:[0,0,0]
v_pk_mul_f32 v[48:49], v[42:43], v[140:141] op_sel:[0,0] op_sel_hi:[0,1] neg_lo:[0,0] neg_hi:[0,0]
v_pk_fma_f32 v[42:43], v[42:43], v[140:141], v[48:49] op_sel:[1,1,0] op_sel_hi:[1,0,1] neg_lo:[0,1,0] neg_hi:[0,0,0]
v_pk_mul_f32 v[48:49], v[74:75], v[142:143] op_sel:[0,0] op_sel_hi:[0,1] neg_lo:[0,0] neg_hi:[0,0]
v_pk_fma_f32 v[74:75], v[74:75], v[142:143], v[48:49] op_sel:[1,1,0] op_sel_hi:[1,0,1] neg_lo:[0,1,0] neg_hi:[0,0,0]
ds_write_b64 v3, v[16:17] offset:0
ds_write_b64 v3, v[14:15] offset:528
ds_write_b64 v3, v[64:65] offset:1056
ds_write_b64 v3, v[40:41] offset:1584
ds_write_b64 v3, v[72:73] offset:2112
ds_write_b64 v3, v[44:45] offset:2640
ds_write_b64 v3, v[28:29] offset:3168
ds_write_b64 v3, v[60:61] offset:3696
ds_write_b64 v3, v[76:77] offset:4224
ds_write_b64 v3, v[46:47] offset:4752
ds_write_b64 v3, v[30:31] offset:5280
ds_write_b64 v3, v[62:63] offset:5808
ds_write_b64 v3, v[22:23] offset:6336
ds_write_b64 v3, v[54:55] offset:6864
ds_write_b64 v3, v[38:39] offset:7392
ds_write_b64 v3, v[70:71] offset:7920
ds_write_b64 v3, v[78:79] offset:8448
ds_write_b64 v3, v[32:33] offset:8976
ds_write_b64 v3, v[24:25] offset:9504
ds_write_b64 v3, v[56:57] offset:10032
ds_write_b64 v3, v[20:21] offset:10560
ds_write_b64 v3, v[52:53] offset:11088
ds_write_b64 v3, v[36:37] offset:11616
ds_write_b64 v3, v[68:69] offset:12144
ds_write_b64 v3, v[18:19] offset:12672
ds_write_b64 v3, v[50:51] offset:13200
ds_write_b64 v3, v[34:35] offset:13728
ds_write_b64 v3, v[66:67] offset:14256
ds_write_b64 v3, v[26:27] offset:14784
ds_write_b64 v3, v[58:59] offset:15312
ds_write_b64 v3, v[42:43] offset:15840
ds_write_b64 v3, v[74:75] offset:16368
s_waitcnt lgkmcnt(0)
ds_read_b64 v[16:17], v4 offset:0
ds_read_b64 v[48:49], v4 offset:256
ds_read_b64 v[18:19], v4 offset:16
ds_read_b64 v[50:51], v4 offset:272
ds_read_b64 v[20:21], v4 offset:32
ds_read_b64 v[52:53], v4 offset:288
ds_read_b64 v[22:23], v4 offset:48
ds_read_b64 v[54:55], v4 offset:304
ds_read_b64 v[24:25], v4 offset:64
ds_read_b64 v[56:57], v4 offset:320
ds_read_b64 v[26:27], v4 offset:80
ds_read_b64 v[58:59], v4 offset:336
ds_read_b64 v[28:29], v4 offset:96
ds_read_b64 v[60:61], v4 offset:352
ds_read_b64 v[30:31], v4 offset:112
ds_read_b64 v[62:63], v4 offset:368
ds_read_b64 v[32:33], v4 offset:128
ds_read_b64 v[64:65], v4 offset:384
ds_read_b64 v[34:35], v4 offset:144
ds_read_b64 v[66:67], v4 offset:400
ds_read_b64 v[36:37], v4 offset:160
ds_read_b64 v[68:69], v4 offset:416
ds_read_b64 v[38:39], v4 offset:176
ds_read_b64 v[70:71], v4 offset:432
ds_read_b64 v[40:41], v4 offset:192
ds_read_b64 v[72:73], v4 offset:448
ds_read_b64 v[42:43], v4 offset:208
ds_read_b64 v[74:75], v4 offset:464
ds_read_b64 v[44:45], v4 offset:224
ds_read_b64 v[76:77], v4 offset:480
ds_read_b64 v[46:47], v4 offset:240
ds_read_b64 v[78:79], v4 offset:496
s_waitcnt lgkmcnt(0)
v_pk_add_f32 v[14:15], v[16:17], v[48:49] neg_lo:[0,1] neg_hi:[0,1]
v_pk_add_f32 v[16:17], v[16:17], v[48:49]
v_pk_add_f32 v[48:49], v[18:19], v[50:51] neg_lo:[0,1] neg_hi:[0,1]
v_pk_add_f32 v[18:19], v[18:19], v[50:51]
v_pk_mul_f32 v[50:51], v[48:49], s[50:51] op_sel:[0,0] op_sel_hi:[0,1] neg_lo:[0,0] neg_hi:[0,1]
v_pk_fma_f32 v[50:51], v[48:49], s[50:51], v[50:51] op_sel:[1,1,0] op_sel_hi:[1,0,1] neg_lo:[0,0,0] neg_hi:[0,0,0]
v_pk_add_f32 v[48:49], v[20:21], v[52:53] neg_lo:[0,1] neg_hi:[0,1]
v_pk_add_f32 v[20:21], v[20:21], v[52:53]
v_pk_mul_f32 v[52:53], v[48:49], s[54:55] op_sel:[0,0] op_sel_hi:[0,1] neg_lo:[0,0] neg_hi:[0,1]
v_pk_fma_f32 v[52:53], v[48:49], s[54:55], v[52:53] op_sel:[1,1,0] op_sel_hi:[1,0,1] neg_lo:[0,0,0] neg_hi:[0,0,0]
v_pk_add_f32 v[48:49], v[22:23], v[54:55] neg_lo:[0,1] neg_hi:[0,1]
v_pk_add_f32 v[22:23], v[22:23], v[54:55]
v_pk_mul_f32 v[54:55], v[48:49], s[58:59] op_sel:[0,0] op_sel_hi:[0,1] neg_lo:[0,0] neg_hi:[0,1]
v_pk_fma_f32 v[54:55], v[48:49], s[58:59], v[54:55] op_sel:[1,1,0] op_sel_hi:[1,0,1] neg_lo:[0,0,0] neg_hi:[0,0,0]
v_pk_add_f32 v[48:49], v[24:25], v[56:57] neg_lo:[0,1] neg_hi:[0,1]
v_pk_add_f32 v[24:25], v[24:25], v[56:57]
v_pk_mul_f32 v[56:57], v[48:49], s[62:63] op_sel:[0,0] op_sel_hi:[0,1] neg_lo:[0,0] neg_hi:[0,1]
v_pk_fma_f32 v[56:57], v[48:49], s[62:63], v[56:57] op_sel:[1,1,0] op_sel_hi:[1,0,1] neg_lo:[0,0,0] neg_hi:[0,0,0]
v_pk_add_f32 v[48:49], v[26:27], v[58:59] neg_lo:[0,1] neg_hi:[0,1]
v_pk_add_f32 v[26:27], v[26:27], v[58:59]
v_pk_mul_f32 v[58:59], v[48:49], s[58:59] op_sel:[0,1] op_sel_hi:[0,0] neg_lo:[0,0] neg_hi:[0,1]
v_pk_fma_f32 v[58:59], v[48:49], s[58:59], v[58:59] op_sel:[1,0,0] op_sel_hi:[1,1,1] neg_lo:[0,0,0] neg_hi:[0,0,0]
v_pk_add_f32 v[48:49], v[28:29], v[60:61] neg_lo:[0,1] neg_hi:[0,1]
v_pk_add_f32 v[28:29], v[28:29], v[60:61]
v_pk_mul_f32 v[60:61], v[48:49], s[54:55] op_sel:[0,1] op_sel_hi:[0,0] neg_lo:[0,0] neg_hi:[0,1]
v_pk_fma_f32 v[60:61], v[48:49], s[54:55], v[60:61] op_sel:[1,0,0] op_sel_hi:[1,1,1] neg_lo:[0,0,0] neg_hi:[0,0,0]
v_pk_add_f32 v[48:49], v[30:31], v[62:63] neg_lo:[0,1] neg_hi:[0,1]
v_pk_add_f32 v[30:31], v[30:31], v[62:63]
v_pk_mul_f32 v[62:63], v[48:49], s[50:51] op_sel:[0,1] op_sel_hi:[0,0] neg_lo:[0,0] neg_hi:[0,1]
v_pk_fma_f32 v[62:63], v[48:49], s[50:51], v[62:63] op_sel:[1,0,0] op_sel_hi:[1,1,1] neg_lo:[0,0,0] neg_hi:[0,0,0]
v_pk_add_f32 v[48:49], v[32:33], v[64:65] op_sel:[1,1] op_sel_hi:[0,0] neg_lo:[0,1] neg_hi:[1,0]
v_pk_add_f32 v[32:33], v[32:33], v[64:65]
v_pk_add_f32 v[64:65], v[34:35], v[66:67] neg_lo:[0,1] neg_hi:[0,1]
v_pk_add_f32 v[34:35], v[34:35], v[66:67]
v_pk_mul_f32 v[66:67], v[64:65], s[50:51] op_sel:[0,1] op_sel_hi:[0,0] neg_lo:[0,1] neg_hi:[0,1]
v_pk_fma_f32 v[66:67], v[64:65], s[50:51], v[66:67] op_sel:[1,0,0] op_sel_hi:[1,1,1] neg_lo:[0,0,0] neg_hi:[0,1,0]
v_pk_add_f32 v[64:65], v[36:37], v[68:69] neg_lo:[0,1] neg_hi:[0,1]
v_pk_add_f32 v[36:37], v[36:37], v[68:69]
v_pk_mul_f32 v[68:69], v[64:65], s[54:55] op_sel:[0,1] op_sel_hi:[0,0] neg_lo:[0,1] neg_hi:[0,1]
v_pk_fma_f32 v[68:69], v[64:65], s[54:55], v[68:69] op_sel:[1,0,0] op_sel_hi:[1,1,1] neg_lo:[0,0,0] neg_hi:[0,1,0]
v_pk_add_f32 v[64:65], v[38:39], v[70:71] neg_lo:[0,1] neg_hi:[0,1]
v_pk_add_f32 v[38:39], v[38:39], v[70:71]
v_pk_mul_f32 v[70:71], v[64:65], s[58:59] op_sel:[0,1] op_sel_hi:[0,0] neg_lo:[0,1] neg_hi:[0,1]
v_pk_fma_f32 v[70:71], v[64:65], s[58:59], v[70:71] op_sel:[1,0,0] op_sel_hi:[1,1,1] neg_lo:[0,0,0] neg_hi:[0,1,0]
v_pk_add_f32 v[64:65], v[40:41], v[72:73] neg_lo:[0,1] neg_hi:[0,1]
v_pk_add_f32 v[40:41], v[40:41], v[72:73]
v_pk_mul_f32 v[72:73], v[64:65], s[62:63] op_sel:[0,0] op_sel_hi:[0,1] neg_lo:[0,1] neg_hi:[0,1]
v_pk_fma_f32 v[72:73], v[64:65], s[62:63], v[72:73] op_sel:[1,1,0] op_sel_hi:[1,0,1] neg_lo:[0,0,0] neg_hi:[0,1,0]
v_pk_add_f32 v[64:65], v[42:43], v[74:75] neg_lo:[0,1] neg_hi:[0,1]
v_pk_add_f32 v[42:43], v[42:43], v[74:75]
v_pk_mul_f32 v[74:75], v[64:65], s[58:59] op_sel:[0,0] op_sel_hi:[0,1] neg_lo:[0,1] neg_hi:[0,1]
v_pk_fma_f32 v[74:75], v[64:65], s[58:59], v[74:75] op_sel:[1,1,0] op_sel_hi:[1,0,1] neg_lo:[0,0,0] neg_hi:[0,1,0]
v_pk_add_f32 v[64:65], v[44:45], v[76:77] neg_lo:[0,1] neg_hi:[0,1]
v_pk_add_f32 v[44:45], v[44:45], v[76:77]
v_pk_mul_f32 v[76:77], v[64:65], s[54:55] op_sel:[0,0] op_sel_hi:[0,1] neg_lo:[0,1] neg_hi:[0,1]
v_pk_fma_f32 v[76:77], v[64:65], s[54:55], v[76:77] op_sel:[1,1,0] op_sel_hi:[1,0,1] neg_lo:[0,0,0] neg_hi:[0,1,0]
v_pk_add_f32 v[64:65], v[46:47], v[78:79] neg_lo:[0,1] neg_hi:[0,1]
v_pk_add_f32 v[46:47], v[46:47], v[78:79]
v_pk_mul_f32 v[78:79], v[64:65], s[50:51] op_sel:[0,0] op_sel_hi:[0,1] neg_lo:[0,1] neg_hi:[0,1]
v_pk_fma_f32 v[78:79], v[64:65], s[50:51], v[78:79] op_sel:[1,1,0] op_sel_hi:[1,0,1] neg_lo:[0,0,0] neg_hi:[0,1,0]
v_pk_add_f32 v[64:65], v[16:17], v[32:33] neg_lo:[0,1] neg_hi:[0,1]
v_pk_add_f32 v[16:17], v[16:17], v[32:33]
v_pk_add_f32 v[32:33], v[18:19], v[34:35] neg_lo:[0,1] neg_hi:[0,1]
v_pk_add_f32 v[18:19], v[18:19], v[34:35]
v_pk_mul_f32 v[34:35], v[32:33], s[54:55] op_sel:[0,0] op_sel_hi:[0,1] neg_lo:[0,0] neg_hi:[0,1]
v_pk_fma_f32 v[34:35], v[32:33], s[54:55], v[34:35] op_sel:[1,1,0] op_sel_hi:[1,0,1] neg_lo:[0,0,0] neg_hi:[0,0,0]
v_pk_add_f32 v[32:33], v[20:21], v[36:37] neg_lo:[0,1] neg_hi:[0,1]
v_pk_add_f32 v[20:21], v[20:21], v[36:37]
v_pk_mul_f32 v[36:37], v[32:33], s[62:63] op_sel:[0,0] op_sel_hi:[0,1] neg_lo:[0,0] neg_hi:[0,1]
v_pk_fma_f32 v[36:37], v[32:33], s[62:63], v[36:37] op_sel:[1,1,0] op_sel_hi:[1,0,1] neg_lo:[0,0,0] neg_hi:[0,0,0]
v_pk_add_f32 v[32:33], v[22:23], v[38:39] neg_lo:[0,1] neg_hi:[0,1]
v_pk_add_f32 v[22:23], v[22:23], v[38:39]
v_pk_mul_f32 v[38:39], v[32:33], s[54:55] op_sel:[0,1] op_sel_hi:[0,0] neg_lo:[0,0] neg_hi:[0,1]
v_pk_fma_f32 v[38:39], v[32:33], s[54:55], v[38:39] op_sel:[1,0,0] op_sel_hi:[1,1,1] neg_lo:[0,0,0] neg_hi:[0,0,0]
v_pk_add_f32 v[32:33], v[24:25], v[40:41] op_sel:[1,1] op_sel_hi:[0,0] neg_lo:[0,1] neg_hi:[1,0]
v_pk_add_f32 v[24:25], v[24:25], v[40:41]
v_pk_add_f32 v[40:41], v[26:27], v[42:43] neg_lo:[0,1] neg_hi:[0,1]
v_pk_add_f32 v[26:27], v[26:27], v[42:43]
v_pk_mul_f32 v[42:43], v[40:41], s[54:55] op_sel:[0,1] op_sel_hi:[0,0] neg_lo:[0,1] neg_hi:[0,1]
v_pk_fma_f32 v[42:43], v[40:41], s[54:55], v[42:43] op_sel:[1,0,0] op_sel_hi:[1,1,1] neg_lo:[0,0,0] neg_hi:[0,1,0]
v_pk_add_f32 v[40:41], v[28:29], v[44:45] neg_lo:[0,1] neg_hi:[0,1]
v_pk_add_f32 v[28:29], v[28:29], v[44:45]
v_pk_mul_f32 v[44:45], v[40:41], s[62:63] op_sel:[0,0] op_sel_hi:[0,1] neg_lo:[0,1] neg_hi:[0,1]
v_pk_fma_f32 v[44:45], v[40:41], s[62:63], v[44:45] op_sel:[1,1,0] op_sel_hi:[1,0,1] neg_lo:[0,0,0] neg_hi:[0,1,0]
v_pk_add_f32 v[40:41], v[30:31], v[46:47] neg_lo:[0,1] neg_hi:[0,1]
v_pk_add_f32 v[30:31], v[30:31], v[46:47]
v_pk_mul_f32 v[46:47], v[40:41], s[54:55] op_sel:[0,0] op_sel_hi:[0,1] neg_lo:[0,1] neg_hi:[0,1]
v_pk_fma_f32 v[46:47], v[40:41], s[54:55], v[46:47] op_sel:[1,1,0] op_sel_hi:[1,0,1] neg_lo:[0,0,0] neg_hi:[0,1,0]
v_pk_add_f32 v[40:41], v[14:15], v[48:49] neg_lo:[0,1] neg_hi:[0,1]
v_pk_add_f32 v[14:15], v[14:15], v[48:49]
v_pk_add_f32 v[48:49], v[50:51], v[66:67] neg_lo:[0,1] neg_hi:[0,1]
v_pk_add_f32 v[50:51], v[50:51], v[66:67]
v_pk_mul_f32 v[66:67], v[48:49], s[54:55] op_sel:[0,0] op_sel_hi:[0,1] neg_lo:[0,0] neg_hi:[0,1]
v_pk_fma_f32 v[66:67], v[48:49], s[54:55], v[66:67] op_sel:[1,1,0] op_sel_hi:[1,0,1] neg_lo:[0,0,0] neg_hi:[0,0,0]
v_pk_add_f32 v[48:49], v[52:53], v[68:69] neg_lo:[0,1] neg_hi:[0,1]
v_pk_add_f32 v[52:53], v[52:53], v[68:69]
v_pk_mul_f32 v[68:69], v[48:49], s[62:63] op_sel:[0,0] op_sel_hi:[0,1] neg_lo:[0,0] neg_hi:[0,1]
v_pk_fma_f32 v[68:69], v[48:49], s[62:63], v[68:69] op_sel:[1,1,0] op_sel_hi:[1,0,1] neg_lo:[0,0,0] neg_hi:[0,0,0]
v_pk_add_f32 v[48:49], v[54:55], v[70:71] neg_lo:[0,1] neg_hi:[0,1]
v_pk_add_f32 v[54:55], v[54:55], v[70:71]
v_pk_mul_f32 v[70:71], v[48:49], s[54:55] op_sel:[0,1] op_sel_hi:[0,0] neg_lo:[0,0] neg_hi:[0,1]
v_pk_fma_f32 v[70:71], v[48:49], s[54:55], v[70:71] op_sel:[1,0,0] op_sel_hi:[1,1,1] neg_lo:[0,0,0] neg_hi:[0,0,0]
v_pk_add_f32 v[48:49], v[56:57], v[72:73] op_sel:[1,1] op_sel_hi:[0,0] neg_lo:[0,1] neg_hi:[1,0]
v_pk_add_f32 v[56:57], v[56:57], v[72:73]
v_pk_add_f32 v[72:73], v[58:59], v[74:75] neg_lo:[0,1] neg_hi:[0,1]
v_pk_add_f32 v[58:59], v[58:59], v[74:75]
v_pk_mul_f32 v[74:75], v[72:73], s[54:55] op_sel:[0,1] op_sel_hi:[0,0] neg_lo:[0,1] neg_hi:[0,1]
v_pk_fma_f32 v[74:75], v[72:73], s[54:55], v[74:75] op_sel:[1,0,0] op_sel_hi:[1,1,1] neg_lo:[0,0,0] neg_hi:[0,1,0]
v_pk_add_f32 v[72:73], v[60:61], v[76:77] neg_lo:[0,1] neg_hi:[0,1]
v_pk_add_f32 v[60:61], v[60:61], v[76:77]
v_pk_mul_f32 v[76:77], v[72:73], s[62:63] op_sel:[0,0] op_sel_hi:[0,1] neg_lo:[0,1] neg_hi:[0,1]
v_pk_fma_f32 v[76:77], v[72:73], s[62:63], v[76:77] op_sel:[1,1,0] op_sel_hi:[1,0,1] neg_lo:[0,0,0] neg_hi:[0,1,0]
v_pk_add_f32 v[72:73], v[62:63], v[78:79] neg_lo:[0,1] neg_hi:[0,1]
v_pk_add_f32 v[62:63], v[62:63], v[78:79]
v_pk_mul_f32 v[78:79], v[72:73], s[54:55] op_sel:[0,0] op_sel_hi:[0,1] neg_lo:[0,1] neg_hi:[0,1]
v_pk_fma_f32 v[78:79], v[72:73], s[54:55], v[78:79] op_sel:[1,1,0] op_sel_hi:[1,0,1] neg_lo:[0,0,0] neg_hi:[0,1,0]
v_pk_add_f32 v[72:73], v[16:17], v[24:25] neg_lo:[0,1] neg_hi:[0,1]
v_pk_add_f32 v[16:17], v[16:17], v[24:25]
v_pk_add_f32 v[24:25], v[18:19], v[26:27] neg_lo:[0,1] neg_hi:[0,1]
v_pk_add_f32 v[18:19], v[18:19], v[26:27]
v_pk_mul_f32 v[26:27], v[24:25], s[62:63] op_sel:[0,0] op_sel_hi:[0,1] neg_lo:[0,0] neg_hi:[0,1]
v_pk_fma_f32 v[26:27], v[24:25], s[62:63], v[26:27] op_sel:[1,1,0] op_sel_hi:[1,0,1] neg_lo:[0,0,0] neg_hi:[0,0,0]
v_pk_add_f32 v[24:25], v[20:21], v[28:29] op_sel:[1,1] op_sel_hi:[0,0] neg_lo:[0,1] neg_hi:[1,0]
v_pk_add_f32 v[20:21], v[20:21], v[28:29]
v_pk_add_f32 v[28:29], v[22:23], v[30:31] neg_lo:[0,1] neg_hi:[0,1]
v_pk_add_f32 v[22:23], v[22:23], v[30:31]
v_pk_mul_f32 v[30:31], v[28:29], s[62:63] op_sel:[0,0] op_sel_hi:[0,1] neg_lo:[0,1] neg_hi:[0,1]
v_pk_fma_f32 v[30:31], v[28:29], s[62:63], v[30:31] op_sel:[1,1,0] op_sel_hi:[1,0,1] neg_lo:[0,0,0] neg_hi:[0,1,0]
v_pk_add_f32 v[28:29], v[64:65], v[32:33] neg_lo:[0,1] neg_hi:[0,1]
v_pk_add_f32 v[64:65], v[64:65], v[32:33]
v_pk_add_f32 v[32:33], v[34:35], v[42:43] neg_lo:[0,1] neg_hi:[0,1]
v_pk_add_f32 v[34:35], v[34:35], v[42:43]
v_pk_mul_f32 v[42:43], v[32:33], s[62:63] op_sel:[0,0] op_sel_hi:[0,1] neg_lo:[0,0] neg_hi:[0,1]
v_pk_fma_f32 v[42:43], v[32:33], s[62:63], v[42:43] op_sel:[1,1,0] op_sel_hi:[1,0,1] neg_lo:[0,0,0] neg_hi:[0,0,0]
v_pk_add_f32 v[32:33], v[36:37], v[44:45] op_sel:[1,1] op_sel_hi:[0,0] neg_lo:[0,1] neg_hi:[1,0]
v_pk_add_f32 v[36:37], v[36:37], v[44:45]
v_pk_add_f32 v[44:45], v[38:39], v[46:47] neg_lo:[0,1] neg_hi:[0,1]
v_pk_add_f32 v[38:39], v[38:39], v[46:47]
v_pk_mul_f32 v[46:47], v[44:45], s[62:63] op_sel:[0,0] op_sel_hi:[0,1] neg_lo:[0,1] neg_hi:[0,1]
v_pk_fma_f32 v[46:47], v[44:45], s[62:63], v[46:47] op_sel:[1,1,0] op_sel_hi:[1,0,1] neg_lo:[0,0,0] neg_hi:[0,1,0]
v_pk_add_f32 v[44:45], v[14:15], v[56:57] neg_lo:[0,1] neg_hi:[0,1]
v_pk_add_f32 v[14:15], v[14:15], v[56:57]
v_pk_add_f32 v[56:57], v[50:51], v[58:59] neg_lo:[0,1] neg_hi:[0,1]
v_pk_add_f32 v[50:51], v[50:51], v[58:59]
v_pk_mul_f32 v[58:59], v[56:57], s[62:63] op_sel:[0,0] op_sel_hi:[0,1] neg_lo:[0,0] neg_hi:[0,1]
v_pk_fma_f32 v[58:59], v[56:57], s[62:63], v[58:59] op_sel:[1,1,0] op_sel_hi:[1,0,1] neg_lo:[0,0,0] neg_hi:[0,0,0]
v_pk_add_f32 v[56:57], v[52:53], v[60:61] op_sel:[1,1] op_sel_hi:[0,0] neg_lo:[0,1] neg_hi:[1,0]
v_pk_add_f32 v[52:53], v[52:53], v[60:61]
v_pk_add_f32 v[60:61], v[54:55], v[62:63] neg_lo:[0,1] neg_hi:[0,1]
v_pk_add_f32 v[54:55], v[54:55], v[62:63]
v_pk_mul_f32 v[62:63], v[60:61], s[62:63] op_sel:[0,0] op_sel_hi:[0,1] neg_lo:[0,1] neg_hi:[0,1]
v_pk_fma_f32 v[62:63], v[60:61], s[62:63], v[62:63] op_sel:[1,1,0] op_sel_hi:[1,0,1] neg_lo:[0,0,0] neg_hi:[0,1,0]
v_pk_add_f32 v[60:61], v[40:41], v[48:49] neg_lo:[0,1] neg_hi:[0,1]
v_pk_add_f32 v[40:41], v[40:41], v[48:49]
v_pk_add_f32 v[48:49], v[66:67], v[74:75] neg_lo:[0,1] neg_hi:[0,1]
v_pk_add_f32 v[66:67], v[66:67], v[74:75]
v_pk_mul_f32 v[74:75], v[48:49], s[62:63] op_sel:[0,0] op_sel_hi:[0,1] neg_lo:[0,0] neg_hi:[0,1]
v_pk_fma_f32 v[74:75], v[48:49], s[62:63], v[74:75] op_sel:[1,1,0] op_sel_hi:[1,0,1] neg_lo:[0,0,0] neg_hi:[0,0,0]
v_pk_add_f32 v[48:49], v[68:69], v[76:77] op_sel:[1,1] op_sel_hi:[0,0] neg_lo:[0,1] neg_hi:[1,0]
v_pk_add_f32 v[68:69], v[68:69], v[76:77]
v_pk_add_f32 v[76:77], v[70:71], v[78:79] neg_lo:[0,1] neg_hi:[0,1]
v_pk_add_f32 v[70:71], v[70:71], v[78:79]
v_pk_mul_f32 v[78:79], v[76:77], s[62:63] op_sel:[0,0] op_sel_hi:[0,1] neg_lo:[0,1] neg_hi:[0,1]
v_pk_fma_f32 v[78:79], v[76:77], s[62:63], v[78:79] op_sel:[1,1,0] op_sel_hi:[1,0,1] neg_lo:[0,0,0] neg_hi:[0,1,0]
v_pk_add_f32 v[76:77], v[16:17], v[20:21] neg_lo:[0,1] neg_hi:[0,1]
v_pk_add_f32 v[16:17], v[16:17], v[20:21]
v_pk_add_f32 v[20:21], v[18:19], v[22:23] op_sel:[1,1] op_sel_hi:[0,0] neg_lo:[0,1] neg_hi:[1,0]
v_pk_add_f32 v[18:19], v[18:19], v[22:23]
v_pk_add_f32 v[22:23], v[72:73], v[24:25] neg_lo:[0,1] neg_hi:[0,1]
v_pk_add_f32 v[72:73], v[72:73], v[24:25]
v_pk_add_f32 v[24:25], v[26:27], v[30:31] op_sel:[1,1] op_sel_hi:[0,0] neg_lo:[0,1] neg_hi:[1,0]
v_pk_add_f32 v[26:27], v[26:27], v[30:31]
v_pk_add_f32 v[30:31], v[64:65], v[36:37] neg_lo:[0,1] neg_hi:[0,1]
v_pk_add_f32 v[64:65], v[64:65], v[36:37]
v_pk_add_f32 v[36:37], v[34:35], v[38:39] op_sel:[1,1] op_sel_hi:[0,0] neg_lo:[0,1] neg_hi:[1,0]
v_pk_add_f32 v[34:35], v[34:35], v[38:39]
v_pk_add_f32 v[38:39], v[28:29], v[32:33] neg_lo:[0,1] neg_hi:[0,1]
v_pk_add_f32 v[28:29], v[28:29], v[32:33]
v_pk_add_f32 v[32:33], v[42:43], v[46:47] op_sel:[1,1] op_sel_hi:[0,0] neg_lo:[0,1] neg_hi:[1,0]
v_pk_add_f32 v[42:43], v[42:43], v[46:47]
v_pk_add_f32 v[46:47], v[14:15], v[52:53] neg_lo:[0,1] neg_hi:[0,1]
v_pk_add_f32 v[14:15], v[14:15], v[52:53]
v_pk_add_f32 v[52:53], v[50:51], v[54:55] op_sel:[1,1] op_sel_hi:[0,0] neg_lo:[0,1] neg_hi:[1,0]
v_pk_add_f32 v[50:51], v[50:51], v[54:55]
v_pk_add_f32 v[54:55], v[44:45], v[56:57] neg_lo:[0,1] neg_hi:[0,1]
v_pk_add_f32 v[44:45], v[44:45], v[56:57]
v_pk_add_f32 v[56:57], v[58:59], v[62:63] op_sel:[1,1] op_sel_hi:[0,0] neg_lo:[0,1] neg_hi:[1,0]
v_pk_add_f32 v[58:59], v[58:59], v[62:63]
v_pk_add_f32 v[62:63], v[40:41], v[68:69] neg_lo:[0,1] neg_hi:[0,1]
v_pk_add_f32 v[40:41], v[40:41], v[68:69]
v_pk_add_f32 v[68:69], v[66:67], v[70:71] op_sel:[1,1] op_sel_hi:[0,0] neg_lo:[0,1] neg_hi:[1,0]
v_pk_add_f32 v[66:67], v[66:67], v[70:71]
v_pk_add_f32 v[70:71], v[60:61], v[48:49] neg_lo:[0,1] neg_hi:[0,1]
v_pk_add_f32 v[60:61], v[60:61], v[48:49]
v_pk_add_f32 v[48:49], v[74:75], v[78:79] op_sel:[1,1] op_sel_hi:[0,0] neg_lo:[0,1] neg_hi:[1,0]
v_pk_add_f32 v[74:75], v[74:75], v[78:79]
v_pk_add_f32 v[78:79], v[16:17], v[18:19] neg_lo:[0,1] neg_hi:[0,1]
v_pk_add_f32 v[16:17], v[16:17], v[18:19]
v_pk_add_f32 v[18:19], v[76:77], v[20:21] neg_lo:[0,1] neg_hi:[0,1]
v_pk_add_f32 v[76:77], v[76:77], v[20:21]
v_pk_add_f32 v[20:21], v[72:73], v[26:27] neg_lo:[0,1] neg_hi:[0,1]
v_pk_add_f32 v[72:73], v[72:73], v[26:27]
v_pk_add_f32 v[26:27], v[22:23], v[24:25] neg_lo:[0,1] neg_hi:[0,1]
v_pk_add_f32 v[22:23], v[22:23], v[24:25]
v_pk_add_f32 v[24:25], v[64:65], v[34:35] neg_lo:[0,1] neg_hi:[0,1]
v_pk_add_f32 v[64:65], v[64:65], v[34:35]
v_pk_add_f32 v[34:35], v[30:31], v[36:37] neg_lo:[0,1] neg_hi:[0,1]
v_pk_add_f32 v[30:31], v[30:31], v[36:37]
v_pk_add_f32 v[36:37], v[28:29], v[42:43] neg_lo:[0,1] neg_hi:[0,1]
v_pk_add_f32 v[28:29], v[28:29], v[42:43]
v_pk_add_f32 v[42:43], v[38:39], v[32:33] neg_lo:[0,1] neg_hi:[0,1]
v_pk_add_f32 v[38:39], v[38:39], v[32:33]
v_pk_add_f32 v[32:33], v[14:15], v[50:51] neg_lo:[0,1] neg_hi:[0,1]
v_pk_add_f32 v[14:15], v[14:15], v[50:51]
v_pk_add_f32 v[50:51], v[46:47], v[52:53] neg_lo:[0,1] neg_hi:[0,1]
v_pk_add_f32 v[46:47], v[46:47], v[52:53]
v_pk_add_f32 v[52:53], v[44:45], v[58:59] neg_lo:[0,1] neg_hi:[0,1]
v_pk_add_f32 v[44:45], v[44:45], v[58:59]
v_pk_add_f32 v[58:59], v[54:55], v[56:57] neg_lo:[0,1] neg_hi:[0,1]
v_pk_add_f32 v[54:55], v[54:55], v[56:57]
v_pk_add_f32 v[56:57], v[40:41], v[66:67] neg_lo:[0,1] neg_hi:[0,1]
v_pk_add_f32 v[40:41], v[40:41], v[66:67]
v_pk_add_f32 v[66:67], v[62:63], v[68:69] neg_lo:[0,1] neg_hi:[0,1]
v_pk_add_f32 v[62:63], v[62:63], v[68:69]
v_pk_add_f32 v[68:69], v[60:61], v[74:75] neg_lo:[0,1] neg_hi:[0,1]
v_pk_add_f32 v[60:61], v[60:61], v[74:75]
v_pk_add_f32 v[74:75], v[70:71], v[48:49] neg_lo:[0,1] neg_hi:[0,1]
v_pk_add_f32 v[70:71], v[70:71], v[48:49]
s_mov_b64 exec, s[18:19]
v_pk_add_f32 v[16:17], v[16:17], 0 neg_lo:[1,0] neg_hi:[1,0]
v_pk_mul_f32 v[48:49], v[14:15], s[48:49] op_sel:[0,0] op_sel_hi:[0,1] neg_lo:[0,1] neg_hi:[0,0]
v_pk_fma_f32 v[14:15], v[14:15], s[48:49], v[48:49] op_sel:[1,1,0] op_sel_hi:[1,0,1] neg_lo:[0,1,0] neg_hi:[0,1,0]
v_pk_mul_f32 v[48:49], v[64:65], s[50:51] op_sel:[0,0] op_sel_hi:[0,1] neg_lo:[0,1] neg_hi:[0,0]
v_pk_fma_f32 v[64:65], v[64:65], s[50:51], v[48:49] op_sel:[1,1,0] op_sel_hi:[1,0,1] neg_lo:[0,1,0] neg_hi:[0,1,0]
v_pk_mul_f32 v[48:49], v[40:41], s[52:53] op_sel:[0,0] op_sel_hi:[0,1] neg_lo:[0,1] neg_hi:[0,0]
v_pk_fma_f32 v[40:41], v[40:41], s[52:53], v[48:49] op_sel:[1,1,0] op_sel_hi:[1,0,1] neg_lo:[0,1,0] neg_hi:[0,1,0]
v_pk_mul_f32 v[48:49], v[72:73], s[54:55] op_sel:[0,0] op_sel_hi:[0,1] neg_lo:[0,1] neg_hi:[0,0]
v_pk_fma_f32 v[72:73], v[72:73], s[54:55], v[48:49] op_sel:[1,1,0] op_sel_hi:[1,0,1] neg_lo:[0,1,0] neg_hi:[0,1,0]
v_pk_mul_f32 v[48:49], v[44:45], s[56:57] op_sel:[0,0] op_sel_hi:[0,1] neg_lo:[0,1] neg_hi:[0,0]
v_pk_fma_f32 v[44:45], v[44:45], s[56:57], v[48:49] op_sel:[1,1,0] op_sel_hi:[1,0,1] neg_lo:[0,1,0] neg_hi:[0,1,0]
v_pk_mul_f32 v[48:49], v[28:29], s[58:59] op_sel:[0,0] op_sel_hi:[0,1] neg_lo:[0,1] neg_hi:[0,0]
v_pk_fma_f32 v[28:29], v[28:29], s[58:59], v[48:49] op_sel:[1,1,0] op_sel_hi:[1,0,1] neg_lo:[0,1,0] neg_hi:[0,1,0]
v_pk_mul_f32 v[48:49], v[60:61], s[60:61] op_sel:[0,0] op_sel_hi:[0,1] neg_lo:[0,1] neg_hi:[0,0]
v_pk_fma_f32 v[60:61], v[60:61], s[60:61], v[48:49] op_sel:[1,1,0] op_sel_hi:[1,0,1] neg_lo:[0,1,0] neg_hi:[0,1,0]
v_pk_mul_f32 v[48:49], v[76:77], s[62:63] op_sel:[0,0] op_sel_hi:[0,1] neg_lo:[0,1] neg_hi:[0,0]
v_pk_fma_f32 v[76:77], v[76:77], s[62:63], v[48:49] op_sel:[1,1,0] op_sel_hi:[1,0,1] neg_lo:[0,1,0] neg_hi:[0,1,0]
v_pk_mul_f32 v[48:49], v[46:47], s[60:61] op_sel:[0,1] op_sel_hi:[0,0] neg_lo:[0,1] neg_hi:[0,0]
v_pk_fma_f32 v[46:47], v[46:47], s[60:61], v[48:49] op_sel:[1,0,0] op_sel_hi:[1,1,1] neg_lo:[0,1,0] neg_hi:[0,1,0]
v_pk_mul_f32 v[48:49], v[30:31], s[58:59] op_sel:[0,1] op_sel_hi:[0,0] neg_lo:[0,1] neg_hi:[0,0]
v_pk_fma_f32 v[30:31], v[30:31], s[58:59], v[48:49] op_sel:[1,0,0] op_sel_hi:[1,1,1] neg_lo:[0,1,0] neg_hi:[0,1,0]
v_pk_mul_f32 v[48:49], v[62:63], s[56:57] op_sel:[0,1] op_sel_hi:[0,0] neg_lo:[0,1] neg_hi:[0,0]
v_pk_fma_f32 v[62:63], v[62:63], s[56:57], v[48:49] op_sel:[1,0,0] op_sel_hi:[1,1,1] neg_lo:[0,1,0] neg_hi:[0,1,0]
v_pk_mul_f32 v[48:49], v[22:23], s[54:55] op_sel:[0,1] op_sel_hi:[0,0] neg_lo:[0,1] neg_hi:[0,0]
v_pk_fma_f32 v[22:23], v[22:23], s[54:55], v[48:49] op_sel:[1,0,0] op_sel_hi:[1,1,1] neg_lo:[0,1,0] neg_hi:[0,1,0]
v_pk_mul_f32 v[48:49], v[54:55], s[52:53] op_sel:[0,1] op_sel_hi:[0,0] neg_lo:[0,1] neg_hi:[0,0]
v_pk_fma_f32 v[54:55], v[54:55], s[52:53], v[48:49] op_sel:[1,0,0] op_sel_hi:[1,1,1] neg_lo:[0,1,0] neg_hi:[0,1,0]
v_pk_mul_f32 v[48:49], v[38:39], s[50:51] op_sel:[0,1] op_sel_hi:[0,0] neg_lo:[0,1] neg_hi:[0,0]
v_pk_fma_f32 v[38:39], v[38:39], s[50:51], v[48:49] op_sel:[1,0,0] op_sel_hi:[1,1,1] neg_lo:[0,1,0] neg_hi:[0,1,0]
v_pk_mul_f32 v[48:49], v[70:71], s[48:49] op_sel:[0,1] op_sel_hi:[0,0] neg_lo:[0,1] neg_hi:[0,0]
v_pk_fma_f32 v[70:71], v[70:71], s[48:49], v[48:49] op_sel:[1,0,0] op_sel_hi:[1,1,1] neg_lo:[0,1,0] neg_hi:[0,1,0]
v_pk_add_f32 v[78:79], v[78:79], 0 op_sel:[1,0] op_sel_hi:[0,0] neg_lo:[1,0] neg_hi:[0,0]
v_pk_mul_f32 v[48:49], v[32:33], s[48:49] op_sel:[0,1] op_sel_hi:[0,0] neg_lo:[0,0] neg_hi:[0,0]
v_pk_fma_f32 v[32:33], v[32:33], s[48:49], v[48:49] op_sel:[1,0,0] op_sel_hi:[1,1,1] neg_lo:[0,1,0] neg_hi:[0,0,0]
v_pk_mul_f32 v[48:49], v[24:25], s[50:51] op_sel:[0,1] op_sel_hi:[0,0] neg_lo:[0,0] neg_hi:[0,0]
v_pk_fma_f32 v[24:25], v[24:25], s[50:51], v[48:49] op_sel:[1,0,0] op_sel_hi:[1,1,1] neg_lo:[0,1,0] neg_hi:[0,0,0]
v_pk_mul_f32 v[48:49], v[56:57], s[52:53] op_sel:[0,1] op_sel_hi:[0,0] neg_lo:[0,0] neg_hi:[0,0]
v_pk_fma_f32 v[56:57], v[56:57], s[52:53], v[48:49] op_sel:[1,0,0] op_sel_hi:[1,1,1] neg_lo:[0,1,0] neg_hi:[0,0,0]
v_pk_mul_f32 v[48:49], v[20:21], s[54:55] op_sel:[0,1] op_sel_hi:[0,0] neg_lo:[0,0] neg_hi:[0,0]
v_pk_fma_f32 v[20:21], v[20:21], s[54:55], v[48:49] op_sel:[1,0,0] op_sel_hi:[1,1,1] neg_lo:[0,1,0] neg_hi:[0,0,0]
v_pk_mul_f32 v[48:49], v[52:53], s[56:57] op_sel:[0,1] op_sel_hi:[0,0] neg_lo:[0,0] neg_hi:[0,0]
v_pk_fma_f32 v[52:53], v[52:53], s[56:57], v[48:49] op_sel:[1,0,0] op_sel_hi:[1,1,1] neg_lo:[0,1,0] neg_hi:[0,0,0]
v_pk_mul_f32 v[48:49], v[36:37], s[58:59] op_sel:[0,1] op_sel_hi:[0,0] neg_lo:[0,0] neg_hi:[0,0]
v_pk_fma_f32 v[36:37], v[36:37], s[58:59], v[48:49] op_sel:[1,0,0] op_sel_hi:[1,1,1] neg_lo:[0,1,0] neg_hi:[0,0,0]
v_pk_mul_f32 v[48:49], v[68:69], s[60:61] op_sel:[0,1] op_sel_hi:[0,0] neg_lo:[0,0] neg_hi:[0,0]
v_pk_fma_f32 v[68:69], v[68:69], s[60:61], v[48:49] op_sel:[1,0,0] op_sel_hi:[1,1,1] neg_lo:[0,1,0] neg_hi:[0,0,0]
v_pk_mul_f32 v[48:49], v[18:19], s[62:63] op_sel:[0,0] op_sel_hi:[0,1] neg_lo:[0,0] neg_hi:[0,0]
v_pk_fma_f32 v[18:19], v[18:19], s[62:63], v[48:49] op_sel:[1,1,0] op_sel_hi:[1,0,1] neg_lo:[0,1,0] neg_hi:[0,0,0]
v_pk_mul_f32 v[48:49], v[50:51], s[60:61] op_sel:[0,0] op_sel_hi:[0,1] neg_lo:[0,0] neg_hi:[0,0]
v_pk_fma_f32 v[50:51], v[50:51], s[60:61], v[48:49] op_sel:[1,1,0] op_sel_hi:[1,0,1] neg_lo:[0,1,0] neg_hi:[0,0,0]
v_pk_mul_f32 v[48:49], v[34:35], s[58:59] op_sel:[0,0] op_sel_hi:[0,1] neg_lo:[0,0] neg_hi:[0,0]
v_pk_fma_f32 v[34:35], v[34:35], s[58:59], v[48:49] op_sel:[1,1,0] op_sel_hi:[1,0,1] neg_lo:[0,1,0] neg_hi:[0,0,0]
v_pk_mul_f32 v[48:49], v[66:67], s[56:57] op_sel:[0,0] op_sel_hi:[0,1] neg_lo:[0,0] neg_hi:[0,0]
v_pk_fma_f32 v[66:67], v[66:67], s[56:57], v[48:49] op_sel:[1,1,0] op_sel_hi:[1,0,1] neg_lo:[0,1,0] neg_hi:[0,0,0]
v_pk_mul_f32 v[48:49], v[26:27], s[54:55] op_sel:[0,0] op_sel_hi:[0,1] neg_lo:[0,0] neg_hi:[0,0]
v_pk_fma_f32 v[26:27], v[26:27], s[54:55], v[48:49] op_sel:[1,1,0] op_sel_hi:[1,0,1] neg_lo:[0,1,0] neg_hi:[0,0,0]
v_pk_mul_f32 v[48:49], v[58:59], s[52:53] op_sel:[0,0] op_sel_hi:[0,1] neg_lo:[0,0] neg_hi:[0,0]
v_pk_fma_f32 v[58:59], v[58:59], s[52:53], v[48:49] op_sel:[1,1,0] op_sel_hi:[1,0,1] neg_lo:[0,1,0] neg_hi:[0,0,0]
v_pk_mul_f32 v[48:49], v[42:43], s[50:51] op_sel:[0,0] op_sel_hi:[0,1] neg_lo:[0,0] neg_hi:[0,0]
v_pk_fma_f32 v[42:43], v[42:43], s[50:51], v[48:49] op_sel:[1,1,0] op_sel_hi:[1,0,1] neg_lo:[0,1,0] neg_hi:[0,0,0]
v_pk_mul_f32 v[48:49], v[74:75], s[48:49] op_sel:[0,0] op_sel_hi:[0,1] neg_lo:[0,0] neg_hi:[0,0]
v_pk_fma_f32 v[74:75], v[74:75], s[48:49], v[48:49] op_sel:[1,1,0] op_sel_hi:[1,0,1] neg_lo:[0,1,0] neg_hi:[0,0,0]
s_mov_b64 exec, -1
v_fmac_f32_dpp v16, v16, v9 quad_perm:[1,0,3,2] row_mask:0xf bank_mask:0xf
v_fmac_f32_dpp v17, v17, v9 quad_perm:[1,0,3,2] row_mask:0xf bank_mask:0xf
v_fmac_f32_dpp v14, v14, v9 quad_perm:[1,0,3,2] row_mask:0xf bank_mask:0xf
v_fmac_f32_dpp v15, v15, v9 quad_perm:[1,0,3,2] row_mask:0xf bank_mask:0xf
v_fmac_f32_dpp v64, v64, v9 quad_perm:[1,0,3,2] row_mask:0xf bank_mask:0xf
v_fmac_f32_dpp v65, v65, v9 quad_perm:[1,0,3,2] row_mask:0xf bank_mask:0xf
v_fmac_f32_dpp v40, v40, v9 quad_perm:[1,0,3,2] row_mask:0xf bank_mask:0xf
v_fmac_f32_dpp v41, v41, v9 quad_perm:[1,0,3,2] row_mask:0xf bank_mask:0xf
v_fmac_f32_dpp v72, v72, v9 quad_perm:[1,0,3,2] row_mask:0xf bank_mask:0xf
v_fmac_f32_dpp v73, v73, v9 quad_perm:[1,0,3,2] row_mask:0xf bank_mask:0xf
v_fmac_f32_dpp v44, v44, v9 quad_perm:[1,0,3,2] row_mask:0xf bank_mask:0xf
v_fmac_f32_dpp v45, v45, v9 quad_perm:[1,0,3,2] row_mask:0xf bank_mask:0xf
v_fmac_f32_dpp v28, v28, v9 quad_perm:[1,0,3,2] row_mask:0xf bank_mask:0xf
v_fmac_f32_dpp v29, v29, v9 quad_perm:[1,0,3,2] row_mask:0xf bank_mask:0xf
v_fmac_f32_dpp v60, v60, v9 quad_perm:[1,0,3,2] row_mask:0xf bank_mask:0xf
v_fmac_f32_dpp v61, v61, v9 quad_perm:[1,0,3,2] row_mask:0xf bank_mask:0xf
v_fmac_f32_dpp v76, v76, v9 quad_perm:[1,0,3,2] row_mask:0xf bank_mask:0xf
v_fmac_f32_dpp v77, v77, v9 quad_perm:[1,0,3,2] row_mask:0xf bank_mask:0xf
v_fmac_f32_dpp v46, v46, v9 quad_perm:[1,0,3,2] row_mask:0xf bank_mask:0xf
v_fmac_f32_dpp v47, v47, v9 quad_perm:[1,0,3,2] row_mask:0xf bank_mask:0xf
v_fmac_f32_dpp v30, v30, v9 quad_perm:[1,0,3,2] row_mask:0xf bank_mask:0xf
v_fmac_f32_dpp v31, v31, v9 quad_perm:[1,0,3,2] row_mask:0xf bank_mask:0xf
v_fmac_f32_dpp v62, v62, v9 quad_perm:[1,0,3,2] row_mask:0xf bank_mask:0xf
v_fmac_f32_dpp v63, v63, v9 quad_perm:[1,0,3,2] row_mask:0xf bank_mask:0xf
v_fmac_f32_dpp v22, v22, v9 quad_perm:[1,0,3,2] row_mask:0xf bank_mask:0xf
v_fmac_f32_dpp v23, v23, v9 quad_perm:[1,0,3,2] row_mask:0xf bank_mask:0xf
v_fmac_f32_dpp v54, v54, v9 quad_perm:[1,0,3,2] row_mask:0xf bank_mask:0xf
v_fmac_f32_dpp v55, v55, v9 quad_perm:[1,0,3,2] row_mask:0xf bank_mask:0xf
v_fmac_f32_dpp v38, v38, v9 quad_perm:[1,0,3,2] row_mask:0xf bank_mask:0xf
v_fmac_f32_dpp v39, v39, v9 quad_perm:[1,0,3,2] row_mask:0xf bank_mask:0xf
v_fmac_f32_dpp v70, v70, v9 quad_perm:[1,0,3,2] row_mask:0xf bank_mask:0xf
v_fmac_f32_dpp v71, v71, v9 quad_perm:[1,0,3,2] row_mask:0xf bank_mask:0xf
v_fmac_f32_dpp v78, v78, v9 quad_perm:[1,0,3,2] row_mask:0xf bank_mask:0xf
v_fmac_f32_dpp v79, v79, v9 quad_perm:[1,0,3,2] row_mask:0xf bank_mask:0xf
v_fmac_f32_dpp v32, v32, v9 quad_perm:[1,0,3,2] row_mask:0xf bank_mask:0xf
v_fmac_f32_dpp v33, v33, v9 quad_perm:[1,0,3,2] row_mask:0xf bank_mask:0xf
v_fmac_f32_dpp v24, v24, v9 quad_perm:[1,0,3,2] row_mask:0xf bank_mask:0xf
v_fmac_f32_dpp v25, v25, v9 quad_perm:[1,0,3,2] row_mask:0xf bank_mask:0xf
v_fmac_f32_dpp v56, v56, v9 quad_perm:[1,0,3,2] row_mask:0xf bank_mask:0xf
v_fmac_f32_dpp v57, v57, v9 quad_perm:[1,0,3,2] row_mask:0xf bank_mask:0xf
v_fmac_f32_dpp v20, v20, v9 quad_perm:[1,0,3,2] row_mask:0xf bank_mask:0xf
v_fmac_f32_dpp v21, v21, v9 quad_perm:[1,0,3,2] row_mask:0xf bank_mask:0xf
v_fmac_f32_dpp v52, v52, v9 quad_perm:[1,0,3,2] row_mask:0xf bank_mask:0xf
v_fmac_f32_dpp v53, v53, v9 quad_perm:[1,0,3,2] row_mask:0xf bank_mask:0xf
v_fmac_f32_dpp v36, v36, v9 quad_perm:[1,0,3,2] row_mask:0xf bank_mask:0xf
v_fmac_f32_dpp v37, v37, v9 quad_perm:[1,0,3,2] row_mask:0xf bank_mask:0xf
v_fmac_f32_dpp v68, v68, v9 quad_perm:[1,0,3,2] row_mask:0xf bank_mask:0xf
v_fmac_f32_dpp v69, v69, v9 quad_perm:[1,0,3,2] row_mask:0xf bank_mask:0xf
v_fmac_f32_dpp v18, v18, v9 quad_perm:[1,0,3,2] row_mask:0xf bank_mask:0xf
v_fmac_f32_dpp v19, v19, v9 quad_perm:[1,0,3,2] row_mask:0xf bank_mask:0xf
v_fmac_f32_dpp v50, v50, v9 quad_perm:[1,0,3,2] row_mask:0xf bank_mask:0xf
v_fmac_f32_dpp v51, v51, v9 quad_perm:[1,0,3,2] row_mask:0xf bank_mask:0xf
v_fmac_f32_dpp v34, v34, v9 quad_perm:[1,0,3,2] row_mask:0xf bank_mask:0xf
v_fmac_f32_dpp v35, v35, v9 quad_perm:[1,0,3,2] row_mask:0xf bank_mask:0xf
v_fmac_f32_dpp v66, v66, v9 quad_perm:[1,0,3,2] row_mask:0xf bank_mask:0xf
v_fmac_f32_dpp v67, v67, v9 quad_perm:[1,0,3,2] row_mask:0xf bank_mask:0xf
v_fmac_f32_dpp v26, v26, v9 quad_perm:[1,0,3,2] row_mask:0xf bank_mask:0xf
v_fmac_f32_dpp v27, v27, v9 quad_perm:[1,0,3,2] row_mask:0xf bank_mask:0xf
v_fmac_f32_dpp v58, v58, v9 quad_perm:[1,0,3,2] row_mask:0xf bank_mask:0xf
v_fmac_f32_dpp v59, v59, v9 quad_perm:[1,0,3,2] row_mask:0xf bank_mask:0xf
v_fmac_f32_dpp v42, v42, v9 quad_perm:[1,0,3,2] row_mask:0xf bank_mask:0xf
v_fmac_f32_dpp v43, v43, v9 quad_perm:[1,0,3,2] row_mask:0xf bank_mask:0xf
v_fmac_f32_dpp v74, v74, v9 quad_perm:[1,0,3,2] row_mask:0xf bank_mask:0xf
v_fmac_f32_dpp v75, v75, v9 quad_perm:[1,0,3,2] row_mask:0xf bank_mask:0xf
v_lshlrev_b32 v240, 16, v208
v_and_b32 v241, 0xffff0000, v208
v_pk_mul_f32 v[48:49], v[16:17], v[240:241] op_sel:[0,0] op_sel_hi:[0,1] neg_lo:[0,0] neg_hi:[0,0]
v_pk_fma_f32 v[16:17], v[16:17], v[240:241], v[48:49] op_sel:[1,1,0] op_sel_hi:[1,0,1] neg_lo:[0,1,0] neg_hi:[0,0,0]
v_lshlrev_b32 v240, 16, v209
v_and_b32 v241, 0xffff0000, v209
v_pk_mul_f32 v[48:49], v[14:15], v[240:241] op_sel:[0,0] op_sel_hi:[0,1] neg_lo:[0,0] neg_hi:[0,0]
v_pk_fma_f32 v[14:15], v[14:15], v[240:241], v[48:49] op_sel:[1,1,0] op_sel_hi:[1,0,1] neg_lo:[0,1,0] neg_hi:[0,0,0]
v_lshlrev_b32 v240, 16, v210
v_and_b32 v241, 0xffff0000, v210
v_pk_mul_f32 v[48:49], v[64:65], v[240:241] op_sel:[0,0] op_sel_hi:[0,1] neg_lo:[0,0] neg_hi:[0,0]
v_pk_fma_f32 v[64:65], v[64:65], v[240:241], v[48:49] op_sel:[1,1,0] op_sel_hi:[1,0,1] neg_lo:[0,1,0] neg_hi:[0,0,0]
v_lshlrev_b32 v240, 16, v211
v_and_b32 v241, 0xffff0000, v211
v_pk_mul_f32 v[48:49], v[40:41], v[240:241] op_sel:[0,0] op_sel_hi:[0,1] neg_lo:[0,0] neg_hi:[0,0]
v_pk_fma_f32 v[40:41], v[40:41], v[240:241], v[48:49] op_sel:[1,1,0] op_sel_hi:[1,0,1] neg_lo:[0,1,0] neg_hi:[0,0,0]
v_lshlrev_b32 v240, 16, v212
v_and_b32 v241, 0xffff0000, v212
v_pk_mul_f32 v[48:49], v[72:73], v[240:241] op_sel:[0,0] op_sel_hi:[0,1] neg_lo:[0,0] neg_hi:[0,0]
v_pk_fma_f32 v[72:73], v[72:73], v[240:241], v[48:49] op_sel:[1,1,0] op_sel_hi:[1,0,1] neg_lo:[0,1,0] neg_hi:[0,0,0]
v_lshlrev_b32 v240, 16, v213
v_and_b32 v241, 0xffff0000, v213
v_pk_mul_f32 v[48:49], v[44:45], v[240:241] op_sel:[0,0] op_sel_hi:[0,1] neg_lo:[0,0] neg_hi:[0,0]
v_pk_fma_f32 v[44:45], v[44:45], v[240:241], v[48:49] op_sel:[1,1,0] op_sel_hi:[1,0,1] neg_lo:[0,1,0] neg_hi:[0,0,0]
v_lshlrev_b32 v240, 16, v214
v_and_b32 v241, 0xffff0000, v214
v_pk_mul_f32 v[48:49], v[28:29], v[240:241] op_sel:[0,0] op_sel_hi:[0,1] neg_lo:[0,0] neg_hi:[0,0]
v_pk_fma_f32 v[28:29], v[28:29], v[240:241], v[48:49] op_sel:[1,1,0] op_sel_hi:[1,0,1] neg_lo:[0,1,0] neg_hi:[0,0,0]
v_lshlrev_b32 v240, 16, v215
v_and_b32 v241, 0xffff0000, v215
v_pk_mul_f32 v[48:49], v[60:61], v[240:241] op_sel:[0,0] op_sel_hi:[0,1] neg_lo:[0,0] neg_hi:[0,0]
v_pk_fma_f32 v[60:61], v[60:61], v[240:241], v[48:49] op_sel:[1,1,0] op_sel_hi:[1,0,1] neg_lo:[0,1,0] neg_hi:[0,0,0]
v_lshlrev_b32 v240, 16, v216
v_and_b32 v241, 0xffff0000, v216
v_pk_mul_f32 v[48:49], v[76:77], v[240:241] op_sel:[0,0] op_sel_hi:[0,1] neg_lo:[0,0] neg_hi:[0,0]
v_pk_fma_f32 v[76:77], v[76:77], v[240:241], v[48:49] op_sel:[1,1,0] op_sel_hi:[1,0,1] neg_lo:[0,1,0] neg_hi:[0,0,0]
v_lshlrev_b32 v240, 16, v217
v_and_b32 v241, 0xffff0000, v217
v_pk_mul_f32 v[48:49], v[46:47], v[240:241] op_sel:[0,0] op_sel_hi:[0,1] neg_lo:[0,0] neg_hi:[0,0]
v_pk_fma_f32 v[46:47], v[46:47], v[240:241], v[48:49] op_sel:[1,1,0] op_sel_hi:[1,0,1] neg_lo:[0,1,0] neg_hi:[0,0,0]
v_lshlrev_b32 v240, 16, v218
v_and_b32 v241, 0xffff0000, v218
v_pk_mul_f32 v[48:49], v[30:31], v[240:241] op_sel:[0,0] op_sel_hi:[0,1] neg_lo:[0,0] neg_hi:[0,0]
v_pk_fma_f32 v[30:31], v[30:31], v[240:241], v[48:49] op_sel:[1,1,0] op_sel_hi:[1,0,1] neg_lo:[0,1,0] neg_hi:[0,0,0]
v_lshlrev_b32 v240, 16, v219
v_and_b32 v241, 0xffff0000, v219
v_pk_mul_f32 v[48:49], v[62:63], v[240:241] op_sel:[0,0] op_sel_hi:[0,1] neg_lo:[0,0] neg_hi:[0,0]
v_pk_fma_f32 v[62:63], v[62:63], v[240:241], v[48:49] op_sel:[1,1,0] op_sel_hi:[1,0,1] neg_lo:[0,1,0] neg_hi:[0,0,0]
v_lshlrev_b32 v240, 16, v220
v_and_b32 v241, 0xffff0000, v220
v_pk_mul_f32 v[48:49], v[22:23], v[240:241] op_sel:[0,0] op_sel_hi:[0,1] neg_lo:[0,0] neg_hi:[0,0]
v_pk_fma_f32 v[22:23], v[22:23], v[240:241], v[48:49] op_sel:[1,1,0] op_sel_hi:[1,0,1] neg_lo:[0,1,0] neg_hi:[0,0,0]
v_lshlrev_b32 v240, 16, v221
v_and_b32 v241, 0xffff0000, v221
v_pk_mul_f32 v[48:49], v[54:55], v[240:241] op_sel:[0,0] op_sel_hi:[0,1] neg_lo:[0,0] neg_hi:[0,0]
v_pk_fma_f32 v[54:55], v[54:55], v[240:241], v[48:49] op_sel:[1,1,0] op_sel_hi:[1,0,1] neg_lo:[0,1,0] neg_hi:[0,0,0]
v_lshlrev_b32 v240, 16, v222
v_and_b32 v241, 0xffff0000, v222
v_pk_mul_f32 v[48:49], v[38:39], v[240:241] op_sel:[0,0] op_sel_hi:[0,1] neg_lo:[0,0] neg_hi:[0,0]
v_pk_fma_f32 v[38:39], v[38:39], v[240:241], v[48:49] op_sel:[1,1,0] op_sel_hi:[1,0,1] neg_lo:[0,1,0] neg_hi:[0,0,0]
v_lshlrev_b32 v240, 16, v223
v_and_b32 v241, 0xffff0000, v223
v_pk_mul_f32 v[48:49], v[70:71], v[240:241] op_sel:[0,0] op_sel_hi:[0,1] neg_lo:[0,0] neg_hi:[0,0]
v_pk_fma_f32 v[70:71], v[70:71], v[240:241], v[48:49] op_sel:[1,1,0] op_sel_hi:[1,0,1] neg_lo:[0,1,0] neg_hi:[0,0,0]
v_lshlrev_b32 v240, 16, v224
v_and_b32 v241, 0xffff0000, v224
v_pk_mul_f32 v[48:49], v[78:79], v[240:241] op_sel:[0,0] op_sel_hi:[0,1] neg_lo:[0,0] neg_hi:[0,0]
v_pk_fma_f32 v[78:79], v[78:79], v[240:241], v[48:49] op_sel:[1,1,0] op_sel_hi:[1,0,1] neg_lo:[0,1,0] neg_hi:[0,0,0]
v_lshlrev_b32 v240, 16, v225
v_and_b32 v241, 0xffff0000, v225
v_pk_mul_f32 v[48:49], v[32:33], v[240:241] op_sel:[0,0] op_sel_hi:[0,1] neg_lo:[0,0] neg_hi:[0,0]
v_pk_fma_f32 v[32:33], v[32:33], v[240:241], v[48:49] op_sel:[1,1,0] op_sel_hi:[1,0,1] neg_lo:[0,1,0] neg_hi:[0,0,0]
v_lshlrev_b32 v240, 16, v226
v_and_b32 v241, 0xffff0000, v226
v_pk_mul_f32 v[48:49], v[24:25], v[240:241] op_sel:[0,0] op_sel_hi:[0,1] neg_lo:[0,0] neg_hi:[0,0]
v_pk_fma_f32 v[24:25], v[24:25], v[240:241], v[48:49] op_sel:[1,1,0] op_sel_hi:[1,0,1] neg_lo:[0,1,0] neg_hi:[0,0,0]
v_lshlrev_b32 v240, 16, v227
v_and_b32 v241, 0xffff0000, v227
v_pk_mul_f32 v[48:49], v[56:57], v[240:241] op_sel:[0,0] op_sel_hi:[0,1] neg_lo:[0,0] neg_hi:[0,0]
v_pk_fma_f32 v[56:57], v[56:57], v[240:241], v[48:49] op_sel:[1,1,0] op_sel_hi:[1,0,1] neg_lo:[0,1,0] neg_hi:[0,0,0]
v_lshlrev_b32 v240, 16, v228
v_and_b32 v241, 0xffff0000, v228
v_pk_mul_f32 v[48:49], v[20:21], v[240:241] op_sel:[0,0] op_sel_hi:[0,1] neg_lo:[0,0] neg_hi:[0,0]
v_pk_fma_f32 v[20:21], v[20:21], v[240:241], v[48:49] op_sel:[1,1,0] op_sel_hi:[1,0,1] neg_lo:[0,1,0] neg_hi:[0,0,0]
v_lshlrev_b32 v240, 16, v229
v_and_b32 v241, 0xffff0000, v229
v_pk_mul_f32 v[48:49], v[52:53], v[240:241] op_sel:[0,0] op_sel_hi:[0,1] neg_lo:[0,0] neg_hi:[0,0]
v_pk_fma_f32 v[52:53], v[52:53], v[240:241], v[48:49] op_sel:[1,1,0] op_sel_hi:[1,0,1] neg_lo:[0,1,0] neg_hi:[0,0,0]
v_lshlrev_b32 v240, 16, v230
v_and_b32 v241, 0xffff0000, v230
v_pk_mul_f32 v[48:49], v[36:37], v[240:241] op_sel:[0,0] op_sel_hi:[0,1] neg_lo:[0,0] neg_hi:[0,0]
v_pk_fma_f32 v[36:37], v[36:37], v[240:241], v[48:49] op_sel:[1,1,0] op_sel_hi:[1,0,1] neg_lo:[0,1,0] neg_hi:[0,0,0]
v_lshlrev_b32 v240, 16, v231
v_and_b32 v241, 0xffff0000, v231
v_pk_mul_f32 v[48:49], v[68:69], v[240:241] op_sel:[0,0] op_sel_hi:[0,1] neg_lo:[0,0] neg_hi:[0,0]
v_pk_fma_f32 v[68:69], v[68:69], v[240:241], v[48:49] op_sel:[1,1,0] op_sel_hi:[1,0,1] neg_lo:[0,1,0] neg_hi:[0,0,0]
v_lshlrev_b32 v240, 16, v232
v_and_b32 v241, 0xffff0000, v232
v_pk_mul_f32 v[48:49], v[18:19], v[240:241] op_sel:[0,0] op_sel_hi:[0,1] neg_lo:[0,0] neg_hi:[0,0]
v_pk_fma_f32 v[18:19], v[18:19], v[240:241], v[48:49] op_sel:[1,1,0] op_sel_hi:[1,0,1] neg_lo:[0,1,0] neg_hi:[0,0,0]
v_lshlrev_b32 v240, 16, v233
v_and_b32 v241, 0xffff0000, v233
v_pk_mul_f32 v[48:49], v[50:51], v[240:241] op_sel:[0,0] op_sel_hi:[0,1] neg_lo:[0,0] neg_hi:[0,0]
v_pk_fma_f32 v[50:51], v[50:51], v[240:241], v[48:49] op_sel:[1,1,0] op_sel_hi:[1,0,1] neg_lo:[0,1,0] neg_hi:[0,0,0]
v_lshlrev_b32 v240, 16, v234
v_and_b32 v241, 0xffff0000, v234
v_pk_mul_f32 v[48:49], v[34:35], v[240:241] op_sel:[0,0] op_sel_hi:[0,1] neg_lo:[0,0] neg_hi:[0,0]
v_pk_fma_f32 v[34:35], v[34:35], v[240:241], v[48:49] op_sel:[1,1,0] op_sel_hi:[1,0,1] neg_lo:[0,1,0] neg_hi:[0,0,0]
v_lshlrev_b32 v240, 16, v235
v_and_b32 v241, 0xffff0000, v235
v_pk_mul_f32 v[48:49], v[66:67], v[240:241] op_sel:[0,0] op_sel_hi:[0,1] neg_lo:[0,0] neg_hi:[0,0]
v_pk_fma_f32 v[66:67], v[66:67], v[240:241], v[48:49] op_sel:[1,1,0] op_sel_hi:[1,0,1] neg_lo:[0,1,0] neg_hi:[0,0,0]
v_lshlrev_b32 v240, 16, v236
v_and_b32 v241, 0xffff0000, v236
v_pk_mul_f32 v[48:49], v[26:27], v[240:241] op_sel:[0,0] op_sel_hi:[0,1] neg_lo:[0,0] neg_hi:[0,0]
v_pk_fma_f32 v[26:27], v[26:27], v[240:241], v[48:49] op_sel:[1,1,0] op_sel_hi:[1,0,1] neg_lo:[0,1,0] neg_hi:[0,0,0]
v_lshlrev_b32 v240, 16, v237
v_and_b32 v241, 0xffff0000, v237
v_pk_mul_f32 v[48:49], v[58:59], v[240:241] op_sel:[0,0] op_sel_hi:[0,1] neg_lo:[0,0] neg_hi:[0,0]
v_pk_fma_f32 v[58:59], v[58:59], v[240:241], v[48:49] op_sel:[1,1,0] op_sel_hi:[1,0,1] neg_lo:[0,1,0] neg_hi:[0,0,0]
v_lshlrev_b32 v240, 16, v238
v_and_b32 v241, 0xffff0000, v238
v_pk_mul_f32 v[48:49], v[42:43], v[240:241] op_sel:[0,0] op_sel_hi:[0,1] neg_lo:[0,0] neg_hi:[0,0]
v_pk_fma_f32 v[42:43], v[42:43], v[240:241], v[48:49] op_sel:[1,1,0] op_sel_hi:[1,0,1] neg_lo:[0,1,0] neg_hi:[0,0,0]
v_lshlrev_b32 v240, 16, v239
v_and_b32 v241, 0xffff0000, v239
v_pk_mul_f32 v[48:49], v[74:75], v[240:241] op_sel:[0,0] op_sel_hi:[0,1] neg_lo:[0,0] neg_hi:[0,0]
v_pk_fma_f32 v[74:75], v[74:75], v[240:241], v[48:49] op_sel:[1,1,0] op_sel_hi:[1,0,1] neg_lo:[0,1,0] neg_hi:[0,0,0]
v_fmac_f32_dpp v16, v16, v7 quad_perm:[1,0,3,2] row_mask:0xf bank_mask:0xf
v_fmac_f32_dpp v17, v17, v7 quad_perm:[1,0,3,2] row_mask:0xf bank_mask:0xf
v_fmac_f32_dpp v14, v14, v7 quad_perm:[1,0,3,2] row_mask:0xf bank_mask:0xf
v_fmac_f32_dpp v15, v15, v7 quad_perm:[1,0,3,2] row_mask:0xf bank_mask:0xf
v_fmac_f32_dpp v64, v64, v7 quad_perm:[1,0,3,2] row_mask:0xf bank_mask:0xf
v_fmac_f32_dpp v65, v65, v7 quad_perm:[1,0,3,2] row_mask:0xf bank_mask:0xf
v_fmac_f32_dpp v40, v40, v7 quad_perm:[1,0,3,2] row_mask:0xf bank_mask:0xf
v_fmac_f32_dpp v41, v41, v7 quad_perm:[1,0,3,2] row_mask:0xf bank_mask:0xf
v_fmac_f32_dpp v72, v72, v7 quad_perm:[1,0,3,2] row_mask:0xf bank_mask:0xf
v_fmac_f32_dpp v73, v73, v7 quad_perm:[1,0,3,2] row_mask:0xf bank_mask:0xf
v_fmac_f32_dpp v44, v44, v7 quad_perm:[1,0,3,2] row_mask:0xf bank_mask:0xf
v_fmac_f32_dpp v45, v45, v7 quad_perm:[1,0,3,2] row_mask:0xf bank_mask:0xf
v_fmac_f32_dpp v28, v28, v7 quad_perm:[1,0,3,2] row_mask:0xf bank_mask:0xf
v_fmac_f32_dpp v29, v29, v7 quad_perm:[1,0,3,2] row_mask:0xf bank_mask:0xf
v_fmac_f32_dpp v60, v60, v7 quad_perm:[1,0,3,2] row_mask:0xf bank_mask:0xf
v_fmac_f32_dpp v61, v61, v7 quad_perm:[1,0,3,2] row_mask:0xf bank_mask:0xf
v_fmac_f32_dpp v76, v76, v7 quad_perm:[1,0,3,2] row_mask:0xf bank_mask:0xf
v_fmac_f32_dpp v77, v77, v7 quad_perm:[1,0,3,2] row_mask:0xf bank_mask:0xf
v_fmac_f32_dpp v46, v46, v7 quad_perm:[1,0,3,2] row_mask:0xf bank_mask:0xf
v_fmac_f32_dpp v47, v47, v7 quad_perm:[1,0,3,2] row_mask:0xf bank_mask:0xf
v_fmac_f32_dpp v30, v30, v7 quad_perm:[1,0,3,2] row_mask:0xf bank_mask:0xf
v_fmac_f32_dpp v31, v31, v7 quad_perm:[1,0,3,2] row_mask:0xf bank_mask:0xf
v_fmac_f32_dpp v62, v62, v7 quad_perm:[1,0,3,2] row_mask:0xf bank_mask:0xf
v_fmac_f32_dpp v63, v63, v7 quad_perm:[1,0,3,2] row_mask:0xf bank_mask:0xf
v_fmac_f32_dpp v22, v22, v7 quad_perm:[1,0,3,2] row_mask:0xf bank_mask:0xf
v_fmac_f32_dpp v23, v23, v7 quad_perm:[1,0,3,2] row_mask:0xf bank_mask:0xf
v_fmac_f32_dpp v54, v54, v7 quad_perm:[1,0,3,2] row_mask:0xf bank_mask:0xf
v_fmac_f32_dpp v55, v55, v7 quad_perm:[1,0,3,2] row_mask:0xf bank_mask:0xf
v_fmac_f32_dpp v38, v38, v7 quad_perm:[1,0,3,2] row_mask:0xf bank_mask:0xf
v_fmac_f32_dpp v39, v39, v7 quad_perm:[1,0,3,2] row_mask:0xf bank_mask:0xf
v_fmac_f32_dpp v70, v70, v7 quad_perm:[1,0,3,2] row_mask:0xf bank_mask:0xf
v_fmac_f32_dpp v71, v71, v7 quad_perm:[1,0,3,2] row_mask:0xf bank_mask:0xf
v_fmac_f32_dpp v78, v78, v7 quad_perm:[1,0,3,2] row_mask:0xf bank_mask:0xf
v_fmac_f32_dpp v79, v79, v7 quad_perm:[1,0,3,2] row_mask:0xf bank_mask:0xf
v_fmac_f32_dpp v32, v32, v7 quad_perm:[1,0,3,2] row_mask:0xf bank_mask:0xf
v_fmac_f32_dpp v33, v33, v7 quad_perm:[1,0,3,2] row_mask:0xf bank_mask:0xf
v_fmac_f32_dpp v24, v24, v7 quad_perm:[1,0,3,2] row_mask:0xf bank_mask:0xf
v_fmac_f32_dpp v25, v25, v7 quad_perm:[1,0,3,2] row_mask:0xf bank_mask:0xf
v_fmac_f32_dpp v56, v56, v7 quad_perm:[1,0,3,2] row_mask:0xf bank_mask:0xf
v_fmac_f32_dpp v57, v57, v7 quad_perm:[1,0,3,2] row_mask:0xf bank_mask:0xf
v_fmac_f32_dpp v20, v20, v7 quad_perm:[1,0,3,2] row_mask:0xf bank_mask:0xf
v_fmac_f32_dpp v21, v21, v7 quad_perm:[1,0,3,2] row_mask:0xf bank_mask:0xf
v_fmac_f32_dpp v52, v52, v7 quad_perm:[1,0,3,2] row_mask:0xf bank_mask:0xf
v_fmac_f32_dpp v53, v53, v7 quad_perm:[1,0,3,2] row_mask:0xf bank_mask:0xf
v_fmac_f32_dpp v36, v36, v7 quad_perm:[1,0,3,2] row_mask:0xf bank_mask:0xf
v_fmac_f32_dpp v37, v37, v7 quad_perm:[1,0,3,2] row_mask:0xf bank_mask:0xf
v_fmac_f32_dpp v68, v68, v7 quad_perm:[1,0,3,2] row_mask:0xf bank_mask:0xf
v_fmac_f32_dpp v69, v69, v7 quad_perm:[1,0,3,2] row_mask:0xf bank_mask:0xf
v_fmac_f32_dpp v18, v18, v7 quad_perm:[1,0,3,2] row_mask:0xf bank_mask:0xf
v_fmac_f32_dpp v19, v19, v7 quad_perm:[1,0,3,2] row_mask:0xf bank_mask:0xf
v_fmac_f32_dpp v50, v50, v7 quad_perm:[1,0,3,2] row_mask:0xf bank_mask:0xf
v_fmac_f32_dpp v51, v51, v7 quad_perm:[1,0,3,2] row_mask:0xf bank_mask:0xf
v_fmac_f32_dpp v34, v34, v7 quad_perm:[1,0,3,2] row_mask:0xf bank_mask:0xf
v_fmac_f32_dpp v35, v35, v7 quad_perm:[1,0,3,2] row_mask:0xf bank_mask:0xf
v_fmac_f32_dpp v66, v66, v7 quad_perm:[1,0,3,2] row_mask:0xf bank_mask:0xf
v_fmac_f32_dpp v67, v67, v7 quad_perm:[1,0,3,2] row_mask:0xf bank_mask:0xf
v_fmac_f32_dpp v26, v26, v7 quad_perm:[1,0,3,2] row_mask:0xf bank_mask:0xf
v_fmac_f32_dpp v27, v27, v7 quad_perm:[1,0,3,2] row_mask:0xf bank_mask:0xf
v_fmac_f32_dpp v58, v58, v7 quad_perm:[1,0,3,2] row_mask:0xf bank_mask:0xf
v_fmac_f32_dpp v59, v59, v7 quad_perm:[1,0,3,2] row_mask:0xf bank_mask:0xf
v_fmac_f32_dpp v42, v42, v7 quad_perm:[1,0,3,2] row_mask:0xf bank_mask:0xf
v_fmac_f32_dpp v43, v43, v7 quad_perm:[1,0,3,2] row_mask:0xf bank_mask:0xf
v_fmac_f32_dpp v74, v74, v7 quad_perm:[1,0,3,2] row_mask:0xf bank_mask:0xf
v_fmac_f32_dpp v75, v75, v7 quad_perm:[1,0,3,2] row_mask:0xf bank_mask:0xf
s_mov_b64 exec, s[18:19]
v_pk_add_f32 v[16:17], v[16:17], 0 neg_lo:[1,0] neg_hi:[1,0]
v_pk_mul_f32 v[48:49], v[14:15], s[48:49] op_sel:[0,0] op_sel_hi:[0,1] neg_lo:[0,1] neg_hi:[0,1]
v_pk_fma_f32 v[14:15], v[14:15], s[48:49], v[48:49] op_sel:[1,1,0] op_sel_hi:[1,0,1] neg_lo:[0,0,0] neg_hi:[0,1,0]
v_pk_mul_f32 v[48:49], v[64:65], s[50:51] op_sel:[0,0] op_sel_hi:[0,1] neg_lo:[0,1] neg_hi:[0,1]
v_pk_fma_f32 v[64:65], v[64:65], s[50:51], v[48:49] op_sel:[1,1,0] op_sel_hi:[1,0,1] neg_lo:[0,0,0] neg_hi:[0,1,0]
v_pk_mul_f32 v[48:49], v[40:41], s[52:53] op_sel:[0,0] op_sel_hi:[0,1] neg_lo:[0,1] neg_hi:[0,1]
v_pk_fma_f32 v[40:41], v[40:41], s[52:53], v[48:49] op_sel:[1,1,0] op_sel_hi:[1,0,1] neg_lo:[0,0,0] neg_hi:[0,1,0]
v_pk_mul_f32 v[48:49], v[72:73], s[54:55] op_sel:[0,0] op_sel_hi:[0,1] neg_lo:[0,1] neg_hi:[0,1]
v_pk_fma_f32 v[72:73], v[72:73], s[54:55], v[48:49] op_sel:[1,1,0] op_sel_hi:[1,0,1] neg_lo:[0,0,0] neg_hi:[0,1,0]
v_pk_mul_f32 v[48:49], v[44:45], s[56:57] op_sel:[0,0] op_sel_hi:[0,1] neg_lo:[0,1] neg_hi:[0,1]
v_pk_fma_f32 v[44:45], v[44:45], s[56:57], v[48:49] op_sel:[1,1,0] op_sel_hi:[1,0,1] neg_lo:[0,0,0] neg_hi:[0,1,0]
v_pk_mul_f32 v[48:49], v[28:29], s[58:59] op_sel:[0,0] op_sel_hi:[0,1] neg_lo:[0,1] neg_hi:[0,1]
v_pk_fma_f32 v[28:29], v[28:29], s[58:59], v[48:49] op_sel:[1,1,0] op_sel_hi:[1,0,1] neg_lo:[0,0,0] neg_hi:[0,1,0]
v_pk_mul_f32 v[48:49], v[60:61], s[60:61] op_sel:[0,0] op_sel_hi:[0,1] neg_lo:[0,1] neg_hi:[0,1]
v_pk_fma_f32 v[60:61], v[60:61], s[60:61], v[48:49] op_sel:[1,1,0] op_sel_hi:[1,0,1] neg_lo:[0,0,0] neg_hi:[0,1,0]
v_pk_mul_f32 v[48:49], v[76:77], s[62:63] op_sel:[0,0] op_sel_hi:[0,1] neg_lo:[0,1] neg_hi:[0,1]
v_pk_fma_f32 v[76:77], v[76:77], s[62:63], v[48:49] op_sel:[1,1,0] op_sel_hi:[1,0,1] neg_lo:[0,0,0] neg_hi:[0,1,0]
v_pk_mul_f32 v[48:49], v[46:47], s[60:61] op_sel:[0,1] op_sel_hi:[0,0] neg_lo:[0,1] neg_hi:[0,1]
v_pk_fma_f32 v[46:47], v[46:47], s[60:61], v[48:49] op_sel:[1,0,0] op_sel_hi:[1,1,1] neg_lo:[0,0,0] neg_hi:[0,1,0]
v_pk_mul_f32 v[48:49], v[30:31], s[58:59] op_sel:[0,1] op_sel_hi:[0,0] neg_lo:[0,1] neg_hi:[0,1]
v_pk_fma_f32 v[30:31], v[30:31], s[58:59], v[48:49] op_sel:[1,0,0] op_sel_hi:[1,1,1] neg_lo:[0,0,0] neg_hi:[0,1,0]
v_pk_mul_f32 v[48:49], v[62:63], s[56:57] op_sel:[0,1] op_sel_hi:[0,0] neg_lo:[0,1] neg_hi:[0,1]
v_pk_fma_f32 v[62:63], v[62:63], s[56:57], v[48:49] op_sel:[1,0,0] op_sel_hi:[1,1,1] neg_lo:[0,0,0] neg_hi:[0,1,0]
v_pk_mul_f32 v[48:49], v[22:23], s[54:55] op_sel:[0,1] op_sel_hi:[0,0] neg_lo:[0,1] neg_hi:[0,1]
v_pk_fma_f32 v[22:23], v[22:23], s[54:55], v[48:49] op_sel:[1,0,0] op_sel_hi:[1,1,1] neg_lo:[0,0,0] neg_hi:[0,1,0]
v_pk_mul_f32 v[48:49], v[54:55], s[52:53] op_sel:[0,1] op_sel_hi:[0,0] neg_lo:[0,1] neg_hi:[0,1]
v_pk_fma_f32 v[54:55], v[54:55], s[52:53], v[48:49] op_sel:[1,0,0] op_sel_hi:[1,1,1] neg_lo:[0,0,0] neg_hi:[0,1,0]
v_pk_mul_f32 v[48:49], v[38:39], s[50:51] op_sel:[0,1] op_sel_hi:[0,0] neg_lo:[0,1] neg_hi:[0,1]
v_pk_fma_f32 v[38:39], v[38:39], s[50:51], v[48:49] op_sel:[1,0,0] op_sel_hi:[1,1,1] neg_lo:[0,0,0] neg_hi:[0,1,0]
v_pk_mul_f32 v[48:49], v[70:71], s[48:49] op_sel:[0,1] op_sel_hi:[0,0] neg_lo:[0,1] neg_hi:[0,1]
v_pk_fma_f32 v[70:71], v[70:71], s[48:49], v[48:49] op_sel:[1,0,0] op_sel_hi:[1,1,1] neg_lo:[0,0,0] neg_hi:[0,1,0]
v_pk_add_f32 v[78:79], v[78:79], 0 op_sel:[1,0] op_sel_hi:[0,0] neg_lo:[0,0] neg_hi:[1,0]
v_pk_mul_f32 v[48:49], v[32:33], s[48:49] op_sel:[0,1] op_sel_hi:[0,0] neg_lo:[0,0] neg_hi:[0,1]
v_pk_fma_f32 v[32:33], v[32:33], s[48:49], v[48:49] op_sel:[1,0,0] op_sel_hi:[1,1,1] neg_lo:[0,0,0] neg_hi:[0,0,0]
v_pk_mul_f32 v[48:49], v[24:25], s[50:51] op_sel:[0,1] op_sel_hi:[0,0] neg_lo:[0,0] neg_hi:[0,1]
v_pk_fma_f32 v[24:25], v[24:25], s[50:51], v[48:49] op_sel:[1,0,0] op_sel_hi:[1,1,1] neg_lo:[0,0,0] neg_hi:[0,0,0]
v_pk_mul_f32 v[48:49], v[56:57], s[52:53] op_sel:[0,1] op_sel_hi:[0,0] neg_lo:[0,0] neg_hi:[0,1]
v_pk_fma_f32 v[56:57], v[56:57], s[52:53], v[48:49] op_sel:[1,0,0] op_sel_hi:[1,1,1] neg_lo:[0,0,0] neg_hi:[0,0,0]
v_pk_mul_f32 v[48:49], v[20:21], s[54:55] op_sel:[0,1] op_sel_hi:[0,0] neg_lo:[0,0] neg_hi:[0,1]
v_pk_fma_f32 v[20:21], v[20:21], s[54:55], v[48:49] op_sel:[1,0,0] op_sel_hi:[1,1,1] neg_lo:[0,0,0] neg_hi:[0,0,0]
v_pk_mul_f32 v[48:49], v[52:53], s[56:57] op_sel:[0,1] op_sel_hi:[0,0] neg_lo:[0,0] neg_hi:[0,1]
v_pk_fma_f32 v[52:53], v[52:53], s[56:57], v[48:49] op_sel:[1,0,0] op_sel_hi:[1,1,1] neg_lo:[0,0,0] neg_hi:[0,0,0]
v_pk_mul_f32 v[48:49], v[36:37], s[58:59] op_sel:[0,1] op_sel_hi:[0,0] neg_lo:[0,0] neg_hi:[0,1]
v_pk_fma_f32 v[36:37], v[36:37], s[58:59], v[48:49] op_sel:[1,0,0] op_sel_hi:[1,1,1] neg_lo:[0,0,0] neg_hi:[0,0,0]
v_pk_mul_f32 v[48:49], v[68:69], s[60:61] op_sel:[0,1] op_sel_hi:[0,0] neg_lo:[0,0] neg_hi:[0,1]
v_pk_fma_f32 v[68:69], v[68:69], s[60:61], v[48:49] op_sel:[1,0,0] op_sel_hi:[1,1,1] neg_lo:[0,0,0] neg_hi:[0,0,0]
v_pk_mul_f32 v[48:49], v[18:19], s[62:63] op_sel:[0,0] op_sel_hi:[0,1] neg_lo:[0,0] neg_hi:[0,1]
v_pk_fma_f32 v[18:19], v[18:19], s[62:63], v[48:49] op_sel:[1,1,0] op_sel_hi:[1,0,1] neg_lo:[0,0,0] neg_hi:[0,0,0]
v_pk_mul_f32 v[48:49], v[50:51], s[60:61] op_sel:[0,0] op_sel_hi:[0,1] neg_lo:[0,0] neg_hi:[0,1]
v_pk_fma_f32 v[50:51], v[50:51], s[60:61], v[48:49] op_sel:[1,1,0] op_sel_hi:[1,0,1] neg_lo:[0,0,0] neg_hi:[0,0,0]
v_pk_mul_f32 v[48:49], v[34:35], s[58:59] op_sel:[0,0] op_sel_hi:[0,1] neg_lo:[0,0] neg_hi:[0,1]
v_pk_fma_f32 v[34:35], v[34:35], s[58:59], v[48:49] op_sel:[1,1,0] op_sel_hi:[1,0,1] neg_lo:[0,0,0] neg_hi:[0,0,0]
v_pk_mul_f32 v[48:49], v[66:67], s[56:57] op_sel:[0,0] op_sel_hi:[0,1] neg_lo:[0,0] neg_hi:[0,1]
v_pk_fma_f32 v[66:67], v[66:67], s[56:57], v[48:49] op_sel:[1,1,0] op_sel_hi:[1,0,1] neg_lo:[0,0,0] neg_hi:[0,0,0]
v_pk_mul_f32 v[48:49], v[26:27], s[54:55] op_sel:[0,0] op_sel_hi:[0,1] neg_lo:[0,0] neg_hi:[0,1]
v_pk_fma_f32 v[26:27], v[26:27], s[54:55], v[48:49] op_sel:[1,1,0] op_sel_hi:[1,0,1] neg_lo:[0,0,0] neg_hi:[0,0,0]
v_pk_mul_f32 v[48:49], v[58:59], s[52:53] op_sel:[0,0] op_sel_hi:[0,1] neg_lo:[0,0] neg_hi:[0,1]
v_pk_fma_f32 v[58:59], v[58:59], s[52:53], v[48:49] op_sel:[1,1,0] op_sel_hi:[1,0,1] neg_lo:[0,0,0] neg_hi:[0,0,0]
v_pk_mul_f32 v[48:49], v[42:43], s[50:51] op_sel:[0,0] op_sel_hi:[0,1] neg_lo:[0,0] neg_hi:[0,1]
v_pk_fma_f32 v[42:43], v[42:43], s[50:51], v[48:49] op_sel:[1,1,0] op_sel_hi:[1,0,1] neg_lo:[0,0,0] neg_hi:[0,0,0]
v_pk_mul_f32 v[48:49], v[74:75], s[48:49] op_sel:[0,0] op_sel_hi:[0,1] neg_lo:[0,0] neg_hi:[0,1]
v_pk_fma_f32 v[74:75], v[74:75], s[48:49], v[48:49] op_sel:[1,1,0] op_sel_hi:[1,0,1] neg_lo:[0,0,0] neg_hi:[0,0,0]
s_mov_b64 exec, -1
v_pk_add_f32 v[48:49], v[16:17], v[78:79] neg_lo:[0,1] neg_hi:[0,1]
v_pk_add_f32 v[16:17], v[16:17], v[78:79]
v_pk_add_f32 v[78:79], v[14:15], v[32:33] neg_lo:[0,1] neg_hi:[0,1]
v_pk_add_f32 v[14:15], v[14:15], v[32:33]
v_pk_mul_f32 v[32:33], v[78:79], s[50:51] op_sel:[0,0] op_sel_hi:[0,1] neg_lo:[0,0] neg_hi:[0,0]
v_pk_fma_f32 v[32:33], v[78:79], s[50:51], v[32:33] op_sel:[1,1,0] op_sel_hi:[1,0,1] neg_lo:[0,1,0] neg_hi:[0,0,0]
v_pk_add_f32 v[78:79], v[64:65], v[24:25] neg_lo:[0,1] neg_hi:[0,1]
v_pk_add_f32 v[64:65], v[64:65], v[24:25]
v_pk_mul_f32 v[24:25], v[78:79], s[54:55] op_sel:[0,0] op_sel_hi:[0,1] neg_lo:[0,0] neg_hi:[0,0]
v_pk_fma_f32 v[24:25], v[78:79], s[54:55], v[24:25] op_sel:[1,1,0] op_sel_hi:[1,0,1] neg_lo:[0,1,0] neg_hi:[0,0,0]
v_pk_add_f32 v[78:79], v[40:41], v[56:57] neg_lo:[0,1] neg_hi:[0,1]
v_pk_add_f32 v[40:41], v[40:41], v[56:57]
v_pk_mul_f32 v[56:57], v[78:79], s[58:59] op_sel:[0,0] op_sel_hi:[0,1] neg_lo:[0,0] neg_hi:[0,0]
v_pk_fma_f32 v[56:57], v[78:79], s[58:59], v[56:57] op_sel:[1,1,0] op_sel_hi:[1,0,1] neg_lo:[0,1,0] neg_hi:[0,0,0]
v_pk_add_f32 v[78:79], v[72:73], v[20:21] neg_lo:[0,1] neg_hi:[0,1]
v_pk_add_f32 v[72:73], v[72:73], v[20:21]
v_pk_mul_f32 v[20:21], v[78:79], s[62:63] op_sel:[0,0] op_sel_hi:[0,1] neg_lo:[0,0] neg_hi:[0,0]
v_pk_fma_f32 v[20:21], v[78:79], s[62:63], v[20:21] op_sel:[1,1,0] op_sel_hi:[1,0,1] neg_lo:[0,1,0] neg_hi:[0,0,0]
v_pk_add_f32 v[78:79], v[44:45], v[52:53] neg_lo:[0,1] neg_hi:[0,1]
v_pk_add_f32 v[44:45], v[44:45], v[52:53]
v_pk_mul_f32 v[52:53], v[78:79], s[58:59] op_sel:[0,1] op_sel_hi:[0,0] neg_lo:[0,0] neg_hi:[0,0]
v_pk_fma_f32 v[52:53], v[78:79], s[58:59], v[52:53] op_sel:[1,0,0] op_sel_hi:[1,1,1] neg_lo:[0,1,0] neg_hi:[0,0,0]
v_pk_add_f32 v[78:79], v[28:29], v[36:37] neg_lo:[0,1] neg_hi:[0,1]
v_pk_add_f32 v[28:29], v[28:29], v[36:37]
v_pk_mul_f32 v[36:37], v[78:79], s[54:55] op_sel:[0,1] op_sel_hi:[0,0] neg_lo:[0,0] neg_hi:[0,0]
v_pk_fma_f32 v[36:37], v[78:79], s[54:55], v[36:37] op_sel:[1,0,0] op_sel_hi:[1,1,1] neg_lo:[0,1,0] neg_hi:[0,0,0]
v_pk_add_f32 v[78:79], v[60:61], v[68:69] neg_lo:[0,1] neg_hi:[0,1]
v_pk_add_f32 v[60:61], v[60:61], v[68:69]
v_pk_mul_f32 v[68:69], v[78:79], s[50:51] op_sel:[0,1] op_sel_hi:[0,0] neg_lo:[0,0] neg_hi:[0,0]
v_pk_fma_f32 v[68:69], v[78:79], s[50:51], v[68:69] op_sel:[1,0,0] op_sel_hi:[1,1,1] neg_lo:[0,1,0] neg_hi:[0,0,0]
v_pk_add_f32 v[78:79], v[76:77], v[18:19] op_sel:[1,1] op_sel_hi:[0,0] neg_lo:[1,0] neg_hi:[0,1]
v_pk_add_f32 v[76:77], v[76:77], v[18:19]
v_pk_add_f32 v[18:19], v[46:47], v[50:51] neg_lo:[0,1] neg_hi:[0,1]
v_pk_add_f32 v[46:47], v[46:47], v[50:51]
v_pk_mul_f32 v[50:51], v[18:19], s[50:51] op_sel:[0,1] op_sel_hi:[0,0] neg_lo:[0,1] neg_hi:[0,0]
v_pk_fma_f32 v[50:51], v[18:19], s[50:51], v[50:51] op_sel:[1,0,0] op_sel_hi:[1,1,1] neg_lo:[0,1,0] neg_hi:[0,1,0]
v_pk_add_f32 v[18:19], v[30:31], v[34:35] neg_lo:[0,1] neg_hi:[0,1]
v_pk_add_f32 v[30:31], v[30:31], v[34:35]
v_pk_mul_f32 v[34:35], v[18:19], s[54:55] op_sel:[0,1] op_sel_hi:[0,0] neg_lo:[0,1] neg_hi:[0,0]
v_pk_fma_f32 v[34:35], v[18:19], s[54:55], v[34:35] op_sel:[1,0,0] op_sel_hi:[1,1,1] neg_lo:[0,1,0] neg_hi:[0,1,0]
v_pk_add_f32 v[18:19], v[62:63], v[66:67] neg_lo:[0,1] neg_hi:[0,1]
v_pk_add_f32 v[62:63], v[62:63], v[66:67]
v_pk_mul_f32 v[66:67], v[18:19], s[58:59] op_sel:[0,1] op_sel_hi:[0,0] neg_lo:[0,1] neg_hi:[0,0]
v_pk_fma_f32 v[66:67], v[18:19], s[58:59], v[66:67] op_sel:[1,0,0] op_sel_hi:[1,1,1] neg_lo:[0,1,0] neg_hi:[0,1,0]
v_pk_add_f32 v[18:19], v[22:23], v[26:27] neg_lo:[0,1] neg_hi:[0,1]
v_pk_add_f32 v[22:23], v[22:23], v[26:27]
v_pk_mul_f32 v[26:27], v[18:19], s[62:63] op_sel:[0,0] op_sel_hi:[0,1] neg_lo:[0,1] neg_hi:[0,0]
v_pk_fma_f32 v[26:27], v[18:19], s[62:63], v[26:27] op_sel:[1,1,0] op_sel_hi:[1,0,1] neg_lo:[0,1,0] neg_hi:[0,1,0]
v_pk_add_f32 v[18:19], v[54:55], v[58:59] neg_lo:[0,1] neg_hi:[0,1]
v_pk_add_f32 v[54:55], v[54:55], v[58:59]
v_pk_mul_f32 v[58:59], v[18:19], s[58:59] op_sel:[0,0] op_sel_hi:[0,1] neg_lo:[0,1] neg_hi:[0,0]
v_pk_fma_f32 v[58:59], v[18:19], s[58:59], v[58:59] op_sel:[1,1,0] op_sel_hi:[1,0,1] neg_lo:[0,1,0] neg_hi:[0,1,0]
v_pk_add_f32 v[18:19], v[38:39], v[42:43] neg_lo:[0,1] neg_hi:[0,1]
v_pk_add_f32 v[38:39], v[38:39], v[42:43]
v_pk_mul_f32 v[42:43], v[18:19], s[54:55] op_sel:[0,0] op_sel_hi:[0,1] neg_lo:[0,1] neg_hi:[0,0]
v_pk_fma_f32 v[42:43], v[18:19], s[54:55], v[42:43] op_sel:[1,1,0] op_sel_hi:[1,0,1] neg_lo:[0,1,0] neg_hi:[0,1,0]
v_pk_add_f32 v[18:19], v[70:71], v[74:75] neg_lo:[0,1] neg_hi:[0,1]
v_pk_add_f32 v[70:71], v[70:71], v[74:75]
v_pk_mul_f32 v[74:75], v[18:19], s[50:51] op_sel:[0,0] op_sel_hi:[0,1] neg_lo:[0,1] neg_hi:[0,0]
v_pk_fma_f32 v[74:75], v[18:19], s[50:51], v[74:75] op_sel:[1,1,0] op_sel_hi:[1,0,1] neg_lo:[0,1,0] neg_hi:[0,1,0]
v_pk_add_f32 v[18:19], v[16:17], v[76:77] neg_lo:[0,1] neg_hi:[0,1]
v_pk_add_f32 v[16:17], v[16:17], v[76:77]
v_pk_add_f32 v[76:77], v[14:15], v[46:47] neg_lo:[0,1] neg_hi:[0,1]
v_pk_add_f32 v[14:15], v[14:15], v[46:47]
v_pk_mul_f32 v[46:47], v[76:77], s[54:55] op_sel:[0,0] op_sel_hi:[0,1] neg_lo:[0,0] neg_hi:[0,0]
v_pk_fma_f32 v[46:47], v[76:77], s[54:55], v[46:47] op_sel:[1,1,0] op_sel_hi:[1,0,1] neg_lo:[0,1,0] neg_hi:[0,0,0]
v_pk_add_f32 v[76:77], v[64:65], v[30:31] neg_lo:[0,1] neg_hi:[0,1]
v_pk_add_f32 v[64:65], v[64:65], v[30:31]
v_pk_mul_f32 v[30:31], v[76:77], s[62:63] op_sel:[0,0] op_sel_hi:[0,1] neg_lo:[0,0] neg_hi:[0,0]
v_pk_fma_f32 v[30:31], v[76:77], s[62:63], v[30:31] op_sel:[1,1,0] op_sel_hi:[1,0,1] neg_lo:[0,1,0] neg_hi:[0,0,0]
v_pk_add_f32 v[76:77], v[40:41], v[62:63] neg_lo:[0,1] neg_hi:[0,1]
v_pk_add_f32 v[40:41], v[40:41], v[62:63]
v_pk_mul_f32 v[62:63], v[76:77], s[54:55] op_sel:[0,1] op_sel_hi:[0,0] neg_lo:[0,0] neg_hi:[0,0]
v_pk_fma_f32 v[62:63], v[76:77], s[54:55], v[62:63] op_sel:[1,0,0] op_sel_hi:[1,1,1] neg_lo:[0,1,0] neg_hi:[0,0,0]
v_pk_add_f32 v[76:77], v[72:73], v[22:23] op_sel:[1,1] op_sel_hi:[0,0] neg_lo:[1,0] neg_hi:[0,1]
v_pk_add_f32 v[72:73], v[72:73], v[22:23]
v_pk_add_f32 v[22:23], v[44:45], v[54:55] neg_lo:[0,1] neg_hi:[0,1]
v_pk_add_f32 v[44:45], v[44:45], v[54:55]
v_pk_mul_f32 v[54:55], v[22:23], s[54:55] op_sel:[0,1] op_sel_hi:[0,0] neg_lo:[0,1] neg_hi:[0,0]
v_pk_fma_f32 v[54:55], v[22:23], s[54:55], v[54:55] op_sel:[1,0,0] op_sel_hi:[1,1,1] neg_lo:[0,1,0] neg_hi:[0,1,0]
v_pk_add_f32 v[22:23], v[28:29], v[38:39] neg_lo:[0,1] neg_hi:[0,1]
v_pk_add_f32 v[28:29], v[28:29], v[38:39]
v_pk_mul_f32 v[38:39], v[22:23], s[62:63] op_sel:[0,0] op_sel_hi:[0,1] neg_lo:[0,1] neg_hi:[0,0]
v_pk_fma_f32 v[38:39], v[22:23], s[62:63], v[38:39] op_sel:[1,1,0] op_sel_hi:[1,0,1] neg_lo:[0,1,0] neg_hi:[0,1,0]
v_pk_add_f32 v[22:23], v[60:61], v[70:71] neg_lo:[0,1] neg_hi:[0,1]
v_pk_add_f32 v[60:61], v[60:61], v[70:71]
v_pk_mul_f32 v[70:71], v[22:23], s[54:55] op_sel:[0,0] op_sel_hi:[0,1] neg_lo:[0,1] neg_hi:[0,0]
v_pk_fma_f32 v[70:71], v[22:23], s[54:55], v[70:71] op_sel:[1,1,0] op_sel_hi:[1,0,1] neg_lo:[0,1,0] neg_hi:[0,1,0]
v_pk_add_f32 v[22:23], v[48:49], v[78:79] neg_lo:[0,1] neg_hi:[0,1]
v_pk_add_f32 v[48:49], v[48:49], v[78:79]
v_pk_add_f32 v[78:79], v[32:33], v[50:51] neg_lo:[0,1] neg_hi:[0,1]
v_pk_add_f32 v[32:33], v[32:33], v[50:51]
v_pk_mul_f32 v[50:51], v[78:79], s[54:55] op_sel:[0,0] op_sel_hi:[0,1] neg_lo:[0,0] neg_hi:[0,0]
v_pk_fma_f32 v[50:51], v[78:79], s[54:55], v[50:51] op_sel:[1,1,0] op_sel_hi:[1,0,1] neg_lo:[0,1,0] neg_hi:[0,0,0]
v_pk_add_f32 v[78:79], v[24:25], v[34:35] neg_lo:[0,1] neg_hi:[0,1]
v_pk_add_f32 v[24:25], v[24:25], v[34:35]
v_pk_mul_f32 v[34:35], v[78:79], s[62:63] op_sel:[0,0] op_sel_hi:[0,1] neg_lo:[0,0] neg_hi:[0,0]
v_pk_fma_f32 v[34:35], v[78:79], s[62:63], v[34:35] op_sel:[1,1,0] op_sel_hi:[1,0,1] neg_lo:[0,1,0] neg_hi:[0,0,0]
v_pk_add_f32 v[78:79], v[56:57], v[66:67] neg_lo:[0,1] neg_hi:[0,1]
v_pk_add_f32 v[56:57], v[56:57], v[66:67]
v_pk_mul_f32 v[66:67], v[78:79], s[54:55] op_sel:[0,1] op_sel_hi:[0,0] neg_lo:[0,0] neg_hi:[0,0]
v_pk_fma_f32 v[66:67], v[78:79], s[54:55], v[66:67] op_sel:[1,0,0] op_sel_hi:[1,1,1] neg_lo:[0,1,0] neg_hi:[0,0,0]
v_pk_add_f32 v[78:79], v[20:21], v[26:27] op_sel:[1,1] op_sel_hi:[0,0] neg_lo:[1,0] neg_hi:[0,1]
v_pk_add_f32 v[20:21], v[20:21], v[26:27]
v_pk_add_f32 v[26:27], v[52:53], v[58:59] neg_lo:[0,1] neg_hi:[0,1]
v_pk_add_f32 v[52:53], v[52:53], v[58:59]
v_pk_mul_f32 v[58:59], v[26:27], s[54:55] op_sel:[0,1] op_sel_hi:[0,0] neg_lo:[0,1] neg_hi:[0,0]
v_pk_fma_f32 v[58:59], v[26:27], s[54:55], v[58:59] op_sel:[1,0,0] op_sel_hi:[1,1,1] neg_lo:[0,1,0] neg_hi:[0,1,0]
v_pk_add_f32 v[26:27], v[36:37], v[42:43] neg_lo:[0,1] neg_hi:[0,1]
v_pk_add_f32 v[36:37], v[36:37], v[42:43]
v_pk_mul_f32 v[42:43], v[26:27], s[62:63] op_sel:[0,0] op_sel_hi:[0,1] neg_lo:[0,1] neg_hi:[0,0]
v_pk_fma_f32 v[42:43], v[26:27], s[62:63], v[42:43] op_sel:[1,1,0] op_sel_hi:[1,0,1] neg_lo:[0,1,0] neg_hi:[0,1,0]
v_pk_add_f32 v[26:27], v[68:69], v[74:75] neg_lo:[0,1] neg_hi:[0,1]
v_pk_add_f32 v[68:69], v[68:69], v[74:75]
v_pk_mul_f32 v[74:75], v[26:27], s[54:55] op_sel:[0,0] op_sel_hi:[0,1] neg_lo:[0,1] neg_hi:[0,0]
v_pk_fma_f32 v[74:75], v[26:27], s[54:55], v[74:75] op_sel:[1,1,0] op_sel_hi:[1,0,1] neg_lo:[0,1,0] neg_hi:[0,1,0]
v_pk_add_f32 v[26:27], v[16:17], v[72:73] neg_lo:[0,1] neg_hi:[0,1]
v_pk_add_f32 v[16:17], v[16:17], v[72:73]
v_pk_add_f32 v[72:73], v[14:15], v[44:45] neg_lo:[0,1] neg_hi:[0,1]
v_pk_add_f32 v[14:15], v[14:15], v[44:45]
v_pk_mul_f32 v[44:45], v[72:73], s[62:63] op_sel:[0,0] op_sel_hi:[0,1] neg_lo:[0,0] neg_hi:[0,0]
v_pk_fma_f32 v[44:45], v[72:73], s[62:63], v[44:45] op_sel:[1,1,0] op_sel_hi:[1,0,1] neg_lo:[0,1,0] neg_hi:[0,0,0]
v_pk_add_f32 v[72:73], v[64:65], v[28:29] op_sel:[1,1] op_sel_hi:[0,0] neg_lo:[1,0] neg_hi:[0,1]
v_pk_add_f32 v[64:65], v[64:65], v[28:29]
v_pk_add_f32 v[28:29], v[40:41], v[60:61] neg_lo:[0,1] neg_hi:[0,1]
v_pk_add_f32 v[40:41], v[40:41], v[60:61]
v_pk_mul_f32 v[60:61], v[28:29], s[62:63] op_sel:[0,0] op_sel_hi:[0,1] neg_lo:[0,1] neg_hi:[0,0]
v_pk_fma_f32 v[60:61], v[28:29], s[62:63], v[60:61] op_sel:[1,1,0] op_sel_hi:[1,0,1] neg_lo:[0,1,0] neg_hi:[0,1,0]
v_pk_add_f32 v[28:29], v[18:19], v[76:77] neg_lo:[0,1] neg_hi:[0,1]
v_pk_add_f32 v[18:19], v[18:19], v[76:77]
v_pk_add_f32 v[76:77], v[46:47], v[54:55] neg_lo:[0,1] neg_hi:[0,1]
v_pk_add_f32 v[46:47], v[46:47], v[54:55]
v_pk_mul_f32 v[54:55], v[76:77], s[62:63] op_sel:[0,0] op_sel_hi:[0,1] neg_lo:[0,0] neg_hi:[0,0]
v_pk_fma_f32 v[54:55], v[76:77], s[62:63], v[54:55] op_sel:[1,1,0] op_sel_hi:[1,0,1] neg_lo:[0,1,0] neg_hi:[0,0,0]
v_pk_add_f32 v[76:77], v[30:31], v[38:39] op_sel:[1,1] op_sel_hi:[0,0] neg_lo:[1,0] neg_hi:[0,1]
v_pk_add_f32 v[30:31], v[30:31], v[38:39]
v_pk_add_f32 v[38:39], v[62:63], v[70:71] neg_lo:[0,1] neg_hi:[0,1]
v_pk_add_f32 v[62:63], v[62:63], v[70:71]
v_pk_mul_f32 v[70:71], v[38:39], s[62:63] op_sel:[0,0] op_sel_hi:[0,1] neg_lo:[0,1] neg_hi:[0,0]
v_pk_fma_f32 v[70:71], v[38:39], s[62:63], v[70:71] op_sel:[1,1,0] op_sel_hi:[1,0,1] neg_lo:[0,1,0] neg_hi:[0,1,0]
v_pk_add_f32 v[38:39], v[48:49], v[20:21] neg_lo:[0,1] neg_hi:[0,1]
v_pk_add_f32 v[48:49], v[48:49], v[20:21]
v_pk_add_f32 v[20:21], v[32:33], v[52:53] neg_lo:[0,1] neg_hi:[0,1]
v_pk_add_f32 v[32:33], v[32:33], v[52:53]
v_pk_mul_f32 v[52:53], v[20:21], s[62:63] op_sel:[0,0] op_sel_hi:[0,1] neg_lo:[0,0] neg_hi:[0,0]
v_pk_fma_f32 v[52:53], v[20:21], s[62:63], v[52:53] op_sel:[1,1,0] op_sel_hi:[1,0,1] neg_lo:[0,1,0] neg_hi:[0,0,0]
v_pk_add_f32 v[20:21], v[24:25], v[36:37] op_sel:[1,1] op_sel_hi:[0,0] neg_lo:[1,0] neg_hi:[0,1]
v_pk_add_f32 v[24:25], v[24:25], v[36:37]
v_pk_add_f32 v[36:37], v[56:57], v[68:69] neg_lo:[0,1] neg_hi:[0,1]
v_pk_add_f32 v[56:57], v[56:57], v[68:69]
v_pk_mul_f32 v[68:69], v[36:37], s[62:63] op_sel:[0,0] op_sel_hi:[0,1] neg_lo:[0,1] neg_hi:[0,0]
v_pk_fma_f32 v[68:69], v[36:37], s[62:63], v[68:69] op_sel:[1,1,0] op_sel_hi:[1,0,1] neg_lo:[0,1,0] neg_hi:[0,1,0]
v_pk_add_f32 v[36:37], v[22:23], v[78:79] neg_lo:[0,1] neg_hi:[0,1]
v_pk_add_f32 v[22:23], v[22:23], v[78:79]
v_pk_add_f32 v[78:79], v[50:51], v[58:59] neg_lo:[0,1] neg_hi:[0,1]
v_pk_add_f32 v[50:51], v[50:51], v[58:59]
v_pk_mul_f32 v[58:59], v[78:79], s[62:63] op_sel:[0,0] op_sel_hi:[0,1] neg_lo:[0,0] neg_hi:[0,0]
v_pk_fma_f32 v[58:59], v[78:79], s[62:63], v[58:59] op_sel:[1,1,0] op_sel_hi:[1,0,1] neg_lo:[0,1,0] neg_hi:[0,0,0]
v_pk_add_f32 v[78:79], v[34:35], v[42:43] op_sel:[1,1] op_sel_hi:[0,0] neg_lo:[1,0] neg_hi:[0,1]
v_pk_add_f32 v[34:35], v[34:35], v[42:43]
v_pk_add_f32 v[42:43], v[66:67], v[74:75] neg_lo:[0,1] neg_hi:[0,1]
v_pk_add_f32 v[66:67], v[66:67], v[74:75]
v_pk_mul_f32 v[74:75], v[42:43], s[62:63] op_sel:[0,0] op_sel_hi:[0,1] neg_lo:[0,1] neg_hi:[0,0]
v_pk_fma_f32 v[74:75], v[42:43], s[62:63], v[74:75] op_sel:[1,1,0] op_sel_hi:[1,0,1] neg_lo:[0,1,0] neg_hi:[0,1,0]
v_pk_add_f32 v[42:43], v[16:17], v[64:65] neg_lo:[0,1] neg_hi:[0,1]
v_pk_add_f32 v[16:17], v[16:17], v[64:65]
v_pk_add_f32 v[64:65], v[14:15], v[40:41] op_sel:[1,1] op_sel_hi:[0,0] neg_lo:[1,0] neg_hi:[0,1]
v_pk_add_f32 v[14:15], v[14:15], v[40:41]
v_pk_add_f32 v[40:41], v[26:27], v[72:73] neg_lo:[0,1] neg_hi:[0,1]
v_pk_add_f32 v[26:27], v[26:27], v[72:73]
v_pk_add_f32 v[72:73], v[44:45], v[60:61] op_sel:[1,1] op_sel_hi:[0,0] neg_lo:[1,0] neg_hi:[0,1]
v_pk_add_f32 v[44:45], v[44:45], v[60:61]
v_pk_add_f32 v[60:61], v[18:19], v[30:31] neg_lo:[0,1] neg_hi:[0,1]
v_pk_add_f32 v[18:19], v[18:19], v[30:31]
v_pk_add_f32 v[30:31], v[46:47], v[62:63] op_sel:[1,1] op_sel_hi:[0,0] neg_lo:[1,0] neg_hi:[0,1]
v_pk_add_f32 v[46:47], v[46:47], v[62:63]
v_pk_add_f32 v[62:63], v[28:29], v[76:77] neg_lo:[0,1] neg_hi:[0,1]
v_pk_add_f32 v[28:29], v[28:29], v[76:77]
v_pk_add_f32 v[76:77], v[54:55], v[70:71] op_sel:[1,1] op_sel_hi:[0,0] neg_lo:[1,0] neg_hi:[0,1]
v_pk_add_f32 v[54:55], v[54:55], v[70:71]
v_pk_add_f32 v[70:71], v[48:49], v[24:25] neg_lo:[0,1] neg_hi:[0,1]
v_pk_add_f32 v[48:49], v[48:49], v[24:25]
v_pk_add_f32 v[24:25], v[32:33], v[56:57] op_sel:[1,1] op_sel_hi:[0,0] neg_lo:[1,0] neg_hi:[0,1]
v_pk_add_f32 v[32:33], v[32:33], v[56:57]
v_pk_add_f32 v[56:57], v[38:39], v[20:21] neg_lo:[0,1] neg_hi:[0,1]
v_pk_add_f32 v[38:39], v[38:39], v[20:21]
v_pk_add_f32 v[20:21], v[52:53], v[68:69] op_sel:[1,1] op_sel_hi:[0,0] neg_lo:[1,0] neg_hi:[0,1]
v_pk_add_f32 v[52:53], v[52:53], v[68:69]
v_pk_add_f32 v[68:69], v[22:23], v[34:35] neg_lo:[0,1] neg_hi:[0,1]
v_pk_add_f32 v[22:23], v[22:23], v[34:35]
v_pk_add_f32 v[34:35], v[50:51], v[66:67] op_sel:[1,1] op_sel_hi:[0,0] neg_lo:[1,0] neg_hi:[0,1]
v_pk_add_f32 v[50:51], v[50:51], v[66:67]
v_pk_add_f32 v[66:67], v[36:37], v[78:79] neg_lo:[0,1] neg_hi:[0,1]
v_pk_add_f32 v[36:37], v[36:37], v[78:79]
v_pk_add_f32 v[78:79], v[58:59], v[74:75] op_sel:[1,1] op_sel_hi:[0,0] neg_lo:[1,0] neg_hi:[0,1]
v_pk_add_f32 v[58:59], v[58:59], v[74:75]
v_pk_add_f32 v[74:75], v[16:17], v[14:15] neg_lo:[0,1] neg_hi:[0,1]
v_pk_add_f32 v[16:17], v[16:17], v[14:15]
v_pk_add_f32 v[14:15], v[42:43], v[64:65] neg_lo:[0,1] neg_hi:[0,1]
v_pk_add_f32 v[42:43], v[42:43], v[64:65]
v_pk_add_f32 v[64:65], v[26:27], v[44:45] neg_lo:[0,1] neg_hi:[0,1]
v_pk_add_f32 v[26:27], v[26:27], v[44:45]
v_pk_add_f32 v[44:45], v[40:41], v[72:73] neg_lo:[0,1] neg_hi:[0,1]
v_pk_add_f32 v[40:41], v[40:41], v[72:73]
v_pk_add_f32 v[72:73], v[18:19], v[46:47] neg_lo:[0,1] neg_hi:[0,1]
v_pk_add_f32 v[18:19], v[18:19], v[46:47]
v_pk_add_f32 v[46:47], v[60:61], v[30:31] neg_lo:[0,1] neg_hi:[0,1]
v_pk_add_f32 v[60:61], v[60:61], v[30:31]
v_pk_add_f32 v[30:31], v[28:29], v[54:55] neg_lo:[0,1] neg_hi:[0,1]
v_pk_add_f32 v[28:29], v[28:29], v[54:55]
v_pk_add_f32 v[54:55], v[62:63], v[76:77] neg_lo:[0,1] neg_hi:[0,1]
v_pk_add_f32 v[62:63], v[62:63], v[76:77]
v_pk_add_f32 v[76:77], v[48:49], v[32:33] neg_lo:[0,1] neg_hi:[0,1]
v_pk_add_f32 v[48:49], v[48:49], v[32:33]
v_pk_add_f32 v[32:33], v[70:71], v[24:25] neg_lo:[0,1] neg_hi:[0,1]
v_pk_add_f32 v[70:71], v[70:71], v[24:25]
v_pk_add_f32 v[24:25], v[38:39], v[52:53] neg_lo:[0,1] neg_hi:[0,1]
v_pk_add_f32 v[38:39], v[38:39], v[52:53]
v_pk_add_f32 v[52:53], v[56:57], v[20:21] neg_lo:[0,1] neg_hi:[0,1]
v_pk_add_f32 v[56:57], v[56:57], v[20:21]
v_pk_add_f32 v[20:21], v[22:23], v[50:51] neg_lo:[0,1] neg_hi:[0,1]
v_pk_add_f32 v[22:23], v[22:23], v[50:51]
v_pk_add_f32 v[50:51], v[68:69], v[34:35] neg_lo:[0,1] neg_hi:[0,1]
v_pk_add_f32 v[68:69], v[68:69], v[34:35]
v_pk_add_f32 v[34:35], v[36:37], v[58:59] neg_lo:[0,1] neg_hi:[0,1]
v_pk_add_f32 v[36:37], v[36:37], v[58:59]
v_pk_add_f32 v[58:59], v[66:67], v[78:79] neg_lo:[0,1] neg_hi:[0,1]
v_pk_add_f32 v[66:67], v[66:67], v[78:79]
v_pk_mul_f32 v[78:79], v[16:17], v[144:145] op_sel:[0,0] op_sel_hi:[0,1] neg_lo:[0,0] neg_hi:[0,0]
v_pk_fma_f32 v[16:17], v[16:17], v[144:145], v[78:79] op_sel:[1,1,0] op_sel_hi:[1,0,1] neg_lo:[0,1,0] neg_hi:[0,0,0]
v_pk_mul_f32 v[78:79], v[48:49], v[146:147] op_sel:[0,0] op_sel_hi:[0,1] neg_lo:[0,0] neg_hi:[0,0]
v_pk_fma_f32 v[48:49], v[48:49], v[146:147], v[78:79] op_sel:[1,1,0] op_sel_hi:[1,0,1] neg_lo:[0,1,0] neg_hi:[0,0,0]
v_pk_mul_f32 v[78:79], v[18:19], v[148:149] op_sel:[0,0] op_sel_hi:[0,1] neg_lo:[0,0] neg_hi:[0,0]
v_pk_fma_f32 v[18:19], v[18:19], v[148:149], v[78:79] op_sel:[1,1,0] op_sel_hi:[1,0,1] neg_lo:[0,1,0] neg_hi:[0,0,0]
v_pk_mul_f32 v[78:79], v[22:23], v[150:151] op_sel:[0,0] op_sel_hi:[0,1] neg_lo:[0,0] neg_hi:[0,0]
v_pk_fma_f32 v[22:23], v[22:23], v[150:151], v[78:79] op_sel:[1,1,0] op_sel_hi:[1,0,1] neg_lo:[0,1,0] neg_hi:[0,0,0]
v_pk_mul_f32 v[78:79], v[26:27], v[152:153] op_sel:[0,0] op_sel_hi:[0,1] neg_lo:[0,0] neg_hi:[0,0]
v_pk_fma_f32 v[26:27], v[26:27], v[152:153], v[78:79] op_sel:[1,1,0] op_sel_hi:[1,0,1] neg_lo:[0,1,0] neg_hi:[0,0,0]
v_pk_mul_f32 v[78:79], v[38:39], v[154:155] op_sel:[0,0] op_sel_hi:[0,1] neg_lo:[0,0] neg_hi:[0,0]
v_pk_fma_f32 v[38:39], v[38:39], v[154:155], v[78:79] op_sel:[1,1,0] op_sel_hi:[1,0,1] neg_lo:[0,1,0] neg_hi:[0,0,0]
v_pk_mul_f32 v[78:79], v[28:29], v[156:157] op_sel:[0,0] op_sel_hi:[0,1] neg_lo:[0,0] neg_hi:[0,0]
v_pk_fma_f32 v[28:29], v[28:29], v[156:157], v[78:79] op_sel:[1,1,0] op_sel_hi:[1,0,1] neg_lo:[0,1,0] neg_hi:[0,0,0]
v_pk_mul_f32 v[78:79], v[36:37], v[158:159] op_sel:[0,0] op_sel_hi:[0,1] neg_lo:[0,0] neg_hi:[0,0]
v_pk_fma_f32 v[36:37], v[36:37], v[158:159], v[78:79] op_sel:[1,1,0] op_sel_hi:[1,0,1] neg_lo:[0,1,0] neg_hi:[0,0,0]
v_pk_mul_f32 v[78:79], v[42:43], v[160:161] op_sel:[0,0] op_sel_hi:[0,1] neg_lo:[0,0] neg_hi:[0,0]
v_pk_fma_f32 v[42:43], v[42:43], v[160:161], v[78:79] op_sel:[1,1,0] op_sel_hi:[1,0,1] neg_lo:[0,1,0] neg_hi:[0,0,0]
v_pk_mul_f32 v[78:79], v[70:71], v[162:163] op_sel:[0,0] op_sel_hi:[0,1] neg_lo:[0,0] neg_hi:[0,0]
v_pk_fma_f32 v[70:71], v[70:71], v[162:163], v[78:79] op_sel:[1,1,0] op_sel_hi:[1,0,1] neg_lo:[0,1,0] neg_hi:[0,0,0]
v_pk_mul_f32 v[78:79], v[60:61], v[164:165] op_sel:[0,0] op_sel_hi:[0,1] neg_lo:[0,0] neg_hi:[0,0]
v_pk_fma_f32 v[60:61], v[60:61], v[164:165], v[78:79] op_sel:[1,1,0] op_sel_hi:[1,0,1] neg_lo:[0,1,0] neg_hi:[0,0,0]
v_pk_mul_f32 v[78:79], v[68:69], v[166:167] op_sel:[0,0] op_sel_hi:[0,1] neg_lo:[0,0] neg_hi:[0,0]
v_pk_fma_f32 v[68:69], v[68:69], v[166:167], v[78:79] op_sel:[1,1,0] op_sel_hi:[1,0,1] neg_lo:[0,1,0] neg_hi:[0,0,0]
v_pk_mul_f32 v[78:79], v[40:41], v[168:169] op_sel:[0,0] op_sel_hi:[0,1] neg_lo:[0,0] neg_hi:[0,0]
v_pk_fma_f32 v[40:41], v[40:41], v[168:169], v[78:79] op_sel:[1,1,0] op_sel_hi:[1,0,1] neg_lo:[0,1,0] neg_hi:[0,0,0]
v_pk_mul_f32 v[78:79], v[56:57], v[170:171] op_sel:[0,0] op_sel_hi:[0,1] neg_lo:[0,0] neg_hi:[0,0]
v_pk_fma_f32 v[56:57], v[56:57], v[170:171], v[78:79] op_sel:[1,1,0] op_sel_hi:[1,0,1] neg_lo:[0,1,0] neg_hi:[0,0,0]
v_pk_mul_f32 v[78:79], v[62:63], v[172:173] op_sel:[0,0] op_sel_hi:[0,1] neg_lo:[0,0] neg_hi:[0,0]
v_pk_fma_f32 v[62:63], v[62:63], v[172:173], v[78:79] op_sel:[1,1,0] op_sel_hi:[1,0,1] neg_lo:[0,1,0] neg_hi:[0,0,0]
v_pk_mul_f32 v[78:79], v[66:67], v[174:175] op_sel:[0,0] op_sel_hi:[0,1] neg_lo:[0,0] neg_hi:[0,0]
v_pk_fma_f32 v[66:67], v[66:67], v[174:175], v[78:79] op_sel:[1,1,0] op_sel_hi:[1,0,1] neg_lo:[0,1,0] neg_hi:[0,0,0]
v_pk_mul_f32 v[78:79], v[74:75], v[176:177] op_sel:[0,0] op_sel_hi:[0,1] neg_lo:[0,0] neg_hi:[0,0]
v_pk_fma_f32 v[74:75], v[74:75], v[176:177], v[78:79] op_sel:[1,1,0] op_sel_hi:[1,0,1] neg_lo:[0,1,0] neg_hi:[0,0,0]
v_pk_mul_f32 v[78:79], v[76:77], v[178:179] op_sel:[0,0] op_sel_hi:[0,1] neg_lo:[0,0] neg_hi:[0,0]
v_pk_fma_f32 v[76:77], v[76:77], v[178:179], v[78:79] op_sel:[1,1,0] op_sel_hi:[1,0,1] neg_lo:[0,1,0] neg_hi:[0,0,0]
v_pk_mul_f32 v[78:79], v[72:73], v[180:181] op_sel:[0,0] op_sel_hi:[0,1] neg_lo:[0,0] neg_hi:[0,0]
v_pk_fma_f32 v[72:73], v[72:73], v[180:181], v[78:79] op_sel:[1,1,0] op_sel_hi:[1,0,1] neg_lo:[0,1,0] neg_hi:[0,0,0]
v_pk_mul_f32 v[78:79], v[20:21], v[182:183] op_sel:[0,0] op_sel_hi:[0,1] neg_lo:[0,0] neg_hi:[0,0]
v_pk_fma_f32 v[20:21], v[20:21], v[182:183], v[78:79] op_sel:[1,1,0] op_sel_hi:[1,0,1] neg_lo:[0,1,0] neg_hi:[0,0,0]
v_pk_mul_f32 v[78:79], v[64:65], v[184:185] op_sel:[0,0] op_sel_hi:[0,1] neg_lo:[0,0] neg_hi:[0,0]
v_pk_fma_f32 v[64:65], v[64:65], v[184:185], v[78:79] op_sel:[1,1,0] op_sel_hi:[1,0,1] neg_lo:[0,1,0] neg_hi:[0,0,0]
v_pk_mul_f32 v[78:79], v[24:25], v[186:187] op_sel:[0,0] op_sel_hi:[0,1] neg_lo:[0,0] neg_hi:[0,0]
v_pk_fma_f32 v[24:25], v[24:25], v[186:187], v[78:79] op_sel:[1,1,0] op_sel_hi:[1,0,1] neg_lo:[0,1,0] neg_hi:[0,0,0]
v_pk_mul_f32 v[78:79], v[30:31], v[188:189] op_sel:[0,0] op_sel_hi:[0,1] neg_lo:[0,0] neg_hi:[0,0]
v_pk_fma_f32 v[30:31], v[30:31], v[188:189], v[78:79] op_sel:[1,1,0] op_sel_hi:[1,0,1] neg_lo:[0,1,0] neg_hi:[0,0,0]
v_pk_mul_f32 v[78:79], v[34:35], v[190:191] op_sel:[0,0] op_sel_hi:[0,1] neg_lo:[0,0] neg_hi:[0,0]
v_pk_fma_f32 v[34:35], v[34:35], v[190:191], v[78:79] op_sel:[1,1,0] op_sel_hi:[1,0,1] neg_lo:[0,1,0] neg_hi:[0,0,0]
v_pk_mul_f32 v[78:79], v[14:15], v[192:193] op_sel:[0,0] op_sel_hi:[0,1] neg_lo:[0,0] neg_hi:[0,0]
v_pk_fma_f32 v[14:15], v[14:15], v[192:193], v[78:79] op_sel:[1,1,0] op_sel_hi:[1,0,1] neg_lo:[0,1,0] neg_hi:[0,0,0]
v_pk_mul_f32 v[78:79], v[32:33], v[194:195] op_sel:[0,0] op_sel_hi:[0,1] neg_lo:[0,0] neg_hi:[0,0]
v_pk_fma_f32 v[32:33], v[32:33], v[194:195], v[78:79] op_sel:[1,1,0] op_sel_hi:[1,0,1] neg_lo:[0,1,0] neg_hi:[0,0,0]
v_pk_mul_f32 v[78:79], v[46:47], v[196:197] op_sel:[0,0] op_sel_hi:[0,1] neg_lo:[0,0] neg_hi:[0,0]
v_pk_fma_f32 v[46:47], v[46:47], v[196:197], v[78:79] op_sel:[1,1,0] op_sel_hi:[1,0,1] neg_lo:[0,1,0] neg_hi:[0,0,0]
v_pk_mul_f32 v[78:79], v[50:51], v[198:199] op_sel:[0,0] op_sel_hi:[0,1] neg_lo:[0,0] neg_hi:[0,0]
v_pk_fma_f32 v[50:51], v[50:51], v[198:199], v[78:79] op_sel:[1,1,0] op_sel_hi:[1,0,1] neg_lo:[0,1,0] neg_hi:[0,0,0]
v_pk_mul_f32 v[78:79], v[44:45], v[200:201] op_sel:[0,0] op_sel_hi:[0,1] neg_lo:[0,0] neg_hi:[0,0]
v_pk_fma_f32 v[44:45], v[44:45], v[200:201], v[78:79] op_sel:[1,1,0] op_sel_hi:[1,0,1] neg_lo:[0,1,0] neg_hi:[0,0,0]
v_pk_mul_f32 v[78:79], v[52:53], v[202:203] op_sel:[0,0] op_sel_hi:[0,1] neg_lo:[0,0] neg_hi:[0,0]
v_pk_fma_f32 v[52:53], v[52:53], v[202:203], v[78:79] op_sel:[1,1,0] op_sel_hi:[1,0,1] neg_lo:[0,1,0] neg_hi:[0,0,0]
v_pk_mul_f32 v[78:79], v[54:55], v[204:205] op_sel:[0,0] op_sel_hi:[0,1] neg_lo:[0,0] neg_hi:[0,0]
v_pk_fma_f32 v[54:55], v[54:55], v[204:205], v[78:79] op_sel:[1,1,0] op_sel_hi:[1,0,1] neg_lo:[0,1,0] neg_hi:[0,0,0]
v_pk_mul_f32 v[78:79], v[58:59], v[206:207] op_sel:[0,0] op_sel_hi:[0,1] neg_lo:[0,0] neg_hi:[0,0]
v_pk_fma_f32 v[58:59], v[58:59], v[206:207], v[78:79] op_sel:[1,1,0] op_sel_hi:[1,0,1] neg_lo:[0,1,0] neg_hi:[0,0,0]
ds_write_b64 v4, v[16:17] offset:0
ds_write_b64 v4, v[48:49] offset:16
ds_write_b64 v4, v[18:19] offset:32
ds_write_b64 v4, v[22:23] offset:48
ds_write_b64 v4, v[26:27] offset:64
ds_write_b64 v4, v[38:39] offset:80
ds_write_b64 v4, v[28:29] offset:96
ds_write_b64 v4, v[36:37] offset:112
ds_write_b64 v4, v[42:43] offset:128
ds_write_b64 v4, v[70:71] offset:144
ds_write_b64 v4, v[60:61] offset:160
ds_write_b64 v4, v[68:69] offset:176
ds_write_b64 v4, v[40:41] offset:192
ds_write_b64 v4, v[56:57] offset:208
ds_write_b64 v4, v[62:63] offset:224
ds_write_b64 v4, v[66:67] offset:240
ds_write_b64 v4, v[74:75] offset:256
ds_write_b64 v4, v[76:77] offset:272
ds_write_b64 v4, v[72:73] offset:288
ds_write_b64 v4, v[20:21] offset:304
ds_write_b64 v4, v[64:65] offset:320
ds_write_b64 v4, v[24:25] offset:336
ds_write_b64 v4, v[30:31] offset:352
ds_write_b64 v4, v[34:35] offset:368
ds_write_b64 v4, v[14:15] offset:384
ds_write_b64 v4, v[32:33] offset:400
ds_write_b64 v4, v[46:47] offset:416
ds_write_b64 v4, v[50:51] offset:432
ds_write_b64 v4, v[44:45] offset:448
ds_write_b64 v4, v[52:53] offset:464
ds_write_b64 v4, v[54:55] offset:480
ds_write_b64 v4, v[58:59] offset:496
s_waitcnt lgkmcnt(0)
ds_read_b64 v[16:17], v3 offset:0
ds_read_b64 v[48:49], v3 offset:8448
ds_read_b64 v[18:19], v3 offset:528
ds_read_b64 v[50:51], v3 offset:8976
ds_read_b64 v[20:21], v3 offset:1056
ds_read_b64 v[52:53], v3 offset:9504
ds_read_b64 v[22:23], v3 offset:1584
ds_read_b64 v[54:55], v3 offset:10032
ds_read_b64 v[24:25], v3 offset:2112
ds_read_b64 v[56:57], v3 offset:10560
ds_read_b64 v[26:27], v3 offset:2640
ds_read_b64 v[58:59], v3 offset:11088
ds_read_b64 v[28:29], v3 offset:3168
ds_read_b64 v[60:61], v3 offset:11616
ds_read_b64 v[30:31], v3 offset:3696
ds_read_b64 v[62:63], v3 offset:12144
ds_read_b64 v[32:33], v3 offset:4224
ds_read_b64 v[64:65], v3 offset:12672
ds_read_b64 v[34:35], v3 offset:4752
ds_read_b64 v[66:67], v3 offset:13200
ds_read_b64 v[36:37], v3 offset:5280
ds_read_b64 v[68:69], v3 offset:13728
ds_read_b64 v[38:39], v3 offset:5808
ds_read_b64 v[70:71], v3 offset:14256
ds_read_b64 v[40:41], v3 offset:6336
ds_read_b64 v[72:73], v3 offset:14784
ds_read_b64 v[42:43], v3 offset:6864
ds_read_b64 v[74:75], v3 offset:15312
ds_read_b64 v[44:45], v3 offset:7392
ds_read_b64 v[76:77], v3 offset:15840
ds_read_b64 v[46:47], v3 offset:7920
ds_read_b64 v[78:79], v3 offset:16368
s_waitcnt lgkmcnt(0)
v_pk_add_f32 v[14:15], v[16:17], v[48:49] neg_lo:[0,1] neg_hi:[0,1]
v_pk_add_f32 v[16:17], v[16:17], v[48:49]
v_pk_add_f32 v[48:49], v[18:19], v[50:51] neg_lo:[0,1] neg_hi:[0,1]
v_pk_add_f32 v[18:19], v[18:19], v[50:51]
v_pk_mul_f32 v[50:51], v[48:49], s[50:51] op_sel:[0,0] op_sel_hi:[0,1] neg_lo:[0,0] neg_hi:[0,0]
v_pk_fma_f32 v[50:51], v[48:49], s[50:51], v[50:51] op_sel:[1,1,0] op_sel_hi:[1,0,1] neg_lo:[0,1,0] neg_hi:[0,0,0]
v_pk_add_f32 v[48:49], v[20:21], v[52:53] neg_lo:[0,1] neg_hi:[0,1]
v_pk_add_f32 v[20:21], v[20:21], v[52:53]
v_pk_mul_f32 v[52:53], v[48:49], s[54:55] op_sel:[0,0] op_sel_hi:[0,1] neg_lo:[0,0] neg_hi:[0,0]
v_pk_fma_f32 v[52:53], v[48:49], s[54:55], v[52:53] op_sel:[1,1,0] op_sel_hi:[1,0,1] neg_lo:[0,1,0] neg_hi:[0,0,0]
v_pk_add_f32 v[48:49], v[22:23], v[54:55] neg_lo:[0,1] neg_hi:[0,1]
v_pk_add_f32 v[22:23], v[22:23], v[54:55]
v_pk_mul_f32 v[54:55], v[48:49], s[58:59] op_sel:[0,0] op_sel_hi:[0,1] neg_lo:[0,0] neg_hi:[0,0]
v_pk_fma_f32 v[54:55], v[48:49], s[58:59], v[54:55] op_sel:[1,1,0] op_sel_hi:[1,0,1] neg_lo:[0,1,0] neg_hi:[0,0,0]
v_pk_add_f32 v[48:49], v[24:25], v[56:57] neg_lo:[0,1] neg_hi:[0,1]
v_pk_add_f32 v[24:25], v[24:25], v[56:57]
v_pk_mul_f32 v[56:57], v[48:49], s[62:63] op_sel:[0,0] op_sel_hi:[0,1] neg_lo:[0,0] neg_hi:[0,0]
v_pk_fma_f32 v[56:57], v[48:49], s[62:63], v[56:57] op_sel:[1,1,0] op_sel_hi:[1,0,1] neg_lo:[0,1,0] neg_hi:[0,0,0]
v_pk_add_f32 v[48:49], v[26:27], v[58:59] neg_lo:[0,1] neg_hi:[0,1]
v_pk_add_f32 v[26:27], v[26:27], v[58:59]
v_pk_mul_f32 v[58:59], v[48:49], s[58:59] op_sel:[0,1] op_sel_hi:[0,0] neg_lo:[0,0] neg_hi:[0,0]
v_pk_fma_f32 v[58:59], v[48:49], s[58:59], v[58:59] op_sel:[1,0,0] op_sel_hi:[1,1,1] neg_lo:[0,1,0] neg_hi:[0,0,0]
v_pk_add_f32 v[48:49], v[28:29], v[60:61] neg_lo:[0,1] neg_hi:[0,1]
v_pk_add_f32 v[28:29], v[28:29], v[60:61]
v_pk_mul_f32 v[60:61], v[48:49], s[54:55] op_sel:[0,1] op_sel_hi:[0,0] neg_lo:[0,0] neg_hi:[0,0]
v_pk_fma_f32 v[60:61], v[48:49], s[54:55], v[60:61] op_sel:[1,0,0] op_sel_hi:[1,1,1] neg_lo:[0,1,0] neg_hi:[0,0,0]
v_pk_add_f32 v[48:49], v[30:31], v[62:63] neg_lo:[0,1] neg_hi:[0,1]
v_pk_add_f32 v[30:31], v[30:31], v[62:63]
v_pk_mul_f32 v[62:63], v[48:49], s[50:51] op_sel:[0,1] op_sel_hi:[0,0] neg_lo:[0,0] neg_hi:[0,0]
v_pk_fma_f32 v[62:63], v[48:49], s[50:51], v[62:63] op_sel:[1,0,0] op_sel_hi:[1,1,1] neg_lo:[0,1,0] neg_hi:[0,0,0]
v_pk_add_f32 v[48:49], v[32:33], v[64:65] op_sel:[1,1] op_sel_hi:[0,0] neg_lo:[1,0] neg_hi:[0,1]
v_pk_add_f32 v[32:33], v[32:33], v[64:65]
v_pk_add_f32 v[64:65], v[34:35], v[66:67] neg_lo:[0,1] neg_hi:[0,1]
v_pk_add_f32 v[34:35], v[34:35], v[66:67]
v_pk_mul_f32 v[66:67], v[64:65], s[50:51] op_sel:[0,1] op_sel_hi:[0,0] neg_lo:[0,1] neg_hi:[0,0]
v_pk_fma_f32 v[66:67], v[64:65], s[50:51], v[66:67] op_sel:[1,0,0] op_sel_hi:[1,1,1] neg_lo:[0,1,0] neg_hi:[0,1,0]
v_pk_add_f32 v[64:65], v[36:37], v[68:69] neg_lo:[0,1] neg_hi:[0,1]
v_pk_add_f32 v[36:37], v[36:37], v[68:69]
v_pk_mul_f32 v[68:69], v[64:65], s[54:55] op_sel:[0,1] op_sel_hi:[0,0] neg_lo:[0,1] neg_hi:[0,0]
v_pk_fma_f32 v[68:69], v[64:65], s[54:55], v[68:69] op_sel:[1,0,0] op_sel_hi:[1,1,1] neg_lo:[0,1,0] neg_hi:[0,1,0]
v_pk_add_f32 v[64:65], v[38:39], v[70:71] neg_lo:[0,1] neg_hi:[0,1]
v_pk_add_f32 v[38:39], v[38:39], v[70:71]
v_pk_mul_f32 v[70:71], v[64:65], s[58:59] op_sel:[0,1] op_sel_hi:[0,0] neg_lo:[0,1] neg_hi:[0,0]
v_pk_fma_f32 v[70:71], v[64:65], s[58:59], v[70:71] op_sel:[1,0,0] op_sel_hi:[1,1,1] neg_lo:[0,1,0] neg_hi:[0,1,0]
v_pk_add_f32 v[64:65], v[40:41], v[72:73] neg_lo:[0,1] neg_hi:[0,1]
v_pk_add_f32 v[40:41], v[40:41], v[72:73]
v_pk_mul_f32 v[72:73], v[64:65], s[62:63] op_sel:[0,0] op_sel_hi:[0,1] neg_lo:[0,1] neg_hi:[0,0]
v_pk_fma_f32 v[72:73], v[64:65], s[62:63], v[72:73] op_sel:[1,1,0] op_sel_hi:[1,0,1] neg_lo:[0,1,0] neg_hi:[0,1,0]
v_pk_add_f32 v[64:65], v[42:43], v[74:75] neg_lo:[0,1] neg_hi:[0,1]
v_pk_add_f32 v[42:43], v[42:43], v[74:75]
v_pk_mul_f32 v[74:75], v[64:65], s[58:59] op_sel:[0,0] op_sel_hi:[0,1] neg_lo:[0,1] neg_hi:[0,0]
v_pk_fma_f32 v[74:75], v[64:65], s[58:59], v[74:75] op_sel:[1,1,0] op_sel_hi:[1,0,1] neg_lo:[0,1,0] neg_hi:[0,1,0]
v_pk_add_f32 v[64:65], v[44:45], v[76:77] neg_lo:[0,1] neg_hi:[0,1]
v_pk_add_f32 v[44:45], v[44:45], v[76:77]
v_pk_mul_f32 v[76:77], v[64:65], s[54:55] op_sel:[0,0] op_sel_hi:[0,1] neg_lo:[0,1] neg_hi:[0,0]
v_pk_fma_f32 v[76:77], v[64:65], s[54:55], v[76:77] op_sel:[1,1,0] op_sel_hi:[1,0,1] neg_lo:[0,1,0] neg_hi:[0,1,0]
v_pk_add_f32 v[64:65], v[46:47], v[78:79] neg_lo:[0,1] neg_hi:[0,1]
v_pk_add_f32 v[46:47], v[46:47], v[78:79]
v_pk_mul_f32 v[78:79], v[64:65], s[50:51] op_sel:[0,0] op_sel_hi:[0,1] neg_lo:[0,1] neg_hi:[0,0]
v_pk_fma_f32 v[78:79], v[64:65], s[50:51], v[78:79] op_sel:[1,1,0] op_sel_hi:[1,0,1] neg_lo:[0,1,0] neg_hi:[0,1,0]
v_pk_add_f32 v[64:65], v[16:17], v[32:33] neg_lo:[0,1] neg_hi:[0,1]
v_pk_add_f32 v[16:17], v[16:17], v[32:33]
v_pk_add_f32 v[32:33], v[18:19], v[34:35] neg_lo:[0,1] neg_hi:[0,1]
v_pk_add_f32 v[18:19], v[18:19], v[34:35]
v_pk_mul_f32 v[34:35], v[32:33], s[54:55] op_sel:[0,0] op_sel_hi:[0,1] neg_lo:[0,0] neg_hi:[0,0]
v_pk_fma_f32 v[34:35], v[32:33], s[54:55], v[34:35] op_sel:[1,1,0] op_sel_hi:[1,0,1] neg_lo:[0,1,0] neg_hi:[0,0,0]
v_pk_add_f32 v[32:33], v[20:21], v[36:37] neg_lo:[0,1] neg_hi:[0,1]
v_pk_add_f32 v[20:21], v[20:21], v[36:37]
v_pk_mul_f32 v[36:37], v[32:33], s[62:63] op_sel:[0,0] op_sel_hi:[0,1] neg_lo:[0,0] neg_hi:[0,0]
v_pk_fma_f32 v[36:37], v[32:33], s[62:63], v[36:37] op_sel:[1,1,0] op_sel_hi:[1,0,1] neg_lo:[0,1,0] neg_hi:[0,0,0]
v_pk_add_f32 v[32:33], v[22:23], v[38:39] neg_lo:[0,1] neg_hi:[0,1]
v_pk_add_f32 v[22:23], v[22:23], v[38:39]
v_pk_mul_f32 v[38:39], v[32:33], s[54:55] op_sel:[0,1] op_sel_hi:[0,0] neg_lo:[0,0] neg_hi:[0,0]
v_pk_fma_f32 v[38:39], v[32:33], s[54:55], v[38:39] op_sel:[1,0,0] op_sel_hi:[1,1,1] neg_lo:[0,1,0] neg_hi:[0,0,0]
v_pk_add_f32 v[32:33], v[24:25], v[40:41] op_sel:[1,1] op_sel_hi:[0,0] neg_lo:[1,0] neg_hi:[0,1]
v_pk_add_f32 v[24:25], v[24:25], v[40:41]
v_pk_add_f32 v[40:41], v[26:27], v[42:43] neg_lo:[0,1] neg_hi:[0,1]
v_pk_add_f32 v[26:27], v[26:27], v[42:43]
v_pk_mul_f32 v[42:43], v[40:41], s[54:55] op_sel:[0,1] op_sel_hi:[0,0] neg_lo:[0,1] neg_hi:[0,0]
v_pk_fma_f32 v[42:43], v[40:41], s[54:55], v[42:43] op_sel:[1,0,0] op_sel_hi:[1,1,1] neg_lo:[0,1,0] neg_hi:[0,1,0]
v_pk_add_f32 v[40:41], v[28:29], v[44:45] neg_lo:[0,1] neg_hi:[0,1]
v_pk_add_f32 v[28:29], v[28:29], v[44:45]
v_pk_mul_f32 v[44:45], v[40:41], s[62:63] op_sel:[0,0] op_sel_hi:[0,1] neg_lo:[0,1] neg_hi:[0,0]
v_pk_fma_f32 v[44:45], v[40:41], s[62:63], v[44:45] op_sel:[1,1,0] op_sel_hi:[1,0,1] neg_lo:[0,1,0] neg_hi:[0,1,0]
v_pk_add_f32 v[40:41], v[30:31], v[46:47] neg_lo:[0,1] neg_hi:[0,1]
v_pk_add_f32 v[30:31], v[30:31], v[46:47]
v_pk_mul_f32 v[46:47], v[40:41], s[54:55] op_sel:[0,0] op_sel_hi:[0,1] neg_lo:[0,1] neg_hi:[0,0]
v_pk_fma_f32 v[46:47], v[40:41], s[54:55], v[46:47] op_sel:[1,1,0] op_sel_hi:[1,0,1] neg_lo:[0,1,0] neg_hi:[0,1,0]
v_pk_add_f32 v[40:41], v[14:15], v[48:49] neg_lo:[0,1] neg_hi:[0,1]
v_pk_add_f32 v[14:15], v[14:15], v[48:49]
v_pk_add_f32 v[48:49], v[50:51], v[66:67] neg_lo:[0,1] neg_hi:[0,1]
v_pk_add_f32 v[50:51], v[50:51], v[66:67]
v_pk_mul_f32 v[66:67], v[48:49], s[54:55] op_sel:[0,0] op_sel_hi:[0,1] neg_lo:[0,0] neg_hi:[0,0]
v_pk_fma_f32 v[66:67], v[48:49], s[54:55], v[66:67] op_sel:[1,1,0] op_sel_hi:[1,0,1] neg_lo:[0,1,0] neg_hi:[0,0,0]
v_pk_add_f32 v[48:49], v[52:53], v[68:69] neg_lo:[0,1] neg_hi:[0,1]
v_pk_add_f32 v[52:53], v[52:53], v[68:69]
v_pk_mul_f32 v[68:69], v[48:49], s[62:63] op_sel:[0,0] op_sel_hi:[0,1] neg_lo:[0,0] neg_hi:[0,0]
v_pk_fma_f32 v[68:69], v[48:49], s[62:63], v[68:69] op_sel:[1,1,0] op_sel_hi:[1,0,1] neg_lo:[0,1,0] neg_hi:[0,0,0]
v_pk_add_f32 v[48:49], v[54:55], v[70:71] neg_lo:[0,1] neg_hi:[0,1]
v_pk_add_f32 v[54:55], v[54:55], v[70:71]
v_pk_mul_f32 v[70:71], v[48:49], s[54:55] op_sel:[0,1] op_sel_hi:[0,0] neg_lo:[0,0] neg_hi:[0,0]
v_pk_fma_f32 v[70:71], v[48:49], s[54:55], v[70:71] op_sel:[1,0,0] op_sel_hi:[1,1,1] neg_lo:[0,1,0] neg_hi:[0,0,0]
v_pk_add_f32 v[48:49], v[56:57], v[72:73] op_sel:[1,1] op_sel_hi:[0,0] neg_lo:[1,0] neg_hi:[0,1]
v_pk_add_f32 v[56:57], v[56:57], v[72:73]
v_pk_add_f32 v[72:73], v[58:59], v[74:75] neg_lo:[0,1] neg_hi:[0,1]
v_pk_add_f32 v[58:59], v[58:59], v[74:75]
v_pk_mul_f32 v[74:75], v[72:73], s[54:55] op_sel:[0,1] op_sel_hi:[0,0] neg_lo:[0,1] neg_hi:[0,0]
v_pk_fma_f32 v[74:75], v[72:73], s[54:55], v[74:75] op_sel:[1,0,0] op_sel_hi:[1,1,1] neg_lo:[0,1,0] neg_hi:[0,1,0]
v_pk_add_f32 v[72:73], v[60:61], v[76:77] neg_lo:[0,1] neg_hi:[0,1]
v_pk_add_f32 v[60:61], v[60:61], v[76:77]
v_pk_mul_f32 v[76:77], v[72:73], s[62:63] op_sel:[0,0] op_sel_hi:[0,1] neg_lo:[0,1] neg_hi:[0,0]
v_pk_fma_f32 v[76:77], v[72:73], s[62:63], v[76:77] op_sel:[1,1,0] op_sel_hi:[1,0,1] neg_lo:[0,1,0] neg_hi:[0,1,0]
v_pk_add_f32 v[72:73], v[62:63], v[78:79] neg_lo:[0,1] neg_hi:[0,1]
v_pk_add_f32 v[62:63], v[62:63], v[78:79]
v_pk_mul_f32 v[78:79], v[72:73], s[54:55] op_sel:[0,0] op_sel_hi:[0,1] neg_lo:[0,1] neg_hi:[0,0]
v_pk_fma_f32 v[78:79], v[72:73], s[54:55], v[78:79] op_sel:[1,1,0] op_sel_hi:[1,0,1] neg_lo:[0,1,0] neg_hi:[0,1,0]
v_pk_add_f32 v[72:73], v[16:17], v[24:25] neg_lo:[0,1] neg_hi:[0,1]
v_pk_add_f32 v[16:17], v[16:17], v[24:25]
v_pk_add_f32 v[24:25], v[18:19], v[26:27] neg_lo:[0,1] neg_hi:[0,1]
v_pk_add_f32 v[18:19], v[18:19], v[26:27]
v_pk_mul_f32 v[26:27], v[24:25], s[62:63] op_sel:[0,0] op_sel_hi:[0,1] neg_lo:[0,0] neg_hi:[0,0]
v_pk_fma_f32 v[26:27], v[24:25], s[62:63], v[26:27] op_sel:[1,1,0] op_sel_hi:[1,0,1] neg_lo:[0,1,0] neg_hi:[0,0,0]
v_pk_add_f32 v[24:25], v[20:21], v[28:29] op_sel:[1,1] op_sel_hi:[0,0] neg_lo:[1,0] neg_hi:[0,1]
v_pk_add_f32 v[20:21], v[20:21], v[28:29]
v_pk_add_f32 v[28:29], v[22:23], v[30:31] neg_lo:[0,1] neg_hi:[0,1]
v_pk_add_f32 v[22:23], v[22:23], v[30:31]
v_pk_mul_f32 v[30:31], v[28:29], s[62:63] op_sel:[0,0] op_sel_hi:[0,1] neg_lo:[0,1] neg_hi:[0,0]
v_pk_fma_f32 v[30:31], v[28:29], s[62:63], v[30:31] op_sel:[1,1,0] op_sel_hi:[1,0,1] neg_lo:[0,1,0] neg_hi:[0,1,0]
v_pk_add_f32 v[28:29], v[64:65], v[32:33] neg_lo:[0,1] neg_hi:[0,1]
v_pk_add_f32 v[64:65], v[64:65], v[32:33]
v_pk_add_f32 v[32:33], v[34:35], v[42:43] neg_lo:[0,1] neg_hi:[0,1]
v_pk_add_f32 v[34:35], v[34:35], v[42:43]
v_pk_mul_f32 v[42:43], v[32:33], s[62:63] op_sel:[0,0] op_sel_hi:[0,1] neg_lo:[0,0] neg_hi:[0,0]
v_pk_fma_f32 v[42:43], v[32:33], s[62:63], v[42:43] op_sel:[1,1,0] op_sel_hi:[1,0,1] neg_lo:[0,1,0] neg_hi:[0,0,0]
v_pk_add_f32 v[32:33], v[36:37], v[44:45] op_sel:[1,1] op_sel_hi:[0,0] neg_lo:[1,0] neg_hi:[0,1]
v_pk_add_f32 v[36:37], v[36:37], v[44:45]
v_pk_add_f32 v[44:45], v[38:39], v[46:47] neg_lo:[0,1] neg_hi:[0,1]
v_pk_add_f32 v[38:39], v[38:39], v[46:47]
v_pk_mul_f32 v[46:47], v[44:45], s[62:63] op_sel:[0,0] op_sel_hi:[0,1] neg_lo:[0,1] neg_hi:[0,0]
v_pk_fma_f32 v[46:47], v[44:45], s[62:63], v[46:47] op_sel:[1,1,0] op_sel_hi:[1,0,1] neg_lo:[0,1,0] neg_hi:[0,1,0]
v_pk_add_f32 v[44:45], v[14:15], v[56:57] neg_lo:[0,1] neg_hi:[0,1]
v_pk_add_f32 v[14:15], v[14:15], v[56:57]
v_pk_add_f32 v[56:57], v[50:51], v[58:59] neg_lo:[0,1] neg_hi:[0,1]
v_pk_add_f32 v[50:51], v[50:51], v[58:59]
v_pk_mul_f32 v[58:59], v[56:57], s[62:63] op_sel:[0,0] op_sel_hi:[0,1] neg_lo:[0,0] neg_hi:[0,0]
v_pk_fma_f32 v[58:59], v[56:57], s[62:63], v[58:59] op_sel:[1,1,0] op_sel_hi:[1,0,1] neg_lo:[0,1,0] neg_hi:[0,0,0]
v_pk_add_f32 v[56:57], v[52:53], v[60:61] op_sel:[1,1] op_sel_hi:[0,0] neg_lo:[1,0] neg_hi:[0,1]
v_pk_add_f32 v[52:53], v[52:53], v[60:61]
v_pk_add_f32 v[60:61], v[54:55], v[62:63] neg_lo:[0,1] neg_hi:[0,1]
v_pk_add_f32 v[54:55], v[54:55], v[62:63]
v_pk_mul_f32 v[62:63], v[60:61], s[62:63] op_sel:[0,0] op_sel_hi:[0,1] neg_lo:[0,1] neg_hi:[0,0]
v_pk_fma_f32 v[62:63], v[60:61], s[62:63], v[62:63] op_sel:[1,1,0] op_sel_hi:[1,0,1] neg_lo:[0,1,0] neg_hi:[0,1,0]
v_pk_add_f32 v[60:61], v[40:41], v[48:49] neg_lo:[0,1] neg_hi:[0,1]
v_pk_add_f32 v[40:41], v[40:41], v[48:49]
v_pk_add_f32 v[48:49], v[66:67], v[74:75] neg_lo:[0,1] neg_hi:[0,1]
v_pk_add_f32 v[66:67], v[66:67], v[74:75]
v_pk_mul_f32 v[74:75], v[48:49], s[62:63] op_sel:[0,0] op_sel_hi:[0,1] neg_lo:[0,0] neg_hi:[0,0]
v_pk_fma_f32 v[74:75], v[48:49], s[62:63], v[74:75] op_sel:[1,1,0] op_sel_hi:[1,0,1] neg_lo:[0,1,0] neg_hi:[0,0,0]
v_pk_add_f32 v[48:49], v[68:69], v[76:77] op_sel:[1,1] op_sel_hi:[0,0] neg_lo:[1,0] neg_hi:[0,1]
v_pk_add_f32 v[68:69], v[68:69], v[76:77]
v_pk_add_f32 v[76:77], v[70:71], v[78:79] neg_lo:[0,1] neg_hi:[0,1]
v_pk_add_f32 v[70:71], v[70:71], v[78:79]
v_pk_mul_f32 v[78:79], v[76:77], s[62:63] op_sel:[0,0] op_sel_hi:[0,1] neg_lo:[0,1] neg_hi:[0,0]
v_pk_fma_f32 v[78:79], v[76:77], s[62:63], v[78:79] op_sel:[1,1,0] op_sel_hi:[1,0,1] neg_lo:[0,1,0] neg_hi:[0,1,0]
v_pk_add_f32 v[76:77], v[16:17], v[20:21] neg_lo:[0,1] neg_hi:[0,1]
v_pk_add_f32 v[16:17], v[16:17], v[20:21]
v_pk_add_f32 v[20:21], v[18:19], v[22:23] op_sel:[1,1] op_sel_hi:[0,0] neg_lo:[1,0] neg_hi:[0,1]
v_pk_add_f32 v[18:19], v[18:19], v[22:23]
v_pk_add_f32 v[22:23], v[72:73], v[24:25] neg_lo:[0,1] neg_hi:[0,1]
v_pk_add_f32 v[72:73], v[72:73], v[24:25]
v_pk_add_f32 v[24:25], v[26:27], v[30:31] op_sel:[1,1] op_sel_hi:[0,0] neg_lo:[1,0] neg_hi:[0,1]
v_pk_add_f32 v[26:27], v[26:27], v[30:31]
v_pk_add_f32 v[30:31], v[64:65], v[36:37] neg_lo:[0,1] neg_hi:[0,1]
v_pk_add_f32 v[64:65], v[64:65], v[36:37]
v_pk_add_f32 v[36:37], v[34:35], v[38:39] op_sel:[1,1] op_sel_hi:[0,0] neg_lo:[1,0] neg_hi:[0,1]
v_pk_add_f32 v[34:35], v[34:35], v[38:39]
v_pk_add_f32 v[38:39], v[28:29], v[32:33] neg_lo:[0,1] neg_hi:[0,1]
v_pk_add_f32 v[28:29], v[28:29], v[32:33]
v_pk_add_f32 v[32:33], v[42:43], v[46:47] op_sel:[1,1] op_sel_hi:[0,0] neg_lo:[1,0] neg_hi:[0,1]
v_pk_add_f32 v[42:43], v[42:43], v[46:47]
v_pk_add_f32 v[46:47], v[14:15], v[52:53] neg_lo:[0,1] neg_hi:[0,1]
v_pk_add_f32 v[14:15], v[14:15], v[52:53]
v_pk_add_f32 v[52:53], v[50:51], v[54:55] op_sel:[1,1] op_sel_hi:[0,0] neg_lo:[1,0] neg_hi:[0,1]
v_pk_add_f32 v[50:51], v[50:51], v[54:55]
v_pk_add_f32 v[54:55], v[44:45], v[56:57] neg_lo:[0,1] neg_hi:[0,1]
v_pk_add_f32 v[44:45], v[44:45], v[56:57]
v_pk_add_f32 v[56:57], v[58:59], v[62:63] op_sel:[1,1] op_sel_hi:[0,0] neg_lo:[1,0] neg_hi:[0,1]
v_pk_add_f32 v[58:59], v[58:59], v[62:63]
v_pk_add_f32 v[62:63], v[40:41], v[68:69] neg_lo:[0,1] neg_hi:[0,1]
v_pk_add_f32 v[40:41], v[40:41], v[68:69]
v_pk_add_f32 v[68:69], v[66:67], v[70:71] op_sel:[1,1] op_sel_hi:[0,0] neg_lo:[1,0] neg_hi:[0,1]
v_pk_add_f32 v[66:67], v[66:67], v[70:71]
v_pk_add_f32 v[70:71], v[60:61], v[48:49] neg_lo:[0,1] neg_hi:[0,1]
v_pk_add_f32 v[60:61], v[60:61], v[48:49]
v_pk_add_f32 v[48:49], v[74:75], v[78:79] op_sel:[1,1] op_sel_hi:[0,0] neg_lo:[1,0] neg_hi:[0,1]
v_pk_add_f32 v[74:75], v[74:75], v[78:79]
v_pk_add_f32 v[78:79], v[16:17], v[18:19] neg_lo:[0,1] neg_hi:[0,1]
v_pk_add_f32 v[16:17], v[16:17], v[18:19]
v_pk_add_f32 v[18:19], v[76:77], v[20:21] neg_lo:[0,1] neg_hi:[0,1]
v_pk_add_f32 v[76:77], v[76:77], v[20:21]
v_pk_add_f32 v[20:21], v[72:73], v[26:27] neg_lo:[0,1] neg_hi:[0,1]
v_pk_add_f32 v[72:73], v[72:73], v[26:27]
v_pk_add_f32 v[26:27], v[22:23], v[24:25] neg_lo:[0,1] neg_hi:[0,1]
v_pk_add_f32 v[22:23], v[22:23], v[24:25]
v_pk_add_f32 v[24:25], v[64:65], v[34:35] neg_lo:[0,1] neg_hi:[0,1]
v_pk_add_f32 v[64:65], v[64:65], v[34:35]
v_pk_add_f32 v[34:35], v[30:31], v[36:37] neg_lo:[0,1] neg_hi:[0,1]
v_pk_add_f32 v[30:31], v[30:31], v[36:37]
v_pk_add_f32 v[36:37], v[28:29], v[42:43] neg_lo:[0,1] neg_hi:[0,1]
v_pk_add_f32 v[28:29], v[28:29], v[42:43]
v_pk_add_f32 v[42:43], v[38:39], v[32:33] neg_lo:[0,1] neg_hi:[0,1]
v_pk_add_f32 v[38:39], v[38:39], v[32:33]
v_pk_add_f32 v[32:33], v[14:15], v[50:51] neg_lo:[0,1] neg_hi:[0,1]
v_pk_add_f32 v[14:15], v[14:15], v[50:51]
v_pk_add_f32 v[50:51], v[46:47], v[52:53] neg_lo:[0,1] neg_hi:[0,1]
v_pk_add_f32 v[46:47], v[46:47], v[52:53]
v_pk_add_f32 v[52:53], v[44:45], v[58:59] neg_lo:[0,1] neg_hi:[0,1]
v_pk_add_f32 v[44:45], v[44:45], v[58:59]
v_pk_add_f32 v[58:59], v[54:55], v[56:57] neg_lo:[0,1] neg_hi:[0,1]
v_pk_add_f32 v[54:55], v[54:55], v[56:57]
v_pk_add_f32 v[56:57], v[40:41], v[66:67] neg_lo:[0,1] neg_hi:[0,1]
v_pk_add_f32 v[40:41], v[40:41], v[66:67]
v_pk_add_f32 v[66:67], v[62:63], v[68:69] neg_lo:[0,1] neg_hi:[0,1]
v_pk_add_f32 v[62:63], v[62:63], v[68:69]
v_pk_add_f32 v[68:69], v[60:61], v[74:75] neg_lo:[0,1] neg_hi:[0,1]
v_pk_add_f32 v[60:61], v[60:61], v[74:75]
v_pk_add_f32 v[74:75], v[70:71], v[48:49] neg_lo:[0,1] neg_hi:[0,1]
v_pk_add_f32 v[70:71], v[70:71], v[48:49]
s_lshl_b32 s12, s38, 2
s_add_u32 s12, s12, s16
s_min_u32 s12, s12, 512
s_lshl_b32 s12, s12, 14
s_add_u32 s12, s12, 109051904
buffer_store_dwordx2 v[16:17], v5, s[84:87], s12 offen offset:0 sc1
buffer_store_dwordx2 v[14:15], v5, s[84:87], s12 offen offset:512 sc1
buffer_store_dwordx2 v[64:65], v5, s[84:87], s12 offen offset:1024 sc1
buffer_store_dwordx2 v[40:41], v5, s[84:87], s12 offen offset:1536 sc1
buffer_store_dwordx2 v[72:73], v5, s[84:87], s12 offen offset:2048 sc1
buffer_store_dwordx2 v[44:45], v5, s[84:87], s12 offen offset:2560 sc1
buffer_store_dwordx2 v[28:29], v5, s[84:87], s12 offen offset:3072 sc1
buffer_store_dwordx2 v[60:61], v5, s[84:87], s12 offen offset:3584 sc1
s_add_u32 s12, s12, 4096
buffer_store_dwordx2 v[76:77], v5, s[84:87], s12 offen offset:0 sc1
buffer_store_dwordx2 v[46:47], v5, s[84:87], s12 offen offset:512 sc1
buffer_store_dwordx2 v[30:31], v5, s[84:87], s12 offen offset:1024 sc1
buffer_store_dwordx2 v[62:63], v5, s[84:87], s12 offen offset:1536 sc1
buffer_store_dwordx2 v[22:23], v5, s[84:87], s12 offen offset:2048 sc1
buffer_store_dwordx2 v[54:55], v5, s[84:87], s12 offen offset:2560 sc1
buffer_store_dwordx2 v[38:39], v5, s[84:87], s12 offen offset:3072 sc1
buffer_store_dwordx2 v[70:71], v5, s[84:87], s12 offen offset:3584 sc1
s_add_u32 s12, s12, 4096
buffer_store_dwordx2 v[78:79], v5, s[84:87], s12 offen offset:0 sc1
buffer_store_dwordx2 v[32:33], v5, s[84:87], s12 offen offset:512 sc1
buffer_store_dwordx2 v[24:25], v5, s[84:87], s12 offen offset:1024 sc1
buffer_store_dwordx2 v[56:57], v5, s[84:87], s12 offen offset:1536 sc1
buffer_store_dwordx2 v[20:21], v5, s[84:87], s12 offen offset:2048 sc1
buffer_store_dwordx2 v[52:53], v5, s[84:87], s12 offen offset:2560 sc1
buffer_store_dwordx2 v[36:37], v5, s[84:87], s12 offen offset:3072 sc1
buffer_store_dwordx2 v[68:69], v5, s[84:87], s12 offen offset:3584 sc1
s_add_u32 s12, s12, 4096
buffer_store_dwordx2 v[18:19], v5, s[84:87], s12 offen offset:0 sc1
buffer_store_dwordx2 v[50:51], v5, s[84:87], s12 offen offset:512 sc1
buffer_store_dwordx2 v[34:35], v5, s[84:87], s12 offen offset:1024 sc1
buffer_store_dwordx2 v[66:67], v5, s[84:87], s12 offen offset:1536 sc1
buffer_store_dwordx2 v[26:27], v5, s[84:87], s12 offen offset:2048 sc1
buffer_store_dwordx2 v[58:59], v5, s[84:87], s12 offen offset:2560 sc1
buffer_store_dwordx2 v[42:43], v5, s[84:87], s12 offen offset:3072 sc1
buffer_store_dwordx2 v[74:75], v5, s[84:87], s12 offen offset:3584 sc1
s_add_u32 s12, s12, 4096
s_mov_b32 s38, s21
s_cmp_lt_u32 s38, s37
s_cbranch_scc1 mega_kernel_f2_l
mega_kernel_f2_e:
mega_kernel_f2e:
s_waitcnt vmcnt(0)
s_barrier
v_mov_b32 v1, 0
v_mov_b32 v2, 1
s_mov_b32 s82, 69259392
v_cmp_eq_u32 vcc, 0, v0
s_and_saveexec_b64 s[80:81], vcc
s_cbranch_execz mega_kernel_sg1
buffer_atomic_add v2, v1, s[84:87], s82 offen sc1
mega_kernel_sg1:
s_mov_b64 exec, s[80:81]
s_mov_b32 s64, 0
s_mov_b32 s65, 62
s_lshl_b32 s66, s40, 13
s_add_u32 s66, s66, 67633152
s_mov_b32 s67, 0
s_mov_b32 s68, 8192
s_mov_b32 s69, 1
s_cmp_eq_u32 s91, 3
s_cbranch_scc1 mega_kernel_out
v_mov_b32 v1, 0
s_mov_b32 s82, 69259392
mega_kernel_w1:
s_sleep 8
buffer_load_dword v2, v1, s[84:87], s82 offen sc1
s_waitcnt vmcnt(0)
v_cmp_ne_u32 vcc, 95, v2
s_cbranch_vccnz mega_kernel_w1
s_mov_b32 s93, s92
s_load_dwordx2 s[4:5], s[0:1], 80
s_mov_b32 s48, 0x3f7ec46d
s_mov_b32 s49, 0x3dc8bd36
s_mov_b32 s50, 0x3f7b14be
s_mov_b32 s51, 0x3e47c5c2
s_mov_b32 s52, 0x3f74fa0b
s_mov_b32 s53, 0x3e94a031
s_mov_b32 s54, 0x3f6c835e
s_mov_b32 s55, 0x3ec3ef15
s_mov_b32 s56, 0x3f61c598
s_mov_b32 s57, 0x3ef15aea
s_mov_b32 s58, 0x3f54db31
s_mov_b32 s59, 0x3f0e39da
s_mov_b32 s60, 0x3f45e403
s_mov_b32 s61, 0x3f226799
s_mov_b32 s62, 0x3f3504f3
s_mov_b32 s63, 0x3f3504f3
v_and_b32 v1, 31, v0
v_lshrrev_b32 v2, 5, v0
v_cvt_f32_u32 v3, v1
v_mul_u32_u24 v10, 8448, v2
v_lshl_add_u32 v4, v1, 3, v10
v_mul_u32_u24 v5, 264, v1
v_add_u32 v5, v5, v10
v_and_b32 v11, 7, v0
v_lshrrev_b32 v9, 3, v0
v_mul_u32_u24 v10, 8448, v11
v_lshl_add_u32 v6, v9, 3, v10
v_lshlrev_b32 v7, 3, v9
v_sub_u32 v7, v10, v7
v_add_u32 v7, 4096, v7
v_lshlrev_b32 v8, 14, v9
v_lshl_add_u32 v8, v11, 4, v8
v_mul_f32 v12, 0x3a800000, v3
v_cos_f32 v82, v12
v_sin_f32 v83, v12
v_mul_f32 v12, 0x3b000000, v3
v_cos_f32 v84, v12
v_sin_f32 v85, v12
v_mul_f32 v12, 0x3b400000, v3
v_cos_f32 v86, v12
v_sin_f32 v87, v12
v_mul_f32 v12, 0x3b800000, v3
v_cos_f32 v88, v12
v_sin_f32 v89, v12
v_mul_f32 v12, 0x3ba00000, v3
v_cos_f32 v90, v12
v_sin_f32 v91, v12
v_mul_f32 v12, 0x3bc00000, v3
v_cos_f32 v92, v12
v_sin_f32 v93, v12
v_mul_f32 v12, 0x3be00000, v3
v_cos_f32 v94, v12
v_sin_f32 v95, v12
v_mul_f32 v12, 0x3c000000, v3
v_cos_f32 v96, v12
v_sin_f32 v97, v12
v_mul_f32 v12, 0x3c100000, v3
v_cos_f32 v98, v12
v_sin_f32 v99, v12
v_mul_f32 v12, 0x3c200000, v3
v_cos_f32 v100, v12
v_sin_f32 v101, v12
v_mul_f32 v12, 0x3c300000, v3
v_cos_f32 v102, v12
v_sin_f32 v103, v12
v_mul_f32 v12, 0x3c400000, v3
v_cos_f32 v104, v12
v_sin_f32 v105, v12
v_mul_f32 v12, 0x3c500000, v3
v_cos_f32 v106, v12
v_sin_f32 v107, v12
v_mul_f32 v12, 0x3c600000, v3
v_cos_f32 v108, v12
v_sin_f32 v109, v12
v_mul_f32 v12, 0x3c700000, v3
v_cos_f32 v110, v12
v_sin_f32 v111, v12
v_mul_f32 v12, 0x3c800000, v3
v_cos_f32 v112, v12
v_sin_f32 v113, v12
v_mul_f32 v12, 0x3c880000, v3
v_cos_f32 v114, v12
v_sin_f32 v115, v12
v_mul_f32 v12, 0x3c900000, v3
v_cos_f32 v116, v12
v_sin_f32 v117, v12
v_mul_f32 v12, 0x3c980000, v3
v_cos_f32 v118, v12
v_sin_f32 v119, v12
v_mul_f32 v12, 0x3ca00000, v3
v_cos_f32 v120, v12
v_sin_f32 v121, v12
v_mul_f32 v12, 0x3ca80000, v3
v_cos_f32 v122, v12
v_sin_f32 v123, v12
v_mul_f32 v12, 0x3cb00000, v3
v_cos_f32 v124, v12
v_sin_f32 v125, v12
v_mul_f32 v12, 0x3cb80000, v3
v_cos_f32 v126, v12
v_sin_f32 v127, v12
v_mul_f32 v12, 0x3cc00000, v3
v_cos_f32 v128, v12
v_sin_f32 v129, v12
v_mul_f32 v12, 0x3cc80000, v3
v_cos_f32 v130, v12
v_sin_f32 v131, v12
v_mul_f32 v12, 0x3cd00000, v3
v_cos_f32 v132, v12
v_sin_f32 v133, v12
v_mul_f32 v12, 0x3cd80000, v3
v_cos_f32 v134, v12
v_sin_f32 v135, v12
v_mul_f32 v12, 0x3ce00000, v3
v_cos_f32 v136, v12
v_sin_f32 v137, v12
v_mul_f32 v12, 0x3ce80000, v3
v_cos_f32 v138, v12
v_sin_f32 v139, v12
v_mul_f32 v12, 0x3cf00000, v3
v_cos_f32 v140, v12
v_sin_f32 v141, v12
v_mul_f32 v12, 0x3cf80000, v3
v_cos_f32 v142, v12
v_sin_f32 v143, v12
v_lshlrev_b32 v12, 2, v1
v_sub_u32 v12, v4, v12
v_and_b32 v10, 127, v0
v_lshrrev_b32 v11, 7, v0
v_lshlrev_b32 v2, 5, v10
v_lshl_add_u32 v2, v11, 12, v2
v_lshlrev_b32 v3, 4, v10
v_lshl_add_u32 v3, v11, 12, v3
v_add_u32 v3, 2048, v3
v_cmp_eq_u32 s[14:15], 0, v9
s_waitcnt lgkmcnt(0)
s_mov_b32 s6, 8388608
s_mov_b32 s7, 0x00020000
s_cmp_lt_u32 s93, 128
s_cbranch_scc0 mega_kernel_f3_e
s_lshl_b32 s12, s93, 7
s_add_u32 s12, s12, 109051904
buffer_load_dwordx4 v[144:147], v8, s[84:87], s12 offen sc1
s_add_u32 s12, s12, 524288
buffer_load_dwordx4 v[148:151], v8, s[84:87], s12 offen sc1
s_add_u32 s12, s12, 524288
buffer_load_dwordx4 v[152:155], v8, s[84:87], s12 offen sc1
s_add_u32 s12, s12, 524288
buffer_load_dwordx4 v[156:159], v8, s[84:87], s12 offen sc1
s_add_u32 s12, s12, 524288
buffer_load_dwordx4 v[160:163], v8, s[84:87], s12 offen sc1
s_add_u32 s12, s12, 524288
buffer_load_dwordx4 v[164:167], v8, s[84:87], s12 offen sc1
s_add_u32 s12, s12, 524288
buffer_load_dwordx4 v[168:171], v8, s[84:87], s12 offen sc1
s_add_u32 s12, s12, 524288
buffer_load_dwordx4 v[172:175], v8, s[84:87], s12 offen sc1
s_add_u32 s12, s12, 524288
buffer_load_dwordx4 v[176:179], v8, s[84:87], s12 offen sc1
s_add_u32 s12, s12, 524288
buffer_load_dwordx4 v[180:183], v8, s[84:87], s12 offen sc1
s_add_u32 s12, s12, 524288
buffer_load_dwordx4 v[184:187], v8, s[84:87], s12 offen sc1
s_add_u32 s12, s12, 524288
buffer_load_dwordx4 v[188:191], v8, s[84:87], s12 offen sc1
s_add_u32 s12, s12, 524288
buffer_load_dwordx4 v[192:195], v8, s[84:87], s12 offen sc1
s_add_u32 s12, s12, 524288
buffer_load_dwordx4 v[196:199], v8, s[84:87], s12 offen sc1
s_add_u32 s12, s12, 524288
buffer_load_dwordx4 v[200:203], v8, s[84:87], s12 offen sc1
s_add_u32 s12, s12, 524288
buffer_load_dwordx4 v[204:207], v8, s[84:87], s12 offen sc1
s_add_u32 s12, s12, 524288
buffer_load_dwordx4 v[208:211], v8, s[84:87], s12 offen sc1
s_add_u32 s12, s12, 524288
s_waitcnt vmcnt(0)
mega_kernel_f3_l:
s_add_u32 s21, s93, 64
s_cmp_lt_u32 s21, 128
s_cselect_b32 s22, s21, s93
s_waitcnt vmcnt(8)
s_barrier
v_cndmask_b32 v145, v145, 0, s[14:15]
v_cndmask_b32 v147, v147, 0, s[14:15]
v_cndmask_b32 v209, v209, 0, s[14:15]
v_cndmask_b32 v211, v211, 0, s[14:15]
v_pk_add_f32 v[16:17], v[144:145], v[146:147] op_sel:[0,1] op_sel_hi:[1,0] neg_lo:[0,1]
v_pk_add_f32 v[18:19], v[144:145], v[146:147] op_sel:[0,1] op_sel_hi:[1,0] neg_hi:[1,0]
ds_write_b64 v6, v[16:17] offset:0
ds_write_b64 v7, v[18:19] offset:4096
v_pk_add_f32 v[20:21], v[148:149], v[150:151] op_sel:[0,1] op_sel_hi:[1,0] neg_lo:[0,1]
v_pk_add_f32 v[22:23], v[148:149], v[150:151] op_sel:[0,1] op_sel_hi:[1,0] neg_hi:[1,0]
ds_write_b64 v6, v[20:21] offset:256
ds_write_b64 v7, v[22:23] offset:3840
v_pk_add_f32 v[24:25], v[152:153], v[154:155] op_sel:[0,1] op_sel_hi:[1,0] neg_lo:[0,1]
v_pk_add_f32 v[26:27], v[152:153], v[154:155] op_sel:[0,1] op_sel_hi:[1,0] neg_hi:[1,0]
ds_write_b64 v6, v[24:25] offset:512
ds_write_b64 v7, v[26:27] offset:3584
v_pk_add_f32 v[28:29], v[156:157], v[158:159] op_sel:[0,1] op_sel_hi:[1,0] neg_lo:[0,1]
v_pk_add_f32 v[30:31], v[156:157], v[158:159] op_sel:[0,1] op_sel_hi:[1,0] neg_hi:[1,0]
ds_write_b64 v6, v[28:29] offset:768
ds_write_b64 v7, v[30:31] offset:3328
v_pk_add_f32 v[32:33], v[160:161], v[162:163] op_sel:[0,1] op_sel_hi:[1,0] neg_lo:[0,1]
v_pk_add_f32 v[34:35], v[160:161], v[162:163] op_sel:[0,1] op_sel_hi:[1,0] neg_hi:[1,0]
ds_write_b64 v6, v[32:33] offset:1024
ds_write_b64 v7, v[34:35] offset:3072
v_pk_add_f32 v[36:37], v[164:165], v[166:167] op_sel:[0,1] op_sel_hi:[1,0] neg_lo:[0,1]
v_pk_add_f32 v[38:39], v[164:165], v[166:167] op_sel:[0,1] op_sel_hi:[1,0] neg_hi:[1,0]
ds_write_b64 v6, v[36:37] offset:1280
ds_write_b64 v7, v[38:39] offset:2816
v_pk_add_f32 v[40:41], v[168:169], v[170:171] op_sel:[0,1] op_sel_hi:[1,0] neg_lo:[0,1]
v_pk_add_f32 v[42:43], v[168:169], v[170:171] op_sel:[0,1] op_sel_hi:[1,0] neg_hi:[1,0]
ds_write_b64 v6, v[40:41] offset:1536
ds_write_b64 v7, v[42:43] offset:2560
v_pk_add_f32 v[44:45], v[172:173], v[174:175] op_sel:[0,1] op_sel_hi:[1,0] neg_lo:[0,1]
v_pk_add_f32 v[46:47], v[172:173], v[174:175] op_sel:[0,1] op_sel_hi:[1,0] neg_hi:[1,0]
ds_write_b64 v6, v[44:45] offset:1792
ds_write_b64 v7, v[46:47] offset:2304
v_pk_add_f32 v[48:49], v[176:177], v[178:179] op_sel:[0,1] op_sel_hi:[1,0] neg_lo:[0,1]
v_pk_add_f32 v[50:51], v[176:177], v[178:179] op_sel:[0,1] op_sel_hi:[1,0] neg_hi:[1,0]
ds_write_b64 v6, v[48:49] offset:2048
ds_write_b64 v7, v[50:51] offset:2048
v_pk_add_f32 v[52:53], v[180:181], v[182:183] op_sel:[0,1] op_sel_hi:[1,0] neg_lo:[0,1]
v_pk_add_f32 v[54:55], v[180:181], v[182:183] op_sel:[0,1] op_sel_hi:[1,0] neg_hi:[1,0]
ds_write_b64 v6, v[52:53] offset:2304
ds_write_b64 v7, v[54:55] offset:1792
v_pk_add_f32 v[56:57], v[184:185], v[186:187] op_sel:[0,1] op_sel_hi:[1,0] neg_lo:[0,1]
v_pk_add_f32 v[58:59], v[184:185], v[186:187] op_sel:[0,1] op_sel_hi:[1,0] neg_hi:[1,0]
ds_write_b64 v6, v[56:57] offset:2560
ds_write_b64 v7, v[58:59] offset:1536
v_pk_add_f32 v[60:61], v[188:189], v[190:191] op_sel:[0,1] op_sel_hi:[1,0] neg_lo:[0,1]
v_pk_add_f32 v[62:63], v[188:189], v[190:191] op_sel:[0,1] op_sel_hi:[1,0] neg_hi:[1,0]
ds_write_b64 v6, v[60:61] offset:2816
ds_write_b64 v7, v[62:63] offset:1280
v_pk_add_f32 v[64:65], v[192:193], v[194:195] op_sel:[0,1] op_sel_hi:[1,0] neg_lo:[0,1]
v_pk_add_f32 v[66:67], v[192:193], v[194:195] op_sel:[0,1] op_sel_hi:[1,0] neg_hi:[1,0]
ds_write_b64 v6, v[64:65] offset:3072
ds_write_b64 v7, v[66:67] offset:1024
v_pk_add_f32 v[68:69], v[196:197], v[198:199] op_sel:[0,1] op_sel_hi:[1,0] neg_lo:[0,1]
v_pk_add_f32 v[70:71], v[196:197], v[198:199] op_sel:[0,1] op_sel_hi:[1,0] neg_hi:[1,0]
ds_write_b64 v6, v[68:69] offset:3328
ds_write_b64 v7, v[70:71] offset:768
v_pk_add_f32 v[72:73], v[200:201], v[202:203] op_sel:[0,1] op_sel_hi:[1,0] neg_lo:[0,1]
v_pk_add_f32 v[74:75], v[200:201], v[202:203] op_sel:[0,1] op_sel_hi:[1,0] neg_hi:[1,0]
ds_write_b64 v6, v[72:73] offset:3584
ds_write_b64 v7, v[74:75] offset:512
s_waitcnt lgkmcnt(8)
v_pk_add_f32 v[76:77], v[204:205], v[206:207] op_sel:[0,1] op_sel_hi:[1,0] neg_lo:[0,1]
v_pk_add_f32 v[78:79], v[204:205], v[206:207] op_sel:[0,1] op_sel_hi:[1,0] neg_hi:[1,0]
ds_write_b64 v6, v[76:77] offset:3840
ds_write_b64 v7, v[78:79] offset:256
v_pk_add_f32 v[16:17], v[208:209], v[210:211] op_sel:[0,1] op_sel_hi:[1,0] neg_lo:[0,1]
v_pk_add_f32 v[18:19], v[208:209], v[210:211] op_sel:[0,1] op_sel_hi:[1,0] neg_hi:[1,0]
s_mov_b64 exec, s[14:15]
ds_write_b64 v6, v[16:17] offset:4096
s_mov_b64 exec, -1
s_lshl_b32 s12, s22, 7
s_add_u32 s12, s12, 109051904
buffer_load_dwordx4 v[144:147], v8, s[84:87], s12 offen sc1
s_add_u32 s12, s12, 524288
buffer_load_dwordx4 v[148:151], v8, s[84:87], s12 offen sc1
s_add_u32 s12, s12, 524288
buffer_load_dwordx4 v[152:155], v8, s[84:87], s12 offen sc1
s_add_u32 s12, s12, 524288
buffer_load_dwordx4 v[156:159], v8, s[84:87], s12 offen sc1
s_add_u32 s12, s12, 524288
buffer_load_dwordx4 v[160:163], v8, s[84:87], s12 offen sc1
s_add_u32 s12, s12, 524288
buffer_load_dwordx4 v[164:167], v8, s[84:87], s12 offen sc1
s_add_u32 s12, s12, 524288
buffer_load_dwordx4 v[168:171], v8, s[84:87], s12 offen sc1
s_add_u32 s12, s12, 524288
buffer_load_dwordx4 v[172:175], v8, s[84:87], s12 offen sc1
s_add_u32 s12, s12, 524288
buffer_load_dwordx4 v[176:179], v8, s[84:87], s12 offen sc1
s_add_u32 s12, s12, 524288
buffer_load_dwordx4 v[180:183], v8, s[84:87], s12 offen sc1
s_add_u32 s12, s12, 524288
buffer_load_dwordx4 v[184:187], v8, s[84:87], s12 offen sc1
s_add_u32 s12, s12, 524288
buffer_load_dwordx4 v[188:191], v8, s[84:87], s12 offen sc1
s_add_u32 s12, s12, 524288
buffer_load_dwordx4 v[192:195], v8, s[84:87], s12 offen sc1
s_add_u32 s12, s12, 524288
buffer_load_dwordx4 v[196:199], v8, s[84:87], s12 offen sc1
s_add_u32 s12, s12, 524288
buffer_load_dwordx4 v[200:203], v8, s[84:87], s12 offen sc1
s_add_u32 s12, s12, 524288
buffer_load_dwordx4 v[204:207], v8, s[84:87], s12 offen sc1
s_add_u32 s12, s12, 524288
buffer_load_dwordx4 v[208:211], v8, s[84:87], s12 offen sc1
s_add_u32 s12, s12, 524288
s_waitcnt lgkmcnt(0)
s_barrier
ds_read_b64 v[16:17], v4 offset:0
ds_read_b64 v[48:49], v4 offset:4096
ds_read_b64 v[18:19], v4 offset:256
ds_read_b64 v[50:51], v4 offset:4352
ds_read_b64 v[20:21], v4 offset:512
ds_read_b64 v[52:53], v4 offset:4608
ds_read_b64 v[22:23], v4 offset:768
ds_read_b64 v[54:55], v4 offset:4864
ds_read_b64 v[24:25], v4 offset:1024
ds_read_b64 v[56:57], v4 offset:5120
ds_read_b64 v[26:27], v4 offset:1280
ds_read_b64 v[58:59], v4 offset:5376
ds_read_b64 v[28:29], v4 offset:1536
ds_read_b64 v[60:61], v4 offset:5632
ds_read_b64 v[30:31], v4 offset:1792
ds_read_b64 v[62:63], v4 offset:5888
ds_read_b64 v[32:33], v4 offset:2048
ds_read_b64 v[64:65], v4 offset:6144
ds_read_b64 v[34:35], v4 offset:2304
ds_read_b64 v[66:67], v4 offset:6400
ds_read_b64 v[36:37], v4 offset:2560
ds_read_b64 v[68:69], v4 offset:6656
ds_read_b64 v[38:39], v4 offset:2816
ds_read_b64 v[70:71], v4 offset:6912
ds_read_b64 v[40:41], v4 offset:3072
ds_read_b64 v[72:73], v4 offset:7168
ds_read_b64 v[42:43], v4 offset:3328
ds_read_b64 v[74:75], v4 offset:7424
ds_read_b64 v[44:45], v4 offset:3584
ds_read_b64 v[76:77], v4 offset:7680
ds_read_b64 v[46:47], v4 offset:3840
ds_read_b64 v[78:79], v4 offset:7936
s_waitcnt lgkmcnt(0)
v_pk_add_f32 v[14:15], v[16:17], v[48:49] neg_lo:[0,1] neg_hi:[0,1]
v_pk_add_f32 v[16:17], v[16:17], v[48:49]
v_pk_add_f32 v[48:49], v[18:19], v[50:51] neg_lo:[0,1] neg_hi:[0,1]
v_pk_add_f32 v[18:19], v[18:19], v[50:51]
v_pk_mul_f32 v[50:51], v[48:49], s[50:51] op_sel:[0,0] op_sel_hi:[0,1] neg_lo:[0,0] neg_hi:[0,0]
v_pk_fma_f32 v[50:51], v[48:49], s[50:51], v[50:51] op_sel:[1,1,0] op_sel_hi:[1,0,1] neg_lo:[0,1,0] neg_hi:[0,0,0]
v_pk_add_f32 v[48:49], v[20:21], v[52:53] neg_lo:[0,1] neg_hi:[0,1]
v_pk_add_f32 v[20:21], v[20:21], v[52:53]
v_pk_mul_f32 v[52:53], v[48:49], s[54:55] op_sel:[0,0] op_sel_hi:[0,1] neg_lo:[0,0] neg_hi:[0,0]
v_pk_fma_f32 v[52:53], v[48:49], s[54:55], v[52:53] op_sel:[1,1,0] op_sel_hi:[1,0,1] neg_lo:[0,1,0] neg_hi:[0,0,0]
v_pk_add_f32 v[48:49], v[22:23], v[54:55] neg_lo:[0,1] neg_hi:[0,1]
v_pk_add_f32 v[22:23], v[22:23], v[54:55]
v_pk_mul_f32 v[54:55], v[48:49], s[58:59] op_sel:[0,0] op_sel_hi:[0,1] neg_lo:[0,0] neg_hi:[0,0]
v_pk_fma_f32 v[54:55], v[48:49], s[58:59], v[54:55] op_sel:[1,1,0] op_sel_hi:[1,0,1] neg_lo:[0,1,0] neg_hi:[0,0,0]
v_pk_add_f32 v[48:49], v[24:25], v[56:57] neg_lo:[0,1] neg_hi:[0,1]
v_pk_add_f32 v[24:25], v[24:25], v[56:57]
v_pk_mul_f32 v[56:57], v[48:49], s[62:63] op_sel:[0,0] op_sel_hi:[0,1] neg_lo:[0,0] neg_hi:[0,0]
v_pk_fma_f32 v[56:57], v[48:49], s[62:63], v[56:57] op_sel:[1,1,0] op_sel_hi:[1,0,1] neg_lo:[0,1,0] neg_hi:[0,0,0]
v_pk_add_f32 v[48:49], v[26:27], v[58:59] neg_lo:[0,1] neg_hi:[0,1]
v_pk_add_f32 v[26:27], v[26:27], v[58:59]
v_pk_mul_f32 v[58:59], v[48:49], s[58:59] op_sel:[0,1] op_sel_hi:[0,0] neg_lo:[0,0] neg_hi:[0,0]
v_pk_fma_f32 v[58:59], v[48:49], s[58:59], v[58:59] op_sel:[1,0,0] op_sel_hi:[1,1,1] neg_lo:[0,1,0] neg_hi:[0,0,0]
v_pk_add_f32 v[48:49], v[28:29], v[60:61] neg_lo:[0,1] neg_hi:[0,1]
v_pk_add_f32 v[28:29], v[28:29], v[60:61]
v_pk_mul_f32 v[60:61], v[48:49], s[54:55] op_sel:[0,1] op_sel_hi:[0,0] neg_lo:[0,0] neg_hi:[0,0]
v_pk_fma_f32 v[60:61], v[48:49], s[54:55], v[60:61] op_sel:[1,0,0] op_sel_hi:[1,1,1] neg_lo:[0,1,0] neg_hi:[0,0,0]
v_pk_add_f32 v[48:49], v[30:31], v[62:63] neg_lo:[0,1] neg_hi:[0,1]
v_pk_add_f32 v[30:31], v[30:31], v[62:63]
v_pk_mul_f32 v[62:63], v[48:49], s[50:51] op_sel:[0,1] op_sel_hi:[0,0] neg_lo:[0,0] neg_hi:[0,0]
v_pk_fma_f32 v[62:63], v[48:49], s[50:51], v[62:63] op_sel:[1,0,0] op_sel_hi:[1,1,1] neg_lo:[0,1,0] neg_hi:[0,0,0]
v_pk_add_f32 v[48:49], v[32:33], v[64:65] op_sel:[1,1] op_sel_hi:[0,0] neg_lo:[1,0] neg_hi:[0,1]
v_pk_add_f32 v[32:33], v[32:33], v[64:65]
v_pk_add_f32 v[64:65], v[34:35], v[66:67] neg_lo:[0,1] neg_hi:[0,1]
v_pk_add_f32 v[34:35], v[34:35], v[66:67]
v_pk_mul_f32 v[66:67], v[64:65], s[50:51] op_sel:[0,1] op_sel_hi:[0,0] neg_lo:[0,1] neg_hi:[0,0]
v_pk_fma_f32 v[66:67], v[64:65], s[50:51], v[66:67] op_sel:[1,0,0] op_sel_hi:[1,1,1] neg_lo:[0,1,0] neg_hi:[0,1,0]
v_pk_add_f32 v[64:65], v[36:37], v[68:69] neg_lo:[0,1] neg_hi:[0,1]
v_pk_add_f32 v[36:37], v[36:37], v[68:69]
v_pk_mul_f32 v[68:69], v[64:65], s[54:55] op_sel:[0,1] op_sel_hi:[0,0] neg_lo:[0,1] neg_hi:[0,0]
v_pk_fma_f32 v[68:69], v[64:65], s[54:55], v[68:69] op_sel:[1,0,0] op_sel_hi:[1,1,1] neg_lo:[0,1,0] neg_hi:[0,1,0]
v_pk_add_f32 v[64:65], v[38:39], v[70:71] neg_lo:[0,1] neg_hi:[0,1]
v_pk_add_f32 v[38:39], v[38:39], v[70:71]
v_pk_mul_f32 v[70:71], v[64:65], s[58:59] op_sel:[0,1] op_sel_hi:[0,0] neg_lo:[0,1] neg_hi:[0,0]
v_pk_fma_f32 v[70:71], v[64:65], s[58:59], v[70:71] op_sel:[1,0,0] op_sel_hi:[1,1,1] neg_lo:[0,1,0] neg_hi:[0,1,0]
v_pk_add_f32 v[64:65], v[40:41], v[72:73] neg_lo:[0,1] neg_hi:[0,1]
v_pk_add_f32 v[40:41], v[40:41], v[72:73]
v_pk_mul_f32 v[72:73], v[64:65], s[62:63] op_sel:[0,0] op_sel_hi:[0,1] neg_lo:[0,1] neg_hi:[0,0]
v_pk_fma_f32 v[72:73], v[64:65], s[62:63], v[72:73] op_sel:[1,1,0] op_sel_hi:[1,0,1] neg_lo:[0,1,0] neg_hi:[0,1,0]
v_pk_add_f32 v[64:65], v[42:43], v[74:75] neg_lo:[0,1] neg_hi:[0,1]
v_pk_add_f32 v[42:43], v[42:43], v[74:75]
v_pk_mul_f32 v[74:75], v[64:65], s[58:59] op_sel:[0,0] op_sel_hi:[0,1] neg_lo:[0,1] neg_hi:[0,0]
v_pk_fma_f32 v[74:75], v[64:65], s[58:59], v[74:75] op_sel:[1,1,0] op_sel_hi:[1,0,1] neg_lo:[0,1,0] neg_hi:[0,1,0]
v_pk_add_f32 v[64:65], v[44:45], v[76:77] neg_lo:[0,1] neg_hi:[0,1]
v_pk_add_f32 v[44:45], v[44:45], v[76:77]
v_pk_mul_f32 v[76:77], v[64:65], s[54:55] op_sel:[0,0] op_sel_hi:[0,1] neg_lo:[0,1] neg_hi:[0,0]
v_pk_fma_f32 v[76:77], v[64:65], s[54:55], v[76:77] op_sel:[1,1,0] op_sel_hi:[1,0,1] neg_lo:[0,1,0] neg_hi:[0,1,0]
v_pk_add_f32 v[64:65], v[46:47], v[78:79] neg_lo:[0,1] neg_hi:[0,1]
v_pk_add_f32 v[46:47], v[46:47], v[78:79]
v_pk_mul_f32 v[78:79], v[64:65], s[50:51] op_sel:[0,0] op_sel_hi:[0,1] neg_lo:[0,1] neg_hi:[0,0]
v_pk_fma_f32 v[78:79], v[64:65], s[50:51], v[78:79] op_sel:[1,1,0] op_sel_hi:[1,0,1] neg_lo:[0,1,0] neg_hi:[0,1,0]
v_pk_add_f32 v[64:65], v[16:17], v[32:33] neg_lo:[0,1] neg_hi:[0,1]
v_pk_add_f32 v[16:17], v[16:17], v[32:33]
v_pk_add_f32 v[32:33], v[18:19], v[34:35] neg_lo:[0,1] neg_hi:[0,1]
v_pk_add_f32 v[18:19], v[18:19], v[34:35]
v_pk_mul_f32 v[34:35], v[32:33], s[54:55] op_sel:[0,0] op_sel_hi:[0,1] neg_lo:[0,0] neg_hi:[0,0]
v_pk_fma_f32 v[34:35], v[32:33], s[54:55], v[34:35] op_sel:[1,1,0] op_sel_hi:[1,0,1] neg_lo:[0,1,0] neg_hi:[0,0,0]
v_pk_add_f32 v[32:33], v[20:21], v[36:37] neg_lo:[0,1] neg_hi:[0,1]
v_pk_add_f32 v[20:21], v[20:21], v[36:37]
v_pk_mul_f32 v[36:37], v[32:33], s[62:63] op_sel:[0,0] op_sel_hi:[0,1] neg_lo:[0,0] neg_hi:[0,0]
v_pk_fma_f32 v[36:37], v[32:33], s[62:63], v[36:37] op_sel:[1,1,0] op_sel_hi:[1,0,1] neg_lo:[0,1,0] neg_hi:[0,0,0]
v_pk_add_f32 v[32:33], v[22:23], v[38:39] neg_lo:[0,1] neg_hi:[0,1]
v_pk_add_f32 v[22:23], v[22:23], v[38:39]
v_pk_mul_f32 v[38:39], v[32:33], s[54:55] op_sel:[0,1] op_sel_hi:[0,0] neg_lo:[0,0] neg_hi:[0,0]
v_pk_fma_f32 v[38:39], v[32:33], s[54:55], v[38:39] op_sel:[1,0,0] op_sel_hi:[1,1,1] neg_lo:[0,1,0] neg_hi:[0,0,0]
v_pk_add_f32 v[32:33], v[24:25], v[40:41] op_sel:[1,1] op_sel_hi:[0,0] neg_lo:[1,0] neg_hi:[0,1]
v_pk_add_f32 v[24:25], v[24:25], v[40:41]
v_pk_add_f32 v[40:41], v[26:27], v[42:43] neg_lo:[0,1] neg_hi:[0,1]
v_pk_add_f32 v[26:27], v[26:27], v[42:43]
v_pk_mul_f32 v[42:43], v[40:41], s[54:55] op_sel:[0,1] op_sel_hi:[0,0] neg_lo:[0,1] neg_hi:[0,0]
v_pk_fma_f32 v[42:43], v[40:41], s[54:55], v[42:43] op_sel:[1,0,0] op_sel_hi:[1,1,1] neg_lo:[0,1,0] neg_hi:[0,1,0]
v_pk_add_f32 v[40:41], v[28:29], v[44:45] neg_lo:[0,1] neg_hi:[0,1]
v_pk_add_f32 v[28:29], v[28:29], v[44:45]
v_pk_mul_f32 v[44:45], v[40:41], s[62:63] op_sel:[0,0] op_sel_hi:[0,1] neg_lo:[0,1] neg_hi:[0,0]
v_pk_fma_f32 v[44:45], v[40:41], s[62:63], v[44:45] op_sel:[1,1,0] op_sel_hi:[1,0,1] neg_lo:[0,1,0] neg_hi:[0,1,0]
v_pk_add_f32 v[40:41], v[30:31], v[46:47] neg_lo:[0,1] neg_hi:[0,1]
v_pk_add_f32 v[30:31], v[30:31], v[46:47]
v_pk_mul_f32 v[46:47], v[40:41], s[54:55] op_sel:[0,0] op_sel_hi:[0,1] neg_lo:[0,1] neg_hi:[0,0]
v_pk_fma_f32 v[46:47], v[40:41], s[54:55], v[46:47] op_sel:[1,1,0] op_sel_hi:[1,0,1] neg_lo:[0,1,0] neg_hi:[0,1,0]
v_pk_add_f32 v[40:41], v[14:15], v[48:49] neg_lo:[0,1] neg_hi:[0,1]
v_pk_add_f32 v[14:15], v[14:15], v[48:49]
v_pk_add_f32 v[48:49], v[50:51], v[66:67] neg_lo:[0,1] neg_hi:[0,1]
v_pk_add_f32 v[50:51], v[50:51], v[66:67]
v_pk_mul_f32 v[66:67], v[48:49], s[54:55] op_sel:[0,0] op_sel_hi:[0,1] neg_lo:[0,0] neg_hi:[0,0]
v_pk_fma_f32 v[66:67], v[48:49], s[54:55], v[66:67] op_sel:[1,1,0] op_sel_hi:[1,0,1] neg_lo:[0,1,0] neg_hi:[0,0,0]
v_pk_add_f32 v[48:49], v[52:53], v[68:69] neg_lo:[0,1] neg_hi:[0,1]
v_pk_add_f32 v[52:53], v[52:53], v[68:69]
v_pk_mul_f32 v[68:69], v[48:49], s[62:63] op_sel:[0,0] op_sel_hi:[0,1] neg_lo:[0,0] neg_hi:[0,0]
v_pk_fma_f32 v[68:69], v[48:49], s[62:63], v[68:69] op_sel:[1,1,0] op_sel_hi:[1,0,1] neg_lo:[0,1,0] neg_hi:[0,0,0]
v_pk_add_f32 v[48:49], v[54:55], v[70:71] neg_lo:[0,1] neg_hi:[0,1]
v_pk_add_f32 v[54:55], v[54:55], v[70:71]
v_pk_mul_f32 v[70:71], v[48:49], s[54:55] op_sel:[0,1] op_sel_hi:[0,0] neg_lo:[0,0] neg_hi:[0,0]
v_pk_fma_f32 v[70:71], v[48:49], s[54:55], v[70:71] op_sel:[1,0,0] op_sel_hi:[1,1,1] neg_lo:[0,1,0] neg_hi:[0,0,0]
v_pk_add_f32 v[48:49], v[56:57], v[72:73] op_sel:[1,1] op_sel_hi:[0,0] neg_lo:[1,0] neg_hi:[0,1]
v_pk_add_f32 v[56:57], v[56:57], v[72:73]
v_pk_add_f32 v[72:73], v[58:59], v[74:75] neg_lo:[0,1] neg_hi:[0,1]
v_pk_add_f32 v[58:59], v[58:59], v[74:75]
v_pk_mul_f32 v[74:75], v[72:73], s[54:55] op_sel:[0,1] op_sel_hi:[0,0] neg_lo:[0,1] neg_hi:[0,0]
v_pk_fma_f32 v[74:75], v[72:73], s[54:55], v[74:75] op_sel:[1,0,0] op_sel_hi:[1,1,1] neg_lo:[0,1,0] neg_hi:[0,1,0]
v_pk_add_f32 v[72:73], v[60:61], v[76:77] neg_lo:[0,1] neg_hi:[0,1]
v_pk_add_f32 v[60:61], v[60:61], v[76:77]
v_pk_mul_f32 v[76:77], v[72:73], s[62:63] op_sel:[0,0] op_sel_hi:[0,1] neg_lo:[0,1] neg_hi:[0,0]
v_pk_fma_f32 v[76:77], v[72:73], s[62:63], v[76:77] op_sel:[1,1,0] op_sel_hi:[1,0,1] neg_lo:[0,1,0] neg_hi:[0,1,0]
v_pk_add_f32 v[72:73], v[62:63], v[78:79] neg_lo:[0,1] neg_hi:[0,1]
v_pk_add_f32 v[62:63], v[62:63], v[78:79]
v_pk_mul_f32 v[78:79], v[72:73], s[54:55] op_sel:[0,0] op_sel_hi:[0,1] neg_lo:[0,1] neg_hi:[0,0]
v_pk_fma_f32 v[78:79], v[72:73], s[54:55], v[78:79] op_sel:[1,1,0] op_sel_hi:[1,0,1] neg_lo:[0,1,0] neg_hi:[0,1,0]
v_pk_add_f32 v[72:73], v[16:17], v[24:25] neg_lo:[0,1] neg_hi:[0,1]
v_pk_add_f32 v[16:17], v[16:17], v[24:25]
v_pk_add_f32 v[24:25], v[18:19], v[26:27] neg_lo:[0,1] neg_hi:[0,1]
v_pk_add_f32 v[18:19], v[18:19], v[26:27]
v_pk_mul_f32 v[26:27], v[24:25], s[62:63] op_sel:[0,0] op_sel_hi:[0,1] neg_lo:[0,0] neg_hi:[0,0]
v_pk_fma_f32 v[26:27], v[24:25], s[62:63], v[26:27] op_sel:[1,1,0] op_sel_hi:[1,0,1] neg_lo:[0,1,0] neg_hi:[0,0,0]
v_pk_add_f32 v[24:25], v[20:21], v[28:29] op_sel:[1,1] op_sel_hi:[0,0] neg_lo:[1,0] neg_hi:[0,1]
v_pk_add_f32 v[20:21], v[20:21], v[28:29]
v_pk_add_f32 v[28:29], v[22:23], v[30:31] neg_lo:[0,1] neg_hi:[0,1]
v_pk_add_f32 v[22:23], v[22:23], v[30:31]
v_pk_mul_f32 v[30:31], v[28:29], s[62:63] op_sel:[0,0] op_sel_hi:[0,1] neg_lo:[0,1] neg_hi:[0,0]
v_pk_fma_f32 v[30:31], v[28:29], s[62:63], v[30:31] op_sel:[1,1,0] op_sel_hi:[1,0,1] neg_lo:[0,1,0] neg_hi:[0,1,0]
v_pk_add_f32 v[28:29], v[64:65], v[32:33] neg_lo:[0,1] neg_hi:[0,1]
v_pk_add_f32 v[64:65], v[64:65], v[32:33]
v_pk_add_f32 v[32:33], v[34:35], v[42:43] neg_lo:[0,1] neg_hi:[0,1]
v_pk_add_f32 v[34:35], v[34:35], v[42:43]
v_pk_mul_f32 v[42:43], v[32:33], s[62:63] op_sel:[0,0] op_sel_hi:[0,1] neg_lo:[0,0] neg_hi:[0,0]
v_pk_fma_f32 v[42:43], v[32:33], s[62:63], v[42:43] op_sel:[1,1,0] op_sel_hi:[1,0,1] neg_lo:[0,1,0] neg_hi:[0,0,0]
v_pk_add_f32 v[32:33], v[36:37], v[44:45] op_sel:[1,1] op_sel_hi:[0,0] neg_lo:[1,0] neg_hi:[0,1]
v_pk_add_f32 v[36:37], v[36:37], v[44:45]
v_pk_add_f32 v[44:45], v[38:39], v[46:47] neg_lo:[0,1] neg_hi:[0,1]
v_pk_add_f32 v[38:39], v[38:39], v[46:47]
v_pk_mul_f32 v[46:47], v[44:45], s[62:63] op_sel:[0,0] op_sel_hi:[0,1] neg_lo:[0,1] neg_hi:[0,0]
v_pk_fma_f32 v[46:47], v[44:45], s[62:63], v[46:47] op_sel:[1,1,0] op_sel_hi:[1,0,1] neg_lo:[0,1,0] neg_hi:[0,1,0]
v_pk_add_f32 v[44:45], v[14:15], v[56:57] neg_lo:[0,1] neg_hi:[0,1]
v_pk_add_f32 v[14:15], v[14:15], v[56:57]
v_pk_add_f32 v[56:57], v[50:51], v[58:59] neg_lo:[0,1] neg_hi:[0,1]
v_pk_add_f32 v[50:51], v[50:51], v[58:59]
v_pk_mul_f32 v[58:59], v[56:57], s[62:63] op_sel:[0,0] op_sel_hi:[0,1] neg_lo:[0,0] neg_hi:[0,0]
v_pk_fma_f32 v[58:59], v[56:57], s[62:63], v[58:59] op_sel:[1,1,0] op_sel_hi:[1,0,1] neg_lo:[0,1,0] neg_hi:[0,0,0]
v_pk_add_f32 v[56:57], v[52:53], v[60:61] op_sel:[1,1] op_sel_hi:[0,0] neg_lo:[1,0] neg_hi:[0,1]
v_pk_add_f32 v[52:53], v[52:53], v[60:61]
v_pk_add_f32 v[60:61], v[54:55], v[62:63] neg_lo:[0,1] neg_hi:[0,1]
v_pk_add_f32 v[54:55], v[54:55], v[62:63]
v_pk_mul_f32 v[62:63], v[60:61], s[62:63] op_sel:[0,0] op_sel_hi:[0,1] neg_lo:[0,1] neg_hi:[0,0]
v_pk_fma_f32 v[62:63], v[60:61], s[62:63], v[62:63] op_sel:[1,1,0] op_sel_hi:[1,0,1] neg_lo:[0,1,0] neg_hi:[0,1,0]
v_pk_add_f32 v[60:61], v[40:41], v[48:49] neg_lo:[0,1] neg_hi:[0,1]
v_pk_add_f32 v[40:41], v[40:41], v[48:49]
v_pk_add_f32 v[48:49], v[66:67], v[74:75] neg_lo:[0,1] neg_hi:[0,1]
v_pk_add_f32 v[66:67], v[66:67], v[74:75]
v_pk_mul_f32 v[74:75], v[48:49], s[62:63] op_sel:[0,0] op_sel_hi:[0,1] neg_lo:[0,0] neg_hi:[0,0]
v_pk_fma_f32 v[74:75], v[48:49], s[62:63], v[74:75] op_sel:[1,1,0] op_sel_hi:[1,0,1] neg_lo:[0,1,0] neg_hi:[0,0,0]
v_pk_add_f32 v[48:49], v[68:69], v[76:77] op_sel:[1,1] op_sel_hi:[0,0] neg_lo:[1,0] neg_hi:[0,1]
v_pk_add_f32 v[68:69], v[68:69], v[76:77]
v_pk_add_f32 v[76:77], v[70:71], v[78:79] neg_lo:[0,1] neg_hi:[0,1]
v_pk_add_f32 v[70:71], v[70:71], v[78:79]
v_pk_mul_f32 v[78:79], v[76:77], s[62:63] op_sel:[0,0] op_sel_hi:[0,1] neg_lo:[0,1] neg_hi:[0,0]
v_pk_fma_f32 v[78:79], v[76:77], s[62:63], v[78:79] op_sel:[1,1,0] op_sel_hi:[1,0,1] neg_lo:[0,1,0] neg_hi:[0,1,0]
v_pk_add_f32 v[76:77], v[16:17], v[20:21] neg_lo:[0,1] neg_hi:[0,1]
v_pk_add_f32 v[16:17], v[16:17], v[20:21]
v_pk_add_f32 v[20:21], v[18:19], v[22:23] op_sel:[1,1] op_sel_hi:[0,0] neg_lo:[1,0] neg_hi:[0,1]
v_pk_add_f32 v[18:19], v[18:19], v[22:23]
v_pk_add_f32 v[22:23], v[72:73], v[24:25] neg_lo:[0,1] neg_hi:[0,1]
v_pk_add_f32 v[72:73], v[72:73], v[24:25]
v_pk_add_f32 v[24:25], v[26:27], v[30:31] op_sel:[1,1] op_sel_hi:[0,0] neg_lo:[1,0] neg_hi:[0,1]
v_pk_add_f32 v[26:27], v[26:27], v[30:31]
v_pk_add_f32 v[30:31], v[64:65], v[36:37] neg_lo:[0,1] neg_hi:[0,1]
v_pk_add_f32 v[64:65], v[64:65], v[36:37]
v_pk_add_f32 v[36:37], v[34:35], v[38:39] op_sel:[1,1] op_sel_hi:[0,0] neg_lo:[1,0] neg_hi:[0,1]
v_pk_add_f32 v[34:35], v[34:35], v[38:39]
v_pk_add_f32 v[38:39], v[28:29], v[32:33] neg_lo:[0,1] neg_hi:[0,1]
v_pk_add_f32 v[28:29], v[28:29], v[32:33]
v_pk_add_f32 v[32:33], v[42:43], v[46:47] op_sel:[1,1] op_sel_hi:[0,0] neg_lo:[1,0] neg_hi:[0,1]
v_pk_add_f32 v[42:43], v[42:43], v[46:47]
v_pk_add_f32 v[46:47], v[14:15], v[52:53] neg_lo:[0,1] neg_hi:[0,1]
v_pk_add_f32 v[14:15], v[14:15], v[52:53]
v_pk_add_f32 v[52:53], v[50:51], v[54:55] op_sel:[1,1] op_sel_hi:[0,0] neg_lo:[1,0] neg_hi:[0,1]
v_pk_add_f32 v[50:51], v[50:51], v[54:55]
v_pk_add_f32 v[54:55], v[44:45], v[56:57] neg_lo:[0,1] neg_hi:[0,1]
v_pk_add_f32 v[44:45], v[44:45], v[56:57]
v_pk_add_f32 v[56:57], v[58:59], v[62:63] op_sel:[1,1] op_sel_hi:[0,0] neg_lo:[1,0] neg_hi:[0,1]
v_pk_add_f32 v[58:59], v[58:59], v[62:63]
v_pk_add_f32 v[62:63], v[40:41], v[68:69] neg_lo:[0,1] neg_hi:[0,1]
v_pk_add_f32 v[40:41], v[40:41], v[68:69]
v_pk_add_f32 v[68:69], v[66:67], v[70:71] op_sel:[1,1] op_sel_hi:[0,0] neg_lo:[1,0] neg_hi:[0,1]
v_pk_add_f32 v[66:67], v[66:67], v[70:71]
v_pk_add_f32 v[70:71], v[60:61], v[48:49] neg_lo:[0,1] neg_hi:[0,1]
v_pk_add_f32 v[60:61], v[60:61], v[48:49]
v_pk_add_f32 v[48:49], v[74:75], v[78:79] op_sel:[1,1] op_sel_hi:[0,0] neg_lo:[1,0] neg_hi:[0,1]
v_pk_add_f32 v[74:75], v[74:75], v[78:79]
v_pk_add_f32 v[78:79], v[16:17], v[18:19] neg_lo:[0,1] neg_hi:[0,1]
v_pk_add_f32 v[16:17], v[16:17], v[18:19]
v_pk_add_f32 v[18:19], v[76:77], v[20:21] neg_lo:[0,1] neg_hi:[0,1]
v_pk_add_f32 v[76:77], v[76:77], v[20:21]
v_pk_add_f32 v[20:21], v[72:73], v[26:27] neg_lo:[0,1] neg_hi:[0,1]
v_pk_add_f32 v[72:73], v[72:73], v[26:27]
v_pk_add_f32 v[26:27], v[22:23], v[24:25] neg_lo:[0,1] neg_hi:[0,1]
v_pk_add_f32 v[22:23], v[22:23], v[24:25]
v_pk_add_f32 v[24:25], v[64:65], v[34:35] neg_lo:[0,1] neg_hi:[0,1]
v_pk_add_f32 v[64:65], v[64:65], v[34:35]
v_pk_add_f32 v[34:35], v[30:31], v[36:37] neg_lo:[0,1] neg_hi:[0,1]
v_pk_add_f32 v[30:31], v[30:31], v[36:37]
v_pk_add_f32 v[36:37], v[28:29], v[42:43] neg_lo:[0,1] neg_hi:[0,1]
v_pk_add_f32 v[28:29], v[28:29], v[42:43]
v_pk_add_f32 v[42:43], v[38:39], v[32:33] neg_lo:[0,1] neg_hi:[0,1]
v_pk_add_f32 v[38:39], v[38:39], v[32:33]
v_pk_add_f32 v[32:33], v[14:15], v[50:51] neg_lo:[0,1] neg_hi:[0,1]
v_pk_add_f32 v[14:15], v[14:15], v[50:51]
v_pk_add_f32 v[50:51], v[46:47], v[52:53] neg_lo:[0,1] neg_hi:[0,1]
v_pk_add_f32 v[46:47], v[46:47], v[52:53]
v_pk_add_f32 v[52:53], v[44:45], v[58:59] neg_lo:[0,1] neg_hi:[0,1]
v_pk_add_f32 v[44:45], v[44:45], v[58:59]
v_pk_add_f32 v[58:59], v[54:55], v[56:57] neg_lo:[0,1] neg_hi:[0,1]
v_pk_add_f32 v[54:55], v[54:55], v[56:57]
v_pk_add_f32 v[56:57], v[40:41], v[66:67] neg_lo:[0,1] neg_hi:[0,1]
v_pk_add_f32 v[40:41], v[40:41], v[66:67]
v_pk_add_f32 v[66:67], v[62:63], v[68:69] neg_lo:[0,1] neg_hi:[0,1]
v_pk_add_f32 v[62:63], v[62:63], v[68:69]
v_pk_add_f32 v[68:69], v[60:61], v[74:75] neg_lo:[0,1] neg_hi:[0,1]
v_pk_add_f32 v[60:61], v[60:61], v[74:75]
v_pk_add_f32 v[74:75], v[70:71], v[48:49] neg_lo:[0,1] neg_hi:[0,1]
v_pk_add_f32 v[70:71], v[70:71], v[48:49]
v_pk_mul_f32 v[48:49], v[14:15], v[82:83] op_sel:[0,0] op_sel_hi:[0,1] neg_lo:[0,0] neg_hi:[0,0]
v_pk_fma_f32 v[14:15], v[14:15], v[82:83], v[48:49] op_sel:[1,1,0] op_sel_hi:[1,0,1] neg_lo:[0,1,0] neg_hi:[0,0,0]
v_pk_mul_f32 v[48:49], v[64:65], v[84:85] op_sel:[0,0] op_sel_hi:[0,1] neg_lo:[0,0] neg_hi:[0,0]
v_pk_fma_f32 v[64:65], v[64:65], v[84:85], v[48:49] op_sel:[1,1,0] op_sel_hi:[1,0,1] neg_lo:[0,1,0] neg_hi:[0,0,0]
v_pk_mul_f32 v[48:49], v[40:41], v[86:87] op_sel:[0,0] op_sel_hi:[0,1] neg_lo:[0,0] neg_hi:[0,0]
v_pk_fma_f32 v[40:41], v[40:41], v[86:87], v[48:49] op_sel:[1,1,0] op_sel_hi:[1,0,1] neg_lo:[0,1,0] neg_hi:[0,0,0]
v_pk_mul_f32 v[48:49], v[72:73], v[88:89] op_sel:[0,0] op_sel_hi:[0,1] neg_lo:[0,0] neg_hi:[0,0]
v_pk_fma_f32 v[72:73], v[72:73], v[88:89], v[48:49] op_sel:[1,1,0] op_sel_hi:[1,0,1] neg_lo:[0,1,0] neg_hi:[0,0,0]
v_pk_mul_f32 v[48:49], v[44:45], v[90:91] op_sel:[0,0] op_sel_hi:[0,1] neg_lo:[0,0] neg_hi:[0,0]
v_pk_fma_f32 v[44:45], v[44:45], v[90:91], v[48:49] op_sel:[1,1,0] op_sel_hi:[1,0,1] neg_lo:[0,1,0] neg_hi:[0,0,0]
v_pk_mul_f32 v[48:49], v[28:29], v[92:93] op_sel:[0,0] op_sel_hi:[0,1] neg_lo:[0,0] neg_hi:[0,0]
v_pk_fma_f32 v[28:29], v[28:29], v[92:93], v[48:49] op_sel:[1,1,0] op_sel_hi:[1,0,1] neg_lo:[0,1,0] neg_hi:[0,0,0]
v_pk_mul_f32 v[48:49], v[60:61], v[94:95] op_sel:[0,0] op_sel_hi:[0,1] neg_lo:[0,0] neg_hi:[0,0]
v_pk_fma_f32 v[60:61], v[60:61], v[94:95], v[48:49] op_sel:[1,1,0] op_sel_hi:[1,0,1] neg_lo:[0,1,0] neg_hi:[0,0,0]
v_pk_mul_f32 v[48:49], v[76:77], v[96:97] op_sel:[0,0] op_sel_hi:[0,1] neg_lo:[0,0] neg_hi:[0,0]
v_pk_fma_f32 v[76:77], v[76:77], v[96:97], v[48:49] op_sel:[1,1,0] op_sel_hi:[1,0,1] neg_lo:[0,1,0] neg_hi:[0,0,0]
v_pk_mul_f32 v[48:49], v[46:47], v[98:99] op_sel:[0,0] op_sel_hi:[0,1] neg_lo:[0,0] neg_hi:[0,0]
v_pk_fma_f32 v[46:47], v[46:47], v[98:99], v[48:49] op_sel:[1,1,0] op_sel_hi:[1,0,1] neg_lo:[0,1,0] neg_hi:[0,0,0]
v_pk_mul_f32 v[48:49], v[30:31], v[100:101] op_sel:[0,0] op_sel_hi:[0,1] neg_lo:[0,0] neg_hi:[0,0]
v_pk_fma_f32 v[30:31], v[30:31], v[100:101], v[48:49] op_sel:[1,1,0] op_sel_hi:[1,0,1] neg_lo:[0,1,0] neg_hi:[0,0,0]
v_pk_mul_f32 v[48:49], v[62:63], v[102:103] op_sel:[0,0] op_sel_hi:[0,1] neg_lo:[0,0] neg_hi:[0,0]
v_pk_fma_f32 v[62:63], v[62:63], v[102:103], v[48:49] op_sel:[1,1,0] op_sel_hi:[1,0,1] neg_lo:[0,1,0] neg_hi:[0,0,0]
v_pk_mul_f32 v[48:49], v[22:23], v[104:105] op_sel:[0,0] op_sel_hi:[0,1] neg_lo:[0,0] neg_hi:[0,0]
v_pk_fma_f32 v[22:23], v[22:23], v[104:105], v[48:49] op_sel:[1,1,0] op_sel_hi:[1,0,1] neg_lo:[0,1,0] neg_hi:[0,0,0]
v_pk_mul_f32 v[48:49], v[54:55], v[106:107] op_sel:[0,0] op_sel_hi:[0,1] neg_lo:[0,0] neg_hi:[0,0]
v_pk_fma_f32 v[54:55], v[54:55], v[106:107], v[48:49] op_sel:[1,1,0] op_sel_hi:[1,0,1] neg_lo:[0,1,0] neg_hi:[0,0,0]
v_pk_mul_f32 v[48:49], v[38:39], v[108:109] op_sel:[0,0] op_sel_hi:[0,1] neg_lo:[0,0] neg_hi:[0,0]
v_pk_fma_f32 v[38:39], v[38:39], v[108:109], v[48:49] op_sel:[1,1,0] op_sel_hi:[1,0,1] neg_lo:[0,1,0] neg_hi:[0,0,0]
v_pk_mul_f32 v[48:49], v[70:71], v[110:111] op_sel:[0,0] op_sel_hi:[0,1] neg_lo:[0,0] neg_hi:[0,0]
v_pk_fma_f32 v[70:71], v[70:71], v[110:111], v[48:49] op_sel:[1,1,0] op_sel_hi:[1,0,1] neg_lo:[0,1,0] neg_hi:[0,0,0]
v_pk_mul_f32 v[48:49], v[78:79], v[112:113] op_sel:[0,0] op_sel_hi:[0,1] neg_lo:[0,0] neg_hi:[0,0]
v_pk_fma_f32 v[78:79], v[78:79], v[112:113], v[48:49] op_sel:[1,1,0] op_sel_hi:[1,0,1] neg_lo:[0,1,0] neg_hi:[0,0,0]
v_pk_mul_f32 v[48:49], v[32:33], v[114:115] op_sel:[0,0] op_sel_hi:[0,1] neg_lo:[0,0] neg_hi:[0,0]
v_pk_fma_f32 v[32:33], v[32:33], v[114:115], v[48:49] op_sel:[1,1,0] op_sel_hi:[1,0,1] neg_lo:[0,1,0] neg_hi:[0,0,0]
v_pk_mul_f32 v[48:49], v[24:25], v[116:117] op_sel:[0,0] op_sel_hi:[0,1] neg_lo:[0,0] neg_hi:[0,0]
v_pk_fma_f32 v[24:25], v[24:25], v[116:117], v[48:49] op_sel:[1,1,0] op_sel_hi:[1,0,1] neg_lo:[0,1,0] neg_hi:[0,0,0]
v_pk_mul_f32 v[48:49], v[56:57], v[118:119] op_sel:[0,0] op_sel_hi:[0,1] neg_lo:[0,0] neg_hi:[0,0]
v_pk_fma_f32 v[56:57], v[56:57], v[118:119], v[48:49] op_sel:[1,1,0] op_sel_hi:[1,0,1] neg_lo:[0,1,0] neg_hi:[0,0,0]
v_pk_mul_f32 v[48:49], v[20:21], v[120:121] op_sel:[0,0] op_sel_hi:[0,1] neg_lo:[0,0] neg_hi:[0,0]
v_pk_fma_f32 v[20:21], v[20:21], v[120:121], v[48:49] op_sel:[1,1,0] op_sel_hi:[1,0,1] neg_lo:[0,1,0] neg_hi:[0,0,0]
v_pk_mul_f32 v[48:49], v[52:53], v[122:123] op_sel:[0,0] op_sel_hi:[0,1] neg_lo:[0,0] neg_hi:[0,0]
v_pk_fma_f32 v[52:53], v[52:53], v[122:123], v[48:49] op_sel:[1,1,0] op_sel_hi:[1,0,1] neg_lo:[0,1,0] neg_hi:[0,0,0]
v_pk_mul_f32 v[48:49], v[36:37], v[124:125] op_sel:[0,0] op_sel_hi:[0,1] neg_lo:[0,0] neg_hi:[0,0]
v_pk_fma_f32 v[36:37], v[36:37], v[124:125], v[48:49] op_sel:[1,1,0] op_sel_hi:[1,0,1] neg_lo:[0,1,0] neg_hi:[0,0,0]
v_pk_mul_f32 v[48:49], v[68:69], v[126:127] op_sel:[0,0] op_sel_hi:[0,1] neg_lo:[0,0] neg_hi:[0,0]
v_pk_fma_f32 v[68:69], v[68:69], v[126:127], v[48:49] op_sel:[1,1,0] op_sel_hi:[1,0,1] neg_lo:[0,1,0] neg_hi:[0,0,0]
v_pk_mul_f32 v[48:49], v[18:19], v[128:129] op_sel:[0,0] op_sel_hi:[0,1] neg_lo:[0,0] neg_hi:[0,0]
v_pk_fma_f32 v[18:19], v[18:19], v[128:129], v[48:49] op_sel:[1,1,0] op_sel_hi:[1,0,1] neg_lo:[0,1,0] neg_hi:[0,0,0]
v_pk_mul_f32 v[48:49], v[50:51], v[130:131] op_sel:[0,0] op_sel_hi:[0,1] neg_lo:[0,0] neg_hi:[0,0]
v_pk_fma_f32 v[50:51], v[50:51], v[130:131], v[48:49] op_sel:[1,1,0] op_sel_hi:[1,0,1] neg_lo:[0,1,0] neg_hi:[0,0,0]
v_pk_mul_f32 v[48:49], v[34:35], v[132:133] op_sel:[0,0] op_sel_hi:[0,1] neg_lo:[0,0] neg_hi:[0,0]
v_pk_fma_f32 v[34:35], v[34:35], v[132:133], v[48:49] op_sel:[1,1,0] op_sel_hi:[1,0,1] neg_lo:[0,1,0] neg_hi:[0,0,0]
v_pk_mul_f32 v[48:49], v[66:67], v[134:135] op_sel:[0,0] op_sel_hi:[0,1] neg_lo:[0,0] neg_hi:[0,0]
v_pk_fma_f32 v[66:67], v[66:67], v[134:135], v[48:49] op_sel:[1,1,0] op_sel_hi:[1,0,1] neg_lo:[0,1,0] neg_hi:[0,0,0]
v_pk_mul_f32 v[48:49], v[26:27], v[136:137] op_sel:[0,0] op_sel_hi:[0,1] neg_lo:[0,0] neg_hi:[0,0]
v_pk_fma_f32 v[26:27], v[26:27], v[136:137], v[48:49] op_sel:[1,1,0] op_sel_hi:[1,0,1] neg_lo:[0,1,0] neg_hi:[0,0,0]
v_pk_mul_f32 v[48:49], v[58:59], v[138:139] op_sel:[0,0] op_sel_hi:[0,1] neg_lo:[0,0] neg_hi:[0,0]
v_pk_fma_f32 v[58:59], v[58:59], v[138:139], v[48:49] op_sel:[1,1,0] op_sel_hi:[1,0,1] neg_lo:[0,1,0] neg_hi:[0,0,0]
v_pk_mul_f32 v[48:49], v[42:43], v[140:141] op_sel:[0,0] op_sel_hi:[0,1] neg_lo:[0,0] neg_hi:[0,0]
v_pk_fma_f32 v[42:43], v[42:43], v[140:141], v[48:49] op_sel:[1,1,0] op_sel_hi:[1,0,1] neg_lo:[0,1,0] neg_hi:[0,0,0]
v_pk_mul_f32 v[48:49], v[74:75], v[142:143] op_sel:[0,0] op_sel_hi:[0,1] neg_lo:[0,0] neg_hi:[0,0]
v_pk_fma_f32 v[74:75], v[74:75], v[142:143], v[48:49] op_sel:[1,1,0] op_sel_hi:[1,0,1] neg_lo:[0,1,0] neg_hi:[0,0,0]
ds_write_b64 v4, v[16:17] offset:0
ds_write_b64 v4, v[14:15] offset:264
ds_write_b64 v4, v[64:65] offset:528
ds_write_b64 v4, v[40:41] offset:792
ds_write_b64 v4, v[72:73] offset:1056
ds_write_b64 v4, v[44:45] offset:1320
ds_write_b64 v4, v[28:29] offset:1584
ds_write_b64 v4, v[60:61] offset:1848
ds_write_b64 v4, v[76:77] offset:2112
ds_write_b64 v4, v[46:47] offset:2376
ds_write_b64 v4, v[30:31] offset:2640
ds_write_b64 v4, v[62:63] offset:2904
ds_write_b64 v4, v[22:23] offset:3168
ds_write_b64 v4, v[54:55] offset:3432
ds_write_b64 v4, v[38:39] offset:3696
ds_write_b64 v4, v[70:71] offset:3960
ds_write_b64 v4, v[78:79] offset:4224
ds_write_b64 v4, v[32:33] offset:4488
ds_write_b64 v4, v[24:25] offset:4752
ds_write_b64 v4, v[56:57] offset:5016
ds_write_b64 v4, v[20:21] offset:5280
ds_write_b64 v4, v[52:53] offset:5544
ds_write_b64 v4, v[36:37] offset:5808
ds_write_b64 v4, v[68:69] offset:6072
ds_write_b64 v4, v[18:19] offset:6336
ds_write_b64 v4, v[50:51] offset:6600
ds_write_b64 v4, v[34:35] offset:6864
ds_write_b64 v4, v[66:67] offset:7128
ds_write_b64 v4, v[26:27] offset:7392
ds_write_b64 v4, v[58:59] offset:7656
ds_write_b64 v4, v[42:43] offset:7920
ds_write_b64 v4, v[74:75] offset:8184
s_waitcnt lgkmcnt(0)
ds_read_b64 v[16:17], v5 offset:0
ds_read_b64 v[48:49], v5 offset:128
ds_read_b64 v[18:19], v5 offset:8
ds_read_b64 v[50:51], v5 offset:136
ds_read_b64 v[20:21], v5 offset:16
ds_read_b64 v[52:53], v5 offset:144
ds_read_b64 v[22:23], v5 offset:24
ds_read_b64 v[54:55], v5 offset:152
ds_read_b64 v[24:25], v5 offset:32
ds_read_b64 v[56:57], v5 offset:160
ds_read_b64 v[26:27], v5 offset:40
ds_read_b64 v[58:59], v5 offset:168
ds_read_b64 v[28:29], v5 offset:48
ds_read_b64 v[60:61], v5 offset:176
ds_read_b64 v[30:31], v5 offset:56
ds_read_b64 v[62:63], v5 offset:184
ds_read_b64 v[32:33], v5 offset:64
ds_read_b64 v[64:65], v5 offset:192
ds_read_b64 v[34:35], v5 offset:72
ds_read_b64 v[66:67], v5 offset:200
ds_read_b64 v[36:37], v5 offset:80
ds_read_b64 v[68:69], v5 offset:208
ds_read_b64 v[38:39], v5 offset:88
ds_read_b64 v[70:71], v5 offset:216
ds_read_b64 v[40:41], v5 offset:96
ds_read_b64 v[72:73], v5 offset:224
ds_read_b64 v[42:43], v5 offset:104
ds_read_b64 v[74:75], v5 offset:232
ds_read_b64 v[44:45], v5 offset:112
ds_read_b64 v[76:77], v5 offset:240
ds_read_b64 v[46:47], v5 offset:120
ds_read_b64 v[78:79], v5 offset:248
s_waitcnt lgkmcnt(0)
v_pk_add_f32 v[14:15], v[16:17], v[48:49] neg_lo:[0,1] neg_hi:[0,1]
v_pk_add_f32 v[16:17], v[16:17], v[48:49]
v_pk_add_f32 v[48:49], v[18:19], v[50:51] neg_lo:[0,1] neg_hi:[0,1]
v_pk_add_f32 v[18:19], v[18:19], v[50:51]
v_pk_mul_f32 v[50:51], v[48:49], s[50:51] op_sel:[0,0] op_sel_hi:[0,1] neg_lo:[0,0] neg_hi:[0,0]
v_pk_fma_f32 v[50:51], v[48:49], s[50:51], v[50:51] op_sel:[1,1,0] op_sel_hi:[1,0,1] neg_lo:[0,1,0] neg_hi:[0,0,0]
v_pk_add_f32 v[48:49], v[20:21], v[52:53] neg_lo:[0,1] neg_hi:[0,1]
v_pk_add_f32 v[20:21], v[20:21], v[52:53]
v_pk_mul_f32 v[52:53], v[48:49], s[54:55] op_sel:[0,0] op_sel_hi:[0,1] neg_lo:[0,0] neg_hi:[0,0]
v_pk_fma_f32 v[52:53], v[48:49], s[54:55], v[52:53] op_sel:[1,1,0] op_sel_hi:[1,0,1] neg_lo:[0,1,0] neg_hi:[0,0,0]
v_pk_add_f32 v[48:49], v[22:23], v[54:55] neg_lo:[0,1] neg_hi:[0,1]
v_pk_add_f32 v[22:23], v[22:23], v[54:55]
v_pk_mul_f32 v[54:55], v[48:49], s[58:59] op_sel:[0,0] op_sel_hi:[0,1] neg_lo:[0,0] neg_hi:[0,0]
v_pk_fma_f32 v[54:55], v[48:49], s[58:59], v[54:55] op_sel:[1,1,0] op_sel_hi:[1,0,1] neg_lo:[0,1,0] neg_hi:[0,0,0]
v_pk_add_f32 v[48:49], v[24:25], v[56:57] neg_lo:[0,1] neg_hi:[0,1]
v_pk_add_f32 v[24:25], v[24:25], v[56:57]
v_pk_mul_f32 v[56:57], v[48:49], s[62:63] op_sel:[0,0] op_sel_hi:[0,1] neg_lo:[0,0] neg_hi:[0,0]
v_pk_fma_f32 v[56:57], v[48:49], s[62:63], v[56:57] op_sel:[1,1,0] op_sel_hi:[1,0,1] neg_lo:[0,1,0] neg_hi:[0,0,0]
v_pk_add_f32 v[48:49], v[26:27], v[58:59] neg_lo:[0,1] neg_hi:[0,1]
v_pk_add_f32 v[26:27], v[26:27], v[58:59]
v_pk_mul_f32 v[58:59], v[48:49], s[58:59] op_sel:[0,1] op_sel_hi:[0,0] neg_lo:[0,0] neg_hi:[0,0]
v_pk_fma_f32 v[58:59], v[48:49], s[58:59], v[58:59] op_sel:[1,0,0] op_sel_hi:[1,1,1] neg_lo:[0,1,0] neg_hi:[0,0,0]
v_pk_add_f32 v[48:49], v[28:29], v[60:61] neg_lo:[0,1] neg_hi:[0,1]
v_pk_add_f32 v[28:29], v[28:29], v[60:61]
v_pk_mul_f32 v[60:61], v[48:49], s[54:55] op_sel:[0,1] op_sel_hi:[0,0] neg_lo:[0,0] neg_hi:[0,0]
v_pk_fma_f32 v[60:61], v[48:49], s[54:55], v[60:61] op_sel:[1,0,0] op_sel_hi:[1,1,1] neg_lo:[0,1,0] neg_hi:[0,0,0]
v_pk_add_f32 v[48:49], v[30:31], v[62:63] neg_lo:[0,1] neg_hi:[0,1]
v_pk_add_f32 v[30:31], v[30:31], v[62:63]
v_pk_mul_f32 v[62:63], v[48:49], s[50:51] op_sel:[0,1] op_sel_hi:[0,0] neg_lo:[0,0] neg_hi:[0,0]
v_pk_fma_f32 v[62:63], v[48:49], s[50:51], v[62:63] op_sel:[1,0,0] op_sel_hi:[1,1,1] neg_lo:[0,1,0] neg_hi:[0,0,0]
v_pk_add_f32 v[48:49], v[32:33], v[64:65] op_sel:[1,1] op_sel_hi:[0,0] neg_lo:[1,0] neg_hi:[0,1]
v_pk_add_f32 v[32:33], v[32:33], v[64:65]
v_pk_add_f32 v[64:65], v[34:35], v[66:67] neg_lo:[0,1] neg_hi:[0,1]
v_pk_add_f32 v[34:35], v[34:35], v[66:67]
v_pk_mul_f32 v[66:67], v[64:65], s[50:51] op_sel:[0,1] op_sel_hi:[0,0] neg_lo:[0,1] neg_hi:[0,0]
v_pk_fma_f32 v[66:67], v[64:65], s[50:51], v[66:67] op_sel:[1,0,0] op_sel_hi:[1,1,1] neg_lo:[0,1,0] neg_hi:[0,1,0]
v_pk_add_f32 v[64:65], v[36:37], v[68:69] neg_lo:[0,1] neg_hi:[0,1]
v_pk_add_f32 v[36:37], v[36:37], v[68:69]
v_pk_mul_f32 v[68:69], v[64:65], s[54:55] op_sel:[0,1] op_sel_hi:[0,0] neg_lo:[0,1] neg_hi:[0,0]
v_pk_fma_f32 v[68:69], v[64:65], s[54:55], v[68:69] op_sel:[1,0,0] op_sel_hi:[1,1,1] neg_lo:[0,1,0] neg_hi:[0,1,0]
v_pk_add_f32 v[64:65], v[38:39], v[70:71] neg_lo:[0,1] neg_hi:[0,1]
v_pk_add_f32 v[38:39], v[38:39], v[70:71]
v_pk_mul_f32 v[70:71], v[64:65], s[58:59] op_sel:[0,1] op_sel_hi:[0,0] neg_lo:[0,1] neg_hi:[0,0]
v_pk_fma_f32 v[70:71], v[64:65], s[58:59], v[70:71] op_sel:[1,0,0] op_sel_hi:[1,1,1] neg_lo:[0,1,0] neg_hi:[0,1,0]
v_pk_add_f32 v[64:65], v[40:41], v[72:73] neg_lo:[0,1] neg_hi:[0,1]
v_pk_add_f32 v[40:41], v[40:41], v[72:73]
v_pk_mul_f32 v[72:73], v[64:65], s[62:63] op_sel:[0,0] op_sel_hi:[0,1] neg_lo:[0,1] neg_hi:[0,0]
v_pk_fma_f32 v[72:73], v[64:65], s[62:63], v[72:73] op_sel:[1,1,0] op_sel_hi:[1,0,1] neg_lo:[0,1,0] neg_hi:[0,1,0]
v_pk_add_f32 v[64:65], v[42:43], v[74:75] neg_lo:[0,1] neg_hi:[0,1]
v_pk_add_f32 v[42:43], v[42:43], v[74:75]
v_pk_mul_f32 v[74:75], v[64:65], s[58:59] op_sel:[0,0] op_sel_hi:[0,1] neg_lo:[0,1] neg_hi:[0,0]
v_pk_fma_f32 v[74:75], v[64:65], s[58:59], v[74:75] op_sel:[1,1,0] op_sel_hi:[1,0,1] neg_lo:[0,1,0] neg_hi:[0,1,0]
v_pk_add_f32 v[64:65], v[44:45], v[76:77] neg_lo:[0,1] neg_hi:[0,1]
v_pk_add_f32 v[44:45], v[44:45], v[76:77]
v_pk_mul_f32 v[76:77], v[64:65], s[54:55] op_sel:[0,0] op_sel_hi:[0,1] neg_lo:[0,1] neg_hi:[0,0]
v_pk_fma_f32 v[76:77], v[64:65], s[54:55], v[76:77] op_sel:[1,1,0] op_sel_hi:[1,0,1] neg_lo:[0,1,0] neg_hi:[0,1,0]
v_pk_add_f32 v[64:65], v[46:47], v[78:79] neg_lo:[0,1] neg_hi:[0,1]
v_pk_add_f32 v[46:47], v[46:47], v[78:79]
v_pk_mul_f32 v[78:79], v[64:65], s[50:51] op_sel:[0,0] op_sel_hi:[0,1] neg_lo:[0,1] neg_hi:[0,0]
v_pk_fma_f32 v[78:79], v[64:65], s[50:51], v[78:79] op_sel:[1,1,0] op_sel_hi:[1,0,1] neg_lo:[0,1,0] neg_hi:[0,1,0]
v_pk_add_f32 v[64:65], v[16:17], v[32:33] neg_lo:[0,1] neg_hi:[0,1]
v_pk_add_f32 v[16:17], v[16:17], v[32:33]
v_pk_add_f32 v[32:33], v[18:19], v[34:35] neg_lo:[0,1] neg_hi:[0,1]
v_pk_add_f32 v[18:19], v[18:19], v[34:35]
v_pk_mul_f32 v[34:35], v[32:33], s[54:55] op_sel:[0,0] op_sel_hi:[0,1] neg_lo:[0,0] neg_hi:[0,0]
v_pk_fma_f32 v[34:35], v[32:33], s[54:55], v[34:35] op_sel:[1,1,0] op_sel_hi:[1,0,1] neg_lo:[0,1,0] neg_hi:[0,0,0]
v_pk_add_f32 v[32:33], v[20:21], v[36:37] neg_lo:[0,1] neg_hi:[0,1]
v_pk_add_f32 v[20:21], v[20:21], v[36:37]
v_pk_mul_f32 v[36:37], v[32:33], s[62:63] op_sel:[0,0] op_sel_hi:[0,1] neg_lo:[0,0] neg_hi:[0,0]
v_pk_fma_f32 v[36:37], v[32:33], s[62:63], v[36:37] op_sel:[1,1,0] op_sel_hi:[1,0,1] neg_lo:[0,1,0] neg_hi:[0,0,0]
v_pk_add_f32 v[32:33], v[22:23], v[38:39] neg_lo:[0,1] neg_hi:[0,1]
v_pk_add_f32 v[22:23], v[22:23], v[38:39]
v_pk_mul_f32 v[38:39], v[32:33], s[54:55] op_sel:[0,1] op_sel_hi:[0,0] neg_lo:[0,0] neg_hi:[0,0]
v_pk_fma_f32 v[38:39], v[32:33], s[54:55], v[38:39] op_sel:[1,0,0] op_sel_hi:[1,1,1] neg_lo:[0,1,0] neg_hi:[0,0,0]
v_pk_add_f32 v[32:33], v[24:25], v[40:41] op_sel:[1,1] op_sel_hi:[0,0] neg_lo:[1,0] neg_hi:[0,1]
v_pk_add_f32 v[24:25], v[24:25], v[40:41]
v_pk_add_f32 v[40:41], v[26:27], v[42:43] neg_lo:[0,1] neg_hi:[0,1]
v_pk_add_f32 v[26:27], v[26:27], v[42:43]
v_pk_mul_f32 v[42:43], v[40:41], s[54:55] op_sel:[0,1] op_sel_hi:[0,0] neg_lo:[0,1] neg_hi:[0,0]
v_pk_fma_f32 v[42:43], v[40:41], s[54:55], v[42:43] op_sel:[1,0,0] op_sel_hi:[1,1,1] neg_lo:[0,1,0] neg_hi:[0,1,0]
v_pk_add_f32 v[40:41], v[28:29], v[44:45] neg_lo:[0,1] neg_hi:[0,1]
v_pk_add_f32 v[28:29], v[28:29], v[44:45]
v_pk_mul_f32 v[44:45], v[40:41], s[62:63] op_sel:[0,0] op_sel_hi:[0,1] neg_lo:[0,1] neg_hi:[0,0]
v_pk_fma_f32 v[44:45], v[40:41], s[62:63], v[44:45] op_sel:[1,1,0] op_sel_hi:[1,0,1] neg_lo:[0,1,0] neg_hi:[0,1,0]
v_pk_add_f32 v[40:41], v[30:31], v[46:47] neg_lo:[0,1] neg_hi:[0,1]
v_pk_add_f32 v[30:31], v[30:31], v[46:47]
v_pk_mul_f32 v[46:47], v[40:41], s[54:55] op_sel:[0,0] op_sel_hi:[0,1] neg_lo:[0,1] neg_hi:[0,0]
v_pk_fma_f32 v[46:47], v[40:41], s[54:55], v[46:47] op_sel:[1,1,0] op_sel_hi:[1,0,1] neg_lo:[0,1,0] neg_hi:[0,1,0]
v_pk_add_f32 v[40:41], v[14:15], v[48:49] neg_lo:[0,1] neg_hi:[0,1]
v_pk_add_f32 v[14:15], v[14:15], v[48:49]
v_pk_add_f32 v[48:49], v[50:51], v[66:67] neg_lo:[0,1] neg_hi:[0,1]
v_pk_add_f32 v[50:51], v[50:51], v[66:67]
v_pk_mul_f32 v[66:67], v[48:49], s[54:55] op_sel:[0,0] op_sel_hi:[0,1] neg_lo:[0,0] neg_hi:[0,0]
v_pk_fma_f32 v[66:67], v[48:49], s[54:55], v[66:67] op_sel:[1,1,0] op_sel_hi:[1,0,1] neg_lo:[0,1,0] neg_hi:[0,0,0]
v_pk_add_f32 v[48:49], v[52:53], v[68:69] neg_lo:[0,1] neg_hi:[0,1]
v_pk_add_f32 v[52:53], v[52:53], v[68:69]
v_pk_mul_f32 v[68:69], v[48:49], s[62:63] op_sel:[0,0] op_sel_hi:[0,1] neg_lo:[0,0] neg_hi:[0,0]
v_pk_fma_f32 v[68:69], v[48:49], s[62:63], v[68:69] op_sel:[1,1,0] op_sel_hi:[1,0,1] neg_lo:[0,1,0] neg_hi:[0,0,0]
v_pk_add_f32 v[48:49], v[54:55], v[70:71] neg_lo:[0,1] neg_hi:[0,1]
v_pk_add_f32 v[54:55], v[54:55], v[70:71]
v_pk_mul_f32 v[70:71], v[48:49], s[54:55] op_sel:[0,1] op_sel_hi:[0,0] neg_lo:[0,0] neg_hi:[0,0]
v_pk_fma_f32 v[70:71], v[48:49], s[54:55], v[70:71] op_sel:[1,0,0] op_sel_hi:[1,1,1] neg_lo:[0,1,0] neg_hi:[0,0,0]
v_pk_add_f32 v[48:49], v[56:57], v[72:73] op_sel:[1,1] op_sel_hi:[0,0] neg_lo:[1,0] neg_hi:[0,1]
v_pk_add_f32 v[56:57], v[56:57], v[72:73]
v_pk_add_f32 v[72:73], v[58:59], v[74:75] neg_lo:[0,1] neg_hi:[0,1]
v_pk_add_f32 v[58:59], v[58:59], v[74:75]
v_pk_mul_f32 v[74:75], v[72:73], s[54:55] op_sel:[0,1] op_sel_hi:[0,0] neg_lo:[0,1] neg_hi:[0,0]
v_pk_fma_f32 v[74:75], v[72:73], s[54:55], v[74:75] op_sel:[1,0,0] op_sel_hi:[1,1,1] neg_lo:[0,1,0] neg_hi:[0,1,0]
v_pk_add_f32 v[72:73], v[60:61], v[76:77] neg_lo:[0,1] neg_hi:[0,1]
v_pk_add_f32 v[60:61], v[60:61], v[76:77]
v_pk_mul_f32 v[76:77], v[72:73], s[62:63] op_sel:[0,0] op_sel_hi:[0,1] neg_lo:[0,1] neg_hi:[0,0]
v_pk_fma_f32 v[76:77], v[72:73], s[62:63], v[76:77] op_sel:[1,1,0] op_sel_hi:[1,0,1] neg_lo:[0,1,0] neg_hi:[0,1,0]
v_pk_add_f32 v[72:73], v[62:63], v[78:79] neg_lo:[0,1] neg_hi:[0,1]
v_pk_add_f32 v[62:63], v[62:63], v[78:79]
v_pk_mul_f32 v[78:79], v[72:73], s[54:55] op_sel:[0,0] op_sel_hi:[0,1] neg_lo:[0,1] neg_hi:[0,0]
v_pk_fma_f32 v[78:79], v[72:73], s[54:55], v[78:79] op_sel:[1,1,0] op_sel_hi:[1,0,1] neg_lo:[0,1,0] neg_hi:[0,1,0]
v_pk_add_f32 v[72:73], v[16:17], v[24:25] neg_lo:[0,1] neg_hi:[0,1]
v_pk_add_f32 v[16:17], v[16:17], v[24:25]
v_pk_add_f32 v[24:25], v[18:19], v[26:27] neg_lo:[0,1] neg_hi:[0,1]
v_pk_add_f32 v[18:19], v[18:19], v[26:27]
v_pk_mul_f32 v[26:27], v[24:25], s[62:63] op_sel:[0,0] op_sel_hi:[0,1] neg_lo:[0,0] neg_hi:[0,0]
v_pk_fma_f32 v[26:27], v[24:25], s[62:63], v[26:27] op_sel:[1,1,0] op_sel_hi:[1,0,1] neg_lo:[0,1,0] neg_hi:[0,0,0]
v_pk_add_f32 v[24:25], v[20:21], v[28:29] op_sel:[1,1] op_sel_hi:[0,0] neg_lo:[1,0] neg_hi:[0,1]
v_pk_add_f32 v[20:21], v[20:21], v[28:29]
v_pk_add_f32 v[28:29], v[22:23], v[30:31] neg_lo:[0,1] neg_hi:[0,1]
v_pk_add_f32 v[22:23], v[22:23], v[30:31]
v_pk_mul_f32 v[30:31], v[28:29], s[62:63] op_sel:[0,0] op_sel_hi:[0,1] neg_lo:[0,1] neg_hi:[0,0]
v_pk_fma_f32 v[30:31], v[28:29], s[62:63], v[30:31] op_sel:[1,1,0] op_sel_hi:[1,0,1] neg_lo:[0,1,0] neg_hi:[0,1,0]
v_pk_add_f32 v[28:29], v[64:65], v[32:33] neg_lo:[0,1] neg_hi:[0,1]
v_pk_add_f32 v[64:65], v[64:65], v[32:33]
v_pk_add_f32 v[32:33], v[34:35], v[42:43] neg_lo:[0,1] neg_hi:[0,1]
v_pk_add_f32 v[34:35], v[34:35], v[42:43]
v_pk_mul_f32 v[42:43], v[32:33], s[62:63] op_sel:[0,0] op_sel_hi:[0,1] neg_lo:[0,0] neg_hi:[0,0]
v_pk_fma_f32 v[42:43], v[32:33], s[62:63], v[42:43] op_sel:[1,1,0] op_sel_hi:[1,0,1] neg_lo:[0,1,0] neg_hi:[0,0,0]
v_pk_add_f32 v[32:33], v[36:37], v[44:45] op_sel:[1,1] op_sel_hi:[0,0] neg_lo:[1,0] neg_hi:[0,1]
v_pk_add_f32 v[36:37], v[36:37], v[44:45]
v_pk_add_f32 v[44:45], v[38:39], v[46:47] neg_lo:[0,1] neg_hi:[0,1]
v_pk_add_f32 v[38:39], v[38:39], v[46:47]
v_pk_mul_f32 v[46:47], v[44:45], s[62:63] op_sel:[0,0] op_sel_hi:[0,1] neg_lo:[0,1] neg_hi:[0,0]
v_pk_fma_f32 v[46:47], v[44:45], s[62:63], v[46:47] op_sel:[1,1,0] op_sel_hi:[1,0,1] neg_lo:[0,1,0] neg_hi:[0,1,0]
v_pk_add_f32 v[44:45], v[14:15], v[56:57] neg_lo:[0,1] neg_hi:[0,1]
v_pk_add_f32 v[14:15], v[14:15], v[56:57]
v_pk_add_f32 v[56:57], v[50:51], v[58:59] neg_lo:[0,1] neg_hi:[0,1]
v_pk_add_f32 v[50:51], v[50:51], v[58:59]
v_pk_mul_f32 v[58:59], v[56:57], s[62:63] op_sel:[0,0] op_sel_hi:[0,1] neg_lo:[0,0] neg_hi:[0,0]
v_pk_fma_f32 v[58:59], v[56:57], s[62:63], v[58:59] op_sel:[1,1,0] op_sel_hi:[1,0,1] neg_lo:[0,1,0] neg_hi:[0,0,0]
v_pk_add_f32 v[56:57], v[52:53], v[60:61] op_sel:[1,1] op_sel_hi:[0,0] neg_lo:[1,0] neg_hi:[0,1]
v_pk_add_f32 v[52:53], v[52:53], v[60:61]
v_pk_add_f32 v[60:61], v[54:55], v[62:63] neg_lo:[0,1] neg_hi:[0,1]
v_pk_add_f32 v[54:55], v[54:55], v[62:63]
v_pk_mul_f32 v[62:63], v[60:61], s[62:63] op_sel:[0,0] op_sel_hi:[0,1] neg_lo:[0,1] neg_hi:[0,0]
v_pk_fma_f32 v[62:63], v[60:61], s[62:63], v[62:63] op_sel:[1,1,0] op_sel_hi:[1,0,1] neg_lo:[0,1,0] neg_hi:[0,1,0]
v_pk_add_f32 v[60:61], v[40:41], v[48:49] neg_lo:[0,1] neg_hi:[0,1]
v_pk_add_f32 v[40:41], v[40:41], v[48:49]
v_pk_add_f32 v[48:49], v[66:67], v[74:75] neg_lo:[0,1] neg_hi:[0,1]
v_pk_add_f32 v[66:67], v[66:67], v[74:75]
v_pk_mul_f32 v[74:75], v[48:49], s[62:63] op_sel:[0,0] op_sel_hi:[0,1] neg_lo:[0,0] neg_hi:[0,0]
v_pk_fma_f32 v[74:75], v[48:49], s[62:63], v[74:75] op_sel:[1,1,0] op_sel_hi:[1,0,1] neg_lo:[0,1,0] neg_hi:[0,0,0]
v_pk_add_f32 v[48:49], v[68:69], v[76:77] op_sel:[1,1] op_sel_hi:[0,0] neg_lo:[1,0] neg_hi:[0,1]
v_pk_add_f32 v[68:69], v[68:69], v[76:77]
v_pk_add_f32 v[76:77], v[70:71], v[78:79] neg_lo:[0,1] neg_hi:[0,1]
v_pk_add_f32 v[70:71], v[70:71], v[78:79]
v_pk_mul_f32 v[78:79], v[76:77], s[62:63] op_sel:[0,0] op_sel_hi:[0,1] neg_lo:[0,1] neg_hi:[0,0]
v_pk_fma_f32 v[78:79], v[76:77], s[62:63], v[78:79] op_sel:[1,1,0] op_sel_hi:[1,0,1] neg_lo:[0,1,0] neg_hi:[0,1,0]
v_pk_add_f32 v[76:77], v[16:17], v[20:21] neg_lo:[0,1] neg_hi:[0,1]
v_pk_add_f32 v[16:17], v[16:17], v[20:21]
v_pk_add_f32 v[20:21], v[18:19], v[22:23] op_sel:[1,1] op_sel_hi:[0,0] neg_lo:[1,0] neg_hi:[0,1]
v_pk_add_f32 v[18:19], v[18:19], v[22:23]
v_pk_add_f32 v[22:23], v[72:73], v[24:25] neg_lo:[0,1] neg_hi:[0,1]
v_pk_add_f32 v[72:73], v[72:73], v[24:25]
v_pk_add_f32 v[24:25], v[26:27], v[30:31] op_sel:[1,1] op_sel_hi:[0,0] neg_lo:[1,0] neg_hi:[0,1]
v_pk_add_f32 v[26:27], v[26:27], v[30:31]
v_pk_add_f32 v[30:31], v[64:65], v[36:37] neg_lo:[0,1] neg_hi:[0,1]
v_pk_add_f32 v[64:65], v[64:65], v[36:37]
v_pk_add_f32 v[36:37], v[34:35], v[38:39] op_sel:[1,1] op_sel_hi:[0,0] neg_lo:[1,0] neg_hi:[0,1]
v_pk_add_f32 v[34:35], v[34:35], v[38:39]
v_pk_add_f32 v[38:39], v[28:29], v[32:33] neg_lo:[0,1] neg_hi:[0,1]
v_pk_add_f32 v[28:29], v[28:29], v[32:33]
v_pk_add_f32 v[32:33], v[42:43], v[46:47] op_sel:[1,1] op_sel_hi:[0,0] neg_lo:[1,0] neg_hi:[0,1]
v_pk_add_f32 v[42:43], v[42:43], v[46:47]
v_pk_add_f32 v[46:47], v[14:15], v[52:53] neg_lo:[0,1] neg_hi:[0,1]
v_pk_add_f32 v[14:15], v[14:15], v[52:53]
v_pk_add_f32 v[52:53], v[50:51], v[54:55] op_sel:[1,1] op_sel_hi:[0,0] neg_lo:[1,0] neg_hi:[0,1]
v_pk_add_f32 v[50:51], v[50:51], v[54:55]
v_pk_add_f32 v[54:55], v[44:45], v[56:57] neg_lo:[0,1] neg_hi:[0,1]
v_pk_add_f32 v[44:45], v[44:45], v[56:57]
v_pk_add_f32 v[56:57], v[58:59], v[62:63] op_sel:[1,1] op_sel_hi:[0,0] neg_lo:[1,0] neg_hi:[0,1]
v_pk_add_f32 v[58:59], v[58:59], v[62:63]
v_pk_add_f32 v[62:63], v[40:41], v[68:69] neg_lo:[0,1] neg_hi:[0,1]
v_pk_add_f32 v[40:41], v[40:41], v[68:69]
v_pk_add_f32 v[68:69], v[66:67], v[70:71] op_sel:[1,1] op_sel_hi:[0,0] neg_lo:[1,0] neg_hi:[0,1]
v_pk_add_f32 v[66:67], v[66:67], v[70:71]
v_pk_add_f32 v[70:71], v[60:61], v[48:49] neg_lo:[0,1] neg_hi:[0,1]
v_pk_add_f32 v[60:61], v[60:61], v[48:49]
v_pk_add_f32 v[48:49], v[74:75], v[78:79] op_sel:[1,1] op_sel_hi:[0,0] neg_lo:[1,0] neg_hi:[0,1]
v_pk_add_f32 v[74:75], v[74:75], v[78:79]
v_pk_add_f32 v[78:79], v[16:17], v[18:19] neg_lo:[0,1] neg_hi:[0,1]
v_pk_add_f32 v[16:17], v[16:17], v[18:19]
v_pk_add_f32 v[18:19], v[76:77], v[20:21] neg_lo:[0,1] neg_hi:[0,1]
v_pk_add_f32 v[76:77], v[76:77], v[20:21]
v_pk_add_f32 v[20:21], v[72:73], v[26:27] neg_lo:[0,1] neg_hi:[0,1]
v_pk_add_f32 v[72:73], v[72:73], v[26:27]
v_pk_add_f32 v[26:27], v[22:23], v[24:25] neg_lo:[0,1] neg_hi:[0,1]
v_pk_add_f32 v[22:23], v[22:23], v[24:25]
v_pk_add_f32 v[24:25], v[64:65], v[34:35] neg_lo:[0,1] neg_hi:[0,1]
v_pk_add_f32 v[64:65], v[64:65], v[34:35]
v_pk_add_f32 v[34:35], v[30:31], v[36:37] neg_lo:[0,1] neg_hi:[0,1]
v_pk_add_f32 v[30:31], v[30:31], v[36:37]
v_pk_add_f32 v[36:37], v[28:29], v[42:43] neg_lo:[0,1] neg_hi:[0,1]
v_pk_add_f32 v[28:29], v[28:29], v[42:43]
v_pk_add_f32 v[42:43], v[38:39], v[32:33] neg_lo:[0,1] neg_hi:[0,1]
v_pk_add_f32 v[38:39], v[38:39], v[32:33]
v_pk_add_f32 v[32:33], v[14:15], v[50:51] neg_lo:[0,1] neg_hi:[0,1]
v_pk_add_f32 v[14:15], v[14:15], v[50:51]
v_pk_add_f32 v[50:51], v[46:47], v[52:53] neg_lo:[0,1] neg_hi:[0,1]
v_pk_add_f32 v[46:47], v[46:47], v[52:53]
v_pk_add_f32 v[52:53], v[44:45], v[58:59] neg_lo:[0,1] neg_hi:[0,1]
v_pk_add_f32 v[44:45], v[44:45], v[58:59]
v_pk_add_f32 v[58:59], v[54:55], v[56:57] neg_lo:[0,1] neg_hi:[0,1]
v_pk_add_f32 v[54:55], v[54:55], v[56:57]
v_pk_add_f32 v[56:57], v[40:41], v[66:67] neg_lo:[0,1] neg_hi:[0,1]
v_pk_add_f32 v[40:41], v[40:41], v[66:67]
v_pk_add_f32 v[66:67], v[62:63], v[68:69] neg_lo:[0,1] neg_hi:[0,1]
v_pk_add_f32 v[62:63], v[62:63], v[68:69]
v_pk_add_f32 v[68:69], v[60:61], v[74:75] neg_lo:[0,1] neg_hi:[0,1]
v_pk_add_f32 v[60:61], v[60:61], v[74:75]
v_pk_add_f32 v[74:75], v[70:71], v[48:49] neg_lo:[0,1] neg_hi:[0,1]
v_pk_add_f32 v[70:71], v[70:71], v[48:49]
ds_write2st64_b32 v12, v16, v17 offset0:0 offset1:16
ds_write_b32 v12, v14 offset:128
ds_write_b32 v12, v15 offset:4224
ds_write_b32 v12, v64 offset:256
ds_write_b32 v12, v65 offset:4352
ds_write_b32 v12, v40 offset:384
ds_write_b32 v12, v41 offset:4480
ds_write_b32 v12, v72 offset:512
ds_write_b32 v12, v73 offset:4608
ds_write_b32 v12, v44 offset:640
ds_write_b32 v12, v45 offset:4736
ds_write_b32 v12, v28 offset:768
ds_write_b32 v12, v29 offset:4864
ds_write_b32 v12, v60 offset:896
ds_write_b32 v12, v61 offset:4992
ds_write_b32 v12, v76 offset:1024
ds_write_b32 v12, v77 offset:5120
ds_write_b32 v12, v46 offset:1152
ds_write_b32 v12, v47 offset:5248
ds_write_b32 v12, v30 offset:1280
ds_write_b32 v12, v31 offset:5376
ds_write_b32 v12, v62 offset:1408
ds_write_b32 v12, v63 offset:5504
ds_write_b32 v12, v22 offset:1536
ds_write_b32 v12, v23 offset:5632
ds_write_b32 v12, v54 offset:1664
ds_write_b32 v12, v55 offset:5760
ds_write_b32 v12, v38 offset:1792
ds_write_b32 v12, v39 offset:5888
ds_write_b32 v12, v70 offset:1920
ds_write_b32 v12, v71 offset:6016
ds_write_b32 v12, v78 offset:2048
ds_write_b32 v12, v79 offset:6144
ds_write_b32 v12, v32 offset:2176
ds_write_b32 v12, v33 offset:6272
ds_write_b32 v12, v24 offset:2304
ds_write_b32 v12, v25 offset:6400
ds_write_b32 v12, v56 offset:2432
ds_write_b32 v12, v57 offset:6528
ds_write_b32 v12, v20 offset:2560
ds_write_b32 v12, v21 offset:6656
ds_write_b32 v12, v52 offset:2688
ds_write_b32 v12, v53 offset:6784
ds_write_b32 v12, v36 offset:2816
ds_write_b32 v12, v37 offset:6912
ds_write_b32 v12, v68 offset:2944
ds_write_b32 v12, v69 offset:7040
ds_write_b32 v12, v18 offset:3072
ds_write_b32 v12, v19 offset:7168
ds_write_b32 v12, v50 offset:3200
ds_write_b32 v12, v51 offset:7296
ds_write_b32 v12, v34 offset:3328
ds_write_b32 v12, v35 offset:7424
ds_write_b32 v12, v66 offset:3456
ds_write_b32 v12, v67 offset:7552
ds_write_b32 v12, v26 offset:3584
ds_write_b32 v12, v27 offset:7680
ds_write_b32 v12, v58 offset:3712
ds_write_b32 v12, v59 offset:7808
ds_write_b32 v12, v42 offset:3840
ds_write_b32 v12, v43 offset:7936
ds_write_b32 v12, v74 offset:3968
ds_write_b32 v12, v75 offset:8064
s_waitcnt lgkmcnt(0)
s_barrier
s_lshl_b32 s13, s93, 16
ds_read_b128 v[16:19], v2 offset:0
ds_read_b128 v[20:23], v2 offset:16
ds_read_b128 v[24:27], v2 offset:8448
ds_read_b128 v[28:31], v2 offset:8464
ds_read_b128 v[32:35], v2 offset:16896
ds_read_b128 v[36:39], v2 offset:16912
ds_read_b128 v[40:43], v2 offset:25344
ds_read_b128 v[44:47], v2 offset:25360
ds_read_b128 v[48:51], v2 offset:33792
ds_read_b128 v[52:55], v2 offset:33808
ds_read_b128 v[56:59], v2 offset:42240
ds_read_b128 v[60:63], v2 offset:42256
ds_read_b128 v[64:67], v2 offset:50688
ds_read_b128 v[68:71], v2 offset:50704
s_waitcnt lgkmcnt(12)
ds_read_b128 v[72:75], v2 offset:59136
ds_read_b128 v[76:79], v2 offset:59152
s_waitcnt lgkmcnt(14)
v_cvt_pk_bf16_f32 v216, v16, v17
v_cvt_pk_bf16_f32 v217, v18, v19
v_cvt_pk_bf16_f32 v218, v20, v21
v_cvt_pk_bf16_f32 v219, v22, v23
buffer_store_dwordx4 v[216:219], v3, s[4:7], s13 offen sc1
s_add_u32 s13, s13, 8192
s_waitcnt lgkmcnt(12)
v_cvt_pk_bf16_f32 v220, v24, v25
v_cvt_pk_bf16_f32 v221, v26, v27
v_cvt_pk_bf16_f32 v222, v28, v29
v_cvt_pk_bf16_f32 v223, v30, v31
buffer_store_dwordx4 v[220:223], v3, s[4:7], s13 offen sc1
s_add_u32 s13, s13, 8192
s_waitcnt lgkmcnt(10)
v_cvt_pk_bf16_f32 v224, v32, v33
v_cvt_pk_bf16_f32 v225, v34, v35
v_cvt_pk_bf16_f32 v226, v36, v37
v_cvt_pk_bf16_f32 v227, v38, v39
buffer_store_dwordx4 v[224:227], v3, s[4:7], s13 offen sc1
s_add_u32 s13, s13, 8192
s_waitcnt lgkmcnt(8)
v_cvt_pk_bf16_f32 v228, v40, v41
v_cvt_pk_bf16_f32 v229, v42, v43
v_cvt_pk_bf16_f32 v230, v44, v45
v_cvt_pk_bf16_f32 v231, v46, v47
buffer_store_dwordx4 v[228:231], v3, s[4:7], s13 offen sc1
s_add_u32 s13, s13, 8192
s_waitcnt lgkmcnt(6)
v_cvt_pk_bf16_f32 v232, v48, v49
v_cvt_pk_bf16_f32 v233, v50, v51
v_cvt_pk_bf16_f32 v234, v52, v53
v_cvt_pk_bf16_f32 v235, v54, v55
buffer_store_dwordx4 v[232:235], v3, s[4:7], s13 offen sc1
s_add_u32 s13, s13, 8192
s_waitcnt lgkmcnt(4)
v_cvt_pk_bf16_f32 v236, v56, v57
v_cvt_pk_bf16_f32 v237, v58, v59
v_cvt_pk_bf16_f32 v238, v60, v61
v_cvt_pk_bf16_f32 v239, v62, v63
buffer_store_dwordx4 v[236:239], v3, s[4:7], s13 offen sc1
s_add_u32 s13, s13, 8192
s_waitcnt lgkmcnt(2)
v_cvt_pk_bf16_f32 v240, v64, v65
v_cvt_pk_bf16_f32 v241, v66, v67
v_cvt_pk_bf16_f32 v242, v68, v69
v_cvt_pk_bf16_f32 v243, v70, v71
buffer_store_dwordx4 v[240:243], v3, s[4:7], s13 offen sc1
s_add_u32 s13, s13, 8192
s_waitcnt lgkmcnt(0)
v_cvt_pk_bf16_f32 v244, v72, v73
v_cvt_pk_bf16_f32 v245, v74, v75
v_cvt_pk_bf16_f32 v246, v76, v77
v_cvt_pk_bf16_f32 v247, v78, v79
buffer_store_dwordx4 v[244:247], v3, s[4:7], s13 offen sc1
s_add_u32 s13, s13, 8192
s_mov_b32 s93, s21
s_cmp_lt_u32 s93, 128
s_cbranch_scc1 mega_kernel_f3_l
mega_kernel_f3_e:
s_waitcnt vmcnt(0)
s_barrier
s_mov_b32 s64, 62
s_mov_b32 s65, 63
s_add_u32 s66, s66, 262144
s_mov_b32 s67, 1
s_cmp_eq_u32 s91, 0
s_cbranch_scc1 mega_kernel_out
s_mov_b32 s64, 63
s_mov_b32 s65, 64
s_lshr_b32 s66, s40, 2
s_lshl_b32 s66, s66, 17
s_and_b32 s67, s40, 3
s_lshl_b32 s67, s67, 12
s_add_u32 s66, s66, s67
s_add_u32 s66, s66, 68272128
s_mov_b32 s67, 1
s_mov_b32 s68, 4096
s_mov_b32 s69, 0
mega_kernel_out:
s_load_dwordx2 s[4:5], s[0:1], 40
s_load_dwordx2 s[8:9], s[0:1], 80
v_lshrrev_b32 v2, 6, v0
v_and_b32 v1, 63, v0
v_readfirstlane_b32 s41, v2
v_lshlrev_b32 v5, 4, v1
s_waitcnt lgkmcnt(0)
s_mov_b32 s6, 8388608
s_mov_b32 s7, 0x00020000
s_mov_b32 s10, 8388608
s_mov_b32 s11, 0x00020000
s_and_b32 s58, s40, 1
s_lshr_b32 s59, s40, 1
s_lshl_b32 s43, s58, 22
s_lshl_b32 s44, s41, 20
s_add_u32 s43, s43, s44
s_lshl_b32 s44, s59, 7
s_add_u32 s48, s43, s44
s_and_b32 s56, s59, 7
s_lshl_b32 s56, s56, 6
v_lshrrev_b32 v2, 3, v1
v_and_b32 v3, 7, v1
v_lshlrev_b32 v16, 11, v2
v_lshl_add_u32 v16, v3, 4, v16
v_add_u32 v16, s48, v16
v_and_b32 v3, 3, v1
s_lshl_b32 s45, s41, 15
v_bfe_u32 v17, v1, 2, 2
v_lshrrev_b32 v18, 5, v1
v_mul_u32_u24 v18, 4, v18
v_add_u32 v17, v17, v18
v_lshlrev_b32 v17, 7, v17
v_bfe_u32 v18, v1, 4, 1
v_lshl_add_u32 v17, v18, 5, v17
v_lshl_add_u32 v17, v3, 3, v17
v_add_u32 v17, s45, v17
s_add_u32 m0, s45, 0
s_add_u32 s44, s56, 0
s_and_b32 s44, s44, 511
s_lshl_b32 s44, s44, 11
buffer_load_dwordx4 v16, s[4:7], s44 offen lds
s_add_u32 m0, s45, 1024
s_add_u32 s44, s56, 8
s_and_b32 s44, s44, 511
s_lshl_b32 s44, s44, 11
buffer_load_dwordx4 v16, s[4:7], s44 offen lds
s_add_u32 m0, s45, 2048
s_add_u32 s44, s56, 16
s_and_b32 s44, s44, 511
s_lshl_b32 s44, s44, 11
buffer_load_dwordx4 v16, s[4:7], s44 offen lds
s_add_u32 m0, s45, 3072
s_add_u32 s44, s56, 24
s_and_b32 s44, s44, 511
s_lshl_b32 s44, s44, 11
buffer_load_dwordx4 v16, s[4:7], s44 offen lds
s_add_u32 m0, s45, 4096
s_add_u32 s44, s56, 32
s_and_b32 s44, s44, 511
s_lshl_b32 s44, s44, 11
buffer_load_dwordx4 v16, s[4:7], s44 offen lds
s_add_u32 m0, s45, 5120
s_add_u32 s44, s56, 40
s_and_b32 s44, s44, 511
s_lshl_b32 s44, s44, 11
buffer_load_dwordx4 v16, s[4:7], s44 offen lds
s_add_u32 m0, s45, 6144
s_add_u32 s44, s56, 48
s_and_b32 s44, s44, 511
s_lshl_b32 s44, s44, 11
buffer_load_dwordx4 v16, s[4:7], s44 offen lds
s_add_u32 m0, s45, 7168
s_add_u32 s44, s56, 56
s_and_b32 s44, s44, 511
s_lshl_b32 s44, s44, 11
buffer_load_dwordx4 v16, s[4:7], s44 offen lds
s_add_u32 m0, s45, 8192
s_add_u32 s44, s56, 64
s_and_b32 s44, s44, 511
s_lshl_b32 s44, s44, 11
buffer_load_dwordx4 v16, s[4:7], s44 offen lds
s_add_u32 m0, s45, 9216
s_add_u32 s44, s56, 72
s_and_b32 s44, s44, 511
s_lshl_b32 s44, s44, 11
buffer_load_dwordx4 v16, s[4:7], s44 offen lds
s_add_u32 m0, s45, 10240
s_add_u32 s44, s56, 80
s_and_b32 s44, s44, 511
s_lshl_b32 s44, s44, 11
buffer_load_dwordx4 v16, s[4:7], s44 offen lds
s_add_u32 m0, s45, 11264
s_add_u32 s44, s56, 88
s_and_b32 s44, s44, 511
s_lshl_b32 s44, s44, 11
buffer_load_dwordx4 v16, s[4:7], s44 offen lds
s_add_u32 m0, s45, 12288
s_add_u32 s44, s56, 96
s_and_b32 s44, s44, 511
s_lshl_b32 s44, s44, 11
buffer_load_dwordx4 v16, s[4:7], s44 offen lds
s_add_u32 m0, s45, 13312
s_add_u32 s44, s56, 104
s_and_b32 s44, s44, 511
s_lshl_b32 s44, s44, 11
buffer_load_dwordx4 v16, s[4:7], s44 offen lds
s_add_u32 m0, s45, 14336
s_add_u32 s44, s56, 112
s_and_b32 s44, s44, 511
s_lshl_b32 s44, s44, 11
buffer_load_dwordx4 v16, s[4:7], s44 offen lds
s_add_u32 m0, s45, 15360
s_add_u32 s44, s56, 120
s_and_b32 s44, s44, 511
s_lshl_b32 s44, s44, 11
buffer_load_dwordx4 v16, s[4:7], s44 offen lds
s_add_u32 m0, s45, 16384
s_add_u32 s44, s56, 128
s_and_b32 s44, s44, 511
s_lshl_b32 s44, s44, 11
buffer_load_dwordx4 v16, s[4:7], s44 offen lds
s_add_u32 m0, s45, 17408
s_add_u32 s44, s56, 136
s_and_b32 s44, s44, 511
s_lshl_b32 s44, s44, 11
buffer_load_dwordx4 v16, s[4:7], s44 offen lds
s_add_u32 m0, s45, 18432
s_add_u32 s44, s56, 144
s_and_b32 s44, s44, 511
s_lshl_b32 s44, s44, 11
buffer_load_dwordx4 v16, s[4:7], s44 offen lds
s_add_u32 m0, s45, 19456
s_add_u32 s44, s56, 152
s_and_b32 s44, s44, 511
s_lshl_b32 s44, s44, 11
buffer_load_dwordx4 v16, s[4:7], s44 offen lds
s_add_u32 m0, s45, 20480
s_add_u32 s44, s56, 160
s_and_b32 s44, s44, 511
s_lshl_b32 s44, s44, 11
buffer_load_dwordx4 v16, s[4:7], s44 offen lds
s_add_u32 m0, s45, 21504
s_add_u32 s44, s56, 168
s_and_b32 s44, s44, 511
s_lshl_b32 s44, s44, 11
buffer_load_dwordx4 v16, s[4:7], s44 offen lds
s_add_u32 m0, s45, 22528
s_add_u32 s44, s56, 176
s_and_b32 s44, s44, 511
s_lshl_b32 s44, s44, 11
buffer_load_dwordx4 v16, s[4:7], s44 offen lds
s_add_u32 m0, s45, 23552
s_add_u32 s44, s56, 184
s_and_b32 s44, s44, 511
s_lshl_b32 s44, s44, 11
buffer_load_dwordx4 v16, s[4:7], s44 offen lds
s_add_u32 m0, s45, 24576
s_add_u32 s44, s56, 192
s_and_b32 s44, s44, 511
s_lshl_b32 s44, s44, 11
buffer_load_dwordx4 v16, s[4:7], s44 offen lds
s_add_u32 m0, s45, 25600
s_add_u32 s44, s56, 200
s_and_b32 s44, s44, 511
s_lshl_b32 s44, s44, 11
buffer_load_dwordx4 v16, s[4:7], s44 offen lds
s_add_u32 m0, s45, 26624
s_add_u32 s44, s56, 208
s_and_b32 s44, s44, 511
s_lshl_b32 s44, s44, 11
buffer_load_dwordx4 v16, s[4:7], s44 offen lds
s_add_u32 m0, s45, 27648
s_add_u32 s44, s56, 216
s_and_b32 s44, s44, 511
s_lshl_b32 s44, s44, 11
buffer_load_dwordx4 v16, s[4:7], s44 offen lds
s_add_u32 m0, s45, 28672
s_add_u32 s44, s56, 224
s_and_b32 s44, s44, 511
s_lshl_b32 s44, s44, 11
buffer_load_dwordx4 v16, s[4:7], s44 offen lds
s_add_u32 m0, s45, 29696
s_add_u32 s44, s56, 232
s_and_b32 s44, s44, 511
s_lshl_b32 s44, s44, 11
buffer_load_dwordx4 v16, s[4:7], s44 offen lds
s_add_u32 m0, s45, 30720
s_add_u32 s44, s56, 240
s_and_b32 s44, s44, 511
s_lshl_b32 s44, s44, 11
buffer_load_dwordx4 v16, s[4:7], s44 offen lds
s_add_u32 m0, s45, 31744
s_add_u32 s44, s56, 248
s_and_b32 s44, s44, 511
s_lshl_b32 s44, s44, 11
buffer_load_dwordx4 v16, s[4:7], s44 offen lds
s_waitcnt vmcnt(16)
ds_read_b64_tr_b16 a[0:1], v17 offset:0
ds_read_b64_tr_b16 a[2:3], v17 offset:2048
ds_read_b64_tr_b16 a[4:5], v17 offset:64
ds_read_b64_tr_b16 a[6:7], v17 offset:2112
ds_read_b64_tr_b16 a[8:9], v17 offset:1024
ds_read_b64_tr_b16 a[10:11], v17 offset:3072
ds_read_b64_tr_b16 a[12:13], v17 offset:1088
ds_read_b64_tr_b16 a[14:15], v17 offset:3136
s_waitcnt lgkmcnt(0)
ds_read_b64_tr_b16 a[16:17], v17 offset:4096
ds_read_b64_tr_b16 a[18:19], v17 offset:6144
ds_read_b64_tr_b16 a[20:21], v17 offset:4160
ds_read_b64_tr_b16 a[22:23], v17 offset:6208
ds_read_b64_tr_b16 a[24:25], v17 offset:5120
ds_read_b64_tr_b16 a[26:27], v17 offset:7168
ds_read_b64_tr_b16 a[28:29], v17 offset:5184
ds_read_b64_tr_b16 a[30:31], v17 offset:7232
s_waitcnt lgkmcnt(0)
ds_read_b64_tr_b16 a[32:33], v17 offset:8192
ds_read_b64_tr_b16 a[34:35], v17 offset:10240
ds_read_b64_tr_b16 a[36:37], v17 offset:8256
ds_read_b64_tr_b16 a[38:39], v17 offset:10304
ds_read_b64_tr_b16 a[40:41], v17 offset:9216
ds_read_b64_tr_b16 a[42:43], v17 offset:11264
ds_read_b64_tr_b16 a[44:45], v17 offset:9280
ds_read_b64_tr_b16 a[46:47], v17 offset:11328
s_waitcnt lgkmcnt(0)
ds_read_b64_tr_b16 a[48:49], v17 offset:12288
ds_read_b64_tr_b16 a[50:51], v17 offset:14336
ds_read_b64_tr_b16 a[52:53], v17 offset:12352
ds_read_b64_tr_b16 a[54:55], v17 offset:14400
ds_read_b64_tr_b16 a[56:57], v17 offset:13312
ds_read_b64_tr_b16 a[58:59], v17 offset:15360
ds_read_b64_tr_b16 a[60:61], v17 offset:13376
ds_read_b64_tr_b16 a[62:63], v17 offset:15424
s_waitcnt lgkmcnt(0)
s_add_u32 m0, s45, 0
s_add_u32 s44, s56, 256
s_and_b32 s44, s44, 511
s_lshl_b32 s44, s44, 11
buffer_load_dwordx4 v16, s[4:7], s44 offen lds
s_add_u32 m0, s45, 1024
s_add_u32 s44, s56, 264
s_and_b32 s44, s44, 511
s_lshl_b32 s44, s44, 11
buffer_load_dwordx4 v16, s[4:7], s44 offen lds
s_add_u32 m0, s45, 2048
s_add_u32 s44, s56, 272
s_and_b32 s44, s44, 511
s_lshl_b32 s44, s44, 11
buffer_load_dwordx4 v16, s[4:7], s44 offen lds
s_add_u32 m0, s45, 3072
s_add_u32 s44, s56, 280
s_and_b32 s44, s44, 511
s_lshl_b32 s44, s44, 11
buffer_load_dwordx4 v16, s[4:7], s44 offen lds
s_add_u32 m0, s45, 4096
s_add_u32 s44, s56, 288
s_and_b32 s44, s44, 511
s_lshl_b32 s44, s44, 11
buffer_load_dwordx4 v16, s[4:7], s44 offen lds
s_add_u32 m0, s45, 5120
s_add_u32 s44, s56, 296
s_and_b32 s44, s44, 511
s_lshl_b32 s44, s44, 11
buffer_load_dwordx4 v16, s[4:7], s44 offen lds
s_add_u32 m0, s45, 6144
s_add_u32 s44, s56, 304
s_and_b32 s44, s44, 511
s_lshl_b32 s44, s44, 11
buffer_load_dwordx4 v16, s[4:7], s44 offen lds
s_add_u32 m0, s45, 7168
s_add_u32 s44, s56, 312
s_and_b32 s44, s44, 511
s_lshl_b32 s44, s44, 11
buffer_load_dwordx4 v16, s[4:7], s44 offen lds
s_add_u32 m0, s45, 8192
s_add_u32 s44, s56, 320
s_and_b32 s44, s44, 511
s_lshl_b32 s44, s44, 11
buffer_load_dwordx4 v16, s[4:7], s44 offen lds
s_add_u32 m0, s45, 9216
s_add_u32 s44, s56, 328
s_and_b32 s44, s44, 511
s_lshl_b32 s44, s44, 11
buffer_load_dwordx4 v16, s[4:7], s44 offen lds
s_add_u32 m0, s45, 10240
s_add_u32 s44, s56, 336
s_and_b32 s44, s44, 511
s_lshl_b32 s44, s44, 11
buffer_load_dwordx4 v16, s[4:7], s44 offen lds
s_add_u32 m0, s45, 11264
s_add_u32 s44, s56, 344
s_and_b32 s44, s44, 511
s_lshl_b32 s44, s44, 11
buffer_load_dwordx4 v16, s[4:7], s44 offen lds
s_add_u32 m0, s45, 12288
s_add_u32 s44, s56, 352
s_and_b32 s44, s44, 511
s_lshl_b32 s44, s44, 11
buffer_load_dwordx4 v16, s[4:7], s44 offen lds
s_add_u32 m0, s45, 13312
s_add_u32 s44, s56, 360
s_and_b32 s44, s44, 511
s_lshl_b32 s44, s44, 11
buffer_load_dwordx4 v16, s[4:7], s44 offen lds
s_add_u32 m0, s45, 14336
s_add_u32 s44, s56, 368
s_and_b32 s44, s44, 511
s_lshl_b32 s44, s44, 11
buffer_load_dwordx4 v16, s[4:7], s44 offen lds
s_add_u32 m0, s45, 15360
s_add_u32 s44, s56, 376
s_and_b32 s44, s44, 511
s_lshl_b32 s44, s44, 11
buffer_load_dwordx4 v16, s[4:7], s44 offen lds
s_waitcnt vmcnt(16)
ds_read_b64_tr_b16 a[64:65], v17 offset:16384
ds_read_b64_tr_b16 a[66:67], v17 offset:18432
ds_read_b64_tr_b16 a[68:69], v17 offset:16448
ds_read_b64_tr_b16 a[70:71], v17 offset:18496
ds_read_b64_tr_b16 a[72:73], v17 offset:17408
ds_read_b64_tr_b16 a[74:75], v17 offset:19456
ds_read_b64_tr_b16 a[76:77], v17 offset:17472
ds_read_b64_tr_b16 a[78:79], v17 offset:19520
s_waitcnt lgkmcnt(0)
ds_read_b64_tr_b16 a[80:81], v17 offset:20480
ds_read_b64_tr_b16 a[82:83], v17 offset:22528
ds_read_b64_tr_b16 a[84:85], v17 offset:20544
ds_read_b64_tr_b16 a[86:87], v17 offset:22592
ds_read_b64_tr_b16 a[88:89], v17 offset:21504
ds_read_b64_tr_b16 a[90:91], v17 offset:23552
ds_read_b64_tr_b16 a[92:93], v17 offset:21568
ds_read_b64_tr_b16 a[94:95], v17 offset:23616
s_waitcnt lgkmcnt(0)
ds_read_b64_tr_b16 a[96:97], v17 offset:24576
ds_read_b64_tr_b16 a[98:99], v17 offset:26624
ds_read_b64_tr_b16 a[100:101], v17 offset:24640
ds_read_b64_tr_b16 a[102:103], v17 offset:26688
ds_read_b64_tr_b16 a[104:105], v17 offset:25600
ds_read_b64_tr_b16 a[106:107], v17 offset:27648
ds_read_b64_tr_b16 a[108:109], v17 offset:25664
ds_read_b64_tr_b16 a[110:111], v17 offset:27712
s_waitcnt lgkmcnt(0)
ds_read_b64_tr_b16 a[112:113], v17 offset:28672
ds_read_b64_tr_b16 a[114:115], v17 offset:30720
ds_read_b64_tr_b16 a[116:117], v17 offset:28736
ds_read_b64_tr_b16 a[118:119], v17 offset:30784
ds_read_b64_tr_b16 a[120:121], v17 offset:29696
ds_read_b64_tr_b16 a[122:123], v17 offset:31744
ds_read_b64_tr_b16 a[124:125], v17 offset:29760
ds_read_b64_tr_b16 a[126:127], v17 offset:31808
s_waitcnt lgkmcnt(0)
s_add_u32 m0, s45, 16384
s_add_u32 s44, s56, 384
s_and_b32 s44, s44, 511
s_lshl_b32 s44, s44, 11
buffer_load_dwordx4 v16, s[4:7], s44 offen lds
s_add_u32 m0, s45, 17408
s_add_u32 s44, s56, 392
s_and_b32 s44, s44, 511
s_lshl_b32 s44, s44, 11
buffer_load_dwordx4 v16, s[4:7], s44 offen lds
s_add_u32 m0, s45, 18432
s_add_u32 s44, s56, 400
s_and_b32 s44, s44, 511
s_lshl_b32 s44, s44, 11
buffer_load_dwordx4 v16, s[4:7], s44 offen lds
s_add_u32 m0, s45, 19456
s_add_u32 s44, s56, 408
s_and_b32 s44, s44, 511
s_lshl_b32 s44, s44, 11
buffer_load_dwordx4 v16, s[4:7], s44 offen lds
s_add_u32 m0, s45, 20480
s_add_u32 s44, s56, 416
s_and_b32 s44, s44, 511
s_lshl_b32 s44, s44, 11
buffer_load_dwordx4 v16, s[4:7], s44 offen lds
s_add_u32 m0, s45, 21504
s_add_u32 s44, s56, 424
s_and_b32 s44, s44, 511
s_lshl_b32 s44, s44, 11
buffer_load_dwordx4 v16, s[4:7], s44 offen lds
s_add_u32 m0, s45, 22528
s_add_u32 s44, s56, 432
s_and_b32 s44, s44, 511
s_lshl_b32 s44, s44, 11
buffer_load_dwordx4 v16, s[4:7], s44 offen lds
s_add_u32 m0, s45, 23552
s_add_u32 s44, s56, 440
s_and_b32 s44, s44, 511
s_lshl_b32 s44, s44, 11
buffer_load_dwordx4 v16, s[4:7], s44 offen lds
s_add_u32 m0, s45, 24576
s_add_u32 s44, s56, 448
s_and_b32 s44, s44, 511
s_lshl_b32 s44, s44, 11
buffer_load_dwordx4 v16, s[4:7], s44 offen lds
s_add_u32 m0, s45, 25600
s_add_u32 s44, s56, 456
s_and_b32 s44, s44, 511
s_lshl_b32 s44, s44, 11
buffer_load_dwordx4 v16, s[4:7], s44 offen lds
s_add_u32 m0, s45, 26624
s_add_u32 s44, s56, 464
s_and_b32 s44, s44, 511
s_lshl_b32 s44, s44, 11
buffer_load_dwordx4 v16, s[4:7], s44 offen lds
s_add_u32 m0, s45, 27648
s_add_u32 s44, s56, 472
s_and_b32 s44, s44, 511
s_lshl_b32 s44, s44, 11
buffer_load_dwordx4 v16, s[4:7], s44 offen lds
s_add_u32 m0, s45, 28672
s_add_u32 s44, s56, 480
s_and_b32 s44, s44, 511
s_lshl_b32 s44, s44, 11
buffer_load_dwordx4 v16, s[4:7], s44 offen lds
s_add_u32 m0, s45, 29696
s_add_u32 s44, s56, 488
s_and_b32 s44, s44, 511
s_lshl_b32 s44, s44, 11
buffer_load_dwordx4 v16, s[4:7], s44 offen lds
s_add_u32 m0, s45, 30720
s_add_u32 s44, s56, 496
s_and_b32 s44, s44, 511
s_lshl_b32 s44, s44, 11
buffer_load_dwordx4 v16, s[4:7], s44 offen lds
s_add_u32 m0, s45, 31744
s_add_u32 s44, s56, 504
s_and_b32 s44, s44, 511
s_lshl_b32 s44, s44, 11
buffer_load_dwordx4 v16, s[4:7], s44 offen lds
s_waitcnt vmcnt(16)
ds_read_b64_tr_b16 a[128:129], v17 offset:0
ds_read_b64_tr_b16 a[130:131], v17 offset:2048
ds_read_b64_tr_b16 a[132:133], v17 offset:64
ds_read_b64_tr_b16 a[134:135], v17 offset:2112
ds_read_b64_tr_b16 a[136:137], v17 offset:1024
ds_read_b64_tr_b16 a[138:139], v17 offset:3072
ds_read_b64_tr_b16 a[140:141], v17 offset:1088
ds_read_b64_tr_b16 a[142:143], v17 offset:3136
s_waitcnt lgkmcnt(0)
ds_read_b64_tr_b16 a[144:145], v17 offset:4096
ds_read_b64_tr_b16 a[146:147], v17 offset:6144
ds_read_b64_tr_b16 a[148:149], v17 offset:4160
ds_read_b64_tr_b16 a[150:151], v17 offset:6208
ds_read_b64_tr_b16 a[152:153], v17 offset:5120
ds_read_b64_tr_b16 a[154:155], v17 offset:7168
ds_read_b64_tr_b16 a[156:157], v17 offset:5184
ds_read_b64_tr_b16 a[158:159], v17 offset:7232
s_waitcnt lgkmcnt(0)
ds_read_b64_tr_b16 a[160:161], v17 offset:8192
ds_read_b64_tr_b16 a[162:163], v17 offset:10240
ds_read_b64_tr_b16 a[164:165], v17 offset:8256
ds_read_b64_tr_b16 a[166:167], v17 offset:10304
ds_read_b64_tr_b16 a[168:169], v17 offset:9216
ds_read_b64_tr_b16 a[170:171], v17 offset:11264
ds_read_b64_tr_b16 a[172:173], v17 offset:9280
ds_read_b64_tr_b16 a[174:175], v17 offset:11328
s_waitcnt lgkmcnt(0)
ds_read_b64_tr_b16 a[176:177], v17 offset:12288
ds_read_b64_tr_b16 a[178:179], v17 offset:14336
ds_read_b64_tr_b16 a[180:181], v17 offset:12352
ds_read_b64_tr_b16 a[182:183], v17 offset:14400
ds_read_b64_tr_b16 a[184:185], v17 offset:13312
ds_read_b64_tr_b16 a[186:187], v17 offset:15360
ds_read_b64_tr_b16 a[188:189], v17 offset:13376
ds_read_b64_tr_b16 a[190:191], v17 offset:15424
s_waitcnt lgkmcnt(0)
s_waitcnt vmcnt(0)
ds_read_b64_tr_b16 a[192:193], v17 offset:16384
ds_read_b64_tr_b16 a[194:195], v17 offset:18432
ds_read_b64_tr_b16 a[196:197], v17 offset:16448
ds_read_b64_tr_b16 a[198:199], v17 offset:18496
ds_read_b64_tr_b16 a[200:201], v17 offset:17408
ds_read_b64_tr_b16 a[202:203], v17 offset:19456
ds_read_b64_tr_b16 a[204:205], v17 offset:17472
ds_read_b64_tr_b16 a[206:207], v17 offset:19520
s_waitcnt lgkmcnt(0)
ds_read_b64_tr_b16 a[208:209], v17 offset:20480
ds_read_b64_tr_b16 a[210:211], v17 offset:22528
ds_read_b64_tr_b16 a[212:213], v17 offset:20544
ds_read_b64_tr_b16 a[214:215], v17 offset:22592
ds_read_b64_tr_b16 a[216:217], v17 offset:21504
ds_read_b64_tr_b16 a[218:219], v17 offset:23552
ds_read_b64_tr_b16 a[220:221], v17 offset:21568
ds_read_b64_tr_b16 a[222:223], v17 offset:23616
s_waitcnt lgkmcnt(0)
ds_read_b64_tr_b16 a[224:225], v17 offset:24576
ds_read_b64_tr_b16 a[226:227], v17 offset:26624
ds_read_b64_tr_b16 a[228:229], v17 offset:24640
ds_read_b64_tr_b16 a[230:231], v17 offset:26688
ds_read_b64_tr_b16 a[232:233], v17 offset:25600
ds_read_b64_tr_b16 a[234:235], v17 offset:27648
ds_read_b64_tr_b16 a[236:237], v17 offset:25664
ds_read_b64_tr_b16 a[238:239], v17 offset:27712
s_waitcnt lgkmcnt(0)
ds_read_b64_tr_b16 a[240:241], v17 offset:28672
ds_read_b64_tr_b16 a[242:243], v17 offset:30720
ds_read_b64_tr_b16 a[244:245], v17 offset:28736
ds_read_b64_tr_b16 a[246:247], v17 offset:30784
ds_read_b64_tr_b16 a[248:249], v17 offset:29696
ds_read_b64_tr_b16 a[250:251], v17 offset:31744
ds_read_b64_tr_b16 a[252:253], v17 offset:29760
ds_read_b64_tr_b16 a[254:255], v17 offset:31808
s_waitcnt lgkmcnt(0)
s_barrier
s_lshl_b32 s56, s56, 6
s_lshl_b32 s43, s58, 17
s_lshl_b32 s44, s41, 15
s_add_u32 s43, s43, s44
s_add_u32 s43, s43, 134217728
v_add_u32 v6, s43, v5
v_and_b32 v2, 3, v1
v_lshlrev_b32 v7, 2, v2
v_bfe_u32 v2, v1, 2, 2
v_lshl_add_u32 v7, v2, 7, v7
s_lshl_b32 s43, s58, 11
s_lshl_b32 s44, s41, 9
s_add_u32 s43, s43, s44
s_lshl_b32 s44, s98, 13
s_add_u32 s43, s43, s44
s_add_u32 s43, s43, 69255168
v_add_u32 v7, s43, v7
s_mul_i32 s43, s41, 8704
v_lshrrev_b32 v2, 5, v1
v_lshl_add_u32 v8, v2, 5, v5
v_add_u32 v8, s43, v8
v_and_b32 v2, 7, v1
v_mul_u32_u24 v9, 544, v2
v_lshrrev_b32 v3, 3, v1
v_lshl_add_u32 v9, v3, 4, v9
s_lshl_b32 s43, s41, 7
v_add_u32 v9, s43, v9
s_mul_i32 s43, s58, 4352
s_sub_u32 s44, 4352, s43
v_add_u32 v10, s44, v9
v_add_u32 v9, s43, v9
s_lshl_b32 s43, s41, 15
s_lshl_b32 s44, s40, 6
s_add_u32 s43, s43, s44
v_lshlrev_b32 v11, 12, v3
v_and_b32 v2, 7, v1
v_lshl_add_u32 v11, v2, 3, v11
v_add_u32 v11, s43, v11
s_lshl_b32 s44, s41, 10
s_add_u32 s43, s66, s44
v_add_u32 v13, s43, v5
v_xor_b32 v12, s68, v13
s_mov_b32 s42, s64
s_mov_b32 s52, 0
s_mov_b32 s53, 0
s_mov_b32 s57, 0
s_mov_b32 s71, 1
s_cmp_eq_u32 s64, 0
s_cbranch_scc1 mega_kernel_o_nodry
s_mov_b32 s71, 0
s_mov_b32 s42, 0
s_mov_b32 s70, s65
s_mov_b32 s65, 1
v_mov_b32 v16, v12
v_mov_b32 v17, v11
v_mov_b32 v12, -16
v_mov_b32 v11, -16
mega_kernel_o_nodry:
mega_kernel_o_cold:
s_cmp_gt_i32 s52, s42
s_cbranch_scc1 mega_kernel_o_fk
mega_kernel_o_fw:
buffer_load_dword v2, v7, s[84:87], 0 offen sc1
s_waitcnt vmcnt(0)
v_min_i32_dpp v2, v2, v2 quad_perm:[1,0,3,2] row_mask:0xf bank_mask:0xf
s_nop 1
v_min_i32_dpp v2, v2, v2 quad_perm:[2,3,0,1] row_mask:0xf bank_mask:0xf
s_nop 1
v_min_i32_dpp v2, v2, v2 row_ror:4 row_mask:0xf bank_mask:0xf
s_nop 1
v_min_i32_dpp v2, v2, v2 row_ror:8 row_mask:0xf bank_mask:0xf
s_nop 0
v_readfirstlane_b32 s52, v2
s_min_i32 s52, s52, s65
s_cmp_gt_i32 s52, s42
s_cbranch_scc1 mega_kernel_o_fk
s_sleep 2
s_add_u32 s43, s52, 2
s_cmp_gt_i32 s43, s42
s_cbranch_scc1 mega_kernel_o_fw
s_sleep 48
s_branch mega_kernel_o_fw
mega_kernel_o_fk:
s_add_u32 s54, s42, 1
s_cmp_gt_i32 s52, s54
s_cbranch_scc0 mega_kernel_o_c0
s_lshl_b32 s50, s42, 18
s_add_u32 s51, s56, 0
s_and_b32 s51, s51, 0x7fff
s_add_u32 s51, s51, s50
buffer_load_dwordx4 v[96:99], v6, s[84:87], s51 offen offset:0 sc1
buffer_load_dwordx4 v[100:103], v6, s[84:87], s51 offen offset:1024 sc1
buffer_load_dwordx4 v[104:107], v6, s[84:87], s51 offen offset:2048 sc1
buffer_load_dwordx4 v[108:111], v6, s[84:87], s51 offen offset:3072 sc1
s_add_u32 s51, s56, 4096
s_and_b32 s51, s51, 0x7fff
s_add_u32 s51, s51, s50
buffer_load_dwordx4 v[112:115], v6, s[84:87], s51 offen offset:0 sc1
buffer_load_dwordx4 v[116:119], v6, s[84:87], s51 offen offset:1024 sc1
buffer_load_dwordx4 v[120:123], v6, s[84:87], s51 offen offset:2048 sc1
buffer_load_dwordx4 v[124:127], v6, s[84:87], s51 offen offset:3072 sc1
s_add_u32 s51, s56, 8192
s_and_b32 s51, s51, 0x7fff
s_add_u32 s51, s51, s50
buffer_load_dwordx4 v[128:131], v6, s[84:87], s51 offen offset:0 sc1
buffer_load_dwordx4 v[132:135], v6, s[84:87], s51 offen offset:1024 sc1
buffer_load_dwordx4 v[136:139], v6, s[84:87], s51 offen offset:2048 sc1
buffer_load_dwordx4 v[140:143], v6, s[84:87], s51 offen offset:3072 sc1
s_add_u32 s51, s56, 12288
s_and_b32 s51, s51, 0x7fff
s_add_u32 s51, s51, s50
buffer_load_dwordx4 v[144:147], v6, s[84:87], s51 offen offset:0 sc1
buffer_load_dwordx4 v[148:151], v6, s[84:87], s51 offen offset:1024 sc1
buffer_load_dwordx4 v[152:155], v6, s[84:87], s51 offen offset:2048 sc1
buffer_load_dwordx4 v[156:159], v6, s[84:87], s51 offen offset:3072 sc1
s_add_u32 s51, s56, 16384
s_and_b32 s51, s51, 0x7fff
s_add_u32 s51, s51, s50
buffer_load_dwordx4 v[160:163], v6, s[84:87], s51 offen offset:0 sc1
buffer_load_dwordx4 v[164:167], v6, s[84:87], s51 offen offset:1024 sc1
buffer_load_dwordx4 v[168:171], v6, s[84:87], s51 offen offset:2048 sc1
buffer_load_dwordx4 v[172:175], v6, s[84:87], s51 offen offset:3072 sc1
s_add_u32 s51, s56, 20480
s_and_b32 s51, s51, 0x7fff
s_add_u32 s51, s51, s50
buffer_load_dwordx4 v[176:179], v6, s[84:87], s51 offen offset:0 sc1
buffer_load_dwordx4 v[180:183], v6, s[84:87], s51 offen offset:1024 sc1
buffer_load_dwordx4 v[184:187], v6, s[84:87], s51 offen offset:2048 sc1
buffer_load_dwordx4 v[188:191], v6, s[84:87], s51 offen offset:3072 sc1
s_add_u32 s51, s56, 24576
s_and_b32 s51, s51, 0x7fff
s_add_u32 s51, s51, s50
buffer_load_dwordx4 v[192:195], v6, s[84:87], s51 offen offset:0 sc1
buffer_load_dwordx4 v[196:199], v6, s[84:87], s51 offen offset:1024 sc1
buffer_load_dwordx4 v[200:203], v6, s[84:87], s51 offen offset:2048 sc1
buffer_load_dwordx4 v[204:207], v6, s[84:87], s51 offen offset:3072 sc1
s_add_u32 s51, s56, 28672
s_and_b32 s51, s51, 0x7fff
s_add_u32 s51, s51, s50
buffer_load_dwordx4 v[208:211], v6, s[84:87], s51 offen offset:0 sc1
buffer_load_dwordx4 v[212:215], v6, s[84:87], s51 offen offset:1024 sc1
buffer_load_dwordx4 v[216:219], v6, s[84:87], s51 offen offset:2048 sc1
buffer_load_dwordx4 v[220:223], v6, s[84:87], s51 offen offset:3072 sc1
mega_kernel_o_w0:
s_add_u32 s54, s42, 1
s_sub_u32 s62, s42, 1
s_lshl_b32 s50, s54, 18
s_cmp_gt_i32 s52, s54
s_cbranch_scc0 mega_kernel_o_n0
s_waitcnt vmcnt(31)
v_mfma_f32_32x32x16_bf16 v[20:35], a[0:3], v[96:99], 0
v_mfma_f32_32x32x16_bf16 v[36:51], a[4:7], v[96:99], 0
s_add_u32 s51, s56, 0
s_and_b32 s51, s51, 0x7fff
s_add_u32 s51, s51, s50
buffer_load_dwordx4 v[96:99], v6, s[84:87], s51 offen offset:0 sc1
s_waitcnt vmcnt(31)
v_mfma_f32_32x32x16_bf16 v[20:35], a[8:11], v[100:103], v[20:35]
v_mfma_f32_32x32x16_bf16 v[36:51], a[12:15], v[100:103], v[36:51]
buffer_load_dwordx4 v[100:103], v6, s[84:87], s51 offen offset:1024 sc1
s_waitcnt vmcnt(31)
v_mfma_f32_32x32x16_bf16 v[20:35], a[16:19], v[104:107], v[20:35]
v_mfma_f32_32x32x16_bf16 v[36:51], a[20:23], v[104:107], v[36:51]
buffer_load_dwordx4 v[104:107], v6, s[84:87], s51 offen offset:2048 sc1
s_waitcnt vmcnt(31)
v_mfma_f32_32x32x16_bf16 v[20:35], a[24:27], v[108:111], v[20:35]
v_mfma_f32_32x32x16_bf16 v[36:51], a[28:31], v[108:111], v[36:51]
buffer_load_dwordx4 v[108:111], v6, s[84:87], s51 offen offset:3072 sc1
s_waitcnt vmcnt(31)
v_mfma_f32_32x32x16_bf16 v[20:35], a[32:35], v[112:115], v[20:35]
v_mfma_f32_32x32x16_bf16 v[36:51], a[36:39], v[112:115], v[36:51]
s_add_u32 s51, s56, 4096
s_and_b32 s51, s51, 0x7fff
s_add_u32 s51, s51, s50
buffer_load_dwordx4 v[112:115], v6, s[84:87], s51 offen offset:0 sc1
s_waitcnt vmcnt(31)
v_mfma_f32_32x32x16_bf16 v[20:35], a[40:43], v[116:119], v[20:35]
v_mfma_f32_32x32x16_bf16 v[36:51], a[44:47], v[116:119], v[36:51]
buffer_load_dwordx4 v[116:119], v6, s[84:87], s51 offen offset:1024 sc1
s_waitcnt vmcnt(31)
v_mfma_f32_32x32x16_bf16 v[20:35], a[48:51], v[120:123], v[20:35]
v_mfma_f32_32x32x16_bf16 v[36:51], a[52:55], v[120:123], v[36:51]
buffer_load_dwordx4 v[120:123], v6, s[84:87], s51 offen offset:2048 sc1
s_waitcnt vmcnt(31)
v_mfma_f32_32x32x16_bf16 v[20:35], a[56:59], v[124:127], v[20:35]
v_mfma_f32_32x32x16_bf16 v[36:51], a[60:63], v[124:127], v[36:51]
buffer_load_dwordx4 v[124:127], v6, s[84:87], s51 offen offset:3072 sc1
s_waitcnt vmcnt(31)
v_mfma_f32_32x32x16_bf16 v[20:35], a[64:67], v[128:131], v[20:35]
v_mfma_f32_32x32x16_bf16 v[36:51], a[68:71], v[128:131], v[36:51]
s_add_u32 s51, s56, 8192
s_and_b32 s51, s51, 0x7fff
s_add_u32 s51, s51, s50
buffer_load_dwordx4 v[128:131], v6, s[84:87], s51 offen offset:0 sc1
s_waitcnt vmcnt(31)
v_mfma_f32_32x32x16_bf16 v[20:35], a[72:75], v[132:135], v[20:35]
v_mfma_f32_32x32x16_bf16 v[36:51], a[76:79], v[132:135], v[36:51]
buffer_load_dwordx4 v[132:135], v6, s[84:87], s51 offen offset:1024 sc1
s_waitcnt vmcnt(31)
v_mfma_f32_32x32x16_bf16 v[20:35], a[80:83], v[136:139], v[20:35]
v_mfma_f32_32x32x16_bf16 v[36:51], a[84:87], v[136:139], v[36:51]
buffer_load_dwordx4 v[136:139], v6, s[84:87], s51 offen offset:2048 sc1
s_waitcnt vmcnt(31)
v_mfma_f32_32x32x16_bf16 v[20:35], a[88:91], v[140:143], v[20:35]
v_mfma_f32_32x32x16_bf16 v[36:51], a[92:95], v[140:143], v[36:51]
buffer_load_dwordx4 v[140:143], v6, s[84:87], s51 offen offset:3072 sc1
s_waitcnt vmcnt(31)
v_mfma_f32_32x32x16_bf16 v[20:35], a[96:99], v[144:147], v[20:35]
v_mfma_f32_32x32x16_bf16 v[36:51], a[100:103], v[144:147], v[36:51]
s_add_u32 s51, s56, 12288
s_and_b32 s51, s51, 0x7fff
s_add_u32 s51, s51, s50
buffer_load_dwordx4 v[144:147], v6, s[84:87], s51 offen offset:0 sc1
s_waitcnt vmcnt(31)
v_mfma_f32_32x32x16_bf16 v[20:35], a[104:107], v[148:151], v[20:35]
v_mfma_f32_32x32x16_bf16 v[36:51], a[108:111], v[148:151], v[36:51]
buffer_load_dwordx4 v[148:151], v6, s[84:87], s51 offen offset:1024 sc1
s_waitcnt vmcnt(31)
v_mfma_f32_32x32x16_bf16 v[20:35], a[112:115], v[152:155], v[20:35]
v_mfma_f32_32x32x16_bf16 v[36:51], a[116:119], v[152:155], v[36:51]
buffer_load_dwordx4 v[152:155], v6, s[84:87], s51 offen offset:2048 sc1
s_waitcnt vmcnt(31)
v_mfma_f32_32x32x16_bf16 v[20:35], a[120:123], v[156:159], v[20:35]
v_mfma_f32_32x32x16_bf16 v[36:51], a[124:127], v[156:159], v[36:51]
buffer_load_dwordx4 v[156:159], v6, s[84:87], s51 offen offset:3072 sc1
s_waitcnt vmcnt(31)
v_mfma_f32_32x32x16_bf16 v[20:35], a[128:131], v[160:163], v[20:35]
v_mfma_f32_32x32x16_bf16 v[36:51], a[132:135], v[160:163], v[36:51]
s_add_u32 s51, s56, 16384
s_and_b32 s51, s51, 0x7fff
s_add_u32 s51, s51, s50
buffer_load_dwordx4 v[160:163], v6, s[84:87], s51 offen offset:0 sc1
s_waitcnt vmcnt(31)
v_mfma_f32_32x32x16_bf16 v[20:35], a[136:139], v[164:167], v[20:35]
v_mfma_f32_32x32x16_bf16 v[36:51], a[140:143], v[164:167], v[36:51]
buffer_load_dwordx4 v[164:167], v6, s[84:87], s51 offen offset:1024 sc1
s_waitcnt vmcnt(31)
v_mfma_f32_32x32x16_bf16 v[20:35], a[144:147], v[168:171], v[20:35]
v_mfma_f32_32x32x16_bf16 v[36:51], a[148:151], v[168:171], v[36:51]
buffer_load_dwordx4 v[168:171], v6, s[84:87], s51 offen offset:2048 sc1
s_waitcnt vmcnt(31)
v_mfma_f32_32x32x16_bf16 v[20:35], a[152:155], v[172:175], v[20:35]
v_mfma_f32_32x32x16_bf16 v[36:51], a[156:159], v[172:175], v[36:51]
buffer_load_dwordx4 v[172:175], v6, s[84:87], s51 offen offset:3072 sc1
s_waitcnt vmcnt(31)
v_mfma_f32_32x32x16_bf16 v[20:35], a[160:163], v[176:179], v[20:35]
v_mfma_f32_32x32x16_bf16 v[36:51], a[164:167], v[176:179], v[36:51]
s_add_u32 s51, s56, 20480
s_and_b32 s51, s51, 0x7fff
s_add_u32 s51, s51, s50
buffer_load_dwordx4 v[176:179], v6, s[84:87], s51 offen offset:0 sc1
s_waitcnt vmcnt(31)
v_mfma_f32_32x32x16_bf16 v[20:35], a[168:171], v[180:183], v[20:35]
v_mfma_f32_32x32x16_bf16 v[36:51], a[172:175], v[180:183], v[36:51]
buffer_load_dwordx4 v[180:183], v6, s[84:87], s51 offen offset:1024 sc1
s_waitcnt vmcnt(31)
v_mfma_f32_32x32x16_bf16 v[20:35], a[176:179], v[184:187], v[20:35]
v_mfma_f32_32x32x16_bf16 v[36:51], a[180:183], v[184:187], v[36:51]
buffer_load_dwordx4 v[184:187], v6, s[84:87], s51 offen offset:2048 sc1
s_waitcnt vmcnt(31)
v_mfma_f32_32x32x16_bf16 v[20:35], a[184:187], v[188:191], v[20:35]
v_mfma_f32_32x32x16_bf16 v[36:51], a[188:191], v[188:191], v[36:51]
buffer_load_dwordx4 v[188:191], v6, s[84:87], s51 offen offset:3072 sc1
s_waitcnt vmcnt(31)
v_mfma_f32_32x32x16_bf16 v[20:35], a[192:195], v[192:195], v[20:35]
v_mfma_f32_32x32x16_bf16 v[36:51], a[196:199], v[192:195], v[36:51]
s_add_u32 s51, s56, 24576
s_and_b32 s51, s51, 0x7fff
s_add_u32 s51, s51, s50
buffer_load_dwordx4 v[192:195], v6, s[84:87], s51 offen offset:0 sc1
s_waitcnt vmcnt(31)
v_mfma_f32_32x32x16_bf16 v[20:35], a[200:203], v[196:199], v[20:35]
v_mfma_f32_32x32x16_bf16 v[36:51], a[204:207], v[196:199], v[36:51]
buffer_load_dwordx4 v[196:199], v6, s[84:87], s51 offen offset:1024 sc1
s_waitcnt vmcnt(31)
v_mfma_f32_32x32x16_bf16 v[20:35], a[208:211], v[200:203], v[20:35]
v_mfma_f32_32x32x16_bf16 v[36:51], a[212:215], v[200:203], v[36:51]
buffer_load_dwordx4 v[200:203], v6, s[84:87], s51 offen offset:2048 sc1
s_waitcnt vmcnt(31)
v_mfma_f32_32x32x16_bf16 v[20:35], a[216:219], v[204:207], v[20:35]
v_mfma_f32_32x32x16_bf16 v[36:51], a[220:223], v[204:207], v[36:51]
buffer_load_dwordx4 v[204:207], v6, s[84:87], s51 offen offset:3072 sc1
s_waitcnt vmcnt(31)
v_mfma_f32_32x32x16_bf16 v[20:35], a[224:227], v[208:211], v[20:35]
v_mfma_f32_32x32x16_bf16 v[36:51], a[228:231], v[208:211], v[36:51]
s_add_u32 s51, s56, 28672
s_and_b32 s51, s51, 0x7fff
s_add_u32 s51, s51, s50
buffer_load_dwordx4 v[208:211], v6, s[84:87], s51 offen offset:0 sc1
s_waitcnt vmcnt(31)
v_mfma_f32_32x32x16_bf16 v[20:35], a[232:235], v[212:215], v[20:35]
v_mfma_f32_32x32x16_bf16 v[36:51], a[236:239], v[212:215], v[36:51]
buffer_load_dwordx4 v[212:215], v6, s[84:87], s51 offen offset:1024 sc1
s_waitcnt vmcnt(31)
v_mfma_f32_32x32x16_bf16 v[20:35], a[240:243], v[216:219], v[20:35]
v_mfma_f32_32x32x16_bf16 v[36:51], a[244:247], v[216:219], v[36:51]
buffer_load_dwordx4 v[216:219], v6, s[84:87], s51 offen offset:2048 sc1
s_waitcnt vmcnt(31)
v_mfma_f32_32x32x16_bf16 v[224:239], a[248:251], v[220:223], v[20:35]
v_mfma_f32_32x32x16_bf16 v[240:255], a[252:255], v[220:223], v[36:51]
buffer_load_dwordx4 v[220:223], v6, s[84:87], s51 offen offset:3072 sc1
s_add_u32 s42, s42, 1
s_branch mega_kernel_o_w1
mega_kernel_o_n0:
s_waitcnt vmcnt(31)
v_mfma_f32_32x32x16_bf16 v[20:35], a[0:3], v[96:99], 0
v_mfma_f32_32x32x16_bf16 v[36:51], a[4:7], v[96:99], 0
s_waitcnt vmcnt(30)
v_mfma_f32_32x32x16_bf16 v[20:35], a[8:11], v[100:103], v[20:35]
v_mfma_f32_32x32x16_bf16 v[36:51], a[12:15], v[100:103], v[36:51]
s_waitcnt vmcnt(29)
v_mfma_f32_32x32x16_bf16 v[20:35], a[16:19], v[104:107], v[20:35]
v_mfma_f32_32x32x16_bf16 v[36:51], a[20:23], v[104:107], v[36:51]
s_waitcnt vmcnt(28)
v_mfma_f32_32x32x16_bf16 v[20:35], a[24:27], v[108:111], v[20:35]
v_mfma_f32_32x32x16_bf16 v[36:51], a[28:31], v[108:111], v[36:51]
s_waitcnt vmcnt(27)
v_mfma_f32_32x32x16_bf16 v[20:35], a[32:35], v[112:115], v[20:35]
v_mfma_f32_32x32x16_bf16 v[36:51], a[36:39], v[112:115], v[36:51]
s_waitcnt vmcnt(26)
v_mfma_f32_32x32x16_bf16 v[20:35], a[40:43], v[116:119], v[20:35]
v_mfma_f32_32x32x16_bf16 v[36:51], a[44:47], v[116:119], v[36:51]
s_waitcnt vmcnt(25)
v_mfma_f32_32x32x16_bf16 v[20:35], a[48:51], v[120:123], v[20:35]
v_mfma_f32_32x32x16_bf16 v[36:51], a[52:55], v[120:123], v[36:51]
s_waitcnt vmcnt(24)
v_mfma_f32_32x32x16_bf16 v[20:35], a[56:59], v[124:127], v[20:35]
v_mfma_f32_32x32x16_bf16 v[36:51], a[60:63], v[124:127], v[36:51]
s_waitcnt vmcnt(23)
v_mfma_f32_32x32x16_bf16 v[20:35], a[64:67], v[128:131], v[20:35]
v_mfma_f32_32x32x16_bf16 v[36:51], a[68:71], v[128:131], v[36:51]
s_waitcnt vmcnt(22)
v_mfma_f32_32x32x16_bf16 v[20:35], a[72:75], v[132:135], v[20:35]
v_mfma_f32_32x32x16_bf16 v[36:51], a[76:79], v[132:135], v[36:51]
s_waitcnt vmcnt(21)
v_mfma_f32_32x32x16_bf16 v[20:35], a[80:83], v[136:139], v[20:35]
v_mfma_f32_32x32x16_bf16 v[36:51], a[84:87], v[136:139], v[36:51]
s_waitcnt vmcnt(20)
v_mfma_f32_32x32x16_bf16 v[20:35], a[88:91], v[140:143], v[20:35]
v_mfma_f32_32x32x16_bf16 v[36:51], a[92:95], v[140:143], v[36:51]
s_waitcnt vmcnt(19)
v_mfma_f32_32x32x16_bf16 v[20:35], a[96:99], v[144:147], v[20:35]
v_mfma_f32_32x32x16_bf16 v[36:51], a[100:103], v[144:147], v[36:51]
s_waitcnt vmcnt(18)
v_mfma_f32_32x32x16_bf16 v[20:35], a[104:107], v[148:151], v[20:35]
v_mfma_f32_32x32x16_bf16 v[36:51], a[108:111], v[148:151], v[36:51]
s_waitcnt vmcnt(17)
v_mfma_f32_32x32x16_bf16 v[20:35], a[112:115], v[152:155], v[20:35]
v_mfma_f32_32x32x16_bf16 v[36:51], a[116:119], v[152:155], v[36:51]
s_waitcnt vmcnt(16)
v_mfma_f32_32x32x16_bf16 v[20:35], a[120:123], v[156:159], v[20:35]
v_mfma_f32_32x32x16_bf16 v[36:51], a[124:127], v[156:159], v[36:51]
s_waitcnt vmcnt(15)
v_mfma_f32_32x32x16_bf16 v[20:35], a[128:131], v[160:163], v[20:35]
v_mfma_f32_32x32x16_bf16 v[36:51], a[132:135], v[160:163], v[36:51]
s_waitcnt vmcnt(14)
v_mfma_f32_32x32x16_bf16 v[20:35], a[136:139], v[164:167], v[20:35]
v_mfma_f32_32x32x16_bf16 v[36:51], a[140:143], v[164:167], v[36:51]
s_waitcnt vmcnt(13)
v_mfma_f32_32x32x16_bf16 v[20:35], a[144:147], v[168:171], v[20:35]
v_mfma_f32_32x32x16_bf16 v[36:51], a[148:151], v[168:171], v[36:51]
s_waitcnt vmcnt(12)
v_mfma_f32_32x32x16_bf16 v[20:35], a[152:155], v[172:175], v[20:35]
v_mfma_f32_32x32x16_bf16 v[36:51], a[156:159], v[172:175], v[36:51]
s_waitcnt vmcnt(11)
v_mfma_f32_32x32x16_bf16 v[20:35], a[160:163], v[176:179], v[20:35]
v_mfma_f32_32x32x16_bf16 v[36:51], a[164:167], v[176:179], v[36:51]
buffer_load_dword v15, v7, s[84:87], 0 offen sc1
s_waitcnt vmcnt(10)
v_mfma_f32_32x32x16_bf16 v[20:35], a[168:171], v[180:183], v[20:35]
v_mfma_f32_32x32x16_bf16 v[36:51], a[172:175], v[180:183], v[36:51]
s_waitcnt vmcnt(9)
v_mfma_f32_32x32x16_bf16 v[20:35], a[176:179], v[184:187], v[20:35]
v_mfma_f32_32x32x16_bf16 v[36:51], a[180:183], v[184:187], v[36:51]
s_waitcnt vmcnt(8)
v_mfma_f32_32x32x16_bf16 v[20:35], a[184:187], v[188:191], v[20:35]
v_mfma_f32_32x32x16_bf16 v[36:51], a[188:191], v[188:191], v[36:51]
s_waitcnt vmcnt(7)
v_mfma_f32_32x32x16_bf16 v[20:35], a[192:195], v[192:195], v[20:35]
v_mfma_f32_32x32x16_bf16 v[36:51], a[196:199], v[192:195], v[36:51]
s_waitcnt vmcnt(6)
v_mfma_f32_32x32x16_bf16 v[20:35], a[200:203], v[196:199], v[20:35]
v_mfma_f32_32x32x16_bf16 v[36:51], a[204:207], v[196:199], v[36:51]
s_waitcnt vmcnt(5)
v_mfma_f32_32x32x16_bf16 v[20:35], a[208:211], v[200:203], v[20:35]
v_mfma_f32_32x32x16_bf16 v[36:51], a[212:215], v[200:203], v[36:51]
s_waitcnt vmcnt(4)
v_mfma_f32_32x32x16_bf16 v[20:35], a[216:219], v[204:207], v[20:35]
v_mfma_f32_32x32x16_bf16 v[36:51], a[220:223], v[204:207], v[36:51]
s_waitcnt vmcnt(3)
v_mfma_f32_32x32x16_bf16 v[20:35], a[224:227], v[208:211], v[20:35]
v_mfma_f32_32x32x16_bf16 v[36:51], a[228:231], v[208:211], v[36:51]
s_waitcnt vmcnt(2)
v_mfma_f32_32x32x16_bf16 v[20:35], a[232:235], v[212:215], v[20:35]
v_mfma_f32_32x32x16_bf16 v[36:51], a[236:239], v[212:215], v[36:51]
s_waitcnt vmcnt(1)
v_mfma_f32_32x32x16_bf16 v[20:35], a[240:243], v[216:219], v[20:35]
v_mfma_f32_32x32x16_bf16 v[36:51], a[244:247], v[216:219], v[36:51]
s_waitcnt vmcnt(0)
v_mfma_f32_32x32x16_bf16 v[224:239], a[248:251], v[220:223], v[20:35]
v_mfma_f32_32x32x16_bf16 v[240:255], a[252:255], v[220:223], v[36:51]
s_branch mega_kernel_o_imm
mega_kernel_o_w1:
s_add_u32 s54, s42, 1
s_sub_u32 s62, s42, 1
s_lshl_b32 s50, s54, 18
s_cmp_gt_i32 s52, s54
s_cbranch_scc0 mega_kernel_o_n1
s_waitcnt vmcnt(31)
v_mfma_f32_32x32x16_bf16 v[20:35], a[0:3], v[96:99], 0
v_mfma_f32_32x32x16_bf16 v[36:51], a[4:7], v[96:99], 0
s_add_u32 s51, s56, 0
s_and_b32 s51, s51, 0x7fff
s_add_u32 s51, s51, s50
buffer_load_dwordx4 v[96:99], v6, s[84:87], s51 offen offset:0 sc1
s_waitcnt vmcnt(31)
v_mfma_f32_32x32x16_bf16 v[20:35], a[8:11], v[100:103], v[20:35]
v_mfma_f32_32x32x16_bf16 v[36:51], a[12:15], v[100:103], v[36:51]
buffer_load_dwordx4 v[100:103], v6, s[84:87], s51 offen offset:1024 sc1
v_add_u32 v2, s53, v8
v_add_u32 v3, s53, v9
v_add_u32 v4, s53, v10
s_waitcnt vmcnt(31)
v_mfma_f32_32x32x16_bf16 v[20:35], a[16:19], v[104:107], v[20:35]
v_mfma_f32_32x32x16_bf16 v[36:51], a[20:23], v[104:107], v[36:51]
buffer_load_dwordx4 v[104:107], v6, s[84:87], s51 offen offset:2048 sc1
ds_write_b128 v2, v[224:227] offset:0
ds_write_b128 v2, v[228:231] offset:1088
s_waitcnt vmcnt(31)
v_mfma_f32_32x32x16_bf16 v[20:35], a[24:27], v[108:111], v[20:35]
v_mfma_f32_32x32x16_bf16 v[36:51], a[28:31], v[108:111], v[36:51]
buffer_load_dwordx4 v[108:111], v6, s[84:87], s51 offen offset:3072 sc1
ds_write_b128 v2, v[232:235] offset:2176
ds_write_b128 v2, v[236:239] offset:3264
s_waitcnt vmcnt(31)
v_mfma_f32_32x32x16_bf16 v[20:35], a[32:35], v[112:115], v[20:35]
v_mfma_f32_32x32x16_bf16 v[36:51], a[36:39], v[112:115], v[36:51]
s_add_u32 s51, s56, 4096
s_and_b32 s51, s51, 0x7fff
s_add_u32 s51, s51, s50
buffer_load_dwordx4 v[112:115], v6, s[84:87], s51 offen offset:0 sc1
ds_write_b128 v2, v[240:243] offset:4352
ds_write_b128 v2, v[244:247] offset:5440
s_waitcnt vmcnt(31)
v_mfma_f32_32x32x16_bf16 v[20:35], a[40:43], v[116:119], v[20:35]
v_mfma_f32_32x32x16_bf16 v[36:51], a[44:47], v[116:119], v[36:51]
buffer_load_dwordx4 v[116:119], v6, s[84:87], s51 offen offset:1024 sc1
ds_write_b128 v2, v[248:251] offset:6528
ds_write_b128 v2, v[252:255] offset:7616
s_waitcnt vmcnt(31)
v_mfma_f32_32x32x16_bf16 v[20:35], a[48:51], v[120:123], v[20:35]
v_mfma_f32_32x32x16_bf16 v[36:51], a[52:55], v[120:123], v[36:51]
buffer_load_dwordx4 v[120:123], v6, s[84:87], s51 offen offset:2048 sc1
s_waitcnt vmcnt(31)
v_mfma_f32_32x32x16_bf16 v[20:35], a[56:59], v[124:127], v[20:35]
v_mfma_f32_32x32x16_bf16 v[36:51], a[60:63], v[124:127], v[36:51]
buffer_load_dwordx4 v[124:127], v6, s[84:87], s51 offen offset:3072 sc1
s_waitcnt lgkmcnt(0)
s_barrier
ds_read_b128 v[52:55], v4 offset:0
ds_read_b128 v[56:59], v4 offset:8704
ds_read_b128 v[60:63], v4 offset:17408
ds_read_b128 v[64:67], v4 offset:26112
s_waitcnt vmcnt(31)
v_mfma_f32_32x32x16_bf16 v[20:35], a[64:67], v[128:131], v[20:35]
v_mfma_f32_32x32x16_bf16 v[36:51], a[68:71], v[128:131], v[36:51]
s_add_u32 s51, s56, 8192
s_and_b32 s51, s51, 0x7fff
s_add_u32 s51, s51, s50
buffer_load_dwordx4 v[128:131], v6, s[84:87], s51 offen offset:0 sc1
ds_read_b128 v[68:71], v3 offset:0
ds_read_b128 v[72:75], v3 offset:8704
ds_read_b128 v[76:79], v3 offset:17408
ds_read_b128 v[80:83], v3 offset:26112
s_sub_u32 s53, 34816, s53
s_bfe_u32 s61, s62, 0x10001
s_xor_b32 s61, s61, s67
s_and_b32 s60, s62, s69
s_lshl_b32 s60, s60, 12
s_waitcnt vmcnt(31)
v_mfma_f32_32x32x16_bf16 v[20:35], a[72:75], v[132:135], v[20:35]
v_mfma_f32_32x32x16_bf16 v[36:51], a[76:79], v[132:135], v[36:51]
buffer_load_dwordx4 v[132:135], v6, s[84:87], s51 offen offset:1024 sc1
s_waitcnt vmcnt(31)
v_mfma_f32_32x32x16_bf16 v[20:35], a[80:83], v[136:139], v[20:35]
v_mfma_f32_32x32x16_bf16 v[36:51], a[84:87], v[136:139], v[36:51]
buffer_load_dwordx4 v[136:139], v6, s[84:87], s51 offen offset:2048 sc1
s_waitcnt lgkmcnt(4)
v_add_f32 v52, v52, v56
v_add_f32 v60, v60, v64
v_add_f32 v53, v53, v57
v_add_f32 v61, v61, v65
v_add_f32 v54, v54, v58
v_add_f32 v62, v62, v66
v_add_f32 v55, v55, v59
v_add_f32 v63, v63, v67
s_waitcnt vmcnt(31)
v_mfma_f32_32x32x16_bf16 v[20:35], a[88:91], v[140:143], v[20:35]
v_mfma_f32_32x32x16_bf16 v[36:51], a[92:95], v[140:143], v[36:51]
buffer_load_dwordx4 v[140:143], v6, s[84:87], s51 offen offset:3072 sc1
v_add_f32 v52, v52, v60
v_add_f32 v53, v53, v61
v_add_f32 v54, v54, v62
v_add_f32 v55, v55, v63
v_and_or_b32 v52, v52, -2, s61
s_cmp_eq_u32 s95, 0
s_cbranch_scc1 mega_kernel_o_sa1
buffer_store_dwordx4 v[52:55], v12, s[84:87], s60 offen sc1
s_branch mega_kernel_o_sb1
mega_kernel_o_sa1:
buffer_store_dwordx4 v[52:55], v12, s[84:87], s60 offen
mega_kernel_o_sb1:
s_waitcnt vmcnt(31)
v_mfma_f32_32x32x16_bf16 v[20:35], a[96:99], v[144:147], v[20:35]
v_mfma_f32_32x32x16_bf16 v[36:51], a[100:103], v[144:147], v[36:51]
s_add_u32 s51, s56, 12288
s_and_b32 s51, s51, 0x7fff
s_add_u32 s51, s51, s50
buffer_load_dwordx4 v[144:147], v6, s[84:87], s51 offen offset:0 sc1
s_waitcnt lgkmcnt(0)
v_add_f32 v68, v68, v72
v_add_f32 v76, v76, v80
v_add_f32 v69, v69, v73
v_add_f32 v77, v77, v81
v_add_f32 v70, v70, v74
v_add_f32 v78, v78, v82
v_add_f32 v71, v71, v75
v_add_f32 v79, v79, v83
s_waitcnt vmcnt(31)
v_mfma_f32_32x32x16_bf16 v[20:35], a[104:107], v[148:151], v[20:35]
v_mfma_f32_32x32x16_bf16 v[36:51], a[108:111], v[148:151], v[36:51]
buffer_load_dwordx4 v[148:151], v6, s[84:87], s51 offen offset:1024 sc1
v_add_f32 v84, v68, v76
v_add_f32 v85, v69, v77
v_add_f32 v86, v70, v78
v_add_f32 v87, v71, v79
s_waitcnt vmcnt(31)
v_mfma_f32_32x32x16_bf16 v[20:35], a[112:115], v[152:155], v[20:35]
v_mfma_f32_32x32x16_bf16 v[36:51], a[116:119], v[152:155], v[36:51]
buffer_load_dwordx4 v[152:155], v6, s[84:87], s51 offen offset:2048 sc1
s_waitcnt vmcnt(31)
v_mfma_f32_32x32x16_bf16 v[20:35], a[120:123], v[156:159], v[20:35]
v_mfma_f32_32x32x16_bf16 v[36:51], a[124:127], v[156:159], v[36:51]
buffer_load_dwordx4 v[156:159], v6, s[84:87], s51 offen offset:3072 sc1
s_waitcnt vmcnt(31)
v_mfma_f32_32x32x16_bf16 v[20:35], a[128:131], v[160:163], v[20:35]
v_mfma_f32_32x32x16_bf16 v[36:51], a[132:135], v[160:163], v[36:51]
s_add_u32 s51, s56, 16384
s_and_b32 s51, s51, 0x7fff
s_add_u32 s51, s51, s50
buffer_load_dwordx4 v[160:163], v6, s[84:87], s51 offen offset:0 sc1
s_waitcnt vmcnt(31)
v_mfma_f32_32x32x16_bf16 v[20:35], a[136:139], v[164:167], v[20:35]
v_mfma_f32_32x32x16_bf16 v[36:51], a[140:143], v[164:167], v[36:51]
buffer_load_dwordx4 v[164:167], v6, s[84:87], s51 offen offset:1024 sc1
s_waitcnt vmcnt(31)
v_mfma_f32_32x32x16_bf16 v[20:35], a[144:147], v[168:171], v[20:35]
v_mfma_f32_32x32x16_bf16 v[36:51], a[148:151], v[168:171], v[36:51]
buffer_load_dwordx4 v[168:171], v6, s[84:87], s51 offen offset:2048 sc1
s_waitcnt vmcnt(31)
v_mfma_f32_32x32x16_bf16 v[20:35], a[152:155], v[172:175], v[20:35]
v_mfma_f32_32x32x16_bf16 v[36:51], a[156:159], v[172:175], v[36:51]
buffer_load_dwordx4 v[172:175], v6, s[84:87], s51 offen offset:3072 sc1
s_waitcnt vmcnt(31)
v_mfma_f32_32x32x16_bf16 v[20:35], a[160:163], v[176:179], v[20:35]
v_mfma_f32_32x32x16_bf16 v[36:51], a[164:167], v[176:179], v[36:51]
s_add_u32 s51, s56, 20480
s_and_b32 s51, s51, 0x7fff
s_add_u32 s51, s51, s50
buffer_load_dwordx4 v[176:179], v6, s[84:87], s51 offen offset:0 sc1
s_waitcnt vmcnt(31)
v_mfma_f32_32x32x16_bf16 v[20:35], a[168:171], v[180:183], v[20:35]
v_mfma_f32_32x32x16_bf16 v[36:51], a[172:175], v[180:183], v[36:51]
buffer_load_dwordx4 v[180:183], v6, s[84:87], s51 offen offset:1024 sc1
s_waitcnt vmcnt(31)
v_mfma_f32_32x32x16_bf16 v[20:35], a[176:179], v[184:187], v[20:35]
v_mfma_f32_32x32x16_bf16 v[36:51], a[180:183], v[184:187], v[36:51]
buffer_load_dwordx4 v[184:187], v6, s[84:87], s51 offen offset:2048 sc1
s_waitcnt vmcnt(31)
v_mfma_f32_32x32x16_bf16 v[20:35], a[184:187], v[188:191], v[20:35]
v_mfma_f32_32x32x16_bf16 v[36:51], a[188:191], v[188:191], v[36:51]
buffer_load_dwordx4 v[188:191], v6, s[84:87], s51 offen offset:3072 sc1
s_waitcnt vmcnt(31)
v_mfma_f32_32x32x16_bf16 v[20:35], a[192:195], v[192:195], v[20:35]
v_mfma_f32_32x32x16_bf16 v[36:51], a[196:199], v[192:195], v[36:51]
s_add_u32 s51, s56, 24576
s_and_b32 s51, s51, 0x7fff
s_add_u32 s51, s51, s50
buffer_load_dwordx4 v[192:195], v6, s[84:87], s51 offen offset:0 sc1
s_waitcnt vmcnt(31)
v_mfma_f32_32x32x16_bf16 v[20:35], a[200:203], v[196:199], v[20:35]
v_mfma_f32_32x32x16_bf16 v[36:51], a[204:207], v[196:199], v[36:51]
buffer_load_dwordx4 v[196:199], v6, s[84:87], s51 offen offset:1024 sc1
s_waitcnt vmcnt(31)
v_mfma_f32_32x32x16_bf16 v[20:35], a[208:211], v[200:203], v[20:35]
v_mfma_f32_32x32x16_bf16 v[36:51], a[212:215], v[200:203], v[36:51]
buffer_load_dwordx4 v[200:203], v6, s[84:87], s51 offen offset:2048 sc1
s_waitcnt vmcnt(31)
v_mfma_f32_32x32x16_bf16 v[20:35], a[216:219], v[204:207], v[20:35]
v_mfma_f32_32x32x16_bf16 v[36:51], a[220:223], v[204:207], v[36:51]
buffer_load_dwordx4 v[204:207], v6, s[84:87], s51 offen offset:3072 sc1
s_and_b32 s60, s62, s69
s_lshl_b32 s60, s60, 12
buffer_load_dwordx4 v[88:91], v13, s[84:87], s60 offen sc1
s_waitcnt vmcnt(31)
v_mfma_f32_32x32x16_bf16 v[20:35], a[224:227], v[208:211], v[20:35]
v_mfma_f32_32x32x16_bf16 v[36:51], a[228:231], v[208:211], v[36:51]
s_add_u32 s51, s56, 28672
s_and_b32 s51, s51, 0x7fff
s_add_u32 s51, s51, s50
buffer_load_dwordx4 v[208:211], v6, s[84:87], s51 offen offset:0 sc1
s_waitcnt vmcnt(31)
v_mfma_f32_32x32x16_bf16 v[20:35], a[232:235], v[212:215], v[20:35]
v_mfma_f32_32x32x16_bf16 v[36:51], a[236:239], v[212:215], v[36:51]
buffer_load_dwordx4 v[212:215], v6, s[84:87], s51 offen offset:1024 sc1
s_waitcnt vmcnt(31)
v_mfma_f32_32x32x16_bf16 v[20:35], a[240:243], v[216:219], v[20:35]
v_mfma_f32_32x32x16_bf16 v[36:51], a[244:247], v[216:219], v[36:51]
buffer_load_dwordx4 v[216:219], v6, s[84:87], s51 offen offset:2048 sc1
s_waitcnt vmcnt(31)
v_mfma_f32_32x32x16_bf16 v[224:239], a[248:251], v[220:223], v[20:35]
v_mfma_f32_32x32x16_bf16 v[240:255], a[252:255], v[220:223], v[36:51]
buffer_load_dwordx4 v[220:223], v6, s[84:87], s51 offen offset:3072 sc1
s_bfe_u32 s61, s62, 0x10001
s_xor_b32 s61, s61, s67
s_and_b32 s61, s61, s71
s_waitcnt vmcnt(4)
mega_kernel_o_f1c:
v_and_b32 v14, s71, v88
v_cmp_ne_u32 vcc, s61, v14
s_cbranch_vccz mega_kernel_o_f1k
s_and_b32 s60, s62, s69
s_lshl_b32 s60, s60, 12
buffer_load_dwordx4 v[88:91], v13, s[84:87], s60 offen sc1
s_waitcnt vmcnt(0)
s_branch mega_kernel_o_f1c
mega_kernel_o_f1k:
v_pk_add_f32 v[88:89], v[88:89], v[84:85]
v_pk_add_f32 v[90:91], v[90:91], v[86:87]
s_lshl_b32 s60, s62, 17
v_cvt_pk_bf16_f32 v92, v88, v89
v_cvt_pk_bf16_f32 v93, v90, v91
buffer_store_dwordx2 v[92:93], v11, s[8:11], s60 offen sc1
s_add_u32 s42, s42, 1
s_branch mega_kernel_o_w1
mega_kernel_o_n1:
s_waitcnt vmcnt(31)
v_mfma_f32_32x32x16_bf16 v[20:35], a[0:3], v[96:99], 0
v_mfma_f32_32x32x16_bf16 v[36:51], a[4:7], v[96:99], 0
s_waitcnt vmcnt(30)
v_mfma_f32_32x32x16_bf16 v[20:35], a[8:11], v[100:103], v[20:35]
v_mfma_f32_32x32x16_bf16 v[36:51], a[12:15], v[100:103], v[36:51]
v_add_u32 v2, s53, v8
v_add_u32 v3, s53, v9
v_add_u32 v4, s53, v10
s_waitcnt vmcnt(29)
v_mfma_f32_32x32x16_bf16 v[20:35], a[16:19], v[104:107], v[20:35]
v_mfma_f32_32x32x16_bf16 v[36:51], a[20:23], v[104:107], v[36:51]
ds_write_b128 v2, v[224:227] offset:0
ds_write_b128 v2, v[228:231] offset:1088
s_waitcnt vmcnt(28)
v_mfma_f32_32x32x16_bf16 v[20:35], a[24:27], v[108:111], v[20:35]
v_mfma_f32_32x32x16_bf16 v[36:51], a[28:31], v[108:111], v[36:51]
ds_write_b128 v2, v[232:235] offset:2176
ds_write_b128 v2, v[236:239] offset:3264
s_waitcnt vmcnt(27)
v_mfma_f32_32x32x16_bf16 v[20:35], a[32:35], v[112:115], v[20:35]
v_mfma_f32_32x32x16_bf16 v[36:51], a[36:39], v[112:115], v[36:51]
ds_write_b128 v2, v[240:243] offset:4352
ds_write_b128 v2, v[244:247] offset:5440
s_waitcnt vmcnt(26)
v_mfma_f32_32x32x16_bf16 v[20:35], a[40:43], v[116:119], v[20:35]
v_mfma_f32_32x32x16_bf16 v[36:51], a[44:47], v[116:119], v[36:51]
ds_write_b128 v2, v[248:251] offset:6528
ds_write_b128 v2, v[252:255] offset:7616
s_waitcnt vmcnt(25)
v_mfma_f32_32x32x16_bf16 v[20:35], a[48:51], v[120:123], v[20:35]
v_mfma_f32_32x32x16_bf16 v[36:51], a[52:55], v[120:123], v[36:51]
s_waitcnt vmcnt(24)
v_mfma_f32_32x32x16_bf16 v[20:35], a[56:59], v[124:127], v[20:35]
v_mfma_f32_32x32x16_bf16 v[36:51], a[60:63], v[124:127], v[36:51]
s_waitcnt lgkmcnt(0)
s_barrier
ds_read_b128 v[52:55], v4 offset:0
ds_read_b128 v[56:59], v4 offset:8704
ds_read_b128 v[60:63], v4 offset:17408
ds_read_b128 v[64:67], v4 offset:26112
s_waitcnt vmcnt(23)
v_mfma_f32_32x32x16_bf16 v[20:35], a[64:67], v[128:131], v[20:35]
v_mfma_f32_32x32x16_bf16 v[36:51], a[68:71], v[128:131], v[36:51]
ds_read_b128 v[68:71], v3 offset:0
ds_read_b128 v[72:75], v3 offset:8704
ds_read_b128 v[76:79], v3 offset:17408
ds_read_b128 v[80:83], v3 offset:26112
s_sub_u32 s53, 34816, s53
s_bfe_u32 s61, s62, 0x10001
s_xor_b32 s61, s61, s67
s_and_b32 s60, s62, s69
s_lshl_b32 s60, s60, 12
s_waitcnt vmcnt(22)
v_mfma_f32_32x32x16_bf16 v[20:35], a[72:75], v[132:135], v[20:35]
v_mfma_f32_32x32x16_bf16 v[36:51], a[76:79], v[132:135], v[36:51]
s_waitcnt vmcnt(21)
v_mfma_f32_32x32x16_bf16 v[20:35], a[80:83], v[136:139], v[20:35]
v_mfma_f32_32x32x16_bf16 v[36:51], a[84:87], v[136:139], v[36:51]
s_waitcnt lgkmcnt(4)
v_add_f32 v52, v52, v56
v_add_f32 v60, v60, v64
v_add_f32 v53, v53, v57
v_add_f32 v61, v61, v65
v_add_f32 v54, v54, v58
v_add_f32 v62, v62, v66
v_add_f32 v55, v55, v59
v_add_f32 v63, v63, v67
s_waitcnt vmcnt(20)
v_mfma_f32_32x32x16_bf16 v[20:35], a[88:91], v[140:143], v[20:35]
v_mfma_f32_32x32x16_bf16 v[36:51], a[92:95], v[140:143], v[36:51]
v_add_f32 v52, v52, v60
v_add_f32 v53, v53, v61
v_add_f32 v54, v54, v62
v_add_f32 v55, v55, v63
v_and_or_b32 v52, v52, -2, s61
s_cmp_eq_u32 s95, 0
s_cbranch_scc1 mega_kernel_o_sa2
buffer_store_dwordx4 v[52:55], v12, s[84:87], s60 offen sc1
s_branch mega_kernel_o_sb2
mega_kernel_o_sa2:
buffer_store_dwordx4 v[52:55], v12, s[84:87], s60 offen
mega_kernel_o_sb2:
s_waitcnt vmcnt(19)
v_mfma_f32_32x32x16_bf16 v[20:35], a[96:99], v[144:147], v[20:35]
v_mfma_f32_32x32x16_bf16 v[36:51], a[100:103], v[144:147], v[36:51]
s_waitcnt lgkmcnt(0)
v_add_f32 v68, v68, v72
v_add_f32 v76, v76, v80
v_add_f32 v69, v69, v73
v_add_f32 v77, v77, v81
v_add_f32 v70, v70, v74
v_add_f32 v78, v78, v82
v_add_f32 v71, v71, v75
v_add_f32 v79, v79, v83
s_waitcnt vmcnt(18)
v_mfma_f32_32x32x16_bf16 v[20:35], a[104:107], v[148:151], v[20:35]
v_mfma_f32_32x32x16_bf16 v[36:51], a[108:111], v[148:151], v[36:51]
v_add_f32 v84, v68, v76
v_add_f32 v85, v69, v77
v_add_f32 v86, v70, v78
v_add_f32 v87, v71, v79
s_waitcnt vmcnt(17)
v_mfma_f32_32x32x16_bf16 v[20:35], a[112:115], v[152:155], v[20:35]
v_mfma_f32_32x32x16_bf16 v[36:51], a[116:119], v[152:155], v[36:51]
s_waitcnt vmcnt(16)
v_mfma_f32_32x32x16_bf16 v[20:35], a[120:123], v[156:159], v[20:35]
v_mfma_f32_32x32x16_bf16 v[36:51], a[124:127], v[156:159], v[36:51]
s_waitcnt vmcnt(15)
v_mfma_f32_32x32x16_bf16 v[20:35], a[128:131], v[160:163], v[20:35]
v_mfma_f32_32x32x16_bf16 v[36:51], a[132:135], v[160:163], v[36:51]
s_waitcnt vmcnt(14)
v_mfma_f32_32x32x16_bf16 v[20:35], a[136:139], v[164:167], v[20:35]
v_mfma_f32_32x32x16_bf16 v[36:51], a[140:143], v[164:167], v[36:51]
s_waitcnt vmcnt(13)
v_mfma_f32_32x32x16_bf16 v[20:35], a[144:147], v[168:171], v[20:35]
v_mfma_f32_32x32x16_bf16 v[36:51], a[148:151], v[168:171], v[36:51]
s_waitcnt vmcnt(12)
v_mfma_f32_32x32x16_bf16 v[20:35], a[152:155], v[172:175], v[20:35]
v_mfma_f32_32x32x16_bf16 v[36:51], a[156:159], v[172:175], v[36:51]
s_waitcnt vmcnt(11)
v_mfma_f32_32x32x16_bf16 v[20:35], a[160:163], v[176:179], v[20:35]
v_mfma_f32_32x32x16_bf16 v[36:51], a[164:167], v[176:179], v[36:51]
buffer_load_dword v15, v7, s[84:87], 0 offen sc1
s_waitcnt vmcnt(10)
v_mfma_f32_32x32x16_bf16 v[20:35], a[168:171], v[180:183], v[20:35]
v_mfma_f32_32x32x16_bf16 v[36:51], a[172:175], v[180:183], v[36:51]
s_waitcnt vmcnt(9)
v_mfma_f32_32x32x16_bf16 v[20:35], a[176:179], v[184:187], v[20:35]
v_mfma_f32_32x32x16_bf16 v[36:51], a[180:183], v[184:187], v[36:51]
s_waitcnt vmcnt(8)
v_mfma_f32_32x32x16_bf16 v[20:35], a[184:187], v[188:191], v[20:35]
v_mfma_f32_32x32x16_bf16 v[36:51], a[188:191], v[188:191], v[36:51]
s_waitcnt vmcnt(7)
v_mfma_f32_32x32x16_bf16 v[20:35], a[192:195], v[192:195], v[20:35]
v_mfma_f32_32x32x16_bf16 v[36:51], a[196:199], v[192:195], v[36:51]
s_waitcnt vmcnt(6)
v_mfma_f32_32x32x16_bf16 v[20:35], a[200:203], v[196:199], v[20:35]
v_mfma_f32_32x32x16_bf16 v[36:51], a[204:207], v[196:199], v[36:51]
s_waitcnt vmcnt(5)
v_mfma_f32_32x32x16_bf16 v[20:35], a[208:211], v[200:203], v[20:35]
v_mfma_f32_32x32x16_bf16 v[36:51], a[212:215], v[200:203], v[36:51]
s_waitcnt vmcnt(4)
v_mfma_f32_32x32x16_bf16 v[20:35], a[216:219], v[204:207], v[20:35]
v_mfma_f32_32x32x16_bf16 v[36:51], a[220:223], v[204:207], v[36:51]
s_and_b32 s60, s62, s69
s_lshl_b32 s60, s60, 12
buffer_load_dwordx4 v[88:91], v13, s[84:87], s60 offen sc1
s_waitcnt vmcnt(3)
v_mfma_f32_32x32x16_bf16 v[20:35], a[224:227], v[208:211], v[20:35]
v_mfma_f32_32x32x16_bf16 v[36:51], a[228:231], v[208:211], v[36:51]
s_waitcnt vmcnt(2)
v_mfma_f32_32x32x16_bf16 v[20:35], a[232:235], v[212:215], v[20:35]
v_mfma_f32_32x32x16_bf16 v[36:51], a[236:239], v[212:215], v[36:51]
s_waitcnt vmcnt(1)
v_mfma_f32_32x32x16_bf16 v[20:35], a[240:243], v[216:219], v[20:35]
v_mfma_f32_32x32x16_bf16 v[36:51], a[244:247], v[216:219], v[36:51]
s_waitcnt vmcnt(0)
v_mfma_f32_32x32x16_bf16 v[224:239], a[248:251], v[220:223], v[20:35]
v_mfma_f32_32x32x16_bf16 v[240:255], a[252:255], v[220:223], v[36:51]
s_bfe_u32 s61, s62, 0x10001
s_xor_b32 s61, s61, s67
s_and_b32 s61, s61, s71
s_waitcnt vmcnt(0)
mega_kernel_o_f0c:
v_and_b32 v14, s71, v88
v_cmp_ne_u32 vcc, s61, v14
s_cbranch_vccz mega_kernel_o_f0k
s_and_b32 s60, s62, s69
s_lshl_b32 s60, s60, 12
buffer_load_dwordx4 v[88:91], v13, s[84:87], s60 offen sc1
s_waitcnt vmcnt(0)
s_branch mega_kernel_o_f0c
mega_kernel_o_f0k:
v_pk_add_f32 v[88:89], v[88:89], v[84:85]
v_pk_add_f32 v[90:91], v[90:91], v[86:87]
s_lshl_b32 s60, s62, 17
v_cvt_pk_bf16_f32 v92, v88, v89
v_cvt_pk_bf16_f32 v93, v90, v91
buffer_store_dwordx2 v[92:93], v11, s[8:11], s60 offen sc1
mega_kernel_o_imm:
s_waitcnt vmcnt(1)
v_min_i32_dpp v15, v15, v15 quad_perm:[1,0,3,2] row_mask:0xf bank_mask:0xf
s_nop 1
v_min_i32_dpp v15, v15, v15 quad_perm:[2,3,0,1] row_mask:0xf bank_mask:0xf
s_nop 1
v_min_i32_dpp v15, v15, v15 row_ror:4 row_mask:0xf bank_mask:0xf
s_nop 1
v_min_i32_dpp v15, v15, v15 row_ror:8 row_mask:0xf bank_mask:0xf
s_nop 0
v_readfirstlane_b32 s52, v15
s_min_i32 s52, s52, s65
s_cmp_gt_i32 s52, s54
s_cbranch_scc0 mega_kernel_o_im2
s_add_u32 s42, s42, 1
s_add_u32 s54, s54, 1
s_cmp_gt_i32 s52, s54
s_cbranch_scc0 mega_kernel_o_c1
s_add_u32 s51, s56, 0
s_and_b32 s51, s51, 0x7fff
s_add_u32 s51, s51, s50
buffer_load_dwordx4 v[96:99], v6, s[84:87], s51 offen offset:0 sc1
buffer_load_dwordx4 v[100:103], v6, s[84:87], s51 offen offset:1024 sc1
buffer_load_dwordx4 v[104:107], v6, s[84:87], s51 offen offset:2048 sc1
buffer_load_dwordx4 v[108:111], v6, s[84:87], s51 offen offset:3072 sc1
s_add_u32 s51, s56, 4096
s_and_b32 s51, s51, 0x7fff
s_add_u32 s51, s51, s50
buffer_load_dwordx4 v[112:115], v6, s[84:87], s51 offen offset:0 sc1
buffer_load_dwordx4 v[116:119], v6, s[84:87], s51 offen offset:1024 sc1
buffer_load_dwordx4 v[120:123], v6, s[84:87], s51 offen offset:2048 sc1
buffer_load_dwordx4 v[124:127], v6, s[84:87], s51 offen offset:3072 sc1
s_add_u32 s51, s56, 8192
s_and_b32 s51, s51, 0x7fff
s_add_u32 s51, s51, s50
buffer_load_dwordx4 v[128:131], v6, s[84:87], s51 offen offset:0 sc1
buffer_load_dwordx4 v[132:135], v6, s[84:87], s51 offen offset:1024 sc1
buffer_load_dwordx4 v[136:139], v6, s[84:87], s51 offen offset:2048 sc1
buffer_load_dwordx4 v[140:143], v6, s[84:87], s51 offen offset:3072 sc1
s_add_u32 s51, s56, 12288
s_and_b32 s51, s51, 0x7fff
s_add_u32 s51, s51, s50
buffer_load_dwordx4 v[144:147], v6, s[84:87], s51 offen offset:0 sc1
buffer_load_dwordx4 v[148:151], v6, s[84:87], s51 offen offset:1024 sc1
buffer_load_dwordx4 v[152:155], v6, s[84:87], s51 offen offset:2048 sc1
buffer_load_dwordx4 v[156:159], v6, s[84:87], s51 offen offset:3072 sc1
s_add_u32 s51, s56, 16384
s_and_b32 s51, s51, 0x7fff
s_add_u32 s51, s51, s50
buffer_load_dwordx4 v[160:163], v6, s[84:87], s51 offen offset:0 sc1
buffer_load_dwordx4 v[164:167], v6, s[84:87], s51 offen offset:1024 sc1
buffer_load_dwordx4 v[168:171], v6, s[84:87], s51 offen offset:2048 sc1
buffer_load_dwordx4 v[172:175], v6, s[84:87], s51 offen offset:3072 sc1
s_add_u32 s51, s56, 20480
s_and_b32 s51, s51, 0x7fff
s_add_u32 s51, s51, s50
buffer_load_dwordx4 v[176:179], v6, s[84:87], s51 offen offset:0 sc1
buffer_load_dwordx4 v[180:183], v6, s[84:87], s51 offen offset:1024 sc1
buffer_load_dwordx4 v[184:187], v6, s[84:87], s51 offen offset:2048 sc1
buffer_load_dwordx4 v[188:191], v6, s[84:87], s51 offen offset:3072 sc1
s_add_u32 s51, s56, 24576
s_and_b32 s51, s51, 0x7fff
s_add_u32 s51, s51, s50
buffer_load_dwordx4 v[192:195], v6, s[84:87], s51 offen offset:0 sc1
buffer_load_dwordx4 v[196:199], v6, s[84:87], s51 offen offset:1024 sc1
buffer_load_dwordx4 v[200:203], v6, s[84:87], s51 offen offset:2048 sc1
buffer_load_dwordx4 v[204:207], v6, s[84:87], s51 offen offset:3072 sc1
s_add_u32 s51, s56, 28672
s_and_b32 s51, s51, 0x7fff
s_add_u32 s51, s51, s50
buffer_load_dwordx4 v[208:211], v6, s[84:87], s51 offen offset:0 sc1
buffer_load_dwordx4 v[212:215], v6, s[84:87], s51 offen offset:1024 sc1
buffer_load_dwordx4 v[216:219], v6, s[84:87], s51 offen offset:2048 sc1
buffer_load_dwordx4 v[220:223], v6, s[84:87], s51 offen offset:3072 sc1
s_branch mega_kernel_o_w1
mega_kernel_o_c0:
s_add_u32 s54, s42, 1
s_sub_u32 s62, s42, 1
s_lshl_b32 s50, s42, 18
s_add_u32 s51, s56, 0
s_and_b32 s51, s51, 0x7fff
s_add_u32 s51, s51, s50
buffer_load_dwordx4 v[96:99], v6, s[84:87], s51 offen offset:0 sc1
buffer_load_dwordx4 v[100:103], v6, s[84:87], s51 offen offset:1024 sc1
buffer_load_dwordx4 v[104:107], v6, s[84:87], s51 offen offset:2048 sc1
buffer_load_dwordx4 v[108:111], v6, s[84:87], s51 offen offset:3072 sc1
s_add_u32 s51, s56, 4096
s_and_b32 s51, s51, 0x7fff
s_add_u32 s51, s51, s50
buffer_load_dwordx4 v[112:115], v6, s[84:87], s51 offen offset:0 sc1
buffer_load_dwordx4 v[116:119], v6, s[84:87], s51 offen offset:1024 sc1
buffer_load_dwordx4 v[120:123], v6, s[84:87], s51 offen offset:2048 sc1
buffer_load_dwordx4 v[124:127], v6, s[84:87], s51 offen offset:3072 sc1
s_waitcnt vmcnt(7)
v_mfma_f32_32x32x16_bf16 v[20:35], a[0:3], v[96:99], 0
v_mfma_f32_32x32x16_bf16 v[36:51], a[4:7], v[96:99], 0
s_add_u32 s51, s56, 8192
s_and_b32 s51, s51, 0x7fff
s_add_u32 s51, s51, s50
buffer_load_dwordx4 v[128:131], v6, s[84:87], s51 offen offset:0 sc1
s_waitcnt vmcnt(7)
v_mfma_f32_32x32x16_bf16 v[20:35], a[8:11], v[100:103], v[20:35]
v_mfma_f32_32x32x16_bf16 v[36:51], a[12:15], v[100:103], v[36:51]
buffer_load_dwordx4 v[132:135], v6, s[84:87], s51 offen offset:1024 sc1
s_waitcnt vmcnt(7)
v_mfma_f32_32x32x16_bf16 v[20:35], a[16:19], v[104:107], v[20:35]
v_mfma_f32_32x32x16_bf16 v[36:51], a[20:23], v[104:107], v[36:51]
buffer_load_dwordx4 v[136:139], v6, s[84:87], s51 offen offset:2048 sc1
s_waitcnt vmcnt(7)
v_mfma_f32_32x32x16_bf16 v[20:35], a[24:27], v[108:111], v[20:35]
v_mfma_f32_32x32x16_bf16 v[36:51], a[28:31], v[108:111], v[36:51]
buffer_load_dwordx4 v[140:143], v6, s[84:87], s51 offen offset:3072 sc1
s_waitcnt vmcnt(7)
v_mfma_f32_32x32x16_bf16 v[20:35], a[32:35], v[112:115], v[20:35]
v_mfma_f32_32x32x16_bf16 v[36:51], a[36:39], v[112:115], v[36:51]
s_add_u32 s51, s56, 12288
s_and_b32 s51, s51, 0x7fff
s_add_u32 s51, s51, s50
buffer_load_dwordx4 v[144:147], v6, s[84:87], s51 offen offset:0 sc1
s_waitcnt vmcnt(7)
v_mfma_f32_32x32x16_bf16 v[20:35], a[40:43], v[116:119], v[20:35]
v_mfma_f32_32x32x16_bf16 v[36:51], a[44:47], v[116:119], v[36:51]
buffer_load_dwordx4 v[148:151], v6, s[84:87], s51 offen offset:1024 sc1
s_waitcnt vmcnt(7)
v_mfma_f32_32x32x16_bf16 v[20:35], a[48:51], v[120:123], v[20:35]
v_mfma_f32_32x32x16_bf16 v[36:51], a[52:55], v[120:123], v[36:51]
buffer_load_dwordx4 v[152:155], v6, s[84:87], s51 offen offset:2048 sc1
s_waitcnt vmcnt(7)
v_mfma_f32_32x32x16_bf16 v[20:35], a[56:59], v[124:127], v[20:35]
v_mfma_f32_32x32x16_bf16 v[36:51], a[60:63], v[124:127], v[36:51]
buffer_load_dwordx4 v[156:159], v6, s[84:87], s51 offen offset:3072 sc1
s_waitcnt vmcnt(7)
v_mfma_f32_32x32x16_bf16 v[20:35], a[64:67], v[128:131], v[20:35]
v_mfma_f32_32x32x16_bf16 v[36:51], a[68:71], v[128:131], v[36:51]
s_add_u32 s51, s56, 16384
s_and_b32 s51, s51, 0x7fff
s_add_u32 s51, s51, s50
buffer_load_dwordx4 v[160:163], v6, s[84:87], s51 offen offset:0 sc1
s_waitcnt vmcnt(7)
v_mfma_f32_32x32x16_bf16 v[20:35], a[72:75], v[132:135], v[20:35]
v_mfma_f32_32x32x16_bf16 v[36:51], a[76:79], v[132:135], v[36:51]
buffer_load_dwordx4 v[164:167], v6, s[84:87], s51 offen offset:1024 sc1
s_waitcnt vmcnt(7)
v_mfma_f32_32x32x16_bf16 v[20:35], a[80:83], v[136:139], v[20:35]
v_mfma_f32_32x32x16_bf16 v[36:51], a[84:87], v[136:139], v[36:51]
buffer_load_dwordx4 v[168:171], v6, s[84:87], s51 offen offset:2048 sc1
s_waitcnt vmcnt(7)
v_mfma_f32_32x32x16_bf16 v[20:35], a[88:91], v[140:143], v[20:35]
v_mfma_f32_32x32x16_bf16 v[36:51], a[92:95], v[140:143], v[36:51]
buffer_load_dwordx4 v[172:175], v6, s[84:87], s51 offen offset:3072 sc1
s_waitcnt vmcnt(7)
v_mfma_f32_32x32x16_bf16 v[20:35], a[96:99], v[144:147], v[20:35]
v_mfma_f32_32x32x16_bf16 v[36:51], a[100:103], v[144:147], v[36:51]
s_add_u32 s51, s56, 20480
s_and_b32 s51, s51, 0x7fff
s_add_u32 s51, s51, s50
buffer_load_dwordx4 v[176:179], v6, s[84:87], s51 offen offset:0 sc1
s_waitcnt vmcnt(7)
v_mfma_f32_32x32x16_bf16 v[20:35], a[104:107], v[148:151], v[20:35]
v_mfma_f32_32x32x16_bf16 v[36:51], a[108:111], v[148:151], v[36:51]
buffer_load_dwordx4 v[180:183], v6, s[84:87], s51 offen offset:1024 sc1
s_waitcnt vmcnt(7)
v_mfma_f32_32x32x16_bf16 v[20:35], a[112:115], v[152:155], v[20:35]
v_mfma_f32_32x32x16_bf16 v[36:51], a[116:119], v[152:155], v[36:51]
buffer_load_dwordx4 v[184:187], v6, s[84:87], s51 offen offset:2048 sc1
s_waitcnt vmcnt(7)
v_mfma_f32_32x32x16_bf16 v[20:35], a[120:123], v[156:159], v[20:35]
v_mfma_f32_32x32x16_bf16 v[36:51], a[124:127], v[156:159], v[36:51]
buffer_load_dwordx4 v[188:191], v6, s[84:87], s51 offen offset:3072 sc1
s_waitcnt vmcnt(7)
v_mfma_f32_32x32x16_bf16 v[20:35], a[128:131], v[160:163], v[20:35]
v_mfma_f32_32x32x16_bf16 v[36:51], a[132:135], v[160:163], v[36:51]
s_add_u32 s51, s56, 24576
s_and_b32 s51, s51, 0x7fff
s_add_u32 s51, s51, s50
buffer_load_dwordx4 v[192:195], v6, s[84:87], s51 offen offset:0 sc1
s_waitcnt vmcnt(7)
v_mfma_f32_32x32x16_bf16 v[20:35], a[136:139], v[164:167], v[20:35]
v_mfma_f32_32x32x16_bf16 v[36:51], a[140:143], v[164:167], v[36:51]
buffer_load_dwordx4 v[196:199], v6, s[84:87], s51 offen offset:1024 sc1
s_waitcnt vmcnt(7)
v_mfma_f32_32x32x16_bf16 v[20:35], a[144:147], v[168:171], v[20:35]
v_mfma_f32_32x32x16_bf16 v[36:51], a[148:151], v[168:171], v[36:51]
buffer_load_dwordx4 v[200:203], v6, s[84:87], s51 offen offset:2048 sc1
s_waitcnt vmcnt(7)
v_mfma_f32_32x32x16_bf16 v[20:35], a[152:155], v[172:175], v[20:35]
v_mfma_f32_32x32x16_bf16 v[36:51], a[156:159], v[172:175], v[36:51]
buffer_load_dwordx4 v[204:207], v6, s[84:87], s51 offen offset:3072 sc1
s_waitcnt vmcnt(7)
v_mfma_f32_32x32x16_bf16 v[20:35], a[160:163], v[176:179], v[20:35]
v_mfma_f32_32x32x16_bf16 v[36:51], a[164:167], v[176:179], v[36:51]
s_add_u32 s51, s56, 28672
s_and_b32 s51, s51, 0x7fff
s_add_u32 s51, s51, s50
buffer_load_dwordx4 v[208:211], v6, s[84:87], s51 offen offset:0 sc1
s_waitcnt vmcnt(7)
v_mfma_f32_32x32x16_bf16 v[20:35], a[168:171], v[180:183], v[20:35]
v_mfma_f32_32x32x16_bf16 v[36:51], a[172:175], v[180:183], v[36:51]
buffer_load_dwordx4 v[212:215], v6, s[84:87], s51 offen offset:1024 sc1
s_waitcnt vmcnt(7)
v_mfma_f32_32x32x16_bf16 v[20:35], a[176:179], v[184:187], v[20:35]
v_mfma_f32_32x32x16_bf16 v[36:51], a[180:183], v[184:187], v[36:51]
buffer_load_dwordx4 v[216:219], v6, s[84:87], s51 offen offset:2048 sc1
s_waitcnt vmcnt(7)
v_mfma_f32_32x32x16_bf16 v[20:35], a[184:187], v[188:191], v[20:35]
v_mfma_f32_32x32x16_bf16 v[36:51], a[188:191], v[188:191], v[36:51]
buffer_load_dwordx4 v[220:223], v6, s[84:87], s51 offen offset:3072 sc1
s_waitcnt vmcnt(7)
v_mfma_f32_32x32x16_bf16 v[20:35], a[192:195], v[192:195], v[20:35]
v_mfma_f32_32x32x16_bf16 v[36:51], a[196:199], v[192:195], v[36:51]
buffer_load_dword v15, v7, s[84:87], 0 offen sc1
s_waitcnt vmcnt(6)
v_mfma_f32_32x32x16_bf16 v[20:35], a[200:203], v[196:199], v[20:35]
v_mfma_f32_32x32x16_bf16 v[36:51], a[204:207], v[196:199], v[36:51]
s_waitcnt vmcnt(5)
v_mfma_f32_32x32x16_bf16 v[20:35], a[208:211], v[200:203], v[20:35]
v_mfma_f32_32x32x16_bf16 v[36:51], a[212:215], v[200:203], v[36:51]
s_waitcnt vmcnt(4)
v_mfma_f32_32x32x16_bf16 v[20:35], a[216:219], v[204:207], v[20:35]
v_mfma_f32_32x32x16_bf16 v[36:51], a[220:223], v[204:207], v[36:51]
s_waitcnt vmcnt(3)
v_mfma_f32_32x32x16_bf16 v[20:35], a[224:227], v[208:211], v[20:35]
v_mfma_f32_32x32x16_bf16 v[36:51], a[228:231], v[208:211], v[36:51]
s_waitcnt vmcnt(2)
v_mfma_f32_32x32x16_bf16 v[20:35], a[232:235], v[212:215], v[20:35]
v_mfma_f32_32x32x16_bf16 v[36:51], a[236:239], v[212:215], v[36:51]
s_waitcnt vmcnt(1)
v_mfma_f32_32x32x16_bf16 v[20:35], a[240:243], v[216:219], v[20:35]
v_mfma_f32_32x32x16_bf16 v[36:51], a[244:247], v[216:219], v[36:51]
s_waitcnt vmcnt(0)
v_mfma_f32_32x32x16_bf16 v[224:239], a[248:251], v[220:223], v[20:35]
v_mfma_f32_32x32x16_bf16 v[240:255], a[252:255], v[220:223], v[36:51]
s_lshl_b32 s50, s54, 18
s_branch mega_kernel_o_imm
mega_kernel_o_c1:
s_add_u32 s54, s42, 1
s_sub_u32 s62, s42, 1
s_lshl_b32 s50, s42, 18
s_add_u32 s51, s56, 0
s_and_b32 s51, s51, 0x7fff
s_add_u32 s51, s51, s50
buffer_load_dwordx4 v[96:99], v6, s[84:87], s51 offen offset:0 sc1
buffer_load_dwordx4 v[100:103], v6, s[84:87], s51 offen offset:1024 sc1
buffer_load_dwordx4 v[104:107], v6, s[84:87], s51 offen offset:2048 sc1
buffer_load_dwordx4 v[108:111], v6, s[84:87], s51 offen offset:3072 sc1
s_add_u32 s51, s56, 4096
s_and_b32 s51, s51, 0x7fff
s_add_u32 s51, s51, s50
buffer_load_dwordx4 v[112:115], v6, s[84:87], s51 offen offset:0 sc1
buffer_load_dwordx4 v[116:119], v6, s[84:87], s51 offen offset:1024 sc1
buffer_load_dwordx4 v[120:123], v6, s[84:87], s51 offen offset:2048 sc1
buffer_load_dwordx4 v[124:127], v6, s[84:87], s51 offen offset:3072 sc1
v_add_u32 v2, s53, v8
v_add_u32 v3, s53, v9
v_add_u32 v4, s53, v10
ds_write_b128 v2, v[224:227] offset:0
ds_write_b128 v2, v[228:231] offset:1088
ds_write_b128 v2, v[232:235] offset:2176
ds_write_b128 v2, v[236:239] offset:3264
ds_write_b128 v2, v[240:243] offset:4352
ds_write_b128 v2, v[244:247] offset:5440
ds_write_b128 v2, v[248:251] offset:6528
ds_write_b128 v2, v[252:255] offset:7616
s_waitcnt lgkmcnt(0)
s_barrier
ds_read_b128 v[52:55], v4 offset:0
ds_read_b128 v[56:59], v4 offset:8704
ds_read_b128 v[60:63], v4 offset:17408
ds_read_b128 v[64:67], v4 offset:26112
ds_read_b128 v[68:71], v3 offset:0
ds_read_b128 v[72:75], v3 offset:8704
ds_read_b128 v[76:79], v3 offset:17408
ds_read_b128 v[80:83], v3 offset:26112
s_sub_u32 s53, 34816, s53
s_bfe_u32 s61, s62, 0x10001
s_xor_b32 s61, s61, s67
s_and_b32 s60, s62, s69
s_lshl_b32 s60, s60, 12
s_waitcnt lgkmcnt(4)
v_add_f32 v52, v52, v56
v_add_f32 v60, v60, v64
v_add_f32 v53, v53, v57
v_add_f32 v61, v61, v65
v_add_f32 v54, v54, v58
v_add_f32 v62, v62, v66
v_add_f32 v55, v55, v59
v_add_f32 v63, v63, v67
v_add_f32 v52, v52, v60
v_add_f32 v53, v53, v61
v_add_f32 v54, v54, v62
v_add_f32 v55, v55, v63
v_and_or_b32 v52, v52, -2, s61
s_cmp_eq_u32 s95, 0
s_cbranch_scc1 mega_kernel_o_sa3
buffer_store_dwordx4 v[52:55], v12, s[84:87], s60 offen sc1
s_branch mega_kernel_o_sb3
mega_kernel_o_sa3:
buffer_store_dwordx4 v[52:55], v12, s[84:87], s60 offen
mega_kernel_o_sb3:
s_waitcnt lgkmcnt(0)
v_add_f32 v68, v68, v72
v_add_f32 v76, v76, v80
v_add_f32 v69, v69, v73
v_add_f32 v77, v77, v81
v_add_f32 v70, v70, v74
v_add_f32 v78, v78, v82
v_add_f32 v71, v71, v75
v_add_f32 v79, v79, v83
v_add_f32 v84, v68, v76
v_add_f32 v85, v69, v77
v_add_f32 v86, v70, v78
v_add_f32 v87, v71, v79
s_waitcnt vmcnt(7)
v_mfma_f32_32x32x16_bf16 v[20:35], a[0:3], v[96:99], 0
v_mfma_f32_32x32x16_bf16 v[36:51], a[4:7], v[96:99], 0
s_add_u32 s51, s56, 8192
s_and_b32 s51, s51, 0x7fff
s_add_u32 s51, s51, s50
buffer_load_dwordx4 v[128:131], v6, s[84:87], s51 offen offset:0 sc1
s_waitcnt vmcnt(7)
v_mfma_f32_32x32x16_bf16 v[20:35], a[8:11], v[100:103], v[20:35]
v_mfma_f32_32x32x16_bf16 v[36:51], a[12:15], v[100:103], v[36:51]
buffer_load_dwordx4 v[132:135], v6, s[84:87], s51 offen offset:1024 sc1
s_waitcnt vmcnt(7)
v_mfma_f32_32x32x16_bf16 v[20:35], a[16:19], v[104:107], v[20:35]
v_mfma_f32_32x32x16_bf16 v[36:51], a[20:23], v[104:107], v[36:51]
buffer_load_dwordx4 v[136:139], v6, s[84:87], s51 offen offset:2048 sc1
s_waitcnt vmcnt(7)
v_mfma_f32_32x32x16_bf16 v[20:35], a[24:27], v[108:111], v[20:35]
v_mfma_f32_32x32x16_bf16 v[36:51], a[28:31], v[108:111], v[36:51]
buffer_load_dwordx4 v[140:143], v6, s[84:87], s51 offen offset:3072 sc1
s_waitcnt vmcnt(7)
v_mfma_f32_32x32x16_bf16 v[20:35], a[32:35], v[112:115], v[20:35]
v_mfma_f32_32x32x16_bf16 v[36:51], a[36:39], v[112:115], v[36:51]
s_add_u32 s51, s56, 12288
s_and_b32 s51, s51, 0x7fff
s_add_u32 s51, s51, s50
buffer_load_dwordx4 v[144:147], v6, s[84:87], s51 offen offset:0 sc1
s_waitcnt vmcnt(7)
v_mfma_f32_32x32x16_bf16 v[20:35], a[40:43], v[116:119], v[20:35]
v_mfma_f32_32x32x16_bf16 v[36:51], a[44:47], v[116:119], v[36:51]
buffer_load_dwordx4 v[148:151], v6, s[84:87], s51 offen offset:1024 sc1
s_waitcnt vmcnt(7)
v_mfma_f32_32x32x16_bf16 v[20:35], a[48:51], v[120:123], v[20:35]
v_mfma_f32_32x32x16_bf16 v[36:51], a[52:55], v[120:123], v[36:51]
buffer_load_dwordx4 v[152:155], v6, s[84:87], s51 offen offset:2048 sc1
s_waitcnt vmcnt(7)
v_mfma_f32_32x32x16_bf16 v[20:35], a[56:59], v[124:127], v[20:35]
v_mfma_f32_32x32x16_bf16 v[36:51], a[60:63], v[124:127], v[36:51]
buffer_load_dwordx4 v[156:159], v6, s[84:87], s51 offen offset:3072 sc1
s_waitcnt vmcnt(7)
v_mfma_f32_32x32x16_bf16 v[20:35], a[64:67], v[128:131], v[20:35]
v_mfma_f32_32x32x16_bf16 v[36:51], a[68:71], v[128:131], v[36:51]
s_add_u32 s51, s56, 16384
s_and_b32 s51, s51, 0x7fff
s_add_u32 s51, s51, s50
buffer_load_dwordx4 v[160:163], v6, s[84:87], s51 offen offset:0 sc1
s_waitcnt vmcnt(7)
v_mfma_f32_32x32x16_bf16 v[20:35], a[72:75], v[132:135], v[20:35]
v_mfma_f32_32x32x16_bf16 v[36:51], a[76:79], v[132:135], v[36:51]
buffer_load_dwordx4 v[164:167], v6, s[84:87], s51 offen offset:1024 sc1
s_waitcnt vmcnt(7)
v_mfma_f32_32x32x16_bf16 v[20:35], a[80:83], v[136:139], v[20:35]
v_mfma_f32_32x32x16_bf16 v[36:51], a[84:87], v[136:139], v[36:51]
buffer_load_dwordx4 v[168:171], v6, s[84:87], s51 offen offset:2048 sc1
s_waitcnt vmcnt(7)
v_mfma_f32_32x32x16_bf16 v[20:35], a[88:91], v[140:143], v[20:35]
v_mfma_f32_32x32x16_bf16 v[36:51], a[92:95], v[140:143], v[36:51]
buffer_load_dwordx4 v[172:175], v6, s[84:87], s51 offen offset:3072 sc1
s_waitcnt vmcnt(7)
v_mfma_f32_32x32x16_bf16 v[20:35], a[96:99], v[144:147], v[20:35]
v_mfma_f32_32x32x16_bf16 v[36:51], a[100:103], v[144:147], v[36:51]
s_add_u32 s51, s56, 20480
s_and_b32 s51, s51, 0x7fff
s_add_u32 s51, s51, s50
buffer_load_dwordx4 v[176:179], v6, s[84:87], s51 offen offset:0 sc1
s_waitcnt vmcnt(7)
v_mfma_f32_32x32x16_bf16 v[20:35], a[104:107], v[148:151], v[20:35]
v_mfma_f32_32x32x16_bf16 v[36:51], a[108:111], v[148:151], v[36:51]
buffer_load_dwordx4 v[180:183], v6, s[84:87], s51 offen offset:1024 sc1
s_waitcnt vmcnt(7)
v_mfma_f32_32x32x16_bf16 v[20:35], a[112:115], v[152:155], v[20:35]
v_mfma_f32_32x32x16_bf16 v[36:51], a[116:119], v[152:155], v[36:51]
buffer_load_dwordx4 v[184:187], v6, s[84:87], s51 offen offset:2048 sc1
s_waitcnt vmcnt(7)
v_mfma_f32_32x32x16_bf16 v[20:35], a[120:123], v[156:159], v[20:35]
v_mfma_f32_32x32x16_bf16 v[36:51], a[124:127], v[156:159], v[36:51]
buffer_load_dwordx4 v[188:191], v6, s[84:87], s51 offen offset:3072 sc1
s_waitcnt vmcnt(7)
v_mfma_f32_32x32x16_bf16 v[20:35], a[128:131], v[160:163], v[20:35]
v_mfma_f32_32x32x16_bf16 v[36:51], a[132:135], v[160:163], v[36:51]
s_add_u32 s51, s56, 24576
s_and_b32 s51, s51, 0x7fff
s_add_u32 s51, s51, s50
buffer_load_dwordx4 v[192:195], v6, s[84:87], s51 offen offset:0 sc1
s_waitcnt vmcnt(7)
v_mfma_f32_32x32x16_bf16 v[20:35], a[136:139], v[164:167], v[20:35]
v_mfma_f32_32x32x16_bf16 v[36:51], a[140:143], v[164:167], v[36:51]
buffer_load_dwordx4 v[196:199], v6, s[84:87], s51 offen offset:1024 sc1
s_waitcnt vmcnt(7)
v_mfma_f32_32x32x16_bf16 v[20:35], a[144:147], v[168:171], v[20:35]
v_mfma_f32_32x32x16_bf16 v[36:51], a[148:151], v[168:171], v[36:51]
buffer_load_dwordx4 v[200:203], v6, s[84:87], s51 offen offset:2048 sc1
s_waitcnt vmcnt(7)
v_mfma_f32_32x32x16_bf16 v[20:35], a[152:155], v[172:175], v[20:35]
v_mfma_f32_32x32x16_bf16 v[36:51], a[156:159], v[172:175], v[36:51]
buffer_load_dwordx4 v[204:207], v6, s[84:87], s51 offen offset:3072 sc1
s_waitcnt vmcnt(7)
v_mfma_f32_32x32x16_bf16 v[20:35], a[160:163], v[176:179], v[20:35]
v_mfma_f32_32x32x16_bf16 v[36:51], a[164:167], v[176:179], v[36:51]
s_add_u32 s51, s56, 28672
s_and_b32 s51, s51, 0x7fff
s_add_u32 s51, s51, s50
buffer_load_dwordx4 v[208:211], v6, s[84:87], s51 offen offset:0 sc1
s_waitcnt vmcnt(7)
v_mfma_f32_32x32x16_bf16 v[20:35], a[168:171], v[180:183], v[20:35]
v_mfma_f32_32x32x16_bf16 v[36:51], a[172:175], v[180:183], v[36:51]
buffer_load_dwordx4 v[212:215], v6, s[84:87], s51 offen offset:1024 sc1
s_waitcnt vmcnt(7)
v_mfma_f32_32x32x16_bf16 v[20:35], a[176:179], v[184:187], v[20:35]
v_mfma_f32_32x32x16_bf16 v[36:51], a[180:183], v[184:187], v[36:51]
buffer_load_dwordx4 v[216:219], v6, s[84:87], s51 offen offset:2048 sc1
s_waitcnt vmcnt(7)
v_mfma_f32_32x32x16_bf16 v[20:35], a[184:187], v[188:191], v[20:35]
v_mfma_f32_32x32x16_bf16 v[36:51], a[188:191], v[188:191], v[36:51]
buffer_load_dwordx4 v[220:223], v6, s[84:87], s51 offen offset:3072 sc1
s_waitcnt vmcnt(7)
v_mfma_f32_32x32x16_bf16 v[20:35], a[192:195], v[192:195], v[20:35]
v_mfma_f32_32x32x16_bf16 v[36:51], a[196:199], v[192:195], v[36:51]
s_and_b32 s60, s62, s69
s_lshl_b32 s60, s60, 12
buffer_load_dwordx4 v[88:91], v13, s[84:87], s60 offen sc1
buffer_load_dword v15, v7, s[84:87], 0 offen sc1
s_waitcnt vmcnt(6)
v_mfma_f32_32x32x16_bf16 v[20:35], a[200:203], v[196:199], v[20:35]
v_mfma_f32_32x32x16_bf16 v[36:51], a[204:207], v[196:199], v[36:51]
s_waitcnt vmcnt(5)
v_mfma_f32_32x32x16_bf16 v[20:35], a[208:211], v[200:203], v[20:35]
v_mfma_f32_32x32x16_bf16 v[36:51], a[212:215], v[200:203], v[36:51]
s_waitcnt vmcnt(4)
v_mfma_f32_32x32x16_bf16 v[20:35], a[216:219], v[204:207], v[20:35]
v_mfma_f32_32x32x16_bf16 v[36:51], a[220:223], v[204:207], v[36:51]
s_waitcnt vmcnt(3)
v_mfma_f32_32x32x16_bf16 v[20:35], a[224:227], v[208:211], v[20:35]
v_mfma_f32_32x32x16_bf16 v[36:51], a[228:231], v[208:211], v[36:51]
s_waitcnt vmcnt(2)
v_mfma_f32_32x32x16_bf16 v[20:35], a[232:235], v[212:215], v[20:35]
v_mfma_f32_32x32x16_bf16 v[36:51], a[236:239], v[212:215], v[36:51]
s_waitcnt vmcnt(1)
v_mfma_f32_32x32x16_bf16 v[20:35], a[240:243], v[216:219], v[20:35]
v_mfma_f32_32x32x16_bf16 v[36:51], a[244:247], v[216:219], v[36:51]
s_waitcnt vmcnt(0)
v_mfma_f32_32x32x16_bf16 v[224:239], a[248:251], v[220:223], v[20:35]
v_mfma_f32_32x32x16_bf16 v[240:255], a[252:255], v[220:223], v[36:51]
s_bfe_u32 s61, s62, 0x10001
s_xor_b32 s61, s61, s67
s_and_b32 s61, s61, s71
s_waitcnt vmcnt(0)
mega_kernel_o_fcc:
v_and_b32 v14, s71, v88
v_cmp_ne_u32 vcc, s61, v14
s_cbranch_vccz mega_kernel_o_fck
s_and_b32 s60, s62, s69
s_lshl_b32 s60, s60, 12
buffer_load_dwordx4 v[88:91], v13, s[84:87], s60 offen sc1
s_waitcnt vmcnt(0)
s_branch mega_kernel_o_fcc
mega_kernel_o_fck:
v_pk_add_f32 v[88:89], v[88:89], v[84:85]
v_pk_add_f32 v[90:91], v[90:91], v[86:87]
s_lshl_b32 s60, s62, 17
v_cvt_pk_bf16_f32 v92, v88, v89
v_cvt_pk_bf16_f32 v93, v90, v91
buffer_store_dwordx2 v[92:93], v11, s[8:11], s60 offen sc1
s_lshl_b32 s50, s54, 18
s_branch mega_kernel_o_imm
mega_kernel_o_im2:
v_add_u32 v2, s53, v8
v_add_u32 v3, s53, v9
v_add_u32 v4, s53, v10
ds_write_b128 v2, v[224:227] offset:0
ds_write_b128 v2, v[228:231] offset:1088
ds_write_b128 v2, v[232:235] offset:2176
ds_write_b128 v2, v[236:239] offset:3264
ds_write_b128 v2, v[240:243] offset:4352
ds_write_b128 v2, v[244:247] offset:5440
ds_write_b128 v2, v[248:251] offset:6528
ds_write_b128 v2, v[252:255] offset:7616
s_waitcnt lgkmcnt(0)
s_barrier
ds_read_b128 v[52:55], v4 offset:0
ds_read_b128 v[56:59], v4 offset:8704
ds_read_b128 v[60:63], v4 offset:17408
ds_read_b128 v[64:67], v4 offset:26112
ds_read_b128 v[68:71], v3 offset:0
ds_read_b128 v[72:75], v3 offset:8704
ds_read_b128 v[76:79], v3 offset:17408
ds_read_b128 v[80:83], v3 offset:26112
s_sub_u32 s53, 34816, s53
s_bfe_u32 s61, s42, 0x10001
s_xor_b32 s61, s61, s67
s_and_b32 s60, s42, s69
s_lshl_b32 s60, s60, 12
s_waitcnt lgkmcnt(4)
v_add_f32 v52, v52, v56
v_add_f32 v60, v60, v64
v_add_f32 v53, v53, v57
v_add_f32 v61, v61, v65
v_add_f32 v54, v54, v58
v_add_f32 v62, v62, v66
v_add_f32 v55, v55, v59
v_add_f32 v63, v63, v67
v_add_f32 v52, v52, v60
v_add_f32 v53, v53, v61
v_add_f32 v54, v54, v62
v_add_f32 v55, v55, v63
v_and_or_b32 v52, v52, -2, s61
s_cmp_eq_u32 s95, 0
s_cbranch_scc1 mega_kernel_o_sa4
buffer_store_dwordx4 v[52:55], v12, s[84:87], s60 offen sc1
s_branch mega_kernel_o_sb4
mega_kernel_o_sa4:
buffer_store_dwordx4 v[52:55], v12, s[84:87], s60 offen
mega_kernel_o_sb4:
s_waitcnt lgkmcnt(0)
v_add_f32 v68, v68, v72
v_add_f32 v76, v76, v80
v_add_f32 v69, v69, v73
v_add_f32 v77, v77, v81
v_add_f32 v70, v70, v74
v_add_f32 v78, v78, v82
v_add_f32 v71, v71, v75
v_add_f32 v79, v79, v83
v_add_f32 v84, v68, v76
v_add_f32 v85, v69, v77
v_add_f32 v86, v70, v78
v_add_f32 v87, v71, v79
s_and_b32 s60, s42, s69
s_lshl_b32 s60, s60, 12
buffer_load_dwordx4 v[88:91], v13, s[84:87], s60 offen sc1
s_bfe_u32 s61, s42, 0x10001
s_xor_b32 s61, s61, s67
s_and_b32 s61, s61, s71
s_waitcnt vmcnt(0)
mega_kernel_o_f2c:
v_and_b32 v14, s71, v88
v_cmp_ne_u32 vcc, s61, v14
s_cbranch_vccz mega_kernel_o_f2k
s_and_b32 s60, s42, s69
s_lshl_b32 s60, s60, 12
buffer_load_dwordx4 v[88:91], v13, s[84:87], s60 offen sc1
s_waitcnt vmcnt(0)
s_branch mega_kernel_o_f2c
mega_kernel_o_f2k:
v_pk_add_f32 v[88:89], v[88:89], v[84:85]
v_pk_add_f32 v[90:91], v[90:91], v[86:87]
s_lshl_b32 s60, s42, 17
v_cvt_pk_bf16_f32 v92, v88, v89
v_cvt_pk_bf16_f32 v93, v90, v91
buffer_store_dwordx2 v[92:93], v11, s[8:11], s60 offen sc1
s_add_u32 s42, s42, 1
s_cmp_lt_u32 s42, s65
s_cbranch_scc1 mega_kernel_o_cold
s_cmp_eq_u32 s71, 1
s_cbranch_scc1 mega_kernel_o_fin
s_mov_b32 s71, 1
s_mov_b32 s42, s64
s_mov_b32 s65, s70
v_mov_b32 v12, v16
v_mov_b32 v11, v17
s_and_b32 s60, s42, s69
s_lshl_b32 s60, s60, 12
buffer_load_dwordx4 v[88:91], v13, s[84:87], s60 offen sc1
s_branch mega_kernel_o_cold
mega_kernel_o_fin:
mega_kernel_o_quit:
s_endpgm
mega_kernel_exit:
s_endpgm
mega_kernel_recf:
s_load_dwordx2 s[20:21], s[0:1], 8
s_load_dwordx2 s[16:17], s[0:1], 40
s_load_dwordx2 s[4:5], s[0:1], 16
s_load_dwordx2 s[8:9], s[0:1], 24
s_load_dwordx2 s[12:13], s[0:1], 32
v_lshrrev_b32 v4, 6, v0
v_and_b32 v1, 63, v0
v_readfirstlane_b32 s24, v4
v_lshrrev_b32 v2, 4, v1
v_and_b32 v3, 15, v1
v_lshlrev_b32 v17, 4, v1
s_lshr_b32 s28, s31, 2
s_lshl_b32 s25, s30, 3
s_add_u32 s25, s25, s28
s_and_b32 s26, s31, 3
s_waitcnt lgkmcnt(0)
s_mov_b32 s22, 16384
s_mov_b32 s23, 0x00020000
s_mov_b32 s18, 8388608
s_mov_b32 s19, 0x00020000
s_mov_b32 s6, 8388608
s_mov_b32 s7, 0x00020000
s_mov_b32 s10, 8388608
s_mov_b32 s11, 0x00020000
s_mov_b32 s14, 8388608
s_mov_b32 s15, 0x00020000
s_lshl_b32 s28, s25, 8
s_lshr_b32 s29, s26, 0
s_lshl_b32 s29, s29, 6
s_add_u32 s28, s28, s29
s_lshl_b32 s29, s24, 21
s_add_u32 s28, s28, s29
v_lshrrev_b32 v4, 2, v1
v_and_b32 v5, 3, v1
v_lshlrev_b32 v40, 13, v4
v_lshl_add_u32 v40, v5, 4, v40
v_add_u32 v40, s28, v40
s_lshl_b32 s28, s30, 21
s_lshl_b32 s29, s24, 19
s_add_u32 s28, s28, s29
s_lshr_b32 s29, s31, 0
s_lshl_b32 s29, s29, 6
s_add_u32 s28, s28, s29
v_lshlrev_b32 v41, 11, v4
v_lshl_add_u32 v41, v5, 4, v41
v_add_u32 v41, s28, v41
s_lshl_b32 s47, s24, 15
s_add_u32 s47, s47, 32768
s_lshl_b32 s28, s31, 18
s_lshl_b32 s29, s24, 16
s_add_u32 s28, s28, s29
s_lshl_b32 s29, s30, 11
s_add_u32 s28, s28, s29
v_lshlrev_b32 v48, 13, v2
v_lshl_add_u32 v48, v3, 7, v48
v_add_u32 v48, s28, v48
s_lshl_b32 s28, s30, 21
s_lshl_b32 s29, s31, 16
s_add_u32 s28, s28, s29
s_lshl_b32 s29, s24, 14
s_add_u32 s28, s28, s29
v_lshlrev_b32 v49, 7, v1
v_add_u32 v49, s28, v49
s_and_b32 s76, s31, 1
s_mul_i32 s76, s76, 8
s_and_b32 s28, s31, 15
s_lshl_b32 s28, s28, 4
s_lshl_b32 s29, s24, 8
s_add_u32 s28, s28, s29
v_add_u32 v53, s28, v3
s_lshr_b32 s28, s31, 4
s_lshl_b32 s28, s28, 10
s_add_u32 s28, s28, 384
v_mov_b32 v54, s28
v_mov_b32 v55, 1920
v_cmp_gt_u32 vcc, 32, v1
s_nop 1
v_cndmask_b32 v54, v55, v54, vcc
s_lshl_b32 s29, s30, 11
v_lshl_add_u32 v51, v53, 13, v54
v_add_u32 v51, s29, v51
s_lshl_b32 s29, s30, 21
v_lshl_add_u32 v52, v53, 11, v54
v_add_u32 v52, s29, v52
buffer_load_dword v50, v51, s[8:11], 0 offen
s_xor_b32 s29, s76, 0
s_lshl_b32 s28, s29, 10
s_add_u32 s28, s28, s47
s_add_u32 m0, s28, 0
s_lshl_b32 s29, s29, 17
buffer_load_dwordx4 v40, s[8:11], s29 offen lds
s_xor_b32 s29, s76, 1
s_lshl_b32 s28, s29, 10
s_add_u32 s28, s28, s47
s_add_u32 m0, s28, 0
s_lshl_b32 s29, s29, 17
buffer_load_dwordx4 v40, s[8:11], s29 offen lds
s_xor_b32 s29, s76, 2
s_lshl_b32 s28, s29, 10
s_add_u32 s28, s28, s47
s_add_u32 m0, s28, 0
s_lshl_b32 s29, s29, 17
buffer_load_dwordx4 v40, s[8:11], s29 offen lds
s_xor_b32 s29, s76, 3
s_lshl_b32 s28, s29, 10
s_add_u32 s28, s28, s47
s_add_u32 m0, s28, 0
s_lshl_b32 s29, s29, 17
buffer_load_dwordx4 v40, s[8:11], s29 offen lds
s_xor_b32 s29, s76, 4
s_lshl_b32 s28, s29, 10
s_add_u32 s28, s28, s47
s_add_u32 m0, s28, 0
s_lshl_b32 s29, s29, 17
buffer_load_dwordx4 v40, s[8:11], s29 offen lds
s_xor_b32 s29, s76, 5
s_lshl_b32 s28, s29, 10
s_add_u32 s28, s28, s47
s_add_u32 m0, s28, 0
s_lshl_b32 s29, s29, 17
buffer_load_dwordx4 v40, s[8:11], s29 offen lds
s_xor_b32 s29, s76, 6
s_lshl_b32 s28, s29, 10
s_add_u32 s28, s28, s47
s_add_u32 m0, s28, 0
s_lshl_b32 s29, s29, 17
buffer_load_dwordx4 v40, s[8:11], s29 offen lds
s_xor_b32 s29, s76, 7
s_lshl_b32 s28, s29, 10
s_add_u32 s28, s28, s47
s_add_u32 m0, s28, 0
s_lshl_b32 s29, s29, 17
buffer_load_dwordx4 v40, s[8:11], s29 offen lds
s_xor_b32 s29, s76, 8
s_lshl_b32 s28, s29, 10
s_add_u32 s28, s28, s47
s_add_u32 m0, s28, 0
s_lshl_b32 s29, s29, 17
buffer_load_dwordx4 v40, s[8:11], s29 offen lds
s_xor_b32 s29, s76, 9
s_lshl_b32 s28, s29, 10
s_add_u32 s28, s28, s47
s_add_u32 m0, s28, 0
s_lshl_b32 s29, s29, 17
buffer_load_dwordx4 v40, s[8:11], s29 offen lds
s_xor_b32 s29, s76, 10
s_lshl_b32 s28, s29, 10
s_add_u32 s28, s28, s47
s_add_u32 m0, s28, 0
s_lshl_b32 s29, s29, 17
buffer_load_dwordx4 v40, s[8:11], s29 offen lds
s_xor_b32 s29, s76, 11
s_lshl_b32 s28, s29, 10
s_add_u32 s28, s28, s47
s_add_u32 m0, s28, 0
s_lshl_b32 s29, s29, 17
buffer_load_dwordx4 v40, s[8:11], s29 offen lds
s_xor_b32 s29, s76, 12
s_lshl_b32 s28, s29, 10
s_add_u32 s28, s28, s47
s_add_u32 m0, s28, 0
s_lshl_b32 s29, s29, 17
buffer_load_dwordx4 v40, s[8:11], s29 offen lds
s_xor_b32 s29, s76, 13
s_lshl_b32 s28, s29, 10
s_add_u32 s28, s28, s47
s_add_u32 m0, s28, 0
s_lshl_b32 s29, s29, 17
buffer_load_dwordx4 v40, s[8:11], s29 offen lds
s_xor_b32 s29, s76, 14
s_lshl_b32 s28, s29, 10
s_add_u32 s28, s28, s47
s_add_u32 m0, s28, 0
s_lshl_b32 s29, s29, 17
buffer_load_dwordx4 v40, s[8:11], s29 offen lds
s_xor_b32 s29, s76, 15
s_lshl_b32 s28, s29, 10
s_add_u32 s28, s28, s47
s_add_u32 m0, s28, 0
s_lshl_b32 s29, s29, 17
buffer_load_dwordx4 v40, s[8:11], s29 offen lds
buffer_load_dword v50, v51, s[12:15], 0 offen
s_xor_b32 s29, s76, 0
s_lshl_b32 s28, s29, 10
s_add_u32 s28, s28, s47
s_add_u32 m0, s28, 16384
s_lshl_b32 s29, s29, 17
buffer_load_dwordx4 v40, s[12:15], s29 offen lds
s_xor_b32 s29, s76, 1
s_lshl_b32 s28, s29, 10
s_add_u32 s28, s28, s47
s_add_u32 m0, s28, 16384
s_lshl_b32 s29, s29, 17
buffer_load_dwordx4 v40, s[12:15], s29 offen lds
s_xor_b32 s29, s76, 2
s_lshl_b32 s28, s29, 10
s_add_u32 s28, s28, s47
s_add_u32 m0, s28, 16384
s_lshl_b32 s29, s29, 17
buffer_load_dwordx4 v40, s[12:15], s29 offen lds
s_xor_b32 s29, s76, 3
s_lshl_b32 s28, s29, 10
s_add_u32 s28, s28, s47
s_add_u32 m0, s28, 16384
s_lshl_b32 s29, s29, 17
buffer_load_dwordx4 v40, s[12:15], s29 offen lds
s_xor_b32 s29, s76, 4
s_lshl_b32 s28, s29, 10
s_add_u32 s28, s28, s47
s_add_u32 m0, s28, 16384
s_lshl_b32 s29, s29, 17
buffer_load_dwordx4 v40, s[12:15], s29 offen lds
s_xor_b32 s29, s76, 5
s_lshl_b32 s28, s29, 10
s_add_u32 s28, s28, s47
s_add_u32 m0, s28, 16384
s_lshl_b32 s29, s29, 17
buffer_load_dwordx4 v40, s[12:15], s29 offen lds
s_xor_b32 s29, s76, 6
s_lshl_b32 s28, s29, 10
s_add_u32 s28, s28, s47
s_add_u32 m0, s28, 16384
s_lshl_b32 s29, s29, 17
buffer_load_dwordx4 v40, s[12:15], s29 offen lds
s_xor_b32 s29, s76, 7
s_lshl_b32 s28, s29, 10
s_add_u32 s28, s28, s47
s_add_u32 m0, s28, 16384
s_lshl_b32 s29, s29, 17
buffer_load_dwordx4 v40, s[12:15], s29 offen lds
s_xor_b32 s29, s76, 8
s_lshl_b32 s28, s29, 10
s_add_u32 s28, s28, s47
s_add_u32 m0, s28, 16384
s_lshl_b32 s29, s29, 17
buffer_load_dwordx4 v40, s[12:15], s29 offen lds
s_xor_b32 s29, s76, 9
s_lshl_b32 s28, s29, 10
s_add_u32 s28, s28, s47
s_add_u32 m0, s28, 16384
s_lshl_b32 s29, s29, 17
buffer_load_dwordx4 v40, s[12:15], s29 offen lds
s_xor_b32 s29, s76, 10
s_lshl_b32 s28, s29, 10
s_add_u32 s28, s28, s47
s_add_u32 m0, s28, 16384
s_lshl_b32 s29, s29, 17
buffer_load_dwordx4 v40, s[12:15], s29 offen lds
s_xor_b32 s29, s76, 11
s_lshl_b32 s28, s29, 10
s_add_u32 s28, s28, s47
s_add_u32 m0, s28, 16384
s_lshl_b32 s29, s29, 17
buffer_load_dwordx4 v40, s[12:15], s29 offen lds
s_xor_b32 s29, s76, 12
s_lshl_b32 s28, s29, 10
s_add_u32 s28, s28, s47
s_add_u32 m0, s28, 16384
s_lshl_b32 s29, s29, 17
buffer_load_dwordx4 v40, s[12:15], s29 offen lds
s_xor_b32 s29, s76, 13
s_lshl_b32 s28, s29, 10
s_add_u32 s28, s28, s47
s_add_u32 m0, s28, 16384
s_lshl_b32 s29, s29, 17
buffer_load_dwordx4 v40, s[12:15], s29 offen lds
s_xor_b32 s29, s76, 14
s_lshl_b32 s28, s29, 10
s_add_u32 s28, s28, s47
s_add_u32 m0, s28, 16384
s_lshl_b32 s29, s29, 17
buffer_load_dwordx4 v40, s[12:15], s29 offen lds
s_xor_b32 s29, s76, 15
s_lshl_b32 s28, s29, 10
s_add_u32 s28, s28, s47
s_add_u32 m0, s28, 16384
s_lshl_b32 s29, s29, 17
buffer_load_dwordx4 v40, s[12:15], s29 offen lds
s_mov_b32 s40, 0x00ff00ff
s_mov_b32 s41, 0x00ff00ff
s_mov_b32 s48, 0xff00ff00
s_mov_b32 s49, 0xff00ff00
s_mov_b32 s42, 0
s_mov_b32 s43, 0x00ff00ff
s_mov_b32 s32, 0x3e0293ee
v_mov_b32 v23, 0xff800000
v_mov_b32 v6, 0x4444
v_mov_b32 v4, 0xeeee
v_cndmask_b32 v6, v6, v4, s[48:49]
v_mov_b32 v28, -1
v_mov_b32 v29, -1
v_mov_b32 v30, -1
v_mov_b32 v31, -1
s_mul_i32 s28, s24, 4096
v_add_u32 v7, s28, v17
v_and_b32 v4, 7, v1
v_lshlrev_b32 v8, 11, v4
v_lshrrev_b32 v5, 3, v1
v_lshl_add_u32 v8, v5, 4, v8
s_lshl_b32 s28, s24, 9
v_add_u32 v8, s28, v8
s_lshl_b32 s28, s31, 9
s_lshr_b32 s29, s31, 3
s_mul_i32 s29, s29, 0
s_add_u32 s28, s28, s29
v_lshlrev_b32 v9, 3, v1
v_add_u32 v9, s28, v9
v_and_b32 v4, 7, v3
v_lshlrev_b32 v11, 7, v2
v_lshl_add_u32 v11, v4, 4, v11
v_add_u32 v22, 0, v11
s_add_u32 s28, s28, 24576
v_add_u32 v11, s28, v11
v_and_b32 v5, 1, v2
v_lshlrev_b32 v10, 7, v5
v_lshl_add_u32 v10, v4, 4, v10
v_add_u32 v10, 1024, v10
s_xor_b32 s37, s31, 1
s_mul_i32 s37, s37, 2048
s_add_u32 s37, s37, 49152
s_xor_b32 s38, s31, 2
s_mul_i32 s38, s38, 2048
s_add_u32 s38, s38, 49152
s_xor_b32 s39, s31, 3
s_mul_i32 s39, s39, 2048
s_add_u32 s39, s39, 49152
v_and_b32 v4, 1, v2
v_mul_u32_u24 v14, 576, v4
v_lshrrev_b32 v5, 1, v2
v_lshl_add_u32 v5, v5, 4, v3
v_lshl_add_u32 v14, v5, 2, v14
s_mul_i32 s28, s24, 1152
s_add_u32 s28, s28, 13312
v_add_u32 v18, s28, v14
s_mul_i32 s28, s24, 2304
v_add_u32 v14, s28, v14
v_add_u32 v15, 1152, v14
v_mul_u32_u24 v16, 144, v3
v_lshl_add_u32 v16, v2, 5, v16
v_bfe_u32 v4, v1, 1, 3
v_mul_u32_u24 v19, 144, v4
v_lshl_add_u32 v19, v2, 5, v19
v_and_b32 v4, 1, v1
v_lshl_add_u32 v19, v4, 4, v19
v_add_u32 v19, 13312, v19
s_lshl_b32 s28, s24, 10
s_add_u32 s28, s28, 9216
v_add_u32 v20, s28, v17
v_and_b32 v4, 31, v1
v_lshlrev_b32 v21, 3, v4
v_add_u32 v21, 17920, v21
v_lshrrev_b32 v4, 2, v3
v_and_b32 v42, 1, v4
v_lshrrev_b32 v43, 1, v4
v_lshrrev_b32 v44, 1, v2
v_and_b32 v45, 1, v2
v_lshl_add_u32 v46, v44, 4, v42
v_lshl_add_u32 v46, v45, 2, v46
v_lshl_add_u32 v46, v43, 3, v46
v_lshl_add_u32 v47, v44, 3, v42
v_lshl_add_u32 v47, v45, 4, v47
v_lshl_add_u32 v47, v43, 2, v47
v_and_b32 v5, 3, v3
v_lshlrev_b32 v5, 3, v5
v_lshl_add_u32 v46, v46, 6, v5
v_lshl_add_u32 v47, v47, 6, v5
s_and_b32 s28, s31, 0
s_lshl_b32 s28, s28, 6
s_add_u32 s28, s28, s47
v_add_u32 v46, s28, v46
v_add_u32 v47, s28, v47
s_waitcnt vmcnt(17)
ds_read_b64_tr_b16 a[64:65], v46 offset:0
ds_read_b64_tr_b16 a[66:67], v46 offset:128
ds_read_b64_tr_b16 a[68:69], v46 offset:2048
ds_read_b64_tr_b16 a[70:71], v46 offset:2176
ds_read_b64_tr_b16 a[72:73], v46 offset:4096
ds_read_b64_tr_b16 a[74:75], v46 offset:4224
ds_read_b64_tr_b16 a[76:77], v46 offset:6144
ds_read_b64_tr_b16 a[78:79], v46 offset:6272
s_waitcnt lgkmcnt(0)
ds_read_b64_tr_b16 a[80:81], v46 offset:8192
ds_read_b64_tr_b16 a[82:83], v46 offset:8320
ds_read_b64_tr_b16 a[84:85], v46 offset:10240
ds_read_b64_tr_b16 a[86:87], v46 offset:10368
ds_read_b64_tr_b16 a[88:89], v46 offset:12288
ds_read_b64_tr_b16 a[90:91], v46 offset:12416
ds_read_b64_tr_b16 a[92:93], v46 offset:14336
ds_read_b64_tr_b16 a[94:95], v46 offset:14464
s_waitcnt lgkmcnt(0)
ds_read_b64_tr_b16 a[96:97], v46 offset:32
ds_read_b64_tr_b16 a[98:99], v46 offset:160
ds_read_b64_tr_b16 a[100:101], v46 offset:2080
ds_read_b64_tr_b16 a[102:103], v46 offset:2208
ds_read_b64_tr_b16 a[104:105], v46 offset:4128
ds_read_b64_tr_b16 a[106:107], v46 offset:4256
ds_read_b64_tr_b16 a[108:109], v46 offset:6176
ds_read_b64_tr_b16 a[110:111], v46 offset:6304
s_waitcnt lgkmcnt(0)
ds_read_b64_tr_b16 a[112:113], v46 offset:8224
ds_read_b64_tr_b16 a[114:115], v46 offset:8352
ds_read_b64_tr_b16 a[116:117], v46 offset:10272
ds_read_b64_tr_b16 a[118:119], v46 offset:10400
ds_read_b64_tr_b16 a[120:121], v46 offset:12320
ds_read_b64_tr_b16 a[122:123], v46 offset:12448
ds_read_b64_tr_b16 a[124:125], v46 offset:14368
ds_read_b64_tr_b16 a[126:127], v46 offset:14496
s_waitcnt lgkmcnt(0)
buffer_load_dword v50, v51, s[4:7], 0 offen
s_xor_b32 s29, s76, 0
s_lshl_b32 s28, s29, 10
s_add_u32 s28, s28, s47
s_add_u32 m0, s28, 0
s_lshl_b32 s29, s29, 17
buffer_load_dwordx4 v40, s[4:7], s29 offen lds
s_xor_b32 s29, s76, 1
s_lshl_b32 s28, s29, 10
s_add_u32 s28, s28, s47
s_add_u32 m0, s28, 0
s_lshl_b32 s29, s29, 17
buffer_load_dwordx4 v40, s[4:7], s29 offen lds
s_xor_b32 s29, s76, 2
s_lshl_b32 s28, s29, 10
s_add_u32 s28, s28, s47
s_add_u32 m0, s28, 0
s_lshl_b32 s29, s29, 17
buffer_load_dwordx4 v40, s[4:7], s29 offen lds
s_xor_b32 s29, s76, 3
s_lshl_b32 s28, s29, 10
s_add_u32 s28, s28, s47
s_add_u32 m0, s28, 0
s_lshl_b32 s29, s29, 17
buffer_load_dwordx4 v40, s[4:7], s29 offen lds
s_xor_b32 s29, s76, 4
s_lshl_b32 s28, s29, 10
s_add_u32 s28, s28, s47
s_add_u32 m0, s28, 0
s_lshl_b32 s29, s29, 17
buffer_load_dwordx4 v40, s[4:7], s29 offen lds
s_xor_b32 s29, s76, 5
s_lshl_b32 s28, s29, 10
s_add_u32 s28, s28, s47
s_add_u32 m0, s28, 0
s_lshl_b32 s29, s29, 17
buffer_load_dwordx4 v40, s[4:7], s29 offen lds
s_xor_b32 s29, s76, 6
s_lshl_b32 s28, s29, 10
s_add_u32 s28, s28, s47
s_add_u32 m0, s28, 0
s_lshl_b32 s29, s29, 17
buffer_load_dwordx4 v40, s[4:7], s29 offen lds
s_xor_b32 s29, s76, 7
s_lshl_b32 s28, s29, 10
s_add_u32 s28, s28, s47
s_add_u32 m0, s28, 0
s_lshl_b32 s29, s29, 17
buffer_load_dwordx4 v40, s[4:7], s29 offen lds
s_xor_b32 s29, s76, 8
s_lshl_b32 s28, s29, 10
s_add_u32 s28, s28, s47
s_add_u32 m0, s28, 0
s_lshl_b32 s29, s29, 17
buffer_load_dwordx4 v40, s[4:7], s29 offen lds
s_xor_b32 s29, s76, 9
s_lshl_b32 s28, s29, 10
s_add_u32 s28, s28, s47
s_add_u32 m0, s28, 0
s_lshl_b32 s29, s29, 17
buffer_load_dwordx4 v40, s[4:7], s29 offen lds
s_xor_b32 s29, s76, 10
s_lshl_b32 s28, s29, 10
s_add_u32 s28, s28, s47
s_add_u32 m0, s28, 0
s_lshl_b32 s29, s29, 17
buffer_load_dwordx4 v40, s[4:7], s29 offen lds
s_xor_b32 s29, s76, 11
s_lshl_b32 s28, s29, 10
s_add_u32 s28, s28, s47
s_add_u32 m0, s28, 0
s_lshl_b32 s29, s29, 17
buffer_load_dwordx4 v40, s[4:7], s29 offen lds
s_xor_b32 s29, s76, 12
s_lshl_b32 s28, s29, 10
s_add_u32 s28, s28, s47
s_add_u32 m0, s28, 0
s_lshl_b32 s29, s29, 17
buffer_load_dwordx4 v40, s[4:7], s29 offen lds
s_xor_b32 s29, s76, 13
s_lshl_b32 s28, s29, 10
s_add_u32 s28, s28, s47
s_add_u32 m0, s28, 0
s_lshl_b32 s29, s29, 17
buffer_load_dwordx4 v40, s[4:7], s29 offen lds
s_xor_b32 s29, s76, 14
s_lshl_b32 s28, s29, 10
s_add_u32 s28, s28, s47
s_add_u32 m0, s28, 0
s_lshl_b32 s29, s29, 17
buffer_load_dwordx4 v40, s[4:7], s29 offen lds
s_xor_b32 s29, s76, 15
s_lshl_b32 s28, s29, 10
s_add_u32 s28, s28, s47
s_add_u32 m0, s28, 0
s_lshl_b32 s29, s29, 17
buffer_load_dwordx4 v40, s[4:7], s29 offen lds
s_waitcnt vmcnt(17)
ds_read_b64_tr_b16 a[128:129], v46 offset:16384
ds_read_b64_tr_b16 a[130:131], v46 offset:16512
ds_read_b64_tr_b16 a[132:133], v46 offset:18432
ds_read_b64_tr_b16 a[134:135], v46 offset:18560
ds_read_b64_tr_b16 a[136:137], v46 offset:20480
ds_read_b64_tr_b16 a[138:139], v46 offset:20608
ds_read_b64_tr_b16 a[140:141], v46 offset:22528
ds_read_b64_tr_b16 a[142:143], v46 offset:22656
s_waitcnt lgkmcnt(0)
ds_read_b64_tr_b16 a[144:145], v46 offset:24576
ds_read_b64_tr_b16 a[146:147], v46 offset:24704
ds_read_b64_tr_b16 a[148:149], v46 offset:26624
ds_read_b64_tr_b16 a[150:151], v46 offset:26752
ds_read_b64_tr_b16 a[152:153], v46 offset:28672
ds_read_b64_tr_b16 a[154:155], v46 offset:28800
ds_read_b64_tr_b16 a[156:157], v46 offset:30720
ds_read_b64_tr_b16 a[158:159], v46 offset:30848
s_waitcnt lgkmcnt(0)
ds_read_b64_tr_b16 a[160:161], v46 offset:16416
ds_read_b64_tr_b16 a[162:163], v46 offset:16544
ds_read_b64_tr_b16 a[164:165], v46 offset:18464
ds_read_b64_tr_b16 a[166:167], v46 offset:18592
ds_read_b64_tr_b16 a[168:169], v46 offset:20512
ds_read_b64_tr_b16 a[170:171], v46 offset:20640
ds_read_b64_tr_b16 a[172:173], v46 offset:22560
ds_read_b64_tr_b16 a[174:175], v46 offset:22688
s_waitcnt lgkmcnt(0)
ds_read_b64_tr_b16 a[176:177], v46 offset:24608
ds_read_b64_tr_b16 a[178:179], v46 offset:24736
ds_read_b64_tr_b16 a[180:181], v46 offset:26656
ds_read_b64_tr_b16 a[182:183], v46 offset:26784
ds_read_b64_tr_b16 a[184:185], v46 offset:28704
ds_read_b64_tr_b16 a[186:187], v46 offset:28832
ds_read_b64_tr_b16 a[188:189], v46 offset:30752
ds_read_b64_tr_b16 a[190:191], v46 offset:30880
s_waitcnt lgkmcnt(0)
buffer_load_dword v50, v52, s[16:19], 0 offen
s_xor_b32 s29, s76, 0
s_lshl_b32 s28, s29, 10
s_add_u32 s28, s28, s47
s_add_u32 m0, s28, 16384
s_lshl_b32 s29, s29, 15
buffer_load_dwordx4 v41, s[16:19], s29 offen lds
s_xor_b32 s29, s76, 1
s_lshl_b32 s28, s29, 10
s_add_u32 s28, s28, s47
s_add_u32 m0, s28, 16384
s_lshl_b32 s29, s29, 15
buffer_load_dwordx4 v41, s[16:19], s29 offen lds
s_xor_b32 s29, s76, 2
s_lshl_b32 s28, s29, 10
s_add_u32 s28, s28, s47
s_add_u32 m0, s28, 16384
s_lshl_b32 s29, s29, 15
buffer_load_dwordx4 v41, s[16:19], s29 offen lds
s_xor_b32 s29, s76, 3
s_lshl_b32 s28, s29, 10
s_add_u32 s28, s28, s47
s_add_u32 m0, s28, 16384
s_lshl_b32 s29, s29, 15
buffer_load_dwordx4 v41, s[16:19], s29 offen lds
s_xor_b32 s29, s76, 4
s_lshl_b32 s28, s29, 10
s_add_u32 s28, s28, s47
s_add_u32 m0, s28, 16384
s_lshl_b32 s29, s29, 15
buffer_load_dwordx4 v41, s[16:19], s29 offen lds
s_xor_b32 s29, s76, 5
s_lshl_b32 s28, s29, 10
s_add_u32 s28, s28, s47
s_add_u32 m0, s28, 16384
s_lshl_b32 s29, s29, 15
buffer_load_dwordx4 v41, s[16:19], s29 offen lds
s_xor_b32 s29, s76, 6
s_lshl_b32 s28, s29, 10
s_add_u32 s28, s28, s47
s_add_u32 m0, s28, 16384
s_lshl_b32 s29, s29, 15
buffer_load_dwordx4 v41, s[16:19], s29 offen lds
s_xor_b32 s29, s76, 7
s_lshl_b32 s28, s29, 10
s_add_u32 s28, s28, s47
s_add_u32 m0, s28, 16384
s_lshl_b32 s29, s29, 15
buffer_load_dwordx4 v41, s[16:19], s29 offen lds
s_xor_b32 s29, s76, 8
s_lshl_b32 s28, s29, 10
s_add_u32 s28, s28, s47
s_add_u32 m0, s28, 16384
s_lshl_b32 s29, s29, 15
buffer_load_dwordx4 v41, s[16:19], s29 offen lds
s_xor_b32 s29, s76, 9
s_lshl_b32 s28, s29, 10
s_add_u32 s28, s28, s47
s_add_u32 m0, s28, 16384
s_lshl_b32 s29, s29, 15
buffer_load_dwordx4 v41, s[16:19], s29 offen lds
s_xor_b32 s29, s76, 10
s_lshl_b32 s28, s29, 10
s_add_u32 s28, s28, s47
s_add_u32 m0, s28, 16384
s_lshl_b32 s29, s29, 15
buffer_load_dwordx4 v41, s[16:19], s29 offen lds
s_xor_b32 s29, s76, 11
s_lshl_b32 s28, s29, 10
s_add_u32 s28, s28, s47
s_add_u32 m0, s28, 16384
s_lshl_b32 s29, s29, 15
buffer_load_dwordx4 v41, s[16:19], s29 offen lds
s_xor_b32 s29, s76, 12
s_lshl_b32 s28, s29, 10
s_add_u32 s28, s28, s47
s_add_u32 m0, s28, 16384
s_lshl_b32 s29, s29, 15
buffer_load_dwordx4 v41, s[16:19], s29 offen lds
s_xor_b32 s29, s76, 13
s_lshl_b32 s28, s29, 10
s_add_u32 s28, s28, s47
s_add_u32 m0, s28, 16384
s_lshl_b32 s29, s29, 15
buffer_load_dwordx4 v41, s[16:19], s29 offen lds
s_xor_b32 s29, s76, 14
s_lshl_b32 s28, s29, 10
s_add_u32 s28, s28, s47
s_add_u32 m0, s28, 16384
s_lshl_b32 s29, s29, 15
buffer_load_dwordx4 v41, s[16:19], s29 offen lds
s_xor_b32 s29, s76, 15
s_lshl_b32 s28, s29, 10
s_add_u32 s28, s28, s47
s_add_u32 m0, s28, 16384
s_lshl_b32 s29, s29, 15
buffer_load_dwordx4 v41, s[16:19], s29 offen lds
s_waitcnt vmcnt(17)
ds_read_b64_tr_b16 a[0:1], v46 offset:0
ds_read_b64_tr_b16 a[2:3], v46 offset:128
ds_read_b64_tr_b16 a[4:5], v46 offset:2048
ds_read_b64_tr_b16 a[6:7], v46 offset:2176
ds_read_b64_tr_b16 a[8:9], v46 offset:4096
ds_read_b64_tr_b16 a[10:11], v46 offset:4224
ds_read_b64_tr_b16 a[12:13], v46 offset:6144
ds_read_b64_tr_b16 a[14:15], v46 offset:6272
s_waitcnt lgkmcnt(0)
ds_read_b64_tr_b16 a[16:17], v46 offset:8192
ds_read_b64_tr_b16 a[18:19], v46 offset:8320
ds_read_b64_tr_b16 a[20:21], v46 offset:10240
ds_read_b64_tr_b16 a[22:23], v46 offset:10368
ds_read_b64_tr_b16 a[24:25], v46 offset:12288
ds_read_b64_tr_b16 a[26:27], v46 offset:12416
ds_read_b64_tr_b16 a[28:29], v46 offset:14336
ds_read_b64_tr_b16 a[30:31], v46 offset:14464
s_waitcnt lgkmcnt(0)
ds_read_b64_tr_b16 a[32:33], v46 offset:32
ds_read_b64_tr_b16 a[34:35], v46 offset:160
ds_read_b64_tr_b16 a[36:37], v46 offset:2080
ds_read_b64_tr_b16 a[38:39], v46 offset:2208
ds_read_b64_tr_b16 a[40:41], v46 offset:4128
ds_read_b64_tr_b16 a[42:43], v46 offset:4256
ds_read_b64_tr_b16 a[44:45], v46 offset:6176
ds_read_b64_tr_b16 a[46:47], v46 offset:6304
s_waitcnt lgkmcnt(0)
ds_read_b64_tr_b16 a[48:49], v46 offset:8224
ds_read_b64_tr_b16 a[50:51], v46 offset:8352
ds_read_b64_tr_b16 a[52:53], v46 offset:10272
ds_read_b64_tr_b16 a[54:55], v46 offset:10400
ds_read_b64_tr_b16 a[56:57], v46 offset:12320
ds_read_b64_tr_b16 a[58:59], v46 offset:12448
ds_read_b64_tr_b16 a[60:61], v46 offset:14368
ds_read_b64_tr_b16 a[62:63], v46 offset:14496
s_waitcnt lgkmcnt(0)
s_waitcnt vmcnt(0)
ds_read_b64_tr_b16 a[192:193], v47 offset:16384
ds_read_b64_tr_b16 a[194:195], v47 offset:16512
ds_read_b64_tr_b16 a[196:197], v47 offset:18432
ds_read_b64_tr_b16 a[198:199], v47 offset:18560
ds_read_b64_tr_b16 a[200:201], v47 offset:20480
ds_read_b64_tr_b16 a[202:203], v47 offset:20608
ds_read_b64_tr_b16 a[204:205], v47 offset:22528
ds_read_b64_tr_b16 a[206:207], v47 offset:22656
s_waitcnt lgkmcnt(0)
ds_read_b64_tr_b16 a[208:209], v47 offset:24576
ds_read_b64_tr_b16 a[210:211], v47 offset:24704
ds_read_b64_tr_b16 a[212:213], v47 offset:26624
ds_read_b64_tr_b16 a[214:215], v47 offset:26752
ds_read_b64_tr_b16 a[216:217], v47 offset:28672
ds_read_b64_tr_b16 a[218:219], v47 offset:28800
ds_read_b64_tr_b16 a[220:221], v47 offset:30720
ds_read_b64_tr_b16 a[222:223], v47 offset:30848
s_waitcnt lgkmcnt(0)
ds_read_b64_tr_b16 a[224:225], v47 offset:16416
ds_read_b64_tr_b16 a[226:227], v47 offset:16544
ds_read_b64_tr_b16 a[228:229], v47 offset:18464
ds_read_b64_tr_b16 a[230:231], v47 offset:18592
ds_read_b64_tr_b16 a[232:233], v47 offset:20512
ds_read_b64_tr_b16 a[234:235], v47 offset:20640
ds_read_b64_tr_b16 a[236:237], v47 offset:22560
ds_read_b64_tr_b16 a[238:239], v47 offset:22688
s_waitcnt lgkmcnt(0)
ds_read_b64_tr_b16 a[240:241], v47 offset:24608
ds_read_b64_tr_b16 a[242:243], v47 offset:24736
ds_read_b64_tr_b16 a[244:245], v47 offset:26656
ds_read_b64_tr_b16 a[246:247], v47 offset:26784
ds_read_b64_tr_b16 a[248:249], v47 offset:28704
ds_read_b64_tr_b16 a[250:251], v47 offset:28832
ds_read_b64_tr_b16 a[252:253], v47 offset:30752
ds_read_b64_tr_b16 a[254:255], v47 offset:30880
s_waitcnt lgkmcnt(0)
v_and_b32 v5, 15, v0
v_lshlrev_b32 v5, 4, v5
s_branch mega_kernel_syr
mega_kernel_syrw:
s_sleep 4
mega_kernel_syr:
buffer_load_dword v4, v5, s[72:75], 0 offen sc1
s_waitcnt vmcnt(0)
s_cmp_eq_u32 s95, 1
s_cbranch_scc0 mega_kernel_syrf
v_readlane_b32 s76, v4, 14
s_mov_b32 s98, 0
s_cmp_eq_u32 s76, 64
s_cbranch_scc0 mega_kernel_syrw
s_branch mega_kernel_syrd
mega_kernel_syrf:
s_mov_b32 s77, 0
s_mov_b32 s78, 0
v_readlane_b32 s76, v4, 0
s_add_u32 s77, s77, s76
s_xor_b32 s76, s76, 32
s_or_b32 s78, s78, s76
v_readlane_b32 s76, v4, 1
s_add_u32 s77, s77, s76
s_xor_b32 s76, s76, 32
s_or_b32 s78, s78, s76
v_readlane_b32 s76, v4, 2
s_add_u32 s77, s77, s76
s_xor_b32 s76, s76, 32
s_or_b32 s78, s78, s76
v_readlane_b32 s76, v4, 3
s_add_u32 s77, s77, s76
s_xor_b32 s76, s76, 32
s_or_b32 s78, s78, s76
v_readlane_b32 s76, v4, 4
s_add_u32 s77, s77, s76
s_xor_b32 s76, s76, 32
s_or_b32 s78, s78, s76
v_readlane_b32 s76, v4, 5
s_add_u32 s77, s77, s76
s_xor_b32 s76, s76, 32
s_or_b32 s78, s78, s76
v_readlane_b32 s76, v4, 6
s_add_u32 s77, s77, s76
s_xor_b32 s76, s76, 32
s_or_b32 s78, s78, s76
v_readlane_b32 s76, v4, 7
s_add_u32 s77, s77, s76
s_xor_b32 s76, s76, 32
s_or_b32 s78, s78, s76
s_cmp_eq_u32 s77, 256
s_cbranch_scc0 mega_kernel_syrw
v_mov_b32 v252, v4
s_cmp_eq_u32 s78, 0
s_cbranch_scc0 mega_kernel_slowent
v_readlane_b32 s76, v4, 10
v_readlane_b32 s77, v4, 8
s_cmp_eq_u32 s76, 64
s_cbranch_scc0 mega_kernel_syrw
s_cmp_gt_u32 s77, 32
s_cselect_b32 s98, 1, 0
mega_kernel_syrd:
s_lshr_b32 s28, s31, 3
s_lshl_b32 s28, s28, 14
s_lshl_b32 s29, s98, 13
s_add_u32 s28, s28, s29
s_and_b32 s29, s31, 7
s_lshl_b32 s29, s29, 10
s_add_u32 s28, s28, s29
s_lshl_b32 s29, s30, 16
s_add_u32 s28, s28, s29
s_add_u32 s28, s28, 67108864
v_add_u32 v12, s28, v17
v_xor_b32 v25, 0x10000, v12
v_xor_b32 v26, 0x20000, v12
v_xor_b32 v27, 0x30000, v12
v_add_u32 v25, 0, v25
v_add_u32 v26, 0, v26
v_add_u32 v27, 0, v27
s_lshl_b32 s28, s25, 2
s_add_u32 s28, s28, s26
s_mov_b32 s82, s28
s_lshr_b32 s29, s28, 3
s_xor_b32 s29, s29, s98
s_and_b32 s29, s29, 1
s_lshl_b32 s29, s29, 13
s_lshl_b32 s76, s28, 18
s_add_u32 s76, s76, s29
s_mov_b32 s83, s76
v_add_u32 v240, s76, v17
v_add_u32 v241, 33554432, v240
s_lshr_b32 s29, s28, 4
s_xor_b32 s29, s29, s98
s_and_b32 s29, s29, 1
s_lshl_b32 s29, s29, 13
s_lshl_b32 s79, s28, 17
s_add_u32 s79, s79, s29
s_add_u32 s79, s79, 71303168
s_xor_b32 s29, s98, 1
s_lshl_b32 s29, s29, 13
s_lshl_b32 s28, s25, 7
s_add_u32 s28, s28, s29
s_add_u32 s28, s28, 69206016
v_and_b32 v4, 1, v1
v_lshlrev_b32 v24, 12, v4
v_add_u32 v24, s28, v24
s_lshl_b32 s29, s26, 2
v_add_u32 v24, s29, v24
s_xor_b32 s81, s98, 1
s_lshl_b32 s81, s81, 13
s_lshr_b32 s29, s82, 6
s_lshl_b32 s29, s29, 14
s_add_u32 s81, s81, s29
s_and_b32 s29, s82, 63
s_lshl_b32 s29, s29, 7
s_add_u32 s81, s81, s29
s_add_u32 s81, s81, 69222400
v_mov_b32 v220, 0x3f803f80
v_mov_b32 v221, 0x3f803f80
v_mov_b32 v222, 0x3f803f80
v_mov_b32 v223, 0x3f803f80
v_mov_b32 v228, 0
s_mov_b32 s27, 0
s_mov_b32 s46, 0
s_mov_b32 s89, 0
s_mov_b32 s88, 0
s_mov_b32 s44, 18432
s_mov_b32 s45, 18432
s_cmp_eq_u32 s24, 3
s_cbranch_scc0 mega_kernel_rf_pfi
s_mov_b32 s76, 0
s_cmp_gt_i32 s46, s76
s_cbranch_scc1 mega_kernel_rf_pf0ok
mega_kernel_rf_pf0w:
buffer_load_dword v4, v24, s[84:87], 0 offen sc1
s_waitcnt vmcnt(0)
v_readlane_b32 s46, v4, 0
v_readlane_b32 s28, v4, 1
s_nop 1
s_min_i32 s46, s46, s28
s_cmp_gt_i32 s46, s76
s_cbranch_scc0 mega_kernel_rf_pf0w
mega_kernel_rf_pf0ok:
s_add_u32 s77, s76, s82
s_bfe_u32 s28, s77, 0x40002
s_lshl_b32 s28, s28, 14
s_and_b32 s77, s77, 3
s_lshl_b32 s77, s77, 11
s_add_u32 s28, s28, s77
s_add_u32 m0, s45, 0
s_nop 0
buffer_load_dwordx4 v240, s[84:87], s28 offen offset:0 sc1 lds
s_add_u32 m0, s45, 0
s_nop 0
buffer_load_dwordx4 v240, s[84:87], s28 offen offset:1024 sc1 lds
s_add_u32 m0, s45, 2048
s_nop 0
buffer_load_dwordx4 v241, s[84:87], s28 offen offset:0 sc1 lds
s_add_u32 m0, s45, 2048
s_nop 0
buffer_load_dwordx4 v241, s[84:87], s28 offen offset:1024 sc1 lds
s_add_u32 s45, s45, 4096
s_cmp_eq_u32 s45, 30720
s_cselect_b32 s45, 18432, s45
s_waitcnt vmcnt(0) lgkmcnt(0)
mega_kernel_rf_pfi:
v_mov_b32 v96, 0
v_mov_b32 v97, 0
v_mov_b32 v98, 0
v_mov_b32 v99, 0
v_mov_b32 v100, 0
v_mov_b32 v101, 0
v_mov_b32 v102, 0
v_mov_b32 v103, 0
v_mov_b32 v104, 0
v_mov_b32 v105, 0
v_mov_b32 v106, 0
v_mov_b32 v107, 0
v_mov_b32 v108, 0
v_mov_b32 v109, 0
v_mov_b32 v110, 0
v_mov_b32 v111, 0
v_mov_b32 v112, 0
v_mov_b32 v113, 0
v_mov_b32 v114, 0
v_mov_b32 v115, 0
v_mov_b32 v116, 0
v_mov_b32 v117, 0
v_mov_b32 v118, 0
v_mov_b32 v119, 0
s_barrier
s_and_b32 s29, s27, 1
s_lshl_b32 s33, s29, 17
s_lshl_b32 s28, s30, 18
s_add_u32 s33, s33, s28
s_add_u32 s33, s33, 68157440
s_xor_b32 s34, s33, 131072
s_lshl_b32 s35, s29, 18
s_bfe_u32 s47, s27, 0x10001
s_branch mega_kernel_rf_first
mega_kernel_rf_loop:
buffer_load_dwordx4 v[32:35], v7, s[84:87], s33 offen offset:0 sc1
v_add_u32 v5, s44, v17
ds_read_b128 v[156:159], v5 offset:0
ds_read_b128 v[160:163], v5 offset:1024
ds_read_b128 v[164:167], v5 offset:2048
ds_read_b128 v[168:171], v5 offset:3072
s_nop 4
buffer_load_dwordx4 v[36:39], v7, s[84:87], s33 offen offset:1024 sc1
s_nop 9
buffer_load_dwordx4 v[40:43], v7, s[84:87], s33 offen offset:2048 sc1
s_nop 9
buffer_load_dwordx4 v[44:47], v7, s[84:87], s33 offen offset:3072 sc1
s_waitcnt vmcnt(3)
v_max_u32 v4, v32, v34
v_cmp_eq_u32 vcc, -1, v4
s_cbranch_vccnz mega_kernel_rf_pa_15_0f
v_smfmac_f32_16x16x64_bf16 v[96:99], v[32:35], a[0:7], v6
v_smfmac_f32_16x16x64_bf16 v[100:103], v[32:35], a[32:39], v6
v_smfmac_f32_16x16x64_bf16 v[104:107], v[32:35], a[64:71], v6
s_waitcnt vmcnt(2)
v_max_u32 v4, v36, v38
v_cmp_eq_u32 vcc, -1, v4
v_smfmac_f32_16x16x64_bf16 v[108:111], v[32:35], a[96:103], v6
s_cbranch_vccnz mega_kernel_rf_pa_14_1f
v_smfmac_f32_16x16x64_bf16 v[96:99], v[36:39], a[8:15], v6
v_smfmac_f32_16x16x64_bf16 v[100:103], v[36:39], a[40:47], v6
v_smfmac_f32_16x16x64_bf16 v[104:107], v[36:39], a[72:79], v6
s_waitcnt vmcnt(1)
v_max_u32 v4, v40, v42
v_cmp_eq_u32 vcc, -1, v4
v_smfmac_f32_16x16x64_bf16 v[108:111], v[36:39], a[104:111], v6
s_cbranch_vccnz mega_kernel_rf_pa_12_2f
v_smfmac_f32_16x16x64_bf16 v[96:99], v[40:43], a[16:23], v6
v_smfmac_f32_16x16x64_bf16 v[100:103], v[40:43], a[48:55], v6
v_smfmac_f32_16x16x64_bf16 v[104:107], v[40:43], a[80:87], v6
s_waitcnt vmcnt(0)
v_max_u32 v4, v44, v46
v_cmp_eq_u32 vcc, -1, v4
v_smfmac_f32_16x16x64_bf16 v[108:111], v[40:43], a[112:119], v6
s_cbranch_vccnz mega_kernel_rf_pa_8_3f
v_smfmac_f32_16x16x64_bf16 v[96:99], v[44:47], a[24:31], v6
v_smfmac_f32_16x16x64_bf16 v[100:103], v[44:47], a[56:63], v6
v_smfmac_f32_16x16x64_bf16 v[104:107], v[44:47], a[88:95], v6
v_smfmac_f32_16x16x64_bf16 v[108:111], v[44:47], a[120:127], v6
mega_kernel_rf_pa_d:
mega_kernel_rf_adone:
s_nop 5
v_permlane32_swap_b32 v96, v100
v_permlane32_swap_b32 v97, v101
v_permlane32_swap_b32 v98, v102
v_permlane32_swap_b32 v99, v103
v_pk_add_f32 v[96:97], v[96:97], v[100:101]
v_pk_add_f32 v[98:99], v[98:99], v[102:103]
ds_write2_b32 v14, v96, v97 offset0:0 offset1:36
ds_write2_b32 v14, v98, v99 offset0:72 offset1:108
v_permlane32_swap_b32 v104, v108
v_permlane32_swap_b32 v105, v109
v_permlane32_swap_b32 v106, v110
v_permlane32_swap_b32 v107, v111
v_pk_add_f32 v[104:105], v[104:105], v[108:109]
v_pk_add_f32 v[106:107], v[106:107], v[110:111]
ds_write2_b32 v15, v104, v105 offset0:0 offset1:36
ds_write2_b32 v15, v106, v107 offset0:72 offset1:108
v_smfmac_f32_16x16x64_bf16 v[112:115], v[32:35], a[128:135], v6
v_smfmac_f32_16x16x64_bf16 v[116:119], v[32:35], a[160:167], v6
v_smfmac_f32_16x16x64_bf16 v[112:115], v[36:39], a[136:143], v6
v_smfmac_f32_16x16x64_bf16 v[116:119], v[36:39], a[168:175], v6
s_waitcnt lgkmcnt(0)
s_barrier
s_cmp_lg_u32 s24, 0
s_cbranch_scc1 mega_kernel_rf_side
ds_read_b128 v[120:123], v16 offset:0
ds_read_b128 v[124:127], v16 offset:16
ds_read_b128 v[128:131], v16 offset:2304
ds_read_b128 v[132:135], v16 offset:2320
ds_read_b128 v[136:139], v16 offset:4608
ds_read_b128 v[140:143], v16 offset:4624
ds_read_b128 v[144:147], v16 offset:6912
ds_read_b128 v[148:151], v16 offset:6928
v_smfmac_f32_16x16x64_bf16 v[112:115], v[40:43], a[144:151], v6
v_smfmac_f32_16x16x64_bf16 v[116:119], v[40:43], a[176:183], v6
v_smfmac_f32_16x16x64_bf16 v[112:115], v[44:47], a[152:159], v6
v_smfmac_f32_16x16x64_bf16 v[116:119], v[44:47], a[184:191], v6
s_mul_i32 s28, s31, 2048
s_add_u32 s28, s28, s33
s_add_u32 s28, s28, 49152
s_add_u32 s76, s37, s33
s_add_u32 s77, s38, s33
s_add_u32 s78, s39, s33
s_waitcnt lgkmcnt(4)
v_pk_add_f32 v[120:121], v[120:121], v[128:129]
v_pk_add_f32 v[122:123], v[122:123], v[130:131]
v_pk_add_f32 v[124:125], v[124:125], v[132:133]
v_pk_add_f32 v[126:127], v[126:127], v[134:135]
s_waitcnt lgkmcnt(0)
v_pk_add_f32 v[136:137], v[136:137], v[144:145]
v_pk_add_f32 v[138:139], v[138:139], v[146:147]
v_pk_add_f32 v[140:141], v[140:141], v[148:149]
v_pk_add_f32 v[142:143], v[142:143], v[150:151]
v_pk_add_f32 v[120:121], v[120:121], v[136:137]
v_pk_add_f32 v[122:123], v[122:123], v[138:139]
v_pk_add_f32 v[124:125], v[124:125], v[140:141]
v_pk_add_f32 v[126:127], v[126:127], v[142:143]
v_cvt_pk_bf16_f32 v152, v120, v121
v_cvt_pk_bf16_f32 v153, v122, v123
v_cvt_pk_bf16_f32 v154, v124, v125
v_cvt_pk_bf16_f32 v155, v126, v127
s_nop 1
v_mfma_f32_16x16x32_bf16 v[176:179], v[160:163], v[152:155], 0
v_mfma_f32_16x16x32_bf16 v[172:175], v[156:159], v[152:155], 0
v_mfma_f32_16x16x32_bf16 v[180:183], v[152:155], v[152:155], 0
s_cmp_eq_u32 s27, 63
s_cbranch_scc1 mega_kernel_rf_w0last
s_nop 4
v_mov_b32_dpp v172, v176 row_shr:8 row_mask:0xf bank_mask:0xc
v_mov_b32_dpp v173, v177 row_shr:8 row_mask:0xf bank_mask:0xc
v_mov_b32_dpp v174, v178 row_shr:8 row_mask:0xf bank_mask:0xc
v_mov_b32_dpp v175, v179 row_shr:8 row_mask:0xf bank_mask:0xc
v_min_u32 v180, -2, v180
v_min_u32 v172, -2, v172
s_mov_b64 exec, s[42:43]
buffer_store_dwordx4 v[180:183], v10, s[84:87], s28 offen
s_mov_b64 exec, -1
buffer_store_dwordx4 v[172:175], v17, s[84:87], s28 offen
v_permlane32_swap_b32 v112, v116
v_permlane32_swap_b32 v113, v117
v_permlane32_swap_b32 v114, v118
v_permlane32_swap_b32 v115, v119
v_pk_add_f32 v[112:113], v[112:113], v[116:117]
v_pk_add_f32 v[114:115], v[114:115], v[118:119]
ds_write_b128 v20, v[112:115]
s_waitcnt lgkmcnt(0)
s_barrier
v_mov_b32 v96, 0
v_mov_b32 v97, 0
v_mov_b32 v98, 0
v_mov_b32 v99, 0
v_mov_b32 v100, 0
v_mov_b32 v101, 0
v_mov_b32 v102, 0
v_mov_b32 v103, 0
v_cndmask_b32 v176, v23, v180, s[42:43]
v_cndmask_b32 v177, v23, v181, s[42:43]
v_cndmask_b32 v178, v23, v182, s[42:43]
v_cndmask_b32 v179, v23, v183, s[42:43]
buffer_load_dwordx4 v[184:187], v17, s[84:87], s76 offen sc1
buffer_load_dwordx4 v[188:191], v10, s[84:87], s76 offen sc1
buffer_load_dwordx4 v[192:195], v17, s[84:87], s77 offen sc1
buffer_load_dwordx4 v[196:199], v10, s[84:87], s77 offen sc1
buffer_load_dwordx4 v[200:203], v17, s[84:87], s78 offen sc1
buffer_load_dwordx4 v[204:207], v10, s[84:87], s78 offen sc1
s_nop 15
s_nop 7
buffer_load_dwordx4 v[184:187], v17, s[84:87], s76 offen sc1
buffer_load_dwordx4 v[188:191], v10, s[84:87], s76 offen sc1
buffer_load_dwordx4 v[192:195], v17, s[84:87], s77 offen sc1
buffer_load_dwordx4 v[196:199], v10, s[84:87], s77 offen sc1
buffer_load_dwordx4 v[200:203], v17, s[84:87], s78 offen sc1
buffer_load_dwordx4 v[204:207], v10, s[84:87], s78 offen sc1
mega_kernel_rf_p2:
s_waitcnt vmcnt(6)
v_max3_u32 v4, v184, v188, v192
v_max3_u32 v5, v196, v200, v204
v_max_u32 v4, v4, v5
v_cmp_eq_u32 vcc, -1, v4
s_cbranch_vccnz mega_kernel_rf_p2r
v_pk_add_f32 v[176:177], v[176:177], v[188:189]
v_pk_add_f32 v[124:125], v[196:197], v[204:205]
v_pk_add_f32 v[178:179], v[178:179], v[190:191]
v_pk_add_f32 v[126:127], v[198:199], v[206:207]
v_pk_add_f32 v[172:173], v[172:173], v[184:185]
v_pk_add_f32 v[120:121], v[192:193], v[200:201]
v_pk_add_f32 v[174:175], v[174:175], v[186:187]
v_pk_add_f32 v[122:123], v[194:195], v[202:203]
v_pk_add_f32 v[176:177], v[176:177], v[124:125]
v_pk_add_f32 v[178:179], v[178:179], v[126:127]
v_pk_add_f32 v[172:173], v[172:173], v[120:121]
v_pk_add_f32 v[174:175], v[174:175], v[122:123]
v_max3_f32 v232, v172, v173, v174
v_max3_f32 v233, v176, v177, v178
v_max3_f32 v232, v232, v175, v179
v_max_f32 v234, v232, v233
s_barrier
ds_read2_b64 v[208:211], v21 offset0:0 offset1:32
v_max_f32_dpp v232, v234, v234 row_ror:8 row_mask:0xf bank_mask:0xf
v_max_f32_dpp v233, v234, v234 row_ror:8 row_mask:0xf bank_mask:0xf
s_nop 1
v_permlane16_swap_b32 v232, v233
s_nop 0
v_max_f32 v234, v232, v233
v_max_f32 v235, v232, v233
s_nop 1
v_permlane32_swap_b32 v234, v235
s_nop 0
v_max_f32 v232, v234, v235
v_mul_f32 v232, s32, v232
v_pk_fma_f32 v[176:177], v[176:177], s[32:33], v[232:233] op_sel_hi:[1,0,0] neg_lo:[0,0,1] neg_hi:[0,0,1]
v_pk_fma_f32 v[178:179], v[178:179], s[32:33], v[232:233] op_sel_hi:[1,0,0] neg_lo:[0,0,1] neg_hi:[0,0,1]
v_pk_fma_f32 v[172:173], v[172:173], s[32:33], v[232:233] op_sel_hi:[1,0,0] neg_lo:[0,0,1] neg_hi:[0,0,1]
v_pk_fma_f32 v[174:175], v[174:175], s[32:33], v[232:233] op_sel_hi:[1,0,0] neg_lo:[0,0,1] neg_hi:[0,0,1]
v_exp_f32 v176, v176
v_exp_f32 v177, v177
v_exp_f32 v178, v178
v_exp_f32 v179, v179
v_exp_f32 v172, v172
v_cvt_pk_bf16_f32 v216, v176, v177
v_cvt_pk_bf16_f32 v217, v178, v179
v_exp_f32 v173, v173
v_exp_f32 v174, v174
v_mfma_f32_16x16x16_bf16 v[224:227], v[220:221], v[216:217], 0
v_exp_f32 v175, v175
v_cvt_pk_bf16_f32 v212, v172, v173
s_waitcnt lgkmcnt(0)
v_mfma_f32_16x16x16_bf16 v[120:123], v[208:209], v[216:217], 0
v_cvt_pk_bf16_f32 v213, v174, v175
v_mfma_f32_16x16x16_bf16 v[124:127], v[210:211], v[216:217], 0
v_mov_b32_dpp v214, v212 row_ror:8 row_mask:0xf bank_mask:0xf
v_mov_b32_dpp v215, v213 row_ror:8 row_mask:0xf bank_mask:0xf
s_nop 1
v_mfma_f32_16x16x32_bf16 v[224:227], v[220:223], v[212:215], v[224:227]
v_mfma_f32_16x16x32_bf16 v[120:123], v[164:167], v[212:215], v[120:123]
v_mfma_f32_16x16x32_bf16 v[124:127], v[168:171], v[212:215], v[124:127]
s_add_u32 s29, s33, 24576
s_nop 4
v_rcp_f32 v234, v224
s_nop 0
v_pk_mul_f32 v[120:121], v[120:121], v[234:235] op_sel_hi:[1,0]
v_pk_mul_f32 v[122:123], v[122:123], v[234:235] op_sel_hi:[1,0]
v_pk_mul_f32 v[124:125], v[124:125], v[234:235] op_sel_hi:[1,0]
v_pk_mul_f32 v[126:127], v[126:127], v[234:235] op_sel_hi:[1,0]
v_cvt_pk_bf16_f32 v212, v120, v121
v_cvt_pk_bf16_f32 v213, v122, v123
v_cvt_pk_bf16_f32 v214, v124, v125
v_cvt_pk_bf16_f32 v215, v126, v127
v_min_u32 v212, -2, v212
s_mov_b64 exec, s[40:41]
buffer_store_dwordx4 v[212:215], v11, s[84:87], s33 offen
s_mov_b64 exec, -1
mega_kernel_rf_b3:
s_barrier
s_nop 15
s_nop 7
buffer_load_dwordx4 v[32:35], v7, s[84:87], s29 offen offset:0 sc1
s_nop 9
buffer_load_dwordx4 v[36:39], v7, s[84:87], s29 offen offset:1024 sc1
s_nop 9
buffer_load_dwordx4 v[40:43], v7, s[84:87], s29 offen offset:2048 sc1
s_nop 9
buffer_load_dwordx4 v[44:47], v7, s[84:87], s29 offen offset:3072 sc1
mega_kernel_rf_pc_15_0:
s_waitcnt vmcnt(3)
v_cmp_eq_u32 vcc, -1, v32
s_cbranch_vccnz mega_kernel_rf_pc_15_0f
v_smfmac_f32_16x16x64_bf16 v[96:99], v[32:35], a[192:199], v6
v_smfmac_f32_16x16x64_bf16 v[100:103], v[32:35], a[224:231], v6
mega_kernel_rf_pc_14_1:
s_waitcnt vmcnt(2)
v_cmp_eq_u32 vcc, -1, v36
s_cbranch_vccnz mega_kernel_rf_pc_14_1f
v_smfmac_f32_16x16x64_bf16 v[96:99], v[36:39], a[200:207], v6
v_smfmac_f32_16x16x64_bf16 v[100:103], v[36:39], a[232:239], v6
mega_kernel_rf_pc_12_2:
s_waitcnt vmcnt(1)
v_cmp_eq_u32 vcc, -1, v40
s_cbranch_vccnz mega_kernel_rf_pc_12_2f
v_smfmac_f32_16x16x64_bf16 v[96:99], v[40:43], a[208:215], v6
v_smfmac_f32_16x16x64_bf16 v[100:103], v[40:43], a[240:247], v6
mega_kernel_rf_pc_8_3:
s_waitcnt vmcnt(0)
v_cmp_eq_u32 vcc, -1, v44
s_cbranch_vccnz mega_kernel_rf_pc_8_3f
v_smfmac_f32_16x16x64_bf16 v[96:99], v[44:47], a[216:223], v6
v_smfmac_f32_16x16x64_bf16 v[100:103], v[44:47], a[248:255], v6
mega_kernel_rf_pc_d:
s_nop 7
v_permlane32_swap_b32 v96, v100
v_permlane32_swap_b32 v97, v101
v_permlane32_swap_b32 v98, v102
v_permlane32_swap_b32 v99, v103
v_pk_add_f32 v[96:97], v[96:97], v[100:101]
v_pk_add_f32 v[98:99], v[98:99], v[102:103]
ds_write2_b32 v18, v96, v97 offset0:0 offset1:36
ds_write2_b32 v18, v98, v99 offset0:72 offset1:108
s_waitcnt lgkmcnt(0)
s_barrier
s_cmp_lg_u32 s24, 0
s_cbranch_scc1 mega_kernel_rf_x1
ds_read_b128 v[120:123], v19 offset:0
ds_read_b128 v[124:127], v19 offset:1152
ds_read_b128 v[128:131], v19 offset:2304
ds_read_b128 v[132:135], v19 offset:3456
s_waitcnt lgkmcnt(2)
v_pk_add_f32 v[120:121], v[120:121], v[124:125]
v_pk_add_f32 v[122:123], v[122:123], v[126:127]
s_waitcnt lgkmcnt(0)
v_pk_add_f32 v[128:129], v[128:129], v[132:133]
v_pk_add_f32 v[130:131], v[130:131], v[134:135]
v_pk_add_f32 v[120:121], v[120:121], v[128:129]
v_pk_add_f32 v[122:123], v[122:123], v[130:131]
v_and_or_b32 v120, v120, -2, s47
v_and_or_b32 v121, v121, -2, s47
v_and_or_b32 v122, v122, -2, s47
v_and_or_b32 v123, v123, -2, s47
buffer_store_dwordx4 v[120:123], v12, s[84:87], s35 offen sc1
s_xor_b32 s76, s47, 1
v_mov_b32 v48, s76
v_mov_b32 v49, s76
v_mov_b32 v50, s76
v_mov_b32 v51, s76
v_mov_b32 v52, s76
v_mov_b32 v53, s76
v_mov_b32 v54, s76
v_mov_b32 v55, s76
v_mov_b32 v56, s76
v_mov_b32 v57, s76
v_mov_b32 v58, s76
v_mov_b32 v59, s76
v_mov_b32 v96, 0
v_mov_b32 v97, 0
v_mov_b32 v98, 0
v_mov_b32 v99, 0
v_mov_b32 v100, 0
v_mov_b32 v101, 0
v_mov_b32 v102, 0
v_mov_b32 v103, 0
v_mov_b32 v104, 0
v_mov_b32 v105, 0
v_mov_b32 v106, 0
v_mov_b32 v107, 0
v_mov_b32 v108, 0
v_mov_b32 v109, 0
v_mov_b32 v110, 0
v_mov_b32 v111, 0
v_mov_b32 v112, 0
v_mov_b32 v113, 0
v_mov_b32 v114, 0
v_mov_b32 v115, 0
v_mov_b32 v116, 0
v_mov_b32 v117, 0
v_mov_b32 v118, 0
v_mov_b32 v119, 0
s_nop 15
s_cmp_eq_u32 s47, 1
s_cbranch_scc1 mega_kernel_rf_p4_1
mega_kernel_rf_p4_0:
buffer_load_dwordx4 v[48:51], v25, s[84:87], s35 offen sc1
buffer_load_dwordx4 v[52:55], v26, s[84:87], s35 offen sc1
buffer_load_dwordx4 v[56:59], v27, s[84:87], s35 offen sc1
s_waitcnt vmcnt(36)
v_bitop3_b32 v4, v48, v49, v50 bitop3:0xfe
v_bitop3_b32 v5, v54, v55, v56 bitop3:0xfe
v_bitop3_b32 v4, v4, v51, v52 bitop3:0xfe
v_bitop3_b32 v5, v5, v57, v58 bitop3:0xfe
v_bitop3_b32 v4, v4, v53, v59 bitop3:0xfe
v_bitop3_b32 v4, v4, v5, 1 bitop3:0xa8
v_cmp_ne_u32 vcc, 0, v4
s_cbranch_vccnz mega_kernel_rf_p4_0
s_branch mega_kernel_rf_p4d
mega_kernel_rf_p4_1:
buffer_load_dwordx4 v[48:51], v25, s[84:87], s35 offen sc1
buffer_load_dwordx4 v[52:55], v26, s[84:87], s35 offen sc1
buffer_load_dwordx4 v[56:59], v27, s[84:87], s35 offen sc1
s_waitcnt vmcnt(36)
v_bitop3_b32 v4, v48, v49, v50 bitop3:0x80
v_bitop3_b32 v5, v54, v55, v56 bitop3:0x80
v_bitop3_b32 v4, v4, v51, v52 bitop3:0x80
v_bitop3_b32 v5, v5, v57, v58 bitop3:0x80
v_bitop3_b32 v4, v4, v53, v59 bitop3:0x80
v_bitop3_b32 v4, v4, v5, 1 bitop3:0x80
v_cmp_ne_u32 vcc, 1, v4
s_cbranch_vccnz mega_kernel_rf_p4_1
mega_kernel_rf_p4d:
v_pk_add_f32 v[120:121], v[120:121], v[48:49]
v_pk_add_f32 v[124:125], v[52:53], v[56:57]
v_pk_add_f32 v[122:123], v[122:123], v[50:51]
v_pk_add_f32 v[126:127], v[54:55], v[58:59]
v_pk_add_f32 v[120:121], v[120:121], v[124:125]
v_pk_add_f32 v[122:123], v[122:123], v[126:127]
v_cvt_pk_bf16_f32 v212, v120, v121
v_cvt_pk_bf16_f32 v213, v122, v123
v_min_u32 v212, -2, v212
buffer_store_dwordx2 v[212:213], v9, s[84:87], s34 offen
mega_kernel_rf_b5:
s_add_u32 s27, s27, 1
s_add_u32 s44, s44, 4096
s_cmp_eq_u32 s44, 30720
s_cselect_b32 s44, 18432, s44
s_mov_b32 s28, s33
s_mov_b32 s33, s34
s_mov_b32 s34, s28
s_xor_b32 s35, s35, 262144
s_bfe_u32 s47, s27, 0x10001
s_barrier
s_nop 15
s_nop 7
s_branch mega_kernel_rf_loop
mega_kernel_rf_x1:
s_cmp_eq_u32 s24, 1
s_cbranch_scc0 mega_kernel_rf_x2
s_add_u32 s76, s27, 1
v_mov_b32 v5, s76
s_mov_b64 exec, 1
buffer_store_dword v5, v228, s[84:87], s81 offen sc1
s_mov_b64 exec, -1
mega_kernel_rf_x2:
s_cmp_eq_u32 s24, 3
s_cbranch_scc0 mega_kernel_rf_x4
s_cmp_eq_u32 s36, 1
s_cbranch_scc0 mega_kernel_rf_x5
s_add_u32 s76, s27, 1
s_cmp_gt_i32 s46, s76
s_cbranch_scc1 mega_kernel_rf_pf1ok
mega_kernel_rf_pf1w:
buffer_load_dword v4, v24, s[84:87], 0 offen sc1
s_waitcnt vmcnt(0)
v_readlane_b32 s46, v4, 0
v_readlane_b32 s28, v4, 1
s_nop 1
s_min_i32 s46, s46, s28
s_cmp_gt_i32 s46, s76
s_cbranch_scc0 mega_kernel_rf_pf1w
mega_kernel_rf_pf1ok:
s_add_u32 s77, s76, s82
s_bfe_u32 s28, s77, 0x40002
s_lshl_b32 s28, s28, 14
s_and_b32 s77, s77, 3
s_lshl_b32 s77, s77, 11
s_add_u32 s28, s28, s77
s_add_u32 m0, s45, 0
s_nop 0
buffer_load_dwordx4 v240, s[84:87], s28 offen offset:0 sc1 lds
s_add_u32 m0, s45, 0
s_nop 0
buffer_load_dwordx4 v240, s[84:87], s28 offen offset:1024 sc1 lds
s_add_u32 m0, s45, 2048
s_nop 0
buffer_load_dwordx4 v241, s[84:87], s28 offen offset:0 sc1 lds
s_add_u32 m0, s45, 2048
s_nop 0
buffer_load_dwordx4 v241, s[84:87], s28 offen offset:1024 sc1 lds
s_add_u32 s45, s45, 4096
s_cmp_eq_u32 s45, 30720
s_cselect_b32 s45, 18432, s45
s_waitcnt vmcnt(0)
mega_kernel_rf_x5:
s_add_u32 s76, s27, 3
s_min_u32 s76, s76, 63
s_cmp_gt_i32 s46, s76
s_cbranch_scc1 mega_kernel_rf_pf2ok
mega_kernel_rf_pf2w:
buffer_load_dword v4, v24, s[84:87], 0 offen sc1
s_waitcnt vmcnt(0)
v_readlane_b32 s46, v4, 0
v_readlane_b32 s28, v4, 1
s_nop 1
s_min_i32 s46, s46, s28
s_cmp_gt_i32 s46, s76
s_cbranch_scc0 mega_kernel_rf_x6
mega_kernel_rf_pf2ok:
mega_kernel_rf_x6:
s_add_u32 s76, s27, 2
s_cmp_lt_u32 s76, 63
s_cbranch_scc0 mega_kernel_rf_x4
s_cmp_gt_i32 s46, s76
s_cbranch_scc0 mega_kernel_rf_x4
s_cmp_eq_u32 s88, s76
s_cbranch_scc1 mega_kernel_rf_x7
s_add_u32 s77, s76, s82
s_bfe_u32 s28, s77, 0x40002
s_lshl_b32 s28, s28, 14
s_and_b32 s77, s77, 3
s_lshl_b32 s77, s77, 11
s_add_u32 s28, s28, s77
s_add_u32 s28, s28, s83
s_buffer_load_dword s78, s[84:87], s28 offset:0
s_buffer_load_dword s78, s[84:87], s28 offset:128
s_buffer_load_dword s78, s[84:87], s28 offset:256
s_buffer_load_dword s78, s[84:87], s28 offset:384
s_buffer_load_dword s78, s[84:87], s28 offset:512
s_buffer_load_dword s78, s[84:87], s28 offset:640
s_buffer_load_dword s78, s[84:87], s28 offset:768
s_buffer_load_dword s78, s[84:87], s28 offset:896
s_buffer_load_dword s78, s[84:87], s28 offset:1024
s_buffer_load_dword s78, s[84:87], s28 offset:1152
s_buffer_load_dword s78, s[84:87], s28 offset:1280
s_buffer_load_dword s78, s[84:87], s28 offset:1408
s_buffer_load_dword s78, s[84:87], s28 offset:1536
s_buffer_load_dword s78, s[84:87], s28 offset:1664
s_buffer_load_dword s78, s[84:87], s28 offset:1792
s_buffer_load_dword s78, s[84:87], s28 offset:1920
mega_kernel_rf_x7:
s_add_u32 s77, s76, s82
s_bfe_u32 s28, s77, 0x40002
s_lshl_b32 s28, s28, 14
s_and_b32 s77, s77, 3
s_lshl_b32 s77, s77, 11
s_add_u32 s28, s28, s77
s_add_u32 s28, s28, s83
s_add_u32 s28, s28, 33554432
s_buffer_load_dword s78, s[84:87], s28 offset:0
s_buffer_load_dword s78, s[84:87], s28 offset:128
s_buffer_load_dword s78, s[84:87], s28 offset:256
s_buffer_load_dword s78, s[84:87], s28 offset:384
s_buffer_load_dword s78, s[84:87], s28 offset:512
s_buffer_load_dword s78, s[84:87], s28 offset:640
s_buffer_load_dword s78, s[84:87], s28 offset:768
s_buffer_load_dword s78, s[84:87], s28 offset:896
s_buffer_load_dword s78, s[84:87], s28 offset:1024
s_buffer_load_dword s78, s[84:87], s28 offset:1152
s_buffer_load_dword s78, s[84:87], s28 offset:1280
s_buffer_load_dword s78, s[84:87], s28 offset:1408
s_buffer_load_dword s78, s[84:87], s28 offset:1536
s_buffer_load_dword s78, s[84:87], s28 offset:1664
s_buffer_load_dword s78, s[84:87], s28 offset:1792
s_buffer_load_dword s78, s[84:87], s28 offset:1920
s_mov_b32 s89, s76
mega_kernel_rf_x4:
v_mov_b32 v96, 0
v_mov_b32 v97, 0
v_mov_b32 v98, 0
v_mov_b32 v99, 0
v_mov_b32 v100, 0
v_mov_b32 v101, 0
v_mov_b32 v102, 0
v_mov_b32 v103, 0
v_mov_b32 v104, 0
v_mov_b32 v105, 0
v_mov_b32 v106, 0
v_mov_b32 v107, 0
v_mov_b32 v108, 0
v_mov_b32 v109, 0
v_mov_b32 v110, 0
v_mov_b32 v111, 0
v_mov_b32 v112, 0
v_mov_b32 v113, 0
v_mov_b32 v114, 0
v_mov_b32 v115, 0
v_mov_b32 v116, 0
v_mov_b32 v117, 0
v_mov_b32 v118, 0
v_mov_b32 v119, 0
s_branch mega_kernel_rf_b5
mega_kernel_rf_p2r:
buffer_load_dwordx4 v[184:187], v17, s[84:87], s76 offen sc1
buffer_load_dwordx4 v[188:191], v10, s[84:87], s76 offen sc1
buffer_load_dwordx4 v[192:195], v17, s[84:87], s77 offen sc1
buffer_load_dwordx4 v[196:199], v10, s[84:87], s77 offen sc1
buffer_load_dwordx4 v[200:203], v17, s[84:87], s78 offen sc1
buffer_load_dwordx4 v[204:207], v10, s[84:87], s78 offen sc1
s_branch mega_kernel_rf_p2
mega_kernel_rf_pa_1_0f:
s_mov_b64 exec, vcc
buffer_load_dwordx4 v[32:35], v7, s[84:87], s33 offen offset:0 sc1
s_mov_b64 exec, -1
s_branch mega_kernel_rf_pa_1_0
mega_kernel_rf_pa_1_0:
s_waitcnt vmcnt(0)
v_max_u32 v4, v32, v34
v_cmp_eq_u32 vcc, -1, v4
s_cbranch_vccnz mega_kernel_rf_pa_1_0f
v_smfmac_f32_16x16x64_bf16 v[96:99], v[32:35], a[0:7], v6
v_smfmac_f32_16x16x64_bf16 v[100:103], v[32:35], a[32:39], v6
v_smfmac_f32_16x16x64_bf16 v[104:107], v[32:35], a[64:71], v6
v_smfmac_f32_16x16x64_bf16 v[108:111], v[32:35], a[96:103], v6
s_branch mega_kernel_rf_pa_d
mega_kernel_rf_pa_2_1f:
s_mov_b64 exec, vcc
buffer_load_dwordx4 v[36:39], v7, s[84:87], s33 offen offset:1024 sc1
s_mov_b64 exec, -1
s_branch mega_kernel_rf_pa_2_1
mega_kernel_rf_pa_2_1:
s_waitcnt vmcnt(0)
v_max_u32 v4, v36, v38
v_cmp_eq_u32 vcc, -1, v4
s_cbranch_vccnz mega_kernel_rf_pa_2_1f
v_smfmac_f32_16x16x64_bf16 v[96:99], v[36:39], a[8:15], v6
v_smfmac_f32_16x16x64_bf16 v[100:103], v[36:39], a[40:47], v6
v_smfmac_f32_16x16x64_bf16 v[104:107], v[36:39], a[72:79], v6
v_smfmac_f32_16x16x64_bf16 v[108:111], v[36:39], a[104:111], v6
s_branch mega_kernel_rf_pa_d
mega_kernel_rf_pa_3_0f:
s_mov_b64 exec, vcc
buffer_load_dwordx4 v[32:35], v7, s[84:87], s33 offen offset:0 sc1
s_mov_b64 exec, -1
s_branch mega_kernel_rf_pa_3_1
mega_kernel_rf_pa_3_0:
s_waitcnt vmcnt(1)
v_max_u32 v4, v32, v34
v_cmp_eq_u32 vcc, -1, v4
s_cbranch_vccnz mega_kernel_rf_pa_3_0f
v_smfmac_f32_16x16x64_bf16 v[96:99], v[32:35], a[0:7], v6
v_smfmac_f32_16x16x64_bf16 v[100:103], v[32:35], a[32:39], v6
v_smfmac_f32_16x16x64_bf16 v[104:107], v[32:35], a[64:71], v6
v_smfmac_f32_16x16x64_bf16 v[108:111], v[32:35], a[96:103], v6
s_branch mega_kernel_rf_pa_2_1
mega_kernel_rf_pa_3_1f:
s_mov_b64 exec, vcc
buffer_load_dwordx4 v[36:39], v7, s[84:87], s33 offen offset:1024 sc1
s_mov_b64 exec, -1
s_branch mega_kernel_rf_pa_3_0
mega_kernel_rf_pa_3_1:
s_waitcnt vmcnt(1)
v_max_u32 v4, v36, v38
v_cmp_eq_u32 vcc, -1, v4
s_cbranch_vccnz mega_kernel_rf_pa_3_1f
v_smfmac_f32_16x16x64_bf16 v[96:99], v[36:39], a[8:15], v6
v_smfmac_f32_16x16x64_bf16 v[100:103], v[36:39], a[40:47], v6
v_smfmac_f32_16x16x64_bf16 v[104:107], v[36:39], a[72:79], v6
v_smfmac_f32_16x16x64_bf16 v[108:111], v[36:39], a[104:111], v6
s_branch mega_kernel_rf_pa_1_0
mega_kernel_rf_pa_4_2f:
s_mov_b64 exec, vcc
buffer_load_dwordx4 v[40:43], v7, s[84:87], s33 offen offset:2048 sc1
s_mov_b64 exec, -1
s_branch mega_kernel_rf_pa_4_2
mega_kernel_rf_pa_4_2:
s_waitcnt vmcnt(0)
v_max_u32 v4, v40, v42
v_cmp_eq_u32 vcc, -1, v4
s_cbranch_vccnz mega_kernel_rf_pa_4_2f
v_smfmac_f32_16x16x64_bf16 v[96:99], v[40:43], a[16:23], v6
v_smfmac_f32_16x16x64_bf16 v[100:103], v[40:43], a[48:55], v6
v_smfmac_f32_16x16x64_bf16 v[104:107], v[40:43], a[80:87], v6
v_smfmac_f32_16x16x64_bf16 v[108:111], v[40:43], a[112:119], v6
s_branch mega_kernel_rf_pa_d
mega_kernel_rf_pa_5_0f:
s_mov_b64 exec, vcc
buffer_load_dwordx4 v[32:35], v7, s[84:87], s33 offen offset:0 sc1
s_mov_b64 exec, -1
s_branch mega_kernel_rf_pa_5_2
mega_kernel_rf_pa_5_0:
s_waitcnt vmcnt(1)
v_max_u32 v4, v32, v34
v_cmp_eq_u32 vcc, -1, v4
s_cbranch_vccnz mega_kernel_rf_pa_5_0f
v_smfmac_f32_16x16x64_bf16 v[96:99], v[32:35], a[0:7], v6
v_smfmac_f32_16x16x64_bf16 v[100:103], v[32:35], a[32:39], v6
v_smfmac_f32_16x16x64_bf16 v[104:107], v[32:35], a[64:71], v6
v_smfmac_f32_16x16x64_bf16 v[108:111], v[32:35], a[96:103], v6
s_branch mega_kernel_rf_pa_4_2
mega_kernel_rf_pa_5_2f:
s_mov_b64 exec, vcc
buffer_load_dwordx4 v[40:43], v7, s[84:87], s33 offen offset:2048 sc1
s_mov_b64 exec, -1
s_branch mega_kernel_rf_pa_5_0
mega_kernel_rf_pa_5_2:
s_waitcnt vmcnt(1)
v_max_u32 v4, v40, v42
v_cmp_eq_u32 vcc, -1, v4
s_cbranch_vccnz mega_kernel_rf_pa_5_2f
v_smfmac_f32_16x16x64_bf16 v[96:99], v[40:43], a[16:23], v6
v_smfmac_f32_16x16x64_bf16 v[100:103], v[40:43], a[48:55], v6
v_smfmac_f32_16x16x64_bf16 v[104:107], v[40:43], a[80:87], v6
v_smfmac_f32_16x16x64_bf16 v[108:111], v[40:43], a[112:119], v6
s_branch mega_kernel_rf_pa_1_0
mega_kernel_rf_pa_6_1f:
s_mov_b64 exec, vcc
buffer_load_dwordx4 v[36:39], v7, s[84:87], s33 offen offset:1024 sc1
s_mov_b64 exec, -1
s_branch mega_kernel_rf_pa_6_2
mega_kernel_rf_pa_6_1:
s_waitcnt vmcnt(1)
v_max_u32 v4, v36, v38
v_cmp_eq_u32 vcc, -1, v4
s_cbranch_vccnz mega_kernel_rf_pa_6_1f
v_smfmac_f32_16x16x64_bf16 v[96:99], v[36:39], a[8:15], v6
v_smfmac_f32_16x16x64_bf16 v[100:103], v[36:39], a[40:47], v6
v_smfmac_f32_16x16x64_bf16 v[104:107], v[36:39], a[72:79], v6
v_smfmac_f32_16x16x64_bf16 v[108:111], v[36:39], a[104:111], v6
s_branch mega_kernel_rf_pa_4_2
mega_kernel_rf_pa_6_2f:
s_mov_b64 exec, vcc
buffer_load_dwordx4 v[40:43], v7, s[84:87], s33 offen offset:2048 sc1
s_mov_b64 exec, -1
s_branch mega_kernel_rf_pa_6_1
mega_kernel_rf_pa_6_2:
s_waitcnt vmcnt(1)
v_max_u32 v4, v40, v42
v_cmp_eq_u32 vcc, -1, v4
s_cbranch_vccnz mega_kernel_rf_pa_6_2f
v_smfmac_f32_16x16x64_bf16 v[96:99], v[40:43], a[16:23], v6
v_smfmac_f32_16x16x64_bf16 v[100:103], v[40:43], a[48:55], v6
v_smfmac_f32_16x16x64_bf16 v[104:107], v[40:43], a[80:87], v6
v_smfmac_f32_16x16x64_bf16 v[108:111], v[40:43], a[112:119], v6
s_branch mega_kernel_rf_pa_2_1
mega_kernel_rf_pa_7_0f:
s_mov_b64 exec, vcc
buffer_load_dwordx4 v[32:35], v7, s[84:87], s33 offen offset:0 sc1
s_mov_b64 exec, -1
s_branch mega_kernel_rf_pa_7_1
mega_kernel_rf_pa_7_0:
s_waitcnt vmcnt(2)
v_max_u32 v4, v32, v34
v_cmp_eq_u32 vcc, -1, v4
s_cbranch_vccnz mega_kernel_rf_pa_7_0f
v_smfmac_f32_16x16x64_bf16 v[96:99], v[32:35], a[0:7], v6
v_smfmac_f32_16x16x64_bf16 v[100:103], v[32:35], a[32:39], v6
v_smfmac_f32_16x16x64_bf16 v[104:107], v[32:35], a[64:71], v6
v_smfmac_f32_16x16x64_bf16 v[108:111], v[32:35], a[96:103], v6
s_branch mega_kernel_rf_pa_6_1
mega_kernel_rf_pa_7_1f:
s_mov_b64 exec, vcc
buffer_load_dwordx4 v[36:39], v7, s[84:87], s33 offen offset:1024 sc1
s_mov_b64 exec, -1
s_branch mega_kernel_rf_pa_7_2
mega_kernel_rf_pa_7_1:
s_waitcnt vmcnt(2)
v_max_u32 v4, v36, v38
v_cmp_eq_u32 vcc, -1, v4
s_cbranch_vccnz mega_kernel_rf_pa_7_1f
v_smfmac_f32_16x16x64_bf16 v[96:99], v[36:39], a[8:15], v6
v_smfmac_f32_16x16x64_bf16 v[100:103], v[36:39], a[40:47], v6
v_smfmac_f32_16x16x64_bf16 v[104:107], v[36:39], a[72:79], v6
v_smfmac_f32_16x16x64_bf16 v[108:111], v[36:39], a[104:111], v6
s_branch mega_kernel_rf_pa_5_2
mega_kernel_rf_pa_7_2f:
s_mov_b64 exec, vcc
buffer_load_dwordx4 v[40:43], v7, s[84:87], s33 offen offset:2048 sc1
s_mov_b64 exec, -1
s_branch mega_kernel_rf_pa_7_0
mega_kernel_rf_pa_7_2:
s_waitcnt vmcnt(2)
v_max_u32 v4, v40, v42
v_cmp_eq_u32 vcc, -1, v4
s_cbranch_vccnz mega_kernel_rf_pa_7_2f
v_smfmac_f32_16x16x64_bf16 v[96:99], v[40:43], a[16:23], v6
v_smfmac_f32_16x16x64_bf16 v[100:103], v[40:43], a[48:55], v6
v_smfmac_f32_16x16x64_bf16 v[104:107], v[40:43], a[80:87], v6
v_smfmac_f32_16x16x64_bf16 v[108:111], v[40:43], a[112:119], v6
s_branch mega_kernel_rf_pa_3_0
mega_kernel_rf_pa_8_3f:
s_mov_b64 exec, vcc
buffer_load_dwordx4 v[44:47], v7, s[84:87], s33 offen offset:3072 sc1
s_mov_b64 exec, -1
s_branch mega_kernel_rf_pa_8_3
mega_kernel_rf_pa_8_3:
s_waitcnt vmcnt(0)
v_max_u32 v4, v44, v46
v_cmp_eq_u32 vcc, -1, v4
s_cbranch_vccnz mega_kernel_rf_pa_8_3f
v_smfmac_f32_16x16x64_bf16 v[96:99], v[44:47], a[24:31], v6
v_smfmac_f32_16x16x64_bf16 v[100:103], v[44:47], a[56:63], v6
v_smfmac_f32_16x16x64_bf16 v[104:107], v[44:47], a[88:95], v6
v_smfmac_f32_16x16x64_bf16 v[108:111], v[44:47], a[120:127], v6
s_branch mega_kernel_rf_pa_d
mega_kernel_rf_pa_9_0f:
s_mov_b64 exec, vcc
buffer_load_dwordx4 v[32:35], v7, s[84:87], s33 offen offset:0 sc1
s_mov_b64 exec, -1
s_branch mega_kernel_rf_pa_9_3
mega_kernel_rf_pa_9_0:
s_waitcnt vmcnt(1)
v_max_u32 v4, v32, v34
v_cmp_eq_u32 vcc, -1, v4
s_cbranch_vccnz mega_kernel_rf_pa_9_0f
v_smfmac_f32_16x16x64_bf16 v[96:99], v[32:35], a[0:7], v6
v_smfmac_f32_16x16x64_bf16 v[100:103], v[32:35], a[32:39], v6
v_smfmac_f32_16x16x64_bf16 v[104:107], v[32:35], a[64:71], v6
v_smfmac_f32_16x16x64_bf16 v[108:111], v[32:35], a[96:103], v6
s_branch mega_kernel_rf_pa_8_3
mega_kernel_rf_pa_9_3f:
s_mov_b64 exec, vcc
buffer_load_dwordx4 v[44:47], v7, s[84:87], s33 offen offset:3072 sc1
s_mov_b64 exec, -1
s_branch mega_kernel_rf_pa_9_0
mega_kernel_rf_pa_9_3:
s_waitcnt vmcnt(1)
v_max_u32 v4, v44, v46
v_cmp_eq_u32 vcc, -1, v4
s_cbranch_vccnz mega_kernel_rf_pa_9_3f
v_smfmac_f32_16x16x64_bf16 v[96:99], v[44:47], a[24:31], v6
v_smfmac_f32_16x16x64_bf16 v[100:103], v[44:47], a[56:63], v6
v_smfmac_f32_16x16x64_bf16 v[104:107], v[44:47], a[88:95], v6
v_smfmac_f32_16x16x64_bf16 v[108:111], v[44:47], a[120:127], v6
s_branch mega_kernel_rf_pa_1_0
mega_kernel_rf_pa_10_1f:
s_mov_b64 exec, vcc
buffer_load_dwordx4 v[36:39], v7, s[84:87], s33 offen offset:1024 sc1
s_mov_b64 exec, -1
s_branch mega_kernel_rf_pa_10_3
mega_kernel_rf_pa_10_1:
s_waitcnt vmcnt(1)
v_max_u32 v4, v36, v38
v_cmp_eq_u32 vcc, -1, v4
s_cbranch_vccnz mega_kernel_rf_pa_10_1f
v_smfmac_f32_16x16x64_bf16 v[96:99], v[36:39], a[8:15], v6
v_smfmac_f32_16x16x64_bf16 v[100:103], v[36:39], a[40:47], v6
v_smfmac_f32_16x16x64_bf16 v[104:107], v[36:39], a[72:79], v6
v_smfmac_f32_16x16x64_bf16 v[108:111], v[36:39], a[104:111], v6
s_branch mega_kernel_rf_pa_8_3
mega_kernel_rf_pa_10_3f:
s_mov_b64 exec, vcc
buffer_load_dwordx4 v[44:47], v7, s[84:87], s33 offen offset:3072 sc1
s_mov_b64 exec, -1
s_branch mega_kernel_rf_pa_10_1
mega_kernel_rf_pa_10_3:
s_waitcnt vmcnt(1)
v_max_u32 v4, v44, v46
v_cmp_eq_u32 vcc, -1, v4
s_cbranch_vccnz mega_kernel_rf_pa_10_3f
v_smfmac_f32_16x16x64_bf16 v[96:99], v[44:47], a[24:31], v6
v_smfmac_f32_16x16x64_bf16 v[100:103], v[44:47], a[56:63], v6
v_smfmac_f32_16x16x64_bf16 v[104:107], v[44:47], a[88:95], v6
v_smfmac_f32_16x16x64_bf16 v[108:111], v[44:47], a[120:127], v6
s_branch mega_kernel_rf_pa_2_1
mega_kernel_rf_pa_11_0f:
s_mov_b64 exec, vcc
buffer_load_dwordx4 v[32:35], v7, s[84:87], s33 offen offset:0 sc1
s_mov_b64 exec, -1
s_branch mega_kernel_rf_pa_11_1
mega_kernel_rf_pa_11_0:
s_waitcnt vmcnt(2)
v_max_u32 v4, v32, v34
v_cmp_eq_u32 vcc, -1, v4
s_cbranch_vccnz mega_kernel_rf_pa_11_0f
v_smfmac_f32_16x16x64_bf16 v[96:99], v[32:35], a[0:7], v6
v_smfmac_f32_16x16x64_bf16 v[100:103], v[32:35], a[32:39], v6
v_smfmac_f32_16x16x64_bf16 v[104:107], v[32:35], a[64:71], v6
v_smfmac_f32_16x16x64_bf16 v[108:111], v[32:35], a[96:103], v6
s_branch mega_kernel_rf_pa_10_1
mega_kernel_rf_pa_11_1f:
s_mov_b64 exec, vcc
buffer_load_dwordx4 v[36:39], v7, s[84:87], s33 offen offset:1024 sc1
s_mov_b64 exec, -1
s_branch mega_kernel_rf_pa_11_3
mega_kernel_rf_pa_11_1:
s_waitcnt vmcnt(2)
v_max_u32 v4, v36, v38
v_cmp_eq_u32 vcc, -1, v4
s_cbranch_vccnz mega_kernel_rf_pa_11_1f
v_smfmac_f32_16x16x64_bf16 v[96:99], v[36:39], a[8:15], v6
v_smfmac_f32_16x16x64_bf16 v[100:103], v[36:39], a[40:47], v6
v_smfmac_f32_16x16x64_bf16 v[104:107], v[36:39], a[72:79], v6
v_smfmac_f32_16x16x64_bf16 v[108:111], v[36:39], a[104:111], v6
s_branch mega_kernel_rf_pa_9_3
mega_kernel_rf_pa_11_3f:
s_mov_b64 exec, vcc
buffer_load_dwordx4 v[44:47], v7, s[84:87], s33 offen offset:3072 sc1
s_mov_b64 exec, -1
s_branch mega_kernel_rf_pa_11_0
mega_kernel_rf_pa_11_3:
s_waitcnt vmcnt(2)
v_max_u32 v4, v44, v46
v_cmp_eq_u32 vcc, -1, v4
s_cbranch_vccnz mega_kernel_rf_pa_11_3f
v_smfmac_f32_16x16x64_bf16 v[96:99], v[44:47], a[24:31], v6
v_smfmac_f32_16x16x64_bf16 v[100:103], v[44:47], a[56:63], v6
v_smfmac_f32_16x16x64_bf16 v[104:107], v[44:47], a[88:95], v6
v_smfmac_f32_16x16x64_bf16 v[108:111], v[44:47], a[120:127], v6
s_branch mega_kernel_rf_pa_3_0
mega_kernel_rf_pa_12_2f:
s_mov_b64 exec, vcc
buffer_load_dwordx4 v[40:43], v7, s[84:87], s33 offen offset:2048 sc1
s_mov_b64 exec, -1
s_branch mega_kernel_rf_pa_12_3
mega_kernel_rf_pa_12_2:
s_waitcnt vmcnt(1)
v_max_u32 v4, v40, v42
v_cmp_eq_u32 vcc, -1, v4
s_cbranch_vccnz mega_kernel_rf_pa_12_2f
v_smfmac_f32_16x16x64_bf16 v[96:99], v[40:43], a[16:23], v6
v_smfmac_f32_16x16x64_bf16 v[100:103], v[40:43], a[48:55], v6
v_smfmac_f32_16x16x64_bf16 v[104:107], v[40:43], a[80:87], v6
v_smfmac_f32_16x16x64_bf16 v[108:111], v[40:43], a[112:119], v6
s_branch mega_kernel_rf_pa_8_3
mega_kernel_rf_pa_12_3f:
s_mov_b64 exec, vcc
buffer_load_dwordx4 v[44:47], v7, s[84:87], s33 offen offset:3072 sc1
s_mov_b64 exec, -1
s_branch mega_kernel_rf_pa_12_2
mega_kernel_rf_pa_12_3:
s_waitcnt vmcnt(1)
v_max_u32 v4, v44, v46
v_cmp_eq_u32 vcc, -1, v4
s_cbranch_vccnz mega_kernel_rf_pa_12_3f
v_smfmac_f32_16x16x64_bf16 v[96:99], v[44:47], a[24:31], v6
v_smfmac_f32_16x16x64_bf16 v[100:103], v[44:47], a[56:63], v6
v_smfmac_f32_16x16x64_bf16 v[104:107], v[44:47], a[88:95], v6
v_smfmac_f32_16x16x64_bf16 v[108:111], v[44:47], a[120:127], v6
s_branch mega_kernel_rf_pa_4_2
mega_kernel_rf_pa_13_0f:
s_mov_b64 exec, vcc
buffer_load_dwordx4 v[32:35], v7, s[84:87], s33 offen offset:0 sc1
s_mov_b64 exec, -1
s_branch mega_kernel_rf_pa_13_2
mega_kernel_rf_pa_13_0:
s_waitcnt vmcnt(2)
v_max_u32 v4, v32, v34
v_cmp_eq_u32 vcc, -1, v4
s_cbranch_vccnz mega_kernel_rf_pa_13_0f
v_smfmac_f32_16x16x64_bf16 v[96:99], v[32:35], a[0:7], v6
v_smfmac_f32_16x16x64_bf16 v[100:103], v[32:35], a[32:39], v6
v_smfmac_f32_16x16x64_bf16 v[104:107], v[32:35], a[64:71], v6
v_smfmac_f32_16x16x64_bf16 v[108:111], v[32:35], a[96:103], v6
s_branch mega_kernel_rf_pa_12_2
mega_kernel_rf_pa_13_2f:
s_mov_b64 exec, vcc
buffer_load_dwordx4 v[40:43], v7, s[84:87], s33 offen offset:2048 sc1
s_mov_b64 exec, -1
s_branch mega_kernel_rf_pa_13_3
mega_kernel_rf_pa_13_2:
s_waitcnt vmcnt(2)
v_max_u32 v4, v40, v42
v_cmp_eq_u32 vcc, -1, v4
s_cbranch_vccnz mega_kernel_rf_pa_13_2f
v_smfmac_f32_16x16x64_bf16 v[96:99], v[40:43], a[16:23], v6
v_smfmac_f32_16x16x64_bf16 v[100:103], v[40:43], a[48:55], v6
v_smfmac_f32_16x16x64_bf16 v[104:107], v[40:43], a[80:87], v6
v_smfmac_f32_16x16x64_bf16 v[108:111], v[40:43], a[112:119], v6
s_branch mega_kernel_rf_pa_9_3
mega_kernel_rf_pa_13_3f:
s_mov_b64 exec, vcc
buffer_load_dwordx4 v[44:47], v7, s[84:87], s33 offen offset:3072 sc1
s_mov_b64 exec, -1
s_branch mega_kernel_rf_pa_13_0
mega_kernel_rf_pa_13_3:
s_waitcnt vmcnt(2)
v_max_u32 v4, v44, v46
v_cmp_eq_u32 vcc, -1, v4
s_cbranch_vccnz mega_kernel_rf_pa_13_3f
v_smfmac_f32_16x16x64_bf16 v[96:99], v[44:47], a[24:31], v6
v_smfmac_f32_16x16x64_bf16 v[100:103], v[44:47], a[56:63], v6
v_smfmac_f32_16x16x64_bf16 v[104:107], v[44:47], a[88:95], v6
v_smfmac_f32_16x16x64_bf16 v[108:111], v[44:47], a[120:127], v6
s_branch mega_kernel_rf_pa_5_0
mega_kernel_rf_pa_14_1f:
s_mov_b64 exec, vcc
buffer_load_dwordx4 v[36:39], v7, s[84:87], s33 offen offset:1024 sc1
s_mov_b64 exec, -1
s_branch mega_kernel_rf_pa_14_2
mega_kernel_rf_pa_14_1:
s_waitcnt vmcnt(2)
v_max_u32 v4, v36, v38
v_cmp_eq_u32 vcc, -1, v4
s_cbranch_vccnz mega_kernel_rf_pa_14_1f
v_smfmac_f32_16x16x64_bf16 v[96:99], v[36:39], a[8:15], v6
v_smfmac_f32_16x16x64_bf16 v[100:103], v[36:39], a[40:47], v6
v_smfmac_f32_16x16x64_bf16 v[104:107], v[36:39], a[72:79], v6
v_smfmac_f32_16x16x64_bf16 v[108:111], v[36:39], a[104:111], v6
s_branch mega_kernel_rf_pa_12_2
mega_kernel_rf_pa_14_2f:
s_mov_b64 exec, vcc
buffer_load_dwordx4 v[40:43], v7, s[84:87], s33 offen offset:2048 sc1
s_mov_b64 exec, -1
s_branch mega_kernel_rf_pa_14_3
mega_kernel_rf_pa_14_2:
s_waitcnt vmcnt(2)
v_max_u32 v4, v40, v42
v_cmp_eq_u32 vcc, -1, v4
s_cbranch_vccnz mega_kernel_rf_pa_14_2f
v_smfmac_f32_16x16x64_bf16 v[96:99], v[40:43], a[16:23], v6
v_smfmac_f32_16x16x64_bf16 v[100:103], v[40:43], a[48:55], v6
v_smfmac_f32_16x16x64_bf16 v[104:107], v[40:43], a[80:87], v6
v_smfmac_f32_16x16x64_bf16 v[108:111], v[40:43], a[112:119], v6
s_branch mega_kernel_rf_pa_10_3
mega_kernel_rf_pa_14_3f:
s_mov_b64 exec, vcc
buffer_load_dwordx4 v[44:47], v7, s[84:87], s33 offen offset:3072 sc1
s_mov_b64 exec, -1
s_branch mega_kernel_rf_pa_14_1
mega_kernel_rf_pa_14_3:
s_waitcnt vmcnt(2)
v_max_u32 v4, v44, v46
v_cmp_eq_u32 vcc, -1, v4
s_cbranch_vccnz mega_kernel_rf_pa_14_3f
v_smfmac_f32_16x16x64_bf16 v[96:99], v[44:47], a[24:31], v6
v_smfmac_f32_16x16x64_bf16 v[100:103], v[44:47], a[56:63], v6
v_smfmac_f32_16x16x64_bf16 v[104:107], v[44:47], a[88:95], v6
v_smfmac_f32_16x16x64_bf16 v[108:111], v[44:47], a[120:127], v6
s_branch mega_kernel_rf_pa_6_1
mega_kernel_rf_pa_15_0f:
s_mov_b64 exec, vcc
buffer_load_dwordx4 v[32:35], v7, s[84:87], s33 offen offset:0 sc1
s_mov_b64 exec, -1
s_branch mega_kernel_rf_pa_15_1
mega_kernel_rf_pa_15_0:
s_waitcnt vmcnt(3)
v_max_u32 v4, v32, v34
v_cmp_eq_u32 vcc, -1, v4
s_cbranch_vccnz mega_kernel_rf_pa_15_0f
v_smfmac_f32_16x16x64_bf16 v[96:99], v[32:35], a[0:7], v6
v_smfmac_f32_16x16x64_bf16 v[100:103], v[32:35], a[32:39], v6
v_smfmac_f32_16x16x64_bf16 v[104:107], v[32:35], a[64:71], v6
v_smfmac_f32_16x16x64_bf16 v[108:111], v[32:35], a[96:103], v6
s_branch mega_kernel_rf_pa_14_1
mega_kernel_rf_pa_15_1f:
s_mov_b64 exec, vcc
buffer_load_dwordx4 v[36:39], v7, s[84:87], s33 offen offset:1024 sc1
s_mov_b64 exec, -1
s_branch mega_kernel_rf_pa_15_2
mega_kernel_rf_pa_15_1:
s_waitcnt vmcnt(3)
v_max_u32 v4, v36, v38
v_cmp_eq_u32 vcc, -1, v4
s_cbranch_vccnz mega_kernel_rf_pa_15_1f
v_smfmac_f32_16x16x64_bf16 v[96:99], v[36:39], a[8:15], v6
v_smfmac_f32_16x16x64_bf16 v[100:103], v[36:39], a[40:47], v6
v_smfmac_f32_16x16x64_bf16 v[104:107], v[36:39], a[72:79], v6
v_smfmac_f32_16x16x64_bf16 v[108:111], v[36:39], a[104:111], v6
s_branch mega_kernel_rf_pa_13_2
mega_kernel_rf_pa_15_2f:
s_mov_b64 exec, vcc
buffer_load_dwordx4 v[40:43], v7, s[84:87], s33 offen offset:2048 sc1
s_mov_b64 exec, -1
s_branch mega_kernel_rf_pa_15_3
mega_kernel_rf_pa_15_2:
s_waitcnt vmcnt(3)
v_max_u32 v4, v40, v42
v_cmp_eq_u32 vcc, -1, v4
s_cbranch_vccnz mega_kernel_rf_pa_15_2f
v_smfmac_f32_16x16x64_bf16 v[96:99], v[40:43], a[16:23], v6
v_smfmac_f32_16x16x64_bf16 v[100:103], v[40:43], a[48:55], v6
v_smfmac_f32_16x16x64_bf16 v[104:107], v[40:43], a[80:87], v6
v_smfmac_f32_16x16x64_bf16 v[108:111], v[40:43], a[112:119], v6
s_branch mega_kernel_rf_pa_11_3
mega_kernel_rf_pa_15_3f:
s_mov_b64 exec, vcc
buffer_load_dwordx4 v[44:47], v7, s[84:87], s33 offen offset:3072 sc1
s_mov_b64 exec, -1
s_branch mega_kernel_rf_pa_15_0
mega_kernel_rf_pa_15_3:
s_waitcnt vmcnt(3)
v_max_u32 v4, v44, v46
v_cmp_eq_u32 vcc, -1, v4
s_cbranch_vccnz mega_kernel_rf_pa_15_3f
v_smfmac_f32_16x16x64_bf16 v[96:99], v[44:47], a[24:31], v6
v_smfmac_f32_16x16x64_bf16 v[100:103], v[44:47], a[56:63], v6
v_smfmac_f32_16x16x64_bf16 v[104:107], v[44:47], a[88:95], v6
v_smfmac_f32_16x16x64_bf16 v[108:111], v[44:47], a[120:127], v6
s_branch mega_kernel_rf_pa_7_0
mega_kernel_rf_pc_1_0f:
s_mov_b64 exec, vcc
buffer_load_dwordx4 v[32:35], v7, s[84:87], s29 offen offset:0 sc1
s_mov_b64 exec, -1
s_branch mega_kernel_rf_pc_1_0
mega_kernel_rf_pc_1_0:
s_waitcnt vmcnt(0)
v_cmp_eq_u32 vcc, -1, v32
s_cbranch_vccnz mega_kernel_rf_pc_1_0f
v_smfmac_f32_16x16x64_bf16 v[96:99], v[32:35], a[192:199], v6
v_smfmac_f32_16x16x64_bf16 v[100:103], v[32:35], a[224:231], v6
s_branch mega_kernel_rf_pc_d
mega_kernel_rf_pc_2_1f:
s_mov_b64 exec, vcc
buffer_load_dwordx4 v[36:39], v7, s[84:87], s29 offen offset:1024 sc1
s_mov_b64 exec, -1
s_branch mega_kernel_rf_pc_2_1
mega_kernel_rf_pc_2_1:
s_waitcnt vmcnt(0)
v_cmp_eq_u32 vcc, -1, v36
s_cbranch_vccnz mega_kernel_rf_pc_2_1f
v_smfmac_f32_16x16x64_bf16 v[96:99], v[36:39], a[200:207], v6
v_smfmac_f32_16x16x64_bf16 v[100:103], v[36:39], a[232:239], v6
s_branch mega_kernel_rf_pc_d
mega_kernel_rf_pc_3_0f:
s_mov_b64 exec, vcc
buffer_load_dwordx4 v[32:35], v7, s[84:87], s29 offen offset:0 sc1
s_mov_b64 exec, -1
s_branch mega_kernel_rf_pc_3_1
mega_kernel_rf_pc_3_0:
s_waitcnt vmcnt(1)
v_cmp_eq_u32 vcc, -1, v32
s_cbranch_vccnz mega_kernel_rf_pc_3_0f
v_smfmac_f32_16x16x64_bf16 v[96:99], v[32:35], a[192:199], v6
v_smfmac_f32_16x16x64_bf16 v[100:103], v[32:35], a[224:231], v6
s_branch mega_kernel_rf_pc_2_1
mega_kernel_rf_pc_3_1f:
s_mov_b64 exec, vcc
buffer_load_dwordx4 v[36:39], v7, s[84:87], s29 offen offset:1024 sc1
s_mov_b64 exec, -1
s_branch mega_kernel_rf_pc_3_0
mega_kernel_rf_pc_3_1:
s_waitcnt vmcnt(1)
v_cmp_eq_u32 vcc, -1, v36
s_cbranch_vccnz mega_kernel_rf_pc_3_1f
v_smfmac_f32_16x16x64_bf16 v[96:99], v[36:39], a[200:207], v6
v_smfmac_f32_16x16x64_bf16 v[100:103], v[36:39], a[232:239], v6
s_branch mega_kernel_rf_pc_1_0
mega_kernel_rf_pc_4_2f:
s_mov_b64 exec, vcc
buffer_load_dwordx4 v[40:43], v7, s[84:87], s29 offen offset:2048 sc1
s_mov_b64 exec, -1
s_branch mega_kernel_rf_pc_4_2
mega_kernel_rf_pc_4_2:
s_waitcnt vmcnt(0)
v_cmp_eq_u32 vcc, -1, v40
s_cbranch_vccnz mega_kernel_rf_pc_4_2f
v_smfmac_f32_16x16x64_bf16 v[96:99], v[40:43], a[208:215], v6
v_smfmac_f32_16x16x64_bf16 v[100:103], v[40:43], a[240:247], v6
s_branch mega_kernel_rf_pc_d
mega_kernel_rf_pc_5_0f:
s_mov_b64 exec, vcc
buffer_load_dwordx4 v[32:35], v7, s[84:87], s29 offen offset:0 sc1
s_mov_b64 exec, -1
s_branch mega_kernel_rf_pc_5_2
mega_kernel_rf_pc_5_0:
s_waitcnt vmcnt(1)
v_cmp_eq_u32 vcc, -1, v32
s_cbranch_vccnz mega_kernel_rf_pc_5_0f
v_smfmac_f32_16x16x64_bf16 v[96:99], v[32:35], a[192:199], v6
v_smfmac_f32_16x16x64_bf16 v[100:103], v[32:35], a[224:231], v6
s_branch mega_kernel_rf_pc_4_2
mega_kernel_rf_pc_5_2f:
s_mov_b64 exec, vcc
buffer_load_dwordx4 v[40:43], v7, s[84:87], s29 offen offset:2048 sc1
s_mov_b64 exec, -1
s_branch mega_kernel_rf_pc_5_0
mega_kernel_rf_pc_5_2:
s_waitcnt vmcnt(1)
v_cmp_eq_u32 vcc, -1, v40
s_cbranch_vccnz mega_kernel_rf_pc_5_2f
v_smfmac_f32_16x16x64_bf16 v[96:99], v[40:43], a[208:215], v6
v_smfmac_f32_16x16x64_bf16 v[100:103], v[40:43], a[240:247], v6
s_branch mega_kernel_rf_pc_1_0
mega_kernel_rf_pc_6_1f:
s_mov_b64 exec, vcc
buffer_load_dwordx4 v[36:39], v7, s[84:87], s29 offen offset:1024 sc1
s_mov_b64 exec, -1
s_branch mega_kernel_rf_pc_6_2
mega_kernel_rf_pc_6_1:
s_waitcnt vmcnt(1)
v_cmp_eq_u32 vcc, -1, v36
s_cbranch_vccnz mega_kernel_rf_pc_6_1f
v_smfmac_f32_16x16x64_bf16 v[96:99], v[36:39], a[200:207], v6
v_smfmac_f32_16x16x64_bf16 v[100:103], v[36:39], a[232:239], v6
s_branch mega_kernel_rf_pc_4_2
mega_kernel_rf_pc_6_2f:
s_mov_b64 exec, vcc
buffer_load_dwordx4 v[40:43], v7, s[84:87], s29 offen offset:2048 sc1
s_mov_b64 exec, -1
s_branch mega_kernel_rf_pc_6_1
mega_kernel_rf_pc_6_2:
s_waitcnt vmcnt(1)
v_cmp_eq_u32 vcc, -1, v40
s_cbranch_vccnz mega_kernel_rf_pc_6_2f
v_smfmac_f32_16x16x64_bf16 v[96:99], v[40:43], a[208:215], v6
v_smfmac_f32_16x16x64_bf16 v[100:103], v[40:43], a[240:247], v6
s_branch mega_kernel_rf_pc_2_1
mega_kernel_rf_pc_7_0f:
s_mov_b64 exec, vcc
buffer_load_dwordx4 v[32:35], v7, s[84:87], s29 offen offset:0 sc1
s_mov_b64 exec, -1
s_branch mega_kernel_rf_pc_7_1
mega_kernel_rf_pc_7_0:
s_waitcnt vmcnt(2)
v_cmp_eq_u32 vcc, -1, v32
s_cbranch_vccnz mega_kernel_rf_pc_7_0f
v_smfmac_f32_16x16x64_bf16 v[96:99], v[32:35], a[192:199], v6
v_smfmac_f32_16x16x64_bf16 v[100:103], v[32:35], a[224:231], v6
s_branch mega_kernel_rf_pc_6_1
mega_kernel_rf_pc_7_1f:
s_mov_b64 exec, vcc
buffer_load_dwordx4 v[36:39], v7, s[84:87], s29 offen offset:1024 sc1
s_mov_b64 exec, -1
s_branch mega_kernel_rf_pc_7_2
mega_kernel_rf_pc_7_1:
s_waitcnt vmcnt(2)
v_cmp_eq_u32 vcc, -1, v36
s_cbranch_vccnz mega_kernel_rf_pc_7_1f
v_smfmac_f32_16x16x64_bf16 v[96:99], v[36:39], a[200:207], v6
v_smfmac_f32_16x16x64_bf16 v[100:103], v[36:39], a[232:239], v6
s_branch mega_kernel_rf_pc_5_2
mega_kernel_rf_pc_7_2f:
s_mov_b64 exec, vcc
buffer_load_dwordx4 v[40:43], v7, s[84:87], s29 offen offset:2048 sc1
s_mov_b64 exec, -1
s_branch mega_kernel_rf_pc_7_0
mega_kernel_rf_pc_7_2:
s_waitcnt vmcnt(2)
v_cmp_eq_u32 vcc, -1, v40
s_cbranch_vccnz mega_kernel_rf_pc_7_2f
v_smfmac_f32_16x16x64_bf16 v[96:99], v[40:43], a[208:215], v6
v_smfmac_f32_16x16x64_bf16 v[100:103], v[40:43], a[240:247], v6
s_branch mega_kernel_rf_pc_3_0
mega_kernel_rf_pc_8_3f:
s_mov_b64 exec, vcc
buffer_load_dwordx4 v[44:47], v7, s[84:87], s29 offen offset:3072 sc1
s_mov_b64 exec, -1
s_branch mega_kernel_rf_pc_8_3
mega_kernel_rf_pc_9_0f:
s_mov_b64 exec, vcc
buffer_load_dwordx4 v[32:35], v7, s[84:87], s29 offen offset:0 sc1
s_mov_b64 exec, -1
s_branch mega_kernel_rf_pc_9_3
mega_kernel_rf_pc_9_0:
s_waitcnt vmcnt(1)
v_cmp_eq_u32 vcc, -1, v32
s_cbranch_vccnz mega_kernel_rf_pc_9_0f
v_smfmac_f32_16x16x64_bf16 v[96:99], v[32:35], a[192:199], v6
v_smfmac_f32_16x16x64_bf16 v[100:103], v[32:35], a[224:231], v6
s_branch mega_kernel_rf_pc_8_3
mega_kernel_rf_pc_9_3f:
s_mov_b64 exec, vcc
buffer_load_dwordx4 v[44:47], v7, s[84:87], s29 offen offset:3072 sc1
s_mov_b64 exec, -1
s_branch mega_kernel_rf_pc_9_0
mega_kernel_rf_pc_9_3:
s_waitcnt vmcnt(1)
v_cmp_eq_u32 vcc, -1, v44
s_cbranch_vccnz mega_kernel_rf_pc_9_3f
v_smfmac_f32_16x16x64_bf16 v[96:99], v[44:47], a[216:223], v6
v_smfmac_f32_16x16x64_bf16 v[100:103], v[44:47], a[248:255], v6
s_branch mega_kernel_rf_pc_1_0
mega_kernel_rf_pc_10_1f:
s_mov_b64 exec, vcc
buffer_load_dwordx4 v[36:39], v7, s[84:87], s29 offen offset:1024 sc1
s_mov_b64 exec, -1
s_branch mega_kernel_rf_pc_10_3
mega_kernel_rf_pc_10_1:
s_waitcnt vmcnt(1)
v_cmp_eq_u32 vcc, -1, v36
s_cbranch_vccnz mega_kernel_rf_pc_10_1f
v_smfmac_f32_16x16x64_bf16 v[96:99], v[36:39], a[200:207], v6
v_smfmac_f32_16x16x64_bf16 v[100:103], v[36:39], a[232:239], v6
s_branch mega_kernel_rf_pc_8_3
mega_kernel_rf_pc_10_3f:
s_mov_b64 exec, vcc
buffer_load_dwordx4 v[44:47], v7, s[84:87], s29 offen offset:3072 sc1
s_mov_b64 exec, -1
s_branch mega_kernel_rf_pc_10_1
mega_kernel_rf_pc_10_3:
s_waitcnt vmcnt(1)
v_cmp_eq_u32 vcc, -1, v44
s_cbranch_vccnz mega_kernel_rf_pc_10_3f
v_smfmac_f32_16x16x64_bf16 v[96:99], v[44:47], a[216:223], v6
v_smfmac_f32_16x16x64_bf16 v[100:103], v[44:47], a[248:255], v6
s_branch mega_kernel_rf_pc_2_1
mega_kernel_rf_pc_11_0f:
s_mov_b64 exec, vcc
buffer_load_dwordx4 v[32:35], v7, s[84:87], s29 offen offset:0 sc1
s_mov_b64 exec, -1
s_branch mega_kernel_rf_pc_11_1
mega_kernel_rf_pc_11_0:
s_waitcnt vmcnt(2)
v_cmp_eq_u32 vcc, -1, v32
s_cbranch_vccnz mega_kernel_rf_pc_11_0f
v_smfmac_f32_16x16x64_bf16 v[96:99], v[32:35], a[192:199], v6
v_smfmac_f32_16x16x64_bf16 v[100:103], v[32:35], a[224:231], v6
s_branch mega_kernel_rf_pc_10_1
mega_kernel_rf_pc_11_1f:
s_mov_b64 exec, vcc
buffer_load_dwordx4 v[36:39], v7, s[84:87], s29 offen offset:1024 sc1
s_mov_b64 exec, -1
s_branch mega_kernel_rf_pc_11_3
mega_kernel_rf_pc_11_1:
s_waitcnt vmcnt(2)
v_cmp_eq_u32 vcc, -1, v36
s_cbranch_vccnz mega_kernel_rf_pc_11_1f
v_smfmac_f32_16x16x64_bf16 v[96:99], v[36:39], a[200:207], v6
v_smfmac_f32_16x16x64_bf16 v[100:103], v[36:39], a[232:239], v6
s_branch mega_kernel_rf_pc_9_3
mega_kernel_rf_pc_11_3f:
s_mov_b64 exec, vcc
buffer_load_dwordx4 v[44:47], v7, s[84:87], s29 offen offset:3072 sc1
s_mov_b64 exec, -1
s_branch mega_kernel_rf_pc_11_0
mega_kernel_rf_pc_11_3:
s_waitcnt vmcnt(2)
v_cmp_eq_u32 vcc, -1, v44
s_cbranch_vccnz mega_kernel_rf_pc_11_3f
v_smfmac_f32_16x16x64_bf16 v[96:99], v[44:47], a[216:223], v6
v_smfmac_f32_16x16x64_bf16 v[100:103], v[44:47], a[248:255], v6
s_branch mega_kernel_rf_pc_3_0
mega_kernel_rf_pc_12_2f:
s_mov_b64 exec, vcc
buffer_load_dwordx4 v[40:43], v7, s[84:87], s29 offen offset:2048 sc1
s_mov_b64 exec, -1
s_branch mega_kernel_rf_pc_12_3
mega_kernel_rf_pc_12_3f:
s_mov_b64 exec, vcc
buffer_load_dwordx4 v[44:47], v7, s[84:87], s29 offen offset:3072 sc1
s_mov_b64 exec, -1
s_branch mega_kernel_rf_pc_12_2
mega_kernel_rf_pc_12_3:
s_waitcnt vmcnt(1)
v_cmp_eq_u32 vcc, -1, v44
s_cbranch_vccnz mega_kernel_rf_pc_12_3f
v_smfmac_f32_16x16x64_bf16 v[96:99], v[44:47], a[216:223], v6
v_smfmac_f32_16x16x64_bf16 v[100:103], v[44:47], a[248:255], v6
s_branch mega_kernel_rf_pc_4_2
mega_kernel_rf_pc_13_0f:
s_mov_b64 exec, vcc
buffer_load_dwordx4 v[32:35], v7, s[84:87], s29 offen offset:0 sc1
s_mov_b64 exec, -1
s_branch mega_kernel_rf_pc_13_2
mega_kernel_rf_pc_13_0:
s_waitcnt vmcnt(2)
v_cmp_eq_u32 vcc, -1, v32
s_cbranch_vccnz mega_kernel_rf_pc_13_0f
v_smfmac_f32_16x16x64_bf16 v[96:99], v[32:35], a[192:199], v6
v_smfmac_f32_16x16x64_bf16 v[100:103], v[32:35], a[224:231], v6
s_branch mega_kernel_rf_pc_12_2
mega_kernel_rf_pc_13_2f:
s_mov_b64 exec, vcc
buffer_load_dwordx4 v[40:43], v7, s[84:87], s29 offen offset:2048 sc1
s_mov_b64 exec, -1
s_branch mega_kernel_rf_pc_13_3
mega_kernel_rf_pc_13_2:
s_waitcnt vmcnt(2)
v_cmp_eq_u32 vcc, -1, v40
s_cbranch_vccnz mega_kernel_rf_pc_13_2f
v_smfmac_f32_16x16x64_bf16 v[96:99], v[40:43], a[208:215], v6
v_smfmac_f32_16x16x64_bf16 v[100:103], v[40:43], a[240:247], v6
s_branch mega_kernel_rf_pc_9_3
mega_kernel_rf_pc_13_3f:
s_mov_b64 exec, vcc
buffer_load_dwordx4 v[44:47], v7, s[84:87], s29 offen offset:3072 sc1
s_mov_b64 exec, -1
s_branch mega_kernel_rf_pc_13_0
mega_kernel_rf_pc_13_3:
s_waitcnt vmcnt(2)
v_cmp_eq_u32 vcc, -1, v44
s_cbranch_vccnz mega_kernel_rf_pc_13_3f
v_smfmac_f32_16x16x64_bf16 v[96:99], v[44:47], a[216:223], v6
v_smfmac_f32_16x16x64_bf16 v[100:103], v[44:47], a[248:255], v6
s_branch mega_kernel_rf_pc_5_0
mega_kernel_rf_pc_14_1f:
s_mov_b64 exec, vcc
buffer_load_dwordx4 v[36:39], v7, s[84:87], s29 offen offset:1024 sc1
s_mov_b64 exec, -1
s_branch mega_kernel_rf_pc_14_2
mega_kernel_rf_pc_14_2f:
s_mov_b64 exec, vcc
buffer_load_dwordx4 v[40:43], v7, s[84:87], s29 offen offset:2048 sc1
s_mov_b64 exec, -1
s_branch mega_kernel_rf_pc_14_3
mega_kernel_rf_pc_14_2:
s_waitcnt vmcnt(2)
v_cmp_eq_u32 vcc, -1, v40
s_cbranch_vccnz mega_kernel_rf_pc_14_2f
v_smfmac_f32_16x16x64_bf16 v[96:99], v[40:43], a[208:215], v6
v_smfmac_f32_16x16x64_bf16 v[100:103], v[40:43], a[240:247], v6
s_branch mega_kernel_rf_pc_10_3
mega_kernel_rf_pc_14_3f:
s_mov_b64 exec, vcc
buffer_load_dwordx4 v[44:47], v7, s[84:87], s29 offen offset:3072 sc1
s_mov_b64 exec, -1
s_branch mega_kernel_rf_pc_14_1
mega_kernel_rf_pc_14_3:
s_waitcnt vmcnt(2)
v_cmp_eq_u32 vcc, -1, v44
s_cbranch_vccnz mega_kernel_rf_pc_14_3f
v_smfmac_f32_16x16x64_bf16 v[96:99], v[44:47], a[216:223], v6
v_smfmac_f32_16x16x64_bf16 v[100:103], v[44:47], a[248:255], v6
s_branch mega_kernel_rf_pc_6_1
mega_kernel_rf_pc_15_0f:
s_mov_b64 exec, vcc
buffer_load_dwordx4 v[32:35], v7, s[84:87], s29 offen offset:0 sc1
s_mov_b64 exec, -1
s_branch mega_kernel_rf_pc_15_1
mega_kernel_rf_pc_15_1f:
s_mov_b64 exec, vcc
buffer_load_dwordx4 v[36:39], v7, s[84:87], s29 offen offset:1024 sc1
s_mov_b64 exec, -1
s_branch mega_kernel_rf_pc_15_2
mega_kernel_rf_pc_15_1:
s_waitcnt vmcnt(3)
v_cmp_eq_u32 vcc, -1, v36
s_cbranch_vccnz mega_kernel_rf_pc_15_1f
v_smfmac_f32_16x16x64_bf16 v[96:99], v[36:39], a[200:207], v6
v_smfmac_f32_16x16x64_bf16 v[100:103], v[36:39], a[232:239], v6
s_branch mega_kernel_rf_pc_13_2
mega_kernel_rf_pc_15_2f:
s_mov_b64 exec, vcc
buffer_load_dwordx4 v[40:43], v7, s[84:87], s29 offen offset:2048 sc1
s_mov_b64 exec, -1
s_branch mega_kernel_rf_pc_15_3
mega_kernel_rf_pc_15_2:
s_waitcnt vmcnt(3)
v_cmp_eq_u32 vcc, -1, v40
s_cbranch_vccnz mega_kernel_rf_pc_15_2f
v_smfmac_f32_16x16x64_bf16 v[96:99], v[40:43], a[208:215], v6
v_smfmac_f32_16x16x64_bf16 v[100:103], v[40:43], a[240:247], v6
s_branch mega_kernel_rf_pc_11_3
mega_kernel_rf_pc_15_3f:
s_mov_b64 exec, vcc
buffer_load_dwordx4 v[44:47], v7, s[84:87], s29 offen offset:3072 sc1
s_mov_b64 exec, -1
s_branch mega_kernel_rf_pc_15_0
mega_kernel_rf_pc_15_3:
s_waitcnt vmcnt(3)
v_cmp_eq_u32 vcc, -1, v44
s_cbranch_vccnz mega_kernel_rf_pc_15_3f
v_smfmac_f32_16x16x64_bf16 v[96:99], v[44:47], a[216:223], v6
v_smfmac_f32_16x16x64_bf16 v[100:103], v[44:47], a[248:255], v6
s_branch mega_kernel_rf_pc_7_0
mega_kernel_rf_w0last:
s_nop 7
v_permlane32_swap_b32 v112, v116
v_permlane32_swap_b32 v113, v117
v_permlane32_swap_b32 v114, v118
v_permlane32_swap_b32 v115, v119
v_pk_add_f32 v[112:113], v[112:113], v[116:117]
v_pk_add_f32 v[114:115], v[114:115], v[118:119]
ds_write_b128 v20, v[112:115]
s_waitcnt lgkmcnt(0)
s_barrier
s_branch mega_kernel_rf_end
mega_kernel_rf_side:
s_cmp_eq_u32 s24, 3
s_cbranch_scc1 mega_kernel_rf_sd3
s_cmp_eq_u32 s24, 2
s_cbranch_scc0 mega_kernel_rf_sd4
s_mov_b64 exec, s[40:41]
buffer_store_dwordx4 v[28:31], v11, s[84:87], s34 offen
s_mov_b64 exec, -1
buffer_store_dwordx2 v[28:29], v9, s[84:87], s34 offen
s_mul_i32 s28, s31, 2048
s_add_u32 s28, s28, s34
s_add_u32 s28, s28, 49152
buffer_store_dwordx4 v[28:31], v17, s[84:87], s28 offen
buffer_store_dwordx4 v[28:31], v10, s[84:87], s28 offen
s_branch mega_kernel_rf_sd4
mega_kernel_rf_sd3:
s_mov_b32 s36, 0
s_add_u32 s76, s27, 1
s_cmp_lt_u32 s76, 63
s_cbranch_scc0 mega_kernel_rf_sd4
s_cmp_ge_u32 s76, 0
s_cbranch_scc0 mega_kernel_rf_sd4
s_cmp_gt_i32 s46, s76
s_cselect_b32 s36, 0, 1
s_cbranch_scc0 mega_kernel_rf_sd4
s_add_u32 s77, s76, s82
s_bfe_u32 s28, s77, 0x40002
s_lshl_b32 s28, s28, 14
s_and_b32 s77, s77, 3
s_lshl_b32 s77, s77, 11
s_add_u32 s28, s28, s77
s_add_u32 m0, s45, 0
s_nop 0
buffer_load_dwordx4 v240, s[84:87], s28 offen offset:0 sc1 lds
s_add_u32 m0, s45, 0
s_nop 0
buffer_load_dwordx4 v240, s[84:87], s28 offen offset:1024 sc1 lds
s_add_u32 m0, s45, 2048
s_nop 0
buffer_load_dwordx4 v241, s[84:87], s28 offen offset:0 sc1 lds
s_add_u32 m0, s45, 2048
s_nop 0
buffer_load_dwordx4 v241, s[84:87], s28 offen offset:1024 sc1 lds
s_add_u32 s45, s45, 4096
s_cmp_eq_u32 s45, 30720
s_cselect_b32 s45, 18432, s45
mega_kernel_rf_sd4:
v_smfmac_f32_16x16x64_bf16 v[112:115], v[40:43], a[144:151], v6
v_smfmac_f32_16x16x64_bf16 v[116:119], v[40:43], a[176:183], v6
v_smfmac_f32_16x16x64_bf16 v[112:115], v[44:47], a[152:159], v6
v_smfmac_f32_16x16x64_bf16 v[116:119], v[44:47], a[184:191], v6
s_nop 7
v_permlane32_swap_b32 v112, v116
v_permlane32_swap_b32 v113, v117
v_permlane32_swap_b32 v114, v118
v_permlane32_swap_b32 v115, v119
v_pk_add_f32 v[112:113], v[112:113], v[116:117]
v_pk_add_f32 v[114:115], v[114:115], v[118:119]
ds_write_b128 v20, v[112:115]
v_mov_b32 v96, 0
v_mov_b32 v97, 0
v_mov_b32 v98, 0
v_mov_b32 v99, 0
v_mov_b32 v100, 0
v_mov_b32 v101, 0
v_mov_b32 v102, 0
v_mov_b32 v103, 0
s_cmp_eq_u32 s24, 1
s_cbranch_scc0 mega_kernel_rf_s1
s_waitcnt lgkmcnt(0)
ds_read_b128 v[120:123], v16 offset:0
ds_read_b128 v[124:127], v16 offset:16
ds_read_b128 v[128:131], v16 offset:2304
ds_read_b128 v[132:135], v16 offset:2320
ds_read_b128 v[136:139], v16 offset:4608
ds_read_b128 v[140:143], v16 offset:4624
ds_read_b128 v[144:147], v16 offset:6912
ds_read_b128 v[148:151], v16 offset:6928
s_waitcnt lgkmcnt(4)
v_pk_add_f32 v[120:121], v[120:121], v[128:129]
v_pk_add_f32 v[122:123], v[122:123], v[130:131]
v_pk_add_f32 v[124:125], v[124:125], v[132:133]
v_pk_add_f32 v[126:127], v[126:127], v[134:135]
s_waitcnt lgkmcnt(0)
v_pk_add_f32 v[136:137], v[136:137], v[144:145]
v_pk_add_f32 v[138:139], v[138:139], v[146:147]
v_pk_add_f32 v[140:141], v[140:141], v[148:149]
v_pk_add_f32 v[142:143], v[142:143], v[150:151]
v_pk_add_f32 v[120:121], v[120:121], v[136:137]
v_pk_add_f32 v[122:123], v[122:123], v[138:139]
v_pk_add_f32 v[124:125], v[124:125], v[140:141]
v_pk_add_f32 v[126:127], v[126:127], v[142:143]
v_cvt_pk_bf16_f32 v244, v120, v121
v_cvt_pk_bf16_f32 v245, v122, v123
v_cvt_pk_bf16_f32 v246, v124, v125
v_cvt_pk_bf16_f32 v247, v126, v127
mega_kernel_rf_s1:
v_add_u32 v5, 9216, v17
s_waitcnt lgkmcnt(0)
s_barrier
s_cmp_eq_u32 s24, 2
s_cbranch_scc1 mega_kernel_rf_s2
s_cmp_eq_u32 s24, 3
s_cbranch_scc0 mega_kernel_rf_s3
s_add_u32 s76, s27, 2
s_cmp_lt_u32 s76, 63
s_cbranch_scc0 mega_kernel_rf_s3
s_cmp_gt_i32 s46, s76
s_cbranch_scc0 mega_kernel_rf_s3
s_add_u32 s77, s76, s82
s_bfe_u32 s28, s77, 0x40002
s_lshl_b32 s28, s28, 14
s_and_b32 s77, s77, 3
s_lshl_b32 s77, s77, 11
s_add_u32 s28, s28, s77
s_add_u32 s28, s28, s83
s_buffer_load_dword s78, s[84:87], s28 offset:0
s_buffer_load_dword s78, s[84:87], s28 offset:128
s_buffer_load_dword s78, s[84:87], s28 offset:256
s_buffer_load_dword s78, s[84:87], s28 offset:384
s_buffer_load_dword s78, s[84:87], s28 offset:512
s_buffer_load_dword s78, s[84:87], s28 offset:640
s_buffer_load_dword s78, s[84:87], s28 offset:768
s_buffer_load_dword s78, s[84:87], s28 offset:896
s_buffer_load_dword s78, s[84:87], s28 offset:1024
s_buffer_load_dword s78, s[84:87], s28 offset:1152
s_buffer_load_dword s78, s[84:87], s28 offset:1280
s_buffer_load_dword s78, s[84:87], s28 offset:1408
s_buffer_load_dword s78, s[84:87], s28 offset:1536
s_buffer_load_dword s78, s[84:87], s28 offset:1664
s_buffer_load_dword s78, s[84:87], s28 offset:1792
s_buffer_load_dword s78, s[84:87], s28 offset:1920
s_mov_b32 s88, s76
s_branch mega_kernel_rf_s3
mega_kernel_rf_s2:
ds_read_b128 v[120:123], v5 offset:0
ds_read_b128 v[124:127], v5 offset:1024
ds_read_b128 v[128:131], v5 offset:2048
ds_read_b128 v[132:135], v5 offset:3072
v_lshrrev_b32 v5, 1, v17
s_waitcnt lgkmcnt(2)
v_pk_add_f32 v[120:121], v[120:121], v[124:125]
v_pk_add_f32 v[122:123], v[122:123], v[126:127]
s_waitcnt lgkmcnt(0)
v_pk_add_f32 v[128:129], v[128:129], v[132:133]
v_pk_add_f32 v[130:131], v[130:131], v[134:135]
v_pk_add_f32 v[120:121], v[120:121], v[128:129]
v_pk_add_f32 v[122:123], v[122:123], v[130:131]
v_cvt_pk_bf16_f32 v244, v120, v121
v_cvt_pk_bf16_f32 v245, v122, v123
ds_write_b64 v5, v[244:245] offset:17920
s_waitcnt lgkmcnt(0) vmcnt(0)
mega_kernel_rf_s3:
s_cmp_eq_u32 s27, 63
s_cbranch_scc1 mega_kernel_rf_slast
s_add_u32 s29, s33, 24576
s_barrier
s_cmp_eq_u32 s24, 3
s_cbranch_scc1 mega_kernel_rf_y3
s_add_u32 s77, s27, s82
s_bfe_u32 s28, s77, 0x30003
s_lshl_b32 s28, s28, 14
s_and_b32 s77, s77, 7
s_lshl_b32 s77, s77, 10
s_add_u32 s28, s28, s77
s_add_u32 s28, s28, s79
s_cmp_eq_u32 s24, 2
s_cbranch_scc1 mega_kernel_rf_kv2a
s_mov_b64 exec, s[48:49]
buffer_store_dwordx4 v[244:247], v22, s[84:87], s28 offen sc1
s_mov_b64 exec, -1
s_branch mega_kernel_rf_kvda
mega_kernel_rf_kv2a:
v_lshlrev_b32 v4, 3, v1
buffer_store_dwordx2 v[244:245], v4, s[84:87], s28 offen offset:512 sc1
mega_kernel_rf_kvda:
s_branch mega_kernel_rf_y4
mega_kernel_rf_y3:
s_add_u32 s76, s27, 2
s_cmp_lt_u32 s76, 63
s_cbranch_scc0 mega_kernel_rf_y4
mega_kernel_rf_y4:
s_branch mega_kernel_rf_b3
mega_kernel_rf_first:
buffer_load_dwordx4 v[32:35], v8, s[20:23], 0 offen offset:0
buffer_load_dwordx4 v[36:39], v8, s[20:23], 0 offen offset:128
buffer_load_dwordx4 v[40:43], v8, s[20:23], 0 offen offset:256
buffer_load_dwordx4 v[44:47], v8, s[20:23], 0 offen offset:384
v_add_u32 v5, s44, v17
ds_read_b128 v[156:159], v5 offset:0
ds_read_b128 v[160:163], v5 offset:1024
ds_read_b128 v[164:167], v5 offset:2048
ds_read_b128 v[168:171], v5 offset:3072
s_waitcnt vmcnt(0)
v_smfmac_f32_16x16x64_bf16 v[96:99], v[32:35], a[0:7], v6
v_smfmac_f32_16x16x64_bf16 v[100:103], v[32:35], a[32:39], v6
v_smfmac_f32_16x16x64_bf16 v[104:107], v[32:35], a[64:71], v6
v_smfmac_f32_16x16x64_bf16 v[108:111], v[32:35], a[96:103], v6
v_smfmac_f32_16x16x64_bf16 v[96:99], v[36:39], a[8:15], v6
v_smfmac_f32_16x16x64_bf16 v[100:103], v[36:39], a[40:47], v6
v_smfmac_f32_16x16x64_bf16 v[104:107], v[36:39], a[72:79], v6
v_smfmac_f32_16x16x64_bf16 v[108:111], v[36:39], a[104:111], v6
v_smfmac_f32_16x16x64_bf16 v[96:99], v[40:43], a[16:23], v6
v_smfmac_f32_16x16x64_bf16 v[100:103], v[40:43], a[48:55], v6
v_smfmac_f32_16x16x64_bf16 v[104:107], v[40:43], a[80:87], v6
v_smfmac_f32_16x16x64_bf16 v[108:111], v[40:43], a[112:119], v6
v_smfmac_f32_16x16x64_bf16 v[96:99], v[44:47], a[24:31], v6
v_smfmac_f32_16x16x64_bf16 v[100:103], v[44:47], a[56:63], v6
v_smfmac_f32_16x16x64_bf16 v[104:107], v[44:47], a[88:95], v6
v_smfmac_f32_16x16x64_bf16 v[108:111], v[44:47], a[120:127], v6
s_nop 1
s_branch mega_kernel_rf_adone
mega_kernel_rf_slast:
s_cmp_eq_u32 s24, 3
s_cbranch_scc1 mega_kernel_rf_end
s_add_u32 s77, s27, s82
s_bfe_u32 s28, s77, 0x30003
s_lshl_b32 s28, s28, 14
s_and_b32 s77, s77, 7
s_lshl_b32 s77, s77, 10
s_add_u32 s28, s28, s77
s_add_u32 s28, s28, s79
s_cmp_eq_u32 s24, 2
s_cbranch_scc1 mega_kernel_rf_kv2b
s_mov_b64 exec, s[48:49]
buffer_store_dwordx4 v[244:247], v22, s[84:87], s28 offen sc1
s_mov_b64 exec, -1
s_branch mega_kernel_rf_kvdb
mega_kernel_rf_kv2b:
v_lshlrev_b32 v4, 3, v1
buffer_store_dwordx2 v[244:245], v4, s[84:87], s28 offen offset:512 sc1
mega_kernel_rf_kvdb:
s_waitcnt vmcnt(0)
s_barrier
s_mov_b32 s76, 64
s_cmp_eq_u32 s24, 1
s_cbranch_scc0 mega_kernel_rf_end
v_mov_b32 v5, s76
s_mov_b64 exec, 1
buffer_store_dword v5, v228, s[84:87], s81 offen sc1
s_mov_b64 exec, -1
mega_kernel_rf_end:
s_endpgm
mega_kernel_recs:
s_load_dwordx2 s[20:21], s[0:1], 8
s_load_dwordx2 s[16:17], s[0:1], 40
s_load_dwordx2 s[4:5], s[0:1], 16
s_load_dwordx2 s[8:9], s[0:1], 24
s_load_dwordx2 s[12:13], s[0:1], 32
v_lshrrev_b32 v4, 6, v0
v_and_b32 v1, 63, v0
v_readfirstlane_b32 s24, v4
v_lshrrev_b32 v2, 4, v1
v_and_b32 v3, 15, v1
v_lshlrev_b32 v17, 4, v1
s_lshr_b32 s28, s31, 2
s_lshl_b32 s25, s30, 3
s_add_u32 s25, s25, s28
s_and_b32 s26, s31, 3
s_waitcnt lgkmcnt(0)
s_mov_b32 s22, 16384
s_mov_b32 s23, 0x00020000
s_mov_b32 s18, 8388608
s_mov_b32 s19, 0x00020000
s_mov_b32 s6, 8388608
s_mov_b32 s7, 0x00020000
s_mov_b32 s10, 8388608
s_mov_b32 s11, 0x00020000
s_mov_b32 s14, 8388608
s_mov_b32 s15, 0x00020000
s_lshl_b32 s28, s25, 8
s_lshr_b32 s29, s26, 0
s_lshl_b32 s29, s29, 6
s_add_u32 s28, s28, s29
s_lshl_b32 s29, s24, 21
s_add_u32 s28, s28, s29
v_lshrrev_b32 v4, 2, v1
v_and_b32 v5, 3, v1
v_lshlrev_b32 v40, 13, v4
v_lshl_add_u32 v40, v5, 4, v40
v_add_u32 v40, s28, v40
s_lshl_b32 s28, s30, 21
s_lshl_b32 s29, s24, 19
s_add_u32 s28, s28, s29
s_lshr_b32 s29, s31, 0
s_lshl_b32 s29, s29, 6
s_add_u32 s28, s28, s29
v_lshlrev_b32 v41, 11, v4
v_lshl_add_u32 v41, v5, 4, v41
v_add_u32 v41, s28, v41
s_lshl_b32 s47, s24, 15
s_add_u32 s47, s47, 32768
s_lshl_b32 s28, s31, 18
s_lshl_b32 s29, s24, 16
s_add_u32 s28, s28, s29
s_lshl_b32 s29, s30, 11
s_add_u32 s28, s28, s29
v_lshlrev_b32 v48, 13, v2
v_lshl_add_u32 v48, v3, 7, v48
v_add_u32 v48, s28, v48
s_lshl_b32 s28, s30, 21
s_lshl_b32 s29, s31, 16
s_add_u32 s28, s28, s29
s_lshl_b32 s29, s24, 14
s_add_u32 s28, s28, s29
v_lshlrev_b32 v49, 7, v1
v_add_u32 v49, s28, v49
s_and_b32 s76, s31, 1
s_mul_i32 s76, s76, 8
s_and_b32 s28, s31, 15
s_lshl_b32 s28, s28, 4
s_lshl_b32 s29, s24, 8
s_add_u32 s28, s28, s29
v_add_u32 v53, s28, v3
s_lshr_b32 s28, s31, 4
s_lshl_b32 s28, s28, 10
s_add_u32 s28, s28, 384
v_mov_b32 v54, s28
v_mov_b32 v55, 1920
v_cmp_gt_u32 vcc, 32, v1
s_nop 1
v_cndmask_b32 v54, v55, v54, vcc
s_lshl_b32 s29, s30, 11
v_lshl_add_u32 v51, v53, 13, v54
v_add_u32 v51, s29, v51
s_lshl_b32 s29, s30, 21
v_lshl_add_u32 v52, v53, 11, v54
v_add_u32 v52, s29, v52
buffer_load_dword v50, v51, s[8:11], 0 offen
s_xor_b32 s29, s76, 0
s_lshl_b32 s28, s29, 10
s_add_u32 s28, s28, s47
s_add_u32 m0, s28, 0
s_lshl_b32 s29, s29, 17
buffer_load_dwordx4 v40, s[8:11], s29 offen lds
s_xor_b32 s29, s76, 1
s_lshl_b32 s28, s29, 10
s_add_u32 s28, s28, s47
s_add_u32 m0, s28, 0
s_lshl_b32 s29, s29, 17
buffer_load_dwordx4 v40, s[8:11], s29 offen lds
s_xor_b32 s29, s76, 2
s_lshl_b32 s28, s29, 10
s_add_u32 s28, s28, s47
s_add_u32 m0, s28, 0
s_lshl_b32 s29, s29, 17
buffer_load_dwordx4 v40, s[8:11], s29 offen lds
s_xor_b32 s29, s76, 3
s_lshl_b32 s28, s29, 10
s_add_u32 s28, s28, s47
s_add_u32 m0, s28, 0
s_lshl_b32 s29, s29, 17
buffer_load_dwordx4 v40, s[8:11], s29 offen lds
s_xor_b32 s29, s76, 4
s_lshl_b32 s28, s29, 10
s_add_u32 s28, s28, s47
s_add_u32 m0, s28, 0
s_lshl_b32 s29, s29, 17
buffer_load_dwordx4 v40, s[8:11], s29 offen lds
s_xor_b32 s29, s76, 5
s_lshl_b32 s28, s29, 10
s_add_u32 s28, s28, s47
s_add_u32 m0, s28, 0
s_lshl_b32 s29, s29, 17
buffer_load_dwordx4 v40, s[8:11], s29 offen lds
s_xor_b32 s29, s76, 6
s_lshl_b32 s28, s29, 10
s_add_u32 s28, s28, s47
s_add_u32 m0, s28, 0
s_lshl_b32 s29, s29, 17
buffer_load_dwordx4 v40, s[8:11], s29 offen lds
s_xor_b32 s29, s76, 7
s_lshl_b32 s28, s29, 10
s_add_u32 s28, s28, s47
s_add_u32 m0, s28, 0
s_lshl_b32 s29, s29, 17
buffer_load_dwordx4 v40, s[8:11], s29 offen lds
s_xor_b32 s29, s76, 8
s_lshl_b32 s28, s29, 10
s_add_u32 s28, s28, s47
s_add_u32 m0, s28, 0
s_lshl_b32 s29, s29, 17
buffer_load_dwordx4 v40, s[8:11], s29 offen lds
s_xor_b32 s29, s76, 9
s_lshl_b32 s28, s29, 10
s_add_u32 s28, s28, s47
s_add_u32 m0, s28, 0
s_lshl_b32 s29, s29, 17
buffer_load_dwordx4 v40, s[8:11], s29 offen lds
s_xor_b32 s29, s76, 10
s_lshl_b32 s28, s29, 10
s_add_u32 s28, s28, s47
s_add_u32 m0, s28, 0
s_lshl_b32 s29, s29, 17
buffer_load_dwordx4 v40, s[8:11], s29 offen lds
s_xor_b32 s29, s76, 11
s_lshl_b32 s28, s29, 10
s_add_u32 s28, s28, s47
s_add_u32 m0, s28, 0
s_lshl_b32 s29, s29, 17
buffer_load_dwordx4 v40, s[8:11], s29 offen lds
s_xor_b32 s29, s76, 12
s_lshl_b32 s28, s29, 10
s_add_u32 s28, s28, s47
s_add_u32 m0, s28, 0
s_lshl_b32 s29, s29, 17
buffer_load_dwordx4 v40, s[8:11], s29 offen lds
s_xor_b32 s29, s76, 13
s_lshl_b32 s28, s29, 10
s_add_u32 s28, s28, s47
s_add_u32 m0, s28, 0
s_lshl_b32 s29, s29, 17
buffer_load_dwordx4 v40, s[8:11], s29 offen lds
s_xor_b32 s29, s76, 14
s_lshl_b32 s28, s29, 10
s_add_u32 s28, s28, s47
s_add_u32 m0, s28, 0
s_lshl_b32 s29, s29, 17
buffer_load_dwordx4 v40, s[8:11], s29 offen lds
s_xor_b32 s29, s76, 15
s_lshl_b32 s28, s29, 10
s_add_u32 s28, s28, s47
s_add_u32 m0, s28, 0
s_lshl_b32 s29, s29, 17
buffer_load_dwordx4 v40, s[8:11], s29 offen lds
buffer_load_dword v50, v51, s[12:15], 0 offen
s_xor_b32 s29, s76, 0
s_lshl_b32 s28, s29, 10
s_add_u32 s28, s28, s47
s_add_u32 m0, s28, 16384
s_lshl_b32 s29, s29, 17
buffer_load_dwordx4 v40, s[12:15], s29 offen lds
s_xor_b32 s29, s76, 1
s_lshl_b32 s28, s29, 10
s_add_u32 s28, s28, s47
s_add_u32 m0, s28, 16384
s_lshl_b32 s29, s29, 17
buffer_load_dwordx4 v40, s[12:15], s29 offen lds
s_xor_b32 s29, s76, 2
s_lshl_b32 s28, s29, 10
s_add_u32 s28, s28, s47
s_add_u32 m0, s28, 16384
s_lshl_b32 s29, s29, 17
buffer_load_dwordx4 v40, s[12:15], s29 offen lds
s_xor_b32 s29, s76, 3
s_lshl_b32 s28, s29, 10
s_add_u32 s28, s28, s47
s_add_u32 m0, s28, 16384
s_lshl_b32 s29, s29, 17
buffer_load_dwordx4 v40, s[12:15], s29 offen lds
s_xor_b32 s29, s76, 4
s_lshl_b32 s28, s29, 10
s_add_u32 s28, s28, s47
s_add_u32 m0, s28, 16384
s_lshl_b32 s29, s29, 17
buffer_load_dwordx4 v40, s[12:15], s29 offen lds
s_xor_b32 s29, s76, 5
s_lshl_b32 s28, s29, 10
s_add_u32 s28, s28, s47
s_add_u32 m0, s28, 16384
s_lshl_b32 s29, s29, 17
buffer_load_dwordx4 v40, s[12:15], s29 offen lds
s_xor_b32 s29, s76, 6
s_lshl_b32 s28, s29, 10
s_add_u32 s28, s28, s47
s_add_u32 m0, s28, 16384
s_lshl_b32 s29, s29, 17
buffer_load_dwordx4 v40, s[12:15], s29 offen lds
s_xor_b32 s29, s76, 7
s_lshl_b32 s28, s29, 10
s_add_u32 s28, s28, s47
s_add_u32 m0, s28, 16384
s_lshl_b32 s29, s29, 17
buffer_load_dwordx4 v40, s[12:15], s29 offen lds
s_xor_b32 s29, s76, 8
s_lshl_b32 s28, s29, 10
s_add_u32 s28, s28, s47
s_add_u32 m0, s28, 16384
s_lshl_b32 s29, s29, 17
buffer_load_dwordx4 v40, s[12:15], s29 offen lds
s_xor_b32 s29, s76, 9
s_lshl_b32 s28, s29, 10
s_add_u32 s28, s28, s47
s_add_u32 m0, s28, 16384
s_lshl_b32 s29, s29, 17
buffer_load_dwordx4 v40, s[12:15], s29 offen lds
s_xor_b32 s29, s76, 10
s_lshl_b32 s28, s29, 10
s_add_u32 s28, s28, s47
s_add_u32 m0, s28, 16384
s_lshl_b32 s29, s29, 17
buffer_load_dwordx4 v40, s[12:15], s29 offen lds
s_xor_b32 s29, s76, 11
s_lshl_b32 s28, s29, 10
s_add_u32 s28, s28, s47
s_add_u32 m0, s28, 16384
s_lshl_b32 s29, s29, 17
buffer_load_dwordx4 v40, s[12:15], s29 offen lds
s_xor_b32 s29, s76, 12
s_lshl_b32 s28, s29, 10
s_add_u32 s28, s28, s47
s_add_u32 m0, s28, 16384
s_lshl_b32 s29, s29, 17
buffer_load_dwordx4 v40, s[12:15], s29 offen lds
s_xor_b32 s29, s76, 13
s_lshl_b32 s28, s29, 10
s_add_u32 s28, s28, s47
s_add_u32 m0, s28, 16384
s_lshl_b32 s29, s29, 17
buffer_load_dwordx4 v40, s[12:15], s29 offen lds
s_xor_b32 s29, s76, 14
s_lshl_b32 s28, s29, 10
s_add_u32 s28, s28, s47
s_add_u32 m0, s28, 16384
s_lshl_b32 s29, s29, 17
buffer_load_dwordx4 v40, s[12:15], s29 offen lds
s_xor_b32 s29, s76, 15
s_lshl_b32 s28, s29, 10
s_add_u32 s28, s28, s47
s_add_u32 m0, s28, 16384
s_lshl_b32 s29, s29, 17
buffer_load_dwordx4 v40, s[12:15], s29 offen lds
s_mov_b32 s40, 0x00ff00ff
s_mov_b32 s41, 0x00ff00ff
s_mov_b32 s48, 0xff00ff00
s_mov_b32 s49, 0xff00ff00
s_mov_b32 s42, 0
s_mov_b32 s43, 0x00ff00ff
s_mov_b32 s32, 0x3e0293ee
v_mov_b32 v23, 0xff800000
v_mov_b32 v6, 0x4444
v_mov_b32 v4, 0xeeee
v_cndmask_b32 v6, v6, v4, s[48:49]
v_mov_b32 v28, -1
v_mov_b32 v29, -1
v_mov_b32 v30, -1
v_mov_b32 v31, -1
s_mul_i32 s28, s24, 4096
v_add_u32 v7, s28, v17
v_and_b32 v4, 7, v1
v_lshlrev_b32 v8, 11, v4
v_lshrrev_b32 v5, 3, v1
v_lshl_add_u32 v8, v5, 4, v8
s_lshl_b32 s28, s24, 9
v_add_u32 v8, s28, v8
s_lshl_b32 s28, s31, 9
s_lshr_b32 s29, s31, 3
s_mul_i32 s29, s29, 0
s_add_u32 s28, s28, s29
v_lshlrev_b32 v9, 3, v1
v_add_u32 v9, s28, v9
v_and_b32 v4, 7, v3
v_lshlrev_b32 v11, 7, v2
v_lshl_add_u32 v11, v4, 4, v11
v_add_u32 v22, 0, v11
s_add_u32 s28, s28, 24576
v_add_u32 v11, s28, v11
v_and_b32 v5, 1, v2
v_lshlrev_b32 v10, 7, v5
v_lshl_add_u32 v10, v4, 4, v10
v_add_u32 v10, 1024, v10
s_xor_b32 s37, s31, 1
s_mul_i32 s37, s37, 2048
s_add_u32 s37, s37, 49152
s_xor_b32 s38, s31, 2
s_mul_i32 s38, s38, 2048
s_add_u32 s38, s38, 49152
s_xor_b32 s39, s31, 3
s_mul_i32 s39, s39, 2048
s_add_u32 s39, s39, 49152
v_and_b32 v4, 1, v2
v_mul_u32_u24 v14, 576, v4
v_lshrrev_b32 v5, 1, v2
v_lshl_add_u32 v5, v5, 4, v3
v_lshl_add_u32 v14, v5, 2, v14
s_mul_i32 s28, s24, 1152
s_add_u32 s28, s28, 13312
v_add_u32 v18, s28, v14
s_mul_i32 s28, s24, 2304
v_add_u32 v14, s28, v14
v_add_u32 v15, 1152, v14
v_mul_u32_u24 v16, 144, v3
v_lshl_add_u32 v16, v2, 5, v16
v_bfe_u32 v4, v1, 1, 3
v_mul_u32_u24 v19, 144, v4
v_lshl_add_u32 v19, v2, 5, v19
v_and_b32 v4, 1, v1
v_lshl_add_u32 v19, v4, 4, v19
v_add_u32 v19, 13312, v19
s_lshl_b32 s28, s24, 10
s_add_u32 s28, s28, 9216
v_add_u32 v20, s28, v17
v_and_b32 v4, 31, v1
v_lshlrev_b32 v21, 3, v4
v_add_u32 v21, 17920, v21
v_lshrrev_b32 v4, 2, v3
v_and_b32 v42, 1, v4
v_lshrrev_b32 v43, 1, v4
v_lshrrev_b32 v44, 1, v2
v_and_b32 v45, 1, v2
v_lshl_add_u32 v46, v44, 4, v42
v_lshl_add_u32 v46, v45, 2, v46
v_lshl_add_u32 v46, v43, 3, v46
v_lshl_add_u32 v47, v44, 3, v42
v_lshl_add_u32 v47, v45, 4, v47
v_lshl_add_u32 v47, v43, 2, v47
v_and_b32 v5, 3, v3
v_lshlrev_b32 v5, 3, v5
v_lshl_add_u32 v46, v46, 6, v5
v_lshl_add_u32 v47, v47, 6, v5
s_and_b32 s28, s31, 0
s_lshl_b32 s28, s28, 6
s_add_u32 s28, s28, s47
v_add_u32 v46, s28, v46
v_add_u32 v47, s28, v47
s_waitcnt vmcnt(17)
ds_read_b64_tr_b16 a[64:65], v46 offset:0
ds_read_b64_tr_b16 a[66:67], v46 offset:128
ds_read_b64_tr_b16 a[68:69], v46 offset:2048
ds_read_b64_tr_b16 a[70:71], v46 offset:2176
ds_read_b64_tr_b16 a[72:73], v46 offset:4096
ds_read_b64_tr_b16 a[74:75], v46 offset:4224
ds_read_b64_tr_b16 a[76:77], v46 offset:6144
ds_read_b64_tr_b16 a[78:79], v46 offset:6272
s_waitcnt lgkmcnt(0)
ds_read_b64_tr_b16 a[80:81], v46 offset:8192
ds_read_b64_tr_b16 a[82:83], v46 offset:8320
ds_read_b64_tr_b16 a[84:85], v46 offset:10240
ds_read_b64_tr_b16 a[86:87], v46 offset:10368
ds_read_b64_tr_b16 a[88:89], v46 offset:12288
ds_read_b64_tr_b16 a[90:91], v46 offset:12416
ds_read_b64_tr_b16 a[92:93], v46 offset:14336
ds_read_b64_tr_b16 a[94:95], v46 offset:14464
s_waitcnt lgkmcnt(0)
ds_read_b64_tr_b16 a[96:97], v46 offset:32
ds_read_b64_tr_b16 a[98:99], v46 offset:160
ds_read_b64_tr_b16 a[100:101], v46 offset:2080
ds_read_b64_tr_b16 a[102:103], v46 offset:2208
ds_read_b64_tr_b16 a[104:105], v46 offset:4128
ds_read_b64_tr_b16 a[106:107], v46 offset:4256
ds_read_b64_tr_b16 a[108:109], v46 offset:6176
ds_read_b64_tr_b16 a[110:111], v46 offset:6304
s_waitcnt lgkmcnt(0)
ds_read_b64_tr_b16 a[112:113], v46 offset:8224
ds_read_b64_tr_b16 a[114:115], v46 offset:8352
ds_read_b64_tr_b16 a[116:117], v46 offset:10272
ds_read_b64_tr_b16 a[118:119], v46 offset:10400
ds_read_b64_tr_b16 a[120:121], v46 offset:12320
ds_read_b64_tr_b16 a[122:123], v46 offset:12448
ds_read_b64_tr_b16 a[124:125], v46 offset:14368
ds_read_b64_tr_b16 a[126:127], v46 offset:14496
s_waitcnt lgkmcnt(0)
buffer_load_dword v50, v51, s[4:7], 0 offen
s_xor_b32 s29, s76, 0
s_lshl_b32 s28, s29, 10
s_add_u32 s28, s28, s47
s_add_u32 m0, s28, 0
s_lshl_b32 s29, s29, 17
buffer_load_dwordx4 v40, s[4:7], s29 offen lds
s_xor_b32 s29, s76, 1
s_lshl_b32 s28, s29, 10
s_add_u32 s28, s28, s47
s_add_u32 m0, s28, 0
s_lshl_b32 s29, s29, 17
buffer_load_dwordx4 v40, s[4:7], s29 offen lds
s_xor_b32 s29, s76, 2
s_lshl_b32 s28, s29, 10
s_add_u32 s28, s28, s47
s_add_u32 m0, s28, 0
s_lshl_b32 s29, s29, 17
buffer_load_dwordx4 v40, s[4:7], s29 offen lds
s_xor_b32 s29, s76, 3
s_lshl_b32 s28, s29, 10
s_add_u32 s28, s28, s47
s_add_u32 m0, s28, 0
s_lshl_b32 s29, s29, 17
buffer_load_dwordx4 v40, s[4:7], s29 offen lds
s_xor_b32 s29, s76, 4
s_lshl_b32 s28, s29, 10
s_add_u32 s28, s28, s47
s_add_u32 m0, s28, 0
s_lshl_b32 s29, s29, 17
buffer_load_dwordx4 v40, s[4:7], s29 offen lds
s_xor_b32 s29, s76, 5
s_lshl_b32 s28, s29, 10
s_add_u32 s28, s28, s47
s_add_u32 m0, s28, 0
s_lshl_b32 s29, s29, 17
buffer_load_dwordx4 v40, s[4:7], s29 offen lds
s_xor_b32 s29, s76, 6
s_lshl_b32 s28, s29, 10
s_add_u32 s28, s28, s47
s_add_u32 m0, s28, 0
s_lshl_b32 s29, s29, 17
buffer_load_dwordx4 v40, s[4:7], s29 offen lds
s_xor_b32 s29, s76, 7
s_lshl_b32 s28, s29, 10
s_add_u32 s28, s28, s47
s_add_u32 m0, s28, 0
s_lshl_b32 s29, s29, 17
buffer_load_dwordx4 v40, s[4:7], s29 offen lds
s_xor_b32 s29, s76, 8
s_lshl_b32 s28, s29, 10
s_add_u32 s28, s28, s47
s_add_u32 m0, s28, 0
s_lshl_b32 s29, s29, 17
buffer_load_dwordx4 v40, s[4:7], s29 offen lds
s_xor_b32 s29, s76, 9
s_lshl_b32 s28, s29, 10
s_add_u32 s28, s28, s47
s_add_u32 m0, s28, 0
s_lshl_b32 s29, s29, 17
buffer_load_dwordx4 v40, s[4:7], s29 offen lds
s_xor_b32 s29, s76, 10
s_lshl_b32 s28, s29, 10
s_add_u32 s28, s28, s47
s_add_u32 m0, s28, 0
s_lshl_b32 s29, s29, 17
buffer_load_dwordx4 v40, s[4:7], s29 offen lds
s_xor_b32 s29, s76, 11
s_lshl_b32 s28, s29, 10
s_add_u32 s28, s28, s47
s_add_u32 m0, s28, 0
s_lshl_b32 s29, s29, 17
buffer_load_dwordx4 v40, s[4:7], s29 offen lds
s_xor_b32 s29, s76, 12
s_lshl_b32 s28, s29, 10
s_add_u32 s28, s28, s47
s_add_u32 m0, s28, 0
s_lshl_b32 s29, s29, 17
buffer_load_dwordx4 v40, s[4:7], s29 offen lds
s_xor_b32 s29, s76, 13
s_lshl_b32 s28, s29, 10
s_add_u32 s28, s28, s47
s_add_u32 m0, s28, 0
s_lshl_b32 s29, s29, 17
buffer_load_dwordx4 v40, s[4:7], s29 offen lds
s_xor_b32 s29, s76, 14
s_lshl_b32 s28, s29, 10
s_add_u32 s28, s28, s47
s_add_u32 m0, s28, 0
s_lshl_b32 s29, s29, 17
buffer_load_dwordx4 v40, s[4:7], s29 offen lds
s_xor_b32 s29, s76, 15
s_lshl_b32 s28, s29, 10
s_add_u32 s28, s28, s47
s_add_u32 m0, s28, 0
s_lshl_b32 s29, s29, 17
buffer_load_dwordx4 v40, s[4:7], s29 offen lds
s_waitcnt vmcnt(17)
ds_read_b64_tr_b16 a[128:129], v46 offset:16384
ds_read_b64_tr_b16 a[130:131], v46 offset:16512
ds_read_b64_tr_b16 a[132:133], v46 offset:18432
ds_read_b64_tr_b16 a[134:135], v46 offset:18560
ds_read_b64_tr_b16 a[136:137], v46 offset:20480
ds_read_b64_tr_b16 a[138:139], v46 offset:20608
ds_read_b64_tr_b16 a[140:141], v46 offset:22528
ds_read_b64_tr_b16 a[142:143], v46 offset:22656
s_waitcnt lgkmcnt(0)
ds_read_b64_tr_b16 a[144:145], v46 offset:24576
ds_read_b64_tr_b16 a[146:147], v46 offset:24704
ds_read_b64_tr_b16 a[148:149], v46 offset:26624
ds_read_b64_tr_b16 a[150:151], v46 offset:26752
ds_read_b64_tr_b16 a[152:153], v46 offset:28672
ds_read_b64_tr_b16 a[154:155], v46 offset:28800
ds_read_b64_tr_b16 a[156:157], v46 offset:30720
ds_read_b64_tr_b16 a[158:159], v46 offset:30848
s_waitcnt lgkmcnt(0)
ds_read_b64_tr_b16 a[160:161], v46 offset:16416
ds_read_b64_tr_b16 a[162:163], v46 offset:16544
ds_read_b64_tr_b16 a[164:165], v46 offset:18464
ds_read_b64_tr_b16 a[166:167], v46 offset:18592
ds_read_b64_tr_b16 a[168:169], v46 offset:20512
ds_read_b64_tr_b16 a[170:171], v46 offset:20640
ds_read_b64_tr_b16 a[172:173], v46 offset:22560
ds_read_b64_tr_b16 a[174:175], v46 offset:22688
s_waitcnt lgkmcnt(0)
ds_read_b64_tr_b16 a[176:177], v46 offset:24608
ds_read_b64_tr_b16 a[178:179], v46 offset:24736
ds_read_b64_tr_b16 a[180:181], v46 offset:26656
ds_read_b64_tr_b16 a[182:183], v46 offset:26784
ds_read_b64_tr_b16 a[184:185], v46 offset:28704
ds_read_b64_tr_b16 a[186:187], v46 offset:28832
ds_read_b64_tr_b16 a[188:189], v46 offset:30752
ds_read_b64_tr_b16 a[190:191], v46 offset:30880
s_waitcnt lgkmcnt(0)
buffer_load_dword v50, v52, s[16:19], 0 offen
s_xor_b32 s29, s76, 0
s_lshl_b32 s28, s29, 10
s_add_u32 s28, s28, s47
s_add_u32 m0, s28, 16384
s_lshl_b32 s29, s29, 15
buffer_load_dwordx4 v41, s[16:19], s29 offen lds
s_xor_b32 s29, s76, 1
s_lshl_b32 s28, s29, 10
s_add_u32 s28, s28, s47
s_add_u32 m0, s28, 16384
s_lshl_b32 s29, s29, 15
buffer_load_dwordx4 v41, s[16:19], s29 offen lds
s_xor_b32 s29, s76, 2
s_lshl_b32 s28, s29, 10
s_add_u32 s28, s28, s47
s_add_u32 m0, s28, 16384
s_lshl_b32 s29, s29, 15
buffer_load_dwordx4 v41, s[16:19], s29 offen lds
s_xor_b32 s29, s76, 3
s_lshl_b32 s28, s29, 10
s_add_u32 s28, s28, s47
s_add_u32 m0, s28, 16384
s_lshl_b32 s29, s29, 15
buffer_load_dwordx4 v41, s[16:19], s29 offen lds
s_xor_b32 s29, s76, 4
s_lshl_b32 s28, s29, 10
s_add_u32 s28, s28, s47
s_add_u32 m0, s28, 16384
s_lshl_b32 s29, s29, 15
buffer_load_dwordx4 v41, s[16:19], s29 offen lds
s_xor_b32 s29, s76, 5
s_lshl_b32 s28, s29, 10
s_add_u32 s28, s28, s47
s_add_u32 m0, s28, 16384
s_lshl_b32 s29, s29, 15
buffer_load_dwordx4 v41, s[16:19], s29 offen lds
s_xor_b32 s29, s76, 6
s_lshl_b32 s28, s29, 10
s_add_u32 s28, s28, s47
s_add_u32 m0, s28, 16384
s_lshl_b32 s29, s29, 15
buffer_load_dwordx4 v41, s[16:19], s29 offen lds
s_xor_b32 s29, s76, 7
s_lshl_b32 s28, s29, 10
s_add_u32 s28, s28, s47
s_add_u32 m0, s28, 16384
s_lshl_b32 s29, s29, 15
buffer_load_dwordx4 v41, s[16:19], s29 offen lds
s_xor_b32 s29, s76, 8
s_lshl_b32 s28, s29, 10
s_add_u32 s28, s28, s47
s_add_u32 m0, s28, 16384
s_lshl_b32 s29, s29, 15
buffer_load_dwordx4 v41, s[16:19], s29 offen lds
s_xor_b32 s29, s76, 9
s_lshl_b32 s28, s29, 10
s_add_u32 s28, s28, s47
s_add_u32 m0, s28, 16384
s_lshl_b32 s29, s29, 15
buffer_load_dwordx4 v41, s[16:19], s29 offen lds
s_xor_b32 s29, s76, 10
s_lshl_b32 s28, s29, 10
s_add_u32 s28, s28, s47
s_add_u32 m0, s28, 16384
s_lshl_b32 s29, s29, 15
buffer_load_dwordx4 v41, s[16:19], s29 offen lds
s_xor_b32 s29, s76, 11
s_lshl_b32 s28, s29, 10
s_add_u32 s28, s28, s47
s_add_u32 m0, s28, 16384
s_lshl_b32 s29, s29, 15
buffer_load_dwordx4 v41, s[16:19], s29 offen lds
s_xor_b32 s29, s76, 12
s_lshl_b32 s28, s29, 10
s_add_u32 s28, s28, s47
s_add_u32 m0, s28, 16384
s_lshl_b32 s29, s29, 15
buffer_load_dwordx4 v41, s[16:19], s29 offen lds
s_xor_b32 s29, s76, 13
s_lshl_b32 s28, s29, 10
s_add_u32 s28, s28, s47
s_add_u32 m0, s28, 16384
s_lshl_b32 s29, s29, 15
buffer_load_dwordx4 v41, s[16:19], s29 offen lds
s_xor_b32 s29, s76, 14
s_lshl_b32 s28, s29, 10
s_add_u32 s28, s28, s47
s_add_u32 m0, s28, 16384
s_lshl_b32 s29, s29, 15
buffer_load_dwordx4 v41, s[16:19], s29 offen lds
s_xor_b32 s29, s76, 15
s_lshl_b32 s28, s29, 10
s_add_u32 s28, s28, s47
s_add_u32 m0, s28, 16384
s_lshl_b32 s29, s29, 15
buffer_load_dwordx4 v41, s[16:19], s29 offen lds
s_waitcnt vmcnt(17)
ds_read_b64_tr_b16 a[0:1], v46 offset:0
ds_read_b64_tr_b16 a[2:3], v46 offset:128
ds_read_b64_tr_b16 a[4:5], v46 offset:2048
ds_read_b64_tr_b16 a[6:7], v46 offset:2176
ds_read_b64_tr_b16 a[8:9], v46 offset:4096
ds_read_b64_tr_b16 a[10:11], v46 offset:4224
ds_read_b64_tr_b16 a[12:13], v46 offset:6144
ds_read_b64_tr_b16 a[14:15], v46 offset:6272
s_waitcnt lgkmcnt(0)
ds_read_b64_tr_b16 a[16:17], v46 offset:8192
ds_read_b64_tr_b16 a[18:19], v46 offset:8320
ds_read_b64_tr_b16 a[20:21], v46 offset:10240
ds_read_b64_tr_b16 a[22:23], v46 offset:10368
ds_read_b64_tr_b16 a[24:25], v46 offset:12288
ds_read_b64_tr_b16 a[26:27], v46 offset:12416
ds_read_b64_tr_b16 a[28:29], v46 offset:14336
ds_read_b64_tr_b16 a[30:31], v46 offset:14464
s_waitcnt lgkmcnt(0)
ds_read_b64_tr_b16 a[32:33], v46 offset:32
ds_read_b64_tr_b16 a[34:35], v46 offset:160
ds_read_b64_tr_b16 a[36:37], v46 offset:2080
ds_read_b64_tr_b16 a[38:39], v46 offset:2208
ds_read_b64_tr_b16 a[40:41], v46 offset:4128
ds_read_b64_tr_b16 a[42:43], v46 offset:4256
ds_read_b64_tr_b16 a[44:45], v46 offset:6176
ds_read_b64_tr_b16 a[46:47], v46 offset:6304
s_waitcnt lgkmcnt(0)
ds_read_b64_tr_b16 a[48:49], v46 offset:8224
ds_read_b64_tr_b16 a[50:51], v46 offset:8352
ds_read_b64_tr_b16 a[52:53], v46 offset:10272
ds_read_b64_tr_b16 a[54:55], v46 offset:10400
ds_read_b64_tr_b16 a[56:57], v46 offset:12320
ds_read_b64_tr_b16 a[58:59], v46 offset:12448
ds_read_b64_tr_b16 a[60:61], v46 offset:14368
ds_read_b64_tr_b16 a[62:63], v46 offset:14496
s_waitcnt lgkmcnt(0)
s_waitcnt vmcnt(0)
ds_read_b64_tr_b16 a[192:193], v47 offset:16384
ds_read_b64_tr_b16 a[194:195], v47 offset:16512
ds_read_b64_tr_b16 a[196:197], v47 offset:18432
ds_read_b64_tr_b16 a[198:199], v47 offset:18560
ds_read_b64_tr_b16 a[200:201], v47 offset:20480
ds_read_b64_tr_b16 a[202:203], v47 offset:20608
ds_read_b64_tr_b16 a[204:205], v47 offset:22528
ds_read_b64_tr_b16 a[206:207], v47 offset:22656
s_waitcnt lgkmcnt(0)
ds_read_b64_tr_b16 a[208:209], v47 offset:24576
ds_read_b64_tr_b16 a[210:211], v47 offset:24704
ds_read_b64_tr_b16 a[212:213], v47 offset:26624
ds_read_b64_tr_b16 a[214:215], v47 offset:26752
ds_read_b64_tr_b16 a[216:217], v47 offset:28672
ds_read_b64_tr_b16 a[218:219], v47 offset:28800
ds_read_b64_tr_b16 a[220:221], v47 offset:30720
ds_read_b64_tr_b16 a[222:223], v47 offset:30848
s_waitcnt lgkmcnt(0)
ds_read_b64_tr_b16 a[224:225], v47 offset:16416
ds_read_b64_tr_b16 a[226:227], v47 offset:16544
ds_read_b64_tr_b16 a[228:229], v47 offset:18464
ds_read_b64_tr_b16 a[230:231], v47 offset:18592
ds_read_b64_tr_b16 a[232:233], v47 offset:20512
ds_read_b64_tr_b16 a[234:235], v47 offset:20640
ds_read_b64_tr_b16 a[236:237], v47 offset:22560
ds_read_b64_tr_b16 a[238:239], v47 offset:22688
s_waitcnt lgkmcnt(0)
ds_read_b64_tr_b16 a[240:241], v47 offset:24608
ds_read_b64_tr_b16 a[242:243], v47 offset:24736
ds_read_b64_tr_b16 a[244:245], v47 offset:26656
ds_read_b64_tr_b16 a[246:247], v47 offset:26784
ds_read_b64_tr_b16 a[248:249], v47 offset:28704
ds_read_b64_tr_b16 a[250:251], v47 offset:28832
ds_read_b64_tr_b16 a[252:253], v47 offset:30752
ds_read_b64_tr_b16 a[254:255], v47 offset:30880
s_waitcnt lgkmcnt(0)
v_and_b32 v5, 15, v0
v_lshlrev_b32 v5, 4, v5
s_branch mega_kernel_sys
mega_kernel_sysw:
s_sleep 4
mega_kernel_sys:
buffer_load_dword v4, v5, s[72:75], 0 offen sc1
s_waitcnt vmcnt(0)
s_cmp_eq_u32 s95, 1
s_cbranch_scc0 mega_kernel_sysf
v_readlane_b32 s76, v4, 14
s_mov_b32 s98, 0
s_cmp_eq_u32 s76, 64
s_cbranch_scc0 mega_kernel_sysw
s_branch mega_kernel_sysd
mega_kernel_sysf:
s_mov_b32 s77, 0
s_mov_b32 s78, 0
v_readlane_b32 s76, v4, 0
s_add_u32 s77, s77, s76
s_xor_b32 s76, s76, 32
s_or_b32 s78, s78, s76
v_readlane_b32 s76, v4, 1
s_add_u32 s77, s77, s76
s_xor_b32 s76, s76, 32
s_or_b32 s78, s78, s76
v_readlane_b32 s76, v4, 2
s_add_u32 s77, s77, s76
s_xor_b32 s76, s76, 32
s_or_b32 s78, s78, s76
v_readlane_b32 s76, v4, 3
s_add_u32 s77, s77, s76
s_xor_b32 s76, s76, 32
s_or_b32 s78, s78, s76
v_readlane_b32 s76, v4, 4
s_add_u32 s77, s77, s76
s_xor_b32 s76, s76, 32
s_or_b32 s78, s78, s76
v_readlane_b32 s76, v4, 5
s_add_u32 s77, s77, s76
s_xor_b32 s76, s76, 32
s_or_b32 s78, s78, s76
v_readlane_b32 s76, v4, 6
s_add_u32 s77, s77, s76
s_xor_b32 s76, s76, 32
s_or_b32 s78, s78, s76
v_readlane_b32 s76, v4, 7
s_add_u32 s77, s77, s76
s_xor_b32 s76, s76, 32
s_or_b32 s78, s78, s76
s_cmp_eq_u32 s77, 256
s_cbranch_scc0 mega_kernel_sysw
v_mov_b32 v252, v4
s_cmp_eq_u32 s78, 0
s_cbranch_scc0 mega_kernel_slowent
v_readlane_b32 s76, v4, 10
v_readlane_b32 s77, v4, 8
s_cmp_eq_u32 s76, 64
s_cbranch_scc0 mega_kernel_sysw
s_cmp_gt_u32 s77, 32
s_cselect_b32 s98, 1, 0
mega_kernel_sysd:
s_lshr_b32 s28, s31, 3
s_lshl_b32 s28, s28, 14
s_lshl_b32 s29, s98, 13
s_add_u32 s28, s28, s29
s_and_b32 s29, s31, 7
s_lshl_b32 s29, s29, 10
s_add_u32 s28, s28, s29
s_lshl_b32 s29, s30, 16
s_add_u32 s28, s28, s29
s_add_u32 s28, s28, 67108864
v_add_u32 v12, s28, v17
v_xor_b32 v25, 0x10000, v12
v_xor_b32 v26, 0x20000, v12
v_xor_b32 v27, 0x30000, v12
v_add_u32 v25, 0, v25
v_add_u32 v26, 0, v26
v_add_u32 v27, 0, v27
s_lshl_b32 s28, s25, 2
s_add_u32 s28, s28, s26
s_mov_b32 s82, s28
s_lshr_b32 s29, s28, 3
s_xor_b32 s29, s29, s98
s_and_b32 s29, s29, 1
s_lshl_b32 s29, s29, 13
s_lshl_b32 s76, s28, 18
s_add_u32 s76, s76, s29
s_mov_b32 s83, s76
v_add_u32 v240, s76, v17
v_add_u32 v241, 33554432, v240
s_lshr_b32 s29, s28, 4
s_xor_b32 s29, s29, s98
s_and_b32 s29, s29, 1
s_lshl_b32 s29, s29, 13
s_lshl_b32 s79, s28, 17
s_add_u32 s79, s79, s29
s_add_u32 s79, s79, 71303168
s_xor_b32 s29, s98, 1
s_lshl_b32 s29, s29, 13
s_lshl_b32 s28, s25, 7
s_add_u32 s28, s28, s29
s_add_u32 s28, s28, 69206016
v_and_b32 v4, 1, v1
v_lshlrev_b32 v24, 12, v4
v_add_u32 v24, s28, v24
s_lshl_b32 s29, s26, 2
v_add_u32 v24, s29, v24
s_xor_b32 s81, s98, 1
s_lshl_b32 s81, s81, 13
s_lshr_b32 s29, s82, 6
s_lshl_b32 s29, s29, 14
s_add_u32 s81, s81, s29
s_and_b32 s29, s82, 63
s_lshl_b32 s29, s29, 7
s_add_u32 s81, s81, s29
s_add_u32 s81, s81, 69222400
v_mov_b32 v220, 0x3f803f80
v_mov_b32 v221, 0x3f803f80
v_mov_b32 v222, 0x3f803f80
v_mov_b32 v223, 0x3f803f80
v_mov_b32 v228, 0
s_mov_b32 s27, 0
s_mov_b32 s46, 0
s_mov_b32 s89, 0
s_mov_b32 s88, 0
s_mov_b32 s44, 18432
s_mov_b32 s45, 18432
s_cmp_eq_u32 s24, 3
s_cbranch_scc0 mega_kernel_rs_pfi
s_mov_b32 s76, 0
s_cmp_gt_i32 s46, s76
s_cbranch_scc1 mega_kernel_rs_pf0ok
mega_kernel_rs_pf0w:
buffer_load_dword v4, v24, s[84:87], 0 offen sc1
s_waitcnt vmcnt(0)
v_readlane_b32 s46, v4, 0
v_readlane_b32 s28, v4, 1
s_nop 1
s_min_i32 s46, s46, s28
s_cmp_gt_i32 s46, s76
s_cbranch_scc0 mega_kernel_rs_pf0w
mega_kernel_rs_pf0ok:
s_add_u32 s77, s76, s82
s_bfe_u32 s28, s77, 0x40002
s_lshl_b32 s28, s28, 14
s_and_b32 s77, s77, 3
s_lshl_b32 s77, s77, 11
s_add_u32 s28, s28, s77
s_add_u32 m0, s45, 0
s_nop 0
buffer_load_dwordx4 v240, s[84:87], s28 offen offset:0 sc1 lds
s_add_u32 m0, s45, 0
s_nop 0
buffer_load_dwordx4 v240, s[84:87], s28 offen offset:1024 sc1 lds
s_add_u32 m0, s45, 2048
s_nop 0
buffer_load_dwordx4 v241, s[84:87], s28 offen offset:0 sc1 lds
s_add_u32 m0, s45, 2048
s_nop 0
buffer_load_dwordx4 v241, s[84:87], s28 offen offset:1024 sc1 lds
s_add_u32 s45, s45, 4096
s_cmp_eq_u32 s45, 30720
s_cselect_b32 s45, 18432, s45
s_waitcnt vmcnt(0) lgkmcnt(0)
mega_kernel_rs_pfi:
v_mov_b32 v96, 0
v_mov_b32 v97, 0
v_mov_b32 v98, 0
v_mov_b32 v99, 0
v_mov_b32 v100, 0
v_mov_b32 v101, 0
v_mov_b32 v102, 0
v_mov_b32 v103, 0
v_mov_b32 v104, 0
v_mov_b32 v105, 0
v_mov_b32 v106, 0
v_mov_b32 v107, 0
v_mov_b32 v108, 0
v_mov_b32 v109, 0
v_mov_b32 v110, 0
v_mov_b32 v111, 0
v_mov_b32 v112, 0
v_mov_b32 v113, 0
v_mov_b32 v114, 0
v_mov_b32 v115, 0
v_mov_b32 v116, 0
v_mov_b32 v117, 0
v_mov_b32 v118, 0
v_mov_b32 v119, 0
s_barrier
s_and_b32 s29, s27, 1
s_lshl_b32 s33, s29, 17
s_lshl_b32 s28, s30, 18
s_add_u32 s33, s33, s28
s_add_u32 s33, s33, 68157440
s_xor_b32 s34, s33, 131072
s_lshl_b32 s35, s29, 18
s_bfe_u32 s47, s27, 0x10001
s_branch mega_kernel_rs_first
mega_kernel_rs_loop:
buffer_load_dwordx4 v[32:35], v7, s[84:87], s33 offen offset:0 sc1
v_add_u32 v5, s44, v17
ds_read_b128 v[156:159], v5 offset:0
ds_read_b128 v[160:163], v5 offset:1024
ds_read_b128 v[164:167], v5 offset:2048
ds_read_b128 v[168:171], v5 offset:3072
s_nop 4
buffer_load_dwordx4 v[36:39], v7, s[84:87], s33 offen offset:1024 sc1
s_nop 9
buffer_load_dwordx4 v[40:43], v7, s[84:87], s33 offen offset:2048 sc1
s_nop 9
buffer_load_dwordx4 v[44:47], v7, s[84:87], s33 offen offset:3072 sc1
s_waitcnt vmcnt(3)
v_max_u32 v4, v32, v34
v_cmp_eq_u32 vcc, -1, v4
s_cbranch_vccnz mega_kernel_rs_pa_15_0f
v_smfmac_f32_16x16x64_bf16 v[96:99], v[32:35], a[0:7], v6
v_smfmac_f32_16x16x64_bf16 v[100:103], v[32:35], a[32:39], v6
v_smfmac_f32_16x16x64_bf16 v[104:107], v[32:35], a[64:71], v6
s_waitcnt vmcnt(2)
v_max_u32 v4, v36, v38
v_cmp_eq_u32 vcc, -1, v4
v_smfmac_f32_16x16x64_bf16 v[108:111], v[32:35], a[96:103], v6
s_cbranch_vccnz mega_kernel_rs_pa_14_1f
v_smfmac_f32_16x16x64_bf16 v[96:99], v[36:39], a[8:15], v6
v_smfmac_f32_16x16x64_bf16 v[100:103], v[36:39], a[40:47], v6
v_smfmac_f32_16x16x64_bf16 v[104:107], v[36:39], a[72:79], v6
s_waitcnt vmcnt(1)
v_max_u32 v4, v40, v42
v_cmp_eq_u32 vcc, -1, v4
v_smfmac_f32_16x16x64_bf16 v[108:111], v[36:39], a[104:111], v6
s_cbranch_vccnz mega_kernel_rs_pa_12_2f
v_smfmac_f32_16x16x64_bf16 v[96:99], v[40:43], a[16:23], v6
v_smfmac_f32_16x16x64_bf16 v[100:103], v[40:43], a[48:55], v6
v_smfmac_f32_16x16x64_bf16 v[104:107], v[40:43], a[80:87], v6
s_waitcnt vmcnt(0)
v_max_u32 v4, v44, v46
v_cmp_eq_u32 vcc, -1, v4
v_smfmac_f32_16x16x64_bf16 v[108:111], v[40:43], a[112:119], v6
s_cbranch_vccnz mega_kernel_rs_pa_8_3f
v_smfmac_f32_16x16x64_bf16 v[96:99], v[44:47], a[24:31], v6
v_smfmac_f32_16x16x64_bf16 v[100:103], v[44:47], a[56:63], v6
v_smfmac_f32_16x16x64_bf16 v[104:107], v[44:47], a[88:95], v6
v_smfmac_f32_16x16x64_bf16 v[108:111], v[44:47], a[120:127], v6
mega_kernel_rs_pa_d:
mega_kernel_rs_adone:
s_nop 5
v_permlane32_swap_b32 v96, v100
v_permlane32_swap_b32 v97, v101
v_permlane32_swap_b32 v98, v102
v_permlane32_swap_b32 v99, v103
v_pk_add_f32 v[96:97], v[96:97], v[100:101]
v_pk_add_f32 v[98:99], v[98:99], v[102:103]
ds_write2_b32 v14, v96, v97 offset0:0 offset1:36
ds_write2_b32 v14, v98, v99 offset0:72 offset1:108
v_permlane32_swap_b32 v104, v108
v_permlane32_swap_b32 v105, v109
v_permlane32_swap_b32 v106, v110
v_permlane32_swap_b32 v107, v111
v_pk_add_f32 v[104:105], v[104:105], v[108:109]
v_pk_add_f32 v[106:107], v[106:107], v[110:111]
ds_write2_b32 v15, v104, v105 offset0:0 offset1:36
ds_write2_b32 v15, v106, v107 offset0:72 offset1:108
v_smfmac_f32_16x16x64_bf16 v[112:115], v[32:35], a[128:135], v6
v_smfmac_f32_16x16x64_bf16 v[116:119], v[32:35], a[160:167], v6
v_smfmac_f32_16x16x64_bf16 v[112:115], v[36:39], a[136:143], v6
v_smfmac_f32_16x16x64_bf16 v[116:119], v[36:39], a[168:175], v6
s_waitcnt lgkmcnt(0)
s_barrier
s_cmp_lg_u32 s24, 0
s_cbranch_scc1 mega_kernel_rs_side
ds_read_b128 v[120:123], v16 offset:0
ds_read_b128 v[124:127], v16 offset:16
ds_read_b128 v[128:131], v16 offset:2304
ds_read_b128 v[132:135], v16 offset:2320
ds_read_b128 v[136:139], v16 offset:4608
ds_read_b128 v[140:143], v16 offset:4624
ds_read_b128 v[144:147], v16 offset:6912
ds_read_b128 v[148:151], v16 offset:6928
v_smfmac_f32_16x16x64_bf16 v[112:115], v[40:43], a[144:151], v6
v_smfmac_f32_16x16x64_bf16 v[116:119], v[40:43], a[176:183], v6
v_smfmac_f32_16x16x64_bf16 v[112:115], v[44:47], a[152:159], v6
v_smfmac_f32_16x16x64_bf16 v[116:119], v[44:47], a[184:191], v6
s_mul_i32 s28, s31, 2048
s_add_u32 s28, s28, s33
s_add_u32 s28, s28, 49152
s_add_u32 s76, s37, s33
s_add_u32 s77, s38, s33
s_add_u32 s78, s39, s33
s_waitcnt lgkmcnt(4)
v_pk_add_f32 v[120:121], v[120:121], v[128:129]
v_pk_add_f32 v[122:123], v[122:123], v[130:131]
v_pk_add_f32 v[124:125], v[124:125], v[132:133]
v_pk_add_f32 v[126:127], v[126:127], v[134:135]
s_waitcnt lgkmcnt(0)
v_pk_add_f32 v[136:137], v[136:137], v[144:145]
v_pk_add_f32 v[138:139], v[138:139], v[146:147]
v_pk_add_f32 v[140:141], v[140:141], v[148:149]
v_pk_add_f32 v[142:143], v[142:143], v[150:151]
v_pk_add_f32 v[120:121], v[120:121], v[136:137]
v_pk_add_f32 v[122:123], v[122:123], v[138:139]
v_pk_add_f32 v[124:125], v[124:125], v[140:141]
v_pk_add_f32 v[126:127], v[126:127], v[142:143]
v_cvt_pk_bf16_f32 v152, v120, v121
v_cvt_pk_bf16_f32 v153, v122, v123
v_cvt_pk_bf16_f32 v154, v124, v125
v_cvt_pk_bf16_f32 v155, v126, v127
s_nop 1
v_mfma_f32_16x16x32_bf16 v[176:179], v[160:163], v[152:155], 0
v_mfma_f32_16x16x32_bf16 v[172:175], v[156:159], v[152:155], 0
v_mfma_f32_16x16x32_bf16 v[180:183], v[152:155], v[152:155], 0
s_cmp_eq_u32 s27, 63
s_cbranch_scc1 mega_kernel_rs_w0last
s_nop 4
v_mov_b32_dpp v172, v176 row_shr:8 row_mask:0xf bank_mask:0xc
v_mov_b32_dpp v173, v177 row_shr:8 row_mask:0xf bank_mask:0xc
v_mov_b32_dpp v174, v178 row_shr:8 row_mask:0xf bank_mask:0xc
v_mov_b32_dpp v175, v179 row_shr:8 row_mask:0xf bank_mask:0xc
v_min_u32 v180, -2, v180
v_min_u32 v172, -2, v172
s_mov_b64 exec, s[42:43]
buffer_store_dwordx4 v[180:183], v10, s[84:87], s28 offen sc1
s_mov_b64 exec, -1
buffer_store_dwordx4 v[172:175], v17, s[84:87], s28 offen sc1
v_permlane32_swap_b32 v112, v116
v_permlane32_swap_b32 v113, v117
v_permlane32_swap_b32 v114, v118
v_permlane32_swap_b32 v115, v119
v_pk_add_f32 v[112:113], v[112:113], v[116:117]
v_pk_add_f32 v[114:115], v[114:115], v[118:119]
ds_write_b128 v20, v[112:115]
s_waitcnt lgkmcnt(0)
s_barrier
v_mov_b32 v96, 0
v_mov_b32 v97, 0
v_mov_b32 v98, 0
v_mov_b32 v99, 0
v_mov_b32 v100, 0
v_mov_b32 v101, 0
v_mov_b32 v102, 0
v_mov_b32 v103, 0
v_cndmask_b32 v176, v23, v180, s[42:43]
v_cndmask_b32 v177, v23, v181, s[42:43]
v_cndmask_b32 v178, v23, v182, s[42:43]
v_cndmask_b32 v179, v23, v183, s[42:43]
buffer_load_dwordx4 v[184:187], v17, s[84:87], s76 offen sc1
buffer_load_dwordx4 v[188:191], v10, s[84:87], s76 offen sc1
buffer_load_dwordx4 v[192:195], v17, s[84:87], s77 offen sc1
buffer_load_dwordx4 v[196:199], v10, s[84:87], s77 offen sc1
buffer_load_dwordx4 v[200:203], v17, s[84:87], s78 offen sc1
buffer_load_dwordx4 v[204:207], v10, s[84:87], s78 offen sc1
s_nop 15
s_nop 7
buffer_load_dwordx4 v[184:187], v17, s[84:87], s76 offen sc1
buffer_load_dwordx4 v[188:191], v10, s[84:87], s76 offen sc1
buffer_load_dwordx4 v[192:195], v17, s[84:87], s77 offen sc1
buffer_load_dwordx4 v[196:199], v10, s[84:87], s77 offen sc1
buffer_load_dwordx4 v[200:203], v17, s[84:87], s78 offen sc1
buffer_load_dwordx4 v[204:207], v10, s[84:87], s78 offen sc1
mega_kernel_rs_p2:
s_waitcnt vmcnt(6)
v_max3_u32 v4, v184, v188, v192
v_max3_u32 v5, v196, v200, v204
v_max_u32 v4, v4, v5
v_cmp_eq_u32 vcc, -1, v4
s_cbranch_vccnz mega_kernel_rs_p2r
v_pk_add_f32 v[176:177], v[176:177], v[188:189]
v_pk_add_f32 v[124:125], v[196:197], v[204:205]
v_pk_add_f32 v[178:179], v[178:179], v[190:191]
v_pk_add_f32 v[126:127], v[198:199], v[206:207]
v_pk_add_f32 v[172:173], v[172:173], v[184:185]
v_pk_add_f32 v[120:121], v[192:193], v[200:201]
v_pk_add_f32 v[174:175], v[174:175], v[186:187]
v_pk_add_f32 v[122:123], v[194:195], v[202:203]
v_pk_add_f32 v[176:177], v[176:177], v[124:125]
v_pk_add_f32 v[178:179], v[178:179], v[126:127]
v_pk_add_f32 v[172:173], v[172:173], v[120:121]
v_pk_add_f32 v[174:175], v[174:175], v[122:123]
v_max3_f32 v232, v172, v173, v174
v_max3_f32 v233, v176, v177, v178
v_max3_f32 v232, v232, v175, v179
v_max_f32 v234, v232, v233
s_barrier
ds_read2_b64 v[208:211], v21 offset0:0 offset1:32
v_max_f32_dpp v232, v234, v234 row_ror:8 row_mask:0xf bank_mask:0xf
v_max_f32_dpp v233, v234, v234 row_ror:8 row_mask:0xf bank_mask:0xf
s_nop 1
v_permlane16_swap_b32 v232, v233
s_nop 0
v_max_f32 v234, v232, v233
v_max_f32 v235, v232, v233
s_nop 1
v_permlane32_swap_b32 v234, v235
s_nop 0
v_max_f32 v232, v234, v235
v_mul_f32 v232, s32, v232
v_pk_fma_f32 v[176:177], v[176:177], s[32:33], v[232:233] op_sel_hi:[1,0,0] neg_lo:[0,0,1] neg_hi:[0,0,1]
v_pk_fma_f32 v[178:179], v[178:179], s[32:33], v[232:233] op_sel_hi:[1,0,0] neg_lo:[0,0,1] neg_hi:[0,0,1]
v_pk_fma_f32 v[172:173], v[172:173], s[32:33], v[232:233] op_sel_hi:[1,0,0] neg_lo:[0,0,1] neg_hi:[0,0,1]
v_pk_fma_f32 v[174:175], v[174:175], s[32:33], v[232:233] op_sel_hi:[1,0,0] neg_lo:[0,0,1] neg_hi:[0,0,1]
v_exp_f32 v176, v176
v_exp_f32 v177, v177
v_exp_f32 v178, v178
v_exp_f32 v179, v179
v_exp_f32 v172, v172
v_cvt_pk_bf16_f32 v216, v176, v177
v_cvt_pk_bf16_f32 v217, v178, v179
v_exp_f32 v173, v173
v_exp_f32 v174, v174
v_mfma_f32_16x16x16_bf16 v[224:227], v[220:221], v[216:217], 0
v_exp_f32 v175, v175
v_cvt_pk_bf16_f32 v212, v172, v173
s_waitcnt lgkmcnt(0)
v_mfma_f32_16x16x16_bf16 v[120:123], v[208:209], v[216:217], 0
v_cvt_pk_bf16_f32 v213, v174, v175
v_mfma_f32_16x16x16_bf16 v[124:127], v[210:211], v[216:217], 0
v_mov_b32_dpp v214, v212 row_ror:8 row_mask:0xf bank_mask:0xf
v_mov_b32_dpp v215, v213 row_ror:8 row_mask:0xf bank_mask:0xf
s_nop 1
v_mfma_f32_16x16x32_bf16 v[224:227], v[220:223], v[212:215], v[224:227]
v_mfma_f32_16x16x32_bf16 v[120:123], v[164:167], v[212:215], v[120:123]
v_mfma_f32_16x16x32_bf16 v[124:127], v[168:171], v[212:215], v[124:127]
s_add_u32 s29, s33, 24576
s_nop 4
v_rcp_f32 v234, v224
s_nop 0
v_pk_mul_f32 v[120:121], v[120:121], v[234:235] op_sel_hi:[1,0]
v_pk_mul_f32 v[122:123], v[122:123], v[234:235] op_sel_hi:[1,0]
v_pk_mul_f32 v[124:125], v[124:125], v[234:235] op_sel_hi:[1,0]
v_pk_mul_f32 v[126:127], v[126:127], v[234:235] op_sel_hi:[1,0]
v_cvt_pk_bf16_f32 v212, v120, v121
v_cvt_pk_bf16_f32 v213, v122, v123
v_cvt_pk_bf16_f32 v214, v124, v125
v_cvt_pk_bf16_f32 v215, v126, v127
v_min_u32 v212, -2, v212
s_mov_b64 exec, s[40:41]
buffer_store_dwordx4 v[212:215], v11, s[84:87], s33 offen sc1
s_mov_b64 exec, -1
mega_kernel_rs_b3:
s_barrier
s_nop 15
s_nop 7
buffer_load_dwordx4 v[32:35], v7, s[84:87], s29 offen offset:0 sc1
s_nop 9
buffer_load_dwordx4 v[36:39], v7, s[84:87], s29 offen offset:1024 sc1
s_nop 9
buffer_load_dwordx4 v[40:43], v7, s[84:87], s29 offen offset:2048 sc1
s_nop 9
buffer_load_dwordx4 v[44:47], v7, s[84:87], s29 offen offset:3072 sc1
mega_kernel_rs_pc_15_0:
s_waitcnt vmcnt(3)
v_cmp_eq_u32 vcc, -1, v32
s_cbranch_vccnz mega_kernel_rs_pc_15_0f
v_smfmac_f32_16x16x64_bf16 v[96:99], v[32:35], a[192:199], v6
v_smfmac_f32_16x16x64_bf16 v[100:103], v[32:35], a[224:231], v6
mega_kernel_rs_pc_14_1:
s_waitcnt vmcnt(2)
v_cmp_eq_u32 vcc, -1, v36
s_cbranch_vccnz mega_kernel_rs_pc_14_1f
v_smfmac_f32_16x16x64_bf16 v[96:99], v[36:39], a[200:207], v6
v_smfmac_f32_16x16x64_bf16 v[100:103], v[36:39], a[232:239], v6
mega_kernel_rs_pc_12_2:
s_waitcnt vmcnt(1)
v_cmp_eq_u32 vcc, -1, v40
s_cbranch_vccnz mega_kernel_rs_pc_12_2f
v_smfmac_f32_16x16x64_bf16 v[96:99], v[40:43], a[208:215], v6
v_smfmac_f32_16x16x64_bf16 v[100:103], v[40:43], a[240:247], v6
mega_kernel_rs_pc_8_3:
s_waitcnt vmcnt(0)
v_cmp_eq_u32 vcc, -1, v44
s_cbranch_vccnz mega_kernel_rs_pc_8_3f
v_smfmac_f32_16x16x64_bf16 v[96:99], v[44:47], a[216:223], v6
v_smfmac_f32_16x16x64_bf16 v[100:103], v[44:47], a[248:255], v6
mega_kernel_rs_pc_d:
s_nop 7
v_permlane32_swap_b32 v96, v100
v_permlane32_swap_b32 v97, v101
v_permlane32_swap_b32 v98, v102
v_permlane32_swap_b32 v99, v103
v_pk_add_f32 v[96:97], v[96:97], v[100:101]
v_pk_add_f32 v[98:99], v[98:99], v[102:103]
ds_write2_b32 v18, v96, v97 offset0:0 offset1:36
ds_write2_b32 v18, v98, v99 offset0:72 offset1:108
s_waitcnt lgkmcnt(0)
s_barrier
s_cmp_lg_u32 s24, 0
s_cbranch_scc1 mega_kernel_rs_x1
ds_read_b128 v[120:123], v19 offset:0
ds_read_b128 v[124:127], v19 offset:1152
ds_read_b128 v[128:131], v19 offset:2304
ds_read_b128 v[132:135], v19 offset:3456
s_waitcnt lgkmcnt(2)
v_pk_add_f32 v[120:121], v[120:121], v[124:125]
v_pk_add_f32 v[122:123], v[122:123], v[126:127]
s_waitcnt lgkmcnt(0)
v_pk_add_f32 v[128:129], v[128:129], v[132:133]
v_pk_add_f32 v[130:131], v[130:131], v[134:135]
v_pk_add_f32 v[120:121], v[120:121], v[128:129]
v_pk_add_f32 v[122:123], v[122:123], v[130:131]
v_and_or_b32 v120, v120, -2, s47
v_and_or_b32 v121, v121, -2, s47
v_and_or_b32 v122, v122, -2, s47
v_and_or_b32 v123, v123, -2, s47
buffer_store_dwordx4 v[120:123], v12, s[84:87], s35 offen sc1
s_xor_b32 s76, s47, 1
v_mov_b32 v48, s76
v_mov_b32 v49, s76
v_mov_b32 v50, s76
v_mov_b32 v51, s76
v_mov_b32 v52, s76
v_mov_b32 v53, s76
v_mov_b32 v54, s76
v_mov_b32 v55, s76
v_mov_b32 v56, s76
v_mov_b32 v57, s76
v_mov_b32 v58, s76
v_mov_b32 v59, s76
v_mov_b32 v96, 0
v_mov_b32 v97, 0
v_mov_b32 v98, 0
v_mov_b32 v99, 0
v_mov_b32 v100, 0
v_mov_b32 v101, 0
v_mov_b32 v102, 0
v_mov_b32 v103, 0
v_mov_b32 v104, 0
v_mov_b32 v105, 0
v_mov_b32 v106, 0
v_mov_b32 v107, 0
v_mov_b32 v108, 0
v_mov_b32 v109, 0
v_mov_b32 v110, 0
v_mov_b32 v111, 0
v_mov_b32 v112, 0
v_mov_b32 v113, 0
v_mov_b32 v114, 0
v_mov_b32 v115, 0
v_mov_b32 v116, 0
v_mov_b32 v117, 0
v_mov_b32 v118, 0
v_mov_b32 v119, 0
s_nop 15
s_cmp_eq_u32 s47, 1
s_cbranch_scc1 mega_kernel_rs_p4_1
mega_kernel_rs_p4_0:
buffer_load_dwordx4 v[48:51], v25, s[84:87], s35 offen sc1
buffer_load_dwordx4 v[52:55], v26, s[84:87], s35 offen sc1
buffer_load_dwordx4 v[56:59], v27, s[84:87], s35 offen sc1
s_waitcnt vmcnt(36)
v_bitop3_b32 v4, v48, v49, v50 bitop3:0xfe
v_bitop3_b32 v5, v54, v55, v56 bitop3:0xfe
v_bitop3_b32 v4, v4, v51, v52 bitop3:0xfe
v_bitop3_b32 v5, v5, v57, v58 bitop3:0xfe
v_bitop3_b32 v4, v4, v53, v59 bitop3:0xfe
v_bitop3_b32 v4, v4, v5, 1 bitop3:0xa8
v_cmp_ne_u32 vcc, 0, v4
s_cbranch_vccnz mega_kernel_rs_p4_0
s_branch mega_kernel_rs_p4d
mega_kernel_rs_p4_1:
buffer_load_dwordx4 v[48:51], v25, s[84:87], s35 offen sc1
buffer_load_dwordx4 v[52:55], v26, s[84:87], s35 offen sc1
buffer_load_dwordx4 v[56:59], v27, s[84:87], s35 offen sc1
s_waitcnt vmcnt(36)
v_bitop3_b32 v4, v48, v49, v50 bitop3:0x80
v_bitop3_b32 v5, v54, v55, v56 bitop3:0x80
v_bitop3_b32 v4, v4, v51, v52 bitop3:0x80
v_bitop3_b32 v5, v5, v57, v58 bitop3:0x80
v_bitop3_b32 v4, v4, v53, v59 bitop3:0x80
v_bitop3_b32 v4, v4, v5, 1 bitop3:0x80
v_cmp_ne_u32 vcc, 1, v4
s_cbranch_vccnz mega_kernel_rs_p4_1
mega_kernel_rs_p4d:
v_pk_add_f32 v[120:121], v[120:121], v[48:49]
v_pk_add_f32 v[124:125], v[52:53], v[56:57]
v_pk_add_f32 v[122:123], v[122:123], v[50:51]
v_pk_add_f32 v[126:127], v[54:55], v[58:59]
v_pk_add_f32 v[120:121], v[120:121], v[124:125]
v_pk_add_f32 v[122:123], v[122:123], v[126:127]
v_cvt_pk_bf16_f32 v212, v120, v121
v_cvt_pk_bf16_f32 v213, v122, v123
v_min_u32 v212, -2, v212
buffer_store_dwordx2 v[212:213], v9, s[84:87], s34 offen sc1
mega_kernel_rs_b5:
s_add_u32 s27, s27, 1
s_add_u32 s44, s44, 4096
s_cmp_eq_u32 s44, 30720
s_cselect_b32 s44, 18432, s44
s_mov_b32 s28, s33
s_mov_b32 s33, s34
s_mov_b32 s34, s28
s_xor_b32 s35, s35, 262144
s_bfe_u32 s47, s27, 0x10001
s_barrier
s_nop 15
s_nop 7
s_branch mega_kernel_rs_loop
mega_kernel_rs_x1:
s_cmp_eq_u32 s24, 1
s_cbranch_scc0 mega_kernel_rs_x2
s_add_u32 s76, s27, 1
v_mov_b32 v5, s76
s_mov_b64 exec, 1
buffer_store_dword v5, v228, s[84:87], s81 offen sc1
s_mov_b64 exec, -1
mega_kernel_rs_x2:
s_cmp_eq_u32 s24, 3
s_cbranch_scc0 mega_kernel_rs_x4
s_cmp_eq_u32 s36, 1
s_cbranch_scc0 mega_kernel_rs_x5
s_add_u32 s76, s27, 1
s_cmp_gt_i32 s46, s76
s_cbranch_scc1 mega_kernel_rs_pf1ok
mega_kernel_rs_pf1w:
buffer_load_dword v4, v24, s[84:87], 0 offen sc1
s_waitcnt vmcnt(0)
v_readlane_b32 s46, v4, 0
v_readlane_b32 s28, v4, 1
s_nop 1
s_min_i32 s46, s46, s28
s_cmp_gt_i32 s46, s76
s_cbranch_scc0 mega_kernel_rs_pf1w
mega_kernel_rs_pf1ok:
s_add_u32 s77, s76, s82
s_bfe_u32 s28, s77, 0x40002
s_lshl_b32 s28, s28, 14
s_and_b32 s77, s77, 3
s_lshl_b32 s77, s77, 11
s_add_u32 s28, s28, s77
s_add_u32 m0, s45, 0
s_nop 0
buffer_load_dwordx4 v240, s[84:87], s28 offen offset:0 sc1 lds
s_add_u32 m0, s45, 0
s_nop 0
buffer_load_dwordx4 v240, s[84:87], s28 offen offset:1024 sc1 lds
s_add_u32 m0, s45, 2048
s_nop 0
buffer_load_dwordx4 v241, s[84:87], s28 offen offset:0 sc1 lds
s_add_u32 m0, s45, 2048
s_nop 0
buffer_load_dwordx4 v241, s[84:87], s28 offen offset:1024 sc1 lds
s_add_u32 s45, s45, 4096
s_cmp_eq_u32 s45, 30720
s_cselect_b32 s45, 18432, s45
s_waitcnt vmcnt(0)
mega_kernel_rs_x5:
s_add_u32 s76, s27, 3
s_min_u32 s76, s76, 63
s_cmp_gt_i32 s46, s76
s_cbranch_scc1 mega_kernel_rs_pf2ok
mega_kernel_rs_pf2w:
buffer_load_dword v4, v24, s[84:87], 0 offen sc1
s_waitcnt vmcnt(0)
v_readlane_b32 s46, v4, 0
v_readlane_b32 s28, v4, 1
s_nop 1
s_min_i32 s46, s46, s28
s_cmp_gt_i32 s46, s76
s_cbranch_scc0 mega_kernel_rs_x6
mega_kernel_rs_pf2ok:
mega_kernel_rs_x6:
s_add_u32 s76, s27, 2
s_cmp_lt_u32 s76, 63
s_cbranch_scc0 mega_kernel_rs_x4
s_cmp_gt_i32 s46, s76
s_cbranch_scc0 mega_kernel_rs_x4
s_cmp_eq_u32 s88, s76
s_cbranch_scc1 mega_kernel_rs_x7
s_add_u32 s77, s76, s82
s_bfe_u32 s28, s77, 0x40002
s_lshl_b32 s28, s28, 14
s_and_b32 s77, s77, 3
s_lshl_b32 s77, s77, 11
s_add_u32 s28, s28, s77
s_add_u32 s28, s28, s83
s_buffer_load_dword s78, s[84:87], s28 offset:0
s_buffer_load_dword s78, s[84:87], s28 offset:128
s_buffer_load_dword s78, s[84:87], s28 offset:256
s_buffer_load_dword s78, s[84:87], s28 offset:384
s_buffer_load_dword s78, s[84:87], s28 offset:512
s_buffer_load_dword s78, s[84:87], s28 offset:640
s_buffer_load_dword s78, s[84:87], s28 offset:768
s_buffer_load_dword s78, s[84:87], s28 offset:896
s_buffer_load_dword s78, s[84:87], s28 offset:1024
s_buffer_load_dword s78, s[84:87], s28 offset:1152
s_buffer_load_dword s78, s[84:87], s28 offset:1280
s_buffer_load_dword s78, s[84:87], s28 offset:1408
s_buffer_load_dword s78, s[84:87], s28 offset:1536
s_buffer_load_dword s78, s[84:87], s28 offset:1664
s_buffer_load_dword s78, s[84:87], s28 offset:1792
s_buffer_load_dword s78, s[84:87], s28 offset:1920
mega_kernel_rs_x7:
s_add_u32 s77, s76, s82
s_bfe_u32 s28, s77, 0x40002
s_lshl_b32 s28, s28, 14
s_and_b32 s77, s77, 3
s_lshl_b32 s77, s77, 11
s_add_u32 s28, s28, s77
s_add_u32 s28, s28, s83
s_add_u32 s28, s28, 33554432
s_buffer_load_dword s78, s[84:87], s28 offset:0
s_buffer_load_dword s78, s[84:87], s28 offset:128
s_buffer_load_dword s78, s[84:87], s28 offset:256
s_buffer_load_dword s78, s[84:87], s28 offset:384
s_buffer_load_dword s78, s[84:87], s28 offset:512
s_buffer_load_dword s78, s[84:87], s28 offset:640
s_buffer_load_dword s78, s[84:87], s28 offset:768
s_buffer_load_dword s78, s[84:87], s28 offset:896
s_buffer_load_dword s78, s[84:87], s28 offset:1024
s_buffer_load_dword s78, s[84:87], s28 offset:1152
s_buffer_load_dword s78, s[84:87], s28 offset:1280
s_buffer_load_dword s78, s[84:87], s28 offset:1408
s_buffer_load_dword s78, s[84:87], s28 offset:1536
s_buffer_load_dword s78, s[84:87], s28 offset:1664
s_buffer_load_dword s78, s[84:87], s28 offset:1792
s_buffer_load_dword s78, s[84:87], s28 offset:1920
s_mov_b32 s89, s76
mega_kernel_rs_x4:
v_mov_b32 v96, 0
v_mov_b32 v97, 0
v_mov_b32 v98, 0
v_mov_b32 v99, 0
v_mov_b32 v100, 0
v_mov_b32 v101, 0
v_mov_b32 v102, 0
v_mov_b32 v103, 0
v_mov_b32 v104, 0
v_mov_b32 v105, 0
v_mov_b32 v106, 0
v_mov_b32 v107, 0
v_mov_b32 v108, 0
v_mov_b32 v109, 0
v_mov_b32 v110, 0
v_mov_b32 v111, 0
v_mov_b32 v112, 0
v_mov_b32 v113, 0
v_mov_b32 v114, 0
v_mov_b32 v115, 0
v_mov_b32 v116, 0
v_mov_b32 v117, 0
v_mov_b32 v118, 0
v_mov_b32 v119, 0
s_branch mega_kernel_rs_b5
mega_kernel_rs_p2r:
buffer_load_dwordx4 v[184:187], v17, s[84:87], s76 offen sc1
buffer_load_dwordx4 v[188:191], v10, s[84:87], s76 offen sc1
buffer_load_dwordx4 v[192:195], v17, s[84:87], s77 offen sc1
buffer_load_dwordx4 v[196:199], v10, s[84:87], s77 offen sc1
buffer_load_dwordx4 v[200:203], v17, s[84:87], s78 offen sc1
buffer_load_dwordx4 v[204:207], v10, s[84:87], s78 offen sc1
s_branch mega_kernel_rs_p2
mega_kernel_rs_pa_1_0f:
s_mov_b64 exec, vcc
buffer_load_dwordx4 v[32:35], v7, s[84:87], s33 offen offset:0 sc1
s_mov_b64 exec, -1
s_branch mega_kernel_rs_pa_1_0
mega_kernel_rs_pa_1_0:
s_waitcnt vmcnt(0)
v_max_u32 v4, v32, v34
v_cmp_eq_u32 vcc, -1, v4
s_cbranch_vccnz mega_kernel_rs_pa_1_0f
v_smfmac_f32_16x16x64_bf16 v[96:99], v[32:35], a[0:7], v6
v_smfmac_f32_16x16x64_bf16 v[100:103], v[32:35], a[32:39], v6
v_smfmac_f32_16x16x64_bf16 v[104:107], v[32:35], a[64:71], v6
v_smfmac_f32_16x16x64_bf16 v[108:111], v[32:35], a[96:103], v6
s_branch mega_kernel_rs_pa_d
mega_kernel_rs_pa_2_1f:
s_mov_b64 exec, vcc
buffer_load_dwordx4 v[36:39], v7, s[84:87], s33 offen offset:1024 sc1
s_mov_b64 exec, -1
s_branch mega_kernel_rs_pa_2_1
mega_kernel_rs_pa_2_1:
s_waitcnt vmcnt(0)
v_max_u32 v4, v36, v38
v_cmp_eq_u32 vcc, -1, v4
s_cbranch_vccnz mega_kernel_rs_pa_2_1f
v_smfmac_f32_16x16x64_bf16 v[96:99], v[36:39], a[8:15], v6
v_smfmac_f32_16x16x64_bf16 v[100:103], v[36:39], a[40:47], v6
v_smfmac_f32_16x16x64_bf16 v[104:107], v[36:39], a[72:79], v6
v_smfmac_f32_16x16x64_bf16 v[108:111], v[36:39], a[104:111], v6
s_branch mega_kernel_rs_pa_d
mega_kernel_rs_pa_3_0f:
s_mov_b64 exec, vcc
buffer_load_dwordx4 v[32:35], v7, s[84:87], s33 offen offset:0 sc1
s_mov_b64 exec, -1
s_branch mega_kernel_rs_pa_3_1
mega_kernel_rs_pa_3_0:
s_waitcnt vmcnt(1)
v_max_u32 v4, v32, v34
v_cmp_eq_u32 vcc, -1, v4
s_cbranch_vccnz mega_kernel_rs_pa_3_0f
v_smfmac_f32_16x16x64_bf16 v[96:99], v[32:35], a[0:7], v6
v_smfmac_f32_16x16x64_bf16 v[100:103], v[32:35], a[32:39], v6
v_smfmac_f32_16x16x64_bf16 v[104:107], v[32:35], a[64:71], v6
v_smfmac_f32_16x16x64_bf16 v[108:111], v[32:35], a[96:103], v6
s_branch mega_kernel_rs_pa_2_1
mega_kernel_rs_pa_3_1f:
s_mov_b64 exec, vcc
buffer_load_dwordx4 v[36:39], v7, s[84:87], s33 offen offset:1024 sc1
s_mov_b64 exec, -1
s_branch mega_kernel_rs_pa_3_0
mega_kernel_rs_pa_3_1:
s_waitcnt vmcnt(1)
v_max_u32 v4, v36, v38
v_cmp_eq_u32 vcc, -1, v4
s_cbranch_vccnz mega_kernel_rs_pa_3_1f
v_smfmac_f32_16x16x64_bf16 v[96:99], v[36:39], a[8:15], v6
v_smfmac_f32_16x16x64_bf16 v[100:103], v[36:39], a[40:47], v6
v_smfmac_f32_16x16x64_bf16 v[104:107], v[36:39], a[72:79], v6
v_smfmac_f32_16x16x64_bf16 v[108:111], v[36:39], a[104:111], v6
s_branch mega_kernel_rs_pa_1_0
mega_kernel_rs_pa_4_2f:
s_mov_b64 exec, vcc
buffer_load_dwordx4 v[40:43], v7, s[84:87], s33 offen offset:2048 sc1
s_mov_b64 exec, -1
s_branch mega_kernel_rs_pa_4_2
mega_kernel_rs_pa_4_2:
s_waitcnt vmcnt(0)
v_max_u32 v4, v40, v42
v_cmp_eq_u32 vcc, -1, v4
s_cbranch_vccnz mega_kernel_rs_pa_4_2f
v_smfmac_f32_16x16x64_bf16 v[96:99], v[40:43], a[16:23], v6
v_smfmac_f32_16x16x64_bf16 v[100:103], v[40:43], a[48:55], v6
v_smfmac_f32_16x16x64_bf16 v[104:107], v[40:43], a[80:87], v6
v_smfmac_f32_16x16x64_bf16 v[108:111], v[40:43], a[112:119], v6
s_branch mega_kernel_rs_pa_d
mega_kernel_rs_pa_5_0f:
s_mov_b64 exec, vcc
buffer_load_dwordx4 v[32:35], v7, s[84:87], s33 offen offset:0 sc1
s_mov_b64 exec, -1
s_branch mega_kernel_rs_pa_5_2
mega_kernel_rs_pa_5_0:
s_waitcnt vmcnt(1)
v_max_u32 v4, v32, v34
v_cmp_eq_u32 vcc, -1, v4
s_cbranch_vccnz mega_kernel_rs_pa_5_0f
v_smfmac_f32_16x16x64_bf16 v[96:99], v[32:35], a[0:7], v6
v_smfmac_f32_16x16x64_bf16 v[100:103], v[32:35], a[32:39], v6
v_smfmac_f32_16x16x64_bf16 v[104:107], v[32:35], a[64:71], v6
v_smfmac_f32_16x16x64_bf16 v[108:111], v[32:35], a[96:103], v6
s_branch mega_kernel_rs_pa_4_2
mega_kernel_rs_pa_5_2f:
s_mov_b64 exec, vcc
buffer_load_dwordx4 v[40:43], v7, s[84:87], s33 offen offset:2048 sc1
s_mov_b64 exec, -1
s_branch mega_kernel_rs_pa_5_0
mega_kernel_rs_pa_5_2:
s_waitcnt vmcnt(1)
v_max_u32 v4, v40, v42
v_cmp_eq_u32 vcc, -1, v4
s_cbranch_vccnz mega_kernel_rs_pa_5_2f
v_smfmac_f32_16x16x64_bf16 v[96:99], v[40:43], a[16:23], v6
v_smfmac_f32_16x16x64_bf16 v[100:103], v[40:43], a[48:55], v6
v_smfmac_f32_16x16x64_bf16 v[104:107], v[40:43], a[80:87], v6
v_smfmac_f32_16x16x64_bf16 v[108:111], v[40:43], a[112:119], v6
s_branch mega_kernel_rs_pa_1_0
mega_kernel_rs_pa_6_1f:
s_mov_b64 exec, vcc
buffer_load_dwordx4 v[36:39], v7, s[84:87], s33 offen offset:1024 sc1
s_mov_b64 exec, -1
s_branch mega_kernel_rs_pa_6_2
mega_kernel_rs_pa_6_1:
s_waitcnt vmcnt(1)
v_max_u32 v4, v36, v38
v_cmp_eq_u32 vcc, -1, v4
s_cbranch_vccnz mega_kernel_rs_pa_6_1f
v_smfmac_f32_16x16x64_bf16 v[96:99], v[36:39], a[8:15], v6
v_smfmac_f32_16x16x64_bf16 v[100:103], v[36:39], a[40:47], v6
v_smfmac_f32_16x16x64_bf16 v[104:107], v[36:39], a[72:79], v6
v_smfmac_f32_16x16x64_bf16 v[108:111], v[36:39], a[104:111], v6
s_branch mega_kernel_rs_pa_4_2
mega_kernel_rs_pa_6_2f:
s_mov_b64 exec, vcc
buffer_load_dwordx4 v[40:43], v7, s[84:87], s33 offen offset:2048 sc1
s_mov_b64 exec, -1
s_branch mega_kernel_rs_pa_6_1
mega_kernel_rs_pa_6_2:
s_waitcnt vmcnt(1)
v_max_u32 v4, v40, v42
v_cmp_eq_u32 vcc, -1, v4
s_cbranch_vccnz mega_kernel_rs_pa_6_2f
v_smfmac_f32_16x16x64_bf16 v[96:99], v[40:43], a[16:23], v6
v_smfmac_f32_16x16x64_bf16 v[100:103], v[40:43], a[48:55], v6
v_smfmac_f32_16x16x64_bf16 v[104:107], v[40:43], a[80:87], v6
v_smfmac_f32_16x16x64_bf16 v[108:111], v[40:43], a[112:119], v6
s_branch mega_kernel_rs_pa_2_1
mega_kernel_rs_pa_7_0f:
s_mov_b64 exec, vcc
buffer_load_dwordx4 v[32:35], v7, s[84:87], s33 offen offset:0 sc1
s_mov_b64 exec, -1
s_branch mega_kernel_rs_pa_7_1
mega_kernel_rs_pa_7_0:
s_waitcnt vmcnt(2)
v_max_u32 v4, v32, v34
v_cmp_eq_u32 vcc, -1, v4
s_cbranch_vccnz mega_kernel_rs_pa_7_0f
v_smfmac_f32_16x16x64_bf16 v[96:99], v[32:35], a[0:7], v6
v_smfmac_f32_16x16x64_bf16 v[100:103], v[32:35], a[32:39], v6
v_smfmac_f32_16x16x64_bf16 v[104:107], v[32:35], a[64:71], v6
v_smfmac_f32_16x16x64_bf16 v[108:111], v[32:35], a[96:103], v6
s_branch mega_kernel_rs_pa_6_1
mega_kernel_rs_pa_7_1f:
s_mov_b64 exec, vcc
buffer_load_dwordx4 v[36:39], v7, s[84:87], s33 offen offset:1024 sc1
s_mov_b64 exec, -1
s_branch mega_kernel_rs_pa_7_2
mega_kernel_rs_pa_7_1:
s_waitcnt vmcnt(2)
v_max_u32 v4, v36, v38
v_cmp_eq_u32 vcc, -1, v4
s_cbranch_vccnz mega_kernel_rs_pa_7_1f
v_smfmac_f32_16x16x64_bf16 v[96:99], v[36:39], a[8:15], v6
v_smfmac_f32_16x16x64_bf16 v[100:103], v[36:39], a[40:47], v6
v_smfmac_f32_16x16x64_bf16 v[104:107], v[36:39], a[72:79], v6
v_smfmac_f32_16x16x64_bf16 v[108:111], v[36:39], a[104:111], v6
s_branch mega_kernel_rs_pa_5_2
mega_kernel_rs_pa_7_2f:
s_mov_b64 exec, vcc
buffer_load_dwordx4 v[40:43], v7, s[84:87], s33 offen offset:2048 sc1
s_mov_b64 exec, -1
s_branch mega_kernel_rs_pa_7_0
mega_kernel_rs_pa_7_2:
s_waitcnt vmcnt(2)
v_max_u32 v4, v40, v42
v_cmp_eq_u32 vcc, -1, v4
s_cbranch_vccnz mega_kernel_rs_pa_7_2f
v_smfmac_f32_16x16x64_bf16 v[96:99], v[40:43], a[16:23], v6
v_smfmac_f32_16x16x64_bf16 v[100:103], v[40:43], a[48:55], v6
v_smfmac_f32_16x16x64_bf16 v[104:107], v[40:43], a[80:87], v6
v_smfmac_f32_16x16x64_bf16 v[108:111], v[40:43], a[112:119], v6
s_branch mega_kernel_rs_pa_3_0
mega_kernel_rs_pa_8_3f:
s_mov_b64 exec, vcc
buffer_load_dwordx4 v[44:47], v7, s[84:87], s33 offen offset:3072 sc1
s_mov_b64 exec, -1
s_branch mega_kernel_rs_pa_8_3
mega_kernel_rs_pa_8_3:
s_waitcnt vmcnt(0)
v_max_u32 v4, v44, v46
v_cmp_eq_u32 vcc, -1, v4
s_cbranch_vccnz mega_kernel_rs_pa_8_3f
v_smfmac_f32_16x16x64_bf16 v[96:99], v[44:47], a[24:31], v6
v_smfmac_f32_16x16x64_bf16 v[100:103], v[44:47], a[56:63], v6
v_smfmac_f32_16x16x64_bf16 v[104:107], v[44:47], a[88:95], v6
v_smfmac_f32_16x16x64_bf16 v[108:111], v[44:47], a[120:127], v6
s_branch mega_kernel_rs_pa_d
mega_kernel_rs_pa_9_0f:
s_mov_b64 exec, vcc
buffer_load_dwordx4 v[32:35], v7, s[84:87], s33 offen offset:0 sc1
s_mov_b64 exec, -1
s_branch mega_kernel_rs_pa_9_3
mega_kernel_rs_pa_9_0:
s_waitcnt vmcnt(1)
v_max_u32 v4, v32, v34
v_cmp_eq_u32 vcc, -1, v4
s_cbranch_vccnz mega_kernel_rs_pa_9_0f
v_smfmac_f32_16x16x64_bf16 v[96:99], v[32:35], a[0:7], v6
v_smfmac_f32_16x16x64_bf16 v[100:103], v[32:35], a[32:39], v6
v_smfmac_f32_16x16x64_bf16 v[104:107], v[32:35], a[64:71], v6
v_smfmac_f32_16x16x64_bf16 v[108:111], v[32:35], a[96:103], v6
s_branch mega_kernel_rs_pa_8_3
mega_kernel_rs_pa_9_3f:
s_mov_b64 exec, vcc
buffer_load_dwordx4 v[44:47], v7, s[84:87], s33 offen offset:3072 sc1
s_mov_b64 exec, -1
s_branch mega_kernel_rs_pa_9_0
mega_kernel_rs_pa_9_3:
s_waitcnt vmcnt(1)
v_max_u32 v4, v44, v46
v_cmp_eq_u32 vcc, -1, v4
s_cbranch_vccnz mega_kernel_rs_pa_9_3f
v_smfmac_f32_16x16x64_bf16 v[96:99], v[44:47], a[24:31], v6
v_smfmac_f32_16x16x64_bf16 v[100:103], v[44:47], a[56:63], v6
v_smfmac_f32_16x16x64_bf16 v[104:107], v[44:47], a[88:95], v6
v_smfmac_f32_16x16x64_bf16 v[108:111], v[44:47], a[120:127], v6
s_branch mega_kernel_rs_pa_1_0
mega_kernel_rs_pa_10_1f:
s_mov_b64 exec, vcc
buffer_load_dwordx4 v[36:39], v7, s[84:87], s33 offen offset:1024 sc1
s_mov_b64 exec, -1
s_branch mega_kernel_rs_pa_10_3
mega_kernel_rs_pa_10_1:
s_waitcnt vmcnt(1)
v_max_u32 v4, v36, v38
v_cmp_eq_u32 vcc, -1, v4
s_cbranch_vccnz mega_kernel_rs_pa_10_1f
v_smfmac_f32_16x16x64_bf16 v[96:99], v[36:39], a[8:15], v6
v_smfmac_f32_16x16x64_bf16 v[100:103], v[36:39], a[40:47], v6
v_smfmac_f32_16x16x64_bf16 v[104:107], v[36:39], a[72:79], v6
v_smfmac_f32_16x16x64_bf16 v[108:111], v[36:39], a[104:111], v6
s_branch mega_kernel_rs_pa_8_3
mega_kernel_rs_pa_10_3f:
s_mov_b64 exec, vcc
buffer_load_dwordx4 v[44:47], v7, s[84:87], s33 offen offset:3072 sc1
s_mov_b64 exec, -1
s_branch mega_kernel_rs_pa_10_1
mega_kernel_rs_pa_10_3:
s_waitcnt vmcnt(1)
v_max_u32 v4, v44, v46
v_cmp_eq_u32 vcc, -1, v4
s_cbranch_vccnz mega_kernel_rs_pa_10_3f
v_smfmac_f32_16x16x64_bf16 v[96:99], v[44:47], a[24:31], v6
v_smfmac_f32_16x16x64_bf16 v[100:103], v[44:47], a[56:63], v6
v_smfmac_f32_16x16x64_bf16 v[104:107], v[44:47], a[88:95], v6
v_smfmac_f32_16x16x64_bf16 v[108:111], v[44:47], a[120:127], v6
s_branch mega_kernel_rs_pa_2_1
mega_kernel_rs_pa_11_0f:
s_mov_b64 exec, vcc
buffer_load_dwordx4 v[32:35], v7, s[84:87], s33 offen offset:0 sc1
s_mov_b64 exec, -1
s_branch mega_kernel_rs_pa_11_1
mega_kernel_rs_pa_11_0:
s_waitcnt vmcnt(2)
v_max_u32 v4, v32, v34
v_cmp_eq_u32 vcc, -1, v4
s_cbranch_vccnz mega_kernel_rs_pa_11_0f
v_smfmac_f32_16x16x64_bf16 v[96:99], v[32:35], a[0:7], v6
v_smfmac_f32_16x16x64_bf16 v[100:103], v[32:35], a[32:39], v6
v_smfmac_f32_16x16x64_bf16 v[104:107], v[32:35], a[64:71], v6
v_smfmac_f32_16x16x64_bf16 v[108:111], v[32:35], a[96:103], v6
s_branch mega_kernel_rs_pa_10_1
mega_kernel_rs_pa_11_1f:
s_mov_b64 exec, vcc
buffer_load_dwordx4 v[36:39], v7, s[84:87], s33 offen offset:1024 sc1
s_mov_b64 exec, -1
s_branch mega_kernel_rs_pa_11_3
mega_kernel_rs_pa_11_1:
s_waitcnt vmcnt(2)
v_max_u32 v4, v36, v38
v_cmp_eq_u32 vcc, -1, v4
s_cbranch_vccnz mega_kernel_rs_pa_11_1f
v_smfmac_f32_16x16x64_bf16 v[96:99], v[36:39], a[8:15], v6
v_smfmac_f32_16x16x64_bf16 v[100:103], v[36:39], a[40:47], v6
v_smfmac_f32_16x16x64_bf16 v[104:107], v[36:39], a[72:79], v6
v_smfmac_f32_16x16x64_bf16 v[108:111], v[36:39], a[104:111], v6
s_branch mega_kernel_rs_pa_9_3
mega_kernel_rs_pa_11_3f:
s_mov_b64 exec, vcc
buffer_load_dwordx4 v[44:47], v7, s[84:87], s33 offen offset:3072 sc1
s_mov_b64 exec, -1
s_branch mega_kernel_rs_pa_11_0
mega_kernel_rs_pa_11_3:
s_waitcnt vmcnt(2)
v_max_u32 v4, v44, v46
v_cmp_eq_u32 vcc, -1, v4
s_cbranch_vccnz mega_kernel_rs_pa_11_3f
v_smfmac_f32_16x16x64_bf16 v[96:99], v[44:47], a[24:31], v6
v_smfmac_f32_16x16x64_bf16 v[100:103], v[44:47], a[56:63], v6
v_smfmac_f32_16x16x64_bf16 v[104:107], v[44:47], a[88:95], v6
v_smfmac_f32_16x16x64_bf16 v[108:111], v[44:47], a[120:127], v6
s_branch mega_kernel_rs_pa_3_0
mega_kernel_rs_pa_12_2f:
s_mov_b64 exec, vcc
buffer_load_dwordx4 v[40:43], v7, s[84:87], s33 offen offset:2048 sc1
s_mov_b64 exec, -1
s_branch mega_kernel_rs_pa_12_3
mega_kernel_rs_pa_12_2:
s_waitcnt vmcnt(1)
v_max_u32 v4, v40, v42
v_cmp_eq_u32 vcc, -1, v4
s_cbranch_vccnz mega_kernel_rs_pa_12_2f
v_smfmac_f32_16x16x64_bf16 v[96:99], v[40:43], a[16:23], v6
v_smfmac_f32_16x16x64_bf16 v[100:103], v[40:43], a[48:55], v6
v_smfmac_f32_16x16x64_bf16 v[104:107], v[40:43], a[80:87], v6
v_smfmac_f32_16x16x64_bf16 v[108:111], v[40:43], a[112:119], v6
s_branch mega_kernel_rs_pa_8_3
mega_kernel_rs_pa_12_3f:
s_mov_b64 exec, vcc
buffer_load_dwordx4 v[44:47], v7, s[84:87], s33 offen offset:3072 sc1
s_mov_b64 exec, -1
s_branch mega_kernel_rs_pa_12_2
mega_kernel_rs_pa_12_3:
s_waitcnt vmcnt(1)
v_max_u32 v4, v44, v46
v_cmp_eq_u32 vcc, -1, v4
s_cbranch_vccnz mega_kernel_rs_pa_12_3f
v_smfmac_f32_16x16x64_bf16 v[96:99], v[44:47], a[24:31], v6
v_smfmac_f32_16x16x64_bf16 v[100:103], v[44:47], a[56:63], v6
v_smfmac_f32_16x16x64_bf16 v[104:107], v[44:47], a[88:95], v6
v_smfmac_f32_16x16x64_bf16 v[108:111], v[44:47], a[120:127], v6
s_branch mega_kernel_rs_pa_4_2
mega_kernel_rs_pa_13_0f:
s_mov_b64 exec, vcc
buffer_load_dwordx4 v[32:35], v7, s[84:87], s33 offen offset:0 sc1
s_mov_b64 exec, -1
s_branch mega_kernel_rs_pa_13_2
mega_kernel_rs_pa_13_0:
s_waitcnt vmcnt(2)
v_max_u32 v4, v32, v34
v_cmp_eq_u32 vcc, -1, v4
s_cbranch_vccnz mega_kernel_rs_pa_13_0f
v_smfmac_f32_16x16x64_bf16 v[96:99], v[32:35], a[0:7], v6
v_smfmac_f32_16x16x64_bf16 v[100:103], v[32:35], a[32:39], v6
v_smfmac_f32_16x16x64_bf16 v[104:107], v[32:35], a[64:71], v6
v_smfmac_f32_16x16x64_bf16 v[108:111], v[32:35], a[96:103], v6
s_branch mega_kernel_rs_pa_12_2
mega_kernel_rs_pa_13_2f:
s_mov_b64 exec, vcc
buffer_load_dwordx4 v[40:43], v7, s[84:87], s33 offen offset:2048 sc1
s_mov_b64 exec, -1
s_branch mega_kernel_rs_pa_13_3
mega_kernel_rs_pa_13_2:
s_waitcnt vmcnt(2)
v_max_u32 v4, v40, v42
v_cmp_eq_u32 vcc, -1, v4
s_cbranch_vccnz mega_kernel_rs_pa_13_2f
v_smfmac_f32_16x16x64_bf16 v[96:99], v[40:43], a[16:23], v6
v_smfmac_f32_16x16x64_bf16 v[100:103], v[40:43], a[48:55], v6
v_smfmac_f32_16x16x64_bf16 v[104:107], v[40:43], a[80:87], v6
v_smfmac_f32_16x16x64_bf16 v[108:111], v[40:43], a[112:119], v6
s_branch mega_kernel_rs_pa_9_3
mega_kernel_rs_pa_13_3f:
s_mov_b64 exec, vcc
buffer_load_dwordx4 v[44:47], v7, s[84:87], s33 offen offset:3072 sc1
s_mov_b64 exec, -1
s_branch mega_kernel_rs_pa_13_0
mega_kernel_rs_pa_13_3:
s_waitcnt vmcnt(2)
v_max_u32 v4, v44, v46
v_cmp_eq_u32 vcc, -1, v4
s_cbranch_vccnz mega_kernel_rs_pa_13_3f
v_smfmac_f32_16x16x64_bf16 v[96:99], v[44:47], a[24:31], v6
v_smfmac_f32_16x16x64_bf16 v[100:103], v[44:47], a[56:63], v6
v_smfmac_f32_16x16x64_bf16 v[104:107], v[44:47], a[88:95], v6
v_smfmac_f32_16x16x64_bf16 v[108:111], v[44:47], a[120:127], v6
s_branch mega_kernel_rs_pa_5_0
mega_kernel_rs_pa_14_1f:
s_mov_b64 exec, vcc
buffer_load_dwordx4 v[36:39], v7, s[84:87], s33 offen offset:1024 sc1
s_mov_b64 exec, -1
s_branch mega_kernel_rs_pa_14_2
mega_kernel_rs_pa_14_1:
s_waitcnt vmcnt(2)
v_max_u32 v4, v36, v38
v_cmp_eq_u32 vcc, -1, v4
s_cbranch_vccnz mega_kernel_rs_pa_14_1f
v_smfmac_f32_16x16x64_bf16 v[96:99], v[36:39], a[8:15], v6
v_smfmac_f32_16x16x64_bf16 v[100:103], v[36:39], a[40:47], v6
v_smfmac_f32_16x16x64_bf16 v[104:107], v[36:39], a[72:79], v6
v_smfmac_f32_16x16x64_bf16 v[108:111], v[36:39], a[104:111], v6
s_branch mega_kernel_rs_pa_12_2
mega_kernel_rs_pa_14_2f:
s_mov_b64 exec, vcc
buffer_load_dwordx4 v[40:43], v7, s[84:87], s33 offen offset:2048 sc1
s_mov_b64 exec, -1
s_branch mega_kernel_rs_pa_14_3
mega_kernel_rs_pa_14_2:
s_waitcnt vmcnt(2)
v_max_u32 v4, v40, v42
v_cmp_eq_u32 vcc, -1, v4
s_cbranch_vccnz mega_kernel_rs_pa_14_2f
v_smfmac_f32_16x16x64_bf16 v[96:99], v[40:43], a[16:23], v6
v_smfmac_f32_16x16x64_bf16 v[100:103], v[40:43], a[48:55], v6
v_smfmac_f32_16x16x64_bf16 v[104:107], v[40:43], a[80:87], v6
v_smfmac_f32_16x16x64_bf16 v[108:111], v[40:43], a[112:119], v6
s_branch mega_kernel_rs_pa_10_3
mega_kernel_rs_pa_14_3f:
s_mov_b64 exec, vcc
buffer_load_dwordx4 v[44:47], v7, s[84:87], s33 offen offset:3072 sc1
s_mov_b64 exec, -1
s_branch mega_kernel_rs_pa_14_1
mega_kernel_rs_pa_14_3:
s_waitcnt vmcnt(2)
v_max_u32 v4, v44, v46
v_cmp_eq_u32 vcc, -1, v4
s_cbranch_vccnz mega_kernel_rs_pa_14_3f
v_smfmac_f32_16x16x64_bf16 v[96:99], v[44:47], a[24:31], v6
v_smfmac_f32_16x16x64_bf16 v[100:103], v[44:47], a[56:63], v6
v_smfmac_f32_16x16x64_bf16 v[104:107], v[44:47], a[88:95], v6
v_smfmac_f32_16x16x64_bf16 v[108:111], v[44:47], a[120:127], v6
s_branch mega_kernel_rs_pa_6_1
mega_kernel_rs_pa_15_0f:
s_mov_b64 exec, vcc
buffer_load_dwordx4 v[32:35], v7, s[84:87], s33 offen offset:0 sc1
s_mov_b64 exec, -1
s_branch mega_kernel_rs_pa_15_1
mega_kernel_rs_pa_15_0:
s_waitcnt vmcnt(3)
v_max_u32 v4, v32, v34
v_cmp_eq_u32 vcc, -1, v4
s_cbranch_vccnz mega_kernel_rs_pa_15_0f
v_smfmac_f32_16x16x64_bf16 v[96:99], v[32:35], a[0:7], v6
v_smfmac_f32_16x16x64_bf16 v[100:103], v[32:35], a[32:39], v6
v_smfmac_f32_16x16x64_bf16 v[104:107], v[32:35], a[64:71], v6
v_smfmac_f32_16x16x64_bf16 v[108:111], v[32:35], a[96:103], v6
s_branch mega_kernel_rs_pa_14_1
mega_kernel_rs_pa_15_1f:
s_mov_b64 exec, vcc
buffer_load_dwordx4 v[36:39], v7, s[84:87], s33 offen offset:1024 sc1
s_mov_b64 exec, -1
s_branch mega_kernel_rs_pa_15_2
mega_kernel_rs_pa_15_1:
s_waitcnt vmcnt(3)
v_max_u32 v4, v36, v38
v_cmp_eq_u32 vcc, -1, v4
s_cbranch_vccnz mega_kernel_rs_pa_15_1f
v_smfmac_f32_16x16x64_bf16 v[96:99], v[36:39], a[8:15], v6
v_smfmac_f32_16x16x64_bf16 v[100:103], v[36:39], a[40:47], v6
v_smfmac_f32_16x16x64_bf16 v[104:107], v[36:39], a[72:79], v6
v_smfmac_f32_16x16x64_bf16 v[108:111], v[36:39], a[104:111], v6
s_branch mega_kernel_rs_pa_13_2
mega_kernel_rs_pa_15_2f:
s_mov_b64 exec, vcc
buffer_load_dwordx4 v[40:43], v7, s[84:87], s33 offen offset:2048 sc1
s_mov_b64 exec, -1
s_branch mega_kernel_rs_pa_15_3
mega_kernel_rs_pa_15_2:
s_waitcnt vmcnt(3)
v_max_u32 v4, v40, v42
v_cmp_eq_u32 vcc, -1, v4
s_cbranch_vccnz mega_kernel_rs_pa_15_2f
v_smfmac_f32_16x16x64_bf16 v[96:99], v[40:43], a[16:23], v6
v_smfmac_f32_16x16x64_bf16 v[100:103], v[40:43], a[48:55], v6
v_smfmac_f32_16x16x64_bf16 v[104:107], v[40:43], a[80:87], v6
v_smfmac_f32_16x16x64_bf16 v[108:111], v[40:43], a[112:119], v6
s_branch mega_kernel_rs_pa_11_3
mega_kernel_rs_pa_15_3f:
s_mov_b64 exec, vcc
buffer_load_dwordx4 v[44:47], v7, s[84:87], s33 offen offset:3072 sc1
s_mov_b64 exec, -1
s_branch mega_kernel_rs_pa_15_0
mega_kernel_rs_pa_15_3:
s_waitcnt vmcnt(3)
v_max_u32 v4, v44, v46
v_cmp_eq_u32 vcc, -1, v4
s_cbranch_vccnz mega_kernel_rs_pa_15_3f
v_smfmac_f32_16x16x64_bf16 v[96:99], v[44:47], a[24:31], v6
v_smfmac_f32_16x16x64_bf16 v[100:103], v[44:47], a[56:63], v6
v_smfmac_f32_16x16x64_bf16 v[104:107], v[44:47], a[88:95], v6
v_smfmac_f32_16x16x64_bf16 v[108:111], v[44:47], a[120:127], v6
s_branch mega_kernel_rs_pa_7_0
mega_kernel_rs_pc_1_0f:
s_mov_b64 exec, vcc
buffer_load_dwordx4 v[32:35], v7, s[84:87], s29 offen offset:0 sc1
s_mov_b64 exec, -1
s_branch mega_kernel_rs_pc_1_0
mega_kernel_rs_pc_1_0:
s_waitcnt vmcnt(0)
v_cmp_eq_u32 vcc, -1, v32
s_cbranch_vccnz mega_kernel_rs_pc_1_0f
v_smfmac_f32_16x16x64_bf16 v[96:99], v[32:35], a[192:199], v6
v_smfmac_f32_16x16x64_bf16 v[100:103], v[32:35], a[224:231], v6
s_branch mega_kernel_rs_pc_d
mega_kernel_rs_pc_2_1f:
s_mov_b64 exec, vcc
buffer_load_dwordx4 v[36:39], v7, s[84:87], s29 offen offset:1024 sc1
s_mov_b64 exec, -1
s_branch mega_kernel_rs_pc_2_1
mega_kernel_rs_pc_2_1:
s_waitcnt vmcnt(0)
v_cmp_eq_u32 vcc, -1, v36
s_cbranch_vccnz mega_kernel_rs_pc_2_1f
v_smfmac_f32_16x16x64_bf16 v[96:99], v[36:39], a[200:207], v6
v_smfmac_f32_16x16x64_bf16 v[100:103], v[36:39], a[232:239], v6
s_branch mega_kernel_rs_pc_d
mega_kernel_rs_pc_3_0f:
s_mov_b64 exec, vcc
buffer_load_dwordx4 v[32:35], v7, s[84:87], s29 offen offset:0 sc1
s_mov_b64 exec, -1
s_branch mega_kernel_rs_pc_3_1
mega_kernel_rs_pc_3_0:
s_waitcnt vmcnt(1)
v_cmp_eq_u32 vcc, -1, v32
s_cbranch_vccnz mega_kernel_rs_pc_3_0f
v_smfmac_f32_16x16x64_bf16 v[96:99], v[32:35], a[192:199], v6
v_smfmac_f32_16x16x64_bf16 v[100:103], v[32:35], a[224:231], v6
s_branch mega_kernel_rs_pc_2_1
mega_kernel_rs_pc_3_1f:
s_mov_b64 exec, vcc
buffer_load_dwordx4 v[36:39], v7, s[84:87], s29 offen offset:1024 sc1
s_mov_b64 exec, -1
s_branch mega_kernel_rs_pc_3_0
mega_kernel_rs_pc_3_1:
s_waitcnt vmcnt(1)
v_cmp_eq_u32 vcc, -1, v36
s_cbranch_vccnz mega_kernel_rs_pc_3_1f
v_smfmac_f32_16x16x64_bf16 v[96:99], v[36:39], a[200:207], v6
v_smfmac_f32_16x16x64_bf16 v[100:103], v[36:39], a[232:239], v6
s_branch mega_kernel_rs_pc_1_0
mega_kernel_rs_pc_4_2f:
s_mov_b64 exec, vcc
buffer_load_dwordx4 v[40:43], v7, s[84:87], s29 offen offset:2048 sc1
s_mov_b64 exec, -1
s_branch mega_kernel_rs_pc_4_2
mega_kernel_rs_pc_4_2:
s_waitcnt vmcnt(0)
v_cmp_eq_u32 vcc, -1, v40
s_cbranch_vccnz mega_kernel_rs_pc_4_2f
v_smfmac_f32_16x16x64_bf16 v[96:99], v[40:43], a[208:215], v6
v_smfmac_f32_16x16x64_bf16 v[100:103], v[40:43], a[240:247], v6
s_branch mega_kernel_rs_pc_d
mega_kernel_rs_pc_5_0f:
s_mov_b64 exec, vcc
buffer_load_dwordx4 v[32:35], v7, s[84:87], s29 offen offset:0 sc1
s_mov_b64 exec, -1
s_branch mega_kernel_rs_pc_5_2
mega_kernel_rs_pc_5_0:
s_waitcnt vmcnt(1)
v_cmp_eq_u32 vcc, -1, v32
s_cbranch_vccnz mega_kernel_rs_pc_5_0f
v_smfmac_f32_16x16x64_bf16 v[96:99], v[32:35], a[192:199], v6
v_smfmac_f32_16x16x64_bf16 v[100:103], v[32:35], a[224:231], v6
s_branch mega_kernel_rs_pc_4_2
mega_kernel_rs_pc_5_2f:
s_mov_b64 exec, vcc
buffer_load_dwordx4 v[40:43], v7, s[84:87], s29 offen offset:2048 sc1
s_mov_b64 exec, -1
s_branch mega_kernel_rs_pc_5_0
mega_kernel_rs_pc_5_2:
s_waitcnt vmcnt(1)
v_cmp_eq_u32 vcc, -1, v40
s_cbranch_vccnz mega_kernel_rs_pc_5_2f
v_smfmac_f32_16x16x64_bf16 v[96:99], v[40:43], a[208:215], v6
v_smfmac_f32_16x16x64_bf16 v[100:103], v[40:43], a[240:247], v6
s_branch mega_kernel_rs_pc_1_0
mega_kernel_rs_pc_6_1f:
s_mov_b64 exec, vcc
buffer_load_dwordx4 v[36:39], v7, s[84:87], s29 offen offset:1024 sc1
s_mov_b64 exec, -1
s_branch mega_kernel_rs_pc_6_2
mega_kernel_rs_pc_6_1:
s_waitcnt vmcnt(1)
v_cmp_eq_u32 vcc, -1, v36
s_cbranch_vccnz mega_kernel_rs_pc_6_1f
v_smfmac_f32_16x16x64_bf16 v[96:99], v[36:39], a[200:207], v6
v_smfmac_f32_16x16x64_bf16 v[100:103], v[36:39], a[232:239], v6
s_branch mega_kernel_rs_pc_4_2
mega_kernel_rs_pc_6_2f:
s_mov_b64 exec, vcc
buffer_load_dwordx4 v[40:43], v7, s[84:87], s29 offen offset:2048 sc1
s_mov_b64 exec, -1
s_branch mega_kernel_rs_pc_6_1
mega_kernel_rs_pc_6_2:
s_waitcnt vmcnt(1)
v_cmp_eq_u32 vcc, -1, v40
s_cbranch_vccnz mega_kernel_rs_pc_6_2f
v_smfmac_f32_16x16x64_bf16 v[96:99], v[40:43], a[208:215], v6
v_smfmac_f32_16x16x64_bf16 v[100:103], v[40:43], a[240:247], v6
s_branch mega_kernel_rs_pc_2_1
mega_kernel_rs_pc_7_0f:
s_mov_b64 exec, vcc
buffer_load_dwordx4 v[32:35], v7, s[84:87], s29 offen offset:0 sc1
s_mov_b64 exec, -1
s_branch mega_kernel_rs_pc_7_1
mega_kernel_rs_pc_7_0:
s_waitcnt vmcnt(2)
v_cmp_eq_u32 vcc, -1, v32
s_cbranch_vccnz mega_kernel_rs_pc_7_0f
v_smfmac_f32_16x16x64_bf16 v[96:99], v[32:35], a[192:199], v6
v_smfmac_f32_16x16x64_bf16 v[100:103], v[32:35], a[224:231], v6
s_branch mega_kernel_rs_pc_6_1
mega_kernel_rs_pc_7_1f:
s_mov_b64 exec, vcc
buffer_load_dwordx4 v[36:39], v7, s[84:87], s29 offen offset:1024 sc1
s_mov_b64 exec, -1
s_branch mega_kernel_rs_pc_7_2
mega_kernel_rs_pc_7_1:
s_waitcnt vmcnt(2)
v_cmp_eq_u32 vcc, -1, v36
s_cbranch_vccnz mega_kernel_rs_pc_7_1f
v_smfmac_f32_16x16x64_bf16 v[96:99], v[36:39], a[200:207], v6
v_smfmac_f32_16x16x64_bf16 v[100:103], v[36:39], a[232:239], v6
s_branch mega_kernel_rs_pc_5_2
mega_kernel_rs_pc_7_2f:
s_mov_b64 exec, vcc
buffer_load_dwordx4 v[40:43], v7, s[84:87], s29 offen offset:2048 sc1
s_mov_b64 exec, -1
s_branch mega_kernel_rs_pc_7_0
mega_kernel_rs_pc_7_2:
s_waitcnt vmcnt(2)
v_cmp_eq_u32 vcc, -1, v40
s_cbranch_vccnz mega_kernel_rs_pc_7_2f
v_smfmac_f32_16x16x64_bf16 v[96:99], v[40:43], a[208:215], v6
v_smfmac_f32_16x16x64_bf16 v[100:103], v[40:43], a[240:247], v6
s_branch mega_kernel_rs_pc_3_0
mega_kernel_rs_pc_8_3f:
s_mov_b64 exec, vcc
buffer_load_dwordx4 v[44:47], v7, s[84:87], s29 offen offset:3072 sc1
s_mov_b64 exec, -1
s_branch mega_kernel_rs_pc_8_3
mega_kernel_rs_pc_9_0f:
s_mov_b64 exec, vcc
buffer_load_dwordx4 v[32:35], v7, s[84:87], s29 offen offset:0 sc1
s_mov_b64 exec, -1
s_branch mega_kernel_rs_pc_9_3
mega_kernel_rs_pc_9_0:
s_waitcnt vmcnt(1)
v_cmp_eq_u32 vcc, -1, v32
s_cbranch_vccnz mega_kernel_rs_pc_9_0f
v_smfmac_f32_16x16x64_bf16 v[96:99], v[32:35], a[192:199], v6
v_smfmac_f32_16x16x64_bf16 v[100:103], v[32:35], a[224:231], v6
s_branch mega_kernel_rs_pc_8_3
mega_kernel_rs_pc_9_3f:
s_mov_b64 exec, vcc
buffer_load_dwordx4 v[44:47], v7, s[84:87], s29 offen offset:3072 sc1
s_mov_b64 exec, -1
s_branch mega_kernel_rs_pc_9_0
mega_kernel_rs_pc_9_3:
s_waitcnt vmcnt(1)
v_cmp_eq_u32 vcc, -1, v44
s_cbranch_vccnz mega_kernel_rs_pc_9_3f
v_smfmac_f32_16x16x64_bf16 v[96:99], v[44:47], a[216:223], v6
v_smfmac_f32_16x16x64_bf16 v[100:103], v[44:47], a[248:255], v6
s_branch mega_kernel_rs_pc_1_0
mega_kernel_rs_pc_10_1f:
s_mov_b64 exec, vcc
buffer_load_dwordx4 v[36:39], v7, s[84:87], s29 offen offset:1024 sc1
s_mov_b64 exec, -1
s_branch mega_kernel_rs_pc_10_3
mega_kernel_rs_pc_10_1:
s_waitcnt vmcnt(1)
v_cmp_eq_u32 vcc, -1, v36
s_cbranch_vccnz mega_kernel_rs_pc_10_1f
v_smfmac_f32_16x16x64_bf16 v[96:99], v[36:39], a[200:207], v6
v_smfmac_f32_16x16x64_bf16 v[100:103], v[36:39], a[232:239], v6
s_branch mega_kernel_rs_pc_8_3
mega_kernel_rs_pc_10_3f:
s_mov_b64 exec, vcc
buffer_load_dwordx4 v[44:47], v7, s[84:87], s29 offen offset:3072 sc1
s_mov_b64 exec, -1
s_branch mega_kernel_rs_pc_10_1
mega_kernel_rs_pc_10_3:
s_waitcnt vmcnt(1)
v_cmp_eq_u32 vcc, -1, v44
s_cbranch_vccnz mega_kernel_rs_pc_10_3f
v_smfmac_f32_16x16x64_bf16 v[96:99], v[44:47], a[216:223], v6
v_smfmac_f32_16x16x64_bf16 v[100:103], v[44:47], a[248:255], v6
s_branch mega_kernel_rs_pc_2_1
mega_kernel_rs_pc_11_0f:
s_mov_b64 exec, vcc
buffer_load_dwordx4 v[32:35], v7, s[84:87], s29 offen offset:0 sc1
s_mov_b64 exec, -1
s_branch mega_kernel_rs_pc_11_1
mega_kernel_rs_pc_11_0:
s_waitcnt vmcnt(2)
v_cmp_eq_u32 vcc, -1, v32
s_cbranch_vccnz mega_kernel_rs_pc_11_0f
v_smfmac_f32_16x16x64_bf16 v[96:99], v[32:35], a[192:199], v6
v_smfmac_f32_16x16x64_bf16 v[100:103], v[32:35], a[224:231], v6
s_branch mega_kernel_rs_pc_10_1
mega_kernel_rs_pc_11_1f:
s_mov_b64 exec, vcc
buffer_load_dwordx4 v[36:39], v7, s[84:87], s29 offen offset:1024 sc1
s_mov_b64 exec, -1
s_branch mega_kernel_rs_pc_11_3
mega_kernel_rs_pc_11_1:
s_waitcnt vmcnt(2)
v_cmp_eq_u32 vcc, -1, v36
s_cbranch_vccnz mega_kernel_rs_pc_11_1f
v_smfmac_f32_16x16x64_bf16 v[96:99], v[36:39], a[200:207], v6
v_smfmac_f32_16x16x64_bf16 v[100:103], v[36:39], a[232:239], v6
s_branch mega_kernel_rs_pc_9_3
mega_kernel_rs_pc_11_3f:
s_mov_b64 exec, vcc
buffer_load_dwordx4 v[44:47], v7, s[84:87], s29 offen offset:3072 sc1
s_mov_b64 exec, -1
s_branch mega_kernel_rs_pc_11_0
mega_kernel_rs_pc_11_3:
s_waitcnt vmcnt(2)
v_cmp_eq_u32 vcc, -1, v44
s_cbranch_vccnz mega_kernel_rs_pc_11_3f
v_smfmac_f32_16x16x64_bf16 v[96:99], v[44:47], a[216:223], v6
v_smfmac_f32_16x16x64_bf16 v[100:103], v[44:47], a[248:255], v6
s_branch mega_kernel_rs_pc_3_0
mega_kernel_rs_pc_12_2f:
s_mov_b64 exec, vcc
buffer_load_dwordx4 v[40:43], v7, s[84:87], s29 offen offset:2048 sc1
s_mov_b64 exec, -1
s_branch mega_kernel_rs_pc_12_3
mega_kernel_rs_pc_12_3f:
s_mov_b64 exec, vcc
buffer_load_dwordx4 v[44:47], v7, s[84:87], s29 offen offset:3072 sc1
s_mov_b64 exec, -1
s_branch mega_kernel_rs_pc_12_2
mega_kernel_rs_pc_12_3:
s_waitcnt vmcnt(1)
v_cmp_eq_u32 vcc, -1, v44
s_cbranch_vccnz mega_kernel_rs_pc_12_3f
v_smfmac_f32_16x16x64_bf16 v[96:99], v[44:47], a[216:223], v6
v_smfmac_f32_16x16x64_bf16 v[100:103], v[44:47], a[248:255], v6
s_branch mega_kernel_rs_pc_4_2
mega_kernel_rs_pc_13_0f:
s_mov_b64 exec, vcc
buffer_load_dwordx4 v[32:35], v7, s[84:87], s29 offen offset:0 sc1
s_mov_b64 exec, -1
s_branch mega_kernel_rs_pc_13_2
mega_kernel_rs_pc_13_0:
s_waitcnt vmcnt(2)
v_cmp_eq_u32 vcc, -1, v32
s_cbranch_vccnz mega_kernel_rs_pc_13_0f
v_smfmac_f32_16x16x64_bf16 v[96:99], v[32:35], a[192:199], v6
v_smfmac_f32_16x16x64_bf16 v[100:103], v[32:35], a[224:231], v6
s_branch mega_kernel_rs_pc_12_2
mega_kernel_rs_pc_13_2f:
s_mov_b64 exec, vcc
buffer_load_dwordx4 v[40:43], v7, s[84:87], s29 offen offset:2048 sc1
s_mov_b64 exec, -1
s_branch mega_kernel_rs_pc_13_3
mega_kernel_rs_pc_13_2:
s_waitcnt vmcnt(2)
v_cmp_eq_u32 vcc, -1, v40
s_cbranch_vccnz mega_kernel_rs_pc_13_2f
v_smfmac_f32_16x16x64_bf16 v[96:99], v[40:43], a[208:215], v6
v_smfmac_f32_16x16x64_bf16 v[100:103], v[40:43], a[240:247], v6
s_branch mega_kernel_rs_pc_9_3
mega_kernel_rs_pc_13_3f:
s_mov_b64 exec, vcc
buffer_load_dwordx4 v[44:47], v7, s[84:87], s29 offen offset:3072 sc1
s_mov_b64 exec, -1
s_branch mega_kernel_rs_pc_13_0
mega_kernel_rs_pc_13_3:
s_waitcnt vmcnt(2)
v_cmp_eq_u32 vcc, -1, v44
s_cbranch_vccnz mega_kernel_rs_pc_13_3f
v_smfmac_f32_16x16x64_bf16 v[96:99], v[44:47], a[216:223], v6
v_smfmac_f32_16x16x64_bf16 v[100:103], v[44:47], a[248:255], v6
s_branch mega_kernel_rs_pc_5_0
mega_kernel_rs_pc_14_1f:
s_mov_b64 exec, vcc
buffer_load_dwordx4 v[36:39], v7, s[84:87], s29 offen offset:1024 sc1
s_mov_b64 exec, -1
s_branch mega_kernel_rs_pc_14_2
mega_kernel_rs_pc_14_2f:
s_mov_b64 exec, vcc
buffer_load_dwordx4 v[40:43], v7, s[84:87], s29 offen offset:2048 sc1
s_mov_b64 exec, -1
s_branch mega_kernel_rs_pc_14_3
mega_kernel_rs_pc_14_2:
s_waitcnt vmcnt(2)
v_cmp_eq_u32 vcc, -1, v40
s_cbranch_vccnz mega_kernel_rs_pc_14_2f
v_smfmac_f32_16x16x64_bf16 v[96:99], v[40:43], a[208:215], v6
v_smfmac_f32_16x16x64_bf16 v[100:103], v[40:43], a[240:247], v6
s_branch mega_kernel_rs_pc_10_3
mega_kernel_rs_pc_14_3f:
s_mov_b64 exec, vcc
buffer_load_dwordx4 v[44:47], v7, s[84:87], s29 offen offset:3072 sc1
s_mov_b64 exec, -1
s_branch mega_kernel_rs_pc_14_1
mega_kernel_rs_pc_14_3:
s_waitcnt vmcnt(2)
v_cmp_eq_u32 vcc, -1, v44
s_cbranch_vccnz mega_kernel_rs_pc_14_3f
v_smfmac_f32_16x16x64_bf16 v[96:99], v[44:47], a[216:223], v6
v_smfmac_f32_16x16x64_bf16 v[100:103], v[44:47], a[248:255], v6
s_branch mega_kernel_rs_pc_6_1
mega_kernel_rs_pc_15_0f:
s_mov_b64 exec, vcc
buffer_load_dwordx4 v[32:35], v7, s[84:87], s29 offen offset:0 sc1
s_mov_b64 exec, -1
s_branch mega_kernel_rs_pc_15_1
mega_kernel_rs_pc_15_1f:
s_mov_b64 exec, vcc
buffer_load_dwordx4 v[36:39], v7, s[84:87], s29 offen offset:1024 sc1
s_mov_b64 exec, -1
s_branch mega_kernel_rs_pc_15_2
mega_kernel_rs_pc_15_1:
s_waitcnt vmcnt(3)
v_cmp_eq_u32 vcc, -1, v36
s_cbranch_vccnz mega_kernel_rs_pc_15_1f
v_smfmac_f32_16x16x64_bf16 v[96:99], v[36:39], a[200:207], v6
v_smfmac_f32_16x16x64_bf16 v[100:103], v[36:39], a[232:239], v6
s_branch mega_kernel_rs_pc_13_2
mega_kernel_rs_pc_15_2f:
s_mov_b64 exec, vcc
buffer_load_dwordx4 v[40:43], v7, s[84:87], s29 offen offset:2048 sc1
s_mov_b64 exec, -1
s_branch mega_kernel_rs_pc_15_3
mega_kernel_rs_pc_15_2:
s_waitcnt vmcnt(3)
v_cmp_eq_u32 vcc, -1, v40
s_cbranch_vccnz mega_kernel_rs_pc_15_2f
v_smfmac_f32_16x16x64_bf16 v[96:99], v[40:43], a[208:215], v6
v_smfmac_f32_16x16x64_bf16 v[100:103], v[40:43], a[240:247], v6
s_branch mega_kernel_rs_pc_11_3
mega_kernel_rs_pc_15_3f:
s_mov_b64 exec, vcc
buffer_load_dwordx4 v[44:47], v7, s[84:87], s29 offen offset:3072 sc1
s_mov_b64 exec, -1
s_branch mega_kernel_rs_pc_15_0
mega_kernel_rs_pc_15_3:
s_waitcnt vmcnt(3)
v_cmp_eq_u32 vcc, -1, v44
s_cbranch_vccnz mega_kernel_rs_pc_15_3f
v_smfmac_f32_16x16x64_bf16 v[96:99], v[44:47], a[216:223], v6
v_smfmac_f32_16x16x64_bf16 v[100:103], v[44:47], a[248:255], v6
s_branch mega_kernel_rs_pc_7_0
mega_kernel_rs_w0last:
s_nop 7
v_permlane32_swap_b32 v112, v116
v_permlane32_swap_b32 v113, v117
v_permlane32_swap_b32 v114, v118
v_permlane32_swap_b32 v115, v119
v_pk_add_f32 v[112:113], v[112:113], v[116:117]
v_pk_add_f32 v[114:115], v[114:115], v[118:119]
ds_write_b128 v20, v[112:115]
s_waitcnt lgkmcnt(0)
s_barrier
s_branch mega_kernel_rs_end
mega_kernel_rs_side:
s_cmp_eq_u32 s24, 3
s_cbranch_scc1 mega_kernel_rs_sd3
s_cmp_eq_u32 s24, 2
s_cbranch_scc0 mega_kernel_rs_sd4
s_mov_b64 exec, s[40:41]
buffer_store_dwordx4 v[28:31], v11, s[84:87], s34 offen sc1
s_mov_b64 exec, -1
buffer_store_dwordx2 v[28:29], v9, s[84:87], s34 offen sc1
s_mul_i32 s28, s31, 2048
s_add_u32 s28, s28, s34
s_add_u32 s28, s28, 49152
buffer_store_dwordx4 v[28:31], v17, s[84:87], s28 offen sc1
buffer_store_dwordx4 v[28:31], v10, s[84:87], s28 offen sc1
s_branch mega_kernel_rs_sd4
mega_kernel_rs_sd3:
s_mov_b32 s36, 0
s_add_u32 s76, s27, 1
s_cmp_lt_u32 s76, 63
s_cbranch_scc0 mega_kernel_rs_sd4
s_cmp_ge_u32 s76, 0
s_cbranch_scc0 mega_kernel_rs_sd4
s_cmp_gt_i32 s46, s76
s_cselect_b32 s36, 0, 1
s_cbranch_scc0 mega_kernel_rs_sd4
s_add_u32 s77, s76, s82
s_bfe_u32 s28, s77, 0x40002
s_lshl_b32 s28, s28, 14
s_and_b32 s77, s77, 3
s_lshl_b32 s77, s77, 11
s_add_u32 s28, s28, s77
s_add_u32 m0, s45, 0
s_nop 0
buffer_load_dwordx4 v240, s[84:87], s28 offen offset:0 sc1 lds
s_add_u32 m0, s45, 0
s_nop 0
buffer_load_dwordx4 v240, s[84:87], s28 offen offset:1024 sc1 lds
s_add_u32 m0, s45, 2048
s_nop 0
buffer_load_dwordx4 v241, s[84:87], s28 offen offset:0 sc1 lds
s_add_u32 m0, s45, 2048
s_nop 0
buffer_load_dwordx4 v241, s[84:87], s28 offen offset:1024 sc1 lds
s_add_u32 s45, s45, 4096
s_cmp_eq_u32 s45, 30720
s_cselect_b32 s45, 18432, s45
mega_kernel_rs_sd4:
v_smfmac_f32_16x16x64_bf16 v[112:115], v[40:43], a[144:151], v6
v_smfmac_f32_16x16x64_bf16 v[116:119], v[40:43], a[176:183], v6
v_smfmac_f32_16x16x64_bf16 v[112:115], v[44:47], a[152:159], v6
v_smfmac_f32_16x16x64_bf16 v[116:119], v[44:47], a[184:191], v6
s_nop 7
v_permlane32_swap_b32 v112, v116
v_permlane32_swap_b32 v113, v117
v_permlane32_swap_b32 v114, v118
v_permlane32_swap_b32 v115, v119
v_pk_add_f32 v[112:113], v[112:113], v[116:117]
v_pk_add_f32 v[114:115], v[114:115], v[118:119]
ds_write_b128 v20, v[112:115]
v_mov_b32 v96, 0
v_mov_b32 v97, 0
v_mov_b32 v98, 0
v_mov_b32 v99, 0
v_mov_b32 v100, 0
v_mov_b32 v101, 0
v_mov_b32 v102, 0
v_mov_b32 v103, 0
s_cmp_eq_u32 s24, 1
s_cbranch_scc0 mega_kernel_rs_s1
s_waitcnt lgkmcnt(0)
ds_read_b128 v[120:123], v16 offset:0
ds_read_b128 v[124:127], v16 offset:16
ds_read_b128 v[128:131], v16 offset:2304
ds_read_b128 v[132:135], v16 offset:2320
ds_read_b128 v[136:139], v16 offset:4608
ds_read_b128 v[140:143], v16 offset:4624
ds_read_b128 v[144:147], v16 offset:6912
ds_read_b128 v[148:151], v16 offset:6928
s_waitcnt lgkmcnt(4)
v_pk_add_f32 v[120:121], v[120:121], v[128:129]
v_pk_add_f32 v[122:123], v[122:123], v[130:131]
v_pk_add_f32 v[124:125], v[124:125], v[132:133]
v_pk_add_f32 v[126:127], v[126:127], v[134:135]
s_waitcnt lgkmcnt(0)
v_pk_add_f32 v[136:137], v[136:137], v[144:145]
v_pk_add_f32 v[138:139], v[138:139], v[146:147]
v_pk_add_f32 v[140:141], v[140:141], v[148:149]
v_pk_add_f32 v[142:143], v[142:143], v[150:151]
v_pk_add_f32 v[120:121], v[120:121], v[136:137]
v_pk_add_f32 v[122:123], v[122:123], v[138:139]
v_pk_add_f32 v[124:125], v[124:125], v[140:141]
v_pk_add_f32 v[126:127], v[126:127], v[142:143]
v_cvt_pk_bf16_f32 v244, v120, v121
v_cvt_pk_bf16_f32 v245, v122, v123
v_cvt_pk_bf16_f32 v246, v124, v125
v_cvt_pk_bf16_f32 v247, v126, v127
mega_kernel_rs_s1:
v_add_u32 v5, 9216, v17
s_waitcnt lgkmcnt(0)
s_barrier
s_cmp_eq_u32 s24, 2
s_cbranch_scc1 mega_kernel_rs_s2
s_cmp_eq_u32 s24, 3
s_cbranch_scc0 mega_kernel_rs_s3
s_add_u32 s76, s27, 2
s_cmp_lt_u32 s76, 63
s_cbranch_scc0 mega_kernel_rs_s3
s_cmp_gt_i32 s46, s76
s_cbranch_scc0 mega_kernel_rs_s3
s_add_u32 s77, s76, s82
s_bfe_u32 s28, s77, 0x40002
s_lshl_b32 s28, s28, 14
s_and_b32 s77, s77, 3
s_lshl_b32 s77, s77, 11
s_add_u32 s28, s28, s77
s_add_u32 s28, s28, s83
s_buffer_load_dword s78, s[84:87], s28 offset:0
s_buffer_load_dword s78, s[84:87], s28 offset:128
s_buffer_load_dword s78, s[84:87], s28 offset:256
s_buffer_load_dword s78, s[84:87], s28 offset:384
s_buffer_load_dword s78, s[84:87], s28 offset:512
s_buffer_load_dword s78, s[84:87], s28 offset:640
s_buffer_load_dword s78, s[84:87], s28 offset:768
s_buffer_load_dword s78, s[84:87], s28 offset:896
s_buffer_load_dword s78, s[84:87], s28 offset:1024
s_buffer_load_dword s78, s[84:87], s28 offset:1152
s_buffer_load_dword s78, s[84:87], s28 offset:1280
s_buffer_load_dword s78, s[84:87], s28 offset:1408
s_buffer_load_dword s78, s[84:87], s28 offset:1536
s_buffer_load_dword s78, s[84:87], s28 offset:1664
s_buffer_load_dword s78, s[84:87], s28 offset:1792
s_buffer_load_dword s78, s[84:87], s28 offset:1920
s_mov_b32 s88, s76
s_branch mega_kernel_rs_s3
mega_kernel_rs_s2:
ds_read_b128 v[120:123], v5 offset:0
ds_read_b128 v[124:127], v5 offset:1024
ds_read_b128 v[128:131], v5 offset:2048
ds_read_b128 v[132:135], v5 offset:3072
v_lshrrev_b32 v5, 1, v17
s_waitcnt lgkmcnt(2)
v_pk_add_f32 v[120:121], v[120:121], v[124:125]
v_pk_add_f32 v[122:123], v[122:123], v[126:127]
s_waitcnt lgkmcnt(0)
v_pk_add_f32 v[128:129], v[128:129], v[132:133]
v_pk_add_f32 v[130:131], v[130:131], v[134:135]
v_pk_add_f32 v[120:121], v[120:121], v[128:129]
v_pk_add_f32 v[122:123], v[122:123], v[130:131]
v_cvt_pk_bf16_f32 v244, v120, v121
v_cvt_pk_bf16_f32 v245, v122, v123
ds_write_b64 v5, v[244:245] offset:17920
s_waitcnt lgkmcnt(0) vmcnt(0)
mega_kernel_rs_s3:
s_cmp_eq_u32 s27, 63
s_cbranch_scc1 mega_kernel_rs_slast
s_add_u32 s29, s33, 24576
s_barrier
s_cmp_eq_u32 s24, 3
s_cbranch_scc1 mega_kernel_rs_y3
s_add_u32 s77, s27, s82
s_bfe_u32 s28, s77, 0x30003
s_lshl_b32 s28, s28, 14
s_and_b32 s77, s77, 7
s_lshl_b32 s77, s77, 10
s_add_u32 s28, s28, s77
s_add_u32 s28, s28, s79
s_cmp_eq_u32 s24, 2
s_cbranch_scc1 mega_kernel_rs_kv2a
s_mov_b64 exec, s[48:49]
buffer_store_dwordx4 v[244:247], v22, s[84:87], s28 offen sc1
s_mov_b64 exec, -1
s_branch mega_kernel_rs_kvda
mega_kernel_rs_kv2a:
v_lshlrev_b32 v4, 3, v1
buffer_store_dwordx2 v[244:245], v4, s[84:87], s28 offen offset:512 sc1
mega_kernel_rs_kvda:
s_branch mega_kernel_rs_y4
mega_kernel_rs_y3:
s_add_u32 s76, s27, 2
s_cmp_lt_u32 s76, 63
s_cbranch_scc0 mega_kernel_rs_y4
mega_kernel_rs_y4:
s_branch mega_kernel_rs_b3
mega_kernel_rs_first:
buffer_load_dwordx4 v[32:35], v8, s[20:23], 0 offen offset:0
buffer_load_dwordx4 v[36:39], v8, s[20:23], 0 offen offset:128
buffer_load_dwordx4 v[40:43], v8, s[20:23], 0 offen offset:256
buffer_load_dwordx4 v[44:47], v8, s[20:23], 0 offen offset:384
v_add_u32 v5, s44, v17
ds_read_b128 v[156:159], v5 offset:0
ds_read_b128 v[160:163], v5 offset:1024
ds_read_b128 v[164:167], v5 offset:2048
ds_read_b128 v[168:171], v5 offset:3072
s_waitcnt vmcnt(0)
v_smfmac_f32_16x16x64_bf16 v[96:99], v[32:35], a[0:7], v6
v_smfmac_f32_16x16x64_bf16 v[100:103], v[32:35], a[32:39], v6
v_smfmac_f32_16x16x64_bf16 v[104:107], v[32:35], a[64:71], v6
v_smfmac_f32_16x16x64_bf16 v[108:111], v[32:35], a[96:103], v6
v_smfmac_f32_16x16x64_bf16 v[96:99], v[36:39], a[8:15], v6
v_smfmac_f32_16x16x64_bf16 v[100:103], v[36:39], a[40:47], v6
v_smfmac_f32_16x16x64_bf16 v[104:107], v[36:39], a[72:79], v6
v_smfmac_f32_16x16x64_bf16 v[108:111], v[36:39], a[104:111], v6
v_smfmac_f32_16x16x64_bf16 v[96:99], v[40:43], a[16:23], v6
v_smfmac_f32_16x16x64_bf16 v[100:103], v[40:43], a[48:55], v6
v_smfmac_f32_16x16x64_bf16 v[104:107], v[40:43], a[80:87], v6
v_smfmac_f32_16x16x64_bf16 v[108:111], v[40:43], a[112:119], v6
v_smfmac_f32_16x16x64_bf16 v[96:99], v[44:47], a[24:31], v6
v_smfmac_f32_16x16x64_bf16 v[100:103], v[44:47], a[56:63], v6
v_smfmac_f32_16x16x64_bf16 v[104:107], v[44:47], a[88:95], v6
v_smfmac_f32_16x16x64_bf16 v[108:111], v[44:47], a[120:127], v6
s_nop 1
s_branch mega_kernel_rs_adone
mega_kernel_rs_slast:
s_cmp_eq_u32 s24, 3
s_cbranch_scc1 mega_kernel_rs_end
s_add_u32 s77, s27, s82
s_bfe_u32 s28, s77, 0x30003
s_lshl_b32 s28, s28, 14
s_and_b32 s77, s77, 7
s_lshl_b32 s77, s77, 10
s_add_u32 s28, s28, s77
s_add_u32 s28, s28, s79
s_cmp_eq_u32 s24, 2
s_cbranch_scc1 mega_kernel_rs_kv2b
s_mov_b64 exec, s[48:49]
buffer_store_dwordx4 v[244:247], v22, s[84:87], s28 offen sc1
s_mov_b64 exec, -1
s_branch mega_kernel_rs_kvdb
mega_kernel_rs_kv2b:
v_lshlrev_b32 v4, 3, v1
buffer_store_dwordx2 v[244:245], v4, s[84:87], s28 offen offset:512 sc1
mega_kernel_rs_kvdb:
s_waitcnt vmcnt(0)
s_barrier
s_mov_b32 s76, 64
s_cmp_eq_u32 s24, 1
s_cbranch_scc0 mega_kernel_rs_end
v_mov_b32 v5, s76
s_mov_b64 exec, 1
buffer_store_dword v5, v228, s[84:87], s81 offen sc1
s_mov_b64 exec, -1
mega_kernel_rs_end:
s_endpgm
.section .rodata,"a"
.p2align 6
.amdhsa_kernel mega_kernel
  .amdhsa_next_free_vgpr 512
  .amdhsa_next_free_sgpr 102
  .amdhsa_accum_offset 256
  .amdhsa_group_segment_fixed_size 0
  .amdhsa_kernarg_size 104
  .amdhsa_user_sgpr_count 2
  .amdhsa_user_sgpr_kernarg_segment_ptr 1
  .amdhsa_system_sgpr_workgroup_id_x 1
.end_amdhsa_kernel
```

```asm
; @launch kernel=mega_kernel grid=(256,1,1) block=(256,1,1) lds=163840
.amdgcn_target "amdgcn-amd-amdhsa--gfx950"
.text
.globl mega_kernel
.p2align 8
.type mega_kernel,@function
mega_kernel:
s_cmp_ge_u32 s2, 256
s_cbranch_scc1 mega_kernel_exit
s_load_dwordx2 s[84:85], s[0:1], 96
s_load_dwordx2 s[72:73], s[0:1], 88
s_getreg_b32 s90, hwreg(HW_REG_XCC_ID)
s_and_b32 s90, s90, 7
v_mov_b32 v1, 0
v_mov_b32 v2, 1
s_lshl_b32 s91, s90, 4
s_mov_b32 s95, 0
s_mov_b32 s99, 0
s_waitcnt lgkmcnt(0)
s_mov_b32 s86, 268435456
s_mov_b32 s87, 0x00020000
s_mov_b32 s74, 256
s_mov_b32 s75, 0x00020000
v_cmp_eq_u32 vcc, 0, v0
s_and_saveexec_b64 s[88:89], vcc
s_cbranch_execz mega_kernel_tkd
s_lshl_b32 s92, s2, 13
s_add_u32 s92, s92, 167772160
buffer_atomic_add v2, v1, s[72:75], s91 offen sc0
buffer_load_dword v251, v1, s[84:87], s92 offen offset:2048 sc1
s_waitcnt vmcnt(1)
ds_write_b32 v1, v2
s_waitcnt lgkmcnt(0)
mega_kernel_tkd:
s_mov_b64 exec, s[88:89]
s_barrier
ds_read_b32 v2, v1
s_waitcnt lgkmcnt(0)
v_readfirstlane_b32 s96, v2
s_barrier
s_cmp_lt_u32 s96, 32
s_cbranch_scc1 mega_kernel_spec
v_and_b32 v3, 15, v0
v_lshlrev_b32 v3, 4, v3
s_branch mega_kernel_syx
mega_kernel_syxw:
s_sleep 4
mega_kernel_syx:
buffer_load_dword v2, v3, s[72:75], 0 offen sc1
s_waitcnt vmcnt(0)
s_cmp_eq_u32 s95, 1
s_cbranch_scc0 mega_kernel_syxf
v_readlane_b32 s76, v2, 14
s_mov_b32 s98, 0
s_cmp_eq_u32 s76, 64
s_cbranch_scc0 mega_kernel_syxw
s_branch mega_kernel_syxd
mega_kernel_syxf:
s_mov_b32 s77, 0
s_mov_b32 s78, 0
v_readlane_b32 s76, v2, 0
s_add_u32 s77, s77, s76
s_xor_b32 s76, s76, 32
s_or_b32 s78, s78, s76
v_readlane_b32 s76, v2, 1
s_add_u32 s77, s77, s76
s_xor_b32 s76, s76, 32
s_or_b32 s78, s78, s76
v_readlane_b32 s76, v2, 2
s_add_u32 s77, s77, s76
s_xor_b32 s76, s76, 32
s_or_b32 s78, s78, s76
v_readlane_b32 s76, v2, 3
s_add_u32 s77, s77, s76
s_xor_b32 s76, s76, 32
s_or_b32 s78, s78, s76
v_readlane_b32 s76, v2, 4
s_add_u32 s77, s77, s76
s_xor_b32 s76, s76, 32
s_or_b32 s78, s78, s76
v_readlane_b32 s76, v2, 5
s_add_u32 s77, s77, s76
s_xor_b32 s76, s76, 32
s_or_b32 s78, s78, s76
v_readlane_b32 s76, v2, 6
s_add_u32 s77, s77, s76
s_xor_b32 s76, s76, 32
s_or_b32 s78, s78, s76
v_readlane_b32 s76, v2, 7
s_add_u32 s77, s77, s76
s_xor_b32 s76, s76, 32
s_or_b32 s78, s78, s76
s_cmp_eq_u32 s77, 256
s_cbranch_scc0 mega_kernel_syxw
v_mov_b32 v252, v2
s_cmp_eq_u32 s78, 0
s_cbranch_scc0 mega_kernel_slowent
v_readlane_b32 s76, v2, 10
v_readlane_b32 s77, v2, 8
s_cmp_eq_u32 s76, 64
s_cbranch_scc0 mega_kernel_syxw
s_cmp_gt_u32 s77, 32
s_cselect_b32 s98, 1, 0
mega_kernel_syxd:
mega_kernel_slowent:
s_mov_b64 exec, -1
s_waitcnt vmcnt(0) lgkmcnt(0)
s_barrier
s_mov_b32 s97, s96
v_readlane_b32 s76, v252, 0
s_cmp_gt_u32 s90, 0
s_cselect_b32 s76, s76, 0
s_add_u32 s97, s97, s76
v_readlane_b32 s76, v252, 1
s_cmp_gt_u32 s90, 1
s_cselect_b32 s76, s76, 0
s_add_u32 s97, s97, s76
v_readlane_b32 s76, v252, 2
s_cmp_gt_u32 s90, 2
s_cselect_b32 s76, s76, 0
s_add_u32 s97, s97, s76
v_readlane_b32 s76, v252, 3
s_cmp_gt_u32 s90, 3
s_cselect_b32 s76, s76, 0
s_add_u32 s97, s97, s76
v_readlane_b32 s76, v252, 4
s_cmp_gt_u32 s90, 4
s_cselect_b32 s76, s76, 0
s_add_u32 s97, s97, s76
v_readlane_b32 s76, v252, 5
s_cmp_gt_u32 s90, 5
s_cselect_b32 s76, s76, 0
s_add_u32 s97, s97, s76
v_readlane_b32 s76, v252, 6
s_cmp_gt_u32 s90, 6
s_cselect_b32 s76, s76, 0
s_add_u32 s97, s97, s76
v_mov_b32 v1, 0
v_mov_b32 v2, 1
v_cmp_eq_u32 vcc, 0, v0
s_and_saveexec_b64 s[88:89], vcc
s_cbranch_execz mega_kernel_sb1
buffer_atomic_add v2, v1, s[72:75], 0 offen offset:192 sc1
mega_kernel_sb1:
s_mov_b64 exec, s[88:89]
mega_kernel_sb2:
s_sleep 4
buffer_load_dword v2, v1, s[72:75], 0 offen offset:192 sc1
s_waitcnt vmcnt(0)
v_cmp_ne_u32 vcc, 256, v2
s_cbranch_vccnz mega_kernel_sb2
s_mov_b32 s95, 1
s_lshr_b32 s30, s97, 5
s_and_b32 s31, s97, 31
s_cmp_lt_u32 s97, 128
s_cbranch_scc1 mega_kernel_recs
s_sub_u32 s94, s97, 128
s_branch mega_kernel_bulk
mega_kernel_spec:
s_mov_b32 s30, s90
s_mov_b32 s31, s96
s_cmp_lt_u32 s90, 4
s_cbranch_scc1 mega_kernel_recf
s_sub_u32 s94, s90, 4
s_lshl_b32 s94, s94, 5
s_add_u32 s94, s94, s96
mega_kernel_bulk:
s_lshr_b32 s91, s94, 5
s_and_b32 s40, s94, 31
s_and_b32 s92, s91, 1
s_lshl_b32 s92, s92, 5
s_add_u32 s92, s92, s40
s_cmp_eq_u32 s91, 0
s_cbranch_scc1 mega_kernel_rk
s_cmp_eq_u32 s91, 1
s_cbranch_scc1 mega_kernel_rv
v_mov_b32 v8, -1
v_mov_b32 v9, -1
v_mov_b32 v10, -1
v_mov_b32 v11, -1
v_lshlrev_b32 v1, 4, v0
v_mov_b32 v2, 0
v_cmp_gt_u32 vcc, 64, v0
s_cbranch_vccz mega_kernel_nv
s_cmp_eq_u32 s95, 0
s_cbranch_scc0 mega_kernel_nv
s_lshr_b32 s60, s2, 1
s_lshl_b32 s60, s60, 14
s_and_b32 s61, s92, 1
s_lshl_b32 s66, s61, 13
s_add_u32 s60, s60, s66
s_and_b32 s66, s2, 1
s_lshl_b32 s66, s66, 10
s_add_u32 s60, s60, s66
s_add_u32 s60, s60, 167772160
s_mov_b32 s66, 0x7fffffff
s_mov_b32 s67, 0x7fffffff
s_mov_b64 exec, 0xff
s_waitcnt vmcnt(0)
s_memtime s[62:63]
s_waitcnt lgkmcnt(0)
buffer_store_dwordx4 v[8:11], v1, s[84:87], s60 offen offset:0 sc1
s_waitcnt vmcnt(0)
s_memtime s[64:65]
s_xor_b32 s60, s60, 8192
s_waitcnt lgkmcnt(0)
s_sub_u32 s64, s64, s62
s_min_u32 s66, s66, s64
s_memtime s[62:63]
s_waitcnt lgkmcnt(0)
buffer_store_dwordx4 v[8:11], v1, s[84:87], s60 offen offset:0 sc1
s_waitcnt vmcnt(0)
s_memtime s[64:65]
s_xor_b32 s60, s60, 8192
s_waitcnt lgkmcnt(0)
s_sub_u32 s64, s64, s62
s_min_u32 s67, s67, s64
s_memtime s[62:63]
s_waitcnt lgkmcnt(0)
buffer_store_dwordx4 v[8:11], v1, s[84:87], s60 offen offset:256 sc1
s_waitcnt vmcnt(0)
s_memtime s[64:65]
s_xor_b32 s60, s60, 8192
s_waitcnt lgkmcnt(0)
s_sub_u32 s64, s64, s62
s_min_u32 s66, s66, s64
s_memtime s[62:63]
s_waitcnt lgkmcnt(0)
buffer_store_dwordx4 v[8:11], v1, s[84:87], s60 offen offset:256 sc1
s_waitcnt vmcnt(0)
s_memtime s[64:65]
s_xor_b32 s60, s60, 8192
s_waitcnt lgkmcnt(0)
s_sub_u32 s64, s64, s62
s_min_u32 s67, s67, s64
s_cmp_lt_u32 s67, s66
s_cselect_b32 s60, 1, 0
s_xor_b32 s60, s60, s61
s_lshr_b32 s61, s90, 2
s_xor_b32 s60, s60, s61
v_mov_b32 v3, s60
s_mov_b64 exec, 1
buffer_atomic_add v3, v2, s[72:75], 0 offen offset:128 sc1
s_mov_b64 exec, -1
mega_kernel_nv:
s_barrier
s_lshl_b32 s60, s92, 12
s_add_u32 s60, s60, 67108864
buffer_store_dwordx4 v[8:11], v1, s[84:87], s60 offen sc1
s_add_u32 s60, s60, 262144
buffer_store_dwordx4 v[8:11], v1, s[84:87], s60 offen sc1
s_add_u32 s60, s60, 262144
buffer_store_dwordx4 v[8:11], v1, s[84:87], s60 offen sc1
s_add_u32 s60, s60, 262144
buffer_store_dwordx4 v[8:11], v1, s[84:87], s60 offen sc1
s_add_u32 s60, s60, 262144
buffer_store_dwordx4 v[8:11], v1, s[84:87], s60 offen sc1
s_add_u32 s60, s60, 262144
buffer_store_dwordx4 v[8:11], v1, s[84:87], s60 offen sc1
s_add_u32 s60, s60, 262144
buffer_store_dwordx4 v[8:11], v1, s[84:87], s60 offen sc1
s_add_u32 s60, s60, 262144
buffer_store_dwordx4 v[8:11], v1, s[84:87], s60 offen sc1
s_add_u32 s60, s60, 262144
s_lshr_b32 s62, s92, 1
s_and_b32 s63, s92, 1
s_add_u32 s63, s63, s62
s_lshl_b32 s62, s62, 19
s_and_b32 s64, s63, 14
s_lshl_b32 s64, s64, 13
s_add_u32 s62, s62, s64
s_and_b32 s64, s63, 1
s_lshl_b32 s64, s64, 12
s_add_u32 s62, s62, s64
s_add_u32 s62, s62, 150994944
s_add_u32 s62, s62, 8192
s_cmp_lt_u32 s92, 16
s_cbranch_scc0 mega_kernel_pz
buffer_store_dwordx4 v[8:11], v1, s[84:87], s60 offen sc1
mega_kernel_pz:
s_waitcnt vmcnt(0)
s_barrier
v_mov_b32 v3, 1
s_lshl_b32 s62, s95, 6
v_cmp_eq_u32 vcc, 0, v0
s_and_saveexec_b64 s[60:61], vcc
s_cbranch_execz mega_kernel_xps
buffer_atomic_add v3, v2, s[72:75], s62 offen offset:160 sc1
mega_kernel_xps:
s_mov_b64 exec, s[60:61]
s_cmp_eq_u32 s91, 2
s_cbranch_scc0 mega_kernel_rd
v_and_b32 v3, 15, v0
v_lshlrev_b32 v3, 4, v3
s_branch mega_kernel_syc
mega_kernel_sycw:
s_sleep 4
mega_kernel_syc:
buffer_load_dword v2, v3, s[72:75], 0 offen sc1
s_waitcnt vmcnt(0)
s_cmp_eq_u32 s95, 1
s_cbranch_scc0 mega_kernel_sycf
v_readlane_b32 s76, v2, 14
s_mov_b32 s98, 0
s_cmp_eq_u32 s76, 64
s_cbranch_scc0 mega_kernel_sycw
s_branch mega_kernel_sycd
mega_kernel_sycf:
s_mov_b32 s77, 0
s_mov_b32 s78, 0
v_readlane_b32 s76, v2, 0
s_add_u32 s77, s77, s76
s_xor_b32 s76, s76, 32
s_or_b32 s78, s78, s76
v_readlane_b32 s76, v2, 1
s_add_u32 s77, s77, s76
s_xor_b32 s76, s76, 32
s_or_b32 s78, s78, s76
v_readlane_b32 s76, v2, 2
s_add_u32 s77, s77, s76
s_xor_b32 s76, s76, 32
s_or_b32 s78, s78, s76
v_readlane_b32 s76, v2, 3
s_add_u32 s77, s77, s76
s_xor_b32 s76, s76, 32
s_or_b32 s78, s78, s76
v_readlane_b32 s76, v2, 4
s_add_u32 s77, s77, s76
s_xor_b32 s76, s76, 32
s_or_b32 s78, s78, s76
v_readlane_b32 s76, v2, 5
s_add_u32 s77, s77, s76
s_xor_b32 s76, s76, 32
s_or_b32 s78, s78, s76
v_readlane_b32 s76, v2, 6
s_add_u32 s77, s77, s76
s_xor_b32 s76, s76, 32
s_or_b32 s78, s78, s76
v_readlane_b32 s76, v2, 7
s_add_u32 s77, s77, s76
s_xor_b32 s76, s76, 32
s_or_b32 s78, s78, s76
s_cmp_eq_u32 s77, 256
s_cbranch_scc0 mega_kernel_sycw
v_mov_b32 v252, v2
s_cmp_eq_u32 s78, 0
s_cbranch_scc0 mega_kernel_slowent
v_readlane_b32 s76, v2, 10
v_readlane_b32 s77, v2, 8
s_cmp_eq_u32 s76, 64
s_cbranch_scc0 mega_kernel_sycw
s_cmp_gt_u32 s77, 32
s_cselect_b32 s98, 1, 0
mega_kernel_sycd:
s_load_dwordx2 s[4:5], s[0:1], 16
s_load_dwordx2 s[8:9], s[0:1], 0
v_lshrrev_b32 v2, 6, v0
v_and_b32 v1, 63, v0
v_readfirstlane_b32 s41, v2
v_lshlrev_b32 v5, 4, v1
s_waitcnt lgkmcnt(0)
s_mov_b32 s6, 8388608
s_mov_b32 s7, 0x00020000
s_mov_b32 s10, 4194304
s_mov_b32 s11, 0x00020000
s_lshl_b32 s43, s40, 8
s_lshl_b32 s44, s41, 6
s_add_u32 s48, s43, s44
s_and_b32 s43, s48, 0x7ff
v_add_u32 v19, s43, v1
v_lshlrev_b32 v19, 7, v19
buffer_load_dword v250, v19, s[8:11], 0 offen
s_nop 0
v_lshrrev_b32 v2, 3, v1
s_lshl_b32 s43, s41, 3
v_add_u32 v2, s43, v2
v_bfe_u32 v3, v2, 1, 3
v_and_b32 v4, 7, v1
v_xor_b32 v3, v3, v4
v_lshlrev_b32 v6, 11, v2
v_lshl_add_u32 v6, v3, 4, v6
s_lshl_b32 s46, s41, 10
v_and_b32 v2, 15, v1
v_bfe_u32 v3, v2, 1, 3
v_lshrrev_b32 v4, 4, v1
v_xor_b32 v3, v3, v4
v_lshlrev_b32 v8, 7, v2
v_lshl_add_u32 v8, v3, 4, v8
v_xor_b32 v9, 64, v8
v_add_u32 v10, 0x10000, v8
v_add_u32 v11, 0x10000, v9
v_mov_b32 v7, v5
s_lshl_b32 s47, s40, 2
s_add_u32 s47, s47, s41
s_mov_b32 s42, 0
s_mov_b32 s50, 0
s_add_u32 m0, s46, 0
s_nop 0
buffer_load_dwordx4 v6, s[8:11], s50 offen offset:0 lds
s_add_u32 m0, s46, 3968
s_nop 0
buffer_load_dwordx4 v6, s[8:11], s50 offen offset:128 lds
s_add_u32 m0, s46, 7936
s_nop 0
buffer_load_dwordx4 v6, s[8:11], s50 offen offset:256 lds
s_add_u32 m0, s46, 11904
s_nop 0
buffer_load_dwordx4 v6, s[8:11], s50 offen offset:384 lds
s_add_u32 m0, s46, 15872
s_nop 0
buffer_load_dwordx4 v6, s[8:11], s50 offen offset:512 lds
s_add_u32 m0, s46, 19840
s_nop 0
buffer_load_dwordx4 v6, s[8:11], s50 offen offset:640 lds
s_add_u32 m0, s46, 23808
s_nop 0
buffer_load_dwordx4 v6, s[8:11], s50 offen offset:768 lds
s_add_u32 m0, s46, 27776
s_nop 0
buffer_load_dwordx4 v6, s[8:11], s50 offen offset:896 lds
s_add_u32 m0, s46, 31744
s_nop 0
buffer_load_dwordx4 v6, s[8:11], s50 offen offset:1024 lds
s_add_u32 m0, s46, 35712
s_nop 0
buffer_load_dwordx4 v6, s[8:11], s50 offen offset:1152 lds
s_add_u32 m0, s46, 39680
s_nop 0
buffer_load_dwordx4 v6, s[8:11], s50 offen offset:1280 lds
s_add_u32 m0, s46, 43648
s_nop 0
buffer_load_dwordx4 v6, s[8:11], s50 offen offset:1408 lds
s_add_u32 m0, s46, 47616
s_nop 0
buffer_load_dwordx4 v6, s[8:11], s50 offen offset:1536 lds
s_add_u32 m0, s46, 51584
s_nop 0
buffer_load_dwordx4 v6, s[8:11], s50 offen offset:1664 lds
s_add_u32 m0, s46, 55552
s_nop 0
buffer_load_dwordx4 v6, s[8:11], s50 offen offset:1792 lds
s_add_u32 m0, s46, 59520
s_nop 0
buffer_load_dwordx4 v6, s[8:11], s50 offen offset:1920 lds
v_lshrrev_b32 v2, 2, v1
v_and_b32 v3, 3, v1
v_lshlrev_b32 v16, 13, v2
v_lshl_add_u32 v16, v3, 4, v16
v_add_u32 v16, s48, v16
s_mul_i32 s45, s41, 24576
s_add_u32 s45, s45, 65536
v_bfe_u32 v17, v1, 2, 2
v_lshrrev_b32 v18, 4, v1
v_lshl_add_u32 v17, v18, 3, v17
v_lshlrev_b32 v17, 6, v17
v_lshl_add_u32 v17, v3, 4, v17
v_add_u32 v17, s45, v17
s_and_b32 s43, s40, 3
s_lshl_b32 s43, s43, 2
s_add_u32 s43, s43, s41
s_lshl_b32 s43, s43, 3
v_and_b32 v12, 7, v1
v_add_u32 v12, s43, v12
s_lshr_b32 s43, s40, 2
s_lshl_b32 s43, s43, 10
s_add_u32 s44, s43, 896
s_add_u32 s43, s43, 384
s_cmp_ge_u32 s40, 28
s_cselect_b32 s44, s44, s43
v_mov_b32 v13, s43
v_mov_b32 v14, s44
v_cmp_gt_u32 vcc, 32, v1
s_nop 1
v_cndmask_b32 v13, v14, v13, vcc
v_lshl_add_u32 v12, v12, 13, v13
s_mov_b32 s44, 0
buffer_load_dword v250, v12, s[4:7], s44 offen
s_add_u32 m0, s45, 0
s_mov_b32 s44, 0
buffer_load_dwordx4 v16, s[4:7], s44 offen lds
s_add_u32 m0, s45, 1024
s_mov_b32 s44, 131072
buffer_load_dwordx4 v16, s[4:7], s44 offen lds
s_add_u32 m0, s45, 2048
s_mov_b32 s44, 262144
buffer_load_dwordx4 v16, s[4:7], s44 offen lds
s_add_u32 m0, s45, 3072
s_mov_b32 s44, 393216
buffer_load_dwordx4 v16, s[4:7], s44 offen lds
s_add_u32 m0, s45, 4096
s_mov_b32 s44, 524288
buffer_load_dwordx4 v16, s[4:7], s44 offen lds
s_add_u32 m0, s45, 5120
s_mov_b32 s44, 655360
buffer_load_dwordx4 v16, s[4:7], s44 offen lds
s_add_u32 m0, s45, 6144
s_mov_b32 s44, 786432
buffer_load_dwordx4 v16, s[4:7], s44 offen lds
s_add_u32 m0, s45, 7168
s_mov_b32 s44, 917504
buffer_load_dwordx4 v16, s[4:7], s44 offen lds
s_mov_b32 s44, 1048576
buffer_load_dword v250, v12, s[4:7], s44 offen
s_add_u32 m0, s45, 8192
s_mov_b32 s44, 1048576
buffer_load_dwordx4 v16, s[4:7], s44 offen lds
s_add_u32 m0, s45, 9216
s_mov_b32 s44, 1179648
buffer_load_dwordx4 v16, s[4:7], s44 offen lds
s_add_u32 m0, s45, 10240
s_mov_b32 s44, 1310720
buffer_load_dwordx4 v16, s[4:7], s44 offen lds
s_add_u32 m0, s45, 11264
s_mov_b32 s44, 1441792
buffer_load_dwordx4 v16, s[4:7], s44 offen lds
s_add_u32 m0, s45, 12288
s_mov_b32 s44, 1572864
buffer_load_dwordx4 v16, s[4:7], s44 offen lds
s_add_u32 m0, s45, 13312
s_mov_b32 s44, 1703936
buffer_load_dwordx4 v16, s[4:7], s44 offen lds
s_add_u32 m0, s45, 14336
s_mov_b32 s44, 1835008
buffer_load_dwordx4 v16, s[4:7], s44 offen lds
s_add_u32 m0, s45, 15360
s_mov_b32 s44, 1966080
buffer_load_dwordx4 v16, s[4:7], s44 offen lds
s_mov_b32 s44, 2097152
buffer_load_dword v250, v12, s[4:7], s44 offen
s_add_u32 m0, s45, 16384
s_mov_b32 s44, 2097152
buffer_load_dwordx4 v16, s[4:7], s44 offen lds
s_add_u32 m0, s45, 17408
s_mov_b32 s44, 2228224
buffer_load_dwordx4 v16, s[4:7], s44 offen lds
s_add_u32 m0, s45, 18432
s_mov_b32 s44, 2359296
buffer_load_dwordx4 v16, s[4:7], s44 offen lds
s_add_u32 m0, s45, 19456
s_mov_b32 s44, 2490368
buffer_load_dwordx4 v16, s[4:7], s44 offen lds
s_add_u32 m0, s45, 20480
s_mov_b32 s44, 2621440
buffer_load_dwordx4 v16, s[4:7], s44 offen lds
s_add_u32 m0, s45, 21504
s_mov_b32 s44, 2752512
buffer_load_dwordx4 v16, s[4:7], s44 offen lds
s_add_u32 m0, s45, 22528
s_mov_b32 s44, 2883584
buffer_load_dwordx4 v16, s[4:7], s44 offen lds
s_add_u32 m0, s45, 23552
s_mov_b32 s44, 3014656
buffer_load_dwordx4 v16, s[4:7], s44 offen lds
s_waitcnt vmcnt(18)
s_barrier
ds_read_b64_tr_b16 a[0:1], v17 offset:0
ds_read_b64_tr_b16 a[2:3], v17 offset:256
ds_read_b64_tr_b16 a[4:5], v17 offset:8
ds_read_b64_tr_b16 a[6:7], v17 offset:264
ds_read_b64_tr_b16 a[8:9], v17 offset:2048
ds_read_b64_tr_b16 a[10:11], v17 offset:2304
ds_read_b64_tr_b16 a[12:13], v17 offset:2056
ds_read_b64_tr_b16 a[14:15], v17 offset:2312
s_waitcnt lgkmcnt(0)
ds_read_b64_tr_b16 a[16:17], v17 offset:4096
ds_read_b64_tr_b16 a[18:19], v17 offset:4352
ds_read_b64_tr_b16 a[20:21], v17 offset:4104
ds_read_b64_tr_b16 a[22:23], v17 offset:4360
ds_read_b64_tr_b16 a[24:25], v17 offset:6144
ds_read_b64_tr_b16 a[26:27], v17 offset:6400
ds_read_b64_tr_b16 a[28:29], v17 offset:6152
ds_read_b64_tr_b16 a[30:31], v17 offset:6408
s_waitcnt lgkmcnt(0)
ds_read_b128 v[20:23], v8 offset:0
ds_read_b128 v[24:27], v8 offset:2048
ds_read_b128 v[28:31], v9 offset:0
ds_read_b128 v[32:35], v9 offset:2048
ds_read_b128 v[36:39], v8 offset:4096
ds_read_b128 v[40:43], v8 offset:6144
ds_read_b128 v[44:47], v9 offset:4096
ds_read_b128 v[48:51], v9 offset:6144
s_mov_b32 s44, 3145728
buffer_load_dword v250, v12, s[4:7], s44 offen
s_add_u32 m0, s45, 0
s_mov_b32 s44, 3145728
buffer_load_dwordx4 v16, s[4:7], s44 offen lds
s_add_u32 m0, s45, 1024
s_mov_b32 s44, 3276800
buffer_load_dwordx4 v16, s[4:7], s44 offen lds
s_add_u32 m0, s45, 2048
s_mov_b32 s44, 3407872
buffer_load_dwordx4 v16, s[4:7], s44 offen lds
s_add_u32 m0, s45, 3072
s_mov_b32 s44, 3538944
buffer_load_dwordx4 v16, s[4:7], s44 offen lds
s_add_u32 m0, s45, 4096
s_mov_b32 s44, 3670016
buffer_load_dwordx4 v16, s[4:7], s44 offen lds
s_add_u32 m0, s45, 5120
s_mov_b32 s44, 3801088
buffer_load_dwordx4 v16, s[4:7], s44 offen lds
s_add_u32 m0, s45, 6144
s_mov_b32 s44, 3932160
buffer_load_dwordx4 v16, s[4:7], s44 offen lds
s_add_u32 m0, s45, 7168
s_mov_b32 s44, 4063232
buffer_load_dwordx4 v16, s[4:7], s44 offen lds
s_waitcnt lgkmcnt(0)
v_mfma_f32_16x16x32_bf16 v[52:55], a[0:3], v[20:23], 0
v_mfma_f32_16x16x32_bf16 v[56:59], a[4:7], v[20:23], 0
v_mfma_f32_16x16x32_bf16 v[60:63], a[0:3], v[24:27], 0
v_mfma_f32_16x16x32_bf16 v[64:67], a[4:7], v[24:27], 0
v_mfma_f32_16x16x32_bf16 v[52:55], a[8:11], v[28:31], v[52:55]
v_mfma_f32_16x16x32_bf16 v[56:59], a[12:15], v[28:31], v[56:59]
v_mfma_f32_16x16x32_bf16 v[60:63], a[8:11], v[32:35], v[60:63]
v_mfma_f32_16x16x32_bf16 v[64:67], a[12:15], v[32:35], v[64:67]
v_mfma_f32_16x16x32_bf16 v[52:55], a[16:19], v[36:39], v[52:55]
v_mfma_f32_16x16x32_bf16 v[56:59], a[20:23], v[36:39], v[56:59]
v_mfma_f32_16x16x32_bf16 v[60:63], a[16:19], v[40:43], v[60:63]
v_mfma_f32_16x16x32_bf16 v[64:67], a[20:23], v[40:43], v[64:67]
v_mfma_f32_16x16x32_bf16 v[52:55], a[24:27], v[44:47], v[52:55]
v_mfma_f32_16x16x32_bf16 v[56:59], a[28:31], v[44:47], v[56:59]
v_mfma_f32_16x16x32_bf16 v[60:63], a[24:27], v[48:51], v[60:63]
v_mfma_f32_16x16x32_bf16 v[64:67], a[28:31], v[48:51], v[64:67]
s_waitcnt vmcnt(18)
ds_read_b64_tr_b16 a[32:33], v17 offset:8192
ds_read_b64_tr_b16 a[34:35], v17 offset:8448
ds_read_b64_tr_b16 a[36:37], v17 offset:8200
ds_read_b64_tr_b16 a[38:39], v17 offset:8456
ds_read_b64_tr_b16 a[40:41], v17 offset:10240
ds_read_b64_tr_b16 a[42:43], v17 offset:10496
ds_read_b64_tr_b16 a[44:45], v17 offset:10248
ds_read_b64_tr_b16 a[46:47], v17 offset:10504
s_waitcnt lgkmcnt(0)
ds_read_b64_tr_b16 a[48:49], v17 offset:12288
ds_read_b64_tr_b16 a[50:51], v17 offset:12544
ds_read_b64_tr_b16 a[52:53], v17 offset:12296
ds_read_b64_tr_b16 a[54:55], v17 offset:12552
ds_read_b64_tr_b16 a[56:57], v17 offset:14336
ds_read_b64_tr_b16 a[58:59], v17 offset:14592
ds_read_b64_tr_b16 a[60:61], v17 offset:14344
ds_read_b64_tr_b16 a[62:63], v17 offset:14600
s_waitcnt lgkmcnt(0)
ds_read_b128 v[20:23], v8 offset:8192
ds_read_b128 v[24:27], v8 offset:10240
ds_read_b128 v[28:31], v9 offset:8192
ds_read_b128 v[32:35], v9 offset:10240
ds_read_b128 v[36:39], v8 offset:12288
ds_read_b128 v[40:43], v8 offset:14336
ds_read_b128 v[44:47], v9 offset:12288
ds_read_b128 v[48:51], v9 offset:14336
s_mov_b32 s44, 4194304
buffer_load_dword v250, v12, s[4:7], s44 offen
s_add_u32 m0, s45, 8192
s_mov_b32 s44, 4194304
buffer_load_dwordx4 v16, s[4:7], s44 offen lds
s_add_u32 m0, s45, 9216
s_mov_b32 s44, 4325376
buffer_load_dwordx4 v16, s[4:7], s44 offen lds
s_add_u32 m0, s45, 10240
s_mov_b32 s44, 4456448
buffer_load_dwordx4 v16, s[4:7], s44 offen lds
s_add_u32 m0, s45, 11264
s_mov_b32 s44, 4587520
buffer_load_dwordx4 v16, s[4:7], s44 offen lds
s_add_u32 m0, s45, 12288
s_mov_b32 s44, 4718592
buffer_load_dwordx4 v16, s[4:7], s44 offen lds
s_add_u32 m0, s45, 13312
s_mov_b32 s44, 4849664
buffer_load_dwordx4 v16, s[4:7], s44 offen lds
s_add_u32 m0, s45, 14336
s_mov_b32 s44, 4980736
buffer_load_dwordx4 v16, s[4:7], s44 offen lds
s_add_u32 m0, s45, 15360
s_mov_b32 s44, 5111808
buffer_load_dwordx4 v16, s[4:7], s44 offen lds
s_waitcnt lgkmcnt(0)
v_mfma_f32_16x16x32_bf16 v[52:55], a[32:35], v[20:23], v[52:55]
v_mfma_f32_16x16x32_bf16 v[56:59], a[36:39], v[20:23], v[56:59]
v_mfma_f32_16x16x32_bf16 v[60:63], a[32:35], v[24:27], v[60:63]
v_mfma_f32_16x16x32_bf16 v[64:67], a[36:39], v[24:27], v[64:67]
v_mfma_f32_16x16x32_bf16 v[52:55], a[40:43], v[28:31], v[52:55]
v_mfma_f32_16x16x32_bf16 v[56:59], a[44:47], v[28:31], v[56:59]
v_mfma_f32_16x16x32_bf16 v[60:63], a[40:43], v[32:35], v[60:63]
v_mfma_f32_16x16x32_bf16 v[64:67], a[44:47], v[32:35], v[64:67]
v_mfma_f32_16x16x32_bf16 v[52:55], a[48:51], v[36:39], v[52:55]
v_mfma_f32_16x16x32_bf16 v[56:59], a[52:55], v[36:39], v[56:59]
v_mfma_f32_16x16x32_bf16 v[60:63], a[48:51], v[40:43], v[60:63]
v_mfma_f32_16x16x32_bf16 v[64:67], a[52:55], v[40:43], v[64:67]
v_mfma_f32_16x16x32_bf16 v[52:55], a[56:59], v[44:47], v[52:55]
v_mfma_f32_16x16x32_bf16 v[56:59], a[60:63], v[44:47], v[56:59]
v_mfma_f32_16x16x32_bf16 v[60:63], a[56:59], v[48:51], v[60:63]
v_mfma_f32_16x16x32_bf16 v[64:67], a[60:63], v[48:51], v[64:67]
s_waitcnt vmcnt(18)
ds_read_b64_tr_b16 a[64:65], v17 offset:16384
ds_read_b64_tr_b16 a[66:67], v17 offset:16640
ds_read_b64_tr_b16 a[68:69], v17 offset:16392
ds_read_b64_tr_b16 a[70:71], v17 offset:16648
ds_read_b64_tr_b16 a[72:73], v17 offset:18432
ds_read_b64_tr_b16 a[74:75], v17 offset:18688
ds_read_b64_tr_b16 a[76:77], v17 offset:18440
ds_read_b64_tr_b16 a[78:79], v17 offset:18696
s_waitcnt lgkmcnt(0)
ds_read_b64_tr_b16 a[80:81], v17 offset:20480
ds_read_b64_tr_b16 a[82:83], v17 offset:20736
ds_read_b64_tr_b16 a[84:85], v17 offset:20488
ds_read_b64_tr_b16 a[86:87], v17 offset:20744
ds_read_b64_tr_b16 a[88:89], v17 offset:22528
ds_read_b64_tr_b16 a[90:91], v17 offset:22784
ds_read_b64_tr_b16 a[92:93], v17 offset:22536
ds_read_b64_tr_b16 a[94:95], v17 offset:22792
s_waitcnt lgkmcnt(0)
ds_read_b128 v[20:23], v8 offset:16384
ds_read_b128 v[24:27], v8 offset:18432
ds_read_b128 v[28:31], v9 offset:16384
ds_read_b128 v[32:35], v9 offset:18432
ds_read_b128 v[36:39], v8 offset:20480
ds_read_b128 v[40:43], v8 offset:22528
ds_read_b128 v[44:47], v9 offset:20480
ds_read_b128 v[48:51], v9 offset:22528
s_mov_b32 s44, 5242880
buffer_load_dword v250, v12, s[4:7], s44 offen
s_add_u32 m0, s45, 16384
s_mov_b32 s44, 5242880
buffer_load_dwordx4 v16, s[4:7], s44 offen lds
s_add_u32 m0, s45, 17408
s_mov_b32 s44, 5373952
buffer_load_dwordx4 v16, s[4:7], s44 offen lds
s_add_u32 m0, s45, 18432
s_mov_b32 s44, 5505024
buffer_load_dwordx4 v16, s[4:7], s44 offen lds
s_add_u32 m0, s45, 19456
s_mov_b32 s44, 5636096
buffer_load_dwordx4 v16, s[4:7], s44 offen lds
s_add_u32 m0, s45, 20480
s_mov_b32 s44, 5767168
buffer_load_dwordx4 v16, s[4:7], s44 offen lds
s_add_u32 m0, s45, 21504
s_mov_b32 s44, 5898240
buffer_load_dwordx4 v16, s[4:7], s44 offen lds
s_add_u32 m0, s45, 22528
s_mov_b32 s44, 6029312
buffer_load_dwordx4 v16, s[4:7], s44 offen lds
s_add_u32 m0, s45, 23552
s_mov_b32 s44, 6160384
buffer_load_dwordx4 v16, s[4:7], s44 offen lds
s_waitcnt lgkmcnt(0)
v_mfma_f32_16x16x32_bf16 v[52:55], a[64:67], v[20:23], v[52:55]
v_mfma_f32_16x16x32_bf16 v[56:59], a[68:71], v[20:23], v[56:59]
v_mfma_f32_16x16x32_bf16 v[60:63], a[64:67], v[24:27], v[60:63]
v_mfma_f32_16x16x32_bf16 v[64:67], a[68:71], v[24:27], v[64:67]
v_mfma_f32_16x16x32_bf16 v[52:55], a[72:75], v[28:31], v[52:55]
v_mfma_f32_16x16x32_bf16 v[56:59], a[76:79], v[28:31], v[56:59]
v_mfma_f32_16x16x32_bf16 v[60:63], a[72:75], v[32:35], v[60:63]
v_mfma_f32_16x16x32_bf16 v[64:67], a[76:79], v[32:35], v[64:67]
v_mfma_f32_16x16x32_bf16 v[52:55], a[80:83], v[36:39], v[52:55]
v_mfma_f32_16x16x32_bf16 v[56:59], a[84:87], v[36:39], v[56:59]
v_mfma_f32_16x16x32_bf16 v[60:63], a[80:83], v[40:43], v[60:63]
v_mfma_f32_16x16x32_bf16 v[64:67], a[84:87], v[40:43], v[64:67]
v_mfma_f32_16x16x32_bf16 v[52:55], a[88:91], v[44:47], v[52:55]
v_mfma_f32_16x16x32_bf16 v[56:59], a[92:95], v[44:47], v[56:59]
v_mfma_f32_16x16x32_bf16 v[60:63], a[88:91], v[48:51], v[60:63]
v_mfma_f32_16x16x32_bf16 v[64:67], a[92:95], v[48:51], v[64:67]
s_waitcnt vmcnt(18)
ds_read_b64_tr_b16 a[96:97], v17 offset:0
ds_read_b64_tr_b16 a[98:99], v17 offset:256
ds_read_b64_tr_b16 a[100:101], v17 offset:8
ds_read_b64_tr_b16 a[102:103], v17 offset:264
ds_read_b64_tr_b16 a[104:105], v17 offset:2048
ds_read_b64_tr_b16 a[106:107], v17 offset:2304
ds_read_b64_tr_b16 a[108:109], v17 offset:2056
ds_read_b64_tr_b16 a[110:111], v17 offset:2312
s_waitcnt lgkmcnt(0)
ds_read_b64_tr_b16 a[112:113], v17 offset:4096
ds_read_b64_tr_b16 a[114:115], v17 offset:4352
ds_read_b64_tr_b16 a[116:117], v17 offset:4104
ds_read_b64_tr_b16 a[118:119], v17 offset:4360
ds_read_b64_tr_b16 a[120:121], v17 offset:6144
ds_read_b64_tr_b16 a[122:123], v17 offset:6400
ds_read_b64_tr_b16 a[124:125], v17 offset:6152
ds_read_b64_tr_b16 a[126:127], v17 offset:6408
s_waitcnt lgkmcnt(0)
ds_read_b128 v[20:23], v8 offset:24576
ds_read_b128 v[24:27], v8 offset:26624
ds_read_b128 v[28:31], v9 offset:24576
ds_read_b128 v[32:35], v9 offset:26624
ds_read_b128 v[36:39], v8 offset:28672
ds_read_b128 v[40:43], v8 offset:30720
ds_read_b128 v[44:47], v9 offset:28672
ds_read_b128 v[48:51], v9 offset:30720
s_mov_b32 s44, 6291456
buffer_load_dword v250, v12, s[4:7], s44 offen
s_add_u32 m0, s45, 0
s_mov_b32 s44, 6291456
buffer_load_dwordx4 v16, s[4:7], s44 offen lds
s_add_u32 m0, s45, 1024
s_mov_b32 s44, 6422528
buffer_load_dwordx4 v16, s[4:7], s44 offen lds
s_add_u32 m0, s45, 2048
s_mov_b32 s44, 6553600
buffer_load_dwordx4 v16, s[4:7], s44 offen lds
s_add_u32 m0, s45, 3072
s_mov_b32 s44, 6684672
buffer_load_dwordx4 v16, s[4:7], s44 offen lds
s_add_u32 m0, s45, 4096
s_mov_b32 s44, 6815744
buffer_load_dwordx4 v16, s[4:7], s44 offen lds
s_add_u32 m0, s45, 5120
s_mov_b32 s44, 6946816
buffer_load_dwordx4 v16, s[4:7], s44 offen lds
s_add_u32 m0, s45, 6144
s_mov_b32 s44, 7077888
buffer_load_dwordx4 v16, s[4:7], s44 offen lds
s_add_u32 m0, s45, 7168
s_mov_b32 s44, 7208960
buffer_load_dwordx4 v16, s[4:7], s44 offen lds
s_waitcnt lgkmcnt(0)
v_mfma_f32_16x16x32_bf16 v[52:55], a[96:99], v[20:23], v[52:55]
v_mfma_f32_16x16x32_bf16 v[56:59], a[100:103], v[20:23], v[56:59]
v_mfma_f32_16x16x32_bf16 v[60:63], a[96:99], v[24:27], v[60:63]
v_mfma_f32_16x16x32_bf16 v[64:67], a[100:103], v[24:27], v[64:67]
v_mfma_f32_16x16x32_bf16 v[52:55], a[104:107], v[28:31], v[52:55]
v_mfma_f32_16x16x32_bf16 v[56:59], a[108:111], v[28:31], v[56:59]
v_mfma_f32_16x16x32_bf16 v[60:63], a[104:107], v[32:35], v[60:63]
v_mfma_f32_16x16x32_bf16 v[64:67], a[108:111], v[32:35], v[64:67]
v_mfma_f32_16x16x32_bf16 v[52:55], a[112:115], v[36:39], v[52:55]
v_mfma_f32_16x16x32_bf16 v[56:59], a[116:119], v[36:39], v[56:59]
v_mfma_f32_16x16x32_bf16 v[60:63], a[112:115], v[40:43], v[60:63]
v_mfma_f32_16x16x32_bf16 v[64:67], a[116:119], v[40:43], v[64:67]
v_mfma_f32_16x16x32_bf16 v[52:55], a[120:123], v[44:47], v[52:55]
v_mfma_f32_16x16x32_bf16 v[56:59], a[124:127], v[44:47], v[56:59]
v_mfma_f32_16x16x32_bf16 v[60:63], a[120:123], v[48:51], v[60:63]
v_mfma_f32_16x16x32_bf16 v[64:67], a[124:127], v[48:51], v[64:67]
s_waitcnt vmcnt(18)
ds_read_b64_tr_b16 a[128:129], v17 offset:8192
ds_read_b64_tr_b16 a[130:131], v17 offset:8448
ds_read_b64_tr_b16 a[132:133], v17 offset:8200
ds_read_b64_tr_b16 a[134:135], v17 offset:8456
ds_read_b64_tr_b16 a[136:137], v17 offset:10240
ds_read_b64_tr_b16 a[138:139], v17 offset:10496
ds_read_b64_tr_b16 a[140:141], v17 offset:10248
ds_read_b64_tr_b16 a[142:143], v17 offset:10504
s_waitcnt lgkmcnt(0)
ds_read_b64_tr_b16 a[144:145], v17 offset:12288
ds_read_b64_tr_b16 a[146:147], v17 offset:12544
ds_read_b64_tr_b16 a[148:149], v17 offset:12296
ds_read_b64_tr_b16 a[150:151], v17 offset:12552
ds_read_b64_tr_b16 a[152:153], v17 offset:14336
ds_read_b64_tr_b16 a[154:155], v17 offset:14592
ds_read_b64_tr_b16 a[156:157], v17 offset:14344
ds_read_b64_tr_b16 a[158:159], v17 offset:14600
s_waitcnt lgkmcnt(0)
ds_read_b128 v[20:23], v8 offset:32768
ds_read_b128 v[24:27], v8 offset:34816
ds_read_b128 v[28:31], v9 offset:32768
ds_read_b128 v[32:35], v9 offset:34816
ds_read_b128 v[36:39], v8 offset:36864
ds_read_b128 v[40:43], v8 offset:38912
ds_read_b128 v[44:47], v9 offset:36864
ds_read_b128 v[48:51], v9 offset:38912
s_mov_b32 s44, 7340032
buffer_load_dword v250, v12, s[4:7], s44 offen
s_add_u32 m0, s45, 8192
s_mov_b32 s44, 7340032
buffer_load_dwordx4 v16, s[4:7], s44 offen lds
s_add_u32 m0, s45, 9216
s_mov_b32 s44, 7471104
buffer_load_dwordx4 v16, s[4:7], s44 offen lds
s_add_u32 m0, s45, 10240
s_mov_b32 s44, 7602176
buffer_load_dwordx4 v16, s[4:7], s44 offen lds
s_add_u32 m0, s45, 11264
s_mov_b32 s44, 7733248
buffer_load_dwordx4 v16, s[4:7], s44 offen lds
s_add_u32 m0, s45, 12288
s_mov_b32 s44, 7864320
buffer_load_dwordx4 v16, s[4:7], s44 offen lds
s_add_u32 m0, s45, 13312
s_mov_b32 s44, 7995392
buffer_load_dwordx4 v16, s[4:7], s44 offen lds
s_add_u32 m0, s45, 14336
s_mov_b32 s44, 8126464
buffer_load_dwordx4 v16, s[4:7], s44 offen lds
s_add_u32 m0, s45, 15360
s_mov_b32 s44, 8257536
buffer_load_dwordx4 v16, s[4:7], s44 offen lds
s_waitcnt lgkmcnt(0)
v_mfma_f32_16x16x32_bf16 v[52:55], a[128:131], v[20:23], v[52:55]
v_mfma_f32_16x16x32_bf16 v[56:59], a[132:135], v[20:23], v[56:59]
v_mfma_f32_16x16x32_bf16 v[60:63], a[128:131], v[24:27], v[60:63]
v_mfma_f32_16x16x32_bf16 v[64:67], a[132:135], v[24:27], v[64:67]
v_mfma_f32_16x16x32_bf16 v[52:55], a[136:139], v[28:31], v[52:55]
v_mfma_f32_16x16x32_bf16 v[56:59], a[140:143], v[28:31], v[56:59]
v_mfma_f32_16x16x32_bf16 v[60:63], a[136:139], v[32:35], v[60:63]
v_mfma_f32_16x16x32_bf16 v[64:67], a[140:143], v[32:35], v[64:67]
v_mfma_f32_16x16x32_bf16 v[52:55], a[144:147], v[36:39], v[52:55]
v_mfma_f32_16x16x32_bf16 v[56:59], a[148:151], v[36:39], v[56:59]
v_mfma_f32_16x16x32_bf16 v[60:63], a[144:147], v[40:43], v[60:63]
v_mfma_f32_16x16x32_bf16 v[64:67], a[148:151], v[40:43], v[64:67]
v_mfma_f32_16x16x32_bf16 v[52:55], a[152:155], v[44:47], v[52:55]
v_mfma_f32_16x16x32_bf16 v[56:59], a[156:159], v[44:47], v[56:59]
v_mfma_f32_16x16x32_bf16 v[60:63], a[152:155], v[48:51], v[60:63]
v_mfma_f32_16x16x32_bf16 v[64:67], a[156:159], v[48:51], v[64:67]
s_waitcnt vmcnt(18)
ds_read_b64_tr_b16 a[160:161], v17 offset:16384
ds_read_b64_tr_b16 a[162:163], v17 offset:16640
ds_read_b64_tr_b16 a[164:165], v17 offset:16392
ds_read_b64_tr_b16 a[166:167], v17 offset:16648
ds_read_b64_tr_b16 a[168:169], v17 offset:18432
ds_read_b64_tr_b16 a[170:171], v17 offset:18688
ds_read_b64_tr_b16 a[172:173], v17 offset:18440
ds_read_b64_tr_b16 a[174:175], v17 offset:18696
s_waitcnt lgkmcnt(0)
ds_read_b64_tr_b16 a[176:177], v17 offset:20480
ds_read_b64_tr_b16 a[178:179], v17 offset:20736
ds_read_b64_tr_b16 a[180:181], v17 offset:20488
ds_read_b64_tr_b16 a[182:183], v17 offset:20744
ds_read_b64_tr_b16 a[184:185], v17 offset:22528
ds_read_b64_tr_b16 a[186:187], v17 offset:22784
ds_read_b64_tr_b16 a[188:189], v17 offset:22536
ds_read_b64_tr_b16 a[190:191], v17 offset:22792
s_waitcnt lgkmcnt(0)
ds_read_b128 v[20:23], v8 offset:40960
ds_read_b128 v[24:27], v8 offset:43008
ds_read_b128 v[28:31], v9 offset:40960
ds_read_b128 v[32:35], v9 offset:43008
ds_read_b128 v[36:39], v8 offset:45056
ds_read_b128 v[40:43], v8 offset:47104
ds_read_b128 v[44:47], v9 offset:45056
ds_read_b128 v[48:51], v9 offset:47104
s_waitcnt lgkmcnt(0)
v_mfma_f32_16x16x32_bf16 v[52:55], a[160:163], v[20:23], v[52:55]
v_mfma_f32_16x16x32_bf16 v[56:59], a[164:167], v[20:23], v[56:59]
v_mfma_f32_16x16x32_bf16 v[60:63], a[160:163], v[24:27], v[60:63]
v_mfma_f32_16x16x32_bf16 v[64:67], a[164:167], v[24:27], v[64:67]
v_mfma_f32_16x16x32_bf16 v[52:55], a[168:171], v[28:31], v[52:55]
v_mfma_f32_16x16x32_bf16 v[56:59], a[172:175], v[28:31], v[56:59]
v_mfma_f32_16x16x32_bf16 v[60:63], a[168:171], v[32:35], v[60:63]
v_mfma_f32_16x16x32_bf16 v[64:67], a[172:175], v[32:35], v[64:67]
v_mfma_f32_16x16x32_bf16 v[52:55], a[176:179], v[36:39], v[52:55]
v_mfma_f32_16x16x32_bf16 v[56:59], a[180:183], v[36:39], v[56:59]
v_mfma_f32_16x16x32_bf16 v[60:63], a[176:179], v[40:43], v[60:63]
v_mfma_f32_16x16x32_bf16 v[64:67], a[180:183], v[40:43], v[64:67]
v_mfma_f32_16x16x32_bf16 v[52:55], a[184:187], v[44:47], v[52:55]
v_mfma_f32_16x16x32_bf16 v[56:59], a[188:191], v[44:47], v[56:59]
v_mfma_f32_16x16x32_bf16 v[60:63], a[184:187], v[48:51], v[60:63]
v_mfma_f32_16x16x32_bf16 v[64:67], a[188:191], v[48:51], v[64:67]
s_waitcnt vmcnt(9)
ds_read_b64_tr_b16 a[192:193], v17 offset:0
ds_read_b64_tr_b16 a[194:195], v17 offset:256
ds_read_b64_tr_b16 a[196:197], v17 offset:8
ds_read_b64_tr_b16 a[198:199], v17 offset:264
ds_read_b64_tr_b16 a[200:201], v17 offset:2048
ds_read_b64_tr_b16 a[202:203], v17 offset:2304
ds_read_b64_tr_b16 a[204:205], v17 offset:2056
ds_read_b64_tr_b16 a[206:207], v17 offset:2312
s_waitcnt lgkmcnt(0)
ds_read_b64_tr_b16 a[208:209], v17 offset:4096
ds_read_b64_tr_b16 a[210:211], v17 offset:4352
ds_read_b64_tr_b16 a[212:213], v17 offset:4104
ds_read_b64_tr_b16 a[214:215], v17 offset:4360
ds_read_b64_tr_b16 a[216:217], v17 offset:6144
ds_read_b64_tr_b16 a[218:219], v17 offset:6400
ds_read_b64_tr_b16 a[220:221], v17 offset:6152
ds_read_b64_tr_b16 a[222:223], v17 offset:6408
s_waitcnt lgkmcnt(0)
ds_read_b128 v[20:23], v8 offset:49152
ds_read_b128 v[24:27], v8 offset:51200
ds_read_b128 v[28:31], v9 offset:49152
ds_read_b128 v[32:35], v9 offset:51200
ds_read_b128 v[36:39], v8 offset:53248
ds_read_b128 v[40:43], v8 offset:55296
ds_read_b128 v[44:47], v9 offset:53248
ds_read_b128 v[48:51], v9 offset:55296
s_waitcnt lgkmcnt(0)
v_mfma_f32_16x16x32_bf16 v[52:55], a[192:195], v[20:23], v[52:55]
v_mfma_f32_16x16x32_bf16 v[56:59], a[196:199], v[20:23], v[56:59]
v_mfma_f32_16x16x32_bf16 v[60:63], a[192:195], v[24:27], v[60:63]
v_mfma_f32_16x16x32_bf16 v[64:67], a[196:199], v[24:27], v[64:67]
v_mfma_f32_16x16x32_bf16 v[52:55], a[200:203], v[28:31], v[52:55]
v_mfma_f32_16x16x32_bf16 v[56:59], a[204:207], v[28:31], v[56:59]
v_mfma_f32_16x16x32_bf16 v[60:63], a[200:203], v[32:35], v[60:63]
v_mfma_f32_16x16x32_bf16 v[64:67], a[204:207], v[32:35], v[64:67]
v_mfma_f32_16x16x32_bf16 v[52:55], a[208:211], v[36:39], v[52:55]
v_mfma_f32_16x16x32_bf16 v[56:59], a[212:215], v[36:39], v[56:59]
v_mfma_f32_16x16x32_bf16 v[60:63], a[208:211], v[40:43], v[60:63]
v_mfma_f32_16x16x32_bf16 v[64:67], a[212:215], v[40:43], v[64:67]
v_mfma_f32_16x16x32_bf16 v[52:55], a[216:219], v[44:47], v[52:55]
v_mfma_f32_16x16x32_bf16 v[56:59], a[220:223], v[44:47], v[56:59]
v_mfma_f32_16x16x32_bf16 v[60:63], a[216:219], v[48:51], v[60:63]
v_mfma_f32_16x16x32_bf16 v[64:67], a[220:223], v[48:51], v[64:67]
s_waitcnt vmcnt(0)
ds_read_b64_tr_b16 a[224:225], v17 offset:8192
ds_read_b64_tr_b16 a[226:227], v17 offset:8448
ds_read_b64_tr_b16 a[228:229], v17 offset:8200
ds_read_b64_tr_b16 a[230:231], v17 offset:8456
ds_read_b64_tr_b16 a[232:233], v17 offset:10240
ds_read_b64_tr_b16 a[234:235], v17 offset:10496
ds_read_b64_tr_b16 a[236:237], v17 offset:10248
ds_read_b64_tr_b16 a[238:239], v17 offset:10504
s_waitcnt lgkmcnt(0)
ds_read_b64_tr_b16 a[240:241], v17 offset:12288
ds_read_b64_tr_b16 a[242:243], v17 offset:12544
ds_read_b64_tr_b16 a[244:245], v17 offset:12296
ds_read_b64_tr_b16 a[246:247], v17 offset:12552
ds_read_b64_tr_b16 a[248:249], v17 offset:14336
ds_read_b64_tr_b16 a[250:251], v17 offset:14592
ds_read_b64_tr_b16 a[252:253], v17 offset:14344
ds_read_b64_tr_b16 a[254:255], v17 offset:14600
s_waitcnt lgkmcnt(0)
ds_read_b128 v[20:23], v8 offset:57344
ds_read_b128 v[24:27], v8 offset:59392
ds_read_b128 v[28:31], v9 offset:57344
ds_read_b128 v[32:35], v9 offset:59392
ds_read_b128 v[36:39], v8 offset:61440
ds_read_b128 v[40:43], v8 offset:63488
ds_read_b128 v[44:47], v9 offset:61440
ds_read_b128 v[48:51], v9 offset:63488
s_waitcnt lgkmcnt(0)
v_mfma_f32_16x16x32_bf16 v[52:55], a[224:227], v[20:23], v[52:55]
v_mfma_f32_16x16x32_bf16 v[56:59], a[228:231], v[20:23], v[56:59]
v_mfma_f32_16x16x32_bf16 v[60:63], a[224:227], v[24:27], v[60:63]
v_mfma_f32_16x16x32_bf16 v[64:67], a[228:231], v[24:27], v[64:67]
v_mfma_f32_16x16x32_bf16 v[52:55], a[232:235], v[28:31], v[52:55]
v_mfma_f32_16x16x32_bf16 v[56:59], a[236:239], v[28:31], v[56:59]
v_mfma_f32_16x16x32_bf16 v[60:63], a[232:235], v[32:35], v[60:63]
v_mfma_f32_16x16x32_bf16 v[64:67], a[236:239], v[32:35], v[64:67]
v_mfma_f32_16x16x32_bf16 v[52:55], a[240:243], v[36:39], v[52:55]
v_mfma_f32_16x16x32_bf16 v[56:59], a[244:247], v[36:39], v[56:59]
v_mfma_f32_16x16x32_bf16 v[60:63], a[240:243], v[40:43], v[60:63]
v_mfma_f32_16x16x32_bf16 v[64:67], a[244:247], v[40:43], v[64:67]
v_mfma_f32_16x16x32_bf16 v[52:55], a[248:251], v[44:47], v[52:55]
v_mfma_f32_16x16x32_bf16 v[56:59], a[252:255], v[44:47], v[56:59]
v_mfma_f32_16x16x32_bf16 v[60:63], a[248:251], v[48:51], v[60:63]
v_mfma_f32_16x16x32_bf16 v[64:67], a[252:255], v[48:51], v[64:67]
s_barrier
s_mov_b32 s50, 0x10000
s_add_u32 m0, s46, 65536
s_nop 0
buffer_load_dwordx4 v6, s[8:11], s50 offen offset:0 lds
s_add_u32 m0, s46, 69504
s_nop 0
buffer_load_dwordx4 v6, s[8:11], s50 offen offset:128 lds
s_add_u32 m0, s46, 73472
s_nop 0
buffer_load_dwordx4 v6, s[8:11], s50 offen offset:256 lds
s_add_u32 m0, s46, 77440
s_nop 0
buffer_load_dwordx4 v6, s[8:11], s50 offen offset:384 lds
s_add_u32 m0, s46, 81408
s_nop 0
buffer_load_dwordx4 v6, s[8:11], s50 offen offset:512 lds
s_add_u32 m0, s46, 85376
s_nop 0
buffer_load_dwordx4 v6, s[8:11], s50 offen offset:640 lds
s_add_u32 m0, s46, 89344
s_nop 0
buffer_load_dwordx4 v6, s[8:11], s50 offen offset:768 lds
s_add_u32 m0, s46, 93312
s_nop 0
buffer_load_dwordx4 v6, s[8:11], s50 offen offset:896 lds
s_add_u32 m0, s46, 97280
s_nop 0
buffer_load_dwordx4 v6, s[8:11], s50 offen offset:1024 lds
s_add_u32 m0, s46, 101248
s_nop 0
buffer_load_dwordx4 v6, s[8:11], s50 offen offset:1152 lds
s_add_u32 m0, s46, 105216
s_nop 0
buffer_load_dwordx4 v6, s[8:11], s50 offen offset:1280 lds
s_add_u32 m0, s46, 109184
s_nop 0
buffer_load_dwordx4 v6, s[8:11], s50 offen offset:1408 lds
s_add_u32 m0, s46, 113152
s_nop 0
buffer_load_dwordx4 v6, s[8:11], s50 offen offset:1536 lds
s_add_u32 m0, s46, 117120
s_nop 0
buffer_load_dwordx4 v6, s[8:11], s50 offen offset:1664 lds
s_add_u32 m0, s46, 121088
s_nop 0
buffer_load_dwordx4 v6, s[8:11], s50 offen offset:1792 lds
s_add_u32 m0, s46, 125056
s_nop 0
buffer_load_dwordx4 v6, s[8:11], s50 offen offset:1920 lds
v_lshrrev_b32 v92, 4, v1
v_and_b32 v93, 15, v1
s_and_b32 s52, s41, 1
s_lshr_b32 s53, s41, 1
s_mov_b32 s54, 0x3e0293ee
s_mov_b32 s55, 0
s_mov_b32 s56, 0
v_mov_b32 v97, 0xff800000
v_mov_b32 v241, 0xceabdc6e
v_and_b32 v2, 7, v93
v_lshlrev_b32 v94, 7, v92
v_lshl_add_u32 v94, v2, 4, v94
v_and_b32 v2, 31, v1
v_lshlrev_b32 v95, 3, v2
v_lshrrev_b32 v2, 1, v92
v_lshlrev_b32 v96, 10, v2
v_and_b32 v2, 1, v92
v_lshl_add_u32 v96, v2, 9, v96
v_lshl_add_u32 v96, v93, 4, v96
s_lshl_b32 s43, s40, 13
s_lshl_b32 s44, s53, 12
s_add_u32 s43, s43, s44
s_lshl_b32 s44, s52, 8
s_add_u32 s43, s43, s44
s_add_u32 s43, s43, 134217728
v_add_u32 v96, s43, v96
s_lshl_b32 s43, s52, 4
v_add_u32 v98, s43, v93
v_lshlrev_b32 v2, 2, v92
v_sub_u32 v98, v98, v2
s_mov_b32 s28, 0
s_mov_b32 s29, -1
s_xor_b32 s44, s98, 1
s_lshl_b32 s44, s44, 13
s_lshl_b32 s43, s40, 7
s_add_u32 s43, s43, s44
s_add_u32 s43, s43, 69206016
v_and_b32 v2, 3, v1
v_bfe_u32 v3, v1, 2, 1
v_lshlrev_b32 v99, 12, v3
v_lshl_add_u32 v99, v2, 2, v99
v_add_u32 v99, s43, v99
s_xor_b32 s62, s98, 1
s_lshl_b32 s62, s62, 13
s_lshr_b32 s44, s47, 6
s_lshl_b32 s44, s44, 14
s_add_u32 s62, s62, s44
s_and_b32 s44, s47, 63
s_lshl_b32 s44, s44, 7
s_add_u32 s62, s62, s44
s_add_u32 s62, s62, 69222400
s_lshl_b32 s49, s40, 7
s_lshl_b32 s44, s41, 2
s_add_u32 s49, s49, s44
s_lshl_b32 s44, s98, 13
s_add_u32 s49, s49, s44
s_add_u32 s49, s49, 69255168
s_lshl_b32 s43, s41, 11
s_add_u32 s43, s43, 131072
v_add_u32 v101, s43, v7
s_lshl_b32 s43, s52, 10
s_add_u32 s43, s43, 131072
v_add_u32 v102, s43, v5
v_mov_b32 v16, 0
s_mov_b32 s50, 0
v_mov_b32 v104, 0x3f803f80
v_mov_b32 v105, 0x3f803f80
v_mov_b32 v106, 0x3f803f80
v_mov_b32 v107, 0x3f803f80
v_cmp_gt_i32 s[12:13], 0, v98
v_cmp_gt_i32 s[14:15], 1, v98
v_cmp_gt_i32 s[16:17], 2, v98
v_cmp_gt_i32 s[18:19], 3, v98
v_cmp_gt_i32 s[20:21], 16, v98
v_cmp_gt_i32 s[22:23], 17, v98
v_cmp_gt_i32 s[24:25], 18, v98
v_cmp_gt_i32 s[26:27], 19, v98
s_lshr_b32 s44, s47, 3
s_xor_b32 s44, s44, s98
s_and_b32 s44, s44, 1
s_lshl_b32 s44, s44, 13
s_lshl_b32 s58, s47, 18
s_add_u32 s58, s58, s44
s_add_u32 s58, s58, 0
s_lshr_b32 s44, s47, 4
s_xor_b32 s44, s44, s98
s_and_b32 s44, s44, 1
s_lshl_b32 s44, s44, 13
s_lshl_b32 s59, s47, 17
s_add_u32 s59, s59, s44
s_add_u32 s59, s59, 71303168
s_lshl_b32 s60, s41, 11
s_add_u32 s60, s60, 139264
s_lshl_b32 s61, s41, 10
s_add_u32 s61, s61, 155648
v_add_u32 v94, 155648, v94
s_lshl_b32 s43, s53, 11
s_add_u32 s43, s43, 156160
v_add_u32 v95, s43, v95
v_add_u32 v103, 139264, v5
s_lshl_b32 s43, s53, 12
s_add_u32 s43, s43, 147456
v_add_u32 v240, s43, v5
s_waitcnt vmcnt(0)
v_mov_b32 v68, v52
v_mov_b32 v69, v53
v_mov_b32 v70, v54
v_mov_b32 v71, v55
v_mov_b32 v72, v56
v_mov_b32 v73, v57
v_mov_b32 v74, v58
v_mov_b32 v75, v59
v_mov_b32 v76, v60
v_mov_b32 v77, v61
v_mov_b32 v78, v62
v_mov_b32 v79, v63
v_mov_b32 v80, v64
v_mov_b32 v81, v65
v_mov_b32 v82, v66
v_mov_b32 v83, v67
mega_kernel_q_loop:
s_barrier
s_cmp_gt_i32 s55, s42
s_cbranch_scc1 mega_kernel_q_kv1k
mega_kernel_q_kv1w:
buffer_load_dword v2, v99, s[84:87], 0 offen sc1
s_waitcnt vmcnt(0)
v_min_i32_dpp v2, v2, v2 quad_perm:[1,0,3,2] row_mask:0xf bank_mask:0xf
s_nop 1
v_min_i32_dpp v2, v2, v2 quad_perm:[2,3,0,1] row_mask:0xf bank_mask:0xf
s_nop 1
v_min_i32_dpp v2, v2, v2 row_ror:4 row_mask:0xf bank_mask:0xf
s_nop 0
v_readfirstlane_b32 s55, v2
s_cmp_gt_i32 s55, s42
s_cbranch_scc1 mega_kernel_q_kv1k
s_sleep 4
s_branch mega_kernel_q_kv1w
mega_kernel_q_kv1k:
ds_read_b128 v[20:23], v10 offset:0
ds_read_b128 v[24:27], v10 offset:2048
ds_read_b128 v[28:31], v11 offset:0
ds_read_b128 v[32:35], v11 offset:2048
ds_read_b128 v[36:39], v10 offset:4096
ds_read_b128 v[40:43], v10 offset:6144
s_add_u32 s51, s47, s42
s_bfe_u32 s57, s51, 0x40002
s_lshl_b32 s57, s57, 14
s_and_b32 s66, s51, 3
s_lshl_b32 s66, s66, 11
s_add_u32 s66, s66, s57
s_add_u32 s66, s66, s58
s_add_u32 s67, s66, 33554432
s_bfe_u32 s57, s51, 0x30003
s_lshl_b32 s57, s57, 14
s_and_b32 s68, s51, 7
s_lshl_b32 s68, s68, 10
s_add_u32 s68, s68, s57
s_add_u32 s68, s68, s59
s_add_u32 s50, s42, 2
s_min_u32 s50, s50, 63
s_lshl_b32 s50, s50, 16
s_cmp_gt_i32 s56, s42
s_cselect_b32 s30, 1, 0
s_add_u32 m0, s60, 0
s_waitcnt lgkmcnt(4)
v_mfma_f32_16x16x32_bf16 v[52:55], a[0:3], v[20:23], 0
ds_read_b128 v[44:47], v11 offset:4096
v_mfma_f32_16x16x32_bf16 v[56:59], a[4:7], v[20:23], 0
buffer_load_dwordx4 v5, s[84:87], s66 offen offset:0 sc1 lds
v_mfma_f32_16x16x32_bf16 v[60:63], a[0:3], v[24:27], 0
ds_read_b128 v[48:51], v11 offset:6144
v_mfma_f32_16x16x32_bf16 v[64:67], a[4:7], v[24:27], 0
s_add_u32 m0, s60, 0
s_waitcnt lgkmcnt(4)
v_mfma_f32_16x16x32_bf16 v[52:55], a[8:11], v[28:31], v[52:55]
ds_read_b128 v[20:23], v10 offset:8192
v_mfma_f32_16x16x32_bf16 v[56:59], a[12:15], v[28:31], v[56:59]
buffer_load_dwordx4 v5, s[84:87], s66 offen offset:1024 sc1 lds
v_mfma_f32_16x16x32_bf16 v[60:63], a[8:11], v[32:35], v[60:63]
ds_read_b128 v[24:27], v10 offset:10240
v_mfma_f32_16x16x32_bf16 v[64:67], a[12:15], v[32:35], v[64:67]
s_add_u32 m0, s60, 8192
s_waitcnt lgkmcnt(4)
v_mfma_f32_16x16x32_bf16 v[52:55], a[16:19], v[36:39], v[52:55]
ds_read_b128 v[28:31], v11 offset:8192
v_mfma_f32_16x16x32_bf16 v[56:59], a[20:23], v[36:39], v[56:59]
buffer_load_dwordx4 v5, s[84:87], s67 offen offset:0 sc1 lds
v_mfma_f32_16x16x32_bf16 v[60:63], a[16:19], v[40:43], v[60:63]
ds_read_b128 v[32:35], v11 offset:10240
v_mfma_f32_16x16x32_bf16 v[64:67], a[20:23], v[40:43], v[64:67]
s_add_u32 m0, s60, 8192
s_waitcnt lgkmcnt(4)
v_mfma_f32_16x16x32_bf16 v[52:55], a[24:27], v[44:47], v[52:55]
ds_read_b128 v[36:39], v10 offset:12288
v_mfma_f32_16x16x32_bf16 v[56:59], a[28:31], v[44:47], v[56:59]
buffer_load_dwordx4 v5, s[84:87], s67 offen offset:1024 sc1 lds
v_mfma_f32_16x16x32_bf16 v[60:63], a[24:27], v[48:51], v[60:63]
ds_read_b128 v[40:43], v10 offset:14336
v_mfma_f32_16x16x32_bf16 v[64:67], a[28:31], v[48:51], v[64:67]
s_waitcnt lgkmcnt(4)
v_mfma_f32_16x16x32_bf16 v[52:55], a[32:35], v[20:23], v[52:55]
ds_read_b128 v[44:47], v11 offset:12288
v_mfma_f32_16x16x32_bf16 v[56:59], a[36:39], v[20:23], v[56:59]
s_cmp_eq_u32 s30, 1
s_cbranch_scc0 mega_kernel_q_ke1
s_mov_b32 m0, s61
s_nop 0
buffer_load_dwordx4 v5, s[84:87], s68 offen sc1 lds
mega_kernel_q_ke1:
v_mfma_f32_16x16x32_bf16 v[60:63], a[32:35], v[24:27], v[60:63]
ds_read_b128 v[48:51], v11 offset:14336
v_mfma_f32_16x16x32_bf16 v[64:67], a[36:39], v[24:27], v[64:67]
s_add_u32 m0, s46, 0
s_waitcnt lgkmcnt(4)
v_mfma_f32_16x16x32_bf16 v[52:55], a[40:43], v[28:31], v[52:55]
ds_read_b128 v[20:23], v10 offset:16384
v_mfma_f32_16x16x32_bf16 v[56:59], a[44:47], v[28:31], v[56:59]
buffer_load_dwordx4 v6, s[8:11], s50 offen offset:0 lds
v_mfma_f32_16x16x32_bf16 v[60:63], a[40:43], v[32:35], v[60:63]
ds_read_b128 v[24:27], v10 offset:18432
v_mfma_f32_16x16x32_bf16 v[64:67], a[44:47], v[32:35], v[64:67]
s_add_u32 m0, s46, 3968
s_waitcnt lgkmcnt(4)
v_mfma_f32_16x16x32_bf16 v[52:55], a[48:51], v[36:39], v[52:55]
ds_read_b128 v[28:31], v11 offset:16384
v_mfma_f32_16x16x32_bf16 v[56:59], a[52:55], v[36:39], v[56:59]
buffer_load_dwordx4 v6, s[8:11], s50 offen offset:128 lds
v_mfma_f32_16x16x32_bf16 v[60:63], a[48:51], v[40:43], v[60:63]
ds_read_b128 v[32:35], v11 offset:18432
v_mfma_f32_16x16x32_bf16 v[64:67], a[52:55], v[40:43], v[64:67]
s_add_u32 m0, s46, 7936
s_waitcnt lgkmcnt(4)
v_mfma_f32_16x16x32_bf16 v[52:55], a[56:59], v[44:47], v[52:55]
ds_read_b128 v[36:39], v10 offset:20480
v_mfma_f32_16x16x32_bf16 v[56:59], a[60:63], v[44:47], v[56:59]
buffer_load_dwordx4 v6, s[8:11], s50 offen offset:256 lds
v_mfma_f32_16x16x32_bf16 v[60:63], a[56:59], v[48:51], v[60:63]
ds_read_b128 v[40:43], v10 offset:22528
v_mfma_f32_16x16x32_bf16 v[64:67], a[60:63], v[48:51], v[64:67]
s_add_u32 m0, s46, 11904
s_waitcnt lgkmcnt(4)
v_mfma_f32_16x16x32_bf16 v[52:55], a[64:67], v[20:23], v[52:55]
ds_read_b128 v[44:47], v11 offset:20480
v_mfma_f32_16x16x32_bf16 v[56:59], a[68:71], v[20:23], v[56:59]
buffer_load_dwordx4 v6, s[8:11], s50 offen offset:384 lds
v_mfma_f32_16x16x32_bf16 v[60:63], a[64:67], v[24:27], v[60:63]
ds_read_b128 v[48:51], v11 offset:22528
v_mfma_f32_16x16x32_bf16 v[64:67], a[68:71], v[24:27], v[64:67]
s_add_u32 m0, s46, 15872
s_waitcnt lgkmcnt(4)
v_mfma_f32_16x16x32_bf16 v[52:55], a[72:75], v[28:31], v[52:55]
ds_read_b128 v[20:23], v10 offset:24576
v_mfma_f32_16x16x32_bf16 v[56:59], a[76:79], v[28:31], v[56:59]
buffer_load_dwordx4 v6, s[8:11], s50 offen offset:512 lds
v_mfma_f32_16x16x32_bf16 v[60:63], a[72:75], v[32:35], v[60:63]
ds_read_b128 v[24:27], v10 offset:26624
v_mfma_f32_16x16x32_bf16 v[64:67], a[76:79], v[32:35], v[64:67]
s_add_u32 m0, s46, 19840
s_waitcnt lgkmcnt(4)
v_mfma_f32_16x16x32_bf16 v[52:55], a[80:83], v[36:39], v[52:55]
ds_read_b128 v[28:31], v11 offset:24576
v_mfma_f32_16x16x32_bf16 v[56:59], a[84:87], v[36:39], v[56:59]
buffer_load_dwordx4 v6, s[8:11], s50 offen offset:640 lds
v_mfma_f32_16x16x32_bf16 v[60:63], a[80:83], v[40:43], v[60:63]
ds_read_b128 v[32:35], v11 offset:26624
v_mfma_f32_16x16x32_bf16 v[64:67], a[84:87], v[40:43], v[64:67]
s_add_u32 m0, s46, 23808
s_waitcnt lgkmcnt(4)
v_mfma_f32_16x16x32_bf16 v[52:55], a[88:91], v[44:47], v[52:55]
ds_read_b128 v[36:39], v10 offset:28672
v_mfma_f32_16x16x32_bf16 v[56:59], a[92:95], v[44:47], v[56:59]
buffer_load_dwordx4 v6, s[8:11], s50 offen offset:768 lds
v_mfma_f32_16x16x32_bf16 v[60:63], a[88:91], v[48:51], v[60:63]
ds_read_b128 v[40:43], v10 offset:30720
v_mfma_f32_16x16x32_bf16 v[64:67], a[92:95], v[48:51], v[64:67]
s_add_u32 m0, s46, 27776
s_waitcnt lgkmcnt(4)
v_mfma_f32_16x16x32_bf16 v[52:55], a[96:99], v[20:23], v[52:55]
ds_read_b128 v[44:47], v11 offset:28672
v_mfma_f32_16x16x32_bf16 v[56:59], a[100:103], v[20:23], v[56:59]
buffer_load_dwordx4 v6, s[8:11], s50 offen offset:896 lds
v_mfma_f32_16x16x32_bf16 v[60:63], a[96:99], v[24:27], v[60:63]
ds_read_b128 v[48:51], v11 offset:30720
v_mfma_f32_16x16x32_bf16 v[64:67], a[100:103], v[24:27], v[64:67]
s_add_u32 m0, s46, 31744
s_waitcnt lgkmcnt(4)
v_mfma_f32_16x16x32_bf16 v[52:55], a[104:107], v[28:31], v[52:55]
ds_read_b128 v[20:23], v10 offset:32768
v_mfma_f32_16x16x32_bf16 v[56:59], a[108:111], v[28:31], v[56:59]
buffer_load_dwordx4 v6, s[8:11], s50 offen offset:1024 lds
v_mfma_f32_16x16x32_bf16 v[60:63], a[104:107], v[32:35], v[60:63]
ds_read_b128 v[24:27], v10 offset:34816
v_mfma_f32_16x16x32_bf16 v[64:67], a[108:111], v[32:35], v[64:67]
s_waitcnt vmcnt(13)
v_mov_b32 v17, s42
s_mov_b64 exec, 1
buffer_store_dword v17, v16, s[84:87], s49 offen sc1
s_mov_b64 exec, -1
s_add_u32 m0, s46, 35712
s_waitcnt lgkmcnt(4)
v_mfma_f32_16x16x32_bf16 v[52:55], a[112:115], v[36:39], v[52:55]
ds_read_b128 v[28:31], v11 offset:32768
v_mfma_f32_16x16x32_bf16 v[56:59], a[116:119], v[36:39], v[56:59]
buffer_load_dwordx4 v6, s[8:11], s50 offen offset:1152 lds
v_mfma_f32_16x16x32_bf16 v[60:63], a[112:115], v[40:43], v[60:63]
ds_read_b128 v[32:35], v11 offset:34816
v_mfma_f32_16x16x32_bf16 v[64:67], a[116:119], v[40:43], v[64:67]
v_mov_b32 v100, 0
s_mov_b64 exec, 1
buffer_atomic_add v100, v16, s[84:87], s62 offen sc0 sc1
s_mov_b64 exec, -1
s_add_u32 m0, s46, 39680
s_waitcnt lgkmcnt(4)
v_mfma_f32_16x16x32_bf16 v[52:55], a[120:123], v[44:47], v[52:55]
ds_read_b128 v[36:39], v10 offset:36864
v_mfma_f32_16x16x32_bf16 v[56:59], a[124:127], v[44:47], v[56:59]
buffer_load_dwordx4 v6, s[8:11], s50 offen offset:1280 lds
v_mfma_f32_16x16x32_bf16 v[60:63], a[120:123], v[48:51], v[60:63]
ds_read_b128 v[40:43], v10 offset:38912
v_mfma_f32_16x16x32_bf16 v[64:67], a[124:127], v[48:51], v[64:67]
s_add_u32 m0, s46, 43648
s_waitcnt lgkmcnt(4)
v_mfma_f32_16x16x32_bf16 v[52:55], a[128:131], v[20:23], v[52:55]
ds_read_b128 v[44:47], v11 offset:36864
v_mfma_f32_16x16x32_bf16 v[56:59], a[132:135], v[20:23], v[56:59]
buffer_load_dwordx4 v6, s[8:11], s50 offen offset:1408 lds
v_mfma_f32_16x16x32_bf16 v[60:63], a[128:131], v[24:27], v[60:63]
ds_read_b128 v[48:51], v11 offset:38912
v_mfma_f32_16x16x32_bf16 v[64:67], a[132:135], v[24:27], v[64:67]
s_add_u32 m0, s46, 47616
s_waitcnt lgkmcnt(4)
v_mfma_f32_16x16x32_bf16 v[52:55], a[136:139], v[28:31], v[52:55]
ds_read_b128 v[20:23], v10 offset:40960
v_mfma_f32_16x16x32_bf16 v[56:59], a[140:143], v[28:31], v[56:59]
buffer_load_dwordx4 v6, s[8:11], s50 offen offset:1536 lds
v_mfma_f32_16x16x32_bf16 v[60:63], a[136:139], v[32:35], v[60:63]
ds_read_b128 v[24:27], v10 offset:43008
v_mfma_f32_16x16x32_bf16 v[64:67], a[140:143], v[32:35], v[64:67]
s_add_u32 m0, s46, 51584
s_waitcnt lgkmcnt(4)
v_mfma_f32_16x16x32_bf16 v[52:55], a[144:147], v[36:39], v[52:55]
ds_read_b128 v[28:31], v11 offset:40960
v_mfma_f32_16x16x32_bf16 v[56:59], a[148:151], v[36:39], v[56:59]
buffer_load_dwordx4 v6, s[8:11], s50 offen offset:1664 lds
v_mfma_f32_16x16x32_bf16 v[60:63], a[144:147], v[40:43], v[60:63]
ds_read_b128 v[32:35], v11 offset:43008
v_mfma_f32_16x16x32_bf16 v[64:67], a[148:151], v[40:43], v[64:67]
s_add_u32 m0, s46, 55552
s_waitcnt lgkmcnt(4)
v_mfma_f32_16x16x32_bf16 v[52:55], a[152:155], v[44:47], v[52:55]
ds_read_b128 v[36:39], v10 offset:45056
v_mfma_f32_16x16x32_bf16 v[56:59], a[156:159], v[44:47], v[56:59]
buffer_load_dwordx4 v6, s[8:11], s50 offen offset:1792 lds
v_mfma_f32_16x16x32_bf16 v[60:63], a[152:155], v[48:51], v[60:63]
ds_read_b128 v[40:43], v10 offset:47104
v_mfma_f32_16x16x32_bf16 v[64:67], a[156:159], v[48:51], v[64:67]
s_add_u32 m0, s46, 59520
s_waitcnt lgkmcnt(4)
v_mfma_f32_16x16x32_bf16 v[52:55], a[160:163], v[20:23], v[52:55]
ds_read_b128 v[44:47], v11 offset:45056
v_mfma_f32_16x16x32_bf16 v[56:59], a[164:167], v[20:23], v[56:59]
buffer_load_dwordx4 v6, s[8:11], s50 offen offset:1920 lds
v_mfma_f32_16x16x32_bf16 v[60:63], a[160:163], v[24:27], v[60:63]
ds_read_b128 v[48:51], v11 offset:47104
v_mfma_f32_16x16x32_bf16 v[64:67], a[164:167], v[24:27], v[64:67]
s_waitcnt lgkmcnt(4)
v_mfma_f32_16x16x32_bf16 v[52:55], a[168:171], v[28:31], v[52:55]
ds_read_b128 v[20:23], v10 offset:49152
v_mfma_f32_16x16x32_bf16 v[56:59], a[172:175], v[28:31], v[56:59]
v_mfma_f32_16x16x32_bf16 v[60:63], a[168:171], v[32:35], v[60:63]
ds_read_b128 v[24:27], v10 offset:51200
v_mfma_f32_16x16x32_bf16 v[64:67], a[172:175], v[32:35], v[64:67]
v_cvt_pk_bf16_f32 v84, v68, v69
v_cvt_pk_bf16_f32 v85, v70, v71
s_waitcnt lgkmcnt(4)
v_mfma_f32_16x16x32_bf16 v[52:55], a[176:179], v[36:39], v[52:55]
ds_read_b128 v[28:31], v11 offset:49152
v_mfma_f32_16x16x32_bf16 v[56:59], a[180:183], v[36:39], v[56:59]
v_mfma_f32_16x16x32_bf16 v[60:63], a[176:179], v[40:43], v[60:63]
ds_read_b128 v[32:35], v11 offset:51200
v_mfma_f32_16x16x32_bf16 v[64:67], a[180:183], v[40:43], v[64:67]
v_cvt_pk_bf16_f32 v86, v72, v73
v_cvt_pk_bf16_f32 v87, v74, v75
s_waitcnt lgkmcnt(4)
v_mfma_f32_16x16x32_bf16 v[52:55], a[184:187], v[44:47], v[52:55]
ds_read_b128 v[36:39], v10 offset:53248
v_mfma_f32_16x16x32_bf16 v[56:59], a[188:191], v[44:47], v[56:59]
v_mfma_f32_16x16x32_bf16 v[60:63], a[184:187], v[48:51], v[60:63]
ds_read_b128 v[40:43], v10 offset:55296
v_mfma_f32_16x16x32_bf16 v[64:67], a[188:191], v[48:51], v[64:67]
v_cvt_pk_bf16_f32 v88, v76, v77
v_cvt_pk_bf16_f32 v89, v78, v79
s_waitcnt lgkmcnt(4)
v_mfma_f32_16x16x32_bf16 v[52:55], a[192:195], v[20:23], v[52:55]
ds_read_b128 v[44:47], v11 offset:53248
v_mfma_f32_16x16x32_bf16 v[56:59], a[196:199], v[20:23], v[56:59]
v_mfma_f32_16x16x32_bf16 v[60:63], a[192:195], v[24:27], v[60:63]
ds_read_b128 v[48:51], v11 offset:55296
v_mfma_f32_16x16x32_bf16 v[64:67], a[196:199], v[24:27], v[64:67]
v_cvt_pk_bf16_f32 v90, v80, v81
v_cvt_pk_bf16_f32 v91, v82, v83
s_waitcnt lgkmcnt(4)
v_mfma_f32_16x16x32_bf16 v[52:55], a[200:203], v[28:31], v[52:55]
ds_read_b128 v[20:23], v10 offset:57344
v_mfma_f32_16x16x32_bf16 v[56:59], a[204:207], v[28:31], v[56:59]
v_mfma_f32_16x16x32_bf16 v[60:63], a[200:203], v[32:35], v[60:63]
ds_read_b128 v[24:27], v10 offset:59392
v_mfma_f32_16x16x32_bf16 v[64:67], a[204:207], v[32:35], v[64:67]
s_waitcnt lgkmcnt(4)
v_mfma_f32_16x16x32_bf16 v[52:55], a[208:211], v[36:39], v[52:55]
ds_read_b128 v[28:31], v11 offset:57344
v_mfma_f32_16x16x32_bf16 v[56:59], a[212:215], v[36:39], v[56:59]
v_mfma_f32_16x16x32_bf16 v[60:63], a[208:211], v[40:43], v[60:63]
ds_read_b128 v[32:35], v11 offset:59392
v_mfma_f32_16x16x32_bf16 v[64:67], a[212:215], v[40:43], v[64:67]
s_waitcnt lgkmcnt(4)
v_mfma_f32_16x16x32_bf16 v[52:55], a[216:219], v[44:47], v[52:55]
ds_read_b128 v[36:39], v10 offset:61440
v_mfma_f32_16x16x32_bf16 v[56:59], a[220:223], v[44:47], v[56:59]
s_waitcnt vmcnt(6)
v_readfirstlane_b32 s56, v100
s_cmp_eq_u32 s30, 1
s_cbranch_scc1 mega_kernel_q_kf1
s_cmp_gt_i32 s56, s42
s_cbranch_scc0 mega_kernel_q_kf1
s_mov_b32 s30, 1
s_mov_b32 m0, s61
s_nop 0
buffer_load_dwordx4 v5, s[84:87], s68 offen sc1 lds
mega_kernel_q_kf1:
v_mfma_f32_16x16x32_bf16 v[60:63], a[216:219], v[48:51], v[60:63]
ds_read_b128 v[40:43], v10 offset:63488
v_mfma_f32_16x16x32_bf16 v[64:67], a[220:223], v[48:51], v[64:67]
s_waitcnt lgkmcnt(4)
v_mfma_f32_16x16x32_bf16 v[52:55], a[224:227], v[20:23], v[52:55]
ds_read_b128 v[44:47], v11 offset:61440
v_mfma_f32_16x16x32_bf16 v[56:59], a[228:231], v[20:23], v[56:59]
v_mfma_f32_16x16x32_bf16 v[60:63], a[224:227], v[24:27], v[60:63]
ds_read_b128 v[48:51], v11 offset:63488
v_mfma_f32_16x16x32_bf16 v[64:67], a[228:231], v[24:27], v[64:67]
s_waitcnt lgkmcnt(5)
v_mfma_f32_16x16x32_bf16 v[52:55], a[232:235], v[28:31], v[52:55]
v_mfma_f32_16x16x32_bf16 v[56:59], a[236:239], v[28:31], v[56:59]
s_waitcnt lgkmcnt(4)
v_mfma_f32_16x16x32_bf16 v[60:63], a[232:235], v[32:35], v[60:63]
v_mfma_f32_16x16x32_bf16 v[64:67], a[236:239], v[32:35], v[64:67]
s_waitcnt lgkmcnt(3)
v_mfma_f32_16x16x32_bf16 v[52:55], a[240:243], v[36:39], v[52:55]
v_mfma_f32_16x16x32_bf16 v[56:59], a[244:247], v[36:39], v[56:59]
s_waitcnt lgkmcnt(2)
v_mfma_f32_16x16x32_bf16 v[60:63], a[240:243], v[40:43], v[60:63]
v_mfma_f32_16x16x32_bf16 v[64:67], a[244:247], v[40:43], v[64:67]
ds_write_b128 v101, v[84:87]
ds_write_b128 v101, v[88:91] offset:1024
s_waitcnt lgkmcnt(1)
v_mfma_f32_16x16x32_bf16 v[68:71], a[248:251], v[44:47], v[52:55]
v_mfma_f32_16x16x32_bf16 v[72:75], a[252:255], v[44:47], v[56:59]
s_waitcnt lgkmcnt(0)
v_mfma_f32_16x16x32_bf16 v[76:79], a[248:251], v[48:51], v[60:63]
v_mfma_f32_16x16x32_bf16 v[80:83], a[252:255], v[48:51], v[64:67]
s_cmp_eq_u32 s30, 1
s_cbranch_scc1 mega_kernel_q_kl1
mega_kernel_q_kw1:
v_mov_b32 v100, 0
s_mov_b64 exec, 1
buffer_atomic_add v100, v16, s[84:87], s62 offen sc0 sc1
s_mov_b64 exec, -1
s_waitcnt vmcnt(0)
v_readfirstlane_b32 s56, v100
s_cmp_gt_i32 s56, s42
s_cbranch_scc0 mega_kernel_q_kw1
s_mov_b32 m0, s61
s_nop 0
buffer_load_dwordx4 v5, s[84:87], s68 offen sc1 lds
mega_kernel_q_kl1:
s_waitcnt lgkmcnt(0) vmcnt(0)
s_barrier
ds_read_b128 v[184:187], v102 offset:0
ds_read_b128 v[112:115], v103 offset:0
ds_read_b128 v[128:131], v103 offset:1024
ds_read_b128 v[188:191], v102 offset:2048
ds_read_b128 v[116:119], v103 offset:2048
ds_read_b128 v[132:135], v103 offset:3072
ds_read_b128 v[192:195], v102 offset:4096
ds_read_b128 v[120:123], v103 offset:4096
ds_read_b128 v[136:139], v103 offset:5120
ds_read_b128 v[196:199], v102 offset:6144
ds_read_b128 v[124:127], v103 offset:6144
ds_read_b128 v[140:143], v103 offset:7168
s_waitcnt lgkmcnt(9)
v_mfma_f32_16x16x32_bf16 v[200:203], v[112:115], v[184:187], 0
v_mfma_f32_16x16x32_bf16 v[204:207], v[128:131], v[184:187], 0
ds_read_b128 v[160:163], v94 offset:0
s_waitcnt lgkmcnt(7)
v_mfma_f32_16x16x32_bf16 v[200:203], v[116:119], v[188:191], v[200:203]
v_mfma_f32_16x16x32_bf16 v[204:207], v[132:135], v[188:191], v[204:207]
ds_read_b128 v[164:167], v94 offset:1024
s_waitcnt lgkmcnt(5)
v_mfma_f32_16x16x32_bf16 v[200:203], v[120:123], v[192:195], v[200:203]
v_mfma_f32_16x16x32_bf16 v[204:207], v[136:139], v[192:195], v[204:207]
ds_read_b128 v[168:171], v94 offset:2048
s_waitcnt lgkmcnt(3)
v_mfma_f32_16x16x32_bf16 v[200:203], v[124:127], v[196:199], v[200:203]
v_mfma_f32_16x16x32_bf16 v[204:207], v[140:143], v[196:199], v[204:207]
ds_read_b128 v[172:175], v94 offset:3072
s_waitcnt lgkmcnt(3)
v_mfma_f32_16x16x32_bf16 v[208:211], v[160:163], v[184:187], 0
ds_read_b128 v[144:147], v240 offset:0
ds_read_b64 v[176:177], v95 offset:0
s_waitcnt lgkmcnt(4)
v_mfma_f32_16x16x32_bf16 v[208:211], v[164:167], v[188:191], v[208:211]
ds_read_b128 v[148:151], v240 offset:1024
ds_read_b64 v[178:179], v95 offset:256
s_waitcnt lgkmcnt(5)
v_mfma_f32_16x16x32_bf16 v[208:211], v[168:171], v[192:195], v[208:211]
ds_read_b128 v[152:155], v240 offset:2048
ds_read_b64 v[180:181], v95 offset:1024
s_waitcnt lgkmcnt(6)
v_mfma_f32_16x16x32_bf16 v[208:211], v[172:175], v[196:199], v[208:211]
ds_read_b128 v[156:159], v240 offset:3072
ds_read_b64 v[182:183], v95 offset:1280
v_pk_mul_f32 v[200:201], v[200:201], s[54:55] op_sel_hi:[1,0]
v_pk_mul_f32 v[202:203], v[202:203], s[54:55] op_sel_hi:[1,0]
v_pk_mul_f32 v[204:205], v[204:205], s[54:55] op_sel_hi:[1,0]
v_pk_mul_f32 v[206:207], v[206:207], s[54:55] op_sel_hi:[1,0]
v_cndmask_b32 v200, v200, v241, s[12:13]
v_cndmask_b32 v201, v201, v241, s[14:15]
v_cndmask_b32 v202, v202, v241, s[16:17]
v_cndmask_b32 v203, v203, v241, s[18:19]
v_cndmask_b32 v204, v204, v241, s[20:21]
v_cndmask_b32 v205, v205, v241, s[22:23]
v_cndmask_b32 v206, v206, v241, s[24:25]
v_cndmask_b32 v207, v207, v241, s[26:27]
v_pk_mul_f32 v[208:209], v[208:209], s[54:55] op_sel_hi:[1,0]
v_pk_mul_f32 v[210:211], v[210:211], s[54:55] op_sel_hi:[1,0]
v_cndmask_b32 v208, v208, v97, s[28:29]
v_cndmask_b32 v209, v209, v97, s[28:29]
v_cndmask_b32 v210, v210, v97, s[28:29]
v_cndmask_b32 v211, v211, v97, s[28:29]
v_max3_f32 v236, v200, v201, v202
v_max3_f32 v236, v236, v203, v204
v_max3_f32 v236, v236, v205, v206
v_max3_f32 v236, v236, v207, v208
v_max3_f32 v236, v236, v209, v210
v_max_f32 v237, v236, v211
v_max_f32 v236, v236, v211
s_nop 1
v_permlane16_swap_b32 v236, v237
s_nop 0
v_max_f32 v238, v236, v237
v_max_f32 v239, v236, v237
s_nop 1
v_permlane32_swap_b32 v238, v239
s_nop 0
v_max_f32 v236, v238, v239
v_pk_add_f32 v[200:201], v[200:201], v[236:237] op_sel_hi:[1,0] neg_lo:[0,1] neg_hi:[0,1]
v_pk_add_f32 v[202:203], v[202:203], v[236:237] op_sel_hi:[1,0] neg_lo:[0,1] neg_hi:[0,1]
v_pk_add_f32 v[204:205], v[204:205], v[236:237] op_sel_hi:[1,0] neg_lo:[0,1] neg_hi:[0,1]
v_pk_add_f32 v[206:207], v[206:207], v[236:237] op_sel_hi:[1,0] neg_lo:[0,1] neg_hi:[0,1]
v_pk_add_f32 v[208:209], v[208:209], v[236:237] op_sel_hi:[1,0] neg_lo:[0,1] neg_hi:[0,1]
v_pk_add_f32 v[210:211], v[210:211], v[236:237] op_sel_hi:[1,0] neg_lo:[0,1] neg_hi:[0,1]
v_exp_f32 v200, v200
v_exp_f32 v201, v201
v_exp_f32 v202, v202
v_exp_f32 v203, v203
v_exp_f32 v204, v204
v_exp_f32 v205, v205
v_exp_f32 v206, v206
v_exp_f32 v207, v207
v_exp_f32 v208, v208
v_exp_f32 v209, v209
v_exp_f32 v210, v210
v_exp_f32 v211, v211
s_nop 0
v_cvt_pk_bf16_f32 v212, v200, v201
v_cvt_pk_bf16_f32 v213, v202, v203
v_cvt_pk_bf16_f32 v214, v204, v205
v_cvt_pk_bf16_f32 v215, v206, v207
v_cvt_pk_bf16_f32 v216, v208, v209
v_cvt_pk_bf16_f32 v217, v210, v211
s_waitcnt lgkmcnt(0)
s_nop 0
v_mfma_f32_16x16x32_bf16 v[108:111], v[104:107], v[212:215], 0
v_mfma_f32_16x16x32_bf16 v[220:223], v[144:147], v[212:215], 0
v_mfma_f32_16x16x32_bf16 v[224:227], v[148:151], v[212:215], 0
v_mfma_f32_16x16x32_bf16 v[228:231], v[152:155], v[212:215], 0
v_mfma_f32_16x16x32_bf16 v[232:235], v[156:159], v[212:215], 0
v_mfma_f32_16x16x16_bf16 v[108:111], v[104:105], v[216:217], v[108:111]
v_mfma_f32_16x16x16_bf16 v[220:223], v[176:177], v[216:217], v[220:223]
v_mfma_f32_16x16x16_bf16 v[224:227], v[178:179], v[216:217], v[224:227]
v_mfma_f32_16x16x16_bf16 v[228:231], v[180:181], v[216:217], v[228:231]
v_mfma_f32_16x16x16_bf16 v[232:235], v[182:183], v[216:217], v[232:235]
s_lshl_b32 s51, s42, 18
s_nop 2
v_rcp_f32 v238, v108
v_rcp_f32 v239, v109
s_nop 1
v_pk_mul_f32 v[220:221], v[220:221], v[238:239]
v_pk_mul_f32 v[222:223], v[222:223], v[238:239]
v_pk_mul_f32 v[224:225], v[224:225], v[238:239]
v_pk_mul_f32 v[226:227], v[226:227], v[238:239]
v_pk_mul_f32 v[228:229], v[228:229], v[238:239]
v_pk_mul_f32 v[230:231], v[230:231], v[238:239]
v_pk_mul_f32 v[232:233], v[232:233], v[238:239]
v_pk_mul_f32 v[234:235], v[234:235], v[238:239]
v_cvt_pk_bf16_f32 v200, v220, v221
v_cvt_pk_bf16_f32 v201, v222, v223
v_cvt_pk_bf16_f32 v202, v224, v225
v_cvt_pk_bf16_f32 v203, v226, v227
v_cvt_pk_bf16_f32 v204, v228, v229
v_cvt_pk_bf16_f32 v205, v230, v231
v_cvt_pk_bf16_f32 v206, v232, v233
v_cvt_pk_bf16_f32 v207, v234, v235
buffer_store_dwordx4 v[200:203], v96, s[84:87], s51 offen sc1
buffer_store_dwordx4 v[204:207], v96, s[84:87], s51 offen offset:2048 sc1
s_add_u32 s42, s42, 1
s_barrier
s_cmp_gt_i32 s55, s42
s_cbranch_scc1 mega_kernel_q_kv0k
mega_kernel_q_kv0w:
buffer_load_dword v2, v99, s[84:87], 0 offen sc1
s_waitcnt vmcnt(0)
v_min_i32_dpp v2, v2, v2 quad_perm:[1,0,3,2] row_mask:0xf bank_mask:0xf
s_nop 1
v_min_i32_dpp v2, v2, v2 quad_perm:[2,3,0,1] row_mask:0xf bank_mask:0xf
s_nop 1
v_min_i32_dpp v2, v2, v2 row_ror:4 row_mask:0xf bank_mask:0xf
s_nop 0
v_readfirstlane_b32 s55, v2
s_cmp_gt_i32 s55, s42
s_cbranch_scc1 mega_kernel_q_kv0k
s_sleep 4
s_branch mega_kernel_q_kv0w
mega_kernel_q_kv0k:
s_cmp_eq_u32 s42, 63
s_cbranch_scc0 mega_kernel_q_nl
s_add_u32 s51, s47, s42
s_bfe_u32 s57, s51, 0x40002
s_lshl_b32 s57, s57, 14
s_and_b32 s66, s51, 3
s_lshl_b32 s66, s66, 11
s_add_u32 s66, s66, s57
s_add_u32 s66, s66, s58
s_add_u32 s67, s66, 33554432
s_bfe_u32 s57, s51, 0x30003
s_lshl_b32 s57, s57, 14
s_and_b32 s68, s51, 7
s_lshl_b32 s68, s68, 10
s_add_u32 s68, s68, s57
s_add_u32 s68, s68, s59
s_add_u32 s50, s42, 2
s_min_u32 s50, s50, 63
s_lshl_b32 s50, s50, 16
s_cmp_gt_i32 s56, s42
s_cselect_b32 s30, 1, 0
s_add_u32 m0, s60, 0
s_nop 0
buffer_load_dwordx4 v5, s[84:87], s66 offen offset:0 sc1 lds
s_add_u32 m0, s60, 0
s_nop 0
buffer_load_dwordx4 v5, s[84:87], s66 offen offset:1024 sc1 lds
s_add_u32 m0, s60, 8192
s_nop 0
buffer_load_dwordx4 v5, s[84:87], s67 offen offset:0 sc1 lds
s_add_u32 m0, s60, 8192
s_nop 0
buffer_load_dwordx4 v5, s[84:87], s67 offen offset:1024 sc1 lds
s_cmp_eq_u32 s30, 1
s_cbranch_scc0 mega_kernel_q_ke2
s_mov_b32 m0, s61
s_nop 0
buffer_load_dwordx4 v5, s[84:87], s68 offen sc1 lds
mega_kernel_q_ke2:
v_cvt_pk_bf16_f32 v84, v68, v69
v_cvt_pk_bf16_f32 v85, v70, v71
v_cvt_pk_bf16_f32 v86, v72, v73
v_cvt_pk_bf16_f32 v87, v74, v75
v_cvt_pk_bf16_f32 v88, v76, v77
v_cvt_pk_bf16_f32 v89, v78, v79
v_cvt_pk_bf16_f32 v90, v80, v81
v_cvt_pk_bf16_f32 v91, v82, v83
ds_write_b128 v101, v[84:87]
ds_write_b128 v101, v[88:91] offset:1024
s_waitcnt vmcnt(4)
v_mov_b32 v17, s42
s_mov_b64 exec, 1
buffer_store_dword v17, v16, s[84:87], s49 offen sc1
s_mov_b64 exec, -1
s_branch mega_kernel_q_jl
mega_kernel_q_nl:
ds_read_b128 v[20:23], v8 offset:0
ds_read_b128 v[24:27], v8 offset:2048
ds_read_b128 v[28:31], v9 offset:0
ds_read_b128 v[32:35], v9 offset:2048
ds_read_b128 v[36:39], v8 offset:4096
ds_read_b128 v[40:43], v8 offset:6144
s_add_u32 s51, s47, s42
s_bfe_u32 s57, s51, 0x40002
s_lshl_b32 s57, s57, 14
s_and_b32 s66, s51, 3
s_lshl_b32 s66, s66, 11
s_add_u32 s66, s66, s57
s_add_u32 s66, s66, s58
s_add_u32 s67, s66, 33554432
s_bfe_u32 s57, s51, 0x30003
s_lshl_b32 s57, s57, 14
s_and_b32 s68, s51, 7
s_lshl_b32 s68, s68, 10
s_add_u32 s68, s68, s57
s_add_u32 s68, s68, s59
s_add_u32 s50, s42, 2
s_min_u32 s50, s50, 63
s_lshl_b32 s50, s50, 16
s_cmp_gt_i32 s56, s42
s_cselect_b32 s30, 1, 0
s_add_u32 m0, s60, 0
s_waitcnt lgkmcnt(4)
v_mfma_f32_16x16x32_bf16 v[52:55], a[0:3], v[20:23], 0
ds_read_b128 v[44:47], v9 offset:4096
v_mfma_f32_16x16x32_bf16 v[56:59], a[4:7], v[20:23], 0
buffer_load_dwordx4 v5, s[84:87], s66 offen offset:0 sc1 lds
v_mfma_f32_16x16x32_bf16 v[60:63], a[0:3], v[24:27], 0
ds_read_b128 v[48:51], v9 offset:6144
v_mfma_f32_16x16x32_bf16 v[64:67], a[4:7], v[24:27], 0
s_add_u32 m0, s60, 0
s_waitcnt lgkmcnt(4)
v_mfma_f32_16x16x32_bf16 v[52:55], a[8:11], v[28:31], v[52:55]
ds_read_b128 v[20:23], v8 offset:8192
v_mfma_f32_16x16x32_bf16 v[56:59], a[12:15], v[28:31], v[56:59]
buffer_load_dwordx4 v5, s[84:87], s66 offen offset:1024 sc1 lds
v_mfma_f32_16x16x32_bf16 v[60:63], a[8:11], v[32:35], v[60:63]
ds_read_b128 v[24:27], v8 offset:10240
v_mfma_f32_16x16x32_bf16 v[64:67], a[12:15], v[32:35], v[64:67]
s_add_u32 m0, s60, 8192
s_waitcnt lgkmcnt(4)
v_mfma_f32_16x16x32_bf16 v[52:55], a[16:19], v[36:39], v[52:55]
ds_read_b128 v[28:31], v9 offset:8192
v_mfma_f32_16x16x32_bf16 v[56:59], a[20:23], v[36:39], v[56:59]
buffer_load_dwordx4 v5, s[84:87], s67 offen offset:0 sc1 lds
v_mfma_f32_16x16x32_bf16 v[60:63], a[16:19], v[40:43], v[60:63]
ds_read_b128 v[32:35], v9 offset:10240
v_mfma_f32_16x16x32_bf16 v[64:67], a[20:23], v[40:43], v[64:67]
s_add_u32 m0, s60, 8192
s_waitcnt lgkmcnt(4)
v_mfma_f32_16x16x32_bf16 v[52:55], a[24:27], v[44:47], v[52:55]
ds_read_b128 v[36:39], v8 offset:12288
v_mfma_f32_16x16x32_bf16 v[56:59], a[28:31], v[44:47], v[56:59]
buffer_load_dwordx4 v5, s[84:87], s67 offen offset:1024 sc1 lds
v_mfma_f32_16x16x32_bf16 v[60:63], a[24:27], v[48:51], v[60:63]
ds_read_b128 v[40:43], v8 offset:14336
v_mfma_f32_16x16x32_bf16 v[64:67], a[28:31], v[48:51], v[64:67]
s_waitcnt lgkmcnt(4)
v_mfma_f32_16x16x32_bf16 v[52:55], a[32:35], v[20:23], v[52:55]
ds_read_b128 v[44:47], v9 offset:12288
v_mfma_f32_16x16x32_bf16 v[56:59], a[36:39], v[20:23], v[56:59]
s_cmp_eq_u32 s30, 1
s_cbranch_scc0 mega_kernel_q_ke0
s_mov_b32 m0, s61
s_nop 0
buffer_load_dwordx4 v5, s[84:87], s68 offen sc1 lds
mega_kernel_q_ke0:
v_mfma_f32_16x16x32_bf16 v[60:63], a[32:35], v[24:27], v[60:63]
ds_read_b128 v[48:51], v9 offset:14336
v_mfma_f32_16x16x32_bf16 v[64:67], a[36:39], v[24:27], v[64:67]
s_add_u32 m0, s46, 65536
s_waitcnt lgkmcnt(4)
v_mfma_f32_16x16x32_bf16 v[52:55], a[40:43], v[28:31], v[52:55]
ds_read_b128 v[20:23], v8 offset:16384
v_mfma_f32_16x16x32_bf16 v[56:59], a[44:47], v[28:31], v[56:59]
buffer_load_dwordx4 v6, s[8:11], s50 offen offset:0 lds
v_mfma_f32_16x16x32_bf16 v[60:63], a[40:43], v[32:35], v[60:63]
ds_read_b128 v[24:27], v8 offset:18432
v_mfma_f32_16x16x32_bf16 v[64:67], a[44:47], v[32:35], v[64:67]
s_add_u32 m0, s46, 69504
s_waitcnt lgkmcnt(4)
v_mfma_f32_16x16x32_bf16 v[52:55], a[48:51], v[36:39], v[52:55]
ds_read_b128 v[28:31], v9 offset:16384
v_mfma_f32_16x16x32_bf16 v[56:59], a[52:55], v[36:39], v[56:59]
buffer_load_dwordx4 v6, s[8:11], s50 offen offset:128 lds
v_mfma_f32_16x16x32_bf16 v[60:63], a[48:51], v[40:43], v[60:63]
ds_read_b128 v[32:35], v9 offset:18432
v_mfma_f32_16x16x32_bf16 v[64:67], a[52:55], v[40:43], v[64:67]
s_add_u32 m0, s46, 73472
s_waitcnt lgkmcnt(4)
v_mfma_f32_16x16x32_bf16 v[52:55], a[56:59], v[44:47], v[52:55]
ds_read_b128 v[36:39], v8 offset:20480
v_mfma_f32_16x16x32_bf16 v[56:59], a[60:63], v[44:47], v[56:59]
buffer_load_dwordx4 v6, s[8:11], s50 offen offset:256 lds
v_mfma_f32_16x16x32_bf16 v[60:63], a[56:59], v[48:51], v[60:63]
ds_read_b128 v[40:43], v8 offset:22528
v_mfma_f32_16x16x32_bf16 v[64:67], a[60:63], v[48:51], v[64:67]
s_add_u32 m0, s46, 77440
s_waitcnt lgkmcnt(4)
v_mfma_f32_16x16x32_bf16 v[52:55], a[64:67], v[20:23], v[52:55]
ds_read_b128 v[44:47], v9 offset:20480
v_mfma_f32_16x16x32_bf16 v[56:59], a[68:71], v[20:23], v[56:59]
buffer_load_dwordx4 v6, s[8:11], s50 offen offset:384 lds
v_mfma_f32_16x16x32_bf16 v[60:63], a[64:67], v[24:27], v[60:63]
ds_read_b128 v[48:51], v9 offset:22528
v_mfma_f32_16x16x32_bf16 v[64:67], a[68:71], v[24:27], v[64:67]
s_add_u32 m0, s46, 81408
s_waitcnt lgkmcnt(4)
v_mfma_f32_16x16x32_bf16 v[52:55], a[72:75], v[28:31], v[52:55]
ds_read_b128 v[20:23], v8 offset:24576
v_mfma_f32_16x16x32_bf16 v[56:59], a[76:79], v[28:31], v[56:59]
buffer_load_dwordx4 v6, s[8:11], s50 offen offset:512 lds
v_mfma_f32_16x16x32_bf16 v[60:63], a[72:75], v[32:35], v[60:63]
ds_read_b128 v[24:27], v8 offset:26624
v_mfma_f32_16x16x32_bf16 v[64:67], a[76:79], v[32:35], v[64:67]
s_add_u32 m0, s46, 85376
s_waitcnt lgkmcnt(4)
v_mfma_f32_16x16x32_bf16 v[52:55], a[80:83], v[36:39], v[52:55]
ds_read_b128 v[28:31], v9 offset:24576
v_mfma_f32_16x16x32_bf16 v[56:59], a[84:87], v[36:39], v[56:59]
buffer_load_dwordx4 v6, s[8:11], s50 offen offset:640 lds
v_mfma_f32_16x16x32_bf16 v[60:63], a[80:83], v[40:43], v[60:63]
ds_read_b128 v[32:35], v9 offset:26624
v_mfma_f32_16x16x32_bf16 v[64:67], a[84:87], v[40:43], v[64:67]
s_add_u32 m0, s46, 89344
s_waitcnt lgkmcnt(4)
v_mfma_f32_16x16x32_bf16 v[52:55], a[88:91], v[44:47], v[52:55]
ds_read_b128 v[36:39], v8 offset:28672
v_mfma_f32_16x16x32_bf16 v[56:59], a[92:95], v[44:47], v[56:59]
buffer_load_dwordx4 v6, s[8:11], s50 offen offset:768 lds
v_mfma_f32_16x16x32_bf16 v[60:63], a[88:91], v[48:51], v[60:63]
ds_read_b128 v[40:43], v8 offset:30720
v_mfma_f32_16x16x32_bf16 v[64:67], a[92:95], v[48:51], v[64:67]
s_add_u32 m0, s46, 93312
s_waitcnt lgkmcnt(4)
v_mfma_f32_16x16x32_bf16 v[52:55], a[96:99], v[20:23], v[52:55]
ds_read_b128 v[44:47], v9 offset:28672
v_mfma_f32_16x16x32_bf16 v[56:59], a[100:103], v[20:23], v[56:59]
buffer_load_dwordx4 v6, s[8:11], s50 offen offset:896 lds
v_mfma_f32_16x16x32_bf16 v[60:63], a[96:99], v[24:27], v[60:63]
ds_read_b128 v[48:51], v9 offset:30720
v_mfma_f32_16x16x32_bf16 v[64:67], a[100:103], v[24:27], v[64:67]
s_add_u32 m0, s46, 97280
s_waitcnt lgkmcnt(4)
v_mfma_f32_16x16x32_bf16 v[52:55], a[104:107], v[28:31], v[52:55]
ds_read_b128 v[20:23], v8 offset:32768
v_mfma_f32_16x16x32_bf16 v[56:59], a[108:111], v[28:31], v[56:59]
buffer_load_dwordx4 v6, s[8:11], s50 offen offset:1024 lds
v_mfma_f32_16x16x32_bf16 v[60:63], a[104:107], v[32:35], v[60:63]
ds_read_b128 v[24:27], v8 offset:34816
v_mfma_f32_16x16x32_bf16 v[64:67], a[108:111], v[32:35], v[64:67]
s_waitcnt vmcnt(13)
v_mov_b32 v17, s42
s_mov_b64 exec, 1
buffer_store_dword v17, v16, s[84:87], s49 offen sc1
s_mov_b64 exec, -1
s_add_u32 m0, s46, 101248
s_waitcnt lgkmcnt(4)
v_mfma_f32_16x16x32_bf16 v[52:55], a[112:115], v[36:39], v[52:55]
ds_read_b128 v[28:31], v9 offset:32768
v_mfma_f32_16x16x32_bf16 v[56:59], a[116:119], v[36:39], v[56:59]
buffer_load_dwordx4 v6, s[8:11], s50 offen offset:1152 lds
v_mfma_f32_16x16x32_bf16 v[60:63], a[112:115], v[40:43], v[60:63]
ds_read_b128 v[32:35], v9 offset:34816
v_mfma_f32_16x16x32_bf16 v[64:67], a[116:119], v[40:43], v[64:67]
v_mov_b32 v100, 0
s_mov_b64 exec, 1
buffer_atomic_add v100, v16, s[84:87], s62 offen sc0 sc1
s_mov_b64 exec, -1
s_add_u32 m0, s46, 105216
s_waitcnt lgkmcnt(4)
v_mfma_f32_16x16x32_bf16 v[52:55], a[120:123], v[44:47], v[52:55]
ds_read_b128 v[36:39], v8 offset:36864
v_mfma_f32_16x16x32_bf16 v[56:59], a[124:127], v[44:47], v[56:59]
buffer_load_dwordx4 v6, s[8:11], s50 offen offset:1280 lds
v_mfma_f32_16x16x32_bf16 v[60:63], a[120:123], v[48:51], v[60:63]
ds_read_b128 v[40:43], v8 offset:38912
v_mfma_f32_16x16x32_bf16 v[64:67], a[124:127], v[48:51], v[64:67]
s_add_u32 m0, s46, 109184
s_waitcnt lgkmcnt(4)
v_mfma_f32_16x16x32_bf16 v[52:55], a[128:131], v[20:23], v[52:55]
ds_read_b128 v[44:47], v9 offset:36864
v_mfma_f32_16x16x32_bf16 v[56:59], a[132:135], v[20:23], v[56:59]
buffer_load_dwordx4 v6, s[8:11], s50 offen offset:1408 lds
v_mfma_f32_16x16x32_bf16 v[60:63], a[128:131], v[24:27], v[60:63]
ds_read_b128 v[48:51], v9 offset:38912
v_mfma_f32_16x16x32_bf16 v[64:67], a[132:135], v[24:27], v[64:67]
s_add_u32 m0, s46, 113152
s_waitcnt lgkmcnt(4)
v_mfma_f32_16x16x32_bf16 v[52:55], a[136:139], v[28:31], v[52:55]
ds_read_b128 v[20:23], v8 offset:40960
v_mfma_f32_16x16x32_bf16 v[56:59], a[140:143], v[28:31], v[56:59]
buffer_load_dwordx4 v6, s[8:11], s50 offen offset:1536 lds
v_mfma_f32_16x16x32_bf16 v[60:63], a[136:139], v[32:35], v[60:63]
ds_read_b128 v[24:27], v8 offset:43008
v_mfma_f32_16x16x32_bf16 v[64:67], a[140:143], v[32:35], v[64:67]
s_add_u32 m0, s46, 117120
s_waitcnt lgkmcnt(4)
v_mfma_f32_16x16x32_bf16 v[52:55], a[144:147], v[36:39], v[52:55]
ds_read_b128 v[28:31], v9 offset:40960
v_mfma_f32_16x16x32_bf16 v[56:59], a[148:151], v[36:39], v[56:59]
buffer_load_dwordx4 v6, s[8:11], s50 offen offset:1664 lds
v_mfma_f32_16x16x32_bf16 v[60:63], a[144:147], v[40:43], v[60:63]
ds_read_b128 v[32:35], v9 offset:43008
v_mfma_f32_16x16x32_bf16 v[64:67], a[148:151], v[40:43], v[64:67]
s_add_u32 m0, s46, 121088
s_waitcnt lgkmcnt(4)
v_mfma_f32_16x16x32_bf16 v[52:55], a[152:155], v[44:47], v[52:55]
ds_read_b128 v[36:39], v8 offset:45056
v_mfma_f32_16x16x32_bf16 v[56:59], a[156:159], v[44:47], v[56:59]
buffer_load_dwordx4 v6, s[8:11], s50 offen offset:1792 lds
v_mfma_f32_16x16x32_bf16 v[60:63], a[152:155], v[48:51], v[60:63]
ds_read_b128 v[40:43], v8 offset:47104
v_mfma_f32_16x16x32_bf16 v[64:67], a[156:159], v[48:51], v[64:67]
s_add_u32 m0, s46, 125056
s_waitcnt lgkmcnt(4)
v_mfma_f32_16x16x32_bf16 v[52:55], a[160:163], v[20:23], v[52:55]
ds_read_b128 v[44:47], v9 offset:45056
v_mfma_f32_16x16x32_bf16 v[56:59], a[164:167], v[20:23], v[56:59]
buffer_load_dwordx4 v6, s[8:11], s50 offen offset:1920 lds
v_mfma_f32_16x16x32_bf16 v[60:63], a[160:163], v[24:27], v[60:63]
ds_read_b128 v[48:51], v9 offset:47104
v_mfma_f32_16x16x32_bf16 v[64:67], a[164:167], v[24:27], v[64:67]
s_waitcnt lgkmcnt(4)
v_mfma_f32_16x16x32_bf16 v[52:55], a[168:171], v[28:31], v[52:55]
ds_read_b128 v[20:23], v8 offset:49152
v_mfma_f32_16x16x32_bf16 v[56:59], a[172:175], v[28:31], v[56:59]
v_mfma_f32_16x16x32_bf16 v[60:63], a[168:171], v[32:35], v[60:63]
ds_read_b128 v[24:27], v8 offset:51200
v_mfma_f32_16x16x32_bf16 v[64:67], a[172:175], v[32:35], v[64:67]
v_cvt_pk_bf16_f32 v84, v68, v69
v_cvt_pk_bf16_f32 v85, v70, v71
s_waitcnt lgkmcnt(4)
v_mfma_f32_16x16x32_bf16 v[52:55], a[176:179], v[36:39], v[52:55]
ds_read_b128 v[28:31], v9 offset:49152
v_mfma_f32_16x16x32_bf16 v[56:59], a[180:183], v[36:39], v[56:59]
v_mfma_f32_16x16x32_bf16 v[60:63], a[176:179], v[40:43], v[60:63]
ds_read_b128 v[32:35], v9 offset:51200
v_mfma_f32_16x16x32_bf16 v[64:67], a[180:183], v[40:43], v[64:67]
v_cvt_pk_bf16_f32 v86, v72, v73
v_cvt_pk_bf16_f32 v87, v74, v75
s_waitcnt lgkmcnt(4)
v_mfma_f32_16x16x32_bf16 v[52:55], a[184:187], v[44:47], v[52:55]
ds_read_b128 v[36:39], v8 offset:53248
v_mfma_f32_16x16x32_bf16 v[56:59], a[188:191], v[44:47], v[56:59]
v_mfma_f32_16x16x32_bf16 v[60:63], a[184:187], v[48:51], v[60:63]
ds_read_b128 v[40:43], v8 offset:55296
v_mfma_f32_16x16x32_bf16 v[64:67], a[188:191], v[48:51], v[64:67]
v_cvt_pk_bf16_f32 v88, v76, v77
v_cvt_pk_bf16_f32 v89, v78, v79
s_waitcnt lgkmcnt(4)
v_mfma_f32_16x16x32_bf16 v[52:55], a[192:195], v[20:23], v[52:55]
ds_read_b128 v[44:47], v9 offset:53248
v_mfma_f32_16x16x32_bf16 v[56:59], a[196:199], v[20:23], v[56:59]
v_mfma_f32_16x16x32_bf16 v[60:63], a[192:195], v[24:27], v[60:63]
ds_read_b128 v[48:51], v9 offset:55296
v_mfma_f32_16x16x32_bf16 v[64:67], a[196:199], v[24:27], v[64:67]
v_cvt_pk_bf16_f32 v90, v80, v81
v_cvt_pk_bf16_f32 v91, v82, v83
s_waitcnt lgkmcnt(4)
v_mfma_f32_16x16x32_bf16 v[52:55], a[200:203], v[28:31], v[52:55]
ds_read_b128 v[20:23], v8 offset:57344
v_mfma_f32_16x16x32_bf16 v[56:59], a[204:207], v[28:31], v[56:59]
v_mfma_f32_16x16x32_bf16 v[60:63], a[200:203], v[32:35], v[60:63]
ds_read_b128 v[24:27], v8 offset:59392
v_mfma_f32_16x16x32_bf16 v[64:67], a[204:207], v[32:35], v[64:67]
s_waitcnt lgkmcnt(4)
v_mfma_f32_16x16x32_bf16 v[52:55], a[208:211], v[36:39], v[52:55]
ds_read_b128 v[28:31], v9 offset:57344
v_mfma_f32_16x16x32_bf16 v[56:59], a[212:215], v[36:39], v[56:59]
v_mfma_f32_16x16x32_bf16 v[60:63], a[208:211], v[40:43], v[60:63]
ds_read_b128 v[32:35], v9 offset:59392
v_mfma_f32_16x16x32_bf16 v[64:67], a[212:215], v[40:43], v[64:67]
s_waitcnt lgkmcnt(4)
v_mfma_f32_16x16x32_bf16 v[52:55], a[216:219], v[44:47], v[52:55]
ds_read_b128 v[36:39], v8 offset:61440
v_mfma_f32_16x16x32_bf16 v[56:59], a[220:223], v[44:47], v[56:59]
s_waitcnt vmcnt(6)
v_readfirstlane_b32 s56, v100
s_cmp_eq_u32 s30, 1
s_cbranch_scc1 mega_kernel_q_kf0
s_cmp_gt_i32 s56, s42
s_cbranch_scc0 mega_kernel_q_kf0
s_mov_b32 s30, 1
s_mov_b32 m0, s61
s_nop 0
buffer_load_dwordx4 v5, s[84:87], s68 offen sc1 lds
mega_kernel_q_kf0:
v_mfma_f32_16x16x32_bf16 v[60:63], a[216:219], v[48:51], v[60:63]
ds_read_b128 v[40:43], v8 offset:63488
v_mfma_f32_16x16x32_bf16 v[64:67], a[220:223], v[48:51], v[64:67]
s_waitcnt lgkmcnt(4)
v_mfma_f32_16x16x32_bf16 v[52:55], a[224:227], v[20:23], v[52:55]
ds_read_b128 v[44:47], v9 offset:61440
v_mfma_f32_16x16x32_bf16 v[56:59], a[228:231], v[20:23], v[56:59]
v_mfma_f32_16x16x32_bf16 v[60:63], a[224:227], v[24:27], v[60:63]
ds_read_b128 v[48:51], v9 offset:63488
v_mfma_f32_16x16x32_bf16 v[64:67], a[228:231], v[24:27], v[64:67]
s_waitcnt lgkmcnt(5)
v_mfma_f32_16x16x32_bf16 v[52:55], a[232:235], v[28:31], v[52:55]
v_mfma_f32_16x16x32_bf16 v[56:59], a[236:239], v[28:31], v[56:59]
s_waitcnt lgkmcnt(4)
v_mfma_f32_16x16x32_bf16 v[60:63], a[232:235], v[32:35], v[60:63]
v_mfma_f32_16x16x32_bf16 v[64:67], a[236:239], v[32:35], v[64:67]
s_waitcnt lgkmcnt(3)
v_mfma_f32_16x16x32_bf16 v[52:55], a[240:243], v[36:39], v[52:55]
v_mfma_f32_16x16x32_bf16 v[56:59], a[244:247], v[36:39], v[56:59]
s_waitcnt lgkmcnt(2)
v_mfma_f32_16x16x32_bf16 v[60:63], a[240:243], v[40:43], v[60:63]
v_mfma_f32_16x16x32_bf16 v[64:67], a[244:247], v[40:43], v[64:67]
ds_write_b128 v101, v[84:87]
ds_write_b128 v101, v[88:91] offset:1024
s_waitcnt lgkmcnt(1)
v_mfma_f32_16x16x32_bf16 v[68:71], a[248:251], v[44:47], v[52:55]
v_mfma_f32_16x16x32_bf16 v[72:75], a[252:255], v[44:47], v[56:59]
s_waitcnt lgkmcnt(0)
v_mfma_f32_16x16x32_bf16 v[76:79], a[248:251], v[48:51], v[60:63]
v_mfma_f32_16x16x32_bf16 v[80:83], a[252:255], v[48:51], v[64:67]
mega_kernel_q_jl:
s_cmp_eq_u32 s30, 1
s_cbranch_scc1 mega_kernel_q_kl0
mega_kernel_q_kw0:
v_mov_b32 v100, 0
s_mov_b64 exec, 1
buffer_atomic_add v100, v16, s[84:87], s62 offen sc0 sc1
s_mov_b64 exec, -1
s_waitcnt vmcnt(0)
v_readfirstlane_b32 s56, v100
s_cmp_gt_i32 s56, s42
s_cbranch_scc0 mega_kernel_q_kw0
s_mov_b32 m0, s61
s_nop 0
buffer_load_dwordx4 v5, s[84:87], s68 offen sc1 lds
mega_kernel_q_kl0:
s_waitcnt lgkmcnt(0) vmcnt(0)
s_barrier
ds_read_b128 v[184:187], v102 offset:0
ds_read_b128 v[112:115], v103 offset:0
ds_read_b128 v[128:131], v103 offset:1024
ds_read_b128 v[188:191], v102 offset:2048
ds_read_b128 v[116:119], v103 offset:2048
ds_read_b128 v[132:135], v103 offset:3072
ds_read_b128 v[192:195], v102 offset:4096
ds_read_b128 v[120:123], v103 offset:4096
ds_read_b128 v[136:139], v103 offset:5120
ds_read_b128 v[196:199], v102 offset:6144
ds_read_b128 v[124:127], v103 offset:6144
ds_read_b128 v[140:143], v103 offset:7168
s_waitcnt lgkmcnt(9)
v_mfma_f32_16x16x32_bf16 v[200:203], v[112:115], v[184:187], 0
v_mfma_f32_16x16x32_bf16 v[204:207], v[128:131], v[184:187], 0
ds_read_b128 v[160:163], v94 offset:0
s_waitcnt lgkmcnt(7)
v_mfma_f32_16x16x32_bf16 v[200:203], v[116:119], v[188:191], v[200:203]
v_mfma_f32_16x16x32_bf16 v[204:207], v[132:135], v[188:191], v[204:207]
ds_read_b128 v[164:167], v94 offset:1024
s_waitcnt lgkmcnt(5)
v_mfma_f32_16x16x32_bf16 v[200:203], v[120:123], v[192:195], v[200:203]
v_mfma_f32_16x16x32_bf16 v[204:207], v[136:139], v[192:195], v[204:207]
ds_read_b128 v[168:171], v94 offset:2048
s_waitcnt lgkmcnt(3)
v_mfma_f32_16x16x32_bf16 v[200:203], v[124:127], v[196:199], v[200:203]
v_mfma_f32_16x16x32_bf16 v[204:207], v[140:143], v[196:199], v[204:207]
ds_read_b128 v[172:175], v94 offset:3072
s_waitcnt lgkmcnt(3)
v_mfma_f32_16x16x32_bf16 v[208:211], v[160:163], v[184:187], 0
ds_read_b128 v[144:147], v240 offset:0
ds_read_b64 v[176:177], v95 offset:0
s_waitcnt lgkmcnt(4)
v_mfma_f32_16x16x32_bf16 v[208:211], v[164:167], v[188:191], v[208:211]
ds_read_b128 v[148:151], v240 offset:1024
ds_read_b64 v[178:179], v95 offset:256
s_waitcnt lgkmcnt(5)
v_mfma_f32_16x16x32_bf16 v[208:211], v[168:171], v[192:195], v[208:211]
ds_read_b128 v[152:155], v240 offset:2048
ds_read_b64 v[180:181], v95 offset:1024
s_waitcnt lgkmcnt(6)
v_mfma_f32_16x16x32_bf16 v[208:211], v[172:175], v[196:199], v[208:211]
ds_read_b128 v[156:159], v240 offset:3072
ds_read_b64 v[182:183], v95 offset:1280
v_pk_mul_f32 v[200:201], v[200:201], s[54:55] op_sel_hi:[1,0]
v_pk_mul_f32 v[202:203], v[202:203], s[54:55] op_sel_hi:[1,0]
v_pk_mul_f32 v[204:205], v[204:205], s[54:55] op_sel_hi:[1,0]
v_pk_mul_f32 v[206:207], v[206:207], s[54:55] op_sel_hi:[1,0]
v_cndmask_b32 v200, v200, v241, s[12:13]
v_cndmask_b32 v201, v201, v241, s[14:15]
v_cndmask_b32 v202, v202, v241, s[16:17]
v_cndmask_b32 v203, v203, v241, s[18:19]
v_cndmask_b32 v204, v204, v241, s[20:21]
v_cndmask_b32 v205, v205, v241, s[22:23]
v_cndmask_b32 v206, v206, v241, s[24:25]
v_cndmask_b32 v207, v207, v241, s[26:27]
v_pk_mul_f32 v[208:209], v[208:209], s[54:55] op_sel_hi:[1,0]
v_pk_mul_f32 v[210:211], v[210:211], s[54:55] op_sel_hi:[1,0]
v_cndmask_b32 v208, v208, v97, s[28:29]
v_cndmask_b32 v209, v209, v97, s[28:29]
v_cndmask_b32 v210, v210, v97, s[28:29]
v_cndmask_b32 v211, v211, v97, s[28:29]
v_max3_f32 v236, v200, v201, v202
v_max3_f32 v236, v236, v203, v204
v_max3_f32 v236, v236, v205, v206
v_max3_f32 v236, v236, v207, v208
v_max3_f32 v236, v236, v209, v210
v_max_f32 v237, v236, v211
v_max_f32 v236, v236, v211
s_nop 1
v_permlane16_swap_b32 v236, v237
s_nop 0
v_max_f32 v238, v236, v237
v_max_f32 v239, v236, v237
s_nop 1
v_permlane32_swap_b32 v238, v239
s_nop 0
v_max_f32 v236, v238, v239
v_pk_add_f32 v[200:201], v[200:201], v[236:237] op_sel_hi:[1,0] neg_lo:[0,1] neg_hi:[0,1]
v_pk_add_f32 v[202:203], v[202:203], v[236:237] op_sel_hi:[1,0] neg_lo:[0,1] neg_hi:[0,1]
v_pk_add_f32 v[204:205], v[204:205], v[236:237] op_sel_hi:[1,0] neg_lo:[0,1] neg_hi:[0,1]
v_pk_add_f32 v[206:207], v[206:207], v[236:237] op_sel_hi:[1,0] neg_lo:[0,1] neg_hi:[0,1]
v_pk_add_f32 v[208:209], v[208:209], v[236:237] op_sel_hi:[1,0] neg_lo:[0,1] neg_hi:[0,1]
v_pk_add_f32 v[210:211], v[210:211], v[236:237] op_sel_hi:[1,0] neg_lo:[0,1] neg_hi:[0,1]
v_exp_f32 v200, v200
v_exp_f32 v201, v201
v_exp_f32 v202, v202
v_exp_f32 v203, v203
v_exp_f32 v204, v204
v_exp_f32 v205, v205
v_exp_f32 v206, v206
v_exp_f32 v207, v207
v_exp_f32 v208, v208
v_exp_f32 v209, v209
v_exp_f32 v210, v210
v_exp_f32 v211, v211
s_nop 0
v_cvt_pk_bf16_f32 v212, v200, v201
v_cvt_pk_bf16_f32 v213, v202, v203
v_cvt_pk_bf16_f32 v214, v204, v205
v_cvt_pk_bf16_f32 v215, v206, v207
v_cvt_pk_bf16_f32 v216, v208, v209
v_cvt_pk_bf16_f32 v217, v210, v211
s_waitcnt lgkmcnt(0)
s_nop 0
v_mfma_f32_16x16x32_bf16 v[108:111], v[104:107], v[212:215], 0
v_mfma_f32_16x16x32_bf16 v[220:223], v[144:147], v[212:215], 0
v_mfma_f32_16x16x32_bf16 v[224:227], v[148:151], v[212:215], 0
v_mfma_f32_16x16x32_bf16 v[228:231], v[152:155], v[212:215], 0
v_mfma_f32_16x16x32_bf16 v[232:235], v[156:159], v[212:215], 0
v_mfma_f32_16x16x16_bf16 v[108:111], v[104:105], v[216:217], v[108:111]
v_mfma_f32_16x16x16_bf16 v[220:223], v[176:177], v[216:217], v[220:223]
v_mfma_f32_16x16x16_bf16 v[224:227], v[178:179], v[216:217], v[224:227]
v_mfma_f32_16x16x16_bf16 v[228:231], v[180:181], v[216:217], v[228:231]
v_mfma_f32_16x16x16_bf16 v[232:235], v[182:183], v[216:217], v[232:235]
s_lshl_b32 s51, s42, 18
s_nop 2
v_rcp_f32 v238, v108
v_rcp_f32 v239, v109
s_nop 1
v_pk_mul_f32 v[220:221], v[220:221], v[238:239]
v_pk_mul_f32 v[222:223], v[222:223], v[238:239]
v_pk_mul_f32 v[224:225], v[224:225], v[238:239]
v_pk_mul_f32 v[226:227], v[226:227], v[238:239]
v_pk_mul_f32 v[228:229], v[228:229], v[238:239]
v_pk_mul_f32 v[230:231], v[230:231], v[238:239]
v_pk_mul_f32 v[232:233], v[232:233], v[238:239]
v_pk_mul_f32 v[234:235], v[234:235], v[238:239]
v_cvt_pk_bf16_f32 v200, v220, v221
v_cvt_pk_bf16_f32 v201, v222, v223
v_cvt_pk_bf16_f32 v202, v224, v225
v_cvt_pk_bf16_f32 v203, v226, v227
v_cvt_pk_bf16_f32 v204, v228, v229
v_cvt_pk_bf16_f32 v205, v230, v231
v_cvt_pk_bf16_f32 v206, v232, v233
v_cvt_pk_bf16_f32 v207, v234, v235
buffer_store_dwordx4 v[200:203], v96, s[84:87], s51 offen sc1
buffer_store_dwordx4 v[204:207], v96, s[84:87], s51 offen offset:2048 sc1
s_add_u32 s42, s42, 1
s_cmp_lt_u32 s42, 64
s_cbranch_scc1 mega_kernel_q_loop
s_waitcnt vmcnt(0)
v_mov_b32 v17, s42
s_mov_b64 exec, 1
buffer_store_dword v17, v16, s[84:87], s49 offen sc1
s_mov_b64 exec, -1
mega_kernel_q_quit:
s_endpgm
mega_kernel_rd:
s_mov_b32 s93, s40
s_load_dwordx2 s[4:5], s[0:1], 56
s_mov_b32 s48, 0x3f7ec46d
s_mov_b32 s49, 0x3dc8bd36
s_mov_b32 s50, 0x3f7b14be
s_mov_b32 s51, 0x3e47c5c2
s_mov_b32 s52, 0x3f74fa0b
s_mov_b32 s53, 0x3e94a031
s_mov_b32 s54, 0x3f6c835e
s_mov_b32 s55, 0x3ec3ef15
s_mov_b32 s56, 0x3f61c598
s_mov_b32 s57, 0x3ef15aea
s_mov_b32 s58, 0x3f54db31
s_mov_b32 s59, 0x3f0e39da
s_mov_b32 s60, 0x3f45e403
s_mov_b32 s61, 0x3f226799
s_mov_b32 s62, 0x3f3504f3
s_mov_b32 s63, 0x3f3504f3
v_and_b32 v1, 31, v0
v_lshrrev_b32 v2, 5, v0
v_cvt_f32_u32 v3, v1
v_mul_u32_u24 v10, 8448, v2
v_lshl_add_u32 v4, v1, 3, v10
v_mul_u32_u24 v5, 264, v1
v_add_u32 v5, v5, v10
v_and_b32 v11, 7, v0
v_lshrrev_b32 v9, 3, v0
v_mul_u32_u24 v10, 8448, v11
v_lshl_add_u32 v6, v9, 3, v10
v_lshlrev_b32 v7, 3, v9
v_sub_u32 v7, v10, v7
v_add_u32 v7, 4096, v7
v_lshlrev_b32 v8, 14, v9
v_lshl_add_u32 v8, v11, 4, v8
v_mul_f32 v12, 0xba800000, v3
v_cos_f32 v82, v12
v_sin_f32 v83, v12
v_mul_f32 v12, 0xbb000000, v3
v_cos_f32 v84, v12
v_sin_f32 v85, v12
v_mul_f32 v12, 0xbb400000, v3
v_cos_f32 v86, v12
v_sin_f32 v87, v12
v_mul_f32 v12, 0xbb800000, v3
v_cos_f32 v88, v12
v_sin_f32 v89, v12
v_mul_f32 v12, 0xbba00000, v3
v_cos_f32 v90, v12
v_sin_f32 v91, v12
v_mul_f32 v12, 0xbbc00000, v3
v_cos_f32 v92, v12
v_sin_f32 v93, v12
v_mul_f32 v12, 0xbbe00000, v3
v_cos_f32 v94, v12
v_sin_f32 v95, v12
v_mul_f32 v12, 0xbc000000, v3
v_cos_f32 v96, v12
v_sin_f32 v97, v12
v_mul_f32 v12, 0xbc100000, v3
v_cos_f32 v98, v12
v_sin_f32 v99, v12
v_mul_f32 v12, 0xbc200000, v3
v_cos_f32 v100, v12
v_sin_f32 v101, v12
v_mul_f32 v12, 0xbc300000, v3
v_cos_f32 v102, v12
v_sin_f32 v103, v12
v_mul_f32 v12, 0xbc400000, v3
v_cos_f32 v104, v12
v_sin_f32 v105, v12
v_mul_f32 v12, 0xbc500000, v3
v_cos_f32 v106, v12
v_sin_f32 v107, v12
v_mul_f32 v12, 0xbc600000, v3
v_cos_f32 v108, v12
v_sin_f32 v109, v12
v_mul_f32 v12, 0xbc700000, v3
v_cos_f32 v110, v12
v_sin_f32 v111, v12
v_mul_f32 v12, 0xbc800000, v3
v_cos_f32 v112, v12
v_sin_f32 v113, v12
v_mul_f32 v12, 0xbc880000, v3
v_cos_f32 v114, v12
v_sin_f32 v115, v12
v_mul_f32 v12, 0xbc900000, v3
v_cos_f32 v116, v12
v_sin_f32 v117, v12
v_mul_f32 v12, 0xbc980000, v3
v_cos_f32 v118, v12
v_sin_f32 v119, v12
v_mul_f32 v12, 0xbca00000, v3
v_cos_f32 v120, v12
v_sin_f32 v121, v12
v_mul_f32 v12, 0xbca80000, v3
v_cos_f32 v122, v12
v_sin_f32 v123, v12
v_mul_f32 v12, 0xbcb00000, v3
v_cos_f32 v124, v12
v_sin_f32 v125, v12
v_mul_f32 v12, 0xbcb80000, v3
v_cos_f32 v126, v12
v_sin_f32 v127, v12
v_mul_f32 v12, 0xbcc00000, v3
v_cos_f32 v128, v12
v_sin_f32 v129, v12
v_mul_f32 v12, 0xbcc80000, v3
v_cos_f32 v130, v12
v_sin_f32 v131, v12
v_mul_f32 v12, 0xbcd00000, v3
v_cos_f32 v132, v12
v_sin_f32 v133, v12
v_mul_f32 v12, 0xbcd80000, v3
v_cos_f32 v134, v12
v_sin_f32 v135, v12
v_mul_f32 v12, 0xbce00000, v3
v_cos_f32 v136, v12
v_sin_f32 v137, v12
v_mul_f32 v12, 0xbce80000, v3
v_cos_f32 v138, v12
v_sin_f32 v139, v12
v_mul_f32 v12, 0xbcf00000, v3
v_cos_f32 v140, v12
v_sin_f32 v141, v12
v_mul_f32 v12, 0xbcf80000, v3
v_cos_f32 v142, v12
v_sin_f32 v143, v12
v_lshlrev_b32 v12, 12, v2
v_lshl_add_u32 v12, v1, 1, v12
s_waitcnt lgkmcnt(0)
s_mov_b32 s6, 4194304
s_mov_b32 s7, 0x00020000
v_mov_b32 v144, 0
v_mov_b32 v145, 0
v_mov_b32 v146, 0
v_mov_b32 v147, 0
v_mov_b32 v148, 0
v_mov_b32 v149, 0
v_mov_b32 v150, 0
v_mov_b32 v151, 0
v_mov_b32 v152, 0
v_mov_b32 v153, 0
v_mov_b32 v154, 0
v_mov_b32 v155, 0
v_mov_b32 v156, 0
v_mov_b32 v157, 0
v_mov_b32 v158, 0
v_mov_b32 v159, 0
v_mov_b32 v160, 0
v_mov_b32 v161, 0
v_mov_b32 v162, 0
v_mov_b32 v163, 0
v_mov_b32 v164, 0
v_mov_b32 v165, 0
v_mov_b32 v166, 0
v_mov_b32 v167, 0
v_mov_b32 v168, 0
v_mov_b32 v169, 0
v_mov_b32 v170, 0
v_mov_b32 v171, 0
v_mov_b32 v172, 0
v_mov_b32 v173, 0
v_mov_b32 v174, 0
v_mov_b32 v175, 0
v_mov_b32 v176, 0
v_mov_b32 v177, 0
v_mov_b32 v178, 0
v_mov_b32 v179, 0
v_mov_b32 v180, 0
v_mov_b32 v181, 0
v_mov_b32 v182, 0
v_mov_b32 v183, 0
v_mov_b32 v184, 0
v_mov_b32 v185, 0
v_mov_b32 v186, 0
v_mov_b32 v187, 0
v_mov_b32 v188, 0
v_mov_b32 v189, 0
v_mov_b32 v190, 0
v_mov_b32 v191, 0
v_mov_b32 v192, 0
v_mov_b32 v193, 0
v_mov_b32 v194, 0
v_mov_b32 v195, 0
v_mov_b32 v196, 0
v_mov_b32 v197, 0
v_mov_b32 v198, 0
v_mov_b32 v199, 0
v_mov_b32 v200, 0
v_mov_b32 v201, 0
v_mov_b32 v202, 0
v_mov_b32 v203, 0
v_mov_b32 v204, 0
v_mov_b32 v205, 0
v_mov_b32 v206, 0
v_mov_b32 v207, 0
s_cmp_lt_u32 s93, 128
s_cbranch_scc0 mega_kernel_f1_e
s_lshl_b32 s12, s93, 15
buffer_load_short_d16_hi v144, v12, s[4:7], s12 offen offset:0
buffer_load_short_d16_hi v145, v12, s[4:7], s12 offen offset:2048
buffer_load_short_d16_hi v176, v12, s[4:7], s12 offen offset:1024
buffer_load_short_d16_hi v177, v12, s[4:7], s12 offen offset:3072
buffer_load_short_d16_hi v146, v12, s[4:7], s12 offen offset:64
buffer_load_short_d16_hi v147, v12, s[4:7], s12 offen offset:2112
buffer_load_short_d16_hi v178, v12, s[4:7], s12 offen offset:1088
buffer_load_short_d16_hi v179, v12, s[4:7], s12 offen offset:3136
buffer_load_short_d16_hi v148, v12, s[4:7], s12 offen offset:128
buffer_load_short_d16_hi v149, v12, s[4:7], s12 offen offset:2176
buffer_load_short_d16_hi v180, v12, s[4:7], s12 offen offset:1152
buffer_load_short_d16_hi v181, v12, s[4:7], s12 offen offset:3200
buffer_load_short_d16_hi v150, v12, s[4:7], s12 offen offset:192
buffer_load_short_d16_hi v151, v12, s[4:7], s12 offen offset:2240
buffer_load_short_d16_hi v182, v12, s[4:7], s12 offen offset:1216
buffer_load_short_d16_hi v183, v12, s[4:7], s12 offen offset:3264
buffer_load_short_d16_hi v152, v12, s[4:7], s12 offen offset:256
buffer_load_short_d16_hi v153, v12, s[4:7], s12 offen offset:2304
buffer_load_short_d16_hi v184, v12, s[4:7], s12 offen offset:1280
buffer_load_short_d16_hi v185, v12, s[4:7], s12 offen offset:3328
buffer_load_short_d16_hi v154, v12, s[4:7], s12 offen offset:320
buffer_load_short_d16_hi v155, v12, s[4:7], s12 offen offset:2368
buffer_load_short_d16_hi v186, v12, s[4:7], s12 offen offset:1344
buffer_load_short_d16_hi v187, v12, s[4:7], s12 offen offset:3392
buffer_load_short_d16_hi v156, v12, s[4:7], s12 offen offset:384
buffer_load_short_d16_hi v157, v12, s[4:7], s12 offen offset:2432
buffer_load_short_d16_hi v188, v12, s[4:7], s12 offen offset:1408
buffer_load_short_d16_hi v189, v12, s[4:7], s12 offen offset:3456
buffer_load_short_d16_hi v158, v12, s[4:7], s12 offen offset:448
buffer_load_short_d16_hi v159, v12, s[4:7], s12 offen offset:2496
buffer_load_short_d16_hi v190, v12, s[4:7], s12 offen offset:1472
buffer_load_short_d16_hi v191, v12, s[4:7], s12 offen offset:3520
buffer_load_short_d16_hi v160, v12, s[4:7], s12 offen offset:512
buffer_load_short_d16_hi v161, v12, s[4:7], s12 offen offset:2560
buffer_load_short_d16_hi v192, v12, s[4:7], s12 offen offset:1536
buffer_load_short_d16_hi v193, v12, s[4:7], s12 offen offset:3584
buffer_load_short_d16_hi v162, v12, s[4:7], s12 offen offset:576
buffer_load_short_d16_hi v163, v12, s[4:7], s12 offen offset:2624
buffer_load_short_d16_hi v194, v12, s[4:7], s12 offen offset:1600
buffer_load_short_d16_hi v195, v12, s[4:7], s12 offen offset:3648
buffer_load_short_d16_hi v164, v12, s[4:7], s12 offen offset:640
buffer_load_short_d16_hi v165, v12, s[4:7], s12 offen offset:2688
buffer_load_short_d16_hi v196, v12, s[4:7], s12 offen offset:1664
buffer_load_short_d16_hi v197, v12, s[4:7], s12 offen offset:3712
buffer_load_short_d16_hi v166, v12, s[4:7], s12 offen offset:704
buffer_load_short_d16_hi v167, v12, s[4:7], s12 offen offset:2752
buffer_load_short_d16_hi v198, v12, s[4:7], s12 offen offset:1728
buffer_load_short_d16_hi v199, v12, s[4:7], s12 offen offset:3776
buffer_load_short_d16_hi v168, v12, s[4:7], s12 offen offset:768
buffer_load_short_d16_hi v169, v12, s[4:7], s12 offen offset:2816
buffer_load_short_d16_hi v200, v12, s[4:7], s12 offen offset:1792
buffer_load_short_d16_hi v201, v12, s[4:7], s12 offen offset:3840
buffer_load_short_d16_hi v170, v12, s[4:7], s12 offen offset:832
buffer_load_short_d16_hi v171, v12, s[4:7], s12 offen offset:2880
buffer_load_short_d16_hi v202, v12, s[4:7], s12 offen offset:1856
buffer_load_short_d16_hi v203, v12, s[4:7], s12 offen offset:3904
buffer_load_short_d16_hi v172, v12, s[4:7], s12 offen offset:896
buffer_load_short_d16_hi v173, v12, s[4:7], s12 offen offset:2944
buffer_load_short_d16_hi v204, v12, s[4:7], s12 offen offset:1920
buffer_load_short_d16_hi v205, v12, s[4:7], s12 offen offset:3968
buffer_load_short_d16_hi v174, v12, s[4:7], s12 offen offset:960
buffer_load_short_d16_hi v175, v12, s[4:7], s12 offen offset:3008
buffer_load_short_d16_hi v206, v12, s[4:7], s12 offen offset:1984
buffer_load_short_d16_hi v207, v12, s[4:7], s12 offen offset:4032
s_waitcnt vmcnt(0)
mega_kernel_f1_l:
s_add_u32 s21, s93, 32
s_cmp_lt_u32 s21, 128
s_cselect_b32 s22, s21, s93
s_waitcnt vmcnt(17)
v_pk_add_f32 v[48:49], v[144:145], v[176:177] neg_lo:[0,1] neg_hi:[0,1]
v_pk_add_f32 v[16:17], v[144:145], v[176:177]
v_pk_add_f32 v[14:15], v[146:147], v[178:179] neg_lo:[0,1] neg_hi:[0,1]
v_pk_add_f32 v[18:19], v[146:147], v[178:179]
v_pk_mul_f32 v[50:51], v[14:15], s[50:51] op_sel:[0,0] op_sel_hi:[0,1] neg_lo:[0,0] neg_hi:[0,1]
v_pk_fma_f32 v[50:51], v[14:15], s[50:51], v[50:51] op_sel:[1,1,0] op_sel_hi:[1,0,1] neg_lo:[0,0,0] neg_hi:[0,0,0]
v_pk_add_f32 v[14:15], v[148:149], v[180:181] neg_lo:[0,1] neg_hi:[0,1]
v_pk_add_f32 v[20:21], v[148:149], v[180:181]
v_pk_mul_f32 v[52:53], v[14:15], s[54:55] op_sel:[0,0] op_sel_hi:[0,1] neg_lo:[0,0] neg_hi:[0,1]
v_pk_fma_f32 v[52:53], v[14:15], s[54:55], v[52:53] op_sel:[1,1,0] op_sel_hi:[1,0,1] neg_lo:[0,0,0] neg_hi:[0,0,0]
v_pk_add_f32 v[14:15], v[150:151], v[182:183] neg_lo:[0,1] neg_hi:[0,1]
v_pk_add_f32 v[22:23], v[150:151], v[182:183]
v_pk_mul_f32 v[54:55], v[14:15], s[58:59] op_sel:[0,0] op_sel_hi:[0,1] neg_lo:[0,0] neg_hi:[0,1]
v_pk_fma_f32 v[54:55], v[14:15], s[58:59], v[54:55] op_sel:[1,1,0] op_sel_hi:[1,0,1] neg_lo:[0,0,0] neg_hi:[0,0,0]
v_pk_add_f32 v[14:15], v[152:153], v[184:185] neg_lo:[0,1] neg_hi:[0,1]
v_pk_add_f32 v[24:25], v[152:153], v[184:185]
v_pk_mul_f32 v[56:57], v[14:15], s[62:63] op_sel:[0,0] op_sel_hi:[0,1] neg_lo:[0,0] neg_hi:[0,1]
v_pk_fma_f32 v[56:57], v[14:15], s[62:63], v[56:57] op_sel:[1,1,0] op_sel_hi:[1,0,1] neg_lo:[0,0,0] neg_hi:[0,0,0]
v_pk_add_f32 v[14:15], v[154:155], v[186:187] neg_lo:[0,1] neg_hi:[0,1]
v_pk_add_f32 v[26:27], v[154:155], v[186:187]
v_pk_mul_f32 v[58:59], v[14:15], s[58:59] op_sel:[0,1] op_sel_hi:[0,0] neg_lo:[0,0] neg_hi:[0,1]
v_pk_fma_f32 v[58:59], v[14:15], s[58:59], v[58:59] op_sel:[1,0,0] op_sel_hi:[1,1,1] neg_lo:[0,0,0] neg_hi:[0,0,0]
v_pk_add_f32 v[14:15], v[156:157], v[188:189] neg_lo:[0,1] neg_hi:[0,1]
v_pk_add_f32 v[28:29], v[156:157], v[188:189]
v_pk_mul_f32 v[60:61], v[14:15], s[54:55] op_sel:[0,1] op_sel_hi:[0,0] neg_lo:[0,0] neg_hi:[0,1]
v_pk_fma_f32 v[60:61], v[14:15], s[54:55], v[60:61] op_sel:[1,0,0] op_sel_hi:[1,1,1] neg_lo:[0,0,0] neg_hi:[0,0,0]
v_pk_add_f32 v[14:15], v[158:159], v[190:191] neg_lo:[0,1] neg_hi:[0,1]
v_pk_add_f32 v[30:31], v[158:159], v[190:191]
v_pk_mul_f32 v[62:63], v[14:15], s[50:51] op_sel:[0,1] op_sel_hi:[0,0] neg_lo:[0,0] neg_hi:[0,1]
v_pk_fma_f32 v[62:63], v[14:15], s[50:51], v[62:63] op_sel:[1,0,0] op_sel_hi:[1,1,1] neg_lo:[0,0,0] neg_hi:[0,0,0]
v_pk_add_f32 v[64:65], v[160:161], v[192:193] op_sel:[1,1] op_sel_hi:[0,0] neg_lo:[0,1] neg_hi:[1,0]
v_pk_add_f32 v[32:33], v[160:161], v[192:193]
v_pk_add_f32 v[14:15], v[162:163], v[194:195] neg_lo:[0,1] neg_hi:[0,1]
v_pk_add_f32 v[34:35], v[162:163], v[194:195]
v_pk_mul_f32 v[66:67], v[14:15], s[50:51] op_sel:[0,1] op_sel_hi:[0,0] neg_lo:[0,1] neg_hi:[0,1]
v_pk_fma_f32 v[66:67], v[14:15], s[50:51], v[66:67] op_sel:[1,0,0] op_sel_hi:[1,1,1] neg_lo:[0,0,0] neg_hi:[0,1,0]
v_pk_add_f32 v[14:15], v[164:165], v[196:197] neg_lo:[0,1] neg_hi:[0,1]
v_pk_add_f32 v[36:37], v[164:165], v[196:197]
v_pk_mul_f32 v[68:69], v[14:15], s[54:55] op_sel:[0,1] op_sel_hi:[0,0] neg_lo:[0,1] neg_hi:[0,1]
v_pk_fma_f32 v[68:69], v[14:15], s[54:55], v[68:69] op_sel:[1,0,0] op_sel_hi:[1,1,1] neg_lo:[0,0,0] neg_hi:[0,1,0]
v_pk_add_f32 v[14:15], v[166:167], v[198:199] neg_lo:[0,1] neg_hi:[0,1]
v_pk_add_f32 v[38:39], v[166:167], v[198:199]
v_pk_mul_f32 v[70:71], v[14:15], s[58:59] op_sel:[0,1] op_sel_hi:[0,0] neg_lo:[0,1] neg_hi:[0,1]
v_pk_fma_f32 v[70:71], v[14:15], s[58:59], v[70:71] op_sel:[1,0,0] op_sel_hi:[1,1,1] neg_lo:[0,0,0] neg_hi:[0,1,0]
v_pk_add_f32 v[14:15], v[168:169], v[200:201] neg_lo:[0,1] neg_hi:[0,1]
v_pk_add_f32 v[40:41], v[168:169], v[200:201]
v_pk_mul_f32 v[72:73], v[14:15], s[62:63] op_sel:[0,0] op_sel_hi:[0,1] neg_lo:[0,1] neg_hi:[0,1]
v_pk_fma_f32 v[72:73], v[14:15], s[62:63], v[72:73] op_sel:[1,1,0] op_sel_hi:[1,0,1] neg_lo:[0,0,0] neg_hi:[0,1,0]
v_pk_add_f32 v[14:15], v[170:171], v[202:203] neg_lo:[0,1] neg_hi:[0,1]
v_pk_add_f32 v[42:43], v[170:171], v[202:203]
v_pk_mul_f32 v[74:75], v[14:15], s[58:59] op_sel:[0,0] op_sel_hi:[0,1] neg_lo:[0,1] neg_hi:[0,1]
v_pk_fma_f32 v[74:75], v[14:15], s[58:59], v[74:75] op_sel:[1,1,0] op_sel_hi:[1,0,1] neg_lo:[0,0,0] neg_hi:[0,1,0]
v_pk_add_f32 v[14:15], v[172:173], v[204:205] neg_lo:[0,1] neg_hi:[0,1]
v_pk_add_f32 v[44:45], v[172:173], v[204:205]
v_pk_mul_f32 v[76:77], v[14:15], s[54:55] op_sel:[0,0] op_sel_hi:[0,1] neg_lo:[0,1] neg_hi:[0,1]
v_pk_fma_f32 v[76:77], v[14:15], s[54:55], v[76:77] op_sel:[1,1,0] op_sel_hi:[1,0,1] neg_lo:[0,0,0] neg_hi:[0,1,0]
v_pk_add_f32 v[14:15], v[174:175], v[206:207] neg_lo:[0,1] neg_hi:[0,1]
v_pk_add_f32 v[46:47], v[174:175], v[206:207]
v_pk_mul_f32 v[78:79], v[14:15], s[50:51] op_sel:[0,0] op_sel_hi:[0,1] neg_lo:[0,1] neg_hi:[0,1]
v_pk_fma_f32 v[78:79], v[14:15], s[50:51], v[78:79] op_sel:[1,1,0] op_sel_hi:[1,0,1] neg_lo:[0,0,0] neg_hi:[0,1,0]
s_lshl_b32 s12, s22, 15
buffer_load_short_d16_hi v144, v12, s[4:7], s12 offen offset:0
buffer_load_short_d16_hi v145, v12, s[4:7], s12 offen offset:2048
buffer_load_short_d16_hi v176, v12, s[4:7], s12 offen offset:1024
buffer_load_short_d16_hi v177, v12, s[4:7], s12 offen offset:3072
buffer_load_short_d16_hi v146, v12, s[4:7], s12 offen offset:64
buffer_load_short_d16_hi v147, v12, s[4:7], s12 offen offset:2112
buffer_load_short_d16_hi v178, v12, s[4:7], s12 offen offset:1088
buffer_load_short_d16_hi v179, v12, s[4:7], s12 offen offset:3136
buffer_load_short_d16_hi v148, v12, s[4:7], s12 offen offset:128
buffer_load_short_d16_hi v149, v12, s[4:7], s12 offen offset:2176
buffer_load_short_d16_hi v180, v12, s[4:7], s12 offen offset:1152
buffer_load_short_d16_hi v181, v12, s[4:7], s12 offen offset:3200
buffer_load_short_d16_hi v150, v12, s[4:7], s12 offen offset:192
buffer_load_short_d16_hi v151, v12, s[4:7], s12 offen offset:2240
buffer_load_short_d16_hi v182, v12, s[4:7], s12 offen offset:1216
buffer_load_short_d16_hi v183, v12, s[4:7], s12 offen offset:3264
buffer_load_short_d16_hi v152, v12, s[4:7], s12 offen offset:256
buffer_load_short_d16_hi v153, v12, s[4:7], s12 offen offset:2304
buffer_load_short_d16_hi v184, v12, s[4:7], s12 offen offset:1280
buffer_load_short_d16_hi v185, v12, s[4:7], s12 offen offset:3328
buffer_load_short_d16_hi v154, v12, s[4:7], s12 offen offset:320
buffer_load_short_d16_hi v155, v12, s[4:7], s12 offen offset:2368
buffer_load_short_d16_hi v186, v12, s[4:7], s12 offen offset:1344
buffer_load_short_d16_hi v187, v12, s[4:7], s12 offen offset:3392
buffer_load_short_d16_hi v156, v12, s[4:7], s12 offen offset:384
buffer_load_short_d16_hi v157, v12, s[4:7], s12 offen offset:2432
buffer_load_short_d16_hi v188, v12, s[4:7], s12 offen offset:1408
buffer_load_short_d16_hi v189, v12, s[4:7], s12 offen offset:3456
buffer_load_short_d16_hi v158, v12, s[4:7], s12 offen offset:448
buffer_load_short_d16_hi v159, v12, s[4:7], s12 offen offset:2496
buffer_load_short_d16_hi v190, v12, s[4:7], s12 offen offset:1472
buffer_load_short_d16_hi v191, v12, s[4:7], s12 offen offset:3520
buffer_load_short_d16_hi v160, v12, s[4:7], s12 offen offset:512
buffer_load_short_d16_hi v161, v12, s[4:7], s12 offen offset:2560
buffer_load_short_d16_hi v192, v12, s[4:7], s12 offen offset:1536
buffer_load_short_d16_hi v193, v12, s[4:7], s12 offen offset:3584
buffer_load_short_d16_hi v162, v12, s[4:7], s12 offen offset:576
buffer_load_short_d16_hi v163, v12, s[4:7], s12 offen offset:2624
buffer_load_short_d16_hi v194, v12, s[4:7], s12 offen offset:1600
buffer_load_short_d16_hi v195, v12, s[4:7], s12 offen offset:3648
buffer_load_short_d16_hi v164, v12, s[4:7], s12 offen offset:640
buffer_load_short_d16_hi v165, v12, s[4:7], s12 offen offset:2688
buffer_load_short_d16_hi v196, v12, s[4:7], s12 offen offset:1664
buffer_load_short_d16_hi v197, v12, s[4:7], s12 offen offset:3712
buffer_load_short_d16_hi v166, v12, s[4:7], s12 offen offset:704
buffer_load_short_d16_hi v167, v12, s[4:7], s12 offen offset:2752
buffer_load_short_d16_hi v198, v12, s[4:7], s12 offen offset:1728
buffer_load_short_d16_hi v199, v12, s[4:7], s12 offen offset:3776
buffer_load_short_d16_hi v168, v12, s[4:7], s12 offen offset:768
buffer_load_short_d16_hi v169, v12, s[4:7], s12 offen offset:2816
buffer_load_short_d16_hi v200, v12, s[4:7], s12 offen offset:1792
buffer_load_short_d16_hi v201, v12, s[4:7], s12 offen offset:3840
buffer_load_short_d16_hi v170, v12, s[4:7], s12 offen offset:832
buffer_load_short_d16_hi v171, v12, s[4:7], s12 offen offset:2880
buffer_load_short_d16_hi v202, v12, s[4:7], s12 offen offset:1856
buffer_load_short_d16_hi v203, v12, s[4:7], s12 offen offset:3904
buffer_load_short_d16_hi v172, v12, s[4:7], s12 offen offset:896
buffer_load_short_d16_hi v173, v12, s[4:7], s12 offen offset:2944
buffer_load_short_d16_hi v204, v12, s[4:7], s12 offen offset:1920
buffer_load_short_d16_hi v205, v12, s[4:7], s12 offen offset:3968
buffer_load_short_d16_hi v174, v12, s[4:7], s12 offen offset:960
buffer_load_short_d16_hi v175, v12, s[4:7], s12 offen offset:3008
buffer_load_short_d16_hi v206, v12, s[4:7], s12 offen offset:1984
buffer_load_short_d16_hi v207, v12, s[4:7], s12 offen offset:4032
v_pk_add_f32 v[14:15], v[16:17], v[32:33] neg_lo:[0,1] neg_hi:[0,1]
v_pk_add_f32 v[16:17], v[16:17], v[32:33]
v_pk_add_f32 v[32:33], v[18:19], v[34:35] neg_lo:[0,1] neg_hi:[0,1]
v_pk_add_f32 v[18:19], v[18:19], v[34:35]
v_pk_mul_f32 v[34:35], v[32:33], s[54:55] op_sel:[0,0] op_sel_hi:[0,1] neg_lo:[0,0] neg_hi:[0,1]
v_pk_fma_f32 v[34:35], v[32:33], s[54:55], v[34:35] op_sel:[1,1,0] op_sel_hi:[1,0,1] neg_lo:[0,0,0] neg_hi:[0,0,0]
v_pk_add_f32 v[32:33], v[20:21], v[36:37] neg_lo:[0,1] neg_hi:[0,1]
v_pk_add_f32 v[20:21], v[20:21], v[36:37]
v_pk_mul_f32 v[36:37], v[32:33], s[62:63] op_sel:[0,0] op_sel_hi:[0,1] neg_lo:[0,0] neg_hi:[0,1]
v_pk_fma_f32 v[36:37], v[32:33], s[62:63], v[36:37] op_sel:[1,1,0] op_sel_hi:[1,0,1] neg_lo:[0,0,0] neg_hi:[0,0,0]
v_pk_add_f32 v[32:33], v[22:23], v[38:39] neg_lo:[0,1] neg_hi:[0,1]
v_pk_add_f32 v[22:23], v[22:23], v[38:39]
v_pk_mul_f32 v[38:39], v[32:33], s[54:55] op_sel:[0,1] op_sel_hi:[0,0] neg_lo:[0,0] neg_hi:[0,1]
v_pk_fma_f32 v[38:39], v[32:33], s[54:55], v[38:39] op_sel:[1,0,0] op_sel_hi:[1,1,1] neg_lo:[0,0,0] neg_hi:[0,0,0]
v_pk_add_f32 v[32:33], v[24:25], v[40:41] op_sel:[1,1] op_sel_hi:[0,0] neg_lo:[0,1] neg_hi:[1,0]
v_pk_add_f32 v[24:25], v[24:25], v[40:41]
v_pk_add_f32 v[40:41], v[26:27], v[42:43] neg_lo:[0,1] neg_hi:[0,1]
v_pk_add_f32 v[26:27], v[26:27], v[42:43]
v_pk_mul_f32 v[42:43], v[40:41], s[54:55] op_sel:[0,1] op_sel_hi:[0,0] neg_lo:[0,1] neg_hi:[0,1]
v_pk_fma_f32 v[42:43], v[40:41], s[54:55], v[42:43] op_sel:[1,0,0] op_sel_hi:[1,1,1] neg_lo:[0,0,0] neg_hi:[0,1,0]
v_pk_add_f32 v[40:41], v[28:29], v[44:45] neg_lo:[0,1] neg_hi:[0,1]
v_pk_add_f32 v[28:29], v[28:29], v[44:45]
v_pk_mul_f32 v[44:45], v[40:41], s[62:63] op_sel:[0,0] op_sel_hi:[0,1] neg_lo:[0,1] neg_hi:[0,1]
v_pk_fma_f32 v[44:45], v[40:41], s[62:63], v[44:45] op_sel:[1,1,0] op_sel_hi:[1,0,1] neg_lo:[0,0,0] neg_hi:[0,1,0]
v_pk_add_f32 v[40:41], v[30:31], v[46:47] neg_lo:[0,1] neg_hi:[0,1]
v_pk_add_f32 v[30:31], v[30:31], v[46:47]
v_pk_mul_f32 v[46:47], v[40:41], s[54:55] op_sel:[0,0] op_sel_hi:[0,1] neg_lo:[0,1] neg_hi:[0,1]
v_pk_fma_f32 v[46:47], v[40:41], s[54:55], v[46:47] op_sel:[1,1,0] op_sel_hi:[1,0,1] neg_lo:[0,0,0] neg_hi:[0,1,0]
v_pk_add_f32 v[40:41], v[48:49], v[64:65] neg_lo:[0,1] neg_hi:[0,1]
v_pk_add_f32 v[48:49], v[48:49], v[64:65]
v_pk_add_f32 v[64:65], v[50:51], v[66:67] neg_lo:[0,1] neg_hi:[0,1]
v_pk_add_f32 v[50:51], v[50:51], v[66:67]
v_pk_mul_f32 v[66:67], v[64:65], s[54:55] op_sel:[0,0] op_sel_hi:[0,1] neg_lo:[0,0] neg_hi:[0,1]
v_pk_fma_f32 v[66:67], v[64:65], s[54:55], v[66:67] op_sel:[1,1,0] op_sel_hi:[1,0,1] neg_lo:[0,0,0] neg_hi:[0,0,0]
v_pk_add_f32 v[64:65], v[52:53], v[68:69] neg_lo:[0,1] neg_hi:[0,1]
v_pk_add_f32 v[52:53], v[52:53], v[68:69]
v_pk_mul_f32 v[68:69], v[64:65], s[62:63] op_sel:[0,0] op_sel_hi:[0,1] neg_lo:[0,0] neg_hi:[0,1]
v_pk_fma_f32 v[68:69], v[64:65], s[62:63], v[68:69] op_sel:[1,1,0] op_sel_hi:[1,0,1] neg_lo:[0,0,0] neg_hi:[0,0,0]
v_pk_add_f32 v[64:65], v[54:55], v[70:71] neg_lo:[0,1] neg_hi:[0,1]
v_pk_add_f32 v[54:55], v[54:55], v[70:71]
v_pk_mul_f32 v[70:71], v[64:65], s[54:55] op_sel:[0,1] op_sel_hi:[0,0] neg_lo:[0,0] neg_hi:[0,1]
v_pk_fma_f32 v[70:71], v[64:65], s[54:55], v[70:71] op_sel:[1,0,0] op_sel_hi:[1,1,1] neg_lo:[0,0,0] neg_hi:[0,0,0]
v_pk_add_f32 v[64:65], v[56:57], v[72:73] op_sel:[1,1] op_sel_hi:[0,0] neg_lo:[0,1] neg_hi:[1,0]
v_pk_add_f32 v[56:57], v[56:57], v[72:73]
v_pk_add_f32 v[72:73], v[58:59], v[74:75] neg_lo:[0,1] neg_hi:[0,1]
v_pk_add_f32 v[58:59], v[58:59], v[74:75]
v_pk_mul_f32 v[74:75], v[72:73], s[54:55] op_sel:[0,1] op_sel_hi:[0,0] neg_lo:[0,1] neg_hi:[0,1]
v_pk_fma_f32 v[74:75], v[72:73], s[54:55], v[74:75] op_sel:[1,0,0] op_sel_hi:[1,1,1] neg_lo:[0,0,0] neg_hi:[0,1,0]
v_pk_add_f32 v[72:73], v[60:61], v[76:77] neg_lo:[0,1] neg_hi:[0,1]
v_pk_add_f32 v[60:61], v[60:61], v[76:77]
v_pk_mul_f32 v[76:77], v[72:73], s[62:63] op_sel:[0,0] op_sel_hi:[0,1] neg_lo:[0,1] neg_hi:[0,1]
v_pk_fma_f32 v[76:77], v[72:73], s[62:63], v[76:77] op_sel:[1,1,0] op_sel_hi:[1,0,1] neg_lo:[0,0,0] neg_hi:[0,1,0]
v_pk_add_f32 v[72:73], v[62:63], v[78:79] neg_lo:[0,1] neg_hi:[0,1]
v_pk_add_f32 v[62:63], v[62:63], v[78:79]
v_pk_mul_f32 v[78:79], v[72:73], s[54:55] op_sel:[0,0] op_sel_hi:[0,1] neg_lo:[0,1] neg_hi:[0,1]
v_pk_fma_f32 v[78:79], v[72:73], s[54:55], v[78:79] op_sel:[1,1,0] op_sel_hi:[1,0,1] neg_lo:[0,0,0] neg_hi:[0,1,0]
v_pk_add_f32 v[72:73], v[16:17], v[24:25] neg_lo:[0,1] neg_hi:[0,1]
v_pk_add_f32 v[16:17], v[16:17], v[24:25]
v_pk_add_f32 v[24:25], v[18:19], v[26:27] neg_lo:[0,1] neg_hi:[0,1]
v_pk_add_f32 v[18:19], v[18:19], v[26:27]
v_pk_mul_f32 v[26:27], v[24:25], s[62:63] op_sel:[0,0] op_sel_hi:[0,1] neg_lo:[0,0] neg_hi:[0,1]
v_pk_fma_f32 v[26:27], v[24:25], s[62:63], v[26:27] op_sel:[1,1,0] op_sel_hi:[1,0,1] neg_lo:[0,0,0] neg_hi:[0,0,0]
v_pk_add_f32 v[24:25], v[20:21], v[28:29] op_sel:[1,1] op_sel_hi:[0,0] neg_lo:[0,1] neg_hi:[1,0]
v_pk_add_f32 v[20:21], v[20:21], v[28:29]
v_pk_add_f32 v[28:29], v[22:23], v[30:31] neg_lo:[0,1] neg_hi:[0,1]
v_pk_add_f32 v[22:23], v[22:23], v[30:31]
v_pk_mul_f32 v[30:31], v[28:29], s[62:63] op_sel:[0,0] op_sel_hi:[0,1] neg_lo:[0,1] neg_hi:[0,1]
v_pk_fma_f32 v[30:31], v[28:29], s[62:63], v[30:31] op_sel:[1,1,0] op_sel_hi:[1,0,1] neg_lo:[0,0,0] neg_hi:[0,1,0]
v_pk_add_f32 v[28:29], v[14:15], v[32:33] neg_lo:[0,1] neg_hi:[0,1]
v_pk_add_f32 v[14:15], v[14:15], v[32:33]
v_pk_add_f32 v[32:33], v[34:35], v[42:43] neg_lo:[0,1] neg_hi:[0,1]
v_pk_add_f32 v[34:35], v[34:35], v[42:43]
v_pk_mul_f32 v[42:43], v[32:33], s[62:63] op_sel:[0,0] op_sel_hi:[0,1] neg_lo:[0,0] neg_hi:[0,1]
v_pk_fma_f32 v[42:43], v[32:33], s[62:63], v[42:43] op_sel:[1,1,0] op_sel_hi:[1,0,1] neg_lo:[0,0,0] neg_hi:[0,0,0]
v_pk_add_f32 v[32:33], v[36:37], v[44:45] op_sel:[1,1] op_sel_hi:[0,0] neg_lo:[0,1] neg_hi:[1,0]
v_pk_add_f32 v[36:37], v[36:37], v[44:45]
v_pk_add_f32 v[44:45], v[38:39], v[46:47] neg_lo:[0,1] neg_hi:[0,1]
v_pk_add_f32 v[38:39], v[38:39], v[46:47]
v_pk_mul_f32 v[46:47], v[44:45], s[62:63] op_sel:[0,0] op_sel_hi:[0,1] neg_lo:[0,1] neg_hi:[0,1]
v_pk_fma_f32 v[46:47], v[44:45], s[62:63], v[46:47] op_sel:[1,1,0] op_sel_hi:[1,0,1] neg_lo:[0,0,0] neg_hi:[0,1,0]
v_pk_add_f32 v[44:45], v[48:49], v[56:57] neg_lo:[0,1] neg_hi:[0,1]
v_pk_add_f32 v[48:49], v[48:49], v[56:57]
v_pk_add_f32 v[56:57], v[50:51], v[58:59] neg_lo:[0,1] neg_hi:[0,1]
v_pk_add_f32 v[50:51], v[50:51], v[58:59]
v_pk_mul_f32 v[58:59], v[56:57], s[62:63] op_sel:[0,0] op_sel_hi:[0,1] neg_lo:[0,0] neg_hi:[0,1]
v_pk_fma_f32 v[58:59], v[56:57], s[62:63], v[58:59] op_sel:[1,1,0] op_sel_hi:[1,0,1] neg_lo:[0,0,0] neg_hi:[0,0,0]
v_pk_add_f32 v[56:57], v[52:53], v[60:61] op_sel:[1,1] op_sel_hi:[0,0] neg_lo:[0,1] neg_hi:[1,0]
v_pk_add_f32 v[52:53], v[52:53], v[60:61]
v_pk_add_f32 v[60:61], v[54:55], v[62:63] neg_lo:[0,1] neg_hi:[0,1]
v_pk_add_f32 v[54:55], v[54:55], v[62:63]
v_pk_mul_f32 v[62:63], v[60:61], s[62:63] op_sel:[0,0] op_sel_hi:[0,1] neg_lo:[0,1] neg_hi:[0,1]
v_pk_fma_f32 v[62:63], v[60:61], s[62:63], v[62:63] op_sel:[1,1,0] op_sel_hi:[1,0,1] neg_lo:[0,0,0] neg_hi:[0,1,0]
v_pk_add_f32 v[60:61], v[40:41], v[64:65] neg_lo:[0,1] neg_hi:[0,1]
v_pk_add_f32 v[40:41], v[40:41], v[64:65]
v_pk_add_f32 v[64:65], v[66:67], v[74:75] neg_lo:[0,1] neg_hi:[0,1]
v_pk_add_f32 v[66:67], v[66:67], v[74:75]
v_pk_mul_f32 v[74:75], v[64:65], s[62:63] op_sel:[0,0] op_sel_hi:[0,1] neg_lo:[0,0] neg_hi:[0,1]
v_pk_fma_f32 v[74:75], v[64:65], s[62:63], v[74:75] op_sel:[1,1,0] op_sel_hi:[1,0,1] neg_lo:[0,0,0] neg_hi:[0,0,0]
v_pk_add_f32 v[64:65], v[68:69], v[76:77] op_sel:[1,1] op_sel_hi:[0,0] neg_lo:[0,1] neg_hi:[1,0]
v_pk_add_f32 v[68:69], v[68:69], v[76:77]
v_pk_add_f32 v[76:77], v[70:71], v[78:79] neg_lo:[0,1] neg_hi:[0,1]
v_pk_add_f32 v[70:71], v[70:71], v[78:79]
v_pk_mul_f32 v[78:79], v[76:77], s[62:63] op_sel:[0,0] op_sel_hi:[0,1] neg_lo:[0,1] neg_hi:[0,1]
v_pk_fma_f32 v[78:79], v[76:77], s[62:63], v[78:79] op_sel:[1,1,0] op_sel_hi:[1,0,1] neg_lo:[0,0,0] neg_hi:[0,1,0]
v_pk_add_f32 v[76:77], v[16:17], v[20:21] neg_lo:[0,1] neg_hi:[0,1]
v_pk_add_f32 v[16:17], v[16:17], v[20:21]
v_pk_add_f32 v[20:21], v[18:19], v[22:23] op_sel:[1,1] op_sel_hi:[0,0] neg_lo:[0,1] neg_hi:[1,0]
v_pk_add_f32 v[18:19], v[18:19], v[22:23]
v_pk_add_f32 v[22:23], v[72:73], v[24:25] neg_lo:[0,1] neg_hi:[0,1]
v_pk_add_f32 v[72:73], v[72:73], v[24:25]
v_pk_add_f32 v[24:25], v[26:27], v[30:31] op_sel:[1,1] op_sel_hi:[0,0] neg_lo:[0,1] neg_hi:[1,0]
v_pk_add_f32 v[26:27], v[26:27], v[30:31]
v_pk_add_f32 v[30:31], v[14:15], v[36:37] neg_lo:[0,1] neg_hi:[0,1]
v_pk_add_f32 v[14:15], v[14:15], v[36:37]
v_pk_add_f32 v[36:37], v[34:35], v[38:39] op_sel:[1,1] op_sel_hi:[0,0] neg_lo:[0,1] neg_hi:[1,0]
v_pk_add_f32 v[34:35], v[34:35], v[38:39]
v_pk_add_f32 v[38:39], v[28:29], v[32:33] neg_lo:[0,1] neg_hi:[0,1]
v_pk_add_f32 v[28:29], v[28:29], v[32:33]
v_pk_add_f32 v[32:33], v[42:43], v[46:47] op_sel:[1,1] op_sel_hi:[0,0] neg_lo:[0,1] neg_hi:[1,0]
v_pk_add_f32 v[42:43], v[42:43], v[46:47]
v_pk_add_f32 v[46:47], v[48:49], v[52:53] neg_lo:[0,1] neg_hi:[0,1]
v_pk_add_f32 v[48:49], v[48:49], v[52:53]
v_pk_add_f32 v[52:53], v[50:51], v[54:55] op_sel:[1,1] op_sel_hi:[0,0] neg_lo:[0,1] neg_hi:[1,0]
v_pk_add_f32 v[50:51], v[50:51], v[54:55]
v_pk_add_f32 v[54:55], v[44:45], v[56:57] neg_lo:[0,1] neg_hi:[0,1]
v_pk_add_f32 v[44:45], v[44:45], v[56:57]
v_pk_add_f32 v[56:57], v[58:59], v[62:63] op_sel:[1,1] op_sel_hi:[0,0] neg_lo:[0,1] neg_hi:[1,0]
v_pk_add_f32 v[58:59], v[58:59], v[62:63]
v_pk_add_f32 v[62:63], v[40:41], v[68:69] neg_lo:[0,1] neg_hi:[0,1]
v_pk_add_f32 v[40:41], v[40:41], v[68:69]
v_pk_add_f32 v[68:69], v[66:67], v[70:71] op_sel:[1,1] op_sel_hi:[0,0] neg_lo:[0,1] neg_hi:[1,0]
v_pk_add_f32 v[66:67], v[66:67], v[70:71]
v_pk_add_f32 v[70:71], v[60:61], v[64:65] neg_lo:[0,1] neg_hi:[0,1]
v_pk_add_f32 v[60:61], v[60:61], v[64:65]
v_pk_add_f32 v[64:65], v[74:75], v[78:79] op_sel:[1,1] op_sel_hi:[0,0] neg_lo:[0,1] neg_hi:[1,0]
v_pk_add_f32 v[74:75], v[74:75], v[78:79]
v_pk_add_f32 v[78:79], v[16:17], v[18:19] neg_lo:[0,1] neg_hi:[0,1]
v_pk_add_f32 v[16:17], v[16:17], v[18:19]
v_pk_add_f32 v[18:19], v[76:77], v[20:21] neg_lo:[0,1] neg_hi:[0,1]
v_pk_add_f32 v[76:77], v[76:77], v[20:21]
v_pk_add_f32 v[20:21], v[72:73], v[26:27] neg_lo:[0,1] neg_hi:[0,1]
v_pk_add_f32 v[72:73], v[72:73], v[26:27]
v_pk_add_f32 v[26:27], v[22:23], v[24:25] neg_lo:[0,1] neg_hi:[0,1]
v_pk_add_f32 v[22:23], v[22:23], v[24:25]
v_pk_add_f32 v[24:25], v[14:15], v[34:35] neg_lo:[0,1] neg_hi:[0,1]
v_pk_add_f32 v[14:15], v[14:15], v[34:35]
v_pk_add_f32 v[34:35], v[30:31], v[36:37] neg_lo:[0,1] neg_hi:[0,1]
v_pk_add_f32 v[30:31], v[30:31], v[36:37]
v_pk_add_f32 v[36:37], v[28:29], v[42:43] neg_lo:[0,1] neg_hi:[0,1]
v_pk_add_f32 v[28:29], v[28:29], v[42:43]
v_pk_add_f32 v[42:43], v[38:39], v[32:33] neg_lo:[0,1] neg_hi:[0,1]
v_pk_add_f32 v[38:39], v[38:39], v[32:33]
v_pk_add_f32 v[32:33], v[48:49], v[50:51] neg_lo:[0,1] neg_hi:[0,1]
v_pk_add_f32 v[48:49], v[48:49], v[50:51]
v_pk_add_f32 v[50:51], v[46:47], v[52:53] neg_lo:[0,1] neg_hi:[0,1]
v_pk_add_f32 v[46:47], v[46:47], v[52:53]
v_pk_add_f32 v[52:53], v[44:45], v[58:59] neg_lo:[0,1] neg_hi:[0,1]
v_pk_add_f32 v[44:45], v[44:45], v[58:59]
v_pk_add_f32 v[58:59], v[54:55], v[56:57] neg_lo:[0,1] neg_hi:[0,1]
v_pk_add_f32 v[54:55], v[54:55], v[56:57]
v_pk_add_f32 v[56:57], v[40:41], v[66:67] neg_lo:[0,1] neg_hi:[0,1]
v_pk_add_f32 v[40:41], v[40:41], v[66:67]
v_pk_add_f32 v[66:67], v[62:63], v[68:69] neg_lo:[0,1] neg_hi:[0,1]
v_pk_add_f32 v[62:63], v[62:63], v[68:69]
v_pk_add_f32 v[68:69], v[60:61], v[74:75] neg_lo:[0,1] neg_hi:[0,1]
v_pk_add_f32 v[60:61], v[60:61], v[74:75]
v_pk_add_f32 v[74:75], v[70:71], v[64:65] neg_lo:[0,1] neg_hi:[0,1]
v_pk_add_f32 v[70:71], v[70:71], v[64:65]
v_pk_mul_f32 v[64:65], v[48:49], v[82:83] op_sel:[0,0] op_sel_hi:[0,1] neg_lo:[0,0] neg_hi:[0,0]
v_pk_fma_f32 v[48:49], v[48:49], v[82:83], v[64:65] op_sel:[1,1,0] op_sel_hi:[1,0,1] neg_lo:[0,1,0] neg_hi:[0,0,0]
v_pk_mul_f32 v[64:65], v[14:15], v[84:85] op_sel:[0,0] op_sel_hi:[0,1] neg_lo:[0,0] neg_hi:[0,0]
v_pk_fma_f32 v[14:15], v[14:15], v[84:85], v[64:65] op_sel:[1,1,0] op_sel_hi:[1,0,1] neg_lo:[0,1,0] neg_hi:[0,0,0]
v_pk_mul_f32 v[64:65], v[40:41], v[86:87] op_sel:[0,0] op_sel_hi:[0,1] neg_lo:[0,0] neg_hi:[0,0]
v_pk_fma_f32 v[40:41], v[40:41], v[86:87], v[64:65] op_sel:[1,1,0] op_sel_hi:[1,0,1] neg_lo:[0,1,0] neg_hi:[0,0,0]
v_pk_mul_f32 v[64:65], v[72:73], v[88:89] op_sel:[0,0] op_sel_hi:[0,1] neg_lo:[0,0] neg_hi:[0,0]
v_pk_fma_f32 v[72:73], v[72:73], v[88:89], v[64:65] op_sel:[1,1,0] op_sel_hi:[1,0,1] neg_lo:[0,1,0] neg_hi:[0,0,0]
v_pk_mul_f32 v[64:65], v[44:45], v[90:91] op_sel:[0,0] op_sel_hi:[0,1] neg_lo:[0,0] neg_hi:[0,0]
v_pk_fma_f32 v[44:45], v[44:45], v[90:91], v[64:65] op_sel:[1,1,0] op_sel_hi:[1,0,1] neg_lo:[0,1,0] neg_hi:[0,0,0]
v_pk_mul_f32 v[64:65], v[28:29], v[92:93] op_sel:[0,0] op_sel_hi:[0,1] neg_lo:[0,0] neg_hi:[0,0]
v_pk_fma_f32 v[28:29], v[28:29], v[92:93], v[64:65] op_sel:[1,1,0] op_sel_hi:[1,0,1] neg_lo:[0,1,0] neg_hi:[0,0,0]
v_pk_mul_f32 v[64:65], v[60:61], v[94:95] op_sel:[0,0] op_sel_hi:[0,1] neg_lo:[0,0] neg_hi:[0,0]
v_pk_fma_f32 v[60:61], v[60:61], v[94:95], v[64:65] op_sel:[1,1,0] op_sel_hi:[1,0,1] neg_lo:[0,1,0] neg_hi:[0,0,0]
v_pk_mul_f32 v[64:65], v[76:77], v[96:97] op_sel:[0,0] op_sel_hi:[0,1] neg_lo:[0,0] neg_hi:[0,0]
v_pk_fma_f32 v[76:77], v[76:77], v[96:97], v[64:65] op_sel:[1,1,0] op_sel_hi:[1,0,1] neg_lo:[0,1,0] neg_hi:[0,0,0]
v_pk_mul_f32 v[64:65], v[46:47], v[98:99] op_sel:[0,0] op_sel_hi:[0,1] neg_lo:[0,0] neg_hi:[0,0]
v_pk_fma_f32 v[46:47], v[46:47], v[98:99], v[64:65] op_sel:[1,1,0] op_sel_hi:[1,0,1] neg_lo:[0,1,0] neg_hi:[0,0,0]
v_pk_mul_f32 v[64:65], v[30:31], v[100:101] op_sel:[0,0] op_sel_hi:[0,1] neg_lo:[0,0] neg_hi:[0,0]
v_pk_fma_f32 v[30:31], v[30:31], v[100:101], v[64:65] op_sel:[1,1,0] op_sel_hi:[1,0,1] neg_lo:[0,1,0] neg_hi:[0,0,0]
v_pk_mul_f32 v[64:65], v[62:63], v[102:103] op_sel:[0,0] op_sel_hi:[0,1] neg_lo:[0,0] neg_hi:[0,0]
v_pk_fma_f32 v[62:63], v[62:63], v[102:103], v[64:65] op_sel:[1,1,0] op_sel_hi:[1,0,1] neg_lo:[0,1,0] neg_hi:[0,0,0]
v_pk_mul_f32 v[64:65], v[22:23], v[104:105] op_sel:[0,0] op_sel_hi:[0,1] neg_lo:[0,0] neg_hi:[0,0]
v_pk_fma_f32 v[22:23], v[22:23], v[104:105], v[64:65] op_sel:[1,1,0] op_sel_hi:[1,0,1] neg_lo:[0,1,0] neg_hi:[0,0,0]
v_pk_mul_f32 v[64:65], v[54:55], v[106:107] op_sel:[0,0] op_sel_hi:[0,1] neg_lo:[0,0] neg_hi:[0,0]
v_pk_fma_f32 v[54:55], v[54:55], v[106:107], v[64:65] op_sel:[1,1,0] op_sel_hi:[1,0,1] neg_lo:[0,1,0] neg_hi:[0,0,0]
v_pk_mul_f32 v[64:65], v[38:39], v[108:109] op_sel:[0,0] op_sel_hi:[0,1] neg_lo:[0,0] neg_hi:[0,0]
v_pk_fma_f32 v[38:39], v[38:39], v[108:109], v[64:65] op_sel:[1,1,0] op_sel_hi:[1,0,1] neg_lo:[0,1,0] neg_hi:[0,0,0]
v_pk_mul_f32 v[64:65], v[70:71], v[110:111] op_sel:[0,0] op_sel_hi:[0,1] neg_lo:[0,0] neg_hi:[0,0]
v_pk_fma_f32 v[70:71], v[70:71], v[110:111], v[64:65] op_sel:[1,1,0] op_sel_hi:[1,0,1] neg_lo:[0,1,0] neg_hi:[0,0,0]
v_pk_mul_f32 v[64:65], v[78:79], v[112:113] op_sel:[0,0] op_sel_hi:[0,1] neg_lo:[0,0] neg_hi:[0,0]
v_pk_fma_f32 v[78:79], v[78:79], v[112:113], v[64:65] op_sel:[1,1,0] op_sel_hi:[1,0,1] neg_lo:[0,1,0] neg_hi:[0,0,0]
v_pk_mul_f32 v[64:65], v[32:33], v[114:115] op_sel:[0,0] op_sel_hi:[0,1] neg_lo:[0,0] neg_hi:[0,0]
v_pk_fma_f32 v[32:33], v[32:33], v[114:115], v[64:65] op_sel:[1,1,0] op_sel_hi:[1,0,1] neg_lo:[0,1,0] neg_hi:[0,0,0]
v_pk_mul_f32 v[64:65], v[24:25], v[116:117] op_sel:[0,0] op_sel_hi:[0,1] neg_lo:[0,0] neg_hi:[0,0]
v_pk_fma_f32 v[24:25], v[24:25], v[116:117], v[64:65] op_sel:[1,1,0] op_sel_hi:[1,0,1] neg_lo:[0,1,0] neg_hi:[0,0,0]
v_pk_mul_f32 v[64:65], v[56:57], v[118:119] op_sel:[0,0] op_sel_hi:[0,1] neg_lo:[0,0] neg_hi:[0,0]
v_pk_fma_f32 v[56:57], v[56:57], v[118:119], v[64:65] op_sel:[1,1,0] op_sel_hi:[1,0,1] neg_lo:[0,1,0] neg_hi:[0,0,0]
v_pk_mul_f32 v[64:65], v[20:21], v[120:121] op_sel:[0,0] op_sel_hi:[0,1] neg_lo:[0,0] neg_hi:[0,0]
v_pk_fma_f32 v[20:21], v[20:21], v[120:121], v[64:65] op_sel:[1,1,0] op_sel_hi:[1,0,1] neg_lo:[0,1,0] neg_hi:[0,0,0]
v_pk_mul_f32 v[64:65], v[52:53], v[122:123] op_sel:[0,0] op_sel_hi:[0,1] neg_lo:[0,0] neg_hi:[0,0]
v_pk_fma_f32 v[52:53], v[52:53], v[122:123], v[64:65] op_sel:[1,1,0] op_sel_hi:[1,0,1] neg_lo:[0,1,0] neg_hi:[0,0,0]
v_pk_mul_f32 v[64:65], v[36:37], v[124:125] op_sel:[0,0] op_sel_hi:[0,1] neg_lo:[0,0] neg_hi:[0,0]
v_pk_fma_f32 v[36:37], v[36:37], v[124:125], v[64:65] op_sel:[1,1,0] op_sel_hi:[1,0,1] neg_lo:[0,1,0] neg_hi:[0,0,0]
v_pk_mul_f32 v[64:65], v[68:69], v[126:127] op_sel:[0,0] op_sel_hi:[0,1] neg_lo:[0,0] neg_hi:[0,0]
v_pk_fma_f32 v[68:69], v[68:69], v[126:127], v[64:65] op_sel:[1,1,0] op_sel_hi:[1,0,1] neg_lo:[0,1,0] neg_hi:[0,0,0]
v_pk_mul_f32 v[64:65], v[18:19], v[128:129] op_sel:[0,0] op_sel_hi:[0,1] neg_lo:[0,0] neg_hi:[0,0]
v_pk_fma_f32 v[18:19], v[18:19], v[128:129], v[64:65] op_sel:[1,1,0] op_sel_hi:[1,0,1] neg_lo:[0,1,0] neg_hi:[0,0,0]
v_pk_mul_f32 v[64:65], v[50:51], v[130:131] op_sel:[0,0] op_sel_hi:[0,1] neg_lo:[0,0] neg_hi:[0,0]
v_pk_fma_f32 v[50:51], v[50:51], v[130:131], v[64:65] op_sel:[1,1,0] op_sel_hi:[1,0,1] neg_lo:[0,1,0] neg_hi:[0,0,0]
v_pk_mul_f32 v[64:65], v[34:35], v[132:133] op_sel:[0,0] op_sel_hi:[0,1] neg_lo:[0,0] neg_hi:[0,0]
v_pk_fma_f32 v[34:35], v[34:35], v[132:133], v[64:65] op_sel:[1,1,0] op_sel_hi:[1,0,1] neg_lo:[0,1,0] neg_hi:[0,0,0]
v_pk_mul_f32 v[64:65], v[66:67], v[134:135] op_sel:[0,0] op_sel_hi:[0,1] neg_lo:[0,0] neg_hi:[0,0]
v_pk_fma_f32 v[66:67], v[66:67], v[134:135], v[64:65] op_sel:[1,1,0] op_sel_hi:[1,0,1] neg_lo:[0,1,0] neg_hi:[0,0,0]
v_pk_mul_f32 v[64:65], v[26:27], v[136:137] op_sel:[0,0] op_sel_hi:[0,1] neg_lo:[0,0] neg_hi:[0,0]
v_pk_fma_f32 v[26:27], v[26:27], v[136:137], v[64:65] op_sel:[1,1,0] op_sel_hi:[1,0,1] neg_lo:[0,1,0] neg_hi:[0,0,0]
v_pk_mul_f32 v[64:65], v[58:59], v[138:139] op_sel:[0,0] op_sel_hi:[0,1] neg_lo:[0,0] neg_hi:[0,0]
v_pk_fma_f32 v[58:59], v[58:59], v[138:139], v[64:65] op_sel:[1,1,0] op_sel_hi:[1,0,1] neg_lo:[0,1,0] neg_hi:[0,0,0]
v_pk_mul_f32 v[64:65], v[42:43], v[140:141] op_sel:[0,0] op_sel_hi:[0,1] neg_lo:[0,0] neg_hi:[0,0]
v_pk_fma_f32 v[42:43], v[42:43], v[140:141], v[64:65] op_sel:[1,1,0] op_sel_hi:[1,0,1] neg_lo:[0,1,0] neg_hi:[0,0,0]
v_pk_mul_f32 v[64:65], v[74:75], v[142:143] op_sel:[0,0] op_sel_hi:[0,1] neg_lo:[0,0] neg_hi:[0,0]
v_pk_fma_f32 v[74:75], v[74:75], v[142:143], v[64:65] op_sel:[1,1,0] op_sel_hi:[1,0,1] neg_lo:[0,1,0] neg_hi:[0,0,0]
s_barrier
ds_write_b64 v4, v[16:17] offset:0
ds_write_b64 v4, v[48:49] offset:264
ds_write_b64 v4, v[14:15] offset:528
ds_write_b64 v4, v[40:41] offset:792
ds_write_b64 v4, v[72:73] offset:1056
ds_write_b64 v4, v[44:45] offset:1320
ds_write_b64 v4, v[28:29] offset:1584
ds_write_b64 v4, v[60:61] offset:1848
ds_write_b64 v4, v[76:77] offset:2112
ds_write_b64 v4, v[46:47] offset:2376
ds_write_b64 v4, v[30:31] offset:2640
ds_write_b64 v4, v[62:63] offset:2904
ds_write_b64 v4, v[22:23] offset:3168
ds_write_b64 v4, v[54:55] offset:3432
ds_write_b64 v4, v[38:39] offset:3696
ds_write_b64 v4, v[70:71] offset:3960
ds_write_b64 v4, v[78:79] offset:4224
ds_write_b64 v4, v[32:33] offset:4488
ds_write_b64 v4, v[24:25] offset:4752
ds_write_b64 v4, v[56:57] offset:5016
ds_write_b64 v4, v[20:21] offset:5280
ds_write_b64 v4, v[52:53] offset:5544
ds_write_b64 v4, v[36:37] offset:5808
ds_write_b64 v4, v[68:69] offset:6072
ds_write_b64 v4, v[18:19] offset:6336
ds_write_b64 v4, v[50:51] offset:6600
ds_write_b64 v4, v[34:35] offset:6864
ds_write_b64 v4, v[66:67] offset:7128
ds_write_b64 v4, v[26:27] offset:7392
ds_write_b64 v4, v[58:59] offset:7656
ds_write_b64 v4, v[42:43] offset:7920
ds_write_b64 v4, v[74:75] offset:8184
s_waitcnt lgkmcnt(0)
ds_read_b64 v[16:17], v5 offset:0
ds_read_b64 v[48:49], v5 offset:128
ds_read_b64 v[18:19], v5 offset:8
ds_read_b64 v[50:51], v5 offset:136
ds_read_b64 v[20:21], v5 offset:16
ds_read_b64 v[52:53], v5 offset:144
ds_read_b64 v[22:23], v5 offset:24
ds_read_b64 v[54:55], v5 offset:152
ds_read_b64 v[24:25], v5 offset:32
ds_read_b64 v[56:57], v5 offset:160
ds_read_b64 v[26:27], v5 offset:40
ds_read_b64 v[58:59], v5 offset:168
ds_read_b64 v[28:29], v5 offset:48
ds_read_b64 v[60:61], v5 offset:176
ds_read_b64 v[30:31], v5 offset:56
ds_read_b64 v[62:63], v5 offset:184
ds_read_b64 v[32:33], v5 offset:64
ds_read_b64 v[64:65], v5 offset:192
ds_read_b64 v[34:35], v5 offset:72
ds_read_b64 v[66:67], v5 offset:200
ds_read_b64 v[36:37], v5 offset:80
ds_read_b64 v[68:69], v5 offset:208
ds_read_b64 v[38:39], v5 offset:88
ds_read_b64 v[70:71], v5 offset:216
ds_read_b64 v[40:41], v5 offset:96
ds_read_b64 v[72:73], v5 offset:224
ds_read_b64 v[42:43], v5 offset:104
ds_read_b64 v[74:75], v5 offset:232
ds_read_b64 v[44:45], v5 offset:112
ds_read_b64 v[76:77], v5 offset:240
ds_read_b64 v[46:47], v5 offset:120
ds_read_b64 v[78:79], v5 offset:248
s_waitcnt lgkmcnt(0)
v_pk_add_f32 v[14:15], v[16:17], v[48:49] neg_lo:[0,1] neg_hi:[0,1]
v_pk_add_f32 v[16:17], v[16:17], v[48:49]
v_pk_add_f32 v[48:49], v[18:19], v[50:51] neg_lo:[0,1] neg_hi:[0,1]
v_pk_add_f32 v[18:19], v[18:19], v[50:51]
v_pk_mul_f32 v[50:51], v[48:49], s[50:51] op_sel:[0,0] op_sel_hi:[0,1] neg_lo:[0,0] neg_hi:[0,1]
v_pk_fma_f32 v[50:51], v[48:49], s[50:51], v[50:51] op_sel:[1,1,0] op_sel_hi:[1,0,1] neg_lo:[0,0,0] neg_hi:[0,0,0]
v_pk_add_f32 v[48:49], v[20:21], v[52:53] neg_lo:[0,1] neg_hi:[0,1]
v_pk_add_f32 v[20:21], v[20:21], v[52:53]
v_pk_mul_f32 v[52:53], v[48:49], s[54:55] op_sel:[0,0] op_sel_hi:[0,1] neg_lo:[0,0] neg_hi:[0,1]
v_pk_fma_f32 v[52:53], v[48:49], s[54:55], v[52:53] op_sel:[1,1,0] op_sel_hi:[1,0,1] neg_lo:[0,0,0] neg_hi:[0,0,0]
v_pk_add_f32 v[48:49], v[22:23], v[54:55] neg_lo:[0,1] neg_hi:[0,1]
v_pk_add_f32 v[22:23], v[22:23], v[54:55]
v_pk_mul_f32 v[54:55], v[48:49], s[58:59] op_sel:[0,0] op_sel_hi:[0,1] neg_lo:[0,0] neg_hi:[0,1]
v_pk_fma_f32 v[54:55], v[48:49], s[58:59], v[54:55] op_sel:[1,1,0] op_sel_hi:[1,0,1] neg_lo:[0,0,0] neg_hi:[0,0,0]
v_pk_add_f32 v[48:49], v[24:25], v[56:57] neg_lo:[0,1] neg_hi:[0,1]
v_pk_add_f32 v[24:25], v[24:25], v[56:57]
v_pk_mul_f32 v[56:57], v[48:49], s[62:63] op_sel:[0,0] op_sel_hi:[0,1] neg_lo:[0,0] neg_hi:[0,1]
v_pk_fma_f32 v[56:57], v[48:49], s[62:63], v[56:57] op_sel:[1,1,0] op_sel_hi:[1,0,1] neg_lo:[0,0,0] neg_hi:[0,0,0]
v_pk_add_f32 v[48:49], v[26:27], v[58:59] neg_lo:[0,1] neg_hi:[0,1]
v_pk_add_f32 v[26:27], v[26:27], v[58:59]
v_pk_mul_f32 v[58:59], v[48:49], s[58:59] op_sel:[0,1] op_sel_hi:[0,0] neg_lo:[0,0] neg_hi:[0,1]
v_pk_fma_f32 v[58:59], v[48:49], s[58:59], v[58:59] op_sel:[1,0,0] op_sel_hi:[1,1,1] neg_lo:[0,0,0] neg_hi:[0,0,0]
v_pk_add_f32 v[48:49], v[28:29], v[60:61] neg_lo:[0,1] neg_hi:[0,1]
v_pk_add_f32 v[28:29], v[28:29], v[60:61]
v_pk_mul_f32 v[60:61], v[48:49], s[54:55] op_sel:[0,1] op_sel_hi:[0,0] neg_lo:[0,0] neg_hi:[0,1]
v_pk_fma_f32 v[60:61], v[48:49], s[54:55], v[60:61] op_sel:[1,0,0] op_sel_hi:[1,1,1] neg_lo:[0,0,0] neg_hi:[0,0,0]
v_pk_add_f32 v[48:49], v[30:31], v[62:63] neg_lo:[0,1] neg_hi:[0,1]
v_pk_add_f32 v[30:31], v[30:31], v[62:63]
v_pk_mul_f32 v[62:63], v[48:49], s[50:51] op_sel:[0,1] op_sel_hi:[0,0] neg_lo:[0,0] neg_hi:[0,1]
v_pk_fma_f32 v[62:63], v[48:49], s[50:51], v[62:63] op_sel:[1,0,0] op_sel_hi:[1,1,1] neg_lo:[0,0,0] neg_hi:[0,0,0]
v_pk_add_f32 v[48:49], v[32:33], v[64:65] op_sel:[1,1] op_sel_hi:[0,0] neg_lo:[0,1] neg_hi:[1,0]
v_pk_add_f32 v[32:33], v[32:33], v[64:65]
v_pk_add_f32 v[64:65], v[34:35], v[66:67] neg_lo:[0,1] neg_hi:[0,1]
v_pk_add_f32 v[34:35], v[34:35], v[66:67]
v_pk_mul_f32 v[66:67], v[64:65], s[50:51] op_sel:[0,1] op_sel_hi:[0,0] neg_lo:[0,1] neg_hi:[0,1]
v_pk_fma_f32 v[66:67], v[64:65], s[50:51], v[66:67] op_sel:[1,0,0] op_sel_hi:[1,1,1] neg_lo:[0,0,0] neg_hi:[0,1,0]
v_pk_add_f32 v[64:65], v[36:37], v[68:69] neg_lo:[0,1] neg_hi:[0,1]
v_pk_add_f32 v[36:37], v[36:37], v[68:69]
v_pk_mul_f32 v[68:69], v[64:65], s[54:55] op_sel:[0,1] op_sel_hi:[0,0] neg_lo:[0,1] neg_hi:[0,1]
v_pk_fma_f32 v[68:69], v[64:65], s[54:55], v[68:69] op_sel:[1,0,0] op_sel_hi:[1,1,1] neg_lo:[0,0,0] neg_hi:[0,1,0]
v_pk_add_f32 v[64:65], v[38:39], v[70:71] neg_lo:[0,1] neg_hi:[0,1]
v_pk_add_f32 v[38:39], v[38:39], v[70:71]
v_pk_mul_f32 v[70:71], v[64:65], s[58:59] op_sel:[0,1] op_sel_hi:[0,0] neg_lo:[0,1] neg_hi:[0,1]
v_pk_fma_f32 v[70:71], v[64:65], s[58:59], v[70:71] op_sel:[1,0,0] op_sel_hi:[1,1,1] neg_lo:[0,0,0] neg_hi:[0,1,0]
v_pk_add_f32 v[64:65], v[40:41], v[72:73] neg_lo:[0,1] neg_hi:[0,1]
v_pk_add_f32 v[40:41], v[40:41], v[72:73]
v_pk_mul_f32 v[72:73], v[64:65], s[62:63] op_sel:[0,0] op_sel_hi:[0,1] neg_lo:[0,1] neg_hi:[0,1]
v_pk_fma_f32 v[72:73], v[64:65], s[62:63], v[72:73] op_sel:[1,1,0] op_sel_hi:[1,0,1] neg_lo:[0,0,0] neg_hi:[0,1,0]
v_pk_add_f32 v[64:65], v[42:43], v[74:75] neg_lo:[0,1] neg_hi:[0,1]
v_pk_add_f32 v[42:43], v[42:43], v[74:75]
v_pk_mul_f32 v[74:75], v[64:65], s[58:59] op_sel:[0,0] op_sel_hi:[0,1] neg_lo:[0,1] neg_hi:[0,1]
v_pk_fma_f32 v[74:75], v[64:65], s[58:59], v[74:75] op_sel:[1,1,0] op_sel_hi:[1,0,1] neg_lo:[0,0,0] neg_hi:[0,1,0]
v_pk_add_f32 v[64:65], v[44:45], v[76:77] neg_lo:[0,1] neg_hi:[0,1]
v_pk_add_f32 v[44:45], v[44:45], v[76:77]
v_pk_mul_f32 v[76:77], v[64:65], s[54:55] op_sel:[0,0] op_sel_hi:[0,1] neg_lo:[0,1] neg_hi:[0,1]
v_pk_fma_f32 v[76:77], v[64:65], s[54:55], v[76:77] op_sel:[1,1,0] op_sel_hi:[1,0,1] neg_lo:[0,0,0] neg_hi:[0,1,0]
v_pk_add_f32 v[64:65], v[46:47], v[78:79] neg_lo:[0,1] neg_hi:[0,1]
v_pk_add_f32 v[46:47], v[46:47], v[78:79]
v_pk_mul_f32 v[78:79], v[64:65], s[50:51] op_sel:[0,0] op_sel_hi:[0,1] neg_lo:[0,1] neg_hi:[0,1]
v_pk_fma_f32 v[78:79], v[64:65], s[50:51], v[78:79] op_sel:[1,1,0] op_sel_hi:[1,0,1] neg_lo:[0,0,0] neg_hi:[0,1,0]
v_pk_add_f32 v[64:65], v[16:17], v[32:33] neg_lo:[0,1] neg_hi:[0,1]
v_pk_add_f32 v[16:17], v[16:17], v[32:33]
v_pk_add_f32 v[32:33], v[18:19], v[34:35] neg_lo:[0,1] neg_hi:[0,1]
v_pk_add_f32 v[18:19], v[18:19], v[34:35]
v_pk_mul_f32 v[34:35], v[32:33], s[54:55] op_sel:[0,0] op_sel_hi:[0,1] neg_lo:[0,0] neg_hi:[0,1]
v_pk_fma_f32 v[34:35], v[32:33], s[54:55], v[34:35] op_sel:[1,1,0] op_sel_hi:[1,0,1] neg_lo:[0,0,0] neg_hi:[0,0,0]
v_pk_add_f32 v[32:33], v[20:21], v[36:37] neg_lo:[0,1] neg_hi:[0,1]
v_pk_add_f32 v[20:21], v[20:21], v[36:37]
v_pk_mul_f32 v[36:37], v[32:33], s[62:63] op_sel:[0,0] op_sel_hi:[0,1] neg_lo:[0,0] neg_hi:[0,1]
v_pk_fma_f32 v[36:37], v[32:33], s[62:63], v[36:37] op_sel:[1,1,0] op_sel_hi:[1,0,1] neg_lo:[0,0,0] neg_hi:[0,0,0]
v_pk_add_f32 v[32:33], v[22:23], v[38:39] neg_lo:[0,1] neg_hi:[0,1]
v_pk_add_f32 v[22:23], v[22:23], v[38:39]
v_pk_mul_f32 v[38:39], v[32:33], s[54:55] op_sel:[0,1] op_sel_hi:[0,0] neg_lo:[0,0] neg_hi:[0,1]
v_pk_fma_f32 v[38:39], v[32:33], s[54:55], v[38:39] op_sel:[1,0,0] op_sel_hi:[1,1,1] neg_lo:[0,0,0] neg_hi:[0,0,0]
v_pk_add_f32 v[32:33], v[24:25], v[40:41] op_sel:[1,1] op_sel_hi:[0,0] neg_lo:[0,1] neg_hi:[1,0]
v_pk_add_f32 v[24:25], v[24:25], v[40:41]
v_pk_add_f32 v[40:41], v[26:27], v[42:43] neg_lo:[0,1] neg_hi:[0,1]
v_pk_add_f32 v[26:27], v[26:27], v[42:43]
v_pk_mul_f32 v[42:43], v[40:41], s[54:55] op_sel:[0,1] op_sel_hi:[0,0] neg_lo:[0,1] neg_hi:[0,1]
v_pk_fma_f32 v[42:43], v[40:41], s[54:55], v[42:43] op_sel:[1,0,0] op_sel_hi:[1,1,1] neg_lo:[0,0,0] neg_hi:[0,1,0]
v_pk_add_f32 v[40:41], v[28:29], v[44:45] neg_lo:[0,1] neg_hi:[0,1]
v_pk_add_f32 v[28:29], v[28:29], v[44:45]
v_pk_mul_f32 v[44:45], v[40:41], s[62:63] op_sel:[0,0] op_sel_hi:[0,1] neg_lo:[0,1] neg_hi:[0,1]
v_pk_fma_f32 v[44:45], v[40:41], s[62:63], v[44:45] op_sel:[1,1,0] op_sel_hi:[1,0,1] neg_lo:[0,0,0] neg_hi:[0,1,0]
v_pk_add_f32 v[40:41], v[30:31], v[46:47] neg_lo:[0,1] neg_hi:[0,1]
v_pk_add_f32 v[30:31], v[30:31], v[46:47]
v_pk_mul_f32 v[46:47], v[40:41], s[54:55] op_sel:[0,0] op_sel_hi:[0,1] neg_lo:[0,1] neg_hi:[0,1]
v_pk_fma_f32 v[46:47], v[40:41], s[54:55], v[46:47] op_sel:[1,1,0] op_sel_hi:[1,0,1] neg_lo:[0,0,0] neg_hi:[0,1,0]
v_pk_add_f32 v[40:41], v[14:15], v[48:49] neg_lo:[0,1] neg_hi:[0,1]
v_pk_add_f32 v[14:15], v[14:15], v[48:49]
v_pk_add_f32 v[48:49], v[50:51], v[66:67] neg_lo:[0,1] neg_hi:[0,1]
v_pk_add_f32 v[50:51], v[50:51], v[66:67]
v_pk_mul_f32 v[66:67], v[48:49], s[54:55] op_sel:[0,0] op_sel_hi:[0,1] neg_lo:[0,0] neg_hi:[0,1]
v_pk_fma_f32 v[66:67], v[48:49], s[54:55], v[66:67] op_sel:[1,1,0] op_sel_hi:[1,0,1] neg_lo:[0,0,0] neg_hi:[0,0,0]
v_pk_add_f32 v[48:49], v[52:53], v[68:69] neg_lo:[0,1] neg_hi:[0,1]
v_pk_add_f32 v[52:53], v[52:53], v[68:69]
v_pk_mul_f32 v[68:69], v[48:49], s[62:63] op_sel:[0,0] op_sel_hi:[0,1] neg_lo:[0,0] neg_hi:[0,1]
v_pk_fma_f32 v[68:69], v[48:49], s[62:63], v[68:69] op_sel:[1,1,0] op_sel_hi:[1,0,1] neg_lo:[0,0,0] neg_hi:[0,0,0]
v_pk_add_f32 v[48:49], v[54:55], v[70:71] neg_lo:[0,1] neg_hi:[0,1]
v_pk_add_f32 v[54:55], v[54:55], v[70:71]
v_pk_mul_f32 v[70:71], v[48:49], s[54:55] op_sel:[0,1] op_sel_hi:[0,0] neg_lo:[0,0] neg_hi:[0,1]
v_pk_fma_f32 v[70:71], v[48:49], s[54:55], v[70:71] op_sel:[1,0,0] op_sel_hi:[1,1,1] neg_lo:[0,0,0] neg_hi:[0,0,0]
v_pk_add_f32 v[48:49], v[56:57], v[72:73] op_sel:[1,1] op_sel_hi:[0,0] neg_lo:[0,1] neg_hi:[1,0]
v_pk_add_f32 v[56:57], v[56:57], v[72:73]
v_pk_add_f32 v[72:73], v[58:59], v[74:75] neg_lo:[0,1] neg_hi:[0,1]
v_pk_add_f32 v[58:59], v[58:59], v[74:75]
v_pk_mul_f32 v[74:75], v[72:73], s[54:55] op_sel:[0,1] op_sel_hi:[0,0] neg_lo:[0,1] neg_hi:[0,1]
v_pk_fma_f32 v[74:75], v[72:73], s[54:55], v[74:75] op_sel:[1,0,0] op_sel_hi:[1,1,1] neg_lo:[0,0,0] neg_hi:[0,1,0]
v_pk_add_f32 v[72:73], v[60:61], v[76:77] neg_lo:[0,1] neg_hi:[0,1]
v_pk_add_f32 v[60:61], v[60:61], v[76:77]
v_pk_mul_f32 v[76:77], v[72:73], s[62:63] op_sel:[0,0] op_sel_hi:[0,1] neg_lo:[0,1] neg_hi:[0,1]
v_pk_fma_f32 v[76:77], v[72:73], s[62:63], v[76:77] op_sel:[1,1,0] op_sel_hi:[1,0,1] neg_lo:[0,0,0] neg_hi:[0,1,0]
v_pk_add_f32 v[72:73], v[62:63], v[78:79] neg_lo:[0,1] neg_hi:[0,1]
v_pk_add_f32 v[62:63], v[62:63], v[78:79]
v_pk_mul_f32 v[78:79], v[72:73], s[54:55] op_sel:[0,0] op_sel_hi:[0,1] neg_lo:[0,1] neg_hi:[0,1]
v_pk_fma_f32 v[78:79], v[72:73], s[54:55], v[78:79] op_sel:[1,1,0] op_sel_hi:[1,0,1] neg_lo:[0,0,0] neg_hi:[0,1,0]
v_pk_add_f32 v[72:73], v[16:17], v[24:25] neg_lo:[0,1] neg_hi:[0,1]
v_pk_add_f32 v[16:17], v[16:17], v[24:25]
v_pk_add_f32 v[24:25], v[18:19], v[26:27] neg_lo:[0,1] neg_hi:[0,1]
v_pk_add_f32 v[18:19], v[18:19], v[26:27]
v_pk_mul_f32 v[26:27], v[24:25], s[62:63] op_sel:[0,0] op_sel_hi:[0,1] neg_lo:[0,0] neg_hi:[0,1]
v_pk_fma_f32 v[26:27], v[24:25], s[62:63], v[26:27] op_sel:[1,1,0] op_sel_hi:[1,0,1] neg_lo:[0,0,0] neg_hi:[0,0,0]
v_pk_add_f32 v[24:25], v[20:21], v[28:29] op_sel:[1,1] op_sel_hi:[0,0] neg_lo:[0,1] neg_hi:[1,0]
v_pk_add_f32 v[20:21], v[20:21], v[28:29]
v_pk_add_f32 v[28:29], v[22:23], v[30:31] neg_lo:[0,1] neg_hi:[0,1]
v_pk_add_f32 v[22:23], v[22:23], v[30:31]
v_pk_mul_f32 v[30:31], v[28:29], s[62:63] op_sel:[0,0] op_sel_hi:[0,1] neg_lo:[0,1] neg_hi:[0,1]
v_pk_fma_f32 v[30:31], v[28:29], s[62:63], v[30:31] op_sel:[1,1,0] op_sel_hi:[1,0,1] neg_lo:[0,0,0] neg_hi:[0,1,0]
v_pk_add_f32 v[28:29], v[64:65], v[32:33] neg_lo:[0,1] neg_hi:[0,1]
v_pk_add_f32 v[64:65], v[64:65], v[32:33]
v_pk_add_f32 v[32:33], v[34:35], v[42:43] neg_lo:[0,1] neg_hi:[0,1]
v_pk_add_f32 v[34:35], v[34:35], v[42:43]
v_pk_mul_f32 v[42:43], v[32:33], s[62:63] op_sel:[0,0] op_sel_hi:[0,1] neg_lo:[0,0] neg_hi:[0,1]
v_pk_fma_f32 v[42:43], v[32:33], s[62:63], v[42:43] op_sel:[1,1,0] op_sel_hi:[1,0,1] neg_lo:[0,0,0] neg_hi:[0,0,0]
v_pk_add_f32 v[32:33], v[36:37], v[44:45] op_sel:[1,1] op_sel_hi:[0,0] neg_lo:[0,1] neg_hi:[1,0]
v_pk_add_f32 v[36:37], v[36:37], v[44:45]
v_pk_add_f32 v[44:45], v[38:39], v[46:47] neg_lo:[0,1] neg_hi:[0,1]
v_pk_add_f32 v[38:39], v[38:39], v[46:47]
v_pk_mul_f32 v[46:47], v[44:45], s[62:63] op_sel:[0,0] op_sel_hi:[0,1] neg_lo:[0,1] neg_hi:[0,1]
v_pk_fma_f32 v[46:47], v[44:45], s[62:63], v[46:47] op_sel:[1,1,0] op_sel_hi:[1,0,1] neg_lo:[0,0,0] neg_hi:[0,1,0]
v_pk_add_f32 v[44:45], v[14:15], v[56:57] neg_lo:[0,1] neg_hi:[0,1]
v_pk_add_f32 v[14:15], v[14:15], v[56:57]
v_pk_add_f32 v[56:57], v[50:51], v[58:59] neg_lo:[0,1] neg_hi:[0,1]
v_pk_add_f32 v[50:51], v[50:51], v[58:59]
v_pk_mul_f32 v[58:59], v[56:57], s[62:63] op_sel:[0,0] op_sel_hi:[0,1] neg_lo:[0,0] neg_hi:[0,1]
v_pk_fma_f32 v[58:59], v[56:57], s[62:63], v[58:59] op_sel:[1,1,0] op_sel_hi:[1,0,1] neg_lo:[0,0,0] neg_hi:[0,0,0]
v_pk_add_f32 v[56:57], v[52:53], v[60:61] op_sel:[1,1] op_sel_hi:[0,0] neg_lo:[0,1] neg_hi:[1,0]
v_pk_add_f32 v[52:53], v[52:53], v[60:61]
v_pk_add_f32 v[60:61], v[54:55], v[62:63] neg_lo:[0,1] neg_hi:[0,1]
v_pk_add_f32 v[54:55], v[54:55], v[62:63]
v_pk_mul_f32 v[62:63], v[60:61], s[62:63] op_sel:[0,0] op_sel_hi:[0,1] neg_lo:[0,1] neg_hi:[0,1]
v_pk_fma_f32 v[62:63], v[60:61], s[62:63], v[62:63] op_sel:[1,1,0] op_sel_hi:[1,0,1] neg_lo:[0,0,0] neg_hi:[0,1,0]
v_pk_add_f32 v[60:61], v[40:41], v[48:49] neg_lo:[0,1] neg_hi:[0,1]
v_pk_add_f32 v[40:41], v[40:41], v[48:49]
v_pk_add_f32 v[48:49], v[66:67], v[74:75] neg_lo:[0,1] neg_hi:[0,1]
v_pk_add_f32 v[66:67], v[66:67], v[74:75]
v_pk_mul_f32 v[74:75], v[48:49], s[62:63] op_sel:[0,0] op_sel_hi:[0,1] neg_lo:[0,0] neg_hi:[0,1]
v_pk_fma_f32 v[74:75], v[48:49], s[62:63], v[74:75] op_sel:[1,1,0] op_sel_hi:[1,0,1] neg_lo:[0,0,0] neg_hi:[0,0,0]
v_pk_add_f32 v[48:49], v[68:69], v[76:77] op_sel:[1,1] op_sel_hi:[0,0] neg_lo:[0,1] neg_hi:[1,0]
v_pk_add_f32 v[68:69], v[68:69], v[76:77]
v_pk_add_f32 v[76:77], v[70:71], v[78:79] neg_lo:[0,1] neg_hi:[0,1]
v_pk_add_f32 v[70:71], v[70:71], v[78:79]
v_pk_mul_f32 v[78:79], v[76:77], s[62:63] op_sel:[0,0] op_sel_hi:[0,1] neg_lo:[0,1] neg_hi:[0,1]
v_pk_fma_f32 v[78:79], v[76:77], s[62:63], v[78:79] op_sel:[1,1,0] op_sel_hi:[1,0,1] neg_lo:[0,0,0] neg_hi:[0,1,0]
v_pk_add_f32 v[76:77], v[16:17], v[20:21] neg_lo:[0,1] neg_hi:[0,1]
v_pk_add_f32 v[16:17], v[16:17], v[20:21]
v_pk_add_f32 v[20:21], v[18:19], v[22:23] op_sel:[1,1] op_sel_hi:[0,0] neg_lo:[0,1] neg_hi:[1,0]
v_pk_add_f32 v[18:19], v[18:19], v[22:23]
v_pk_add_f32 v[22:23], v[72:73], v[24:25] neg_lo:[0,1] neg_hi:[0,1]
v_pk_add_f32 v[72:73], v[72:73], v[24:25]
v_pk_add_f32 v[24:25], v[26:27], v[30:31] op_sel:[1,1] op_sel_hi:[0,0] neg_lo:[0,1] neg_hi:[1,0]
v_pk_add_f32 v[26:27], v[26:27], v[30:31]
v_pk_add_f32 v[30:31], v[64:65], v[36:37] neg_lo:[0,1] neg_hi:[0,1]
v_pk_add_f32 v[64:65], v[64:65], v[36:37]
v_pk_add_f32 v[36:37], v[34:35], v[38:39] op_sel:[1,1] op_sel_hi:[0,0] neg_lo:[0,1] neg_hi:[1,0]
v_pk_add_f32 v[34:35], v[34:35], v[38:39]
v_pk_add_f32 v[38:39], v[28:29], v[32:33] neg_lo:[0,1] neg_hi:[0,1]
v_pk_add_f32 v[28:29], v[28:29], v[32:33]
v_pk_add_f32 v[32:33], v[42:43], v[46:47] op_sel:[1,1] op_sel_hi:[0,0] neg_lo:[0,1] neg_hi:[1,0]
v_pk_add_f32 v[42:43], v[42:43], v[46:47]
v_pk_add_f32 v[46:47], v[14:15], v[52:53] neg_lo:[0,1] neg_hi:[0,1]
v_pk_add_f32 v[14:15], v[14:15], v[52:53]
v_pk_add_f32 v[52:53], v[50:51], v[54:55] op_sel:[1,1] op_sel_hi:[0,0] neg_lo:[0,1] neg_hi:[1,0]
v_pk_add_f32 v[50:51], v[50:51], v[54:55]
v_pk_add_f32 v[54:55], v[44:45], v[56:57] neg_lo:[0,1] neg_hi:[0,1]
v_pk_add_f32 v[44:45], v[44:45], v[56:57]
v_pk_add_f32 v[56:57], v[58:59], v[62:63] op_sel:[1,1] op_sel_hi:[0,0] neg_lo:[0,1] neg_hi:[1,0]
v_pk_add_f32 v[58:59], v[58:59], v[62:63]
v_pk_add_f32 v[62:63], v[40:41], v[68:69] neg_lo:[0,1] neg_hi:[0,1]
v_pk_add_f32 v[40:41], v[40:41], v[68:69]
v_pk_add_f32 v[68:69], v[66:67], v[70:71] op_sel:[1,1] op_sel_hi:[0,0] neg_lo:[0,1] neg_hi:[1,0]
v_pk_add_f32 v[66:67], v[66:67], v[70:71]
v_pk_add_f32 v[70:71], v[60:61], v[48:49] neg_lo:[0,1] neg_hi:[0,1]
v_pk_add_f32 v[60:61], v[60:61], v[48:49]
v_pk_add_f32 v[48:49], v[74:75], v[78:79] op_sel:[1,1] op_sel_hi:[0,0] neg_lo:[0,1] neg_hi:[1,0]
v_pk_add_f32 v[74:75], v[74:75], v[78:79]
v_pk_add_f32 v[78:79], v[16:17], v[18:19] neg_lo:[0,1] neg_hi:[0,1]
v_pk_add_f32 v[16:17], v[16:17], v[18:19]
v_pk_add_f32 v[18:19], v[76:77], v[20:21] neg_lo:[0,1] neg_hi:[0,1]
v_pk_add_f32 v[76:77], v[76:77], v[20:21]
v_pk_add_f32 v[20:21], v[72:73], v[26:27] neg_lo:[0,1] neg_hi:[0,1]
v_pk_add_f32 v[72:73], v[72:73], v[26:27]
v_pk_add_f32 v[26:27], v[22:23], v[24:25] neg_lo:[0,1] neg_hi:[0,1]
v_pk_add_f32 v[22:23], v[22:23], v[24:25]
v_pk_add_f32 v[24:25], v[64:65], v[34:35] neg_lo:[0,1] neg_hi:[0,1]
v_pk_add_f32 v[64:65], v[64:65], v[34:35]
v_pk_add_f32 v[34:35], v[30:31], v[36:37] neg_lo:[0,1] neg_hi:[0,1]
v_pk_add_f32 v[30:31], v[30:31], v[36:37]
v_pk_add_f32 v[36:37], v[28:29], v[42:43] neg_lo:[0,1] neg_hi:[0,1]
v_pk_add_f32 v[28:29], v[28:29], v[42:43]
v_pk_add_f32 v[42:43], v[38:39], v[32:33] neg_lo:[0,1] neg_hi:[0,1]
v_pk_add_f32 v[38:39], v[38:39], v[32:33]
v_pk_add_f32 v[32:33], v[14:15], v[50:51] neg_lo:[0,1] neg_hi:[0,1]
v_pk_add_f32 v[14:15], v[14:15], v[50:51]
v_pk_add_f32 v[50:51], v[46:47], v[52:53] neg_lo:[0,1] neg_hi:[0,1]
v_pk_add_f32 v[46:47], v[46:47], v[52:53]
v_pk_add_f32 v[52:53], v[44:45], v[58:59] neg_lo:[0,1] neg_hi:[0,1]
v_pk_add_f32 v[44:45], v[44:45], v[58:59]
v_pk_add_f32 v[58:59], v[54:55], v[56:57] neg_lo:[0,1] neg_hi:[0,1]
v_pk_add_f32 v[54:55], v[54:55], v[56:57]
v_pk_add_f32 v[56:57], v[40:41], v[66:67] neg_lo:[0,1] neg_hi:[0,1]
v_pk_add_f32 v[40:41], v[40:41], v[66:67]
v_pk_add_f32 v[66:67], v[62:63], v[68:69] neg_lo:[0,1] neg_hi:[0,1]
v_pk_add_f32 v[62:63], v[62:63], v[68:69]
v_pk_add_f32 v[68:69], v[60:61], v[74:75] neg_lo:[0,1] neg_hi:[0,1]
v_pk_add_f32 v[60:61], v[60:61], v[74:75]
v_pk_add_f32 v[74:75], v[70:71], v[48:49] neg_lo:[0,1] neg_hi:[0,1]
v_pk_add_f32 v[70:71], v[70:71], v[48:49]
ds_write_b64 v4, v[16:17] offset:0
ds_write_b64 v4, v[14:15] offset:256
ds_write_b64 v4, v[64:65] offset:512
ds_write_b64 v4, v[40:41] offset:768
ds_write_b64 v4, v[72:73] offset:1024
ds_write_b64 v4, v[44:45] offset:1280
ds_write_b64 v4, v[28:29] offset:1536
ds_write_b64 v4, v[60:61] offset:1792
ds_write_b64 v4, v[76:77] offset:2048
ds_write_b64 v4, v[46:47] offset:2304
ds_write_b64 v4, v[30:31] offset:2560
ds_write_b64 v4, v[62:63] offset:2816
ds_write_b64 v4, v[22:23] offset:3072
ds_write_b64 v4, v[54:55] offset:3328
ds_write_b64 v4, v[38:39] offset:3584
ds_write_b64 v4, v[70:71] offset:3840
ds_write_b64 v4, v[78:79] offset:4096
ds_write_b64 v4, v[32:33] offset:4352
ds_write_b64 v4, v[24:25] offset:4608
ds_write_b64 v4, v[56:57] offset:4864
ds_write_b64 v4, v[20:21] offset:5120
ds_write_b64 v4, v[52:53] offset:5376
ds_write_b64 v4, v[36:37] offset:5632
ds_write_b64 v4, v[68:69] offset:5888
ds_write_b64 v4, v[18:19] offset:6144
ds_write_b64 v4, v[50:51] offset:6400
ds_write_b64 v4, v[34:35] offset:6656
ds_write_b64 v4, v[66:67] offset:6912
ds_write_b64 v4, v[26:27] offset:7168
ds_write_b64 v4, v[58:59] offset:7424
ds_write_b64 v4, v[42:43] offset:7680
ds_write_b64 v4, v[74:75] offset:7936
ds_write_b64 v4, v[16:17] offset:8192
s_waitcnt lgkmcnt(0)
s_barrier
s_lshl_b32 s13, s93, 7
s_add_u32 s13, s13, 96468992
ds_read_b64 v[16:17], v6 offset:0
ds_read_b64 v[18:19], v7 offset:4096
ds_read_b64 v[20:21], v6 offset:256
ds_read_b64 v[22:23], v7 offset:3840
ds_read_b64 v[24:25], v6 offset:512
ds_read_b64 v[26:27], v7 offset:3584
ds_read_b64 v[28:29], v6 offset:768
ds_read_b64 v[30:31], v7 offset:3328
ds_read_b64 v[32:33], v6 offset:1024
ds_read_b64 v[34:35], v7 offset:3072
ds_read_b64 v[36:37], v6 offset:1280
ds_read_b64 v[38:39], v7 offset:2816
s_waitcnt lgkmcnt(10)
v_pk_add_f32 v[208:209], v[16:17], v[18:19] neg_hi:[0,1]
v_pk_add_f32 v[210:211], v[16:17], v[18:19] op_sel:[1,1] op_sel_hi:[0,0] neg_hi:[1,0]
ds_read_b64 v[40:41], v6 offset:1536
ds_read_b64 v[42:43], v7 offset:2560
buffer_store_dwordx4 v[208:211], v8, s[84:87], s13 offen sc1
s_add_u32 s13, s13, 524288
s_waitcnt lgkmcnt(10)
v_pk_add_f32 v[212:213], v[20:21], v[22:23] neg_hi:[0,1]
v_pk_add_f32 v[214:215], v[20:21], v[22:23] op_sel:[1,1] op_sel_hi:[0,0] neg_hi:[1,0]
ds_read_b64 v[44:45], v6 offset:1792
ds_read_b64 v[46:47], v7 offset:2304
buffer_store_dwordx4 v[212:215], v8, s[84:87], s13 offen sc1
s_add_u32 s13, s13, 524288
s_waitcnt lgkmcnt(10)
v_pk_add_f32 v[216:217], v[24:25], v[26:27] neg_hi:[0,1]
v_pk_add_f32 v[218:219], v[24:25], v[26:27] op_sel:[1,1] op_sel_hi:[0,0] neg_hi:[1,0]
ds_read_b64 v[16:17], v6 offset:2048
ds_read_b64 v[18:19], v7 offset:2048
buffer_store_dwordx4 v[216:219], v8, s[84:87], s13 offen sc1
s_add_u32 s13, s13, 524288
s_waitcnt lgkmcnt(10)
v_pk_add_f32 v[220:221], v[28:29], v[30:31] neg_hi:[0,1]
v_pk_add_f32 v[222:223], v[28:29], v[30:31] op_sel:[1,1] op_sel_hi:[0,0] neg_hi:[1,0]
ds_read_b64 v[20:21], v6 offset:2304
ds_read_b64 v[22:23], v7 offset:1792
buffer_store_dwordx4 v[220:223], v8, s[84:87], s13 offen sc1
s_add_u32 s13, s13, 524288
s_waitcnt lgkmcnt(10)
v_pk_add_f32 v[224:225], v[32:33], v[34:35] neg_hi:[0,1]
v_pk_add_f32 v[226:227], v[32:33], v[34:35] op_sel:[1,1] op_sel_hi:[0,0] neg_hi:[1,0]
ds_read_b64 v[24:25], v6 offset:2560
ds_read_b64 v[26:27], v7 offset:1536
buffer_store_dwordx4 v[224:227], v8, s[84:87], s13 offen sc1
s_add_u32 s13, s13, 524288
s_waitcnt lgkmcnt(10)
v_pk_add_f32 v[228:229], v[36:37], v[38:39] neg_hi:[0,1]
v_pk_add_f32 v[230:231], v[36:37], v[38:39] op_sel:[1,1] op_sel_hi:[0,0] neg_hi:[1,0]
ds_read_b64 v[28:29], v6 offset:2816
ds_read_b64 v[30:31], v7 offset:1280
buffer_store_dwordx4 v[228:231], v8, s[84:87], s13 offen sc1
s_add_u32 s13, s13, 524288
s_waitcnt lgkmcnt(10)
v_pk_add_f32 v[232:233], v[40:41], v[42:43] neg_hi:[0,1]
v_pk_add_f32 v[234:235], v[40:41], v[42:43] op_sel:[1,1] op_sel_hi:[0,0] neg_hi:[1,0]
ds_read_b64 v[32:33], v6 offset:3072
ds_read_b64 v[34:35], v7 offset:1024
buffer_store_dwordx4 v[232:235], v8, s[84:87], s13 offen sc1
s_add_u32 s13, s13, 524288
s_waitcnt lgkmcnt(10)
v_pk_add_f32 v[236:237], v[44:45], v[46:47] neg_hi:[0,1]
v_pk_add_f32 v[238:239], v[44:45], v[46:47] op_sel:[1,1] op_sel_hi:[0,0] neg_hi:[1,0]
ds_read_b64 v[36:37], v6 offset:3328
ds_read_b64 v[38:39], v7 offset:768
buffer_store_dwordx4 v[236:239], v8, s[84:87], s13 offen sc1
s_add_u32 s13, s13, 524288
s_waitcnt lgkmcnt(10)
v_pk_add_f32 v[208:209], v[16:17], v[18:19] neg_hi:[0,1]
v_pk_add_f32 v[210:211], v[16:17], v[18:19] op_sel:[1,1] op_sel_hi:[0,0] neg_hi:[1,0]
ds_read_b64 v[40:41], v6 offset:3584
ds_read_b64 v[42:43], v7 offset:512
buffer_store_dwordx4 v[208:211], v8, s[84:87], s13 offen sc1
s_add_u32 s13, s13, 524288
s_waitcnt lgkmcnt(10)
v_pk_add_f32 v[212:213], v[20:21], v[22:23] neg_hi:[0,1]
v_pk_add_f32 v[214:215], v[20:21], v[22:23] op_sel:[1,1] op_sel_hi:[0,0] neg_hi:[1,0]
ds_read_b64 v[44:45], v6 offset:3840
ds_read_b64 v[46:47], v7 offset:256
buffer_store_dwordx4 v[212:215], v8, s[84:87], s13 offen sc1
s_add_u32 s13, s13, 524288
s_waitcnt lgkmcnt(10)
v_pk_add_f32 v[216:217], v[24:25], v[26:27] neg_hi:[0,1]
v_pk_add_f32 v[218:219], v[24:25], v[26:27] op_sel:[1,1] op_sel_hi:[0,0] neg_hi:[1,0]
ds_read_b64 v[16:17], v6 offset:4096
ds_read_b64 v[18:19], v7 offset:0
buffer_store_dwordx4 v[216:219], v8, s[84:87], s13 offen sc1
s_add_u32 s13, s13, 524288
s_waitcnt lgkmcnt(10)
v_pk_add_f32 v[220:221], v[28:29], v[30:31] neg_hi:[0,1]
v_pk_add_f32 v[222:223], v[28:29], v[30:31] op_sel:[1,1] op_sel_hi:[0,0] neg_hi:[1,0]
buffer_store_dwordx4 v[220:223], v8, s[84:87], s13 offen sc1
s_add_u32 s13, s13, 524288
s_waitcnt lgkmcnt(8)
v_pk_add_f32 v[224:225], v[32:33], v[34:35] neg_hi:[0,1]
v_pk_add_f32 v[226:227], v[32:33], v[34:35] op_sel:[1,1] op_sel_hi:[0,0] neg_hi:[1,0]
buffer_store_dwordx4 v[224:227], v8, s[84:87], s13 offen sc1
s_add_u32 s13, s13, 524288
s_waitcnt lgkmcnt(6)
v_pk_add_f32 v[228:229], v[36:37], v[38:39] neg_hi:[0,1]
v_pk_add_f32 v[230:231], v[36:37], v[38:39] op_sel:[1,1] op_sel_hi:[0,0] neg_hi:[1,0]
buffer_store_dwordx4 v[228:231], v8, s[84:87], s13 offen sc1
s_add_u32 s13, s13, 524288
s_waitcnt lgkmcnt(4)
v_pk_add_f32 v[232:233], v[40:41], v[42:43] neg_hi:[0,1]
v_pk_add_f32 v[234:235], v[40:41], v[42:43] op_sel:[1,1] op_sel_hi:[0,0] neg_hi:[1,0]
buffer_store_dwordx4 v[232:235], v8, s[84:87], s13 offen sc1
s_add_u32 s13, s13, 524288
s_waitcnt lgkmcnt(2)
v_pk_add_f32 v[236:237], v[44:45], v[46:47] neg_hi:[0,1]
v_pk_add_f32 v[238:239], v[44:45], v[46:47] op_sel:[1,1] op_sel_hi:[0,0] neg_hi:[1,0]
buffer_store_dwordx4 v[236:239], v8, s[84:87], s13 offen sc1
s_add_u32 s13, s13, 524288
s_waitcnt lgkmcnt(0)
v_pk_add_f32 v[208:209], v[16:17], v[18:19] neg_hi:[0,1]
v_pk_add_f32 v[210:211], v[16:17], v[18:19] op_sel:[1,1] op_sel_hi:[0,0] neg_hi:[1,0]
v_cmp_eq_u32 vcc, 0, v9
s_nop 1
v_cndmask_b32 v13, -16, v8, vcc
buffer_store_dwordx4 v[208:211], v13, s[84:87], s13 offen sc1
s_add_u32 s13, s13, 524288
s_mov_b32 s93, s21
s_cmp_lt_u32 s93, 128
s_cbranch_scc1 mega_kernel_f1_l
mega_kernel_f1_e:
s_mov_b32 s93, s40
s_waitcnt vmcnt(0)
s_load_dwordx2 s[4:5], s[0:1], 64
s_load_dwordx2 s[8:9], s[0:1], 72
v_and_b32 v1, 63, v0
v_lshrrev_b32 v2, 6, v0
v_mul_u32_u24 v3, 1026, v2
v_lshl_add_u32 v3, v1, 1, v3
v_mul_u32_u24 v4, 65, v1
v_add_u32 v4, v4, v2
v_lshlrev_b32 v4, 2, v4
v_lshrrev_b32 v7, 4, v0
v_and_b32 v8, 15, v0
v_mul_u32_u24 v5, 65, v7
v_lshl_add_u32 v5, v8, 2, v5
v_lshlrev_b32 v5, 2, v5
v_lshlrev_b32 v6, 13, v7
v_lshl_add_u32 v6, v8, 4, v6
s_add_u32 s24, s84, 121634816
s_addc_u32 s25, s85, 0
s_mov_b32 s26, 4202496
s_mov_b32 s27, 0x00020000
s_waitcnt lgkmcnt(0)
s_mov_b32 s6, 2101248
s_mov_b32 s7, 0x00020000
s_mov_b32 s10, 2101248
s_mov_b32 s11, 0x00020000
s_cmp_lt_u32 s93, 288
s_cbranch_scc0 mega_kernel_f0_e
s_and_b32 s12, s93, 31
s_mul_i32 s12, s12, 65664
s_lshr_b32 s13, s93, 5
s_lshl_b32 s13, s13, 7
s_add_u32 s12, s12, s13
buffer_load_ushort v16, v3, s[4:7], s12 offen
buffer_load_ushort v32, v3, s[8:11], s12 offen
s_add_u32 s12, s12, 4104
buffer_load_ushort v17, v3, s[4:7], s12 offen
buffer_load_ushort v33, v3, s[8:11], s12 offen
s_add_u32 s12, s12, 4104
buffer_load_ushort v18, v3, s[4:7], s12 offen
buffer_load_ushort v34, v3, s[8:11], s12 offen
s_add_u32 s12, s12, 4104
buffer_load_ushort v19, v3, s[4:7], s12 offen
buffer_load_ushort v35, v3, s[8:11], s12 offen
s_add_u32 s12, s12, 4104
buffer_load_ushort v20, v3, s[4:7], s12 offen
buffer_load_ushort v36, v3, s[8:11], s12 offen
s_add_u32 s12, s12, 4104
buffer_load_ushort v21, v3, s[4:7], s12 offen
buffer_load_ushort v37, v3, s[8:11], s12 offen
s_add_u32 s12, s12, 4104
buffer_load_ushort v22, v3, s[4:7], s12 offen
buffer_load_ushort v38, v3, s[8:11], s12 offen
s_add_u32 s12, s12, 4104
buffer_load_ushort v23, v3, s[4:7], s12 offen
buffer_load_ushort v39, v3, s[8:11], s12 offen
s_add_u32 s12, s12, 4104
buffer_load_ushort v24, v3, s[4:7], s12 offen
buffer_load_ushort v40, v3, s[8:11], s12 offen
s_add_u32 s12, s12, 4104
buffer_load_ushort v25, v3, s[4:7], s12 offen
buffer_load_ushort v41, v3, s[8:11], s12 offen
s_add_u32 s12, s12, 4104
buffer_load_ushort v26, v3, s[4:7], s12 offen
buffer_load_ushort v42, v3, s[8:11], s12 offen
s_add_u32 s12, s12, 4104
buffer_load_ushort v27, v3, s[4:7], s12 offen
buffer_load_ushort v43, v3, s[8:11], s12 offen
s_add_u32 s12, s12, 4104
buffer_load_ushort v28, v3, s[4:7], s12 offen
buffer_load_ushort v44, v3, s[8:11], s12 offen
s_add_u32 s12, s12, 4104
buffer_load_ushort v29, v3, s[4:7], s12 offen
buffer_load_ushort v45, v3, s[8:11], s12 offen
s_add_u32 s12, s12, 4104
buffer_load_ushort v30, v3, s[4:7], s12 offen
buffer_load_ushort v46, v3, s[8:11], s12 offen
s_add_u32 s12, s12, 4104
buffer_load_ushort v31, v3, s[4:7], s12 offen
buffer_load_ushort v47, v3, s[8:11], s12 offen
s_add_u32 s12, s12, 4104
s_waitcnt vmcnt(0)
mega_kernel_f0_l:
s_add_u32 s21, s93, 32
s_cmp_lt_u32 s21, 288
s_cselect_b32 s22, s21, s93
s_waitcnt vmcnt(4)
v_lshl_or_b32 v48, v32, 16, v16
v_lshl_or_b32 v49, v33, 16, v17
v_lshl_or_b32 v50, v34, 16, v18
v_lshl_or_b32 v51, v35, 16, v19
v_lshl_or_b32 v52, v36, 16, v20
v_lshl_or_b32 v53, v37, 16, v21
v_lshl_or_b32 v54, v38, 16, v22
v_lshl_or_b32 v55, v39, 16, v23
v_lshl_or_b32 v56, v40, 16, v24
v_lshl_or_b32 v57, v41, 16, v25
v_lshl_or_b32 v58, v42, 16, v26
v_lshl_or_b32 v59, v43, 16, v27
v_lshl_or_b32 v60, v44, 16, v28
v_lshl_or_b32 v61, v45, 16, v29
v_lshl_or_b32 v62, v46, 16, v30
v_lshl_or_b32 v63, v47, 16, v31
s_and_b32 s12, s22, 31
s_mul_i32 s12, s12, 65664
s_lshr_b32 s13, s22, 5
s_lshl_b32 s13, s13, 7
s_add_u32 s12, s12, s13
buffer_load_ushort v16, v3, s[4:7], s12 offen
buffer_load_ushort v32, v3, s[8:11], s12 offen
s_add_u32 s12, s12, 4104
buffer_load_ushort v17, v3, s[4:7], s12 offen
buffer_load_ushort v33, v3, s[8:11], s12 offen
s_add_u32 s12, s12, 4104
buffer_load_ushort v18, v3, s[4:7], s12 offen
buffer_load_ushort v34, v3, s[8:11], s12 offen
s_add_u32 s12, s12, 4104
buffer_load_ushort v19, v3, s[4:7], s12 offen
buffer_load_ushort v35, v3, s[8:11], s12 offen
s_add_u32 s12, s12, 4104
buffer_load_ushort v20, v3, s[4:7], s12 offen
buffer_load_ushort v36, v3, s[8:11], s12 offen
s_add_u32 s12, s12, 4104
buffer_load_ushort v21, v3, s[4:7], s12 offen
buffer_load_ushort v37, v3, s[8:11], s12 offen
s_add_u32 s12, s12, 4104
buffer_load_ushort v22, v3, s[4:7], s12 offen
buffer_load_ushort v38, v3, s[8:11], s12 offen
s_add_u32 s12, s12, 4104
buffer_load_ushort v23, v3, s[4:7], s12 offen
buffer_load_ushort v39, v3, s[8:11], s12 offen
s_add_u32 s12, s12, 4104
buffer_load_ushort v24, v3, s[4:7], s12 offen
buffer_load_ushort v40, v3, s[8:11], s12 offen
s_add_u32 s12, s12, 4104
buffer_load_ushort v25, v3, s[4:7], s12 offen
buffer_load_ushort v41, v3, s[8:11], s12 offen
s_add_u32 s12, s12, 4104
buffer_load_ushort v26, v3, s[4:7], s12 offen
buffer_load_ushort v42, v3, s[8:11], s12 offen
s_add_u32 s12, s12, 4104
buffer_load_ushort v27, v3, s[4:7], s12 offen
buffer_load_ushort v43, v3, s[8:11], s12 offen
s_add_u32 s12, s12, 4104
buffer_load_ushort v28, v3, s[4:7], s12 offen
buffer_load_ushort v44, v3, s[8:11], s12 offen
s_add_u32 s12, s12, 4104
buffer_load_ushort v29, v3, s[4:7], s12 offen
buffer_load_ushort v45, v3, s[8:11], s12 offen
s_add_u32 s12, s12, 4104
buffer_load_ushort v30, v3, s[4:7], s12 offen
buffer_load_ushort v46, v3, s[8:11], s12 offen
s_add_u32 s12, s12, 4104
buffer_load_ushort v31, v3, s[4:7], s12 offen
buffer_load_ushort v47, v3, s[8:11], s12 offen
s_add_u32 s12, s12, 4104
s_barrier
ds_write_b32 v4, v48 offset:0
ds_write_b32 v4, v49 offset:16
ds_write_b32 v4, v50 offset:32
ds_write_b32 v4, v51 offset:48
ds_write_b32 v4, v52 offset:64
ds_write_b32 v4, v53 offset:80
ds_write_b32 v4, v54 offset:96
ds_write_b32 v4, v55 offset:112
ds_write_b32 v4, v56 offset:128
ds_write_b32 v4, v57 offset:144
ds_write_b32 v4, v58 offset:160
ds_write_b32 v4, v59 offset:176
s_waitcnt lgkmcnt(4)
ds_write_b32 v4, v60 offset:192
ds_write_b32 v4, v61 offset:208
ds_write_b32 v4, v62 offset:224
ds_write_b32 v4, v63 offset:240
s_waitcnt lgkmcnt(0)
s_barrier
ds_read2_b32 v[64:65], v5 offset0:0 offset1:1
ds_read_b32 v66, v5 offset:8
ds_read_b32 v67, v5 offset:12
ds_read_b32 v68, v5 offset:4160
ds_read_b32 v69, v5 offset:4164
ds_read_b32 v70, v5 offset:4168
ds_read_b32 v71, v5 offset:4172
ds_read_b32 v72, v5 offset:8320
ds_read_b32 v73, v5 offset:8324
ds_read_b32 v74, v5 offset:8328
ds_read_b32 v75, v5 offset:8332
ds_read_b32 v76, v5 offset:12480
ds_read_b32 v77, v5 offset:12484
ds_read_b32 v78, v5 offset:12488
ds_read_b32 v79, v5 offset:12492
s_and_b32 s14, s93, 31
s_lshl_b32 s14, s14, 8
s_lshr_b32 s15, s93, 5
s_lshl_b32 s15, s15, 19
s_add_u32 s14, s14, s15
s_waitcnt lgkmcnt(0)
buffer_store_dwordx4 v[64:67], v6, s[24:27], s14 offen sc1
s_add_u32 s14, s14, 131072
buffer_store_dwordx4 v[68:71], v6, s[24:27], s14 offen sc1
s_add_u32 s14, s14, 131072
buffer_store_dwordx4 v[72:75], v6, s[24:27], s14 offen sc1
s_add_u32 s14, s14, 131072
buffer_store_dwordx4 v[76:79], v6, s[24:27], s14 offen sc1
s_add_u32 s14, s14, 131072
s_mov_b32 s93, s21
s_cmp_lt_u32 s93, 288
s_cbranch_scc1 mega_kernel_f0_l
mega_kernel_f0_e:
v_and_b32 v3, 15, v0
v_lshlrev_b32 v3, 4, v3
s_branch mega_kernel_syd
mega_kernel_sydw:
s_sleep 4
mega_kernel_syd:
buffer_load_dword v2, v3, s[72:75], 0 offen sc1
s_waitcnt vmcnt(0)
s_cmp_eq_u32 s95, 1
s_cbranch_scc0 mega_kernel_sydf
v_readlane_b32 s76, v2, 14
s_mov_b32 s98, 0
s_cmp_eq_u32 s76, 64
s_cbranch_scc0 mega_kernel_sydw
s_branch mega_kernel_sydd
mega_kernel_sydf:
s_mov_b32 s77, 0
s_mov_b32 s78, 0
v_readlane_b32 s76, v2, 0
s_add_u32 s77, s77, s76
s_xor_b32 s76, s76, 32
s_or_b32 s78, s78, s76
v_readlane_b32 s76, v2, 1
s_add_u32 s77, s77, s76
s_xor_b32 s76, s76, 32
s_or_b32 s78, s78, s76
v_readlane_b32 s76, v2, 2
s_add_u32 s77, s77, s76
s_xor_b32 s76, s76, 32
s_or_b32 s78, s78, s76
v_readlane_b32 s76, v2, 3
s_add_u32 s77, s77, s76
s_xor_b32 s76, s76, 32
s_or_b32 s78, s78, s76
v_readlane_b32 s76, v2, 4
s_add_u32 s77, s77, s76
s_xor_b32 s76, s76, 32
s_or_b32 s78, s78, s76
v_readlane_b32 s76, v2, 5
s_add_u32 s77, s77, s76
s_xor_b32 s76, s76, 32
s_or_b32 s78, s78, s76
v_readlane_b32 s76, v2, 6
s_add_u32 s77, s77, s76
s_xor_b32 s76, s76, 32
s_or_b32 s78, s78, s76
v_readlane_b32 s76, v2, 7
s_add_u32 s77, s77, s76
s_xor_b32 s76, s76, 32
s_or_b32 s78, s78, s76
s_cmp_eq_u32 s77, 256
s_cbranch_scc0 mega_kernel_sydw
v_mov_b32 v252, v2
s_cmp_eq_u32 s78, 0
s_cbranch_scc0 mega_kernel_slowent
v_readlane_b32 s76, v2, 10
v_readlane_b32 s77, v2, 8
s_cmp_eq_u32 s76, 64
s_cbranch_scc0 mega_kernel_sydw
s_cmp_gt_u32 s77, 32
s_cselect_b32 s98, 1, 0
mega_kernel_sydd:
s_waitcnt vmcnt(0)
s_barrier
v_mov_b32 v1, 0
v_mov_b32 v2, 1
s_mov_b32 s82, 69259264
v_cmp_eq_u32 vcc, 0, v0
s_and_saveexec_b64 s[80:81], vcc
s_cbranch_execz mega_kernel_sg0
buffer_atomic_add v2, v1, s[84:87], s82 offen sc1
mega_kernel_sg0:
s_mov_b64 exec, s[80:81]
s_add_u32 s38, s40, 129
s_mov_b32 s39, 32
s_mov_b32 s37, 129
s_cmp_lt_u32 s38, 129
s_cbranch_scc1 mega_kernel_f2s
s_branch mega_kernel_f2e
mega_kernel_rk:
s_load_dwordx2 s[4:5], s[0:1], 24
s_load_dwordx2 s[8:9], s[0:1], 0
v_lshrrev_b32 v2, 6, v0
v_and_b32 v1, 63, v0
v_readfirstlane_b32 s41, v2
v_lshlrev_b32 v5, 4, v1
s_waitcnt lgkmcnt(0)
s_mov_b32 s6, 8388608
s_mov_b32 s7, 0x00020000
s_mov_b32 s10, 4194304
s_mov_b32 s11, 0x00020000
s_lshl_b32 s43, s40, 8
s_lshl_b32 s44, s41, 6
s_add_u32 s48, s43, s44
s_and_b32 s43, s48, 0x7ff
v_add_u32 v19, s43, v1
v_lshlrev_b32 v19, 7, v19
buffer_load_dword v250, v19, s[8:11], 0 offen
s_nop 0
v_lshrrev_b32 v2, 3, v1
s_lshl_b32 s43, s41, 3
v_add_u32 v2, s43, v2
v_bfe_u32 v3, v2, 1, 3
v_and_b32 v4, 7, v1
v_xor_b32 v3, v3, v4
v_lshlrev_b32 v6, 11, v2
v_lshl_add_u32 v6, v3, 4, v6
s_lshl_b32 s46, s41, 10
v_and_b32 v2, 15, v1
v_bfe_u32 v3, v2, 1, 3
v_lshrrev_b32 v4, 4, v1
v_xor_b32 v3, v3, v4
v_lshlrev_b32 v8, 7, v2
v_lshl_add_u32 v8, v3, 4, v8
v_xor_b32 v9, 64, v8
v_add_u32 v10, 0x10000, v8
v_add_u32 v11, 0x10000, v9
v_mov_b32 v7, v5
s_lshl_b32 s47, s40, 2
s_add_u32 s47, s47, s41
s_mov_b32 s42, 0
s_mov_b32 s50, 0
s_add_u32 m0, s46, 0
s_nop 0
buffer_load_dwordx4 v6, s[8:11], s50 offen offset:0 lds
s_add_u32 m0, s46, 3968
s_nop 0
buffer_load_dwordx4 v6, s[8:11], s50 offen offset:128 lds
s_add_u32 m0, s46, 7936
s_nop 0
buffer_load_dwordx4 v6, s[8:11], s50 offen offset:256 lds
s_add_u32 m0, s46, 11904
s_nop 0
buffer_load_dwordx4 v6, s[8:11], s50 offen offset:384 lds
s_add_u32 m0, s46, 15872
s_nop 0
buffer_load_dwordx4 v6, s[8:11], s50 offen offset:512 lds
s_add_u32 m0, s46, 19840
s_nop 0
buffer_load_dwordx4 v6, s[8:11], s50 offen offset:640 lds
s_add_u32 m0, s46, 23808
s_nop 0
buffer_load_dwordx4 v6, s[8:11], s50 offen offset:768 lds
s_add_u32 m0, s46, 27776
s_nop 0
buffer_load_dwordx4 v6, s[8:11], s50 offen offset:896 lds
s_add_u32 m0, s46, 31744
s_nop 0
buffer_load_dwordx4 v6, s[8:11], s50 offen offset:1024 lds
s_add_u32 m0, s46, 35712
s_nop 0
buffer_load_dwordx4 v6, s[8:11], s50 offen offset:1152 lds
s_add_u32 m0, s46, 39680
s_nop 0
buffer_load_dwordx4 v6, s[8:11], s50 offen offset:1280 lds
s_add_u32 m0, s46, 43648
s_nop 0
buffer_load_dwordx4 v6, s[8:11], s50 offen offset:1408 lds
s_add_u32 m0, s46, 47616
s_nop 0
buffer_load_dwordx4 v6, s[8:11], s50 offen offset:1536 lds
s_add_u32 m0, s46, 51584
s_nop 0
buffer_load_dwordx4 v6, s[8:11], s50 offen offset:1664 lds
s_add_u32 m0, s46, 55552
s_nop 0
buffer_load_dwordx4 v6, s[8:11], s50 offen offset:1792 lds
s_add_u32 m0, s46, 59520
s_nop 0
buffer_load_dwordx4 v6, s[8:11], s50 offen offset:1920 lds
v_lshrrev_b32 v2, 2, v1
v_and_b32 v3, 3, v1
v_lshlrev_b32 v16, 13, v2
v_lshl_add_u32 v16, v3, 4, v16
v_add_u32 v16, s48, v16
s_mul_i32 s45, s41, 24576
s_add_u32 s45, s45, 65536
v_bfe_u32 v17, v1, 2, 2
v_lshrrev_b32 v18, 4, v1
v_lshl_add_u32 v17, v18, 3, v17
v_lshlrev_b32 v17, 6, v17
v_lshl_add_u32 v17, v3, 4, v17
v_add_u32 v17, s45, v17
s_and_b32 s43, s40, 3
s_lshl_b32 s43, s43, 2
s_add_u32 s43, s43, s41
s_lshl_b32 s43, s43, 3
v_and_b32 v12, 7, v1
v_add_u32 v12, s43, v12
s_lshr_b32 s43, s40, 2
s_lshl_b32 s43, s43, 10
s_add_u32 s44, s43, 896
s_add_u32 s43, s43, 384
s_cmp_ge_u32 s40, 28
s_cselect_b32 s44, s44, s43
v_mov_b32 v13, s43
v_mov_b32 v14, s44
v_cmp_gt_u32 vcc, 32, v1
s_nop 1
v_cndmask_b32 v13, v14, v13, vcc
v_lshl_add_u32 v12, v12, 13, v13
s_mov_b32 s44, 0
buffer_load_dword v250, v12, s[4:7], s44 offen
s_add_u32 m0, s45, 0
s_mov_b32 s44, 0
buffer_load_dwordx4 v16, s[4:7], s44 offen lds
s_add_u32 m0, s45, 1024
s_mov_b32 s44, 131072
buffer_load_dwordx4 v16, s[4:7], s44 offen lds
s_add_u32 m0, s45, 2048
s_mov_b32 s44, 262144
buffer_load_dwordx4 v16, s[4:7], s44 offen lds
s_add_u32 m0, s45, 3072
s_mov_b32 s44, 393216
buffer_load_dwordx4 v16, s[4:7], s44 offen lds
s_add_u32 m0, s45, 4096
s_mov_b32 s44, 524288
buffer_load_dwordx4 v16, s[4:7], s44 offen lds
s_add_u32 m0, s45, 5120
s_mov_b32 s44, 655360
buffer_load_dwordx4 v16, s[4:7], s44 offen lds
s_add_u32 m0, s45, 6144
s_mov_b32 s44, 786432
buffer_load_dwordx4 v16, s[4:7], s44 offen lds
s_add_u32 m0, s45, 7168
s_mov_b32 s44, 917504
buffer_load_dwordx4 v16, s[4:7], s44 offen lds
s_mov_b32 s44, 1048576
buffer_load_dword v250, v12, s[4:7], s44 offen
s_add_u32 m0, s45, 8192
s_mov_b32 s44, 1048576
buffer_load_dwordx4 v16, s[4:7], s44 offen lds
s_add_u32 m0, s45, 9216
s_mov_b32 s44, 1179648
buffer_load_dwordx4 v16, s[4:7], s44 offen lds
s_add_u32 m0, s45, 10240
s_mov_b32 s44, 1310720
buffer_load_dwordx4 v16, s[4:7], s44 offen lds
s_add_u32 m0, s45, 11264
s_mov_b32 s44, 1441792
buffer_load_dwordx4 v16, s[4:7], s44 offen lds
s_add_u32 m0, s45, 12288
s_mov_b32 s44, 1572864
buffer_load_dwordx4 v16, s[4:7], s44 offen lds
s_add_u32 m0, s45, 13312
s_mov_b32 s44, 1703936
buffer_load_dwordx4 v16, s[4:7], s44 offen lds
s_add_u32 m0, s45, 14336
s_mov_b32 s44, 1835008
buffer_load_dwordx4 v16, s[4:7], s44 offen lds
s_add_u32 m0, s45, 15360
s_mov_b32 s44, 1966080
buffer_load_dwordx4 v16, s[4:7], s44 offen lds
s_mov_b32 s44, 2097152
buffer_load_dword v250, v12, s[4:7], s44 offen
s_add_u32 m0, s45, 16384
s_mov_b32 s44, 2097152
buffer_load_dwordx4 v16, s[4:7], s44 offen lds
s_add_u32 m0, s45, 17408
s_mov_b32 s44, 2228224
buffer_load_dwordx4 v16, s[4:7], s44 offen lds
s_add_u32 m0, s45, 18432
s_mov_b32 s44, 2359296
buffer_load_dwordx4 v16, s[4:7], s44 offen lds
s_add_u32 m0, s45, 19456
s_mov_b32 s44, 2490368
buffer_load_dwordx4 v16, s[4:7], s44 offen lds
s_add_u32 m0, s45, 20480
s_mov_b32 s44, 2621440
buffer_load_dwordx4 v16, s[4:7], s44 offen lds
s_add_u32 m0, s45, 21504
s_mov_b32 s44, 2752512
buffer_load_dwordx4 v16, s[4:7], s44 offen lds
s_add_u32 m0, s45, 22528
s_mov_b32 s44, 2883584
buffer_load_dwordx4 v16, s[4:7], s44 offen lds
s_add_u32 m0, s45, 23552
s_mov_b32 s44, 3014656
buffer_load_dwordx4 v16, s[4:7], s44 offen lds
s_waitcnt vmcnt(18)
s_barrier
ds_read_b64_tr_b16 a[0:1], v17 offset:0
ds_read_b64_tr_b16 a[2:3], v17 offset:256
ds_read_b64_tr_b16 a[4:5], v17 offset:8
ds_read_b64_tr_b16 a[6:7], v17 offset:264
ds_read_b64_tr_b16 a[8:9], v17 offset:2048
ds_read_b64_tr_b16 a[10:11], v17 offset:2304
ds_read_b64_tr_b16 a[12:13], v17 offset:2056
ds_read_b64_tr_b16 a[14:15], v17 offset:2312
s_waitcnt lgkmcnt(0)
ds_read_b64_tr_b16 a[16:17], v17 offset:4096
ds_read_b64_tr_b16 a[18:19], v17 offset:4352
ds_read_b64_tr_b16 a[20:21], v17 offset:4104
ds_read_b64_tr_b16 a[22:23], v17 offset:4360
ds_read_b64_tr_b16 a[24:25], v17 offset:6144
ds_read_b64_tr_b16 a[26:27], v17 offset:6400
ds_read_b64_tr_b16 a[28:29], v17 offset:6152
ds_read_b64_tr_b16 a[30:31], v17 offset:6408
s_waitcnt lgkmcnt(0)
ds_read_b128 v[20:23], v8 offset:0
ds_read_b128 v[24:27], v8 offset:2048
ds_read_b128 v[28:31], v9 offset:0
ds_read_b128 v[32:35], v9 offset:2048
ds_read_b128 v[36:39], v8 offset:4096
ds_read_b128 v[40:43], v8 offset:6144
ds_read_b128 v[44:47], v9 offset:4096
ds_read_b128 v[48:51], v9 offset:6144
s_mov_b32 s44, 3145728
buffer_load_dword v250, v12, s[4:7], s44 offen
s_add_u32 m0, s45, 0
s_mov_b32 s44, 3145728
buffer_load_dwordx4 v16, s[4:7], s44 offen lds
s_add_u32 m0, s45, 1024
s_mov_b32 s44, 3276800
buffer_load_dwordx4 v16, s[4:7], s44 offen lds
s_add_u32 m0, s45, 2048
s_mov_b32 s44, 3407872
buffer_load_dwordx4 v16, s[4:7], s44 offen lds
s_add_u32 m0, s45, 3072
s_mov_b32 s44, 3538944
buffer_load_dwordx4 v16, s[4:7], s44 offen lds
s_add_u32 m0, s45, 4096
s_mov_b32 s44, 3670016
buffer_load_dwordx4 v16, s[4:7], s44 offen lds
s_add_u32 m0, s45, 5120
s_mov_b32 s44, 3801088
buffer_load_dwordx4 v16, s[4:7], s44 offen lds
s_add_u32 m0, s45, 6144
s_mov_b32 s44, 3932160
buffer_load_dwordx4 v16, s[4:7], s44 offen lds
s_add_u32 m0, s45, 7168
s_mov_b32 s44, 4063232
buffer_load_dwordx4 v16, s[4:7], s44 offen lds
s_waitcnt lgkmcnt(0)
v_mfma_f32_16x16x32_bf16 v[52:55], a[0:3], v[20:23], 0
v_mfma_f32_16x16x32_bf16 v[56:59], a[4:7], v[20:23], 0
v_mfma_f32_16x16x32_bf16 v[60:63], a[0:3], v[24:27], 0
v_mfma_f32_16x16x32_bf16 v[64:67], a[4:7], v[24:27], 0
v_mfma_f32_16x16x32_bf16 v[52:55], a[8:11], v[28:31], v[52:55]
v_mfma_f32_16x16x32_bf16 v[56:59], a[12:15], v[28:31], v[56:59]
v_mfma_f32_16x16x32_bf16 v[60:63], a[8:11], v[32:35], v[60:63]
v_mfma_f32_16x16x32_bf16 v[64:67], a[12:15], v[32:35], v[64:67]
v_mfma_f32_16x16x32_bf16 v[52:55], a[16:19], v[36:39], v[52:55]
v_mfma_f32_16x16x32_bf16 v[56:59], a[20:23], v[36:39], v[56:59]
v_mfma_f32_16x16x32_bf16 v[60:63], a[16:19], v[40:43], v[60:63]
v_mfma_f32_16x16x32_bf16 v[64:67], a[20:23], v[40:43], v[64:67]
v_mfma_f32_16x16x32_bf16 v[52:55], a[24:27], v[44:47], v[52:55]
v_mfma_f32_16x16x32_bf16 v[56:59], a[28:31], v[44:47], v[56:59]
v_mfma_f32_16x16x32_bf16 v[60:63], a[24:27], v[48:51], v[60:63]
v_mfma_f32_16x16x32_bf16 v[64:67], a[28:31], v[48:51], v[64:67]
s_waitcnt vmcnt(18)
ds_read_b64_tr_b16 a[32:33], v17 offset:8192
ds_read_b64_tr_b16 a[34:35], v17 offset:8448
ds_read_b64_tr_b16 a[36:37], v17 offset:8200
ds_read_b64_tr_b16 a[38:39], v17 offset:8456
ds_read_b64_tr_b16 a[40:41], v17 offset:10240
ds_read_b64_tr_b16 a[42:43], v17 offset:10496
ds_read_b64_tr_b16 a[44:45], v17 offset:10248
ds_read_b64_tr_b16 a[46:47], v17 offset:10504
s_waitcnt lgkmcnt(0)
ds_read_b64_tr_b16 a[48:49], v17 offset:12288
ds_read_b64_tr_b16 a[50:51], v17 offset:12544
ds_read_b64_tr_b16 a[52:53], v17 offset:12296
ds_read_b64_tr_b16 a[54:55], v17 offset:12552
ds_read_b64_tr_b16 a[56:57], v17 offset:14336
ds_read_b64_tr_b16 a[58:59], v17 offset:14592
ds_read_b64_tr_b16 a[60:61], v17 offset:14344
ds_read_b64_tr_b16 a[62:63], v17 offset:14600
s_waitcnt lgkmcnt(0)
ds_read_b128 v[20:23], v8 offset:8192
ds_read_b128 v[24:27], v8 offset:10240
ds_read_b128 v[28:31], v9 offset:8192
ds_read_b128 v[32:35], v9 offset:10240
ds_read_b128 v[36:39], v8 offset:12288
ds_read_b128 v[40:43], v8 offset:14336
ds_read_b128 v[44:47], v9 offset:12288
ds_read_b128 v[48:51], v9 offset:14336
s_mov_b32 s44, 4194304
buffer_load_dword v250, v12, s[4:7], s44 offen
s_add_u32 m0, s45, 8192
s_mov_b32 s44, 4194304
buffer_load_dwordx4 v16, s[4:7], s44 offen lds
s_add_u32 m0, s45, 9216
s_mov_b32 s44, 4325376
buffer_load_dwordx4 v16, s[4:7], s44 offen lds
s_add_u32 m0, s45, 10240
s_mov_b32 s44, 4456448
buffer_load_dwordx4 v16, s[4:7], s44 offen lds
s_add_u32 m0, s45, 11264
s_mov_b32 s44, 4587520
buffer_load_dwordx4 v16, s[4:7], s44 offen lds
s_add_u32 m0, s45, 12288
s_mov_b32 s44, 4718592
buffer_load_dwordx4 v16, s[4:7], s44 offen lds
s_add_u32 m0, s45, 13312
s_mov_b32 s44, 4849664
buffer_load_dwordx4 v16, s[4:7], s44 offen lds
s_add_u32 m0, s45, 14336
s_mov_b32 s44, 4980736
buffer_load_dwordx4 v16, s[4:7], s44 offen lds
s_add_u32 m0, s45, 15360
s_mov_b32 s44, 5111808
buffer_load_dwordx4 v16, s[4:7], s44 offen lds
s_waitcnt lgkmcnt(0)
v_mfma_f32_16x16x32_bf16 v[52:55], a[32:35], v[20:23], v[52:55]
v_mfma_f32_16x16x32_bf16 v[56:59], a[36:39], v[20:23], v[56:59]
v_mfma_f32_16x16x32_bf16 v[60:63], a[32:35], v[24:27], v[60:63]
v_mfma_f32_16x16x32_bf16 v[64:67], a[36:39], v[24:27], v[64:67]
v_mfma_f32_16x16x32_bf16 v[52:55], a[40:43], v[28:31], v[52:55]
v_mfma_f32_16x16x32_bf16 v[56:59], a[44:47], v[28:31], v[56:59]
v_mfma_f32_16x16x32_bf16 v[60:63], a[40:43], v[32:35], v[60:63]
v_mfma_f32_16x16x32_bf16 v[64:67], a[44:47], v[32:35], v[64:67]
v_mfma_f32_16x16x32_bf16 v[52:55], a[48:51], v[36:39], v[52:55]
v_mfma_f32_16x16x32_bf16 v[56:59], a[52:55], v[36:39], v[56:59]
v_mfma_f32_16x16x32_bf16 v[60:63], a[48:51], v[40:43], v[60:63]
v_mfma_f32_16x16x32_bf16 v[64:67], a[52:55], v[40:43], v[64:67]
v_mfma_f32_16x16x32_bf16 v[52:55], a[56:59], v[44:47], v[52:55]
v_mfma_f32_16x16x32_bf16 v[56:59], a[60:63], v[44:47], v[56:59]
v_mfma_f32_16x16x32_bf16 v[60:63], a[56:59], v[48:51], v[60:63]
v_mfma_f32_16x16x32_bf16 v[64:67], a[60:63], v[48:51], v[64:67]
s_waitcnt vmcnt(18)
ds_read_b64_tr_b16 a[64:65], v17 offset:16384
ds_read_b64_tr_b16 a[66:67], v17 offset:16640
ds_read_b64_tr_b16 a[68:69], v17 offset:16392
ds_read_b64_tr_b16 a[70:71], v17 offset:16648
ds_read_b64_tr_b16 a[72:73], v17 offset:18432
ds_read_b64_tr_b16 a[74:75], v17 offset:18688
ds_read_b64_tr_b16 a[76:77], v17 offset:18440
ds_read_b64_tr_b16 a[78:79], v17 offset:18696
s_waitcnt lgkmcnt(0)
ds_read_b64_tr_b16 a[80:81], v17 offset:20480
ds_read_b64_tr_b16 a[82:83], v17 offset:20736
ds_read_b64_tr_b16 a[84:85], v17 offset:20488
ds_read_b64_tr_b16 a[86:87], v17 offset:20744
ds_read_b64_tr_b16 a[88:89], v17 offset:22528
ds_read_b64_tr_b16 a[90:91], v17 offset:22784
ds_read_b64_tr_b16 a[92:93], v17 offset:22536
ds_read_b64_tr_b16 a[94:95], v17 offset:22792
s_waitcnt lgkmcnt(0)
ds_read_b128 v[20:23], v8 offset:16384
ds_read_b128 v[24:27], v8 offset:18432
ds_read_b128 v[28:31], v9 offset:16384
ds_read_b128 v[32:35], v9 offset:18432
ds_read_b128 v[36:39], v8 offset:20480
ds_read_b128 v[40:43], v8 offset:22528
ds_read_b128 v[44:47], v9 offset:20480
ds_read_b128 v[48:51], v9 offset:22528
s_mov_b32 s44, 5242880
buffer_load_dword v250, v12, s[4:7], s44 offen
s_add_u32 m0, s45, 16384
s_mov_b32 s44, 5242880
buffer_load_dwordx4 v16, s[4:7], s44 offen lds
s_add_u32 m0, s45, 17408
s_mov_b32 s44, 5373952
buffer_load_dwordx4 v16, s[4:7], s44 offen lds
s_add_u32 m0, s45, 18432
s_mov_b32 s44, 5505024
buffer_load_dwordx4 v16, s[4:7], s44 offen lds
s_add_u32 m0, s45, 19456
s_mov_b32 s44, 5636096
buffer_load_dwordx4 v16, s[4:7], s44 offen lds
s_add_u32 m0, s45, 20480
s_mov_b32 s44, 5767168
buffer_load_dwordx4 v16, s[4:7], s44 offen lds
s_add_u32 m0, s45, 21504
s_mov_b32 s44, 5898240
buffer_load_dwordx4 v16, s[4:7], s44 offen lds
s_add_u32 m0, s45, 22528
s_mov_b32 s44, 6029312
buffer_load_dwordx4 v16, s[4:7], s44 offen lds
s_add_u32 m0, s45, 23552
s_mov_b32 s44, 6160384
buffer_load_dwordx4 v16, s[4:7], s44 offen lds
s_waitcnt lgkmcnt(0)
v_mfma_f32_16x16x32_bf16 v[52:55], a[64:67], v[20:23], v[52:55]
v_mfma_f32_16x16x32_bf16 v[56:59], a[68:71], v[20:23], v[56:59]
v_mfma_f32_16x16x32_bf16 v[60:63], a[64:67], v[24:27], v[60:63]
v_mfma_f32_16x16x32_bf16 v[64:67], a[68:71], v[24:27], v[64:67]
v_mfma_f32_16x16x32_bf16 v[52:55], a[72:75], v[28:31], v[52:55]
v_mfma_f32_16x16x32_bf16 v[56:59], a[76:79], v[28:31], v[56:59]
v_mfma_f32_16x16x32_bf16 v[60:63], a[72:75], v[32:35], v[60:63]
v_mfma_f32_16x16x32_bf16 v[64:67], a[76:79], v[32:35], v[64:67]
v_mfma_f32_16x16x32_bf16 v[52:55], a[80:83], v[36:39], v[52:55]
v_mfma_f32_16x16x32_bf16 v[56:59], a[84:87], v[36:39], v[56:59]
v_mfma_f32_16x16x32_bf16 v[60:63], a[80:83], v[40:43], v[60:63]
v_mfma_f32_16x16x32_bf16 v[64:67], a[84:87], v[40:43], v[64:67]
v_mfma_f32_16x16x32_bf16 v[52:55], a[88:91], v[44:47], v[52:55]
v_mfma_f32_16x16x32_bf16 v[56:59], a[92:95], v[44:47], v[56:59]
v_mfma_f32_16x16x32_bf16 v[60:63], a[88:91], v[48:51], v[60:63]
v_mfma_f32_16x16x32_bf16 v[64:67], a[92:95], v[48:51], v[64:67]
s_waitcnt vmcnt(18)
ds_read_b64_tr_b16 a[96:97], v17 offset:0
ds_read_b64_tr_b16 a[98:99], v17 offset:256
ds_read_b64_tr_b16 a[100:101], v17 offset:8
ds_read_b64_tr_b16 a[102:103], v17 offset:264
ds_read_b64_tr_b16 a[104:105], v17 offset:2048
ds_read_b64_tr_b16 a[106:107], v17 offset:2304
ds_read_b64_tr_b16 a[108:109], v17 offset:2056
ds_read_b64_tr_b16 a[110:111], v17 offset:2312
s_waitcnt lgkmcnt(0)
ds_read_b64_tr_b16 a[112:113], v17 offset:4096
ds_read_b64_tr_b16 a[114:115], v17 offset:4352
ds_read_b64_tr_b16 a[116:117], v17 offset:4104
ds_read_b64_tr_b16 a[118:119], v17 offset:4360
ds_read_b64_tr_b16 a[120:121], v17 offset:6144
ds_read_b64_tr_b16 a[122:123], v17 offset:6400
ds_read_b64_tr_b16 a[124:125], v17 offset:6152
ds_read_b64_tr_b16 a[126:127], v17 offset:6408
s_waitcnt lgkmcnt(0)
ds_read_b128 v[20:23], v8 offset:24576
ds_read_b128 v[24:27], v8 offset:26624
ds_read_b128 v[28:31], v9 offset:24576
ds_read_b128 v[32:35], v9 offset:26624
ds_read_b128 v[36:39], v8 offset:28672
ds_read_b128 v[40:43], v8 offset:30720
ds_read_b128 v[44:47], v9 offset:28672
ds_read_b128 v[48:51], v9 offset:30720
s_mov_b32 s44, 6291456
buffer_load_dword v250, v12, s[4:7], s44 offen
s_add_u32 m0, s45, 0
s_mov_b32 s44, 6291456
buffer_load_dwordx4 v16, s[4:7], s44 offen lds
s_add_u32 m0, s45, 1024
s_mov_b32 s44, 6422528
buffer_load_dwordx4 v16, s[4:7], s44 offen lds
s_add_u32 m0, s45, 2048
s_mov_b32 s44, 6553600
buffer_load_dwordx4 v16, s[4:7], s44 offen lds
s_add_u32 m0, s45, 3072
s_mov_b32 s44, 6684672
buffer_load_dwordx4 v16, s[4:7], s44 offen lds
s_add_u32 m0, s45, 4096
s_mov_b32 s44, 6815744
buffer_load_dwordx4 v16, s[4:7], s44 offen lds
s_add_u32 m0, s45, 5120
s_mov_b32 s44, 6946816
buffer_load_dwordx4 v16, s[4:7], s44 offen lds
s_add_u32 m0, s45, 6144
s_mov_b32 s44, 7077888
buffer_load_dwordx4 v16, s[4:7], s44 offen lds
s_add_u32 m0, s45, 7168
s_mov_b32 s44, 7208960
buffer_load_dwordx4 v16, s[4:7], s44 offen lds
s_waitcnt lgkmcnt(0)
v_mfma_f32_16x16x32_bf16 v[52:55], a[96:99], v[20:23], v[52:55]
v_mfma_f32_16x16x32_bf16 v[56:59], a[100:103], v[20:23], v[56:59]
v_mfma_f32_16x16x32_bf16 v[60:63], a[96:99], v[24:27], v[60:63]
v_mfma_f32_16x16x32_bf16 v[64:67], a[100:103], v[24:27], v[64:67]
v_mfma_f32_16x16x32_bf16 v[52:55], a[104:107], v[28:31], v[52:55]
v_mfma_f32_16x16x32_bf16 v[56:59], a[108:111], v[28:31], v[56:59]
v_mfma_f32_16x16x32_bf16 v[60:63], a[104:107], v[32:35], v[60:63]
v_mfma_f32_16x16x32_bf16 v[64:67], a[108:111], v[32:35], v[64:67]
v_mfma_f32_16x16x32_bf16 v[52:55], a[112:115], v[36:39], v[52:55]
v_mfma_f32_16x16x32_bf16 v[56:59], a[116:119], v[36:39], v[56:59]
v_mfma_f32_16x16x32_bf16 v[60:63], a[112:115], v[40:43], v[60:63]
v_mfma_f32_16x16x32_bf16 v[64:67], a[116:119], v[40:43], v[64:67]
v_mfma_f32_16x16x32_bf16 v[52:55], a[120:123], v[44:47], v[52:55]
v_mfma_f32_16x16x32_bf16 v[56:59], a[124:127], v[44:47], v[56:59]
v_mfma_f32_16x16x32_bf16 v[60:63], a[120:123], v[48:51], v[60:63]
v_mfma_f32_16x16x32_bf16 v[64:67], a[124:127], v[48:51], v[64:67]
s_waitcnt vmcnt(18)
ds_read_b64_tr_b16 a[128:129], v17 offset:8192
ds_read_b64_tr_b16 a[130:131], v17 offset:8448
ds_read_b64_tr_b16 a[132:133], v17 offset:8200
ds_read_b64_tr_b16 a[134:135], v17 offset:8456
ds_read_b64_tr_b16 a[136:137], v17 offset:10240
ds_read_b64_tr_b16 a[138:139], v17 offset:10496
ds_read_b64_tr_b16 a[140:141], v17 offset:10248
ds_read_b64_tr_b16 a[142:143], v17 offset:10504
s_waitcnt lgkmcnt(0)
ds_read_b64_tr_b16 a[144:145], v17 offset:12288
ds_read_b64_tr_b16 a[146:147], v17 offset:12544
ds_read_b64_tr_b16 a[148:149], v17 offset:12296
ds_read_b64_tr_b16 a[150:151], v17 offset:12552
ds_read_b64_tr_b16 a[152:153], v17 offset:14336
ds_read_b64_tr_b16 a[154:155], v17 offset:14592
ds_read_b64_tr_b16 a[156:157], v17 offset:14344
ds_read_b64_tr_b16 a[158:159], v17 offset:14600
s_waitcnt lgkmcnt(0)
ds_read_b128 v[20:23], v8 offset:32768
ds_read_b128 v[24:27], v8 offset:34816
ds_read_b128 v[28:31], v9 offset:32768
ds_read_b128 v[32:35], v9 offset:34816
ds_read_b128 v[36:39], v8 offset:36864
ds_read_b128 v[40:43], v8 offset:38912
ds_read_b128 v[44:47], v9 offset:36864
ds_read_b128 v[48:51], v9 offset:38912
s_mov_b32 s44, 7340032
buffer_load_dword v250, v12, s[4:7], s44 offen
s_add_u32 m0, s45, 8192
s_mov_b32 s44, 7340032
buffer_load_dwordx4 v16, s[4:7], s44 offen lds
s_add_u32 m0, s45, 9216
s_mov_b32 s44, 7471104
buffer_load_dwordx4 v16, s[4:7], s44 offen lds
s_add_u32 m0, s45, 10240
s_mov_b32 s44, 7602176
buffer_load_dwordx4 v16, s[4:7], s44 offen lds
s_add_u32 m0, s45, 11264
s_mov_b32 s44, 7733248
buffer_load_dwordx4 v16, s[4:7], s44 offen lds
s_add_u32 m0, s45, 12288
s_mov_b32 s44, 7864320
buffer_load_dwordx4 v16, s[4:7], s44 offen lds
s_add_u32 m0, s45, 13312
s_mov_b32 s44, 7995392
buffer_load_dwordx4 v16, s[4:7], s44 offen lds
s_add_u32 m0, s45, 14336
s_mov_b32 s44, 8126464
buffer_load_dwordx4 v16, s[4:7], s44 offen lds
s_add_u32 m0, s45, 15360
s_mov_b32 s44, 8257536
buffer_load_dwordx4 v16, s[4:7], s44 offen lds
s_waitcnt lgkmcnt(0)
v_mfma_f32_16x16x32_bf16 v[52:55], a[128:131], v[20:23], v[52:55]
v_mfma_f32_16x16x32_bf16 v[56:59], a[132:135], v[20:23], v[56:59]
v_mfma_f32_16x16x32_bf16 v[60:63], a[128:131], v[24:27], v[60:63]
v_mfma_f32_16x16x32_bf16 v[64:67], a[132:135], v[24:27], v[64:67]
v_mfma_f32_16x16x32_bf16 v[52:55], a[136:139], v[28:31], v[52:55]
v_mfma_f32_16x16x32_bf16 v[56:59], a[140:143], v[28:31], v[56:59]
v_mfma_f32_16x16x32_bf16 v[60:63], a[136:139], v[32:35], v[60:63]
v_mfma_f32_16x16x32_bf16 v[64:67], a[140:143], v[32:35], v[64:67]
v_mfma_f32_16x16x32_bf16 v[52:55], a[144:147], v[36:39], v[52:55]
v_mfma_f32_16x16x32_bf16 v[56:59], a[148:151], v[36:39], v[56:59]
v_mfma_f32_16x16x32_bf16 v[60:63], a[144:147], v[40:43], v[60:63]
v_mfma_f32_16x16x32_bf16 v[64:67], a[148:151], v[40:43], v[64:67]
v_mfma_f32_16x16x32_bf16 v[52:55], a[152:155], v[44:47], v[52:55]
v_mfma_f32_16x16x32_bf16 v[56:59], a[156:159], v[44:47], v[56:59]
v_mfma_f32_16x16x32_bf16 v[60:63], a[152:155], v[48:51], v[60:63]
v_mfma_f32_16x16x32_bf16 v[64:67], a[156:159], v[48:51], v[64:67]
s_waitcnt vmcnt(18)
ds_read_b64_tr_b16 a[160:161], v17 offset:16384
ds_read_b64_tr_b16 a[162:163], v17 offset:16640
ds_read_b64_tr_b16 a[164:165], v17 offset:16392
ds_read_b64_tr_b16 a[166:167], v17 offset:16648
ds_read_b64_tr_b16 a[168:169], v17 offset:18432
ds_read_b64_tr_b16 a[170:171], v17 offset:18688
ds_read_b64_tr_b16 a[172:173], v17 offset:18440
ds_read_b64_tr_b16 a[174:175], v17 offset:18696
s_waitcnt lgkmcnt(0)
ds_read_b64_tr_b16 a[176:177], v17 offset:20480
ds_read_b64_tr_b16 a[178:179], v17 offset:20736
ds_read_b64_tr_b16 a[180:181], v17 offset:20488
ds_read_b64_tr_b16 a[182:183], v17 offset:20744
ds_read_b64_tr_b16 a[184:185], v17 offset:22528
ds_read_b64_tr_b16 a[186:187], v17 offset:22784
ds_read_b64_tr_b16 a[188:189], v17 offset:22536
ds_read_b64_tr_b16 a[190:191], v17 offset:22792
s_waitcnt lgkmcnt(0)
ds_read_b128 v[20:23], v8 offset:40960
ds_read_b128 v[24:27], v8 offset:43008
ds_read_b128 v[28:31], v9 offset:40960
ds_read_b128 v[32:35], v9 offset:43008
ds_read_b128 v[36:39], v8 offset:45056
ds_read_b128 v[40:43], v8 offset:47104
ds_read_b128 v[44:47], v9 offset:45056
ds_read_b128 v[48:51], v9 offset:47104
s_waitcnt lgkmcnt(0)
v_mfma_f32_16x16x32_bf16 v[52:55], a[160:163], v[20:23], v[52:55]
v_mfma_f32_16x16x32_bf16 v[56:59], a[164:167], v[20:23], v[56:59]
v_mfma_f32_16x16x32_bf16 v[60:63], a[160:163], v[24:27], v[60:63]
v_mfma_f32_16x16x32_bf16 v[64:67], a[164:167], v[24:27], v[64:67]
v_mfma_f32_16x16x32_bf16 v[52:55], a[168:171], v[28:31], v[52:55]
v_mfma_f32_16x16x32_bf16 v[56:59], a[172:175], v[28:31], v[56:59]
v_mfma_f32_16x16x32_bf16 v[60:63], a[168:171], v[32:35], v[60:63]
v_mfma_f32_16x16x32_bf16 v[64:67], a[172:175], v[32:35], v[64:67]
v_mfma_f32_16x16x32_bf16 v[52:55], a[176:179], v[36:39], v[52:55]
v_mfma_f32_16x16x32_bf16 v[56:59], a[180:183], v[36:39], v[56:59]
v_mfma_f32_16x16x32_bf16 v[60:63], a[176:179], v[40:43], v[60:63]
v_mfma_f32_16x16x32_bf16 v[64:67], a[180:183], v[40:43], v[64:67]
v_mfma_f32_16x16x32_bf16 v[52:55], a[184:187], v[44:47], v[52:55]
v_mfma_f32_16x16x32_bf16 v[56:59], a[188:191], v[44:47], v[56:59]
v_mfma_f32_16x16x32_bf16 v[60:63], a[184:187], v[48:51], v[60:63]
v_mfma_f32_16x16x32_bf16 v[64:67], a[188:191], v[48:51], v[64:67]
s_waitcnt vmcnt(9)
ds_read_b64_tr_b16 a[192:193], v17 offset:0
ds_read_b64_tr_b16 a[194:195], v17 offset:256
ds_read_b64_tr_b16 a[196:197], v17 offset:8
ds_read_b64_tr_b16 a[198:199], v17 offset:264
ds_read_b64_tr_b16 a[200:201], v17 offset:2048
ds_read_b64_tr_b16 a[202:203], v17 offset:2304
ds_read_b64_tr_b16 a[204:205], v17 offset:2056
ds_read_b64_tr_b16 a[206:207], v17 offset:2312
s_waitcnt lgkmcnt(0)
ds_read_b64_tr_b16 a[208:209], v17 offset:4096
ds_read_b64_tr_b16 a[210:211], v17 offset:4352
ds_read_b64_tr_b16 a[212:213], v17 offset:4104
ds_read_b64_tr_b16 a[214:215], v17 offset:4360
ds_read_b64_tr_b16 a[216:217], v17 offset:6144
ds_read_b64_tr_b16 a[218:219], v17 offset:6400
ds_read_b64_tr_b16 a[220:221], v17 offset:6152
ds_read_b64_tr_b16 a[222:223], v17 offset:6408
s_waitcnt lgkmcnt(0)
ds_read_b128 v[20:23], v8 offset:49152
ds_read_b128 v[24:27], v8 offset:51200
ds_read_b128 v[28:31], v9 offset:49152
ds_read_b128 v[32:35], v9 offset:51200
ds_read_b128 v[36:39], v8 offset:53248
ds_read_b128 v[40:43], v8 offset:55296
ds_read_b128 v[44:47], v9 offset:53248
ds_read_b128 v[48:51], v9 offset:55296
s_waitcnt lgkmcnt(0)
v_mfma_f32_16x16x32_bf16 v[52:55], a[192:195], v[20:23], v[52:55]
v_mfma_f32_16x16x32_bf16 v[56:59], a[196:199], v[20:23], v[56:59]
v_mfma_f32_16x16x32_bf16 v[60:63], a[192:195], v[24:27], v[60:63]
v_mfma_f32_16x16x32_bf16 v[64:67], a[196:199], v[24:27], v[64:67]
v_mfma_f32_16x16x32_bf16 v[52:55], a[200:203], v[28:31], v[52:55]
v_mfma_f32_16x16x32_bf16 v[56:59], a[204:207], v[28:31], v[56:59]
v_mfma_f32_16x16x32_bf16 v[60:63], a[200:203], v[32:35], v[60:63]
v_mfma_f32_16x16x32_bf16 v[64:67], a[204:207], v[32:35], v[64:67]
v_mfma_f32_16x16x32_bf16 v[52:55], a[208:211], v[36:39], v[52:55]
v_mfma_f32_16x16x32_bf16 v[56:59], a[212:215], v[36:39], v[56:59]
v_mfma_f32_16x16x32_bf16 v[60:63], a[208:211], v[40:43], v[60:63]
v_mfma_f32_16x16x32_bf16 v[64:67], a[212:215], v[40:43], v[64:67]
v_mfma_f32_16x16x32_bf16 v[52:55], a[216:219], v[44:47], v[52:55]
v_mfma_f32_16x16x32_bf16 v[56:59], a[220:223], v[44:47], v[56:59]
v_mfma_f32_16x16x32_bf16 v[60:63], a[216:219], v[48:51], v[60:63]
v_mfma_f32_16x16x32_bf16 v[64:67], a[220:223], v[48:51], v[64:67]
s_waitcnt vmcnt(0)
ds_read_b64_tr_b16 a[224:225], v17 offset:8192
ds_read_b64_tr_b16 a[226:227], v17 offset:8448
ds_read_b64_tr_b16 a[228:229], v17 offset:8200
ds_read_b64_tr_b16 a[230:231], v17 offset:8456
ds_read_b64_tr_b16 a[232:233], v17 offset:10240
ds_read_b64_tr_b16 a[234:235], v17 offset:10496
ds_read_b64_tr_b16 a[236:237], v17 offset:10248
ds_read_b64_tr_b16 a[238:239], v17 offset:10504
s_waitcnt lgkmcnt(0)
ds_read_b64_tr_b16 a[240:241], v17 offset:12288
ds_read_b64_tr_b16 a[242:243], v17 offset:12544
ds_read_b64_tr_b16 a[244:245], v17 offset:12296
ds_read_b64_tr_b16 a[246:247], v17 offset:12552
ds_read_b64_tr_b16 a[248:249], v17 offset:14336
ds_read_b64_tr_b16 a[250:251], v17 offset:14592
ds_read_b64_tr_b16 a[252:253], v17 offset:14344
ds_read_b64_tr_b16 a[254:255], v17 offset:14600
s_waitcnt lgkmcnt(0)
ds_read_b128 v[20:23], v8 offset:57344
ds_read_b128 v[24:27], v8 offset:59392
ds_read_b128 v[28:31], v9 offset:57344
ds_read_b128 v[32:35], v9 offset:59392
ds_read_b128 v[36:39], v8 offset:61440
ds_read_b128 v[40:43], v8 offset:63488
ds_read_b128 v[44:47], v9 offset:61440
ds_read_b128 v[48:51], v9 offset:63488
s_waitcnt lgkmcnt(0)
v_mfma_f32_16x16x32_bf16 v[52:55], a[224:227], v[20:23], v[52:55]
v_mfma_f32_16x16x32_bf16 v[56:59], a[228:231], v[20:23], v[56:59]
v_mfma_f32_16x16x32_bf16 v[60:63], a[224:227], v[24:27], v[60:63]
v_mfma_f32_16x16x32_bf16 v[64:67], a[228:231], v[24:27], v[64:67]
v_mfma_f32_16x16x32_bf16 v[52:55], a[232:235], v[28:31], v[52:55]
v_mfma_f32_16x16x32_bf16 v[56:59], a[236:239], v[28:31], v[56:59]
v_mfma_f32_16x16x32_bf16 v[60:63], a[232:235], v[32:35], v[60:63]
v_mfma_f32_16x16x32_bf16 v[64:67], a[236:239], v[32:35], v[64:67]
v_mfma_f32_16x16x32_bf16 v[52:55], a[240:243], v[36:39], v[52:55]
v_mfma_f32_16x16x32_bf16 v[56:59], a[244:247], v[36:39], v[56:59]
v_mfma_f32_16x16x32_bf16 v[60:63], a[240:243], v[40:43], v[60:63]
v_mfma_f32_16x16x32_bf16 v[64:67], a[244:247], v[40:43], v[64:67]
v_mfma_f32_16x16x32_bf16 v[52:55], a[248:251], v[44:47], v[52:55]
v_mfma_f32_16x16x32_bf16 v[56:59], a[252:255], v[44:47], v[56:59]
v_mfma_f32_16x16x32_bf16 v[60:63], a[248:251], v[48:51], v[60:63]
v_mfma_f32_16x16x32_bf16 v[64:67], a[252:255], v[48:51], v[64:67]
s_barrier
s_mov_b32 s50, 0x10000
s_add_u32 m0, s46, 65536
s_nop 0
buffer_load_dwordx4 v6, s[8:11], s50 offen offset:0 lds
s_add_u32 m0, s46, 69504
s_nop 0
buffer_load_dwordx4 v6, s[8:11], s50 offen offset:128 lds
s_add_u32 m0, s46, 73472
s_nop 0
buffer_load_dwordx4 v6, s[8:11], s50 offen offset:256 lds
s_add_u32 m0, s46, 77440
s_nop 0
buffer_load_dwordx4 v6, s[8:11], s50 offen offset:384 lds
s_add_u32 m0, s46, 81408
s_nop 0
buffer_load_dwordx4 v6, s[8:11], s50 offen offset:512 lds
s_add_u32 m0, s46, 85376
s_nop 0
buffer_load_dwordx4 v6, s[8:11], s50 offen offset:640 lds
s_add_u32 m0, s46, 89344
s_nop 0
buffer_load_dwordx4 v6, s[8:11], s50 offen offset:768 lds
s_add_u32 m0, s46, 93312
s_nop 0
buffer_load_dwordx4 v6, s[8:11], s50 offen offset:896 lds
s_add_u32 m0, s46, 97280
s_nop 0
buffer_load_dwordx4 v6, s[8:11], s50 offen offset:1024 lds
s_add_u32 m0, s46, 101248
s_nop 0
buffer_load_dwordx4 v6, s[8:11], s50 offen offset:1152 lds
s_add_u32 m0, s46, 105216
s_nop 0
buffer_load_dwordx4 v6, s[8:11], s50 offen offset:1280 lds
s_add_u32 m0, s46, 109184
s_nop 0
buffer_load_dwordx4 v6, s[8:11], s50 offen offset:1408 lds
s_add_u32 m0, s46, 113152
s_nop 0
buffer_load_dwordx4 v6, s[8:11], s50 offen offset:1536 lds
s_add_u32 m0, s46, 117120
s_nop 0
buffer_load_dwordx4 v6, s[8:11], s50 offen offset:1664 lds
s_add_u32 m0, s46, 121088
s_nop 0
buffer_load_dwordx4 v6, s[8:11], s50 offen offset:1792 lds
s_add_u32 m0, s46, 125056
s_nop 0
buffer_load_dwordx4 v6, s[8:11], s50 offen offset:1920 lds
s_and_b32 s53, s47, 31
s_lshl_b32 s53, s53, 4
v_add_u32 v19, s53, v1
v_lshlrev_b32 v19, 7, v19
s_mov_b32 s42, 1
v_and_b32 v3, 15, v0
v_lshlrev_b32 v3, 4, v3
s_branch mega_kernel_syk
mega_kernel_sykw:
s_sleep 4
mega_kernel_syk:
buffer_load_dword v2, v3, s[72:75], 0 offen sc1
s_waitcnt vmcnt(0)
s_cmp_eq_u32 s95, 1
s_cbranch_scc0 mega_kernel_sykf
v_readlane_b32 s76, v2, 14
s_mov_b32 s98, 0
s_cmp_eq_u32 s76, 64
s_cbranch_scc0 mega_kernel_sykw
s_branch mega_kernel_sykd
mega_kernel_sykf:
s_mov_b32 s77, 0
s_mov_b32 s78, 0
v_readlane_b32 s76, v2, 0
s_add_u32 s77, s77, s76
s_xor_b32 s76, s76, 32
s_or_b32 s78, s78, s76
v_readlane_b32 s76, v2, 1
s_add_u32 s77, s77, s76
s_xor_b32 s76, s76, 32
s_or_b32 s78, s78, s76
v_readlane_b32 s76, v2, 2
s_add_u32 s77, s77, s76
s_xor_b32 s76, s76, 32
s_or_b32 s78, s78, s76
v_readlane_b32 s76, v2, 3
s_add_u32 s77, s77, s76
s_xor_b32 s76, s76, 32
s_or_b32 s78, s78, s76
v_readlane_b32 s76, v2, 4
s_add_u32 s77, s77, s76
s_xor_b32 s76, s76, 32
s_or_b32 s78, s78, s76
v_readlane_b32 s76, v2, 5
s_add_u32 s77, s77, s76
s_xor_b32 s76, s76, 32
s_or_b32 s78, s78, s76
v_readlane_b32 s76, v2, 6
s_add_u32 s77, s77, s76
s_xor_b32 s76, s76, 32
s_or_b32 s78, s78, s76
v_readlane_b32 s76, v2, 7
s_add_u32 s77, s77, s76
s_xor_b32 s76, s76, 32
s_or_b32 s78, s78, s76
s_cmp_eq_u32 s77, 256
s_cbranch_scc0 mega_kernel_sykw
v_mov_b32 v252, v2
s_cmp_eq_u32 s78, 0
s_cbranch_scc0 mega_kernel_slowent
v_readlane_b32 s76, v2, 10
v_readlane_b32 s77, v2, 8
s_cmp_eq_u32 s76, 64
s_cbranch_scc0 mega_kernel_sykw
s_cmp_gt_u32 s77, 32
s_cselect_b32 s98, 1, 0
mega_kernel_sykd:
s_lshr_b32 s44, s47, 3
s_xor_b32 s44, s44, s98
s_and_b32 s44, s44, 1
s_lshl_b32 s44, s44, 13
s_lshl_b32 s48, s47, 18
s_add_u32 s48, s48, s44
s_add_u32 s48, s48, 0
s_xor_b32 s44, s98, 1
s_lshl_b32 s44, s44, 13
s_lshl_b32 s49, s40, 7
s_add_u32 s49, s49, s44
s_lshl_b32 s44, s41, 2
s_add_u32 s49, s49, s44
s_add_u32 s49, s49, 69206016
v_mov_b32 v16, 0
v_cvt_pk_bf16_f32 v84, v52, v53
v_cvt_pk_bf16_f32 v85, v54, v55
v_cvt_pk_bf16_f32 v86, v56, v57
v_cvt_pk_bf16_f32 v87, v58, v59
v_cvt_pk_bf16_f32 v88, v60, v61
v_cvt_pk_bf16_f32 v89, v62, v63
v_cvt_pk_bf16_f32 v90, v64, v65
v_cvt_pk_bf16_f32 v91, v66, v67
s_add_u32 s51, s42, s47
s_sub_u32 s51, s51, 1
s_bfe_u32 s52, s51, 0x40002
s_lshl_b32 s52, s52, 14
s_and_b32 s51, s51, 3
s_lshl_b32 s51, s51, 11
s_add_u32 s51, s51, s52
s_add_u32 s51, s51, s48
buffer_store_dwordx4 v[84:87], v7, s[84:87], s51 offen sc1
buffer_store_dwordx4 v[88:91], v7, s[84:87], s51 offen offset:1024 sc1
s_waitcnt vmcnt(0)
v_mov_b32 v17, s42
s_mov_b64 exec, 1
buffer_store_dword v17, v16, s[84:87], s49 offen sc1
s_mov_b64 exec, -1
mega_kernel_k_loop:
s_waitcnt vmcnt(2)
s_barrier
s_add_u32 s50, s42, 1
s_min_u32 s50, s50, 63
s_lshl_b32 s50, s50, 16
ds_read_b128 v[20:23], v10 offset:0
ds_read_b128 v[24:27], v10 offset:2048
ds_read_b128 v[28:31], v11 offset:0
ds_read_b128 v[32:35], v11 offset:2048
ds_read_b128 v[36:39], v10 offset:4096
ds_read_b128 v[40:43], v10 offset:6144
s_waitcnt lgkmcnt(4)
v_mfma_f32_16x16x32_bf16 v[68:71], a[0:3], v[20:23], 0
ds_read_b128 v[44:47], v11 offset:4096
v_mfma_f32_16x16x32_bf16 v[72:75], a[4:7], v[20:23], 0
v_cvt_pk_bf16_f32 v84, v52, v53
v_cvt_pk_bf16_f32 v85, v54, v55
v_cvt_pk_bf16_f32 v86, v56, v57
v_mfma_f32_16x16x32_bf16 v[76:79], a[0:3], v[24:27], 0
ds_read_b128 v[48:51], v11 offset:6144
v_mfma_f32_16x16x32_bf16 v[80:83], a[4:7], v[24:27], 0
v_cvt_pk_bf16_f32 v87, v58, v59
v_cvt_pk_bf16_f32 v88, v60, v61
v_cvt_pk_bf16_f32 v89, v62, v63
s_waitcnt lgkmcnt(4)
v_mfma_f32_16x16x32_bf16 v[68:71], a[8:11], v[28:31], v[68:71]
ds_read_b128 v[20:23], v10 offset:8192
v_mfma_f32_16x16x32_bf16 v[72:75], a[12:15], v[28:31], v[72:75]
v_cvt_pk_bf16_f32 v90, v64, v65
v_cvt_pk_bf16_f32 v91, v66, v67
v_mfma_f32_16x16x32_bf16 v[76:79], a[8:11], v[32:35], v[76:79]
ds_read_b128 v[24:27], v10 offset:10240
v_mfma_f32_16x16x32_bf16 v[80:83], a[12:15], v[32:35], v[80:83]
s_add_u32 s51, s42, s47
s_sub_u32 s51, s51, 1
s_bfe_u32 s52, s51, 0x40002
s_lshl_b32 s52, s52, 14
s_waitcnt lgkmcnt(4)
v_mfma_f32_16x16x32_bf16 v[68:71], a[16:19], v[36:39], v[68:71]
ds_read_b128 v[28:31], v11 offset:8192
v_mfma_f32_16x16x32_bf16 v[72:75], a[20:23], v[36:39], v[72:75]
s_and_b32 s51, s51, 3
s_lshl_b32 s51, s51, 11
s_add_u32 s51, s51, s52
s_add_u32 s51, s51, s48
buffer_store_dwordx4 v[84:87], v7, s[84:87], s51 offen sc1
v_mfma_f32_16x16x32_bf16 v[76:79], a[16:19], v[40:43], v[76:79]
ds_read_b128 v[32:35], v11 offset:10240
v_mfma_f32_16x16x32_bf16 v[80:83], a[20:23], v[40:43], v[80:83]
buffer_store_dwordx4 v[88:91], v7, s[84:87], s51 offen offset:1024 sc1
s_waitcnt lgkmcnt(4)
v_mfma_f32_16x16x32_bf16 v[68:71], a[24:27], v[44:47], v[68:71]
ds_read_b128 v[36:39], v10 offset:12288
v_mfma_f32_16x16x32_bf16 v[72:75], a[28:31], v[44:47], v[72:75]
s_add_u32 m0, s46, 0
v_mfma_f32_16x16x32_bf16 v[76:79], a[24:27], v[48:51], v[76:79]
ds_read_b128 v[40:43], v10 offset:14336
v_mfma_f32_16x16x32_bf16 v[80:83], a[28:31], v[48:51], v[80:83]
buffer_load_dwordx4 v6, s[8:11], s50 offen offset:0 lds
s_waitcnt lgkmcnt(4)
v_mfma_f32_16x16x32_bf16 v[68:71], a[32:35], v[20:23], v[68:71]
ds_read_b128 v[44:47], v11 offset:12288
v_mfma_f32_16x16x32_bf16 v[72:75], a[36:39], v[20:23], v[72:75]
s_add_u32 m0, s46, 3968
v_mfma_f32_16x16x32_bf16 v[76:79], a[32:35], v[24:27], v[76:79]
ds_read_b128 v[48:51], v11 offset:14336
v_mfma_f32_16x16x32_bf16 v[80:83], a[36:39], v[24:27], v[80:83]
buffer_load_dwordx4 v6, s[8:11], s50 offen offset:128 lds
s_waitcnt lgkmcnt(4)
v_mfma_f32_16x16x32_bf16 v[68:71], a[40:43], v[28:31], v[68:71]
ds_read_b128 v[20:23], v10 offset:16384
v_mfma_f32_16x16x32_bf16 v[72:75], a[44:47], v[28:31], v[72:75]
s_add_u32 m0, s46, 7936
v_mfma_f32_16x16x32_bf16 v[76:79], a[40:43], v[32:35], v[76:79]
ds_read_b128 v[24:27], v10 offset:18432
v_mfma_f32_16x16x32_bf16 v[80:83], a[44:47], v[32:35], v[80:83]
buffer_load_dwordx4 v6, s[8:11], s50 offen offset:256 lds
s_waitcnt lgkmcnt(4)
v_mfma_f32_16x16x32_bf16 v[68:71], a[48:51], v[36:39], v[68:71]
ds_read_b128 v[28:31], v11 offset:16384
v_mfma_f32_16x16x32_bf16 v[72:75], a[52:55], v[36:39], v[72:75]
s_add_u32 m0, s46, 11904
v_mfma_f32_16x16x32_bf16 v[76:79], a[48:51], v[40:43], v[76:79]
ds_read_b128 v[32:35], v11 offset:18432
v_mfma_f32_16x16x32_bf16 v[80:83], a[52:55], v[40:43], v[80:83]
buffer_load_dwordx4 v6, s[8:11], s50 offen offset:384 lds
s_waitcnt lgkmcnt(4)
v_mfma_f32_16x16x32_bf16 v[68:71], a[56:59], v[44:47], v[68:71]
ds_read_b128 v[36:39], v10 offset:20480
v_mfma_f32_16x16x32_bf16 v[72:75], a[60:63], v[44:47], v[72:75]
s_add_u32 m0, s46, 15872
v_mfma_f32_16x16x32_bf16 v[76:79], a[56:59], v[48:51], v[76:79]
ds_read_b128 v[40:43], v10 offset:22528
v_mfma_f32_16x16x32_bf16 v[80:83], a[60:63], v[48:51], v[80:83]
buffer_load_dwordx4 v6, s[8:11], s50 offen offset:512 lds
s_waitcnt lgkmcnt(4)
v_mfma_f32_16x16x32_bf16 v[68:71], a[64:67], v[20:23], v[68:71]
ds_read_b128 v[44:47], v11 offset:20480
v_mfma_f32_16x16x32_bf16 v[72:75], a[68:71], v[20:23], v[72:75]
s_add_u32 m0, s46, 19840
v_mfma_f32_16x16x32_bf16 v[76:79], a[64:67], v[24:27], v[76:79]
ds_read_b128 v[48:51], v11 offset:22528
v_mfma_f32_16x16x32_bf16 v[80:83], a[68:71], v[24:27], v[80:83]
buffer_load_dwordx4 v6, s[8:11], s50 offen offset:640 lds
s_waitcnt lgkmcnt(4)
v_mfma_f32_16x16x32_bf16 v[68:71], a[72:75], v[28:31], v[68:71]
ds_read_b128 v[20:23], v10 offset:24576
v_mfma_f32_16x16x32_bf16 v[72:75], a[76:79], v[28:31], v[72:75]
s_add_u32 m0, s46, 23808
v_mfma_f32_16x16x32_bf16 v[76:79], a[72:75], v[32:35], v[76:79]
ds_read_b128 v[24:27], v10 offset:26624
v_mfma_f32_16x16x32_bf16 v[80:83], a[76:79], v[32:35], v[80:83]
buffer_load_dwordx4 v6, s[8:11], s50 offen offset:768 lds
s_waitcnt lgkmcnt(4)
v_mfma_f32_16x16x32_bf16 v[68:71], a[80:83], v[36:39], v[68:71]
ds_read_b128 v[28:31], v11 offset:24576
v_mfma_f32_16x16x32_bf16 v[72:75], a[84:87], v[36:39], v[72:75]
s_add_u32 m0, s46, 27776
v_mfma_f32_16x16x32_bf16 v[76:79], a[80:83], v[40:43], v[76:79]
ds_read_b128 v[32:35], v11 offset:26624
v_mfma_f32_16x16x32_bf16 v[80:83], a[84:87], v[40:43], v[80:83]
buffer_load_dwordx4 v6, s[8:11], s50 offen offset:896 lds
s_waitcnt lgkmcnt(4)
v_mfma_f32_16x16x32_bf16 v[68:71], a[88:91], v[44:47], v[68:71]
ds_read_b128 v[36:39], v10 offset:28672
v_mfma_f32_16x16x32_bf16 v[72:75], a[92:95], v[44:47], v[72:75]
s_add_u32 m0, s46, 31744
v_mfma_f32_16x16x32_bf16 v[76:79], a[88:91], v[48:51], v[76:79]
ds_read_b128 v[40:43], v10 offset:30720
v_mfma_f32_16x16x32_bf16 v[80:83], a[92:95], v[48:51], v[80:83]
buffer_load_dwordx4 v6, s[8:11], s50 offen offset:1024 lds
s_waitcnt lgkmcnt(4)
v_mfma_f32_16x16x32_bf16 v[68:71], a[96:99], v[20:23], v[68:71]
ds_read_b128 v[44:47], v11 offset:28672
v_mfma_f32_16x16x32_bf16 v[72:75], a[100:103], v[20:23], v[72:75]
s_add_u32 m0, s46, 35712
v_mfma_f32_16x16x32_bf16 v[76:79], a[96:99], v[24:27], v[76:79]
ds_read_b128 v[48:51], v11 offset:30720
v_mfma_f32_16x16x32_bf16 v[80:83], a[100:103], v[24:27], v[80:83]
buffer_load_dwordx4 v6, s[8:11], s50 offen offset:1152 lds
s_waitcnt lgkmcnt(4)
v_mfma_f32_16x16x32_bf16 v[68:71], a[104:107], v[28:31], v[68:71]
ds_read_b128 v[20:23], v10 offset:32768
v_mfma_f32_16x16x32_bf16 v[72:75], a[108:111], v[28:31], v[72:75]
s_add_u32 m0, s46, 39680
v_mfma_f32_16x16x32_bf16 v[76:79], a[104:107], v[32:35], v[76:79]
ds_read_b128 v[24:27], v10 offset:34816
v_mfma_f32_16x16x32_bf16 v[80:83], a[108:111], v[32:35], v[80:83]
buffer_load_dwordx4 v6, s[8:11], s50 offen offset:1280 lds
s_waitcnt lgkmcnt(4)
v_mfma_f32_16x16x32_bf16 v[68:71], a[112:115], v[36:39], v[68:71]
ds_read_b128 v[28:31], v11 offset:32768
v_mfma_f32_16x16x32_bf16 v[72:75], a[116:119], v[36:39], v[72:75]
s_add_u32 m0, s46, 43648
v_mfma_f32_16x16x32_bf16 v[76:79], a[112:115], v[40:43], v[76:79]
ds_read_b128 v[32:35], v11 offset:34816
v_mfma_f32_16x16x32_bf16 v[80:83], a[116:119], v[40:43], v[80:83]
buffer_load_dwordx4 v6, s[8:11], s50 offen offset:1408 lds
s_waitcnt lgkmcnt(4)
v_mfma_f32_16x16x32_bf16 v[68:71], a[120:123], v[44:47], v[68:71]
ds_read_b128 v[36:39], v10 offset:36864
v_mfma_f32_16x16x32_bf16 v[72:75], a[124:127], v[44:47], v[72:75]
s_add_u32 m0, s46, 47616
v_mfma_f32_16x16x32_bf16 v[76:79], a[120:123], v[48:51], v[76:79]
ds_read_b128 v[40:43], v10 offset:38912
v_mfma_f32_16x16x32_bf16 v[80:83], a[124:127], v[48:51], v[80:83]
buffer_load_dwordx4 v6, s[8:11], s50 offen offset:1536 lds
s_waitcnt lgkmcnt(4)
v_mfma_f32_16x16x32_bf16 v[68:71], a[128:131], v[20:23], v[68:71]
ds_read_b128 v[44:47], v11 offset:36864
v_mfma_f32_16x16x32_bf16 v[72:75], a[132:135], v[20:23], v[72:75]
s_add_u32 m0, s46, 51584
v_mfma_f32_16x16x32_bf16 v[76:79], a[128:131], v[24:27], v[76:79]
ds_read_b128 v[48:51], v11 offset:38912
v_mfma_f32_16x16x32_bf16 v[80:83], a[132:135], v[24:27], v[80:83]
buffer_load_dwordx4 v6, s[8:11], s50 offen offset:1664 lds
s_waitcnt lgkmcnt(4)
v_mfma_f32_16x16x32_bf16 v[68:71], a[136:139], v[28:31], v[68:71]
ds_read_b128 v[20:23], v10 offset:40960
v_mfma_f32_16x16x32_bf16 v[72:75], a[140:143], v[28:31], v[72:75]
s_add_u32 m0, s46, 55552
v_mfma_f32_16x16x32_bf16 v[76:79], a[136:139], v[32:35], v[76:79]
ds_read_b128 v[24:27], v10 offset:43008
v_mfma_f32_16x16x32_bf16 v[80:83], a[140:143], v[32:35], v[80:83]
buffer_load_dwordx4 v6, s[8:11], s50 offen offset:1792 lds
s_waitcnt lgkmcnt(4)
v_mfma_f32_16x16x32_bf16 v[68:71], a[144:147], v[36:39], v[68:71]
ds_read_b128 v[28:31], v11 offset:40960
v_mfma_f32_16x16x32_bf16 v[72:75], a[148:151], v[36:39], v[72:75]
s_add_u32 m0, s46, 59520
v_mfma_f32_16x16x32_bf16 v[76:79], a[144:147], v[40:43], v[76:79]
ds_read_b128 v[32:35], v11 offset:43008
v_mfma_f32_16x16x32_bf16 v[80:83], a[148:151], v[40:43], v[80:83]
buffer_load_dwordx4 v6, s[8:11], s50 offen offset:1920 lds
s_waitcnt lgkmcnt(4)
v_mfma_f32_16x16x32_bf16 v[68:71], a[152:155], v[44:47], v[68:71]
ds_read_b128 v[36:39], v10 offset:45056
v_mfma_f32_16x16x32_bf16 v[72:75], a[156:159], v[44:47], v[72:75]
v_mfma_f32_16x16x32_bf16 v[76:79], a[152:155], v[48:51], v[76:79]
ds_read_b128 v[40:43], v10 offset:47104
v_mfma_f32_16x16x32_bf16 v[80:83], a[156:159], v[48:51], v[80:83]
s_waitcnt lgkmcnt(4)
v_mfma_f32_16x16x32_bf16 v[68:71], a[160:163], v[20:23], v[68:71]
ds_read_b128 v[44:47], v11 offset:45056
v_mfma_f32_16x16x32_bf16 v[72:75], a[164:167], v[20:23], v[72:75]
v_mfma_f32_16x16x32_bf16 v[76:79], a[160:163], v[24:27], v[76:79]
ds_read_b128 v[48:51], v11 offset:47104
v_mfma_f32_16x16x32_bf16 v[80:83], a[164:167], v[24:27], v[80:83]
s_waitcnt lgkmcnt(4)
v_mfma_f32_16x16x32_bf16 v[68:71], a[168:171], v[28:31], v[68:71]
ds_read_b128 v[20:23], v10 offset:49152
v_mfma_f32_16x16x32_bf16 v[72:75], a[172:175], v[28:31], v[72:75]
s_waitcnt vmcnt(16)
v_mov_b32 v17, s42
s_mov_b64 exec, 1
buffer_store_dword v17, v16, s[84:87], s49 offen sc1
s_mov_b64 exec, -1
v_mfma_f32_16x16x32_bf16 v[76:79], a[168:171], v[32:35], v[76:79]
ds_read_b128 v[24:27], v10 offset:51200
v_mfma_f32_16x16x32_bf16 v[80:83], a[172:175], v[32:35], v[80:83]
s_waitcnt lgkmcnt(4)
v_mfma_f32_16x16x32_bf16 v[68:71], a[176:179], v[36:39], v[68:71]
ds_read_b128 v[28:31], v11 offset:49152
v_mfma_f32_16x16x32_bf16 v[72:75], a[180:183], v[36:39], v[72:75]
s_add_u32 s53, s42, 3
s_min_u32 s53, s53, 63
s_lshl_b32 s53, s53, 16
s_mov_b64 exec, 0xffff
buffer_load_dword v250, v19, s[8:11], s53 offen
s_mov_b64 exec, -1
v_mfma_f32_16x16x32_bf16 v[76:79], a[176:179], v[40:43], v[76:79]
ds_read_b128 v[32:35], v11 offset:51200
v_mfma_f32_16x16x32_bf16 v[80:83], a[180:183], v[40:43], v[80:83]
s_waitcnt lgkmcnt(4)
v_mfma_f32_16x16x32_bf16 v[68:71], a[184:187], v[44:47], v[68:71]
ds_read_b128 v[36:39], v10 offset:53248
v_mfma_f32_16x16x32_bf16 v[72:75], a[188:191], v[44:47], v[72:75]
v_mfma_f32_16x16x32_bf16 v[76:79], a[184:187], v[48:51], v[76:79]
ds_read_b128 v[40:43], v10 offset:55296
v_mfma_f32_16x16x32_bf16 v[80:83], a[188:191], v[48:51], v[80:83]
s_waitcnt lgkmcnt(4)
v_mfma_f32_16x16x32_bf16 v[68:71], a[192:195], v[20:23], v[68:71]
ds_read_b128 v[44:47], v11 offset:53248
v_mfma_f32_16x16x32_bf16 v[72:75], a[196:199], v[20:23], v[72:75]
v_mfma_f32_16x16x32_bf16 v[76:79], a[192:195], v[24:27], v[76:79]
ds_read_b128 v[48:51], v11 offset:55296
v_mfma_f32_16x16x32_bf16 v[80:83], a[196:199], v[24:27], v[80:83]
s_waitcnt lgkmcnt(4)
v_mfma_f32_16x16x32_bf16 v[68:71], a[200:203], v[28:31], v[68:71]
ds_read_b128 v[20:23], v10 offset:57344
v_mfma_f32_16x16x32_bf16 v[72:75], a[204:207], v[28:31], v[72:75]
v_mfma_f32_16x16x32_bf16 v[76:79], a[200:203], v[32:35], v[76:79]
ds_read_b128 v[24:27], v10 offset:59392
v_mfma_f32_16x16x32_bf16 v[80:83], a[204:207], v[32:35], v[80:83]
s_waitcnt lgkmcnt(4)
v_mfma_f32_16x16x32_bf16 v[68:71], a[208:211], v[36:39], v[68:71]
ds_read_b128 v[28:31], v11 offset:57344
v_mfma_f32_16x16x32_bf16 v[72:75], a[212:215], v[36:39], v[72:75]
v_mfma_f32_16x16x32_bf16 v[76:79], a[208:211], v[40:43], v[76:79]
ds_read_b128 v[32:35], v11 offset:59392
v_mfma_f32_16x16x32_bf16 v[80:83], a[212:215], v[40:43], v[80:83]
s_waitcnt lgkmcnt(4)
v_mfma_f32_16x16x32_bf16 v[68:71], a[216:219], v[44:47], v[68:71]
ds_read_b128 v[36:39], v10 offset:61440
v_mfma_f32_16x16x32_bf16 v[72:75], a[220:223], v[44:47], v[72:75]
v_mfma_f32_16x16x32_bf16 v[76:79], a[216:219], v[48:51], v[76:79]
ds_read_b128 v[40:43], v10 offset:63488
v_mfma_f32_16x16x32_bf16 v[80:83], a[220:223], v[48:51], v[80:83]
s_waitcnt lgkmcnt(4)
v_mfma_f32_16x16x32_bf16 v[68:71], a[224:227], v[20:23], v[68:71]
ds_read_b128 v[44:47], v11 offset:61440
v_mfma_f32_16x16x32_bf16 v[72:75], a[228:231], v[20:23], v[72:75]
v_mfma_f32_16x16x32_bf16 v[76:79], a[224:227], v[24:27], v[76:79]
ds_read_b128 v[48:51], v11 offset:63488
v_mfma_f32_16x16x32_bf16 v[80:83], a[228:231], v[24:27], v[80:83]
s_waitcnt lgkmcnt(5)
v_mfma_f32_16x16x32_bf16 v[68:71], a[232:235], v[28:31], v[68:71]
v_mfma_f32_16x16x32_bf16 v[72:75], a[236:239], v[28:31], v[72:75]
s_waitcnt lgkmcnt(4)
v_mfma_f32_16x16x32_bf16 v[76:79], a[232:235], v[32:35], v[76:79]
v_mfma_f32_16x16x32_bf16 v[80:83], a[236:239], v[32:35], v[80:83]
s_waitcnt lgkmcnt(3)
v_mfma_f32_16x16x32_bf16 v[68:71], a[240:243], v[36:39], v[68:71]
v_mfma_f32_16x16x32_bf16 v[72:75], a[244:247], v[36:39], v[72:75]
s_waitcnt lgkmcnt(2)
v_mfma_f32_16x16x32_bf16 v[76:79], a[240:243], v[40:43], v[76:79]
v_mfma_f32_16x16x32_bf16 v[80:83], a[244:247], v[40:43], v[80:83]
s_waitcnt lgkmcnt(1)
v_mfma_f32_16x16x32_bf16 v[68:71], a[248:251], v[44:47], v[68:71]
v_mfma_f32_16x16x32_bf16 v[72:75], a[252:255], v[44:47], v[72:75]
s_waitcnt lgkmcnt(0)
v_mfma_f32_16x16x32_bf16 v[76:79], a[248:251], v[48:51], v[76:79]
v_mfma_f32_16x16x32_bf16 v[80:83], a[252:255], v[48:51], v[80:83]
s_add_u32 s42, s42, 1
s_cmp_eq_u32 s42, 64
s_cbranch_scc1 mega_kernel_k_fin
s_waitcnt vmcnt(2)
s_barrier
s_add_u32 s50, s42, 1
s_min_u32 s50, s50, 63
s_lshl_b32 s50, s50, 16
ds_read_b128 v[20:23], v8 offset:0
ds_read_b128 v[24:27], v8 offset:2048
ds_read_b128 v[28:31], v9 offset:0
ds_read_b128 v[32:35], v9 offset:2048
ds_read_b128 v[36:39], v8 offset:4096
ds_read_b128 v[40:43], v8 offset:6144
s_waitcnt lgkmcnt(4)
v_mfma_f32_16x16x32_bf16 v[52:55], a[0:3], v[20:23], 0
ds_read_b128 v[44:47], v9 offset:4096
v_mfma_f32_16x16x32_bf16 v[56:59], a[4:7], v[20:23], 0
v_cvt_pk_bf16_f32 v84, v68, v69
v_cvt_pk_bf16_f32 v85, v70, v71
v_cvt_pk_bf16_f32 v86, v72, v73
v_mfma_f32_16x16x32_bf16 v[60:63], a[0:3], v[24:27], 0
ds_read_b128 v[48:51], v9 offset:6144
v_mfma_f32_16x16x32_bf16 v[64:67], a[4:7], v[24:27], 0
v_cvt_pk_bf16_f32 v87, v74, v75
v_cvt_pk_bf16_f32 v88, v76, v77
v_cvt_pk_bf16_f32 v89, v78, v79
s_waitcnt lgkmcnt(4)
v_mfma_f32_16x16x32_bf16 v[52:55], a[8:11], v[28:31], v[52:55]
ds_read_b128 v[20:23], v8 offset:8192
v_mfma_f32_16x16x32_bf16 v[56:59], a[12:15], v[28:31], v[56:59]
v_cvt_pk_bf16_f32 v90, v80, v81
v_cvt_pk_bf16_f32 v91, v82, v83
v_mfma_f32_16x16x32_bf16 v[60:63], a[8:11], v[32:35], v[60:63]
ds_read_b128 v[24:27], v8 offset:10240
v_mfma_f32_16x16x32_bf16 v[64:67], a[12:15], v[32:35], v[64:67]
s_add_u32 s51, s42, s47
s_sub_u32 s51, s51, 1
s_bfe_u32 s52, s51, 0x40002
s_lshl_b32 s52, s52, 14
s_waitcnt lgkmcnt(4)
v_mfma_f32_16x16x32_bf16 v[52:55], a[16:19], v[36:39], v[52:55]
ds_read_b128 v[28:31], v9 offset:8192
v_mfma_f32_16x16x32_bf16 v[56:59], a[20:23], v[36:39], v[56:59]
s_and_b32 s51, s51, 3
s_lshl_b32 s51, s51, 11
s_add_u32 s51, s51, s52
s_add_u32 s51, s51, s48
buffer_store_dwordx4 v[84:87], v7, s[84:87], s51 offen sc1
v_mfma_f32_16x16x32_bf16 v[60:63], a[16:19], v[40:43], v[60:63]
ds_read_b128 v[32:35], v9 offset:10240
v_mfma_f32_16x16x32_bf16 v[64:67], a[20:23], v[40:43], v[64:67]
buffer_store_dwordx4 v[88:91], v7, s[84:87], s51 offen offset:1024 sc1
s_waitcnt lgkmcnt(4)
v_mfma_f32_16x16x32_bf16 v[52:55], a[24:27], v[44:47], v[52:55]
ds_read_b128 v[36:39], v8 offset:12288
v_mfma_f32_16x16x32_bf16 v[56:59], a[28:31], v[44:47], v[56:59]
s_add_u32 m0, s46, 65536
v_mfma_f32_16x16x32_bf16 v[60:63], a[24:27], v[48:51], v[60:63]
ds_read_b128 v[40:43], v8 offset:14336
v_mfma_f32_16x16x32_bf16 v[64:67], a[28:31], v[48:51], v[64:67]
buffer_load_dwordx4 v6, s[8:11], s50 offen offset:0 lds
s_waitcnt lgkmcnt(4)
v_mfma_f32_16x16x32_bf16 v[52:55], a[32:35], v[20:23], v[52:55]
ds_read_b128 v[44:47], v9 offset:12288
v_mfma_f32_16x16x32_bf16 v[56:59], a[36:39], v[20:23], v[56:59]
s_add_u32 m0, s46, 69504
v_mfma_f32_16x16x32_bf16 v[60:63], a[32:35], v[24:27], v[60:63]
ds_read_b128 v[48:51], v9 offset:14336
v_mfma_f32_16x16x32_bf16 v[64:67], a[36:39], v[24:27], v[64:67]
buffer_load_dwordx4 v6, s[8:11], s50 offen offset:128 lds
s_waitcnt lgkmcnt(4)
v_mfma_f32_16x16x32_bf16 v[52:55], a[40:43], v[28:31], v[52:55]
ds_read_b128 v[20:23], v8 offset:16384
v_mfma_f32_16x16x32_bf16 v[56:59], a[44:47], v[28:31], v[56:59]
s_add_u32 m0, s46, 73472
v_mfma_f32_16x16x32_bf16 v[60:63], a[40:43], v[32:35], v[60:63]
ds_read_b128 v[24:27], v8 offset:18432
v_mfma_f32_16x16x32_bf16 v[64:67], a[44:47], v[32:35], v[64:67]
buffer_load_dwordx4 v6, s[8:11], s50 offen offset:256 lds
s_waitcnt lgkmcnt(4)
v_mfma_f32_16x16x32_bf16 v[52:55], a[48:51], v[36:39], v[52:55]
ds_read_b128 v[28:31], v9 offset:16384
v_mfma_f32_16x16x32_bf16 v[56:59], a[52:55], v[36:39], v[56:59]
s_add_u32 m0, s46, 77440
v_mfma_f32_16x16x32_bf16 v[60:63], a[48:51], v[40:43], v[60:63]
ds_read_b128 v[32:35], v9 offset:18432
v_mfma_f32_16x16x32_bf16 v[64:67], a[52:55], v[40:43], v[64:67]
buffer_load_dwordx4 v6, s[8:11], s50 offen offset:384 lds
s_waitcnt lgkmcnt(4)
v_mfma_f32_16x16x32_bf16 v[52:55], a[56:59], v[44:47], v[52:55]
ds_read_b128 v[36:39], v8 offset:20480
v_mfma_f32_16x16x32_bf16 v[56:59], a[60:63], v[44:47], v[56:59]
s_add_u32 m0, s46, 81408
v_mfma_f32_16x16x32_bf16 v[60:63], a[56:59], v[48:51], v[60:63]
ds_read_b128 v[40:43], v8 offset:22528
v_mfma_f32_16x16x32_bf16 v[64:67], a[60:63], v[48:51], v[64:67]
buffer_load_dwordx4 v6, s[8:11], s50 offen offset:512 lds
s_waitcnt lgkmcnt(4)
v_mfma_f32_16x16x32_bf16 v[52:55], a[64:67], v[20:23], v[52:55]
ds_read_b128 v[44:47], v9 offset:20480
v_mfma_f32_16x16x32_bf16 v[56:59], a[68:71], v[20:23], v[56:59]
s_add_u32 m0, s46, 85376
v_mfma_f32_16x16x32_bf16 v[60:63], a[64:67], v[24:27], v[60:63]
ds_read_b128 v[48:51], v9 offset:22528
v_mfma_f32_16x16x32_bf16 v[64:67], a[68:71], v[24:27], v[64:67]
buffer_load_dwordx4 v6, s[8:11], s50 offen offset:640 lds
s_waitcnt lgkmcnt(4)
v_mfma_f32_16x16x32_bf16 v[52:55], a[72:75], v[28:31], v[52:55]
ds_read_b128 v[20:23], v8 offset:24576
v_mfma_f32_16x16x32_bf16 v[56:59], a[76:79], v[28:31], v[56:59]
s_add_u32 m0, s46, 89344
v_mfma_f32_16x16x32_bf16 v[60:63], a[72:75], v[32:35], v[60:63]
ds_read_b128 v[24:27], v8 offset:26624
v_mfma_f32_16x16x32_bf16 v[64:67], a[76:79], v[32:35], v[64:67]
buffer_load_dwordx4 v6, s[8:11], s50 offen offset:768 lds
s_waitcnt lgkmcnt(4)
v_mfma_f32_16x16x32_bf16 v[52:55], a[80:83], v[36:39], v[52:55]
ds_read_b128 v[28:31], v9 offset:24576
v_mfma_f32_16x16x32_bf16 v[56:59], a[84:87], v[36:39], v[56:59]
s_add_u32 m0, s46, 93312
v_mfma_f32_16x16x32_bf16 v[60:63], a[80:83], v[40:43], v[60:63]
ds_read_b128 v[32:35], v9 offset:26624
v_mfma_f32_16x16x32_bf16 v[64:67], a[84:87], v[40:43], v[64:67]
buffer_load_dwordx4 v6, s[8:11], s50 offen offset:896 lds
s_waitcnt lgkmcnt(4)
v_mfma_f32_16x16x32_bf16 v[52:55], a[88:91], v[44:47], v[52:55]
ds_read_b128 v[36:39], v8 offset:28672
v_mfma_f32_16x16x32_bf16 v[56:59], a[92:95], v[44:47], v[56:59]
s_add_u32 m0, s46, 97280
v_mfma_f32_16x16x32_bf16 v[60:63], a[88:91], v[48:51], v[60:63]
ds_read_b128 v[40:43], v8 offset:30720
v_mfma_f32_16x16x32_bf16 v[64:67], a[92:95], v[48:51], v[64:67]
buffer_load_dwordx4 v6, s[8:11], s50 offen offset:1024 lds
s_waitcnt lgkmcnt(4)
v_mfma_f32_16x16x32_bf16 v[52:55], a[96:99], v[20:23], v[52:55]
ds_read_b128 v[44:47], v9 offset:28672
v_mfma_f32_16x16x32_bf16 v[56:59], a[100:103], v[20:23], v[56:59]
s_add_u32 m0, s46, 101248
v_mfma_f32_16x16x32_bf16 v[60:63], a[96:99], v[24:27], v[60:63]
ds_read_b128 v[48:51], v9 offset:30720
v_mfma_f32_16x16x32_bf16 v[64:67], a[100:103], v[24:27], v[64:67]
buffer_load_dwordx4 v6, s[8:11], s50 offen offset:1152 lds
s_waitcnt lgkmcnt(4)
v_mfma_f32_16x16x32_bf16 v[52:55], a[104:107], v[28:31], v[52:55]
ds_read_b128 v[20:23], v8 offset:32768
v_mfma_f32_16x16x32_bf16 v[56:59], a[108:111], v[28:31], v[56:59]
s_add_u32 m0, s46, 105216
v_mfma_f32_16x16x32_bf16 v[60:63], a[104:107], v[32:35], v[60:63]
ds_read_b128 v[24:27], v8 offset:34816
v_mfma_f32_16x16x32_bf16 v[64:67], a[108:111], v[32:35], v[64:67]
buffer_load_dwordx4 v6, s[8:11], s50 offen offset:1280 lds
s_waitcnt lgkmcnt(4)
v_mfma_f32_16x16x32_bf16 v[52:55], a[112:115], v[36:39], v[52:55]
ds_read_b128 v[28:31], v9 offset:32768
v_mfma_f32_16x16x32_bf16 v[56:59], a[116:119], v[36:39], v[56:59]
s_add_u32 m0, s46, 109184
v_mfma_f32_16x16x32_bf16 v[60:63], a[112:115], v[40:43], v[60:63]
ds_read_b128 v[32:35], v9 offset:34816
v_mfma_f32_16x16x32_bf16 v[64:67], a[116:119], v[40:43], v[64:67]
buffer_load_dwordx4 v6, s[8:11], s50 offen offset:1408 lds
s_waitcnt lgkmcnt(4)
v_mfma_f32_16x16x32_bf16 v[52:55], a[120:123], v[44:47], v[52:55]
ds_read_b128 v[36:39], v8 offset:36864
v_mfma_f32_16x16x32_bf16 v[56:59], a[124:127], v[44:47], v[56:59]
s_add_u32 m0, s46, 113152
v_mfma_f32_16x16x32_bf16 v[60:63], a[120:123], v[48:51], v[60:63]
ds_read_b128 v[40:43], v8 offset:38912
v_mfma_f32_16x16x32_bf16 v[64:67], a[124:127], v[48:51], v[64:67]
buffer_load_dwordx4 v6, s[8:11], s50 offen offset:1536 lds
s_waitcnt lgkmcnt(4)
v_mfma_f32_16x16x32_bf16 v[52:55], a[128:131], v[20:23], v[52:55]
ds_read_b128 v[44:47], v9 offset:36864
v_mfma_f32_16x16x32_bf16 v[56:59], a[132:135], v[20:23], v[56:59]
s_add_u32 m0, s46, 117120
v_mfma_f32_16x16x32_bf16 v[60:63], a[128:131], v[24:27], v[60:63]
ds_read_b128 v[48:51], v9 offset:38912
v_mfma_f32_16x16x32_bf16 v[64:67], a[132:135], v[24:27], v[64:67]
buffer_load_dwordx4 v6, s[8:11], s50 offen offset:1664 lds
s_waitcnt lgkmcnt(4)
v_mfma_f32_16x16x32_bf16 v[52:55], a[136:139], v[28:31], v[52:55]
ds_read_b128 v[20:23], v8 offset:40960
v_mfma_f32_16x16x32_bf16 v[56:59], a[140:143], v[28:31], v[56:59]
s_add_u32 m0, s46, 121088
v_mfma_f32_16x16x32_bf16 v[60:63], a[136:139], v[32:35], v[60:63]
ds_read_b128 v[24:27], v8 offset:43008
v_mfma_f32_16x16x32_bf16 v[64:67], a[140:143], v[32:35], v[64:67]
buffer_load_dwordx4 v6, s[8:11], s50 offen offset:1792 lds
s_waitcnt lgkmcnt(4)
v_mfma_f32_16x16x32_bf16 v[52:55], a[144:147], v[36:39], v[52:55]
ds_read_b128 v[28:31], v9 offset:40960
v_mfma_f32_16x16x32_bf16 v[56:59], a[148:151], v[36:39], v[56:59]
s_add_u32 m0, s46, 125056
v_mfma_f32_16x16x32_bf16 v[60:63], a[144:147], v[40:43], v[60:63]
ds_read_b128 v[32:35], v9 offset:43008
v_mfma_f32_16x16x32_bf16 v[64:67], a[148:151], v[40:43], v[64:67]
buffer_load_dwordx4 v6, s[8:11], s50 offen offset:1920 lds
s_waitcnt lgkmcnt(4)
v_mfma_f32_16x16x32_bf16 v[52:55], a[152:155], v[44:47], v[52:55]
ds_read_b128 v[36:39], v8 offset:45056
v_mfma_f32_16x16x32_bf16 v[56:59], a[156:159], v[44:47], v[56:59]
v_mfma_f32_16x16x32_bf16 v[60:63], a[152:155], v[48:51], v[60:63]
ds_read_b128 v[40:43], v8 offset:47104
v_mfma_f32_16x16x32_bf16 v[64:67], a[156:159], v[48:51], v[64:67]
s_waitcnt lgkmcnt(4)
v_mfma_f32_16x16x32_bf16 v[52:55], a[160:163], v[20:23], v[52:55]
ds_read_b128 v[44:47], v9 offset:45056
v_mfma_f32_16x16x32_bf16 v[56:59], a[164:167], v[20:23], v[56:59]
v_mfma_f32_16x16x32_bf16 v[60:63], a[160:163], v[24:27], v[60:63]
ds_read_b128 v[48:51], v9 offset:47104
v_mfma_f32_16x16x32_bf16 v[64:67], a[164:167], v[24:27], v[64:67]
s_waitcnt lgkmcnt(4)
v_mfma_f32_16x16x32_bf16 v[52:55], a[168:171], v[28:31], v[52:55]
ds_read_b128 v[20:23], v8 offset:49152
v_mfma_f32_16x16x32_bf16 v[56:59], a[172:175], v[28:31], v[56:59]
s_waitcnt vmcnt(16)
v_mov_b32 v17, s42
s_mov_b64 exec, 1
buffer_store_dword v17, v16, s[84:87], s49 offen sc1
s_mov_b64 exec, -1
v_mfma_f32_16x16x32_bf16 v[60:63], a[168:171], v[32:35], v[60:63]
ds_read_b128 v[24:27], v8 offset:51200
v_mfma_f32_16x16x32_bf16 v[64:67], a[172:175], v[32:35], v[64:67]
s_waitcnt lgkmcnt(4)
v_mfma_f32_16x16x32_bf16 v[52:55], a[176:179], v[36:39], v[52:55]
ds_read_b128 v[28:31], v9 offset:49152
v_mfma_f32_16x16x32_bf16 v[56:59], a[180:183], v[36:39], v[56:59]
s_add_u32 s53, s42, 3
s_min_u32 s53, s53, 63
s_lshl_b32 s53, s53, 16
s_mov_b64 exec, 0xffff
buffer_load_dword v250, v19, s[8:11], s53 offen
s_mov_b64 exec, -1
v_mfma_f32_16x16x32_bf16 v[60:63], a[176:179], v[40:43], v[60:63]
ds_read_b128 v[32:35], v9 offset:51200
v_mfma_f32_16x16x32_bf16 v[64:67], a[180:183], v[40:43], v[64:67]
s_waitcnt lgkmcnt(4)
v_mfma_f32_16x16x32_bf16 v[52:55], a[184:187], v[44:47], v[52:55]
ds_read_b128 v[36:39], v8 offset:53248
v_mfma_f32_16x16x32_bf16 v[56:59], a[188:191], v[44:47], v[56:59]
v_mfma_f32_16x16x32_bf16 v[60:63], a[184:187], v[48:51], v[60:63]
ds_read_b128 v[40:43], v8 offset:55296
v_mfma_f32_16x16x32_bf16 v[64:67], a[188:191], v[48:51], v[64:67]
s_waitcnt lgkmcnt(4)
v_mfma_f32_16x16x32_bf16 v[52:55], a[192:195], v[20:23], v[52:55]
ds_read_b128 v[44:47], v9 offset:53248
v_mfma_f32_16x16x32_bf16 v[56:59], a[196:199], v[20:23], v[56:59]
v_mfma_f32_16x16x32_bf16 v[60:63], a[192:195], v[24:27], v[60:63]
ds_read_b128 v[48:51], v9 offset:55296
v_mfma_f32_16x16x32_bf16 v[64:67], a[196:199], v[24:27], v[64:67]
s_waitcnt lgkmcnt(4)
v_mfma_f32_16x16x32_bf16 v[52:55], a[200:203], v[28:31], v[52:55]
ds_read_b128 v[20:23], v8 offset:57344
v_mfma_f32_16x16x32_bf16 v[56:59], a[204:207], v[28:31], v[56:59]
v_mfma_f32_16x16x32_bf16 v[60:63], a[200:203], v[32:35], v[60:63]
ds_read_b128 v[24:27], v8 offset:59392
v_mfma_f32_16x16x32_bf16 v[64:67], a[204:207], v[32:35], v[64:67]
s_waitcnt lgkmcnt(4)
v_mfma_f32_16x16x32_bf16 v[52:55], a[208:211], v[36:39], v[52:55]
ds_read_b128 v[28:31], v9 offset:57344
v_mfma_f32_16x16x32_bf16 v[56:59], a[212:215], v[36:39], v[56:59]
v_mfma_f32_16x16x32_bf16 v[60:63], a[208:211], v[40:43], v[60:63]
ds_read_b128 v[32:35], v9 offset:59392
v_mfma_f32_16x16x32_bf16 v[64:67], a[212:215], v[40:43], v[64:67]
s_waitcnt lgkmcnt(4)
v_mfma_f32_16x16x32_bf16 v[52:55], a[216:219], v[44:47], v[52:55]
ds_read_b128 v[36:39], v8 offset:61440
v_mfma_f32_16x16x32_bf16 v[56:59], a[220:223], v[44:47], v[56:59]
v_mfma_f32_16x16x32_bf16 v[60:63], a[216:219], v[48:51], v[60:63]
ds_read_b128 v[40:43], v8 offset:63488
v_mfma_f32_16x16x32_bf16 v[64:67], a[220:223], v[48:51], v[64:67]
s_waitcnt lgkmcnt(4)
v_mfma_f32_16x16x32_bf16 v[52:55], a[224:227], v[20:23], v[52:55]
ds_read_b128 v[44:47], v9 offset:61440
v_mfma_f32_16x16x32_bf16 v[56:59], a[228:231], v[20:23], v[56:59]
v_mfma_f32_16x16x32_bf16 v[60:63], a[224:227], v[24:27], v[60:63]
ds_read_b128 v[48:51], v9 offset:63488
v_mfma_f32_16x16x32_bf16 v[64:67], a[228:231], v[24:27], v[64:67]
s_waitcnt lgkmcnt(5)
v_mfma_f32_16x16x32_bf16 v[52:55], a[232:235], v[28:31], v[52:55]
v_mfma_f32_16x16x32_bf16 v[56:59], a[236:239], v[28:31], v[56:59]
s_waitcnt lgkmcnt(4)
v_mfma_f32_16x16x32_bf16 v[60:63], a[232:235], v[32:35], v[60:63]
v_mfma_f32_16x16x32_bf16 v[64:67], a[236:239], v[32:35], v[64:67]
s_waitcnt lgkmcnt(3)
v_mfma_f32_16x16x32_bf16 v[52:55], a[240:243], v[36:39], v[52:55]
v_mfma_f32_16x16x32_bf16 v[56:59], a[244:247], v[36:39], v[56:59]
s_waitcnt lgkmcnt(2)
v_mfma_f32_16x16x32_bf16 v[60:63], a[240:243], v[40:43], v[60:63]
v_mfma_f32_16x16x32_bf16 v[64:67], a[244:247], v[40:43], v[64:67]
s_waitcnt lgkmcnt(1)
v_mfma_f32_16x16x32_bf16 v[52:55], a[248:251], v[44:47], v[52:55]
v_mfma_f32_16x16x32_bf16 v[56:59], a[252:255], v[44:47], v[56:59]
s_waitcnt lgkmcnt(0)
v_mfma_f32_16x16x32_bf16 v[60:63], a[248:251], v[48:51], v[60:63]
v_mfma_f32_16x16x32_bf16 v[64:67], a[252:255], v[48:51], v[64:67]
s_add_u32 s42, s42, 1
s_branch mega_kernel_k_loop
mega_kernel_k_fin:
s_nop 11
v_cvt_pk_bf16_f32 v84, v68, v69
v_cvt_pk_bf16_f32 v85, v70, v71
v_cvt_pk_bf16_f32 v86, v72, v73
v_cvt_pk_bf16_f32 v87, v74, v75
v_cvt_pk_bf16_f32 v88, v76, v77
v_cvt_pk_bf16_f32 v89, v78, v79
v_cvt_pk_bf16_f32 v90, v80, v81
v_cvt_pk_bf16_f32 v91, v82, v83
s_add_u32 s51, s42, s47
s_sub_u32 s51, s51, 1
s_bfe_u32 s52, s51, 0x40002
s_lshl_b32 s52, s52, 14
s_and_b32 s51, s51, 3
s_lshl_b32 s51, s51, 11
s_add_u32 s51, s51, s52
s_add_u32 s51, s51, s48
buffer_store_dwordx4 v[84:87], v7, s[84:87], s51 offen sc1
buffer_store_dwordx4 v[88:91], v7, s[84:87], s51 offen offset:1024 sc1
s_waitcnt vmcnt(0)
v_mov_b32 v17, s42
s_mov_b64 exec, 1
buffer_store_dword v17, v16, s[84:87], s49 offen sc1
s_mov_b64 exec, -1
s_waitcnt vmcnt(0)
s_barrier
s_branch mega_kernel_fft
mega_kernel_rv:
s_load_dwordx2 s[4:5], s[0:1], 32
s_load_dwordx2 s[8:9], s[0:1], 0
v_lshrrev_b32 v2, 6, v0
v_and_b32 v1, 63, v0
v_readfirstlane_b32 s41, v2
v_lshlrev_b32 v5, 4, v1
s_waitcnt lgkmcnt(0)
s_mov_b32 s6, 8388608
s_mov_b32 s7, 0x00020000
s_mov_b32 s10, 4194304
s_mov_b32 s11, 0x00020000
s_lshl_b32 s43, s40, 8
s_lshl_b32 s44, s41, 6
s_add_u32 s48, s43, s44
s_and_b32 s43, s48, 0x7ff
v_add_u32 v19, s43, v1
v_lshlrev_b32 v19, 7, v19
buffer_load_dword v250, v19, s[8:11], 0 offen
s_nop 0
v_lshrrev_b32 v2, 3, v1
s_lshl_b32 s43, s41, 3
v_add_u32 v2, s43, v2
v_bfe_u32 v3, v2, 1, 3
v_and_b32 v4, 7, v1
v_xor_b32 v3, v3, v4
v_lshlrev_b32 v6, 11, v2
v_lshl_add_u32 v6, v3, 4, v6
s_lshl_b32 s46, s41, 10
v_and_b32 v2, 15, v1
v_bfe_u32 v3, v2, 1, 3
v_lshrrev_b32 v4, 4, v1
v_xor_b32 v3, v3, v4
v_lshlrev_b32 v8, 7, v2
v_lshl_add_u32 v8, v3, 4, v8
v_xor_b32 v9, 64, v8
v_add_u32 v10, 0x10000, v8
v_add_u32 v11, 0x10000, v9
v_mov_b32 v7, v5
s_lshl_b32 s47, s40, 2
s_add_u32 s47, s47, s41
s_mov_b32 s42, 0
s_mov_b32 s50, 0
s_add_u32 m0, s46, 0
s_nop 0
buffer_load_dwordx4 v6, s[8:11], s50 offen offset:0 lds
s_add_u32 m0, s46, 3968
s_nop 0
buffer_load_dwordx4 v6, s[8:11], s50 offen offset:128 lds
s_add_u32 m0, s46, 7936
s_nop 0
buffer_load_dwordx4 v6, s[8:11], s50 offen offset:256 lds
s_add_u32 m0, s46, 11904
s_nop 0
buffer_load_dwordx4 v6, s[8:11], s50 offen offset:384 lds
s_add_u32 m0, s46, 15872
s_nop 0
buffer_load_dwordx4 v6, s[8:11], s50 offen offset:512 lds
s_add_u32 m0, s46, 19840
s_nop 0
buffer_load_dwordx4 v6, s[8:11], s50 offen offset:640 lds
s_add_u32 m0, s46, 23808
s_nop 0
buffer_load_dwordx4 v6, s[8:11], s50 offen offset:768 lds
s_add_u32 m0, s46, 27776
s_nop 0
buffer_load_dwordx4 v6, s[8:11], s50 offen offset:896 lds
s_add_u32 m0, s46, 31744
s_nop 0
buffer_load_dwordx4 v6, s[8:11], s50 offen offset:1024 lds
s_add_u32 m0, s46, 35712
s_nop 0
buffer_load_dwordx4 v6, s[8:11], s50 offen offset:1152 lds
s_add_u32 m0, s46, 39680
s_nop 0
buffer_load_dwordx4 v6, s[8:11], s50 offen offset:1280 lds
s_add_u32 m0, s46, 43648
s_nop 0
buffer_load_dwordx4 v6, s[8:11], s50 offen offset:1408 lds
s_add_u32 m0, s46, 47616
s_nop 0
buffer_load_dwordx4 v6, s[8:11], s50 offen offset:1536 lds
s_add_u32 m0, s46, 51584
s_nop 0
buffer_load_dwordx4 v6, s[8:11], s50 offen offset:1664 lds
s_add_u32 m0, s46, 55552
s_nop 0
buffer_load_dwordx4 v6, s[8:11], s50 offen offset:1792 lds
s_add_u32 m0, s46, 59520
s_nop 0
buffer_load_dwordx4 v6, s[8:11], s50 offen offset:1920 lds
v_lshrrev_b32 v2, 2, v1
v_and_b32 v3, 3, v1
v_lshlrev_b32 v16, 13, v2
v_lshl_add_u32 v16, v3, 4, v16
v_add_u32 v16, s48, v16
s_mul_i32 s45, s41, 24576
s_add_u32 s45, s45, 65536
v_bfe_u32 v17, v1, 2, 2
v_lshrrev_b32 v18, 4, v1
v_lshl_add_u32 v17, v18, 3, v17
v_lshlrev_b32 v17, 6, v17
v_lshl_add_u32 v17, v3, 3, v17
v_add_u32 v17, s45, v17
s_and_b32 s43, s40, 3
s_lshl_b32 s43, s43, 2
s_add_u32 s43, s43, s41
s_lshl_b32 s43, s43, 3
v_and_b32 v12, 7, v1
v_add_u32 v12, s43, v12
s_lshr_b32 s43, s40, 2
s_lshl_b32 s43, s43, 10
s_add_u32 s44, s43, 896
s_add_u32 s43, s43, 384
s_cmp_ge_u32 s40, 28
s_cselect_b32 s44, s44, s43
v_mov_b32 v13, s43
v_mov_b32 v14, s44
v_cmp_gt_u32 vcc, 32, v1
s_nop 1
v_cndmask_b32 v13, v14, v13, vcc
v_lshl_add_u32 v12, v12, 13, v13
s_mov_b32 s44, 0
buffer_load_dword v250, v12, s[4:7], s44 offen
s_add_u32 m0, s45, 0
s_mov_b32 s44, 0
buffer_load_dwordx4 v16, s[4:7], s44 offen lds
s_add_u32 m0, s45, 1024
s_mov_b32 s44, 131072
buffer_load_dwordx4 v16, s[4:7], s44 offen lds
s_add_u32 m0, s45, 2048
s_mov_b32 s44, 262144
buffer_load_dwordx4 v16, s[4:7], s44 offen lds
s_add_u32 m0, s45, 3072
s_mov_b32 s44, 393216
buffer_load_dwordx4 v16, s[4:7], s44 offen lds
s_add_u32 m0, s45, 4096
s_mov_b32 s44, 524288
buffer_load_dwordx4 v16, s[4:7], s44 offen lds
s_add_u32 m0, s45, 5120
s_mov_b32 s44, 655360
buffer_load_dwordx4 v16, s[4:7], s44 offen lds
s_add_u32 m0, s45, 6144
s_mov_b32 s44, 786432
buffer_load_dwordx4 v16, s[4:7], s44 offen lds
s_add_u32 m0, s45, 7168
s_mov_b32 s44, 917504
buffer_load_dwordx4 v16, s[4:7], s44 offen lds
s_mov_b32 s44, 1048576
buffer_load_dword v250, v12, s[4:7], s44 offen
s_add_u32 m0, s45, 8192
s_mov_b32 s44, 1048576
buffer_load_dwordx4 v16, s[4:7], s44 offen lds
s_add_u32 m0, s45, 9216
s_mov_b32 s44, 1179648
buffer_load_dwordx4 v16, s[4:7], s44 offen lds
s_add_u32 m0, s45, 10240
s_mov_b32 s44, 1310720
buffer_load_dwordx4 v16, s[4:7], s44 offen lds
s_add_u32 m0, s45, 11264
s_mov_b32 s44, 1441792
buffer_load_dwordx4 v16, s[4:7], s44 offen lds
s_add_u32 m0, s45, 12288
s_mov_b32 s44, 1572864
buffer_load_dwordx4 v16, s[4:7], s44 offen lds
s_add_u32 m0, s45, 13312
s_mov_b32 s44, 1703936
buffer_load_dwordx4 v16, s[4:7], s44 offen lds
s_add_u32 m0, s45, 14336
s_mov_b32 s44, 1835008
buffer_load_dwordx4 v16, s[4:7], s44 offen lds
s_add_u32 m0, s45, 15360
s_mov_b32 s44, 1966080
buffer_load_dwordx4 v16, s[4:7], s44 offen lds
s_mov_b32 s44, 2097152
buffer_load_dword v250, v12, s[4:7], s44 offen
s_add_u32 m0, s45, 16384
s_mov_b32 s44, 2097152
buffer_load_dwordx4 v16, s[4:7], s44 offen lds
s_add_u32 m0, s45, 17408
s_mov_b32 s44, 2228224
buffer_load_dwordx4 v16, s[4:7], s44 offen lds
s_add_u32 m0, s45, 18432
s_mov_b32 s44, 2359296
buffer_load_dwordx4 v16, s[4:7], s44 offen lds
s_add_u32 m0, s45, 19456
s_mov_b32 s44, 2490368
buffer_load_dwordx4 v16, s[4:7], s44 offen lds
s_add_u32 m0, s45, 20480
s_mov_b32 s44, 2621440
buffer_load_dwordx4 v16, s[4:7], s44 offen lds
s_add_u32 m0, s45, 21504
s_mov_b32 s44, 2752512
buffer_load_dwordx4 v16, s[4:7], s44 offen lds
s_add_u32 m0, s45, 22528
s_mov_b32 s44, 2883584
buffer_load_dwordx4 v16, s[4:7], s44 offen lds
s_add_u32 m0, s45, 23552
s_mov_b32 s44, 3014656
buffer_load_dwordx4 v16, s[4:7], s44 offen lds
s_waitcnt vmcnt(18)
s_barrier
ds_read_b64_tr_b16 a[0:1], v17 offset:0
ds_read_b64_tr_b16 a[2:3], v17 offset:256
ds_read_b64_tr_b16 a[4:5], v17 offset:32
ds_read_b64_tr_b16 a[6:7], v17 offset:288
ds_read_b64_tr_b16 a[8:9], v17 offset:2048
ds_read_b64_tr_b16 a[10:11], v17 offset:2304
ds_read_b64_tr_b16 a[12:13], v17 offset:2080
ds_read_b64_tr_b16 a[14:15], v17 offset:2336
s_waitcnt lgkmcnt(0)
ds_read_b64_tr_b16 a[16:17], v17 offset:4096
ds_read_b64_tr_b16 a[18:19], v17 offset:4352
ds_read_b64_tr_b16 a[20:21], v17 offset:4128
ds_read_b64_tr_b16 a[22:23], v17 offset:4384
ds_read_b64_tr_b16 a[24:25], v17 offset:6144
ds_read_b64_tr_b16 a[26:27], v17 offset:6400
ds_read_b64_tr_b16 a[28:29], v17 offset:6176
ds_read_b64_tr_b16 a[30:31], v17 offset:6432
s_waitcnt lgkmcnt(0)
ds_read_b128 v[20:23], v8 offset:0
ds_read_b128 v[24:27], v8 offset:2048
ds_read_b128 v[28:31], v9 offset:0
ds_read_b128 v[32:35], v9 offset:2048
ds_read_b128 v[36:39], v8 offset:4096
ds_read_b128 v[40:43], v8 offset:6144
ds_read_b128 v[44:47], v9 offset:4096
ds_read_b128 v[48:51], v9 offset:6144
s_mov_b32 s44, 3145728
buffer_load_dword v250, v12, s[4:7], s44 offen
s_add_u32 m0, s45, 0
s_mov_b32 s44, 3145728
buffer_load_dwordx4 v16, s[4:7], s44 offen lds
s_add_u32 m0, s45, 1024
s_mov_b32 s44, 3276800
buffer_load_dwordx4 v16, s[4:7], s44 offen lds
s_add_u32 m0, s45, 2048
s_mov_b32 s44, 3407872
buffer_load_dwordx4 v16, s[4:7], s44 offen lds
s_add_u32 m0, s45, 3072
s_mov_b32 s44, 3538944
buffer_load_dwordx4 v16, s[4:7], s44 offen lds
s_add_u32 m0, s45, 4096
s_mov_b32 s44, 3670016
buffer_load_dwordx4 v16, s[4:7], s44 offen lds
s_add_u32 m0, s45, 5120
s_mov_b32 s44, 3801088
buffer_load_dwordx4 v16, s[4:7], s44 offen lds
s_add_u32 m0, s45, 6144
s_mov_b32 s44, 3932160
buffer_load_dwordx4 v16, s[4:7], s44 offen lds
s_add_u32 m0, s45, 7168
s_mov_b32 s44, 4063232
buffer_load_dwordx4 v16, s[4:7], s44 offen lds
s_waitcnt lgkmcnt(0)
v_mfma_f32_16x16x32_bf16 v[52:55], v[20:23], a[0:3], 0
v_mfma_f32_16x16x32_bf16 v[56:59], v[20:23], a[4:7], 0
v_mfma_f32_16x16x32_bf16 v[60:63], v[24:27], a[0:3], 0
v_mfma_f32_16x16x32_bf16 v[64:67], v[24:27], a[4:7], 0
v_mfma_f32_16x16x32_bf16 v[52:55], v[28:31], a[8:11], v[52:55]
v_mfma_f32_16x16x32_bf16 v[56:59], v[28:31], a[12:15], v[56:59]
v_mfma_f32_16x16x32_bf16 v[60:63], v[32:35], a[8:11], v[60:63]
v_mfma_f32_16x16x32_bf16 v[64:67], v[32:35], a[12:15], v[64:67]
v_mfma_f32_16x16x32_bf16 v[52:55], v[36:39], a[16:19], v[52:55]
v_mfma_f32_16x16x32_bf16 v[56:59], v[36:39], a[20:23], v[56:59]
v_mfma_f32_16x16x32_bf16 v[60:63], v[40:43], a[16:19], v[60:63]
v_mfma_f32_16x16x32_bf16 v[64:67], v[40:43], a[20:23], v[64:67]
v_mfma_f32_16x16x32_bf16 v[52:55], v[44:47], a[24:27], v[52:55]
v_mfma_f32_16x16x32_bf16 v[56:59], v[44:47], a[28:31], v[56:59]
v_mfma_f32_16x16x32_bf16 v[60:63], v[48:51], a[24:27], v[60:63]
v_mfma_f32_16x16x32_bf16 v[64:67], v[48:51], a[28:31], v[64:67]
s_waitcnt vmcnt(18)
ds_read_b64_tr_b16 a[32:33], v17 offset:8192
ds_read_b64_tr_b16 a[34:35], v17 offset:8448
ds_read_b64_tr_b16 a[36:37], v17 offset:8224
ds_read_b64_tr_b16 a[38:39], v17 offset:8480
ds_read_b64_tr_b16 a[40:41], v17 offset:10240
ds_read_b64_tr_b16 a[42:43], v17 offset:10496
ds_read_b64_tr_b16 a[44:45], v17 offset:10272
ds_read_b64_tr_b16 a[46:47], v17 offset:10528
s_waitcnt lgkmcnt(0)
ds_read_b64_tr_b16 a[48:49], v17 offset:12288
ds_read_b64_tr_b16 a[50:51], v17 offset:12544
ds_read_b64_tr_b16 a[52:53], v17 offset:12320
ds_read_b64_tr_b16 a[54:55], v17 offset:12576
ds_read_b64_tr_b16 a[56:57], v17 offset:14336
ds_read_b64_tr_b16 a[58:59], v17 offset:14592
ds_read_b64_tr_b16 a[60:61], v17 offset:14368
ds_read_b64_tr_b16 a[62:63], v17 offset:14624
s_waitcnt lgkmcnt(0)
ds_read_b128 v[20:23], v8 offset:8192
ds_read_b128 v[24:27], v8 offset:10240
ds_read_b128 v[28:31], v9 offset:8192
ds_read_b128 v[32:35], v9 offset:10240
ds_read_b128 v[36:39], v8 offset:12288
ds_read_b128 v[40:43], v8 offset:14336
ds_read_b128 v[44:47], v9 offset:12288
ds_read_b128 v[48:51], v9 offset:14336
s_mov_b32 s44, 4194304
buffer_load_dword v250, v12, s[4:7], s44 offen
s_add_u32 m0, s45, 8192
s_mov_b32 s44, 4194304
buffer_load_dwordx4 v16, s[4:7], s44 offen lds
s_add_u32 m0, s45, 9216
s_mov_b32 s44, 4325376
buffer_load_dwordx4 v16, s[4:7], s44 offen lds
s_add_u32 m0, s45, 10240
s_mov_b32 s44, 4456448
buffer_load_dwordx4 v16, s[4:7], s44 offen lds
s_add_u32 m0, s45, 11264
s_mov_b32 s44, 4587520
buffer_load_dwordx4 v16, s[4:7], s44 offen lds
s_add_u32 m0, s45, 12288
s_mov_b32 s44, 4718592
buffer_load_dwordx4 v16, s[4:7], s44 offen lds
s_add_u32 m0, s45, 13312
s_mov_b32 s44, 4849664
buffer_load_dwordx4 v16, s[4:7], s44 offen lds
s_add_u32 m0, s45, 14336
s_mov_b32 s44, 4980736
buffer_load_dwordx4 v16, s[4:7], s44 offen lds
s_add_u32 m0, s45, 15360
s_mov_b32 s44, 5111808
buffer_load_dwordx4 v16, s[4:7], s44 offen lds
s_waitcnt lgkmcnt(0)
v_mfma_f32_16x16x32_bf16 v[52:55], v[20:23], a[32:35], v[52:55]
v_mfma_f32_16x16x32_bf16 v[56:59], v[20:23], a[36:39], v[56:59]
v_mfma_f32_16x16x32_bf16 v[60:63], v[24:27], a[32:35], v[60:63]
v_mfma_f32_16x16x32_bf16 v[64:67], v[24:27], a[36:39], v[64:67]
v_mfma_f32_16x16x32_bf16 v[52:55], v[28:31], a[40:43], v[52:55]
v_mfma_f32_16x16x32_bf16 v[56:59], v[28:31], a[44:47], v[56:59]
v_mfma_f32_16x16x32_bf16 v[60:63], v[32:35], a[40:43], v[60:63]
v_mfma_f32_16x16x32_bf16 v[64:67], v[32:35], a[44:47], v[64:67]
v_mfma_f32_16x16x32_bf16 v[52:55], v[36:39], a[48:51], v[52:55]
v_mfma_f32_16x16x32_bf16 v[56:59], v[36:39], a[52:55], v[56:59]
v_mfma_f32_16x16x32_bf16 v[60:63], v[40:43], a[48:51], v[60:63]
v_mfma_f32_16x16x32_bf16 v[64:67], v[40:43], a[52:55], v[64:67]
v_mfma_f32_16x16x32_bf16 v[52:55], v[44:47], a[56:59], v[52:55]
v_mfma_f32_16x16x32_bf16 v[56:59], v[44:47], a[60:63], v[56:59]
v_mfma_f32_16x16x32_bf16 v[60:63], v[48:51], a[56:59], v[60:63]
v_mfma_f32_16x16x32_bf16 v[64:67], v[48:51], a[60:63], v[64:67]
s_waitcnt vmcnt(18)
ds_read_b64_tr_b16 a[64:65], v17 offset:16384
ds_read_b64_tr_b16 a[66:67], v17 offset:16640
ds_read_b64_tr_b16 a[68:69], v17 offset:16416
ds_read_b64_tr_b16 a[70:71], v17 offset:16672
ds_read_b64_tr_b16 a[72:73], v17 offset:18432
ds_read_b64_tr_b16 a[74:75], v17 offset:18688
ds_read_b64_tr_b16 a[76:77], v17 offset:18464
ds_read_b64_tr_b16 a[78:79], v17 offset:18720
s_waitcnt lgkmcnt(0)
ds_read_b64_tr_b16 a[80:81], v17 offset:20480
ds_read_b64_tr_b16 a[82:83], v17 offset:20736
ds_read_b64_tr_b16 a[84:85], v17 offset:20512
ds_read_b64_tr_b16 a[86:87], v17 offset:20768
ds_read_b64_tr_b16 a[88:89], v17 offset:22528
ds_read_b64_tr_b16 a[90:91], v17 offset:22784
ds_read_b64_tr_b16 a[92:93], v17 offset:22560
ds_read_b64_tr_b16 a[94:95], v17 offset:22816
s_waitcnt lgkmcnt(0)
ds_read_b128 v[20:23], v8 offset:16384
ds_read_b128 v[24:27], v8 offset:18432
ds_read_b128 v[28:31], v9 offset:16384
ds_read_b128 v[32:35], v9 offset:18432
ds_read_b128 v[36:39], v8 offset:20480
ds_read_b128 v[40:43], v8 offset:22528
ds_read_b128 v[44:47], v9 offset:20480
ds_read_b128 v[48:51], v9 offset:22528
s_mov_b32 s44, 5242880
buffer_load_dword v250, v12, s[4:7], s44 offen
s_add_u32 m0, s45, 16384
s_mov_b32 s44, 5242880
buffer_load_dwordx4 v16, s[4:7], s44 offen lds
s_add_u32 m0, s45, 17408
s_mov_b32 s44, 5373952
buffer_load_dwordx4 v16, s[4:7], s44 offen lds
s_add_u32 m0, s45, 18432
s_mov_b32 s44, 5505024
buffer_load_dwordx4 v16, s[4:7], s44 offen lds
s_add_u32 m0, s45, 19456
s_mov_b32 s44, 5636096
buffer_load_dwordx4 v16, s[4:7], s44 offen lds
s_add_u32 m0, s45, 20480
s_mov_b32 s44, 5767168
buffer_load_dwordx4 v16, s[4:7], s44 offen lds
s_add_u32 m0, s45, 21504
s_mov_b32 s44, 5898240
buffer_load_dwordx4 v16, s[4:7], s44 offen lds
s_add_u32 m0, s45, 22528
s_mov_b32 s44, 6029312
buffer_load_dwordx4 v16, s[4:7], s44 offen lds
s_add_u32 m0, s45, 23552
s_mov_b32 s44, 6160384
buffer_load_dwordx4 v16, s[4:7], s44 offen lds
s_waitcnt lgkmcnt(0)
v_mfma_f32_16x16x32_bf16 v[52:55], v[20:23], a[64:67], v[52:55]
v_mfma_f32_16x16x32_bf16 v[56:59], v[20:23], a[68:71], v[56:59]
v_mfma_f32_16x16x32_bf16 v[60:63], v[24:27], a[64:67], v[60:63]
v_mfma_f32_16x16x32_bf16 v[64:67], v[24:27], a[68:71], v[64:67]
v_mfma_f32_16x16x32_bf16 v[52:55], v[28:31], a[72:75], v[52:55]
v_mfma_f32_16x16x32_bf16 v[56:59], v[28:31], a[76:79], v[56:59]
v_mfma_f32_16x16x32_bf16 v[60:63], v[32:35], a[72:75], v[60:63]
v_mfma_f32_16x16x32_bf16 v[64:67], v[32:35], a[76:79], v[64:67]
v_mfma_f32_16x16x32_bf16 v[52:55], v[36:39], a[80:83], v[52:55]
v_mfma_f32_16x16x32_bf16 v[56:59], v[36:39], a[84:87], v[56:59]
v_mfma_f32_16x16x32_bf16 v[60:63], v[40:43], a[80:83], v[60:63]
v_mfma_f32_16x16x32_bf16 v[64:67], v[40:43], a[84:87], v[64:67]
v_mfma_f32_16x16x32_bf16 v[52:55], v[44:47], a[88:91], v[52:55]
v_mfma_f32_16x16x32_bf16 v[56:59], v[44:47], a[92:95], v[56:59]
v_mfma_f32_16x16x32_bf16 v[60:63], v[48:51], a[88:91], v[60:63]
v_mfma_f32_16x16x32_bf16 v[64:67], v[48:51], a[92:95], v[64:67]
s_waitcnt vmcnt(18)
ds_read_b64_tr_b16 a[96:97], v17 offset:0
ds_read_b64_tr_b16 a[98:99], v17 offset:256
ds_read_b64_tr_b16 a[100:101], v17 offset:32
ds_read_b64_tr_b16 a[102:103], v17 offset:288
ds_read_b64_tr_b16 a[104:105], v17 offset:2048
ds_read_b64_tr_b16 a[106:107], v17 offset:2304
ds_read_b64_tr_b16 a[108:109], v17 offset:2080
ds_read_b64_tr_b16 a[110:111], v17 offset:2336
s_waitcnt lgkmcnt(0)
ds_read_b64_tr_b16 a[112:113], v17 offset:4096
ds_read_b64_tr_b16 a[114:115], v17 offset:4352
ds_read_b64_tr_b16 a[116:117], v17 offset:4128
ds_read_b64_tr_b16 a[118:119], v17 offset:4384
ds_read_b64_tr_b16 a[120:121], v17 offset:6144
ds_read_b64_tr_b16 a[122:123], v17 offset:6400
ds_read_b64_tr_b16 a[124:125], v17 offset:6176
ds_read_b64_tr_b16 a[126:127], v17 offset:6432
s_waitcnt lgkmcnt(0)
ds_read_b128 v[20:23], v8 offset:24576
ds_read_b128 v[24:27], v8 offset:26624
ds_read_b128 v[28:31], v9 offset:24576
ds_read_b128 v[32:35], v9 offset:26624
ds_read_b128 v[36:39], v8 offset:28672
ds_read_b128 v[40:43], v8 offset:30720
ds_read_b128 v[44:47], v9 offset:28672
ds_read_b128 v[48:51], v9 offset:30720
s_mov_b32 s44, 6291456
buffer_load_dword v250, v12, s[4:7], s44 offen
s_add_u32 m0, s45, 0
s_mov_b32 s44, 6291456
buffer_load_dwordx4 v16, s[4:7], s44 offen lds
s_add_u32 m0, s45, 1024
s_mov_b32 s44, 6422528
buffer_load_dwordx4 v16, s[4:7], s44 offen lds
s_add_u32 m0, s45, 2048
s_mov_b32 s44, 6553600
buffer_load_dwordx4 v16, s[4:7], s44 offen lds
s_add_u32 m0, s45, 3072
s_mov_b32 s44, 6684672
buffer_load_dwordx4 v16, s[4:7], s44 offen lds
s_add_u32 m0, s45, 4096
s_mov_b32 s44, 6815744
buffer_load_dwordx4 v16, s[4:7], s44 offen lds
s_add_u32 m0, s45, 5120
s_mov_b32 s44, 6946816
buffer_load_dwordx4 v16, s[4:7], s44 offen lds
s_add_u32 m0, s45, 6144
s_mov_b32 s44, 7077888
buffer_load_dwordx4 v16, s[4:7], s44 offen lds
s_add_u32 m0, s45, 7168
s_mov_b32 s44, 7208960
buffer_load_dwordx4 v16, s[4:7], s44 offen lds
s_waitcnt lgkmcnt(0)
v_mfma_f32_16x16x32_bf16 v[52:55], v[20:23], a[96:99], v[52:55]
v_mfma_f32_16x16x32_bf16 v[56:59], v[20:23], a[100:103], v[56:59]
v_mfma_f32_16x16x32_bf16 v[60:63], v[24:27], a[96:99], v[60:63]
v_mfma_f32_16x16x32_bf16 v[64:67], v[24:27], a[100:103], v[64:67]
v_mfma_f32_16x16x32_bf16 v[52:55], v[28:31], a[104:107], v[52:55]
v_mfma_f32_16x16x32_bf16 v[56:59], v[28:31], a[108:111], v[56:59]
v_mfma_f32_16x16x32_bf16 v[60:63], v[32:35], a[104:107], v[60:63]
v_mfma_f32_16x16x32_bf16 v[64:67], v[32:35], a[108:111], v[64:67]
v_mfma_f32_16x16x32_bf16 v[52:55], v[36:39], a[112:115], v[52:55]
v_mfma_f32_16x16x32_bf16 v[56:59], v[36:39], a[116:119], v[56:59]
v_mfma_f32_16x16x32_bf16 v[60:63], v[40:43], a[112:115], v[60:63]
v_mfma_f32_16x16x32_bf16 v[64:67], v[40:43], a[116:119], v[64:67]
v_mfma_f32_16x16x32_bf16 v[52:55], v[44:47], a[120:123], v[52:55]
v_mfma_f32_16x16x32_bf16 v[56:59], v[44:47], a[124:127], v[56:59]
v_mfma_f32_16x16x32_bf16 v[60:63], v[48:51], a[120:123], v[60:63]
v_mfma_f32_16x16x32_bf16 v[64:67], v[48:51], a[124:127], v[64:67]
s_waitcnt vmcnt(18)
ds_read_b64_tr_b16 a[128:129], v17 offset:8192
ds_read_b64_tr_b16 a[130:131], v17 offset:8448
ds_read_b64_tr_b16 a[132:133], v17 offset:8224
ds_read_b64_tr_b16 a[134:135], v17 offset:8480
ds_read_b64_tr_b16 a[136:137], v17 offset:10240
ds_read_b64_tr_b16 a[138:139], v17 offset:10496
ds_read_b64_tr_b16 a[140:141], v17 offset:10272
ds_read_b64_tr_b16 a[142:143], v17 offset:10528
s_waitcnt lgkmcnt(0)
ds_read_b64_tr_b16 a[144:145], v17 offset:12288
ds_read_b64_tr_b16 a[146:147], v17 offset:12544
ds_read_b64_tr_b16 a[148:149], v17 offset:12320
ds_read_b64_tr_b16 a[150:151], v17 offset:12576
ds_read_b64_tr_b16 a[152:153], v17 offset:14336
ds_read_b64_tr_b16 a[154:155], v17 offset:14592
ds_read_b64_tr_b16 a[156:157], v17 offset:14368
ds_read_b64_tr_b16 a[158:159], v17 offset:14624
s_waitcnt lgkmcnt(0)
ds_read_b128 v[20:23], v8 offset:32768
ds_read_b128 v[24:27], v8 offset:34816
ds_read_b128 v[28:31], v9 offset:32768
ds_read_b128 v[32:35], v9 offset:34816
ds_read_b128 v[36:39], v8 offset:36864
ds_read_b128 v[40:43], v8 offset:38912
ds_read_b128 v[44:47], v9 offset:36864
ds_read_b128 v[48:51], v9 offset:38912
s_mov_b32 s44, 7340032
buffer_load_dword v250, v12, s[4:7], s44 offen
s_add_u32 m0, s45, 8192
s_mov_b32 s44, 7340032
buffer_load_dwordx4 v16, s[4:7], s44 offen lds
s_add_u32 m0, s45, 9216
s_mov_b32 s44, 7471104
buffer_load_dwordx4 v16, s[4:7], s44 offen lds
s_add_u32 m0, s45, 10240
s_mov_b32 s44, 7602176
buffer_load_dwordx4 v16, s[4:7], s44 offen lds
s_add_u32 m0, s45, 11264
s_mov_b32 s44, 7733248
buffer_load_dwordx4 v16, s[4:7], s44 offen lds
s_add_u32 m0, s45, 12288
s_mov_b32 s44, 7864320
buffer_load_dwordx4 v16, s[4:7], s44 offen lds
s_add_u32 m0, s45, 13312
s_mov_b32 s44, 7995392
buffer_load_dwordx4 v16, s[4:7], s44 offen lds
s_add_u32 m0, s45, 14336
s_mov_b32 s44, 8126464
buffer_load_dwordx4 v16, s[4:7], s44 offen lds
s_add_u32 m0, s45, 15360
s_mov_b32 s44, 8257536
buffer_load_dwordx4 v16, s[4:7], s44 offen lds
s_waitcnt lgkmcnt(0)
v_mfma_f32_16x16x32_bf16 v[52:55], v[20:23], a[128:131], v[52:55]
v_mfma_f32_16x16x32_bf16 v[56:59], v[20:23], a[132:135], v[56:59]
v_mfma_f32_16x16x32_bf16 v[60:63], v[24:27], a[128:131], v[60:63]
v_mfma_f32_16x16x32_bf16 v[64:67], v[24:27], a[132:135], v[64:67]
v_mfma_f32_16x16x32_bf16 v[52:55], v[28:31], a[136:139], v[52:55]
v_mfma_f32_16x16x32_bf16 v[56:59], v[28:31], a[140:143], v[56:59]
v_mfma_f32_16x16x32_bf16 v[60:63], v[32:35], a[136:139], v[60:63]
v_mfma_f32_16x16x32_bf16 v[64:67], v[32:35], a[140:143], v[64:67]
v_mfma_f32_16x16x32_bf16 v[52:55], v[36:39], a[144:147], v[52:55]
v_mfma_f32_16x16x32_bf16 v[56:59], v[36:39], a[148:151], v[56:59]
v_mfma_f32_16x16x32_bf16 v[60:63], v[40:43], a[144:147], v[60:63]
v_mfma_f32_16x16x32_bf16 v[64:67], v[40:43], a[148:151], v[64:67]
v_mfma_f32_16x16x32_bf16 v[52:55], v[44:47], a[152:155], v[52:55]
v_mfma_f32_16x16x32_bf16 v[56:59], v[44:47], a[156:159], v[56:59]
v_mfma_f32_16x16x32_bf16 v[60:63], v[48:51], a[152:155], v[60:63]
v_mfma_f32_16x16x32_bf16 v[64:67], v[48:51], a[156:159], v[64:67]
s_waitcnt vmcnt(18)
ds_read_b64_tr_b16 a[160:161], v17 offset:16384
ds_read_b64_tr_b16 a[162:163], v17 offset:16640
ds_read_b64_tr_b16 a[164:165], v17 offset:16416
ds_read_b64_tr_b16 a[166:167], v17 offset:16672
ds_read_b64_tr_b16 a[168:169], v17 offset:18432
ds_read_b64_tr_b16 a[170:171], v17 offset:18688
ds_read_b64_tr_b16 a[172:173], v17 offset:18464
ds_read_b64_tr_b16 a[174:175], v17 offset:18720
s_waitcnt lgkmcnt(0)
ds_read_b64_tr_b16 a[176:177], v17 offset:20480
ds_read_b64_tr_b16 a[178:179], v17 offset:20736
ds_read_b64_tr_b16 a[180:181], v17 offset:20512
ds_read_b64_tr_b16 a[182:183], v17 offset:20768
ds_read_b64_tr_b16 a[184:185], v17 offset:22528
ds_read_b64_tr_b16 a[186:187], v17 offset:22784
ds_read_b64_tr_b16 a[188:189], v17 offset:22560
ds_read_b64_tr_b16 a[190:191], v17 offset:22816
s_waitcnt lgkmcnt(0)
ds_read_b128 v[20:23], v8 offset:40960
ds_read_b128 v[24:27], v8 offset:43008
ds_read_b128 v[28:31], v9 offset:40960
ds_read_b128 v[32:35], v9 offset:43008
ds_read_b128 v[36:39], v8 offset:45056
ds_read_b128 v[40:43], v8 offset:47104
ds_read_b128 v[44:47], v9 offset:45056
ds_read_b128 v[48:51], v9 offset:47104
s_waitcnt lgkmcnt(0)
v_mfma_f32_16x16x32_bf16 v[52:55], v[20:23], a[160:163], v[52:55]
v_mfma_f32_16x16x32_bf16 v[56:59], v[20:23], a[164:167], v[56:59]
v_mfma_f32_16x16x32_bf16 v[60:63], v[24:27], a[160:163], v[60:63]
v_mfma_f32_16x16x32_bf16 v[64:67], v[24:27], a[164:167], v[64:67]
v_mfma_f32_16x16x32_bf16 v[52:55], v[28:31], a[168:171], v[52:55]
v_mfma_f32_16x16x32_bf16 v[56:59], v[28:31], a[172:175], v[56:59]
v_mfma_f32_16x16x32_bf16 v[60:63], v[32:35], a[168:171], v[60:63]
v_mfma_f32_16x16x32_bf16 v[64:67], v[32:35], a[172:175], v[64:67]
v_mfma_f32_16x16x32_bf16 v[52:55], v[36:39], a[176:179], v[52:55]
v_mfma_f32_16x16x32_bf16 v[56:59], v[36:39], a[180:183], v[56:59]
v_mfma_f32_16x16x32_bf16 v[60:63], v[40:43], a[176:179], v[60:63]
v_mfma_f32_16x16x32_bf16 v[64:67], v[40:43], a[180:183], v[64:67]
v_mfma_f32_16x16x32_bf16 v[52:55], v[44:47], a[184:187], v[52:55]
v_mfma_f32_16x16x32_bf16 v[56:59], v[44:47], a[188:191], v[56:59]
v_mfma_f32_16x16x32_bf16 v[60:63], v[48:51], a[184:187], v[60:63]
v_mfma_f32_16x16x32_bf16 v[64:67], v[48:51], a[188:191], v[64:67]
s_waitcnt vmcnt(9)
ds_read_b64_tr_b16 a[192:193], v17 offset:0
ds_read_b64_tr_b16 a[194:195], v17 offset:256
ds_read_b64_tr_b16 a[196:197], v17 offset:32
ds_read_b64_tr_b16 a[198:199], v17 offset:288
ds_read_b64_tr_b16 a[200:201], v17 offset:2048
ds_read_b64_tr_b16 a[202:203], v17 offset:2304
ds_read_b64_tr_b16 a[204:205], v17 offset:2080
ds_read_b64_tr_b16 a[206:207], v17 offset:2336
s_waitcnt lgkmcnt(0)
ds_read_b64_tr_b16 a[208:209], v17 offset:4096
ds_read_b64_tr_b16 a[210:211], v17 offset:4352
ds_read_b64_tr_b16 a[212:213], v17 offset:4128
ds_read_b64_tr_b16 a[214:215], v17 offset:4384
ds_read_b64_tr_b16 a[216:217], v17 offset:6144
ds_read_b64_tr_b16 a[218:219], v17 offset:6400
ds_read_b64_tr_b16 a[220:221], v17 offset:6176
ds_read_b64_tr_b16 a[222:223], v17 offset:6432
s_waitcnt lgkmcnt(0)
ds_read_b128 v[20:23], v8 offset:49152
ds_read_b128 v[24:27], v8 offset:51200
ds_read_b128 v[28:31], v9 offset:49152
ds_read_b128 v[32:35], v9 offset:51200
ds_read_b128 v[36:39], v8 offset:53248
ds_read_b128 v[40:43], v8 offset:55296
ds_read_b128 v[44:47], v9 offset:53248
ds_read_b128 v[48:51], v9 offset:55296
s_waitcnt lgkmcnt(0)
v_mfma_f32_16x16x32_bf16 v[52:55], v[20:23], a[192:195], v[52:55]
v_mfma_f32_16x16x32_bf16 v[56:59], v[20:23], a[196:199], v[56:59]
v_mfma_f32_16x16x32_bf16 v[60:63], v[24:27], a[192:195], v[60:63]
v_mfma_f32_16x16x32_bf16 v[64:67], v[24:27], a[196:199], v[64:67]
v_mfma_f32_16x16x32_bf16 v[52:55], v[28:31], a[200:203], v[52:55]
v_mfma_f32_16x16x32_bf16 v[56:59], v[28:31], a[204:207], v[56:59]
v_mfma_f32_16x16x32_bf16 v[60:63], v[32:35], a[200:203], v[60:63]
v_mfma_f32_16x16x32_bf16 v[64:67], v[32:35], a[204:207], v[64:67]
v_mfma_f32_16x16x32_bf16 v[52:55], v[36:39], a[208:211], v[52:55]
v_mfma_f32_16x16x32_bf16 v[56:59], v[36:39], a[212:215], v[56:59]
v_mfma_f32_16x16x32_bf16 v[60:63], v[40:43], a[208:211], v[60:63]
v_mfma_f32_16x16x32_bf16 v[64:67], v[40:43], a[212:215], v[64:67]
v_mfma_f32_16x16x32_bf16 v[52:55], v[44:47], a[216:219], v[52:55]
v_mfma_f32_16x16x32_bf16 v[56:59], v[44:47], a[220:223], v[56:59]
v_mfma_f32_16x16x32_bf16 v[60:63], v[48:51], a[216:219], v[60:63]
v_mfma_f32_16x16x32_bf16 v[64:67], v[48:51], a[220:223], v[64:67]
s_waitcnt vmcnt(0)
ds_read_b64_tr_b16 a[224:225], v17 offset:8192
ds_read_b64_tr_b16 a[226:227], v17 offset:8448
ds_read_b64_tr_b16 a[228:229], v17 offset:8224
ds_read_b64_tr_b16 a[230:231], v17 offset:8480
ds_read_b64_tr_b16 a[232:233], v17 offset:10240
ds_read_b64_tr_b16 a[234:235], v17 offset:10496
ds_read_b64_tr_b16 a[236:237], v17 offset:10272
ds_read_b64_tr_b16 a[238:239], v17 offset:10528
s_waitcnt lgkmcnt(0)
ds_read_b64_tr_b16 a[240:241], v17 offset:12288
ds_read_b64_tr_b16 a[242:243], v17 offset:12544
ds_read_b64_tr_b16 a[244:245], v17 offset:12320
ds_read_b64_tr_b16 a[246:247], v17 offset:12576
ds_read_b64_tr_b16 a[248:249], v17 offset:14336
ds_read_b64_tr_b16 a[250:251], v17 offset:14592
ds_read_b64_tr_b16 a[252:253], v17 offset:14368
ds_read_b64_tr_b16 a[254:255], v17 offset:14624
s_waitcnt lgkmcnt(0)
ds_read_b128 v[20:23], v8 offset:57344
ds_read_b128 v[24:27], v8 offset:59392
ds_read_b128 v[28:31], v9 offset:57344
ds_read_b128 v[32:35], v9 offset:59392
ds_read_b128 v[36:39], v8 offset:61440
ds_read_b128 v[40:43], v8 offset:63488
ds_read_b128 v[44:47], v9 offset:61440
ds_read_b128 v[48:51], v9 offset:63488
s_waitcnt lgkmcnt(0)
v_mfma_f32_16x16x32_bf16 v[52:55], v[20:23], a[224:227], v[52:55]
v_mfma_f32_16x16x32_bf16 v[56:59], v[20:23], a[228:231], v[56:59]
v_mfma_f32_16x16x32_bf16 v[60:63], v[24:27], a[224:227], v[60:63]
v_mfma_f32_16x16x32_bf16 v[64:67], v[24:27], a[228:231], v[64:67]
v_mfma_f32_16x16x32_bf16 v[52:55], v[28:31], a[232:235], v[52:55]
v_mfma_f32_16x16x32_bf16 v[56:59], v[28:31], a[236:239], v[56:59]
v_mfma_f32_16x16x32_bf16 v[60:63], v[32:35], a[232:235], v[60:63]
v_mfma_f32_16x16x32_bf16 v[64:67], v[32:35], a[236:239], v[64:67]
v_mfma_f32_16x16x32_bf16 v[52:55], v[36:39], a[240:243], v[52:55]
v_mfma_f32_16x16x32_bf16 v[56:59], v[36:39], a[244:247], v[56:59]
v_mfma_f32_16x16x32_bf16 v[60:63], v[40:43], a[240:243], v[60:63]
v_mfma_f32_16x16x32_bf16 v[64:67], v[40:43], a[244:247], v[64:67]
v_mfma_f32_16x16x32_bf16 v[52:55], v[44:47], a[248:251], v[52:55]
v_mfma_f32_16x16x32_bf16 v[56:59], v[44:47], a[252:255], v[56:59]
v_mfma_f32_16x16x32_bf16 v[60:63], v[48:51], a[248:251], v[60:63]
v_mfma_f32_16x16x32_bf16 v[64:67], v[48:51], a[252:255], v[64:67]
s_barrier
s_mov_b32 s50, 0x10000
s_add_u32 m0, s46, 65536
s_nop 0
buffer_load_dwordx4 v6, s[8:11], s50 offen offset:0 lds
s_add_u32 m0, s46, 69504
s_nop 0
buffer_load_dwordx4 v6, s[8:11], s50 offen offset:128 lds
s_add_u32 m0, s46, 73472
s_nop 0
buffer_load_dwordx4 v6, s[8:11], s50 offen offset:256 lds
s_add_u32 m0, s46, 77440
s_nop 0
buffer_load_dwordx4 v6, s[8:11], s50 offen offset:384 lds
s_add_u32 m0, s46, 81408
s_nop 0
buffer_load_dwordx4 v6, s[8:11], s50 offen offset:512 lds
s_add_u32 m0, s46, 85376
s_nop 0
buffer_load_dwordx4 v6, s[8:11], s50 offen offset:640 lds
s_add_u32 m0, s46, 89344
s_nop 0
buffer_load_dwordx4 v6, s[8:11], s50 offen offset:768 lds
s_add_u32 m0, s46, 93312
s_nop 0
buffer_load_dwordx4 v6, s[8:11], s50 offen offset:896 lds
s_add_u32 m0, s46, 97280
s_nop 0
buffer_load_dwordx4 v6, s[8:11], s50 offen offset:1024 lds
s_add_u32 m0, s46, 101248
s_nop 0
buffer_load_dwordx4 v6, s[8:11], s50 offen offset:1152 lds
s_add_u32 m0, s46, 105216
s_nop 0
buffer_load_dwordx4 v6, s[8:11], s50 offen offset:1280 lds
s_add_u32 m0, s46, 109184
s_nop 0
buffer_load_dwordx4 v6, s[8:11], s50 offen offset:1408 lds
s_add_u32 m0, s46, 113152
s_nop 0
buffer_load_dwordx4 v6, s[8:11], s50 offen offset:1536 lds
s_add_u32 m0, s46, 117120
s_nop 0
buffer_load_dwordx4 v6, s[8:11], s50 offen offset:1664 lds
s_add_u32 m0, s46, 121088
s_nop 0
buffer_load_dwordx4 v6, s[8:11], s50 offen offset:1792 lds
s_add_u32 m0, s46, 125056
s_nop 0
buffer_load_dwordx4 v6, s[8:11], s50 offen offset:1920 lds
s_and_b32 s53, s47, 31
s_lshl_b32 s53, s53, 4
v_add_u32 v19, s53, v1
v_lshlrev_b32 v19, 7, v19
s_mov_b32 s42, 1
v_and_b32 v3, 15, v0
v_lshlrev_b32 v3, 4, v3
s_branch mega_kernel_syv
mega_kernel_syvw:
s_sleep 4
mega_kernel_syv:
buffer_load_dword v2, v3, s[72:75], 0 offen sc1
s_waitcnt vmcnt(0)
s_cmp_eq_u32 s95, 1
s_cbranch_scc0 mega_kernel_syvf
v_readlane_b32 s76, v2, 14
s_mov_b32 s98, 0
s_cmp_eq_u32 s76, 64
s_cbranch_scc0 mega_kernel_syvw
s_branch mega_kernel_syvd
mega_kernel_syvf:
s_mov_b32 s77, 0
s_mov_b32 s78, 0
v_readlane_b32 s76, v2, 0
s_add_u32 s77, s77, s76
s_xor_b32 s76, s76, 32
s_or_b32 s78, s78, s76
v_readlane_b32 s76, v2, 1
s_add_u32 s77, s77, s76
s_xor_b32 s76, s76, 32
s_or_b32 s78, s78, s76
v_readlane_b32 s76, v2, 2
s_add_u32 s77, s77, s76
s_xor_b32 s76, s76, 32
s_or_b32 s78, s78, s76
v_readlane_b32 s76, v2, 3
s_add_u32 s77, s77, s76
s_xor_b32 s76, s76, 32
s_or_b32 s78, s78, s76
v_readlane_b32 s76, v2, 4
s_add_u32 s77, s77, s76
s_xor_b32 s76, s76, 32
s_or_b32 s78, s78, s76
v_readlane_b32 s76, v2, 5
s_add_u32 s77, s77, s76
s_xor_b32 s76, s76, 32
s_or_b32 s78, s78, s76
v_readlane_b32 s76, v2, 6
s_add_u32 s77, s77, s76
s_xor_b32 s76, s76, 32
s_or_b32 s78, s78, s76
v_readlane_b32 s76, v2, 7
s_add_u32 s77, s77, s76
s_xor_b32 s76, s76, 32
s_or_b32 s78, s78, s76
s_cmp_eq_u32 s77, 256
s_cbranch_scc0 mega_kernel_syvw
v_mov_b32 v252, v2
s_cmp_eq_u32 s78, 0
s_cbranch_scc0 mega_kernel_slowent
v_readlane_b32 s76, v2, 10
v_readlane_b32 s77, v2, 8
s_cmp_eq_u32 s76, 64
s_cbranch_scc0 mega_kernel_syvw
s_cmp_gt_u32 s77, 32
s_cselect_b32 s98, 1, 0
mega_kernel_syvd:
s_lshr_b32 s44, s47, 3
s_xor_b32 s44, s44, s98
s_and_b32 s44, s44, 1
s_lshl_b32 s44, s44, 13
s_lshl_b32 s48, s47, 18
s_add_u32 s48, s48, s44
s_add_u32 s48, s48, 33554432
s_xor_b32 s44, s98, 1
s_lshl_b32 s44, s44, 13
s_lshl_b32 s49, s40, 7
s_add_u32 s49, s49, s44
s_lshl_b32 s44, s41, 2
s_add_u32 s49, s49, s44
s_add_u32 s49, s49, 69210112
v_mov_b32 v16, 0
v_cvt_pk_bf16_f32 v84, v52, v53
v_cvt_pk_bf16_f32 v85, v54, v55
v_cvt_pk_bf16_f32 v86, v60, v61
v_cvt_pk_bf16_f32 v87, v62, v63
v_cvt_pk_bf16_f32 v88, v56, v57
v_cvt_pk_bf16_f32 v89, v58, v59
v_cvt_pk_bf16_f32 v90, v64, v65
v_cvt_pk_bf16_f32 v91, v66, v67
s_add_u32 s51, s42, s47
s_sub_u32 s51, s51, 1
s_bfe_u32 s52, s51, 0x40002
s_lshl_b32 s52, s52, 14
s_and_b32 s51, s51, 3
s_lshl_b32 s51, s51, 11
s_add_u32 s51, s51, s52
s_add_u32 s51, s51, s48
buffer_store_dwordx4 v[84:87], v7, s[84:87], s51 offen sc1
buffer_store_dwordx4 v[88:91], v7, s[84:87], s51 offen offset:1024 sc1
s_waitcnt vmcnt(0)
v_mov_b32 v17, s42
s_mov_b64 exec, 1
buffer_store_dword v17, v16, s[84:87], s49 offen sc1
s_mov_b64 exec, -1
mega_kernel_v_loop:
s_waitcnt vmcnt(2)
s_barrier
s_add_u32 s50, s42, 1
s_min_u32 s50, s50, 63
s_lshl_b32 s50, s50, 16
ds_read_b128 v[20:23], v10 offset:0
ds_read_b128 v[24:27], v10 offset:2048
ds_read_b128 v[28:31], v11 offset:0
ds_read_b128 v[32:35], v11 offset:2048
ds_read_b128 v[36:39], v10 offset:4096
ds_read_b128 v[40:43], v10 offset:6144
s_waitcnt lgkmcnt(4)
v_mfma_f32_16x16x32_bf16 v[68:71], v[20:23], a[0:3], 0
ds_read_b128 v[44:47], v11 offset:4096
v_mfma_f32_16x16x32_bf16 v[72:75], v[20:23], a[4:7], 0
v_cvt_pk_bf16_f32 v84, v52, v53
v_cvt_pk_bf16_f32 v85, v54, v55
v_cvt_pk_bf16_f32 v86, v60, v61
v_mfma_f32_16x16x32_bf16 v[76:79], v[24:27], a[0:3], 0
ds_read_b128 v[48:51], v11 offset:6144
v_mfma_f32_16x16x32_bf16 v[80:83], v[24:27], a[4:7], 0
v_cvt_pk_bf16_f32 v87, v62, v63
v_cvt_pk_bf16_f32 v88, v56, v57
v_cvt_pk_bf16_f32 v89, v58, v59
s_waitcnt lgkmcnt(4)
v_mfma_f32_16x16x32_bf16 v[68:71], v[28:31], a[8:11], v[68:71]
ds_read_b128 v[20:23], v10 offset:8192
v_mfma_f32_16x16x32_bf16 v[72:75], v[28:31], a[12:15], v[72:75]
v_cvt_pk_bf16_f32 v90, v64, v65
v_cvt_pk_bf16_f32 v91, v66, v67
v_mfma_f32_16x16x32_bf16 v[76:79], v[32:35], a[8:11], v[76:79]
ds_read_b128 v[24:27], v10 offset:10240
v_mfma_f32_16x16x32_bf16 v[80:83], v[32:35], a[12:15], v[80:83]
s_add_u32 s51, s42, s47
s_sub_u32 s51, s51, 1
s_bfe_u32 s52, s51, 0x40002
s_lshl_b32 s52, s52, 14
s_waitcnt lgkmcnt(4)
v_mfma_f32_16x16x32_bf16 v[68:71], v[36:39], a[16:19], v[68:71]
ds_read_b128 v[28:31], v11 offset:8192
v_mfma_f32_16x16x32_bf16 v[72:75], v[36:39], a[20:23], v[72:75]
s_and_b32 s51, s51, 3
s_lshl_b32 s51, s51, 11
s_add_u32 s51, s51, s52
s_add_u32 s51, s51, s48
buffer_store_dwordx4 v[84:87], v7, s[84:87], s51 offen sc1
v_mfma_f32_16x16x32_bf16 v[76:79], v[40:43], a[16:19], v[76:79]
ds_read_b128 v[32:35], v11 offset:10240
v_mfma_f32_16x16x32_bf16 v[80:83], v[40:43], a[20:23], v[80:83]
buffer_store_dwordx4 v[88:91], v7, s[84:87], s51 offen offset:1024 sc1
s_waitcnt lgkmcnt(4)
v_mfma_f32_16x16x32_bf16 v[68:71], v[44:47], a[24:27], v[68:71]
ds_read_b128 v[36:39], v10 offset:12288
v_mfma_f32_16x16x32_bf16 v[72:75], v[44:47], a[28:31], v[72:75]
s_add_u32 m0, s46, 0
v_mfma_f32_16x16x32_bf16 v[76:79], v[48:51], a[24:27], v[76:79]
ds_read_b128 v[40:43], v10 offset:14336
v_mfma_f32_16x16x32_bf16 v[80:83], v[48:51], a[28:31], v[80:83]
buffer_load_dwordx4 v6, s[8:11], s50 offen offset:0 lds
s_waitcnt lgkmcnt(4)
v_mfma_f32_16x16x32_bf16 v[68:71], v[20:23], a[32:35], v[68:71]
ds_read_b128 v[44:47], v11 offset:12288
v_mfma_f32_16x16x32_bf16 v[72:75], v[20:23], a[36:39], v[72:75]
s_add_u32 m0, s46, 3968
v_mfma_f32_16x16x32_bf16 v[76:79], v[24:27], a[32:35], v[76:79]
ds_read_b128 v[48:51], v11 offset:14336
v_mfma_f32_16x16x32_bf16 v[80:83], v[24:27], a[36:39], v[80:83]
buffer_load_dwordx4 v6, s[8:11], s50 offen offset:128 lds
s_waitcnt lgkmcnt(4)
v_mfma_f32_16x16x32_bf16 v[68:71], v[28:31], a[40:43], v[68:71]
ds_read_b128 v[20:23], v10 offset:16384
v_mfma_f32_16x16x32_bf16 v[72:75], v[28:31], a[44:47], v[72:75]
s_add_u32 m0, s46, 7936
v_mfma_f32_16x16x32_bf16 v[76:79], v[32:35], a[40:43], v[76:79]
ds_read_b128 v[24:27], v10 offset:18432
v_mfma_f32_16x16x32_bf16 v[80:83], v[32:35], a[44:47], v[80:83]
buffer_load_dwordx4 v6, s[8:11], s50 offen offset:256 lds
s_waitcnt lgkmcnt(4)
v_mfma_f32_16x16x32_bf16 v[68:71], v[36:39], a[48:51], v[68:71]
ds_read_b128 v[28:31], v11 offset:16384
v_mfma_f32_16x16x32_bf16 v[72:75], v[36:39], a[52:55], v[72:75]
s_add_u32 m0, s46, 11904
v_mfma_f32_16x16x32_bf16 v[76:79], v[40:43], a[48:51], v[76:79]
ds_read_b128 v[32:35], v11 offset:18432
v_mfma_f32_16x16x32_bf16 v[80:83], v[40:43], a[52:55], v[80:83]
buffer_load_dwordx4 v6, s[8:11], s50 offen offset:384 lds
s_waitcnt lgkmcnt(4)
v_mfma_f32_16x16x32_bf16 v[68:71], v[44:47], a[56:59], v[68:71]
ds_read_b128 v[36:39], v10 offset:20480
v_mfma_f32_16x16x32_bf16 v[72:75], v[44:47], a[60:63], v[72:75]
s_add_u32 m0, s46, 15872
v_mfma_f32_16x16x32_bf16 v[76:79], v[48:51], a[56:59], v[76:79]
ds_read_b128 v[40:43], v10 offset:22528
v_mfma_f32_16x16x32_bf16 v[80:83], v[48:51], a[60:63], v[80:83]
buffer_load_dwordx4 v6, s[8:11], s50 offen offset:512 lds
s_waitcnt lgkmcnt(4)
v_mfma_f32_16x16x32_bf16 v[68:71], v[20:23], a[64:67], v[68:71]
ds_read_b128 v[44:47], v11 offset:20480
v_mfma_f32_16x16x32_bf16 v[72:75], v[20:23], a[68:71], v[72:75]
s_add_u32 m0, s46, 19840
v_mfma_f32_16x16x32_bf16 v[76:79], v[24:27], a[64:67], v[76:79]
ds_read_b128 v[48:51], v11 offset:22528
v_mfma_f32_16x16x32_bf16 v[80:83], v[24:27], a[68:71], v[80:83]
buffer_load_dwordx4 v6, s[8:11], s50 offen offset:640 lds
s_waitcnt lgkmcnt(4)
v_mfma_f32_16x16x32_bf16 v[68:71], v[28:31], a[72:75], v[68:71]
ds_read_b128 v[20:23], v10 offset:24576
v_mfma_f32_16x16x32_bf16 v[72:75], v[28:31], a[76:79], v[72:75]
s_add_u32 m0, s46, 23808
v_mfma_f32_16x16x32_bf16 v[76:79], v[32:35], a[72:75], v[76:79]
ds_read_b128 v[24:27], v10 offset:26624
v_mfma_f32_16x16x32_bf16 v[80:83], v[32:35], a[76:79], v[80:83]
buffer_load_dwordx4 v6, s[8:11], s50 offen offset:768 lds
s_waitcnt lgkmcnt(4)
v_mfma_f32_16x16x32_bf16 v[68:71], v[36:39], a[80:83], v[68:71]
ds_read_b128 v[28:31], v11 offset:24576
v_mfma_f32_16x16x32_bf16 v[72:75], v[36:39], a[84:87], v[72:75]
s_add_u32 m0, s46, 27776
v_mfma_f32_16x16x32_bf16 v[76:79], v[40:43], a[80:83], v[76:79]
ds_read_b128 v[32:35], v11 offset:26624
v_mfma_f32_16x16x32_bf16 v[80:83], v[40:43], a[84:87], v[80:83]
buffer_load_dwordx4 v6, s[8:11], s50 offen offset:896 lds
s_waitcnt lgkmcnt(4)
v_mfma_f32_16x16x32_bf16 v[68:71], v[44:47], a[88:91], v[68:71]
ds_read_b128 v[36:39], v10 offset:28672
v_mfma_f32_16x16x32_bf16 v[72:75], v[44:47], a[92:95], v[72:75]
s_add_u32 m0, s46, 31744
v_mfma_f32_16x16x32_bf16 v[76:79], v[48:51], a[88:91], v[76:79]
ds_read_b128 v[40:43], v10 offset:30720
v_mfma_f32_16x16x32_bf16 v[80:83], v[48:51], a[92:95], v[80:83]
buffer_load_dwordx4 v6, s[8:11], s50 offen offset:1024 lds
s_waitcnt lgkmcnt(4)
v_mfma_f32_16x16x32_bf16 v[68:71], v[20:23], a[96:99], v[68:71]
ds_read_b128 v[44:47], v11 offset:28672
v_mfma_f32_16x16x32_bf16 v[72:75], v[20:23], a[100:103], v[72:75]
s_add_u32 m0, s46, 35712
v_mfma_f32_16x16x32_bf16 v[76:79], v[24:27], a[96:99], v[76:79]
ds_read_b128 v[48:51], v11 offset:30720
v_mfma_f32_16x16x32_bf16 v[80:83], v[24:27], a[100:103], v[80:83]
buffer_load_dwordx4 v6, s[8:11], s50 offen offset:1152 lds
s_waitcnt lgkmcnt(4)
v_mfma_f32_16x16x32_bf16 v[68:71], v[28:31], a[104:107], v[68:71]
ds_read_b128 v[20:23], v10 offset:32768
v_mfma_f32_16x16x32_bf16 v[72:75], v[28:31], a[108:111], v[72:75]
s_add_u32 m0, s46, 39680
v_mfma_f32_16x16x32_bf16 v[76:79], v[32:35], a[104:107], v[76:79]
ds_read_b128 v[24:27], v10 offset:34816
v_mfma_f32_16x16x32_bf16 v[80:83], v[32:35], a[108:111], v[80:83]
buffer_load_dwordx4 v6, s[8:11], s50 offen offset:1280 lds
s_waitcnt lgkmcnt(4)
v_mfma_f32_16x16x32_bf16 v[68:71], v[36:39], a[112:115], v[68:71]
ds_read_b128 v[28:31], v11 offset:32768
v_mfma_f32_16x16x32_bf16 v[72:75], v[36:39], a[116:119], v[72:75]
s_add_u32 m0, s46, 43648
v_mfma_f32_16x16x32_bf16 v[76:79], v[40:43], a[112:115], v[76:79]
ds_read_b128 v[32:35], v11 offset:34816
v_mfma_f32_16x16x32_bf16 v[80:83], v[40:43], a[116:119], v[80:83]
buffer_load_dwordx4 v6, s[8:11], s50 offen offset:1408 lds
s_waitcnt lgkmcnt(4)
v_mfma_f32_16x16x32_bf16 v[68:71], v[44:47], a[120:123], v[68:71]
ds_read_b128 v[36:39], v10 offset:36864
v_mfma_f32_16x16x32_bf16 v[72:75], v[44:47], a[124:127], v[72:75]
s_add_u32 m0, s46, 47616
v_mfma_f32_16x16x32_bf16 v[76:79], v[48:51], a[120:123], v[76:79]
ds_read_b128 v[40:43], v10 offset:38912
v_mfma_f32_16x16x32_bf16 v[80:83], v[48:51], a[124:127], v[80:83]
buffer_load_dwordx4 v6, s[8:11], s50 offen offset:1536 lds
s_waitcnt lgkmcnt(4)
v_mfma_f32_16x16x32_bf16 v[68:71], v[20:23], a[128:131], v[68:71]
ds_read_b128 v[44:47], v11 offset:36864
v_mfma_f32_16x16x32_bf16 v[72:75], v[20:23], a[132:135], v[72:75]
s_add_u32 m0, s46, 51584
v_mfma_f32_16x16x32_bf16 v[76:79], v[24:27], a[128:131], v[76:79]
ds_read_b128 v[48:51], v11 offset:38912
v_mfma_f32_16x16x32_bf16 v[80:83], v[24:27], a[132:135], v[80:83]
buffer_load_dwordx4 v6, s[8:11], s50 offen offset:1664 lds
s_waitcnt lgkmcnt(4)
v_mfma_f32_16x16x32_bf16 v[68:71], v[28:31], a[136:139], v[68:71]
ds_read_b128 v[20:23], v10 offset:40960
v_mfma_f32_16x16x32_bf16 v[72:75], v[28:31], a[140:143], v[72:75]
s_add_u32 m0, s46, 55552
v_mfma_f32_16x16x32_bf16 v[76:79], v[32:35], a[136:139], v[76:79]
ds_read_b128 v[24:27], v10 offset:43008
v_mfma_f32_16x16x32_bf16 v[80:83], v[32:35], a[140:143], v[80:83]
buffer_load_dwordx4 v6, s[8:11], s50 offen offset:1792 lds
s_waitcnt lgkmcnt(4)
v_mfma_f32_16x16x32_bf16 v[68:71], v[36:39], a[144:147], v[68:71]
ds_read_b128 v[28:31], v11 offset:40960
v_mfma_f32_16x16x32_bf16 v[72:75], v[36:39], a[148:151], v[72:75]
s_add_u32 m0, s46, 59520
v_mfma_f32_16x16x32_bf16 v[76:79], v[40:43], a[144:147], v[76:79]
ds_read_b128 v[32:35], v11 offset:43008
v_mfma_f32_16x16x32_bf16 v[80:83], v[40:43], a[148:151], v[80:83]
buffer_load_dwordx4 v6, s[8:11], s50 offen offset:1920 lds
s_waitcnt lgkmcnt(4)
v_mfma_f32_16x16x32_bf16 v[68:71], v[44:47], a[152:155], v[68:71]
ds_read_b128 v[36:39], v10 offset:45056
v_mfma_f32_16x16x32_bf16 v[72:75], v[44:47], a[156:159], v[72:75]
v_mfma_f32_16x16x32_bf16 v[76:79], v[48:51], a[152:155], v[76:79]
ds_read_b128 v[40:43], v10 offset:47104
v_mfma_f32_16x16x32_bf16 v[80:83], v[48:51], a[156:159], v[80:83]
s_waitcnt lgkmcnt(4)
v_mfma_f32_16x16x32_bf16 v[68:71], v[20:23], a[160:163], v[68:71]
ds_read_b128 v[44:47], v11 offset:45056
v_mfma_f32_16x16x32_bf16 v[72:75], v[20:23], a[164:167], v[72:75]
v_mfma_f32_16x16x32_bf16 v[76:79], v[24:27], a[160:163], v[76:79]
ds_read_b128 v[48:51], v11 offset:47104
v_mfma_f32_16x16x32_bf16 v[80:83], v[24:27], a[164:167], v[80:83]
s_waitcnt lgkmcnt(4)
v_mfma_f32_16x16x32_bf16 v[68:71], v[28:31], a[168:171], v[68:71]
ds_read_b128 v[20:23], v10 offset:49152
v_mfma_f32_16x16x32_bf16 v[72:75], v[28:31], a[172:175], v[72:75]
s_waitcnt vmcnt(16)
v_mov_b32 v17, s42
s_mov_b64 exec, 1
buffer_store_dword v17, v16, s[84:87], s49 offen sc1
s_mov_b64 exec, -1
v_mfma_f32_16x16x32_bf16 v[76:79], v[32:35], a[168:171], v[76:79]
ds_read_b128 v[24:27], v10 offset:51200
v_mfma_f32_16x16x32_bf16 v[80:83], v[32:35], a[172:175], v[80:83]
s_waitcnt lgkmcnt(4)
v_mfma_f32_16x16x32_bf16 v[68:71], v[36:39], a[176:179], v[68:71]
ds_read_b128 v[28:31], v11 offset:49152
v_mfma_f32_16x16x32_bf16 v[72:75], v[36:39], a[180:183], v[72:75]
s_add_u32 s53, s42, 3
s_min_u32 s53, s53, 63
s_lshl_b32 s53, s53, 16
s_mov_b64 exec, 0xffff
buffer_load_dword v250, v19, s[8:11], s53 offen
s_mov_b64 exec, -1
v_mfma_f32_16x16x32_bf16 v[76:79], v[40:43], a[176:179], v[76:79]
ds_read_b128 v[32:35], v11 offset:51200
v_mfma_f32_16x16x32_bf16 v[80:83], v[40:43], a[180:183], v[80:83]
s_waitcnt lgkmcnt(4)
v_mfma_f32_16x16x32_bf16 v[68:71], v[44:47], a[184:187], v[68:71]
ds_read_b128 v[36:39], v10 offset:53248
v_mfma_f32_16x16x32_bf16 v[72:75], v[44:47], a[188:191], v[72:75]
v_mfma_f32_16x16x32_bf16 v[76:79], v[48:51], a[184:187], v[76:79]
ds_read_b128 v[40:43], v10 offset:55296
v_mfma_f32_16x16x32_bf16 v[80:83], v[48:51], a[188:191], v[80:83]
s_waitcnt lgkmcnt(4)
v_mfma_f32_16x16x32_bf16 v[68:71], v[20:23], a[192:195], v[68:71]
ds_read_b128 v[44:47], v11 offset:53248
v_mfma_f32_16x16x32_bf16 v[72:75], v[20:23], a[196:199], v[72:75]
v_mfma_f32_16x16x32_bf16 v[76:79], v[24:27], a[192:195], v[76:79]
ds_read_b128 v[48:51], v11 offset:55296
v_mfma_f32_16x16x32_bf16 v[80:83], v[24:27], a[196:199], v[80:83]
s_waitcnt lgkmcnt(4)
v_mfma_f32_16x16x32_bf16 v[68:71], v[28:31], a[200:203], v[68:71]
ds_read_b128 v[20:23], v10 offset:57344
v_mfma_f32_16x16x32_bf16 v[72:75], v[28:31], a[204:207], v[72:75]
v_mfma_f32_16x16x32_bf16 v[76:79], v[32:35], a[200:203], v[76:79]
ds_read_b128 v[24:27], v10 offset:59392
v_mfma_f32_16x16x32_bf16 v[80:83], v[32:35], a[204:207], v[80:83]
s_waitcnt lgkmcnt(4)
v_mfma_f32_16x16x32_bf16 v[68:71], v[36:39], a[208:211], v[68:71]
ds_read_b128 v[28:31], v11 offset:57344
v_mfma_f32_16x16x32_bf16 v[72:75], v[36:39], a[212:215], v[72:75]
v_mfma_f32_16x16x32_bf16 v[76:79], v[40:43], a[208:211], v[76:79]
ds_read_b128 v[32:35], v11 offset:59392
v_mfma_f32_16x16x32_bf16 v[80:83], v[40:43], a[212:215], v[80:83]
s_waitcnt lgkmcnt(4)
v_mfma_f32_16x16x32_bf16 v[68:71], v[44:47], a[216:219], v[68:71]
ds_read_b128 v[36:39], v10 offset:61440
v_mfma_f32_16x16x32_bf16 v[72:75], v[44:47], a[220:223], v[72:75]
v_mfma_f32_16x16x32_bf16 v[76:79], v[48:51], a[216:219], v[76:79]
ds_read_b128 v[40:43], v10 offset:63488
v_mfma_f32_16x16x32_bf16 v[80:83], v[48:51], a[220:223], v[80:83]
s_waitcnt lgkmcnt(4)
v_mfma_f32_16x16x32_bf16 v[68:71], v[20:23], a[224:227], v[68:71]
ds_read_b128 v[44:47], v11 offset:61440
v_mfma_f32_16x16x32_bf16 v[72:75], v[20:23], a[228:231], v[72:75]
v_mfma_f32_16x16x32_bf16 v[76:79], v[24:27], a[224:227], v[76:79]
ds_read_b128 v[48:51], v11 offset:63488
v_mfma_f32_16x16x32_bf16 v[80:83], v[24:27], a[228:231], v[80:83]
s_waitcnt lgkmcnt(5)
v_mfma_f32_16x16x32_bf16 v[68:71], v[28:31], a[232:235], v[68:71]
v_mfma_f32_16x16x32_bf16 v[72:75], v[28:31], a[236:239], v[72:75]
s_waitcnt lgkmcnt(4)
v_mfma_f32_16x16x32_bf16 v[76:79], v[32:35], a[232:235], v[76:79]
v_mfma_f32_16x16x32_bf16 v[80:83], v[32:35], a[236:239], v[80:83]
s_waitcnt lgkmcnt(3)
v_mfma_f32_16x16x32_bf16 v[68:71], v[36:39], a[240:243], v[68:71]
v_mfma_f32_16x16x32_bf16 v[72:75], v[36:39], a[244:247], v[72:75]
s_waitcnt lgkmcnt(2)
v_mfma_f32_16x16x32_bf16 v[76:79], v[40:43], a[240:243], v[76:79]
v_mfma_f32_16x16x32_bf16 v[80:83], v[40:43], a[244:247], v[80:83]
s_waitcnt lgkmcnt(1)
v_mfma_f32_16x16x32_bf16 v[68:71], v[44:47], a[248:251], v[68:71]
v_mfma_f32_16x16x32_bf16 v[72:75], v[44:47], a[252:255], v[72:75]
s_waitcnt lgkmcnt(0)
v_mfma_f32_16x16x32_bf16 v[76:79], v[48:51], a[248:251], v[76:79]
v_mfma_f32_16x16x32_bf16 v[80:83], v[48:51], a[252:255], v[80:83]
s_add_u32 s42, s42, 1
s_cmp_eq_u32 s42, 64
s_cbranch_scc1 mega_kernel_v_fin
s_waitcnt vmcnt(2)
s_barrier
s_add_u32 s50, s42, 1
s_min_u32 s50, s50, 63
s_lshl_b32 s50, s50, 16
ds_read_b128 v[20:23], v8 offset:0
ds_read_b128 v[24:27], v8 offset:2048
ds_read_b128 v[28:31], v9 offset:0
ds_read_b128 v[32:35], v9 offset:2048
ds_read_b128 v[36:39], v8 offset:4096
ds_read_b128 v[40:43], v8 offset:6144
s_waitcnt lgkmcnt(4)
v_mfma_f32_16x16x32_bf16 v[52:55], v[20:23], a[0:3], 0
ds_read_b128 v[44:47], v9 offset:4096
v_mfma_f32_16x16x32_bf16 v[56:59], v[20:23], a[4:7], 0
v_cvt_pk_bf16_f32 v84, v68, v69
v_cvt_pk_bf16_f32 v85, v70, v71
v_cvt_pk_bf16_f32 v86, v76, v77
v_mfma_f32_16x16x32_bf16 v[60:63], v[24:27], a[0:3], 0
ds_read_b128 v[48:51], v9 offset:6144
v_mfma_f32_16x16x32_bf16 v[64:67], v[24:27], a[4:7], 0
v_cvt_pk_bf16_f32 v87, v78, v79
v_cvt_pk_bf16_f32 v88, v72, v73
v_cvt_pk_bf16_f32 v89, v74, v75
s_waitcnt lgkmcnt(4)
v_mfma_f32_16x16x32_bf16 v[52:55], v[28:31], a[8:11], v[52:55]
ds_read_b128 v[20:23], v8 offset:8192
v_mfma_f32_16x16x32_bf16 v[56:59], v[28:31], a[12:15], v[56:59]
v_cvt_pk_bf16_f32 v90, v80, v81
v_cvt_pk_bf16_f32 v91, v82, v83
v_mfma_f32_16x16x32_bf16 v[60:63], v[32:35], a[8:11], v[60:63]
ds_read_b128 v[24:27], v8 offset:10240
v_mfma_f32_16x16x32_bf16 v[64:67], v[32:35], a[12:15], v[64:67]
s_add_u32 s51, s42, s47
s_sub_u32 s51, s51, 1
s_bfe_u32 s52, s51, 0x40002
s_lshl_b32 s52, s52, 14
s_waitcnt lgkmcnt(4)
v_mfma_f32_16x16x32_bf16 v[52:55], v[36:39], a[16:19], v[52:55]
ds_read_b128 v[28:31], v9 offset:8192
v_mfma_f32_16x16x32_bf16 v[56:59], v[36:39], a[20:23], v[56:59]
s_and_b32 s51, s51, 3
s_lshl_b32 s51, s51, 11
s_add_u32 s51, s51, s52
s_add_u32 s51, s51, s48
buffer_store_dwordx4 v[84:87], v7, s[84:87], s51 offen sc1
v_mfma_f32_16x16x32_bf16 v[60:63], v[40:43], a[16:19], v[60:63]
ds_read_b128 v[32:35], v9 offset:10240
v_mfma_f32_16x16x32_bf16 v[64:67], v[40:43], a[20:23], v[64:67]
buffer_store_dwordx4 v[88:91], v7, s[84:87], s51 offen offset:1024 sc1
s_waitcnt lgkmcnt(4)
v_mfma_f32_16x16x32_bf16 v[52:55], v[44:47], a[24:27], v[52:55]
ds_read_b128 v[36:39], v8 offset:12288
v_mfma_f32_16x16x32_bf16 v[56:59], v[44:47], a[28:31], v[56:59]
s_add_u32 m0, s46, 65536
v_mfma_f32_16x16x32_bf16 v[60:63], v[48:51], a[24:27], v[60:63]
ds_read_b128 v[40:43], v8 offset:14336
v_mfma_f32_16x16x32_bf16 v[64:67], v[48:51], a[28:31], v[64:67]
buffer_load_dwordx4 v6, s[8:11], s50 offen offset:0 lds
s_waitcnt lgkmcnt(4)
v_mfma_f32_16x16x32_bf16 v[52:55], v[20:23], a[32:35], v[52:55]
ds_read_b128 v[44:47], v9 offset:12288
v_mfma_f32_16x16x32_bf16 v[56:59], v[20:23], a[36:39], v[56:59]
s_add_u32 m0, s46, 69504
v_mfma_f32_16x16x32_bf16 v[60:63], v[24:27], a[32:35], v[60:63]
ds_read_b128 v[48:51], v9 offset:14336
v_mfma_f32_16x16x32_bf16 v[64:67], v[24:27], a[36:39], v[64:67]
buffer_load_dwordx4 v6, s[8:11], s50 offen offset:128 lds
s_waitcnt lgkmcnt(4)
v_mfma_f32_16x16x32_bf16 v[52:55], v[28:31], a[40:43], v[52:55]
ds_read_b128 v[20:23], v8 offset:16384
v_mfma_f32_16x16x32_bf16 v[56:59], v[28:31], a[44:47], v[56:59]
s_add_u32 m0, s46, 73472
v_mfma_f32_16x16x32_bf16 v[60:63], v[32:35], a[40:43], v[60:63]
ds_read_b128 v[24:27], v8 offset:18432
v_mfma_f32_16x16x32_bf16 v[64:67], v[32:35], a[44:47], v[64:67]
buffer_load_dwordx4 v6, s[8:11], s50 offen offset:256 lds
s_waitcnt lgkmcnt(4)
v_mfma_f32_16x16x32_bf16 v[52:55], v[36:39], a[48:51], v[52:55]
ds_read_b128 v[28:31], v9 offset:16384
v_mfma_f32_16x16x32_bf16 v[56:59], v[36:39], a[52:55], v[56:59]
s_add_u32 m0, s46, 77440
v_mfma_f32_16x16x32_bf16 v[60:63], v[40:43], a[48:51], v[60:63]
ds_read_b128 v[32:35], v9 offset:18432
v_mfma_f32_16x16x32_bf16 v[64:67], v[40:43], a[52:55], v[64:67]
buffer_load_dwordx4 v6, s[8:11], s50 offen offset:384 lds
s_waitcnt lgkmcnt(4)
v_mfma_f32_16x16x32_bf16 v[52:55], v[44:47], a[56:59], v[52:55]
ds_read_b128 v[36:39], v8 offset:20480
v_mfma_f32_16x16x32_bf16 v[56:59], v[44:47], a[60:63], v[56:59]
s_add_u32 m0, s46, 81408
v_mfma_f32_16x16x32_bf16 v[60:63], v[48:51], a[56:59], v[60:63]
ds_read_b128 v[40:43], v8 offset:22528
v_mfma_f32_16x16x32_bf16 v[64:67], v[48:51], a[60:63], v[64:67]
buffer_load_dwordx4 v6, s[8:11], s50 offen offset:512 lds
s_waitcnt lgkmcnt(4)
v_mfma_f32_16x16x32_bf16 v[52:55], v[20:23], a[64:67], v[52:55]
ds_read_b128 v[44:47], v9 offset:20480
v_mfma_f32_16x16x32_bf16 v[56:59], v[20:23], a[68:71], v[56:59]
s_add_u32 m0, s46, 85376
v_mfma_f32_16x16x32_bf16 v[60:63], v[24:27], a[64:67], v[60:63]
ds_read_b128 v[48:51], v9 offset:22528
v_mfma_f32_16x16x32_bf16 v[64:67], v[24:27], a[68:71], v[64:67]
buffer_load_dwordx4 v6, s[8:11], s50 offen offset:640 lds
s_waitcnt lgkmcnt(4)
v_mfma_f32_16x16x32_bf16 v[52:55], v[28:31], a[72:75], v[52:55]
ds_read_b128 v[20:23], v8 offset:24576
v_mfma_f32_16x16x32_bf16 v[56:59], v[28:31], a[76:79], v[56:59]
s_add_u32 m0, s46, 89344
v_mfma_f32_16x16x32_bf16 v[60:63], v[32:35], a[72:75], v[60:63]
ds_read_b128 v[24:27], v8 offset:26624
v_mfma_f32_16x16x32_bf16 v[64:67], v[32:35], a[76:79], v[64:67]
buffer_load_dwordx4 v6, s[8:11], s50 offen offset:768 lds
s_waitcnt lgkmcnt(4)
v_mfma_f32_16x16x32_bf16 v[52:55], v[36:39], a[80:83], v[52:55]
ds_read_b128 v[28:31], v9 offset:24576
v_mfma_f32_16x16x32_bf16 v[56:59], v[36:39], a[84:87], v[56:59]
s_add_u32 m0, s46, 93312
v_mfma_f32_16x16x32_bf16 v[60:63], v[40:43], a[80:83], v[60:63]
ds_read_b128 v[32:35], v9 offset:26624
v_mfma_f32_16x16x32_bf16 v[64:67], v[40:43], a[84:87], v[64:67]
buffer_load_dwordx4 v6, s[8:11], s50 offen offset:896 lds
s_waitcnt lgkmcnt(4)
v_mfma_f32_16x16x32_bf16 v[52:55], v[44:47], a[88:91], v[52:55]
ds_read_b128 v[36:39], v8 offset:28672
v_mfma_f32_16x16x32_bf16 v[56:59], v[44:47], a[92:95], v[56:59]
s_add_u32 m0, s46, 97280
v_mfma_f32_16x16x32_bf16 v[60:63], v[48:51], a[88:91], v[60:63]
ds_read_b128 v[40:43], v8 offset:30720
v_mfma_f32_16x16x32_bf16 v[64:67], v[48:51], a[92:95], v[64:67]
buffer_load_dwordx4 v6, s[8:11], s50 offen offset:1024 lds
s_waitcnt lgkmcnt(4)
v_mfma_f32_16x16x32_bf16 v[52:55], v[20:23], a[96:99], v[52:55]
ds_read_b128 v[44:47], v9 offset:28672
v_mfma_f32_16x16x32_bf16 v[56:59], v[20:23], a[100:103], v[56:59]
s_add_u32 m0, s46, 101248
v_mfma_f32_16x16x32_bf16 v[60:63], v[24:27], a[96:99], v[60:63]
ds_read_b128 v[48:51], v9 offset:30720
v_mfma_f32_16x16x32_bf16 v[64:67], v[24:27], a[100:103], v[64:67]
buffer_load_dwordx4 v6, s[8:11], s50 offen offset:1152 lds
s_waitcnt lgkmcnt(4)
v_mfma_f32_16x16x32_bf16 v[52:55], v[28:31], a[104:107], v[52:55]
ds_read_b128 v[20:23], v8 offset:32768
v_mfma_f32_16x16x32_bf16 v[56:59], v[28:31], a[108:111], v[56:59]
s_add_u32 m0, s46, 105216
v_mfma_f32_16x16x32_bf16 v[60:63], v[32:35], a[104:107], v[60:63]
ds_read_b128 v[24:27], v8 offset:34816
v_mfma_f32_16x16x32_bf16 v[64:67], v[32:35], a[108:111], v[64:67]
buffer_load_dwordx4 v6, s[8:11], s50 offen offset:1280 lds
s_waitcnt lgkmcnt(4)
v_mfma_f32_16x16x32_bf16 v[52:55], v[36:39], a[112:115], v[52:55]
ds_read_b128 v[28:31], v9 offset:32768
v_mfma_f32_16x16x32_bf16 v[56:59], v[36:39], a[116:119], v[56:59]
s_add_u32 m0, s46, 109184
v_mfma_f32_16x16x32_bf16 v[60:63], v[40:43], a[112:115], v[60:63]
ds_read_b128 v[32:35], v9 offset:34816
v_mfma_f32_16x16x32_bf16 v[64:67], v[40:43], a[116:119], v[64:67]
buffer_load_dwordx4 v6, s[8:11], s50 offen offset:1408 lds
s_waitcnt lgkmcnt(4)
v_mfma_f32_16x16x32_bf16 v[52:55], v[44:47], a[120:123], v[52:55]
ds_read_b128 v[36:39], v8 offset:36864
v_mfma_f32_16x16x32_bf16 v[56:59], v[44:47], a[124:127], v[56:59]
s_add_u32 m0, s46, 113152
v_mfma_f32_16x16x32_bf16 v[60:63], v[48:51], a[120:123], v[60:63]
ds_read_b128 v[40:43], v8 offset:38912
v_mfma_f32_16x16x32_bf16 v[64:67], v[48:51], a[124:127], v[64:67]
buffer_load_dwordx4 v6, s[8:11], s50 offen offset:1536 lds
s_waitcnt lgkmcnt(4)
v_mfma_f32_16x16x32_bf16 v[52:55], v[20:23], a[128:131], v[52:55]
ds_read_b128 v[44:47], v9 offset:36864
v_mfma_f32_16x16x32_bf16 v[56:59], v[20:23], a[132:135], v[56:59]
s_add_u32 m0, s46, 117120
v_mfma_f32_16x16x32_bf16 v[60:63], v[24:27], a[128:131], v[60:63]
ds_read_b128 v[48:51], v9 offset:38912
v_mfma_f32_16x16x32_bf16 v[64:67], v[24:27], a[132:135], v[64:67]
buffer_load_dwordx4 v6, s[8:11], s50 offen offset:1664 lds
s_waitcnt lgkmcnt(4)
v_mfma_f32_16x16x32_bf16 v[52:55], v[28:31], a[136:139], v[52:55]
ds_read_b128 v[20:23], v8 offset:40960
v_mfma_f32_16x16x32_bf16 v[56:59], v[28:31], a[140:143], v[56:59]
s_add_u32 m0, s46, 121088
v_mfma_f32_16x16x32_bf16 v[60:63], v[32:35], a[136:139], v[60:63]
ds_read_b128 v[24:27], v8 offset:43008
v_mfma_f32_16x16x32_bf16 v[64:67], v[32:35], a[140:143], v[64:67]
buffer_load_dwordx4 v6, s[8:11], s50 offen offset:1792 lds
s_waitcnt lgkmcnt(4)
v_mfma_f32_16x16x32_bf16 v[52:55], v[36:39], a[144:147], v[52:55]
ds_read_b128 v[28:31], v9 offset:40960
v_mfma_f32_16x16x32_bf16 v[56:59], v[36:39], a[148:151], v[56:59]
s_add_u32 m0, s46, 125056
v_mfma_f32_16x16x32_bf16 v[60:63], v[40:43], a[144:147], v[60:63]
ds_read_b128 v[32:35], v9 offset:43008
v_mfma_f32_16x16x32_bf16 v[64:67], v[40:43], a[148:151], v[64:67]
buffer_load_dwordx4 v6, s[8:11], s50 offen offset:1920 lds
s_waitcnt lgkmcnt(4)
v_mfma_f32_16x16x32_bf16 v[52:55], v[44:47], a[152:155], v[52:55]
ds_read_b128 v[36:39], v8 offset:45056
v_mfma_f32_16x16x32_bf16 v[56:59], v[44:47], a[156:159], v[56:59]
v_mfma_f32_16x16x32_bf16 v[60:63], v[48:51], a[152:155], v[60:63]
ds_read_b128 v[40:43], v8 offset:47104
v_mfma_f32_16x16x32_bf16 v[64:67], v[48:51], a[156:159], v[64:67]
s_waitcnt lgkmcnt(4)
v_mfma_f32_16x16x32_bf16 v[52:55], v[20:23], a[160:163], v[52:55]
ds_read_b128 v[44:47], v9 offset:45056
v_mfma_f32_16x16x32_bf16 v[56:59], v[20:23], a[164:167], v[56:59]
v_mfma_f32_16x16x32_bf16 v[60:63], v[24:27], a[160:163], v[60:63]
ds_read_b128 v[48:51], v9 offset:47104
v_mfma_f32_16x16x32_bf16 v[64:67], v[24:27], a[164:167], v[64:67]
s_waitcnt lgkmcnt(4)
v_mfma_f32_16x16x32_bf16 v[52:55], v[28:31], a[168:171], v[52:55]
ds_read_b128 v[20:23], v8 offset:49152
v_mfma_f32_16x16x32_bf16 v[56:59], v[28:31], a[172:175], v[56:59]
s_waitcnt vmcnt(16)
v_mov_b32 v17, s42
s_mov_b64 exec, 1
buffer_store_dword v17, v16, s[84:87], s49 offen sc1
s_mov_b64 exec, -1
v_mfma_f32_16x16x32_bf16 v[60:63], v[32:35], a[168:171], v[60:63]
ds_read_b128 v[24:27], v8 offset:51200
v_mfma_f32_16x16x32_bf16 v[64:67], v[32:35], a[172:175], v[64:67]
s_waitcnt lgkmcnt(4)
v_mfma_f32_16x16x32_bf16 v[52:55], v[36:39], a[176:179], v[52:55]
ds_read_b128 v[28:31], v9 offset:49152
v_mfma_f32_16x16x32_bf16 v[56:59], v[36:39], a[180:183], v[56:59]
s_add_u32 s53, s42, 3
s_min_u32 s53, s53, 63
s_lshl_b32 s53, s53, 16
s_mov_b64 exec, 0xffff
buffer_load_dword v250, v19, s[8:11], s53 offen
s_mov_b64 exec, -1
v_mfma_f32_16x16x32_bf16 v[60:63], v[40:43], a[176:179], v[60:63]
ds_read_b128 v[32:35], v9 offset:51200
v_mfma_f32_16x16x32_bf16 v[64:67], v[40:43], a[180:183], v[64:67]
s_waitcnt lgkmcnt(4)
v_mfma_f32_16x16x32_bf16 v[52:55], v[44:47], a[184:187], v[52:55]
ds_read_b128 v[36:39], v8 offset:53248
v_mfma_f32_16x16x32_bf16 v[56:59], v[44:47], a[188:191], v[56:59]
v_mfma_f32_16x16x32_bf16 v[60:63], v[48:51], a[184:187], v[60:63]
ds_read_b128 v[40:43], v8 offset:55296
v_mfma_f32_16x16x32_bf16 v[64:67], v[48:51], a[188:191], v[64:67]
s_waitcnt lgkmcnt(4)
v_mfma_f32_16x16x32_bf16 v[52:55], v[20:23], a[192:195], v[52:55]
ds_read_b128 v[44:47], v9 offset:53248
v_mfma_f32_16x16x32_bf16 v[56:59], v[20:23], a[196:199], v[56:59]
v_mfma_f32_16x16x32_bf16 v[60:63], v[24:27], a[192:195], v[60:63]
ds_read_b128 v[48:51], v9 offset:55296
v_mfma_f32_16x16x32_bf16 v[64:67], v[24:27], a[196:199], v[64:67]
s_waitcnt lgkmcnt(4)
v_mfma_f32_16x16x32_bf16 v[52:55], v[28:31], a[200:203], v[52:55]
ds_read_b128 v[20:23], v8 offset:57344
v_mfma_f32_16x16x32_bf16 v[56:59], v[28:31], a[204:207], v[56:59]
v_mfma_f32_16x16x32_bf16 v[60:63], v[32:35], a[200:203], v[60:63]
ds_read_b128 v[24:27], v8 offset:59392
v_mfma_f32_16x16x32_bf16 v[64:67], v[32:35], a[204:207], v[64:67]
s_waitcnt lgkmcnt(4)
v_mfma_f32_16x16x32_bf16 v[52:55], v[36:39], a[208:211], v[52:55]
ds_read_b128 v[28:31], v9 offset:57344
v_mfma_f32_16x16x32_bf16 v[56:59], v[36:39], a[212:215], v[56:59]
v_mfma_f32_16x16x32_bf16 v[60:63], v[40:43], a[208:211], v[60:63]
ds_read_b128 v[32:35], v9 offset:59392
v_mfma_f32_16x16x32_bf16 v[64:67], v[40:43], a[212:215], v[64:67]
s_waitcnt lgkmcnt(4)
v_mfma_f32_16x16x32_bf16 v[52:55], v[44:47], a[216:219], v[52:55]
ds_read_b128 v[36:39], v8 offset:61440
v_mfma_f32_16x16x32_bf16 v[56:59], v[44:47], a[220:223], v[56:59]
v_mfma_f32_16x16x32_bf16 v[60:63], v[48:51], a[216:219], v[60:63]
ds_read_b128 v[40:43], v8 offset:63488
v_mfma_f32_16x16x32_bf16 v[64:67], v[48:51], a[220:223], v[64:67]
s_waitcnt lgkmcnt(4)
v_mfma_f32_16x16x32_bf16 v[52:55], v[20:23], a[224:227], v[52:55]
ds_read_b128 v[44:47], v9 offset:61440
v_mfma_f32_16x16x32_bf16 v[56:59], v[20:23], a[228:231], v[56:59]
v_mfma_f32_16x16x32_bf16 v[60:63], v[24:27], a[224:227], v[60:63]
ds_read_b128 v[48:51], v9 offset:63488
v_mfma_f32_16x16x32_bf16 v[64:67], v[24:27], a[228:231], v[64:67]
s_waitcnt lgkmcnt(5)
v_mfma_f32_16x16x32_bf16 v[52:55], v[28:31], a[232:235], v[52:55]
v_mfma_f32_16x16x32_bf16 v[56:59], v[28:31], a[236:239], v[56:59]
s_waitcnt lgkmcnt(4)
v_mfma_f32_16x16x32_bf16 v[60:63], v[32:35], a[232:235], v[60:63]
v_mfma_f32_16x16x32_bf16 v[64:67], v[32:35], a[236:239], v[64:67]
s_waitcnt lgkmcnt(3)
v_mfma_f32_16x16x32_bf16 v[52:55], v[36:39], a[240:243], v[52:55]
v_mfma_f32_16x16x32_bf16 v[56:59], v[36:39], a[244:247], v[56:59]
s_waitcnt lgkmcnt(2)
v_mfma_f32_16x16x32_bf16 v[60:63], v[40:43], a[240:243], v[60:63]
v_mfma_f32_16x16x32_bf16 v[64:67], v[40:43], a[244:247], v[64:67]
s_waitcnt lgkmcnt(1)
v_mfma_f32_16x16x32_bf16 v[52:55], v[44:47], a[248:251], v[52:55]
v_mfma_f32_16x16x32_bf16 v[56:59], v[44:47], a[252:255], v[56:59]
s_waitcnt lgkmcnt(0)
v_mfma_f32_16x16x32_bf16 v[60:63], v[48:51], a[248:251], v[60:63]
v_mfma_f32_16x16x32_bf16 v[64:67], v[48:51], a[252:255], v[64:67]
s_add_u32 s42, s42, 1
s_branch mega_kernel_v_loop
mega_kernel_v_fin:
s_nop 11
v_cvt_pk_bf16_f32 v84, v68, v69
v_cvt_pk_bf16_f32 v85, v70, v71
v_cvt_pk_bf16_f32 v86, v76, v77
v_cvt_pk_bf16_f32 v87, v78, v79
v_cvt_pk_bf16_f32 v88, v72, v73
v_cvt_pk_bf16_f32 v89, v74, v75
v_cvt_pk_bf16_f32 v90, v80, v81
v_cvt_pk_bf16_f32 v91, v82, v83
s_add_u32 s51, s42, s47
s_sub_u32 s51, s51, 1
s_bfe_u32 s52, s51, 0x40002
s_lshl_b32 s52, s52, 14
s_and_b32 s51, s51, 3
s_lshl_b32 s51, s51, 11
s_add_u32 s51, s51, s52
s_add_u32 s51, s51, s48
buffer_store_dwordx4 v[84:87], v7, s[84:87], s51 offen sc1
buffer_store_dwordx4 v[88:91], v7, s[84:87], s51 offen offset:1024 sc1
s_waitcnt vmcnt(0)
v_mov_b32 v17, s42
s_mov_b64 exec, 1
buffer_store_dword v17, v16, s[84:87], s49 offen sc1
s_mov_b64 exec, -1
s_waitcnt vmcnt(0)
s_barrier
mega_kernel_fft:
s_mov_b32 s38, s92
s_mov_b32 s39, 64
s_mov_b32 s37, 129
mega_kernel_f2s:
v_mov_b32 v1, 0
s_mov_b32 s82, 69259264
mega_kernel_w0:
s_sleep 8
buffer_load_dword v2, v1, s[84:87], s82 offen sc1
s_waitcnt vmcnt(0)
v_cmp_ne_u32 vcc, 31, v2
s_cbranch_vccnz mega_kernel_w0
s_mov_b32 s48, 0x3f7ec46d
s_mov_b32 s49, 0x3dc8bd36
s_mov_b32 s50, 0x3f7b14be
s_mov_b32 s51, 0x3e47c5c2
s_mov_b32 s52, 0x3f74fa0b
s_mov_b32 s53, 0x3e94a031
s_mov_b32 s54, 0x3f6c835e
s_mov_b32 s55, 0x3ec3ef15
s_mov_b32 s56, 0x3f61c598
s_mov_b32 s57, 0x3ef15aea
s_mov_b32 s58, 0x3f54db31
s_mov_b32 s59, 0x3f0e39da
s_mov_b32 s60, 0x3f45e403
s_mov_b32 s61, 0x3f226799
s_mov_b32 s62, 0x3f3504f3
s_mov_b32 s63, 0x3f3504f3
v_lshrrev_b32 v10, 6, v0
v_and_b32 v1, 63, v0
v_readfirstlane_b32 s16, v10
v_cvt_f32_u32 v2, v1
v_lshlrev_b32 v5, 3, v1
s_mul_i32 s17, s16, 16896
v_add_u32 v3, s17, v5
v_and_b32 v7, 1, v1
v_lshrrev_b32 v6, 1, v1
v_cvt_f32_u32 v8, v6
v_cvt_f32_u32 v10, v7
v_mul_u32_u24 v4, 528, v6
v_lshl_add_u32 v4, v7, 3, v4
v_add_u32 v4, s17, v4
v_lshlrev_b32 v11, 12, v7
v_lshl_add_u32 v11, v6, 2, v11
v_fma_f32 v9, v10, 2.0, -1.0
v_sub_f32 v7, 0, v9
v_mul_f32 v13, v10, v8
v_mul_f32 v13, 0x3a000000, v13
s_mov_b32 s18, 0xaaaaaaaa
s_mov_b32 s19, 0xaaaaaaaa
v_mul_f32 v12, 0xba000000, v2
v_cos_f32 v82, v12
v_sin_f32 v83, v12
v_mul_f32 v12, 0xba800000, v2
v_cos_f32 v84, v12
v_sin_f32 v85, v12
v_mul_f32 v12, 0xbac00000, v2
v_cos_f32 v86, v12
v_sin_f32 v87, v12
v_mul_f32 v12, 0xbb000000, v2
v_cos_f32 v88, v12
v_sin_f32 v89, v12
v_mul_f32 v12, 0xbb200000, v2
v_cos_f32 v90, v12
v_sin_f32 v91, v12
v_mul_f32 v12, 0xbb400000, v2
v_cos_f32 v92, v12
v_sin_f32 v93, v12
v_mul_f32 v12, 0xbb600000, v2
v_cos_f32 v94, v12
v_sin_f32 v95, v12
v_mul_f32 v12, 0xbb800000, v2
v_cos_f32 v96, v12
v_sin_f32 v97, v12
v_mul_f32 v12, 0xbb900000, v2
v_cos_f32 v98, v12
v_sin_f32 v99, v12
v_mul_f32 v12, 0xbba00000, v2
v_cos_f32 v100, v12
v_sin_f32 v101, v12
v_mul_f32 v12, 0xbbb00000, v2
v_cos_f32 v102, v12
v_sin_f32 v103, v12
v_mul_f32 v12, 0xbbc00000, v2
v_cos_f32 v104, v12
v_sin_f32 v105, v12
v_mul_f32 v12, 0xbbd00000, v2
v_cos_f32 v106, v12
v_sin_f32 v107, v12
v_mul_f32 v12, 0xbbe00000, v2
v_cos_f32 v108, v12
v_sin_f32 v109, v12
v_mul_f32 v12, 0xbbf00000, v2
v_cos_f32 v110, v12
v_sin_f32 v111, v12
v_mul_f32 v12, 0xbc000000, v2
v_cos_f32 v112, v12
v_sin_f32 v113, v12
v_mul_f32 v12, 0xbc080000, v2
v_cos_f32 v114, v12
v_sin_f32 v115, v12
v_mul_f32 v12, 0xbc100000, v2
v_cos_f32 v116, v12
v_sin_f32 v117, v12
v_mul_f32 v12, 0xbc180000, v2
v_cos_f32 v118, v12
v_sin_f32 v119, v12
v_mul_f32 v12, 0xbc200000, v2
v_cos_f32 v120, v12
v_sin_f32 v121, v12
v_mul_f32 v12, 0xbc280000, v2
v_cos_f32 v122, v12
v_sin_f32 v123, v12
v_mul_f32 v12, 0xbc300000, v2
v_cos_f32 v124, v12
v_sin_f32 v125, v12
v_mul_f32 v12, 0xbc380000, v2
v_cos_f32 v126, v12
v_sin_f32 v127, v12
v_mul_f32 v12, 0xbc400000, v2
v_cos_f32 v128, v12
v_sin_f32 v129, v12
v_mul_f32 v12, 0xbc480000, v2
v_cos_f32 v130, v12
v_sin_f32 v131, v12
v_mul_f32 v12, 0xbc500000, v2
v_cos_f32 v132, v12
v_sin_f32 v133, v12
v_mul_f32 v12, 0xbc580000, v2
v_cos_f32 v134, v12
v_sin_f32 v135, v12
v_mul_f32 v12, 0xbc600000, v2
v_cos_f32 v136, v12
v_sin_f32 v137, v12
v_mul_f32 v12, 0xbc680000, v2
v_cos_f32 v138, v12
v_sin_f32 v139, v12
v_mul_f32 v12, 0xbc700000, v2
v_cos_f32 v140, v12
v_sin_f32 v141, v12
v_mul_f32 v12, 0xbc780000, v2
v_cos_f32 v142, v12
v_sin_f32 v143, v12
v_mov_b32 v12, v13
v_fmac_f32 v12, 0x00000000, v8
v_cos_f32 v144, v12
v_sin_f32 v145, v12
v_mov_b32 v12, v13
v_fmac_f32 v12, 0x3a800000, v8
v_cos_f32 v146, v12
v_sin_f32 v147, v12
v_mov_b32 v12, v13
v_fmac_f32 v12, 0x3b000000, v8
v_cos_f32 v148, v12
v_sin_f32 v149, v12
v_mov_b32 v12, v13
v_fmac_f32 v12, 0x3b400000, v8
v_cos_f32 v150, v12
v_sin_f32 v151, v12
v_mov_b32 v12, v13
v_fmac_f32 v12, 0x3b800000, v8
v_cos_f32 v152, v12
v_sin_f32 v153, v12
v_mov_b32 v12, v13
v_fmac_f32 v12, 0x3ba00000, v8
v_cos_f32 v154, v12
v_sin_f32 v155, v12
v_mov_b32 v12, v13
v_fmac_f32 v12, 0x3bc00000, v8
v_cos_f32 v156, v12
v_sin_f32 v157, v12
v_mov_b32 v12, v13
v_fmac_f32 v12, 0x3be00000, v8
v_cos_f32 v158, v12
v_sin_f32 v159, v12
v_mov_b32 v12, v13
v_fmac_f32 v12, 0x3c000000, v8
v_cos_f32 v160, v12
v_sin_f32 v161, v12
v_mov_b32 v12, v13
v_fmac_f32 v12, 0x3c100000, v8
v_cos_f32 v162, v12
v_sin_f32 v163, v12
v_mov_b32 v12, v13
v_fmac_f32 v12, 0x3c200000, v8
v_cos_f32 v164, v12
v_sin_f32 v165, v12
v_mov_b32 v12, v13
v_fmac_f32 v12, 0x3c300000, v8
v_cos_f32 v166, v12
v_sin_f32 v167, v12
v_mov_b32 v12, v13
v_fmac_f32 v12, 0x3c400000, v8
v_cos_f32 v168, v12
v_sin_f32 v169, v12
v_mov_b32 v12, v13
v_fmac_f32 v12, 0x3c500000, v8
v_cos_f32 v170, v12
v_sin_f32 v171, v12
v_mov_b32 v12, v13
v_fmac_f32 v12, 0x3c600000, v8
v_cos_f32 v172, v12
v_sin_f32 v173, v12
v_mov_b32 v12, v13
v_fmac_f32 v12, 0x3c700000, v8
v_cos_f32 v174, v12
v_sin_f32 v175, v12
v_mov_b32 v12, v13
v_fmac_f32 v12, 0x3c800000, v8
v_cos_f32 v176, v12
v_sin_f32 v177, v12
v_mov_b32 v12, v13
v_fmac_f32 v12, 0x3c880000, v8
v_cos_f32 v178, v12
v_sin_f32 v179, v12
v_mov_b32 v12, v13
v_fmac_f32 v12, 0x3c900000, v8
v_cos_f32 v180, v12
v_sin_f32 v181, v12
v_mov_b32 v12, v13
v_fmac_f32 v12, 0x3c980000, v8
v_cos_f32 v182, v12
v_sin_f32 v183, v12
v_mov_b32 v12, v13
v_fmac_f32 v12, 0x3ca00000, v8
v_cos_f32 v184, v12
v_sin_f32 v185, v12
v_mov_b32 v12, v13
v_fmac_f32 v12, 0x3ca80000, v8
v_cos_f32 v186, v12
v_sin_f32 v187, v12
v_mov_b32 v12, v13
v_fmac_f32 v12, 0x3cb00000, v8
v_cos_f32 v188, v12
v_sin_f32 v189, v12
v_mov_b32 v12, v13
v_fmac_f32 v12, 0x3cb80000, v8
v_cos_f32 v190, v12
v_sin_f32 v191, v12
v_mov_b32 v12, v13
v_fmac_f32 v12, 0x3cc00000, v8
v_cos_f32 v192, v12
v_sin_f32 v193, v12
v_mov_b32 v12, v13
v_fmac_f32 v12, 0x3cc80000, v8
v_cos_f32 v194, v12
v_sin_f32 v195, v12
v_mov_b32 v12, v13
v_fmac_f32 v12, 0x3cd00000, v8
v_cos_f32 v196, v12
v_sin_f32 v197, v12
v_mov_b32 v12, v13
v_fmac_f32 v12, 0x3cd80000, v8
v_cos_f32 v198, v12
v_sin_f32 v199, v12
v_mov_b32 v12, v13
v_fmac_f32 v12, 0x3ce00000, v8
v_cos_f32 v200, v12
v_sin_f32 v201, v12
v_mov_b32 v12, v13
v_fmac_f32 v12, 0x3ce80000, v8
v_cos_f32 v202, v12
v_sin_f32 v203, v12
v_mov_b32 v12, v13
v_fmac_f32 v12, 0x3cf00000, v8
v_cos_f32 v204, v12
v_sin_f32 v205, v12
v_mov_b32 v12, v13
v_fmac_f32 v12, 0x3cf80000, v8
v_cos_f32 v206, v12
v_sin_f32 v207, v12
s_nop 0
v_mul_f32 v144, 0x34800000, v144
v_mul_f32 v145, 0x34800000, v145
v_mul_f32 v146, 0x34800000, v146
v_mul_f32 v147, 0x34800000, v147
v_mul_f32 v148, 0x34800000, v148
v_mul_f32 v149, 0x34800000, v149
v_mul_f32 v150, 0x34800000, v150
v_mul_f32 v151, 0x34800000, v151
v_mul_f32 v152, 0x34800000, v152
v_mul_f32 v153, 0x34800000, v153
v_mul_f32 v154, 0x34800000, v154
v_mul_f32 v155, 0x34800000, v155
v_mul_f32 v156, 0x34800000, v156
v_mul_f32 v157, 0x34800000, v157
v_mul_f32 v158, 0x34800000, v158
v_mul_f32 v159, 0x34800000, v159
v_mul_f32 v160, 0x34800000, v160
v_mul_f32 v161, 0x34800000, v161
v_mul_f32 v162, 0x34800000, v162
v_mul_f32 v163, 0x34800000, v163
v_mul_f32 v164, 0x34800000, v164
v_mul_f32 v165, 0x34800000, v165
v_mul_f32 v166, 0x34800000, v166
v_mul_f32 v167, 0x34800000, v167
v_mul_f32 v168, 0x34800000, v168
v_mul_f32 v169, 0x34800000, v169
v_mul_f32 v170, 0x34800000, v170
v_mul_f32 v171, 0x34800000, v171
v_mul_f32 v172, 0x34800000, v172
v_mul_f32 v173, 0x34800000, v173
v_mul_f32 v174, 0x34800000, v174
v_mul_f32 v175, 0x34800000, v175
v_mul_f32 v176, 0x34800000, v176
v_mul_f32 v177, 0x34800000, v177
v_mul_f32 v178, 0x34800000, v178
v_mul_f32 v179, 0x34800000, v179
v_mul_f32 v180, 0x34800000, v180
v_mul_f32 v181, 0x34800000, v181
v_mul_f32 v182, 0x34800000, v182
v_mul_f32 v183, 0x34800000, v183
v_mul_f32 v184, 0x34800000, v184
v_mul_f32 v185, 0x34800000, v185
v_mul_f32 v186, 0x34800000, v186
v_mul_f32 v187, 0x34800000, v187
v_mul_f32 v188, 0x34800000, v188
v_mul_f32 v189, 0x34800000, v189
v_mul_f32 v190, 0x34800000, v190
v_mul_f32 v191, 0x34800000, v191
v_mul_f32 v192, 0x34800000, v192
v_mul_f32 v193, 0x34800000, v193
v_mul_f32 v194, 0x34800000, v194
v_mul_f32 v195, 0x34800000, v195
v_mul_f32 v196, 0x34800000, v196
v_mul_f32 v197, 0x34800000, v197
v_mul_f32 v198, 0x34800000, v198
v_mul_f32 v199, 0x34800000, v199
v_mul_f32 v200, 0x34800000, v200
v_mul_f32 v201, 0x34800000, v201
v_mul_f32 v202, 0x34800000, v202
v_mul_f32 v203, 0x34800000, v203
v_mul_f32 v204, 0x34800000, v204
v_mul_f32 v205, 0x34800000, v205
v_mul_f32 v206, 0x34800000, v206
v_mul_f32 v207, 0x34800000, v207
s_cmp_lt_u32 s38, s37
s_cbranch_scc0 mega_kernel_f2_e
s_lshl_b32 s12, s38, 2
s_add_u32 s12, s12, s16
s_min_u32 s12, s12, 512
s_lshl_b32 s13, s12, 13
s_lshl_b32 s12, s12, 14
s_add_u32 s12, s12, 96468992
s_add_u32 s13, s13, 121634816
buffer_load_dwordx2 a[0:1], v5, s[84:87], s12 offen offset:0 sc1
buffer_load_dwordx2 a[2:3], v5, s[84:87], s12 offen offset:512 sc1
buffer_load_dwordx2 a[4:5], v5, s[84:87], s12 offen offset:1024 sc1
buffer_load_dwordx2 a[6:7], v5, s[84:87], s12 offen offset:1536 sc1
buffer_load_dwordx2 a[8:9], v5, s[84:87], s12 offen offset:2048 sc1
buffer_load_dwordx2 a[10:11], v5, s[84:87], s12 offen offset:2560 sc1
buffer_load_dwordx2 a[12:13], v5, s[84:87], s12 offen offset:3072 sc1
buffer_load_dwordx2 a[14:15], v5, s[84:87], s12 offen offset:3584 sc1
s_add_u32 s12, s12, 4096
buffer_load_dwordx2 a[16:17], v5, s[84:87], s12 offen offset:0 sc1
buffer_load_dwordx2 a[18:19], v5, s[84:87], s12 offen offset:512 sc1
buffer_load_dwordx2 a[20:21], v5, s[84:87], s12 offen offset:1024 sc1
buffer_load_dwordx2 a[22:23], v5, s[84:87], s12 offen offset:1536 sc1
buffer_load_dwordx2 a[24:25], v5, s[84:87], s12 offen offset:2048 sc1
buffer_load_dwordx2 a[26:27], v5, s[84:87], s12 offen offset:2560 sc1
buffer_load_dwordx2 a[28:29], v5, s[84:87], s12 offen offset:3072 sc1
buffer_load_dwordx2 a[30:31], v5, s[84:87], s12 offen offset:3584 sc1
s_add_u32 s12, s12, 4096
buffer_load_dwordx2 a[32:33], v5, s[84:87], s12 offen offset:0 sc1
buffer_load_dwordx2 a[34:35], v5, s[84:87], s12 offen offset:512 sc1
buffer_load_dwordx2 a[36:37], v5, s[84:87], s12 offen offset:1024 sc1
buffer_load_dwordx2 a[38:39], v5, s[84:87], s12 offen offset:1536 sc1
buffer_load_dwordx2 a[40:41], v5, s[84:87], s12 offen offset:2048 sc1
buffer_load_dwordx2 a[42:43], v5, s[84:87], s12 offen offset:2560 sc1
buffer_load_dwordx2 a[44:45], v5, s[84:87], s12 offen offset:3072 sc1
buffer_load_dwordx2 a[46:47], v5, s[84:87], s12 offen offset:3584 sc1
s_add_u32 s12, s12, 4096
buffer_load_dwordx2 a[48:49], v5, s[84:87], s12 offen offset:0 sc1
buffer_load_dwordx2 a[50:51], v5, s[84:87], s12 offen offset:512 sc1
buffer_load_dwordx2 a[52:53], v5, s[84:87], s12 offen offset:1024 sc1
buffer_load_dwordx2 a[54:55], v5, s[84:87], s12 offen offset:1536 sc1
buffer_load_dwordx2 a[56:57], v5, s[84:87], s12 offen offset:2048 sc1
buffer_load_dwordx2 a[58:59], v5, s[84:87], s12 offen offset:2560 sc1
buffer_load_dwordx2 a[60:61], v5, s[84:87], s12 offen offset:3072 sc1
buffer_load_dwordx2 a[62:63], v5, s[84:87], s12 offen offset:3584 sc1
s_add_u32 s12, s12, 4096
buffer_load_dword a64, v11, s[84:87], s13 offen offset:0 sc1
buffer_load_dword a65, v11, s[84:87], s13 offen offset:128 sc1
buffer_load_dword a66, v11, s[84:87], s13 offen offset:256 sc1
buffer_load_dword a67, v11, s[84:87], s13 offen offset:384 sc1
buffer_load_dword a68, v11, s[84:87], s13 offen offset:512 sc1
buffer_load_dword a69, v11, s[84:87], s13 offen offset:640 sc1
buffer_load_dword a70, v11, s[84:87], s13 offen offset:768 sc1
buffer_load_dword a71, v11, s[84:87], s13 offen offset:896 sc1
buffer_load_dword a72, v11, s[84:87], s13 offen offset:1024 sc1
buffer_load_dword a73, v11, s[84:87], s13 offen offset:1152 sc1
buffer_load_dword a74, v11, s[84:87], s13 offen offset:1280 sc1
buffer_load_dword a75, v11, s[84:87], s13 offen offset:1408 sc1
buffer_load_dword a76, v11, s[84:87], s13 offen offset:1536 sc1
buffer_load_dword a77, v11, s[84:87], s13 offen offset:1664 sc1
buffer_load_dword a78, v11, s[84:87], s13 offen offset:1792 sc1
buffer_load_dword a79, v11, s[84:87], s13 offen offset:1920 sc1
buffer_load_dword a80, v11, s[84:87], s13 offen offset:2048 sc1
buffer_load_dword a81, v11, s[84:87], s13 offen offset:2176 sc1
buffer_load_dword a82, v11, s[84:87], s13 offen offset:2304 sc1
buffer_load_dword a83, v11, s[84:87], s13 offen offset:2432 sc1
buffer_load_dword a84, v11, s[84:87], s13 offen offset:2560 sc1
buffer_load_dword a85, v11, s[84:87], s13 offen offset:2688 sc1
buffer_load_dword a86, v11, s[84:87], s13 offen offset:2816 sc1
buffer_load_dword a87, v11, s[84:87], s13 offen offset:2944 sc1
buffer_load_dword a88, v11, s[84:87], s13 offen offset:3072 sc1
buffer_load_dword a89, v11, s[84:87], s13 offen offset:3200 sc1
buffer_load_dword a90, v11, s[84:87], s13 offen offset:3328 sc1
buffer_load_dword a91, v11, s[84:87], s13 offen offset:3456 sc1
buffer_load_dword a92, v11, s[84:87], s13 offen offset:3584 sc1
buffer_load_dword a93, v11, s[84:87], s13 offen offset:3712 sc1
buffer_load_dword a94, v11, s[84:87], s13 offen offset:3840 sc1
buffer_load_dword a95, v11, s[84:87], s13 offen offset:3968 sc1
s_waitcnt vmcnt(0)
mega_kernel_f2_l:
s_add_u32 s21, s38, s39
s_cmp_lt_u32 s21, s37
s_cselect_b32 s22, s21, s38
s_waitcnt vmcnt(32)
v_accvgpr_read_b32 v16, a0
v_accvgpr_read_b32 v17, a1
v_accvgpr_read_b32 v18, a2
v_accvgpr_read_b32 v19, a3
v_accvgpr_read_b32 v20, a4
v_accvgpr_read_b32 v21, a5
v_accvgpr_read_b32 v22, a6
v_accvgpr_read_b32 v23, a7
v_accvgpr_read_b32 v24, a8
v_accvgpr_read_b32 v25, a9
v_accvgpr_read_b32 v26, a10
v_accvgpr_read_b32 v27, a11
v_accvgpr_read_b32 v28, a12
v_accvgpr_read_b32 v29, a13
v_accvgpr_read_b32 v30, a14
v_accvgpr_read_b32 v31, a15
v_accvgpr_read_b32 v32, a16
v_accvgpr_read_b32 v33, a17
v_accvgpr_read_b32 v34, a18
v_accvgpr_read_b32 v35, a19
v_accvgpr_read_b32 v36, a20
v_accvgpr_read_b32 v37, a21
v_accvgpr_read_b32 v38, a22
v_accvgpr_read_b32 v39, a23
v_accvgpr_read_b32 v40, a24
v_accvgpr_read_b32 v41, a25
v_accvgpr_read_b32 v42, a26
v_accvgpr_read_b32 v43, a27
v_accvgpr_read_b32 v44, a28
v_accvgpr_read_b32 v45, a29
v_accvgpr_read_b32 v46, a30
v_accvgpr_read_b32 v47, a31
v_accvgpr_read_b32 v48, a32
v_accvgpr_read_b32 v49, a33
v_accvgpr_read_b32 v50, a34
v_accvgpr_read_b32 v51, a35
v_accvgpr_read_b32 v52, a36
v_accvgpr_read_b32 v53, a37
v_accvgpr_read_b32 v54, a38
v_accvgpr_read_b32 v55, a39
v_accvgpr_read_b32 v56, a40
v_accvgpr_read_b32 v57, a41
v_accvgpr_read_b32 v58, a42
v_accvgpr_read_b32 v59, a43
v_accvgpr_read_b32 v60, a44
v_accvgpr_read_b32 v61, a45
v_accvgpr_read_b32 v62, a46
v_accvgpr_read_b32 v63, a47
v_accvgpr_read_b32 v64, a48
v_accvgpr_read_b32 v65, a49
v_accvgpr_read_b32 v66, a50
v_accvgpr_read_b32 v67, a51
v_accvgpr_read_b32 v68, a52
v_accvgpr_read_b32 v69, a53
v_accvgpr_read_b32 v70, a54
v_accvgpr_read_b32 v71, a55
v_accvgpr_read_b32 v72, a56
v_accvgpr_read_b32 v73, a57
v_accvgpr_read_b32 v74, a58
v_accvgpr_read_b32 v75, a59
v_accvgpr_read_b32 v76, a60
v_accvgpr_read_b32 v77, a61
v_accvgpr_read_b32 v78, a62
v_accvgpr_read_b32 v79, a63
v_accvgpr_read_b32 v208, a64
v_accvgpr_read_b32 v209, a65
v_accvgpr_read_b32 v210, a66
v_accvgpr_read_b32 v211, a67
v_accvgpr_read_b32 v212, a68
v_accvgpr_read_b32 v213, a69
v_accvgpr_read_b32 v214, a70
v_accvgpr_read_b32 v215, a71
v_accvgpr_read_b32 v216, a72
v_accvgpr_read_b32 v217, a73
v_accvgpr_read_b32 v218, a74
v_accvgpr_read_b32 v219, a75
v_accvgpr_read_b32 v220, a76
v_accvgpr_read_b32 v221, a77
v_accvgpr_read_b32 v222, a78
v_accvgpr_read_b32 v223, a79
v_accvgpr_read_b32 v224, a80
v_accvgpr_read_b32 v225, a81
v_accvgpr_read_b32 v226, a82
v_accvgpr_read_b32 v227, a83
v_accvgpr_read_b32 v228, a84
v_accvgpr_read_b32 v229, a85
v_accvgpr_read_b32 v230, a86
v_accvgpr_read_b32 v231, a87
v_accvgpr_read_b32 v232, a88
v_accvgpr_read_b32 v233, a89
v_accvgpr_read_b32 v234, a90
v_accvgpr_read_b32 v235, a91
v_accvgpr_read_b32 v236, a92
v_accvgpr_read_b32 v237, a93
v_accvgpr_read_b32 v238, a94
v_accvgpr_read_b32 v239, a95
s_lshl_b32 s12, s22, 2
s_add_u32 s12, s12, s16
s_min_u32 s12, s12, 512
s_lshl_b32 s13, s12, 13
s_lshl_b32 s12, s12, 14
s_add_u32 s12, s12, 96468992
s_add_u32 s13, s13, 121634816
buffer_load_dwordx2 a[0:1], v5, s[84:87], s12 offen offset:0 sc1
buffer_load_dwordx2 a[2:3], v5, s[84:87], s12 offen offset:512 sc1
buffer_load_dwordx2 a[4:5], v5, s[84:87], s12 offen offset:1024 sc1
buffer_load_dwordx2 a[6:7], v5, s[84:87], s12 offen offset:1536 sc1
buffer_load_dwordx2 a[8:9], v5, s[84:87], s12 offen offset:2048 sc1
buffer_load_dwordx2 a[10:11], v5, s[84:87], s12 offen offset:2560 sc1
buffer_load_dwordx2 a[12:13], v5, s[84:87], s12 offen offset:3072 sc1
buffer_load_dwordx2 a[14:15], v5, s[84:87], s12 offen offset:3584 sc1
s_add_u32 s12, s12, 4096
buffer_load_dwordx2 a[16:17], v5, s[84:87], s12 offen offset:0 sc1
buffer_load_dwordx2 a[18:19], v5, s[84:87], s12 offen offset:512 sc1
buffer_load_dwordx2 a[20:21], v5, s[84:87], s12 offen offset:1024 sc1
buffer_load_dwordx2 a[22:23], v5, s[84:87], s12 offen offset:1536 sc1
buffer_load_dwordx2 a[24:25], v5, s[84:87], s12 offen offset:2048 sc1
buffer_load_dwordx2 a[26:27], v5, s[84:87], s12 offen offset:2560 sc1
buffer_load_dwordx2 a[28:29], v5, s[84:87], s12 offen offset:3072 sc1
buffer_load_dwordx2 a[30:31], v5, s[84:87], s12 offen offset:3584 sc1
s_add_u32 s12, s12, 4096
buffer_load_dwordx2 a[32:33], v5, s[84:87], s12 offen offset:0 sc1
buffer_load_dwordx2 a[34:35], v5, s[84:87], s12 offen offset:512 sc1
buffer_load_dwordx2 a[36:37], v5, s[84:87], s12 offen offset:1024 sc1
buffer_load_dwordx2 a[38:39], v5, s[84:87], s12 offen offset:1536 sc1
buffer_load_dwordx2 a[40:41], v5, s[84:87], s12 offen offset:2048 sc1
buffer_load_dwordx2 a[42:43], v5, s[84:87], s12 offen offset:2560 sc1
buffer_load_dwordx2 a[44:45], v5, s[84:87], s12 offen offset:3072 sc1
buffer_load_dwordx2 a[46:47], v5, s[84:87], s12 offen offset:3584 sc1
s_add_u32 s12, s12, 4096
buffer_load_dwordx2 a[48:49], v5, s[84:87], s12 offen offset:0 sc1
buffer_load_dwordx2 a[50:51], v5, s[84:87], s12 offen offset:512 sc1
buffer_load_dwordx2 a[52:53], v5, s[84:87], s12 offen offset:1024 sc1
buffer_load_dwordx2 a[54:55], v5, s[84:87], s12 offen offset:1536 sc1
buffer_load_dwordx2 a[56:57], v5, s[84:87], s12 offen offset:2048 sc1
buffer_load_dwordx2 a[58:59], v5, s[84:87], s12 offen offset:2560 sc1
buffer_load_dwordx2 a[60:61], v5, s[84:87], s12 offen offset:3072 sc1
buffer_load_dwordx2 a[62:63], v5, s[84:87], s12 offen offset:3584 sc1
s_add_u32 s12, s12, 4096
buffer_load_dword a64, v11, s[84:87], s13 offen offset:0 sc1
buffer_load_dword a65, v11, s[84:87], s13 offen offset:128 sc1
buffer_load_dword a66, v11, s[84:87], s13 offen offset:256 sc1
buffer_load_dword a67, v11, s[84:87], s13 offen offset:384 sc1
buffer_load_dword a68, v11, s[84:87], s13 offen offset:512 sc1
buffer_load_dword a69, v11, s[84:87], s13 offen offset:640 sc1
buffer_load_dword a70, v11, s[84:87], s13 offen offset:768 sc1
buffer_load_dword a71, v11, s[84:87], s13 offen offset:896 sc1
buffer_load_dword a72, v11, s[84:87], s13 offen offset:1024 sc1
buffer_load_dword a73, v11, s[84:87], s13 offen offset:1152 sc1
buffer_load_dword a74, v11, s[84:87], s13 offen offset:1280 sc1
buffer_load_dword a75, v11, s[84:87], s13 offen offset:1408 sc1
buffer_load_dword a76, v11, s[84:87], s13 offen offset:1536 sc1
buffer_load_dword a77, v11, s[84:87], s13 offen offset:1664 sc1
buffer_load_dword a78, v11, s[84:87], s13 offen offset:1792 sc1
buffer_load_dword a79, v11, s[84:87], s13 offen offset:1920 sc1
buffer_load_dword a80, v11, s[84:87], s13 offen offset:2048 sc1
buffer_load_dword a81, v11, s[84:87], s13 offen offset:2176 sc1
buffer_load_dword a82, v11, s[84:87], s13 offen offset:2304 sc1
buffer_load_dword a83, v11, s[84:87], s13 offen offset:2432 sc1
buffer_load_dword a84, v11, s[84:87], s13 offen offset:2560 sc1
buffer_load_dword a85, v11, s[84:87], s13 offen offset:2688 sc1
buffer_load_dword a86, v11, s[84:87], s13 offen offset:2816 sc1
buffer_load_dword a87, v11, s[84:87], s13 offen offset:2944 sc1
buffer_load_dword a88, v11, s[84:87], s13 offen offset:3072 sc1
buffer_load_dword a89, v11, s[84:87], s13 offen offset:3200 sc1
buffer_load_dword a90, v11, s[84:87], s13 offen offset:3328 sc1
buffer_load_dword a91, v11, s[84:87], s13 offen offset:3456 sc1
buffer_load_dword a92, v11, s[84:87], s13 offen offset:3584 sc1
buffer_load_dword a93, v11, s[84:87], s13 offen offset:3712 sc1
buffer_load_dword a94, v11, s[84:87], s13 offen offset:3840 sc1
buffer_load_dword a95, v11, s[84:87], s13 offen offset:3968 sc1
v_pk_add_f32 v[14:15], v[16:17], v[48:49] neg_lo:[0,1] neg_hi:[0,1]
v_pk_add_f32 v[16:17], v[16:17], v[48:49]
v_pk_add_f32 v[48:49], v[18:19], v[50:51] neg_lo:[0,1] neg_hi:[0,1]
v_pk_add_f32 v[18:19], v[18:19], v[50:51]
v_pk_mul_f32 v[50:51], v[48:49], s[50:51] op_sel:[0,0] op_sel_hi:[0,1] neg_lo:[0,0] neg_hi:[0,1]
v_pk_fma_f32 v[50:51], v[48:49], s[50:51], v[50:51] op_sel:[1,1,0] op_sel_hi:[1,0,1] neg_lo:[0,0,0] neg_hi:[0,0,0]
v_pk_add_f32 v[48:49], v[20:21], v[52:53] neg_lo:[0,1] neg_hi:[0,1]
v_pk_add_f32 v[20:21], v[20:21], v[52:53]
v_pk_mul_f32 v[52:53], v[48:49], s[54:55] op_sel:[0,0] op_sel_hi:[0,1] neg_lo:[0,0] neg_hi:[0,1]
v_pk_fma_f32 v[52:53], v[48:49], s[54:55], v[52:53] op_sel:[1,1,0] op_sel_hi:[1,0,1] neg_lo:[0,0,0] neg_hi:[0,0,0]
v_pk_add_f32 v[48:49], v[22:23], v[54:55] neg_lo:[0,1] neg_hi:[0,1]
v_pk_add_f32 v[22:23], v[22:23], v[54:55]
v_pk_mul_f32 v[54:55], v[48:49], s[58:59] op_sel:[0,0] op_sel_hi:[0,1] neg_lo:[0,0] neg_hi:[0,1]
v_pk_fma_f32 v[54:55], v[48:49], s[58:59], v[54:55] op_sel:[1,1,0] op_sel_hi:[1,0,1] neg_lo:[0,0,0] neg_hi:[0,0,0]
v_pk_add_f32 v[48:49], v[24:25], v[56:57] neg_lo:[0,1] neg_hi:[0,1]
v_pk_add_f32 v[24:25], v[24:25], v[56:57]
v_pk_mul_f32 v[56:57], v[48:49], s[62:63] op_sel:[0,0] op_sel_hi:[0,1] neg_lo:[0,0] neg_hi:[0,1]
v_pk_fma_f32 v[56:57], v[48:49], s[62:63], v[56:57] op_sel:[1,1,0] op_sel_hi:[1,0,1] neg_lo:[0,0,0] neg_hi:[0,0,0]
v_pk_add_f32 v[48:49], v[26:27], v[58:59] neg_lo:[0,1] neg_hi:[0,1]
v_pk_add_f32 v[26:27], v[26:27], v[58:59]
v_pk_mul_f32 v[58:59], v[48:49], s[58:59] op_sel:[0,1] op_sel_hi:[0,0] neg_lo:[0,0] neg_hi:[0,1]
v_pk_fma_f32 v[58:59], v[48:49], s[58:59], v[58:59] op_sel:[1,0,0] op_sel_hi:[1,1,1] neg_lo:[0,0,0] neg_hi:[0,0,0]
v_pk_add_f32 v[48:49], v[28:29], v[60:61] neg_lo:[0,1] neg_hi:[0,1]
v_pk_add_f32 v[28:29], v[28:29], v[60:61]
v_pk_mul_f32 v[60:61], v[48:49], s[54:55] op_sel:[0,1] op_sel_hi:[0,0] neg_lo:[0,0] neg_hi:[0,1]
v_pk_fma_f32 v[60:61], v[48:49], s[54:55], v[60:61] op_sel:[1,0,0] op_sel_hi:[1,1,1] neg_lo:[0,0,0] neg_hi:[0,0,0]
v_pk_add_f32 v[48:49], v[30:31], v[62:63] neg_lo:[0,1] neg_hi:[0,1]
v_pk_add_f32 v[30:31], v[30:31], v[62:63]
v_pk_mul_f32 v[62:63], v[48:49], s[50:51] op_sel:[0,1] op_sel_hi:[0,0] neg_lo:[0,0] neg_hi:[0,1]
v_pk_fma_f32 v[62:63], v[48:49], s[50:51], v[62:63] op_sel:[1,0,0] op_sel_hi:[1,1,1] neg_lo:[0,0,0] neg_hi:[0,0,0]
v_pk_add_f32 v[48:49], v[32:33], v[64:65] op_sel:[1,1] op_sel_hi:[0,0] neg_lo:[0,1] neg_hi:[1,0]
v_pk_add_f32 v[32:33], v[32:33], v[64:65]
v_pk_add_f32 v[64:65], v[34:35], v[66:67] neg_lo:[0,1] neg_hi:[0,1]
v_pk_add_f32 v[34:35], v[34:35], v[66:67]
v_pk_mul_f32 v[66:67], v[64:65], s[50:51] op_sel:[0,1] op_sel_hi:[0,0] neg_lo:[0,1] neg_hi:[0,1]
v_pk_fma_f32 v[66:67], v[64:65], s[50:51], v[66:67] op_sel:[1,0,0] op_sel_hi:[1,1,1] neg_lo:[0,0,0] neg_hi:[0,1,0]
v_pk_add_f32 v[64:65], v[36:37], v[68:69] neg_lo:[0,1] neg_hi:[0,1]
v_pk_add_f32 v[36:37], v[36:37], v[68:69]
v_pk_mul_f32 v[68:69], v[64:65], s[54:55] op_sel:[0,1] op_sel_hi:[0,0] neg_lo:[0,1] neg_hi:[0,1]
v_pk_fma_f32 v[68:69], v[64:65], s[54:55], v[68:69] op_sel:[1,0,0] op_sel_hi:[1,1,1] neg_lo:[0,0,0] neg_hi:[0,1,0]
v_pk_add_f32 v[64:65], v[38:39], v[70:71] neg_lo:[0,1] neg_hi:[0,1]
v_pk_add_f32 v[38:39], v[38:39], v[70:71]
v_pk_mul_f32 v[70:71], v[64:65], s[58:59] op_sel:[0,1] op_sel_hi:[0,0] neg_lo:[0,1] neg_hi:[0,1]
v_pk_fma_f32 v[70:71], v[64:65], s[58:59], v[70:71] op_sel:[1,0,0] op_sel_hi:[1,1,1] neg_lo:[0,0,0] neg_hi:[0,1,0]
v_pk_add_f32 v[64:65], v[40:41], v[72:73] neg_lo:[0,1] neg_hi:[0,1]
v_pk_add_f32 v[40:41], v[40:41], v[72:73]
v_pk_mul_f32 v[72:73], v[64:65], s[62:63] op_sel:[0,0] op_sel_hi:[0,1] neg_lo:[0,1] neg_hi:[0,1]
v_pk_fma_f32 v[72:73], v[64:65], s[62:63], v[72:73] op_sel:[1,1,0] op_sel_hi:[1,0,1] neg_lo:[0,0,0] neg_hi:[0,1,0]
v_pk_add_f32 v[64:65], v[42:43], v[74:75] neg_lo:[0,1] neg_hi:[0,1]
v_pk_add_f32 v[42:43], v[42:43], v[74:75]
v_pk_mul_f32 v[74:75], v[64:65], s[58:59] op_sel:[0,0] op_sel_hi:[0,1] neg_lo:[0,1] neg_hi:[0,1]
v_pk_fma_f32 v[74:75], v[64:65], s[58:59], v[74:75] op_sel:[1,1,0] op_sel_hi:[1,0,1] neg_lo:[0,0,0] neg_hi:[0,1,0]
v_pk_add_f32 v[64:65], v[44:45], v[76:77] neg_lo:[0,1] neg_hi:[0,1]
v_pk_add_f32 v[44:45], v[44:45], v[76:77]
v_pk_mul_f32 v[76:77], v[64:65], s[54:55] op_sel:[0,0] op_sel_hi:[0,1] neg_lo:[0,1] neg_hi:[0,1]
v_pk_fma_f32 v[76:77], v[64:65], s[54:55], v[76:77] op_sel:[1,1,0] op_sel_hi:[1,0,1] neg_lo:[0,0,0] neg_hi:[0,1,0]
v_pk_add_f32 v[64:65], v[46:47], v[78:79] neg_lo:[0,1] neg_hi:[0,1]
v_pk_add_f32 v[46:47], v[46:47], v[78:79]
v_pk_mul_f32 v[78:79], v[64:65], s[50:51] op_sel:[0,0] op_sel_hi:[0,1] neg_lo:[0,1] neg_hi:[0,1]
v_pk_fma_f32 v[78:79], v[64:65], s[50:51], v[78:79] op_sel:[1,1,0] op_sel_hi:[1,0,1] neg_lo:[0,0,0] neg_hi:[0,1,0]
v_pk_add_f32 v[64:65], v[16:17], v[32:33] neg_lo:[0,1] neg_hi:[0,1]
v_pk_add_f32 v[16:17], v[16:17], v[32:33]
v_pk_add_f32 v[32:33], v[18:19], v[34:35] neg_lo:[0,1] neg_hi:[0,1]
v_pk_add_f32 v[18:19], v[18:19], v[34:35]
v_pk_mul_f32 v[34:35], v[32:33], s[54:55] op_sel:[0,0] op_sel_hi:[0,1] neg_lo:[0,0] neg_hi:[0,1]
v_pk_fma_f32 v[34:35], v[32:33], s[54:55], v[34:35] op_sel:[1,1,0] op_sel_hi:[1,0,1] neg_lo:[0,0,0] neg_hi:[0,0,0]
v_pk_add_f32 v[32:33], v[20:21], v[36:37] neg_lo:[0,1] neg_hi:[0,1]
v_pk_add_f32 v[20:21], v[20:21], v[36:37]
v_pk_mul_f32 v[36:37], v[32:33], s[62:63] op_sel:[0,0] op_sel_hi:[0,1] neg_lo:[0,0] neg_hi:[0,1]
v_pk_fma_f32 v[36:37], v[32:33], s[62:63], v[36:37] op_sel:[1,1,0] op_sel_hi:[1,0,1] neg_lo:[0,0,0] neg_hi:[0,0,0]
v_pk_add_f32 v[32:33], v[22:23], v[38:39] neg_lo:[0,1] neg_hi:[0,1]
v_pk_add_f32 v[22:23], v[22:23], v[38:39]
v_pk_mul_f32 v[38:39], v[32:33], s[54:55] op_sel:[0,1] op_sel_hi:[0,0] neg_lo:[0,0] neg_hi:[0,1]
v_pk_fma_f32 v[38:39], v[32:33], s[54:55], v[38:39] op_sel:[1,0,0] op_sel_hi:[1,1,1] neg_lo:[0,0,0] neg_hi:[0,0,0]
v_pk_add_f32 v[32:33], v[24:25], v[40:41] op_sel:[1,1] op_sel_hi:[0,0] neg_lo:[0,1] neg_hi:[1,0]
v_pk_add_f32 v[24:25], v[24:25], v[40:41]
v_pk_add_f32 v[40:41], v[26:27], v[42:43] neg_lo:[0,1] neg_hi:[0,1]
v_pk_add_f32 v[26:27], v[26:27], v[42:43]
v_pk_mul_f32 v[42:43], v[40:41], s[54:55] op_sel:[0,1] op_sel_hi:[0,0] neg_lo:[0,1] neg_hi:[0,1]
v_pk_fma_f32 v[42:43], v[40:41], s[54:55], v[42:43] op_sel:[1,0,0] op_sel_hi:[1,1,1] neg_lo:[0,0,0] neg_hi:[0,1,0]
v_pk_add_f32 v[40:41], v[28:29], v[44:45] neg_lo:[0,1] neg_hi:[0,1]
v_pk_add_f32 v[28:29], v[28:29], v[44:45]
v_pk_mul_f32 v[44:45], v[40:41], s[62:63] op_sel:[0,0] op_sel_hi:[0,1] neg_lo:[0,1] neg_hi:[0,1]
v_pk_fma_f32 v[44:45], v[40:41], s[62:63], v[44:45] op_sel:[1,1,0] op_sel_hi:[1,0,1] neg_lo:[0,0,0] neg_hi:[0,1,0]
v_pk_add_f32 v[40:41], v[30:31], v[46:47] neg_lo:[0,1] neg_hi:[0,1]
v_pk_add_f32 v[30:31], v[30:31], v[46:47]
v_pk_mul_f32 v[46:47], v[40:41], s[54:55] op_sel:[0,0] op_sel_hi:[0,1] neg_lo:[0,1] neg_hi:[0,1]
v_pk_fma_f32 v[46:47], v[40:41], s[54:55], v[46:47] op_sel:[1,1,0] op_sel_hi:[1,0,1] neg_lo:[0,0,0] neg_hi:[0,1,0]
v_pk_add_f32 v[40:41], v[14:15], v[48:49] neg_lo:[0,1] neg_hi:[0,1]
v_pk_add_f32 v[14:15], v[14:15], v[48:49]
v_pk_add_f32 v[48:49], v[50:51], v[66:67] neg_lo:[0,1] neg_hi:[0,1]
v_pk_add_f32 v[50:51], v[50:51], v[66:67]
v_pk_mul_f32 v[66:67], v[48:49], s[54:55] op_sel:[0,0] op_sel_hi:[0,1] neg_lo:[0,0] neg_hi:[0,1]
v_pk_fma_f32 v[66:67], v[48:49], s[54:55], v[66:67] op_sel:[1,1,0] op_sel_hi:[1,0,1] neg_lo:[0,0,0] neg_hi:[0,0,0]
v_pk_add_f32 v[48:49], v[52:53], v[68:69] neg_lo:[0,1] neg_hi:[0,1]
v_pk_add_f32 v[52:53], v[52:53], v[68:69]
v_pk_mul_f32 v[68:69], v[48:49], s[62:63] op_sel:[0,0] op_sel_hi:[0,1] neg_lo:[0,0] neg_hi:[0,1]
v_pk_fma_f32 v[68:69], v[48:49], s[62:63], v[68:69] op_sel:[1,1,0] op_sel_hi:[1,0,1] neg_lo:[0,0,0] neg_hi:[0,0,0]
v_pk_add_f32 v[48:49], v[54:55], v[70:71] neg_lo:[0,1] neg_hi:[0,1]
v_pk_add_f32 v[54:55], v[54:55], v[70:71]
v_pk_mul_f32 v[70:71], v[48:49], s[54:55] op_sel:[0,1] op_sel_hi:[0,0] neg_lo:[0,0] neg_hi:[0,1]
v_pk_fma_f32 v[70:71], v[48:49], s[54:55], v[70:71] op_sel:[1,0,0] op_sel_hi:[1,1,1] neg_lo:[0,0,0] neg_hi:[0,0,0]
v_pk_add_f32 v[48:49], v[56:57], v[72:73] op_sel:[1,1] op_sel_hi:[0,0] neg_lo:[0,1] neg_hi:[1,0]
v_pk_add_f32 v[56:57], v[56:57], v[72:73]
v_pk_add_f32 v[72:73], v[58:59], v[74:75] neg_lo:[0,1] neg_hi:[0,1]
v_pk_add_f32 v[58:59], v[58:59], v[74:75]
v_pk_mul_f32 v[74:75], v[72:73], s[54:55] op_sel:[0,1] op_sel_hi:[0,0] neg_lo:[0,1] neg_hi:[0,1]
v_pk_fma_f32 v[74:75], v[72:73], s[54:55], v[74:75] op_sel:[1,0,0] op_sel_hi:[1,1,1] neg_lo:[0,0,0] neg_hi:[0,1,0]
v_pk_add_f32 v[72:73], v[60:61], v[76:77] neg_lo:[0,1] neg_hi:[0,1]
v_pk_add_f32 v[60:61], v[60:61], v[76:77]
v_pk_mul_f32 v[76:77], v[72:73], s[62:63] op_sel:[0,0] op_sel_hi:[0,1] neg_lo:[0,1] neg_hi:[0,1]
v_pk_fma_f32 v[76:77], v[72:73], s[62:63], v[76:77] op_sel:[1,1,0] op_sel_hi:[1,0,1] neg_lo:[0,0,0] neg_hi:[0,1,0]
v_pk_add_f32 v[72:73], v[62:63], v[78:79] neg_lo:[0,1] neg_hi:[0,1]
v_pk_add_f32 v[62:63], v[62:63], v[78:79]
v_pk_mul_f32 v[78:79], v[72:73], s[54:55] op_sel:[0,0] op_sel_hi:[0,1] neg_lo:[0,1] neg_hi:[0,1]
v_pk_fma_f32 v[78:79], v[72:73], s[54:55], v[78:79] op_sel:[1,1,0] op_sel_hi:[1,0,1] neg_lo:[0,0,0] neg_hi:[0,1,0]
v_pk_add_f32 v[72:73], v[16:17], v[24:25] neg_lo:[0,1] neg_hi:[0,1]
v_pk_add_f32 v[16:17], v[16:17], v[24:25]
v_pk_add_f32 v[24:25], v[18:19], v[26:27] neg_lo:[0,1] neg_hi:[0,1]
v_pk_add_f32 v[18:19], v[18:19], v[26:27]
v_pk_mul_f32 v[26:27], v[24:25], s[62:63] op_sel:[0,0] op_sel_hi:[0,1] neg_lo:[0,0] neg_hi:[0,1]
v_pk_fma_f32 v[26:27], v[24:25], s[62:63], v[26:27] op_sel:[1,1,0] op_sel_hi:[1,0,1] neg_lo:[0,0,0] neg_hi:[0,0,0]
v_pk_add_f32 v[24:25], v[20:21], v[28:29] op_sel:[1,1] op_sel_hi:[0,0] neg_lo:[0,1] neg_hi:[1,0]
v_pk_add_f32 v[20:21], v[20:21], v[28:29]
v_pk_add_f32 v[28:29], v[22:23], v[30:31] neg_lo:[0,1] neg_hi:[0,1]
v_pk_add_f32 v[22:23], v[22:23], v[30:31]
v_pk_mul_f32 v[30:31], v[28:29], s[62:63] op_sel:[0,0] op_sel_hi:[0,1] neg_lo:[0,1] neg_hi:[0,1]
v_pk_fma_f32 v[30:31], v[28:29], s[62:63], v[30:31] op_sel:[1,1,0] op_sel_hi:[1,0,1] neg_lo:[0,0,0] neg_hi:[0,1,0]
v_pk_add_f32 v[28:29], v[64:65], v[32:33] neg_lo:[0,1] neg_hi:[0,1]
v_pk_add_f32 v[64:65], v[64:65], v[32:33]
v_pk_add_f32 v[32:33], v[34:35], v[42:43] neg_lo:[0,1] neg_hi:[0,1]
v_pk_add_f32 v[34:35], v[34:35], v[42:43]
v_pk_mul_f32 v[42:43], v[32:33], s[62:63] op_sel:[0,0] op_sel_hi:[0,1] neg_lo:[0,0] neg_hi:[0,1]
v_pk_fma_f32 v[42:43], v[32:33], s[62:63], v[42:43] op_sel:[1,1,0] op_sel_hi:[1,0,1] neg_lo:[0,0,0] neg_hi:[0,0,0]
v_pk_add_f32 v[32:33], v[36:37], v[44:45] op_sel:[1,1] op_sel_hi:[0,0] neg_lo:[0,1] neg_hi:[1,0]
v_pk_add_f32 v[36:37], v[36:37], v[44:45]
v_pk_add_f32 v[44:45], v[38:39], v[46:47] neg_lo:[0,1] neg_hi:[0,1]
v_pk_add_f32 v[38:39], v[38:39], v[46:47]
v_pk_mul_f32 v[46:47], v[44:45], s[62:63] op_sel:[0,0] op_sel_hi:[0,1] neg_lo:[0,1] neg_hi:[0,1]
v_pk_fma_f32 v[46:47], v[44:45], s[62:63], v[46:47] op_sel:[1,1,0] op_sel_hi:[1,0,1] neg_lo:[0,0,0] neg_hi:[0,1,0]
v_pk_add_f32 v[44:45], v[14:15], v[56:57] neg_lo:[0,1] neg_hi:[0,1]
v_pk_add_f32 v[14:15], v[14:15], v[56:57]
v_pk_add_f32 v[56:57], v[50:51], v[58:59] neg_lo:[0,1] neg_hi:[0,1]
v_pk_add_f32 v[50:51], v[50:51], v[58:59]
v_pk_mul_f32 v[58:59], v[56:57], s[62:63] op_sel:[0,0] op_sel_hi:[0,1] neg_lo:[0,0] neg_hi:[0,1]
v_pk_fma_f32 v[58:59], v[56:57], s[62:63], v[58:59] op_sel:[1,1,0] op_sel_hi:[1,0,1] neg_lo:[0,0,0] neg_hi:[0,0,0]
v_pk_add_f32 v[56:57], v[52:53], v[60:61] op_sel:[1,1] op_sel_hi:[0,0] neg_lo:[0,1] neg_hi:[1,0]
v_pk_add_f32 v[52:53], v[52:53], v[60:61]
v_pk_add_f32 v[60:61], v[54:55], v[62:63] neg_lo:[0,1] neg_hi:[0,1]
v_pk_add_f32 v[54:55], v[54:55], v[62:63]
v_pk_mul_f32 v[62:63], v[60:61], s[62:63] op_sel:[0,0] op_sel_hi:[0,1] neg_lo:[0,1] neg_hi:[0,1]
v_pk_fma_f32 v[62:63], v[60:61], s[62:63], v[62:63] op_sel:[1,1,0] op_sel_hi:[1,0,1] neg_lo:[0,0,0] neg_hi:[0,1,0]
v_pk_add_f32 v[60:61], v[40:41], v[48:49] neg_lo:[0,1] neg_hi:[0,1]
v_pk_add_f32 v[40:41], v[40:41], v[48:49]
v_pk_add_f32 v[48:49], v[66:67], v[74:75] neg_lo:[0,1] neg_hi:[0,1]
v_pk_add_f32 v[66:67], v[66:67], v[74:75]
v_pk_mul_f32 v[74:75], v[48:49], s[62:63] op_sel:[0,0] op_sel_hi:[0,1] neg_lo:[0,0] neg_hi:[0,1]
v_pk_fma_f32 v[74:75], v[48:49], s[62:63], v[74:75] op_sel:[1,1,0] op_sel_hi:[1,0,1] neg_lo:[0,0,0] neg_hi:[0,0,0]
v_pk_add_f32 v[48:49], v[68:69], v[76:77] op_sel:[1,1] op_sel_hi:[0,0] neg_lo:[0,1] neg_hi:[1,0]
v_pk_add_f32 v[68:69], v[68:69], v[76:77]
v_pk_add_f32 v[76:77], v[70:71], v[78:79] neg_lo:[0,1] neg_hi:[0,1]
v_pk_add_f32 v[70:71], v[70:71], v[78:79]
v_pk_mul_f32 v[78:79], v[76:77], s[62:63] op_sel:[0,0] op_sel_hi:[0,1] neg_lo:[0,1] neg_hi:[0,1]
v_pk_fma_f32 v[78:79], v[76:77], s[62:63], v[78:79] op_sel:[1,1,0] op_sel_hi:[1,0,1] neg_lo:[0,0,0] neg_hi:[0,1,0]
v_pk_add_f32 v[76:77], v[16:17], v[20:21] neg_lo:[0,1] neg_hi:[0,1]
v_pk_add_f32 v[16:17], v[16:17], v[20:21]
v_pk_add_f32 v[20:21], v[18:19], v[22:23] op_sel:[1,1] op_sel_hi:[0,0] neg_lo:[0,1] neg_hi:[1,0]
v_pk_add_f32 v[18:19], v[18:19], v[22:23]
v_pk_add_f32 v[22:23], v[72:73], v[24:25] neg_lo:[0,1] neg_hi:[0,1]
v_pk_add_f32 v[72:73], v[72:73], v[24:25]
v_pk_add_f32 v[24:25], v[26:27], v[30:31] op_sel:[1,1] op_sel_hi:[0,0] neg_lo:[0,1] neg_hi:[1,0]
v_pk_add_f32 v[26:27], v[26:27], v[30:31]
v_pk_add_f32 v[30:31], v[64:65], v[36:37] neg_lo:[0,1] neg_hi:[0,1]
v_pk_add_f32 v[64:65], v[64:65], v[36:37]
v_pk_add_f32 v[36:37], v[34:35], v[38:39] op_sel:[1,1] op_sel_hi:[0,0] neg_lo:[0,1] neg_hi:[1,0]
v_pk_add_f32 v[34:35], v[34:35], v[38:39]
v_pk_add_f32 v[38:39], v[28:29], v[32:33] neg_lo:[0,1] neg_hi:[0,1]
v_pk_add_f32 v[28:29], v[28:29], v[32:33]
v_pk_add_f32 v[32:33], v[42:43], v[46:47] op_sel:[1,1] op_sel_hi:[0,0] neg_lo:[0,1] neg_hi:[1,0]
v_pk_add_f32 v[42:43], v[42:43], v[46:47]
v_pk_add_f32 v[46:47], v[14:15], v[52:53] neg_lo:[0,1] neg_hi:[0,1]
v_pk_add_f32 v[14:15], v[14:15], v[52:53]
v_pk_add_f32 v[52:53], v[50:51], v[54:55] op_sel:[1,1] op_sel_hi:[0,0] neg_lo:[0,1] neg_hi:[1,0]
v_pk_add_f32 v[50:51], v[50:51], v[54:55]
v_pk_add_f32 v[54:55], v[44:45], v[56:57] neg_lo:[0,1] neg_hi:[0,1]
v_pk_add_f32 v[44:45], v[44:45], v[56:57]
v_pk_add_f32 v[56:57], v[58:59], v[62:63] op_sel:[1,1] op_sel_hi:[0,0] neg_lo:[0,1] neg_hi:[1,0]
v_pk_add_f32 v[58:59], v[58:59], v[62:63]
v_pk_add_f32 v[62:63], v[40:41], v[68:69] neg_lo:[0,1] neg_hi:[0,1]
v_pk_add_f32 v[40:41], v[40:41], v[68:69]
v_pk_add_f32 v[68:69], v[66:67], v[70:71] op_sel:[1,1] op_sel_hi:[0,0] neg_lo:[0,1] neg_hi:[1,0]
v_pk_add_f32 v[66:67], v[66:67], v[70:71]
v_pk_add_f32 v[70:71], v[60:61], v[48:49] neg_lo:[0,1] neg_hi:[0,1]
v_pk_add_f32 v[60:61], v[60:61], v[48:49]
v_pk_add_f32 v[48:49], v[74:75], v[78:79] op_sel:[1,1] op_sel_hi:[0,0] neg_lo:[0,1] neg_hi:[1,0]
v_pk_add_f32 v[74:75], v[74:75], v[78:79]
v_pk_add_f32 v[78:79], v[16:17], v[18:19] neg_lo:[0,1] neg_hi:[0,1]
v_pk_add_f32 v[16:17], v[16:17], v[18:19]
v_pk_add_f32 v[18:19], v[76:77], v[20:21] neg_lo:[0,1] neg_hi:[0,1]
v_pk_add_f32 v[76:77], v[76:77], v[20:21]
v_pk_add_f32 v[20:21], v[72:73], v[26:27] neg_lo:[0,1] neg_hi:[0,1]
v_pk_add_f32 v[72:73], v[72:73], v[26:27]
v_pk_add_f32 v[26:27], v[22:23], v[24:25] neg_lo:[0,1] neg_hi:[0,1]
v_pk_add_f32 v[22:23], v[22:23], v[24:25]
v_pk_add_f32 v[24:25], v[64:65], v[34:35] neg_lo:[0,1] neg_hi:[0,1]
v_pk_add_f32 v[64:65], v[64:65], v[34:35]
v_pk_add_f32 v[34:35], v[30:31], v[36:37] neg_lo:[0,1] neg_hi:[0,1]
v_pk_add_f32 v[30:31], v[30:31], v[36:37]
v_pk_add_f32 v[36:37], v[28:29], v[42:43] neg_lo:[0,1] neg_hi:[0,1]
v_pk_add_f32 v[28:29], v[28:29], v[42:43]
v_pk_add_f32 v[42:43], v[38:39], v[32:33] neg_lo:[0,1] neg_hi:[0,1]
v_pk_add_f32 v[38:39], v[38:39], v[32:33]
v_pk_add_f32 v[32:33], v[14:15], v[50:51] neg_lo:[0,1] neg_hi:[0,1]
v_pk_add_f32 v[14:15], v[14:15], v[50:51]
v_pk_add_f32 v[50:51], v[46:47], v[52:53] neg_lo:[0,1] neg_hi:[0,1]
v_pk_add_f32 v[46:47], v[46:47], v[52:53]
v_pk_add_f32 v[52:53], v[44:45], v[58:59] neg_lo:[0,1] neg_hi:[0,1]
v_pk_add_f32 v[44:45], v[44:45], v[58:59]
v_pk_add_f32 v[58:59], v[54:55], v[56:57] neg_lo:[0,1] neg_hi:[0,1]
v_pk_add_f32 v[54:55], v[54:55], v[56:57]
v_pk_add_f32 v[56:57], v[40:41], v[66:67] neg_lo:[0,1] neg_hi:[0,1]
v_pk_add_f32 v[40:41], v[40:41], v[66:67]
v_pk_add_f32 v[66:67], v[62:63], v[68:69] neg_lo:[0,1] neg_hi:[0,1]
v_pk_add_f32 v[62:63], v[62:63], v[68:69]
v_pk_add_f32 v[68:69], v[60:61], v[74:75] neg_lo:[0,1] neg_hi:[0,1]
v_pk_add_f32 v[60:61], v[60:61], v[74:75]
v_pk_add_f32 v[74:75], v[70:71], v[48:49] neg_lo:[0,1] neg_hi:[0,1]
v_pk_add_f32 v[70:71], v[70:71], v[48:49]
v_pk_mul_f32 v[48:49], v[14:15], v[82:83] op_sel:[0,0] op_sel_hi:[0,1] neg_lo:[0,0] neg_hi:[0,0]
v_pk_fma_f32 v[14:15], v[14:15], v[82:83], v[48:49] op_sel:[1,1,0] op_sel_hi:[1,0,1] neg_lo:[0,1,0] neg_hi:[0,0,0]
v_pk_mul_f32 v[48:49], v[64:65], v[84:85] op_sel:[0,0] op_sel_hi:[0,1] neg_lo:[0,0] neg_hi:[0,0]
v_pk_fma_f32 v[64:65], v[64:65], v[84:85], v[48:49] op_sel:[1,1,0] op_sel_hi:[1,0,1] neg_lo:[0,1,0] neg_hi:[0,0,0]
v_pk_mul_f32 v[48:49], v[40:41], v[86:87] op_sel:[0,0] op_sel_hi:[0,1] neg_lo:[0,0] neg_hi:[0,0]
v_pk_fma_f32 v[40:41], v[40:41], v[86:87], v[48:49] op_sel:[1,1,0] op_sel_hi:[1,0,1] neg_lo:[0,1,0] neg_hi:[0,0,0]
v_pk_mul_f32 v[48:49], v[72:73], v[88:89] op_sel:[0,0] op_sel_hi:[0,1] neg_lo:[0,0] neg_hi:[0,0]
v_pk_fma_f32 v[72:73], v[72:73], v[88:89], v[48:49] op_sel:[1,1,0] op_sel_hi:[1,0,1] neg_lo:[0,1,0] neg_hi:[0,0,0]
v_pk_mul_f32 v[48:49], v[44:45], v[90:91] op_sel:[0,0] op_sel_hi:[0,1] neg_lo:[0,0] neg_hi:[0,0]
v_pk_fma_f32 v[44:45], v[44:45], v[90:91], v[48:49] op_sel:[1,1,0] op_sel_hi:[1,0,1] neg_lo:[0,1,0] neg_hi:[0,0,0]
v_pk_mul_f32 v[48:49], v[28:29], v[92:93] op_sel:[0,0] op_sel_hi:[0,1] neg_lo:[0,0] neg_hi:[0,0]
v_pk_fma_f32 v[28:29], v[28:29], v[92:93], v[48:49] op_sel:[1,1,0] op_sel_hi:[1,0,1] neg_lo:[0,1,0] neg_hi:[0,0,0]
v_pk_mul_f32 v[48:49], v[60:61], v[94:95] op_sel:[0,0] op_sel_hi:[0,1] neg_lo:[0,0] neg_hi:[0,0]
v_pk_fma_f32 v[60:61], v[60:61], v[94:95], v[48:49] op_sel:[1,1,0] op_sel_hi:[1,0,1] neg_lo:[0,1,0] neg_hi:[0,0,0]
v_pk_mul_f32 v[48:49], v[76:77], v[96:97] op_sel:[0,0] op_sel_hi:[0,1] neg_lo:[0,0] neg_hi:[0,0]
v_pk_fma_f32 v[76:77], v[76:77], v[96:97], v[48:49] op_sel:[1,1,0] op_sel_hi:[1,0,1] neg_lo:[0,1,0] neg_hi:[0,0,0]
v_pk_mul_f32 v[48:49], v[46:47], v[98:99] op_sel:[0,0] op_sel_hi:[0,1] neg_lo:[0,0] neg_hi:[0,0]
v_pk_fma_f32 v[46:47], v[46:47], v[98:99], v[48:49] op_sel:[1,1,0] op_sel_hi:[1,0,1] neg_lo:[0,1,0] neg_hi:[0,0,0]
v_pk_mul_f32 v[48:49], v[30:31], v[100:101] op_sel:[0,0] op_sel_hi:[0,1] neg_lo:[0,0] neg_hi:[0,0]
v_pk_fma_f32 v[30:31], v[30:31], v[100:101], v[48:49] op_sel:[1,1,0] op_sel_hi:[1,0,1] neg_lo:[0,1,0] neg_hi:[0,0,0]
v_pk_mul_f32 v[48:49], v[62:63], v[102:103] op_sel:[0,0] op_sel_hi:[0,1] neg_lo:[0,0] neg_hi:[0,0]
v_pk_fma_f32 v[62:63], v[62:63], v[102:103], v[48:49] op_sel:[1,1,0] op_sel_hi:[1,0,1] neg_lo:[0,1,0] neg_hi:[0,0,0]
v_pk_mul_f32 v[48:49], v[22:23], v[104:105] op_sel:[0,0] op_sel_hi:[0,1] neg_lo:[0,0] neg_hi:[0,0]
v_pk_fma_f32 v[22:23], v[22:23], v[104:105], v[48:49] op_sel:[1,1,0] op_sel_hi:[1,0,1] neg_lo:[0,1,0] neg_hi:[0,0,0]
v_pk_mul_f32 v[48:49], v[54:55], v[106:107] op_sel:[0,0] op_sel_hi:[0,1] neg_lo:[0,0] neg_hi:[0,0]
v_pk_fma_f32 v[54:55], v[54:55], v[106:107], v[48:49] op_sel:[1,1,0] op_sel_hi:[1,0,1] neg_lo:[0,1,0] neg_hi:[0,0,0]
v_pk_mul_f32 v[48:49], v[38:39], v[108:109] op_sel:[0,0] op_sel_hi:[0,1] neg_lo:[0,0] neg_hi:[0,0]
v_pk_fma_f32 v[38:39], v[38:39], v[108:109], v[48:49] op_sel:[1,1,0] op_sel_hi:[1,0,1] neg_lo:[0,1,0] neg_hi:[0,0,0]
v_pk_mul_f32 v[48:49], v[70:71], v[110:111] op_sel:[0,0] op_sel_hi:[0,1] neg_lo:[0,0] neg_hi:[0,0]
v_pk_fma_f32 v[70:71], v[70:71], v[110:111], v[48:49] op_sel:[1,1,0] op_sel_hi:[1,0,1] neg_lo:[0,1,0] neg_hi:[0,0,0]
v_pk_mul_f32 v[48:49], v[78:79], v[112:113] op_sel:[0,0] op_sel_hi:[0,1] neg_lo:[0,0] neg_hi:[0,0]
v_pk_fma_f32 v[78:79], v[78:79], v[112:113], v[48:49] op_sel:[1,1,0] op_sel_hi:[1,0,1] neg_lo:[0,1,0] neg_hi:[0,0,0]
v_pk_mul_f32 v[48:49], v[32:33], v[114:115] op_sel:[0,0] op_sel_hi:[0,1] neg_lo:[0,0] neg_hi:[0,0]
v_pk_fma_f32 v[32:33], v[32:33], v[114:115], v[48:49] op_sel:[1,1,0] op_sel_hi:[1,0,1] neg_lo:[0,1,0] neg_hi:[0,0,0]
v_pk_mul_f32 v[48:49], v[24:25], v[116:117] op_sel:[0,0] op_sel_hi:[0,1] neg_lo:[0,0] neg_hi:[0,0]
v_pk_fma_f32 v[24:25], v[24:25], v[116:117], v[48:49] op_sel:[1,1,0] op_sel_hi:[1,0,1] neg_lo:[0,1,0] neg_hi:[0,0,0]
v_pk_mul_f32 v[48:49], v[56:57], v[118:119] op_sel:[0,0] op_sel_hi:[0,1] neg_lo:[0,0] neg_hi:[0,0]
v_pk_fma_f32 v[56:57], v[56:57], v[118:119], v[48:49] op_sel:[1,1,0] op_sel_hi:[1,0,1] neg_lo:[0,1,0] neg_hi:[0,0,0]
v_pk_mul_f32 v[48:49], v[20:21], v[120:121] op_sel:[0,0] op_sel_hi:[0,1] neg_lo:[0,0] neg_hi:[0,0]
v_pk_fma_f32 v[20:21], v[20:21], v[120:121], v[48:49] op_sel:[1,1,0] op_sel_hi:[1,0,1] neg_lo:[0,1,0] neg_hi:[0,0,0]
v_pk_mul_f32 v[48:49], v[52:53], v[122:123] op_sel:[0,0] op_sel_hi:[0,1] neg_lo:[0,0] neg_hi:[0,0]
v_pk_fma_f32 v[52:53], v[52:53], v[122:123], v[48:49] op_sel:[1,1,0] op_sel_hi:[1,0,1] neg_lo:[0,1,0] neg_hi:[0,0,0]
v_pk_mul_f32 v[48:49], v[36:37], v[124:125] op_sel:[0,0] op_sel_hi:[0,1] neg_lo:[0,0] neg_hi:[0,0]
v_pk_fma_f32 v[36:37], v[36:37], v[124:125], v[48:49] op_sel:[1,1,0] op_sel_hi:[1,0,1] neg_lo:[0,1,0] neg_hi:[0,0,0]
v_pk_mul_f32 v[48:49], v[68:69], v[126:127] op_sel:[0,0] op_sel_hi:[0,1] neg_lo:[0,0] neg_hi:[0,0]
v_pk_fma_f32 v[68:69], v[68:69], v[126:127], v[48:49] op_sel:[1,1,0] op_sel_hi:[1,0,1] neg_lo:[0,1,0] neg_hi:[0,0,0]
v_pk_mul_f32 v[48:49], v[18:19], v[128:129] op_sel:[0,0] op_sel_hi:[0,1] neg_lo:[0,0] neg_hi:[0,0]
v_pk_fma_f32 v[18:19], v[18:19], v[128:129], v[48:49] op_sel:[1,1,0] op_sel_hi:[1,0,1] neg_lo:[0,1,0] neg_hi:[0,0,0]
v_pk_mul_f32 v[48:49], v[50:51], v[130:131] op_sel:[0,0] op_sel_hi:[0,1] neg_lo:[0,0] neg_hi:[0,0]
v_pk_fma_f32 v[50:51], v[50:51], v[130:131], v[48:49] op_sel:[1,1,0] op_sel_hi:[1,0,1] neg_lo:[0,1,0] neg_hi:[0,0,0]
v_pk_mul_f32 v[48:49], v[34:35], v[132:133] op_sel:[0,0] op_sel_hi:[0,1] neg_lo:[0,0] neg_hi:[0,0]
v_pk_fma_f32 v[34:35], v[34:35], v[132:133], v[48:49] op_sel:[1,1,0] op_sel_hi:[1,0,1] neg_lo:[0,1,0] neg_hi:[0,0,0]
v_pk_mul_f32 v[48:49], v[66:67], v[134:135] op_sel:[0,0] op_sel_hi:[0,1] neg_lo:[0,0] neg_hi:[0,0]
v_pk_fma_f32 v[66:67], v[66:67], v[134:135], v[48:49] op_sel:[1,1,0] op_sel_hi:[1,0,1] neg_lo:[0,1,0] neg_hi:[0,0,0]
v_pk_mul_f32 v[48:49], v[26:27], v[136:137] op_sel:[0,0] op_sel_hi:[0,1] neg_lo:[0,0] neg_hi:[0,0]
v_pk_fma_f32 v[26:27], v[26:27], v[136:137], v[48:49] op_sel:[1,1,0] op_sel_hi:[1,0,1] neg_lo:[0,1,0] neg_hi:[0,0,0]
v_pk_mul_f32 v[48:49], v[58:59], v[138:139] op_sel:[0,0] op_sel_hi:[0,1] neg_lo:[0,0] neg_hi:[0,0]
v_pk_fma_f32 v[58:59], v[58:59], v[138:139], v[48:49] op_sel:[1,1,0] op_sel_hi:[1,0,1] neg_lo:[0,1,0] neg_hi:[0,0,0]
v_pk_mul_f32 v[48:49], v[42:43], v[140:141] op_sel:[0,0] op_sel_hi:[0,1] neg_lo:[0,0] neg_hi:[0,0]
v_pk_fma_f32 v[42:43], v[42:43], v[140:141], v[48:49] op_sel:[1,1,0] op_sel_hi:[1,0,1] neg_lo:[0,1,0] neg_hi:[0,0,0]
v_pk_mul_f32 v[48:49], v[74:75], v[142:143] op_sel:[0,0] op_sel_hi:[0,1] neg_lo:[0,0] neg_hi:[0,0]
v_pk_fma_f32 v[74:75], v[74:75], v[142:143], v[48:49] op_sel:[1,1,0] op_sel_hi:[1,0,1] neg_lo:[0,1,0] neg_hi:[0,0,0]
ds_write_b64 v3, v[16:17] offset:0
ds_write_b64 v3, v[14:15] offset:528
ds_write_b64 v3, v[64:65] offset:1056
ds_write_b64 v3, v[40:41] offset:1584
ds_write_b64 v3, v[72:73] offset:2112
ds_write_b64 v3, v[44:45] offset:2640
ds_write_b64 v3, v[28:29] offset:3168
ds_write_b64 v3, v[60:61] offset:3696
ds_write_b64 v3, v[76:77] offset:4224
ds_write_b64 v3, v[46:47] offset:4752
ds_write_b64 v3, v[30:31] offset:5280
ds_write_b64 v3, v[62:63] offset:5808
ds_write_b64 v3, v[22:23] offset:6336
ds_write_b64 v3, v[54:55] offset:6864
ds_write_b64 v3, v[38:39] offset:7392
ds_write_b64 v3, v[70:71] offset:7920
ds_write_b64 v3, v[78:79] offset:8448
ds_write_b64 v3, v[32:33] offset:8976
ds_write_b64 v3, v[24:25] offset:9504
ds_write_b64 v3, v[56:57] offset:10032
ds_write_b64 v3, v[20:21] offset:10560
ds_write_b64 v3, v[52:53] offset:11088
ds_write_b64 v3, v[36:37] offset:11616
ds_write_b64 v3, v[68:69] offset:12144
ds_write_b64 v3, v[18:19] offset:12672
ds_write_b64 v3, v[50:51] offset:13200
ds_write_b64 v3, v[34:35] offset:13728
ds_write_b64 v3, v[66:67] offset:14256
ds_write_b64 v3, v[26:27] offset:14784
ds_write_b64 v3, v[58:59] offset:15312
ds_write_b64 v3, v[42:43] offset:15840
ds_write_b64 v3, v[74:75] offset:16368
s_waitcnt lgkmcnt(0)
ds_read_b64 v[16:17], v4 offset:0
ds_read_b64 v[48:49], v4 offset:256
ds_read_b64 v[18:19], v4 offset:16
ds_read_b64 v[50:51], v4 offset:272
ds_read_b64 v[20:21], v4 offset:32
ds_read_b64 v[52:53], v4 offset:288
ds_read_b64 v[22:23], v4 offset:48
ds_read_b64 v[54:55], v4 offset:304
ds_read_b64 v[24:25], v4 offset:64
ds_read_b64 v[56:57], v4 offset:320
ds_read_b64 v[26:27], v4 offset:80
ds_read_b64 v[58:59], v4 offset:336
ds_read_b64 v[28:29], v4 offset:96
ds_read_b64 v[60:61], v4 offset:352
ds_read_b64 v[30:31], v4 offset:112
ds_read_b64 v[62:63], v4 offset:368
ds_read_b64 v[32:33], v4 offset:128
ds_read_b64 v[64:65], v4 offset:384
ds_read_b64 v[34:35], v4 offset:144
ds_read_b64 v[66:67], v4 offset:400
ds_read_b64 v[36:37], v4 offset:160
ds_read_b64 v[68:69], v4 offset:416
ds_read_b64 v[38:39], v4 offset:176
ds_read_b64 v[70:71], v4 offset:432
ds_read_b64 v[40:41], v4 offset:192
ds_read_b64 v[72:73], v4 offset:448
ds_read_b64 v[42:43], v4 offset:208
ds_read_b64 v[74:75], v4 offset:464
ds_read_b64 v[44:45], v4 offset:224
ds_read_b64 v[76:77], v4 offset:480
ds_read_b64 v[46:47], v4 offset:240
ds_read_b64 v[78:79], v4 offset:496
s_waitcnt lgkmcnt(0)
v_pk_add_f32 v[14:15], v[16:17], v[48:49] neg_lo:[0,1] neg_hi:[0,1]
v_pk_add_f32 v[16:17], v[16:17], v[48:49]
v_pk_add_f32 v[48:49], v[18:19], v[50:51] neg_lo:[0,1] neg_hi:[0,1]
v_pk_add_f32 v[18:19], v[18:19], v[50:51]
v_pk_mul_f32 v[50:51], v[48:49], s[50:51] op_sel:[0,0] op_sel_hi:[0,1] neg_lo:[0,0] neg_hi:[0,1]
v_pk_fma_f32 v[50:51], v[48:49], s[50:51], v[50:51] op_sel:[1,1,0] op_sel_hi:[1,0,1] neg_lo:[0,0,0] neg_hi:[0,0,0]
v_pk_add_f32 v[48:49], v[20:21], v[52:53] neg_lo:[0,1] neg_hi:[0,1]
v_pk_add_f32 v[20:21], v[20:21], v[52:53]
v_pk_mul_f32 v[52:53], v[48:49], s[54:55] op_sel:[0,0] op_sel_hi:[0,1] neg_lo:[0,0] neg_hi:[0,1]
v_pk_fma_f32 v[52:53], v[48:49], s[54:55], v[52:53] op_sel:[1,1,0] op_sel_hi:[1,0,1] neg_lo:[0,0,0] neg_hi:[0,0,0]
v_pk_add_f32 v[48:49], v[22:23], v[54:55] neg_lo:[0,1] neg_hi:[0,1]
v_pk_add_f32 v[22:23], v[22:23], v[54:55]
v_pk_mul_f32 v[54:55], v[48:49], s[58:59] op_sel:[0,0] op_sel_hi:[0,1] neg_lo:[0,0] neg_hi:[0,1]
v_pk_fma_f32 v[54:55], v[48:49], s[58:59], v[54:55] op_sel:[1,1,0] op_sel_hi:[1,0,1] neg_lo:[0,0,0] neg_hi:[0,0,0]
v_pk_add_f32 v[48:49], v[24:25], v[56:57] neg_lo:[0,1] neg_hi:[0,1]
v_pk_add_f32 v[24:25], v[24:25], v[56:57]
v_pk_mul_f32 v[56:57], v[48:49], s[62:63] op_sel:[0,0] op_sel_hi:[0,1] neg_lo:[0,0] neg_hi:[0,1]
v_pk_fma_f32 v[56:57], v[48:49], s[62:63], v[56:57] op_sel:[1,1,0] op_sel_hi:[1,0,1] neg_lo:[0,0,0] neg_hi:[0,0,0]
v_pk_add_f32 v[48:49], v[26:27], v[58:59] neg_lo:[0,1] neg_hi:[0,1]
v_pk_add_f32 v[26:27], v[26:27], v[58:59]
v_pk_mul_f32 v[58:59], v[48:49], s[58:59] op_sel:[0,1] op_sel_hi:[0,0] neg_lo:[0,0] neg_hi:[0,1]
v_pk_fma_f32 v[58:59], v[48:49], s[58:59], v[58:59] op_sel:[1,0,0] op_sel_hi:[1,1,1] neg_lo:[0,0,0] neg_hi:[0,0,0]
v_pk_add_f32 v[48:49], v[28:29], v[60:61] neg_lo:[0,1] neg_hi:[0,1]
v_pk_add_f32 v[28:29], v[28:29], v[60:61]
v_pk_mul_f32 v[60:61], v[48:49], s[54:55] op_sel:[0,1] op_sel_hi:[0,0] neg_lo:[0,0] neg_hi:[0,1]
v_pk_fma_f32 v[60:61], v[48:49], s[54:55], v[60:61] op_sel:[1,0,0] op_sel_hi:[1,1,1] neg_lo:[0,0,0] neg_hi:[0,0,0]
v_pk_add_f32 v[48:49], v[30:31], v[62:63] neg_lo:[0,1] neg_hi:[0,1]
v_pk_add_f32 v[30:31], v[30:31], v[62:63]
v_pk_mul_f32 v[62:63], v[48:49], s[50:51] op_sel:[0,1] op_sel_hi:[0,0] neg_lo:[0,0] neg_hi:[0,1]
v_pk_fma_f32 v[62:63], v[48:49], s[50:51], v[62:63] op_sel:[1,0,0] op_sel_hi:[1,1,1] neg_lo:[0,0,0] neg_hi:[0,0,0]
v_pk_add_f32 v[48:49], v[32:33], v[64:65] op_sel:[1,1] op_sel_hi:[0,0] neg_lo:[0,1] neg_hi:[1,0]
v_pk_add_f32 v[32:33], v[32:33], v[64:65]
v_pk_add_f32 v[64:65], v[34:35], v[66:67] neg_lo:[0,1] neg_hi:[0,1]
v_pk_add_f32 v[34:35], v[34:35], v[66:67]
v_pk_mul_f32 v[66:67], v[64:65], s[50:51] op_sel:[0,1] op_sel_hi:[0,0] neg_lo:[0,1] neg_hi:[0,1]
v_pk_fma_f32 v[66:67], v[64:65], s[50:51], v[66:67] op_sel:[1,0,0] op_sel_hi:[1,1,1] neg_lo:[0,0,0] neg_hi:[0,1,0]
v_pk_add_f32 v[64:65], v[36:37], v[68:69] neg_lo:[0,1] neg_hi:[0,1]
v_pk_add_f32 v[36:37], v[36:37], v[68:69]
v_pk_mul_f32 v[68:69], v[64:65], s[54:55] op_sel:[0,1] op_sel_hi:[0,0] neg_lo:[0,1] neg_hi:[0,1]
v_pk_fma_f32 v[68:69], v[64:65], s[54:55], v[68:69] op_sel:[1,0,0] op_sel_hi:[1,1,1] neg_lo:[0,0,0] neg_hi:[0,1,0]
v_pk_add_f32 v[64:65], v[38:39], v[70:71] neg_lo:[0,1] neg_hi:[0,1]
v_pk_add_f32 v[38:39], v[38:39], v[70:71]
v_pk_mul_f32 v[70:71], v[64:65], s[58:59] op_sel:[0,1] op_sel_hi:[0,0] neg_lo:[0,1] neg_hi:[0,1]
v_pk_fma_f32 v[70:71], v[64:65], s[58:59], v[70:71] op_sel:[1,0,0] op_sel_hi:[1,1,1] neg_lo:[0,0,0] neg_hi:[0,1,0]
v_pk_add_f32 v[64:65], v[40:41], v[72:73] neg_lo:[0,1] neg_hi:[0,1]
v_pk_add_f32 v[40:41], v[40:41], v[72:73]
v_pk_mul_f32 v[72:73], v[64:65], s[62:63] op_sel:[0,0] op_sel_hi:[0,1] neg_lo:[0,1] neg_hi:[0,1]
v_pk_fma_f32 v[72:73], v[64:65], s[62:63], v[72:73] op_sel:[1,1,0] op_sel_hi:[1,0,1] neg_lo:[0,0,0] neg_hi:[0,1,0]
v_pk_add_f32 v[64:65], v[42:43], v[74:75] neg_lo:[0,1] neg_hi:[0,1]
v_pk_add_f32 v[42:43], v[42:43], v[74:75]
v_pk_mul_f32 v[74:75], v[64:65], s[58:59] op_sel:[0,0] op_sel_hi:[0,1] neg_lo:[0,1] neg_hi:[0,1]
v_pk_fma_f32 v[74:75], v[64:65], s[58:59], v[74:75] op_sel:[1,1,0] op_sel_hi:[1,0,1] neg_lo:[0,0,0] neg_hi:[0,1,0]
v_pk_add_f32 v[64:65], v[44:45], v[76:77] neg_lo:[0,1] neg_hi:[0,1]
v_pk_add_f32 v[44:45], v[44:45], v[76:77]
v_pk_mul_f32 v[76:77], v[64:65], s[54:55] op_sel:[0,0] op_sel_hi:[0,1] neg_lo:[0,1] neg_hi:[0,1]
v_pk_fma_f32 v[76:77], v[64:65], s[54:55], v[76:77] op_sel:[1,1,0] op_sel_hi:[1,0,1] neg_lo:[0,0,0] neg_hi:[0,1,0]
v_pk_add_f32 v[64:65], v[46:47], v[78:79] neg_lo:[0,1] neg_hi:[0,1]
v_pk_add_f32 v[46:47], v[46:47], v[78:79]
v_pk_mul_f32 v[78:79], v[64:65], s[50:51] op_sel:[0,0] op_sel_hi:[0,1] neg_lo:[0,1] neg_hi:[0,1]
v_pk_fma_f32 v[78:79], v[64:65], s[50:51], v[78:79] op_sel:[1,1,0] op_sel_hi:[1,0,1] neg_lo:[0,0,0] neg_hi:[0,1,0]
v_pk_add_f32 v[64:65], v[16:17], v[32:33] neg_lo:[0,1] neg_hi:[0,1]
v_pk_add_f32 v[16:17], v[16:17], v[32:33]
v_pk_add_f32 v[32:33], v[18:19], v[34:35] neg_lo:[0,1] neg_hi:[0,1]
v_pk_add_f32 v[18:19], v[18:19], v[34:35]
v_pk_mul_f32 v[34:35], v[32:33], s[54:55] op_sel:[0,0] op_sel_hi:[0,1] neg_lo:[0,0] neg_hi:[0,1]
v_pk_fma_f32 v[34:35], v[32:33], s[54:55], v[34:35] op_sel:[1,1,0] op_sel_hi:[1,0,1] neg_lo:[0,0,0] neg_hi:[0,0,0]
v_pk_add_f32 v[32:33], v[20:21], v[36:37] neg_lo:[0,1] neg_hi:[0,1]
v_pk_add_f32 v[20:21], v[20:21], v[36:37]
v_pk_mul_f32 v[36:37], v[32:33], s[62:63] op_sel:[0,0] op_sel_hi:[0,1] neg_lo:[0,0] neg_hi:[0,1]
v_pk_fma_f32 v[36:37], v[32:33], s[62:63], v[36:37] op_sel:[1,1,0] op_sel_hi:[1,0,1] neg_lo:[0,0,0] neg_hi:[0,0,0]
v_pk_add_f32 v[32:33], v[22:23], v[38:39] neg_lo:[0,1] neg_hi:[0,1]
v_pk_add_f32 v[22:23], v[22:23], v[38:39]
v_pk_mul_f32 v[38:39], v[32:33], s[54:55] op_sel:[0,1] op_sel_hi:[0,0] neg_lo:[0,0] neg_hi:[0,1]
v_pk_fma_f32 v[38:39], v[32:33], s[54:55], v[38:39] op_sel:[1,0,0] op_sel_hi:[1,1,1] neg_lo:[0,0,0] neg_hi:[0,0,0]
v_pk_add_f32 v[32:33], v[24:25], v[40:41] op_sel:[1,1] op_sel_hi:[0,0] neg_lo:[0,1] neg_hi:[1,0]
v_pk_add_f32 v[24:25], v[24:25], v[40:41]
v_pk_add_f32 v[40:41], v[26:27], v[42:43] neg_lo:[0,1] neg_hi:[0,1]
v_pk_add_f32 v[26:27], v[26:27], v[42:43]
v_pk_mul_f32 v[42:43], v[40:41], s[54:55] op_sel:[0,1] op_sel_hi:[0,0] neg_lo:[0,1] neg_hi:[0,1]
v_pk_fma_f32 v[42:43], v[40:41], s[54:55], v[42:43] op_sel:[1,0,0] op_sel_hi:[1,1,1] neg_lo:[0,0,0] neg_hi:[0,1,0]
v_pk_add_f32 v[40:41], v[28:29], v[44:45] neg_lo:[0,1] neg_hi:[0,1]
v_pk_add_f32 v[28:29], v[28:29], v[44:45]
v_pk_mul_f32 v[44:45], v[40:41], s[62:63] op_sel:[0,0] op_sel_hi:[0,1] neg_lo:[0,1] neg_hi:[0,1]
v_pk_fma_f32 v[44:45], v[40:41], s[62:63], v[44:45] op_sel:[1,1,0] op_sel_hi:[1,0,1] neg_lo:[0,0,0] neg_hi:[0,1,0]
v_pk_add_f32 v[40:41], v[30:31], v[46:47] neg_lo:[0,1] neg_hi:[0,1]
v_pk_add_f32 v[30:31], v[30:31], v[46:47]
v_pk_mul_f32 v[46:47], v[40:41], s[54:55] op_sel:[0,0] op_sel_hi:[0,1] neg_lo:[0,1] neg_hi:[0,1]
v_pk_fma_f32 v[46:47], v[40:41], s[54:55], v[46:47] op_sel:[1,1,0] op_sel_hi:[1,0,1] neg_lo:[0,0,0] neg_hi:[0,1,0]
v_pk_add_f32 v[40:41], v[14:15], v[48:49] neg_lo:[0,1] neg_hi:[0,1]
v_pk_add_f32 v[14:15], v[14:15], v[48:49]
v_pk_add_f32 v[48:49], v[50:51], v[66:67] neg_lo:[0,1] neg_hi:[0,1]
v_pk_add_f32 v[50:51], v[50:51], v[66:67]
v_pk_mul_f32 v[66:67], v[48:49], s[54:55] op_sel:[0,0] op_sel_hi:[0,1] neg_lo:[0,0] neg_hi:[0,1]
v_pk_fma_f32 v[66:67], v[48:49], s[54:55], v[66:67] op_sel:[1,1,0] op_sel_hi:[1,0,1] neg_lo:[0,0,0] neg_hi:[0,0,0]
v_pk_add_f32 v[48:49], v[52:53], v[68:69] neg_lo:[0,1] neg_hi:[0,1]
v_pk_add_f32 v[52:53], v[52:53], v[68:69]
v_pk_mul_f32 v[68:69], v[48:49], s[62:63] op_sel:[0,0] op_sel_hi:[0,1] neg_lo:[0,0] neg_hi:[0,1]
v_pk_fma_f32 v[68:69], v[48:49], s[62:63], v[68:69] op_sel:[1,1,0] op_sel_hi:[1,0,1] neg_lo:[0,0,0] neg_hi:[0,0,0]
v_pk_add_f32 v[48:49], v[54:55], v[70:71] neg_lo:[0,1] neg_hi:[0,1]
v_pk_add_f32 v[54:55], v[54:55], v[70:71]
v_pk_mul_f32 v[70:71], v[48:49], s[54:55] op_sel:[0,1] op_sel_hi:[0,0] neg_lo:[0,0] neg_hi:[0,1]
v_pk_fma_f32 v[70:71], v[48:49], s[54:55], v[70:71] op_sel:[1,0,0] op_sel_hi:[1,1,1] neg_lo:[0,0,0] neg_hi:[0,0,0]
v_pk_add_f32 v[48:49], v[56:57], v[72:73] op_sel:[1,1] op_sel_hi:[0,0] neg_lo:[0,1] neg_hi:[1,0]
v_pk_add_f32 v[56:57], v[56:57], v[72:73]
v_pk_add_f32 v[72:73], v[58:59], v[74:75] neg_lo:[0,1] neg_hi:[0,1]
v_pk_add_f32 v[58:59], v[58:59], v[74:75]
v_pk_mul_f32 v[74:75], v[72:73], s[54:55] op_sel:[0,1] op_sel_hi:[0,0] neg_lo:[0,1] neg_hi:[0,1]
v_pk_fma_f32 v[74:75], v[72:73], s[54:55], v[74:75] op_sel:[1,0,0] op_sel_hi:[1,1,1] neg_lo:[0,0,0] neg_hi:[0,1,0]
v_pk_add_f32 v[72:73], v[60:61], v[76:77] neg_lo:[0,1] neg_hi:[0,1]
v_pk_add_f32 v[60:61], v[60:61], v[76:77]
v_pk_mul_f32 v[76:77], v[72:73], s[62:63] op_sel:[0,0] op_sel_hi:[0,1] neg_lo:[0,1] neg_hi:[0,1]
v_pk_fma_f32 v[76:77], v[72:73], s[62:63], v[76:77] op_sel:[1,1,0] op_sel_hi:[1,0,1] neg_lo:[0,0,0] neg_hi:[0,1,0]
v_pk_add_f32 v[72:73], v[62:63], v[78:79] neg_lo:[0,1] neg_hi:[0,1]
v_pk_add_f32 v[62:63], v[62:63], v[78:79]
v_pk_mul_f32 v[78:79], v[72:73], s[54:55] op_sel:[0,0] op_sel_hi:[0,1] neg_lo:[0,1] neg_hi:[0,1]
v_pk_fma_f32 v[78:79], v[72:73], s[54:55], v[78:79] op_sel:[1,1,0] op_sel_hi:[1,0,1] neg_lo:[0,0,0] neg_hi:[0,1,0]
v_pk_add_f32 v[72:73], v[16:17], v[24:25] neg_lo:[0,1] neg_hi:[0,1]
v_pk_add_f32 v[16:17], v[16:17], v[24:25]
v_pk_add_f32 v[24:25], v[18:19], v[26:27] neg_lo:[0,1] neg_hi:[0,1]
v_pk_add_f32 v[18:19], v[18:19], v[26:27]
v_pk_mul_f32 v[26:27], v[24:25], s[62:63] op_sel:[0,0] op_sel_hi:[0,1] neg_lo:[0,0] neg_hi:[0,1]
v_pk_fma_f32 v[26:27], v[24:25], s[62:63], v[26:27] op_sel:[1,1,0] op_sel_hi:[1,0,1] neg_lo:[0,0,0] neg_hi:[0,0,0]
v_pk_add_f32 v[24:25], v[20:21], v[28:29] op_sel:[1,1] op_sel_hi:[0,0] neg_lo:[0,1] neg_hi:[1,0]
v_pk_add_f32 v[20:21], v[20:21], v[28:29]
v_pk_add_f32 v[28:29], v[22:23], v[30:31] neg_lo:[0,1] neg_hi:[0,1]
v_pk_add_f32 v[22:23], v[22:23], v[30:31]
v_pk_mul_f32 v[30:31], v[28:29], s[62:63] op_sel:[0,0] op_sel_hi:[0,1] neg_lo:[0,1] neg_hi:[0,1]
v_pk_fma_f32 v[30:31], v[28:29], s[62:63], v[30:31] op_sel:[1,1,0] op_sel_hi:[1,0,1] neg_lo:[0,0,0] neg_hi:[0,1,0]
v_pk_add_f32 v[28:29], v[64:65], v[32:33] neg_lo:[0,1] neg_hi:[0,1]
v_pk_add_f32 v[64:65], v[64:65], v[32:33]
v_pk_add_f32 v[32:33], v[34:35], v[42:43] neg_lo:[0,1] neg_hi:[0,1]
v_pk_add_f32 v[34:35], v[34:35], v[42:43]
v_pk_mul_f32 v[42:43], v[32:33], s[62:63] op_sel:[0,0] op_sel_hi:[0,1] neg_lo:[0,0] neg_hi:[0,1]
v_pk_fma_f32 v[42:43], v[32:33], s[62:63], v[42:43] op_sel:[1,1,0] op_sel_hi:[1,0,1] neg_lo:[0,0,0] neg_hi:[0,0,0]
v_pk_add_f32 v[32:33], v[36:37], v[44:45] op_sel:[1,1] op_sel_hi:[0,0] neg_lo:[0,1] neg_hi:[1,0]
v_pk_add_f32 v[36:37], v[36:37], v[44:45]
v_pk_add_f32 v[44:45], v[38:39], v[46:47] neg_lo:[0,1] neg_hi:[0,1]
v_pk_add_f32 v[38:39], v[38:39], v[46:47]
v_pk_mul_f32 v[46:47], v[44:45], s[62:63] op_sel:[0,0] op_sel_hi:[0,1] neg_lo:[0,1] neg_hi:[0,1]
v_pk_fma_f32 v[46:47], v[44:45], s[62:63], v[46:47] op_sel:[1,1,0] op_sel_hi:[1,0,1] neg_lo:[0,0,0] neg_hi:[0,1,0]
v_pk_add_f32 v[44:45], v[14:15], v[56:57] neg_lo:[0,1] neg_hi:[0,1]
v_pk_add_f32 v[14:15], v[14:15], v[56:57]
v_pk_add_f32 v[56:57], v[50:51], v[58:59] neg_lo:[0,1] neg_hi:[0,1]
v_pk_add_f32 v[50:51], v[50:51], v[58:59]
v_pk_mul_f32 v[58:59], v[56:57], s[62:63] op_sel:[0,0] op_sel_hi:[0,1] neg_lo:[0,0] neg_hi:[0,1]
v_pk_fma_f32 v[58:59], v[56:57], s[62:63], v[58:59] op_sel:[1,1,0] op_sel_hi:[1,0,1] neg_lo:[0,0,0] neg_hi:[0,0,0]
v_pk_add_f32 v[56:57], v[52:53], v[60:61] op_sel:[1,1] op_sel_hi:[0,0] neg_lo:[0,1] neg_hi:[1,0]
v_pk_add_f32 v[52:53], v[52:53], v[60:61]
v_pk_add_f32 v[60:61], v[54:55], v[62:63] neg_lo:[0,1] neg_hi:[0,1]
v_pk_add_f32 v[54:55], v[54:55], v[62:63]
v_pk_mul_f32 v[62:63], v[60:61], s[62:63] op_sel:[0,0] op_sel_hi:[0,1] neg_lo:[0,1] neg_hi:[0,1]
v_pk_fma_f32 v[62:63], v[60:61], s[62:63], v[62:63] op_sel:[1,1,0] op_sel_hi:[1,0,1] neg_lo:[0,0,0] neg_hi:[0,1,0]
v_pk_add_f32 v[60:61], v[40:41], v[48:49] neg_lo:[0,1] neg_hi:[0,1]
v_pk_add_f32 v[40:41], v[40:41], v[48:49]
v_pk_add_f32 v[48:49], v[66:67], v[74:75] neg_lo:[0,1] neg_hi:[0,1]
v_pk_add_f32 v[66:67], v[66:67], v[74:75]
v_pk_mul_f32 v[74:75], v[48:49], s[62:63] op_sel:[0,0] op_sel_hi:[0,1] neg_lo:[0,0] neg_hi:[0,1]
v_pk_fma_f32 v[74:75], v[48:49], s[62:63], v[74:75] op_sel:[1,1,0] op_sel_hi:[1,0,1] neg_lo:[0,0,0] neg_hi:[0,0,0]
v_pk_add_f32 v[48:49], v[68:69], v[76:77] op_sel:[1,1] op_sel_hi:[0,0] neg_lo:[0,1] neg_hi:[1,0]
v_pk_add_f32 v[68:69], v[68:69], v[76:77]
v_pk_add_f32 v[76:77], v[70:71], v[78:79] neg_lo:[0,1] neg_hi:[0,1]
v_pk_add_f32 v[70:71], v[70:71], v[78:79]
v_pk_mul_f32 v[78:79], v[76:77], s[62:63] op_sel:[0,0] op_sel_hi:[0,1] neg_lo:[0,1] neg_hi:[0,1]
v_pk_fma_f32 v[78:79], v[76:77], s[62:63], v[78:79] op_sel:[1,1,0] op_sel_hi:[1,0,1] neg_lo:[0,0,0] neg_hi:[0,1,0]
v_pk_add_f32 v[76:77], v[16:17], v[20:21] neg_lo:[0,1] neg_hi:[0,1]
v_pk_add_f32 v[16:17], v[16:17], v[20:21]
v_pk_add_f32 v[20:21], v[18:19], v[22:23] op_sel:[1,1] op_sel_hi:[0,0] neg_lo:[0,1] neg_hi:[1,0]
v_pk_add_f32 v[18:19], v[18:19], v[22:23]
v_pk_add_f32 v[22:23], v[72:73], v[24:25] neg_lo:[0,1] neg_hi:[0,1]
v_pk_add_f32 v[72:73], v[72:73], v[24:25]
v_pk_add_f32 v[24:25], v[26:27], v[30:31] op_sel:[1,1] op_sel_hi:[0,0] neg_lo:[0,1] neg_hi:[1,0]
v_pk_add_f32 v[26:27], v[26:27], v[30:31]
v_pk_add_f32 v[30:31], v[64:65], v[36:37] neg_lo:[0,1] neg_hi:[0,1]
v_pk_add_f32 v[64:65], v[64:65], v[36:37]
v_pk_add_f32 v[36:37], v[34:35], v[38:39] op_sel:[1,1] op_sel_hi:[0,0] neg_lo:[0,1] neg_hi:[1,0]
v_pk_add_f32 v[34:35], v[34:35], v[38:39]
v_pk_add_f32 v[38:39], v[28:29], v[32:33] neg_lo:[0,1] neg_hi:[0,1]
v_pk_add_f32 v[28:29], v[28:29], v[32:33]
v_pk_add_f32 v[32:33], v[42:43], v[46:47] op_sel:[1,1] op_sel_hi:[0,0] neg_lo:[0,1] neg_hi:[1,0]
v_pk_add_f32 v[42:43], v[42:43], v[46:47]
v_pk_add_f32 v[46:47], v[14:15], v[52:53] neg_lo:[0,1] neg_hi:[0,1]
v_pk_add_f32 v[14:15], v[14:15], v[52:53]
v_pk_add_f32 v[52:53], v[50:51], v[54:55] op_sel:[1,1] op_sel_hi:[0,0] neg_lo:[0,1] neg_hi:[1,0]
v_pk_add_f32 v[50:51], v[50:51], v[54:55]
v_pk_add_f32 v[54:55], v[44:45], v[56:57] neg_lo:[0,1] neg_hi:[0,1]
v_pk_add_f32 v[44:45], v[44:45], v[56:57]
v_pk_add_f32 v[56:57], v[58:59], v[62:63] op_sel:[1,1] op_sel_hi:[0,0] neg_lo:[0,1] neg_hi:[1,0]
v_pk_add_f32 v[58:59], v[58:59], v[62:63]
v_pk_add_f32 v[62:63], v[40:41], v[68:69] neg_lo:[0,1] neg_hi:[0,1]
v_pk_add_f32 v[40:41], v[40:41], v[68:69]
v_pk_add_f32 v[68:69], v[66:67], v[70:71] op_sel:[1,1] op_sel_hi:[0,0] neg_lo:[0,1] neg_hi:[1,0]
v_pk_add_f32 v[66:67], v[66:67], v[70:71]
v_pk_add_f32 v[70:71], v[60:61], v[48:49] neg_lo:[0,1] neg_hi:[0,1]
v_pk_add_f32 v[60:61], v[60:61], v[48:49]
v_pk_add_f32 v[48:49], v[74:75], v[78:79] op_sel:[1,1] op_sel_hi:[0,0] neg_lo:[0,1] neg_hi:[1,0]
v_pk_add_f32 v[74:75], v[74:75], v[78:79]
v_pk_add_f32 v[78:79], v[16:17], v[18:19] neg_lo:[0,1] neg_hi:[0,1]
v_pk_add_f32 v[16:17], v[16:17], v[18:19]
v_pk_add_f32 v[18:19], v[76:77], v[20:21] neg_lo:[0,1] neg_hi:[0,1]
v_pk_add_f32 v[76:77], v[76:77], v[20:21]
v_pk_add_f32 v[20:21], v[72:73], v[26:27] neg_lo:[0,1] neg_hi:[0,1]
v_pk_add_f32 v[72:73], v[72:73], v[26:27]
v_pk_add_f32 v[26:27], v[22:23], v[24:25] neg_lo:[0,1] neg_hi:[0,1]
v_pk_add_f32 v[22:23], v[22:23], v[24:25]
v_pk_add_f32 v[24:25], v[64:65], v[34:35] neg_lo:[0,1] neg_hi:[0,1]
v_pk_add_f32 v[64:65], v[64:65], v[34:35]
v_pk_add_f32 v[34:35], v[30:31], v[36:37] neg_lo:[0,1] neg_hi:[0,1]
v_pk_add_f32 v[30:31], v[30:31], v[36:37]
v_pk_add_f32 v[36:37], v[28:29], v[42:43] neg_lo:[0,1] neg_hi:[0,1]
v_pk_add_f32 v[28:29], v[28:29], v[42:43]
v_pk_add_f32 v[42:43], v[38:39], v[32:33] neg_lo:[0,1] neg_hi:[0,1]
v_pk_add_f32 v[38:39], v[38:39], v[32:33]
v_pk_add_f32 v[32:33], v[14:15], v[50:51] neg_lo:[0,1] neg_hi:[0,1]
v_pk_add_f32 v[14:15], v[14:15], v[50:51]
v_pk_add_f32 v[50:51], v[46:47], v[52:53] neg_lo:[0,1] neg_hi:[0,1]
v_pk_add_f32 v[46:47], v[46:47], v[52:53]
v_pk_add_f32 v[52:53], v[44:45], v[58:59] neg_lo:[0,1] neg_hi:[0,1]
v_pk_add_f32 v[44:45], v[44:45], v[58:59]
v_pk_add_f32 v[58:59], v[54:55], v[56:57] neg_lo:[0,1] neg_hi:[0,1]
v_pk_add_f32 v[54:55], v[54:55], v[56:57]
v_pk_add_f32 v[56:57], v[40:41], v[66:67] neg_lo:[0,1] neg_hi:[0,1]
v_pk_add_f32 v[40:41], v[40:41], v[66:67]
v_pk_add_f32 v[66:67], v[62:63], v[68:69] neg_lo:[0,1] neg_hi:[0,1]
v_pk_add_f32 v[62:63], v[62:63], v[68:69]
v_pk_add_f32 v[68:69], v[60:61], v[74:75] neg_lo:[0,1] neg_hi:[0,1]
v_pk_add_f32 v[60:61], v[60:61], v[74:75]
v_pk_add_f32 v[74:75], v[70:71], v[48:49] neg_lo:[0,1] neg_hi:[0,1]
v_pk_add_f32 v[70:71], v[70:71], v[48:49]
s_mov_b64 exec, s[18:19]
v_pk_add_f32 v[16:17], v[16:17], 0 neg_lo:[1,0] neg_hi:[1,0]
v_pk_mul_f32 v[48:49], v[14:15], s[48:49] op_sel:[0,0] op_sel_hi:[0,1] neg_lo:[0,1] neg_hi:[0,0]
v_pk_fma_f32 v[14:15], v[14:15], s[48:49], v[48:49] op_sel:[1,1,0] op_sel_hi:[1,0,1] neg_lo:[0,1,0] neg_hi:[0,1,0]
v_pk_mul_f32 v[48:49], v[64:65], s[50:51] op_sel:[0,0] op_sel_hi:[0,1] neg_lo:[0,1] neg_hi:[0,0]
v_pk_fma_f32 v[64:65], v[64:65], s[50:51], v[48:49] op_sel:[1,1,0] op_sel_hi:[1,0,1] neg_lo:[0,1,0] neg_hi:[0,1,0]
v_pk_mul_f32 v[48:49], v[40:41], s[52:53] op_sel:[0,0] op_sel_hi:[0,1] neg_lo:[0,1] neg_hi:[0,0]
v_pk_fma_f32 v[40:41], v[40:41], s[52:53], v[48:49] op_sel:[1,1,0] op_sel_hi:[1,0,1] neg_lo:[0,1,0] neg_hi:[0,1,0]
v_pk_mul_f32 v[48:49], v[72:73], s[54:55] op_sel:[0,0] op_sel_hi:[0,1] neg_lo:[0,1] neg_hi:[0,0]
v_pk_fma_f32 v[72:73], v[72:73], s[54:55], v[48:49] op_sel:[1,1,0] op_sel_hi:[1,0,1] neg_lo:[0,1,0] neg_hi:[0,1,0]
v_pk_mul_f32 v[48:49], v[44:45], s[56:57] op_sel:[0,0] op_sel_hi:[0,1] neg_lo:[0,1] neg_hi:[0,0]
v_pk_fma_f32 v[44:45], v[44:45], s[56:57], v[48:49] op_sel:[1,1,0] op_sel_hi:[1,0,1] neg_lo:[0,1,0] neg_hi:[0,1,0]
v_pk_mul_f32 v[48:49], v[28:29], s[58:59] op_sel:[0,0] op_sel_hi:[0,1] neg_lo:[0,1] neg_hi:[0,0]
v_pk_fma_f32 v[28:29], v[28:29], s[58:59], v[48:49] op_sel:[1,1,0] op_sel_hi:[1,0,1] neg_lo:[0,1,0] neg_hi:[0,1,0]
v_pk_mul_f32 v[48:49], v[60:61], s[60:61] op_sel:[0,0] op_sel_hi:[0,1] neg_lo:[0,1] neg_hi:[0,0]
v_pk_fma_f32 v[60:61], v[60:61], s[60:61], v[48:49] op_sel:[1,1,0] op_sel_hi:[1,0,1] neg_lo:[0,1,0] neg_hi:[0,1,0]
v_pk_mul_f32 v[48:49], v[76:77], s[62:63] op_sel:[0,0] op_sel_hi:[0,1] neg_lo:[0,1] neg_hi:[0,0]
v_pk_fma_f32 v[76:77], v[76:77], s[62:63], v[48:49] op_sel:[1,1,0] op_sel_hi:[1,0,1] neg_lo:[0,1,0] neg_hi:[0,1,0]
v_pk_mul_f32 v[48:49], v[46:47], s[60:61] op_sel:[0,1] op_sel_hi:[0,0] neg_lo:[0,1] neg_hi:[0,0]
v_pk_fma_f32 v[46:47], v[46:47], s[60:61], v[48:49] op_sel:[1,0,0] op_sel_hi:[1,1,1] neg_lo:[0,1,0] neg_hi:[0,1,0]
v_pk_mul_f32 v[48:49], v[30:31], s[58:59] op_sel:[0,1] op_sel_hi:[0,0] neg_lo:[0,1] neg_hi:[0,0]
v_pk_fma_f32 v[30:31], v[30:31], s[58:59], v[48:49] op_sel:[1,0,0] op_sel_hi:[1,1,1] neg_lo:[0,1,0] neg_hi:[0,1,0]
v_pk_mul_f32 v[48:49], v[62:63], s[56:57] op_sel:[0,1] op_sel_hi:[0,0] neg_lo:[0,1] neg_hi:[0,0]
v_pk_fma_f32 v[62:63], v[62:63], s[56:57], v[48:49] op_sel:[1,0,0] op_sel_hi:[1,1,1] neg_lo:[0,1,0] neg_hi:[0,1,0]
v_pk_mul_f32 v[48:49], v[22:23], s[54:55] op_sel:[0,1] op_sel_hi:[0,0] neg_lo:[0,1] neg_hi:[0,0]
v_pk_fma_f32 v[22:23], v[22:23], s[54:55], v[48:49] op_sel:[1,0,0] op_sel_hi:[1,1,1] neg_lo:[0,1,0] neg_hi:[0,1,0]
v_pk_mul_f32 v[48:49], v[54:55], s[52:53] op_sel:[0,1] op_sel_hi:[0,0] neg_lo:[0,1] neg_hi:[0,0]
v_pk_fma_f32 v[54:55], v[54:55], s[52:53], v[48:49] op_sel:[1,0,0] op_sel_hi:[1,1,1] neg_lo:[0,1,0] neg_hi:[0,1,0]
v_pk_mul_f32 v[48:49], v[38:39], s[50:51] op_sel:[0,1] op_sel_hi:[0,0] neg_lo:[0,1] neg_hi:[0,0]
v_pk_fma_f32 v[38:39], v[38:39], s[50:51], v[48:49] op_sel:[1,0,0] op_sel_hi:[1,1,1] neg_lo:[0,1,0] neg_hi:[0,1,0]
v_pk_mul_f32 v[48:49], v[70:71], s[48:49] op_sel:[0,1] op_sel_hi:[0,0] neg_lo:[0,1] neg_hi:[0,0]
v_pk_fma_f32 v[70:71], v[70:71], s[48:49], v[48:49] op_sel:[1,0,0] op_sel_hi:[1,1,1] neg_lo:[0,1,0] neg_hi:[0,1,0]
v_pk_add_f32 v[78:79], v[78:79], 0 op_sel:[1,0] op_sel_hi:[0,0] neg_lo:[1,0] neg_hi:[0,0]
v_pk_mul_f32 v[48:49], v[32:33], s[48:49] op_sel:[0,1] op_sel_hi:[0,0] neg_lo:[0,0] neg_hi:[0,0]
v_pk_fma_f32 v[32:33], v[32:33], s[48:49], v[48:49] op_sel:[1,0,0] op_sel_hi:[1,1,1] neg_lo:[0,1,0] neg_hi:[0,0,0]
v_pk_mul_f32 v[48:49], v[24:25], s[50:51] op_sel:[0,1] op_sel_hi:[0,0] neg_lo:[0,0] neg_hi:[0,0]
v_pk_fma_f32 v[24:25], v[24:25], s[50:51], v[48:49] op_sel:[1,0,0] op_sel_hi:[1,1,1] neg_lo:[0,1,0] neg_hi:[0,0,0]
v_pk_mul_f32 v[48:49], v[56:57], s[52:53] op_sel:[0,1] op_sel_hi:[0,0] neg_lo:[0,0] neg_hi:[0,0]
v_pk_fma_f32 v[56:57], v[56:57], s[52:53], v[48:49] op_sel:[1,0,0] op_sel_hi:[1,1,1] neg_lo:[0,1,0] neg_hi:[0,0,0]
v_pk_mul_f32 v[48:49], v[20:21], s[54:55] op_sel:[0,1] op_sel_hi:[0,0] neg_lo:[0,0] neg_hi:[0,0]
v_pk_fma_f32 v[20:21], v[20:21], s[54:55], v[48:49] op_sel:[1,0,0] op_sel_hi:[1,1,1] neg_lo:[0,1,0] neg_hi:[0,0,0]
v_pk_mul_f32 v[48:49], v[52:53], s[56:57] op_sel:[0,1] op_sel_hi:[0,0] neg_lo:[0,0] neg_hi:[0,0]
v_pk_fma_f32 v[52:53], v[52:53], s[56:57], v[48:49] op_sel:[1,0,0] op_sel_hi:[1,1,1] neg_lo:[0,1,0] neg_hi:[0,0,0]
v_pk_mul_f32 v[48:49], v[36:37], s[58:59] op_sel:[0,1] op_sel_hi:[0,0] neg_lo:[0,0] neg_hi:[0,0]
v_pk_fma_f32 v[36:37], v[36:37], s[58:59], v[48:49] op_sel:[1,0,0] op_sel_hi:[1,1,1] neg_lo:[0,1,0] neg_hi:[0,0,0]
v_pk_mul_f32 v[48:49], v[68:69], s[60:61] op_sel:[0,1] op_sel_hi:[0,0] neg_lo:[0,0] neg_hi:[0,0]
v_pk_fma_f32 v[68:69], v[68:69], s[60:61], v[48:49] op_sel:[1,0,0] op_sel_hi:[1,1,1] neg_lo:[0,1,0] neg_hi:[0,0,0]
v_pk_mul_f32 v[48:49], v[18:19], s[62:63] op_sel:[0,0] op_sel_hi:[0,1] neg_lo:[0,0] neg_hi:[0,0]
v_pk_fma_f32 v[18:19], v[18:19], s[62:63], v[48:49] op_sel:[1,1,0] op_sel_hi:[1,0,1] neg_lo:[0,1,0] neg_hi:[0,0,0]
v_pk_mul_f32 v[48:49], v[50:51], s[60:61] op_sel:[0,0] op_sel_hi:[0,1] neg_lo:[0,0] neg_hi:[0,0]
v_pk_fma_f32 v[50:51], v[50:51], s[60:61], v[48:49] op_sel:[1,1,0] op_sel_hi:[1,0,1] neg_lo:[0,1,0] neg_hi:[0,0,0]
v_pk_mul_f32 v[48:49], v[34:35], s[58:59] op_sel:[0,0] op_sel_hi:[0,1] neg_lo:[0,0] neg_hi:[0,0]
v_pk_fma_f32 v[34:35], v[34:35], s[58:59], v[48:49] op_sel:[1,1,0] op_sel_hi:[1,0,1] neg_lo:[0,1,0] neg_hi:[0,0,0]
v_pk_mul_f32 v[48:49], v[66:67], s[56:57] op_sel:[0,0] op_sel_hi:[0,1] neg_lo:[0,0] neg_hi:[0,0]
v_pk_fma_f32 v[66:67], v[66:67], s[56:57], v[48:49] op_sel:[1,1,0] op_sel_hi:[1,0,1] neg_lo:[0,1,0] neg_hi:[0,0,0]
v_pk_mul_f32 v[48:49], v[26:27], s[54:55] op_sel:[0,0] op_sel_hi:[0,1] neg_lo:[0,0] neg_hi:[0,0]
v_pk_fma_f32 v[26:27], v[26:27], s[54:55], v[48:49] op_sel:[1,1,0] op_sel_hi:[1,0,1] neg_lo:[0,1,0] neg_hi:[0,0,0]
v_pk_mul_f32 v[48:49], v[58:59], s[52:53] op_sel:[0,0] op_sel_hi:[0,1] neg_lo:[0,0] neg_hi:[0,0]
v_pk_fma_f32 v[58:59], v[58:59], s[52:53], v[48:49] op_sel:[1,1,0] op_sel_hi:[1,0,1] neg_lo:[0,1,0] neg_hi:[0,0,0]
v_pk_mul_f32 v[48:49], v[42:43], s[50:51] op_sel:[0,0] op_sel_hi:[0,1] neg_lo:[0,0] neg_hi:[0,0]
v_pk_fma_f32 v[42:43], v[42:43], s[50:51], v[48:49] op_sel:[1,1,0] op_sel_hi:[1,0,1] neg_lo:[0,1,0] neg_hi:[0,0,0]
v_pk_mul_f32 v[48:49], v[74:75], s[48:49] op_sel:[0,0] op_sel_hi:[0,1] neg_lo:[0,0] neg_hi:[0,0]
v_pk_fma_f32 v[74:75], v[74:75], s[48:49], v[48:49] op_sel:[1,1,0] op_sel_hi:[1,0,1] neg_lo:[0,1,0] neg_hi:[0,0,0]
s_mov_b64 exec, -1
v_fmac_f32_dpp v16, v16, v9 quad_perm:[1,0,3,2] row_mask:0xf bank_mask:0xf
v_fmac_f32_dpp v17, v17, v9 quad_perm:[1,0,3,2] row_mask:0xf bank_mask:0xf
v_fmac_f32_dpp v14, v14, v9 quad_perm:[1,0,3,2] row_mask:0xf bank_mask:0xf
v_fmac_f32_dpp v15, v15, v9 quad_perm:[1,0,3,2] row_mask:0xf bank_mask:0xf
v_fmac_f32_dpp v64, v64, v9 quad_perm:[1,0,3,2] row_mask:0xf bank_mask:0xf
v_fmac_f32_dpp v65, v65, v9 quad_perm:[1,0,3,2] row_mask:0xf bank_mask:0xf
v_fmac_f32_dpp v40, v40, v9 quad_perm:[1,0,3,2] row_mask:0xf bank_mask:0xf
v_fmac_f32_dpp v41, v41, v9 quad_perm:[1,0,3,2] row_mask:0xf bank_mask:0xf
v_fmac_f32_dpp v72, v72, v9 quad_perm:[1,0,3,2] row_mask:0xf bank_mask:0xf
v_fmac_f32_dpp v73, v73, v9 quad_perm:[1,0,3,2] row_mask:0xf bank_mask:0xf
v_fmac_f32_dpp v44, v44, v9 quad_perm:[1,0,3,2] row_mask:0xf bank_mask:0xf
v_fmac_f32_dpp v45, v45, v9 quad_perm:[1,0,3,2] row_mask:0xf bank_mask:0xf
v_fmac_f32_dpp v28, v28, v9 quad_perm:[1,0,3,2] row_mask:0xf bank_mask:0xf
v_fmac_f32_dpp v29, v29, v9 quad_perm:[1,0,3,2] row_mask:0xf bank_mask:0xf
v_fmac_f32_dpp v60, v60, v9 quad_perm:[1,0,3,2] row_mask:0xf bank_mask:0xf
v_fmac_f32_dpp v61, v61, v9 quad_perm:[1,0,3,2] row_mask:0xf bank_mask:0xf
v_fmac_f32_dpp v76, v76, v9 quad_perm:[1,0,3,2] row_mask:0xf bank_mask:0xf
v_fmac_f32_dpp v77, v77, v9 quad_perm:[1,0,3,2] row_mask:0xf bank_mask:0xf
v_fmac_f32_dpp v46, v46, v9 quad_perm:[1,0,3,2] row_mask:0xf bank_mask:0xf
v_fmac_f32_dpp v47, v47, v9 quad_perm:[1,0,3,2] row_mask:0xf bank_mask:0xf
v_fmac_f32_dpp v30, v30, v9 quad_perm:[1,0,3,2] row_mask:0xf bank_mask:0xf
v_fmac_f32_dpp v31, v31, v9 quad_perm:[1,0,3,2] row_mask:0xf bank_mask:0xf
v_fmac_f32_dpp v62, v62, v9 quad_perm:[1,0,3,2] row_mask:0xf bank_mask:0xf
v_fmac_f32_dpp v63, v63, v9 quad_perm:[1,0,3,2] row_mask:0xf bank_mask:0xf
v_fmac_f32_dpp v22, v22, v9 quad_perm:[1,0,3,2] row_mask:0xf bank_mask:0xf
v_fmac_f32_dpp v23, v23, v9 quad_perm:[1,0,3,2] row_mask:0xf bank_mask:0xf
v_fmac_f32_dpp v54, v54, v9 quad_perm:[1,0,3,2] row_mask:0xf bank_mask:0xf
v_fmac_f32_dpp v55, v55, v9 quad_perm:[1,0,3,2] row_mask:0xf bank_mask:0xf
v_fmac_f32_dpp v38, v38, v9 quad_perm:[1,0,3,2] row_mask:0xf bank_mask:0xf
v_fmac_f32_dpp v39, v39, v9 quad_perm:[1,0,3,2] row_mask:0xf bank_mask:0xf
v_fmac_f32_dpp v70, v70, v9 quad_perm:[1,0,3,2] row_mask:0xf bank_mask:0xf
v_fmac_f32_dpp v71, v71, v9 quad_perm:[1,0,3,2] row_mask:0xf bank_mask:0xf
v_fmac_f32_dpp v78, v78, v9 quad_perm:[1,0,3,2] row_mask:0xf bank_mask:0xf
v_fmac_f32_dpp v79, v79, v9 quad_perm:[1,0,3,2] row_mask:0xf bank_mask:0xf
v_fmac_f32_dpp v32, v32, v9 quad_perm:[1,0,3,2] row_mask:0xf bank_mask:0xf
v_fmac_f32_dpp v33, v33, v9 quad_perm:[1,0,3,2] row_mask:0xf bank_mask:0xf
v_fmac_f32_dpp v24, v24, v9 quad_perm:[1,0,3,2] row_mask:0xf bank_mask:0xf
v_fmac_f32_dpp v25, v25, v9 quad_perm:[1,0,3,2] row_mask:0xf bank_mask:0xf
v_fmac_f32_dpp v56, v56, v9 quad_perm:[1,0,3,2] row_mask:0xf bank_mask:0xf
v_fmac_f32_dpp v57, v57, v9 quad_perm:[1,0,3,2] row_mask:0xf bank_mask:0xf
v_fmac_f32_dpp v20, v20, v9 quad_perm:[1,0,3,2] row_mask:0xf bank_mask:0xf
v_fmac_f32_dpp v21, v21, v9 quad_perm:[1,0,3,2] row_mask:0xf bank_mask:0xf
v_fmac_f32_dpp v52, v52, v9 quad_perm:[1,0,3,2] row_mask:0xf bank_mask:0xf
v_fmac_f32_dpp v53, v53, v9 quad_perm:[1,0,3,2] row_mask:0xf bank_mask:0xf
v_fmac_f32_dpp v36, v36, v9 quad_perm:[1,0,3,2] row_mask:0xf bank_mask:0xf
v_fmac_f32_dpp v37, v37, v9 quad_perm:[1,0,3,2] row_mask:0xf bank_mask:0xf
v_fmac_f32_dpp v68, v68, v9 quad_perm:[1,0,3,2] row_mask:0xf bank_mask:0xf
v_fmac_f32_dpp v69, v69, v9 quad_perm:[1,0,3,2] row_mask:0xf bank_mask:0xf
v_fmac_f32_dpp v18, v18, v9 quad_perm:[1,0,3,2] row_mask:0xf bank_mask:0xf
v_fmac_f32_dpp v19, v19, v9 quad_perm:[1,0,3,2] row_mask:0xf bank_mask:0xf
v_fmac_f32_dpp v50, v50, v9 quad_perm:[1,0,3,2] row_mask:0xf bank_mask:0xf
v_fmac_f32_dpp v51, v51, v9 quad_perm:[1,0,3,2] row_mask:0xf bank_mask:0xf
v_fmac_f32_dpp v34, v34, v9 quad_perm:[1,0,3,2] row_mask:0xf bank_mask:0xf
v_fmac_f32_dpp v35, v35, v9 quad_perm:[1,0,3,2] row_mask:0xf bank_mask:0xf
v_fmac_f32_dpp v66, v66, v9 quad_perm:[1,0,3,2] row_mask:0xf bank_mask:0xf
v_fmac_f32_dpp v67, v67, v9 quad_perm:[1,0,3,2] row_mask:0xf bank_mask:0xf
v_fmac_f32_dpp v26, v26, v9 quad_perm:[1,0,3,2] row_mask:0xf bank_mask:0xf
v_fmac_f32_dpp v27, v27, v9 quad_perm:[1,0,3,2] row_mask:0xf bank_mask:0xf
v_fmac_f32_dpp v58, v58, v9 quad_perm:[1,0,3,2] row_mask:0xf bank_mask:0xf
v_fmac_f32_dpp v59, v59, v9 quad_perm:[1,0,3,2] row_mask:0xf bank_mask:0xf
v_fmac_f32_dpp v42, v42, v9 quad_perm:[1,0,3,2] row_mask:0xf bank_mask:0xf
v_fmac_f32_dpp v43, v43, v9 quad_perm:[1,0,3,2] row_mask:0xf bank_mask:0xf
v_fmac_f32_dpp v74, v74, v9 quad_perm:[1,0,3,2] row_mask:0xf bank_mask:0xf
v_fmac_f32_dpp v75, v75, v9 quad_perm:[1,0,3,2] row_mask:0xf bank_mask:0xf
v_lshlrev_b32 v240, 16, v208
v_and_b32 v241, 0xffff0000, v208
v_pk_mul_f32 v[48:49], v[16:17], v[240:241] op_sel:[0,0] op_sel_hi:[0,1] neg_lo:[0,0] neg_hi:[0,0]
v_pk_fma_f32 v[16:17], v[16:17], v[240:241], v[48:49] op_sel:[1,1,0] op_sel_hi:[1,0,1] neg_lo:[0,1,0] neg_hi:[0,0,0]
v_lshlrev_b32 v240, 16, v209
v_and_b32 v241, 0xffff0000, v209
v_pk_mul_f32 v[48:49], v[14:15], v[240:241] op_sel:[0,0] op_sel_hi:[0,1] neg_lo:[0,0] neg_hi:[0,0]
v_pk_fma_f32 v[14:15], v[14:15], v[240:241], v[48:49] op_sel:[1,1,0] op_sel_hi:[1,0,1] neg_lo:[0,1,0] neg_hi:[0,0,0]
v_lshlrev_b32 v240, 16, v210
v_and_b32 v241, 0xffff0000, v210
v_pk_mul_f32 v[48:49], v[64:65], v[240:241] op_sel:[0,0] op_sel_hi:[0,1] neg_lo:[0,0] neg_hi:[0,0]
v_pk_fma_f32 v[64:65], v[64:65], v[240:241], v[48:49] op_sel:[1,1,0] op_sel_hi:[1,0,1] neg_lo:[0,1,0] neg_hi:[0,0,0]
v_lshlrev_b32 v240, 16, v211
v_and_b32 v241, 0xffff0000, v211
v_pk_mul_f32 v[48:49], v[40:41], v[240:241] op_sel:[0,0] op_sel_hi:[0,1] neg_lo:[0,0] neg_hi:[0,0]
v_pk_fma_f32 v[40:41], v[40:41], v[240:241], v[48:49] op_sel:[1,1,0] op_sel_hi:[1,0,1] neg_lo:[0,1,0] neg_hi:[0,0,0]
v_lshlrev_b32 v240, 16, v212
v_and_b32 v241, 0xffff0000, v212
v_pk_mul_f32 v[48:49], v[72:73], v[240:241] op_sel:[0,0] op_sel_hi:[0,1] neg_lo:[0,0] neg_hi:[0,0]
v_pk_fma_f32 v[72:73], v[72:73], v[240:241], v[48:49] op_sel:[1,1,0] op_sel_hi:[1,0,1] neg_lo:[0,1,0] neg_hi:[0,0,0]
v_lshlrev_b32 v240, 16, v213
v_and_b32 v241, 0xffff0000, v213
v_pk_mul_f32 v[48:49], v[44:45], v[240:241] op_sel:[0,0] op_sel_hi:[0,1] neg_lo:[0,0] neg_hi:[0,0]
v_pk_fma_f32 v[44:45], v[44:45], v[240:241], v[48:49] op_sel:[1,1,0] op_sel_hi:[1,0,1] neg_lo:[0,1,0] neg_hi:[0,0,0]
v_lshlrev_b32 v240, 16, v214
v_and_b32 v241, 0xffff0000, v214
v_pk_mul_f32 v[48:49], v[28:29], v[240:241] op_sel:[0,0] op_sel_hi:[0,1] neg_lo:[0,0] neg_hi:[0,0]
v_pk_fma_f32 v[28:29], v[28:29], v[240:241], v[48:49] op_sel:[1,1,0] op_sel_hi:[1,0,1] neg_lo:[0,1,0] neg_hi:[0,0,0]
v_lshlrev_b32 v240, 16, v215
v_and_b32 v241, 0xffff0000, v215
v_pk_mul_f32 v[48:49], v[60:61], v[240:241] op_sel:[0,0] op_sel_hi:[0,1] neg_lo:[0,0] neg_hi:[0,0]
v_pk_fma_f32 v[60:61], v[60:61], v[240:241], v[48:49] op_sel:[1,1,0] op_sel_hi:[1,0,1] neg_lo:[0,1,0] neg_hi:[0,0,0]
v_lshlrev_b32 v240, 16, v216
v_and_b32 v241, 0xffff0000, v216
v_pk_mul_f32 v[48:49], v[76:77], v[240:241] op_sel:[0,0] op_sel_hi:[0,1] neg_lo:[0,0] neg_hi:[0,0]
v_pk_fma_f32 v[76:77], v[76:77], v[240:241], v[48:49] op_sel:[1,1,0] op_sel_hi:[1,0,1] neg_lo:[0,1,0] neg_hi:[0,0,0]
v_lshlrev_b32 v240, 16, v217
v_and_b32 v241, 0xffff0000, v217
v_pk_mul_f32 v[48:49], v[46:47], v[240:241] op_sel:[0,0] op_sel_hi:[0,1] neg_lo:[0,0] neg_hi:[0,0]
v_pk_fma_f32 v[46:47], v[46:47], v[240:241], v[48:49] op_sel:[1,1,0] op_sel_hi:[1,0,1] neg_lo:[0,1,0] neg_hi:[0,0,0]
v_lshlrev_b32 v240, 16, v218
v_and_b32 v241, 0xffff0000, v218
v_pk_mul_f32 v[48:49], v[30:31], v[240:241] op_sel:[0,0] op_sel_hi:[0,1] neg_lo:[0,0] neg_hi:[0,0]
v_pk_fma_f32 v[30:31], v[30:31], v[240:241], v[48:49] op_sel:[1,1,0] op_sel_hi:[1,0,1] neg_lo:[0,1,0] neg_hi:[0,0,0]
v_lshlrev_b32 v240, 16, v219
v_and_b32 v241, 0xffff0000, v219
v_pk_mul_f32 v[48:49], v[62:63], v[240:241] op_sel:[0,0] op_sel_hi:[0,1] neg_lo:[0,0] neg_hi:[0,0]
v_pk_fma_f32 v[62:63], v[62:63], v[240:241], v[48:49] op_sel:[1,1,0] op_sel_hi:[1,0,1] neg_lo:[0,1,0] neg_hi:[0,0,0]
v_lshlrev_b32 v240, 16, v220
v_and_b32 v241, 0xffff0000, v220
v_pk_mul_f32 v[48:49], v[22:23], v[240:241] op_sel:[0,0] op_sel_hi:[0,1] neg_lo:[0,0] neg_hi:[0,0]
v_pk_fma_f32 v[22:23], v[22:23], v[240:241], v[48:49] op_sel:[1,1,0] op_sel_hi:[1,0,1] neg_lo:[0,1,0] neg_hi:[0,0,0]
v_lshlrev_b32 v240, 16, v221
v_and_b32 v241, 0xffff0000, v221
v_pk_mul_f32 v[48:49], v[54:55], v[240:241] op_sel:[0,0] op_sel_hi:[0,1] neg_lo:[0,0] neg_hi:[0,0]
v_pk_fma_f32 v[54:55], v[54:55], v[240:241], v[48:49] op_sel:[1,1,0] op_sel_hi:[1,0,1] neg_lo:[0,1,0] neg_hi:[0,0,0]
v_lshlrev_b32 v240, 16, v222
v_and_b32 v241, 0xffff0000, v222
v_pk_mul_f32 v[48:49], v[38:39], v[240:241] op_sel:[0,0] op_sel_hi:[0,1] neg_lo:[0,0] neg_hi:[0,0]
v_pk_fma_f32 v[38:39], v[38:39], v[240:241], v[48:49] op_sel:[1,1,0] op_sel_hi:[1,0,1] neg_lo:[0,1,0] neg_hi:[0,0,0]
v_lshlrev_b32 v240, 16, v223
v_and_b32 v241, 0xffff0000, v223
v_pk_mul_f32 v[48:49], v[70:71], v[240:241] op_sel:[0,0] op_sel_hi:[0,1] neg_lo:[0,0] neg_hi:[0,0]
v_pk_fma_f32 v[70:71], v[70:71], v[240:241], v[48:49] op_sel:[1,1,0] op_sel_hi:[1,0,1] neg_lo:[0,1,0] neg_hi:[0,0,0]
v_lshlrev_b32 v240, 16, v224
v_and_b32 v241, 0xffff0000, v224
v_pk_mul_f32 v[48:49], v[78:79], v[240:241] op_sel:[0,0] op_sel_hi:[0,1] neg_lo:[0,0] neg_hi:[0,0]
v_pk_fma_f32 v[78:79], v[78:79], v[240:241], v[48:49] op_sel:[1,1,0] op_sel_hi:[1,0,1] neg_lo:[0,1,0] neg_hi:[0,0,0]
v_lshlrev_b32 v240, 16, v225
v_and_b32 v241, 0xffff0000, v225
v_pk_mul_f32 v[48:49], v[32:33], v[240:241] op_sel:[0,0] op_sel_hi:[0,1] neg_lo:[0,0] neg_hi:[0,0]
v_pk_fma_f32 v[32:33], v[32:33], v[240:241], v[48:49] op_sel:[1,1,0] op_sel_hi:[1,0,1] neg_lo:[0,1,0] neg_hi:[0,0,0]
v_lshlrev_b32 v240, 16, v226
v_and_b32 v241, 0xffff0000, v226
v_pk_mul_f32 v[48:49], v[24:25], v[240:241] op_sel:[0,0] op_sel_hi:[0,1] neg_lo:[0,0] neg_hi:[0,0]
v_pk_fma_f32 v[24:25], v[24:25], v[240:241], v[48:49] op_sel:[1,1,0] op_sel_hi:[1,0,1] neg_lo:[0,1,0] neg_hi:[0,0,0]
v_lshlrev_b32 v240, 16, v227
v_and_b32 v241, 0xffff0000, v227
v_pk_mul_f32 v[48:49], v[56:57], v[240:241] op_sel:[0,0] op_sel_hi:[0,1] neg_lo:[0,0] neg_hi:[0,0]
v_pk_fma_f32 v[56:57], v[56:57], v[240:241], v[48:49] op_sel:[1,1,0] op_sel_hi:[1,0,1] neg_lo:[0,1,0] neg_hi:[0,0,0]
v_lshlrev_b32 v240, 16, v228
v_and_b32 v241, 0xffff0000, v228
v_pk_mul_f32 v[48:49], v[20:21], v[240:241] op_sel:[0,0] op_sel_hi:[0,1] neg_lo:[0,0] neg_hi:[0,0]
v_pk_fma_f32 v[20:21], v[20:21], v[240:241], v[48:49] op_sel:[1,1,0] op_sel_hi:[1,0,1] neg_lo:[0,1,0] neg_hi:[0,0,0]
v_lshlrev_b32 v240, 16, v229
v_and_b32 v241, 0xffff0000, v229
v_pk_mul_f32 v[48:49], v[52:53], v[240:241] op_sel:[0,0] op_sel_hi:[0,1] neg_lo:[0,0] neg_hi:[0,0]
v_pk_fma_f32 v[52:53], v[52:53], v[240:241], v[48:49] op_sel:[1,1,0] op_sel_hi:[1,0,1] neg_lo:[0,1,0] neg_hi:[0,0,0]
v_lshlrev_b32 v240, 16, v230
v_and_b32 v241, 0xffff0000, v230
v_pk_mul_f32 v[48:49], v[36:37], v[240:241] op_sel:[0,0] op_sel_hi:[0,1] neg_lo:[0,0] neg_hi:[0,0]
v_pk_fma_f32 v[36:37], v[36:37], v[240:241], v[48:49] op_sel:[1,1,0] op_sel_hi:[1,0,1] neg_lo:[0,1,0] neg_hi:[0,0,0]
v_lshlrev_b32 v240, 16, v231
v_and_b32 v241, 0xffff0000, v231
v_pk_mul_f32 v[48:49], v[68:69], v[240:241] op_sel:[0,0] op_sel_hi:[0,1] neg_lo:[0,0] neg_hi:[0,0]
v_pk_fma_f32 v[68:69], v[68:69], v[240:241], v[48:49] op_sel:[1,1,0] op_sel_hi:[1,0,1] neg_lo:[0,1,0] neg_hi:[0,0,0]
v_lshlrev_b32 v240, 16, v232
v_and_b32 v241, 0xffff0000, v232
v_pk_mul_f32 v[48:49], v[18:19], v[240:241] op_sel:[0,0] op_sel_hi:[0,1] neg_lo:[0,0] neg_hi:[0,0]
v_pk_fma_f32 v[18:19], v[18:19], v[240:241], v[48:49] op_sel:[1,1,0] op_sel_hi:[1,0,1] neg_lo:[0,1,0] neg_hi:[0,0,0]
v_lshlrev_b32 v240, 16, v233
v_and_b32 v241, 0xffff0000, v233
v_pk_mul_f32 v[48:49], v[50:51], v[240:241] op_sel:[0,0] op_sel_hi:[0,1] neg_lo:[0,0] neg_hi:[0,0]
v_pk_fma_f32 v[50:51], v[50:51], v[240:241], v[48:49] op_sel:[1,1,0] op_sel_hi:[1,0,1] neg_lo:[0,1,0] neg_hi:[0,0,0]
v_lshlrev_b32 v240, 16, v234
v_and_b32 v241, 0xffff0000, v234
v_pk_mul_f32 v[48:49], v[34:35], v[240:241] op_sel:[0,0] op_sel_hi:[0,1] neg_lo:[0,0] neg_hi:[0,0]
v_pk_fma_f32 v[34:35], v[34:35], v[240:241], v[48:49] op_sel:[1,1,0] op_sel_hi:[1,0,1] neg_lo:[0,1,0] neg_hi:[0,0,0]
v_lshlrev_b32 v240, 16, v235
v_and_b32 v241, 0xffff0000, v235
v_pk_mul_f32 v[48:49], v[66:67], v[240:241] op_sel:[0,0] op_sel_hi:[0,1] neg_lo:[0,0] neg_hi:[0,0]
v_pk_fma_f32 v[66:67], v[66:67], v[240:241], v[48:49] op_sel:[1,1,0] op_sel_hi:[1,0,1] neg_lo:[0,1,0] neg_hi:[0,0,0]
v_lshlrev_b32 v240, 16, v236
v_and_b32 v241, 0xffff0000, v236
v_pk_mul_f32 v[48:49], v[26:27], v[240:241] op_sel:[0,0] op_sel_hi:[0,1] neg_lo:[0,0] neg_hi:[0,0]
v_pk_fma_f32 v[26:27], v[26:27], v[240:241], v[48:49] op_sel:[1,1,0] op_sel_hi:[1,0,1] neg_lo:[0,1,0] neg_hi:[0,0,0]
v_lshlrev_b32 v240, 16, v237
v_and_b32 v241, 0xffff0000, v237
v_pk_mul_f32 v[48:49], v[58:59], v[240:241] op_sel:[0,0] op_sel_hi:[0,1] neg_lo:[0,0] neg_hi:[0,0]
v_pk_fma_f32 v[58:59], v[58:59], v[240:241], v[48:49] op_sel:[1,1,0] op_sel_hi:[1,0,1] neg_lo:[0,1,0] neg_hi:[0,0,0]
v_lshlrev_b32 v240, 16, v238
v_and_b32 v241, 0xffff0000, v238
v_pk_mul_f32 v[48:49], v[42:43], v[240:241] op_sel:[0,0] op_sel_hi:[0,1] neg_lo:[0,0] neg_hi:[0,0]
v_pk_fma_f32 v[42:43], v[42:43], v[240:241], v[48:49] op_sel:[1,1,0] op_sel_hi:[1,0,1] neg_lo:[0,1,0] neg_hi:[0,0,0]
v_lshlrev_b32 v240, 16, v239
v_and_b32 v241, 0xffff0000, v239
v_pk_mul_f32 v[48:49], v[74:75], v[240:241] op_sel:[0,0] op_sel_hi:[0,1] neg_lo:[0,0] neg_hi:[0,0]
v_pk_fma_f32 v[74:75], v[74:75], v[240:241], v[48:49] op_sel:[1,1,0] op_sel_hi:[1,0,1] neg_lo:[0,1,0] neg_hi:[0,0,0]
v_fmac_f32_dpp v16, v16, v7 quad_perm:[1,0,3,2] row_mask:0xf bank_mask:0xf
v_fmac_f32_dpp v17, v17, v7 quad_perm:[1,0,3,2] row_mask:0xf bank_mask:0xf
v_fmac_f32_dpp v14, v14, v7 quad_perm:[1,0,3,2] row_mask:0xf bank_mask:0xf
v_fmac_f32_dpp v15, v15, v7 quad_perm:[1,0,3,2] row_mask:0xf bank_mask:0xf
v_fmac_f32_dpp v64, v64, v7 quad_perm:[1,0,3,2] row_mask:0xf bank_mask:0xf
v_fmac_f32_dpp v65, v65, v7 quad_perm:[1,0,3,2] row_mask:0xf bank_mask:0xf
v_fmac_f32_dpp v40, v40, v7 quad_perm:[1,0,3,2] row_mask:0xf bank_mask:0xf
v_fmac_f32_dpp v41, v41, v7 quad_perm:[1,0,3,2] row_mask:0xf bank_mask:0xf
v_fmac_f32_dpp v72, v72, v7 quad_perm:[1,0,3,2] row_mask:0xf bank_mask:0xf
v_fmac_f32_dpp v73, v73, v7 quad_perm:[1,0,3,2] row_mask:0xf bank_mask:0xf
v_fmac_f32_dpp v44, v44, v7 quad_perm:[1,0,3,2] row_mask:0xf bank_mask:0xf
v_fmac_f32_dpp v45, v45, v7 quad_perm:[1,0,3,2] row_mask:0xf bank_mask:0xf
v_fmac_f32_dpp v28, v28, v7 quad_perm:[1,0,3,2] row_mask:0xf bank_mask:0xf
v_fmac_f32_dpp v29, v29, v7 quad_perm:[1,0,3,2] row_mask:0xf bank_mask:0xf
v_fmac_f32_dpp v60, v60, v7 quad_perm:[1,0,3,2] row_mask:0xf bank_mask:0xf
v_fmac_f32_dpp v61, v61, v7 quad_perm:[1,0,3,2] row_mask:0xf bank_mask:0xf
v_fmac_f32_dpp v76, v76, v7 quad_perm:[1,0,3,2] row_mask:0xf bank_mask:0xf
v_fmac_f32_dpp v77, v77, v7 quad_perm:[1,0,3,2] row_mask:0xf bank_mask:0xf
v_fmac_f32_dpp v46, v46, v7 quad_perm:[1,0,3,2] row_mask:0xf bank_mask:0xf
v_fmac_f32_dpp v47, v47, v7 quad_perm:[1,0,3,2] row_mask:0xf bank_mask:0xf
v_fmac_f32_dpp v30, v30, v7 quad_perm:[1,0,3,2] row_mask:0xf bank_mask:0xf
v_fmac_f32_dpp v31, v31, v7 quad_perm:[1,0,3,2] row_mask:0xf bank_mask:0xf
v_fmac_f32_dpp v62, v62, v7 quad_perm:[1,0,3,2] row_mask:0xf bank_mask:0xf
v_fmac_f32_dpp v63, v63, v7 quad_perm:[1,0,3,2] row_mask:0xf bank_mask:0xf
v_fmac_f32_dpp v22, v22, v7 quad_perm:[1,0,3,2] row_mask:0xf bank_mask:0xf
v_fmac_f32_dpp v23, v23, v7 quad_perm:[1,0,3,2] row_mask:0xf bank_mask:0xf
v_fmac_f32_dpp v54, v54, v7 quad_perm:[1,0,3,2] row_mask:0xf bank_mask:0xf
v_fmac_f32_dpp v55, v55, v7 quad_perm:[1,0,3,2] row_mask:0xf bank_mask:0xf
v_fmac_f32_dpp v38, v38, v7 quad_perm:[1,0,3,2] row_mask:0xf bank_mask:0xf
v_fmac_f32_dpp v39, v39, v7 quad_perm:[1,0,3,2] row_mask:0xf bank_mask:0xf
v_fmac_f32_dpp v70, v70, v7 quad_perm:[1,0,3,2] row_mask:0xf bank_mask:0xf
v_fmac_f32_dpp v71, v71, v7 quad_perm:[1,0,3,2] row_mask:0xf bank_mask:0xf
v_fmac_f32_dpp v78, v78, v7 quad_perm:[1,0,3,2] row_mask:0xf bank_mask:0xf
v_fmac_f32_dpp v79, v79, v7 quad_perm:[1,0,3,2] row_mask:0xf bank_mask:0xf
v_fmac_f32_dpp v32, v32, v7 quad_perm:[1,0,3,2] row_mask:0xf bank_mask:0xf
v_fmac_f32_dpp v33, v33, v7 quad_perm:[1,0,3,2] row_mask:0xf bank_mask:0xf
v_fmac_f32_dpp v24, v24, v7 quad_perm:[1,0,3,2] row_mask:0xf bank_mask:0xf
v_fmac_f32_dpp v25, v25, v7 quad_perm:[1,0,3,2] row_mask:0xf bank_mask:0xf
v_fmac_f32_dpp v56, v56, v7 quad_perm:[1,0,3,2] row_mask:0xf bank_mask:0xf
v_fmac_f32_dpp v57, v57, v7 quad_perm:[1,0,3,2] row_mask:0xf bank_mask:0xf
v_fmac_f32_dpp v20, v20, v7 quad_perm:[1,0,3,2] row_mask:0xf bank_mask:0xf
v_fmac_f32_dpp v21, v21, v7 quad_perm:[1,0,3,2] row_mask:0xf bank_mask:0xf
v_fmac_f32_dpp v52, v52, v7 quad_perm:[1,0,3,2] row_mask:0xf bank_mask:0xf
v_fmac_f32_dpp v53, v53, v7 quad_perm:[1,0,3,2] row_mask:0xf bank_mask:0xf
v_fmac_f32_dpp v36, v36, v7 quad_perm:[1,0,3,2] row_mask:0xf bank_mask:0xf
v_fmac_f32_dpp v37, v37, v7 quad_perm:[1,0,3,2] row_mask:0xf bank_mask:0xf
v_fmac_f32_dpp v68, v68, v7 quad_perm:[1,0,3,2] row_mask:0xf bank_mask:0xf
v_fmac_f32_dpp v69, v69, v7 quad_perm:[1,0,3,2] row_mask:0xf bank_mask:0xf
v_fmac_f32_dpp v18, v18, v7 quad_perm:[1,0,3,2] row_mask:0xf bank_mask:0xf
v_fmac_f32_dpp v19, v19, v7 quad_perm:[1,0,3,2] row_mask:0xf bank_mask:0xf
v_fmac_f32_dpp v50, v50, v7 quad_perm:[1,0,3,2] row_mask:0xf bank_mask:0xf
v_fmac_f32_dpp v51, v51, v7 quad_perm:[1,0,3,2] row_mask:0xf bank_mask:0xf
v_fmac_f32_dpp v34, v34, v7 quad_perm:[1,0,3,2] row_mask:0xf bank_mask:0xf
v_fmac_f32_dpp v35, v35, v7 quad_perm:[1,0,3,2] row_mask:0xf bank_mask:0xf
v_fmac_f32_dpp v66, v66, v7 quad_perm:[1,0,3,2] row_mask:0xf bank_mask:0xf
v_fmac_f32_dpp v67, v67, v7 quad_perm:[1,0,3,2] row_mask:0xf bank_mask:0xf
v_fmac_f32_dpp v26, v26, v7 quad_perm:[1,0,3,2] row_mask:0xf bank_mask:0xf
v_fmac_f32_dpp v27, v27, v7 quad_perm:[1,0,3,2] row_mask:0xf bank_mask:0xf
v_fmac_f32_dpp v58, v58, v7 quad_perm:[1,0,3,2] row_mask:0xf bank_mask:0xf
v_fmac_f32_dpp v59, v59, v7 quad_perm:[1,0,3,2] row_mask:0xf bank_mask:0xf
v_fmac_f32_dpp v42, v42, v7 quad_perm:[1,0,3,2] row_mask:0xf bank_mask:0xf
v_fmac_f32_dpp v43, v43, v7 quad_perm:[1,0,3,2] row_mask:0xf bank_mask:0xf
v_fmac_f32_dpp v74, v74, v7 quad_perm:[1,0,3,2] row_mask:0xf bank_mask:0xf
v_fmac_f32_dpp v75, v75, v7 quad_perm:[1,0,3,2] row_mask:0xf bank_mask:0xf
s_mov_b64 exec, s[18:19]
v_pk_add_f32 v[16:17], v[16:17], 0 neg_lo:[1,0] neg_hi:[1,0]
v_pk_mul_f32 v[48:49], v[14:15], s[48:49] op_sel:[0,0] op_sel_hi:[0,1] neg_lo:[0,1] neg_hi:[0,1]
v_pk_fma_f32 v[14:15], v[14:15], s[48:49], v[48:49] op_sel:[1,1,0] op_sel_hi:[1,0,1] neg_lo:[0,0,0] neg_hi:[0,1,0]
v_pk_mul_f32 v[48:49], v[64:65], s[50:51] op_sel:[0,0] op_sel_hi:[0,1] neg_lo:[0,1] neg_hi:[0,1]
v_pk_fma_f32 v[64:65], v[64:65], s[50:51], v[48:49] op_sel:[1,1,0] op_sel_hi:[1,0,1] neg_lo:[0,0,0] neg_hi:[0,1,0]
v_pk_mul_f32 v[48:49], v[40:41], s[52:53] op_sel:[0,0] op_sel_hi:[0,1] neg_lo:[0,1] neg_hi:[0,1]
v_pk_fma_f32 v[40:41], v[40:41], s[52:53], v[48:49] op_sel:[1,1,0] op_sel_hi:[1,0,1] neg_lo:[0,0,0] neg_hi:[0,1,0]
v_pk_mul_f32 v[48:49], v[72:73], s[54:55] op_sel:[0,0] op_sel_hi:[0,1] neg_lo:[0,1] neg_hi:[0,1]
v_pk_fma_f32 v[72:73], v[72:73], s[54:55], v[48:49] op_sel:[1,1,0] op_sel_hi:[1,0,1] neg_lo:[0,0,0] neg_hi:[0,1,0]
v_pk_mul_f32 v[48:49], v[44:45], s[56:57] op_sel:[0,0] op_sel_hi:[0,1] neg_lo:[0,1] neg_hi:[0,1]
v_pk_fma_f32 v[44:45], v[44:45], s[56:57], v[48:49] op_sel:[1,1,0] op_sel_hi:[1,0,1] neg_lo:[0,0,0] neg_hi:[0,1,0]
v_pk_mul_f32 v[48:49], v[28:29], s[58:59] op_sel:[0,0] op_sel_hi:[0,1] neg_lo:[0,1] neg_hi:[0,1]
v_pk_fma_f32 v[28:29], v[28:29], s[58:59], v[48:49] op_sel:[1,1,0] op_sel_hi:[1,0,1] neg_lo:[0,0,0] neg_hi:[0,1,0]
v_pk_mul_f32 v[48:49], v[60:61], s[60:61] op_sel:[0,0] op_sel_hi:[0,1] neg_lo:[0,1] neg_hi:[0,1]
v_pk_fma_f32 v[60:61], v[60:61], s[60:61], v[48:49] op_sel:[1,1,0] op_sel_hi:[1,0,1] neg_lo:[0,0,0] neg_hi:[0,1,0]
v_pk_mul_f32 v[48:49], v[76:77], s[62:63] op_sel:[0,0] op_sel_hi:[0,1] neg_lo:[0,1] neg_hi:[0,1]
v_pk_fma_f32 v[76:77], v[76:77], s[62:63], v[48:49] op_sel:[1,1,0] op_sel_hi:[1,0,1] neg_lo:[0,0,0] neg_hi:[0,1,0]
v_pk_mul_f32 v[48:49], v[46:47], s[60:61] op_sel:[0,1] op_sel_hi:[0,0] neg_lo:[0,1] neg_hi:[0,1]
v_pk_fma_f32 v[46:47], v[46:47], s[60:61], v[48:49] op_sel:[1,0,0] op_sel_hi:[1,1,1] neg_lo:[0,0,0] neg_hi:[0,1,0]
v_pk_mul_f32 v[48:49], v[30:31], s[58:59] op_sel:[0,1] op_sel_hi:[0,0] neg_lo:[0,1] neg_hi:[0,1]
v_pk_fma_f32 v[30:31], v[30:31], s[58:59], v[48:49] op_sel:[1,0,0] op_sel_hi:[1,1,1] neg_lo:[0,0,0] neg_hi:[0,1,0]
v_pk_mul_f32 v[48:49], v[62:63], s[56:57] op_sel:[0,1] op_sel_hi:[0,0] neg_lo:[0,1] neg_hi:[0,1]
v_pk_fma_f32 v[62:63], v[62:63], s[56:57], v[48:49] op_sel:[1,0,0] op_sel_hi:[1,1,1] neg_lo:[0,0,0] neg_hi:[0,1,0]
v_pk_mul_f32 v[48:49], v[22:23], s[54:55] op_sel:[0,1] op_sel_hi:[0,0] neg_lo:[0,1] neg_hi:[0,1]
v_pk_fma_f32 v[22:23], v[22:23], s[54:55], v[48:49] op_sel:[1,0,0] op_sel_hi:[1,1,1] neg_lo:[0,0,0] neg_hi:[0,1,0]
v_pk_mul_f32 v[48:49], v[54:55], s[52:53] op_sel:[0,1] op_sel_hi:[0,0] neg_lo:[0,1] neg_hi:[0,1]
v_pk_fma_f32 v[54:55], v[54:55], s[52:53], v[48:49] op_sel:[1,0,0] op_sel_hi:[1,1,1] neg_lo:[0,0,0] neg_hi:[0,1,0]
v_pk_mul_f32 v[48:49], v[38:39], s[50:51] op_sel:[0,1] op_sel_hi:[0,0] neg_lo:[0,1] neg_hi:[0,1]
v_pk_fma_f32 v[38:39], v[38:39], s[50:51], v[48:49] op_sel:[1,0,0] op_sel_hi:[1,1,1] neg_lo:[0,0,0] neg_hi:[0,1,0]
v_pk_mul_f32 v[48:49], v[70:71], s[48:49] op_sel:[0,1] op_sel_hi:[0,0] neg_lo:[0,1] neg_hi:[0,1]
v_pk_fma_f32 v[70:71], v[70:71], s[48:49], v[48:49] op_sel:[1,0,0] op_sel_hi:[1,1,1] neg_lo:[0,0,0] neg_hi:[0,1,0]
v_pk_add_f32 v[78:79], v[78:79], 0 op_sel:[1,0] op_sel_hi:[0,0] neg_lo:[0,0] neg_hi:[1,0]
v_pk_mul_f32 v[48:49], v[32:33], s[48:49] op_sel:[0,1] op_sel_hi:[0,0] neg_lo:[0,0] neg_hi:[0,1]
v_pk_fma_f32 v[32:33], v[32:33], s[48:49], v[48:49] op_sel:[1,0,0] op_sel_hi:[1,1,1] neg_lo:[0,0,0] neg_hi:[0,0,0]
v_pk_mul_f32 v[48:49], v[24:25], s[50:51] op_sel:[0,1] op_sel_hi:[0,0] neg_lo:[0,0] neg_hi:[0,1]
v_pk_fma_f32 v[24:25], v[24:25], s[50:51], v[48:49] op_sel:[1,0,0] op_sel_hi:[1,1,1] neg_lo:[0,0,0] neg_hi:[0,0,0]
v_pk_mul_f32 v[48:49], v[56:57], s[52:53] op_sel:[0,1] op_sel_hi:[0,0] neg_lo:[0,0] neg_hi:[0,1]
v_pk_fma_f32 v[56:57], v[56:57], s[52:53], v[48:49] op_sel:[1,0,0] op_sel_hi:[1,1,1] neg_lo:[0,0,0] neg_hi:[0,0,0]
v_pk_mul_f32 v[48:49], v[20:21], s[54:55] op_sel:[0,1] op_sel_hi:[0,0] neg_lo:[0,0] neg_hi:[0,1]
v_pk_fma_f32 v[20:21], v[20:21], s[54:55], v[48:49] op_sel:[1,0,0] op_sel_hi:[1,1,1] neg_lo:[0,0,0] neg_hi:[0,0,0]
v_pk_mul_f32 v[48:49], v[52:53], s[56:57] op_sel:[0,1] op_sel_hi:[0,0] neg_lo:[0,0] neg_hi:[0,1]
v_pk_fma_f32 v[52:53], v[52:53], s[56:57], v[48:49] op_sel:[1,0,0] op_sel_hi:[1,1,1] neg_lo:[0,0,0] neg_hi:[0,0,0]
v_pk_mul_f32 v[48:49], v[36:37], s[58:59] op_sel:[0,1] op_sel_hi:[0,0] neg_lo:[0,0] neg_hi:[0,1]
v_pk_fma_f32 v[36:37], v[36:37], s[58:59], v[48:49] op_sel:[1,0,0] op_sel_hi:[1,1,1] neg_lo:[0,0,0] neg_hi:[0,0,0]
v_pk_mul_f32 v[48:49], v[68:69], s[60:61] op_sel:[0,1] op_sel_hi:[0,0] neg_lo:[0,0] neg_hi:[0,1]
v_pk_fma_f32 v[68:69], v[68:69], s[60:61], v[48:49] op_sel:[1,0,0] op_sel_hi:[1,1,1] neg_lo:[0,0,0] neg_hi:[0,0,0]
v_pk_mul_f32 v[48:49], v[18:19], s[62:63] op_sel:[0,0] op_sel_hi:[0,1] neg_lo:[0,0] neg_hi:[0,1]
v_pk_fma_f32 v[18:19], v[18:19], s[62:63], v[48:49] op_sel:[1,1,0] op_sel_hi:[1,0,1] neg_lo:[0,0,0] neg_hi:[0,0,0]
v_pk_mul_f32 v[48:49], v[50:51], s[60:61] op_sel:[0,0] op_sel_hi:[0,1] neg_lo:[0,0] neg_hi:[0,1]
v_pk_fma_f32 v[50:51], v[50:51], s[60:61], v[48:49] op_sel:[1,1,0] op_sel_hi:[1,0,1] neg_lo:[0,0,0] neg_hi:[0,0,0]
v_pk_mul_f32 v[48:49], v[34:35], s[58:59] op_sel:[0,0] op_sel_hi:[0,1] neg_lo:[0,0] neg_hi:[0,1]
v_pk_fma_f32 v[34:35], v[34:35], s[58:59], v[48:49] op_sel:[1,1,0] op_sel_hi:[1,0,1] neg_lo:[0,0,0] neg_hi:[0,0,0]
v_pk_mul_f32 v[48:49], v[66:67], s[56:57] op_sel:[0,0] op_sel_hi:[0,1] neg_lo:[0,0] neg_hi:[0,1]
v_pk_fma_f32 v[66:67], v[66:67], s[56:57], v[48:49] op_sel:[1,1,0] op_sel_hi:[1,0,1] neg_lo:[0,0,0] neg_hi:[0,0,0]
v_pk_mul_f32 v[48:49], v[26:27], s[54:55] op_sel:[0,0] op_sel_hi:[0,1] neg_lo:[0,0] neg_hi:[0,1]
v_pk_fma_f32 v[26:27], v[26:27], s[54:55], v[48:49] op_sel:[1,1,0] op_sel_hi:[1,0,1] neg_lo:[0,0,0] neg_hi:[0,0,0]
v_pk_mul_f32 v[48:49], v[58:59], s[52:53] op_sel:[0,0] op_sel_hi:[0,1] neg_lo:[0,0] neg_hi:[0,1]
v_pk_fma_f32 v[58:59], v[58:59], s[52:53], v[48:49] op_sel:[1,1,0] op_sel_hi:[1,0,1] neg_lo:[0,0,0] neg_hi:[0,0,0]
v_pk_mul_f32 v[48:49], v[42:43], s[50:51] op_sel:[0,0] op_sel_hi:[0,1] neg_lo:[0,0] neg_hi:[0,1]
v_pk_fma_f32 v[42:43], v[42:43], s[50:51], v[48:49] op_sel:[1,1,0] op_sel_hi:[1,0,1] neg_lo:[0,0,0] neg_hi:[0,0,0]
v_pk_mul_f32 v[48:49], v[74:75], s[48:49] op_sel:[0,0] op_sel_hi:[0,1] neg_lo:[0,0] neg_hi:[0,1]
v_pk_fma_f32 v[74:75], v[74:75], s[48:49], v[48:49] op_sel:[1,1,0] op_sel_hi:[1,0,1] neg_lo:[0,0,0] neg_hi:[0,0,0]
s_mov_b64 exec, -1
v_pk_add_f32 v[48:49], v[16:17], v[78:79] neg_lo:[0,1] neg_hi:[0,1]
v_pk_add_f32 v[16:17], v[16:17], v[78:79]
v_pk_add_f32 v[78:79], v[14:15], v[32:33] neg_lo:[0,1] neg_hi:[0,1]
v_pk_add_f32 v[14:15], v[14:15], v[32:33]
v_pk_mul_f32 v[32:33], v[78:79], s[50:51] op_sel:[0,0] op_sel_hi:[0,1] neg_lo:[0,0] neg_hi:[0,0]
v_pk_fma_f32 v[32:33], v[78:79], s[50:51], v[32:33] op_sel:[1,1,0] op_sel_hi:[1,0,1] neg_lo:[0,1,0] neg_hi:[0,0,0]
v_pk_add_f32 v[78:79], v[64:65], v[24:25] neg_lo:[0,1] neg_hi:[0,1]
v_pk_add_f32 v[64:65], v[64:65], v[24:25]
v_pk_mul_f32 v[24:25], v[78:79], s[54:55] op_sel:[0,0] op_sel_hi:[0,1] neg_lo:[0,0] neg_hi:[0,0]
v_pk_fma_f32 v[24:25], v[78:79], s[54:55], v[24:25] op_sel:[1,1,0] op_sel_hi:[1,0,1] neg_lo:[0,1,0] neg_hi:[0,0,0]
v_pk_add_f32 v[78:79], v[40:41], v[56:57] neg_lo:[0,1] neg_hi:[0,1]
v_pk_add_f32 v[40:41], v[40:41], v[56:57]
v_pk_mul_f32 v[56:57], v[78:79], s[58:59] op_sel:[0,0] op_sel_hi:[0,1] neg_lo:[0,0] neg_hi:[0,0]
v_pk_fma_f32 v[56:57], v[78:79], s[58:59], v[56:57] op_sel:[1,1,0] op_sel_hi:[1,0,1] neg_lo:[0,1,0] neg_hi:[0,0,0]
v_pk_add_f32 v[78:79], v[72:73], v[20:21] neg_lo:[0,1] neg_hi:[0,1]
v_pk_add_f32 v[72:73], v[72:73], v[20:21]
v_pk_mul_f32 v[20:21], v[78:79], s[62:63] op_sel:[0,0] op_sel_hi:[0,1] neg_lo:[0,0] neg_hi:[0,0]
v_pk_fma_f32 v[20:21], v[78:79], s[62:63], v[20:21] op_sel:[1,1,0] op_sel_hi:[1,0,1] neg_lo:[0,1,0] neg_hi:[0,0,0]
v_pk_add_f32 v[78:79], v[44:45], v[52:53] neg_lo:[0,1] neg_hi:[0,1]
v_pk_add_f32 v[44:45], v[44:45], v[52:53]
v_pk_mul_f32 v[52:53], v[78:79], s[58:59] op_sel:[0,1] op_sel_hi:[0,0] neg_lo:[0,0] neg_hi:[0,0]
v_pk_fma_f32 v[52:53], v[78:79], s[58:59], v[52:53] op_sel:[1,0,0] op_sel_hi:[1,1,1] neg_lo:[0,1,0] neg_hi:[0,0,0]
v_pk_add_f32 v[78:79], v[28:29], v[36:37] neg_lo:[0,1] neg_hi:[0,1]
v_pk_add_f32 v[28:29], v[28:29], v[36:37]
v_pk_mul_f32 v[36:37], v[78:79], s[54:55] op_sel:[0,1] op_sel_hi:[0,0] neg_lo:[0,0] neg_hi:[0,0]
v_pk_fma_f32 v[36:37], v[78:79], s[54:55], v[36:37] op_sel:[1,0,0] op_sel_hi:[1,1,1] neg_lo:[0,1,0] neg_hi:[0,0,0]
v_pk_add_f32 v[78:79], v[60:61], v[68:69] neg_lo:[0,1] neg_hi:[0,1]
v_pk_add_f32 v[60:61], v[60:61], v[68:69]
v_pk_mul_f32 v[68:69], v[78:79], s[50:51] op_sel:[0,1] op_sel_hi:[0,0] neg_lo:[0,0] neg_hi:[0,0]
v_pk_fma_f32 v[68:69], v[78:79], s[50:51], v[68:69] op_sel:[1,0,0] op_sel_hi:[1,1,1] neg_lo:[0,1,0] neg_hi:[0,0,0]
v_pk_add_f32 v[78:79], v[76:77], v[18:19] op_sel:[1,1] op_sel_hi:[0,0] neg_lo:[1,0] neg_hi:[0,1]
v_pk_add_f32 v[76:77], v[76:77], v[18:19]
v_pk_add_f32 v[18:19], v[46:47], v[50:51] neg_lo:[0,1] neg_hi:[0,1]
v_pk_add_f32 v[46:47], v[46:47], v[50:51]
v_pk_mul_f32 v[50:51], v[18:19], s[50:51] op_sel:[0,1] op_sel_hi:[0,0] neg_lo:[0,1] neg_hi:[0,0]
v_pk_fma_f32 v[50:51], v[18:19], s[50:51], v[50:51] op_sel:[1,0,0] op_sel_hi:[1,1,1] neg_lo:[0,1,0] neg_hi:[0,1,0]
v_pk_add_f32 v[18:19], v[30:31], v[34:35] neg_lo:[0,1] neg_hi:[0,1]
v_pk_add_f32 v[30:31], v[30:31], v[34:35]
v_pk_mul_f32 v[34:35], v[18:19], s[54:55] op_sel:[0,1] op_sel_hi:[0,0] neg_lo:[0,1] neg_hi:[0,0]
v_pk_fma_f32 v[34:35], v[18:19], s[54:55], v[34:35] op_sel:[1,0,0] op_sel_hi:[1,1,1] neg_lo:[0,1,0] neg_hi:[0,1,0]
v_pk_add_f32 v[18:19], v[62:63], v[66:67] neg_lo:[0,1] neg_hi:[0,1]
v_pk_add_f32 v[62:63], v[62:63], v[66:67]
v_pk_mul_f32 v[66:67], v[18:19], s[58:59] op_sel:[0,1] op_sel_hi:[0,0] neg_lo:[0,1] neg_hi:[0,0]
v_pk_fma_f32 v[66:67], v[18:19], s[58:59], v[66:67] op_sel:[1,0,0] op_sel_hi:[1,1,1] neg_lo:[0,1,0] neg_hi:[0,1,0]
v_pk_add_f32 v[18:19], v[22:23], v[26:27] neg_lo:[0,1] neg_hi:[0,1]
v_pk_add_f32 v[22:23], v[22:23], v[26:27]
v_pk_mul_f32 v[26:27], v[18:19], s[62:63] op_sel:[0,0] op_sel_hi:[0,1] neg_lo:[0,1] neg_hi:[0,0]
v_pk_fma_f32 v[26:27], v[18:19], s[62:63], v[26:27] op_sel:[1,1,0] op_sel_hi:[1,0,1] neg_lo:[0,1,0] neg_hi:[0,1,0]
v_pk_add_f32 v[18:19], v[54:55], v[58:59] neg_lo:[0,1] neg_hi:[0,1]
v_pk_add_f32 v[54:55], v[54:55], v[58:59]
v_pk_mul_f32 v[58:59], v[18:19], s[58:59] op_sel:[0,0] op_sel_hi:[0,1] neg_lo:[0,1] neg_hi:[0,0]
v_pk_fma_f32 v[58:59], v[18:19], s[58:59], v[58:59] op_sel:[1,1,0] op_sel_hi:[1,0,1] neg_lo:[0,1,0] neg_hi:[0,1,0]
v_pk_add_f32 v[18:19], v[38:39], v[42:43] neg_lo:[0,1] neg_hi:[0,1]
v_pk_add_f32 v[38:39], v[38:39], v[42:43]
v_pk_mul_f32 v[42:43], v[18:19], s[54:55] op_sel:[0,0] op_sel_hi:[0,1] neg_lo:[0,1] neg_hi:[0,0]
v_pk_fma_f32 v[42:43], v[18:19], s[54:55], v[42:43] op_sel:[1,1,0] op_sel_hi:[1,0,1] neg_lo:[0,1,0] neg_hi:[0,1,0]
v_pk_add_f32 v[18:19], v[70:71], v[74:75] neg_lo:[0,1] neg_hi:[0,1]
v_pk_add_f32 v[70:71], v[70:71], v[74:75]
v_pk_mul_f32 v[74:75], v[18:19], s[50:51] op_sel:[0,0] op_sel_hi:[0,1] neg_lo:[0,1] neg_hi:[0,0]
v_pk_fma_f32 v[74:75], v[18:19], s[50:51], v[74:75] op_sel:[1,1,0] op_sel_hi:[1,0,1] neg_lo:[0,1,0] neg_hi:[0,1,0]
v_pk_add_f32 v[18:19], v[16:17], v[76:77] neg_lo:[0,1] neg_hi:[0,1]
v_pk_add_f32 v[16:17], v[16:17], v[76:77]
v_pk_add_f32 v[76:77], v[14:15], v[46:47] neg_lo:[0,1] neg_hi:[0,1]
v_pk_add_f32 v[14:15], v[14:15], v[46:47]
v_pk_mul_f32 v[46:47], v[76:77], s[54:55] op_sel:[0,0] op_sel_hi:[0,1] neg_lo:[0,0] neg_hi:[0,0]
v_pk_fma_f32 v[46:47], v[76:77], s[54:55], v[46:47] op_sel:[1,1,0] op_sel_hi:[1,0,1] neg_lo:[0,1,0] neg_hi:[0,0,0]
v_pk_add_f32 v[76:77], v[64:65], v[30:31] neg_lo:[0,1] neg_hi:[0,1]
v_pk_add_f32 v[64:65], v[64:65], v[30:31]
v_pk_mul_f32 v[30:31], v[76:77], s[62:63] op_sel:[0,0] op_sel_hi:[0,1] neg_lo:[0,0] neg_hi:[0,0]
v_pk_fma_f32 v[30:31], v[76:77], s[62:63], v[30:31] op_sel:[1,1,0] op_sel_hi:[1,0,1] neg_lo:[0,1,0] neg_hi:[0,0,0]
v_pk_add_f32 v[76:77], v[40:41], v[62:63] neg_lo:[0,1] neg_hi:[0,1]
v_pk_add_f32 v[40:41], v[40:41], v[62:63]
v_pk_mul_f32 v[62:63], v[76:77], s[54:55] op_sel:[0,1] op_sel_hi:[0,0] neg_lo:[0,0] neg_hi:[0,0]
v_pk_fma_f32 v[62:63], v[76:77], s[54:55], v[62:63] op_sel:[1,0,0] op_sel_hi:[1,1,1] neg_lo:[0,1,0] neg_hi:[0,0,0]
v_pk_add_f32 v[76:77], v[72:73], v[22:23] op_sel:[1,1] op_sel_hi:[0,0] neg_lo:[1,0] neg_hi:[0,1]
v_pk_add_f32 v[72:73], v[72:73], v[22:23]
v_pk_add_f32 v[22:23], v[44:45], v[54:55] neg_lo:[0,1] neg_hi:[0,1]
v_pk_add_f32 v[44:45], v[44:45], v[54:55]
v_pk_mul_f32 v[54:55], v[22:23], s[54:55] op_sel:[0,1] op_sel_hi:[0,0] neg_lo:[0,1] neg_hi:[0,0]
v_pk_fma_f32 v[54:55], v[22:23], s[54:55], v[54:55] op_sel:[1,0,0] op_sel_hi:[1,1,1] neg_lo:[0,1,0] neg_hi:[0,1,0]
v_pk_add_f32 v[22:23], v[28:29], v[38:39] neg_lo:[0,1] neg_hi:[0,1]
v_pk_add_f32 v[28:29], v[28:29], v[38:39]
v_pk_mul_f32 v[38:39], v[22:23], s[62:63] op_sel:[0,0] op_sel_hi:[0,1] neg_lo:[0,1] neg_hi:[0,0]
v_pk_fma_f32 v[38:39], v[22:23], s[62:63], v[38:39] op_sel:[1,1,0] op_sel_hi:[1,0,1] neg_lo:[0,1,0] neg_hi:[0,1,0]
v_pk_add_f32 v[22:23], v[60:61], v[70:71] neg_lo:[0,1] neg_hi:[0,1]
v_pk_add_f32 v[60:61], v[60:61], v[70:71]
v_pk_mul_f32 v[70:71], v[22:23], s[54:55] op_sel:[0,0] op_sel_hi:[0,1] neg_lo:[0,1] neg_hi:[0,0]
v_pk_fma_f32 v[70:71], v[22:23], s[54:55], v[70:71] op_sel:[1,1,0] op_sel_hi:[1,0,1] neg_lo:[0,1,0] neg_hi:[0,1,0]
v_pk_add_f32 v[22:23], v[48:49], v[78:79] neg_lo:[0,1] neg_hi:[0,1]
v_pk_add_f32 v[48:49], v[48:49], v[78:79]
v_pk_add_f32 v[78:79], v[32:33], v[50:51] neg_lo:[0,1] neg_hi:[0,1]
v_pk_add_f32 v[32:33], v[32:33], v[50:51]
v_pk_mul_f32 v[50:51], v[78:79], s[54:55] op_sel:[0,0] op_sel_hi:[0,1] neg_lo:[0,0] neg_hi:[0,0]
v_pk_fma_f32 v[50:51], v[78:79], s[54:55], v[50:51] op_sel:[1,1,0] op_sel_hi:[1,0,1] neg_lo:[0,1,0] neg_hi:[0,0,0]
v_pk_add_f32 v[78:79], v[24:25], v[34:35] neg_lo:[0,1] neg_hi:[0,1]
v_pk_add_f32 v[24:25], v[24:25], v[34:35]
v_pk_mul_f32 v[34:35], v[78:79], s[62:63] op_sel:[0,0] op_sel_hi:[0,1] neg_lo:[0,0] neg_hi:[0,0]
v_pk_fma_f32 v[34:35], v[78:79], s[62:63], v[34:35] op_sel:[1,1,0] op_sel_hi:[1,0,1] neg_lo:[0,1,0] neg_hi:[0,0,0]
v_pk_add_f32 v[78:79], v[56:57], v[66:67] neg_lo:[0,1] neg_hi:[0,1]
v_pk_add_f32 v[56:57], v[56:57], v[66:67]
v_pk_mul_f32 v[66:67], v[78:79], s[54:55] op_sel:[0,1] op_sel_hi:[0,0] neg_lo:[0,0] neg_hi:[0,0]
v_pk_fma_f32 v[66:67], v[78:79], s[54:55], v[66:67] op_sel:[1,0,0] op_sel_hi:[1,1,1] neg_lo:[0,1,0] neg_hi:[0,0,0]
v_pk_add_f32 v[78:79], v[20:21], v[26:27] op_sel:[1,1] op_sel_hi:[0,0] neg_lo:[1,0] neg_hi:[0,1]
v_pk_add_f32 v[20:21], v[20:21], v[26:27]
v_pk_add_f32 v[26:27], v[52:53], v[58:59] neg_lo:[0,1] neg_hi:[0,1]
v_pk_add_f32 v[52:53], v[52:53], v[58:59]
v_pk_mul_f32 v[58:59], v[26:27], s[54:55] op_sel:[0,1] op_sel_hi:[0,0] neg_lo:[0,1] neg_hi:[0,0]
v_pk_fma_f32 v[58:59], v[26:27], s[54:55], v[58:59] op_sel:[1,0,0] op_sel_hi:[1,1,1] neg_lo:[0,1,0] neg_hi:[0,1,0]
v_pk_add_f32 v[26:27], v[36:37], v[42:43] neg_lo:[0,1] neg_hi:[0,1]
v_pk_add_f32 v[36:37], v[36:37], v[42:43]
v_pk_mul_f32 v[42:43], v[26:27], s[62:63] op_sel:[0,0] op_sel_hi:[0,1] neg_lo:[0,1] neg_hi:[0,0]
v_pk_fma_f32 v[42:43], v[26:27], s[62:63], v[42:43] op_sel:[1,1,0] op_sel_hi:[1,0,1] neg_lo:[0,1,0] neg_hi:[0,1,0]
v_pk_add_f32 v[26:27], v[68:69], v[74:75] neg_lo:[0,1] neg_hi:[0,1]
v_pk_add_f32 v[68:69], v[68:69], v[74:75]
v_pk_mul_f32 v[74:75], v[26:27], s[54:55] op_sel:[0,0] op_sel_hi:[0,1] neg_lo:[0,1] neg_hi:[0,0]
v_pk_fma_f32 v[74:75], v[26:27], s[54:55], v[74:75] op_sel:[1,1,0] op_sel_hi:[1,0,1] neg_lo:[0,1,0] neg_hi:[0,1,0]
v_pk_add_f32 v[26:27], v[16:17], v[72:73] neg_lo:[0,1] neg_hi:[0,1]
v_pk_add_f32 v[16:17], v[16:17], v[72:73]
v_pk_add_f32 v[72:73], v[14:15], v[44:45] neg_lo:[0,1] neg_hi:[0,1]
v_pk_add_f32 v[14:15], v[14:15], v[44:45]
v_pk_mul_f32 v[44:45], v[72:73], s[62:63] op_sel:[0,0] op_sel_hi:[0,1] neg_lo:[0,0] neg_hi:[0,0]
v_pk_fma_f32 v[44:45], v[72:73], s[62:63], v[44:45] op_sel:[1,1,0] op_sel_hi:[1,0,1] neg_lo:[0,1,0] neg_hi:[0,0,0]
v_pk_add_f32 v[72:73], v[64:65], v[28:29] op_sel:[1,1] op_sel_hi:[0,0] neg_lo:[1,0] neg_hi:[0,1]
v_pk_add_f32 v[64:65], v[64:65], v[28:29]
v_pk_add_f32 v[28:29], v[40:41], v[60:61] neg_lo:[0,1] neg_hi:[0,1]
v_pk_add_f32 v[40:41], v[40:41], v[60:61]
v_pk_mul_f32 v[60:61], v[28:29], s[62:63] op_sel:[0,0] op_sel_hi:[0,1] neg_lo:[0,1] neg_hi:[0,0]
v_pk_fma_f32 v[60:61], v[28:29], s[62:63], v[60:61] op_sel:[1,1,0] op_sel_hi:[1,0,1] neg_lo:[0,1,0] neg_hi:[0,1,0]
v_pk_add_f32 v[28:29], v[18:19], v[76:77] neg_lo:[0,1] neg_hi:[0,1]
v_pk_add_f32 v[18:19], v[18:19], v[76:77]
v_pk_add_f32 v[76:77], v[46:47], v[54:55] neg_lo:[0,1] neg_hi:[0,1]
v_pk_add_f32 v[46:47], v[46:47], v[54:55]
v_pk_mul_f32 v[54:55], v[76:77], s[62:63] op_sel:[0,0] op_sel_hi:[0,1] neg_lo:[0,0] neg_hi:[0,0]
v_pk_fma_f32 v[54:55], v[76:77], s[62:63], v[54:55] op_sel:[1,1,0] op_sel_hi:[1,0,1] neg_lo:[0,1,0] neg_hi:[0,0,0]
v_pk_add_f32 v[76:77], v[30:31], v[38:39] op_sel:[1,1] op_sel_hi:[0,0] neg_lo:[1,0] neg_hi:[0,1]
v_pk_add_f32 v[30:31], v[30:31], v[38:39]
v_pk_add_f32 v[38:39], v[62:63], v[70:71] neg_lo:[0,1] neg_hi:[0,1]
v_pk_add_f32 v[62:63], v[62:63], v[70:71]
v_pk_mul_f32 v[70:71], v[38:39], s[62:63] op_sel:[0,0] op_sel_hi:[0,1] neg_lo:[0,1] neg_hi:[0,0]
v_pk_fma_f32 v[70:71], v[38:39], s[62:63], v[70:71] op_sel:[1,1,0] op_sel_hi:[1,0,1] neg_lo:[0,1,0] neg_hi:[0,1,0]
v_pk_add_f32 v[38:39], v[48:49], v[20:21] neg_lo:[0,1] neg_hi:[0,1]
v_pk_add_f32 v[48:49], v[48:49], v[20:21]
v_pk_add_f32 v[20:21], v[32:33], v[52:53] neg_lo:[0,1] neg_hi:[0,1]
v_pk_add_f32 v[32:33], v[32:33], v[52:53]
v_pk_mul_f32 v[52:53], v[20:21], s[62:63] op_sel:[0,0] op_sel_hi:[0,1] neg_lo:[0,0] neg_hi:[0,0]
v_pk_fma_f32 v[52:53], v[20:21], s[62:63], v[52:53] op_sel:[1,1,0] op_sel_hi:[1,0,1] neg_lo:[0,1,0] neg_hi:[0,0,0]
v_pk_add_f32 v[20:21], v[24:25], v[36:37] op_sel:[1,1] op_sel_hi:[0,0] neg_lo:[1,0] neg_hi:[0,1]
v_pk_add_f32 v[24:25], v[24:25], v[36:37]
v_pk_add_f32 v[36:37], v[56:57], v[68:69] neg_lo:[0,1] neg_hi:[0,1]
v_pk_add_f32 v[56:57], v[56:57], v[68:69]
v_pk_mul_f32 v[68:69], v[36:37], s[62:63] op_sel:[0,0] op_sel_hi:[0,1] neg_lo:[0,1] neg_hi:[0,0]
v_pk_fma_f32 v[68:69], v[36:37], s[62:63], v[68:69] op_sel:[1,1,0] op_sel_hi:[1,0,1] neg_lo:[0,1,0] neg_hi:[0,1,0]
v_pk_add_f32 v[36:37], v[22:23], v[78:79] neg_lo:[0,1] neg_hi:[0,1]
v_pk_add_f32 v[22:23], v[22:23], v[78:79]
v_pk_add_f32 v[78:79], v[50:51], v[58:59] neg_lo:[0,1] neg_hi:[0,1]
v_pk_add_f32 v[50:51], v[50:51], v[58:59]
v_pk_mul_f32 v[58:59], v[78:79], s[62:63] op_sel:[0,0] op_sel_hi:[0,1] neg_lo:[0,0] neg_hi:[0,0]
v_pk_fma_f32 v[58:59], v[78:79], s[62:63], v[58:59] op_sel:[1,1,0] op_sel_hi:[1,0,1] neg_lo:[0,1,0] neg_hi:[0,0,0]
v_pk_add_f32 v[78:79], v[34:35], v[42:43] op_sel:[1,1] op_sel_hi:[0,0] neg_lo:[1,0] neg_hi:[0,1]
v_pk_add_f32 v[34:35], v[34:35], v[42:43]
v_pk_add_f32 v[42:43], v[66:67], v[74:75] neg_lo:[0,1] neg_hi:[0,1]
v_pk_add_f32 v[66:67], v[66:67], v[74:75]
v_pk_mul_f32 v[74:75], v[42:43], s[62:63] op_sel:[0,0] op_sel_hi:[0,1] neg_lo:[0,1] neg_hi:[0,0]
v_pk_fma_f32 v[74:75], v[42:43], s[62:63], v[74:75] op_sel:[1,1,0] op_sel_hi:[1,0,1] neg_lo:[0,1,0] neg_hi:[0,1,0]
v_pk_add_f32 v[42:43], v[16:17], v[64:65] neg_lo:[0,1] neg_hi:[0,1]
v_pk_add_f32 v[16:17], v[16:17], v[64:65]
v_pk_add_f32 v[64:65], v[14:15], v[40:41] op_sel:[1,1] op_sel_hi:[0,0] neg_lo:[1,0] neg_hi:[0,1]
v_pk_add_f32 v[14:15], v[14:15], v[40:41]
v_pk_add_f32 v[40:41], v[26:27], v[72:73] neg_lo:[0,1] neg_hi:[0,1]
v_pk_add_f32 v[26:27], v[26:27], v[72:73]
v_pk_add_f32 v[72:73], v[44:45], v[60:61] op_sel:[1,1] op_sel_hi:[0,0] neg_lo:[1,0] neg_hi:[0,1]
v_pk_add_f32 v[44:45], v[44:45], v[60:61]
v_pk_add_f32 v[60:61], v[18:19], v[30:31] neg_lo:[0,1] neg_hi:[0,1]
v_pk_add_f32 v[18:19], v[18:19], v[30:31]
v_pk_add_f32 v[30:31], v[46:47], v[62:63] op_sel:[1,1] op_sel_hi:[0,0] neg_lo:[1,0] neg_hi:[0,1]
v_pk_add_f32 v[46:47], v[46:47], v[62:63]
v_pk_add_f32 v[62:63], v[28:29], v[76:77] neg_lo:[0,1] neg_hi:[0,1]
v_pk_add_f32 v[28:29], v[28:29], v[76:77]
v_pk_add_f32 v[76:77], v[54:55], v[70:71] op_sel:[1,1] op_sel_hi:[0,0] neg_lo:[1,0] neg_hi:[0,1]
v_pk_add_f32 v[54:55], v[54:55], v[70:71]
v_pk_add_f32 v[70:71], v[48:49], v[24:25] neg_lo:[0,1] neg_hi:[0,1]
v_pk_add_f32 v[48:49], v[48:49], v[24:25]
v_pk_add_f32 v[24:25], v[32:33], v[56:57] op_sel:[1,1] op_sel_hi:[0,0] neg_lo:[1,0] neg_hi:[0,1]
v_pk_add_f32 v[32:33], v[32:33], v[56:57]
v_pk_add_f32 v[56:57], v[38:39], v[20:21] neg_lo:[0,1] neg_hi:[0,1]
v_pk_add_f32 v[38:39], v[38:39], v[20:21]
v_pk_add_f32 v[20:21], v[52:53], v[68:69] op_sel:[1,1] op_sel_hi:[0,0] neg_lo:[1,0] neg_hi:[0,1]
v_pk_add_f32 v[52:53], v[52:53], v[68:69]
v_pk_add_f32 v[68:69], v[22:23], v[34:35] neg_lo:[0,1] neg_hi:[0,1]
v_pk_add_f32 v[22:23], v[22:23], v[34:35]
v_pk_add_f32 v[34:35], v[50:51], v[66:67] op_sel:[1,1] op_sel_hi:[0,0] neg_lo:[1,0] neg_hi:[0,1]
v_pk_add_f32 v[50:51], v[50:51], v[66:67]
v_pk_add_f32 v[66:67], v[36:37], v[78:79] neg_lo:[0,1] neg_hi:[0,1]
v_pk_add_f32 v[36:37], v[36:37], v[78:79]
v_pk_add_f32 v[78:79], v[58:59], v[74:75] op_sel:[1,1] op_sel_hi:[0,0] neg_lo:[1,0] neg_hi:[0,1]
v_pk_add_f32 v[58:59], v[58:59], v[74:75]
v_pk_add_f32 v[74:75], v[16:17], v[14:15] neg_lo:[0,1] neg_hi:[0,1]
v_pk_add_f32 v[16:17], v[16:17], v[14:15]
v_pk_add_f32 v[14:15], v[42:43], v[64:65] neg_lo:[0,1] neg_hi:[0,1]
v_pk_add_f32 v[42:43], v[42:43], v[64:65]
v_pk_add_f32 v[64:65], v[26:27], v[44:45] neg_lo:[0,1] neg_hi:[0,1]
v_pk_add_f32 v[26:27], v[26:27], v[44:45]
v_pk_add_f32 v[44:45], v[40:41], v[72:73] neg_lo:[0,1] neg_hi:[0,1]
v_pk_add_f32 v[40:41], v[40:41], v[72:73]
v_pk_add_f32 v[72:73], v[18:19], v[46:47] neg_lo:[0,1] neg_hi:[0,1]
v_pk_add_f32 v[18:19], v[18:19], v[46:47]
v_pk_add_f32 v[46:47], v[60:61], v[30:31] neg_lo:[0,1] neg_hi:[0,1]
v_pk_add_f32 v[60:61], v[60:61], v[30:31]
v_pk_add_f32 v[30:31], v[28:29], v[54:55] neg_lo:[0,1] neg_hi:[0,1]
v_pk_add_f32 v[28:29], v[28:29], v[54:55]
v_pk_add_f32 v[54:55], v[62:63], v[76:77] neg_lo:[0,1] neg_hi:[0,1]
v_pk_add_f32 v[62:63], v[62:63], v[76:77]
v_pk_add_f32 v[76:77], v[48:49], v[32:33] neg_lo:[0,1] neg_hi:[0,1]
v_pk_add_f32 v[48:49], v[48:49], v[32:33]
v_pk_add_f32 v[32:33], v[70:71], v[24:25] neg_lo:[0,1] neg_hi:[0,1]
v_pk_add_f32 v[70:71], v[70:71], v[24:25]
v_pk_add_f32 v[24:25], v[38:39], v[52:53] neg_lo:[0,1] neg_hi:[0,1]
v_pk_add_f32 v[38:39], v[38:39], v[52:53]
v_pk_add_f32 v[52:53], v[56:57], v[20:21] neg_lo:[0,1] neg_hi:[0,1]
v_pk_add_f32 v[56:57], v[56:57], v[20:21]
v_pk_add_f32 v[20:21], v[22:23], v[50:51] neg_lo:[0,1] neg_hi:[0,1]
v_pk_add_f32 v[22:23], v[22:23], v[50:51]
v_pk_add_f32 v[50:51], v[68:69], v[34:35] neg_lo:[0,1] neg_hi:[0,1]
v_pk_add_f32 v[68:69], v[68:69], v[34:35]
v_pk_add_f32 v[34:35], v[36:37], v[58:59] neg_lo:[0,1] neg_hi:[0,1]
v_pk_add_f32 v[36:37], v[36:37], v[58:59]
v_pk_add_f32 v[58:59], v[66:67], v[78:79] neg_lo:[0,1] neg_hi:[0,1]
v_pk_add_f32 v[66:67], v[66:67], v[78:79]
v_pk_mul_f32 v[78:79], v[16:17], v[144:145] op_sel:[0,0] op_sel_hi:[0,1] neg_lo:[0,0] neg_hi:[0,0]
v_pk_fma_f32 v[16:17], v[16:17], v[144:145], v[78:79] op_sel:[1,1,0] op_sel_hi:[1,0,1] neg_lo:[0,1,0] neg_hi:[0,0,0]
v_pk_mul_f32 v[78:79], v[48:49], v[146:147] op_sel:[0,0] op_sel_hi:[0,1] neg_lo:[0,0] neg_hi:[0,0]
v_pk_fma_f32 v[48:49], v[48:49], v[146:147], v[78:79] op_sel:[1,1,0] op_sel_hi:[1,0,1] neg_lo:[0,1,0] neg_hi:[0,0,0]
v_pk_mul_f32 v[78:79], v[18:19], v[148:149] op_sel:[0,0] op_sel_hi:[0,1] neg_lo:[0,0] neg_hi:[0,0]
v_pk_fma_f32 v[18:19], v[18:19], v[148:149], v[78:79] op_sel:[1,1,0] op_sel_hi:[1,0,1] neg_lo:[0,1,0] neg_hi:[0,0,0]
v_pk_mul_f32 v[78:79], v[22:23], v[150:151] op_sel:[0,0] op_sel_hi:[0,1] neg_lo:[0,0] neg_hi:[0,0]
v_pk_fma_f32 v[22:23], v[22:23], v[150:151], v[78:79] op_sel:[1,1,0] op_sel_hi:[1,0,1] neg_lo:[0,1,0] neg_hi:[0,0,0]
v_pk_mul_f32 v[78:79], v[26:27], v[152:153] op_sel:[0,0] op_sel_hi:[0,1] neg_lo:[0,0] neg_hi:[0,0]
v_pk_fma_f32 v[26:27], v[26:27], v[152:153], v[78:79] op_sel:[1,1,0] op_sel_hi:[1,0,1] neg_lo:[0,1,0] neg_hi:[0,0,0]
v_pk_mul_f32 v[78:79], v[38:39], v[154:155] op_sel:[0,0] op_sel_hi:[0,1] neg_lo:[0,0] neg_hi:[0,0]
v_pk_fma_f32 v[38:39], v[38:39], v[154:155], v[78:79] op_sel:[1,1,0] op_sel_hi:[1,0,1] neg_lo:[0,1,0] neg_hi:[0,0,0]
v_pk_mul_f32 v[78:79], v[28:29], v[156:157] op_sel:[0,0] op_sel_hi:[0,1] neg_lo:[0,0] neg_hi:[0,0]
v_pk_fma_f32 v[28:29], v[28:29], v[156:157], v[78:79] op_sel:[1,1,0] op_sel_hi:[1,0,1] neg_lo:[0,1,0] neg_hi:[0,0,0]
v_pk_mul_f32 v[78:79], v[36:37], v[158:159] op_sel:[0,0] op_sel_hi:[0,1] neg_lo:[0,0] neg_hi:[0,0]
v_pk_fma_f32 v[36:37], v[36:37], v[158:159], v[78:79] op_sel:[1,1,0] op_sel_hi:[1,0,1] neg_lo:[0,1,0] neg_hi:[0,0,0]
v_pk_mul_f32 v[78:79], v[42:43], v[160:161] op_sel:[0,0] op_sel_hi:[0,1] neg_lo:[0,0] neg_hi:[0,0]
v_pk_fma_f32 v[42:43], v[42:43], v[160:161], v[78:79] op_sel:[1,1,0] op_sel_hi:[1,0,1] neg_lo:[0,1,0] neg_hi:[0,0,0]
v_pk_mul_f32 v[78:79], v[70:71], v[162:163] op_sel:[0,0] op_sel_hi:[0,1] neg_lo:[0,0] neg_hi:[0,0]
v_pk_fma_f32 v[70:71], v[70:71], v[162:163], v[78:79] op_sel:[1,1,0] op_sel_hi:[1,0,1] neg_lo:[0,1,0] neg_hi:[0,0,0]
v_pk_mul_f32 v[78:79], v[60:61], v[164:165] op_sel:[0,0] op_sel_hi:[0,1] neg_lo:[0,0] neg_hi:[0,0]
v_pk_fma_f32 v[60:61], v[60:61], v[164:165], v[78:79] op_sel:[1,1,0] op_sel_hi:[1,0,1] neg_lo:[0,1,0] neg_hi:[0,0,0]
v_pk_mul_f32 v[78:79], v[68:69], v[166:167] op_sel:[0,0] op_sel_hi:[0,1] neg_lo:[0,0] neg_hi:[0,0]
v_pk_fma_f32 v[68:69], v[68:69], v[166:167], v[78:79] op_sel:[1,1,0] op_sel_hi:[1,0,1] neg_lo:[0,1,0] neg_hi:[0,0,0]
v_pk_mul_f32 v[78:79], v[40:41], v[168:169] op_sel:[0,0] op_sel_hi:[0,1] neg_lo:[0,0] neg_hi:[0,0]
v_pk_fma_f32 v[40:41], v[40:41], v[168:169], v[78:79] op_sel:[1,1,0] op_sel_hi:[1,0,1] neg_lo:[0,1,0] neg_hi:[0,0,0]
v_pk_mul_f32 v[78:79], v[56:57], v[170:171] op_sel:[0,0] op_sel_hi:[0,1] neg_lo:[0,0] neg_hi:[0,0]
v_pk_fma_f32 v[56:57], v[56:57], v[170:171], v[78:79] op_sel:[1,1,0] op_sel_hi:[1,0,1] neg_lo:[0,1,0] neg_hi:[0,0,0]
v_pk_mul_f32 v[78:79], v[62:63], v[172:173] op_sel:[0,0] op_sel_hi:[0,1] neg_lo:[0,0] neg_hi:[0,0]
v_pk_fma_f32 v[62:63], v[62:63], v[172:173], v[78:79] op_sel:[1,1,0] op_sel_hi:[1,0,1] neg_lo:[0,1,0] neg_hi:[0,0,0]
v_pk_mul_f32 v[78:79], v[66:67], v[174:175] op_sel:[0,0] op_sel_hi:[0,1] neg_lo:[0,0] neg_hi:[0,0]
v_pk_fma_f32 v[66:67], v[66:67], v[174:175], v[78:79] op_sel:[1,1,0] op_sel_hi:[1,0,1] neg_lo:[0,1,0] neg_hi:[0,0,0]
v_pk_mul_f32 v[78:79], v[74:75], v[176:177] op_sel:[0,0] op_sel_hi:[0,1] neg_lo:[0,0] neg_hi:[0,0]
v_pk_fma_f32 v[74:75], v[74:75], v[176:177], v[78:79] op_sel:[1,1,0] op_sel_hi:[1,0,1] neg_lo:[0,1,0] neg_hi:[0,0,0]
v_pk_mul_f32 v[78:79], v[76:77], v[178:179] op_sel:[0,0] op_sel_hi:[0,1] neg_lo:[0,0] neg_hi:[0,0]
v_pk_fma_f32 v[76:77], v[76:77], v[178:179], v[78:79] op_sel:[1,1,0] op_sel_hi:[1,0,1] neg_lo:[0,1,0] neg_hi:[0,0,0]
v_pk_mul_f32 v[78:79], v[72:73], v[180:181] op_sel:[0,0] op_sel_hi:[0,1] neg_lo:[0,0] neg_hi:[0,0]
v_pk_fma_f32 v[72:73], v[72:73], v[180:181], v[78:79] op_sel:[1,1,0] op_sel_hi:[1,0,1] neg_lo:[0,1,0] neg_hi:[0,0,0]
v_pk_mul_f32 v[78:79], v[20:21], v[182:183] op_sel:[0,0] op_sel_hi:[0,1] neg_lo:[0,0] neg_hi:[0,0]
v_pk_fma_f32 v[20:21], v[20:21], v[182:183], v[78:79] op_sel:[1,1,0] op_sel_hi:[1,0,1] neg_lo:[0,1,0] neg_hi:[0,0,0]
v_pk_mul_f32 v[78:79], v[64:65], v[184:185] op_sel:[0,0] op_sel_hi:[0,1] neg_lo:[0,0] neg_hi:[0,0]
v_pk_fma_f32 v[64:65], v[64:65], v[184:185], v[78:79] op_sel:[1,1,0] op_sel_hi:[1,0,1] neg_lo:[0,1,0] neg_hi:[0,0,0]
v_pk_mul_f32 v[78:79], v[24:25], v[186:187] op_sel:[0,0] op_sel_hi:[0,1] neg_lo:[0,0] neg_hi:[0,0]
v_pk_fma_f32 v[24:25], v[24:25], v[186:187], v[78:79] op_sel:[1,1,0] op_sel_hi:[1,0,1] neg_lo:[0,1,0] neg_hi:[0,0,0]
v_pk_mul_f32 v[78:79], v[30:31], v[188:189] op_sel:[0,0] op_sel_hi:[0,1] neg_lo:[0,0] neg_hi:[0,0]
v_pk_fma_f32 v[30:31], v[30:31], v[188:189], v[78:79] op_sel:[1,1,0] op_sel_hi:[1,0,1] neg_lo:[0,1,0] neg_hi:[0,0,0]
v_pk_mul_f32 v[78:79], v[34:35], v[190:191] op_sel:[0,0] op_sel_hi:[0,1] neg_lo:[0,0] neg_hi:[0,0]
v_pk_fma_f32 v[34:35], v[34:35], v[190:191], v[78:79] op_sel:[1,1,0] op_sel_hi:[1,0,1] neg_lo:[0,1,0] neg_hi:[0,0,0]
v_pk_mul_f32 v[78:79], v[14:15], v[192:193] op_sel:[0,0] op_sel_hi:[0,1] neg_lo:[0,0] neg_hi:[0,0]
v_pk_fma_f32 v[14:15], v[14:15], v[192:193], v[78:79] op_sel:[1,1,0] op_sel_hi:[1,0,1] neg_lo:[0,1,0] neg_hi:[0,0,0]
v_pk_mul_f32 v[78:79], v[32:33], v[194:195] op_sel:[0,0] op_sel_hi:[0,1] neg_lo:[0,0] neg_hi:[0,0]
v_pk_fma_f32 v[32:33], v[32:33], v[194:195], v[78:79] op_sel:[1,1,0] op_sel_hi:[1,0,1] neg_lo:[0,1,0] neg_hi:[0,0,0]
v_pk_mul_f32 v[78:79], v[46:47], v[196:197] op_sel:[0,0] op_sel_hi:[0,1] neg_lo:[0,0] neg_hi:[0,0]
v_pk_fma_f32 v[46:47], v[46:47], v[196:197], v[78:79] op_sel:[1,1,0] op_sel_hi:[1,0,1] neg_lo:[0,1,0] neg_hi:[0,0,0]
v_pk_mul_f32 v[78:79], v[50:51], v[198:199] op_sel:[0,0] op_sel_hi:[0,1] neg_lo:[0,0] neg_hi:[0,0]
v_pk_fma_f32 v[50:51], v[50:51], v[198:199], v[78:79] op_sel:[1,1,0] op_sel_hi:[1,0,1] neg_lo:[0,1,0] neg_hi:[0,0,0]
v_pk_mul_f32 v[78:79], v[44:45], v[200:201] op_sel:[0,0] op_sel_hi:[0,1] neg_lo:[0,0] neg_hi:[0,0]
v_pk_fma_f32 v[44:45], v[44:45], v[200:201], v[78:79] op_sel:[1,1,0] op_sel_hi:[1,0,1] neg_lo:[0,1,0] neg_hi:[0,0,0]
v_pk_mul_f32 v[78:79], v[52:53], v[202:203] op_sel:[0,0] op_sel_hi:[0,1] neg_lo:[0,0] neg_hi:[0,0]
v_pk_fma_f32 v[52:53], v[52:53], v[202:203], v[78:79] op_sel:[1,1,0] op_sel_hi:[1,0,1] neg_lo:[0,1,0] neg_hi:[0,0,0]
v_pk_mul_f32 v[78:79], v[54:55], v[204:205] op_sel:[0,0] op_sel_hi:[0,1] neg_lo:[0,0] neg_hi:[0,0]
v_pk_fma_f32 v[54:55], v[54:55], v[204:205], v[78:79] op_sel:[1,1,0] op_sel_hi:[1,0,1] neg_lo:[0,1,0] neg_hi:[0,0,0]
v_pk_mul_f32 v[78:79], v[58:59], v[206:207] op_sel:[0,0] op_sel_hi:[0,1] neg_lo:[0,0] neg_hi:[0,0]
v_pk_fma_f32 v[58:59], v[58:59], v[206:207], v[78:79] op_sel:[1,1,0] op_sel_hi:[1,0,1] neg_lo:[0,1,0] neg_hi:[0,0,0]
ds_write_b64 v4, v[16:17] offset:0
ds_write_b64 v4, v[48:49] offset:16
ds_write_b64 v4, v[18:19] offset:32
ds_write_b64 v4, v[22:23] offset:48
ds_write_b64 v4, v[26:27] offset:64
ds_write_b64 v4, v[38:39] offset:80
ds_write_b64 v4, v[28:29] offset:96
ds_write_b64 v4, v[36:37] offset:112
ds_write_b64 v4, v[42:43] offset:128
ds_write_b64 v4, v[70:71] offset:144
ds_write_b64 v4, v[60:61] offset:160
ds_write_b64 v4, v[68:69] offset:176
ds_write_b64 v4, v[40:41] offset:192
ds_write_b64 v4, v[56:57] offset:208
ds_write_b64 v4, v[62:63] offset:224
ds_write_b64 v4, v[66:67] offset:240
ds_write_b64 v4, v[74:75] offset:256
ds_write_b64 v4, v[76:77] offset:272
ds_write_b64 v4, v[72:73] offset:288
ds_write_b64 v4, v[20:21] offset:304
ds_write_b64 v4, v[64:65] offset:320
ds_write_b64 v4, v[24:25] offset:336
ds_write_b64 v4, v[30:31] offset:352
ds_write_b64 v4, v[34:35] offset:368
ds_write_b64 v4, v[14:15] offset:384
ds_write_b64 v4, v[32:33] offset:400
ds_write_b64 v4, v[46:47] offset:416
ds_write_b64 v4, v[50:51] offset:432
ds_write_b64 v4, v[44:45] offset:448
ds_write_b64 v4, v[52:53] offset:464
ds_write_b64 v4, v[54:55] offset:480
ds_write_b64 v4, v[58:59] offset:496
s_waitcnt lgkmcnt(0)
ds_read_b64 v[16:17], v3 offset:0
ds_read_b64 v[48:49], v3 offset:8448
ds_read_b64 v[18:19], v3 offset:528
ds_read_b64 v[50:51], v3 offset:8976
ds_read_b64 v[20:21], v3 offset:1056
ds_read_b64 v[52:53], v3 offset:9504
ds_read_b64 v[22:23], v3 offset:1584
ds_read_b64 v[54:55], v3 offset:10032
ds_read_b64 v[24:25], v3 offset:2112
ds_read_b64 v[56:57], v3 offset:10560
ds_read_b64 v[26:27], v3 offset:2640
ds_read_b64 v[58:59], v3 offset:11088
ds_read_b64 v[28:29], v3 offset:3168
ds_read_b64 v[60:61], v3 offset:11616
ds_read_b64 v[30:31], v3 offset:3696
ds_read_b64 v[62:63], v3 offset:12144
ds_read_b64 v[32:33], v3 offset:4224
ds_read_b64 v[64:65], v3 offset:12672
ds_read_b64 v[34:35], v3 offset:4752
ds_read_b64 v[66:67], v3 offset:13200
ds_read_b64 v[36:37], v3 offset:5280
ds_read_b64 v[68:69], v3 offset:13728
ds_read_b64 v[38:39], v3 offset:5808
ds_read_b64 v[70:71], v3 offset:14256
ds_read_b64 v[40:41], v3 offset:6336
ds_read_b64 v[72:73], v3 offset:14784
ds_read_b64 v[42:43], v3 offset:6864
ds_read_b64 v[74:75], v3 offset:15312
ds_read_b64 v[44:45], v3 offset:7392
ds_read_b64 v[76:77], v3 offset:15840
ds_read_b64 v[46:47], v3 offset:7920
ds_read_b64 v[78:79], v3 offset:16368
s_waitcnt lgkmcnt(0)
v_pk_add_f32 v[14:15], v[16:17], v[48:49] neg_lo:[0,1] neg_hi:[0,1]
v_pk_add_f32 v[16:17], v[16:17], v[48:49]
v_pk_add_f32 v[48:49], v[18:19], v[50:51] neg_lo:[0,1] neg_hi:[0,1]
v_pk_add_f32 v[18:19], v[18:19], v[50:51]
v_pk_mul_f32 v[50:51], v[48:49], s[50:51] op_sel:[0,0] op_sel_hi:[0,1] neg_lo:[0,0] neg_hi:[0,0]
v_pk_fma_f32 v[50:51], v[48:49], s[50:51], v[50:51] op_sel:[1,1,0] op_sel_hi:[1,0,1] neg_lo:[0,1,0] neg_hi:[0,0,0]
v_pk_add_f32 v[48:49], v[20:21], v[52:53] neg_lo:[0,1] neg_hi:[0,1]
v_pk_add_f32 v[20:21], v[20:21], v[52:53]
v_pk_mul_f32 v[52:53], v[48:49], s[54:55] op_sel:[0,0] op_sel_hi:[0,1] neg_lo:[0,0] neg_hi:[0,0]
v_pk_fma_f32 v[52:53], v[48:49], s[54:55], v[52:53] op_sel:[1,1,0] op_sel_hi:[1,0,1] neg_lo:[0,1,0] neg_hi:[0,0,0]
v_pk_add_f32 v[48:49], v[22:23], v[54:55] neg_lo:[0,1] neg_hi:[0,1]
v_pk_add_f32 v[22:23], v[22:23], v[54:55]
v_pk_mul_f32 v[54:55], v[48:49], s[58:59] op_sel:[0,0] op_sel_hi:[0,1] neg_lo:[0,0] neg_hi:[0,0]
v_pk_fma_f32 v[54:55], v[48:49], s[58:59], v[54:55] op_sel:[1,1,0] op_sel_hi:[1,0,1] neg_lo:[0,1,0] neg_hi:[0,0,0]
v_pk_add_f32 v[48:49], v[24:25], v[56:57] neg_lo:[0,1] neg_hi:[0,1]
v_pk_add_f32 v[24:25], v[24:25], v[56:57]
v_pk_mul_f32 v[56:57], v[48:49], s[62:63] op_sel:[0,0] op_sel_hi:[0,1] neg_lo:[0,0] neg_hi:[0,0]
v_pk_fma_f32 v[56:57], v[48:49], s[62:63], v[56:57] op_sel:[1,1,0] op_sel_hi:[1,0,1] neg_lo:[0,1,0] neg_hi:[0,0,0]
v_pk_add_f32 v[48:49], v[26:27], v[58:59] neg_lo:[0,1] neg_hi:[0,1]
v_pk_add_f32 v[26:27], v[26:27], v[58:59]
v_pk_mul_f32 v[58:59], v[48:49], s[58:59] op_sel:[0,1] op_sel_hi:[0,0] neg_lo:[0,0] neg_hi:[0,0]
v_pk_fma_f32 v[58:59], v[48:49], s[58:59], v[58:59] op_sel:[1,0,0] op_sel_hi:[1,1,1] neg_lo:[0,1,0] neg_hi:[0,0,0]
v_pk_add_f32 v[48:49], v[28:29], v[60:61] neg_lo:[0,1] neg_hi:[0,1]
v_pk_add_f32 v[28:29], v[28:29], v[60:61]
v_pk_mul_f32 v[60:61], v[48:49], s[54:55] op_sel:[0,1] op_sel_hi:[0,0] neg_lo:[0,0] neg_hi:[0,0]
v_pk_fma_f32 v[60:61], v[48:49], s[54:55], v[60:61] op_sel:[1,0,0] op_sel_hi:[1,1,1] neg_lo:[0,1,0] neg_hi:[0,0,0]
v_pk_add_f32 v[48:49], v[30:31], v[62:63] neg_lo:[0,1] neg_hi:[0,1]
v_pk_add_f32 v[30:31], v[30:31], v[62:63]
v_pk_mul_f32 v[62:63], v[48:49], s[50:51] op_sel:[0,1] op_sel_hi:[0,0] neg_lo:[0,0] neg_hi:[0,0]
v_pk_fma_f32 v[62:63], v[48:49], s[50:51], v[62:63] op_sel:[1,0,0] op_sel_hi:[1,1,1] neg_lo:[0,1,0] neg_hi:[0,0,0]
v_pk_add_f32 v[48:49], v[32:33], v[64:65] op_sel:[1,1] op_sel_hi:[0,0] neg_lo:[1,0] neg_hi:[0,1]
v_pk_add_f32 v[32:33], v[32:33], v[64:65]
v_pk_add_f32 v[64:65], v[34:35], v[66:67] neg_lo:[0,1] neg_hi:[0,1]
v_pk_add_f32 v[34:35], v[34:35], v[66:67]
v_pk_mul_f32 v[66:67], v[64:65], s[50:51] op_sel:[0,1] op_sel_hi:[0,0] neg_lo:[0,1] neg_hi:[0,0]
v_pk_fma_f32 v[66:67], v[64:65], s[50:51], v[66:67] op_sel:[1,0,0] op_sel_hi:[1,1,1] neg_lo:[0,1,0] neg_hi:[0,1,0]
v_pk_add_f32 v[64:65], v[36:37], v[68:69] neg_lo:[0,1] neg_hi:[0,1]
v_pk_add_f32 v[36:37], v[36:37], v[68:69]
v_pk_mul_f32 v[68:69], v[64:65], s[54:55] op_sel:[0,1] op_sel_hi:[0,0] neg_lo:[0,1] neg_hi:[0,0]
v_pk_fma_f32 v[68:69], v[64:65], s[54:55], v[68:69] op_sel:[1,0,0] op_sel_hi:[1,1,1] neg_lo:[0,1,0] neg_hi:[0,1,0]
v_pk_add_f32 v[64:65], v[38:39], v[70:71] neg_lo:[0,1] neg_hi:[0,1]
v_pk_add_f32 v[38:39], v[38:39], v[70:71]
v_pk_mul_f32 v[70:71], v[64:65], s[58:59] op_sel:[0,1] op_sel_hi:[0,0] neg_lo:[0,1] neg_hi:[0,0]
v_pk_fma_f32 v[70:71], v[64:65], s[58:59], v[70:71] op_sel:[1,0,0] op_sel_hi:[1,1,1] neg_lo:[0,1,0] neg_hi:[0,1,0]
v_pk_add_f32 v[64:65], v[40:41], v[72:73] neg_lo:[0,1] neg_hi:[0,1]
v_pk_add_f32 v[40:41], v[40:41], v[72:73]
v_pk_mul_f32 v[72:73], v[64:65], s[62:63] op_sel:[0,0] op_sel_hi:[0,1] neg_lo:[0,1] neg_hi:[0,0]
v_pk_fma_f32 v[72:73], v[64:65], s[62:63], v[72:73] op_sel:[1,1,0] op_sel_hi:[1,0,1] neg_lo:[0,1,0] neg_hi:[0,1,0]
v_pk_add_f32 v[64:65], v[42:43], v[74:75] neg_lo:[0,1] neg_hi:[0,1]
v_pk_add_f32 v[42:43], v[42:43], v[74:75]
v_pk_mul_f32 v[74:75], v[64:65], s[58:59] op_sel:[0,0] op_sel_hi:[0,1] neg_lo:[0,1] neg_hi:[0,0]
v_pk_fma_f32 v[74:75], v[64:65], s[58:59], v[74:75] op_sel:[1,1,0] op_sel_hi:[1,0,1] neg_lo:[0,1,0] neg_hi:[0,1,0]
v_pk_add_f32 v[64:65], v[44:45], v[76:77] neg_lo:[0,1] neg_hi:[0,1]
v_pk_add_f32 v[44:45], v[44:45], v[76:77]
v_pk_mul_f32 v[76:77], v[64:65], s[54:55] op_sel:[0,0] op_sel_hi:[0,1] neg_lo:[0,1] neg_hi:[0,0]
v_pk_fma_f32 v[76:77], v[64:65], s[54:55], v[76:77] op_sel:[1,1,0] op_sel_hi:[1,0,1] neg_lo:[0,1,0] neg_hi:[0,1,0]
v_pk_add_f32 v[64:65], v[46:47], v[78:79] neg_lo:[0,1] neg_hi:[0,1]
v_pk_add_f32 v[46:47], v[46:47], v[78:79]
v_pk_mul_f32 v[78:79], v[64:65], s[50:51] op_sel:[0,0] op_sel_hi:[0,1] neg_lo:[0,1] neg_hi:[0,0]
v_pk_fma_f32 v[78:79], v[64:65], s[50:51], v[78:79] op_sel:[1,1,0] op_sel_hi:[1,0,1] neg_lo:[0,1,0] neg_hi:[0,1,0]
v_pk_add_f32 v[64:65], v[16:17], v[32:33] neg_lo:[0,1] neg_hi:[0,1]
v_pk_add_f32 v[16:17], v[16:17], v[32:33]
v_pk_add_f32 v[32:33], v[18:19], v[34:35] neg_lo:[0,1] neg_hi:[0,1]
v_pk_add_f32 v[18:19], v[18:19], v[34:35]
v_pk_mul_f32 v[34:35], v[32:33], s[54:55] op_sel:[0,0] op_sel_hi:[0,1] neg_lo:[0,0] neg_hi:[0,0]
v_pk_fma_f32 v[34:35], v[32:33], s[54:55], v[34:35] op_sel:[1,1,0] op_sel_hi:[1,0,1] neg_lo:[0,1,0] neg_hi:[0,0,0]
v_pk_add_f32 v[32:33], v[20:21], v[36:37] neg_lo:[0,1] neg_hi:[0,1]
v_pk_add_f32 v[20:21], v[20:21], v[36:37]
v_pk_mul_f32 v[36:37], v[32:33], s[62:63] op_sel:[0,0] op_sel_hi:[0,1] neg_lo:[0,0] neg_hi:[0,0]
v_pk_fma_f32 v[36:37], v[32:33], s[62:63], v[36:37] op_sel:[1,1,0] op_sel_hi:[1,0,1] neg_lo:[0,1,0] neg_hi:[0,0,0]
v_pk_add_f32 v[32:33], v[22:23], v[38:39] neg_lo:[0,1] neg_hi:[0,1]
v_pk_add_f32 v[22:23], v[22:23], v[38:39]
v_pk_mul_f32 v[38:39], v[32:33], s[54:55] op_sel:[0,1] op_sel_hi:[0,0] neg_lo:[0,0] neg_hi:[0,0]
v_pk_fma_f32 v[38:39], v[32:33], s[54:55], v[38:39] op_sel:[1,0,0] op_sel_hi:[1,1,1] neg_lo:[0,1,0] neg_hi:[0,0,0]
v_pk_add_f32 v[32:33], v[24:25], v[40:41] op_sel:[1,1] op_sel_hi:[0,0] neg_lo:[1,0] neg_hi:[0,1]
v_pk_add_f32 v[24:25], v[24:25], v[40:41]
v_pk_add_f32 v[40:41], v[26:27], v[42:43] neg_lo:[0,1] neg_hi:[0,1]
v_pk_add_f32 v[26:27], v[26:27], v[42:43]
v_pk_mul_f32 v[42:43], v[40:41], s[54:55] op_sel:[0,1] op_sel_hi:[0,0] neg_lo:[0,1] neg_hi:[0,0]
v_pk_fma_f32 v[42:43], v[40:41], s[54:55], v[42:43] op_sel:[1,0,0] op_sel_hi:[1,1,1] neg_lo:[0,1,0] neg_hi:[0,1,0]
v_pk_add_f32 v[40:41], v[28:29], v[44:45] neg_lo:[0,1] neg_hi:[0,1]
v_pk_add_f32 v[28:29], v[28:29], v[44:45]
v_pk_mul_f32 v[44:45], v[40:41], s[62:63] op_sel:[0,0] op_sel_hi:[0,1] neg_lo:[0,1] neg_hi:[0,0]
v_pk_fma_f32 v[44:45], v[40:41], s[62:63], v[44:45] op_sel:[1,1,0] op_sel_hi:[1,0,1] neg_lo:[0,1,0] neg_hi:[0,1,0]
v_pk_add_f32 v[40:41], v[30:31], v[46:47] neg_lo:[0,1] neg_hi:[0,1]
v_pk_add_f32 v[30:31], v[30:31], v[46:47]
v_pk_mul_f32 v[46:47], v[40:41], s[54:55] op_sel:[0,0] op_sel_hi:[0,1] neg_lo:[0,1] neg_hi:[0,0]
v_pk_fma_f32 v[46:47], v[40:41], s[54:55], v[46:47] op_sel:[1,1,0] op_sel_hi:[1,0,1] neg_lo:[0,1,0] neg_hi:[0,1,0]
v_pk_add_f32 v[40:41], v[14:15], v[48:49] neg_lo:[0,1] neg_hi:[0,1]
v_pk_add_f32 v[14:15], v[14:15], v[48:49]
v_pk_add_f32 v[48:49], v[50:51], v[66:67] neg_lo:[0,1] neg_hi:[0,1]
v_pk_add_f32 v[50:51], v[50:51], v[66:67]
v_pk_mul_f32 v[66:67], v[48:49], s[54:55] op_sel:[0,0] op_sel_hi:[0,1] neg_lo:[0,0] neg_hi:[0,0]
v_pk_fma_f32 v[66:67], v[48:49], s[54:55], v[66:67] op_sel:[1,1,0] op_sel_hi:[1,0,1] neg_lo:[0,1,0] neg_hi:[0,0,0]
v_pk_add_f32 v[48:49], v[52:53], v[68:69] neg_lo:[0,1] neg_hi:[0,1]
v_pk_add_f32 v[52:53], v[52:53], v[68:69]
v_pk_mul_f32 v[68:69], v[48:49], s[62:63] op_sel:[0,0] op_sel_hi:[0,1] neg_lo:[0,0] neg_hi:[0,0]
v_pk_fma_f32 v[68:69], v[48:49], s[62:63], v[68:69] op_sel:[1,1,0] op_sel_hi:[1,0,1] neg_lo:[0,1,0] neg_hi:[0,0,0]
v_pk_add_f32 v[48:49], v[54:55], v[70:71] neg_lo:[0,1] neg_hi:[0,1]
v_pk_add_f32 v[54:55], v[54:55], v[70:71]
v_pk_mul_f32 v[70:71], v[48:49], s[54:55] op_sel:[0,1] op_sel_hi:[0,0] neg_lo:[0,0] neg_hi:[0,0]
v_pk_fma_f32 v[70:71], v[48:49], s[54:55], v[70:71] op_sel:[1,0,0] op_sel_hi:[1,1,1] neg_lo:[0,1,0] neg_hi:[0,0,0]
v_pk_add_f32 v[48:49], v[56:57], v[72:73] op_sel:[1,1] op_sel_hi:[0,0] neg_lo:[1,0] neg_hi:[0,1]
v_pk_add_f32 v[56:57], v[56:57], v[72:73]
v_pk_add_f32 v[72:73], v[58:59], v[74:75] neg_lo:[0,1] neg_hi:[0,1]
v_pk_add_f32 v[58:59], v[58:59], v[74:75]
v_pk_mul_f32 v[74:75], v[72:73], s[54:55] op_sel:[0,1] op_sel_hi:[0,0] neg_lo:[0,1] neg_hi:[0,0]
v_pk_fma_f32 v[74:75], v[72:73], s[54:55], v[74:75] op_sel:[1,0,0] op_sel_hi:[1,1,1] neg_lo:[0,1,0] neg_hi:[0,1,0]
v_pk_add_f32 v[72:73], v[60:61], v[76:77] neg_lo:[0,1] neg_hi:[0,1]
v_pk_add_f32 v[60:61], v[60:61], v[76:77]
v_pk_mul_f32 v[76:77], v[72:73], s[62:63] op_sel:[0,0] op_sel_hi:[0,1] neg_lo:[0,1] neg_hi:[0,0]
v_pk_fma_f32 v[76:77], v[72:73], s[62:63], v[76:77] op_sel:[1,1,0] op_sel_hi:[1,0,1] neg_lo:[0,1,0] neg_hi:[0,1,0]
v_pk_add_f32 v[72:73], v[62:63], v[78:79] neg_lo:[0,1] neg_hi:[0,1]
v_pk_add_f32 v[62:63], v[62:63], v[78:79]
v_pk_mul_f32 v[78:79], v[72:73], s[54:55] op_sel:[0,0] op_sel_hi:[0,1] neg_lo:[0,1] neg_hi:[0,0]
v_pk_fma_f32 v[78:79], v[72:73], s[54:55], v[78:79] op_sel:[1,1,0] op_sel_hi:[1,0,1] neg_lo:[0,1,0] neg_hi:[0,1,0]
v_pk_add_f32 v[72:73], v[16:17], v[24:25] neg_lo:[0,1] neg_hi:[0,1]
v_pk_add_f32 v[16:17], v[16:17], v[24:25]
v_pk_add_f32 v[24:25], v[18:19], v[26:27] neg_lo:[0,1] neg_hi:[0,1]
v_pk_add_f32 v[18:19], v[18:19], v[26:27]
v_pk_mul_f32 v[26:27], v[24:25], s[62:63] op_sel:[0,0] op_sel_hi:[0,1] neg_lo:[0,0] neg_hi:[0,0]
v_pk_fma_f32 v[26:27], v[24:25], s[62:63], v[26:27] op_sel:[1,1,0] op_sel_hi:[1,0,1] neg_lo:[0,1,0] neg_hi:[0,0,0]
v_pk_add_f32 v[24:25], v[20:21], v[28:29] op_sel:[1,1] op_sel_hi:[0,0] neg_lo:[1,0] neg_hi:[0,1]
v_pk_add_f32 v[20:21], v[20:21], v[28:29]
v_pk_add_f32 v[28:29], v[22:23], v[30:31] neg_lo:[0,1] neg_hi:[0,1]
v_pk_add_f32 v[22:23], v[22:23], v[30:31]
v_pk_mul_f32 v[30:31], v[28:29], s[62:63] op_sel:[0,0] op_sel_hi:[0,1] neg_lo:[0,1] neg_hi:[0,0]
v_pk_fma_f32 v[30:31], v[28:29], s[62:63], v[30:31] op_sel:[1,1,0] op_sel_hi:[1,0,1] neg_lo:[0,1,0] neg_hi:[0,1,0]
v_pk_add_f32 v[28:29], v[64:65], v[32:33] neg_lo:[0,1] neg_hi:[0,1]
v_pk_add_f32 v[64:65], v[64:65], v[32:33]
v_pk_add_f32 v[32:33], v[34:35], v[42:43] neg_lo:[0,1] neg_hi:[0,1]
v_pk_add_f32 v[34:35], v[34:35], v[42:43]
v_pk_mul_f32 v[42:43], v[32:33], s[62:63] op_sel:[0,0] op_sel_hi:[0,1] neg_lo:[0,0] neg_hi:[0,0]
v_pk_fma_f32 v[42:43], v[32:33], s[62:63], v[42:43] op_sel:[1,1,0] op_sel_hi:[1,0,1] neg_lo:[0,1,0] neg_hi:[0,0,0]
v_pk_add_f32 v[32:33], v[36:37], v[44:45] op_sel:[1,1] op_sel_hi:[0,0] neg_lo:[1,0] neg_hi:[0,1]
v_pk_add_f32 v[36:37], v[36:37], v[44:45]
v_pk_add_f32 v[44:45], v[38:39], v[46:47] neg_lo:[0,1] neg_hi:[0,1]
v_pk_add_f32 v[38:39], v[38:39], v[46:47]
v_pk_mul_f32 v[46:47], v[44:45], s[62:63] op_sel:[0,0] op_sel_hi:[0,1] neg_lo:[0,1] neg_hi:[0,0]
v_pk_fma_f32 v[46:47], v[44:45], s[62:63], v[46:47] op_sel:[1,1,0] op_sel_hi:[1,0,1] neg_lo:[0,1,0] neg_hi:[0,1,0]
v_pk_add_f32 v[44:45], v[14:15], v[56:57] neg_lo:[0,1] neg_hi:[0,1]
v_pk_add_f32 v[14:15], v[14:15], v[56:57]
v_pk_add_f32 v[56:57], v[50:51], v[58:59] neg_lo:[0,1] neg_hi:[0,1]
v_pk_add_f32 v[50:51], v[50:51], v[58:59]
v_pk_mul_f32 v[58:59], v[56:57], s[62:63] op_sel:[0,0] op_sel_hi:[0,1] neg_lo:[0,0] neg_hi:[0,0]
v_pk_fma_f32 v[58:59], v[56:57], s[62:63], v[58:59] op_sel:[1,1,0] op_sel_hi:[1,0,1] neg_lo:[0,1,0] neg_hi:[0,0,0]
v_pk_add_f32 v[56:57], v[52:53], v[60:61] op_sel:[1,1] op_sel_hi:[0,0] neg_lo:[1,0] neg_hi:[0,1]
v_pk_add_f32 v[52:53], v[52:53], v[60:61]
v_pk_add_f32 v[60:61], v[54:55], v[62:63] neg_lo:[0,1] neg_hi:[0,1]
v_pk_add_f32 v[54:55], v[54:55], v[62:63]
v_pk_mul_f32 v[62:63], v[60:61], s[62:63] op_sel:[0,0] op_sel_hi:[0,1] neg_lo:[0,1] neg_hi:[0,0]
v_pk_fma_f32 v[62:63], v[60:61], s[62:63], v[62:63] op_sel:[1,1,0] op_sel_hi:[1,0,1] neg_lo:[0,1,0] neg_hi:[0,1,0]
v_pk_add_f32 v[60:61], v[40:41], v[48:49] neg_lo:[0,1] neg_hi:[0,1]
v_pk_add_f32 v[40:41], v[40:41], v[48:49]
v_pk_add_f32 v[48:49], v[66:67], v[74:75] neg_lo:[0,1] neg_hi:[0,1]
v_pk_add_f32 v[66:67], v[66:67], v[74:75]
v_pk_mul_f32 v[74:75], v[48:49], s[62:63] op_sel:[0,0] op_sel_hi:[0,1] neg_lo:[0,0] neg_hi:[0,0]
v_pk_fma_f32 v[74:75], v[48:49], s[62:63], v[74:75] op_sel:[1,1,0] op_sel_hi:[1,0,1] neg_lo:[0,1,0] neg_hi:[0,0,0]
v_pk_add_f32 v[48:49], v[68:69], v[76:77] op_sel:[1,1] op_sel_hi:[0,0] neg_lo:[1,0] neg_hi:[0,1]
v_pk_add_f32 v[68:69], v[68:69], v[76:77]
v_pk_add_f32 v[76:77], v[70:71], v[78:79] neg_lo:[0,1] neg_hi:[0,1]
v_pk_add_f32 v[70:71], v[70:71], v[78:79]
v_pk_mul_f32 v[78:79], v[76:77], s[62:63] op_sel:[0,0] op_sel_hi:[0,1] neg_lo:[0,1] neg_hi:[0,0]
v_pk_fma_f32 v[78:79], v[76:77], s[62:63], v[78:79] op_sel:[1,1,0] op_sel_hi:[1,0,1] neg_lo:[0,1,0] neg_hi:[0,1,0]
v_pk_add_f32 v[76:77], v[16:17], v[20:21] neg_lo:[0,1] neg_hi:[0,1]
v_pk_add_f32 v[16:17], v[16:17], v[20:21]
v_pk_add_f32 v[20:21], v[18:19], v[22:23] op_sel:[1,1] op_sel_hi:[0,0] neg_lo:[1,0] neg_hi:[0,1]
v_pk_add_f32 v[18:19], v[18:19], v[22:23]
v_pk_add_f32 v[22:23], v[72:73], v[24:25] neg_lo:[0,1] neg_hi:[0,1]
v_pk_add_f32 v[72:73], v[72:73], v[24:25]
v_pk_add_f32 v[24:25], v[26:27], v[30:31] op_sel:[1,1] op_sel_hi:[0,0] neg_lo:[1,0] neg_hi:[0,1]
v_pk_add_f32 v[26:27], v[26:27], v[30:31]
v_pk_add_f32 v[30:31], v[64:65], v[36:37] neg_lo:[0,1] neg_hi:[0,1]
v_pk_add_f32 v[64:65], v[64:65], v[36:37]
v_pk_add_f32 v[36:37], v[34:35], v[38:39] op_sel:[1,1] op_sel_hi:[0,0] neg_lo:[1,0] neg_hi:[0,1]
v_pk_add_f32 v[34:35], v[34:35], v[38:39]
v_pk_add_f32 v[38:39], v[28:29], v[32:33] neg_lo:[0,1] neg_hi:[0,1]
v_pk_add_f32 v[28:29], v[28:29], v[32:33]
v_pk_add_f32 v[32:33], v[42:43], v[46:47] op_sel:[1,1] op_sel_hi:[0,0] neg_lo:[1,0] neg_hi:[0,1]
v_pk_add_f32 v[42:43], v[42:43], v[46:47]
v_pk_add_f32 v[46:47], v[14:15], v[52:53] neg_lo:[0,1] neg_hi:[0,1]
v_pk_add_f32 v[14:15], v[14:15], v[52:53]
v_pk_add_f32 v[52:53], v[50:51], v[54:55] op_sel:[1,1] op_sel_hi:[0,0] neg_lo:[1,0] neg_hi:[0,1]
v_pk_add_f32 v[50:51], v[50:51], v[54:55]
v_pk_add_f32 v[54:55], v[44:45], v[56:57] neg_lo:[0,1] neg_hi:[0,1]
v_pk_add_f32 v[44:45], v[44:45], v[56:57]
v_pk_add_f32 v[56:57], v[58:59], v[62:63] op_sel:[1,1] op_sel_hi:[0,0] neg_lo:[1,0] neg_hi:[0,1]
v_pk_add_f32 v[58:59], v[58:59], v[62:63]
v_pk_add_f32 v[62:63], v[40:41], v[68:69] neg_lo:[0,1] neg_hi:[0,1]
v_pk_add_f32 v[40:41], v[40:41], v[68:69]
v_pk_add_f32 v[68:69], v[66:67], v[70:71] op_sel:[1,1] op_sel_hi:[0,0] neg_lo:[1,0] neg_hi:[0,1]
v_pk_add_f32 v[66:67], v[66:67], v[70:71]
v_pk_add_f32 v[70:71], v[60:61], v[48:49] neg_lo:[0,1] neg_hi:[0,1]
v_pk_add_f32 v[60:61], v[60:61], v[48:49]
v_pk_add_f32 v[48:49], v[74:75], v[78:79] op_sel:[1,1] op_sel_hi:[0,0] neg_lo:[1,0] neg_hi:[0,1]
v_pk_add_f32 v[74:75], v[74:75], v[78:79]
v_pk_add_f32 v[78:79], v[16:17], v[18:19] neg_lo:[0,1] neg_hi:[0,1]
v_pk_add_f32 v[16:17], v[16:17], v[18:19]
v_pk_add_f32 v[18:19], v[76:77], v[20:21] neg_lo:[0,1] neg_hi:[0,1]
v_pk_add_f32 v[76:77], v[76:77], v[20:21]
v_pk_add_f32 v[20:21], v[72:73], v[26:27] neg_lo:[0,1] neg_hi:[0,1]
v_pk_add_f32 v[72:73], v[72:73], v[26:27]
v_pk_add_f32 v[26:27], v[22:23], v[24:25] neg_lo:[0,1] neg_hi:[0,1]
v_pk_add_f32 v[22:23], v[22:23], v[24:25]
v_pk_add_f32 v[24:25], v[64:65], v[34:35] neg_lo:[0,1] neg_hi:[0,1]
v_pk_add_f32 v[64:65], v[64:65], v[34:35]
v_pk_add_f32 v[34:35], v[30:31], v[36:37] neg_lo:[0,1] neg_hi:[0,1]
v_pk_add_f32 v[30:31], v[30:31], v[36:37]
v_pk_add_f32 v[36:37], v[28:29], v[42:43] neg_lo:[0,1] neg_hi:[0,1]
v_pk_add_f32 v[28:29], v[28:29], v[42:43]
v_pk_add_f32 v[42:43], v[38:39], v[32:33] neg_lo:[0,1] neg_hi:[0,1]
v_pk_add_f32 v[38:39], v[38:39], v[32:33]
v_pk_add_f32 v[32:33], v[14:15], v[50:51] neg_lo:[0,1] neg_hi:[0,1]
v_pk_add_f32 v[14:15], v[14:15], v[50:51]
v_pk_add_f32 v[50:51], v[46:47], v[52:53] neg_lo:[0,1] neg_hi:[0,1]
v_pk_add_f32 v[46:47], v[46:47], v[52:53]
v_pk_add_f32 v[52:53], v[44:45], v[58:59] neg_lo:[0,1] neg_hi:[0,1]
v_pk_add_f32 v[44:45], v[44:45], v[58:59]
v_pk_add_f32 v[58:59], v[54:55], v[56:57] neg_lo:[0,1] neg_hi:[0,1]
v_pk_add_f32 v[54:55], v[54:55], v[56:57]
v_pk_add_f32 v[56:57], v[40:41], v[66:67] neg_lo:[0,1] neg_hi:[0,1]
v_pk_add_f32 v[40:41], v[40:41], v[66:67]
v_pk_add_f32 v[66:67], v[62:63], v[68:69] neg_lo:[0,1] neg_hi:[0,1]
v_pk_add_f32 v[62:63], v[62:63], v[68:69]
v_pk_add_f32 v[68:69], v[60:61], v[74:75] neg_lo:[0,1] neg_hi:[0,1]
v_pk_add_f32 v[60:61], v[60:61], v[74:75]
v_pk_add_f32 v[74:75], v[70:71], v[48:49] neg_lo:[0,1] neg_hi:[0,1]
v_pk_add_f32 v[70:71], v[70:71], v[48:49]
s_lshl_b32 s12, s38, 2
s_add_u32 s12, s12, s16
s_min_u32 s12, s12, 512
s_lshl_b32 s12, s12, 14
s_add_u32 s12, s12, 109051904
buffer_store_dwordx2 v[16:17], v5, s[84:87], s12 offen offset:0 sc1
buffer_store_dwordx2 v[14:15], v5, s[84:87], s12 offen offset:512 sc1
buffer_store_dwordx2 v[64:65], v5, s[84:87], s12 offen offset:1024 sc1
buffer_store_dwordx2 v[40:41], v5, s[84:87], s12 offen offset:1536 sc1
buffer_store_dwordx2 v[72:73], v5, s[84:87], s12 offen offset:2048 sc1
buffer_store_dwordx2 v[44:45], v5, s[84:87], s12 offen offset:2560 sc1
buffer_store_dwordx2 v[28:29], v5, s[84:87], s12 offen offset:3072 sc1
buffer_store_dwordx2 v[60:61], v5, s[84:87], s12 offen offset:3584 sc1
s_add_u32 s12, s12, 4096
buffer_store_dwordx2 v[76:77], v5, s[84:87], s12 offen offset:0 sc1
buffer_store_dwordx2 v[46:47], v5, s[84:87], s12 offen offset:512 sc1
buffer_store_dwordx2 v[30:31], v5, s[84:87], s12 offen offset:1024 sc1
buffer_store_dwordx2 v[62:63], v5, s[84:87], s12 offen offset:1536 sc1
buffer_store_dwordx2 v[22:23], v5, s[84:87], s12 offen offset:2048 sc1
buffer_store_dwordx2 v[54:55], v5, s[84:87], s12 offen offset:2560 sc1
buffer_store_dwordx2 v[38:39], v5, s[84:87], s12 offen offset:3072 sc1
buffer_store_dwordx2 v[70:71], v5, s[84:87], s12 offen offset:3584 sc1
s_add_u32 s12, s12, 4096
buffer_store_dwordx2 v[78:79], v5, s[84:87], s12 offen offset:0 sc1
buffer_store_dwordx2 v[32:33], v5, s[84:87], s12 offen offset:512 sc1
buffer_store_dwordx2 v[24:25], v5, s[84:87], s12 offen offset:1024 sc1
buffer_store_dwordx2 v[56:57], v5, s[84:87], s12 offen offset:1536 sc1
buffer_store_dwordx2 v[20:21], v5, s[84:87], s12 offen offset:2048 sc1
buffer_store_dwordx2 v[52:53], v5, s[84:87], s12 offen offset:2560 sc1
buffer_store_dwordx2 v[36:37], v5, s[84:87], s12 offen offset:3072 sc1
buffer_store_dwordx2 v[68:69], v5, s[84:87], s12 offen offset:3584 sc1
s_add_u32 s12, s12, 4096
buffer_store_dwordx2 v[18:19], v5, s[84:87], s12 offen offset:0 sc1
buffer_store_dwordx2 v[50:51], v5, s[84:87], s12 offen offset:512 sc1
buffer_store_dwordx2 v[34:35], v5, s[84:87], s12 offen offset:1024 sc1
buffer_store_dwordx2 v[66:67], v5, s[84:87], s12 offen offset:1536 sc1
buffer_store_dwordx2 v[26:27], v5, s[84:87], s12 offen offset:2048 sc1
buffer_store_dwordx2 v[58:59], v5, s[84:87], s12 offen offset:2560 sc1
buffer_store_dwordx2 v[42:43], v5, s[84:87], s12 offen offset:3072 sc1
buffer_store_dwordx2 v[74:75], v5, s[84:87], s12 offen offset:3584 sc1
s_add_u32 s12, s12, 4096
s_mov_b32 s38, s21
s_cmp_lt_u32 s38, s37
s_cbranch_scc1 mega_kernel_f2_l
mega_kernel_f2_e:
mega_kernel_f2e:
s_waitcnt vmcnt(0)
s_barrier
v_mov_b32 v1, 0
v_mov_b32 v2, 1
s_mov_b32 s82, 69259392
v_cmp_eq_u32 vcc, 0, v0
s_and_saveexec_b64 s[80:81], vcc
s_cbranch_execz mega_kernel_sg1
buffer_atomic_add v2, v1, s[84:87], s82 offen sc1
mega_kernel_sg1:
s_mov_b64 exec, s[80:81]
s_mov_b32 s64, 0
s_mov_b32 s65, 62
s_lshl_b32 s66, s40, 13
s_add_u32 s66, s66, 67633152
s_mov_b32 s67, 0
s_mov_b32 s68, 8192
s_mov_b32 s69, 1
s_cmp_eq_u32 s91, 3
s_cbranch_scc1 mega_kernel_out
v_mov_b32 v1, 0
s_mov_b32 s82, 69259392
mega_kernel_w1:
s_sleep 8
buffer_load_dword v2, v1, s[84:87], s82 offen sc1
s_waitcnt vmcnt(0)
v_cmp_ne_u32 vcc, 95, v2
s_cbranch_vccnz mega_kernel_w1
s_mov_b32 s93, s92
s_load_dwordx2 s[4:5], s[0:1], 80
s_mov_b32 s48, 0x3f7ec46d
s_mov_b32 s49, 0x3dc8bd36
s_mov_b32 s50, 0x3f7b14be
s_mov_b32 s51, 0x3e47c5c2
s_mov_b32 s52, 0x3f74fa0b
s_mov_b32 s53, 0x3e94a031
s_mov_b32 s54, 0x3f6c835e
s_mov_b32 s55, 0x3ec3ef15
s_mov_b32 s56, 0x3f61c598
s_mov_b32 s57, 0x3ef15aea
s_mov_b32 s58, 0x3f54db31
s_mov_b32 s59, 0x3f0e39da
s_mov_b32 s60, 0x3f45e403
s_mov_b32 s61, 0x3f226799
s_mov_b32 s62, 0x3f3504f3
s_mov_b32 s63, 0x3f3504f3
v_and_b32 v1, 31, v0
v_lshrrev_b32 v2, 5, v0
v_cvt_f32_u32 v3, v1
v_mul_u32_u24 v10, 8448, v2
v_lshl_add_u32 v4, v1, 3, v10
v_mul_u32_u24 v5, 264, v1
v_add_u32 v5, v5, v10
v_and_b32 v11, 7, v0
v_lshrrev_b32 v9, 3, v0
v_mul_u32_u24 v10, 8448, v11
v_lshl_add_u32 v6, v9, 3, v10
v_lshlrev_b32 v7, 3, v9
v_sub_u32 v7, v10, v7
v_add_u32 v7, 4096, v7
v_lshlrev_b32 v8, 14, v9
v_lshl_add_u32 v8, v11, 4, v8
v_mul_f32 v12, 0x3a800000, v3
v_cos_f32 v82, v12
v_sin_f32 v83, v12
v_mul_f32 v12, 0x3b000000, v3
v_cos_f32 v84, v12
v_sin_f32 v85, v12
v_mul_f32 v12, 0x3b400000, v3
v_cos_f32 v86, v12
v_sin_f32 v87, v12
v_mul_f32 v12, 0x3b800000, v3
v_cos_f32 v88, v12
v_sin_f32 v89, v12
v_mul_f32 v12, 0x3ba00000, v3
v_cos_f32 v90, v12
v_sin_f32 v91, v12
v_mul_f32 v12, 0x3bc00000, v3
v_cos_f32 v92, v12
v_sin_f32 v93, v12
v_mul_f32 v12, 0x3be00000, v3
v_cos_f32 v94, v12
v_sin_f32 v95, v12
v_mul_f32 v12, 0x3c000000, v3
v_cos_f32 v96, v12
v_sin_f32 v97, v12
v_mul_f32 v12, 0x3c100000, v3
v_cos_f32 v98, v12
v_sin_f32 v99, v12
v_mul_f32 v12, 0x3c200000, v3
v_cos_f32 v100, v12
v_sin_f32 v101, v12
v_mul_f32 v12, 0x3c300000, v3
v_cos_f32 v102, v12
v_sin_f32 v103, v12
v_mul_f32 v12, 0x3c400000, v3
v_cos_f32 v104, v12
v_sin_f32 v105, v12
v_mul_f32 v12, 0x3c500000, v3
v_cos_f32 v106, v12
v_sin_f32 v107, v12
v_mul_f32 v12, 0x3c600000, v3
v_cos_f32 v108, v12
v_sin_f32 v109, v12
v_mul_f32 v12, 0x3c700000, v3
v_cos_f32 v110, v12
v_sin_f32 v111, v12
v_mul_f32 v12, 0x3c800000, v3
v_cos_f32 v112, v12
v_sin_f32 v113, v12
v_mul_f32 v12, 0x3c880000, v3
v_cos_f32 v114, v12
v_sin_f32 v115, v12
v_mul_f32 v12, 0x3c900000, v3
v_cos_f32 v116, v12
v_sin_f32 v117, v12
v_mul_f32 v12, 0x3c980000, v3
v_cos_f32 v118, v12
v_sin_f32 v119, v12
v_mul_f32 v12, 0x3ca00000, v3
v_cos_f32 v120, v12
v_sin_f32 v121, v12
v_mul_f32 v12, 0x3ca80000, v3
v_cos_f32 v122, v12
v_sin_f32 v123, v12
v_mul_f32 v12, 0x3cb00000, v3
v_cos_f32 v124, v12
v_sin_f32 v125, v12
v_mul_f32 v12, 0x3cb80000, v3
v_cos_f32 v126, v12
v_sin_f32 v127, v12
v_mul_f32 v12, 0x3cc00000, v3
v_cos_f32 v128, v12
v_sin_f32 v129, v12
v_mul_f32 v12, 0x3cc80000, v3
v_cos_f32 v130, v12
v_sin_f32 v131, v12
v_mul_f32 v12, 0x3cd00000, v3
v_cos_f32 v132, v12
v_sin_f32 v133, v12
v_mul_f32 v12, 0x3cd80000, v3
v_cos_f32 v134, v12
v_sin_f32 v135, v12
v_mul_f32 v12, 0x3ce00000, v3
v_cos_f32 v136, v12
v_sin_f32 v137, v12
v_mul_f32 v12, 0x3ce80000, v3
v_cos_f32 v138, v12
v_sin_f32 v139, v12
v_mul_f32 v12, 0x3cf00000, v3
v_cos_f32 v140, v12
v_sin_f32 v141, v12
v_mul_f32 v12, 0x3cf80000, v3
v_cos_f32 v142, v12
v_sin_f32 v143, v12
v_lshlrev_b32 v12, 2, v1
v_sub_u32 v12, v4, v12
v_and_b32 v10, 127, v0
v_lshrrev_b32 v11, 7, v0
v_lshlrev_b32 v2, 5, v10
v_lshl_add_u32 v2, v11, 12, v2
v_lshlrev_b32 v3, 4, v10
v_lshl_add_u32 v3, v11, 12, v3
v_add_u32 v3, 2048, v3
v_cmp_eq_u32 s[14:15], 0, v9
s_waitcnt lgkmcnt(0)
s_mov_b32 s6, 8388608
s_mov_b32 s7, 0x00020000
s_cmp_lt_u32 s93, 128
s_cbranch_scc0 mega_kernel_f3_e
s_lshl_b32 s12, s93, 7
s_add_u32 s12, s12, 109051904
buffer_load_dwordx4 v[144:147], v8, s[84:87], s12 offen sc1
s_add_u32 s12, s12, 524288
buffer_load_dwordx4 v[148:151], v8, s[84:87], s12 offen sc1
s_add_u32 s12, s12, 524288
buffer_load_dwordx4 v[152:155], v8, s[84:87], s12 offen sc1
s_add_u32 s12, s12, 524288
buffer_load_dwordx4 v[156:159], v8, s[84:87], s12 offen sc1
s_add_u32 s12, s12, 524288
buffer_load_dwordx4 v[160:163], v8, s[84:87], s12 offen sc1
s_add_u32 s12, s12, 524288
buffer_load_dwordx4 v[164:167], v8, s[84:87], s12 offen sc1
s_add_u32 s12, s12, 524288
buffer_load_dwordx4 v[168:171], v8, s[84:87], s12 offen sc1
s_add_u32 s12, s12, 524288
buffer_load_dwordx4 v[172:175], v8, s[84:87], s12 offen sc1
s_add_u32 s12, s12, 524288
buffer_load_dwordx4 v[176:179], v8, s[84:87], s12 offen sc1
s_add_u32 s12, s12, 524288
buffer_load_dwordx4 v[180:183], v8, s[84:87], s12 offen sc1
s_add_u32 s12, s12, 524288
buffer_load_dwordx4 v[184:187], v8, s[84:87], s12 offen sc1
s_add_u32 s12, s12, 524288
buffer_load_dwordx4 v[188:191], v8, s[84:87], s12 offen sc1
s_add_u32 s12, s12, 524288
buffer_load_dwordx4 v[192:195], v8, s[84:87], s12 offen sc1
s_add_u32 s12, s12, 524288
buffer_load_dwordx4 v[196:199], v8, s[84:87], s12 offen sc1
s_add_u32 s12, s12, 524288
buffer_load_dwordx4 v[200:203], v8, s[84:87], s12 offen sc1
s_add_u32 s12, s12, 524288
buffer_load_dwordx4 v[204:207], v8, s[84:87], s12 offen sc1
s_add_u32 s12, s12, 524288
buffer_load_dwordx4 v[208:211], v8, s[84:87], s12 offen sc1
s_add_u32 s12, s12, 524288
s_waitcnt vmcnt(0)
mega_kernel_f3_l:
s_add_u32 s21, s93, 64
s_cmp_lt_u32 s21, 128
s_cselect_b32 s22, s21, s93
s_waitcnt vmcnt(8)
s_barrier
v_cndmask_b32 v145, v145, 0, s[14:15]
v_cndmask_b32 v147, v147, 0, s[14:15]
v_cndmask_b32 v209, v209, 0, s[14:15]
v_cndmask_b32 v211, v211, 0, s[14:15]
v_pk_add_f32 v[16:17], v[144:145], v[146:147] op_sel:[0,1] op_sel_hi:[1,0] neg_lo:[0,1]
v_pk_add_f32 v[18:19], v[144:145], v[146:147] op_sel:[0,1] op_sel_hi:[1,0] neg_hi:[1,0]
ds_write_b64 v6, v[16:17] offset:0
ds_write_b64 v7, v[18:19] offset:4096
v_pk_add_f32 v[20:21], v[148:149], v[150:151] op_sel:[0,1] op_sel_hi:[1,0] neg_lo:[0,1]
v_pk_add_f32 v[22:23], v[148:149], v[150:151] op_sel:[0,1] op_sel_hi:[1,0] neg_hi:[1,0]
ds_write_b64 v6, v[20:21] offset:256
ds_write_b64 v7, v[22:23] offset:3840
v_pk_add_f32 v[24:25], v[152:153], v[154:155] op_sel:[0,1] op_sel_hi:[1,0] neg_lo:[0,1]
v_pk_add_f32 v[26:27], v[152:153], v[154:155] op_sel:[0,1] op_sel_hi:[1,0] neg_hi:[1,0]
ds_write_b64 v6, v[24:25] offset:512
ds_write_b64 v7, v[26:27] offset:3584
v_pk_add_f32 v[28:29], v[156:157], v[158:159] op_sel:[0,1] op_sel_hi:[1,0] neg_lo:[0,1]
v_pk_add_f32 v[30:31], v[156:157], v[158:159] op_sel:[0,1] op_sel_hi:[1,0] neg_hi:[1,0]
ds_write_b64 v6, v[28:29] offset:768
ds_write_b64 v7, v[30:31] offset:3328
v_pk_add_f32 v[32:33], v[160:161], v[162:163] op_sel:[0,1] op_sel_hi:[1,0] neg_lo:[0,1]
v_pk_add_f32 v[34:35], v[160:161], v[162:163] op_sel:[0,1] op_sel_hi:[1,0] neg_hi:[1,0]
ds_write_b64 v6, v[32:33] offset:1024
ds_write_b64 v7, v[34:35] offset:3072
v_pk_add_f32 v[36:37], v[164:165], v[166:167] op_sel:[0,1] op_sel_hi:[1,0] neg_lo:[0,1]
v_pk_add_f32 v[38:39], v[164:165], v[166:167] op_sel:[0,1] op_sel_hi:[1,0] neg_hi:[1,0]
ds_write_b64 v6, v[36:37] offset:1280
ds_write_b64 v7, v[38:39] offset:2816
v_pk_add_f32 v[40:41], v[168:169], v[170:171] op_sel:[0,1] op_sel_hi:[1,0] neg_lo:[0,1]
v_pk_add_f32 v[42:43], v[168:169], v[170:171] op_sel:[0,1] op_sel_hi:[1,0] neg_hi:[1,0]
ds_write_b64 v6, v[40:41] offset:1536
ds_write_b64 v7, v[42:43] offset:2560
v_pk_add_f32 v[44:45], v[172:173], v[174:175] op_sel:[0,1] op_sel_hi:[1,0] neg_lo:[0,1]
v_pk_add_f32 v[46:47], v[172:173], v[174:175] op_sel:[0,1] op_sel_hi:[1,0] neg_hi:[1,0]
ds_write_b64 v6, v[44:45] offset:1792
ds_write_b64 v7, v[46:47] offset:2304
v_pk_add_f32 v[48:49], v[176:177], v[178:179] op_sel:[0,1] op_sel_hi:[1,0] neg_lo:[0,1]
v_pk_add_f32 v[50:51], v[176:177], v[178:179] op_sel:[0,1] op_sel_hi:[1,0] neg_hi:[1,0]
ds_write_b64 v6, v[48:49] offset:2048
ds_write_b64 v7, v[50:51] offset:2048
v_pk_add_f32 v[52:53], v[180:181], v[182:183] op_sel:[0,1] op_sel_hi:[1,0] neg_lo:[0,1]
v_pk_add_f32 v[54:55], v[180:181], v[182:183] op_sel:[0,1] op_sel_hi:[1,0] neg_hi:[1,0]
ds_write_b64 v6, v[52:53] offset:2304
ds_write_b64 v7, v[54:55] offset:1792
v_pk_add_f32 v[56:57], v[184:185], v[186:187] op_sel:[0,1] op_sel_hi:[1,0] neg_lo:[0,1]
v_pk_add_f32 v[58:59], v[184:185], v[186:187] op_sel:[0,1] op_sel_hi:[1,0] neg_hi:[1,0]
ds_write_b64 v6, v[56:57] offset:2560
ds_write_b64 v7, v[58:59] offset:1536
v_pk_add_f32 v[60:61], v[188:189], v[190:191] op_sel:[0,1] op_sel_hi:[1,0] neg_lo:[0,1]
v_pk_add_f32 v[62:63], v[188:189], v[190:191] op_sel:[0,1] op_sel_hi:[1,0] neg_hi:[1,0]
ds_write_b64 v6, v[60:61] offset:2816
ds_write_b64 v7, v[62:63] offset:1280
v_pk_add_f32 v[64:65], v[192:193], v[194:195] op_sel:[0,1] op_sel_hi:[1,0] neg_lo:[0,1]
v_pk_add_f32 v[66:67], v[192:193], v[194:195] op_sel:[0,1] op_sel_hi:[1,0] neg_hi:[1,0]
ds_write_b64 v6, v[64:65] offset:3072
ds_write_b64 v7, v[66:67] offset:1024
v_pk_add_f32 v[68:69], v[196:197], v[198:199] op_sel:[0,1] op_sel_hi:[1,0] neg_lo:[0,1]
v_pk_add_f32 v[70:71], v[196:197], v[198:199] op_sel:[0,1] op_sel_hi:[1,0] neg_hi:[1,0]
ds_write_b64 v6, v[68:69] offset:3328
ds_write_b64 v7, v[70:71] offset:768
v_pk_add_f32 v[72:73], v[200:201], v[202:203] op_sel:[0,1] op_sel_hi:[1,0] neg_lo:[0,1]
v_pk_add_f32 v[74:75], v[200:201], v[202:203] op_sel:[0,1] op_sel_hi:[1,0] neg_hi:[1,0]
ds_write_b64 v6, v[72:73] offset:3584
ds_write_b64 v7, v[74:75] offset:512
s_waitcnt lgkmcnt(8)
v_pk_add_f32 v[76:77], v[204:205], v[206:207] op_sel:[0,1] op_sel_hi:[1,0] neg_lo:[0,1]
v_pk_add_f32 v[78:79], v[204:205], v[206:207] op_sel:[0,1] op_sel_hi:[1,0] neg_hi:[1,0]
ds_write_b64 v6, v[76:77] offset:3840
ds_write_b64 v7, v[78:79] offset:256
v_pk_add_f32 v[16:17], v[208:209], v[210:211] op_sel:[0,1] op_sel_hi:[1,0] neg_lo:[0,1]
v_pk_add_f32 v[18:19], v[208:209], v[210:211] op_sel:[0,1] op_sel_hi:[1,0] neg_hi:[1,0]
s_mov_b64 exec, s[14:15]
ds_write_b64 v6, v[16:17] offset:4096
s_mov_b64 exec, -1
s_lshl_b32 s12, s22, 7
s_add_u32 s12, s12, 109051904
buffer_load_dwordx4 v[144:147], v8, s[84:87], s12 offen sc1
s_add_u32 s12, s12, 524288
buffer_load_dwordx4 v[148:151], v8, s[84:87], s12 offen sc1
s_add_u32 s12, s12, 524288
buffer_load_dwordx4 v[152:155], v8, s[84:87], s12 offen sc1
s_add_u32 s12, s12, 524288
buffer_load_dwordx4 v[156:159], v8, s[84:87], s12 offen sc1
s_add_u32 s12, s12, 524288
buffer_load_dwordx4 v[160:163], v8, s[84:87], s12 offen sc1
s_add_u32 s12, s12, 524288
buffer_load_dwordx4 v[164:167], v8, s[84:87], s12 offen sc1
s_add_u32 s12, s12, 524288
buffer_load_dwordx4 v[168:171], v8, s[84:87], s12 offen sc1
s_add_u32 s12, s12, 524288
buffer_load_dwordx4 v[172:175], v8, s[84:87], s12 offen sc1
s_add_u32 s12, s12, 524288
buffer_load_dwordx4 v[176:179], v8, s[84:87], s12 offen sc1
s_add_u32 s12, s12, 524288
buffer_load_dwordx4 v[180:183], v8, s[84:87], s12 offen sc1
s_add_u32 s12, s12, 524288
buffer_load_dwordx4 v[184:187], v8, s[84:87], s12 offen sc1
s_add_u32 s12, s12, 524288
buffer_load_dwordx4 v[188:191], v8, s[84:87], s12 offen sc1
s_add_u32 s12, s12, 524288
buffer_load_dwordx4 v[192:195], v8, s[84:87], s12 offen sc1
s_add_u32 s12, s12, 524288
buffer_load_dwordx4 v[196:199], v8, s[84:87], s12 offen sc1
s_add_u32 s12, s12, 524288
buffer_load_dwordx4 v[200:203], v8, s[84:87], s12 offen sc1
s_add_u32 s12, s12, 524288
buffer_load_dwordx4 v[204:207], v8, s[84:87], s12 offen sc1
s_add_u32 s12, s12, 524288
buffer_load_dwordx4 v[208:211], v8, s[84:87], s12 offen sc1
s_add_u32 s12, s12, 524288
s_waitcnt lgkmcnt(0)
s_barrier
ds_read_b64 v[16:17], v4 offset:0
ds_read_b64 v[48:49], v4 offset:4096
ds_read_b64 v[18:19], v4 offset:256
ds_read_b64 v[50:51], v4 offset:4352
ds_read_b64 v[20:21], v4 offset:512
ds_read_b64 v[52:53], v4 offset:4608
ds_read_b64 v[22:23], v4 offset:768
ds_read_b64 v[54:55], v4 offset:4864
ds_read_b64 v[24:25], v4 offset:1024
ds_read_b64 v[56:57], v4 offset:5120
ds_read_b64 v[26:27], v4 offset:1280
ds_read_b64 v[58:59], v4 offset:5376
ds_read_b64 v[28:29], v4 offset:1536
ds_read_b64 v[60:61], v4 offset:5632
ds_read_b64 v[30:31], v4 offset:1792
ds_read_b64 v[62:63], v4 offset:5888
ds_read_b64 v[32:33], v4 offset:2048
ds_read_b64 v[64:65], v4 offset:6144
ds_read_b64 v[34:35], v4 offset:2304
ds_read_b64 v[66:67], v4 offset:6400
ds_read_b64 v[36:37], v4 offset:2560
ds_read_b64 v[68:69], v4 offset:6656
ds_read_b64 v[38:39], v4 offset:2816
ds_read_b64 v[70:71], v4 offset:6912
ds_read_b64 v[40:41], v4 offset:3072
ds_read_b64 v[72:73], v4 offset:7168
ds_read_b64 v[42:43], v4 offset:3328
ds_read_b64 v[74:75], v4 offset:7424
ds_read_b64 v[44:45], v4 offset:3584
ds_read_b64 v[76:77], v4 offset:7680
ds_read_b64 v[46:47], v4 offset:3840
ds_read_b64 v[78:79], v4 offset:7936
s_waitcnt lgkmcnt(0)
v_pk_add_f32 v[14:15], v[16:17], v[48:49] neg_lo:[0,1] neg_hi:[0,1]
v_pk_add_f32 v[16:17], v[16:17], v[48:49]
v_pk_add_f32 v[48:49], v[18:19], v[50:51] neg_lo:[0,1] neg_hi:[0,1]
v_pk_add_f32 v[18:19], v[18:19], v[50:51]
v_pk_mul_f32 v[50:51], v[48:49], s[50:51] op_sel:[0,0] op_sel_hi:[0,1] neg_lo:[0,0] neg_hi:[0,0]
v_pk_fma_f32 v[50:51], v[48:49], s[50:51], v[50:51] op_sel:[1,1,0] op_sel_hi:[1,0,1] neg_lo:[0,1,0] neg_hi:[0,0,0]
v_pk_add_f32 v[48:49], v[20:21], v[52:53] neg_lo:[0,1] neg_hi:[0,1]
v_pk_add_f32 v[20:21], v[20:21], v[52:53]
v_pk_mul_f32 v[52:53], v[48:49], s[54:55] op_sel:[0,0] op_sel_hi:[0,1] neg_lo:[0,0] neg_hi:[0,0]
v_pk_fma_f32 v[52:53], v[48:49], s[54:55], v[52:53] op_sel:[1,1,0] op_sel_hi:[1,0,1] neg_lo:[0,1,0] neg_hi:[0,0,0]
v_pk_add_f32 v[48:49], v[22:23], v[54:55] neg_lo:[0,1] neg_hi:[0,1]
v_pk_add_f32 v[22:23], v[22:23], v[54:55]
v_pk_mul_f32 v[54:55], v[48:49], s[58:59] op_sel:[0,0] op_sel_hi:[0,1] neg_lo:[0,0] neg_hi:[0,0]
v_pk_fma_f32 v[54:55], v[48:49], s[58:59], v[54:55] op_sel:[1,1,0] op_sel_hi:[1,0,1] neg_lo:[0,1,0] neg_hi:[0,0,0]
v_pk_add_f32 v[48:49], v[24:25], v[56:57] neg_lo:[0,1] neg_hi:[0,1]
v_pk_add_f32 v[24:25], v[24:25], v[56:57]
v_pk_mul_f32 v[56:57], v[48:49], s[62:63] op_sel:[0,0] op_sel_hi:[0,1] neg_lo:[0,0] neg_hi:[0,0]
v_pk_fma_f32 v[56:57], v[48:49], s[62:63], v[56:57] op_sel:[1,1,0] op_sel_hi:[1,0,1] neg_lo:[0,1,0] neg_hi:[0,0,0]
v_pk_add_f32 v[48:49], v[26:27], v[58:59] neg_lo:[0,1] neg_hi:[0,1]
v_pk_add_f32 v[26:27], v[26:27], v[58:59]
v_pk_mul_f32 v[58:59], v[48:49], s[58:59] op_sel:[0,1] op_sel_hi:[0,0] neg_lo:[0,0] neg_hi:[0,0]
v_pk_fma_f32 v[58:59], v[48:49], s[58:59], v[58:59] op_sel:[1,0,0] op_sel_hi:[1,1,1] neg_lo:[0,1,0] neg_hi:[0,0,0]
v_pk_add_f32 v[48:49], v[28:29], v[60:61] neg_lo:[0,1] neg_hi:[0,1]
v_pk_add_f32 v[28:29], v[28:29], v[60:61]
v_pk_mul_f32 v[60:61], v[48:49], s[54:55] op_sel:[0,1] op_sel_hi:[0,0] neg_lo:[0,0] neg_hi:[0,0]
v_pk_fma_f32 v[60:61], v[48:49], s[54:55], v[60:61] op_sel:[1,0,0] op_sel_hi:[1,1,1] neg_lo:[0,1,0] neg_hi:[0,0,0]
v_pk_add_f32 v[48:49], v[30:31], v[62:63] neg_lo:[0,1] neg_hi:[0,1]
v_pk_add_f32 v[30:31], v[30:31], v[62:63]
v_pk_mul_f32 v[62:63], v[48:49], s[50:51] op_sel:[0,1] op_sel_hi:[0,0] neg_lo:[0,0] neg_hi:[0,0]
v_pk_fma_f32 v[62:63], v[48:49], s[50:51], v[62:63] op_sel:[1,0,0] op_sel_hi:[1,1,1] neg_lo:[0,1,0] neg_hi:[0,0,0]
v_pk_add_f32 v[48:49], v[32:33], v[64:65] op_sel:[1,1] op_sel_hi:[0,0] neg_lo:[1,0] neg_hi:[0,1]
v_pk_add_f32 v[32:33], v[32:33], v[64:65]
v_pk_add_f32 v[64:65], v[34:35], v[66:67] neg_lo:[0,1] neg_hi:[0,1]
v_pk_add_f32 v[34:35], v[34:35], v[66:67]
v_pk_mul_f32 v[66:67], v[64:65], s[50:51] op_sel:[0,1] op_sel_hi:[0,0] neg_lo:[0,1] neg_hi:[0,0]
v_pk_fma_f32 v[66:67], v[64:65], s[50:51], v[66:67] op_sel:[1,0,0] op_sel_hi:[1,1,1] neg_lo:[0,1,0] neg_hi:[0,1,0]
v_pk_add_f32 v[64:65], v[36:37], v[68:69] neg_lo:[0,1] neg_hi:[0,1]
v_pk_add_f32 v[36:37], v[36:37], v[68:69]
v_pk_mul_f32 v[68:69], v[64:65], s[54:55] op_sel:[0,1] op_sel_hi:[0,0] neg_lo:[0,1] neg_hi:[0,0]
v_pk_fma_f32 v[68:69], v[64:65], s[54:55], v[68:69] op_sel:[1,0,0] op_sel_hi:[1,1,1] neg_lo:[0,1,0] neg_hi:[0,1,0]
v_pk_add_f32 v[64:65], v[38:39], v[70:71] neg_lo:[0,1] neg_hi:[0,1]
v_pk_add_f32 v[38:39], v[38:39], v[70:71]
v_pk_mul_f32 v[70:71], v[64:65], s[58:59] op_sel:[0,1] op_sel_hi:[0,0] neg_lo:[0,1] neg_hi:[0,0]
v_pk_fma_f32 v[70:71], v[64:65], s[58:59], v[70:71] op_sel:[1,0,0] op_sel_hi:[1,1,1] neg_lo:[0,1,0] neg_hi:[0,1,0]
v_pk_add_f32 v[64:65], v[40:41], v[72:73] neg_lo:[0,1] neg_hi:[0,1]
v_pk_add_f32 v[40:41], v[40:41], v[72:73]
v_pk_mul_f32 v[72:73], v[64:65], s[62:63] op_sel:[0,0] op_sel_hi:[0,1] neg_lo:[0,1] neg_hi:[0,0]
v_pk_fma_f32 v[72:73], v[64:65], s[62:63], v[72:73] op_sel:[1,1,0] op_sel_hi:[1,0,1] neg_lo:[0,1,0] neg_hi:[0,1,0]
v_pk_add_f32 v[64:65], v[42:43], v[74:75] neg_lo:[0,1] neg_hi:[0,1]
v_pk_add_f32 v[42:43], v[42:43], v[74:75]
v_pk_mul_f32 v[74:75], v[64:65], s[58:59] op_sel:[0,0] op_sel_hi:[0,1] neg_lo:[0,1] neg_hi:[0,0]
v_pk_fma_f32 v[74:75], v[64:65], s[58:59], v[74:75] op_sel:[1,1,0] op_sel_hi:[1,0,1] neg_lo:[0,1,0] neg_hi:[0,1,0]
v_pk_add_f32 v[64:65], v[44:45], v[76:77] neg_lo:[0,1] neg_hi:[0,1]
v_pk_add_f32 v[44:45], v[44:45], v[76:77]
v_pk_mul_f32 v[76:77], v[64:65], s[54:55] op_sel:[0,0] op_sel_hi:[0,1] neg_lo:[0,1] neg_hi:[0,0]
v_pk_fma_f32 v[76:77], v[64:65], s[54:55], v[76:77] op_sel:[1,1,0] op_sel_hi:[1,0,1] neg_lo:[0,1,0] neg_hi:[0,1,0]
v_pk_add_f32 v[64:65], v[46:47], v[78:79] neg_lo:[0,1] neg_hi:[0,1]
v_pk_add_f32 v[46:47], v[46:47], v[78:79]
v_pk_mul_f32 v[78:79], v[64:65], s[50:51] op_sel:[0,0] op_sel_hi:[0,1] neg_lo:[0,1] neg_hi:[0,0]
v_pk_fma_f32 v[78:79], v[64:65], s[50:51], v[78:79] op_sel:[1,1,0] op_sel_hi:[1,0,1] neg_lo:[0,1,0] neg_hi:[0,1,0]
v_pk_add_f32 v[64:65], v[16:17], v[32:33] neg_lo:[0,1] neg_hi:[0,1]
v_pk_add_f32 v[16:17], v[16:17], v[32:33]
v_pk_add_f32 v[32:33], v[18:19], v[34:35] neg_lo:[0,1] neg_hi:[0,1]
v_pk_add_f32 v[18:19], v[18:19], v[34:35]
v_pk_mul_f32 v[34:35], v[32:33], s[54:55] op_sel:[0,0] op_sel_hi:[0,1] neg_lo:[0,0] neg_hi:[0,0]
v_pk_fma_f32 v[34:35], v[32:33], s[54:55], v[34:35] op_sel:[1,1,0] op_sel_hi:[1,0,1] neg_lo:[0,1,0] neg_hi:[0,0,0]
v_pk_add_f32 v[32:33], v[20:21], v[36:37] neg_lo:[0,1] neg_hi:[0,1]
v_pk_add_f32 v[20:21], v[20:21], v[36:37]
v_pk_mul_f32 v[36:37], v[32:33], s[62:63] op_sel:[0,0] op_sel_hi:[0,1] neg_lo:[0,0] neg_hi:[0,0]
v_pk_fma_f32 v[36:37], v[32:33], s[62:63], v[36:37] op_sel:[1,1,0] op_sel_hi:[1,0,1] neg_lo:[0,1,0] neg_hi:[0,0,0]
v_pk_add_f32 v[32:33], v[22:23], v[38:39] neg_lo:[0,1] neg_hi:[0,1]
v_pk_add_f32 v[22:23], v[22:23], v[38:39]
v_pk_mul_f32 v[38:39], v[32:33], s[54:55] op_sel:[0,1] op_sel_hi:[0,0] neg_lo:[0,0] neg_hi:[0,0]
v_pk_fma_f32 v[38:39], v[32:33], s[54:55], v[38:39] op_sel:[1,0,0] op_sel_hi:[1,1,1] neg_lo:[0,1,0] neg_hi:[0,0,0]
v_pk_add_f32 v[32:33], v[24:25], v[40:41] op_sel:[1,1] op_sel_hi:[0,0] neg_lo:[1,0] neg_hi:[0,1]
v_pk_add_f32 v[24:25], v[24:25], v[40:41]
v_pk_add_f32 v[40:41], v[26:27], v[42:43] neg_lo:[0,1] neg_hi:[0,1]
v_pk_add_f32 v[26:27], v[26:27], v[42:43]
v_pk_mul_f32 v[42:43], v[40:41], s[54:55] op_sel:[0,1] op_sel_hi:[0,0] neg_lo:[0,1] neg_hi:[0,0]
v_pk_fma_f32 v[42:43], v[40:41], s[54:55], v[42:43] op_sel:[1,0,0] op_sel_hi:[1,1,1] neg_lo:[0,1,0] neg_hi:[0,1,0]
v_pk_add_f32 v[40:41], v[28:29], v[44:45] neg_lo:[0,1] neg_hi:[0,1]
v_pk_add_f32 v[28:29], v[28:29], v[44:45]
v_pk_mul_f32 v[44:45], v[40:41], s[62:63] op_sel:[0,0] op_sel_hi:[0,1] neg_lo:[0,1] neg_hi:[0,0]
v_pk_fma_f32 v[44:45], v[40:41], s[62:63], v[44:45] op_sel:[1,1,0] op_sel_hi:[1,0,1] neg_lo:[0,1,0] neg_hi:[0,1,0]
v_pk_add_f32 v[40:41], v[30:31], v[46:47] neg_lo:[0,1] neg_hi:[0,1]
v_pk_add_f32 v[30:31], v[30:31], v[46:47]
v_pk_mul_f32 v[46:47], v[40:41], s[54:55] op_sel:[0,0] op_sel_hi:[0,1] neg_lo:[0,1] neg_hi:[0,0]
v_pk_fma_f32 v[46:47], v[40:41], s[54:55], v[46:47] op_sel:[1,1,0] op_sel_hi:[1,0,1] neg_lo:[0,1,0] neg_hi:[0,1,0]
v_pk_add_f32 v[40:41], v[14:15], v[48:49] neg_lo:[0,1] neg_hi:[0,1]
v_pk_add_f32 v[14:15], v[14:15], v[48:49]
v_pk_add_f32 v[48:49], v[50:51], v[66:67] neg_lo:[0,1] neg_hi:[0,1]
v_pk_add_f32 v[50:51], v[50:51], v[66:67]
v_pk_mul_f32 v[66:67], v[48:49], s[54:55] op_sel:[0,0] op_sel_hi:[0,1] neg_lo:[0,0] neg_hi:[0,0]
v_pk_fma_f32 v[66:67], v[48:49], s[54:55], v[66:67] op_sel:[1,1,0] op_sel_hi:[1,0,1] neg_lo:[0,1,0] neg_hi:[0,0,0]
v_pk_add_f32 v[48:49], v[52:53], v[68:69] neg_lo:[0,1] neg_hi:[0,1]
v_pk_add_f32 v[52:53], v[52:53], v[68:69]
v_pk_mul_f32 v[68:69], v[48:49], s[62:63] op_sel:[0,0] op_sel_hi:[0,1] neg_lo:[0,0] neg_hi:[0,0]
v_pk_fma_f32 v[68:69], v[48:49], s[62:63], v[68:69] op_sel:[1,1,0] op_sel_hi:[1,0,1] neg_lo:[0,1,0] neg_hi:[0,0,0]
v_pk_add_f32 v[48:49], v[54:55], v[70:71] neg_lo:[0,1] neg_hi:[0,1]
v_pk_add_f32 v[54:55], v[54:55], v[70:71]
v_pk_mul_f32 v[70:71], v[48:49], s[54:55] op_sel:[0,1] op_sel_hi:[0,0] neg_lo:[0,0] neg_hi:[0,0]
v_pk_fma_f32 v[70:71], v[48:49], s[54:55], v[70:71] op_sel:[1,0,0] op_sel_hi:[1,1,1] neg_lo:[0,1,0] neg_hi:[0,0,0]
v_pk_add_f32 v[48:49], v[56:57], v[72:73] op_sel:[1,1] op_sel_hi:[0,0] neg_lo:[1,0] neg_hi:[0,1]
v_pk_add_f32 v[56:57], v[56:57], v[72:73]
v_pk_add_f32 v[72:73], v[58:59], v[74:75] neg_lo:[0,1] neg_hi:[0,1]
v_pk_add_f32 v[58:59], v[58:59], v[74:75]
v_pk_mul_f32 v[74:75], v[72:73], s[54:55] op_sel:[0,1] op_sel_hi:[0,0] neg_lo:[0,1] neg_hi:[0,0]
v_pk_fma_f32 v[74:75], v[72:73], s[54:55], v[74:75] op_sel:[1,0,0] op_sel_hi:[1,1,1] neg_lo:[0,1,0] neg_hi:[0,1,0]
v_pk_add_f32 v[72:73], v[60:61], v[76:77] neg_lo:[0,1] neg_hi:[0,1]
v_pk_add_f32 v[60:61], v[60:61], v[76:77]
v_pk_mul_f32 v[76:77], v[72:73], s[62:63] op_sel:[0,0] op_sel_hi:[0,1] neg_lo:[0,1] neg_hi:[0,0]
v_pk_fma_f32 v[76:77], v[72:73], s[62:63], v[76:77] op_sel:[1,1,0] op_sel_hi:[1,0,1] neg_lo:[0,1,0] neg_hi:[0,1,0]
v_pk_add_f32 v[72:73], v[62:63], v[78:79] neg_lo:[0,1] neg_hi:[0,1]
v_pk_add_f32 v[62:63], v[62:63], v[78:79]
v_pk_mul_f32 v[78:79], v[72:73], s[54:55] op_sel:[0,0] op_sel_hi:[0,1] neg_lo:[0,1] neg_hi:[0,0]
v_pk_fma_f32 v[78:79], v[72:73], s[54:55], v[78:79] op_sel:[1,1,0] op_sel_hi:[1,0,1] neg_lo:[0,1,0] neg_hi:[0,1,0]
v_pk_add_f32 v[72:73], v[16:17], v[24:25] neg_lo:[0,1] neg_hi:[0,1]
v_pk_add_f32 v[16:17], v[16:17], v[24:25]
v_pk_add_f32 v[24:25], v[18:19], v[26:27] neg_lo:[0,1] neg_hi:[0,1]
v_pk_add_f32 v[18:19], v[18:19], v[26:27]
v_pk_mul_f32 v[26:27], v[24:25], s[62:63] op_sel:[0,0] op_sel_hi:[0,1] neg_lo:[0,0] neg_hi:[0,0]
v_pk_fma_f32 v[26:27], v[24:25], s[62:63], v[26:27] op_sel:[1,1,0] op_sel_hi:[1,0,1] neg_lo:[0,1,0] neg_hi:[0,0,0]
v_pk_add_f32 v[24:25], v[20:21], v[28:29] op_sel:[1,1] op_sel_hi:[0,0] neg_lo:[1,0] neg_hi:[0,1]
v_pk_add_f32 v[20:21], v[20:21], v[28:29]
v_pk_add_f32 v[28:29], v[22:23], v[30:31] neg_lo:[0,1] neg_hi:[0,1]
v_pk_add_f32 v[22:23], v[22:23], v[30:31]
v_pk_mul_f32 v[30:31], v[28:29], s[62:63] op_sel:[0,0] op_sel_hi:[0,1] neg_lo:[0,1] neg_hi:[0,0]
v_pk_fma_f32 v[30:31], v[28:29], s[62:63], v[30:31] op_sel:[1,1,0] op_sel_hi:[1,0,1] neg_lo:[0,1,0] neg_hi:[0,1,0]
v_pk_add_f32 v[28:29], v[64:65], v[32:33] neg_lo:[0,1] neg_hi:[0,1]
v_pk_add_f32 v[64:65], v[64:65], v[32:33]
v_pk_add_f32 v[32:33], v[34:35], v[42:43] neg_lo:[0,1] neg_hi:[0,1]
v_pk_add_f32 v[34:35], v[34:35], v[42:43]
v_pk_mul_f32 v[42:43], v[32:33], s[62:63] op_sel:[0,0] op_sel_hi:[0,1] neg_lo:[0,0] neg_hi:[0,0]
v_pk_fma_f32 v[42:43], v[32:33], s[62:63], v[42:43] op_sel:[1,1,0] op_sel_hi:[1,0,1] neg_lo:[0,1,0] neg_hi:[0,0,0]
v_pk_add_f32 v[32:33], v[36:37], v[44:45] op_sel:[1,1] op_sel_hi:[0,0] neg_lo:[1,0] neg_hi:[0,1]
v_pk_add_f32 v[36:37], v[36:37], v[44:45]
v_pk_add_f32 v[44:45], v[38:39], v[46:47] neg_lo:[0,1] neg_hi:[0,1]
v_pk_add_f32 v[38:39], v[38:39], v[46:47]
v_pk_mul_f32 v[46:47], v[44:45], s[62:63] op_sel:[0,0] op_sel_hi:[0,1] neg_lo:[0,1] neg_hi:[0,0]
v_pk_fma_f32 v[46:47], v[44:45], s[62:63], v[46:47] op_sel:[1,1,0] op_sel_hi:[1,0,1] neg_lo:[0,1,0] neg_hi:[0,1,0]
v_pk_add_f32 v[44:45], v[14:15], v[56:57] neg_lo:[0,1] neg_hi:[0,1]
v_pk_add_f32 v[14:15], v[14:15], v[56:57]
v_pk_add_f32 v[56:57], v[50:51], v[58:59] neg_lo:[0,1] neg_hi:[0,1]
v_pk_add_f32 v[50:51], v[50:51], v[58:59]
v_pk_mul_f32 v[58:59], v[56:57], s[62:63] op_sel:[0,0] op_sel_hi:[0,1] neg_lo:[0,0] neg_hi:[0,0]
v_pk_fma_f32 v[58:59], v[56:57], s[62:63], v[58:59] op_sel:[1,1,0] op_sel_hi:[1,0,1] neg_lo:[0,1,0] neg_hi:[0,0,0]
v_pk_add_f32 v[56:57], v[52:53], v[60:61] op_sel:[1,1] op_sel_hi:[0,0] neg_lo:[1,0] neg_hi:[0,1]
v_pk_add_f32 v[52:53], v[52:53], v[60:61]
v_pk_add_f32 v[60:61], v[54:55], v[62:63] neg_lo:[0,1] neg_hi:[0,1]
v_pk_add_f32 v[54:55], v[54:55], v[62:63]
v_pk_mul_f32 v[62:63], v[60:61], s[62:63] op_sel:[0,0] op_sel_hi:[0,1] neg_lo:[0,1] neg_hi:[0,0]
v_pk_fma_f32 v[62:63], v[60:61], s[62:63], v[62:63] op_sel:[1,1,0] op_sel_hi:[1,0,1] neg_lo:[0,1,0] neg_hi:[0,1,0]
v_pk_add_f32 v[60:61], v[40:41], v[48:49] neg_lo:[0,1] neg_hi:[0,1]
v_pk_add_f32 v[40:41], v[40:41], v[48:49]
v_pk_add_f32 v[48:49], v[66:67], v[74:75] neg_lo:[0,1] neg_hi:[0,1]
v_pk_add_f32 v[66:67], v[66:67], v[74:75]
v_pk_mul_f32 v[74:75], v[48:49], s[62:63] op_sel:[0,0] op_sel_hi:[0,1] neg_lo:[0,0] neg_hi:[0,0]
v_pk_fma_f32 v[74:75], v[48:49], s[62:63], v[74:75] op_sel:[1,1,0] op_sel_hi:[1,0,1] neg_lo:[0,1,0] neg_hi:[0,0,0]
v_pk_add_f32 v[48:49], v[68:69], v[76:77] op_sel:[1,1] op_sel_hi:[0,0] neg_lo:[1,0] neg_hi:[0,1]
v_pk_add_f32 v[68:69], v[68:69], v[76:77]
v_pk_add_f32 v[76:77], v[70:71], v[78:79] neg_lo:[0,1] neg_hi:[0,1]
v_pk_add_f32 v[70:71], v[70:71], v[78:79]
v_pk_mul_f32 v[78:79], v[76:77], s[62:63] op_sel:[0,0] op_sel_hi:[0,1] neg_lo:[0,1] neg_hi:[0,0]
v_pk_fma_f32 v[78:79], v[76:77], s[62:63], v[78:79] op_sel:[1,1,0] op_sel_hi:[1,0,1] neg_lo:[0,1,0] neg_hi:[0,1,0]
v_pk_add_f32 v[76:77], v[16:17], v[20:21] neg_lo:[0,1] neg_hi:[0,1]
v_pk_add_f32 v[16:17], v[16:17], v[20:21]
v_pk_add_f32 v[20:21], v[18:19], v[22:23] op_sel:[1,1] op_sel_hi:[0,0] neg_lo:[1,0] neg_hi:[0,1]
v_pk_add_f32 v[18:19], v[18:19], v[22:23]
v_pk_add_f32 v[22:23], v[72:73], v[24:25] neg_lo:[0,1] neg_hi:[0,1]
v_pk_add_f32 v[72:73], v[72:73], v[24:25]
v_pk_add_f32 v[24:25], v[26:27], v[30:31] op_sel:[1,1] op_sel_hi:[0,0] neg_lo:[1,0] neg_hi:[0,1]
v_pk_add_f32 v[26:27], v[26:27], v[30:31]
v_pk_add_f32 v[30:31], v[64:65], v[36:37] neg_lo:[0,1] neg_hi:[0,1]
v_pk_add_f32 v[64:65], v[64:65], v[36:37]
v_pk_add_f32 v[36:37], v[34:35], v[38:39] op_sel:[1,1] op_sel_hi:[0,0] neg_lo:[1,0] neg_hi:[0,1]
v_pk_add_f32 v[34:35], v[34:35], v[38:39]
v_pk_add_f32 v[38:39], v[28:29], v[32:33] neg_lo:[0,1] neg_hi:[0,1]
v_pk_add_f32 v[28:29], v[28:29], v[32:33]
v_pk_add_f32 v[32:33], v[42:43], v[46:47] op_sel:[1,1] op_sel_hi:[0,0] neg_lo:[1,0] neg_hi:[0,1]
v_pk_add_f32 v[42:43], v[42:43], v[46:47]
v_pk_add_f32 v[46:47], v[14:15], v[52:53] neg_lo:[0,1] neg_hi:[0,1]
v_pk_add_f32 v[14:15], v[14:15], v[52:53]
v_pk_add_f32 v[52:53], v[50:51], v[54:55] op_sel:[1,1] op_sel_hi:[0,0] neg_lo:[1,0] neg_hi:[0,1]
v_pk_add_f32 v[50:51], v[50:51], v[54:55]
v_pk_add_f32 v[54:55], v[44:45], v[56:57] neg_lo:[0,1] neg_hi:[0,1]
v_pk_add_f32 v[44:45], v[44:45], v[56:57]
v_pk_add_f32 v[56:57], v[58:59], v[62:63] op_sel:[1,1] op_sel_hi:[0,0] neg_lo:[1,0] neg_hi:[0,1]
v_pk_add_f32 v[58:59], v[58:59], v[62:63]
v_pk_add_f32 v[62:63], v[40:41], v[68:69] neg_lo:[0,1] neg_hi:[0,1]
v_pk_add_f32 v[40:41], v[40:41], v[68:69]
v_pk_add_f32 v[68:69], v[66:67], v[70:71] op_sel:[1,1] op_sel_hi:[0,0] neg_lo:[1,0] neg_hi:[0,1]
v_pk_add_f32 v[66:67], v[66:67], v[70:71]
v_pk_add_f32 v[70:71], v[60:61], v[48:49] neg_lo:[0,1] neg_hi:[0,1]
v_pk_add_f32 v[60:61], v[60:61], v[48:49]
v_pk_add_f32 v[48:49], v[74:75], v[78:79] op_sel:[1,1] op_sel_hi:[0,0] neg_lo:[1,0] neg_hi:[0,1]
v_pk_add_f32 v[74:75], v[74:75], v[78:79]
v_pk_add_f32 v[78:79], v[16:17], v[18:19] neg_lo:[0,1] neg_hi:[0,1]
v_pk_add_f32 v[16:17], v[16:17], v[18:19]
v_pk_add_f32 v[18:19], v[76:77], v[20:21] neg_lo:[0,1] neg_hi:[0,1]
v_pk_add_f32 v[76:77], v[76:77], v[20:21]
v_pk_add_f32 v[20:21], v[72:73], v[26:27] neg_lo:[0,1] neg_hi:[0,1]
v_pk_add_f32 v[72:73], v[72:73], v[26:27]
v_pk_add_f32 v[26:27], v[22:23], v[24:25] neg_lo:[0,1] neg_hi:[0,1]
v_pk_add_f32 v[22:23], v[22:23], v[24:25]
v_pk_add_f32 v[24:25], v[64:65], v[34:35] neg_lo:[0,1] neg_hi:[0,1]
v_pk_add_f32 v[64:65], v[64:65], v[34:35]
v_pk_add_f32 v[34:35], v[30:31], v[36:37] neg_lo:[0,1] neg_hi:[0,1]
v_pk_add_f32 v[30:31], v[30:31], v[36:37]
v_pk_add_f32 v[36:37], v[28:29], v[42:43] neg_lo:[0,1] neg_hi:[0,1]
v_pk_add_f32 v[28:29], v[28:29], v[42:43]
v_pk_add_f32 v[42:43], v[38:39], v[32:33] neg_lo:[0,1] neg_hi:[0,1]
v_pk_add_f32 v[38:39], v[38:39], v[32:33]
v_pk_add_f32 v[32:33], v[14:15], v[50:51] neg_lo:[0,1] neg_hi:[0,1]
v_pk_add_f32 v[14:15], v[14:15], v[50:51]
v_pk_add_f32 v[50:51], v[46:47], v[52:53] neg_lo:[0,1] neg_hi:[0,1]
v_pk_add_f32 v[46:47], v[46:47], v[52:53]
v_pk_add_f32 v[52:53], v[44:45], v[58:59] neg_lo:[0,1] neg_hi:[0,1]
v_pk_add_f32 v[44:45], v[44:45], v[58:59]
v_pk_add_f32 v[58:59], v[54:55], v[56:57] neg_lo:[0,1] neg_hi:[0,1]
v_pk_add_f32 v[54:55], v[54:55], v[56:57]
v_pk_add_f32 v[56:57], v[40:41], v[66:67] neg_lo:[0,1] neg_hi:[0,1]
v_pk_add_f32 v[40:41], v[40:41], v[66:67]
v_pk_add_f32 v[66:67], v[62:63], v[68:69] neg_lo:[0,1] neg_hi:[0,1]
v_pk_add_f32 v[62:63], v[62:63], v[68:69]
v_pk_add_f32 v[68:69], v[60:61], v[74:75] neg_lo:[0,1] neg_hi:[0,1]
v_pk_add_f32 v[60:61], v[60:61], v[74:75]
v_pk_add_f32 v[74:75], v[70:71], v[48:49] neg_lo:[0,1] neg_hi:[0,1]
v_pk_add_f32 v[70:71], v[70:71], v[48:49]
v_pk_mul_f32 v[48:49], v[14:15], v[82:83] op_sel:[0,0] op_sel_hi:[0,1] neg_lo:[0,0] neg_hi:[0,0]
v_pk_fma_f32 v[14:15], v[14:15], v[82:83], v[48:49] op_sel:[1,1,0] op_sel_hi:[1,0,1] neg_lo:[0,1,0] neg_hi:[0,0,0]
v_pk_mul_f32 v[48:49], v[64:65], v[84:85] op_sel:[0,0] op_sel_hi:[0,1] neg_lo:[0,0] neg_hi:[0,0]
v_pk_fma_f32 v[64:65], v[64:65], v[84:85], v[48:49] op_sel:[1,1,0] op_sel_hi:[1,0,1] neg_lo:[0,1,0] neg_hi:[0,0,0]
v_pk_mul_f32 v[48:49], v[40:41], v[86:87] op_sel:[0,0] op_sel_hi:[0,1] neg_lo:[0,0] neg_hi:[0,0]
v_pk_fma_f32 v[40:41], v[40:41], v[86:87], v[48:49] op_sel:[1,1,0] op_sel_hi:[1,0,1] neg_lo:[0,1,0] neg_hi:[0,0,0]
v_pk_mul_f32 v[48:49], v[72:73], v[88:89] op_sel:[0,0] op_sel_hi:[0,1] neg_lo:[0,0] neg_hi:[0,0]
v_pk_fma_f32 v[72:73], v[72:73], v[88:89], v[48:49] op_sel:[1,1,0] op_sel_hi:[1,0,1] neg_lo:[0,1,0] neg_hi:[0,0,0]
v_pk_mul_f32 v[48:49], v[44:45], v[90:91] op_sel:[0,0] op_sel_hi:[0,1] neg_lo:[0,0] neg_hi:[0,0]
v_pk_fma_f32 v[44:45], v[44:45], v[90:91], v[48:49] op_sel:[1,1,0] op_sel_hi:[1,0,1] neg_lo:[0,1,0] neg_hi:[0,0,0]
v_pk_mul_f32 v[48:49], v[28:29], v[92:93] op_sel:[0,0] op_sel_hi:[0,1] neg_lo:[0,0] neg_hi:[0,0]
v_pk_fma_f32 v[28:29], v[28:29], v[92:93], v[48:49] op_sel:[1,1,0] op_sel_hi:[1,0,1] neg_lo:[0,1,0] neg_hi:[0,0,0]
v_pk_mul_f32 v[48:49], v[60:61], v[94:95] op_sel:[0,0] op_sel_hi:[0,1] neg_lo:[0,0] neg_hi:[0,0]
v_pk_fma_f32 v[60:61], v[60:61], v[94:95], v[48:49] op_sel:[1,1,0] op_sel_hi:[1,0,1] neg_lo:[0,1,0] neg_hi:[0,0,0]
v_pk_mul_f32 v[48:49], v[76:77], v[96:97] op_sel:[0,0] op_sel_hi:[0,1] neg_lo:[0,0] neg_hi:[0,0]
v_pk_fma_f32 v[76:77], v[76:77], v[96:97], v[48:49] op_sel:[1,1,0] op_sel_hi:[1,0,1] neg_lo:[0,1,0] neg_hi:[0,0,0]
v_pk_mul_f32 v[48:49], v[46:47], v[98:99] op_sel:[0,0] op_sel_hi:[0,1] neg_lo:[0,0] neg_hi:[0,0]
v_pk_fma_f32 v[46:47], v[46:47], v[98:99], v[48:49] op_sel:[1,1,0] op_sel_hi:[1,0,1] neg_lo:[0,1,0] neg_hi:[0,0,0]
v_pk_mul_f32 v[48:49], v[30:31], v[100:101] op_sel:[0,0] op_sel_hi:[0,1] neg_lo:[0,0] neg_hi:[0,0]
v_pk_fma_f32 v[30:31], v[30:31], v[100:101], v[48:49] op_sel:[1,1,0] op_sel_hi:[1,0,1] neg_lo:[0,1,0] neg_hi:[0,0,0]
v_pk_mul_f32 v[48:49], v[62:63], v[102:103] op_sel:[0,0] op_sel_hi:[0,1] neg_lo:[0,0] neg_hi:[0,0]
v_pk_fma_f32 v[62:63], v[62:63], v[102:103], v[48:49] op_sel:[1,1,0] op_sel_hi:[1,0,1] neg_lo:[0,1,0] neg_hi:[0,0,0]
v_pk_mul_f32 v[48:49], v[22:23], v[104:105] op_sel:[0,0] op_sel_hi:[0,1] neg_lo:[0,0] neg_hi:[0,0]
v_pk_fma_f32 v[22:23], v[22:23], v[104:105], v[48:49] op_sel:[1,1,0] op_sel_hi:[1,0,1] neg_lo:[0,1,0] neg_hi:[0,0,0]
v_pk_mul_f32 v[48:49], v[54:55], v[106:107] op_sel:[0,0] op_sel_hi:[0,1] neg_lo:[0,0] neg_hi:[0,0]
v_pk_fma_f32 v[54:55], v[54:55], v[106:107], v[48:49] op_sel:[1,1,0] op_sel_hi:[1,0,1] neg_lo:[0,1,0] neg_hi:[0,0,0]
v_pk_mul_f32 v[48:49], v[38:39], v[108:109] op_sel:[0,0] op_sel_hi:[0,1] neg_lo:[0,0] neg_hi:[0,0]
v_pk_fma_f32 v[38:39], v[38:39], v[108:109], v[48:49] op_sel:[1,1,0] op_sel_hi:[1,0,1] neg_lo:[0,1,0] neg_hi:[0,0,0]
v_pk_mul_f32 v[48:49], v[70:71], v[110:111] op_sel:[0,0] op_sel_hi:[0,1] neg_lo:[0,0] neg_hi:[0,0]
v_pk_fma_f32 v[70:71], v[70:71], v[110:111], v[48:49] op_sel:[1,1,0] op_sel_hi:[1,0,1] neg_lo:[0,1,0] neg_hi:[0,0,0]
v_pk_mul_f32 v[48:49], v[78:79], v[112:113] op_sel:[0,0] op_sel_hi:[0,1] neg_lo:[0,0] neg_hi:[0,0]
v_pk_fma_f32 v[78:79], v[78:79], v[112:113], v[48:49] op_sel:[1,1,0] op_sel_hi:[1,0,1] neg_lo:[0,1,0] neg_hi:[0,0,0]
v_pk_mul_f32 v[48:49], v[32:33], v[114:115] op_sel:[0,0] op_sel_hi:[0,1] neg_lo:[0,0] neg_hi:[0,0]
v_pk_fma_f32 v[32:33], v[32:33], v[114:115], v[48:49] op_sel:[1,1,0] op_sel_hi:[1,0,1] neg_lo:[0,1,0] neg_hi:[0,0,0]
v_pk_mul_f32 v[48:49], v[24:25], v[116:117] op_sel:[0,0] op_sel_hi:[0,1] neg_lo:[0,0] neg_hi:[0,0]
v_pk_fma_f32 v[24:25], v[24:25], v[116:117], v[48:49] op_sel:[1,1,0] op_sel_hi:[1,0,1] neg_lo:[0,1,0] neg_hi:[0,0,0]
v_pk_mul_f32 v[48:49], v[56:57], v[118:119] op_sel:[0,0] op_sel_hi:[0,1] neg_lo:[0,0] neg_hi:[0,0]
v_pk_fma_f32 v[56:57], v[56:57], v[118:119], v[48:49] op_sel:[1,1,0] op_sel_hi:[1,0,1] neg_lo:[0,1,0] neg_hi:[0,0,0]
v_pk_mul_f32 v[48:49], v[20:21], v[120:121] op_sel:[0,0] op_sel_hi:[0,1] neg_lo:[0,0] neg_hi:[0,0]
v_pk_fma_f32 v[20:21], v[20:21], v[120:121], v[48:49] op_sel:[1,1,0] op_sel_hi:[1,0,1] neg_lo:[0,1,0] neg_hi:[0,0,0]
v_pk_mul_f32 v[48:49], v[52:53], v[122:123] op_sel:[0,0] op_sel_hi:[0,1] neg_lo:[0,0] neg_hi:[0,0]
v_pk_fma_f32 v[52:53], v[52:53], v[122:123], v[48:49] op_sel:[1,1,0] op_sel_hi:[1,0,1] neg_lo:[0,1,0] neg_hi:[0,0,0]
v_pk_mul_f32 v[48:49], v[36:37], v[124:125] op_sel:[0,0] op_sel_hi:[0,1] neg_lo:[0,0] neg_hi:[0,0]
v_pk_fma_f32 v[36:37], v[36:37], v[124:125], v[48:49] op_sel:[1,1,0] op_sel_hi:[1,0,1] neg_lo:[0,1,0] neg_hi:[0,0,0]
v_pk_mul_f32 v[48:49], v[68:69], v[126:127] op_sel:[0,0] op_sel_hi:[0,1] neg_lo:[0,0] neg_hi:[0,0]
v_pk_fma_f32 v[68:69], v[68:69], v[126:127], v[48:49] op_sel:[1,1,0] op_sel_hi:[1,0,1] neg_lo:[0,1,0] neg_hi:[0,0,0]
v_pk_mul_f32 v[48:49], v[18:19], v[128:129] op_sel:[0,0] op_sel_hi:[0,1] neg_lo:[0,0] neg_hi:[0,0]
v_pk_fma_f32 v[18:19], v[18:19], v[128:129], v[48:49] op_sel:[1,1,0] op_sel_hi:[1,0,1] neg_lo:[0,1,0] neg_hi:[0,0,0]
v_pk_mul_f32 v[48:49], v[50:51], v[130:131] op_sel:[0,0] op_sel_hi:[0,1] neg_lo:[0,0] neg_hi:[0,0]
v_pk_fma_f32 v[50:51], v[50:51], v[130:131], v[48:49] op_sel:[1,1,0] op_sel_hi:[1,0,1] neg_lo:[0,1,0] neg_hi:[0,0,0]
v_pk_mul_f32 v[48:49], v[34:35], v[132:133] op_sel:[0,0] op_sel_hi:[0,1] neg_lo:[0,0] neg_hi:[0,0]
v_pk_fma_f32 v[34:35], v[34:35], v[132:133], v[48:49] op_sel:[1,1,0] op_sel_hi:[1,0,1] neg_lo:[0,1,0] neg_hi:[0,0,0]
v_pk_mul_f32 v[48:49], v[66:67], v[134:135] op_sel:[0,0] op_sel_hi:[0,1] neg_lo:[0,0] neg_hi:[0,0]
v_pk_fma_f32 v[66:67], v[66:67], v[134:135], v[48:49] op_sel:[1,1,0] op_sel_hi:[1,0,1] neg_lo:[0,1,0] neg_hi:[0,0,0]
v_pk_mul_f32 v[48:49], v[26:27], v[136:137] op_sel:[0,0] op_sel_hi:[0,1] neg_lo:[0,0] neg_hi:[0,0]
v_pk_fma_f32 v[26:27], v[26:27], v[136:137], v[48:49] op_sel:[1,1,0] op_sel_hi:[1,0,1] neg_lo:[0,1,0] neg_hi:[0,0,0]
v_pk_mul_f32 v[48:49], v[58:59], v[138:139] op_sel:[0,0] op_sel_hi:[0,1] neg_lo:[0,0] neg_hi:[0,0]
v_pk_fma_f32 v[58:59], v[58:59], v[138:139], v[48:49] op_sel:[1,1,0] op_sel_hi:[1,0,1] neg_lo:[0,1,0] neg_hi:[0,0,0]
v_pk_mul_f32 v[48:49], v[42:43], v[140:141] op_sel:[0,0] op_sel_hi:[0,1] neg_lo:[0,0] neg_hi:[0,0]
v_pk_fma_f32 v[42:43], v[42:43], v[140:141], v[48:49] op_sel:[1,1,0] op_sel_hi:[1,0,1] neg_lo:[0,1,0] neg_hi:[0,0,0]
v_pk_mul_f32 v[48:49], v[74:75], v[142:143] op_sel:[0,0] op_sel_hi:[0,1] neg_lo:[0,0] neg_hi:[0,0]
v_pk_fma_f32 v[74:75], v[74:75], v[142:143], v[48:49] op_sel:[1,1,0] op_sel_hi:[1,0,1] neg_lo:[0,1,0] neg_hi:[0,0,0]
ds_write_b64 v4, v[16:17] offset:0
ds_write_b64 v4, v[14:15] offset:264
ds_write_b64 v4, v[64:65] offset:528
ds_write_b64 v4, v[40:41] offset:792
ds_write_b64 v4, v[72:73] offset:1056
ds_write_b64 v4, v[44:45] offset:1320
ds_write_b64 v4, v[28:29] offset:1584
ds_write_b64 v4, v[60:61] offset:1848
ds_write_b64 v4, v[76:77] offset:2112
ds_write_b64 v4, v[46:47] offset:2376
ds_write_b64 v4, v[30:31] offset:2640
ds_write_b64 v4, v[62:63] offset:2904
ds_write_b64 v4, v[22:23] offset:3168
ds_write_b64 v4, v[54:55] offset:3432
ds_write_b64 v4, v[38:39] offset:3696
ds_write_b64 v4, v[70:71] offset:3960
ds_write_b64 v4, v[78:79] offset:4224
ds_write_b64 v4, v[32:33] offset:4488
ds_write_b64 v4, v[24:25] offset:4752
ds_write_b64 v4, v[56:57] offset:5016
ds_write_b64 v4, v[20:21] offset:5280
ds_write_b64 v4, v[52:53] offset:5544
ds_write_b64 v4, v[36:37] offset:5808
ds_write_b64 v4, v[68:69] offset:6072
ds_write_b64 v4, v[18:19] offset:6336
ds_write_b64 v4, v[50:51] offset:6600
ds_write_b64 v4, v[34:35] offset:6864
ds_write_b64 v4, v[66:67] offset:7128
ds_write_b64 v4, v[26:27] offset:7392
ds_write_b64 v4, v[58:59] offset:7656
ds_write_b64 v4, v[42:43] offset:7920
ds_write_b64 v4, v[74:75] offset:8184
s_waitcnt lgkmcnt(0)
ds_read_b64 v[16:17], v5 offset:0
ds_read_b64 v[48:49], v5 offset:128
ds_read_b64 v[18:19], v5 offset:8
ds_read_b64 v[50:51], v5 offset:136
ds_read_b64 v[20:21], v5 offset:16
ds_read_b64 v[52:53], v5 offset:144
ds_read_b64 v[22:23], v5 offset:24
ds_read_b64 v[54:55], v5 offset:152
ds_read_b64 v[24:25], v5 offset:32
ds_read_b64 v[56:57], v5 offset:160
ds_read_b64 v[26:27], v5 offset:40
ds_read_b64 v[58:59], v5 offset:168
ds_read_b64 v[28:29], v5 offset:48
ds_read_b64 v[60:61], v5 offset:176
ds_read_b64 v[30:31], v5 offset:56
ds_read_b64 v[62:63], v5 offset:184
ds_read_b64 v[32:33], v5 offset:64
ds_read_b64 v[64:65], v5 offset:192
ds_read_b64 v[34:35], v5 offset:72
ds_read_b64 v[66:67], v5 offset:200
ds_read_b64 v[36:37], v5 offset:80
ds_read_b64 v[68:69], v5 offset:208
ds_read_b64 v[38:39], v5 offset:88
ds_read_b64 v[70:71], v5 offset:216
ds_read_b64 v[40:41], v5 offset:96
ds_read_b64 v[72:73], v5 offset:224
ds_read_b64 v[42:43], v5 offset:104
ds_read_b64 v[74:75], v5 offset:232
ds_read_b64 v[44:45], v5 offset:112
ds_read_b64 v[76:77], v5 offset:240
ds_read_b64 v[46:47], v5 offset:120
ds_read_b64 v[78:79], v5 offset:248
s_waitcnt lgkmcnt(0)
v_pk_add_f32 v[14:15], v[16:17], v[48:49] neg_lo:[0,1] neg_hi:[0,1]
v_pk_add_f32 v[16:17], v[16:17], v[48:49]
v_pk_add_f32 v[48:49], v[18:19], v[50:51] neg_lo:[0,1] neg_hi:[0,1]
v_pk_add_f32 v[18:19], v[18:19], v[50:51]
v_pk_mul_f32 v[50:51], v[48:49], s[50:51] op_sel:[0,0] op_sel_hi:[0,1] neg_lo:[0,0] neg_hi:[0,0]
v_pk_fma_f32 v[50:51], v[48:49], s[50:51], v[50:51] op_sel:[1,1,0] op_sel_hi:[1,0,1] neg_lo:[0,1,0] neg_hi:[0,0,0]
v_pk_add_f32 v[48:49], v[20:21], v[52:53] neg_lo:[0,1] neg_hi:[0,1]
v_pk_add_f32 v[20:21], v[20:21], v[52:53]
v_pk_mul_f32 v[52:53], v[48:49], s[54:55] op_sel:[0,0] op_sel_hi:[0,1] neg_lo:[0,0] neg_hi:[0,0]
v_pk_fma_f32 v[52:53], v[48:49], s[54:55], v[52:53] op_sel:[1,1,0] op_sel_hi:[1,0,1] neg_lo:[0,1,0] neg_hi:[0,0,0]
v_pk_add_f32 v[48:49], v[22:23], v[54:55] neg_lo:[0,1] neg_hi:[0,1]
v_pk_add_f32 v[22:23], v[22:23], v[54:55]
v_pk_mul_f32 v[54:55], v[48:49], s[58:59] op_sel:[0,0] op_sel_hi:[0,1] neg_lo:[0,0] neg_hi:[0,0]
v_pk_fma_f32 v[54:55], v[48:49], s[58:59], v[54:55] op_sel:[1,1,0] op_sel_hi:[1,0,1] neg_lo:[0,1,0] neg_hi:[0,0,0]
v_pk_add_f32 v[48:49], v[24:25], v[56:57] neg_lo:[0,1] neg_hi:[0,1]
v_pk_add_f32 v[24:25], v[24:25], v[56:57]
v_pk_mul_f32 v[56:57], v[48:49], s[62:63] op_sel:[0,0] op_sel_hi:[0,1] neg_lo:[0,0] neg_hi:[0,0]
v_pk_fma_f32 v[56:57], v[48:49], s[62:63], v[56:57] op_sel:[1,1,0] op_sel_hi:[1,0,1] neg_lo:[0,1,0] neg_hi:[0,0,0]
v_pk_add_f32 v[48:49], v[26:27], v[58:59] neg_lo:[0,1] neg_hi:[0,1]
v_pk_add_f32 v[26:27], v[26:27], v[58:59]
v_pk_mul_f32 v[58:59], v[48:49], s[58:59] op_sel:[0,1] op_sel_hi:[0,0] neg_lo:[0,0] neg_hi:[0,0]
v_pk_fma_f32 v[58:59], v[48:49], s[58:59], v[58:59] op_sel:[1,0,0] op_sel_hi:[1,1,1] neg_lo:[0,1,0] neg_hi:[0,0,0]
v_pk_add_f32 v[48:49], v[28:29], v[60:61] neg_lo:[0,1] neg_hi:[0,1]
v_pk_add_f32 v[28:29], v[28:29], v[60:61]
v_pk_mul_f32 v[60:61], v[48:49], s[54:55] op_sel:[0,1] op_sel_hi:[0,0] neg_lo:[0,0] neg_hi:[0,0]
v_pk_fma_f32 v[60:61], v[48:49], s[54:55], v[60:61] op_sel:[1,0,0] op_sel_hi:[1,1,1] neg_lo:[0,1,0] neg_hi:[0,0,0]
v_pk_add_f32 v[48:49], v[30:31], v[62:63] neg_lo:[0,1] neg_hi:[0,1]
v_pk_add_f32 v[30:31], v[30:31], v[62:63]
v_pk_mul_f32 v[62:63], v[48:49], s[50:51] op_sel:[0,1] op_sel_hi:[0,0] neg_lo:[0,0] neg_hi:[0,0]
v_pk_fma_f32 v[62:63], v[48:49], s[50:51], v[62:63] op_sel:[1,0,0] op_sel_hi:[1,1,1] neg_lo:[0,1,0] neg_hi:[0,0,0]
v_pk_add_f32 v[48:49], v[32:33], v[64:65] op_sel:[1,1] op_sel_hi:[0,0] neg_lo:[1,0] neg_hi:[0,1]
v_pk_add_f32 v[32:33], v[32:33], v[64:65]
v_pk_add_f32 v[64:65], v[34:35], v[66:67] neg_lo:[0,1] neg_hi:[0,1]
v_pk_add_f32 v[34:35], v[34:35], v[66:67]
v_pk_mul_f32 v[66:67], v[64:65], s[50:51] op_sel:[0,1] op_sel_hi:[0,0] neg_lo:[0,1] neg_hi:[0,0]
v_pk_fma_f32 v[66:67], v[64:65], s[50:51], v[66:67] op_sel:[1,0,0] op_sel_hi:[1,1,1] neg_lo:[0,1,0] neg_hi:[0,1,0]
v_pk_add_f32 v[64:65], v[36:37], v[68:69] neg_lo:[0,1] neg_hi:[0,1]
v_pk_add_f32 v[36:37], v[36:37], v[68:69]
v_pk_mul_f32 v[68:69], v[64:65], s[54:55] op_sel:[0,1] op_sel_hi:[0,0] neg_lo:[0,1] neg_hi:[0,0]
v_pk_fma_f32 v[68:69], v[64:65], s[54:55], v[68:69] op_sel:[1,0,0] op_sel_hi:[1,1,1] neg_lo:[0,1,0] neg_hi:[0,1,0]
v_pk_add_f32 v[64:65], v[38:39], v[70:71] neg_lo:[0,1] neg_hi:[0,1]
v_pk_add_f32 v[38:39], v[38:39], v[70:71]
v_pk_mul_f32 v[70:71], v[64:65], s[58:59] op_sel:[0,1] op_sel_hi:[0,0] neg_lo:[0,1] neg_hi:[0,0]
v_pk_fma_f32 v[70:71], v[64:65], s[58:59], v[70:71] op_sel:[1,0,0] op_sel_hi:[1,1,1] neg_lo:[0,1,0] neg_hi:[0,1,0]
v_pk_add_f32 v[64:65], v[40:41], v[72:73] neg_lo:[0,1] neg_hi:[0,1]
v_pk_add_f32 v[40:41], v[40:41], v[72:73]
v_pk_mul_f32 v[72:73], v[64:65], s[62:63] op_sel:[0,0] op_sel_hi:[0,1] neg_lo:[0,1] neg_hi:[0,0]
v_pk_fma_f32 v[72:73], v[64:65], s[62:63], v[72:73] op_sel:[1,1,0] op_sel_hi:[1,0,1] neg_lo:[0,1,0] neg_hi:[0,1,0]
v_pk_add_f32 v[64:65], v[42:43], v[74:75] neg_lo:[0,1] neg_hi:[0,1]
v_pk_add_f32 v[42:43], v[42:43], v[74:75]
v_pk_mul_f32 v[74:75], v[64:65], s[58:59] op_sel:[0,0] op_sel_hi:[0,1] neg_lo:[0,1] neg_hi:[0,0]
v_pk_fma_f32 v[74:75], v[64:65], s[58:59], v[74:75] op_sel:[1,1,0] op_sel_hi:[1,0,1] neg_lo:[0,1,0] neg_hi:[0,1,0]
v_pk_add_f32 v[64:65], v[44:45], v[76:77] neg_lo:[0,1] neg_hi:[0,1]
v_pk_add_f32 v[44:45], v[44:45], v[76:77]
v_pk_mul_f32 v[76:77], v[64:65], s[54:55] op_sel:[0,0] op_sel_hi:[0,1] neg_lo:[0,1] neg_hi:[0,0]
v_pk_fma_f32 v[76:77], v[64:65], s[54:55], v[76:77] op_sel:[1,1,0] op_sel_hi:[1,0,1] neg_lo:[0,1,0] neg_hi:[0,1,0]
v_pk_add_f32 v[64:65], v[46:47], v[78:79] neg_lo:[0,1] neg_hi:[0,1]
v_pk_add_f32 v[46:47], v[46:47], v[78:79]
v_pk_mul_f32 v[78:79], v[64:65], s[50:51] op_sel:[0,0] op_sel_hi:[0,1] neg_lo:[0,1] neg_hi:[0,0]
v_pk_fma_f32 v[78:79], v[64:65], s[50:51], v[78:79] op_sel:[1,1,0] op_sel_hi:[1,0,1] neg_lo:[0,1,0] neg_hi:[0,1,0]
v_pk_add_f32 v[64:65], v[16:17], v[32:33] neg_lo:[0,1] neg_hi:[0,1]
v_pk_add_f32 v[16:17], v[16:17], v[32:33]
v_pk_add_f32 v[32:33], v[18:19], v[34:35] neg_lo:[0,1] neg_hi:[0,1]
v_pk_add_f32 v[18:19], v[18:19], v[34:35]
v_pk_mul_f32 v[34:35], v[32:33], s[54:55] op_sel:[0,0] op_sel_hi:[0,1] neg_lo:[0,0] neg_hi:[0,0]
v_pk_fma_f32 v[34:35], v[32:33], s[54:55], v[34:35] op_sel:[1,1,0] op_sel_hi:[1,0,1] neg_lo:[0,1,0] neg_hi:[0,0,0]
v_pk_add_f32 v[32:33], v[20:21], v[36:37] neg_lo:[0,1] neg_hi:[0,1]
v_pk_add_f32 v[20:21], v[20:21], v[36:37]
v_pk_mul_f32 v[36:37], v[32:33], s[62:63] op_sel:[0,0] op_sel_hi:[0,1] neg_lo:[0,0] neg_hi:[0,0]
v_pk_fma_f32 v[36:37], v[32:33], s[62:63], v[36:37] op_sel:[1,1,0] op_sel_hi:[1,0,1] neg_lo:[0,1,0] neg_hi:[0,0,0]
v_pk_add_f32 v[32:33], v[22:23], v[38:39] neg_lo:[0,1] neg_hi:[0,1]
v_pk_add_f32 v[22:23], v[22:23], v[38:39]
v_pk_mul_f32 v[38:39], v[32:33], s[54:55] op_sel:[0,1] op_sel_hi:[0,0] neg_lo:[0,0] neg_hi:[0,0]
v_pk_fma_f32 v[38:39], v[32:33], s[54:55], v[38:39] op_sel:[1,0,0] op_sel_hi:[1,1,1] neg_lo:[0,1,0] neg_hi:[0,0,0]
v_pk_add_f32 v[32:33], v[24:25], v[40:41] op_sel:[1,1] op_sel_hi:[0,0] neg_lo:[1,0] neg_hi:[0,1]
v_pk_add_f32 v[24:25], v[24:25], v[40:41]
v_pk_add_f32 v[40:41], v[26:27], v[42:43] neg_lo:[0,1] neg_hi:[0,1]
v_pk_add_f32 v[26:27], v[26:27], v[42:43]
v_pk_mul_f32 v[42:43], v[40:41], s[54:55] op_sel:[0,1] op_sel_hi:[0,0] neg_lo:[0,1] neg_hi:[0,0]
v_pk_fma_f32 v[42:43], v[40:41], s[54:55], v[42:43] op_sel:[1,0,0] op_sel_hi:[1,1,1] neg_lo:[0,1,0] neg_hi:[0,1,0]
v_pk_add_f32 v[40:41], v[28:29], v[44:45] neg_lo:[0,1] neg_hi:[0,1]
v_pk_add_f32 v[28:29], v[28:29], v[44:45]
v_pk_mul_f32 v[44:45], v[40:41], s[62:63] op_sel:[0,0] op_sel_hi:[0,1] neg_lo:[0,1] neg_hi:[0,0]
v_pk_fma_f32 v[44:45], v[40:41], s[62:63], v[44:45] op_sel:[1,1,0] op_sel_hi:[1,0,1] neg_lo:[0,1,0] neg_hi:[0,1,0]
v_pk_add_f32 v[40:41], v[30:31], v[46:47] neg_lo:[0,1] neg_hi:[0,1]
v_pk_add_f32 v[30:31], v[30:31], v[46:47]
v_pk_mul_f32 v[46:47], v[40:41], s[54:55] op_sel:[0,0] op_sel_hi:[0,1] neg_lo:[0,1] neg_hi:[0,0]
v_pk_fma_f32 v[46:47], v[40:41], s[54:55], v[46:47] op_sel:[1,1,0] op_sel_hi:[1,0,1] neg_lo:[0,1,0] neg_hi:[0,1,0]
v_pk_add_f32 v[40:41], v[14:15], v[48:49] neg_lo:[0,1] neg_hi:[0,1]
v_pk_add_f32 v[14:15], v[14:15], v[48:49]
v_pk_add_f32 v[48:49], v[50:51], v[66:67] neg_lo:[0,1] neg_hi:[0,1]
v_pk_add_f32 v[50:51], v[50:51], v[66:67]
v_pk_mul_f32 v[66:67], v[48:49], s[54:55] op_sel:[0,0] op_sel_hi:[0,1] neg_lo:[0,0] neg_hi:[0,0]
v_pk_fma_f32 v[66:67], v[48:49], s[54:55], v[66:67] op_sel:[1,1,0] op_sel_hi:[1,0,1] neg_lo:[0,1,0] neg_hi:[0,0,0]
v_pk_add_f32 v[48:49], v[52:53], v[68:69] neg_lo:[0,1] neg_hi:[0,1]
v_pk_add_f32 v[52:53], v[52:53], v[68:69]
v_pk_mul_f32 v[68:69], v[48:49], s[62:63] op_sel:[0,0] op_sel_hi:[0,1] neg_lo:[0,0] neg_hi:[0,0]
v_pk_fma_f32 v[68:69], v[48:49], s[62:63], v[68:69] op_sel:[1,1,0] op_sel_hi:[1,0,1] neg_lo:[0,1,0] neg_hi:[0,0,0]
v_pk_add_f32 v[48:49], v[54:55], v[70:71] neg_lo:[0,1] neg_hi:[0,1]
v_pk_add_f32 v[54:55], v[54:55], v[70:71]
v_pk_mul_f32 v[70:71], v[48:49], s[54:55] op_sel:[0,1] op_sel_hi:[0,0] neg_lo:[0,0] neg_hi:[0,0]
v_pk_fma_f32 v[70:71], v[48:49], s[54:55], v[70:71] op_sel:[1,0,0] op_sel_hi:[1,1,1] neg_lo:[0,1,0] neg_hi:[0,0,0]
v_pk_add_f32 v[48:49], v[56:57], v[72:73] op_sel:[1,1] op_sel_hi:[0,0] neg_lo:[1,0] neg_hi:[0,1]
v_pk_add_f32 v[56:57], v[56:57], v[72:73]
v_pk_add_f32 v[72:73], v[58:59], v[74:75] neg_lo:[0,1] neg_hi:[0,1]
v_pk_add_f32 v[58:59], v[58:59], v[74:75]
v_pk_mul_f32 v[74:75], v[72:73], s[54:55] op_sel:[0,1] op_sel_hi:[0,0] neg_lo:[0,1] neg_hi:[0,0]
v_pk_fma_f32 v[74:75], v[72:73], s[54:55], v[74:75] op_sel:[1,0,0] op_sel_hi:[1,1,1] neg_lo:[0,1,0] neg_hi:[0,1,0]
v_pk_add_f32 v[72:73], v[60:61], v[76:77] neg_lo:[0,1] neg_hi:[0,1]
v_pk_add_f32 v[60:61], v[60:61], v[76:77]
v_pk_mul_f32 v[76:77], v[72:73], s[62:63] op_sel:[0,0] op_sel_hi:[0,1] neg_lo:[0,1] neg_hi:[0,0]
v_pk_fma_f32 v[76:77], v[72:73], s[62:63], v[76:77] op_sel:[1,1,0] op_sel_hi:[1,0,1] neg_lo:[0,1,0] neg_hi:[0,1,0]
v_pk_add_f32 v[72:73], v[62:63], v[78:79] neg_lo:[0,1] neg_hi:[0,1]
v_pk_add_f32 v[62:63], v[62:63], v[78:79]
v_pk_mul_f32 v[78:79], v[72:73], s[54:55] op_sel:[0,0] op_sel_hi:[0,1] neg_lo:[0,1] neg_hi:[0,0]
v_pk_fma_f32 v[78:79], v[72:73], s[54:55], v[78:79] op_sel:[1,1,0] op_sel_hi:[1,0,1] neg_lo:[0,1,0] neg_hi:[0,1,0]
v_pk_add_f32 v[72:73], v[16:17], v[24:25] neg_lo:[0,1] neg_hi:[0,1]
v_pk_add_f32 v[16:17], v[16:17], v[24:25]
v_pk_add_f32 v[24:25], v[18:19], v[26:27] neg_lo:[0,1] neg_hi:[0,1]
v_pk_add_f32 v[18:19], v[18:19], v[26:27]
v_pk_mul_f32 v[26:27], v[24:25], s[62:63] op_sel:[0,0] op_sel_hi:[0,1] neg_lo:[0,0] neg_hi:[0,0]
v_pk_fma_f32 v[26:27], v[24:25], s[62:63], v[26:27] op_sel:[1,1,0] op_sel_hi:[1,0,1] neg_lo:[0,1,0] neg_hi:[0,0,0]
v_pk_add_f32 v[24:25], v[20:21], v[28:29] op_sel:[1,1] op_sel_hi:[0,0] neg_lo:[1,0] neg_hi:[0,1]
v_pk_add_f32 v[20:21], v[20:21], v[28:29]
v_pk_add_f32 v[28:29], v[22:23], v[30:31] neg_lo:[0,1] neg_hi:[0,1]
v_pk_add_f32 v[22:23], v[22:23], v[30:31]
v_pk_mul_f32 v[30:31], v[28:29], s[62:63] op_sel:[0,0] op_sel_hi:[0,1] neg_lo:[0,1] neg_hi:[0,0]
v_pk_fma_f32 v[30:31], v[28:29], s[62:63], v[30:31] op_sel:[1,1,0] op_sel_hi:[1,0,1] neg_lo:[0,1,0] neg_hi:[0,1,0]
v_pk_add_f32 v[28:29], v[64:65], v[32:33] neg_lo:[0,1] neg_hi:[0,1]
v_pk_add_f32 v[64:65], v[64:65], v[32:33]
v_pk_add_f32 v[32:33], v[34:35], v[42:43] neg_lo:[0,1] neg_hi:[0,1]
v_pk_add_f32 v[34:35], v[34:35], v[42:43]
v_pk_mul_f32 v[42:43], v[32:33], s[62:63] op_sel:[0,0] op_sel_hi:[0,1] neg_lo:[0,0] neg_hi:[0,0]
v_pk_fma_f32 v[42:43], v[32:33], s[62:63], v[42:43] op_sel:[1,1,0] op_sel_hi:[1,0,1] neg_lo:[0,1,0] neg_hi:[0,0,0]
v_pk_add_f32 v[32:33], v[36:37], v[44:45] op_sel:[1,1] op_sel_hi:[0,0] neg_lo:[1,0] neg_hi:[0,1]
v_pk_add_f32 v[36:37], v[36:37], v[44:45]
v_pk_add_f32 v[44:45], v[38:39], v[46:47] neg_lo:[0,1] neg_hi:[0,1]
v_pk_add_f32 v[38:39], v[38:39], v[46:47]
v_pk_mul_f32 v[46:47], v[44:45], s[62:63] op_sel:[0,0] op_sel_hi:[0,1] neg_lo:[0,1] neg_hi:[0,0]
v_pk_fma_f32 v[46:47], v[44:45], s[62:63], v[46:47] op_sel:[1,1,0] op_sel_hi:[1,0,1] neg_lo:[0,1,0] neg_hi:[0,1,0]
v_pk_add_f32 v[44:45], v[14:15], v[56:57] neg_lo:[0,1] neg_hi:[0,1]
v_pk_add_f32 v[14:15], v[14:15], v[56:57]
v_pk_add_f32 v[56:57], v[50:51], v[58:59] neg_lo:[0,1] neg_hi:[0,1]
v_pk_add_f32 v[50:51], v[50:51], v[58:59]
v_pk_mul_f32 v[58:59], v[56:57], s[62:63] op_sel:[0,0] op_sel_hi:[0,1] neg_lo:[0,0] neg_hi:[0,0]
v_pk_fma_f32 v[58:59], v[56:57], s[62:63], v[58:59] op_sel:[1,1,0] op_sel_hi:[1,0,1] neg_lo:[0,1,0] neg_hi:[0,0,0]
v_pk_add_f32 v[56:57], v[52:53], v[60:61] op_sel:[1,1] op_sel_hi:[0,0] neg_lo:[1,0] neg_hi:[0,1]
v_pk_add_f32 v[52:53], v[52:53], v[60:61]
v_pk_add_f32 v[60:61], v[54:55], v[62:63] neg_lo:[0,1] neg_hi:[0,1]
v_pk_add_f32 v[54:55], v[54:55], v[62:63]
v_pk_mul_f32 v[62:63], v[60:61], s[62:63] op_sel:[0,0] op_sel_hi:[0,1] neg_lo:[0,1] neg_hi:[0,0]
v_pk_fma_f32 v[62:63], v[60:61], s[62:63], v[62:63] op_sel:[1,1,0] op_sel_hi:[1,0,1] neg_lo:[0,1,0] neg_hi:[0,1,0]
v_pk_add_f32 v[60:61], v[40:41], v[48:49] neg_lo:[0,1] neg_hi:[0,1]
v_pk_add_f32 v[40:41], v[40:41], v[48:49]
v_pk_add_f32 v[48:49], v[66:67], v[74:75] neg_lo:[0,1] neg_hi:[0,1]
v_pk_add_f32 v[66:67], v[66:67], v[74:75]
v_pk_mul_f32 v[74:75], v[48:49], s[62:63] op_sel:[0,0] op_sel_hi:[0,1] neg_lo:[0,0] neg_hi:[0,0]
v_pk_fma_f32 v[74:75], v[48:49], s[62:63], v[74:75] op_sel:[1,1,0] op_sel_hi:[1,0,1] neg_lo:[0,1,0] neg_hi:[0,0,0]
v_pk_add_f32 v[48:49], v[68:69], v[76:77] op_sel:[1,1] op_sel_hi:[0,0] neg_lo:[1,0] neg_hi:[0,1]
v_pk_add_f32 v[68:69], v[68:69], v[76:77]
v_pk_add_f32 v[76:77], v[70:71], v[78:79] neg_lo:[0,1] neg_hi:[0,1]
v_pk_add_f32 v[70:71], v[70:71], v[78:79]
v_pk_mul_f32 v[78:79], v[76:77], s[62:63] op_sel:[0,0] op_sel_hi:[0,1] neg_lo:[0,1] neg_hi:[0,0]
v_pk_fma_f32 v[78:79], v[76:77], s[62:63], v[78:79] op_sel:[1,1,0] op_sel_hi:[1,0,1] neg_lo:[0,1,0] neg_hi:[0,1,0]
v_pk_add_f32 v[76:77], v[16:17], v[20:21] neg_lo:[0,1] neg_hi:[0,1]
v_pk_add_f32 v[16:17], v[16:17], v[20:21]
v_pk_add_f32 v[20:21], v[18:19], v[22:23] op_sel:[1,1] op_sel_hi:[0,0] neg_lo:[1,0] neg_hi:[0,1]
v_pk_add_f32 v[18:19], v[18:19], v[22:23]
v_pk_add_f32 v[22:23], v[72:73], v[24:25] neg_lo:[0,1] neg_hi:[0,1]
v_pk_add_f32 v[72:73], v[72:73], v[24:25]
v_pk_add_f32 v[24:25], v[26:27], v[30:31] op_sel:[1,1] op_sel_hi:[0,0] neg_lo:[1,0] neg_hi:[0,1]
v_pk_add_f32 v[26:27], v[26:27], v[30:31]
v_pk_add_f32 v[30:31], v[64:65], v[36:37] neg_lo:[0,1] neg_hi:[0,1]
v_pk_add_f32 v[64:65], v[64:65], v[36:37]
v_pk_add_f32 v[36:37], v[34:35], v[38:39] op_sel:[1,1] op_sel_hi:[0,0] neg_lo:[1,0] neg_hi:[0,1]
v_pk_add_f32 v[34:35], v[34:35], v[38:39]
v_pk_add_f32 v[38:39], v[28:29], v[32:33] neg_lo:[0,1] neg_hi:[0,1]
v_pk_add_f32 v[28:29], v[28:29], v[32:33]
v_pk_add_f32 v[32:33], v[42:43], v[46:47] op_sel:[1,1] op_sel_hi:[0,0] neg_lo:[1,0] neg_hi:[0,1]
v_pk_add_f32 v[42:43], v[42:43], v[46:47]
v_pk_add_f32 v[46:47], v[14:15], v[52:53] neg_lo:[0,1] neg_hi:[0,1]
v_pk_add_f32 v[14:15], v[14:15], v[52:53]
v_pk_add_f32 v[52:53], v[50:51], v[54:55] op_sel:[1,1] op_sel_hi:[0,0] neg_lo:[1,0] neg_hi:[0,1]
v_pk_add_f32 v[50:51], v[50:51], v[54:55]
v_pk_add_f32 v[54:55], v[44:45], v[56:57] neg_lo:[0,1] neg_hi:[0,1]
v_pk_add_f32 v[44:45], v[44:45], v[56:57]
v_pk_add_f32 v[56:57], v[58:59], v[62:63] op_sel:[1,1] op_sel_hi:[0,0] neg_lo:[1,0] neg_hi:[0,1]
v_pk_add_f32 v[58:59], v[58:59], v[62:63]
v_pk_add_f32 v[62:63], v[40:41], v[68:69] neg_lo:[0,1] neg_hi:[0,1]
v_pk_add_f32 v[40:41], v[40:41], v[68:69]
v_pk_add_f32 v[68:69], v[66:67], v[70:71] op_sel:[1,1] op_sel_hi:[0,0] neg_lo:[1,0] neg_hi:[0,1]
v_pk_add_f32 v[66:67], v[66:67], v[70:71]
v_pk_add_f32 v[70:71], v[60:61], v[48:49] neg_lo:[0,1] neg_hi:[0,1]
v_pk_add_f32 v[60:61], v[60:61], v[48:49]
v_pk_add_f32 v[48:49], v[74:75], v[78:79] op_sel:[1,1] op_sel_hi:[0,0] neg_lo:[1,0] neg_hi:[0,1]
v_pk_add_f32 v[74:75], v[74:75], v[78:79]
v_pk_add_f32 v[78:79], v[16:17], v[18:19] neg_lo:[0,1] neg_hi:[0,1]
v_pk_add_f32 v[16:17], v[16:17], v[18:19]
v_pk_add_f32 v[18:19], v[76:77], v[20:21] neg_lo:[0,1] neg_hi:[0,1]
v_pk_add_f32 v[76:77], v[76:77], v[20:21]
v_pk_add_f32 v[20:21], v[72:73], v[26:27] neg_lo:[0,1] neg_hi:[0,1]
v_pk_add_f32 v[72:73], v[72:73], v[26:27]
v_pk_add_f32 v[26:27], v[22:23], v[24:25] neg_lo:[0,1] neg_hi:[0,1]
v_pk_add_f32 v[22:23], v[22:23], v[24:25]
v_pk_add_f32 v[24:25], v[64:65], v[34:35] neg_lo:[0,1] neg_hi:[0,1]
v_pk_add_f32 v[64:65], v[64:65], v[34:35]
v_pk_add_f32 v[34:35], v[30:31], v[36:37] neg_lo:[0,1] neg_hi:[0,1]
v_pk_add_f32 v[30:31], v[30:31], v[36:37]
v_pk_add_f32 v[36:37], v[28:29], v[42:43] neg_lo:[0,1] neg_hi:[0,1]
v_pk_add_f32 v[28:29], v[28:29], v[42:43]
v_pk_add_f32 v[42:43], v[38:39], v[32:33] neg_lo:[0,1] neg_hi:[0,1]
v_pk_add_f32 v[38:39], v[38:39], v[32:33]
v_pk_add_f32 v[32:33], v[14:15], v[50:51] neg_lo:[0,1] neg_hi:[0,1]
v_pk_add_f32 v[14:15], v[14:15], v[50:51]
v_pk_add_f32 v[50:51], v[46:47], v[52:53] neg_lo:[0,1] neg_hi:[0,1]
v_pk_add_f32 v[46:47], v[46:47], v[52:53]
v_pk_add_f32 v[52:53], v[44:45], v[58:59] neg_lo:[0,1] neg_hi:[0,1]
v_pk_add_f32 v[44:45], v[44:45], v[58:59]
v_pk_add_f32 v[58:59], v[54:55], v[56:57] neg_lo:[0,1] neg_hi:[0,1]
v_pk_add_f32 v[54:55], v[54:55], v[56:57]
v_pk_add_f32 v[56:57], v[40:41], v[66:67] neg_lo:[0,1] neg_hi:[0,1]
v_pk_add_f32 v[40:41], v[40:41], v[66:67]
v_pk_add_f32 v[66:67], v[62:63], v[68:69] neg_lo:[0,1] neg_hi:[0,1]
v_pk_add_f32 v[62:63], v[62:63], v[68:69]
v_pk_add_f32 v[68:69], v[60:61], v[74:75] neg_lo:[0,1] neg_hi:[0,1]
v_pk_add_f32 v[60:61], v[60:61], v[74:75]
v_pk_add_f32 v[74:75], v[70:71], v[48:49] neg_lo:[0,1] neg_hi:[0,1]
v_pk_add_f32 v[70:71], v[70:71], v[48:49]
ds_write2st64_b32 v12, v16, v17 offset0:0 offset1:16
ds_write_b32 v12, v14 offset:128
ds_write_b32 v12, v15 offset:4224
ds_write_b32 v12, v64 offset:256
ds_write_b32 v12, v65 offset:4352
ds_write_b32 v12, v40 offset:384
ds_write_b32 v12, v41 offset:4480
ds_write_b32 v12, v72 offset:512
ds_write_b32 v12, v73 offset:4608
ds_write_b32 v12, v44 offset:640
ds_write_b32 v12, v45 offset:4736
ds_write_b32 v12, v28 offset:768
ds_write_b32 v12, v29 offset:4864
ds_write_b32 v12, v60 offset:896
ds_write_b32 v12, v61 offset:4992
ds_write_b32 v12, v76 offset:1024
ds_write_b32 v12, v77 offset:5120
ds_write_b32 v12, v46 offset:1152
ds_write_b32 v12, v47 offset:5248
ds_write_b32 v12, v30 offset:1280
ds_write_b32 v12, v31 offset:5376
ds_write_b32 v12, v62 offset:1408
ds_write_b32 v12, v63 offset:5504
ds_write_b32 v12, v22 offset:1536
ds_write_b32 v12, v23 offset:5632
ds_write_b32 v12, v54 offset:1664
ds_write_b32 v12, v55 offset:5760
ds_write_b32 v12, v38 offset:1792
ds_write_b32 v12, v39 offset:5888
ds_write_b32 v12, v70 offset:1920
ds_write_b32 v12, v71 offset:6016
ds_write_b32 v12, v78 offset:2048
ds_write_b32 v12, v79 offset:6144
ds_write_b32 v12, v32 offset:2176
ds_write_b32 v12, v33 offset:6272
ds_write_b32 v12, v24 offset:2304
ds_write_b32 v12, v25 offset:6400
ds_write_b32 v12, v56 offset:2432
ds_write_b32 v12, v57 offset:6528
ds_write_b32 v12, v20 offset:2560
ds_write_b32 v12, v21 offset:6656
ds_write_b32 v12, v52 offset:2688
ds_write_b32 v12, v53 offset:6784
ds_write_b32 v12, v36 offset:2816
ds_write_b32 v12, v37 offset:6912
ds_write_b32 v12, v68 offset:2944
ds_write_b32 v12, v69 offset:7040
ds_write_b32 v12, v18 offset:3072
ds_write_b32 v12, v19 offset:7168
ds_write_b32 v12, v50 offset:3200
ds_write_b32 v12, v51 offset:7296
ds_write_b32 v12, v34 offset:3328
ds_write_b32 v12, v35 offset:7424
ds_write_b32 v12, v66 offset:3456
ds_write_b32 v12, v67 offset:7552
ds_write_b32 v12, v26 offset:3584
ds_write_b32 v12, v27 offset:7680
ds_write_b32 v12, v58 offset:3712
ds_write_b32 v12, v59 offset:7808
ds_write_b32 v12, v42 offset:3840
ds_write_b32 v12, v43 offset:7936
ds_write_b32 v12, v74 offset:3968
ds_write_b32 v12, v75 offset:8064
s_waitcnt lgkmcnt(0)
s_barrier
s_lshl_b32 s13, s93, 16
ds_read_b128 v[16:19], v2 offset:0
ds_read_b128 v[20:23], v2 offset:16
ds_read_b128 v[24:27], v2 offset:8448
ds_read_b128 v[28:31], v2 offset:8464
ds_read_b128 v[32:35], v2 offset:16896
ds_read_b128 v[36:39], v2 offset:16912
ds_read_b128 v[40:43], v2 offset:25344
ds_read_b128 v[44:47], v2 offset:25360
ds_read_b128 v[48:51], v2 offset:33792
ds_read_b128 v[52:55], v2 offset:33808
ds_read_b128 v[56:59], v2 offset:42240
ds_read_b128 v[60:63], v2 offset:42256
ds_read_b128 v[64:67], v2 offset:50688
ds_read_b128 v[68:71], v2 offset:50704
s_waitcnt lgkmcnt(12)
ds_read_b128 v[72:75], v2 offset:59136
ds_read_b128 v[76:79], v2 offset:59152
s_waitcnt lgkmcnt(14)
v_cvt_pk_bf16_f32 v216, v16, v17
v_cvt_pk_bf16_f32 v217, v18, v19
v_cvt_pk_bf16_f32 v218, v20, v21
v_cvt_pk_bf16_f32 v219, v22, v23
buffer_store_dwordx4 v[216:219], v3, s[4:7], s13 offen sc1
s_add_u32 s13, s13, 8192
s_waitcnt lgkmcnt(12)
v_cvt_pk_bf16_f32 v220, v24, v25
v_cvt_pk_bf16_f32 v221, v26, v27
v_cvt_pk_bf16_f32 v222, v28, v29
v_cvt_pk_bf16_f32 v223, v30, v31
buffer_store_dwordx4 v[220:223], v3, s[4:7], s13 offen sc1
s_add_u32 s13, s13, 8192
s_waitcnt lgkmcnt(10)
v_cvt_pk_bf16_f32 v224, v32, v33
v_cvt_pk_bf16_f32 v225, v34, v35
v_cvt_pk_bf16_f32 v226, v36, v37
v_cvt_pk_bf16_f32 v227, v38, v39
buffer_store_dwordx4 v[224:227], v3, s[4:7], s13 offen sc1
s_add_u32 s13, s13, 8192
s_waitcnt lgkmcnt(8)
v_cvt_pk_bf16_f32 v228, v40, v41
v_cvt_pk_bf16_f32 v229, v42, v43
v_cvt_pk_bf16_f32 v230, v44, v45
v_cvt_pk_bf16_f32 v231, v46, v47
buffer_store_dwordx4 v[228:231], v3, s[4:7], s13 offen sc1
s_add_u32 s13, s13, 8192
s_waitcnt lgkmcnt(6)
v_cvt_pk_bf16_f32 v232, v48, v49
v_cvt_pk_bf16_f32 v233, v50, v51
v_cvt_pk_bf16_f32 v234, v52, v53
v_cvt_pk_bf16_f32 v235, v54, v55
buffer_store_dwordx4 v[232:235], v3, s[4:7], s13 offen sc1
s_add_u32 s13, s13, 8192
s_waitcnt lgkmcnt(4)
v_cvt_pk_bf16_f32 v236, v56, v57
v_cvt_pk_bf16_f32 v237, v58, v59
v_cvt_pk_bf16_f32 v238, v60, v61
v_cvt_pk_bf16_f32 v239, v62, v63
buffer_store_dwordx4 v[236:239], v3, s[4:7], s13 offen sc1
s_add_u32 s13, s13, 8192
s_waitcnt lgkmcnt(2)
v_cvt_pk_bf16_f32 v240, v64, v65
v_cvt_pk_bf16_f32 v241, v66, v67
v_cvt_pk_bf16_f32 v242, v68, v69
v_cvt_pk_bf16_f32 v243, v70, v71
buffer_store_dwordx4 v[240:243], v3, s[4:7], s13 offen sc1
s_add_u32 s13, s13, 8192
s_waitcnt lgkmcnt(0)
v_cvt_pk_bf16_f32 v244, v72, v73
v_cvt_pk_bf16_f32 v245, v74, v75
v_cvt_pk_bf16_f32 v246, v76, v77
v_cvt_pk_bf16_f32 v247, v78, v79
buffer_store_dwordx4 v[244:247], v3, s[4:7], s13 offen sc1
s_add_u32 s13, s13, 8192
s_mov_b32 s93, s21
s_cmp_lt_u32 s93, 128
s_cbranch_scc1 mega_kernel_f3_l
mega_kernel_f3_e:
s_waitcnt vmcnt(0)
s_barrier
s_mov_b32 s64, 62
s_mov_b32 s65, 63
s_add_u32 s66, s66, 262144
s_mov_b32 s67, 1
s_cmp_eq_u32 s91, 0
s_cbranch_scc1 mega_kernel_out
s_mov_b32 s64, 63
s_mov_b32 s65, 64
s_lshr_b32 s66, s40, 2
s_lshl_b32 s66, s66, 17
s_and_b32 s67, s40, 3
s_lshl_b32 s67, s67, 12
s_add_u32 s66, s66, s67
s_add_u32 s66, s66, 68272128
s_mov_b32 s67, 1
s_mov_b32 s68, 4096
s_mov_b32 s69, 0
mega_kernel_out:
s_load_dwordx2 s[4:5], s[0:1], 40
s_load_dwordx2 s[8:9], s[0:1], 80
v_lshrrev_b32 v2, 6, v0
v_and_b32 v1, 63, v0
v_readfirstlane_b32 s41, v2
v_lshlrev_b32 v5, 4, v1
s_waitcnt lgkmcnt(0)
s_mov_b32 s6, 8388608
s_mov_b32 s7, 0x00020000
s_mov_b32 s10, 8388608
s_mov_b32 s11, 0x00020000
s_and_b32 s58, s40, 1
s_lshr_b32 s59, s40, 1
s_lshl_b32 s43, s58, 22
s_lshl_b32 s44, s41, 20
s_add_u32 s43, s43, s44
s_lshl_b32 s44, s59, 7
s_add_u32 s48, s43, s44
s_and_b32 s56, s59, 7
s_lshl_b32 s56, s56, 6
v_lshrrev_b32 v2, 3, v1
v_and_b32 v3, 7, v1
v_lshlrev_b32 v16, 11, v2
v_lshl_add_u32 v16, v3, 4, v16
v_add_u32 v16, s48, v16
v_and_b32 v3, 3, v1
s_lshl_b32 s45, s41, 15
v_bfe_u32 v17, v1, 2, 2
v_lshrrev_b32 v18, 5, v1
v_mul_u32_u24 v18, 4, v18
v_add_u32 v17, v17, v18
v_lshlrev_b32 v17, 7, v17
v_bfe_u32 v18, v1, 4, 1
v_lshl_add_u32 v17, v18, 5, v17
v_lshl_add_u32 v17, v3, 3, v17
v_add_u32 v17, s45, v17
s_add_u32 m0, s45, 0
s_add_u32 s44, s56, 0
s_and_b32 s44, s44, 511
s_lshl_b32 s44, s44, 11
buffer_load_dwordx4 v16, s[4:7], s44 offen lds
s_add_u32 m0, s45, 1024
s_add_u32 s44, s56, 8
s_and_b32 s44, s44, 511
s_lshl_b32 s44, s44, 11
buffer_load_dwordx4 v16, s[4:7], s44 offen lds
s_add_u32 m0, s45, 2048
s_add_u32 s44, s56, 16
s_and_b32 s44, s44, 511
s_lshl_b32 s44, s44, 11
buffer_load_dwordx4 v16, s[4:7], s44 offen lds
s_add_u32 m0, s45, 3072
s_add_u32 s44, s56, 24
s_and_b32 s44, s44, 511
s_lshl_b32 s44, s44, 11
buffer_load_dwordx4 v16, s[4:7], s44 offen lds
s_add_u32 m0, s45, 4096
s_add_u32 s44, s56, 32
s_and_b32 s44, s44, 511
s_lshl_b32 s44, s44, 11
buffer_load_dwordx4 v16, s[4:7], s44 offen lds
s_add_u32 m0, s45, 5120
s_add_u32 s44, s56, 40
s_and_b32 s44, s44, 511
s_lshl_b32 s44, s44, 11
buffer_load_dwordx4 v16, s[4:7], s44 offen lds
s_add_u32 m0, s45, 6144
s_add_u32 s44, s56, 48
s_and_b32 s44, s44, 511
s_lshl_b32 s44, s44, 11
buffer_load_dwordx4 v16, s[4:7], s44 offen lds
s_add_u32 m0, s45, 7168
s_add_u32 s44, s56, 56
s_and_b32 s44, s44, 511
s_lshl_b32 s44, s44, 11
buffer_load_dwordx4 v16, s[4:7], s44 offen lds
s_add_u32 m0, s45, 8192
s_add_u32 s44, s56, 64
s_and_b32 s44, s44, 511
s_lshl_b32 s44, s44, 11
buffer_load_dwordx4 v16, s[4:7], s44 offen lds
s_add_u32 m0, s45, 9216
s_add_u32 s44, s56, 72
s_and_b32 s44, s44, 511
s_lshl_b32 s44, s44, 11
buffer_load_dwordx4 v16, s[4:7], s44 offen lds
s_add_u32 m0, s45, 10240
s_add_u32 s44, s56, 80
s_and_b32 s44, s44, 511
s_lshl_b32 s44, s44, 11
buffer_load_dwordx4 v16, s[4:7], s44 offen lds
s_add_u32 m0, s45, 11264
s_add_u32 s44, s56, 88
s_and_b32 s44, s44, 511
s_lshl_b32 s44, s44, 11
buffer_load_dwordx4 v16, s[4:7], s44 offen lds
s_add_u32 m0, s45, 12288
s_add_u32 s44, s56, 96
s_and_b32 s44, s44, 511
s_lshl_b32 s44, s44, 11
buffer_load_dwordx4 v16, s[4:7], s44 offen lds
s_add_u32 m0, s45, 13312
s_add_u32 s44, s56, 104
s_and_b32 s44, s44, 511
s_lshl_b32 s44, s44, 11
buffer_load_dwordx4 v16, s[4:7], s44 offen lds
s_add_u32 m0, s45, 14336
s_add_u32 s44, s56, 112
s_and_b32 s44, s44, 511
s_lshl_b32 s44, s44, 11
buffer_load_dwordx4 v16, s[4:7], s44 offen lds
s_add_u32 m0, s45, 15360
s_add_u32 s44, s56, 120
s_and_b32 s44, s44, 511
s_lshl_b32 s44, s44, 11
buffer_load_dwordx4 v16, s[4:7], s44 offen lds
s_add_u32 m0, s45, 16384
s_add_u32 s44, s56, 128
s_and_b32 s44, s44, 511
s_lshl_b32 s44, s44, 11
buffer_load_dwordx4 v16, s[4:7], s44 offen lds
s_add_u32 m0, s45, 17408
s_add_u32 s44, s56, 136
s_and_b32 s44, s44, 511
s_lshl_b32 s44, s44, 11
buffer_load_dwordx4 v16, s[4:7], s44 offen lds
s_add_u32 m0, s45, 18432
s_add_u32 s44, s56, 144
s_and_b32 s44, s44, 511
s_lshl_b32 s44, s44, 11
buffer_load_dwordx4 v16, s[4:7], s44 offen lds
s_add_u32 m0, s45, 19456
s_add_u32 s44, s56, 152
s_and_b32 s44, s44, 511
s_lshl_b32 s44, s44, 11
buffer_load_dwordx4 v16, s[4:7], s44 offen lds
s_add_u32 m0, s45, 20480
s_add_u32 s44, s56, 160
s_and_b32 s44, s44, 511
s_lshl_b32 s44, s44, 11
buffer_load_dwordx4 v16, s[4:7], s44 offen lds
s_add_u32 m0, s45, 21504
s_add_u32 s44, s56, 168
s_and_b32 s44, s44, 511
s_lshl_b32 s44, s44, 11
buffer_load_dwordx4 v16, s[4:7], s44 offen lds
s_add_u32 m0, s45, 22528
s_add_u32 s44, s56, 176
s_and_b32 s44, s44, 511
s_lshl_b32 s44, s44, 11
buffer_load_dwordx4 v16, s[4:7], s44 offen lds
s_add_u32 m0, s45, 23552
s_add_u32 s44, s56, 184
s_and_b32 s44, s44, 511
s_lshl_b32 s44, s44, 11
buffer_load_dwordx4 v16, s[4:7], s44 offen lds
s_add_u32 m0, s45, 24576
s_add_u32 s44, s56, 192
s_and_b32 s44, s44, 511
s_lshl_b32 s44, s44, 11
buffer_load_dwordx4 v16, s[4:7], s44 offen lds
s_add_u32 m0, s45, 25600
s_add_u32 s44, s56, 200
s_and_b32 s44, s44, 511
s_lshl_b32 s44, s44, 11
buffer_load_dwordx4 v16, s[4:7], s44 offen lds
s_add_u32 m0, s45, 26624
s_add_u32 s44, s56, 208
s_and_b32 s44, s44, 511
s_lshl_b32 s44, s44, 11
buffer_load_dwordx4 v16, s[4:7], s44 offen lds
s_add_u32 m0, s45, 27648
s_add_u32 s44, s56, 216
s_and_b32 s44, s44, 511
s_lshl_b32 s44, s44, 11
buffer_load_dwordx4 v16, s[4:7], s44 offen lds
s_add_u32 m0, s45, 28672
s_add_u32 s44, s56, 224
s_and_b32 s44, s44, 511
s_lshl_b32 s44, s44, 11
buffer_load_dwordx4 v16, s[4:7], s44 offen lds
s_add_u32 m0, s45, 29696
s_add_u32 s44, s56, 232
s_and_b32 s44, s44, 511
s_lshl_b32 s44, s44, 11
buffer_load_dwordx4 v16, s[4:7], s44 offen lds
s_add_u32 m0, s45, 30720
s_add_u32 s44, s56, 240
s_and_b32 s44, s44, 511
s_lshl_b32 s44, s44, 11
buffer_load_dwordx4 v16, s[4:7], s44 offen lds
s_add_u32 m0, s45, 31744
s_add_u32 s44, s56, 248
s_and_b32 s44, s44, 511
s_lshl_b32 s44, s44, 11
buffer_load_dwordx4 v16, s[4:7], s44 offen lds
s_waitcnt vmcnt(16)
ds_read_b64_tr_b16 a[0:1], v17 offset:0
ds_read_b64_tr_b16 a[2:3], v17 offset:2048
ds_read_b64_tr_b16 a[4:5], v17 offset:64
ds_read_b64_tr_b16 a[6:7], v17 offset:2112
ds_read_b64_tr_b16 a[8:9], v17 offset:1024
ds_read_b64_tr_b16 a[10:11], v17 offset:3072
ds_read_b64_tr_b16 a[12:13], v17 offset:1088
ds_read_b64_tr_b16 a[14:15], v17 offset:3136
s_waitcnt lgkmcnt(0)
ds_read_b64_tr_b16 a[16:17], v17 offset:4096
ds_read_b64_tr_b16 a[18:19], v17 offset:6144
ds_read_b64_tr_b16 a[20:21], v17 offset:4160
ds_read_b64_tr_b16 a[22:23], v17 offset:6208
ds_read_b64_tr_b16 a[24:25], v17 offset:5120
ds_read_b64_tr_b16 a[26:27], v17 offset:7168
ds_read_b64_tr_b16 a[28:29], v17 offset:5184
ds_read_b64_tr_b16 a[30:31], v17 offset:7232
s_waitcnt lgkmcnt(0)
ds_read_b64_tr_b16 a[32:33], v17 offset:8192
ds_read_b64_tr_b16 a[34:35], v17 offset:10240
ds_read_b64_tr_b16 a[36:37], v17 offset:8256
ds_read_b64_tr_b16 a[38:39], v17 offset:10304
ds_read_b64_tr_b16 a[40:41], v17 offset:9216
ds_read_b64_tr_b16 a[42:43], v17 offset:11264
ds_read_b64_tr_b16 a[44:45], v17 offset:9280
ds_read_b64_tr_b16 a[46:47], v17 offset:11328
s_waitcnt lgkmcnt(0)
ds_read_b64_tr_b16 a[48:49], v17 offset:12288
ds_read_b64_tr_b16 a[50:51], v17 offset:14336
ds_read_b64_tr_b16 a[52:53], v17 offset:12352
ds_read_b64_tr_b16 a[54:55], v17 offset:14400
ds_read_b64_tr_b16 a[56:57], v17 offset:13312
ds_read_b64_tr_b16 a[58:59], v17 offset:15360
ds_read_b64_tr_b16 a[60:61], v17 offset:13376
ds_read_b64_tr_b16 a[62:63], v17 offset:15424
s_waitcnt lgkmcnt(0)
s_add_u32 m0, s45, 0
s_add_u32 s44, s56, 256
s_and_b32 s44, s44, 511
s_lshl_b32 s44, s44, 11
buffer_load_dwordx4 v16, s[4:7], s44 offen lds
s_add_u32 m0, s45, 1024
s_add_u32 s44, s56, 264
s_and_b32 s44, s44, 511
s_lshl_b32 s44, s44, 11
buffer_load_dwordx4 v16, s[4:7], s44 offen lds
s_add_u32 m0, s45, 2048
s_add_u32 s44, s56, 272
s_and_b32 s44, s44, 511
s_lshl_b32 s44, s44, 11
buffer_load_dwordx4 v16, s[4:7], s44 offen lds
s_add_u32 m0, s45, 3072
s_add_u32 s44, s56, 280
s_and_b32 s44, s44, 511
s_lshl_b32 s44, s44, 11
buffer_load_dwordx4 v16, s[4:7], s44 offen lds
s_add_u32 m0, s45, 4096
s_add_u32 s44, s56, 288
s_and_b32 s44, s44, 511
s_lshl_b32 s44, s44, 11
buffer_load_dwordx4 v16, s[4:7], s44 offen lds
s_add_u32 m0, s45, 5120
s_add_u32 s44, s56, 296
s_and_b32 s44, s44, 511
s_lshl_b32 s44, s44, 11
buffer_load_dwordx4 v16, s[4:7], s44 offen lds
s_add_u32 m0, s45, 6144
s_add_u32 s44, s56, 304
s_and_b32 s44, s44, 511
s_lshl_b32 s44, s44, 11
buffer_load_dwordx4 v16, s[4:7], s44 offen lds
s_add_u32 m0, s45, 7168
s_add_u32 s44, s56, 312
s_and_b32 s44, s44, 511
s_lshl_b32 s44, s44, 11
buffer_load_dwordx4 v16, s[4:7], s44 offen lds
s_add_u32 m0, s45, 8192
s_add_u32 s44, s56, 320
s_and_b32 s44, s44, 511
s_lshl_b32 s44, s44, 11
buffer_load_dwordx4 v16, s[4:7], s44 offen lds
s_add_u32 m0, s45, 9216
s_add_u32 s44, s56, 328
s_and_b32 s44, s44, 511
s_lshl_b32 s44, s44, 11
buffer_load_dwordx4 v16, s[4:7], s44 offen lds
s_add_u32 m0, s45, 10240
s_add_u32 s44, s56, 336
s_and_b32 s44, s44, 511
s_lshl_b32 s44, s44, 11
buffer_load_dwordx4 v16, s[4:7], s44 offen lds
s_add_u32 m0, s45, 11264
s_add_u32 s44, s56, 344
s_and_b32 s44, s44, 511
s_lshl_b32 s44, s44, 11
buffer_load_dwordx4 v16, s[4:7], s44 offen lds
s_add_u32 m0, s45, 12288
s_add_u32 s44, s56, 352
s_and_b32 s44, s44, 511
s_lshl_b32 s44, s44, 11
buffer_load_dwordx4 v16, s[4:7], s44 offen lds
s_add_u32 m0, s45, 13312
s_add_u32 s44, s56, 360
s_and_b32 s44, s44, 511
s_lshl_b32 s44, s44, 11
buffer_load_dwordx4 v16, s[4:7], s44 offen lds
s_add_u32 m0, s45, 14336
s_add_u32 s44, s56, 368
s_and_b32 s44, s44, 511
s_lshl_b32 s44, s44, 11
buffer_load_dwordx4 v16, s[4:7], s44 offen lds
s_add_u32 m0, s45, 15360
s_add_u32 s44, s56, 376
s_and_b32 s44, s44, 511
s_lshl_b32 s44, s44, 11
buffer_load_dwordx4 v16, s[4:7], s44 offen lds
s_waitcnt vmcnt(16)
ds_read_b64_tr_b16 a[64:65], v17 offset:16384
ds_read_b64_tr_b16 a[66:67], v17 offset:18432
ds_read_b64_tr_b16 a[68:69], v17 offset:16448
ds_read_b64_tr_b16 a[70:71], v17 offset:18496
ds_read_b64_tr_b16 a[72:73], v17 offset:17408
ds_read_b64_tr_b16 a[74:75], v17 offset:19456
ds_read_b64_tr_b16 a[76:77], v17 offset:17472
ds_read_b64_tr_b16 a[78:79], v17 offset:19520
s_waitcnt lgkmcnt(0)
ds_read_b64_tr_b16 a[80:81], v17 offset:20480
ds_read_b64_tr_b16 a[82:83], v17 offset:22528
ds_read_b64_tr_b16 a[84:85], v17 offset:20544
ds_read_b64_tr_b16 a[86:87], v17 offset:22592
ds_read_b64_tr_b16 a[88:89], v17 offset:21504
ds_read_b64_tr_b16 a[90:91], v17 offset:23552
ds_read_b64_tr_b16 a[92:93], v17 offset:21568
ds_read_b64_tr_b16 a[94:95], v17 offset:23616
s_waitcnt lgkmcnt(0)
ds_read_b64_tr_b16 a[96:97], v17 offset:24576
ds_read_b64_tr_b16 a[98:99], v17 offset:26624
ds_read_b64_tr_b16 a[100:101], v17 offset:24640
ds_read_b64_tr_b16 a[102:103], v17 offset:26688
ds_read_b64_tr_b16 a[104:105], v17 offset:25600
ds_read_b64_tr_b16 a[106:107], v17 offset:27648
ds_read_b64_tr_b16 a[108:109], v17 offset:25664
ds_read_b64_tr_b16 a[110:111], v17 offset:27712
s_waitcnt lgkmcnt(0)
ds_read_b64_tr_b16 a[112:113], v17 offset:28672
ds_read_b64_tr_b16 a[114:115], v17 offset:30720
ds_read_b64_tr_b16 a[116:117], v17 offset:28736
ds_read_b64_tr_b16 a[118:119], v17 offset:30784
ds_read_b64_tr_b16 a[120:121], v17 offset:29696
ds_read_b64_tr_b16 a[122:123], v17 offset:31744
ds_read_b64_tr_b16 a[124:125], v17 offset:29760
ds_read_b64_tr_b16 a[126:127], v17 offset:31808
s_waitcnt lgkmcnt(0)
s_add_u32 m0, s45, 16384
s_add_u32 s44, s56, 384
s_and_b32 s44, s44, 511
s_lshl_b32 s44, s44, 11
buffer_load_dwordx4 v16, s[4:7], s44 offen lds
s_add_u32 m0, s45, 17408
s_add_u32 s44, s56, 392
s_and_b32 s44, s44, 511
s_lshl_b32 s44, s44, 11
buffer_load_dwordx4 v16, s[4:7], s44 offen lds
s_add_u32 m0, s45, 18432
s_add_u32 s44, s56, 400
s_and_b32 s44, s44, 511
s_lshl_b32 s44, s44, 11
buffer_load_dwordx4 v16, s[4:7], s44 offen lds
s_add_u32 m0, s45, 19456
s_add_u32 s44, s56, 408
s_and_b32 s44, s44, 511
s_lshl_b32 s44, s44, 11
buffer_load_dwordx4 v16, s[4:7], s44 offen lds
s_add_u32 m0, s45, 20480
s_add_u32 s44, s56, 416
s_and_b32 s44, s44, 511
s_lshl_b32 s44, s44, 11
buffer_load_dwordx4 v16, s[4:7], s44 offen lds
s_add_u32 m0, s45, 21504
s_add_u32 s44, s56, 424
s_and_b32 s44, s44, 511
s_lshl_b32 s44, s44, 11
buffer_load_dwordx4 v16, s[4:7], s44 offen lds
s_add_u32 m0, s45, 22528
s_add_u32 s44, s56, 432
s_and_b32 s44, s44, 511
s_lshl_b32 s44, s44, 11
buffer_load_dwordx4 v16, s[4:7], s44 offen lds
s_add_u32 m0, s45, 23552
s_add_u32 s44, s56, 440
s_and_b32 s44, s44, 511
s_lshl_b32 s44, s44, 11
buffer_load_dwordx4 v16, s[4:7], s44 offen lds
s_add_u32 m0, s45, 24576
s_add_u32 s44, s56, 448
s_and_b32 s44, s44, 511
s_lshl_b32 s44, s44, 11
buffer_load_dwordx4 v16, s[4:7], s44 offen lds
s_add_u32 m0, s45, 25600
s_add_u32 s44, s56, 456
s_and_b32 s44, s44, 511
s_lshl_b32 s44, s44, 11
buffer_load_dwordx4 v16, s[4:7], s44 offen lds
s_add_u32 m0, s45, 26624
s_add_u32 s44, s56, 464
s_and_b32 s44, s44, 511
s_lshl_b32 s44, s44, 11
buffer_load_dwordx4 v16, s[4:7], s44 offen lds
s_add_u32 m0, s45, 27648
s_add_u32 s44, s56, 472
s_and_b32 s44, s44, 511
s_lshl_b32 s44, s44, 11
buffer_load_dwordx4 v16, s[4:7], s44 offen lds
s_add_u32 m0, s45, 28672
s_add_u32 s44, s56, 480
s_and_b32 s44, s44, 511
s_lshl_b32 s44, s44, 11
buffer_load_dwordx4 v16, s[4:7], s44 offen lds
s_add_u32 m0, s45, 29696
s_add_u32 s44, s56, 488
s_and_b32 s44, s44, 511
s_lshl_b32 s44, s44, 11
buffer_load_dwordx4 v16, s[4:7], s44 offen lds
s_add_u32 m0, s45, 30720
s_add_u32 s44, s56, 496
s_and_b32 s44, s44, 511
s_lshl_b32 s44, s44, 11
buffer_load_dwordx4 v16, s[4:7], s44 offen lds
s_add_u32 m0, s45, 31744
s_add_u32 s44, s56, 504
s_and_b32 s44, s44, 511
s_lshl_b32 s44, s44, 11
buffer_load_dwordx4 v16, s[4:7], s44 offen lds
s_waitcnt vmcnt(16)
ds_read_b64_tr_b16 a[128:129], v17 offset:0
ds_read_b64_tr_b16 a[130:131], v17 offset:2048
ds_read_b64_tr_b16 a[132:133], v17 offset:64
ds_read_b64_tr_b16 a[134:135], v17 offset:2112
ds_read_b64_tr_b16 a[136:137], v17 offset:1024
ds_read_b64_tr_b16 a[138:139], v17 offset:3072
ds_read_b64_tr_b16 a[140:141], v17 offset:1088
ds_read_b64_tr_b16 a[142:143], v17 offset:3136
s_waitcnt lgkmcnt(0)
ds_read_b64_tr_b16 a[144:145], v17 offset:4096
ds_read_b64_tr_b16 a[146:147], v17 offset:6144
ds_read_b64_tr_b16 a[148:149], v17 offset:4160
ds_read_b64_tr_b16 a[150:151], v17 offset:6208
ds_read_b64_tr_b16 a[152:153], v17 offset:5120
ds_read_b64_tr_b16 a[154:155], v17 offset:7168
ds_read_b64_tr_b16 a[156:157], v17 offset:5184
ds_read_b64_tr_b16 a[158:159], v17 offset:7232
s_waitcnt lgkmcnt(0)
ds_read_b64_tr_b16 a[160:161], v17 offset:8192
ds_read_b64_tr_b16 a[162:163], v17 offset:10240
ds_read_b64_tr_b16 a[164:165], v17 offset:8256
ds_read_b64_tr_b16 a[166:167], v17 offset:10304
ds_read_b64_tr_b16 a[168:169], v17 offset:9216
ds_read_b64_tr_b16 a[170:171], v17 offset:11264
ds_read_b64_tr_b16 a[172:173], v17 offset:9280
ds_read_b64_tr_b16 a[174:175], v17 offset:11328
s_waitcnt lgkmcnt(0)
ds_read_b64_tr_b16 a[176:177], v17 offset:12288
ds_read_b64_tr_b16 a[178:179], v17 offset:14336
ds_read_b64_tr_b16 a[180:181], v17 offset:12352
ds_read_b64_tr_b16 a[182:183], v17 offset:14400
ds_read_b64_tr_b16 a[184:185], v17 offset:13312
ds_read_b64_tr_b16 a[186:187], v17 offset:15360
ds_read_b64_tr_b16 a[188:189], v17 offset:13376
ds_read_b64_tr_b16 a[190:191], v17 offset:15424
s_waitcnt lgkmcnt(0)
s_waitcnt vmcnt(0)
ds_read_b64_tr_b16 a[192:193], v17 offset:16384
ds_read_b64_tr_b16 a[194:195], v17 offset:18432
ds_read_b64_tr_b16 a[196:197], v17 offset:16448
ds_read_b64_tr_b16 a[198:199], v17 offset:18496
ds_read_b64_tr_b16 a[200:201], v17 offset:17408
ds_read_b64_tr_b16 a[202:203], v17 offset:19456
ds_read_b64_tr_b16 a[204:205], v17 offset:17472
ds_read_b64_tr_b16 a[206:207], v17 offset:19520
s_waitcnt lgkmcnt(0)
ds_read_b64_tr_b16 a[208:209], v17 offset:20480
ds_read_b64_tr_b16 a[210:211], v17 offset:22528
ds_read_b64_tr_b16 a[212:213], v17 offset:20544
ds_read_b64_tr_b16 a[214:215], v17 offset:22592
ds_read_b64_tr_b16 a[216:217], v17 offset:21504
ds_read_b64_tr_b16 a[218:219], v17 offset:23552
ds_read_b64_tr_b16 a[220:221], v17 offset:21568
ds_read_b64_tr_b16 a[222:223], v17 offset:23616
s_waitcnt lgkmcnt(0)
ds_read_b64_tr_b16 a[224:225], v17 offset:24576
ds_read_b64_tr_b16 a[226:227], v17 offset:26624
ds_read_b64_tr_b16 a[228:229], v17 offset:24640
ds_read_b64_tr_b16 a[230:231], v17 offset:26688
ds_read_b64_tr_b16 a[232:233], v17 offset:25600
ds_read_b64_tr_b16 a[234:235], v17 offset:27648
ds_read_b64_tr_b16 a[236:237], v17 offset:25664
ds_read_b64_tr_b16 a[238:239], v17 offset:27712
s_waitcnt lgkmcnt(0)
ds_read_b64_tr_b16 a[240:241], v17 offset:28672
ds_read_b64_tr_b16 a[242:243], v17 offset:30720
ds_read_b64_tr_b16 a[244:245], v17 offset:28736
ds_read_b64_tr_b16 a[246:247], v17 offset:30784
ds_read_b64_tr_b16 a[248:249], v17 offset:29696
ds_read_b64_tr_b16 a[250:251], v17 offset:31744
ds_read_b64_tr_b16 a[252:253], v17 offset:29760
ds_read_b64_tr_b16 a[254:255], v17 offset:31808
s_waitcnt lgkmcnt(0)
s_barrier
s_lshl_b32 s56, s56, 6
s_lshl_b32 s43, s58, 17
s_lshl_b32 s44, s41, 15
s_add_u32 s43, s43, s44
s_add_u32 s43, s43, 134217728
v_add_u32 v6, s43, v5
v_and_b32 v2, 3, v1
v_lshlrev_b32 v7, 2, v2
v_bfe_u32 v2, v1, 2, 2
v_lshl_add_u32 v7, v2, 7, v7
s_lshl_b32 s43, s58, 11
s_lshl_b32 s44, s41, 9
s_add_u32 s43, s43, s44
s_lshl_b32 s44, s98, 13
s_add_u32 s43, s43, s44
s_add_u32 s43, s43, 69255168
v_add_u32 v7, s43, v7
s_mul_i32 s43, s41, 8704
v_lshrrev_b32 v2, 5, v1
v_lshl_add_u32 v8, v2, 5, v5
v_add_u32 v8, s43, v8
v_and_b32 v2, 7, v1
v_mul_u32_u24 v9, 544, v2
v_lshrrev_b32 v3, 3, v1
v_lshl_add_u32 v9, v3, 4, v9
s_lshl_b32 s43, s41, 7
v_add_u32 v9, s43, v9
s_mul_i32 s43, s58, 4352
s_sub_u32 s44, 4352, s43
v_add_u32 v10, s44, v9
v_add_u32 v9, s43, v9
s_lshl_b32 s43, s41, 15
s_lshl_b32 s44, s40, 6
s_add_u32 s43, s43, s44
v_lshlrev_b32 v11, 12, v3
v_and_b32 v2, 7, v1
v_lshl_add_u32 v11, v2, 3, v11
v_add_u32 v11, s43, v11
s_lshl_b32 s44, s41, 10
s_add_u32 s43, s66, s44
v_add_u32 v13, s43, v5
v_xor_b32 v12, s68, v13
s_mov_b32 s42, s64
s_mov_b32 s52, 0
s_mov_b32 s53, 0
s_mov_b32 s57, 0
s_mov_b32 s71, 1
s_cmp_eq_u32 s64, 0
s_cbranch_scc1 mega_kernel_o_nodry
s_mov_b32 s71, 0
s_mov_b32 s42, 0
s_mov_b32 s70, s65
s_mov_b32 s65, 1
v_mov_b32 v16, v12
v_mov_b32 v17, v11
v_mov_b32 v12, -16
v_mov_b32 v11, -16
mega_kernel_o_nodry:
mega_kernel_o_cold:
s_cmp_gt_i32 s52, s42
s_cbranch_scc1 mega_kernel_o_fk
mega_kernel_o_fw:
buffer_load_dword v2, v7, s[84:87], 0 offen sc1
s_waitcnt vmcnt(0)
v_min_i32_dpp v2, v2, v2 quad_perm:[1,0,3,2] row_mask:0xf bank_mask:0xf
s_nop 1
v_min_i32_dpp v2, v2, v2 quad_perm:[2,3,0,1] row_mask:0xf bank_mask:0xf
s_nop 1
v_min_i32_dpp v2, v2, v2 row_ror:4 row_mask:0xf bank_mask:0xf
s_nop 1
v_min_i32_dpp v2, v2, v2 row_ror:8 row_mask:0xf bank_mask:0xf
s_nop 0
v_readfirstlane_b32 s52, v2
s_min_i32 s52, s52, s65
s_cmp_gt_i32 s52, s42
s_cbranch_scc1 mega_kernel_o_fk
s_sleep 2
s_add_u32 s43, s52, 2
s_cmp_gt_i32 s43, s42
s_cbranch_scc1 mega_kernel_o_fw
s_sleep 48
s_branch mega_kernel_o_fw
mega_kernel_o_fk:
s_add_u32 s54, s42, 1
s_cmp_gt_i32 s52, s54
s_cbranch_scc0 mega_kernel_o_c0
s_lshl_b32 s50, s42, 18
s_add_u32 s51, s56, 0
s_and_b32 s51, s51, 0x7fff
s_add_u32 s51, s51, s50
buffer_load_dwordx4 v[96:99], v6, s[84:87], s51 offen offset:0 sc1
buffer_load_dwordx4 v[100:103], v6, s[84:87], s51 offen offset:1024 sc1
buffer_load_dwordx4 v[104:107], v6, s[84:87], s51 offen offset:2048 sc1
buffer_load_dwordx4 v[108:111], v6, s[84:87], s51 offen offset:3072 sc1
s_add_u32 s51, s56, 4096
s_and_b32 s51, s51, 0x7fff
s_add_u32 s51, s51, s50
buffer_load_dwordx4 v[112:115], v6, s[84:87], s51 offen offset:0 sc1
buffer_load_dwordx4 v[116:119], v6, s[84:87], s51 offen offset:1024 sc1
buffer_load_dwordx4 v[120:123], v6, s[84:87], s51 offen offset:2048 sc1
buffer_load_dwordx4 v[124:127], v6, s[84:87], s51 offen offset:3072 sc1
s_add_u32 s51, s56, 8192
s_and_b32 s51, s51, 0x7fff
s_add_u32 s51, s51, s50
buffer_load_dwordx4 v[128:131], v6, s[84:87], s51 offen offset:0 sc1
buffer_load_dwordx4 v[132:135], v6, s[84:87], s51 offen offset:1024 sc1
buffer_load_dwordx4 v[136:139], v6, s[84:87], s51 offen offset:2048 sc1
buffer_load_dwordx4 v[140:143], v6, s[84:87], s51 offen offset:3072 sc1
s_add_u32 s51, s56, 12288
s_and_b32 s51, s51, 0x7fff
s_add_u32 s51, s51, s50
buffer_load_dwordx4 v[144:147], v6, s[84:87], s51 offen offset:0 sc1
buffer_load_dwordx4 v[148:151], v6, s[84:87], s51 offen offset:1024 sc1
buffer_load_dwordx4 v[152:155], v6, s[84:87], s51 offen offset:2048 sc1
buffer_load_dwordx4 v[156:159], v6, s[84:87], s51 offen offset:3072 sc1
s_add_u32 s51, s56, 16384
s_and_b32 s51, s51, 0x7fff
s_add_u32 s51, s51, s50
buffer_load_dwordx4 v[160:163], v6, s[84:87], s51 offen offset:0 sc1
buffer_load_dwordx4 v[164:167], v6, s[84:87], s51 offen offset:1024 sc1
buffer_load_dwordx4 v[168:171], v6, s[84:87], s51 offen offset:2048 sc1
buffer_load_dwordx4 v[172:175], v6, s[84:87], s51 offen offset:3072 sc1
s_add_u32 s51, s56, 20480
s_and_b32 s51, s51, 0x7fff
s_add_u32 s51, s51, s50
buffer_load_dwordx4 v[176:179], v6, s[84:87], s51 offen offset:0 sc1
buffer_load_dwordx4 v[180:183], v6, s[84:87], s51 offen offset:1024 sc1
buffer_load_dwordx4 v[184:187], v6, s[84:87], s51 offen offset:2048 sc1
buffer_load_dwordx4 v[188:191], v6, s[84:87], s51 offen offset:3072 sc1
s_add_u32 s51, s56, 24576
s_and_b32 s51, s51, 0x7fff
s_add_u32 s51, s51, s50
buffer_load_dwordx4 v[192:195], v6, s[84:87], s51 offen offset:0 sc1
buffer_load_dwordx4 v[196:199], v6, s[84:87], s51 offen offset:1024 sc1
buffer_load_dwordx4 v[200:203], v6, s[84:87], s51 offen offset:2048 sc1
buffer_load_dwordx4 v[204:207], v6, s[84:87], s51 offen offset:3072 sc1
s_add_u32 s51, s56, 28672
s_and_b32 s51, s51, 0x7fff
s_add_u32 s51, s51, s50
buffer_load_dwordx4 v[208:211], v6, s[84:87], s51 offen offset:0 sc1
buffer_load_dwordx4 v[212:215], v6, s[84:87], s51 offen offset:1024 sc1
buffer_load_dwordx4 v[216:219], v6, s[84:87], s51 offen offset:2048 sc1
buffer_load_dwordx4 v[220:223], v6, s[84:87], s51 offen offset:3072 sc1
mega_kernel_o_w0:
s_add_u32 s54, s42, 1
s_sub_u32 s62, s42, 1
s_lshl_b32 s50, s54, 18
s_cmp_gt_i32 s52, s54
s_cbranch_scc0 mega_kernel_o_n0
s_waitcnt vmcnt(31)
v_mfma_f32_32x32x16_bf16 v[20:35], a[0:3], v[96:99], 0
v_mfma_f32_32x32x16_bf16 v[36:51], a[4:7], v[96:99], 0
s_add_u32 s51, s56, 0
s_and_b32 s51, s51, 0x7fff
s_add_u32 s51, s51, s50
buffer_load_dwordx4 v[96:99], v6, s[84:87], s51 offen offset:0 sc1
s_waitcnt vmcnt(31)
v_mfma_f32_32x32x16_bf16 v[20:35], a[8:11], v[100:103], v[20:35]
v_mfma_f32_32x32x16_bf16 v[36:51], a[12:15], v[100:103], v[36:51]
buffer_load_dwordx4 v[100:103], v6, s[84:87], s51 offen offset:1024 sc1
s_waitcnt vmcnt(31)
v_mfma_f32_32x32x16_bf16 v[20:35], a[16:19], v[104:107], v[20:35]
v_mfma_f32_32x32x16_bf16 v[36:51], a[20:23], v[104:107], v[36:51]
buffer_load_dwordx4 v[104:107], v6, s[84:87], s51 offen offset:2048 sc1
s_waitcnt vmcnt(31)
v_mfma_f32_32x32x16_bf16 v[20:35], a[24:27], v[108:111], v[20:35]
v_mfma_f32_32x32x16_bf16 v[36:51], a[28:31], v[108:111], v[36:51]
buffer_load_dwordx4 v[108:111], v6, s[84:87], s51 offen offset:3072 sc1
s_waitcnt vmcnt(31)
v_mfma_f32_32x32x16_bf16 v[20:35], a[32:35], v[112:115], v[20:35]
v_mfma_f32_32x32x16_bf16 v[36:51], a[36:39], v[112:115], v[36:51]
s_add_u32 s51, s56, 4096
s_and_b32 s51, s51, 0x7fff
s_add_u32 s51, s51, s50
buffer_load_dwordx4 v[112:115], v6, s[84:87], s51 offen offset:0 sc1
s_waitcnt vmcnt(31)
v_mfma_f32_32x32x16_bf16 v[20:35], a[40:43], v[116:119], v[20:35]
v_mfma_f32_32x32x16_bf16 v[36:51], a[44:47], v[116:119], v[36:51]
buffer_load_dwordx4 v[116:119], v6, s[84:87], s51 offen offset:1024 sc1
s_waitcnt vmcnt(31)
v_mfma_f32_32x32x16_bf16 v[20:35], a[48:51], v[120:123], v[20:35]
v_mfma_f32_32x32x16_bf16 v[36:51], a[52:55], v[120:123], v[36:51]
buffer_load_dwordx4 v[120:123], v6, s[84:87], s51 offen offset:2048 sc1
s_waitcnt vmcnt(31)
v_mfma_f32_32x32x16_bf16 v[20:35], a[56:59], v[124:127], v[20:35]
v_mfma_f32_32x32x16_bf16 v[36:51], a[60:63], v[124:127], v[36:51]
buffer_load_dwordx4 v[124:127], v6, s[84:87], s51 offen offset:3072 sc1
s_waitcnt vmcnt(31)
v_mfma_f32_32x32x16_bf16 v[20:35], a[64:67], v[128:131], v[20:35]
v_mfma_f32_32x32x16_bf16 v[36:51], a[68:71], v[128:131], v[36:51]
s_add_u32 s51, s56, 8192
s_and_b32 s51, s51, 0x7fff
s_add_u32 s51, s51, s50
buffer_load_dwordx4 v[128:131], v6, s[84:87], s51 offen offset:0 sc1
s_waitcnt vmcnt(31)
v_mfma_f32_32x32x16_bf16 v[20:35], a[72:75], v[132:135], v[20:35]
v_mfma_f32_32x32x16_bf16 v[36:51], a[76:79], v[132:135], v[36:51]
buffer_load_dwordx4 v[132:135], v6, s[84:87], s51 offen offset:1024 sc1
s_waitcnt vmcnt(31)
v_mfma_f32_32x32x16_bf16 v[20:35], a[80:83], v[136:139], v[20:35]
v_mfma_f32_32x32x16_bf16 v[36:51], a[84:87], v[136:139], v[36:51]
buffer_load_dwordx4 v[136:139], v6, s[84:87], s51 offen offset:2048 sc1
s_waitcnt vmcnt(31)
v_mfma_f32_32x32x16_bf16 v[20:35], a[88:91], v[140:143], v[20:35]
v_mfma_f32_32x32x16_bf16 v[36:51], a[92:95], v[140:143], v[36:51]
buffer_load_dwordx4 v[140:143], v6, s[84:87], s51 offen offset:3072 sc1
s_waitcnt vmcnt(31)
v_mfma_f32_32x32x16_bf16 v[20:35], a[96:99], v[144:147], v[20:35]
v_mfma_f32_32x32x16_bf16 v[36:51], a[100:103], v[144:147], v[36:51]
s_add_u32 s51, s56, 12288
s_and_b32 s51, s51, 0x7fff
s_add_u32 s51, s51, s50
buffer_load_dwordx4 v[144:147], v6, s[84:87], s51 offen offset:0 sc1
s_waitcnt vmcnt(31)
v_mfma_f32_32x32x16_bf16 v[20:35], a[104:107], v[148:151], v[20:35]
v_mfma_f32_32x32x16_bf16 v[36:51], a[108:111], v[148:151], v[36:51]
buffer_load_dwordx4 v[148:151], v6, s[84:87], s51 offen offset:1024 sc1
s_waitcnt vmcnt(31)
v_mfma_f32_32x32x16_bf16 v[20:35], a[112:115], v[152:155], v[20:35]
v_mfma_f32_32x32x16_bf16 v[36:51], a[116:119], v[152:155], v[36:51]
buffer_load_dwordx4 v[152:155], v6, s[84:87], s51 offen offset:2048 sc1
s_waitcnt vmcnt(31)
v_mfma_f32_32x32x16_bf16 v[20:35], a[120:123], v[156:159], v[20:35]
v_mfma_f32_32x32x16_bf16 v[36:51], a[124:127], v[156:159], v[36:51]
buffer_load_dwordx4 v[156:159], v6, s[84:87], s51 offen offset:3072 sc1
s_waitcnt vmcnt(31)
v_mfma_f32_32x32x16_bf16 v[20:35], a[128:131], v[160:163], v[20:35]
v_mfma_f32_32x32x16_bf16 v[36:51], a[132:135], v[160:163], v[36:51]
s_add_u32 s51, s56, 16384
s_and_b32 s51, s51, 0x7fff
s_add_u32 s51, s51, s50
buffer_load_dwordx4 v[160:163], v6, s[84:87], s51 offen offset:0 sc1
s_waitcnt vmcnt(31)
v_mfma_f32_32x32x16_bf16 v[20:35], a[136:139], v[164:167], v[20:35]
v_mfma_f32_32x32x16_bf16 v[36:51], a[140:143], v[164:167], v[36:51]
buffer_load_dwordx4 v[164:167], v6, s[84:87], s51 offen offset:1024 sc1
s_waitcnt vmcnt(31)
v_mfma_f32_32x32x16_bf16 v[20:35], a[144:147], v[168:171], v[20:35]
v_mfma_f32_32x32x16_bf16 v[36:51], a[148:151], v[168:171], v[36:51]
buffer_load_dwordx4 v[168:171], v6, s[84:87], s51 offen offset:2048 sc1
s_waitcnt vmcnt(31)
v_mfma_f32_32x32x16_bf16 v[20:35], a[152:155], v[172:175], v[20:35]
v_mfma_f32_32x32x16_bf16 v[36:51], a[156:159], v[172:175], v[36:51]
buffer_load_dwordx4 v[172:175], v6, s[84:87], s51 offen offset:3072 sc1
s_waitcnt vmcnt(31)
v_mfma_f32_32x32x16_bf16 v[20:35], a[160:163], v[176:179], v[20:35]
v_mfma_f32_32x32x16_bf16 v[36:51], a[164:167], v[176:179], v[36:51]
s_add_u32 s51, s56, 20480
s_and_b32 s51, s51, 0x7fff
s_add_u32 s51, s51, s50
buffer_load_dwordx4 v[176:179], v6, s[84:87], s51 offen offset:0 sc1
s_waitcnt vmcnt(31)
v_mfma_f32_32x32x16_bf16 v[20:35], a[168:171], v[180:183], v[20:35]
v_mfma_f32_32x32x16_bf16 v[36:51], a[172:175], v[180:183], v[36:51]
buffer_load_dwordx4 v[180:183], v6, s[84:87], s51 offen offset:1024 sc1
s_waitcnt vmcnt(31)
v_mfma_f32_32x32x16_bf16 v[20:35], a[176:179], v[184:187], v[20:35]
v_mfma_f32_32x32x16_bf16 v[36:51], a[180:183], v[184:187], v[36:51]
buffer_load_dwordx4 v[184:187], v6, s[84:87], s51 offen offset:2048 sc1
s_waitcnt vmcnt(31)
v_mfma_f32_32x32x16_bf16 v[20:35], a[184:187], v[188:191], v[20:35]
v_mfma_f32_32x32x16_bf16 v[36:51], a[188:191], v[188:191], v[36:51]
buffer_load_dwordx4 v[188:191], v6, s[84:87], s51 offen offset:3072 sc1
s_waitcnt vmcnt(31)
v_mfma_f32_32x32x16_bf16 v[20:35], a[192:195], v[192:195], v[20:35]
v_mfma_f32_32x32x16_bf16 v[36:51], a[196:199], v[192:195], v[36:51]
s_add_u32 s51, s56, 24576
s_and_b32 s51, s51, 0x7fff
s_add_u32 s51, s51, s50
buffer_load_dwordx4 v[192:195], v6, s[84:87], s51 offen offset:0 sc1
s_waitcnt vmcnt(31)
v_mfma_f32_32x32x16_bf16 v[20:35], a[200:203], v[196:199], v[20:35]
v_mfma_f32_32x32x16_bf16 v[36:51], a[204:207], v[196:199], v[36:51]
buffer_load_dwordx4 v[196:199], v6, s[84:87], s51 offen offset:1024 sc1
s_waitcnt vmcnt(31)
v_mfma_f32_32x32x16_bf16 v[20:35], a[208:211], v[200:203], v[20:35]
v_mfma_f32_32x32x16_bf16 v[36:51], a[212:215], v[200:203], v[36:51]
buffer_load_dwordx4 v[200:203], v6, s[84:87], s51 offen offset:2048 sc1
s_waitcnt vmcnt(31)
v_mfma_f32_32x32x16_bf16 v[20:35], a[216:219], v[204:207], v[20:35]
v_mfma_f32_32x32x16_bf16 v[36:51], a[220:223], v[204:207], v[36:51]
buffer_load_dwordx4 v[204:207], v6, s[84:87], s51 offen offset:3072 sc1
s_waitcnt vmcnt(31)
v_mfma_f32_32x32x16_bf16 v[20:35], a[224:227], v[208:211], v[20:35]
v_mfma_f32_32x32x16_bf16 v[36:51], a[228:231], v[208:211], v[36:51]
s_add_u32 s51, s56, 28672
s_and_b32 s51, s51, 0x7fff
s_add_u32 s51, s51, s50
buffer_load_dwordx4 v[208:211], v6, s[84:87], s51 offen offset:0 sc1
s_waitcnt vmcnt(31)
v_mfma_f32_32x32x16_bf16 v[20:35], a[232:235], v[212:215], v[20:35]
v_mfma_f32_32x32x16_bf16 v[36:51], a[236:239], v[212:215], v[36:51]
buffer_load_dwordx4 v[212:215], v6, s[84:87], s51 offen offset:1024 sc1
s_waitcnt vmcnt(31)
v_mfma_f32_32x32x16_bf16 v[20:35], a[240:243], v[216:219], v[20:35]
v_mfma_f32_32x32x16_bf16 v[36:51], a[244:247], v[216:219], v[36:51]
buffer_load_dwordx4 v[216:219], v6, s[84:87], s51 offen offset:2048 sc1
s_waitcnt vmcnt(31)
v_mfma_f32_32x32x16_bf16 v[224:239], a[248:251], v[220:223], v[20:35]
v_mfma_f32_32x32x16_bf16 v[240:255], a[252:255], v[220:223], v[36:51]
buffer_load_dwordx4 v[220:223], v6, s[84:87], s51 offen offset:3072 sc1
s_add_u32 s42, s42, 1
s_branch mega_kernel_o_w1
mega_kernel_o_n0:
s_waitcnt vmcnt(31)
v_mfma_f32_32x32x16_bf16 v[20:35], a[0:3], v[96:99], 0
v_mfma_f32_32x32x16_bf16 v[36:51], a[4:7], v[96:99], 0
s_waitcnt vmcnt(30)
v_mfma_f32_32x32x16_bf16 v[20:35], a[8:11], v[100:103], v[20:35]
v_mfma_f32_32x32x16_bf16 v[36:51], a[12:15], v[100:103], v[36:51]
s_waitcnt vmcnt(29)
v_mfma_f32_32x32x16_bf16 v[20:35], a[16:19], v[104:107], v[20:35]
v_mfma_f32_32x32x16_bf16 v[36:51], a[20:23], v[104:107], v[36:51]
s_waitcnt vmcnt(28)
v_mfma_f32_32x32x16_bf16 v[20:35], a[24:27], v[108:111], v[20:35]
v_mfma_f32_32x32x16_bf16 v[36:51], a[28:31], v[108:111], v[36:51]
s_waitcnt vmcnt(27)
v_mfma_f32_32x32x16_bf16 v[20:35], a[32:35], v[112:115], v[20:35]
v_mfma_f32_32x32x16_bf16 v[36:51], a[36:39], v[112:115], v[36:51]
s_waitcnt vmcnt(26)
v_mfma_f32_32x32x16_bf16 v[20:35], a[40:43], v[116:119], v[20:35]
v_mfma_f32_32x32x16_bf16 v[36:51], a[44:47], v[116:119], v[36:51]
s_waitcnt vmcnt(25)
v_mfma_f32_32x32x16_bf16 v[20:35], a[48:51], v[120:123], v[20:35]
v_mfma_f32_32x32x16_bf16 v[36:51], a[52:55], v[120:123], v[36:51]
s_waitcnt vmcnt(24)
v_mfma_f32_32x32x16_bf16 v[20:35], a[56:59], v[124:127], v[20:35]
v_mfma_f32_32x32x16_bf16 v[36:51], a[60:63], v[124:127], v[36:51]
s_waitcnt vmcnt(23)
v_mfma_f32_32x32x16_bf16 v[20:35], a[64:67], v[128:131], v[20:35]
v_mfma_f32_32x32x16_bf16 v[36:51], a[68:71], v[128:131], v[36:51]
s_waitcnt vmcnt(22)
v_mfma_f32_32x32x16_bf16 v[20:35], a[72:75], v[132:135], v[20:35]
v_mfma_f32_32x32x16_bf16 v[36:51], a[76:79], v[132:135], v[36:51]
s_waitcnt vmcnt(21)
v_mfma_f32_32x32x16_bf16 v[20:35], a[80:83], v[136:139], v[20:35]
v_mfma_f32_32x32x16_bf16 v[36:51], a[84:87], v[136:139], v[36:51]
s_waitcnt vmcnt(20)
v_mfma_f32_32x32x16_bf16 v[20:35], a[88:91], v[140:143], v[20:35]
v_mfma_f32_32x32x16_bf16 v[36:51], a[92:95], v[140:143], v[36:51]
s_waitcnt vmcnt(19)
v_mfma_f32_32x32x16_bf16 v[20:35], a[96:99], v[144:147], v[20:35]
v_mfma_f32_32x32x16_bf16 v[36:51], a[100:103], v[144:147], v[36:51]
s_waitcnt vmcnt(18)
v_mfma_f32_32x32x16_bf16 v[20:35], a[104:107], v[148:151], v[20:35]
v_mfma_f32_32x32x16_bf16 v[36:51], a[108:111], v[148:151], v[36:51]
s_waitcnt vmcnt(17)
v_mfma_f32_32x32x16_bf16 v[20:35], a[112:115], v[152:155], v[20:35]
v_mfma_f32_32x32x16_bf16 v[36:51], a[116:119], v[152:155], v[36:51]
s_waitcnt vmcnt(16)
v_mfma_f32_32x32x16_bf16 v[20:35], a[120:123], v[156:159], v[20:35]
v_mfma_f32_32x32x16_bf16 v[36:51], a[124:127], v[156:159], v[36:51]
s_waitcnt vmcnt(15)
v_mfma_f32_32x32x16_bf16 v[20:35], a[128:131], v[160:163], v[20:35]
v_mfma_f32_32x32x16_bf16 v[36:51], a[132:135], v[160:163], v[36:51]
s_waitcnt vmcnt(14)
v_mfma_f32_32x32x16_bf16 v[20:35], a[136:139], v[164:167], v[20:35]
v_mfma_f32_32x32x16_bf16 v[36:51], a[140:143], v[164:167], v[36:51]
s_waitcnt vmcnt(13)
v_mfma_f32_32x32x16_bf16 v[20:35], a[144:147], v[168:171], v[20:35]
v_mfma_f32_32x32x16_bf16 v[36:51], a[148:151], v[168:171], v[36:51]
s_waitcnt vmcnt(12)
v_mfma_f32_32x32x16_bf16 v[20:35], a[152:155], v[172:175], v[20:35]
v_mfma_f32_32x32x16_bf16 v[36:51], a[156:159], v[172:175], v[36:51]
s_waitcnt vmcnt(11)
v_mfma_f32_32x32x16_bf16 v[20:35], a[160:163], v[176:179], v[20:35]
v_mfma_f32_32x32x16_bf16 v[36:51], a[164:167], v[176:179], v[36:51]
buffer_load_dword v15, v7, s[84:87], 0 offen sc1
s_waitcnt vmcnt(10)
v_mfma_f32_32x32x16_bf16 v[20:35], a[168:171], v[180:183], v[20:35]
v_mfma_f32_32x32x16_bf16 v[36:51], a[172:175], v[180:183], v[36:51]
s_waitcnt vmcnt(9)
v_mfma_f32_32x32x16_bf16 v[20:35], a[176:179], v[184:187], v[20:35]
v_mfma_f32_32x32x16_bf16 v[36:51], a[180:183], v[184:187], v[36:51]
s_waitcnt vmcnt(8)
v_mfma_f32_32x32x16_bf16 v[20:35], a[184:187], v[188:191], v[20:35]
v_mfma_f32_32x32x16_bf16 v[36:51], a[188:191], v[188:191], v[36:51]
s_waitcnt vmcnt(7)
v_mfma_f32_32x32x16_bf16 v[20:35], a[192:195], v[192:195], v[20:35]
v_mfma_f32_32x32x16_bf16 v[36:51], a[196:199], v[192:195], v[36:51]
s_waitcnt vmcnt(6)
v_mfma_f32_32x32x16_bf16 v[20:35], a[200:203], v[196:199], v[20:35]
v_mfma_f32_32x32x16_bf16 v[36:51], a[204:207], v[196:199], v[36:51]
s_waitcnt vmcnt(5)
v_mfma_f32_32x32x16_bf16 v[20:35], a[208:211], v[200:203], v[20:35]
v_mfma_f32_32x32x16_bf16 v[36:51], a[212:215], v[200:203], v[36:51]
s_waitcnt vmcnt(4)
v_mfma_f32_32x32x16_bf16 v[20:35], a[216:219], v[204:207], v[20:35]
v_mfma_f32_32x32x16_bf16 v[36:51], a[220:223], v[204:207], v[36:51]
s_waitcnt vmcnt(3)
v_mfma_f32_32x32x16_bf16 v[20:35], a[224:227], v[208:211], v[20:35]
v_mfma_f32_32x32x16_bf16 v[36:51], a[228:231], v[208:211], v[36:51]
s_waitcnt vmcnt(2)
v_mfma_f32_32x32x16_bf16 v[20:35], a[232:235], v[212:215], v[20:35]
v_mfma_f32_32x32x16_bf16 v[36:51], a[236:239], v[212:215], v[36:51]
s_waitcnt vmcnt(1)
v_mfma_f32_32x32x16_bf16 v[20:35], a[240:243], v[216:219], v[20:35]
v_mfma_f32_32x32x16_bf16 v[36:51], a[244:247], v[216:219], v[36:51]
s_waitcnt vmcnt(0)
v_mfma_f32_32x32x16_bf16 v[224:239], a[248:251], v[220:223], v[20:35]
v_mfma_f32_32x32x16_bf16 v[240:255], a[252:255], v[220:223], v[36:51]
s_branch mega_kernel_o_imm
mega_kernel_o_w1:
s_add_u32 s54, s42, 1
s_sub_u32 s62, s42, 1
s_lshl_b32 s50, s54, 18
s_cmp_gt_i32 s52, s54
s_cbranch_scc0 mega_kernel_o_n1
s_waitcnt vmcnt(31)
v_mfma_f32_32x32x16_bf16 v[20:35], a[0:3], v[96:99], 0
v_mfma_f32_32x32x16_bf16 v[36:51], a[4:7], v[96:99], 0
s_add_u32 s51, s56, 0
s_and_b32 s51, s51, 0x7fff
s_add_u32 s51, s51, s50
buffer_load_dwordx4 v[96:99], v6, s[84:87], s51 offen offset:0 sc1
s_waitcnt vmcnt(31)
v_mfma_f32_32x32x16_bf16 v[20:35], a[8:11], v[100:103], v[20:35]
v_mfma_f32_32x32x16_bf16 v[36:51], a[12:15], v[100:103], v[36:51]
buffer_load_dwordx4 v[100:103], v6, s[84:87], s51 offen offset:1024 sc1
v_add_u32 v2, s53, v8
v_add_u32 v3, s53, v9
v_add_u32 v4, s53, v10
s_waitcnt vmcnt(31)
v_mfma_f32_32x32x16_bf16 v[20:35], a[16:19], v[104:107], v[20:35]
v_mfma_f32_32x32x16_bf16 v[36:51], a[20:23], v[104:107], v[36:51]
buffer_load_dwordx4 v[104:107], v6, s[84:87], s51 offen offset:2048 sc1
ds_write_b128 v2, v[224:227] offset:0
ds_write_b128 v2, v[228:231] offset:1088
s_waitcnt vmcnt(31)
v_mfma_f32_32x32x16_bf16 v[20:35], a[24:27], v[108:111], v[20:35]
v_mfma_f32_32x32x16_bf16 v[36:51], a[28:31], v[108:111], v[36:51]
buffer_load_dwordx4 v[108:111], v6, s[84:87], s51 offen offset:3072 sc1
ds_write_b128 v2, v[232:235] offset:2176
ds_write_b128 v2, v[236:239] offset:3264
s_waitcnt vmcnt(31)
v_mfma_f32_32x32x16_bf16 v[20:35], a[32:35], v[112:115], v[20:35]
v_mfma_f32_32x32x16_bf16 v[36:51], a[36:39], v[112:115], v[36:51]
s_add_u32 s51, s56, 4096
s_and_b32 s51, s51, 0x7fff
s_add_u32 s51, s51, s50
buffer_load_dwordx4 v[112:115], v6, s[84:87], s51 offen offset:0 sc1
ds_write_b128 v2, v[240:243] offset:4352
ds_write_b128 v2, v[244:247] offset:5440
s_waitcnt vmcnt(31)
v_mfma_f32_32x32x16_bf16 v[20:35], a[40:43], v[116:119], v[20:35]
v_mfma_f32_32x32x16_bf16 v[36:51], a[44:47], v[116:119], v[36:51]
buffer_load_dwordx4 v[116:119], v6, s[84:87], s51 offen offset:1024 sc1
ds_write_b128 v2, v[248:251] offset:6528
ds_write_b128 v2, v[252:255] offset:7616
s_waitcnt vmcnt(31)
v_mfma_f32_32x32x16_bf16 v[20:35], a[48:51], v[120:123], v[20:35]
v_mfma_f32_32x32x16_bf16 v[36:51], a[52:55], v[120:123], v[36:51]
buffer_load_dwordx4 v[120:123], v6, s[84:87], s51 offen offset:2048 sc1
s_waitcnt vmcnt(31)
v_mfma_f32_32x32x16_bf16 v[20:35], a[56:59], v[124:127], v[20:35]
v_mfma_f32_32x32x16_bf16 v[36:51], a[60:63], v[124:127], v[36:51]
buffer_load_dwordx4 v[124:127], v6, s[84:87], s51 offen offset:3072 sc1
s_waitcnt lgkmcnt(0)
s_barrier
ds_read_b128 v[52:55], v4 offset:0
ds_read_b128 v[56:59], v4 offset:8704
ds_read_b128 v[60:63], v4 offset:17408
ds_read_b128 v[64:67], v4 offset:26112
s_waitcnt vmcnt(31)
v_mfma_f32_32x32x16_bf16 v[20:35], a[64:67], v[128:131], v[20:35]
v_mfma_f32_32x32x16_bf16 v[36:51], a[68:71], v[128:131], v[36:51]
s_add_u32 s51, s56, 8192
s_and_b32 s51, s51, 0x7fff
s_add_u32 s51, s51, s50
buffer_load_dwordx4 v[128:131], v6, s[84:87], s51 offen offset:0 sc1
ds_read_b128 v[68:71], v3 offset:0
ds_read_b128 v[72:75], v3 offset:8704
ds_read_b128 v[76:79], v3 offset:17408
ds_read_b128 v[80:83], v3 offset:26112
s_sub_u32 s53, 34816, s53
s_bfe_u32 s61, s62, 0x10001
s_xor_b32 s61, s61, s67
s_and_b32 s60, s62, s69
s_lshl_b32 s60, s60, 12
s_waitcnt vmcnt(31)
v_mfma_f32_32x32x16_bf16 v[20:35], a[72:75], v[132:135], v[20:35]
v_mfma_f32_32x32x16_bf16 v[36:51], a[76:79], v[132:135], v[36:51]
buffer_load_dwordx4 v[132:135], v6, s[84:87], s51 offen offset:1024 sc1
s_waitcnt vmcnt(31)
v_mfma_f32_32x32x16_bf16 v[20:35], a[80:83], v[136:139], v[20:35]
v_mfma_f32_32x32x16_bf16 v[36:51], a[84:87], v[136:139], v[36:51]
buffer_load_dwordx4 v[136:139], v6, s[84:87], s51 offen offset:2048 sc1
s_waitcnt lgkmcnt(4)
v_add_f32 v52, v52, v56
v_add_f32 v60, v60, v64
v_add_f32 v53, v53, v57
v_add_f32 v61, v61, v65
v_add_f32 v54, v54, v58
v_add_f32 v62, v62, v66
v_add_f32 v55, v55, v59
v_add_f32 v63, v63, v67
s_waitcnt vmcnt(31)
v_mfma_f32_32x32x16_bf16 v[20:35], a[88:91], v[140:143], v[20:35]
v_mfma_f32_32x32x16_bf16 v[36:51], a[92:95], v[140:143], v[36:51]
buffer_load_dwordx4 v[140:143], v6, s[84:87], s51 offen offset:3072 sc1
v_add_f32 v52, v52, v60
v_add_f32 v53, v53, v61
v_add_f32 v54, v54, v62
v_add_f32 v55, v55, v63
v_and_or_b32 v52, v52, -2, s61
s_cmp_eq_u32 s95, 0
s_cbranch_scc1 mega_kernel_o_sa1
buffer_store_dwordx4 v[52:55], v12, s[84:87], s60 offen sc1
s_branch mega_kernel_o_sb1
mega_kernel_o_sa1:
buffer_store_dwordx4 v[52:55], v12, s[84:87], s60 offen
mega_kernel_o_sb1:
s_waitcnt vmcnt(31)
v_mfma_f32_32x32x16_bf16 v[20:35], a[96:99], v[144:147], v[20:35]
v_mfma_f32_32x32x16_bf16 v[36:51], a[100:103], v[144:147], v[36:51]
s_add_u32 s51, s56, 12288
s_and_b32 s51, s51, 0x7fff
s_add_u32 s51, s51, s50
buffer_load_dwordx4 v[144:147], v6, s[84:87], s51 offen offset:0 sc1
s_waitcnt lgkmcnt(0)
v_add_f32 v68, v68, v72
v_add_f32 v76, v76, v80
v_add_f32 v69, v69, v73
v_add_f32 v77, v77, v81
v_add_f32 v70, v70, v74
v_add_f32 v78, v78, v82
v_add_f32 v71, v71, v75
v_add_f32 v79, v79, v83
s_waitcnt vmcnt(31)
v_mfma_f32_32x32x16_bf16 v[20:35], a[104:107], v[148:151], v[20:35]
v_mfma_f32_32x32x16_bf16 v[36:51], a[108:111], v[148:151], v[36:51]
buffer_load_dwordx4 v[148:151], v6, s[84:87], s51 offen offset:1024 sc1
v_add_f32 v84, v68, v76
v_add_f32 v85, v69, v77
v_add_f32 v86, v70, v78
v_add_f32 v87, v71, v79
s_waitcnt vmcnt(31)
v_mfma_f32_32x32x16_bf16 v[20:35], a[112:115], v[152:155], v[20:35]
v_mfma_f32_32x32x16_bf16 v[36:51], a[116:119], v[152:155], v[36:51]
buffer_load_dwordx4 v[152:155], v6, s[84:87], s51 offen offset:2048 sc1
s_waitcnt vmcnt(31)
v_mfma_f32_32x32x16_bf16 v[20:35], a[120:123], v[156:159], v[20:35]
v_mfma_f32_32x32x16_bf16 v[36:51], a[124:127], v[156:159], v[36:51]
buffer_load_dwordx4 v[156:159], v6, s[84:87], s51 offen offset:3072 sc1
s_waitcnt vmcnt(31)
v_mfma_f32_32x32x16_bf16 v[20:35], a[128:131], v[160:163], v[20:35]
v_mfma_f32_32x32x16_bf16 v[36:51], a[132:135], v[160:163], v[36:51]
s_add_u32 s51, s56, 16384
s_and_b32 s51, s51, 0x7fff
s_add_u32 s51, s51, s50
buffer_load_dwordx4 v[160:163], v6, s[84:87], s51 offen offset:0 sc1
s_waitcnt vmcnt(31)
v_mfma_f32_32x32x16_bf16 v[20:35], a[136:139], v[164:167], v[20:35]
v_mfma_f32_32x32x16_bf16 v[36:51], a[140:143], v[164:167], v[36:51]
buffer_load_dwordx4 v[164:167], v6, s[84:87], s51 offen offset:1024 sc1
s_waitcnt vmcnt(31)
v_mfma_f32_32x32x16_bf16 v[20:35], a[144:147], v[168:171], v[20:35]
v_mfma_f32_32x32x16_bf16 v[36:51], a[148:151], v[168:171], v[36:51]
buffer_load_dwordx4 v[168:171], v6, s[84:87], s51 offen offset:2048 sc1
s_waitcnt vmcnt(31)
v_mfma_f32_32x32x16_bf16 v[20:35], a[152:155], v[172:175], v[20:35]
v_mfma_f32_32x32x16_bf16 v[36:51], a[156:159], v[172:175], v[36:51]
buffer_load_dwordx4 v[172:175], v6, s[84:87], s51 offen offset:3072 sc1
s_waitcnt vmcnt(31)
v_mfma_f32_32x32x16_bf16 v[20:35], a[160:163], v[176:179], v[20:35]
v_mfma_f32_32x32x16_bf16 v[36:51], a[164:167], v[176:179], v[36:51]
s_add_u32 s51, s56, 20480
s_and_b32 s51, s51, 0x7fff
s_add_u32 s51, s51, s50
buffer_load_dwordx4 v[176:179], v6, s[84:87], s51 offen offset:0 sc1
s_waitcnt vmcnt(31)
v_mfma_f32_32x32x16_bf16 v[20:35], a[168:171], v[180:183], v[20:35]
v_mfma_f32_32x32x16_bf16 v[36:51], a[172:175], v[180:183], v[36:51]
buffer_load_dwordx4 v[180:183], v6, s[84:87], s51 offen offset:1024 sc1
s_waitcnt vmcnt(31)
v_mfma_f32_32x32x16_bf16 v[20:35], a[176:179], v[184:187], v[20:35]
v_mfma_f32_32x32x16_bf16 v[36:51], a[180:183], v[184:187], v[36:51]
buffer_load_dwordx4 v[184:187], v6, s[84:87], s51 offen offset:2048 sc1
s_waitcnt vmcnt(31)
v_mfma_f32_32x32x16_bf16 v[20:35], a[184:187], v[188:191], v[20:35]
v_mfma_f32_32x32x16_bf16 v[36:51], a[188:191], v[188:191], v[36:51]
buffer_load_dwordx4 v[188:191], v6, s[84:87], s51 offen offset:3072 sc1
s_waitcnt vmcnt(31)
v_mfma_f32_32x32x16_bf16 v[20:35], a[192:195], v[192:195], v[20:35]
v_mfma_f32_32x32x16_bf16 v[36:51], a[196:199], v[192:195], v[36:51]
s_add_u32 s51, s56, 24576
s_and_b32 s51, s51, 0x7fff
s_add_u32 s51, s51, s50
buffer_load_dwordx4 v[192:195], v6, s[84:87], s51 offen offset:0 sc1
s_waitcnt vmcnt(31)
v_mfma_f32_32x32x16_bf16 v[20:35], a[200:203], v[196:199], v[20:35]
v_mfma_f32_32x32x16_bf16 v[36:51], a[204:207], v[196:199], v[36:51]
buffer_load_dwordx4 v[196:199], v6, s[84:87], s51 offen offset:1024 sc1
s_waitcnt vmcnt(31)
v_mfma_f32_32x32x16_bf16 v[20:35], a[208:211], v[200:203], v[20:35]
v_mfma_f32_32x32x16_bf16 v[36:51], a[212:215], v[200:203], v[36:51]
buffer_load_dwordx4 v[200:203], v6, s[84:87], s51 offen offset:2048 sc1
s_waitcnt vmcnt(31)
v_mfma_f32_32x32x16_bf16 v[20:35], a[216:219], v[204:207], v[20:35]
v_mfma_f32_32x32x16_bf16 v[36:51], a[220:223], v[204:207], v[36:51]
buffer_load_dwordx4 v[204:207], v6, s[84:87], s51 offen offset:3072 sc1
s_and_b32 s60, s62, s69
s_lshl_b32 s60, s60, 12
buffer_load_dwordx4 v[88:91], v13, s[84:87], s60 offen sc1
s_waitcnt vmcnt(31)
v_mfma_f32_32x32x16_bf16 v[20:35], a[224:227], v[208:211], v[20:35]
v_mfma_f32_32x32x16_bf16 v[36:51], a[228:231], v[208:211], v[36:51]
s_add_u32 s51, s56, 28672
s_and_b32 s51, s51, 0x7fff
s_add_u32 s51, s51, s50
buffer_load_dwordx4 v[208:211], v6, s[84:87], s51 offen offset:0 sc1
s_waitcnt vmcnt(31)
v_mfma_f32_32x32x16_bf16 v[20:35], a[232:235], v[212:215], v[20:35]
v_mfma_f32_32x32x16_bf16 v[36:51], a[236:239], v[212:215], v[36:51]
buffer_load_dwordx4 v[212:215], v6, s[84:87], s51 offen offset:1024 sc1
s_waitcnt vmcnt(31)
v_mfma_f32_32x32x16_bf16 v[20:35], a[240:243], v[216:219], v[20:35]
v_mfma_f32_32x32x16_bf16 v[36:51], a[244:247], v[216:219], v[36:51]
buffer_load_dwordx4 v[216:219], v6, s[84:87], s51 offen offset:2048 sc1
s_waitcnt vmcnt(31)
v_mfma_f32_32x32x16_bf16 v[224:239], a[248:251], v[220:223], v[20:35]
v_mfma_f32_32x32x16_bf16 v[240:255], a[252:255], v[220:223], v[36:51]
buffer_load_dwordx4 v[220:223], v6, s[84:87], s51 offen offset:3072 sc1
s_bfe_u32 s61, s62, 0x10001
s_xor_b32 s61, s61, s67
s_and_b32 s61, s61, s71
s_waitcnt vmcnt(4)
mega_kernel_o_f1c:
v_and_b32 v14, s71, v88
v_cmp_ne_u32 vcc, s61, v14
s_cbranch_vccz mega_kernel_o_f1k
s_and_b32 s60, s62, s69
s_lshl_b32 s60, s60, 12
buffer_load_dwordx4 v[88:91], v13, s[84:87], s60 offen sc1
s_waitcnt vmcnt(0)
s_branch mega_kernel_o_f1c
mega_kernel_o_f1k:
v_pk_add_f32 v[88:89], v[88:89], v[84:85]
v_pk_add_f32 v[90:91], v[90:91], v[86:87]
s_lshl_b32 s60, s62, 17
v_cvt_pk_bf16_f32 v92, v88, v89
v_cvt_pk_bf16_f32 v93, v90, v91
buffer_store_dwordx2 v[92:93], v11, s[8:11], s60 offen sc1
s_add_u32 s42, s42, 1
s_branch mega_kernel_o_w1
mega_kernel_o_n1:
s_waitcnt vmcnt(31)
v_mfma_f32_32x32x16_bf16 v[20:35], a[0:3], v[96:99], 0
v_mfma_f32_32x32x16_bf16 v[36:51], a[4:7], v[96:99], 0
s_waitcnt vmcnt(30)
v_mfma_f32_32x32x16_bf16 v[20:35], a[8:11], v[100:103], v[20:35]
v_mfma_f32_32x32x16_bf16 v[36:51], a[12:15], v[100:103], v[36:51]
v_add_u32 v2, s53, v8
v_add_u32 v3, s53, v9
v_add_u32 v4, s53, v10
s_waitcnt vmcnt(29)
v_mfma_f32_32x32x16_bf16 v[20:35], a[16:19], v[104:107], v[20:35]
v_mfma_f32_32x32x16_bf16 v[36:51], a[20:23], v[104:107], v[36:51]
ds_write_b128 v2, v[224:227] offset:0
ds_write_b128 v2, v[228:231] offset:1088
s_waitcnt vmcnt(28)
v_mfma_f32_32x32x16_bf16 v[20:35], a[24:27], v[108:111], v[20:35]
v_mfma_f32_32x32x16_bf16 v[36:51], a[28:31], v[108:111], v[36:51]
ds_write_b128 v2, v[232:235] offset:2176
ds_write_b128 v2, v[236:239] offset:3264
s_waitcnt vmcnt(27)
v_mfma_f32_32x32x16_bf16 v[20:35], a[32:35], v[112:115], v[20:35]
v_mfma_f32_32x32x16_bf16 v[36:51], a[36:39], v[112:115], v[36:51]
ds_write_b128 v2, v[240:243] offset:4352
ds_write_b128 v2, v[244:247] offset:5440
s_waitcnt vmcnt(26)
v_mfma_f32_32x32x16_bf16 v[20:35], a[40:43], v[116:119], v[20:35]
v_mfma_f32_32x32x16_bf16 v[36:51], a[44:47], v[116:119], v[36:51]
ds_write_b128 v2, v[248:251] offset:6528
ds_write_b128 v2, v[252:255] offset:7616
s_waitcnt vmcnt(25)
v_mfma_f32_32x32x16_bf16 v[20:35], a[48:51], v[120:123], v[20:35]
v_mfma_f32_32x32x16_bf16 v[36:51], a[52:55], v[120:123], v[36:51]
s_waitcnt vmcnt(24)
v_mfma_f32_32x32x16_bf16 v[20:35], a[56:59], v[124:127], v[20:35]
v_mfma_f32_32x32x16_bf16 v[36:51], a[60:63], v[124:127], v[36:51]
s_waitcnt lgkmcnt(0)
s_barrier
ds_read_b128 v[52:55], v4 offset:0
ds_read_b128 v[56:59], v4 offset:8704
ds_read_b128 v[60:63], v4 offset:17408
ds_read_b128 v[64:67], v4 offset:26112
s_waitcnt vmcnt(23)
v_mfma_f32_32x32x16_bf16 v[20:35], a[64:67], v[128:131], v[20:35]
v_mfma_f32_32x32x16_bf16 v[36:51], a[68:71], v[128:131], v[36:51]
ds_read_b128 v[68:71], v3 offset:0
ds_read_b128 v[72:75], v3 offset:8704
ds_read_b128 v[76:79], v3 offset:17408
ds_read_b128 v[80:83], v3 offset:26112
s_sub_u32 s53, 34816, s53
s_bfe_u32 s61, s62, 0x10001
s_xor_b32 s61, s61, s67
s_and_b32 s60, s62, s69
s_lshl_b32 s60, s60, 12
s_waitcnt vmcnt(22)
v_mfma_f32_32x32x16_bf16 v[20:35], a[72:75], v[132:135], v[20:35]
v_mfma_f32_32x32x16_bf16 v[36:51], a[76:79], v[132:135], v[36:51]
s_waitcnt vmcnt(21)
v_mfma_f32_32x32x16_bf16 v[20:35], a[80:83], v[136:139], v[20:35]
v_mfma_f32_32x32x16_bf16 v[36:51], a[84:87], v[136:139], v[36:51]
s_waitcnt lgkmcnt(4)
v_add_f32 v52, v52, v56
v_add_f32 v60, v60, v64
v_add_f32 v53, v53, v57
v_add_f32 v61, v61, v65
v_add_f32 v54, v54, v58
v_add_f32 v62, v62, v66
v_add_f32 v55, v55, v59
v_add_f32 v63, v63, v67
s_waitcnt vmcnt(20)
v_mfma_f32_32x32x16_bf16 v[20:35], a[88:91], v[140:143], v[20:35]
v_mfma_f32_32x32x16_bf16 v[36:51], a[92:95], v[140:143], v[36:51]
v_add_f32 v52, v52, v60
v_add_f32 v53, v53, v61
v_add_f32 v54, v54, v62
v_add_f32 v55, v55, v63
v_and_or_b32 v52, v52, -2, s61
s_cmp_eq_u32 s95, 0
s_cbranch_scc1 mega_kernel_o_sa2
buffer_store_dwordx4 v[52:55], v12, s[84:87], s60 offen sc1
s_branch mega_kernel_o_sb2
mega_kernel_o_sa2:
buffer_store_dwordx4 v[52:55], v12, s[84:87], s60 offen
mega_kernel_o_sb2:
s_waitcnt vmcnt(19)
v_mfma_f32_32x32x16_bf16 v[20:35], a[96:99], v[144:147], v[20:35]
v_mfma_f32_32x32x16_bf16 v[36:51], a[100:103], v[144:147], v[36:51]
s_waitcnt lgkmcnt(0)
v_add_f32 v68, v68, v72
v_add_f32 v76, v76, v80
v_add_f32 v69, v69, v73
v_add_f32 v77, v77, v81
v_add_f32 v70, v70, v74
v_add_f32 v78, v78, v82
v_add_f32 v71, v71, v75
v_add_f32 v79, v79, v83
s_waitcnt vmcnt(18)
v_mfma_f32_32x32x16_bf16 v[20:35], a[104:107], v[148:151], v[20:35]
v_mfma_f32_32x32x16_bf16 v[36:51], a[108:111], v[148:151], v[36:51]
v_add_f32 v84, v68, v76
v_add_f32 v85, v69, v77
v_add_f32 v86, v70, v78
v_add_f32 v87, v71, v79
s_waitcnt vmcnt(17)
v_mfma_f32_32x32x16_bf16 v[20:35], a[112:115], v[152:155], v[20:35]
v_mfma_f32_32x32x16_bf16 v[36:51], a[116:119], v[152:155], v[36:51]
s_waitcnt vmcnt(16)
v_mfma_f32_32x32x16_bf16 v[20:35], a[120:123], v[156:159], v[20:35]
v_mfma_f32_32x32x16_bf16 v[36:51], a[124:127], v[156:159], v[36:51]
s_waitcnt vmcnt(15)
v_mfma_f32_32x32x16_bf16 v[20:35], a[128:131], v[160:163], v[20:35]
v_mfma_f32_32x32x16_bf16 v[36:51], a[132:135], v[160:163], v[36:51]
s_waitcnt vmcnt(14)
v_mfma_f32_32x32x16_bf16 v[20:35], a[136:139], v[164:167], v[20:35]
v_mfma_f32_32x32x16_bf16 v[36:51], a[140:143], v[164:167], v[36:51]
s_waitcnt vmcnt(13)
v_mfma_f32_32x32x16_bf16 v[20:35], a[144:147], v[168:171], v[20:35]
v_mfma_f32_32x32x16_bf16 v[36:51], a[148:151], v[168:171], v[36:51]
s_waitcnt vmcnt(12)
v_mfma_f32_32x32x16_bf16 v[20:35], a[152:155], v[172:175], v[20:35]
v_mfma_f32_32x32x16_bf16 v[36:51], a[156:159], v[172:175], v[36:51]
s_waitcnt vmcnt(11)
v_mfma_f32_32x32x16_bf16 v[20:35], a[160:163], v[176:179], v[20:35]
v_mfma_f32_32x32x16_bf16 v[36:51], a[164:167], v[176:179], v[36:51]
buffer_load_dword v15, v7, s[84:87], 0 offen sc1
s_waitcnt vmcnt(10)
v_mfma_f32_32x32x16_bf16 v[20:35], a[168:171], v[180:183], v[20:35]
v_mfma_f32_32x32x16_bf16 v[36:51], a[172:175], v[180:183], v[36:51]
s_waitcnt vmcnt(9)
v_mfma_f32_32x32x16_bf16 v[20:35], a[176:179], v[184:187], v[20:35]
v_mfma_f32_32x32x16_bf16 v[36:51], a[180:183], v[184:187], v[36:51]
s_waitcnt vmcnt(8)
v_mfma_f32_32x32x16_bf16 v[20:35], a[184:187], v[188:191], v[20:35]
v_mfma_f32_32x32x16_bf16 v[36:51], a[188:191], v[188:191], v[36:51]
s_waitcnt vmcnt(7)
v_mfma_f32_32x32x16_bf16 v[20:35], a[192:195], v[192:195], v[20:35]
v_mfma_f32_32x32x16_bf16 v[36:51], a[196:199], v[192:195], v[36:51]
s_waitcnt vmcnt(6)
v_mfma_f32_32x32x16_bf16 v[20:35], a[200:203], v[196:199], v[20:35]
v_mfma_f32_32x32x16_bf16 v[36:51], a[204:207], v[196:199], v[36:51]
s_waitcnt vmcnt(5)
v_mfma_f32_32x32x16_bf16 v[20:35], a[208:211], v[200:203], v[20:35]
v_mfma_f32_32x32x16_bf16 v[36:51], a[212:215], v[200:203], v[36:51]
s_waitcnt vmcnt(4)
v_mfma_f32_32x32x16_bf16 v[20:35], a[216:219], v[204:207], v[20:35]
v_mfma_f32_32x32x16_bf16 v[36:51], a[220:223], v[204:207], v[36:51]
s_and_b32 s60, s62, s69
s_lshl_b32 s60, s60, 12
buffer_load_dwordx4 v[88:91], v13, s[84:87], s60 offen sc1
s_waitcnt vmcnt(3)
v_mfma_f32_32x32x16_bf16 v[20:35], a[224:227], v[208:211], v[20:35]
v_mfma_f32_32x32x16_bf16 v[36:51], a[228:231], v[208:211], v[36:51]
s_waitcnt vmcnt(2)
v_mfma_f32_32x32x16_bf16 v[20:35], a[232:235], v[212:215], v[20:35]
v_mfma_f32_32x32x16_bf16 v[36:51], a[236:239], v[212:215], v[36:51]
s_waitcnt vmcnt(1)
v_mfma_f32_32x32x16_bf16 v[20:35], a[240:243], v[216:219], v[20:35]
v_mfma_f32_32x32x16_bf16 v[36:51], a[244:247], v[216:219], v[36:51]
s_waitcnt vmcnt(0)
v_mfma_f32_32x32x16_bf16 v[224:239], a[248:251], v[220:223], v[20:35]
v_mfma_f32_32x32x16_bf16 v[240:255], a[252:255], v[220:223], v[36:51]
s_bfe_u32 s61, s62, 0x10001
s_xor_b32 s61, s61, s67
s_and_b32 s61, s61, s71
s_waitcnt vmcnt(0)
mega_kernel_o_f0c:
v_and_b32 v14, s71, v88
v_cmp_ne_u32 vcc, s61, v14
s_cbranch_vccz mega_kernel_o_f0k
s_and_b32 s60, s62, s69
s_lshl_b32 s60, s60, 12
buffer_load_dwordx4 v[88:91], v13, s[84:87], s60 offen sc1
s_waitcnt vmcnt(0)
s_branch mega_kernel_o_f0c
mega_kernel_o_f0k:
v_pk_add_f32 v[88:89], v[88:89], v[84:85]
v_pk_add_f32 v[90:91], v[90:91], v[86:87]
s_lshl_b32 s60, s62, 17
v_cvt_pk_bf16_f32 v92, v88, v89
v_cvt_pk_bf16_f32 v93, v90, v91
buffer_store_dwordx2 v[92:93], v11, s[8:11], s60 offen sc1
mega_kernel_o_imm:
s_waitcnt vmcnt(1)
v_min_i32_dpp v15, v15, v15 quad_perm:[1,0,3,2] row_mask:0xf bank_mask:0xf
s_nop 1
v_min_i32_dpp v15, v15, v15 quad_perm:[2,3,0,1] row_mask:0xf bank_mask:0xf
s_nop 1
v_min_i32_dpp v15, v15, v15 row_ror:4 row_mask:0xf bank_mask:0xf
s_nop 1
v_min_i32_dpp v15, v15, v15 row_ror:8 row_mask:0xf bank_mask:0xf
s_nop 0
v_readfirstlane_b32 s52, v15
s_min_i32 s52, s52, s65
s_cmp_gt_i32 s52, s54
s_cbranch_scc0 mega_kernel_o_im2
s_add_u32 s42, s42, 1
s_add_u32 s54, s54, 1
s_cmp_gt_i32 s52, s54
s_cbranch_scc0 mega_kernel_o_c1
s_add_u32 s51, s56, 0
s_and_b32 s51, s51, 0x7fff
s_add_u32 s51, s51, s50
buffer_load_dwordx4 v[96:99], v6, s[84:87], s51 offen offset:0 sc1
buffer_load_dwordx4 v[100:103], v6, s[84:87], s51 offen offset:1024 sc1
buffer_load_dwordx4 v[104:107], v6, s[84:87], s51 offen offset:2048 sc1
buffer_load_dwordx4 v[108:111], v6, s[84:87], s51 offen offset:3072 sc1
s_add_u32 s51, s56, 4096
s_and_b32 s51, s51, 0x7fff
s_add_u32 s51, s51, s50
buffer_load_dwordx4 v[112:115], v6, s[84:87], s51 offen offset:0 sc1
buffer_load_dwordx4 v[116:119], v6, s[84:87], s51 offen offset:1024 sc1
buffer_load_dwordx4 v[120:123], v6, s[84:87], s51 offen offset:2048 sc1
buffer_load_dwordx4 v[124:127], v6, s[84:87], s51 offen offset:3072 sc1
s_add_u32 s51, s56, 8192
s_and_b32 s51, s51, 0x7fff
s_add_u32 s51, s51, s50
buffer_load_dwordx4 v[128:131], v6, s[84:87], s51 offen offset:0 sc1
buffer_load_dwordx4 v[132:135], v6, s[84:87], s51 offen offset:1024 sc1
buffer_load_dwordx4 v[136:139], v6, s[84:87], s51 offen offset:2048 sc1
buffer_load_dwordx4 v[140:143], v6, s[84:87], s51 offen offset:3072 sc1
s_add_u32 s51, s56, 12288
s_and_b32 s51, s51, 0x7fff
s_add_u32 s51, s51, s50
buffer_load_dwordx4 v[144:147], v6, s[84:87], s51 offen offset:0 sc1
buffer_load_dwordx4 v[148:151], v6, s[84:87], s51 offen offset:1024 sc1
buffer_load_dwordx4 v[152:155], v6, s[84:87], s51 offen offset:2048 sc1
buffer_load_dwordx4 v[156:159], v6, s[84:87], s51 offen offset:3072 sc1
s_add_u32 s51, s56, 16384
s_and_b32 s51, s51, 0x7fff
s_add_u32 s51, s51, s50
buffer_load_dwordx4 v[160:163], v6, s[84:87], s51 offen offset:0 sc1
buffer_load_dwordx4 v[164:167], v6, s[84:87], s51 offen offset:1024 sc1
buffer_load_dwordx4 v[168:171], v6, s[84:87], s51 offen offset:2048 sc1
buffer_load_dwordx4 v[172:175], v6, s[84:87], s51 offen offset:3072 sc1
s_add_u32 s51, s56, 20480
s_and_b32 s51, s51, 0x7fff
s_add_u32 s51, s51, s50
buffer_load_dwordx4 v[176:179], v6, s[84:87], s51 offen offset:0 sc1
buffer_load_dwordx4 v[180:183], v6, s[84:87], s51 offen offset:1024 sc1
buffer_load_dwordx4 v[184:187], v6, s[84:87], s51 offen offset:2048 sc1
buffer_load_dwordx4 v[188:191], v6, s[84:87], s51 offen offset:3072 sc1
s_add_u32 s51, s56, 24576
s_and_b32 s51, s51, 0x7fff
s_add_u32 s51, s51, s50
buffer_load_dwordx4 v[192:195], v6, s[84:87], s51 offen offset:0 sc1
buffer_load_dwordx4 v[196:199], v6, s[84:87], s51 offen offset:1024 sc1
buffer_load_dwordx4 v[200:203], v6, s[84:87], s51 offen offset:2048 sc1
buffer_load_dwordx4 v[204:207], v6, s[84:87], s51 offen offset:3072 sc1
s_add_u32 s51, s56, 28672
s_and_b32 s51, s51, 0x7fff
s_add_u32 s51, s51, s50
buffer_load_dwordx4 v[208:211], v6, s[84:87], s51 offen offset:0 sc1
buffer_load_dwordx4 v[212:215], v6, s[84:87], s51 offen offset:1024 sc1
buffer_load_dwordx4 v[216:219], v6, s[84:87], s51 offen offset:2048 sc1
buffer_load_dwordx4 v[220:223], v6, s[84:87], s51 offen offset:3072 sc1
s_branch mega_kernel_o_w1
mega_kernel_o_c0:
s_add_u32 s54, s42, 1
s_sub_u32 s62, s42, 1
s_lshl_b32 s50, s42, 18
s_add_u32 s51, s56, 0
s_and_b32 s51, s51, 0x7fff
s_add_u32 s51, s51, s50
buffer_load_dwordx4 v[96:99], v6, s[84:87], s51 offen offset:0 sc1
buffer_load_dwordx4 v[100:103], v6, s[84:87], s51 offen offset:1024 sc1
buffer_load_dwordx4 v[104:107], v6, s[84:87], s51 offen offset:2048 sc1
buffer_load_dwordx4 v[108:111], v6, s[84:87], s51 offen offset:3072 sc1
s_add_u32 s51, s56, 4096
s_and_b32 s51, s51, 0x7fff
s_add_u32 s51, s51, s50
buffer_load_dwordx4 v[112:115], v6, s[84:87], s51 offen offset:0 sc1
buffer_load_dwordx4 v[116:119], v6, s[84:87], s51 offen offset:1024 sc1
buffer_load_dwordx4 v[120:123], v6, s[84:87], s51 offen offset:2048 sc1
buffer_load_dwordx4 v[124:127], v6, s[84:87], s51 offen offset:3072 sc1
s_waitcnt vmcnt(7)
v_mfma_f32_32x32x16_bf16 v[20:35], a[0:3], v[96:99], 0
v_mfma_f32_32x32x16_bf16 v[36:51], a[4:7], v[96:99], 0
s_add_u32 s51, s56, 8192
s_and_b32 s51, s51, 0x7fff
s_add_u32 s51, s51, s50
buffer_load_dwordx4 v[128:131], v6, s[84:87], s51 offen offset:0 sc1
s_waitcnt vmcnt(7)
v_mfma_f32_32x32x16_bf16 v[20:35], a[8:11], v[100:103], v[20:35]
v_mfma_f32_32x32x16_bf16 v[36:51], a[12:15], v[100:103], v[36:51]
buffer_load_dwordx4 v[132:135], v6, s[84:87], s51 offen offset:1024 sc1
s_waitcnt vmcnt(7)
v_mfma_f32_32x32x16_bf16 v[20:35], a[16:19], v[104:107], v[20:35]
v_mfma_f32_32x32x16_bf16 v[36:51], a[20:23], v[104:107], v[36:51]
buffer_load_dwordx4 v[136:139], v6, s[84:87], s51 offen offset:2048 sc1
s_waitcnt vmcnt(7)
v_mfma_f32_32x32x16_bf16 v[20:35], a[24:27], v[108:111], v[20:35]
v_mfma_f32_32x32x16_bf16 v[36:51], a[28:31], v[108:111], v[36:51]
buffer_load_dwordx4 v[140:143], v6, s[84:87], s51 offen offset:3072 sc1
s_waitcnt vmcnt(7)
v_mfma_f32_32x32x16_bf16 v[20:35], a[32:35], v[112:115], v[20:35]
v_mfma_f32_32x32x16_bf16 v[36:51], a[36:39], v[112:115], v[36:51]
s_add_u32 s51, s56, 12288
s_and_b32 s51, s51, 0x7fff
s_add_u32 s51, s51, s50
buffer_load_dwordx4 v[144:147], v6, s[84:87], s51 offen offset:0 sc1
s_waitcnt vmcnt(7)
v_mfma_f32_32x32x16_bf16 v[20:35], a[40:43], v[116:119], v[20:35]
v_mfma_f32_32x32x16_bf16 v[36:51], a[44:47], v[116:119], v[36:51]
buffer_load_dwordx4 v[148:151], v6, s[84:87], s51 offen offset:1024 sc1
s_waitcnt vmcnt(7)
v_mfma_f32_32x32x16_bf16 v[20:35], a[48:51], v[120:123], v[20:35]
v_mfma_f32_32x32x16_bf16 v[36:51], a[52:55], v[120:123], v[36:51]
buffer_load_dwordx4 v[152:155], v6, s[84:87], s51 offen offset:2048 sc1
s_waitcnt vmcnt(7)
v_mfma_f32_32x32x16_bf16 v[20:35], a[56:59], v[124:127], v[20:35]
v_mfma_f32_32x32x16_bf16 v[36:51], a[60:63], v[124:127], v[36:51]
buffer_load_dwordx4 v[156:159], v6, s[84:87], s51 offen offset:3072 sc1
s_waitcnt vmcnt(7)
v_mfma_f32_32x32x16_bf16 v[20:35], a[64:67], v[128:131], v[20:35]
v_mfma_f32_32x32x16_bf16 v[36:51], a[68:71], v[128:131], v[36:51]
s_add_u32 s51, s56, 16384
s_and_b32 s51, s51, 0x7fff
s_add_u32 s51, s51, s50
buffer_load_dwordx4 v[160:163], v6, s[84:87], s51 offen offset:0 sc1
s_waitcnt vmcnt(7)
v_mfma_f32_32x32x16_bf16 v[20:35], a[72:75], v[132:135], v[20:35]
v_mfma_f32_32x32x16_bf16 v[36:51], a[76:79], v[132:135], v[36:51]
buffer_load_dwordx4 v[164:167], v6, s[84:87], s51 offen offset:1024 sc1
s_waitcnt vmcnt(7)
v_mfma_f32_32x32x16_bf16 v[20:35], a[80:83], v[136:139], v[20:35]
v_mfma_f32_32x32x16_bf16 v[36:51], a[84:87], v[136:139], v[36:51]
buffer_load_dwordx4 v[168:171], v6, s[84:87], s51 offen offset:2048 sc1
s_waitcnt vmcnt(7)
v_mfma_f32_32x32x16_bf16 v[20:35], a[88:91], v[140:143], v[20:35]
v_mfma_f32_32x32x16_bf16 v[36:51], a[92:95], v[140:143], v[36:51]
buffer_load_dwordx4 v[172:175], v6, s[84:87], s51 offen offset:3072 sc1
s_waitcnt vmcnt(7)
v_mfma_f32_32x32x16_bf16 v[20:35], a[96:99], v[144:147], v[20:35]
v_mfma_f32_32x32x16_bf16 v[36:51], a[100:103], v[144:147], v[36:51]
s_add_u32 s51, s56, 20480
s_and_b32 s51, s51, 0x7fff
s_add_u32 s51, s51, s50
buffer_load_dwordx4 v[176:179], v6, s[84:87], s51 offen offset:0 sc1
s_waitcnt vmcnt(7)
v_mfma_f32_32x32x16_bf16 v[20:35], a[104:107], v[148:151], v[20:35]
v_mfma_f32_32x32x16_bf16 v[36:51], a[108:111], v[148:151], v[36:51]
buffer_load_dwordx4 v[180:183], v6, s[84:87], s51 offen offset:1024 sc1
s_waitcnt vmcnt(7)
v_mfma_f32_32x32x16_bf16 v[20:35], a[112:115], v[152:155], v[20:35]
v_mfma_f32_32x32x16_bf16 v[36:51], a[116:119], v[152:155], v[36:51]
buffer_load_dwordx4 v[184:187], v6, s[84:87], s51 offen offset:2048 sc1
s_waitcnt vmcnt(7)
v_mfma_f32_32x32x16_bf16 v[20:35], a[120:123], v[156:159], v[20:35]
v_mfma_f32_32x32x16_bf16 v[36:51], a[124:127], v[156:159], v[36:51]
buffer_load_dwordx4 v[188:191], v6, s[84:87], s51 offen offset:3072 sc1
s_waitcnt vmcnt(7)
v_mfma_f32_32x32x16_bf16 v[20:35], a[128:131], v[160:163], v[20:35]
v_mfma_f32_32x32x16_bf16 v[36:51], a[132:135], v[160:163], v[36:51]
s_add_u32 s51, s56, 24576
s_and_b32 s51, s51, 0x7fff
s_add_u32 s51, s51, s50
buffer_load_dwordx4 v[192:195], v6, s[84:87], s51 offen offset:0 sc1
s_waitcnt vmcnt(7)
v_mfma_f32_32x32x16_bf16 v[20:35], a[136:139], v[164:167], v[20:35]
v_mfma_f32_32x32x16_bf16 v[36:51], a[140:143], v[164:167], v[36:51]
buffer_load_dwordx4 v[196:199], v6, s[84:87], s51 offen offset:1024 sc1
s_waitcnt vmcnt(7)
v_mfma_f32_32x32x16_bf16 v[20:35], a[144:147], v[168:171], v[20:35]
v_mfma_f32_32x32x16_bf16 v[36:51], a[148:151], v[168:171], v[36:51]
buffer_load_dwordx4 v[200:203], v6, s[84:87], s51 offen offset:2048 sc1
s_waitcnt vmcnt(7)
v_mfma_f32_32x32x16_bf16 v[20:35], a[152:155], v[172:175], v[20:35]
v_mfma_f32_32x32x16_bf16 v[36:51], a[156:159], v[172:175], v[36:51]
buffer_load_dwordx4 v[204:207], v6, s[84:87], s51 offen offset:3072 sc1
s_waitcnt vmcnt(7)
v_mfma_f32_32x32x16_bf16 v[20:35], a[160:163], v[176:179], v[20:35]
v_mfma_f32_32x32x16_bf16 v[36:51], a[164:167], v[176:179], v[36:51]
s_add_u32 s51, s56, 28672
s_and_b32 s51, s51, 0x7fff
s_add_u32 s51, s51, s50
buffer_load_dwordx4 v[208:211], v6, s[84:87], s51 offen offset:0 sc1
s_waitcnt vmcnt(7)
v_mfma_f32_32x32x16_bf16 v[20:35], a[168:171], v[180:183], v[20:35]
v_mfma_f32_32x32x16_bf16 v[36:51], a[172:175], v[180:183], v[36:51]
buffer_load_dwordx4 v[212:215], v6, s[84:87], s51 offen offset:1024 sc1
s_waitcnt vmcnt(7)
v_mfma_f32_32x32x16_bf16 v[20:35], a[176:179], v[184:187], v[20:35]
v_mfma_f32_32x32x16_bf16 v[36:51], a[180:183], v[184:187], v[36:51]
buffer_load_dwordx4 v[216:219], v6, s[84:87], s51 offen offset:2048 sc1
s_waitcnt vmcnt(7)
v_mfma_f32_32x32x16_bf16 v[20:35], a[184:187], v[188:191], v[20:35]
v_mfma_f32_32x32x16_bf16 v[36:51], a[188:191], v[188:191], v[36:51]
buffer_load_dwordx4 v[220:223], v6, s[84:87], s51 offen offset:3072 sc1
s_waitcnt vmcnt(7)
v_mfma_f32_32x32x16_bf16 v[20:35], a[192:195], v[192:195], v[20:35]
v_mfma_f32_32x32x16_bf16 v[36:51], a[196:199], v[192:195], v[36:51]
buffer_load_dword v15, v7, s[84:87], 0 offen sc1
s_waitcnt vmcnt(6)
v_mfma_f32_32x32x16_bf16 v[20:35], a[200:203], v[196:199], v[20:35]
v_mfma_f32_32x32x16_bf16 v[36:51], a[204:207], v[196:199], v[36:51]
s_waitcnt vmcnt(5)
v_mfma_f32_32x32x16_bf16 v[20:35], a[208:211], v[200:203], v[20:35]
v_mfma_f32_32x32x16_bf16 v[36:51], a[212:215], v[200:203], v[36:51]
s_waitcnt vmcnt(4)
v_mfma_f32_32x32x16_bf16 v[20:35], a[216:219], v[204:207], v[20:35]
v_mfma_f32_32x32x16_bf16 v[36:51], a[220:223], v[204:207], v[36:51]
s_waitcnt vmcnt(3)
v_mfma_f32_32x32x16_bf16 v[20:35], a[224:227], v[208:211], v[20:35]
v_mfma_f32_32x32x16_bf16 v[36:51], a[228:231], v[208:211], v[36:51]
s_waitcnt vmcnt(2)
v_mfma_f32_32x32x16_bf16 v[20:35], a[232:235], v[212:215], v[20:35]
v_mfma_f32_32x32x16_bf16 v[36:51], a[236:239], v[212:215], v[36:51]
s_waitcnt vmcnt(1)
v_mfma_f32_32x32x16_bf16 v[20:35], a[240:243], v[216:219], v[20:35]
v_mfma_f32_32x32x16_bf16 v[36:51], a[244:247], v[216:219], v[36:51]
s_waitcnt vmcnt(0)
v_mfma_f32_32x32x16_bf16 v[224:239], a[248:251], v[220:223], v[20:35]
v_mfma_f32_32x32x16_bf16 v[240:255], a[252:255], v[220:223], v[36:51]
s_lshl_b32 s50, s54, 18
s_branch mega_kernel_o_imm
mega_kernel_o_c1:
s_add_u32 s54, s42, 1
s_sub_u32 s62, s42, 1
s_lshl_b32 s50, s42, 18
s_add_u32 s51, s56, 0
s_and_b32 s51, s51, 0x7fff
s_add_u32 s51, s51, s50
buffer_load_dwordx4 v[96:99], v6, s[84:87], s51 offen offset:0 sc1
buffer_load_dwordx4 v[100:103], v6, s[84:87], s51 offen offset:1024 sc1
buffer_load_dwordx4 v[104:107], v6, s[84:87], s51 offen offset:2048 sc1
buffer_load_dwordx4 v[108:111], v6, s[84:87], s51 offen offset:3072 sc1
s_add_u32 s51, s56, 4096
s_and_b32 s51, s51, 0x7fff
s_add_u32 s51, s51, s50
buffer_load_dwordx4 v[112:115], v6, s[84:87], s51 offen offset:0 sc1
buffer_load_dwordx4 v[116:119], v6, s[84:87], s51 offen offset:1024 sc1
buffer_load_dwordx4 v[120:123], v6, s[84:87], s51 offen offset:2048 sc1
buffer_load_dwordx4 v[124:127], v6, s[84:87], s51 offen offset:3072 sc1
v_add_u32 v2, s53, v8
v_add_u32 v3, s53, v9
v_add_u32 v4, s53, v10
ds_write_b128 v2, v[224:227] offset:0
ds_write_b128 v2, v[228:231] offset:1088
ds_write_b128 v2, v[232:235] offset:2176
ds_write_b128 v2, v[236:239] offset:3264
ds_write_b128 v2, v[240:243] offset:4352
ds_write_b128 v2, v[244:247] offset:5440
ds_write_b128 v2, v[248:251] offset:6528
ds_write_b128 v2, v[252:255] offset:7616
s_waitcnt lgkmcnt(0)
s_barrier
ds_read_b128 v[52:55], v4 offset:0
ds_read_b128 v[56:59], v4 offset:8704
ds_read_b128 v[60:63], v4 offset:17408
ds_read_b128 v[64:67], v4 offset:26112
ds_read_b128 v[68:71], v3 offset:0
ds_read_b128 v[72:75], v3 offset:8704
ds_read_b128 v[76:79], v3 offset:17408
ds_read_b128 v[80:83], v3 offset:26112
s_sub_u32 s53, 34816, s53
s_bfe_u32 s61, s62, 0x10001
s_xor_b32 s61, s61, s67
s_and_b32 s60, s62, s69
s_lshl_b32 s60, s60, 12
s_waitcnt lgkmcnt(4)
v_add_f32 v52, v52, v56
v_add_f32 v60, v60, v64
v_add_f32 v53, v53, v57
v_add_f32 v61, v61, v65
v_add_f32 v54, v54, v58
v_add_f32 v62, v62, v66
v_add_f32 v55, v55, v59
v_add_f32 v63, v63, v67
v_add_f32 v52, v52, v60
v_add_f32 v53, v53, v61
v_add_f32 v54, v54, v62
v_add_f32 v55, v55, v63
v_and_or_b32 v52, v52, -2, s61
s_cmp_eq_u32 s95, 0
s_cbranch_scc1 mega_kernel_o_sa3
buffer_store_dwordx4 v[52:55], v12, s[84:87], s60 offen sc1
s_branch mega_kernel_o_sb3
mega_kernel_o_sa3:
buffer_store_dwordx4 v[52:55], v12, s[84:87], s60 offen
mega_kernel_o_sb3:
s_waitcnt lgkmcnt(0)
v_add_f32 v68, v68, v72
v_add_f32 v76, v76, v80
v_add_f32 v69, v69, v73
v_add_f32 v77, v77, v81
v_add_f32 v70, v70, v74
v_add_f32 v78, v78, v82
v_add_f32 v71, v71, v75
v_add_f32 v79, v79, v83
v_add_f32 v84, v68, v76
v_add_f32 v85, v69, v77
v_add_f32 v86, v70, v78
v_add_f32 v87, v71, v79
s_waitcnt vmcnt(7)
v_mfma_f32_32x32x16_bf16 v[20:35], a[0:3], v[96:99], 0
v_mfma_f32_32x32x16_bf16 v[36:51], a[4:7], v[96:99], 0
s_add_u32 s51, s56, 8192
s_and_b32 s51, s51, 0x7fff
s_add_u32 s51, s51, s50
buffer_load_dwordx4 v[128:131], v6, s[84:87], s51 offen offset:0 sc1
s_waitcnt vmcnt(7)
v_mfma_f32_32x32x16_bf16 v[20:35], a[8:11], v[100:103], v[20:35]
v_mfma_f32_32x32x16_bf16 v[36:51], a[12:15], v[100:103], v[36:51]
buffer_load_dwordx4 v[132:135], v6, s[84:87], s51 offen offset:1024 sc1
s_waitcnt vmcnt(7)
v_mfma_f32_32x32x16_bf16 v[20:35], a[16:19], v[104:107], v[20:35]
v_mfma_f32_32x32x16_bf16 v[36:51], a[20:23], v[104:107], v[36:51]
buffer_load_dwordx4 v[136:139], v6, s[84:87], s51 offen offset:2048 sc1
s_waitcnt vmcnt(7)
v_mfma_f32_32x32x16_bf16 v[20:35], a[24:27], v[108:111], v[20:35]
v_mfma_f32_32x32x16_bf16 v[36:51], a[28:31], v[108:111], v[36:51]
buffer_load_dwordx4 v[140:143], v6, s[84:87], s51 offen offset:3072 sc1
s_waitcnt vmcnt(7)
v_mfma_f32_32x32x16_bf16 v[20:35], a[32:35], v[112:115], v[20:35]
v_mfma_f32_32x32x16_bf16 v[36:51], a[36:39], v[112:115], v[36:51]
s_add_u32 s51, s56, 12288
s_and_b32 s51, s51, 0x7fff
s_add_u32 s51, s51, s50
buffer_load_dwordx4 v[144:147], v6, s[84:87], s51 offen offset:0 sc1
s_waitcnt vmcnt(7)
v_mfma_f32_32x32x16_bf16 v[20:35], a[40:43], v[116:119], v[20:35]
v_mfma_f32_32x32x16_bf16 v[36:51], a[44:47], v[116:119], v[36:51]
buffer_load_dwordx4 v[148:151], v6, s[84:87], s51 offen offset:1024 sc1
s_waitcnt vmcnt(7)
v_mfma_f32_32x32x16_bf16 v[20:35], a[48:51], v[120:123], v[20:35]
v_mfma_f32_32x32x16_bf16 v[36:51], a[52:55], v[120:123], v[36:51]
buffer_load_dwordx4 v[152:155], v6, s[84:87], s51 offen offset:2048 sc1
s_waitcnt vmcnt(7)
v_mfma_f32_32x32x16_bf16 v[20:35], a[56:59], v[124:127], v[20:35]
v_mfma_f32_32x32x16_bf16 v[36:51], a[60:63], v[124:127], v[36:51]
buffer_load_dwordx4 v[156:159], v6, s[84:87], s51 offen offset:3072 sc1
s_waitcnt vmcnt(7)
v_mfma_f32_32x32x16_bf16 v[20:35], a[64:67], v[128:131], v[20:35]
v_mfma_f32_32x32x16_bf16 v[36:51], a[68:71], v[128:131], v[36:51]
s_add_u32 s51, s56, 16384
s_and_b32 s51, s51, 0x7fff
s_add_u32 s51, s51, s50
buffer_load_dwordx4 v[160:163], v6, s[84:87], s51 offen offset:0 sc1
s_waitcnt vmcnt(7)
v_mfma_f32_32x32x16_bf16 v[20:35], a[72:75], v[132:135], v[20:35]
v_mfma_f32_32x32x16_bf16 v[36:51], a[76:79], v[132:135], v[36:51]
buffer_load_dwordx4 v[164:167], v6, s[84:87], s51 offen offset:1024 sc1
s_waitcnt vmcnt(7)
v_mfma_f32_32x32x16_bf16 v[20:35], a[80:83], v[136:139], v[20:35]
v_mfma_f32_32x32x16_bf16 v[36:51], a[84:87], v[136:139], v[36:51]
buffer_load_dwordx4 v[168:171], v6, s[84:87], s51 offen offset:2048 sc1
s_waitcnt vmcnt(7)
v_mfma_f32_32x32x16_bf16 v[20:35], a[88:91], v[140:143], v[20:35]
v_mfma_f32_32x32x16_bf16 v[36:51], a[92:95], v[140:143], v[36:51]
buffer_load_dwordx4 v[172:175], v6, s[84:87], s51 offen offset:3072 sc1
s_waitcnt vmcnt(7)
v_mfma_f32_32x32x16_bf16 v[20:35], a[96:99], v[144:147], v[20:35]
v_mfma_f32_32x32x16_bf16 v[36:51], a[100:103], v[144:147], v[36:51]
s_add_u32 s51, s56, 20480
s_and_b32 s51, s51, 0x7fff
s_add_u32 s51, s51, s50
buffer_load_dwordx4 v[176:179], v6, s[84:87], s51 offen offset:0 sc1
s_waitcnt vmcnt(7)
v_mfma_f32_32x32x16_bf16 v[20:35], a[104:107], v[148:151], v[20:35]
v_mfma_f32_32x32x16_bf16 v[36:51], a[108:111], v[148:151], v[36:51]
buffer_load_dwordx4 v[180:183], v6, s[84:87], s51 offen offset:1024 sc1
s_waitcnt vmcnt(7)
v_mfma_f32_32x32x16_bf16 v[20:35], a[112:115], v[152:155], v[20:35]
v_mfma_f32_32x32x16_bf16 v[36:51], a[116:119], v[152:155], v[36:51]
buffer_load_dwordx4 v[184:187], v6, s[84:87], s51 offen offset:2048 sc1
s_waitcnt vmcnt(7)
v_mfma_f32_32x32x16_bf16 v[20:35], a[120:123], v[156:159], v[20:35]
v_mfma_f32_32x32x16_bf16 v[36:51], a[124:127], v[156:159], v[36:51]
buffer_load_dwordx4 v[188:191], v6, s[84:87], s51 offen offset:3072 sc1
s_waitcnt vmcnt(7)
v_mfma_f32_32x32x16_bf16 v[20:35], a[128:131], v[160:163], v[20:35]
v_mfma_f32_32x32x16_bf16 v[36:51], a[132:135], v[160:163], v[36:51]
s_add_u32 s51, s56, 24576
s_and_b32 s51, s51, 0x7fff
s_add_u32 s51, s51, s50
buffer_load_dwordx4 v[192:195], v6, s[84:87], s51 offen offset:0 sc1
s_waitcnt vmcnt(7)
v_mfma_f32_32x32x16_bf16 v[20:35], a[136:139], v[164:167], v[20:35]
v_mfma_f32_32x32x16_bf16 v[36:51], a[140:143], v[164:167], v[36:51]
buffer_load_dwordx4 v[196:199], v6, s[84:87], s51 offen offset:1024 sc1
s_waitcnt vmcnt(7)
v_mfma_f32_32x32x16_bf16 v[20:35], a[144:147], v[168:171], v[20:35]
v_mfma_f32_32x32x16_bf16 v[36:51], a[148:151], v[168:171], v[36:51]
buffer_load_dwordx4 v[200:203], v6, s[84:87], s51 offen offset:2048 sc1
s_waitcnt vmcnt(7)
v_mfma_f32_32x32x16_bf16 v[20:35], a[152:155], v[172:175], v[20:35]
v_mfma_f32_32x32x16_bf16 v[36:51], a[156:159], v[172:175], v[36:51]
buffer_load_dwordx4 v[204:207], v6, s[84:87], s51 offen offset:3072 sc1
s_waitcnt vmcnt(7)
v_mfma_f32_32x32x16_bf16 v[20:35], a[160:163], v[176:179], v[20:35]
v_mfma_f32_32x32x16_bf16 v[36:51], a[164:167], v[176:179], v[36:51]
s_add_u32 s51, s56, 28672
s_and_b32 s51, s51, 0x7fff
s_add_u32 s51, s51, s50
buffer_load_dwordx4 v[208:211], v6, s[84:87], s51 offen offset:0 sc1
s_waitcnt vmcnt(7)
v_mfma_f32_32x32x16_bf16 v[20:35], a[168:171], v[180:183], v[20:35]
v_mfma_f32_32x32x16_bf16 v[36:51], a[172:175], v[180:183], v[36:51]
buffer_load_dwordx4 v[212:215], v6, s[84:87], s51 offen offset:1024 sc1
s_waitcnt vmcnt(7)
v_mfma_f32_32x32x16_bf16 v[20:35], a[176:179], v[184:187], v[20:35]
v_mfma_f32_32x32x16_bf16 v[36:51], a[180:183], v[184:187], v[36:51]
buffer_load_dwordx4 v[216:219], v6, s[84:87], s51 offen offset:2048 sc1
s_waitcnt vmcnt(7)
v_mfma_f32_32x32x16_bf16 v[20:35], a[184:187], v[188:191], v[20:35]
v_mfma_f32_32x32x16_bf16 v[36:51], a[188:191], v[188:191], v[36:51]
buffer_load_dwordx4 v[220:223], v6, s[84:87], s51 offen offset:3072 sc1
s_waitcnt vmcnt(7)
v_mfma_f32_32x32x16_bf16 v[20:35], a[192:195], v[192:195], v[20:35]
v_mfma_f32_32x32x16_bf16 v[36:51], a[196:199], v[192:195], v[36:51]
s_and_b32 s60, s62, s69
s_lshl_b32 s60, s60, 12
buffer_load_dwordx4 v[88:91], v13, s[84:87], s60 offen sc1
buffer_load_dword v15, v7, s[84:87], 0 offen sc1
s_waitcnt vmcnt(6)
v_mfma_f32_32x32x16_bf16 v[20:35], a[200:203], v[196:199], v[20:35]
v_mfma_f32_32x32x16_bf16 v[36:51], a[204:207], v[196:199], v[36:51]
s_waitcnt vmcnt(5)
v_mfma_f32_32x32x16_bf16 v[20:35], a[208:211], v[200:203], v[20:35]
v_mfma_f32_32x32x16_bf16 v[36:51], a[212:215], v[200:203], v[36:51]
s_waitcnt vmcnt(4)
v_mfma_f32_32x32x16_bf16 v[20:35], a[216:219], v[204:207], v[20:35]
v_mfma_f32_32x32x16_bf16 v[36:51], a[220:223], v[204:207], v[36:51]
s_waitcnt vmcnt(3)
v_mfma_f32_32x32x16_bf16 v[20:35], a[224:227], v[208:211], v[20:35]
v_mfma_f32_32x32x16_bf16 v[36:51], a[228:231], v[208:211], v[36:51]
s_waitcnt vmcnt(2)
v_mfma_f32_32x32x16_bf16 v[20:35], a[232:235], v[212:215], v[20:35]
v_mfma_f32_32x32x16_bf16 v[36:51], a[236:239], v[212:215], v[36:51]
s_waitcnt vmcnt(1)
v_mfma_f32_32x32x16_bf16 v[20:35], a[240:243], v[216:219], v[20:35]
v_mfma_f32_32x32x16_bf16 v[36:51], a[244:247], v[216:219], v[36:51]
s_waitcnt vmcnt(0)
v_mfma_f32_32x32x16_bf16 v[224:239], a[248:251], v[220:223], v[20:35]
v_mfma_f32_32x32x16_bf16 v[240:255], a[252:255], v[220:223], v[36:51]
s_bfe_u32 s61, s62, 0x10001
s_xor_b32 s61, s61, s67
s_and_b32 s61, s61, s71
s_waitcnt vmcnt(0)
mega_kernel_o_fcc:
v_and_b32 v14, s71, v88
v_cmp_ne_u32 vcc, s61, v14
s_cbranch_vccz mega_kernel_o_fck
s_and_b32 s60, s62, s69
s_lshl_b32 s60, s60, 12
buffer_load_dwordx4 v[88:91], v13, s[84:87], s60 offen sc1
s_waitcnt vmcnt(0)
s_branch mega_kernel_o_fcc
mega_kernel_o_fck:
v_pk_add_f32 v[88:89], v[88:89], v[84:85]
v_pk_add_f32 v[90:91], v[90:91], v[86:87]
s_lshl_b32 s60, s62, 17
v_cvt_pk_bf16_f32 v92, v88, v89
v_cvt_pk_bf16_f32 v93, v90, v91
buffer_store_dwordx2 v[92:93], v11, s[8:11], s60 offen sc1
s_lshl_b32 s50, s54, 18
s_branch mega_kernel_o_imm
mega_kernel_o_im2:
v_add_u32 v2, s53, v8
v_add_u32 v3, s53, v9
v_add_u32 v4, s53, v10
ds_write_b128 v2, v[224:227] offset:0
ds_write_b128 v2, v[228:231] offset:1088
ds_write_b128 v2, v[232:235] offset:2176
ds_write_b128 v2, v[236:239] offset:3264
ds_write_b128 v2, v[240:243] offset:4352
ds_write_b128 v2, v[244:247] offset:5440
ds_write_b128 v2, v[248:251] offset:6528
ds_write_b128 v2, v[252:255] offset:7616
s_waitcnt lgkmcnt(0)
s_barrier
ds_read_b128 v[52:55], v4 offset:0
ds_read_b128 v[56:59], v4 offset:8704
ds_read_b128 v[60:63], v4 offset:17408
ds_read_b128 v[64:67], v4 offset:26112
ds_read_b128 v[68:71], v3 offset:0
ds_read_b128 v[72:75], v3 offset:8704
ds_read_b128 v[76:79], v3 offset:17408
ds_read_b128 v[80:83], v3 offset:26112
s_sub_u32 s53, 34816, s53
s_bfe_u32 s61, s42, 0x10001
s_xor_b32 s61, s61, s67
s_and_b32 s60, s42, s69
s_lshl_b32 s60, s60, 12
s_waitcnt lgkmcnt(4)
v_add_f32 v52, v52, v56
v_add_f32 v60, v60, v64
v_add_f32 v53, v53, v57
v_add_f32 v61, v61, v65
v_add_f32 v54, v54, v58
v_add_f32 v62, v62, v66
v_add_f32 v55, v55, v59
v_add_f32 v63, v63, v67
v_add_f32 v52, v52, v60
v_add_f32 v53, v53, v61
v_add_f32 v54, v54, v62
v_add_f32 v55, v55, v63
v_and_or_b32 v52, v52, -2, s61
s_cmp_eq_u32 s95, 0
s_cbranch_scc1 mega_kernel_o_sa4
buffer_store_dwordx4 v[52:55], v12, s[84:87], s60 offen sc1
s_branch mega_kernel_o_sb4
mega_kernel_o_sa4:
buffer_store_dwordx4 v[52:55], v12, s[84:87], s60 offen
mega_kernel_o_sb4:
s_waitcnt lgkmcnt(0)
v_add_f32 v68, v68, v72
v_add_f32 v76, v76, v80
v_add_f32 v69, v69, v73
v_add_f32 v77, v77, v81
v_add_f32 v70, v70, v74
v_add_f32 v78, v78, v82
v_add_f32 v71, v71, v75
v_add_f32 v79, v79, v83
v_add_f32 v84, v68, v76
v_add_f32 v85, v69, v77
v_add_f32 v86, v70, v78
v_add_f32 v87, v71, v79
s_and_b32 s60, s42, s69
s_lshl_b32 s60, s60, 12
buffer_load_dwordx4 v[88:91], v13, s[84:87], s60 offen sc1
s_bfe_u32 s61, s42, 0x10001
s_xor_b32 s61, s61, s67
s_and_b32 s61, s61, s71
s_waitcnt vmcnt(0)
mega_kernel_o_f2c:
v_and_b32 v14, s71, v88
v_cmp_ne_u32 vcc, s61, v14
s_cbranch_vccz mega_kernel_o_f2k
s_and_b32 s60, s42, s69
s_lshl_b32 s60, s60, 12
buffer_load_dwordx4 v[88:91], v13, s[84:87], s60 offen sc1
s_waitcnt vmcnt(0)
s_branch mega_kernel_o_f2c
mega_kernel_o_f2k:
v_pk_add_f32 v[88:89], v[88:89], v[84:85]
v_pk_add_f32 v[90:91], v[90:91], v[86:87]
s_lshl_b32 s60, s42, 17
v_cvt_pk_bf16_f32 v92, v88, v89
v_cvt_pk_bf16_f32 v93, v90, v91
buffer_store_dwordx2 v[92:93], v11, s[8:11], s60 offen sc1
s_add_u32 s42, s42, 1
s_cmp_lt_u32 s42, s65
s_cbranch_scc1 mega_kernel_o_cold
s_cmp_eq_u32 s71, 1
s_cbranch_scc1 mega_kernel_o_fin
s_mov_b32 s71, 1
s_mov_b32 s42, s64
s_mov_b32 s65, s70
v_mov_b32 v12, v16
v_mov_b32 v11, v17
s_and_b32 s60, s42, s69
s_lshl_b32 s60, s60, 12
buffer_load_dwordx4 v[88:91], v13, s[84:87], s60 offen sc1
s_branch mega_kernel_o_cold
mega_kernel_o_fin:
mega_kernel_o_quit:
s_endpgm
mega_kernel_exit:
s_endpgm
mega_kernel_recf:
s_load_dwordx2 s[20:21], s[0:1], 8
s_load_dwordx2 s[16:17], s[0:1], 40
s_load_dwordx2 s[4:5], s[0:1], 16
s_load_dwordx2 s[8:9], s[0:1], 24
s_load_dwordx2 s[12:13], s[0:1], 32
v_lshrrev_b32 v4, 6, v0
v_and_b32 v1, 63, v0
v_readfirstlane_b32 s24, v4
v_lshrrev_b32 v2, 4, v1
v_and_b32 v3, 15, v1
v_lshlrev_b32 v17, 4, v1
s_lshr_b32 s28, s31, 2
s_lshl_b32 s25, s30, 3
s_add_u32 s25, s25, s28
s_and_b32 s26, s31, 3
s_waitcnt lgkmcnt(0)
s_mov_b32 s22, 16384
s_mov_b32 s23, 0x00020000
s_mov_b32 s18, 8388608
s_mov_b32 s19, 0x00020000
s_mov_b32 s6, 8388608
s_mov_b32 s7, 0x00020000
s_mov_b32 s10, 8388608
s_mov_b32 s11, 0x00020000
s_mov_b32 s14, 8388608
s_mov_b32 s15, 0x00020000
s_lshl_b32 s28, s25, 8
s_lshr_b32 s29, s26, 0
s_lshl_b32 s29, s29, 6
s_add_u32 s28, s28, s29
s_lshl_b32 s29, s24, 21
s_add_u32 s28, s28, s29
v_lshrrev_b32 v4, 2, v1
v_and_b32 v5, 3, v1
v_lshlrev_b32 v40, 13, v4
v_lshl_add_u32 v40, v5, 4, v40
v_add_u32 v40, s28, v40
s_lshl_b32 s28, s30, 21
s_lshl_b32 s29, s24, 19
s_add_u32 s28, s28, s29
s_lshr_b32 s29, s31, 0
s_lshl_b32 s29, s29, 6
s_add_u32 s28, s28, s29
v_lshlrev_b32 v41, 11, v4
v_lshl_add_u32 v41, v5, 4, v41
v_add_u32 v41, s28, v41
s_lshl_b32 s47, s24, 15
s_add_u32 s47, s47, 32768
s_lshl_b32 s28, s31, 18
s_lshl_b32 s29, s24, 16
s_add_u32 s28, s28, s29
s_lshl_b32 s29, s30, 11
s_add_u32 s28, s28, s29
v_lshlrev_b32 v48, 13, v2
v_lshl_add_u32 v48, v3, 7, v48
v_add_u32 v48, s28, v48
s_lshl_b32 s28, s30, 21
s_lshl_b32 s29, s31, 16
s_add_u32 s28, s28, s29
s_lshl_b32 s29, s24, 14
s_add_u32 s28, s28, s29
v_lshlrev_b32 v49, 7, v1
v_add_u32 v49, s28, v49
s_and_b32 s76, s31, 1
s_mul_i32 s76, s76, 8
s_and_b32 s28, s31, 15
s_lshl_b32 s28, s28, 4
s_lshl_b32 s29, s24, 8
s_add_u32 s28, s28, s29
v_add_u32 v53, s28, v3
s_lshr_b32 s28, s31, 4
s_lshl_b32 s28, s28, 10
s_add_u32 s28, s28, 384
v_mov_b32 v54, s28
v_mov_b32 v55, 1920
v_cmp_gt_u32 vcc, 32, v1
s_nop 1
v_cndmask_b32 v54, v55, v54, vcc
s_lshl_b32 s29, s30, 11
v_lshl_add_u32 v51, v53, 13, v54
v_add_u32 v51, s29, v51
s_lshl_b32 s29, s30, 21
v_lshl_add_u32 v52, v53, 11, v54
v_add_u32 v52, s29, v52
buffer_load_dword v50, v51, s[8:11], 0 offen
s_xor_b32 s29, s76, 0
s_lshl_b32 s28, s29, 10
s_add_u32 s28, s28, s47
s_add_u32 m0, s28, 0
s_lshl_b32 s29, s29, 17
buffer_load_dwordx4 v40, s[8:11], s29 offen lds
s_xor_b32 s29, s76, 1
s_lshl_b32 s28, s29, 10
s_add_u32 s28, s28, s47
s_add_u32 m0, s28, 0
s_lshl_b32 s29, s29, 17
buffer_load_dwordx4 v40, s[8:11], s29 offen lds
s_xor_b32 s29, s76, 2
s_lshl_b32 s28, s29, 10
s_add_u32 s28, s28, s47
s_add_u32 m0, s28, 0
s_lshl_b32 s29, s29, 17
buffer_load_dwordx4 v40, s[8:11], s29 offen lds
s_xor_b32 s29, s76, 3
s_lshl_b32 s28, s29, 10
s_add_u32 s28, s28, s47
s_add_u32 m0, s28, 0
s_lshl_b32 s29, s29, 17
buffer_load_dwordx4 v40, s[8:11], s29 offen lds
s_xor_b32 s29, s76, 4
s_lshl_b32 s28, s29, 10
s_add_u32 s28, s28, s47
s_add_u32 m0, s28, 0
s_lshl_b32 s29, s29, 17
buffer_load_dwordx4 v40, s[8:11], s29 offen lds
s_xor_b32 s29, s76, 5
s_lshl_b32 s28, s29, 10
s_add_u32 s28, s28, s47
s_add_u32 m0, s28, 0
s_lshl_b32 s29, s29, 17
buffer_load_dwordx4 v40, s[8:11], s29 offen lds
s_xor_b32 s29, s76, 6
s_lshl_b32 s28, s29, 10
s_add_u32 s28, s28, s47
s_add_u32 m0, s28, 0
s_lshl_b32 s29, s29, 17
buffer_load_dwordx4 v40, s[8:11], s29 offen lds
s_xor_b32 s29, s76, 7
s_lshl_b32 s28, s29, 10
s_add_u32 s28, s28, s47
s_add_u32 m0, s28, 0
s_lshl_b32 s29, s29, 17
buffer_load_dwordx4 v40, s[8:11], s29 offen lds
s_xor_b32 s29, s76, 8
s_lshl_b32 s28, s29, 10
s_add_u32 s28, s28, s47
s_add_u32 m0, s28, 0
s_lshl_b32 s29, s29, 17
buffer_load_dwordx4 v40, s[8:11], s29 offen lds
s_xor_b32 s29, s76, 9
s_lshl_b32 s28, s29, 10
s_add_u32 s28, s28, s47
s_add_u32 m0, s28, 0
s_lshl_b32 s29, s29, 17
buffer_load_dwordx4 v40, s[8:11], s29 offen lds
s_xor_b32 s29, s76, 10
s_lshl_b32 s28, s29, 10
s_add_u32 s28, s28, s47
s_add_u32 m0, s28, 0
s_lshl_b32 s29, s29, 17
buffer_load_dwordx4 v40, s[8:11], s29 offen lds
s_xor_b32 s29, s76, 11
s_lshl_b32 s28, s29, 10
s_add_u32 s28, s28, s47
s_add_u32 m0, s28, 0
s_lshl_b32 s29, s29, 17
buffer_load_dwordx4 v40, s[8:11], s29 offen lds
s_xor_b32 s29, s76, 12
s_lshl_b32 s28, s29, 10
s_add_u32 s28, s28, s47
s_add_u32 m0, s28, 0
s_lshl_b32 s29, s29, 17
buffer_load_dwordx4 v40, s[8:11], s29 offen lds
s_xor_b32 s29, s76, 13
s_lshl_b32 s28, s29, 10
s_add_u32 s28, s28, s47
s_add_u32 m0, s28, 0
s_lshl_b32 s29, s29, 17
buffer_load_dwordx4 v40, s[8:11], s29 offen lds
s_xor_b32 s29, s76, 14
s_lshl_b32 s28, s29, 10
s_add_u32 s28, s28, s47
s_add_u32 m0, s28, 0
s_lshl_b32 s29, s29, 17
buffer_load_dwordx4 v40, s[8:11], s29 offen lds
s_xor_b32 s29, s76, 15
s_lshl_b32 s28, s29, 10
s_add_u32 s28, s28, s47
s_add_u32 m0, s28, 0
s_lshl_b32 s29, s29, 17
buffer_load_dwordx4 v40, s[8:11], s29 offen lds
buffer_load_dword v50, v51, s[12:15], 0 offen
s_xor_b32 s29, s76, 0
s_lshl_b32 s28, s29, 10
s_add_u32 s28, s28, s47
s_add_u32 m0, s28, 16384
s_lshl_b32 s29, s29, 17
buffer_load_dwordx4 v40, s[12:15], s29 offen lds
s_xor_b32 s29, s76, 1
s_lshl_b32 s28, s29, 10
s_add_u32 s28, s28, s47
s_add_u32 m0, s28, 16384
s_lshl_b32 s29, s29, 17
buffer_load_dwordx4 v40, s[12:15], s29 offen lds
s_xor_b32 s29, s76, 2
s_lshl_b32 s28, s29, 10
s_add_u32 s28, s28, s47
s_add_u32 m0, s28, 16384
s_lshl_b32 s29, s29, 17
buffer_load_dwordx4 v40, s[12:15], s29 offen lds
s_xor_b32 s29, s76, 3
s_lshl_b32 s28, s29, 10
s_add_u32 s28, s28, s47
s_add_u32 m0, s28, 16384
s_lshl_b32 s29, s29, 17
buffer_load_dwordx4 v40, s[12:15], s29 offen lds
s_xor_b32 s29, s76, 4
s_lshl_b32 s28, s29, 10
s_add_u32 s28, s28, s47
s_add_u32 m0, s28, 16384
s_lshl_b32 s29, s29, 17
buffer_load_dwordx4 v40, s[12:15], s29 offen lds
s_xor_b32 s29, s76, 5
s_lshl_b32 s28, s29, 10
s_add_u32 s28, s28, s47
s_add_u32 m0, s28, 16384
s_lshl_b32 s29, s29, 17
buffer_load_dwordx4 v40, s[12:15], s29 offen lds
s_xor_b32 s29, s76, 6
s_lshl_b32 s28, s29, 10
s_add_u32 s28, s28, s47
s_add_u32 m0, s28, 16384
s_lshl_b32 s29, s29, 17
buffer_load_dwordx4 v40, s[12:15], s29 offen lds
s_xor_b32 s29, s76, 7
s_lshl_b32 s28, s29, 10
s_add_u32 s28, s28, s47
s_add_u32 m0, s28, 16384
s_lshl_b32 s29, s29, 17
buffer_load_dwordx4 v40, s[12:15], s29 offen lds
s_xor_b32 s29, s76, 8
s_lshl_b32 s28, s29, 10
s_add_u32 s28, s28, s47
s_add_u32 m0, s28, 16384
s_lshl_b32 s29, s29, 17
buffer_load_dwordx4 v40, s[12:15], s29 offen lds
s_xor_b32 s29, s76, 9
s_lshl_b32 s28, s29, 10
s_add_u32 s28, s28, s47
s_add_u32 m0, s28, 16384
s_lshl_b32 s29, s29, 17
buffer_load_dwordx4 v40, s[12:15], s29 offen lds
s_xor_b32 s29, s76, 10
s_lshl_b32 s28, s29, 10
s_add_u32 s28, s28, s47
s_add_u32 m0, s28, 16384
s_lshl_b32 s29, s29, 17
buffer_load_dwordx4 v40, s[12:15], s29 offen lds
s_xor_b32 s29, s76, 11
s_lshl_b32 s28, s29, 10
s_add_u32 s28, s28, s47
s_add_u32 m0, s28, 16384
s_lshl_b32 s29, s29, 17
buffer_load_dwordx4 v40, s[12:15], s29 offen lds
s_xor_b32 s29, s76, 12
s_lshl_b32 s28, s29, 10
s_add_u32 s28, s28, s47
s_add_u32 m0, s28, 16384
s_lshl_b32 s29, s29, 17
buffer_load_dwordx4 v40, s[12:15], s29 offen lds
s_xor_b32 s29, s76, 13
s_lshl_b32 s28, s29, 10
s_add_u32 s28, s28, s47
s_add_u32 m0, s28, 16384
s_lshl_b32 s29, s29, 17
buffer_load_dwordx4 v40, s[12:15], s29 offen lds
s_xor_b32 s29, s76, 14
s_lshl_b32 s28, s29, 10
s_add_u32 s28, s28, s47
s_add_u32 m0, s28, 16384
s_lshl_b32 s29, s29, 17
buffer_load_dwordx4 v40, s[12:15], s29 offen lds
s_xor_b32 s29, s76, 15
s_lshl_b32 s28, s29, 10
s_add_u32 s28, s28, s47
s_add_u32 m0, s28, 16384
s_lshl_b32 s29, s29, 17
buffer_load_dwordx4 v40, s[12:15], s29 offen lds
s_mov_b32 s40, 0x00ff00ff
s_mov_b32 s41, 0x00ff00ff
s_mov_b32 s48, 0xff00ff00
s_mov_b32 s49, 0xff00ff00
s_mov_b32 s42, 0
s_mov_b32 s43, 0x00ff00ff
s_mov_b32 s32, 0x3e0293ee
v_mov_b32 v23, 0xff800000
v_mov_b32 v6, 0x4444
v_mov_b32 v4, 0xeeee
v_cndmask_b32 v6, v6, v4, s[48:49]
v_mov_b32 v28, -1
v_mov_b32 v29, -1
v_mov_b32 v30, -1
v_mov_b32 v31, -1
s_mul_i32 s28, s24, 4096
v_add_u32 v7, s28, v17
v_and_b32 v4, 7, v1
v_lshlrev_b32 v8, 11, v4
v_lshrrev_b32 v5, 3, v1
v_lshl_add_u32 v8, v5, 4, v8
s_lshl_b32 s28, s24, 9
v_add_u32 v8, s28, v8
s_lshl_b32 s28, s31, 9
s_lshr_b32 s29, s31, 3
s_mul_i32 s29, s29, 0
s_add_u32 s28, s28, s29
v_lshlrev_b32 v9, 3, v1
v_add_u32 v9, s28, v9
v_and_b32 v4, 7, v3
v_lshlrev_b32 v11, 7, v2
v_lshl_add_u32 v11, v4, 4, v11
v_add_u32 v22, 0, v11
s_add_u32 s28, s28, 24576
v_add_u32 v11, s28, v11
v_and_b32 v5, 1, v2
v_lshlrev_b32 v10, 7, v5
v_lshl_add_u32 v10, v4, 4, v10
v_add_u32 v10, 1024, v10
s_xor_b32 s37, s31, 1
s_mul_i32 s37, s37, 2048
s_add_u32 s37, s37, 49152
s_xor_b32 s38, s31, 2
s_mul_i32 s38, s38, 2048
s_add_u32 s38, s38, 49152
s_xor_b32 s39, s31, 3
s_mul_i32 s39, s39, 2048
s_add_u32 s39, s39, 49152
v_and_b32 v4, 1, v2
v_mul_u32_u24 v14, 576, v4
v_lshrrev_b32 v5, 1, v2
v_lshl_add_u32 v5, v5, 4, v3
v_lshl_add_u32 v14, v5, 2, v14
s_mul_i32 s28, s24, 1152
s_add_u32 s28, s28, 13312
v_add_u32 v18, s28, v14
s_mul_i32 s28, s24, 2304
v_add_u32 v14, s28, v14
v_add_u32 v15, 1152, v14
v_mul_u32_u24 v16, 144, v3
v_lshl_add_u32 v16, v2, 5, v16
v_bfe_u32 v4, v1, 1, 3
v_mul_u32_u24 v19, 144, v4
v_lshl_add_u32 v19, v2, 5, v19
v_and_b32 v4, 1, v1
v_lshl_add_u32 v19, v4, 4, v19
v_add_u32 v19, 13312, v19
s_lshl_b32 s28, s24, 10
s_add_u32 s28, s28, 9216
v_add_u32 v20, s28, v17
v_and_b32 v4, 31, v1
v_lshlrev_b32 v21, 3, v4
v_add_u32 v21, 17920, v21
v_lshrrev_b32 v4, 2, v3
v_and_b32 v42, 1, v4
v_lshrrev_b32 v43, 1, v4
v_lshrrev_b32 v44, 1, v2
v_and_b32 v45, 1, v2
v_lshl_add_u32 v46, v44, 4, v42
v_lshl_add_u32 v46, v45, 2, v46
v_lshl_add_u32 v46, v43, 3, v46
v_lshl_add_u32 v47, v44, 3, v42
v_lshl_add_u32 v47, v45, 4, v47
v_lshl_add_u32 v47, v43, 2, v47
v_and_b32 v5, 3, v3
v_lshlrev_b32 v5, 3, v5
v_lshl_add_u32 v46, v46, 6, v5
v_lshl_add_u32 v47, v47, 6, v5
s_and_b32 s28, s31, 0
s_lshl_b32 s28, s28, 6
s_add_u32 s28, s28, s47
v_add_u32 v46, s28, v46
v_add_u32 v47, s28, v47
s_waitcnt vmcnt(17)
ds_read_b64_tr_b16 a[64:65], v46 offset:0
ds_read_b64_tr_b16 a[66:67], v46 offset:128
ds_read_b64_tr_b16 a[68:69], v46 offset:2048
ds_read_b64_tr_b16 a[70:71], v46 offset:2176
ds_read_b64_tr_b16 a[72:73], v46 offset:4096
ds_read_b64_tr_b16 a[74:75], v46 offset:4224
ds_read_b64_tr_b16 a[76:77], v46 offset:6144
ds_read_b64_tr_b16 a[78:79], v46 offset:6272
s_waitcnt lgkmcnt(0)
ds_read_b64_tr_b16 a[80:81], v46 offset:8192
ds_read_b64_tr_b16 a[82:83], v46 offset:8320
ds_read_b64_tr_b16 a[84:85], v46 offset:10240
ds_read_b64_tr_b16 a[86:87], v46 offset:10368
ds_read_b64_tr_b16 a[88:89], v46 offset:12288
ds_read_b64_tr_b16 a[90:91], v46 offset:12416
ds_read_b64_tr_b16 a[92:93], v46 offset:14336
ds_read_b64_tr_b16 a[94:95], v46 offset:14464
s_waitcnt lgkmcnt(0)
ds_read_b64_tr_b16 a[96:97], v46 offset:32
ds_read_b64_tr_b16 a[98:99], v46 offset:160
ds_read_b64_tr_b16 a[100:101], v46 offset:2080
ds_read_b64_tr_b16 a[102:103], v46 offset:2208
ds_read_b64_tr_b16 a[104:105], v46 offset:4128
ds_read_b64_tr_b16 a[106:107], v46 offset:4256
ds_read_b64_tr_b16 a[108:109], v46 offset:6176
ds_read_b64_tr_b16 a[110:111], v46 offset:6304
s_waitcnt lgkmcnt(0)
ds_read_b64_tr_b16 a[112:113], v46 offset:8224
ds_read_b64_tr_b16 a[114:115], v46 offset:8352
ds_read_b64_tr_b16 a[116:117], v46 offset:10272
ds_read_b64_tr_b16 a[118:119], v46 offset:10400
ds_read_b64_tr_b16 a[120:121], v46 offset:12320
ds_read_b64_tr_b16 a[122:123], v46 offset:12448
ds_read_b64_tr_b16 a[124:125], v46 offset:14368
ds_read_b64_tr_b16 a[126:127], v46 offset:14496
s_waitcnt lgkmcnt(0)
buffer_load_dword v50, v51, s[4:7], 0 offen
s_xor_b32 s29, s76, 0
s_lshl_b32 s28, s29, 10
s_add_u32 s28, s28, s47
s_add_u32 m0, s28, 0
s_lshl_b32 s29, s29, 17
buffer_load_dwordx4 v40, s[4:7], s29 offen lds
s_xor_b32 s29, s76, 1
s_lshl_b32 s28, s29, 10
s_add_u32 s28, s28, s47
s_add_u32 m0, s28, 0
s_lshl_b32 s29, s29, 17
buffer_load_dwordx4 v40, s[4:7], s29 offen lds
s_xor_b32 s29, s76, 2
s_lshl_b32 s28, s29, 10
s_add_u32 s28, s28, s47
s_add_u32 m0, s28, 0
s_lshl_b32 s29, s29, 17
buffer_load_dwordx4 v40, s[4:7], s29 offen lds
s_xor_b32 s29, s76, 3
s_lshl_b32 s28, s29, 10
s_add_u32 s28, s28, s47
s_add_u32 m0, s28, 0
s_lshl_b32 s29, s29, 17
buffer_load_dwordx4 v40, s[4:7], s29 offen lds
s_xor_b32 s29, s76, 4
s_lshl_b32 s28, s29, 10
s_add_u32 s28, s28, s47
s_add_u32 m0, s28, 0
s_lshl_b32 s29, s29, 17
buffer_load_dwordx4 v40, s[4:7], s29 offen lds
s_xor_b32 s29, s76, 5
s_lshl_b32 s28, s29, 10
s_add_u32 s28, s28, s47
s_add_u32 m0, s28, 0
s_lshl_b32 s29, s29, 17
buffer_load_dwordx4 v40, s[4:7], s29 offen lds
s_xor_b32 s29, s76, 6
s_lshl_b32 s28, s29, 10
s_add_u32 s28, s28, s47
s_add_u32 m0, s28, 0
s_lshl_b32 s29, s29, 17
buffer_load_dwordx4 v40, s[4:7], s29 offen lds
s_xor_b32 s29, s76, 7
s_lshl_b32 s28, s29, 10
s_add_u32 s28, s28, s47
s_add_u32 m0, s28, 0
s_lshl_b32 s29, s29, 17
buffer_load_dwordx4 v40, s[4:7], s29 offen lds
s_xor_b32 s29, s76, 8
s_lshl_b32 s28, s29, 10
s_add_u32 s28, s28, s47
s_add_u32 m0, s28, 0
s_lshl_b32 s29, s29, 17
buffer_load_dwordx4 v40, s[4:7], s29 offen lds
s_xor_b32 s29, s76, 9
s_lshl_b32 s28, s29, 10
s_add_u32 s28, s28, s47
s_add_u32 m0, s28, 0
s_lshl_b32 s29, s29, 17
buffer_load_dwordx4 v40, s[4:7], s29 offen lds
s_xor_b32 s29, s76, 10
s_lshl_b32 s28, s29, 10
s_add_u32 s28, s28, s47
s_add_u32 m0, s28, 0
s_lshl_b32 s29, s29, 17
buffer_load_dwordx4 v40, s[4:7], s29 offen lds
s_xor_b32 s29, s76, 11
s_lshl_b32 s28, s29, 10
s_add_u32 s28, s28, s47
s_add_u32 m0, s28, 0
s_lshl_b32 s29, s29, 17
buffer_load_dwordx4 v40, s[4:7], s29 offen lds
s_xor_b32 s29, s76, 12
s_lshl_b32 s28, s29, 10
s_add_u32 s28, s28, s47
s_add_u32 m0, s28, 0
s_lshl_b32 s29, s29, 17
buffer_load_dwordx4 v40, s[4:7], s29 offen lds
s_xor_b32 s29, s76, 13
s_lshl_b32 s28, s29, 10
s_add_u32 s28, s28, s47
s_add_u32 m0, s28, 0
s_lshl_b32 s29, s29, 17
buffer_load_dwordx4 v40, s[4:7], s29 offen lds
s_xor_b32 s29, s76, 14
s_lshl_b32 s28, s29, 10
s_add_u32 s28, s28, s47
s_add_u32 m0, s28, 0
s_lshl_b32 s29, s29, 17
buffer_load_dwordx4 v40, s[4:7], s29 offen lds
s_xor_b32 s29, s76, 15
s_lshl_b32 s28, s29, 10
s_add_u32 s28, s28, s47
s_add_u32 m0, s28, 0
s_lshl_b32 s29, s29, 17
buffer_load_dwordx4 v40, s[4:7], s29 offen lds
s_waitcnt vmcnt(17)
ds_read_b64_tr_b16 a[128:129], v46 offset:16384
ds_read_b64_tr_b16 a[130:131], v46 offset:16512
ds_read_b64_tr_b16 a[132:133], v46 offset:18432
ds_read_b64_tr_b16 a[134:135], v46 offset:18560
ds_read_b64_tr_b16 a[136:137], v46 offset:20480
ds_read_b64_tr_b16 a[138:139], v46 offset:20608
ds_read_b64_tr_b16 a[140:141], v46 offset:22528
ds_read_b64_tr_b16 a[142:143], v46 offset:22656
s_waitcnt lgkmcnt(0)
ds_read_b64_tr_b16 a[144:145], v46 offset:24576
ds_read_b64_tr_b16 a[146:147], v46 offset:24704
ds_read_b64_tr_b16 a[148:149], v46 offset:26624
ds_read_b64_tr_b16 a[150:151], v46 offset:26752
ds_read_b64_tr_b16 a[152:153], v46 offset:28672
ds_read_b64_tr_b16 a[154:155], v46 offset:28800
ds_read_b64_tr_b16 a[156:157], v46 offset:30720
ds_read_b64_tr_b16 a[158:159], v46 offset:30848
s_waitcnt lgkmcnt(0)
ds_read_b64_tr_b16 a[160:161], v46 offset:16416
ds_read_b64_tr_b16 a[162:163], v46 offset:16544
ds_read_b64_tr_b16 a[164:165], v46 offset:18464
ds_read_b64_tr_b16 a[166:167], v46 offset:18592
ds_read_b64_tr_b16 a[168:169], v46 offset:20512
ds_read_b64_tr_b16 a[170:171], v46 offset:20640
ds_read_b64_tr_b16 a[172:173], v46 offset:22560
ds_read_b64_tr_b16 a[174:175], v46 offset:22688
s_waitcnt lgkmcnt(0)
ds_read_b64_tr_b16 a[176:177], v46 offset:24608
ds_read_b64_tr_b16 a[178:179], v46 offset:24736
ds_read_b64_tr_b16 a[180:181], v46 offset:26656
ds_read_b64_tr_b16 a[182:183], v46 offset:26784
ds_read_b64_tr_b16 a[184:185], v46 offset:28704
ds_read_b64_tr_b16 a[186:187], v46 offset:28832
ds_read_b64_tr_b16 a[188:189], v46 offset:30752
ds_read_b64_tr_b16 a[190:191], v46 offset:30880
s_waitcnt lgkmcnt(0)
buffer_load_dword v50, v52, s[16:19], 0 offen
s_xor_b32 s29, s76, 0
s_lshl_b32 s28, s29, 10
s_add_u32 s28, s28, s47
s_add_u32 m0, s28, 16384
s_lshl_b32 s29, s29, 15
buffer_load_dwordx4 v41, s[16:19], s29 offen lds
s_xor_b32 s29, s76, 1
s_lshl_b32 s28, s29, 10
s_add_u32 s28, s28, s47
s_add_u32 m0, s28, 16384
s_lshl_b32 s29, s29, 15
buffer_load_dwordx4 v41, s[16:19], s29 offen lds
s_xor_b32 s29, s76, 2
s_lshl_b32 s28, s29, 10
s_add_u32 s28, s28, s47
s_add_u32 m0, s28, 16384
s_lshl_b32 s29, s29, 15
buffer_load_dwordx4 v41, s[16:19], s29 offen lds
s_xor_b32 s29, s76, 3
s_lshl_b32 s28, s29, 10
s_add_u32 s28, s28, s47
s_add_u32 m0, s28, 16384
s_lshl_b32 s29, s29, 15
buffer_load_dwordx4 v41, s[16:19], s29 offen lds
s_xor_b32 s29, s76, 4
s_lshl_b32 s28, s29, 10
s_add_u32 s28, s28, s47
s_add_u32 m0, s28, 16384
s_lshl_b32 s29, s29, 15
buffer_load_dwordx4 v41, s[16:19], s29 offen lds
s_xor_b32 s29, s76, 5
s_lshl_b32 s28, s29, 10
s_add_u32 s28, s28, s47
s_add_u32 m0, s28, 16384
s_lshl_b32 s29, s29, 15
buffer_load_dwordx4 v41, s[16:19], s29 offen lds
s_xor_b32 s29, s76, 6
s_lshl_b32 s28, s29, 10
s_add_u32 s28, s28, s47
s_add_u32 m0, s28, 16384
s_lshl_b32 s29, s29, 15
buffer_load_dwordx4 v41, s[16:19], s29 offen lds
s_xor_b32 s29, s76, 7
s_lshl_b32 s28, s29, 10
s_add_u32 s28, s28, s47
s_add_u32 m0, s28, 16384
s_lshl_b32 s29, s29, 15
buffer_load_dwordx4 v41, s[16:19], s29 offen lds
s_xor_b32 s29, s76, 8
s_lshl_b32 s28, s29, 10
s_add_u32 s28, s28, s47
s_add_u32 m0, s28, 16384
s_lshl_b32 s29, s29, 15
buffer_load_dwordx4 v41, s[16:19], s29 offen lds
s_xor_b32 s29, s76, 9
s_lshl_b32 s28, s29, 10
s_add_u32 s28, s28, s47
s_add_u32 m0, s28, 16384
s_lshl_b32 s29, s29, 15
buffer_load_dwordx4 v41, s[16:19], s29 offen lds
s_xor_b32 s29, s76, 10
s_lshl_b32 s28, s29, 10
s_add_u32 s28, s28, s47
s_add_u32 m0, s28, 16384
s_lshl_b32 s29, s29, 15
buffer_load_dwordx4 v41, s[16:19], s29 offen lds
s_xor_b32 s29, s76, 11
s_lshl_b32 s28, s29, 10
s_add_u32 s28, s28, s47
s_add_u32 m0, s28, 16384
s_lshl_b32 s29, s29, 15
buffer_load_dwordx4 v41, s[16:19], s29 offen lds
s_xor_b32 s29, s76, 12
s_lshl_b32 s28, s29, 10
s_add_u32 s28, s28, s47
s_add_u32 m0, s28, 16384
s_lshl_b32 s29, s29, 15
buffer_load_dwordx4 v41, s[16:19], s29 offen lds
s_xor_b32 s29, s76, 13
s_lshl_b32 s28, s29, 10
s_add_u32 s28, s28, s47
s_add_u32 m0, s28, 16384
s_lshl_b32 s29, s29, 15
buffer_load_dwordx4 v41, s[16:19], s29 offen lds
s_xor_b32 s29, s76, 14
s_lshl_b32 s28, s29, 10
s_add_u32 s28, s28, s47
s_add_u32 m0, s28, 16384
s_lshl_b32 s29, s29, 15
buffer_load_dwordx4 v41, s[16:19], s29 offen lds
s_xor_b32 s29, s76, 15
s_lshl_b32 s28, s29, 10
s_add_u32 s28, s28, s47
s_add_u32 m0, s28, 16384
s_lshl_b32 s29, s29, 15
buffer_load_dwordx4 v41, s[16:19], s29 offen lds
s_waitcnt vmcnt(17)
ds_read_b64_tr_b16 a[0:1], v46 offset:0
ds_read_b64_tr_b16 a[2:3], v46 offset:128
ds_read_b64_tr_b16 a[4:5], v46 offset:2048
ds_read_b64_tr_b16 a[6:7], v46 offset:2176
ds_read_b64_tr_b16 a[8:9], v46 offset:4096
ds_read_b64_tr_b16 a[10:11], v46 offset:4224
ds_read_b64_tr_b16 a[12:13], v46 offset:6144
ds_read_b64_tr_b16 a[14:15], v46 offset:6272
s_waitcnt lgkmcnt(0)
ds_read_b64_tr_b16 a[16:17], v46 offset:8192
ds_read_b64_tr_b16 a[18:19], v46 offset:8320
ds_read_b64_tr_b16 a[20:21], v46 offset:10240
ds_read_b64_tr_b16 a[22:23], v46 offset:10368
ds_read_b64_tr_b16 a[24:25], v46 offset:12288
ds_read_b64_tr_b16 a[26:27], v46 offset:12416
ds_read_b64_tr_b16 a[28:29], v46 offset:14336
ds_read_b64_tr_b16 a[30:31], v46 offset:14464
s_waitcnt lgkmcnt(0)
ds_read_b64_tr_b16 a[32:33], v46 offset:32
ds_read_b64_tr_b16 a[34:35], v46 offset:160
ds_read_b64_tr_b16 a[36:37], v46 offset:2080
ds_read_b64_tr_b16 a[38:39], v46 offset:2208
ds_read_b64_tr_b16 a[40:41], v46 offset:4128
ds_read_b64_tr_b16 a[42:43], v46 offset:4256
ds_read_b64_tr_b16 a[44:45], v46 offset:6176
ds_read_b64_tr_b16 a[46:47], v46 offset:6304
s_waitcnt lgkmcnt(0)
ds_read_b64_tr_b16 a[48:49], v46 offset:8224
ds_read_b64_tr_b16 a[50:51], v46 offset:8352
ds_read_b64_tr_b16 a[52:53], v46 offset:10272
ds_read_b64_tr_b16 a[54:55], v46 offset:10400
ds_read_b64_tr_b16 a[56:57], v46 offset:12320
ds_read_b64_tr_b16 a[58:59], v46 offset:12448
ds_read_b64_tr_b16 a[60:61], v46 offset:14368
ds_read_b64_tr_b16 a[62:63], v46 offset:14496
s_waitcnt lgkmcnt(0)
s_waitcnt vmcnt(0)
ds_read_b64_tr_b16 a[192:193], v47 offset:16384
ds_read_b64_tr_b16 a[194:195], v47 offset:16512
ds_read_b64_tr_b16 a[196:197], v47 offset:18432
ds_read_b64_tr_b16 a[198:199], v47 offset:18560
ds_read_b64_tr_b16 a[200:201], v47 offset:20480
ds_read_b64_tr_b16 a[202:203], v47 offset:20608
ds_read_b64_tr_b16 a[204:205], v47 offset:22528
ds_read_b64_tr_b16 a[206:207], v47 offset:22656
s_waitcnt lgkmcnt(0)
ds_read_b64_tr_b16 a[208:209], v47 offset:24576
ds_read_b64_tr_b16 a[210:211], v47 offset:24704
ds_read_b64_tr_b16 a[212:213], v47 offset:26624
ds_read_b64_tr_b16 a[214:215], v47 offset:26752
ds_read_b64_tr_b16 a[216:217], v47 offset:28672
ds_read_b64_tr_b16 a[218:219], v47 offset:28800
ds_read_b64_tr_b16 a[220:221], v47 offset:30720
ds_read_b64_tr_b16 a[222:223], v47 offset:30848
s_waitcnt lgkmcnt(0)
ds_read_b64_tr_b16 a[224:225], v47 offset:16416
ds_read_b64_tr_b16 a[226:227], v47 offset:16544
ds_read_b64_tr_b16 a[228:229], v47 offset:18464
ds_read_b64_tr_b16 a[230:231], v47 offset:18592
ds_read_b64_tr_b16 a[232:233], v47 offset:20512
ds_read_b64_tr_b16 a[234:235], v47 offset:20640
ds_read_b64_tr_b16 a[236:237], v47 offset:22560
ds_read_b64_tr_b16 a[238:239], v47 offset:22688
s_waitcnt lgkmcnt(0)
ds_read_b64_tr_b16 a[240:241], v47 offset:24608
ds_read_b64_tr_b16 a[242:243], v47 offset:24736
ds_read_b64_tr_b16 a[244:245], v47 offset:26656
ds_read_b64_tr_b16 a[246:247], v47 offset:26784
ds_read_b64_tr_b16 a[248:249], v47 offset:28704
ds_read_b64_tr_b16 a[250:251], v47 offset:28832
ds_read_b64_tr_b16 a[252:253], v47 offset:30752
ds_read_b64_tr_b16 a[254:255], v47 offset:30880
s_waitcnt lgkmcnt(0)
v_and_b32 v5, 15, v0
v_lshlrev_b32 v5, 4, v5
s_branch mega_kernel_syr
mega_kernel_syrw:
s_sleep 4
mega_kernel_syr:
buffer_load_dword v4, v5, s[72:75], 0 offen sc1
s_waitcnt vmcnt(0)
s_cmp_eq_u32 s95, 1
s_cbranch_scc0 mega_kernel_syrf
v_readlane_b32 s76, v4, 14
s_mov_b32 s98, 0
s_cmp_eq_u32 s76, 64
s_cbranch_scc0 mega_kernel_syrw
s_branch mega_kernel_syrd
mega_kernel_syrf:
s_mov_b32 s77, 0
s_mov_b32 s78, 0
v_readlane_b32 s76, v4, 0
s_add_u32 s77, s77, s76
s_xor_b32 s76, s76, 32
s_or_b32 s78, s78, s76
v_readlane_b32 s76, v4, 1
s_add_u32 s77, s77, s76
s_xor_b32 s76, s76, 32
s_or_b32 s78, s78, s76
v_readlane_b32 s76, v4, 2
s_add_u32 s77, s77, s76
s_xor_b32 s76, s76, 32
s_or_b32 s78, s78, s76
v_readlane_b32 s76, v4, 3
s_add_u32 s77, s77, s76
s_xor_b32 s76, s76, 32
s_or_b32 s78, s78, s76
v_readlane_b32 s76, v4, 4
s_add_u32 s77, s77, s76
s_xor_b32 s76, s76, 32
s_or_b32 s78, s78, s76
v_readlane_b32 s76, v4, 5
s_add_u32 s77, s77, s76
s_xor_b32 s76, s76, 32
s_or_b32 s78, s78, s76
v_readlane_b32 s76, v4, 6
s_add_u32 s77, s77, s76
s_xor_b32 s76, s76, 32
s_or_b32 s78, s78, s76
v_readlane_b32 s76, v4, 7
s_add_u32 s77, s77, s76
s_xor_b32 s76, s76, 32
s_or_b32 s78, s78, s76
s_cmp_eq_u32 s77, 256
s_cbranch_scc0 mega_kernel_syrw
v_mov_b32 v252, v4
s_cmp_eq_u32 s78, 0
s_cbranch_scc0 mega_kernel_slowent
v_readlane_b32 s76, v4, 10
v_readlane_b32 s77, v4, 8
s_cmp_eq_u32 s76, 64
s_cbranch_scc0 mega_kernel_syrw
s_cmp_gt_u32 s77, 32
s_cselect_b32 s98, 1, 0
mega_kernel_syrd:
s_lshr_b32 s28, s31, 3
s_lshl_b32 s28, s28, 14
s_lshl_b32 s29, s98, 13
s_add_u32 s28, s28, s29
s_and_b32 s29, s31, 7
s_lshl_b32 s29, s29, 10
s_add_u32 s28, s28, s29
s_lshl_b32 s29, s30, 16
s_add_u32 s28, s28, s29
s_add_u32 s28, s28, 67108864
v_add_u32 v12, s28, v17
v_xor_b32 v25, 0x10000, v12
v_xor_b32 v26, 0x20000, v12
v_xor_b32 v27, 0x30000, v12
v_add_u32 v25, 0, v25
v_add_u32 v26, 0, v26
v_add_u32 v27, 0, v27
s_lshl_b32 s28, s25, 2
s_add_u32 s28, s28, s26
s_mov_b32 s82, s28
s_lshr_b32 s29, s28, 3
s_xor_b32 s29, s29, s98
s_and_b32 s29, s29, 1
s_lshl_b32 s29, s29, 13
s_lshl_b32 s76, s28, 18
s_add_u32 s76, s76, s29
s_mov_b32 s83, s76
v_add_u32 v240, s76, v17
v_add_u32 v241, 33554432, v240
s_lshr_b32 s29, s28, 4
s_xor_b32 s29, s29, s98
s_and_b32 s29, s29, 1
s_lshl_b32 s29, s29, 13
s_lshl_b32 s79, s28, 17
s_add_u32 s79, s79, s29
s_add_u32 s79, s79, 71303168
s_xor_b32 s29, s98, 1
s_lshl_b32 s29, s29, 13
s_lshl_b32 s28, s25, 7
s_add_u32 s28, s28, s29
s_add_u32 s28, s28, 69206016
v_and_b32 v4, 1, v1
v_lshlrev_b32 v24, 12, v4
v_add_u32 v24, s28, v24
s_lshl_b32 s29, s26, 2
v_add_u32 v24, s29, v24
s_xor_b32 s81, s98, 1
s_lshl_b32 s81, s81, 13
s_lshr_b32 s29, s82, 6
s_lshl_b32 s29, s29, 14
s_add_u32 s81, s81, s29
s_and_b32 s29, s82, 63
s_lshl_b32 s29, s29, 7
s_add_u32 s81, s81, s29
s_add_u32 s81, s81, 69222400
v_mov_b32 v220, 0x3f803f80
v_mov_b32 v221, 0x3f803f80
v_mov_b32 v222, 0x3f803f80
v_mov_b32 v223, 0x3f803f80
v_mov_b32 v228, 0
s_mov_b32 s27, 0
s_mov_b32 s46, 0
s_mov_b32 s89, 0
s_mov_b32 s88, 0
s_mov_b32 s44, 18432
s_mov_b32 s45, 18432
s_cmp_eq_u32 s24, 3
s_cbranch_scc0 mega_kernel_rf_pfi
s_mov_b32 s76, 0
s_cmp_gt_i32 s46, s76
s_cbranch_scc1 mega_kernel_rf_pf0ok
mega_kernel_rf_pf0w:
buffer_load_dword v4, v24, s[84:87], 0 offen sc1
s_waitcnt vmcnt(0)
v_readlane_b32 s46, v4, 0
v_readlane_b32 s28, v4, 1
s_nop 1
s_min_i32 s46, s46, s28
s_cmp_gt_i32 s46, s76
s_cbranch_scc0 mega_kernel_rf_pf0w
mega_kernel_rf_pf0ok:
s_add_u32 s77, s76, s82
s_bfe_u32 s28, s77, 0x40002
s_lshl_b32 s28, s28, 14
s_and_b32 s77, s77, 3
s_lshl_b32 s77, s77, 11
s_add_u32 s28, s28, s77
s_add_u32 m0, s45, 0
s_nop 0
buffer_load_dwordx4 v240, s[84:87], s28 offen offset:0 sc1 lds
s_add_u32 m0, s45, 0
s_nop 0
buffer_load_dwordx4 v240, s[84:87], s28 offen offset:1024 sc1 lds
s_add_u32 m0, s45, 2048
s_nop 0
buffer_load_dwordx4 v241, s[84:87], s28 offen offset:0 sc1 lds
s_add_u32 m0, s45, 2048
s_nop 0
buffer_load_dwordx4 v241, s[84:87], s28 offen offset:1024 sc1 lds
s_add_u32 s45, s45, 4096
s_cmp_eq_u32 s45, 30720
s_cselect_b32 s45, 18432, s45
s_waitcnt vmcnt(0) lgkmcnt(0)
mega_kernel_rf_pfi:
v_mov_b32 v184, 0
v_mov_b32 v185, 0
v_mov_b32 v186, 0
v_mov_b32 v187, 0
v_mov_b32 v188, 0
v_mov_b32 v189, 0
v_mov_b32 v190, 0
v_mov_b32 v191, 0
v_mov_b32 v192, 0
v_mov_b32 v193, 0
v_mov_b32 v194, 0
v_mov_b32 v195, 0
v_mov_b32 v196, 0
v_mov_b32 v197, 0
v_mov_b32 v198, 0
v_mov_b32 v199, 0
v_mov_b32 v200, 0
v_mov_b32 v201, 0
v_mov_b32 v202, 0
v_mov_b32 v203, 0
v_mov_b32 v204, 0
v_mov_b32 v205, 0
v_mov_b32 v206, 0
v_mov_b32 v207, 0
v_mov_b32 v96, 0
v_mov_b32 v97, 0
v_mov_b32 v98, 0
v_mov_b32 v99, 0
v_mov_b32 v100, 0
v_mov_b32 v101, 0
v_mov_b32 v102, 0
v_mov_b32 v103, 0
v_mov_b32 v104, 0
v_mov_b32 v105, 0
v_mov_b32 v106, 0
v_mov_b32 v107, 0
v_mov_b32 v108, 0
v_mov_b32 v109, 0
v_mov_b32 v110, 0
v_mov_b32 v111, 0
v_mov_b32 v112, 0
v_mov_b32 v113, 0
v_mov_b32 v114, 0
v_mov_b32 v115, 0
v_mov_b32 v116, 0
v_mov_b32 v117, 0
v_mov_b32 v118, 0
v_mov_b32 v119, 0
s_barrier
s_and_b32 s29, s27, 1
s_lshl_b32 s33, s29, 17
s_lshl_b32 s28, s30, 18
s_add_u32 s33, s33, s28
s_add_u32 s33, s33, 68157440
s_xor_b32 s34, s33, 131072
s_lshl_b32 s35, s29, 18
s_bfe_u32 s47, s27, 0x10001
s_branch mega_kernel_rf_first
.p2align 6
s_nop 0
s_nop 0
mega_kernel_rf_loop:
buffer_load_dwordx4 v[32:35], v7, s[84:87], s33 offen offset:0 sc1
v_add_u32 v5, s44, v17
ds_read_b128 v[156:159], v5 offset:0
ds_read_b128 v[160:163], v5 offset:1024
ds_read_b128 v[164:167], v5 offset:2048
ds_read_b128 v[168:171], v5 offset:3072
s_nop 4
buffer_load_dwordx4 v[36:39], v7, s[84:87], s33 offen offset:1024 sc1
s_nop 9
buffer_load_dwordx4 v[40:43], v7, s[84:87], s33 offen offset:2048 sc1
s_nop 9
buffer_load_dwordx4 v[44:47], v7, s[84:87], s33 offen offset:3072 sc1
s_waitcnt vmcnt(3)
v_max_u32 v4, v32, v34
v_cmp_eq_u32 vcc, -1, v4
s_cbranch_vccnz mega_kernel_rf_pa_15_0f
v_smfmac_f32_16x16x64_bf16 v[96:99], v[32:35], a[0:7], v6
v_smfmac_f32_16x16x64_bf16 v[100:103], v[32:35], a[32:39], v6
v_smfmac_f32_16x16x64_bf16 v[104:107], v[32:35], a[64:71], v6
s_waitcnt vmcnt(2)
v_max_u32 v4, v36, v38
v_cmp_eq_u32 vcc, -1, v4
v_smfmac_f32_16x16x64_bf16 v[108:111], v[32:35], a[96:103], v6
s_cbranch_vccnz mega_kernel_rf_pa_14_1f
v_smfmac_f32_16x16x64_bf16 v[96:99], v[36:39], a[8:15], v6
v_smfmac_f32_16x16x64_bf16 v[100:103], v[36:39], a[40:47], v6
v_smfmac_f32_16x16x64_bf16 v[104:107], v[36:39], a[72:79], v6
s_waitcnt vmcnt(1)
v_max_u32 v4, v40, v42
v_cmp_eq_u32 vcc, -1, v4
v_smfmac_f32_16x16x64_bf16 v[108:111], v[36:39], a[104:111], v6
s_cbranch_vccnz mega_kernel_rf_pa_12_2f
v_smfmac_f32_16x16x64_bf16 v[96:99], v[40:43], a[16:23], v6
v_smfmac_f32_16x16x64_bf16 v[100:103], v[40:43], a[48:55], v6
v_smfmac_f32_16x16x64_bf16 v[104:107], v[40:43], a[80:87], v6
s_waitcnt vmcnt(0)
v_max_u32 v4, v44, v46
v_cmp_eq_u32 vcc, -1, v4
v_smfmac_f32_16x16x64_bf16 v[108:111], v[40:43], a[112:119], v6
s_cbranch_vccnz mega_kernel_rf_pa_8_3f
v_smfmac_f32_16x16x64_bf16 v[96:99], v[44:47], a[24:31], v6
v_smfmac_f32_16x16x64_bf16 v[100:103], v[44:47], a[56:63], v6
v_smfmac_f32_16x16x64_bf16 v[104:107], v[44:47], a[88:95], v6
v_smfmac_f32_16x16x64_bf16 v[108:111], v[44:47], a[120:127], v6
mega_kernel_rf_pa_d:
mega_kernel_rf_adone:
s_nop 5
v_permlane32_swap_b32 v96, v100
v_permlane32_swap_b32 v97, v101
v_permlane32_swap_b32 v98, v102
v_permlane32_swap_b32 v99, v103
v_pk_add_f32 v[96:97], v[96:97], v[100:101]
v_pk_add_f32 v[98:99], v[98:99], v[102:103]
ds_write2_b32 v14, v96, v97 offset0:0 offset1:36
ds_write2_b32 v14, v98, v99 offset0:72 offset1:108
v_permlane32_swap_b32 v104, v108
v_permlane32_swap_b32 v105, v109
v_permlane32_swap_b32 v106, v110
v_permlane32_swap_b32 v107, v111
v_pk_add_f32 v[104:105], v[104:105], v[108:109]
v_pk_add_f32 v[106:107], v[106:107], v[110:111]
ds_write2_b32 v15, v104, v105 offset0:0 offset1:36
ds_write2_b32 v15, v106, v107 offset0:72 offset1:108
v_smfmac_f32_16x16x64_bf16 v[112:115], v[32:35], a[128:135], v6
v_smfmac_f32_16x16x64_bf16 v[116:119], v[32:35], a[160:167], v6
v_smfmac_f32_16x16x64_bf16 v[112:115], v[36:39], a[136:143], v6
v_smfmac_f32_16x16x64_bf16 v[116:119], v[36:39], a[168:175], v6
s_waitcnt lgkmcnt(0)
s_barrier
s_cmp_lg_u32 s24, 0
s_cbranch_scc1 mega_kernel_rf_side
ds_read_b128 v[120:123], v16 offset:0
ds_read_b128 v[124:127], v16 offset:16
ds_read_b128 v[128:131], v16 offset:2304
ds_read_b128 v[132:135], v16 offset:2320
ds_read_b128 v[136:139], v16 offset:4608
ds_read_b128 v[140:143], v16 offset:4624
ds_read_b128 v[144:147], v16 offset:6912
ds_read_b128 v[148:151], v16 offset:6928
v_smfmac_f32_16x16x64_bf16 v[112:115], v[40:43], a[144:151], v6
v_smfmac_f32_16x16x64_bf16 v[116:119], v[40:43], a[176:183], v6
v_smfmac_f32_16x16x64_bf16 v[112:115], v[44:47], a[152:159], v6
v_smfmac_f32_16x16x64_bf16 v[116:119], v[44:47], a[184:191], v6
s_mul_i32 s28, s31, 2048
s_add_u32 s28, s28, s33
s_add_u32 s28, s28, 49152
s_add_u32 s76, s37, s33
s_add_u32 s77, s38, s33
s_add_u32 s78, s39, s33
s_waitcnt lgkmcnt(4)
v_pk_add_f32 v[120:121], v[120:121], v[128:129]
v_pk_add_f32 v[122:123], v[122:123], v[130:131]
v_pk_add_f32 v[124:125], v[124:125], v[132:133]
v_pk_add_f32 v[126:127], v[126:127], v[134:135]
s_waitcnt lgkmcnt(0)
v_pk_add_f32 v[136:137], v[136:137], v[144:145]
v_pk_add_f32 v[138:139], v[138:139], v[146:147]
v_pk_add_f32 v[140:141], v[140:141], v[148:149]
v_pk_add_f32 v[142:143], v[142:143], v[150:151]
v_pk_add_f32 v[120:121], v[120:121], v[136:137]
v_pk_add_f32 v[122:123], v[122:123], v[138:139]
v_pk_add_f32 v[124:125], v[124:125], v[140:141]
v_pk_add_f32 v[126:127], v[126:127], v[142:143]
v_cvt_pk_bf16_f32 v152, v120, v121
v_cvt_pk_bf16_f32 v153, v122, v123
v_cvt_pk_bf16_f32 v154, v124, v125
v_cvt_pk_bf16_f32 v155, v126, v127
s_nop 1
v_mfma_f32_16x16x32_bf16 v[176:179], v[160:163], v[152:155], 0
v_mfma_f32_16x16x32_bf16 v[172:175], v[156:159], v[152:155], 0
v_mfma_f32_16x16x32_bf16 v[180:183], v[152:155], v[152:155], 0
s_cmp_eq_u32 s27, 63
s_cbranch_scc1 mega_kernel_rf_w0last
s_nop 4
v_mov_b32_dpp v172, v176 row_shr:8 row_mask:0xf bank_mask:0xc
v_mov_b32_dpp v173, v177 row_shr:8 row_mask:0xf bank_mask:0xc
v_mov_b32_dpp v174, v178 row_shr:8 row_mask:0xf bank_mask:0xc
v_mov_b32_dpp v175, v179 row_shr:8 row_mask:0xf bank_mask:0xc
v_min_u32 v180, -2, v180
v_min_u32 v172, -2, v172
s_mov_b64 exec, s[42:43]
buffer_store_dwordx4 v[180:183], v10, s[84:87], s28 offen
s_mov_b64 exec, -1
buffer_store_dwordx4 v[172:175], v17, s[84:87], s28 offen
v_permlane32_swap_b32 v112, v116
v_permlane32_swap_b32 v113, v117
v_permlane32_swap_b32 v114, v118
v_permlane32_swap_b32 v115, v119
v_pk_add_f32 v[112:113], v[112:113], v[116:117]
v_pk_add_f32 v[114:115], v[114:115], v[118:119]
ds_write_b128 v20, v[112:115]
s_waitcnt lgkmcnt(0)
s_barrier
v_mov_b32 v96, 0
v_mov_b32 v97, 0
v_mov_b32 v98, 0
v_mov_b32 v99, 0
v_mov_b32 v100, 0
v_mov_b32 v101, 0
v_mov_b32 v102, 0
v_mov_b32 v103, 0
v_cndmask_b32 v176, v23, v180, s[42:43]
v_cndmask_b32 v177, v23, v181, s[42:43]
v_cndmask_b32 v178, v23, v182, s[42:43]
v_cndmask_b32 v179, v23, v183, s[42:43]
s_mov_b64 exec, s[42:43]
buffer_load_dwordx4 v[188:191], v10, s[84:87], s76 offen sc1
buffer_load_dwordx4 v[196:199], v10, s[84:87], s77 offen sc1
buffer_load_dwordx4 v[204:207], v10, s[84:87], s78 offen sc1
s_mov_b64 exec, -1
buffer_load_dwordx4 v[184:187], v17, s[84:87], s76 offen sc1
buffer_load_dwordx4 v[192:195], v17, s[84:87], s77 offen sc1
buffer_load_dwordx4 v[200:203], v17, s[84:87], s78 offen sc1
v_pk_mul_f32 v[172:173], v[172:173], s[32:33] op_sel_hi:[1,0]
v_pk_mul_f32 v[174:175], v[174:175], s[32:33] op_sel_hi:[1,0]
v_pk_mul_f32 v[176:177], v[176:177], s[32:33] op_sel_hi:[1,0]
v_pk_mul_f32 v[178:179], v[178:179], s[32:33] op_sel_hi:[1,0]
s_nop 15
s_nop 3
s_mov_b64 exec, s[42:43]
buffer_load_dwordx4 v[188:191], v10, s[84:87], s76 offen sc1
buffer_load_dwordx4 v[196:199], v10, s[84:87], s77 offen sc1
buffer_load_dwordx4 v[204:207], v10, s[84:87], s78 offen sc1
s_mov_b64 exec, -1
buffer_load_dwordx4 v[184:187], v17, s[84:87], s76 offen sc1
buffer_load_dwordx4 v[192:195], v17, s[84:87], s77 offen sc1
buffer_load_dwordx4 v[200:203], v17, s[84:87], s78 offen sc1
mega_kernel_rf_p2:
s_waitcnt vmcnt(6)
v_max3_u32 v4, v184, v188, v192
v_max3_u32 v5, v196, v200, v204
v_max_u32 v4, v4, v5
v_cmp_eq_u32 vcc, -1, v4
s_cbranch_vccnz mega_kernel_rf_p2r
v_pk_add_f32 v[124:125], v[196:197], v[204:205]
v_pk_add_f32 v[126:127], v[198:199], v[206:207]
v_pk_add_f32 v[120:121], v[192:193], v[200:201]
v_pk_add_f32 v[122:123], v[194:195], v[202:203]
v_pk_add_f32 v[124:125], v[124:125], v[188:189]
v_pk_add_f32 v[126:127], v[126:127], v[190:191]
v_pk_add_f32 v[120:121], v[120:121], v[184:185]
v_pk_add_f32 v[122:123], v[122:123], v[186:187]
v_pk_fma_f32 v[176:177], v[124:125], s[32:33], v[176:177] op_sel_hi:[1,0,1]
v_pk_fma_f32 v[178:179], v[126:127], s[32:33], v[178:179] op_sel_hi:[1,0,1]
v_pk_fma_f32 v[172:173], v[120:121], s[32:33], v[172:173] op_sel_hi:[1,0,1]
v_pk_fma_f32 v[174:175], v[122:123], s[32:33], v[174:175] op_sel_hi:[1,0,1]
v_max3_f32 v232, v172, v173, v174
v_max3_f32 v233, v176, v177, v178
v_max3_f32 v232, v232, v175, v179
v_max_f32 v234, v232, v233
s_barrier
ds_read2_b64 v[208:211], v21 offset0:0 offset1:32
v_max_f32_dpp v232, v234, v234 row_ror:8 row_mask:0xf bank_mask:0xf
v_max_f32_dpp v233, v234, v234 row_ror:8 row_mask:0xf bank_mask:0xf
s_nop 1
v_permlane16_swap_b32 v232, v233
s_nop 0
v_max_f32 v234, v232, v233
v_max_f32 v235, v232, v233
s_nop 1
v_permlane32_swap_b32 v234, v235
s_nop 0
v_max_f32 v232, v234, v235
v_pk_add_f32 v[176:177], v[176:177], v[232:233] op_sel_hi:[1,0] neg_lo:[0,1] neg_hi:[0,1]
v_pk_add_f32 v[178:179], v[178:179], v[232:233] op_sel_hi:[1,0] neg_lo:[0,1] neg_hi:[0,1]
v_pk_add_f32 v[172:173], v[172:173], v[232:233] op_sel_hi:[1,0] neg_lo:[0,1] neg_hi:[0,1]
v_pk_add_f32 v[174:175], v[174:175], v[232:233] op_sel_hi:[1,0] neg_lo:[0,1] neg_hi:[0,1]
v_exp_f32 v176, v176
v_exp_f32 v177, v177
v_exp_f32 v178, v178
v_exp_f32 v179, v179
v_exp_f32 v172, v172
v_cvt_pk_bf16_f32 v216, v176, v177
v_cvt_pk_bf16_f32 v217, v178, v179
v_exp_f32 v173, v173
v_exp_f32 v174, v174
v_mfma_f32_16x16x16_bf16 v[224:227], v[220:221], v[216:217], 0
v_exp_f32 v175, v175
v_cvt_pk_bf16_f32 v212, v172, v173
s_waitcnt lgkmcnt(0)
v_mfma_f32_16x16x16_bf16 v[120:123], v[208:209], v[216:217], 0
v_cvt_pk_bf16_f32 v213, v174, v175
v_mfma_f32_16x16x16_bf16 v[124:127], v[210:211], v[216:217], 0
v_mov_b32_dpp v214, v212 row_ror:8 row_mask:0xf bank_mask:0xf
v_mov_b32_dpp v215, v213 row_ror:8 row_mask:0xf bank_mask:0xf
s_nop 1
v_mfma_f32_16x16x32_bf16 v[224:227], v[220:223], v[212:215], v[224:227]
v_mfma_f32_16x16x32_bf16 v[120:123], v[164:167], v[212:215], v[120:123]
v_mfma_f32_16x16x32_bf16 v[124:127], v[168:171], v[212:215], v[124:127]
s_add_u32 s29, s33, 24576
s_nop 4
v_rcp_f32 v234, v224
s_nop 0
v_pk_mul_f32 v[120:121], v[120:121], v[234:235] op_sel_hi:[1,0]
v_pk_mul_f32 v[122:123], v[122:123], v[234:235] op_sel_hi:[1,0]
v_pk_mul_f32 v[124:125], v[124:125], v[234:235] op_sel_hi:[1,0]
v_pk_mul_f32 v[126:127], v[126:127], v[234:235] op_sel_hi:[1,0]
v_cvt_pk_bf16_f32 v212, v120, v121
v_cvt_pk_bf16_f32 v213, v122, v123
v_cvt_pk_bf16_f32 v214, v124, v125
v_cvt_pk_bf16_f32 v215, v126, v127
v_min_u32 v212, -2, v212
s_mov_b64 exec, s[40:41]
buffer_store_dwordx4 v[212:215], v11, s[84:87], s33 offen
s_mov_b64 exec, -1
mega_kernel_rf_b3:
s_barrier
s_nop 15
buffer_load_dwordx4 v[32:35], v7, s[84:87], s29 offen offset:0 sc1
s_nop 9
buffer_load_dwordx4 v[36:39], v7, s[84:87], s29 offen offset:1024 sc1
s_nop 9
buffer_load_dwordx4 v[40:43], v7, s[84:87], s29 offen offset:2048 sc1
s_nop 9
buffer_load_dwordx4 v[44:47], v7, s[84:87], s29 offen offset:3072 sc1
mega_kernel_rf_pc_15_0:
s_waitcnt vmcnt(3)
v_cmp_eq_u32 vcc, -1, v32
s_cbranch_vccnz mega_kernel_rf_pc_15_0f
v_smfmac_f32_16x16x64_bf16 v[96:99], v[32:35], a[192:199], v6
v_smfmac_f32_16x16x64_bf16 v[100:103], v[32:35], a[224:231], v6
mega_kernel_rf_pc_14_1:
s_waitcnt vmcnt(2)
v_cmp_eq_u32 vcc, -1, v36
s_cbranch_vccnz mega_kernel_rf_pc_14_1f
v_smfmac_f32_16x16x64_bf16 v[96:99], v[36:39], a[200:207], v6
v_smfmac_f32_16x16x64_bf16 v[100:103], v[36:39], a[232:239], v6
mega_kernel_rf_pc_12_2:
s_waitcnt vmcnt(1)
v_cmp_eq_u32 vcc, -1, v40
s_cbranch_vccnz mega_kernel_rf_pc_12_2f
v_smfmac_f32_16x16x64_bf16 v[96:99], v[40:43], a[208:215], v6
v_smfmac_f32_16x16x64_bf16 v[100:103], v[40:43], a[240:247], v6
mega_kernel_rf_pc_8_3:
s_waitcnt vmcnt(0)
v_cmp_eq_u32 vcc, -1, v44
s_cbranch_vccnz mega_kernel_rf_pc_8_3f
v_smfmac_f32_16x16x64_bf16 v[96:99], v[44:47], a[216:223], v6
v_smfmac_f32_16x16x64_bf16 v[100:103], v[44:47], a[248:255], v6
mega_kernel_rf_pc_d:
s_nop 7
v_permlane32_swap_b32 v96, v100
v_permlane32_swap_b32 v97, v101
v_permlane32_swap_b32 v98, v102
v_permlane32_swap_b32 v99, v103
v_pk_add_f32 v[96:97], v[96:97], v[100:101]
v_pk_add_f32 v[98:99], v[98:99], v[102:103]
ds_write2_b32 v18, v96, v97 offset0:0 offset1:36
ds_write2_b32 v18, v98, v99 offset0:72 offset1:108
s_waitcnt lgkmcnt(0)
s_barrier
s_cmp_lg_u32 s24, 0
s_cbranch_scc1 mega_kernel_rf_x1
ds_read_b128 v[120:123], v19 offset:0
ds_read_b128 v[124:127], v19 offset:1152
ds_read_b128 v[128:131], v19 offset:2304
ds_read_b128 v[132:135], v19 offset:3456
s_waitcnt lgkmcnt(2)
v_pk_add_f32 v[120:121], v[120:121], v[124:125]
v_pk_add_f32 v[122:123], v[122:123], v[126:127]
s_waitcnt lgkmcnt(0)
v_pk_add_f32 v[128:129], v[128:129], v[132:133]
v_pk_add_f32 v[130:131], v[130:131], v[134:135]
v_pk_add_f32 v[120:121], v[120:121], v[128:129]
v_pk_add_f32 v[122:123], v[122:123], v[130:131]
v_and_or_b32 v120, v120, -2, s47
v_and_or_b32 v121, v121, -2, s47
v_and_or_b32 v122, v122, -2, s47
v_and_or_b32 v123, v123, -2, s47
buffer_store_dwordx4 v[120:123], v12, s[84:87], s35 offen sc1
s_xor_b32 s76, s47, 1
v_mov_b32 v48, s76
v_mov_b32 v49, s76
v_mov_b32 v50, s76
v_mov_b32 v51, s76
v_mov_b32 v52, s76
v_mov_b32 v53, s76
v_mov_b32 v54, s76
v_mov_b32 v55, s76
v_mov_b32 v56, s76
v_mov_b32 v57, s76
v_mov_b32 v58, s76
v_mov_b32 v59, s76
v_mov_b32 v96, 0
v_mov_b32 v97, 0
v_mov_b32 v98, 0
v_mov_b32 v99, 0
v_mov_b32 v100, 0
v_mov_b32 v101, 0
v_mov_b32 v102, 0
v_mov_b32 v103, 0
v_mov_b32 v104, 0
v_mov_b32 v105, 0
v_mov_b32 v106, 0
v_mov_b32 v107, 0
v_mov_b32 v108, 0
v_mov_b32 v109, 0
v_mov_b32 v110, 0
v_mov_b32 v111, 0
v_mov_b32 v112, 0
v_mov_b32 v113, 0
v_mov_b32 v114, 0
v_mov_b32 v115, 0
v_mov_b32 v116, 0
v_mov_b32 v117, 0
v_mov_b32 v118, 0
v_mov_b32 v119, 0
s_nop 15
s_cmp_eq_u32 s47, 1
s_cbranch_scc1 mega_kernel_rf_p4_1
mega_kernel_rf_p4_0:
buffer_load_dwordx4 v[48:51], v25, s[84:87], s35 offen sc1
buffer_load_dwordx4 v[52:55], v26, s[84:87], s35 offen sc1
buffer_load_dwordx4 v[56:59], v27, s[84:87], s35 offen sc1
s_waitcnt vmcnt(12)
mega_kernel_rf_p4c_0:
v_bitop3_b32 v4, v48, v49, v50 bitop3:0xfe
v_bitop3_b32 v5, v54, v55, v56 bitop3:0xfe
v_bitop3_b32 v4, v4, v51, v52 bitop3:0xfe
v_bitop3_b32 v5, v5, v57, v58 bitop3:0xfe
v_bitop3_b32 v4, v4, v53, v59 bitop3:0xfe
v_bitop3_b32 v4, v4, v5, 1 bitop3:0xa8
v_cmp_ne_u32 vcc, 0, v4
s_cbranch_vccnz mega_kernel_rf_p4_0
v_pk_add_f32 v[120:121], v[120:121], v[48:49]
v_pk_add_f32 v[124:125], v[52:53], v[56:57]
v_pk_add_f32 v[122:123], v[122:123], v[50:51]
v_pk_add_f32 v[126:127], v[54:55], v[58:59]
v_pk_add_f32 v[120:121], v[120:121], v[124:125]
v_pk_add_f32 v[122:123], v[122:123], v[126:127]
v_cvt_pk_bf16_f32 v212, v120, v121
v_cvt_pk_bf16_f32 v213, v122, v123
v_min_u32 v212, -2, v212
buffer_store_dwordx2 v[212:213], v9, s[84:87], s34 offen
s_branch mega_kernel_rf_p4d
mega_kernel_rf_p4_1:
buffer_load_dwordx4 v[48:51], v25, s[84:87], s35 offen sc1
buffer_load_dwordx4 v[52:55], v26, s[84:87], s35 offen sc1
buffer_load_dwordx4 v[56:59], v27, s[84:87], s35 offen sc1
s_waitcnt vmcnt(12)
mega_kernel_rf_p4c_1:
v_bitop3_b32 v4, v48, v49, v50 bitop3:0x80
v_bitop3_b32 v5, v54, v55, v56 bitop3:0x80
v_bitop3_b32 v4, v4, v51, v52 bitop3:0x80
v_bitop3_b32 v5, v5, v57, v58 bitop3:0x80
v_bitop3_b32 v4, v4, v53, v59 bitop3:0x80
v_bitop3_b32 v4, v4, v5, 1 bitop3:0x80
v_cmp_ne_u32 vcc, 1, v4
s_cbranch_vccnz mega_kernel_rf_p4_1
v_pk_add_f32 v[120:121], v[120:121], v[48:49]
v_pk_add_f32 v[124:125], v[52:53], v[56:57]
v_pk_add_f32 v[122:123], v[122:123], v[50:51]
v_pk_add_f32 v[126:127], v[54:55], v[58:59]
v_pk_add_f32 v[120:121], v[120:121], v[124:125]
v_pk_add_f32 v[122:123], v[122:123], v[126:127]
v_cvt_pk_bf16_f32 v212, v120, v121
v_cvt_pk_bf16_f32 v213, v122, v123
v_min_u32 v212, -2, v212
buffer_store_dwordx2 v[212:213], v9, s[84:87], s34 offen
mega_kernel_rf_p4d:
mega_kernel_rf_b5:
s_add_u32 s27, s27, 1
s_add_u32 s44, s44, 4096
s_cmp_eq_u32 s44, 30720
s_cselect_b32 s44, 18432, s44
s_mov_b32 s28, s33
s_mov_b32 s33, s34
s_mov_b32 s34, s28
s_xor_b32 s35, s35, 262144
s_bfe_u32 s47, s27, 0x10001
s_barrier
s_nop 15
s_branch mega_kernel_rf_loop
mega_kernel_rf_x1:
s_cmp_eq_u32 s24, 1
s_cbranch_scc0 mega_kernel_rf_x2
s_add_u32 s76, s27, 1
v_mov_b32 v5, s76
s_mov_b64 exec, 1
buffer_store_dword v5, v228, s[84:87], s81 offen sc1
s_mov_b64 exec, -1
mega_kernel_rf_x2:
s_cmp_eq_u32 s24, 3
s_cbranch_scc0 mega_kernel_rf_x4
s_cmp_eq_u32 s36, 1
s_cbranch_scc0 mega_kernel_rf_x5
s_add_u32 s76, s27, 1
s_cmp_gt_i32 s46, s76
s_cbranch_scc1 mega_kernel_rf_pf1ok
mega_kernel_rf_pf1w:
buffer_load_dword v4, v24, s[84:87], 0 offen sc1
s_waitcnt vmcnt(0)
v_readlane_b32 s46, v4, 0
v_readlane_b32 s28, v4, 1
s_nop 1
s_min_i32 s46, s46, s28
s_cmp_gt_i32 s46, s76
s_cbranch_scc0 mega_kernel_rf_pf1w
mega_kernel_rf_pf1ok:
s_add_u32 s77, s76, s82
s_bfe_u32 s28, s77, 0x40002
s_lshl_b32 s28, s28, 14
s_and_b32 s77, s77, 3
s_lshl_b32 s77, s77, 11
s_add_u32 s28, s28, s77
s_add_u32 m0, s45, 0
s_nop 0
buffer_load_dwordx4 v240, s[84:87], s28 offen offset:0 sc1 lds
s_add_u32 m0, s45, 0
s_nop 0
buffer_load_dwordx4 v240, s[84:87], s28 offen offset:1024 sc1 lds
s_add_u32 m0, s45, 2048
s_nop 0
buffer_load_dwordx4 v241, s[84:87], s28 offen offset:0 sc1 lds
s_add_u32 m0, s45, 2048
s_nop 0
buffer_load_dwordx4 v241, s[84:87], s28 offen offset:1024 sc1 lds
s_add_u32 s45, s45, 4096
s_cmp_eq_u32 s45, 30720
s_cselect_b32 s45, 18432, s45
s_waitcnt vmcnt(0)
mega_kernel_rf_x5:
s_add_u32 s76, s27, 3
s_min_u32 s76, s76, 63
s_cmp_gt_i32 s46, s76
s_cbranch_scc1 mega_kernel_rf_pf2ok
mega_kernel_rf_pf2w:
buffer_load_dword v4, v24, s[84:87], 0 offen sc1
s_waitcnt vmcnt(0)
v_readlane_b32 s46, v4, 0
v_readlane_b32 s28, v4, 1
s_nop 1
s_min_i32 s46, s46, s28
s_cmp_gt_i32 s46, s76
s_cbranch_scc0 mega_kernel_rf_x6
mega_kernel_rf_pf2ok:
mega_kernel_rf_x6:
s_add_u32 s76, s27, 2
s_cmp_lt_u32 s76, 63
s_cbranch_scc0 mega_kernel_rf_x4
s_cmp_gt_i32 s46, s76
s_cbranch_scc0 mega_kernel_rf_x4
s_cmp_eq_u32 s88, s76
s_cbranch_scc1 mega_kernel_rf_x7
s_add_u32 s77, s76, s82
s_bfe_u32 s28, s77, 0x40002
s_lshl_b32 s28, s28, 14
s_and_b32 s77, s77, 3
s_lshl_b32 s77, s77, 11
s_add_u32 s28, s28, s77
s_add_u32 s28, s28, s83
s_buffer_load_dword s78, s[84:87], s28 offset:0
s_buffer_load_dword s78, s[84:87], s28 offset:128
s_buffer_load_dword s78, s[84:87], s28 offset:256
s_buffer_load_dword s78, s[84:87], s28 offset:384
s_buffer_load_dword s78, s[84:87], s28 offset:512
s_buffer_load_dword s78, s[84:87], s28 offset:640
s_buffer_load_dword s78, s[84:87], s28 offset:768
s_buffer_load_dword s78, s[84:87], s28 offset:896
s_buffer_load_dword s78, s[84:87], s28 offset:1024
s_buffer_load_dword s78, s[84:87], s28 offset:1152
s_buffer_load_dword s78, s[84:87], s28 offset:1280
s_buffer_load_dword s78, s[84:87], s28 offset:1408
s_buffer_load_dword s78, s[84:87], s28 offset:1536
s_buffer_load_dword s78, s[84:87], s28 offset:1664
s_buffer_load_dword s78, s[84:87], s28 offset:1792
s_buffer_load_dword s78, s[84:87], s28 offset:1920
mega_kernel_rf_x7:
s_add_u32 s77, s76, s82
s_bfe_u32 s28, s77, 0x40002
s_lshl_b32 s28, s28, 14
s_and_b32 s77, s77, 3
s_lshl_b32 s77, s77, 11
s_add_u32 s28, s28, s77
s_add_u32 s28, s28, s83
s_add_u32 s28, s28, 33554432
s_buffer_load_dword s78, s[84:87], s28 offset:0
s_buffer_load_dword s78, s[84:87], s28 offset:128
s_buffer_load_dword s78, s[84:87], s28 offset:256
s_buffer_load_dword s78, s[84:87], s28 offset:384
s_buffer_load_dword s78, s[84:87], s28 offset:512
s_buffer_load_dword s78, s[84:87], s28 offset:640
s_buffer_load_dword s78, s[84:87], s28 offset:768
s_buffer_load_dword s78, s[84:87], s28 offset:896
s_buffer_load_dword s78, s[84:87], s28 offset:1024
s_buffer_load_dword s78, s[84:87], s28 offset:1152
s_buffer_load_dword s78, s[84:87], s28 offset:1280
s_buffer_load_dword s78, s[84:87], s28 offset:1408
s_buffer_load_dword s78, s[84:87], s28 offset:1536
s_buffer_load_dword s78, s[84:87], s28 offset:1664
s_buffer_load_dword s78, s[84:87], s28 offset:1792
s_buffer_load_dword s78, s[84:87], s28 offset:1920
s_mov_b32 s89, s76
mega_kernel_rf_x4:
v_mov_b32 v96, 0
v_mov_b32 v97, 0
v_mov_b32 v98, 0
v_mov_b32 v99, 0
v_mov_b32 v100, 0
v_mov_b32 v101, 0
v_mov_b32 v102, 0
v_mov_b32 v103, 0
v_mov_b32 v104, 0
v_mov_b32 v105, 0
v_mov_b32 v106, 0
v_mov_b32 v107, 0
v_mov_b32 v108, 0
v_mov_b32 v109, 0
v_mov_b32 v110, 0
v_mov_b32 v111, 0
v_mov_b32 v112, 0
v_mov_b32 v113, 0
v_mov_b32 v114, 0
v_mov_b32 v115, 0
v_mov_b32 v116, 0
v_mov_b32 v117, 0
v_mov_b32 v118, 0
v_mov_b32 v119, 0
s_branch mega_kernel_rf_b5
mega_kernel_rf_p2r:
s_mov_b64 exec, s[42:43]
buffer_load_dwordx4 v[188:191], v10, s[84:87], s76 offen sc1
buffer_load_dwordx4 v[196:199], v10, s[84:87], s77 offen sc1
buffer_load_dwordx4 v[204:207], v10, s[84:87], s78 offen sc1
s_mov_b64 exec, -1
buffer_load_dwordx4 v[184:187], v17, s[84:87], s76 offen sc1
buffer_load_dwordx4 v[192:195], v17, s[84:87], s77 offen sc1
buffer_load_dwordx4 v[200:203], v17, s[84:87], s78 offen sc1
s_branch mega_kernel_rf_p2
mega_kernel_rf_pa_1_0f:
s_mov_b64 exec, vcc
buffer_load_dwordx4 v[32:35], v7, s[84:87], s33 offen offset:0 sc1
s_mov_b64 exec, -1
s_branch mega_kernel_rf_pa_1_0
mega_kernel_rf_pa_1_0:
s_waitcnt vmcnt(0)
v_max_u32 v4, v32, v34
v_cmp_eq_u32 vcc, -1, v4
s_cbranch_vccnz mega_kernel_rf_pa_1_0f
v_smfmac_f32_16x16x64_bf16 v[96:99], v[32:35], a[0:7], v6
v_smfmac_f32_16x16x64_bf16 v[100:103], v[32:35], a[32:39], v6
v_smfmac_f32_16x16x64_bf16 v[104:107], v[32:35], a[64:71], v6
v_smfmac_f32_16x16x64_bf16 v[108:111], v[32:35], a[96:103], v6
s_branch mega_kernel_rf_pa_d
mega_kernel_rf_pa_2_1f:
s_mov_b64 exec, vcc
buffer_load_dwordx4 v[36:39], v7, s[84:87], s33 offen offset:1024 sc1
s_mov_b64 exec, -1
s_branch mega_kernel_rf_pa_2_1
mega_kernel_rf_pa_2_1:
s_waitcnt vmcnt(0)
v_max_u32 v4, v36, v38
v_cmp_eq_u32 vcc, -1, v4
s_cbranch_vccnz mega_kernel_rf_pa_2_1f
v_smfmac_f32_16x16x64_bf16 v[96:99], v[36:39], a[8:15], v6
v_smfmac_f32_16x16x64_bf16 v[100:103], v[36:39], a[40:47], v6
v_smfmac_f32_16x16x64_bf16 v[104:107], v[36:39], a[72:79], v6
v_smfmac_f32_16x16x64_bf16 v[108:111], v[36:39], a[104:111], v6
s_branch mega_kernel_rf_pa_d
mega_kernel_rf_pa_3_0f:
s_mov_b64 exec, vcc
buffer_load_dwordx4 v[32:35], v7, s[84:87], s33 offen offset:0 sc1
s_mov_b64 exec, -1
s_branch mega_kernel_rf_pa_3_1
mega_kernel_rf_pa_3_0:
s_waitcnt vmcnt(1)
v_max_u32 v4, v32, v34
v_cmp_eq_u32 vcc, -1, v4
s_cbranch_vccnz mega_kernel_rf_pa_3_0f
v_smfmac_f32_16x16x64_bf16 v[96:99], v[32:35], a[0:7], v6
v_smfmac_f32_16x16x64_bf16 v[100:103], v[32:35], a[32:39], v6
v_smfmac_f32_16x16x64_bf16 v[104:107], v[32:35], a[64:71], v6
v_smfmac_f32_16x16x64_bf16 v[108:111], v[32:35], a[96:103], v6
s_branch mega_kernel_rf_pa_2_1
mega_kernel_rf_pa_3_1f:
s_mov_b64 exec, vcc
buffer_load_dwordx4 v[36:39], v7, s[84:87], s33 offen offset:1024 sc1
s_mov_b64 exec, -1
s_branch mega_kernel_rf_pa_3_0
mega_kernel_rf_pa_3_1:
s_waitcnt vmcnt(1)
v_max_u32 v4, v36, v38
v_cmp_eq_u32 vcc, -1, v4
s_cbranch_vccnz mega_kernel_rf_pa_3_1f
v_smfmac_f32_16x16x64_bf16 v[96:99], v[36:39], a[8:15], v6
v_smfmac_f32_16x16x64_bf16 v[100:103], v[36:39], a[40:47], v6
v_smfmac_f32_16x16x64_bf16 v[104:107], v[36:39], a[72:79], v6
v_smfmac_f32_16x16x64_bf16 v[108:111], v[36:39], a[104:111], v6
s_branch mega_kernel_rf_pa_1_0
mega_kernel_rf_pa_4_2f:
s_mov_b64 exec, vcc
buffer_load_dwordx4 v[40:43], v7, s[84:87], s33 offen offset:2048 sc1
s_mov_b64 exec, -1
s_branch mega_kernel_rf_pa_4_2
mega_kernel_rf_pa_4_2:
s_waitcnt vmcnt(0)
v_max_u32 v4, v40, v42
v_cmp_eq_u32 vcc, -1, v4
s_cbranch_vccnz mega_kernel_rf_pa_4_2f
v_smfmac_f32_16x16x64_bf16 v[96:99], v[40:43], a[16:23], v6
v_smfmac_f32_16x16x64_bf16 v[100:103], v[40:43], a[48:55], v6
v_smfmac_f32_16x16x64_bf16 v[104:107], v[40:43], a[80:87], v6
v_smfmac_f32_16x16x64_bf16 v[108:111], v[40:43], a[112:119], v6
s_branch mega_kernel_rf_pa_d
mega_kernel_rf_pa_5_0f:
s_mov_b64 exec, vcc
buffer_load_dwordx4 v[32:35], v7, s[84:87], s33 offen offset:0 sc1
s_mov_b64 exec, -1
s_branch mega_kernel_rf_pa_5_2
mega_kernel_rf_pa_5_0:
s_waitcnt vmcnt(1)
v_max_u32 v4, v32, v34
v_cmp_eq_u32 vcc, -1, v4
s_cbranch_vccnz mega_kernel_rf_pa_5_0f
v_smfmac_f32_16x16x64_bf16 v[96:99], v[32:35], a[0:7], v6
v_smfmac_f32_16x16x64_bf16 v[100:103], v[32:35], a[32:39], v6
v_smfmac_f32_16x16x64_bf16 v[104:107], v[32:35], a[64:71], v6
v_smfmac_f32_16x16x64_bf16 v[108:111], v[32:35], a[96:103], v6
s_branch mega_kernel_rf_pa_4_2
mega_kernel_rf_pa_5_2f:
s_mov_b64 exec, vcc
buffer_load_dwordx4 v[40:43], v7, s[84:87], s33 offen offset:2048 sc1
s_mov_b64 exec, -1
s_branch mega_kernel_rf_pa_5_0
mega_kernel_rf_pa_5_2:
s_waitcnt vmcnt(1)
v_max_u32 v4, v40, v42
v_cmp_eq_u32 vcc, -1, v4
s_cbranch_vccnz mega_kernel_rf_pa_5_2f
v_smfmac_f32_16x16x64_bf16 v[96:99], v[40:43], a[16:23], v6
v_smfmac_f32_16x16x64_bf16 v[100:103], v[40:43], a[48:55], v6
v_smfmac_f32_16x16x64_bf16 v[104:107], v[40:43], a[80:87], v6
v_smfmac_f32_16x16x64_bf16 v[108:111], v[40:43], a[112:119], v6
s_branch mega_kernel_rf_pa_1_0
mega_kernel_rf_pa_6_1f:
s_mov_b64 exec, vcc
buffer_load_dwordx4 v[36:39], v7, s[84:87], s33 offen offset:1024 sc1
s_mov_b64 exec, -1
s_branch mega_kernel_rf_pa_6_2
mega_kernel_rf_pa_6_1:
s_waitcnt vmcnt(1)
v_max_u32 v4, v36, v38
v_cmp_eq_u32 vcc, -1, v4
s_cbranch_vccnz mega_kernel_rf_pa_6_1f
v_smfmac_f32_16x16x64_bf16 v[96:99], v[36:39], a[8:15], v6
v_smfmac_f32_16x16x64_bf16 v[100:103], v[36:39], a[40:47], v6
v_smfmac_f32_16x16x64_bf16 v[104:107], v[36:39], a[72:79], v6
v_smfmac_f32_16x16x64_bf16 v[108:111], v[36:39], a[104:111], v6
s_branch mega_kernel_rf_pa_4_2
mega_kernel_rf_pa_6_2f:
s_mov_b64 exec, vcc
buffer_load_dwordx4 v[40:43], v7, s[84:87], s33 offen offset:2048 sc1
s_mov_b64 exec, -1
s_branch mega_kernel_rf_pa_6_1
mega_kernel_rf_pa_6_2:
s_waitcnt vmcnt(1)
v_max_u32 v4, v40, v42
v_cmp_eq_u32 vcc, -1, v4
s_cbranch_vccnz mega_kernel_rf_pa_6_2f
v_smfmac_f32_16x16x64_bf16 v[96:99], v[40:43], a[16:23], v6
v_smfmac_f32_16x16x64_bf16 v[100:103], v[40:43], a[48:55], v6
v_smfmac_f32_16x16x64_bf16 v[104:107], v[40:43], a[80:87], v6
v_smfmac_f32_16x16x64_bf16 v[108:111], v[40:43], a[112:119], v6
s_branch mega_kernel_rf_pa_2_1
mega_kernel_rf_pa_7_0f:
s_mov_b64 exec, vcc
buffer_load_dwordx4 v[32:35], v7, s[84:87], s33 offen offset:0 sc1
s_mov_b64 exec, -1
s_branch mega_kernel_rf_pa_7_1
mega_kernel_rf_pa_7_0:
s_waitcnt vmcnt(2)
v_max_u32 v4, v32, v34
v_cmp_eq_u32 vcc, -1, v4
s_cbranch_vccnz mega_kernel_rf_pa_7_0f
v_smfmac_f32_16x16x64_bf16 v[96:99], v[32:35], a[0:7], v6
v_smfmac_f32_16x16x64_bf16 v[100:103], v[32:35], a[32:39], v6
v_smfmac_f32_16x16x64_bf16 v[104:107], v[32:35], a[64:71], v6
v_smfmac_f32_16x16x64_bf16 v[108:111], v[32:35], a[96:103], v6
s_branch mega_kernel_rf_pa_6_1
mega_kernel_rf_pa_7_1f:
s_mov_b64 exec, vcc
buffer_load_dwordx4 v[36:39], v7, s[84:87], s33 offen offset:1024 sc1
s_mov_b64 exec, -1
s_branch mega_kernel_rf_pa_7_2
mega_kernel_rf_pa_7_1:
s_waitcnt vmcnt(2)
v_max_u32 v4, v36, v38
v_cmp_eq_u32 vcc, -1, v4
s_cbranch_vccnz mega_kernel_rf_pa_7_1f
v_smfmac_f32_16x16x64_bf16 v[96:99], v[36:39], a[8:15], v6
v_smfmac_f32_16x16x64_bf16 v[100:103], v[36:39], a[40:47], v6
v_smfmac_f32_16x16x64_bf16 v[104:107], v[36:39], a[72:79], v6
v_smfmac_f32_16x16x64_bf16 v[108:111], v[36:39], a[104:111], v6
s_branch mega_kernel_rf_pa_5_2
mega_kernel_rf_pa_7_2f:
s_mov_b64 exec, vcc
buffer_load_dwordx4 v[40:43], v7, s[84:87], s33 offen offset:2048 sc1
s_mov_b64 exec, -1
s_branch mega_kernel_rf_pa_7_0
mega_kernel_rf_pa_7_2:
s_waitcnt vmcnt(2)
v_max_u32 v4, v40, v42
v_cmp_eq_u32 vcc, -1, v4
s_cbranch_vccnz mega_kernel_rf_pa_7_2f
v_smfmac_f32_16x16x64_bf16 v[96:99], v[40:43], a[16:23], v6
v_smfmac_f32_16x16x64_bf16 v[100:103], v[40:43], a[48:55], v6
v_smfmac_f32_16x16x64_bf16 v[104:107], v[40:43], a[80:87], v6
v_smfmac_f32_16x16x64_bf16 v[108:111], v[40:43], a[112:119], v6
s_branch mega_kernel_rf_pa_3_0
mega_kernel_rf_pa_8_3f:
s_mov_b64 exec, vcc
buffer_load_dwordx4 v[44:47], v7, s[84:87], s33 offen offset:3072 sc1
s_mov_b64 exec, -1
s_branch mega_kernel_rf_pa_8_3
mega_kernel_rf_pa_8_3:
s_waitcnt vmcnt(0)
v_max_u32 v4, v44, v46
v_cmp_eq_u32 vcc, -1, v4
s_cbranch_vccnz mega_kernel_rf_pa_8_3f
v_smfmac_f32_16x16x64_bf16 v[96:99], v[44:47], a[24:31], v6
v_smfmac_f32_16x16x64_bf16 v[100:103], v[44:47], a[56:63], v6
v_smfmac_f32_16x16x64_bf16 v[104:107], v[44:47], a[88:95], v6
v_smfmac_f32_16x16x64_bf16 v[108:111], v[44:47], a[120:127], v6
s_branch mega_kernel_rf_pa_d
mega_kernel_rf_pa_9_0f:
s_mov_b64 exec, vcc
buffer_load_dwordx4 v[32:35], v7, s[84:87], s33 offen offset:0 sc1
s_mov_b64 exec, -1
s_branch mega_kernel_rf_pa_9_3
mega_kernel_rf_pa_9_0:
s_waitcnt vmcnt(1)
v_max_u32 v4, v32, v34
v_cmp_eq_u32 vcc, -1, v4
s_cbranch_vccnz mega_kernel_rf_pa_9_0f
v_smfmac_f32_16x16x64_bf16 v[96:99], v[32:35], a[0:7], v6
v_smfmac_f32_16x16x64_bf16 v[100:103], v[32:35], a[32:39], v6
v_smfmac_f32_16x16x64_bf16 v[104:107], v[32:35], a[64:71], v6
v_smfmac_f32_16x16x64_bf16 v[108:111], v[32:35], a[96:103], v6
s_branch mega_kernel_rf_pa_8_3
mega_kernel_rf_pa_9_3f:
s_mov_b64 exec, vcc
buffer_load_dwordx4 v[44:47], v7, s[84:87], s33 offen offset:3072 sc1
s_mov_b64 exec, -1
s_branch mega_kernel_rf_pa_9_0
mega_kernel_rf_pa_9_3:
s_waitcnt vmcnt(1)
v_max_u32 v4, v44, v46
v_cmp_eq_u32 vcc, -1, v4
s_cbranch_vccnz mega_kernel_rf_pa_9_3f
v_smfmac_f32_16x16x64_bf16 v[96:99], v[44:47], a[24:31], v6
v_smfmac_f32_16x16x64_bf16 v[100:103], v[44:47], a[56:63], v6
v_smfmac_f32_16x16x64_bf16 v[104:107], v[44:47], a[88:95], v6
v_smfmac_f32_16x16x64_bf16 v[108:111], v[44:47], a[120:127], v6
s_branch mega_kernel_rf_pa_1_0
mega_kernel_rf_pa_10_1f:
s_mov_b64 exec, vcc
buffer_load_dwordx4 v[36:39], v7, s[84:87], s33 offen offset:1024 sc1
s_mov_b64 exec, -1
s_branch mega_kernel_rf_pa_10_3
mega_kernel_rf_pa_10_1:
s_waitcnt vmcnt(1)
v_max_u32 v4, v36, v38
v_cmp_eq_u32 vcc, -1, v4
s_cbranch_vccnz mega_kernel_rf_pa_10_1f
v_smfmac_f32_16x16x64_bf16 v[96:99], v[36:39], a[8:15], v6
v_smfmac_f32_16x16x64_bf16 v[100:103], v[36:39], a[40:47], v6
v_smfmac_f32_16x16x64_bf16 v[104:107], v[36:39], a[72:79], v6
v_smfmac_f32_16x16x64_bf16 v[108:111], v[36:39], a[104:111], v6
s_branch mega_kernel_rf_pa_8_3
mega_kernel_rf_pa_10_3f:
s_mov_b64 exec, vcc
buffer_load_dwordx4 v[44:47], v7, s[84:87], s33 offen offset:3072 sc1
s_mov_b64 exec, -1
s_branch mega_kernel_rf_pa_10_1
mega_kernel_rf_pa_10_3:
s_waitcnt vmcnt(1)
v_max_u32 v4, v44, v46
v_cmp_eq_u32 vcc, -1, v4
s_cbranch_vccnz mega_kernel_rf_pa_10_3f
v_smfmac_f32_16x16x64_bf16 v[96:99], v[44:47], a[24:31], v6
v_smfmac_f32_16x16x64_bf16 v[100:103], v[44:47], a[56:63], v6
v_smfmac_f32_16x16x64_bf16 v[104:107], v[44:47], a[88:95], v6
v_smfmac_f32_16x16x64_bf16 v[108:111], v[44:47], a[120:127], v6
s_branch mega_kernel_rf_pa_2_1
mega_kernel_rf_pa_11_0f:
s_mov_b64 exec, vcc
buffer_load_dwordx4 v[32:35], v7, s[84:87], s33 offen offset:0 sc1
s_mov_b64 exec, -1
s_branch mega_kernel_rf_pa_11_1
mega_kernel_rf_pa_11_0:
s_waitcnt vmcnt(2)
v_max_u32 v4, v32, v34
v_cmp_eq_u32 vcc, -1, v4
s_cbranch_vccnz mega_kernel_rf_pa_11_0f
v_smfmac_f32_16x16x64_bf16 v[96:99], v[32:35], a[0:7], v6
v_smfmac_f32_16x16x64_bf16 v[100:103], v[32:35], a[32:39], v6
v_smfmac_f32_16x16x64_bf16 v[104:107], v[32:35], a[64:71], v6
v_smfmac_f32_16x16x64_bf16 v[108:111], v[32:35], a[96:103], v6
s_branch mega_kernel_rf_pa_10_1
mega_kernel_rf_pa_11_1f:
s_mov_b64 exec, vcc
buffer_load_dwordx4 v[36:39], v7, s[84:87], s33 offen offset:1024 sc1
s_mov_b64 exec, -1
s_branch mega_kernel_rf_pa_11_3
mega_kernel_rf_pa_11_1:
s_waitcnt vmcnt(2)
v_max_u32 v4, v36, v38
v_cmp_eq_u32 vcc, -1, v4
s_cbranch_vccnz mega_kernel_rf_pa_11_1f
v_smfmac_f32_16x16x64_bf16 v[96:99], v[36:39], a[8:15], v6
v_smfmac_f32_16x16x64_bf16 v[100:103], v[36:39], a[40:47], v6
v_smfmac_f32_16x16x64_bf16 v[104:107], v[36:39], a[72:79], v6
v_smfmac_f32_16x16x64_bf16 v[108:111], v[36:39], a[104:111], v6
s_branch mega_kernel_rf_pa_9_3
mega_kernel_rf_pa_11_3f:
s_mov_b64 exec, vcc
buffer_load_dwordx4 v[44:47], v7, s[84:87], s33 offen offset:3072 sc1
s_mov_b64 exec, -1
s_branch mega_kernel_rf_pa_11_0
mega_kernel_rf_pa_11_3:
s_waitcnt vmcnt(2)
v_max_u32 v4, v44, v46
v_cmp_eq_u32 vcc, -1, v4
s_cbranch_vccnz mega_kernel_rf_pa_11_3f
v_smfmac_f32_16x16x64_bf16 v[96:99], v[44:47], a[24:31], v6
v_smfmac_f32_16x16x64_bf16 v[100:103], v[44:47], a[56:63], v6
v_smfmac_f32_16x16x64_bf16 v[104:107], v[44:47], a[88:95], v6
v_smfmac_f32_16x16x64_bf16 v[108:111], v[44:47], a[120:127], v6
s_branch mega_kernel_rf_pa_3_0
mega_kernel_rf_pa_12_2f:
s_mov_b64 exec, vcc
buffer_load_dwordx4 v[40:43], v7, s[84:87], s33 offen offset:2048 sc1
s_mov_b64 exec, -1
s_branch mega_kernel_rf_pa_12_3
mega_kernel_rf_pa_12_2:
s_waitcnt vmcnt(1)
v_max_u32 v4, v40, v42
v_cmp_eq_u32 vcc, -1, v4
s_cbranch_vccnz mega_kernel_rf_pa_12_2f
v_smfmac_f32_16x16x64_bf16 v[96:99], v[40:43], a[16:23], v6
v_smfmac_f32_16x16x64_bf16 v[100:103], v[40:43], a[48:55], v6
v_smfmac_f32_16x16x64_bf16 v[104:107], v[40:43], a[80:87], v6
v_smfmac_f32_16x16x64_bf16 v[108:111], v[40:43], a[112:119], v6
s_branch mega_kernel_rf_pa_8_3
mega_kernel_rf_pa_12_3f:
s_mov_b64 exec, vcc
buffer_load_dwordx4 v[44:47], v7, s[84:87], s33 offen offset:3072 sc1
s_mov_b64 exec, -1
s_branch mega_kernel_rf_pa_12_2
mega_kernel_rf_pa_12_3:
s_waitcnt vmcnt(1)
v_max_u32 v4, v44, v46
v_cmp_eq_u32 vcc, -1, v4
s_cbranch_vccnz mega_kernel_rf_pa_12_3f
v_smfmac_f32_16x16x64_bf16 v[96:99], v[44:47], a[24:31], v6
v_smfmac_f32_16x16x64_bf16 v[100:103], v[44:47], a[56:63], v6
v_smfmac_f32_16x16x64_bf16 v[104:107], v[44:47], a[88:95], v6
v_smfmac_f32_16x16x64_bf16 v[108:111], v[44:47], a[120:127], v6
s_branch mega_kernel_rf_pa_4_2
mega_kernel_rf_pa_13_0f:
s_mov_b64 exec, vcc
buffer_load_dwordx4 v[32:35], v7, s[84:87], s33 offen offset:0 sc1
s_mov_b64 exec, -1
s_branch mega_kernel_rf_pa_13_2
mega_kernel_rf_pa_13_0:
s_waitcnt vmcnt(2)
v_max_u32 v4, v32, v34
v_cmp_eq_u32 vcc, -1, v4
s_cbranch_vccnz mega_kernel_rf_pa_13_0f
v_smfmac_f32_16x16x64_bf16 v[96:99], v[32:35], a[0:7], v6
v_smfmac_f32_16x16x64_bf16 v[100:103], v[32:35], a[32:39], v6
v_smfmac_f32_16x16x64_bf16 v[104:107], v[32:35], a[64:71], v6
v_smfmac_f32_16x16x64_bf16 v[108:111], v[32:35], a[96:103], v6
s_branch mega_kernel_rf_pa_12_2
mega_kernel_rf_pa_13_2f:
s_mov_b64 exec, vcc
buffer_load_dwordx4 v[40:43], v7, s[84:87], s33 offen offset:2048 sc1
s_mov_b64 exec, -1
s_branch mega_kernel_rf_pa_13_3
mega_kernel_rf_pa_13_2:
s_waitcnt vmcnt(2)
v_max_u32 v4, v40, v42
v_cmp_eq_u32 vcc, -1, v4
s_cbranch_vccnz mega_kernel_rf_pa_13_2f
v_smfmac_f32_16x16x64_bf16 v[96:99], v[40:43], a[16:23], v6
v_smfmac_f32_16x16x64_bf16 v[100:103], v[40:43], a[48:55], v6
v_smfmac_f32_16x16x64_bf16 v[104:107], v[40:43], a[80:87], v6
v_smfmac_f32_16x16x64_bf16 v[108:111], v[40:43], a[112:119], v6
s_branch mega_kernel_rf_pa_9_3
mega_kernel_rf_pa_13_3f:
s_mov_b64 exec, vcc
buffer_load_dwordx4 v[44:47], v7, s[84:87], s33 offen offset:3072 sc1
s_mov_b64 exec, -1
s_branch mega_kernel_rf_pa_13_0
mega_kernel_rf_pa_13_3:
s_waitcnt vmcnt(2)
v_max_u32 v4, v44, v46
v_cmp_eq_u32 vcc, -1, v4
s_cbranch_vccnz mega_kernel_rf_pa_13_3f
v_smfmac_f32_16x16x64_bf16 v[96:99], v[44:47], a[24:31], v6
v_smfmac_f32_16x16x64_bf16 v[100:103], v[44:47], a[56:63], v6
v_smfmac_f32_16x16x64_bf16 v[104:107], v[44:47], a[88:95], v6
v_smfmac_f32_16x16x64_bf16 v[108:111], v[44:47], a[120:127], v6
s_branch mega_kernel_rf_pa_5_0
mega_kernel_rf_pa_14_1f:
s_mov_b64 exec, vcc
buffer_load_dwordx4 v[36:39], v7, s[84:87], s33 offen offset:1024 sc1
s_mov_b64 exec, -1
s_branch mega_kernel_rf_pa_14_2
mega_kernel_rf_pa_14_1:
s_waitcnt vmcnt(2)
v_max_u32 v4, v36, v38
v_cmp_eq_u32 vcc, -1, v4
s_cbranch_vccnz mega_kernel_rf_pa_14_1f
v_smfmac_f32_16x16x64_bf16 v[96:99], v[36:39], a[8:15], v6
v_smfmac_f32_16x16x64_bf16 v[100:103], v[36:39], a[40:47], v6
v_smfmac_f32_16x16x64_bf16 v[104:107], v[36:39], a[72:79], v6
v_smfmac_f32_16x16x64_bf16 v[108:111], v[36:39], a[104:111], v6
s_branch mega_kernel_rf_pa_12_2
mega_kernel_rf_pa_14_2f:
s_mov_b64 exec, vcc
buffer_load_dwordx4 v[40:43], v7, s[84:87], s33 offen offset:2048 sc1
s_mov_b64 exec, -1
s_branch mega_kernel_rf_pa_14_3
mega_kernel_rf_pa_14_2:
s_waitcnt vmcnt(2)
v_max_u32 v4, v40, v42
v_cmp_eq_u32 vcc, -1, v4
s_cbranch_vccnz mega_kernel_rf_pa_14_2f
v_smfmac_f32_16x16x64_bf16 v[96:99], v[40:43], a[16:23], v6
v_smfmac_f32_16x16x64_bf16 v[100:103], v[40:43], a[48:55], v6
v_smfmac_f32_16x16x64_bf16 v[104:107], v[40:43], a[80:87], v6
v_smfmac_f32_16x16x64_bf16 v[108:111], v[40:43], a[112:119], v6
s_branch mega_kernel_rf_pa_10_3
mega_kernel_rf_pa_14_3f:
s_mov_b64 exec, vcc
buffer_load_dwordx4 v[44:47], v7, s[84:87], s33 offen offset:3072 sc1
s_mov_b64 exec, -1
s_branch mega_kernel_rf_pa_14_1
mega_kernel_rf_pa_14_3:
s_waitcnt vmcnt(2)
v_max_u32 v4, v44, v46
v_cmp_eq_u32 vcc, -1, v4
s_cbranch_vccnz mega_kernel_rf_pa_14_3f
v_smfmac_f32_16x16x64_bf16 v[96:99], v[44:47], a[24:31], v6
v_smfmac_f32_16x16x64_bf16 v[100:103], v[44:47], a[56:63], v6
v_smfmac_f32_16x16x64_bf16 v[104:107], v[44:47], a[88:95], v6
v_smfmac_f32_16x16x64_bf16 v[108:111], v[44:47], a[120:127], v6
s_branch mega_kernel_rf_pa_6_1
mega_kernel_rf_pa_15_0f:
s_mov_b64 exec, vcc
buffer_load_dwordx4 v[32:35], v7, s[84:87], s33 offen offset:0 sc1
s_mov_b64 exec, -1
s_branch mega_kernel_rf_pa_15_1
mega_kernel_rf_pa_15_0:
s_waitcnt vmcnt(3)
v_max_u32 v4, v32, v34
v_cmp_eq_u32 vcc, -1, v4
s_cbranch_vccnz mega_kernel_rf_pa_15_0f
v_smfmac_f32_16x16x64_bf16 v[96:99], v[32:35], a[0:7], v6
v_smfmac_f32_16x16x64_bf16 v[100:103], v[32:35], a[32:39], v6
v_smfmac_f32_16x16x64_bf16 v[104:107], v[32:35], a[64:71], v6
v_smfmac_f32_16x16x64_bf16 v[108:111], v[32:35], a[96:103], v6
s_branch mega_kernel_rf_pa_14_1
mega_kernel_rf_pa_15_1f:
s_mov_b64 exec, vcc
buffer_load_dwordx4 v[36:39], v7, s[84:87], s33 offen offset:1024 sc1
s_mov_b64 exec, -1
s_branch mega_kernel_rf_pa_15_2
mega_kernel_rf_pa_15_1:
s_waitcnt vmcnt(3)
v_max_u32 v4, v36, v38
v_cmp_eq_u32 vcc, -1, v4
s_cbranch_vccnz mega_kernel_rf_pa_15_1f
v_smfmac_f32_16x16x64_bf16 v[96:99], v[36:39], a[8:15], v6
v_smfmac_f32_16x16x64_bf16 v[100:103], v[36:39], a[40:47], v6
v_smfmac_f32_16x16x64_bf16 v[104:107], v[36:39], a[72:79], v6
v_smfmac_f32_16x16x64_bf16 v[108:111], v[36:39], a[104:111], v6
s_branch mega_kernel_rf_pa_13_2
mega_kernel_rf_pa_15_2f:
s_mov_b64 exec, vcc
buffer_load_dwordx4 v[40:43], v7, s[84:87], s33 offen offset:2048 sc1
s_mov_b64 exec, -1
s_branch mega_kernel_rf_pa_15_3
mega_kernel_rf_pa_15_2:
s_waitcnt vmcnt(3)
v_max_u32 v4, v40, v42
v_cmp_eq_u32 vcc, -1, v4
s_cbranch_vccnz mega_kernel_rf_pa_15_2f
v_smfmac_f32_16x16x64_bf16 v[96:99], v[40:43], a[16:23], v6
v_smfmac_f32_16x16x64_bf16 v[100:103], v[40:43], a[48:55], v6
v_smfmac_f32_16x16x64_bf16 v[104:107], v[40:43], a[80:87], v6
v_smfmac_f32_16x16x64_bf16 v[108:111], v[40:43], a[112:119], v6
s_branch mega_kernel_rf_pa_11_3
mega_kernel_rf_pa_15_3f:
s_mov_b64 exec, vcc
buffer_load_dwordx4 v[44:47], v7, s[84:87], s33 offen offset:3072 sc1
s_mov_b64 exec, -1
s_branch mega_kernel_rf_pa_15_0
mega_kernel_rf_pa_15_3:
s_waitcnt vmcnt(3)
v_max_u32 v4, v44, v46
v_cmp_eq_u32 vcc, -1, v4
s_cbranch_vccnz mega_kernel_rf_pa_15_3f
v_smfmac_f32_16x16x64_bf16 v[96:99], v[44:47], a[24:31], v6
v_smfmac_f32_16x16x64_bf16 v[100:103], v[44:47], a[56:63], v6
v_smfmac_f32_16x16x64_bf16 v[104:107], v[44:47], a[88:95], v6
v_smfmac_f32_16x16x64_bf16 v[108:111], v[44:47], a[120:127], v6
s_branch mega_kernel_rf_pa_7_0
mega_kernel_rf_pc_1_0f:
s_mov_b64 exec, vcc
buffer_load_dwordx4 v[32:35], v7, s[84:87], s29 offen offset:0 sc1
s_mov_b64 exec, -1
s_branch mega_kernel_rf_pc_1_0
mega_kernel_rf_pc_1_0:
s_waitcnt vmcnt(0)
v_cmp_eq_u32 vcc, -1, v32
s_cbranch_vccnz mega_kernel_rf_pc_1_0f
v_smfmac_f32_16x16x64_bf16 v[96:99], v[32:35], a[192:199], v6
v_smfmac_f32_16x16x64_bf16 v[100:103], v[32:35], a[224:231], v6
s_branch mega_kernel_rf_pc_d
mega_kernel_rf_pc_2_1f:
s_mov_b64 exec, vcc
buffer_load_dwordx4 v[36:39], v7, s[84:87], s29 offen offset:1024 sc1
s_mov_b64 exec, -1
s_branch mega_kernel_rf_pc_2_1
mega_kernel_rf_pc_2_1:
s_waitcnt vmcnt(0)
v_cmp_eq_u32 vcc, -1, v36
s_cbranch_vccnz mega_kernel_rf_pc_2_1f
v_smfmac_f32_16x16x64_bf16 v[96:99], v[36:39], a[200:207], v6
v_smfmac_f32_16x16x64_bf16 v[100:103], v[36:39], a[232:239], v6
s_branch mega_kernel_rf_pc_d
mega_kernel_rf_pc_3_0f:
s_mov_b64 exec, vcc
buffer_load_dwordx4 v[32:35], v7, s[84:87], s29 offen offset:0 sc1
s_mov_b64 exec, -1
s_branch mega_kernel_rf_pc_3_1
mega_kernel_rf_pc_3_0:
s_waitcnt vmcnt(1)
v_cmp_eq_u32 vcc, -1, v32
s_cbranch_vccnz mega_kernel_rf_pc_3_0f
v_smfmac_f32_16x16x64_bf16 v[96:99], v[32:35], a[192:199], v6
v_smfmac_f32_16x16x64_bf16 v[100:103], v[32:35], a[224:231], v6
s_branch mega_kernel_rf_pc_2_1
mega_kernel_rf_pc_3_1f:
s_mov_b64 exec, vcc
buffer_load_dwordx4 v[36:39], v7, s[84:87], s29 offen offset:1024 sc1
s_mov_b64 exec, -1
s_branch mega_kernel_rf_pc_3_0
mega_kernel_rf_pc_3_1:
s_waitcnt vmcnt(1)
v_cmp_eq_u32 vcc, -1, v36
s_cbranch_vccnz mega_kernel_rf_pc_3_1f
v_smfmac_f32_16x16x64_bf16 v[96:99], v[36:39], a[200:207], v6
v_smfmac_f32_16x16x64_bf16 v[100:103], v[36:39], a[232:239], v6
s_branch mega_kernel_rf_pc_1_0
mega_kernel_rf_pc_4_2f:
s_mov_b64 exec, vcc
buffer_load_dwordx4 v[40:43], v7, s[84:87], s29 offen offset:2048 sc1
s_mov_b64 exec, -1
s_branch mega_kernel_rf_pc_4_2
mega_kernel_rf_pc_4_2:
s_waitcnt vmcnt(0)
v_cmp_eq_u32 vcc, -1, v40
s_cbranch_vccnz mega_kernel_rf_pc_4_2f
v_smfmac_f32_16x16x64_bf16 v[96:99], v[40:43], a[208:215], v6
v_smfmac_f32_16x16x64_bf16 v[100:103], v[40:43], a[240:247], v6
s_branch mega_kernel_rf_pc_d
mega_kernel_rf_pc_5_0f:
s_mov_b64 exec, vcc
buffer_load_dwordx4 v[32:35], v7, s[84:87], s29 offen offset:0 sc1
s_mov_b64 exec, -1
s_branch mega_kernel_rf_pc_5_2
mega_kernel_rf_pc_5_0:
s_waitcnt vmcnt(1)
v_cmp_eq_u32 vcc, -1, v32
s_cbranch_vccnz mega_kernel_rf_pc_5_0f
v_smfmac_f32_16x16x64_bf16 v[96:99], v[32:35], a[192:199], v6
v_smfmac_f32_16x16x64_bf16 v[100:103], v[32:35], a[224:231], v6
s_branch mega_kernel_rf_pc_4_2
mega_kernel_rf_pc_5_2f:
s_mov_b64 exec, vcc
buffer_load_dwordx4 v[40:43], v7, s[84:87], s29 offen offset:2048 sc1
s_mov_b64 exec, -1
s_branch mega_kernel_rf_pc_5_0
mega_kernel_rf_pc_5_2:
s_waitcnt vmcnt(1)
v_cmp_eq_u32 vcc, -1, v40
s_cbranch_vccnz mega_kernel_rf_pc_5_2f
v_smfmac_f32_16x16x64_bf16 v[96:99], v[40:43], a[208:215], v6
v_smfmac_f32_16x16x64_bf16 v[100:103], v[40:43], a[240:247], v6
s_branch mega_kernel_rf_pc_1_0
mega_kernel_rf_pc_6_1f:
s_mov_b64 exec, vcc
buffer_load_dwordx4 v[36:39], v7, s[84:87], s29 offen offset:1024 sc1
s_mov_b64 exec, -1
s_branch mega_kernel_rf_pc_6_2
mega_kernel_rf_pc_6_1:
s_waitcnt vmcnt(1)
v_cmp_eq_u32 vcc, -1, v36
s_cbranch_vccnz mega_kernel_rf_pc_6_1f
v_smfmac_f32_16x16x64_bf16 v[96:99], v[36:39], a[200:207], v6
v_smfmac_f32_16x16x64_bf16 v[100:103], v[36:39], a[232:239], v6
s_branch mega_kernel_rf_pc_4_2
mega_kernel_rf_pc_6_2f:
s_mov_b64 exec, vcc
buffer_load_dwordx4 v[40:43], v7, s[84:87], s29 offen offset:2048 sc1
s_mov_b64 exec, -1
s_branch mega_kernel_rf_pc_6_1
mega_kernel_rf_pc_6_2:
s_waitcnt vmcnt(1)
v_cmp_eq_u32 vcc, -1, v40
s_cbranch_vccnz mega_kernel_rf_pc_6_2f
v_smfmac_f32_16x16x64_bf16 v[96:99], v[40:43], a[208:215], v6
v_smfmac_f32_16x16x64_bf16 v[100:103], v[40:43], a[240:247], v6
s_branch mega_kernel_rf_pc_2_1
mega_kernel_rf_pc_7_0f:
s_mov_b64 exec, vcc
buffer_load_dwordx4 v[32:35], v7, s[84:87], s29 offen offset:0 sc1
s_mov_b64 exec, -1
s_branch mega_kernel_rf_pc_7_1
mega_kernel_rf_pc_7_0:
s_waitcnt vmcnt(2)
v_cmp_eq_u32 vcc, -1, v32
s_cbranch_vccnz mega_kernel_rf_pc_7_0f
v_smfmac_f32_16x16x64_bf16 v[96:99], v[32:35], a[192:199], v6
v_smfmac_f32_16x16x64_bf16 v[100:103], v[32:35], a[224:231], v6
s_branch mega_kernel_rf_pc_6_1
mega_kernel_rf_pc_7_1f:
s_mov_b64 exec, vcc
buffer_load_dwordx4 v[36:39], v7, s[84:87], s29 offen offset:1024 sc1
s_mov_b64 exec, -1
s_branch mega_kernel_rf_pc_7_2
mega_kernel_rf_pc_7_1:
s_waitcnt vmcnt(2)
v_cmp_eq_u32 vcc, -1, v36
s_cbranch_vccnz mega_kernel_rf_pc_7_1f
v_smfmac_f32_16x16x64_bf16 v[96:99], v[36:39], a[200:207], v6
v_smfmac_f32_16x16x64_bf16 v[100:103], v[36:39], a[232:239], v6
s_branch mega_kernel_rf_pc_5_2
mega_kernel_rf_pc_7_2f:
s_mov_b64 exec, vcc
buffer_load_dwordx4 v[40:43], v7, s[84:87], s29 offen offset:2048 sc1
s_mov_b64 exec, -1
s_branch mega_kernel_rf_pc_7_0
mega_kernel_rf_pc_7_2:
s_waitcnt vmcnt(2)
v_cmp_eq_u32 vcc, -1, v40
s_cbranch_vccnz mega_kernel_rf_pc_7_2f
v_smfmac_f32_16x16x64_bf16 v[96:99], v[40:43], a[208:215], v6
v_smfmac_f32_16x16x64_bf16 v[100:103], v[40:43], a[240:247], v6
s_branch mega_kernel_rf_pc_3_0
mega_kernel_rf_pc_8_3f:
s_mov_b64 exec, vcc
buffer_load_dwordx4 v[44:47], v7, s[84:87], s29 offen offset:3072 sc1
s_mov_b64 exec, -1
s_branch mega_kernel_rf_pc_8_3
mega_kernel_rf_pc_9_0f:
s_mov_b64 exec, vcc
buffer_load_dwordx4 v[32:35], v7, s[84:87], s29 offen offset:0 sc1
s_mov_b64 exec, -1
s_branch mega_kernel_rf_pc_9_3
mega_kernel_rf_pc_9_0:
s_waitcnt vmcnt(1)
v_cmp_eq_u32 vcc, -1, v32
s_cbranch_vccnz mega_kernel_rf_pc_9_0f
v_smfmac_f32_16x16x64_bf16 v[96:99], v[32:35], a[192:199], v6
v_smfmac_f32_16x16x64_bf16 v[100:103], v[32:35], a[224:231], v6
s_branch mega_kernel_rf_pc_8_3
mega_kernel_rf_pc_9_3f:
s_mov_b64 exec, vcc
buffer_load_dwordx4 v[44:47], v7, s[84:87], s29 offen offset:3072 sc1
s_mov_b64 exec, -1
s_branch mega_kernel_rf_pc_9_0
mega_kernel_rf_pc_9_3:
s_waitcnt vmcnt(1)
v_cmp_eq_u32 vcc, -1, v44
s_cbranch_vccnz mega_kernel_rf_pc_9_3f
v_smfmac_f32_16x16x64_bf16 v[96:99], v[44:47], a[216:223], v6
v_smfmac_f32_16x16x64_bf16 v[100:103], v[44:47], a[248:255], v6
s_branch mega_kernel_rf_pc_1_0
mega_kernel_rf_pc_10_1f:
s_mov_b64 exec, vcc
buffer_load_dwordx4 v[36:39], v7, s[84:87], s29 offen offset:1024 sc1
s_mov_b64 exec, -1
s_branch mega_kernel_rf_pc_10_3
mega_kernel_rf_pc_10_1:
s_waitcnt vmcnt(1)
v_cmp_eq_u32 vcc, -1, v36
s_cbranch_vccnz mega_kernel_rf_pc_10_1f
v_smfmac_f32_16x16x64_bf16 v[96:99], v[36:39], a[200:207], v6
v_smfmac_f32_16x16x64_bf16 v[100:103], v[36:39], a[232:239], v6
s_branch mega_kernel_rf_pc_8_3
mega_kernel_rf_pc_10_3f:
s_mov_b64 exec, vcc
buffer_load_dwordx4 v[44:47], v7, s[84:87], s29 offen offset:3072 sc1
s_mov_b64 exec, -1
s_branch mega_kernel_rf_pc_10_1
mega_kernel_rf_pc_10_3:
s_waitcnt vmcnt(1)
v_cmp_eq_u32 vcc, -1, v44
s_cbranch_vccnz mega_kernel_rf_pc_10_3f
v_smfmac_f32_16x16x64_bf16 v[96:99], v[44:47], a[216:223], v6
v_smfmac_f32_16x16x64_bf16 v[100:103], v[44:47], a[248:255], v6
s_branch mega_kernel_rf_pc_2_1
mega_kernel_rf_pc_11_0f:
s_mov_b64 exec, vcc
buffer_load_dwordx4 v[32:35], v7, s[84:87], s29 offen offset:0 sc1
s_mov_b64 exec, -1
s_branch mega_kernel_rf_pc_11_1
mega_kernel_rf_pc_11_0:
s_waitcnt vmcnt(2)
v_cmp_eq_u32 vcc, -1, v32
s_cbranch_vccnz mega_kernel_rf_pc_11_0f
v_smfmac_f32_16x16x64_bf16 v[96:99], v[32:35], a[192:199], v6
v_smfmac_f32_16x16x64_bf16 v[100:103], v[32:35], a[224:231], v6
s_branch mega_kernel_rf_pc_10_1
mega_kernel_rf_pc_11_1f:
s_mov_b64 exec, vcc
buffer_load_dwordx4 v[36:39], v7, s[84:87], s29 offen offset:1024 sc1
s_mov_b64 exec, -1
s_branch mega_kernel_rf_pc_11_3
mega_kernel_rf_pc_11_1:
s_waitcnt vmcnt(2)
v_cmp_eq_u32 vcc, -1, v36
s_cbranch_vccnz mega_kernel_rf_pc_11_1f
v_smfmac_f32_16x16x64_bf16 v[96:99], v[36:39], a[200:207], v6
v_smfmac_f32_16x16x64_bf16 v[100:103], v[36:39], a[232:239], v6
s_branch mega_kernel_rf_pc_9_3
mega_kernel_rf_pc_11_3f:
s_mov_b64 exec, vcc
buffer_load_dwordx4 v[44:47], v7, s[84:87], s29 offen offset:3072 sc1
s_mov_b64 exec, -1
s_branch mega_kernel_rf_pc_11_0
mega_kernel_rf_pc_11_3:
s_waitcnt vmcnt(2)
v_cmp_eq_u32 vcc, -1, v44
s_cbranch_vccnz mega_kernel_rf_pc_11_3f
v_smfmac_f32_16x16x64_bf16 v[96:99], v[44:47], a[216:223], v6
v_smfmac_f32_16x16x64_bf16 v[100:103], v[44:47], a[248:255], v6
s_branch mega_kernel_rf_pc_3_0
mega_kernel_rf_pc_12_2f:
s_mov_b64 exec, vcc
buffer_load_dwordx4 v[40:43], v7, s[84:87], s29 offen offset:2048 sc1
s_mov_b64 exec, -1
s_branch mega_kernel_rf_pc_12_3
mega_kernel_rf_pc_12_3f:
s_mov_b64 exec, vcc
buffer_load_dwordx4 v[44:47], v7, s[84:87], s29 offen offset:3072 sc1
s_mov_b64 exec, -1
s_branch mega_kernel_rf_pc_12_2
mega_kernel_rf_pc_12_3:
s_waitcnt vmcnt(1)
v_cmp_eq_u32 vcc, -1, v44
s_cbranch_vccnz mega_kernel_rf_pc_12_3f
v_smfmac_f32_16x16x64_bf16 v[96:99], v[44:47], a[216:223], v6
v_smfmac_f32_16x16x64_bf16 v[100:103], v[44:47], a[248:255], v6
s_branch mega_kernel_rf_pc_4_2
mega_kernel_rf_pc_13_0f:
s_mov_b64 exec, vcc
buffer_load_dwordx4 v[32:35], v7, s[84:87], s29 offen offset:0 sc1
s_mov_b64 exec, -1
s_branch mega_kernel_rf_pc_13_2
mega_kernel_rf_pc_13_0:
s_waitcnt vmcnt(2)
v_cmp_eq_u32 vcc, -1, v32
s_cbranch_vccnz mega_kernel_rf_pc_13_0f
v_smfmac_f32_16x16x64_bf16 v[96:99], v[32:35], a[192:199], v6
v_smfmac_f32_16x16x64_bf16 v[100:103], v[32:35], a[224:231], v6
s_branch mega_kernel_rf_pc_12_2
mega_kernel_rf_pc_13_2f:
s_mov_b64 exec, vcc
buffer_load_dwordx4 v[40:43], v7, s[84:87], s29 offen offset:2048 sc1
s_mov_b64 exec, -1
s_branch mega_kernel_rf_pc_13_3
mega_kernel_rf_pc_13_2:
s_waitcnt vmcnt(2)
v_cmp_eq_u32 vcc, -1, v40
s_cbranch_vccnz mega_kernel_rf_pc_13_2f
v_smfmac_f32_16x16x64_bf16 v[96:99], v[40:43], a[208:215], v6
v_smfmac_f32_16x16x64_bf16 v[100:103], v[40:43], a[240:247], v6
s_branch mega_kernel_rf_pc_9_3
mega_kernel_rf_pc_13_3f:
s_mov_b64 exec, vcc
buffer_load_dwordx4 v[44:47], v7, s[84:87], s29 offen offset:3072 sc1
s_mov_b64 exec, -1
s_branch mega_kernel_rf_pc_13_0
mega_kernel_rf_pc_13_3:
s_waitcnt vmcnt(2)
v_cmp_eq_u32 vcc, -1, v44
s_cbranch_vccnz mega_kernel_rf_pc_13_3f
v_smfmac_f32_16x16x64_bf16 v[96:99], v[44:47], a[216:223], v6
v_smfmac_f32_16x16x64_bf16 v[100:103], v[44:47], a[248:255], v6
s_branch mega_kernel_rf_pc_5_0
mega_kernel_rf_pc_14_1f:
s_mov_b64 exec, vcc
buffer_load_dwordx4 v[36:39], v7, s[84:87], s29 offen offset:1024 sc1
s_mov_b64 exec, -1
s_branch mega_kernel_rf_pc_14_2
mega_kernel_rf_pc_14_2f:
s_mov_b64 exec, vcc
buffer_load_dwordx4 v[40:43], v7, s[84:87], s29 offen offset:2048 sc1
s_mov_b64 exec, -1
s_branch mega_kernel_rf_pc_14_3
mega_kernel_rf_pc_14_2:
s_waitcnt vmcnt(2)
v_cmp_eq_u32 vcc, -1, v40
s_cbranch_vccnz mega_kernel_rf_pc_14_2f
v_smfmac_f32_16x16x64_bf16 v[96:99], v[40:43], a[208:215], v6
v_smfmac_f32_16x16x64_bf16 v[100:103], v[40:43], a[240:247], v6
s_branch mega_kernel_rf_pc_10_3
mega_kernel_rf_pc_14_3f:
s_mov_b64 exec, vcc
buffer_load_dwordx4 v[44:47], v7, s[84:87], s29 offen offset:3072 sc1
s_mov_b64 exec, -1
s_branch mega_kernel_rf_pc_14_1
mega_kernel_rf_pc_14_3:
s_waitcnt vmcnt(2)
v_cmp_eq_u32 vcc, -1, v44
s_cbranch_vccnz mega_kernel_rf_pc_14_3f
v_smfmac_f32_16x16x64_bf16 v[96:99], v[44:47], a[216:223], v6
v_smfmac_f32_16x16x64_bf16 v[100:103], v[44:47], a[248:255], v6
s_branch mega_kernel_rf_pc_6_1
mega_kernel_rf_pc_15_0f:
s_mov_b64 exec, vcc
buffer_load_dwordx4 v[32:35], v7, s[84:87], s29 offen offset:0 sc1
s_mov_b64 exec, -1
s_branch mega_kernel_rf_pc_15_1
mega_kernel_rf_pc_15_1f:
s_mov_b64 exec, vcc
buffer_load_dwordx4 v[36:39], v7, s[84:87], s29 offen offset:1024 sc1
s_mov_b64 exec, -1
s_branch mega_kernel_rf_pc_15_2
mega_kernel_rf_pc_15_1:
s_waitcnt vmcnt(3)
v_cmp_eq_u32 vcc, -1, v36
s_cbranch_vccnz mega_kernel_rf_pc_15_1f
v_smfmac_f32_16x16x64_bf16 v[96:99], v[36:39], a[200:207], v6
v_smfmac_f32_16x16x64_bf16 v[100:103], v[36:39], a[232:239], v6
s_branch mega_kernel_rf_pc_13_2
mega_kernel_rf_pc_15_2f:
s_mov_b64 exec, vcc
buffer_load_dwordx4 v[40:43], v7, s[84:87], s29 offen offset:2048 sc1
s_mov_b64 exec, -1
s_branch mega_kernel_rf_pc_15_3
mega_kernel_rf_pc_15_2:
s_waitcnt vmcnt(3)
v_cmp_eq_u32 vcc, -1, v40
s_cbranch_vccnz mega_kernel_rf_pc_15_2f
v_smfmac_f32_16x16x64_bf16 v[96:99], v[40:43], a[208:215], v6
v_smfmac_f32_16x16x64_bf16 v[100:103], v[40:43], a[240:247], v6
s_branch mega_kernel_rf_pc_11_3
mega_kernel_rf_pc_15_3f:
s_mov_b64 exec, vcc
buffer_load_dwordx4 v[44:47], v7, s[84:87], s29 offen offset:3072 sc1
s_mov_b64 exec, -1
s_branch mega_kernel_rf_pc_15_0
mega_kernel_rf_pc_15_3:
s_waitcnt vmcnt(3)
v_cmp_eq_u32 vcc, -1, v44
s_cbranch_vccnz mega_kernel_rf_pc_15_3f
v_smfmac_f32_16x16x64_bf16 v[96:99], v[44:47], a[216:223], v6
v_smfmac_f32_16x16x64_bf16 v[100:103], v[44:47], a[248:255], v6
s_branch mega_kernel_rf_pc_7_0
mega_kernel_rf_w0last:
s_nop 7
v_permlane32_swap_b32 v112, v116
v_permlane32_swap_b32 v113, v117
v_permlane32_swap_b32 v114, v118
v_permlane32_swap_b32 v115, v119
v_pk_add_f32 v[112:113], v[112:113], v[116:117]
v_pk_add_f32 v[114:115], v[114:115], v[118:119]
ds_write_b128 v20, v[112:115]
s_waitcnt lgkmcnt(0)
s_barrier
s_branch mega_kernel_rf_end
mega_kernel_rf_side:
s_cmp_eq_u32 s24, 3
s_cbranch_scc1 mega_kernel_rf_sd3
s_cmp_eq_u32 s24, 2
s_cbranch_scc0 mega_kernel_rf_sd4
s_mov_b64 exec, s[40:41]
buffer_store_dwordx4 v[28:31], v11, s[84:87], s34 offen
s_mov_b64 exec, -1
buffer_store_dwordx2 v[28:29], v9, s[84:87], s34 offen
s_mul_i32 s28, s31, 2048
s_add_u32 s28, s28, s34
s_add_u32 s28, s28, 49152
buffer_store_dwordx4 v[28:31], v17, s[84:87], s28 offen
buffer_store_dwordx4 v[28:31], v10, s[84:87], s28 offen
s_branch mega_kernel_rf_sd4
mega_kernel_rf_sd3:
s_mov_b32 s36, 0
s_add_u32 s76, s27, 1
s_cmp_lt_u32 s76, 63
s_cbranch_scc0 mega_kernel_rf_sd4
s_cmp_ge_u32 s76, 0
s_cbranch_scc0 mega_kernel_rf_sd4
s_cmp_gt_i32 s46, s76
s_cselect_b32 s36, 0, 1
s_cbranch_scc0 mega_kernel_rf_sd4
s_add_u32 s77, s76, s82
s_bfe_u32 s28, s77, 0x40002
s_lshl_b32 s28, s28, 14
s_and_b32 s77, s77, 3
s_lshl_b32 s77, s77, 11
s_add_u32 s28, s28, s77
s_add_u32 m0, s45, 0
s_nop 0
buffer_load_dwordx4 v240, s[84:87], s28 offen offset:0 sc1 lds
s_add_u32 m0, s45, 0
s_nop 0
buffer_load_dwordx4 v240, s[84:87], s28 offen offset:1024 sc1 lds
s_add_u32 m0, s45, 2048
s_nop 0
buffer_load_dwordx4 v241, s[84:87], s28 offen offset:0 sc1 lds
s_add_u32 m0, s45, 2048
s_nop 0
buffer_load_dwordx4 v241, s[84:87], s28 offen offset:1024 sc1 lds
s_add_u32 s45, s45, 4096
s_cmp_eq_u32 s45, 30720
s_cselect_b32 s45, 18432, s45
mega_kernel_rf_sd4:
v_smfmac_f32_16x16x64_bf16 v[112:115], v[40:43], a[144:151], v6
v_smfmac_f32_16x16x64_bf16 v[116:119], v[40:43], a[176:183], v6
v_smfmac_f32_16x16x64_bf16 v[112:115], v[44:47], a[152:159], v6
v_smfmac_f32_16x16x64_bf16 v[116:119], v[44:47], a[184:191], v6
s_nop 7
v_permlane32_swap_b32 v112, v116
v_permlane32_swap_b32 v113, v117
v_permlane32_swap_b32 v114, v118
v_permlane32_swap_b32 v115, v119
v_pk_add_f32 v[112:113], v[112:113], v[116:117]
v_pk_add_f32 v[114:115], v[114:115], v[118:119]
ds_write_b128 v20, v[112:115]
v_mov_b32 v96, 0
v_mov_b32 v97, 0
v_mov_b32 v98, 0
v_mov_b32 v99, 0
v_mov_b32 v100, 0
v_mov_b32 v101, 0
v_mov_b32 v102, 0
v_mov_b32 v103, 0
s_cmp_eq_u32 s24, 1
s_cbranch_scc0 mega_kernel_rf_s1
s_waitcnt lgkmcnt(0)
ds_read_b128 v[120:123], v16 offset:0
ds_read_b128 v[124:127], v16 offset:16
ds_read_b128 v[128:131], v16 offset:2304
ds_read_b128 v[132:135], v16 offset:2320
ds_read_b128 v[136:139], v16 offset:4608
ds_read_b128 v[140:143], v16 offset:4624
ds_read_b128 v[144:147], v16 offset:6912
ds_read_b128 v[148:151], v16 offset:6928
s_waitcnt lgkmcnt(4)
v_pk_add_f32 v[120:121], v[120:121], v[128:129]
v_pk_add_f32 v[122:123], v[122:123], v[130:131]
v_pk_add_f32 v[124:125], v[124:125], v[132:133]
v_pk_add_f32 v[126:127], v[126:127], v[134:135]
s_waitcnt lgkmcnt(0)
v_pk_add_f32 v[136:137], v[136:137], v[144:145]
v_pk_add_f32 v[138:139], v[138:139], v[146:147]
v_pk_add_f32 v[140:141], v[140:141], v[148:149]
v_pk_add_f32 v[142:143], v[142:143], v[150:151]
v_pk_add_f32 v[120:121], v[120:121], v[136:137]
v_pk_add_f32 v[122:123], v[122:123], v[138:139]
v_pk_add_f32 v[124:125], v[124:125], v[140:141]
v_pk_add_f32 v[126:127], v[126:127], v[142:143]
v_cvt_pk_bf16_f32 v244, v120, v121
v_cvt_pk_bf16_f32 v245, v122, v123
v_cvt_pk_bf16_f32 v246, v124, v125
v_cvt_pk_bf16_f32 v247, v126, v127
mega_kernel_rf_s1:
v_add_u32 v5, 9216, v17
s_waitcnt lgkmcnt(0)
s_barrier
s_cmp_eq_u32 s24, 2
s_cbranch_scc1 mega_kernel_rf_s2
s_cmp_eq_u32 s24, 3
s_cbranch_scc0 mega_kernel_rf_s3
s_add_u32 s76, s27, 2
s_cmp_lt_u32 s76, 63
s_cbranch_scc0 mega_kernel_rf_s3
s_cmp_gt_i32 s46, s76
s_cbranch_scc0 mega_kernel_rf_s3
s_add_u32 s77, s76, s82
s_bfe_u32 s28, s77, 0x40002
s_lshl_b32 s28, s28, 14
s_and_b32 s77, s77, 3
s_lshl_b32 s77, s77, 11
s_add_u32 s28, s28, s77
s_add_u32 s28, s28, s83
s_buffer_load_dword s78, s[84:87], s28 offset:0
s_buffer_load_dword s78, s[84:87], s28 offset:128
s_buffer_load_dword s78, s[84:87], s28 offset:256
s_buffer_load_dword s78, s[84:87], s28 offset:384
s_buffer_load_dword s78, s[84:87], s28 offset:512
s_buffer_load_dword s78, s[84:87], s28 offset:640
s_buffer_load_dword s78, s[84:87], s28 offset:768
s_buffer_load_dword s78, s[84:87], s28 offset:896
s_buffer_load_dword s78, s[84:87], s28 offset:1024
s_buffer_load_dword s78, s[84:87], s28 offset:1152
s_buffer_load_dword s78, s[84:87], s28 offset:1280
s_buffer_load_dword s78, s[84:87], s28 offset:1408
s_buffer_load_dword s78, s[84:87], s28 offset:1536
s_buffer_load_dword s78, s[84:87], s28 offset:1664
s_buffer_load_dword s78, s[84:87], s28 offset:1792
s_buffer_load_dword s78, s[84:87], s28 offset:1920
s_mov_b32 s88, s76
s_branch mega_kernel_rf_s3
mega_kernel_rf_s2:
ds_read_b128 v[120:123], v5 offset:0
ds_read_b128 v[124:127], v5 offset:1024
ds_read_b128 v[128:131], v5 offset:2048
ds_read_b128 v[132:135], v5 offset:3072
v_lshrrev_b32 v5, 1, v17
s_waitcnt lgkmcnt(2)
v_pk_add_f32 v[120:121], v[120:121], v[124:125]
v_pk_add_f32 v[122:123], v[122:123], v[126:127]
s_waitcnt lgkmcnt(0)
v_pk_add_f32 v[128:129], v[128:129], v[132:133]
v_pk_add_f32 v[130:131], v[130:131], v[134:135]
v_pk_add_f32 v[120:121], v[120:121], v[128:129]
v_pk_add_f32 v[122:123], v[122:123], v[130:131]
v_cvt_pk_bf16_f32 v244, v120, v121
v_cvt_pk_bf16_f32 v245, v122, v123
ds_write_b64 v5, v[244:245] offset:17920
s_waitcnt lgkmcnt(0) vmcnt(0)
mega_kernel_rf_s3:
s_cmp_eq_u32 s27, 63
s_cbranch_scc1 mega_kernel_rf_slast
s_add_u32 s29, s33, 24576
s_barrier
s_cmp_eq_u32 s24, 3
s_cbranch_scc1 mega_kernel_rf_y3
s_add_u32 s77, s27, s82
s_bfe_u32 s28, s77, 0x30003
s_lshl_b32 s28, s28, 14
s_and_b32 s77, s77, 7
s_lshl_b32 s77, s77, 10
s_add_u32 s28, s28, s77
s_add_u32 s28, s28, s79
s_cmp_eq_u32 s24, 2
s_cbranch_scc1 mega_kernel_rf_kv2a
s_mov_b64 exec, s[48:49]
buffer_store_dwordx4 v[244:247], v22, s[84:87], s28 offen sc1
s_mov_b64 exec, -1
s_branch mega_kernel_rf_kvda
mega_kernel_rf_kv2a:
v_lshlrev_b32 v4, 3, v1
buffer_store_dwordx2 v[244:245], v4, s[84:87], s28 offen offset:512 sc1
mega_kernel_rf_kvda:
s_branch mega_kernel_rf_y4
mega_kernel_rf_y3:
s_add_u32 s76, s27, 2
s_cmp_lt_u32 s76, 63
s_cbranch_scc0 mega_kernel_rf_y4
mega_kernel_rf_y4:
s_branch mega_kernel_rf_b3
mega_kernel_rf_first:
buffer_load_dwordx4 v[32:35], v8, s[20:23], 0 offen offset:0
buffer_load_dwordx4 v[36:39], v8, s[20:23], 0 offen offset:128
buffer_load_dwordx4 v[40:43], v8, s[20:23], 0 offen offset:256
buffer_load_dwordx4 v[44:47], v8, s[20:23], 0 offen offset:384
v_add_u32 v5, s44, v17
ds_read_b128 v[156:159], v5 offset:0
ds_read_b128 v[160:163], v5 offset:1024
ds_read_b128 v[164:167], v5 offset:2048
ds_read_b128 v[168:171], v5 offset:3072
s_waitcnt vmcnt(0)
v_smfmac_f32_16x16x64_bf16 v[96:99], v[32:35], a[0:7], v6
v_smfmac_f32_16x16x64_bf16 v[100:103], v[32:35], a[32:39], v6
v_smfmac_f32_16x16x64_bf16 v[104:107], v[32:35], a[64:71], v6
v_smfmac_f32_16x16x64_bf16 v[108:111], v[32:35], a[96:103], v6
v_smfmac_f32_16x16x64_bf16 v[96:99], v[36:39], a[8:15], v6
v_smfmac_f32_16x16x64_bf16 v[100:103], v[36:39], a[40:47], v6
v_smfmac_f32_16x16x64_bf16 v[104:107], v[36:39], a[72:79], v6
v_smfmac_f32_16x16x64_bf16 v[108:111], v[36:39], a[104:111], v6
v_smfmac_f32_16x16x64_bf16 v[96:99], v[40:43], a[16:23], v6
v_smfmac_f32_16x16x64_bf16 v[100:103], v[40:43], a[48:55], v6
v_smfmac_f32_16x16x64_bf16 v[104:107], v[40:43], a[80:87], v6
v_smfmac_f32_16x16x64_bf16 v[108:111], v[40:43], a[112:119], v6
v_smfmac_f32_16x16x64_bf16 v[96:99], v[44:47], a[24:31], v6
v_smfmac_f32_16x16x64_bf16 v[100:103], v[44:47], a[56:63], v6
v_smfmac_f32_16x16x64_bf16 v[104:107], v[44:47], a[88:95], v6
v_smfmac_f32_16x16x64_bf16 v[108:111], v[44:47], a[120:127], v6
s_nop 1
s_branch mega_kernel_rf_adone
mega_kernel_rf_slast:
s_cmp_eq_u32 s24, 3
s_cbranch_scc1 mega_kernel_rf_end
s_add_u32 s77, s27, s82
s_bfe_u32 s28, s77, 0x30003
s_lshl_b32 s28, s28, 14
s_and_b32 s77, s77, 7
s_lshl_b32 s77, s77, 10
s_add_u32 s28, s28, s77
s_add_u32 s28, s28, s79
s_cmp_eq_u32 s24, 2
s_cbranch_scc1 mega_kernel_rf_kv2b
s_mov_b64 exec, s[48:49]
buffer_store_dwordx4 v[244:247], v22, s[84:87], s28 offen sc1
s_mov_b64 exec, -1
s_branch mega_kernel_rf_kvdb
mega_kernel_rf_kv2b:
v_lshlrev_b32 v4, 3, v1
buffer_store_dwordx2 v[244:245], v4, s[84:87], s28 offen offset:512 sc1
mega_kernel_rf_kvdb:
s_waitcnt vmcnt(0)
s_barrier
s_mov_b32 s76, 64
s_cmp_eq_u32 s24, 1
s_cbranch_scc0 mega_kernel_rf_end
v_mov_b32 v5, s76
s_mov_b64 exec, 1
buffer_store_dword v5, v228, s[84:87], s81 offen sc1
s_mov_b64 exec, -1
mega_kernel_rf_end:
s_endpgm
mega_kernel_recs:
s_load_dwordx2 s[20:21], s[0:1], 8
s_load_dwordx2 s[16:17], s[0:1], 40
s_load_dwordx2 s[4:5], s[0:1], 16
s_load_dwordx2 s[8:9], s[0:1], 24
s_load_dwordx2 s[12:13], s[0:1], 32
v_lshrrev_b32 v4, 6, v0
v_and_b32 v1, 63, v0
v_readfirstlane_b32 s24, v4
v_lshrrev_b32 v2, 4, v1
v_and_b32 v3, 15, v1
v_lshlrev_b32 v17, 4, v1
s_lshr_b32 s28, s31, 2
s_lshl_b32 s25, s30, 3
s_add_u32 s25, s25, s28
s_and_b32 s26, s31, 3
s_waitcnt lgkmcnt(0)
s_mov_b32 s22, 16384
s_mov_b32 s23, 0x00020000
s_mov_b32 s18, 8388608
s_mov_b32 s19, 0x00020000
s_mov_b32 s6, 8388608
s_mov_b32 s7, 0x00020000
s_mov_b32 s10, 8388608
s_mov_b32 s11, 0x00020000
s_mov_b32 s14, 8388608
s_mov_b32 s15, 0x00020000
s_lshl_b32 s28, s25, 8
s_lshr_b32 s29, s26, 0
s_lshl_b32 s29, s29, 6
s_add_u32 s28, s28, s29
s_lshl_b32 s29, s24, 21
s_add_u32 s28, s28, s29
v_lshrrev_b32 v4, 2, v1
v_and_b32 v5, 3, v1
v_lshlrev_b32 v40, 13, v4
v_lshl_add_u32 v40, v5, 4, v40
v_add_u32 v40, s28, v40
s_lshl_b32 s28, s30, 21
s_lshl_b32 s29, s24, 19
s_add_u32 s28, s28, s29
s_lshr_b32 s29, s31, 0
s_lshl_b32 s29, s29, 6
s_add_u32 s28, s28, s29
v_lshlrev_b32 v41, 11, v4
v_lshl_add_u32 v41, v5, 4, v41
v_add_u32 v41, s28, v41
s_lshl_b32 s47, s24, 15
s_add_u32 s47, s47, 32768
s_lshl_b32 s28, s31, 18
s_lshl_b32 s29, s24, 16
s_add_u32 s28, s28, s29
s_lshl_b32 s29, s30, 11
s_add_u32 s28, s28, s29
v_lshlrev_b32 v48, 13, v2
v_lshl_add_u32 v48, v3, 7, v48
v_add_u32 v48, s28, v48
s_lshl_b32 s28, s30, 21
s_lshl_b32 s29, s31, 16
s_add_u32 s28, s28, s29
s_lshl_b32 s29, s24, 14
s_add_u32 s28, s28, s29
v_lshlrev_b32 v49, 7, v1
v_add_u32 v49, s28, v49
s_and_b32 s76, s31, 1
s_mul_i32 s76, s76, 8
s_and_b32 s28, s31, 15
s_lshl_b32 s28, s28, 4
s_lshl_b32 s29, s24, 8
s_add_u32 s28, s28, s29
v_add_u32 v53, s28, v3
s_lshr_b32 s28, s31, 4
s_lshl_b32 s28, s28, 10
s_add_u32 s28, s28, 384
v_mov_b32 v54, s28
v_mov_b32 v55, 1920
v_cmp_gt_u32 vcc, 32, v1
s_nop 1
v_cndmask_b32 v54, v55, v54, vcc
s_lshl_b32 s29, s30, 11
v_lshl_add_u32 v51, v53, 13, v54
v_add_u32 v51, s29, v51
s_lshl_b32 s29, s30, 21
v_lshl_add_u32 v52, v53, 11, v54
v_add_u32 v52, s29, v52
buffer_load_dword v50, v51, s[8:11], 0 offen
s_xor_b32 s29, s76, 0
s_lshl_b32 s28, s29, 10
s_add_u32 s28, s28, s47
s_add_u32 m0, s28, 0
s_lshl_b32 s29, s29, 17
buffer_load_dwordx4 v40, s[8:11], s29 offen lds
s_xor_b32 s29, s76, 1
s_lshl_b32 s28, s29, 10
s_add_u32 s28, s28, s47
s_add_u32 m0, s28, 0
s_lshl_b32 s29, s29, 17
buffer_load_dwordx4 v40, s[8:11], s29 offen lds
s_xor_b32 s29, s76, 2
s_lshl_b32 s28, s29, 10
s_add_u32 s28, s28, s47
s_add_u32 m0, s28, 0
s_lshl_b32 s29, s29, 17
buffer_load_dwordx4 v40, s[8:11], s29 offen lds
s_xor_b32 s29, s76, 3
s_lshl_b32 s28, s29, 10
s_add_u32 s28, s28, s47
s_add_u32 m0, s28, 0
s_lshl_b32 s29, s29, 17
buffer_load_dwordx4 v40, s[8:11], s29 offen lds
s_xor_b32 s29, s76, 4
s_lshl_b32 s28, s29, 10
s_add_u32 s28, s28, s47
s_add_u32 m0, s28, 0
s_lshl_b32 s29, s29, 17
buffer_load_dwordx4 v40, s[8:11], s29 offen lds
s_xor_b32 s29, s76, 5
s_lshl_b32 s28, s29, 10
s_add_u32 s28, s28, s47
s_add_u32 m0, s28, 0
s_lshl_b32 s29, s29, 17
buffer_load_dwordx4 v40, s[8:11], s29 offen lds
s_xor_b32 s29, s76, 6
s_lshl_b32 s28, s29, 10
s_add_u32 s28, s28, s47
s_add_u32 m0, s28, 0
s_lshl_b32 s29, s29, 17
buffer_load_dwordx4 v40, s[8:11], s29 offen lds
s_xor_b32 s29, s76, 7
s_lshl_b32 s28, s29, 10
s_add_u32 s28, s28, s47
s_add_u32 m0, s28, 0
s_lshl_b32 s29, s29, 17
buffer_load_dwordx4 v40, s[8:11], s29 offen lds
s_xor_b32 s29, s76, 8
s_lshl_b32 s28, s29, 10
s_add_u32 s28, s28, s47
s_add_u32 m0, s28, 0
s_lshl_b32 s29, s29, 17
buffer_load_dwordx4 v40, s[8:11], s29 offen lds
s_xor_b32 s29, s76, 9
s_lshl_b32 s28, s29, 10
s_add_u32 s28, s28, s47
s_add_u32 m0, s28, 0
s_lshl_b32 s29, s29, 17
buffer_load_dwordx4 v40, s[8:11], s29 offen lds
s_xor_b32 s29, s76, 10
s_lshl_b32 s28, s29, 10
s_add_u32 s28, s28, s47
s_add_u32 m0, s28, 0
s_lshl_b32 s29, s29, 17
buffer_load_dwordx4 v40, s[8:11], s29 offen lds
s_xor_b32 s29, s76, 11
s_lshl_b32 s28, s29, 10
s_add_u32 s28, s28, s47
s_add_u32 m0, s28, 0
s_lshl_b32 s29, s29, 17
buffer_load_dwordx4 v40, s[8:11], s29 offen lds
s_xor_b32 s29, s76, 12
s_lshl_b32 s28, s29, 10
s_add_u32 s28, s28, s47
s_add_u32 m0, s28, 0
s_lshl_b32 s29, s29, 17
buffer_load_dwordx4 v40, s[8:11], s29 offen lds
s_xor_b32 s29, s76, 13
s_lshl_b32 s28, s29, 10
s_add_u32 s28, s28, s47
s_add_u32 m0, s28, 0
s_lshl_b32 s29, s29, 17
buffer_load_dwordx4 v40, s[8:11], s29 offen lds
s_xor_b32 s29, s76, 14
s_lshl_b32 s28, s29, 10
s_add_u32 s28, s28, s47
s_add_u32 m0, s28, 0
s_lshl_b32 s29, s29, 17
buffer_load_dwordx4 v40, s[8:11], s29 offen lds
s_xor_b32 s29, s76, 15
s_lshl_b32 s28, s29, 10
s_add_u32 s28, s28, s47
s_add_u32 m0, s28, 0
s_lshl_b32 s29, s29, 17
buffer_load_dwordx4 v40, s[8:11], s29 offen lds
buffer_load_dword v50, v51, s[12:15], 0 offen
s_xor_b32 s29, s76, 0
s_lshl_b32 s28, s29, 10
s_add_u32 s28, s28, s47
s_add_u32 m0, s28, 16384
s_lshl_b32 s29, s29, 17
buffer_load_dwordx4 v40, s[12:15], s29 offen lds
s_xor_b32 s29, s76, 1
s_lshl_b32 s28, s29, 10
s_add_u32 s28, s28, s47
s_add_u32 m0, s28, 16384
s_lshl_b32 s29, s29, 17
buffer_load_dwordx4 v40, s[12:15], s29 offen lds
s_xor_b32 s29, s76, 2
s_lshl_b32 s28, s29, 10
s_add_u32 s28, s28, s47
s_add_u32 m0, s28, 16384
s_lshl_b32 s29, s29, 17
buffer_load_dwordx4 v40, s[12:15], s29 offen lds
s_xor_b32 s29, s76, 3
s_lshl_b32 s28, s29, 10
s_add_u32 s28, s28, s47
s_add_u32 m0, s28, 16384
s_lshl_b32 s29, s29, 17
buffer_load_dwordx4 v40, s[12:15], s29 offen lds
s_xor_b32 s29, s76, 4
s_lshl_b32 s28, s29, 10
s_add_u32 s28, s28, s47
s_add_u32 m0, s28, 16384
s_lshl_b32 s29, s29, 17
buffer_load_dwordx4 v40, s[12:15], s29 offen lds
s_xor_b32 s29, s76, 5
s_lshl_b32 s28, s29, 10
s_add_u32 s28, s28, s47
s_add_u32 m0, s28, 16384
s_lshl_b32 s29, s29, 17
buffer_load_dwordx4 v40, s[12:15], s29 offen lds
s_xor_b32 s29, s76, 6
s_lshl_b32 s28, s29, 10
s_add_u32 s28, s28, s47
s_add_u32 m0, s28, 16384
s_lshl_b32 s29, s29, 17
buffer_load_dwordx4 v40, s[12:15], s29 offen lds
s_xor_b32 s29, s76, 7
s_lshl_b32 s28, s29, 10
s_add_u32 s28, s28, s47
s_add_u32 m0, s28, 16384
s_lshl_b32 s29, s29, 17
buffer_load_dwordx4 v40, s[12:15], s29 offen lds
s_xor_b32 s29, s76, 8
s_lshl_b32 s28, s29, 10
s_add_u32 s28, s28, s47
s_add_u32 m0, s28, 16384
s_lshl_b32 s29, s29, 17
buffer_load_dwordx4 v40, s[12:15], s29 offen lds
s_xor_b32 s29, s76, 9
s_lshl_b32 s28, s29, 10
s_add_u32 s28, s28, s47
s_add_u32 m0, s28, 16384
s_lshl_b32 s29, s29, 17
buffer_load_dwordx4 v40, s[12:15], s29 offen lds
s_xor_b32 s29, s76, 10
s_lshl_b32 s28, s29, 10
s_add_u32 s28, s28, s47
s_add_u32 m0, s28, 16384
s_lshl_b32 s29, s29, 17
buffer_load_dwordx4 v40, s[12:15], s29 offen lds
s_xor_b32 s29, s76, 11
s_lshl_b32 s28, s29, 10
s_add_u32 s28, s28, s47
s_add_u32 m0, s28, 16384
s_lshl_b32 s29, s29, 17
buffer_load_dwordx4 v40, s[12:15], s29 offen lds
s_xor_b32 s29, s76, 12
s_lshl_b32 s28, s29, 10
s_add_u32 s28, s28, s47
s_add_u32 m0, s28, 16384
s_lshl_b32 s29, s29, 17
buffer_load_dwordx4 v40, s[12:15], s29 offen lds
s_xor_b32 s29, s76, 13
s_lshl_b32 s28, s29, 10
s_add_u32 s28, s28, s47
s_add_u32 m0, s28, 16384
s_lshl_b32 s29, s29, 17
buffer_load_dwordx4 v40, s[12:15], s29 offen lds
s_xor_b32 s29, s76, 14
s_lshl_b32 s28, s29, 10
s_add_u32 s28, s28, s47
s_add_u32 m0, s28, 16384
s_lshl_b32 s29, s29, 17
buffer_load_dwordx4 v40, s[12:15], s29 offen lds
s_xor_b32 s29, s76, 15
s_lshl_b32 s28, s29, 10
s_add_u32 s28, s28, s47
s_add_u32 m0, s28, 16384
s_lshl_b32 s29, s29, 17
buffer_load_dwordx4 v40, s[12:15], s29 offen lds
s_mov_b32 s40, 0x00ff00ff
s_mov_b32 s41, 0x00ff00ff
s_mov_b32 s48, 0xff00ff00
s_mov_b32 s49, 0xff00ff00
s_mov_b32 s42, 0
s_mov_b32 s43, 0x00ff00ff
s_mov_b32 s32, 0x3e0293ee
v_mov_b32 v23, 0xff800000
v_mov_b32 v6, 0x4444
v_mov_b32 v4, 0xeeee
v_cndmask_b32 v6, v6, v4, s[48:49]
v_mov_b32 v28, -1
v_mov_b32 v29, -1
v_mov_b32 v30, -1
v_mov_b32 v31, -1
s_mul_i32 s28, s24, 4096
v_add_u32 v7, s28, v17
v_and_b32 v4, 7, v1
v_lshlrev_b32 v8, 11, v4
v_lshrrev_b32 v5, 3, v1
v_lshl_add_u32 v8, v5, 4, v8
s_lshl_b32 s28, s24, 9
v_add_u32 v8, s28, v8
s_lshl_b32 s28, s31, 9
s_lshr_b32 s29, s31, 3
s_mul_i32 s29, s29, 0
s_add_u32 s28, s28, s29
v_lshlrev_b32 v9, 3, v1
v_add_u32 v9, s28, v9
v_and_b32 v4, 7, v3
v_lshlrev_b32 v11, 7, v2
v_lshl_add_u32 v11, v4, 4, v11
v_add_u32 v22, 0, v11
s_add_u32 s28, s28, 24576
v_add_u32 v11, s28, v11
v_and_b32 v5, 1, v2
v_lshlrev_b32 v10, 7, v5
v_lshl_add_u32 v10, v4, 4, v10
v_add_u32 v10, 1024, v10
s_xor_b32 s37, s31, 1
s_mul_i32 s37, s37, 2048
s_add_u32 s37, s37, 49152
s_xor_b32 s38, s31, 2
s_mul_i32 s38, s38, 2048
s_add_u32 s38, s38, 49152
s_xor_b32 s39, s31, 3
s_mul_i32 s39, s39, 2048
s_add_u32 s39, s39, 49152
v_and_b32 v4, 1, v2
v_mul_u32_u24 v14, 576, v4
v_lshrrev_b32 v5, 1, v2
v_lshl_add_u32 v5, v5, 4, v3
v_lshl_add_u32 v14, v5, 2, v14
s_mul_i32 s28, s24, 1152
s_add_u32 s28, s28, 13312
v_add_u32 v18, s28, v14
s_mul_i32 s28, s24, 2304
v_add_u32 v14, s28, v14
v_add_u32 v15, 1152, v14
v_mul_u32_u24 v16, 144, v3
v_lshl_add_u32 v16, v2, 5, v16
v_bfe_u32 v4, v1, 1, 3
v_mul_u32_u24 v19, 144, v4
v_lshl_add_u32 v19, v2, 5, v19
v_and_b32 v4, 1, v1
v_lshl_add_u32 v19, v4, 4, v19
v_add_u32 v19, 13312, v19
s_lshl_b32 s28, s24, 10
s_add_u32 s28, s28, 9216
v_add_u32 v20, s28, v17
v_and_b32 v4, 31, v1
v_lshlrev_b32 v21, 3, v4
v_add_u32 v21, 17920, v21
v_lshrrev_b32 v4, 2, v3
v_and_b32 v42, 1, v4
v_lshrrev_b32 v43, 1, v4
v_lshrrev_b32 v44, 1, v2
v_and_b32 v45, 1, v2
v_lshl_add_u32 v46, v44, 4, v42
v_lshl_add_u32 v46, v45, 2, v46
v_lshl_add_u32 v46, v43, 3, v46
v_lshl_add_u32 v47, v44, 3, v42
v_lshl_add_u32 v47, v45, 4, v47
v_lshl_add_u32 v47, v43, 2, v47
v_and_b32 v5, 3, v3
v_lshlrev_b32 v5, 3, v5
v_lshl_add_u32 v46, v46, 6, v5
v_lshl_add_u32 v47, v47, 6, v5
s_and_b32 s28, s31, 0
s_lshl_b32 s28, s28, 6
s_add_u32 s28, s28, s47
v_add_u32 v46, s28, v46
v_add_u32 v47, s28, v47
s_waitcnt vmcnt(17)
ds_read_b64_tr_b16 a[64:65], v46 offset:0
ds_read_b64_tr_b16 a[66:67], v46 offset:128
ds_read_b64_tr_b16 a[68:69], v46 offset:2048
ds_read_b64_tr_b16 a[70:71], v46 offset:2176
ds_read_b64_tr_b16 a[72:73], v46 offset:4096
ds_read_b64_tr_b16 a[74:75], v46 offset:4224
ds_read_b64_tr_b16 a[76:77], v46 offset:6144
ds_read_b64_tr_b16 a[78:79], v46 offset:6272
s_waitcnt lgkmcnt(0)
ds_read_b64_tr_b16 a[80:81], v46 offset:8192
ds_read_b64_tr_b16 a[82:83], v46 offset:8320
ds_read_b64_tr_b16 a[84:85], v46 offset:10240
ds_read_b64_tr_b16 a[86:87], v46 offset:10368
ds_read_b64_tr_b16 a[88:89], v46 offset:12288
ds_read_b64_tr_b16 a[90:91], v46 offset:12416
ds_read_b64_tr_b16 a[92:93], v46 offset:14336
ds_read_b64_tr_b16 a[94:95], v46 offset:14464
s_waitcnt lgkmcnt(0)
ds_read_b64_tr_b16 a[96:97], v46 offset:32
ds_read_b64_tr_b16 a[98:99], v46 offset:160
ds_read_b64_tr_b16 a[100:101], v46 offset:2080
ds_read_b64_tr_b16 a[102:103], v46 offset:2208
ds_read_b64_tr_b16 a[104:105], v46 offset:4128
ds_read_b64_tr_b16 a[106:107], v46 offset:4256
ds_read_b64_tr_b16 a[108:109], v46 offset:6176
ds_read_b64_tr_b16 a[110:111], v46 offset:6304
s_waitcnt lgkmcnt(0)
ds_read_b64_tr_b16 a[112:113], v46 offset:8224
ds_read_b64_tr_b16 a[114:115], v46 offset:8352
ds_read_b64_tr_b16 a[116:117], v46 offset:10272
ds_read_b64_tr_b16 a[118:119], v46 offset:10400
ds_read_b64_tr_b16 a[120:121], v46 offset:12320
ds_read_b64_tr_b16 a[122:123], v46 offset:12448
ds_read_b64_tr_b16 a[124:125], v46 offset:14368
ds_read_b64_tr_b16 a[126:127], v46 offset:14496
s_waitcnt lgkmcnt(0)
buffer_load_dword v50, v51, s[4:7], 0 offen
s_xor_b32 s29, s76, 0
s_lshl_b32 s28, s29, 10
s_add_u32 s28, s28, s47
s_add_u32 m0, s28, 0
s_lshl_b32 s29, s29, 17
buffer_load_dwordx4 v40, s[4:7], s29 offen lds
s_xor_b32 s29, s76, 1
s_lshl_b32 s28, s29, 10
s_add_u32 s28, s28, s47
s_add_u32 m0, s28, 0
s_lshl_b32 s29, s29, 17
buffer_load_dwordx4 v40, s[4:7], s29 offen lds
s_xor_b32 s29, s76, 2
s_lshl_b32 s28, s29, 10
s_add_u32 s28, s28, s47
s_add_u32 m0, s28, 0
s_lshl_b32 s29, s29, 17
buffer_load_dwordx4 v40, s[4:7], s29 offen lds
s_xor_b32 s29, s76, 3
s_lshl_b32 s28, s29, 10
s_add_u32 s28, s28, s47
s_add_u32 m0, s28, 0
s_lshl_b32 s29, s29, 17
buffer_load_dwordx4 v40, s[4:7], s29 offen lds
s_xor_b32 s29, s76, 4
s_lshl_b32 s28, s29, 10
s_add_u32 s28, s28, s47
s_add_u32 m0, s28, 0
s_lshl_b32 s29, s29, 17
buffer_load_dwordx4 v40, s[4:7], s29 offen lds
s_xor_b32 s29, s76, 5
s_lshl_b32 s28, s29, 10
s_add_u32 s28, s28, s47
s_add_u32 m0, s28, 0
s_lshl_b32 s29, s29, 17
buffer_load_dwordx4 v40, s[4:7], s29 offen lds
s_xor_b32 s29, s76, 6
s_lshl_b32 s28, s29, 10
s_add_u32 s28, s28, s47
s_add_u32 m0, s28, 0
s_lshl_b32 s29, s29, 17
buffer_load_dwordx4 v40, s[4:7], s29 offen lds
s_xor_b32 s29, s76, 7
s_lshl_b32 s28, s29, 10
s_add_u32 s28, s28, s47
s_add_u32 m0, s28, 0
s_lshl_b32 s29, s29, 17
buffer_load_dwordx4 v40, s[4:7], s29 offen lds
s_xor_b32 s29, s76, 8
s_lshl_b32 s28, s29, 10
s_add_u32 s28, s28, s47
s_add_u32 m0, s28, 0
s_lshl_b32 s29, s29, 17
buffer_load_dwordx4 v40, s[4:7], s29 offen lds
s_xor_b32 s29, s76, 9
s_lshl_b32 s28, s29, 10
s_add_u32 s28, s28, s47
s_add_u32 m0, s28, 0
s_lshl_b32 s29, s29, 17
buffer_load_dwordx4 v40, s[4:7], s29 offen lds
s_xor_b32 s29, s76, 10
s_lshl_b32 s28, s29, 10
s_add_u32 s28, s28, s47
s_add_u32 m0, s28, 0
s_lshl_b32 s29, s29, 17
buffer_load_dwordx4 v40, s[4:7], s29 offen lds
s_xor_b32 s29, s76, 11
s_lshl_b32 s28, s29, 10
s_add_u32 s28, s28, s47
s_add_u32 m0, s28, 0
s_lshl_b32 s29, s29, 17
buffer_load_dwordx4 v40, s[4:7], s29 offen lds
s_xor_b32 s29, s76, 12
s_lshl_b32 s28, s29, 10
s_add_u32 s28, s28, s47
s_add_u32 m0, s28, 0
s_lshl_b32 s29, s29, 17
buffer_load_dwordx4 v40, s[4:7], s29 offen lds
s_xor_b32 s29, s76, 13
s_lshl_b32 s28, s29, 10
s_add_u32 s28, s28, s47
s_add_u32 m0, s28, 0
s_lshl_b32 s29, s29, 17
buffer_load_dwordx4 v40, s[4:7], s29 offen lds
s_xor_b32 s29, s76, 14
s_lshl_b32 s28, s29, 10
s_add_u32 s28, s28, s47
s_add_u32 m0, s28, 0
s_lshl_b32 s29, s29, 17
buffer_load_dwordx4 v40, s[4:7], s29 offen lds
s_xor_b32 s29, s76, 15
s_lshl_b32 s28, s29, 10
s_add_u32 s28, s28, s47
s_add_u32 m0, s28, 0
s_lshl_b32 s29, s29, 17
buffer_load_dwordx4 v40, s[4:7], s29 offen lds
s_waitcnt vmcnt(17)
ds_read_b64_tr_b16 a[128:129], v46 offset:16384
ds_read_b64_tr_b16 a[130:131], v46 offset:16512
ds_read_b64_tr_b16 a[132:133], v46 offset:18432
ds_read_b64_tr_b16 a[134:135], v46 offset:18560
ds_read_b64_tr_b16 a[136:137], v46 offset:20480
ds_read_b64_tr_b16 a[138:139], v46 offset:20608
ds_read_b64_tr_b16 a[140:141], v46 offset:22528
ds_read_b64_tr_b16 a[142:143], v46 offset:22656
s_waitcnt lgkmcnt(0)
ds_read_b64_tr_b16 a[144:145], v46 offset:24576
ds_read_b64_tr_b16 a[146:147], v46 offset:24704
ds_read_b64_tr_b16 a[148:149], v46 offset:26624
ds_read_b64_tr_b16 a[150:151], v46 offset:26752
ds_read_b64_tr_b16 a[152:153], v46 offset:28672
ds_read_b64_tr_b16 a[154:155], v46 offset:28800
ds_read_b64_tr_b16 a[156:157], v46 offset:30720
ds_read_b64_tr_b16 a[158:159], v46 offset:30848
s_waitcnt lgkmcnt(0)
ds_read_b64_tr_b16 a[160:161], v46 offset:16416
ds_read_b64_tr_b16 a[162:163], v46 offset:16544
ds_read_b64_tr_b16 a[164:165], v46 offset:18464
ds_read_b64_tr_b16 a[166:167], v46 offset:18592
ds_read_b64_tr_b16 a[168:169], v46 offset:20512
ds_read_b64_tr_b16 a[170:171], v46 offset:20640
ds_read_b64_tr_b16 a[172:173], v46 offset:22560
ds_read_b64_tr_b16 a[174:175], v46 offset:22688
s_waitcnt lgkmcnt(0)
ds_read_b64_tr_b16 a[176:177], v46 offset:24608
ds_read_b64_tr_b16 a[178:179], v46 offset:24736
ds_read_b64_tr_b16 a[180:181], v46 offset:26656
ds_read_b64_tr_b16 a[182:183], v46 offset:26784
ds_read_b64_tr_b16 a[184:185], v46 offset:28704
ds_read_b64_tr_b16 a[186:187], v46 offset:28832
ds_read_b64_tr_b16 a[188:189], v46 offset:30752
ds_read_b64_tr_b16 a[190:191], v46 offset:30880
s_waitcnt lgkmcnt(0)
buffer_load_dword v50, v52, s[16:19], 0 offen
s_xor_b32 s29, s76, 0
s_lshl_b32 s28, s29, 10
s_add_u32 s28, s28, s47
s_add_u32 m0, s28, 16384
s_lshl_b32 s29, s29, 15
buffer_load_dwordx4 v41, s[16:19], s29 offen lds
s_xor_b32 s29, s76, 1
s_lshl_b32 s28, s29, 10
s_add_u32 s28, s28, s47
s_add_u32 m0, s28, 16384
s_lshl_b32 s29, s29, 15
buffer_load_dwordx4 v41, s[16:19], s29 offen lds
s_xor_b32 s29, s76, 2
s_lshl_b32 s28, s29, 10
s_add_u32 s28, s28, s47
s_add_u32 m0, s28, 16384
s_lshl_b32 s29, s29, 15
buffer_load_dwordx4 v41, s[16:19], s29 offen lds
s_xor_b32 s29, s76, 3
s_lshl_b32 s28, s29, 10
s_add_u32 s28, s28, s47
s_add_u32 m0, s28, 16384
s_lshl_b32 s29, s29, 15
buffer_load_dwordx4 v41, s[16:19], s29 offen lds
s_xor_b32 s29, s76, 4
s_lshl_b32 s28, s29, 10
s_add_u32 s28, s28, s47
s_add_u32 m0, s28, 16384
s_lshl_b32 s29, s29, 15
buffer_load_dwordx4 v41, s[16:19], s29 offen lds
s_xor_b32 s29, s76, 5
s_lshl_b32 s28, s29, 10
s_add_u32 s28, s28, s47
s_add_u32 m0, s28, 16384
s_lshl_b32 s29, s29, 15
buffer_load_dwordx4 v41, s[16:19], s29 offen lds
s_xor_b32 s29, s76, 6
s_lshl_b32 s28, s29, 10
s_add_u32 s28, s28, s47
s_add_u32 m0, s28, 16384
s_lshl_b32 s29, s29, 15
buffer_load_dwordx4 v41, s[16:19], s29 offen lds
s_xor_b32 s29, s76, 7
s_lshl_b32 s28, s29, 10
s_add_u32 s28, s28, s47
s_add_u32 m0, s28, 16384
s_lshl_b32 s29, s29, 15
buffer_load_dwordx4 v41, s[16:19], s29 offen lds
s_xor_b32 s29, s76, 8
s_lshl_b32 s28, s29, 10
s_add_u32 s28, s28, s47
s_add_u32 m0, s28, 16384
s_lshl_b32 s29, s29, 15
buffer_load_dwordx4 v41, s[16:19], s29 offen lds
s_xor_b32 s29, s76, 9
s_lshl_b32 s28, s29, 10
s_add_u32 s28, s28, s47
s_add_u32 m0, s28, 16384
s_lshl_b32 s29, s29, 15
buffer_load_dwordx4 v41, s[16:19], s29 offen lds
s_xor_b32 s29, s76, 10
s_lshl_b32 s28, s29, 10
s_add_u32 s28, s28, s47
s_add_u32 m0, s28, 16384
s_lshl_b32 s29, s29, 15
buffer_load_dwordx4 v41, s[16:19], s29 offen lds
s_xor_b32 s29, s76, 11
s_lshl_b32 s28, s29, 10
s_add_u32 s28, s28, s47
s_add_u32 m0, s28, 16384
s_lshl_b32 s29, s29, 15
buffer_load_dwordx4 v41, s[16:19], s29 offen lds
s_xor_b32 s29, s76, 12
s_lshl_b32 s28, s29, 10
s_add_u32 s28, s28, s47
s_add_u32 m0, s28, 16384
s_lshl_b32 s29, s29, 15
buffer_load_dwordx4 v41, s[16:19], s29 offen lds
s_xor_b32 s29, s76, 13
s_lshl_b32 s28, s29, 10
s_add_u32 s28, s28, s47
s_add_u32 m0, s28, 16384
s_lshl_b32 s29, s29, 15
buffer_load_dwordx4 v41, s[16:19], s29 offen lds
s_xor_b32 s29, s76, 14
s_lshl_b32 s28, s29, 10
s_add_u32 s28, s28, s47
s_add_u32 m0, s28, 16384
s_lshl_b32 s29, s29, 15
buffer_load_dwordx4 v41, s[16:19], s29 offen lds
s_xor_b32 s29, s76, 15
s_lshl_b32 s28, s29, 10
s_add_u32 s28, s28, s47
s_add_u32 m0, s28, 16384
s_lshl_b32 s29, s29, 15
buffer_load_dwordx4 v41, s[16:19], s29 offen lds
s_waitcnt vmcnt(17)
ds_read_b64_tr_b16 a[0:1], v46 offset:0
ds_read_b64_tr_b16 a[2:3], v46 offset:128
ds_read_b64_tr_b16 a[4:5], v46 offset:2048
ds_read_b64_tr_b16 a[6:7], v46 offset:2176
ds_read_b64_tr_b16 a[8:9], v46 offset:4096
ds_read_b64_tr_b16 a[10:11], v46 offset:4224
ds_read_b64_tr_b16 a[12:13], v46 offset:6144
ds_read_b64_tr_b16 a[14:15], v46 offset:6272
s_waitcnt lgkmcnt(0)
ds_read_b64_tr_b16 a[16:17], v46 offset:8192
ds_read_b64_tr_b16 a[18:19], v46 offset:8320
ds_read_b64_tr_b16 a[20:21], v46 offset:10240
ds_read_b64_tr_b16 a[22:23], v46 offset:10368
ds_read_b64_tr_b16 a[24:25], v46 offset:12288
ds_read_b64_tr_b16 a[26:27], v46 offset:12416
ds_read_b64_tr_b16 a[28:29], v46 offset:14336
ds_read_b64_tr_b16 a[30:31], v46 offset:14464
s_waitcnt lgkmcnt(0)
ds_read_b64_tr_b16 a[32:33], v46 offset:32
ds_read_b64_tr_b16 a[34:35], v46 offset:160
ds_read_b64_tr_b16 a[36:37], v46 offset:2080
ds_read_b64_tr_b16 a[38:39], v46 offset:2208
ds_read_b64_tr_b16 a[40:41], v46 offset:4128
ds_read_b64_tr_b16 a[42:43], v46 offset:4256
ds_read_b64_tr_b16 a[44:45], v46 offset:6176
ds_read_b64_tr_b16 a[46:47], v46 offset:6304
s_waitcnt lgkmcnt(0)
ds_read_b64_tr_b16 a[48:49], v46 offset:8224
ds_read_b64_tr_b16 a[50:51], v46 offset:8352
ds_read_b64_tr_b16 a[52:53], v46 offset:10272
ds_read_b64_tr_b16 a[54:55], v46 offset:10400
ds_read_b64_tr_b16 a[56:57], v46 offset:12320
ds_read_b64_tr_b16 a[58:59], v46 offset:12448
ds_read_b64_tr_b16 a[60:61], v46 offset:14368
ds_read_b64_tr_b16 a[62:63], v46 offset:14496
s_waitcnt lgkmcnt(0)
s_waitcnt vmcnt(0)
ds_read_b64_tr_b16 a[192:193], v47 offset:16384
ds_read_b64_tr_b16 a[194:195], v47 offset:16512
ds_read_b64_tr_b16 a[196:197], v47 offset:18432
ds_read_b64_tr_b16 a[198:199], v47 offset:18560
ds_read_b64_tr_b16 a[200:201], v47 offset:20480
ds_read_b64_tr_b16 a[202:203], v47 offset:20608
ds_read_b64_tr_b16 a[204:205], v47 offset:22528
ds_read_b64_tr_b16 a[206:207], v47 offset:22656
s_waitcnt lgkmcnt(0)
ds_read_b64_tr_b16 a[208:209], v47 offset:24576
ds_read_b64_tr_b16 a[210:211], v47 offset:24704
ds_read_b64_tr_b16 a[212:213], v47 offset:26624
ds_read_b64_tr_b16 a[214:215], v47 offset:26752
ds_read_b64_tr_b16 a[216:217], v47 offset:28672
ds_read_b64_tr_b16 a[218:219], v47 offset:28800
ds_read_b64_tr_b16 a[220:221], v47 offset:30720
ds_read_b64_tr_b16 a[222:223], v47 offset:30848
s_waitcnt lgkmcnt(0)
ds_read_b64_tr_b16 a[224:225], v47 offset:16416
ds_read_b64_tr_b16 a[226:227], v47 offset:16544
ds_read_b64_tr_b16 a[228:229], v47 offset:18464
ds_read_b64_tr_b16 a[230:231], v47 offset:18592
ds_read_b64_tr_b16 a[232:233], v47 offset:20512
ds_read_b64_tr_b16 a[234:235], v47 offset:20640
ds_read_b64_tr_b16 a[236:237], v47 offset:22560
ds_read_b64_tr_b16 a[238:239], v47 offset:22688
s_waitcnt lgkmcnt(0)
ds_read_b64_tr_b16 a[240:241], v47 offset:24608
ds_read_b64_tr_b16 a[242:243], v47 offset:24736
ds_read_b64_tr_b16 a[244:245], v47 offset:26656
ds_read_b64_tr_b16 a[246:247], v47 offset:26784
ds_read_b64_tr_b16 a[248:249], v47 offset:28704
ds_read_b64_tr_b16 a[250:251], v47 offset:28832
ds_read_b64_tr_b16 a[252:253], v47 offset:30752
ds_read_b64_tr_b16 a[254:255], v47 offset:30880
s_waitcnt lgkmcnt(0)
v_and_b32 v5, 15, v0
v_lshlrev_b32 v5, 4, v5
s_branch mega_kernel_sys
mega_kernel_sysw:
s_sleep 4
mega_kernel_sys:
buffer_load_dword v4, v5, s[72:75], 0 offen sc1
s_waitcnt vmcnt(0)
s_cmp_eq_u32 s95, 1
s_cbranch_scc0 mega_kernel_sysf
v_readlane_b32 s76, v4, 14
s_mov_b32 s98, 0
s_cmp_eq_u32 s76, 64
s_cbranch_scc0 mega_kernel_sysw
s_branch mega_kernel_sysd
mega_kernel_sysf:
s_mov_b32 s77, 0
s_mov_b32 s78, 0
v_readlane_b32 s76, v4, 0
s_add_u32 s77, s77, s76
s_xor_b32 s76, s76, 32
s_or_b32 s78, s78, s76
v_readlane_b32 s76, v4, 1
s_add_u32 s77, s77, s76
s_xor_b32 s76, s76, 32
s_or_b32 s78, s78, s76
v_readlane_b32 s76, v4, 2
s_add_u32 s77, s77, s76
s_xor_b32 s76, s76, 32
s_or_b32 s78, s78, s76
v_readlane_b32 s76, v4, 3
s_add_u32 s77, s77, s76
s_xor_b32 s76, s76, 32
s_or_b32 s78, s78, s76
v_readlane_b32 s76, v4, 4
s_add_u32 s77, s77, s76
s_xor_b32 s76, s76, 32
s_or_b32 s78, s78, s76
v_readlane_b32 s76, v4, 5
s_add_u32 s77, s77, s76
s_xor_b32 s76, s76, 32
s_or_b32 s78, s78, s76
v_readlane_b32 s76, v4, 6
s_add_u32 s77, s77, s76
s_xor_b32 s76, s76, 32
s_or_b32 s78, s78, s76
v_readlane_b32 s76, v4, 7
s_add_u32 s77, s77, s76
s_xor_b32 s76, s76, 32
s_or_b32 s78, s78, s76
s_cmp_eq_u32 s77, 256
s_cbranch_scc0 mega_kernel_sysw
v_mov_b32 v252, v4
s_cmp_eq_u32 s78, 0
s_cbranch_scc0 mega_kernel_slowent
v_readlane_b32 s76, v4, 10
v_readlane_b32 s77, v4, 8
s_cmp_eq_u32 s76, 64
s_cbranch_scc0 mega_kernel_sysw
s_cmp_gt_u32 s77, 32
s_cselect_b32 s98, 1, 0
mega_kernel_sysd:
s_lshr_b32 s28, s31, 3
s_lshl_b32 s28, s28, 14
s_lshl_b32 s29, s98, 13
s_add_u32 s28, s28, s29
s_and_b32 s29, s31, 7
s_lshl_b32 s29, s29, 10
s_add_u32 s28, s28, s29
s_lshl_b32 s29, s30, 16
s_add_u32 s28, s28, s29
s_add_u32 s28, s28, 67108864
v_add_u32 v12, s28, v17
v_xor_b32 v25, 0x10000, v12
v_xor_b32 v26, 0x20000, v12
v_xor_b32 v27, 0x30000, v12
v_add_u32 v25, 0, v25
v_add_u32 v26, 0, v26
v_add_u32 v27, 0, v27
s_lshl_b32 s28, s25, 2
s_add_u32 s28, s28, s26
s_mov_b32 s82, s28
s_lshr_b32 s29, s28, 3
s_xor_b32 s29, s29, s98
s_and_b32 s29, s29, 1
s_lshl_b32 s29, s29, 13
s_lshl_b32 s76, s28, 18
s_add_u32 s76, s76, s29
s_mov_b32 s83, s76
v_add_u32 v240, s76, v17
v_add_u32 v241, 33554432, v240
s_lshr_b32 s29, s28, 4
s_xor_b32 s29, s29, s98
s_and_b32 s29, s29, 1
s_lshl_b32 s29, s29, 13
s_lshl_b32 s79, s28, 17
s_add_u32 s79, s79, s29
s_add_u32 s79, s79, 71303168
s_xor_b32 s29, s98, 1
s_lshl_b32 s29, s29, 13
s_lshl_b32 s28, s25, 7
s_add_u32 s28, s28, s29
s_add_u32 s28, s28, 69206016
v_and_b32 v4, 1, v1
v_lshlrev_b32 v24, 12, v4
v_add_u32 v24, s28, v24
s_lshl_b32 s29, s26, 2
v_add_u32 v24, s29, v24
s_xor_b32 s81, s98, 1
s_lshl_b32 s81, s81, 13
s_lshr_b32 s29, s82, 6
s_lshl_b32 s29, s29, 14
s_add_u32 s81, s81, s29
s_and_b32 s29, s82, 63
s_lshl_b32 s29, s29, 7
s_add_u32 s81, s81, s29
s_add_u32 s81, s81, 69222400
v_mov_b32 v220, 0x3f803f80
v_mov_b32 v221, 0x3f803f80
v_mov_b32 v222, 0x3f803f80
v_mov_b32 v223, 0x3f803f80
v_mov_b32 v228, 0
s_mov_b32 s27, 0
s_mov_b32 s46, 0
s_mov_b32 s89, 0
s_mov_b32 s88, 0
s_mov_b32 s44, 18432
s_mov_b32 s45, 18432
s_cmp_eq_u32 s24, 3
s_cbranch_scc0 mega_kernel_rs_pfi
s_mov_b32 s76, 0
s_cmp_gt_i32 s46, s76
s_cbranch_scc1 mega_kernel_rs_pf0ok
mega_kernel_rs_pf0w:
buffer_load_dword v4, v24, s[84:87], 0 offen sc1
s_waitcnt vmcnt(0)
v_readlane_b32 s46, v4, 0
v_readlane_b32 s28, v4, 1
s_nop 1
s_min_i32 s46, s46, s28
s_cmp_gt_i32 s46, s76
s_cbranch_scc0 mega_kernel_rs_pf0w
mega_kernel_rs_pf0ok:
s_add_u32 s77, s76, s82
s_bfe_u32 s28, s77, 0x40002
s_lshl_b32 s28, s28, 14
s_and_b32 s77, s77, 3
s_lshl_b32 s77, s77, 11
s_add_u32 s28, s28, s77
s_add_u32 m0, s45, 0
s_nop 0
buffer_load_dwordx4 v240, s[84:87], s28 offen offset:0 sc1 lds
s_add_u32 m0, s45, 0
s_nop 0
buffer_load_dwordx4 v240, s[84:87], s28 offen offset:1024 sc1 lds
s_add_u32 m0, s45, 2048
s_nop 0
buffer_load_dwordx4 v241, s[84:87], s28 offen offset:0 sc1 lds
s_add_u32 m0, s45, 2048
s_nop 0
buffer_load_dwordx4 v241, s[84:87], s28 offen offset:1024 sc1 lds
s_add_u32 s45, s45, 4096
s_cmp_eq_u32 s45, 30720
s_cselect_b32 s45, 18432, s45
s_waitcnt vmcnt(0) lgkmcnt(0)
mega_kernel_rs_pfi:
v_mov_b32 v184, 0
v_mov_b32 v185, 0
v_mov_b32 v186, 0
v_mov_b32 v187, 0
v_mov_b32 v188, 0
v_mov_b32 v189, 0
v_mov_b32 v190, 0
v_mov_b32 v191, 0
v_mov_b32 v192, 0
v_mov_b32 v193, 0
v_mov_b32 v194, 0
v_mov_b32 v195, 0
v_mov_b32 v196, 0
v_mov_b32 v197, 0
v_mov_b32 v198, 0
v_mov_b32 v199, 0
v_mov_b32 v200, 0
v_mov_b32 v201, 0
v_mov_b32 v202, 0
v_mov_b32 v203, 0
v_mov_b32 v204, 0
v_mov_b32 v205, 0
v_mov_b32 v206, 0
v_mov_b32 v207, 0
v_mov_b32 v96, 0
v_mov_b32 v97, 0
v_mov_b32 v98, 0
v_mov_b32 v99, 0
v_mov_b32 v100, 0
v_mov_b32 v101, 0
v_mov_b32 v102, 0
v_mov_b32 v103, 0
v_mov_b32 v104, 0
v_mov_b32 v105, 0
v_mov_b32 v106, 0
v_mov_b32 v107, 0
v_mov_b32 v108, 0
v_mov_b32 v109, 0
v_mov_b32 v110, 0
v_mov_b32 v111, 0
v_mov_b32 v112, 0
v_mov_b32 v113, 0
v_mov_b32 v114, 0
v_mov_b32 v115, 0
v_mov_b32 v116, 0
v_mov_b32 v117, 0
v_mov_b32 v118, 0
v_mov_b32 v119, 0
s_barrier
s_and_b32 s29, s27, 1
s_lshl_b32 s33, s29, 17
s_lshl_b32 s28, s30, 18
s_add_u32 s33, s33, s28
s_add_u32 s33, s33, 68157440
s_xor_b32 s34, s33, 131072
s_lshl_b32 s35, s29, 18
s_bfe_u32 s47, s27, 0x10001
s_branch mega_kernel_rs_first
.p2align 6
s_nop 0
s_nop 0
mega_kernel_rs_loop:
buffer_load_dwordx4 v[32:35], v7, s[84:87], s33 offen offset:0 sc1
v_add_u32 v5, s44, v17
ds_read_b128 v[156:159], v5 offset:0
ds_read_b128 v[160:163], v5 offset:1024
ds_read_b128 v[164:167], v5 offset:2048
ds_read_b128 v[168:171], v5 offset:3072
s_nop 4
buffer_load_dwordx4 v[36:39], v7, s[84:87], s33 offen offset:1024 sc1
s_nop 9
buffer_load_dwordx4 v[40:43], v7, s[84:87], s33 offen offset:2048 sc1
s_nop 9
buffer_load_dwordx4 v[44:47], v7, s[84:87], s33 offen offset:3072 sc1
s_waitcnt vmcnt(3)
v_max_u32 v4, v32, v34
v_cmp_eq_u32 vcc, -1, v4
s_cbranch_vccnz mega_kernel_rs_pa_15_0f
v_smfmac_f32_16x16x64_bf16 v[96:99], v[32:35], a[0:7], v6
v_smfmac_f32_16x16x64_bf16 v[100:103], v[32:35], a[32:39], v6
v_smfmac_f32_16x16x64_bf16 v[104:107], v[32:35], a[64:71], v6
s_waitcnt vmcnt(2)
v_max_u32 v4, v36, v38
v_cmp_eq_u32 vcc, -1, v4
v_smfmac_f32_16x16x64_bf16 v[108:111], v[32:35], a[96:103], v6
s_cbranch_vccnz mega_kernel_rs_pa_14_1f
v_smfmac_f32_16x16x64_bf16 v[96:99], v[36:39], a[8:15], v6
v_smfmac_f32_16x16x64_bf16 v[100:103], v[36:39], a[40:47], v6
v_smfmac_f32_16x16x64_bf16 v[104:107], v[36:39], a[72:79], v6
s_waitcnt vmcnt(1)
v_max_u32 v4, v40, v42
v_cmp_eq_u32 vcc, -1, v4
v_smfmac_f32_16x16x64_bf16 v[108:111], v[36:39], a[104:111], v6
s_cbranch_vccnz mega_kernel_rs_pa_12_2f
v_smfmac_f32_16x16x64_bf16 v[96:99], v[40:43], a[16:23], v6
v_smfmac_f32_16x16x64_bf16 v[100:103], v[40:43], a[48:55], v6
v_smfmac_f32_16x16x64_bf16 v[104:107], v[40:43], a[80:87], v6
s_waitcnt vmcnt(0)
v_max_u32 v4, v44, v46
v_cmp_eq_u32 vcc, -1, v4
v_smfmac_f32_16x16x64_bf16 v[108:111], v[40:43], a[112:119], v6
s_cbranch_vccnz mega_kernel_rs_pa_8_3f
v_smfmac_f32_16x16x64_bf16 v[96:99], v[44:47], a[24:31], v6
v_smfmac_f32_16x16x64_bf16 v[100:103], v[44:47], a[56:63], v6
v_smfmac_f32_16x16x64_bf16 v[104:107], v[44:47], a[88:95], v6
v_smfmac_f32_16x16x64_bf16 v[108:111], v[44:47], a[120:127], v6
mega_kernel_rs_pa_d:
mega_kernel_rs_adone:
s_nop 5
v_permlane32_swap_b32 v96, v100
v_permlane32_swap_b32 v97, v101
v_permlane32_swap_b32 v98, v102
v_permlane32_swap_b32 v99, v103
v_pk_add_f32 v[96:97], v[96:97], v[100:101]
v_pk_add_f32 v[98:99], v[98:99], v[102:103]
ds_write2_b32 v14, v96, v97 offset0:0 offset1:36
ds_write2_b32 v14, v98, v99 offset0:72 offset1:108
v_permlane32_swap_b32 v104, v108
v_permlane32_swap_b32 v105, v109
v_permlane32_swap_b32 v106, v110
v_permlane32_swap_b32 v107, v111
v_pk_add_f32 v[104:105], v[104:105], v[108:109]
v_pk_add_f32 v[106:107], v[106:107], v[110:111]
ds_write2_b32 v15, v104, v105 offset0:0 offset1:36
ds_write2_b32 v15, v106, v107 offset0:72 offset1:108
v_smfmac_f32_16x16x64_bf16 v[112:115], v[32:35], a[128:135], v6
v_smfmac_f32_16x16x64_bf16 v[116:119], v[32:35], a[160:167], v6
v_smfmac_f32_16x16x64_bf16 v[112:115], v[36:39], a[136:143], v6
v_smfmac_f32_16x16x64_bf16 v[116:119], v[36:39], a[168:175], v6
s_waitcnt lgkmcnt(0)
s_barrier
s_cmp_lg_u32 s24, 0
s_cbranch_scc1 mega_kernel_rs_side
ds_read_b128 v[120:123], v16 offset:0
ds_read_b128 v[124:127], v16 offset:16
ds_read_b128 v[128:131], v16 offset:2304
ds_read_b128 v[132:135], v16 offset:2320
ds_read_b128 v[136:139], v16 offset:4608
ds_read_b128 v[140:143], v16 offset:4624
ds_read_b128 v[144:147], v16 offset:6912
ds_read_b128 v[148:151], v16 offset:6928
v_smfmac_f32_16x16x64_bf16 v[112:115], v[40:43], a[144:151], v6
v_smfmac_f32_16x16x64_bf16 v[116:119], v[40:43], a[176:183], v6
v_smfmac_f32_16x16x64_bf16 v[112:115], v[44:47], a[152:159], v6
v_smfmac_f32_16x16x64_bf16 v[116:119], v[44:47], a[184:191], v6
s_mul_i32 s28, s31, 2048
s_add_u32 s28, s28, s33
s_add_u32 s28, s28, 49152
s_add_u32 s76, s37, s33
s_add_u32 s77, s38, s33
s_add_u32 s78, s39, s33
s_waitcnt lgkmcnt(4)
v_pk_add_f32 v[120:121], v[120:121], v[128:129]
v_pk_add_f32 v[122:123], v[122:123], v[130:131]
v_pk_add_f32 v[124:125], v[124:125], v[132:133]
v_pk_add_f32 v[126:127], v[126:127], v[134:135]
s_waitcnt lgkmcnt(0)
v_pk_add_f32 v[136:137], v[136:137], v[144:145]
v_pk_add_f32 v[138:139], v[138:139], v[146:147]
v_pk_add_f32 v[140:141], v[140:141], v[148:149]
v_pk_add_f32 v[142:143], v[142:143], v[150:151]
v_pk_add_f32 v[120:121], v[120:121], v[136:137]
v_pk_add_f32 v[122:123], v[122:123], v[138:139]
v_pk_add_f32 v[124:125], v[124:125], v[140:141]
v_pk_add_f32 v[126:127], v[126:127], v[142:143]
v_cvt_pk_bf16_f32 v152, v120, v121
v_cvt_pk_bf16_f32 v153, v122, v123
v_cvt_pk_bf16_f32 v154, v124, v125
v_cvt_pk_bf16_f32 v155, v126, v127
s_nop 1
v_mfma_f32_16x16x32_bf16 v[176:179], v[160:163], v[152:155], 0
v_mfma_f32_16x16x32_bf16 v[172:175], v[156:159], v[152:155], 0
v_mfma_f32_16x16x32_bf16 v[180:183], v[152:155], v[152:155], 0
s_cmp_eq_u32 s27, 63
s_cbranch_scc1 mega_kernel_rs_w0last
s_nop 4
v_mov_b32_dpp v172, v176 row_shr:8 row_mask:0xf bank_mask:0xc
v_mov_b32_dpp v173, v177 row_shr:8 row_mask:0xf bank_mask:0xc
v_mov_b32_dpp v174, v178 row_shr:8 row_mask:0xf bank_mask:0xc
v_mov_b32_dpp v175, v179 row_shr:8 row_mask:0xf bank_mask:0xc
v_min_u32 v180, -2, v180
v_min_u32 v172, -2, v172
s_mov_b64 exec, s[42:43]
buffer_store_dwordx4 v[180:183], v10, s[84:87], s28 offen sc1
s_mov_b64 exec, -1
buffer_store_dwordx4 v[172:175], v17, s[84:87], s28 offen sc1
v_permlane32_swap_b32 v112, v116
v_permlane32_swap_b32 v113, v117
v_permlane32_swap_b32 v114, v118
v_permlane32_swap_b32 v115, v119
v_pk_add_f32 v[112:113], v[112:113], v[116:117]
v_pk_add_f32 v[114:115], v[114:115], v[118:119]
ds_write_b128 v20, v[112:115]
s_waitcnt lgkmcnt(0)
s_barrier
v_mov_b32 v96, 0
v_mov_b32 v97, 0
v_mov_b32 v98, 0
v_mov_b32 v99, 0
v_mov_b32 v100, 0
v_mov_b32 v101, 0
v_mov_b32 v102, 0
v_mov_b32 v103, 0
v_cndmask_b32 v176, v23, v180, s[42:43]
v_cndmask_b32 v177, v23, v181, s[42:43]
v_cndmask_b32 v178, v23, v182, s[42:43]
v_cndmask_b32 v179, v23, v183, s[42:43]
s_mov_b64 exec, s[42:43]
buffer_load_dwordx4 v[188:191], v10, s[84:87], s76 offen sc1
buffer_load_dwordx4 v[196:199], v10, s[84:87], s77 offen sc1
buffer_load_dwordx4 v[204:207], v10, s[84:87], s78 offen sc1
s_mov_b64 exec, -1
buffer_load_dwordx4 v[184:187], v17, s[84:87], s76 offen sc1
buffer_load_dwordx4 v[192:195], v17, s[84:87], s77 offen sc1
buffer_load_dwordx4 v[200:203], v17, s[84:87], s78 offen sc1
v_pk_mul_f32 v[172:173], v[172:173], s[32:33] op_sel_hi:[1,0]
v_pk_mul_f32 v[174:175], v[174:175], s[32:33] op_sel_hi:[1,0]
v_pk_mul_f32 v[176:177], v[176:177], s[32:33] op_sel_hi:[1,0]
v_pk_mul_f32 v[178:179], v[178:179], s[32:33] op_sel_hi:[1,0]
s_nop 15
s_nop 3
s_mov_b64 exec, s[42:43]
buffer_load_dwordx4 v[188:191], v10, s[84:87], s76 offen sc1
buffer_load_dwordx4 v[196:199], v10, s[84:87], s77 offen sc1
buffer_load_dwordx4 v[204:207], v10, s[84:87], s78 offen sc1
s_mov_b64 exec, -1
buffer_load_dwordx4 v[184:187], v17, s[84:87], s76 offen sc1
buffer_load_dwordx4 v[192:195], v17, s[84:87], s77 offen sc1
buffer_load_dwordx4 v[200:203], v17, s[84:87], s78 offen sc1
mega_kernel_rs_p2:
s_waitcnt vmcnt(6)
v_max3_u32 v4, v184, v188, v192
v_max3_u32 v5, v196, v200, v204
v_max_u32 v4, v4, v5
v_cmp_eq_u32 vcc, -1, v4
s_cbranch_vccnz mega_kernel_rs_p2r
v_pk_add_f32 v[124:125], v[196:197], v[204:205]
v_pk_add_f32 v[126:127], v[198:199], v[206:207]
v_pk_add_f32 v[120:121], v[192:193], v[200:201]
v_pk_add_f32 v[122:123], v[194:195], v[202:203]
v_pk_add_f32 v[124:125], v[124:125], v[188:189]
v_pk_add_f32 v[126:127], v[126:127], v[190:191]
v_pk_add_f32 v[120:121], v[120:121], v[184:185]
v_pk_add_f32 v[122:123], v[122:123], v[186:187]
v_pk_fma_f32 v[176:177], v[124:125], s[32:33], v[176:177] op_sel_hi:[1,0,1]
v_pk_fma_f32 v[178:179], v[126:127], s[32:33], v[178:179] op_sel_hi:[1,0,1]
v_pk_fma_f32 v[172:173], v[120:121], s[32:33], v[172:173] op_sel_hi:[1,0,1]
v_pk_fma_f32 v[174:175], v[122:123], s[32:33], v[174:175] op_sel_hi:[1,0,1]
v_max3_f32 v232, v172, v173, v174
v_max3_f32 v233, v176, v177, v178
v_max3_f32 v232, v232, v175, v179
v_max_f32 v234, v232, v233
s_barrier
ds_read2_b64 v[208:211], v21 offset0:0 offset1:32
v_max_f32_dpp v232, v234, v234 row_ror:8 row_mask:0xf bank_mask:0xf
v_max_f32_dpp v233, v234, v234 row_ror:8 row_mask:0xf bank_mask:0xf
s_nop 1
v_permlane16_swap_b32 v232, v233
s_nop 0
v_max_f32 v234, v232, v233
v_max_f32 v235, v232, v233
s_nop 1
v_permlane32_swap_b32 v234, v235
s_nop 0
v_max_f32 v232, v234, v235
v_pk_add_f32 v[176:177], v[176:177], v[232:233] op_sel_hi:[1,0] neg_lo:[0,1] neg_hi:[0,1]
v_pk_add_f32 v[178:179], v[178:179], v[232:233] op_sel_hi:[1,0] neg_lo:[0,1] neg_hi:[0,1]
v_pk_add_f32 v[172:173], v[172:173], v[232:233] op_sel_hi:[1,0] neg_lo:[0,1] neg_hi:[0,1]
v_pk_add_f32 v[174:175], v[174:175], v[232:233] op_sel_hi:[1,0] neg_lo:[0,1] neg_hi:[0,1]
v_exp_f32 v176, v176
v_exp_f32 v177, v177
v_exp_f32 v178, v178
v_exp_f32 v179, v179
v_exp_f32 v172, v172
v_cvt_pk_bf16_f32 v216, v176, v177
v_cvt_pk_bf16_f32 v217, v178, v179
v_exp_f32 v173, v173
v_exp_f32 v174, v174
v_mfma_f32_16x16x16_bf16 v[224:227], v[220:221], v[216:217], 0
v_exp_f32 v175, v175
v_cvt_pk_bf16_f32 v212, v172, v173
s_waitcnt lgkmcnt(0)
v_mfma_f32_16x16x16_bf16 v[120:123], v[208:209], v[216:217], 0
v_cvt_pk_bf16_f32 v213, v174, v175
v_mfma_f32_16x16x16_bf16 v[124:127], v[210:211], v[216:217], 0
v_mov_b32_dpp v214, v212 row_ror:8 row_mask:0xf bank_mask:0xf
v_mov_b32_dpp v215, v213 row_ror:8 row_mask:0xf bank_mask:0xf
s_nop 1
v_mfma_f32_16x16x32_bf16 v[224:227], v[220:223], v[212:215], v[224:227]
v_mfma_f32_16x16x32_bf16 v[120:123], v[164:167], v[212:215], v[120:123]
v_mfma_f32_16x16x32_bf16 v[124:127], v[168:171], v[212:215], v[124:127]
s_add_u32 s29, s33, 24576
s_nop 4
v_rcp_f32 v234, v224
s_nop 0
v_pk_mul_f32 v[120:121], v[120:121], v[234:235] op_sel_hi:[1,0]
v_pk_mul_f32 v[122:123], v[122:123], v[234:235] op_sel_hi:[1,0]
v_pk_mul_f32 v[124:125], v[124:125], v[234:235] op_sel_hi:[1,0]
v_pk_mul_f32 v[126:127], v[126:127], v[234:235] op_sel_hi:[1,0]
v_cvt_pk_bf16_f32 v212, v120, v121
v_cvt_pk_bf16_f32 v213, v122, v123
v_cvt_pk_bf16_f32 v214, v124, v125
v_cvt_pk_bf16_f32 v215, v126, v127
v_min_u32 v212, -2, v212
s_mov_b64 exec, s[40:41]
buffer_store_dwordx4 v[212:215], v11, s[84:87], s33 offen sc1
s_mov_b64 exec, -1
mega_kernel_rs_b3:
s_barrier
s_nop 15
buffer_load_dwordx4 v[32:35], v7, s[84:87], s29 offen offset:0 sc1
s_nop 9
buffer_load_dwordx4 v[36:39], v7, s[84:87], s29 offen offset:1024 sc1
s_nop 9
buffer_load_dwordx4 v[40:43], v7, s[84:87], s29 offen offset:2048 sc1
s_nop 9
buffer_load_dwordx4 v[44:47], v7, s[84:87], s29 offen offset:3072 sc1
mega_kernel_rs_pc_15_0:
s_waitcnt vmcnt(3)
v_cmp_eq_u32 vcc, -1, v32
s_cbranch_vccnz mega_kernel_rs_pc_15_0f
v_smfmac_f32_16x16x64_bf16 v[96:99], v[32:35], a[192:199], v6
v_smfmac_f32_16x16x64_bf16 v[100:103], v[32:35], a[224:231], v6
mega_kernel_rs_pc_14_1:
s_waitcnt vmcnt(2)
v_cmp_eq_u32 vcc, -1, v36
s_cbranch_vccnz mega_kernel_rs_pc_14_1f
v_smfmac_f32_16x16x64_bf16 v[96:99], v[36:39], a[200:207], v6
v_smfmac_f32_16x16x64_bf16 v[100:103], v[36:39], a[232:239], v6
mega_kernel_rs_pc_12_2:
s_waitcnt vmcnt(1)
v_cmp_eq_u32 vcc, -1, v40
s_cbranch_vccnz mega_kernel_rs_pc_12_2f
v_smfmac_f32_16x16x64_bf16 v[96:99], v[40:43], a[208:215], v6
v_smfmac_f32_16x16x64_bf16 v[100:103], v[40:43], a[240:247], v6
mega_kernel_rs_pc_8_3:
s_waitcnt vmcnt(0)
v_cmp_eq_u32 vcc, -1, v44
s_cbranch_vccnz mega_kernel_rs_pc_8_3f
v_smfmac_f32_16x16x64_bf16 v[96:99], v[44:47], a[216:223], v6
v_smfmac_f32_16x16x64_bf16 v[100:103], v[44:47], a[248:255], v6
mega_kernel_rs_pc_d:
s_nop 7
v_permlane32_swap_b32 v96, v100
v_permlane32_swap_b32 v97, v101
v_permlane32_swap_b32 v98, v102
v_permlane32_swap_b32 v99, v103
v_pk_add_f32 v[96:97], v[96:97], v[100:101]
v_pk_add_f32 v[98:99], v[98:99], v[102:103]
ds_write2_b32 v18, v96, v97 offset0:0 offset1:36
ds_write2_b32 v18, v98, v99 offset0:72 offset1:108
s_waitcnt lgkmcnt(0)
s_barrier
s_cmp_lg_u32 s24, 0
s_cbranch_scc1 mega_kernel_rs_x1
ds_read_b128 v[120:123], v19 offset:0
ds_read_b128 v[124:127], v19 offset:1152
ds_read_b128 v[128:131], v19 offset:2304
ds_read_b128 v[132:135], v19 offset:3456
s_waitcnt lgkmcnt(2)
v_pk_add_f32 v[120:121], v[120:121], v[124:125]
v_pk_add_f32 v[122:123], v[122:123], v[126:127]
s_waitcnt lgkmcnt(0)
v_pk_add_f32 v[128:129], v[128:129], v[132:133]
v_pk_add_f32 v[130:131], v[130:131], v[134:135]
v_pk_add_f32 v[120:121], v[120:121], v[128:129]
v_pk_add_f32 v[122:123], v[122:123], v[130:131]
v_and_or_b32 v120, v120, -2, s47
v_and_or_b32 v121, v121, -2, s47
v_and_or_b32 v122, v122, -2, s47
v_and_or_b32 v123, v123, -2, s47
buffer_store_dwordx4 v[120:123], v12, s[84:87], s35 offen sc1
s_xor_b32 s76, s47, 1
v_mov_b32 v48, s76
v_mov_b32 v49, s76
v_mov_b32 v50, s76
v_mov_b32 v51, s76
v_mov_b32 v52, s76
v_mov_b32 v53, s76
v_mov_b32 v54, s76
v_mov_b32 v55, s76
v_mov_b32 v56, s76
v_mov_b32 v57, s76
v_mov_b32 v58, s76
v_mov_b32 v59, s76
v_mov_b32 v96, 0
v_mov_b32 v97, 0
v_mov_b32 v98, 0
v_mov_b32 v99, 0
v_mov_b32 v100, 0
v_mov_b32 v101, 0
v_mov_b32 v102, 0
v_mov_b32 v103, 0
v_mov_b32 v104, 0
v_mov_b32 v105, 0
v_mov_b32 v106, 0
v_mov_b32 v107, 0
v_mov_b32 v108, 0
v_mov_b32 v109, 0
v_mov_b32 v110, 0
v_mov_b32 v111, 0
v_mov_b32 v112, 0
v_mov_b32 v113, 0
v_mov_b32 v114, 0
v_mov_b32 v115, 0
v_mov_b32 v116, 0
v_mov_b32 v117, 0
v_mov_b32 v118, 0
v_mov_b32 v119, 0
s_nop 15
s_cmp_eq_u32 s47, 1
s_cbranch_scc1 mega_kernel_rs_p4_1
mega_kernel_rs_p4_0:
buffer_load_dwordx4 v[48:51], v25, s[84:87], s35 offen sc1
buffer_load_dwordx4 v[52:55], v26, s[84:87], s35 offen sc1
buffer_load_dwordx4 v[56:59], v27, s[84:87], s35 offen sc1
s_waitcnt vmcnt(12)
mega_kernel_rs_p4c_0:
v_bitop3_b32 v4, v48, v49, v50 bitop3:0xfe
v_bitop3_b32 v5, v54, v55, v56 bitop3:0xfe
v_bitop3_b32 v4, v4, v51, v52 bitop3:0xfe
v_bitop3_b32 v5, v5, v57, v58 bitop3:0xfe
v_bitop3_b32 v4, v4, v53, v59 bitop3:0xfe
v_bitop3_b32 v4, v4, v5, 1 bitop3:0xa8
v_cmp_ne_u32 vcc, 0, v4
s_cbranch_vccnz mega_kernel_rs_p4_0
v_pk_add_f32 v[120:121], v[120:121], v[48:49]
v_pk_add_f32 v[124:125], v[52:53], v[56:57]
v_pk_add_f32 v[122:123], v[122:123], v[50:51]
v_pk_add_f32 v[126:127], v[54:55], v[58:59]
v_pk_add_f32 v[120:121], v[120:121], v[124:125]
v_pk_add_f32 v[122:123], v[122:123], v[126:127]
v_cvt_pk_bf16_f32 v212, v120, v121
v_cvt_pk_bf16_f32 v213, v122, v123
v_min_u32 v212, -2, v212
buffer_store_dwordx2 v[212:213], v9, s[84:87], s34 offen sc1
s_branch mega_kernel_rs_p4d
mega_kernel_rs_p4_1:
buffer_load_dwordx4 v[48:51], v25, s[84:87], s35 offen sc1
buffer_load_dwordx4 v[52:55], v26, s[84:87], s35 offen sc1
buffer_load_dwordx4 v[56:59], v27, s[84:87], s35 offen sc1
s_waitcnt vmcnt(12)
mega_kernel_rs_p4c_1:
v_bitop3_b32 v4, v48, v49, v50 bitop3:0x80
v_bitop3_b32 v5, v54, v55, v56 bitop3:0x80
v_bitop3_b32 v4, v4, v51, v52 bitop3:0x80
v_bitop3_b32 v5, v5, v57, v58 bitop3:0x80
v_bitop3_b32 v4, v4, v53, v59 bitop3:0x80
v_bitop3_b32 v4, v4, v5, 1 bitop3:0x80
v_cmp_ne_u32 vcc, 1, v4
s_cbranch_vccnz mega_kernel_rs_p4_1
v_pk_add_f32 v[120:121], v[120:121], v[48:49]
v_pk_add_f32 v[124:125], v[52:53], v[56:57]
v_pk_add_f32 v[122:123], v[122:123], v[50:51]
v_pk_add_f32 v[126:127], v[54:55], v[58:59]
v_pk_add_f32 v[120:121], v[120:121], v[124:125]
v_pk_add_f32 v[122:123], v[122:123], v[126:127]
v_cvt_pk_bf16_f32 v212, v120, v121
v_cvt_pk_bf16_f32 v213, v122, v123
v_min_u32 v212, -2, v212
buffer_store_dwordx2 v[212:213], v9, s[84:87], s34 offen sc1
mega_kernel_rs_p4d:
mega_kernel_rs_b5:
s_add_u32 s27, s27, 1
s_add_u32 s44, s44, 4096
s_cmp_eq_u32 s44, 30720
s_cselect_b32 s44, 18432, s44
s_mov_b32 s28, s33
s_mov_b32 s33, s34
s_mov_b32 s34, s28
s_xor_b32 s35, s35, 262144
s_bfe_u32 s47, s27, 0x10001
s_barrier
s_nop 15
s_branch mega_kernel_rs_loop
mega_kernel_rs_x1:
s_cmp_eq_u32 s24, 1
s_cbranch_scc0 mega_kernel_rs_x2
s_add_u32 s76, s27, 1
v_mov_b32 v5, s76
s_mov_b64 exec, 1
buffer_store_dword v5, v228, s[84:87], s81 offen sc1
s_mov_b64 exec, -1
mega_kernel_rs_x2:
s_cmp_eq_u32 s24, 3
s_cbranch_scc0 mega_kernel_rs_x4
s_cmp_eq_u32 s36, 1
s_cbranch_scc0 mega_kernel_rs_x5
s_add_u32 s76, s27, 1
s_cmp_gt_i32 s46, s76
s_cbranch_scc1 mega_kernel_rs_pf1ok
mega_kernel_rs_pf1w:
buffer_load_dword v4, v24, s[84:87], 0 offen sc1
s_waitcnt vmcnt(0)
v_readlane_b32 s46, v4, 0
v_readlane_b32 s28, v4, 1
s_nop 1
s_min_i32 s46, s46, s28
s_cmp_gt_i32 s46, s76
s_cbranch_scc0 mega_kernel_rs_pf1w
mega_kernel_rs_pf1ok:
s_add_u32 s77, s76, s82
s_bfe_u32 s28, s77, 0x40002
s_lshl_b32 s28, s28, 14
s_and_b32 s77, s77, 3
s_lshl_b32 s77, s77, 11
s_add_u32 s28, s28, s77
s_add_u32 m0, s45, 0
s_nop 0
buffer_load_dwordx4 v240, s[84:87], s28 offen offset:0 sc1 lds
s_add_u32 m0, s45, 0
s_nop 0
buffer_load_dwordx4 v240, s[84:87], s28 offen offset:1024 sc1 lds
s_add_u32 m0, s45, 2048
s_nop 0
buffer_load_dwordx4 v241, s[84:87], s28 offen offset:0 sc1 lds
s_add_u32 m0, s45, 2048
s_nop 0
buffer_load_dwordx4 v241, s[84:87], s28 offen offset:1024 sc1 lds
s_add_u32 s45, s45, 4096
s_cmp_eq_u32 s45, 30720
s_cselect_b32 s45, 18432, s45
s_waitcnt vmcnt(0)
mega_kernel_rs_x5:
s_add_u32 s76, s27, 3
s_min_u32 s76, s76, 63
s_cmp_gt_i32 s46, s76
s_cbranch_scc1 mega_kernel_rs_pf2ok
mega_kernel_rs_pf2w:
buffer_load_dword v4, v24, s[84:87], 0 offen sc1
s_waitcnt vmcnt(0)
v_readlane_b32 s46, v4, 0
v_readlane_b32 s28, v4, 1
s_nop 1
s_min_i32 s46, s46, s28
s_cmp_gt_i32 s46, s76
s_cbranch_scc0 mega_kernel_rs_x6
mega_kernel_rs_pf2ok:
mega_kernel_rs_x6:
s_add_u32 s76, s27, 2
s_cmp_lt_u32 s76, 63
s_cbranch_scc0 mega_kernel_rs_x4
s_cmp_gt_i32 s46, s76
s_cbranch_scc0 mega_kernel_rs_x4
s_cmp_eq_u32 s88, s76
s_cbranch_scc1 mega_kernel_rs_x7
s_add_u32 s77, s76, s82
s_bfe_u32 s28, s77, 0x40002
s_lshl_b32 s28, s28, 14
s_and_b32 s77, s77, 3
s_lshl_b32 s77, s77, 11
s_add_u32 s28, s28, s77
s_add_u32 s28, s28, s83
s_buffer_load_dword s78, s[84:87], s28 offset:0
s_buffer_load_dword s78, s[84:87], s28 offset:128
s_buffer_load_dword s78, s[84:87], s28 offset:256
s_buffer_load_dword s78, s[84:87], s28 offset:384
s_buffer_load_dword s78, s[84:87], s28 offset:512
s_buffer_load_dword s78, s[84:87], s28 offset:640
s_buffer_load_dword s78, s[84:87], s28 offset:768
s_buffer_load_dword s78, s[84:87], s28 offset:896
s_buffer_load_dword s78, s[84:87], s28 offset:1024
s_buffer_load_dword s78, s[84:87], s28 offset:1152
s_buffer_load_dword s78, s[84:87], s28 offset:1280
s_buffer_load_dword s78, s[84:87], s28 offset:1408
s_buffer_load_dword s78, s[84:87], s28 offset:1536
s_buffer_load_dword s78, s[84:87], s28 offset:1664
s_buffer_load_dword s78, s[84:87], s28 offset:1792
s_buffer_load_dword s78, s[84:87], s28 offset:1920
mega_kernel_rs_x7:
s_add_u32 s77, s76, s82
s_bfe_u32 s28, s77, 0x40002
s_lshl_b32 s28, s28, 14
s_and_b32 s77, s77, 3
s_lshl_b32 s77, s77, 11
s_add_u32 s28, s28, s77
s_add_u32 s28, s28, s83
s_add_u32 s28, s28, 33554432
s_buffer_load_dword s78, s[84:87], s28 offset:0
s_buffer_load_dword s78, s[84:87], s28 offset:128
s_buffer_load_dword s78, s[84:87], s28 offset:256
s_buffer_load_dword s78, s[84:87], s28 offset:384
s_buffer_load_dword s78, s[84:87], s28 offset:512
s_buffer_load_dword s78, s[84:87], s28 offset:640
s_buffer_load_dword s78, s[84:87], s28 offset:768
s_buffer_load_dword s78, s[84:87], s28 offset:896
s_buffer_load_dword s78, s[84:87], s28 offset:1024
s_buffer_load_dword s78, s[84:87], s28 offset:1152
s_buffer_load_dword s78, s[84:87], s28 offset:1280
s_buffer_load_dword s78, s[84:87], s28 offset:1408
s_buffer_load_dword s78, s[84:87], s28 offset:1536
s_buffer_load_dword s78, s[84:87], s28 offset:1664
s_buffer_load_dword s78, s[84:87], s28 offset:1792
s_buffer_load_dword s78, s[84:87], s28 offset:1920
s_mov_b32 s89, s76
mega_kernel_rs_x4:
v_mov_b32 v96, 0
v_mov_b32 v97, 0
v_mov_b32 v98, 0
v_mov_b32 v99, 0
v_mov_b32 v100, 0
v_mov_b32 v101, 0
v_mov_b32 v102, 0
v_mov_b32 v103, 0
v_mov_b32 v104, 0
v_mov_b32 v105, 0
v_mov_b32 v106, 0
v_mov_b32 v107, 0
v_mov_b32 v108, 0
v_mov_b32 v109, 0
v_mov_b32 v110, 0
v_mov_b32 v111, 0
v_mov_b32 v112, 0
v_mov_b32 v113, 0
v_mov_b32 v114, 0
v_mov_b32 v115, 0
v_mov_b32 v116, 0
v_mov_b32 v117, 0
v_mov_b32 v118, 0
v_mov_b32 v119, 0
s_branch mega_kernel_rs_b5
mega_kernel_rs_p2r:
s_mov_b64 exec, s[42:43]
buffer_load_dwordx4 v[188:191], v10, s[84:87], s76 offen sc1
buffer_load_dwordx4 v[196:199], v10, s[84:87], s77 offen sc1
buffer_load_dwordx4 v[204:207], v10, s[84:87], s78 offen sc1
s_mov_b64 exec, -1
buffer_load_dwordx4 v[184:187], v17, s[84:87], s76 offen sc1
buffer_load_dwordx4 v[192:195], v17, s[84:87], s77 offen sc1
buffer_load_dwordx4 v[200:203], v17, s[84:87], s78 offen sc1
s_branch mega_kernel_rs_p2
mega_kernel_rs_pa_1_0f:
s_mov_b64 exec, vcc
buffer_load_dwordx4 v[32:35], v7, s[84:87], s33 offen offset:0 sc1
s_mov_b64 exec, -1
s_branch mega_kernel_rs_pa_1_0
mega_kernel_rs_pa_1_0:
s_waitcnt vmcnt(0)
v_max_u32 v4, v32, v34
v_cmp_eq_u32 vcc, -1, v4
s_cbranch_vccnz mega_kernel_rs_pa_1_0f
v_smfmac_f32_16x16x64_bf16 v[96:99], v[32:35], a[0:7], v6
v_smfmac_f32_16x16x64_bf16 v[100:103], v[32:35], a[32:39], v6
v_smfmac_f32_16x16x64_bf16 v[104:107], v[32:35], a[64:71], v6
v_smfmac_f32_16x16x64_bf16 v[108:111], v[32:35], a[96:103], v6
s_branch mega_kernel_rs_pa_d
mega_kernel_rs_pa_2_1f:
s_mov_b64 exec, vcc
buffer_load_dwordx4 v[36:39], v7, s[84:87], s33 offen offset:1024 sc1
s_mov_b64 exec, -1
s_branch mega_kernel_rs_pa_2_1
mega_kernel_rs_pa_2_1:
s_waitcnt vmcnt(0)
v_max_u32 v4, v36, v38
v_cmp_eq_u32 vcc, -1, v4
s_cbranch_vccnz mega_kernel_rs_pa_2_1f
v_smfmac_f32_16x16x64_bf16 v[96:99], v[36:39], a[8:15], v6
v_smfmac_f32_16x16x64_bf16 v[100:103], v[36:39], a[40:47], v6
v_smfmac_f32_16x16x64_bf16 v[104:107], v[36:39], a[72:79], v6
v_smfmac_f32_16x16x64_bf16 v[108:111], v[36:39], a[104:111], v6
s_branch mega_kernel_rs_pa_d
mega_kernel_rs_pa_3_0f:
s_mov_b64 exec, vcc
buffer_load_dwordx4 v[32:35], v7, s[84:87], s33 offen offset:0 sc1
s_mov_b64 exec, -1
s_branch mega_kernel_rs_pa_3_1
mega_kernel_rs_pa_3_0:
s_waitcnt vmcnt(1)
v_max_u32 v4, v32, v34
v_cmp_eq_u32 vcc, -1, v4
s_cbranch_vccnz mega_kernel_rs_pa_3_0f
v_smfmac_f32_16x16x64_bf16 v[96:99], v[32:35], a[0:7], v6
v_smfmac_f32_16x16x64_bf16 v[100:103], v[32:35], a[32:39], v6
v_smfmac_f32_16x16x64_bf16 v[104:107], v[32:35], a[64:71], v6
v_smfmac_f32_16x16x64_bf16 v[108:111], v[32:35], a[96:103], v6
s_branch mega_kernel_rs_pa_2_1
mega_kernel_rs_pa_3_1f:
s_mov_b64 exec, vcc
buffer_load_dwordx4 v[36:39], v7, s[84:87], s33 offen offset:1024 sc1
s_mov_b64 exec, -1
s_branch mega_kernel_rs_pa_3_0
mega_kernel_rs_pa_3_1:
s_waitcnt vmcnt(1)
v_max_u32 v4, v36, v38
v_cmp_eq_u32 vcc, -1, v4
s_cbranch_vccnz mega_kernel_rs_pa_3_1f
v_smfmac_f32_16x16x64_bf16 v[96:99], v[36:39], a[8:15], v6
v_smfmac_f32_16x16x64_bf16 v[100:103], v[36:39], a[40:47], v6
v_smfmac_f32_16x16x64_bf16 v[104:107], v[36:39], a[72:79], v6
v_smfmac_f32_16x16x64_bf16 v[108:111], v[36:39], a[104:111], v6
s_branch mega_kernel_rs_pa_1_0
mega_kernel_rs_pa_4_2f:
s_mov_b64 exec, vcc
buffer_load_dwordx4 v[40:43], v7, s[84:87], s33 offen offset:2048 sc1
s_mov_b64 exec, -1
s_branch mega_kernel_rs_pa_4_2
mega_kernel_rs_pa_4_2:
s_waitcnt vmcnt(0)
v_max_u32 v4, v40, v42
v_cmp_eq_u32 vcc, -1, v4
s_cbranch_vccnz mega_kernel_rs_pa_4_2f
v_smfmac_f32_16x16x64_bf16 v[96:99], v[40:43], a[16:23], v6
v_smfmac_f32_16x16x64_bf16 v[100:103], v[40:43], a[48:55], v6
v_smfmac_f32_16x16x64_bf16 v[104:107], v[40:43], a[80:87], v6
v_smfmac_f32_16x16x64_bf16 v[108:111], v[40:43], a[112:119], v6
s_branch mega_kernel_rs_pa_d
mega_kernel_rs_pa_5_0f:
s_mov_b64 exec, vcc
buffer_load_dwordx4 v[32:35], v7, s[84:87], s33 offen offset:0 sc1
s_mov_b64 exec, -1
s_branch mega_kernel_rs_pa_5_2
mega_kernel_rs_pa_5_0:
s_waitcnt vmcnt(1)
v_max_u32 v4, v32, v34
v_cmp_eq_u32 vcc, -1, v4
s_cbranch_vccnz mega_kernel_rs_pa_5_0f
v_smfmac_f32_16x16x64_bf16 v[96:99], v[32:35], a[0:7], v6
v_smfmac_f32_16x16x64_bf16 v[100:103], v[32:35], a[32:39], v6
v_smfmac_f32_16x16x64_bf16 v[104:107], v[32:35], a[64:71], v6
v_smfmac_f32_16x16x64_bf16 v[108:111], v[32:35], a[96:103], v6
s_branch mega_kernel_rs_pa_4_2
mega_kernel_rs_pa_5_2f:
s_mov_b64 exec, vcc
buffer_load_dwordx4 v[40:43], v7, s[84:87], s33 offen offset:2048 sc1
s_mov_b64 exec, -1
s_branch mega_kernel_rs_pa_5_0
mega_kernel_rs_pa_5_2:
s_waitcnt vmcnt(1)
v_max_u32 v4, v40, v42
v_cmp_eq_u32 vcc, -1, v4
s_cbranch_vccnz mega_kernel_rs_pa_5_2f
v_smfmac_f32_16x16x64_bf16 v[96:99], v[40:43], a[16:23], v6
v_smfmac_f32_16x16x64_bf16 v[100:103], v[40:43], a[48:55], v6
v_smfmac_f32_16x16x64_bf16 v[104:107], v[40:43], a[80:87], v6
v_smfmac_f32_16x16x64_bf16 v[108:111], v[40:43], a[112:119], v6
s_branch mega_kernel_rs_pa_1_0
mega_kernel_rs_pa_6_1f:
s_mov_b64 exec, vcc
buffer_load_dwordx4 v[36:39], v7, s[84:87], s33 offen offset:1024 sc1
s_mov_b64 exec, -1
s_branch mega_kernel_rs_pa_6_2
mega_kernel_rs_pa_6_1:
s_waitcnt vmcnt(1)
v_max_u32 v4, v36, v38
v_cmp_eq_u32 vcc, -1, v4
s_cbranch_vccnz mega_kernel_rs_pa_6_1f
v_smfmac_f32_16x16x64_bf16 v[96:99], v[36:39], a[8:15], v6
v_smfmac_f32_16x16x64_bf16 v[100:103], v[36:39], a[40:47], v6
v_smfmac_f32_16x16x64_bf16 v[104:107], v[36:39], a[72:79], v6
v_smfmac_f32_16x16x64_bf16 v[108:111], v[36:39], a[104:111], v6
s_branch mega_kernel_rs_pa_4_2
mega_kernel_rs_pa_6_2f:
s_mov_b64 exec, vcc
buffer_load_dwordx4 v[40:43], v7, s[84:87], s33 offen offset:2048 sc1
s_mov_b64 exec, -1
s_branch mega_kernel_rs_pa_6_1
mega_kernel_rs_pa_6_2:
s_waitcnt vmcnt(1)
v_max_u32 v4, v40, v42
v_cmp_eq_u32 vcc, -1, v4
s_cbranch_vccnz mega_kernel_rs_pa_6_2f
v_smfmac_f32_16x16x64_bf16 v[96:99], v[40:43], a[16:23], v6
v_smfmac_f32_16x16x64_bf16 v[100:103], v[40:43], a[48:55], v6
v_smfmac_f32_16x16x64_bf16 v[104:107], v[40:43], a[80:87], v6
v_smfmac_f32_16x16x64_bf16 v[108:111], v[40:43], a[112:119], v6
s_branch mega_kernel_rs_pa_2_1
mega_kernel_rs_pa_7_0f:
s_mov_b64 exec, vcc
buffer_load_dwordx4 v[32:35], v7, s[84:87], s33 offen offset:0 sc1
s_mov_b64 exec, -1
s_branch mega_kernel_rs_pa_7_1
mega_kernel_rs_pa_7_0:
s_waitcnt vmcnt(2)
v_max_u32 v4, v32, v34
v_cmp_eq_u32 vcc, -1, v4
s_cbranch_vccnz mega_kernel_rs_pa_7_0f
v_smfmac_f32_16x16x64_bf16 v[96:99], v[32:35], a[0:7], v6
v_smfmac_f32_16x16x64_bf16 v[100:103], v[32:35], a[32:39], v6
v_smfmac_f32_16x16x64_bf16 v[104:107], v[32:35], a[64:71], v6
v_smfmac_f32_16x16x64_bf16 v[108:111], v[32:35], a[96:103], v6
s_branch mega_kernel_rs_pa_6_1
mega_kernel_rs_pa_7_1f:
s_mov_b64 exec, vcc
buffer_load_dwordx4 v[36:39], v7, s[84:87], s33 offen offset:1024 sc1
s_mov_b64 exec, -1
s_branch mega_kernel_rs_pa_7_2
mega_kernel_rs_pa_7_1:
s_waitcnt vmcnt(2)
v_max_u32 v4, v36, v38
v_cmp_eq_u32 vcc, -1, v4
s_cbranch_vccnz mega_kernel_rs_pa_7_1f
v_smfmac_f32_16x16x64_bf16 v[96:99], v[36:39], a[8:15], v6
v_smfmac_f32_16x16x64_bf16 v[100:103], v[36:39], a[40:47], v6
v_smfmac_f32_16x16x64_bf16 v[104:107], v[36:39], a[72:79], v6
v_smfmac_f32_16x16x64_bf16 v[108:111], v[36:39], a[104:111], v6
s_branch mega_kernel_rs_pa_5_2
mega_kernel_rs_pa_7_2f:
s_mov_b64 exec, vcc
buffer_load_dwordx4 v[40:43], v7, s[84:87], s33 offen offset:2048 sc1
s_mov_b64 exec, -1
s_branch mega_kernel_rs_pa_7_0
mega_kernel_rs_pa_7_2:
s_waitcnt vmcnt(2)
v_max_u32 v4, v40, v42
v_cmp_eq_u32 vcc, -1, v4
s_cbranch_vccnz mega_kernel_rs_pa_7_2f
v_smfmac_f32_16x16x64_bf16 v[96:99], v[40:43], a[16:23], v6
v_smfmac_f32_16x16x64_bf16 v[100:103], v[40:43], a[48:55], v6
v_smfmac_f32_16x16x64_bf16 v[104:107], v[40:43], a[80:87], v6
v_smfmac_f32_16x16x64_bf16 v[108:111], v[40:43], a[112:119], v6
s_branch mega_kernel_rs_pa_3_0
mega_kernel_rs_pa_8_3f:
s_mov_b64 exec, vcc
buffer_load_dwordx4 v[44:47], v7, s[84:87], s33 offen offset:3072 sc1
s_mov_b64 exec, -1
s_branch mega_kernel_rs_pa_8_3
mega_kernel_rs_pa_8_3:
s_waitcnt vmcnt(0)
v_max_u32 v4, v44, v46
v_cmp_eq_u32 vcc, -1, v4
s_cbranch_vccnz mega_kernel_rs_pa_8_3f
v_smfmac_f32_16x16x64_bf16 v[96:99], v[44:47], a[24:31], v6
v_smfmac_f32_16x16x64_bf16 v[100:103], v[44:47], a[56:63], v6
v_smfmac_f32_16x16x64_bf16 v[104:107], v[44:47], a[88:95], v6
v_smfmac_f32_16x16x64_bf16 v[108:111], v[44:47], a[120:127], v6
s_branch mega_kernel_rs_pa_d
mega_kernel_rs_pa_9_0f:
s_mov_b64 exec, vcc
buffer_load_dwordx4 v[32:35], v7, s[84:87], s33 offen offset:0 sc1
s_mov_b64 exec, -1
s_branch mega_kernel_rs_pa_9_3
mega_kernel_rs_pa_9_0:
s_waitcnt vmcnt(1)
v_max_u32 v4, v32, v34
v_cmp_eq_u32 vcc, -1, v4
s_cbranch_vccnz mega_kernel_rs_pa_9_0f
v_smfmac_f32_16x16x64_bf16 v[96:99], v[32:35], a[0:7], v6
v_smfmac_f32_16x16x64_bf16 v[100:103], v[32:35], a[32:39], v6
v_smfmac_f32_16x16x64_bf16 v[104:107], v[32:35], a[64:71], v6
v_smfmac_f32_16x16x64_bf16 v[108:111], v[32:35], a[96:103], v6
s_branch mega_kernel_rs_pa_8_3
mega_kernel_rs_pa_9_3f:
s_mov_b64 exec, vcc
buffer_load_dwordx4 v[44:47], v7, s[84:87], s33 offen offset:3072 sc1
s_mov_b64 exec, -1
s_branch mega_kernel_rs_pa_9_0
mega_kernel_rs_pa_9_3:
s_waitcnt vmcnt(1)
v_max_u32 v4, v44, v46
v_cmp_eq_u32 vcc, -1, v4
s_cbranch_vccnz mega_kernel_rs_pa_9_3f
v_smfmac_f32_16x16x64_bf16 v[96:99], v[44:47], a[24:31], v6
v_smfmac_f32_16x16x64_bf16 v[100:103], v[44:47], a[56:63], v6
v_smfmac_f32_16x16x64_bf16 v[104:107], v[44:47], a[88:95], v6
v_smfmac_f32_16x16x64_bf16 v[108:111], v[44:47], a[120:127], v6
s_branch mega_kernel_rs_pa_1_0
mega_kernel_rs_pa_10_1f:
s_mov_b64 exec, vcc
buffer_load_dwordx4 v[36:39], v7, s[84:87], s33 offen offset:1024 sc1
s_mov_b64 exec, -1
s_branch mega_kernel_rs_pa_10_3
mega_kernel_rs_pa_10_1:
s_waitcnt vmcnt(1)
v_max_u32 v4, v36, v38
v_cmp_eq_u32 vcc, -1, v4
s_cbranch_vccnz mega_kernel_rs_pa_10_1f
v_smfmac_f32_16x16x64_bf16 v[96:99], v[36:39], a[8:15], v6
v_smfmac_f32_16x16x64_bf16 v[100:103], v[36:39], a[40:47], v6
v_smfmac_f32_16x16x64_bf16 v[104:107], v[36:39], a[72:79], v6
v_smfmac_f32_16x16x64_bf16 v[108:111], v[36:39], a[104:111], v6
s_branch mega_kernel_rs_pa_8_3
mega_kernel_rs_pa_10_3f:
s_mov_b64 exec, vcc
buffer_load_dwordx4 v[44:47], v7, s[84:87], s33 offen offset:3072 sc1
s_mov_b64 exec, -1
s_branch mega_kernel_rs_pa_10_1
mega_kernel_rs_pa_10_3:
s_waitcnt vmcnt(1)
v_max_u32 v4, v44, v46
v_cmp_eq_u32 vcc, -1, v4
s_cbranch_vccnz mega_kernel_rs_pa_10_3f
v_smfmac_f32_16x16x64_bf16 v[96:99], v[44:47], a[24:31], v6
v_smfmac_f32_16x16x64_bf16 v[100:103], v[44:47], a[56:63], v6
v_smfmac_f32_16x16x64_bf16 v[104:107], v[44:47], a[88:95], v6
v_smfmac_f32_16x16x64_bf16 v[108:111], v[44:47], a[120:127], v6
s_branch mega_kernel_rs_pa_2_1
mega_kernel_rs_pa_11_0f:
s_mov_b64 exec, vcc
buffer_load_dwordx4 v[32:35], v7, s[84:87], s33 offen offset:0 sc1
s_mov_b64 exec, -1
s_branch mega_kernel_rs_pa_11_1
mega_kernel_rs_pa_11_0:
s_waitcnt vmcnt(2)
v_max_u32 v4, v32, v34
v_cmp_eq_u32 vcc, -1, v4
s_cbranch_vccnz mega_kernel_rs_pa_11_0f
v_smfmac_f32_16x16x64_bf16 v[96:99], v[32:35], a[0:7], v6
v_smfmac_f32_16x16x64_bf16 v[100:103], v[32:35], a[32:39], v6
v_smfmac_f32_16x16x64_bf16 v[104:107], v[32:35], a[64:71], v6
v_smfmac_f32_16x16x64_bf16 v[108:111], v[32:35], a[96:103], v6
s_branch mega_kernel_rs_pa_10_1
mega_kernel_rs_pa_11_1f:
s_mov_b64 exec, vcc
buffer_load_dwordx4 v[36:39], v7, s[84:87], s33 offen offset:1024 sc1
s_mov_b64 exec, -1
s_branch mega_kernel_rs_pa_11_3
mega_kernel_rs_pa_11_1:
s_waitcnt vmcnt(2)
v_max_u32 v4, v36, v38
v_cmp_eq_u32 vcc, -1, v4
s_cbranch_vccnz mega_kernel_rs_pa_11_1f
v_smfmac_f32_16x16x64_bf16 v[96:99], v[36:39], a[8:15], v6
v_smfmac_f32_16x16x64_bf16 v[100:103], v[36:39], a[40:47], v6
v_smfmac_f32_16x16x64_bf16 v[104:107], v[36:39], a[72:79], v6
v_smfmac_f32_16x16x64_bf16 v[108:111], v[36:39], a[104:111], v6
s_branch mega_kernel_rs_pa_9_3
mega_kernel_rs_pa_11_3f:
s_mov_b64 exec, vcc
buffer_load_dwordx4 v[44:47], v7, s[84:87], s33 offen offset:3072 sc1
s_mov_b64 exec, -1
s_branch mega_kernel_rs_pa_11_0
mega_kernel_rs_pa_11_3:
s_waitcnt vmcnt(2)
v_max_u32 v4, v44, v46
v_cmp_eq_u32 vcc, -1, v4
s_cbranch_vccnz mega_kernel_rs_pa_11_3f
v_smfmac_f32_16x16x64_bf16 v[96:99], v[44:47], a[24:31], v6
v_smfmac_f32_16x16x64_bf16 v[100:103], v[44:47], a[56:63], v6
v_smfmac_f32_16x16x64_bf16 v[104:107], v[44:47], a[88:95], v6
v_smfmac_f32_16x16x64_bf16 v[108:111], v[44:47], a[120:127], v6
s_branch mega_kernel_rs_pa_3_0
mega_kernel_rs_pa_12_2f:
s_mov_b64 exec, vcc
buffer_load_dwordx4 v[40:43], v7, s[84:87], s33 offen offset:2048 sc1
s_mov_b64 exec, -1
s_branch mega_kernel_rs_pa_12_3
mega_kernel_rs_pa_12_2:
s_waitcnt vmcnt(1)
v_max_u32 v4, v40, v42
v_cmp_eq_u32 vcc, -1, v4
s_cbranch_vccnz mega_kernel_rs_pa_12_2f
v_smfmac_f32_16x16x64_bf16 v[96:99], v[40:43], a[16:23], v6
v_smfmac_f32_16x16x64_bf16 v[100:103], v[40:43], a[48:55], v6
v_smfmac_f32_16x16x64_bf16 v[104:107], v[40:43], a[80:87], v6
v_smfmac_f32_16x16x64_bf16 v[108:111], v[40:43], a[112:119], v6
s_branch mega_kernel_rs_pa_8_3
mega_kernel_rs_pa_12_3f:
s_mov_b64 exec, vcc
buffer_load_dwordx4 v[44:47], v7, s[84:87], s33 offen offset:3072 sc1
s_mov_b64 exec, -1
s_branch mega_kernel_rs_pa_12_2
mega_kernel_rs_pa_12_3:
s_waitcnt vmcnt(1)
v_max_u32 v4, v44, v46
v_cmp_eq_u32 vcc, -1, v4
s_cbranch_vccnz mega_kernel_rs_pa_12_3f
v_smfmac_f32_16x16x64_bf16 v[96:99], v[44:47], a[24:31], v6
v_smfmac_f32_16x16x64_bf16 v[100:103], v[44:47], a[56:63], v6
v_smfmac_f32_16x16x64_bf16 v[104:107], v[44:47], a[88:95], v6
v_smfmac_f32_16x16x64_bf16 v[108:111], v[44:47], a[120:127], v6
s_branch mega_kernel_rs_pa_4_2
mega_kernel_rs_pa_13_0f:
s_mov_b64 exec, vcc
buffer_load_dwordx4 v[32:35], v7, s[84:87], s33 offen offset:0 sc1
s_mov_b64 exec, -1
s_branch mega_kernel_rs_pa_13_2
mega_kernel_rs_pa_13_0:
s_waitcnt vmcnt(2)
v_max_u32 v4, v32, v34
v_cmp_eq_u32 vcc, -1, v4
s_cbranch_vccnz mega_kernel_rs_pa_13_0f
v_smfmac_f32_16x16x64_bf16 v[96:99], v[32:35], a[0:7], v6
v_smfmac_f32_16x16x64_bf16 v[100:103], v[32:35], a[32:39], v6
v_smfmac_f32_16x16x64_bf16 v[104:107], v[32:35], a[64:71], v6
v_smfmac_f32_16x16x64_bf16 v[108:111], v[32:35], a[96:103], v6
s_branch mega_kernel_rs_pa_12_2
mega_kernel_rs_pa_13_2f:
s_mov_b64 exec, vcc
buffer_load_dwordx4 v[40:43], v7, s[84:87], s33 offen offset:2048 sc1
s_mov_b64 exec, -1
s_branch mega_kernel_rs_pa_13_3
mega_kernel_rs_pa_13_2:
s_waitcnt vmcnt(2)
v_max_u32 v4, v40, v42
v_cmp_eq_u32 vcc, -1, v4
s_cbranch_vccnz mega_kernel_rs_pa_13_2f
v_smfmac_f32_16x16x64_bf16 v[96:99], v[40:43], a[16:23], v6
v_smfmac_f32_16x16x64_bf16 v[100:103], v[40:43], a[48:55], v6
v_smfmac_f32_16x16x64_bf16 v[104:107], v[40:43], a[80:87], v6
v_smfmac_f32_16x16x64_bf16 v[108:111], v[40:43], a[112:119], v6
s_branch mega_kernel_rs_pa_9_3
mega_kernel_rs_pa_13_3f:
s_mov_b64 exec, vcc
buffer_load_dwordx4 v[44:47], v7, s[84:87], s33 offen offset:3072 sc1
s_mov_b64 exec, -1
s_branch mega_kernel_rs_pa_13_0
mega_kernel_rs_pa_13_3:
s_waitcnt vmcnt(2)
v_max_u32 v4, v44, v46
v_cmp_eq_u32 vcc, -1, v4
s_cbranch_vccnz mega_kernel_rs_pa_13_3f
v_smfmac_f32_16x16x64_bf16 v[96:99], v[44:47], a[24:31], v6
v_smfmac_f32_16x16x64_bf16 v[100:103], v[44:47], a[56:63], v6
v_smfmac_f32_16x16x64_bf16 v[104:107], v[44:47], a[88:95], v6
v_smfmac_f32_16x16x64_bf16 v[108:111], v[44:47], a[120:127], v6
s_branch mega_kernel_rs_pa_5_0
mega_kernel_rs_pa_14_1f:
s_mov_b64 exec, vcc
buffer_load_dwordx4 v[36:39], v7, s[84:87], s33 offen offset:1024 sc1
s_mov_b64 exec, -1
s_branch mega_kernel_rs_pa_14_2
mega_kernel_rs_pa_14_1:
s_waitcnt vmcnt(2)
v_max_u32 v4, v36, v38
v_cmp_eq_u32 vcc, -1, v4
s_cbranch_vccnz mega_kernel_rs_pa_14_1f
v_smfmac_f32_16x16x64_bf16 v[96:99], v[36:39], a[8:15], v6
v_smfmac_f32_16x16x64_bf16 v[100:103], v[36:39], a[40:47], v6
v_smfmac_f32_16x16x64_bf16 v[104:107], v[36:39], a[72:79], v6
v_smfmac_f32_16x16x64_bf16 v[108:111], v[36:39], a[104:111], v6
s_branch mega_kernel_rs_pa_12_2
mega_kernel_rs_pa_14_2f:
s_mov_b64 exec, vcc
buffer_load_dwordx4 v[40:43], v7, s[84:87], s33 offen offset:2048 sc1
s_mov_b64 exec, -1
s_branch mega_kernel_rs_pa_14_3
mega_kernel_rs_pa_14_2:
s_waitcnt vmcnt(2)
v_max_u32 v4, v40, v42
v_cmp_eq_u32 vcc, -1, v4
s_cbranch_vccnz mega_kernel_rs_pa_14_2f
v_smfmac_f32_16x16x64_bf16 v[96:99], v[40:43], a[16:23], v6
v_smfmac_f32_16x16x64_bf16 v[100:103], v[40:43], a[48:55], v6
v_smfmac_f32_16x16x64_bf16 v[104:107], v[40:43], a[80:87], v6
v_smfmac_f32_16x16x64_bf16 v[108:111], v[40:43], a[112:119], v6
s_branch mega_kernel_rs_pa_10_3
mega_kernel_rs_pa_14_3f:
s_mov_b64 exec, vcc
buffer_load_dwordx4 v[44:47], v7, s[84:87], s33 offen offset:3072 sc1
s_mov_b64 exec, -1
s_branch mega_kernel_rs_pa_14_1
mega_kernel_rs_pa_14_3:
s_waitcnt vmcnt(2)
v_max_u32 v4, v44, v46
v_cmp_eq_u32 vcc, -1, v4
s_cbranch_vccnz mega_kernel_rs_pa_14_3f
v_smfmac_f32_16x16x64_bf16 v[96:99], v[44:47], a[24:31], v6
v_smfmac_f32_16x16x64_bf16 v[100:103], v[44:47], a[56:63], v6
v_smfmac_f32_16x16x64_bf16 v[104:107], v[44:47], a[88:95], v6
v_smfmac_f32_16x16x64_bf16 v[108:111], v[44:47], a[120:127], v6
s_branch mega_kernel_rs_pa_6_1
mega_kernel_rs_pa_15_0f:
s_mov_b64 exec, vcc
buffer_load_dwordx4 v[32:35], v7, s[84:87], s33 offen offset:0 sc1
s_mov_b64 exec, -1
s_branch mega_kernel_rs_pa_15_1
mega_kernel_rs_pa_15_0:
s_waitcnt vmcnt(3)
v_max_u32 v4, v32, v34
v_cmp_eq_u32 vcc, -1, v4
s_cbranch_vccnz mega_kernel_rs_pa_15_0f
v_smfmac_f32_16x16x64_bf16 v[96:99], v[32:35], a[0:7], v6
v_smfmac_f32_16x16x64_bf16 v[100:103], v[32:35], a[32:39], v6
v_smfmac_f32_16x16x64_bf16 v[104:107], v[32:35], a[64:71], v6
v_smfmac_f32_16x16x64_bf16 v[108:111], v[32:35], a[96:103], v6
s_branch mega_kernel_rs_pa_14_1
mega_kernel_rs_pa_15_1f:
s_mov_b64 exec, vcc
buffer_load_dwordx4 v[36:39], v7, s[84:87], s33 offen offset:1024 sc1
s_mov_b64 exec, -1
s_branch mega_kernel_rs_pa_15_2
mega_kernel_rs_pa_15_1:
s_waitcnt vmcnt(3)
v_max_u32 v4, v36, v38
v_cmp_eq_u32 vcc, -1, v4
s_cbranch_vccnz mega_kernel_rs_pa_15_1f
v_smfmac_f32_16x16x64_bf16 v[96:99], v[36:39], a[8:15], v6
v_smfmac_f32_16x16x64_bf16 v[100:103], v[36:39], a[40:47], v6
v_smfmac_f32_16x16x64_bf16 v[104:107], v[36:39], a[72:79], v6
v_smfmac_f32_16x16x64_bf16 v[108:111], v[36:39], a[104:111], v6
s_branch mega_kernel_rs_pa_13_2
mega_kernel_rs_pa_15_2f:
s_mov_b64 exec, vcc
buffer_load_dwordx4 v[40:43], v7, s[84:87], s33 offen offset:2048 sc1
s_mov_b64 exec, -1
s_branch mega_kernel_rs_pa_15_3
mega_kernel_rs_pa_15_2:
s_waitcnt vmcnt(3)
v_max_u32 v4, v40, v42
v_cmp_eq_u32 vcc, -1, v4
s_cbranch_vccnz mega_kernel_rs_pa_15_2f
v_smfmac_f32_16x16x64_bf16 v[96:99], v[40:43], a[16:23], v6
v_smfmac_f32_16x16x64_bf16 v[100:103], v[40:43], a[48:55], v6
v_smfmac_f32_16x16x64_bf16 v[104:107], v[40:43], a[80:87], v6
v_smfmac_f32_16x16x64_bf16 v[108:111], v[40:43], a[112:119], v6
s_branch mega_kernel_rs_pa_11_3
mega_kernel_rs_pa_15_3f:
s_mov_b64 exec, vcc
buffer_load_dwordx4 v[44:47], v7, s[84:87], s33 offen offset:3072 sc1
s_mov_b64 exec, -1
s_branch mega_kernel_rs_pa_15_0
mega_kernel_rs_pa_15_3:
s_waitcnt vmcnt(3)
v_max_u32 v4, v44, v46
v_cmp_eq_u32 vcc, -1, v4
s_cbranch_vccnz mega_kernel_rs_pa_15_3f
v_smfmac_f32_16x16x64_bf16 v[96:99], v[44:47], a[24:31], v6
v_smfmac_f32_16x16x64_bf16 v[100:103], v[44:47], a[56:63], v6
v_smfmac_f32_16x16x64_bf16 v[104:107], v[44:47], a[88:95], v6
v_smfmac_f32_16x16x64_bf16 v[108:111], v[44:47], a[120:127], v6
s_branch mega_kernel_rs_pa_7_0
mega_kernel_rs_pc_1_0f:
s_mov_b64 exec, vcc
buffer_load_dwordx4 v[32:35], v7, s[84:87], s29 offen offset:0 sc1
s_mov_b64 exec, -1
s_branch mega_kernel_rs_pc_1_0
mega_kernel_rs_pc_1_0:
s_waitcnt vmcnt(0)
v_cmp_eq_u32 vcc, -1, v32
s_cbranch_vccnz mega_kernel_rs_pc_1_0f
v_smfmac_f32_16x16x64_bf16 v[96:99], v[32:35], a[192:199], v6
v_smfmac_f32_16x16x64_bf16 v[100:103], v[32:35], a[224:231], v6
s_branch mega_kernel_rs_pc_d
mega_kernel_rs_pc_2_1f:
s_mov_b64 exec, vcc
buffer_load_dwordx4 v[36:39], v7, s[84:87], s29 offen offset:1024 sc1
s_mov_b64 exec, -1
s_branch mega_kernel_rs_pc_2_1
mega_kernel_rs_pc_2_1:
s_waitcnt vmcnt(0)
v_cmp_eq_u32 vcc, -1, v36
s_cbranch_vccnz mega_kernel_rs_pc_2_1f
v_smfmac_f32_16x16x64_bf16 v[96:99], v[36:39], a[200:207], v6
v_smfmac_f32_16x16x64_bf16 v[100:103], v[36:39], a[232:239], v6
s_branch mega_kernel_rs_pc_d
mega_kernel_rs_pc_3_0f:
s_mov_b64 exec, vcc
buffer_load_dwordx4 v[32:35], v7, s[84:87], s29 offen offset:0 sc1
s_mov_b64 exec, -1
s_branch mega_kernel_rs_pc_3_1
mega_kernel_rs_pc_3_0:
s_waitcnt vmcnt(1)
v_cmp_eq_u32 vcc, -1, v32
s_cbranch_vccnz mega_kernel_rs_pc_3_0f
v_smfmac_f32_16x16x64_bf16 v[96:99], v[32:35], a[192:199], v6
v_smfmac_f32_16x16x64_bf16 v[100:103], v[32:35], a[224:231], v6
s_branch mega_kernel_rs_pc_2_1
mega_kernel_rs_pc_3_1f:
s_mov_b64 exec, vcc
buffer_load_dwordx4 v[36:39], v7, s[84:87], s29 offen offset:1024 sc1
s_mov_b64 exec, -1
s_branch mega_kernel_rs_pc_3_0
mega_kernel_rs_pc_3_1:
s_waitcnt vmcnt(1)
v_cmp_eq_u32 vcc, -1, v36
s_cbranch_vccnz mega_kernel_rs_pc_3_1f
v_smfmac_f32_16x16x64_bf16 v[96:99], v[36:39], a[200:207], v6
v_smfmac_f32_16x16x64_bf16 v[100:103], v[36:39], a[232:239], v6
s_branch mega_kernel_rs_pc_1_0
mega_kernel_rs_pc_4_2f:
s_mov_b64 exec, vcc
buffer_load_dwordx4 v[40:43], v7, s[84:87], s29 offen offset:2048 sc1
s_mov_b64 exec, -1
s_branch mega_kernel_rs_pc_4_2
mega_kernel_rs_pc_4_2:
s_waitcnt vmcnt(0)
v_cmp_eq_u32 vcc, -1, v40
s_cbranch_vccnz mega_kernel_rs_pc_4_2f
v_smfmac_f32_16x16x64_bf16 v[96:99], v[40:43], a[208:215], v6
v_smfmac_f32_16x16x64_bf16 v[100:103], v[40:43], a[240:247], v6
s_branch mega_kernel_rs_pc_d
mega_kernel_rs_pc_5_0f:
s_mov_b64 exec, vcc
buffer_load_dwordx4 v[32:35], v7, s[84:87], s29 offen offset:0 sc1
s_mov_b64 exec, -1
s_branch mega_kernel_rs_pc_5_2
mega_kernel_rs_pc_5_0:
s_waitcnt vmcnt(1)
v_cmp_eq_u32 vcc, -1, v32
s_cbranch_vccnz mega_kernel_rs_pc_5_0f
v_smfmac_f32_16x16x64_bf16 v[96:99], v[32:35], a[192:199], v6
v_smfmac_f32_16x16x64_bf16 v[100:103], v[32:35], a[224:231], v6
s_branch mega_kernel_rs_pc_4_2
mega_kernel_rs_pc_5_2f:
s_mov_b64 exec, vcc
buffer_load_dwordx4 v[40:43], v7, s[84:87], s29 offen offset:2048 sc1
s_mov_b64 exec, -1
s_branch mega_kernel_rs_pc_5_0
mega_kernel_rs_pc_5_2:
s_waitcnt vmcnt(1)
v_cmp_eq_u32 vcc, -1, v40
s_cbranch_vccnz mega_kernel_rs_pc_5_2f
v_smfmac_f32_16x16x64_bf16 v[96:99], v[40:43], a[208:215], v6
v_smfmac_f32_16x16x64_bf16 v[100:103], v[40:43], a[240:247], v6
s_branch mega_kernel_rs_pc_1_0
mega_kernel_rs_pc_6_1f:
s_mov_b64 exec, vcc
buffer_load_dwordx4 v[36:39], v7, s[84:87], s29 offen offset:1024 sc1
s_mov_b64 exec, -1
s_branch mega_kernel_rs_pc_6_2
mega_kernel_rs_pc_6_1:
s_waitcnt vmcnt(1)
v_cmp_eq_u32 vcc, -1, v36
s_cbranch_vccnz mega_kernel_rs_pc_6_1f
v_smfmac_f32_16x16x64_bf16 v[96:99], v[36:39], a[200:207], v6
v_smfmac_f32_16x16x64_bf16 v[100:103], v[36:39], a[232:239], v6
s_branch mega_kernel_rs_pc_4_2
mega_kernel_rs_pc_6_2f:
s_mov_b64 exec, vcc
buffer_load_dwordx4 v[40:43], v7, s[84:87], s29 offen offset:2048 sc1
s_mov_b64 exec, -1
s_branch mega_kernel_rs_pc_6_1
mega_kernel_rs_pc_6_2:
s_waitcnt vmcnt(1)
v_cmp_eq_u32 vcc, -1, v40
s_cbranch_vccnz mega_kernel_rs_pc_6_2f
v_smfmac_f32_16x16x64_bf16 v[96:99], v[40:43], a[208:215], v6
v_smfmac_f32_16x16x64_bf16 v[100:103], v[40:43], a[240:247], v6
s_branch mega_kernel_rs_pc_2_1
mega_kernel_rs_pc_7_0f:
s_mov_b64 exec, vcc
buffer_load_dwordx4 v[32:35], v7, s[84:87], s29 offen offset:0 sc1
s_mov_b64 exec, -1
s_branch mega_kernel_rs_pc_7_1
mega_kernel_rs_pc_7_0:
s_waitcnt vmcnt(2)
v_cmp_eq_u32 vcc, -1, v32
s_cbranch_vccnz mega_kernel_rs_pc_7_0f
v_smfmac_f32_16x16x64_bf16 v[96:99], v[32:35], a[192:199], v6
v_smfmac_f32_16x16x64_bf16 v[100:103], v[32:35], a[224:231], v6
s_branch mega_kernel_rs_pc_6_1
mega_kernel_rs_pc_7_1f:
s_mov_b64 exec, vcc
buffer_load_dwordx4 v[36:39], v7, s[84:87], s29 offen offset:1024 sc1
s_mov_b64 exec, -1
s_branch mega_kernel_rs_pc_7_2
mega_kernel_rs_pc_7_1:
s_waitcnt vmcnt(2)
v_cmp_eq_u32 vcc, -1, v36
s_cbranch_vccnz mega_kernel_rs_pc_7_1f
v_smfmac_f32_16x16x64_bf16 v[96:99], v[36:39], a[200:207], v6
v_smfmac_f32_16x16x64_bf16 v[100:103], v[36:39], a[232:239], v6
s_branch mega_kernel_rs_pc_5_2
mega_kernel_rs_pc_7_2f:
s_mov_b64 exec, vcc
buffer_load_dwordx4 v[40:43], v7, s[84:87], s29 offen offset:2048 sc1
s_mov_b64 exec, -1
s_branch mega_kernel_rs_pc_7_0
mega_kernel_rs_pc_7_2:
s_waitcnt vmcnt(2)
v_cmp_eq_u32 vcc, -1, v40
s_cbranch_vccnz mega_kernel_rs_pc_7_2f
v_smfmac_f32_16x16x64_bf16 v[96:99], v[40:43], a[208:215], v6
v_smfmac_f32_16x16x64_bf16 v[100:103], v[40:43], a[240:247], v6
s_branch mega_kernel_rs_pc_3_0
mega_kernel_rs_pc_8_3f:
s_mov_b64 exec, vcc
buffer_load_dwordx4 v[44:47], v7, s[84:87], s29 offen offset:3072 sc1
s_mov_b64 exec, -1
s_branch mega_kernel_rs_pc_8_3
mega_kernel_rs_pc_9_0f:
s_mov_b64 exec, vcc
buffer_load_dwordx4 v[32:35], v7, s[84:87], s29 offen offset:0 sc1
s_mov_b64 exec, -1
s_branch mega_kernel_rs_pc_9_3
mega_kernel_rs_pc_9_0:
s_waitcnt vmcnt(1)
v_cmp_eq_u32 vcc, -1, v32
s_cbranch_vccnz mega_kernel_rs_pc_9_0f
v_smfmac_f32_16x16x64_bf16 v[96:99], v[32:35], a[192:199], v6
v_smfmac_f32_16x16x64_bf16 v[100:103], v[32:35], a[224:231], v6
s_branch mega_kernel_rs_pc_8_3
mega_kernel_rs_pc_9_3f:
s_mov_b64 exec, vcc
buffer_load_dwordx4 v[44:47], v7, s[84:87], s29 offen offset:3072 sc1
s_mov_b64 exec, -1
s_branch mega_kernel_rs_pc_9_0
mega_kernel_rs_pc_9_3:
s_waitcnt vmcnt(1)
v_cmp_eq_u32 vcc, -1, v44
s_cbranch_vccnz mega_kernel_rs_pc_9_3f
v_smfmac_f32_16x16x64_bf16 v[96:99], v[44:47], a[216:223], v6
v_smfmac_f32_16x16x64_bf16 v[100:103], v[44:47], a[248:255], v6
s_branch mega_kernel_rs_pc_1_0
mega_kernel_rs_pc_10_1f:
s_mov_b64 exec, vcc
buffer_load_dwordx4 v[36:39], v7, s[84:87], s29 offen offset:1024 sc1
s_mov_b64 exec, -1
s_branch mega_kernel_rs_pc_10_3
mega_kernel_rs_pc_10_1:
s_waitcnt vmcnt(1)
v_cmp_eq_u32 vcc, -1, v36
s_cbranch_vccnz mega_kernel_rs_pc_10_1f
v_smfmac_f32_16x16x64_bf16 v[96:99], v[36:39], a[200:207], v6
v_smfmac_f32_16x16x64_bf16 v[100:103], v[36:39], a[232:239], v6
s_branch mega_kernel_rs_pc_8_3
mega_kernel_rs_pc_10_3f:
s_mov_b64 exec, vcc
buffer_load_dwordx4 v[44:47], v7, s[84:87], s29 offen offset:3072 sc1
s_mov_b64 exec, -1
s_branch mega_kernel_rs_pc_10_1
mega_kernel_rs_pc_10_3:
s_waitcnt vmcnt(1)
v_cmp_eq_u32 vcc, -1, v44
s_cbranch_vccnz mega_kernel_rs_pc_10_3f
v_smfmac_f32_16x16x64_bf16 v[96:99], v[44:47], a[216:223], v6
v_smfmac_f32_16x16x64_bf16 v[100:103], v[44:47], a[248:255], v6
s_branch mega_kernel_rs_pc_2_1
mega_kernel_rs_pc_11_0f:
s_mov_b64 exec, vcc
buffer_load_dwordx4 v[32:35], v7, s[84:87], s29 offen offset:0 sc1
s_mov_b64 exec, -1
s_branch mega_kernel_rs_pc_11_1
mega_kernel_rs_pc_11_0:
s_waitcnt vmcnt(2)
v_cmp_eq_u32 vcc, -1, v32
s_cbranch_vccnz mega_kernel_rs_pc_11_0f
v_smfmac_f32_16x16x64_bf16 v[96:99], v[32:35], a[192:199], v6
v_smfmac_f32_16x16x64_bf16 v[100:103], v[32:35], a[224:231], v6
s_branch mega_kernel_rs_pc_10_1
mega_kernel_rs_pc_11_1f:
s_mov_b64 exec, vcc
buffer_load_dwordx4 v[36:39], v7, s[84:87], s29 offen offset:1024 sc1
s_mov_b64 exec, -1
s_branch mega_kernel_rs_pc_11_3
mega_kernel_rs_pc_11_1:
s_waitcnt vmcnt(2)
v_cmp_eq_u32 vcc, -1, v36
s_cbranch_vccnz mega_kernel_rs_pc_11_1f
v_smfmac_f32_16x16x64_bf16 v[96:99], v[36:39], a[200:207], v6
v_smfmac_f32_16x16x64_bf16 v[100:103], v[36:39], a[232:239], v6
s_branch mega_kernel_rs_pc_9_3
mega_kernel_rs_pc_11_3f:
s_mov_b64 exec, vcc
buffer_load_dwordx4 v[44:47], v7, s[84:87], s29 offen offset:3072 sc1
s_mov_b64 exec, -1
s_branch mega_kernel_rs_pc_11_0
mega_kernel_rs_pc_11_3:
s_waitcnt vmcnt(2)
v_cmp_eq_u32 vcc, -1, v44
s_cbranch_vccnz mega_kernel_rs_pc_11_3f
v_smfmac_f32_16x16x64_bf16 v[96:99], v[44:47], a[216:223], v6
v_smfmac_f32_16x16x64_bf16 v[100:103], v[44:47], a[248:255], v6
s_branch mega_kernel_rs_pc_3_0
mega_kernel_rs_pc_12_2f:
s_mov_b64 exec, vcc
buffer_load_dwordx4 v[40:43], v7, s[84:87], s29 offen offset:2048 sc1
s_mov_b64 exec, -1
s_branch mega_kernel_rs_pc_12_3
mega_kernel_rs_pc_12_3f:
s_mov_b64 exec, vcc
buffer_load_dwordx4 v[44:47], v7, s[84:87], s29 offen offset:3072 sc1
s_mov_b64 exec, -1
s_branch mega_kernel_rs_pc_12_2
mega_kernel_rs_pc_12_3:
s_waitcnt vmcnt(1)
v_cmp_eq_u32 vcc, -1, v44
s_cbranch_vccnz mega_kernel_rs_pc_12_3f
v_smfmac_f32_16x16x64_bf16 v[96:99], v[44:47], a[216:223], v6
v_smfmac_f32_16x16x64_bf16 v[100:103], v[44:47], a[248:255], v6
s_branch mega_kernel_rs_pc_4_2
mega_kernel_rs_pc_13_0f:
s_mov_b64 exec, vcc
buffer_load_dwordx4 v[32:35], v7, s[84:87], s29 offen offset:0 sc1
s_mov_b64 exec, -1
s_branch mega_kernel_rs_pc_13_2
mega_kernel_rs_pc_13_0:
s_waitcnt vmcnt(2)
v_cmp_eq_u32 vcc, -1, v32
s_cbranch_vccnz mega_kernel_rs_pc_13_0f
v_smfmac_f32_16x16x64_bf16 v[96:99], v[32:35], a[192:199], v6
v_smfmac_f32_16x16x64_bf16 v[100:103], v[32:35], a[224:231], v6
s_branch mega_kernel_rs_pc_12_2
mega_kernel_rs_pc_13_2f:
s_mov_b64 exec, vcc
buffer_load_dwordx4 v[40:43], v7, s[84:87], s29 offen offset:2048 sc1
s_mov_b64 exec, -1
s_branch mega_kernel_rs_pc_13_3
mega_kernel_rs_pc_13_2:
s_waitcnt vmcnt(2)
v_cmp_eq_u32 vcc, -1, v40
s_cbranch_vccnz mega_kernel_rs_pc_13_2f
v_smfmac_f32_16x16x64_bf16 v[96:99], v[40:43], a[208:215], v6
v_smfmac_f32_16x16x64_bf16 v[100:103], v[40:43], a[240:247], v6
s_branch mega_kernel_rs_pc_9_3
mega_kernel_rs_pc_13_3f:
s_mov_b64 exec, vcc
buffer_load_dwordx4 v[44:47], v7, s[84:87], s29 offen offset:3072 sc1
s_mov_b64 exec, -1
s_branch mega_kernel_rs_pc_13_0
mega_kernel_rs_pc_13_3:
s_waitcnt vmcnt(2)
v_cmp_eq_u32 vcc, -1, v44
s_cbranch_vccnz mega_kernel_rs_pc_13_3f
v_smfmac_f32_16x16x64_bf16 v[96:99], v[44:47], a[216:223], v6
v_smfmac_f32_16x16x64_bf16 v[100:103], v[44:47], a[248:255], v6
s_branch mega_kernel_rs_pc_5_0
mega_kernel_rs_pc_14_1f:
s_mov_b64 exec, vcc
buffer_load_dwordx4 v[36:39], v7, s[84:87], s29 offen offset:1024 sc1
s_mov_b64 exec, -1
s_branch mega_kernel_rs_pc_14_2
mega_kernel_rs_pc_14_2f:
s_mov_b64 exec, vcc
buffer_load_dwordx4 v[40:43], v7, s[84:87], s29 offen offset:2048 sc1
s_mov_b64 exec, -1
s_branch mega_kernel_rs_pc_14_3
mega_kernel_rs_pc_14_2:
s_waitcnt vmcnt(2)
v_cmp_eq_u32 vcc, -1, v40
s_cbranch_vccnz mega_kernel_rs_pc_14_2f
v_smfmac_f32_16x16x64_bf16 v[96:99], v[40:43], a[208:215], v6
v_smfmac_f32_16x16x64_bf16 v[100:103], v[40:43], a[240:247], v6
s_branch mega_kernel_rs_pc_10_3
mega_kernel_rs_pc_14_3f:
s_mov_b64 exec, vcc
buffer_load_dwordx4 v[44:47], v7, s[84:87], s29 offen offset:3072 sc1
s_mov_b64 exec, -1
s_branch mega_kernel_rs_pc_14_1
mega_kernel_rs_pc_14_3:
s_waitcnt vmcnt(2)
v_cmp_eq_u32 vcc, -1, v44
s_cbranch_vccnz mega_kernel_rs_pc_14_3f
v_smfmac_f32_16x16x64_bf16 v[96:99], v[44:47], a[216:223], v6
v_smfmac_f32_16x16x64_bf16 v[100:103], v[44:47], a[248:255], v6
s_branch mega_kernel_rs_pc_6_1
mega_kernel_rs_pc_15_0f:
s_mov_b64 exec, vcc
buffer_load_dwordx4 v[32:35], v7, s[84:87], s29 offen offset:0 sc1
s_mov_b64 exec, -1
s_branch mega_kernel_rs_pc_15_1
mega_kernel_rs_pc_15_1f:
s_mov_b64 exec, vcc
buffer_load_dwordx4 v[36:39], v7, s[84:87], s29 offen offset:1024 sc1
s_mov_b64 exec, -1
s_branch mega_kernel_rs_pc_15_2
mega_kernel_rs_pc_15_1:
s_waitcnt vmcnt(3)
v_cmp_eq_u32 vcc, -1, v36
s_cbranch_vccnz mega_kernel_rs_pc_15_1f
v_smfmac_f32_16x16x64_bf16 v[96:99], v[36:39], a[200:207], v6
v_smfmac_f32_16x16x64_bf16 v[100:103], v[36:39], a[232:239], v6
s_branch mega_kernel_rs_pc_13_2
mega_kernel_rs_pc_15_2f:
s_mov_b64 exec, vcc
buffer_load_dwordx4 v[40:43], v7, s[84:87], s29 offen offset:2048 sc1
s_mov_b64 exec, -1
s_branch mega_kernel_rs_pc_15_3
mega_kernel_rs_pc_15_2:
s_waitcnt vmcnt(3)
v_cmp_eq_u32 vcc, -1, v40
s_cbranch_vccnz mega_kernel_rs_pc_15_2f
v_smfmac_f32_16x16x64_bf16 v[96:99], v[40:43], a[208:215], v6
v_smfmac_f32_16x16x64_bf16 v[100:103], v[40:43], a[240:247], v6
s_branch mega_kernel_rs_pc_11_3
mega_kernel_rs_pc_15_3f:
s_mov_b64 exec, vcc
buffer_load_dwordx4 v[44:47], v7, s[84:87], s29 offen offset:3072 sc1
s_mov_b64 exec, -1
s_branch mega_kernel_rs_pc_15_0
mega_kernel_rs_pc_15_3:
s_waitcnt vmcnt(3)
v_cmp_eq_u32 vcc, -1, v44
s_cbranch_vccnz mega_kernel_rs_pc_15_3f
v_smfmac_f32_16x16x64_bf16 v[96:99], v[44:47], a[216:223], v6
v_smfmac_f32_16x16x64_bf16 v[100:103], v[44:47], a[248:255], v6
s_branch mega_kernel_rs_pc_7_0
mega_kernel_rs_w0last:
s_nop 7
v_permlane32_swap_b32 v112, v116
v_permlane32_swap_b32 v113, v117
v_permlane32_swap_b32 v114, v118
v_permlane32_swap_b32 v115, v119
v_pk_add_f32 v[112:113], v[112:113], v[116:117]
v_pk_add_f32 v[114:115], v[114:115], v[118:119]
ds_write_b128 v20, v[112:115]
s_waitcnt lgkmcnt(0)
s_barrier
s_branch mega_kernel_rs_end
mega_kernel_rs_side:
s_cmp_eq_u32 s24, 3
s_cbranch_scc1 mega_kernel_rs_sd3
s_cmp_eq_u32 s24, 2
s_cbranch_scc0 mega_kernel_rs_sd4
s_mov_b64 exec, s[40:41]
buffer_store_dwordx4 v[28:31], v11, s[84:87], s34 offen sc1
s_mov_b64 exec, -1
buffer_store_dwordx2 v[28:29], v9, s[84:87], s34 offen sc1
s_mul_i32 s28, s31, 2048
s_add_u32 s28, s28, s34
s_add_u32 s28, s28, 49152
buffer_store_dwordx4 v[28:31], v17, s[84:87], s28 offen sc1
buffer_store_dwordx4 v[28:31], v10, s[84:87], s28 offen sc1
s_branch mega_kernel_rs_sd4
mega_kernel_rs_sd3:
s_mov_b32 s36, 0
s_add_u32 s76, s27, 1
s_cmp_lt_u32 s76, 63
s_cbranch_scc0 mega_kernel_rs_sd4
s_cmp_ge_u32 s76, 0
s_cbranch_scc0 mega_kernel_rs_sd4
s_cmp_gt_i32 s46, s76
s_cselect_b32 s36, 0, 1
s_cbranch_scc0 mega_kernel_rs_sd4
s_add_u32 s77, s76, s82
s_bfe_u32 s28, s77, 0x40002
s_lshl_b32 s28, s28, 14
s_and_b32 s77, s77, 3
s_lshl_b32 s77, s77, 11
s_add_u32 s28, s28, s77
s_add_u32 m0, s45, 0
s_nop 0
buffer_load_dwordx4 v240, s[84:87], s28 offen offset:0 sc1 lds
s_add_u32 m0, s45, 0
s_nop 0
buffer_load_dwordx4 v240, s[84:87], s28 offen offset:1024 sc1 lds
s_add_u32 m0, s45, 2048
s_nop 0
buffer_load_dwordx4 v241, s[84:87], s28 offen offset:0 sc1 lds
s_add_u32 m0, s45, 2048
s_nop 0
buffer_load_dwordx4 v241, s[84:87], s28 offen offset:1024 sc1 lds
s_add_u32 s45, s45, 4096
s_cmp_eq_u32 s45, 30720
s_cselect_b32 s45, 18432, s45
mega_kernel_rs_sd4:
v_smfmac_f32_16x16x64_bf16 v[112:115], v[40:43], a[144:151], v6
v_smfmac_f32_16x16x64_bf16 v[116:119], v[40:43], a[176:183], v6
v_smfmac_f32_16x16x64_bf16 v[112:115], v[44:47], a[152:159], v6
v_smfmac_f32_16x16x64_bf16 v[116:119], v[44:47], a[184:191], v6
s_nop 7
v_permlane32_swap_b32 v112, v116
v_permlane32_swap_b32 v113, v117
v_permlane32_swap_b32 v114, v118
v_permlane32_swap_b32 v115, v119
v_pk_add_f32 v[112:113], v[112:113], v[116:117]
v_pk_add_f32 v[114:115], v[114:115], v[118:119]
ds_write_b128 v20, v[112:115]
v_mov_b32 v96, 0
v_mov_b32 v97, 0
v_mov_b32 v98, 0
v_mov_b32 v99, 0
v_mov_b32 v100, 0
v_mov_b32 v101, 0
v_mov_b32 v102, 0
v_mov_b32 v103, 0
s_cmp_eq_u32 s24, 1
s_cbranch_scc0 mega_kernel_rs_s1
s_waitcnt lgkmcnt(0)
ds_read_b128 v[120:123], v16 offset:0
ds_read_b128 v[124:127], v16 offset:16
ds_read_b128 v[128:131], v16 offset:2304
ds_read_b128 v[132:135], v16 offset:2320
ds_read_b128 v[136:139], v16 offset:4608
ds_read_b128 v[140:143], v16 offset:4624
ds_read_b128 v[144:147], v16 offset:6912
ds_read_b128 v[148:151], v16 offset:6928
s_waitcnt lgkmcnt(4)
v_pk_add_f32 v[120:121], v[120:121], v[128:129]
v_pk_add_f32 v[122:123], v[122:123], v[130:131]
v_pk_add_f32 v[124:125], v[124:125], v[132:133]
v_pk_add_f32 v[126:127], v[126:127], v[134:135]
s_waitcnt lgkmcnt(0)
v_pk_add_f32 v[136:137], v[136:137], v[144:145]
v_pk_add_f32 v[138:139], v[138:139], v[146:147]
v_pk_add_f32 v[140:141], v[140:141], v[148:149]
v_pk_add_f32 v[142:143], v[142:143], v[150:151]
v_pk_add_f32 v[120:121], v[120:121], v[136:137]
v_pk_add_f32 v[122:123], v[122:123], v[138:139]
v_pk_add_f32 v[124:125], v[124:125], v[140:141]
v_pk_add_f32 v[126:127], v[126:127], v[142:143]
v_cvt_pk_bf16_f32 v244, v120, v121
v_cvt_pk_bf16_f32 v245, v122, v123
v_cvt_pk_bf16_f32 v246, v124, v125
v_cvt_pk_bf16_f32 v247, v126, v127
mega_kernel_rs_s1:
v_add_u32 v5, 9216, v17
s_waitcnt lgkmcnt(0)
s_barrier
s_cmp_eq_u32 s24, 2
s_cbranch_scc1 mega_kernel_rs_s2
s_cmp_eq_u32 s24, 3
s_cbranch_scc0 mega_kernel_rs_s3
s_add_u32 s76, s27, 2
s_cmp_lt_u32 s76, 63
s_cbranch_scc0 mega_kernel_rs_s3
s_cmp_gt_i32 s46, s76
s_cbranch_scc0 mega_kernel_rs_s3
s_add_u32 s77, s76, s82
s_bfe_u32 s28, s77, 0x40002
s_lshl_b32 s28, s28, 14
s_and_b32 s77, s77, 3
s_lshl_b32 s77, s77, 11
s_add_u32 s28, s28, s77
s_add_u32 s28, s28, s83
s_buffer_load_dword s78, s[84:87], s28 offset:0
s_buffer_load_dword s78, s[84:87], s28 offset:128
s_buffer_load_dword s78, s[84:87], s28 offset:256
s_buffer_load_dword s78, s[84:87], s28 offset:384
s_buffer_load_dword s78, s[84:87], s28 offset:512
s_buffer_load_dword s78, s[84:87], s28 offset:640
s_buffer_load_dword s78, s[84:87], s28 offset:768
s_buffer_load_dword s78, s[84:87], s28 offset:896
s_buffer_load_dword s78, s[84:87], s28 offset:1024
s_buffer_load_dword s78, s[84:87], s28 offset:1152
s_buffer_load_dword s78, s[84:87], s28 offset:1280
s_buffer_load_dword s78, s[84:87], s28 offset:1408
s_buffer_load_dword s78, s[84:87], s28 offset:1536
s_buffer_load_dword s78, s[84:87], s28 offset:1664
s_buffer_load_dword s78, s[84:87], s28 offset:1792
s_buffer_load_dword s78, s[84:87], s28 offset:1920
s_mov_b32 s88, s76
s_branch mega_kernel_rs_s3
mega_kernel_rs_s2:
ds_read_b128 v[120:123], v5 offset:0
ds_read_b128 v[124:127], v5 offset:1024
ds_read_b128 v[128:131], v5 offset:2048
ds_read_b128 v[132:135], v5 offset:3072
v_lshrrev_b32 v5, 1, v17
s_waitcnt lgkmcnt(2)
v_pk_add_f32 v[120:121], v[120:121], v[124:125]
v_pk_add_f32 v[122:123], v[122:123], v[126:127]
s_waitcnt lgkmcnt(0)
v_pk_add_f32 v[128:129], v[128:129], v[132:133]
v_pk_add_f32 v[130:131], v[130:131], v[134:135]
v_pk_add_f32 v[120:121], v[120:121], v[128:129]
v_pk_add_f32 v[122:123], v[122:123], v[130:131]
v_cvt_pk_bf16_f32 v244, v120, v121
v_cvt_pk_bf16_f32 v245, v122, v123
ds_write_b64 v5, v[244:245] offset:17920
s_waitcnt lgkmcnt(0) vmcnt(0)
mega_kernel_rs_s3:
s_cmp_eq_u32 s27, 63
s_cbranch_scc1 mega_kernel_rs_slast
s_add_u32 s29, s33, 24576
s_barrier
s_cmp_eq_u32 s24, 3
s_cbranch_scc1 mega_kernel_rs_y3
s_add_u32 s77, s27, s82
s_bfe_u32 s28, s77, 0x30003
s_lshl_b32 s28, s28, 14
s_and_b32 s77, s77, 7
s_lshl_b32 s77, s77, 10
s_add_u32 s28, s28, s77
s_add_u32 s28, s28, s79
s_cmp_eq_u32 s24, 2
s_cbranch_scc1 mega_kernel_rs_kv2a
s_mov_b64 exec, s[48:49]
buffer_store_dwordx4 v[244:247], v22, s[84:87], s28 offen sc1
s_mov_b64 exec, -1
s_branch mega_kernel_rs_kvda
mega_kernel_rs_kv2a:
v_lshlrev_b32 v4, 3, v1
buffer_store_dwordx2 v[244:245], v4, s[84:87], s28 offen offset:512 sc1
mega_kernel_rs_kvda:
s_branch mega_kernel_rs_y4
mega_kernel_rs_y3:
s_add_u32 s76, s27, 2
s_cmp_lt_u32 s76, 63
s_cbranch_scc0 mega_kernel_rs_y4
mega_kernel_rs_y4:
s_branch mega_kernel_rs_b3
mega_kernel_rs_first:
buffer_load_dwordx4 v[32:35], v8, s[20:23], 0 offen offset:0
buffer_load_dwordx4 v[36:39], v8, s[20:23], 0 offen offset:128
buffer_load_dwordx4 v[40:43], v8, s[20:23], 0 offen offset:256
buffer_load_dwordx4 v[44:47], v8, s[20:23], 0 offen offset:384
v_add_u32 v5, s44, v17
ds_read_b128 v[156:159], v5 offset:0
ds_read_b128 v[160:163], v5 offset:1024
ds_read_b128 v[164:167], v5 offset:2048
ds_read_b128 v[168:171], v5 offset:3072
s_waitcnt vmcnt(0)
v_smfmac_f32_16x16x64_bf16 v[96:99], v[32:35], a[0:7], v6
v_smfmac_f32_16x16x64_bf16 v[100:103], v[32:35], a[32:39], v6
v_smfmac_f32_16x16x64_bf16 v[104:107], v[32:35], a[64:71], v6
v_smfmac_f32_16x16x64_bf16 v[108:111], v[32:35], a[96:103], v6
v_smfmac_f32_16x16x64_bf16 v[96:99], v[36:39], a[8:15], v6
v_smfmac_f32_16x16x64_bf16 v[100:103], v[36:39], a[40:47], v6
v_smfmac_f32_16x16x64_bf16 v[104:107], v[36:39], a[72:79], v6
v_smfmac_f32_16x16x64_bf16 v[108:111], v[36:39], a[104:111], v6
v_smfmac_f32_16x16x64_bf16 v[96:99], v[40:43], a[16:23], v6
v_smfmac_f32_16x16x64_bf16 v[100:103], v[40:43], a[48:55], v6
v_smfmac_f32_16x16x64_bf16 v[104:107], v[40:43], a[80:87], v6
v_smfmac_f32_16x16x64_bf16 v[108:111], v[40:43], a[112:119], v6
v_smfmac_f32_16x16x64_bf16 v[96:99], v[44:47], a[24:31], v6
v_smfmac_f32_16x16x64_bf16 v[100:103], v[44:47], a[56:63], v6
v_smfmac_f32_16x16x64_bf16 v[104:107], v[44:47], a[88:95], v6
v_smfmac_f32_16x16x64_bf16 v[108:111], v[44:47], a[120:127], v6
s_nop 1
s_branch mega_kernel_rs_adone
mega_kernel_rs_slast:
s_cmp_eq_u32 s24, 3
s_cbranch_scc1 mega_kernel_rs_end
s_add_u32 s77, s27, s82
s_bfe_u32 s28, s77, 0x30003
s_lshl_b32 s28, s28, 14
s_and_b32 s77, s77, 7
s_lshl_b32 s77, s77, 10
s_add_u32 s28, s28, s77
s_add_u32 s28, s28, s79
s_cmp_eq_u32 s24, 2
s_cbranch_scc1 mega_kernel_rs_kv2b
s_mov_b64 exec, s[48:49]
buffer_store_dwordx4 v[244:247], v22, s[84:87], s28 offen sc1
s_mov_b64 exec, -1
s_branch mega_kernel_rs_kvdb
mega_kernel_rs_kv2b:
v_lshlrev_b32 v4, 3, v1
buffer_store_dwordx2 v[244:245], v4, s[84:87], s28 offen offset:512 sc1
mega_kernel_rs_kvdb:
s_waitcnt vmcnt(0)
s_barrier
s_mov_b32 s76, 64
s_cmp_eq_u32 s24, 1
s_cbranch_scc0 mega_kernel_rs_end
v_mov_b32 v5, s76
s_mov_b64 exec, 1
buffer_store_dword v5, v228, s[84:87], s81 offen sc1
s_mov_b64 exec, -1
mega_kernel_rs_end:
s_endpgm
.section .rodata,"a"
.p2align 6
.amdhsa_kernel mega_kernel
  .amdhsa_next_free_vgpr 512
  .amdhsa_next_free_sgpr 102
  .amdhsa_accum_offset 256
  .amdhsa_group_segment_fixed_size 0
  .amdhsa_kernarg_size 104
  .amdhsa_user_sgpr_count 2
  .amdhsa_user_sgpr_kernarg_segment_ptr 1
  .amdhsa_system_sgpr_workgroup_id_x 1
.end_amdhsa_kernel
```

```asm
; @launch kernel=mega_kernel grid=(256,1,1) block=(256,1,1) lds=163840
.amdgcn_target "amdgcn-amd-amdhsa--gfx950"
.text
.globl mega_kernel
.p2align 8
.type mega_kernel,@function
mega_kernel:
s_cmp_ge_u32 s2, 256
s_cbranch_scc1 mega_kernel_exit
s_load_dwordx2 s[84:85], s[0:1], 96
s_load_dwordx2 s[72:73], s[0:1], 88
s_getreg_b32 s90, hwreg(HW_REG_XCC_ID)
s_and_b32 s90, s90, 7
v_mov_b32 v1, 0
v_mov_b32 v2, 1
s_lshl_b32 s91, s90, 4
s_mov_b32 s95, 0
s_mov_b32 s99, 0
s_waitcnt lgkmcnt(0)
s_mov_b32 s86, 268435456
s_mov_b32 s87, 0x00020000
s_mov_b32 s74, 256
s_mov_b32 s75, 0x00020000
v_cmp_eq_u32 vcc, 0, v0
s_and_saveexec_b64 s[88:89], vcc
s_cbranch_execz mega_kernel_tkd
s_lshl_b32 s92, s2, 13
s_add_u32 s92, s92, 167772160
buffer_atomic_add v2, v1, s[72:75], s91 offen sc0
buffer_load_dword v251, v1, s[84:87], s92 offen offset:2048 sc1
s_waitcnt vmcnt(1)
ds_write_b32 v1, v2
s_waitcnt lgkmcnt(0)
mega_kernel_tkd:
s_mov_b64 exec, s[88:89]
s_barrier
ds_read_b32 v2, v1
s_waitcnt lgkmcnt(0)
v_readfirstlane_b32 s96, v2
s_barrier
s_cmp_lt_u32 s96, 32
s_cbranch_scc1 mega_kernel_spec
v_and_b32 v3, 15, v0
v_lshlrev_b32 v3, 4, v3
s_branch mega_kernel_syx
mega_kernel_syxw:
s_sleep 4
mega_kernel_syx:
buffer_load_dword v2, v3, s[72:75], 0 offen sc1
s_waitcnt vmcnt(0)
mega_kernel_syxp:
s_cmp_eq_u32 s95, 1
s_cbranch_scc0 mega_kernel_syxf
v_readlane_b32 s76, v2, 14
s_mov_b32 s98, 0
s_cmp_eq_u32 s76, 64
s_cbranch_scc0 mega_kernel_syxw
s_branch mega_kernel_syxd
mega_kernel_syxf:
s_mov_b32 s77, 0
s_mov_b32 s78, 0
v_readlane_b32 s76, v2, 0
s_add_u32 s77, s77, s76
s_xor_b32 s76, s76, 32
s_or_b32 s78, s78, s76
v_readlane_b32 s76, v2, 1
s_add_u32 s77, s77, s76
s_xor_b32 s76, s76, 32
s_or_b32 s78, s78, s76
v_readlane_b32 s76, v2, 2
s_add_u32 s77, s77, s76
s_xor_b32 s76, s76, 32
s_or_b32 s78, s78, s76
v_readlane_b32 s76, v2, 3
s_add_u32 s77, s77, s76
s_xor_b32 s76, s76, 32
s_or_b32 s78, s78, s76
v_readlane_b32 s76, v2, 4
s_add_u32 s77, s77, s76
s_xor_b32 s76, s76, 32
s_or_b32 s78, s78, s76
v_readlane_b32 s76, v2, 5
s_add_u32 s77, s77, s76
s_xor_b32 s76, s76, 32
s_or_b32 s78, s78, s76
v_readlane_b32 s76, v2, 6
s_add_u32 s77, s77, s76
s_xor_b32 s76, s76, 32
s_or_b32 s78, s78, s76
v_readlane_b32 s76, v2, 7
s_add_u32 s77, s77, s76
s_xor_b32 s76, s76, 32
s_or_b32 s78, s78, s76
s_cmp_eq_u32 s77, 256
s_cbranch_scc0 mega_kernel_syxw
v_mov_b32 v252, v2
s_cmp_eq_u32 s78, 0
s_cbranch_scc0 mega_kernel_slowent
v_readlane_b32 s76, v2, 10
v_readlane_b32 s77, v2, 8
s_cmp_eq_u32 s76, 64
s_cbranch_scc0 mega_kernel_syxw
s_cmp_gt_u32 s77, 32
s_cselect_b32 s98, 1, 0
mega_kernel_syxd:
mega_kernel_slowent:
s_mov_b64 exec, -1
s_waitcnt vmcnt(0) lgkmcnt(0)
s_barrier
s_mov_b32 s97, s96
v_readlane_b32 s76, v252, 0
s_cmp_gt_u32 s90, 0
s_cselect_b32 s76, s76, 0
s_add_u32 s97, s97, s76
v_readlane_b32 s76, v252, 1
s_cmp_gt_u32 s90, 1
s_cselect_b32 s76, s76, 0
s_add_u32 s97, s97, s76
v_readlane_b32 s76, v252, 2
s_cmp_gt_u32 s90, 2
s_cselect_b32 s76, s76, 0
s_add_u32 s97, s97, s76
v_readlane_b32 s76, v252, 3
s_cmp_gt_u32 s90, 3
s_cselect_b32 s76, s76, 0
s_add_u32 s97, s97, s76
v_readlane_b32 s76, v252, 4
s_cmp_gt_u32 s90, 4
s_cselect_b32 s76, s76, 0
s_add_u32 s97, s97, s76
v_readlane_b32 s76, v252, 5
s_cmp_gt_u32 s90, 5
s_cselect_b32 s76, s76, 0
s_add_u32 s97, s97, s76
v_readlane_b32 s76, v252, 6
s_cmp_gt_u32 s90, 6
s_cselect_b32 s76, s76, 0
s_add_u32 s97, s97, s76
v_mov_b32 v1, 0
v_mov_b32 v2, 1
v_cmp_eq_u32 vcc, 0, v0
s_and_saveexec_b64 s[88:89], vcc
s_cbranch_execz mega_kernel_sb1
buffer_atomic_add v2, v1, s[72:75], 0 offen offset:192 sc1
mega_kernel_sb1:
s_mov_b64 exec, s[88:89]
mega_kernel_sb2:
s_sleep 4
buffer_load_dword v2, v1, s[72:75], 0 offen offset:192 sc1
s_waitcnt vmcnt(0)
v_cmp_ne_u32 vcc, 256, v2
s_cbranch_vccnz mega_kernel_sb2
s_mov_b32 s95, 1
s_lshr_b32 s30, s97, 5
s_and_b32 s31, s97, 31
s_cmp_lt_u32 s97, 128
s_cbranch_scc1 mega_kernel_recs
s_sub_u32 s94, s97, 128
s_branch mega_kernel_bulk
mega_kernel_spec:
s_mov_b32 s30, s90
s_mov_b32 s31, s96
s_cmp_lt_u32 s90, 4
s_cbranch_scc1 mega_kernel_recf
s_sub_u32 s94, s90, 4
s_lshl_b32 s94, s94, 5
s_add_u32 s94, s94, s96
mega_kernel_bulk:
s_lshr_b32 s91, s94, 5
s_and_b32 s40, s94, 31
s_and_b32 s92, s91, 1
s_lshl_b32 s92, s92, 5
s_add_u32 s92, s92, s40
s_cmp_eq_u32 s91, 0
s_cbranch_scc1 mega_kernel_rk
s_cmp_eq_u32 s91, 1
s_cbranch_scc1 mega_kernel_rv
v_mov_b32 v8, -1
v_mov_b32 v9, -1
v_mov_b32 v10, -1
v_mov_b32 v11, -1
v_lshlrev_b32 v1, 4, v0
v_mov_b32 v2, 0
v_cmp_gt_u32 vcc, 64, v0
s_cbranch_vccz mega_kernel_nv
s_cmp_eq_u32 s95, 0
s_cbranch_scc0 mega_kernel_nv
s_lshr_b32 s60, s2, 1
s_lshl_b32 s60, s60, 14
s_and_b32 s61, s92, 1
s_lshl_b32 s66, s61, 13
s_add_u32 s60, s60, s66
s_and_b32 s66, s2, 1
s_lshl_b32 s66, s66, 10
s_add_u32 s60, s60, s66
s_add_u32 s60, s60, 167772160
s_mov_b32 s66, 0x7fffffff
s_mov_b32 s67, 0x7fffffff
s_mov_b64 exec, 0xff
s_waitcnt vmcnt(0)
s_memtime s[62:63]
s_waitcnt lgkmcnt(0)
buffer_store_dwordx4 v[8:11], v1, s[84:87], s60 offen offset:0 sc1
s_waitcnt vmcnt(0)
s_memtime s[64:65]
s_xor_b32 s60, s60, 8192
s_waitcnt lgkmcnt(0)
s_sub_u32 s64, s64, s62
s_min_u32 s66, s66, s64
s_memtime s[62:63]
s_waitcnt lgkmcnt(0)
buffer_store_dwordx4 v[8:11], v1, s[84:87], s60 offen offset:0 sc1
s_waitcnt vmcnt(0)
s_memtime s[64:65]
s_xor_b32 s60, s60, 8192
s_waitcnt lgkmcnt(0)
s_sub_u32 s64, s64, s62
s_min_u32 s67, s67, s64
s_memtime s[62:63]
s_waitcnt lgkmcnt(0)
buffer_store_dwordx4 v[8:11], v1, s[84:87], s60 offen offset:256 sc1
s_waitcnt vmcnt(0)
s_memtime s[64:65]
s_xor_b32 s60, s60, 8192
s_waitcnt lgkmcnt(0)
s_sub_u32 s64, s64, s62
s_min_u32 s66, s66, s64
s_memtime s[62:63]
s_waitcnt lgkmcnt(0)
buffer_store_dwordx4 v[8:11], v1, s[84:87], s60 offen offset:256 sc1
s_waitcnt vmcnt(0)
s_memtime s[64:65]
s_xor_b32 s60, s60, 8192
s_waitcnt lgkmcnt(0)
s_sub_u32 s64, s64, s62
s_min_u32 s67, s67, s64
s_cmp_lt_u32 s67, s66
s_cselect_b32 s60, 1, 0
s_xor_b32 s60, s60, s61
s_lshr_b32 s61, s90, 2
s_xor_b32 s60, s60, s61
v_mov_b32 v3, s60
s_mov_b64 exec, 1
buffer_atomic_add v3, v2, s[72:75], 0 offen offset:128 sc1
s_mov_b64 exec, -1
mega_kernel_nv:
s_barrier
s_lshl_b32 s60, s92, 12
s_add_u32 s60, s60, 67108864
buffer_store_dwordx4 v[8:11], v1, s[84:87], s60 offen sc1
s_add_u32 s60, s60, 262144
buffer_store_dwordx4 v[8:11], v1, s[84:87], s60 offen sc1
s_add_u32 s60, s60, 262144
buffer_store_dwordx4 v[8:11], v1, s[84:87], s60 offen sc1
s_add_u32 s60, s60, 262144
buffer_store_dwordx4 v[8:11], v1, s[84:87], s60 offen sc1
s_add_u32 s60, s60, 262144
buffer_store_dwordx4 v[8:11], v1, s[84:87], s60 offen sc1
s_add_u32 s60, s60, 262144
buffer_store_dwordx4 v[8:11], v1, s[84:87], s60 offen sc1
s_add_u32 s60, s60, 262144
buffer_store_dwordx4 v[8:11], v1, s[84:87], s60 offen sc1
s_add_u32 s60, s60, 262144
buffer_store_dwordx4 v[8:11], v1, s[84:87], s60 offen sc1
s_add_u32 s60, s60, 262144
s_lshr_b32 s62, s92, 1
s_and_b32 s63, s92, 1
s_add_u32 s63, s63, s62
s_lshl_b32 s62, s62, 19
s_and_b32 s64, s63, 14
s_lshl_b32 s64, s64, 13
s_add_u32 s62, s62, s64
s_and_b32 s64, s63, 1
s_lshl_b32 s64, s64, 12
s_add_u32 s62, s62, s64
s_add_u32 s62, s62, 150994944
s_add_u32 s62, s62, 8192
s_cmp_lt_u32 s92, 16
s_cbranch_scc0 mega_kernel_pz
buffer_store_dwordx4 v[8:11], v1, s[84:87], s60 offen sc1
mega_kernel_pz:
s_waitcnt vmcnt(0)
s_barrier
v_mov_b32 v3, 1
s_lshl_b32 s62, s95, 6
v_cmp_eq_u32 vcc, 0, v0
s_and_saveexec_b64 s[60:61], vcc
s_cbranch_execz mega_kernel_xps
buffer_atomic_add v3, v2, s[72:75], s62 offen offset:160 sc1
mega_kernel_xps:
s_mov_b64 exec, s[60:61]
s_cmp_eq_u32 s91, 2
s_cbranch_scc0 mega_kernel_rd
v_and_b32 v3, 15, v0
v_lshlrev_b32 v3, 4, v3
s_branch mega_kernel_syc
mega_kernel_sycw:
s_sleep 4
mega_kernel_syc:
buffer_load_dword v2, v3, s[72:75], 0 offen sc1
s_waitcnt vmcnt(0)
mega_kernel_sycp:
s_cmp_eq_u32 s95, 1
s_cbranch_scc0 mega_kernel_sycf
v_readlane_b32 s76, v2, 14
s_mov_b32 s98, 0
s_cmp_eq_u32 s76, 64
s_cbranch_scc0 mega_kernel_sycw
s_branch mega_kernel_sycd
mega_kernel_sycf:
s_mov_b32 s77, 0
s_mov_b32 s78, 0
v_readlane_b32 s76, v2, 0
s_add_u32 s77, s77, s76
s_xor_b32 s76, s76, 32
s_or_b32 s78, s78, s76
v_readlane_b32 s76, v2, 1
s_add_u32 s77, s77, s76
s_xor_b32 s76, s76, 32
s_or_b32 s78, s78, s76
v_readlane_b32 s76, v2, 2
s_add_u32 s77, s77, s76
s_xor_b32 s76, s76, 32
s_or_b32 s78, s78, s76
v_readlane_b32 s76, v2, 3
s_add_u32 s77, s77, s76
s_xor_b32 s76, s76, 32
s_or_b32 s78, s78, s76
v_readlane_b32 s76, v2, 4
s_add_u32 s77, s77, s76
s_xor_b32 s76, s76, 32
s_or_b32 s78, s78, s76
v_readlane_b32 s76, v2, 5
s_add_u32 s77, s77, s76
s_xor_b32 s76, s76, 32
s_or_b32 s78, s78, s76
v_readlane_b32 s76, v2, 6
s_add_u32 s77, s77, s76
s_xor_b32 s76, s76, 32
s_or_b32 s78, s78, s76
v_readlane_b32 s76, v2, 7
s_add_u32 s77, s77, s76
s_xor_b32 s76, s76, 32
s_or_b32 s78, s78, s76
s_cmp_eq_u32 s77, 256
s_cbranch_scc0 mega_kernel_sycw
v_mov_b32 v252, v2
s_cmp_eq_u32 s78, 0
s_cbranch_scc0 mega_kernel_slowent
v_readlane_b32 s76, v2, 10
v_readlane_b32 s77, v2, 8
s_cmp_eq_u32 s76, 64
s_cbranch_scc0 mega_kernel_sycw
s_cmp_gt_u32 s77, 32
s_cselect_b32 s98, 1, 0
mega_kernel_sycd:
s_load_dwordx2 s[4:5], s[0:1], 16
s_load_dwordx2 s[8:9], s[0:1], 0
v_lshrrev_b32 v2, 6, v0
v_and_b32 v1, 63, v0
v_readfirstlane_b32 s41, v2
v_lshlrev_b32 v5, 4, v1
s_waitcnt lgkmcnt(0)
s_mov_b32 s6, 8388608
s_mov_b32 s7, 0x00020000
s_mov_b32 s10, 4194304
s_mov_b32 s11, 0x00020000
s_lshl_b32 s43, s40, 8
s_lshl_b32 s44, s41, 6
s_add_u32 s48, s43, s44
s_and_b32 s43, s48, 0x7ff
v_add_u32 v19, s43, v1
v_lshlrev_b32 v19, 7, v19
s_mov_b32 s43, 0
buffer_load_dword v250, v19, s[8:11], s43 offen
s_nop 0
v_lshrrev_b32 v2, 3, v1
s_lshl_b32 s43, s41, 3
v_add_u32 v2, s43, v2
v_bfe_u32 v3, v2, 1, 3
v_and_b32 v4, 7, v1
v_xor_b32 v3, v3, v4
v_lshlrev_b32 v6, 11, v2
v_lshl_add_u32 v6, v3, 4, v6
s_lshl_b32 s46, s41, 10
v_and_b32 v2, 15, v1
v_bfe_u32 v3, v2, 1, 3
v_lshrrev_b32 v4, 4, v1
v_xor_b32 v3, v3, v4
v_lshlrev_b32 v8, 7, v2
v_lshl_add_u32 v8, v3, 4, v8
v_xor_b32 v9, 64, v8
v_add_u32 v10, 0x10000, v8
v_add_u32 v11, 0x10000, v9
v_mov_b32 v7, v5
s_lshl_b32 s47, s40, 2
s_add_u32 s47, s47, s41
s_mov_b32 s42, 0
s_mov_b32 s50, 0
s_add_u32 m0, s46, 0
s_nop 0
buffer_load_dwordx4 v6, s[8:11], s50 offen offset:0 lds
s_add_u32 m0, s46, 3968
s_nop 0
buffer_load_dwordx4 v6, s[8:11], s50 offen offset:128 lds
s_add_u32 m0, s46, 7936
s_nop 0
buffer_load_dwordx4 v6, s[8:11], s50 offen offset:256 lds
s_add_u32 m0, s46, 11904
s_nop 0
buffer_load_dwordx4 v6, s[8:11], s50 offen offset:384 lds
s_add_u32 m0, s46, 15872
s_nop 0
buffer_load_dwordx4 v6, s[8:11], s50 offen offset:512 lds
s_add_u32 m0, s46, 19840
s_nop 0
buffer_load_dwordx4 v6, s[8:11], s50 offen offset:640 lds
s_add_u32 m0, s46, 23808
s_nop 0
buffer_load_dwordx4 v6, s[8:11], s50 offen offset:768 lds
s_add_u32 m0, s46, 27776
s_nop 0
buffer_load_dwordx4 v6, s[8:11], s50 offen offset:896 lds
s_add_u32 m0, s46, 31744
s_nop 0
buffer_load_dwordx4 v6, s[8:11], s50 offen offset:1024 lds
s_add_u32 m0, s46, 35712
s_nop 0
buffer_load_dwordx4 v6, s[8:11], s50 offen offset:1152 lds
s_add_u32 m0, s46, 39680
s_nop 0
buffer_load_dwordx4 v6, s[8:11], s50 offen offset:1280 lds
s_add_u32 m0, s46, 43648
s_nop 0
buffer_load_dwordx4 v6, s[8:11], s50 offen offset:1408 lds
s_add_u32 m0, s46, 47616
s_nop 0
buffer_load_dwordx4 v6, s[8:11], s50 offen offset:1536 lds
s_add_u32 m0, s46, 51584
s_nop 0
buffer_load_dwordx4 v6, s[8:11], s50 offen offset:1664 lds
s_add_u32 m0, s46, 55552
s_nop 0
buffer_load_dwordx4 v6, s[8:11], s50 offen offset:1792 lds
s_add_u32 m0, s46, 59520
s_nop 0
buffer_load_dwordx4 v6, s[8:11], s50 offen offset:1920 lds
v_lshrrev_b32 v2, 2, v1
v_and_b32 v3, 3, v1
v_lshlrev_b32 v16, 13, v2
v_lshl_add_u32 v16, v3, 4, v16
v_add_u32 v16, s48, v16
s_mul_i32 s45, s41, 24576
s_add_u32 s45, s45, 65536
v_bfe_u32 v17, v1, 2, 2
v_lshrrev_b32 v18, 4, v1
v_lshl_add_u32 v17, v18, 3, v17
v_lshlrev_b32 v17, 6, v17
v_lshl_add_u32 v17, v3, 4, v17
v_add_u32 v17, s45, v17
s_and_b32 s43, s40, 3
s_lshl_b32 s43, s43, 2
s_add_u32 s43, s43, s41
s_lshl_b32 s43, s43, 3
v_and_b32 v12, 7, v1
v_add_u32 v12, s43, v12
s_lshr_b32 s43, s40, 2
s_lshl_b32 s43, s43, 10
s_add_u32 s44, s43, 896
s_add_u32 s43, s43, 384
s_cmp_ge_u32 s40, 28
s_cselect_b32 s44, s44, s43
v_mov_b32 v13, s43
v_mov_b32 v14, s44
v_cmp_gt_u32 vcc, 32, v1
s_nop 1
v_cndmask_b32 v13, v14, v13, vcc
v_lshl_add_u32 v12, v12, 13, v13
s_mov_b32 s44, 0
buffer_load_dword v250, v12, s[4:7], s44 offen
s_add_u32 m0, s45, 0
s_mov_b32 s44, 0
buffer_load_dwordx4 v16, s[4:7], s44 offen lds
s_add_u32 m0, s45, 1024
s_mov_b32 s44, 131072
buffer_load_dwordx4 v16, s[4:7], s44 offen lds
s_add_u32 m0, s45, 2048
s_mov_b32 s44, 262144
buffer_load_dwordx4 v16, s[4:7], s44 offen lds
s_add_u32 m0, s45, 3072
s_mov_b32 s44, 393216
buffer_load_dwordx4 v16, s[4:7], s44 offen lds
s_add_u32 m0, s45, 4096
s_mov_b32 s44, 524288
buffer_load_dwordx4 v16, s[4:7], s44 offen lds
s_add_u32 m0, s45, 5120
s_mov_b32 s44, 655360
buffer_load_dwordx4 v16, s[4:7], s44 offen lds
s_add_u32 m0, s45, 6144
s_mov_b32 s44, 786432
buffer_load_dwordx4 v16, s[4:7], s44 offen lds
s_add_u32 m0, s45, 7168
s_mov_b32 s44, 917504
buffer_load_dwordx4 v16, s[4:7], s44 offen lds
s_mov_b32 s44, 1048576
buffer_load_dword v250, v12, s[4:7], s44 offen
s_add_u32 m0, s45, 8192
s_mov_b32 s44, 1048576
buffer_load_dwordx4 v16, s[4:7], s44 offen lds
s_add_u32 m0, s45, 9216
s_mov_b32 s44, 1179648
buffer_load_dwordx4 v16, s[4:7], s44 offen lds
s_add_u32 m0, s45, 10240
s_mov_b32 s44, 1310720
buffer_load_dwordx4 v16, s[4:7], s44 offen lds
s_add_u32 m0, s45, 11264
s_mov_b32 s44, 1441792
buffer_load_dwordx4 v16, s[4:7], s44 offen lds
s_add_u32 m0, s45, 12288
s_mov_b32 s44, 1572864
buffer_load_dwordx4 v16, s[4:7], s44 offen lds
s_add_u32 m0, s45, 13312
s_mov_b32 s44, 1703936
buffer_load_dwordx4 v16, s[4:7], s44 offen lds
s_add_u32 m0, s45, 14336
s_mov_b32 s44, 1835008
buffer_load_dwordx4 v16, s[4:7], s44 offen lds
s_add_u32 m0, s45, 15360
s_mov_b32 s44, 1966080
buffer_load_dwordx4 v16, s[4:7], s44 offen lds
s_mov_b32 s44, 2097152
buffer_load_dword v250, v12, s[4:7], s44 offen
s_add_u32 m0, s45, 16384
s_mov_b32 s44, 2097152
buffer_load_dwordx4 v16, s[4:7], s44 offen lds
s_add_u32 m0, s45, 17408
s_mov_b32 s44, 2228224
buffer_load_dwordx4 v16, s[4:7], s44 offen lds
s_add_u32 m0, s45, 18432
s_mov_b32 s44, 2359296
buffer_load_dwordx4 v16, s[4:7], s44 offen lds
s_add_u32 m0, s45, 19456
s_mov_b32 s44, 2490368
buffer_load_dwordx4 v16, s[4:7], s44 offen lds
s_add_u32 m0, s45, 20480
s_mov_b32 s44, 2621440
buffer_load_dwordx4 v16, s[4:7], s44 offen lds
s_add_u32 m0, s45, 21504
s_mov_b32 s44, 2752512
buffer_load_dwordx4 v16, s[4:7], s44 offen lds
s_add_u32 m0, s45, 22528
s_mov_b32 s44, 2883584
buffer_load_dwordx4 v16, s[4:7], s44 offen lds
s_add_u32 m0, s45, 23552
s_mov_b32 s44, 3014656
buffer_load_dwordx4 v16, s[4:7], s44 offen lds
s_waitcnt vmcnt(18)
s_barrier
ds_read_b64_tr_b16 a[0:1], v17 offset:0
ds_read_b64_tr_b16 a[2:3], v17 offset:256
ds_read_b64_tr_b16 a[4:5], v17 offset:8
ds_read_b64_tr_b16 a[6:7], v17 offset:264
ds_read_b64_tr_b16 a[8:9], v17 offset:2048
ds_read_b64_tr_b16 a[10:11], v17 offset:2304
ds_read_b64_tr_b16 a[12:13], v17 offset:2056
ds_read_b64_tr_b16 a[14:15], v17 offset:2312
s_waitcnt lgkmcnt(0)
ds_read_b64_tr_b16 a[16:17], v17 offset:4096
ds_read_b64_tr_b16 a[18:19], v17 offset:4352
ds_read_b64_tr_b16 a[20:21], v17 offset:4104
ds_read_b64_tr_b16 a[22:23], v17 offset:4360
ds_read_b64_tr_b16 a[24:25], v17 offset:6144
ds_read_b64_tr_b16 a[26:27], v17 offset:6400
ds_read_b64_tr_b16 a[28:29], v17 offset:6152
ds_read_b64_tr_b16 a[30:31], v17 offset:6408
s_waitcnt lgkmcnt(0)
s_mov_b32 s44, 3145728
buffer_load_dword v250, v12, s[4:7], s44 offen
s_add_u32 m0, s45, 0
s_mov_b32 s44, 3145728
buffer_load_dwordx4 v16, s[4:7], s44 offen lds
s_add_u32 m0, s45, 1024
s_mov_b32 s44, 3276800
buffer_load_dwordx4 v16, s[4:7], s44 offen lds
s_add_u32 m0, s45, 2048
s_mov_b32 s44, 3407872
buffer_load_dwordx4 v16, s[4:7], s44 offen lds
s_add_u32 m0, s45, 3072
s_mov_b32 s44, 3538944
buffer_load_dwordx4 v16, s[4:7], s44 offen lds
s_add_u32 m0, s45, 4096
s_mov_b32 s44, 3670016
buffer_load_dwordx4 v16, s[4:7], s44 offen lds
s_add_u32 m0, s45, 5120
s_mov_b32 s44, 3801088
buffer_load_dwordx4 v16, s[4:7], s44 offen lds
s_add_u32 m0, s45, 6144
s_mov_b32 s44, 3932160
buffer_load_dwordx4 v16, s[4:7], s44 offen lds
s_add_u32 m0, s45, 7168
s_mov_b32 s44, 4063232
buffer_load_dwordx4 v16, s[4:7], s44 offen lds
ds_read_b128 v[20:23], v8 offset:0
ds_read_b128 v[24:27], v8 offset:2048
ds_read_b128 v[28:31], v9 offset:0
ds_read_b128 v[32:35], v9 offset:2048
ds_read_b128 v[36:39], v8 offset:4096
ds_read_b128 v[40:43], v8 offset:6144
ds_read_b128 v[44:47], v9 offset:4096
ds_read_b128 v[48:51], v9 offset:6144
s_waitcnt lgkmcnt(0)
v_mfma_f32_16x16x32_bf16 v[52:55], a[0:3], v[20:23], 0
v_mfma_f32_16x16x32_bf16 v[56:59], a[4:7], v[20:23], 0
v_mfma_f32_16x16x32_bf16 v[60:63], a[0:3], v[24:27], 0
v_mfma_f32_16x16x32_bf16 v[64:67], a[4:7], v[24:27], 0
v_mfma_f32_16x16x32_bf16 v[52:55], a[8:11], v[28:31], v[52:55]
v_mfma_f32_16x16x32_bf16 v[56:59], a[12:15], v[28:31], v[56:59]
v_mfma_f32_16x16x32_bf16 v[60:63], a[8:11], v[32:35], v[60:63]
v_mfma_f32_16x16x32_bf16 v[64:67], a[12:15], v[32:35], v[64:67]
v_mfma_f32_16x16x32_bf16 v[52:55], a[16:19], v[36:39], v[52:55]
v_mfma_f32_16x16x32_bf16 v[56:59], a[20:23], v[36:39], v[56:59]
v_mfma_f32_16x16x32_bf16 v[60:63], a[16:19], v[40:43], v[60:63]
v_mfma_f32_16x16x32_bf16 v[64:67], a[20:23], v[40:43], v[64:67]
v_mfma_f32_16x16x32_bf16 v[52:55], a[24:27], v[44:47], v[52:55]
v_mfma_f32_16x16x32_bf16 v[56:59], a[28:31], v[44:47], v[56:59]
v_mfma_f32_16x16x32_bf16 v[60:63], a[24:27], v[48:51], v[60:63]
v_mfma_f32_16x16x32_bf16 v[64:67], a[28:31], v[48:51], v[64:67]
s_waitcnt vmcnt(18)
ds_read_b64_tr_b16 a[32:33], v17 offset:8192
ds_read_b64_tr_b16 a[34:35], v17 offset:8448
ds_read_b64_tr_b16 a[36:37], v17 offset:8200
ds_read_b64_tr_b16 a[38:39], v17 offset:8456
ds_read_b64_tr_b16 a[40:41], v17 offset:10240
ds_read_b64_tr_b16 a[42:43], v17 offset:10496
ds_read_b64_tr_b16 a[44:45], v17 offset:10248
ds_read_b64_tr_b16 a[46:47], v17 offset:10504
s_waitcnt lgkmcnt(0)
ds_read_b64_tr_b16 a[48:49], v17 offset:12288
ds_read_b64_tr_b16 a[50:51], v17 offset:12544
ds_read_b64_tr_b16 a[52:53], v17 offset:12296
ds_read_b64_tr_b16 a[54:55], v17 offset:12552
ds_read_b64_tr_b16 a[56:57], v17 offset:14336
ds_read_b64_tr_b16 a[58:59], v17 offset:14592
ds_read_b64_tr_b16 a[60:61], v17 offset:14344
ds_read_b64_tr_b16 a[62:63], v17 offset:14600
s_waitcnt lgkmcnt(0)
s_mov_b32 s44, 4194304
buffer_load_dword v250, v12, s[4:7], s44 offen
s_add_u32 m0, s45, 8192
s_mov_b32 s44, 4194304
buffer_load_dwordx4 v16, s[4:7], s44 offen lds
s_add_u32 m0, s45, 9216
s_mov_b32 s44, 4325376
buffer_load_dwordx4 v16, s[4:7], s44 offen lds
s_add_u32 m0, s45, 10240
s_mov_b32 s44, 4456448
buffer_load_dwordx4 v16, s[4:7], s44 offen lds
s_add_u32 m0, s45, 11264
s_mov_b32 s44, 4587520
buffer_load_dwordx4 v16, s[4:7], s44 offen lds
s_add_u32 m0, s45, 12288
s_mov_b32 s44, 4718592
buffer_load_dwordx4 v16, s[4:7], s44 offen lds
s_add_u32 m0, s45, 13312
s_mov_b32 s44, 4849664
buffer_load_dwordx4 v16, s[4:7], s44 offen lds
s_add_u32 m0, s45, 14336
s_mov_b32 s44, 4980736
buffer_load_dwordx4 v16, s[4:7], s44 offen lds
s_add_u32 m0, s45, 15360
s_mov_b32 s44, 5111808
buffer_load_dwordx4 v16, s[4:7], s44 offen lds
ds_read_b128 v[20:23], v8 offset:8192
ds_read_b128 v[24:27], v8 offset:10240
ds_read_b128 v[28:31], v9 offset:8192
ds_read_b128 v[32:35], v9 offset:10240
ds_read_b128 v[36:39], v8 offset:12288
ds_read_b128 v[40:43], v8 offset:14336
ds_read_b128 v[44:47], v9 offset:12288
ds_read_b128 v[48:51], v9 offset:14336
s_waitcnt lgkmcnt(0)
v_mfma_f32_16x16x32_bf16 v[52:55], a[32:35], v[20:23], v[52:55]
v_mfma_f32_16x16x32_bf16 v[56:59], a[36:39], v[20:23], v[56:59]
v_mfma_f32_16x16x32_bf16 v[60:63], a[32:35], v[24:27], v[60:63]
v_mfma_f32_16x16x32_bf16 v[64:67], a[36:39], v[24:27], v[64:67]
v_mfma_f32_16x16x32_bf16 v[52:55], a[40:43], v[28:31], v[52:55]
v_mfma_f32_16x16x32_bf16 v[56:59], a[44:47], v[28:31], v[56:59]
v_mfma_f32_16x16x32_bf16 v[60:63], a[40:43], v[32:35], v[60:63]
v_mfma_f32_16x16x32_bf16 v[64:67], a[44:47], v[32:35], v[64:67]
v_mfma_f32_16x16x32_bf16 v[52:55], a[48:51], v[36:39], v[52:55]
v_mfma_f32_16x16x32_bf16 v[56:59], a[52:55], v[36:39], v[56:59]
v_mfma_f32_16x16x32_bf16 v[60:63], a[48:51], v[40:43], v[60:63]
v_mfma_f32_16x16x32_bf16 v[64:67], a[52:55], v[40:43], v[64:67]
v_mfma_f32_16x16x32_bf16 v[52:55], a[56:59], v[44:47], v[52:55]
v_mfma_f32_16x16x32_bf16 v[56:59], a[60:63], v[44:47], v[56:59]
v_mfma_f32_16x16x32_bf16 v[60:63], a[56:59], v[48:51], v[60:63]
v_mfma_f32_16x16x32_bf16 v[64:67], a[60:63], v[48:51], v[64:67]
s_waitcnt vmcnt(18)
ds_read_b64_tr_b16 a[64:65], v17 offset:16384
ds_read_b64_tr_b16 a[66:67], v17 offset:16640
ds_read_b64_tr_b16 a[68:69], v17 offset:16392
ds_read_b64_tr_b16 a[70:71], v17 offset:16648
ds_read_b64_tr_b16 a[72:73], v17 offset:18432
ds_read_b64_tr_b16 a[74:75], v17 offset:18688
ds_read_b64_tr_b16 a[76:77], v17 offset:18440
ds_read_b64_tr_b16 a[78:79], v17 offset:18696
s_waitcnt lgkmcnt(0)
ds_read_b64_tr_b16 a[80:81], v17 offset:20480
ds_read_b64_tr_b16 a[82:83], v17 offset:20736
ds_read_b64_tr_b16 a[84:85], v17 offset:20488
ds_read_b64_tr_b16 a[86:87], v17 offset:20744
ds_read_b64_tr_b16 a[88:89], v17 offset:22528
ds_read_b64_tr_b16 a[90:91], v17 offset:22784
ds_read_b64_tr_b16 a[92:93], v17 offset:22536
ds_read_b64_tr_b16 a[94:95], v17 offset:22792
s_waitcnt lgkmcnt(0)
s_mov_b32 s44, 5242880
buffer_load_dword v250, v12, s[4:7], s44 offen
s_add_u32 m0, s45, 16384
s_mov_b32 s44, 5242880
buffer_load_dwordx4 v16, s[4:7], s44 offen lds
s_add_u32 m0, s45, 17408
s_mov_b32 s44, 5373952
buffer_load_dwordx4 v16, s[4:7], s44 offen lds
s_add_u32 m0, s45, 18432
s_mov_b32 s44, 5505024
buffer_load_dwordx4 v16, s[4:7], s44 offen lds
s_add_u32 m0, s45, 19456
s_mov_b32 s44, 5636096
buffer_load_dwordx4 v16, s[4:7], s44 offen lds
s_add_u32 m0, s45, 20480
s_mov_b32 s44, 5767168
buffer_load_dwordx4 v16, s[4:7], s44 offen lds
s_add_u32 m0, s45, 21504
s_mov_b32 s44, 5898240
buffer_load_dwordx4 v16, s[4:7], s44 offen lds
s_add_u32 m0, s45, 22528
s_mov_b32 s44, 6029312
buffer_load_dwordx4 v16, s[4:7], s44 offen lds
s_add_u32 m0, s45, 23552
s_mov_b32 s44, 6160384
buffer_load_dwordx4 v16, s[4:7], s44 offen lds
ds_read_b128 v[20:23], v8 offset:16384
ds_read_b128 v[24:27], v8 offset:18432
ds_read_b128 v[28:31], v9 offset:16384
ds_read_b128 v[32:35], v9 offset:18432
ds_read_b128 v[36:39], v8 offset:20480
ds_read_b128 v[40:43], v8 offset:22528
ds_read_b128 v[44:47], v9 offset:20480
ds_read_b128 v[48:51], v9 offset:22528
s_waitcnt lgkmcnt(0)
v_mfma_f32_16x16x32_bf16 v[52:55], a[64:67], v[20:23], v[52:55]
v_mfma_f32_16x16x32_bf16 v[56:59], a[68:71], v[20:23], v[56:59]
v_mfma_f32_16x16x32_bf16 v[60:63], a[64:67], v[24:27], v[60:63]
v_mfma_f32_16x16x32_bf16 v[64:67], a[68:71], v[24:27], v[64:67]
v_mfma_f32_16x16x32_bf16 v[52:55], a[72:75], v[28:31], v[52:55]
v_mfma_f32_16x16x32_bf16 v[56:59], a[76:79], v[28:31], v[56:59]
v_mfma_f32_16x16x32_bf16 v[60:63], a[72:75], v[32:35], v[60:63]
v_mfma_f32_16x16x32_bf16 v[64:67], a[76:79], v[32:35], v[64:67]
v_mfma_f32_16x16x32_bf16 v[52:55], a[80:83], v[36:39], v[52:55]
v_mfma_f32_16x16x32_bf16 v[56:59], a[84:87], v[36:39], v[56:59]
v_mfma_f32_16x16x32_bf16 v[60:63], a[80:83], v[40:43], v[60:63]
v_mfma_f32_16x16x32_bf16 v[64:67], a[84:87], v[40:43], v[64:67]
v_mfma_f32_16x16x32_bf16 v[52:55], a[88:91], v[44:47], v[52:55]
v_mfma_f32_16x16x32_bf16 v[56:59], a[92:95], v[44:47], v[56:59]
v_mfma_f32_16x16x32_bf16 v[60:63], a[88:91], v[48:51], v[60:63]
v_mfma_f32_16x16x32_bf16 v[64:67], a[92:95], v[48:51], v[64:67]
s_waitcnt vmcnt(18)
ds_read_b64_tr_b16 a[96:97], v17 offset:0
ds_read_b64_tr_b16 a[98:99], v17 offset:256
ds_read_b64_tr_b16 a[100:101], v17 offset:8
ds_read_b64_tr_b16 a[102:103], v17 offset:264
ds_read_b64_tr_b16 a[104:105], v17 offset:2048
ds_read_b64_tr_b16 a[106:107], v17 offset:2304
ds_read_b64_tr_b16 a[108:109], v17 offset:2056
ds_read_b64_tr_b16 a[110:111], v17 offset:2312
s_waitcnt lgkmcnt(0)
ds_read_b64_tr_b16 a[112:113], v17 offset:4096
ds_read_b64_tr_b16 a[114:115], v17 offset:4352
ds_read_b64_tr_b16 a[116:117], v17 offset:4104
ds_read_b64_tr_b16 a[118:119], v17 offset:4360
ds_read_b64_tr_b16 a[120:121], v17 offset:6144
ds_read_b64_tr_b16 a[122:123], v17 offset:6400
ds_read_b64_tr_b16 a[124:125], v17 offset:6152
ds_read_b64_tr_b16 a[126:127], v17 offset:6408
s_waitcnt lgkmcnt(0)
s_mov_b32 s44, 6291456
buffer_load_dword v250, v12, s[4:7], s44 offen
s_add_u32 m0, s45, 0
s_mov_b32 s44, 6291456
buffer_load_dwordx4 v16, s[4:7], s44 offen lds
s_add_u32 m0, s45, 1024
s_mov_b32 s44, 6422528
buffer_load_dwordx4 v16, s[4:7], s44 offen lds
s_add_u32 m0, s45, 2048
s_mov_b32 s44, 6553600
buffer_load_dwordx4 v16, s[4:7], s44 offen lds
s_add_u32 m0, s45, 3072
s_mov_b32 s44, 6684672
buffer_load_dwordx4 v16, s[4:7], s44 offen lds
s_add_u32 m0, s45, 4096
s_mov_b32 s44, 6815744
buffer_load_dwordx4 v16, s[4:7], s44 offen lds
s_add_u32 m0, s45, 5120
s_mov_b32 s44, 6946816
buffer_load_dwordx4 v16, s[4:7], s44 offen lds
s_add_u32 m0, s45, 6144
s_mov_b32 s44, 7077888
buffer_load_dwordx4 v16, s[4:7], s44 offen lds
s_add_u32 m0, s45, 7168
s_mov_b32 s44, 7208960
buffer_load_dwordx4 v16, s[4:7], s44 offen lds
ds_read_b128 v[20:23], v8 offset:24576
ds_read_b128 v[24:27], v8 offset:26624
ds_read_b128 v[28:31], v9 offset:24576
ds_read_b128 v[32:35], v9 offset:26624
ds_read_b128 v[36:39], v8 offset:28672
ds_read_b128 v[40:43], v8 offset:30720
ds_read_b128 v[44:47], v9 offset:28672
ds_read_b128 v[48:51], v9 offset:30720
s_waitcnt lgkmcnt(0)
v_mfma_f32_16x16x32_bf16 v[52:55], a[96:99], v[20:23], v[52:55]
v_mfma_f32_16x16x32_bf16 v[56:59], a[100:103], v[20:23], v[56:59]
v_mfma_f32_16x16x32_bf16 v[60:63], a[96:99], v[24:27], v[60:63]
v_mfma_f32_16x16x32_bf16 v[64:67], a[100:103], v[24:27], v[64:67]
v_mfma_f32_16x16x32_bf16 v[52:55], a[104:107], v[28:31], v[52:55]
v_mfma_f32_16x16x32_bf16 v[56:59], a[108:111], v[28:31], v[56:59]
v_mfma_f32_16x16x32_bf16 v[60:63], a[104:107], v[32:35], v[60:63]
v_mfma_f32_16x16x32_bf16 v[64:67], a[108:111], v[32:35], v[64:67]
v_mfma_f32_16x16x32_bf16 v[52:55], a[112:115], v[36:39], v[52:55]
v_mfma_f32_16x16x32_bf16 v[56:59], a[116:119], v[36:39], v[56:59]
v_mfma_f32_16x16x32_bf16 v[60:63], a[112:115], v[40:43], v[60:63]
v_mfma_f32_16x16x32_bf16 v[64:67], a[116:119], v[40:43], v[64:67]
v_mfma_f32_16x16x32_bf16 v[52:55], a[120:123], v[44:47], v[52:55]
v_mfma_f32_16x16x32_bf16 v[56:59], a[124:127], v[44:47], v[56:59]
v_mfma_f32_16x16x32_bf16 v[60:63], a[120:123], v[48:51], v[60:63]
v_mfma_f32_16x16x32_bf16 v[64:67], a[124:127], v[48:51], v[64:67]
s_waitcnt vmcnt(18)
ds_read_b64_tr_b16 a[128:129], v17 offset:8192
ds_read_b64_tr_b16 a[130:131], v17 offset:8448
ds_read_b64_tr_b16 a[132:133], v17 offset:8200
ds_read_b64_tr_b16 a[134:135], v17 offset:8456
ds_read_b64_tr_b16 a[136:137], v17 offset:10240
ds_read_b64_tr_b16 a[138:139], v17 offset:10496
ds_read_b64_tr_b16 a[140:141], v17 offset:10248
ds_read_b64_tr_b16 a[142:143], v17 offset:10504
s_waitcnt lgkmcnt(0)
ds_read_b64_tr_b16 a[144:145], v17 offset:12288
ds_read_b64_tr_b16 a[146:147], v17 offset:12544
ds_read_b64_tr_b16 a[148:149], v17 offset:12296
ds_read_b64_tr_b16 a[150:151], v17 offset:12552
ds_read_b64_tr_b16 a[152:153], v17 offset:14336
ds_read_b64_tr_b16 a[154:155], v17 offset:14592
ds_read_b64_tr_b16 a[156:157], v17 offset:14344
ds_read_b64_tr_b16 a[158:159], v17 offset:14600
s_waitcnt lgkmcnt(0)
s_mov_b32 s44, 7340032
buffer_load_dword v250, v12, s[4:7], s44 offen
s_add_u32 m0, s45, 8192
s_mov_b32 s44, 7340032
buffer_load_dwordx4 v16, s[4:7], s44 offen lds
s_add_u32 m0, s45, 9216
s_mov_b32 s44, 7471104
buffer_load_dwordx4 v16, s[4:7], s44 offen lds
s_add_u32 m0, s45, 10240
s_mov_b32 s44, 7602176
buffer_load_dwordx4 v16, s[4:7], s44 offen lds
s_add_u32 m0, s45, 11264
s_mov_b32 s44, 7733248
buffer_load_dwordx4 v16, s[4:7], s44 offen lds
s_add_u32 m0, s45, 12288
s_mov_b32 s44, 7864320
buffer_load_dwordx4 v16, s[4:7], s44 offen lds
s_add_u32 m0, s45, 13312
s_mov_b32 s44, 7995392
buffer_load_dwordx4 v16, s[4:7], s44 offen lds
s_add_u32 m0, s45, 14336
s_mov_b32 s44, 8126464
buffer_load_dwordx4 v16, s[4:7], s44 offen lds
s_add_u32 m0, s45, 15360
s_mov_b32 s44, 8257536
buffer_load_dwordx4 v16, s[4:7], s44 offen lds
ds_read_b128 v[20:23], v8 offset:32768
ds_read_b128 v[24:27], v8 offset:34816
ds_read_b128 v[28:31], v9 offset:32768
ds_read_b128 v[32:35], v9 offset:34816
ds_read_b128 v[36:39], v8 offset:36864
ds_read_b128 v[40:43], v8 offset:38912
ds_read_b128 v[44:47], v9 offset:36864
ds_read_b128 v[48:51], v9 offset:38912
s_waitcnt lgkmcnt(0)
v_mfma_f32_16x16x32_bf16 v[52:55], a[128:131], v[20:23], v[52:55]
v_mfma_f32_16x16x32_bf16 v[56:59], a[132:135], v[20:23], v[56:59]
v_mfma_f32_16x16x32_bf16 v[60:63], a[128:131], v[24:27], v[60:63]
v_mfma_f32_16x16x32_bf16 v[64:67], a[132:135], v[24:27], v[64:67]
v_mfma_f32_16x16x32_bf16 v[52:55], a[136:139], v[28:31], v[52:55]
v_mfma_f32_16x16x32_bf16 v[56:59], a[140:143], v[28:31], v[56:59]
v_mfma_f32_16x16x32_bf16 v[60:63], a[136:139], v[32:35], v[60:63]
v_mfma_f32_16x16x32_bf16 v[64:67], a[140:143], v[32:35], v[64:67]
v_mfma_f32_16x16x32_bf16 v[52:55], a[144:147], v[36:39], v[52:55]
v_mfma_f32_16x16x32_bf16 v[56:59], a[148:151], v[36:39], v[56:59]
v_mfma_f32_16x16x32_bf16 v[60:63], a[144:147], v[40:43], v[60:63]
v_mfma_f32_16x16x32_bf16 v[64:67], a[148:151], v[40:43], v[64:67]
v_mfma_f32_16x16x32_bf16 v[52:55], a[152:155], v[44:47], v[52:55]
v_mfma_f32_16x16x32_bf16 v[56:59], a[156:159], v[44:47], v[56:59]
v_mfma_f32_16x16x32_bf16 v[60:63], a[152:155], v[48:51], v[60:63]
v_mfma_f32_16x16x32_bf16 v[64:67], a[156:159], v[48:51], v[64:67]
s_waitcnt vmcnt(18)
ds_read_b64_tr_b16 a[160:161], v17 offset:16384
ds_read_b64_tr_b16 a[162:163], v17 offset:16640
ds_read_b64_tr_b16 a[164:165], v17 offset:16392
ds_read_b64_tr_b16 a[166:167], v17 offset:16648
ds_read_b64_tr_b16 a[168:169], v17 offset:18432
ds_read_b64_tr_b16 a[170:171], v17 offset:18688
ds_read_b64_tr_b16 a[172:173], v17 offset:18440
ds_read_b64_tr_b16 a[174:175], v17 offset:18696
s_waitcnt lgkmcnt(0)
ds_read_b64_tr_b16 a[176:177], v17 offset:20480
ds_read_b64_tr_b16 a[178:179], v17 offset:20736
ds_read_b64_tr_b16 a[180:181], v17 offset:20488
ds_read_b64_tr_b16 a[182:183], v17 offset:20744
ds_read_b64_tr_b16 a[184:185], v17 offset:22528
ds_read_b64_tr_b16 a[186:187], v17 offset:22784
ds_read_b64_tr_b16 a[188:189], v17 offset:22536
ds_read_b64_tr_b16 a[190:191], v17 offset:22792
s_waitcnt lgkmcnt(0)
ds_read_b128 v[20:23], v8 offset:40960
ds_read_b128 v[24:27], v8 offset:43008
ds_read_b128 v[28:31], v9 offset:40960
ds_read_b128 v[32:35], v9 offset:43008
ds_read_b128 v[36:39], v8 offset:45056
ds_read_b128 v[40:43], v8 offset:47104
ds_read_b128 v[44:47], v9 offset:45056
ds_read_b128 v[48:51], v9 offset:47104
s_waitcnt lgkmcnt(0)
v_mfma_f32_16x16x32_bf16 v[52:55], a[160:163], v[20:23], v[52:55]
v_mfma_f32_16x16x32_bf16 v[56:59], a[164:167], v[20:23], v[56:59]
v_mfma_f32_16x16x32_bf16 v[60:63], a[160:163], v[24:27], v[60:63]
v_mfma_f32_16x16x32_bf16 v[64:67], a[164:167], v[24:27], v[64:67]
v_mfma_f32_16x16x32_bf16 v[52:55], a[168:171], v[28:31], v[52:55]
v_mfma_f32_16x16x32_bf16 v[56:59], a[172:175], v[28:31], v[56:59]
v_mfma_f32_16x16x32_bf16 v[60:63], a[168:171], v[32:35], v[60:63]
v_mfma_f32_16x16x32_bf16 v[64:67], a[172:175], v[32:35], v[64:67]
v_mfma_f32_16x16x32_bf16 v[52:55], a[176:179], v[36:39], v[52:55]
v_mfma_f32_16x16x32_bf16 v[56:59], a[180:183], v[36:39], v[56:59]
v_mfma_f32_16x16x32_bf16 v[60:63], a[176:179], v[40:43], v[60:63]
v_mfma_f32_16x16x32_bf16 v[64:67], a[180:183], v[40:43], v[64:67]
v_mfma_f32_16x16x32_bf16 v[52:55], a[184:187], v[44:47], v[52:55]
v_mfma_f32_16x16x32_bf16 v[56:59], a[188:191], v[44:47], v[56:59]
v_mfma_f32_16x16x32_bf16 v[60:63], a[184:187], v[48:51], v[60:63]
v_mfma_f32_16x16x32_bf16 v[64:67], a[188:191], v[48:51], v[64:67]
s_waitcnt vmcnt(9)
ds_read_b64_tr_b16 a[192:193], v17 offset:0
ds_read_b64_tr_b16 a[194:195], v17 offset:256
ds_read_b64_tr_b16 a[196:197], v17 offset:8
ds_read_b64_tr_b16 a[198:199], v17 offset:264
ds_read_b64_tr_b16 a[200:201], v17 offset:2048
ds_read_b64_tr_b16 a[202:203], v17 offset:2304
ds_read_b64_tr_b16 a[204:205], v17 offset:2056
ds_read_b64_tr_b16 a[206:207], v17 offset:2312
s_waitcnt lgkmcnt(0)
ds_read_b64_tr_b16 a[208:209], v17 offset:4096
ds_read_b64_tr_b16 a[210:211], v17 offset:4352
ds_read_b64_tr_b16 a[212:213], v17 offset:4104
ds_read_b64_tr_b16 a[214:215], v17 offset:4360
ds_read_b64_tr_b16 a[216:217], v17 offset:6144
ds_read_b64_tr_b16 a[218:219], v17 offset:6400
ds_read_b64_tr_b16 a[220:221], v17 offset:6152
ds_read_b64_tr_b16 a[222:223], v17 offset:6408
s_waitcnt lgkmcnt(0)
ds_read_b128 v[20:23], v8 offset:49152
ds_read_b128 v[24:27], v8 offset:51200
ds_read_b128 v[28:31], v9 offset:49152
ds_read_b128 v[32:35], v9 offset:51200
ds_read_b128 v[36:39], v8 offset:53248
ds_read_b128 v[40:43], v8 offset:55296
ds_read_b128 v[44:47], v9 offset:53248
ds_read_b128 v[48:51], v9 offset:55296
s_waitcnt lgkmcnt(0)
v_mfma_f32_16x16x32_bf16 v[52:55], a[192:195], v[20:23], v[52:55]
v_mfma_f32_16x16x32_bf16 v[56:59], a[196:199], v[20:23], v[56:59]
v_mfma_f32_16x16x32_bf16 v[60:63], a[192:195], v[24:27], v[60:63]
v_mfma_f32_16x16x32_bf16 v[64:67], a[196:199], v[24:27], v[64:67]
v_mfma_f32_16x16x32_bf16 v[52:55], a[200:203], v[28:31], v[52:55]
v_mfma_f32_16x16x32_bf16 v[56:59], a[204:207], v[28:31], v[56:59]
v_mfma_f32_16x16x32_bf16 v[60:63], a[200:203], v[32:35], v[60:63]
v_mfma_f32_16x16x32_bf16 v[64:67], a[204:207], v[32:35], v[64:67]
v_mfma_f32_16x16x32_bf16 v[52:55], a[208:211], v[36:39], v[52:55]
v_mfma_f32_16x16x32_bf16 v[56:59], a[212:215], v[36:39], v[56:59]
v_mfma_f32_16x16x32_bf16 v[60:63], a[208:211], v[40:43], v[60:63]
v_mfma_f32_16x16x32_bf16 v[64:67], a[212:215], v[40:43], v[64:67]
v_mfma_f32_16x16x32_bf16 v[52:55], a[216:219], v[44:47], v[52:55]
v_mfma_f32_16x16x32_bf16 v[56:59], a[220:223], v[44:47], v[56:59]
v_mfma_f32_16x16x32_bf16 v[60:63], a[216:219], v[48:51], v[60:63]
v_mfma_f32_16x16x32_bf16 v[64:67], a[220:223], v[48:51], v[64:67]
s_waitcnt vmcnt(0)
ds_read_b64_tr_b16 a[224:225], v17 offset:8192
ds_read_b64_tr_b16 a[226:227], v17 offset:8448
ds_read_b64_tr_b16 a[228:229], v17 offset:8200
ds_read_b64_tr_b16 a[230:231], v17 offset:8456
ds_read_b64_tr_b16 a[232:233], v17 offset:10240
ds_read_b64_tr_b16 a[234:235], v17 offset:10496
ds_read_b64_tr_b16 a[236:237], v17 offset:10248
ds_read_b64_tr_b16 a[238:239], v17 offset:10504
s_waitcnt lgkmcnt(0)
ds_read_b64_tr_b16 a[240:241], v17 offset:12288
ds_read_b64_tr_b16 a[242:243], v17 offset:12544
ds_read_b64_tr_b16 a[244:245], v17 offset:12296
ds_read_b64_tr_b16 a[246:247], v17 offset:12552
ds_read_b64_tr_b16 a[248:249], v17 offset:14336
ds_read_b64_tr_b16 a[250:251], v17 offset:14592
ds_read_b64_tr_b16 a[252:253], v17 offset:14344
ds_read_b64_tr_b16 a[254:255], v17 offset:14600
s_waitcnt lgkmcnt(0)
ds_read_b128 v[20:23], v8 offset:57344
ds_read_b128 v[24:27], v8 offset:59392
ds_read_b128 v[28:31], v9 offset:57344
ds_read_b128 v[32:35], v9 offset:59392
ds_read_b128 v[36:39], v8 offset:61440
ds_read_b128 v[40:43], v8 offset:63488
ds_read_b128 v[44:47], v9 offset:61440
ds_read_b128 v[48:51], v9 offset:63488
s_waitcnt lgkmcnt(0)
v_mfma_f32_16x16x32_bf16 v[52:55], a[224:227], v[20:23], v[52:55]
v_mfma_f32_16x16x32_bf16 v[56:59], a[228:231], v[20:23], v[56:59]
v_mfma_f32_16x16x32_bf16 v[60:63], a[224:227], v[24:27], v[60:63]
v_mfma_f32_16x16x32_bf16 v[64:67], a[228:231], v[24:27], v[64:67]
v_mfma_f32_16x16x32_bf16 v[52:55], a[232:235], v[28:31], v[52:55]
v_mfma_f32_16x16x32_bf16 v[56:59], a[236:239], v[28:31], v[56:59]
v_mfma_f32_16x16x32_bf16 v[60:63], a[232:235], v[32:35], v[60:63]
v_mfma_f32_16x16x32_bf16 v[64:67], a[236:239], v[32:35], v[64:67]
v_mfma_f32_16x16x32_bf16 v[52:55], a[240:243], v[36:39], v[52:55]
v_mfma_f32_16x16x32_bf16 v[56:59], a[244:247], v[36:39], v[56:59]
v_mfma_f32_16x16x32_bf16 v[60:63], a[240:243], v[40:43], v[60:63]
v_mfma_f32_16x16x32_bf16 v[64:67], a[244:247], v[40:43], v[64:67]
v_mfma_f32_16x16x32_bf16 v[52:55], a[248:251], v[44:47], v[52:55]
v_mfma_f32_16x16x32_bf16 v[56:59], a[252:255], v[44:47], v[56:59]
v_mfma_f32_16x16x32_bf16 v[60:63], a[248:251], v[48:51], v[60:63]
v_mfma_f32_16x16x32_bf16 v[64:67], a[252:255], v[48:51], v[64:67]
s_barrier
s_mov_b32 s50, 0x10000
s_add_u32 m0, s46, 65536
s_nop 0
buffer_load_dwordx4 v6, s[8:11], s50 offen offset:0 lds
s_add_u32 m0, s46, 69504
s_nop 0
buffer_load_dwordx4 v6, s[8:11], s50 offen offset:128 lds
s_add_u32 m0, s46, 73472
s_nop 0
buffer_load_dwordx4 v6, s[8:11], s50 offen offset:256 lds
s_add_u32 m0, s46, 77440
s_nop 0
buffer_load_dwordx4 v6, s[8:11], s50 offen offset:384 lds
s_add_u32 m0, s46, 81408
s_nop 0
buffer_load_dwordx4 v6, s[8:11], s50 offen offset:512 lds
s_add_u32 m0, s46, 85376
s_nop 0
buffer_load_dwordx4 v6, s[8:11], s50 offen offset:640 lds
s_add_u32 m0, s46, 89344
s_nop 0
buffer_load_dwordx4 v6, s[8:11], s50 offen offset:768 lds
s_add_u32 m0, s46, 93312
s_nop 0
buffer_load_dwordx4 v6, s[8:11], s50 offen offset:896 lds
s_add_u32 m0, s46, 97280
s_nop 0
buffer_load_dwordx4 v6, s[8:11], s50 offen offset:1024 lds
s_add_u32 m0, s46, 101248
s_nop 0
buffer_load_dwordx4 v6, s[8:11], s50 offen offset:1152 lds
s_add_u32 m0, s46, 105216
s_nop 0
buffer_load_dwordx4 v6, s[8:11], s50 offen offset:1280 lds
s_add_u32 m0, s46, 109184
s_nop 0
buffer_load_dwordx4 v6, s[8:11], s50 offen offset:1408 lds
s_add_u32 m0, s46, 113152
s_nop 0
buffer_load_dwordx4 v6, s[8:11], s50 offen offset:1536 lds
s_add_u32 m0, s46, 117120
s_nop 0
buffer_load_dwordx4 v6, s[8:11], s50 offen offset:1664 lds
s_add_u32 m0, s46, 121088
s_nop 0
buffer_load_dwordx4 v6, s[8:11], s50 offen offset:1792 lds
s_add_u32 m0, s46, 125056
s_nop 0
buffer_load_dwordx4 v6, s[8:11], s50 offen offset:1920 lds
v_lshrrev_b32 v92, 4, v1
v_and_b32 v93, 15, v1
s_and_b32 s52, s41, 1
s_lshr_b32 s53, s41, 1
s_mov_b32 s54, 0x3e0293ee
s_mov_b32 s55, 0
s_mov_b32 s56, 0
v_mov_b32 v97, 0xff800000
v_mov_b32 v241, 0xceabdc6e
v_and_b32 v2, 7, v93
v_lshlrev_b32 v94, 7, v92
v_lshl_add_u32 v94, v2, 4, v94
v_and_b32 v2, 31, v1
v_lshlrev_b32 v95, 3, v2
v_lshrrev_b32 v2, 1, v92
v_lshlrev_b32 v96, 10, v2
v_and_b32 v2, 1, v92
v_lshl_add_u32 v96, v2, 9, v96
v_lshl_add_u32 v96, v93, 4, v96
s_lshl_b32 s43, s40, 13
s_lshl_b32 s44, s53, 12
s_add_u32 s43, s43, s44
s_lshl_b32 s44, s52, 8
s_add_u32 s43, s43, s44
s_add_u32 s43, s43, 134217728
v_add_u32 v96, s43, v96
s_lshl_b32 s43, s52, 4
v_add_u32 v98, s43, v93
v_lshlrev_b32 v2, 2, v92
v_sub_u32 v98, v98, v2
s_mov_b32 s28, 0
s_mov_b32 s29, -1
s_xor_b32 s44, s98, 1
s_lshl_b32 s44, s44, 13
s_lshl_b32 s43, s40, 7
s_add_u32 s43, s43, s44
s_add_u32 s43, s43, 69206016
v_and_b32 v2, 3, v1
v_bfe_u32 v3, v1, 2, 1
v_lshlrev_b32 v99, 12, v3
v_lshl_add_u32 v99, v2, 2, v99
v_add_u32 v99, s43, v99
s_xor_b32 s62, s98, 1
s_lshl_b32 s62, s62, 13
s_lshr_b32 s44, s47, 6
s_lshl_b32 s44, s44, 14
s_add_u32 s62, s62, s44
s_and_b32 s44, s47, 63
s_lshl_b32 s44, s44, 7
s_add_u32 s62, s62, s44
s_add_u32 s62, s62, 69222400
s_lshl_b32 s49, s40, 7
s_lshl_b32 s44, s41, 2
s_add_u32 s49, s49, s44
s_lshl_b32 s44, s98, 13
s_add_u32 s49, s49, s44
s_add_u32 s49, s49, 69255168
s_lshl_b32 s43, s41, 11
s_add_u32 s43, s43, 131072
v_add_u32 v101, s43, v7
s_lshl_b32 s43, s52, 10
s_add_u32 s43, s43, 131072
v_add_u32 v102, s43, v5
v_mov_b32 v16, 0
s_mov_b32 s50, 0
v_mov_b32 v104, 0x3f803f80
v_mov_b32 v105, 0x3f803f80
v_mov_b32 v106, 0x3f803f80
v_mov_b32 v107, 0x3f803f80
v_cmp_gt_i32 s[12:13], 0, v98
v_cmp_gt_i32 s[14:15], 1, v98
v_cmp_gt_i32 s[16:17], 2, v98
v_cmp_gt_i32 s[18:19], 3, v98
v_cmp_gt_i32 s[20:21], 16, v98
v_cmp_gt_i32 s[22:23], 17, v98
v_cmp_gt_i32 s[24:25], 18, v98
v_cmp_gt_i32 s[26:27], 19, v98
s_lshr_b32 s44, s47, 3
s_xor_b32 s44, s44, s98
s_and_b32 s44, s44, 1
s_lshl_b32 s44, s44, 13
s_lshl_b32 s58, s47, 18
s_add_u32 s58, s58, s44
s_add_u32 s58, s58, 0
s_lshr_b32 s44, s47, 4
s_xor_b32 s44, s44, s98
s_and_b32 s44, s44, 1
s_lshl_b32 s44, s44, 13
s_lshl_b32 s59, s47, 17
s_add_u32 s59, s59, s44
s_add_u32 s59, s59, 71303168
s_lshl_b32 s60, s41, 11
s_add_u32 s60, s60, 139264
s_lshl_b32 s61, s41, 10
s_add_u32 s61, s61, 155648
v_add_u32 v94, 155648, v94
s_lshl_b32 s43, s53, 11
s_add_u32 s43, s43, 156160
v_add_u32 v95, s43, v95
v_add_u32 v103, 139264, v5
s_lshl_b32 s43, s53, 12
s_add_u32 s43, s43, 147456
v_add_u32 v240, s43, v5
s_waitcnt vmcnt(0)
v_mov_b32 v68, v52
v_mov_b32 v69, v53
v_mov_b32 v70, v54
v_mov_b32 v71, v55
v_mov_b32 v72, v56
v_mov_b32 v73, v57
v_mov_b32 v74, v58
v_mov_b32 v75, v59
v_mov_b32 v76, v60
v_mov_b32 v77, v61
v_mov_b32 v78, v62
v_mov_b32 v79, v63
v_mov_b32 v80, v64
v_mov_b32 v81, v65
v_mov_b32 v82, v66
v_mov_b32 v83, v67
mega_kernel_q_loop:
s_barrier
s_cmp_gt_i32 s55, s42
s_cbranch_scc1 mega_kernel_q_kv1k
mega_kernel_q_kv1w:
v_mov_b32 v2, 0
s_mov_b64 exec, 0xff
buffer_atomic_add v2, v99, s[84:87], 0 offen sc0 sc1
s_mov_b64 exec, -1
s_waitcnt vmcnt(0)
v_min_i32_dpp v2, v2, v2 quad_perm:[1,0,3,2] row_mask:0xf bank_mask:0xf
s_nop 1
v_min_i32_dpp v2, v2, v2 quad_perm:[2,3,0,1] row_mask:0xf bank_mask:0xf
s_nop 1
v_min_i32_dpp v2, v2, v2 row_half_mirror row_mask:0xf bank_mask:0xf
s_nop 0
v_readfirstlane_b32 s55, v2
s_cmp_gt_i32 s55, s42
s_cbranch_scc1 mega_kernel_q_kv1k
s_sleep 4
s_branch mega_kernel_q_kv1w
mega_kernel_q_kv1k:
ds_read_b128 v[20:23], v10 offset:0
ds_read_b128 v[24:27], v10 offset:2048
ds_read_b128 v[28:31], v11 offset:0
ds_read_b128 v[32:35], v11 offset:2048
ds_read_b128 v[36:39], v10 offset:4096
ds_read_b128 v[40:43], v10 offset:6144
s_add_u32 s51, s47, s42
s_bfe_u32 s57, s51, 0x40002
s_lshl_b32 s57, s57, 14
s_and_b32 s66, s51, 3
s_lshl_b32 s66, s66, 11
s_add_u32 s66, s66, s57
s_add_u32 s66, s66, s58
s_add_u32 s67, s66, 33554432
s_bfe_u32 s57, s51, 0x30003
s_lshl_b32 s57, s57, 14
s_and_b32 s68, s51, 7
s_lshl_b32 s68, s68, 10
s_add_u32 s68, s68, s57
s_add_u32 s68, s68, s59
s_add_u32 s50, s42, 2
s_min_u32 s50, s50, 63
s_lshl_b32 s50, s50, 16
s_cmp_gt_i32 s56, s42
s_cselect_b32 s30, 1, 0
s_add_u32 m0, s60, 0
s_waitcnt lgkmcnt(4)
v_mfma_f32_16x16x32_bf16 v[52:55], a[0:3], v[20:23], 0
ds_read_b128 v[44:47], v11 offset:4096
v_mfma_f32_16x16x32_bf16 v[56:59], a[4:7], v[20:23], 0
buffer_load_dwordx4 v5, s[84:87], s66 offen offset:0 sc1 lds
v_mfma_f32_16x16x32_bf16 v[60:63], a[0:3], v[24:27], 0
ds_read_b128 v[48:51], v11 offset:6144
v_mfma_f32_16x16x32_bf16 v[64:67], a[4:7], v[24:27], 0
s_add_u32 m0, s60, 0
s_waitcnt lgkmcnt(4)
v_mfma_f32_16x16x32_bf16 v[52:55], a[8:11], v[28:31], v[52:55]
ds_read_b128 v[20:23], v10 offset:8192
v_mfma_f32_16x16x32_bf16 v[56:59], a[12:15], v[28:31], v[56:59]
buffer_load_dwordx4 v5, s[84:87], s66 offen offset:1024 sc1 lds
v_mfma_f32_16x16x32_bf16 v[60:63], a[8:11], v[32:35], v[60:63]
ds_read_b128 v[24:27], v10 offset:10240
v_mfma_f32_16x16x32_bf16 v[64:67], a[12:15], v[32:35], v[64:67]
s_add_u32 m0, s60, 8192
s_waitcnt lgkmcnt(4)
v_mfma_f32_16x16x32_bf16 v[52:55], a[16:19], v[36:39], v[52:55]
ds_read_b128 v[28:31], v11 offset:8192
v_mfma_f32_16x16x32_bf16 v[56:59], a[20:23], v[36:39], v[56:59]
buffer_load_dwordx4 v5, s[84:87], s67 offen offset:0 sc1 lds
v_mfma_f32_16x16x32_bf16 v[60:63], a[16:19], v[40:43], v[60:63]
ds_read_b128 v[32:35], v11 offset:10240
v_mfma_f32_16x16x32_bf16 v[64:67], a[20:23], v[40:43], v[64:67]
s_add_u32 m0, s60, 8192
s_waitcnt lgkmcnt(4)
v_mfma_f32_16x16x32_bf16 v[52:55], a[24:27], v[44:47], v[52:55]
ds_read_b128 v[36:39], v10 offset:12288
v_mfma_f32_16x16x32_bf16 v[56:59], a[28:31], v[44:47], v[56:59]
buffer_load_dwordx4 v5, s[84:87], s67 offen offset:1024 sc1 lds
v_mfma_f32_16x16x32_bf16 v[60:63], a[24:27], v[48:51], v[60:63]
ds_read_b128 v[40:43], v10 offset:14336
v_mfma_f32_16x16x32_bf16 v[64:67], a[28:31], v[48:51], v[64:67]
s_waitcnt lgkmcnt(4)
v_mfma_f32_16x16x32_bf16 v[52:55], a[32:35], v[20:23], v[52:55]
ds_read_b128 v[44:47], v11 offset:12288
v_mfma_f32_16x16x32_bf16 v[56:59], a[36:39], v[20:23], v[56:59]
s_cmp_eq_u32 s30, 1
s_cbranch_scc0 mega_kernel_q_ke1
s_mov_b32 m0, s61
s_nop 0
buffer_load_dwordx4 v5, s[84:87], s68 offen sc1 lds
mega_kernel_q_ke1:
v_mfma_f32_16x16x32_bf16 v[60:63], a[32:35], v[24:27], v[60:63]
ds_read_b128 v[48:51], v11 offset:14336
v_mfma_f32_16x16x32_bf16 v[64:67], a[36:39], v[24:27], v[64:67]
s_add_u32 m0, s46, 0
s_waitcnt lgkmcnt(4)
v_mfma_f32_16x16x32_bf16 v[52:55], a[40:43], v[28:31], v[52:55]
ds_read_b128 v[20:23], v10 offset:16384
v_mfma_f32_16x16x32_bf16 v[56:59], a[44:47], v[28:31], v[56:59]
buffer_load_dwordx4 v6, s[8:11], s50 offen offset:0 lds
v_mfma_f32_16x16x32_bf16 v[60:63], a[40:43], v[32:35], v[60:63]
ds_read_b128 v[24:27], v10 offset:18432
v_mfma_f32_16x16x32_bf16 v[64:67], a[44:47], v[32:35], v[64:67]
s_add_u32 m0, s46, 3968
s_waitcnt lgkmcnt(4)
v_mfma_f32_16x16x32_bf16 v[52:55], a[48:51], v[36:39], v[52:55]
ds_read_b128 v[28:31], v11 offset:16384
v_mfma_f32_16x16x32_bf16 v[56:59], a[52:55], v[36:39], v[56:59]
buffer_load_dwordx4 v6, s[8:11], s50 offen offset:128 lds
v_mfma_f32_16x16x32_bf16 v[60:63], a[48:51], v[40:43], v[60:63]
ds_read_b128 v[32:35], v11 offset:18432
v_mfma_f32_16x16x32_bf16 v[64:67], a[52:55], v[40:43], v[64:67]
s_add_u32 m0, s46, 7936
s_waitcnt lgkmcnt(4)
v_mfma_f32_16x16x32_bf16 v[52:55], a[56:59], v[44:47], v[52:55]
ds_read_b128 v[36:39], v10 offset:20480
v_mfma_f32_16x16x32_bf16 v[56:59], a[60:63], v[44:47], v[56:59]
buffer_load_dwordx4 v6, s[8:11], s50 offen offset:256 lds
v_mfma_f32_16x16x32_bf16 v[60:63], a[56:59], v[48:51], v[60:63]
ds_read_b128 v[40:43], v10 offset:22528
v_mfma_f32_16x16x32_bf16 v[64:67], a[60:63], v[48:51], v[64:67]
s_add_u32 m0, s46, 11904
s_waitcnt lgkmcnt(4)
v_mfma_f32_16x16x32_bf16 v[52:55], a[64:67], v[20:23], v[52:55]
ds_read_b128 v[44:47], v11 offset:20480
v_mfma_f32_16x16x32_bf16 v[56:59], a[68:71], v[20:23], v[56:59]
buffer_load_dwordx4 v6, s[8:11], s50 offen offset:384 lds
v_mfma_f32_16x16x32_bf16 v[60:63], a[64:67], v[24:27], v[60:63]
ds_read_b128 v[48:51], v11 offset:22528
v_mfma_f32_16x16x32_bf16 v[64:67], a[68:71], v[24:27], v[64:67]
s_add_u32 m0, s46, 15872
s_waitcnt lgkmcnt(4)
v_mfma_f32_16x16x32_bf16 v[52:55], a[72:75], v[28:31], v[52:55]
ds_read_b128 v[20:23], v10 offset:24576
v_mfma_f32_16x16x32_bf16 v[56:59], a[76:79], v[28:31], v[56:59]
buffer_load_dwordx4 v6, s[8:11], s50 offen offset:512 lds
v_mfma_f32_16x16x32_bf16 v[60:63], a[72:75], v[32:35], v[60:63]
ds_read_b128 v[24:27], v10 offset:26624
v_mfma_f32_16x16x32_bf16 v[64:67], a[76:79], v[32:35], v[64:67]
s_add_u32 m0, s46, 19840
s_waitcnt lgkmcnt(4)
v_mfma_f32_16x16x32_bf16 v[52:55], a[80:83], v[36:39], v[52:55]
ds_read_b128 v[28:31], v11 offset:24576
v_mfma_f32_16x16x32_bf16 v[56:59], a[84:87], v[36:39], v[56:59]
buffer_load_dwordx4 v6, s[8:11], s50 offen offset:640 lds
v_mfma_f32_16x16x32_bf16 v[60:63], a[80:83], v[40:43], v[60:63]
ds_read_b128 v[32:35], v11 offset:26624
v_mfma_f32_16x16x32_bf16 v[64:67], a[84:87], v[40:43], v[64:67]
s_add_u32 m0, s46, 23808
s_waitcnt lgkmcnt(4)
v_mfma_f32_16x16x32_bf16 v[52:55], a[88:91], v[44:47], v[52:55]
ds_read_b128 v[36:39], v10 offset:28672
v_mfma_f32_16x16x32_bf16 v[56:59], a[92:95], v[44:47], v[56:59]
buffer_load_dwordx4 v6, s[8:11], s50 offen offset:768 lds
v_mfma_f32_16x16x32_bf16 v[60:63], a[88:91], v[48:51], v[60:63]
ds_read_b128 v[40:43], v10 offset:30720
v_mfma_f32_16x16x32_bf16 v[64:67], a[92:95], v[48:51], v[64:67]
s_add_u32 m0, s46, 27776
s_waitcnt lgkmcnt(4)
v_mfma_f32_16x16x32_bf16 v[52:55], a[96:99], v[20:23], v[52:55]
ds_read_b128 v[44:47], v11 offset:28672
v_mfma_f32_16x16x32_bf16 v[56:59], a[100:103], v[20:23], v[56:59]
buffer_load_dwordx4 v6, s[8:11], s50 offen offset:896 lds
v_mfma_f32_16x16x32_bf16 v[60:63], a[96:99], v[24:27], v[60:63]
ds_read_b128 v[48:51], v11 offset:30720
v_mfma_f32_16x16x32_bf16 v[64:67], a[100:103], v[24:27], v[64:67]
s_add_u32 m0, s46, 31744
s_waitcnt lgkmcnt(4)
v_mfma_f32_16x16x32_bf16 v[52:55], a[104:107], v[28:31], v[52:55]
ds_read_b128 v[20:23], v10 offset:32768
v_mfma_f32_16x16x32_bf16 v[56:59], a[108:111], v[28:31], v[56:59]
buffer_load_dwordx4 v6, s[8:11], s50 offen offset:1024 lds
v_mfma_f32_16x16x32_bf16 v[60:63], a[104:107], v[32:35], v[60:63]
ds_read_b128 v[24:27], v10 offset:34816
v_mfma_f32_16x16x32_bf16 v[64:67], a[108:111], v[32:35], v[64:67]
s_waitcnt vmcnt(13)
v_mov_b32 v17, s42
s_mov_b64 exec, 1
buffer_store_dword v17, v16, s[84:87], s49 offen sc1
s_mov_b64 exec, -1
s_add_u32 m0, s46, 35712
s_waitcnt lgkmcnt(4)
v_mfma_f32_16x16x32_bf16 v[52:55], a[112:115], v[36:39], v[52:55]
ds_read_b128 v[28:31], v11 offset:32768
v_mfma_f32_16x16x32_bf16 v[56:59], a[116:119], v[36:39], v[56:59]
buffer_load_dwordx4 v6, s[8:11], s50 offen offset:1152 lds
v_mfma_f32_16x16x32_bf16 v[60:63], a[112:115], v[40:43], v[60:63]
ds_read_b128 v[32:35], v11 offset:34816
v_mfma_f32_16x16x32_bf16 v[64:67], a[116:119], v[40:43], v[64:67]
v_mov_b32 v100, 0
s_mov_b64 exec, 1
buffer_atomic_add v100, v16, s[84:87], s62 offen sc0 sc1
s_mov_b64 exec, -1
s_add_u32 m0, s46, 39680
s_waitcnt lgkmcnt(4)
v_mfma_f32_16x16x32_bf16 v[52:55], a[120:123], v[44:47], v[52:55]
ds_read_b128 v[36:39], v10 offset:36864
v_mfma_f32_16x16x32_bf16 v[56:59], a[124:127], v[44:47], v[56:59]
buffer_load_dwordx4 v6, s[8:11], s50 offen offset:1280 lds
v_mfma_f32_16x16x32_bf16 v[60:63], a[120:123], v[48:51], v[60:63]
ds_read_b128 v[40:43], v10 offset:38912
v_mfma_f32_16x16x32_bf16 v[64:67], a[124:127], v[48:51], v[64:67]
s_add_u32 m0, s46, 43648
s_waitcnt lgkmcnt(4)
v_mfma_f32_16x16x32_bf16 v[52:55], a[128:131], v[20:23], v[52:55]
ds_read_b128 v[44:47], v11 offset:36864
v_mfma_f32_16x16x32_bf16 v[56:59], a[132:135], v[20:23], v[56:59]
buffer_load_dwordx4 v6, s[8:11], s50 offen offset:1408 lds
v_mfma_f32_16x16x32_bf16 v[60:63], a[128:131], v[24:27], v[60:63]
ds_read_b128 v[48:51], v11 offset:38912
v_mfma_f32_16x16x32_bf16 v[64:67], a[132:135], v[24:27], v[64:67]
s_add_u32 m0, s46, 47616
s_waitcnt lgkmcnt(4)
v_mfma_f32_16x16x32_bf16 v[52:55], a[136:139], v[28:31], v[52:55]
ds_read_b128 v[20:23], v10 offset:40960
v_mfma_f32_16x16x32_bf16 v[56:59], a[140:143], v[28:31], v[56:59]
buffer_load_dwordx4 v6, s[8:11], s50 offen offset:1536 lds
v_mfma_f32_16x16x32_bf16 v[60:63], a[136:139], v[32:35], v[60:63]
ds_read_b128 v[24:27], v10 offset:43008
v_mfma_f32_16x16x32_bf16 v[64:67], a[140:143], v[32:35], v[64:67]
s_add_u32 m0, s46, 51584
s_waitcnt lgkmcnt(4)
v_mfma_f32_16x16x32_bf16 v[52:55], a[144:147], v[36:39], v[52:55]
ds_read_b128 v[28:31], v11 offset:40960
v_mfma_f32_16x16x32_bf16 v[56:59], a[148:151], v[36:39], v[56:59]
buffer_load_dwordx4 v6, s[8:11], s50 offen offset:1664 lds
v_mfma_f32_16x16x32_bf16 v[60:63], a[144:147], v[40:43], v[60:63]
ds_read_b128 v[32:35], v11 offset:43008
v_mfma_f32_16x16x32_bf16 v[64:67], a[148:151], v[40:43], v[64:67]
s_add_u32 m0, s46, 55552
s_waitcnt lgkmcnt(4)
v_mfma_f32_16x16x32_bf16 v[52:55], a[152:155], v[44:47], v[52:55]
ds_read_b128 v[36:39], v10 offset:45056
v_mfma_f32_16x16x32_bf16 v[56:59], a[156:159], v[44:47], v[56:59]
buffer_load_dwordx4 v6, s[8:11], s50 offen offset:1792 lds
v_mfma_f32_16x16x32_bf16 v[60:63], a[152:155], v[48:51], v[60:63]
ds_read_b128 v[40:43], v10 offset:47104
v_mfma_f32_16x16x32_bf16 v[64:67], a[156:159], v[48:51], v[64:67]
s_add_u32 m0, s46, 59520
s_waitcnt lgkmcnt(4)
v_mfma_f32_16x16x32_bf16 v[52:55], a[160:163], v[20:23], v[52:55]
ds_read_b128 v[44:47], v11 offset:45056
v_mfma_f32_16x16x32_bf16 v[56:59], a[164:167], v[20:23], v[56:59]
buffer_load_dwordx4 v6, s[8:11], s50 offen offset:1920 lds
v_mfma_f32_16x16x32_bf16 v[60:63], a[160:163], v[24:27], v[60:63]
ds_read_b128 v[48:51], v11 offset:47104
v_mfma_f32_16x16x32_bf16 v[64:67], a[164:167], v[24:27], v[64:67]
s_waitcnt lgkmcnt(4)
v_mfma_f32_16x16x32_bf16 v[52:55], a[168:171], v[28:31], v[52:55]
ds_read_b128 v[20:23], v10 offset:49152
v_mfma_f32_16x16x32_bf16 v[56:59], a[172:175], v[28:31], v[56:59]
v_mfma_f32_16x16x32_bf16 v[60:63], a[168:171], v[32:35], v[60:63]
ds_read_b128 v[24:27], v10 offset:51200
v_mfma_f32_16x16x32_bf16 v[64:67], a[172:175], v[32:35], v[64:67]
v_cvt_pk_bf16_f32 v84, v68, v69
v_cvt_pk_bf16_f32 v85, v70, v71
s_waitcnt lgkmcnt(4)
v_mfma_f32_16x16x32_bf16 v[52:55], a[176:179], v[36:39], v[52:55]
ds_read_b128 v[28:31], v11 offset:49152
v_mfma_f32_16x16x32_bf16 v[56:59], a[180:183], v[36:39], v[56:59]
v_mfma_f32_16x16x32_bf16 v[60:63], a[176:179], v[40:43], v[60:63]
ds_read_b128 v[32:35], v11 offset:51200
v_mfma_f32_16x16x32_bf16 v[64:67], a[180:183], v[40:43], v[64:67]
v_cvt_pk_bf16_f32 v86, v72, v73
v_cvt_pk_bf16_f32 v87, v74, v75
s_waitcnt lgkmcnt(4)
v_mfma_f32_16x16x32_bf16 v[52:55], a[184:187], v[44:47], v[52:55]
ds_read_b128 v[36:39], v10 offset:53248
v_mfma_f32_16x16x32_bf16 v[56:59], a[188:191], v[44:47], v[56:59]
v_mfma_f32_16x16x32_bf16 v[60:63], a[184:187], v[48:51], v[60:63]
ds_read_b128 v[40:43], v10 offset:55296
v_mfma_f32_16x16x32_bf16 v[64:67], a[188:191], v[48:51], v[64:67]
v_cvt_pk_bf16_f32 v88, v76, v77
v_cvt_pk_bf16_f32 v89, v78, v79
s_waitcnt lgkmcnt(4)
v_mfma_f32_16x16x32_bf16 v[52:55], a[192:195], v[20:23], v[52:55]
ds_read_b128 v[44:47], v11 offset:53248
v_mfma_f32_16x16x32_bf16 v[56:59], a[196:199], v[20:23], v[56:59]
v_mfma_f32_16x16x32_bf16 v[60:63], a[192:195], v[24:27], v[60:63]
ds_read_b128 v[48:51], v11 offset:55296
v_mfma_f32_16x16x32_bf16 v[64:67], a[196:199], v[24:27], v[64:67]
v_cvt_pk_bf16_f32 v90, v80, v81
v_cvt_pk_bf16_f32 v91, v82, v83
s_waitcnt lgkmcnt(4)
v_mfma_f32_16x16x32_bf16 v[52:55], a[200:203], v[28:31], v[52:55]
ds_read_b128 v[20:23], v10 offset:57344
v_mfma_f32_16x16x32_bf16 v[56:59], a[204:207], v[28:31], v[56:59]
v_mfma_f32_16x16x32_bf16 v[60:63], a[200:203], v[32:35], v[60:63]
ds_read_b128 v[24:27], v10 offset:59392
v_mfma_f32_16x16x32_bf16 v[64:67], a[204:207], v[32:35], v[64:67]
s_waitcnt lgkmcnt(4)
v_mfma_f32_16x16x32_bf16 v[52:55], a[208:211], v[36:39], v[52:55]
ds_read_b128 v[28:31], v11 offset:57344
v_mfma_f32_16x16x32_bf16 v[56:59], a[212:215], v[36:39], v[56:59]
v_mfma_f32_16x16x32_bf16 v[60:63], a[208:211], v[40:43], v[60:63]
ds_read_b128 v[32:35], v11 offset:59392
v_mfma_f32_16x16x32_bf16 v[64:67], a[212:215], v[40:43], v[64:67]
s_waitcnt lgkmcnt(4)
v_mfma_f32_16x16x32_bf16 v[52:55], a[216:219], v[44:47], v[52:55]
ds_read_b128 v[36:39], v10 offset:61440
v_mfma_f32_16x16x32_bf16 v[56:59], a[220:223], v[44:47], v[56:59]
s_waitcnt vmcnt(6)
v_readfirstlane_b32 s56, v100
s_cmp_eq_u32 s30, 1
s_cbranch_scc1 mega_kernel_q_kf1
s_cmp_gt_i32 s56, s42
s_cbranch_scc0 mega_kernel_q_kf1
s_mov_b32 s30, 1
s_mov_b32 m0, s61
s_nop 0
buffer_load_dwordx4 v5, s[84:87], s68 offen sc1 lds
mega_kernel_q_kf1:
v_mfma_f32_16x16x32_bf16 v[60:63], a[216:219], v[48:51], v[60:63]
ds_read_b128 v[40:43], v10 offset:63488
v_mfma_f32_16x16x32_bf16 v[64:67], a[220:223], v[48:51], v[64:67]
s_waitcnt lgkmcnt(4)
v_mfma_f32_16x16x32_bf16 v[52:55], a[224:227], v[20:23], v[52:55]
ds_read_b128 v[44:47], v11 offset:61440
v_mfma_f32_16x16x32_bf16 v[56:59], a[228:231], v[20:23], v[56:59]
v_mfma_f32_16x16x32_bf16 v[60:63], a[224:227], v[24:27], v[60:63]
ds_read_b128 v[48:51], v11 offset:63488
v_mfma_f32_16x16x32_bf16 v[64:67], a[228:231], v[24:27], v[64:67]
s_waitcnt lgkmcnt(5)
v_mfma_f32_16x16x32_bf16 v[52:55], a[232:235], v[28:31], v[52:55]
v_mfma_f32_16x16x32_bf16 v[56:59], a[236:239], v[28:31], v[56:59]
s_waitcnt lgkmcnt(4)
v_mfma_f32_16x16x32_bf16 v[60:63], a[232:235], v[32:35], v[60:63]
v_mfma_f32_16x16x32_bf16 v[64:67], a[236:239], v[32:35], v[64:67]
s_waitcnt lgkmcnt(3)
v_mfma_f32_16x16x32_bf16 v[52:55], a[240:243], v[36:39], v[52:55]
v_mfma_f32_16x16x32_bf16 v[56:59], a[244:247], v[36:39], v[56:59]
s_waitcnt lgkmcnt(2)
v_mfma_f32_16x16x32_bf16 v[60:63], a[240:243], v[40:43], v[60:63]
v_mfma_f32_16x16x32_bf16 v[64:67], a[244:247], v[40:43], v[64:67]
ds_write_b128 v101, v[84:87]
ds_write_b128 v101, v[88:91] offset:1024
s_waitcnt lgkmcnt(1)
v_mfma_f32_16x16x32_bf16 v[68:71], a[248:251], v[44:47], v[52:55]
v_mfma_f32_16x16x32_bf16 v[72:75], a[252:255], v[44:47], v[56:59]
s_waitcnt lgkmcnt(0)
v_mfma_f32_16x16x32_bf16 v[76:79], a[248:251], v[48:51], v[60:63]
v_mfma_f32_16x16x32_bf16 v[80:83], a[252:255], v[48:51], v[64:67]
s_cmp_eq_u32 s30, 1
s_cbranch_scc1 mega_kernel_q_kl1
mega_kernel_q_kw1:
v_mov_b32 v100, 0
s_mov_b64 exec, 1
buffer_atomic_add v100, v16, s[84:87], s62 offen sc0 sc1
s_mov_b64 exec, -1
s_waitcnt vmcnt(0)
v_readfirstlane_b32 s56, v100
s_cmp_gt_i32 s56, s42
s_cbranch_scc0 mega_kernel_q_kw1
s_mov_b32 m0, s61
s_nop 0
buffer_load_dwordx4 v5, s[84:87], s68 offen sc1 lds
mega_kernel_q_kl1:
s_waitcnt lgkmcnt(0) vmcnt(0)
s_barrier
ds_read_b128 v[184:187], v102 offset:0
ds_read_b128 v[112:115], v103 offset:0
ds_read_b128 v[128:131], v103 offset:1024
ds_read_b128 v[188:191], v102 offset:2048
ds_read_b128 v[116:119], v103 offset:2048
ds_read_b128 v[132:135], v103 offset:3072
ds_read_b128 v[192:195], v102 offset:4096
ds_read_b128 v[120:123], v103 offset:4096
ds_read_b128 v[136:139], v103 offset:5120
ds_read_b128 v[196:199], v102 offset:6144
ds_read_b128 v[124:127], v103 offset:6144
ds_read_b128 v[140:143], v103 offset:7168
s_waitcnt lgkmcnt(9)
v_mfma_f32_16x16x32_bf16 v[200:203], v[112:115], v[184:187], 0
v_mfma_f32_16x16x32_bf16 v[204:207], v[128:131], v[184:187], 0
ds_read_b128 v[160:163], v94 offset:0
s_waitcnt lgkmcnt(7)
v_mfma_f32_16x16x32_bf16 v[200:203], v[116:119], v[188:191], v[200:203]
v_mfma_f32_16x16x32_bf16 v[204:207], v[132:135], v[188:191], v[204:207]
ds_read_b128 v[164:167], v94 offset:1024
s_waitcnt lgkmcnt(5)
v_mfma_f32_16x16x32_bf16 v[200:203], v[120:123], v[192:195], v[200:203]
v_mfma_f32_16x16x32_bf16 v[204:207], v[136:139], v[192:195], v[204:207]
ds_read_b128 v[168:171], v94 offset:2048
s_waitcnt lgkmcnt(3)
v_mfma_f32_16x16x32_bf16 v[200:203], v[124:127], v[196:199], v[200:203]
v_mfma_f32_16x16x32_bf16 v[204:207], v[140:143], v[196:199], v[204:207]
ds_read_b128 v[172:175], v94 offset:3072
s_waitcnt lgkmcnt(3)
v_mfma_f32_16x16x32_bf16 v[208:211], v[160:163], v[184:187], 0
ds_read_b128 v[144:147], v240 offset:0
ds_read_b64 v[176:177], v95 offset:0
s_waitcnt lgkmcnt(4)
v_mfma_f32_16x16x32_bf16 v[208:211], v[164:167], v[188:191], v[208:211]
ds_read_b128 v[148:151], v240 offset:1024
ds_read_b64 v[178:179], v95 offset:256
s_waitcnt lgkmcnt(5)
v_mfma_f32_16x16x32_bf16 v[208:211], v[168:171], v[192:195], v[208:211]
ds_read_b128 v[152:155], v240 offset:2048
ds_read_b64 v[180:181], v95 offset:1024
s_waitcnt lgkmcnt(6)
v_mfma_f32_16x16x32_bf16 v[208:211], v[172:175], v[196:199], v[208:211]
ds_read_b128 v[156:159], v240 offset:3072
ds_read_b64 v[182:183], v95 offset:1280
v_pk_mul_f32 v[200:201], v[200:201], s[54:55] op_sel_hi:[1,0]
v_pk_mul_f32 v[202:203], v[202:203], s[54:55] op_sel_hi:[1,0]
v_pk_mul_f32 v[204:205], v[204:205], s[54:55] op_sel_hi:[1,0]
v_pk_mul_f32 v[206:207], v[206:207], s[54:55] op_sel_hi:[1,0]
v_cndmask_b32 v200, v200, v241, s[12:13]
v_cndmask_b32 v201, v201, v241, s[14:15]
v_cndmask_b32 v202, v202, v241, s[16:17]
v_cndmask_b32 v203, v203, v241, s[18:19]
v_cndmask_b32 v204, v204, v241, s[20:21]
v_cndmask_b32 v205, v205, v241, s[22:23]
v_cndmask_b32 v206, v206, v241, s[24:25]
v_cndmask_b32 v207, v207, v241, s[26:27]
v_pk_mul_f32 v[208:209], v[208:209], s[54:55] op_sel_hi:[1,0]
v_pk_mul_f32 v[210:211], v[210:211], s[54:55] op_sel_hi:[1,0]
v_cndmask_b32 v208, v208, v97, s[28:29]
v_cndmask_b32 v209, v209, v97, s[28:29]
v_cndmask_b32 v210, v210, v97, s[28:29]
v_cndmask_b32 v211, v211, v97, s[28:29]
v_max3_f32 v236, v200, v201, v202
v_max3_f32 v236, v236, v203, v204
v_max3_f32 v236, v236, v205, v206
v_max3_f32 v236, v236, v207, v208
v_max3_f32 v236, v236, v209, v210
v_max_f32 v237, v236, v211
v_max_f32 v236, v236, v211
s_nop 1
v_permlane16_swap_b32 v236, v237
s_nop 0
v_max_f32 v238, v236, v237
v_max_f32 v239, v236, v237
s_nop 1
v_permlane32_swap_b32 v238, v239
s_nop 0
v_max_f32 v236, v238, v239
v_pk_add_f32 v[200:201], v[200:201], v[236:237] op_sel_hi:[1,0] neg_lo:[0,1] neg_hi:[0,1]
v_pk_add_f32 v[202:203], v[202:203], v[236:237] op_sel_hi:[1,0] neg_lo:[0,1] neg_hi:[0,1]
v_pk_add_f32 v[204:205], v[204:205], v[236:237] op_sel_hi:[1,0] neg_lo:[0,1] neg_hi:[0,1]
v_pk_add_f32 v[206:207], v[206:207], v[236:237] op_sel_hi:[1,0] neg_lo:[0,1] neg_hi:[0,1]
v_pk_add_f32 v[208:209], v[208:209], v[236:237] op_sel_hi:[1,0] neg_lo:[0,1] neg_hi:[0,1]
v_pk_add_f32 v[210:211], v[210:211], v[236:237] op_sel_hi:[1,0] neg_lo:[0,1] neg_hi:[0,1]
v_exp_f32 v200, v200
v_exp_f32 v201, v201
v_exp_f32 v202, v202
v_exp_f32 v203, v203
v_exp_f32 v204, v204
v_exp_f32 v205, v205
v_exp_f32 v206, v206
v_exp_f32 v207, v207
v_exp_f32 v208, v208
v_exp_f32 v209, v209
v_exp_f32 v210, v210
v_exp_f32 v211, v211
s_nop 0
v_cvt_pk_bf16_f32 v212, v200, v201
v_cvt_pk_bf16_f32 v213, v202, v203
v_cvt_pk_bf16_f32 v214, v204, v205
v_cvt_pk_bf16_f32 v215, v206, v207
v_cvt_pk_bf16_f32 v216, v208, v209
v_cvt_pk_bf16_f32 v217, v210, v211
s_waitcnt lgkmcnt(0)
s_nop 0
v_mfma_f32_16x16x32_bf16 v[108:111], v[104:107], v[212:215], 0
v_mfma_f32_16x16x32_bf16 v[220:223], v[144:147], v[212:215], 0
v_mfma_f32_16x16x32_bf16 v[224:227], v[148:151], v[212:215], 0
v_mfma_f32_16x16x32_bf16 v[228:231], v[152:155], v[212:215], 0
v_mfma_f32_16x16x32_bf16 v[232:235], v[156:159], v[212:215], 0
v_mfma_f32_16x16x16_bf16 v[108:111], v[104:105], v[216:217], v[108:111]
v_mfma_f32_16x16x16_bf16 v[220:223], v[176:177], v[216:217], v[220:223]
v_mfma_f32_16x16x16_bf16 v[224:227], v[178:179], v[216:217], v[224:227]
v_mfma_f32_16x16x16_bf16 v[228:231], v[180:181], v[216:217], v[228:231]
v_mfma_f32_16x16x16_bf16 v[232:235], v[182:183], v[216:217], v[232:235]
s_lshl_b32 s51, s42, 18
s_nop 2
v_rcp_f32 v238, v108
v_rcp_f32 v239, v109
s_nop 1
v_pk_mul_f32 v[220:221], v[220:221], v[238:239]
v_pk_mul_f32 v[222:223], v[222:223], v[238:239]
v_pk_mul_f32 v[224:225], v[224:225], v[238:239]
v_pk_mul_f32 v[226:227], v[226:227], v[238:239]
v_pk_mul_f32 v[228:229], v[228:229], v[238:239]
v_pk_mul_f32 v[230:231], v[230:231], v[238:239]
v_pk_mul_f32 v[232:233], v[232:233], v[238:239]
v_pk_mul_f32 v[234:235], v[234:235], v[238:239]
v_cvt_pk_bf16_f32 v200, v220, v221
v_cvt_pk_bf16_f32 v201, v222, v223
v_cvt_pk_bf16_f32 v202, v224, v225
v_cvt_pk_bf16_f32 v203, v226, v227
v_cvt_pk_bf16_f32 v204, v228, v229
v_cvt_pk_bf16_f32 v205, v230, v231
v_cvt_pk_bf16_f32 v206, v232, v233
v_cvt_pk_bf16_f32 v207, v234, v235
buffer_store_dwordx4 v[200:203], v96, s[84:87], s51 offen sc1
buffer_store_dwordx4 v[204:207], v96, s[84:87], s51 offen offset:2048 sc1
s_add_u32 s42, s42, 1
s_barrier
s_cmp_gt_i32 s55, s42
s_cbranch_scc1 mega_kernel_q_kv0k
mega_kernel_q_kv0w:
v_mov_b32 v2, 0
s_mov_b64 exec, 0xff
buffer_atomic_add v2, v99, s[84:87], 0 offen sc0 sc1
s_mov_b64 exec, -1
s_waitcnt vmcnt(0)
v_min_i32_dpp v2, v2, v2 quad_perm:[1,0,3,2] row_mask:0xf bank_mask:0xf
s_nop 1
v_min_i32_dpp v2, v2, v2 quad_perm:[2,3,0,1] row_mask:0xf bank_mask:0xf
s_nop 1
v_min_i32_dpp v2, v2, v2 row_half_mirror row_mask:0xf bank_mask:0xf
s_nop 0
v_readfirstlane_b32 s55, v2
s_cmp_gt_i32 s55, s42
s_cbranch_scc1 mega_kernel_q_kv0k
s_sleep 4
s_branch mega_kernel_q_kv0w
mega_kernel_q_kv0k:
s_cmp_eq_u32 s42, 63
s_cbranch_scc0 mega_kernel_q_nl
s_add_u32 s51, s47, s42
s_bfe_u32 s57, s51, 0x40002
s_lshl_b32 s57, s57, 14
s_and_b32 s66, s51, 3
s_lshl_b32 s66, s66, 11
s_add_u32 s66, s66, s57
s_add_u32 s66, s66, s58
s_add_u32 s67, s66, 33554432
s_bfe_u32 s57, s51, 0x30003
s_lshl_b32 s57, s57, 14
s_and_b32 s68, s51, 7
s_lshl_b32 s68, s68, 10
s_add_u32 s68, s68, s57
s_add_u32 s68, s68, s59
s_add_u32 s50, s42, 2
s_min_u32 s50, s50, 63
s_lshl_b32 s50, s50, 16
s_cmp_gt_i32 s56, s42
s_cselect_b32 s30, 1, 0
s_add_u32 m0, s60, 0
s_nop 0
buffer_load_dwordx4 v5, s[84:87], s66 offen offset:0 sc1 lds
s_add_u32 m0, s60, 0
s_nop 0
buffer_load_dwordx4 v5, s[84:87], s66 offen offset:1024 sc1 lds
s_add_u32 m0, s60, 8192
s_nop 0
buffer_load_dwordx4 v5, s[84:87], s67 offen offset:0 sc1 lds
s_add_u32 m0, s60, 8192
s_nop 0
buffer_load_dwordx4 v5, s[84:87], s67 offen offset:1024 sc1 lds
s_cmp_eq_u32 s30, 1
s_cbranch_scc0 mega_kernel_q_ke2
s_mov_b32 m0, s61
s_nop 0
buffer_load_dwordx4 v5, s[84:87], s68 offen sc1 lds
mega_kernel_q_ke2:
v_cvt_pk_bf16_f32 v84, v68, v69
v_cvt_pk_bf16_f32 v85, v70, v71
v_cvt_pk_bf16_f32 v86, v72, v73
v_cvt_pk_bf16_f32 v87, v74, v75
v_cvt_pk_bf16_f32 v88, v76, v77
v_cvt_pk_bf16_f32 v89, v78, v79
v_cvt_pk_bf16_f32 v90, v80, v81
v_cvt_pk_bf16_f32 v91, v82, v83
ds_write_b128 v101, v[84:87]
ds_write_b128 v101, v[88:91] offset:1024
s_waitcnt vmcnt(4)
v_mov_b32 v17, s42
s_mov_b64 exec, 1
buffer_store_dword v17, v16, s[84:87], s49 offen sc1
s_mov_b64 exec, -1
s_branch mega_kernel_q_jl
mega_kernel_q_nl:
ds_read_b128 v[20:23], v8 offset:0
ds_read_b128 v[24:27], v8 offset:2048
ds_read_b128 v[28:31], v9 offset:0
ds_read_b128 v[32:35], v9 offset:2048
ds_read_b128 v[36:39], v8 offset:4096
ds_read_b128 v[40:43], v8 offset:6144
s_add_u32 s51, s47, s42
s_bfe_u32 s57, s51, 0x40002
s_lshl_b32 s57, s57, 14
s_and_b32 s66, s51, 3
s_lshl_b32 s66, s66, 11
s_add_u32 s66, s66, s57
s_add_u32 s66, s66, s58
s_add_u32 s67, s66, 33554432
s_bfe_u32 s57, s51, 0x30003
s_lshl_b32 s57, s57, 14
s_and_b32 s68, s51, 7
s_lshl_b32 s68, s68, 10
s_add_u32 s68, s68, s57
s_add_u32 s68, s68, s59
s_add_u32 s50, s42, 2
s_min_u32 s50, s50, 63
s_lshl_b32 s50, s50, 16
s_cmp_gt_i32 s56, s42
s_cselect_b32 s30, 1, 0
s_add_u32 m0, s60, 0
s_waitcnt lgkmcnt(4)
v_mfma_f32_16x16x32_bf16 v[52:55], a[0:3], v[20:23], 0
ds_read_b128 v[44:47], v9 offset:4096
v_mfma_f32_16x16x32_bf16 v[56:59], a[4:7], v[20:23], 0
buffer_load_dwordx4 v5, s[84:87], s66 offen offset:0 sc1 lds
v_mfma_f32_16x16x32_bf16 v[60:63], a[0:3], v[24:27], 0
ds_read_b128 v[48:51], v9 offset:6144
v_mfma_f32_16x16x32_bf16 v[64:67], a[4:7], v[24:27], 0
s_add_u32 m0, s60, 0
s_waitcnt lgkmcnt(4)
v_mfma_f32_16x16x32_bf16 v[52:55], a[8:11], v[28:31], v[52:55]
ds_read_b128 v[20:23], v8 offset:8192
v_mfma_f32_16x16x32_bf16 v[56:59], a[12:15], v[28:31], v[56:59]
buffer_load_dwordx4 v5, s[84:87], s66 offen offset:1024 sc1 lds
v_mfma_f32_16x16x32_bf16 v[60:63], a[8:11], v[32:35], v[60:63]
ds_read_b128 v[24:27], v8 offset:10240
v_mfma_f32_16x16x32_bf16 v[64:67], a[12:15], v[32:35], v[64:67]
s_add_u32 m0, s60, 8192
s_waitcnt lgkmcnt(4)
v_mfma_f32_16x16x32_bf16 v[52:55], a[16:19], v[36:39], v[52:55]
ds_read_b128 v[28:31], v9 offset:8192
v_mfma_f32_16x16x32_bf16 v[56:59], a[20:23], v[36:39], v[56:59]
buffer_load_dwordx4 v5, s[84:87], s67 offen offset:0 sc1 lds
v_mfma_f32_16x16x32_bf16 v[60:63], a[16:19], v[40:43], v[60:63]
ds_read_b128 v[32:35], v9 offset:10240
v_mfma_f32_16x16x32_bf16 v[64:67], a[20:23], v[40:43], v[64:67]
s_add_u32 m0, s60, 8192
s_waitcnt lgkmcnt(4)
v_mfma_f32_16x16x32_bf16 v[52:55], a[24:27], v[44:47], v[52:55]
ds_read_b128 v[36:39], v8 offset:12288
v_mfma_f32_16x16x32_bf16 v[56:59], a[28:31], v[44:47], v[56:59]
buffer_load_dwordx4 v5, s[84:87], s67 offen offset:1024 sc1 lds
v_mfma_f32_16x16x32_bf16 v[60:63], a[24:27], v[48:51], v[60:63]
ds_read_b128 v[40:43], v8 offset:14336
v_mfma_f32_16x16x32_bf16 v[64:67], a[28:31], v[48:51], v[64:67]
s_waitcnt lgkmcnt(4)
v_mfma_f32_16x16x32_bf16 v[52:55], a[32:35], v[20:23], v[52:55]
ds_read_b128 v[44:47], v9 offset:12288
v_mfma_f32_16x16x32_bf16 v[56:59], a[36:39], v[20:23], v[56:59]
s_cmp_eq_u32 s30, 1
s_cbranch_scc0 mega_kernel_q_ke0
s_mov_b32 m0, s61
s_nop 0
buffer_load_dwordx4 v5, s[84:87], s68 offen sc1 lds
mega_kernel_q_ke0:
v_mfma_f32_16x16x32_bf16 v[60:63], a[32:35], v[24:27], v[60:63]
ds_read_b128 v[48:51], v9 offset:14336
v_mfma_f32_16x16x32_bf16 v[64:67], a[36:39], v[24:27], v[64:67]
s_add_u32 m0, s46, 65536
s_waitcnt lgkmcnt(4)
v_mfma_f32_16x16x32_bf16 v[52:55], a[40:43], v[28:31], v[52:55]
ds_read_b128 v[20:23], v8 offset:16384
v_mfma_f32_16x16x32_bf16 v[56:59], a[44:47], v[28:31], v[56:59]
buffer_load_dwordx4 v6, s[8:11], s50 offen offset:0 lds
v_mfma_f32_16x16x32_bf16 v[60:63], a[40:43], v[32:35], v[60:63]
ds_read_b128 v[24:27], v8 offset:18432
v_mfma_f32_16x16x32_bf16 v[64:67], a[44:47], v[32:35], v[64:67]
s_add_u32 m0, s46, 69504
s_waitcnt lgkmcnt(4)
v_mfma_f32_16x16x32_bf16 v[52:55], a[48:51], v[36:39], v[52:55]
ds_read_b128 v[28:31], v9 offset:16384
v_mfma_f32_16x16x32_bf16 v[56:59], a[52:55], v[36:39], v[56:59]
buffer_load_dwordx4 v6, s[8:11], s50 offen offset:128 lds
v_mfma_f32_16x16x32_bf16 v[60:63], a[48:51], v[40:43], v[60:63]
ds_read_b128 v[32:35], v9 offset:18432
v_mfma_f32_16x16x32_bf16 v[64:67], a[52:55], v[40:43], v[64:67]
s_add_u32 m0, s46, 73472
s_waitcnt lgkmcnt(4)
v_mfma_f32_16x16x32_bf16 v[52:55], a[56:59], v[44:47], v[52:55]
ds_read_b128 v[36:39], v8 offset:20480
v_mfma_f32_16x16x32_bf16 v[56:59], a[60:63], v[44:47], v[56:59]
buffer_load_dwordx4 v6, s[8:11], s50 offen offset:256 lds
v_mfma_f32_16x16x32_bf16 v[60:63], a[56:59], v[48:51], v[60:63]
ds_read_b128 v[40:43], v8 offset:22528
v_mfma_f32_16x16x32_bf16 v[64:67], a[60:63], v[48:51], v[64:67]
s_add_u32 m0, s46, 77440
s_waitcnt lgkmcnt(4)
v_mfma_f32_16x16x32_bf16 v[52:55], a[64:67], v[20:23], v[52:55]
ds_read_b128 v[44:47], v9 offset:20480
v_mfma_f32_16x16x32_bf16 v[56:59], a[68:71], v[20:23], v[56:59]
buffer_load_dwordx4 v6, s[8:11], s50 offen offset:384 lds
v_mfma_f32_16x16x32_bf16 v[60:63], a[64:67], v[24:27], v[60:63]
ds_read_b128 v[48:51], v9 offset:22528
v_mfma_f32_16x16x32_bf16 v[64:67], a[68:71], v[24:27], v[64:67]
s_add_u32 m0, s46, 81408
s_waitcnt lgkmcnt(4)
v_mfma_f32_16x16x32_bf16 v[52:55], a[72:75], v[28:31], v[52:55]
ds_read_b128 v[20:23], v8 offset:24576
v_mfma_f32_16x16x32_bf16 v[56:59], a[76:79], v[28:31], v[56:59]
buffer_load_dwordx4 v6, s[8:11], s50 offen offset:512 lds
v_mfma_f32_16x16x32_bf16 v[60:63], a[72:75], v[32:35], v[60:63]
ds_read_b128 v[24:27], v8 offset:26624
v_mfma_f32_16x16x32_bf16 v[64:67], a[76:79], v[32:35], v[64:67]
s_add_u32 m0, s46, 85376
s_waitcnt lgkmcnt(4)
v_mfma_f32_16x16x32_bf16 v[52:55], a[80:83], v[36:39], v[52:55]
ds_read_b128 v[28:31], v9 offset:24576
v_mfma_f32_16x16x32_bf16 v[56:59], a[84:87], v[36:39], v[56:59]
buffer_load_dwordx4 v6, s[8:11], s50 offen offset:640 lds
v_mfma_f32_16x16x32_bf16 v[60:63], a[80:83], v[40:43], v[60:63]
ds_read_b128 v[32:35], v9 offset:26624
v_mfma_f32_16x16x32_bf16 v[64:67], a[84:87], v[40:43], v[64:67]
s_add_u32 m0, s46, 89344
s_waitcnt lgkmcnt(4)
v_mfma_f32_16x16x32_bf16 v[52:55], a[88:91], v[44:47], v[52:55]
ds_read_b128 v[36:39], v8 offset:28672
v_mfma_f32_16x16x32_bf16 v[56:59], a[92:95], v[44:47], v[56:59]
buffer_load_dwordx4 v6, s[8:11], s50 offen offset:768 lds
v_mfma_f32_16x16x32_bf16 v[60:63], a[88:91], v[48:51], v[60:63]
ds_read_b128 v[40:43], v8 offset:30720
v_mfma_f32_16x16x32_bf16 v[64:67], a[92:95], v[48:51], v[64:67]
s_add_u32 m0, s46, 93312
s_waitcnt lgkmcnt(4)
v_mfma_f32_16x16x32_bf16 v[52:55], a[96:99], v[20:23], v[52:55]
ds_read_b128 v[44:47], v9 offset:28672
v_mfma_f32_16x16x32_bf16 v[56:59], a[100:103], v[20:23], v[56:59]
buffer_load_dwordx4 v6, s[8:11], s50 offen offset:896 lds
v_mfma_f32_16x16x32_bf16 v[60:63], a[96:99], v[24:27], v[60:63]
ds_read_b128 v[48:51], v9 offset:30720
v_mfma_f32_16x16x32_bf16 v[64:67], a[100:103], v[24:27], v[64:67]
s_add_u32 m0, s46, 97280
s_waitcnt lgkmcnt(4)
v_mfma_f32_16x16x32_bf16 v[52:55], a[104:107], v[28:31], v[52:55]
ds_read_b128 v[20:23], v8 offset:32768
v_mfma_f32_16x16x32_bf16 v[56:59], a[108:111], v[28:31], v[56:59]
buffer_load_dwordx4 v6, s[8:11], s50 offen offset:1024 lds
v_mfma_f32_16x16x32_bf16 v[60:63], a[104:107], v[32:35], v[60:63]
ds_read_b128 v[24:27], v8 offset:34816
v_mfma_f32_16x16x32_bf16 v[64:67], a[108:111], v[32:35], v[64:67]
s_waitcnt vmcnt(13)
v_mov_b32 v17, s42
s_mov_b64 exec, 1
buffer_store_dword v17, v16, s[84:87], s49 offen sc1
s_mov_b64 exec, -1
s_add_u32 m0, s46, 101248
s_waitcnt lgkmcnt(4)
v_mfma_f32_16x16x32_bf16 v[52:55], a[112:115], v[36:39], v[52:55]
ds_read_b128 v[28:31], v9 offset:32768
v_mfma_f32_16x16x32_bf16 v[56:59], a[116:119], v[36:39], v[56:59]
buffer_load_dwordx4 v6, s[8:11], s50 offen offset:1152 lds
v_mfma_f32_16x16x32_bf16 v[60:63], a[112:115], v[40:43], v[60:63]
ds_read_b128 v[32:35], v9 offset:34816
v_mfma_f32_16x16x32_bf16 v[64:67], a[116:119], v[40:43], v[64:67]
v_mov_b32 v100, 0
s_mov_b64 exec, 1
buffer_atomic_add v100, v16, s[84:87], s62 offen sc0 sc1
s_mov_b64 exec, -1
s_add_u32 m0, s46, 105216
s_waitcnt lgkmcnt(4)
v_mfma_f32_16x16x32_bf16 v[52:55], a[120:123], v[44:47], v[52:55]
ds_read_b128 v[36:39], v8 offset:36864
v_mfma_f32_16x16x32_bf16 v[56:59], a[124:127], v[44:47], v[56:59]
buffer_load_dwordx4 v6, s[8:11], s50 offen offset:1280 lds
v_mfma_f32_16x16x32_bf16 v[60:63], a[120:123], v[48:51], v[60:63]
ds_read_b128 v[40:43], v8 offset:38912
v_mfma_f32_16x16x32_bf16 v[64:67], a[124:127], v[48:51], v[64:67]
s_add_u32 m0, s46, 109184
s_waitcnt lgkmcnt(4)
v_mfma_f32_16x16x32_bf16 v[52:55], a[128:131], v[20:23], v[52:55]
ds_read_b128 v[44:47], v9 offset:36864
v_mfma_f32_16x16x32_bf16 v[56:59], a[132:135], v[20:23], v[56:59]
buffer_load_dwordx4 v6, s[8:11], s50 offen offset:1408 lds
v_mfma_f32_16x16x32_bf16 v[60:63], a[128:131], v[24:27], v[60:63]
ds_read_b128 v[48:51], v9 offset:38912
v_mfma_f32_16x16x32_bf16 v[64:67], a[132:135], v[24:27], v[64:67]
s_add_u32 m0, s46, 113152
s_waitcnt lgkmcnt(4)
v_mfma_f32_16x16x32_bf16 v[52:55], a[136:139], v[28:31], v[52:55]
ds_read_b128 v[20:23], v8 offset:40960
v_mfma_f32_16x16x32_bf16 v[56:59], a[140:143], v[28:31], v[56:59]
buffer_load_dwordx4 v6, s[8:11], s50 offen offset:1536 lds
v_mfma_f32_16x16x32_bf16 v[60:63], a[136:139], v[32:35], v[60:63]
ds_read_b128 v[24:27], v8 offset:43008
v_mfma_f32_16x16x32_bf16 v[64:67], a[140:143], v[32:35], v[64:67]
s_add_u32 m0, s46, 117120
s_waitcnt lgkmcnt(4)
v_mfma_f32_16x16x32_bf16 v[52:55], a[144:147], v[36:39], v[52:55]
ds_read_b128 v[28:31], v9 offset:40960
v_mfma_f32_16x16x32_bf16 v[56:59], a[148:151], v[36:39], v[56:59]
buffer_load_dwordx4 v6, s[8:11], s50 offen offset:1664 lds
v_mfma_f32_16x16x32_bf16 v[60:63], a[144:147], v[40:43], v[60:63]
ds_read_b128 v[32:35], v9 offset:43008
v_mfma_f32_16x16x32_bf16 v[64:67], a[148:151], v[40:43], v[64:67]
s_add_u32 m0, s46, 121088
s_waitcnt lgkmcnt(4)
v_mfma_f32_16x16x32_bf16 v[52:55], a[152:155], v[44:47], v[52:55]
ds_read_b128 v[36:39], v8 offset:45056
v_mfma_f32_16x16x32_bf16 v[56:59], a[156:159], v[44:47], v[56:59]
buffer_load_dwordx4 v6, s[8:11], s50 offen offset:1792 lds
v_mfma_f32_16x16x32_bf16 v[60:63], a[152:155], v[48:51], v[60:63]
ds_read_b128 v[40:43], v8 offset:47104
v_mfma_f32_16x16x32_bf16 v[64:67], a[156:159], v[48:51], v[64:67]
s_add_u32 m0, s46, 125056
s_waitcnt lgkmcnt(4)
v_mfma_f32_16x16x32_bf16 v[52:55], a[160:163], v[20:23], v[52:55]
ds_read_b128 v[44:47], v9 offset:45056
v_mfma_f32_16x16x32_bf16 v[56:59], a[164:167], v[20:23], v[56:59]
buffer_load_dwordx4 v6, s[8:11], s50 offen offset:1920 lds
v_mfma_f32_16x16x32_bf16 v[60:63], a[160:163], v[24:27], v[60:63]
ds_read_b128 v[48:51], v9 offset:47104
v_mfma_f32_16x16x32_bf16 v[64:67], a[164:167], v[24:27], v[64:67]
s_waitcnt lgkmcnt(4)
v_mfma_f32_16x16x32_bf16 v[52:55], a[168:171], v[28:31], v[52:55]
ds_read_b128 v[20:23], v8 offset:49152
v_mfma_f32_16x16x32_bf16 v[56:59], a[172:175], v[28:31], v[56:59]
v_mfma_f32_16x16x32_bf16 v[60:63], a[168:171], v[32:35], v[60:63]
ds_read_b128 v[24:27], v8 offset:51200
v_mfma_f32_16x16x32_bf16 v[64:67], a[172:175], v[32:35], v[64:67]
v_cvt_pk_bf16_f32 v84, v68, v69
v_cvt_pk_bf16_f32 v85, v70, v71
s_waitcnt lgkmcnt(4)
v_mfma_f32_16x16x32_bf16 v[52:55], a[176:179], v[36:39], v[52:55]
ds_read_b128 v[28:31], v9 offset:49152
v_mfma_f32_16x16x32_bf16 v[56:59], a[180:183], v[36:39], v[56:59]
v_mfma_f32_16x16x32_bf16 v[60:63], a[176:179], v[40:43], v[60:63]
ds_read_b128 v[32:35], v9 offset:51200
v_mfma_f32_16x16x32_bf16 v[64:67], a[180:183], v[40:43], v[64:67]
v_cvt_pk_bf16_f32 v86, v72, v73
v_cvt_pk_bf16_f32 v87, v74, v75
s_waitcnt lgkmcnt(4)
v_mfma_f32_16x16x32_bf16 v[52:55], a[184:187], v[44:47], v[52:55]
ds_read_b128 v[36:39], v8 offset:53248
v_mfma_f32_16x16x32_bf16 v[56:59], a[188:191], v[44:47], v[56:59]
v_mfma_f32_16x16x32_bf16 v[60:63], a[184:187], v[48:51], v[60:63]
ds_read_b128 v[40:43], v8 offset:55296
v_mfma_f32_16x16x32_bf16 v[64:67], a[188:191], v[48:51], v[64:67]
v_cvt_pk_bf16_f32 v88, v76, v77
v_cvt_pk_bf16_f32 v89, v78, v79
s_waitcnt lgkmcnt(4)
v_mfma_f32_16x16x32_bf16 v[52:55], a[192:195], v[20:23], v[52:55]
ds_read_b128 v[44:47], v9 offset:53248
v_mfma_f32_16x16x32_bf16 v[56:59], a[196:199], v[20:23], v[56:59]
v_mfma_f32_16x16x32_bf16 v[60:63], a[192:195], v[24:27], v[60:63]
ds_read_b128 v[48:51], v9 offset:55296
v_mfma_f32_16x16x32_bf16 v[64:67], a[196:199], v[24:27], v[64:67]
v_cvt_pk_bf16_f32 v90, v80, v81
v_cvt_pk_bf16_f32 v91, v82, v83
s_waitcnt lgkmcnt(4)
v_mfma_f32_16x16x32_bf16 v[52:55], a[200:203], v[28:31], v[52:55]
ds_read_b128 v[20:23], v8 offset:57344
v_mfma_f32_16x16x32_bf16 v[56:59], a[204:207], v[28:31], v[56:59]
v_mfma_f32_16x16x32_bf16 v[60:63], a[200:203], v[32:35], v[60:63]
ds_read_b128 v[24:27], v8 offset:59392
v_mfma_f32_16x16x32_bf16 v[64:67], a[204:207], v[32:35], v[64:67]
s_waitcnt lgkmcnt(4)
v_mfma_f32_16x16x32_bf16 v[52:55], a[208:211], v[36:39], v[52:55]
ds_read_b128 v[28:31], v9 offset:57344
v_mfma_f32_16x16x32_bf16 v[56:59], a[212:215], v[36:39], v[56:59]
v_mfma_f32_16x16x32_bf16 v[60:63], a[208:211], v[40:43], v[60:63]
ds_read_b128 v[32:35], v9 offset:59392
v_mfma_f32_16x16x32_bf16 v[64:67], a[212:215], v[40:43], v[64:67]
s_waitcnt lgkmcnt(4)
v_mfma_f32_16x16x32_bf16 v[52:55], a[216:219], v[44:47], v[52:55]
ds_read_b128 v[36:39], v8 offset:61440
v_mfma_f32_16x16x32_bf16 v[56:59], a[220:223], v[44:47], v[56:59]
s_waitcnt vmcnt(6)
v_readfirstlane_b32 s56, v100
s_cmp_eq_u32 s30, 1
s_cbranch_scc1 mega_kernel_q_kf0
s_cmp_gt_i32 s56, s42
s_cbranch_scc0 mega_kernel_q_kf0
s_mov_b32 s30, 1
s_mov_b32 m0, s61
s_nop 0
buffer_load_dwordx4 v5, s[84:87], s68 offen sc1 lds
mega_kernel_q_kf0:
v_mfma_f32_16x16x32_bf16 v[60:63], a[216:219], v[48:51], v[60:63]
ds_read_b128 v[40:43], v8 offset:63488
v_mfma_f32_16x16x32_bf16 v[64:67], a[220:223], v[48:51], v[64:67]
s_waitcnt lgkmcnt(4)
v_mfma_f32_16x16x32_bf16 v[52:55], a[224:227], v[20:23], v[52:55]
ds_read_b128 v[44:47], v9 offset:61440
v_mfma_f32_16x16x32_bf16 v[56:59], a[228:231], v[20:23], v[56:59]
v_mfma_f32_16x16x32_bf16 v[60:63], a[224:227], v[24:27], v[60:63]
ds_read_b128 v[48:51], v9 offset:63488
v_mfma_f32_16x16x32_bf16 v[64:67], a[228:231], v[24:27], v[64:67]
s_waitcnt lgkmcnt(5)
v_mfma_f32_16x16x32_bf16 v[52:55], a[232:235], v[28:31], v[52:55]
v_mfma_f32_16x16x32_bf16 v[56:59], a[236:239], v[28:31], v[56:59]
s_waitcnt lgkmcnt(4)
v_mfma_f32_16x16x32_bf16 v[60:63], a[232:235], v[32:35], v[60:63]
v_mfma_f32_16x16x32_bf16 v[64:67], a[236:239], v[32:35], v[64:67]
s_waitcnt lgkmcnt(3)
v_mfma_f32_16x16x32_bf16 v[52:55], a[240:243], v[36:39], v[52:55]
v_mfma_f32_16x16x32_bf16 v[56:59], a[244:247], v[36:39], v[56:59]
s_waitcnt lgkmcnt(2)
v_mfma_f32_16x16x32_bf16 v[60:63], a[240:243], v[40:43], v[60:63]
v_mfma_f32_16x16x32_bf16 v[64:67], a[244:247], v[40:43], v[64:67]
ds_write_b128 v101, v[84:87]
ds_write_b128 v101, v[88:91] offset:1024
s_waitcnt lgkmcnt(1)
v_mfma_f32_16x16x32_bf16 v[68:71], a[248:251], v[44:47], v[52:55]
v_mfma_f32_16x16x32_bf16 v[72:75], a[252:255], v[44:47], v[56:59]
s_waitcnt lgkmcnt(0)
v_mfma_f32_16x16x32_bf16 v[76:79], a[248:251], v[48:51], v[60:63]
v_mfma_f32_16x16x32_bf16 v[80:83], a[252:255], v[48:51], v[64:67]
mega_kernel_q_jl:
s_cmp_eq_u32 s30, 1
s_cbranch_scc1 mega_kernel_q_kl0
mega_kernel_q_kw0:
v_mov_b32 v100, 0
s_mov_b64 exec, 1
buffer_atomic_add v100, v16, s[84:87], s62 offen sc0 sc1
s_mov_b64 exec, -1
s_waitcnt vmcnt(0)
v_readfirstlane_b32 s56, v100
s_cmp_gt_i32 s56, s42
s_cbranch_scc0 mega_kernel_q_kw0
s_mov_b32 m0, s61
s_nop 0
buffer_load_dwordx4 v5, s[84:87], s68 offen sc1 lds
mega_kernel_q_kl0:
s_waitcnt lgkmcnt(0) vmcnt(0)
s_barrier
ds_read_b128 v[184:187], v102 offset:0
ds_read_b128 v[112:115], v103 offset:0
ds_read_b128 v[128:131], v103 offset:1024
ds_read_b128 v[188:191], v102 offset:2048
ds_read_b128 v[116:119], v103 offset:2048
ds_read_b128 v[132:135], v103 offset:3072
ds_read_b128 v[192:195], v102 offset:4096
ds_read_b128 v[120:123], v103 offset:4096
ds_read_b128 v[136:139], v103 offset:5120
ds_read_b128 v[196:199], v102 offset:6144
ds_read_b128 v[124:127], v103 offset:6144
ds_read_b128 v[140:143], v103 offset:7168
s_waitcnt lgkmcnt(9)
v_mfma_f32_16x16x32_bf16 v[200:203], v[112:115], v[184:187], 0
v_mfma_f32_16x16x32_bf16 v[204:207], v[128:131], v[184:187], 0
ds_read_b128 v[160:163], v94 offset:0
s_waitcnt lgkmcnt(7)
v_mfma_f32_16x16x32_bf16 v[200:203], v[116:119], v[188:191], v[200:203]
v_mfma_f32_16x16x32_bf16 v[204:207], v[132:135], v[188:191], v[204:207]
ds_read_b128 v[164:167], v94 offset:1024
s_waitcnt lgkmcnt(5)
v_mfma_f32_16x16x32_bf16 v[200:203], v[120:123], v[192:195], v[200:203]
v_mfma_f32_16x16x32_bf16 v[204:207], v[136:139], v[192:195], v[204:207]
ds_read_b128 v[168:171], v94 offset:2048
s_waitcnt lgkmcnt(3)
v_mfma_f32_16x16x32_bf16 v[200:203], v[124:127], v[196:199], v[200:203]
v_mfma_f32_16x16x32_bf16 v[204:207], v[140:143], v[196:199], v[204:207]
ds_read_b128 v[172:175], v94 offset:3072
s_waitcnt lgkmcnt(3)
v_mfma_f32_16x16x32_bf16 v[208:211], v[160:163], v[184:187], 0
ds_read_b128 v[144:147], v240 offset:0
ds_read_b64 v[176:177], v95 offset:0
s_waitcnt lgkmcnt(4)
v_mfma_f32_16x16x32_bf16 v[208:211], v[164:167], v[188:191], v[208:211]
ds_read_b128 v[148:151], v240 offset:1024
ds_read_b64 v[178:179], v95 offset:256
s_waitcnt lgkmcnt(5)
v_mfma_f32_16x16x32_bf16 v[208:211], v[168:171], v[192:195], v[208:211]
ds_read_b128 v[152:155], v240 offset:2048
ds_read_b64 v[180:181], v95 offset:1024
s_waitcnt lgkmcnt(6)
v_mfma_f32_16x16x32_bf16 v[208:211], v[172:175], v[196:199], v[208:211]
ds_read_b128 v[156:159], v240 offset:3072
ds_read_b64 v[182:183], v95 offset:1280
v_pk_mul_f32 v[200:201], v[200:201], s[54:55] op_sel_hi:[1,0]
v_pk_mul_f32 v[202:203], v[202:203], s[54:55] op_sel_hi:[1,0]
v_pk_mul_f32 v[204:205], v[204:205], s[54:55] op_sel_hi:[1,0]
v_pk_mul_f32 v[206:207], v[206:207], s[54:55] op_sel_hi:[1,0]
v_cndmask_b32 v200, v200, v241, s[12:13]
v_cndmask_b32 v201, v201, v241, s[14:15]
v_cndmask_b32 v202, v202, v241, s[16:17]
v_cndmask_b32 v203, v203, v241, s[18:19]
v_cndmask_b32 v204, v204, v241, s[20:21]
v_cndmask_b32 v205, v205, v241, s[22:23]
v_cndmask_b32 v206, v206, v241, s[24:25]
v_cndmask_b32 v207, v207, v241, s[26:27]
v_pk_mul_f32 v[208:209], v[208:209], s[54:55] op_sel_hi:[1,0]
v_pk_mul_f32 v[210:211], v[210:211], s[54:55] op_sel_hi:[1,0]
v_cndmask_b32 v208, v208, v97, s[28:29]
v_cndmask_b32 v209, v209, v97, s[28:29]
v_cndmask_b32 v210, v210, v97, s[28:29]
v_cndmask_b32 v211, v211, v97, s[28:29]
v_max3_f32 v236, v200, v201, v202
v_max3_f32 v236, v236, v203, v204
v_max3_f32 v236, v236, v205, v206
v_max3_f32 v236, v236, v207, v208
v_max3_f32 v236, v236, v209, v210
v_max_f32 v237, v236, v211
v_max_f32 v236, v236, v211
s_nop 1
v_permlane16_swap_b32 v236, v237
s_nop 0
v_max_f32 v238, v236, v237
v_max_f32 v239, v236, v237
s_nop 1
v_permlane32_swap_b32 v238, v239
s_nop 0
v_max_f32 v236, v238, v239
v_pk_add_f32 v[200:201], v[200:201], v[236:237] op_sel_hi:[1,0] neg_lo:[0,1] neg_hi:[0,1]
v_pk_add_f32 v[202:203], v[202:203], v[236:237] op_sel_hi:[1,0] neg_lo:[0,1] neg_hi:[0,1]
v_pk_add_f32 v[204:205], v[204:205], v[236:237] op_sel_hi:[1,0] neg_lo:[0,1] neg_hi:[0,1]
v_pk_add_f32 v[206:207], v[206:207], v[236:237] op_sel_hi:[1,0] neg_lo:[0,1] neg_hi:[0,1]
v_pk_add_f32 v[208:209], v[208:209], v[236:237] op_sel_hi:[1,0] neg_lo:[0,1] neg_hi:[0,1]
v_pk_add_f32 v[210:211], v[210:211], v[236:237] op_sel_hi:[1,0] neg_lo:[0,1] neg_hi:[0,1]
v_exp_f32 v200, v200
v_exp_f32 v201, v201
v_exp_f32 v202, v202
v_exp_f32 v203, v203
v_exp_f32 v204, v204
v_exp_f32 v205, v205
v_exp_f32 v206, v206
v_exp_f32 v207, v207
v_exp_f32 v208, v208
v_exp_f32 v209, v209
v_exp_f32 v210, v210
v_exp_f32 v211, v211
s_nop 0
v_cvt_pk_bf16_f32 v212, v200, v201
v_cvt_pk_bf16_f32 v213, v202, v203
v_cvt_pk_bf16_f32 v214, v204, v205
v_cvt_pk_bf16_f32 v215, v206, v207
v_cvt_pk_bf16_f32 v216, v208, v209
v_cvt_pk_bf16_f32 v217, v210, v211
s_waitcnt lgkmcnt(0)
s_nop 0
v_mfma_f32_16x16x32_bf16 v[108:111], v[104:107], v[212:215], 0
v_mfma_f32_16x16x32_bf16 v[220:223], v[144:147], v[212:215], 0
v_mfma_f32_16x16x32_bf16 v[224:227], v[148:151], v[212:215], 0
v_mfma_f32_16x16x32_bf16 v[228:231], v[152:155], v[212:215], 0
v_mfma_f32_16x16x32_bf16 v[232:235], v[156:159], v[212:215], 0
v_mfma_f32_16x16x16_bf16 v[108:111], v[104:105], v[216:217], v[108:111]
v_mfma_f32_16x16x16_bf16 v[220:223], v[176:177], v[216:217], v[220:223]
v_mfma_f32_16x16x16_bf16 v[224:227], v[178:179], v[216:217], v[224:227]
v_mfma_f32_16x16x16_bf16 v[228:231], v[180:181], v[216:217], v[228:231]
v_mfma_f32_16x16x16_bf16 v[232:235], v[182:183], v[216:217], v[232:235]
s_lshl_b32 s51, s42, 18
s_nop 2
v_rcp_f32 v238, v108
v_rcp_f32 v239, v109
s_nop 1
v_pk_mul_f32 v[220:221], v[220:221], v[238:239]
v_pk_mul_f32 v[222:223], v[222:223], v[238:239]
v_pk_mul_f32 v[224:225], v[224:225], v[238:239]
v_pk_mul_f32 v[226:227], v[226:227], v[238:239]
v_pk_mul_f32 v[228:229], v[228:229], v[238:239]
v_pk_mul_f32 v[230:231], v[230:231], v[238:239]
v_pk_mul_f32 v[232:233], v[232:233], v[238:239]
v_pk_mul_f32 v[234:235], v[234:235], v[238:239]
v_cvt_pk_bf16_f32 v200, v220, v221
v_cvt_pk_bf16_f32 v201, v222, v223
v_cvt_pk_bf16_f32 v202, v224, v225
v_cvt_pk_bf16_f32 v203, v226, v227
v_cvt_pk_bf16_f32 v204, v228, v229
v_cvt_pk_bf16_f32 v205, v230, v231
v_cvt_pk_bf16_f32 v206, v232, v233
v_cvt_pk_bf16_f32 v207, v234, v235
buffer_store_dwordx4 v[200:203], v96, s[84:87], s51 offen sc1
buffer_store_dwordx4 v[204:207], v96, s[84:87], s51 offen offset:2048 sc1
s_add_u32 s42, s42, 1
s_cmp_lt_u32 s42, 64
s_cbranch_scc1 mega_kernel_q_loop
s_waitcnt vmcnt(0)
v_mov_b32 v17, s42
s_mov_b64 exec, 1
buffer_store_dword v17, v16, s[84:87], s49 offen sc1
s_mov_b64 exec, -1
mega_kernel_q_quit:
s_endpgm
mega_kernel_rd:
s_mov_b32 s93, s40
s_load_dwordx2 s[4:5], s[0:1], 64
s_load_dwordx2 s[8:9], s[0:1], 72
v_and_b32 v1, 63, v0
v_lshrrev_b32 v2, 6, v0
v_mul_u32_u24 v3, 1026, v2
v_lshl_add_u32 v3, v1, 1, v3
v_mul_u32_u24 v4, 65, v1
v_add_u32 v4, v4, v2
v_lshlrev_b32 v4, 2, v4
v_lshrrev_b32 v7, 4, v0
v_and_b32 v8, 15, v0
v_mul_u32_u24 v5, 65, v7
v_lshl_add_u32 v5, v8, 2, v5
v_lshlrev_b32 v5, 2, v5
v_mul_u32_u24 v6, 8192, v7
v_lshl_add_u32 v6, v8, 4, v6
s_add_u32 s24, s84, 121634816
s_addc_u32 s25, s85, 0
s_mov_b32 s26, 4202496
s_mov_b32 s27, 0x00020000
s_waitcnt lgkmcnt(0)
s_mov_b32 s6, 2101248
s_mov_b32 s7, 0x00020000
s_mov_b32 s10, 2101248
s_mov_b32 s11, 0x00020000
s_cmp_lt_u32 s93, 288
s_cbranch_scc0 mega_kernel_f0_e
s_and_b32 s12, s93, 31
s_mul_i32 s12, s12, 65664
s_lshr_b32 s13, s93, 5
s_lshl_b32 s13, s13, 7
s_add_u32 s12, s12, s13
buffer_load_ushort v16, v3, s[4:7], s12 offen
buffer_load_ushort v32, v3, s[8:11], s12 offen
s_add_u32 s12, s12, 4104
buffer_load_ushort v17, v3, s[4:7], s12 offen
buffer_load_ushort v33, v3, s[8:11], s12 offen
s_add_u32 s12, s12, 4104
buffer_load_ushort v18, v3, s[4:7], s12 offen
buffer_load_ushort v34, v3, s[8:11], s12 offen
s_add_u32 s12, s12, 4104
buffer_load_ushort v19, v3, s[4:7], s12 offen
buffer_load_ushort v35, v3, s[8:11], s12 offen
s_add_u32 s12, s12, 4104
buffer_load_ushort v20, v3, s[4:7], s12 offen
buffer_load_ushort v36, v3, s[8:11], s12 offen
s_add_u32 s12, s12, 4104
buffer_load_ushort v21, v3, s[4:7], s12 offen
buffer_load_ushort v37, v3, s[8:11], s12 offen
s_add_u32 s12, s12, 4104
buffer_load_ushort v22, v3, s[4:7], s12 offen
buffer_load_ushort v38, v3, s[8:11], s12 offen
s_add_u32 s12, s12, 4104
buffer_load_ushort v23, v3, s[4:7], s12 offen
buffer_load_ushort v39, v3, s[8:11], s12 offen
s_add_u32 s12, s12, 4104
buffer_load_ushort v24, v3, s[4:7], s12 offen
buffer_load_ushort v40, v3, s[8:11], s12 offen
s_add_u32 s12, s12, 4104
buffer_load_ushort v25, v3, s[4:7], s12 offen
buffer_load_ushort v41, v3, s[8:11], s12 offen
s_add_u32 s12, s12, 4104
buffer_load_ushort v26, v3, s[4:7], s12 offen
buffer_load_ushort v42, v3, s[8:11], s12 offen
s_add_u32 s12, s12, 4104
buffer_load_ushort v27, v3, s[4:7], s12 offen
buffer_load_ushort v43, v3, s[8:11], s12 offen
s_add_u32 s12, s12, 4104
buffer_load_ushort v28, v3, s[4:7], s12 offen
buffer_load_ushort v44, v3, s[8:11], s12 offen
s_add_u32 s12, s12, 4104
buffer_load_ushort v29, v3, s[4:7], s12 offen
buffer_load_ushort v45, v3, s[8:11], s12 offen
s_add_u32 s12, s12, 4104
buffer_load_ushort v30, v3, s[4:7], s12 offen
buffer_load_ushort v46, v3, s[8:11], s12 offen
s_add_u32 s12, s12, 4104
buffer_load_ushort v31, v3, s[4:7], s12 offen
buffer_load_ushort v47, v3, s[8:11], s12 offen
s_add_u32 s12, s12, 4104
s_waitcnt vmcnt(0)
mega_kernel_f0_l:
s_add_u32 s21, s93, 32
s_cmp_lt_u32 s21, 288
s_cselect_b32 s22, s21, s93
s_waitcnt vmcnt(4)
v_lshl_or_b32 v48, v32, 16, v16
v_lshl_or_b32 v49, v33, 16, v17
v_lshl_or_b32 v50, v34, 16, v18
v_lshl_or_b32 v51, v35, 16, v19
v_lshl_or_b32 v52, v36, 16, v20
v_lshl_or_b32 v53, v37, 16, v21
v_lshl_or_b32 v54, v38, 16, v22
v_lshl_or_b32 v55, v39, 16, v23
v_lshl_or_b32 v56, v40, 16, v24
v_lshl_or_b32 v57, v41, 16, v25
v_lshl_or_b32 v58, v42, 16, v26
v_lshl_or_b32 v59, v43, 16, v27
v_lshl_or_b32 v60, v44, 16, v28
v_lshl_or_b32 v61, v45, 16, v29
v_lshl_or_b32 v62, v46, 16, v30
v_lshl_or_b32 v63, v47, 16, v31
s_and_b32 s12, s22, 31
s_mul_i32 s12, s12, 65664
s_lshr_b32 s13, s22, 5
s_lshl_b32 s13, s13, 7
s_add_u32 s12, s12, s13
buffer_load_ushort v16, v3, s[4:7], s12 offen
buffer_load_ushort v32, v3, s[8:11], s12 offen
s_add_u32 s12, s12, 4104
buffer_load_ushort v17, v3, s[4:7], s12 offen
buffer_load_ushort v33, v3, s[8:11], s12 offen
s_add_u32 s12, s12, 4104
buffer_load_ushort v18, v3, s[4:7], s12 offen
buffer_load_ushort v34, v3, s[8:11], s12 offen
s_add_u32 s12, s12, 4104
buffer_load_ushort v19, v3, s[4:7], s12 offen
buffer_load_ushort v35, v3, s[8:11], s12 offen
s_add_u32 s12, s12, 4104
buffer_load_ushort v20, v3, s[4:7], s12 offen
buffer_load_ushort v36, v3, s[8:11], s12 offen
s_add_u32 s12, s12, 4104
buffer_load_ushort v21, v3, s[4:7], s12 offen
buffer_load_ushort v37, v3, s[8:11], s12 offen
s_add_u32 s12, s12, 4104
buffer_load_ushort v22, v3, s[4:7], s12 offen
buffer_load_ushort v38, v3, s[8:11], s12 offen
s_add_u32 s12, s12, 4104
buffer_load_ushort v23, v3, s[4:7], s12 offen
buffer_load_ushort v39, v3, s[8:11], s12 offen
s_add_u32 s12, s12, 4104
buffer_load_ushort v24, v3, s[4:7], s12 offen
buffer_load_ushort v40, v3, s[8:11], s12 offen
s_add_u32 s12, s12, 4104
buffer_load_ushort v25, v3, s[4:7], s12 offen
buffer_load_ushort v41, v3, s[8:11], s12 offen
s_add_u32 s12, s12, 4104
buffer_load_ushort v26, v3, s[4:7], s12 offen
buffer_load_ushort v42, v3, s[8:11], s12 offen
s_add_u32 s12, s12, 4104
buffer_load_ushort v27, v3, s[4:7], s12 offen
buffer_load_ushort v43, v3, s[8:11], s12 offen
s_add_u32 s12, s12, 4104
buffer_load_ushort v28, v3, s[4:7], s12 offen
buffer_load_ushort v44, v3, s[8:11], s12 offen
s_add_u32 s12, s12, 4104
buffer_load_ushort v29, v3, s[4:7], s12 offen
buffer_load_ushort v45, v3, s[8:11], s12 offen
s_add_u32 s12, s12, 4104
buffer_load_ushort v30, v3, s[4:7], s12 offen
buffer_load_ushort v46, v3, s[8:11], s12 offen
s_add_u32 s12, s12, 4104
buffer_load_ushort v31, v3, s[4:7], s12 offen
buffer_load_ushort v47, v3, s[8:11], s12 offen
s_add_u32 s12, s12, 4104
s_barrier
ds_write_b32 v4, v48 offset:0
ds_write_b32 v4, v49 offset:16
ds_write_b32 v4, v50 offset:32
ds_write_b32 v4, v51 offset:48
ds_write_b32 v4, v52 offset:64
ds_write_b32 v4, v53 offset:80
ds_write_b32 v4, v54 offset:96
ds_write_b32 v4, v55 offset:112
ds_write_b32 v4, v56 offset:128
ds_write_b32 v4, v57 offset:144
ds_write_b32 v4, v58 offset:160
ds_write_b32 v4, v59 offset:176
s_waitcnt lgkmcnt(4)
ds_write_b32 v4, v60 offset:192
ds_write_b32 v4, v61 offset:208
ds_write_b32 v4, v62 offset:224
ds_write_b32 v4, v63 offset:240
s_waitcnt lgkmcnt(0)
s_barrier
ds_read2_b32 v[64:65], v5 offset0:0 offset1:1
ds_read_b32 v66, v5 offset:8
ds_read_b32 v67, v5 offset:12
ds_read_b32 v68, v5 offset:4160
ds_read_b32 v69, v5 offset:4164
ds_read_b32 v70, v5 offset:4168
ds_read_b32 v71, v5 offset:4172
ds_read_b32 v72, v5 offset:8320
ds_read_b32 v73, v5 offset:8324
ds_read_b32 v74, v5 offset:8328
ds_read_b32 v75, v5 offset:8332
ds_read_b32 v76, v5 offset:12480
ds_read_b32 v77, v5 offset:12484
ds_read_b32 v78, v5 offset:12488
ds_read_b32 v79, v5 offset:12492
s_and_b32 s14, s93, 31
s_lshl_b32 s14, s14, 8
s_lshr_b32 s15, s93, 5
s_mul_i32 s15, s15, 524288
s_add_u32 s14, s14, s15
s_waitcnt lgkmcnt(0)
buffer_store_dwordx4 v[64:67], v6, s[24:27], s14 offen sc1
s_add_u32 s14, s14, 131072
buffer_store_dwordx4 v[68:71], v6, s[24:27], s14 offen sc1
s_add_u32 s14, s14, 131072
buffer_store_dwordx4 v[72:75], v6, s[24:27], s14 offen sc1
s_add_u32 s14, s14, 131072
buffer_store_dwordx4 v[76:79], v6, s[24:27], s14 offen sc1
s_add_u32 s14, s14, 131072
s_mov_b32 s93, s21
s_cmp_lt_u32 s93, 288
s_cbranch_scc1 mega_kernel_f0_l
mega_kernel_f0_e:
s_mov_b32 s93, s40
s_waitcnt vmcnt(0)
s_load_dwordx2 s[4:5], s[0:1], 56
s_mov_b32 s48, 0x3f7ec46d
s_mov_b32 s49, 0x3dc8bd36
s_mov_b32 s50, 0x3f7b14be
s_mov_b32 s51, 0x3e47c5c2
s_mov_b32 s52, 0x3f74fa0b
s_mov_b32 s53, 0x3e94a031
s_mov_b32 s54, 0x3f6c835e
s_mov_b32 s55, 0x3ec3ef15
s_mov_b32 s56, 0x3f61c598
s_mov_b32 s57, 0x3ef15aea
s_mov_b32 s58, 0x3f54db31
s_mov_b32 s59, 0x3f0e39da
s_mov_b32 s60, 0x3f45e403
s_mov_b32 s61, 0x3f226799
s_mov_b32 s62, 0x3f3504f3
s_mov_b32 s63, 0x3f3504f3
v_and_b32 v1, 31, v0
v_lshrrev_b32 v2, 5, v0
v_cvt_f32_u32 v3, v1
v_mul_u32_u24 v10, 8448, v2
v_lshl_add_u32 v4, v1, 3, v10
v_mul_u32_u24 v5, 264, v1
v_add_u32 v5, v5, v10
v_and_b32 v11, 7, v0
v_lshrrev_b32 v9, 3, v0
v_mul_u32_u24 v10, 8448, v11
v_lshl_add_u32 v6, v9, 3, v10
v_lshlrev_b32 v7, 3, v9
v_sub_u32 v7, v10, v7
v_add_u32 v7, 4096, v7
v_mul_u32_u24 v8, 16384, v9
v_lshl_add_u32 v8, v11, 4, v8
v_mul_f32 v12, 0xba800000, v3
v_cos_f32 v82, v12
v_sin_f32 v83, v12
v_mul_f32 v12, 0xbb000000, v3
v_cos_f32 v84, v12
v_sin_f32 v85, v12
v_mul_f32 v12, 0xbb400000, v3
v_cos_f32 v86, v12
v_sin_f32 v87, v12
v_mul_f32 v12, 0xbb800000, v3
v_cos_f32 v88, v12
v_sin_f32 v89, v12
v_mul_f32 v12, 0xbba00000, v3
v_cos_f32 v90, v12
v_sin_f32 v91, v12
v_mul_f32 v12, 0xbbc00000, v3
v_cos_f32 v92, v12
v_sin_f32 v93, v12
v_mul_f32 v12, 0xbbe00000, v3
v_cos_f32 v94, v12
v_sin_f32 v95, v12
v_mul_f32 v12, 0xbc000000, v3
v_cos_f32 v96, v12
v_sin_f32 v97, v12
v_mul_f32 v12, 0xbc100000, v3
v_cos_f32 v98, v12
v_sin_f32 v99, v12
v_mul_f32 v12, 0xbc200000, v3
v_cos_f32 v100, v12
v_sin_f32 v101, v12
v_mul_f32 v12, 0xbc300000, v3
v_cos_f32 v102, v12
v_sin_f32 v103, v12
v_mul_f32 v12, 0xbc400000, v3
v_cos_f32 v104, v12
v_sin_f32 v105, v12
v_mul_f32 v12, 0xbc500000, v3
v_cos_f32 v106, v12
v_sin_f32 v107, v12
v_mul_f32 v12, 0xbc600000, v3
v_cos_f32 v108, v12
v_sin_f32 v109, v12
v_mul_f32 v12, 0xbc700000, v3
v_cos_f32 v110, v12
v_sin_f32 v111, v12
v_mul_f32 v12, 0xbc800000, v3
v_cos_f32 v112, v12
v_sin_f32 v113, v12
v_mul_f32 v12, 0xbc880000, v3
v_cos_f32 v114, v12
v_sin_f32 v115, v12
v_mul_f32 v12, 0xbc900000, v3
v_cos_f32 v116, v12
v_sin_f32 v117, v12
v_mul_f32 v12, 0xbc980000, v3
v_cos_f32 v118, v12
v_sin_f32 v119, v12
v_mul_f32 v12, 0xbca00000, v3
v_cos_f32 v120, v12
v_sin_f32 v121, v12
v_mul_f32 v12, 0xbca80000, v3
v_cos_f32 v122, v12
v_sin_f32 v123, v12
v_mul_f32 v12, 0xbcb00000, v3
v_cos_f32 v124, v12
v_sin_f32 v125, v12
v_mul_f32 v12, 0xbcb80000, v3
v_cos_f32 v126, v12
v_sin_f32 v127, v12
v_mul_f32 v12, 0xbcc00000, v3
v_cos_f32 v128, v12
v_sin_f32 v129, v12
v_mul_f32 v12, 0xbcc80000, v3
v_cos_f32 v130, v12
v_sin_f32 v131, v12
v_mul_f32 v12, 0xbcd00000, v3
v_cos_f32 v132, v12
v_sin_f32 v133, v12
v_mul_f32 v12, 0xbcd80000, v3
v_cos_f32 v134, v12
v_sin_f32 v135, v12
v_mul_f32 v12, 0xbce00000, v3
v_cos_f32 v136, v12
v_sin_f32 v137, v12
v_mul_f32 v12, 0xbce80000, v3
v_cos_f32 v138, v12
v_sin_f32 v139, v12
v_mul_f32 v12, 0xbcf00000, v3
v_cos_f32 v140, v12
v_sin_f32 v141, v12
v_mul_f32 v12, 0xbcf80000, v3
v_cos_f32 v142, v12
v_sin_f32 v143, v12
v_lshlrev_b32 v12, 12, v2
v_lshl_add_u32 v12, v1, 1, v12
s_waitcnt lgkmcnt(0)
s_mov_b32 s6, 4194304
s_mov_b32 s7, 0x00020000
v_mov_b32 v144, 0
v_mov_b32 v145, 0
v_mov_b32 v146, 0
v_mov_b32 v147, 0
v_mov_b32 v148, 0
v_mov_b32 v149, 0
v_mov_b32 v150, 0
v_mov_b32 v151, 0
v_mov_b32 v152, 0
v_mov_b32 v153, 0
v_mov_b32 v154, 0
v_mov_b32 v155, 0
v_mov_b32 v156, 0
v_mov_b32 v157, 0
v_mov_b32 v158, 0
v_mov_b32 v159, 0
v_mov_b32 v160, 0
v_mov_b32 v161, 0
v_mov_b32 v162, 0
v_mov_b32 v163, 0
v_mov_b32 v164, 0
v_mov_b32 v165, 0
v_mov_b32 v166, 0
v_mov_b32 v167, 0
v_mov_b32 v168, 0
v_mov_b32 v169, 0
v_mov_b32 v170, 0
v_mov_b32 v171, 0
v_mov_b32 v172, 0
v_mov_b32 v173, 0
v_mov_b32 v174, 0
v_mov_b32 v175, 0
v_mov_b32 v176, 0
v_mov_b32 v177, 0
v_mov_b32 v178, 0
v_mov_b32 v179, 0
v_mov_b32 v180, 0
v_mov_b32 v181, 0
v_mov_b32 v182, 0
v_mov_b32 v183, 0
v_mov_b32 v184, 0
v_mov_b32 v185, 0
v_mov_b32 v186, 0
v_mov_b32 v187, 0
v_mov_b32 v188, 0
v_mov_b32 v189, 0
v_mov_b32 v190, 0
v_mov_b32 v191, 0
v_mov_b32 v192, 0
v_mov_b32 v193, 0
v_mov_b32 v194, 0
v_mov_b32 v195, 0
v_mov_b32 v196, 0
v_mov_b32 v197, 0
v_mov_b32 v198, 0
v_mov_b32 v199, 0
v_mov_b32 v200, 0
v_mov_b32 v201, 0
v_mov_b32 v202, 0
v_mov_b32 v203, 0
v_mov_b32 v204, 0
v_mov_b32 v205, 0
v_mov_b32 v206, 0
v_mov_b32 v207, 0
s_cmp_lt_u32 s93, 128
s_cbranch_scc0 mega_kernel_f1_e
s_lshl_b32 s12, s93, 15
buffer_load_short_d16_hi v144, v12, s[4:7], s12 offen offset:0
buffer_load_short_d16_hi v145, v12, s[4:7], s12 offen offset:2048
buffer_load_short_d16_hi v176, v12, s[4:7], s12 offen offset:1024
buffer_load_short_d16_hi v177, v12, s[4:7], s12 offen offset:3072
buffer_load_short_d16_hi v146, v12, s[4:7], s12 offen offset:64
buffer_load_short_d16_hi v147, v12, s[4:7], s12 offen offset:2112
buffer_load_short_d16_hi v178, v12, s[4:7], s12 offen offset:1088
buffer_load_short_d16_hi v179, v12, s[4:7], s12 offen offset:3136
buffer_load_short_d16_hi v148, v12, s[4:7], s12 offen offset:128
buffer_load_short_d16_hi v149, v12, s[4:7], s12 offen offset:2176
buffer_load_short_d16_hi v180, v12, s[4:7], s12 offen offset:1152
buffer_load_short_d16_hi v181, v12, s[4:7], s12 offen offset:3200
buffer_load_short_d16_hi v150, v12, s[4:7], s12 offen offset:192
buffer_load_short_d16_hi v151, v12, s[4:7], s12 offen offset:2240
buffer_load_short_d16_hi v182, v12, s[4:7], s12 offen offset:1216
buffer_load_short_d16_hi v183, v12, s[4:7], s12 offen offset:3264
buffer_load_short_d16_hi v152, v12, s[4:7], s12 offen offset:256
buffer_load_short_d16_hi v153, v12, s[4:7], s12 offen offset:2304
buffer_load_short_d16_hi v184, v12, s[4:7], s12 offen offset:1280
buffer_load_short_d16_hi v185, v12, s[4:7], s12 offen offset:3328
buffer_load_short_d16_hi v154, v12, s[4:7], s12 offen offset:320
buffer_load_short_d16_hi v155, v12, s[4:7], s12 offen offset:2368
buffer_load_short_d16_hi v186, v12, s[4:7], s12 offen offset:1344
buffer_load_short_d16_hi v187, v12, s[4:7], s12 offen offset:3392
buffer_load_short_d16_hi v156, v12, s[4:7], s12 offen offset:384
buffer_load_short_d16_hi v157, v12, s[4:7], s12 offen offset:2432
buffer_load_short_d16_hi v188, v12, s[4:7], s12 offen offset:1408
buffer_load_short_d16_hi v189, v12, s[4:7], s12 offen offset:3456
buffer_load_short_d16_hi v158, v12, s[4:7], s12 offen offset:448
buffer_load_short_d16_hi v159, v12, s[4:7], s12 offen offset:2496
buffer_load_short_d16_hi v190, v12, s[4:7], s12 offen offset:1472
buffer_load_short_d16_hi v191, v12, s[4:7], s12 offen offset:3520
buffer_load_short_d16_hi v160, v12, s[4:7], s12 offen offset:512
buffer_load_short_d16_hi v161, v12, s[4:7], s12 offen offset:2560
buffer_load_short_d16_hi v192, v12, s[4:7], s12 offen offset:1536
buffer_load_short_d16_hi v193, v12, s[4:7], s12 offen offset:3584
buffer_load_short_d16_hi v162, v12, s[4:7], s12 offen offset:576
buffer_load_short_d16_hi v163, v12, s[4:7], s12 offen offset:2624
buffer_load_short_d16_hi v194, v12, s[4:7], s12 offen offset:1600
buffer_load_short_d16_hi v195, v12, s[4:7], s12 offen offset:3648
buffer_load_short_d16_hi v164, v12, s[4:7], s12 offen offset:640
buffer_load_short_d16_hi v165, v12, s[4:7], s12 offen offset:2688
buffer_load_short_d16_hi v196, v12, s[4:7], s12 offen offset:1664
buffer_load_short_d16_hi v197, v12, s[4:7], s12 offen offset:3712
buffer_load_short_d16_hi v166, v12, s[4:7], s12 offen offset:704
buffer_load_short_d16_hi v167, v12, s[4:7], s12 offen offset:2752
buffer_load_short_d16_hi v198, v12, s[4:7], s12 offen offset:1728
buffer_load_short_d16_hi v199, v12, s[4:7], s12 offen offset:3776
buffer_load_short_d16_hi v168, v12, s[4:7], s12 offen offset:768
buffer_load_short_d16_hi v169, v12, s[4:7], s12 offen offset:2816
buffer_load_short_d16_hi v200, v12, s[4:7], s12 offen offset:1792
buffer_load_short_d16_hi v201, v12, s[4:7], s12 offen offset:3840
buffer_load_short_d16_hi v170, v12, s[4:7], s12 offen offset:832
buffer_load_short_d16_hi v171, v12, s[4:7], s12 offen offset:2880
buffer_load_short_d16_hi v202, v12, s[4:7], s12 offen offset:1856
buffer_load_short_d16_hi v203, v12, s[4:7], s12 offen offset:3904
buffer_load_short_d16_hi v172, v12, s[4:7], s12 offen offset:896
buffer_load_short_d16_hi v173, v12, s[4:7], s12 offen offset:2944
buffer_load_short_d16_hi v204, v12, s[4:7], s12 offen offset:1920
buffer_load_short_d16_hi v205, v12, s[4:7], s12 offen offset:3968
buffer_load_short_d16_hi v174, v12, s[4:7], s12 offen offset:960
buffer_load_short_d16_hi v175, v12, s[4:7], s12 offen offset:3008
buffer_load_short_d16_hi v206, v12, s[4:7], s12 offen offset:1984
buffer_load_short_d16_hi v207, v12, s[4:7], s12 offen offset:4032
s_waitcnt vmcnt(0)
mega_kernel_f1_l:
s_add_u32 s21, s93, 32
s_cmp_lt_u32 s21, 128
s_cselect_b32 s22, s21, s93
s_waitcnt vmcnt(17)
v_pk_add_f32 v[48:49], v[144:145], v[176:177] neg_lo:[0,1] neg_hi:[0,1]
v_pk_add_f32 v[16:17], v[144:145], v[176:177]
v_pk_add_f32 v[14:15], v[146:147], v[178:179] neg_lo:[0,1] neg_hi:[0,1]
v_pk_add_f32 v[18:19], v[146:147], v[178:179]
v_pk_mul_f32 v[50:51], v[14:15], s[50:51] op_sel:[0,0] op_sel_hi:[0,1] neg_lo:[0,0] neg_hi:[0,1]
v_pk_fma_f32 v[50:51], v[14:15], s[50:51], v[50:51] op_sel:[1,1,0] op_sel_hi:[1,0,1] neg_lo:[0,0,0] neg_hi:[0,0,0]
v_pk_add_f32 v[14:15], v[148:149], v[180:181] neg_lo:[0,1] neg_hi:[0,1]
v_pk_add_f32 v[20:21], v[148:149], v[180:181]
v_pk_mul_f32 v[52:53], v[14:15], s[54:55] op_sel:[0,0] op_sel_hi:[0,1] neg_lo:[0,0] neg_hi:[0,1]
v_pk_fma_f32 v[52:53], v[14:15], s[54:55], v[52:53] op_sel:[1,1,0] op_sel_hi:[1,0,1] neg_lo:[0,0,0] neg_hi:[0,0,0]
v_pk_add_f32 v[14:15], v[150:151], v[182:183] neg_lo:[0,1] neg_hi:[0,1]
v_pk_add_f32 v[22:23], v[150:151], v[182:183]
v_pk_mul_f32 v[54:55], v[14:15], s[58:59] op_sel:[0,0] op_sel_hi:[0,1] neg_lo:[0,0] neg_hi:[0,1]
v_pk_fma_f32 v[54:55], v[14:15], s[58:59], v[54:55] op_sel:[1,1,0] op_sel_hi:[1,0,1] neg_lo:[0,0,0] neg_hi:[0,0,0]
v_pk_add_f32 v[14:15], v[152:153], v[184:185] neg_lo:[0,1] neg_hi:[0,1]
v_pk_add_f32 v[24:25], v[152:153], v[184:185]
v_pk_mul_f32 v[56:57], v[14:15], s[62:63] op_sel:[0,0] op_sel_hi:[0,1] neg_lo:[0,0] neg_hi:[0,1]
v_pk_fma_f32 v[56:57], v[14:15], s[62:63], v[56:57] op_sel:[1,1,0] op_sel_hi:[1,0,1] neg_lo:[0,0,0] neg_hi:[0,0,0]
v_pk_add_f32 v[14:15], v[154:155], v[186:187] neg_lo:[0,1] neg_hi:[0,1]
v_pk_add_f32 v[26:27], v[154:155], v[186:187]
v_pk_mul_f32 v[58:59], v[14:15], s[58:59] op_sel:[0,1] op_sel_hi:[0,0] neg_lo:[0,0] neg_hi:[0,1]
v_pk_fma_f32 v[58:59], v[14:15], s[58:59], v[58:59] op_sel:[1,0,0] op_sel_hi:[1,1,1] neg_lo:[0,0,0] neg_hi:[0,0,0]
v_pk_add_f32 v[14:15], v[156:157], v[188:189] neg_lo:[0,1] neg_hi:[0,1]
v_pk_add_f32 v[28:29], v[156:157], v[188:189]
v_pk_mul_f32 v[60:61], v[14:15], s[54:55] op_sel:[0,1] op_sel_hi:[0,0] neg_lo:[0,0] neg_hi:[0,1]
v_pk_fma_f32 v[60:61], v[14:15], s[54:55], v[60:61] op_sel:[1,0,0] op_sel_hi:[1,1,1] neg_lo:[0,0,0] neg_hi:[0,0,0]
v_pk_add_f32 v[14:15], v[158:159], v[190:191] neg_lo:[0,1] neg_hi:[0,1]
v_pk_add_f32 v[30:31], v[158:159], v[190:191]
v_pk_mul_f32 v[62:63], v[14:15], s[50:51] op_sel:[0,1] op_sel_hi:[0,0] neg_lo:[0,0] neg_hi:[0,1]
v_pk_fma_f32 v[62:63], v[14:15], s[50:51], v[62:63] op_sel:[1,0,0] op_sel_hi:[1,1,1] neg_lo:[0,0,0] neg_hi:[0,0,0]
v_pk_add_f32 v[64:65], v[160:161], v[192:193] op_sel:[1,1] op_sel_hi:[0,0] neg_lo:[0,1] neg_hi:[1,0]
v_pk_add_f32 v[32:33], v[160:161], v[192:193]
v_pk_add_f32 v[14:15], v[162:163], v[194:195] neg_lo:[0,1] neg_hi:[0,1]
v_pk_add_f32 v[34:35], v[162:163], v[194:195]
v_pk_mul_f32 v[66:67], v[14:15], s[50:51] op_sel:[0,1] op_sel_hi:[0,0] neg_lo:[0,1] neg_hi:[0,1]
v_pk_fma_f32 v[66:67], v[14:15], s[50:51], v[66:67] op_sel:[1,0,0] op_sel_hi:[1,1,1] neg_lo:[0,0,0] neg_hi:[0,1,0]
v_pk_add_f32 v[14:15], v[164:165], v[196:197] neg_lo:[0,1] neg_hi:[0,1]
v_pk_add_f32 v[36:37], v[164:165], v[196:197]
v_pk_mul_f32 v[68:69], v[14:15], s[54:55] op_sel:[0,1] op_sel_hi:[0,0] neg_lo:[0,1] neg_hi:[0,1]
v_pk_fma_f32 v[68:69], v[14:15], s[54:55], v[68:69] op_sel:[1,0,0] op_sel_hi:[1,1,1] neg_lo:[0,0,0] neg_hi:[0,1,0]
v_pk_add_f32 v[14:15], v[166:167], v[198:199] neg_lo:[0,1] neg_hi:[0,1]
v_pk_add_f32 v[38:39], v[166:167], v[198:199]
v_pk_mul_f32 v[70:71], v[14:15], s[58:59] op_sel:[0,1] op_sel_hi:[0,0] neg_lo:[0,1] neg_hi:[0,1]
v_pk_fma_f32 v[70:71], v[14:15], s[58:59], v[70:71] op_sel:[1,0,0] op_sel_hi:[1,1,1] neg_lo:[0,0,0] neg_hi:[0,1,0]
v_pk_add_f32 v[14:15], v[168:169], v[200:201] neg_lo:[0,1] neg_hi:[0,1]
v_pk_add_f32 v[40:41], v[168:169], v[200:201]
v_pk_mul_f32 v[72:73], v[14:15], s[62:63] op_sel:[0,0] op_sel_hi:[0,1] neg_lo:[0,1] neg_hi:[0,1]
v_pk_fma_f32 v[72:73], v[14:15], s[62:63], v[72:73] op_sel:[1,1,0] op_sel_hi:[1,0,1] neg_lo:[0,0,0] neg_hi:[0,1,0]
v_pk_add_f32 v[14:15], v[170:171], v[202:203] neg_lo:[0,1] neg_hi:[0,1]
v_pk_add_f32 v[42:43], v[170:171], v[202:203]
v_pk_mul_f32 v[74:75], v[14:15], s[58:59] op_sel:[0,0] op_sel_hi:[0,1] neg_lo:[0,1] neg_hi:[0,1]
v_pk_fma_f32 v[74:75], v[14:15], s[58:59], v[74:75] op_sel:[1,1,0] op_sel_hi:[1,0,1] neg_lo:[0,0,0] neg_hi:[0,1,0]
v_pk_add_f32 v[14:15], v[172:173], v[204:205] neg_lo:[0,1] neg_hi:[0,1]
v_pk_add_f32 v[44:45], v[172:173], v[204:205]
v_pk_mul_f32 v[76:77], v[14:15], s[54:55] op_sel:[0,0] op_sel_hi:[0,1] neg_lo:[0,1] neg_hi:[0,1]
v_pk_fma_f32 v[76:77], v[14:15], s[54:55], v[76:77] op_sel:[1,1,0] op_sel_hi:[1,0,1] neg_lo:[0,0,0] neg_hi:[0,1,0]
v_pk_add_f32 v[14:15], v[174:175], v[206:207] neg_lo:[0,1] neg_hi:[0,1]
v_pk_add_f32 v[46:47], v[174:175], v[206:207]
v_pk_mul_f32 v[78:79], v[14:15], s[50:51] op_sel:[0,0] op_sel_hi:[0,1] neg_lo:[0,1] neg_hi:[0,1]
v_pk_fma_f32 v[78:79], v[14:15], s[50:51], v[78:79] op_sel:[1,1,0] op_sel_hi:[1,0,1] neg_lo:[0,0,0] neg_hi:[0,1,0]
s_lshl_b32 s12, s22, 15
buffer_load_short_d16_hi v144, v12, s[4:7], s12 offen offset:0
buffer_load_short_d16_hi v145, v12, s[4:7], s12 offen offset:2048
buffer_load_short_d16_hi v176, v12, s[4:7], s12 offen offset:1024
buffer_load_short_d16_hi v177, v12, s[4:7], s12 offen offset:3072
buffer_load_short_d16_hi v146, v12, s[4:7], s12 offen offset:64
buffer_load_short_d16_hi v147, v12, s[4:7], s12 offen offset:2112
buffer_load_short_d16_hi v178, v12, s[4:7], s12 offen offset:1088
buffer_load_short_d16_hi v179, v12, s[4:7], s12 offen offset:3136
buffer_load_short_d16_hi v148, v12, s[4:7], s12 offen offset:128
buffer_load_short_d16_hi v149, v12, s[4:7], s12 offen offset:2176
buffer_load_short_d16_hi v180, v12, s[4:7], s12 offen offset:1152
buffer_load_short_d16_hi v181, v12, s[4:7], s12 offen offset:3200
buffer_load_short_d16_hi v150, v12, s[4:7], s12 offen offset:192
buffer_load_short_d16_hi v151, v12, s[4:7], s12 offen offset:2240
buffer_load_short_d16_hi v182, v12, s[4:7], s12 offen offset:1216
buffer_load_short_d16_hi v183, v12, s[4:7], s12 offen offset:3264
buffer_load_short_d16_hi v152, v12, s[4:7], s12 offen offset:256
buffer_load_short_d16_hi v153, v12, s[4:7], s12 offen offset:2304
buffer_load_short_d16_hi v184, v12, s[4:7], s12 offen offset:1280
buffer_load_short_d16_hi v185, v12, s[4:7], s12 offen offset:3328
buffer_load_short_d16_hi v154, v12, s[4:7], s12 offen offset:320
buffer_load_short_d16_hi v155, v12, s[4:7], s12 offen offset:2368
buffer_load_short_d16_hi v186, v12, s[4:7], s12 offen offset:1344
buffer_load_short_d16_hi v187, v12, s[4:7], s12 offen offset:3392
buffer_load_short_d16_hi v156, v12, s[4:7], s12 offen offset:384
buffer_load_short_d16_hi v157, v12, s[4:7], s12 offen offset:2432
buffer_load_short_d16_hi v188, v12, s[4:7], s12 offen offset:1408
buffer_load_short_d16_hi v189, v12, s[4:7], s12 offen offset:3456
buffer_load_short_d16_hi v158, v12, s[4:7], s12 offen offset:448
buffer_load_short_d16_hi v159, v12, s[4:7], s12 offen offset:2496
buffer_load_short_d16_hi v190, v12, s[4:7], s12 offen offset:1472
buffer_load_short_d16_hi v191, v12, s[4:7], s12 offen offset:3520
buffer_load_short_d16_hi v160, v12, s[4:7], s12 offen offset:512
buffer_load_short_d16_hi v161, v12, s[4:7], s12 offen offset:2560
buffer_load_short_d16_hi v192, v12, s[4:7], s12 offen offset:1536
buffer_load_short_d16_hi v193, v12, s[4:7], s12 offen offset:3584
buffer_load_short_d16_hi v162, v12, s[4:7], s12 offen offset:576
buffer_load_short_d16_hi v163, v12, s[4:7], s12 offen offset:2624
buffer_load_short_d16_hi v194, v12, s[4:7], s12 offen offset:1600
buffer_load_short_d16_hi v195, v12, s[4:7], s12 offen offset:3648
buffer_load_short_d16_hi v164, v12, s[4:7], s12 offen offset:640
buffer_load_short_d16_hi v165, v12, s[4:7], s12 offen offset:2688
buffer_load_short_d16_hi v196, v12, s[4:7], s12 offen offset:1664
buffer_load_short_d16_hi v197, v12, s[4:7], s12 offen offset:3712
buffer_load_short_d16_hi v166, v12, s[4:7], s12 offen offset:704
buffer_load_short_d16_hi v167, v12, s[4:7], s12 offen offset:2752
buffer_load_short_d16_hi v198, v12, s[4:7], s12 offen offset:1728
buffer_load_short_d16_hi v199, v12, s[4:7], s12 offen offset:3776
buffer_load_short_d16_hi v168, v12, s[4:7], s12 offen offset:768
buffer_load_short_d16_hi v169, v12, s[4:7], s12 offen offset:2816
buffer_load_short_d16_hi v200, v12, s[4:7], s12 offen offset:1792
buffer_load_short_d16_hi v201, v12, s[4:7], s12 offen offset:3840
buffer_load_short_d16_hi v170, v12, s[4:7], s12 offen offset:832
buffer_load_short_d16_hi v171, v12, s[4:7], s12 offen offset:2880
buffer_load_short_d16_hi v202, v12, s[4:7], s12 offen offset:1856
buffer_load_short_d16_hi v203, v12, s[4:7], s12 offen offset:3904
buffer_load_short_d16_hi v172, v12, s[4:7], s12 offen offset:896
buffer_load_short_d16_hi v173, v12, s[4:7], s12 offen offset:2944
buffer_load_short_d16_hi v204, v12, s[4:7], s12 offen offset:1920
buffer_load_short_d16_hi v205, v12, s[4:7], s12 offen offset:3968
buffer_load_short_d16_hi v174, v12, s[4:7], s12 offen offset:960
buffer_load_short_d16_hi v175, v12, s[4:7], s12 offen offset:3008
buffer_load_short_d16_hi v206, v12, s[4:7], s12 offen offset:1984
buffer_load_short_d16_hi v207, v12, s[4:7], s12 offen offset:4032
v_pk_add_f32 v[14:15], v[16:17], v[32:33] neg_lo:[0,1] neg_hi:[0,1]
v_pk_add_f32 v[16:17], v[16:17], v[32:33]
v_pk_add_f32 v[32:33], v[18:19], v[34:35] neg_lo:[0,1] neg_hi:[0,1]
v_pk_add_f32 v[18:19], v[18:19], v[34:35]
v_pk_mul_f32 v[34:35], v[32:33], s[54:55] op_sel:[0,0] op_sel_hi:[0,1] neg_lo:[0,0] neg_hi:[0,1]
v_pk_fma_f32 v[34:35], v[32:33], s[54:55], v[34:35] op_sel:[1,1,0] op_sel_hi:[1,0,1] neg_lo:[0,0,0] neg_hi:[0,0,0]
v_pk_add_f32 v[32:33], v[20:21], v[36:37] neg_lo:[0,1] neg_hi:[0,1]
v_pk_add_f32 v[20:21], v[20:21], v[36:37]
v_pk_mul_f32 v[36:37], v[32:33], s[62:63] op_sel:[0,0] op_sel_hi:[0,1] neg_lo:[0,0] neg_hi:[0,1]
v_pk_fma_f32 v[36:37], v[32:33], s[62:63], v[36:37] op_sel:[1,1,0] op_sel_hi:[1,0,1] neg_lo:[0,0,0] neg_hi:[0,0,0]
v_pk_add_f32 v[32:33], v[22:23], v[38:39] neg_lo:[0,1] neg_hi:[0,1]
v_pk_add_f32 v[22:23], v[22:23], v[38:39]
v_pk_mul_f32 v[38:39], v[32:33], s[54:55] op_sel:[0,1] op_sel_hi:[0,0] neg_lo:[0,0] neg_hi:[0,1]
v_pk_fma_f32 v[38:39], v[32:33], s[54:55], v[38:39] op_sel:[1,0,0] op_sel_hi:[1,1,1] neg_lo:[0,0,0] neg_hi:[0,0,0]
v_pk_add_f32 v[32:33], v[24:25], v[40:41] op_sel:[1,1] op_sel_hi:[0,0] neg_lo:[0,1] neg_hi:[1,0]
v_pk_add_f32 v[24:25], v[24:25], v[40:41]
v_pk_add_f32 v[40:41], v[26:27], v[42:43] neg_lo:[0,1] neg_hi:[0,1]
v_pk_add_f32 v[26:27], v[26:27], v[42:43]
v_pk_mul_f32 v[42:43], v[40:41], s[54:55] op_sel:[0,1] op_sel_hi:[0,0] neg_lo:[0,1] neg_hi:[0,1]
v_pk_fma_f32 v[42:43], v[40:41], s[54:55], v[42:43] op_sel:[1,0,0] op_sel_hi:[1,1,1] neg_lo:[0,0,0] neg_hi:[0,1,0]
v_pk_add_f32 v[40:41], v[28:29], v[44:45] neg_lo:[0,1] neg_hi:[0,1]
v_pk_add_f32 v[28:29], v[28:29], v[44:45]
v_pk_mul_f32 v[44:45], v[40:41], s[62:63] op_sel:[0,0] op_sel_hi:[0,1] neg_lo:[0,1] neg_hi:[0,1]
v_pk_fma_f32 v[44:45], v[40:41], s[62:63], v[44:45] op_sel:[1,1,0] op_sel_hi:[1,0,1] neg_lo:[0,0,0] neg_hi:[0,1,0]
v_pk_add_f32 v[40:41], v[30:31], v[46:47] neg_lo:[0,1] neg_hi:[0,1]
v_pk_add_f32 v[30:31], v[30:31], v[46:47]
v_pk_mul_f32 v[46:47], v[40:41], s[54:55] op_sel:[0,0] op_sel_hi:[0,1] neg_lo:[0,1] neg_hi:[0,1]
v_pk_fma_f32 v[46:47], v[40:41], s[54:55], v[46:47] op_sel:[1,1,0] op_sel_hi:[1,0,1] neg_lo:[0,0,0] neg_hi:[0,1,0]
v_pk_add_f32 v[40:41], v[48:49], v[64:65] neg_lo:[0,1] neg_hi:[0,1]
v_pk_add_f32 v[48:49], v[48:49], v[64:65]
v_pk_add_f32 v[64:65], v[50:51], v[66:67] neg_lo:[0,1] neg_hi:[0,1]
v_pk_add_f32 v[50:51], v[50:51], v[66:67]
v_pk_mul_f32 v[66:67], v[64:65], s[54:55] op_sel:[0,0] op_sel_hi:[0,1] neg_lo:[0,0] neg_hi:[0,1]
v_pk_fma_f32 v[66:67], v[64:65], s[54:55], v[66:67] op_sel:[1,1,0] op_sel_hi:[1,0,1] neg_lo:[0,0,0] neg_hi:[0,0,0]
v_pk_add_f32 v[64:65], v[52:53], v[68:69] neg_lo:[0,1] neg_hi:[0,1]
v_pk_add_f32 v[52:53], v[52:53], v[68:69]
v_pk_mul_f32 v[68:69], v[64:65], s[62:63] op_sel:[0,0] op_sel_hi:[0,1] neg_lo:[0,0] neg_hi:[0,1]
v_pk_fma_f32 v[68:69], v[64:65], s[62:63], v[68:69] op_sel:[1,1,0] op_sel_hi:[1,0,1] neg_lo:[0,0,0] neg_hi:[0,0,0]
v_pk_add_f32 v[64:65], v[54:55], v[70:71] neg_lo:[0,1] neg_hi:[0,1]
v_pk_add_f32 v[54:55], v[54:55], v[70:71]
v_pk_mul_f32 v[70:71], v[64:65], s[54:55] op_sel:[0,1] op_sel_hi:[0,0] neg_lo:[0,0] neg_hi:[0,1]
v_pk_fma_f32 v[70:71], v[64:65], s[54:55], v[70:71] op_sel:[1,0,0] op_sel_hi:[1,1,1] neg_lo:[0,0,0] neg_hi:[0,0,0]
v_pk_add_f32 v[64:65], v[56:57], v[72:73] op_sel:[1,1] op_sel_hi:[0,0] neg_lo:[0,1] neg_hi:[1,0]
v_pk_add_f32 v[56:57], v[56:57], v[72:73]
v_pk_add_f32 v[72:73], v[58:59], v[74:75] neg_lo:[0,1] neg_hi:[0,1]
v_pk_add_f32 v[58:59], v[58:59], v[74:75]
v_pk_mul_f32 v[74:75], v[72:73], s[54:55] op_sel:[0,1] op_sel_hi:[0,0] neg_lo:[0,1] neg_hi:[0,1]
v_pk_fma_f32 v[74:75], v[72:73], s[54:55], v[74:75] op_sel:[1,0,0] op_sel_hi:[1,1,1] neg_lo:[0,0,0] neg_hi:[0,1,0]
v_pk_add_f32 v[72:73], v[60:61], v[76:77] neg_lo:[0,1] neg_hi:[0,1]
v_pk_add_f32 v[60:61], v[60:61], v[76:77]
v_pk_mul_f32 v[76:77], v[72:73], s[62:63] op_sel:[0,0] op_sel_hi:[0,1] neg_lo:[0,1] neg_hi:[0,1]
v_pk_fma_f32 v[76:77], v[72:73], s[62:63], v[76:77] op_sel:[1,1,0] op_sel_hi:[1,0,1] neg_lo:[0,0,0] neg_hi:[0,1,0]
v_pk_add_f32 v[72:73], v[62:63], v[78:79] neg_lo:[0,1] neg_hi:[0,1]
v_pk_add_f32 v[62:63], v[62:63], v[78:79]
v_pk_mul_f32 v[78:79], v[72:73], s[54:55] op_sel:[0,0] op_sel_hi:[0,1] neg_lo:[0,1] neg_hi:[0,1]
v_pk_fma_f32 v[78:79], v[72:73], s[54:55], v[78:79] op_sel:[1,1,0] op_sel_hi:[1,0,1] neg_lo:[0,0,0] neg_hi:[0,1,0]
v_pk_add_f32 v[72:73], v[16:17], v[24:25] neg_lo:[0,1] neg_hi:[0,1]
v_pk_add_f32 v[16:17], v[16:17], v[24:25]
v_pk_add_f32 v[24:25], v[18:19], v[26:27] neg_lo:[0,1] neg_hi:[0,1]
v_pk_add_f32 v[18:19], v[18:19], v[26:27]
v_pk_mul_f32 v[26:27], v[24:25], s[62:63] op_sel:[0,0] op_sel_hi:[0,1] neg_lo:[0,0] neg_hi:[0,1]
v_pk_fma_f32 v[26:27], v[24:25], s[62:63], v[26:27] op_sel:[1,1,0] op_sel_hi:[1,0,1] neg_lo:[0,0,0] neg_hi:[0,0,0]
v_pk_add_f32 v[24:25], v[20:21], v[28:29] op_sel:[1,1] op_sel_hi:[0,0] neg_lo:[0,1] neg_hi:[1,0]
v_pk_add_f32 v[20:21], v[20:21], v[28:29]
v_pk_add_f32 v[28:29], v[22:23], v[30:31] neg_lo:[0,1] neg_hi:[0,1]
v_pk_add_f32 v[22:23], v[22:23], v[30:31]
v_pk_mul_f32 v[30:31], v[28:29], s[62:63] op_sel:[0,0] op_sel_hi:[0,1] neg_lo:[0,1] neg_hi:[0,1]
v_pk_fma_f32 v[30:31], v[28:29], s[62:63], v[30:31] op_sel:[1,1,0] op_sel_hi:[1,0,1] neg_lo:[0,0,0] neg_hi:[0,1,0]
v_pk_add_f32 v[28:29], v[14:15], v[32:33] neg_lo:[0,1] neg_hi:[0,1]
v_pk_add_f32 v[14:15], v[14:15], v[32:33]
v_pk_add_f32 v[32:33], v[34:35], v[42:43] neg_lo:[0,1] neg_hi:[0,1]
v_pk_add_f32 v[34:35], v[34:35], v[42:43]
v_pk_mul_f32 v[42:43], v[32:33], s[62:63] op_sel:[0,0] op_sel_hi:[0,1] neg_lo:[0,0] neg_hi:[0,1]
v_pk_fma_f32 v[42:43], v[32:33], s[62:63], v[42:43] op_sel:[1,1,0] op_sel_hi:[1,0,1] neg_lo:[0,0,0] neg_hi:[0,0,0]
v_pk_add_f32 v[32:33], v[36:37], v[44:45] op_sel:[1,1] op_sel_hi:[0,0] neg_lo:[0,1] neg_hi:[1,0]
v_pk_add_f32 v[36:37], v[36:37], v[44:45]
v_pk_add_f32 v[44:45], v[38:39], v[46:47] neg_lo:[0,1] neg_hi:[0,1]
v_pk_add_f32 v[38:39], v[38:39], v[46:47]
v_pk_mul_f32 v[46:47], v[44:45], s[62:63] op_sel:[0,0] op_sel_hi:[0,1] neg_lo:[0,1] neg_hi:[0,1]
v_pk_fma_f32 v[46:47], v[44:45], s[62:63], v[46:47] op_sel:[1,1,0] op_sel_hi:[1,0,1] neg_lo:[0,0,0] neg_hi:[0,1,0]
v_pk_add_f32 v[44:45], v[48:49], v[56:57] neg_lo:[0,1] neg_hi:[0,1]
v_pk_add_f32 v[48:49], v[48:49], v[56:57]
v_pk_add_f32 v[56:57], v[50:51], v[58:59] neg_lo:[0,1] neg_hi:[0,1]
v_pk_add_f32 v[50:51], v[50:51], v[58:59]
v_pk_mul_f32 v[58:59], v[56:57], s[62:63] op_sel:[0,0] op_sel_hi:[0,1] neg_lo:[0,0] neg_hi:[0,1]
v_pk_fma_f32 v[58:59], v[56:57], s[62:63], v[58:59] op_sel:[1,1,0] op_sel_hi:[1,0,1] neg_lo:[0,0,0] neg_hi:[0,0,0]
v_pk_add_f32 v[56:57], v[52:53], v[60:61] op_sel:[1,1] op_sel_hi:[0,0] neg_lo:[0,1] neg_hi:[1,0]
v_pk_add_f32 v[52:53], v[52:53], v[60:61]
v_pk_add_f32 v[60:61], v[54:55], v[62:63] neg_lo:[0,1] neg_hi:[0,1]
v_pk_add_f32 v[54:55], v[54:55], v[62:63]
v_pk_mul_f32 v[62:63], v[60:61], s[62:63] op_sel:[0,0] op_sel_hi:[0,1] neg_lo:[0,1] neg_hi:[0,1]
v_pk_fma_f32 v[62:63], v[60:61], s[62:63], v[62:63] op_sel:[1,1,0] op_sel_hi:[1,0,1] neg_lo:[0,0,0] neg_hi:[0,1,0]
v_pk_add_f32 v[60:61], v[40:41], v[64:65] neg_lo:[0,1] neg_hi:[0,1]
v_pk_add_f32 v[40:41], v[40:41], v[64:65]
v_pk_add_f32 v[64:65], v[66:67], v[74:75] neg_lo:[0,1] neg_hi:[0,1]
v_pk_add_f32 v[66:67], v[66:67], v[74:75]
v_pk_mul_f32 v[74:75], v[64:65], s[62:63] op_sel:[0,0] op_sel_hi:[0,1] neg_lo:[0,0] neg_hi:[0,1]
v_pk_fma_f32 v[74:75], v[64:65], s[62:63], v[74:75] op_sel:[1,1,0] op_sel_hi:[1,0,1] neg_lo:[0,0,0] neg_hi:[0,0,0]
v_pk_add_f32 v[64:65], v[68:69], v[76:77] op_sel:[1,1] op_sel_hi:[0,0] neg_lo:[0,1] neg_hi:[1,0]
v_pk_add_f32 v[68:69], v[68:69], v[76:77]
v_pk_add_f32 v[76:77], v[70:71], v[78:79] neg_lo:[0,1] neg_hi:[0,1]
v_pk_add_f32 v[70:71], v[70:71], v[78:79]
v_pk_mul_f32 v[78:79], v[76:77], s[62:63] op_sel:[0,0] op_sel_hi:[0,1] neg_lo:[0,1] neg_hi:[0,1]
v_pk_fma_f32 v[78:79], v[76:77], s[62:63], v[78:79] op_sel:[1,1,0] op_sel_hi:[1,0,1] neg_lo:[0,0,0] neg_hi:[0,1,0]
v_pk_add_f32 v[76:77], v[16:17], v[20:21] neg_lo:[0,1] neg_hi:[0,1]
v_pk_add_f32 v[16:17], v[16:17], v[20:21]
v_pk_add_f32 v[20:21], v[18:19], v[22:23] op_sel:[1,1] op_sel_hi:[0,0] neg_lo:[0,1] neg_hi:[1,0]
v_pk_add_f32 v[18:19], v[18:19], v[22:23]
v_pk_add_f32 v[22:23], v[72:73], v[24:25] neg_lo:[0,1] neg_hi:[0,1]
v_pk_add_f32 v[72:73], v[72:73], v[24:25]
v_pk_add_f32 v[24:25], v[26:27], v[30:31] op_sel:[1,1] op_sel_hi:[0,0] neg_lo:[0,1] neg_hi:[1,0]
v_pk_add_f32 v[26:27], v[26:27], v[30:31]
v_pk_add_f32 v[30:31], v[14:15], v[36:37] neg_lo:[0,1] neg_hi:[0,1]
v_pk_add_f32 v[14:15], v[14:15], v[36:37]
v_pk_add_f32 v[36:37], v[34:35], v[38:39] op_sel:[1,1] op_sel_hi:[0,0] neg_lo:[0,1] neg_hi:[1,0]
v_pk_add_f32 v[34:35], v[34:35], v[38:39]
v_pk_add_f32 v[38:39], v[28:29], v[32:33] neg_lo:[0,1] neg_hi:[0,1]
v_pk_add_f32 v[28:29], v[28:29], v[32:33]
v_pk_add_f32 v[32:33], v[42:43], v[46:47] op_sel:[1,1] op_sel_hi:[0,0] neg_lo:[0,1] neg_hi:[1,0]
v_pk_add_f32 v[42:43], v[42:43], v[46:47]
v_pk_add_f32 v[46:47], v[48:49], v[52:53] neg_lo:[0,1] neg_hi:[0,1]
v_pk_add_f32 v[48:49], v[48:49], v[52:53]
v_pk_add_f32 v[52:53], v[50:51], v[54:55] op_sel:[1,1] op_sel_hi:[0,0] neg_lo:[0,1] neg_hi:[1,0]
v_pk_add_f32 v[50:51], v[50:51], v[54:55]
v_pk_add_f32 v[54:55], v[44:45], v[56:57] neg_lo:[0,1] neg_hi:[0,1]
v_pk_add_f32 v[44:45], v[44:45], v[56:57]
v_pk_add_f32 v[56:57], v[58:59], v[62:63] op_sel:[1,1] op_sel_hi:[0,0] neg_lo:[0,1] neg_hi:[1,0]
v_pk_add_f32 v[58:59], v[58:59], v[62:63]
v_pk_add_f32 v[62:63], v[40:41], v[68:69] neg_lo:[0,1] neg_hi:[0,1]
v_pk_add_f32 v[40:41], v[40:41], v[68:69]
v_pk_add_f32 v[68:69], v[66:67], v[70:71] op_sel:[1,1] op_sel_hi:[0,0] neg_lo:[0,1] neg_hi:[1,0]
v_pk_add_f32 v[66:67], v[66:67], v[70:71]
v_pk_add_f32 v[70:71], v[60:61], v[64:65] neg_lo:[0,1] neg_hi:[0,1]
v_pk_add_f32 v[60:61], v[60:61], v[64:65]
v_pk_add_f32 v[64:65], v[74:75], v[78:79] op_sel:[1,1] op_sel_hi:[0,0] neg_lo:[0,1] neg_hi:[1,0]
v_pk_add_f32 v[74:75], v[74:75], v[78:79]
v_pk_add_f32 v[78:79], v[16:17], v[18:19] neg_lo:[0,1] neg_hi:[0,1]
v_pk_add_f32 v[16:17], v[16:17], v[18:19]
v_pk_add_f32 v[18:19], v[76:77], v[20:21] neg_lo:[0,1] neg_hi:[0,1]
v_pk_add_f32 v[76:77], v[76:77], v[20:21]
v_pk_add_f32 v[20:21], v[72:73], v[26:27] neg_lo:[0,1] neg_hi:[0,1]
v_pk_add_f32 v[72:73], v[72:73], v[26:27]
v_pk_add_f32 v[26:27], v[22:23], v[24:25] neg_lo:[0,1] neg_hi:[0,1]
v_pk_add_f32 v[22:23], v[22:23], v[24:25]
v_pk_add_f32 v[24:25], v[14:15], v[34:35] neg_lo:[0,1] neg_hi:[0,1]
v_pk_add_f32 v[14:15], v[14:15], v[34:35]
v_pk_add_f32 v[34:35], v[30:31], v[36:37] neg_lo:[0,1] neg_hi:[0,1]
v_pk_add_f32 v[30:31], v[30:31], v[36:37]
v_pk_add_f32 v[36:37], v[28:29], v[42:43] neg_lo:[0,1] neg_hi:[0,1]
v_pk_add_f32 v[28:29], v[28:29], v[42:43]
v_pk_add_f32 v[42:43], v[38:39], v[32:33] neg_lo:[0,1] neg_hi:[0,1]
v_pk_add_f32 v[38:39], v[38:39], v[32:33]
v_pk_add_f32 v[32:33], v[48:49], v[50:51] neg_lo:[0,1] neg_hi:[0,1]
v_pk_add_f32 v[48:49], v[48:49], v[50:51]
v_pk_add_f32 v[50:51], v[46:47], v[52:53] neg_lo:[0,1] neg_hi:[0,1]
v_pk_add_f32 v[46:47], v[46:47], v[52:53]
v_pk_add_f32 v[52:53], v[44:45], v[58:59] neg_lo:[0,1] neg_hi:[0,1]
v_pk_add_f32 v[44:45], v[44:45], v[58:59]
v_pk_add_f32 v[58:59], v[54:55], v[56:57] neg_lo:[0,1] neg_hi:[0,1]
v_pk_add_f32 v[54:55], v[54:55], v[56:57]
v_pk_add_f32 v[56:57], v[40:41], v[66:67] neg_lo:[0,1] neg_hi:[0,1]
v_pk_add_f32 v[40:41], v[40:41], v[66:67]
v_pk_add_f32 v[66:67], v[62:63], v[68:69] neg_lo:[0,1] neg_hi:[0,1]
v_pk_add_f32 v[62:63], v[62:63], v[68:69]
v_pk_add_f32 v[68:69], v[60:61], v[74:75] neg_lo:[0,1] neg_hi:[0,1]
v_pk_add_f32 v[60:61], v[60:61], v[74:75]
v_pk_add_f32 v[74:75], v[70:71], v[64:65] neg_lo:[0,1] neg_hi:[0,1]
v_pk_add_f32 v[70:71], v[70:71], v[64:65]
v_pk_mul_f32 v[64:65], v[48:49], v[82:83] op_sel:[0,0] op_sel_hi:[0,1] neg_lo:[0,0] neg_hi:[0,0]
v_pk_fma_f32 v[48:49], v[48:49], v[82:83], v[64:65] op_sel:[1,1,0] op_sel_hi:[1,0,1] neg_lo:[0,1,0] neg_hi:[0,0,0]
v_pk_mul_f32 v[64:65], v[14:15], v[84:85] op_sel:[0,0] op_sel_hi:[0,1] neg_lo:[0,0] neg_hi:[0,0]
v_pk_fma_f32 v[14:15], v[14:15], v[84:85], v[64:65] op_sel:[1,1,0] op_sel_hi:[1,0,1] neg_lo:[0,1,0] neg_hi:[0,0,0]
v_pk_mul_f32 v[64:65], v[40:41], v[86:87] op_sel:[0,0] op_sel_hi:[0,1] neg_lo:[0,0] neg_hi:[0,0]
v_pk_fma_f32 v[40:41], v[40:41], v[86:87], v[64:65] op_sel:[1,1,0] op_sel_hi:[1,0,1] neg_lo:[0,1,0] neg_hi:[0,0,0]
v_pk_mul_f32 v[64:65], v[72:73], v[88:89] op_sel:[0,0] op_sel_hi:[0,1] neg_lo:[0,0] neg_hi:[0,0]
v_pk_fma_f32 v[72:73], v[72:73], v[88:89], v[64:65] op_sel:[1,1,0] op_sel_hi:[1,0,1] neg_lo:[0,1,0] neg_hi:[0,0,0]
v_pk_mul_f32 v[64:65], v[44:45], v[90:91] op_sel:[0,0] op_sel_hi:[0,1] neg_lo:[0,0] neg_hi:[0,0]
v_pk_fma_f32 v[44:45], v[44:45], v[90:91], v[64:65] op_sel:[1,1,0] op_sel_hi:[1,0,1] neg_lo:[0,1,0] neg_hi:[0,0,0]
v_pk_mul_f32 v[64:65], v[28:29], v[92:93] op_sel:[0,0] op_sel_hi:[0,1] neg_lo:[0,0] neg_hi:[0,0]
v_pk_fma_f32 v[28:29], v[28:29], v[92:93], v[64:65] op_sel:[1,1,0] op_sel_hi:[1,0,1] neg_lo:[0,1,0] neg_hi:[0,0,0]
v_pk_mul_f32 v[64:65], v[60:61], v[94:95] op_sel:[0,0] op_sel_hi:[0,1] neg_lo:[0,0] neg_hi:[0,0]
v_pk_fma_f32 v[60:61], v[60:61], v[94:95], v[64:65] op_sel:[1,1,0] op_sel_hi:[1,0,1] neg_lo:[0,1,0] neg_hi:[0,0,0]
v_pk_mul_f32 v[64:65], v[76:77], v[96:97] op_sel:[0,0] op_sel_hi:[0,1] neg_lo:[0,0] neg_hi:[0,0]
v_pk_fma_f32 v[76:77], v[76:77], v[96:97], v[64:65] op_sel:[1,1,0] op_sel_hi:[1,0,1] neg_lo:[0,1,0] neg_hi:[0,0,0]
v_pk_mul_f32 v[64:65], v[46:47], v[98:99] op_sel:[0,0] op_sel_hi:[0,1] neg_lo:[0,0] neg_hi:[0,0]
v_pk_fma_f32 v[46:47], v[46:47], v[98:99], v[64:65] op_sel:[1,1,0] op_sel_hi:[1,0,1] neg_lo:[0,1,0] neg_hi:[0,0,0]
v_pk_mul_f32 v[64:65], v[30:31], v[100:101] op_sel:[0,0] op_sel_hi:[0,1] neg_lo:[0,0] neg_hi:[0,0]
v_pk_fma_f32 v[30:31], v[30:31], v[100:101], v[64:65] op_sel:[1,1,0] op_sel_hi:[1,0,1] neg_lo:[0,1,0] neg_hi:[0,0,0]
v_pk_mul_f32 v[64:65], v[62:63], v[102:103] op_sel:[0,0] op_sel_hi:[0,1] neg_lo:[0,0] neg_hi:[0,0]
v_pk_fma_f32 v[62:63], v[62:63], v[102:103], v[64:65] op_sel:[1,1,0] op_sel_hi:[1,0,1] neg_lo:[0,1,0] neg_hi:[0,0,0]
v_pk_mul_f32 v[64:65], v[22:23], v[104:105] op_sel:[0,0] op_sel_hi:[0,1] neg_lo:[0,0] neg_hi:[0,0]
v_pk_fma_f32 v[22:23], v[22:23], v[104:105], v[64:65] op_sel:[1,1,0] op_sel_hi:[1,0,1] neg_lo:[0,1,0] neg_hi:[0,0,0]
v_pk_mul_f32 v[64:65], v[54:55], v[106:107] op_sel:[0,0] op_sel_hi:[0,1] neg_lo:[0,0] neg_hi:[0,0]
v_pk_fma_f32 v[54:55], v[54:55], v[106:107], v[64:65] op_sel:[1,1,0] op_sel_hi:[1,0,1] neg_lo:[0,1,0] neg_hi:[0,0,0]
v_pk_mul_f32 v[64:65], v[38:39], v[108:109] op_sel:[0,0] op_sel_hi:[0,1] neg_lo:[0,0] neg_hi:[0,0]
v_pk_fma_f32 v[38:39], v[38:39], v[108:109], v[64:65] op_sel:[1,1,0] op_sel_hi:[1,0,1] neg_lo:[0,1,0] neg_hi:[0,0,0]
v_pk_mul_f32 v[64:65], v[70:71], v[110:111] op_sel:[0,0] op_sel_hi:[0,1] neg_lo:[0,0] neg_hi:[0,0]
v_pk_fma_f32 v[70:71], v[70:71], v[110:111], v[64:65] op_sel:[1,1,0] op_sel_hi:[1,0,1] neg_lo:[0,1,0] neg_hi:[0,0,0]
v_pk_mul_f32 v[64:65], v[78:79], v[112:113] op_sel:[0,0] op_sel_hi:[0,1] neg_lo:[0,0] neg_hi:[0,0]
v_pk_fma_f32 v[78:79], v[78:79], v[112:113], v[64:65] op_sel:[1,1,0] op_sel_hi:[1,0,1] neg_lo:[0,1,0] neg_hi:[0,0,0]
v_pk_mul_f32 v[64:65], v[32:33], v[114:115] op_sel:[0,0] op_sel_hi:[0,1] neg_lo:[0,0] neg_hi:[0,0]
v_pk_fma_f32 v[32:33], v[32:33], v[114:115], v[64:65] op_sel:[1,1,0] op_sel_hi:[1,0,1] neg_lo:[0,1,0] neg_hi:[0,0,0]
v_pk_mul_f32 v[64:65], v[24:25], v[116:117] op_sel:[0,0] op_sel_hi:[0,1] neg_lo:[0,0] neg_hi:[0,0]
v_pk_fma_f32 v[24:25], v[24:25], v[116:117], v[64:65] op_sel:[1,1,0] op_sel_hi:[1,0,1] neg_lo:[0,1,0] neg_hi:[0,0,0]
v_pk_mul_f32 v[64:65], v[56:57], v[118:119] op_sel:[0,0] op_sel_hi:[0,1] neg_lo:[0,0] neg_hi:[0,0]
v_pk_fma_f32 v[56:57], v[56:57], v[118:119], v[64:65] op_sel:[1,1,0] op_sel_hi:[1,0,1] neg_lo:[0,1,0] neg_hi:[0,0,0]
v_pk_mul_f32 v[64:65], v[20:21], v[120:121] op_sel:[0,0] op_sel_hi:[0,1] neg_lo:[0,0] neg_hi:[0,0]
v_pk_fma_f32 v[20:21], v[20:21], v[120:121], v[64:65] op_sel:[1,1,0] op_sel_hi:[1,0,1] neg_lo:[0,1,0] neg_hi:[0,0,0]
v_pk_mul_f32 v[64:65], v[52:53], v[122:123] op_sel:[0,0] op_sel_hi:[0,1] neg_lo:[0,0] neg_hi:[0,0]
v_pk_fma_f32 v[52:53], v[52:53], v[122:123], v[64:65] op_sel:[1,1,0] op_sel_hi:[1,0,1] neg_lo:[0,1,0] neg_hi:[0,0,0]
v_pk_mul_f32 v[64:65], v[36:37], v[124:125] op_sel:[0,0] op_sel_hi:[0,1] neg_lo:[0,0] neg_hi:[0,0]
v_pk_fma_f32 v[36:37], v[36:37], v[124:125], v[64:65] op_sel:[1,1,0] op_sel_hi:[1,0,1] neg_lo:[0,1,0] neg_hi:[0,0,0]
v_pk_mul_f32 v[64:65], v[68:69], v[126:127] op_sel:[0,0] op_sel_hi:[0,1] neg_lo:[0,0] neg_hi:[0,0]
v_pk_fma_f32 v[68:69], v[68:69], v[126:127], v[64:65] op_sel:[1,1,0] op_sel_hi:[1,0,1] neg_lo:[0,1,0] neg_hi:[0,0,0]
v_pk_mul_f32 v[64:65], v[18:19], v[128:129] op_sel:[0,0] op_sel_hi:[0,1] neg_lo:[0,0] neg_hi:[0,0]
v_pk_fma_f32 v[18:19], v[18:19], v[128:129], v[64:65] op_sel:[1,1,0] op_sel_hi:[1,0,1] neg_lo:[0,1,0] neg_hi:[0,0,0]
v_pk_mul_f32 v[64:65], v[50:51], v[130:131] op_sel:[0,0] op_sel_hi:[0,1] neg_lo:[0,0] neg_hi:[0,0]
v_pk_fma_f32 v[50:51], v[50:51], v[130:131], v[64:65] op_sel:[1,1,0] op_sel_hi:[1,0,1] neg_lo:[0,1,0] neg_hi:[0,0,0]
v_pk_mul_f32 v[64:65], v[34:35], v[132:133] op_sel:[0,0] op_sel_hi:[0,1] neg_lo:[0,0] neg_hi:[0,0]
v_pk_fma_f32 v[34:35], v[34:35], v[132:133], v[64:65] op_sel:[1,1,0] op_sel_hi:[1,0,1] neg_lo:[0,1,0] neg_hi:[0,0,0]
v_pk_mul_f32 v[64:65], v[66:67], v[134:135] op_sel:[0,0] op_sel_hi:[0,1] neg_lo:[0,0] neg_hi:[0,0]
v_pk_fma_f32 v[66:67], v[66:67], v[134:135], v[64:65] op_sel:[1,1,0] op_sel_hi:[1,0,1] neg_lo:[0,1,0] neg_hi:[0,0,0]
v_pk_mul_f32 v[64:65], v[26:27], v[136:137] op_sel:[0,0] op_sel_hi:[0,1] neg_lo:[0,0] neg_hi:[0,0]
v_pk_fma_f32 v[26:27], v[26:27], v[136:137], v[64:65] op_sel:[1,1,0] op_sel_hi:[1,0,1] neg_lo:[0,1,0] neg_hi:[0,0,0]
v_pk_mul_f32 v[64:65], v[58:59], v[138:139] op_sel:[0,0] op_sel_hi:[0,1] neg_lo:[0,0] neg_hi:[0,0]
v_pk_fma_f32 v[58:59], v[58:59], v[138:139], v[64:65] op_sel:[1,1,0] op_sel_hi:[1,0,1] neg_lo:[0,1,0] neg_hi:[0,0,0]
v_pk_mul_f32 v[64:65], v[42:43], v[140:141] op_sel:[0,0] op_sel_hi:[0,1] neg_lo:[0,0] neg_hi:[0,0]
v_pk_fma_f32 v[42:43], v[42:43], v[140:141], v[64:65] op_sel:[1,1,0] op_sel_hi:[1,0,1] neg_lo:[0,1,0] neg_hi:[0,0,0]
v_pk_mul_f32 v[64:65], v[74:75], v[142:143] op_sel:[0,0] op_sel_hi:[0,1] neg_lo:[0,0] neg_hi:[0,0]
v_pk_fma_f32 v[74:75], v[74:75], v[142:143], v[64:65] op_sel:[1,1,0] op_sel_hi:[1,0,1] neg_lo:[0,1,0] neg_hi:[0,0,0]
s_barrier
ds_write_b64 v4, v[16:17] offset:0
ds_write_b64 v4, v[48:49] offset:264
ds_write_b64 v4, v[14:15] offset:528
ds_write_b64 v4, v[40:41] offset:792
ds_write_b64 v4, v[72:73] offset:1056
ds_write_b64 v4, v[44:45] offset:1320
ds_write_b64 v4, v[28:29] offset:1584
ds_write_b64 v4, v[60:61] offset:1848
ds_write_b64 v4, v[76:77] offset:2112
ds_write_b64 v4, v[46:47] offset:2376
ds_write_b64 v4, v[30:31] offset:2640
ds_write_b64 v4, v[62:63] offset:2904
ds_write_b64 v4, v[22:23] offset:3168
ds_write_b64 v4, v[54:55] offset:3432
ds_write_b64 v4, v[38:39] offset:3696
ds_write_b64 v4, v[70:71] offset:3960
ds_write_b64 v4, v[78:79] offset:4224
ds_write_b64 v4, v[32:33] offset:4488
ds_write_b64 v4, v[24:25] offset:4752
ds_write_b64 v4, v[56:57] offset:5016
ds_write_b64 v4, v[20:21] offset:5280
ds_write_b64 v4, v[52:53] offset:5544
ds_write_b64 v4, v[36:37] offset:5808
ds_write_b64 v4, v[68:69] offset:6072
ds_write_b64 v4, v[18:19] offset:6336
ds_write_b64 v4, v[50:51] offset:6600
ds_write_b64 v4, v[34:35] offset:6864
ds_write_b64 v4, v[66:67] offset:7128
ds_write_b64 v4, v[26:27] offset:7392
ds_write_b64 v4, v[58:59] offset:7656
ds_write_b64 v4, v[42:43] offset:7920
ds_write_b64 v4, v[74:75] offset:8184
s_waitcnt lgkmcnt(0)
ds_read_b64 v[16:17], v5 offset:0
ds_read_b64 v[48:49], v5 offset:128
ds_read_b64 v[18:19], v5 offset:8
ds_read_b64 v[50:51], v5 offset:136
ds_read_b64 v[20:21], v5 offset:16
ds_read_b64 v[52:53], v5 offset:144
ds_read_b64 v[22:23], v5 offset:24
ds_read_b64 v[54:55], v5 offset:152
ds_read_b64 v[24:25], v5 offset:32
ds_read_b64 v[56:57], v5 offset:160
ds_read_b64 v[26:27], v5 offset:40
ds_read_b64 v[58:59], v5 offset:168
ds_read_b64 v[28:29], v5 offset:48
ds_read_b64 v[60:61], v5 offset:176
ds_read_b64 v[30:31], v5 offset:56
ds_read_b64 v[62:63], v5 offset:184
ds_read_b64 v[32:33], v5 offset:64
ds_read_b64 v[64:65], v5 offset:192
ds_read_b64 v[34:35], v5 offset:72
ds_read_b64 v[66:67], v5 offset:200
ds_read_b64 v[36:37], v5 offset:80
ds_read_b64 v[68:69], v5 offset:208
ds_read_b64 v[38:39], v5 offset:88
ds_read_b64 v[70:71], v5 offset:216
ds_read_b64 v[40:41], v5 offset:96
ds_read_b64 v[72:73], v5 offset:224
ds_read_b64 v[42:43], v5 offset:104
ds_read_b64 v[74:75], v5 offset:232
ds_read_b64 v[44:45], v5 offset:112
ds_read_b64 v[76:77], v5 offset:240
ds_read_b64 v[46:47], v5 offset:120
ds_read_b64 v[78:79], v5 offset:248
s_waitcnt lgkmcnt(0)
v_pk_add_f32 v[14:15], v[16:17], v[48:49] neg_lo:[0,1] neg_hi:[0,1]
v_pk_add_f32 v[16:17], v[16:17], v[48:49]
v_pk_add_f32 v[48:49], v[18:19], v[50:51] neg_lo:[0,1] neg_hi:[0,1]
v_pk_add_f32 v[18:19], v[18:19], v[50:51]
v_pk_mul_f32 v[50:51], v[48:49], s[50:51] op_sel:[0,0] op_sel_hi:[0,1] neg_lo:[0,0] neg_hi:[0,1]
v_pk_fma_f32 v[50:51], v[48:49], s[50:51], v[50:51] op_sel:[1,1,0] op_sel_hi:[1,0,1] neg_lo:[0,0,0] neg_hi:[0,0,0]
v_pk_add_f32 v[48:49], v[20:21], v[52:53] neg_lo:[0,1] neg_hi:[0,1]
v_pk_add_f32 v[20:21], v[20:21], v[52:53]
v_pk_mul_f32 v[52:53], v[48:49], s[54:55] op_sel:[0,0] op_sel_hi:[0,1] neg_lo:[0,0] neg_hi:[0,1]
v_pk_fma_f32 v[52:53], v[48:49], s[54:55], v[52:53] op_sel:[1,1,0] op_sel_hi:[1,0,1] neg_lo:[0,0,0] neg_hi:[0,0,0]
v_pk_add_f32 v[48:49], v[22:23], v[54:55] neg_lo:[0,1] neg_hi:[0,1]
v_pk_add_f32 v[22:23], v[22:23], v[54:55]
v_pk_mul_f32 v[54:55], v[48:49], s[58:59] op_sel:[0,0] op_sel_hi:[0,1] neg_lo:[0,0] neg_hi:[0,1]
v_pk_fma_f32 v[54:55], v[48:49], s[58:59], v[54:55] op_sel:[1,1,0] op_sel_hi:[1,0,1] neg_lo:[0,0,0] neg_hi:[0,0,0]
v_pk_add_f32 v[48:49], v[24:25], v[56:57] neg_lo:[0,1] neg_hi:[0,1]
v_pk_add_f32 v[24:25], v[24:25], v[56:57]
v_pk_mul_f32 v[56:57], v[48:49], s[62:63] op_sel:[0,0] op_sel_hi:[0,1] neg_lo:[0,0] neg_hi:[0,1]
v_pk_fma_f32 v[56:57], v[48:49], s[62:63], v[56:57] op_sel:[1,1,0] op_sel_hi:[1,0,1] neg_lo:[0,0,0] neg_hi:[0,0,0]
v_pk_add_f32 v[48:49], v[26:27], v[58:59] neg_lo:[0,1] neg_hi:[0,1]
v_pk_add_f32 v[26:27], v[26:27], v[58:59]
v_pk_mul_f32 v[58:59], v[48:49], s[58:59] op_sel:[0,1] op_sel_hi:[0,0] neg_lo:[0,0] neg_hi:[0,1]
v_pk_fma_f32 v[58:59], v[48:49], s[58:59], v[58:59] op_sel:[1,0,0] op_sel_hi:[1,1,1] neg_lo:[0,0,0] neg_hi:[0,0,0]
v_pk_add_f32 v[48:49], v[28:29], v[60:61] neg_lo:[0,1] neg_hi:[0,1]
v_pk_add_f32 v[28:29], v[28:29], v[60:61]
v_pk_mul_f32 v[60:61], v[48:49], s[54:55] op_sel:[0,1] op_sel_hi:[0,0] neg_lo:[0,0] neg_hi:[0,1]
v_pk_fma_f32 v[60:61], v[48:49], s[54:55], v[60:61] op_sel:[1,0,0] op_sel_hi:[1,1,1] neg_lo:[0,0,0] neg_hi:[0,0,0]
v_pk_add_f32 v[48:49], v[30:31], v[62:63] neg_lo:[0,1] neg_hi:[0,1]
v_pk_add_f32 v[30:31], v[30:31], v[62:63]
v_pk_mul_f32 v[62:63], v[48:49], s[50:51] op_sel:[0,1] op_sel_hi:[0,0] neg_lo:[0,0] neg_hi:[0,1]
v_pk_fma_f32 v[62:63], v[48:49], s[50:51], v[62:63] op_sel:[1,0,0] op_sel_hi:[1,1,1] neg_lo:[0,0,0] neg_hi:[0,0,0]
v_pk_add_f32 v[48:49], v[32:33], v[64:65] op_sel:[1,1] op_sel_hi:[0,0] neg_lo:[0,1] neg_hi:[1,0]
v_pk_add_f32 v[32:33], v[32:33], v[64:65]
v_pk_add_f32 v[64:65], v[34:35], v[66:67] neg_lo:[0,1] neg_hi:[0,1]
v_pk_add_f32 v[34:35], v[34:35], v[66:67]
v_pk_mul_f32 v[66:67], v[64:65], s[50:51] op_sel:[0,1] op_sel_hi:[0,0] neg_lo:[0,1] neg_hi:[0,1]
v_pk_fma_f32 v[66:67], v[64:65], s[50:51], v[66:67] op_sel:[1,0,0] op_sel_hi:[1,1,1] neg_lo:[0,0,0] neg_hi:[0,1,0]
v_pk_add_f32 v[64:65], v[36:37], v[68:69] neg_lo:[0,1] neg_hi:[0,1]
v_pk_add_f32 v[36:37], v[36:37], v[68:69]
v_pk_mul_f32 v[68:69], v[64:65], s[54:55] op_sel:[0,1] op_sel_hi:[0,0] neg_lo:[0,1] neg_hi:[0,1]
v_pk_fma_f32 v[68:69], v[64:65], s[54:55], v[68:69] op_sel:[1,0,0] op_sel_hi:[1,1,1] neg_lo:[0,0,0] neg_hi:[0,1,0]
v_pk_add_f32 v[64:65], v[38:39], v[70:71] neg_lo:[0,1] neg_hi:[0,1]
v_pk_add_f32 v[38:39], v[38:39], v[70:71]
v_pk_mul_f32 v[70:71], v[64:65], s[58:59] op_sel:[0,1] op_sel_hi:[0,0] neg_lo:[0,1] neg_hi:[0,1]
v_pk_fma_f32 v[70:71], v[64:65], s[58:59], v[70:71] op_sel:[1,0,0] op_sel_hi:[1,1,1] neg_lo:[0,0,0] neg_hi:[0,1,0]
v_pk_add_f32 v[64:65], v[40:41], v[72:73] neg_lo:[0,1] neg_hi:[0,1]
v_pk_add_f32 v[40:41], v[40:41], v[72:73]
v_pk_mul_f32 v[72:73], v[64:65], s[62:63] op_sel:[0,0] op_sel_hi:[0,1] neg_lo:[0,1] neg_hi:[0,1]
v_pk_fma_f32 v[72:73], v[64:65], s[62:63], v[72:73] op_sel:[1,1,0] op_sel_hi:[1,0,1] neg_lo:[0,0,0] neg_hi:[0,1,0]
v_pk_add_f32 v[64:65], v[42:43], v[74:75] neg_lo:[0,1] neg_hi:[0,1]
v_pk_add_f32 v[42:43], v[42:43], v[74:75]
v_pk_mul_f32 v[74:75], v[64:65], s[58:59] op_sel:[0,0] op_sel_hi:[0,1] neg_lo:[0,1] neg_hi:[0,1]
v_pk_fma_f32 v[74:75], v[64:65], s[58:59], v[74:75] op_sel:[1,1,0] op_sel_hi:[1,0,1] neg_lo:[0,0,0] neg_hi:[0,1,0]
v_pk_add_f32 v[64:65], v[44:45], v[76:77] neg_lo:[0,1] neg_hi:[0,1]
v_pk_add_f32 v[44:45], v[44:45], v[76:77]
v_pk_mul_f32 v[76:77], v[64:65], s[54:55] op_sel:[0,0] op_sel_hi:[0,1] neg_lo:[0,1] neg_hi:[0,1]
v_pk_fma_f32 v[76:77], v[64:65], s[54:55], v[76:77] op_sel:[1,1,0] op_sel_hi:[1,0,1] neg_lo:[0,0,0] neg_hi:[0,1,0]
v_pk_add_f32 v[64:65], v[46:47], v[78:79] neg_lo:[0,1] neg_hi:[0,1]
v_pk_add_f32 v[46:47], v[46:47], v[78:79]
v_pk_mul_f32 v[78:79], v[64:65], s[50:51] op_sel:[0,0] op_sel_hi:[0,1] neg_lo:[0,1] neg_hi:[0,1]
v_pk_fma_f32 v[78:79], v[64:65], s[50:51], v[78:79] op_sel:[1,1,0] op_sel_hi:[1,0,1] neg_lo:[0,0,0] neg_hi:[0,1,0]
v_pk_add_f32 v[64:65], v[16:17], v[32:33] neg_lo:[0,1] neg_hi:[0,1]
v_pk_add_f32 v[16:17], v[16:17], v[32:33]
v_pk_add_f32 v[32:33], v[18:19], v[34:35] neg_lo:[0,1] neg_hi:[0,1]
v_pk_add_f32 v[18:19], v[18:19], v[34:35]
v_pk_mul_f32 v[34:35], v[32:33], s[54:55] op_sel:[0,0] op_sel_hi:[0,1] neg_lo:[0,0] neg_hi:[0,1]
v_pk_fma_f32 v[34:35], v[32:33], s[54:55], v[34:35] op_sel:[1,1,0] op_sel_hi:[1,0,1] neg_lo:[0,0,0] neg_hi:[0,0,0]
v_pk_add_f32 v[32:33], v[20:21], v[36:37] neg_lo:[0,1] neg_hi:[0,1]
v_pk_add_f32 v[20:21], v[20:21], v[36:37]
v_pk_mul_f32 v[36:37], v[32:33], s[62:63] op_sel:[0,0] op_sel_hi:[0,1] neg_lo:[0,0] neg_hi:[0,1]
v_pk_fma_f32 v[36:37], v[32:33], s[62:63], v[36:37] op_sel:[1,1,0] op_sel_hi:[1,0,1] neg_lo:[0,0,0] neg_hi:[0,0,0]
v_pk_add_f32 v[32:33], v[22:23], v[38:39] neg_lo:[0,1] neg_hi:[0,1]
v_pk_add_f32 v[22:23], v[22:23], v[38:39]
v_pk_mul_f32 v[38:39], v[32:33], s[54:55] op_sel:[0,1] op_sel_hi:[0,0] neg_lo:[0,0] neg_hi:[0,1]
v_pk_fma_f32 v[38:39], v[32:33], s[54:55], v[38:39] op_sel:[1,0,0] op_sel_hi:[1,1,1] neg_lo:[0,0,0] neg_hi:[0,0,0]
v_pk_add_f32 v[32:33], v[24:25], v[40:41] op_sel:[1,1] op_sel_hi:[0,0] neg_lo:[0,1] neg_hi:[1,0]
v_pk_add_f32 v[24:25], v[24:25], v[40:41]
v_pk_add_f32 v[40:41], v[26:27], v[42:43] neg_lo:[0,1] neg_hi:[0,1]
v_pk_add_f32 v[26:27], v[26:27], v[42:43]
v_pk_mul_f32 v[42:43], v[40:41], s[54:55] op_sel:[0,1] op_sel_hi:[0,0] neg_lo:[0,1] neg_hi:[0,1]
v_pk_fma_f32 v[42:43], v[40:41], s[54:55], v[42:43] op_sel:[1,0,0] op_sel_hi:[1,1,1] neg_lo:[0,0,0] neg_hi:[0,1,0]
v_pk_add_f32 v[40:41], v[28:29], v[44:45] neg_lo:[0,1] neg_hi:[0,1]
v_pk_add_f32 v[28:29], v[28:29], v[44:45]
v_pk_mul_f32 v[44:45], v[40:41], s[62:63] op_sel:[0,0] op_sel_hi:[0,1] neg_lo:[0,1] neg_hi:[0,1]
v_pk_fma_f32 v[44:45], v[40:41], s[62:63], v[44:45] op_sel:[1,1,0] op_sel_hi:[1,0,1] neg_lo:[0,0,0] neg_hi:[0,1,0]
v_pk_add_f32 v[40:41], v[30:31], v[46:47] neg_lo:[0,1] neg_hi:[0,1]
v_pk_add_f32 v[30:31], v[30:31], v[46:47]
v_pk_mul_f32 v[46:47], v[40:41], s[54:55] op_sel:[0,0] op_sel_hi:[0,1] neg_lo:[0,1] neg_hi:[0,1]
v_pk_fma_f32 v[46:47], v[40:41], s[54:55], v[46:47] op_sel:[1,1,0] op_sel_hi:[1,0,1] neg_lo:[0,0,0] neg_hi:[0,1,0]
v_pk_add_f32 v[40:41], v[14:15], v[48:49] neg_lo:[0,1] neg_hi:[0,1]
v_pk_add_f32 v[14:15], v[14:15], v[48:49]
v_pk_add_f32 v[48:49], v[50:51], v[66:67] neg_lo:[0,1] neg_hi:[0,1]
v_pk_add_f32 v[50:51], v[50:51], v[66:67]
v_pk_mul_f32 v[66:67], v[48:49], s[54:55] op_sel:[0,0] op_sel_hi:[0,1] neg_lo:[0,0] neg_hi:[0,1]
v_pk_fma_f32 v[66:67], v[48:49], s[54:55], v[66:67] op_sel:[1,1,0] op_sel_hi:[1,0,1] neg_lo:[0,0,0] neg_hi:[0,0,0]
v_pk_add_f32 v[48:49], v[52:53], v[68:69] neg_lo:[0,1] neg_hi:[0,1]
v_pk_add_f32 v[52:53], v[52:53], v[68:69]
v_pk_mul_f32 v[68:69], v[48:49], s[62:63] op_sel:[0,0] op_sel_hi:[0,1] neg_lo:[0,0] neg_hi:[0,1]
v_pk_fma_f32 v[68:69], v[48:49], s[62:63], v[68:69] op_sel:[1,1,0] op_sel_hi:[1,0,1] neg_lo:[0,0,0] neg_hi:[0,0,0]
v_pk_add_f32 v[48:49], v[54:55], v[70:71] neg_lo:[0,1] neg_hi:[0,1]
v_pk_add_f32 v[54:55], v[54:55], v[70:71]
v_pk_mul_f32 v[70:71], v[48:49], s[54:55] op_sel:[0,1] op_sel_hi:[0,0] neg_lo:[0,0] neg_hi:[0,1]
v_pk_fma_f32 v[70:71], v[48:49], s[54:55], v[70:71] op_sel:[1,0,0] op_sel_hi:[1,1,1] neg_lo:[0,0,0] neg_hi:[0,0,0]
v_pk_add_f32 v[48:49], v[56:57], v[72:73] op_sel:[1,1] op_sel_hi:[0,0] neg_lo:[0,1] neg_hi:[1,0]
v_pk_add_f32 v[56:57], v[56:57], v[72:73]
v_pk_add_f32 v[72:73], v[58:59], v[74:75] neg_lo:[0,1] neg_hi:[0,1]
v_pk_add_f32 v[58:59], v[58:59], v[74:75]
v_pk_mul_f32 v[74:75], v[72:73], s[54:55] op_sel:[0,1] op_sel_hi:[0,0] neg_lo:[0,1] neg_hi:[0,1]
v_pk_fma_f32 v[74:75], v[72:73], s[54:55], v[74:75] op_sel:[1,0,0] op_sel_hi:[1,1,1] neg_lo:[0,0,0] neg_hi:[0,1,0]
v_pk_add_f32 v[72:73], v[60:61], v[76:77] neg_lo:[0,1] neg_hi:[0,1]
v_pk_add_f32 v[60:61], v[60:61], v[76:77]
v_pk_mul_f32 v[76:77], v[72:73], s[62:63] op_sel:[0,0] op_sel_hi:[0,1] neg_lo:[0,1] neg_hi:[0,1]
v_pk_fma_f32 v[76:77], v[72:73], s[62:63], v[76:77] op_sel:[1,1,0] op_sel_hi:[1,0,1] neg_lo:[0,0,0] neg_hi:[0,1,0]
v_pk_add_f32 v[72:73], v[62:63], v[78:79] neg_lo:[0,1] neg_hi:[0,1]
v_pk_add_f32 v[62:63], v[62:63], v[78:79]
v_pk_mul_f32 v[78:79], v[72:73], s[54:55] op_sel:[0,0] op_sel_hi:[0,1] neg_lo:[0,1] neg_hi:[0,1]
v_pk_fma_f32 v[78:79], v[72:73], s[54:55], v[78:79] op_sel:[1,1,0] op_sel_hi:[1,0,1] neg_lo:[0,0,0] neg_hi:[0,1,0]
v_pk_add_f32 v[72:73], v[16:17], v[24:25] neg_lo:[0,1] neg_hi:[0,1]
v_pk_add_f32 v[16:17], v[16:17], v[24:25]
v_pk_add_f32 v[24:25], v[18:19], v[26:27] neg_lo:[0,1] neg_hi:[0,1]
v_pk_add_f32 v[18:19], v[18:19], v[26:27]
v_pk_mul_f32 v[26:27], v[24:25], s[62:63] op_sel:[0,0] op_sel_hi:[0,1] neg_lo:[0,0] neg_hi:[0,1]
v_pk_fma_f32 v[26:27], v[24:25], s[62:63], v[26:27] op_sel:[1,1,0] op_sel_hi:[1,0,1] neg_lo:[0,0,0] neg_hi:[0,0,0]
v_pk_add_f32 v[24:25], v[20:21], v[28:29] op_sel:[1,1] op_sel_hi:[0,0] neg_lo:[0,1] neg_hi:[1,0]
v_pk_add_f32 v[20:21], v[20:21], v[28:29]
v_pk_add_f32 v[28:29], v[22:23], v[30:31] neg_lo:[0,1] neg_hi:[0,1]
v_pk_add_f32 v[22:23], v[22:23], v[30:31]
v_pk_mul_f32 v[30:31], v[28:29], s[62:63] op_sel:[0,0] op_sel_hi:[0,1] neg_lo:[0,1] neg_hi:[0,1]
v_pk_fma_f32 v[30:31], v[28:29], s[62:63], v[30:31] op_sel:[1,1,0] op_sel_hi:[1,0,1] neg_lo:[0,0,0] neg_hi:[0,1,0]
v_pk_add_f32 v[28:29], v[64:65], v[32:33] neg_lo:[0,1] neg_hi:[0,1]
v_pk_add_f32 v[64:65], v[64:65], v[32:33]
v_pk_add_f32 v[32:33], v[34:35], v[42:43] neg_lo:[0,1] neg_hi:[0,1]
v_pk_add_f32 v[34:35], v[34:35], v[42:43]
v_pk_mul_f32 v[42:43], v[32:33], s[62:63] op_sel:[0,0] op_sel_hi:[0,1] neg_lo:[0,0] neg_hi:[0,1]
v_pk_fma_f32 v[42:43], v[32:33], s[62:63], v[42:43] op_sel:[1,1,0] op_sel_hi:[1,0,1] neg_lo:[0,0,0] neg_hi:[0,0,0]
v_pk_add_f32 v[32:33], v[36:37], v[44:45] op_sel:[1,1] op_sel_hi:[0,0] neg_lo:[0,1] neg_hi:[1,0]
v_pk_add_f32 v[36:37], v[36:37], v[44:45]
v_pk_add_f32 v[44:45], v[38:39], v[46:47] neg_lo:[0,1] neg_hi:[0,1]
v_pk_add_f32 v[38:39], v[38:39], v[46:47]
v_pk_mul_f32 v[46:47], v[44:45], s[62:63] op_sel:[0,0] op_sel_hi:[0,1] neg_lo:[0,1] neg_hi:[0,1]
v_pk_fma_f32 v[46:47], v[44:45], s[62:63], v[46:47] op_sel:[1,1,0] op_sel_hi:[1,0,1] neg_lo:[0,0,0] neg_hi:[0,1,0]
v_pk_add_f32 v[44:45], v[14:15], v[56:57] neg_lo:[0,1] neg_hi:[0,1]
v_pk_add_f32 v[14:15], v[14:15], v[56:57]
v_pk_add_f32 v[56:57], v[50:51], v[58:59] neg_lo:[0,1] neg_hi:[0,1]
v_pk_add_f32 v[50:51], v[50:51], v[58:59]
v_pk_mul_f32 v[58:59], v[56:57], s[62:63] op_sel:[0,0] op_sel_hi:[0,1] neg_lo:[0,0] neg_hi:[0,1]
v_pk_fma_f32 v[58:59], v[56:57], s[62:63], v[58:59] op_sel:[1,1,0] op_sel_hi:[1,0,1] neg_lo:[0,0,0] neg_hi:[0,0,0]
v_pk_add_f32 v[56:57], v[52:53], v[60:61] op_sel:[1,1] op_sel_hi:[0,0] neg_lo:[0,1] neg_hi:[1,0]
v_pk_add_f32 v[52:53], v[52:53], v[60:61]
v_pk_add_f32 v[60:61], v[54:55], v[62:63] neg_lo:[0,1] neg_hi:[0,1]
v_pk_add_f32 v[54:55], v[54:55], v[62:63]
v_pk_mul_f32 v[62:63], v[60:61], s[62:63] op_sel:[0,0] op_sel_hi:[0,1] neg_lo:[0,1] neg_hi:[0,1]
v_pk_fma_f32 v[62:63], v[60:61], s[62:63], v[62:63] op_sel:[1,1,0] op_sel_hi:[1,0,1] neg_lo:[0,0,0] neg_hi:[0,1,0]
v_pk_add_f32 v[60:61], v[40:41], v[48:49] neg_lo:[0,1] neg_hi:[0,1]
v_pk_add_f32 v[40:41], v[40:41], v[48:49]
v_pk_add_f32 v[48:49], v[66:67], v[74:75] neg_lo:[0,1] neg_hi:[0,1]
v_pk_add_f32 v[66:67], v[66:67], v[74:75]
v_pk_mul_f32 v[74:75], v[48:49], s[62:63] op_sel:[0,0] op_sel_hi:[0,1] neg_lo:[0,0] neg_hi:[0,1]
v_pk_fma_f32 v[74:75], v[48:49], s[62:63], v[74:75] op_sel:[1,1,0] op_sel_hi:[1,0,1] neg_lo:[0,0,0] neg_hi:[0,0,0]
v_pk_add_f32 v[48:49], v[68:69], v[76:77] op_sel:[1,1] op_sel_hi:[0,0] neg_lo:[0,1] neg_hi:[1,0]
v_pk_add_f32 v[68:69], v[68:69], v[76:77]
v_pk_add_f32 v[76:77], v[70:71], v[78:79] neg_lo:[0,1] neg_hi:[0,1]
v_pk_add_f32 v[70:71], v[70:71], v[78:79]
v_pk_mul_f32 v[78:79], v[76:77], s[62:63] op_sel:[0,0] op_sel_hi:[0,1] neg_lo:[0,1] neg_hi:[0,1]
v_pk_fma_f32 v[78:79], v[76:77], s[62:63], v[78:79] op_sel:[1,1,0] op_sel_hi:[1,0,1] neg_lo:[0,0,0] neg_hi:[0,1,0]
v_pk_add_f32 v[76:77], v[16:17], v[20:21] neg_lo:[0,1] neg_hi:[0,1]
v_pk_add_f32 v[16:17], v[16:17], v[20:21]
v_pk_add_f32 v[20:21], v[18:19], v[22:23] op_sel:[1,1] op_sel_hi:[0,0] neg_lo:[0,1] neg_hi:[1,0]
v_pk_add_f32 v[18:19], v[18:19], v[22:23]
v_pk_add_f32 v[22:23], v[72:73], v[24:25] neg_lo:[0,1] neg_hi:[0,1]
v_pk_add_f32 v[72:73], v[72:73], v[24:25]
v_pk_add_f32 v[24:25], v[26:27], v[30:31] op_sel:[1,1] op_sel_hi:[0,0] neg_lo:[0,1] neg_hi:[1,0]
v_pk_add_f32 v[26:27], v[26:27], v[30:31]
v_pk_add_f32 v[30:31], v[64:65], v[36:37] neg_lo:[0,1] neg_hi:[0,1]
v_pk_add_f32 v[64:65], v[64:65], v[36:37]
v_pk_add_f32 v[36:37], v[34:35], v[38:39] op_sel:[1,1] op_sel_hi:[0,0] neg_lo:[0,1] neg_hi:[1,0]
v_pk_add_f32 v[34:35], v[34:35], v[38:39]
v_pk_add_f32 v[38:39], v[28:29], v[32:33] neg_lo:[0,1] neg_hi:[0,1]
v_pk_add_f32 v[28:29], v[28:29], v[32:33]
v_pk_add_f32 v[32:33], v[42:43], v[46:47] op_sel:[1,1] op_sel_hi:[0,0] neg_lo:[0,1] neg_hi:[1,0]
v_pk_add_f32 v[42:43], v[42:43], v[46:47]
v_pk_add_f32 v[46:47], v[14:15], v[52:53] neg_lo:[0,1] neg_hi:[0,1]
v_pk_add_f32 v[14:15], v[14:15], v[52:53]
v_pk_add_f32 v[52:53], v[50:51], v[54:55] op_sel:[1,1] op_sel_hi:[0,0] neg_lo:[0,1] neg_hi:[1,0]
v_pk_add_f32 v[50:51], v[50:51], v[54:55]
v_pk_add_f32 v[54:55], v[44:45], v[56:57] neg_lo:[0,1] neg_hi:[0,1]
v_pk_add_f32 v[44:45], v[44:45], v[56:57]
v_pk_add_f32 v[56:57], v[58:59], v[62:63] op_sel:[1,1] op_sel_hi:[0,0] neg_lo:[0,1] neg_hi:[1,0]
v_pk_add_f32 v[58:59], v[58:59], v[62:63]
v_pk_add_f32 v[62:63], v[40:41], v[68:69] neg_lo:[0,1] neg_hi:[0,1]
v_pk_add_f32 v[40:41], v[40:41], v[68:69]
v_pk_add_f32 v[68:69], v[66:67], v[70:71] op_sel:[1,1] op_sel_hi:[0,0] neg_lo:[0,1] neg_hi:[1,0]
v_pk_add_f32 v[66:67], v[66:67], v[70:71]
v_pk_add_f32 v[70:71], v[60:61], v[48:49] neg_lo:[0,1] neg_hi:[0,1]
v_pk_add_f32 v[60:61], v[60:61], v[48:49]
v_pk_add_f32 v[48:49], v[74:75], v[78:79] op_sel:[1,1] op_sel_hi:[0,0] neg_lo:[0,1] neg_hi:[1,0]
v_pk_add_f32 v[74:75], v[74:75], v[78:79]
v_pk_add_f32 v[78:79], v[16:17], v[18:19] neg_lo:[0,1] neg_hi:[0,1]
v_pk_add_f32 v[16:17], v[16:17], v[18:19]
v_pk_add_f32 v[18:19], v[76:77], v[20:21] neg_lo:[0,1] neg_hi:[0,1]
v_pk_add_f32 v[76:77], v[76:77], v[20:21]
v_pk_add_f32 v[20:21], v[72:73], v[26:27] neg_lo:[0,1] neg_hi:[0,1]
v_pk_add_f32 v[72:73], v[72:73], v[26:27]
v_pk_add_f32 v[26:27], v[22:23], v[24:25] neg_lo:[0,1] neg_hi:[0,1]
v_pk_add_f32 v[22:23], v[22:23], v[24:25]
v_pk_add_f32 v[24:25], v[64:65], v[34:35] neg_lo:[0,1] neg_hi:[0,1]
v_pk_add_f32 v[64:65], v[64:65], v[34:35]
v_pk_add_f32 v[34:35], v[30:31], v[36:37] neg_lo:[0,1] neg_hi:[0,1]
v_pk_add_f32 v[30:31], v[30:31], v[36:37]
v_pk_add_f32 v[36:37], v[28:29], v[42:43] neg_lo:[0,1] neg_hi:[0,1]
v_pk_add_f32 v[28:29], v[28:29], v[42:43]
v_pk_add_f32 v[42:43], v[38:39], v[32:33] neg_lo:[0,1] neg_hi:[0,1]
v_pk_add_f32 v[38:39], v[38:39], v[32:33]
v_pk_add_f32 v[32:33], v[14:15], v[50:51] neg_lo:[0,1] neg_hi:[0,1]
v_pk_add_f32 v[14:15], v[14:15], v[50:51]
v_pk_add_f32 v[50:51], v[46:47], v[52:53] neg_lo:[0,1] neg_hi:[0,1]
v_pk_add_f32 v[46:47], v[46:47], v[52:53]
v_pk_add_f32 v[52:53], v[44:45], v[58:59] neg_lo:[0,1] neg_hi:[0,1]
v_pk_add_f32 v[44:45], v[44:45], v[58:59]
v_pk_add_f32 v[58:59], v[54:55], v[56:57] neg_lo:[0,1] neg_hi:[0,1]
v_pk_add_f32 v[54:55], v[54:55], v[56:57]
v_pk_add_f32 v[56:57], v[40:41], v[66:67] neg_lo:[0,1] neg_hi:[0,1]
v_pk_add_f32 v[40:41], v[40:41], v[66:67]
v_pk_add_f32 v[66:67], v[62:63], v[68:69] neg_lo:[0,1] neg_hi:[0,1]
v_pk_add_f32 v[62:63], v[62:63], v[68:69]
v_pk_add_f32 v[68:69], v[60:61], v[74:75] neg_lo:[0,1] neg_hi:[0,1]
v_pk_add_f32 v[60:61], v[60:61], v[74:75]
v_pk_add_f32 v[74:75], v[70:71], v[48:49] neg_lo:[0,1] neg_hi:[0,1]
v_pk_add_f32 v[70:71], v[70:71], v[48:49]
ds_write_b64 v4, v[16:17] offset:0
ds_write_b64 v4, v[14:15] offset:256
ds_write_b64 v4, v[64:65] offset:512
ds_write_b64 v4, v[40:41] offset:768
ds_write_b64 v4, v[72:73] offset:1024
ds_write_b64 v4, v[44:45] offset:1280
ds_write_b64 v4, v[28:29] offset:1536
ds_write_b64 v4, v[60:61] offset:1792
ds_write_b64 v4, v[76:77] offset:2048
ds_write_b64 v4, v[46:47] offset:2304
ds_write_b64 v4, v[30:31] offset:2560
ds_write_b64 v4, v[62:63] offset:2816
ds_write_b64 v4, v[22:23] offset:3072
ds_write_b64 v4, v[54:55] offset:3328
ds_write_b64 v4, v[38:39] offset:3584
ds_write_b64 v4, v[70:71] offset:3840
ds_write_b64 v4, v[78:79] offset:4096
ds_write_b64 v4, v[32:33] offset:4352
ds_write_b64 v4, v[24:25] offset:4608
ds_write_b64 v4, v[56:57] offset:4864
ds_write_b64 v4, v[20:21] offset:5120
ds_write_b64 v4, v[52:53] offset:5376
ds_write_b64 v4, v[36:37] offset:5632
ds_write_b64 v4, v[68:69] offset:5888
ds_write_b64 v4, v[18:19] offset:6144
ds_write_b64 v4, v[50:51] offset:6400
ds_write_b64 v4, v[34:35] offset:6656
ds_write_b64 v4, v[66:67] offset:6912
ds_write_b64 v4, v[26:27] offset:7168
ds_write_b64 v4, v[58:59] offset:7424
ds_write_b64 v4, v[42:43] offset:7680
ds_write_b64 v4, v[74:75] offset:7936
ds_write_b64 v4, v[16:17] offset:8192
s_waitcnt lgkmcnt(0)
s_barrier
s_lshl_b32 s13, s93, 7
s_add_u32 s13, s13, 96468992
ds_read_b64 v[16:17], v6 offset:0
ds_read_b64 v[18:19], v7 offset:4096
ds_read_b64 v[20:21], v6 offset:256
ds_read_b64 v[22:23], v7 offset:3840
ds_read_b64 v[24:25], v6 offset:512
ds_read_b64 v[26:27], v7 offset:3584
ds_read_b64 v[28:29], v6 offset:768
ds_read_b64 v[30:31], v7 offset:3328
ds_read_b64 v[32:33], v6 offset:1024
ds_read_b64 v[34:35], v7 offset:3072
ds_read_b64 v[36:37], v6 offset:1280
ds_read_b64 v[38:39], v7 offset:2816
s_waitcnt lgkmcnt(10)
v_pk_add_f32 v[208:209], v[16:17], v[18:19] neg_hi:[0,1]
v_pk_add_f32 v[210:211], v[16:17], v[18:19] op_sel:[1,1] op_sel_hi:[0,0] neg_hi:[1,0]
ds_read_b64 v[40:41], v6 offset:1536
ds_read_b64 v[42:43], v7 offset:2560
buffer_store_dwordx4 v[208:211], v8, s[84:87], s13 offen sc1
s_add_u32 s13, s13, 524288
s_waitcnt lgkmcnt(10)
v_pk_add_f32 v[212:213], v[20:21], v[22:23] neg_hi:[0,1]
v_pk_add_f32 v[214:215], v[20:21], v[22:23] op_sel:[1,1] op_sel_hi:[0,0] neg_hi:[1,0]
ds_read_b64 v[44:45], v6 offset:1792
ds_read_b64 v[46:47], v7 offset:2304
buffer_store_dwordx4 v[212:215], v8, s[84:87], s13 offen sc1
s_add_u32 s13, s13, 524288
s_waitcnt lgkmcnt(10)
v_pk_add_f32 v[216:217], v[24:25], v[26:27] neg_hi:[0,1]
v_pk_add_f32 v[218:219], v[24:25], v[26:27] op_sel:[1,1] op_sel_hi:[0,0] neg_hi:[1,0]
ds_read_b64 v[16:17], v6 offset:2048
ds_read_b64 v[18:19], v7 offset:2048
buffer_store_dwordx4 v[216:219], v8, s[84:87], s13 offen sc1
s_add_u32 s13, s13, 524288
s_waitcnt lgkmcnt(10)
v_pk_add_f32 v[220:221], v[28:29], v[30:31] neg_hi:[0,1]
v_pk_add_f32 v[222:223], v[28:29], v[30:31] op_sel:[1,1] op_sel_hi:[0,0] neg_hi:[1,0]
ds_read_b64 v[20:21], v6 offset:2304
ds_read_b64 v[22:23], v7 offset:1792
buffer_store_dwordx4 v[220:223], v8, s[84:87], s13 offen sc1
s_add_u32 s13, s13, 524288
s_waitcnt lgkmcnt(10)
v_pk_add_f32 v[224:225], v[32:33], v[34:35] neg_hi:[0,1]
v_pk_add_f32 v[226:227], v[32:33], v[34:35] op_sel:[1,1] op_sel_hi:[0,0] neg_hi:[1,0]
ds_read_b64 v[24:25], v6 offset:2560
ds_read_b64 v[26:27], v7 offset:1536
buffer_store_dwordx4 v[224:227], v8, s[84:87], s13 offen sc1
s_add_u32 s13, s13, 524288
s_waitcnt lgkmcnt(10)
v_pk_add_f32 v[228:229], v[36:37], v[38:39] neg_hi:[0,1]
v_pk_add_f32 v[230:231], v[36:37], v[38:39] op_sel:[1,1] op_sel_hi:[0,0] neg_hi:[1,0]
ds_read_b64 v[28:29], v6 offset:2816
ds_read_b64 v[30:31], v7 offset:1280
buffer_store_dwordx4 v[228:231], v8, s[84:87], s13 offen sc1
s_add_u32 s13, s13, 524288
s_waitcnt lgkmcnt(10)
v_pk_add_f32 v[232:233], v[40:41], v[42:43] neg_hi:[0,1]
v_pk_add_f32 v[234:235], v[40:41], v[42:43] op_sel:[1,1] op_sel_hi:[0,0] neg_hi:[1,0]
ds_read_b64 v[32:33], v6 offset:3072
ds_read_b64 v[34:35], v7 offset:1024
buffer_store_dwordx4 v[232:235], v8, s[84:87], s13 offen sc1
s_add_u32 s13, s13, 524288
s_waitcnt lgkmcnt(10)
v_pk_add_f32 v[236:237], v[44:45], v[46:47] neg_hi:[0,1]
v_pk_add_f32 v[238:239], v[44:45], v[46:47] op_sel:[1,1] op_sel_hi:[0,0] neg_hi:[1,0]
ds_read_b64 v[36:37], v6 offset:3328
ds_read_b64 v[38:39], v7 offset:768
buffer_store_dwordx4 v[236:239], v8, s[84:87], s13 offen sc1
s_add_u32 s13, s13, 524288
s_waitcnt lgkmcnt(10)
v_pk_add_f32 v[208:209], v[16:17], v[18:19] neg_hi:[0,1]
v_pk_add_f32 v[210:211], v[16:17], v[18:19] op_sel:[1,1] op_sel_hi:[0,0] neg_hi:[1,0]
ds_read_b64 v[40:41], v6 offset:3584
ds_read_b64 v[42:43], v7 offset:512
buffer_store_dwordx4 v[208:211], v8, s[84:87], s13 offen sc1
s_add_u32 s13, s13, 524288
s_waitcnt lgkmcnt(10)
v_pk_add_f32 v[212:213], v[20:21], v[22:23] neg_hi:[0,1]
v_pk_add_f32 v[214:215], v[20:21], v[22:23] op_sel:[1,1] op_sel_hi:[0,0] neg_hi:[1,0]
ds_read_b64 v[44:45], v6 offset:3840
ds_read_b64 v[46:47], v7 offset:256
buffer_store_dwordx4 v[212:215], v8, s[84:87], s13 offen sc1
s_add_u32 s13, s13, 524288
s_waitcnt lgkmcnt(10)
v_pk_add_f32 v[216:217], v[24:25], v[26:27] neg_hi:[0,1]
v_pk_add_f32 v[218:219], v[24:25], v[26:27] op_sel:[1,1] op_sel_hi:[0,0] neg_hi:[1,0]
ds_read_b64 v[16:17], v6 offset:4096
ds_read_b64 v[18:19], v7 offset:0
buffer_store_dwordx4 v[216:219], v8, s[84:87], s13 offen sc1
s_add_u32 s13, s13, 524288
s_waitcnt lgkmcnt(10)
v_pk_add_f32 v[220:221], v[28:29], v[30:31] neg_hi:[0,1]
v_pk_add_f32 v[222:223], v[28:29], v[30:31] op_sel:[1,1] op_sel_hi:[0,0] neg_hi:[1,0]
buffer_store_dwordx4 v[220:223], v8, s[84:87], s13 offen sc1
s_add_u32 s13, s13, 524288
s_waitcnt lgkmcnt(8)
v_pk_add_f32 v[224:225], v[32:33], v[34:35] neg_hi:[0,1]
v_pk_add_f32 v[226:227], v[32:33], v[34:35] op_sel:[1,1] op_sel_hi:[0,0] neg_hi:[1,0]
buffer_store_dwordx4 v[224:227], v8, s[84:87], s13 offen sc1
s_add_u32 s13, s13, 524288
s_waitcnt lgkmcnt(6)
v_pk_add_f32 v[228:229], v[36:37], v[38:39] neg_hi:[0,1]
v_pk_add_f32 v[230:231], v[36:37], v[38:39] op_sel:[1,1] op_sel_hi:[0,0] neg_hi:[1,0]
buffer_store_dwordx4 v[228:231], v8, s[84:87], s13 offen sc1
s_add_u32 s13, s13, 524288
s_waitcnt lgkmcnt(4)
v_pk_add_f32 v[232:233], v[40:41], v[42:43] neg_hi:[0,1]
v_pk_add_f32 v[234:235], v[40:41], v[42:43] op_sel:[1,1] op_sel_hi:[0,0] neg_hi:[1,0]
buffer_store_dwordx4 v[232:235], v8, s[84:87], s13 offen sc1
s_add_u32 s13, s13, 524288
s_waitcnt lgkmcnt(2)
v_pk_add_f32 v[236:237], v[44:45], v[46:47] neg_hi:[0,1]
v_pk_add_f32 v[238:239], v[44:45], v[46:47] op_sel:[1,1] op_sel_hi:[0,0] neg_hi:[1,0]
buffer_store_dwordx4 v[236:239], v8, s[84:87], s13 offen sc1
s_add_u32 s13, s13, 524288
s_waitcnt lgkmcnt(0)
v_pk_add_f32 v[208:209], v[16:17], v[18:19] neg_hi:[0,1]
v_pk_add_f32 v[210:211], v[16:17], v[18:19] op_sel:[1,1] op_sel_hi:[0,0] neg_hi:[1,0]
v_cmp_eq_u32 vcc, 0, v9
s_nop 1
v_cndmask_b32 v13, -16, v8, vcc
buffer_store_dwordx4 v[208:211], v13, s[84:87], s13 offen sc1
s_add_u32 s13, s13, 524288
s_mov_b32 s93, s21
s_cmp_lt_u32 s93, 128
s_cbranch_scc1 mega_kernel_f1_l
mega_kernel_f1_e:
v_and_b32 v3, 15, v0
v_lshlrev_b32 v3, 4, v3
s_branch mega_kernel_syd
mega_kernel_sydw:
s_sleep 4
mega_kernel_syd:
buffer_load_dword v2, v3, s[72:75], 0 offen sc1
s_waitcnt vmcnt(0)
mega_kernel_sydp:
s_cmp_eq_u32 s95, 1
s_cbranch_scc0 mega_kernel_sydf
v_readlane_b32 s76, v2, 14
s_mov_b32 s98, 0
s_cmp_eq_u32 s76, 64
s_cbranch_scc0 mega_kernel_sydw
s_branch mega_kernel_sydd
mega_kernel_sydf:
s_mov_b32 s77, 0
s_mov_b32 s78, 0
v_readlane_b32 s76, v2, 0
s_add_u32 s77, s77, s76
s_xor_b32 s76, s76, 32
s_or_b32 s78, s78, s76
v_readlane_b32 s76, v2, 1
s_add_u32 s77, s77, s76
s_xor_b32 s76, s76, 32
s_or_b32 s78, s78, s76
v_readlane_b32 s76, v2, 2
s_add_u32 s77, s77, s76
s_xor_b32 s76, s76, 32
s_or_b32 s78, s78, s76
v_readlane_b32 s76, v2, 3
s_add_u32 s77, s77, s76
s_xor_b32 s76, s76, 32
s_or_b32 s78, s78, s76
v_readlane_b32 s76, v2, 4
s_add_u32 s77, s77, s76
s_xor_b32 s76, s76, 32
s_or_b32 s78, s78, s76
v_readlane_b32 s76, v2, 5
s_add_u32 s77, s77, s76
s_xor_b32 s76, s76, 32
s_or_b32 s78, s78, s76
v_readlane_b32 s76, v2, 6
s_add_u32 s77, s77, s76
s_xor_b32 s76, s76, 32
s_or_b32 s78, s78, s76
v_readlane_b32 s76, v2, 7
s_add_u32 s77, s77, s76
s_xor_b32 s76, s76, 32
s_or_b32 s78, s78, s76
s_cmp_eq_u32 s77, 256
s_cbranch_scc0 mega_kernel_sydw
v_mov_b32 v252, v2
s_cmp_eq_u32 s78, 0
s_cbranch_scc0 mega_kernel_slowent
v_readlane_b32 s76, v2, 10
v_readlane_b32 s77, v2, 8
s_cmp_eq_u32 s76, 64
s_cbranch_scc0 mega_kernel_sydw
s_cmp_gt_u32 s77, 32
s_cselect_b32 s98, 1, 0
mega_kernel_sydd:
s_waitcnt vmcnt(0)
s_barrier
v_mov_b32 v1, 0
v_mov_b32 v2, 1
s_mov_b32 s82, 69259264
v_cmp_eq_u32 vcc, 0, v0
s_and_saveexec_b64 s[80:81], vcc
s_cbranch_execz mega_kernel_sg0
buffer_atomic_add v2, v1, s[84:87], s82 offen sc1
mega_kernel_sg0:
s_mov_b64 exec, s[80:81]
s_add_u32 s38, s40, 129
s_mov_b32 s39, 32
s_mov_b32 s37, 129
s_cmp_lt_u32 s38, 129
s_cbranch_scc1 mega_kernel_f2s
s_branch mega_kernel_f2e
mega_kernel_rk:
s_load_dwordx2 s[4:5], s[0:1], 24
s_load_dwordx2 s[8:9], s[0:1], 0
v_lshrrev_b32 v2, 6, v0
v_and_b32 v1, 63, v0
v_readfirstlane_b32 s41, v2
v_lshlrev_b32 v5, 4, v1
s_waitcnt lgkmcnt(0)
s_mov_b32 s6, 8388608
s_mov_b32 s7, 0x00020000
s_mov_b32 s10, 4194304
s_mov_b32 s11, 0x00020000
s_lshl_b32 s43, s40, 8
s_lshl_b32 s44, s41, 6
s_add_u32 s48, s43, s44
s_and_b32 s43, s48, 0x7ff
v_add_u32 v19, s43, v1
v_lshlrev_b32 v19, 7, v19
s_mov_b32 s43, 131072
buffer_load_dword v250, v19, s[8:11], s43 offen
s_nop 0
v_lshrrev_b32 v2, 3, v1
s_lshl_b32 s43, s41, 3
v_add_u32 v2, s43, v2
v_bfe_u32 v3, v2, 1, 3
v_and_b32 v4, 7, v1
v_xor_b32 v3, v3, v4
v_lshlrev_b32 v6, 11, v2
v_lshl_add_u32 v6, v3, 4, v6
s_lshl_b32 s46, s41, 10
v_and_b32 v2, 15, v1
v_bfe_u32 v3, v2, 1, 3
v_lshrrev_b32 v4, 4, v1
v_xor_b32 v3, v3, v4
v_lshlrev_b32 v8, 7, v2
v_lshl_add_u32 v8, v3, 4, v8
v_xor_b32 v9, 64, v8
v_add_u32 v10, 0x10000, v8
v_add_u32 v11, 0x10000, v9
v_mov_b32 v7, v5
s_lshl_b32 s47, s40, 2
s_add_u32 s47, s47, s41
s_mov_b32 s42, 0
s_mov_b32 s50, 0
s_add_u32 m0, s46, 0
s_nop 0
buffer_load_dwordx4 v6, s[8:11], s50 offen offset:0 lds
s_add_u32 m0, s46, 3968
s_nop 0
buffer_load_dwordx4 v6, s[8:11], s50 offen offset:128 lds
s_add_u32 m0, s46, 7936
s_nop 0
buffer_load_dwordx4 v6, s[8:11], s50 offen offset:256 lds
s_add_u32 m0, s46, 11904
s_nop 0
buffer_load_dwordx4 v6, s[8:11], s50 offen offset:384 lds
s_add_u32 m0, s46, 15872
s_nop 0
buffer_load_dwordx4 v6, s[8:11], s50 offen offset:512 lds
s_add_u32 m0, s46, 19840
s_nop 0
buffer_load_dwordx4 v6, s[8:11], s50 offen offset:640 lds
s_add_u32 m0, s46, 23808
s_nop 0
buffer_load_dwordx4 v6, s[8:11], s50 offen offset:768 lds
s_add_u32 m0, s46, 27776
s_nop 0
buffer_load_dwordx4 v6, s[8:11], s50 offen offset:896 lds
s_add_u32 m0, s46, 31744
s_nop 0
buffer_load_dwordx4 v6, s[8:11], s50 offen offset:1024 lds
s_add_u32 m0, s46, 35712
s_nop 0
buffer_load_dwordx4 v6, s[8:11], s50 offen offset:1152 lds
s_add_u32 m0, s46, 39680
s_nop 0
buffer_load_dwordx4 v6, s[8:11], s50 offen offset:1280 lds
s_add_u32 m0, s46, 43648
s_nop 0
buffer_load_dwordx4 v6, s[8:11], s50 offen offset:1408 lds
s_add_u32 m0, s46, 47616
s_nop 0
buffer_load_dwordx4 v6, s[8:11], s50 offen offset:1536 lds
s_add_u32 m0, s46, 51584
s_nop 0
buffer_load_dwordx4 v6, s[8:11], s50 offen offset:1664 lds
s_add_u32 m0, s46, 55552
s_nop 0
buffer_load_dwordx4 v6, s[8:11], s50 offen offset:1792 lds
s_add_u32 m0, s46, 59520
s_nop 0
buffer_load_dwordx4 v6, s[8:11], s50 offen offset:1920 lds
s_mov_b32 s50, 0x10000
s_add_u32 m0, s46, 65536
s_nop 0
buffer_load_dwordx4 v6, s[8:11], s50 offen offset:0 lds
s_add_u32 m0, s46, 69504
s_nop 0
buffer_load_dwordx4 v6, s[8:11], s50 offen offset:128 lds
s_add_u32 m0, s46, 73472
s_nop 0
buffer_load_dwordx4 v6, s[8:11], s50 offen offset:256 lds
s_add_u32 m0, s46, 77440
s_nop 0
buffer_load_dwordx4 v6, s[8:11], s50 offen offset:384 lds
s_add_u32 m0, s46, 81408
s_nop 0
buffer_load_dwordx4 v6, s[8:11], s50 offen offset:512 lds
s_add_u32 m0, s46, 85376
s_nop 0
buffer_load_dwordx4 v6, s[8:11], s50 offen offset:640 lds
s_add_u32 m0, s46, 89344
s_nop 0
buffer_load_dwordx4 v6, s[8:11], s50 offen offset:768 lds
s_add_u32 m0, s46, 93312
s_nop 0
buffer_load_dwordx4 v6, s[8:11], s50 offen offset:896 lds
s_add_u32 m0, s46, 97280
s_nop 0
buffer_load_dwordx4 v6, s[8:11], s50 offen offset:1024 lds
s_add_u32 m0, s46, 101248
s_nop 0
buffer_load_dwordx4 v6, s[8:11], s50 offen offset:1152 lds
s_add_u32 m0, s46, 105216
s_nop 0
buffer_load_dwordx4 v6, s[8:11], s50 offen offset:1280 lds
s_add_u32 m0, s46, 109184
s_nop 0
buffer_load_dwordx4 v6, s[8:11], s50 offen offset:1408 lds
s_add_u32 m0, s46, 113152
s_nop 0
buffer_load_dwordx4 v6, s[8:11], s50 offen offset:1536 lds
s_add_u32 m0, s46, 117120
s_nop 0
buffer_load_dwordx4 v6, s[8:11], s50 offen offset:1664 lds
s_add_u32 m0, s46, 121088
s_nop 0
buffer_load_dwordx4 v6, s[8:11], s50 offen offset:1792 lds
s_add_u32 m0, s46, 125056
s_nop 0
buffer_load_dwordx4 v6, s[8:11], s50 offen offset:1920 lds
v_lshrrev_b32 v2, 2, v1
v_and_b32 v3, 3, v1
v_lshlrev_b32 v16, 13, v2
v_lshl_add_u32 v16, v3, 4, v16
v_add_u32 v16, s48, v16
s_mul_i32 s45, s41, 8192
s_add_u32 s45, s45, 131072
v_bfe_u32 v17, v1, 2, 2
v_lshrrev_b32 v18, 4, v1
v_lshl_add_u32 v17, v18, 3, v17
v_lshlrev_b32 v17, 6, v17
v_lshl_add_u32 v17, v3, 4, v17
v_add_u32 v17, s45, v17
s_and_b32 s43, s40, 3
s_lshl_b32 s43, s43, 2
s_add_u32 s43, s43, s41
s_lshl_b32 s43, s43, 3
v_and_b32 v12, 7, v1
v_add_u32 v12, s43, v12
s_lshr_b32 s43, s40, 2
s_lshl_b32 s43, s43, 10
s_add_u32 s44, s43, 896
s_add_u32 s43, s43, 384
s_cmp_ge_u32 s40, 28
s_cselect_b32 s44, s44, s43
v_mov_b32 v13, s43
v_mov_b32 v14, s44
v_cmp_gt_u32 vcc, 32, v1
s_nop 1
v_cndmask_b32 v13, v14, v13, vcc
v_lshl_add_u32 v12, v12, 13, v13
s_mov_b32 s44, 0
buffer_load_dword v250, v12, s[4:7], s44 offen
s_add_u32 m0, s45, 0
s_mov_b32 s44, 0
buffer_load_dwordx4 v16, s[4:7], s44 offen lds
s_add_u32 m0, s45, 1024
s_mov_b32 s44, 131072
buffer_load_dwordx4 v16, s[4:7], s44 offen lds
s_add_u32 m0, s45, 2048
s_mov_b32 s44, 262144
buffer_load_dwordx4 v16, s[4:7], s44 offen lds
s_add_u32 m0, s45, 3072
s_mov_b32 s44, 393216
buffer_load_dwordx4 v16, s[4:7], s44 offen lds
s_add_u32 m0, s45, 4096
s_mov_b32 s44, 524288
buffer_load_dwordx4 v16, s[4:7], s44 offen lds
s_add_u32 m0, s45, 5120
s_mov_b32 s44, 655360
buffer_load_dwordx4 v16, s[4:7], s44 offen lds
s_add_u32 m0, s45, 6144
s_mov_b32 s44, 786432
buffer_load_dwordx4 v16, s[4:7], s44 offen lds
s_add_u32 m0, s45, 7168
s_mov_b32 s44, 917504
buffer_load_dwordx4 v16, s[4:7], s44 offen lds
s_waitcnt vmcnt(4)
s_barrier
ds_read_b64_tr_b16 a[0:1], v17 offset:0
ds_read_b64_tr_b16 a[2:3], v17 offset:256
ds_read_b64_tr_b16 a[4:5], v17 offset:8
ds_read_b64_tr_b16 a[6:7], v17 offset:264
ds_read_b64_tr_b16 a[8:9], v17 offset:2048
ds_read_b64_tr_b16 a[10:11], v17 offset:2304
ds_read_b64_tr_b16 a[12:13], v17 offset:2056
ds_read_b64_tr_b16 a[14:15], v17 offset:2312
s_waitcnt lgkmcnt(0)
s_mov_b32 s44, 1048576
buffer_load_dword v250, v12, s[4:7], s44 offen
s_add_u32 m0, s45, 0
s_mov_b32 s44, 1048576
buffer_load_dwordx4 v16, s[4:7], s44 offen lds
s_add_u32 m0, s45, 1024
s_mov_b32 s44, 1179648
buffer_load_dwordx4 v16, s[4:7], s44 offen lds
s_add_u32 m0, s45, 2048
s_mov_b32 s44, 1310720
buffer_load_dwordx4 v16, s[4:7], s44 offen lds
s_add_u32 m0, s45, 3072
s_mov_b32 s44, 1441792
buffer_load_dwordx4 v16, s[4:7], s44 offen lds
ds_read_b128 v[20:23], v8 offset:0
ds_read_b128 v[24:27], v8 offset:2048
ds_read_b128 v[28:31], v9 offset:0
ds_read_b128 v[32:35], v9 offset:2048
ds_read_b128 v[36:39], v10 offset:0
ds_read_b128 v[40:43], v10 offset:2048
ds_read_b128 v[44:47], v11 offset:0
ds_read_b128 v[48:51], v11 offset:2048
s_waitcnt lgkmcnt(0)
v_mfma_f32_16x16x32_bf16 v[52:55], a[0:3], v[20:23], 0
v_mfma_f32_16x16x32_bf16 v[56:59], a[4:7], v[20:23], 0
v_mfma_f32_16x16x32_bf16 v[60:63], a[0:3], v[24:27], 0
v_mfma_f32_16x16x32_bf16 v[64:67], a[4:7], v[24:27], 0
v_mfma_f32_16x16x32_bf16 v[52:55], a[8:11], v[28:31], v[52:55]
v_mfma_f32_16x16x32_bf16 v[56:59], a[12:15], v[28:31], v[56:59]
v_mfma_f32_16x16x32_bf16 v[60:63], a[8:11], v[32:35], v[60:63]
v_mfma_f32_16x16x32_bf16 v[64:67], a[12:15], v[32:35], v[64:67]
v_mfma_f32_16x16x32_bf16 v[68:71], a[0:3], v[36:39], 0
v_mfma_f32_16x16x32_bf16 v[72:75], a[4:7], v[36:39], 0
v_mfma_f32_16x16x32_bf16 v[76:79], a[0:3], v[40:43], 0
v_mfma_f32_16x16x32_bf16 v[80:83], a[4:7], v[40:43], 0
v_mfma_f32_16x16x32_bf16 v[68:71], a[8:11], v[44:47], v[68:71]
v_mfma_f32_16x16x32_bf16 v[72:75], a[12:15], v[44:47], v[72:75]
v_mfma_f32_16x16x32_bf16 v[76:79], a[8:11], v[48:51], v[76:79]
v_mfma_f32_16x16x32_bf16 v[80:83], a[12:15], v[48:51], v[80:83]
s_waitcnt vmcnt(5)
ds_read_b64_tr_b16 a[16:17], v17 offset:4096
ds_read_b64_tr_b16 a[18:19], v17 offset:4352
ds_read_b64_tr_b16 a[20:21], v17 offset:4104
ds_read_b64_tr_b16 a[22:23], v17 offset:4360
ds_read_b64_tr_b16 a[24:25], v17 offset:6144
ds_read_b64_tr_b16 a[26:27], v17 offset:6400
ds_read_b64_tr_b16 a[28:29], v17 offset:6152
ds_read_b64_tr_b16 a[30:31], v17 offset:6408
s_waitcnt lgkmcnt(0)
s_add_u32 m0, s45, 4096
s_mov_b32 s44, 1572864
buffer_load_dwordx4 v16, s[4:7], s44 offen lds
s_add_u32 m0, s45, 5120
s_mov_b32 s44, 1703936
buffer_load_dwordx4 v16, s[4:7], s44 offen lds
s_add_u32 m0, s45, 6144
s_mov_b32 s44, 1835008
buffer_load_dwordx4 v16, s[4:7], s44 offen lds
s_add_u32 m0, s45, 7168
s_mov_b32 s44, 1966080
buffer_load_dwordx4 v16, s[4:7], s44 offen lds
ds_read_b128 v[20:23], v8 offset:4096
ds_read_b128 v[24:27], v8 offset:6144
ds_read_b128 v[28:31], v9 offset:4096
ds_read_b128 v[32:35], v9 offset:6144
ds_read_b128 v[36:39], v10 offset:4096
ds_read_b128 v[40:43], v10 offset:6144
ds_read_b128 v[44:47], v11 offset:4096
ds_read_b128 v[48:51], v11 offset:6144
s_waitcnt lgkmcnt(0)
v_mfma_f32_16x16x32_bf16 v[52:55], a[16:19], v[20:23], v[52:55]
v_mfma_f32_16x16x32_bf16 v[56:59], a[20:23], v[20:23], v[56:59]
v_mfma_f32_16x16x32_bf16 v[60:63], a[16:19], v[24:27], v[60:63]
v_mfma_f32_16x16x32_bf16 v[64:67], a[20:23], v[24:27], v[64:67]
v_mfma_f32_16x16x32_bf16 v[52:55], a[24:27], v[28:31], v[52:55]
v_mfma_f32_16x16x32_bf16 v[56:59], a[28:31], v[28:31], v[56:59]
v_mfma_f32_16x16x32_bf16 v[60:63], a[24:27], v[32:35], v[60:63]
v_mfma_f32_16x16x32_bf16 v[64:67], a[28:31], v[32:35], v[64:67]
v_mfma_f32_16x16x32_bf16 v[68:71], a[16:19], v[36:39], v[68:71]
v_mfma_f32_16x16x32_bf16 v[72:75], a[20:23], v[36:39], v[72:75]
v_mfma_f32_16x16x32_bf16 v[76:79], a[16:19], v[40:43], v[76:79]
v_mfma_f32_16x16x32_bf16 v[80:83], a[20:23], v[40:43], v[80:83]
v_mfma_f32_16x16x32_bf16 v[68:71], a[24:27], v[44:47], v[68:71]
v_mfma_f32_16x16x32_bf16 v[72:75], a[28:31], v[44:47], v[72:75]
v_mfma_f32_16x16x32_bf16 v[76:79], a[24:27], v[48:51], v[76:79]
v_mfma_f32_16x16x32_bf16 v[80:83], a[28:31], v[48:51], v[80:83]
s_waitcnt vmcnt(4)
ds_read_b64_tr_b16 a[32:33], v17 offset:0
ds_read_b64_tr_b16 a[34:35], v17 offset:256
ds_read_b64_tr_b16 a[36:37], v17 offset:8
ds_read_b64_tr_b16 a[38:39], v17 offset:264
ds_read_b64_tr_b16 a[40:41], v17 offset:2048
ds_read_b64_tr_b16 a[42:43], v17 offset:2304
ds_read_b64_tr_b16 a[44:45], v17 offset:2056
ds_read_b64_tr_b16 a[46:47], v17 offset:2312
s_waitcnt lgkmcnt(0)
s_mov_b32 s44, 2097152
buffer_load_dword v250, v12, s[4:7], s44 offen
s_add_u32 m0, s45, 0
s_mov_b32 s44, 2097152
buffer_load_dwordx4 v16, s[4:7], s44 offen lds
s_add_u32 m0, s45, 1024
s_mov_b32 s44, 2228224
buffer_load_dwordx4 v16, s[4:7], s44 offen lds
s_add_u32 m0, s45, 2048
s_mov_b32 s44, 2359296
buffer_load_dwordx4 v16, s[4:7], s44 offen lds
s_add_u32 m0, s45, 3072
s_mov_b32 s44, 2490368
buffer_load_dwordx4 v16, s[4:7], s44 offen lds
ds_read_b128 v[20:23], v8 offset:8192
ds_read_b128 v[24:27], v8 offset:10240
ds_read_b128 v[28:31], v9 offset:8192
ds_read_b128 v[32:35], v9 offset:10240
ds_read_b128 v[36:39], v10 offset:8192
ds_read_b128 v[40:43], v10 offset:10240
ds_read_b128 v[44:47], v11 offset:8192
ds_read_b128 v[48:51], v11 offset:10240
s_waitcnt lgkmcnt(0)
v_mfma_f32_16x16x32_bf16 v[52:55], a[32:35], v[20:23], v[52:55]
v_mfma_f32_16x16x32_bf16 v[56:59], a[36:39], v[20:23], v[56:59]
v_mfma_f32_16x16x32_bf16 v[60:63], a[32:35], v[24:27], v[60:63]
v_mfma_f32_16x16x32_bf16 v[64:67], a[36:39], v[24:27], v[64:67]
v_mfma_f32_16x16x32_bf16 v[52:55], a[40:43], v[28:31], v[52:55]
v_mfma_f32_16x16x32_bf16 v[56:59], a[44:47], v[28:31], v[56:59]
v_mfma_f32_16x16x32_bf16 v[60:63], a[40:43], v[32:35], v[60:63]
v_mfma_f32_16x16x32_bf16 v[64:67], a[44:47], v[32:35], v[64:67]
v_mfma_f32_16x16x32_bf16 v[68:71], a[32:35], v[36:39], v[68:71]
v_mfma_f32_16x16x32_bf16 v[72:75], a[36:39], v[36:39], v[72:75]
v_mfma_f32_16x16x32_bf16 v[76:79], a[32:35], v[40:43], v[76:79]
v_mfma_f32_16x16x32_bf16 v[80:83], a[36:39], v[40:43], v[80:83]
v_mfma_f32_16x16x32_bf16 v[68:71], a[40:43], v[44:47], v[68:71]
v_mfma_f32_16x16x32_bf16 v[72:75], a[44:47], v[44:47], v[72:75]
v_mfma_f32_16x16x32_bf16 v[76:79], a[40:43], v[48:51], v[76:79]
v_mfma_f32_16x16x32_bf16 v[80:83], a[44:47], v[48:51], v[80:83]
s_waitcnt vmcnt(5)
ds_read_b64_tr_b16 a[48:49], v17 offset:4096
ds_read_b64_tr_b16 a[50:51], v17 offset:4352
ds_read_b64_tr_b16 a[52:53], v17 offset:4104
ds_read_b64_tr_b16 a[54:55], v17 offset:4360
ds_read_b64_tr_b16 a[56:57], v17 offset:6144
ds_read_b64_tr_b16 a[58:59], v17 offset:6400
ds_read_b64_tr_b16 a[60:61], v17 offset:6152
ds_read_b64_tr_b16 a[62:63], v17 offset:6408
s_waitcnt lgkmcnt(0)
s_add_u32 m0, s45, 4096
s_mov_b32 s44, 2621440
buffer_load_dwordx4 v16, s[4:7], s44 offen lds
s_add_u32 m0, s45, 5120
s_mov_b32 s44, 2752512
buffer_load_dwordx4 v16, s[4:7], s44 offen lds
s_add_u32 m0, s45, 6144
s_mov_b32 s44, 2883584
buffer_load_dwordx4 v16, s[4:7], s44 offen lds
s_add_u32 m0, s45, 7168
s_mov_b32 s44, 3014656
buffer_load_dwordx4 v16, s[4:7], s44 offen lds
ds_read_b128 v[20:23], v8 offset:12288
ds_read_b128 v[24:27], v8 offset:14336
ds_read_b128 v[28:31], v9 offset:12288
ds_read_b128 v[32:35], v9 offset:14336
ds_read_b128 v[36:39], v10 offset:12288
ds_read_b128 v[40:43], v10 offset:14336
ds_read_b128 v[44:47], v11 offset:12288
ds_read_b128 v[48:51], v11 offset:14336
s_waitcnt lgkmcnt(0)
v_mfma_f32_16x16x32_bf16 v[52:55], a[48:51], v[20:23], v[52:55]
v_mfma_f32_16x16x32_bf16 v[56:59], a[52:55], v[20:23], v[56:59]
v_mfma_f32_16x16x32_bf16 v[60:63], a[48:51], v[24:27], v[60:63]
v_mfma_f32_16x16x32_bf16 v[64:67], a[52:55], v[24:27], v[64:67]
v_mfma_f32_16x16x32_bf16 v[52:55], a[56:59], v[28:31], v[52:55]
v_mfma_f32_16x16x32_bf16 v[56:59], a[60:63], v[28:31], v[56:59]
v_mfma_f32_16x16x32_bf16 v[60:63], a[56:59], v[32:35], v[60:63]
v_mfma_f32_16x16x32_bf16 v[64:67], a[60:63], v[32:35], v[64:67]
v_mfma_f32_16x16x32_bf16 v[68:71], a[48:51], v[36:39], v[68:71]
v_mfma_f32_16x16x32_bf16 v[72:75], a[52:55], v[36:39], v[72:75]
v_mfma_f32_16x16x32_bf16 v[76:79], a[48:51], v[40:43], v[76:79]
v_mfma_f32_16x16x32_bf16 v[80:83], a[52:55], v[40:43], v[80:83]
v_mfma_f32_16x16x32_bf16 v[68:71], a[56:59], v[44:47], v[68:71]
v_mfma_f32_16x16x32_bf16 v[72:75], a[60:63], v[44:47], v[72:75]
v_mfma_f32_16x16x32_bf16 v[76:79], a[56:59], v[48:51], v[76:79]
v_mfma_f32_16x16x32_bf16 v[80:83], a[60:63], v[48:51], v[80:83]
s_waitcnt vmcnt(4)
ds_read_b64_tr_b16 a[64:65], v17 offset:0
ds_read_b64_tr_b16 a[66:67], v17 offset:256
ds_read_b64_tr_b16 a[68:69], v17 offset:8
ds_read_b64_tr_b16 a[70:71], v17 offset:264
ds_read_b64_tr_b16 a[72:73], v17 offset:2048
ds_read_b64_tr_b16 a[74:75], v17 offset:2304
ds_read_b64_tr_b16 a[76:77], v17 offset:2056
ds_read_b64_tr_b16 a[78:79], v17 offset:2312
s_waitcnt lgkmcnt(0)
s_mov_b32 s44, 3145728
buffer_load_dword v250, v12, s[4:7], s44 offen
s_add_u32 m0, s45, 0
s_mov_b32 s44, 3145728
buffer_load_dwordx4 v16, s[4:7], s44 offen lds
s_add_u32 m0, s45, 1024
s_mov_b32 s44, 3276800
buffer_load_dwordx4 v16, s[4:7], s44 offen lds
s_add_u32 m0, s45, 2048
s_mov_b32 s44, 3407872
buffer_load_dwordx4 v16, s[4:7], s44 offen lds
s_add_u32 m0, s45, 3072
s_mov_b32 s44, 3538944
buffer_load_dwordx4 v16, s[4:7], s44 offen lds
ds_read_b128 v[20:23], v8 offset:16384
ds_read_b128 v[24:27], v8 offset:18432
ds_read_b128 v[28:31], v9 offset:16384
ds_read_b128 v[32:35], v9 offset:18432
ds_read_b128 v[36:39], v10 offset:16384
ds_read_b128 v[40:43], v10 offset:18432
ds_read_b128 v[44:47], v11 offset:16384
ds_read_b128 v[48:51], v11 offset:18432
s_waitcnt lgkmcnt(0)
v_mfma_f32_16x16x32_bf16 v[52:55], a[64:67], v[20:23], v[52:55]
v_mfma_f32_16x16x32_bf16 v[56:59], a[68:71], v[20:23], v[56:59]
v_mfma_f32_16x16x32_bf16 v[60:63], a[64:67], v[24:27], v[60:63]
v_mfma_f32_16x16x32_bf16 v[64:67], a[68:71], v[24:27], v[64:67]
v_mfma_f32_16x16x32_bf16 v[52:55], a[72:75], v[28:31], v[52:55]
v_mfma_f32_16x16x32_bf16 v[56:59], a[76:79], v[28:31], v[56:59]
v_mfma_f32_16x16x32_bf16 v[60:63], a[72:75], v[32:35], v[60:63]
v_mfma_f32_16x16x32_bf16 v[64:67], a[76:79], v[32:35], v[64:67]
v_mfma_f32_16x16x32_bf16 v[68:71], a[64:67], v[36:39], v[68:71]
v_mfma_f32_16x16x32_bf16 v[72:75], a[68:71], v[36:39], v[72:75]
v_mfma_f32_16x16x32_bf16 v[76:79], a[64:67], v[40:43], v[76:79]
v_mfma_f32_16x16x32_bf16 v[80:83], a[68:71], v[40:43], v[80:83]
v_mfma_f32_16x16x32_bf16 v[68:71], a[72:75], v[44:47], v[68:71]
v_mfma_f32_16x16x32_bf16 v[72:75], a[76:79], v[44:47], v[72:75]
v_mfma_f32_16x16x32_bf16 v[76:79], a[72:75], v[48:51], v[76:79]
v_mfma_f32_16x16x32_bf16 v[80:83], a[76:79], v[48:51], v[80:83]
s_waitcnt vmcnt(5)
ds_read_b64_tr_b16 a[80:81], v17 offset:4096
ds_read_b64_tr_b16 a[82:83], v17 offset:4352
ds_read_b64_tr_b16 a[84:85], v17 offset:4104
ds_read_b64_tr_b16 a[86:87], v17 offset:4360
ds_read_b64_tr_b16 a[88:89], v17 offset:6144
ds_read_b64_tr_b16 a[90:91], v17 offset:6400
ds_read_b64_tr_b16 a[92:93], v17 offset:6152
ds_read_b64_tr_b16 a[94:95], v17 offset:6408
s_waitcnt lgkmcnt(0)
s_add_u32 m0, s45, 4096
s_mov_b32 s44, 3670016
buffer_load_dwordx4 v16, s[4:7], s44 offen lds
s_add_u32 m0, s45, 5120
s_mov_b32 s44, 3801088
buffer_load_dwordx4 v16, s[4:7], s44 offen lds
s_add_u32 m0, s45, 6144
s_mov_b32 s44, 3932160
buffer_load_dwordx4 v16, s[4:7], s44 offen lds
s_add_u32 m0, s45, 7168
s_mov_b32 s44, 4063232
buffer_load_dwordx4 v16, s[4:7], s44 offen lds
ds_read_b128 v[20:23], v8 offset:20480
ds_read_b128 v[24:27], v8 offset:22528
ds_read_b128 v[28:31], v9 offset:20480
ds_read_b128 v[32:35], v9 offset:22528
ds_read_b128 v[36:39], v10 offset:20480
ds_read_b128 v[40:43], v10 offset:22528
ds_read_b128 v[44:47], v11 offset:20480
ds_read_b128 v[48:51], v11 offset:22528
s_waitcnt lgkmcnt(0)
v_mfma_f32_16x16x32_bf16 v[52:55], a[80:83], v[20:23], v[52:55]
v_mfma_f32_16x16x32_bf16 v[56:59], a[84:87], v[20:23], v[56:59]
v_mfma_f32_16x16x32_bf16 v[60:63], a[80:83], v[24:27], v[60:63]
v_mfma_f32_16x16x32_bf16 v[64:67], a[84:87], v[24:27], v[64:67]
v_mfma_f32_16x16x32_bf16 v[52:55], a[88:91], v[28:31], v[52:55]
v_mfma_f32_16x16x32_bf16 v[56:59], a[92:95], v[28:31], v[56:59]
v_mfma_f32_16x16x32_bf16 v[60:63], a[88:91], v[32:35], v[60:63]
v_mfma_f32_16x16x32_bf16 v[64:67], a[92:95], v[32:35], v[64:67]
v_mfma_f32_16x16x32_bf16 v[68:71], a[80:83], v[36:39], v[68:71]
v_mfma_f32_16x16x32_bf16 v[72:75], a[84:87], v[36:39], v[72:75]
v_mfma_f32_16x16x32_bf16 v[76:79], a[80:83], v[40:43], v[76:79]
v_mfma_f32_16x16x32_bf16 v[80:83], a[84:87], v[40:43], v[80:83]
v_mfma_f32_16x16x32_bf16 v[68:71], a[88:91], v[44:47], v[68:71]
v_mfma_f32_16x16x32_bf16 v[72:75], a[92:95], v[44:47], v[72:75]
v_mfma_f32_16x16x32_bf16 v[76:79], a[88:91], v[48:51], v[76:79]
v_mfma_f32_16x16x32_bf16 v[80:83], a[92:95], v[48:51], v[80:83]
s_waitcnt vmcnt(4)
ds_read_b64_tr_b16 a[96:97], v17 offset:0
ds_read_b64_tr_b16 a[98:99], v17 offset:256
ds_read_b64_tr_b16 a[100:101], v17 offset:8
ds_read_b64_tr_b16 a[102:103], v17 offset:264
ds_read_b64_tr_b16 a[104:105], v17 offset:2048
ds_read_b64_tr_b16 a[106:107], v17 offset:2304
ds_read_b64_tr_b16 a[108:109], v17 offset:2056
ds_read_b64_tr_b16 a[110:111], v17 offset:2312
s_waitcnt lgkmcnt(0)
s_mov_b32 s44, 4194304
buffer_load_dword v250, v12, s[4:7], s44 offen
s_add_u32 m0, s45, 0
s_mov_b32 s44, 4194304
buffer_load_dwordx4 v16, s[4:7], s44 offen lds
s_add_u32 m0, s45, 1024
s_mov_b32 s44, 4325376
buffer_load_dwordx4 v16, s[4:7], s44 offen lds
s_add_u32 m0, s45, 2048
s_mov_b32 s44, 4456448
buffer_load_dwordx4 v16, s[4:7], s44 offen lds
s_add_u32 m0, s45, 3072
s_mov_b32 s44, 4587520
buffer_load_dwordx4 v16, s[4:7], s44 offen lds
ds_read_b128 v[20:23], v8 offset:24576
ds_read_b128 v[24:27], v8 offset:26624
ds_read_b128 v[28:31], v9 offset:24576
ds_read_b128 v[32:35], v9 offset:26624
ds_read_b128 v[36:39], v10 offset:24576
ds_read_b128 v[40:43], v10 offset:26624
ds_read_b128 v[44:47], v11 offset:24576
ds_read_b128 v[48:51], v11 offset:26624
s_waitcnt lgkmcnt(0)
v_mfma_f32_16x16x32_bf16 v[52:55], a[96:99], v[20:23], v[52:55]
v_mfma_f32_16x16x32_bf16 v[56:59], a[100:103], v[20:23], v[56:59]
v_mfma_f32_16x16x32_bf16 v[60:63], a[96:99], v[24:27], v[60:63]
v_mfma_f32_16x16x32_bf16 v[64:67], a[100:103], v[24:27], v[64:67]
v_mfma_f32_16x16x32_bf16 v[52:55], a[104:107], v[28:31], v[52:55]
v_mfma_f32_16x16x32_bf16 v[56:59], a[108:111], v[28:31], v[56:59]
v_mfma_f32_16x16x32_bf16 v[60:63], a[104:107], v[32:35], v[60:63]
v_mfma_f32_16x16x32_bf16 v[64:67], a[108:111], v[32:35], v[64:67]
v_mfma_f32_16x16x32_bf16 v[68:71], a[96:99], v[36:39], v[68:71]
v_mfma_f32_16x16x32_bf16 v[72:75], a[100:103], v[36:39], v[72:75]
v_mfma_f32_16x16x32_bf16 v[76:79], a[96:99], v[40:43], v[76:79]
v_mfma_f32_16x16x32_bf16 v[80:83], a[100:103], v[40:43], v[80:83]
v_mfma_f32_16x16x32_bf16 v[68:71], a[104:107], v[44:47], v[68:71]
v_mfma_f32_16x16x32_bf16 v[72:75], a[108:111], v[44:47], v[72:75]
v_mfma_f32_16x16x32_bf16 v[76:79], a[104:107], v[48:51], v[76:79]
v_mfma_f32_16x16x32_bf16 v[80:83], a[108:111], v[48:51], v[80:83]
s_waitcnt vmcnt(5)
ds_read_b64_tr_b16 a[112:113], v17 offset:4096
ds_read_b64_tr_b16 a[114:115], v17 offset:4352
ds_read_b64_tr_b16 a[116:117], v17 offset:4104
ds_read_b64_tr_b16 a[118:119], v17 offset:4360
ds_read_b64_tr_b16 a[120:121], v17 offset:6144
ds_read_b64_tr_b16 a[122:123], v17 offset:6400
ds_read_b64_tr_b16 a[124:125], v17 offset:6152
ds_read_b64_tr_b16 a[126:127], v17 offset:6408
s_waitcnt lgkmcnt(0)
s_add_u32 m0, s45, 4096
s_mov_b32 s44, 4718592
buffer_load_dwordx4 v16, s[4:7], s44 offen lds
s_add_u32 m0, s45, 5120
s_mov_b32 s44, 4849664
buffer_load_dwordx4 v16, s[4:7], s44 offen lds
s_add_u32 m0, s45, 6144
s_mov_b32 s44, 4980736
buffer_load_dwordx4 v16, s[4:7], s44 offen lds
s_add_u32 m0, s45, 7168
s_mov_b32 s44, 5111808
buffer_load_dwordx4 v16, s[4:7], s44 offen lds
ds_read_b128 v[20:23], v8 offset:28672
ds_read_b128 v[24:27], v8 offset:30720
ds_read_b128 v[28:31], v9 offset:28672
ds_read_b128 v[32:35], v9 offset:30720
ds_read_b128 v[36:39], v10 offset:28672
ds_read_b128 v[40:43], v10 offset:30720
ds_read_b128 v[44:47], v11 offset:28672
ds_read_b128 v[48:51], v11 offset:30720
s_waitcnt lgkmcnt(0)
v_mfma_f32_16x16x32_bf16 v[52:55], a[112:115], v[20:23], v[52:55]
v_mfma_f32_16x16x32_bf16 v[56:59], a[116:119], v[20:23], v[56:59]
v_mfma_f32_16x16x32_bf16 v[60:63], a[112:115], v[24:27], v[60:63]
v_mfma_f32_16x16x32_bf16 v[64:67], a[116:119], v[24:27], v[64:67]
v_mfma_f32_16x16x32_bf16 v[52:55], a[120:123], v[28:31], v[52:55]
v_mfma_f32_16x16x32_bf16 v[56:59], a[124:127], v[28:31], v[56:59]
v_mfma_f32_16x16x32_bf16 v[60:63], a[120:123], v[32:35], v[60:63]
v_mfma_f32_16x16x32_bf16 v[64:67], a[124:127], v[32:35], v[64:67]
v_mfma_f32_16x16x32_bf16 v[68:71], a[112:115], v[36:39], v[68:71]
v_mfma_f32_16x16x32_bf16 v[72:75], a[116:119], v[36:39], v[72:75]
v_mfma_f32_16x16x32_bf16 v[76:79], a[112:115], v[40:43], v[76:79]
v_mfma_f32_16x16x32_bf16 v[80:83], a[116:119], v[40:43], v[80:83]
v_mfma_f32_16x16x32_bf16 v[68:71], a[120:123], v[44:47], v[68:71]
v_mfma_f32_16x16x32_bf16 v[72:75], a[124:127], v[44:47], v[72:75]
v_mfma_f32_16x16x32_bf16 v[76:79], a[120:123], v[48:51], v[76:79]
v_mfma_f32_16x16x32_bf16 v[80:83], a[124:127], v[48:51], v[80:83]
s_waitcnt vmcnt(4)
ds_read_b64_tr_b16 a[128:129], v17 offset:0
ds_read_b64_tr_b16 a[130:131], v17 offset:256
ds_read_b64_tr_b16 a[132:133], v17 offset:8
ds_read_b64_tr_b16 a[134:135], v17 offset:264
ds_read_b64_tr_b16 a[136:137], v17 offset:2048
ds_read_b64_tr_b16 a[138:139], v17 offset:2304
ds_read_b64_tr_b16 a[140:141], v17 offset:2056
ds_read_b64_tr_b16 a[142:143], v17 offset:2312
s_waitcnt lgkmcnt(0)
s_mov_b32 s44, 5242880
buffer_load_dword v250, v12, s[4:7], s44 offen
s_add_u32 m0, s45, 0
s_mov_b32 s44, 5242880
buffer_load_dwordx4 v16, s[4:7], s44 offen lds
s_add_u32 m0, s45, 1024
s_mov_b32 s44, 5373952
buffer_load_dwordx4 v16, s[4:7], s44 offen lds
s_add_u32 m0, s45, 2048
s_mov_b32 s44, 5505024
buffer_load_dwordx4 v16, s[4:7], s44 offen lds
s_add_u32 m0, s45, 3072
s_mov_b32 s44, 5636096
buffer_load_dwordx4 v16, s[4:7], s44 offen lds
ds_read_b128 v[20:23], v8 offset:32768
ds_read_b128 v[24:27], v8 offset:34816
ds_read_b128 v[28:31], v9 offset:32768
ds_read_b128 v[32:35], v9 offset:34816
ds_read_b128 v[36:39], v10 offset:32768
ds_read_b128 v[40:43], v10 offset:34816
ds_read_b128 v[44:47], v11 offset:32768
ds_read_b128 v[48:51], v11 offset:34816
s_waitcnt lgkmcnt(0)
v_mfma_f32_16x16x32_bf16 v[52:55], a[128:131], v[20:23], v[52:55]
v_mfma_f32_16x16x32_bf16 v[56:59], a[132:135], v[20:23], v[56:59]
v_mfma_f32_16x16x32_bf16 v[60:63], a[128:131], v[24:27], v[60:63]
v_mfma_f32_16x16x32_bf16 v[64:67], a[132:135], v[24:27], v[64:67]
v_mfma_f32_16x16x32_bf16 v[52:55], a[136:139], v[28:31], v[52:55]
v_mfma_f32_16x16x32_bf16 v[56:59], a[140:143], v[28:31], v[56:59]
v_mfma_f32_16x16x32_bf16 v[60:63], a[136:139], v[32:35], v[60:63]
v_mfma_f32_16x16x32_bf16 v[64:67], a[140:143], v[32:35], v[64:67]
v_mfma_f32_16x16x32_bf16 v[68:71], a[128:131], v[36:39], v[68:71]
v_mfma_f32_16x16x32_bf16 v[72:75], a[132:135], v[36:39], v[72:75]
v_mfma_f32_16x16x32_bf16 v[76:79], a[128:131], v[40:43], v[76:79]
v_mfma_f32_16x16x32_bf16 v[80:83], a[132:135], v[40:43], v[80:83]
v_mfma_f32_16x16x32_bf16 v[68:71], a[136:139], v[44:47], v[68:71]
v_mfma_f32_16x16x32_bf16 v[72:75], a[140:143], v[44:47], v[72:75]
v_mfma_f32_16x16x32_bf16 v[76:79], a[136:139], v[48:51], v[76:79]
v_mfma_f32_16x16x32_bf16 v[80:83], a[140:143], v[48:51], v[80:83]
s_waitcnt vmcnt(5)
ds_read_b64_tr_b16 a[144:145], v17 offset:4096
ds_read_b64_tr_b16 a[146:147], v17 offset:4352
ds_read_b64_tr_b16 a[148:149], v17 offset:4104
ds_read_b64_tr_b16 a[150:151], v17 offset:4360
ds_read_b64_tr_b16 a[152:153], v17 offset:6144
ds_read_b64_tr_b16 a[154:155], v17 offset:6400
ds_read_b64_tr_b16 a[156:157], v17 offset:6152
ds_read_b64_tr_b16 a[158:159], v17 offset:6408
s_waitcnt lgkmcnt(0)
s_add_u32 m0, s45, 4096
s_mov_b32 s44, 5767168
buffer_load_dwordx4 v16, s[4:7], s44 offen lds
s_add_u32 m0, s45, 5120
s_mov_b32 s44, 5898240
buffer_load_dwordx4 v16, s[4:7], s44 offen lds
s_add_u32 m0, s45, 6144
s_mov_b32 s44, 6029312
buffer_load_dwordx4 v16, s[4:7], s44 offen lds
s_add_u32 m0, s45, 7168
s_mov_b32 s44, 6160384
buffer_load_dwordx4 v16, s[4:7], s44 offen lds
ds_read_b128 v[20:23], v8 offset:36864
ds_read_b128 v[24:27], v8 offset:38912
ds_read_b128 v[28:31], v9 offset:36864
ds_read_b128 v[32:35], v9 offset:38912
ds_read_b128 v[36:39], v10 offset:36864
ds_read_b128 v[40:43], v10 offset:38912
ds_read_b128 v[44:47], v11 offset:36864
ds_read_b128 v[48:51], v11 offset:38912
s_waitcnt lgkmcnt(0)
v_mfma_f32_16x16x32_bf16 v[52:55], a[144:147], v[20:23], v[52:55]
v_mfma_f32_16x16x32_bf16 v[56:59], a[148:151], v[20:23], v[56:59]
v_mfma_f32_16x16x32_bf16 v[60:63], a[144:147], v[24:27], v[60:63]
v_mfma_f32_16x16x32_bf16 v[64:67], a[148:151], v[24:27], v[64:67]
v_mfma_f32_16x16x32_bf16 v[52:55], a[152:155], v[28:31], v[52:55]
v_mfma_f32_16x16x32_bf16 v[56:59], a[156:159], v[28:31], v[56:59]
v_mfma_f32_16x16x32_bf16 v[60:63], a[152:155], v[32:35], v[60:63]
v_mfma_f32_16x16x32_bf16 v[64:67], a[156:159], v[32:35], v[64:67]
v_mfma_f32_16x16x32_bf16 v[68:71], a[144:147], v[36:39], v[68:71]
v_mfma_f32_16x16x32_bf16 v[72:75], a[148:151], v[36:39], v[72:75]
v_mfma_f32_16x16x32_bf16 v[76:79], a[144:147], v[40:43], v[76:79]
v_mfma_f32_16x16x32_bf16 v[80:83], a[148:151], v[40:43], v[80:83]
v_mfma_f32_16x16x32_bf16 v[68:71], a[152:155], v[44:47], v[68:71]
v_mfma_f32_16x16x32_bf16 v[72:75], a[156:159], v[44:47], v[72:75]
v_mfma_f32_16x16x32_bf16 v[76:79], a[152:155], v[48:51], v[76:79]
v_mfma_f32_16x16x32_bf16 v[80:83], a[156:159], v[48:51], v[80:83]
s_waitcnt vmcnt(4)
ds_read_b64_tr_b16 a[160:161], v17 offset:0
ds_read_b64_tr_b16 a[162:163], v17 offset:256
ds_read_b64_tr_b16 a[164:165], v17 offset:8
ds_read_b64_tr_b16 a[166:167], v17 offset:264
ds_read_b64_tr_b16 a[168:169], v17 offset:2048
ds_read_b64_tr_b16 a[170:171], v17 offset:2304
ds_read_b64_tr_b16 a[172:173], v17 offset:2056
ds_read_b64_tr_b16 a[174:175], v17 offset:2312
s_waitcnt lgkmcnt(0)
s_mov_b32 s44, 6291456
buffer_load_dword v250, v12, s[4:7], s44 offen
s_add_u32 m0, s45, 0
s_mov_b32 s44, 6291456
buffer_load_dwordx4 v16, s[4:7], s44 offen lds
s_add_u32 m0, s45, 1024
s_mov_b32 s44, 6422528
buffer_load_dwordx4 v16, s[4:7], s44 offen lds
s_add_u32 m0, s45, 2048
s_mov_b32 s44, 6553600
buffer_load_dwordx4 v16, s[4:7], s44 offen lds
s_add_u32 m0, s45, 3072
s_mov_b32 s44, 6684672
buffer_load_dwordx4 v16, s[4:7], s44 offen lds
ds_read_b128 v[20:23], v8 offset:40960
ds_read_b128 v[24:27], v8 offset:43008
ds_read_b128 v[28:31], v9 offset:40960
ds_read_b128 v[32:35], v9 offset:43008
ds_read_b128 v[36:39], v10 offset:40960
ds_read_b128 v[40:43], v10 offset:43008
ds_read_b128 v[44:47], v11 offset:40960
ds_read_b128 v[48:51], v11 offset:43008
s_waitcnt lgkmcnt(0)
v_mfma_f32_16x16x32_bf16 v[52:55], a[160:163], v[20:23], v[52:55]
v_mfma_f32_16x16x32_bf16 v[56:59], a[164:167], v[20:23], v[56:59]
v_mfma_f32_16x16x32_bf16 v[60:63], a[160:163], v[24:27], v[60:63]
v_mfma_f32_16x16x32_bf16 v[64:67], a[164:167], v[24:27], v[64:67]
v_mfma_f32_16x16x32_bf16 v[52:55], a[168:171], v[28:31], v[52:55]
v_mfma_f32_16x16x32_bf16 v[56:59], a[172:175], v[28:31], v[56:59]
v_mfma_f32_16x16x32_bf16 v[60:63], a[168:171], v[32:35], v[60:63]
v_mfma_f32_16x16x32_bf16 v[64:67], a[172:175], v[32:35], v[64:67]
v_mfma_f32_16x16x32_bf16 v[68:71], a[160:163], v[36:39], v[68:71]
v_mfma_f32_16x16x32_bf16 v[72:75], a[164:167], v[36:39], v[72:75]
v_mfma_f32_16x16x32_bf16 v[76:79], a[160:163], v[40:43], v[76:79]
v_mfma_f32_16x16x32_bf16 v[80:83], a[164:167], v[40:43], v[80:83]
v_mfma_f32_16x16x32_bf16 v[68:71], a[168:171], v[44:47], v[68:71]
v_mfma_f32_16x16x32_bf16 v[72:75], a[172:175], v[44:47], v[72:75]
v_mfma_f32_16x16x32_bf16 v[76:79], a[168:171], v[48:51], v[76:79]
v_mfma_f32_16x16x32_bf16 v[80:83], a[172:175], v[48:51], v[80:83]
s_waitcnt vmcnt(5)
ds_read_b64_tr_b16 a[176:177], v17 offset:4096
ds_read_b64_tr_b16 a[178:179], v17 offset:4352
ds_read_b64_tr_b16 a[180:181], v17 offset:4104
ds_read_b64_tr_b16 a[182:183], v17 offset:4360
ds_read_b64_tr_b16 a[184:185], v17 offset:6144
ds_read_b64_tr_b16 a[186:187], v17 offset:6400
ds_read_b64_tr_b16 a[188:189], v17 offset:6152
ds_read_b64_tr_b16 a[190:191], v17 offset:6408
s_waitcnt lgkmcnt(0)
s_add_u32 m0, s45, 4096
s_mov_b32 s44, 6815744
buffer_load_dwordx4 v16, s[4:7], s44 offen lds
s_add_u32 m0, s45, 5120
s_mov_b32 s44, 6946816
buffer_load_dwordx4 v16, s[4:7], s44 offen lds
s_add_u32 m0, s45, 6144
s_mov_b32 s44, 7077888
buffer_load_dwordx4 v16, s[4:7], s44 offen lds
s_add_u32 m0, s45, 7168
s_mov_b32 s44, 7208960
buffer_load_dwordx4 v16, s[4:7], s44 offen lds
ds_read_b128 v[20:23], v8 offset:45056
ds_read_b128 v[24:27], v8 offset:47104
ds_read_b128 v[28:31], v9 offset:45056
ds_read_b128 v[32:35], v9 offset:47104
ds_read_b128 v[36:39], v10 offset:45056
ds_read_b128 v[40:43], v10 offset:47104
ds_read_b128 v[44:47], v11 offset:45056
ds_read_b128 v[48:51], v11 offset:47104
s_waitcnt lgkmcnt(0)
v_mfma_f32_16x16x32_bf16 v[52:55], a[176:179], v[20:23], v[52:55]
v_mfma_f32_16x16x32_bf16 v[56:59], a[180:183], v[20:23], v[56:59]
v_mfma_f32_16x16x32_bf16 v[60:63], a[176:179], v[24:27], v[60:63]
v_mfma_f32_16x16x32_bf16 v[64:67], a[180:183], v[24:27], v[64:67]
v_mfma_f32_16x16x32_bf16 v[52:55], a[184:187], v[28:31], v[52:55]
v_mfma_f32_16x16x32_bf16 v[56:59], a[188:191], v[28:31], v[56:59]
v_mfma_f32_16x16x32_bf16 v[60:63], a[184:187], v[32:35], v[60:63]
v_mfma_f32_16x16x32_bf16 v[64:67], a[188:191], v[32:35], v[64:67]
v_mfma_f32_16x16x32_bf16 v[68:71], a[176:179], v[36:39], v[68:71]
v_mfma_f32_16x16x32_bf16 v[72:75], a[180:183], v[36:39], v[72:75]
v_mfma_f32_16x16x32_bf16 v[76:79], a[176:179], v[40:43], v[76:79]
v_mfma_f32_16x16x32_bf16 v[80:83], a[180:183], v[40:43], v[80:83]
v_mfma_f32_16x16x32_bf16 v[68:71], a[184:187], v[44:47], v[68:71]
v_mfma_f32_16x16x32_bf16 v[72:75], a[188:191], v[44:47], v[72:75]
v_mfma_f32_16x16x32_bf16 v[76:79], a[184:187], v[48:51], v[76:79]
v_mfma_f32_16x16x32_bf16 v[80:83], a[188:191], v[48:51], v[80:83]
s_waitcnt vmcnt(4)
ds_read_b64_tr_b16 a[192:193], v17 offset:0
ds_read_b64_tr_b16 a[194:195], v17 offset:256
ds_read_b64_tr_b16 a[196:197], v17 offset:8
ds_read_b64_tr_b16 a[198:199], v17 offset:264
ds_read_b64_tr_b16 a[200:201], v17 offset:2048
ds_read_b64_tr_b16 a[202:203], v17 offset:2304
ds_read_b64_tr_b16 a[204:205], v17 offset:2056
ds_read_b64_tr_b16 a[206:207], v17 offset:2312
s_waitcnt lgkmcnt(0)
s_mov_b32 s44, 7340032
buffer_load_dword v250, v12, s[4:7], s44 offen
s_add_u32 m0, s45, 0
s_mov_b32 s44, 7340032
buffer_load_dwordx4 v16, s[4:7], s44 offen lds
s_add_u32 m0, s45, 1024
s_mov_b32 s44, 7471104
buffer_load_dwordx4 v16, s[4:7], s44 offen lds
s_add_u32 m0, s45, 2048
s_mov_b32 s44, 7602176
buffer_load_dwordx4 v16, s[4:7], s44 offen lds
s_add_u32 m0, s45, 3072
s_mov_b32 s44, 7733248
buffer_load_dwordx4 v16, s[4:7], s44 offen lds
ds_read_b128 v[20:23], v8 offset:49152
ds_read_b128 v[24:27], v8 offset:51200
ds_read_b128 v[28:31], v9 offset:49152
ds_read_b128 v[32:35], v9 offset:51200
ds_read_b128 v[36:39], v10 offset:49152
ds_read_b128 v[40:43], v10 offset:51200
ds_read_b128 v[44:47], v11 offset:49152
ds_read_b128 v[48:51], v11 offset:51200
s_waitcnt lgkmcnt(0)
v_mfma_f32_16x16x32_bf16 v[52:55], a[192:195], v[20:23], v[52:55]
v_mfma_f32_16x16x32_bf16 v[56:59], a[196:199], v[20:23], v[56:59]
v_mfma_f32_16x16x32_bf16 v[60:63], a[192:195], v[24:27], v[60:63]
v_mfma_f32_16x16x32_bf16 v[64:67], a[196:199], v[24:27], v[64:67]
v_mfma_f32_16x16x32_bf16 v[52:55], a[200:203], v[28:31], v[52:55]
v_mfma_f32_16x16x32_bf16 v[56:59], a[204:207], v[28:31], v[56:59]
v_mfma_f32_16x16x32_bf16 v[60:63], a[200:203], v[32:35], v[60:63]
v_mfma_f32_16x16x32_bf16 v[64:67], a[204:207], v[32:35], v[64:67]
v_mfma_f32_16x16x32_bf16 v[68:71], a[192:195], v[36:39], v[68:71]
v_mfma_f32_16x16x32_bf16 v[72:75], a[196:199], v[36:39], v[72:75]
v_mfma_f32_16x16x32_bf16 v[76:79], a[192:195], v[40:43], v[76:79]
v_mfma_f32_16x16x32_bf16 v[80:83], a[196:199], v[40:43], v[80:83]
v_mfma_f32_16x16x32_bf16 v[68:71], a[200:203], v[44:47], v[68:71]
v_mfma_f32_16x16x32_bf16 v[72:75], a[204:207], v[44:47], v[72:75]
v_mfma_f32_16x16x32_bf16 v[76:79], a[200:203], v[48:51], v[76:79]
v_mfma_f32_16x16x32_bf16 v[80:83], a[204:207], v[48:51], v[80:83]
s_waitcnt vmcnt(5)
ds_read_b64_tr_b16 a[208:209], v17 offset:4096
ds_read_b64_tr_b16 a[210:211], v17 offset:4352
ds_read_b64_tr_b16 a[212:213], v17 offset:4104
ds_read_b64_tr_b16 a[214:215], v17 offset:4360
ds_read_b64_tr_b16 a[216:217], v17 offset:6144
ds_read_b64_tr_b16 a[218:219], v17 offset:6400
ds_read_b64_tr_b16 a[220:221], v17 offset:6152
ds_read_b64_tr_b16 a[222:223], v17 offset:6408
s_waitcnt lgkmcnt(0)
v_and_b32 v247, 15, v0
v_lshlrev_b32 v247, 4, v247
buffer_load_dword v246, v247, s[72:75], 0 offen sc1
s_add_u32 m0, s45, 4096
s_mov_b32 s44, 7864320
buffer_load_dwordx4 v16, s[4:7], s44 offen lds
s_add_u32 m0, s45, 5120
s_mov_b32 s44, 7995392
buffer_load_dwordx4 v16, s[4:7], s44 offen lds
s_add_u32 m0, s45, 6144
s_mov_b32 s44, 8126464
buffer_load_dwordx4 v16, s[4:7], s44 offen lds
s_add_u32 m0, s45, 7168
s_mov_b32 s44, 8257536
buffer_load_dwordx4 v16, s[4:7], s44 offen lds
ds_read_b128 v[20:23], v8 offset:53248
ds_read_b128 v[24:27], v8 offset:55296
ds_read_b128 v[28:31], v9 offset:53248
ds_read_b128 v[32:35], v9 offset:55296
ds_read_b128 v[36:39], v10 offset:53248
ds_read_b128 v[40:43], v10 offset:55296
ds_read_b128 v[44:47], v11 offset:53248
ds_read_b128 v[48:51], v11 offset:55296
s_waitcnt lgkmcnt(0)
v_mfma_f32_16x16x32_bf16 v[52:55], a[208:211], v[20:23], v[52:55]
v_mfma_f32_16x16x32_bf16 v[56:59], a[212:215], v[20:23], v[56:59]
v_mfma_f32_16x16x32_bf16 v[60:63], a[208:211], v[24:27], v[60:63]
v_mfma_f32_16x16x32_bf16 v[64:67], a[212:215], v[24:27], v[64:67]
v_mfma_f32_16x16x32_bf16 v[52:55], a[216:219], v[28:31], v[52:55]
v_mfma_f32_16x16x32_bf16 v[56:59], a[220:223], v[28:31], v[56:59]
v_mfma_f32_16x16x32_bf16 v[60:63], a[216:219], v[32:35], v[60:63]
v_mfma_f32_16x16x32_bf16 v[64:67], a[220:223], v[32:35], v[64:67]
v_mfma_f32_16x16x32_bf16 v[68:71], a[208:211], v[36:39], v[68:71]
v_mfma_f32_16x16x32_bf16 v[72:75], a[212:215], v[36:39], v[72:75]
v_mfma_f32_16x16x32_bf16 v[76:79], a[208:211], v[40:43], v[76:79]
v_mfma_f32_16x16x32_bf16 v[80:83], a[212:215], v[40:43], v[80:83]
v_mfma_f32_16x16x32_bf16 v[68:71], a[216:219], v[44:47], v[68:71]
v_mfma_f32_16x16x32_bf16 v[72:75], a[220:223], v[44:47], v[72:75]
v_mfma_f32_16x16x32_bf16 v[76:79], a[216:219], v[48:51], v[76:79]
v_mfma_f32_16x16x32_bf16 v[80:83], a[220:223], v[48:51], v[80:83]
s_waitcnt vmcnt(4)
ds_read_b64_tr_b16 a[224:225], v17 offset:0
ds_read_b64_tr_b16 a[226:227], v17 offset:256
ds_read_b64_tr_b16 a[228:229], v17 offset:8
ds_read_b64_tr_b16 a[230:231], v17 offset:264
ds_read_b64_tr_b16 a[232:233], v17 offset:2048
ds_read_b64_tr_b16 a[234:235], v17 offset:2304
ds_read_b64_tr_b16 a[236:237], v17 offset:2056
ds_read_b64_tr_b16 a[238:239], v17 offset:2312
s_waitcnt lgkmcnt(0)
ds_read_b128 v[20:23], v8 offset:57344
ds_read_b128 v[24:27], v8 offset:59392
ds_read_b128 v[28:31], v9 offset:57344
ds_read_b128 v[32:35], v9 offset:59392
ds_read_b128 v[36:39], v10 offset:57344
ds_read_b128 v[40:43], v10 offset:59392
ds_read_b128 v[44:47], v11 offset:57344
ds_read_b128 v[48:51], v11 offset:59392
s_waitcnt lgkmcnt(0)
v_mfma_f32_16x16x32_bf16 v[52:55], a[224:227], v[20:23], v[52:55]
v_mfma_f32_16x16x32_bf16 v[56:59], a[228:231], v[20:23], v[56:59]
v_mfma_f32_16x16x32_bf16 v[60:63], a[224:227], v[24:27], v[60:63]
v_mfma_f32_16x16x32_bf16 v[64:67], a[228:231], v[24:27], v[64:67]
v_mfma_f32_16x16x32_bf16 v[52:55], a[232:235], v[28:31], v[52:55]
v_mfma_f32_16x16x32_bf16 v[56:59], a[236:239], v[28:31], v[56:59]
v_mfma_f32_16x16x32_bf16 v[60:63], a[232:235], v[32:35], v[60:63]
v_mfma_f32_16x16x32_bf16 v[64:67], a[236:239], v[32:35], v[64:67]
v_mfma_f32_16x16x32_bf16 v[68:71], a[224:227], v[36:39], v[68:71]
v_mfma_f32_16x16x32_bf16 v[72:75], a[228:231], v[36:39], v[72:75]
v_mfma_f32_16x16x32_bf16 v[76:79], a[224:227], v[40:43], v[76:79]
v_mfma_f32_16x16x32_bf16 v[80:83], a[228:231], v[40:43], v[80:83]
v_mfma_f32_16x16x32_bf16 v[68:71], a[232:235], v[44:47], v[68:71]
v_mfma_f32_16x16x32_bf16 v[72:75], a[236:239], v[44:47], v[72:75]
v_mfma_f32_16x16x32_bf16 v[76:79], a[232:235], v[48:51], v[76:79]
v_mfma_f32_16x16x32_bf16 v[80:83], a[236:239], v[48:51], v[80:83]
s_waitcnt vmcnt(0)
ds_read_b64_tr_b16 a[240:241], v17 offset:4096
ds_read_b64_tr_b16 a[242:243], v17 offset:4352
ds_read_b64_tr_b16 a[244:245], v17 offset:4104
ds_read_b64_tr_b16 a[246:247], v17 offset:4360
ds_read_b64_tr_b16 a[248:249], v17 offset:6144
ds_read_b64_tr_b16 a[250:251], v17 offset:6400
ds_read_b64_tr_b16 a[252:253], v17 offset:6152
ds_read_b64_tr_b16 a[254:255], v17 offset:6408
s_waitcnt lgkmcnt(0)
ds_read_b128 v[20:23], v8 offset:61440
ds_read_b128 v[24:27], v8 offset:63488
ds_read_b128 v[28:31], v9 offset:61440
ds_read_b128 v[32:35], v9 offset:63488
ds_read_b128 v[36:39], v10 offset:61440
ds_read_b128 v[40:43], v10 offset:63488
ds_read_b128 v[44:47], v11 offset:61440
ds_read_b128 v[48:51], v11 offset:63488
s_waitcnt lgkmcnt(0)
v_mfma_f32_16x16x32_bf16 v[52:55], a[240:243], v[20:23], v[52:55]
v_mfma_f32_16x16x32_bf16 v[56:59], a[244:247], v[20:23], v[56:59]
v_mfma_f32_16x16x32_bf16 v[60:63], a[240:243], v[24:27], v[60:63]
v_mfma_f32_16x16x32_bf16 v[64:67], a[244:247], v[24:27], v[64:67]
v_mfma_f32_16x16x32_bf16 v[52:55], a[248:251], v[28:31], v[52:55]
v_mfma_f32_16x16x32_bf16 v[56:59], a[252:255], v[28:31], v[56:59]
v_mfma_f32_16x16x32_bf16 v[60:63], a[248:251], v[32:35], v[60:63]
v_mfma_f32_16x16x32_bf16 v[64:67], a[252:255], v[32:35], v[64:67]
v_mfma_f32_16x16x32_bf16 v[68:71], a[240:243], v[36:39], v[68:71]
v_mfma_f32_16x16x32_bf16 v[72:75], a[244:247], v[36:39], v[72:75]
v_mfma_f32_16x16x32_bf16 v[76:79], a[240:243], v[40:43], v[76:79]
v_mfma_f32_16x16x32_bf16 v[80:83], a[244:247], v[40:43], v[80:83]
v_mfma_f32_16x16x32_bf16 v[68:71], a[248:251], v[44:47], v[68:71]
v_mfma_f32_16x16x32_bf16 v[72:75], a[252:255], v[44:47], v[72:75]
v_mfma_f32_16x16x32_bf16 v[76:79], a[248:251], v[48:51], v[76:79]
v_mfma_f32_16x16x32_bf16 v[80:83], a[252:255], v[48:51], v[80:83]
s_and_b32 s53, s47, 31
s_lshl_b32 s53, s53, 4
v_add_u32 v19, s53, v1
v_lshlrev_b32 v19, 7, v19
s_mov_b32 s42, 1
v_and_b32 v247, 15, v0
v_lshlrev_b32 v247, 4, v247
s_branch mega_kernel_sykp
mega_kernel_sykw:
s_sleep 4
mega_kernel_syk:
buffer_load_dword v246, v247, s[72:75], 0 offen sc1
s_waitcnt vmcnt(0)
mega_kernel_sykp:
s_cmp_eq_u32 s95, 1
s_cbranch_scc0 mega_kernel_sykf
v_readlane_b32 s76, v246, 14
s_mov_b32 s98, 0
s_cmp_eq_u32 s76, 64
s_cbranch_scc0 mega_kernel_sykw
s_branch mega_kernel_sykd
mega_kernel_sykf:
s_mov_b32 s77, 0
s_mov_b32 s78, 0
v_readlane_b32 s76, v246, 0
s_add_u32 s77, s77, s76
s_xor_b32 s76, s76, 32
s_or_b32 s78, s78, s76
v_readlane_b32 s76, v246, 1
s_add_u32 s77, s77, s76
s_xor_b32 s76, s76, 32
s_or_b32 s78, s78, s76
v_readlane_b32 s76, v246, 2
s_add_u32 s77, s77, s76
s_xor_b32 s76, s76, 32
s_or_b32 s78, s78, s76
v_readlane_b32 s76, v246, 3
s_add_u32 s77, s77, s76
s_xor_b32 s76, s76, 32
s_or_b32 s78, s78, s76
v_readlane_b32 s76, v246, 4
s_add_u32 s77, s77, s76
s_xor_b32 s76, s76, 32
s_or_b32 s78, s78, s76
v_readlane_b32 s76, v246, 5
s_add_u32 s77, s77, s76
s_xor_b32 s76, s76, 32
s_or_b32 s78, s78, s76
v_readlane_b32 s76, v246, 6
s_add_u32 s77, s77, s76
s_xor_b32 s76, s76, 32
s_or_b32 s78, s78, s76
v_readlane_b32 s76, v246, 7
s_add_u32 s77, s77, s76
s_xor_b32 s76, s76, 32
s_or_b32 s78, s78, s76
s_cmp_eq_u32 s77, 256
s_cbranch_scc0 mega_kernel_sykw
v_mov_b32 v252, v246
s_cmp_eq_u32 s78, 0
s_cbranch_scc0 mega_kernel_slowent
v_readlane_b32 s76, v246, 10
v_readlane_b32 s77, v246, 8
s_cmp_eq_u32 s76, 64
s_cbranch_scc0 mega_kernel_sykw
s_cmp_gt_u32 s77, 32
s_cselect_b32 s98, 1, 0
mega_kernel_sykd:
s_lshr_b32 s44, s47, 3
s_xor_b32 s44, s44, s98
s_and_b32 s44, s44, 1
s_lshl_b32 s44, s44, 13
s_lshl_b32 s48, s47, 18
s_add_u32 s48, s48, s44
s_add_u32 s48, s48, 0
s_xor_b32 s44, s98, 1
s_lshl_b32 s44, s44, 13
s_lshl_b32 s49, s40, 7
s_add_u32 s49, s49, s44
s_lshl_b32 s44, s41, 2
s_add_u32 s49, s49, s44
s_add_u32 s49, s49, 69206016
v_mov_b32 v16, 0
v_cvt_pk_bf16_f32 v84, v52, v53
v_cvt_pk_bf16_f32 v85, v54, v55
v_cvt_pk_bf16_f32 v86, v56, v57
v_cvt_pk_bf16_f32 v87, v58, v59
v_cvt_pk_bf16_f32 v88, v60, v61
v_cvt_pk_bf16_f32 v89, v62, v63
v_cvt_pk_bf16_f32 v90, v64, v65
v_cvt_pk_bf16_f32 v91, v66, v67
s_add_u32 s51, s42, s47
s_sub_u32 s51, s51, 1
s_bfe_u32 s52, s51, 0x40002
s_lshl_b32 s52, s52, 14
s_and_b32 s51, s51, 3
s_lshl_b32 s51, s51, 11
s_add_u32 s51, s51, s52
s_add_u32 s51, s51, s48
buffer_store_dwordx4 v[84:87], v7, s[84:87], s51 offen sc1
buffer_store_dwordx4 v[88:91], v7, s[84:87], s51 offen offset:1024 sc1
s_mov_b32 s42, 2
s_nop 1
v_cvt_pk_bf16_f32 v84, v68, v69
v_cvt_pk_bf16_f32 v85, v70, v71
v_cvt_pk_bf16_f32 v86, v72, v73
v_cvt_pk_bf16_f32 v87, v74, v75
v_cvt_pk_bf16_f32 v88, v76, v77
v_cvt_pk_bf16_f32 v89, v78, v79
v_cvt_pk_bf16_f32 v90, v80, v81
v_cvt_pk_bf16_f32 v91, v82, v83
s_add_u32 s51, s42, s47
s_sub_u32 s51, s51, 1
s_bfe_u32 s52, s51, 0x40002
s_lshl_b32 s52, s52, 14
s_and_b32 s51, s51, 3
s_lshl_b32 s51, s51, 11
s_add_u32 s51, s51, s52
s_add_u32 s51, s51, s48
buffer_store_dwordx4 v[84:87], v7, s[84:87], s51 offen sc1
buffer_store_dwordx4 v[88:91], v7, s[84:87], s51 offen offset:1024 sc1
s_barrier
s_mov_b32 s50, 0x20000
s_add_u32 m0, s46, 0
s_nop 0
buffer_load_dwordx4 v6, s[8:11], s50 offen offset:0 lds
s_add_u32 m0, s46, 3968
s_nop 0
buffer_load_dwordx4 v6, s[8:11], s50 offen offset:128 lds
s_add_u32 m0, s46, 7936
s_nop 0
buffer_load_dwordx4 v6, s[8:11], s50 offen offset:256 lds
s_add_u32 m0, s46, 11904
s_nop 0
buffer_load_dwordx4 v6, s[8:11], s50 offen offset:384 lds
s_add_u32 m0, s46, 15872
s_nop 0
buffer_load_dwordx4 v6, s[8:11], s50 offen offset:512 lds
s_add_u32 m0, s46, 19840
s_nop 0
buffer_load_dwordx4 v6, s[8:11], s50 offen offset:640 lds
s_add_u32 m0, s46, 23808
s_nop 0
buffer_load_dwordx4 v6, s[8:11], s50 offen offset:768 lds
s_add_u32 m0, s46, 27776
s_nop 0
buffer_load_dwordx4 v6, s[8:11], s50 offen offset:896 lds
s_add_u32 m0, s46, 31744
s_nop 0
buffer_load_dwordx4 v6, s[8:11], s50 offen offset:1024 lds
s_add_u32 m0, s46, 35712
s_nop 0
buffer_load_dwordx4 v6, s[8:11], s50 offen offset:1152 lds
s_add_u32 m0, s46, 39680
s_nop 0
buffer_load_dwordx4 v6, s[8:11], s50 offen offset:1280 lds
s_add_u32 m0, s46, 43648
s_nop 0
buffer_load_dwordx4 v6, s[8:11], s50 offen offset:1408 lds
s_add_u32 m0, s46, 47616
s_nop 0
buffer_load_dwordx4 v6, s[8:11], s50 offen offset:1536 lds
s_add_u32 m0, s46, 51584
s_nop 0
buffer_load_dwordx4 v6, s[8:11], s50 offen offset:1664 lds
s_add_u32 m0, s46, 55552
s_nop 0
buffer_load_dwordx4 v6, s[8:11], s50 offen offset:1792 lds
s_add_u32 m0, s46, 59520
s_nop 0
buffer_load_dwordx4 v6, s[8:11], s50 offen offset:1920 lds
s_waitcnt vmcnt(16)
v_mov_b32 v17, s42
s_mov_b64 exec, 1
buffer_store_dword v17, v16, s[84:87], s49 offen sc1
s_mov_b64 exec, -1
s_waitcnt vmcnt(1)
s_branch mega_kernel_k_mid
mega_kernel_k_loop:
s_waitcnt vmcnt(2)
s_barrier
s_add_u32 s50, s42, 1
s_min_u32 s50, s50, 63
s_lshl_b32 s50, s50, 16
ds_read_b128 v[20:23], v10 offset:0
ds_read_b128 v[24:27], v10 offset:2048
ds_read_b128 v[28:31], v11 offset:0
ds_read_b128 v[32:35], v11 offset:2048
ds_read_b128 v[36:39], v10 offset:4096
ds_read_b128 v[40:43], v10 offset:6144
s_waitcnt lgkmcnt(4)
v_mfma_f32_16x16x32_bf16 v[68:71], a[0:3], v[20:23], 0
ds_read_b128 v[44:47], v11 offset:4096
v_mfma_f32_16x16x32_bf16 v[72:75], a[4:7], v[20:23], 0
v_cvt_pk_bf16_f32 v84, v52, v53
v_cvt_pk_bf16_f32 v85, v54, v55
v_cvt_pk_bf16_f32 v86, v56, v57
v_mfma_f32_16x16x32_bf16 v[76:79], a[0:3], v[24:27], 0
ds_read_b128 v[48:51], v11 offset:6144
v_mfma_f32_16x16x32_bf16 v[80:83], a[4:7], v[24:27], 0
v_cvt_pk_bf16_f32 v87, v58, v59
v_cvt_pk_bf16_f32 v88, v60, v61
v_cvt_pk_bf16_f32 v89, v62, v63
s_waitcnt lgkmcnt(4)
v_mfma_f32_16x16x32_bf16 v[68:71], a[8:11], v[28:31], v[68:71]
ds_read_b128 v[20:23], v10 offset:8192
v_mfma_f32_16x16x32_bf16 v[72:75], a[12:15], v[28:31], v[72:75]
v_cvt_pk_bf16_f32 v90, v64, v65
v_cvt_pk_bf16_f32 v91, v66, v67
v_mfma_f32_16x16x32_bf16 v[76:79], a[8:11], v[32:35], v[76:79]
ds_read_b128 v[24:27], v10 offset:10240
v_mfma_f32_16x16x32_bf16 v[80:83], a[12:15], v[32:35], v[80:83]
s_add_u32 s51, s42, s47
s_sub_u32 s51, s51, 1
s_bfe_u32 s52, s51, 0x40002
s_lshl_b32 s52, s52, 14
s_waitcnt lgkmcnt(4)
v_mfma_f32_16x16x32_bf16 v[68:71], a[16:19], v[36:39], v[68:71]
ds_read_b128 v[28:31], v11 offset:8192
v_mfma_f32_16x16x32_bf16 v[72:75], a[20:23], v[36:39], v[72:75]
s_and_b32 s51, s51, 3
s_lshl_b32 s51, s51, 11
s_add_u32 s51, s51, s52
s_add_u32 s51, s51, s48
buffer_store_dwordx4 v[84:87], v7, s[84:87], s51 offen sc1
v_mfma_f32_16x16x32_bf16 v[76:79], a[16:19], v[40:43], v[76:79]
ds_read_b128 v[32:35], v11 offset:10240
v_mfma_f32_16x16x32_bf16 v[80:83], a[20:23], v[40:43], v[80:83]
buffer_store_dwordx4 v[88:91], v7, s[84:87], s51 offen offset:1024 sc1
s_waitcnt lgkmcnt(4)
v_mfma_f32_16x16x32_bf16 v[68:71], a[24:27], v[44:47], v[68:71]
ds_read_b128 v[36:39], v10 offset:12288
v_mfma_f32_16x16x32_bf16 v[72:75], a[28:31], v[44:47], v[72:75]
s_add_u32 m0, s46, 0
v_mfma_f32_16x16x32_bf16 v[76:79], a[24:27], v[48:51], v[76:79]
ds_read_b128 v[40:43], v10 offset:14336
v_mfma_f32_16x16x32_bf16 v[80:83], a[28:31], v[48:51], v[80:83]
buffer_load_dwordx4 v6, s[8:11], s50 offen offset:0 lds
s_waitcnt lgkmcnt(4)
v_mfma_f32_16x16x32_bf16 v[68:71], a[32:35], v[20:23], v[68:71]
ds_read_b128 v[44:47], v11 offset:12288
v_mfma_f32_16x16x32_bf16 v[72:75], a[36:39], v[20:23], v[72:75]
s_add_u32 m0, s46, 3968
v_mfma_f32_16x16x32_bf16 v[76:79], a[32:35], v[24:27], v[76:79]
ds_read_b128 v[48:51], v11 offset:14336
v_mfma_f32_16x16x32_bf16 v[80:83], a[36:39], v[24:27], v[80:83]
buffer_load_dwordx4 v6, s[8:11], s50 offen offset:128 lds
s_waitcnt lgkmcnt(4)
v_mfma_f32_16x16x32_bf16 v[68:71], a[40:43], v[28:31], v[68:71]
ds_read_b128 v[20:23], v10 offset:16384
v_mfma_f32_16x16x32_bf16 v[72:75], a[44:47], v[28:31], v[72:75]
s_add_u32 m0, s46, 7936
v_mfma_f32_16x16x32_bf16 v[76:79], a[40:43], v[32:35], v[76:79]
ds_read_b128 v[24:27], v10 offset:18432
v_mfma_f32_16x16x32_bf16 v[80:83], a[44:47], v[32:35], v[80:83]
buffer_load_dwordx4 v6, s[8:11], s50 offen offset:256 lds
s_waitcnt lgkmcnt(4)
v_mfma_f32_16x16x32_bf16 v[68:71], a[48:51], v[36:39], v[68:71]
ds_read_b128 v[28:31], v11 offset:16384
v_mfma_f32_16x16x32_bf16 v[72:75], a[52:55], v[36:39], v[72:75]
s_add_u32 m0, s46, 11904
v_mfma_f32_16x16x32_bf16 v[76:79], a[48:51], v[40:43], v[76:79]
ds_read_b128 v[32:35], v11 offset:18432
v_mfma_f32_16x16x32_bf16 v[80:83], a[52:55], v[40:43], v[80:83]
buffer_load_dwordx4 v6, s[8:11], s50 offen offset:384 lds
s_waitcnt lgkmcnt(4)
v_mfma_f32_16x16x32_bf16 v[68:71], a[56:59], v[44:47], v[68:71]
ds_read_b128 v[36:39], v10 offset:20480
v_mfma_f32_16x16x32_bf16 v[72:75], a[60:63], v[44:47], v[72:75]
s_add_u32 m0, s46, 15872
v_mfma_f32_16x16x32_bf16 v[76:79], a[56:59], v[48:51], v[76:79]
ds_read_b128 v[40:43], v10 offset:22528
v_mfma_f32_16x16x32_bf16 v[80:83], a[60:63], v[48:51], v[80:83]
buffer_load_dwordx4 v6, s[8:11], s50 offen offset:512 lds
s_waitcnt lgkmcnt(4)
v_mfma_f32_16x16x32_bf16 v[68:71], a[64:67], v[20:23], v[68:71]
ds_read_b128 v[44:47], v11 offset:20480
v_mfma_f32_16x16x32_bf16 v[72:75], a[68:71], v[20:23], v[72:75]
s_add_u32 m0, s46, 19840
v_mfma_f32_16x16x32_bf16 v[76:79], a[64:67], v[24:27], v[76:79]
ds_read_b128 v[48:51], v11 offset:22528
v_mfma_f32_16x16x32_bf16 v[80:83], a[68:71], v[24:27], v[80:83]
buffer_load_dwordx4 v6, s[8:11], s50 offen offset:640 lds
s_waitcnt lgkmcnt(4)
v_mfma_f32_16x16x32_bf16 v[68:71], a[72:75], v[28:31], v[68:71]
ds_read_b128 v[20:23], v10 offset:24576
v_mfma_f32_16x16x32_bf16 v[72:75], a[76:79], v[28:31], v[72:75]
s_add_u32 m0, s46, 23808
v_mfma_f32_16x16x32_bf16 v[76:79], a[72:75], v[32:35], v[76:79]
ds_read_b128 v[24:27], v10 offset:26624
v_mfma_f32_16x16x32_bf16 v[80:83], a[76:79], v[32:35], v[80:83]
buffer_load_dwordx4 v6, s[8:11], s50 offen offset:768 lds
s_waitcnt lgkmcnt(4)
v_mfma_f32_16x16x32_bf16 v[68:71], a[80:83], v[36:39], v[68:71]
ds_read_b128 v[28:31], v11 offset:24576
v_mfma_f32_16x16x32_bf16 v[72:75], a[84:87], v[36:39], v[72:75]
s_add_u32 m0, s46, 27776
v_mfma_f32_16x16x32_bf16 v[76:79], a[80:83], v[40:43], v[76:79]
ds_read_b128 v[32:35], v11 offset:26624
v_mfma_f32_16x16x32_bf16 v[80:83], a[84:87], v[40:43], v[80:83]
buffer_load_dwordx4 v6, s[8:11], s50 offen offset:896 lds
s_waitcnt lgkmcnt(4)
v_mfma_f32_16x16x32_bf16 v[68:71], a[88:91], v[44:47], v[68:71]
ds_read_b128 v[36:39], v10 offset:28672
v_mfma_f32_16x16x32_bf16 v[72:75], a[92:95], v[44:47], v[72:75]
s_add_u32 m0, s46, 31744
v_mfma_f32_16x16x32_bf16 v[76:79], a[88:91], v[48:51], v[76:79]
ds_read_b128 v[40:43], v10 offset:30720
v_mfma_f32_16x16x32_bf16 v[80:83], a[92:95], v[48:51], v[80:83]
buffer_load_dwordx4 v6, s[8:11], s50 offen offset:1024 lds
s_waitcnt lgkmcnt(4)
v_mfma_f32_16x16x32_bf16 v[68:71], a[96:99], v[20:23], v[68:71]
ds_read_b128 v[44:47], v11 offset:28672
v_mfma_f32_16x16x32_bf16 v[72:75], a[100:103], v[20:23], v[72:75]
s_add_u32 m0, s46, 35712
v_mfma_f32_16x16x32_bf16 v[76:79], a[96:99], v[24:27], v[76:79]
ds_read_b128 v[48:51], v11 offset:30720
v_mfma_f32_16x16x32_bf16 v[80:83], a[100:103], v[24:27], v[80:83]
buffer_load_dwordx4 v6, s[8:11], s50 offen offset:1152 lds
s_waitcnt lgkmcnt(4)
v_mfma_f32_16x16x32_bf16 v[68:71], a[104:107], v[28:31], v[68:71]
ds_read_b128 v[20:23], v10 offset:32768
v_mfma_f32_16x16x32_bf16 v[72:75], a[108:111], v[28:31], v[72:75]
s_add_u32 m0, s46, 39680
v_mfma_f32_16x16x32_bf16 v[76:79], a[104:107], v[32:35], v[76:79]
ds_read_b128 v[24:27], v10 offset:34816
v_mfma_f32_16x16x32_bf16 v[80:83], a[108:111], v[32:35], v[80:83]
buffer_load_dwordx4 v6, s[8:11], s50 offen offset:1280 lds
s_waitcnt lgkmcnt(4)
v_mfma_f32_16x16x32_bf16 v[68:71], a[112:115], v[36:39], v[68:71]
ds_read_b128 v[28:31], v11 offset:32768
v_mfma_f32_16x16x32_bf16 v[72:75], a[116:119], v[36:39], v[72:75]
s_add_u32 m0, s46, 43648
v_mfma_f32_16x16x32_bf16 v[76:79], a[112:115], v[40:43], v[76:79]
ds_read_b128 v[32:35], v11 offset:34816
v_mfma_f32_16x16x32_bf16 v[80:83], a[116:119], v[40:43], v[80:83]
buffer_load_dwordx4 v6, s[8:11], s50 offen offset:1408 lds
s_waitcnt lgkmcnt(4)
v_mfma_f32_16x16x32_bf16 v[68:71], a[120:123], v[44:47], v[68:71]
ds_read_b128 v[36:39], v10 offset:36864
v_mfma_f32_16x16x32_bf16 v[72:75], a[124:127], v[44:47], v[72:75]
s_add_u32 m0, s46, 47616
v_mfma_f32_16x16x32_bf16 v[76:79], a[120:123], v[48:51], v[76:79]
ds_read_b128 v[40:43], v10 offset:38912
v_mfma_f32_16x16x32_bf16 v[80:83], a[124:127], v[48:51], v[80:83]
buffer_load_dwordx4 v6, s[8:11], s50 offen offset:1536 lds
s_waitcnt lgkmcnt(4)
v_mfma_f32_16x16x32_bf16 v[68:71], a[128:131], v[20:23], v[68:71]
ds_read_b128 v[44:47], v11 offset:36864
v_mfma_f32_16x16x32_bf16 v[72:75], a[132:135], v[20:23], v[72:75]
s_add_u32 m0, s46, 51584
v_mfma_f32_16x16x32_bf16 v[76:79], a[128:131], v[24:27], v[76:79]
ds_read_b128 v[48:51], v11 offset:38912
v_mfma_f32_16x16x32_bf16 v[80:83], a[132:135], v[24:27], v[80:83]
buffer_load_dwordx4 v6, s[8:11], s50 offen offset:1664 lds
s_waitcnt lgkmcnt(4)
v_mfma_f32_16x16x32_bf16 v[68:71], a[136:139], v[28:31], v[68:71]
ds_read_b128 v[20:23], v10 offset:40960
v_mfma_f32_16x16x32_bf16 v[72:75], a[140:143], v[28:31], v[72:75]
s_add_u32 m0, s46, 55552
v_mfma_f32_16x16x32_bf16 v[76:79], a[136:139], v[32:35], v[76:79]
ds_read_b128 v[24:27], v10 offset:43008
v_mfma_f32_16x16x32_bf16 v[80:83], a[140:143], v[32:35], v[80:83]
buffer_load_dwordx4 v6, s[8:11], s50 offen offset:1792 lds
s_waitcnt lgkmcnt(4)
v_mfma_f32_16x16x32_bf16 v[68:71], a[144:147], v[36:39], v[68:71]
ds_read_b128 v[28:31], v11 offset:40960
v_mfma_f32_16x16x32_bf16 v[72:75], a[148:151], v[36:39], v[72:75]
s_add_u32 m0, s46, 59520
v_mfma_f32_16x16x32_bf16 v[76:79], a[144:147], v[40:43], v[76:79]
ds_read_b128 v[32:35], v11 offset:43008
v_mfma_f32_16x16x32_bf16 v[80:83], a[148:151], v[40:43], v[80:83]
buffer_load_dwordx4 v6, s[8:11], s50 offen offset:1920 lds
s_waitcnt lgkmcnt(4)
v_mfma_f32_16x16x32_bf16 v[68:71], a[152:155], v[44:47], v[68:71]
ds_read_b128 v[36:39], v10 offset:45056
v_mfma_f32_16x16x32_bf16 v[72:75], a[156:159], v[44:47], v[72:75]
v_mfma_f32_16x16x32_bf16 v[76:79], a[152:155], v[48:51], v[76:79]
ds_read_b128 v[40:43], v10 offset:47104
v_mfma_f32_16x16x32_bf16 v[80:83], a[156:159], v[48:51], v[80:83]
s_waitcnt lgkmcnt(4)
v_mfma_f32_16x16x32_bf16 v[68:71], a[160:163], v[20:23], v[68:71]
ds_read_b128 v[44:47], v11 offset:45056
v_mfma_f32_16x16x32_bf16 v[72:75], a[164:167], v[20:23], v[72:75]
v_mfma_f32_16x16x32_bf16 v[76:79], a[160:163], v[24:27], v[76:79]
ds_read_b128 v[48:51], v11 offset:47104
v_mfma_f32_16x16x32_bf16 v[80:83], a[164:167], v[24:27], v[80:83]
s_waitcnt lgkmcnt(4)
v_mfma_f32_16x16x32_bf16 v[68:71], a[168:171], v[28:31], v[68:71]
ds_read_b128 v[20:23], v10 offset:49152
v_mfma_f32_16x16x32_bf16 v[72:75], a[172:175], v[28:31], v[72:75]
s_waitcnt vmcnt(16)
v_mov_b32 v17, s42
s_mov_b64 exec, 1
buffer_store_dword v17, v16, s[84:87], s49 offen sc1
s_mov_b64 exec, -1
v_mfma_f32_16x16x32_bf16 v[76:79], a[168:171], v[32:35], v[76:79]
ds_read_b128 v[24:27], v10 offset:51200
v_mfma_f32_16x16x32_bf16 v[80:83], a[172:175], v[32:35], v[80:83]
s_waitcnt lgkmcnt(4)
v_mfma_f32_16x16x32_bf16 v[68:71], a[176:179], v[36:39], v[68:71]
ds_read_b128 v[28:31], v11 offset:49152
v_mfma_f32_16x16x32_bf16 v[72:75], a[180:183], v[36:39], v[72:75]
s_add_u32 s53, s42, 3
s_min_u32 s53, s53, 63
s_lshl_b32 s53, s53, 16
s_mov_b64 exec, 0xffff
buffer_load_dword v250, v19, s[8:11], s53 offen
s_mov_b64 exec, -1
v_mfma_f32_16x16x32_bf16 v[76:79], a[176:179], v[40:43], v[76:79]
ds_read_b128 v[32:35], v11 offset:51200
v_mfma_f32_16x16x32_bf16 v[80:83], a[180:183], v[40:43], v[80:83]
s_waitcnt lgkmcnt(4)
v_mfma_f32_16x16x32_bf16 v[68:71], a[184:187], v[44:47], v[68:71]
ds_read_b128 v[36:39], v10 offset:53248
v_mfma_f32_16x16x32_bf16 v[72:75], a[188:191], v[44:47], v[72:75]
v_mfma_f32_16x16x32_bf16 v[76:79], a[184:187], v[48:51], v[76:79]
ds_read_b128 v[40:43], v10 offset:55296
v_mfma_f32_16x16x32_bf16 v[80:83], a[188:191], v[48:51], v[80:83]
s_waitcnt lgkmcnt(4)
v_mfma_f32_16x16x32_bf16 v[68:71], a[192:195], v[20:23], v[68:71]
ds_read_b128 v[44:47], v11 offset:53248
v_mfma_f32_16x16x32_bf16 v[72:75], a[196:199], v[20:23], v[72:75]
v_mfma_f32_16x16x32_bf16 v[76:79], a[192:195], v[24:27], v[76:79]
ds_read_b128 v[48:51], v11 offset:55296
v_mfma_f32_16x16x32_bf16 v[80:83], a[196:199], v[24:27], v[80:83]
s_waitcnt lgkmcnt(4)
v_mfma_f32_16x16x32_bf16 v[68:71], a[200:203], v[28:31], v[68:71]
ds_read_b128 v[20:23], v10 offset:57344
v_mfma_f32_16x16x32_bf16 v[72:75], a[204:207], v[28:31], v[72:75]
v_mfma_f32_16x16x32_bf16 v[76:79], a[200:203], v[32:35], v[76:79]
ds_read_b128 v[24:27], v10 offset:59392
v_mfma_f32_16x16x32_bf16 v[80:83], a[204:207], v[32:35], v[80:83]
s_waitcnt lgkmcnt(4)
v_mfma_f32_16x16x32_bf16 v[68:71], a[208:211], v[36:39], v[68:71]
ds_read_b128 v[28:31], v11 offset:57344
v_mfma_f32_16x16x32_bf16 v[72:75], a[212:215], v[36:39], v[72:75]
v_mfma_f32_16x16x32_bf16 v[76:79], a[208:211], v[40:43], v[76:79]
ds_read_b128 v[32:35], v11 offset:59392
v_mfma_f32_16x16x32_bf16 v[80:83], a[212:215], v[40:43], v[80:83]
s_waitcnt lgkmcnt(4)
v_mfma_f32_16x16x32_bf16 v[68:71], a[216:219], v[44:47], v[68:71]
ds_read_b128 v[36:39], v10 offset:61440
v_mfma_f32_16x16x32_bf16 v[72:75], a[220:223], v[44:47], v[72:75]
v_mfma_f32_16x16x32_bf16 v[76:79], a[216:219], v[48:51], v[76:79]
ds_read_b128 v[40:43], v10 offset:63488
v_mfma_f32_16x16x32_bf16 v[80:83], a[220:223], v[48:51], v[80:83]
s_waitcnt lgkmcnt(4)
v_mfma_f32_16x16x32_bf16 v[68:71], a[224:227], v[20:23], v[68:71]
ds_read_b128 v[44:47], v11 offset:61440
v_mfma_f32_16x16x32_bf16 v[72:75], a[228:231], v[20:23], v[72:75]
v_mfma_f32_16x16x32_bf16 v[76:79], a[224:227], v[24:27], v[76:79]
ds_read_b128 v[48:51], v11 offset:63488
v_mfma_f32_16x16x32_bf16 v[80:83], a[228:231], v[24:27], v[80:83]
s_waitcnt lgkmcnt(5)
v_mfma_f32_16x16x32_bf16 v[68:71], a[232:235], v[28:31], v[68:71]
v_mfma_f32_16x16x32_bf16 v[72:75], a[236:239], v[28:31], v[72:75]
s_waitcnt lgkmcnt(4)
v_mfma_f32_16x16x32_bf16 v[76:79], a[232:235], v[32:35], v[76:79]
v_mfma_f32_16x16x32_bf16 v[80:83], a[236:239], v[32:35], v[80:83]
s_waitcnt lgkmcnt(3)
v_mfma_f32_16x16x32_bf16 v[68:71], a[240:243], v[36:39], v[68:71]
v_mfma_f32_16x16x32_bf16 v[72:75], a[244:247], v[36:39], v[72:75]
s_waitcnt lgkmcnt(2)
v_mfma_f32_16x16x32_bf16 v[76:79], a[240:243], v[40:43], v[76:79]
v_mfma_f32_16x16x32_bf16 v[80:83], a[244:247], v[40:43], v[80:83]
s_waitcnt lgkmcnt(1)
v_mfma_f32_16x16x32_bf16 v[68:71], a[248:251], v[44:47], v[68:71]
v_mfma_f32_16x16x32_bf16 v[72:75], a[252:255], v[44:47], v[72:75]
s_waitcnt lgkmcnt(0)
v_mfma_f32_16x16x32_bf16 v[76:79], a[248:251], v[48:51], v[76:79]
v_mfma_f32_16x16x32_bf16 v[80:83], a[252:255], v[48:51], v[80:83]
s_add_u32 s42, s42, 1
s_cmp_eq_u32 s42, 64
s_cbranch_scc1 mega_kernel_k_fin
mega_kernel_k_mid:
s_waitcnt vmcnt(2)
s_barrier
s_add_u32 s50, s42, 1
s_min_u32 s50, s50, 63
s_lshl_b32 s50, s50, 16
ds_read_b128 v[20:23], v8 offset:0
ds_read_b128 v[24:27], v8 offset:2048
ds_read_b128 v[28:31], v9 offset:0
ds_read_b128 v[32:35], v9 offset:2048
ds_read_b128 v[36:39], v8 offset:4096
ds_read_b128 v[40:43], v8 offset:6144
s_waitcnt lgkmcnt(4)
v_mfma_f32_16x16x32_bf16 v[52:55], a[0:3], v[20:23], 0
ds_read_b128 v[44:47], v9 offset:4096
v_mfma_f32_16x16x32_bf16 v[56:59], a[4:7], v[20:23], 0
v_cvt_pk_bf16_f32 v84, v68, v69
v_cvt_pk_bf16_f32 v85, v70, v71
v_cvt_pk_bf16_f32 v86, v72, v73
v_mfma_f32_16x16x32_bf16 v[60:63], a[0:3], v[24:27], 0
ds_read_b128 v[48:51], v9 offset:6144
v_mfma_f32_16x16x32_bf16 v[64:67], a[4:7], v[24:27], 0
v_cvt_pk_bf16_f32 v87, v74, v75
v_cvt_pk_bf16_f32 v88, v76, v77
v_cvt_pk_bf16_f32 v89, v78, v79
s_waitcnt lgkmcnt(4)
v_mfma_f32_16x16x32_bf16 v[52:55], a[8:11], v[28:31], v[52:55]
ds_read_b128 v[20:23], v8 offset:8192
v_mfma_f32_16x16x32_bf16 v[56:59], a[12:15], v[28:31], v[56:59]
v_cvt_pk_bf16_f32 v90, v80, v81
v_cvt_pk_bf16_f32 v91, v82, v83
v_mfma_f32_16x16x32_bf16 v[60:63], a[8:11], v[32:35], v[60:63]
ds_read_b128 v[24:27], v8 offset:10240
v_mfma_f32_16x16x32_bf16 v[64:67], a[12:15], v[32:35], v[64:67]
s_add_u32 s51, s42, s47
s_sub_u32 s51, s51, 1
s_bfe_u32 s52, s51, 0x40002
s_lshl_b32 s52, s52, 14
s_waitcnt lgkmcnt(4)
v_mfma_f32_16x16x32_bf16 v[52:55], a[16:19], v[36:39], v[52:55]
ds_read_b128 v[28:31], v9 offset:8192
v_mfma_f32_16x16x32_bf16 v[56:59], a[20:23], v[36:39], v[56:59]
s_and_b32 s51, s51, 3
s_lshl_b32 s51, s51, 11
s_add_u32 s51, s51, s52
s_add_u32 s51, s51, s48
buffer_store_dwordx4 v[84:87], v7, s[84:87], s51 offen sc1
v_mfma_f32_16x16x32_bf16 v[60:63], a[16:19], v[40:43], v[60:63]
ds_read_b128 v[32:35], v9 offset:10240
v_mfma_f32_16x16x32_bf16 v[64:67], a[20:23], v[40:43], v[64:67]
buffer_store_dwordx4 v[88:91], v7, s[84:87], s51 offen offset:1024 sc1
s_waitcnt lgkmcnt(4)
v_mfma_f32_16x16x32_bf16 v[52:55], a[24:27], v[44:47], v[52:55]
ds_read_b128 v[36:39], v8 offset:12288
v_mfma_f32_16x16x32_bf16 v[56:59], a[28:31], v[44:47], v[56:59]
s_add_u32 m0, s46, 65536
v_mfma_f32_16x16x32_bf16 v[60:63], a[24:27], v[48:51], v[60:63]
ds_read_b128 v[40:43], v8 offset:14336
v_mfma_f32_16x16x32_bf16 v[64:67], a[28:31], v[48:51], v[64:67]
buffer_load_dwordx4 v6, s[8:11], s50 offen offset:0 lds
s_waitcnt lgkmcnt(4)
v_mfma_f32_16x16x32_bf16 v[52:55], a[32:35], v[20:23], v[52:55]
ds_read_b128 v[44:47], v9 offset:12288
v_mfma_f32_16x16x32_bf16 v[56:59], a[36:39], v[20:23], v[56:59]
s_add_u32 m0, s46, 69504
v_mfma_f32_16x16x32_bf16 v[60:63], a[32:35], v[24:27], v[60:63]
ds_read_b128 v[48:51], v9 offset:14336
v_mfma_f32_16x16x32_bf16 v[64:67], a[36:39], v[24:27], v[64:67]
buffer_load_dwordx4 v6, s[8:11], s50 offen offset:128 lds
s_waitcnt lgkmcnt(4)
v_mfma_f32_16x16x32_bf16 v[52:55], a[40:43], v[28:31], v[52:55]
ds_read_b128 v[20:23], v8 offset:16384
v_mfma_f32_16x16x32_bf16 v[56:59], a[44:47], v[28:31], v[56:59]
s_add_u32 m0, s46, 73472
v_mfma_f32_16x16x32_bf16 v[60:63], a[40:43], v[32:35], v[60:63]
ds_read_b128 v[24:27], v8 offset:18432
v_mfma_f32_16x16x32_bf16 v[64:67], a[44:47], v[32:35], v[64:67]
buffer_load_dwordx4 v6, s[8:11], s50 offen offset:256 lds
s_waitcnt lgkmcnt(4)
v_mfma_f32_16x16x32_bf16 v[52:55], a[48:51], v[36:39], v[52:55]
ds_read_b128 v[28:31], v9 offset:16384
v_mfma_f32_16x16x32_bf16 v[56:59], a[52:55], v[36:39], v[56:59]
s_add_u32 m0, s46, 77440
v_mfma_f32_16x16x32_bf16 v[60:63], a[48:51], v[40:43], v[60:63]
ds_read_b128 v[32:35], v9 offset:18432
v_mfma_f32_16x16x32_bf16 v[64:67], a[52:55], v[40:43], v[64:67]
buffer_load_dwordx4 v6, s[8:11], s50 offen offset:384 lds
s_waitcnt lgkmcnt(4)
v_mfma_f32_16x16x32_bf16 v[52:55], a[56:59], v[44:47], v[52:55]
ds_read_b128 v[36:39], v8 offset:20480
v_mfma_f32_16x16x32_bf16 v[56:59], a[60:63], v[44:47], v[56:59]
s_add_u32 m0, s46, 81408
v_mfma_f32_16x16x32_bf16 v[60:63], a[56:59], v[48:51], v[60:63]
ds_read_b128 v[40:43], v8 offset:22528
v_mfma_f32_16x16x32_bf16 v[64:67], a[60:63], v[48:51], v[64:67]
buffer_load_dwordx4 v6, s[8:11], s50 offen offset:512 lds
s_waitcnt lgkmcnt(4)
v_mfma_f32_16x16x32_bf16 v[52:55], a[64:67], v[20:23], v[52:55]
ds_read_b128 v[44:47], v9 offset:20480
v_mfma_f32_16x16x32_bf16 v[56:59], a[68:71], v[20:23], v[56:59]
s_add_u32 m0, s46, 85376
v_mfma_f32_16x16x32_bf16 v[60:63], a[64:67], v[24:27], v[60:63]
ds_read_b128 v[48:51], v9 offset:22528
v_mfma_f32_16x16x32_bf16 v[64:67], a[68:71], v[24:27], v[64:67]
buffer_load_dwordx4 v6, s[8:11], s50 offen offset:640 lds
s_waitcnt lgkmcnt(4)
v_mfma_f32_16x16x32_bf16 v[52:55], a[72:75], v[28:31], v[52:55]
ds_read_b128 v[20:23], v8 offset:24576
v_mfma_f32_16x16x32_bf16 v[56:59], a[76:79], v[28:31], v[56:59]
s_add_u32 m0, s46, 89344
v_mfma_f32_16x16x32_bf16 v[60:63], a[72:75], v[32:35], v[60:63]
ds_read_b128 v[24:27], v8 offset:26624
v_mfma_f32_16x16x32_bf16 v[64:67], a[76:79], v[32:35], v[64:67]
buffer_load_dwordx4 v6, s[8:11], s50 offen offset:768 lds
s_waitcnt lgkmcnt(4)
v_mfma_f32_16x16x32_bf16 v[52:55], a[80:83], v[36:39], v[52:55]
ds_read_b128 v[28:31], v9 offset:24576
v_mfma_f32_16x16x32_bf16 v[56:59], a[84:87], v[36:39], v[56:59]
s_add_u32 m0, s46, 93312
v_mfma_f32_16x16x32_bf16 v[60:63], a[80:83], v[40:43], v[60:63]
ds_read_b128 v[32:35], v9 offset:26624
v_mfma_f32_16x16x32_bf16 v[64:67], a[84:87], v[40:43], v[64:67]
buffer_load_dwordx4 v6, s[8:11], s50 offen offset:896 lds
s_waitcnt lgkmcnt(4)
v_mfma_f32_16x16x32_bf16 v[52:55], a[88:91], v[44:47], v[52:55]
ds_read_b128 v[36:39], v8 offset:28672
v_mfma_f32_16x16x32_bf16 v[56:59], a[92:95], v[44:47], v[56:59]
s_add_u32 m0, s46, 97280
v_mfma_f32_16x16x32_bf16 v[60:63], a[88:91], v[48:51], v[60:63]
ds_read_b128 v[40:43], v8 offset:30720
v_mfma_f32_16x16x32_bf16 v[64:67], a[92:95], v[48:51], v[64:67]
buffer_load_dwordx4 v6, s[8:11], s50 offen offset:1024 lds
s_waitcnt lgkmcnt(4)
v_mfma_f32_16x16x32_bf16 v[52:55], a[96:99], v[20:23], v[52:55]
ds_read_b128 v[44:47], v9 offset:28672
v_mfma_f32_16x16x32_bf16 v[56:59], a[100:103], v[20:23], v[56:59]
s_add_u32 m0, s46, 101248
v_mfma_f32_16x16x32_bf16 v[60:63], a[96:99], v[24:27], v[60:63]
ds_read_b128 v[48:51], v9 offset:30720
v_mfma_f32_16x16x32_bf16 v[64:67], a[100:103], v[24:27], v[64:67]
buffer_load_dwordx4 v6, s[8:11], s50 offen offset:1152 lds
s_waitcnt lgkmcnt(4)
v_mfma_f32_16x16x32_bf16 v[52:55], a[104:107], v[28:31], v[52:55]
ds_read_b128 v[20:23], v8 offset:32768
v_mfma_f32_16x16x32_bf16 v[56:59], a[108:111], v[28:31], v[56:59]
s_add_u32 m0, s46, 105216
v_mfma_f32_16x16x32_bf16 v[60:63], a[104:107], v[32:35], v[60:63]
ds_read_b128 v[24:27], v8 offset:34816
v_mfma_f32_16x16x32_bf16 v[64:67], a[108:111], v[32:35], v[64:67]
buffer_load_dwordx4 v6, s[8:11], s50 offen offset:1280 lds
s_waitcnt lgkmcnt(4)
v_mfma_f32_16x16x32_bf16 v[52:55], a[112:115], v[36:39], v[52:55]
ds_read_b128 v[28:31], v9 offset:32768
v_mfma_f32_16x16x32_bf16 v[56:59], a[116:119], v[36:39], v[56:59]
s_add_u32 m0, s46, 109184
v_mfma_f32_16x16x32_bf16 v[60:63], a[112:115], v[40:43], v[60:63]
ds_read_b128 v[32:35], v9 offset:34816
v_mfma_f32_16x16x32_bf16 v[64:67], a[116:119], v[40:43], v[64:67]
buffer_load_dwordx4 v6, s[8:11], s50 offen offset:1408 lds
s_waitcnt lgkmcnt(4)
v_mfma_f32_16x16x32_bf16 v[52:55], a[120:123], v[44:47], v[52:55]
ds_read_b128 v[36:39], v8 offset:36864
v_mfma_f32_16x16x32_bf16 v[56:59], a[124:127], v[44:47], v[56:59]
s_add_u32 m0, s46, 113152
v_mfma_f32_16x16x32_bf16 v[60:63], a[120:123], v[48:51], v[60:63]
ds_read_b128 v[40:43], v8 offset:38912
v_mfma_f32_16x16x32_bf16 v[64:67], a[124:127], v[48:51], v[64:67]
buffer_load_dwordx4 v6, s[8:11], s50 offen offset:1536 lds
s_waitcnt lgkmcnt(4)
v_mfma_f32_16x16x32_bf16 v[52:55], a[128:131], v[20:23], v[52:55]
ds_read_b128 v[44:47], v9 offset:36864
v_mfma_f32_16x16x32_bf16 v[56:59], a[132:135], v[20:23], v[56:59]
s_add_u32 m0, s46, 117120
v_mfma_f32_16x16x32_bf16 v[60:63], a[128:131], v[24:27], v[60:63]
ds_read_b128 v[48:51], v9 offset:38912
v_mfma_f32_16x16x32_bf16 v[64:67], a[132:135], v[24:27], v[64:67]
buffer_load_dwordx4 v6, s[8:11], s50 offen offset:1664 lds
s_waitcnt lgkmcnt(4)
v_mfma_f32_16x16x32_bf16 v[52:55], a[136:139], v[28:31], v[52:55]
ds_read_b128 v[20:23], v8 offset:40960
v_mfma_f32_16x16x32_bf16 v[56:59], a[140:143], v[28:31], v[56:59]
s_add_u32 m0, s46, 121088
v_mfma_f32_16x16x32_bf16 v[60:63], a[136:139], v[32:35], v[60:63]
ds_read_b128 v[24:27], v8 offset:43008
v_mfma_f32_16x16x32_bf16 v[64:67], a[140:143], v[32:35], v[64:67]
buffer_load_dwordx4 v6, s[8:11], s50 offen offset:1792 lds
s_waitcnt lgkmcnt(4)
v_mfma_f32_16x16x32_bf16 v[52:55], a[144:147], v[36:39], v[52:55]
ds_read_b128 v[28:31], v9 offset:40960
v_mfma_f32_16x16x32_bf16 v[56:59], a[148:151], v[36:39], v[56:59]
s_add_u32 m0, s46, 125056
v_mfma_f32_16x16x32_bf16 v[60:63], a[144:147], v[40:43], v[60:63]
ds_read_b128 v[32:35], v9 offset:43008
v_mfma_f32_16x16x32_bf16 v[64:67], a[148:151], v[40:43], v[64:67]
buffer_load_dwordx4 v6, s[8:11], s50 offen offset:1920 lds
s_waitcnt lgkmcnt(4)
v_mfma_f32_16x16x32_bf16 v[52:55], a[152:155], v[44:47], v[52:55]
ds_read_b128 v[36:39], v8 offset:45056
v_mfma_f32_16x16x32_bf16 v[56:59], a[156:159], v[44:47], v[56:59]
v_mfma_f32_16x16x32_bf16 v[60:63], a[152:155], v[48:51], v[60:63]
ds_read_b128 v[40:43], v8 offset:47104
v_mfma_f32_16x16x32_bf16 v[64:67], a[156:159], v[48:51], v[64:67]
s_waitcnt lgkmcnt(4)
v_mfma_f32_16x16x32_bf16 v[52:55], a[160:163], v[20:23], v[52:55]
ds_read_b128 v[44:47], v9 offset:45056
v_mfma_f32_16x16x32_bf16 v[56:59], a[164:167], v[20:23], v[56:59]
v_mfma_f32_16x16x32_bf16 v[60:63], a[160:163], v[24:27], v[60:63]
ds_read_b128 v[48:51], v9 offset:47104
v_mfma_f32_16x16x32_bf16 v[64:67], a[164:167], v[24:27], v[64:67]
s_waitcnt lgkmcnt(4)
v_mfma_f32_16x16x32_bf16 v[52:55], a[168:171], v[28:31], v[52:55]
ds_read_b128 v[20:23], v8 offset:49152
v_mfma_f32_16x16x32_bf16 v[56:59], a[172:175], v[28:31], v[56:59]
s_waitcnt vmcnt(16)
v_mov_b32 v17, s42
s_mov_b64 exec, 1
buffer_store_dword v17, v16, s[84:87], s49 offen sc1
s_mov_b64 exec, -1
v_mfma_f32_16x16x32_bf16 v[60:63], a[168:171], v[32:35], v[60:63]
ds_read_b128 v[24:27], v8 offset:51200
v_mfma_f32_16x16x32_bf16 v[64:67], a[172:175], v[32:35], v[64:67]
s_waitcnt lgkmcnt(4)
v_mfma_f32_16x16x32_bf16 v[52:55], a[176:179], v[36:39], v[52:55]
ds_read_b128 v[28:31], v9 offset:49152
v_mfma_f32_16x16x32_bf16 v[56:59], a[180:183], v[36:39], v[56:59]
s_add_u32 s53, s42, 3
s_min_u32 s53, s53, 63
s_lshl_b32 s53, s53, 16
s_mov_b64 exec, 0xffff
buffer_load_dword v250, v19, s[8:11], s53 offen
s_mov_b64 exec, -1
v_mfma_f32_16x16x32_bf16 v[60:63], a[176:179], v[40:43], v[60:63]
ds_read_b128 v[32:35], v9 offset:51200
v_mfma_f32_16x16x32_bf16 v[64:67], a[180:183], v[40:43], v[64:67]
s_waitcnt lgkmcnt(4)
v_mfma_f32_16x16x32_bf16 v[52:55], a[184:187], v[44:47], v[52:55]
ds_read_b128 v[36:39], v8 offset:53248
v_mfma_f32_16x16x32_bf16 v[56:59], a[188:191], v[44:47], v[56:59]
v_mfma_f32_16x16x32_bf16 v[60:63], a[184:187], v[48:51], v[60:63]
ds_read_b128 v[40:43], v8 offset:55296
v_mfma_f32_16x16x32_bf16 v[64:67], a[188:191], v[48:51], v[64:67]
s_waitcnt lgkmcnt(4)
v_mfma_f32_16x16x32_bf16 v[52:55], a[192:195], v[20:23], v[52:55]
ds_read_b128 v[44:47], v9 offset:53248
v_mfma_f32_16x16x32_bf16 v[56:59], a[196:199], v[20:23], v[56:59]
v_mfma_f32_16x16x32_bf16 v[60:63], a[192:195], v[24:27], v[60:63]
ds_read_b128 v[48:51], v9 offset:55296
v_mfma_f32_16x16x32_bf16 v[64:67], a[196:199], v[24:27], v[64:67]
s_waitcnt lgkmcnt(4)
v_mfma_f32_16x16x32_bf16 v[52:55], a[200:203], v[28:31], v[52:55]
ds_read_b128 v[20:23], v8 offset:57344
v_mfma_f32_16x16x32_bf16 v[56:59], a[204:207], v[28:31], v[56:59]
v_mfma_f32_16x16x32_bf16 v[60:63], a[200:203], v[32:35], v[60:63]
ds_read_b128 v[24:27], v8 offset:59392
v_mfma_f32_16x16x32_bf16 v[64:67], a[204:207], v[32:35], v[64:67]
s_waitcnt lgkmcnt(4)
v_mfma_f32_16x16x32_bf16 v[52:55], a[208:211], v[36:39], v[52:55]
ds_read_b128 v[28:31], v9 offset:57344
v_mfma_f32_16x16x32_bf16 v[56:59], a[212:215], v[36:39], v[56:59]
v_mfma_f32_16x16x32_bf16 v[60:63], a[208:211], v[40:43], v[60:63]
ds_read_b128 v[32:35], v9 offset:59392
v_mfma_f32_16x16x32_bf16 v[64:67], a[212:215], v[40:43], v[64:67]
s_waitcnt lgkmcnt(4)
v_mfma_f32_16x16x32_bf16 v[52:55], a[216:219], v[44:47], v[52:55]
ds_read_b128 v[36:39], v8 offset:61440
v_mfma_f32_16x16x32_bf16 v[56:59], a[220:223], v[44:47], v[56:59]
v_mfma_f32_16x16x32_bf16 v[60:63], a[216:219], v[48:51], v[60:63]
ds_read_b128 v[40:43], v8 offset:63488
v_mfma_f32_16x16x32_bf16 v[64:67], a[220:223], v[48:51], v[64:67]
s_waitcnt lgkmcnt(4)
v_mfma_f32_16x16x32_bf16 v[52:55], a[224:227], v[20:23], v[52:55]
ds_read_b128 v[44:47], v9 offset:61440
v_mfma_f32_16x16x32_bf16 v[56:59], a[228:231], v[20:23], v[56:59]
v_mfma_f32_16x16x32_bf16 v[60:63], a[224:227], v[24:27], v[60:63]
ds_read_b128 v[48:51], v9 offset:63488
v_mfma_f32_16x16x32_bf16 v[64:67], a[228:231], v[24:27], v[64:67]
s_waitcnt lgkmcnt(5)
v_mfma_f32_16x16x32_bf16 v[52:55], a[232:235], v[28:31], v[52:55]
v_mfma_f32_16x16x32_bf16 v[56:59], a[236:239], v[28:31], v[56:59]
s_waitcnt lgkmcnt(4)
v_mfma_f32_16x16x32_bf16 v[60:63], a[232:235], v[32:35], v[60:63]
v_mfma_f32_16x16x32_bf16 v[64:67], a[236:239], v[32:35], v[64:67]
s_waitcnt lgkmcnt(3)
v_mfma_f32_16x16x32_bf16 v[52:55], a[240:243], v[36:39], v[52:55]
v_mfma_f32_16x16x32_bf16 v[56:59], a[244:247], v[36:39], v[56:59]
s_waitcnt lgkmcnt(2)
v_mfma_f32_16x16x32_bf16 v[60:63], a[240:243], v[40:43], v[60:63]
v_mfma_f32_16x16x32_bf16 v[64:67], a[244:247], v[40:43], v[64:67]
s_waitcnt lgkmcnt(1)
v_mfma_f32_16x16x32_bf16 v[52:55], a[248:251], v[44:47], v[52:55]
v_mfma_f32_16x16x32_bf16 v[56:59], a[252:255], v[44:47], v[56:59]
s_waitcnt lgkmcnt(0)
v_mfma_f32_16x16x32_bf16 v[60:63], a[248:251], v[48:51], v[60:63]
v_mfma_f32_16x16x32_bf16 v[64:67], a[252:255], v[48:51], v[64:67]
s_add_u32 s42, s42, 1
s_branch mega_kernel_k_loop
mega_kernel_k_fin:
s_nop 11
v_cvt_pk_bf16_f32 v84, v68, v69
v_cvt_pk_bf16_f32 v85, v70, v71
v_cvt_pk_bf16_f32 v86, v72, v73
v_cvt_pk_bf16_f32 v87, v74, v75
v_cvt_pk_bf16_f32 v88, v76, v77
v_cvt_pk_bf16_f32 v89, v78, v79
v_cvt_pk_bf16_f32 v90, v80, v81
v_cvt_pk_bf16_f32 v91, v82, v83
s_add_u32 s51, s42, s47
s_sub_u32 s51, s51, 1
s_bfe_u32 s52, s51, 0x40002
s_lshl_b32 s52, s52, 14
s_and_b32 s51, s51, 3
s_lshl_b32 s51, s51, 11
s_add_u32 s51, s51, s52
s_add_u32 s51, s51, s48
buffer_store_dwordx4 v[84:87], v7, s[84:87], s51 offen sc1
buffer_store_dwordx4 v[88:91], v7, s[84:87], s51 offen offset:1024 sc1
s_waitcnt vmcnt(0)
v_mov_b32 v17, s42
s_mov_b64 exec, 1
buffer_store_dword v17, v16, s[84:87], s49 offen sc1
s_mov_b64 exec, -1
s_waitcnt vmcnt(0)
s_barrier
s_branch mega_kernel_fft
mega_kernel_rv:
s_load_dwordx2 s[4:5], s[0:1], 32
s_load_dwordx2 s[8:9], s[0:1], 0
v_lshrrev_b32 v2, 6, v0
v_and_b32 v1, 63, v0
v_readfirstlane_b32 s41, v2
v_lshlrev_b32 v5, 4, v1
s_waitcnt lgkmcnt(0)
s_mov_b32 s6, 8388608
s_mov_b32 s7, 0x00020000
s_mov_b32 s10, 4194304
s_mov_b32 s11, 0x00020000
s_lshl_b32 s43, s40, 8
s_lshl_b32 s44, s41, 6
s_add_u32 s48, s43, s44
s_and_b32 s43, s48, 0x7ff
v_add_u32 v19, s43, v1
v_lshlrev_b32 v19, 7, v19
s_mov_b32 s43, 131072
buffer_load_dword v250, v19, s[8:11], s43 offen
s_nop 0
v_lshrrev_b32 v2, 3, v1
s_lshl_b32 s43, s41, 3
v_add_u32 v2, s43, v2
v_bfe_u32 v3, v2, 1, 3
v_and_b32 v4, 7, v1
v_xor_b32 v3, v3, v4
v_lshlrev_b32 v6, 11, v2
v_lshl_add_u32 v6, v3, 4, v6
s_lshl_b32 s46, s41, 10
v_and_b32 v2, 15, v1
v_bfe_u32 v3, v2, 1, 3
v_lshrrev_b32 v4, 4, v1
v_xor_b32 v3, v3, v4
v_lshlrev_b32 v8, 7, v2
v_lshl_add_u32 v8, v3, 4, v8
v_xor_b32 v9, 64, v8
v_add_u32 v10, 0x10000, v8
v_add_u32 v11, 0x10000, v9
v_mov_b32 v7, v5
s_lshl_b32 s47, s40, 2
s_add_u32 s47, s47, s41
s_mov_b32 s42, 0
s_mov_b32 s50, 0
s_add_u32 m0, s46, 0
s_nop 0
buffer_load_dwordx4 v6, s[8:11], s50 offen offset:0 lds
s_add_u32 m0, s46, 3968
s_nop 0
buffer_load_dwordx4 v6, s[8:11], s50 offen offset:128 lds
s_add_u32 m0, s46, 7936
s_nop 0
buffer_load_dwordx4 v6, s[8:11], s50 offen offset:256 lds
s_add_u32 m0, s46, 11904
s_nop 0
buffer_load_dwordx4 v6, s[8:11], s50 offen offset:384 lds
s_add_u32 m0, s46, 15872
s_nop 0
buffer_load_dwordx4 v6, s[8:11], s50 offen offset:512 lds
s_add_u32 m0, s46, 19840
s_nop 0
buffer_load_dwordx4 v6, s[8:11], s50 offen offset:640 lds
s_add_u32 m0, s46, 23808
s_nop 0
buffer_load_dwordx4 v6, s[8:11], s50 offen offset:768 lds
s_add_u32 m0, s46, 27776
s_nop 0
buffer_load_dwordx4 v6, s[8:11], s50 offen offset:896 lds
s_add_u32 m0, s46, 31744
s_nop 0
buffer_load_dwordx4 v6, s[8:11], s50 offen offset:1024 lds
s_add_u32 m0, s46, 35712
s_nop 0
buffer_load_dwordx4 v6, s[8:11], s50 offen offset:1152 lds
s_add_u32 m0, s46, 39680
s_nop 0
buffer_load_dwordx4 v6, s[8:11], s50 offen offset:1280 lds
s_add_u32 m0, s46, 43648
s_nop 0
buffer_load_dwordx4 v6, s[8:11], s50 offen offset:1408 lds
s_add_u32 m0, s46, 47616
s_nop 0
buffer_load_dwordx4 v6, s[8:11], s50 offen offset:1536 lds
s_add_u32 m0, s46, 51584
s_nop 0
buffer_load_dwordx4 v6, s[8:11], s50 offen offset:1664 lds
s_add_u32 m0, s46, 55552
s_nop 0
buffer_load_dwordx4 v6, s[8:11], s50 offen offset:1792 lds
s_add_u32 m0, s46, 59520
s_nop 0
buffer_load_dwordx4 v6, s[8:11], s50 offen offset:1920 lds
s_mov_b32 s50, 0x10000
s_add_u32 m0, s46, 65536
s_nop 0
buffer_load_dwordx4 v6, s[8:11], s50 offen offset:0 lds
s_add_u32 m0, s46, 69504
s_nop 0
buffer_load_dwordx4 v6, s[8:11], s50 offen offset:128 lds
s_add_u32 m0, s46, 73472
s_nop 0
buffer_load_dwordx4 v6, s[8:11], s50 offen offset:256 lds
s_add_u32 m0, s46, 77440
s_nop 0
buffer_load_dwordx4 v6, s[8:11], s50 offen offset:384 lds
s_add_u32 m0, s46, 81408
s_nop 0
buffer_load_dwordx4 v6, s[8:11], s50 offen offset:512 lds
s_add_u32 m0, s46, 85376
s_nop 0
buffer_load_dwordx4 v6, s[8:11], s50 offen offset:640 lds
s_add_u32 m0, s46, 89344
s_nop 0
buffer_load_dwordx4 v6, s[8:11], s50 offen offset:768 lds
s_add_u32 m0, s46, 93312
s_nop 0
buffer_load_dwordx4 v6, s[8:11], s50 offen offset:896 lds
s_add_u32 m0, s46, 97280
s_nop 0
buffer_load_dwordx4 v6, s[8:11], s50 offen offset:1024 lds
s_add_u32 m0, s46, 101248
s_nop 0
buffer_load_dwordx4 v6, s[8:11], s50 offen offset:1152 lds
s_add_u32 m0, s46, 105216
s_nop 0
buffer_load_dwordx4 v6, s[8:11], s50 offen offset:1280 lds
s_add_u32 m0, s46, 109184
s_nop 0
buffer_load_dwordx4 v6, s[8:11], s50 offen offset:1408 lds
s_add_u32 m0, s46, 113152
s_nop 0
buffer_load_dwordx4 v6, s[8:11], s50 offen offset:1536 lds
s_add_u32 m0, s46, 117120
s_nop 0
buffer_load_dwordx4 v6, s[8:11], s50 offen offset:1664 lds
s_add_u32 m0, s46, 121088
s_nop 0
buffer_load_dwordx4 v6, s[8:11], s50 offen offset:1792 lds
s_add_u32 m0, s46, 125056
s_nop 0
buffer_load_dwordx4 v6, s[8:11], s50 offen offset:1920 lds
v_lshrrev_b32 v2, 2, v1
v_and_b32 v3, 3, v1
v_lshlrev_b32 v16, 13, v2
v_lshl_add_u32 v16, v3, 4, v16
v_add_u32 v16, s48, v16
s_mul_i32 s45, s41, 8192
s_add_u32 s45, s45, 131072
v_bfe_u32 v17, v1, 2, 2
v_lshrrev_b32 v18, 4, v1
v_lshl_add_u32 v17, v18, 3, v17
v_lshlrev_b32 v17, 6, v17
v_lshl_add_u32 v17, v3, 3, v17
v_add_u32 v17, s45, v17
s_and_b32 s43, s40, 3
s_lshl_b32 s43, s43, 2
s_add_u32 s43, s43, s41
s_lshl_b32 s43, s43, 3
v_and_b32 v12, 7, v1
v_add_u32 v12, s43, v12
s_lshr_b32 s43, s40, 2
s_lshl_b32 s43, s43, 10
s_add_u32 s44, s43, 896
s_add_u32 s43, s43, 384
s_cmp_ge_u32 s40, 28
s_cselect_b32 s44, s44, s43
v_mov_b32 v13, s43
v_mov_b32 v14, s44
v_cmp_gt_u32 vcc, 32, v1
s_nop 1
v_cndmask_b32 v13, v14, v13, vcc
v_lshl_add_u32 v12, v12, 13, v13
s_mov_b32 s44, 0
buffer_load_dword v250, v12, s[4:7], s44 offen
s_add_u32 m0, s45, 0
s_mov_b32 s44, 0
buffer_load_dwordx4 v16, s[4:7], s44 offen lds
s_add_u32 m0, s45, 1024
s_mov_b32 s44, 131072
buffer_load_dwordx4 v16, s[4:7], s44 offen lds
s_add_u32 m0, s45, 2048
s_mov_b32 s44, 262144
buffer_load_dwordx4 v16, s[4:7], s44 offen lds
s_add_u32 m0, s45, 3072
s_mov_b32 s44, 393216
buffer_load_dwordx4 v16, s[4:7], s44 offen lds
s_add_u32 m0, s45, 4096
s_mov_b32 s44, 524288
buffer_load_dwordx4 v16, s[4:7], s44 offen lds
s_add_u32 m0, s45, 5120
s_mov_b32 s44, 655360
buffer_load_dwordx4 v16, s[4:7], s44 offen lds
s_add_u32 m0, s45, 6144
s_mov_b32 s44, 786432
buffer_load_dwordx4 v16, s[4:7], s44 offen lds
s_add_u32 m0, s45, 7168
s_mov_b32 s44, 917504
buffer_load_dwordx4 v16, s[4:7], s44 offen lds
s_waitcnt vmcnt(4)
s_barrier
ds_read_b64_tr_b16 a[0:1], v17 offset:0
ds_read_b64_tr_b16 a[2:3], v17 offset:256
ds_read_b64_tr_b16 a[4:5], v17 offset:32
ds_read_b64_tr_b16 a[6:7], v17 offset:288
ds_read_b64_tr_b16 a[8:9], v17 offset:2048
ds_read_b64_tr_b16 a[10:11], v17 offset:2304
ds_read_b64_tr_b16 a[12:13], v17 offset:2080
ds_read_b64_tr_b16 a[14:15], v17 offset:2336
s_waitcnt lgkmcnt(0)
s_mov_b32 s44, 1048576
buffer_load_dword v250, v12, s[4:7], s44 offen
s_add_u32 m0, s45, 0
s_mov_b32 s44, 1048576
buffer_load_dwordx4 v16, s[4:7], s44 offen lds
s_add_u32 m0, s45, 1024
s_mov_b32 s44, 1179648
buffer_load_dwordx4 v16, s[4:7], s44 offen lds
s_add_u32 m0, s45, 2048
s_mov_b32 s44, 1310720
buffer_load_dwordx4 v16, s[4:7], s44 offen lds
s_add_u32 m0, s45, 3072
s_mov_b32 s44, 1441792
buffer_load_dwordx4 v16, s[4:7], s44 offen lds
ds_read_b128 v[20:23], v8 offset:0
ds_read_b128 v[24:27], v8 offset:2048
ds_read_b128 v[28:31], v9 offset:0
ds_read_b128 v[32:35], v9 offset:2048
ds_read_b128 v[36:39], v10 offset:0
ds_read_b128 v[40:43], v10 offset:2048
ds_read_b128 v[44:47], v11 offset:0
ds_read_b128 v[48:51], v11 offset:2048
s_waitcnt lgkmcnt(0)
v_mfma_f32_16x16x32_bf16 v[52:55], v[20:23], a[0:3], 0
v_mfma_f32_16x16x32_bf16 v[56:59], v[20:23], a[4:7], 0
v_mfma_f32_16x16x32_bf16 v[60:63], v[24:27], a[0:3], 0
v_mfma_f32_16x16x32_bf16 v[64:67], v[24:27], a[4:7], 0
v_mfma_f32_16x16x32_bf16 v[52:55], v[28:31], a[8:11], v[52:55]
v_mfma_f32_16x16x32_bf16 v[56:59], v[28:31], a[12:15], v[56:59]
v_mfma_f32_16x16x32_bf16 v[60:63], v[32:35], a[8:11], v[60:63]
v_mfma_f32_16x16x32_bf16 v[64:67], v[32:35], a[12:15], v[64:67]
v_mfma_f32_16x16x32_bf16 v[68:71], v[36:39], a[0:3], 0
v_mfma_f32_16x16x32_bf16 v[72:75], v[36:39], a[4:7], 0
v_mfma_f32_16x16x32_bf16 v[76:79], v[40:43], a[0:3], 0
v_mfma_f32_16x16x32_bf16 v[80:83], v[40:43], a[4:7], 0
v_mfma_f32_16x16x32_bf16 v[68:71], v[44:47], a[8:11], v[68:71]
v_mfma_f32_16x16x32_bf16 v[72:75], v[44:47], a[12:15], v[72:75]
v_mfma_f32_16x16x32_bf16 v[76:79], v[48:51], a[8:11], v[76:79]
v_mfma_f32_16x16x32_bf16 v[80:83], v[48:51], a[12:15], v[80:83]
s_waitcnt vmcnt(5)
ds_read_b64_tr_b16 a[16:17], v17 offset:4096
ds_read_b64_tr_b16 a[18:19], v17 offset:4352
ds_read_b64_tr_b16 a[20:21], v17 offset:4128
ds_read_b64_tr_b16 a[22:23], v17 offset:4384
ds_read_b64_tr_b16 a[24:25], v17 offset:6144
ds_read_b64_tr_b16 a[26:27], v17 offset:6400
ds_read_b64_tr_b16 a[28:29], v17 offset:6176
ds_read_b64_tr_b16 a[30:31], v17 offset:6432
s_waitcnt lgkmcnt(0)
s_add_u32 m0, s45, 4096
s_mov_b32 s44, 1572864
buffer_load_dwordx4 v16, s[4:7], s44 offen lds
s_add_u32 m0, s45, 5120
s_mov_b32 s44, 1703936
buffer_load_dwordx4 v16, s[4:7], s44 offen lds
s_add_u32 m0, s45, 6144
s_mov_b32 s44, 1835008
buffer_load_dwordx4 v16, s[4:7], s44 offen lds
s_add_u32 m0, s45, 7168
s_mov_b32 s44, 1966080
buffer_load_dwordx4 v16, s[4:7], s44 offen lds
ds_read_b128 v[20:23], v8 offset:4096
ds_read_b128 v[24:27], v8 offset:6144
ds_read_b128 v[28:31], v9 offset:4096
ds_read_b128 v[32:35], v9 offset:6144
ds_read_b128 v[36:39], v10 offset:4096
ds_read_b128 v[40:43], v10 offset:6144
ds_read_b128 v[44:47], v11 offset:4096
ds_read_b128 v[48:51], v11 offset:6144
s_waitcnt lgkmcnt(0)
v_mfma_f32_16x16x32_bf16 v[52:55], v[20:23], a[16:19], v[52:55]
v_mfma_f32_16x16x32_bf16 v[56:59], v[20:23], a[20:23], v[56:59]
v_mfma_f32_16x16x32_bf16 v[60:63], v[24:27], a[16:19], v[60:63]
v_mfma_f32_16x16x32_bf16 v[64:67], v[24:27], a[20:23], v[64:67]
v_mfma_f32_16x16x32_bf16 v[52:55], v[28:31], a[24:27], v[52:55]
v_mfma_f32_16x16x32_bf16 v[56:59], v[28:31], a[28:31], v[56:59]
v_mfma_f32_16x16x32_bf16 v[60:63], v[32:35], a[24:27], v[60:63]
v_mfma_f32_16x16x32_bf16 v[64:67], v[32:35], a[28:31], v[64:67]
v_mfma_f32_16x16x32_bf16 v[68:71], v[36:39], a[16:19], v[68:71]
v_mfma_f32_16x16x32_bf16 v[72:75], v[36:39], a[20:23], v[72:75]
v_mfma_f32_16x16x32_bf16 v[76:79], v[40:43], a[16:19], v[76:79]
v_mfma_f32_16x16x32_bf16 v[80:83], v[40:43], a[20:23], v[80:83]
v_mfma_f32_16x16x32_bf16 v[68:71], v[44:47], a[24:27], v[68:71]
v_mfma_f32_16x16x32_bf16 v[72:75], v[44:47], a[28:31], v[72:75]
v_mfma_f32_16x16x32_bf16 v[76:79], v[48:51], a[24:27], v[76:79]
v_mfma_f32_16x16x32_bf16 v[80:83], v[48:51], a[28:31], v[80:83]
s_waitcnt vmcnt(4)
ds_read_b64_tr_b16 a[32:33], v17 offset:0
ds_read_b64_tr_b16 a[34:35], v17 offset:256
ds_read_b64_tr_b16 a[36:37], v17 offset:32
ds_read_b64_tr_b16 a[38:39], v17 offset:288
ds_read_b64_tr_b16 a[40:41], v17 offset:2048
ds_read_b64_tr_b16 a[42:43], v17 offset:2304
ds_read_b64_tr_b16 a[44:45], v17 offset:2080
ds_read_b64_tr_b16 a[46:47], v17 offset:2336
s_waitcnt lgkmcnt(0)
s_mov_b32 s44, 2097152
buffer_load_dword v250, v12, s[4:7], s44 offen
s_add_u32 m0, s45, 0
s_mov_b32 s44, 2097152
buffer_load_dwordx4 v16, s[4:7], s44 offen lds
s_add_u32 m0, s45, 1024
s_mov_b32 s44, 2228224
buffer_load_dwordx4 v16, s[4:7], s44 offen lds
s_add_u32 m0, s45, 2048
s_mov_b32 s44, 2359296
buffer_load_dwordx4 v16, s[4:7], s44 offen lds
s_add_u32 m0, s45, 3072
s_mov_b32 s44, 2490368
buffer_load_dwordx4 v16, s[4:7], s44 offen lds
ds_read_b128 v[20:23], v8 offset:8192
ds_read_b128 v[24:27], v8 offset:10240
ds_read_b128 v[28:31], v9 offset:8192
ds_read_b128 v[32:35], v9 offset:10240
ds_read_b128 v[36:39], v10 offset:8192
ds_read_b128 v[40:43], v10 offset:10240
ds_read_b128 v[44:47], v11 offset:8192
ds_read_b128 v[48:51], v11 offset:10240
s_waitcnt lgkmcnt(0)
v_mfma_f32_16x16x32_bf16 v[52:55], v[20:23], a[32:35], v[52:55]
v_mfma_f32_16x16x32_bf16 v[56:59], v[20:23], a[36:39], v[56:59]
v_mfma_f32_16x16x32_bf16 v[60:63], v[24:27], a[32:35], v[60:63]
v_mfma_f32_16x16x32_bf16 v[64:67], v[24:27], a[36:39], v[64:67]
v_mfma_f32_16x16x32_bf16 v[52:55], v[28:31], a[40:43], v[52:55]
v_mfma_f32_16x16x32_bf16 v[56:59], v[28:31], a[44:47], v[56:59]
v_mfma_f32_16x16x32_bf16 v[60:63], v[32:35], a[40:43], v[60:63]
v_mfma_f32_16x16x32_bf16 v[64:67], v[32:35], a[44:47], v[64:67]
v_mfma_f32_16x16x32_bf16 v[68:71], v[36:39], a[32:35], v[68:71]
v_mfma_f32_16x16x32_bf16 v[72:75], v[36:39], a[36:39], v[72:75]
v_mfma_f32_16x16x32_bf16 v[76:79], v[40:43], a[32:35], v[76:79]
v_mfma_f32_16x16x32_bf16 v[80:83], v[40:43], a[36:39], v[80:83]
v_mfma_f32_16x16x32_bf16 v[68:71], v[44:47], a[40:43], v[68:71]
v_mfma_f32_16x16x32_bf16 v[72:75], v[44:47], a[44:47], v[72:75]
v_mfma_f32_16x16x32_bf16 v[76:79], v[48:51], a[40:43], v[76:79]
v_mfma_f32_16x16x32_bf16 v[80:83], v[48:51], a[44:47], v[80:83]
s_waitcnt vmcnt(5)
ds_read_b64_tr_b16 a[48:49], v17 offset:4096
ds_read_b64_tr_b16 a[50:51], v17 offset:4352
ds_read_b64_tr_b16 a[52:53], v17 offset:4128
ds_read_b64_tr_b16 a[54:55], v17 offset:4384
ds_read_b64_tr_b16 a[56:57], v17 offset:6144
ds_read_b64_tr_b16 a[58:59], v17 offset:6400
ds_read_b64_tr_b16 a[60:61], v17 offset:6176
ds_read_b64_tr_b16 a[62:63], v17 offset:6432
s_waitcnt lgkmcnt(0)
s_add_u32 m0, s45, 4096
s_mov_b32 s44, 2621440
buffer_load_dwordx4 v16, s[4:7], s44 offen lds
s_add_u32 m0, s45, 5120
s_mov_b32 s44, 2752512
buffer_load_dwordx4 v16, s[4:7], s44 offen lds
s_add_u32 m0, s45, 6144
s_mov_b32 s44, 2883584
buffer_load_dwordx4 v16, s[4:7], s44 offen lds
s_add_u32 m0, s45, 7168
s_mov_b32 s44, 3014656
buffer_load_dwordx4 v16, s[4:7], s44 offen lds
ds_read_b128 v[20:23], v8 offset:12288
ds_read_b128 v[24:27], v8 offset:14336
ds_read_b128 v[28:31], v9 offset:12288
ds_read_b128 v[32:35], v9 offset:14336
ds_read_b128 v[36:39], v10 offset:12288
ds_read_b128 v[40:43], v10 offset:14336
ds_read_b128 v[44:47], v11 offset:12288
ds_read_b128 v[48:51], v11 offset:14336
s_waitcnt lgkmcnt(0)
v_mfma_f32_16x16x32_bf16 v[52:55], v[20:23], a[48:51], v[52:55]
v_mfma_f32_16x16x32_bf16 v[56:59], v[20:23], a[52:55], v[56:59]
v_mfma_f32_16x16x32_bf16 v[60:63], v[24:27], a[48:51], v[60:63]
v_mfma_f32_16x16x32_bf16 v[64:67], v[24:27], a[52:55], v[64:67]
v_mfma_f32_16x16x32_bf16 v[52:55], v[28:31], a[56:59], v[52:55]
v_mfma_f32_16x16x32_bf16 v[56:59], v[28:31], a[60:63], v[56:59]
v_mfma_f32_16x16x32_bf16 v[60:63], v[32:35], a[56:59], v[60:63]
v_mfma_f32_16x16x32_bf16 v[64:67], v[32:35], a[60:63], v[64:67]
v_mfma_f32_16x16x32_bf16 v[68:71], v[36:39], a[48:51], v[68:71]
v_mfma_f32_16x16x32_bf16 v[72:75], v[36:39], a[52:55], v[72:75]
v_mfma_f32_16x16x32_bf16 v[76:79], v[40:43], a[48:51], v[76:79]
v_mfma_f32_16x16x32_bf16 v[80:83], v[40:43], a[52:55], v[80:83]
v_mfma_f32_16x16x32_bf16 v[68:71], v[44:47], a[56:59], v[68:71]
v_mfma_f32_16x16x32_bf16 v[72:75], v[44:47], a[60:63], v[72:75]
v_mfma_f32_16x16x32_bf16 v[76:79], v[48:51], a[56:59], v[76:79]
v_mfma_f32_16x16x32_bf16 v[80:83], v[48:51], a[60:63], v[80:83]
s_waitcnt vmcnt(4)
ds_read_b64_tr_b16 a[64:65], v17 offset:0
ds_read_b64_tr_b16 a[66:67], v17 offset:256
ds_read_b64_tr_b16 a[68:69], v17 offset:32
ds_read_b64_tr_b16 a[70:71], v17 offset:288
ds_read_b64_tr_b16 a[72:73], v17 offset:2048
ds_read_b64_tr_b16 a[74:75], v17 offset:2304
ds_read_b64_tr_b16 a[76:77], v17 offset:2080
ds_read_b64_tr_b16 a[78:79], v17 offset:2336
s_waitcnt lgkmcnt(0)
s_mov_b32 s44, 3145728
buffer_load_dword v250, v12, s[4:7], s44 offen
s_add_u32 m0, s45, 0
s_mov_b32 s44, 3145728
buffer_load_dwordx4 v16, s[4:7], s44 offen lds
s_add_u32 m0, s45, 1024
s_mov_b32 s44, 3276800
buffer_load_dwordx4 v16, s[4:7], s44 offen lds
s_add_u32 m0, s45, 2048
s_mov_b32 s44, 3407872
buffer_load_dwordx4 v16, s[4:7], s44 offen lds
s_add_u32 m0, s45, 3072
s_mov_b32 s44, 3538944
buffer_load_dwordx4 v16, s[4:7], s44 offen lds
ds_read_b128 v[20:23], v8 offset:16384
ds_read_b128 v[24:27], v8 offset:18432
ds_read_b128 v[28:31], v9 offset:16384
ds_read_b128 v[32:35], v9 offset:18432
ds_read_b128 v[36:39], v10 offset:16384
ds_read_b128 v[40:43], v10 offset:18432
ds_read_b128 v[44:47], v11 offset:16384
ds_read_b128 v[48:51], v11 offset:18432
s_waitcnt lgkmcnt(0)
v_mfma_f32_16x16x32_bf16 v[52:55], v[20:23], a[64:67], v[52:55]
v_mfma_f32_16x16x32_bf16 v[56:59], v[20:23], a[68:71], v[56:59]
v_mfma_f32_16x16x32_bf16 v[60:63], v[24:27], a[64:67], v[60:63]
v_mfma_f32_16x16x32_bf16 v[64:67], v[24:27], a[68:71], v[64:67]
v_mfma_f32_16x16x32_bf16 v[52:55], v[28:31], a[72:75], v[52:55]
v_mfma_f32_16x16x32_bf16 v[56:59], v[28:31], a[76:79], v[56:59]
v_mfma_f32_16x16x32_bf16 v[60:63], v[32:35], a[72:75], v[60:63]
v_mfma_f32_16x16x32_bf16 v[64:67], v[32:35], a[76:79], v[64:67]
v_mfma_f32_16x16x32_bf16 v[68:71], v[36:39], a[64:67], v[68:71]
v_mfma_f32_16x16x32_bf16 v[72:75], v[36:39], a[68:71], v[72:75]
v_mfma_f32_16x16x32_bf16 v[76:79], v[40:43], a[64:67], v[76:79]
v_mfma_f32_16x16x32_bf16 v[80:83], v[40:43], a[68:71], v[80:83]
v_mfma_f32_16x16x32_bf16 v[68:71], v[44:47], a[72:75], v[68:71]
v_mfma_f32_16x16x32_bf16 v[72:75], v[44:47], a[76:79], v[72:75]
v_mfma_f32_16x16x32_bf16 v[76:79], v[48:51], a[72:75], v[76:79]
v_mfma_f32_16x16x32_bf16 v[80:83], v[48:51], a[76:79], v[80:83]
s_waitcnt vmcnt(5)
ds_read_b64_tr_b16 a[80:81], v17 offset:4096
ds_read_b64_tr_b16 a[82:83], v17 offset:4352
ds_read_b64_tr_b16 a[84:85], v17 offset:4128
ds_read_b64_tr_b16 a[86:87], v17 offset:4384
ds_read_b64_tr_b16 a[88:89], v17 offset:6144
ds_read_b64_tr_b16 a[90:91], v17 offset:6400
ds_read_b64_tr_b16 a[92:93], v17 offset:6176
ds_read_b64_tr_b16 a[94:95], v17 offset:6432
s_waitcnt lgkmcnt(0)
s_add_u32 m0, s45, 4096
s_mov_b32 s44, 3670016
buffer_load_dwordx4 v16, s[4:7], s44 offen lds
s_add_u32 m0, s45, 5120
s_mov_b32 s44, 3801088
buffer_load_dwordx4 v16, s[4:7], s44 offen lds
s_add_u32 m0, s45, 6144
s_mov_b32 s44, 3932160
buffer_load_dwordx4 v16, s[4:7], s44 offen lds
s_add_u32 m0, s45, 7168
s_mov_b32 s44, 4063232
buffer_load_dwordx4 v16, s[4:7], s44 offen lds
ds_read_b128 v[20:23], v8 offset:20480
ds_read_b128 v[24:27], v8 offset:22528
ds_read_b128 v[28:31], v9 offset:20480
ds_read_b128 v[32:35], v9 offset:22528
ds_read_b128 v[36:39], v10 offset:20480
ds_read_b128 v[40:43], v10 offset:22528
ds_read_b128 v[44:47], v11 offset:20480
ds_read_b128 v[48:51], v11 offset:22528
s_waitcnt lgkmcnt(0)
v_mfma_f32_16x16x32_bf16 v[52:55], v[20:23], a[80:83], v[52:55]
v_mfma_f32_16x16x32_bf16 v[56:59], v[20:23], a[84:87], v[56:59]
v_mfma_f32_16x16x32_bf16 v[60:63], v[24:27], a[80:83], v[60:63]
v_mfma_f32_16x16x32_bf16 v[64:67], v[24:27], a[84:87], v[64:67]
v_mfma_f32_16x16x32_bf16 v[52:55], v[28:31], a[88:91], v[52:55]
v_mfma_f32_16x16x32_bf16 v[56:59], v[28:31], a[92:95], v[56:59]
v_mfma_f32_16x16x32_bf16 v[60:63], v[32:35], a[88:91], v[60:63]
v_mfma_f32_16x16x32_bf16 v[64:67], v[32:35], a[92:95], v[64:67]
v_mfma_f32_16x16x32_bf16 v[68:71], v[36:39], a[80:83], v[68:71]
v_mfma_f32_16x16x32_bf16 v[72:75], v[36:39], a[84:87], v[72:75]
v_mfma_f32_16x16x32_bf16 v[76:79], v[40:43], a[80:83], v[76:79]
v_mfma_f32_16x16x32_bf16 v[80:83], v[40:43], a[84:87], v[80:83]
v_mfma_f32_16x16x32_bf16 v[68:71], v[44:47], a[88:91], v[68:71]
v_mfma_f32_16x16x32_bf16 v[72:75], v[44:47], a[92:95], v[72:75]
v_mfma_f32_16x16x32_bf16 v[76:79], v[48:51], a[88:91], v[76:79]
v_mfma_f32_16x16x32_bf16 v[80:83], v[48:51], a[92:95], v[80:83]
s_waitcnt vmcnt(4)
ds_read_b64_tr_b16 a[96:97], v17 offset:0
ds_read_b64_tr_b16 a[98:99], v17 offset:256
ds_read_b64_tr_b16 a[100:101], v17 offset:32
ds_read_b64_tr_b16 a[102:103], v17 offset:288
ds_read_b64_tr_b16 a[104:105], v17 offset:2048
ds_read_b64_tr_b16 a[106:107], v17 offset:2304
ds_read_b64_tr_b16 a[108:109], v17 offset:2080
ds_read_b64_tr_b16 a[110:111], v17 offset:2336
s_waitcnt lgkmcnt(0)
s_mov_b32 s44, 4194304
buffer_load_dword v250, v12, s[4:7], s44 offen
s_add_u32 m0, s45, 0
s_mov_b32 s44, 4194304
buffer_load_dwordx4 v16, s[4:7], s44 offen lds
s_add_u32 m0, s45, 1024
s_mov_b32 s44, 4325376
buffer_load_dwordx4 v16, s[4:7], s44 offen lds
s_add_u32 m0, s45, 2048
s_mov_b32 s44, 4456448
buffer_load_dwordx4 v16, s[4:7], s44 offen lds
s_add_u32 m0, s45, 3072
s_mov_b32 s44, 4587520
buffer_load_dwordx4 v16, s[4:7], s44 offen lds
ds_read_b128 v[20:23], v8 offset:24576
ds_read_b128 v[24:27], v8 offset:26624
ds_read_b128 v[28:31], v9 offset:24576
ds_read_b128 v[32:35], v9 offset:26624
ds_read_b128 v[36:39], v10 offset:24576
ds_read_b128 v[40:43], v10 offset:26624
ds_read_b128 v[44:47], v11 offset:24576
ds_read_b128 v[48:51], v11 offset:26624
s_waitcnt lgkmcnt(0)
v_mfma_f32_16x16x32_bf16 v[52:55], v[20:23], a[96:99], v[52:55]
v_mfma_f32_16x16x32_bf16 v[56:59], v[20:23], a[100:103], v[56:59]
v_mfma_f32_16x16x32_bf16 v[60:63], v[24:27], a[96:99], v[60:63]
v_mfma_f32_16x16x32_bf16 v[64:67], v[24:27], a[100:103], v[64:67]
v_mfma_f32_16x16x32_bf16 v[52:55], v[28:31], a[104:107], v[52:55]
v_mfma_f32_16x16x32_bf16 v[56:59], v[28:31], a[108:111], v[56:59]
v_mfma_f32_16x16x32_bf16 v[60:63], v[32:35], a[104:107], v[60:63]
v_mfma_f32_16x16x32_bf16 v[64:67], v[32:35], a[108:111], v[64:67]
v_mfma_f32_16x16x32_bf16 v[68:71], v[36:39], a[96:99], v[68:71]
v_mfma_f32_16x16x32_bf16 v[72:75], v[36:39], a[100:103], v[72:75]
v_mfma_f32_16x16x32_bf16 v[76:79], v[40:43], a[96:99], v[76:79]
v_mfma_f32_16x16x32_bf16 v[80:83], v[40:43], a[100:103], v[80:83]
v_mfma_f32_16x16x32_bf16 v[68:71], v[44:47], a[104:107], v[68:71]
v_mfma_f32_16x16x32_bf16 v[72:75], v[44:47], a[108:111], v[72:75]
v_mfma_f32_16x16x32_bf16 v[76:79], v[48:51], a[104:107], v[76:79]
v_mfma_f32_16x16x32_bf16 v[80:83], v[48:51], a[108:111], v[80:83]
s_waitcnt vmcnt(5)
ds_read_b64_tr_b16 a[112:113], v17 offset:4096
ds_read_b64_tr_b16 a[114:115], v17 offset:4352
ds_read_b64_tr_b16 a[116:117], v17 offset:4128
ds_read_b64_tr_b16 a[118:119], v17 offset:4384
ds_read_b64_tr_b16 a[120:121], v17 offset:6144
ds_read_b64_tr_b16 a[122:123], v17 offset:6400
ds_read_b64_tr_b16 a[124:125], v17 offset:6176
ds_read_b64_tr_b16 a[126:127], v17 offset:6432
s_waitcnt lgkmcnt(0)
s_add_u32 m0, s45, 4096
s_mov_b32 s44, 4718592
buffer_load_dwordx4 v16, s[4:7], s44 offen lds
s_add_u32 m0, s45, 5120
s_mov_b32 s44, 4849664
buffer_load_dwordx4 v16, s[4:7], s44 offen lds
s_add_u32 m0, s45, 6144
s_mov_b32 s44, 4980736
buffer_load_dwordx4 v16, s[4:7], s44 offen lds
s_add_u32 m0, s45, 7168
s_mov_b32 s44, 5111808
buffer_load_dwordx4 v16, s[4:7], s44 offen lds
ds_read_b128 v[20:23], v8 offset:28672
ds_read_b128 v[24:27], v8 offset:30720
ds_read_b128 v[28:31], v9 offset:28672
ds_read_b128 v[32:35], v9 offset:30720
ds_read_b128 v[36:39], v10 offset:28672
ds_read_b128 v[40:43], v10 offset:30720
ds_read_b128 v[44:47], v11 offset:28672
ds_read_b128 v[48:51], v11 offset:30720
s_waitcnt lgkmcnt(0)
v_mfma_f32_16x16x32_bf16 v[52:55], v[20:23], a[112:115], v[52:55]
v_mfma_f32_16x16x32_bf16 v[56:59], v[20:23], a[116:119], v[56:59]
v_mfma_f32_16x16x32_bf16 v[60:63], v[24:27], a[112:115], v[60:63]
v_mfma_f32_16x16x32_bf16 v[64:67], v[24:27], a[116:119], v[64:67]
v_mfma_f32_16x16x32_bf16 v[52:55], v[28:31], a[120:123], v[52:55]
v_mfma_f32_16x16x32_bf16 v[56:59], v[28:31], a[124:127], v[56:59]
v_mfma_f32_16x16x32_bf16 v[60:63], v[32:35], a[120:123], v[60:63]
v_mfma_f32_16x16x32_bf16 v[64:67], v[32:35], a[124:127], v[64:67]
v_mfma_f32_16x16x32_bf16 v[68:71], v[36:39], a[112:115], v[68:71]
v_mfma_f32_16x16x32_bf16 v[72:75], v[36:39], a[116:119], v[72:75]
v_mfma_f32_16x16x32_bf16 v[76:79], v[40:43], a[112:115], v[76:79]
v_mfma_f32_16x16x32_bf16 v[80:83], v[40:43], a[116:119], v[80:83]
v_mfma_f32_16x16x32_bf16 v[68:71], v[44:47], a[120:123], v[68:71]
v_mfma_f32_16x16x32_bf16 v[72:75], v[44:47], a[124:127], v[72:75]
v_mfma_f32_16x16x32_bf16 v[76:79], v[48:51], a[120:123], v[76:79]
v_mfma_f32_16x16x32_bf16 v[80:83], v[48:51], a[124:127], v[80:83]
s_waitcnt vmcnt(4)
ds_read_b64_tr_b16 a[128:129], v17 offset:0
ds_read_b64_tr_b16 a[130:131], v17 offset:256
ds_read_b64_tr_b16 a[132:133], v17 offset:32
ds_read_b64_tr_b16 a[134:135], v17 offset:288
ds_read_b64_tr_b16 a[136:137], v17 offset:2048
ds_read_b64_tr_b16 a[138:139], v17 offset:2304
ds_read_b64_tr_b16 a[140:141], v17 offset:2080
ds_read_b64_tr_b16 a[142:143], v17 offset:2336
s_waitcnt lgkmcnt(0)
s_mov_b32 s44, 5242880
buffer_load_dword v250, v12, s[4:7], s44 offen
s_add_u32 m0, s45, 0
s_mov_b32 s44, 5242880
buffer_load_dwordx4 v16, s[4:7], s44 offen lds
s_add_u32 m0, s45, 1024
s_mov_b32 s44, 5373952
buffer_load_dwordx4 v16, s[4:7], s44 offen lds
s_add_u32 m0, s45, 2048
s_mov_b32 s44, 5505024
buffer_load_dwordx4 v16, s[4:7], s44 offen lds
s_add_u32 m0, s45, 3072
s_mov_b32 s44, 5636096
buffer_load_dwordx4 v16, s[4:7], s44 offen lds
ds_read_b128 v[20:23], v8 offset:32768
ds_read_b128 v[24:27], v8 offset:34816
ds_read_b128 v[28:31], v9 offset:32768
ds_read_b128 v[32:35], v9 offset:34816
ds_read_b128 v[36:39], v10 offset:32768
ds_read_b128 v[40:43], v10 offset:34816
ds_read_b128 v[44:47], v11 offset:32768
ds_read_b128 v[48:51], v11 offset:34816
s_waitcnt lgkmcnt(0)
v_mfma_f32_16x16x32_bf16 v[52:55], v[20:23], a[128:131], v[52:55]
v_mfma_f32_16x16x32_bf16 v[56:59], v[20:23], a[132:135], v[56:59]
v_mfma_f32_16x16x32_bf16 v[60:63], v[24:27], a[128:131], v[60:63]
v_mfma_f32_16x16x32_bf16 v[64:67], v[24:27], a[132:135], v[64:67]
v_mfma_f32_16x16x32_bf16 v[52:55], v[28:31], a[136:139], v[52:55]
v_mfma_f32_16x16x32_bf16 v[56:59], v[28:31], a[140:143], v[56:59]
v_mfma_f32_16x16x32_bf16 v[60:63], v[32:35], a[136:139], v[60:63]
v_mfma_f32_16x16x32_bf16 v[64:67], v[32:35], a[140:143], v[64:67]
v_mfma_f32_16x16x32_bf16 v[68:71], v[36:39], a[128:131], v[68:71]
v_mfma_f32_16x16x32_bf16 v[72:75], v[36:39], a[132:135], v[72:75]
v_mfma_f32_16x16x32_bf16 v[76:79], v[40:43], a[128:131], v[76:79]
v_mfma_f32_16x16x32_bf16 v[80:83], v[40:43], a[132:135], v[80:83]
v_mfma_f32_16x16x32_bf16 v[68:71], v[44:47], a[136:139], v[68:71]
v_mfma_f32_16x16x32_bf16 v[72:75], v[44:47], a[140:143], v[72:75]
v_mfma_f32_16x16x32_bf16 v[76:79], v[48:51], a[136:139], v[76:79]
v_mfma_f32_16x16x32_bf16 v[80:83], v[48:51], a[140:143], v[80:83]
s_waitcnt vmcnt(5)
ds_read_b64_tr_b16 a[144:145], v17 offset:4096
ds_read_b64_tr_b16 a[146:147], v17 offset:4352
ds_read_b64_tr_b16 a[148:149], v17 offset:4128
ds_read_b64_tr_b16 a[150:151], v17 offset:4384
ds_read_b64_tr_b16 a[152:153], v17 offset:6144
ds_read_b64_tr_b16 a[154:155], v17 offset:6400
ds_read_b64_tr_b16 a[156:157], v17 offset:6176
ds_read_b64_tr_b16 a[158:159], v17 offset:6432
s_waitcnt lgkmcnt(0)
s_add_u32 m0, s45, 4096
s_mov_b32 s44, 5767168
buffer_load_dwordx4 v16, s[4:7], s44 offen lds
s_add_u32 m0, s45, 5120
s_mov_b32 s44, 5898240
buffer_load_dwordx4 v16, s[4:7], s44 offen lds
s_add_u32 m0, s45, 6144
s_mov_b32 s44, 6029312
buffer_load_dwordx4 v16, s[4:7], s44 offen lds
s_add_u32 m0, s45, 7168
s_mov_b32 s44, 6160384
buffer_load_dwordx4 v16, s[4:7], s44 offen lds
ds_read_b128 v[20:23], v8 offset:36864
ds_read_b128 v[24:27], v8 offset:38912
ds_read_b128 v[28:31], v9 offset:36864
ds_read_b128 v[32:35], v9 offset:38912
ds_read_b128 v[36:39], v10 offset:36864
ds_read_b128 v[40:43], v10 offset:38912
ds_read_b128 v[44:47], v11 offset:36864
ds_read_b128 v[48:51], v11 offset:38912
s_waitcnt lgkmcnt(0)
v_mfma_f32_16x16x32_bf16 v[52:55], v[20:23], a[144:147], v[52:55]
v_mfma_f32_16x16x32_bf16 v[56:59], v[20:23], a[148:151], v[56:59]
v_mfma_f32_16x16x32_bf16 v[60:63], v[24:27], a[144:147], v[60:63]
v_mfma_f32_16x16x32_bf16 v[64:67], v[24:27], a[148:151], v[64:67]
v_mfma_f32_16x16x32_bf16 v[52:55], v[28:31], a[152:155], v[52:55]
v_mfma_f32_16x16x32_bf16 v[56:59], v[28:31], a[156:159], v[56:59]
v_mfma_f32_16x16x32_bf16 v[60:63], v[32:35], a[152:155], v[60:63]
v_mfma_f32_16x16x32_bf16 v[64:67], v[32:35], a[156:159], v[64:67]
v_mfma_f32_16x16x32_bf16 v[68:71], v[36:39], a[144:147], v[68:71]
v_mfma_f32_16x16x32_bf16 v[72:75], v[36:39], a[148:151], v[72:75]
v_mfma_f32_16x16x32_bf16 v[76:79], v[40:43], a[144:147], v[76:79]
v_mfma_f32_16x16x32_bf16 v[80:83], v[40:43], a[148:151], v[80:83]
v_mfma_f32_16x16x32_bf16 v[68:71], v[44:47], a[152:155], v[68:71]
v_mfma_f32_16x16x32_bf16 v[72:75], v[44:47], a[156:159], v[72:75]
v_mfma_f32_16x16x32_bf16 v[76:79], v[48:51], a[152:155], v[76:79]
v_mfma_f32_16x16x32_bf16 v[80:83], v[48:51], a[156:159], v[80:83]
s_waitcnt vmcnt(4)
ds_read_b64_tr_b16 a[160:161], v17 offset:0
ds_read_b64_tr_b16 a[162:163], v17 offset:256
ds_read_b64_tr_b16 a[164:165], v17 offset:32
ds_read_b64_tr_b16 a[166:167], v17 offset:288
ds_read_b64_tr_b16 a[168:169], v17 offset:2048
ds_read_b64_tr_b16 a[170:171], v17 offset:2304
ds_read_b64_tr_b16 a[172:173], v17 offset:2080
ds_read_b64_tr_b16 a[174:175], v17 offset:2336
s_waitcnt lgkmcnt(0)
s_mov_b32 s44, 6291456
buffer_load_dword v250, v12, s[4:7], s44 offen
s_add_u32 m0, s45, 0
s_mov_b32 s44, 6291456
buffer_load_dwordx4 v16, s[4:7], s44 offen lds
s_add_u32 m0, s45, 1024
s_mov_b32 s44, 6422528
buffer_load_dwordx4 v16, s[4:7], s44 offen lds
s_add_u32 m0, s45, 2048
s_mov_b32 s44, 6553600
buffer_load_dwordx4 v16, s[4:7], s44 offen lds
s_add_u32 m0, s45, 3072
s_mov_b32 s44, 6684672
buffer_load_dwordx4 v16, s[4:7], s44 offen lds
ds_read_b128 v[20:23], v8 offset:40960
ds_read_b128 v[24:27], v8 offset:43008
ds_read_b128 v[28:31], v9 offset:40960
ds_read_b128 v[32:35], v9 offset:43008
ds_read_b128 v[36:39], v10 offset:40960
ds_read_b128 v[40:43], v10 offset:43008
ds_read_b128 v[44:47], v11 offset:40960
ds_read_b128 v[48:51], v11 offset:43008
s_waitcnt lgkmcnt(0)
v_mfma_f32_16x16x32_bf16 v[52:55], v[20:23], a[160:163], v[52:55]
v_mfma_f32_16x16x32_bf16 v[56:59], v[20:23], a[164:167], v[56:59]
v_mfma_f32_16x16x32_bf16 v[60:63], v[24:27], a[160:163], v[60:63]
v_mfma_f32_16x16x32_bf16 v[64:67], v[24:27], a[164:167], v[64:67]
v_mfma_f32_16x16x32_bf16 v[52:55], v[28:31], a[168:171], v[52:55]
v_mfma_f32_16x16x32_bf16 v[56:59], v[28:31], a[172:175], v[56:59]
v_mfma_f32_16x16x32_bf16 v[60:63], v[32:35], a[168:171], v[60:63]
v_mfma_f32_16x16x32_bf16 v[64:67], v[32:35], a[172:175], v[64:67]
v_mfma_f32_16x16x32_bf16 v[68:71], v[36:39], a[160:163], v[68:71]
v_mfma_f32_16x16x32_bf16 v[72:75], v[36:39], a[164:167], v[72:75]
v_mfma_f32_16x16x32_bf16 v[76:79], v[40:43], a[160:163], v[76:79]
v_mfma_f32_16x16x32_bf16 v[80:83], v[40:43], a[164:167], v[80:83]
v_mfma_f32_16x16x32_bf16 v[68:71], v[44:47], a[168:171], v[68:71]
v_mfma_f32_16x16x32_bf16 v[72:75], v[44:47], a[172:175], v[72:75]
v_mfma_f32_16x16x32_bf16 v[76:79], v[48:51], a[168:171], v[76:79]
v_mfma_f32_16x16x32_bf16 v[80:83], v[48:51], a[172:175], v[80:83]
s_waitcnt vmcnt(5)
ds_read_b64_tr_b16 a[176:177], v17 offset:4096
ds_read_b64_tr_b16 a[178:179], v17 offset:4352
ds_read_b64_tr_b16 a[180:181], v17 offset:4128
ds_read_b64_tr_b16 a[182:183], v17 offset:4384
ds_read_b64_tr_b16 a[184:185], v17 offset:6144
ds_read_b64_tr_b16 a[186:187], v17 offset:6400
ds_read_b64_tr_b16 a[188:189], v17 offset:6176
ds_read_b64_tr_b16 a[190:191], v17 offset:6432
s_waitcnt lgkmcnt(0)
s_add_u32 m0, s45, 4096
s_mov_b32 s44, 6815744
buffer_load_dwordx4 v16, s[4:7], s44 offen lds
s_add_u32 m0, s45, 5120
s_mov_b32 s44, 6946816
buffer_load_dwordx4 v16, s[4:7], s44 offen lds
s_add_u32 m0, s45, 6144
s_mov_b32 s44, 7077888
buffer_load_dwordx4 v16, s[4:7], s44 offen lds
s_add_u32 m0, s45, 7168
s_mov_b32 s44, 7208960
buffer_load_dwordx4 v16, s[4:7], s44 offen lds
ds_read_b128 v[20:23], v8 offset:45056
ds_read_b128 v[24:27], v8 offset:47104
ds_read_b128 v[28:31], v9 offset:45056
ds_read_b128 v[32:35], v9 offset:47104
ds_read_b128 v[36:39], v10 offset:45056
ds_read_b128 v[40:43], v10 offset:47104
ds_read_b128 v[44:47], v11 offset:45056
ds_read_b128 v[48:51], v11 offset:47104
s_waitcnt lgkmcnt(0)
v_mfma_f32_16x16x32_bf16 v[52:55], v[20:23], a[176:179], v[52:55]
v_mfma_f32_16x16x32_bf16 v[56:59], v[20:23], a[180:183], v[56:59]
v_mfma_f32_16x16x32_bf16 v[60:63], v[24:27], a[176:179], v[60:63]
v_mfma_f32_16x16x32_bf16 v[64:67], v[24:27], a[180:183], v[64:67]
v_mfma_f32_16x16x32_bf16 v[52:55], v[28:31], a[184:187], v[52:55]
v_mfma_f32_16x16x32_bf16 v[56:59], v[28:31], a[188:191], v[56:59]
v_mfma_f32_16x16x32_bf16 v[60:63], v[32:35], a[184:187], v[60:63]
v_mfma_f32_16x16x32_bf16 v[64:67], v[32:35], a[188:191], v[64:67]
v_mfma_f32_16x16x32_bf16 v[68:71], v[36:39], a[176:179], v[68:71]
v_mfma_f32_16x16x32_bf16 v[72:75], v[36:39], a[180:183], v[72:75]
v_mfma_f32_16x16x32_bf16 v[76:79], v[40:43], a[176:179], v[76:79]
v_mfma_f32_16x16x32_bf16 v[80:83], v[40:43], a[180:183], v[80:83]
v_mfma_f32_16x16x32_bf16 v[68:71], v[44:47], a[184:187], v[68:71]
v_mfma_f32_16x16x32_bf16 v[72:75], v[44:47], a[188:191], v[72:75]
v_mfma_f32_16x16x32_bf16 v[76:79], v[48:51], a[184:187], v[76:79]
v_mfma_f32_16x16x32_bf16 v[80:83], v[48:51], a[188:191], v[80:83]
s_waitcnt vmcnt(4)
ds_read_b64_tr_b16 a[192:193], v17 offset:0
ds_read_b64_tr_b16 a[194:195], v17 offset:256
ds_read_b64_tr_b16 a[196:197], v17 offset:32
ds_read_b64_tr_b16 a[198:199], v17 offset:288
ds_read_b64_tr_b16 a[200:201], v17 offset:2048
ds_read_b64_tr_b16 a[202:203], v17 offset:2304
ds_read_b64_tr_b16 a[204:205], v17 offset:2080
ds_read_b64_tr_b16 a[206:207], v17 offset:2336
s_waitcnt lgkmcnt(0)
s_mov_b32 s44, 7340032
buffer_load_dword v250, v12, s[4:7], s44 offen
s_add_u32 m0, s45, 0
s_mov_b32 s44, 7340032
buffer_load_dwordx4 v16, s[4:7], s44 offen lds
s_add_u32 m0, s45, 1024
s_mov_b32 s44, 7471104
buffer_load_dwordx4 v16, s[4:7], s44 offen lds
s_add_u32 m0, s45, 2048
s_mov_b32 s44, 7602176
buffer_load_dwordx4 v16, s[4:7], s44 offen lds
s_add_u32 m0, s45, 3072
s_mov_b32 s44, 7733248
buffer_load_dwordx4 v16, s[4:7], s44 offen lds
ds_read_b128 v[20:23], v8 offset:49152
ds_read_b128 v[24:27], v8 offset:51200
ds_read_b128 v[28:31], v9 offset:49152
ds_read_b128 v[32:35], v9 offset:51200
ds_read_b128 v[36:39], v10 offset:49152
ds_read_b128 v[40:43], v10 offset:51200
ds_read_b128 v[44:47], v11 offset:49152
ds_read_b128 v[48:51], v11 offset:51200
s_waitcnt lgkmcnt(0)
v_mfma_f32_16x16x32_bf16 v[52:55], v[20:23], a[192:195], v[52:55]
v_mfma_f32_16x16x32_bf16 v[56:59], v[20:23], a[196:199], v[56:59]
v_mfma_f32_16x16x32_bf16 v[60:63], v[24:27], a[192:195], v[60:63]
v_mfma_f32_16x16x32_bf16 v[64:67], v[24:27], a[196:199], v[64:67]
v_mfma_f32_16x16x32_bf16 v[52:55], v[28:31], a[200:203], v[52:55]
v_mfma_f32_16x16x32_bf16 v[56:59], v[28:31], a[204:207], v[56:59]
v_mfma_f32_16x16x32_bf16 v[60:63], v[32:35], a[200:203], v[60:63]
v_mfma_f32_16x16x32_bf16 v[64:67], v[32:35], a[204:207], v[64:67]
v_mfma_f32_16x16x32_bf16 v[68:71], v[36:39], a[192:195], v[68:71]
v_mfma_f32_16x16x32_bf16 v[72:75], v[36:39], a[196:199], v[72:75]
v_mfma_f32_16x16x32_bf16 v[76:79], v[40:43], a[192:195], v[76:79]
v_mfma_f32_16x16x32_bf16 v[80:83], v[40:43], a[196:199], v[80:83]
v_mfma_f32_16x16x32_bf16 v[68:71], v[44:47], a[200:203], v[68:71]
v_mfma_f32_16x16x32_bf16 v[72:75], v[44:47], a[204:207], v[72:75]
v_mfma_f32_16x16x32_bf16 v[76:79], v[48:51], a[200:203], v[76:79]
v_mfma_f32_16x16x32_bf16 v[80:83], v[48:51], a[204:207], v[80:83]
s_waitcnt vmcnt(5)
ds_read_b64_tr_b16 a[208:209], v17 offset:4096
ds_read_b64_tr_b16 a[210:211], v17 offset:4352
ds_read_b64_tr_b16 a[212:213], v17 offset:4128
ds_read_b64_tr_b16 a[214:215], v17 offset:4384
ds_read_b64_tr_b16 a[216:217], v17 offset:6144
ds_read_b64_tr_b16 a[218:219], v17 offset:6400
ds_read_b64_tr_b16 a[220:221], v17 offset:6176
ds_read_b64_tr_b16 a[222:223], v17 offset:6432
s_waitcnt lgkmcnt(0)
v_and_b32 v247, 15, v0
v_lshlrev_b32 v247, 4, v247
buffer_load_dword v246, v247, s[72:75], 0 offen sc1
s_add_u32 m0, s45, 4096
s_mov_b32 s44, 7864320
buffer_load_dwordx4 v16, s[4:7], s44 offen lds
s_add_u32 m0, s45, 5120
s_mov_b32 s44, 7995392
buffer_load_dwordx4 v16, s[4:7], s44 offen lds
s_add_u32 m0, s45, 6144
s_mov_b32 s44, 8126464
buffer_load_dwordx4 v16, s[4:7], s44 offen lds
s_add_u32 m0, s45, 7168
s_mov_b32 s44, 8257536
buffer_load_dwordx4 v16, s[4:7], s44 offen lds
ds_read_b128 v[20:23], v8 offset:53248
ds_read_b128 v[24:27], v8 offset:55296
ds_read_b128 v[28:31], v9 offset:53248
ds_read_b128 v[32:35], v9 offset:55296
ds_read_b128 v[36:39], v10 offset:53248
ds_read_b128 v[40:43], v10 offset:55296
ds_read_b128 v[44:47], v11 offset:53248
ds_read_b128 v[48:51], v11 offset:55296
s_waitcnt lgkmcnt(0)
v_mfma_f32_16x16x32_bf16 v[52:55], v[20:23], a[208:211], v[52:55]
v_mfma_f32_16x16x32_bf16 v[56:59], v[20:23], a[212:215], v[56:59]
v_mfma_f32_16x16x32_bf16 v[60:63], v[24:27], a[208:211], v[60:63]
v_mfma_f32_16x16x32_bf16 v[64:67], v[24:27], a[212:215], v[64:67]
v_mfma_f32_16x16x32_bf16 v[52:55], v[28:31], a[216:219], v[52:55]
v_mfma_f32_16x16x32_bf16 v[56:59], v[28:31], a[220:223], v[56:59]
v_mfma_f32_16x16x32_bf16 v[60:63], v[32:35], a[216:219], v[60:63]
v_mfma_f32_16x16x32_bf16 v[64:67], v[32:35], a[220:223], v[64:67]
v_mfma_f32_16x16x32_bf16 v[68:71], v[36:39], a[208:211], v[68:71]
v_mfma_f32_16x16x32_bf16 v[72:75], v[36:39], a[212:215], v[72:75]
v_mfma_f32_16x16x32_bf16 v[76:79], v[40:43], a[208:211], v[76:79]
v_mfma_f32_16x16x32_bf16 v[80:83], v[40:43], a[212:215], v[80:83]
v_mfma_f32_16x16x32_bf16 v[68:71], v[44:47], a[216:219], v[68:71]
v_mfma_f32_16x16x32_bf16 v[72:75], v[44:47], a[220:223], v[72:75]
v_mfma_f32_16x16x32_bf16 v[76:79], v[48:51], a[216:219], v[76:79]
v_mfma_f32_16x16x32_bf16 v[80:83], v[48:51], a[220:223], v[80:83]
s_waitcnt vmcnt(4)
ds_read_b64_tr_b16 a[224:225], v17 offset:0
ds_read_b64_tr_b16 a[226:227], v17 offset:256
ds_read_b64_tr_b16 a[228:229], v17 offset:32
ds_read_b64_tr_b16 a[230:231], v17 offset:288
ds_read_b64_tr_b16 a[232:233], v17 offset:2048
ds_read_b64_tr_b16 a[234:235], v17 offset:2304
ds_read_b64_tr_b16 a[236:237], v17 offset:2080
ds_read_b64_tr_b16 a[238:239], v17 offset:2336
s_waitcnt lgkmcnt(0)
ds_read_b128 v[20:23], v8 offset:57344
ds_read_b128 v[24:27], v8 offset:59392
ds_read_b128 v[28:31], v9 offset:57344
ds_read_b128 v[32:35], v9 offset:59392
ds_read_b128 v[36:39], v10 offset:57344
ds_read_b128 v[40:43], v10 offset:59392
ds_read_b128 v[44:47], v11 offset:57344
ds_read_b128 v[48:51], v11 offset:59392
s_waitcnt lgkmcnt(0)
v_mfma_f32_16x16x32_bf16 v[52:55], v[20:23], a[224:227], v[52:55]
v_mfma_f32_16x16x32_bf16 v[56:59], v[20:23], a[228:231], v[56:59]
v_mfma_f32_16x16x32_bf16 v[60:63], v[24:27], a[224:227], v[60:63]
v_mfma_f32_16x16x32_bf16 v[64:67], v[24:27], a[228:231], v[64:67]
v_mfma_f32_16x16x32_bf16 v[52:55], v[28:31], a[232:235], v[52:55]
v_mfma_f32_16x16x32_bf16 v[56:59], v[28:31], a[236:239], v[56:59]
v_mfma_f32_16x16x32_bf16 v[60:63], v[32:35], a[232:235], v[60:63]
v_mfma_f32_16x16x32_bf16 v[64:67], v[32:35], a[236:239], v[64:67]
v_mfma_f32_16x16x32_bf16 v[68:71], v[36:39], a[224:227], v[68:71]
v_mfma_f32_16x16x32_bf16 v[72:75], v[36:39], a[228:231], v[72:75]
v_mfma_f32_16x16x32_bf16 v[76:79], v[40:43], a[224:227], v[76:79]
v_mfma_f32_16x16x32_bf16 v[80:83], v[40:43], a[228:231], v[80:83]
v_mfma_f32_16x16x32_bf16 v[68:71], v[44:47], a[232:235], v[68:71]
v_mfma_f32_16x16x32_bf16 v[72:75], v[44:47], a[236:239], v[72:75]
v_mfma_f32_16x16x32_bf16 v[76:79], v[48:51], a[232:235], v[76:79]
v_mfma_f32_16x16x32_bf16 v[80:83], v[48:51], a[236:239], v[80:83]
s_waitcnt vmcnt(0)
ds_read_b64_tr_b16 a[240:241], v17 offset:4096
ds_read_b64_tr_b16 a[242:243], v17 offset:4352
ds_read_b64_tr_b16 a[244:245], v17 offset:4128
ds_read_b64_tr_b16 a[246:247], v17 offset:4384
ds_read_b64_tr_b16 a[248:249], v17 offset:6144
ds_read_b64_tr_b16 a[250:251], v17 offset:6400
ds_read_b64_tr_b16 a[252:253], v17 offset:6176
ds_read_b64_tr_b16 a[254:255], v17 offset:6432
s_waitcnt lgkmcnt(0)
ds_read_b128 v[20:23], v8 offset:61440
ds_read_b128 v[24:27], v8 offset:63488
ds_read_b128 v[28:31], v9 offset:61440
ds_read_b128 v[32:35], v9 offset:63488
ds_read_b128 v[36:39], v10 offset:61440
ds_read_b128 v[40:43], v10 offset:63488
ds_read_b128 v[44:47], v11 offset:61440
ds_read_b128 v[48:51], v11 offset:63488
s_waitcnt lgkmcnt(0)
v_mfma_f32_16x16x32_bf16 v[52:55], v[20:23], a[240:243], v[52:55]
v_mfma_f32_16x16x32_bf16 v[56:59], v[20:23], a[244:247], v[56:59]
v_mfma_f32_16x16x32_bf16 v[60:63], v[24:27], a[240:243], v[60:63]
v_mfma_f32_16x16x32_bf16 v[64:67], v[24:27], a[244:247], v[64:67]
v_mfma_f32_16x16x32_bf16 v[52:55], v[28:31], a[248:251], v[52:55]
v_mfma_f32_16x16x32_bf16 v[56:59], v[28:31], a[252:255], v[56:59]
v_mfma_f32_16x16x32_bf16 v[60:63], v[32:35], a[248:251], v[60:63]
v_mfma_f32_16x16x32_bf16 v[64:67], v[32:35], a[252:255], v[64:67]
v_mfma_f32_16x16x32_bf16 v[68:71], v[36:39], a[240:243], v[68:71]
v_mfma_f32_16x16x32_bf16 v[72:75], v[36:39], a[244:247], v[72:75]
v_mfma_f32_16x16x32_bf16 v[76:79], v[40:43], a[240:243], v[76:79]
v_mfma_f32_16x16x32_bf16 v[80:83], v[40:43], a[244:247], v[80:83]
v_mfma_f32_16x16x32_bf16 v[68:71], v[44:47], a[248:251], v[68:71]
v_mfma_f32_16x16x32_bf16 v[72:75], v[44:47], a[252:255], v[72:75]
v_mfma_f32_16x16x32_bf16 v[76:79], v[48:51], a[248:251], v[76:79]
v_mfma_f32_16x16x32_bf16 v[80:83], v[48:51], a[252:255], v[80:83]
s_and_b32 s53, s47, 31
s_lshl_b32 s53, s53, 4
v_add_u32 v19, s53, v1
v_lshlrev_b32 v19, 7, v19
s_mov_b32 s42, 1
v_and_b32 v247, 15, v0
v_lshlrev_b32 v247, 4, v247
s_branch mega_kernel_syvp
mega_kernel_syvw:
s_sleep 4
mega_kernel_syv:
buffer_load_dword v246, v247, s[72:75], 0 offen sc1
s_waitcnt vmcnt(0)
mega_kernel_syvp:
s_cmp_eq_u32 s95, 1
s_cbranch_scc0 mega_kernel_syvf
v_readlane_b32 s76, v246, 14
s_mov_b32 s98, 0
s_cmp_eq_u32 s76, 64
s_cbranch_scc0 mega_kernel_syvw
s_branch mega_kernel_syvd
mega_kernel_syvf:
s_mov_b32 s77, 0
s_mov_b32 s78, 0
v_readlane_b32 s76, v246, 0
s_add_u32 s77, s77, s76
s_xor_b32 s76, s76, 32
s_or_b32 s78, s78, s76
v_readlane_b32 s76, v246, 1
s_add_u32 s77, s77, s76
s_xor_b32 s76, s76, 32
s_or_b32 s78, s78, s76
v_readlane_b32 s76, v246, 2
s_add_u32 s77, s77, s76
s_xor_b32 s76, s76, 32
s_or_b32 s78, s78, s76
v_readlane_b32 s76, v246, 3
s_add_u32 s77, s77, s76
s_xor_b32 s76, s76, 32
s_or_b32 s78, s78, s76
v_readlane_b32 s76, v246, 4
s_add_u32 s77, s77, s76
s_xor_b32 s76, s76, 32
s_or_b32 s78, s78, s76
v_readlane_b32 s76, v246, 5
s_add_u32 s77, s77, s76
s_xor_b32 s76, s76, 32
s_or_b32 s78, s78, s76
v_readlane_b32 s76, v246, 6
s_add_u32 s77, s77, s76
s_xor_b32 s76, s76, 32
s_or_b32 s78, s78, s76
v_readlane_b32 s76, v246, 7
s_add_u32 s77, s77, s76
s_xor_b32 s76, s76, 32
s_or_b32 s78, s78, s76
s_cmp_eq_u32 s77, 256
s_cbranch_scc0 mega_kernel_syvw
v_mov_b32 v252, v246
s_cmp_eq_u32 s78, 0
s_cbranch_scc0 mega_kernel_slowent
v_readlane_b32 s76, v246, 10
v_readlane_b32 s77, v246, 8
s_cmp_eq_u32 s76, 64
s_cbranch_scc0 mega_kernel_syvw
s_cmp_gt_u32 s77, 32
s_cselect_b32 s98, 1, 0
mega_kernel_syvd:
s_lshr_b32 s44, s47, 3
s_xor_b32 s44, s44, s98
s_and_b32 s44, s44, 1
s_lshl_b32 s44, s44, 13
s_lshl_b32 s48, s47, 18
s_add_u32 s48, s48, s44
s_add_u32 s48, s48, 33554432
s_xor_b32 s44, s98, 1
s_lshl_b32 s44, s44, 13
s_lshl_b32 s49, s40, 7
s_add_u32 s49, s49, s44
s_lshl_b32 s44, s41, 2
s_add_u32 s49, s49, s44
s_add_u32 s49, s49, 69210112
v_mov_b32 v16, 0
v_cvt_pk_bf16_f32 v84, v52, v53
v_cvt_pk_bf16_f32 v85, v54, v55
v_cvt_pk_bf16_f32 v86, v60, v61
v_cvt_pk_bf16_f32 v87, v62, v63
v_cvt_pk_bf16_f32 v88, v56, v57
v_cvt_pk_bf16_f32 v89, v58, v59
v_cvt_pk_bf16_f32 v90, v64, v65
v_cvt_pk_bf16_f32 v91, v66, v67
s_add_u32 s51, s42, s47
s_sub_u32 s51, s51, 1
s_bfe_u32 s52, s51, 0x40002
s_lshl_b32 s52, s52, 14
s_and_b32 s51, s51, 3
s_lshl_b32 s51, s51, 11
s_add_u32 s51, s51, s52
s_add_u32 s51, s51, s48
buffer_store_dwordx4 v[84:87], v7, s[84:87], s51 offen sc1
buffer_store_dwordx4 v[88:91], v7, s[84:87], s51 offen offset:1024 sc1
s_mov_b32 s42, 2
s_nop 1
v_cvt_pk_bf16_f32 v84, v68, v69
v_cvt_pk_bf16_f32 v85, v70, v71
v_cvt_pk_bf16_f32 v86, v76, v77
v_cvt_pk_bf16_f32 v87, v78, v79
v_cvt_pk_bf16_f32 v88, v72, v73
v_cvt_pk_bf16_f32 v89, v74, v75
v_cvt_pk_bf16_f32 v90, v80, v81
v_cvt_pk_bf16_f32 v91, v82, v83
s_add_u32 s51, s42, s47
s_sub_u32 s51, s51, 1
s_bfe_u32 s52, s51, 0x40002
s_lshl_b32 s52, s52, 14
s_and_b32 s51, s51, 3
s_lshl_b32 s51, s51, 11
s_add_u32 s51, s51, s52
s_add_u32 s51, s51, s48
buffer_store_dwordx4 v[84:87], v7, s[84:87], s51 offen sc1
buffer_store_dwordx4 v[88:91], v7, s[84:87], s51 offen offset:1024 sc1
s_barrier
s_mov_b32 s50, 0x20000
s_add_u32 m0, s46, 0
s_nop 0
buffer_load_dwordx4 v6, s[8:11], s50 offen offset:0 lds
s_add_u32 m0, s46, 3968
s_nop 0
buffer_load_dwordx4 v6, s[8:11], s50 offen offset:128 lds
s_add_u32 m0, s46, 7936
s_nop 0
buffer_load_dwordx4 v6, s[8:11], s50 offen offset:256 lds
s_add_u32 m0, s46, 11904
s_nop 0
buffer_load_dwordx4 v6, s[8:11], s50 offen offset:384 lds
s_add_u32 m0, s46, 15872
s_nop 0
buffer_load_dwordx4 v6, s[8:11], s50 offen offset:512 lds
s_add_u32 m0, s46, 19840
s_nop 0
buffer_load_dwordx4 v6, s[8:11], s50 offen offset:640 lds
s_add_u32 m0, s46, 23808
s_nop 0
buffer_load_dwordx4 v6, s[8:11], s50 offen offset:768 lds
s_add_u32 m0, s46, 27776
s_nop 0
buffer_load_dwordx4 v6, s[8:11], s50 offen offset:896 lds
s_add_u32 m0, s46, 31744
s_nop 0
buffer_load_dwordx4 v6, s[8:11], s50 offen offset:1024 lds
s_add_u32 m0, s46, 35712
s_nop 0
buffer_load_dwordx4 v6, s[8:11], s50 offen offset:1152 lds
s_add_u32 m0, s46, 39680
s_nop 0
buffer_load_dwordx4 v6, s[8:11], s50 offen offset:1280 lds
s_add_u32 m0, s46, 43648
s_nop 0
buffer_load_dwordx4 v6, s[8:11], s50 offen offset:1408 lds
s_add_u32 m0, s46, 47616
s_nop 0
buffer_load_dwordx4 v6, s[8:11], s50 offen offset:1536 lds
s_add_u32 m0, s46, 51584
s_nop 0
buffer_load_dwordx4 v6, s[8:11], s50 offen offset:1664 lds
s_add_u32 m0, s46, 55552
s_nop 0
buffer_load_dwordx4 v6, s[8:11], s50 offen offset:1792 lds
s_add_u32 m0, s46, 59520
s_nop 0
buffer_load_dwordx4 v6, s[8:11], s50 offen offset:1920 lds
s_waitcnt vmcnt(16)
v_mov_b32 v17, s42
s_mov_b64 exec, 1
buffer_store_dword v17, v16, s[84:87], s49 offen sc1
s_mov_b64 exec, -1
s_waitcnt vmcnt(1)
s_branch mega_kernel_v_mid
mega_kernel_v_loop:
s_waitcnt vmcnt(2)
s_barrier
s_add_u32 s50, s42, 1
s_min_u32 s50, s50, 63
s_lshl_b32 s50, s50, 16
ds_read_b128 v[20:23], v10 offset:0
ds_read_b128 v[24:27], v10 offset:2048
ds_read_b128 v[28:31], v11 offset:0
ds_read_b128 v[32:35], v11 offset:2048
ds_read_b128 v[36:39], v10 offset:4096
ds_read_b128 v[40:43], v10 offset:6144
s_waitcnt lgkmcnt(4)
v_mfma_f32_16x16x32_bf16 v[68:71], v[20:23], a[0:3], 0
ds_read_b128 v[44:47], v11 offset:4096
v_mfma_f32_16x16x32_bf16 v[72:75], v[20:23], a[4:7], 0
v_cvt_pk_bf16_f32 v84, v52, v53
v_cvt_pk_bf16_f32 v85, v54, v55
v_cvt_pk_bf16_f32 v86, v60, v61
v_mfma_f32_16x16x32_bf16 v[76:79], v[24:27], a[0:3], 0
ds_read_b128 v[48:51], v11 offset:6144
v_mfma_f32_16x16x32_bf16 v[80:83], v[24:27], a[4:7], 0
v_cvt_pk_bf16_f32 v87, v62, v63
v_cvt_pk_bf16_f32 v88, v56, v57
v_cvt_pk_bf16_f32 v89, v58, v59
s_waitcnt lgkmcnt(4)
v_mfma_f32_16x16x32_bf16 v[68:71], v[28:31], a[8:11], v[68:71]
ds_read_b128 v[20:23], v10 offset:8192
v_mfma_f32_16x16x32_bf16 v[72:75], v[28:31], a[12:15], v[72:75]
v_cvt_pk_bf16_f32 v90, v64, v65
v_cvt_pk_bf16_f32 v91, v66, v67
v_mfma_f32_16x16x32_bf16 v[76:79], v[32:35], a[8:11], v[76:79]
ds_read_b128 v[24:27], v10 offset:10240
v_mfma_f32_16x16x32_bf16 v[80:83], v[32:35], a[12:15], v[80:83]
s_add_u32 s51, s42, s47
s_sub_u32 s51, s51, 1
s_bfe_u32 s52, s51, 0x40002
s_lshl_b32 s52, s52, 14
s_waitcnt lgkmcnt(4)
v_mfma_f32_16x16x32_bf16 v[68:71], v[36:39], a[16:19], v[68:71]
ds_read_b128 v[28:31], v11 offset:8192
v_mfma_f32_16x16x32_bf16 v[72:75], v[36:39], a[20:23], v[72:75]
s_and_b32 s51, s51, 3
s_lshl_b32 s51, s51, 11
s_add_u32 s51, s51, s52
s_add_u32 s51, s51, s48
buffer_store_dwordx4 v[84:87], v7, s[84:87], s51 offen sc1
v_mfma_f32_16x16x32_bf16 v[76:79], v[40:43], a[16:19], v[76:79]
ds_read_b128 v[32:35], v11 offset:10240
v_mfma_f32_16x16x32_bf16 v[80:83], v[40:43], a[20:23], v[80:83]
buffer_store_dwordx4 v[88:91], v7, s[84:87], s51 offen offset:1024 sc1
s_waitcnt lgkmcnt(4)
v_mfma_f32_16x16x32_bf16 v[68:71], v[44:47], a[24:27], v[68:71]
ds_read_b128 v[36:39], v10 offset:12288
v_mfma_f32_16x16x32_bf16 v[72:75], v[44:47], a[28:31], v[72:75]
s_add_u32 m0, s46, 0
v_mfma_f32_16x16x32_bf16 v[76:79], v[48:51], a[24:27], v[76:79]
ds_read_b128 v[40:43], v10 offset:14336
v_mfma_f32_16x16x32_bf16 v[80:83], v[48:51], a[28:31], v[80:83]
buffer_load_dwordx4 v6, s[8:11], s50 offen offset:0 lds
s_waitcnt lgkmcnt(4)
v_mfma_f32_16x16x32_bf16 v[68:71], v[20:23], a[32:35], v[68:71]
ds_read_b128 v[44:47], v11 offset:12288
v_mfma_f32_16x16x32_bf16 v[72:75], v[20:23], a[36:39], v[72:75]
s_add_u32 m0, s46, 3968
v_mfma_f32_16x16x32_bf16 v[76:79], v[24:27], a[32:35], v[76:79]
ds_read_b128 v[48:51], v11 offset:14336
v_mfma_f32_16x16x32_bf16 v[80:83], v[24:27], a[36:39], v[80:83]
buffer_load_dwordx4 v6, s[8:11], s50 offen offset:128 lds
s_waitcnt lgkmcnt(4)
v_mfma_f32_16x16x32_bf16 v[68:71], v[28:31], a[40:43], v[68:71]
ds_read_b128 v[20:23], v10 offset:16384
v_mfma_f32_16x16x32_bf16 v[72:75], v[28:31], a[44:47], v[72:75]
s_add_u32 m0, s46, 7936
v_mfma_f32_16x16x32_bf16 v[76:79], v[32:35], a[40:43], v[76:79]
ds_read_b128 v[24:27], v10 offset:18432
v_mfma_f32_16x16x32_bf16 v[80:83], v[32:35], a[44:47], v[80:83]
buffer_load_dwordx4 v6, s[8:11], s50 offen offset:256 lds
s_waitcnt lgkmcnt(4)
v_mfma_f32_16x16x32_bf16 v[68:71], v[36:39], a[48:51], v[68:71]
ds_read_b128 v[28:31], v11 offset:16384
v_mfma_f32_16x16x32_bf16 v[72:75], v[36:39], a[52:55], v[72:75]
s_add_u32 m0, s46, 11904
v_mfma_f32_16x16x32_bf16 v[76:79], v[40:43], a[48:51], v[76:79]
ds_read_b128 v[32:35], v11 offset:18432
v_mfma_f32_16x16x32_bf16 v[80:83], v[40:43], a[52:55], v[80:83]
buffer_load_dwordx4 v6, s[8:11], s50 offen offset:384 lds
s_waitcnt lgkmcnt(4)
v_mfma_f32_16x16x32_bf16 v[68:71], v[44:47], a[56:59], v[68:71]
ds_read_b128 v[36:39], v10 offset:20480
v_mfma_f32_16x16x32_bf16 v[72:75], v[44:47], a[60:63], v[72:75]
s_add_u32 m0, s46, 15872
v_mfma_f32_16x16x32_bf16 v[76:79], v[48:51], a[56:59], v[76:79]
ds_read_b128 v[40:43], v10 offset:22528
v_mfma_f32_16x16x32_bf16 v[80:83], v[48:51], a[60:63], v[80:83]
buffer_load_dwordx4 v6, s[8:11], s50 offen offset:512 lds
s_waitcnt lgkmcnt(4)
v_mfma_f32_16x16x32_bf16 v[68:71], v[20:23], a[64:67], v[68:71]
ds_read_b128 v[44:47], v11 offset:20480
v_mfma_f32_16x16x32_bf16 v[72:75], v[20:23], a[68:71], v[72:75]
s_add_u32 m0, s46, 19840
v_mfma_f32_16x16x32_bf16 v[76:79], v[24:27], a[64:67], v[76:79]
ds_read_b128 v[48:51], v11 offset:22528
v_mfma_f32_16x16x32_bf16 v[80:83], v[24:27], a[68:71], v[80:83]
buffer_load_dwordx4 v6, s[8:11], s50 offen offset:640 lds
s_waitcnt lgkmcnt(4)
v_mfma_f32_16x16x32_bf16 v[68:71], v[28:31], a[72:75], v[68:71]
ds_read_b128 v[20:23], v10 offset:24576
v_mfma_f32_16x16x32_bf16 v[72:75], v[28:31], a[76:79], v[72:75]
s_add_u32 m0, s46, 23808
v_mfma_f32_16x16x32_bf16 v[76:79], v[32:35], a[72:75], v[76:79]
ds_read_b128 v[24:27], v10 offset:26624
v_mfma_f32_16x16x32_bf16 v[80:83], v[32:35], a[76:79], v[80:83]
buffer_load_dwordx4 v6, s[8:11], s50 offen offset:768 lds
s_waitcnt lgkmcnt(4)
v_mfma_f32_16x16x32_bf16 v[68:71], v[36:39], a[80:83], v[68:71]
ds_read_b128 v[28:31], v11 offset:24576
v_mfma_f32_16x16x32_bf16 v[72:75], v[36:39], a[84:87], v[72:75]
s_add_u32 m0, s46, 27776
v_mfma_f32_16x16x32_bf16 v[76:79], v[40:43], a[80:83], v[76:79]
ds_read_b128 v[32:35], v11 offset:26624
v_mfma_f32_16x16x32_bf16 v[80:83], v[40:43], a[84:87], v[80:83]
buffer_load_dwordx4 v6, s[8:11], s50 offen offset:896 lds
s_waitcnt lgkmcnt(4)
v_mfma_f32_16x16x32_bf16 v[68:71], v[44:47], a[88:91], v[68:71]
ds_read_b128 v[36:39], v10 offset:28672
v_mfma_f32_16x16x32_bf16 v[72:75], v[44:47], a[92:95], v[72:75]
s_add_u32 m0, s46, 31744
v_mfma_f32_16x16x32_bf16 v[76:79], v[48:51], a[88:91], v[76:79]
ds_read_b128 v[40:43], v10 offset:30720
v_mfma_f32_16x16x32_bf16 v[80:83], v[48:51], a[92:95], v[80:83]
buffer_load_dwordx4 v6, s[8:11], s50 offen offset:1024 lds
s_waitcnt lgkmcnt(4)
v_mfma_f32_16x16x32_bf16 v[68:71], v[20:23], a[96:99], v[68:71]
ds_read_b128 v[44:47], v11 offset:28672
v_mfma_f32_16x16x32_bf16 v[72:75], v[20:23], a[100:103], v[72:75]
s_add_u32 m0, s46, 35712
v_mfma_f32_16x16x32_bf16 v[76:79], v[24:27], a[96:99], v[76:79]
ds_read_b128 v[48:51], v11 offset:30720
v_mfma_f32_16x16x32_bf16 v[80:83], v[24:27], a[100:103], v[80:83]
buffer_load_dwordx4 v6, s[8:11], s50 offen offset:1152 lds
s_waitcnt lgkmcnt(4)
v_mfma_f32_16x16x32_bf16 v[68:71], v[28:31], a[104:107], v[68:71]
ds_read_b128 v[20:23], v10 offset:32768
v_mfma_f32_16x16x32_bf16 v[72:75], v[28:31], a[108:111], v[72:75]
s_add_u32 m0, s46, 39680
v_mfma_f32_16x16x32_bf16 v[76:79], v[32:35], a[104:107], v[76:79]
ds_read_b128 v[24:27], v10 offset:34816
v_mfma_f32_16x16x32_bf16 v[80:83], v[32:35], a[108:111], v[80:83]
buffer_load_dwordx4 v6, s[8:11], s50 offen offset:1280 lds
s_waitcnt lgkmcnt(4)
v_mfma_f32_16x16x32_bf16 v[68:71], v[36:39], a[112:115], v[68:71]
ds_read_b128 v[28:31], v11 offset:32768
v_mfma_f32_16x16x32_bf16 v[72:75], v[36:39], a[116:119], v[72:75]
s_add_u32 m0, s46, 43648
v_mfma_f32_16x16x32_bf16 v[76:79], v[40:43], a[112:115], v[76:79]
ds_read_b128 v[32:35], v11 offset:34816
v_mfma_f32_16x16x32_bf16 v[80:83], v[40:43], a[116:119], v[80:83]
buffer_load_dwordx4 v6, s[8:11], s50 offen offset:1408 lds
s_waitcnt lgkmcnt(4)
v_mfma_f32_16x16x32_bf16 v[68:71], v[44:47], a[120:123], v[68:71]
ds_read_b128 v[36:39], v10 offset:36864
v_mfma_f32_16x16x32_bf16 v[72:75], v[44:47], a[124:127], v[72:75]
s_add_u32 m0, s46, 47616
v_mfma_f32_16x16x32_bf16 v[76:79], v[48:51], a[120:123], v[76:79]
ds_read_b128 v[40:43], v10 offset:38912
v_mfma_f32_16x16x32_bf16 v[80:83], v[48:51], a[124:127], v[80:83]
buffer_load_dwordx4 v6, s[8:11], s50 offen offset:1536 lds
s_waitcnt lgkmcnt(4)
v_mfma_f32_16x16x32_bf16 v[68:71], v[20:23], a[128:131], v[68:71]
ds_read_b128 v[44:47], v11 offset:36864
v_mfma_f32_16x16x32_bf16 v[72:75], v[20:23], a[132:135], v[72:75]
s_add_u32 m0, s46, 51584
v_mfma_f32_16x16x32_bf16 v[76:79], v[24:27], a[128:131], v[76:79]
ds_read_b128 v[48:51], v11 offset:38912
v_mfma_f32_16x16x32_bf16 v[80:83], v[24:27], a[132:135], v[80:83]
buffer_load_dwordx4 v6, s[8:11], s50 offen offset:1664 lds
s_waitcnt lgkmcnt(4)
v_mfma_f32_16x16x32_bf16 v[68:71], v[28:31], a[136:139], v[68:71]
ds_read_b128 v[20:23], v10 offset:40960
v_mfma_f32_16x16x32_bf16 v[72:75], v[28:31], a[140:143], v[72:75]
s_add_u32 m0, s46, 55552
v_mfma_f32_16x16x32_bf16 v[76:79], v[32:35], a[136:139], v[76:79]
ds_read_b128 v[24:27], v10 offset:43008
v_mfma_f32_16x16x32_bf16 v[80:83], v[32:35], a[140:143], v[80:83]
buffer_load_dwordx4 v6, s[8:11], s50 offen offset:1792 lds
s_waitcnt lgkmcnt(4)
v_mfma_f32_16x16x32_bf16 v[68:71], v[36:39], a[144:147], v[68:71]
ds_read_b128 v[28:31], v11 offset:40960
v_mfma_f32_16x16x32_bf16 v[72:75], v[36:39], a[148:151], v[72:75]
s_add_u32 m0, s46, 59520
v_mfma_f32_16x16x32_bf16 v[76:79], v[40:43], a[144:147], v[76:79]
ds_read_b128 v[32:35], v11 offset:43008
v_mfma_f32_16x16x32_bf16 v[80:83], v[40:43], a[148:151], v[80:83]
buffer_load_dwordx4 v6, s[8:11], s50 offen offset:1920 lds
s_waitcnt lgkmcnt(4)
v_mfma_f32_16x16x32_bf16 v[68:71], v[44:47], a[152:155], v[68:71]
ds_read_b128 v[36:39], v10 offset:45056
v_mfma_f32_16x16x32_bf16 v[72:75], v[44:47], a[156:159], v[72:75]
v_mfma_f32_16x16x32_bf16 v[76:79], v[48:51], a[152:155], v[76:79]
ds_read_b128 v[40:43], v10 offset:47104
v_mfma_f32_16x16x32_bf16 v[80:83], v[48:51], a[156:159], v[80:83]
s_waitcnt lgkmcnt(4)
v_mfma_f32_16x16x32_bf16 v[68:71], v[20:23], a[160:163], v[68:71]
ds_read_b128 v[44:47], v11 offset:45056
v_mfma_f32_16x16x32_bf16 v[72:75], v[20:23], a[164:167], v[72:75]
v_mfma_f32_16x16x32_bf16 v[76:79], v[24:27], a[160:163], v[76:79]
ds_read_b128 v[48:51], v11 offset:47104
v_mfma_f32_16x16x32_bf16 v[80:83], v[24:27], a[164:167], v[80:83]
s_waitcnt lgkmcnt(4)
v_mfma_f32_16x16x32_bf16 v[68:71], v[28:31], a[168:171], v[68:71]
ds_read_b128 v[20:23], v10 offset:49152
v_mfma_f32_16x16x32_bf16 v[72:75], v[28:31], a[172:175], v[72:75]
s_waitcnt vmcnt(16)
v_mov_b32 v17, s42
s_mov_b64 exec, 1
buffer_store_dword v17, v16, s[84:87], s49 offen sc1
s_mov_b64 exec, -1
v_mfma_f32_16x16x32_bf16 v[76:79], v[32:35], a[168:171], v[76:79]
ds_read_b128 v[24:27], v10 offset:51200
v_mfma_f32_16x16x32_bf16 v[80:83], v[32:35], a[172:175], v[80:83]
s_waitcnt lgkmcnt(4)
v_mfma_f32_16x16x32_bf16 v[68:71], v[36:39], a[176:179], v[68:71]
ds_read_b128 v[28:31], v11 offset:49152
v_mfma_f32_16x16x32_bf16 v[72:75], v[36:39], a[180:183], v[72:75]
s_add_u32 s53, s42, 3
s_min_u32 s53, s53, 63
s_lshl_b32 s53, s53, 16
s_mov_b64 exec, 0xffff
buffer_load_dword v250, v19, s[8:11], s53 offen
s_mov_b64 exec, -1
v_mfma_f32_16x16x32_bf16 v[76:79], v[40:43], a[176:179], v[76:79]
ds_read_b128 v[32:35], v11 offset:51200
v_mfma_f32_16x16x32_bf16 v[80:83], v[40:43], a[180:183], v[80:83]
s_waitcnt lgkmcnt(4)
v_mfma_f32_16x16x32_bf16 v[68:71], v[44:47], a[184:187], v[68:71]
ds_read_b128 v[36:39], v10 offset:53248
v_mfma_f32_16x16x32_bf16 v[72:75], v[44:47], a[188:191], v[72:75]
v_mfma_f32_16x16x32_bf16 v[76:79], v[48:51], a[184:187], v[76:79]
ds_read_b128 v[40:43], v10 offset:55296
v_mfma_f32_16x16x32_bf16 v[80:83], v[48:51], a[188:191], v[80:83]
s_waitcnt lgkmcnt(4)
v_mfma_f32_16x16x32_bf16 v[68:71], v[20:23], a[192:195], v[68:71]
ds_read_b128 v[44:47], v11 offset:53248
v_mfma_f32_16x16x32_bf16 v[72:75], v[20:23], a[196:199], v[72:75]
v_mfma_f32_16x16x32_bf16 v[76:79], v[24:27], a[192:195], v[76:79]
ds_read_b128 v[48:51], v11 offset:55296
v_mfma_f32_16x16x32_bf16 v[80:83], v[24:27], a[196:199], v[80:83]
s_waitcnt lgkmcnt(4)
v_mfma_f32_16x16x32_bf16 v[68:71], v[28:31], a[200:203], v[68:71]
ds_read_b128 v[20:23], v10 offset:57344
v_mfma_f32_16x16x32_bf16 v[72:75], v[28:31], a[204:207], v[72:75]
v_mfma_f32_16x16x32_bf16 v[76:79], v[32:35], a[200:203], v[76:79]
ds_read_b128 v[24:27], v10 offset:59392
v_mfma_f32_16x16x32_bf16 v[80:83], v[32:35], a[204:207], v[80:83]
s_waitcnt lgkmcnt(4)
v_mfma_f32_16x16x32_bf16 v[68:71], v[36:39], a[208:211], v[68:71]
ds_read_b128 v[28:31], v11 offset:57344
v_mfma_f32_16x16x32_bf16 v[72:75], v[36:39], a[212:215], v[72:75]
v_mfma_f32_16x16x32_bf16 v[76:79], v[40:43], a[208:211], v[76:79]
ds_read_b128 v[32:35], v11 offset:59392
v_mfma_f32_16x16x32_bf16 v[80:83], v[40:43], a[212:215], v[80:83]
s_waitcnt lgkmcnt(4)
v_mfma_f32_16x16x32_bf16 v[68:71], v[44:47], a[216:219], v[68:71]
ds_read_b128 v[36:39], v10 offset:61440
v_mfma_f32_16x16x32_bf16 v[72:75], v[44:47], a[220:223], v[72:75]
v_mfma_f32_16x16x32_bf16 v[76:79], v[48:51], a[216:219], v[76:79]
ds_read_b128 v[40:43], v10 offset:63488
v_mfma_f32_16x16x32_bf16 v[80:83], v[48:51], a[220:223], v[80:83]
s_waitcnt lgkmcnt(4)
v_mfma_f32_16x16x32_bf16 v[68:71], v[20:23], a[224:227], v[68:71]
ds_read_b128 v[44:47], v11 offset:61440
v_mfma_f32_16x16x32_bf16 v[72:75], v[20:23], a[228:231], v[72:75]
v_mfma_f32_16x16x32_bf16 v[76:79], v[24:27], a[224:227], v[76:79]
ds_read_b128 v[48:51], v11 offset:63488
v_mfma_f32_16x16x32_bf16 v[80:83], v[24:27], a[228:231], v[80:83]
s_waitcnt lgkmcnt(5)
v_mfma_f32_16x16x32_bf16 v[68:71], v[28:31], a[232:235], v[68:71]
v_mfma_f32_16x16x32_bf16 v[72:75], v[28:31], a[236:239], v[72:75]
s_waitcnt lgkmcnt(4)
v_mfma_f32_16x16x32_bf16 v[76:79], v[32:35], a[232:235], v[76:79]
v_mfma_f32_16x16x32_bf16 v[80:83], v[32:35], a[236:239], v[80:83]
s_waitcnt lgkmcnt(3)
v_mfma_f32_16x16x32_bf16 v[68:71], v[36:39], a[240:243], v[68:71]
v_mfma_f32_16x16x32_bf16 v[72:75], v[36:39], a[244:247], v[72:75]
s_waitcnt lgkmcnt(2)
v_mfma_f32_16x16x32_bf16 v[76:79], v[40:43], a[240:243], v[76:79]
v_mfma_f32_16x16x32_bf16 v[80:83], v[40:43], a[244:247], v[80:83]
s_waitcnt lgkmcnt(1)
v_mfma_f32_16x16x32_bf16 v[68:71], v[44:47], a[248:251], v[68:71]
v_mfma_f32_16x16x32_bf16 v[72:75], v[44:47], a[252:255], v[72:75]
s_waitcnt lgkmcnt(0)
v_mfma_f32_16x16x32_bf16 v[76:79], v[48:51], a[248:251], v[76:79]
v_mfma_f32_16x16x32_bf16 v[80:83], v[48:51], a[252:255], v[80:83]
s_add_u32 s42, s42, 1
s_cmp_eq_u32 s42, 64
s_cbranch_scc1 mega_kernel_v_fin
mega_kernel_v_mid:
s_waitcnt vmcnt(2)
s_barrier
s_add_u32 s50, s42, 1
s_min_u32 s50, s50, 63
s_lshl_b32 s50, s50, 16
ds_read_b128 v[20:23], v8 offset:0
ds_read_b128 v[24:27], v8 offset:2048
ds_read_b128 v[28:31], v9 offset:0
ds_read_b128 v[32:35], v9 offset:2048
ds_read_b128 v[36:39], v8 offset:4096
ds_read_b128 v[40:43], v8 offset:6144
s_waitcnt lgkmcnt(4)
v_mfma_f32_16x16x32_bf16 v[52:55], v[20:23], a[0:3], 0
ds_read_b128 v[44:47], v9 offset:4096
v_mfma_f32_16x16x32_bf16 v[56:59], v[20:23], a[4:7], 0
v_cvt_pk_bf16_f32 v84, v68, v69
v_cvt_pk_bf16_f32 v85, v70, v71
v_cvt_pk_bf16_f32 v86, v76, v77
v_mfma_f32_16x16x32_bf16 v[60:63], v[24:27], a[0:3], 0
ds_read_b128 v[48:51], v9 offset:6144
v_mfma_f32_16x16x32_bf16 v[64:67], v[24:27], a[4:7], 0
v_cvt_pk_bf16_f32 v87, v78, v79
v_cvt_pk_bf16_f32 v88, v72, v73
v_cvt_pk_bf16_f32 v89, v74, v75
s_waitcnt lgkmcnt(4)
v_mfma_f32_16x16x32_bf16 v[52:55], v[28:31], a[8:11], v[52:55]
ds_read_b128 v[20:23], v8 offset:8192
v_mfma_f32_16x16x32_bf16 v[56:59], v[28:31], a[12:15], v[56:59]
v_cvt_pk_bf16_f32 v90, v80, v81
v_cvt_pk_bf16_f32 v91, v82, v83
v_mfma_f32_16x16x32_bf16 v[60:63], v[32:35], a[8:11], v[60:63]
ds_read_b128 v[24:27], v8 offset:10240
v_mfma_f32_16x16x32_bf16 v[64:67], v[32:35], a[12:15], v[64:67]
s_add_u32 s51, s42, s47
s_sub_u32 s51, s51, 1
s_bfe_u32 s52, s51, 0x40002
s_lshl_b32 s52, s52, 14
s_waitcnt lgkmcnt(4)
v_mfma_f32_16x16x32_bf16 v[52:55], v[36:39], a[16:19], v[52:55]
ds_read_b128 v[28:31], v9 offset:8192
v_mfma_f32_16x16x32_bf16 v[56:59], v[36:39], a[20:23], v[56:59]
s_and_b32 s51, s51, 3
s_lshl_b32 s51, s51, 11
s_add_u32 s51, s51, s52
s_add_u32 s51, s51, s48
buffer_store_dwordx4 v[84:87], v7, s[84:87], s51 offen sc1
v_mfma_f32_16x16x32_bf16 v[60:63], v[40:43], a[16:19], v[60:63]
ds_read_b128 v[32:35], v9 offset:10240
v_mfma_f32_16x16x32_bf16 v[64:67], v[40:43], a[20:23], v[64:67]
buffer_store_dwordx4 v[88:91], v7, s[84:87], s51 offen offset:1024 sc1
s_waitcnt lgkmcnt(4)
v_mfma_f32_16x16x32_bf16 v[52:55], v[44:47], a[24:27], v[52:55]
ds_read_b128 v[36:39], v8 offset:12288
v_mfma_f32_16x16x32_bf16 v[56:59], v[44:47], a[28:31], v[56:59]
s_add_u32 m0, s46, 65536
v_mfma_f32_16x16x32_bf16 v[60:63], v[48:51], a[24:27], v[60:63]
ds_read_b128 v[40:43], v8 offset:14336
v_mfma_f32_16x16x32_bf16 v[64:67], v[48:51], a[28:31], v[64:67]
buffer_load_dwordx4 v6, s[8:11], s50 offen offset:0 lds
s_waitcnt lgkmcnt(4)
v_mfma_f32_16x16x32_bf16 v[52:55], v[20:23], a[32:35], v[52:55]
ds_read_b128 v[44:47], v9 offset:12288
v_mfma_f32_16x16x32_bf16 v[56:59], v[20:23], a[36:39], v[56:59]
s_add_u32 m0, s46, 69504
v_mfma_f32_16x16x32_bf16 v[60:63], v[24:27], a[32:35], v[60:63]
ds_read_b128 v[48:51], v9 offset:14336
v_mfma_f32_16x16x32_bf16 v[64:67], v[24:27], a[36:39], v[64:67]
buffer_load_dwordx4 v6, s[8:11], s50 offen offset:128 lds
s_waitcnt lgkmcnt(4)
v_mfma_f32_16x16x32_bf16 v[52:55], v[28:31], a[40:43], v[52:55]
ds_read_b128 v[20:23], v8 offset:16384
v_mfma_f32_16x16x32_bf16 v[56:59], v[28:31], a[44:47], v[56:59]
s_add_u32 m0, s46, 73472
v_mfma_f32_16x16x32_bf16 v[60:63], v[32:35], a[40:43], v[60:63]
ds_read_b128 v[24:27], v8 offset:18432
v_mfma_f32_16x16x32_bf16 v[64:67], v[32:35], a[44:47], v[64:67]
buffer_load_dwordx4 v6, s[8:11], s50 offen offset:256 lds
s_waitcnt lgkmcnt(4)
v_mfma_f32_16x16x32_bf16 v[52:55], v[36:39], a[48:51], v[52:55]
ds_read_b128 v[28:31], v9 offset:16384
v_mfma_f32_16x16x32_bf16 v[56:59], v[36:39], a[52:55], v[56:59]
s_add_u32 m0, s46, 77440
v_mfma_f32_16x16x32_bf16 v[60:63], v[40:43], a[48:51], v[60:63]
ds_read_b128 v[32:35], v9 offset:18432
v_mfma_f32_16x16x32_bf16 v[64:67], v[40:43], a[52:55], v[64:67]
buffer_load_dwordx4 v6, s[8:11], s50 offen offset:384 lds
s_waitcnt lgkmcnt(4)
v_mfma_f32_16x16x32_bf16 v[52:55], v[44:47], a[56:59], v[52:55]
ds_read_b128 v[36:39], v8 offset:20480
v_mfma_f32_16x16x32_bf16 v[56:59], v[44:47], a[60:63], v[56:59]
s_add_u32 m0, s46, 81408
v_mfma_f32_16x16x32_bf16 v[60:63], v[48:51], a[56:59], v[60:63]
ds_read_b128 v[40:43], v8 offset:22528
v_mfma_f32_16x16x32_bf16 v[64:67], v[48:51], a[60:63], v[64:67]
buffer_load_dwordx4 v6, s[8:11], s50 offen offset:512 lds
s_waitcnt lgkmcnt(4)
v_mfma_f32_16x16x32_bf16 v[52:55], v[20:23], a[64:67], v[52:55]
ds_read_b128 v[44:47], v9 offset:20480
v_mfma_f32_16x16x32_bf16 v[56:59], v[20:23], a[68:71], v[56:59]
s_add_u32 m0, s46, 85376
v_mfma_f32_16x16x32_bf16 v[60:63], v[24:27], a[64:67], v[60:63]
ds_read_b128 v[48:51], v9 offset:22528
v_mfma_f32_16x16x32_bf16 v[64:67], v[24:27], a[68:71], v[64:67]
buffer_load_dwordx4 v6, s[8:11], s50 offen offset:640 lds
s_waitcnt lgkmcnt(4)
v_mfma_f32_16x16x32_bf16 v[52:55], v[28:31], a[72:75], v[52:55]
ds_read_b128 v[20:23], v8 offset:24576
v_mfma_f32_16x16x32_bf16 v[56:59], v[28:31], a[76:79], v[56:59]
s_add_u32 m0, s46, 89344
v_mfma_f32_16x16x32_bf16 v[60:63], v[32:35], a[72:75], v[60:63]
ds_read_b128 v[24:27], v8 offset:26624
v_mfma_f32_16x16x32_bf16 v[64:67], v[32:35], a[76:79], v[64:67]
buffer_load_dwordx4 v6, s[8:11], s50 offen offset:768 lds
s_waitcnt lgkmcnt(4)
v_mfma_f32_16x16x32_bf16 v[52:55], v[36:39], a[80:83], v[52:55]
ds_read_b128 v[28:31], v9 offset:24576
v_mfma_f32_16x16x32_bf16 v[56:59], v[36:39], a[84:87], v[56:59]
s_add_u32 m0, s46, 93312
v_mfma_f32_16x16x32_bf16 v[60:63], v[40:43], a[80:83], v[60:63]
ds_read_b128 v[32:35], v9 offset:26624
v_mfma_f32_16x16x32_bf16 v[64:67], v[40:43], a[84:87], v[64:67]
buffer_load_dwordx4 v6, s[8:11], s50 offen offset:896 lds
s_waitcnt lgkmcnt(4)
v_mfma_f32_16x16x32_bf16 v[52:55], v[44:47], a[88:91], v[52:55]
ds_read_b128 v[36:39], v8 offset:28672
v_mfma_f32_16x16x32_bf16 v[56:59], v[44:47], a[92:95], v[56:59]
s_add_u32 m0, s46, 97280
v_mfma_f32_16x16x32_bf16 v[60:63], v[48:51], a[88:91], v[60:63]
ds_read_b128 v[40:43], v8 offset:30720
v_mfma_f32_16x16x32_bf16 v[64:67], v[48:51], a[92:95], v[64:67]
buffer_load_dwordx4 v6, s[8:11], s50 offen offset:1024 lds
s_waitcnt lgkmcnt(4)
v_mfma_f32_16x16x32_bf16 v[52:55], v[20:23], a[96:99], v[52:55]
ds_read_b128 v[44:47], v9 offset:28672
v_mfma_f32_16x16x32_bf16 v[56:59], v[20:23], a[100:103], v[56:59]
s_add_u32 m0, s46, 101248
v_mfma_f32_16x16x32_bf16 v[60:63], v[24:27], a[96:99], v[60:63]
ds_read_b128 v[48:51], v9 offset:30720
v_mfma_f32_16x16x32_bf16 v[64:67], v[24:27], a[100:103], v[64:67]
buffer_load_dwordx4 v6, s[8:11], s50 offen offset:1152 lds
s_waitcnt lgkmcnt(4)
v_mfma_f32_16x16x32_bf16 v[52:55], v[28:31], a[104:107], v[52:55]
ds_read_b128 v[20:23], v8 offset:32768
v_mfma_f32_16x16x32_bf16 v[56:59], v[28:31], a[108:111], v[56:59]
s_add_u32 m0, s46, 105216
v_mfma_f32_16x16x32_bf16 v[60:63], v[32:35], a[104:107], v[60:63]
ds_read_b128 v[24:27], v8 offset:34816
v_mfma_f32_16x16x32_bf16 v[64:67], v[32:35], a[108:111], v[64:67]
buffer_load_dwordx4 v6, s[8:11], s50 offen offset:1280 lds
s_waitcnt lgkmcnt(4)
v_mfma_f32_16x16x32_bf16 v[52:55], v[36:39], a[112:115], v[52:55]
ds_read_b128 v[28:31], v9 offset:32768
v_mfma_f32_16x16x32_bf16 v[56:59], v[36:39], a[116:119], v[56:59]
s_add_u32 m0, s46, 109184
v_mfma_f32_16x16x32_bf16 v[60:63], v[40:43], a[112:115], v[60:63]
ds_read_b128 v[32:35], v9 offset:34816
v_mfma_f32_16x16x32_bf16 v[64:67], v[40:43], a[116:119], v[64:67]
buffer_load_dwordx4 v6, s[8:11], s50 offen offset:1408 lds
s_waitcnt lgkmcnt(4)
v_mfma_f32_16x16x32_bf16 v[52:55], v[44:47], a[120:123], v[52:55]
ds_read_b128 v[36:39], v8 offset:36864
v_mfma_f32_16x16x32_bf16 v[56:59], v[44:47], a[124:127], v[56:59]
s_add_u32 m0, s46, 113152
v_mfma_f32_16x16x32_bf16 v[60:63], v[48:51], a[120:123], v[60:63]
ds_read_b128 v[40:43], v8 offset:38912
v_mfma_f32_16x16x32_bf16 v[64:67], v[48:51], a[124:127], v[64:67]
buffer_load_dwordx4 v6, s[8:11], s50 offen offset:1536 lds
s_waitcnt lgkmcnt(4)
v_mfma_f32_16x16x32_bf16 v[52:55], v[20:23], a[128:131], v[52:55]
ds_read_b128 v[44:47], v9 offset:36864
v_mfma_f32_16x16x32_bf16 v[56:59], v[20:23], a[132:135], v[56:59]
s_add_u32 m0, s46, 117120
v_mfma_f32_16x16x32_bf16 v[60:63], v[24:27], a[128:131], v[60:63]
ds_read_b128 v[48:51], v9 offset:38912
v_mfma_f32_16x16x32_bf16 v[64:67], v[24:27], a[132:135], v[64:67]
buffer_load_dwordx4 v6, s[8:11], s50 offen offset:1664 lds
s_waitcnt lgkmcnt(4)
v_mfma_f32_16x16x32_bf16 v[52:55], v[28:31], a[136:139], v[52:55]
ds_read_b128 v[20:23], v8 offset:40960
v_mfma_f32_16x16x32_bf16 v[56:59], v[28:31], a[140:143], v[56:59]
s_add_u32 m0, s46, 121088
v_mfma_f32_16x16x32_bf16 v[60:63], v[32:35], a[136:139], v[60:63]
ds_read_b128 v[24:27], v8 offset:43008
v_mfma_f32_16x16x32_bf16 v[64:67], v[32:35], a[140:143], v[64:67]
buffer_load_dwordx4 v6, s[8:11], s50 offen offset:1792 lds
s_waitcnt lgkmcnt(4)
v_mfma_f32_16x16x32_bf16 v[52:55], v[36:39], a[144:147], v[52:55]
ds_read_b128 v[28:31], v9 offset:40960
v_mfma_f32_16x16x32_bf16 v[56:59], v[36:39], a[148:151], v[56:59]
s_add_u32 m0, s46, 125056
v_mfma_f32_16x16x32_bf16 v[60:63], v[40:43], a[144:147], v[60:63]
ds_read_b128 v[32:35], v9 offset:43008
v_mfma_f32_16x16x32_bf16 v[64:67], v[40:43], a[148:151], v[64:67]
buffer_load_dwordx4 v6, s[8:11], s50 offen offset:1920 lds
s_waitcnt lgkmcnt(4)
v_mfma_f32_16x16x32_bf16 v[52:55], v[44:47], a[152:155], v[52:55]
ds_read_b128 v[36:39], v8 offset:45056
v_mfma_f32_16x16x32_bf16 v[56:59], v[44:47], a[156:159], v[56:59]
v_mfma_f32_16x16x32_bf16 v[60:63], v[48:51], a[152:155], v[60:63]
ds_read_b128 v[40:43], v8 offset:47104
v_mfma_f32_16x16x32_bf16 v[64:67], v[48:51], a[156:159], v[64:67]
s_waitcnt lgkmcnt(4)
v_mfma_f32_16x16x32_bf16 v[52:55], v[20:23], a[160:163], v[52:55]
ds_read_b128 v[44:47], v9 offset:45056
v_mfma_f32_16x16x32_bf16 v[56:59], v[20:23], a[164:167], v[56:59]
v_mfma_f32_16x16x32_bf16 v[60:63], v[24:27], a[160:163], v[60:63]
ds_read_b128 v[48:51], v9 offset:47104
v_mfma_f32_16x16x32_bf16 v[64:67], v[24:27], a[164:167], v[64:67]
s_waitcnt lgkmcnt(4)
v_mfma_f32_16x16x32_bf16 v[52:55], v[28:31], a[168:171], v[52:55]
ds_read_b128 v[20:23], v8 offset:49152
v_mfma_f32_16x16x32_bf16 v[56:59], v[28:31], a[172:175], v[56:59]
s_waitcnt vmcnt(16)
v_mov_b32 v17, s42
s_mov_b64 exec, 1
buffer_store_dword v17, v16, s[84:87], s49 offen sc1
s_mov_b64 exec, -1
v_mfma_f32_16x16x32_bf16 v[60:63], v[32:35], a[168:171], v[60:63]
ds_read_b128 v[24:27], v8 offset:51200
v_mfma_f32_16x16x32_bf16 v[64:67], v[32:35], a[172:175], v[64:67]
s_waitcnt lgkmcnt(4)
v_mfma_f32_16x16x32_bf16 v[52:55], v[36:39], a[176:179], v[52:55]
ds_read_b128 v[28:31], v9 offset:49152
v_mfma_f32_16x16x32_bf16 v[56:59], v[36:39], a[180:183], v[56:59]
s_add_u32 s53, s42, 3
s_min_u32 s53, s53, 63
s_lshl_b32 s53, s53, 16
s_mov_b64 exec, 0xffff
buffer_load_dword v250, v19, s[8:11], s53 offen
s_mov_b64 exec, -1
v_mfma_f32_16x16x32_bf16 v[60:63], v[40:43], a[176:179], v[60:63]
ds_read_b128 v[32:35], v9 offset:51200
v_mfma_f32_16x16x32_bf16 v[64:67], v[40:43], a[180:183], v[64:67]
s_waitcnt lgkmcnt(4)
v_mfma_f32_16x16x32_bf16 v[52:55], v[44:47], a[184:187], v[52:55]
ds_read_b128 v[36:39], v8 offset:53248
v_mfma_f32_16x16x32_bf16 v[56:59], v[44:47], a[188:191], v[56:59]
v_mfma_f32_16x16x32_bf16 v[60:63], v[48:51], a[184:187], v[60:63]
ds_read_b128 v[40:43], v8 offset:55296
v_mfma_f32_16x16x32_bf16 v[64:67], v[48:51], a[188:191], v[64:67]
s_waitcnt lgkmcnt(4)
v_mfma_f32_16x16x32_bf16 v[52:55], v[20:23], a[192:195], v[52:55]
ds_read_b128 v[44:47], v9 offset:53248
v_mfma_f32_16x16x32_bf16 v[56:59], v[20:23], a[196:199], v[56:59]
v_mfma_f32_16x16x32_bf16 v[60:63], v[24:27], a[192:195], v[60:63]
ds_read_b128 v[48:51], v9 offset:55296
v_mfma_f32_16x16x32_bf16 v[64:67], v[24:27], a[196:199], v[64:67]
s_waitcnt lgkmcnt(4)
v_mfma_f32_16x16x32_bf16 v[52:55], v[28:31], a[200:203], v[52:55]
ds_read_b128 v[20:23], v8 offset:57344
v_mfma_f32_16x16x32_bf16 v[56:59], v[28:31], a[204:207], v[56:59]
v_mfma_f32_16x16x32_bf16 v[60:63], v[32:35], a[200:203], v[60:63]
ds_read_b128 v[24:27], v8 offset:59392
v_mfma_f32_16x16x32_bf16 v[64:67], v[32:35], a[204:207], v[64:67]
s_waitcnt lgkmcnt(4)
v_mfma_f32_16x16x32_bf16 v[52:55], v[36:39], a[208:211], v[52:55]
ds_read_b128 v[28:31], v9 offset:57344
v_mfma_f32_16x16x32_bf16 v[56:59], v[36:39], a[212:215], v[56:59]
v_mfma_f32_16x16x32_bf16 v[60:63], v[40:43], a[208:211], v[60:63]
ds_read_b128 v[32:35], v9 offset:59392
v_mfma_f32_16x16x32_bf16 v[64:67], v[40:43], a[212:215], v[64:67]
s_waitcnt lgkmcnt(4)
v_mfma_f32_16x16x32_bf16 v[52:55], v[44:47], a[216:219], v[52:55]
ds_read_b128 v[36:39], v8 offset:61440
v_mfma_f32_16x16x32_bf16 v[56:59], v[44:47], a[220:223], v[56:59]
v_mfma_f32_16x16x32_bf16 v[60:63], v[48:51], a[216:219], v[60:63]
ds_read_b128 v[40:43], v8 offset:63488
v_mfma_f32_16x16x32_bf16 v[64:67], v[48:51], a[220:223], v[64:67]
s_waitcnt lgkmcnt(4)
v_mfma_f32_16x16x32_bf16 v[52:55], v[20:23], a[224:227], v[52:55]
ds_read_b128 v[44:47], v9 offset:61440
v_mfma_f32_16x16x32_bf16 v[56:59], v[20:23], a[228:231], v[56:59]
v_mfma_f32_16x16x32_bf16 v[60:63], v[24:27], a[224:227], v[60:63]
ds_read_b128 v[48:51], v9 offset:63488
v_mfma_f32_16x16x32_bf16 v[64:67], v[24:27], a[228:231], v[64:67]
s_waitcnt lgkmcnt(5)
v_mfma_f32_16x16x32_bf16 v[52:55], v[28:31], a[232:235], v[52:55]
v_mfma_f32_16x16x32_bf16 v[56:59], v[28:31], a[236:239], v[56:59]
s_waitcnt lgkmcnt(4)
v_mfma_f32_16x16x32_bf16 v[60:63], v[32:35], a[232:235], v[60:63]
v_mfma_f32_16x16x32_bf16 v[64:67], v[32:35], a[236:239], v[64:67]
s_waitcnt lgkmcnt(3)
v_mfma_f32_16x16x32_bf16 v[52:55], v[36:39], a[240:243], v[52:55]
v_mfma_f32_16x16x32_bf16 v[56:59], v[36:39], a[244:247], v[56:59]
s_waitcnt lgkmcnt(2)
v_mfma_f32_16x16x32_bf16 v[60:63], v[40:43], a[240:243], v[60:63]
v_mfma_f32_16x16x32_bf16 v[64:67], v[40:43], a[244:247], v[64:67]
s_waitcnt lgkmcnt(1)
v_mfma_f32_16x16x32_bf16 v[52:55], v[44:47], a[248:251], v[52:55]
v_mfma_f32_16x16x32_bf16 v[56:59], v[44:47], a[252:255], v[56:59]
s_waitcnt lgkmcnt(0)
v_mfma_f32_16x16x32_bf16 v[60:63], v[48:51], a[248:251], v[60:63]
v_mfma_f32_16x16x32_bf16 v[64:67], v[48:51], a[252:255], v[64:67]
s_add_u32 s42, s42, 1
s_branch mega_kernel_v_loop
mega_kernel_v_fin:
s_nop 11
v_cvt_pk_bf16_f32 v84, v68, v69
v_cvt_pk_bf16_f32 v85, v70, v71
v_cvt_pk_bf16_f32 v86, v76, v77
v_cvt_pk_bf16_f32 v87, v78, v79
v_cvt_pk_bf16_f32 v88, v72, v73
v_cvt_pk_bf16_f32 v89, v74, v75
v_cvt_pk_bf16_f32 v90, v80, v81
v_cvt_pk_bf16_f32 v91, v82, v83
s_add_u32 s51, s42, s47
s_sub_u32 s51, s51, 1
s_bfe_u32 s52, s51, 0x40002
s_lshl_b32 s52, s52, 14
s_and_b32 s51, s51, 3
s_lshl_b32 s51, s51, 11
s_add_u32 s51, s51, s52
s_add_u32 s51, s51, s48
buffer_store_dwordx4 v[84:87], v7, s[84:87], s51 offen sc1
buffer_store_dwordx4 v[88:91], v7, s[84:87], s51 offen offset:1024 sc1
s_waitcnt vmcnt(0)
v_mov_b32 v17, s42
s_mov_b64 exec, 1
buffer_store_dword v17, v16, s[84:87], s49 offen sc1
s_mov_b64 exec, -1
s_waitcnt vmcnt(0)
s_barrier
mega_kernel_fft:
s_mov_b32 s38, s92
s_mov_b32 s39, 64
s_mov_b32 s37, 129
mega_kernel_f2s:
v_mov_b32 v1, 0
s_mov_b32 s82, 69259264
mega_kernel_w0:
s_sleep 8
buffer_load_dword v2, v1, s[84:87], s82 offen sc1
s_waitcnt vmcnt(0)
v_cmp_ne_u32 vcc, 31, v2
s_cbranch_vccnz mega_kernel_w0
s_mov_b32 s48, 0x3f7ec46d
s_mov_b32 s49, 0x3dc8bd36
s_mov_b32 s50, 0x3f7b14be
s_mov_b32 s51, 0x3e47c5c2
s_mov_b32 s52, 0x3f74fa0b
s_mov_b32 s53, 0x3e94a031
s_mov_b32 s54, 0x3f6c835e
s_mov_b32 s55, 0x3ec3ef15
s_mov_b32 s56, 0x3f61c598
s_mov_b32 s57, 0x3ef15aea
s_mov_b32 s58, 0x3f54db31
s_mov_b32 s59, 0x3f0e39da
s_mov_b32 s60, 0x3f45e403
s_mov_b32 s61, 0x3f226799
s_mov_b32 s62, 0x3f3504f3
s_mov_b32 s63, 0x3f3504f3
v_lshrrev_b32 v10, 6, v0
v_and_b32 v1, 63, v0
v_readfirstlane_b32 s16, v10
v_cvt_f32_u32 v2, v1
v_lshlrev_b32 v5, 3, v1
s_mul_i32 s17, s16, 16896
v_add_u32 v3, s17, v5
v_and_b32 v7, 1, v1
v_lshrrev_b32 v6, 1, v1
v_cvt_f32_u32 v8, v6
v_cvt_f32_u32 v10, v7
v_mul_u32_u24 v4, 528, v6
v_lshl_add_u32 v4, v7, 3, v4
v_add_u32 v4, s17, v4
v_lshlrev_b32 v11, 12, v7
v_lshl_add_u32 v11, v6, 2, v11
v_fma_f32 v9, v10, 2.0, -1.0
v_sub_f32 v7, 0, v9
v_mul_f32 v13, v10, v8
v_mul_f32 v13, 0x3a000000, v13
s_mov_b32 s18, 0xaaaaaaaa
s_mov_b32 s19, 0xaaaaaaaa
v_mul_f32 v12, 0xba000000, v2
v_cos_f32 v82, v12
v_sin_f32 v83, v12
v_mul_f32 v12, 0xba800000, v2
v_cos_f32 v84, v12
v_sin_f32 v85, v12
v_mul_f32 v12, 0xbac00000, v2
v_cos_f32 v86, v12
v_sin_f32 v87, v12
v_mul_f32 v12, 0xbb000000, v2
v_cos_f32 v88, v12
v_sin_f32 v89, v12
v_mul_f32 v12, 0xbb200000, v2
v_cos_f32 v90, v12
v_sin_f32 v91, v12
v_mul_f32 v12, 0xbb400000, v2
v_cos_f32 v92, v12
v_sin_f32 v93, v12
v_mul_f32 v12, 0xbb600000, v2
v_cos_f32 v94, v12
v_sin_f32 v95, v12
v_mul_f32 v12, 0xbb800000, v2
v_cos_f32 v96, v12
v_sin_f32 v97, v12
v_mul_f32 v12, 0xbb900000, v2
v_cos_f32 v98, v12
v_sin_f32 v99, v12
v_mul_f32 v12, 0xbba00000, v2
v_cos_f32 v100, v12
v_sin_f32 v101, v12
v_mul_f32 v12, 0xbbb00000, v2
v_cos_f32 v102, v12
v_sin_f32 v103, v12
v_mul_f32 v12, 0xbbc00000, v2
v_cos_f32 v104, v12
v_sin_f32 v105, v12
v_mul_f32 v12, 0xbbd00000, v2
v_cos_f32 v106, v12
v_sin_f32 v107, v12
v_mul_f32 v12, 0xbbe00000, v2
v_cos_f32 v108, v12
v_sin_f32 v109, v12
v_mul_f32 v12, 0xbbf00000, v2
v_cos_f32 v110, v12
v_sin_f32 v111, v12
v_mul_f32 v12, 0xbc000000, v2
v_cos_f32 v112, v12
v_sin_f32 v113, v12
v_mul_f32 v12, 0xbc080000, v2
v_cos_f32 v114, v12
v_sin_f32 v115, v12
v_mul_f32 v12, 0xbc100000, v2
v_cos_f32 v116, v12
v_sin_f32 v117, v12
v_mul_f32 v12, 0xbc180000, v2
v_cos_f32 v118, v12
v_sin_f32 v119, v12
v_mul_f32 v12, 0xbc200000, v2
v_cos_f32 v120, v12
v_sin_f32 v121, v12
v_mul_f32 v12, 0xbc280000, v2
v_cos_f32 v122, v12
v_sin_f32 v123, v12
v_mul_f32 v12, 0xbc300000, v2
v_cos_f32 v124, v12
v_sin_f32 v125, v12
v_mul_f32 v12, 0xbc380000, v2
v_cos_f32 v126, v12
v_sin_f32 v127, v12
v_mul_f32 v12, 0xbc400000, v2
v_cos_f32 v128, v12
v_sin_f32 v129, v12
v_mul_f32 v12, 0xbc480000, v2
v_cos_f32 v130, v12
v_sin_f32 v131, v12
v_mul_f32 v12, 0xbc500000, v2
v_cos_f32 v132, v12
v_sin_f32 v133, v12
v_mul_f32 v12, 0xbc580000, v2
v_cos_f32 v134, v12
v_sin_f32 v135, v12
v_mul_f32 v12, 0xbc600000, v2
v_cos_f32 v136, v12
v_sin_f32 v137, v12
v_mul_f32 v12, 0xbc680000, v2
v_cos_f32 v138, v12
v_sin_f32 v139, v12
v_mul_f32 v12, 0xbc700000, v2
v_cos_f32 v140, v12
v_sin_f32 v141, v12
v_mul_f32 v12, 0xbc780000, v2
v_cos_f32 v142, v12
v_sin_f32 v143, v12
v_mov_b32 v12, v13
v_fmac_f32 v12, 0x00000000, v8
v_cos_f32 v144, v12
v_sin_f32 v145, v12
v_mov_b32 v12, v13
v_fmac_f32 v12, 0x3a800000, v8
v_cos_f32 v146, v12
v_sin_f32 v147, v12
v_mov_b32 v12, v13
v_fmac_f32 v12, 0x3b000000, v8
v_cos_f32 v148, v12
v_sin_f32 v149, v12
v_mov_b32 v12, v13
v_fmac_f32 v12, 0x3b400000, v8
v_cos_f32 v150, v12
v_sin_f32 v151, v12
v_mov_b32 v12, v13
v_fmac_f32 v12, 0x3b800000, v8
v_cos_f32 v152, v12
v_sin_f32 v153, v12
v_mov_b32 v12, v13
v_fmac_f32 v12, 0x3ba00000, v8
v_cos_f32 v154, v12
v_sin_f32 v155, v12
v_mov_b32 v12, v13
v_fmac_f32 v12, 0x3bc00000, v8
v_cos_f32 v156, v12
v_sin_f32 v157, v12
v_mov_b32 v12, v13
v_fmac_f32 v12, 0x3be00000, v8
v_cos_f32 v158, v12
v_sin_f32 v159, v12
v_mov_b32 v12, v13
v_fmac_f32 v12, 0x3c000000, v8
v_cos_f32 v160, v12
v_sin_f32 v161, v12
v_mov_b32 v12, v13
v_fmac_f32 v12, 0x3c100000, v8
v_cos_f32 v162, v12
v_sin_f32 v163, v12
v_mov_b32 v12, v13
v_fmac_f32 v12, 0x3c200000, v8
v_cos_f32 v164, v12
v_sin_f32 v165, v12
v_mov_b32 v12, v13
v_fmac_f32 v12, 0x3c300000, v8
v_cos_f32 v166, v12
v_sin_f32 v167, v12
v_mov_b32 v12, v13
v_fmac_f32 v12, 0x3c400000, v8
v_cos_f32 v168, v12
v_sin_f32 v169, v12
v_mov_b32 v12, v13
v_fmac_f32 v12, 0x3c500000, v8
v_cos_f32 v170, v12
v_sin_f32 v171, v12
v_mov_b32 v12, v13
v_fmac_f32 v12, 0x3c600000, v8
v_cos_f32 v172, v12
v_sin_f32 v173, v12
v_mov_b32 v12, v13
v_fmac_f32 v12, 0x3c700000, v8
v_cos_f32 v174, v12
v_sin_f32 v175, v12
v_mov_b32 v12, v13
v_fmac_f32 v12, 0x3c800000, v8
v_cos_f32 v176, v12
v_sin_f32 v177, v12
v_mov_b32 v12, v13
v_fmac_f32 v12, 0x3c880000, v8
v_cos_f32 v178, v12
v_sin_f32 v179, v12
v_mov_b32 v12, v13
v_fmac_f32 v12, 0x3c900000, v8
v_cos_f32 v180, v12
v_sin_f32 v181, v12
v_mov_b32 v12, v13
v_fmac_f32 v12, 0x3c980000, v8
v_cos_f32 v182, v12
v_sin_f32 v183, v12
v_mov_b32 v12, v13
v_fmac_f32 v12, 0x3ca00000, v8
v_cos_f32 v184, v12
v_sin_f32 v185, v12
v_mov_b32 v12, v13
v_fmac_f32 v12, 0x3ca80000, v8
v_cos_f32 v186, v12
v_sin_f32 v187, v12
v_mov_b32 v12, v13
v_fmac_f32 v12, 0x3cb00000, v8
v_cos_f32 v188, v12
v_sin_f32 v189, v12
v_mov_b32 v12, v13
v_fmac_f32 v12, 0x3cb80000, v8
v_cos_f32 v190, v12
v_sin_f32 v191, v12
v_mov_b32 v12, v13
v_fmac_f32 v12, 0x3cc00000, v8
v_cos_f32 v192, v12
v_sin_f32 v193, v12
v_mov_b32 v12, v13
v_fmac_f32 v12, 0x3cc80000, v8
v_cos_f32 v194, v12
v_sin_f32 v195, v12
v_mov_b32 v12, v13
v_fmac_f32 v12, 0x3cd00000, v8
v_cos_f32 v196, v12
v_sin_f32 v197, v12
v_mov_b32 v12, v13
v_fmac_f32 v12, 0x3cd80000, v8
v_cos_f32 v198, v12
v_sin_f32 v199, v12
v_mov_b32 v12, v13
v_fmac_f32 v12, 0x3ce00000, v8
v_cos_f32 v200, v12
v_sin_f32 v201, v12
v_mov_b32 v12, v13
v_fmac_f32 v12, 0x3ce80000, v8
v_cos_f32 v202, v12
v_sin_f32 v203, v12
v_mov_b32 v12, v13
v_fmac_f32 v12, 0x3cf00000, v8
v_cos_f32 v204, v12
v_sin_f32 v205, v12
v_mov_b32 v12, v13
v_fmac_f32 v12, 0x3cf80000, v8
v_cos_f32 v206, v12
v_sin_f32 v207, v12
s_nop 0
v_mul_f32 v144, 0x34800000, v144
v_mul_f32 v145, 0x34800000, v145
v_mul_f32 v146, 0x34800000, v146
v_mul_f32 v147, 0x34800000, v147
v_mul_f32 v148, 0x34800000, v148
v_mul_f32 v149, 0x34800000, v149
v_mul_f32 v150, 0x34800000, v150
v_mul_f32 v151, 0x34800000, v151
v_mul_f32 v152, 0x34800000, v152
v_mul_f32 v153, 0x34800000, v153
v_mul_f32 v154, 0x34800000, v154
v_mul_f32 v155, 0x34800000, v155
v_mul_f32 v156, 0x34800000, v156
v_mul_f32 v157, 0x34800000, v157
v_mul_f32 v158, 0x34800000, v158
v_mul_f32 v159, 0x34800000, v159
v_mul_f32 v160, 0x34800000, v160
v_mul_f32 v161, 0x34800000, v161
v_mul_f32 v162, 0x34800000, v162
v_mul_f32 v163, 0x34800000, v163
v_mul_f32 v164, 0x34800000, v164
v_mul_f32 v165, 0x34800000, v165
v_mul_f32 v166, 0x34800000, v166
v_mul_f32 v167, 0x34800000, v167
v_mul_f32 v168, 0x34800000, v168
v_mul_f32 v169, 0x34800000, v169
v_mul_f32 v170, 0x34800000, v170
v_mul_f32 v171, 0x34800000, v171
v_mul_f32 v172, 0x34800000, v172
v_mul_f32 v173, 0x34800000, v173
v_mul_f32 v174, 0x34800000, v174
v_mul_f32 v175, 0x34800000, v175
v_mul_f32 v176, 0x34800000, v176
v_mul_f32 v177, 0x34800000, v177
v_mul_f32 v178, 0x34800000, v178
v_mul_f32 v179, 0x34800000, v179
v_mul_f32 v180, 0x34800000, v180
v_mul_f32 v181, 0x34800000, v181
v_mul_f32 v182, 0x34800000, v182
v_mul_f32 v183, 0x34800000, v183
v_mul_f32 v184, 0x34800000, v184
v_mul_f32 v185, 0x34800000, v185
v_mul_f32 v186, 0x34800000, v186
v_mul_f32 v187, 0x34800000, v187
v_mul_f32 v188, 0x34800000, v188
v_mul_f32 v189, 0x34800000, v189
v_mul_f32 v190, 0x34800000, v190
v_mul_f32 v191, 0x34800000, v191
v_mul_f32 v192, 0x34800000, v192
v_mul_f32 v193, 0x34800000, v193
v_mul_f32 v194, 0x34800000, v194
v_mul_f32 v195, 0x34800000, v195
v_mul_f32 v196, 0x34800000, v196
v_mul_f32 v197, 0x34800000, v197
v_mul_f32 v198, 0x34800000, v198
v_mul_f32 v199, 0x34800000, v199
v_mul_f32 v200, 0x34800000, v200
v_mul_f32 v201, 0x34800000, v201
v_mul_f32 v202, 0x34800000, v202
v_mul_f32 v203, 0x34800000, v203
v_mul_f32 v204, 0x34800000, v204
v_mul_f32 v205, 0x34800000, v205
v_mul_f32 v206, 0x34800000, v206
v_mul_f32 v207, 0x34800000, v207
s_cmp_lt_u32 s38, s37
s_cbranch_scc0 mega_kernel_f2_e
s_lshl_b32 s12, s38, 2
s_add_u32 s12, s12, s16
s_min_u32 s12, s12, 512
s_mul_i32 s13, s12, 8192
s_mul_i32 s12, s12, 16384
s_add_u32 s12, s12, 96468992
s_add_u32 s13, s13, 121634816
buffer_load_dwordx2 a[0:1], v5, s[84:87], s12 offen offset:0 sc1
buffer_load_dwordx2 a[2:3], v5, s[84:87], s12 offen offset:512 sc1
buffer_load_dwordx2 a[4:5], v5, s[84:87], s12 offen offset:1024 sc1
buffer_load_dwordx2 a[6:7], v5, s[84:87], s12 offen offset:1536 sc1
buffer_load_dwordx2 a[8:9], v5, s[84:87], s12 offen offset:2048 sc1
buffer_load_dwordx2 a[10:11], v5, s[84:87], s12 offen offset:2560 sc1
buffer_load_dwordx2 a[12:13], v5, s[84:87], s12 offen offset:3072 sc1
buffer_load_dwordx2 a[14:15], v5, s[84:87], s12 offen offset:3584 sc1
s_add_u32 s12, s12, 4096
buffer_load_dwordx2 a[16:17], v5, s[84:87], s12 offen offset:0 sc1
buffer_load_dwordx2 a[18:19], v5, s[84:87], s12 offen offset:512 sc1
buffer_load_dwordx2 a[20:21], v5, s[84:87], s12 offen offset:1024 sc1
buffer_load_dwordx2 a[22:23], v5, s[84:87], s12 offen offset:1536 sc1
buffer_load_dwordx2 a[24:25], v5, s[84:87], s12 offen offset:2048 sc1
buffer_load_dwordx2 a[26:27], v5, s[84:87], s12 offen offset:2560 sc1
buffer_load_dwordx2 a[28:29], v5, s[84:87], s12 offen offset:3072 sc1
buffer_load_dwordx2 a[30:31], v5, s[84:87], s12 offen offset:3584 sc1
s_add_u32 s12, s12, 4096
buffer_load_dwordx2 a[32:33], v5, s[84:87], s12 offen offset:0 sc1
buffer_load_dwordx2 a[34:35], v5, s[84:87], s12 offen offset:512 sc1
buffer_load_dwordx2 a[36:37], v5, s[84:87], s12 offen offset:1024 sc1
buffer_load_dwordx2 a[38:39], v5, s[84:87], s12 offen offset:1536 sc1
buffer_load_dwordx2 a[40:41], v5, s[84:87], s12 offen offset:2048 sc1
buffer_load_dwordx2 a[42:43], v5, s[84:87], s12 offen offset:2560 sc1
buffer_load_dwordx2 a[44:45], v5, s[84:87], s12 offen offset:3072 sc1
buffer_load_dwordx2 a[46:47], v5, s[84:87], s12 offen offset:3584 sc1
s_add_u32 s12, s12, 4096
buffer_load_dwordx2 a[48:49], v5, s[84:87], s12 offen offset:0 sc1
buffer_load_dwordx2 a[50:51], v5, s[84:87], s12 offen offset:512 sc1
buffer_load_dwordx2 a[52:53], v5, s[84:87], s12 offen offset:1024 sc1
buffer_load_dwordx2 a[54:55], v5, s[84:87], s12 offen offset:1536 sc1
buffer_load_dwordx2 a[56:57], v5, s[84:87], s12 offen offset:2048 sc1
buffer_load_dwordx2 a[58:59], v5, s[84:87], s12 offen offset:2560 sc1
buffer_load_dwordx2 a[60:61], v5, s[84:87], s12 offen offset:3072 sc1
buffer_load_dwordx2 a[62:63], v5, s[84:87], s12 offen offset:3584 sc1
s_add_u32 s12, s12, 4096
buffer_load_dword a64, v11, s[84:87], s13 offen offset:0 sc1
buffer_load_dword a65, v11, s[84:87], s13 offen offset:128 sc1
buffer_load_dword a66, v11, s[84:87], s13 offen offset:256 sc1
buffer_load_dword a67, v11, s[84:87], s13 offen offset:384 sc1
buffer_load_dword a68, v11, s[84:87], s13 offen offset:512 sc1
buffer_load_dword a69, v11, s[84:87], s13 offen offset:640 sc1
buffer_load_dword a70, v11, s[84:87], s13 offen offset:768 sc1
buffer_load_dword a71, v11, s[84:87], s13 offen offset:896 sc1
buffer_load_dword a72, v11, s[84:87], s13 offen offset:1024 sc1
buffer_load_dword a73, v11, s[84:87], s13 offen offset:1152 sc1
buffer_load_dword a74, v11, s[84:87], s13 offen offset:1280 sc1
buffer_load_dword a75, v11, s[84:87], s13 offen offset:1408 sc1
buffer_load_dword a76, v11, s[84:87], s13 offen offset:1536 sc1
buffer_load_dword a77, v11, s[84:87], s13 offen offset:1664 sc1
buffer_load_dword a78, v11, s[84:87], s13 offen offset:1792 sc1
buffer_load_dword a79, v11, s[84:87], s13 offen offset:1920 sc1
buffer_load_dword a80, v11, s[84:87], s13 offen offset:2048 sc1
buffer_load_dword a81, v11, s[84:87], s13 offen offset:2176 sc1
buffer_load_dword a82, v11, s[84:87], s13 offen offset:2304 sc1
buffer_load_dword a83, v11, s[84:87], s13 offen offset:2432 sc1
buffer_load_dword a84, v11, s[84:87], s13 offen offset:2560 sc1
buffer_load_dword a85, v11, s[84:87], s13 offen offset:2688 sc1
buffer_load_dword a86, v11, s[84:87], s13 offen offset:2816 sc1
buffer_load_dword a87, v11, s[84:87], s13 offen offset:2944 sc1
buffer_load_dword a88, v11, s[84:87], s13 offen offset:3072 sc1
buffer_load_dword a89, v11, s[84:87], s13 offen offset:3200 sc1
buffer_load_dword a90, v11, s[84:87], s13 offen offset:3328 sc1
buffer_load_dword a91, v11, s[84:87], s13 offen offset:3456 sc1
buffer_load_dword a92, v11, s[84:87], s13 offen offset:3584 sc1
buffer_load_dword a93, v11, s[84:87], s13 offen offset:3712 sc1
buffer_load_dword a94, v11, s[84:87], s13 offen offset:3840 sc1
buffer_load_dword a95, v11, s[84:87], s13 offen offset:3968 sc1
s_waitcnt vmcnt(0)
mega_kernel_f2_l:
s_add_u32 s21, s38, s39
s_cmp_lt_u32 s21, s37
s_cselect_b32 s22, s21, s38
s_waitcnt vmcnt(32)
v_accvgpr_read_b32 v16, a0
v_accvgpr_read_b32 v17, a1
v_accvgpr_read_b32 v18, a2
v_accvgpr_read_b32 v19, a3
v_accvgpr_read_b32 v20, a4
v_accvgpr_read_b32 v21, a5
v_accvgpr_read_b32 v22, a6
v_accvgpr_read_b32 v23, a7
v_accvgpr_read_b32 v24, a8
v_accvgpr_read_b32 v25, a9
v_accvgpr_read_b32 v26, a10
v_accvgpr_read_b32 v27, a11
v_accvgpr_read_b32 v28, a12
v_accvgpr_read_b32 v29, a13
v_accvgpr_read_b32 v30, a14
v_accvgpr_read_b32 v31, a15
v_accvgpr_read_b32 v32, a16
v_accvgpr_read_b32 v33, a17
v_accvgpr_read_b32 v34, a18
v_accvgpr_read_b32 v35, a19
v_accvgpr_read_b32 v36, a20
v_accvgpr_read_b32 v37, a21
v_accvgpr_read_b32 v38, a22
v_accvgpr_read_b32 v39, a23
v_accvgpr_read_b32 v40, a24
v_accvgpr_read_b32 v41, a25
v_accvgpr_read_b32 v42, a26
v_accvgpr_read_b32 v43, a27
v_accvgpr_read_b32 v44, a28
v_accvgpr_read_b32 v45, a29
v_accvgpr_read_b32 v46, a30
v_accvgpr_read_b32 v47, a31
v_accvgpr_read_b32 v48, a32
v_accvgpr_read_b32 v49, a33
v_accvgpr_read_b32 v50, a34
v_accvgpr_read_b32 v51, a35
v_accvgpr_read_b32 v52, a36
v_accvgpr_read_b32 v53, a37
v_accvgpr_read_b32 v54, a38
v_accvgpr_read_b32 v55, a39
v_accvgpr_read_b32 v56, a40
v_accvgpr_read_b32 v57, a41
v_accvgpr_read_b32 v58, a42
v_accvgpr_read_b32 v59, a43
v_accvgpr_read_b32 v60, a44
v_accvgpr_read_b32 v61, a45
v_accvgpr_read_b32 v62, a46
v_accvgpr_read_b32 v63, a47
v_accvgpr_read_b32 v64, a48
v_accvgpr_read_b32 v65, a49
v_accvgpr_read_b32 v66, a50
v_accvgpr_read_b32 v67, a51
v_accvgpr_read_b32 v68, a52
v_accvgpr_read_b32 v69, a53
v_accvgpr_read_b32 v70, a54
v_accvgpr_read_b32 v71, a55
v_accvgpr_read_b32 v72, a56
v_accvgpr_read_b32 v73, a57
v_accvgpr_read_b32 v74, a58
v_accvgpr_read_b32 v75, a59
v_accvgpr_read_b32 v76, a60
v_accvgpr_read_b32 v77, a61
v_accvgpr_read_b32 v78, a62
v_accvgpr_read_b32 v79, a63
v_accvgpr_read_b32 v208, a64
v_accvgpr_read_b32 v209, a65
v_accvgpr_read_b32 v210, a66
v_accvgpr_read_b32 v211, a67
v_accvgpr_read_b32 v212, a68
v_accvgpr_read_b32 v213, a69
v_accvgpr_read_b32 v214, a70
v_accvgpr_read_b32 v215, a71
v_accvgpr_read_b32 v216, a72
v_accvgpr_read_b32 v217, a73
v_accvgpr_read_b32 v218, a74
v_accvgpr_read_b32 v219, a75
v_accvgpr_read_b32 v220, a76
v_accvgpr_read_b32 v221, a77
v_accvgpr_read_b32 v222, a78
v_accvgpr_read_b32 v223, a79
v_accvgpr_read_b32 v224, a80
v_accvgpr_read_b32 v225, a81
v_accvgpr_read_b32 v226, a82
v_accvgpr_read_b32 v227, a83
v_accvgpr_read_b32 v228, a84
v_accvgpr_read_b32 v229, a85
v_accvgpr_read_b32 v230, a86
v_accvgpr_read_b32 v231, a87
v_accvgpr_read_b32 v232, a88
v_accvgpr_read_b32 v233, a89
v_accvgpr_read_b32 v234, a90
v_accvgpr_read_b32 v235, a91
v_accvgpr_read_b32 v236, a92
v_accvgpr_read_b32 v237, a93
v_accvgpr_read_b32 v238, a94
v_accvgpr_read_b32 v239, a95
s_lshl_b32 s12, s22, 2
s_add_u32 s12, s12, s16
s_min_u32 s12, s12, 512
s_mul_i32 s13, s12, 8192
s_mul_i32 s12, s12, 16384
s_add_u32 s12, s12, 96468992
s_add_u32 s13, s13, 121634816
buffer_load_dwordx2 a[0:1], v5, s[84:87], s12 offen offset:0 sc1
buffer_load_dwordx2 a[2:3], v5, s[84:87], s12 offen offset:512 sc1
buffer_load_dwordx2 a[4:5], v5, s[84:87], s12 offen offset:1024 sc1
buffer_load_dwordx2 a[6:7], v5, s[84:87], s12 offen offset:1536 sc1
buffer_load_dwordx2 a[8:9], v5, s[84:87], s12 offen offset:2048 sc1
buffer_load_dwordx2 a[10:11], v5, s[84:87], s12 offen offset:2560 sc1
buffer_load_dwordx2 a[12:13], v5, s[84:87], s12 offen offset:3072 sc1
buffer_load_dwordx2 a[14:15], v5, s[84:87], s12 offen offset:3584 sc1
s_add_u32 s12, s12, 4096
buffer_load_dwordx2 a[16:17], v5, s[84:87], s12 offen offset:0 sc1
buffer_load_dwordx2 a[18:19], v5, s[84:87], s12 offen offset:512 sc1
buffer_load_dwordx2 a[20:21], v5, s[84:87], s12 offen offset:1024 sc1
buffer_load_dwordx2 a[22:23], v5, s[84:87], s12 offen offset:1536 sc1
buffer_load_dwordx2 a[24:25], v5, s[84:87], s12 offen offset:2048 sc1
buffer_load_dwordx2 a[26:27], v5, s[84:87], s12 offen offset:2560 sc1
buffer_load_dwordx2 a[28:29], v5, s[84:87], s12 offen offset:3072 sc1
buffer_load_dwordx2 a[30:31], v5, s[84:87], s12 offen offset:3584 sc1
s_add_u32 s12, s12, 4096
buffer_load_dwordx2 a[32:33], v5, s[84:87], s12 offen offset:0 sc1
buffer_load_dwordx2 a[34:35], v5, s[84:87], s12 offen offset:512 sc1
buffer_load_dwordx2 a[36:37], v5, s[84:87], s12 offen offset:1024 sc1
buffer_load_dwordx2 a[38:39], v5, s[84:87], s12 offen offset:1536 sc1
buffer_load_dwordx2 a[40:41], v5, s[84:87], s12 offen offset:2048 sc1
buffer_load_dwordx2 a[42:43], v5, s[84:87], s12 offen offset:2560 sc1
buffer_load_dwordx2 a[44:45], v5, s[84:87], s12 offen offset:3072 sc1
buffer_load_dwordx2 a[46:47], v5, s[84:87], s12 offen offset:3584 sc1
s_add_u32 s12, s12, 4096
buffer_load_dwordx2 a[48:49], v5, s[84:87], s12 offen offset:0 sc1
buffer_load_dwordx2 a[50:51], v5, s[84:87], s12 offen offset:512 sc1
buffer_load_dwordx2 a[52:53], v5, s[84:87], s12 offen offset:1024 sc1
buffer_load_dwordx2 a[54:55], v5, s[84:87], s12 offen offset:1536 sc1
buffer_load_dwordx2 a[56:57], v5, s[84:87], s12 offen offset:2048 sc1
buffer_load_dwordx2 a[58:59], v5, s[84:87], s12 offen offset:2560 sc1
buffer_load_dwordx2 a[60:61], v5, s[84:87], s12 offen offset:3072 sc1
buffer_load_dwordx2 a[62:63], v5, s[84:87], s12 offen offset:3584 sc1
s_add_u32 s12, s12, 4096
buffer_load_dword a64, v11, s[84:87], s13 offen offset:0 sc1
buffer_load_dword a65, v11, s[84:87], s13 offen offset:128 sc1
buffer_load_dword a66, v11, s[84:87], s13 offen offset:256 sc1
buffer_load_dword a67, v11, s[84:87], s13 offen offset:384 sc1
buffer_load_dword a68, v11, s[84:87], s13 offen offset:512 sc1
buffer_load_dword a69, v11, s[84:87], s13 offen offset:640 sc1
buffer_load_dword a70, v11, s[84:87], s13 offen offset:768 sc1
buffer_load_dword a71, v11, s[84:87], s13 offen offset:896 sc1
buffer_load_dword a72, v11, s[84:87], s13 offen offset:1024 sc1
buffer_load_dword a73, v11, s[84:87], s13 offen offset:1152 sc1
buffer_load_dword a74, v11, s[84:87], s13 offen offset:1280 sc1
buffer_load_dword a75, v11, s[84:87], s13 offen offset:1408 sc1
buffer_load_dword a76, v11, s[84:87], s13 offen offset:1536 sc1
buffer_load_dword a77, v11, s[84:87], s13 offen offset:1664 sc1
buffer_load_dword a78, v11, s[84:87], s13 offen offset:1792 sc1
buffer_load_dword a79, v11, s[84:87], s13 offen offset:1920 sc1
buffer_load_dword a80, v11, s[84:87], s13 offen offset:2048 sc1
buffer_load_dword a81, v11, s[84:87], s13 offen offset:2176 sc1
buffer_load_dword a82, v11, s[84:87], s13 offen offset:2304 sc1
buffer_load_dword a83, v11, s[84:87], s13 offen offset:2432 sc1
buffer_load_dword a84, v11, s[84:87], s13 offen offset:2560 sc1
buffer_load_dword a85, v11, s[84:87], s13 offen offset:2688 sc1
buffer_load_dword a86, v11, s[84:87], s13 offen offset:2816 sc1
buffer_load_dword a87, v11, s[84:87], s13 offen offset:2944 sc1
buffer_load_dword a88, v11, s[84:87], s13 offen offset:3072 sc1
buffer_load_dword a89, v11, s[84:87], s13 offen offset:3200 sc1
buffer_load_dword a90, v11, s[84:87], s13 offen offset:3328 sc1
buffer_load_dword a91, v11, s[84:87], s13 offen offset:3456 sc1
buffer_load_dword a92, v11, s[84:87], s13 offen offset:3584 sc1
buffer_load_dword a93, v11, s[84:87], s13 offen offset:3712 sc1
buffer_load_dword a94, v11, s[84:87], s13 offen offset:3840 sc1
buffer_load_dword a95, v11, s[84:87], s13 offen offset:3968 sc1
v_pk_add_f32 v[14:15], v[16:17], v[48:49] neg_lo:[0,1] neg_hi:[0,1]
v_pk_add_f32 v[16:17], v[16:17], v[48:49]
v_pk_add_f32 v[48:49], v[18:19], v[50:51] neg_lo:[0,1] neg_hi:[0,1]
v_pk_add_f32 v[18:19], v[18:19], v[50:51]
v_pk_mul_f32 v[50:51], v[48:49], s[50:51] op_sel:[0,0] op_sel_hi:[0,1] neg_lo:[0,0] neg_hi:[0,1]
v_pk_fma_f32 v[50:51], v[48:49], s[50:51], v[50:51] op_sel:[1,1,0] op_sel_hi:[1,0,1] neg_lo:[0,0,0] neg_hi:[0,0,0]
v_pk_add_f32 v[48:49], v[20:21], v[52:53] neg_lo:[0,1] neg_hi:[0,1]
v_pk_add_f32 v[20:21], v[20:21], v[52:53]
v_pk_mul_f32 v[52:53], v[48:49], s[54:55] op_sel:[0,0] op_sel_hi:[0,1] neg_lo:[0,0] neg_hi:[0,1]
v_pk_fma_f32 v[52:53], v[48:49], s[54:55], v[52:53] op_sel:[1,1,0] op_sel_hi:[1,0,1] neg_lo:[0,0,0] neg_hi:[0,0,0]
v_pk_add_f32 v[48:49], v[22:23], v[54:55] neg_lo:[0,1] neg_hi:[0,1]
v_pk_add_f32 v[22:23], v[22:23], v[54:55]
v_pk_mul_f32 v[54:55], v[48:49], s[58:59] op_sel:[0,0] op_sel_hi:[0,1] neg_lo:[0,0] neg_hi:[0,1]
v_pk_fma_f32 v[54:55], v[48:49], s[58:59], v[54:55] op_sel:[1,1,0] op_sel_hi:[1,0,1] neg_lo:[0,0,0] neg_hi:[0,0,0]
v_pk_add_f32 v[48:49], v[24:25], v[56:57] neg_lo:[0,1] neg_hi:[0,1]
v_pk_add_f32 v[24:25], v[24:25], v[56:57]
v_pk_mul_f32 v[56:57], v[48:49], s[62:63] op_sel:[0,0] op_sel_hi:[0,1] neg_lo:[0,0] neg_hi:[0,1]
v_pk_fma_f32 v[56:57], v[48:49], s[62:63], v[56:57] op_sel:[1,1,0] op_sel_hi:[1,0,1] neg_lo:[0,0,0] neg_hi:[0,0,0]
v_pk_add_f32 v[48:49], v[26:27], v[58:59] neg_lo:[0,1] neg_hi:[0,1]
v_pk_add_f32 v[26:27], v[26:27], v[58:59]
v_pk_mul_f32 v[58:59], v[48:49], s[58:59] op_sel:[0,1] op_sel_hi:[0,0] neg_lo:[0,0] neg_hi:[0,1]
v_pk_fma_f32 v[58:59], v[48:49], s[58:59], v[58:59] op_sel:[1,0,0] op_sel_hi:[1,1,1] neg_lo:[0,0,0] neg_hi:[0,0,0]
v_pk_add_f32 v[48:49], v[28:29], v[60:61] neg_lo:[0,1] neg_hi:[0,1]
v_pk_add_f32 v[28:29], v[28:29], v[60:61]
v_pk_mul_f32 v[60:61], v[48:49], s[54:55] op_sel:[0,1] op_sel_hi:[0,0] neg_lo:[0,0] neg_hi:[0,1]
v_pk_fma_f32 v[60:61], v[48:49], s[54:55], v[60:61] op_sel:[1,0,0] op_sel_hi:[1,1,1] neg_lo:[0,0,0] neg_hi:[0,0,0]
v_pk_add_f32 v[48:49], v[30:31], v[62:63] neg_lo:[0,1] neg_hi:[0,1]
v_pk_add_f32 v[30:31], v[30:31], v[62:63]
v_pk_mul_f32 v[62:63], v[48:49], s[50:51] op_sel:[0,1] op_sel_hi:[0,0] neg_lo:[0,0] neg_hi:[0,1]
v_pk_fma_f32 v[62:63], v[48:49], s[50:51], v[62:63] op_sel:[1,0,0] op_sel_hi:[1,1,1] neg_lo:[0,0,0] neg_hi:[0,0,0]
v_pk_add_f32 v[48:49], v[32:33], v[64:65] op_sel:[1,1] op_sel_hi:[0,0] neg_lo:[0,1] neg_hi:[1,0]
v_pk_add_f32 v[32:33], v[32:33], v[64:65]
v_pk_add_f32 v[64:65], v[34:35], v[66:67] neg_lo:[0,1] neg_hi:[0,1]
v_pk_add_f32 v[34:35], v[34:35], v[66:67]
v_pk_mul_f32 v[66:67], v[64:65], s[50:51] op_sel:[0,1] op_sel_hi:[0,0] neg_lo:[0,1] neg_hi:[0,1]
v_pk_fma_f32 v[66:67], v[64:65], s[50:51], v[66:67] op_sel:[1,0,0] op_sel_hi:[1,1,1] neg_lo:[0,0,0] neg_hi:[0,1,0]
v_pk_add_f32 v[64:65], v[36:37], v[68:69] neg_lo:[0,1] neg_hi:[0,1]
v_pk_add_f32 v[36:37], v[36:37], v[68:69]
v_pk_mul_f32 v[68:69], v[64:65], s[54:55] op_sel:[0,1] op_sel_hi:[0,0] neg_lo:[0,1] neg_hi:[0,1]
v_pk_fma_f32 v[68:69], v[64:65], s[54:55], v[68:69] op_sel:[1,0,0] op_sel_hi:[1,1,1] neg_lo:[0,0,0] neg_hi:[0,1,0]
v_pk_add_f32 v[64:65], v[38:39], v[70:71] neg_lo:[0,1] neg_hi:[0,1]
v_pk_add_f32 v[38:39], v[38:39], v[70:71]
v_pk_mul_f32 v[70:71], v[64:65], s[58:59] op_sel:[0,1] op_sel_hi:[0,0] neg_lo:[0,1] neg_hi:[0,1]
v_pk_fma_f32 v[70:71], v[64:65], s[58:59], v[70:71] op_sel:[1,0,0] op_sel_hi:[1,1,1] neg_lo:[0,0,0] neg_hi:[0,1,0]
v_pk_add_f32 v[64:65], v[40:41], v[72:73] neg_lo:[0,1] neg_hi:[0,1]
v_pk_add_f32 v[40:41], v[40:41], v[72:73]
v_pk_mul_f32 v[72:73], v[64:65], s[62:63] op_sel:[0,0] op_sel_hi:[0,1] neg_lo:[0,1] neg_hi:[0,1]
v_pk_fma_f32 v[72:73], v[64:65], s[62:63], v[72:73] op_sel:[1,1,0] op_sel_hi:[1,0,1] neg_lo:[0,0,0] neg_hi:[0,1,0]
v_pk_add_f32 v[64:65], v[42:43], v[74:75] neg_lo:[0,1] neg_hi:[0,1]
v_pk_add_f32 v[42:43], v[42:43], v[74:75]
v_pk_mul_f32 v[74:75], v[64:65], s[58:59] op_sel:[0,0] op_sel_hi:[0,1] neg_lo:[0,1] neg_hi:[0,1]
v_pk_fma_f32 v[74:75], v[64:65], s[58:59], v[74:75] op_sel:[1,1,0] op_sel_hi:[1,0,1] neg_lo:[0,0,0] neg_hi:[0,1,0]
v_pk_add_f32 v[64:65], v[44:45], v[76:77] neg_lo:[0,1] neg_hi:[0,1]
v_pk_add_f32 v[44:45], v[44:45], v[76:77]
v_pk_mul_f32 v[76:77], v[64:65], s[54:55] op_sel:[0,0] op_sel_hi:[0,1] neg_lo:[0,1] neg_hi:[0,1]
v_pk_fma_f32 v[76:77], v[64:65], s[54:55], v[76:77] op_sel:[1,1,0] op_sel_hi:[1,0,1] neg_lo:[0,0,0] neg_hi:[0,1,0]
v_pk_add_f32 v[64:65], v[46:47], v[78:79] neg_lo:[0,1] neg_hi:[0,1]
v_pk_add_f32 v[46:47], v[46:47], v[78:79]
v_pk_mul_f32 v[78:79], v[64:65], s[50:51] op_sel:[0,0] op_sel_hi:[0,1] neg_lo:[0,1] neg_hi:[0,1]
v_pk_fma_f32 v[78:79], v[64:65], s[50:51], v[78:79] op_sel:[1,1,0] op_sel_hi:[1,0,1] neg_lo:[0,0,0] neg_hi:[0,1,0]
v_pk_add_f32 v[64:65], v[16:17], v[32:33] neg_lo:[0,1] neg_hi:[0,1]
v_pk_add_f32 v[16:17], v[16:17], v[32:33]
v_pk_add_f32 v[32:33], v[18:19], v[34:35] neg_lo:[0,1] neg_hi:[0,1]
v_pk_add_f32 v[18:19], v[18:19], v[34:35]
v_pk_mul_f32 v[34:35], v[32:33], s[54:55] op_sel:[0,0] op_sel_hi:[0,1] neg_lo:[0,0] neg_hi:[0,1]
v_pk_fma_f32 v[34:35], v[32:33], s[54:55], v[34:35] op_sel:[1,1,0] op_sel_hi:[1,0,1] neg_lo:[0,0,0] neg_hi:[0,0,0]
v_pk_add_f32 v[32:33], v[20:21], v[36:37] neg_lo:[0,1] neg_hi:[0,1]
v_pk_add_f32 v[20:21], v[20:21], v[36:37]
v_pk_mul_f32 v[36:37], v[32:33], s[62:63] op_sel:[0,0] op_sel_hi:[0,1] neg_lo:[0,0] neg_hi:[0,1]
v_pk_fma_f32 v[36:37], v[32:33], s[62:63], v[36:37] op_sel:[1,1,0] op_sel_hi:[1,0,1] neg_lo:[0,0,0] neg_hi:[0,0,0]
v_pk_add_f32 v[32:33], v[22:23], v[38:39] neg_lo:[0,1] neg_hi:[0,1]
v_pk_add_f32 v[22:23], v[22:23], v[38:39]
v_pk_mul_f32 v[38:39], v[32:33], s[54:55] op_sel:[0,1] op_sel_hi:[0,0] neg_lo:[0,0] neg_hi:[0,1]
v_pk_fma_f32 v[38:39], v[32:33], s[54:55], v[38:39] op_sel:[1,0,0] op_sel_hi:[1,1,1] neg_lo:[0,0,0] neg_hi:[0,0,0]
v_pk_add_f32 v[32:33], v[24:25], v[40:41] op_sel:[1,1] op_sel_hi:[0,0] neg_lo:[0,1] neg_hi:[1,0]
v_pk_add_f32 v[24:25], v[24:25], v[40:41]
v_pk_add_f32 v[40:41], v[26:27], v[42:43] neg_lo:[0,1] neg_hi:[0,1]
v_pk_add_f32 v[26:27], v[26:27], v[42:43]
v_pk_mul_f32 v[42:43], v[40:41], s[54:55] op_sel:[0,1] op_sel_hi:[0,0] neg_lo:[0,1] neg_hi:[0,1]
v_pk_fma_f32 v[42:43], v[40:41], s[54:55], v[42:43] op_sel:[1,0,0] op_sel_hi:[1,1,1] neg_lo:[0,0,0] neg_hi:[0,1,0]
v_pk_add_f32 v[40:41], v[28:29], v[44:45] neg_lo:[0,1] neg_hi:[0,1]
v_pk_add_f32 v[28:29], v[28:29], v[44:45]
v_pk_mul_f32 v[44:45], v[40:41], s[62:63] op_sel:[0,0] op_sel_hi:[0,1] neg_lo:[0,1] neg_hi:[0,1]
v_pk_fma_f32 v[44:45], v[40:41], s[62:63], v[44:45] op_sel:[1,1,0] op_sel_hi:[1,0,1] neg_lo:[0,0,0] neg_hi:[0,1,0]
v_pk_add_f32 v[40:41], v[30:31], v[46:47] neg_lo:[0,1] neg_hi:[0,1]
v_pk_add_f32 v[30:31], v[30:31], v[46:47]
v_pk_mul_f32 v[46:47], v[40:41], s[54:55] op_sel:[0,0] op_sel_hi:[0,1] neg_lo:[0,1] neg_hi:[0,1]
v_pk_fma_f32 v[46:47], v[40:41], s[54:55], v[46:47] op_sel:[1,1,0] op_sel_hi:[1,0,1] neg_lo:[0,0,0] neg_hi:[0,1,0]
v_pk_add_f32 v[40:41], v[14:15], v[48:49] neg_lo:[0,1] neg_hi:[0,1]
v_pk_add_f32 v[14:15], v[14:15], v[48:49]
v_pk_add_f32 v[48:49], v[50:51], v[66:67] neg_lo:[0,1] neg_hi:[0,1]
v_pk_add_f32 v[50:51], v[50:51], v[66:67]
v_pk_mul_f32 v[66:67], v[48:49], s[54:55] op_sel:[0,0] op_sel_hi:[0,1] neg_lo:[0,0] neg_hi:[0,1]
v_pk_fma_f32 v[66:67], v[48:49], s[54:55], v[66:67] op_sel:[1,1,0] op_sel_hi:[1,0,1] neg_lo:[0,0,0] neg_hi:[0,0,0]
v_pk_add_f32 v[48:49], v[52:53], v[68:69] neg_lo:[0,1] neg_hi:[0,1]
v_pk_add_f32 v[52:53], v[52:53], v[68:69]
v_pk_mul_f32 v[68:69], v[48:49], s[62:63] op_sel:[0,0] op_sel_hi:[0,1] neg_lo:[0,0] neg_hi:[0,1]
v_pk_fma_f32 v[68:69], v[48:49], s[62:63], v[68:69] op_sel:[1,1,0] op_sel_hi:[1,0,1] neg_lo:[0,0,0] neg_hi:[0,0,0]
v_pk_add_f32 v[48:49], v[54:55], v[70:71] neg_lo:[0,1] neg_hi:[0,1]
v_pk_add_f32 v[54:55], v[54:55], v[70:71]
v_pk_mul_f32 v[70:71], v[48:49], s[54:55] op_sel:[0,1] op_sel_hi:[0,0] neg_lo:[0,0] neg_hi:[0,1]
v_pk_fma_f32 v[70:71], v[48:49], s[54:55], v[70:71] op_sel:[1,0,0] op_sel_hi:[1,1,1] neg_lo:[0,0,0] neg_hi:[0,0,0]
v_pk_add_f32 v[48:49], v[56:57], v[72:73] op_sel:[1,1] op_sel_hi:[0,0] neg_lo:[0,1] neg_hi:[1,0]
v_pk_add_f32 v[56:57], v[56:57], v[72:73]
v_pk_add_f32 v[72:73], v[58:59], v[74:75] neg_lo:[0,1] neg_hi:[0,1]
v_pk_add_f32 v[58:59], v[58:59], v[74:75]
v_pk_mul_f32 v[74:75], v[72:73], s[54:55] op_sel:[0,1] op_sel_hi:[0,0] neg_lo:[0,1] neg_hi:[0,1]
v_pk_fma_f32 v[74:75], v[72:73], s[54:55], v[74:75] op_sel:[1,0,0] op_sel_hi:[1,1,1] neg_lo:[0,0,0] neg_hi:[0,1,0]
v_pk_add_f32 v[72:73], v[60:61], v[76:77] neg_lo:[0,1] neg_hi:[0,1]
v_pk_add_f32 v[60:61], v[60:61], v[76:77]
v_pk_mul_f32 v[76:77], v[72:73], s[62:63] op_sel:[0,0] op_sel_hi:[0,1] neg_lo:[0,1] neg_hi:[0,1]
v_pk_fma_f32 v[76:77], v[72:73], s[62:63], v[76:77] op_sel:[1,1,0] op_sel_hi:[1,0,1] neg_lo:[0,0,0] neg_hi:[0,1,0]
v_pk_add_f32 v[72:73], v[62:63], v[78:79] neg_lo:[0,1] neg_hi:[0,1]
v_pk_add_f32 v[62:63], v[62:63], v[78:79]
v_pk_mul_f32 v[78:79], v[72:73], s[54:55] op_sel:[0,0] op_sel_hi:[0,1] neg_lo:[0,1] neg_hi:[0,1]
v_pk_fma_f32 v[78:79], v[72:73], s[54:55], v[78:79] op_sel:[1,1,0] op_sel_hi:[1,0,1] neg_lo:[0,0,0] neg_hi:[0,1,0]
v_pk_add_f32 v[72:73], v[16:17], v[24:25] neg_lo:[0,1] neg_hi:[0,1]
v_pk_add_f32 v[16:17], v[16:17], v[24:25]
v_pk_add_f32 v[24:25], v[18:19], v[26:27] neg_lo:[0,1] neg_hi:[0,1]
v_pk_add_f32 v[18:19], v[18:19], v[26:27]
v_pk_mul_f32 v[26:27], v[24:25], s[62:63] op_sel:[0,0] op_sel_hi:[0,1] neg_lo:[0,0] neg_hi:[0,1]
v_pk_fma_f32 v[26:27], v[24:25], s[62:63], v[26:27] op_sel:[1,1,0] op_sel_hi:[1,0,1] neg_lo:[0,0,0] neg_hi:[0,0,0]
v_pk_add_f32 v[24:25], v[20:21], v[28:29] op_sel:[1,1] op_sel_hi:[0,0] neg_lo:[0,1] neg_hi:[1,0]
v_pk_add_f32 v[20:21], v[20:21], v[28:29]
v_pk_add_f32 v[28:29], v[22:23], v[30:31] neg_lo:[0,1] neg_hi:[0,1]
v_pk_add_f32 v[22:23], v[22:23], v[30:31]
v_pk_mul_f32 v[30:31], v[28:29], s[62:63] op_sel:[0,0] op_sel_hi:[0,1] neg_lo:[0,1] neg_hi:[0,1]
v_pk_fma_f32 v[30:31], v[28:29], s[62:63], v[30:31] op_sel:[1,1,0] op_sel_hi:[1,0,1] neg_lo:[0,0,0] neg_hi:[0,1,0]
v_pk_add_f32 v[28:29], v[64:65], v[32:33] neg_lo:[0,1] neg_hi:[0,1]
v_pk_add_f32 v[64:65], v[64:65], v[32:33]
v_pk_add_f32 v[32:33], v[34:35], v[42:43] neg_lo:[0,1] neg_hi:[0,1]
v_pk_add_f32 v[34:35], v[34:35], v[42:43]
v_pk_mul_f32 v[42:43], v[32:33], s[62:63] op_sel:[0,0] op_sel_hi:[0,1] neg_lo:[0,0] neg_hi:[0,1]
v_pk_fma_f32 v[42:43], v[32:33], s[62:63], v[42:43] op_sel:[1,1,0] op_sel_hi:[1,0,1] neg_lo:[0,0,0] neg_hi:[0,0,0]
v_pk_add_f32 v[32:33], v[36:37], v[44:45] op_sel:[1,1] op_sel_hi:[0,0] neg_lo:[0,1] neg_hi:[1,0]
v_pk_add_f32 v[36:37], v[36:37], v[44:45]
v_pk_add_f32 v[44:45], v[38:39], v[46:47] neg_lo:[0,1] neg_hi:[0,1]
v_pk_add_f32 v[38:39], v[38:39], v[46:47]
v_pk_mul_f32 v[46:47], v[44:45], s[62:63] op_sel:[0,0] op_sel_hi:[0,1] neg_lo:[0,1] neg_hi:[0,1]
v_pk_fma_f32 v[46:47], v[44:45], s[62:63], v[46:47] op_sel:[1,1,0] op_sel_hi:[1,0,1] neg_lo:[0,0,0] neg_hi:[0,1,0]
v_pk_add_f32 v[44:45], v[14:15], v[56:57] neg_lo:[0,1] neg_hi:[0,1]
v_pk_add_f32 v[14:15], v[14:15], v[56:57]
v_pk_add_f32 v[56:57], v[50:51], v[58:59] neg_lo:[0,1] neg_hi:[0,1]
v_pk_add_f32 v[50:51], v[50:51], v[58:59]
v_pk_mul_f32 v[58:59], v[56:57], s[62:63] op_sel:[0,0] op_sel_hi:[0,1] neg_lo:[0,0] neg_hi:[0,1]
v_pk_fma_f32 v[58:59], v[56:57], s[62:63], v[58:59] op_sel:[1,1,0] op_sel_hi:[1,0,1] neg_lo:[0,0,0] neg_hi:[0,0,0]
v_pk_add_f32 v[56:57], v[52:53], v[60:61] op_sel:[1,1] op_sel_hi:[0,0] neg_lo:[0,1] neg_hi:[1,0]
v_pk_add_f32 v[52:53], v[52:53], v[60:61]
v_pk_add_f32 v[60:61], v[54:55], v[62:63] neg_lo:[0,1] neg_hi:[0,1]
v_pk_add_f32 v[54:55], v[54:55], v[62:63]
v_pk_mul_f32 v[62:63], v[60:61], s[62:63] op_sel:[0,0] op_sel_hi:[0,1] neg_lo:[0,1] neg_hi:[0,1]
v_pk_fma_f32 v[62:63], v[60:61], s[62:63], v[62:63] op_sel:[1,1,0] op_sel_hi:[1,0,1] neg_lo:[0,0,0] neg_hi:[0,1,0]
v_pk_add_f32 v[60:61], v[40:41], v[48:49] neg_lo:[0,1] neg_hi:[0,1]
v_pk_add_f32 v[40:41], v[40:41], v[48:49]
v_pk_add_f32 v[48:49], v[66:67], v[74:75] neg_lo:[0,1] neg_hi:[0,1]
v_pk_add_f32 v[66:67], v[66:67], v[74:75]
v_pk_mul_f32 v[74:75], v[48:49], s[62:63] op_sel:[0,0] op_sel_hi:[0,1] neg_lo:[0,0] neg_hi:[0,1]
v_pk_fma_f32 v[74:75], v[48:49], s[62:63], v[74:75] op_sel:[1,1,0] op_sel_hi:[1,0,1] neg_lo:[0,0,0] neg_hi:[0,0,0]
v_pk_add_f32 v[48:49], v[68:69], v[76:77] op_sel:[1,1] op_sel_hi:[0,0] neg_lo:[0,1] neg_hi:[1,0]
v_pk_add_f32 v[68:69], v[68:69], v[76:77]
v_pk_add_f32 v[76:77], v[70:71], v[78:79] neg_lo:[0,1] neg_hi:[0,1]
v_pk_add_f32 v[70:71], v[70:71], v[78:79]
v_pk_mul_f32 v[78:79], v[76:77], s[62:63] op_sel:[0,0] op_sel_hi:[0,1] neg_lo:[0,1] neg_hi:[0,1]
v_pk_fma_f32 v[78:79], v[76:77], s[62:63], v[78:79] op_sel:[1,1,0] op_sel_hi:[1,0,1] neg_lo:[0,0,0] neg_hi:[0,1,0]
v_pk_add_f32 v[76:77], v[16:17], v[20:21] neg_lo:[0,1] neg_hi:[0,1]
v_pk_add_f32 v[16:17], v[16:17], v[20:21]
v_pk_add_f32 v[20:21], v[18:19], v[22:23] op_sel:[1,1] op_sel_hi:[0,0] neg_lo:[0,1] neg_hi:[1,0]
v_pk_add_f32 v[18:19], v[18:19], v[22:23]
v_pk_add_f32 v[22:23], v[72:73], v[24:25] neg_lo:[0,1] neg_hi:[0,1]
v_pk_add_f32 v[72:73], v[72:73], v[24:25]
v_pk_add_f32 v[24:25], v[26:27], v[30:31] op_sel:[1,1] op_sel_hi:[0,0] neg_lo:[0,1] neg_hi:[1,0]
v_pk_add_f32 v[26:27], v[26:27], v[30:31]
v_pk_add_f32 v[30:31], v[64:65], v[36:37] neg_lo:[0,1] neg_hi:[0,1]
v_pk_add_f32 v[64:65], v[64:65], v[36:37]
v_pk_add_f32 v[36:37], v[34:35], v[38:39] op_sel:[1,1] op_sel_hi:[0,0] neg_lo:[0,1] neg_hi:[1,0]
v_pk_add_f32 v[34:35], v[34:35], v[38:39]
v_pk_add_f32 v[38:39], v[28:29], v[32:33] neg_lo:[0,1] neg_hi:[0,1]
v_pk_add_f32 v[28:29], v[28:29], v[32:33]
v_pk_add_f32 v[32:33], v[42:43], v[46:47] op_sel:[1,1] op_sel_hi:[0,0] neg_lo:[0,1] neg_hi:[1,0]
v_pk_add_f32 v[42:43], v[42:43], v[46:47]
v_pk_add_f32 v[46:47], v[14:15], v[52:53] neg_lo:[0,1] neg_hi:[0,1]
v_pk_add_f32 v[14:15], v[14:15], v[52:53]
v_pk_add_f32 v[52:53], v[50:51], v[54:55] op_sel:[1,1] op_sel_hi:[0,0] neg_lo:[0,1] neg_hi:[1,0]
v_pk_add_f32 v[50:51], v[50:51], v[54:55]
v_pk_add_f32 v[54:55], v[44:45], v[56:57] neg_lo:[0,1] neg_hi:[0,1]
v_pk_add_f32 v[44:45], v[44:45], v[56:57]
v_pk_add_f32 v[56:57], v[58:59], v[62:63] op_sel:[1,1] op_sel_hi:[0,0] neg_lo:[0,1] neg_hi:[1,0]
v_pk_add_f32 v[58:59], v[58:59], v[62:63]
v_pk_add_f32 v[62:63], v[40:41], v[68:69] neg_lo:[0,1] neg_hi:[0,1]
v_pk_add_f32 v[40:41], v[40:41], v[68:69]
v_pk_add_f32 v[68:69], v[66:67], v[70:71] op_sel:[1,1] op_sel_hi:[0,0] neg_lo:[0,1] neg_hi:[1,0]
v_pk_add_f32 v[66:67], v[66:67], v[70:71]
v_pk_add_f32 v[70:71], v[60:61], v[48:49] neg_lo:[0,1] neg_hi:[0,1]
v_pk_add_f32 v[60:61], v[60:61], v[48:49]
v_pk_add_f32 v[48:49], v[74:75], v[78:79] op_sel:[1,1] op_sel_hi:[0,0] neg_lo:[0,1] neg_hi:[1,0]
v_pk_add_f32 v[74:75], v[74:75], v[78:79]
v_pk_add_f32 v[78:79], v[16:17], v[18:19] neg_lo:[0,1] neg_hi:[0,1]
v_pk_add_f32 v[16:17], v[16:17], v[18:19]
v_pk_add_f32 v[18:19], v[76:77], v[20:21] neg_lo:[0,1] neg_hi:[0,1]
v_pk_add_f32 v[76:77], v[76:77], v[20:21]
v_pk_add_f32 v[20:21], v[72:73], v[26:27] neg_lo:[0,1] neg_hi:[0,1]
v_pk_add_f32 v[72:73], v[72:73], v[26:27]
v_pk_add_f32 v[26:27], v[22:23], v[24:25] neg_lo:[0,1] neg_hi:[0,1]
v_pk_add_f32 v[22:23], v[22:23], v[24:25]
v_pk_add_f32 v[24:25], v[64:65], v[34:35] neg_lo:[0,1] neg_hi:[0,1]
v_pk_add_f32 v[64:65], v[64:65], v[34:35]
v_pk_add_f32 v[34:35], v[30:31], v[36:37] neg_lo:[0,1] neg_hi:[0,1]
v_pk_add_f32 v[30:31], v[30:31], v[36:37]
v_pk_add_f32 v[36:37], v[28:29], v[42:43] neg_lo:[0,1] neg_hi:[0,1]
v_pk_add_f32 v[28:29], v[28:29], v[42:43]
v_pk_add_f32 v[42:43], v[38:39], v[32:33] neg_lo:[0,1] neg_hi:[0,1]
v_pk_add_f32 v[38:39], v[38:39], v[32:33]
v_pk_add_f32 v[32:33], v[14:15], v[50:51] neg_lo:[0,1] neg_hi:[0,1]
v_pk_add_f32 v[14:15], v[14:15], v[50:51]
v_pk_add_f32 v[50:51], v[46:47], v[52:53] neg_lo:[0,1] neg_hi:[0,1]
v_pk_add_f32 v[46:47], v[46:47], v[52:53]
v_pk_add_f32 v[52:53], v[44:45], v[58:59] neg_lo:[0,1] neg_hi:[0,1]
v_pk_add_f32 v[44:45], v[44:45], v[58:59]
v_pk_add_f32 v[58:59], v[54:55], v[56:57] neg_lo:[0,1] neg_hi:[0,1]
v_pk_add_f32 v[54:55], v[54:55], v[56:57]
v_pk_add_f32 v[56:57], v[40:41], v[66:67] neg_lo:[0,1] neg_hi:[0,1]
v_pk_add_f32 v[40:41], v[40:41], v[66:67]
v_pk_add_f32 v[66:67], v[62:63], v[68:69] neg_lo:[0,1] neg_hi:[0,1]
v_pk_add_f32 v[62:63], v[62:63], v[68:69]
v_pk_add_f32 v[68:69], v[60:61], v[74:75] neg_lo:[0,1] neg_hi:[0,1]
v_pk_add_f32 v[60:61], v[60:61], v[74:75]
v_pk_add_f32 v[74:75], v[70:71], v[48:49] neg_lo:[0,1] neg_hi:[0,1]
v_pk_add_f32 v[70:71], v[70:71], v[48:49]
v_pk_mul_f32 v[48:49], v[14:15], v[82:83] op_sel:[0,0] op_sel_hi:[0,1] neg_lo:[0,0] neg_hi:[0,0]
v_pk_fma_f32 v[14:15], v[14:15], v[82:83], v[48:49] op_sel:[1,1,0] op_sel_hi:[1,0,1] neg_lo:[0,1,0] neg_hi:[0,0,0]
v_pk_mul_f32 v[48:49], v[64:65], v[84:85] op_sel:[0,0] op_sel_hi:[0,1] neg_lo:[0,0] neg_hi:[0,0]
v_pk_fma_f32 v[64:65], v[64:65], v[84:85], v[48:49] op_sel:[1,1,0] op_sel_hi:[1,0,1] neg_lo:[0,1,0] neg_hi:[0,0,0]
v_pk_mul_f32 v[48:49], v[40:41], v[86:87] op_sel:[0,0] op_sel_hi:[0,1] neg_lo:[0,0] neg_hi:[0,0]
v_pk_fma_f32 v[40:41], v[40:41], v[86:87], v[48:49] op_sel:[1,1,0] op_sel_hi:[1,0,1] neg_lo:[0,1,0] neg_hi:[0,0,0]
v_pk_mul_f32 v[48:49], v[72:73], v[88:89] op_sel:[0,0] op_sel_hi:[0,1] neg_lo:[0,0] neg_hi:[0,0]
v_pk_fma_f32 v[72:73], v[72:73], v[88:89], v[48:49] op_sel:[1,1,0] op_sel_hi:[1,0,1] neg_lo:[0,1,0] neg_hi:[0,0,0]
v_pk_mul_f32 v[48:49], v[44:45], v[90:91] op_sel:[0,0] op_sel_hi:[0,1] neg_lo:[0,0] neg_hi:[0,0]
v_pk_fma_f32 v[44:45], v[44:45], v[90:91], v[48:49] op_sel:[1,1,0] op_sel_hi:[1,0,1] neg_lo:[0,1,0] neg_hi:[0,0,0]
v_pk_mul_f32 v[48:49], v[28:29], v[92:93] op_sel:[0,0] op_sel_hi:[0,1] neg_lo:[0,0] neg_hi:[0,0]
v_pk_fma_f32 v[28:29], v[28:29], v[92:93], v[48:49] op_sel:[1,1,0] op_sel_hi:[1,0,1] neg_lo:[0,1,0] neg_hi:[0,0,0]
v_pk_mul_f32 v[48:49], v[60:61], v[94:95] op_sel:[0,0] op_sel_hi:[0,1] neg_lo:[0,0] neg_hi:[0,0]
v_pk_fma_f32 v[60:61], v[60:61], v[94:95], v[48:49] op_sel:[1,1,0] op_sel_hi:[1,0,1] neg_lo:[0,1,0] neg_hi:[0,0,0]
v_pk_mul_f32 v[48:49], v[76:77], v[96:97] op_sel:[0,0] op_sel_hi:[0,1] neg_lo:[0,0] neg_hi:[0,0]
v_pk_fma_f32 v[76:77], v[76:77], v[96:97], v[48:49] op_sel:[1,1,0] op_sel_hi:[1,0,1] neg_lo:[0,1,0] neg_hi:[0,0,0]
v_pk_mul_f32 v[48:49], v[46:47], v[98:99] op_sel:[0,0] op_sel_hi:[0,1] neg_lo:[0,0] neg_hi:[0,0]
v_pk_fma_f32 v[46:47], v[46:47], v[98:99], v[48:49] op_sel:[1,1,0] op_sel_hi:[1,0,1] neg_lo:[0,1,0] neg_hi:[0,0,0]
v_pk_mul_f32 v[48:49], v[30:31], v[100:101] op_sel:[0,0] op_sel_hi:[0,1] neg_lo:[0,0] neg_hi:[0,0]
v_pk_fma_f32 v[30:31], v[30:31], v[100:101], v[48:49] op_sel:[1,1,0] op_sel_hi:[1,0,1] neg_lo:[0,1,0] neg_hi:[0,0,0]
v_pk_mul_f32 v[48:49], v[62:63], v[102:103] op_sel:[0,0] op_sel_hi:[0,1] neg_lo:[0,0] neg_hi:[0,0]
v_pk_fma_f32 v[62:63], v[62:63], v[102:103], v[48:49] op_sel:[1,1,0] op_sel_hi:[1,0,1] neg_lo:[0,1,0] neg_hi:[0,0,0]
v_pk_mul_f32 v[48:49], v[22:23], v[104:105] op_sel:[0,0] op_sel_hi:[0,1] neg_lo:[0,0] neg_hi:[0,0]
v_pk_fma_f32 v[22:23], v[22:23], v[104:105], v[48:49] op_sel:[1,1,0] op_sel_hi:[1,0,1] neg_lo:[0,1,0] neg_hi:[0,0,0]
v_pk_mul_f32 v[48:49], v[54:55], v[106:107] op_sel:[0,0] op_sel_hi:[0,1] neg_lo:[0,0] neg_hi:[0,0]
v_pk_fma_f32 v[54:55], v[54:55], v[106:107], v[48:49] op_sel:[1,1,0] op_sel_hi:[1,0,1] neg_lo:[0,1,0] neg_hi:[0,0,0]
v_pk_mul_f32 v[48:49], v[38:39], v[108:109] op_sel:[0,0] op_sel_hi:[0,1] neg_lo:[0,0] neg_hi:[0,0]
v_pk_fma_f32 v[38:39], v[38:39], v[108:109], v[48:49] op_sel:[1,1,0] op_sel_hi:[1,0,1] neg_lo:[0,1,0] neg_hi:[0,0,0]
v_pk_mul_f32 v[48:49], v[70:71], v[110:111] op_sel:[0,0] op_sel_hi:[0,1] neg_lo:[0,0] neg_hi:[0,0]
v_pk_fma_f32 v[70:71], v[70:71], v[110:111], v[48:49] op_sel:[1,1,0] op_sel_hi:[1,0,1] neg_lo:[0,1,0] neg_hi:[0,0,0]
v_pk_mul_f32 v[48:49], v[78:79], v[112:113] op_sel:[0,0] op_sel_hi:[0,1] neg_lo:[0,0] neg_hi:[0,0]
v_pk_fma_f32 v[78:79], v[78:79], v[112:113], v[48:49] op_sel:[1,1,0] op_sel_hi:[1,0,1] neg_lo:[0,1,0] neg_hi:[0,0,0]
v_pk_mul_f32 v[48:49], v[32:33], v[114:115] op_sel:[0,0] op_sel_hi:[0,1] neg_lo:[0,0] neg_hi:[0,0]
v_pk_fma_f32 v[32:33], v[32:33], v[114:115], v[48:49] op_sel:[1,1,0] op_sel_hi:[1,0,1] neg_lo:[0,1,0] neg_hi:[0,0,0]
v_pk_mul_f32 v[48:49], v[24:25], v[116:117] op_sel:[0,0] op_sel_hi:[0,1] neg_lo:[0,0] neg_hi:[0,0]
v_pk_fma_f32 v[24:25], v[24:25], v[116:117], v[48:49] op_sel:[1,1,0] op_sel_hi:[1,0,1] neg_lo:[0,1,0] neg_hi:[0,0,0]
v_pk_mul_f32 v[48:49], v[56:57], v[118:119] op_sel:[0,0] op_sel_hi:[0,1] neg_lo:[0,0] neg_hi:[0,0]
v_pk_fma_f32 v[56:57], v[56:57], v[118:119], v[48:49] op_sel:[1,1,0] op_sel_hi:[1,0,1] neg_lo:[0,1,0] neg_hi:[0,0,0]
v_pk_mul_f32 v[48:49], v[20:21], v[120:121] op_sel:[0,0] op_sel_hi:[0,1] neg_lo:[0,0] neg_hi:[0,0]
v_pk_fma_f32 v[20:21], v[20:21], v[120:121], v[48:49] op_sel:[1,1,0] op_sel_hi:[1,0,1] neg_lo:[0,1,0] neg_hi:[0,0,0]
v_pk_mul_f32 v[48:49], v[52:53], v[122:123] op_sel:[0,0] op_sel_hi:[0,1] neg_lo:[0,0] neg_hi:[0,0]
v_pk_fma_f32 v[52:53], v[52:53], v[122:123], v[48:49] op_sel:[1,1,0] op_sel_hi:[1,0,1] neg_lo:[0,1,0] neg_hi:[0,0,0]
v_pk_mul_f32 v[48:49], v[36:37], v[124:125] op_sel:[0,0] op_sel_hi:[0,1] neg_lo:[0,0] neg_hi:[0,0]
v_pk_fma_f32 v[36:37], v[36:37], v[124:125], v[48:49] op_sel:[1,1,0] op_sel_hi:[1,0,1] neg_lo:[0,1,0] neg_hi:[0,0,0]
v_pk_mul_f32 v[48:49], v[68:69], v[126:127] op_sel:[0,0] op_sel_hi:[0,1] neg_lo:[0,0] neg_hi:[0,0]
v_pk_fma_f32 v[68:69], v[68:69], v[126:127], v[48:49] op_sel:[1,1,0] op_sel_hi:[1,0,1] neg_lo:[0,1,0] neg_hi:[0,0,0]
v_pk_mul_f32 v[48:49], v[18:19], v[128:129] op_sel:[0,0] op_sel_hi:[0,1] neg_lo:[0,0] neg_hi:[0,0]
v_pk_fma_f32 v[18:19], v[18:19], v[128:129], v[48:49] op_sel:[1,1,0] op_sel_hi:[1,0,1] neg_lo:[0,1,0] neg_hi:[0,0,0]
v_pk_mul_f32 v[48:49], v[50:51], v[130:131] op_sel:[0,0] op_sel_hi:[0,1] neg_lo:[0,0] neg_hi:[0,0]
v_pk_fma_f32 v[50:51], v[50:51], v[130:131], v[48:49] op_sel:[1,1,0] op_sel_hi:[1,0,1] neg_lo:[0,1,0] neg_hi:[0,0,0]
v_pk_mul_f32 v[48:49], v[34:35], v[132:133] op_sel:[0,0] op_sel_hi:[0,1] neg_lo:[0,0] neg_hi:[0,0]
v_pk_fma_f32 v[34:35], v[34:35], v[132:133], v[48:49] op_sel:[1,1,0] op_sel_hi:[1,0,1] neg_lo:[0,1,0] neg_hi:[0,0,0]
v_pk_mul_f32 v[48:49], v[66:67], v[134:135] op_sel:[0,0] op_sel_hi:[0,1] neg_lo:[0,0] neg_hi:[0,0]
v_pk_fma_f32 v[66:67], v[66:67], v[134:135], v[48:49] op_sel:[1,1,0] op_sel_hi:[1,0,1] neg_lo:[0,1,0] neg_hi:[0,0,0]
v_pk_mul_f32 v[48:49], v[26:27], v[136:137] op_sel:[0,0] op_sel_hi:[0,1] neg_lo:[0,0] neg_hi:[0,0]
v_pk_fma_f32 v[26:27], v[26:27], v[136:137], v[48:49] op_sel:[1,1,0] op_sel_hi:[1,0,1] neg_lo:[0,1,0] neg_hi:[0,0,0]
v_pk_mul_f32 v[48:49], v[58:59], v[138:139] op_sel:[0,0] op_sel_hi:[0,1] neg_lo:[0,0] neg_hi:[0,0]
v_pk_fma_f32 v[58:59], v[58:59], v[138:139], v[48:49] op_sel:[1,1,0] op_sel_hi:[1,0,1] neg_lo:[0,1,0] neg_hi:[0,0,0]
v_pk_mul_f32 v[48:49], v[42:43], v[140:141] op_sel:[0,0] op_sel_hi:[0,1] neg_lo:[0,0] neg_hi:[0,0]
v_pk_fma_f32 v[42:43], v[42:43], v[140:141], v[48:49] op_sel:[1,1,0] op_sel_hi:[1,0,1] neg_lo:[0,1,0] neg_hi:[0,0,0]
v_pk_mul_f32 v[48:49], v[74:75], v[142:143] op_sel:[0,0] op_sel_hi:[0,1] neg_lo:[0,0] neg_hi:[0,0]
v_pk_fma_f32 v[74:75], v[74:75], v[142:143], v[48:49] op_sel:[1,1,0] op_sel_hi:[1,0,1] neg_lo:[0,1,0] neg_hi:[0,0,0]
ds_write_b64 v3, v[16:17] offset:0
ds_write_b64 v3, v[14:15] offset:528
ds_write_b64 v3, v[64:65] offset:1056
ds_write_b64 v3, v[40:41] offset:1584
ds_write_b64 v3, v[72:73] offset:2112
ds_write_b64 v3, v[44:45] offset:2640
ds_write_b64 v3, v[28:29] offset:3168
ds_write_b64 v3, v[60:61] offset:3696
ds_write_b64 v3, v[76:77] offset:4224
ds_write_b64 v3, v[46:47] offset:4752
ds_write_b64 v3, v[30:31] offset:5280
ds_write_b64 v3, v[62:63] offset:5808
ds_write_b64 v3, v[22:23] offset:6336
ds_write_b64 v3, v[54:55] offset:6864
ds_write_b64 v3, v[38:39] offset:7392
ds_write_b64 v3, v[70:71] offset:7920
ds_write_b64 v3, v[78:79] offset:8448
ds_write_b64 v3, v[32:33] offset:8976
ds_write_b64 v3, v[24:25] offset:9504
ds_write_b64 v3, v[56:57] offset:10032
ds_write_b64 v3, v[20:21] offset:10560
ds_write_b64 v3, v[52:53] offset:11088
ds_write_b64 v3, v[36:37] offset:11616
ds_write_b64 v3, v[68:69] offset:12144
ds_write_b64 v3, v[18:19] offset:12672
ds_write_b64 v3, v[50:51] offset:13200
ds_write_b64 v3, v[34:35] offset:13728
ds_write_b64 v3, v[66:67] offset:14256
ds_write_b64 v3, v[26:27] offset:14784
ds_write_b64 v3, v[58:59] offset:15312
ds_write_b64 v3, v[42:43] offset:15840
ds_write_b64 v3, v[74:75] offset:16368
s_waitcnt lgkmcnt(0)
ds_read_b64 v[16:17], v4 offset:0
ds_read_b64 v[48:49], v4 offset:256
ds_read_b64 v[18:19], v4 offset:16
ds_read_b64 v[50:51], v4 offset:272
ds_read_b64 v[20:21], v4 offset:32
ds_read_b64 v[52:53], v4 offset:288
ds_read_b64 v[22:23], v4 offset:48
ds_read_b64 v[54:55], v4 offset:304
ds_read_b64 v[24:25], v4 offset:64
ds_read_b64 v[56:57], v4 offset:320
ds_read_b64 v[26:27], v4 offset:80
ds_read_b64 v[58:59], v4 offset:336
ds_read_b64 v[28:29], v4 offset:96
ds_read_b64 v[60:61], v4 offset:352
ds_read_b64 v[30:31], v4 offset:112
ds_read_b64 v[62:63], v4 offset:368
ds_read_b64 v[32:33], v4 offset:128
ds_read_b64 v[64:65], v4 offset:384
ds_read_b64 v[34:35], v4 offset:144
ds_read_b64 v[66:67], v4 offset:400
ds_read_b64 v[36:37], v4 offset:160
ds_read_b64 v[68:69], v4 offset:416
ds_read_b64 v[38:39], v4 offset:176
ds_read_b64 v[70:71], v4 offset:432
ds_read_b64 v[40:41], v4 offset:192
ds_read_b64 v[72:73], v4 offset:448
ds_read_b64 v[42:43], v4 offset:208
ds_read_b64 v[74:75], v4 offset:464
ds_read_b64 v[44:45], v4 offset:224
ds_read_b64 v[76:77], v4 offset:480
ds_read_b64 v[46:47], v4 offset:240
ds_read_b64 v[78:79], v4 offset:496
s_waitcnt lgkmcnt(0)
v_pk_add_f32 v[14:15], v[16:17], v[48:49] neg_lo:[0,1] neg_hi:[0,1]
v_pk_add_f32 v[16:17], v[16:17], v[48:49]
v_pk_add_f32 v[48:49], v[18:19], v[50:51] neg_lo:[0,1] neg_hi:[0,1]
v_pk_add_f32 v[18:19], v[18:19], v[50:51]
v_pk_mul_f32 v[50:51], v[48:49], s[50:51] op_sel:[0,0] op_sel_hi:[0,1] neg_lo:[0,0] neg_hi:[0,1]
v_pk_fma_f32 v[50:51], v[48:49], s[50:51], v[50:51] op_sel:[1,1,0] op_sel_hi:[1,0,1] neg_lo:[0,0,0] neg_hi:[0,0,0]
v_pk_add_f32 v[48:49], v[20:21], v[52:53] neg_lo:[0,1] neg_hi:[0,1]
v_pk_add_f32 v[20:21], v[20:21], v[52:53]
v_pk_mul_f32 v[52:53], v[48:49], s[54:55] op_sel:[0,0] op_sel_hi:[0,1] neg_lo:[0,0] neg_hi:[0,1]
v_pk_fma_f32 v[52:53], v[48:49], s[54:55], v[52:53] op_sel:[1,1,0] op_sel_hi:[1,0,1] neg_lo:[0,0,0] neg_hi:[0,0,0]
v_pk_add_f32 v[48:49], v[22:23], v[54:55] neg_lo:[0,1] neg_hi:[0,1]
v_pk_add_f32 v[22:23], v[22:23], v[54:55]
v_pk_mul_f32 v[54:55], v[48:49], s[58:59] op_sel:[0,0] op_sel_hi:[0,1] neg_lo:[0,0] neg_hi:[0,1]
v_pk_fma_f32 v[54:55], v[48:49], s[58:59], v[54:55] op_sel:[1,1,0] op_sel_hi:[1,0,1] neg_lo:[0,0,0] neg_hi:[0,0,0]
v_pk_add_f32 v[48:49], v[24:25], v[56:57] neg_lo:[0,1] neg_hi:[0,1]
v_pk_add_f32 v[24:25], v[24:25], v[56:57]
v_pk_mul_f32 v[56:57], v[48:49], s[62:63] op_sel:[0,0] op_sel_hi:[0,1] neg_lo:[0,0] neg_hi:[0,1]
v_pk_fma_f32 v[56:57], v[48:49], s[62:63], v[56:57] op_sel:[1,1,0] op_sel_hi:[1,0,1] neg_lo:[0,0,0] neg_hi:[0,0,0]
v_pk_add_f32 v[48:49], v[26:27], v[58:59] neg_lo:[0,1] neg_hi:[0,1]
v_pk_add_f32 v[26:27], v[26:27], v[58:59]
v_pk_mul_f32 v[58:59], v[48:49], s[58:59] op_sel:[0,1] op_sel_hi:[0,0] neg_lo:[0,0] neg_hi:[0,1]
v_pk_fma_f32 v[58:59], v[48:49], s[58:59], v[58:59] op_sel:[1,0,0] op_sel_hi:[1,1,1] neg_lo:[0,0,0] neg_hi:[0,0,0]
v_pk_add_f32 v[48:49], v[28:29], v[60:61] neg_lo:[0,1] neg_hi:[0,1]
v_pk_add_f32 v[28:29], v[28:29], v[60:61]
v_pk_mul_f32 v[60:61], v[48:49], s[54:55] op_sel:[0,1] op_sel_hi:[0,0] neg_lo:[0,0] neg_hi:[0,1]
v_pk_fma_f32 v[60:61], v[48:49], s[54:55], v[60:61] op_sel:[1,0,0] op_sel_hi:[1,1,1] neg_lo:[0,0,0] neg_hi:[0,0,0]
v_pk_add_f32 v[48:49], v[30:31], v[62:63] neg_lo:[0,1] neg_hi:[0,1]
v_pk_add_f32 v[30:31], v[30:31], v[62:63]
v_pk_mul_f32 v[62:63], v[48:49], s[50:51] op_sel:[0,1] op_sel_hi:[0,0] neg_lo:[0,0] neg_hi:[0,1]
v_pk_fma_f32 v[62:63], v[48:49], s[50:51], v[62:63] op_sel:[1,0,0] op_sel_hi:[1,1,1] neg_lo:[0,0,0] neg_hi:[0,0,0]
v_pk_add_f32 v[48:49], v[32:33], v[64:65] op_sel:[1,1] op_sel_hi:[0,0] neg_lo:[0,1] neg_hi:[1,0]
v_pk_add_f32 v[32:33], v[32:33], v[64:65]
v_pk_add_f32 v[64:65], v[34:35], v[66:67] neg_lo:[0,1] neg_hi:[0,1]
v_pk_add_f32 v[34:35], v[34:35], v[66:67]
v_pk_mul_f32 v[66:67], v[64:65], s[50:51] op_sel:[0,1] op_sel_hi:[0,0] neg_lo:[0,1] neg_hi:[0,1]
v_pk_fma_f32 v[66:67], v[64:65], s[50:51], v[66:67] op_sel:[1,0,0] op_sel_hi:[1,1,1] neg_lo:[0,0,0] neg_hi:[0,1,0]
v_pk_add_f32 v[64:65], v[36:37], v[68:69] neg_lo:[0,1] neg_hi:[0,1]
v_pk_add_f32 v[36:37], v[36:37], v[68:69]
v_pk_mul_f32 v[68:69], v[64:65], s[54:55] op_sel:[0,1] op_sel_hi:[0,0] neg_lo:[0,1] neg_hi:[0,1]
v_pk_fma_f32 v[68:69], v[64:65], s[54:55], v[68:69] op_sel:[1,0,0] op_sel_hi:[1,1,1] neg_lo:[0,0,0] neg_hi:[0,1,0]
v_pk_add_f32 v[64:65], v[38:39], v[70:71] neg_lo:[0,1] neg_hi:[0,1]
v_pk_add_f32 v[38:39], v[38:39], v[70:71]
v_pk_mul_f32 v[70:71], v[64:65], s[58:59] op_sel:[0,1] op_sel_hi:[0,0] neg_lo:[0,1] neg_hi:[0,1]
v_pk_fma_f32 v[70:71], v[64:65], s[58:59], v[70:71] op_sel:[1,0,0] op_sel_hi:[1,1,1] neg_lo:[0,0,0] neg_hi:[0,1,0]
v_pk_add_f32 v[64:65], v[40:41], v[72:73] neg_lo:[0,1] neg_hi:[0,1]
v_pk_add_f32 v[40:41], v[40:41], v[72:73]
v_pk_mul_f32 v[72:73], v[64:65], s[62:63] op_sel:[0,0] op_sel_hi:[0,1] neg_lo:[0,1] neg_hi:[0,1]
v_pk_fma_f32 v[72:73], v[64:65], s[62:63], v[72:73] op_sel:[1,1,0] op_sel_hi:[1,0,1] neg_lo:[0,0,0] neg_hi:[0,1,0]
v_pk_add_f32 v[64:65], v[42:43], v[74:75] neg_lo:[0,1] neg_hi:[0,1]
v_pk_add_f32 v[42:43], v[42:43], v[74:75]
v_pk_mul_f32 v[74:75], v[64:65], s[58:59] op_sel:[0,0] op_sel_hi:[0,1] neg_lo:[0,1] neg_hi:[0,1]
v_pk_fma_f32 v[74:75], v[64:65], s[58:59], v[74:75] op_sel:[1,1,0] op_sel_hi:[1,0,1] neg_lo:[0,0,0] neg_hi:[0,1,0]
v_pk_add_f32 v[64:65], v[44:45], v[76:77] neg_lo:[0,1] neg_hi:[0,1]
v_pk_add_f32 v[44:45], v[44:45], v[76:77]
v_pk_mul_f32 v[76:77], v[64:65], s[54:55] op_sel:[0,0] op_sel_hi:[0,1] neg_lo:[0,1] neg_hi:[0,1]
v_pk_fma_f32 v[76:77], v[64:65], s[54:55], v[76:77] op_sel:[1,1,0] op_sel_hi:[1,0,1] neg_lo:[0,0,0] neg_hi:[0,1,0]
v_pk_add_f32 v[64:65], v[46:47], v[78:79] neg_lo:[0,1] neg_hi:[0,1]
v_pk_add_f32 v[46:47], v[46:47], v[78:79]
v_pk_mul_f32 v[78:79], v[64:65], s[50:51] op_sel:[0,0] op_sel_hi:[0,1] neg_lo:[0,1] neg_hi:[0,1]
v_pk_fma_f32 v[78:79], v[64:65], s[50:51], v[78:79] op_sel:[1,1,0] op_sel_hi:[1,0,1] neg_lo:[0,0,0] neg_hi:[0,1,0]
v_pk_add_f32 v[64:65], v[16:17], v[32:33] neg_lo:[0,1] neg_hi:[0,1]
v_pk_add_f32 v[16:17], v[16:17], v[32:33]
v_pk_add_f32 v[32:33], v[18:19], v[34:35] neg_lo:[0,1] neg_hi:[0,1]
v_pk_add_f32 v[18:19], v[18:19], v[34:35]
v_pk_mul_f32 v[34:35], v[32:33], s[54:55] op_sel:[0,0] op_sel_hi:[0,1] neg_lo:[0,0] neg_hi:[0,1]
v_pk_fma_f32 v[34:35], v[32:33], s[54:55], v[34:35] op_sel:[1,1,0] op_sel_hi:[1,0,1] neg_lo:[0,0,0] neg_hi:[0,0,0]
v_pk_add_f32 v[32:33], v[20:21], v[36:37] neg_lo:[0,1] neg_hi:[0,1]
v_pk_add_f32 v[20:21], v[20:21], v[36:37]
v_pk_mul_f32 v[36:37], v[32:33], s[62:63] op_sel:[0,0] op_sel_hi:[0,1] neg_lo:[0,0] neg_hi:[0,1]
v_pk_fma_f32 v[36:37], v[32:33], s[62:63], v[36:37] op_sel:[1,1,0] op_sel_hi:[1,0,1] neg_lo:[0,0,0] neg_hi:[0,0,0]
v_pk_add_f32 v[32:33], v[22:23], v[38:39] neg_lo:[0,1] neg_hi:[0,1]
v_pk_add_f32 v[22:23], v[22:23], v[38:39]
v_pk_mul_f32 v[38:39], v[32:33], s[54:55] op_sel:[0,1] op_sel_hi:[0,0] neg_lo:[0,0] neg_hi:[0,1]
v_pk_fma_f32 v[38:39], v[32:33], s[54:55], v[38:39] op_sel:[1,0,0] op_sel_hi:[1,1,1] neg_lo:[0,0,0] neg_hi:[0,0,0]
v_pk_add_f32 v[32:33], v[24:25], v[40:41] op_sel:[1,1] op_sel_hi:[0,0] neg_lo:[0,1] neg_hi:[1,0]
v_pk_add_f32 v[24:25], v[24:25], v[40:41]
v_pk_add_f32 v[40:41], v[26:27], v[42:43] neg_lo:[0,1] neg_hi:[0,1]
v_pk_add_f32 v[26:27], v[26:27], v[42:43]
v_pk_mul_f32 v[42:43], v[40:41], s[54:55] op_sel:[0,1] op_sel_hi:[0,0] neg_lo:[0,1] neg_hi:[0,1]
v_pk_fma_f32 v[42:43], v[40:41], s[54:55], v[42:43] op_sel:[1,0,0] op_sel_hi:[1,1,1] neg_lo:[0,0,0] neg_hi:[0,1,0]
v_pk_add_f32 v[40:41], v[28:29], v[44:45] neg_lo:[0,1] neg_hi:[0,1]
v_pk_add_f32 v[28:29], v[28:29], v[44:45]
v_pk_mul_f32 v[44:45], v[40:41], s[62:63] op_sel:[0,0] op_sel_hi:[0,1] neg_lo:[0,1] neg_hi:[0,1]
v_pk_fma_f32 v[44:45], v[40:41], s[62:63], v[44:45] op_sel:[1,1,0] op_sel_hi:[1,0,1] neg_lo:[0,0,0] neg_hi:[0,1,0]
v_pk_add_f32 v[40:41], v[30:31], v[46:47] neg_lo:[0,1] neg_hi:[0,1]
v_pk_add_f32 v[30:31], v[30:31], v[46:47]
v_pk_mul_f32 v[46:47], v[40:41], s[54:55] op_sel:[0,0] op_sel_hi:[0,1] neg_lo:[0,1] neg_hi:[0,1]
v_pk_fma_f32 v[46:47], v[40:41], s[54:55], v[46:47] op_sel:[1,1,0] op_sel_hi:[1,0,1] neg_lo:[0,0,0] neg_hi:[0,1,0]
v_pk_add_f32 v[40:41], v[14:15], v[48:49] neg_lo:[0,1] neg_hi:[0,1]
v_pk_add_f32 v[14:15], v[14:15], v[48:49]
v_pk_add_f32 v[48:49], v[50:51], v[66:67] neg_lo:[0,1] neg_hi:[0,1]
v_pk_add_f32 v[50:51], v[50:51], v[66:67]
v_pk_mul_f32 v[66:67], v[48:49], s[54:55] op_sel:[0,0] op_sel_hi:[0,1] neg_lo:[0,0] neg_hi:[0,1]
v_pk_fma_f32 v[66:67], v[48:49], s[54:55], v[66:67] op_sel:[1,1,0] op_sel_hi:[1,0,1] neg_lo:[0,0,0] neg_hi:[0,0,0]
v_pk_add_f32 v[48:49], v[52:53], v[68:69] neg_lo:[0,1] neg_hi:[0,1]
v_pk_add_f32 v[52:53], v[52:53], v[68:69]
v_pk_mul_f32 v[68:69], v[48:49], s[62:63] op_sel:[0,0] op_sel_hi:[0,1] neg_lo:[0,0] neg_hi:[0,1]
v_pk_fma_f32 v[68:69], v[48:49], s[62:63], v[68:69] op_sel:[1,1,0] op_sel_hi:[1,0,1] neg_lo:[0,0,0] neg_hi:[0,0,0]
v_pk_add_f32 v[48:49], v[54:55], v[70:71] neg_lo:[0,1] neg_hi:[0,1]
v_pk_add_f32 v[54:55], v[54:55], v[70:71]
v_pk_mul_f32 v[70:71], v[48:49], s[54:55] op_sel:[0,1] op_sel_hi:[0,0] neg_lo:[0,0] neg_hi:[0,1]
v_pk_fma_f32 v[70:71], v[48:49], s[54:55], v[70:71] op_sel:[1,0,0] op_sel_hi:[1,1,1] neg_lo:[0,0,0] neg_hi:[0,0,0]
v_pk_add_f32 v[48:49], v[56:57], v[72:73] op_sel:[1,1] op_sel_hi:[0,0] neg_lo:[0,1] neg_hi:[1,0]
v_pk_add_f32 v[56:57], v[56:57], v[72:73]
v_pk_add_f32 v[72:73], v[58:59], v[74:75] neg_lo:[0,1] neg_hi:[0,1]
v_pk_add_f32 v[58:59], v[58:59], v[74:75]
v_pk_mul_f32 v[74:75], v[72:73], s[54:55] op_sel:[0,1] op_sel_hi:[0,0] neg_lo:[0,1] neg_hi:[0,1]
v_pk_fma_f32 v[74:75], v[72:73], s[54:55], v[74:75] op_sel:[1,0,0] op_sel_hi:[1,1,1] neg_lo:[0,0,0] neg_hi:[0,1,0]
v_pk_add_f32 v[72:73], v[60:61], v[76:77] neg_lo:[0,1] neg_hi:[0,1]
v_pk_add_f32 v[60:61], v[60:61], v[76:77]
v_pk_mul_f32 v[76:77], v[72:73], s[62:63] op_sel:[0,0] op_sel_hi:[0,1] neg_lo:[0,1] neg_hi:[0,1]
v_pk_fma_f32 v[76:77], v[72:73], s[62:63], v[76:77] op_sel:[1,1,0] op_sel_hi:[1,0,1] neg_lo:[0,0,0] neg_hi:[0,1,0]
v_pk_add_f32 v[72:73], v[62:63], v[78:79] neg_lo:[0,1] neg_hi:[0,1]
v_pk_add_f32 v[62:63], v[62:63], v[78:79]
v_pk_mul_f32 v[78:79], v[72:73], s[54:55] op_sel:[0,0] op_sel_hi:[0,1] neg_lo:[0,1] neg_hi:[0,1]
v_pk_fma_f32 v[78:79], v[72:73], s[54:55], v[78:79] op_sel:[1,1,0] op_sel_hi:[1,0,1] neg_lo:[0,0,0] neg_hi:[0,1,0]
v_pk_add_f32 v[72:73], v[16:17], v[24:25] neg_lo:[0,1] neg_hi:[0,1]
v_pk_add_f32 v[16:17], v[16:17], v[24:25]
v_pk_add_f32 v[24:25], v[18:19], v[26:27] neg_lo:[0,1] neg_hi:[0,1]
v_pk_add_f32 v[18:19], v[18:19], v[26:27]
v_pk_mul_f32 v[26:27], v[24:25], s[62:63] op_sel:[0,0] op_sel_hi:[0,1] neg_lo:[0,0] neg_hi:[0,1]
v_pk_fma_f32 v[26:27], v[24:25], s[62:63], v[26:27] op_sel:[1,1,0] op_sel_hi:[1,0,1] neg_lo:[0,0,0] neg_hi:[0,0,0]
v_pk_add_f32 v[24:25], v[20:21], v[28:29] op_sel:[1,1] op_sel_hi:[0,0] neg_lo:[0,1] neg_hi:[1,0]
v_pk_add_f32 v[20:21], v[20:21], v[28:29]
v_pk_add_f32 v[28:29], v[22:23], v[30:31] neg_lo:[0,1] neg_hi:[0,1]
v_pk_add_f32 v[22:23], v[22:23], v[30:31]
v_pk_mul_f32 v[30:31], v[28:29], s[62:63] op_sel:[0,0] op_sel_hi:[0,1] neg_lo:[0,1] neg_hi:[0,1]
v_pk_fma_f32 v[30:31], v[28:29], s[62:63], v[30:31] op_sel:[1,1,0] op_sel_hi:[1,0,1] neg_lo:[0,0,0] neg_hi:[0,1,0]
v_pk_add_f32 v[28:29], v[64:65], v[32:33] neg_lo:[0,1] neg_hi:[0,1]
v_pk_add_f32 v[64:65], v[64:65], v[32:33]
v_pk_add_f32 v[32:33], v[34:35], v[42:43] neg_lo:[0,1] neg_hi:[0,1]
v_pk_add_f32 v[34:35], v[34:35], v[42:43]
v_pk_mul_f32 v[42:43], v[32:33], s[62:63] op_sel:[0,0] op_sel_hi:[0,1] neg_lo:[0,0] neg_hi:[0,1]
v_pk_fma_f32 v[42:43], v[32:33], s[62:63], v[42:43] op_sel:[1,1,0] op_sel_hi:[1,0,1] neg_lo:[0,0,0] neg_hi:[0,0,0]
v_pk_add_f32 v[32:33], v[36:37], v[44:45] op_sel:[1,1] op_sel_hi:[0,0] neg_lo:[0,1] neg_hi:[1,0]
v_pk_add_f32 v[36:37], v[36:37], v[44:45]
v_pk_add_f32 v[44:45], v[38:39], v[46:47] neg_lo:[0,1] neg_hi:[0,1]
v_pk_add_f32 v[38:39], v[38:39], v[46:47]
v_pk_mul_f32 v[46:47], v[44:45], s[62:63] op_sel:[0,0] op_sel_hi:[0,1] neg_lo:[0,1] neg_hi:[0,1]
v_pk_fma_f32 v[46:47], v[44:45], s[62:63], v[46:47] op_sel:[1,1,0] op_sel_hi:[1,0,1] neg_lo:[0,0,0] neg_hi:[0,1,0]
v_pk_add_f32 v[44:45], v[14:15], v[56:57] neg_lo:[0,1] neg_hi:[0,1]
v_pk_add_f32 v[14:15], v[14:15], v[56:57]
v_pk_add_f32 v[56:57], v[50:51], v[58:59] neg_lo:[0,1] neg_hi:[0,1]
v_pk_add_f32 v[50:51], v[50:51], v[58:59]
v_pk_mul_f32 v[58:59], v[56:57], s[62:63] op_sel:[0,0] op_sel_hi:[0,1] neg_lo:[0,0] neg_hi:[0,1]
v_pk_fma_f32 v[58:59], v[56:57], s[62:63], v[58:59] op_sel:[1,1,0] op_sel_hi:[1,0,1] neg_lo:[0,0,0] neg_hi:[0,0,0]
v_pk_add_f32 v[56:57], v[52:53], v[60:61] op_sel:[1,1] op_sel_hi:[0,0] neg_lo:[0,1] neg_hi:[1,0]
v_pk_add_f32 v[52:53], v[52:53], v[60:61]
v_pk_add_f32 v[60:61], v[54:55], v[62:63] neg_lo:[0,1] neg_hi:[0,1]
v_pk_add_f32 v[54:55], v[54:55], v[62:63]
v_pk_mul_f32 v[62:63], v[60:61], s[62:63] op_sel:[0,0] op_sel_hi:[0,1] neg_lo:[0,1] neg_hi:[0,1]
v_pk_fma_f32 v[62:63], v[60:61], s[62:63], v[62:63] op_sel:[1,1,0] op_sel_hi:[1,0,1] neg_lo:[0,0,0] neg_hi:[0,1,0]
v_pk_add_f32 v[60:61], v[40:41], v[48:49] neg_lo:[0,1] neg_hi:[0,1]
v_pk_add_f32 v[40:41], v[40:41], v[48:49]
v_pk_add_f32 v[48:49], v[66:67], v[74:75] neg_lo:[0,1] neg_hi:[0,1]
v_pk_add_f32 v[66:67], v[66:67], v[74:75]
v_pk_mul_f32 v[74:75], v[48:49], s[62:63] op_sel:[0,0] op_sel_hi:[0,1] neg_lo:[0,0] neg_hi:[0,1]
v_pk_fma_f32 v[74:75], v[48:49], s[62:63], v[74:75] op_sel:[1,1,0] op_sel_hi:[1,0,1] neg_lo:[0,0,0] neg_hi:[0,0,0]
v_pk_add_f32 v[48:49], v[68:69], v[76:77] op_sel:[1,1] op_sel_hi:[0,0] neg_lo:[0,1] neg_hi:[1,0]
v_pk_add_f32 v[68:69], v[68:69], v[76:77]
v_pk_add_f32 v[76:77], v[70:71], v[78:79] neg_lo:[0,1] neg_hi:[0,1]
v_pk_add_f32 v[70:71], v[70:71], v[78:79]
v_pk_mul_f32 v[78:79], v[76:77], s[62:63] op_sel:[0,0] op_sel_hi:[0,1] neg_lo:[0,1] neg_hi:[0,1]
v_pk_fma_f32 v[78:79], v[76:77], s[62:63], v[78:79] op_sel:[1,1,0] op_sel_hi:[1,0,1] neg_lo:[0,0,0] neg_hi:[0,1,0]
v_pk_add_f32 v[76:77], v[16:17], v[20:21] neg_lo:[0,1] neg_hi:[0,1]
v_pk_add_f32 v[16:17], v[16:17], v[20:21]
v_pk_add_f32 v[20:21], v[18:19], v[22:23] op_sel:[1,1] op_sel_hi:[0,0] neg_lo:[0,1] neg_hi:[1,0]
v_pk_add_f32 v[18:19], v[18:19], v[22:23]
v_pk_add_f32 v[22:23], v[72:73], v[24:25] neg_lo:[0,1] neg_hi:[0,1]
v_pk_add_f32 v[72:73], v[72:73], v[24:25]
v_pk_add_f32 v[24:25], v[26:27], v[30:31] op_sel:[1,1] op_sel_hi:[0,0] neg_lo:[0,1] neg_hi:[1,0]
v_pk_add_f32 v[26:27], v[26:27], v[30:31]
v_pk_add_f32 v[30:31], v[64:65], v[36:37] neg_lo:[0,1] neg_hi:[0,1]
v_pk_add_f32 v[64:65], v[64:65], v[36:37]
v_pk_add_f32 v[36:37], v[34:35], v[38:39] op_sel:[1,1] op_sel_hi:[0,0] neg_lo:[0,1] neg_hi:[1,0]
v_pk_add_f32 v[34:35], v[34:35], v[38:39]
v_pk_add_f32 v[38:39], v[28:29], v[32:33] neg_lo:[0,1] neg_hi:[0,1]
v_pk_add_f32 v[28:29], v[28:29], v[32:33]
v_pk_add_f32 v[32:33], v[42:43], v[46:47] op_sel:[1,1] op_sel_hi:[0,0] neg_lo:[0,1] neg_hi:[1,0]
v_pk_add_f32 v[42:43], v[42:43], v[46:47]
v_pk_add_f32 v[46:47], v[14:15], v[52:53] neg_lo:[0,1] neg_hi:[0,1]
v_pk_add_f32 v[14:15], v[14:15], v[52:53]
v_pk_add_f32 v[52:53], v[50:51], v[54:55] op_sel:[1,1] op_sel_hi:[0,0] neg_lo:[0,1] neg_hi:[1,0]
v_pk_add_f32 v[50:51], v[50:51], v[54:55]
v_pk_add_f32 v[54:55], v[44:45], v[56:57] neg_lo:[0,1] neg_hi:[0,1]
v_pk_add_f32 v[44:45], v[44:45], v[56:57]
v_pk_add_f32 v[56:57], v[58:59], v[62:63] op_sel:[1,1] op_sel_hi:[0,0] neg_lo:[0,1] neg_hi:[1,0]
v_pk_add_f32 v[58:59], v[58:59], v[62:63]
v_pk_add_f32 v[62:63], v[40:41], v[68:69] neg_lo:[0,1] neg_hi:[0,1]
v_pk_add_f32 v[40:41], v[40:41], v[68:69]
v_pk_add_f32 v[68:69], v[66:67], v[70:71] op_sel:[1,1] op_sel_hi:[0,0] neg_lo:[0,1] neg_hi:[1,0]
v_pk_add_f32 v[66:67], v[66:67], v[70:71]
v_pk_add_f32 v[70:71], v[60:61], v[48:49] neg_lo:[0,1] neg_hi:[0,1]
v_pk_add_f32 v[60:61], v[60:61], v[48:49]
v_pk_add_f32 v[48:49], v[74:75], v[78:79] op_sel:[1,1] op_sel_hi:[0,0] neg_lo:[0,1] neg_hi:[1,0]
v_pk_add_f32 v[74:75], v[74:75], v[78:79]
v_pk_add_f32 v[78:79], v[16:17], v[18:19] neg_lo:[0,1] neg_hi:[0,1]
v_pk_add_f32 v[16:17], v[16:17], v[18:19]
v_pk_add_f32 v[18:19], v[76:77], v[20:21] neg_lo:[0,1] neg_hi:[0,1]
v_pk_add_f32 v[76:77], v[76:77], v[20:21]
v_pk_add_f32 v[20:21], v[72:73], v[26:27] neg_lo:[0,1] neg_hi:[0,1]
v_pk_add_f32 v[72:73], v[72:73], v[26:27]
v_pk_add_f32 v[26:27], v[22:23], v[24:25] neg_lo:[0,1] neg_hi:[0,1]
v_pk_add_f32 v[22:23], v[22:23], v[24:25]
v_pk_add_f32 v[24:25], v[64:65], v[34:35] neg_lo:[0,1] neg_hi:[0,1]
v_pk_add_f32 v[64:65], v[64:65], v[34:35]
v_pk_add_f32 v[34:35], v[30:31], v[36:37] neg_lo:[0,1] neg_hi:[0,1]
v_pk_add_f32 v[30:31], v[30:31], v[36:37]
v_pk_add_f32 v[36:37], v[28:29], v[42:43] neg_lo:[0,1] neg_hi:[0,1]
v_pk_add_f32 v[28:29], v[28:29], v[42:43]
v_pk_add_f32 v[42:43], v[38:39], v[32:33] neg_lo:[0,1] neg_hi:[0,1]
v_pk_add_f32 v[38:39], v[38:39], v[32:33]
v_pk_add_f32 v[32:33], v[14:15], v[50:51] neg_lo:[0,1] neg_hi:[0,1]
v_pk_add_f32 v[14:15], v[14:15], v[50:51]
v_pk_add_f32 v[50:51], v[46:47], v[52:53] neg_lo:[0,1] neg_hi:[0,1]
v_pk_add_f32 v[46:47], v[46:47], v[52:53]
v_pk_add_f32 v[52:53], v[44:45], v[58:59] neg_lo:[0,1] neg_hi:[0,1]
v_pk_add_f32 v[44:45], v[44:45], v[58:59]
v_pk_add_f32 v[58:59], v[54:55], v[56:57] neg_lo:[0,1] neg_hi:[0,1]
v_pk_add_f32 v[54:55], v[54:55], v[56:57]
v_pk_add_f32 v[56:57], v[40:41], v[66:67] neg_lo:[0,1] neg_hi:[0,1]
v_pk_add_f32 v[40:41], v[40:41], v[66:67]
v_pk_add_f32 v[66:67], v[62:63], v[68:69] neg_lo:[0,1] neg_hi:[0,1]
v_pk_add_f32 v[62:63], v[62:63], v[68:69]
v_pk_add_f32 v[68:69], v[60:61], v[74:75] neg_lo:[0,1] neg_hi:[0,1]
v_pk_add_f32 v[60:61], v[60:61], v[74:75]
v_pk_add_f32 v[74:75], v[70:71], v[48:49] neg_lo:[0,1] neg_hi:[0,1]
v_pk_add_f32 v[70:71], v[70:71], v[48:49]
s_mov_b64 exec, s[18:19]
v_pk_add_f32 v[16:17], v[16:17], 0 neg_lo:[1,0] neg_hi:[1,0]
v_pk_mul_f32 v[48:49], v[14:15], s[48:49] op_sel:[0,0] op_sel_hi:[0,1] neg_lo:[0,1] neg_hi:[0,0]
v_pk_fma_f32 v[14:15], v[14:15], s[48:49], v[48:49] op_sel:[1,1,0] op_sel_hi:[1,0,1] neg_lo:[0,1,0] neg_hi:[0,1,0]
v_pk_mul_f32 v[48:49], v[64:65], s[50:51] op_sel:[0,0] op_sel_hi:[0,1] neg_lo:[0,1] neg_hi:[0,0]
v_pk_fma_f32 v[64:65], v[64:65], s[50:51], v[48:49] op_sel:[1,1,0] op_sel_hi:[1,0,1] neg_lo:[0,1,0] neg_hi:[0,1,0]
v_pk_mul_f32 v[48:49], v[40:41], s[52:53] op_sel:[0,0] op_sel_hi:[0,1] neg_lo:[0,1] neg_hi:[0,0]
v_pk_fma_f32 v[40:41], v[40:41], s[52:53], v[48:49] op_sel:[1,1,0] op_sel_hi:[1,0,1] neg_lo:[0,1,0] neg_hi:[0,1,0]
v_pk_mul_f32 v[48:49], v[72:73], s[54:55] op_sel:[0,0] op_sel_hi:[0,1] neg_lo:[0,1] neg_hi:[0,0]
v_pk_fma_f32 v[72:73], v[72:73], s[54:55], v[48:49] op_sel:[1,1,0] op_sel_hi:[1,0,1] neg_lo:[0,1,0] neg_hi:[0,1,0]
v_pk_mul_f32 v[48:49], v[44:45], s[56:57] op_sel:[0,0] op_sel_hi:[0,1] neg_lo:[0,1] neg_hi:[0,0]
v_pk_fma_f32 v[44:45], v[44:45], s[56:57], v[48:49] op_sel:[1,1,0] op_sel_hi:[1,0,1] neg_lo:[0,1,0] neg_hi:[0,1,0]
v_pk_mul_f32 v[48:49], v[28:29], s[58:59] op_sel:[0,0] op_sel_hi:[0,1] neg_lo:[0,1] neg_hi:[0,0]
v_pk_fma_f32 v[28:29], v[28:29], s[58:59], v[48:49] op_sel:[1,1,0] op_sel_hi:[1,0,1] neg_lo:[0,1,0] neg_hi:[0,1,0]
v_pk_mul_f32 v[48:49], v[60:61], s[60:61] op_sel:[0,0] op_sel_hi:[0,1] neg_lo:[0,1] neg_hi:[0,0]
v_pk_fma_f32 v[60:61], v[60:61], s[60:61], v[48:49] op_sel:[1,1,0] op_sel_hi:[1,0,1] neg_lo:[0,1,0] neg_hi:[0,1,0]
v_pk_mul_f32 v[48:49], v[76:77], s[62:63] op_sel:[0,0] op_sel_hi:[0,1] neg_lo:[0,1] neg_hi:[0,0]
v_pk_fma_f32 v[76:77], v[76:77], s[62:63], v[48:49] op_sel:[1,1,0] op_sel_hi:[1,0,1] neg_lo:[0,1,0] neg_hi:[0,1,0]
v_pk_mul_f32 v[48:49], v[46:47], s[60:61] op_sel:[0,1] op_sel_hi:[0,0] neg_lo:[0,1] neg_hi:[0,0]
v_pk_fma_f32 v[46:47], v[46:47], s[60:61], v[48:49] op_sel:[1,0,0] op_sel_hi:[1,1,1] neg_lo:[0,1,0] neg_hi:[0,1,0]
v_pk_mul_f32 v[48:49], v[30:31], s[58:59] op_sel:[0,1] op_sel_hi:[0,0] neg_lo:[0,1] neg_hi:[0,0]
v_pk_fma_f32 v[30:31], v[30:31], s[58:59], v[48:49] op_sel:[1,0,0] op_sel_hi:[1,1,1] neg_lo:[0,1,0] neg_hi:[0,1,0]
v_pk_mul_f32 v[48:49], v[62:63], s[56:57] op_sel:[0,1] op_sel_hi:[0,0] neg_lo:[0,1] neg_hi:[0,0]
v_pk_fma_f32 v[62:63], v[62:63], s[56:57], v[48:49] op_sel:[1,0,0] op_sel_hi:[1,1,1] neg_lo:[0,1,0] neg_hi:[0,1,0]
v_pk_mul_f32 v[48:49], v[22:23], s[54:55] op_sel:[0,1] op_sel_hi:[0,0] neg_lo:[0,1] neg_hi:[0,0]
v_pk_fma_f32 v[22:23], v[22:23], s[54:55], v[48:49] op_sel:[1,0,0] op_sel_hi:[1,1,1] neg_lo:[0,1,0] neg_hi:[0,1,0]
v_pk_mul_f32 v[48:49], v[54:55], s[52:53] op_sel:[0,1] op_sel_hi:[0,0] neg_lo:[0,1] neg_hi:[0,0]
v_pk_fma_f32 v[54:55], v[54:55], s[52:53], v[48:49] op_sel:[1,0,0] op_sel_hi:[1,1,1] neg_lo:[0,1,0] neg_hi:[0,1,0]
v_pk_mul_f32 v[48:49], v[38:39], s[50:51] op_sel:[0,1] op_sel_hi:[0,0] neg_lo:[0,1] neg_hi:[0,0]
v_pk_fma_f32 v[38:39], v[38:39], s[50:51], v[48:49] op_sel:[1,0,0] op_sel_hi:[1,1,1] neg_lo:[0,1,0] neg_hi:[0,1,0]
v_pk_mul_f32 v[48:49], v[70:71], s[48:49] op_sel:[0,1] op_sel_hi:[0,0] neg_lo:[0,1] neg_hi:[0,0]
v_pk_fma_f32 v[70:71], v[70:71], s[48:49], v[48:49] op_sel:[1,0,0] op_sel_hi:[1,1,1] neg_lo:[0,1,0] neg_hi:[0,1,0]
v_pk_add_f32 v[78:79], v[78:79], 0 op_sel:[1,0] op_sel_hi:[0,0] neg_lo:[1,0] neg_hi:[0,0]
v_pk_mul_f32 v[48:49], v[32:33], s[48:49] op_sel:[0,1] op_sel_hi:[0,0] neg_lo:[0,0] neg_hi:[0,0]
v_pk_fma_f32 v[32:33], v[32:33], s[48:49], v[48:49] op_sel:[1,0,0] op_sel_hi:[1,1,1] neg_lo:[0,1,0] neg_hi:[0,0,0]
v_pk_mul_f32 v[48:49], v[24:25], s[50:51] op_sel:[0,1] op_sel_hi:[0,0] neg_lo:[0,0] neg_hi:[0,0]
v_pk_fma_f32 v[24:25], v[24:25], s[50:51], v[48:49] op_sel:[1,0,0] op_sel_hi:[1,1,1] neg_lo:[0,1,0] neg_hi:[0,0,0]
v_pk_mul_f32 v[48:49], v[56:57], s[52:53] op_sel:[0,1] op_sel_hi:[0,0] neg_lo:[0,0] neg_hi:[0,0]
v_pk_fma_f32 v[56:57], v[56:57], s[52:53], v[48:49] op_sel:[1,0,0] op_sel_hi:[1,1,1] neg_lo:[0,1,0] neg_hi:[0,0,0]
v_pk_mul_f32 v[48:49], v[20:21], s[54:55] op_sel:[0,1] op_sel_hi:[0,0] neg_lo:[0,0] neg_hi:[0,0]
v_pk_fma_f32 v[20:21], v[20:21], s[54:55], v[48:49] op_sel:[1,0,0] op_sel_hi:[1,1,1] neg_lo:[0,1,0] neg_hi:[0,0,0]
v_pk_mul_f32 v[48:49], v[52:53], s[56:57] op_sel:[0,1] op_sel_hi:[0,0] neg_lo:[0,0] neg_hi:[0,0]
v_pk_fma_f32 v[52:53], v[52:53], s[56:57], v[48:49] op_sel:[1,0,0] op_sel_hi:[1,1,1] neg_lo:[0,1,0] neg_hi:[0,0,0]
v_pk_mul_f32 v[48:49], v[36:37], s[58:59] op_sel:[0,1] op_sel_hi:[0,0] neg_lo:[0,0] neg_hi:[0,0]
v_pk_fma_f32 v[36:37], v[36:37], s[58:59], v[48:49] op_sel:[1,0,0] op_sel_hi:[1,1,1] neg_lo:[0,1,0] neg_hi:[0,0,0]
v_pk_mul_f32 v[48:49], v[68:69], s[60:61] op_sel:[0,1] op_sel_hi:[0,0] neg_lo:[0,0] neg_hi:[0,0]
v_pk_fma_f32 v[68:69], v[68:69], s[60:61], v[48:49] op_sel:[1,0,0] op_sel_hi:[1,1,1] neg_lo:[0,1,0] neg_hi:[0,0,0]
v_pk_mul_f32 v[48:49], v[18:19], s[62:63] op_sel:[0,0] op_sel_hi:[0,1] neg_lo:[0,0] neg_hi:[0,0]
v_pk_fma_f32 v[18:19], v[18:19], s[62:63], v[48:49] op_sel:[1,1,0] op_sel_hi:[1,0,1] neg_lo:[0,1,0] neg_hi:[0,0,0]
v_pk_mul_f32 v[48:49], v[50:51], s[60:61] op_sel:[0,0] op_sel_hi:[0,1] neg_lo:[0,0] neg_hi:[0,0]
v_pk_fma_f32 v[50:51], v[50:51], s[60:61], v[48:49] op_sel:[1,1,0] op_sel_hi:[1,0,1] neg_lo:[0,1,0] neg_hi:[0,0,0]
v_pk_mul_f32 v[48:49], v[34:35], s[58:59] op_sel:[0,0] op_sel_hi:[0,1] neg_lo:[0,0] neg_hi:[0,0]
v_pk_fma_f32 v[34:35], v[34:35], s[58:59], v[48:49] op_sel:[1,1,0] op_sel_hi:[1,0,1] neg_lo:[0,1,0] neg_hi:[0,0,0]
v_pk_mul_f32 v[48:49], v[66:67], s[56:57] op_sel:[0,0] op_sel_hi:[0,1] neg_lo:[0,0] neg_hi:[0,0]
v_pk_fma_f32 v[66:67], v[66:67], s[56:57], v[48:49] op_sel:[1,1,0] op_sel_hi:[1,0,1] neg_lo:[0,1,0] neg_hi:[0,0,0]
v_pk_mul_f32 v[48:49], v[26:27], s[54:55] op_sel:[0,0] op_sel_hi:[0,1] neg_lo:[0,0] neg_hi:[0,0]
v_pk_fma_f32 v[26:27], v[26:27], s[54:55], v[48:49] op_sel:[1,1,0] op_sel_hi:[1,0,1] neg_lo:[0,1,0] neg_hi:[0,0,0]
v_pk_mul_f32 v[48:49], v[58:59], s[52:53] op_sel:[0,0] op_sel_hi:[0,1] neg_lo:[0,0] neg_hi:[0,0]
v_pk_fma_f32 v[58:59], v[58:59], s[52:53], v[48:49] op_sel:[1,1,0] op_sel_hi:[1,0,1] neg_lo:[0,1,0] neg_hi:[0,0,0]
v_pk_mul_f32 v[48:49], v[42:43], s[50:51] op_sel:[0,0] op_sel_hi:[0,1] neg_lo:[0,0] neg_hi:[0,0]
v_pk_fma_f32 v[42:43], v[42:43], s[50:51], v[48:49] op_sel:[1,1,0] op_sel_hi:[1,0,1] neg_lo:[0,1,0] neg_hi:[0,0,0]
v_pk_mul_f32 v[48:49], v[74:75], s[48:49] op_sel:[0,0] op_sel_hi:[0,1] neg_lo:[0,0] neg_hi:[0,0]
v_pk_fma_f32 v[74:75], v[74:75], s[48:49], v[48:49] op_sel:[1,1,0] op_sel_hi:[1,0,1] neg_lo:[0,1,0] neg_hi:[0,0,0]
s_mov_b64 exec, -1
v_fmac_f32_dpp v16, v16, v9 quad_perm:[1,0,3,2] row_mask:0xf bank_mask:0xf
v_fmac_f32_dpp v17, v17, v9 quad_perm:[1,0,3,2] row_mask:0xf bank_mask:0xf
v_fmac_f32_dpp v14, v14, v9 quad_perm:[1,0,3,2] row_mask:0xf bank_mask:0xf
v_fmac_f32_dpp v15, v15, v9 quad_perm:[1,0,3,2] row_mask:0xf bank_mask:0xf
v_fmac_f32_dpp v64, v64, v9 quad_perm:[1,0,3,2] row_mask:0xf bank_mask:0xf
v_fmac_f32_dpp v65, v65, v9 quad_perm:[1,0,3,2] row_mask:0xf bank_mask:0xf
v_fmac_f32_dpp v40, v40, v9 quad_perm:[1,0,3,2] row_mask:0xf bank_mask:0xf
v_fmac_f32_dpp v41, v41, v9 quad_perm:[1,0,3,2] row_mask:0xf bank_mask:0xf
v_fmac_f32_dpp v72, v72, v9 quad_perm:[1,0,3,2] row_mask:0xf bank_mask:0xf
v_fmac_f32_dpp v73, v73, v9 quad_perm:[1,0,3,2] row_mask:0xf bank_mask:0xf
v_fmac_f32_dpp v44, v44, v9 quad_perm:[1,0,3,2] row_mask:0xf bank_mask:0xf
v_fmac_f32_dpp v45, v45, v9 quad_perm:[1,0,3,2] row_mask:0xf bank_mask:0xf
v_fmac_f32_dpp v28, v28, v9 quad_perm:[1,0,3,2] row_mask:0xf bank_mask:0xf
v_fmac_f32_dpp v29, v29, v9 quad_perm:[1,0,3,2] row_mask:0xf bank_mask:0xf
v_fmac_f32_dpp v60, v60, v9 quad_perm:[1,0,3,2] row_mask:0xf bank_mask:0xf
v_fmac_f32_dpp v61, v61, v9 quad_perm:[1,0,3,2] row_mask:0xf bank_mask:0xf
v_fmac_f32_dpp v76, v76, v9 quad_perm:[1,0,3,2] row_mask:0xf bank_mask:0xf
v_fmac_f32_dpp v77, v77, v9 quad_perm:[1,0,3,2] row_mask:0xf bank_mask:0xf
v_fmac_f32_dpp v46, v46, v9 quad_perm:[1,0,3,2] row_mask:0xf bank_mask:0xf
v_fmac_f32_dpp v47, v47, v9 quad_perm:[1,0,3,2] row_mask:0xf bank_mask:0xf
v_fmac_f32_dpp v30, v30, v9 quad_perm:[1,0,3,2] row_mask:0xf bank_mask:0xf
v_fmac_f32_dpp v31, v31, v9 quad_perm:[1,0,3,2] row_mask:0xf bank_mask:0xf
v_fmac_f32_dpp v62, v62, v9 quad_perm:[1,0,3,2] row_mask:0xf bank_mask:0xf
v_fmac_f32_dpp v63, v63, v9 quad_perm:[1,0,3,2] row_mask:0xf bank_mask:0xf
v_fmac_f32_dpp v22, v22, v9 quad_perm:[1,0,3,2] row_mask:0xf bank_mask:0xf
v_fmac_f32_dpp v23, v23, v9 quad_perm:[1,0,3,2] row_mask:0xf bank_mask:0xf
v_fmac_f32_dpp v54, v54, v9 quad_perm:[1,0,3,2] row_mask:0xf bank_mask:0xf
v_fmac_f32_dpp v55, v55, v9 quad_perm:[1,0,3,2] row_mask:0xf bank_mask:0xf
v_fmac_f32_dpp v38, v38, v9 quad_perm:[1,0,3,2] row_mask:0xf bank_mask:0xf
v_fmac_f32_dpp v39, v39, v9 quad_perm:[1,0,3,2] row_mask:0xf bank_mask:0xf
v_fmac_f32_dpp v70, v70, v9 quad_perm:[1,0,3,2] row_mask:0xf bank_mask:0xf
v_fmac_f32_dpp v71, v71, v9 quad_perm:[1,0,3,2] row_mask:0xf bank_mask:0xf
v_fmac_f32_dpp v78, v78, v9 quad_perm:[1,0,3,2] row_mask:0xf bank_mask:0xf
v_fmac_f32_dpp v79, v79, v9 quad_perm:[1,0,3,2] row_mask:0xf bank_mask:0xf
v_fmac_f32_dpp v32, v32, v9 quad_perm:[1,0,3,2] row_mask:0xf bank_mask:0xf
v_fmac_f32_dpp v33, v33, v9 quad_perm:[1,0,3,2] row_mask:0xf bank_mask:0xf
v_fmac_f32_dpp v24, v24, v9 quad_perm:[1,0,3,2] row_mask:0xf bank_mask:0xf
v_fmac_f32_dpp v25, v25, v9 quad_perm:[1,0,3,2] row_mask:0xf bank_mask:0xf
v_fmac_f32_dpp v56, v56, v9 quad_perm:[1,0,3,2] row_mask:0xf bank_mask:0xf
v_fmac_f32_dpp v57, v57, v9 quad_perm:[1,0,3,2] row_mask:0xf bank_mask:0xf
v_fmac_f32_dpp v20, v20, v9 quad_perm:[1,0,3,2] row_mask:0xf bank_mask:0xf
v_fmac_f32_dpp v21, v21, v9 quad_perm:[1,0,3,2] row_mask:0xf bank_mask:0xf
v_fmac_f32_dpp v52, v52, v9 quad_perm:[1,0,3,2] row_mask:0xf bank_mask:0xf
v_fmac_f32_dpp v53, v53, v9 quad_perm:[1,0,3,2] row_mask:0xf bank_mask:0xf
v_fmac_f32_dpp v36, v36, v9 quad_perm:[1,0,3,2] row_mask:0xf bank_mask:0xf
v_fmac_f32_dpp v37, v37, v9 quad_perm:[1,0,3,2] row_mask:0xf bank_mask:0xf
v_fmac_f32_dpp v68, v68, v9 quad_perm:[1,0,3,2] row_mask:0xf bank_mask:0xf
v_fmac_f32_dpp v69, v69, v9 quad_perm:[1,0,3,2] row_mask:0xf bank_mask:0xf
v_fmac_f32_dpp v18, v18, v9 quad_perm:[1,0,3,2] row_mask:0xf bank_mask:0xf
v_fmac_f32_dpp v19, v19, v9 quad_perm:[1,0,3,2] row_mask:0xf bank_mask:0xf
v_fmac_f32_dpp v50, v50, v9 quad_perm:[1,0,3,2] row_mask:0xf bank_mask:0xf
v_fmac_f32_dpp v51, v51, v9 quad_perm:[1,0,3,2] row_mask:0xf bank_mask:0xf
v_fmac_f32_dpp v34, v34, v9 quad_perm:[1,0,3,2] row_mask:0xf bank_mask:0xf
v_fmac_f32_dpp v35, v35, v9 quad_perm:[1,0,3,2] row_mask:0xf bank_mask:0xf
v_fmac_f32_dpp v66, v66, v9 quad_perm:[1,0,3,2] row_mask:0xf bank_mask:0xf
v_fmac_f32_dpp v67, v67, v9 quad_perm:[1,0,3,2] row_mask:0xf bank_mask:0xf
v_fmac_f32_dpp v26, v26, v9 quad_perm:[1,0,3,2] row_mask:0xf bank_mask:0xf
v_fmac_f32_dpp v27, v27, v9 quad_perm:[1,0,3,2] row_mask:0xf bank_mask:0xf
v_fmac_f32_dpp v58, v58, v9 quad_perm:[1,0,3,2] row_mask:0xf bank_mask:0xf
v_fmac_f32_dpp v59, v59, v9 quad_perm:[1,0,3,2] row_mask:0xf bank_mask:0xf
v_fmac_f32_dpp v42, v42, v9 quad_perm:[1,0,3,2] row_mask:0xf bank_mask:0xf
v_fmac_f32_dpp v43, v43, v9 quad_perm:[1,0,3,2] row_mask:0xf bank_mask:0xf
v_fmac_f32_dpp v74, v74, v9 quad_perm:[1,0,3,2] row_mask:0xf bank_mask:0xf
v_fmac_f32_dpp v75, v75, v9 quad_perm:[1,0,3,2] row_mask:0xf bank_mask:0xf
v_lshlrev_b32 v240, 16, v208
v_and_b32 v241, 0xffff0000, v208
v_pk_mul_f32 v[48:49], v[16:17], v[240:241] op_sel:[0,0] op_sel_hi:[0,1] neg_lo:[0,0] neg_hi:[0,0]
v_pk_fma_f32 v[16:17], v[16:17], v[240:241], v[48:49] op_sel:[1,1,0] op_sel_hi:[1,0,1] neg_lo:[0,1,0] neg_hi:[0,0,0]
v_lshlrev_b32 v240, 16, v209
v_and_b32 v241, 0xffff0000, v209
v_pk_mul_f32 v[48:49], v[14:15], v[240:241] op_sel:[0,0] op_sel_hi:[0,1] neg_lo:[0,0] neg_hi:[0,0]
v_pk_fma_f32 v[14:15], v[14:15], v[240:241], v[48:49] op_sel:[1,1,0] op_sel_hi:[1,0,1] neg_lo:[0,1,0] neg_hi:[0,0,0]
v_lshlrev_b32 v240, 16, v210
v_and_b32 v241, 0xffff0000, v210
v_pk_mul_f32 v[48:49], v[64:65], v[240:241] op_sel:[0,0] op_sel_hi:[0,1] neg_lo:[0,0] neg_hi:[0,0]
v_pk_fma_f32 v[64:65], v[64:65], v[240:241], v[48:49] op_sel:[1,1,0] op_sel_hi:[1,0,1] neg_lo:[0,1,0] neg_hi:[0,0,0]
v_lshlrev_b32 v240, 16, v211
v_and_b32 v241, 0xffff0000, v211
v_pk_mul_f32 v[48:49], v[40:41], v[240:241] op_sel:[0,0] op_sel_hi:[0,1] neg_lo:[0,0] neg_hi:[0,0]
v_pk_fma_f32 v[40:41], v[40:41], v[240:241], v[48:49] op_sel:[1,1,0] op_sel_hi:[1,0,1] neg_lo:[0,1,0] neg_hi:[0,0,0]
v_lshlrev_b32 v240, 16, v212
v_and_b32 v241, 0xffff0000, v212
v_pk_mul_f32 v[48:49], v[72:73], v[240:241] op_sel:[0,0] op_sel_hi:[0,1] neg_lo:[0,0] neg_hi:[0,0]
v_pk_fma_f32 v[72:73], v[72:73], v[240:241], v[48:49] op_sel:[1,1,0] op_sel_hi:[1,0,1] neg_lo:[0,1,0] neg_hi:[0,0,0]
v_lshlrev_b32 v240, 16, v213
v_and_b32 v241, 0xffff0000, v213
v_pk_mul_f32 v[48:49], v[44:45], v[240:241] op_sel:[0,0] op_sel_hi:[0,1] neg_lo:[0,0] neg_hi:[0,0]
v_pk_fma_f32 v[44:45], v[44:45], v[240:241], v[48:49] op_sel:[1,1,0] op_sel_hi:[1,0,1] neg_lo:[0,1,0] neg_hi:[0,0,0]
v_lshlrev_b32 v240, 16, v214
v_and_b32 v241, 0xffff0000, v214
v_pk_mul_f32 v[48:49], v[28:29], v[240:241] op_sel:[0,0] op_sel_hi:[0,1] neg_lo:[0,0] neg_hi:[0,0]
v_pk_fma_f32 v[28:29], v[28:29], v[240:241], v[48:49] op_sel:[1,1,0] op_sel_hi:[1,0,1] neg_lo:[0,1,0] neg_hi:[0,0,0]
v_lshlrev_b32 v240, 16, v215
v_and_b32 v241, 0xffff0000, v215
v_pk_mul_f32 v[48:49], v[60:61], v[240:241] op_sel:[0,0] op_sel_hi:[0,1] neg_lo:[0,0] neg_hi:[0,0]
v_pk_fma_f32 v[60:61], v[60:61], v[240:241], v[48:49] op_sel:[1,1,0] op_sel_hi:[1,0,1] neg_lo:[0,1,0] neg_hi:[0,0,0]
v_lshlrev_b32 v240, 16, v216
v_and_b32 v241, 0xffff0000, v216
v_pk_mul_f32 v[48:49], v[76:77], v[240:241] op_sel:[0,0] op_sel_hi:[0,1] neg_lo:[0,0] neg_hi:[0,0]
v_pk_fma_f32 v[76:77], v[76:77], v[240:241], v[48:49] op_sel:[1,1,0] op_sel_hi:[1,0,1] neg_lo:[0,1,0] neg_hi:[0,0,0]
v_lshlrev_b32 v240, 16, v217
v_and_b32 v241, 0xffff0000, v217
v_pk_mul_f32 v[48:49], v[46:47], v[240:241] op_sel:[0,0] op_sel_hi:[0,1] neg_lo:[0,0] neg_hi:[0,0]
v_pk_fma_f32 v[46:47], v[46:47], v[240:241], v[48:49] op_sel:[1,1,0] op_sel_hi:[1,0,1] neg_lo:[0,1,0] neg_hi:[0,0,0]
v_lshlrev_b32 v240, 16, v218
v_and_b32 v241, 0xffff0000, v218
v_pk_mul_f32 v[48:49], v[30:31], v[240:241] op_sel:[0,0] op_sel_hi:[0,1] neg_lo:[0,0] neg_hi:[0,0]
v_pk_fma_f32 v[30:31], v[30:31], v[240:241], v[48:49] op_sel:[1,1,0] op_sel_hi:[1,0,1] neg_lo:[0,1,0] neg_hi:[0,0,0]
v_lshlrev_b32 v240, 16, v219
v_and_b32 v241, 0xffff0000, v219
v_pk_mul_f32 v[48:49], v[62:63], v[240:241] op_sel:[0,0] op_sel_hi:[0,1] neg_lo:[0,0] neg_hi:[0,0]
v_pk_fma_f32 v[62:63], v[62:63], v[240:241], v[48:49] op_sel:[1,1,0] op_sel_hi:[1,0,1] neg_lo:[0,1,0] neg_hi:[0,0,0]
v_lshlrev_b32 v240, 16, v220
v_and_b32 v241, 0xffff0000, v220
v_pk_mul_f32 v[48:49], v[22:23], v[240:241] op_sel:[0,0] op_sel_hi:[0,1] neg_lo:[0,0] neg_hi:[0,0]
v_pk_fma_f32 v[22:23], v[22:23], v[240:241], v[48:49] op_sel:[1,1,0] op_sel_hi:[1,0,1] neg_lo:[0,1,0] neg_hi:[0,0,0]
v_lshlrev_b32 v240, 16, v221
v_and_b32 v241, 0xffff0000, v221
v_pk_mul_f32 v[48:49], v[54:55], v[240:241] op_sel:[0,0] op_sel_hi:[0,1] neg_lo:[0,0] neg_hi:[0,0]
v_pk_fma_f32 v[54:55], v[54:55], v[240:241], v[48:49] op_sel:[1,1,0] op_sel_hi:[1,0,1] neg_lo:[0,1,0] neg_hi:[0,0,0]
v_lshlrev_b32 v240, 16, v222
v_and_b32 v241, 0xffff0000, v222
v_pk_mul_f32 v[48:49], v[38:39], v[240:241] op_sel:[0,0] op_sel_hi:[0,1] neg_lo:[0,0] neg_hi:[0,0]
v_pk_fma_f32 v[38:39], v[38:39], v[240:241], v[48:49] op_sel:[1,1,0] op_sel_hi:[1,0,1] neg_lo:[0,1,0] neg_hi:[0,0,0]
v_lshlrev_b32 v240, 16, v223
v_and_b32 v241, 0xffff0000, v223
v_pk_mul_f32 v[48:49], v[70:71], v[240:241] op_sel:[0,0] op_sel_hi:[0,1] neg_lo:[0,0] neg_hi:[0,0]
v_pk_fma_f32 v[70:71], v[70:71], v[240:241], v[48:49] op_sel:[1,1,0] op_sel_hi:[1,0,1] neg_lo:[0,1,0] neg_hi:[0,0,0]
v_lshlrev_b32 v240, 16, v224
v_and_b32 v241, 0xffff0000, v224
v_pk_mul_f32 v[48:49], v[78:79], v[240:241] op_sel:[0,0] op_sel_hi:[0,1] neg_lo:[0,0] neg_hi:[0,0]
v_pk_fma_f32 v[78:79], v[78:79], v[240:241], v[48:49] op_sel:[1,1,0] op_sel_hi:[1,0,1] neg_lo:[0,1,0] neg_hi:[0,0,0]
v_lshlrev_b32 v240, 16, v225
v_and_b32 v241, 0xffff0000, v225
v_pk_mul_f32 v[48:49], v[32:33], v[240:241] op_sel:[0,0] op_sel_hi:[0,1] neg_lo:[0,0] neg_hi:[0,0]
v_pk_fma_f32 v[32:33], v[32:33], v[240:241], v[48:49] op_sel:[1,1,0] op_sel_hi:[1,0,1] neg_lo:[0,1,0] neg_hi:[0,0,0]
v_lshlrev_b32 v240, 16, v226
v_and_b32 v241, 0xffff0000, v226
v_pk_mul_f32 v[48:49], v[24:25], v[240:241] op_sel:[0,0] op_sel_hi:[0,1] neg_lo:[0,0] neg_hi:[0,0]
v_pk_fma_f32 v[24:25], v[24:25], v[240:241], v[48:49] op_sel:[1,1,0] op_sel_hi:[1,0,1] neg_lo:[0,1,0] neg_hi:[0,0,0]
v_lshlrev_b32 v240, 16, v227
v_and_b32 v241, 0xffff0000, v227
v_pk_mul_f32 v[48:49], v[56:57], v[240:241] op_sel:[0,0] op_sel_hi:[0,1] neg_lo:[0,0] neg_hi:[0,0]
v_pk_fma_f32 v[56:57], v[56:57], v[240:241], v[48:49] op_sel:[1,1,0] op_sel_hi:[1,0,1] neg_lo:[0,1,0] neg_hi:[0,0,0]
v_lshlrev_b32 v240, 16, v228
v_and_b32 v241, 0xffff0000, v228
v_pk_mul_f32 v[48:49], v[20:21], v[240:241] op_sel:[0,0] op_sel_hi:[0,1] neg_lo:[0,0] neg_hi:[0,0]
v_pk_fma_f32 v[20:21], v[20:21], v[240:241], v[48:49] op_sel:[1,1,0] op_sel_hi:[1,0,1] neg_lo:[0,1,0] neg_hi:[0,0,0]
v_lshlrev_b32 v240, 16, v229
v_and_b32 v241, 0xffff0000, v229
v_pk_mul_f32 v[48:49], v[52:53], v[240:241] op_sel:[0,0] op_sel_hi:[0,1] neg_lo:[0,0] neg_hi:[0,0]
v_pk_fma_f32 v[52:53], v[52:53], v[240:241], v[48:49] op_sel:[1,1,0] op_sel_hi:[1,0,1] neg_lo:[0,1,0] neg_hi:[0,0,0]
v_lshlrev_b32 v240, 16, v230
v_and_b32 v241, 0xffff0000, v230
v_pk_mul_f32 v[48:49], v[36:37], v[240:241] op_sel:[0,0] op_sel_hi:[0,1] neg_lo:[0,0] neg_hi:[0,0]
v_pk_fma_f32 v[36:37], v[36:37], v[240:241], v[48:49] op_sel:[1,1,0] op_sel_hi:[1,0,1] neg_lo:[0,1,0] neg_hi:[0,0,0]
v_lshlrev_b32 v240, 16, v231
v_and_b32 v241, 0xffff0000, v231
v_pk_mul_f32 v[48:49], v[68:69], v[240:241] op_sel:[0,0] op_sel_hi:[0,1] neg_lo:[0,0] neg_hi:[0,0]
v_pk_fma_f32 v[68:69], v[68:69], v[240:241], v[48:49] op_sel:[1,1,0] op_sel_hi:[1,0,1] neg_lo:[0,1,0] neg_hi:[0,0,0]
v_lshlrev_b32 v240, 16, v232
v_and_b32 v241, 0xffff0000, v232
v_pk_mul_f32 v[48:49], v[18:19], v[240:241] op_sel:[0,0] op_sel_hi:[0,1] neg_lo:[0,0] neg_hi:[0,0]
v_pk_fma_f32 v[18:19], v[18:19], v[240:241], v[48:49] op_sel:[1,1,0] op_sel_hi:[1,0,1] neg_lo:[0,1,0] neg_hi:[0,0,0]
v_lshlrev_b32 v240, 16, v233
v_and_b32 v241, 0xffff0000, v233
v_pk_mul_f32 v[48:49], v[50:51], v[240:241] op_sel:[0,0] op_sel_hi:[0,1] neg_lo:[0,0] neg_hi:[0,0]
v_pk_fma_f32 v[50:51], v[50:51], v[240:241], v[48:49] op_sel:[1,1,0] op_sel_hi:[1,0,1] neg_lo:[0,1,0] neg_hi:[0,0,0]
v_lshlrev_b32 v240, 16, v234
v_and_b32 v241, 0xffff0000, v234
v_pk_mul_f32 v[48:49], v[34:35], v[240:241] op_sel:[0,0] op_sel_hi:[0,1] neg_lo:[0,0] neg_hi:[0,0]
v_pk_fma_f32 v[34:35], v[34:35], v[240:241], v[48:49] op_sel:[1,1,0] op_sel_hi:[1,0,1] neg_lo:[0,1,0] neg_hi:[0,0,0]
v_lshlrev_b32 v240, 16, v235
v_and_b32 v241, 0xffff0000, v235
v_pk_mul_f32 v[48:49], v[66:67], v[240:241] op_sel:[0,0] op_sel_hi:[0,1] neg_lo:[0,0] neg_hi:[0,0]
v_pk_fma_f32 v[66:67], v[66:67], v[240:241], v[48:49] op_sel:[1,1,0] op_sel_hi:[1,0,1] neg_lo:[0,1,0] neg_hi:[0,0,0]
v_lshlrev_b32 v240, 16, v236
v_and_b32 v241, 0xffff0000, v236
v_pk_mul_f32 v[48:49], v[26:27], v[240:241] op_sel:[0,0] op_sel_hi:[0,1] neg_lo:[0,0] neg_hi:[0,0]
v_pk_fma_f32 v[26:27], v[26:27], v[240:241], v[48:49] op_sel:[1,1,0] op_sel_hi:[1,0,1] neg_lo:[0,1,0] neg_hi:[0,0,0]
v_lshlrev_b32 v240, 16, v237
v_and_b32 v241, 0xffff0000, v237
v_pk_mul_f32 v[48:49], v[58:59], v[240:241] op_sel:[0,0] op_sel_hi:[0,1] neg_lo:[0,0] neg_hi:[0,0]
v_pk_fma_f32 v[58:59], v[58:59], v[240:241], v[48:49] op_sel:[1,1,0] op_sel_hi:[1,0,1] neg_lo:[0,1,0] neg_hi:[0,0,0]
v_lshlrev_b32 v240, 16, v238
v_and_b32 v241, 0xffff0000, v238
v_pk_mul_f32 v[48:49], v[42:43], v[240:241] op_sel:[0,0] op_sel_hi:[0,1] neg_lo:[0,0] neg_hi:[0,0]
v_pk_fma_f32 v[42:43], v[42:43], v[240:241], v[48:49] op_sel:[1,1,0] op_sel_hi:[1,0,1] neg_lo:[0,1,0] neg_hi:[0,0,0]
v_lshlrev_b32 v240, 16, v239
v_and_b32 v241, 0xffff0000, v239
v_pk_mul_f32 v[48:49], v[74:75], v[240:241] op_sel:[0,0] op_sel_hi:[0,1] neg_lo:[0,0] neg_hi:[0,0]
v_pk_fma_f32 v[74:75], v[74:75], v[240:241], v[48:49] op_sel:[1,1,0] op_sel_hi:[1,0,1] neg_lo:[0,1,0] neg_hi:[0,0,0]
v_fmac_f32_dpp v16, v16, v7 quad_perm:[1,0,3,2] row_mask:0xf bank_mask:0xf
v_fmac_f32_dpp v17, v17, v7 quad_perm:[1,0,3,2] row_mask:0xf bank_mask:0xf
v_fmac_f32_dpp v14, v14, v7 quad_perm:[1,0,3,2] row_mask:0xf bank_mask:0xf
v_fmac_f32_dpp v15, v15, v7 quad_perm:[1,0,3,2] row_mask:0xf bank_mask:0xf
v_fmac_f32_dpp v64, v64, v7 quad_perm:[1,0,3,2] row_mask:0xf bank_mask:0xf
v_fmac_f32_dpp v65, v65, v7 quad_perm:[1,0,3,2] row_mask:0xf bank_mask:0xf
v_fmac_f32_dpp v40, v40, v7 quad_perm:[1,0,3,2] row_mask:0xf bank_mask:0xf
v_fmac_f32_dpp v41, v41, v7 quad_perm:[1,0,3,2] row_mask:0xf bank_mask:0xf
v_fmac_f32_dpp v72, v72, v7 quad_perm:[1,0,3,2] row_mask:0xf bank_mask:0xf
v_fmac_f32_dpp v73, v73, v7 quad_perm:[1,0,3,2] row_mask:0xf bank_mask:0xf
v_fmac_f32_dpp v44, v44, v7 quad_perm:[1,0,3,2] row_mask:0xf bank_mask:0xf
v_fmac_f32_dpp v45, v45, v7 quad_perm:[1,0,3,2] row_mask:0xf bank_mask:0xf
v_fmac_f32_dpp v28, v28, v7 quad_perm:[1,0,3,2] row_mask:0xf bank_mask:0xf
v_fmac_f32_dpp v29, v29, v7 quad_perm:[1,0,3,2] row_mask:0xf bank_mask:0xf
v_fmac_f32_dpp v60, v60, v7 quad_perm:[1,0,3,2] row_mask:0xf bank_mask:0xf
v_fmac_f32_dpp v61, v61, v7 quad_perm:[1,0,3,2] row_mask:0xf bank_mask:0xf
v_fmac_f32_dpp v76, v76, v7 quad_perm:[1,0,3,2] row_mask:0xf bank_mask:0xf
v_fmac_f32_dpp v77, v77, v7 quad_perm:[1,0,3,2] row_mask:0xf bank_mask:0xf
v_fmac_f32_dpp v46, v46, v7 quad_perm:[1,0,3,2] row_mask:0xf bank_mask:0xf
v_fmac_f32_dpp v47, v47, v7 quad_perm:[1,0,3,2] row_mask:0xf bank_mask:0xf
v_fmac_f32_dpp v30, v30, v7 quad_perm:[1,0,3,2] row_mask:0xf bank_mask:0xf
v_fmac_f32_dpp v31, v31, v7 quad_perm:[1,0,3,2] row_mask:0xf bank_mask:0xf
v_fmac_f32_dpp v62, v62, v7 quad_perm:[1,0,3,2] row_mask:0xf bank_mask:0xf
v_fmac_f32_dpp v63, v63, v7 quad_perm:[1,0,3,2] row_mask:0xf bank_mask:0xf
v_fmac_f32_dpp v22, v22, v7 quad_perm:[1,0,3,2] row_mask:0xf bank_mask:0xf
v_fmac_f32_dpp v23, v23, v7 quad_perm:[1,0,3,2] row_mask:0xf bank_mask:0xf
v_fmac_f32_dpp v54, v54, v7 quad_perm:[1,0,3,2] row_mask:0xf bank_mask:0xf
v_fmac_f32_dpp v55, v55, v7 quad_perm:[1,0,3,2] row_mask:0xf bank_mask:0xf
v_fmac_f32_dpp v38, v38, v7 quad_perm:[1,0,3,2] row_mask:0xf bank_mask:0xf
v_fmac_f32_dpp v39, v39, v7 quad_perm:[1,0,3,2] row_mask:0xf bank_mask:0xf
v_fmac_f32_dpp v70, v70, v7 quad_perm:[1,0,3,2] row_mask:0xf bank_mask:0xf
v_fmac_f32_dpp v71, v71, v7 quad_perm:[1,0,3,2] row_mask:0xf bank_mask:0xf
v_fmac_f32_dpp v78, v78, v7 quad_perm:[1,0,3,2] row_mask:0xf bank_mask:0xf
v_fmac_f32_dpp v79, v79, v7 quad_perm:[1,0,3,2] row_mask:0xf bank_mask:0xf
v_fmac_f32_dpp v32, v32, v7 quad_perm:[1,0,3,2] row_mask:0xf bank_mask:0xf
v_fmac_f32_dpp v33, v33, v7 quad_perm:[1,0,3,2] row_mask:0xf bank_mask:0xf
v_fmac_f32_dpp v24, v24, v7 quad_perm:[1,0,3,2] row_mask:0xf bank_mask:0xf
v_fmac_f32_dpp v25, v25, v7 quad_perm:[1,0,3,2] row_mask:0xf bank_mask:0xf
v_fmac_f32_dpp v56, v56, v7 quad_perm:[1,0,3,2] row_mask:0xf bank_mask:0xf
v_fmac_f32_dpp v57, v57, v7 quad_perm:[1,0,3,2] row_mask:0xf bank_mask:0xf
v_fmac_f32_dpp v20, v20, v7 quad_perm:[1,0,3,2] row_mask:0xf bank_mask:0xf
v_fmac_f32_dpp v21, v21, v7 quad_perm:[1,0,3,2] row_mask:0xf bank_mask:0xf
v_fmac_f32_dpp v52, v52, v7 quad_perm:[1,0,3,2] row_mask:0xf bank_mask:0xf
v_fmac_f32_dpp v53, v53, v7 quad_perm:[1,0,3,2] row_mask:0xf bank_mask:0xf
v_fmac_f32_dpp v36, v36, v7 quad_perm:[1,0,3,2] row_mask:0xf bank_mask:0xf
v_fmac_f32_dpp v37, v37, v7 quad_perm:[1,0,3,2] row_mask:0xf bank_mask:0xf
v_fmac_f32_dpp v68, v68, v7 quad_perm:[1,0,3,2] row_mask:0xf bank_mask:0xf
v_fmac_f32_dpp v69, v69, v7 quad_perm:[1,0,3,2] row_mask:0xf bank_mask:0xf
v_fmac_f32_dpp v18, v18, v7 quad_perm:[1,0,3,2] row_mask:0xf bank_mask:0xf
v_fmac_f32_dpp v19, v19, v7 quad_perm:[1,0,3,2] row_mask:0xf bank_mask:0xf
v_fmac_f32_dpp v50, v50, v7 quad_perm:[1,0,3,2] row_mask:0xf bank_mask:0xf
v_fmac_f32_dpp v51, v51, v7 quad_perm:[1,0,3,2] row_mask:0xf bank_mask:0xf
v_fmac_f32_dpp v34, v34, v7 quad_perm:[1,0,3,2] row_mask:0xf bank_mask:0xf
v_fmac_f32_dpp v35, v35, v7 quad_perm:[1,0,3,2] row_mask:0xf bank_mask:0xf
v_fmac_f32_dpp v66, v66, v7 quad_perm:[1,0,3,2] row_mask:0xf bank_mask:0xf
v_fmac_f32_dpp v67, v67, v7 quad_perm:[1,0,3,2] row_mask:0xf bank_mask:0xf
v_fmac_f32_dpp v26, v26, v7 quad_perm:[1,0,3,2] row_mask:0xf bank_mask:0xf
v_fmac_f32_dpp v27, v27, v7 quad_perm:[1,0,3,2] row_mask:0xf bank_mask:0xf
v_fmac_f32_dpp v58, v58, v7 quad_perm:[1,0,3,2] row_mask:0xf bank_mask:0xf
v_fmac_f32_dpp v59, v59, v7 quad_perm:[1,0,3,2] row_mask:0xf bank_mask:0xf
v_fmac_f32_dpp v42, v42, v7 quad_perm:[1,0,3,2] row_mask:0xf bank_mask:0xf
v_fmac_f32_dpp v43, v43, v7 quad_perm:[1,0,3,2] row_mask:0xf bank_mask:0xf
v_fmac_f32_dpp v74, v74, v7 quad_perm:[1,0,3,2] row_mask:0xf bank_mask:0xf
v_fmac_f32_dpp v75, v75, v7 quad_perm:[1,0,3,2] row_mask:0xf bank_mask:0xf
s_mov_b64 exec, s[18:19]
v_pk_add_f32 v[16:17], v[16:17], 0 neg_lo:[1,0] neg_hi:[1,0]
v_pk_mul_f32 v[48:49], v[14:15], s[48:49] op_sel:[0,0] op_sel_hi:[0,1] neg_lo:[0,1] neg_hi:[0,1]
v_pk_fma_f32 v[14:15], v[14:15], s[48:49], v[48:49] op_sel:[1,1,0] op_sel_hi:[1,0,1] neg_lo:[0,0,0] neg_hi:[0,1,0]
v_pk_mul_f32 v[48:49], v[64:65], s[50:51] op_sel:[0,0] op_sel_hi:[0,1] neg_lo:[0,1] neg_hi:[0,1]
v_pk_fma_f32 v[64:65], v[64:65], s[50:51], v[48:49] op_sel:[1,1,0] op_sel_hi:[1,0,1] neg_lo:[0,0,0] neg_hi:[0,1,0]
v_pk_mul_f32 v[48:49], v[40:41], s[52:53] op_sel:[0,0] op_sel_hi:[0,1] neg_lo:[0,1] neg_hi:[0,1]
v_pk_fma_f32 v[40:41], v[40:41], s[52:53], v[48:49] op_sel:[1,1,0] op_sel_hi:[1,0,1] neg_lo:[0,0,0] neg_hi:[0,1,0]
v_pk_mul_f32 v[48:49], v[72:73], s[54:55] op_sel:[0,0] op_sel_hi:[0,1] neg_lo:[0,1] neg_hi:[0,1]
v_pk_fma_f32 v[72:73], v[72:73], s[54:55], v[48:49] op_sel:[1,1,0] op_sel_hi:[1,0,1] neg_lo:[0,0,0] neg_hi:[0,1,0]
v_pk_mul_f32 v[48:49], v[44:45], s[56:57] op_sel:[0,0] op_sel_hi:[0,1] neg_lo:[0,1] neg_hi:[0,1]
v_pk_fma_f32 v[44:45], v[44:45], s[56:57], v[48:49] op_sel:[1,1,0] op_sel_hi:[1,0,1] neg_lo:[0,0,0] neg_hi:[0,1,0]
v_pk_mul_f32 v[48:49], v[28:29], s[58:59] op_sel:[0,0] op_sel_hi:[0,1] neg_lo:[0,1] neg_hi:[0,1]
v_pk_fma_f32 v[28:29], v[28:29], s[58:59], v[48:49] op_sel:[1,1,0] op_sel_hi:[1,0,1] neg_lo:[0,0,0] neg_hi:[0,1,0]
v_pk_mul_f32 v[48:49], v[60:61], s[60:61] op_sel:[0,0] op_sel_hi:[0,1] neg_lo:[0,1] neg_hi:[0,1]
v_pk_fma_f32 v[60:61], v[60:61], s[60:61], v[48:49] op_sel:[1,1,0] op_sel_hi:[1,0,1] neg_lo:[0,0,0] neg_hi:[0,1,0]
v_pk_mul_f32 v[48:49], v[76:77], s[62:63] op_sel:[0,0] op_sel_hi:[0,1] neg_lo:[0,1] neg_hi:[0,1]
v_pk_fma_f32 v[76:77], v[76:77], s[62:63], v[48:49] op_sel:[1,1,0] op_sel_hi:[1,0,1] neg_lo:[0,0,0] neg_hi:[0,1,0]
v_pk_mul_f32 v[48:49], v[46:47], s[60:61] op_sel:[0,1] op_sel_hi:[0,0] neg_lo:[0,1] neg_hi:[0,1]
v_pk_fma_f32 v[46:47], v[46:47], s[60:61], v[48:49] op_sel:[1,0,0] op_sel_hi:[1,1,1] neg_lo:[0,0,0] neg_hi:[0,1,0]
v_pk_mul_f32 v[48:49], v[30:31], s[58:59] op_sel:[0,1] op_sel_hi:[0,0] neg_lo:[0,1] neg_hi:[0,1]
v_pk_fma_f32 v[30:31], v[30:31], s[58:59], v[48:49] op_sel:[1,0,0] op_sel_hi:[1,1,1] neg_lo:[0,0,0] neg_hi:[0,1,0]
v_pk_mul_f32 v[48:49], v[62:63], s[56:57] op_sel:[0,1] op_sel_hi:[0,0] neg_lo:[0,1] neg_hi:[0,1]
v_pk_fma_f32 v[62:63], v[62:63], s[56:57], v[48:49] op_sel:[1,0,0] op_sel_hi:[1,1,1] neg_lo:[0,0,0] neg_hi:[0,1,0]
v_pk_mul_f32 v[48:49], v[22:23], s[54:55] op_sel:[0,1] op_sel_hi:[0,0] neg_lo:[0,1] neg_hi:[0,1]
v_pk_fma_f32 v[22:23], v[22:23], s[54:55], v[48:49] op_sel:[1,0,0] op_sel_hi:[1,1,1] neg_lo:[0,0,0] neg_hi:[0,1,0]
v_pk_mul_f32 v[48:49], v[54:55], s[52:53] op_sel:[0,1] op_sel_hi:[0,0] neg_lo:[0,1] neg_hi:[0,1]
v_pk_fma_f32 v[54:55], v[54:55], s[52:53], v[48:49] op_sel:[1,0,0] op_sel_hi:[1,1,1] neg_lo:[0,0,0] neg_hi:[0,1,0]
v_pk_mul_f32 v[48:49], v[38:39], s[50:51] op_sel:[0,1] op_sel_hi:[0,0] neg_lo:[0,1] neg_hi:[0,1]
v_pk_fma_f32 v[38:39], v[38:39], s[50:51], v[48:49] op_sel:[1,0,0] op_sel_hi:[1,1,1] neg_lo:[0,0,0] neg_hi:[0,1,0]
v_pk_mul_f32 v[48:49], v[70:71], s[48:49] op_sel:[0,1] op_sel_hi:[0,0] neg_lo:[0,1] neg_hi:[0,1]
v_pk_fma_f32 v[70:71], v[70:71], s[48:49], v[48:49] op_sel:[1,0,0] op_sel_hi:[1,1,1] neg_lo:[0,0,0] neg_hi:[0,1,0]
v_pk_add_f32 v[78:79], v[78:79], 0 op_sel:[1,0] op_sel_hi:[0,0] neg_lo:[0,0] neg_hi:[1,0]
v_pk_mul_f32 v[48:49], v[32:33], s[48:49] op_sel:[0,1] op_sel_hi:[0,0] neg_lo:[0,0] neg_hi:[0,1]
v_pk_fma_f32 v[32:33], v[32:33], s[48:49], v[48:49] op_sel:[1,0,0] op_sel_hi:[1,1,1] neg_lo:[0,0,0] neg_hi:[0,0,0]
v_pk_mul_f32 v[48:49], v[24:25], s[50:51] op_sel:[0,1] op_sel_hi:[0,0] neg_lo:[0,0] neg_hi:[0,1]
v_pk_fma_f32 v[24:25], v[24:25], s[50:51], v[48:49] op_sel:[1,0,0] op_sel_hi:[1,1,1] neg_lo:[0,0,0] neg_hi:[0,0,0]
v_pk_mul_f32 v[48:49], v[56:57], s[52:53] op_sel:[0,1] op_sel_hi:[0,0] neg_lo:[0,0] neg_hi:[0,1]
v_pk_fma_f32 v[56:57], v[56:57], s[52:53], v[48:49] op_sel:[1,0,0] op_sel_hi:[1,1,1] neg_lo:[0,0,0] neg_hi:[0,0,0]
v_pk_mul_f32 v[48:49], v[20:21], s[54:55] op_sel:[0,1] op_sel_hi:[0,0] neg_lo:[0,0] neg_hi:[0,1]
v_pk_fma_f32 v[20:21], v[20:21], s[54:55], v[48:49] op_sel:[1,0,0] op_sel_hi:[1,1,1] neg_lo:[0,0,0] neg_hi:[0,0,0]
v_pk_mul_f32 v[48:49], v[52:53], s[56:57] op_sel:[0,1] op_sel_hi:[0,0] neg_lo:[0,0] neg_hi:[0,1]
v_pk_fma_f32 v[52:53], v[52:53], s[56:57], v[48:49] op_sel:[1,0,0] op_sel_hi:[1,1,1] neg_lo:[0,0,0] neg_hi:[0,0,0]
v_pk_mul_f32 v[48:49], v[36:37], s[58:59] op_sel:[0,1] op_sel_hi:[0,0] neg_lo:[0,0] neg_hi:[0,1]
v_pk_fma_f32 v[36:37], v[36:37], s[58:59], v[48:49] op_sel:[1,0,0] op_sel_hi:[1,1,1] neg_lo:[0,0,0] neg_hi:[0,0,0]
v_pk_mul_f32 v[48:49], v[68:69], s[60:61] op_sel:[0,1] op_sel_hi:[0,0] neg_lo:[0,0] neg_hi:[0,1]
v_pk_fma_f32 v[68:69], v[68:69], s[60:61], v[48:49] op_sel:[1,0,0] op_sel_hi:[1,1,1] neg_lo:[0,0,0] neg_hi:[0,0,0]
v_pk_mul_f32 v[48:49], v[18:19], s[62:63] op_sel:[0,0] op_sel_hi:[0,1] neg_lo:[0,0] neg_hi:[0,1]
v_pk_fma_f32 v[18:19], v[18:19], s[62:63], v[48:49] op_sel:[1,1,0] op_sel_hi:[1,0,1] neg_lo:[0,0,0] neg_hi:[0,0,0]
v_pk_mul_f32 v[48:49], v[50:51], s[60:61] op_sel:[0,0] op_sel_hi:[0,1] neg_lo:[0,0] neg_hi:[0,1]
v_pk_fma_f32 v[50:51], v[50:51], s[60:61], v[48:49] op_sel:[1,1,0] op_sel_hi:[1,0,1] neg_lo:[0,0,0] neg_hi:[0,0,0]
v_pk_mul_f32 v[48:49], v[34:35], s[58:59] op_sel:[0,0] op_sel_hi:[0,1] neg_lo:[0,0] neg_hi:[0,1]
v_pk_fma_f32 v[34:35], v[34:35], s[58:59], v[48:49] op_sel:[1,1,0] op_sel_hi:[1,0,1] neg_lo:[0,0,0] neg_hi:[0,0,0]
v_pk_mul_f32 v[48:49], v[66:67], s[56:57] op_sel:[0,0] op_sel_hi:[0,1] neg_lo:[0,0] neg_hi:[0,1]
v_pk_fma_f32 v[66:67], v[66:67], s[56:57], v[48:49] op_sel:[1,1,0] op_sel_hi:[1,0,1] neg_lo:[0,0,0] neg_hi:[0,0,0]
v_pk_mul_f32 v[48:49], v[26:27], s[54:55] op_sel:[0,0] op_sel_hi:[0,1] neg_lo:[0,0] neg_hi:[0,1]
v_pk_fma_f32 v[26:27], v[26:27], s[54:55], v[48:49] op_sel:[1,1,0] op_sel_hi:[1,0,1] neg_lo:[0,0,0] neg_hi:[0,0,0]
v_pk_mul_f32 v[48:49], v[58:59], s[52:53] op_sel:[0,0] op_sel_hi:[0,1] neg_lo:[0,0] neg_hi:[0,1]
v_pk_fma_f32 v[58:59], v[58:59], s[52:53], v[48:49] op_sel:[1,1,0] op_sel_hi:[1,0,1] neg_lo:[0,0,0] neg_hi:[0,0,0]
v_pk_mul_f32 v[48:49], v[42:43], s[50:51] op_sel:[0,0] op_sel_hi:[0,1] neg_lo:[0,0] neg_hi:[0,1]
v_pk_fma_f32 v[42:43], v[42:43], s[50:51], v[48:49] op_sel:[1,1,0] op_sel_hi:[1,0,1] neg_lo:[0,0,0] neg_hi:[0,0,0]
v_pk_mul_f32 v[48:49], v[74:75], s[48:49] op_sel:[0,0] op_sel_hi:[0,1] neg_lo:[0,0] neg_hi:[0,1]
v_pk_fma_f32 v[74:75], v[74:75], s[48:49], v[48:49] op_sel:[1,1,0] op_sel_hi:[1,0,1] neg_lo:[0,0,0] neg_hi:[0,0,0]
s_mov_b64 exec, -1
v_pk_add_f32 v[48:49], v[16:17], v[78:79] neg_lo:[0,1] neg_hi:[0,1]
v_pk_add_f32 v[16:17], v[16:17], v[78:79]
v_pk_add_f32 v[78:79], v[14:15], v[32:33] neg_lo:[0,1] neg_hi:[0,1]
v_pk_add_f32 v[14:15], v[14:15], v[32:33]
v_pk_mul_f32 v[32:33], v[78:79], s[50:51] op_sel:[0,0] op_sel_hi:[0,1] neg_lo:[0,0] neg_hi:[0,0]
v_pk_fma_f32 v[32:33], v[78:79], s[50:51], v[32:33] op_sel:[1,1,0] op_sel_hi:[1,0,1] neg_lo:[0,1,0] neg_hi:[0,0,0]
v_pk_add_f32 v[78:79], v[64:65], v[24:25] neg_lo:[0,1] neg_hi:[0,1]
v_pk_add_f32 v[64:65], v[64:65], v[24:25]
v_pk_mul_f32 v[24:25], v[78:79], s[54:55] op_sel:[0,0] op_sel_hi:[0,1] neg_lo:[0,0] neg_hi:[0,0]
v_pk_fma_f32 v[24:25], v[78:79], s[54:55], v[24:25] op_sel:[1,1,0] op_sel_hi:[1,0,1] neg_lo:[0,1,0] neg_hi:[0,0,0]
v_pk_add_f32 v[78:79], v[40:41], v[56:57] neg_lo:[0,1] neg_hi:[0,1]
v_pk_add_f32 v[40:41], v[40:41], v[56:57]
v_pk_mul_f32 v[56:57], v[78:79], s[58:59] op_sel:[0,0] op_sel_hi:[0,1] neg_lo:[0,0] neg_hi:[0,0]
v_pk_fma_f32 v[56:57], v[78:79], s[58:59], v[56:57] op_sel:[1,1,0] op_sel_hi:[1,0,1] neg_lo:[0,1,0] neg_hi:[0,0,0]
v_pk_add_f32 v[78:79], v[72:73], v[20:21] neg_lo:[0,1] neg_hi:[0,1]
v_pk_add_f32 v[72:73], v[72:73], v[20:21]
v_pk_mul_f32 v[20:21], v[78:79], s[62:63] op_sel:[0,0] op_sel_hi:[0,1] neg_lo:[0,0] neg_hi:[0,0]
v_pk_fma_f32 v[20:21], v[78:79], s[62:63], v[20:21] op_sel:[1,1,0] op_sel_hi:[1,0,1] neg_lo:[0,1,0] neg_hi:[0,0,0]
v_pk_add_f32 v[78:79], v[44:45], v[52:53] neg_lo:[0,1] neg_hi:[0,1]
v_pk_add_f32 v[44:45], v[44:45], v[52:53]
v_pk_mul_f32 v[52:53], v[78:79], s[58:59] op_sel:[0,1] op_sel_hi:[0,0] neg_lo:[0,0] neg_hi:[0,0]
v_pk_fma_f32 v[52:53], v[78:79], s[58:59], v[52:53] op_sel:[1,0,0] op_sel_hi:[1,1,1] neg_lo:[0,1,0] neg_hi:[0,0,0]
v_pk_add_f32 v[78:79], v[28:29], v[36:37] neg_lo:[0,1] neg_hi:[0,1]
v_pk_add_f32 v[28:29], v[28:29], v[36:37]
v_pk_mul_f32 v[36:37], v[78:79], s[54:55] op_sel:[0,1] op_sel_hi:[0,0] neg_lo:[0,0] neg_hi:[0,0]
v_pk_fma_f32 v[36:37], v[78:79], s[54:55], v[36:37] op_sel:[1,0,0] op_sel_hi:[1,1,1] neg_lo:[0,1,0] neg_hi:[0,0,0]
v_pk_add_f32 v[78:79], v[60:61], v[68:69] neg_lo:[0,1] neg_hi:[0,1]
v_pk_add_f32 v[60:61], v[60:61], v[68:69]
v_pk_mul_f32 v[68:69], v[78:79], s[50:51] op_sel:[0,1] op_sel_hi:[0,0] neg_lo:[0,0] neg_hi:[0,0]
v_pk_fma_f32 v[68:69], v[78:79], s[50:51], v[68:69] op_sel:[1,0,0] op_sel_hi:[1,1,1] neg_lo:[0,1,0] neg_hi:[0,0,0]
v_pk_add_f32 v[78:79], v[76:77], v[18:19] op_sel:[1,1] op_sel_hi:[0,0] neg_lo:[1,0] neg_hi:[0,1]
v_pk_add_f32 v[76:77], v[76:77], v[18:19]
v_pk_add_f32 v[18:19], v[46:47], v[50:51] neg_lo:[0,1] neg_hi:[0,1]
v_pk_add_f32 v[46:47], v[46:47], v[50:51]
v_pk_mul_f32 v[50:51], v[18:19], s[50:51] op_sel:[0,1] op_sel_hi:[0,0] neg_lo:[0,1] neg_hi:[0,0]
v_pk_fma_f32 v[50:51], v[18:19], s[50:51], v[50:51] op_sel:[1,0,0] op_sel_hi:[1,1,1] neg_lo:[0,1,0] neg_hi:[0,1,0]
v_pk_add_f32 v[18:19], v[30:31], v[34:35] neg_lo:[0,1] neg_hi:[0,1]
v_pk_add_f32 v[30:31], v[30:31], v[34:35]
v_pk_mul_f32 v[34:35], v[18:19], s[54:55] op_sel:[0,1] op_sel_hi:[0,0] neg_lo:[0,1] neg_hi:[0,0]
v_pk_fma_f32 v[34:35], v[18:19], s[54:55], v[34:35] op_sel:[1,0,0] op_sel_hi:[1,1,1] neg_lo:[0,1,0] neg_hi:[0,1,0]
v_pk_add_f32 v[18:19], v[62:63], v[66:67] neg_lo:[0,1] neg_hi:[0,1]
v_pk_add_f32 v[62:63], v[62:63], v[66:67]
v_pk_mul_f32 v[66:67], v[18:19], s[58:59] op_sel:[0,1] op_sel_hi:[0,0] neg_lo:[0,1] neg_hi:[0,0]
v_pk_fma_f32 v[66:67], v[18:19], s[58:59], v[66:67] op_sel:[1,0,0] op_sel_hi:[1,1,1] neg_lo:[0,1,0] neg_hi:[0,1,0]
v_pk_add_f32 v[18:19], v[22:23], v[26:27] neg_lo:[0,1] neg_hi:[0,1]
v_pk_add_f32 v[22:23], v[22:23], v[26:27]
v_pk_mul_f32 v[26:27], v[18:19], s[62:63] op_sel:[0,0] op_sel_hi:[0,1] neg_lo:[0,1] neg_hi:[0,0]
v_pk_fma_f32 v[26:27], v[18:19], s[62:63], v[26:27] op_sel:[1,1,0] op_sel_hi:[1,0,1] neg_lo:[0,1,0] neg_hi:[0,1,0]
v_pk_add_f32 v[18:19], v[54:55], v[58:59] neg_lo:[0,1] neg_hi:[0,1]
v_pk_add_f32 v[54:55], v[54:55], v[58:59]
v_pk_mul_f32 v[58:59], v[18:19], s[58:59] op_sel:[0,0] op_sel_hi:[0,1] neg_lo:[0,1] neg_hi:[0,0]
v_pk_fma_f32 v[58:59], v[18:19], s[58:59], v[58:59] op_sel:[1,1,0] op_sel_hi:[1,0,1] neg_lo:[0,1,0] neg_hi:[0,1,0]
v_pk_add_f32 v[18:19], v[38:39], v[42:43] neg_lo:[0,1] neg_hi:[0,1]
v_pk_add_f32 v[38:39], v[38:39], v[42:43]
v_pk_mul_f32 v[42:43], v[18:19], s[54:55] op_sel:[0,0] op_sel_hi:[0,1] neg_lo:[0,1] neg_hi:[0,0]
v_pk_fma_f32 v[42:43], v[18:19], s[54:55], v[42:43] op_sel:[1,1,0] op_sel_hi:[1,0,1] neg_lo:[0,1,0] neg_hi:[0,1,0]
v_pk_add_f32 v[18:19], v[70:71], v[74:75] neg_lo:[0,1] neg_hi:[0,1]
v_pk_add_f32 v[70:71], v[70:71], v[74:75]
v_pk_mul_f32 v[74:75], v[18:19], s[50:51] op_sel:[0,0] op_sel_hi:[0,1] neg_lo:[0,1] neg_hi:[0,0]
v_pk_fma_f32 v[74:75], v[18:19], s[50:51], v[74:75] op_sel:[1,1,0] op_sel_hi:[1,0,1] neg_lo:[0,1,0] neg_hi:[0,1,0]
v_pk_add_f32 v[18:19], v[16:17], v[76:77] neg_lo:[0,1] neg_hi:[0,1]
v_pk_add_f32 v[16:17], v[16:17], v[76:77]
v_pk_add_f32 v[76:77], v[14:15], v[46:47] neg_lo:[0,1] neg_hi:[0,1]
v_pk_add_f32 v[14:15], v[14:15], v[46:47]
v_pk_mul_f32 v[46:47], v[76:77], s[54:55] op_sel:[0,0] op_sel_hi:[0,1] neg_lo:[0,0] neg_hi:[0,0]
v_pk_fma_f32 v[46:47], v[76:77], s[54:55], v[46:47] op_sel:[1,1,0] op_sel_hi:[1,0,1] neg_lo:[0,1,0] neg_hi:[0,0,0]
v_pk_add_f32 v[76:77], v[64:65], v[30:31] neg_lo:[0,1] neg_hi:[0,1]
v_pk_add_f32 v[64:65], v[64:65], v[30:31]
v_pk_mul_f32 v[30:31], v[76:77], s[62:63] op_sel:[0,0] op_sel_hi:[0,1] neg_lo:[0,0] neg_hi:[0,0]
v_pk_fma_f32 v[30:31], v[76:77], s[62:63], v[30:31] op_sel:[1,1,0] op_sel_hi:[1,0,1] neg_lo:[0,1,0] neg_hi:[0,0,0]
v_pk_add_f32 v[76:77], v[40:41], v[62:63] neg_lo:[0,1] neg_hi:[0,1]
v_pk_add_f32 v[40:41], v[40:41], v[62:63]
v_pk_mul_f32 v[62:63], v[76:77], s[54:55] op_sel:[0,1] op_sel_hi:[0,0] neg_lo:[0,0] neg_hi:[0,0]
v_pk_fma_f32 v[62:63], v[76:77], s[54:55], v[62:63] op_sel:[1,0,0] op_sel_hi:[1,1,1] neg_lo:[0,1,0] neg_hi:[0,0,0]
v_pk_add_f32 v[76:77], v[72:73], v[22:23] op_sel:[1,1] op_sel_hi:[0,0] neg_lo:[1,0] neg_hi:[0,1]
v_pk_add_f32 v[72:73], v[72:73], v[22:23]
v_pk_add_f32 v[22:23], v[44:45], v[54:55] neg_lo:[0,1] neg_hi:[0,1]
v_pk_add_f32 v[44:45], v[44:45], v[54:55]
v_pk_mul_f32 v[54:55], v[22:23], s[54:55] op_sel:[0,1] op_sel_hi:[0,0] neg_lo:[0,1] neg_hi:[0,0]
v_pk_fma_f32 v[54:55], v[22:23], s[54:55], v[54:55] op_sel:[1,0,0] op_sel_hi:[1,1,1] neg_lo:[0,1,0] neg_hi:[0,1,0]
v_pk_add_f32 v[22:23], v[28:29], v[38:39] neg_lo:[0,1] neg_hi:[0,1]
v_pk_add_f32 v[28:29], v[28:29], v[38:39]
v_pk_mul_f32 v[38:39], v[22:23], s[62:63] op_sel:[0,0] op_sel_hi:[0,1] neg_lo:[0,1] neg_hi:[0,0]
v_pk_fma_f32 v[38:39], v[22:23], s[62:63], v[38:39] op_sel:[1,1,0] op_sel_hi:[1,0,1] neg_lo:[0,1,0] neg_hi:[0,1,0]
v_pk_add_f32 v[22:23], v[60:61], v[70:71] neg_lo:[0,1] neg_hi:[0,1]
v_pk_add_f32 v[60:61], v[60:61], v[70:71]
v_pk_mul_f32 v[70:71], v[22:23], s[54:55] op_sel:[0,0] op_sel_hi:[0,1] neg_lo:[0,1] neg_hi:[0,0]
v_pk_fma_f32 v[70:71], v[22:23], s[54:55], v[70:71] op_sel:[1,1,0] op_sel_hi:[1,0,1] neg_lo:[0,1,0] neg_hi:[0,1,0]
v_pk_add_f32 v[22:23], v[48:49], v[78:79] neg_lo:[0,1] neg_hi:[0,1]
v_pk_add_f32 v[48:49], v[48:49], v[78:79]
v_pk_add_f32 v[78:79], v[32:33], v[50:51] neg_lo:[0,1] neg_hi:[0,1]
v_pk_add_f32 v[32:33], v[32:33], v[50:51]
v_pk_mul_f32 v[50:51], v[78:79], s[54:55] op_sel:[0,0] op_sel_hi:[0,1] neg_lo:[0,0] neg_hi:[0,0]
v_pk_fma_f32 v[50:51], v[78:79], s[54:55], v[50:51] op_sel:[1,1,0] op_sel_hi:[1,0,1] neg_lo:[0,1,0] neg_hi:[0,0,0]
v_pk_add_f32 v[78:79], v[24:25], v[34:35] neg_lo:[0,1] neg_hi:[0,1]
v_pk_add_f32 v[24:25], v[24:25], v[34:35]
v_pk_mul_f32 v[34:35], v[78:79], s[62:63] op_sel:[0,0] op_sel_hi:[0,1] neg_lo:[0,0] neg_hi:[0,0]
v_pk_fma_f32 v[34:35], v[78:79], s[62:63], v[34:35] op_sel:[1,1,0] op_sel_hi:[1,0,1] neg_lo:[0,1,0] neg_hi:[0,0,0]
v_pk_add_f32 v[78:79], v[56:57], v[66:67] neg_lo:[0,1] neg_hi:[0,1]
v_pk_add_f32 v[56:57], v[56:57], v[66:67]
v_pk_mul_f32 v[66:67], v[78:79], s[54:55] op_sel:[0,1] op_sel_hi:[0,0] neg_lo:[0,0] neg_hi:[0,0]
v_pk_fma_f32 v[66:67], v[78:79], s[54:55], v[66:67] op_sel:[1,0,0] op_sel_hi:[1,1,1] neg_lo:[0,1,0] neg_hi:[0,0,0]
v_pk_add_f32 v[78:79], v[20:21], v[26:27] op_sel:[1,1] op_sel_hi:[0,0] neg_lo:[1,0] neg_hi:[0,1]
v_pk_add_f32 v[20:21], v[20:21], v[26:27]
v_pk_add_f32 v[26:27], v[52:53], v[58:59] neg_lo:[0,1] neg_hi:[0,1]
v_pk_add_f32 v[52:53], v[52:53], v[58:59]
v_pk_mul_f32 v[58:59], v[26:27], s[54:55] op_sel:[0,1] op_sel_hi:[0,0] neg_lo:[0,1] neg_hi:[0,0]
v_pk_fma_f32 v[58:59], v[26:27], s[54:55], v[58:59] op_sel:[1,0,0] op_sel_hi:[1,1,1] neg_lo:[0,1,0] neg_hi:[0,1,0]
v_pk_add_f32 v[26:27], v[36:37], v[42:43] neg_lo:[0,1] neg_hi:[0,1]
v_pk_add_f32 v[36:37], v[36:37], v[42:43]
v_pk_mul_f32 v[42:43], v[26:27], s[62:63] op_sel:[0,0] op_sel_hi:[0,1] neg_lo:[0,1] neg_hi:[0,0]
v_pk_fma_f32 v[42:43], v[26:27], s[62:63], v[42:43] op_sel:[1,1,0] op_sel_hi:[1,0,1] neg_lo:[0,1,0] neg_hi:[0,1,0]
v_pk_add_f32 v[26:27], v[68:69], v[74:75] neg_lo:[0,1] neg_hi:[0,1]
v_pk_add_f32 v[68:69], v[68:69], v[74:75]
v_pk_mul_f32 v[74:75], v[26:27], s[54:55] op_sel:[0,0] op_sel_hi:[0,1] neg_lo:[0,1] neg_hi:[0,0]
v_pk_fma_f32 v[74:75], v[26:27], s[54:55], v[74:75] op_sel:[1,1,0] op_sel_hi:[1,0,1] neg_lo:[0,1,0] neg_hi:[0,1,0]
v_pk_add_f32 v[26:27], v[16:17], v[72:73] neg_lo:[0,1] neg_hi:[0,1]
v_pk_add_f32 v[16:17], v[16:17], v[72:73]
v_pk_add_f32 v[72:73], v[14:15], v[44:45] neg_lo:[0,1] neg_hi:[0,1]
v_pk_add_f32 v[14:15], v[14:15], v[44:45]
v_pk_mul_f32 v[44:45], v[72:73], s[62:63] op_sel:[0,0] op_sel_hi:[0,1] neg_lo:[0,0] neg_hi:[0,0]
v_pk_fma_f32 v[44:45], v[72:73], s[62:63], v[44:45] op_sel:[1,1,0] op_sel_hi:[1,0,1] neg_lo:[0,1,0] neg_hi:[0,0,0]
v_pk_add_f32 v[72:73], v[64:65], v[28:29] op_sel:[1,1] op_sel_hi:[0,0] neg_lo:[1,0] neg_hi:[0,1]
v_pk_add_f32 v[64:65], v[64:65], v[28:29]
v_pk_add_f32 v[28:29], v[40:41], v[60:61] neg_lo:[0,1] neg_hi:[0,1]
v_pk_add_f32 v[40:41], v[40:41], v[60:61]
v_pk_mul_f32 v[60:61], v[28:29], s[62:63] op_sel:[0,0] op_sel_hi:[0,1] neg_lo:[0,1] neg_hi:[0,0]
v_pk_fma_f32 v[60:61], v[28:29], s[62:63], v[60:61] op_sel:[1,1,0] op_sel_hi:[1,0,1] neg_lo:[0,1,0] neg_hi:[0,1,0]
v_pk_add_f32 v[28:29], v[18:19], v[76:77] neg_lo:[0,1] neg_hi:[0,1]
v_pk_add_f32 v[18:19], v[18:19], v[76:77]
v_pk_add_f32 v[76:77], v[46:47], v[54:55] neg_lo:[0,1] neg_hi:[0,1]
v_pk_add_f32 v[46:47], v[46:47], v[54:55]
v_pk_mul_f32 v[54:55], v[76:77], s[62:63] op_sel:[0,0] op_sel_hi:[0,1] neg_lo:[0,0] neg_hi:[0,0]
v_pk_fma_f32 v[54:55], v[76:77], s[62:63], v[54:55] op_sel:[1,1,0] op_sel_hi:[1,0,1] neg_lo:[0,1,0] neg_hi:[0,0,0]
v_pk_add_f32 v[76:77], v[30:31], v[38:39] op_sel:[1,1] op_sel_hi:[0,0] neg_lo:[1,0] neg_hi:[0,1]
v_pk_add_f32 v[30:31], v[30:31], v[38:39]
v_pk_add_f32 v[38:39], v[62:63], v[70:71] neg_lo:[0,1] neg_hi:[0,1]
v_pk_add_f32 v[62:63], v[62:63], v[70:71]
v_pk_mul_f32 v[70:71], v[38:39], s[62:63] op_sel:[0,0] op_sel_hi:[0,1] neg_lo:[0,1] neg_hi:[0,0]
v_pk_fma_f32 v[70:71], v[38:39], s[62:63], v[70:71] op_sel:[1,1,0] op_sel_hi:[1,0,1] neg_lo:[0,1,0] neg_hi:[0,1,0]
v_pk_add_f32 v[38:39], v[48:49], v[20:21] neg_lo:[0,1] neg_hi:[0,1]
v_pk_add_f32 v[48:49], v[48:49], v[20:21]
v_pk_add_f32 v[20:21], v[32:33], v[52:53] neg_lo:[0,1] neg_hi:[0,1]
v_pk_add_f32 v[32:33], v[32:33], v[52:53]
v_pk_mul_f32 v[52:53], v[20:21], s[62:63] op_sel:[0,0] op_sel_hi:[0,1] neg_lo:[0,0] neg_hi:[0,0]
v_pk_fma_f32 v[52:53], v[20:21], s[62:63], v[52:53] op_sel:[1,1,0] op_sel_hi:[1,0,1] neg_lo:[0,1,0] neg_hi:[0,0,0]
v_pk_add_f32 v[20:21], v[24:25], v[36:37] op_sel:[1,1] op_sel_hi:[0,0] neg_lo:[1,0] neg_hi:[0,1]
v_pk_add_f32 v[24:25], v[24:25], v[36:37]
v_pk_add_f32 v[36:37], v[56:57], v[68:69] neg_lo:[0,1] neg_hi:[0,1]
v_pk_add_f32 v[56:57], v[56:57], v[68:69]
v_pk_mul_f32 v[68:69], v[36:37], s[62:63] op_sel:[0,0] op_sel_hi:[0,1] neg_lo:[0,1] neg_hi:[0,0]
v_pk_fma_f32 v[68:69], v[36:37], s[62:63], v[68:69] op_sel:[1,1,0] op_sel_hi:[1,0,1] neg_lo:[0,1,0] neg_hi:[0,1,0]
v_pk_add_f32 v[36:37], v[22:23], v[78:79] neg_lo:[0,1] neg_hi:[0,1]
v_pk_add_f32 v[22:23], v[22:23], v[78:79]
v_pk_add_f32 v[78:79], v[50:51], v[58:59] neg_lo:[0,1] neg_hi:[0,1]
v_pk_add_f32 v[50:51], v[50:51], v[58:59]
v_pk_mul_f32 v[58:59], v[78:79], s[62:63] op_sel:[0,0] op_sel_hi:[0,1] neg_lo:[0,0] neg_hi:[0,0]
v_pk_fma_f32 v[58:59], v[78:79], s[62:63], v[58:59] op_sel:[1,1,0] op_sel_hi:[1,0,1] neg_lo:[0,1,0] neg_hi:[0,0,0]
v_pk_add_f32 v[78:79], v[34:35], v[42:43] op_sel:[1,1] op_sel_hi:[0,0] neg_lo:[1,0] neg_hi:[0,1]
v_pk_add_f32 v[34:35], v[34:35], v[42:43]
v_pk_add_f32 v[42:43], v[66:67], v[74:75] neg_lo:[0,1] neg_hi:[0,1]
v_pk_add_f32 v[66:67], v[66:67], v[74:75]
v_pk_mul_f32 v[74:75], v[42:43], s[62:63] op_sel:[0,0] op_sel_hi:[0,1] neg_lo:[0,1] neg_hi:[0,0]
v_pk_fma_f32 v[74:75], v[42:43], s[62:63], v[74:75] op_sel:[1,1,0] op_sel_hi:[1,0,1] neg_lo:[0,1,0] neg_hi:[0,1,0]
v_pk_add_f32 v[42:43], v[16:17], v[64:65] neg_lo:[0,1] neg_hi:[0,1]
v_pk_add_f32 v[16:17], v[16:17], v[64:65]
v_pk_add_f32 v[64:65], v[14:15], v[40:41] op_sel:[1,1] op_sel_hi:[0,0] neg_lo:[1,0] neg_hi:[0,1]
v_pk_add_f32 v[14:15], v[14:15], v[40:41]
v_pk_add_f32 v[40:41], v[26:27], v[72:73] neg_lo:[0,1] neg_hi:[0,1]
v_pk_add_f32 v[26:27], v[26:27], v[72:73]
v_pk_add_f32 v[72:73], v[44:45], v[60:61] op_sel:[1,1] op_sel_hi:[0,0] neg_lo:[1,0] neg_hi:[0,1]
v_pk_add_f32 v[44:45], v[44:45], v[60:61]
v_pk_add_f32 v[60:61], v[18:19], v[30:31] neg_lo:[0,1] neg_hi:[0,1]
v_pk_add_f32 v[18:19], v[18:19], v[30:31]
v_pk_add_f32 v[30:31], v[46:47], v[62:63] op_sel:[1,1] op_sel_hi:[0,0] neg_lo:[1,0] neg_hi:[0,1]
v_pk_add_f32 v[46:47], v[46:47], v[62:63]
v_pk_add_f32 v[62:63], v[28:29], v[76:77] neg_lo:[0,1] neg_hi:[0,1]
v_pk_add_f32 v[28:29], v[28:29], v[76:77]
v_pk_add_f32 v[76:77], v[54:55], v[70:71] op_sel:[1,1] op_sel_hi:[0,0] neg_lo:[1,0] neg_hi:[0,1]
v_pk_add_f32 v[54:55], v[54:55], v[70:71]
v_pk_add_f32 v[70:71], v[48:49], v[24:25] neg_lo:[0,1] neg_hi:[0,1]
v_pk_add_f32 v[48:49], v[48:49], v[24:25]
v_pk_add_f32 v[24:25], v[32:33], v[56:57] op_sel:[1,1] op_sel_hi:[0,0] neg_lo:[1,0] neg_hi:[0,1]
v_pk_add_f32 v[32:33], v[32:33], v[56:57]
v_pk_add_f32 v[56:57], v[38:39], v[20:21] neg_lo:[0,1] neg_hi:[0,1]
v_pk_add_f32 v[38:39], v[38:39], v[20:21]
v_pk_add_f32 v[20:21], v[52:53], v[68:69] op_sel:[1,1] op_sel_hi:[0,0] neg_lo:[1,0] neg_hi:[0,1]
v_pk_add_f32 v[52:53], v[52:53], v[68:69]
v_pk_add_f32 v[68:69], v[22:23], v[34:35] neg_lo:[0,1] neg_hi:[0,1]
v_pk_add_f32 v[22:23], v[22:23], v[34:35]
v_pk_add_f32 v[34:35], v[50:51], v[66:67] op_sel:[1,1] op_sel_hi:[0,0] neg_lo:[1,0] neg_hi:[0,1]
v_pk_add_f32 v[50:51], v[50:51], v[66:67]
v_pk_add_f32 v[66:67], v[36:37], v[78:79] neg_lo:[0,1] neg_hi:[0,1]
v_pk_add_f32 v[36:37], v[36:37], v[78:79]
v_pk_add_f32 v[78:79], v[58:59], v[74:75] op_sel:[1,1] op_sel_hi:[0,0] neg_lo:[1,0] neg_hi:[0,1]
v_pk_add_f32 v[58:59], v[58:59], v[74:75]
v_pk_add_f32 v[74:75], v[16:17], v[14:15] neg_lo:[0,1] neg_hi:[0,1]
v_pk_add_f32 v[16:17], v[16:17], v[14:15]
v_pk_add_f32 v[14:15], v[42:43], v[64:65] neg_lo:[0,1] neg_hi:[0,1]
v_pk_add_f32 v[42:43], v[42:43], v[64:65]
v_pk_add_f32 v[64:65], v[26:27], v[44:45] neg_lo:[0,1] neg_hi:[0,1]
v_pk_add_f32 v[26:27], v[26:27], v[44:45]
v_pk_add_f32 v[44:45], v[40:41], v[72:73] neg_lo:[0,1] neg_hi:[0,1]
v_pk_add_f32 v[40:41], v[40:41], v[72:73]
v_pk_add_f32 v[72:73], v[18:19], v[46:47] neg_lo:[0,1] neg_hi:[0,1]
v_pk_add_f32 v[18:19], v[18:19], v[46:47]
v_pk_add_f32 v[46:47], v[60:61], v[30:31] neg_lo:[0,1] neg_hi:[0,1]
v_pk_add_f32 v[60:61], v[60:61], v[30:31]
v_pk_add_f32 v[30:31], v[28:29], v[54:55] neg_lo:[0,1] neg_hi:[0,1]
v_pk_add_f32 v[28:29], v[28:29], v[54:55]
v_pk_add_f32 v[54:55], v[62:63], v[76:77] neg_lo:[0,1] neg_hi:[0,1]
v_pk_add_f32 v[62:63], v[62:63], v[76:77]
v_pk_add_f32 v[76:77], v[48:49], v[32:33] neg_lo:[0,1] neg_hi:[0,1]
v_pk_add_f32 v[48:49], v[48:49], v[32:33]
v_pk_add_f32 v[32:33], v[70:71], v[24:25] neg_lo:[0,1] neg_hi:[0,1]
v_pk_add_f32 v[70:71], v[70:71], v[24:25]
v_pk_add_f32 v[24:25], v[38:39], v[52:53] neg_lo:[0,1] neg_hi:[0,1]
v_pk_add_f32 v[38:39], v[38:39], v[52:53]
v_pk_add_f32 v[52:53], v[56:57], v[20:21] neg_lo:[0,1] neg_hi:[0,1]
v_pk_add_f32 v[56:57], v[56:57], v[20:21]
v_pk_add_f32 v[20:21], v[22:23], v[50:51] neg_lo:[0,1] neg_hi:[0,1]
v_pk_add_f32 v[22:23], v[22:23], v[50:51]
v_pk_add_f32 v[50:51], v[68:69], v[34:35] neg_lo:[0,1] neg_hi:[0,1]
v_pk_add_f32 v[68:69], v[68:69], v[34:35]
v_pk_add_f32 v[34:35], v[36:37], v[58:59] neg_lo:[0,1] neg_hi:[0,1]
v_pk_add_f32 v[36:37], v[36:37], v[58:59]
v_pk_add_f32 v[58:59], v[66:67], v[78:79] neg_lo:[0,1] neg_hi:[0,1]
v_pk_add_f32 v[66:67], v[66:67], v[78:79]
v_pk_mul_f32 v[78:79], v[16:17], v[144:145] op_sel:[0,0] op_sel_hi:[0,1] neg_lo:[0,0] neg_hi:[0,0]
v_pk_fma_f32 v[16:17], v[16:17], v[144:145], v[78:79] op_sel:[1,1,0] op_sel_hi:[1,0,1] neg_lo:[0,1,0] neg_hi:[0,0,0]
v_pk_mul_f32 v[78:79], v[48:49], v[146:147] op_sel:[0,0] op_sel_hi:[0,1] neg_lo:[0,0] neg_hi:[0,0]
v_pk_fma_f32 v[48:49], v[48:49], v[146:147], v[78:79] op_sel:[1,1,0] op_sel_hi:[1,0,1] neg_lo:[0,1,0] neg_hi:[0,0,0]
v_pk_mul_f32 v[78:79], v[18:19], v[148:149] op_sel:[0,0] op_sel_hi:[0,1] neg_lo:[0,0] neg_hi:[0,0]
v_pk_fma_f32 v[18:19], v[18:19], v[148:149], v[78:79] op_sel:[1,1,0] op_sel_hi:[1,0,1] neg_lo:[0,1,0] neg_hi:[0,0,0]
v_pk_mul_f32 v[78:79], v[22:23], v[150:151] op_sel:[0,0] op_sel_hi:[0,1] neg_lo:[0,0] neg_hi:[0,0]
v_pk_fma_f32 v[22:23], v[22:23], v[150:151], v[78:79] op_sel:[1,1,0] op_sel_hi:[1,0,1] neg_lo:[0,1,0] neg_hi:[0,0,0]
v_pk_mul_f32 v[78:79], v[26:27], v[152:153] op_sel:[0,0] op_sel_hi:[0,1] neg_lo:[0,0] neg_hi:[0,0]
v_pk_fma_f32 v[26:27], v[26:27], v[152:153], v[78:79] op_sel:[1,1,0] op_sel_hi:[1,0,1] neg_lo:[0,1,0] neg_hi:[0,0,0]
v_pk_mul_f32 v[78:79], v[38:39], v[154:155] op_sel:[0,0] op_sel_hi:[0,1] neg_lo:[0,0] neg_hi:[0,0]
v_pk_fma_f32 v[38:39], v[38:39], v[154:155], v[78:79] op_sel:[1,1,0] op_sel_hi:[1,0,1] neg_lo:[0,1,0] neg_hi:[0,0,0]
v_pk_mul_f32 v[78:79], v[28:29], v[156:157] op_sel:[0,0] op_sel_hi:[0,1] neg_lo:[0,0] neg_hi:[0,0]
v_pk_fma_f32 v[28:29], v[28:29], v[156:157], v[78:79] op_sel:[1,1,0] op_sel_hi:[1,0,1] neg_lo:[0,1,0] neg_hi:[0,0,0]
v_pk_mul_f32 v[78:79], v[36:37], v[158:159] op_sel:[0,0] op_sel_hi:[0,1] neg_lo:[0,0] neg_hi:[0,0]
v_pk_fma_f32 v[36:37], v[36:37], v[158:159], v[78:79] op_sel:[1,1,0] op_sel_hi:[1,0,1] neg_lo:[0,1,0] neg_hi:[0,0,0]
v_pk_mul_f32 v[78:79], v[42:43], v[160:161] op_sel:[0,0] op_sel_hi:[0,1] neg_lo:[0,0] neg_hi:[0,0]
v_pk_fma_f32 v[42:43], v[42:43], v[160:161], v[78:79] op_sel:[1,1,0] op_sel_hi:[1,0,1] neg_lo:[0,1,0] neg_hi:[0,0,0]
v_pk_mul_f32 v[78:79], v[70:71], v[162:163] op_sel:[0,0] op_sel_hi:[0,1] neg_lo:[0,0] neg_hi:[0,0]
v_pk_fma_f32 v[70:71], v[70:71], v[162:163], v[78:79] op_sel:[1,1,0] op_sel_hi:[1,0,1] neg_lo:[0,1,0] neg_hi:[0,0,0]
v_pk_mul_f32 v[78:79], v[60:61], v[164:165] op_sel:[0,0] op_sel_hi:[0,1] neg_lo:[0,0] neg_hi:[0,0]
v_pk_fma_f32 v[60:61], v[60:61], v[164:165], v[78:79] op_sel:[1,1,0] op_sel_hi:[1,0,1] neg_lo:[0,1,0] neg_hi:[0,0,0]
v_pk_mul_f32 v[78:79], v[68:69], v[166:167] op_sel:[0,0] op_sel_hi:[0,1] neg_lo:[0,0] neg_hi:[0,0]
v_pk_fma_f32 v[68:69], v[68:69], v[166:167], v[78:79] op_sel:[1,1,0] op_sel_hi:[1,0,1] neg_lo:[0,1,0] neg_hi:[0,0,0]
v_pk_mul_f32 v[78:79], v[40:41], v[168:169] op_sel:[0,0] op_sel_hi:[0,1] neg_lo:[0,0] neg_hi:[0,0]
v_pk_fma_f32 v[40:41], v[40:41], v[168:169], v[78:79] op_sel:[1,1,0] op_sel_hi:[1,0,1] neg_lo:[0,1,0] neg_hi:[0,0,0]
v_pk_mul_f32 v[78:79], v[56:57], v[170:171] op_sel:[0,0] op_sel_hi:[0,1] neg_lo:[0,0] neg_hi:[0,0]
v_pk_fma_f32 v[56:57], v[56:57], v[170:171], v[78:79] op_sel:[1,1,0] op_sel_hi:[1,0,1] neg_lo:[0,1,0] neg_hi:[0,0,0]
v_pk_mul_f32 v[78:79], v[62:63], v[172:173] op_sel:[0,0] op_sel_hi:[0,1] neg_lo:[0,0] neg_hi:[0,0]
v_pk_fma_f32 v[62:63], v[62:63], v[172:173], v[78:79] op_sel:[1,1,0] op_sel_hi:[1,0,1] neg_lo:[0,1,0] neg_hi:[0,0,0]
v_pk_mul_f32 v[78:79], v[66:67], v[174:175] op_sel:[0,0] op_sel_hi:[0,1] neg_lo:[0,0] neg_hi:[0,0]
v_pk_fma_f32 v[66:67], v[66:67], v[174:175], v[78:79] op_sel:[1,1,0] op_sel_hi:[1,0,1] neg_lo:[0,1,0] neg_hi:[0,0,0]
v_pk_mul_f32 v[78:79], v[74:75], v[176:177] op_sel:[0,0] op_sel_hi:[0,1] neg_lo:[0,0] neg_hi:[0,0]
v_pk_fma_f32 v[74:75], v[74:75], v[176:177], v[78:79] op_sel:[1,1,0] op_sel_hi:[1,0,1] neg_lo:[0,1,0] neg_hi:[0,0,0]
v_pk_mul_f32 v[78:79], v[76:77], v[178:179] op_sel:[0,0] op_sel_hi:[0,1] neg_lo:[0,0] neg_hi:[0,0]
v_pk_fma_f32 v[76:77], v[76:77], v[178:179], v[78:79] op_sel:[1,1,0] op_sel_hi:[1,0,1] neg_lo:[0,1,0] neg_hi:[0,0,0]
v_pk_mul_f32 v[78:79], v[72:73], v[180:181] op_sel:[0,0] op_sel_hi:[0,1] neg_lo:[0,0] neg_hi:[0,0]
v_pk_fma_f32 v[72:73], v[72:73], v[180:181], v[78:79] op_sel:[1,1,0] op_sel_hi:[1,0,1] neg_lo:[0,1,0] neg_hi:[0,0,0]
v_pk_mul_f32 v[78:79], v[20:21], v[182:183] op_sel:[0,0] op_sel_hi:[0,1] neg_lo:[0,0] neg_hi:[0,0]
v_pk_fma_f32 v[20:21], v[20:21], v[182:183], v[78:79] op_sel:[1,1,0] op_sel_hi:[1,0,1] neg_lo:[0,1,0] neg_hi:[0,0,0]
v_pk_mul_f32 v[78:79], v[64:65], v[184:185] op_sel:[0,0] op_sel_hi:[0,1] neg_lo:[0,0] neg_hi:[0,0]
v_pk_fma_f32 v[64:65], v[64:65], v[184:185], v[78:79] op_sel:[1,1,0] op_sel_hi:[1,0,1] neg_lo:[0,1,0] neg_hi:[0,0,0]
v_pk_mul_f32 v[78:79], v[24:25], v[186:187] op_sel:[0,0] op_sel_hi:[0,1] neg_lo:[0,0] neg_hi:[0,0]
v_pk_fma_f32 v[24:25], v[24:25], v[186:187], v[78:79] op_sel:[1,1,0] op_sel_hi:[1,0,1] neg_lo:[0,1,0] neg_hi:[0,0,0]
v_pk_mul_f32 v[78:79], v[30:31], v[188:189] op_sel:[0,0] op_sel_hi:[0,1] neg_lo:[0,0] neg_hi:[0,0]
v_pk_fma_f32 v[30:31], v[30:31], v[188:189], v[78:79] op_sel:[1,1,0] op_sel_hi:[1,0,1] neg_lo:[0,1,0] neg_hi:[0,0,0]
v_pk_mul_f32 v[78:79], v[34:35], v[190:191] op_sel:[0,0] op_sel_hi:[0,1] neg_lo:[0,0] neg_hi:[0,0]
v_pk_fma_f32 v[34:35], v[34:35], v[190:191], v[78:79] op_sel:[1,1,0] op_sel_hi:[1,0,1] neg_lo:[0,1,0] neg_hi:[0,0,0]
v_pk_mul_f32 v[78:79], v[14:15], v[192:193] op_sel:[0,0] op_sel_hi:[0,1] neg_lo:[0,0] neg_hi:[0,0]
v_pk_fma_f32 v[14:15], v[14:15], v[192:193], v[78:79] op_sel:[1,1,0] op_sel_hi:[1,0,1] neg_lo:[0,1,0] neg_hi:[0,0,0]
v_pk_mul_f32 v[78:79], v[32:33], v[194:195] op_sel:[0,0] op_sel_hi:[0,1] neg_lo:[0,0] neg_hi:[0,0]
v_pk_fma_f32 v[32:33], v[32:33], v[194:195], v[78:79] op_sel:[1,1,0] op_sel_hi:[1,0,1] neg_lo:[0,1,0] neg_hi:[0,0,0]
v_pk_mul_f32 v[78:79], v[46:47], v[196:197] op_sel:[0,0] op_sel_hi:[0,1] neg_lo:[0,0] neg_hi:[0,0]
v_pk_fma_f32 v[46:47], v[46:47], v[196:197], v[78:79] op_sel:[1,1,0] op_sel_hi:[1,0,1] neg_lo:[0,1,0] neg_hi:[0,0,0]
v_pk_mul_f32 v[78:79], v[50:51], v[198:199] op_sel:[0,0] op_sel_hi:[0,1] neg_lo:[0,0] neg_hi:[0,0]
v_pk_fma_f32 v[50:51], v[50:51], v[198:199], v[78:79] op_sel:[1,1,0] op_sel_hi:[1,0,1] neg_lo:[0,1,0] neg_hi:[0,0,0]
v_pk_mul_f32 v[78:79], v[44:45], v[200:201] op_sel:[0,0] op_sel_hi:[0,1] neg_lo:[0,0] neg_hi:[0,0]
v_pk_fma_f32 v[44:45], v[44:45], v[200:201], v[78:79] op_sel:[1,1,0] op_sel_hi:[1,0,1] neg_lo:[0,1,0] neg_hi:[0,0,0]
v_pk_mul_f32 v[78:79], v[52:53], v[202:203] op_sel:[0,0] op_sel_hi:[0,1] neg_lo:[0,0] neg_hi:[0,0]
v_pk_fma_f32 v[52:53], v[52:53], v[202:203], v[78:79] op_sel:[1,1,0] op_sel_hi:[1,0,1] neg_lo:[0,1,0] neg_hi:[0,0,0]
v_pk_mul_f32 v[78:79], v[54:55], v[204:205] op_sel:[0,0] op_sel_hi:[0,1] neg_lo:[0,0] neg_hi:[0,0]
v_pk_fma_f32 v[54:55], v[54:55], v[204:205], v[78:79] op_sel:[1,1,0] op_sel_hi:[1,0,1] neg_lo:[0,1,0] neg_hi:[0,0,0]
v_pk_mul_f32 v[78:79], v[58:59], v[206:207] op_sel:[0,0] op_sel_hi:[0,1] neg_lo:[0,0] neg_hi:[0,0]
v_pk_fma_f32 v[58:59], v[58:59], v[206:207], v[78:79] op_sel:[1,1,0] op_sel_hi:[1,0,1] neg_lo:[0,1,0] neg_hi:[0,0,0]
ds_write_b64 v4, v[16:17] offset:0
ds_write_b64 v4, v[48:49] offset:16
ds_write_b64 v4, v[18:19] offset:32
ds_write_b64 v4, v[22:23] offset:48
ds_write_b64 v4, v[26:27] offset:64
ds_write_b64 v4, v[38:39] offset:80
ds_write_b64 v4, v[28:29] offset:96
ds_write_b64 v4, v[36:37] offset:112
ds_write_b64 v4, v[42:43] offset:128
ds_write_b64 v4, v[70:71] offset:144
ds_write_b64 v4, v[60:61] offset:160
ds_write_b64 v4, v[68:69] offset:176
ds_write_b64 v4, v[40:41] offset:192
ds_write_b64 v4, v[56:57] offset:208
ds_write_b64 v4, v[62:63] offset:224
ds_write_b64 v4, v[66:67] offset:240
ds_write_b64 v4, v[74:75] offset:256
ds_write_b64 v4, v[76:77] offset:272
ds_write_b64 v4, v[72:73] offset:288
ds_write_b64 v4, v[20:21] offset:304
ds_write_b64 v4, v[64:65] offset:320
ds_write_b64 v4, v[24:25] offset:336
ds_write_b64 v4, v[30:31] offset:352
ds_write_b64 v4, v[34:35] offset:368
ds_write_b64 v4, v[14:15] offset:384
ds_write_b64 v4, v[32:33] offset:400
ds_write_b64 v4, v[46:47] offset:416
ds_write_b64 v4, v[50:51] offset:432
ds_write_b64 v4, v[44:45] offset:448
ds_write_b64 v4, v[52:53] offset:464
ds_write_b64 v4, v[54:55] offset:480
ds_write_b64 v4, v[58:59] offset:496
s_waitcnt lgkmcnt(0)
ds_read_b64 v[16:17], v3 offset:0
ds_read_b64 v[48:49], v3 offset:8448
ds_read_b64 v[18:19], v3 offset:528
ds_read_b64 v[50:51], v3 offset:8976
ds_read_b64 v[20:21], v3 offset:1056
ds_read_b64 v[52:53], v3 offset:9504
ds_read_b64 v[22:23], v3 offset:1584
ds_read_b64 v[54:55], v3 offset:10032
ds_read_b64 v[24:25], v3 offset:2112
ds_read_b64 v[56:57], v3 offset:10560
ds_read_b64 v[26:27], v3 offset:2640
ds_read_b64 v[58:59], v3 offset:11088
ds_read_b64 v[28:29], v3 offset:3168
ds_read_b64 v[60:61], v3 offset:11616
ds_read_b64 v[30:31], v3 offset:3696
ds_read_b64 v[62:63], v3 offset:12144
ds_read_b64 v[32:33], v3 offset:4224
ds_read_b64 v[64:65], v3 offset:12672
ds_read_b64 v[34:35], v3 offset:4752
ds_read_b64 v[66:67], v3 offset:13200
ds_read_b64 v[36:37], v3 offset:5280
ds_read_b64 v[68:69], v3 offset:13728
ds_read_b64 v[38:39], v3 offset:5808
ds_read_b64 v[70:71], v3 offset:14256
ds_read_b64 v[40:41], v3 offset:6336
ds_read_b64 v[72:73], v3 offset:14784
ds_read_b64 v[42:43], v3 offset:6864
ds_read_b64 v[74:75], v3 offset:15312
ds_read_b64 v[44:45], v3 offset:7392
ds_read_b64 v[76:77], v3 offset:15840
ds_read_b64 v[46:47], v3 offset:7920
ds_read_b64 v[78:79], v3 offset:16368
s_waitcnt lgkmcnt(0)
v_pk_add_f32 v[14:15], v[16:17], v[48:49] neg_lo:[0,1] neg_hi:[0,1]
v_pk_add_f32 v[16:17], v[16:17], v[48:49]
v_pk_add_f32 v[48:49], v[18:19], v[50:51] neg_lo:[0,1] neg_hi:[0,1]
v_pk_add_f32 v[18:19], v[18:19], v[50:51]
v_pk_mul_f32 v[50:51], v[48:49], s[50:51] op_sel:[0,0] op_sel_hi:[0,1] neg_lo:[0,0] neg_hi:[0,0]
v_pk_fma_f32 v[50:51], v[48:49], s[50:51], v[50:51] op_sel:[1,1,0] op_sel_hi:[1,0,1] neg_lo:[0,1,0] neg_hi:[0,0,0]
v_pk_add_f32 v[48:49], v[20:21], v[52:53] neg_lo:[0,1] neg_hi:[0,1]
v_pk_add_f32 v[20:21], v[20:21], v[52:53]
v_pk_mul_f32 v[52:53], v[48:49], s[54:55] op_sel:[0,0] op_sel_hi:[0,1] neg_lo:[0,0] neg_hi:[0,0]
v_pk_fma_f32 v[52:53], v[48:49], s[54:55], v[52:53] op_sel:[1,1,0] op_sel_hi:[1,0,1] neg_lo:[0,1,0] neg_hi:[0,0,0]
v_pk_add_f32 v[48:49], v[22:23], v[54:55] neg_lo:[0,1] neg_hi:[0,1]
v_pk_add_f32 v[22:23], v[22:23], v[54:55]
v_pk_mul_f32 v[54:55], v[48:49], s[58:59] op_sel:[0,0] op_sel_hi:[0,1] neg_lo:[0,0] neg_hi:[0,0]
v_pk_fma_f32 v[54:55], v[48:49], s[58:59], v[54:55] op_sel:[1,1,0] op_sel_hi:[1,0,1] neg_lo:[0,1,0] neg_hi:[0,0,0]
v_pk_add_f32 v[48:49], v[24:25], v[56:57] neg_lo:[0,1] neg_hi:[0,1]
v_pk_add_f32 v[24:25], v[24:25], v[56:57]
v_pk_mul_f32 v[56:57], v[48:49], s[62:63] op_sel:[0,0] op_sel_hi:[0,1] neg_lo:[0,0] neg_hi:[0,0]
v_pk_fma_f32 v[56:57], v[48:49], s[62:63], v[56:57] op_sel:[1,1,0] op_sel_hi:[1,0,1] neg_lo:[0,1,0] neg_hi:[0,0,0]
v_pk_add_f32 v[48:49], v[26:27], v[58:59] neg_lo:[0,1] neg_hi:[0,1]
v_pk_add_f32 v[26:27], v[26:27], v[58:59]
v_pk_mul_f32 v[58:59], v[48:49], s[58:59] op_sel:[0,1] op_sel_hi:[0,0] neg_lo:[0,0] neg_hi:[0,0]
v_pk_fma_f32 v[58:59], v[48:49], s[58:59], v[58:59] op_sel:[1,0,0] op_sel_hi:[1,1,1] neg_lo:[0,1,0] neg_hi:[0,0,0]
v_pk_add_f32 v[48:49], v[28:29], v[60:61] neg_lo:[0,1] neg_hi:[0,1]
v_pk_add_f32 v[28:29], v[28:29], v[60:61]
v_pk_mul_f32 v[60:61], v[48:49], s[54:55] op_sel:[0,1] op_sel_hi:[0,0] neg_lo:[0,0] neg_hi:[0,0]
v_pk_fma_f32 v[60:61], v[48:49], s[54:55], v[60:61] op_sel:[1,0,0] op_sel_hi:[1,1,1] neg_lo:[0,1,0] neg_hi:[0,0,0]
v_pk_add_f32 v[48:49], v[30:31], v[62:63] neg_lo:[0,1] neg_hi:[0,1]
v_pk_add_f32 v[30:31], v[30:31], v[62:63]
v_pk_mul_f32 v[62:63], v[48:49], s[50:51] op_sel:[0,1] op_sel_hi:[0,0] neg_lo:[0,0] neg_hi:[0,0]
v_pk_fma_f32 v[62:63], v[48:49], s[50:51], v[62:63] op_sel:[1,0,0] op_sel_hi:[1,1,1] neg_lo:[0,1,0] neg_hi:[0,0,0]
v_pk_add_f32 v[48:49], v[32:33], v[64:65] op_sel:[1,1] op_sel_hi:[0,0] neg_lo:[1,0] neg_hi:[0,1]
v_pk_add_f32 v[32:33], v[32:33], v[64:65]
v_pk_add_f32 v[64:65], v[34:35], v[66:67] neg_lo:[0,1] neg_hi:[0,1]
v_pk_add_f32 v[34:35], v[34:35], v[66:67]
v_pk_mul_f32 v[66:67], v[64:65], s[50:51] op_sel:[0,1] op_sel_hi:[0,0] neg_lo:[0,1] neg_hi:[0,0]
v_pk_fma_f32 v[66:67], v[64:65], s[50:51], v[66:67] op_sel:[1,0,0] op_sel_hi:[1,1,1] neg_lo:[0,1,0] neg_hi:[0,1,0]
v_pk_add_f32 v[64:65], v[36:37], v[68:69] neg_lo:[0,1] neg_hi:[0,1]
v_pk_add_f32 v[36:37], v[36:37], v[68:69]
v_pk_mul_f32 v[68:69], v[64:65], s[54:55] op_sel:[0,1] op_sel_hi:[0,0] neg_lo:[0,1] neg_hi:[0,0]
v_pk_fma_f32 v[68:69], v[64:65], s[54:55], v[68:69] op_sel:[1,0,0] op_sel_hi:[1,1,1] neg_lo:[0,1,0] neg_hi:[0,1,0]
v_pk_add_f32 v[64:65], v[38:39], v[70:71] neg_lo:[0,1] neg_hi:[0,1]
v_pk_add_f32 v[38:39], v[38:39], v[70:71]
v_pk_mul_f32 v[70:71], v[64:65], s[58:59] op_sel:[0,1] op_sel_hi:[0,0] neg_lo:[0,1] neg_hi:[0,0]
v_pk_fma_f32 v[70:71], v[64:65], s[58:59], v[70:71] op_sel:[1,0,0] op_sel_hi:[1,1,1] neg_lo:[0,1,0] neg_hi:[0,1,0]
v_pk_add_f32 v[64:65], v[40:41], v[72:73] neg_lo:[0,1] neg_hi:[0,1]
v_pk_add_f32 v[40:41], v[40:41], v[72:73]
v_pk_mul_f32 v[72:73], v[64:65], s[62:63] op_sel:[0,0] op_sel_hi:[0,1] neg_lo:[0,1] neg_hi:[0,0]
v_pk_fma_f32 v[72:73], v[64:65], s[62:63], v[72:73] op_sel:[1,1,0] op_sel_hi:[1,0,1] neg_lo:[0,1,0] neg_hi:[0,1,0]
v_pk_add_f32 v[64:65], v[42:43], v[74:75] neg_lo:[0,1] neg_hi:[0,1]
v_pk_add_f32 v[42:43], v[42:43], v[74:75]
v_pk_mul_f32 v[74:75], v[64:65], s[58:59] op_sel:[0,0] op_sel_hi:[0,1] neg_lo:[0,1] neg_hi:[0,0]
v_pk_fma_f32 v[74:75], v[64:65], s[58:59], v[74:75] op_sel:[1,1,0] op_sel_hi:[1,0,1] neg_lo:[0,1,0] neg_hi:[0,1,0]
v_pk_add_f32 v[64:65], v[44:45], v[76:77] neg_lo:[0,1] neg_hi:[0,1]
v_pk_add_f32 v[44:45], v[44:45], v[76:77]
v_pk_mul_f32 v[76:77], v[64:65], s[54:55] op_sel:[0,0] op_sel_hi:[0,1] neg_lo:[0,1] neg_hi:[0,0]
v_pk_fma_f32 v[76:77], v[64:65], s[54:55], v[76:77] op_sel:[1,1,0] op_sel_hi:[1,0,1] neg_lo:[0,1,0] neg_hi:[0,1,0]
v_pk_add_f32 v[64:65], v[46:47], v[78:79] neg_lo:[0,1] neg_hi:[0,1]
v_pk_add_f32 v[46:47], v[46:47], v[78:79]
v_pk_mul_f32 v[78:79], v[64:65], s[50:51] op_sel:[0,0] op_sel_hi:[0,1] neg_lo:[0,1] neg_hi:[0,0]
v_pk_fma_f32 v[78:79], v[64:65], s[50:51], v[78:79] op_sel:[1,1,0] op_sel_hi:[1,0,1] neg_lo:[0,1,0] neg_hi:[0,1,0]
v_pk_add_f32 v[64:65], v[16:17], v[32:33] neg_lo:[0,1] neg_hi:[0,1]
v_pk_add_f32 v[16:17], v[16:17], v[32:33]
v_pk_add_f32 v[32:33], v[18:19], v[34:35] neg_lo:[0,1] neg_hi:[0,1]
v_pk_add_f32 v[18:19], v[18:19], v[34:35]
v_pk_mul_f32 v[34:35], v[32:33], s[54:55] op_sel:[0,0] op_sel_hi:[0,1] neg_lo:[0,0] neg_hi:[0,0]
v_pk_fma_f32 v[34:35], v[32:33], s[54:55], v[34:35] op_sel:[1,1,0] op_sel_hi:[1,0,1] neg_lo:[0,1,0] neg_hi:[0,0,0]
v_pk_add_f32 v[32:33], v[20:21], v[36:37] neg_lo:[0,1] neg_hi:[0,1]
v_pk_add_f32 v[20:21], v[20:21], v[36:37]
v_pk_mul_f32 v[36:37], v[32:33], s[62:63] op_sel:[0,0] op_sel_hi:[0,1] neg_lo:[0,0] neg_hi:[0,0]
v_pk_fma_f32 v[36:37], v[32:33], s[62:63], v[36:37] op_sel:[1,1,0] op_sel_hi:[1,0,1] neg_lo:[0,1,0] neg_hi:[0,0,0]
v_pk_add_f32 v[32:33], v[22:23], v[38:39] neg_lo:[0,1] neg_hi:[0,1]
v_pk_add_f32 v[22:23], v[22:23], v[38:39]
v_pk_mul_f32 v[38:39], v[32:33], s[54:55] op_sel:[0,1] op_sel_hi:[0,0] neg_lo:[0,0] neg_hi:[0,0]
v_pk_fma_f32 v[38:39], v[32:33], s[54:55], v[38:39] op_sel:[1,0,0] op_sel_hi:[1,1,1] neg_lo:[0,1,0] neg_hi:[0,0,0]
v_pk_add_f32 v[32:33], v[24:25], v[40:41] op_sel:[1,1] op_sel_hi:[0,0] neg_lo:[1,0] neg_hi:[0,1]
v_pk_add_f32 v[24:25], v[24:25], v[40:41]
v_pk_add_f32 v[40:41], v[26:27], v[42:43] neg_lo:[0,1] neg_hi:[0,1]
v_pk_add_f32 v[26:27], v[26:27], v[42:43]
v_pk_mul_f32 v[42:43], v[40:41], s[54:55] op_sel:[0,1] op_sel_hi:[0,0] neg_lo:[0,1] neg_hi:[0,0]
v_pk_fma_f32 v[42:43], v[40:41], s[54:55], v[42:43] op_sel:[1,0,0] op_sel_hi:[1,1,1] neg_lo:[0,1,0] neg_hi:[0,1,0]
v_pk_add_f32 v[40:41], v[28:29], v[44:45] neg_lo:[0,1] neg_hi:[0,1]
v_pk_add_f32 v[28:29], v[28:29], v[44:45]
v_pk_mul_f32 v[44:45], v[40:41], s[62:63] op_sel:[0,0] op_sel_hi:[0,1] neg_lo:[0,1] neg_hi:[0,0]
v_pk_fma_f32 v[44:45], v[40:41], s[62:63], v[44:45] op_sel:[1,1,0] op_sel_hi:[1,0,1] neg_lo:[0,1,0] neg_hi:[0,1,0]
v_pk_add_f32 v[40:41], v[30:31], v[46:47] neg_lo:[0,1] neg_hi:[0,1]
v_pk_add_f32 v[30:31], v[30:31], v[46:47]
v_pk_mul_f32 v[46:47], v[40:41], s[54:55] op_sel:[0,0] op_sel_hi:[0,1] neg_lo:[0,1] neg_hi:[0,0]
v_pk_fma_f32 v[46:47], v[40:41], s[54:55], v[46:47] op_sel:[1,1,0] op_sel_hi:[1,0,1] neg_lo:[0,1,0] neg_hi:[0,1,0]
v_pk_add_f32 v[40:41], v[14:15], v[48:49] neg_lo:[0,1] neg_hi:[0,1]
v_pk_add_f32 v[14:15], v[14:15], v[48:49]
v_pk_add_f32 v[48:49], v[50:51], v[66:67] neg_lo:[0,1] neg_hi:[0,1]
v_pk_add_f32 v[50:51], v[50:51], v[66:67]
v_pk_mul_f32 v[66:67], v[48:49], s[54:55] op_sel:[0,0] op_sel_hi:[0,1] neg_lo:[0,0] neg_hi:[0,0]
v_pk_fma_f32 v[66:67], v[48:49], s[54:55], v[66:67] op_sel:[1,1,0] op_sel_hi:[1,0,1] neg_lo:[0,1,0] neg_hi:[0,0,0]
v_pk_add_f32 v[48:49], v[52:53], v[68:69] neg_lo:[0,1] neg_hi:[0,1]
v_pk_add_f32 v[52:53], v[52:53], v[68:69]
v_pk_mul_f32 v[68:69], v[48:49], s[62:63] op_sel:[0,0] op_sel_hi:[0,1] neg_lo:[0,0] neg_hi:[0,0]
v_pk_fma_f32 v[68:69], v[48:49], s[62:63], v[68:69] op_sel:[1,1,0] op_sel_hi:[1,0,1] neg_lo:[0,1,0] neg_hi:[0,0,0]
v_pk_add_f32 v[48:49], v[54:55], v[70:71] neg_lo:[0,1] neg_hi:[0,1]
v_pk_add_f32 v[54:55], v[54:55], v[70:71]
v_pk_mul_f32 v[70:71], v[48:49], s[54:55] op_sel:[0,1] op_sel_hi:[0,0] neg_lo:[0,0] neg_hi:[0,0]
v_pk_fma_f32 v[70:71], v[48:49], s[54:55], v[70:71] op_sel:[1,0,0] op_sel_hi:[1,1,1] neg_lo:[0,1,0] neg_hi:[0,0,0]
v_pk_add_f32 v[48:49], v[56:57], v[72:73] op_sel:[1,1] op_sel_hi:[0,0] neg_lo:[1,0] neg_hi:[0,1]
v_pk_add_f32 v[56:57], v[56:57], v[72:73]
v_pk_add_f32 v[72:73], v[58:59], v[74:75] neg_lo:[0,1] neg_hi:[0,1]
v_pk_add_f32 v[58:59], v[58:59], v[74:75]
v_pk_mul_f32 v[74:75], v[72:73], s[54:55] op_sel:[0,1] op_sel_hi:[0,0] neg_lo:[0,1] neg_hi:[0,0]
v_pk_fma_f32 v[74:75], v[72:73], s[54:55], v[74:75] op_sel:[1,0,0] op_sel_hi:[1,1,1] neg_lo:[0,1,0] neg_hi:[0,1,0]
v_pk_add_f32 v[72:73], v[60:61], v[76:77] neg_lo:[0,1] neg_hi:[0,1]
v_pk_add_f32 v[60:61], v[60:61], v[76:77]
v_pk_mul_f32 v[76:77], v[72:73], s[62:63] op_sel:[0,0] op_sel_hi:[0,1] neg_lo:[0,1] neg_hi:[0,0]
v_pk_fma_f32 v[76:77], v[72:73], s[62:63], v[76:77] op_sel:[1,1,0] op_sel_hi:[1,0,1] neg_lo:[0,1,0] neg_hi:[0,1,0]
v_pk_add_f32 v[72:73], v[62:63], v[78:79] neg_lo:[0,1] neg_hi:[0,1]
v_pk_add_f32 v[62:63], v[62:63], v[78:79]
v_pk_mul_f32 v[78:79], v[72:73], s[54:55] op_sel:[0,0] op_sel_hi:[0,1] neg_lo:[0,1] neg_hi:[0,0]
v_pk_fma_f32 v[78:79], v[72:73], s[54:55], v[78:79] op_sel:[1,1,0] op_sel_hi:[1,0,1] neg_lo:[0,1,0] neg_hi:[0,1,0]
v_pk_add_f32 v[72:73], v[16:17], v[24:25] neg_lo:[0,1] neg_hi:[0,1]
v_pk_add_f32 v[16:17], v[16:17], v[24:25]
v_pk_add_f32 v[24:25], v[18:19], v[26:27] neg_lo:[0,1] neg_hi:[0,1]
v_pk_add_f32 v[18:19], v[18:19], v[26:27]
v_pk_mul_f32 v[26:27], v[24:25], s[62:63] op_sel:[0,0] op_sel_hi:[0,1] neg_lo:[0,0] neg_hi:[0,0]
v_pk_fma_f32 v[26:27], v[24:25], s[62:63], v[26:27] op_sel:[1,1,0] op_sel_hi:[1,0,1] neg_lo:[0,1,0] neg_hi:[0,0,0]
v_pk_add_f32 v[24:25], v[20:21], v[28:29] op_sel:[1,1] op_sel_hi:[0,0] neg_lo:[1,0] neg_hi:[0,1]
v_pk_add_f32 v[20:21], v[20:21], v[28:29]
v_pk_add_f32 v[28:29], v[22:23], v[30:31] neg_lo:[0,1] neg_hi:[0,1]
v_pk_add_f32 v[22:23], v[22:23], v[30:31]
v_pk_mul_f32 v[30:31], v[28:29], s[62:63] op_sel:[0,0] op_sel_hi:[0,1] neg_lo:[0,1] neg_hi:[0,0]
v_pk_fma_f32 v[30:31], v[28:29], s[62:63], v[30:31] op_sel:[1,1,0] op_sel_hi:[1,0,1] neg_lo:[0,1,0] neg_hi:[0,1,0]
v_pk_add_f32 v[28:29], v[64:65], v[32:33] neg_lo:[0,1] neg_hi:[0,1]
v_pk_add_f32 v[64:65], v[64:65], v[32:33]
v_pk_add_f32 v[32:33], v[34:35], v[42:43] neg_lo:[0,1] neg_hi:[0,1]
v_pk_add_f32 v[34:35], v[34:35], v[42:43]
v_pk_mul_f32 v[42:43], v[32:33], s[62:63] op_sel:[0,0] op_sel_hi:[0,1] neg_lo:[0,0] neg_hi:[0,0]
v_pk_fma_f32 v[42:43], v[32:33], s[62:63], v[42:43] op_sel:[1,1,0] op_sel_hi:[1,0,1] neg_lo:[0,1,0] neg_hi:[0,0,0]
v_pk_add_f32 v[32:33], v[36:37], v[44:45] op_sel:[1,1] op_sel_hi:[0,0] neg_lo:[1,0] neg_hi:[0,1]
v_pk_add_f32 v[36:37], v[36:37], v[44:45]
v_pk_add_f32 v[44:45], v[38:39], v[46:47] neg_lo:[0,1] neg_hi:[0,1]
v_pk_add_f32 v[38:39], v[38:39], v[46:47]
v_pk_mul_f32 v[46:47], v[44:45], s[62:63] op_sel:[0,0] op_sel_hi:[0,1] neg_lo:[0,1] neg_hi:[0,0]
v_pk_fma_f32 v[46:47], v[44:45], s[62:63], v[46:47] op_sel:[1,1,0] op_sel_hi:[1,0,1] neg_lo:[0,1,0] neg_hi:[0,1,0]
v_pk_add_f32 v[44:45], v[14:15], v[56:57] neg_lo:[0,1] neg_hi:[0,1]
v_pk_add_f32 v[14:15], v[14:15], v[56:57]
v_pk_add_f32 v[56:57], v[50:51], v[58:59] neg_lo:[0,1] neg_hi:[0,1]
v_pk_add_f32 v[50:51], v[50:51], v[58:59]
v_pk_mul_f32 v[58:59], v[56:57], s[62:63] op_sel:[0,0] op_sel_hi:[0,1] neg_lo:[0,0] neg_hi:[0,0]
v_pk_fma_f32 v[58:59], v[56:57], s[62:63], v[58:59] op_sel:[1,1,0] op_sel_hi:[1,0,1] neg_lo:[0,1,0] neg_hi:[0,0,0]
v_pk_add_f32 v[56:57], v[52:53], v[60:61] op_sel:[1,1] op_sel_hi:[0,0] neg_lo:[1,0] neg_hi:[0,1]
v_pk_add_f32 v[52:53], v[52:53], v[60:61]
v_pk_add_f32 v[60:61], v[54:55], v[62:63] neg_lo:[0,1] neg_hi:[0,1]
v_pk_add_f32 v[54:55], v[54:55], v[62:63]
v_pk_mul_f32 v[62:63], v[60:61], s[62:63] op_sel:[0,0] op_sel_hi:[0,1] neg_lo:[0,1] neg_hi:[0,0]
v_pk_fma_f32 v[62:63], v[60:61], s[62:63], v[62:63] op_sel:[1,1,0] op_sel_hi:[1,0,1] neg_lo:[0,1,0] neg_hi:[0,1,0]
v_pk_add_f32 v[60:61], v[40:41], v[48:49] neg_lo:[0,1] neg_hi:[0,1]
v_pk_add_f32 v[40:41], v[40:41], v[48:49]
v_pk_add_f32 v[48:49], v[66:67], v[74:75] neg_lo:[0,1] neg_hi:[0,1]
v_pk_add_f32 v[66:67], v[66:67], v[74:75]
v_pk_mul_f32 v[74:75], v[48:49], s[62:63] op_sel:[0,0] op_sel_hi:[0,1] neg_lo:[0,0] neg_hi:[0,0]
v_pk_fma_f32 v[74:75], v[48:49], s[62:63], v[74:75] op_sel:[1,1,0] op_sel_hi:[1,0,1] neg_lo:[0,1,0] neg_hi:[0,0,0]
v_pk_add_f32 v[48:49], v[68:69], v[76:77] op_sel:[1,1] op_sel_hi:[0,0] neg_lo:[1,0] neg_hi:[0,1]
v_pk_add_f32 v[68:69], v[68:69], v[76:77]
v_pk_add_f32 v[76:77], v[70:71], v[78:79] neg_lo:[0,1] neg_hi:[0,1]
v_pk_add_f32 v[70:71], v[70:71], v[78:79]
v_pk_mul_f32 v[78:79], v[76:77], s[62:63] op_sel:[0,0] op_sel_hi:[0,1] neg_lo:[0,1] neg_hi:[0,0]
v_pk_fma_f32 v[78:79], v[76:77], s[62:63], v[78:79] op_sel:[1,1,0] op_sel_hi:[1,0,1] neg_lo:[0,1,0] neg_hi:[0,1,0]
v_pk_add_f32 v[76:77], v[16:17], v[20:21] neg_lo:[0,1] neg_hi:[0,1]
v_pk_add_f32 v[16:17], v[16:17], v[20:21]
v_pk_add_f32 v[20:21], v[18:19], v[22:23] op_sel:[1,1] op_sel_hi:[0,0] neg_lo:[1,0] neg_hi:[0,1]
v_pk_add_f32 v[18:19], v[18:19], v[22:23]
v_pk_add_f32 v[22:23], v[72:73], v[24:25] neg_lo:[0,1] neg_hi:[0,1]
v_pk_add_f32 v[72:73], v[72:73], v[24:25]
v_pk_add_f32 v[24:25], v[26:27], v[30:31] op_sel:[1,1] op_sel_hi:[0,0] neg_lo:[1,0] neg_hi:[0,1]
v_pk_add_f32 v[26:27], v[26:27], v[30:31]
v_pk_add_f32 v[30:31], v[64:65], v[36:37] neg_lo:[0,1] neg_hi:[0,1]
v_pk_add_f32 v[64:65], v[64:65], v[36:37]
v_pk_add_f32 v[36:37], v[34:35], v[38:39] op_sel:[1,1] op_sel_hi:[0,0] neg_lo:[1,0] neg_hi:[0,1]
v_pk_add_f32 v[34:35], v[34:35], v[38:39]
v_pk_add_f32 v[38:39], v[28:29], v[32:33] neg_lo:[0,1] neg_hi:[0,1]
v_pk_add_f32 v[28:29], v[28:29], v[32:33]
v_pk_add_f32 v[32:33], v[42:43], v[46:47] op_sel:[1,1] op_sel_hi:[0,0] neg_lo:[1,0] neg_hi:[0,1]
v_pk_add_f32 v[42:43], v[42:43], v[46:47]
v_pk_add_f32 v[46:47], v[14:15], v[52:53] neg_lo:[0,1] neg_hi:[0,1]
v_pk_add_f32 v[14:15], v[14:15], v[52:53]
v_pk_add_f32 v[52:53], v[50:51], v[54:55] op_sel:[1,1] op_sel_hi:[0,0] neg_lo:[1,0] neg_hi:[0,1]
v_pk_add_f32 v[50:51], v[50:51], v[54:55]
v_pk_add_f32 v[54:55], v[44:45], v[56:57] neg_lo:[0,1] neg_hi:[0,1]
v_pk_add_f32 v[44:45], v[44:45], v[56:57]
v_pk_add_f32 v[56:57], v[58:59], v[62:63] op_sel:[1,1] op_sel_hi:[0,0] neg_lo:[1,0] neg_hi:[0,1]
v_pk_add_f32 v[58:59], v[58:59], v[62:63]
v_pk_add_f32 v[62:63], v[40:41], v[68:69] neg_lo:[0,1] neg_hi:[0,1]
v_pk_add_f32 v[40:41], v[40:41], v[68:69]
v_pk_add_f32 v[68:69], v[66:67], v[70:71] op_sel:[1,1] op_sel_hi:[0,0] neg_lo:[1,0] neg_hi:[0,1]
v_pk_add_f32 v[66:67], v[66:67], v[70:71]
v_pk_add_f32 v[70:71], v[60:61], v[48:49] neg_lo:[0,1] neg_hi:[0,1]
v_pk_add_f32 v[60:61], v[60:61], v[48:49]
v_pk_add_f32 v[48:49], v[74:75], v[78:79] op_sel:[1,1] op_sel_hi:[0,0] neg_lo:[1,0] neg_hi:[0,1]
v_pk_add_f32 v[74:75], v[74:75], v[78:79]
v_pk_add_f32 v[78:79], v[16:17], v[18:19] neg_lo:[0,1] neg_hi:[0,1]
v_pk_add_f32 v[16:17], v[16:17], v[18:19]
v_pk_add_f32 v[18:19], v[76:77], v[20:21] neg_lo:[0,1] neg_hi:[0,1]
v_pk_add_f32 v[76:77], v[76:77], v[20:21]
v_pk_add_f32 v[20:21], v[72:73], v[26:27] neg_lo:[0,1] neg_hi:[0,1]
v_pk_add_f32 v[72:73], v[72:73], v[26:27]
v_pk_add_f32 v[26:27], v[22:23], v[24:25] neg_lo:[0,1] neg_hi:[0,1]
v_pk_add_f32 v[22:23], v[22:23], v[24:25]
v_pk_add_f32 v[24:25], v[64:65], v[34:35] neg_lo:[0,1] neg_hi:[0,1]
v_pk_add_f32 v[64:65], v[64:65], v[34:35]
v_pk_add_f32 v[34:35], v[30:31], v[36:37] neg_lo:[0,1] neg_hi:[0,1]
v_pk_add_f32 v[30:31], v[30:31], v[36:37]
v_pk_add_f32 v[36:37], v[28:29], v[42:43] neg_lo:[0,1] neg_hi:[0,1]
v_pk_add_f32 v[28:29], v[28:29], v[42:43]
v_pk_add_f32 v[42:43], v[38:39], v[32:33] neg_lo:[0,1] neg_hi:[0,1]
v_pk_add_f32 v[38:39], v[38:39], v[32:33]
v_pk_add_f32 v[32:33], v[14:15], v[50:51] neg_lo:[0,1] neg_hi:[0,1]
v_pk_add_f32 v[14:15], v[14:15], v[50:51]
v_pk_add_f32 v[50:51], v[46:47], v[52:53] neg_lo:[0,1] neg_hi:[0,1]
v_pk_add_f32 v[46:47], v[46:47], v[52:53]
v_pk_add_f32 v[52:53], v[44:45], v[58:59] neg_lo:[0,1] neg_hi:[0,1]
v_pk_add_f32 v[44:45], v[44:45], v[58:59]
v_pk_add_f32 v[58:59], v[54:55], v[56:57] neg_lo:[0,1] neg_hi:[0,1]
v_pk_add_f32 v[54:55], v[54:55], v[56:57]
v_pk_add_f32 v[56:57], v[40:41], v[66:67] neg_lo:[0,1] neg_hi:[0,1]
v_pk_add_f32 v[40:41], v[40:41], v[66:67]
v_pk_add_f32 v[66:67], v[62:63], v[68:69] neg_lo:[0,1] neg_hi:[0,1]
v_pk_add_f32 v[62:63], v[62:63], v[68:69]
v_pk_add_f32 v[68:69], v[60:61], v[74:75] neg_lo:[0,1] neg_hi:[0,1]
v_pk_add_f32 v[60:61], v[60:61], v[74:75]
v_pk_add_f32 v[74:75], v[70:71], v[48:49] neg_lo:[0,1] neg_hi:[0,1]
v_pk_add_f32 v[70:71], v[70:71], v[48:49]
s_lshl_b32 s12, s38, 2
s_add_u32 s12, s12, s16
s_min_u32 s12, s12, 512
s_mul_i32 s12, s12, 16384
s_add_u32 s12, s12, 109051904
buffer_store_dwordx2 v[16:17], v5, s[84:87], s12 offen offset:0 sc1
buffer_store_dwordx2 v[14:15], v5, s[84:87], s12 offen offset:512 sc1
buffer_store_dwordx2 v[64:65], v5, s[84:87], s12 offen offset:1024 sc1
buffer_store_dwordx2 v[40:41], v5, s[84:87], s12 offen offset:1536 sc1
buffer_store_dwordx2 v[72:73], v5, s[84:87], s12 offen offset:2048 sc1
buffer_store_dwordx2 v[44:45], v5, s[84:87], s12 offen offset:2560 sc1
buffer_store_dwordx2 v[28:29], v5, s[84:87], s12 offen offset:3072 sc1
buffer_store_dwordx2 v[60:61], v5, s[84:87], s12 offen offset:3584 sc1
s_add_u32 s12, s12, 4096
buffer_store_dwordx2 v[76:77], v5, s[84:87], s12 offen offset:0 sc1
buffer_store_dwordx2 v[46:47], v5, s[84:87], s12 offen offset:512 sc1
buffer_store_dwordx2 v[30:31], v5, s[84:87], s12 offen offset:1024 sc1
buffer_store_dwordx2 v[62:63], v5, s[84:87], s12 offen offset:1536 sc1
buffer_store_dwordx2 v[22:23], v5, s[84:87], s12 offen offset:2048 sc1
buffer_store_dwordx2 v[54:55], v5, s[84:87], s12 offen offset:2560 sc1
buffer_store_dwordx2 v[38:39], v5, s[84:87], s12 offen offset:3072 sc1
buffer_store_dwordx2 v[70:71], v5, s[84:87], s12 offen offset:3584 sc1
s_add_u32 s12, s12, 4096
buffer_store_dwordx2 v[78:79], v5, s[84:87], s12 offen offset:0 sc1
buffer_store_dwordx2 v[32:33], v5, s[84:87], s12 offen offset:512 sc1
buffer_store_dwordx2 v[24:25], v5, s[84:87], s12 offen offset:1024 sc1
buffer_store_dwordx2 v[56:57], v5, s[84:87], s12 offen offset:1536 sc1
buffer_store_dwordx2 v[20:21], v5, s[84:87], s12 offen offset:2048 sc1
buffer_store_dwordx2 v[52:53], v5, s[84:87], s12 offen offset:2560 sc1
buffer_store_dwordx2 v[36:37], v5, s[84:87], s12 offen offset:3072 sc1
buffer_store_dwordx2 v[68:69], v5, s[84:87], s12 offen offset:3584 sc1
s_add_u32 s12, s12, 4096
buffer_store_dwordx2 v[18:19], v5, s[84:87], s12 offen offset:0 sc1
buffer_store_dwordx2 v[50:51], v5, s[84:87], s12 offen offset:512 sc1
buffer_store_dwordx2 v[34:35], v5, s[84:87], s12 offen offset:1024 sc1
buffer_store_dwordx2 v[66:67], v5, s[84:87], s12 offen offset:1536 sc1
buffer_store_dwordx2 v[26:27], v5, s[84:87], s12 offen offset:2048 sc1
buffer_store_dwordx2 v[58:59], v5, s[84:87], s12 offen offset:2560 sc1
buffer_store_dwordx2 v[42:43], v5, s[84:87], s12 offen offset:3072 sc1
buffer_store_dwordx2 v[74:75], v5, s[84:87], s12 offen offset:3584 sc1
s_add_u32 s12, s12, 4096
s_mov_b32 s38, s21
s_cmp_lt_u32 s38, s37
s_cbranch_scc1 mega_kernel_f2_l
mega_kernel_f2_e:
mega_kernel_f2e:
s_waitcnt vmcnt(0)
s_barrier
v_mov_b32 v1, 0
v_mov_b32 v2, 1
s_mov_b32 s82, 69259392
v_cmp_eq_u32 vcc, 0, v0
s_and_saveexec_b64 s[80:81], vcc
s_cbranch_execz mega_kernel_sg1
buffer_atomic_add v2, v1, s[84:87], s82 offen sc1
mega_kernel_sg1:
s_mov_b64 exec, s[80:81]
s_mov_b32 s64, 0
s_mov_b32 s65, 62
s_lshl_b32 s66, s40, 13
s_add_u32 s66, s66, 67633152
s_mov_b32 s67, 0
s_mov_b32 s68, 8192
s_mov_b32 s69, 1
s_cmp_eq_u32 s91, 3
s_cbranch_scc1 mega_kernel_out
v_mov_b32 v1, 0
s_mov_b32 s82, 69259392
mega_kernel_w1:
s_sleep 8
buffer_load_dword v2, v1, s[84:87], s82 offen sc1
s_waitcnt vmcnt(0)
v_cmp_ne_u32 vcc, 95, v2
s_cbranch_vccnz mega_kernel_w1
s_mov_b32 s93, s92
s_load_dwordx2 s[4:5], s[0:1], 80
s_mov_b32 s48, 0x3f7ec46d
s_mov_b32 s49, 0x3dc8bd36
s_mov_b32 s50, 0x3f7b14be
s_mov_b32 s51, 0x3e47c5c2
s_mov_b32 s52, 0x3f74fa0b
s_mov_b32 s53, 0x3e94a031
s_mov_b32 s54, 0x3f6c835e
s_mov_b32 s55, 0x3ec3ef15
s_mov_b32 s56, 0x3f61c598
s_mov_b32 s57, 0x3ef15aea
s_mov_b32 s58, 0x3f54db31
s_mov_b32 s59, 0x3f0e39da
s_mov_b32 s60, 0x3f45e403
s_mov_b32 s61, 0x3f226799
s_mov_b32 s62, 0x3f3504f3
s_mov_b32 s63, 0x3f3504f3
v_and_b32 v1, 31, v0
v_lshrrev_b32 v2, 5, v0
v_cvt_f32_u32 v3, v1
v_mul_u32_u24 v10, 8448, v2
v_lshl_add_u32 v4, v1, 3, v10
v_mul_u32_u24 v5, 264, v1
v_add_u32 v5, v5, v10
v_and_b32 v11, 7, v0
v_lshrrev_b32 v9, 3, v0
v_mul_u32_u24 v10, 8448, v11
v_lshl_add_u32 v6, v9, 3, v10
v_lshlrev_b32 v7, 3, v9
v_sub_u32 v7, v10, v7
v_add_u32 v7, 4096, v7
v_mul_u32_u24 v8, 16384, v9
v_lshl_add_u32 v8, v11, 4, v8
v_mul_f32 v12, 0x3a800000, v3
v_cos_f32 v82, v12
v_sin_f32 v83, v12
v_mul_f32 v12, 0x3b000000, v3
v_cos_f32 v84, v12
v_sin_f32 v85, v12
v_mul_f32 v12, 0x3b400000, v3
v_cos_f32 v86, v12
v_sin_f32 v87, v12
v_mul_f32 v12, 0x3b800000, v3
v_cos_f32 v88, v12
v_sin_f32 v89, v12
v_mul_f32 v12, 0x3ba00000, v3
v_cos_f32 v90, v12
v_sin_f32 v91, v12
v_mul_f32 v12, 0x3bc00000, v3
v_cos_f32 v92, v12
v_sin_f32 v93, v12
v_mul_f32 v12, 0x3be00000, v3
v_cos_f32 v94, v12
v_sin_f32 v95, v12
v_mul_f32 v12, 0x3c000000, v3
v_cos_f32 v96, v12
v_sin_f32 v97, v12
v_mul_f32 v12, 0x3c100000, v3
v_cos_f32 v98, v12
v_sin_f32 v99, v12
v_mul_f32 v12, 0x3c200000, v3
v_cos_f32 v100, v12
v_sin_f32 v101, v12
v_mul_f32 v12, 0x3c300000, v3
v_cos_f32 v102, v12
v_sin_f32 v103, v12
v_mul_f32 v12, 0x3c400000, v3
v_cos_f32 v104, v12
v_sin_f32 v105, v12
v_mul_f32 v12, 0x3c500000, v3
v_cos_f32 v106, v12
v_sin_f32 v107, v12
v_mul_f32 v12, 0x3c600000, v3
v_cos_f32 v108, v12
v_sin_f32 v109, v12
v_mul_f32 v12, 0x3c700000, v3
v_cos_f32 v110, v12
v_sin_f32 v111, v12
v_mul_f32 v12, 0x3c800000, v3
v_cos_f32 v112, v12
v_sin_f32 v113, v12
v_mul_f32 v12, 0x3c880000, v3
v_cos_f32 v114, v12
v_sin_f32 v115, v12
v_mul_f32 v12, 0x3c900000, v3
v_cos_f32 v116, v12
v_sin_f32 v117, v12
v_mul_f32 v12, 0x3c980000, v3
v_cos_f32 v118, v12
v_sin_f32 v119, v12
v_mul_f32 v12, 0x3ca00000, v3
v_cos_f32 v120, v12
v_sin_f32 v121, v12
v_mul_f32 v12, 0x3ca80000, v3
v_cos_f32 v122, v12
v_sin_f32 v123, v12
v_mul_f32 v12, 0x3cb00000, v3
v_cos_f32 v124, v12
v_sin_f32 v125, v12
v_mul_f32 v12, 0x3cb80000, v3
v_cos_f32 v126, v12
v_sin_f32 v127, v12
v_mul_f32 v12, 0x3cc00000, v3
v_cos_f32 v128, v12
v_sin_f32 v129, v12
v_mul_f32 v12, 0x3cc80000, v3
v_cos_f32 v130, v12
v_sin_f32 v131, v12
v_mul_f32 v12, 0x3cd00000, v3
v_cos_f32 v132, v12
v_sin_f32 v133, v12
v_mul_f32 v12, 0x3cd80000, v3
v_cos_f32 v134, v12
v_sin_f32 v135, v12
v_mul_f32 v12, 0x3ce00000, v3
v_cos_f32 v136, v12
v_sin_f32 v137, v12
v_mul_f32 v12, 0x3ce80000, v3
v_cos_f32 v138, v12
v_sin_f32 v139, v12
v_mul_f32 v12, 0x3cf00000, v3
v_cos_f32 v140, v12
v_sin_f32 v141, v12
v_mul_f32 v12, 0x3cf80000, v3
v_cos_f32 v142, v12
v_sin_f32 v143, v12
v_lshlrev_b32 v12, 2, v1
v_sub_u32 v12, v4, v12
v_and_b32 v10, 127, v0
v_lshrrev_b32 v11, 7, v0
v_lshlrev_b32 v2, 5, v10
v_lshl_add_u32 v2, v11, 12, v2
v_lshlrev_b32 v3, 4, v10
v_lshl_add_u32 v3, v11, 12, v3
v_add_u32 v3, 2048, v3
v_cmp_eq_u32 s[14:15], 0, v9
s_waitcnt lgkmcnt(0)
s_mov_b32 s6, 8388608
s_mov_b32 s7, 0x00020000
s_cmp_lt_u32 s93, 128
s_cbranch_scc0 mega_kernel_f3_e
s_lshl_b32 s12, s93, 7
s_add_u32 s12, s12, 109051904
buffer_load_dwordx4 v[144:147], v8, s[84:87], s12 offen sc1
s_add_u32 s12, s12, 524288
buffer_load_dwordx4 v[148:151], v8, s[84:87], s12 offen sc1
s_add_u32 s12, s12, 524288
buffer_load_dwordx4 v[152:155], v8, s[84:87], s12 offen sc1
s_add_u32 s12, s12, 524288
buffer_load_dwordx4 v[156:159], v8, s[84:87], s12 offen sc1
s_add_u32 s12, s12, 524288
buffer_load_dwordx4 v[160:163], v8, s[84:87], s12 offen sc1
s_add_u32 s12, s12, 524288
buffer_load_dwordx4 v[164:167], v8, s[84:87], s12 offen sc1
s_add_u32 s12, s12, 524288
buffer_load_dwordx4 v[168:171], v8, s[84:87], s12 offen sc1
s_add_u32 s12, s12, 524288
buffer_load_dwordx4 v[172:175], v8, s[84:87], s12 offen sc1
s_add_u32 s12, s12, 524288
buffer_load_dwordx4 v[176:179], v8, s[84:87], s12 offen sc1
s_add_u32 s12, s12, 524288
buffer_load_dwordx4 v[180:183], v8, s[84:87], s12 offen sc1
s_add_u32 s12, s12, 524288
buffer_load_dwordx4 v[184:187], v8, s[84:87], s12 offen sc1
s_add_u32 s12, s12, 524288
buffer_load_dwordx4 v[188:191], v8, s[84:87], s12 offen sc1
s_add_u32 s12, s12, 524288
buffer_load_dwordx4 v[192:195], v8, s[84:87], s12 offen sc1
s_add_u32 s12, s12, 524288
buffer_load_dwordx4 v[196:199], v8, s[84:87], s12 offen sc1
s_add_u32 s12, s12, 524288
buffer_load_dwordx4 v[200:203], v8, s[84:87], s12 offen sc1
s_add_u32 s12, s12, 524288
buffer_load_dwordx4 v[204:207], v8, s[84:87], s12 offen sc1
s_add_u32 s12, s12, 524288
buffer_load_dwordx4 v[208:211], v8, s[84:87], s12 offen sc1
s_add_u32 s12, s12, 524288
s_waitcnt vmcnt(0)
mega_kernel_f3_l:
s_add_u32 s21, s93, 64
s_cmp_lt_u32 s21, 128
s_cselect_b32 s22, s21, s93
s_waitcnt vmcnt(8)
s_barrier
v_cndmask_b32 v145, v145, 0, s[14:15]
v_cndmask_b32 v147, v147, 0, s[14:15]
v_cndmask_b32 v209, v209, 0, s[14:15]
v_cndmask_b32 v211, v211, 0, s[14:15]
v_pk_add_f32 v[16:17], v[144:145], v[146:147] op_sel:[0,1] op_sel_hi:[1,0] neg_lo:[0,1]
v_pk_add_f32 v[18:19], v[144:145], v[146:147] op_sel:[0,1] op_sel_hi:[1,0] neg_hi:[1,0]
ds_write_b64 v6, v[16:17] offset:0
ds_write_b64 v7, v[18:19] offset:4096
v_pk_add_f32 v[20:21], v[148:149], v[150:151] op_sel:[0,1] op_sel_hi:[1,0] neg_lo:[0,1]
v_pk_add_f32 v[22:23], v[148:149], v[150:151] op_sel:[0,1] op_sel_hi:[1,0] neg_hi:[1,0]
ds_write_b64 v6, v[20:21] offset:256
ds_write_b64 v7, v[22:23] offset:3840
v_pk_add_f32 v[24:25], v[152:153], v[154:155] op_sel:[0,1] op_sel_hi:[1,0] neg_lo:[0,1]
v_pk_add_f32 v[26:27], v[152:153], v[154:155] op_sel:[0,1] op_sel_hi:[1,0] neg_hi:[1,0]
ds_write_b64 v6, v[24:25] offset:512
ds_write_b64 v7, v[26:27] offset:3584
v_pk_add_f32 v[28:29], v[156:157], v[158:159] op_sel:[0,1] op_sel_hi:[1,0] neg_lo:[0,1]
v_pk_add_f32 v[30:31], v[156:157], v[158:159] op_sel:[0,1] op_sel_hi:[1,0] neg_hi:[1,0]
ds_write_b64 v6, v[28:29] offset:768
ds_write_b64 v7, v[30:31] offset:3328
v_pk_add_f32 v[32:33], v[160:161], v[162:163] op_sel:[0,1] op_sel_hi:[1,0] neg_lo:[0,1]
v_pk_add_f32 v[34:35], v[160:161], v[162:163] op_sel:[0,1] op_sel_hi:[1,0] neg_hi:[1,0]
ds_write_b64 v6, v[32:33] offset:1024
ds_write_b64 v7, v[34:35] offset:3072
v_pk_add_f32 v[36:37], v[164:165], v[166:167] op_sel:[0,1] op_sel_hi:[1,0] neg_lo:[0,1]
v_pk_add_f32 v[38:39], v[164:165], v[166:167] op_sel:[0,1] op_sel_hi:[1,0] neg_hi:[1,0]
ds_write_b64 v6, v[36:37] offset:1280
ds_write_b64 v7, v[38:39] offset:2816
v_pk_add_f32 v[40:41], v[168:169], v[170:171] op_sel:[0,1] op_sel_hi:[1,0] neg_lo:[0,1]
v_pk_add_f32 v[42:43], v[168:169], v[170:171] op_sel:[0,1] op_sel_hi:[1,0] neg_hi:[1,0]
ds_write_b64 v6, v[40:41] offset:1536
ds_write_b64 v7, v[42:43] offset:2560
v_pk_add_f32 v[44:45], v[172:173], v[174:175] op_sel:[0,1] op_sel_hi:[1,0] neg_lo:[0,1]
v_pk_add_f32 v[46:47], v[172:173], v[174:175] op_sel:[0,1] op_sel_hi:[1,0] neg_hi:[1,0]
ds_write_b64 v6, v[44:45] offset:1792
ds_write_b64 v7, v[46:47] offset:2304
v_pk_add_f32 v[48:49], v[176:177], v[178:179] op_sel:[0,1] op_sel_hi:[1,0] neg_lo:[0,1]
v_pk_add_f32 v[50:51], v[176:177], v[178:179] op_sel:[0,1] op_sel_hi:[1,0] neg_hi:[1,0]
ds_write_b64 v6, v[48:49] offset:2048
ds_write_b64 v7, v[50:51] offset:2048
v_pk_add_f32 v[52:53], v[180:181], v[182:183] op_sel:[0,1] op_sel_hi:[1,0] neg_lo:[0,1]
v_pk_add_f32 v[54:55], v[180:181], v[182:183] op_sel:[0,1] op_sel_hi:[1,0] neg_hi:[1,0]
ds_write_b64 v6, v[52:53] offset:2304
ds_write_b64 v7, v[54:55] offset:1792
v_pk_add_f32 v[56:57], v[184:185], v[186:187] op_sel:[0,1] op_sel_hi:[1,0] neg_lo:[0,1]
v_pk_add_f32 v[58:59], v[184:185], v[186:187] op_sel:[0,1] op_sel_hi:[1,0] neg_hi:[1,0]
ds_write_b64 v6, v[56:57] offset:2560
ds_write_b64 v7, v[58:59] offset:1536
v_pk_add_f32 v[60:61], v[188:189], v[190:191] op_sel:[0,1] op_sel_hi:[1,0] neg_lo:[0,1]
v_pk_add_f32 v[62:63], v[188:189], v[190:191] op_sel:[0,1] op_sel_hi:[1,0] neg_hi:[1,0]
ds_write_b64 v6, v[60:61] offset:2816
ds_write_b64 v7, v[62:63] offset:1280
v_pk_add_f32 v[64:65], v[192:193], v[194:195] op_sel:[0,1] op_sel_hi:[1,0] neg_lo:[0,1]
v_pk_add_f32 v[66:67], v[192:193], v[194:195] op_sel:[0,1] op_sel_hi:[1,0] neg_hi:[1,0]
ds_write_b64 v6, v[64:65] offset:3072
ds_write_b64 v7, v[66:67] offset:1024
v_pk_add_f32 v[68:69], v[196:197], v[198:199] op_sel:[0,1] op_sel_hi:[1,0] neg_lo:[0,1]
v_pk_add_f32 v[70:71], v[196:197], v[198:199] op_sel:[0,1] op_sel_hi:[1,0] neg_hi:[1,0]
ds_write_b64 v6, v[68:69] offset:3328
ds_write_b64 v7, v[70:71] offset:768
v_pk_add_f32 v[72:73], v[200:201], v[202:203] op_sel:[0,1] op_sel_hi:[1,0] neg_lo:[0,1]
v_pk_add_f32 v[74:75], v[200:201], v[202:203] op_sel:[0,1] op_sel_hi:[1,0] neg_hi:[1,0]
ds_write_b64 v6, v[72:73] offset:3584
ds_write_b64 v7, v[74:75] offset:512
s_waitcnt lgkmcnt(8)
v_pk_add_f32 v[76:77], v[204:205], v[206:207] op_sel:[0,1] op_sel_hi:[1,0] neg_lo:[0,1]
v_pk_add_f32 v[78:79], v[204:205], v[206:207] op_sel:[0,1] op_sel_hi:[1,0] neg_hi:[1,0]
ds_write_b64 v6, v[76:77] offset:3840
ds_write_b64 v7, v[78:79] offset:256
v_pk_add_f32 v[16:17], v[208:209], v[210:211] op_sel:[0,1] op_sel_hi:[1,0] neg_lo:[0,1]
v_pk_add_f32 v[18:19], v[208:209], v[210:211] op_sel:[0,1] op_sel_hi:[1,0] neg_hi:[1,0]
s_mov_b64 exec, s[14:15]
ds_write_b64 v6, v[16:17] offset:4096
s_mov_b64 exec, -1
s_lshl_b32 s12, s22, 7
s_add_u32 s12, s12, 109051904
buffer_load_dwordx4 v[144:147], v8, s[84:87], s12 offen sc1
s_add_u32 s12, s12, 524288
buffer_load_dwordx4 v[148:151], v8, s[84:87], s12 offen sc1
s_add_u32 s12, s12, 524288
buffer_load_dwordx4 v[152:155], v8, s[84:87], s12 offen sc1
s_add_u32 s12, s12, 524288
buffer_load_dwordx4 v[156:159], v8, s[84:87], s12 offen sc1
s_add_u32 s12, s12, 524288
buffer_load_dwordx4 v[160:163], v8, s[84:87], s12 offen sc1
s_add_u32 s12, s12, 524288
buffer_load_dwordx4 v[164:167], v8, s[84:87], s12 offen sc1
s_add_u32 s12, s12, 524288
buffer_load_dwordx4 v[168:171], v8, s[84:87], s12 offen sc1
s_add_u32 s12, s12, 524288
buffer_load_dwordx4 v[172:175], v8, s[84:87], s12 offen sc1
s_add_u32 s12, s12, 524288
buffer_load_dwordx4 v[176:179], v8, s[84:87], s12 offen sc1
s_add_u32 s12, s12, 524288
buffer_load_dwordx4 v[180:183], v8, s[84:87], s12 offen sc1
s_add_u32 s12, s12, 524288
buffer_load_dwordx4 v[184:187], v8, s[84:87], s12 offen sc1
s_add_u32 s12, s12, 524288
buffer_load_dwordx4 v[188:191], v8, s[84:87], s12 offen sc1
s_add_u32 s12, s12, 524288
buffer_load_dwordx4 v[192:195], v8, s[84:87], s12 offen sc1
s_add_u32 s12, s12, 524288
buffer_load_dwordx4 v[196:199], v8, s[84:87], s12 offen sc1
s_add_u32 s12, s12, 524288
buffer_load_dwordx4 v[200:203], v8, s[84:87], s12 offen sc1
s_add_u32 s12, s12, 524288
buffer_load_dwordx4 v[204:207], v8, s[84:87], s12 offen sc1
s_add_u32 s12, s12, 524288
buffer_load_dwordx4 v[208:211], v8, s[84:87], s12 offen sc1
s_add_u32 s12, s12, 524288
s_waitcnt lgkmcnt(0)
s_barrier
ds_read_b64 v[16:17], v4 offset:0
ds_read_b64 v[48:49], v4 offset:4096
ds_read_b64 v[18:19], v4 offset:256
ds_read_b64 v[50:51], v4 offset:4352
ds_read_b64 v[20:21], v4 offset:512
ds_read_b64 v[52:53], v4 offset:4608
ds_read_b64 v[22:23], v4 offset:768
ds_read_b64 v[54:55], v4 offset:4864
ds_read_b64 v[24:25], v4 offset:1024
ds_read_b64 v[56:57], v4 offset:5120
ds_read_b64 v[26:27], v4 offset:1280
ds_read_b64 v[58:59], v4 offset:5376
ds_read_b64 v[28:29], v4 offset:1536
ds_read_b64 v[60:61], v4 offset:5632
ds_read_b64 v[30:31], v4 offset:1792
ds_read_b64 v[62:63], v4 offset:5888
ds_read_b64 v[32:33], v4 offset:2048
ds_read_b64 v[64:65], v4 offset:6144
ds_read_b64 v[34:35], v4 offset:2304
ds_read_b64 v[66:67], v4 offset:6400
ds_read_b64 v[36:37], v4 offset:2560
ds_read_b64 v[68:69], v4 offset:6656
ds_read_b64 v[38:39], v4 offset:2816
ds_read_b64 v[70:71], v4 offset:6912
ds_read_b64 v[40:41], v4 offset:3072
ds_read_b64 v[72:73], v4 offset:7168
ds_read_b64 v[42:43], v4 offset:3328
ds_read_b64 v[74:75], v4 offset:7424
ds_read_b64 v[44:45], v4 offset:3584
ds_read_b64 v[76:77], v4 offset:7680
ds_read_b64 v[46:47], v4 offset:3840
ds_read_b64 v[78:79], v4 offset:7936
s_waitcnt lgkmcnt(0)
v_pk_add_f32 v[14:15], v[16:17], v[48:49] neg_lo:[0,1] neg_hi:[0,1]
v_pk_add_f32 v[16:17], v[16:17], v[48:49]
v_pk_add_f32 v[48:49], v[18:19], v[50:51] neg_lo:[0,1] neg_hi:[0,1]
v_pk_add_f32 v[18:19], v[18:19], v[50:51]
v_pk_mul_f32 v[50:51], v[48:49], s[50:51] op_sel:[0,0] op_sel_hi:[0,1] neg_lo:[0,0] neg_hi:[0,0]
v_pk_fma_f32 v[50:51], v[48:49], s[50:51], v[50:51] op_sel:[1,1,0] op_sel_hi:[1,0,1] neg_lo:[0,1,0] neg_hi:[0,0,0]
v_pk_add_f32 v[48:49], v[20:21], v[52:53] neg_lo:[0,1] neg_hi:[0,1]
v_pk_add_f32 v[20:21], v[20:21], v[52:53]
v_pk_mul_f32 v[52:53], v[48:49], s[54:55] op_sel:[0,0] op_sel_hi:[0,1] neg_lo:[0,0] neg_hi:[0,0]
v_pk_fma_f32 v[52:53], v[48:49], s[54:55], v[52:53] op_sel:[1,1,0] op_sel_hi:[1,0,1] neg_lo:[0,1,0] neg_hi:[0,0,0]
v_pk_add_f32 v[48:49], v[22:23], v[54:55] neg_lo:[0,1] neg_hi:[0,1]
v_pk_add_f32 v[22:23], v[22:23], v[54:55]
v_pk_mul_f32 v[54:55], v[48:49], s[58:59] op_sel:[0,0] op_sel_hi:[0,1] neg_lo:[0,0] neg_hi:[0,0]
v_pk_fma_f32 v[54:55], v[48:49], s[58:59], v[54:55] op_sel:[1,1,0] op_sel_hi:[1,0,1] neg_lo:[0,1,0] neg_hi:[0,0,0]
v_pk_add_f32 v[48:49], v[24:25], v[56:57] neg_lo:[0,1] neg_hi:[0,1]
v_pk_add_f32 v[24:25], v[24:25], v[56:57]
v_pk_mul_f32 v[56:57], v[48:49], s[62:63] op_sel:[0,0] op_sel_hi:[0,1] neg_lo:[0,0] neg_hi:[0,0]
v_pk_fma_f32 v[56:57], v[48:49], s[62:63], v[56:57] op_sel:[1,1,0] op_sel_hi:[1,0,1] neg_lo:[0,1,0] neg_hi:[0,0,0]
v_pk_add_f32 v[48:49], v[26:27], v[58:59] neg_lo:[0,1] neg_hi:[0,1]
v_pk_add_f32 v[26:27], v[26:27], v[58:59]
v_pk_mul_f32 v[58:59], v[48:49], s[58:59] op_sel:[0,1] op_sel_hi:[0,0] neg_lo:[0,0] neg_hi:[0,0]
v_pk_fma_f32 v[58:59], v[48:49], s[58:59], v[58:59] op_sel:[1,0,0] op_sel_hi:[1,1,1] neg_lo:[0,1,0] neg_hi:[0,0,0]
v_pk_add_f32 v[48:49], v[28:29], v[60:61] neg_lo:[0,1] neg_hi:[0,1]
v_pk_add_f32 v[28:29], v[28:29], v[60:61]
v_pk_mul_f32 v[60:61], v[48:49], s[54:55] op_sel:[0,1] op_sel_hi:[0,0] neg_lo:[0,0] neg_hi:[0,0]
v_pk_fma_f32 v[60:61], v[48:49], s[54:55], v[60:61] op_sel:[1,0,0] op_sel_hi:[1,1,1] neg_lo:[0,1,0] neg_hi:[0,0,0]
v_pk_add_f32 v[48:49], v[30:31], v[62:63] neg_lo:[0,1] neg_hi:[0,1]
v_pk_add_f32 v[30:31], v[30:31], v[62:63]
v_pk_mul_f32 v[62:63], v[48:49], s[50:51] op_sel:[0,1] op_sel_hi:[0,0] neg_lo:[0,0] neg_hi:[0,0]
v_pk_fma_f32 v[62:63], v[48:49], s[50:51], v[62:63] op_sel:[1,0,0] op_sel_hi:[1,1,1] neg_lo:[0,1,0] neg_hi:[0,0,0]
v_pk_add_f32 v[48:49], v[32:33], v[64:65] op_sel:[1,1] op_sel_hi:[0,0] neg_lo:[1,0] neg_hi:[0,1]
v_pk_add_f32 v[32:33], v[32:33], v[64:65]
v_pk_add_f32 v[64:65], v[34:35], v[66:67] neg_lo:[0,1] neg_hi:[0,1]
v_pk_add_f32 v[34:35], v[34:35], v[66:67]
v_pk_mul_f32 v[66:67], v[64:65], s[50:51] op_sel:[0,1] op_sel_hi:[0,0] neg_lo:[0,1] neg_hi:[0,0]
v_pk_fma_f32 v[66:67], v[64:65], s[50:51], v[66:67] op_sel:[1,0,0] op_sel_hi:[1,1,1] neg_lo:[0,1,0] neg_hi:[0,1,0]
v_pk_add_f32 v[64:65], v[36:37], v[68:69] neg_lo:[0,1] neg_hi:[0,1]
v_pk_add_f32 v[36:37], v[36:37], v[68:69]
v_pk_mul_f32 v[68:69], v[64:65], s[54:55] op_sel:[0,1] op_sel_hi:[0,0] neg_lo:[0,1] neg_hi:[0,0]
v_pk_fma_f32 v[68:69], v[64:65], s[54:55], v[68:69] op_sel:[1,0,0] op_sel_hi:[1,1,1] neg_lo:[0,1,0] neg_hi:[0,1,0]
v_pk_add_f32 v[64:65], v[38:39], v[70:71] neg_lo:[0,1] neg_hi:[0,1]
v_pk_add_f32 v[38:39], v[38:39], v[70:71]
v_pk_mul_f32 v[70:71], v[64:65], s[58:59] op_sel:[0,1] op_sel_hi:[0,0] neg_lo:[0,1] neg_hi:[0,0]
v_pk_fma_f32 v[70:71], v[64:65], s[58:59], v[70:71] op_sel:[1,0,0] op_sel_hi:[1,1,1] neg_lo:[0,1,0] neg_hi:[0,1,0]
v_pk_add_f32 v[64:65], v[40:41], v[72:73] neg_lo:[0,1] neg_hi:[0,1]
v_pk_add_f32 v[40:41], v[40:41], v[72:73]
v_pk_mul_f32 v[72:73], v[64:65], s[62:63] op_sel:[0,0] op_sel_hi:[0,1] neg_lo:[0,1] neg_hi:[0,0]
v_pk_fma_f32 v[72:73], v[64:65], s[62:63], v[72:73] op_sel:[1,1,0] op_sel_hi:[1,0,1] neg_lo:[0,1,0] neg_hi:[0,1,0]
v_pk_add_f32 v[64:65], v[42:43], v[74:75] neg_lo:[0,1] neg_hi:[0,1]
v_pk_add_f32 v[42:43], v[42:43], v[74:75]
v_pk_mul_f32 v[74:75], v[64:65], s[58:59] op_sel:[0,0] op_sel_hi:[0,1] neg_lo:[0,1] neg_hi:[0,0]
v_pk_fma_f32 v[74:75], v[64:65], s[58:59], v[74:75] op_sel:[1,1,0] op_sel_hi:[1,0,1] neg_lo:[0,1,0] neg_hi:[0,1,0]
v_pk_add_f32 v[64:65], v[44:45], v[76:77] neg_lo:[0,1] neg_hi:[0,1]
v_pk_add_f32 v[44:45], v[44:45], v[76:77]
v_pk_mul_f32 v[76:77], v[64:65], s[54:55] op_sel:[0,0] op_sel_hi:[0,1] neg_lo:[0,1] neg_hi:[0,0]
v_pk_fma_f32 v[76:77], v[64:65], s[54:55], v[76:77] op_sel:[1,1,0] op_sel_hi:[1,0,1] neg_lo:[0,1,0] neg_hi:[0,1,0]
v_pk_add_f32 v[64:65], v[46:47], v[78:79] neg_lo:[0,1] neg_hi:[0,1]
v_pk_add_f32 v[46:47], v[46:47], v[78:79]
v_pk_mul_f32 v[78:79], v[64:65], s[50:51] op_sel:[0,0] op_sel_hi:[0,1] neg_lo:[0,1] neg_hi:[0,0]
v_pk_fma_f32 v[78:79], v[64:65], s[50:51], v[78:79] op_sel:[1,1,0] op_sel_hi:[1,0,1] neg_lo:[0,1,0] neg_hi:[0,1,0]
v_pk_add_f32 v[64:65], v[16:17], v[32:33] neg_lo:[0,1] neg_hi:[0,1]
v_pk_add_f32 v[16:17], v[16:17], v[32:33]
v_pk_add_f32 v[32:33], v[18:19], v[34:35] neg_lo:[0,1] neg_hi:[0,1]
v_pk_add_f32 v[18:19], v[18:19], v[34:35]
v_pk_mul_f32 v[34:35], v[32:33], s[54:55] op_sel:[0,0] op_sel_hi:[0,1] neg_lo:[0,0] neg_hi:[0,0]
v_pk_fma_f32 v[34:35], v[32:33], s[54:55], v[34:35] op_sel:[1,1,0] op_sel_hi:[1,0,1] neg_lo:[0,1,0] neg_hi:[0,0,0]
v_pk_add_f32 v[32:33], v[20:21], v[36:37] neg_lo:[0,1] neg_hi:[0,1]
v_pk_add_f32 v[20:21], v[20:21], v[36:37]
v_pk_mul_f32 v[36:37], v[32:33], s[62:63] op_sel:[0,0] op_sel_hi:[0,1] neg_lo:[0,0] neg_hi:[0,0]
v_pk_fma_f32 v[36:37], v[32:33], s[62:63], v[36:37] op_sel:[1,1,0] op_sel_hi:[1,0,1] neg_lo:[0,1,0] neg_hi:[0,0,0]
v_pk_add_f32 v[32:33], v[22:23], v[38:39] neg_lo:[0,1] neg_hi:[0,1]
v_pk_add_f32 v[22:23], v[22:23], v[38:39]
v_pk_mul_f32 v[38:39], v[32:33], s[54:55] op_sel:[0,1] op_sel_hi:[0,0] neg_lo:[0,0] neg_hi:[0,0]
v_pk_fma_f32 v[38:39], v[32:33], s[54:55], v[38:39] op_sel:[1,0,0] op_sel_hi:[1,1,1] neg_lo:[0,1,0] neg_hi:[0,0,0]
v_pk_add_f32 v[32:33], v[24:25], v[40:41] op_sel:[1,1] op_sel_hi:[0,0] neg_lo:[1,0] neg_hi:[0,1]
v_pk_add_f32 v[24:25], v[24:25], v[40:41]
v_pk_add_f32 v[40:41], v[26:27], v[42:43] neg_lo:[0,1] neg_hi:[0,1]
v_pk_add_f32 v[26:27], v[26:27], v[42:43]
v_pk_mul_f32 v[42:43], v[40:41], s[54:55] op_sel:[0,1] op_sel_hi:[0,0] neg_lo:[0,1] neg_hi:[0,0]
v_pk_fma_f32 v[42:43], v[40:41], s[54:55], v[42:43] op_sel:[1,0,0] op_sel_hi:[1,1,1] neg_lo:[0,1,0] neg_hi:[0,1,0]
v_pk_add_f32 v[40:41], v[28:29], v[44:45] neg_lo:[0,1] neg_hi:[0,1]
v_pk_add_f32 v[28:29], v[28:29], v[44:45]
v_pk_mul_f32 v[44:45], v[40:41], s[62:63] op_sel:[0,0] op_sel_hi:[0,1] neg_lo:[0,1] neg_hi:[0,0]
v_pk_fma_f32 v[44:45], v[40:41], s[62:63], v[44:45] op_sel:[1,1,0] op_sel_hi:[1,0,1] neg_lo:[0,1,0] neg_hi:[0,1,0]
v_pk_add_f32 v[40:41], v[30:31], v[46:47] neg_lo:[0,1] neg_hi:[0,1]
v_pk_add_f32 v[30:31], v[30:31], v[46:47]
v_pk_mul_f32 v[46:47], v[40:41], s[54:55] op_sel:[0,0] op_sel_hi:[0,1] neg_lo:[0,1] neg_hi:[0,0]
v_pk_fma_f32 v[46:47], v[40:41], s[54:55], v[46:47] op_sel:[1,1,0] op_sel_hi:[1,0,1] neg_lo:[0,1,0] neg_hi:[0,1,0]
v_pk_add_f32 v[40:41], v[14:15], v[48:49] neg_lo:[0,1] neg_hi:[0,1]
v_pk_add_f32 v[14:15], v[14:15], v[48:49]
v_pk_add_f32 v[48:49], v[50:51], v[66:67] neg_lo:[0,1] neg_hi:[0,1]
v_pk_add_f32 v[50:51], v[50:51], v[66:67]
v_pk_mul_f32 v[66:67], v[48:49], s[54:55] op_sel:[0,0] op_sel_hi:[0,1] neg_lo:[0,0] neg_hi:[0,0]
v_pk_fma_f32 v[66:67], v[48:49], s[54:55], v[66:67] op_sel:[1,1,0] op_sel_hi:[1,0,1] neg_lo:[0,1,0] neg_hi:[0,0,0]
v_pk_add_f32 v[48:49], v[52:53], v[68:69] neg_lo:[0,1] neg_hi:[0,1]
v_pk_add_f32 v[52:53], v[52:53], v[68:69]
v_pk_mul_f32 v[68:69], v[48:49], s[62:63] op_sel:[0,0] op_sel_hi:[0,1] neg_lo:[0,0] neg_hi:[0,0]
v_pk_fma_f32 v[68:69], v[48:49], s[62:63], v[68:69] op_sel:[1,1,0] op_sel_hi:[1,0,1] neg_lo:[0,1,0] neg_hi:[0,0,0]
v_pk_add_f32 v[48:49], v[54:55], v[70:71] neg_lo:[0,1] neg_hi:[0,1]
v_pk_add_f32 v[54:55], v[54:55], v[70:71]
v_pk_mul_f32 v[70:71], v[48:49], s[54:55] op_sel:[0,1] op_sel_hi:[0,0] neg_lo:[0,0] neg_hi:[0,0]
v_pk_fma_f32 v[70:71], v[48:49], s[54:55], v[70:71] op_sel:[1,0,0] op_sel_hi:[1,1,1] neg_lo:[0,1,0] neg_hi:[0,0,0]
v_pk_add_f32 v[48:49], v[56:57], v[72:73] op_sel:[1,1] op_sel_hi:[0,0] neg_lo:[1,0] neg_hi:[0,1]
v_pk_add_f32 v[56:57], v[56:57], v[72:73]
v_pk_add_f32 v[72:73], v[58:59], v[74:75] neg_lo:[0,1] neg_hi:[0,1]
v_pk_add_f32 v[58:59], v[58:59], v[74:75]
v_pk_mul_f32 v[74:75], v[72:73], s[54:55] op_sel:[0,1] op_sel_hi:[0,0] neg_lo:[0,1] neg_hi:[0,0]
v_pk_fma_f32 v[74:75], v[72:73], s[54:55], v[74:75] op_sel:[1,0,0] op_sel_hi:[1,1,1] neg_lo:[0,1,0] neg_hi:[0,1,0]
v_pk_add_f32 v[72:73], v[60:61], v[76:77] neg_lo:[0,1] neg_hi:[0,1]
v_pk_add_f32 v[60:61], v[60:61], v[76:77]
v_pk_mul_f32 v[76:77], v[72:73], s[62:63] op_sel:[0,0] op_sel_hi:[0,1] neg_lo:[0,1] neg_hi:[0,0]
v_pk_fma_f32 v[76:77], v[72:73], s[62:63], v[76:77] op_sel:[1,1,0] op_sel_hi:[1,0,1] neg_lo:[0,1,0] neg_hi:[0,1,0]
v_pk_add_f32 v[72:73], v[62:63], v[78:79] neg_lo:[0,1] neg_hi:[0,1]
v_pk_add_f32 v[62:63], v[62:63], v[78:79]
v_pk_mul_f32 v[78:79], v[72:73], s[54:55] op_sel:[0,0] op_sel_hi:[0,1] neg_lo:[0,1] neg_hi:[0,0]
v_pk_fma_f32 v[78:79], v[72:73], s[54:55], v[78:79] op_sel:[1,1,0] op_sel_hi:[1,0,1] neg_lo:[0,1,0] neg_hi:[0,1,0]
v_pk_add_f32 v[72:73], v[16:17], v[24:25] neg_lo:[0,1] neg_hi:[0,1]
v_pk_add_f32 v[16:17], v[16:17], v[24:25]
v_pk_add_f32 v[24:25], v[18:19], v[26:27] neg_lo:[0,1] neg_hi:[0,1]
v_pk_add_f32 v[18:19], v[18:19], v[26:27]
v_pk_mul_f32 v[26:27], v[24:25], s[62:63] op_sel:[0,0] op_sel_hi:[0,1] neg_lo:[0,0] neg_hi:[0,0]
v_pk_fma_f32 v[26:27], v[24:25], s[62:63], v[26:27] op_sel:[1,1,0] op_sel_hi:[1,0,1] neg_lo:[0,1,0] neg_hi:[0,0,0]
v_pk_add_f32 v[24:25], v[20:21], v[28:29] op_sel:[1,1] op_sel_hi:[0,0] neg_lo:[1,0] neg_hi:[0,1]
v_pk_add_f32 v[20:21], v[20:21], v[28:29]
v_pk_add_f32 v[28:29], v[22:23], v[30:31] neg_lo:[0,1] neg_hi:[0,1]
v_pk_add_f32 v[22:23], v[22:23], v[30:31]
v_pk_mul_f32 v[30:31], v[28:29], s[62:63] op_sel:[0,0] op_sel_hi:[0,1] neg_lo:[0,1] neg_hi:[0,0]
v_pk_fma_f32 v[30:31], v[28:29], s[62:63], v[30:31] op_sel:[1,1,0] op_sel_hi:[1,0,1] neg_lo:[0,1,0] neg_hi:[0,1,0]
v_pk_add_f32 v[28:29], v[64:65], v[32:33] neg_lo:[0,1] neg_hi:[0,1]
v_pk_add_f32 v[64:65], v[64:65], v[32:33]
v_pk_add_f32 v[32:33], v[34:35], v[42:43] neg_lo:[0,1] neg_hi:[0,1]
v_pk_add_f32 v[34:35], v[34:35], v[42:43]
v_pk_mul_f32 v[42:43], v[32:33], s[62:63] op_sel:[0,0] op_sel_hi:[0,1] neg_lo:[0,0] neg_hi:[0,0]
v_pk_fma_f32 v[42:43], v[32:33], s[62:63], v[42:43] op_sel:[1,1,0] op_sel_hi:[1,0,1] neg_lo:[0,1,0] neg_hi:[0,0,0]
v_pk_add_f32 v[32:33], v[36:37], v[44:45] op_sel:[1,1] op_sel_hi:[0,0] neg_lo:[1,0] neg_hi:[0,1]
v_pk_add_f32 v[36:37], v[36:37], v[44:45]
v_pk_add_f32 v[44:45], v[38:39], v[46:47] neg_lo:[0,1] neg_hi:[0,1]
v_pk_add_f32 v[38:39], v[38:39], v[46:47]
v_pk_mul_f32 v[46:47], v[44:45], s[62:63] op_sel:[0,0] op_sel_hi:[0,1] neg_lo:[0,1] neg_hi:[0,0]
v_pk_fma_f32 v[46:47], v[44:45], s[62:63], v[46:47] op_sel:[1,1,0] op_sel_hi:[1,0,1] neg_lo:[0,1,0] neg_hi:[0,1,0]
v_pk_add_f32 v[44:45], v[14:15], v[56:57] neg_lo:[0,1] neg_hi:[0,1]
v_pk_add_f32 v[14:15], v[14:15], v[56:57]
v_pk_add_f32 v[56:57], v[50:51], v[58:59] neg_lo:[0,1] neg_hi:[0,1]
v_pk_add_f32 v[50:51], v[50:51], v[58:59]
v_pk_mul_f32 v[58:59], v[56:57], s[62:63] op_sel:[0,0] op_sel_hi:[0,1] neg_lo:[0,0] neg_hi:[0,0]
v_pk_fma_f32 v[58:59], v[56:57], s[62:63], v[58:59] op_sel:[1,1,0] op_sel_hi:[1,0,1] neg_lo:[0,1,0] neg_hi:[0,0,0]
v_pk_add_f32 v[56:57], v[52:53], v[60:61] op_sel:[1,1] op_sel_hi:[0,0] neg_lo:[1,0] neg_hi:[0,1]
v_pk_add_f32 v[52:53], v[52:53], v[60:61]
v_pk_add_f32 v[60:61], v[54:55], v[62:63] neg_lo:[0,1] neg_hi:[0,1]
v_pk_add_f32 v[54:55], v[54:55], v[62:63]
v_pk_mul_f32 v[62:63], v[60:61], s[62:63] op_sel:[0,0] op_sel_hi:[0,1] neg_lo:[0,1] neg_hi:[0,0]
v_pk_fma_f32 v[62:63], v[60:61], s[62:63], v[62:63] op_sel:[1,1,0] op_sel_hi:[1,0,1] neg_lo:[0,1,0] neg_hi:[0,1,0]
v_pk_add_f32 v[60:61], v[40:41], v[48:49] neg_lo:[0,1] neg_hi:[0,1]
v_pk_add_f32 v[40:41], v[40:41], v[48:49]
v_pk_add_f32 v[48:49], v[66:67], v[74:75] neg_lo:[0,1] neg_hi:[0,1]
v_pk_add_f32 v[66:67], v[66:67], v[74:75]
v_pk_mul_f32 v[74:75], v[48:49], s[62:63] op_sel:[0,0] op_sel_hi:[0,1] neg_lo:[0,0] neg_hi:[0,0]
v_pk_fma_f32 v[74:75], v[48:49], s[62:63], v[74:75] op_sel:[1,1,0] op_sel_hi:[1,0,1] neg_lo:[0,1,0] neg_hi:[0,0,0]
v_pk_add_f32 v[48:49], v[68:69], v[76:77] op_sel:[1,1] op_sel_hi:[0,0] neg_lo:[1,0] neg_hi:[0,1]
v_pk_add_f32 v[68:69], v[68:69], v[76:77]
v_pk_add_f32 v[76:77], v[70:71], v[78:79] neg_lo:[0,1] neg_hi:[0,1]
v_pk_add_f32 v[70:71], v[70:71], v[78:79]
v_pk_mul_f32 v[78:79], v[76:77], s[62:63] op_sel:[0,0] op_sel_hi:[0,1] neg_lo:[0,1] neg_hi:[0,0]
v_pk_fma_f32 v[78:79], v[76:77], s[62:63], v[78:79] op_sel:[1,1,0] op_sel_hi:[1,0,1] neg_lo:[0,1,0] neg_hi:[0,1,0]
v_pk_add_f32 v[76:77], v[16:17], v[20:21] neg_lo:[0,1] neg_hi:[0,1]
v_pk_add_f32 v[16:17], v[16:17], v[20:21]
v_pk_add_f32 v[20:21], v[18:19], v[22:23] op_sel:[1,1] op_sel_hi:[0,0] neg_lo:[1,0] neg_hi:[0,1]
v_pk_add_f32 v[18:19], v[18:19], v[22:23]
v_pk_add_f32 v[22:23], v[72:73], v[24:25] neg_lo:[0,1] neg_hi:[0,1]
v_pk_add_f32 v[72:73], v[72:73], v[24:25]
v_pk_add_f32 v[24:25], v[26:27], v[30:31] op_sel:[1,1] op_sel_hi:[0,0] neg_lo:[1,0] neg_hi:[0,1]
v_pk_add_f32 v[26:27], v[26:27], v[30:31]
v_pk_add_f32 v[30:31], v[64:65], v[36:37] neg_lo:[0,1] neg_hi:[0,1]
v_pk_add_f32 v[64:65], v[64:65], v[36:37]
v_pk_add_f32 v[36:37], v[34:35], v[38:39] op_sel:[1,1] op_sel_hi:[0,0] neg_lo:[1,0] neg_hi:[0,1]
v_pk_add_f32 v[34:35], v[34:35], v[38:39]
v_pk_add_f32 v[38:39], v[28:29], v[32:33] neg_lo:[0,1] neg_hi:[0,1]
v_pk_add_f32 v[28:29], v[28:29], v[32:33]
v_pk_add_f32 v[32:33], v[42:43], v[46:47] op_sel:[1,1] op_sel_hi:[0,0] neg_lo:[1,0] neg_hi:[0,1]
v_pk_add_f32 v[42:43], v[42:43], v[46:47]
v_pk_add_f32 v[46:47], v[14:15], v[52:53] neg_lo:[0,1] neg_hi:[0,1]
v_pk_add_f32 v[14:15], v[14:15], v[52:53]
v_pk_add_f32 v[52:53], v[50:51], v[54:55] op_sel:[1,1] op_sel_hi:[0,0] neg_lo:[1,0] neg_hi:[0,1]
v_pk_add_f32 v[50:51], v[50:51], v[54:55]
v_pk_add_f32 v[54:55], v[44:45], v[56:57] neg_lo:[0,1] neg_hi:[0,1]
v_pk_add_f32 v[44:45], v[44:45], v[56:57]
v_pk_add_f32 v[56:57], v[58:59], v[62:63] op_sel:[1,1] op_sel_hi:[0,0] neg_lo:[1,0] neg_hi:[0,1]
v_pk_add_f32 v[58:59], v[58:59], v[62:63]
v_pk_add_f32 v[62:63], v[40:41], v[68:69] neg_lo:[0,1] neg_hi:[0,1]
v_pk_add_f32 v[40:41], v[40:41], v[68:69]
v_pk_add_f32 v[68:69], v[66:67], v[70:71] op_sel:[1,1] op_sel_hi:[0,0] neg_lo:[1,0] neg_hi:[0,1]
v_pk_add_f32 v[66:67], v[66:67], v[70:71]
v_pk_add_f32 v[70:71], v[60:61], v[48:49] neg_lo:[0,1] neg_hi:[0,1]
v_pk_add_f32 v[60:61], v[60:61], v[48:49]
v_pk_add_f32 v[48:49], v[74:75], v[78:79] op_sel:[1,1] op_sel_hi:[0,0] neg_lo:[1,0] neg_hi:[0,1]
v_pk_add_f32 v[74:75], v[74:75], v[78:79]
v_pk_add_f32 v[78:79], v[16:17], v[18:19] neg_lo:[0,1] neg_hi:[0,1]
v_pk_add_f32 v[16:17], v[16:17], v[18:19]
v_pk_add_f32 v[18:19], v[76:77], v[20:21] neg_lo:[0,1] neg_hi:[0,1]
v_pk_add_f32 v[76:77], v[76:77], v[20:21]
v_pk_add_f32 v[20:21], v[72:73], v[26:27] neg_lo:[0,1] neg_hi:[0,1]
v_pk_add_f32 v[72:73], v[72:73], v[26:27]
v_pk_add_f32 v[26:27], v[22:23], v[24:25] neg_lo:[0,1] neg_hi:[0,1]
v_pk_add_f32 v[22:23], v[22:23], v[24:25]
v_pk_add_f32 v[24:25], v[64:65], v[34:35] neg_lo:[0,1] neg_hi:[0,1]
v_pk_add_f32 v[64:65], v[64:65], v[34:35]
v_pk_add_f32 v[34:35], v[30:31], v[36:37] neg_lo:[0,1] neg_hi:[0,1]
v_pk_add_f32 v[30:31], v[30:31], v[36:37]
v_pk_add_f32 v[36:37], v[28:29], v[42:43] neg_lo:[0,1] neg_hi:[0,1]
v_pk_add_f32 v[28:29], v[28:29], v[42:43]
v_pk_add_f32 v[42:43], v[38:39], v[32:33] neg_lo:[0,1] neg_hi:[0,1]
v_pk_add_f32 v[38:39], v[38:39], v[32:33]
v_pk_add_f32 v[32:33], v[14:15], v[50:51] neg_lo:[0,1] neg_hi:[0,1]
v_pk_add_f32 v[14:15], v[14:15], v[50:51]
v_pk_add_f32 v[50:51], v[46:47], v[52:53] neg_lo:[0,1] neg_hi:[0,1]
v_pk_add_f32 v[46:47], v[46:47], v[52:53]
v_pk_add_f32 v[52:53], v[44:45], v[58:59] neg_lo:[0,1] neg_hi:[0,1]
v_pk_add_f32 v[44:45], v[44:45], v[58:59]
v_pk_add_f32 v[58:59], v[54:55], v[56:57] neg_lo:[0,1] neg_hi:[0,1]
v_pk_add_f32 v[54:55], v[54:55], v[56:57]
v_pk_add_f32 v[56:57], v[40:41], v[66:67] neg_lo:[0,1] neg_hi:[0,1]
v_pk_add_f32 v[40:41], v[40:41], v[66:67]
v_pk_add_f32 v[66:67], v[62:63], v[68:69] neg_lo:[0,1] neg_hi:[0,1]
v_pk_add_f32 v[62:63], v[62:63], v[68:69]
v_pk_add_f32 v[68:69], v[60:61], v[74:75] neg_lo:[0,1] neg_hi:[0,1]
v_pk_add_f32 v[60:61], v[60:61], v[74:75]
v_pk_add_f32 v[74:75], v[70:71], v[48:49] neg_lo:[0,1] neg_hi:[0,1]
v_pk_add_f32 v[70:71], v[70:71], v[48:49]
v_pk_mul_f32 v[48:49], v[14:15], v[82:83] op_sel:[0,0] op_sel_hi:[0,1] neg_lo:[0,0] neg_hi:[0,0]
v_pk_fma_f32 v[14:15], v[14:15], v[82:83], v[48:49] op_sel:[1,1,0] op_sel_hi:[1,0,1] neg_lo:[0,1,0] neg_hi:[0,0,0]
v_pk_mul_f32 v[48:49], v[64:65], v[84:85] op_sel:[0,0] op_sel_hi:[0,1] neg_lo:[0,0] neg_hi:[0,0]
v_pk_fma_f32 v[64:65], v[64:65], v[84:85], v[48:49] op_sel:[1,1,0] op_sel_hi:[1,0,1] neg_lo:[0,1,0] neg_hi:[0,0,0]
v_pk_mul_f32 v[48:49], v[40:41], v[86:87] op_sel:[0,0] op_sel_hi:[0,1] neg_lo:[0,0] neg_hi:[0,0]
v_pk_fma_f32 v[40:41], v[40:41], v[86:87], v[48:49] op_sel:[1,1,0] op_sel_hi:[1,0,1] neg_lo:[0,1,0] neg_hi:[0,0,0]
v_pk_mul_f32 v[48:49], v[72:73], v[88:89] op_sel:[0,0] op_sel_hi:[0,1] neg_lo:[0,0] neg_hi:[0,0]
v_pk_fma_f32 v[72:73], v[72:73], v[88:89], v[48:49] op_sel:[1,1,0] op_sel_hi:[1,0,1] neg_lo:[0,1,0] neg_hi:[0,0,0]
v_pk_mul_f32 v[48:49], v[44:45], v[90:91] op_sel:[0,0] op_sel_hi:[0,1] neg_lo:[0,0] neg_hi:[0,0]
v_pk_fma_f32 v[44:45], v[44:45], v[90:91], v[48:49] op_sel:[1,1,0] op_sel_hi:[1,0,1] neg_lo:[0,1,0] neg_hi:[0,0,0]
v_pk_mul_f32 v[48:49], v[28:29], v[92:93] op_sel:[0,0] op_sel_hi:[0,1] neg_lo:[0,0] neg_hi:[0,0]
v_pk_fma_f32 v[28:29], v[28:29], v[92:93], v[48:49] op_sel:[1,1,0] op_sel_hi:[1,0,1] neg_lo:[0,1,0] neg_hi:[0,0,0]
v_pk_mul_f32 v[48:49], v[60:61], v[94:95] op_sel:[0,0] op_sel_hi:[0,1] neg_lo:[0,0] neg_hi:[0,0]
v_pk_fma_f32 v[60:61], v[60:61], v[94:95], v[48:49] op_sel:[1,1,0] op_sel_hi:[1,0,1] neg_lo:[0,1,0] neg_hi:[0,0,0]
v_pk_mul_f32 v[48:49], v[76:77], v[96:97] op_sel:[0,0] op_sel_hi:[0,1] neg_lo:[0,0] neg_hi:[0,0]
v_pk_fma_f32 v[76:77], v[76:77], v[96:97], v[48:49] op_sel:[1,1,0] op_sel_hi:[1,0,1] neg_lo:[0,1,0] neg_hi:[0,0,0]
v_pk_mul_f32 v[48:49], v[46:47], v[98:99] op_sel:[0,0] op_sel_hi:[0,1] neg_lo:[0,0] neg_hi:[0,0]
v_pk_fma_f32 v[46:47], v[46:47], v[98:99], v[48:49] op_sel:[1,1,0] op_sel_hi:[1,0,1] neg_lo:[0,1,0] neg_hi:[0,0,0]
v_pk_mul_f32 v[48:49], v[30:31], v[100:101] op_sel:[0,0] op_sel_hi:[0,1] neg_lo:[0,0] neg_hi:[0,0]
v_pk_fma_f32 v[30:31], v[30:31], v[100:101], v[48:49] op_sel:[1,1,0] op_sel_hi:[1,0,1] neg_lo:[0,1,0] neg_hi:[0,0,0]
v_pk_mul_f32 v[48:49], v[62:63], v[102:103] op_sel:[0,0] op_sel_hi:[0,1] neg_lo:[0,0] neg_hi:[0,0]
v_pk_fma_f32 v[62:63], v[62:63], v[102:103], v[48:49] op_sel:[1,1,0] op_sel_hi:[1,0,1] neg_lo:[0,1,0] neg_hi:[0,0,0]
v_pk_mul_f32 v[48:49], v[22:23], v[104:105] op_sel:[0,0] op_sel_hi:[0,1] neg_lo:[0,0] neg_hi:[0,0]
v_pk_fma_f32 v[22:23], v[22:23], v[104:105], v[48:49] op_sel:[1,1,0] op_sel_hi:[1,0,1] neg_lo:[0,1,0] neg_hi:[0,0,0]
v_pk_mul_f32 v[48:49], v[54:55], v[106:107] op_sel:[0,0] op_sel_hi:[0,1] neg_lo:[0,0] neg_hi:[0,0]
v_pk_fma_f32 v[54:55], v[54:55], v[106:107], v[48:49] op_sel:[1,1,0] op_sel_hi:[1,0,1] neg_lo:[0,1,0] neg_hi:[0,0,0]
v_pk_mul_f32 v[48:49], v[38:39], v[108:109] op_sel:[0,0] op_sel_hi:[0,1] neg_lo:[0,0] neg_hi:[0,0]
v_pk_fma_f32 v[38:39], v[38:39], v[108:109], v[48:49] op_sel:[1,1,0] op_sel_hi:[1,0,1] neg_lo:[0,1,0] neg_hi:[0,0,0]
v_pk_mul_f32 v[48:49], v[70:71], v[110:111] op_sel:[0,0] op_sel_hi:[0,1] neg_lo:[0,0] neg_hi:[0,0]
v_pk_fma_f32 v[70:71], v[70:71], v[110:111], v[48:49] op_sel:[1,1,0] op_sel_hi:[1,0,1] neg_lo:[0,1,0] neg_hi:[0,0,0]
v_pk_mul_f32 v[48:49], v[78:79], v[112:113] op_sel:[0,0] op_sel_hi:[0,1] neg_lo:[0,0] neg_hi:[0,0]
v_pk_fma_f32 v[78:79], v[78:79], v[112:113], v[48:49] op_sel:[1,1,0] op_sel_hi:[1,0,1] neg_lo:[0,1,0] neg_hi:[0,0,0]
v_pk_mul_f32 v[48:49], v[32:33], v[114:115] op_sel:[0,0] op_sel_hi:[0,1] neg_lo:[0,0] neg_hi:[0,0]
v_pk_fma_f32 v[32:33], v[32:33], v[114:115], v[48:49] op_sel:[1,1,0] op_sel_hi:[1,0,1] neg_lo:[0,1,0] neg_hi:[0,0,0]
v_pk_mul_f32 v[48:49], v[24:25], v[116:117] op_sel:[0,0] op_sel_hi:[0,1] neg_lo:[0,0] neg_hi:[0,0]
v_pk_fma_f32 v[24:25], v[24:25], v[116:117], v[48:49] op_sel:[1,1,0] op_sel_hi:[1,0,1] neg_lo:[0,1,0] neg_hi:[0,0,0]
v_pk_mul_f32 v[48:49], v[56:57], v[118:119] op_sel:[0,0] op_sel_hi:[0,1] neg_lo:[0,0] neg_hi:[0,0]
v_pk_fma_f32 v[56:57], v[56:57], v[118:119], v[48:49] op_sel:[1,1,0] op_sel_hi:[1,0,1] neg_lo:[0,1,0] neg_hi:[0,0,0]
v_pk_mul_f32 v[48:49], v[20:21], v[120:121] op_sel:[0,0] op_sel_hi:[0,1] neg_lo:[0,0] neg_hi:[0,0]
v_pk_fma_f32 v[20:21], v[20:21], v[120:121], v[48:49] op_sel:[1,1,0] op_sel_hi:[1,0,1] neg_lo:[0,1,0] neg_hi:[0,0,0]
v_pk_mul_f32 v[48:49], v[52:53], v[122:123] op_sel:[0,0] op_sel_hi:[0,1] neg_lo:[0,0] neg_hi:[0,0]
v_pk_fma_f32 v[52:53], v[52:53], v[122:123], v[48:49] op_sel:[1,1,0] op_sel_hi:[1,0,1] neg_lo:[0,1,0] neg_hi:[0,0,0]
v_pk_mul_f32 v[48:49], v[36:37], v[124:125] op_sel:[0,0] op_sel_hi:[0,1] neg_lo:[0,0] neg_hi:[0,0]
v_pk_fma_f32 v[36:37], v[36:37], v[124:125], v[48:49] op_sel:[1,1,0] op_sel_hi:[1,0,1] neg_lo:[0,1,0] neg_hi:[0,0,0]
v_pk_mul_f32 v[48:49], v[68:69], v[126:127] op_sel:[0,0] op_sel_hi:[0,1] neg_lo:[0,0] neg_hi:[0,0]
v_pk_fma_f32 v[68:69], v[68:69], v[126:127], v[48:49] op_sel:[1,1,0] op_sel_hi:[1,0,1] neg_lo:[0,1,0] neg_hi:[0,0,0]
v_pk_mul_f32 v[48:49], v[18:19], v[128:129] op_sel:[0,0] op_sel_hi:[0,1] neg_lo:[0,0] neg_hi:[0,0]
v_pk_fma_f32 v[18:19], v[18:19], v[128:129], v[48:49] op_sel:[1,1,0] op_sel_hi:[1,0,1] neg_lo:[0,1,0] neg_hi:[0,0,0]
v_pk_mul_f32 v[48:49], v[50:51], v[130:131] op_sel:[0,0] op_sel_hi:[0,1] neg_lo:[0,0] neg_hi:[0,0]
v_pk_fma_f32 v[50:51], v[50:51], v[130:131], v[48:49] op_sel:[1,1,0] op_sel_hi:[1,0,1] neg_lo:[0,1,0] neg_hi:[0,0,0]
v_pk_mul_f32 v[48:49], v[34:35], v[132:133] op_sel:[0,0] op_sel_hi:[0,1] neg_lo:[0,0] neg_hi:[0,0]
v_pk_fma_f32 v[34:35], v[34:35], v[132:133], v[48:49] op_sel:[1,1,0] op_sel_hi:[1,0,1] neg_lo:[0,1,0] neg_hi:[0,0,0]
v_pk_mul_f32 v[48:49], v[66:67], v[134:135] op_sel:[0,0] op_sel_hi:[0,1] neg_lo:[0,0] neg_hi:[0,0]
v_pk_fma_f32 v[66:67], v[66:67], v[134:135], v[48:49] op_sel:[1,1,0] op_sel_hi:[1,0,1] neg_lo:[0,1,0] neg_hi:[0,0,0]
v_pk_mul_f32 v[48:49], v[26:27], v[136:137] op_sel:[0,0] op_sel_hi:[0,1] neg_lo:[0,0] neg_hi:[0,0]
v_pk_fma_f32 v[26:27], v[26:27], v[136:137], v[48:49] op_sel:[1,1,0] op_sel_hi:[1,0,1] neg_lo:[0,1,0] neg_hi:[0,0,0]
v_pk_mul_f32 v[48:49], v[58:59], v[138:139] op_sel:[0,0] op_sel_hi:[0,1] neg_lo:[0,0] neg_hi:[0,0]
v_pk_fma_f32 v[58:59], v[58:59], v[138:139], v[48:49] op_sel:[1,1,0] op_sel_hi:[1,0,1] neg_lo:[0,1,0] neg_hi:[0,0,0]
v_pk_mul_f32 v[48:49], v[42:43], v[140:141] op_sel:[0,0] op_sel_hi:[0,1] neg_lo:[0,0] neg_hi:[0,0]
v_pk_fma_f32 v[42:43], v[42:43], v[140:141], v[48:49] op_sel:[1,1,0] op_sel_hi:[1,0,1] neg_lo:[0,1,0] neg_hi:[0,0,0]
v_pk_mul_f32 v[48:49], v[74:75], v[142:143] op_sel:[0,0] op_sel_hi:[0,1] neg_lo:[0,0] neg_hi:[0,0]
v_pk_fma_f32 v[74:75], v[74:75], v[142:143], v[48:49] op_sel:[1,1,0] op_sel_hi:[1,0,1] neg_lo:[0,1,0] neg_hi:[0,0,0]
ds_write_b64 v4, v[16:17] offset:0
ds_write_b64 v4, v[14:15] offset:264
ds_write_b64 v4, v[64:65] offset:528
ds_write_b64 v4, v[40:41] offset:792
ds_write_b64 v4, v[72:73] offset:1056
ds_write_b64 v4, v[44:45] offset:1320
ds_write_b64 v4, v[28:29] offset:1584
ds_write_b64 v4, v[60:61] offset:1848
ds_write_b64 v4, v[76:77] offset:2112
ds_write_b64 v4, v[46:47] offset:2376
ds_write_b64 v4, v[30:31] offset:2640
ds_write_b64 v4, v[62:63] offset:2904
ds_write_b64 v4, v[22:23] offset:3168
ds_write_b64 v4, v[54:55] offset:3432
ds_write_b64 v4, v[38:39] offset:3696
ds_write_b64 v4, v[70:71] offset:3960
ds_write_b64 v4, v[78:79] offset:4224
ds_write_b64 v4, v[32:33] offset:4488
ds_write_b64 v4, v[24:25] offset:4752
ds_write_b64 v4, v[56:57] offset:5016
ds_write_b64 v4, v[20:21] offset:5280
ds_write_b64 v4, v[52:53] offset:5544
ds_write_b64 v4, v[36:37] offset:5808
ds_write_b64 v4, v[68:69] offset:6072
ds_write_b64 v4, v[18:19] offset:6336
ds_write_b64 v4, v[50:51] offset:6600
ds_write_b64 v4, v[34:35] offset:6864
ds_write_b64 v4, v[66:67] offset:7128
ds_write_b64 v4, v[26:27] offset:7392
ds_write_b64 v4, v[58:59] offset:7656
ds_write_b64 v4, v[42:43] offset:7920
ds_write_b64 v4, v[74:75] offset:8184
s_waitcnt lgkmcnt(0)
ds_read_b64 v[16:17], v5 offset:0
ds_read_b64 v[48:49], v5 offset:128
ds_read_b64 v[18:19], v5 offset:8
ds_read_b64 v[50:51], v5 offset:136
ds_read_b64 v[20:21], v5 offset:16
ds_read_b64 v[52:53], v5 offset:144
ds_read_b64 v[22:23], v5 offset:24
ds_read_b64 v[54:55], v5 offset:152
ds_read_b64 v[24:25], v5 offset:32
ds_read_b64 v[56:57], v5 offset:160
ds_read_b64 v[26:27], v5 offset:40
ds_read_b64 v[58:59], v5 offset:168
ds_read_b64 v[28:29], v5 offset:48
ds_read_b64 v[60:61], v5 offset:176
ds_read_b64 v[30:31], v5 offset:56
ds_read_b64 v[62:63], v5 offset:184
ds_read_b64 v[32:33], v5 offset:64
ds_read_b64 v[64:65], v5 offset:192
ds_read_b64 v[34:35], v5 offset:72
ds_read_b64 v[66:67], v5 offset:200
ds_read_b64 v[36:37], v5 offset:80
ds_read_b64 v[68:69], v5 offset:208
ds_read_b64 v[38:39], v5 offset:88
ds_read_b64 v[70:71], v5 offset:216
ds_read_b64 v[40:41], v5 offset:96
ds_read_b64 v[72:73], v5 offset:224
ds_read_b64 v[42:43], v5 offset:104
ds_read_b64 v[74:75], v5 offset:232
ds_read_b64 v[44:45], v5 offset:112
ds_read_b64 v[76:77], v5 offset:240
ds_read_b64 v[46:47], v5 offset:120
ds_read_b64 v[78:79], v5 offset:248
s_waitcnt lgkmcnt(0)
v_pk_add_f32 v[14:15], v[16:17], v[48:49] neg_lo:[0,1] neg_hi:[0,1]
v_pk_add_f32 v[16:17], v[16:17], v[48:49]
v_pk_add_f32 v[48:49], v[18:19], v[50:51] neg_lo:[0,1] neg_hi:[0,1]
v_pk_add_f32 v[18:19], v[18:19], v[50:51]
v_pk_mul_f32 v[50:51], v[48:49], s[50:51] op_sel:[0,0] op_sel_hi:[0,1] neg_lo:[0,0] neg_hi:[0,0]
v_pk_fma_f32 v[50:51], v[48:49], s[50:51], v[50:51] op_sel:[1,1,0] op_sel_hi:[1,0,1] neg_lo:[0,1,0] neg_hi:[0,0,0]
v_pk_add_f32 v[48:49], v[20:21], v[52:53] neg_lo:[0,1] neg_hi:[0,1]
v_pk_add_f32 v[20:21], v[20:21], v[52:53]
v_pk_mul_f32 v[52:53], v[48:49], s[54:55] op_sel:[0,0] op_sel_hi:[0,1] neg_lo:[0,0] neg_hi:[0,0]
v_pk_fma_f32 v[52:53], v[48:49], s[54:55], v[52:53] op_sel:[1,1,0] op_sel_hi:[1,0,1] neg_lo:[0,1,0] neg_hi:[0,0,0]
v_pk_add_f32 v[48:49], v[22:23], v[54:55] neg_lo:[0,1] neg_hi:[0,1]
v_pk_add_f32 v[22:23], v[22:23], v[54:55]
v_pk_mul_f32 v[54:55], v[48:49], s[58:59] op_sel:[0,0] op_sel_hi:[0,1] neg_lo:[0,0] neg_hi:[0,0]
v_pk_fma_f32 v[54:55], v[48:49], s[58:59], v[54:55] op_sel:[1,1,0] op_sel_hi:[1,0,1] neg_lo:[0,1,0] neg_hi:[0,0,0]
v_pk_add_f32 v[48:49], v[24:25], v[56:57] neg_lo:[0,1] neg_hi:[0,1]
v_pk_add_f32 v[24:25], v[24:25], v[56:57]
v_pk_mul_f32 v[56:57], v[48:49], s[62:63] op_sel:[0,0] op_sel_hi:[0,1] neg_lo:[0,0] neg_hi:[0,0]
v_pk_fma_f32 v[56:57], v[48:49], s[62:63], v[56:57] op_sel:[1,1,0] op_sel_hi:[1,0,1] neg_lo:[0,1,0] neg_hi:[0,0,0]
v_pk_add_f32 v[48:49], v[26:27], v[58:59] neg_lo:[0,1] neg_hi:[0,1]
v_pk_add_f32 v[26:27], v[26:27], v[58:59]
v_pk_mul_f32 v[58:59], v[48:49], s[58:59] op_sel:[0,1] op_sel_hi:[0,0] neg_lo:[0,0] neg_hi:[0,0]
v_pk_fma_f32 v[58:59], v[48:49], s[58:59], v[58:59] op_sel:[1,0,0] op_sel_hi:[1,1,1] neg_lo:[0,1,0] neg_hi:[0,0,0]
v_pk_add_f32 v[48:49], v[28:29], v[60:61] neg_lo:[0,1] neg_hi:[0,1]
v_pk_add_f32 v[28:29], v[28:29], v[60:61]
v_pk_mul_f32 v[60:61], v[48:49], s[54:55] op_sel:[0,1] op_sel_hi:[0,0] neg_lo:[0,0] neg_hi:[0,0]
v_pk_fma_f32 v[60:61], v[48:49], s[54:55], v[60:61] op_sel:[1,0,0] op_sel_hi:[1,1,1] neg_lo:[0,1,0] neg_hi:[0,0,0]
v_pk_add_f32 v[48:49], v[30:31], v[62:63] neg_lo:[0,1] neg_hi:[0,1]
v_pk_add_f32 v[30:31], v[30:31], v[62:63]
v_pk_mul_f32 v[62:63], v[48:49], s[50:51] op_sel:[0,1] op_sel_hi:[0,0] neg_lo:[0,0] neg_hi:[0,0]
v_pk_fma_f32 v[62:63], v[48:49], s[50:51], v[62:63] op_sel:[1,0,0] op_sel_hi:[1,1,1] neg_lo:[0,1,0] neg_hi:[0,0,0]
v_pk_add_f32 v[48:49], v[32:33], v[64:65] op_sel:[1,1] op_sel_hi:[0,0] neg_lo:[1,0] neg_hi:[0,1]
v_pk_add_f32 v[32:33], v[32:33], v[64:65]
v_pk_add_f32 v[64:65], v[34:35], v[66:67] neg_lo:[0,1] neg_hi:[0,1]
v_pk_add_f32 v[34:35], v[34:35], v[66:67]
v_pk_mul_f32 v[66:67], v[64:65], s[50:51] op_sel:[0,1] op_sel_hi:[0,0] neg_lo:[0,1] neg_hi:[0,0]
v_pk_fma_f32 v[66:67], v[64:65], s[50:51], v[66:67] op_sel:[1,0,0] op_sel_hi:[1,1,1] neg_lo:[0,1,0] neg_hi:[0,1,0]
v_pk_add_f32 v[64:65], v[36:37], v[68:69] neg_lo:[0,1] neg_hi:[0,1]
v_pk_add_f32 v[36:37], v[36:37], v[68:69]
v_pk_mul_f32 v[68:69], v[64:65], s[54:55] op_sel:[0,1] op_sel_hi:[0,0] neg_lo:[0,1] neg_hi:[0,0]
v_pk_fma_f32 v[68:69], v[64:65], s[54:55], v[68:69] op_sel:[1,0,0] op_sel_hi:[1,1,1] neg_lo:[0,1,0] neg_hi:[0,1,0]
v_pk_add_f32 v[64:65], v[38:39], v[70:71] neg_lo:[0,1] neg_hi:[0,1]
v_pk_add_f32 v[38:39], v[38:39], v[70:71]
v_pk_mul_f32 v[70:71], v[64:65], s[58:59] op_sel:[0,1] op_sel_hi:[0,0] neg_lo:[0,1] neg_hi:[0,0]
v_pk_fma_f32 v[70:71], v[64:65], s[58:59], v[70:71] op_sel:[1,0,0] op_sel_hi:[1,1,1] neg_lo:[0,1,0] neg_hi:[0,1,0]
v_pk_add_f32 v[64:65], v[40:41], v[72:73] neg_lo:[0,1] neg_hi:[0,1]
v_pk_add_f32 v[40:41], v[40:41], v[72:73]
v_pk_mul_f32 v[72:73], v[64:65], s[62:63] op_sel:[0,0] op_sel_hi:[0,1] neg_lo:[0,1] neg_hi:[0,0]
v_pk_fma_f32 v[72:73], v[64:65], s[62:63], v[72:73] op_sel:[1,1,0] op_sel_hi:[1,0,1] neg_lo:[0,1,0] neg_hi:[0,1,0]
v_pk_add_f32 v[64:65], v[42:43], v[74:75] neg_lo:[0,1] neg_hi:[0,1]
v_pk_add_f32 v[42:43], v[42:43], v[74:75]
v_pk_mul_f32 v[74:75], v[64:65], s[58:59] op_sel:[0,0] op_sel_hi:[0,1] neg_lo:[0,1] neg_hi:[0,0]
v_pk_fma_f32 v[74:75], v[64:65], s[58:59], v[74:75] op_sel:[1,1,0] op_sel_hi:[1,0,1] neg_lo:[0,1,0] neg_hi:[0,1,0]
v_pk_add_f32 v[64:65], v[44:45], v[76:77] neg_lo:[0,1] neg_hi:[0,1]
v_pk_add_f32 v[44:45], v[44:45], v[76:77]
v_pk_mul_f32 v[76:77], v[64:65], s[54:55] op_sel:[0,0] op_sel_hi:[0,1] neg_lo:[0,1] neg_hi:[0,0]
v_pk_fma_f32 v[76:77], v[64:65], s[54:55], v[76:77] op_sel:[1,1,0] op_sel_hi:[1,0,1] neg_lo:[0,1,0] neg_hi:[0,1,0]
v_pk_add_f32 v[64:65], v[46:47], v[78:79] neg_lo:[0,1] neg_hi:[0,1]
v_pk_add_f32 v[46:47], v[46:47], v[78:79]
v_pk_mul_f32 v[78:79], v[64:65], s[50:51] op_sel:[0,0] op_sel_hi:[0,1] neg_lo:[0,1] neg_hi:[0,0]
v_pk_fma_f32 v[78:79], v[64:65], s[50:51], v[78:79] op_sel:[1,1,0] op_sel_hi:[1,0,1] neg_lo:[0,1,0] neg_hi:[0,1,0]
v_pk_add_f32 v[64:65], v[16:17], v[32:33] neg_lo:[0,1] neg_hi:[0,1]
v_pk_add_f32 v[16:17], v[16:17], v[32:33]
v_pk_add_f32 v[32:33], v[18:19], v[34:35] neg_lo:[0,1] neg_hi:[0,1]
v_pk_add_f32 v[18:19], v[18:19], v[34:35]
v_pk_mul_f32 v[34:35], v[32:33], s[54:55] op_sel:[0,0] op_sel_hi:[0,1] neg_lo:[0,0] neg_hi:[0,0]
v_pk_fma_f32 v[34:35], v[32:33], s[54:55], v[34:35] op_sel:[1,1,0] op_sel_hi:[1,0,1] neg_lo:[0,1,0] neg_hi:[0,0,0]
v_pk_add_f32 v[32:33], v[20:21], v[36:37] neg_lo:[0,1] neg_hi:[0,1]
v_pk_add_f32 v[20:21], v[20:21], v[36:37]
v_pk_mul_f32 v[36:37], v[32:33], s[62:63] op_sel:[0,0] op_sel_hi:[0,1] neg_lo:[0,0] neg_hi:[0,0]
v_pk_fma_f32 v[36:37], v[32:33], s[62:63], v[36:37] op_sel:[1,1,0] op_sel_hi:[1,0,1] neg_lo:[0,1,0] neg_hi:[0,0,0]
v_pk_add_f32 v[32:33], v[22:23], v[38:39] neg_lo:[0,1] neg_hi:[0,1]
v_pk_add_f32 v[22:23], v[22:23], v[38:39]
v_pk_mul_f32 v[38:39], v[32:33], s[54:55] op_sel:[0,1] op_sel_hi:[0,0] neg_lo:[0,0] neg_hi:[0,0]
v_pk_fma_f32 v[38:39], v[32:33], s[54:55], v[38:39] op_sel:[1,0,0] op_sel_hi:[1,1,1] neg_lo:[0,1,0] neg_hi:[0,0,0]
v_pk_add_f32 v[32:33], v[24:25], v[40:41] op_sel:[1,1] op_sel_hi:[0,0] neg_lo:[1,0] neg_hi:[0,1]
v_pk_add_f32 v[24:25], v[24:25], v[40:41]
v_pk_add_f32 v[40:41], v[26:27], v[42:43] neg_lo:[0,1] neg_hi:[0,1]
v_pk_add_f32 v[26:27], v[26:27], v[42:43]
v_pk_mul_f32 v[42:43], v[40:41], s[54:55] op_sel:[0,1] op_sel_hi:[0,0] neg_lo:[0,1] neg_hi:[0,0]
v_pk_fma_f32 v[42:43], v[40:41], s[54:55], v[42:43] op_sel:[1,0,0] op_sel_hi:[1,1,1] neg_lo:[0,1,0] neg_hi:[0,1,0]
v_pk_add_f32 v[40:41], v[28:29], v[44:45] neg_lo:[0,1] neg_hi:[0,1]
v_pk_add_f32 v[28:29], v[28:29], v[44:45]
v_pk_mul_f32 v[44:45], v[40:41], s[62:63] op_sel:[0,0] op_sel_hi:[0,1] neg_lo:[0,1] neg_hi:[0,0]
v_pk_fma_f32 v[44:45], v[40:41], s[62:63], v[44:45] op_sel:[1,1,0] op_sel_hi:[1,0,1] neg_lo:[0,1,0] neg_hi:[0,1,0]
v_pk_add_f32 v[40:41], v[30:31], v[46:47] neg_lo:[0,1] neg_hi:[0,1]
v_pk_add_f32 v[30:31], v[30:31], v[46:47]
v_pk_mul_f32 v[46:47], v[40:41], s[54:55] op_sel:[0,0] op_sel_hi:[0,1] neg_lo:[0,1] neg_hi:[0,0]
v_pk_fma_f32 v[46:47], v[40:41], s[54:55], v[46:47] op_sel:[1,1,0] op_sel_hi:[1,0,1] neg_lo:[0,1,0] neg_hi:[0,1,0]
v_pk_add_f32 v[40:41], v[14:15], v[48:49] neg_lo:[0,1] neg_hi:[0,1]
v_pk_add_f32 v[14:15], v[14:15], v[48:49]
v_pk_add_f32 v[48:49], v[50:51], v[66:67] neg_lo:[0,1] neg_hi:[0,1]
v_pk_add_f32 v[50:51], v[50:51], v[66:67]
v_pk_mul_f32 v[66:67], v[48:49], s[54:55] op_sel:[0,0] op_sel_hi:[0,1] neg_lo:[0,0] neg_hi:[0,0]
v_pk_fma_f32 v[66:67], v[48:49], s[54:55], v[66:67] op_sel:[1,1,0] op_sel_hi:[1,0,1] neg_lo:[0,1,0] neg_hi:[0,0,0]
v_pk_add_f32 v[48:49], v[52:53], v[68:69] neg_lo:[0,1] neg_hi:[0,1]
v_pk_add_f32 v[52:53], v[52:53], v[68:69]
v_pk_mul_f32 v[68:69], v[48:49], s[62:63] op_sel:[0,0] op_sel_hi:[0,1] neg_lo:[0,0] neg_hi:[0,0]
v_pk_fma_f32 v[68:69], v[48:49], s[62:63], v[68:69] op_sel:[1,1,0] op_sel_hi:[1,0,1] neg_lo:[0,1,0] neg_hi:[0,0,0]
v_pk_add_f32 v[48:49], v[54:55], v[70:71] neg_lo:[0,1] neg_hi:[0,1]
v_pk_add_f32 v[54:55], v[54:55], v[70:71]
v_pk_mul_f32 v[70:71], v[48:49], s[54:55] op_sel:[0,1] op_sel_hi:[0,0] neg_lo:[0,0] neg_hi:[0,0]
v_pk_fma_f32 v[70:71], v[48:49], s[54:55], v[70:71] op_sel:[1,0,0] op_sel_hi:[1,1,1] neg_lo:[0,1,0] neg_hi:[0,0,0]
v_pk_add_f32 v[48:49], v[56:57], v[72:73] op_sel:[1,1] op_sel_hi:[0,0] neg_lo:[1,0] neg_hi:[0,1]
v_pk_add_f32 v[56:57], v[56:57], v[72:73]
v_pk_add_f32 v[72:73], v[58:59], v[74:75] neg_lo:[0,1] neg_hi:[0,1]
v_pk_add_f32 v[58:59], v[58:59], v[74:75]
v_pk_mul_f32 v[74:75], v[72:73], s[54:55] op_sel:[0,1] op_sel_hi:[0,0] neg_lo:[0,1] neg_hi:[0,0]
v_pk_fma_f32 v[74:75], v[72:73], s[54:55], v[74:75] op_sel:[1,0,0] op_sel_hi:[1,1,1] neg_lo:[0,1,0] neg_hi:[0,1,0]
v_pk_add_f32 v[72:73], v[60:61], v[76:77] neg_lo:[0,1] neg_hi:[0,1]
v_pk_add_f32 v[60:61], v[60:61], v[76:77]
v_pk_mul_f32 v[76:77], v[72:73], s[62:63] op_sel:[0,0] op_sel_hi:[0,1] neg_lo:[0,1] neg_hi:[0,0]
v_pk_fma_f32 v[76:77], v[72:73], s[62:63], v[76:77] op_sel:[1,1,0] op_sel_hi:[1,0,1] neg_lo:[0,1,0] neg_hi:[0,1,0]
v_pk_add_f32 v[72:73], v[62:63], v[78:79] neg_lo:[0,1] neg_hi:[0,1]
v_pk_add_f32 v[62:63], v[62:63], v[78:79]
v_pk_mul_f32 v[78:79], v[72:73], s[54:55] op_sel:[0,0] op_sel_hi:[0,1] neg_lo:[0,1] neg_hi:[0,0]
v_pk_fma_f32 v[78:79], v[72:73], s[54:55], v[78:79] op_sel:[1,1,0] op_sel_hi:[1,0,1] neg_lo:[0,1,0] neg_hi:[0,1,0]
v_pk_add_f32 v[72:73], v[16:17], v[24:25] neg_lo:[0,1] neg_hi:[0,1]
v_pk_add_f32 v[16:17], v[16:17], v[24:25]
v_pk_add_f32 v[24:25], v[18:19], v[26:27] neg_lo:[0,1] neg_hi:[0,1]
v_pk_add_f32 v[18:19], v[18:19], v[26:27]
v_pk_mul_f32 v[26:27], v[24:25], s[62:63] op_sel:[0,0] op_sel_hi:[0,1] neg_lo:[0,0] neg_hi:[0,0]
v_pk_fma_f32 v[26:27], v[24:25], s[62:63], v[26:27] op_sel:[1,1,0] op_sel_hi:[1,0,1] neg_lo:[0,1,0] neg_hi:[0,0,0]
v_pk_add_f32 v[24:25], v[20:21], v[28:29] op_sel:[1,1] op_sel_hi:[0,0] neg_lo:[1,0] neg_hi:[0,1]
v_pk_add_f32 v[20:21], v[20:21], v[28:29]
v_pk_add_f32 v[28:29], v[22:23], v[30:31] neg_lo:[0,1] neg_hi:[0,1]
v_pk_add_f32 v[22:23], v[22:23], v[30:31]
v_pk_mul_f32 v[30:31], v[28:29], s[62:63] op_sel:[0,0] op_sel_hi:[0,1] neg_lo:[0,1] neg_hi:[0,0]
v_pk_fma_f32 v[30:31], v[28:29], s[62:63], v[30:31] op_sel:[1,1,0] op_sel_hi:[1,0,1] neg_lo:[0,1,0] neg_hi:[0,1,0]
v_pk_add_f32 v[28:29], v[64:65], v[32:33] neg_lo:[0,1] neg_hi:[0,1]
v_pk_add_f32 v[64:65], v[64:65], v[32:33]
v_pk_add_f32 v[32:33], v[34:35], v[42:43] neg_lo:[0,1] neg_hi:[0,1]
v_pk_add_f32 v[34:35], v[34:35], v[42:43]
v_pk_mul_f32 v[42:43], v[32:33], s[62:63] op_sel:[0,0] op_sel_hi:[0,1] neg_lo:[0,0] neg_hi:[0,0]
v_pk_fma_f32 v[42:43], v[32:33], s[62:63], v[42:43] op_sel:[1,1,0] op_sel_hi:[1,0,1] neg_lo:[0,1,0] neg_hi:[0,0,0]
v_pk_add_f32 v[32:33], v[36:37], v[44:45] op_sel:[1,1] op_sel_hi:[0,0] neg_lo:[1,0] neg_hi:[0,1]
v_pk_add_f32 v[36:37], v[36:37], v[44:45]
v_pk_add_f32 v[44:45], v[38:39], v[46:47] neg_lo:[0,1] neg_hi:[0,1]
v_pk_add_f32 v[38:39], v[38:39], v[46:47]
v_pk_mul_f32 v[46:47], v[44:45], s[62:63] op_sel:[0,0] op_sel_hi:[0,1] neg_lo:[0,1] neg_hi:[0,0]
v_pk_fma_f32 v[46:47], v[44:45], s[62:63], v[46:47] op_sel:[1,1,0] op_sel_hi:[1,0,1] neg_lo:[0,1,0] neg_hi:[0,1,0]
v_pk_add_f32 v[44:45], v[14:15], v[56:57] neg_lo:[0,1] neg_hi:[0,1]
v_pk_add_f32 v[14:15], v[14:15], v[56:57]
v_pk_add_f32 v[56:57], v[50:51], v[58:59] neg_lo:[0,1] neg_hi:[0,1]
v_pk_add_f32 v[50:51], v[50:51], v[58:59]
v_pk_mul_f32 v[58:59], v[56:57], s[62:63] op_sel:[0,0] op_sel_hi:[0,1] neg_lo:[0,0] neg_hi:[0,0]
v_pk_fma_f32 v[58:59], v[56:57], s[62:63], v[58:59] op_sel:[1,1,0] op_sel_hi:[1,0,1] neg_lo:[0,1,0] neg_hi:[0,0,0]
v_pk_add_f32 v[56:57], v[52:53], v[60:61] op_sel:[1,1] op_sel_hi:[0,0] neg_lo:[1,0] neg_hi:[0,1]
v_pk_add_f32 v[52:53], v[52:53], v[60:61]
v_pk_add_f32 v[60:61], v[54:55], v[62:63] neg_lo:[0,1] neg_hi:[0,1]
v_pk_add_f32 v[54:55], v[54:55], v[62:63]
v_pk_mul_f32 v[62:63], v[60:61], s[62:63] op_sel:[0,0] op_sel_hi:[0,1] neg_lo:[0,1] neg_hi:[0,0]
v_pk_fma_f32 v[62:63], v[60:61], s[62:63], v[62:63] op_sel:[1,1,0] op_sel_hi:[1,0,1] neg_lo:[0,1,0] neg_hi:[0,1,0]
v_pk_add_f32 v[60:61], v[40:41], v[48:49] neg_lo:[0,1] neg_hi:[0,1]
v_pk_add_f32 v[40:41], v[40:41], v[48:49]
v_pk_add_f32 v[48:49], v[66:67], v[74:75] neg_lo:[0,1] neg_hi:[0,1]
v_pk_add_f32 v[66:67], v[66:67], v[74:75]
v_pk_mul_f32 v[74:75], v[48:49], s[62:63] op_sel:[0,0] op_sel_hi:[0,1] neg_lo:[0,0] neg_hi:[0,0]
v_pk_fma_f32 v[74:75], v[48:49], s[62:63], v[74:75] op_sel:[1,1,0] op_sel_hi:[1,0,1] neg_lo:[0,1,0] neg_hi:[0,0,0]
v_pk_add_f32 v[48:49], v[68:69], v[76:77] op_sel:[1,1] op_sel_hi:[0,0] neg_lo:[1,0] neg_hi:[0,1]
v_pk_add_f32 v[68:69], v[68:69], v[76:77]
v_pk_add_f32 v[76:77], v[70:71], v[78:79] neg_lo:[0,1] neg_hi:[0,1]
v_pk_add_f32 v[70:71], v[70:71], v[78:79]
v_pk_mul_f32 v[78:79], v[76:77], s[62:63] op_sel:[0,0] op_sel_hi:[0,1] neg_lo:[0,1] neg_hi:[0,0]
v_pk_fma_f32 v[78:79], v[76:77], s[62:63], v[78:79] op_sel:[1,1,0] op_sel_hi:[1,0,1] neg_lo:[0,1,0] neg_hi:[0,1,0]
v_pk_add_f32 v[76:77], v[16:17], v[20:21] neg_lo:[0,1] neg_hi:[0,1]
v_pk_add_f32 v[16:17], v[16:17], v[20:21]
v_pk_add_f32 v[20:21], v[18:19], v[22:23] op_sel:[1,1] op_sel_hi:[0,0] neg_lo:[1,0] neg_hi:[0,1]
v_pk_add_f32 v[18:19], v[18:19], v[22:23]
v_pk_add_f32 v[22:23], v[72:73], v[24:25] neg_lo:[0,1] neg_hi:[0,1]
v_pk_add_f32 v[72:73], v[72:73], v[24:25]
v_pk_add_f32 v[24:25], v[26:27], v[30:31] op_sel:[1,1] op_sel_hi:[0,0] neg_lo:[1,0] neg_hi:[0,1]
v_pk_add_f32 v[26:27], v[26:27], v[30:31]
v_pk_add_f32 v[30:31], v[64:65], v[36:37] neg_lo:[0,1] neg_hi:[0,1]
v_pk_add_f32 v[64:65], v[64:65], v[36:37]
v_pk_add_f32 v[36:37], v[34:35], v[38:39] op_sel:[1,1] op_sel_hi:[0,0] neg_lo:[1,0] neg_hi:[0,1]
v_pk_add_f32 v[34:35], v[34:35], v[38:39]
v_pk_add_f32 v[38:39], v[28:29], v[32:33] neg_lo:[0,1] neg_hi:[0,1]
v_pk_add_f32 v[28:29], v[28:29], v[32:33]
v_pk_add_f32 v[32:33], v[42:43], v[46:47] op_sel:[1,1] op_sel_hi:[0,0] neg_lo:[1,0] neg_hi:[0,1]
v_pk_add_f32 v[42:43], v[42:43], v[46:47]
v_pk_add_f32 v[46:47], v[14:15], v[52:53] neg_lo:[0,1] neg_hi:[0,1]
v_pk_add_f32 v[14:15], v[14:15], v[52:53]
v_pk_add_f32 v[52:53], v[50:51], v[54:55] op_sel:[1,1] op_sel_hi:[0,0] neg_lo:[1,0] neg_hi:[0,1]
v_pk_add_f32 v[50:51], v[50:51], v[54:55]
v_pk_add_f32 v[54:55], v[44:45], v[56:57] neg_lo:[0,1] neg_hi:[0,1]
v_pk_add_f32 v[44:45], v[44:45], v[56:57]
v_pk_add_f32 v[56:57], v[58:59], v[62:63] op_sel:[1,1] op_sel_hi:[0,0] neg_lo:[1,0] neg_hi:[0,1]
v_pk_add_f32 v[58:59], v[58:59], v[62:63]
v_pk_add_f32 v[62:63], v[40:41], v[68:69] neg_lo:[0,1] neg_hi:[0,1]
v_pk_add_f32 v[40:41], v[40:41], v[68:69]
v_pk_add_f32 v[68:69], v[66:67], v[70:71] op_sel:[1,1] op_sel_hi:[0,0] neg_lo:[1,0] neg_hi:[0,1]
v_pk_add_f32 v[66:67], v[66:67], v[70:71]
v_pk_add_f32 v[70:71], v[60:61], v[48:49] neg_lo:[0,1] neg_hi:[0,1]
v_pk_add_f32 v[60:61], v[60:61], v[48:49]
v_pk_add_f32 v[48:49], v[74:75], v[78:79] op_sel:[1,1] op_sel_hi:[0,0] neg_lo:[1,0] neg_hi:[0,1]
v_pk_add_f32 v[74:75], v[74:75], v[78:79]
v_pk_add_f32 v[78:79], v[16:17], v[18:19] neg_lo:[0,1] neg_hi:[0,1]
v_pk_add_f32 v[16:17], v[16:17], v[18:19]
v_pk_add_f32 v[18:19], v[76:77], v[20:21] neg_lo:[0,1] neg_hi:[0,1]
v_pk_add_f32 v[76:77], v[76:77], v[20:21]
v_pk_add_f32 v[20:21], v[72:73], v[26:27] neg_lo:[0,1] neg_hi:[0,1]
v_pk_add_f32 v[72:73], v[72:73], v[26:27]
v_pk_add_f32 v[26:27], v[22:23], v[24:25] neg_lo:[0,1] neg_hi:[0,1]
v_pk_add_f32 v[22:23], v[22:23], v[24:25]
v_pk_add_f32 v[24:25], v[64:65], v[34:35] neg_lo:[0,1] neg_hi:[0,1]
v_pk_add_f32 v[64:65], v[64:65], v[34:35]
v_pk_add_f32 v[34:35], v[30:31], v[36:37] neg_lo:[0,1] neg_hi:[0,1]
v_pk_add_f32 v[30:31], v[30:31], v[36:37]
v_pk_add_f32 v[36:37], v[28:29], v[42:43] neg_lo:[0,1] neg_hi:[0,1]
v_pk_add_f32 v[28:29], v[28:29], v[42:43]
v_pk_add_f32 v[42:43], v[38:39], v[32:33] neg_lo:[0,1] neg_hi:[0,1]
v_pk_add_f32 v[38:39], v[38:39], v[32:33]
v_pk_add_f32 v[32:33], v[14:15], v[50:51] neg_lo:[0,1] neg_hi:[0,1]
v_pk_add_f32 v[14:15], v[14:15], v[50:51]
v_pk_add_f32 v[50:51], v[46:47], v[52:53] neg_lo:[0,1] neg_hi:[0,1]
v_pk_add_f32 v[46:47], v[46:47], v[52:53]
v_pk_add_f32 v[52:53], v[44:45], v[58:59] neg_lo:[0,1] neg_hi:[0,1]
v_pk_add_f32 v[44:45], v[44:45], v[58:59]
v_pk_add_f32 v[58:59], v[54:55], v[56:57] neg_lo:[0,1] neg_hi:[0,1]
v_pk_add_f32 v[54:55], v[54:55], v[56:57]
v_pk_add_f32 v[56:57], v[40:41], v[66:67] neg_lo:[0,1] neg_hi:[0,1]
v_pk_add_f32 v[40:41], v[40:41], v[66:67]
v_pk_add_f32 v[66:67], v[62:63], v[68:69] neg_lo:[0,1] neg_hi:[0,1]
v_pk_add_f32 v[62:63], v[62:63], v[68:69]
v_pk_add_f32 v[68:69], v[60:61], v[74:75] neg_lo:[0,1] neg_hi:[0,1]
v_pk_add_f32 v[60:61], v[60:61], v[74:75]
v_pk_add_f32 v[74:75], v[70:71], v[48:49] neg_lo:[0,1] neg_hi:[0,1]
v_pk_add_f32 v[70:71], v[70:71], v[48:49]
ds_write2st64_b32 v12, v16, v17 offset0:0 offset1:16
ds_write_b32 v12, v14 offset:128
ds_write_b32 v12, v15 offset:4224
ds_write_b32 v12, v64 offset:256
ds_write_b32 v12, v65 offset:4352
ds_write_b32 v12, v40 offset:384
ds_write_b32 v12, v41 offset:4480
ds_write_b32 v12, v72 offset:512
ds_write_b32 v12, v73 offset:4608
ds_write_b32 v12, v44 offset:640
ds_write_b32 v12, v45 offset:4736
ds_write_b32 v12, v28 offset:768
ds_write_b32 v12, v29 offset:4864
ds_write_b32 v12, v60 offset:896
ds_write_b32 v12, v61 offset:4992
ds_write_b32 v12, v76 offset:1024
ds_write_b32 v12, v77 offset:5120
ds_write_b32 v12, v46 offset:1152
ds_write_b32 v12, v47 offset:5248
ds_write_b32 v12, v30 offset:1280
ds_write_b32 v12, v31 offset:5376
ds_write_b32 v12, v62 offset:1408
ds_write_b32 v12, v63 offset:5504
ds_write_b32 v12, v22 offset:1536
ds_write_b32 v12, v23 offset:5632
ds_write_b32 v12, v54 offset:1664
ds_write_b32 v12, v55 offset:5760
ds_write_b32 v12, v38 offset:1792
ds_write_b32 v12, v39 offset:5888
ds_write_b32 v12, v70 offset:1920
ds_write_b32 v12, v71 offset:6016
ds_write_b32 v12, v78 offset:2048
ds_write_b32 v12, v79 offset:6144
ds_write_b32 v12, v32 offset:2176
ds_write_b32 v12, v33 offset:6272
ds_write_b32 v12, v24 offset:2304
ds_write_b32 v12, v25 offset:6400
ds_write_b32 v12, v56 offset:2432
ds_write_b32 v12, v57 offset:6528
ds_write_b32 v12, v20 offset:2560
ds_write_b32 v12, v21 offset:6656
ds_write_b32 v12, v52 offset:2688
ds_write_b32 v12, v53 offset:6784
ds_write_b32 v12, v36 offset:2816
ds_write_b32 v12, v37 offset:6912
ds_write_b32 v12, v68 offset:2944
ds_write_b32 v12, v69 offset:7040
ds_write_b32 v12, v18 offset:3072
ds_write_b32 v12, v19 offset:7168
ds_write_b32 v12, v50 offset:3200
ds_write_b32 v12, v51 offset:7296
ds_write_b32 v12, v34 offset:3328
ds_write_b32 v12, v35 offset:7424
ds_write_b32 v12, v66 offset:3456
ds_write_b32 v12, v67 offset:7552
ds_write_b32 v12, v26 offset:3584
ds_write_b32 v12, v27 offset:7680
ds_write_b32 v12, v58 offset:3712
ds_write_b32 v12, v59 offset:7808
ds_write_b32 v12, v42 offset:3840
ds_write_b32 v12, v43 offset:7936
ds_write_b32 v12, v74 offset:3968
ds_write_b32 v12, v75 offset:8064
s_waitcnt lgkmcnt(0)
s_barrier
s_lshl_b32 s13, s93, 16
ds_read_b128 v[16:19], v2 offset:0
ds_read_b128 v[20:23], v2 offset:16
ds_read_b128 v[24:27], v2 offset:8448
ds_read_b128 v[28:31], v2 offset:8464
ds_read_b128 v[32:35], v2 offset:16896
ds_read_b128 v[36:39], v2 offset:16912
ds_read_b128 v[40:43], v2 offset:25344
ds_read_b128 v[44:47], v2 offset:25360
ds_read_b128 v[48:51], v2 offset:33792
ds_read_b128 v[52:55], v2 offset:33808
ds_read_b128 v[56:59], v2 offset:42240
ds_read_b128 v[60:63], v2 offset:42256
ds_read_b128 v[64:67], v2 offset:50688
ds_read_b128 v[68:71], v2 offset:50704
s_waitcnt lgkmcnt(12)
ds_read_b128 v[72:75], v2 offset:59136
ds_read_b128 v[76:79], v2 offset:59152
s_waitcnt lgkmcnt(14)
v_cvt_pk_bf16_f32 v216, v16, v17
v_cvt_pk_bf16_f32 v217, v18, v19
v_cvt_pk_bf16_f32 v218, v20, v21
v_cvt_pk_bf16_f32 v219, v22, v23
buffer_store_dwordx4 v[216:219], v3, s[4:7], s13 offen sc1
s_add_u32 s13, s13, 8192
s_waitcnt lgkmcnt(12)
v_cvt_pk_bf16_f32 v220, v24, v25
v_cvt_pk_bf16_f32 v221, v26, v27
v_cvt_pk_bf16_f32 v222, v28, v29
v_cvt_pk_bf16_f32 v223, v30, v31
buffer_store_dwordx4 v[220:223], v3, s[4:7], s13 offen sc1
s_add_u32 s13, s13, 8192
s_waitcnt lgkmcnt(10)
v_cvt_pk_bf16_f32 v224, v32, v33
v_cvt_pk_bf16_f32 v225, v34, v35
v_cvt_pk_bf16_f32 v226, v36, v37
v_cvt_pk_bf16_f32 v227, v38, v39
buffer_store_dwordx4 v[224:227], v3, s[4:7], s13 offen sc1
s_add_u32 s13, s13, 8192
s_waitcnt lgkmcnt(8)
v_cvt_pk_bf16_f32 v228, v40, v41
v_cvt_pk_bf16_f32 v229, v42, v43
v_cvt_pk_bf16_f32 v230, v44, v45
v_cvt_pk_bf16_f32 v231, v46, v47
buffer_store_dwordx4 v[228:231], v3, s[4:7], s13 offen sc1
s_add_u32 s13, s13, 8192
s_waitcnt lgkmcnt(6)
v_cvt_pk_bf16_f32 v232, v48, v49
v_cvt_pk_bf16_f32 v233, v50, v51
v_cvt_pk_bf16_f32 v234, v52, v53
v_cvt_pk_bf16_f32 v235, v54, v55
buffer_store_dwordx4 v[232:235], v3, s[4:7], s13 offen sc1
s_add_u32 s13, s13, 8192
s_waitcnt lgkmcnt(4)
v_cvt_pk_bf16_f32 v236, v56, v57
v_cvt_pk_bf16_f32 v237, v58, v59
v_cvt_pk_bf16_f32 v238, v60, v61
v_cvt_pk_bf16_f32 v239, v62, v63
buffer_store_dwordx4 v[236:239], v3, s[4:7], s13 offen sc1
s_add_u32 s13, s13, 8192
s_waitcnt lgkmcnt(2)
v_cvt_pk_bf16_f32 v240, v64, v65
v_cvt_pk_bf16_f32 v241, v66, v67
v_cvt_pk_bf16_f32 v242, v68, v69
v_cvt_pk_bf16_f32 v243, v70, v71
buffer_store_dwordx4 v[240:243], v3, s[4:7], s13 offen sc1
s_add_u32 s13, s13, 8192
s_waitcnt lgkmcnt(0)
v_cvt_pk_bf16_f32 v244, v72, v73
v_cvt_pk_bf16_f32 v245, v74, v75
v_cvt_pk_bf16_f32 v246, v76, v77
v_cvt_pk_bf16_f32 v247, v78, v79
buffer_store_dwordx4 v[244:247], v3, s[4:7], s13 offen sc1
s_add_u32 s13, s13, 8192
s_mov_b32 s93, s21
s_cmp_lt_u32 s93, 128
s_cbranch_scc1 mega_kernel_f3_l
mega_kernel_f3_e:
s_waitcnt vmcnt(0)
s_barrier
s_mov_b32 s64, 62
s_mov_b32 s65, 63
s_add_u32 s66, s66, 262144
s_mov_b32 s67, 1
s_cmp_eq_u32 s91, 0
s_cbranch_scc1 mega_kernel_out
s_mov_b32 s64, 63
s_mov_b32 s65, 64
s_lshr_b32 s66, s40, 2
s_lshl_b32 s66, s66, 17
s_and_b32 s67, s40, 3
s_lshl_b32 s67, s67, 12
s_add_u32 s66, s66, s67
s_add_u32 s66, s66, 68272128
s_mov_b32 s67, 1
s_mov_b32 s68, 4096
s_mov_b32 s69, 0
mega_kernel_out:
s_load_dwordx2 s[4:5], s[0:1], 40
s_load_dwordx2 s[8:9], s[0:1], 80
v_lshrrev_b32 v2, 6, v0
v_and_b32 v1, 63, v0
v_readfirstlane_b32 s41, v2
v_lshlrev_b32 v5, 4, v1
s_waitcnt lgkmcnt(0)
s_mov_b32 s6, 8388608
s_mov_b32 s7, 0x00020000
s_mov_b32 s10, 8388608
s_mov_b32 s11, 0x00020000
s_and_b32 s58, s40, 1
s_lshr_b32 s59, s40, 1
s_lshl_b32 s43, s58, 22
s_lshl_b32 s44, s41, 20
s_add_u32 s43, s43, s44
s_lshl_b32 s44, s59, 7
s_add_u32 s48, s43, s44
s_and_b32 s56, s59, 7
s_lshl_b32 s56, s56, 6
v_lshrrev_b32 v2, 3, v1
v_and_b32 v3, 7, v1
v_lshlrev_b32 v16, 11, v2
v_lshl_add_u32 v16, v3, 4, v16
v_add_u32 v16, s48, v16
v_and_b32 v3, 3, v1
s_lshl_b32 s45, s41, 15
v_bfe_u32 v17, v1, 2, 2
v_lshrrev_b32 v18, 5, v1
v_mul_u32_u24 v18, 4, v18
v_add_u32 v17, v17, v18
v_lshlrev_b32 v17, 7, v17
v_bfe_u32 v18, v1, 4, 1
v_lshl_add_u32 v17, v18, 5, v17
v_lshl_add_u32 v17, v3, 3, v17
v_add_u32 v17, s45, v17
s_add_u32 m0, s45, 0
s_add_u32 s44, s56, 0
s_and_b32 s44, s44, 511
s_lshl_b32 s44, s44, 11
buffer_load_dwordx4 v16, s[4:7], s44 offen lds
s_add_u32 m0, s45, 1024
s_add_u32 s44, s56, 8
s_and_b32 s44, s44, 511
s_lshl_b32 s44, s44, 11
buffer_load_dwordx4 v16, s[4:7], s44 offen lds
s_add_u32 m0, s45, 2048
s_add_u32 s44, s56, 16
s_and_b32 s44, s44, 511
s_lshl_b32 s44, s44, 11
buffer_load_dwordx4 v16, s[4:7], s44 offen lds
s_add_u32 m0, s45, 3072
s_add_u32 s44, s56, 24
s_and_b32 s44, s44, 511
s_lshl_b32 s44, s44, 11
buffer_load_dwordx4 v16, s[4:7], s44 offen lds
s_add_u32 m0, s45, 4096
s_add_u32 s44, s56, 32
s_and_b32 s44, s44, 511
s_lshl_b32 s44, s44, 11
buffer_load_dwordx4 v16, s[4:7], s44 offen lds
s_add_u32 m0, s45, 5120
s_add_u32 s44, s56, 40
s_and_b32 s44, s44, 511
s_lshl_b32 s44, s44, 11
buffer_load_dwordx4 v16, s[4:7], s44 offen lds
s_add_u32 m0, s45, 6144
s_add_u32 s44, s56, 48
s_and_b32 s44, s44, 511
s_lshl_b32 s44, s44, 11
buffer_load_dwordx4 v16, s[4:7], s44 offen lds
s_add_u32 m0, s45, 7168
s_add_u32 s44, s56, 56
s_and_b32 s44, s44, 511
s_lshl_b32 s44, s44, 11
buffer_load_dwordx4 v16, s[4:7], s44 offen lds
s_add_u32 m0, s45, 8192
s_add_u32 s44, s56, 64
s_and_b32 s44, s44, 511
s_lshl_b32 s44, s44, 11
buffer_load_dwordx4 v16, s[4:7], s44 offen lds
s_add_u32 m0, s45, 9216
s_add_u32 s44, s56, 72
s_and_b32 s44, s44, 511
s_lshl_b32 s44, s44, 11
buffer_load_dwordx4 v16, s[4:7], s44 offen lds
s_add_u32 m0, s45, 10240
s_add_u32 s44, s56, 80
s_and_b32 s44, s44, 511
s_lshl_b32 s44, s44, 11
buffer_load_dwordx4 v16, s[4:7], s44 offen lds
s_add_u32 m0, s45, 11264
s_add_u32 s44, s56, 88
s_and_b32 s44, s44, 511
s_lshl_b32 s44, s44, 11
buffer_load_dwordx4 v16, s[4:7], s44 offen lds
s_add_u32 m0, s45, 12288
s_add_u32 s44, s56, 96
s_and_b32 s44, s44, 511
s_lshl_b32 s44, s44, 11
buffer_load_dwordx4 v16, s[4:7], s44 offen lds
s_add_u32 m0, s45, 13312
s_add_u32 s44, s56, 104
s_and_b32 s44, s44, 511
s_lshl_b32 s44, s44, 11
buffer_load_dwordx4 v16, s[4:7], s44 offen lds
s_add_u32 m0, s45, 14336
s_add_u32 s44, s56, 112
s_and_b32 s44, s44, 511
s_lshl_b32 s44, s44, 11
buffer_load_dwordx4 v16, s[4:7], s44 offen lds
s_add_u32 m0, s45, 15360
s_add_u32 s44, s56, 120
s_and_b32 s44, s44, 511
s_lshl_b32 s44, s44, 11
buffer_load_dwordx4 v16, s[4:7], s44 offen lds
s_add_u32 m0, s45, 16384
s_add_u32 s44, s56, 128
s_and_b32 s44, s44, 511
s_lshl_b32 s44, s44, 11
buffer_load_dwordx4 v16, s[4:7], s44 offen lds
s_add_u32 m0, s45, 17408
s_add_u32 s44, s56, 136
s_and_b32 s44, s44, 511
s_lshl_b32 s44, s44, 11
buffer_load_dwordx4 v16, s[4:7], s44 offen lds
s_add_u32 m0, s45, 18432
s_add_u32 s44, s56, 144
s_and_b32 s44, s44, 511
s_lshl_b32 s44, s44, 11
buffer_load_dwordx4 v16, s[4:7], s44 offen lds
s_add_u32 m0, s45, 19456
s_add_u32 s44, s56, 152
s_and_b32 s44, s44, 511
s_lshl_b32 s44, s44, 11
buffer_load_dwordx4 v16, s[4:7], s44 offen lds
s_add_u32 m0, s45, 20480
s_add_u32 s44, s56, 160
s_and_b32 s44, s44, 511
s_lshl_b32 s44, s44, 11
buffer_load_dwordx4 v16, s[4:7], s44 offen lds
s_add_u32 m0, s45, 21504
s_add_u32 s44, s56, 168
s_and_b32 s44, s44, 511
s_lshl_b32 s44, s44, 11
buffer_load_dwordx4 v16, s[4:7], s44 offen lds
s_add_u32 m0, s45, 22528
s_add_u32 s44, s56, 176
s_and_b32 s44, s44, 511
s_lshl_b32 s44, s44, 11
buffer_load_dwordx4 v16, s[4:7], s44 offen lds
s_add_u32 m0, s45, 23552
s_add_u32 s44, s56, 184
s_and_b32 s44, s44, 511
s_lshl_b32 s44, s44, 11
buffer_load_dwordx4 v16, s[4:7], s44 offen lds
s_add_u32 m0, s45, 24576
s_add_u32 s44, s56, 192
s_and_b32 s44, s44, 511
s_lshl_b32 s44, s44, 11
buffer_load_dwordx4 v16, s[4:7], s44 offen lds
s_add_u32 m0, s45, 25600
s_add_u32 s44, s56, 200
s_and_b32 s44, s44, 511
s_lshl_b32 s44, s44, 11
buffer_load_dwordx4 v16, s[4:7], s44 offen lds
s_add_u32 m0, s45, 26624
s_add_u32 s44, s56, 208
s_and_b32 s44, s44, 511
s_lshl_b32 s44, s44, 11
buffer_load_dwordx4 v16, s[4:7], s44 offen lds
s_add_u32 m0, s45, 27648
s_add_u32 s44, s56, 216
s_and_b32 s44, s44, 511
s_lshl_b32 s44, s44, 11
buffer_load_dwordx4 v16, s[4:7], s44 offen lds
s_add_u32 m0, s45, 28672
s_add_u32 s44, s56, 224
s_and_b32 s44, s44, 511
s_lshl_b32 s44, s44, 11
buffer_load_dwordx4 v16, s[4:7], s44 offen lds
s_add_u32 m0, s45, 29696
s_add_u32 s44, s56, 232
s_and_b32 s44, s44, 511
s_lshl_b32 s44, s44, 11
buffer_load_dwordx4 v16, s[4:7], s44 offen lds
s_add_u32 m0, s45, 30720
s_add_u32 s44, s56, 240
s_and_b32 s44, s44, 511
s_lshl_b32 s44, s44, 11
buffer_load_dwordx4 v16, s[4:7], s44 offen lds
s_add_u32 m0, s45, 31744
s_add_u32 s44, s56, 248
s_and_b32 s44, s44, 511
s_lshl_b32 s44, s44, 11
buffer_load_dwordx4 v16, s[4:7], s44 offen lds
s_waitcnt vmcnt(16)
ds_read_b64_tr_b16 a[0:1], v17 offset:0
ds_read_b64_tr_b16 a[2:3], v17 offset:2048
ds_read_b64_tr_b16 a[4:5], v17 offset:64
ds_read_b64_tr_b16 a[6:7], v17 offset:2112
ds_read_b64_tr_b16 a[8:9], v17 offset:1024
ds_read_b64_tr_b16 a[10:11], v17 offset:3072
ds_read_b64_tr_b16 a[12:13], v17 offset:1088
ds_read_b64_tr_b16 a[14:15], v17 offset:3136
s_waitcnt lgkmcnt(0)
ds_read_b64_tr_b16 a[16:17], v17 offset:4096
ds_read_b64_tr_b16 a[18:19], v17 offset:6144
ds_read_b64_tr_b16 a[20:21], v17 offset:4160
ds_read_b64_tr_b16 a[22:23], v17 offset:6208
ds_read_b64_tr_b16 a[24:25], v17 offset:5120
ds_read_b64_tr_b16 a[26:27], v17 offset:7168
ds_read_b64_tr_b16 a[28:29], v17 offset:5184
ds_read_b64_tr_b16 a[30:31], v17 offset:7232
s_waitcnt lgkmcnt(0)
ds_read_b64_tr_b16 a[32:33], v17 offset:8192
ds_read_b64_tr_b16 a[34:35], v17 offset:10240
ds_read_b64_tr_b16 a[36:37], v17 offset:8256
ds_read_b64_tr_b16 a[38:39], v17 offset:10304
ds_read_b64_tr_b16 a[40:41], v17 offset:9216
ds_read_b64_tr_b16 a[42:43], v17 offset:11264
ds_read_b64_tr_b16 a[44:45], v17 offset:9280
ds_read_b64_tr_b16 a[46:47], v17 offset:11328
s_waitcnt lgkmcnt(0)
ds_read_b64_tr_b16 a[48:49], v17 offset:12288
ds_read_b64_tr_b16 a[50:51], v17 offset:14336
ds_read_b64_tr_b16 a[52:53], v17 offset:12352
ds_read_b64_tr_b16 a[54:55], v17 offset:14400
ds_read_b64_tr_b16 a[56:57], v17 offset:13312
ds_read_b64_tr_b16 a[58:59], v17 offset:15360
ds_read_b64_tr_b16 a[60:61], v17 offset:13376
ds_read_b64_tr_b16 a[62:63], v17 offset:15424
s_waitcnt lgkmcnt(0)
s_add_u32 m0, s45, 0
s_add_u32 s44, s56, 256
s_and_b32 s44, s44, 511
s_lshl_b32 s44, s44, 11
buffer_load_dwordx4 v16, s[4:7], s44 offen lds
s_add_u32 m0, s45, 1024
s_add_u32 s44, s56, 264
s_and_b32 s44, s44, 511
s_lshl_b32 s44, s44, 11
buffer_load_dwordx4 v16, s[4:7], s44 offen lds
s_add_u32 m0, s45, 2048
s_add_u32 s44, s56, 272
s_and_b32 s44, s44, 511
s_lshl_b32 s44, s44, 11
buffer_load_dwordx4 v16, s[4:7], s44 offen lds
s_add_u32 m0, s45, 3072
s_add_u32 s44, s56, 280
s_and_b32 s44, s44, 511
s_lshl_b32 s44, s44, 11
buffer_load_dwordx4 v16, s[4:7], s44 offen lds
s_add_u32 m0, s45, 4096
s_add_u32 s44, s56, 288
s_and_b32 s44, s44, 511
s_lshl_b32 s44, s44, 11
buffer_load_dwordx4 v16, s[4:7], s44 offen lds
s_add_u32 m0, s45, 5120
s_add_u32 s44, s56, 296
s_and_b32 s44, s44, 511
s_lshl_b32 s44, s44, 11
buffer_load_dwordx4 v16, s[4:7], s44 offen lds
s_add_u32 m0, s45, 6144
s_add_u32 s44, s56, 304
s_and_b32 s44, s44, 511
s_lshl_b32 s44, s44, 11
buffer_load_dwordx4 v16, s[4:7], s44 offen lds
s_add_u32 m0, s45, 7168
s_add_u32 s44, s56, 312
s_and_b32 s44, s44, 511
s_lshl_b32 s44, s44, 11
buffer_load_dwordx4 v16, s[4:7], s44 offen lds
s_add_u32 m0, s45, 8192
s_add_u32 s44, s56, 320
s_and_b32 s44, s44, 511
s_lshl_b32 s44, s44, 11
buffer_load_dwordx4 v16, s[4:7], s44 offen lds
s_add_u32 m0, s45, 9216
s_add_u32 s44, s56, 328
s_and_b32 s44, s44, 511
s_lshl_b32 s44, s44, 11
buffer_load_dwordx4 v16, s[4:7], s44 offen lds
s_add_u32 m0, s45, 10240
s_add_u32 s44, s56, 336
s_and_b32 s44, s44, 511
s_lshl_b32 s44, s44, 11
buffer_load_dwordx4 v16, s[4:7], s44 offen lds
s_add_u32 m0, s45, 11264
s_add_u32 s44, s56, 344
s_and_b32 s44, s44, 511
s_lshl_b32 s44, s44, 11
buffer_load_dwordx4 v16, s[4:7], s44 offen lds
s_add_u32 m0, s45, 12288
s_add_u32 s44, s56, 352
s_and_b32 s44, s44, 511
s_lshl_b32 s44, s44, 11
buffer_load_dwordx4 v16, s[4:7], s44 offen lds
s_add_u32 m0, s45, 13312
s_add_u32 s44, s56, 360
s_and_b32 s44, s44, 511
s_lshl_b32 s44, s44, 11
buffer_load_dwordx4 v16, s[4:7], s44 offen lds
s_add_u32 m0, s45, 14336
s_add_u32 s44, s56, 368
s_and_b32 s44, s44, 511
s_lshl_b32 s44, s44, 11
buffer_load_dwordx4 v16, s[4:7], s44 offen lds
s_add_u32 m0, s45, 15360
s_add_u32 s44, s56, 376
s_and_b32 s44, s44, 511
s_lshl_b32 s44, s44, 11
buffer_load_dwordx4 v16, s[4:7], s44 offen lds
s_waitcnt vmcnt(16)
ds_read_b64_tr_b16 a[64:65], v17 offset:16384
ds_read_b64_tr_b16 a[66:67], v17 offset:18432
ds_read_b64_tr_b16 a[68:69], v17 offset:16448
ds_read_b64_tr_b16 a[70:71], v17 offset:18496
ds_read_b64_tr_b16 a[72:73], v17 offset:17408
ds_read_b64_tr_b16 a[74:75], v17 offset:19456
ds_read_b64_tr_b16 a[76:77], v17 offset:17472
ds_read_b64_tr_b16 a[78:79], v17 offset:19520
s_waitcnt lgkmcnt(0)
ds_read_b64_tr_b16 a[80:81], v17 offset:20480
ds_read_b64_tr_b16 a[82:83], v17 offset:22528
ds_read_b64_tr_b16 a[84:85], v17 offset:20544
ds_read_b64_tr_b16 a[86:87], v17 offset:22592
ds_read_b64_tr_b16 a[88:89], v17 offset:21504
ds_read_b64_tr_b16 a[90:91], v17 offset:23552
ds_read_b64_tr_b16 a[92:93], v17 offset:21568
ds_read_b64_tr_b16 a[94:95], v17 offset:23616
s_waitcnt lgkmcnt(0)
ds_read_b64_tr_b16 a[96:97], v17 offset:24576
ds_read_b64_tr_b16 a[98:99], v17 offset:26624
ds_read_b64_tr_b16 a[100:101], v17 offset:24640
ds_read_b64_tr_b16 a[102:103], v17 offset:26688
ds_read_b64_tr_b16 a[104:105], v17 offset:25600
ds_read_b64_tr_b16 a[106:107], v17 offset:27648
ds_read_b64_tr_b16 a[108:109], v17 offset:25664
ds_read_b64_tr_b16 a[110:111], v17 offset:27712
s_waitcnt lgkmcnt(0)
ds_read_b64_tr_b16 a[112:113], v17 offset:28672
ds_read_b64_tr_b16 a[114:115], v17 offset:30720
ds_read_b64_tr_b16 a[116:117], v17 offset:28736
ds_read_b64_tr_b16 a[118:119], v17 offset:30784
ds_read_b64_tr_b16 a[120:121], v17 offset:29696
ds_read_b64_tr_b16 a[122:123], v17 offset:31744
ds_read_b64_tr_b16 a[124:125], v17 offset:29760
ds_read_b64_tr_b16 a[126:127], v17 offset:31808
s_waitcnt lgkmcnt(0)
s_add_u32 m0, s45, 16384
s_add_u32 s44, s56, 384
s_and_b32 s44, s44, 511
s_lshl_b32 s44, s44, 11
buffer_load_dwordx4 v16, s[4:7], s44 offen lds
s_add_u32 m0, s45, 17408
s_add_u32 s44, s56, 392
s_and_b32 s44, s44, 511
s_lshl_b32 s44, s44, 11
buffer_load_dwordx4 v16, s[4:7], s44 offen lds
s_add_u32 m0, s45, 18432
s_add_u32 s44, s56, 400
s_and_b32 s44, s44, 511
s_lshl_b32 s44, s44, 11
buffer_load_dwordx4 v16, s[4:7], s44 offen lds
s_add_u32 m0, s45, 19456
s_add_u32 s44, s56, 408
s_and_b32 s44, s44, 511
s_lshl_b32 s44, s44, 11
buffer_load_dwordx4 v16, s[4:7], s44 offen lds
s_add_u32 m0, s45, 20480
s_add_u32 s44, s56, 416
s_and_b32 s44, s44, 511
s_lshl_b32 s44, s44, 11
buffer_load_dwordx4 v16, s[4:7], s44 offen lds
s_add_u32 m0, s45, 21504
s_add_u32 s44, s56, 424
s_and_b32 s44, s44, 511
s_lshl_b32 s44, s44, 11
buffer_load_dwordx4 v16, s[4:7], s44 offen lds
s_add_u32 m0, s45, 22528
s_add_u32 s44, s56, 432
s_and_b32 s44, s44, 511
s_lshl_b32 s44, s44, 11
buffer_load_dwordx4 v16, s[4:7], s44 offen lds
s_add_u32 m0, s45, 23552
s_add_u32 s44, s56, 440
s_and_b32 s44, s44, 511
s_lshl_b32 s44, s44, 11
buffer_load_dwordx4 v16, s[4:7], s44 offen lds
s_add_u32 m0, s45, 24576
s_add_u32 s44, s56, 448
s_and_b32 s44, s44, 511
s_lshl_b32 s44, s44, 11
buffer_load_dwordx4 v16, s[4:7], s44 offen lds
s_add_u32 m0, s45, 25600
s_add_u32 s44, s56, 456
s_and_b32 s44, s44, 511
s_lshl_b32 s44, s44, 11
buffer_load_dwordx4 v16, s[4:7], s44 offen lds
s_add_u32 m0, s45, 26624
s_add_u32 s44, s56, 464
s_and_b32 s44, s44, 511
s_lshl_b32 s44, s44, 11
buffer_load_dwordx4 v16, s[4:7], s44 offen lds
s_add_u32 m0, s45, 27648
s_add_u32 s44, s56, 472
s_and_b32 s44, s44, 511
s_lshl_b32 s44, s44, 11
buffer_load_dwordx4 v16, s[4:7], s44 offen lds
s_add_u32 m0, s45, 28672
s_add_u32 s44, s56, 480
s_and_b32 s44, s44, 511
s_lshl_b32 s44, s44, 11
buffer_load_dwordx4 v16, s[4:7], s44 offen lds
s_add_u32 m0, s45, 29696
s_add_u32 s44, s56, 488
s_and_b32 s44, s44, 511
s_lshl_b32 s44, s44, 11
buffer_load_dwordx4 v16, s[4:7], s44 offen lds
s_add_u32 m0, s45, 30720
s_add_u32 s44, s56, 496
s_and_b32 s44, s44, 511
s_lshl_b32 s44, s44, 11
buffer_load_dwordx4 v16, s[4:7], s44 offen lds
s_add_u32 m0, s45, 31744
s_add_u32 s44, s56, 504
s_and_b32 s44, s44, 511
s_lshl_b32 s44, s44, 11
buffer_load_dwordx4 v16, s[4:7], s44 offen lds
s_waitcnt vmcnt(16)
ds_read_b64_tr_b16 a[128:129], v17 offset:0
ds_read_b64_tr_b16 a[130:131], v17 offset:2048
ds_read_b64_tr_b16 a[132:133], v17 offset:64
ds_read_b64_tr_b16 a[134:135], v17 offset:2112
ds_read_b64_tr_b16 a[136:137], v17 offset:1024
ds_read_b64_tr_b16 a[138:139], v17 offset:3072
ds_read_b64_tr_b16 a[140:141], v17 offset:1088
ds_read_b64_tr_b16 a[142:143], v17 offset:3136
s_waitcnt lgkmcnt(0)
ds_read_b64_tr_b16 a[144:145], v17 offset:4096
ds_read_b64_tr_b16 a[146:147], v17 offset:6144
ds_read_b64_tr_b16 a[148:149], v17 offset:4160
ds_read_b64_tr_b16 a[150:151], v17 offset:6208
ds_read_b64_tr_b16 a[152:153], v17 offset:5120
ds_read_b64_tr_b16 a[154:155], v17 offset:7168
ds_read_b64_tr_b16 a[156:157], v17 offset:5184
ds_read_b64_tr_b16 a[158:159], v17 offset:7232
s_waitcnt lgkmcnt(0)
ds_read_b64_tr_b16 a[160:161], v17 offset:8192
ds_read_b64_tr_b16 a[162:163], v17 offset:10240
ds_read_b64_tr_b16 a[164:165], v17 offset:8256
ds_read_b64_tr_b16 a[166:167], v17 offset:10304
ds_read_b64_tr_b16 a[168:169], v17 offset:9216
ds_read_b64_tr_b16 a[170:171], v17 offset:11264
ds_read_b64_tr_b16 a[172:173], v17 offset:9280
ds_read_b64_tr_b16 a[174:175], v17 offset:11328
s_waitcnt lgkmcnt(0)
ds_read_b64_tr_b16 a[176:177], v17 offset:12288
ds_read_b64_tr_b16 a[178:179], v17 offset:14336
ds_read_b64_tr_b16 a[180:181], v17 offset:12352
ds_read_b64_tr_b16 a[182:183], v17 offset:14400
ds_read_b64_tr_b16 a[184:185], v17 offset:13312
ds_read_b64_tr_b16 a[186:187], v17 offset:15360
ds_read_b64_tr_b16 a[188:189], v17 offset:13376
ds_read_b64_tr_b16 a[190:191], v17 offset:15424
s_waitcnt lgkmcnt(0)
s_waitcnt vmcnt(0)
ds_read_b64_tr_b16 a[192:193], v17 offset:16384
ds_read_b64_tr_b16 a[194:195], v17 offset:18432
ds_read_b64_tr_b16 a[196:197], v17 offset:16448
ds_read_b64_tr_b16 a[198:199], v17 offset:18496
ds_read_b64_tr_b16 a[200:201], v17 offset:17408
ds_read_b64_tr_b16 a[202:203], v17 offset:19456
ds_read_b64_tr_b16 a[204:205], v17 offset:17472
ds_read_b64_tr_b16 a[206:207], v17 offset:19520
s_waitcnt lgkmcnt(0)
ds_read_b64_tr_b16 a[208:209], v17 offset:20480
ds_read_b64_tr_b16 a[210:211], v17 offset:22528
ds_read_b64_tr_b16 a[212:213], v17 offset:20544
ds_read_b64_tr_b16 a[214:215], v17 offset:22592
ds_read_b64_tr_b16 a[216:217], v17 offset:21504
ds_read_b64_tr_b16 a[218:219], v17 offset:23552
ds_read_b64_tr_b16 a[220:221], v17 offset:21568
ds_read_b64_tr_b16 a[222:223], v17 offset:23616
s_waitcnt lgkmcnt(0)
ds_read_b64_tr_b16 a[224:225], v17 offset:24576
ds_read_b64_tr_b16 a[226:227], v17 offset:26624
ds_read_b64_tr_b16 a[228:229], v17 offset:24640
ds_read_b64_tr_b16 a[230:231], v17 offset:26688
ds_read_b64_tr_b16 a[232:233], v17 offset:25600
ds_read_b64_tr_b16 a[234:235], v17 offset:27648
ds_read_b64_tr_b16 a[236:237], v17 offset:25664
ds_read_b64_tr_b16 a[238:239], v17 offset:27712
s_waitcnt lgkmcnt(0)
ds_read_b64_tr_b16 a[240:241], v17 offset:28672
ds_read_b64_tr_b16 a[242:243], v17 offset:30720
ds_read_b64_tr_b16 a[244:245], v17 offset:28736
ds_read_b64_tr_b16 a[246:247], v17 offset:30784
ds_read_b64_tr_b16 a[248:249], v17 offset:29696
ds_read_b64_tr_b16 a[250:251], v17 offset:31744
ds_read_b64_tr_b16 a[252:253], v17 offset:29760
ds_read_b64_tr_b16 a[254:255], v17 offset:31808
s_waitcnt lgkmcnt(0)
s_barrier
s_lshl_b32 s56, s56, 6
s_lshl_b32 s43, s58, 17
s_lshl_b32 s44, s41, 15
s_add_u32 s43, s43, s44
s_add_u32 s43, s43, 134217728
v_add_u32 v6, s43, v5
v_and_b32 v2, 3, v1
v_lshlrev_b32 v7, 2, v2
v_bfe_u32 v2, v1, 2, 2
v_lshl_add_u32 v7, v2, 7, v7
s_lshl_b32 s43, s58, 11
s_lshl_b32 s44, s41, 9
s_add_u32 s43, s43, s44
s_lshl_b32 s44, s98, 13
s_add_u32 s43, s43, s44
s_add_u32 s43, s43, 69255168
v_add_u32 v7, s43, v7
s_mul_i32 s43, s41, 8704
v_lshrrev_b32 v2, 5, v1
v_lshl_add_u32 v8, v2, 5, v5
v_add_u32 v8, s43, v8
v_and_b32 v2, 7, v1
v_mul_u32_u24 v9, 544, v2
v_lshrrev_b32 v3, 3, v1
v_lshl_add_u32 v9, v3, 4, v9
s_lshl_b32 s43, s41, 7
v_add_u32 v9, s43, v9
s_mul_i32 s43, s58, 4352
s_sub_u32 s44, 4352, s43
v_add_u32 v10, s44, v9
v_add_u32 v9, s43, v9
s_lshl_b32 s43, s41, 15
s_lshl_b32 s44, s40, 6
s_add_u32 s43, s43, s44
v_lshlrev_b32 v11, 12, v3
v_and_b32 v2, 7, v1
v_lshl_add_u32 v11, v2, 3, v11
v_add_u32 v11, s43, v11
s_lshl_b32 s44, s41, 10
s_add_u32 s43, s66, s44
v_add_u32 v13, s43, v5
v_xor_b32 v12, s68, v13
s_mov_b32 s42, s64
s_mov_b32 s52, 0
s_mov_b32 s53, 0
s_mov_b32 s57, 0
s_mov_b32 s71, 1
s_cmp_eq_u32 s64, 0
s_cbranch_scc1 mega_kernel_o_nodry
s_mov_b32 s71, 0
s_mov_b32 s42, 0
s_mov_b32 s70, s65
s_mov_b32 s65, 1
v_mov_b32 v16, v12
v_mov_b32 v17, v11
v_mov_b32 v12, -16
v_mov_b32 v11, -16
mega_kernel_o_nodry:
mega_kernel_o_cold:
s_cmp_gt_i32 s52, s42
s_cbranch_scc1 mega_kernel_o_fk
mega_kernel_o_fw:
buffer_load_dword v2, v7, s[84:87], 0 offen sc1
s_waitcnt vmcnt(0)
v_min_i32_dpp v2, v2, v2 quad_perm:[1,0,3,2] row_mask:0xf bank_mask:0xf
s_nop 1
v_min_i32_dpp v2, v2, v2 quad_perm:[2,3,0,1] row_mask:0xf bank_mask:0xf
s_nop 1
v_min_i32_dpp v2, v2, v2 row_ror:4 row_mask:0xf bank_mask:0xf
s_nop 1
v_min_i32_dpp v2, v2, v2 row_ror:8 row_mask:0xf bank_mask:0xf
s_nop 0
v_readfirstlane_b32 s52, v2
s_min_i32 s52, s52, s65
s_cmp_gt_i32 s52, s42
s_cbranch_scc1 mega_kernel_o_fk
s_sleep 2
s_add_u32 s43, s52, 2
s_cmp_gt_i32 s43, s42
s_cbranch_scc1 mega_kernel_o_fw
s_sleep 48
s_branch mega_kernel_o_fw
mega_kernel_o_fk:
s_add_u32 s54, s42, 1
s_cmp_gt_i32 s52, s54
s_cbranch_scc0 mega_kernel_o_c0
s_lshl_b32 s50, s42, 18
s_add_u32 s51, s56, 0
s_and_b32 s51, s51, 0x7fff
s_add_u32 s51, s51, s50
buffer_load_dwordx4 v[96:99], v6, s[84:87], s51 offen offset:0 sc1
buffer_load_dwordx4 v[100:103], v6, s[84:87], s51 offen offset:1024 sc1
buffer_load_dwordx4 v[104:107], v6, s[84:87], s51 offen offset:2048 sc1
buffer_load_dwordx4 v[108:111], v6, s[84:87], s51 offen offset:3072 sc1
s_add_u32 s51, s56, 4096
s_and_b32 s51, s51, 0x7fff
s_add_u32 s51, s51, s50
buffer_load_dwordx4 v[112:115], v6, s[84:87], s51 offen offset:0 sc1
buffer_load_dwordx4 v[116:119], v6, s[84:87], s51 offen offset:1024 sc1
buffer_load_dwordx4 v[120:123], v6, s[84:87], s51 offen offset:2048 sc1
buffer_load_dwordx4 v[124:127], v6, s[84:87], s51 offen offset:3072 sc1
s_add_u32 s51, s56, 8192
s_and_b32 s51, s51, 0x7fff
s_add_u32 s51, s51, s50
buffer_load_dwordx4 v[128:131], v6, s[84:87], s51 offen offset:0 sc1
buffer_load_dwordx4 v[132:135], v6, s[84:87], s51 offen offset:1024 sc1
buffer_load_dwordx4 v[136:139], v6, s[84:87], s51 offen offset:2048 sc1
buffer_load_dwordx4 v[140:143], v6, s[84:87], s51 offen offset:3072 sc1
s_add_u32 s51, s56, 12288
s_and_b32 s51, s51, 0x7fff
s_add_u32 s51, s51, s50
buffer_load_dwordx4 v[144:147], v6, s[84:87], s51 offen offset:0 sc1
buffer_load_dwordx4 v[148:151], v6, s[84:87], s51 offen offset:1024 sc1
buffer_load_dwordx4 v[152:155], v6, s[84:87], s51 offen offset:2048 sc1
buffer_load_dwordx4 v[156:159], v6, s[84:87], s51 offen offset:3072 sc1
s_add_u32 s51, s56, 16384
s_and_b32 s51, s51, 0x7fff
s_add_u32 s51, s51, s50
buffer_load_dwordx4 v[160:163], v6, s[84:87], s51 offen offset:0 sc1
buffer_load_dwordx4 v[164:167], v6, s[84:87], s51 offen offset:1024 sc1
buffer_load_dwordx4 v[168:171], v6, s[84:87], s51 offen offset:2048 sc1
buffer_load_dwordx4 v[172:175], v6, s[84:87], s51 offen offset:3072 sc1
s_add_u32 s51, s56, 20480
s_and_b32 s51, s51, 0x7fff
s_add_u32 s51, s51, s50
buffer_load_dwordx4 v[176:179], v6, s[84:87], s51 offen offset:0 sc1
buffer_load_dwordx4 v[180:183], v6, s[84:87], s51 offen offset:1024 sc1
buffer_load_dwordx4 v[184:187], v6, s[84:87], s51 offen offset:2048 sc1
buffer_load_dwordx4 v[188:191], v6, s[84:87], s51 offen offset:3072 sc1
s_add_u32 s51, s56, 24576
s_and_b32 s51, s51, 0x7fff
s_add_u32 s51, s51, s50
buffer_load_dwordx4 v[192:195], v6, s[84:87], s51 offen offset:0 sc1
buffer_load_dwordx4 v[196:199], v6, s[84:87], s51 offen offset:1024 sc1
buffer_load_dwordx4 v[200:203], v6, s[84:87], s51 offen offset:2048 sc1
buffer_load_dwordx4 v[204:207], v6, s[84:87], s51 offen offset:3072 sc1
s_add_u32 s51, s56, 28672
s_and_b32 s51, s51, 0x7fff
s_add_u32 s51, s51, s50
buffer_load_dwordx4 v[208:211], v6, s[84:87], s51 offen offset:0 sc1
buffer_load_dwordx4 v[212:215], v6, s[84:87], s51 offen offset:1024 sc1
buffer_load_dwordx4 v[216:219], v6, s[84:87], s51 offen offset:2048 sc1
buffer_load_dwordx4 v[220:223], v6, s[84:87], s51 offen offset:3072 sc1
mega_kernel_o_w0:
s_add_u32 s54, s42, 1
s_sub_u32 s62, s42, 1
s_lshl_b32 s50, s54, 18
s_cmp_gt_i32 s52, s54
s_cbranch_scc0 mega_kernel_o_n0
s_waitcnt vmcnt(31)
v_mfma_f32_32x32x16_bf16 v[20:35], a[0:3], v[96:99], 0
v_mfma_f32_32x32x16_bf16 v[36:51], a[4:7], v[96:99], 0
s_add_u32 s51, s56, 0
s_and_b32 s51, s51, 0x7fff
s_add_u32 s51, s51, s50
buffer_load_dwordx4 v[96:99], v6, s[84:87], s51 offen offset:0 sc1
s_waitcnt vmcnt(31)
v_mfma_f32_32x32x16_bf16 v[20:35], a[8:11], v[100:103], v[20:35]
v_mfma_f32_32x32x16_bf16 v[36:51], a[12:15], v[100:103], v[36:51]
buffer_load_dwordx4 v[100:103], v6, s[84:87], s51 offen offset:1024 sc1
s_waitcnt vmcnt(31)
v_mfma_f32_32x32x16_bf16 v[20:35], a[16:19], v[104:107], v[20:35]
v_mfma_f32_32x32x16_bf16 v[36:51], a[20:23], v[104:107], v[36:51]
buffer_load_dwordx4 v[104:107], v6, s[84:87], s51 offen offset:2048 sc1
s_waitcnt vmcnt(31)
v_mfma_f32_32x32x16_bf16 v[20:35], a[24:27], v[108:111], v[20:35]
v_mfma_f32_32x32x16_bf16 v[36:51], a[28:31], v[108:111], v[36:51]
buffer_load_dwordx4 v[108:111], v6, s[84:87], s51 offen offset:3072 sc1
s_waitcnt vmcnt(31)
v_mfma_f32_32x32x16_bf16 v[20:35], a[32:35], v[112:115], v[20:35]
v_mfma_f32_32x32x16_bf16 v[36:51], a[36:39], v[112:115], v[36:51]
s_add_u32 s51, s56, 4096
s_and_b32 s51, s51, 0x7fff
s_add_u32 s51, s51, s50
buffer_load_dwordx4 v[112:115], v6, s[84:87], s51 offen offset:0 sc1
s_waitcnt vmcnt(31)
v_mfma_f32_32x32x16_bf16 v[20:35], a[40:43], v[116:119], v[20:35]
v_mfma_f32_32x32x16_bf16 v[36:51], a[44:47], v[116:119], v[36:51]
buffer_load_dwordx4 v[116:119], v6, s[84:87], s51 offen offset:1024 sc1
s_waitcnt vmcnt(31)
v_mfma_f32_32x32x16_bf16 v[20:35], a[48:51], v[120:123], v[20:35]
v_mfma_f32_32x32x16_bf16 v[36:51], a[52:55], v[120:123], v[36:51]
buffer_load_dwordx4 v[120:123], v6, s[84:87], s51 offen offset:2048 sc1
s_waitcnt vmcnt(31)
v_mfma_f32_32x32x16_bf16 v[20:35], a[56:59], v[124:127], v[20:35]
v_mfma_f32_32x32x16_bf16 v[36:51], a[60:63], v[124:127], v[36:51]
buffer_load_dwordx4 v[124:127], v6, s[84:87], s51 offen offset:3072 sc1
s_waitcnt vmcnt(31)
v_mfma_f32_32x32x16_bf16 v[20:35], a[64:67], v[128:131], v[20:35]
v_mfma_f32_32x32x16_bf16 v[36:51], a[68:71], v[128:131], v[36:51]
s_add_u32 s51, s56, 8192
s_and_b32 s51, s51, 0x7fff
s_add_u32 s51, s51, s50
buffer_load_dwordx4 v[128:131], v6, s[84:87], s51 offen offset:0 sc1
s_waitcnt vmcnt(31)
v_mfma_f32_32x32x16_bf16 v[20:35], a[72:75], v[132:135], v[20:35]
v_mfma_f32_32x32x16_bf16 v[36:51], a[76:79], v[132:135], v[36:51]
buffer_load_dwordx4 v[132:135], v6, s[84:87], s51 offen offset:1024 sc1
s_waitcnt vmcnt(31)
v_mfma_f32_32x32x16_bf16 v[20:35], a[80:83], v[136:139], v[20:35]
v_mfma_f32_32x32x16_bf16 v[36:51], a[84:87], v[136:139], v[36:51]
buffer_load_dwordx4 v[136:139], v6, s[84:87], s51 offen offset:2048 sc1
s_waitcnt vmcnt(31)
v_mfma_f32_32x32x16_bf16 v[20:35], a[88:91], v[140:143], v[20:35]
v_mfma_f32_32x32x16_bf16 v[36:51], a[92:95], v[140:143], v[36:51]
buffer_load_dwordx4 v[140:143], v6, s[84:87], s51 offen offset:3072 sc1
s_waitcnt vmcnt(31)
v_mfma_f32_32x32x16_bf16 v[20:35], a[96:99], v[144:147], v[20:35]
v_mfma_f32_32x32x16_bf16 v[36:51], a[100:103], v[144:147], v[36:51]
s_add_u32 s51, s56, 12288
s_and_b32 s51, s51, 0x7fff
s_add_u32 s51, s51, s50
buffer_load_dwordx4 v[144:147], v6, s[84:87], s51 offen offset:0 sc1
s_waitcnt vmcnt(31)
v_mfma_f32_32x32x16_bf16 v[20:35], a[104:107], v[148:151], v[20:35]
v_mfma_f32_32x32x16_bf16 v[36:51], a[108:111], v[148:151], v[36:51]
buffer_load_dwordx4 v[148:151], v6, s[84:87], s51 offen offset:1024 sc1
s_waitcnt vmcnt(31)
v_mfma_f32_32x32x16_bf16 v[20:35], a[112:115], v[152:155], v[20:35]
v_mfma_f32_32x32x16_bf16 v[36:51], a[116:119], v[152:155], v[36:51]
buffer_load_dwordx4 v[152:155], v6, s[84:87], s51 offen offset:2048 sc1
s_waitcnt vmcnt(31)
v_mfma_f32_32x32x16_bf16 v[20:35], a[120:123], v[156:159], v[20:35]
v_mfma_f32_32x32x16_bf16 v[36:51], a[124:127], v[156:159], v[36:51]
buffer_load_dwordx4 v[156:159], v6, s[84:87], s51 offen offset:3072 sc1
s_waitcnt vmcnt(31)
v_mfma_f32_32x32x16_bf16 v[20:35], a[128:131], v[160:163], v[20:35]
v_mfma_f32_32x32x16_bf16 v[36:51], a[132:135], v[160:163], v[36:51]
s_add_u32 s51, s56, 16384
s_and_b32 s51, s51, 0x7fff
s_add_u32 s51, s51, s50
buffer_load_dwordx4 v[160:163], v6, s[84:87], s51 offen offset:0 sc1
s_waitcnt vmcnt(31)
v_mfma_f32_32x32x16_bf16 v[20:35], a[136:139], v[164:167], v[20:35]
v_mfma_f32_32x32x16_bf16 v[36:51], a[140:143], v[164:167], v[36:51]
buffer_load_dwordx4 v[164:167], v6, s[84:87], s51 offen offset:1024 sc1
s_waitcnt vmcnt(31)
v_mfma_f32_32x32x16_bf16 v[20:35], a[144:147], v[168:171], v[20:35]
v_mfma_f32_32x32x16_bf16 v[36:51], a[148:151], v[168:171], v[36:51]
buffer_load_dwordx4 v[168:171], v6, s[84:87], s51 offen offset:2048 sc1
s_waitcnt vmcnt(31)
v_mfma_f32_32x32x16_bf16 v[20:35], a[152:155], v[172:175], v[20:35]
v_mfma_f32_32x32x16_bf16 v[36:51], a[156:159], v[172:175], v[36:51]
buffer_load_dwordx4 v[172:175], v6, s[84:87], s51 offen offset:3072 sc1
s_waitcnt vmcnt(31)
v_mfma_f32_32x32x16_bf16 v[20:35], a[160:163], v[176:179], v[20:35]
v_mfma_f32_32x32x16_bf16 v[36:51], a[164:167], v[176:179], v[36:51]
s_add_u32 s51, s56, 20480
s_and_b32 s51, s51, 0x7fff
s_add_u32 s51, s51, s50
buffer_load_dwordx4 v[176:179], v6, s[84:87], s51 offen offset:0 sc1
s_waitcnt vmcnt(31)
v_mfma_f32_32x32x16_bf16 v[20:35], a[168:171], v[180:183], v[20:35]
v_mfma_f32_32x32x16_bf16 v[36:51], a[172:175], v[180:183], v[36:51]
buffer_load_dwordx4 v[180:183], v6, s[84:87], s51 offen offset:1024 sc1
s_waitcnt vmcnt(31)
v_mfma_f32_32x32x16_bf16 v[20:35], a[176:179], v[184:187], v[20:35]
v_mfma_f32_32x32x16_bf16 v[36:51], a[180:183], v[184:187], v[36:51]
buffer_load_dwordx4 v[184:187], v6, s[84:87], s51 offen offset:2048 sc1
s_waitcnt vmcnt(31)
v_mfma_f32_32x32x16_bf16 v[20:35], a[184:187], v[188:191], v[20:35]
v_mfma_f32_32x32x16_bf16 v[36:51], a[188:191], v[188:191], v[36:51]
buffer_load_dwordx4 v[188:191], v6, s[84:87], s51 offen offset:3072 sc1
s_waitcnt vmcnt(31)
v_mfma_f32_32x32x16_bf16 v[20:35], a[192:195], v[192:195], v[20:35]
v_mfma_f32_32x32x16_bf16 v[36:51], a[196:199], v[192:195], v[36:51]
s_add_u32 s51, s56, 24576
s_and_b32 s51, s51, 0x7fff
s_add_u32 s51, s51, s50
buffer_load_dwordx4 v[192:195], v6, s[84:87], s51 offen offset:0 sc1
s_waitcnt vmcnt(31)
v_mfma_f32_32x32x16_bf16 v[20:35], a[200:203], v[196:199], v[20:35]
v_mfma_f32_32x32x16_bf16 v[36:51], a[204:207], v[196:199], v[36:51]
buffer_load_dwordx4 v[196:199], v6, s[84:87], s51 offen offset:1024 sc1
s_waitcnt vmcnt(31)
v_mfma_f32_32x32x16_bf16 v[20:35], a[208:211], v[200:203], v[20:35]
v_mfma_f32_32x32x16_bf16 v[36:51], a[212:215], v[200:203], v[36:51]
buffer_load_dwordx4 v[200:203], v6, s[84:87], s51 offen offset:2048 sc1
s_waitcnt vmcnt(31)
v_mfma_f32_32x32x16_bf16 v[20:35], a[216:219], v[204:207], v[20:35]
v_mfma_f32_32x32x16_bf16 v[36:51], a[220:223], v[204:207], v[36:51]
buffer_load_dwordx4 v[204:207], v6, s[84:87], s51 offen offset:3072 sc1
s_waitcnt vmcnt(31)
v_mfma_f32_32x32x16_bf16 v[20:35], a[224:227], v[208:211], v[20:35]
v_mfma_f32_32x32x16_bf16 v[36:51], a[228:231], v[208:211], v[36:51]
s_add_u32 s51, s56, 28672
s_and_b32 s51, s51, 0x7fff
s_add_u32 s51, s51, s50
buffer_load_dwordx4 v[208:211], v6, s[84:87], s51 offen offset:0 sc1
s_waitcnt vmcnt(31)
v_mfma_f32_32x32x16_bf16 v[20:35], a[232:235], v[212:215], v[20:35]
v_mfma_f32_32x32x16_bf16 v[36:51], a[236:239], v[212:215], v[36:51]
buffer_load_dwordx4 v[212:215], v6, s[84:87], s51 offen offset:1024 sc1
s_waitcnt vmcnt(31)
v_mfma_f32_32x32x16_bf16 v[20:35], a[240:243], v[216:219], v[20:35]
v_mfma_f32_32x32x16_bf16 v[36:51], a[244:247], v[216:219], v[36:51]
buffer_load_dwordx4 v[216:219], v6, s[84:87], s51 offen offset:2048 sc1
s_waitcnt vmcnt(31)
v_mfma_f32_32x32x16_bf16 v[224:239], a[248:251], v[220:223], v[20:35]
v_mfma_f32_32x32x16_bf16 v[240:255], a[252:255], v[220:223], v[36:51]
buffer_load_dwordx4 v[220:223], v6, s[84:87], s51 offen offset:3072 sc1
s_add_u32 s42, s42, 1
s_branch mega_kernel_o_w1
mega_kernel_o_n0:
s_waitcnt vmcnt(31)
v_mfma_f32_32x32x16_bf16 v[20:35], a[0:3], v[96:99], 0
v_mfma_f32_32x32x16_bf16 v[36:51], a[4:7], v[96:99], 0
s_waitcnt vmcnt(30)
v_mfma_f32_32x32x16_bf16 v[20:35], a[8:11], v[100:103], v[20:35]
v_mfma_f32_32x32x16_bf16 v[36:51], a[12:15], v[100:103], v[36:51]
s_waitcnt vmcnt(29)
v_mfma_f32_32x32x16_bf16 v[20:35], a[16:19], v[104:107], v[20:35]
v_mfma_f32_32x32x16_bf16 v[36:51], a[20:23], v[104:107], v[36:51]
s_waitcnt vmcnt(28)
v_mfma_f32_32x32x16_bf16 v[20:35], a[24:27], v[108:111], v[20:35]
v_mfma_f32_32x32x16_bf16 v[36:51], a[28:31], v[108:111], v[36:51]
s_waitcnt vmcnt(27)
v_mfma_f32_32x32x16_bf16 v[20:35], a[32:35], v[112:115], v[20:35]
v_mfma_f32_32x32x16_bf16 v[36:51], a[36:39], v[112:115], v[36:51]
s_waitcnt vmcnt(26)
v_mfma_f32_32x32x16_bf16 v[20:35], a[40:43], v[116:119], v[20:35]
v_mfma_f32_32x32x16_bf16 v[36:51], a[44:47], v[116:119], v[36:51]
s_waitcnt vmcnt(25)
v_mfma_f32_32x32x16_bf16 v[20:35], a[48:51], v[120:123], v[20:35]
v_mfma_f32_32x32x16_bf16 v[36:51], a[52:55], v[120:123], v[36:51]
s_waitcnt vmcnt(24)
v_mfma_f32_32x32x16_bf16 v[20:35], a[56:59], v[124:127], v[20:35]
v_mfma_f32_32x32x16_bf16 v[36:51], a[60:63], v[124:127], v[36:51]
s_waitcnt vmcnt(23)
v_mfma_f32_32x32x16_bf16 v[20:35], a[64:67], v[128:131], v[20:35]
v_mfma_f32_32x32x16_bf16 v[36:51], a[68:71], v[128:131], v[36:51]
s_waitcnt vmcnt(22)
v_mfma_f32_32x32x16_bf16 v[20:35], a[72:75], v[132:135], v[20:35]
v_mfma_f32_32x32x16_bf16 v[36:51], a[76:79], v[132:135], v[36:51]
s_waitcnt vmcnt(21)
v_mfma_f32_32x32x16_bf16 v[20:35], a[80:83], v[136:139], v[20:35]
v_mfma_f32_32x32x16_bf16 v[36:51], a[84:87], v[136:139], v[36:51]
s_waitcnt vmcnt(20)
v_mfma_f32_32x32x16_bf16 v[20:35], a[88:91], v[140:143], v[20:35]
v_mfma_f32_32x32x16_bf16 v[36:51], a[92:95], v[140:143], v[36:51]
s_waitcnt vmcnt(19)
v_mfma_f32_32x32x16_bf16 v[20:35], a[96:99], v[144:147], v[20:35]
v_mfma_f32_32x32x16_bf16 v[36:51], a[100:103], v[144:147], v[36:51]
s_waitcnt vmcnt(18)
v_mfma_f32_32x32x16_bf16 v[20:35], a[104:107], v[148:151], v[20:35]
v_mfma_f32_32x32x16_bf16 v[36:51], a[108:111], v[148:151], v[36:51]
s_waitcnt vmcnt(17)
v_mfma_f32_32x32x16_bf16 v[20:35], a[112:115], v[152:155], v[20:35]
v_mfma_f32_32x32x16_bf16 v[36:51], a[116:119], v[152:155], v[36:51]
s_waitcnt vmcnt(16)
v_mfma_f32_32x32x16_bf16 v[20:35], a[120:123], v[156:159], v[20:35]
v_mfma_f32_32x32x16_bf16 v[36:51], a[124:127], v[156:159], v[36:51]
s_waitcnt vmcnt(15)
v_mfma_f32_32x32x16_bf16 v[20:35], a[128:131], v[160:163], v[20:35]
v_mfma_f32_32x32x16_bf16 v[36:51], a[132:135], v[160:163], v[36:51]
s_waitcnt vmcnt(14)
v_mfma_f32_32x32x16_bf16 v[20:35], a[136:139], v[164:167], v[20:35]
v_mfma_f32_32x32x16_bf16 v[36:51], a[140:143], v[164:167], v[36:51]
s_waitcnt vmcnt(13)
v_mfma_f32_32x32x16_bf16 v[20:35], a[144:147], v[168:171], v[20:35]
v_mfma_f32_32x32x16_bf16 v[36:51], a[148:151], v[168:171], v[36:51]
s_waitcnt vmcnt(12)
v_mfma_f32_32x32x16_bf16 v[20:35], a[152:155], v[172:175], v[20:35]
v_mfma_f32_32x32x16_bf16 v[36:51], a[156:159], v[172:175], v[36:51]
s_waitcnt vmcnt(11)
v_mfma_f32_32x32x16_bf16 v[20:35], a[160:163], v[176:179], v[20:35]
v_mfma_f32_32x32x16_bf16 v[36:51], a[164:167], v[176:179], v[36:51]
buffer_load_dword v15, v7, s[84:87], 0 offen sc1
s_waitcnt vmcnt(10)
v_mfma_f32_32x32x16_bf16 v[20:35], a[168:171], v[180:183], v[20:35]
v_mfma_f32_32x32x16_bf16 v[36:51], a[172:175], v[180:183], v[36:51]
s_waitcnt vmcnt(9)
v_mfma_f32_32x32x16_bf16 v[20:35], a[176:179], v[184:187], v[20:35]
v_mfma_f32_32x32x16_bf16 v[36:51], a[180:183], v[184:187], v[36:51]
s_waitcnt vmcnt(8)
v_mfma_f32_32x32x16_bf16 v[20:35], a[184:187], v[188:191], v[20:35]
v_mfma_f32_32x32x16_bf16 v[36:51], a[188:191], v[188:191], v[36:51]
s_waitcnt vmcnt(7)
v_mfma_f32_32x32x16_bf16 v[20:35], a[192:195], v[192:195], v[20:35]
v_mfma_f32_32x32x16_bf16 v[36:51], a[196:199], v[192:195], v[36:51]
s_waitcnt vmcnt(6)
v_mfma_f32_32x32x16_bf16 v[20:35], a[200:203], v[196:199], v[20:35]
v_mfma_f32_32x32x16_bf16 v[36:51], a[204:207], v[196:199], v[36:51]
s_waitcnt vmcnt(5)
v_mfma_f32_32x32x16_bf16 v[20:35], a[208:211], v[200:203], v[20:35]
v_mfma_f32_32x32x16_bf16 v[36:51], a[212:215], v[200:203], v[36:51]
s_waitcnt vmcnt(4)
v_mfma_f32_32x32x16_bf16 v[20:35], a[216:219], v[204:207], v[20:35]
v_mfma_f32_32x32x16_bf16 v[36:51], a[220:223], v[204:207], v[36:51]
s_waitcnt vmcnt(3)
v_mfma_f32_32x32x16_bf16 v[20:35], a[224:227], v[208:211], v[20:35]
v_mfma_f32_32x32x16_bf16 v[36:51], a[228:231], v[208:211], v[36:51]
s_waitcnt vmcnt(2)
v_mfma_f32_32x32x16_bf16 v[20:35], a[232:235], v[212:215], v[20:35]
v_mfma_f32_32x32x16_bf16 v[36:51], a[236:239], v[212:215], v[36:51]
s_waitcnt vmcnt(1)
v_mfma_f32_32x32x16_bf16 v[20:35], a[240:243], v[216:219], v[20:35]
v_mfma_f32_32x32x16_bf16 v[36:51], a[244:247], v[216:219], v[36:51]
s_waitcnt vmcnt(0)
v_mfma_f32_32x32x16_bf16 v[224:239], a[248:251], v[220:223], v[20:35]
v_mfma_f32_32x32x16_bf16 v[240:255], a[252:255], v[220:223], v[36:51]
s_branch mega_kernel_o_imm
mega_kernel_o_w1:
s_add_u32 s54, s42, 1
s_sub_u32 s62, s42, 1
s_lshl_b32 s50, s54, 18
s_cmp_gt_i32 s52, s54
s_cbranch_scc0 mega_kernel_o_n1
s_waitcnt vmcnt(31)
v_mfma_f32_32x32x16_bf16 v[20:35], a[0:3], v[96:99], 0
v_mfma_f32_32x32x16_bf16 v[36:51], a[4:7], v[96:99], 0
s_add_u32 s51, s56, 0
s_and_b32 s51, s51, 0x7fff
s_add_u32 s51, s51, s50
buffer_load_dwordx4 v[96:99], v6, s[84:87], s51 offen offset:0 sc1
s_waitcnt vmcnt(31)
v_mfma_f32_32x32x16_bf16 v[20:35], a[8:11], v[100:103], v[20:35]
v_mfma_f32_32x32x16_bf16 v[36:51], a[12:15], v[100:103], v[36:51]
buffer_load_dwordx4 v[100:103], v6, s[84:87], s51 offen offset:1024 sc1
v_add_u32 v2, s53, v8
v_add_u32 v3, s53, v9
v_add_u32 v4, s53, v10
s_waitcnt vmcnt(31)
v_mfma_f32_32x32x16_bf16 v[20:35], a[16:19], v[104:107], v[20:35]
v_mfma_f32_32x32x16_bf16 v[36:51], a[20:23], v[104:107], v[36:51]
buffer_load_dwordx4 v[104:107], v6, s[84:87], s51 offen offset:2048 sc1
ds_write_b128 v2, v[224:227] offset:0
ds_write_b128 v2, v[228:231] offset:1088
s_waitcnt vmcnt(31)
v_mfma_f32_32x32x16_bf16 v[20:35], a[24:27], v[108:111], v[20:35]
v_mfma_f32_32x32x16_bf16 v[36:51], a[28:31], v[108:111], v[36:51]
buffer_load_dwordx4 v[108:111], v6, s[84:87], s51 offen offset:3072 sc1
ds_write_b128 v2, v[232:235] offset:2176
ds_write_b128 v2, v[236:239] offset:3264
s_waitcnt vmcnt(31)
v_mfma_f32_32x32x16_bf16 v[20:35], a[32:35], v[112:115], v[20:35]
v_mfma_f32_32x32x16_bf16 v[36:51], a[36:39], v[112:115], v[36:51]
s_add_u32 s51, s56, 4096
s_and_b32 s51, s51, 0x7fff
s_add_u32 s51, s51, s50
buffer_load_dwordx4 v[112:115], v6, s[84:87], s51 offen offset:0 sc1
ds_write_b128 v2, v[240:243] offset:4352
ds_write_b128 v2, v[244:247] offset:5440
s_waitcnt vmcnt(31)
v_mfma_f32_32x32x16_bf16 v[20:35], a[40:43], v[116:119], v[20:35]
v_mfma_f32_32x32x16_bf16 v[36:51], a[44:47], v[116:119], v[36:51]
buffer_load_dwordx4 v[116:119], v6, s[84:87], s51 offen offset:1024 sc1
ds_write_b128 v2, v[248:251] offset:6528
ds_write_b128 v2, v[252:255] offset:7616
s_waitcnt vmcnt(31)
v_mfma_f32_32x32x16_bf16 v[20:35], a[48:51], v[120:123], v[20:35]
v_mfma_f32_32x32x16_bf16 v[36:51], a[52:55], v[120:123], v[36:51]
buffer_load_dwordx4 v[120:123], v6, s[84:87], s51 offen offset:2048 sc1
s_waitcnt vmcnt(31)
v_mfma_f32_32x32x16_bf16 v[20:35], a[56:59], v[124:127], v[20:35]
v_mfma_f32_32x32x16_bf16 v[36:51], a[60:63], v[124:127], v[36:51]
buffer_load_dwordx4 v[124:127], v6, s[84:87], s51 offen offset:3072 sc1
s_waitcnt lgkmcnt(0)
s_barrier
ds_read_b128 v[52:55], v4 offset:0
ds_read_b128 v[56:59], v4 offset:8704
ds_read_b128 v[60:63], v4 offset:17408
ds_read_b128 v[64:67], v4 offset:26112
s_waitcnt vmcnt(31)
v_mfma_f32_32x32x16_bf16 v[20:35], a[64:67], v[128:131], v[20:35]
v_mfma_f32_32x32x16_bf16 v[36:51], a[68:71], v[128:131], v[36:51]
s_add_u32 s51, s56, 8192
s_and_b32 s51, s51, 0x7fff
s_add_u32 s51, s51, s50
buffer_load_dwordx4 v[128:131], v6, s[84:87], s51 offen offset:0 sc1
ds_read_b128 v[68:71], v3 offset:0
ds_read_b128 v[72:75], v3 offset:8704
ds_read_b128 v[76:79], v3 offset:17408
ds_read_b128 v[80:83], v3 offset:26112
s_sub_u32 s53, 34816, s53
s_bfe_u32 s61, s62, 0x10001
s_xor_b32 s61, s61, s67
s_and_b32 s60, s62, s69
s_lshl_b32 s60, s60, 12
s_waitcnt vmcnt(31)
v_mfma_f32_32x32x16_bf16 v[20:35], a[72:75], v[132:135], v[20:35]
v_mfma_f32_32x32x16_bf16 v[36:51], a[76:79], v[132:135], v[36:51]
buffer_load_dwordx4 v[132:135], v6, s[84:87], s51 offen offset:1024 sc1
s_waitcnt vmcnt(31)
v_mfma_f32_32x32x16_bf16 v[20:35], a[80:83], v[136:139], v[20:35]
v_mfma_f32_32x32x16_bf16 v[36:51], a[84:87], v[136:139], v[36:51]
buffer_load_dwordx4 v[136:139], v6, s[84:87], s51 offen offset:2048 sc1
s_waitcnt lgkmcnt(4)
v_add_f32 v52, v52, v56
v_add_f32 v60, v60, v64
v_add_f32 v53, v53, v57
v_add_f32 v61, v61, v65
v_add_f32 v54, v54, v58
v_add_f32 v62, v62, v66
v_add_f32 v55, v55, v59
v_add_f32 v63, v63, v67
s_waitcnt vmcnt(31)
v_mfma_f32_32x32x16_bf16 v[20:35], a[88:91], v[140:143], v[20:35]
v_mfma_f32_32x32x16_bf16 v[36:51], a[92:95], v[140:143], v[36:51]
buffer_load_dwordx4 v[140:143], v6, s[84:87], s51 offen offset:3072 sc1
v_add_f32 v52, v52, v60
v_add_f32 v53, v53, v61
v_add_f32 v54, v54, v62
v_add_f32 v55, v55, v63
v_and_or_b32 v52, v52, -2, s61
s_cmp_eq_u32 s95, 0
s_cbranch_scc1 mega_kernel_o_sa1
buffer_store_dwordx4 v[52:55], v12, s[84:87], s60 offen sc1
s_branch mega_kernel_o_sb1
mega_kernel_o_sa1:
buffer_store_dwordx4 v[52:55], v12, s[84:87], s60 offen
mega_kernel_o_sb1:
s_waitcnt vmcnt(31)
v_mfma_f32_32x32x16_bf16 v[20:35], a[96:99], v[144:147], v[20:35]
v_mfma_f32_32x32x16_bf16 v[36:51], a[100:103], v[144:147], v[36:51]
s_add_u32 s51, s56, 12288
s_and_b32 s51, s51, 0x7fff
s_add_u32 s51, s51, s50
buffer_load_dwordx4 v[144:147], v6, s[84:87], s51 offen offset:0 sc1
s_waitcnt lgkmcnt(0)
v_add_f32 v68, v68, v72
v_add_f32 v76, v76, v80
v_add_f32 v69, v69, v73
v_add_f32 v77, v77, v81
v_add_f32 v70, v70, v74
v_add_f32 v78, v78, v82
v_add_f32 v71, v71, v75
v_add_f32 v79, v79, v83
s_waitcnt vmcnt(31)
v_mfma_f32_32x32x16_bf16 v[20:35], a[104:107], v[148:151], v[20:35]
v_mfma_f32_32x32x16_bf16 v[36:51], a[108:111], v[148:151], v[36:51]
buffer_load_dwordx4 v[148:151], v6, s[84:87], s51 offen offset:1024 sc1
v_add_f32 v84, v68, v76
v_add_f32 v85, v69, v77
v_add_f32 v86, v70, v78
v_add_f32 v87, v71, v79
s_waitcnt vmcnt(31)
v_mfma_f32_32x32x16_bf16 v[20:35], a[112:115], v[152:155], v[20:35]
v_mfma_f32_32x32x16_bf16 v[36:51], a[116:119], v[152:155], v[36:51]
buffer_load_dwordx4 v[152:155], v6, s[84:87], s51 offen offset:2048 sc1
s_waitcnt vmcnt(31)
v_mfma_f32_32x32x16_bf16 v[20:35], a[120:123], v[156:159], v[20:35]
v_mfma_f32_32x32x16_bf16 v[36:51], a[124:127], v[156:159], v[36:51]
buffer_load_dwordx4 v[156:159], v6, s[84:87], s51 offen offset:3072 sc1
s_waitcnt vmcnt(31)
v_mfma_f32_32x32x16_bf16 v[20:35], a[128:131], v[160:163], v[20:35]
v_mfma_f32_32x32x16_bf16 v[36:51], a[132:135], v[160:163], v[36:51]
s_add_u32 s51, s56, 16384
s_and_b32 s51, s51, 0x7fff
s_add_u32 s51, s51, s50
buffer_load_dwordx4 v[160:163], v6, s[84:87], s51 offen offset:0 sc1
s_waitcnt vmcnt(31)
v_mfma_f32_32x32x16_bf16 v[20:35], a[136:139], v[164:167], v[20:35]
v_mfma_f32_32x32x16_bf16 v[36:51], a[140:143], v[164:167], v[36:51]
buffer_load_dwordx4 v[164:167], v6, s[84:87], s51 offen offset:1024 sc1
s_waitcnt vmcnt(31)
v_mfma_f32_32x32x16_bf16 v[20:35], a[144:147], v[168:171], v[20:35]
v_mfma_f32_32x32x16_bf16 v[36:51], a[148:151], v[168:171], v[36:51]
buffer_load_dwordx4 v[168:171], v6, s[84:87], s51 offen offset:2048 sc1
s_waitcnt vmcnt(31)
v_mfma_f32_32x32x16_bf16 v[20:35], a[152:155], v[172:175], v[20:35]
v_mfma_f32_32x32x16_bf16 v[36:51], a[156:159], v[172:175], v[36:51]
buffer_load_dwordx4 v[172:175], v6, s[84:87], s51 offen offset:3072 sc1
s_waitcnt vmcnt(31)
v_mfma_f32_32x32x16_bf16 v[20:35], a[160:163], v[176:179], v[20:35]
v_mfma_f32_32x32x16_bf16 v[36:51], a[164:167], v[176:179], v[36:51]
s_add_u32 s51, s56, 20480
s_and_b32 s51, s51, 0x7fff
s_add_u32 s51, s51, s50
buffer_load_dwordx4 v[176:179], v6, s[84:87], s51 offen offset:0 sc1
s_waitcnt vmcnt(31)
v_mfma_f32_32x32x16_bf16 v[20:35], a[168:171], v[180:183], v[20:35]
v_mfma_f32_32x32x16_bf16 v[36:51], a[172:175], v[180:183], v[36:51]
buffer_load_dwordx4 v[180:183], v6, s[84:87], s51 offen offset:1024 sc1
s_waitcnt vmcnt(31)
v_mfma_f32_32x32x16_bf16 v[20:35], a[176:179], v[184:187], v[20:35]
v_mfma_f32_32x32x16_bf16 v[36:51], a[180:183], v[184:187], v[36:51]
buffer_load_dwordx4 v[184:187], v6, s[84:87], s51 offen offset:2048 sc1
s_waitcnt vmcnt(31)
v_mfma_f32_32x32x16_bf16 v[20:35], a[184:187], v[188:191], v[20:35]
v_mfma_f32_32x32x16_bf16 v[36:51], a[188:191], v[188:191], v[36:51]
buffer_load_dwordx4 v[188:191], v6, s[84:87], s51 offen offset:3072 sc1
s_waitcnt vmcnt(31)
v_mfma_f32_32x32x16_bf16 v[20:35], a[192:195], v[192:195], v[20:35]
v_mfma_f32_32x32x16_bf16 v[36:51], a[196:199], v[192:195], v[36:51]
s_add_u32 s51, s56, 24576
s_and_b32 s51, s51, 0x7fff
s_add_u32 s51, s51, s50
buffer_load_dwordx4 v[192:195], v6, s[84:87], s51 offen offset:0 sc1
s_waitcnt vmcnt(31)
v_mfma_f32_32x32x16_bf16 v[20:35], a[200:203], v[196:199], v[20:35]
v_mfma_f32_32x32x16_bf16 v[36:51], a[204:207], v[196:199], v[36:51]
buffer_load_dwordx4 v[196:199], v6, s[84:87], s51 offen offset:1024 sc1
s_waitcnt vmcnt(31)
v_mfma_f32_32x32x16_bf16 v[20:35], a[208:211], v[200:203], v[20:35]
v_mfma_f32_32x32x16_bf16 v[36:51], a[212:215], v[200:203], v[36:51]
buffer_load_dwordx4 v[200:203], v6, s[84:87], s51 offen offset:2048 sc1
s_waitcnt vmcnt(31)
v_mfma_f32_32x32x16_bf16 v[20:35], a[216:219], v[204:207], v[20:35]
v_mfma_f32_32x32x16_bf16 v[36:51], a[220:223], v[204:207], v[36:51]
buffer_load_dwordx4 v[204:207], v6, s[84:87], s51 offen offset:3072 sc1
s_and_b32 s60, s62, s69
s_lshl_b32 s60, s60, 12
buffer_load_dwordx4 v[88:91], v13, s[84:87], s60 offen sc1
s_waitcnt vmcnt(31)
v_mfma_f32_32x32x16_bf16 v[20:35], a[224:227], v[208:211], v[20:35]
v_mfma_f32_32x32x16_bf16 v[36:51], a[228:231], v[208:211], v[36:51]
s_add_u32 s51, s56, 28672
s_and_b32 s51, s51, 0x7fff
s_add_u32 s51, s51, s50
buffer_load_dwordx4 v[208:211], v6, s[84:87], s51 offen offset:0 sc1
s_waitcnt vmcnt(31)
v_mfma_f32_32x32x16_bf16 v[20:35], a[232:235], v[212:215], v[20:35]
v_mfma_f32_32x32x16_bf16 v[36:51], a[236:239], v[212:215], v[36:51]
buffer_load_dwordx4 v[212:215], v6, s[84:87], s51 offen offset:1024 sc1
s_waitcnt vmcnt(31)
v_mfma_f32_32x32x16_bf16 v[20:35], a[240:243], v[216:219], v[20:35]
v_mfma_f32_32x32x16_bf16 v[36:51], a[244:247], v[216:219], v[36:51]
buffer_load_dwordx4 v[216:219], v6, s[84:87], s51 offen offset:2048 sc1
s_waitcnt vmcnt(31)
v_mfma_f32_32x32x16_bf16 v[224:239], a[248:251], v[220:223], v[20:35]
v_mfma_f32_32x32x16_bf16 v[240:255], a[252:255], v[220:223], v[36:51]
buffer_load_dwordx4 v[220:223], v6, s[84:87], s51 offen offset:3072 sc1
s_bfe_u32 s61, s62, 0x10001
s_xor_b32 s61, s61, s67
s_and_b32 s61, s61, s71
s_waitcnt vmcnt(4)
mega_kernel_o_f1c:
v_and_b32 v14, s71, v88
v_cmp_ne_u32 vcc, s61, v14
s_cbranch_vccz mega_kernel_o_f1k
s_and_b32 s60, s62, s69
s_lshl_b32 s60, s60, 12
buffer_load_dwordx4 v[88:91], v13, s[84:87], s60 offen sc1
s_waitcnt vmcnt(0)
s_branch mega_kernel_o_f1c
mega_kernel_o_f1k:
v_pk_add_f32 v[88:89], v[88:89], v[84:85]
v_pk_add_f32 v[90:91], v[90:91], v[86:87]
s_lshl_b32 s60, s62, 17
v_cvt_pk_bf16_f32 v92, v88, v89
v_cvt_pk_bf16_f32 v93, v90, v91
buffer_store_dwordx2 v[92:93], v11, s[8:11], s60 offen sc1
s_add_u32 s42, s42, 1
s_branch mega_kernel_o_w1
mega_kernel_o_n1:
s_waitcnt vmcnt(31)
v_mfma_f32_32x32x16_bf16 v[20:35], a[0:3], v[96:99], 0
v_mfma_f32_32x32x16_bf16 v[36:51], a[4:7], v[96:99], 0
s_waitcnt vmcnt(30)
v_mfma_f32_32x32x16_bf16 v[20:35], a[8:11], v[100:103], v[20:35]
v_mfma_f32_32x32x16_bf16 v[36:51], a[12:15], v[100:103], v[36:51]
v_add_u32 v2, s53, v8
v_add_u32 v3, s53, v9
v_add_u32 v4, s53, v10
s_waitcnt vmcnt(29)
v_mfma_f32_32x32x16_bf16 v[20:35], a[16:19], v[104:107], v[20:35]
v_mfma_f32_32x32x16_bf16 v[36:51], a[20:23], v[104:107], v[36:51]
ds_write_b128 v2, v[224:227] offset:0
ds_write_b128 v2, v[228:231] offset:1088
s_waitcnt vmcnt(28)
v_mfma_f32_32x32x16_bf16 v[20:35], a[24:27], v[108:111], v[20:35]
v_mfma_f32_32x32x16_bf16 v[36:51], a[28:31], v[108:111], v[36:51]
ds_write_b128 v2, v[232:235] offset:2176
ds_write_b128 v2, v[236:239] offset:3264
s_waitcnt vmcnt(27)
v_mfma_f32_32x32x16_bf16 v[20:35], a[32:35], v[112:115], v[20:35]
v_mfma_f32_32x32x16_bf16 v[36:51], a[36:39], v[112:115], v[36:51]
ds_write_b128 v2, v[240:243] offset:4352
ds_write_b128 v2, v[244:247] offset:5440
s_waitcnt vmcnt(26)
v_mfma_f32_32x32x16_bf16 v[20:35], a[40:43], v[116:119], v[20:35]
v_mfma_f32_32x32x16_bf16 v[36:51], a[44:47], v[116:119], v[36:51]
ds_write_b128 v2, v[248:251] offset:6528
ds_write_b128 v2, v[252:255] offset:7616
s_waitcnt vmcnt(25)
v_mfma_f32_32x32x16_bf16 v[20:35], a[48:51], v[120:123], v[20:35]
v_mfma_f32_32x32x16_bf16 v[36:51], a[52:55], v[120:123], v[36:51]
s_waitcnt vmcnt(24)
v_mfma_f32_32x32x16_bf16 v[20:35], a[56:59], v[124:127], v[20:35]
v_mfma_f32_32x32x16_bf16 v[36:51], a[60:63], v[124:127], v[36:51]
s_waitcnt lgkmcnt(0)
s_barrier
ds_read_b128 v[52:55], v4 offset:0
ds_read_b128 v[56:59], v4 offset:8704
ds_read_b128 v[60:63], v4 offset:17408
ds_read_b128 v[64:67], v4 offset:26112
s_waitcnt vmcnt(23)
v_mfma_f32_32x32x16_bf16 v[20:35], a[64:67], v[128:131], v[20:35]
v_mfma_f32_32x32x16_bf16 v[36:51], a[68:71], v[128:131], v[36:51]
ds_read_b128 v[68:71], v3 offset:0
ds_read_b128 v[72:75], v3 offset:8704
ds_read_b128 v[76:79], v3 offset:17408
ds_read_b128 v[80:83], v3 offset:26112
s_sub_u32 s53, 34816, s53
s_bfe_u32 s61, s62, 0x10001
s_xor_b32 s61, s61, s67
s_and_b32 s60, s62, s69
s_lshl_b32 s60, s60, 12
s_waitcnt vmcnt(22)
v_mfma_f32_32x32x16_bf16 v[20:35], a[72:75], v[132:135], v[20:35]
v_mfma_f32_32x32x16_bf16 v[36:51], a[76:79], v[132:135], v[36:51]
s_waitcnt vmcnt(21)
v_mfma_f32_32x32x16_bf16 v[20:35], a[80:83], v[136:139], v[20:35]
v_mfma_f32_32x32x16_bf16 v[36:51], a[84:87], v[136:139], v[36:51]
s_waitcnt lgkmcnt(4)
v_add_f32 v52, v52, v56
v_add_f32 v60, v60, v64
v_add_f32 v53, v53, v57
v_add_f32 v61, v61, v65
v_add_f32 v54, v54, v58
v_add_f32 v62, v62, v66
v_add_f32 v55, v55, v59
v_add_f32 v63, v63, v67
s_waitcnt vmcnt(20)
v_mfma_f32_32x32x16_bf16 v[20:35], a[88:91], v[140:143], v[20:35]
v_mfma_f32_32x32x16_bf16 v[36:51], a[92:95], v[140:143], v[36:51]
v_add_f32 v52, v52, v60
v_add_f32 v53, v53, v61
v_add_f32 v54, v54, v62
v_add_f32 v55, v55, v63
v_and_or_b32 v52, v52, -2, s61
s_cmp_eq_u32 s95, 0
s_cbranch_scc1 mega_kernel_o_sa2
buffer_store_dwordx4 v[52:55], v12, s[84:87], s60 offen sc1
s_branch mega_kernel_o_sb2
mega_kernel_o_sa2:
buffer_store_dwordx4 v[52:55], v12, s[84:87], s60 offen
mega_kernel_o_sb2:
s_waitcnt vmcnt(19)
v_mfma_f32_32x32x16_bf16 v[20:35], a[96:99], v[144:147], v[20:35]
v_mfma_f32_32x32x16_bf16 v[36:51], a[100:103], v[144:147], v[36:51]
s_waitcnt lgkmcnt(0)
v_add_f32 v68, v68, v72
v_add_f32 v76, v76, v80
v_add_f32 v69, v69, v73
v_add_f32 v77, v77, v81
v_add_f32 v70, v70, v74
v_add_f32 v78, v78, v82
v_add_f32 v71, v71, v75
v_add_f32 v79, v79, v83
s_waitcnt vmcnt(18)
v_mfma_f32_32x32x16_bf16 v[20:35], a[104:107], v[148:151], v[20:35]
v_mfma_f32_32x32x16_bf16 v[36:51], a[108:111], v[148:151], v[36:51]
v_add_f32 v84, v68, v76
v_add_f32 v85, v69, v77
v_add_f32 v86, v70, v78
v_add_f32 v87, v71, v79
s_waitcnt vmcnt(17)
v_mfma_f32_32x32x16_bf16 v[20:35], a[112:115], v[152:155], v[20:35]
v_mfma_f32_32x32x16_bf16 v[36:51], a[116:119], v[152:155], v[36:51]
s_waitcnt vmcnt(16)
v_mfma_f32_32x32x16_bf16 v[20:35], a[120:123], v[156:159], v[20:35]
v_mfma_f32_32x32x16_bf16 v[36:51], a[124:127], v[156:159], v[36:51]
s_waitcnt vmcnt(15)
v_mfma_f32_32x32x16_bf16 v[20:35], a[128:131], v[160:163], v[20:35]
v_mfma_f32_32x32x16_bf16 v[36:51], a[132:135], v[160:163], v[36:51]
s_waitcnt vmcnt(14)
v_mfma_f32_32x32x16_bf16 v[20:35], a[136:139], v[164:167], v[20:35]
v_mfma_f32_32x32x16_bf16 v[36:51], a[140:143], v[164:167], v[36:51]
s_waitcnt vmcnt(13)
v_mfma_f32_32x32x16_bf16 v[20:35], a[144:147], v[168:171], v[20:35]
v_mfma_f32_32x32x16_bf16 v[36:51], a[148:151], v[168:171], v[36:51]
s_waitcnt vmcnt(12)
v_mfma_f32_32x32x16_bf16 v[20:35], a[152:155], v[172:175], v[20:35]
v_mfma_f32_32x32x16_bf16 v[36:51], a[156:159], v[172:175], v[36:51]
s_waitcnt vmcnt(11)
v_mfma_f32_32x32x16_bf16 v[20:35], a[160:163], v[176:179], v[20:35]
v_mfma_f32_32x32x16_bf16 v[36:51], a[164:167], v[176:179], v[36:51]
buffer_load_dword v15, v7, s[84:87], 0 offen sc1
s_waitcnt vmcnt(10)
v_mfma_f32_32x32x16_bf16 v[20:35], a[168:171], v[180:183], v[20:35]
v_mfma_f32_32x32x16_bf16 v[36:51], a[172:175], v[180:183], v[36:51]
s_waitcnt vmcnt(9)
v_mfma_f32_32x32x16_bf16 v[20:35], a[176:179], v[184:187], v[20:35]
v_mfma_f32_32x32x16_bf16 v[36:51], a[180:183], v[184:187], v[36:51]
s_waitcnt vmcnt(8)
v_mfma_f32_32x32x16_bf16 v[20:35], a[184:187], v[188:191], v[20:35]
v_mfma_f32_32x32x16_bf16 v[36:51], a[188:191], v[188:191], v[36:51]
s_waitcnt vmcnt(7)
v_mfma_f32_32x32x16_bf16 v[20:35], a[192:195], v[192:195], v[20:35]
v_mfma_f32_32x32x16_bf16 v[36:51], a[196:199], v[192:195], v[36:51]
s_waitcnt vmcnt(6)
v_mfma_f32_32x32x16_bf16 v[20:35], a[200:203], v[196:199], v[20:35]
v_mfma_f32_32x32x16_bf16 v[36:51], a[204:207], v[196:199], v[36:51]
s_waitcnt vmcnt(5)
v_mfma_f32_32x32x16_bf16 v[20:35], a[208:211], v[200:203], v[20:35]
v_mfma_f32_32x32x16_bf16 v[36:51], a[212:215], v[200:203], v[36:51]
s_waitcnt vmcnt(4)
v_mfma_f32_32x32x16_bf16 v[20:35], a[216:219], v[204:207], v[20:35]
v_mfma_f32_32x32x16_bf16 v[36:51], a[220:223], v[204:207], v[36:51]
s_and_b32 s60, s62, s69
s_lshl_b32 s60, s60, 12
buffer_load_dwordx4 v[88:91], v13, s[84:87], s60 offen sc1
s_waitcnt vmcnt(3)
v_mfma_f32_32x32x16_bf16 v[20:35], a[224:227], v[208:211], v[20:35]
v_mfma_f32_32x32x16_bf16 v[36:51], a[228:231], v[208:211], v[36:51]
s_waitcnt vmcnt(2)
v_mfma_f32_32x32x16_bf16 v[20:35], a[232:235], v[212:215], v[20:35]
v_mfma_f32_32x32x16_bf16 v[36:51], a[236:239], v[212:215], v[36:51]
s_waitcnt vmcnt(1)
v_mfma_f32_32x32x16_bf16 v[20:35], a[240:243], v[216:219], v[20:35]
v_mfma_f32_32x32x16_bf16 v[36:51], a[244:247], v[216:219], v[36:51]
s_waitcnt vmcnt(0)
v_mfma_f32_32x32x16_bf16 v[224:239], a[248:251], v[220:223], v[20:35]
v_mfma_f32_32x32x16_bf16 v[240:255], a[252:255], v[220:223], v[36:51]
s_bfe_u32 s61, s62, 0x10001
s_xor_b32 s61, s61, s67
s_and_b32 s61, s61, s71
s_waitcnt vmcnt(0)
mega_kernel_o_f0c:
v_and_b32 v14, s71, v88
v_cmp_ne_u32 vcc, s61, v14
s_cbranch_vccz mega_kernel_o_f0k
s_and_b32 s60, s62, s69
s_lshl_b32 s60, s60, 12
buffer_load_dwordx4 v[88:91], v13, s[84:87], s60 offen sc1
s_waitcnt vmcnt(0)
s_branch mega_kernel_o_f0c
mega_kernel_o_f0k:
v_pk_add_f32 v[88:89], v[88:89], v[84:85]
v_pk_add_f32 v[90:91], v[90:91], v[86:87]
s_lshl_b32 s60, s62, 17
v_cvt_pk_bf16_f32 v92, v88, v89
v_cvt_pk_bf16_f32 v93, v90, v91
buffer_store_dwordx2 v[92:93], v11, s[8:11], s60 offen sc1
mega_kernel_o_imm:
s_waitcnt vmcnt(1)
v_min_i32_dpp v15, v15, v15 quad_perm:[1,0,3,2] row_mask:0xf bank_mask:0xf
s_nop 1
v_min_i32_dpp v15, v15, v15 quad_perm:[2,3,0,1] row_mask:0xf bank_mask:0xf
s_nop 1
v_min_i32_dpp v15, v15, v15 row_ror:4 row_mask:0xf bank_mask:0xf
s_nop 1
v_min_i32_dpp v15, v15, v15 row_ror:8 row_mask:0xf bank_mask:0xf
s_nop 0
v_readfirstlane_b32 s52, v15
s_min_i32 s52, s52, s65
s_cmp_gt_i32 s52, s54
s_cbranch_scc0 mega_kernel_o_im2
s_add_u32 s42, s42, 1
s_add_u32 s54, s54, 1
s_cmp_gt_i32 s52, s54
s_cbranch_scc0 mega_kernel_o_c1
s_add_u32 s51, s56, 0
s_and_b32 s51, s51, 0x7fff
s_add_u32 s51, s51, s50
buffer_load_dwordx4 v[96:99], v6, s[84:87], s51 offen offset:0 sc1
buffer_load_dwordx4 v[100:103], v6, s[84:87], s51 offen offset:1024 sc1
buffer_load_dwordx4 v[104:107], v6, s[84:87], s51 offen offset:2048 sc1
buffer_load_dwordx4 v[108:111], v6, s[84:87], s51 offen offset:3072 sc1
s_add_u32 s51, s56, 4096
s_and_b32 s51, s51, 0x7fff
s_add_u32 s51, s51, s50
buffer_load_dwordx4 v[112:115], v6, s[84:87], s51 offen offset:0 sc1
buffer_load_dwordx4 v[116:119], v6, s[84:87], s51 offen offset:1024 sc1
buffer_load_dwordx4 v[120:123], v6, s[84:87], s51 offen offset:2048 sc1
buffer_load_dwordx4 v[124:127], v6, s[84:87], s51 offen offset:3072 sc1
s_add_u32 s51, s56, 8192
s_and_b32 s51, s51, 0x7fff
s_add_u32 s51, s51, s50
buffer_load_dwordx4 v[128:131], v6, s[84:87], s51 offen offset:0 sc1
buffer_load_dwordx4 v[132:135], v6, s[84:87], s51 offen offset:1024 sc1
buffer_load_dwordx4 v[136:139], v6, s[84:87], s51 offen offset:2048 sc1
buffer_load_dwordx4 v[140:143], v6, s[84:87], s51 offen offset:3072 sc1
s_add_u32 s51, s56, 12288
s_and_b32 s51, s51, 0x7fff
s_add_u32 s51, s51, s50
buffer_load_dwordx4 v[144:147], v6, s[84:87], s51 offen offset:0 sc1
buffer_load_dwordx4 v[148:151], v6, s[84:87], s51 offen offset:1024 sc1
buffer_load_dwordx4 v[152:155], v6, s[84:87], s51 offen offset:2048 sc1
buffer_load_dwordx4 v[156:159], v6, s[84:87], s51 offen offset:3072 sc1
s_add_u32 s51, s56, 16384
s_and_b32 s51, s51, 0x7fff
s_add_u32 s51, s51, s50
buffer_load_dwordx4 v[160:163], v6, s[84:87], s51 offen offset:0 sc1
buffer_load_dwordx4 v[164:167], v6, s[84:87], s51 offen offset:1024 sc1
buffer_load_dwordx4 v[168:171], v6, s[84:87], s51 offen offset:2048 sc1
buffer_load_dwordx4 v[172:175], v6, s[84:87], s51 offen offset:3072 sc1
s_add_u32 s51, s56, 20480
s_and_b32 s51, s51, 0x7fff
s_add_u32 s51, s51, s50
buffer_load_dwordx4 v[176:179], v6, s[84:87], s51 offen offset:0 sc1
buffer_load_dwordx4 v[180:183], v6, s[84:87], s51 offen offset:1024 sc1
buffer_load_dwordx4 v[184:187], v6, s[84:87], s51 offen offset:2048 sc1
buffer_load_dwordx4 v[188:191], v6, s[84:87], s51 offen offset:3072 sc1
s_add_u32 s51, s56, 24576
s_and_b32 s51, s51, 0x7fff
s_add_u32 s51, s51, s50
buffer_load_dwordx4 v[192:195], v6, s[84:87], s51 offen offset:0 sc1
buffer_load_dwordx4 v[196:199], v6, s[84:87], s51 offen offset:1024 sc1
buffer_load_dwordx4 v[200:203], v6, s[84:87], s51 offen offset:2048 sc1
buffer_load_dwordx4 v[204:207], v6, s[84:87], s51 offen offset:3072 sc1
s_add_u32 s51, s56, 28672
s_and_b32 s51, s51, 0x7fff
s_add_u32 s51, s51, s50
buffer_load_dwordx4 v[208:211], v6, s[84:87], s51 offen offset:0 sc1
buffer_load_dwordx4 v[212:215], v6, s[84:87], s51 offen offset:1024 sc1
buffer_load_dwordx4 v[216:219], v6, s[84:87], s51 offen offset:2048 sc1
buffer_load_dwordx4 v[220:223], v6, s[84:87], s51 offen offset:3072 sc1
s_branch mega_kernel_o_w1
mega_kernel_o_c0:
s_add_u32 s54, s42, 1
s_sub_u32 s62, s42, 1
s_lshl_b32 s50, s42, 18
s_add_u32 s51, s56, 0
s_and_b32 s51, s51, 0x7fff
s_add_u32 s51, s51, s50
buffer_load_dwordx4 v[96:99], v6, s[84:87], s51 offen offset:0 sc1
buffer_load_dwordx4 v[100:103], v6, s[84:87], s51 offen offset:1024 sc1
buffer_load_dwordx4 v[104:107], v6, s[84:87], s51 offen offset:2048 sc1
buffer_load_dwordx4 v[108:111], v6, s[84:87], s51 offen offset:3072 sc1
s_add_u32 s51, s56, 4096
s_and_b32 s51, s51, 0x7fff
s_add_u32 s51, s51, s50
buffer_load_dwordx4 v[112:115], v6, s[84:87], s51 offen offset:0 sc1
buffer_load_dwordx4 v[116:119], v6, s[84:87], s51 offen offset:1024 sc1
buffer_load_dwordx4 v[120:123], v6, s[84:87], s51 offen offset:2048 sc1
buffer_load_dwordx4 v[124:127], v6, s[84:87], s51 offen offset:3072 sc1
s_waitcnt vmcnt(7)
v_mfma_f32_32x32x16_bf16 v[20:35], a[0:3], v[96:99], 0
v_mfma_f32_32x32x16_bf16 v[36:51], a[4:7], v[96:99], 0
s_add_u32 s51, s56, 8192
s_and_b32 s51, s51, 0x7fff
s_add_u32 s51, s51, s50
buffer_load_dwordx4 v[128:131], v6, s[84:87], s51 offen offset:0 sc1
s_waitcnt vmcnt(7)
v_mfma_f32_32x32x16_bf16 v[20:35], a[8:11], v[100:103], v[20:35]
v_mfma_f32_32x32x16_bf16 v[36:51], a[12:15], v[100:103], v[36:51]
buffer_load_dwordx4 v[132:135], v6, s[84:87], s51 offen offset:1024 sc1
s_waitcnt vmcnt(7)
v_mfma_f32_32x32x16_bf16 v[20:35], a[16:19], v[104:107], v[20:35]
v_mfma_f32_32x32x16_bf16 v[36:51], a[20:23], v[104:107], v[36:51]
buffer_load_dwordx4 v[136:139], v6, s[84:87], s51 offen offset:2048 sc1
s_waitcnt vmcnt(7)
v_mfma_f32_32x32x16_bf16 v[20:35], a[24:27], v[108:111], v[20:35]
v_mfma_f32_32x32x16_bf16 v[36:51], a[28:31], v[108:111], v[36:51]
buffer_load_dwordx4 v[140:143], v6, s[84:87], s51 offen offset:3072 sc1
s_waitcnt vmcnt(7)
v_mfma_f32_32x32x16_bf16 v[20:35], a[32:35], v[112:115], v[20:35]
v_mfma_f32_32x32x16_bf16 v[36:51], a[36:39], v[112:115], v[36:51]
s_add_u32 s51, s56, 12288
s_and_b32 s51, s51, 0x7fff
s_add_u32 s51, s51, s50
buffer_load_dwordx4 v[144:147], v6, s[84:87], s51 offen offset:0 sc1
s_waitcnt vmcnt(7)
v_mfma_f32_32x32x16_bf16 v[20:35], a[40:43], v[116:119], v[20:35]
v_mfma_f32_32x32x16_bf16 v[36:51], a[44:47], v[116:119], v[36:51]
buffer_load_dwordx4 v[148:151], v6, s[84:87], s51 offen offset:1024 sc1
s_waitcnt vmcnt(7)
v_mfma_f32_32x32x16_bf16 v[20:35], a[48:51], v[120:123], v[20:35]
v_mfma_f32_32x32x16_bf16 v[36:51], a[52:55], v[120:123], v[36:51]
buffer_load_dwordx4 v[152:155], v6, s[84:87], s51 offen offset:2048 sc1
s_waitcnt vmcnt(7)
v_mfma_f32_32x32x16_bf16 v[20:35], a[56:59], v[124:127], v[20:35]
v_mfma_f32_32x32x16_bf16 v[36:51], a[60:63], v[124:127], v[36:51]
buffer_load_dwordx4 v[156:159], v6, s[84:87], s51 offen offset:3072 sc1
s_waitcnt vmcnt(7)
v_mfma_f32_32x32x16_bf16 v[20:35], a[64:67], v[128:131], v[20:35]
v_mfma_f32_32x32x16_bf16 v[36:51], a[68:71], v[128:131], v[36:51]
s_add_u32 s51, s56, 16384
s_and_b32 s51, s51, 0x7fff
s_add_u32 s51, s51, s50
buffer_load_dwordx4 v[160:163], v6, s[84:87], s51 offen offset:0 sc1
s_waitcnt vmcnt(7)
v_mfma_f32_32x32x16_bf16 v[20:35], a[72:75], v[132:135], v[20:35]
v_mfma_f32_32x32x16_bf16 v[36:51], a[76:79], v[132:135], v[36:51]
buffer_load_dwordx4 v[164:167], v6, s[84:87], s51 offen offset:1024 sc1
s_waitcnt vmcnt(7)
v_mfma_f32_32x32x16_bf16 v[20:35], a[80:83], v[136:139], v[20:35]
v_mfma_f32_32x32x16_bf16 v[36:51], a[84:87], v[136:139], v[36:51]
buffer_load_dwordx4 v[168:171], v6, s[84:87], s51 offen offset:2048 sc1
s_waitcnt vmcnt(7)
v_mfma_f32_32x32x16_bf16 v[20:35], a[88:91], v[140:143], v[20:35]
v_mfma_f32_32x32x16_bf16 v[36:51], a[92:95], v[140:143], v[36:51]
buffer_load_dwordx4 v[172:175], v6, s[84:87], s51 offen offset:3072 sc1
s_waitcnt vmcnt(7)
v_mfma_f32_32x32x16_bf16 v[20:35], a[96:99], v[144:147], v[20:35]
v_mfma_f32_32x32x16_bf16 v[36:51], a[100:103], v[144:147], v[36:51]
s_add_u32 s51, s56, 20480
s_and_b32 s51, s51, 0x7fff
s_add_u32 s51, s51, s50
buffer_load_dwordx4 v[176:179], v6, s[84:87], s51 offen offset:0 sc1
s_waitcnt vmcnt(7)
v_mfma_f32_32x32x16_bf16 v[20:35], a[104:107], v[148:151], v[20:35]
v_mfma_f32_32x32x16_bf16 v[36:51], a[108:111], v[148:151], v[36:51]
buffer_load_dwordx4 v[180:183], v6, s[84:87], s51 offen offset:1024 sc1
s_waitcnt vmcnt(7)
v_mfma_f32_32x32x16_bf16 v[20:35], a[112:115], v[152:155], v[20:35]
v_mfma_f32_32x32x16_bf16 v[36:51], a[116:119], v[152:155], v[36:51]
buffer_load_dwordx4 v[184:187], v6, s[84:87], s51 offen offset:2048 sc1
s_waitcnt vmcnt(7)
v_mfma_f32_32x32x16_bf16 v[20:35], a[120:123], v[156:159], v[20:35]
v_mfma_f32_32x32x16_bf16 v[36:51], a[124:127], v[156:159], v[36:51]
buffer_load_dwordx4 v[188:191], v6, s[84:87], s51 offen offset:3072 sc1
s_waitcnt vmcnt(7)
v_mfma_f32_32x32x16_bf16 v[20:35], a[128:131], v[160:163], v[20:35]
v_mfma_f32_32x32x16_bf16 v[36:51], a[132:135], v[160:163], v[36:51]
s_add_u32 s51, s56, 24576
s_and_b32 s51, s51, 0x7fff
s_add_u32 s51, s51, s50
buffer_load_dwordx4 v[192:195], v6, s[84:87], s51 offen offset:0 sc1
s_waitcnt vmcnt(7)
v_mfma_f32_32x32x16_bf16 v[20:35], a[136:139], v[164:167], v[20:35]
v_mfma_f32_32x32x16_bf16 v[36:51], a[140:143], v[164:167], v[36:51]
buffer_load_dwordx4 v[196:199], v6, s[84:87], s51 offen offset:1024 sc1
s_waitcnt vmcnt(7)
v_mfma_f32_32x32x16_bf16 v[20:35], a[144:147], v[168:171], v[20:35]
v_mfma_f32_32x32x16_bf16 v[36:51], a[148:151], v[168:171], v[36:51]
buffer_load_dwordx4 v[200:203], v6, s[84:87], s51 offen offset:2048 sc1
s_waitcnt vmcnt(7)
v_mfma_f32_32x32x16_bf16 v[20:35], a[152:155], v[172:175], v[20:35]
v_mfma_f32_32x32x16_bf16 v[36:51], a[156:159], v[172:175], v[36:51]
buffer_load_dwordx4 v[204:207], v6, s[84:87], s51 offen offset:3072 sc1
s_waitcnt vmcnt(7)
v_mfma_f32_32x32x16_bf16 v[20:35], a[160:163], v[176:179], v[20:35]
v_mfma_f32_32x32x16_bf16 v[36:51], a[164:167], v[176:179], v[36:51]
s_add_u32 s51, s56, 28672
s_and_b32 s51, s51, 0x7fff
s_add_u32 s51, s51, s50
buffer_load_dwordx4 v[208:211], v6, s[84:87], s51 offen offset:0 sc1
s_waitcnt vmcnt(7)
v_mfma_f32_32x32x16_bf16 v[20:35], a[168:171], v[180:183], v[20:35]
v_mfma_f32_32x32x16_bf16 v[36:51], a[172:175], v[180:183], v[36:51]
buffer_load_dwordx4 v[212:215], v6, s[84:87], s51 offen offset:1024 sc1
s_waitcnt vmcnt(7)
v_mfma_f32_32x32x16_bf16 v[20:35], a[176:179], v[184:187], v[20:35]
v_mfma_f32_32x32x16_bf16 v[36:51], a[180:183], v[184:187], v[36:51]
buffer_load_dwordx4 v[216:219], v6, s[84:87], s51 offen offset:2048 sc1
s_waitcnt vmcnt(7)
v_mfma_f32_32x32x16_bf16 v[20:35], a[184:187], v[188:191], v[20:35]
v_mfma_f32_32x32x16_bf16 v[36:51], a[188:191], v[188:191], v[36:51]
buffer_load_dwordx4 v[220:223], v6, s[84:87], s51 offen offset:3072 sc1
s_waitcnt vmcnt(7)
v_mfma_f32_32x32x16_bf16 v[20:35], a[192:195], v[192:195], v[20:35]
v_mfma_f32_32x32x16_bf16 v[36:51], a[196:199], v[192:195], v[36:51]
buffer_load_dword v15, v7, s[84:87], 0 offen sc1
s_waitcnt vmcnt(6)
v_mfma_f32_32x32x16_bf16 v[20:35], a[200:203], v[196:199], v[20:35]
v_mfma_f32_32x32x16_bf16 v[36:51], a[204:207], v[196:199], v[36:51]
s_waitcnt vmcnt(5)
v_mfma_f32_32x32x16_bf16 v[20:35], a[208:211], v[200:203], v[20:35]
v_mfma_f32_32x32x16_bf16 v[36:51], a[212:215], v[200:203], v[36:51]
s_waitcnt vmcnt(4)
v_mfma_f32_32x32x16_bf16 v[20:35], a[216:219], v[204:207], v[20:35]
v_mfma_f32_32x32x16_bf16 v[36:51], a[220:223], v[204:207], v[36:51]
s_waitcnt vmcnt(3)
v_mfma_f32_32x32x16_bf16 v[20:35], a[224:227], v[208:211], v[20:35]
v_mfma_f32_32x32x16_bf16 v[36:51], a[228:231], v[208:211], v[36:51]
s_waitcnt vmcnt(2)
v_mfma_f32_32x32x16_bf16 v[20:35], a[232:235], v[212:215], v[20:35]
v_mfma_f32_32x32x16_bf16 v[36:51], a[236:239], v[212:215], v[36:51]
s_waitcnt vmcnt(1)
v_mfma_f32_32x32x16_bf16 v[20:35], a[240:243], v[216:219], v[20:35]
v_mfma_f32_32x32x16_bf16 v[36:51], a[244:247], v[216:219], v[36:51]
s_waitcnt vmcnt(0)
v_mfma_f32_32x32x16_bf16 v[224:239], a[248:251], v[220:223], v[20:35]
v_mfma_f32_32x32x16_bf16 v[240:255], a[252:255], v[220:223], v[36:51]
s_lshl_b32 s50, s54, 18
s_branch mega_kernel_o_imm
mega_kernel_o_c1:
s_add_u32 s54, s42, 1
s_sub_u32 s62, s42, 1
s_lshl_b32 s50, s42, 18
s_add_u32 s51, s56, 0
s_and_b32 s51, s51, 0x7fff
s_add_u32 s51, s51, s50
buffer_load_dwordx4 v[96:99], v6, s[84:87], s51 offen offset:0 sc1
buffer_load_dwordx4 v[100:103], v6, s[84:87], s51 offen offset:1024 sc1
buffer_load_dwordx4 v[104:107], v6, s[84:87], s51 offen offset:2048 sc1
buffer_load_dwordx4 v[108:111], v6, s[84:87], s51 offen offset:3072 sc1
s_add_u32 s51, s56, 4096
s_and_b32 s51, s51, 0x7fff
s_add_u32 s51, s51, s50
buffer_load_dwordx4 v[112:115], v6, s[84:87], s51 offen offset:0 sc1
buffer_load_dwordx4 v[116:119], v6, s[84:87], s51 offen offset:1024 sc1
buffer_load_dwordx4 v[120:123], v6, s[84:87], s51 offen offset:2048 sc1
buffer_load_dwordx4 v[124:127], v6, s[84:87], s51 offen offset:3072 sc1
v_add_u32 v2, s53, v8
v_add_u32 v3, s53, v9
v_add_u32 v4, s53, v10
ds_write_b128 v2, v[224:227] offset:0
ds_write_b128 v2, v[228:231] offset:1088
ds_write_b128 v2, v[232:235] offset:2176
ds_write_b128 v2, v[236:239] offset:3264
ds_write_b128 v2, v[240:243] offset:4352
ds_write_b128 v2, v[244:247] offset:5440
ds_write_b128 v2, v[248:251] offset:6528
ds_write_b128 v2, v[252:255] offset:7616
s_waitcnt lgkmcnt(0)
s_barrier
ds_read_b128 v[52:55], v4 offset:0
ds_read_b128 v[56:59], v4 offset:8704
ds_read_b128 v[60:63], v4 offset:17408
ds_read_b128 v[64:67], v4 offset:26112
ds_read_b128 v[68:71], v3 offset:0
ds_read_b128 v[72:75], v3 offset:8704
ds_read_b128 v[76:79], v3 offset:17408
ds_read_b128 v[80:83], v3 offset:26112
s_sub_u32 s53, 34816, s53
s_bfe_u32 s61, s62, 0x10001
s_xor_b32 s61, s61, s67
s_and_b32 s60, s62, s69
s_lshl_b32 s60, s60, 12
s_waitcnt lgkmcnt(4)
v_add_f32 v52, v52, v56
v_add_f32 v60, v60, v64
v_add_f32 v53, v53, v57
v_add_f32 v61, v61, v65
v_add_f32 v54, v54, v58
v_add_f32 v62, v62, v66
v_add_f32 v55, v55, v59
v_add_f32 v63, v63, v67
v_add_f32 v52, v52, v60
v_add_f32 v53, v53, v61
v_add_f32 v54, v54, v62
v_add_f32 v55, v55, v63
v_and_or_b32 v52, v52, -2, s61
s_cmp_eq_u32 s95, 0
s_cbranch_scc1 mega_kernel_o_sa3
buffer_store_dwordx4 v[52:55], v12, s[84:87], s60 offen sc1
s_branch mega_kernel_o_sb3
mega_kernel_o_sa3:
buffer_store_dwordx4 v[52:55], v12, s[84:87], s60 offen
mega_kernel_o_sb3:
s_waitcnt lgkmcnt(0)
v_add_f32 v68, v68, v72
v_add_f32 v76, v76, v80
v_add_f32 v69, v69, v73
v_add_f32 v77, v77, v81
v_add_f32 v70, v70, v74
v_add_f32 v78, v78, v82
v_add_f32 v71, v71, v75
v_add_f32 v79, v79, v83
v_add_f32 v84, v68, v76
v_add_f32 v85, v69, v77
v_add_f32 v86, v70, v78
v_add_f32 v87, v71, v79
s_waitcnt vmcnt(7)
v_mfma_f32_32x32x16_bf16 v[20:35], a[0:3], v[96:99], 0
v_mfma_f32_32x32x16_bf16 v[36:51], a[4:7], v[96:99], 0
s_add_u32 s51, s56, 8192
s_and_b32 s51, s51, 0x7fff
s_add_u32 s51, s51, s50
buffer_load_dwordx4 v[128:131], v6, s[84:87], s51 offen offset:0 sc1
s_waitcnt vmcnt(7)
v_mfma_f32_32x32x16_bf16 v[20:35], a[8:11], v[100:103], v[20:35]
v_mfma_f32_32x32x16_bf16 v[36:51], a[12:15], v[100:103], v[36:51]
buffer_load_dwordx4 v[132:135], v6, s[84:87], s51 offen offset:1024 sc1
s_waitcnt vmcnt(7)
v_mfma_f32_32x32x16_bf16 v[20:35], a[16:19], v[104:107], v[20:35]
v_mfma_f32_32x32x16_bf16 v[36:51], a[20:23], v[104:107], v[36:51]
buffer_load_dwordx4 v[136:139], v6, s[84:87], s51 offen offset:2048 sc1
s_waitcnt vmcnt(7)
v_mfma_f32_32x32x16_bf16 v[20:35], a[24:27], v[108:111], v[20:35]
v_mfma_f32_32x32x16_bf16 v[36:51], a[28:31], v[108:111], v[36:51]
buffer_load_dwordx4 v[140:143], v6, s[84:87], s51 offen offset:3072 sc1
s_waitcnt vmcnt(7)
v_mfma_f32_32x32x16_bf16 v[20:35], a[32:35], v[112:115], v[20:35]
v_mfma_f32_32x32x16_bf16 v[36:51], a[36:39], v[112:115], v[36:51]
s_add_u32 s51, s56, 12288
s_and_b32 s51, s51, 0x7fff
s_add_u32 s51, s51, s50
buffer_load_dwordx4 v[144:147], v6, s[84:87], s51 offen offset:0 sc1
s_waitcnt vmcnt(7)
v_mfma_f32_32x32x16_bf16 v[20:35], a[40:43], v[116:119], v[20:35]
v_mfma_f32_32x32x16_bf16 v[36:51], a[44:47], v[116:119], v[36:51]
buffer_load_dwordx4 v[148:151], v6, s[84:87], s51 offen offset:1024 sc1
s_waitcnt vmcnt(7)
v_mfma_f32_32x32x16_bf16 v[20:35], a[48:51], v[120:123], v[20:35]
v_mfma_f32_32x32x16_bf16 v[36:51], a[52:55], v[120:123], v[36:51]
buffer_load_dwordx4 v[152:155], v6, s[84:87], s51 offen offset:2048 sc1
s_waitcnt vmcnt(7)
v_mfma_f32_32x32x16_bf16 v[20:35], a[56:59], v[124:127], v[20:35]
v_mfma_f32_32x32x16_bf16 v[36:51], a[60:63], v[124:127], v[36:51]
buffer_load_dwordx4 v[156:159], v6, s[84:87], s51 offen offset:3072 sc1
s_waitcnt vmcnt(7)
v_mfma_f32_32x32x16_bf16 v[20:35], a[64:67], v[128:131], v[20:35]
v_mfma_f32_32x32x16_bf16 v[36:51], a[68:71], v[128:131], v[36:51]
s_add_u32 s51, s56, 16384
s_and_b32 s51, s51, 0x7fff
s_add_u32 s51, s51, s50
buffer_load_dwordx4 v[160:163], v6, s[84:87], s51 offen offset:0 sc1
s_waitcnt vmcnt(7)
v_mfma_f32_32x32x16_bf16 v[20:35], a[72:75], v[132:135], v[20:35]
v_mfma_f32_32x32x16_bf16 v[36:51], a[76:79], v[132:135], v[36:51]
buffer_load_dwordx4 v[164:167], v6, s[84:87], s51 offen offset:1024 sc1
s_waitcnt vmcnt(7)
v_mfma_f32_32x32x16_bf16 v[20:35], a[80:83], v[136:139], v[20:35]
v_mfma_f32_32x32x16_bf16 v[36:51], a[84:87], v[136:139], v[36:51]
buffer_load_dwordx4 v[168:171], v6, s[84:87], s51 offen offset:2048 sc1
s_waitcnt vmcnt(7)
v_mfma_f32_32x32x16_bf16 v[20:35], a[88:91], v[140:143], v[20:35]
v_mfma_f32_32x32x16_bf16 v[36:51], a[92:95], v[140:143], v[36:51]
buffer_load_dwordx4 v[172:175], v6, s[84:87], s51 offen offset:3072 sc1
s_waitcnt vmcnt(7)
v_mfma_f32_32x32x16_bf16 v[20:35], a[96:99], v[144:147], v[20:35]
v_mfma_f32_32x32x16_bf16 v[36:51], a[100:103], v[144:147], v[36:51]
s_add_u32 s51, s56, 20480
s_and_b32 s51, s51, 0x7fff
s_add_u32 s51, s51, s50
buffer_load_dwordx4 v[176:179], v6, s[84:87], s51 offen offset:0 sc1
s_waitcnt vmcnt(7)
v_mfma_f32_32x32x16_bf16 v[20:35], a[104:107], v[148:151], v[20:35]
v_mfma_f32_32x32x16_bf16 v[36:51], a[108:111], v[148:151], v[36:51]
buffer_load_dwordx4 v[180:183], v6, s[84:87], s51 offen offset:1024 sc1
s_waitcnt vmcnt(7)
v_mfma_f32_32x32x16_bf16 v[20:35], a[112:115], v[152:155], v[20:35]
v_mfma_f32_32x32x16_bf16 v[36:51], a[116:119], v[152:155], v[36:51]
buffer_load_dwordx4 v[184:187], v6, s[84:87], s51 offen offset:2048 sc1
s_waitcnt vmcnt(7)
v_mfma_f32_32x32x16_bf16 v[20:35], a[120:123], v[156:159], v[20:35]
v_mfma_f32_32x32x16_bf16 v[36:51], a[124:127], v[156:159], v[36:51]
buffer_load_dwordx4 v[188:191], v6, s[84:87], s51 offen offset:3072 sc1
s_waitcnt vmcnt(7)
v_mfma_f32_32x32x16_bf16 v[20:35], a[128:131], v[160:163], v[20:35]
v_mfma_f32_32x32x16_bf16 v[36:51], a[132:135], v[160:163], v[36:51]
s_add_u32 s51, s56, 24576
s_and_b32 s51, s51, 0x7fff
s_add_u32 s51, s51, s50
buffer_load_dwordx4 v[192:195], v6, s[84:87], s51 offen offset:0 sc1
s_waitcnt vmcnt(7)
v_mfma_f32_32x32x16_bf16 v[20:35], a[136:139], v[164:167], v[20:35]
v_mfma_f32_32x32x16_bf16 v[36:51], a[140:143], v[164:167], v[36:51]
buffer_load_dwordx4 v[196:199], v6, s[84:87], s51 offen offset:1024 sc1
s_waitcnt vmcnt(7)
v_mfma_f32_32x32x16_bf16 v[20:35], a[144:147], v[168:171], v[20:35]
v_mfma_f32_32x32x16_bf16 v[36:51], a[148:151], v[168:171], v[36:51]
buffer_load_dwordx4 v[200:203], v6, s[84:87], s51 offen offset:2048 sc1
s_waitcnt vmcnt(7)
v_mfma_f32_32x32x16_bf16 v[20:35], a[152:155], v[172:175], v[20:35]
v_mfma_f32_32x32x16_bf16 v[36:51], a[156:159], v[172:175], v[36:51]
buffer_load_dwordx4 v[204:207], v6, s[84:87], s51 offen offset:3072 sc1
s_waitcnt vmcnt(7)
v_mfma_f32_32x32x16_bf16 v[20:35], a[160:163], v[176:179], v[20:35]
v_mfma_f32_32x32x16_bf16 v[36:51], a[164:167], v[176:179], v[36:51]
s_add_u32 s51, s56, 28672
s_and_b32 s51, s51, 0x7fff
s_add_u32 s51, s51, s50
buffer_load_dwordx4 v[208:211], v6, s[84:87], s51 offen offset:0 sc1
s_waitcnt vmcnt(7)
v_mfma_f32_32x32x16_bf16 v[20:35], a[168:171], v[180:183], v[20:35]
v_mfma_f32_32x32x16_bf16 v[36:51], a[172:175], v[180:183], v[36:51]
buffer_load_dwordx4 v[212:215], v6, s[84:87], s51 offen offset:1024 sc1
s_waitcnt vmcnt(7)
v_mfma_f32_32x32x16_bf16 v[20:35], a[176:179], v[184:187], v[20:35]
v_mfma_f32_32x32x16_bf16 v[36:51], a[180:183], v[184:187], v[36:51]
buffer_load_dwordx4 v[216:219], v6, s[84:87], s51 offen offset:2048 sc1
s_waitcnt vmcnt(7)
v_mfma_f32_32x32x16_bf16 v[20:35], a[184:187], v[188:191], v[20:35]
v_mfma_f32_32x32x16_bf16 v[36:51], a[188:191], v[188:191], v[36:51]
buffer_load_dwordx4 v[220:223], v6, s[84:87], s51 offen offset:3072 sc1
s_waitcnt vmcnt(7)
v_mfma_f32_32x32x16_bf16 v[20:35], a[192:195], v[192:195], v[20:35]
v_mfma_f32_32x32x16_bf16 v[36:51], a[196:199], v[192:195], v[36:51]
s_and_b32 s60, s62, s69
s_lshl_b32 s60, s60, 12
buffer_load_dwordx4 v[88:91], v13, s[84:87], s60 offen sc1
buffer_load_dword v15, v7, s[84:87], 0 offen sc1
s_waitcnt vmcnt(6)
v_mfma_f32_32x32x16_bf16 v[20:35], a[200:203], v[196:199], v[20:35]
v_mfma_f32_32x32x16_bf16 v[36:51], a[204:207], v[196:199], v[36:51]
s_waitcnt vmcnt(5)
v_mfma_f32_32x32x16_bf16 v[20:35], a[208:211], v[200:203], v[20:35]
v_mfma_f32_32x32x16_bf16 v[36:51], a[212:215], v[200:203], v[36:51]
s_waitcnt vmcnt(4)
v_mfma_f32_32x32x16_bf16 v[20:35], a[216:219], v[204:207], v[20:35]
v_mfma_f32_32x32x16_bf16 v[36:51], a[220:223], v[204:207], v[36:51]
s_waitcnt vmcnt(3)
v_mfma_f32_32x32x16_bf16 v[20:35], a[224:227], v[208:211], v[20:35]
v_mfma_f32_32x32x16_bf16 v[36:51], a[228:231], v[208:211], v[36:51]
s_waitcnt vmcnt(2)
v_mfma_f32_32x32x16_bf16 v[20:35], a[232:235], v[212:215], v[20:35]
v_mfma_f32_32x32x16_bf16 v[36:51], a[236:239], v[212:215], v[36:51]
s_waitcnt vmcnt(1)
v_mfma_f32_32x32x16_bf16 v[20:35], a[240:243], v[216:219], v[20:35]
v_mfma_f32_32x32x16_bf16 v[36:51], a[244:247], v[216:219], v[36:51]
s_waitcnt vmcnt(0)
v_mfma_f32_32x32x16_bf16 v[224:239], a[248:251], v[220:223], v[20:35]
v_mfma_f32_32x32x16_bf16 v[240:255], a[252:255], v[220:223], v[36:51]
s_bfe_u32 s61, s62, 0x10001
s_xor_b32 s61, s61, s67
s_and_b32 s61, s61, s71
s_waitcnt vmcnt(0)
mega_kernel_o_fcc:
v_and_b32 v14, s71, v88
v_cmp_ne_u32 vcc, s61, v14
s_cbranch_vccz mega_kernel_o_fck
s_and_b32 s60, s62, s69
s_lshl_b32 s60, s60, 12
buffer_load_dwordx4 v[88:91], v13, s[84:87], s60 offen sc1
s_waitcnt vmcnt(0)
s_branch mega_kernel_o_fcc
mega_kernel_o_fck:
v_pk_add_f32 v[88:89], v[88:89], v[84:85]
v_pk_add_f32 v[90:91], v[90:91], v[86:87]
s_lshl_b32 s60, s62, 17
v_cvt_pk_bf16_f32 v92, v88, v89
v_cvt_pk_bf16_f32 v93, v90, v91
buffer_store_dwordx2 v[92:93], v11, s[8:11], s60 offen sc1
s_lshl_b32 s50, s54, 18
s_branch mega_kernel_o_imm
mega_kernel_o_im2:
v_add_u32 v2, s53, v8
v_add_u32 v3, s53, v9
v_add_u32 v4, s53, v10
ds_write_b128 v2, v[224:227] offset:0
ds_write_b128 v2, v[228:231] offset:1088
ds_write_b128 v2, v[232:235] offset:2176
ds_write_b128 v2, v[236:239] offset:3264
ds_write_b128 v2, v[240:243] offset:4352
ds_write_b128 v2, v[244:247] offset:5440
ds_write_b128 v2, v[248:251] offset:6528
ds_write_b128 v2, v[252:255] offset:7616
s_waitcnt lgkmcnt(0)
s_barrier
ds_read_b128 v[52:55], v4 offset:0
ds_read_b128 v[56:59], v4 offset:8704
ds_read_b128 v[60:63], v4 offset:17408
ds_read_b128 v[64:67], v4 offset:26112
ds_read_b128 v[68:71], v3 offset:0
ds_read_b128 v[72:75], v3 offset:8704
ds_read_b128 v[76:79], v3 offset:17408
ds_read_b128 v[80:83], v3 offset:26112
s_sub_u32 s53, 34816, s53
s_bfe_u32 s61, s42, 0x10001
s_xor_b32 s61, s61, s67
s_and_b32 s60, s42, s69
s_lshl_b32 s60, s60, 12
s_waitcnt lgkmcnt(4)
v_add_f32 v52, v52, v56
v_add_f32 v60, v60, v64
v_add_f32 v53, v53, v57
v_add_f32 v61, v61, v65
v_add_f32 v54, v54, v58
v_add_f32 v62, v62, v66
v_add_f32 v55, v55, v59
v_add_f32 v63, v63, v67
v_add_f32 v52, v52, v60
v_add_f32 v53, v53, v61
v_add_f32 v54, v54, v62
v_add_f32 v55, v55, v63
v_and_or_b32 v52, v52, -2, s61
s_cmp_eq_u32 s95, 0
s_cbranch_scc1 mega_kernel_o_sa4
buffer_store_dwordx4 v[52:55], v12, s[84:87], s60 offen sc1
s_branch mega_kernel_o_sb4
mega_kernel_o_sa4:
buffer_store_dwordx4 v[52:55], v12, s[84:87], s60 offen
mega_kernel_o_sb4:
s_waitcnt lgkmcnt(0)
v_add_f32 v68, v68, v72
v_add_f32 v76, v76, v80
v_add_f32 v69, v69, v73
v_add_f32 v77, v77, v81
v_add_f32 v70, v70, v74
v_add_f32 v78, v78, v82
v_add_f32 v71, v71, v75
v_add_f32 v79, v79, v83
v_add_f32 v84, v68, v76
v_add_f32 v85, v69, v77
v_add_f32 v86, v70, v78
v_add_f32 v87, v71, v79
s_and_b32 s60, s42, s69
s_lshl_b32 s60, s60, 12
buffer_load_dwordx4 v[88:91], v13, s[84:87], s60 offen sc1
s_bfe_u32 s61, s42, 0x10001
s_xor_b32 s61, s61, s67
s_and_b32 s61, s61, s71
s_waitcnt vmcnt(0)
mega_kernel_o_f2c:
v_and_b32 v14, s71, v88
v_cmp_ne_u32 vcc, s61, v14
s_cbranch_vccz mega_kernel_o_f2k
s_and_b32 s60, s42, s69
s_lshl_b32 s60, s60, 12
buffer_load_dwordx4 v[88:91], v13, s[84:87], s60 offen sc1
s_waitcnt vmcnt(0)
s_branch mega_kernel_o_f2c
mega_kernel_o_f2k:
v_pk_add_f32 v[88:89], v[88:89], v[84:85]
v_pk_add_f32 v[90:91], v[90:91], v[86:87]
s_lshl_b32 s60, s42, 17
v_cvt_pk_bf16_f32 v92, v88, v89
v_cvt_pk_bf16_f32 v93, v90, v91
buffer_store_dwordx2 v[92:93], v11, s[8:11], s60 offen sc1
s_add_u32 s42, s42, 1
s_cmp_lt_u32 s42, s65
s_cbranch_scc1 mega_kernel_o_cold
s_cmp_eq_u32 s71, 1
s_cbranch_scc1 mega_kernel_o_fin
s_mov_b32 s71, 1
s_mov_b32 s42, s64
s_mov_b32 s65, s70
v_mov_b32 v12, v16
v_mov_b32 v11, v17
s_and_b32 s60, s42, s69
s_lshl_b32 s60, s60, 12
buffer_load_dwordx4 v[88:91], v13, s[84:87], s60 offen sc1
s_branch mega_kernel_o_cold
mega_kernel_o_fin:
mega_kernel_o_quit:
s_endpgm
mega_kernel_exit:
s_endpgm
mega_kernel_recf:
s_load_dwordx2 s[20:21], s[0:1], 8
s_load_dwordx2 s[16:17], s[0:1], 40
s_load_dwordx2 s[4:5], s[0:1], 16
s_load_dwordx2 s[8:9], s[0:1], 24
s_load_dwordx2 s[12:13], s[0:1], 32
v_lshrrev_b32 v4, 6, v0
v_and_b32 v1, 63, v0
v_readfirstlane_b32 s24, v4
v_lshrrev_b32 v2, 4, v1
v_and_b32 v3, 15, v1
v_lshlrev_b32 v17, 4, v1
s_lshr_b32 s28, s31, 2
s_lshl_b32 s25, s30, 3
s_add_u32 s25, s25, s28
s_and_b32 s26, s31, 3
s_waitcnt lgkmcnt(0)
s_mov_b32 s22, 16384
s_mov_b32 s23, 0x00020000
s_mov_b32 s18, 8388608
s_mov_b32 s19, 0x00020000
s_mov_b32 s6, 8388608
s_mov_b32 s7, 0x00020000
s_mov_b32 s10, 8388608
s_mov_b32 s11, 0x00020000
s_mov_b32 s14, 8388608
s_mov_b32 s15, 0x00020000
s_lshl_b32 s28, s25, 8
s_lshr_b32 s29, s26, 0
s_lshl_b32 s29, s29, 6
s_add_u32 s28, s28, s29
s_lshl_b32 s29, s24, 21
s_add_u32 s28, s28, s29
v_lshrrev_b32 v4, 2, v1
v_and_b32 v5, 3, v1
v_lshlrev_b32 v40, 13, v4
v_lshl_add_u32 v40, v5, 4, v40
v_add_u32 v40, s28, v40
s_lshl_b32 s28, s30, 21
s_lshl_b32 s29, s24, 19
s_add_u32 s28, s28, s29
s_lshr_b32 s29, s31, 0
s_lshl_b32 s29, s29, 6
s_add_u32 s28, s28, s29
v_lshlrev_b32 v41, 11, v4
v_lshl_add_u32 v41, v5, 4, v41
v_add_u32 v41, s28, v41
s_lshl_b32 s47, s24, 15
s_add_u32 s47, s47, 32768
s_lshl_b32 s28, s31, 18
s_lshl_b32 s29, s24, 16
s_add_u32 s28, s28, s29
s_lshl_b32 s29, s30, 11
s_add_u32 s28, s28, s29
v_lshlrev_b32 v48, 13, v2
v_lshl_add_u32 v48, v3, 7, v48
v_add_u32 v48, s28, v48
s_lshl_b32 s28, s30, 21
s_lshl_b32 s29, s31, 16
s_add_u32 s28, s28, s29
s_lshl_b32 s29, s24, 14
s_add_u32 s28, s28, s29
v_lshlrev_b32 v49, 7, v1
v_add_u32 v49, s28, v49
s_and_b32 s76, s31, 1
s_mul_i32 s76, s76, 8
s_and_b32 s28, s31, 15
s_lshl_b32 s28, s28, 4
s_lshl_b32 s29, s24, 8
s_add_u32 s28, s28, s29
v_add_u32 v53, s28, v3
s_lshr_b32 s28, s31, 4
s_lshl_b32 s28, s28, 10
s_add_u32 s28, s28, 384
v_mov_b32 v54, s28
v_mov_b32 v55, 1920
v_cmp_gt_u32 vcc, 32, v1
s_nop 1
v_cndmask_b32 v54, v55, v54, vcc
s_lshl_b32 s29, s30, 11
v_lshl_add_u32 v51, v53, 13, v54
v_add_u32 v51, s29, v51
s_lshl_b32 s29, s30, 21
v_lshl_add_u32 v52, v53, 11, v54
v_add_u32 v52, s29, v52
buffer_load_dword v50, v51, s[8:11], 0 offen
s_xor_b32 s29, s76, 0
s_lshl_b32 s28, s29, 10
s_add_u32 s28, s28, s47
s_add_u32 m0, s28, 0
s_lshl_b32 s29, s29, 17
buffer_load_dwordx4 v40, s[8:11], s29 offen lds
s_xor_b32 s29, s76, 1
s_lshl_b32 s28, s29, 10
s_add_u32 s28, s28, s47
s_add_u32 m0, s28, 0
s_lshl_b32 s29, s29, 17
buffer_load_dwordx4 v40, s[8:11], s29 offen lds
s_xor_b32 s29, s76, 2
s_lshl_b32 s28, s29, 10
s_add_u32 s28, s28, s47
s_add_u32 m0, s28, 0
s_lshl_b32 s29, s29, 17
buffer_load_dwordx4 v40, s[8:11], s29 offen lds
s_xor_b32 s29, s76, 3
s_lshl_b32 s28, s29, 10
s_add_u32 s28, s28, s47
s_add_u32 m0, s28, 0
s_lshl_b32 s29, s29, 17
buffer_load_dwordx4 v40, s[8:11], s29 offen lds
s_xor_b32 s29, s76, 4
s_lshl_b32 s28, s29, 10
s_add_u32 s28, s28, s47
s_add_u32 m0, s28, 0
s_lshl_b32 s29, s29, 17
buffer_load_dwordx4 v40, s[8:11], s29 offen lds
s_xor_b32 s29, s76, 5
s_lshl_b32 s28, s29, 10
s_add_u32 s28, s28, s47
s_add_u32 m0, s28, 0
s_lshl_b32 s29, s29, 17
buffer_load_dwordx4 v40, s[8:11], s29 offen lds
s_xor_b32 s29, s76, 6
s_lshl_b32 s28, s29, 10
s_add_u32 s28, s28, s47
s_add_u32 m0, s28, 0
s_lshl_b32 s29, s29, 17
buffer_load_dwordx4 v40, s[8:11], s29 offen lds
s_xor_b32 s29, s76, 7
s_lshl_b32 s28, s29, 10
s_add_u32 s28, s28, s47
s_add_u32 m0, s28, 0
s_lshl_b32 s29, s29, 17
buffer_load_dwordx4 v40, s[8:11], s29 offen lds
s_xor_b32 s29, s76, 8
s_lshl_b32 s28, s29, 10
s_add_u32 s28, s28, s47
s_add_u32 m0, s28, 0
s_lshl_b32 s29, s29, 17
buffer_load_dwordx4 v40, s[8:11], s29 offen lds
s_xor_b32 s29, s76, 9
s_lshl_b32 s28, s29, 10
s_add_u32 s28, s28, s47
s_add_u32 m0, s28, 0
s_lshl_b32 s29, s29, 17
buffer_load_dwordx4 v40, s[8:11], s29 offen lds
s_xor_b32 s29, s76, 10
s_lshl_b32 s28, s29, 10
s_add_u32 s28, s28, s47
s_add_u32 m0, s28, 0
s_lshl_b32 s29, s29, 17
buffer_load_dwordx4 v40, s[8:11], s29 offen lds
s_xor_b32 s29, s76, 11
s_lshl_b32 s28, s29, 10
s_add_u32 s28, s28, s47
s_add_u32 m0, s28, 0
s_lshl_b32 s29, s29, 17
buffer_load_dwordx4 v40, s[8:11], s29 offen lds
s_xor_b32 s29, s76, 12
s_lshl_b32 s28, s29, 10
s_add_u32 s28, s28, s47
s_add_u32 m0, s28, 0
s_lshl_b32 s29, s29, 17
buffer_load_dwordx4 v40, s[8:11], s29 offen lds
s_xor_b32 s29, s76, 13
s_lshl_b32 s28, s29, 10
s_add_u32 s28, s28, s47
s_add_u32 m0, s28, 0
s_lshl_b32 s29, s29, 17
buffer_load_dwordx4 v40, s[8:11], s29 offen lds
s_xor_b32 s29, s76, 14
s_lshl_b32 s28, s29, 10
s_add_u32 s28, s28, s47
s_add_u32 m0, s28, 0
s_lshl_b32 s29, s29, 17
buffer_load_dwordx4 v40, s[8:11], s29 offen lds
s_xor_b32 s29, s76, 15
s_lshl_b32 s28, s29, 10
s_add_u32 s28, s28, s47
s_add_u32 m0, s28, 0
s_lshl_b32 s29, s29, 17
buffer_load_dwordx4 v40, s[8:11], s29 offen lds
buffer_load_dword v50, v51, s[12:15], 0 offen
s_xor_b32 s29, s76, 0
s_lshl_b32 s28, s29, 10
s_add_u32 s28, s28, s47
s_add_u32 m0, s28, 16384
s_lshl_b32 s29, s29, 17
buffer_load_dwordx4 v40, s[12:15], s29 offen lds
s_xor_b32 s29, s76, 1
s_lshl_b32 s28, s29, 10
s_add_u32 s28, s28, s47
s_add_u32 m0, s28, 16384
s_lshl_b32 s29, s29, 17
buffer_load_dwordx4 v40, s[12:15], s29 offen lds
s_xor_b32 s29, s76, 2
s_lshl_b32 s28, s29, 10
s_add_u32 s28, s28, s47
s_add_u32 m0, s28, 16384
s_lshl_b32 s29, s29, 17
buffer_load_dwordx4 v40, s[12:15], s29 offen lds
s_xor_b32 s29, s76, 3
s_lshl_b32 s28, s29, 10
s_add_u32 s28, s28, s47
s_add_u32 m0, s28, 16384
s_lshl_b32 s29, s29, 17
buffer_load_dwordx4 v40, s[12:15], s29 offen lds
s_xor_b32 s29, s76, 4
s_lshl_b32 s28, s29, 10
s_add_u32 s28, s28, s47
s_add_u32 m0, s28, 16384
s_lshl_b32 s29, s29, 17
buffer_load_dwordx4 v40, s[12:15], s29 offen lds
s_xor_b32 s29, s76, 5
s_lshl_b32 s28, s29, 10
s_add_u32 s28, s28, s47
s_add_u32 m0, s28, 16384
s_lshl_b32 s29, s29, 17
buffer_load_dwordx4 v40, s[12:15], s29 offen lds
s_xor_b32 s29, s76, 6
s_lshl_b32 s28, s29, 10
s_add_u32 s28, s28, s47
s_add_u32 m0, s28, 16384
s_lshl_b32 s29, s29, 17
buffer_load_dwordx4 v40, s[12:15], s29 offen lds
s_xor_b32 s29, s76, 7
s_lshl_b32 s28, s29, 10
s_add_u32 s28, s28, s47
s_add_u32 m0, s28, 16384
s_lshl_b32 s29, s29, 17
buffer_load_dwordx4 v40, s[12:15], s29 offen lds
s_xor_b32 s29, s76, 8
s_lshl_b32 s28, s29, 10
s_add_u32 s28, s28, s47
s_add_u32 m0, s28, 16384
s_lshl_b32 s29, s29, 17
buffer_load_dwordx4 v40, s[12:15], s29 offen lds
s_xor_b32 s29, s76, 9
s_lshl_b32 s28, s29, 10
s_add_u32 s28, s28, s47
s_add_u32 m0, s28, 16384
s_lshl_b32 s29, s29, 17
buffer_load_dwordx4 v40, s[12:15], s29 offen lds
s_xor_b32 s29, s76, 10
s_lshl_b32 s28, s29, 10
s_add_u32 s28, s28, s47
s_add_u32 m0, s28, 16384
s_lshl_b32 s29, s29, 17
buffer_load_dwordx4 v40, s[12:15], s29 offen lds
s_xor_b32 s29, s76, 11
s_lshl_b32 s28, s29, 10
s_add_u32 s28, s28, s47
s_add_u32 m0, s28, 16384
s_lshl_b32 s29, s29, 17
buffer_load_dwordx4 v40, s[12:15], s29 offen lds
s_xor_b32 s29, s76, 12
s_lshl_b32 s28, s29, 10
s_add_u32 s28, s28, s47
s_add_u32 m0, s28, 16384
s_lshl_b32 s29, s29, 17
buffer_load_dwordx4 v40, s[12:15], s29 offen lds
s_xor_b32 s29, s76, 13
s_lshl_b32 s28, s29, 10
s_add_u32 s28, s28, s47
s_add_u32 m0, s28, 16384
s_lshl_b32 s29, s29, 17
buffer_load_dwordx4 v40, s[12:15], s29 offen lds
s_xor_b32 s29, s76, 14
s_lshl_b32 s28, s29, 10
s_add_u32 s28, s28, s47
s_add_u32 m0, s28, 16384
s_lshl_b32 s29, s29, 17
buffer_load_dwordx4 v40, s[12:15], s29 offen lds
s_xor_b32 s29, s76, 15
s_lshl_b32 s28, s29, 10
s_add_u32 s28, s28, s47
s_add_u32 m0, s28, 16384
s_lshl_b32 s29, s29, 17
buffer_load_dwordx4 v40, s[12:15], s29 offen lds
s_mov_b32 s40, 0x00ff00ff
s_mov_b32 s41, 0x00ff00ff
s_mov_b32 s48, 0xff00ff00
s_mov_b32 s49, 0xff00ff00
s_mov_b32 s42, 0
s_mov_b32 s43, 0x00ff00ff
s_mov_b32 s32, 0x3e0293ee
v_mov_b32 v23, 0xff800000
v_mov_b32 v6, 0x4444
v_mov_b32 v4, 0xeeee
v_cndmask_b32 v6, v6, v4, s[48:49]
v_mov_b32 v28, -1
v_mov_b32 v29, -1
v_mov_b32 v30, -1
v_mov_b32 v31, -1
s_mul_i32 s28, s24, 4096
v_add_u32 v7, s28, v17
v_and_b32 v4, 7, v1
v_lshlrev_b32 v8, 11, v4
v_lshrrev_b32 v5, 3, v1
v_lshl_add_u32 v8, v5, 4, v8
s_lshl_b32 s28, s24, 9
v_add_u32 v8, s28, v8
s_lshl_b32 s28, s31, 9
s_lshr_b32 s29, s31, 3
s_mul_i32 s29, s29, 0
s_add_u32 s28, s28, s29
v_lshlrev_b32 v9, 3, v1
v_add_u32 v9, s28, v9
v_and_b32 v4, 7, v3
v_lshlrev_b32 v11, 7, v2
v_lshl_add_u32 v11, v4, 4, v11
v_add_u32 v22, 0, v11
s_add_u32 s28, s28, 24576
v_add_u32 v11, s28, v11
v_and_b32 v5, 1, v2
v_lshlrev_b32 v10, 7, v5
v_lshl_add_u32 v10, v4, 4, v10
v_add_u32 v10, 1024, v10
s_xor_b32 s37, s31, 1
s_mul_i32 s37, s37, 2048
s_add_u32 s37, s37, 49152
s_xor_b32 s38, s31, 2
s_mul_i32 s38, s38, 2048
s_add_u32 s38, s38, 49152
s_xor_b32 s39, s31, 3
s_mul_i32 s39, s39, 2048
s_add_u32 s39, s39, 49152
v_and_b32 v4, 1, v2
v_mul_u32_u24 v14, 576, v4
v_lshrrev_b32 v5, 1, v2
v_lshl_add_u32 v5, v5, 4, v3
v_lshl_add_u32 v14, v5, 2, v14
s_mul_i32 s28, s24, 1152
s_add_u32 s28, s28, 13312
v_add_u32 v18, s28, v14
s_mul_i32 s28, s24, 2304
v_add_u32 v14, s28, v14
v_add_u32 v15, 1152, v14
v_mul_u32_u24 v16, 144, v3
v_lshl_add_u32 v16, v2, 5, v16
v_bfe_u32 v4, v1, 1, 3
v_mul_u32_u24 v19, 144, v4
v_lshl_add_u32 v19, v2, 5, v19
v_and_b32 v4, 1, v1
v_lshl_add_u32 v19, v4, 4, v19
v_add_u32 v19, 13312, v19
s_lshl_b32 s28, s24, 10
s_add_u32 s28, s28, 9216
v_add_u32 v20, s28, v17
v_and_b32 v4, 31, v1
v_lshlrev_b32 v21, 3, v4
v_add_u32 v21, 17920, v21
v_lshrrev_b32 v4, 2, v3
v_and_b32 v42, 1, v4
v_lshrrev_b32 v43, 1, v4
v_lshrrev_b32 v44, 1, v2
v_and_b32 v45, 1, v2
v_lshl_add_u32 v46, v44, 4, v42
v_lshl_add_u32 v46, v45, 2, v46
v_lshl_add_u32 v46, v43, 3, v46
v_lshl_add_u32 v47, v44, 3, v42
v_lshl_add_u32 v47, v45, 4, v47
v_lshl_add_u32 v47, v43, 2, v47
v_and_b32 v5, 3, v3
v_lshlrev_b32 v5, 3, v5
v_lshl_add_u32 v46, v46, 6, v5
v_lshl_add_u32 v47, v47, 6, v5
s_and_b32 s28, s31, 0
s_lshl_b32 s28, s28, 6
s_add_u32 s28, s28, s47
v_add_u32 v46, s28, v46
v_add_u32 v47, s28, v47
s_waitcnt vmcnt(17)
ds_read_b64_tr_b16 a[64:65], v46 offset:0
ds_read_b64_tr_b16 a[66:67], v46 offset:128
ds_read_b64_tr_b16 a[68:69], v46 offset:2048
ds_read_b64_tr_b16 a[70:71], v46 offset:2176
ds_read_b64_tr_b16 a[72:73], v46 offset:4096
ds_read_b64_tr_b16 a[74:75], v46 offset:4224
ds_read_b64_tr_b16 a[76:77], v46 offset:6144
ds_read_b64_tr_b16 a[78:79], v46 offset:6272
s_waitcnt lgkmcnt(0)
ds_read_b64_tr_b16 a[80:81], v46 offset:8192
ds_read_b64_tr_b16 a[82:83], v46 offset:8320
ds_read_b64_tr_b16 a[84:85], v46 offset:10240
ds_read_b64_tr_b16 a[86:87], v46 offset:10368
ds_read_b64_tr_b16 a[88:89], v46 offset:12288
ds_read_b64_tr_b16 a[90:91], v46 offset:12416
ds_read_b64_tr_b16 a[92:93], v46 offset:14336
ds_read_b64_tr_b16 a[94:95], v46 offset:14464
s_waitcnt lgkmcnt(0)
ds_read_b64_tr_b16 a[96:97], v46 offset:32
ds_read_b64_tr_b16 a[98:99], v46 offset:160
ds_read_b64_tr_b16 a[100:101], v46 offset:2080
ds_read_b64_tr_b16 a[102:103], v46 offset:2208
ds_read_b64_tr_b16 a[104:105], v46 offset:4128
ds_read_b64_tr_b16 a[106:107], v46 offset:4256
ds_read_b64_tr_b16 a[108:109], v46 offset:6176
ds_read_b64_tr_b16 a[110:111], v46 offset:6304
s_waitcnt lgkmcnt(0)
ds_read_b64_tr_b16 a[112:113], v46 offset:8224
ds_read_b64_tr_b16 a[114:115], v46 offset:8352
ds_read_b64_tr_b16 a[116:117], v46 offset:10272
ds_read_b64_tr_b16 a[118:119], v46 offset:10400
ds_read_b64_tr_b16 a[120:121], v46 offset:12320
ds_read_b64_tr_b16 a[122:123], v46 offset:12448
ds_read_b64_tr_b16 a[124:125], v46 offset:14368
ds_read_b64_tr_b16 a[126:127], v46 offset:14496
s_waitcnt lgkmcnt(0)
buffer_load_dword v50, v51, s[4:7], 0 offen
s_xor_b32 s29, s76, 0
s_lshl_b32 s28, s29, 10
s_add_u32 s28, s28, s47
s_add_u32 m0, s28, 0
s_lshl_b32 s29, s29, 17
buffer_load_dwordx4 v40, s[4:7], s29 offen lds
s_xor_b32 s29, s76, 1
s_lshl_b32 s28, s29, 10
s_add_u32 s28, s28, s47
s_add_u32 m0, s28, 0
s_lshl_b32 s29, s29, 17
buffer_load_dwordx4 v40, s[4:7], s29 offen lds
s_xor_b32 s29, s76, 2
s_lshl_b32 s28, s29, 10
s_add_u32 s28, s28, s47
s_add_u32 m0, s28, 0
s_lshl_b32 s29, s29, 17
buffer_load_dwordx4 v40, s[4:7], s29 offen lds
s_xor_b32 s29, s76, 3
s_lshl_b32 s28, s29, 10
s_add_u32 s28, s28, s47
s_add_u32 m0, s28, 0
s_lshl_b32 s29, s29, 17
buffer_load_dwordx4 v40, s[4:7], s29 offen lds
s_xor_b32 s29, s76, 4
s_lshl_b32 s28, s29, 10
s_add_u32 s28, s28, s47
s_add_u32 m0, s28, 0
s_lshl_b32 s29, s29, 17
buffer_load_dwordx4 v40, s[4:7], s29 offen lds
s_xor_b32 s29, s76, 5
s_lshl_b32 s28, s29, 10
s_add_u32 s28, s28, s47
s_add_u32 m0, s28, 0
s_lshl_b32 s29, s29, 17
buffer_load_dwordx4 v40, s[4:7], s29 offen lds
s_xor_b32 s29, s76, 6
s_lshl_b32 s28, s29, 10
s_add_u32 s28, s28, s47
s_add_u32 m0, s28, 0
s_lshl_b32 s29, s29, 17
buffer_load_dwordx4 v40, s[4:7], s29 offen lds
s_xor_b32 s29, s76, 7
s_lshl_b32 s28, s29, 10
s_add_u32 s28, s28, s47
s_add_u32 m0, s28, 0
s_lshl_b32 s29, s29, 17
buffer_load_dwordx4 v40, s[4:7], s29 offen lds
s_xor_b32 s29, s76, 8
s_lshl_b32 s28, s29, 10
s_add_u32 s28, s28, s47
s_add_u32 m0, s28, 0
s_lshl_b32 s29, s29, 17
buffer_load_dwordx4 v40, s[4:7], s29 offen lds
s_xor_b32 s29, s76, 9
s_lshl_b32 s28, s29, 10
s_add_u32 s28, s28, s47
s_add_u32 m0, s28, 0
s_lshl_b32 s29, s29, 17
buffer_load_dwordx4 v40, s[4:7], s29 offen lds
s_xor_b32 s29, s76, 10
s_lshl_b32 s28, s29, 10
s_add_u32 s28, s28, s47
s_add_u32 m0, s28, 0
s_lshl_b32 s29, s29, 17
buffer_load_dwordx4 v40, s[4:7], s29 offen lds
s_xor_b32 s29, s76, 11
s_lshl_b32 s28, s29, 10
s_add_u32 s28, s28, s47
s_add_u32 m0, s28, 0
s_lshl_b32 s29, s29, 17
buffer_load_dwordx4 v40, s[4:7], s29 offen lds
s_xor_b32 s29, s76, 12
s_lshl_b32 s28, s29, 10
s_add_u32 s28, s28, s47
s_add_u32 m0, s28, 0
s_lshl_b32 s29, s29, 17
buffer_load_dwordx4 v40, s[4:7], s29 offen lds
s_xor_b32 s29, s76, 13
s_lshl_b32 s28, s29, 10
s_add_u32 s28, s28, s47
s_add_u32 m0, s28, 0
s_lshl_b32 s29, s29, 17
buffer_load_dwordx4 v40, s[4:7], s29 offen lds
s_xor_b32 s29, s76, 14
s_lshl_b32 s28, s29, 10
s_add_u32 s28, s28, s47
s_add_u32 m0, s28, 0
s_lshl_b32 s29, s29, 17
buffer_load_dwordx4 v40, s[4:7], s29 offen lds
s_xor_b32 s29, s76, 15
s_lshl_b32 s28, s29, 10
s_add_u32 s28, s28, s47
s_add_u32 m0, s28, 0
s_lshl_b32 s29, s29, 17
buffer_load_dwordx4 v40, s[4:7], s29 offen lds
s_waitcnt vmcnt(17)
ds_read_b64_tr_b16 a[128:129], v46 offset:16384
ds_read_b64_tr_b16 a[130:131], v46 offset:16512
ds_read_b64_tr_b16 a[132:133], v46 offset:18432
ds_read_b64_tr_b16 a[134:135], v46 offset:18560
ds_read_b64_tr_b16 a[136:137], v46 offset:20480
ds_read_b64_tr_b16 a[138:139], v46 offset:20608
ds_read_b64_tr_b16 a[140:141], v46 offset:22528
ds_read_b64_tr_b16 a[142:143], v46 offset:22656
s_waitcnt lgkmcnt(0)
ds_read_b64_tr_b16 a[144:145], v46 offset:24576
ds_read_b64_tr_b16 a[146:147], v46 offset:24704
ds_read_b64_tr_b16 a[148:149], v46 offset:26624
ds_read_b64_tr_b16 a[150:151], v46 offset:26752
ds_read_b64_tr_b16 a[152:153], v46 offset:28672
ds_read_b64_tr_b16 a[154:155], v46 offset:28800
ds_read_b64_tr_b16 a[156:157], v46 offset:30720
ds_read_b64_tr_b16 a[158:159], v46 offset:30848
s_waitcnt lgkmcnt(0)
ds_read_b64_tr_b16 a[160:161], v46 offset:16416
ds_read_b64_tr_b16 a[162:163], v46 offset:16544
ds_read_b64_tr_b16 a[164:165], v46 offset:18464
ds_read_b64_tr_b16 a[166:167], v46 offset:18592
ds_read_b64_tr_b16 a[168:169], v46 offset:20512
ds_read_b64_tr_b16 a[170:171], v46 offset:20640
ds_read_b64_tr_b16 a[172:173], v46 offset:22560
ds_read_b64_tr_b16 a[174:175], v46 offset:22688
s_waitcnt lgkmcnt(0)
ds_read_b64_tr_b16 a[176:177], v46 offset:24608
ds_read_b64_tr_b16 a[178:179], v46 offset:24736
ds_read_b64_tr_b16 a[180:181], v46 offset:26656
ds_read_b64_tr_b16 a[182:183], v46 offset:26784
ds_read_b64_tr_b16 a[184:185], v46 offset:28704
ds_read_b64_tr_b16 a[186:187], v46 offset:28832
ds_read_b64_tr_b16 a[188:189], v46 offset:30752
ds_read_b64_tr_b16 a[190:191], v46 offset:30880
s_waitcnt lgkmcnt(0)
buffer_load_dword v50, v52, s[16:19], 0 offen
s_xor_b32 s29, s76, 0
s_lshl_b32 s28, s29, 10
s_add_u32 s28, s28, s47
s_add_u32 m0, s28, 16384
s_lshl_b32 s29, s29, 15
buffer_load_dwordx4 v41, s[16:19], s29 offen lds
s_xor_b32 s29, s76, 1
s_lshl_b32 s28, s29, 10
s_add_u32 s28, s28, s47
s_add_u32 m0, s28, 16384
s_lshl_b32 s29, s29, 15
buffer_load_dwordx4 v41, s[16:19], s29 offen lds
s_xor_b32 s29, s76, 2
s_lshl_b32 s28, s29, 10
s_add_u32 s28, s28, s47
s_add_u32 m0, s28, 16384
s_lshl_b32 s29, s29, 15
buffer_load_dwordx4 v41, s[16:19], s29 offen lds
s_xor_b32 s29, s76, 3
s_lshl_b32 s28, s29, 10
s_add_u32 s28, s28, s47
s_add_u32 m0, s28, 16384
s_lshl_b32 s29, s29, 15
buffer_load_dwordx4 v41, s[16:19], s29 offen lds
s_xor_b32 s29, s76, 4
s_lshl_b32 s28, s29, 10
s_add_u32 s28, s28, s47
s_add_u32 m0, s28, 16384
s_lshl_b32 s29, s29, 15
buffer_load_dwordx4 v41, s[16:19], s29 offen lds
s_xor_b32 s29, s76, 5
s_lshl_b32 s28, s29, 10
s_add_u32 s28, s28, s47
s_add_u32 m0, s28, 16384
s_lshl_b32 s29, s29, 15
buffer_load_dwordx4 v41, s[16:19], s29 offen lds
s_xor_b32 s29, s76, 6
s_lshl_b32 s28, s29, 10
s_add_u32 s28, s28, s47
s_add_u32 m0, s28, 16384
s_lshl_b32 s29, s29, 15
buffer_load_dwordx4 v41, s[16:19], s29 offen lds
s_xor_b32 s29, s76, 7
s_lshl_b32 s28, s29, 10
s_add_u32 s28, s28, s47
s_add_u32 m0, s28, 16384
s_lshl_b32 s29, s29, 15
buffer_load_dwordx4 v41, s[16:19], s29 offen lds
s_xor_b32 s29, s76, 8
s_lshl_b32 s28, s29, 10
s_add_u32 s28, s28, s47
s_add_u32 m0, s28, 16384
s_lshl_b32 s29, s29, 15
buffer_load_dwordx4 v41, s[16:19], s29 offen lds
s_xor_b32 s29, s76, 9
s_lshl_b32 s28, s29, 10
s_add_u32 s28, s28, s47
s_add_u32 m0, s28, 16384
s_lshl_b32 s29, s29, 15
buffer_load_dwordx4 v41, s[16:19], s29 offen lds
s_xor_b32 s29, s76, 10
s_lshl_b32 s28, s29, 10
s_add_u32 s28, s28, s47
s_add_u32 m0, s28, 16384
s_lshl_b32 s29, s29, 15
buffer_load_dwordx4 v41, s[16:19], s29 offen lds
s_xor_b32 s29, s76, 11
s_lshl_b32 s28, s29, 10
s_add_u32 s28, s28, s47
s_add_u32 m0, s28, 16384
s_lshl_b32 s29, s29, 15
buffer_load_dwordx4 v41, s[16:19], s29 offen lds
s_xor_b32 s29, s76, 12
s_lshl_b32 s28, s29, 10
s_add_u32 s28, s28, s47
s_add_u32 m0, s28, 16384
s_lshl_b32 s29, s29, 15
buffer_load_dwordx4 v41, s[16:19], s29 offen lds
s_xor_b32 s29, s76, 13
s_lshl_b32 s28, s29, 10
s_add_u32 s28, s28, s47
s_add_u32 m0, s28, 16384
s_lshl_b32 s29, s29, 15
buffer_load_dwordx4 v41, s[16:19], s29 offen lds
s_xor_b32 s29, s76, 14
s_lshl_b32 s28, s29, 10
s_add_u32 s28, s28, s47
s_add_u32 m0, s28, 16384
s_lshl_b32 s29, s29, 15
buffer_load_dwordx4 v41, s[16:19], s29 offen lds
s_xor_b32 s29, s76, 15
s_lshl_b32 s28, s29, 10
s_add_u32 s28, s28, s47
s_add_u32 m0, s28, 16384
s_lshl_b32 s29, s29, 15
buffer_load_dwordx4 v41, s[16:19], s29 offen lds
s_waitcnt vmcnt(17)
ds_read_b64_tr_b16 a[0:1], v46 offset:0
ds_read_b64_tr_b16 a[2:3], v46 offset:128
ds_read_b64_tr_b16 a[4:5], v46 offset:2048
ds_read_b64_tr_b16 a[6:7], v46 offset:2176
ds_read_b64_tr_b16 a[8:9], v46 offset:4096
ds_read_b64_tr_b16 a[10:11], v46 offset:4224
ds_read_b64_tr_b16 a[12:13], v46 offset:6144
ds_read_b64_tr_b16 a[14:15], v46 offset:6272
s_waitcnt lgkmcnt(0)
ds_read_b64_tr_b16 a[16:17], v46 offset:8192
ds_read_b64_tr_b16 a[18:19], v46 offset:8320
ds_read_b64_tr_b16 a[20:21], v46 offset:10240
ds_read_b64_tr_b16 a[22:23], v46 offset:10368
ds_read_b64_tr_b16 a[24:25], v46 offset:12288
ds_read_b64_tr_b16 a[26:27], v46 offset:12416
ds_read_b64_tr_b16 a[28:29], v46 offset:14336
ds_read_b64_tr_b16 a[30:31], v46 offset:14464
s_waitcnt lgkmcnt(0)
ds_read_b64_tr_b16 a[32:33], v46 offset:32
ds_read_b64_tr_b16 a[34:35], v46 offset:160
ds_read_b64_tr_b16 a[36:37], v46 offset:2080
ds_read_b64_tr_b16 a[38:39], v46 offset:2208
ds_read_b64_tr_b16 a[40:41], v46 offset:4128
ds_read_b64_tr_b16 a[42:43], v46 offset:4256
ds_read_b64_tr_b16 a[44:45], v46 offset:6176
ds_read_b64_tr_b16 a[46:47], v46 offset:6304
s_waitcnt lgkmcnt(0)
ds_read_b64_tr_b16 a[48:49], v46 offset:8224
ds_read_b64_tr_b16 a[50:51], v46 offset:8352
ds_read_b64_tr_b16 a[52:53], v46 offset:10272
ds_read_b64_tr_b16 a[54:55], v46 offset:10400
ds_read_b64_tr_b16 a[56:57], v46 offset:12320
ds_read_b64_tr_b16 a[58:59], v46 offset:12448
ds_read_b64_tr_b16 a[60:61], v46 offset:14368
ds_read_b64_tr_b16 a[62:63], v46 offset:14496
s_waitcnt lgkmcnt(0)
v_and_b32 v247, 15, v0
v_lshlrev_b32 v247, 4, v247
buffer_load_dword v246, v247, s[72:75], 0 offen sc1
s_waitcnt vmcnt(0)
ds_read_b64_tr_b16 a[192:193], v47 offset:16384
ds_read_b64_tr_b16 a[194:195], v47 offset:16512
ds_read_b64_tr_b16 a[196:197], v47 offset:18432
ds_read_b64_tr_b16 a[198:199], v47 offset:18560
ds_read_b64_tr_b16 a[200:201], v47 offset:20480
ds_read_b64_tr_b16 a[202:203], v47 offset:20608
ds_read_b64_tr_b16 a[204:205], v47 offset:22528
ds_read_b64_tr_b16 a[206:207], v47 offset:22656
s_waitcnt lgkmcnt(0)
ds_read_b64_tr_b16 a[208:209], v47 offset:24576
ds_read_b64_tr_b16 a[210:211], v47 offset:24704
ds_read_b64_tr_b16 a[212:213], v47 offset:26624
ds_read_b64_tr_b16 a[214:215], v47 offset:26752
ds_read_b64_tr_b16 a[216:217], v47 offset:28672
ds_read_b64_tr_b16 a[218:219], v47 offset:28800
ds_read_b64_tr_b16 a[220:221], v47 offset:30720
ds_read_b64_tr_b16 a[222:223], v47 offset:30848
s_waitcnt lgkmcnt(0)
ds_read_b64_tr_b16 a[224:225], v47 offset:16416
ds_read_b64_tr_b16 a[226:227], v47 offset:16544
ds_read_b64_tr_b16 a[228:229], v47 offset:18464
ds_read_b64_tr_b16 a[230:231], v47 offset:18592
ds_read_b64_tr_b16 a[232:233], v47 offset:20512
ds_read_b64_tr_b16 a[234:235], v47 offset:20640
ds_read_b64_tr_b16 a[236:237], v47 offset:22560
ds_read_b64_tr_b16 a[238:239], v47 offset:22688
s_waitcnt lgkmcnt(0)
ds_read_b64_tr_b16 a[240:241], v47 offset:24608
ds_read_b64_tr_b16 a[242:243], v47 offset:24736
ds_read_b64_tr_b16 a[244:245], v47 offset:26656
ds_read_b64_tr_b16 a[246:247], v47 offset:26784
ds_read_b64_tr_b16 a[248:249], v47 offset:28704
ds_read_b64_tr_b16 a[250:251], v47 offset:28832
ds_read_b64_tr_b16 a[252:253], v47 offset:30752
ds_read_b64_tr_b16 a[254:255], v47 offset:30880
s_waitcnt lgkmcnt(0)
v_and_b32 v247, 15, v0
v_lshlrev_b32 v247, 4, v247
s_branch mega_kernel_syrp
mega_kernel_syrw:
s_sleep 4
mega_kernel_syr:
buffer_load_dword v246, v247, s[72:75], 0 offen sc1
s_waitcnt vmcnt(0)
mega_kernel_syrp:
s_cmp_eq_u32 s95, 1
s_cbranch_scc0 mega_kernel_syrf
v_readlane_b32 s76, v246, 14
s_mov_b32 s98, 0
s_cmp_eq_u32 s76, 64
s_cbranch_scc0 mega_kernel_syrw
s_branch mega_kernel_syrd
mega_kernel_syrf:
s_mov_b32 s77, 0
s_mov_b32 s78, 0
v_readlane_b32 s76, v246, 0
s_add_u32 s77, s77, s76
s_xor_b32 s76, s76, 32
s_or_b32 s78, s78, s76
v_readlane_b32 s76, v246, 1
s_add_u32 s77, s77, s76
s_xor_b32 s76, s76, 32
s_or_b32 s78, s78, s76
v_readlane_b32 s76, v246, 2
s_add_u32 s77, s77, s76
s_xor_b32 s76, s76, 32
s_or_b32 s78, s78, s76
v_readlane_b32 s76, v246, 3
s_add_u32 s77, s77, s76
s_xor_b32 s76, s76, 32
s_or_b32 s78, s78, s76
v_readlane_b32 s76, v246, 4
s_add_u32 s77, s77, s76
s_xor_b32 s76, s76, 32
s_or_b32 s78, s78, s76
v_readlane_b32 s76, v246, 5
s_add_u32 s77, s77, s76
s_xor_b32 s76, s76, 32
s_or_b32 s78, s78, s76
v_readlane_b32 s76, v246, 6
s_add_u32 s77, s77, s76
s_xor_b32 s76, s76, 32
s_or_b32 s78, s78, s76
v_readlane_b32 s76, v246, 7
s_add_u32 s77, s77, s76
s_xor_b32 s76, s76, 32
s_or_b32 s78, s78, s76
s_cmp_eq_u32 s77, 256
s_cbranch_scc0 mega_kernel_syrw
v_mov_b32 v252, v246
s_cmp_eq_u32 s78, 0
s_cbranch_scc0 mega_kernel_slowent
v_readlane_b32 s76, v246, 10
v_readlane_b32 s77, v246, 8
s_cmp_eq_u32 s76, 64
s_cbranch_scc0 mega_kernel_syrw
s_cmp_gt_u32 s77, 32
s_cselect_b32 s98, 1, 0
mega_kernel_syrd:
s_lshr_b32 s28, s31, 3
s_lshl_b32 s28, s28, 14
s_lshl_b32 s29, s98, 13
s_add_u32 s28, s28, s29
s_and_b32 s29, s31, 7
s_lshl_b32 s29, s29, 10
s_add_u32 s28, s28, s29
s_lshl_b32 s29, s30, 16
s_add_u32 s28, s28, s29
s_add_u32 s28, s28, 67108864
v_add_u32 v12, s28, v17
v_xor_b32 v25, 0x10000, v12
v_xor_b32 v26, 0x20000, v12
v_xor_b32 v27, 0x30000, v12
v_add_u32 v25, 0, v25
v_add_u32 v26, 0, v26
v_add_u32 v27, 0, v27
s_lshl_b32 s28, s25, 2
s_add_u32 s28, s28, s26
s_mov_b32 s82, s28
s_lshr_b32 s29, s28, 3
s_xor_b32 s29, s29, s98
s_and_b32 s29, s29, 1
s_lshl_b32 s29, s29, 13
s_lshl_b32 s76, s28, 18
s_add_u32 s76, s76, s29
s_mov_b32 s83, s76
v_add_u32 v240, s76, v17
v_add_u32 v241, 33554432, v240
s_lshr_b32 s29, s28, 4
s_xor_b32 s29, s29, s98
s_and_b32 s29, s29, 1
s_lshl_b32 s29, s29, 13
s_lshl_b32 s79, s28, 17
s_add_u32 s79, s79, s29
s_add_u32 s79, s79, 71303168
s_xor_b32 s29, s98, 1
s_lshl_b32 s29, s29, 13
s_lshl_b32 s28, s25, 7
s_add_u32 s28, s28, s29
s_add_u32 s28, s28, 69206016
v_and_b32 v4, 1, v1
v_lshlrev_b32 v24, 12, v4
v_add_u32 v24, s28, v24
s_lshl_b32 s29, s26, 2
v_add_u32 v24, s29, v24
s_xor_b32 s81, s98, 1
s_lshl_b32 s81, s81, 13
s_lshr_b32 s29, s82, 6
s_lshl_b32 s29, s29, 14
s_add_u32 s81, s81, s29
s_and_b32 s29, s82, 63
s_lshl_b32 s29, s29, 7
s_add_u32 s81, s81, s29
s_add_u32 s81, s81, 69222400
v_mov_b32 v220, 0x3f803f80
v_mov_b32 v221, 0x3f803f80
v_mov_b32 v222, 0x3f803f80
v_mov_b32 v223, 0x3f803f80
v_mov_b32 v228, 0
s_mov_b32 s27, 0
s_mov_b32 s46, 0
s_mov_b32 s89, 0
s_mov_b32 s88, 0
s_mov_b32 s44, 18432
s_mov_b32 s45, 18432
s_cmp_eq_u32 s24, 3
s_cbranch_scc0 mega_kernel_rf_pfi
s_mov_b32 s76, 0
s_cmp_gt_i32 s46, s76
s_cbranch_scc1 mega_kernel_rf_pf0ok
mega_kernel_rf_pf0w:
v_mov_b32 v4, 0
s_mov_b64 exec, 3
buffer_atomic_add v4, v24, s[84:87], 0 offen sc0 sc1
s_mov_b64 exec, -1
s_waitcnt vmcnt(0)
v_readlane_b32 s46, v4, 0
v_readlane_b32 s28, v4, 1
s_nop 1
s_min_i32 s46, s46, s28
s_cmp_gt_i32 s46, s76
s_cbranch_scc0 mega_kernel_rf_pf0w
mega_kernel_rf_pf0ok:
s_add_u32 s77, s76, s82
s_bfe_u32 s28, s77, 0x40002
s_lshl_b32 s28, s28, 14
s_and_b32 s77, s77, 3
s_lshl_b32 s77, s77, 11
s_add_u32 s28, s28, s77
s_add_u32 m0, s45, 0
s_nop 0
buffer_load_dwordx4 v240, s[84:87], s28 offen offset:0 sc1 lds
s_add_u32 m0, s45, 0
s_nop 0
buffer_load_dwordx4 v240, s[84:87], s28 offen offset:1024 sc1 lds
s_add_u32 m0, s45, 2048
s_nop 0
buffer_load_dwordx4 v241, s[84:87], s28 offen offset:0 sc1 lds
s_add_u32 m0, s45, 2048
s_nop 0
buffer_load_dwordx4 v241, s[84:87], s28 offen offset:1024 sc1 lds
s_add_u32 s45, s45, 4096
s_cmp_eq_u32 s45, 30720
s_cselect_b32 s45, 18432, s45
s_waitcnt vmcnt(0) lgkmcnt(0)
mega_kernel_rf_pfi:
v_mov_b32 v184, 0
v_mov_b32 v185, 0
v_mov_b32 v186, 0
v_mov_b32 v187, 0
v_mov_b32 v188, 0
v_mov_b32 v189, 0
v_mov_b32 v190, 0
v_mov_b32 v191, 0
v_mov_b32 v192, 0
v_mov_b32 v193, 0
v_mov_b32 v194, 0
v_mov_b32 v195, 0
v_mov_b32 v196, 0
v_mov_b32 v197, 0
v_mov_b32 v198, 0
v_mov_b32 v199, 0
v_mov_b32 v200, 0
v_mov_b32 v201, 0
v_mov_b32 v202, 0
v_mov_b32 v203, 0
v_mov_b32 v204, 0
v_mov_b32 v205, 0
v_mov_b32 v206, 0
v_mov_b32 v207, 0
v_mov_b32 v249, 0
v_mov_b32 v96, 0
v_mov_b32 v97, 0
v_mov_b32 v98, 0
v_mov_b32 v99, 0
v_mov_b32 v100, 0
v_mov_b32 v101, 0
v_mov_b32 v102, 0
v_mov_b32 v103, 0
v_mov_b32 v104, 0
v_mov_b32 v105, 0
v_mov_b32 v106, 0
v_mov_b32 v107, 0
v_mov_b32 v108, 0
v_mov_b32 v109, 0
v_mov_b32 v110, 0
v_mov_b32 v111, 0
v_mov_b32 v112, 0
v_mov_b32 v113, 0
v_mov_b32 v114, 0
v_mov_b32 v115, 0
v_mov_b32 v116, 0
v_mov_b32 v117, 0
v_mov_b32 v118, 0
v_mov_b32 v119, 0
s_barrier
s_and_b32 s29, s27, 1
s_lshl_b32 s33, s29, 17
s_lshl_b32 s28, s30, 18
s_add_u32 s33, s33, s28
s_add_u32 s33, s33, 68157440
s_xor_b32 s34, s33, 131072
s_lshl_b32 s35, s29, 18
s_bfe_u32 s47, s27, 0x10001
s_branch mega_kernel_rf_first
.p2align 6
s_nop 0
s_nop 0
mega_kernel_rf_loop:
buffer_load_dwordx4 v[32:35], v7, s[84:87], s33 offen offset:0 sc1
v_add_u32 v5, s44, v17
ds_read_b128 v[156:159], v5 offset:0
ds_read_b128 v[160:163], v5 offset:1024
ds_read_b128 v[164:167], v5 offset:2048
ds_read_b128 v[168:171], v5 offset:3072
s_nop 4
buffer_load_dwordx4 v[36:39], v7, s[84:87], s33 offen offset:1024 sc1
s_nop 9
buffer_load_dwordx4 v[40:43], v7, s[84:87], s33 offen offset:2048 sc1
s_nop 9
buffer_load_dwordx4 v[44:47], v7, s[84:87], s33 offen offset:3072 sc1
s_waitcnt vmcnt(3)
v_max_u32 v4, v32, v34
v_cmp_eq_u32 vcc, -1, v4
s_cbranch_vccnz mega_kernel_rf_pa_15_0f
v_smfmac_f32_16x16x64_bf16 v[96:99], v[32:35], a[0:7], v6
v_smfmac_f32_16x16x64_bf16 v[100:103], v[32:35], a[32:39], v6
v_smfmac_f32_16x16x64_bf16 v[104:107], v[32:35], a[64:71], v6
s_waitcnt vmcnt(2)
v_max_u32 v4, v36, v38
v_cmp_eq_u32 vcc, -1, v4
v_smfmac_f32_16x16x64_bf16 v[108:111], v[32:35], a[96:103], v6
s_cbranch_vccnz mega_kernel_rf_pa_14_1f
v_smfmac_f32_16x16x64_bf16 v[96:99], v[36:39], a[8:15], v6
v_smfmac_f32_16x16x64_bf16 v[100:103], v[36:39], a[40:47], v6
v_smfmac_f32_16x16x64_bf16 v[104:107], v[36:39], a[72:79], v6
s_waitcnt vmcnt(1)
v_max_u32 v4, v40, v42
v_cmp_eq_u32 vcc, -1, v4
v_smfmac_f32_16x16x64_bf16 v[108:111], v[36:39], a[104:111], v6
s_cbranch_vccnz mega_kernel_rf_pa_12_2f
v_smfmac_f32_16x16x64_bf16 v[96:99], v[40:43], a[16:23], v6
v_smfmac_f32_16x16x64_bf16 v[100:103], v[40:43], a[48:55], v6
v_smfmac_f32_16x16x64_bf16 v[104:107], v[40:43], a[80:87], v6
s_waitcnt vmcnt(0)
v_max_u32 v4, v44, v46
v_cmp_eq_u32 vcc, -1, v4
v_smfmac_f32_16x16x64_bf16 v[108:111], v[40:43], a[112:119], v6
s_cbranch_vccnz mega_kernel_rf_pa_8_3f
v_smfmac_f32_16x16x64_bf16 v[96:99], v[44:47], a[24:31], v6
v_smfmac_f32_16x16x64_bf16 v[100:103], v[44:47], a[56:63], v6
v_smfmac_f32_16x16x64_bf16 v[104:107], v[44:47], a[88:95], v6
v_smfmac_f32_16x16x64_bf16 v[108:111], v[44:47], a[120:127], v6
mega_kernel_rf_pa_d:
mega_kernel_rf_adone:
s_nop 5
v_permlane32_swap_b32 v96, v100
v_permlane32_swap_b32 v97, v101
v_permlane32_swap_b32 v98, v102
v_permlane32_swap_b32 v99, v103
v_pk_add_f32 v[96:97], v[96:97], v[100:101]
v_pk_add_f32 v[98:99], v[98:99], v[102:103]
ds_write2_b32 v14, v96, v97 offset0:0 offset1:36
ds_write2_b32 v14, v98, v99 offset0:72 offset1:108
v_permlane32_swap_b32 v104, v108
v_permlane32_swap_b32 v105, v109
v_permlane32_swap_b32 v106, v110
v_permlane32_swap_b32 v107, v111
v_pk_add_f32 v[104:105], v[104:105], v[108:109]
v_pk_add_f32 v[106:107], v[106:107], v[110:111]
ds_write2_b32 v15, v104, v105 offset0:0 offset1:36
ds_write2_b32 v15, v106, v107 offset0:72 offset1:108
v_smfmac_f32_16x16x64_bf16 v[112:115], v[32:35], a[128:135], v6
v_smfmac_f32_16x16x64_bf16 v[116:119], v[32:35], a[160:167], v6
v_smfmac_f32_16x16x64_bf16 v[112:115], v[36:39], a[136:143], v6
v_smfmac_f32_16x16x64_bf16 v[116:119], v[36:39], a[168:175], v6
s_waitcnt lgkmcnt(0)
s_barrier
s_cmp_lg_u32 s24, 0
s_cbranch_scc1 mega_kernel_rf_side
ds_read_b128 v[120:123], v16 offset:0
ds_read_b128 v[124:127], v16 offset:16
ds_read_b128 v[128:131], v16 offset:2304
ds_read_b128 v[132:135], v16 offset:2320
ds_read_b128 v[136:139], v16 offset:4608
ds_read_b128 v[140:143], v16 offset:4624
ds_read_b128 v[144:147], v16 offset:6912
ds_read_b128 v[148:151], v16 offset:6928
v_smfmac_f32_16x16x64_bf16 v[112:115], v[40:43], a[144:151], v6
v_smfmac_f32_16x16x64_bf16 v[116:119], v[40:43], a[176:183], v6
v_smfmac_f32_16x16x64_bf16 v[112:115], v[44:47], a[152:159], v6
v_smfmac_f32_16x16x64_bf16 v[116:119], v[44:47], a[184:191], v6
s_mul_i32 s28, s31, 2048
s_add_u32 s28, s28, s33
s_add_u32 s28, s28, 49152
s_add_u32 s76, s37, s33
s_add_u32 s77, s38, s33
s_add_u32 s78, s39, s33
s_waitcnt lgkmcnt(4)
v_pk_add_f32 v[120:121], v[120:121], v[128:129]
v_pk_add_f32 v[122:123], v[122:123], v[130:131]
v_pk_add_f32 v[124:125], v[124:125], v[132:133]
v_pk_add_f32 v[126:127], v[126:127], v[134:135]
s_waitcnt lgkmcnt(0)
v_pk_add_f32 v[136:137], v[136:137], v[144:145]
v_pk_add_f32 v[138:139], v[138:139], v[146:147]
v_pk_add_f32 v[140:141], v[140:141], v[148:149]
v_pk_add_f32 v[142:143], v[142:143], v[150:151]
v_pk_add_f32 v[120:121], v[120:121], v[136:137]
v_pk_add_f32 v[122:123], v[122:123], v[138:139]
v_pk_add_f32 v[124:125], v[124:125], v[140:141]
v_pk_add_f32 v[126:127], v[126:127], v[142:143]
v_cvt_pk_bf16_f32 v152, v120, v121
v_cvt_pk_bf16_f32 v153, v122, v123
v_cvt_pk_bf16_f32 v154, v124, v125
v_cvt_pk_bf16_f32 v155, v126, v127
s_nop 1
v_mfma_f32_16x16x32_bf16 v[176:179], v[160:163], v[152:155], 0
v_mfma_f32_16x16x32_bf16 v[172:175], v[156:159], v[152:155], 0
v_mfma_f32_16x16x32_bf16 v[180:183], v[152:155], v[152:155], 0
s_cmp_eq_u32 s27, 63
s_cbranch_scc1 mega_kernel_rf_w0last
s_nop 4
v_mov_b32_dpp v172, v176 row_shr:8 row_mask:0xf bank_mask:0xc
v_mov_b32_dpp v173, v177 row_shr:8 row_mask:0xf bank_mask:0xc
v_mov_b32_dpp v174, v178 row_shr:8 row_mask:0xf bank_mask:0xc
v_mov_b32_dpp v175, v179 row_shr:8 row_mask:0xf bank_mask:0xc
v_min_u32 v180, -2, v180
v_min_u32 v172, -2, v172
s_mov_b64 exec, s[42:43]
buffer_store_dwordx4 v[180:183], v10, s[84:87], s28 offen
s_mov_b64 exec, -1
buffer_store_dwordx4 v[172:175], v17, s[84:87], s28 offen
v_permlane32_swap_b32 v112, v116
v_permlane32_swap_b32 v113, v117
v_permlane32_swap_b32 v114, v118
v_permlane32_swap_b32 v115, v119
v_pk_add_f32 v[112:113], v[112:113], v[116:117]
v_pk_add_f32 v[114:115], v[114:115], v[118:119]
ds_write_b128 v20, v[112:115]
s_waitcnt lgkmcnt(0)
s_barrier
v_mov_b32 v96, 0
v_mov_b32 v97, 0
v_mov_b32 v98, 0
v_mov_b32 v99, 0
v_mov_b32 v100, 0
v_mov_b32 v101, 0
v_mov_b32 v102, 0
v_mov_b32 v103, 0
v_cndmask_b32 v176, v23, v180, s[42:43]
v_cndmask_b32 v177, v23, v181, s[42:43]
v_cndmask_b32 v178, v23, v182, s[42:43]
v_cndmask_b32 v179, v23, v183, s[42:43]
s_mov_b64 exec, s[42:43]
buffer_load_dwordx4 v[188:191], v10, s[84:87], s76 offen sc1
buffer_load_dwordx4 v[196:199], v10, s[84:87], s77 offen sc1
buffer_load_dwordx4 v[204:207], v10, s[84:87], s78 offen sc1
s_mov_b64 exec, -1
buffer_load_dwordx4 v[184:187], v17, s[84:87], s76 offen sc1
buffer_load_dwordx4 v[192:195], v17, s[84:87], s77 offen sc1
buffer_load_dwordx4 v[200:203], v17, s[84:87], s78 offen sc1
v_pk_mul_f32 v[172:173], v[172:173], s[32:33] op_sel_hi:[1,0]
v_pk_mul_f32 v[174:175], v[174:175], s[32:33] op_sel_hi:[1,0]
v_pk_mul_f32 v[176:177], v[176:177], s[32:33] op_sel_hi:[1,0]
v_pk_mul_f32 v[178:179], v[178:179], s[32:33] op_sel_hi:[1,0]
s_nop 15
s_nop 3
s_mov_b64 exec, s[42:43]
buffer_load_dwordx4 v[188:191], v10, s[84:87], s76 offen sc1
buffer_load_dwordx4 v[196:199], v10, s[84:87], s77 offen sc1
buffer_load_dwordx4 v[204:207], v10, s[84:87], s78 offen sc1
s_mov_b64 exec, -1
buffer_load_dwordx4 v[184:187], v17, s[84:87], s76 offen sc1
buffer_load_dwordx4 v[192:195], v17, s[84:87], s77 offen sc1
buffer_load_dwordx4 v[200:203], v17, s[84:87], s78 offen sc1
mega_kernel_rf_p2:
s_waitcnt vmcnt(6)
v_max3_u32 v4, v184, v188, v192
v_max3_u32 v5, v196, v200, v204
v_max_u32 v4, v4, v5
v_cmp_eq_u32 vcc, -1, v4
s_cbranch_vccnz mega_kernel_rf_p2r
v_pk_add_f32 v[124:125], v[196:197], v[204:205]
v_pk_add_f32 v[126:127], v[198:199], v[206:207]
v_pk_add_f32 v[120:121], v[192:193], v[200:201]
v_pk_add_f32 v[122:123], v[194:195], v[202:203]
v_pk_add_f32 v[124:125], v[124:125], v[188:189]
v_pk_add_f32 v[126:127], v[126:127], v[190:191]
v_pk_add_f32 v[120:121], v[120:121], v[184:185]
v_pk_add_f32 v[122:123], v[122:123], v[186:187]
v_pk_fma_f32 v[176:177], v[124:125], s[32:33], v[176:177] op_sel_hi:[1,0,1]
v_pk_fma_f32 v[178:179], v[126:127], s[32:33], v[178:179] op_sel_hi:[1,0,1]
v_pk_fma_f32 v[172:173], v[120:121], s[32:33], v[172:173] op_sel_hi:[1,0,1]
v_pk_fma_f32 v[174:175], v[122:123], s[32:33], v[174:175] op_sel_hi:[1,0,1]
v_max3_f32 v232, v172, v173, v174
v_max3_f32 v233, v176, v177, v178
v_max3_f32 v232, v232, v175, v179
v_max_f32 v234, v232, v233
s_barrier
ds_read2_b64 v[208:211], v21 offset0:0 offset1:32
v_max_f32_dpp v232, v234, v234 row_ror:8 row_mask:0xf bank_mask:0xf
v_max_f32_dpp v233, v234, v234 row_ror:8 row_mask:0xf bank_mask:0xf
s_nop 1
v_permlane16_swap_b32 v232, v233
s_nop 0
v_max_f32 v234, v232, v233
v_max_f32 v235, v232, v233
s_nop 1
v_permlane32_swap_b32 v234, v235
s_nop 0
v_max_f32 v232, v234, v235
v_pk_add_f32 v[176:177], v[176:177], v[232:233] op_sel_hi:[1,0] neg_lo:[0,1] neg_hi:[0,1]
v_pk_add_f32 v[178:179], v[178:179], v[232:233] op_sel_hi:[1,0] neg_lo:[0,1] neg_hi:[0,1]
v_pk_add_f32 v[172:173], v[172:173], v[232:233] op_sel_hi:[1,0] neg_lo:[0,1] neg_hi:[0,1]
v_pk_add_f32 v[174:175], v[174:175], v[232:233] op_sel_hi:[1,0] neg_lo:[0,1] neg_hi:[0,1]
v_exp_f32 v176, v176
v_exp_f32 v177, v177
v_exp_f32 v178, v178
v_exp_f32 v179, v179
v_exp_f32 v172, v172
v_cvt_pk_bf16_f32 v216, v176, v177
v_cvt_pk_bf16_f32 v217, v178, v179
v_exp_f32 v173, v173
v_exp_f32 v174, v174
v_mfma_f32_16x16x16_bf16 v[224:227], v[220:221], v[216:217], 0
v_exp_f32 v175, v175
v_cvt_pk_bf16_f32 v212, v172, v173
s_waitcnt lgkmcnt(0)
v_mfma_f32_16x16x16_bf16 v[120:123], v[208:209], v[216:217], 0
v_cvt_pk_bf16_f32 v213, v174, v175
v_mfma_f32_16x16x16_bf16 v[124:127], v[210:211], v[216:217], 0
v_mov_b32_dpp v214, v212 row_ror:8 row_mask:0xf bank_mask:0xf
v_mov_b32_dpp v215, v213 row_ror:8 row_mask:0xf bank_mask:0xf
s_nop 1
v_mfma_f32_16x16x32_bf16 v[224:227], v[220:223], v[212:215], v[224:227]
v_mfma_f32_16x16x32_bf16 v[120:123], v[164:167], v[212:215], v[120:123]
v_mfma_f32_16x16x32_bf16 v[124:127], v[168:171], v[212:215], v[124:127]
s_add_u32 s29, s33, 24576
s_nop 4
v_rcp_f32 v234, v224
s_nop 0
v_pk_mul_f32 v[120:121], v[120:121], v[234:235] op_sel_hi:[1,0]
v_pk_mul_f32 v[122:123], v[122:123], v[234:235] op_sel_hi:[1,0]
v_pk_mul_f32 v[124:125], v[124:125], v[234:235] op_sel_hi:[1,0]
v_pk_mul_f32 v[126:127], v[126:127], v[234:235] op_sel_hi:[1,0]
v_cvt_pk_bf16_f32 v212, v120, v121
v_cvt_pk_bf16_f32 v213, v122, v123
v_cvt_pk_bf16_f32 v214, v124, v125
v_cvt_pk_bf16_f32 v215, v126, v127
v_min_u32 v212, -2, v212
s_mov_b64 exec, s[40:41]
buffer_store_dwordx4 v[212:215], v11, s[84:87], s33 offen
s_mov_b64 exec, -1
mega_kernel_rf_b3:
s_barrier
s_nop 15
buffer_load_dwordx4 v[32:35], v7, s[84:87], s29 offen offset:0 sc1
s_nop 9
buffer_load_dwordx4 v[36:39], v7, s[84:87], s29 offen offset:1024 sc1
s_nop 9
buffer_load_dwordx4 v[40:43], v7, s[84:87], s29 offen offset:2048 sc1
s_nop 9
buffer_load_dwordx4 v[44:47], v7, s[84:87], s29 offen offset:3072 sc1
mega_kernel_rf_pc_15_0:
s_waitcnt vmcnt(3)
v_cmp_eq_u32 vcc, -1, v32
s_cbranch_vccnz mega_kernel_rf_pc_15_0f
v_smfmac_f32_16x16x64_bf16 v[96:99], v[32:35], a[192:199], v6
v_smfmac_f32_16x16x64_bf16 v[100:103], v[32:35], a[224:231], v6
mega_kernel_rf_pc_14_1:
s_waitcnt vmcnt(2)
v_cmp_eq_u32 vcc, -1, v36
s_cbranch_vccnz mega_kernel_rf_pc_14_1f
v_smfmac_f32_16x16x64_bf16 v[96:99], v[36:39], a[200:207], v6
v_smfmac_f32_16x16x64_bf16 v[100:103], v[36:39], a[232:239], v6
mega_kernel_rf_pc_12_2:
s_waitcnt vmcnt(1)
v_cmp_eq_u32 vcc, -1, v40
s_cbranch_vccnz mega_kernel_rf_pc_12_2f
v_smfmac_f32_16x16x64_bf16 v[96:99], v[40:43], a[208:215], v6
v_smfmac_f32_16x16x64_bf16 v[100:103], v[40:43], a[240:247], v6
mega_kernel_rf_pc_8_3:
s_waitcnt vmcnt(0)
v_cmp_eq_u32 vcc, -1, v44
s_cbranch_vccnz mega_kernel_rf_pc_8_3f
v_smfmac_f32_16x16x64_bf16 v[96:99], v[44:47], a[216:223], v6
v_smfmac_f32_16x16x64_bf16 v[100:103], v[44:47], a[248:255], v6
mega_kernel_rf_pc_d:
s_nop 7
v_permlane32_swap_b32 v96, v100
v_permlane32_swap_b32 v97, v101
v_permlane32_swap_b32 v98, v102
v_permlane32_swap_b32 v99, v103
v_pk_add_f32 v[96:97], v[96:97], v[100:101]
v_pk_add_f32 v[98:99], v[98:99], v[102:103]
ds_write2_b32 v18, v96, v97 offset0:0 offset1:36
ds_write2_b32 v18, v98, v99 offset0:72 offset1:108
s_waitcnt lgkmcnt(0)
s_barrier
s_cmp_lg_u32 s24, 0
s_cbranch_scc1 mega_kernel_rf_x1
ds_read_b128 v[120:123], v19 offset:0
ds_read_b128 v[124:127], v19 offset:1152
ds_read_b128 v[128:131], v19 offset:2304
ds_read_b128 v[132:135], v19 offset:3456
s_waitcnt lgkmcnt(2)
v_pk_add_f32 v[120:121], v[120:121], v[124:125]
v_pk_add_f32 v[122:123], v[122:123], v[126:127]
s_waitcnt lgkmcnt(0)
v_pk_add_f32 v[128:129], v[128:129], v[132:133]
v_pk_add_f32 v[130:131], v[130:131], v[134:135]
v_pk_add_f32 v[120:121], v[120:121], v[128:129]
v_pk_add_f32 v[122:123], v[122:123], v[130:131]
v_and_or_b32 v120, v120, -2, s47
v_and_or_b32 v121, v121, -2, s47
v_and_or_b32 v122, v122, -2, s47
v_and_or_b32 v123, v123, -2, s47
buffer_store_dwordx4 v[120:123], v12, s[84:87], s35 offen sc1
s_xor_b32 s76, s47, 1
v_mov_b32 v48, s76
v_mov_b32 v49, s76
v_mov_b32 v50, s76
v_mov_b32 v51, s76
v_mov_b32 v52, s76
v_mov_b32 v53, s76
v_mov_b32 v54, s76
v_mov_b32 v55, s76
v_mov_b32 v56, s76
v_mov_b32 v57, s76
v_mov_b32 v58, s76
v_mov_b32 v59, s76
v_mov_b32 v96, 0
v_mov_b32 v97, 0
v_mov_b32 v98, 0
v_mov_b32 v99, 0
v_mov_b32 v100, 0
v_mov_b32 v101, 0
v_mov_b32 v102, 0
v_mov_b32 v103, 0
v_mov_b32 v104, 0
v_mov_b32 v105, 0
v_mov_b32 v106, 0
v_mov_b32 v107, 0
v_mov_b32 v108, 0
v_mov_b32 v109, 0
v_mov_b32 v110, 0
v_mov_b32 v111, 0
v_mov_b32 v112, 0
v_mov_b32 v113, 0
v_mov_b32 v114, 0
v_mov_b32 v115, 0
v_mov_b32 v116, 0
v_mov_b32 v117, 0
v_mov_b32 v118, 0
v_mov_b32 v119, 0
s_nop 15
s_cmp_eq_u32 s47, 1
s_cbranch_scc1 mega_kernel_rf_p4_1
mega_kernel_rf_p4_0:
buffer_load_dwordx4 v[48:51], v25, s[84:87], s35 offen sc1
buffer_load_dwordx4 v[52:55], v26, s[84:87], s35 offen sc1
buffer_load_dwordx4 v[56:59], v27, s[84:87], s35 offen sc1
s_waitcnt vmcnt(12)
mega_kernel_rf_p4c_0:
v_bitop3_b32 v4, v48, v49, v50 bitop3:0xfe
v_bitop3_b32 v5, v54, v55, v56 bitop3:0xfe
v_bitop3_b32 v4, v4, v51, v52 bitop3:0xfe
v_bitop3_b32 v5, v5, v57, v58 bitop3:0xfe
v_bitop3_b32 v4, v4, v53, v59 bitop3:0xfe
v_bitop3_b32 v4, v4, v5, 1 bitop3:0xa8
v_cmp_ne_u32 vcc, 0, v4
s_cbranch_vccnz mega_kernel_rf_p4_0
v_pk_add_f32 v[120:121], v[120:121], v[48:49]
v_pk_add_f32 v[124:125], v[52:53], v[56:57]
v_pk_add_f32 v[122:123], v[122:123], v[50:51]
v_pk_add_f32 v[126:127], v[54:55], v[58:59]
v_pk_add_f32 v[120:121], v[120:121], v[124:125]
v_pk_add_f32 v[122:123], v[122:123], v[126:127]
v_cvt_pk_bf16_f32 v212, v120, v121
v_cvt_pk_bf16_f32 v213, v122, v123
v_min_u32 v212, -2, v212
buffer_store_dwordx2 v[212:213], v9, s[84:87], s34 offen
s_branch mega_kernel_rf_p4d
mega_kernel_rf_p4_1:
buffer_load_dwordx4 v[48:51], v25, s[84:87], s35 offen sc1
buffer_load_dwordx4 v[52:55], v26, s[84:87], s35 offen sc1
buffer_load_dwordx4 v[56:59], v27, s[84:87], s35 offen sc1
s_waitcnt vmcnt(12)
mega_kernel_rf_p4c_1:
v_bitop3_b32 v4, v48, v49, v50 bitop3:0x80
v_bitop3_b32 v5, v54, v55, v56 bitop3:0x80
v_bitop3_b32 v4, v4, v51, v52 bitop3:0x80
v_bitop3_b32 v5, v5, v57, v58 bitop3:0x80
v_bitop3_b32 v4, v4, v53, v59 bitop3:0x80
v_bitop3_b32 v4, v4, v5, 1 bitop3:0x80
v_cmp_ne_u32 vcc, 1, v4
s_cbranch_vccnz mega_kernel_rf_p4_1
v_pk_add_f32 v[120:121], v[120:121], v[48:49]
v_pk_add_f32 v[124:125], v[52:53], v[56:57]
v_pk_add_f32 v[122:123], v[122:123], v[50:51]
v_pk_add_f32 v[126:127], v[54:55], v[58:59]
v_pk_add_f32 v[120:121], v[120:121], v[124:125]
v_pk_add_f32 v[122:123], v[122:123], v[126:127]
v_cvt_pk_bf16_f32 v212, v120, v121
v_cvt_pk_bf16_f32 v213, v122, v123
v_min_u32 v212, -2, v212
buffer_store_dwordx2 v[212:213], v9, s[84:87], s34 offen
mega_kernel_rf_p4d:
mega_kernel_rf_b5:
s_add_u32 s27, s27, 1
s_add_u32 s44, s44, 4096
s_cmp_eq_u32 s44, 30720
s_cselect_b32 s44, 18432, s44
s_mov_b32 s28, s33
s_mov_b32 s33, s34
s_mov_b32 s34, s28
s_xor_b32 s35, s35, 262144
s_bfe_u32 s47, s27, 0x10001
s_barrier
s_nop 15
s_branch mega_kernel_rf_loop
mega_kernel_rf_x1:
s_cmp_eq_u32 s24, 1
s_cbranch_scc0 mega_kernel_rf_x2
s_add_u32 s76, s27, 1
v_mov_b32 v5, s76
s_mov_b64 exec, 1
buffer_store_dword v5, v228, s[84:87], s81 offen sc1
s_mov_b64 exec, -1
mega_kernel_rf_x2:
s_cmp_eq_u32 s24, 3
s_cbranch_scc0 mega_kernel_rf_x4
s_cmp_eq_u32 s36, 1
s_cbranch_scc0 mega_kernel_rf_x5
s_add_u32 s76, s27, 1
s_cmp_gt_i32 s46, s76
s_cbranch_scc1 mega_kernel_rf_pf1ok
mega_kernel_rf_pf1w:
v_mov_b32 v4, 0
s_mov_b64 exec, 3
buffer_atomic_add v4, v24, s[84:87], 0 offen sc0 sc1
s_mov_b64 exec, -1
s_waitcnt vmcnt(0)
v_readlane_b32 s46, v4, 0
v_readlane_b32 s28, v4, 1
s_nop 1
s_min_i32 s46, s46, s28
s_cmp_gt_i32 s46, s76
s_cbranch_scc0 mega_kernel_rf_pf1w
mega_kernel_rf_pf1ok:
s_add_u32 s77, s76, s82
s_bfe_u32 s28, s77, 0x40002
s_lshl_b32 s28, s28, 14
s_and_b32 s77, s77, 3
s_lshl_b32 s77, s77, 11
s_add_u32 s28, s28, s77
s_add_u32 m0, s45, 0
s_nop 0
buffer_load_dwordx4 v240, s[84:87], s28 offen offset:0 sc1 lds
s_add_u32 m0, s45, 0
s_nop 0
buffer_load_dwordx4 v240, s[84:87], s28 offen offset:1024 sc1 lds
s_add_u32 m0, s45, 2048
s_nop 0
buffer_load_dwordx4 v241, s[84:87], s28 offen offset:0 sc1 lds
s_add_u32 m0, s45, 2048
s_nop 0
buffer_load_dwordx4 v241, s[84:87], s28 offen offset:1024 sc1 lds
s_add_u32 s45, s45, 4096
s_cmp_eq_u32 s45, 30720
s_cselect_b32 s45, 18432, s45
s_waitcnt vmcnt(0)
mega_kernel_rf_x5:
s_add_u32 s76, s27, 4
s_min_u32 s76, s76, 63
s_cmp_gt_i32 s46, s76
s_cbranch_scc1 mega_kernel_rf_x6
v_mov_b32 v249, 0
s_mov_b64 exec, 3
buffer_atomic_add v249, v24, s[84:87], 0 offen sc0 sc1
s_mov_b64 exec, -1
mega_kernel_rf_x6:
s_add_u32 s76, s27, 2
s_cmp_lt_u32 s76, 63
s_cbranch_scc0 mega_kernel_rf_x4
s_cmp_gt_i32 s46, s76
s_cbranch_scc0 mega_kernel_rf_x4
s_add_u32 s77, s76, s82
s_bfe_u32 s28, s77, 0x40002
s_lshl_b32 s28, s28, 14
s_and_b32 s77, s77, 3
s_lshl_b32 s77, s77, 11
s_add_u32 s28, s28, s77
s_add_u32 s28, s28, s83
s_add_u32 s28, s28, 33554432
s_buffer_load_dword s78, s[84:87], s28 offset:0
s_buffer_load_dword s78, s[84:87], s28 offset:128
s_buffer_load_dword s78, s[84:87], s28 offset:256
s_buffer_load_dword s78, s[84:87], s28 offset:384
s_buffer_load_dword s78, s[84:87], s28 offset:512
s_buffer_load_dword s78, s[84:87], s28 offset:640
s_buffer_load_dword s78, s[84:87], s28 offset:768
s_buffer_load_dword s78, s[84:87], s28 offset:896
s_buffer_load_dword s78, s[84:87], s28 offset:1024
s_buffer_load_dword s78, s[84:87], s28 offset:1152
s_buffer_load_dword s78, s[84:87], s28 offset:1280
s_buffer_load_dword s78, s[84:87], s28 offset:1408
s_buffer_load_dword s78, s[84:87], s28 offset:1536
s_buffer_load_dword s78, s[84:87], s28 offset:1664
s_buffer_load_dword s78, s[84:87], s28 offset:1792
s_buffer_load_dword s78, s[84:87], s28 offset:1920
s_mov_b32 s89, s76
mega_kernel_rf_x4:
v_mov_b32 v96, 0
v_mov_b32 v97, 0
v_mov_b32 v98, 0
v_mov_b32 v99, 0
v_mov_b32 v100, 0
v_mov_b32 v101, 0
v_mov_b32 v102, 0
v_mov_b32 v103, 0
v_mov_b32 v104, 0
v_mov_b32 v105, 0
v_mov_b32 v106, 0
v_mov_b32 v107, 0
v_mov_b32 v108, 0
v_mov_b32 v109, 0
v_mov_b32 v110, 0
v_mov_b32 v111, 0
v_mov_b32 v112, 0
v_mov_b32 v113, 0
v_mov_b32 v114, 0
v_mov_b32 v115, 0
v_mov_b32 v116, 0
v_mov_b32 v117, 0
v_mov_b32 v118, 0
v_mov_b32 v119, 0
s_branch mega_kernel_rf_b5
mega_kernel_rf_p2r:
s_mov_b64 exec, s[42:43]
buffer_load_dwordx4 v[188:191], v10, s[84:87], s76 offen sc1
buffer_load_dwordx4 v[196:199], v10, s[84:87], s77 offen sc1
buffer_load_dwordx4 v[204:207], v10, s[84:87], s78 offen sc1
s_mov_b64 exec, -1
buffer_load_dwordx4 v[184:187], v17, s[84:87], s76 offen sc1
buffer_load_dwordx4 v[192:195], v17, s[84:87], s77 offen sc1
buffer_load_dwordx4 v[200:203], v17, s[84:87], s78 offen sc1
s_branch mega_kernel_rf_p2
mega_kernel_rf_pa_1_0f:
s_mov_b64 exec, vcc
buffer_load_dwordx4 v[32:35], v7, s[84:87], s33 offen offset:0 sc1
s_mov_b64 exec, -1
s_branch mega_kernel_rf_pa_1_0
mega_kernel_rf_pa_1_0:
s_waitcnt vmcnt(0)
v_max_u32 v4, v32, v34
v_cmp_eq_u32 vcc, -1, v4
s_cbranch_vccnz mega_kernel_rf_pa_1_0f
v_smfmac_f32_16x16x64_bf16 v[96:99], v[32:35], a[0:7], v6
v_smfmac_f32_16x16x64_bf16 v[100:103], v[32:35], a[32:39], v6
v_smfmac_f32_16x16x64_bf16 v[104:107], v[32:35], a[64:71], v6
v_smfmac_f32_16x16x64_bf16 v[108:111], v[32:35], a[96:103], v6
s_branch mega_kernel_rf_pa_d
mega_kernel_rf_pa_2_1f:
s_mov_b64 exec, vcc
buffer_load_dwordx4 v[36:39], v7, s[84:87], s33 offen offset:1024 sc1
s_mov_b64 exec, -1
s_branch mega_kernel_rf_pa_2_1
mega_kernel_rf_pa_2_1:
s_waitcnt vmcnt(0)
v_max_u32 v4, v36, v38
v_cmp_eq_u32 vcc, -1, v4
s_cbranch_vccnz mega_kernel_rf_pa_2_1f
v_smfmac_f32_16x16x64_bf16 v[96:99], v[36:39], a[8:15], v6
v_smfmac_f32_16x16x64_bf16 v[100:103], v[36:39], a[40:47], v6
v_smfmac_f32_16x16x64_bf16 v[104:107], v[36:39], a[72:79], v6
v_smfmac_f32_16x16x64_bf16 v[108:111], v[36:39], a[104:111], v6
s_branch mega_kernel_rf_pa_d
mega_kernel_rf_pa_3_0f:
s_mov_b64 exec, vcc
buffer_load_dwordx4 v[32:35], v7, s[84:87], s33 offen offset:0 sc1
s_mov_b64 exec, -1
s_branch mega_kernel_rf_pa_3_1
mega_kernel_rf_pa_3_0:
s_waitcnt vmcnt(1)
v_max_u32 v4, v32, v34
v_cmp_eq_u32 vcc, -1, v4
s_cbranch_vccnz mega_kernel_rf_pa_3_0f
v_smfmac_f32_16x16x64_bf16 v[96:99], v[32:35], a[0:7], v6
v_smfmac_f32_16x16x64_bf16 v[100:103], v[32:35], a[32:39], v6
v_smfmac_f32_16x16x64_bf16 v[104:107], v[32:35], a[64:71], v6
v_smfmac_f32_16x16x64_bf16 v[108:111], v[32:35], a[96:103], v6
s_branch mega_kernel_rf_pa_2_1
mega_kernel_rf_pa_3_1f:
s_mov_b64 exec, vcc
buffer_load_dwordx4 v[36:39], v7, s[84:87], s33 offen offset:1024 sc1
s_mov_b64 exec, -1
s_branch mega_kernel_rf_pa_3_0
mega_kernel_rf_pa_3_1:
s_waitcnt vmcnt(1)
v_max_u32 v4, v36, v38
v_cmp_eq_u32 vcc, -1, v4
s_cbranch_vccnz mega_kernel_rf_pa_3_1f
v_smfmac_f32_16x16x64_bf16 v[96:99], v[36:39], a[8:15], v6
v_smfmac_f32_16x16x64_bf16 v[100:103], v[36:39], a[40:47], v6
v_smfmac_f32_16x16x64_bf16 v[104:107], v[36:39], a[72:79], v6
v_smfmac_f32_16x16x64_bf16 v[108:111], v[36:39], a[104:111], v6
s_branch mega_kernel_rf_pa_1_0
mega_kernel_rf_pa_4_2f:
s_mov_b64 exec, vcc
buffer_load_dwordx4 v[40:43], v7, s[84:87], s33 offen offset:2048 sc1
s_mov_b64 exec, -1
s_branch mega_kernel_rf_pa_4_2
mega_kernel_rf_pa_4_2:
s_waitcnt vmcnt(0)
v_max_u32 v4, v40, v42
v_cmp_eq_u32 vcc, -1, v4
s_cbranch_vccnz mega_kernel_rf_pa_4_2f
v_smfmac_f32_16x16x64_bf16 v[96:99], v[40:43], a[16:23], v6
v_smfmac_f32_16x16x64_bf16 v[100:103], v[40:43], a[48:55], v6
v_smfmac_f32_16x16x64_bf16 v[104:107], v[40:43], a[80:87], v6
v_smfmac_f32_16x16x64_bf16 v[108:111], v[40:43], a[112:119], v6
s_branch mega_kernel_rf_pa_d
mega_kernel_rf_pa_5_0f:
s_mov_b64 exec, vcc
buffer_load_dwordx4 v[32:35], v7, s[84:87], s33 offen offset:0 sc1
s_mov_b64 exec, -1
s_branch mega_kernel_rf_pa_5_2
mega_kernel_rf_pa_5_0:
s_waitcnt vmcnt(1)
v_max_u32 v4, v32, v34
v_cmp_eq_u32 vcc, -1, v4
s_cbranch_vccnz mega_kernel_rf_pa_5_0f
v_smfmac_f32_16x16x64_bf16 v[96:99], v[32:35], a[0:7], v6
v_smfmac_f32_16x16x64_bf16 v[100:103], v[32:35], a[32:39], v6
v_smfmac_f32_16x16x64_bf16 v[104:107], v[32:35], a[64:71], v6
v_smfmac_f32_16x16x64_bf16 v[108:111], v[32:35], a[96:103], v6
s_branch mega_kernel_rf_pa_4_2
mega_kernel_rf_pa_5_2f:
s_mov_b64 exec, vcc
buffer_load_dwordx4 v[40:43], v7, s[84:87], s33 offen offset:2048 sc1
s_mov_b64 exec, -1
s_branch mega_kernel_rf_pa_5_0
mega_kernel_rf_pa_5_2:
s_waitcnt vmcnt(1)
v_max_u32 v4, v40, v42
v_cmp_eq_u32 vcc, -1, v4
s_cbranch_vccnz mega_kernel_rf_pa_5_2f
v_smfmac_f32_16x16x64_bf16 v[96:99], v[40:43], a[16:23], v6
v_smfmac_f32_16x16x64_bf16 v[100:103], v[40:43], a[48:55], v6
v_smfmac_f32_16x16x64_bf16 v[104:107], v[40:43], a[80:87], v6
v_smfmac_f32_16x16x64_bf16 v[108:111], v[40:43], a[112:119], v6
s_branch mega_kernel_rf_pa_1_0
mega_kernel_rf_pa_6_1f:
s_mov_b64 exec, vcc
buffer_load_dwordx4 v[36:39], v7, s[84:87], s33 offen offset:1024 sc1
s_mov_b64 exec, -1
s_branch mega_kernel_rf_pa_6_2
mega_kernel_rf_pa_6_1:
s_waitcnt vmcnt(1)
v_max_u32 v4, v36, v38
v_cmp_eq_u32 vcc, -1, v4
s_cbranch_vccnz mega_kernel_rf_pa_6_1f
v_smfmac_f32_16x16x64_bf16 v[96:99], v[36:39], a[8:15], v6
v_smfmac_f32_16x16x64_bf16 v[100:103], v[36:39], a[40:47], v6
v_smfmac_f32_16x16x64_bf16 v[104:107], v[36:39], a[72:79], v6
v_smfmac_f32_16x16x64_bf16 v[108:111], v[36:39], a[104:111], v6
s_branch mega_kernel_rf_pa_4_2
mega_kernel_rf_pa_6_2f:
s_mov_b64 exec, vcc
buffer_load_dwordx4 v[40:43], v7, s[84:87], s33 offen offset:2048 sc1
s_mov_b64 exec, -1
s_branch mega_kernel_rf_pa_6_1
mega_kernel_rf_pa_6_2:
s_waitcnt vmcnt(1)
v_max_u32 v4, v40, v42
v_cmp_eq_u32 vcc, -1, v4
s_cbranch_vccnz mega_kernel_rf_pa_6_2f
v_smfmac_f32_16x16x64_bf16 v[96:99], v[40:43], a[16:23], v6
v_smfmac_f32_16x16x64_bf16 v[100:103], v[40:43], a[48:55], v6
v_smfmac_f32_16x16x64_bf16 v[104:107], v[40:43], a[80:87], v6
v_smfmac_f32_16x16x64_bf16 v[108:111], v[40:43], a[112:119], v6
s_branch mega_kernel_rf_pa_2_1
mega_kernel_rf_pa_7_0f:
s_mov_b64 exec, vcc
buffer_load_dwordx4 v[32:35], v7, s[84:87], s33 offen offset:0 sc1
s_mov_b64 exec, -1
s_branch mega_kernel_rf_pa_7_1
mega_kernel_rf_pa_7_0:
s_waitcnt vmcnt(2)
v_max_u32 v4, v32, v34
v_cmp_eq_u32 vcc, -1, v4
s_cbranch_vccnz mega_kernel_rf_pa_7_0f
v_smfmac_f32_16x16x64_bf16 v[96:99], v[32:35], a[0:7], v6
v_smfmac_f32_16x16x64_bf16 v[100:103], v[32:35], a[32:39], v6
v_smfmac_f32_16x16x64_bf16 v[104:107], v[32:35], a[64:71], v6
v_smfmac_f32_16x16x64_bf16 v[108:111], v[32:35], a[96:103], v6
s_branch mega_kernel_rf_pa_6_1
mega_kernel_rf_pa_7_1f:
s_mov_b64 exec, vcc
buffer_load_dwordx4 v[36:39], v7, s[84:87], s33 offen offset:1024 sc1
s_mov_b64 exec, -1
s_branch mega_kernel_rf_pa_7_2
mega_kernel_rf_pa_7_1:
s_waitcnt vmcnt(2)
v_max_u32 v4, v36, v38
v_cmp_eq_u32 vcc, -1, v4
s_cbranch_vccnz mega_kernel_rf_pa_7_1f
v_smfmac_f32_16x16x64_bf16 v[96:99], v[36:39], a[8:15], v6
v_smfmac_f32_16x16x64_bf16 v[100:103], v[36:39], a[40:47], v6
v_smfmac_f32_16x16x64_bf16 v[104:107], v[36:39], a[72:79], v6
v_smfmac_f32_16x16x64_bf16 v[108:111], v[36:39], a[104:111], v6
s_branch mega_kernel_rf_pa_5_2
mega_kernel_rf_pa_7_2f:
s_mov_b64 exec, vcc
buffer_load_dwordx4 v[40:43], v7, s[84:87], s33 offen offset:2048 sc1
s_mov_b64 exec, -1
s_branch mega_kernel_rf_pa_7_0
mega_kernel_rf_pa_7_2:
s_waitcnt vmcnt(2)
v_max_u32 v4, v40, v42
v_cmp_eq_u32 vcc, -1, v4
s_cbranch_vccnz mega_kernel_rf_pa_7_2f
v_smfmac_f32_16x16x64_bf16 v[96:99], v[40:43], a[16:23], v6
v_smfmac_f32_16x16x64_bf16 v[100:103], v[40:43], a[48:55], v6
v_smfmac_f32_16x16x64_bf16 v[104:107], v[40:43], a[80:87], v6
v_smfmac_f32_16x16x64_bf16 v[108:111], v[40:43], a[112:119], v6
s_branch mega_kernel_rf_pa_3_0
mega_kernel_rf_pa_8_3f:
s_mov_b64 exec, vcc
buffer_load_dwordx4 v[44:47], v7, s[84:87], s33 offen offset:3072 sc1
s_mov_b64 exec, -1
s_branch mega_kernel_rf_pa_8_3
mega_kernel_rf_pa_8_3:
s_waitcnt vmcnt(0)
v_max_u32 v4, v44, v46
v_cmp_eq_u32 vcc, -1, v4
s_cbranch_vccnz mega_kernel_rf_pa_8_3f
v_smfmac_f32_16x16x64_bf16 v[96:99], v[44:47], a[24:31], v6
v_smfmac_f32_16x16x64_bf16 v[100:103], v[44:47], a[56:63], v6
v_smfmac_f32_16x16x64_bf16 v[104:107], v[44:47], a[88:95], v6
v_smfmac_f32_16x16x64_bf16 v[108:111], v[44:47], a[120:127], v6
s_branch mega_kernel_rf_pa_d
mega_kernel_rf_pa_9_0f:
s_mov_b64 exec, vcc
buffer_load_dwordx4 v[32:35], v7, s[84:87], s33 offen offset:0 sc1
s_mov_b64 exec, -1
s_branch mega_kernel_rf_pa_9_3
mega_kernel_rf_pa_9_0:
s_waitcnt vmcnt(1)
v_max_u32 v4, v32, v34
v_cmp_eq_u32 vcc, -1, v4
s_cbranch_vccnz mega_kernel_rf_pa_9_0f
v_smfmac_f32_16x16x64_bf16 v[96:99], v[32:35], a[0:7], v6
v_smfmac_f32_16x16x64_bf16 v[100:103], v[32:35], a[32:39], v6
v_smfmac_f32_16x16x64_bf16 v[104:107], v[32:35], a[64:71], v6
v_smfmac_f32_16x16x64_bf16 v[108:111], v[32:35], a[96:103], v6
s_branch mega_kernel_rf_pa_8_3
mega_kernel_rf_pa_9_3f:
s_mov_b64 exec, vcc
buffer_load_dwordx4 v[44:47], v7, s[84:87], s33 offen offset:3072 sc1
s_mov_b64 exec, -1
s_branch mega_kernel_rf_pa_9_0
mega_kernel_rf_pa_9_3:
s_waitcnt vmcnt(1)
v_max_u32 v4, v44, v46
v_cmp_eq_u32 vcc, -1, v4
s_cbranch_vccnz mega_kernel_rf_pa_9_3f
v_smfmac_f32_16x16x64_bf16 v[96:99], v[44:47], a[24:31], v6
v_smfmac_f32_16x16x64_bf16 v[100:103], v[44:47], a[56:63], v6
v_smfmac_f32_16x16x64_bf16 v[104:107], v[44:47], a[88:95], v6
v_smfmac_f32_16x16x64_bf16 v[108:111], v[44:47], a[120:127], v6
s_branch mega_kernel_rf_pa_1_0
mega_kernel_rf_pa_10_1f:
s_mov_b64 exec, vcc
buffer_load_dwordx4 v[36:39], v7, s[84:87], s33 offen offset:1024 sc1
s_mov_b64 exec, -1
s_branch mega_kernel_rf_pa_10_3
mega_kernel_rf_pa_10_1:
s_waitcnt vmcnt(1)
v_max_u32 v4, v36, v38
v_cmp_eq_u32 vcc, -1, v4
s_cbranch_vccnz mega_kernel_rf_pa_10_1f
v_smfmac_f32_16x16x64_bf16 v[96:99], v[36:39], a[8:15], v6
v_smfmac_f32_16x16x64_bf16 v[100:103], v[36:39], a[40:47], v6
v_smfmac_f32_16x16x64_bf16 v[104:107], v[36:39], a[72:79], v6
v_smfmac_f32_16x16x64_bf16 v[108:111], v[36:39], a[104:111], v6
s_branch mega_kernel_rf_pa_8_3
mega_kernel_rf_pa_10_3f:
s_mov_b64 exec, vcc
buffer_load_dwordx4 v[44:47], v7, s[84:87], s33 offen offset:3072 sc1
s_mov_b64 exec, -1
s_branch mega_kernel_rf_pa_10_1
mega_kernel_rf_pa_10_3:
s_waitcnt vmcnt(1)
v_max_u32 v4, v44, v46
v_cmp_eq_u32 vcc, -1, v4
s_cbranch_vccnz mega_kernel_rf_pa_10_3f
v_smfmac_f32_16x16x64_bf16 v[96:99], v[44:47], a[24:31], v6
v_smfmac_f32_16x16x64_bf16 v[100:103], v[44:47], a[56:63], v6
v_smfmac_f32_16x16x64_bf16 v[104:107], v[44:47], a[88:95], v6
v_smfmac_f32_16x16x64_bf16 v[108:111], v[44:47], a[120:127], v6
s_branch mega_kernel_rf_pa_2_1
mega_kernel_rf_pa_11_0f:
s_mov_b64 exec, vcc
buffer_load_dwordx4 v[32:35], v7, s[84:87], s33 offen offset:0 sc1
s_mov_b64 exec, -1
s_branch mega_kernel_rf_pa_11_1
mega_kernel_rf_pa_11_0:
s_waitcnt vmcnt(2)
v_max_u32 v4, v32, v34
v_cmp_eq_u32 vcc, -1, v4
s_cbranch_vccnz mega_kernel_rf_pa_11_0f
v_smfmac_f32_16x16x64_bf16 v[96:99], v[32:35], a[0:7], v6
v_smfmac_f32_16x16x64_bf16 v[100:103], v[32:35], a[32:39], v6
v_smfmac_f32_16x16x64_bf16 v[104:107], v[32:35], a[64:71], v6
v_smfmac_f32_16x16x64_bf16 v[108:111], v[32:35], a[96:103], v6
s_branch mega_kernel_rf_pa_10_1
mega_kernel_rf_pa_11_1f:
s_mov_b64 exec, vcc
buffer_load_dwordx4 v[36:39], v7, s[84:87], s33 offen offset:1024 sc1
s_mov_b64 exec, -1
s_branch mega_kernel_rf_pa_11_3
mega_kernel_rf_pa_11_1:
s_waitcnt vmcnt(2)
v_max_u32 v4, v36, v38
v_cmp_eq_u32 vcc, -1, v4
s_cbranch_vccnz mega_kernel_rf_pa_11_1f
v_smfmac_f32_16x16x64_bf16 v[96:99], v[36:39], a[8:15], v6
v_smfmac_f32_16x16x64_bf16 v[100:103], v[36:39], a[40:47], v6
v_smfmac_f32_16x16x64_bf16 v[104:107], v[36:39], a[72:79], v6
v_smfmac_f32_16x16x64_bf16 v[108:111], v[36:39], a[104:111], v6
s_branch mega_kernel_rf_pa_9_3
mega_kernel_rf_pa_11_3f:
s_mov_b64 exec, vcc
buffer_load_dwordx4 v[44:47], v7, s[84:87], s33 offen offset:3072 sc1
s_mov_b64 exec, -1
s_branch mega_kernel_rf_pa_11_0
mega_kernel_rf_pa_11_3:
s_waitcnt vmcnt(2)
v_max_u32 v4, v44, v46
v_cmp_eq_u32 vcc, -1, v4
s_cbranch_vccnz mega_kernel_rf_pa_11_3f
v_smfmac_f32_16x16x64_bf16 v[96:99], v[44:47], a[24:31], v6
v_smfmac_f32_16x16x64_bf16 v[100:103], v[44:47], a[56:63], v6
v_smfmac_f32_16x16x64_bf16 v[104:107], v[44:47], a[88:95], v6
v_smfmac_f32_16x16x64_bf16 v[108:111], v[44:47], a[120:127], v6
s_branch mega_kernel_rf_pa_3_0
mega_kernel_rf_pa_12_2f:
s_mov_b64 exec, vcc
buffer_load_dwordx4 v[40:43], v7, s[84:87], s33 offen offset:2048 sc1
s_mov_b64 exec, -1
s_branch mega_kernel_rf_pa_12_3
mega_kernel_rf_pa_12_2:
s_waitcnt vmcnt(1)
v_max_u32 v4, v40, v42
v_cmp_eq_u32 vcc, -1, v4
s_cbranch_vccnz mega_kernel_rf_pa_12_2f
v_smfmac_f32_16x16x64_bf16 v[96:99], v[40:43], a[16:23], v6
v_smfmac_f32_16x16x64_bf16 v[100:103], v[40:43], a[48:55], v6
v_smfmac_f32_16x16x64_bf16 v[104:107], v[40:43], a[80:87], v6
v_smfmac_f32_16x16x64_bf16 v[108:111], v[40:43], a[112:119], v6
s_branch mega_kernel_rf_pa_8_3
mega_kernel_rf_pa_12_3f:
s_mov_b64 exec, vcc
buffer_load_dwordx4 v[44:47], v7, s[84:87], s33 offen offset:3072 sc1
s_mov_b64 exec, -1
s_branch mega_kernel_rf_pa_12_2
mega_kernel_rf_pa_12_3:
s_waitcnt vmcnt(1)
v_max_u32 v4, v44, v46
v_cmp_eq_u32 vcc, -1, v4
s_cbranch_vccnz mega_kernel_rf_pa_12_3f
v_smfmac_f32_16x16x64_bf16 v[96:99], v[44:47], a[24:31], v6
v_smfmac_f32_16x16x64_bf16 v[100:103], v[44:47], a[56:63], v6
v_smfmac_f32_16x16x64_bf16 v[104:107], v[44:47], a[88:95], v6
v_smfmac_f32_16x16x64_bf16 v[108:111], v[44:47], a[120:127], v6
s_branch mega_kernel_rf_pa_4_2
mega_kernel_rf_pa_13_0f:
s_mov_b64 exec, vcc
buffer_load_dwordx4 v[32:35], v7, s[84:87], s33 offen offset:0 sc1
s_mov_b64 exec, -1
s_branch mega_kernel_rf_pa_13_2
mega_kernel_rf_pa_13_0:
s_waitcnt vmcnt(2)
v_max_u32 v4, v32, v34
v_cmp_eq_u32 vcc, -1, v4
s_cbranch_vccnz mega_kernel_rf_pa_13_0f
v_smfmac_f32_16x16x64_bf16 v[96:99], v[32:35], a[0:7], v6
v_smfmac_f32_16x16x64_bf16 v[100:103], v[32:35], a[32:39], v6
v_smfmac_f32_16x16x64_bf16 v[104:107], v[32:35], a[64:71], v6
v_smfmac_f32_16x16x64_bf16 v[108:111], v[32:35], a[96:103], v6
s_branch mega_kernel_rf_pa_12_2
mega_kernel_rf_pa_13_2f:
s_mov_b64 exec, vcc
buffer_load_dwordx4 v[40:43], v7, s[84:87], s33 offen offset:2048 sc1
s_mov_b64 exec, -1
s_branch mega_kernel_rf_pa_13_3
mega_kernel_rf_pa_13_2:
s_waitcnt vmcnt(2)
v_max_u32 v4, v40, v42
v_cmp_eq_u32 vcc, -1, v4
s_cbranch_vccnz mega_kernel_rf_pa_13_2f
v_smfmac_f32_16x16x64_bf16 v[96:99], v[40:43], a[16:23], v6
v_smfmac_f32_16x16x64_bf16 v[100:103], v[40:43], a[48:55], v6
v_smfmac_f32_16x16x64_bf16 v[104:107], v[40:43], a[80:87], v6
v_smfmac_f32_16x16x64_bf16 v[108:111], v[40:43], a[112:119], v6
s_branch mega_kernel_rf_pa_9_3
mega_kernel_rf_pa_13_3f:
s_mov_b64 exec, vcc
buffer_load_dwordx4 v[44:47], v7, s[84:87], s33 offen offset:3072 sc1
s_mov_b64 exec, -1
s_branch mega_kernel_rf_pa_13_0
mega_kernel_rf_pa_13_3:
s_waitcnt vmcnt(2)
v_max_u32 v4, v44, v46
v_cmp_eq_u32 vcc, -1, v4
s_cbranch_vccnz mega_kernel_rf_pa_13_3f
v_smfmac_f32_16x16x64_bf16 v[96:99], v[44:47], a[24:31], v6
v_smfmac_f32_16x16x64_bf16 v[100:103], v[44:47], a[56:63], v6
v_smfmac_f32_16x16x64_bf16 v[104:107], v[44:47], a[88:95], v6
v_smfmac_f32_16x16x64_bf16 v[108:111], v[44:47], a[120:127], v6
s_branch mega_kernel_rf_pa_5_0
mega_kernel_rf_pa_14_1f:
s_mov_b64 exec, vcc
buffer_load_dwordx4 v[36:39], v7, s[84:87], s33 offen offset:1024 sc1
s_mov_b64 exec, -1
s_branch mega_kernel_rf_pa_14_2
mega_kernel_rf_pa_14_1:
s_waitcnt vmcnt(2)
v_max_u32 v4, v36, v38
v_cmp_eq_u32 vcc, -1, v4
s_cbranch_vccnz mega_kernel_rf_pa_14_1f
v_smfmac_f32_16x16x64_bf16 v[96:99], v[36:39], a[8:15], v6
v_smfmac_f32_16x16x64_bf16 v[100:103], v[36:39], a[40:47], v6
v_smfmac_f32_16x16x64_bf16 v[104:107], v[36:39], a[72:79], v6
v_smfmac_f32_16x16x64_bf16 v[108:111], v[36:39], a[104:111], v6
s_branch mega_kernel_rf_pa_12_2
mega_kernel_rf_pa_14_2f:
s_mov_b64 exec, vcc
buffer_load_dwordx4 v[40:43], v7, s[84:87], s33 offen offset:2048 sc1
s_mov_b64 exec, -1
s_branch mega_kernel_rf_pa_14_3
mega_kernel_rf_pa_14_2:
s_waitcnt vmcnt(2)
v_max_u32 v4, v40, v42
v_cmp_eq_u32 vcc, -1, v4
s_cbranch_vccnz mega_kernel_rf_pa_14_2f
v_smfmac_f32_16x16x64_bf16 v[96:99], v[40:43], a[16:23], v6
v_smfmac_f32_16x16x64_bf16 v[100:103], v[40:43], a[48:55], v6
v_smfmac_f32_16x16x64_bf16 v[104:107], v[40:43], a[80:87], v6
v_smfmac_f32_16x16x64_bf16 v[108:111], v[40:43], a[112:119], v6
s_branch mega_kernel_rf_pa_10_3
mega_kernel_rf_pa_14_3f:
s_mov_b64 exec, vcc
buffer_load_dwordx4 v[44:47], v7, s[84:87], s33 offen offset:3072 sc1
s_mov_b64 exec, -1
s_branch mega_kernel_rf_pa_14_1
mega_kernel_rf_pa_14_3:
s_waitcnt vmcnt(2)
v_max_u32 v4, v44, v46
v_cmp_eq_u32 vcc, -1, v4
s_cbranch_vccnz mega_kernel_rf_pa_14_3f
v_smfmac_f32_16x16x64_bf16 v[96:99], v[44:47], a[24:31], v6
v_smfmac_f32_16x16x64_bf16 v[100:103], v[44:47], a[56:63], v6
v_smfmac_f32_16x16x64_bf16 v[104:107], v[44:47], a[88:95], v6
v_smfmac_f32_16x16x64_bf16 v[108:111], v[44:47], a[120:127], v6
s_branch mega_kernel_rf_pa_6_1
mega_kernel_rf_pa_15_0f:
s_mov_b64 exec, vcc
buffer_load_dwordx4 v[32:35], v7, s[84:87], s33 offen offset:0 sc1
s_mov_b64 exec, -1
s_branch mega_kernel_rf_pa_15_1
mega_kernel_rf_pa_15_0:
s_waitcnt vmcnt(3)
v_max_u32 v4, v32, v34
v_cmp_eq_u32 vcc, -1, v4
s_cbranch_vccnz mega_kernel_rf_pa_15_0f
v_smfmac_f32_16x16x64_bf16 v[96:99], v[32:35], a[0:7], v6
v_smfmac_f32_16x16x64_bf16 v[100:103], v[32:35], a[32:39], v6
v_smfmac_f32_16x16x64_bf16 v[104:107], v[32:35], a[64:71], v6
v_smfmac_f32_16x16x64_bf16 v[108:111], v[32:35], a[96:103], v6
s_branch mega_kernel_rf_pa_14_1
mega_kernel_rf_pa_15_1f:
s_mov_b64 exec, vcc
buffer_load_dwordx4 v[36:39], v7, s[84:87], s33 offen offset:1024 sc1
s_mov_b64 exec, -1
s_branch mega_kernel_rf_pa_15_2
mega_kernel_rf_pa_15_1:
s_waitcnt vmcnt(3)
v_max_u32 v4, v36, v38
v_cmp_eq_u32 vcc, -1, v4
s_cbranch_vccnz mega_kernel_rf_pa_15_1f
v_smfmac_f32_16x16x64_bf16 v[96:99], v[36:39], a[8:15], v6
v_smfmac_f32_16x16x64_bf16 v[100:103], v[36:39], a[40:47], v6
v_smfmac_f32_16x16x64_bf16 v[104:107], v[36:39], a[72:79], v6
v_smfmac_f32_16x16x64_bf16 v[108:111], v[36:39], a[104:111], v6
s_branch mega_kernel_rf_pa_13_2
mega_kernel_rf_pa_15_2f:
s_mov_b64 exec, vcc
buffer_load_dwordx4 v[40:43], v7, s[84:87], s33 offen offset:2048 sc1
s_mov_b64 exec, -1
s_branch mega_kernel_rf_pa_15_3
mega_kernel_rf_pa_15_2:
s_waitcnt vmcnt(3)
v_max_u32 v4, v40, v42
v_cmp_eq_u32 vcc, -1, v4
s_cbranch_vccnz mega_kernel_rf_pa_15_2f
v_smfmac_f32_16x16x64_bf16 v[96:99], v[40:43], a[16:23], v6
v_smfmac_f32_16x16x64_bf16 v[100:103], v[40:43], a[48:55], v6
v_smfmac_f32_16x16x64_bf16 v[104:107], v[40:43], a[80:87], v6
v_smfmac_f32_16x16x64_bf16 v[108:111], v[40:43], a[112:119], v6
s_branch mega_kernel_rf_pa_11_3
mega_kernel_rf_pa_15_3f:
s_mov_b64 exec, vcc
buffer_load_dwordx4 v[44:47], v7, s[84:87], s33 offen offset:3072 sc1
s_mov_b64 exec, -1
s_branch mega_kernel_rf_pa_15_0
mega_kernel_rf_pa_15_3:
s_waitcnt vmcnt(3)
v_max_u32 v4, v44, v46
v_cmp_eq_u32 vcc, -1, v4
s_cbranch_vccnz mega_kernel_rf_pa_15_3f
v_smfmac_f32_16x16x64_bf16 v[96:99], v[44:47], a[24:31], v6
v_smfmac_f32_16x16x64_bf16 v[100:103], v[44:47], a[56:63], v6
v_smfmac_f32_16x16x64_bf16 v[104:107], v[44:47], a[88:95], v6
v_smfmac_f32_16x16x64_bf16 v[108:111], v[44:47], a[120:127], v6
s_branch mega_kernel_rf_pa_7_0
mega_kernel_rf_pc_1_0f:
s_mov_b64 exec, vcc
buffer_load_dwordx4 v[32:35], v7, s[84:87], s29 offen offset:0 sc1
s_mov_b64 exec, -1
s_branch mega_kernel_rf_pc_1_0
mega_kernel_rf_pc_1_0:
s_waitcnt vmcnt(0)
v_cmp_eq_u32 vcc, -1, v32
s_cbranch_vccnz mega_kernel_rf_pc_1_0f
v_smfmac_f32_16x16x64_bf16 v[96:99], v[32:35], a[192:199], v6
v_smfmac_f32_16x16x64_bf16 v[100:103], v[32:35], a[224:231], v6
s_branch mega_kernel_rf_pc_d
mega_kernel_rf_pc_2_1f:
s_mov_b64 exec, vcc
buffer_load_dwordx4 v[36:39], v7, s[84:87], s29 offen offset:1024 sc1
s_mov_b64 exec, -1
s_branch mega_kernel_rf_pc_2_1
mega_kernel_rf_pc_2_1:
s_waitcnt vmcnt(0)
v_cmp_eq_u32 vcc, -1, v36
s_cbranch_vccnz mega_kernel_rf_pc_2_1f
v_smfmac_f32_16x16x64_bf16 v[96:99], v[36:39], a[200:207], v6
v_smfmac_f32_16x16x64_bf16 v[100:103], v[36:39], a[232:239], v6
s_branch mega_kernel_rf_pc_d
mega_kernel_rf_pc_3_0f:
s_mov_b64 exec, vcc
buffer_load_dwordx4 v[32:35], v7, s[84:87], s29 offen offset:0 sc1
s_mov_b64 exec, -1
s_branch mega_kernel_rf_pc_3_1
mega_kernel_rf_pc_3_0:
s_waitcnt vmcnt(1)
v_cmp_eq_u32 vcc, -1, v32
s_cbranch_vccnz mega_kernel_rf_pc_3_0f
v_smfmac_f32_16x16x64_bf16 v[96:99], v[32:35], a[192:199], v6
v_smfmac_f32_16x16x64_bf16 v[100:103], v[32:35], a[224:231], v6
s_branch mega_kernel_rf_pc_2_1
mega_kernel_rf_pc_3_1f:
s_mov_b64 exec, vcc
buffer_load_dwordx4 v[36:39], v7, s[84:87], s29 offen offset:1024 sc1
s_mov_b64 exec, -1
s_branch mega_kernel_rf_pc_3_0
mega_kernel_rf_pc_3_1:
s_waitcnt vmcnt(1)
v_cmp_eq_u32 vcc, -1, v36
s_cbranch_vccnz mega_kernel_rf_pc_3_1f
v_smfmac_f32_16x16x64_bf16 v[96:99], v[36:39], a[200:207], v6
v_smfmac_f32_16x16x64_bf16 v[100:103], v[36:39], a[232:239], v6
s_branch mega_kernel_rf_pc_1_0
mega_kernel_rf_pc_4_2f:
s_mov_b64 exec, vcc
buffer_load_dwordx4 v[40:43], v7, s[84:87], s29 offen offset:2048 sc1
s_mov_b64 exec, -1
s_branch mega_kernel_rf_pc_4_2
mega_kernel_rf_pc_4_2:
s_waitcnt vmcnt(0)
v_cmp_eq_u32 vcc, -1, v40
s_cbranch_vccnz mega_kernel_rf_pc_4_2f
v_smfmac_f32_16x16x64_bf16 v[96:99], v[40:43], a[208:215], v6
v_smfmac_f32_16x16x64_bf16 v[100:103], v[40:43], a[240:247], v6
s_branch mega_kernel_rf_pc_d
mega_kernel_rf_pc_5_0f:
s_mov_b64 exec, vcc
buffer_load_dwordx4 v[32:35], v7, s[84:87], s29 offen offset:0 sc1
s_mov_b64 exec, -1
s_branch mega_kernel_rf_pc_5_2
mega_kernel_rf_pc_5_0:
s_waitcnt vmcnt(1)
v_cmp_eq_u32 vcc, -1, v32
s_cbranch_vccnz mega_kernel_rf_pc_5_0f
v_smfmac_f32_16x16x64_bf16 v[96:99], v[32:35], a[192:199], v6
v_smfmac_f32_16x16x64_bf16 v[100:103], v[32:35], a[224:231], v6
s_branch mega_kernel_rf_pc_4_2
mega_kernel_rf_pc_5_2f:
s_mov_b64 exec, vcc
buffer_load_dwordx4 v[40:43], v7, s[84:87], s29 offen offset:2048 sc1
s_mov_b64 exec, -1
s_branch mega_kernel_rf_pc_5_0
mega_kernel_rf_pc_5_2:
s_waitcnt vmcnt(1)
v_cmp_eq_u32 vcc, -1, v40
s_cbranch_vccnz mega_kernel_rf_pc_5_2f
v_smfmac_f32_16x16x64_bf16 v[96:99], v[40:43], a[208:215], v6
v_smfmac_f32_16x16x64_bf16 v[100:103], v[40:43], a[240:247], v6
s_branch mega_kernel_rf_pc_1_0
mega_kernel_rf_pc_6_1f:
s_mov_b64 exec, vcc
buffer_load_dwordx4 v[36:39], v7, s[84:87], s29 offen offset:1024 sc1
s_mov_b64 exec, -1
s_branch mega_kernel_rf_pc_6_2
mega_kernel_rf_pc_6_1:
s_waitcnt vmcnt(1)
v_cmp_eq_u32 vcc, -1, v36
s_cbranch_vccnz mega_kernel_rf_pc_6_1f
v_smfmac_f32_16x16x64_bf16 v[96:99], v[36:39], a[200:207], v6
v_smfmac_f32_16x16x64_bf16 v[100:103], v[36:39], a[232:239], v6
s_branch mega_kernel_rf_pc_4_2
mega_kernel_rf_pc_6_2f:
s_mov_b64 exec, vcc
buffer_load_dwordx4 v[40:43], v7, s[84:87], s29 offen offset:2048 sc1
s_mov_b64 exec, -1
s_branch mega_kernel_rf_pc_6_1
mega_kernel_rf_pc_6_2:
s_waitcnt vmcnt(1)
v_cmp_eq_u32 vcc, -1, v40
s_cbranch_vccnz mega_kernel_rf_pc_6_2f
v_smfmac_f32_16x16x64_bf16 v[96:99], v[40:43], a[208:215], v6
v_smfmac_f32_16x16x64_bf16 v[100:103], v[40:43], a[240:247], v6
s_branch mega_kernel_rf_pc_2_1
mega_kernel_rf_pc_7_0f:
s_mov_b64 exec, vcc
buffer_load_dwordx4 v[32:35], v7, s[84:87], s29 offen offset:0 sc1
s_mov_b64 exec, -1
s_branch mega_kernel_rf_pc_7_1
mega_kernel_rf_pc_7_0:
s_waitcnt vmcnt(2)
v_cmp_eq_u32 vcc, -1, v32
s_cbranch_vccnz mega_kernel_rf_pc_7_0f
v_smfmac_f32_16x16x64_bf16 v[96:99], v[32:35], a[192:199], v6
v_smfmac_f32_16x16x64_bf16 v[100:103], v[32:35], a[224:231], v6
s_branch mega_kernel_rf_pc_6_1
mega_kernel_rf_pc_7_1f:
s_mov_b64 exec, vcc
buffer_load_dwordx4 v[36:39], v7, s[84:87], s29 offen offset:1024 sc1
s_mov_b64 exec, -1
s_branch mega_kernel_rf_pc_7_2
mega_kernel_rf_pc_7_1:
s_waitcnt vmcnt(2)
v_cmp_eq_u32 vcc, -1, v36
s_cbranch_vccnz mega_kernel_rf_pc_7_1f
v_smfmac_f32_16x16x64_bf16 v[96:99], v[36:39], a[200:207], v6
v_smfmac_f32_16x16x64_bf16 v[100:103], v[36:39], a[232:239], v6
s_branch mega_kernel_rf_pc_5_2
mega_kernel_rf_pc_7_2f:
s_mov_b64 exec, vcc
buffer_load_dwordx4 v[40:43], v7, s[84:87], s29 offen offset:2048 sc1
s_mov_b64 exec, -1
s_branch mega_kernel_rf_pc_7_0
mega_kernel_rf_pc_7_2:
s_waitcnt vmcnt(2)
v_cmp_eq_u32 vcc, -1, v40
s_cbranch_vccnz mega_kernel_rf_pc_7_2f
v_smfmac_f32_16x16x64_bf16 v[96:99], v[40:43], a[208:215], v6
v_smfmac_f32_16x16x64_bf16 v[100:103], v[40:43], a[240:247], v6
s_branch mega_kernel_rf_pc_3_0
mega_kernel_rf_pc_8_3f:
s_mov_b64 exec, vcc
buffer_load_dwordx4 v[44:47], v7, s[84:87], s29 offen offset:3072 sc1
s_mov_b64 exec, -1
s_branch mega_kernel_rf_pc_8_3
mega_kernel_rf_pc_9_0f:
s_mov_b64 exec, vcc
buffer_load_dwordx4 v[32:35], v7, s[84:87], s29 offen offset:0 sc1
s_mov_b64 exec, -1
s_branch mega_kernel_rf_pc_9_3
mega_kernel_rf_pc_9_0:
s_waitcnt vmcnt(1)
v_cmp_eq_u32 vcc, -1, v32
s_cbranch_vccnz mega_kernel_rf_pc_9_0f
v_smfmac_f32_16x16x64_bf16 v[96:99], v[32:35], a[192:199], v6
v_smfmac_f32_16x16x64_bf16 v[100:103], v[32:35], a[224:231], v6
s_branch mega_kernel_rf_pc_8_3
mega_kernel_rf_pc_9_3f:
s_mov_b64 exec, vcc
buffer_load_dwordx4 v[44:47], v7, s[84:87], s29 offen offset:3072 sc1
s_mov_b64 exec, -1
s_branch mega_kernel_rf_pc_9_0
mega_kernel_rf_pc_9_3:
s_waitcnt vmcnt(1)
v_cmp_eq_u32 vcc, -1, v44
s_cbranch_vccnz mega_kernel_rf_pc_9_3f
v_smfmac_f32_16x16x64_bf16 v[96:99], v[44:47], a[216:223], v6
v_smfmac_f32_16x16x64_bf16 v[100:103], v[44:47], a[248:255], v6
s_branch mega_kernel_rf_pc_1_0
mega_kernel_rf_pc_10_1f:
s_mov_b64 exec, vcc
buffer_load_dwordx4 v[36:39], v7, s[84:87], s29 offen offset:1024 sc1
s_mov_b64 exec, -1
s_branch mega_kernel_rf_pc_10_3
mega_kernel_rf_pc_10_1:
s_waitcnt vmcnt(1)
v_cmp_eq_u32 vcc, -1, v36
s_cbranch_vccnz mega_kernel_rf_pc_10_1f
v_smfmac_f32_16x16x64_bf16 v[96:99], v[36:39], a[200:207], v6
v_smfmac_f32_16x16x64_bf16 v[100:103], v[36:39], a[232:239], v6
s_branch mega_kernel_rf_pc_8_3
mega_kernel_rf_pc_10_3f:
s_mov_b64 exec, vcc
buffer_load_dwordx4 v[44:47], v7, s[84:87], s29 offen offset:3072 sc1
s_mov_b64 exec, -1
s_branch mega_kernel_rf_pc_10_1
mega_kernel_rf_pc_10_3:
s_waitcnt vmcnt(1)
v_cmp_eq_u32 vcc, -1, v44
s_cbranch_vccnz mega_kernel_rf_pc_10_3f
v_smfmac_f32_16x16x64_bf16 v[96:99], v[44:47], a[216:223], v6
v_smfmac_f32_16x16x64_bf16 v[100:103], v[44:47], a[248:255], v6
s_branch mega_kernel_rf_pc_2_1
mega_kernel_rf_pc_11_0f:
s_mov_b64 exec, vcc
buffer_load_dwordx4 v[32:35], v7, s[84:87], s29 offen offset:0 sc1
s_mov_b64 exec, -1
s_branch mega_kernel_rf_pc_11_1
mega_kernel_rf_pc_11_0:
s_waitcnt vmcnt(2)
v_cmp_eq_u32 vcc, -1, v32
s_cbranch_vccnz mega_kernel_rf_pc_11_0f
v_smfmac_f32_16x16x64_bf16 v[96:99], v[32:35], a[192:199], v6
v_smfmac_f32_16x16x64_bf16 v[100:103], v[32:35], a[224:231], v6
s_branch mega_kernel_rf_pc_10_1
mega_kernel_rf_pc_11_1f:
s_mov_b64 exec, vcc
buffer_load_dwordx4 v[36:39], v7, s[84:87], s29 offen offset:1024 sc1
s_mov_b64 exec, -1
s_branch mega_kernel_rf_pc_11_3
mega_kernel_rf_pc_11_1:
s_waitcnt vmcnt(2)
v_cmp_eq_u32 vcc, -1, v36
s_cbranch_vccnz mega_kernel_rf_pc_11_1f
v_smfmac_f32_16x16x64_bf16 v[96:99], v[36:39], a[200:207], v6
v_smfmac_f32_16x16x64_bf16 v[100:103], v[36:39], a[232:239], v6
s_branch mega_kernel_rf_pc_9_3
mega_kernel_rf_pc_11_3f:
s_mov_b64 exec, vcc
buffer_load_dwordx4 v[44:47], v7, s[84:87], s29 offen offset:3072 sc1
s_mov_b64 exec, -1
s_branch mega_kernel_rf_pc_11_0
mega_kernel_rf_pc_11_3:
s_waitcnt vmcnt(2)
v_cmp_eq_u32 vcc, -1, v44
s_cbranch_vccnz mega_kernel_rf_pc_11_3f
v_smfmac_f32_16x16x64_bf16 v[96:99], v[44:47], a[216:223], v6
v_smfmac_f32_16x16x64_bf16 v[100:103], v[44:47], a[248:255], v6
s_branch mega_kernel_rf_pc_3_0
mega_kernel_rf_pc_12_2f:
s_mov_b64 exec, vcc
buffer_load_dwordx4 v[40:43], v7, s[84:87], s29 offen offset:2048 sc1
s_mov_b64 exec, -1
s_branch mega_kernel_rf_pc_12_3
mega_kernel_rf_pc_12_3f:
s_mov_b64 exec, vcc
buffer_load_dwordx4 v[44:47], v7, s[84:87], s29 offen offset:3072 sc1
s_mov_b64 exec, -1
s_branch mega_kernel_rf_pc_12_2
mega_kernel_rf_pc_12_3:
s_waitcnt vmcnt(1)
v_cmp_eq_u32 vcc, -1, v44
s_cbranch_vccnz mega_kernel_rf_pc_12_3f
v_smfmac_f32_16x16x64_bf16 v[96:99], v[44:47], a[216:223], v6
v_smfmac_f32_16x16x64_bf16 v[100:103], v[44:47], a[248:255], v6
s_branch mega_kernel_rf_pc_4_2
mega_kernel_rf_pc_13_0f:
s_mov_b64 exec, vcc
buffer_load_dwordx4 v[32:35], v7, s[84:87], s29 offen offset:0 sc1
s_mov_b64 exec, -1
s_branch mega_kernel_rf_pc_13_2
mega_kernel_rf_pc_13_0:
s_waitcnt vmcnt(2)
v_cmp_eq_u32 vcc, -1, v32
s_cbranch_vccnz mega_kernel_rf_pc_13_0f
v_smfmac_f32_16x16x64_bf16 v[96:99], v[32:35], a[192:199], v6
v_smfmac_f32_16x16x64_bf16 v[100:103], v[32:35], a[224:231], v6
s_branch mega_kernel_rf_pc_12_2
mega_kernel_rf_pc_13_2f:
s_mov_b64 exec, vcc
buffer_load_dwordx4 v[40:43], v7, s[84:87], s29 offen offset:2048 sc1
s_mov_b64 exec, -1
s_branch mega_kernel_rf_pc_13_3
mega_kernel_rf_pc_13_2:
s_waitcnt vmcnt(2)
v_cmp_eq_u32 vcc, -1, v40
s_cbranch_vccnz mega_kernel_rf_pc_13_2f
v_smfmac_f32_16x16x64_bf16 v[96:99], v[40:43], a[208:215], v6
v_smfmac_f32_16x16x64_bf16 v[100:103], v[40:43], a[240:247], v6
s_branch mega_kernel_rf_pc_9_3
mega_kernel_rf_pc_13_3f:
s_mov_b64 exec, vcc
buffer_load_dwordx4 v[44:47], v7, s[84:87], s29 offen offset:3072 sc1
s_mov_b64 exec, -1
s_branch mega_kernel_rf_pc_13_0
mega_kernel_rf_pc_13_3:
s_waitcnt vmcnt(2)
v_cmp_eq_u32 vcc, -1, v44
s_cbranch_vccnz mega_kernel_rf_pc_13_3f
v_smfmac_f32_16x16x64_bf16 v[96:99], v[44:47], a[216:223], v6
v_smfmac_f32_16x16x64_bf16 v[100:103], v[44:47], a[248:255], v6
s_branch mega_kernel_rf_pc_5_0
mega_kernel_rf_pc_14_1f:
s_mov_b64 exec, vcc
buffer_load_dwordx4 v[36:39], v7, s[84:87], s29 offen offset:1024 sc1
s_mov_b64 exec, -1
s_branch mega_kernel_rf_pc_14_2
mega_kernel_rf_pc_14_2f:
s_mov_b64 exec, vcc
buffer_load_dwordx4 v[40:43], v7, s[84:87], s29 offen offset:2048 sc1
s_mov_b64 exec, -1
s_branch mega_kernel_rf_pc_14_3
mega_kernel_rf_pc_14_2:
s_waitcnt vmcnt(2)
v_cmp_eq_u32 vcc, -1, v40
s_cbranch_vccnz mega_kernel_rf_pc_14_2f
v_smfmac_f32_16x16x64_bf16 v[96:99], v[40:43], a[208:215], v6
v_smfmac_f32_16x16x64_bf16 v[100:103], v[40:43], a[240:247], v6
s_branch mega_kernel_rf_pc_10_3
mega_kernel_rf_pc_14_3f:
s_mov_b64 exec, vcc
buffer_load_dwordx4 v[44:47], v7, s[84:87], s29 offen offset:3072 sc1
s_mov_b64 exec, -1
s_branch mega_kernel_rf_pc_14_1
mega_kernel_rf_pc_14_3:
s_waitcnt vmcnt(2)
v_cmp_eq_u32 vcc, -1, v44
s_cbranch_vccnz mega_kernel_rf_pc_14_3f
v_smfmac_f32_16x16x64_bf16 v[96:99], v[44:47], a[216:223], v6
v_smfmac_f32_16x16x64_bf16 v[100:103], v[44:47], a[248:255], v6
s_branch mega_kernel_rf_pc_6_1
mega_kernel_rf_pc_15_0f:
s_mov_b64 exec, vcc
buffer_load_dwordx4 v[32:35], v7, s[84:87], s29 offen offset:0 sc1
s_mov_b64 exec, -1
s_branch mega_kernel_rf_pc_15_1
mega_kernel_rf_pc_15_1f:
s_mov_b64 exec, vcc
buffer_load_dwordx4 v[36:39], v7, s[84:87], s29 offen offset:1024 sc1
s_mov_b64 exec, -1
s_branch mega_kernel_rf_pc_15_2
mega_kernel_rf_pc_15_1:
s_waitcnt vmcnt(3)
v_cmp_eq_u32 vcc, -1, v36
s_cbranch_vccnz mega_kernel_rf_pc_15_1f
v_smfmac_f32_16x16x64_bf16 v[96:99], v[36:39], a[200:207], v6
v_smfmac_f32_16x16x64_bf16 v[100:103], v[36:39], a[232:239], v6
s_branch mega_kernel_rf_pc_13_2
mega_kernel_rf_pc_15_2f:
s_mov_b64 exec, vcc
buffer_load_dwordx4 v[40:43], v7, s[84:87], s29 offen offset:2048 sc1
s_mov_b64 exec, -1
s_branch mega_kernel_rf_pc_15_3
mega_kernel_rf_pc_15_2:
s_waitcnt vmcnt(3)
v_cmp_eq_u32 vcc, -1, v40
s_cbranch_vccnz mega_kernel_rf_pc_15_2f
v_smfmac_f32_16x16x64_bf16 v[96:99], v[40:43], a[208:215], v6
v_smfmac_f32_16x16x64_bf16 v[100:103], v[40:43], a[240:247], v6
s_branch mega_kernel_rf_pc_11_3
mega_kernel_rf_pc_15_3f:
s_mov_b64 exec, vcc
buffer_load_dwordx4 v[44:47], v7, s[84:87], s29 offen offset:3072 sc1
s_mov_b64 exec, -1
s_branch mega_kernel_rf_pc_15_0
mega_kernel_rf_pc_15_3:
s_waitcnt vmcnt(3)
v_cmp_eq_u32 vcc, -1, v44
s_cbranch_vccnz mega_kernel_rf_pc_15_3f
v_smfmac_f32_16x16x64_bf16 v[96:99], v[44:47], a[216:223], v6
v_smfmac_f32_16x16x64_bf16 v[100:103], v[44:47], a[248:255], v6
s_branch mega_kernel_rf_pc_7_0
mega_kernel_rf_w0last:
s_nop 7
v_permlane32_swap_b32 v112, v116
v_permlane32_swap_b32 v113, v117
v_permlane32_swap_b32 v114, v118
v_permlane32_swap_b32 v115, v119
v_pk_add_f32 v[112:113], v[112:113], v[116:117]
v_pk_add_f32 v[114:115], v[114:115], v[118:119]
ds_write_b128 v20, v[112:115]
s_waitcnt lgkmcnt(0)
s_barrier
s_branch mega_kernel_rf_end
mega_kernel_rf_side:
s_cmp_eq_u32 s24, 3
s_cbranch_scc1 mega_kernel_rf_sd3
s_cmp_eq_u32 s24, 2
s_cbranch_scc0 mega_kernel_rf_sd4
s_mov_b64 exec, s[40:41]
buffer_store_dwordx4 v[28:31], v11, s[84:87], s34 offen
s_mov_b64 exec, -1
buffer_store_dwordx2 v[28:29], v9, s[84:87], s34 offen
s_mul_i32 s28, s31, 2048
s_add_u32 s28, s28, s34
s_add_u32 s28, s28, 49152
buffer_store_dwordx4 v[28:31], v17, s[84:87], s28 offen
buffer_store_dwordx4 v[28:31], v10, s[84:87], s28 offen
s_branch mega_kernel_rf_sd4
mega_kernel_rf_sd3:
v_readlane_b32 s76, v249, 0
v_readlane_b32 s77, v249, 1
s_min_i32 s76, s76, s77
s_max_i32 s46, s46, s76
s_mov_b32 s36, 0
s_add_u32 s76, s27, 1
s_cmp_lt_u32 s76, 63
s_cbranch_scc0 mega_kernel_rf_sd4
s_cmp_ge_u32 s76, 0
s_cbranch_scc0 mega_kernel_rf_sd4
s_cmp_gt_i32 s46, s76
s_cselect_b32 s36, 0, 1
s_cbranch_scc0 mega_kernel_rf_sd4
s_add_u32 s77, s76, s82
s_bfe_u32 s28, s77, 0x40002
s_lshl_b32 s28, s28, 14
s_and_b32 s77, s77, 3
s_lshl_b32 s77, s77, 11
s_add_u32 s28, s28, s77
s_add_u32 m0, s45, 0
s_nop 0
buffer_load_dwordx4 v240, s[84:87], s28 offen offset:0 sc1 lds
s_add_u32 m0, s45, 0
s_nop 0
buffer_load_dwordx4 v240, s[84:87], s28 offen offset:1024 sc1 lds
s_add_u32 m0, s45, 2048
s_nop 0
buffer_load_dwordx4 v241, s[84:87], s28 offen offset:0 sc1 lds
s_add_u32 m0, s45, 2048
s_nop 0
buffer_load_dwordx4 v241, s[84:87], s28 offen offset:1024 sc1 lds
s_add_u32 s45, s45, 4096
s_cmp_eq_u32 s45, 30720
s_cselect_b32 s45, 18432, s45
mega_kernel_rf_sd4:
v_smfmac_f32_16x16x64_bf16 v[112:115], v[40:43], a[144:151], v6
v_smfmac_f32_16x16x64_bf16 v[116:119], v[40:43], a[176:183], v6
v_smfmac_f32_16x16x64_bf16 v[112:115], v[44:47], a[152:159], v6
v_smfmac_f32_16x16x64_bf16 v[116:119], v[44:47], a[184:191], v6
s_nop 7
v_permlane32_swap_b32 v112, v116
v_permlane32_swap_b32 v113, v117
v_permlane32_swap_b32 v114, v118
v_permlane32_swap_b32 v115, v119
v_pk_add_f32 v[112:113], v[112:113], v[116:117]
v_pk_add_f32 v[114:115], v[114:115], v[118:119]
ds_write_b128 v20, v[112:115]
v_mov_b32 v96, 0
v_mov_b32 v97, 0
v_mov_b32 v98, 0
v_mov_b32 v99, 0
v_mov_b32 v100, 0
v_mov_b32 v101, 0
v_mov_b32 v102, 0
v_mov_b32 v103, 0
s_cmp_eq_u32 s24, 1
s_cbranch_scc0 mega_kernel_rf_s1
s_waitcnt lgkmcnt(0)
ds_read_b128 v[120:123], v16 offset:0
ds_read_b128 v[124:127], v16 offset:16
ds_read_b128 v[128:131], v16 offset:2304
ds_read_b128 v[132:135], v16 offset:2320
ds_read_b128 v[136:139], v16 offset:4608
ds_read_b128 v[140:143], v16 offset:4624
ds_read_b128 v[144:147], v16 offset:6912
ds_read_b128 v[148:151], v16 offset:6928
s_waitcnt lgkmcnt(4)
v_pk_add_f32 v[120:121], v[120:121], v[128:129]
v_pk_add_f32 v[122:123], v[122:123], v[130:131]
v_pk_add_f32 v[124:125], v[124:125], v[132:133]
v_pk_add_f32 v[126:127], v[126:127], v[134:135]
s_waitcnt lgkmcnt(0)
v_pk_add_f32 v[136:137], v[136:137], v[144:145]
v_pk_add_f32 v[138:139], v[138:139], v[146:147]
v_pk_add_f32 v[140:141], v[140:141], v[148:149]
v_pk_add_f32 v[142:143], v[142:143], v[150:151]
v_pk_add_f32 v[120:121], v[120:121], v[136:137]
v_pk_add_f32 v[122:123], v[122:123], v[138:139]
v_pk_add_f32 v[124:125], v[124:125], v[140:141]
v_pk_add_f32 v[126:127], v[126:127], v[142:143]
v_cvt_pk_bf16_f32 v244, v120, v121
v_cvt_pk_bf16_f32 v245, v122, v123
v_cvt_pk_bf16_f32 v246, v124, v125
v_cvt_pk_bf16_f32 v247, v126, v127
mega_kernel_rf_s1:
v_add_u32 v5, 9216, v17
s_waitcnt lgkmcnt(0)
s_barrier
s_cmp_eq_u32 s24, 2
s_cbranch_scc1 mega_kernel_rf_s2
s_cmp_eq_u32 s24, 3
s_cbranch_scc0 mega_kernel_rf_s3
s_add_u32 s76, s27, 2
s_cmp_lt_u32 s76, 63
s_cbranch_scc0 mega_kernel_rf_s3
s_cmp_gt_i32 s46, s76
s_cbranch_scc0 mega_kernel_rf_s3
s_add_u32 s77, s76, s82
s_bfe_u32 s28, s77, 0x40002
s_lshl_b32 s28, s28, 14
s_and_b32 s77, s77, 3
s_lshl_b32 s77, s77, 11
s_add_u32 s28, s28, s77
s_add_u32 s28, s28, s83
s_buffer_load_dword s78, s[84:87], s28 offset:0
s_buffer_load_dword s78, s[84:87], s28 offset:128
s_buffer_load_dword s78, s[84:87], s28 offset:256
s_buffer_load_dword s78, s[84:87], s28 offset:384
s_buffer_load_dword s78, s[84:87], s28 offset:512
s_buffer_load_dword s78, s[84:87], s28 offset:640
s_buffer_load_dword s78, s[84:87], s28 offset:768
s_buffer_load_dword s78, s[84:87], s28 offset:896
s_buffer_load_dword s78, s[84:87], s28 offset:1024
s_buffer_load_dword s78, s[84:87], s28 offset:1152
s_buffer_load_dword s78, s[84:87], s28 offset:1280
s_buffer_load_dword s78, s[84:87], s28 offset:1408
s_buffer_load_dword s78, s[84:87], s28 offset:1536
s_buffer_load_dword s78, s[84:87], s28 offset:1664
s_buffer_load_dword s78, s[84:87], s28 offset:1792
s_buffer_load_dword s78, s[84:87], s28 offset:1920
s_mov_b32 s88, s76
s_branch mega_kernel_rf_s3
mega_kernel_rf_s2:
ds_read_b128 v[120:123], v5 offset:0
ds_read_b128 v[124:127], v5 offset:1024
ds_read_b128 v[128:131], v5 offset:2048
ds_read_b128 v[132:135], v5 offset:3072
v_lshrrev_b32 v5, 1, v17
s_waitcnt lgkmcnt(2)
v_pk_add_f32 v[120:121], v[120:121], v[124:125]
v_pk_add_f32 v[122:123], v[122:123], v[126:127]
s_waitcnt lgkmcnt(0)
v_pk_add_f32 v[128:129], v[128:129], v[132:133]
v_pk_add_f32 v[130:131], v[130:131], v[134:135]
v_pk_add_f32 v[120:121], v[120:121], v[128:129]
v_pk_add_f32 v[122:123], v[122:123], v[130:131]
v_cvt_pk_bf16_f32 v244, v120, v121
v_cvt_pk_bf16_f32 v245, v122, v123
ds_write_b64 v5, v[244:245] offset:17920
s_waitcnt lgkmcnt(0) vmcnt(0)
mega_kernel_rf_s3:
s_cmp_eq_u32 s27, 63
s_cbranch_scc1 mega_kernel_rf_slast
s_add_u32 s29, s33, 24576
s_barrier
s_cmp_eq_u32 s24, 3
s_cbranch_scc1 mega_kernel_rf_y3
s_add_u32 s77, s27, s82
s_bfe_u32 s28, s77, 0x30003
s_lshl_b32 s28, s28, 14
s_and_b32 s77, s77, 7
s_lshl_b32 s77, s77, 10
s_add_u32 s28, s28, s77
s_add_u32 s28, s28, s79
s_cmp_eq_u32 s24, 2
s_cbranch_scc1 mega_kernel_rf_kv2a
s_mov_b64 exec, s[48:49]
buffer_store_dwordx4 v[244:247], v22, s[84:87], s28 offen sc1
s_mov_b64 exec, -1
s_branch mega_kernel_rf_kvda
mega_kernel_rf_kv2a:
v_lshlrev_b32 v4, 3, v1
buffer_store_dwordx2 v[244:245], v4, s[84:87], s28 offen offset:512 sc1
mega_kernel_rf_kvda:
s_branch mega_kernel_rf_y4
mega_kernel_rf_y3:
s_add_u32 s76, s27, 2
s_cmp_lt_u32 s76, 63
s_cbranch_scc0 mega_kernel_rf_y4
mega_kernel_rf_y4:
s_branch mega_kernel_rf_b3
mega_kernel_rf_first:
buffer_load_dwordx4 v[32:35], v8, s[20:23], 0 offen offset:0
buffer_load_dwordx4 v[36:39], v8, s[20:23], 0 offen offset:128
buffer_load_dwordx4 v[40:43], v8, s[20:23], 0 offen offset:256
buffer_load_dwordx4 v[44:47], v8, s[20:23], 0 offen offset:384
v_add_u32 v5, s44, v17
ds_read_b128 v[156:159], v5 offset:0
ds_read_b128 v[160:163], v5 offset:1024
ds_read_b128 v[164:167], v5 offset:2048
ds_read_b128 v[168:171], v5 offset:3072
s_waitcnt vmcnt(0)
v_smfmac_f32_16x16x64_bf16 v[96:99], v[32:35], a[0:7], v6
v_smfmac_f32_16x16x64_bf16 v[100:103], v[32:35], a[32:39], v6
v_smfmac_f32_16x16x64_bf16 v[104:107], v[32:35], a[64:71], v6
v_smfmac_f32_16x16x64_bf16 v[108:111], v[32:35], a[96:103], v6
v_smfmac_f32_16x16x64_bf16 v[96:99], v[36:39], a[8:15], v6
v_smfmac_f32_16x16x64_bf16 v[100:103], v[36:39], a[40:47], v6
v_smfmac_f32_16x16x64_bf16 v[104:107], v[36:39], a[72:79], v6
v_smfmac_f32_16x16x64_bf16 v[108:111], v[36:39], a[104:111], v6
v_smfmac_f32_16x16x64_bf16 v[96:99], v[40:43], a[16:23], v6
v_smfmac_f32_16x16x64_bf16 v[100:103], v[40:43], a[48:55], v6
v_smfmac_f32_16x16x64_bf16 v[104:107], v[40:43], a[80:87], v6
v_smfmac_f32_16x16x64_bf16 v[108:111], v[40:43], a[112:119], v6
v_smfmac_f32_16x16x64_bf16 v[96:99], v[44:47], a[24:31], v6
v_smfmac_f32_16x16x64_bf16 v[100:103], v[44:47], a[56:63], v6
v_smfmac_f32_16x16x64_bf16 v[104:107], v[44:47], a[88:95], v6
v_smfmac_f32_16x16x64_bf16 v[108:111], v[44:47], a[120:127], v6
s_nop 1
s_branch mega_kernel_rf_adone
mega_kernel_rf_slast:
s_cmp_eq_u32 s24, 3
s_cbranch_scc1 mega_kernel_rf_end
s_add_u32 s77, s27, s82
s_bfe_u32 s28, s77, 0x30003
s_lshl_b32 s28, s28, 14
s_and_b32 s77, s77, 7
s_lshl_b32 s77, s77, 10
s_add_u32 s28, s28, s77
s_add_u32 s28, s28, s79
s_cmp_eq_u32 s24, 2
s_cbranch_scc1 mega_kernel_rf_kv2b
s_mov_b64 exec, s[48:49]
buffer_store_dwordx4 v[244:247], v22, s[84:87], s28 offen sc1
s_mov_b64 exec, -1
s_branch mega_kernel_rf_kvdb
mega_kernel_rf_kv2b:
v_lshlrev_b32 v4, 3, v1
buffer_store_dwordx2 v[244:245], v4, s[84:87], s28 offen offset:512 sc1
mega_kernel_rf_kvdb:
s_waitcnt vmcnt(0)
s_barrier
s_mov_b32 s76, 64
s_cmp_eq_u32 s24, 1
s_cbranch_scc0 mega_kernel_rf_end
v_mov_b32 v5, s76
s_mov_b64 exec, 1
buffer_store_dword v5, v228, s[84:87], s81 offen sc1
s_mov_b64 exec, -1
mega_kernel_rf_end:
s_endpgm
mega_kernel_recs:
s_load_dwordx2 s[20:21], s[0:1], 8
s_load_dwordx2 s[16:17], s[0:1], 40
s_load_dwordx2 s[4:5], s[0:1], 16
s_load_dwordx2 s[8:9], s[0:1], 24
s_load_dwordx2 s[12:13], s[0:1], 32
v_lshrrev_b32 v4, 6, v0
v_and_b32 v1, 63, v0
v_readfirstlane_b32 s24, v4
v_lshrrev_b32 v2, 4, v1
v_and_b32 v3, 15, v1
v_lshlrev_b32 v17, 4, v1
s_lshr_b32 s28, s31, 2
s_lshl_b32 s25, s30, 3
s_add_u32 s25, s25, s28
s_and_b32 s26, s31, 3
s_waitcnt lgkmcnt(0)
s_mov_b32 s22, 16384
s_mov_b32 s23, 0x00020000
s_mov_b32 s18, 8388608
s_mov_b32 s19, 0x00020000
s_mov_b32 s6, 8388608
s_mov_b32 s7, 0x00020000
s_mov_b32 s10, 8388608
s_mov_b32 s11, 0x00020000
s_mov_b32 s14, 8388608
s_mov_b32 s15, 0x00020000
s_lshl_b32 s28, s25, 8
s_lshr_b32 s29, s26, 0
s_lshl_b32 s29, s29, 6
s_add_u32 s28, s28, s29
s_lshl_b32 s29, s24, 21
s_add_u32 s28, s28, s29
v_lshrrev_b32 v4, 2, v1
v_and_b32 v5, 3, v1
v_lshlrev_b32 v40, 13, v4
v_lshl_add_u32 v40, v5, 4, v40
v_add_u32 v40, s28, v40
s_lshl_b32 s28, s30, 21
s_lshl_b32 s29, s24, 19
s_add_u32 s28, s28, s29
s_lshr_b32 s29, s31, 0
s_lshl_b32 s29, s29, 6
s_add_u32 s28, s28, s29
v_lshlrev_b32 v41, 11, v4
v_lshl_add_u32 v41, v5, 4, v41
v_add_u32 v41, s28, v41
s_lshl_b32 s47, s24, 15
s_add_u32 s47, s47, 32768
s_lshl_b32 s28, s31, 18
s_lshl_b32 s29, s24, 16
s_add_u32 s28, s28, s29
s_lshl_b32 s29, s30, 11
s_add_u32 s28, s28, s29
v_lshlrev_b32 v48, 13, v2
v_lshl_add_u32 v48, v3, 7, v48
v_add_u32 v48, s28, v48
s_lshl_b32 s28, s30, 21
s_lshl_b32 s29, s31, 16
s_add_u32 s28, s28, s29
s_lshl_b32 s29, s24, 14
s_add_u32 s28, s28, s29
v_lshlrev_b32 v49, 7, v1
v_add_u32 v49, s28, v49
s_and_b32 s76, s31, 1
s_mul_i32 s76, s76, 8
s_and_b32 s28, s31, 15
s_lshl_b32 s28, s28, 4
s_lshl_b32 s29, s24, 8
s_add_u32 s28, s28, s29
v_add_u32 v53, s28, v3
s_lshr_b32 s28, s31, 4
s_lshl_b32 s28, s28, 10
s_add_u32 s28, s28, 384
v_mov_b32 v54, s28
v_mov_b32 v55, 1920
v_cmp_gt_u32 vcc, 32, v1
s_nop 1
v_cndmask_b32 v54, v55, v54, vcc
s_lshl_b32 s29, s30, 11
v_lshl_add_u32 v51, v53, 13, v54
v_add_u32 v51, s29, v51
s_lshl_b32 s29, s30, 21
v_lshl_add_u32 v52, v53, 11, v54
v_add_u32 v52, s29, v52
buffer_load_dword v50, v51, s[8:11], 0 offen
s_xor_b32 s29, s76, 0
s_lshl_b32 s28, s29, 10
s_add_u32 s28, s28, s47
s_add_u32 m0, s28, 0
s_lshl_b32 s29, s29, 17
buffer_load_dwordx4 v40, s[8:11], s29 offen lds
s_xor_b32 s29, s76, 1
s_lshl_b32 s28, s29, 10
s_add_u32 s28, s28, s47
s_add_u32 m0, s28, 0
s_lshl_b32 s29, s29, 17
buffer_load_dwordx4 v40, s[8:11], s29 offen lds
s_xor_b32 s29, s76, 2
s_lshl_b32 s28, s29, 10
s_add_u32 s28, s28, s47
s_add_u32 m0, s28, 0
s_lshl_b32 s29, s29, 17
buffer_load_dwordx4 v40, s[8:11], s29 offen lds
s_xor_b32 s29, s76, 3
s_lshl_b32 s28, s29, 10
s_add_u32 s28, s28, s47
s_add_u32 m0, s28, 0
s_lshl_b32 s29, s29, 17
buffer_load_dwordx4 v40, s[8:11], s29 offen lds
s_xor_b32 s29, s76, 4
s_lshl_b32 s28, s29, 10
s_add_u32 s28, s28, s47
s_add_u32 m0, s28, 0
s_lshl_b32 s29, s29, 17
buffer_load_dwordx4 v40, s[8:11], s29 offen lds
s_xor_b32 s29, s76, 5
s_lshl_b32 s28, s29, 10
s_add_u32 s28, s28, s47
s_add_u32 m0, s28, 0
s_lshl_b32 s29, s29, 17
buffer_load_dwordx4 v40, s[8:11], s29 offen lds
s_xor_b32 s29, s76, 6
s_lshl_b32 s28, s29, 10
s_add_u32 s28, s28, s47
s_add_u32 m0, s28, 0
s_lshl_b32 s29, s29, 17
buffer_load_dwordx4 v40, s[8:11], s29 offen lds
s_xor_b32 s29, s76, 7
s_lshl_b32 s28, s29, 10
s_add_u32 s28, s28, s47
s_add_u32 m0, s28, 0
s_lshl_b32 s29, s29, 17
buffer_load_dwordx4 v40, s[8:11], s29 offen lds
s_xor_b32 s29, s76, 8
s_lshl_b32 s28, s29, 10
s_add_u32 s28, s28, s47
s_add_u32 m0, s28, 0
s_lshl_b32 s29, s29, 17
buffer_load_dwordx4 v40, s[8:11], s29 offen lds
s_xor_b32 s29, s76, 9
s_lshl_b32 s28, s29, 10
s_add_u32 s28, s28, s47
s_add_u32 m0, s28, 0
s_lshl_b32 s29, s29, 17
buffer_load_dwordx4 v40, s[8:11], s29 offen lds
s_xor_b32 s29, s76, 10
s_lshl_b32 s28, s29, 10
s_add_u32 s28, s28, s47
s_add_u32 m0, s28, 0
s_lshl_b32 s29, s29, 17
buffer_load_dwordx4 v40, s[8:11], s29 offen lds
s_xor_b32 s29, s76, 11
s_lshl_b32 s28, s29, 10
s_add_u32 s28, s28, s47
s_add_u32 m0, s28, 0
s_lshl_b32 s29, s29, 17
buffer_load_dwordx4 v40, s[8:11], s29 offen lds
s_xor_b32 s29, s76, 12
s_lshl_b32 s28, s29, 10
s_add_u32 s28, s28, s47
s_add_u32 m0, s28, 0
s_lshl_b32 s29, s29, 17
buffer_load_dwordx4 v40, s[8:11], s29 offen lds
s_xor_b32 s29, s76, 13
s_lshl_b32 s28, s29, 10
s_add_u32 s28, s28, s47
s_add_u32 m0, s28, 0
s_lshl_b32 s29, s29, 17
buffer_load_dwordx4 v40, s[8:11], s29 offen lds
s_xor_b32 s29, s76, 14
s_lshl_b32 s28, s29, 10
s_add_u32 s28, s28, s47
s_add_u32 m0, s28, 0
s_lshl_b32 s29, s29, 17
buffer_load_dwordx4 v40, s[8:11], s29 offen lds
s_xor_b32 s29, s76, 15
s_lshl_b32 s28, s29, 10
s_add_u32 s28, s28, s47
s_add_u32 m0, s28, 0
s_lshl_b32 s29, s29, 17
buffer_load_dwordx4 v40, s[8:11], s29 offen lds
buffer_load_dword v50, v51, s[12:15], 0 offen
s_xor_b32 s29, s76, 0
s_lshl_b32 s28, s29, 10
s_add_u32 s28, s28, s47
s_add_u32 m0, s28, 16384
s_lshl_b32 s29, s29, 17
buffer_load_dwordx4 v40, s[12:15], s29 offen lds
s_xor_b32 s29, s76, 1
s_lshl_b32 s28, s29, 10
s_add_u32 s28, s28, s47
s_add_u32 m0, s28, 16384
s_lshl_b32 s29, s29, 17
buffer_load_dwordx4 v40, s[12:15], s29 offen lds
s_xor_b32 s29, s76, 2
s_lshl_b32 s28, s29, 10
s_add_u32 s28, s28, s47
s_add_u32 m0, s28, 16384
s_lshl_b32 s29, s29, 17
buffer_load_dwordx4 v40, s[12:15], s29 offen lds
s_xor_b32 s29, s76, 3
s_lshl_b32 s28, s29, 10
s_add_u32 s28, s28, s47
s_add_u32 m0, s28, 16384
s_lshl_b32 s29, s29, 17
buffer_load_dwordx4 v40, s[12:15], s29 offen lds
s_xor_b32 s29, s76, 4
s_lshl_b32 s28, s29, 10
s_add_u32 s28, s28, s47
s_add_u32 m0, s28, 16384
s_lshl_b32 s29, s29, 17
buffer_load_dwordx4 v40, s[12:15], s29 offen lds
s_xor_b32 s29, s76, 5
s_lshl_b32 s28, s29, 10
s_add_u32 s28, s28, s47
s_add_u32 m0, s28, 16384
s_lshl_b32 s29, s29, 17
buffer_load_dwordx4 v40, s[12:15], s29 offen lds
s_xor_b32 s29, s76, 6
s_lshl_b32 s28, s29, 10
s_add_u32 s28, s28, s47
s_add_u32 m0, s28, 16384
s_lshl_b32 s29, s29, 17
buffer_load_dwordx4 v40, s[12:15], s29 offen lds
s_xor_b32 s29, s76, 7
s_lshl_b32 s28, s29, 10
s_add_u32 s28, s28, s47
s_add_u32 m0, s28, 16384
s_lshl_b32 s29, s29, 17
buffer_load_dwordx4 v40, s[12:15], s29 offen lds
s_xor_b32 s29, s76, 8
s_lshl_b32 s28, s29, 10
s_add_u32 s28, s28, s47
s_add_u32 m0, s28, 16384
s_lshl_b32 s29, s29, 17
buffer_load_dwordx4 v40, s[12:15], s29 offen lds
s_xor_b32 s29, s76, 9
s_lshl_b32 s28, s29, 10
s_add_u32 s28, s28, s47
s_add_u32 m0, s28, 16384
s_lshl_b32 s29, s29, 17
buffer_load_dwordx4 v40, s[12:15], s29 offen lds
s_xor_b32 s29, s76, 10
s_lshl_b32 s28, s29, 10
s_add_u32 s28, s28, s47
s_add_u32 m0, s28, 16384
s_lshl_b32 s29, s29, 17
buffer_load_dwordx4 v40, s[12:15], s29 offen lds
s_xor_b32 s29, s76, 11
s_lshl_b32 s28, s29, 10
s_add_u32 s28, s28, s47
s_add_u32 m0, s28, 16384
s_lshl_b32 s29, s29, 17
buffer_load_dwordx4 v40, s[12:15], s29 offen lds
s_xor_b32 s29, s76, 12
s_lshl_b32 s28, s29, 10
s_add_u32 s28, s28, s47
s_add_u32 m0, s28, 16384
s_lshl_b32 s29, s29, 17
buffer_load_dwordx4 v40, s[12:15], s29 offen lds
s_xor_b32 s29, s76, 13
s_lshl_b32 s28, s29, 10
s_add_u32 s28, s28, s47
s_add_u32 m0, s28, 16384
s_lshl_b32 s29, s29, 17
buffer_load_dwordx4 v40, s[12:15], s29 offen lds
s_xor_b32 s29, s76, 14
s_lshl_b32 s28, s29, 10
s_add_u32 s28, s28, s47
s_add_u32 m0, s28, 16384
s_lshl_b32 s29, s29, 17
buffer_load_dwordx4 v40, s[12:15], s29 offen lds
s_xor_b32 s29, s76, 15
s_lshl_b32 s28, s29, 10
s_add_u32 s28, s28, s47
s_add_u32 m0, s28, 16384
s_lshl_b32 s29, s29, 17
buffer_load_dwordx4 v40, s[12:15], s29 offen lds
s_mov_b32 s40, 0x00ff00ff
s_mov_b32 s41, 0x00ff00ff
s_mov_b32 s48, 0xff00ff00
s_mov_b32 s49, 0xff00ff00
s_mov_b32 s42, 0
s_mov_b32 s43, 0x00ff00ff
s_mov_b32 s32, 0x3e0293ee
v_mov_b32 v23, 0xff800000
v_mov_b32 v6, 0x4444
v_mov_b32 v4, 0xeeee
v_cndmask_b32 v6, v6, v4, s[48:49]
v_mov_b32 v28, -1
v_mov_b32 v29, -1
v_mov_b32 v30, -1
v_mov_b32 v31, -1
s_mul_i32 s28, s24, 4096
v_add_u32 v7, s28, v17
v_and_b32 v4, 7, v1
v_lshlrev_b32 v8, 11, v4
v_lshrrev_b32 v5, 3, v1
v_lshl_add_u32 v8, v5, 4, v8
s_lshl_b32 s28, s24, 9
v_add_u32 v8, s28, v8
s_lshl_b32 s28, s31, 9
s_lshr_b32 s29, s31, 3
s_mul_i32 s29, s29, 0
s_add_u32 s28, s28, s29
v_lshlrev_b32 v9, 3, v1
v_add_u32 v9, s28, v9
v_and_b32 v4, 7, v3
v_lshlrev_b32 v11, 7, v2
v_lshl_add_u32 v11, v4, 4, v11
v_add_u32 v22, 0, v11
s_add_u32 s28, s28, 24576
v_add_u32 v11, s28, v11
v_and_b32 v5, 1, v2
v_lshlrev_b32 v10, 7, v5
v_lshl_add_u32 v10, v4, 4, v10
v_add_u32 v10, 1024, v10
s_xor_b32 s37, s31, 1
s_mul_i32 s37, s37, 2048
s_add_u32 s37, s37, 49152
s_xor_b32 s38, s31, 2
s_mul_i32 s38, s38, 2048
s_add_u32 s38, s38, 49152
s_xor_b32 s39, s31, 3
s_mul_i32 s39, s39, 2048
s_add_u32 s39, s39, 49152
v_and_b32 v4, 1, v2
v_mul_u32_u24 v14, 576, v4
v_lshrrev_b32 v5, 1, v2
v_lshl_add_u32 v5, v5, 4, v3
v_lshl_add_u32 v14, v5, 2, v14
s_mul_i32 s28, s24, 1152
s_add_u32 s28, s28, 13312
v_add_u32 v18, s28, v14
s_mul_i32 s28, s24, 2304
v_add_u32 v14, s28, v14
v_add_u32 v15, 1152, v14
v_mul_u32_u24 v16, 144, v3
v_lshl_add_u32 v16, v2, 5, v16
v_bfe_u32 v4, v1, 1, 3
v_mul_u32_u24 v19, 144, v4
v_lshl_add_u32 v19, v2, 5, v19
v_and_b32 v4, 1, v1
v_lshl_add_u32 v19, v4, 4, v19
v_add_u32 v19, 13312, v19
s_lshl_b32 s28, s24, 10
s_add_u32 s28, s28, 9216
v_add_u32 v20, s28, v17
v_and_b32 v4, 31, v1
v_lshlrev_b32 v21, 3, v4
v_add_u32 v21, 17920, v21
v_lshrrev_b32 v4, 2, v3
v_and_b32 v42, 1, v4
v_lshrrev_b32 v43, 1, v4
v_lshrrev_b32 v44, 1, v2
v_and_b32 v45, 1, v2
v_lshl_add_u32 v46, v44, 4, v42
v_lshl_add_u32 v46, v45, 2, v46
v_lshl_add_u32 v46, v43, 3, v46
v_lshl_add_u32 v47, v44, 3, v42
v_lshl_add_u32 v47, v45, 4, v47
v_lshl_add_u32 v47, v43, 2, v47
v_and_b32 v5, 3, v3
v_lshlrev_b32 v5, 3, v5
v_lshl_add_u32 v46, v46, 6, v5
v_lshl_add_u32 v47, v47, 6, v5
s_and_b32 s28, s31, 0
s_lshl_b32 s28, s28, 6
s_add_u32 s28, s28, s47
v_add_u32 v46, s28, v46
v_add_u32 v47, s28, v47
s_waitcnt vmcnt(17)
ds_read_b64_tr_b16 a[64:65], v46 offset:0
ds_read_b64_tr_b16 a[66:67], v46 offset:128
ds_read_b64_tr_b16 a[68:69], v46 offset:2048
ds_read_b64_tr_b16 a[70:71], v46 offset:2176
ds_read_b64_tr_b16 a[72:73], v46 offset:4096
ds_read_b64_tr_b16 a[74:75], v46 offset:4224
ds_read_b64_tr_b16 a[76:77], v46 offset:6144
ds_read_b64_tr_b16 a[78:79], v46 offset:6272
s_waitcnt lgkmcnt(0)
ds_read_b64_tr_b16 a[80:81], v46 offset:8192
ds_read_b64_tr_b16 a[82:83], v46 offset:8320
ds_read_b64_tr_b16 a[84:85], v46 offset:10240
ds_read_b64_tr_b16 a[86:87], v46 offset:10368
ds_read_b64_tr_b16 a[88:89], v46 offset:12288
ds_read_b64_tr_b16 a[90:91], v46 offset:12416
ds_read_b64_tr_b16 a[92:93], v46 offset:14336
ds_read_b64_tr_b16 a[94:95], v46 offset:14464
s_waitcnt lgkmcnt(0)
ds_read_b64_tr_b16 a[96:97], v46 offset:32
ds_read_b64_tr_b16 a[98:99], v46 offset:160
ds_read_b64_tr_b16 a[100:101], v46 offset:2080
ds_read_b64_tr_b16 a[102:103], v46 offset:2208
ds_read_b64_tr_b16 a[104:105], v46 offset:4128
ds_read_b64_tr_b16 a[106:107], v46 offset:4256
ds_read_b64_tr_b16 a[108:109], v46 offset:6176
ds_read_b64_tr_b16 a[110:111], v46 offset:6304
s_waitcnt lgkmcnt(0)
ds_read_b64_tr_b16 a[112:113], v46 offset:8224
ds_read_b64_tr_b16 a[114:115], v46 offset:8352
ds_read_b64_tr_b16 a[116:117], v46 offset:10272
ds_read_b64_tr_b16 a[118:119], v46 offset:10400
ds_read_b64_tr_b16 a[120:121], v46 offset:12320
ds_read_b64_tr_b16 a[122:123], v46 offset:12448
ds_read_b64_tr_b16 a[124:125], v46 offset:14368
ds_read_b64_tr_b16 a[126:127], v46 offset:14496
s_waitcnt lgkmcnt(0)
buffer_load_dword v50, v51, s[4:7], 0 offen
s_xor_b32 s29, s76, 0
s_lshl_b32 s28, s29, 10
s_add_u32 s28, s28, s47
s_add_u32 m0, s28, 0
s_lshl_b32 s29, s29, 17
buffer_load_dwordx4 v40, s[4:7], s29 offen lds
s_xor_b32 s29, s76, 1
s_lshl_b32 s28, s29, 10
s_add_u32 s28, s28, s47
s_add_u32 m0, s28, 0
s_lshl_b32 s29, s29, 17
buffer_load_dwordx4 v40, s[4:7], s29 offen lds
s_xor_b32 s29, s76, 2
s_lshl_b32 s28, s29, 10
s_add_u32 s28, s28, s47
s_add_u32 m0, s28, 0
s_lshl_b32 s29, s29, 17
buffer_load_dwordx4 v40, s[4:7], s29 offen lds
s_xor_b32 s29, s76, 3
s_lshl_b32 s28, s29, 10
s_add_u32 s28, s28, s47
s_add_u32 m0, s28, 0
s_lshl_b32 s29, s29, 17
buffer_load_dwordx4 v40, s[4:7], s29 offen lds
s_xor_b32 s29, s76, 4
s_lshl_b32 s28, s29, 10
s_add_u32 s28, s28, s47
s_add_u32 m0, s28, 0
s_lshl_b32 s29, s29, 17
buffer_load_dwordx4 v40, s[4:7], s29 offen lds
s_xor_b32 s29, s76, 5
s_lshl_b32 s28, s29, 10
s_add_u32 s28, s28, s47
s_add_u32 m0, s28, 0
s_lshl_b32 s29, s29, 17
buffer_load_dwordx4 v40, s[4:7], s29 offen lds
s_xor_b32 s29, s76, 6
s_lshl_b32 s28, s29, 10
s_add_u32 s28, s28, s47
s_add_u32 m0, s28, 0
s_lshl_b32 s29, s29, 17
buffer_load_dwordx4 v40, s[4:7], s29 offen lds
s_xor_b32 s29, s76, 7
s_lshl_b32 s28, s29, 10
s_add_u32 s28, s28, s47
s_add_u32 m0, s28, 0
s_lshl_b32 s29, s29, 17
buffer_load_dwordx4 v40, s[4:7], s29 offen lds
s_xor_b32 s29, s76, 8
s_lshl_b32 s28, s29, 10
s_add_u32 s28, s28, s47
s_add_u32 m0, s28, 0
s_lshl_b32 s29, s29, 17
buffer_load_dwordx4 v40, s[4:7], s29 offen lds
s_xor_b32 s29, s76, 9
s_lshl_b32 s28, s29, 10
s_add_u32 s28, s28, s47
s_add_u32 m0, s28, 0
s_lshl_b32 s29, s29, 17
buffer_load_dwordx4 v40, s[4:7], s29 offen lds
s_xor_b32 s29, s76, 10
s_lshl_b32 s28, s29, 10
s_add_u32 s28, s28, s47
s_add_u32 m0, s28, 0
s_lshl_b32 s29, s29, 17
buffer_load_dwordx4 v40, s[4:7], s29 offen lds
s_xor_b32 s29, s76, 11
s_lshl_b32 s28, s29, 10
s_add_u32 s28, s28, s47
s_add_u32 m0, s28, 0
s_lshl_b32 s29, s29, 17
buffer_load_dwordx4 v40, s[4:7], s29 offen lds
s_xor_b32 s29, s76, 12
s_lshl_b32 s28, s29, 10
s_add_u32 s28, s28, s47
s_add_u32 m0, s28, 0
s_lshl_b32 s29, s29, 17
buffer_load_dwordx4 v40, s[4:7], s29 offen lds
s_xor_b32 s29, s76, 13
s_lshl_b32 s28, s29, 10
s_add_u32 s28, s28, s47
s_add_u32 m0, s28, 0
s_lshl_b32 s29, s29, 17
buffer_load_dwordx4 v40, s[4:7], s29 offen lds
s_xor_b32 s29, s76, 14
s_lshl_b32 s28, s29, 10
s_add_u32 s28, s28, s47
s_add_u32 m0, s28, 0
s_lshl_b32 s29, s29, 17
buffer_load_dwordx4 v40, s[4:7], s29 offen lds
s_xor_b32 s29, s76, 15
s_lshl_b32 s28, s29, 10
s_add_u32 s28, s28, s47
s_add_u32 m0, s28, 0
s_lshl_b32 s29, s29, 17
buffer_load_dwordx4 v40, s[4:7], s29 offen lds
s_waitcnt vmcnt(17)
ds_read_b64_tr_b16 a[128:129], v46 offset:16384
ds_read_b64_tr_b16 a[130:131], v46 offset:16512
ds_read_b64_tr_b16 a[132:133], v46 offset:18432
ds_read_b64_tr_b16 a[134:135], v46 offset:18560
ds_read_b64_tr_b16 a[136:137], v46 offset:20480
ds_read_b64_tr_b16 a[138:139], v46 offset:20608
ds_read_b64_tr_b16 a[140:141], v46 offset:22528
ds_read_b64_tr_b16 a[142:143], v46 offset:22656
s_waitcnt lgkmcnt(0)
ds_read_b64_tr_b16 a[144:145], v46 offset:24576
ds_read_b64_tr_b16 a[146:147], v46 offset:24704
ds_read_b64_tr_b16 a[148:149], v46 offset:26624
ds_read_b64_tr_b16 a[150:151], v46 offset:26752
ds_read_b64_tr_b16 a[152:153], v46 offset:28672
ds_read_b64_tr_b16 a[154:155], v46 offset:28800
ds_read_b64_tr_b16 a[156:157], v46 offset:30720
ds_read_b64_tr_b16 a[158:159], v46 offset:30848
s_waitcnt lgkmcnt(0)
ds_read_b64_tr_b16 a[160:161], v46 offset:16416
ds_read_b64_tr_b16 a[162:163], v46 offset:16544
ds_read_b64_tr_b16 a[164:165], v46 offset:18464
ds_read_b64_tr_b16 a[166:167], v46 offset:18592
ds_read_b64_tr_b16 a[168:169], v46 offset:20512
ds_read_b64_tr_b16 a[170:171], v46 offset:20640
ds_read_b64_tr_b16 a[172:173], v46 offset:22560
ds_read_b64_tr_b16 a[174:175], v46 offset:22688
s_waitcnt lgkmcnt(0)
ds_read_b64_tr_b16 a[176:177], v46 offset:24608
ds_read_b64_tr_b16 a[178:179], v46 offset:24736
ds_read_b64_tr_b16 a[180:181], v46 offset:26656
ds_read_b64_tr_b16 a[182:183], v46 offset:26784
ds_read_b64_tr_b16 a[184:185], v46 offset:28704
ds_read_b64_tr_b16 a[186:187], v46 offset:28832
ds_read_b64_tr_b16 a[188:189], v46 offset:30752
ds_read_b64_tr_b16 a[190:191], v46 offset:30880
s_waitcnt lgkmcnt(0)
buffer_load_dword v50, v52, s[16:19], 0 offen
s_xor_b32 s29, s76, 0
s_lshl_b32 s28, s29, 10
s_add_u32 s28, s28, s47
s_add_u32 m0, s28, 16384
s_lshl_b32 s29, s29, 15
buffer_load_dwordx4 v41, s[16:19], s29 offen lds
s_xor_b32 s29, s76, 1
s_lshl_b32 s28, s29, 10
s_add_u32 s28, s28, s47
s_add_u32 m0, s28, 16384
s_lshl_b32 s29, s29, 15
buffer_load_dwordx4 v41, s[16:19], s29 offen lds
s_xor_b32 s29, s76, 2
s_lshl_b32 s28, s29, 10
s_add_u32 s28, s28, s47
s_add_u32 m0, s28, 16384
s_lshl_b32 s29, s29, 15
buffer_load_dwordx4 v41, s[16:19], s29 offen lds
s_xor_b32 s29, s76, 3
s_lshl_b32 s28, s29, 10
s_add_u32 s28, s28, s47
s_add_u32 m0, s28, 16384
s_lshl_b32 s29, s29, 15
buffer_load_dwordx4 v41, s[16:19], s29 offen lds
s_xor_b32 s29, s76, 4
s_lshl_b32 s28, s29, 10
s_add_u32 s28, s28, s47
s_add_u32 m0, s28, 16384
s_lshl_b32 s29, s29, 15
buffer_load_dwordx4 v41, s[16:19], s29 offen lds
s_xor_b32 s29, s76, 5
s_lshl_b32 s28, s29, 10
s_add_u32 s28, s28, s47
s_add_u32 m0, s28, 16384
s_lshl_b32 s29, s29, 15
buffer_load_dwordx4 v41, s[16:19], s29 offen lds
s_xor_b32 s29, s76, 6
s_lshl_b32 s28, s29, 10
s_add_u32 s28, s28, s47
s_add_u32 m0, s28, 16384
s_lshl_b32 s29, s29, 15
buffer_load_dwordx4 v41, s[16:19], s29 offen lds
s_xor_b32 s29, s76, 7
s_lshl_b32 s28, s29, 10
s_add_u32 s28, s28, s47
s_add_u32 m0, s28, 16384
s_lshl_b32 s29, s29, 15
buffer_load_dwordx4 v41, s[16:19], s29 offen lds
s_xor_b32 s29, s76, 8
s_lshl_b32 s28, s29, 10
s_add_u32 s28, s28, s47
s_add_u32 m0, s28, 16384
s_lshl_b32 s29, s29, 15
buffer_load_dwordx4 v41, s[16:19], s29 offen lds
s_xor_b32 s29, s76, 9
s_lshl_b32 s28, s29, 10
s_add_u32 s28, s28, s47
s_add_u32 m0, s28, 16384
s_lshl_b32 s29, s29, 15
buffer_load_dwordx4 v41, s[16:19], s29 offen lds
s_xor_b32 s29, s76, 10
s_lshl_b32 s28, s29, 10
s_add_u32 s28, s28, s47
s_add_u32 m0, s28, 16384
s_lshl_b32 s29, s29, 15
buffer_load_dwordx4 v41, s[16:19], s29 offen lds
s_xor_b32 s29, s76, 11
s_lshl_b32 s28, s29, 10
s_add_u32 s28, s28, s47
s_add_u32 m0, s28, 16384
s_lshl_b32 s29, s29, 15
buffer_load_dwordx4 v41, s[16:19], s29 offen lds
s_xor_b32 s29, s76, 12
s_lshl_b32 s28, s29, 10
s_add_u32 s28, s28, s47
s_add_u32 m0, s28, 16384
s_lshl_b32 s29, s29, 15
buffer_load_dwordx4 v41, s[16:19], s29 offen lds
s_xor_b32 s29, s76, 13
s_lshl_b32 s28, s29, 10
s_add_u32 s28, s28, s47
s_add_u32 m0, s28, 16384
s_lshl_b32 s29, s29, 15
buffer_load_dwordx4 v41, s[16:19], s29 offen lds
s_xor_b32 s29, s76, 14
s_lshl_b32 s28, s29, 10
s_add_u32 s28, s28, s47
s_add_u32 m0, s28, 16384
s_lshl_b32 s29, s29, 15
buffer_load_dwordx4 v41, s[16:19], s29 offen lds
s_xor_b32 s29, s76, 15
s_lshl_b32 s28, s29, 10
s_add_u32 s28, s28, s47
s_add_u32 m0, s28, 16384
s_lshl_b32 s29, s29, 15
buffer_load_dwordx4 v41, s[16:19], s29 offen lds
s_waitcnt vmcnt(17)
ds_read_b64_tr_b16 a[0:1], v46 offset:0
ds_read_b64_tr_b16 a[2:3], v46 offset:128
ds_read_b64_tr_b16 a[4:5], v46 offset:2048
ds_read_b64_tr_b16 a[6:7], v46 offset:2176
ds_read_b64_tr_b16 a[8:9], v46 offset:4096
ds_read_b64_tr_b16 a[10:11], v46 offset:4224
ds_read_b64_tr_b16 a[12:13], v46 offset:6144
ds_read_b64_tr_b16 a[14:15], v46 offset:6272
s_waitcnt lgkmcnt(0)
ds_read_b64_tr_b16 a[16:17], v46 offset:8192
ds_read_b64_tr_b16 a[18:19], v46 offset:8320
ds_read_b64_tr_b16 a[20:21], v46 offset:10240
ds_read_b64_tr_b16 a[22:23], v46 offset:10368
ds_read_b64_tr_b16 a[24:25], v46 offset:12288
ds_read_b64_tr_b16 a[26:27], v46 offset:12416
ds_read_b64_tr_b16 a[28:29], v46 offset:14336
ds_read_b64_tr_b16 a[30:31], v46 offset:14464
s_waitcnt lgkmcnt(0)
ds_read_b64_tr_b16 a[32:33], v46 offset:32
ds_read_b64_tr_b16 a[34:35], v46 offset:160
ds_read_b64_tr_b16 a[36:37], v46 offset:2080
ds_read_b64_tr_b16 a[38:39], v46 offset:2208
ds_read_b64_tr_b16 a[40:41], v46 offset:4128
ds_read_b64_tr_b16 a[42:43], v46 offset:4256
ds_read_b64_tr_b16 a[44:45], v46 offset:6176
ds_read_b64_tr_b16 a[46:47], v46 offset:6304
s_waitcnt lgkmcnt(0)
ds_read_b64_tr_b16 a[48:49], v46 offset:8224
ds_read_b64_tr_b16 a[50:51], v46 offset:8352
ds_read_b64_tr_b16 a[52:53], v46 offset:10272
ds_read_b64_tr_b16 a[54:55], v46 offset:10400
ds_read_b64_tr_b16 a[56:57], v46 offset:12320
ds_read_b64_tr_b16 a[58:59], v46 offset:12448
ds_read_b64_tr_b16 a[60:61], v46 offset:14368
ds_read_b64_tr_b16 a[62:63], v46 offset:14496
s_waitcnt lgkmcnt(0)
v_and_b32 v247, 15, v0
v_lshlrev_b32 v247, 4, v247
buffer_load_dword v246, v247, s[72:75], 0 offen sc1
s_waitcnt vmcnt(0)
ds_read_b64_tr_b16 a[192:193], v47 offset:16384
ds_read_b64_tr_b16 a[194:195], v47 offset:16512
ds_read_b64_tr_b16 a[196:197], v47 offset:18432
ds_read_b64_tr_b16 a[198:199], v47 offset:18560
ds_read_b64_tr_b16 a[200:201], v47 offset:20480
ds_read_b64_tr_b16 a[202:203], v47 offset:20608
ds_read_b64_tr_b16 a[204:205], v47 offset:22528
ds_read_b64_tr_b16 a[206:207], v47 offset:22656
s_waitcnt lgkmcnt(0)
ds_read_b64_tr_b16 a[208:209], v47 offset:24576
ds_read_b64_tr_b16 a[210:211], v47 offset:24704
ds_read_b64_tr_b16 a[212:213], v47 offset:26624
ds_read_b64_tr_b16 a[214:215], v47 offset:26752
ds_read_b64_tr_b16 a[216:217], v47 offset:28672
ds_read_b64_tr_b16 a[218:219], v47 offset:28800
ds_read_b64_tr_b16 a[220:221], v47 offset:30720
ds_read_b64_tr_b16 a[222:223], v47 offset:30848
s_waitcnt lgkmcnt(0)
ds_read_b64_tr_b16 a[224:225], v47 offset:16416
ds_read_b64_tr_b16 a[226:227], v47 offset:16544
ds_read_b64_tr_b16 a[228:229], v47 offset:18464
ds_read_b64_tr_b16 a[230:231], v47 offset:18592
ds_read_b64_tr_b16 a[232:233], v47 offset:20512
ds_read_b64_tr_b16 a[234:235], v47 offset:20640
ds_read_b64_tr_b16 a[236:237], v47 offset:22560
ds_read_b64_tr_b16 a[238:239], v47 offset:22688
s_waitcnt lgkmcnt(0)
ds_read_b64_tr_b16 a[240:241], v47 offset:24608
ds_read_b64_tr_b16 a[242:243], v47 offset:24736
ds_read_b64_tr_b16 a[244:245], v47 offset:26656
ds_read_b64_tr_b16 a[246:247], v47 offset:26784
ds_read_b64_tr_b16 a[248:249], v47 offset:28704
ds_read_b64_tr_b16 a[250:251], v47 offset:28832
ds_read_b64_tr_b16 a[252:253], v47 offset:30752
ds_read_b64_tr_b16 a[254:255], v47 offset:30880
s_waitcnt lgkmcnt(0)
v_and_b32 v247, 15, v0
v_lshlrev_b32 v247, 4, v247
s_branch mega_kernel_sysp
mega_kernel_sysw:
s_sleep 4
mega_kernel_sys:
buffer_load_dword v246, v247, s[72:75], 0 offen sc1
s_waitcnt vmcnt(0)
mega_kernel_sysp:
s_cmp_eq_u32 s95, 1
s_cbranch_scc0 mega_kernel_sysf
v_readlane_b32 s76, v246, 14
s_mov_b32 s98, 0
s_cmp_eq_u32 s76, 64
s_cbranch_scc0 mega_kernel_sysw
s_branch mega_kernel_sysd
mega_kernel_sysf:
s_mov_b32 s77, 0
s_mov_b32 s78, 0
v_readlane_b32 s76, v246, 0
s_add_u32 s77, s77, s76
s_xor_b32 s76, s76, 32
s_or_b32 s78, s78, s76
v_readlane_b32 s76, v246, 1
s_add_u32 s77, s77, s76
s_xor_b32 s76, s76, 32
s_or_b32 s78, s78, s76
v_readlane_b32 s76, v246, 2
s_add_u32 s77, s77, s76
s_xor_b32 s76, s76, 32
s_or_b32 s78, s78, s76
v_readlane_b32 s76, v246, 3
s_add_u32 s77, s77, s76
s_xor_b32 s76, s76, 32
s_or_b32 s78, s78, s76
v_readlane_b32 s76, v246, 4
s_add_u32 s77, s77, s76
s_xor_b32 s76, s76, 32
s_or_b32 s78, s78, s76
v_readlane_b32 s76, v246, 5
s_add_u32 s77, s77, s76
s_xor_b32 s76, s76, 32
s_or_b32 s78, s78, s76
v_readlane_b32 s76, v246, 6
s_add_u32 s77, s77, s76
s_xor_b32 s76, s76, 32
s_or_b32 s78, s78, s76
v_readlane_b32 s76, v246, 7
s_add_u32 s77, s77, s76
s_xor_b32 s76, s76, 32
s_or_b32 s78, s78, s76
s_cmp_eq_u32 s77, 256
s_cbranch_scc0 mega_kernel_sysw
v_mov_b32 v252, v246
s_cmp_eq_u32 s78, 0
s_cbranch_scc0 mega_kernel_slowent
v_readlane_b32 s76, v246, 10
v_readlane_b32 s77, v246, 8
s_cmp_eq_u32 s76, 64
s_cbranch_scc0 mega_kernel_sysw
s_cmp_gt_u32 s77, 32
s_cselect_b32 s98, 1, 0
mega_kernel_sysd:
s_lshr_b32 s28, s31, 3
s_lshl_b32 s28, s28, 14
s_lshl_b32 s29, s98, 13
s_add_u32 s28, s28, s29
s_and_b32 s29, s31, 7
s_lshl_b32 s29, s29, 10
s_add_u32 s28, s28, s29
s_lshl_b32 s29, s30, 16
s_add_u32 s28, s28, s29
s_add_u32 s28, s28, 67108864
v_add_u32 v12, s28, v17
v_xor_b32 v25, 0x10000, v12
v_xor_b32 v26, 0x20000, v12
v_xor_b32 v27, 0x30000, v12
v_add_u32 v25, 0, v25
v_add_u32 v26, 0, v26
v_add_u32 v27, 0, v27
s_lshl_b32 s28, s25, 2
s_add_u32 s28, s28, s26
s_mov_b32 s82, s28
s_lshr_b32 s29, s28, 3
s_xor_b32 s29, s29, s98
s_and_b32 s29, s29, 1
s_lshl_b32 s29, s29, 13
s_lshl_b32 s76, s28, 18
s_add_u32 s76, s76, s29
s_mov_b32 s83, s76
v_add_u32 v240, s76, v17
v_add_u32 v241, 33554432, v240
s_lshr_b32 s29, s28, 4
s_xor_b32 s29, s29, s98
s_and_b32 s29, s29, 1
s_lshl_b32 s29, s29, 13
s_lshl_b32 s79, s28, 17
s_add_u32 s79, s79, s29
s_add_u32 s79, s79, 71303168
s_xor_b32 s29, s98, 1
s_lshl_b32 s29, s29, 13
s_lshl_b32 s28, s25, 7
s_add_u32 s28, s28, s29
s_add_u32 s28, s28, 69206016
v_and_b32 v4, 1, v1
v_lshlrev_b32 v24, 12, v4
v_add_u32 v24, s28, v24
s_lshl_b32 s29, s26, 2
v_add_u32 v24, s29, v24
s_xor_b32 s81, s98, 1
s_lshl_b32 s81, s81, 13
s_lshr_b32 s29, s82, 6
s_lshl_b32 s29, s29, 14
s_add_u32 s81, s81, s29
s_and_b32 s29, s82, 63
s_lshl_b32 s29, s29, 7
s_add_u32 s81, s81, s29
s_add_u32 s81, s81, 69222400
v_mov_b32 v220, 0x3f803f80
v_mov_b32 v221, 0x3f803f80
v_mov_b32 v222, 0x3f803f80
v_mov_b32 v223, 0x3f803f80
v_mov_b32 v228, 0
s_mov_b32 s27, 0
s_mov_b32 s46, 0
s_mov_b32 s89, 0
s_mov_b32 s88, 0
s_mov_b32 s44, 18432
s_mov_b32 s45, 18432
s_cmp_eq_u32 s24, 3
s_cbranch_scc0 mega_kernel_rs_pfi
s_mov_b32 s76, 0
s_cmp_gt_i32 s46, s76
s_cbranch_scc1 mega_kernel_rs_pf0ok
mega_kernel_rs_pf0w:
v_mov_b32 v4, 0
s_mov_b64 exec, 3
buffer_atomic_add v4, v24, s[84:87], 0 offen sc0 sc1
s_mov_b64 exec, -1
s_waitcnt vmcnt(0)
v_readlane_b32 s46, v4, 0
v_readlane_b32 s28, v4, 1
s_nop 1
s_min_i32 s46, s46, s28
s_cmp_gt_i32 s46, s76
s_cbranch_scc0 mega_kernel_rs_pf0w
mega_kernel_rs_pf0ok:
s_add_u32 s77, s76, s82
s_bfe_u32 s28, s77, 0x40002
s_lshl_b32 s28, s28, 14
s_and_b32 s77, s77, 3
s_lshl_b32 s77, s77, 11
s_add_u32 s28, s28, s77
s_add_u32 m0, s45, 0
s_nop 0
buffer_load_dwordx4 v240, s[84:87], s28 offen offset:0 sc1 lds
s_add_u32 m0, s45, 0
s_nop 0
buffer_load_dwordx4 v240, s[84:87], s28 offen offset:1024 sc1 lds
s_add_u32 m0, s45, 2048
s_nop 0
buffer_load_dwordx4 v241, s[84:87], s28 offen offset:0 sc1 lds
s_add_u32 m0, s45, 2048
s_nop 0
buffer_load_dwordx4 v241, s[84:87], s28 offen offset:1024 sc1 lds
s_add_u32 s45, s45, 4096
s_cmp_eq_u32 s45, 30720
s_cselect_b32 s45, 18432, s45
s_waitcnt vmcnt(0) lgkmcnt(0)
mega_kernel_rs_pfi:
v_mov_b32 v184, 0
v_mov_b32 v185, 0
v_mov_b32 v186, 0
v_mov_b32 v187, 0
v_mov_b32 v188, 0
v_mov_b32 v189, 0
v_mov_b32 v190, 0
v_mov_b32 v191, 0
v_mov_b32 v192, 0
v_mov_b32 v193, 0
v_mov_b32 v194, 0
v_mov_b32 v195, 0
v_mov_b32 v196, 0
v_mov_b32 v197, 0
v_mov_b32 v198, 0
v_mov_b32 v199, 0
v_mov_b32 v200, 0
v_mov_b32 v201, 0
v_mov_b32 v202, 0
v_mov_b32 v203, 0
v_mov_b32 v204, 0
v_mov_b32 v205, 0
v_mov_b32 v206, 0
v_mov_b32 v207, 0
v_mov_b32 v249, 0
v_mov_b32 v96, 0
v_mov_b32 v97, 0
v_mov_b32 v98, 0
v_mov_b32 v99, 0
v_mov_b32 v100, 0
v_mov_b32 v101, 0
v_mov_b32 v102, 0
v_mov_b32 v103, 0
v_mov_b32 v104, 0
v_mov_b32 v105, 0
v_mov_b32 v106, 0
v_mov_b32 v107, 0
v_mov_b32 v108, 0
v_mov_b32 v109, 0
v_mov_b32 v110, 0
v_mov_b32 v111, 0
v_mov_b32 v112, 0
v_mov_b32 v113, 0
v_mov_b32 v114, 0
v_mov_b32 v115, 0
v_mov_b32 v116, 0
v_mov_b32 v117, 0
v_mov_b32 v118, 0
v_mov_b32 v119, 0
s_barrier
s_and_b32 s29, s27, 1
s_lshl_b32 s33, s29, 17
s_lshl_b32 s28, s30, 18
s_add_u32 s33, s33, s28
s_add_u32 s33, s33, 68157440
s_xor_b32 s34, s33, 131072
s_lshl_b32 s35, s29, 18
s_bfe_u32 s47, s27, 0x10001
s_branch mega_kernel_rs_first
.p2align 6
s_nop 0
s_nop 0
mega_kernel_rs_loop:
buffer_load_dwordx4 v[32:35], v7, s[84:87], s33 offen offset:0 sc1
v_add_u32 v5, s44, v17
ds_read_b128 v[156:159], v5 offset:0
ds_read_b128 v[160:163], v5 offset:1024
ds_read_b128 v[164:167], v5 offset:2048
ds_read_b128 v[168:171], v5 offset:3072
s_nop 4
buffer_load_dwordx4 v[36:39], v7, s[84:87], s33 offen offset:1024 sc1
s_nop 9
buffer_load_dwordx4 v[40:43], v7, s[84:87], s33 offen offset:2048 sc1
s_nop 9
buffer_load_dwordx4 v[44:47], v7, s[84:87], s33 offen offset:3072 sc1
s_waitcnt vmcnt(3)
v_max_u32 v4, v32, v34
v_cmp_eq_u32 vcc, -1, v4
s_cbranch_vccnz mega_kernel_rs_pa_15_0f
v_smfmac_f32_16x16x64_bf16 v[96:99], v[32:35], a[0:7], v6
v_smfmac_f32_16x16x64_bf16 v[100:103], v[32:35], a[32:39], v6
v_smfmac_f32_16x16x64_bf16 v[104:107], v[32:35], a[64:71], v6
s_waitcnt vmcnt(2)
v_max_u32 v4, v36, v38
v_cmp_eq_u32 vcc, -1, v4
v_smfmac_f32_16x16x64_bf16 v[108:111], v[32:35], a[96:103], v6
s_cbranch_vccnz mega_kernel_rs_pa_14_1f
v_smfmac_f32_16x16x64_bf16 v[96:99], v[36:39], a[8:15], v6
v_smfmac_f32_16x16x64_bf16 v[100:103], v[36:39], a[40:47], v6
v_smfmac_f32_16x16x64_bf16 v[104:107], v[36:39], a[72:79], v6
s_waitcnt vmcnt(1)
v_max_u32 v4, v40, v42
v_cmp_eq_u32 vcc, -1, v4
v_smfmac_f32_16x16x64_bf16 v[108:111], v[36:39], a[104:111], v6
s_cbranch_vccnz mega_kernel_rs_pa_12_2f
v_smfmac_f32_16x16x64_bf16 v[96:99], v[40:43], a[16:23], v6
v_smfmac_f32_16x16x64_bf16 v[100:103], v[40:43], a[48:55], v6
v_smfmac_f32_16x16x64_bf16 v[104:107], v[40:43], a[80:87], v6
s_waitcnt vmcnt(0)
v_max_u32 v4, v44, v46
v_cmp_eq_u32 vcc, -1, v4
v_smfmac_f32_16x16x64_bf16 v[108:111], v[40:43], a[112:119], v6
s_cbranch_vccnz mega_kernel_rs_pa_8_3f
v_smfmac_f32_16x16x64_bf16 v[96:99], v[44:47], a[24:31], v6
v_smfmac_f32_16x16x64_bf16 v[100:103], v[44:47], a[56:63], v6
v_smfmac_f32_16x16x64_bf16 v[104:107], v[44:47], a[88:95], v6
v_smfmac_f32_16x16x64_bf16 v[108:111], v[44:47], a[120:127], v6
mega_kernel_rs_pa_d:
mega_kernel_rs_adone:
s_nop 5
v_permlane32_swap_b32 v96, v100
v_permlane32_swap_b32 v97, v101
v_permlane32_swap_b32 v98, v102
v_permlane32_swap_b32 v99, v103
v_pk_add_f32 v[96:97], v[96:97], v[100:101]
v_pk_add_f32 v[98:99], v[98:99], v[102:103]
ds_write2_b32 v14, v96, v97 offset0:0 offset1:36
ds_write2_b32 v14, v98, v99 offset0:72 offset1:108
v_permlane32_swap_b32 v104, v108
v_permlane32_swap_b32 v105, v109
v_permlane32_swap_b32 v106, v110
v_permlane32_swap_b32 v107, v111
v_pk_add_f32 v[104:105], v[104:105], v[108:109]
v_pk_add_f32 v[106:107], v[106:107], v[110:111]
ds_write2_b32 v15, v104, v105 offset0:0 offset1:36
ds_write2_b32 v15, v106, v107 offset0:72 offset1:108
v_smfmac_f32_16x16x64_bf16 v[112:115], v[32:35], a[128:135], v6
v_smfmac_f32_16x16x64_bf16 v[116:119], v[32:35], a[160:167], v6
v_smfmac_f32_16x16x64_bf16 v[112:115], v[36:39], a[136:143], v6
v_smfmac_f32_16x16x64_bf16 v[116:119], v[36:39], a[168:175], v6
s_waitcnt lgkmcnt(0)
s_barrier
s_cmp_lg_u32 s24, 0
s_cbranch_scc1 mega_kernel_rs_side
ds_read_b128 v[120:123], v16 offset:0
ds_read_b128 v[124:127], v16 offset:16
ds_read_b128 v[128:131], v16 offset:2304
ds_read_b128 v[132:135], v16 offset:2320
ds_read_b128 v[136:139], v16 offset:4608
ds_read_b128 v[140:143], v16 offset:4624
ds_read_b128 v[144:147], v16 offset:6912
ds_read_b128 v[148:151], v16 offset:6928
v_smfmac_f32_16x16x64_bf16 v[112:115], v[40:43], a[144:151], v6
v_smfmac_f32_16x16x64_bf16 v[116:119], v[40:43], a[176:183], v6
v_smfmac_f32_16x16x64_bf16 v[112:115], v[44:47], a[152:159], v6
v_smfmac_f32_16x16x64_bf16 v[116:119], v[44:47], a[184:191], v6
s_mul_i32 s28, s31, 2048
s_add_u32 s28, s28, s33
s_add_u32 s28, s28, 49152
s_add_u32 s76, s37, s33
s_add_u32 s77, s38, s33
s_add_u32 s78, s39, s33
s_waitcnt lgkmcnt(4)
v_pk_add_f32 v[120:121], v[120:121], v[128:129]
v_pk_add_f32 v[122:123], v[122:123], v[130:131]
v_pk_add_f32 v[124:125], v[124:125], v[132:133]
v_pk_add_f32 v[126:127], v[126:127], v[134:135]
s_waitcnt lgkmcnt(0)
v_pk_add_f32 v[136:137], v[136:137], v[144:145]
v_pk_add_f32 v[138:139], v[138:139], v[146:147]
v_pk_add_f32 v[140:141], v[140:141], v[148:149]
v_pk_add_f32 v[142:143], v[142:143], v[150:151]
v_pk_add_f32 v[120:121], v[120:121], v[136:137]
v_pk_add_f32 v[122:123], v[122:123], v[138:139]
v_pk_add_f32 v[124:125], v[124:125], v[140:141]
v_pk_add_f32 v[126:127], v[126:127], v[142:143]
v_cvt_pk_bf16_f32 v152, v120, v121
v_cvt_pk_bf16_f32 v153, v122, v123
v_cvt_pk_bf16_f32 v154, v124, v125
v_cvt_pk_bf16_f32 v155, v126, v127
s_nop 1
v_mfma_f32_16x16x32_bf16 v[176:179], v[160:163], v[152:155], 0
v_mfma_f32_16x16x32_bf16 v[172:175], v[156:159], v[152:155], 0
v_mfma_f32_16x16x32_bf16 v[180:183], v[152:155], v[152:155], 0
s_cmp_eq_u32 s27, 63
s_cbranch_scc1 mega_kernel_rs_w0last
s_nop 4
v_mov_b32_dpp v172, v176 row_shr:8 row_mask:0xf bank_mask:0xc
v_mov_b32_dpp v173, v177 row_shr:8 row_mask:0xf bank_mask:0xc
v_mov_b32_dpp v174, v178 row_shr:8 row_mask:0xf bank_mask:0xc
v_mov_b32_dpp v175, v179 row_shr:8 row_mask:0xf bank_mask:0xc
v_min_u32 v180, -2, v180
v_min_u32 v172, -2, v172
s_mov_b64 exec, s[42:43]
buffer_store_dwordx4 v[180:183], v10, s[84:87], s28 offen sc1
s_mov_b64 exec, -1
buffer_store_dwordx4 v[172:175], v17, s[84:87], s28 offen sc1
v_permlane32_swap_b32 v112, v116
v_permlane32_swap_b32 v113, v117
v_permlane32_swap_b32 v114, v118
v_permlane32_swap_b32 v115, v119
v_pk_add_f32 v[112:113], v[112:113], v[116:117]
v_pk_add_f32 v[114:115], v[114:115], v[118:119]
ds_write_b128 v20, v[112:115]
s_waitcnt lgkmcnt(0)
s_barrier
v_mov_b32 v96, 0
v_mov_b32 v97, 0
v_mov_b32 v98, 0
v_mov_b32 v99, 0
v_mov_b32 v100, 0
v_mov_b32 v101, 0
v_mov_b32 v102, 0
v_mov_b32 v103, 0
v_cndmask_b32 v176, v23, v180, s[42:43]
v_cndmask_b32 v177, v23, v181, s[42:43]
v_cndmask_b32 v178, v23, v182, s[42:43]
v_cndmask_b32 v179, v23, v183, s[42:43]
s_mov_b64 exec, s[42:43]
buffer_load_dwordx4 v[188:191], v10, s[84:87], s76 offen sc1
buffer_load_dwordx4 v[196:199], v10, s[84:87], s77 offen sc1
buffer_load_dwordx4 v[204:207], v10, s[84:87], s78 offen sc1
s_mov_b64 exec, -1
buffer_load_dwordx4 v[184:187], v17, s[84:87], s76 offen sc1
buffer_load_dwordx4 v[192:195], v17, s[84:87], s77 offen sc1
buffer_load_dwordx4 v[200:203], v17, s[84:87], s78 offen sc1
v_pk_mul_f32 v[172:173], v[172:173], s[32:33] op_sel_hi:[1,0]
v_pk_mul_f32 v[174:175], v[174:175], s[32:33] op_sel_hi:[1,0]
v_pk_mul_f32 v[176:177], v[176:177], s[32:33] op_sel_hi:[1,0]
v_pk_mul_f32 v[178:179], v[178:179], s[32:33] op_sel_hi:[1,0]
s_nop 15
s_nop 3
s_mov_b64 exec, s[42:43]
buffer_load_dwordx4 v[188:191], v10, s[84:87], s76 offen sc1
buffer_load_dwordx4 v[196:199], v10, s[84:87], s77 offen sc1
buffer_load_dwordx4 v[204:207], v10, s[84:87], s78 offen sc1
s_mov_b64 exec, -1
buffer_load_dwordx4 v[184:187], v17, s[84:87], s76 offen sc1
buffer_load_dwordx4 v[192:195], v17, s[84:87], s77 offen sc1
buffer_load_dwordx4 v[200:203], v17, s[84:87], s78 offen sc1
mega_kernel_rs_p2:
s_waitcnt vmcnt(6)
v_max3_u32 v4, v184, v188, v192
v_max3_u32 v5, v196, v200, v204
v_max_u32 v4, v4, v5
v_cmp_eq_u32 vcc, -1, v4
s_cbranch_vccnz mega_kernel_rs_p2r
v_pk_add_f32 v[124:125], v[196:197], v[204:205]
v_pk_add_f32 v[126:127], v[198:199], v[206:207]
v_pk_add_f32 v[120:121], v[192:193], v[200:201]
v_pk_add_f32 v[122:123], v[194:195], v[202:203]
v_pk_add_f32 v[124:125], v[124:125], v[188:189]
v_pk_add_f32 v[126:127], v[126:127], v[190:191]
v_pk_add_f32 v[120:121], v[120:121], v[184:185]
v_pk_add_f32 v[122:123], v[122:123], v[186:187]
v_pk_fma_f32 v[176:177], v[124:125], s[32:33], v[176:177] op_sel_hi:[1,0,1]
v_pk_fma_f32 v[178:179], v[126:127], s[32:33], v[178:179] op_sel_hi:[1,0,1]
v_pk_fma_f32 v[172:173], v[120:121], s[32:33], v[172:173] op_sel_hi:[1,0,1]
v_pk_fma_f32 v[174:175], v[122:123], s[32:33], v[174:175] op_sel_hi:[1,0,1]
v_max3_f32 v232, v172, v173, v174
v_max3_f32 v233, v176, v177, v178
v_max3_f32 v232, v232, v175, v179
v_max_f32 v234, v232, v233
s_barrier
ds_read2_b64 v[208:211], v21 offset0:0 offset1:32
v_max_f32_dpp v232, v234, v234 row_ror:8 row_mask:0xf bank_mask:0xf
v_max_f32_dpp v233, v234, v234 row_ror:8 row_mask:0xf bank_mask:0xf
s_nop 1
v_permlane16_swap_b32 v232, v233
s_nop 0
v_max_f32 v234, v232, v233
v_max_f32 v235, v232, v233
s_nop 1
v_permlane32_swap_b32 v234, v235
s_nop 0
v_max_f32 v232, v234, v235
v_pk_add_f32 v[176:177], v[176:177], v[232:233] op_sel_hi:[1,0] neg_lo:[0,1] neg_hi:[0,1]
v_pk_add_f32 v[178:179], v[178:179], v[232:233] op_sel_hi:[1,0] neg_lo:[0,1] neg_hi:[0,1]
v_pk_add_f32 v[172:173], v[172:173], v[232:233] op_sel_hi:[1,0] neg_lo:[0,1] neg_hi:[0,1]
v_pk_add_f32 v[174:175], v[174:175], v[232:233] op_sel_hi:[1,0] neg_lo:[0,1] neg_hi:[0,1]
v_exp_f32 v176, v176
v_exp_f32 v177, v177
v_exp_f32 v178, v178
v_exp_f32 v179, v179
v_exp_f32 v172, v172
v_cvt_pk_bf16_f32 v216, v176, v177
v_cvt_pk_bf16_f32 v217, v178, v179
v_exp_f32 v173, v173
v_exp_f32 v174, v174
v_mfma_f32_16x16x16_bf16 v[224:227], v[220:221], v[216:217], 0
v_exp_f32 v175, v175
v_cvt_pk_bf16_f32 v212, v172, v173
s_waitcnt lgkmcnt(0)
v_mfma_f32_16x16x16_bf16 v[120:123], v[208:209], v[216:217], 0
v_cvt_pk_bf16_f32 v213, v174, v175
v_mfma_f32_16x16x16_bf16 v[124:127], v[210:211], v[216:217], 0
v_mov_b32_dpp v214, v212 row_ror:8 row_mask:0xf bank_mask:0xf
v_mov_b32_dpp v215, v213 row_ror:8 row_mask:0xf bank_mask:0xf
s_nop 1
v_mfma_f32_16x16x32_bf16 v[224:227], v[220:223], v[212:215], v[224:227]
v_mfma_f32_16x16x32_bf16 v[120:123], v[164:167], v[212:215], v[120:123]
v_mfma_f32_16x16x32_bf16 v[124:127], v[168:171], v[212:215], v[124:127]
s_add_u32 s29, s33, 24576
s_nop 4
v_rcp_f32 v234, v224
s_nop 0
v_pk_mul_f32 v[120:121], v[120:121], v[234:235] op_sel_hi:[1,0]
v_pk_mul_f32 v[122:123], v[122:123], v[234:235] op_sel_hi:[1,0]
v_pk_mul_f32 v[124:125], v[124:125], v[234:235] op_sel_hi:[1,0]
v_pk_mul_f32 v[126:127], v[126:127], v[234:235] op_sel_hi:[1,0]
v_cvt_pk_bf16_f32 v212, v120, v121
v_cvt_pk_bf16_f32 v213, v122, v123
v_cvt_pk_bf16_f32 v214, v124, v125
v_cvt_pk_bf16_f32 v215, v126, v127
v_min_u32 v212, -2, v212
s_mov_b64 exec, s[40:41]
buffer_store_dwordx4 v[212:215], v11, s[84:87], s33 offen sc1
s_mov_b64 exec, -1
mega_kernel_rs_b3:
s_barrier
s_nop 15
buffer_load_dwordx4 v[32:35], v7, s[84:87], s29 offen offset:0 sc1
s_nop 9
buffer_load_dwordx4 v[36:39], v7, s[84:87], s29 offen offset:1024 sc1
s_nop 9
buffer_load_dwordx4 v[40:43], v7, s[84:87], s29 offen offset:2048 sc1
s_nop 9
buffer_load_dwordx4 v[44:47], v7, s[84:87], s29 offen offset:3072 sc1
mega_kernel_rs_pc_15_0:
s_waitcnt vmcnt(3)
v_cmp_eq_u32 vcc, -1, v32
s_cbranch_vccnz mega_kernel_rs_pc_15_0f
v_smfmac_f32_16x16x64_bf16 v[96:99], v[32:35], a[192:199], v6
v_smfmac_f32_16x16x64_bf16 v[100:103], v[32:35], a[224:231], v6
mega_kernel_rs_pc_14_1:
s_waitcnt vmcnt(2)
v_cmp_eq_u32 vcc, -1, v36
s_cbranch_vccnz mega_kernel_rs_pc_14_1f
v_smfmac_f32_16x16x64_bf16 v[96:99], v[36:39], a[200:207], v6
v_smfmac_f32_16x16x64_bf16 v[100:103], v[36:39], a[232:239], v6
mega_kernel_rs_pc_12_2:
s_waitcnt vmcnt(1)
v_cmp_eq_u32 vcc, -1, v40
s_cbranch_vccnz mega_kernel_rs_pc_12_2f
v_smfmac_f32_16x16x64_bf16 v[96:99], v[40:43], a[208:215], v6
v_smfmac_f32_16x16x64_bf16 v[100:103], v[40:43], a[240:247], v6
mega_kernel_rs_pc_8_3:
s_waitcnt vmcnt(0)
v_cmp_eq_u32 vcc, -1, v44
s_cbranch_vccnz mega_kernel_rs_pc_8_3f
v_smfmac_f32_16x16x64_bf16 v[96:99], v[44:47], a[216:223], v6
v_smfmac_f32_16x16x64_bf16 v[100:103], v[44:47], a[248:255], v6
mega_kernel_rs_pc_d:
s_nop 7
v_permlane32_swap_b32 v96, v100
v_permlane32_swap_b32 v97, v101
v_permlane32_swap_b32 v98, v102
v_permlane32_swap_b32 v99, v103
v_pk_add_f32 v[96:97], v[96:97], v[100:101]
v_pk_add_f32 v[98:99], v[98:99], v[102:103]
ds_write2_b32 v18, v96, v97 offset0:0 offset1:36
ds_write2_b32 v18, v98, v99 offset0:72 offset1:108
s_waitcnt lgkmcnt(0)
s_barrier
s_cmp_lg_u32 s24, 0
s_cbranch_scc1 mega_kernel_rs_x1
ds_read_b128 v[120:123], v19 offset:0
ds_read_b128 v[124:127], v19 offset:1152
ds_read_b128 v[128:131], v19 offset:2304
ds_read_b128 v[132:135], v19 offset:3456
s_waitcnt lgkmcnt(2)
v_pk_add_f32 v[120:121], v[120:121], v[124:125]
v_pk_add_f32 v[122:123], v[122:123], v[126:127]
s_waitcnt lgkmcnt(0)
v_pk_add_f32 v[128:129], v[128:129], v[132:133]
v_pk_add_f32 v[130:131], v[130:131], v[134:135]
v_pk_add_f32 v[120:121], v[120:121], v[128:129]
v_pk_add_f32 v[122:123], v[122:123], v[130:131]
v_and_or_b32 v120, v120, -2, s47
v_and_or_b32 v121, v121, -2, s47
v_and_or_b32 v122, v122, -2, s47
v_and_or_b32 v123, v123, -2, s47
buffer_store_dwordx4 v[120:123], v12, s[84:87], s35 offen sc1
s_xor_b32 s76, s47, 1
v_mov_b32 v48, s76
v_mov_b32 v49, s76
v_mov_b32 v50, s76
v_mov_b32 v51, s76
v_mov_b32 v52, s76
v_mov_b32 v53, s76
v_mov_b32 v54, s76
v_mov_b32 v55, s76
v_mov_b32 v56, s76
v_mov_b32 v57, s76
v_mov_b32 v58, s76
v_mov_b32 v59, s76
v_mov_b32 v96, 0
v_mov_b32 v97, 0
v_mov_b32 v98, 0
v_mov_b32 v99, 0
v_mov_b32 v100, 0
v_mov_b32 v101, 0
v_mov_b32 v102, 0
v_mov_b32 v103, 0
v_mov_b32 v104, 0
v_mov_b32 v105, 0
v_mov_b32 v106, 0
v_mov_b32 v107, 0
v_mov_b32 v108, 0
v_mov_b32 v109, 0
v_mov_b32 v110, 0
v_mov_b32 v111, 0
v_mov_b32 v112, 0
v_mov_b32 v113, 0
v_mov_b32 v114, 0
v_mov_b32 v115, 0
v_mov_b32 v116, 0
v_mov_b32 v117, 0
v_mov_b32 v118, 0
v_mov_b32 v119, 0
s_nop 15
s_cmp_eq_u32 s47, 1
s_cbranch_scc1 mega_kernel_rs_p4_1
mega_kernel_rs_p4_0:
buffer_load_dwordx4 v[48:51], v25, s[84:87], s35 offen sc1
buffer_load_dwordx4 v[52:55], v26, s[84:87], s35 offen sc1
buffer_load_dwordx4 v[56:59], v27, s[84:87], s35 offen sc1
s_waitcnt vmcnt(12)
mega_kernel_rs_p4c_0:
v_bitop3_b32 v4, v48, v49, v50 bitop3:0xfe
v_bitop3_b32 v5, v54, v55, v56 bitop3:0xfe
v_bitop3_b32 v4, v4, v51, v52 bitop3:0xfe
v_bitop3_b32 v5, v5, v57, v58 bitop3:0xfe
v_bitop3_b32 v4, v4, v53, v59 bitop3:0xfe
v_bitop3_b32 v4, v4, v5, 1 bitop3:0xa8
v_cmp_ne_u32 vcc, 0, v4
s_cbranch_vccnz mega_kernel_rs_p4_0
v_pk_add_f32 v[120:121], v[120:121], v[48:49]
v_pk_add_f32 v[124:125], v[52:53], v[56:57]
v_pk_add_f32 v[122:123], v[122:123], v[50:51]
v_pk_add_f32 v[126:127], v[54:55], v[58:59]
v_pk_add_f32 v[120:121], v[120:121], v[124:125]
v_pk_add_f32 v[122:123], v[122:123], v[126:127]
v_cvt_pk_bf16_f32 v212, v120, v121
v_cvt_pk_bf16_f32 v213, v122, v123
v_min_u32 v212, -2, v212
buffer_store_dwordx2 v[212:213], v9, s[84:87], s34 offen sc1
s_branch mega_kernel_rs_p4d
mega_kernel_rs_p4_1:
buffer_load_dwordx4 v[48:51], v25, s[84:87], s35 offen sc1
buffer_load_dwordx4 v[52:55], v26, s[84:87], s35 offen sc1
buffer_load_dwordx4 v[56:59], v27, s[84:87], s35 offen sc1
s_waitcnt vmcnt(12)
mega_kernel_rs_p4c_1:
v_bitop3_b32 v4, v48, v49, v50 bitop3:0x80
v_bitop3_b32 v5, v54, v55, v56 bitop3:0x80
v_bitop3_b32 v4, v4, v51, v52 bitop3:0x80
v_bitop3_b32 v5, v5, v57, v58 bitop3:0x80
v_bitop3_b32 v4, v4, v53, v59 bitop3:0x80
v_bitop3_b32 v4, v4, v5, 1 bitop3:0x80
v_cmp_ne_u32 vcc, 1, v4
s_cbranch_vccnz mega_kernel_rs_p4_1
v_pk_add_f32 v[120:121], v[120:121], v[48:49]
v_pk_add_f32 v[124:125], v[52:53], v[56:57]
v_pk_add_f32 v[122:123], v[122:123], v[50:51]
v_pk_add_f32 v[126:127], v[54:55], v[58:59]
v_pk_add_f32 v[120:121], v[120:121], v[124:125]
v_pk_add_f32 v[122:123], v[122:123], v[126:127]
v_cvt_pk_bf16_f32 v212, v120, v121
v_cvt_pk_bf16_f32 v213, v122, v123
v_min_u32 v212, -2, v212
buffer_store_dwordx2 v[212:213], v9, s[84:87], s34 offen sc1
mega_kernel_rs_p4d:
mega_kernel_rs_b5:
s_add_u32 s27, s27, 1
s_add_u32 s44, s44, 4096
s_cmp_eq_u32 s44, 30720
s_cselect_b32 s44, 18432, s44
s_mov_b32 s28, s33
s_mov_b32 s33, s34
s_mov_b32 s34, s28
s_xor_b32 s35, s35, 262144
s_bfe_u32 s47, s27, 0x10001
s_barrier
s_nop 15
s_branch mega_kernel_rs_loop
mega_kernel_rs_x1:
s_cmp_eq_u32 s24, 1
s_cbranch_scc0 mega_kernel_rs_x2
s_add_u32 s76, s27, 1
v_mov_b32 v5, s76
s_mov_b64 exec, 1
buffer_store_dword v5, v228, s[84:87], s81 offen sc1
s_mov_b64 exec, -1
mega_kernel_rs_x2:
s_cmp_eq_u32 s24, 3
s_cbranch_scc0 mega_kernel_rs_x4
s_cmp_eq_u32 s36, 1
s_cbranch_scc0 mega_kernel_rs_x5
s_add_u32 s76, s27, 1
s_cmp_gt_i32 s46, s76
s_cbranch_scc1 mega_kernel_rs_pf1ok
mega_kernel_rs_pf1w:
v_mov_b32 v4, 0
s_mov_b64 exec, 3
buffer_atomic_add v4, v24, s[84:87], 0 offen sc0 sc1
s_mov_b64 exec, -1
s_waitcnt vmcnt(0)
v_readlane_b32 s46, v4, 0
v_readlane_b32 s28, v4, 1
s_nop 1
s_min_i32 s46, s46, s28
s_cmp_gt_i32 s46, s76
s_cbranch_scc0 mega_kernel_rs_pf1w
mega_kernel_rs_pf1ok:
s_add_u32 s77, s76, s82
s_bfe_u32 s28, s77, 0x40002
s_lshl_b32 s28, s28, 14
s_and_b32 s77, s77, 3
s_lshl_b32 s77, s77, 11
s_add_u32 s28, s28, s77
s_add_u32 m0, s45, 0
s_nop 0
buffer_load_dwordx4 v240, s[84:87], s28 offen offset:0 sc1 lds
s_add_u32 m0, s45, 0
s_nop 0
buffer_load_dwordx4 v240, s[84:87], s28 offen offset:1024 sc1 lds
s_add_u32 m0, s45, 2048
s_nop 0
buffer_load_dwordx4 v241, s[84:87], s28 offen offset:0 sc1 lds
s_add_u32 m0, s45, 2048
s_nop 0
buffer_load_dwordx4 v241, s[84:87], s28 offen offset:1024 sc1 lds
s_add_u32 s45, s45, 4096
s_cmp_eq_u32 s45, 30720
s_cselect_b32 s45, 18432, s45
s_waitcnt vmcnt(0)
mega_kernel_rs_x5:
s_add_u32 s76, s27, 4
s_min_u32 s76, s76, 63
s_cmp_gt_i32 s46, s76
s_cbranch_scc1 mega_kernel_rs_x6
v_mov_b32 v249, 0
s_mov_b64 exec, 3
buffer_atomic_add v249, v24, s[84:87], 0 offen sc0 sc1
s_mov_b64 exec, -1
mega_kernel_rs_x6:
s_add_u32 s76, s27, 2
s_cmp_lt_u32 s76, 63
s_cbranch_scc0 mega_kernel_rs_x4
s_cmp_gt_i32 s46, s76
s_cbranch_scc0 mega_kernel_rs_x4
s_add_u32 s77, s76, s82
s_bfe_u32 s28, s77, 0x40002
s_lshl_b32 s28, s28, 14
s_and_b32 s77, s77, 3
s_lshl_b32 s77, s77, 11
s_add_u32 s28, s28, s77
s_add_u32 s28, s28, s83
s_add_u32 s28, s28, 33554432
s_buffer_load_dword s78, s[84:87], s28 offset:0
s_buffer_load_dword s78, s[84:87], s28 offset:128
s_buffer_load_dword s78, s[84:87], s28 offset:256
s_buffer_load_dword s78, s[84:87], s28 offset:384
s_buffer_load_dword s78, s[84:87], s28 offset:512
s_buffer_load_dword s78, s[84:87], s28 offset:640
s_buffer_load_dword s78, s[84:87], s28 offset:768
s_buffer_load_dword s78, s[84:87], s28 offset:896
s_buffer_load_dword s78, s[84:87], s28 offset:1024
s_buffer_load_dword s78, s[84:87], s28 offset:1152
s_buffer_load_dword s78, s[84:87], s28 offset:1280
s_buffer_load_dword s78, s[84:87], s28 offset:1408
s_buffer_load_dword s78, s[84:87], s28 offset:1536
s_buffer_load_dword s78, s[84:87], s28 offset:1664
s_buffer_load_dword s78, s[84:87], s28 offset:1792
s_buffer_load_dword s78, s[84:87], s28 offset:1920
s_mov_b32 s89, s76
mega_kernel_rs_x4:
v_mov_b32 v96, 0
v_mov_b32 v97, 0
v_mov_b32 v98, 0
v_mov_b32 v99, 0
v_mov_b32 v100, 0
v_mov_b32 v101, 0
v_mov_b32 v102, 0
v_mov_b32 v103, 0
v_mov_b32 v104, 0
v_mov_b32 v105, 0
v_mov_b32 v106, 0
v_mov_b32 v107, 0
v_mov_b32 v108, 0
v_mov_b32 v109, 0
v_mov_b32 v110, 0
v_mov_b32 v111, 0
v_mov_b32 v112, 0
v_mov_b32 v113, 0
v_mov_b32 v114, 0
v_mov_b32 v115, 0
v_mov_b32 v116, 0
v_mov_b32 v117, 0
v_mov_b32 v118, 0
v_mov_b32 v119, 0
s_branch mega_kernel_rs_b5
mega_kernel_rs_p2r:
s_mov_b64 exec, s[42:43]
buffer_load_dwordx4 v[188:191], v10, s[84:87], s76 offen sc1
buffer_load_dwordx4 v[196:199], v10, s[84:87], s77 offen sc1
buffer_load_dwordx4 v[204:207], v10, s[84:87], s78 offen sc1
s_mov_b64 exec, -1
buffer_load_dwordx4 v[184:187], v17, s[84:87], s76 offen sc1
buffer_load_dwordx4 v[192:195], v17, s[84:87], s77 offen sc1
buffer_load_dwordx4 v[200:203], v17, s[84:87], s78 offen sc1
s_branch mega_kernel_rs_p2
mega_kernel_rs_pa_1_0f:
s_mov_b64 exec, vcc
buffer_load_dwordx4 v[32:35], v7, s[84:87], s33 offen offset:0 sc1
s_mov_b64 exec, -1
s_branch mega_kernel_rs_pa_1_0
mega_kernel_rs_pa_1_0:
s_waitcnt vmcnt(0)
v_max_u32 v4, v32, v34
v_cmp_eq_u32 vcc, -1, v4
s_cbranch_vccnz mega_kernel_rs_pa_1_0f
v_smfmac_f32_16x16x64_bf16 v[96:99], v[32:35], a[0:7], v6
v_smfmac_f32_16x16x64_bf16 v[100:103], v[32:35], a[32:39], v6
v_smfmac_f32_16x16x64_bf16 v[104:107], v[32:35], a[64:71], v6
v_smfmac_f32_16x16x64_bf16 v[108:111], v[32:35], a[96:103], v6
s_branch mega_kernel_rs_pa_d
mega_kernel_rs_pa_2_1f:
s_mov_b64 exec, vcc
buffer_load_dwordx4 v[36:39], v7, s[84:87], s33 offen offset:1024 sc1
s_mov_b64 exec, -1
s_branch mega_kernel_rs_pa_2_1
mega_kernel_rs_pa_2_1:
s_waitcnt vmcnt(0)
v_max_u32 v4, v36, v38
v_cmp_eq_u32 vcc, -1, v4
s_cbranch_vccnz mega_kernel_rs_pa_2_1f
v_smfmac_f32_16x16x64_bf16 v[96:99], v[36:39], a[8:15], v6
v_smfmac_f32_16x16x64_bf16 v[100:103], v[36:39], a[40:47], v6
v_smfmac_f32_16x16x64_bf16 v[104:107], v[36:39], a[72:79], v6
v_smfmac_f32_16x16x64_bf16 v[108:111], v[36:39], a[104:111], v6
s_branch mega_kernel_rs_pa_d
mega_kernel_rs_pa_3_0f:
s_mov_b64 exec, vcc
buffer_load_dwordx4 v[32:35], v7, s[84:87], s33 offen offset:0 sc1
s_mov_b64 exec, -1
s_branch mega_kernel_rs_pa_3_1
mega_kernel_rs_pa_3_0:
s_waitcnt vmcnt(1)
v_max_u32 v4, v32, v34
v_cmp_eq_u32 vcc, -1, v4
s_cbranch_vccnz mega_kernel_rs_pa_3_0f
v_smfmac_f32_16x16x64_bf16 v[96:99], v[32:35], a[0:7], v6
v_smfmac_f32_16x16x64_bf16 v[100:103], v[32:35], a[32:39], v6
v_smfmac_f32_16x16x64_bf16 v[104:107], v[32:35], a[64:71], v6
v_smfmac_f32_16x16x64_bf16 v[108:111], v[32:35], a[96:103], v6
s_branch mega_kernel_rs_pa_2_1
mega_kernel_rs_pa_3_1f:
s_mov_b64 exec, vcc
buffer_load_dwordx4 v[36:39], v7, s[84:87], s33 offen offset:1024 sc1
s_mov_b64 exec, -1
s_branch mega_kernel_rs_pa_3_0
mega_kernel_rs_pa_3_1:
s_waitcnt vmcnt(1)
v_max_u32 v4, v36, v38
v_cmp_eq_u32 vcc, -1, v4
s_cbranch_vccnz mega_kernel_rs_pa_3_1f
v_smfmac_f32_16x16x64_bf16 v[96:99], v[36:39], a[8:15], v6
v_smfmac_f32_16x16x64_bf16 v[100:103], v[36:39], a[40:47], v6
v_smfmac_f32_16x16x64_bf16 v[104:107], v[36:39], a[72:79], v6
v_smfmac_f32_16x16x64_bf16 v[108:111], v[36:39], a[104:111], v6
s_branch mega_kernel_rs_pa_1_0
mega_kernel_rs_pa_4_2f:
s_mov_b64 exec, vcc
buffer_load_dwordx4 v[40:43], v7, s[84:87], s33 offen offset:2048 sc1
s_mov_b64 exec, -1
s_branch mega_kernel_rs_pa_4_2
mega_kernel_rs_pa_4_2:
s_waitcnt vmcnt(0)
v_max_u32 v4, v40, v42
v_cmp_eq_u32 vcc, -1, v4
s_cbranch_vccnz mega_kernel_rs_pa_4_2f
v_smfmac_f32_16x16x64_bf16 v[96:99], v[40:43], a[16:23], v6
v_smfmac_f32_16x16x64_bf16 v[100:103], v[40:43], a[48:55], v6
v_smfmac_f32_16x16x64_bf16 v[104:107], v[40:43], a[80:87], v6
v_smfmac_f32_16x16x64_bf16 v[108:111], v[40:43], a[112:119], v6
s_branch mega_kernel_rs_pa_d
mega_kernel_rs_pa_5_0f:
s_mov_b64 exec, vcc
buffer_load_dwordx4 v[32:35], v7, s[84:87], s33 offen offset:0 sc1
s_mov_b64 exec, -1
s_branch mega_kernel_rs_pa_5_2
mega_kernel_rs_pa_5_0:
s_waitcnt vmcnt(1)
v_max_u32 v4, v32, v34
v_cmp_eq_u32 vcc, -1, v4
s_cbranch_vccnz mega_kernel_rs_pa_5_0f
v_smfmac_f32_16x16x64_bf16 v[96:99], v[32:35], a[0:7], v6
v_smfmac_f32_16x16x64_bf16 v[100:103], v[32:35], a[32:39], v6
v_smfmac_f32_16x16x64_bf16 v[104:107], v[32:35], a[64:71], v6
v_smfmac_f32_16x16x64_bf16 v[108:111], v[32:35], a[96:103], v6
s_branch mega_kernel_rs_pa_4_2
mega_kernel_rs_pa_5_2f:
s_mov_b64 exec, vcc
buffer_load_dwordx4 v[40:43], v7, s[84:87], s33 offen offset:2048 sc1
s_mov_b64 exec, -1
s_branch mega_kernel_rs_pa_5_0
mega_kernel_rs_pa_5_2:
s_waitcnt vmcnt(1)
v_max_u32 v4, v40, v42
v_cmp_eq_u32 vcc, -1, v4
s_cbranch_vccnz mega_kernel_rs_pa_5_2f
v_smfmac_f32_16x16x64_bf16 v[96:99], v[40:43], a[16:23], v6
v_smfmac_f32_16x16x64_bf16 v[100:103], v[40:43], a[48:55], v6
v_smfmac_f32_16x16x64_bf16 v[104:107], v[40:43], a[80:87], v6
v_smfmac_f32_16x16x64_bf16 v[108:111], v[40:43], a[112:119], v6
s_branch mega_kernel_rs_pa_1_0
mega_kernel_rs_pa_6_1f:
s_mov_b64 exec, vcc
buffer_load_dwordx4 v[36:39], v7, s[84:87], s33 offen offset:1024 sc1
s_mov_b64 exec, -1
s_branch mega_kernel_rs_pa_6_2
mega_kernel_rs_pa_6_1:
s_waitcnt vmcnt(1)
v_max_u32 v4, v36, v38
v_cmp_eq_u32 vcc, -1, v4
s_cbranch_vccnz mega_kernel_rs_pa_6_1f
v_smfmac_f32_16x16x64_bf16 v[96:99], v[36:39], a[8:15], v6
v_smfmac_f32_16x16x64_bf16 v[100:103], v[36:39], a[40:47], v6
v_smfmac_f32_16x16x64_bf16 v[104:107], v[36:39], a[72:79], v6
v_smfmac_f32_16x16x64_bf16 v[108:111], v[36:39], a[104:111], v6
s_branch mega_kernel_rs_pa_4_2
mega_kernel_rs_pa_6_2f:
s_mov_b64 exec, vcc
buffer_load_dwordx4 v[40:43], v7, s[84:87], s33 offen offset:2048 sc1
s_mov_b64 exec, -1
s_branch mega_kernel_rs_pa_6_1
mega_kernel_rs_pa_6_2:
s_waitcnt vmcnt(1)
v_max_u32 v4, v40, v42
v_cmp_eq_u32 vcc, -1, v4
s_cbranch_vccnz mega_kernel_rs_pa_6_2f
v_smfmac_f32_16x16x64_bf16 v[96:99], v[40:43], a[16:23], v6
v_smfmac_f32_16x16x64_bf16 v[100:103], v[40:43], a[48:55], v6
v_smfmac_f32_16x16x64_bf16 v[104:107], v[40:43], a[80:87], v6
v_smfmac_f32_16x16x64_bf16 v[108:111], v[40:43], a[112:119], v6
s_branch mega_kernel_rs_pa_2_1
mega_kernel_rs_pa_7_0f:
s_mov_b64 exec, vcc
buffer_load_dwordx4 v[32:35], v7, s[84:87], s33 offen offset:0 sc1
s_mov_b64 exec, -1
s_branch mega_kernel_rs_pa_7_1
mega_kernel_rs_pa_7_0:
s_waitcnt vmcnt(2)
v_max_u32 v4, v32, v34
v_cmp_eq_u32 vcc, -1, v4
s_cbranch_vccnz mega_kernel_rs_pa_7_0f
v_smfmac_f32_16x16x64_bf16 v[96:99], v[32:35], a[0:7], v6
v_smfmac_f32_16x16x64_bf16 v[100:103], v[32:35], a[32:39], v6
v_smfmac_f32_16x16x64_bf16 v[104:107], v[32:35], a[64:71], v6
v_smfmac_f32_16x16x64_bf16 v[108:111], v[32:35], a[96:103], v6
s_branch mega_kernel_rs_pa_6_1
mega_kernel_rs_pa_7_1f:
s_mov_b64 exec, vcc
buffer_load_dwordx4 v[36:39], v7, s[84:87], s33 offen offset:1024 sc1
s_mov_b64 exec, -1
s_branch mega_kernel_rs_pa_7_2
mega_kernel_rs_pa_7_1:
s_waitcnt vmcnt(2)
v_max_u32 v4, v36, v38
v_cmp_eq_u32 vcc, -1, v4
s_cbranch_vccnz mega_kernel_rs_pa_7_1f
v_smfmac_f32_16x16x64_bf16 v[96:99], v[36:39], a[8:15], v6
v_smfmac_f32_16x16x64_bf16 v[100:103], v[36:39], a[40:47], v6
v_smfmac_f32_16x16x64_bf16 v[104:107], v[36:39], a[72:79], v6
v_smfmac_f32_16x16x64_bf16 v[108:111], v[36:39], a[104:111], v6
s_branch mega_kernel_rs_pa_5_2
mega_kernel_rs_pa_7_2f:
s_mov_b64 exec, vcc
buffer_load_dwordx4 v[40:43], v7, s[84:87], s33 offen offset:2048 sc1
s_mov_b64 exec, -1
s_branch mega_kernel_rs_pa_7_0
mega_kernel_rs_pa_7_2:
s_waitcnt vmcnt(2)
v_max_u32 v4, v40, v42
v_cmp_eq_u32 vcc, -1, v4
s_cbranch_vccnz mega_kernel_rs_pa_7_2f
v_smfmac_f32_16x16x64_bf16 v[96:99], v[40:43], a[16:23], v6
v_smfmac_f32_16x16x64_bf16 v[100:103], v[40:43], a[48:55], v6
v_smfmac_f32_16x16x64_bf16 v[104:107], v[40:43], a[80:87], v6
v_smfmac_f32_16x16x64_bf16 v[108:111], v[40:43], a[112:119], v6
s_branch mega_kernel_rs_pa_3_0
mega_kernel_rs_pa_8_3f:
s_mov_b64 exec, vcc
buffer_load_dwordx4 v[44:47], v7, s[84:87], s33 offen offset:3072 sc1
s_mov_b64 exec, -1
s_branch mega_kernel_rs_pa_8_3
mega_kernel_rs_pa_8_3:
s_waitcnt vmcnt(0)
v_max_u32 v4, v44, v46
v_cmp_eq_u32 vcc, -1, v4
s_cbranch_vccnz mega_kernel_rs_pa_8_3f
v_smfmac_f32_16x16x64_bf16 v[96:99], v[44:47], a[24:31], v6
v_smfmac_f32_16x16x64_bf16 v[100:103], v[44:47], a[56:63], v6
v_smfmac_f32_16x16x64_bf16 v[104:107], v[44:47], a[88:95], v6
v_smfmac_f32_16x16x64_bf16 v[108:111], v[44:47], a[120:127], v6
s_branch mega_kernel_rs_pa_d
mega_kernel_rs_pa_9_0f:
s_mov_b64 exec, vcc
buffer_load_dwordx4 v[32:35], v7, s[84:87], s33 offen offset:0 sc1
s_mov_b64 exec, -1
s_branch mega_kernel_rs_pa_9_3
mega_kernel_rs_pa_9_0:
s_waitcnt vmcnt(1)
v_max_u32 v4, v32, v34
v_cmp_eq_u32 vcc, -1, v4
s_cbranch_vccnz mega_kernel_rs_pa_9_0f
v_smfmac_f32_16x16x64_bf16 v[96:99], v[32:35], a[0:7], v6
v_smfmac_f32_16x16x64_bf16 v[100:103], v[32:35], a[32:39], v6
v_smfmac_f32_16x16x64_bf16 v[104:107], v[32:35], a[64:71], v6
v_smfmac_f32_16x16x64_bf16 v[108:111], v[32:35], a[96:103], v6
s_branch mega_kernel_rs_pa_8_3
mega_kernel_rs_pa_9_3f:
s_mov_b64 exec, vcc
buffer_load_dwordx4 v[44:47], v7, s[84:87], s33 offen offset:3072 sc1
s_mov_b64 exec, -1
s_branch mega_kernel_rs_pa_9_0
mega_kernel_rs_pa_9_3:
s_waitcnt vmcnt(1)
v_max_u32 v4, v44, v46
v_cmp_eq_u32 vcc, -1, v4
s_cbranch_vccnz mega_kernel_rs_pa_9_3f
v_smfmac_f32_16x16x64_bf16 v[96:99], v[44:47], a[24:31], v6
v_smfmac_f32_16x16x64_bf16 v[100:103], v[44:47], a[56:63], v6
v_smfmac_f32_16x16x64_bf16 v[104:107], v[44:47], a[88:95], v6
v_smfmac_f32_16x16x64_bf16 v[108:111], v[44:47], a[120:127], v6
s_branch mega_kernel_rs_pa_1_0
mega_kernel_rs_pa_10_1f:
s_mov_b64 exec, vcc
buffer_load_dwordx4 v[36:39], v7, s[84:87], s33 offen offset:1024 sc1
s_mov_b64 exec, -1
s_branch mega_kernel_rs_pa_10_3
mega_kernel_rs_pa_10_1:
s_waitcnt vmcnt(1)
v_max_u32 v4, v36, v38
v_cmp_eq_u32 vcc, -1, v4
s_cbranch_vccnz mega_kernel_rs_pa_10_1f
v_smfmac_f32_16x16x64_bf16 v[96:99], v[36:39], a[8:15], v6
v_smfmac_f32_16x16x64_bf16 v[100:103], v[36:39], a[40:47], v6
v_smfmac_f32_16x16x64_bf16 v[104:107], v[36:39], a[72:79], v6
v_smfmac_f32_16x16x64_bf16 v[108:111], v[36:39], a[104:111], v6
s_branch mega_kernel_rs_pa_8_3
mega_kernel_rs_pa_10_3f:
s_mov_b64 exec, vcc
buffer_load_dwordx4 v[44:47], v7, s[84:87], s33 offen offset:3072 sc1
s_mov_b64 exec, -1
s_branch mega_kernel_rs_pa_10_1
mega_kernel_rs_pa_10_3:
s_waitcnt vmcnt(1)
v_max_u32 v4, v44, v46
v_cmp_eq_u32 vcc, -1, v4
s_cbranch_vccnz mega_kernel_rs_pa_10_3f
v_smfmac_f32_16x16x64_bf16 v[96:99], v[44:47], a[24:31], v6
v_smfmac_f32_16x16x64_bf16 v[100:103], v[44:47], a[56:63], v6
v_smfmac_f32_16x16x64_bf16 v[104:107], v[44:47], a[88:95], v6
v_smfmac_f32_16x16x64_bf16 v[108:111], v[44:47], a[120:127], v6
s_branch mega_kernel_rs_pa_2_1
mega_kernel_rs_pa_11_0f:
s_mov_b64 exec, vcc
buffer_load_dwordx4 v[32:35], v7, s[84:87], s33 offen offset:0 sc1
s_mov_b64 exec, -1
s_branch mega_kernel_rs_pa_11_1
mega_kernel_rs_pa_11_0:
s_waitcnt vmcnt(2)
v_max_u32 v4, v32, v34
v_cmp_eq_u32 vcc, -1, v4
s_cbranch_vccnz mega_kernel_rs_pa_11_0f
v_smfmac_f32_16x16x64_bf16 v[96:99], v[32:35], a[0:7], v6
v_smfmac_f32_16x16x64_bf16 v[100:103], v[32:35], a[32:39], v6
v_smfmac_f32_16x16x64_bf16 v[104:107], v[32:35], a[64:71], v6
v_smfmac_f32_16x16x64_bf16 v[108:111], v[32:35], a[96:103], v6
s_branch mega_kernel_rs_pa_10_1
mega_kernel_rs_pa_11_1f:
s_mov_b64 exec, vcc
buffer_load_dwordx4 v[36:39], v7, s[84:87], s33 offen offset:1024 sc1
s_mov_b64 exec, -1
s_branch mega_kernel_rs_pa_11_3
mega_kernel_rs_pa_11_1:
s_waitcnt vmcnt(2)
v_max_u32 v4, v36, v38
v_cmp_eq_u32 vcc, -1, v4
s_cbranch_vccnz mega_kernel_rs_pa_11_1f
v_smfmac_f32_16x16x64_bf16 v[96:99], v[36:39], a[8:15], v6
v_smfmac_f32_16x16x64_bf16 v[100:103], v[36:39], a[40:47], v6
v_smfmac_f32_16x16x64_bf16 v[104:107], v[36:39], a[72:79], v6
v_smfmac_f32_16x16x64_bf16 v[108:111], v[36:39], a[104:111], v6
s_branch mega_kernel_rs_pa_9_3
mega_kernel_rs_pa_11_3f:
s_mov_b64 exec, vcc
buffer_load_dwordx4 v[44:47], v7, s[84:87], s33 offen offset:3072 sc1
s_mov_b64 exec, -1
s_branch mega_kernel_rs_pa_11_0
mega_kernel_rs_pa_11_3:
s_waitcnt vmcnt(2)
v_max_u32 v4, v44, v46
v_cmp_eq_u32 vcc, -1, v4
s_cbranch_vccnz mega_kernel_rs_pa_11_3f
v_smfmac_f32_16x16x64_bf16 v[96:99], v[44:47], a[24:31], v6
v_smfmac_f32_16x16x64_bf16 v[100:103], v[44:47], a[56:63], v6
v_smfmac_f32_16x16x64_bf16 v[104:107], v[44:47], a[88:95], v6
v_smfmac_f32_16x16x64_bf16 v[108:111], v[44:47], a[120:127], v6
s_branch mega_kernel_rs_pa_3_0
mega_kernel_rs_pa_12_2f:
s_mov_b64 exec, vcc
buffer_load_dwordx4 v[40:43], v7, s[84:87], s33 offen offset:2048 sc1
s_mov_b64 exec, -1
s_branch mega_kernel_rs_pa_12_3
mega_kernel_rs_pa_12_2:
s_waitcnt vmcnt(1)
v_max_u32 v4, v40, v42
v_cmp_eq_u32 vcc, -1, v4
s_cbranch_vccnz mega_kernel_rs_pa_12_2f
v_smfmac_f32_16x16x64_bf16 v[96:99], v[40:43], a[16:23], v6
v_smfmac_f32_16x16x64_bf16 v[100:103], v[40:43], a[48:55], v6
v_smfmac_f32_16x16x64_bf16 v[104:107], v[40:43], a[80:87], v6
v_smfmac_f32_16x16x64_bf16 v[108:111], v[40:43], a[112:119], v6
s_branch mega_kernel_rs_pa_8_3
mega_kernel_rs_pa_12_3f:
s_mov_b64 exec, vcc
buffer_load_dwordx4 v[44:47], v7, s[84:87], s33 offen offset:3072 sc1
s_mov_b64 exec, -1
s_branch mega_kernel_rs_pa_12_2
mega_kernel_rs_pa_12_3:
s_waitcnt vmcnt(1)
v_max_u32 v4, v44, v46
v_cmp_eq_u32 vcc, -1, v4
s_cbranch_vccnz mega_kernel_rs_pa_12_3f
v_smfmac_f32_16x16x64_bf16 v[96:99], v[44:47], a[24:31], v6
v_smfmac_f32_16x16x64_bf16 v[100:103], v[44:47], a[56:63], v6
v_smfmac_f32_16x16x64_bf16 v[104:107], v[44:47], a[88:95], v6
v_smfmac_f32_16x16x64_bf16 v[108:111], v[44:47], a[120:127], v6
s_branch mega_kernel_rs_pa_4_2
mega_kernel_rs_pa_13_0f:
s_mov_b64 exec, vcc
buffer_load_dwordx4 v[32:35], v7, s[84:87], s33 offen offset:0 sc1
s_mov_b64 exec, -1
s_branch mega_kernel_rs_pa_13_2
mega_kernel_rs_pa_13_0:
s_waitcnt vmcnt(2)
v_max_u32 v4, v32, v34
v_cmp_eq_u32 vcc, -1, v4
s_cbranch_vccnz mega_kernel_rs_pa_13_0f
v_smfmac_f32_16x16x64_bf16 v[96:99], v[32:35], a[0:7], v6
v_smfmac_f32_16x16x64_bf16 v[100:103], v[32:35], a[32:39], v6
v_smfmac_f32_16x16x64_bf16 v[104:107], v[32:35], a[64:71], v6
v_smfmac_f32_16x16x64_bf16 v[108:111], v[32:35], a[96:103], v6
s_branch mega_kernel_rs_pa_12_2
mega_kernel_rs_pa_13_2f:
s_mov_b64 exec, vcc
buffer_load_dwordx4 v[40:43], v7, s[84:87], s33 offen offset:2048 sc1
s_mov_b64 exec, -1
s_branch mega_kernel_rs_pa_13_3
mega_kernel_rs_pa_13_2:
s_waitcnt vmcnt(2)
v_max_u32 v4, v40, v42
v_cmp_eq_u32 vcc, -1, v4
s_cbranch_vccnz mega_kernel_rs_pa_13_2f
v_smfmac_f32_16x16x64_bf16 v[96:99], v[40:43], a[16:23], v6
v_smfmac_f32_16x16x64_bf16 v[100:103], v[40:43], a[48:55], v6
v_smfmac_f32_16x16x64_bf16 v[104:107], v[40:43], a[80:87], v6
v_smfmac_f32_16x16x64_bf16 v[108:111], v[40:43], a[112:119], v6
s_branch mega_kernel_rs_pa_9_3
mega_kernel_rs_pa_13_3f:
s_mov_b64 exec, vcc
buffer_load_dwordx4 v[44:47], v7, s[84:87], s33 offen offset:3072 sc1
s_mov_b64 exec, -1
s_branch mega_kernel_rs_pa_13_0
mega_kernel_rs_pa_13_3:
s_waitcnt vmcnt(2)
v_max_u32 v4, v44, v46
v_cmp_eq_u32 vcc, -1, v4
s_cbranch_vccnz mega_kernel_rs_pa_13_3f
v_smfmac_f32_16x16x64_bf16 v[96:99], v[44:47], a[24:31], v6
v_smfmac_f32_16x16x64_bf16 v[100:103], v[44:47], a[56:63], v6
v_smfmac_f32_16x16x64_bf16 v[104:107], v[44:47], a[88:95], v6
v_smfmac_f32_16x16x64_bf16 v[108:111], v[44:47], a[120:127], v6
s_branch mega_kernel_rs_pa_5_0
mega_kernel_rs_pa_14_1f:
s_mov_b64 exec, vcc
buffer_load_dwordx4 v[36:39], v7, s[84:87], s33 offen offset:1024 sc1
s_mov_b64 exec, -1
s_branch mega_kernel_rs_pa_14_2
mega_kernel_rs_pa_14_1:
s_waitcnt vmcnt(2)
v_max_u32 v4, v36, v38
v_cmp_eq_u32 vcc, -1, v4
s_cbranch_vccnz mega_kernel_rs_pa_14_1f
v_smfmac_f32_16x16x64_bf16 v[96:99], v[36:39], a[8:15], v6
v_smfmac_f32_16x16x64_bf16 v[100:103], v[36:39], a[40:47], v6
v_smfmac_f32_16x16x64_bf16 v[104:107], v[36:39], a[72:79], v6
v_smfmac_f32_16x16x64_bf16 v[108:111], v[36:39], a[104:111], v6
s_branch mega_kernel_rs_pa_12_2
mega_kernel_rs_pa_14_2f:
s_mov_b64 exec, vcc
buffer_load_dwordx4 v[40:43], v7, s[84:87], s33 offen offset:2048 sc1
s_mov_b64 exec, -1
s_branch mega_kernel_rs_pa_14_3
mega_kernel_rs_pa_14_2:
s_waitcnt vmcnt(2)
v_max_u32 v4, v40, v42
v_cmp_eq_u32 vcc, -1, v4
s_cbranch_vccnz mega_kernel_rs_pa_14_2f
v_smfmac_f32_16x16x64_bf16 v[96:99], v[40:43], a[16:23], v6
v_smfmac_f32_16x16x64_bf16 v[100:103], v[40:43], a[48:55], v6
v_smfmac_f32_16x16x64_bf16 v[104:107], v[40:43], a[80:87], v6
v_smfmac_f32_16x16x64_bf16 v[108:111], v[40:43], a[112:119], v6
s_branch mega_kernel_rs_pa_10_3
mega_kernel_rs_pa_14_3f:
s_mov_b64 exec, vcc
buffer_load_dwordx4 v[44:47], v7, s[84:87], s33 offen offset:3072 sc1
s_mov_b64 exec, -1
s_branch mega_kernel_rs_pa_14_1
mega_kernel_rs_pa_14_3:
s_waitcnt vmcnt(2)
v_max_u32 v4, v44, v46
v_cmp_eq_u32 vcc, -1, v4
s_cbranch_vccnz mega_kernel_rs_pa_14_3f
v_smfmac_f32_16x16x64_bf16 v[96:99], v[44:47], a[24:31], v6
v_smfmac_f32_16x16x64_bf16 v[100:103], v[44:47], a[56:63], v6
v_smfmac_f32_16x16x64_bf16 v[104:107], v[44:47], a[88:95], v6
v_smfmac_f32_16x16x64_bf16 v[108:111], v[44:47], a[120:127], v6
s_branch mega_kernel_rs_pa_6_1
mega_kernel_rs_pa_15_0f:
s_mov_b64 exec, vcc
buffer_load_dwordx4 v[32:35], v7, s[84:87], s33 offen offset:0 sc1
s_mov_b64 exec, -1
s_branch mega_kernel_rs_pa_15_1
mega_kernel_rs_pa_15_0:
s_waitcnt vmcnt(3)
v_max_u32 v4, v32, v34
v_cmp_eq_u32 vcc, -1, v4
s_cbranch_vccnz mega_kernel_rs_pa_15_0f
v_smfmac_f32_16x16x64_bf16 v[96:99], v[32:35], a[0:7], v6
v_smfmac_f32_16x16x64_bf16 v[100:103], v[32:35], a[32:39], v6
v_smfmac_f32_16x16x64_bf16 v[104:107], v[32:35], a[64:71], v6
v_smfmac_f32_16x16x64_bf16 v[108:111], v[32:35], a[96:103], v6
s_branch mega_kernel_rs_pa_14_1
mega_kernel_rs_pa_15_1f:
s_mov_b64 exec, vcc
buffer_load_dwordx4 v[36:39], v7, s[84:87], s33 offen offset:1024 sc1
s_mov_b64 exec, -1
s_branch mega_kernel_rs_pa_15_2
mega_kernel_rs_pa_15_1:
s_waitcnt vmcnt(3)
v_max_u32 v4, v36, v38
v_cmp_eq_u32 vcc, -1, v4
s_cbranch_vccnz mega_kernel_rs_pa_15_1f
v_smfmac_f32_16x16x64_bf16 v[96:99], v[36:39], a[8:15], v6
v_smfmac_f32_16x16x64_bf16 v[100:103], v[36:39], a[40:47], v6
v_smfmac_f32_16x16x64_bf16 v[104:107], v[36:39], a[72:79], v6
v_smfmac_f32_16x16x64_bf16 v[108:111], v[36:39], a[104:111], v6
s_branch mega_kernel_rs_pa_13_2
mega_kernel_rs_pa_15_2f:
s_mov_b64 exec, vcc
buffer_load_dwordx4 v[40:43], v7, s[84:87], s33 offen offset:2048 sc1
s_mov_b64 exec, -1
s_branch mega_kernel_rs_pa_15_3
mega_kernel_rs_pa_15_2:
s_waitcnt vmcnt(3)
v_max_u32 v4, v40, v42
v_cmp_eq_u32 vcc, -1, v4
s_cbranch_vccnz mega_kernel_rs_pa_15_2f
v_smfmac_f32_16x16x64_bf16 v[96:99], v[40:43], a[16:23], v6
v_smfmac_f32_16x16x64_bf16 v[100:103], v[40:43], a[48:55], v6
v_smfmac_f32_16x16x64_bf16 v[104:107], v[40:43], a[80:87], v6
v_smfmac_f32_16x16x64_bf16 v[108:111], v[40:43], a[112:119], v6
s_branch mega_kernel_rs_pa_11_3
mega_kernel_rs_pa_15_3f:
s_mov_b64 exec, vcc
buffer_load_dwordx4 v[44:47], v7, s[84:87], s33 offen offset:3072 sc1
s_mov_b64 exec, -1
s_branch mega_kernel_rs_pa_15_0
mega_kernel_rs_pa_15_3:
s_waitcnt vmcnt(3)
v_max_u32 v4, v44, v46
v_cmp_eq_u32 vcc, -1, v4
s_cbranch_vccnz mega_kernel_rs_pa_15_3f
v_smfmac_f32_16x16x64_bf16 v[96:99], v[44:47], a[24:31], v6
v_smfmac_f32_16x16x64_bf16 v[100:103], v[44:47], a[56:63], v6
v_smfmac_f32_16x16x64_bf16 v[104:107], v[44:47], a[88:95], v6
v_smfmac_f32_16x16x64_bf16 v[108:111], v[44:47], a[120:127], v6
s_branch mega_kernel_rs_pa_7_0
mega_kernel_rs_pc_1_0f:
s_mov_b64 exec, vcc
buffer_load_dwordx4 v[32:35], v7, s[84:87], s29 offen offset:0 sc1
s_mov_b64 exec, -1
s_branch mega_kernel_rs_pc_1_0
mega_kernel_rs_pc_1_0:
s_waitcnt vmcnt(0)
v_cmp_eq_u32 vcc, -1, v32
s_cbranch_vccnz mega_kernel_rs_pc_1_0f
v_smfmac_f32_16x16x64_bf16 v[96:99], v[32:35], a[192:199], v6
v_smfmac_f32_16x16x64_bf16 v[100:103], v[32:35], a[224:231], v6
s_branch mega_kernel_rs_pc_d
mega_kernel_rs_pc_2_1f:
s_mov_b64 exec, vcc
buffer_load_dwordx4 v[36:39], v7, s[84:87], s29 offen offset:1024 sc1
s_mov_b64 exec, -1
s_branch mega_kernel_rs_pc_2_1
mega_kernel_rs_pc_2_1:
s_waitcnt vmcnt(0)
v_cmp_eq_u32 vcc, -1, v36
s_cbranch_vccnz mega_kernel_rs_pc_2_1f
v_smfmac_f32_16x16x64_bf16 v[96:99], v[36:39], a[200:207], v6
v_smfmac_f32_16x16x64_bf16 v[100:103], v[36:39], a[232:239], v6
s_branch mega_kernel_rs_pc_d
mega_kernel_rs_pc_3_0f:
s_mov_b64 exec, vcc
buffer_load_dwordx4 v[32:35], v7, s[84:87], s29 offen offset:0 sc1
s_mov_b64 exec, -1
s_branch mega_kernel_rs_pc_3_1
mega_kernel_rs_pc_3_0:
s_waitcnt vmcnt(1)
v_cmp_eq_u32 vcc, -1, v32
s_cbranch_vccnz mega_kernel_rs_pc_3_0f
v_smfmac_f32_16x16x64_bf16 v[96:99], v[32:35], a[192:199], v6
v_smfmac_f32_16x16x64_bf16 v[100:103], v[32:35], a[224:231], v6
s_branch mega_kernel_rs_pc_2_1
mega_kernel_rs_pc_3_1f:
s_mov_b64 exec, vcc
buffer_load_dwordx4 v[36:39], v7, s[84:87], s29 offen offset:1024 sc1
s_mov_b64 exec, -1
s_branch mega_kernel_rs_pc_3_0
mega_kernel_rs_pc_3_1:
s_waitcnt vmcnt(1)
v_cmp_eq_u32 vcc, -1, v36
s_cbranch_vccnz mega_kernel_rs_pc_3_1f
v_smfmac_f32_16x16x64_bf16 v[96:99], v[36:39], a[200:207], v6
v_smfmac_f32_16x16x64_bf16 v[100:103], v[36:39], a[232:239], v6
s_branch mega_kernel_rs_pc_1_0
mega_kernel_rs_pc_4_2f:
s_mov_b64 exec, vcc
buffer_load_dwordx4 v[40:43], v7, s[84:87], s29 offen offset:2048 sc1
s_mov_b64 exec, -1
s_branch mega_kernel_rs_pc_4_2
mega_kernel_rs_pc_4_2:
s_waitcnt vmcnt(0)
v_cmp_eq_u32 vcc, -1, v40
s_cbranch_vccnz mega_kernel_rs_pc_4_2f
v_smfmac_f32_16x16x64_bf16 v[96:99], v[40:43], a[208:215], v6
v_smfmac_f32_16x16x64_bf16 v[100:103], v[40:43], a[240:247], v6
s_branch mega_kernel_rs_pc_d
mega_kernel_rs_pc_5_0f:
s_mov_b64 exec, vcc
buffer_load_dwordx4 v[32:35], v7, s[84:87], s29 offen offset:0 sc1
s_mov_b64 exec, -1
s_branch mega_kernel_rs_pc_5_2
mega_kernel_rs_pc_5_0:
s_waitcnt vmcnt(1)
v_cmp_eq_u32 vcc, -1, v32
s_cbranch_vccnz mega_kernel_rs_pc_5_0f
v_smfmac_f32_16x16x64_bf16 v[96:99], v[32:35], a[192:199], v6
v_smfmac_f32_16x16x64_bf16 v[100:103], v[32:35], a[224:231], v6
s_branch mega_kernel_rs_pc_4_2
mega_kernel_rs_pc_5_2f:
s_mov_b64 exec, vcc
buffer_load_dwordx4 v[40:43], v7, s[84:87], s29 offen offset:2048 sc1
s_mov_b64 exec, -1
s_branch mega_kernel_rs_pc_5_0
mega_kernel_rs_pc_5_2:
s_waitcnt vmcnt(1)
v_cmp_eq_u32 vcc, -1, v40
s_cbranch_vccnz mega_kernel_rs_pc_5_2f
v_smfmac_f32_16x16x64_bf16 v[96:99], v[40:43], a[208:215], v6
v_smfmac_f32_16x16x64_bf16 v[100:103], v[40:43], a[240:247], v6
s_branch mega_kernel_rs_pc_1_0
mega_kernel_rs_pc_6_1f:
s_mov_b64 exec, vcc
buffer_load_dwordx4 v[36:39], v7, s[84:87], s29 offen offset:1024 sc1
s_mov_b64 exec, -1
s_branch mega_kernel_rs_pc_6_2
mega_kernel_rs_pc_6_1:
s_waitcnt vmcnt(1)
v_cmp_eq_u32 vcc, -1, v36
s_cbranch_vccnz mega_kernel_rs_pc_6_1f
v_smfmac_f32_16x16x64_bf16 v[96:99], v[36:39], a[200:207], v6
v_smfmac_f32_16x16x64_bf16 v[100:103], v[36:39], a[232:239], v6
s_branch mega_kernel_rs_pc_4_2
mega_kernel_rs_pc_6_2f:
s_mov_b64 exec, vcc
buffer_load_dwordx4 v[40:43], v7, s[84:87], s29 offen offset:2048 sc1
s_mov_b64 exec, -1
s_branch mega_kernel_rs_pc_6_1
mega_kernel_rs_pc_6_2:
s_waitcnt vmcnt(1)
v_cmp_eq_u32 vcc, -1, v40
s_cbranch_vccnz mega_kernel_rs_pc_6_2f
v_smfmac_f32_16x16x64_bf16 v[96:99], v[40:43], a[208:215], v6
v_smfmac_f32_16x16x64_bf16 v[100:103], v[40:43], a[240:247], v6
s_branch mega_kernel_rs_pc_2_1
mega_kernel_rs_pc_7_0f:
s_mov_b64 exec, vcc
buffer_load_dwordx4 v[32:35], v7, s[84:87], s29 offen offset:0 sc1
s_mov_b64 exec, -1
s_branch mega_kernel_rs_pc_7_1
mega_kernel_rs_pc_7_0:
s_waitcnt vmcnt(2)
v_cmp_eq_u32 vcc, -1, v32
s_cbranch_vccnz mega_kernel_rs_pc_7_0f
v_smfmac_f32_16x16x64_bf16 v[96:99], v[32:35], a[192:199], v6
v_smfmac_f32_16x16x64_bf16 v[100:103], v[32:35], a[224:231], v6
s_branch mega_kernel_rs_pc_6_1
mega_kernel_rs_pc_7_1f:
s_mov_b64 exec, vcc
buffer_load_dwordx4 v[36:39], v7, s[84:87], s29 offen offset:1024 sc1
s_mov_b64 exec, -1
s_branch mega_kernel_rs_pc_7_2
mega_kernel_rs_pc_7_1:
s_waitcnt vmcnt(2)
v_cmp_eq_u32 vcc, -1, v36
s_cbranch_vccnz mega_kernel_rs_pc_7_1f
v_smfmac_f32_16x16x64_bf16 v[96:99], v[36:39], a[200:207], v6
v_smfmac_f32_16x16x64_bf16 v[100:103], v[36:39], a[232:239], v6
s_branch mega_kernel_rs_pc_5_2
mega_kernel_rs_pc_7_2f:
s_mov_b64 exec, vcc
buffer_load_dwordx4 v[40:43], v7, s[84:87], s29 offen offset:2048 sc1
s_mov_b64 exec, -1
s_branch mega_kernel_rs_pc_7_0
mega_kernel_rs_pc_7_2:
s_waitcnt vmcnt(2)
v_cmp_eq_u32 vcc, -1, v40
s_cbranch_vccnz mega_kernel_rs_pc_7_2f
v_smfmac_f32_16x16x64_bf16 v[96:99], v[40:43], a[208:215], v6
v_smfmac_f32_16x16x64_bf16 v[100:103], v[40:43], a[240:247], v6
s_branch mega_kernel_rs_pc_3_0
mega_kernel_rs_pc_8_3f:
s_mov_b64 exec, vcc
buffer_load_dwordx4 v[44:47], v7, s[84:87], s29 offen offset:3072 sc1
s_mov_b64 exec, -1
s_branch mega_kernel_rs_pc_8_3
mega_kernel_rs_pc_9_0f:
s_mov_b64 exec, vcc
buffer_load_dwordx4 v[32:35], v7, s[84:87], s29 offen offset:0 sc1
s_mov_b64 exec, -1
s_branch mega_kernel_rs_pc_9_3
mega_kernel_rs_pc_9_0:
s_waitcnt vmcnt(1)
v_cmp_eq_u32 vcc, -1, v32
s_cbranch_vccnz mega_kernel_rs_pc_9_0f
v_smfmac_f32_16x16x64_bf16 v[96:99], v[32:35], a[192:199], v6
v_smfmac_f32_16x16x64_bf16 v[100:103], v[32:35], a[224:231], v6
s_branch mega_kernel_rs_pc_8_3
mega_kernel_rs_pc_9_3f:
s_mov_b64 exec, vcc
buffer_load_dwordx4 v[44:47], v7, s[84:87], s29 offen offset:3072 sc1
s_mov_b64 exec, -1
s_branch mega_kernel_rs_pc_9_0
mega_kernel_rs_pc_9_3:
s_waitcnt vmcnt(1)
v_cmp_eq_u32 vcc, -1, v44
s_cbranch_vccnz mega_kernel_rs_pc_9_3f
v_smfmac_f32_16x16x64_bf16 v[96:99], v[44:47], a[216:223], v6
v_smfmac_f32_16x16x64_bf16 v[100:103], v[44:47], a[248:255], v6
s_branch mega_kernel_rs_pc_1_0
mega_kernel_rs_pc_10_1f:
s_mov_b64 exec, vcc
buffer_load_dwordx4 v[36:39], v7, s[84:87], s29 offen offset:1024 sc1
s_mov_b64 exec, -1
s_branch mega_kernel_rs_pc_10_3
mega_kernel_rs_pc_10_1:
s_waitcnt vmcnt(1)
v_cmp_eq_u32 vcc, -1, v36
s_cbranch_vccnz mega_kernel_rs_pc_10_1f
v_smfmac_f32_16x16x64_bf16 v[96:99], v[36:39], a[200:207], v6
v_smfmac_f32_16x16x64_bf16 v[100:103], v[36:39], a[232:239], v6
s_branch mega_kernel_rs_pc_8_3
mega_kernel_rs_pc_10_3f:
s_mov_b64 exec, vcc
buffer_load_dwordx4 v[44:47], v7, s[84:87], s29 offen offset:3072 sc1
s_mov_b64 exec, -1
s_branch mega_kernel_rs_pc_10_1
mega_kernel_rs_pc_10_3:
s_waitcnt vmcnt(1)
v_cmp_eq_u32 vcc, -1, v44
s_cbranch_vccnz mega_kernel_rs_pc_10_3f
v_smfmac_f32_16x16x64_bf16 v[96:99], v[44:47], a[216:223], v6
v_smfmac_f32_16x16x64_bf16 v[100:103], v[44:47], a[248:255], v6
s_branch mega_kernel_rs_pc_2_1
mega_kernel_rs_pc_11_0f:
s_mov_b64 exec, vcc
buffer_load_dwordx4 v[32:35], v7, s[84:87], s29 offen offset:0 sc1
s_mov_b64 exec, -1
s_branch mega_kernel_rs_pc_11_1
mega_kernel_rs_pc_11_0:
s_waitcnt vmcnt(2)
v_cmp_eq_u32 vcc, -1, v32
s_cbranch_vccnz mega_kernel_rs_pc_11_0f
v_smfmac_f32_16x16x64_bf16 v[96:99], v[32:35], a[192:199], v6
v_smfmac_f32_16x16x64_bf16 v[100:103], v[32:35], a[224:231], v6
s_branch mega_kernel_rs_pc_10_1
mega_kernel_rs_pc_11_1f:
s_mov_b64 exec, vcc
buffer_load_dwordx4 v[36:39], v7, s[84:87], s29 offen offset:1024 sc1
s_mov_b64 exec, -1
s_branch mega_kernel_rs_pc_11_3
mega_kernel_rs_pc_11_1:
s_waitcnt vmcnt(2)
v_cmp_eq_u32 vcc, -1, v36
s_cbranch_vccnz mega_kernel_rs_pc_11_1f
v_smfmac_f32_16x16x64_bf16 v[96:99], v[36:39], a[200:207], v6
v_smfmac_f32_16x16x64_bf16 v[100:103], v[36:39], a[232:239], v6
s_branch mega_kernel_rs_pc_9_3
mega_kernel_rs_pc_11_3f:
s_mov_b64 exec, vcc
buffer_load_dwordx4 v[44:47], v7, s[84:87], s29 offen offset:3072 sc1
s_mov_b64 exec, -1
s_branch mega_kernel_rs_pc_11_0
mega_kernel_rs_pc_11_3:
s_waitcnt vmcnt(2)
v_cmp_eq_u32 vcc, -1, v44
s_cbranch_vccnz mega_kernel_rs_pc_11_3f
v_smfmac_f32_16x16x64_bf16 v[96:99], v[44:47], a[216:223], v6
v_smfmac_f32_16x16x64_bf16 v[100:103], v[44:47], a[248:255], v6
s_branch mega_kernel_rs_pc_3_0
mega_kernel_rs_pc_12_2f:
s_mov_b64 exec, vcc
buffer_load_dwordx4 v[40:43], v7, s[84:87], s29 offen offset:2048 sc1
s_mov_b64 exec, -1
s_branch mega_kernel_rs_pc_12_3
mega_kernel_rs_pc_12_3f:
s_mov_b64 exec, vcc
buffer_load_dwordx4 v[44:47], v7, s[84:87], s29 offen offset:3072 sc1
s_mov_b64 exec, -1
s_branch mega_kernel_rs_pc_12_2
mega_kernel_rs_pc_12_3:
s_waitcnt vmcnt(1)
v_cmp_eq_u32 vcc, -1, v44
s_cbranch_vccnz mega_kernel_rs_pc_12_3f
v_smfmac_f32_16x16x64_bf16 v[96:99], v[44:47], a[216:223], v6
v_smfmac_f32_16x16x64_bf16 v[100:103], v[44:47], a[248:255], v6
s_branch mega_kernel_rs_pc_4_2
mega_kernel_rs_pc_13_0f:
s_mov_b64 exec, vcc
buffer_load_dwordx4 v[32:35], v7, s[84:87], s29 offen offset:0 sc1
s_mov_b64 exec, -1
s_branch mega_kernel_rs_pc_13_2
mega_kernel_rs_pc_13_0:
s_waitcnt vmcnt(2)
v_cmp_eq_u32 vcc, -1, v32
s_cbranch_vccnz mega_kernel_rs_pc_13_0f
v_smfmac_f32_16x16x64_bf16 v[96:99], v[32:35], a[192:199], v6
v_smfmac_f32_16x16x64_bf16 v[100:103], v[32:35], a[224:231], v6
s_branch mega_kernel_rs_pc_12_2
mega_kernel_rs_pc_13_2f:
s_mov_b64 exec, vcc
buffer_load_dwordx4 v[40:43], v7, s[84:87], s29 offen offset:2048 sc1
s_mov_b64 exec, -1
s_branch mega_kernel_rs_pc_13_3
mega_kernel_rs_pc_13_2:
s_waitcnt vmcnt(2)
v_cmp_eq_u32 vcc, -1, v40
s_cbranch_vccnz mega_kernel_rs_pc_13_2f
v_smfmac_f32_16x16x64_bf16 v[96:99], v[40:43], a[208:215], v6
v_smfmac_f32_16x16x64_bf16 v[100:103], v[40:43], a[240:247], v6
s_branch mega_kernel_rs_pc_9_3
mega_kernel_rs_pc_13_3f:
s_mov_b64 exec, vcc
buffer_load_dwordx4 v[44:47], v7, s[84:87], s29 offen offset:3072 sc1
s_mov_b64 exec, -1
s_branch mega_kernel_rs_pc_13_0
mega_kernel_rs_pc_13_3:
s_waitcnt vmcnt(2)
v_cmp_eq_u32 vcc, -1, v44
s_cbranch_vccnz mega_kernel_rs_pc_13_3f
v_smfmac_f32_16x16x64_bf16 v[96:99], v[44:47], a[216:223], v6
v_smfmac_f32_16x16x64_bf16 v[100:103], v[44:47], a[248:255], v6
s_branch mega_kernel_rs_pc_5_0
mega_kernel_rs_pc_14_1f:
s_mov_b64 exec, vcc
buffer_load_dwordx4 v[36:39], v7, s[84:87], s29 offen offset:1024 sc1
s_mov_b64 exec, -1
s_branch mega_kernel_rs_pc_14_2
mega_kernel_rs_pc_14_2f:
s_mov_b64 exec, vcc
buffer_load_dwordx4 v[40:43], v7, s[84:87], s29 offen offset:2048 sc1
s_mov_b64 exec, -1
s_branch mega_kernel_rs_pc_14_3
mega_kernel_rs_pc_14_2:
s_waitcnt vmcnt(2)
v_cmp_eq_u32 vcc, -1, v40
s_cbranch_vccnz mega_kernel_rs_pc_14_2f
v_smfmac_f32_16x16x64_bf16 v[96:99], v[40:43], a[208:215], v6
v_smfmac_f32_16x16x64_bf16 v[100:103], v[40:43], a[240:247], v6
s_branch mega_kernel_rs_pc_10_3
mega_kernel_rs_pc_14_3f:
s_mov_b64 exec, vcc
buffer_load_dwordx4 v[44:47], v7, s[84:87], s29 offen offset:3072 sc1
s_mov_b64 exec, -1
s_branch mega_kernel_rs_pc_14_1
mega_kernel_rs_pc_14_3:
s_waitcnt vmcnt(2)
v_cmp_eq_u32 vcc, -1, v44
s_cbranch_vccnz mega_kernel_rs_pc_14_3f
v_smfmac_f32_16x16x64_bf16 v[96:99], v[44:47], a[216:223], v6
v_smfmac_f32_16x16x64_bf16 v[100:103], v[44:47], a[248:255], v6
s_branch mega_kernel_rs_pc_6_1
mega_kernel_rs_pc_15_0f:
s_mov_b64 exec, vcc
buffer_load_dwordx4 v[32:35], v7, s[84:87], s29 offen offset:0 sc1
s_mov_b64 exec, -1
s_branch mega_kernel_rs_pc_15_1
mega_kernel_rs_pc_15_1f:
s_mov_b64 exec, vcc
buffer_load_dwordx4 v[36:39], v7, s[84:87], s29 offen offset:1024 sc1
s_mov_b64 exec, -1
s_branch mega_kernel_rs_pc_15_2
mega_kernel_rs_pc_15_1:
s_waitcnt vmcnt(3)
v_cmp_eq_u32 vcc, -1, v36
s_cbranch_vccnz mega_kernel_rs_pc_15_1f
v_smfmac_f32_16x16x64_bf16 v[96:99], v[36:39], a[200:207], v6
v_smfmac_f32_16x16x64_bf16 v[100:103], v[36:39], a[232:239], v6
s_branch mega_kernel_rs_pc_13_2
mega_kernel_rs_pc_15_2f:
s_mov_b64 exec, vcc
buffer_load_dwordx4 v[40:43], v7, s[84:87], s29 offen offset:2048 sc1
s_mov_b64 exec, -1
s_branch mega_kernel_rs_pc_15_3
mega_kernel_rs_pc_15_2:
s_waitcnt vmcnt(3)
v_cmp_eq_u32 vcc, -1, v40
s_cbranch_vccnz mega_kernel_rs_pc_15_2f
v_smfmac_f32_16x16x64_bf16 v[96:99], v[40:43], a[208:215], v6
v_smfmac_f32_16x16x64_bf16 v[100:103], v[40:43], a[240:247], v6
s_branch mega_kernel_rs_pc_11_3
mega_kernel_rs_pc_15_3f:
s_mov_b64 exec, vcc
buffer_load_dwordx4 v[44:47], v7, s[84:87], s29 offen offset:3072 sc1
s_mov_b64 exec, -1
s_branch mega_kernel_rs_pc_15_0
mega_kernel_rs_pc_15_3:
s_waitcnt vmcnt(3)
v_cmp_eq_u32 vcc, -1, v44
s_cbranch_vccnz mega_kernel_rs_pc_15_3f
v_smfmac_f32_16x16x64_bf16 v[96:99], v[44:47], a[216:223], v6
v_smfmac_f32_16x16x64_bf16 v[100:103], v[44:47], a[248:255], v6
s_branch mega_kernel_rs_pc_7_0
mega_kernel_rs_w0last:
s_nop 7
v_permlane32_swap_b32 v112, v116
v_permlane32_swap_b32 v113, v117
v_permlane32_swap_b32 v114, v118
v_permlane32_swap_b32 v115, v119
v_pk_add_f32 v[112:113], v[112:113], v[116:117]
v_pk_add_f32 v[114:115], v[114:115], v[118:119]
ds_write_b128 v20, v[112:115]
s_waitcnt lgkmcnt(0)
s_barrier
s_branch mega_kernel_rs_end
mega_kernel_rs_side:
s_cmp_eq_u32 s24, 3
s_cbranch_scc1 mega_kernel_rs_sd3
s_cmp_eq_u32 s24, 2
s_cbranch_scc0 mega_kernel_rs_sd4
s_mov_b64 exec, s[40:41]
buffer_store_dwordx4 v[28:31], v11, s[84:87], s34 offen sc1
s_mov_b64 exec, -1
buffer_store_dwordx2 v[28:29], v9, s[84:87], s34 offen sc1
s_mul_i32 s28, s31, 2048
s_add_u32 s28, s28, s34
s_add_u32 s28, s28, 49152
buffer_store_dwordx4 v[28:31], v17, s[84:87], s28 offen sc1
buffer_store_dwordx4 v[28:31], v10, s[84:87], s28 offen sc1
s_branch mega_kernel_rs_sd4
mega_kernel_rs_sd3:
v_readlane_b32 s76, v249, 0
v_readlane_b32 s77, v249, 1
s_min_i32 s76, s76, s77
s_max_i32 s46, s46, s76
s_mov_b32 s36, 0
s_add_u32 s76, s27, 1
s_cmp_lt_u32 s76, 63
s_cbranch_scc0 mega_kernel_rs_sd4
s_cmp_ge_u32 s76, 0
s_cbranch_scc0 mega_kernel_rs_sd4
s_cmp_gt_i32 s46, s76
s_cselect_b32 s36, 0, 1
s_cbranch_scc0 mega_kernel_rs_sd4
s_add_u32 s77, s76, s82
s_bfe_u32 s28, s77, 0x40002
s_lshl_b32 s28, s28, 14
s_and_b32 s77, s77, 3
s_lshl_b32 s77, s77, 11
s_add_u32 s28, s28, s77
s_add_u32 m0, s45, 0
s_nop 0
buffer_load_dwordx4 v240, s[84:87], s28 offen offset:0 sc1 lds
s_add_u32 m0, s45, 0
s_nop 0
buffer_load_dwordx4 v240, s[84:87], s28 offen offset:1024 sc1 lds
s_add_u32 m0, s45, 2048
s_nop 0
buffer_load_dwordx4 v241, s[84:87], s28 offen offset:0 sc1 lds
s_add_u32 m0, s45, 2048
s_nop 0
buffer_load_dwordx4 v241, s[84:87], s28 offen offset:1024 sc1 lds
s_add_u32 s45, s45, 4096
s_cmp_eq_u32 s45, 30720
s_cselect_b32 s45, 18432, s45
mega_kernel_rs_sd4:
v_smfmac_f32_16x16x64_bf16 v[112:115], v[40:43], a[144:151], v6
v_smfmac_f32_16x16x64_bf16 v[116:119], v[40:43], a[176:183], v6
v_smfmac_f32_16x16x64_bf16 v[112:115], v[44:47], a[152:159], v6
v_smfmac_f32_16x16x64_bf16 v[116:119], v[44:47], a[184:191], v6
s_nop 7
v_permlane32_swap_b32 v112, v116
v_permlane32_swap_b32 v113, v117
v_permlane32_swap_b32 v114, v118
v_permlane32_swap_b32 v115, v119
v_pk_add_f32 v[112:113], v[112:113], v[116:117]
v_pk_add_f32 v[114:115], v[114:115], v[118:119]
ds_write_b128 v20, v[112:115]
v_mov_b32 v96, 0
v_mov_b32 v97, 0
v_mov_b32 v98, 0
v_mov_b32 v99, 0
v_mov_b32 v100, 0
v_mov_b32 v101, 0
v_mov_b32 v102, 0
v_mov_b32 v103, 0
s_cmp_eq_u32 s24, 1
s_cbranch_scc0 mega_kernel_rs_s1
s_waitcnt lgkmcnt(0)
ds_read_b128 v[120:123], v16 offset:0
ds_read_b128 v[124:127], v16 offset:16
ds_read_b128 v[128:131], v16 offset:2304
ds_read_b128 v[132:135], v16 offset:2320
ds_read_b128 v[136:139], v16 offset:4608
ds_read_b128 v[140:143], v16 offset:4624
ds_read_b128 v[144:147], v16 offset:6912
ds_read_b128 v[148:151], v16 offset:6928
s_waitcnt lgkmcnt(4)
v_pk_add_f32 v[120:121], v[120:121], v[128:129]
v_pk_add_f32 v[122:123], v[122:123], v[130:131]
v_pk_add_f32 v[124:125], v[124:125], v[132:133]
v_pk_add_f32 v[126:127], v[126:127], v[134:135]
s_waitcnt lgkmcnt(0)
v_pk_add_f32 v[136:137], v[136:137], v[144:145]
v_pk_add_f32 v[138:139], v[138:139], v[146:147]
v_pk_add_f32 v[140:141], v[140:141], v[148:149]
v_pk_add_f32 v[142:143], v[142:143], v[150:151]
v_pk_add_f32 v[120:121], v[120:121], v[136:137]
v_pk_add_f32 v[122:123], v[122:123], v[138:139]
v_pk_add_f32 v[124:125], v[124:125], v[140:141]
v_pk_add_f32 v[126:127], v[126:127], v[142:143]
v_cvt_pk_bf16_f32 v244, v120, v121
v_cvt_pk_bf16_f32 v245, v122, v123
v_cvt_pk_bf16_f32 v246, v124, v125
v_cvt_pk_bf16_f32 v247, v126, v127
mega_kernel_rs_s1:
v_add_u32 v5, 9216, v17
s_waitcnt lgkmcnt(0)
s_barrier
s_cmp_eq_u32 s24, 2
s_cbranch_scc1 mega_kernel_rs_s2
s_cmp_eq_u32 s24, 3
s_cbranch_scc0 mega_kernel_rs_s3
s_add_u32 s76, s27, 2
s_cmp_lt_u32 s76, 63
s_cbranch_scc0 mega_kernel_rs_s3
s_cmp_gt_i32 s46, s76
s_cbranch_scc0 mega_kernel_rs_s3
s_add_u32 s77, s76, s82
s_bfe_u32 s28, s77, 0x40002
s_lshl_b32 s28, s28, 14
s_and_b32 s77, s77, 3
s_lshl_b32 s77, s77, 11
s_add_u32 s28, s28, s77
s_add_u32 s28, s28, s83
s_buffer_load_dword s78, s[84:87], s28 offset:0
s_buffer_load_dword s78, s[84:87], s28 offset:128
s_buffer_load_dword s78, s[84:87], s28 offset:256
s_buffer_load_dword s78, s[84:87], s28 offset:384
s_buffer_load_dword s78, s[84:87], s28 offset:512
s_buffer_load_dword s78, s[84:87], s28 offset:640
s_buffer_load_dword s78, s[84:87], s28 offset:768
s_buffer_load_dword s78, s[84:87], s28 offset:896
s_buffer_load_dword s78, s[84:87], s28 offset:1024
s_buffer_load_dword s78, s[84:87], s28 offset:1152
s_buffer_load_dword s78, s[84:87], s28 offset:1280
s_buffer_load_dword s78, s[84:87], s28 offset:1408
s_buffer_load_dword s78, s[84:87], s28 offset:1536
s_buffer_load_dword s78, s[84:87], s28 offset:1664
s_buffer_load_dword s78, s[84:87], s28 offset:1792
s_buffer_load_dword s78, s[84:87], s28 offset:1920
s_mov_b32 s88, s76
s_branch mega_kernel_rs_s3
mega_kernel_rs_s2:
ds_read_b128 v[120:123], v5 offset:0
ds_read_b128 v[124:127], v5 offset:1024
ds_read_b128 v[128:131], v5 offset:2048
ds_read_b128 v[132:135], v5 offset:3072
v_lshrrev_b32 v5, 1, v17
s_waitcnt lgkmcnt(2)
v_pk_add_f32 v[120:121], v[120:121], v[124:125]
v_pk_add_f32 v[122:123], v[122:123], v[126:127]
s_waitcnt lgkmcnt(0)
v_pk_add_f32 v[128:129], v[128:129], v[132:133]
v_pk_add_f32 v[130:131], v[130:131], v[134:135]
v_pk_add_f32 v[120:121], v[120:121], v[128:129]
v_pk_add_f32 v[122:123], v[122:123], v[130:131]
v_cvt_pk_bf16_f32 v244, v120, v121
v_cvt_pk_bf16_f32 v245, v122, v123
ds_write_b64 v5, v[244:245] offset:17920
s_waitcnt lgkmcnt(0) vmcnt(0)
mega_kernel_rs_s3:
s_cmp_eq_u32 s27, 63
s_cbranch_scc1 mega_kernel_rs_slast
s_add_u32 s29, s33, 24576
s_barrier
s_cmp_eq_u32 s24, 3
s_cbranch_scc1 mega_kernel_rs_y3
s_add_u32 s77, s27, s82
s_bfe_u32 s28, s77, 0x30003
s_lshl_b32 s28, s28, 14
s_and_b32 s77, s77, 7
s_lshl_b32 s77, s77, 10
s_add_u32 s28, s28, s77
s_add_u32 s28, s28, s79
s_cmp_eq_u32 s24, 2
s_cbranch_scc1 mega_kernel_rs_kv2a
s_mov_b64 exec, s[48:49]
buffer_store_dwordx4 v[244:247], v22, s[84:87], s28 offen sc1
s_mov_b64 exec, -1
s_branch mega_kernel_rs_kvda
mega_kernel_rs_kv2a:
v_lshlrev_b32 v4, 3, v1
buffer_store_dwordx2 v[244:245], v4, s[84:87], s28 offen offset:512 sc1
mega_kernel_rs_kvda:
s_branch mega_kernel_rs_y4
mega_kernel_rs_y3:
s_add_u32 s76, s27, 2
s_cmp_lt_u32 s76, 63
s_cbranch_scc0 mega_kernel_rs_y4
mega_kernel_rs_y4:
s_branch mega_kernel_rs_b3
mega_kernel_rs_first:
buffer_load_dwordx4 v[32:35], v8, s[20:23], 0 offen offset:0
buffer_load_dwordx4 v[36:39], v8, s[20:23], 0 offen offset:128
buffer_load_dwordx4 v[40:43], v8, s[20:23], 0 offen offset:256
buffer_load_dwordx4 v[44:47], v8, s[20:23], 0 offen offset:384
v_add_u32 v5, s44, v17
ds_read_b128 v[156:159], v5 offset:0
ds_read_b128 v[160:163], v5 offset:1024
ds_read_b128 v[164:167], v5 offset:2048
ds_read_b128 v[168:171], v5 offset:3072
s_waitcnt vmcnt(0)
v_smfmac_f32_16x16x64_bf16 v[96:99], v[32:35], a[0:7], v6
v_smfmac_f32_16x16x64_bf16 v[100:103], v[32:35], a[32:39], v6
v_smfmac_f32_16x16x64_bf16 v[104:107], v[32:35], a[64:71], v6
v_smfmac_f32_16x16x64_bf16 v[108:111], v[32:35], a[96:103], v6
v_smfmac_f32_16x16x64_bf16 v[96:99], v[36:39], a[8:15], v6
v_smfmac_f32_16x16x64_bf16 v[100:103], v[36:39], a[40:47], v6
v_smfmac_f32_16x16x64_bf16 v[104:107], v[36:39], a[72:79], v6
v_smfmac_f32_16x16x64_bf16 v[108:111], v[36:39], a[104:111], v6
v_smfmac_f32_16x16x64_bf16 v[96:99], v[40:43], a[16:23], v6
v_smfmac_f32_16x16x64_bf16 v[100:103], v[40:43], a[48:55], v6
v_smfmac_f32_16x16x64_bf16 v[104:107], v[40:43], a[80:87], v6
v_smfmac_f32_16x16x64_bf16 v[108:111], v[40:43], a[112:119], v6
v_smfmac_f32_16x16x64_bf16 v[96:99], v[44:47], a[24:31], v6
v_smfmac_f32_16x16x64_bf16 v[100:103], v[44:47], a[56:63], v6
v_smfmac_f32_16x16x64_bf16 v[104:107], v[44:47], a[88:95], v6
v_smfmac_f32_16x16x64_bf16 v[108:111], v[44:47], a[120:127], v6
s_nop 1
s_branch mega_kernel_rs_adone
mega_kernel_rs_slast:
s_cmp_eq_u32 s24, 3
s_cbranch_scc1 mega_kernel_rs_end
s_add_u32 s77, s27, s82
s_bfe_u32 s28, s77, 0x30003
s_lshl_b32 s28, s28, 14
s_and_b32 s77, s77, 7
s_lshl_b32 s77, s77, 10
s_add_u32 s28, s28, s77
s_add_u32 s28, s28, s79
s_cmp_eq_u32 s24, 2
s_cbranch_scc1 mega_kernel_rs_kv2b
s_mov_b64 exec, s[48:49]
buffer_store_dwordx4 v[244:247], v22, s[84:87], s28 offen sc1
s_mov_b64 exec, -1
s_branch mega_kernel_rs_kvdb
mega_kernel_rs_kv2b:
v_lshlrev_b32 v4, 3, v1
buffer_store_dwordx2 v[244:245], v4, s[84:87], s28 offen offset:512 sc1
mega_kernel_rs_kvdb:
s_waitcnt vmcnt(0)
s_barrier
s_mov_b32 s76, 64
s_cmp_eq_u32 s24, 1
s_cbranch_scc0 mega_kernel_rs_end
v_mov_b32 v5, s76
s_mov_b64 exec, 1
buffer_store_dword v5, v228, s[84:87], s81 offen sc1
s_mov_b64 exec, -1
mega_kernel_rs_end:
s_endpgm
.section .rodata,"a"
.p2align 6
.amdhsa_kernel mega_kernel
  .amdhsa_next_free_vgpr 512
  .amdhsa_next_free_sgpr 102
  .amdhsa_accum_offset 256
  .amdhsa_group_segment_fixed_size 0
  .amdhsa_kernarg_size 104
  .amdhsa_user_sgpr_count 2
  .amdhsa_user_sgpr_kernarg_segment_ptr 1
  .amdhsa_system_sgpr_workgroup_id_x 1
.end_amdhsa_kernel
```

```asm
; @launch kernel=mega_kernel grid=(256,1,1) block=(256,1,1) lds=163840
.amdgcn_target "amdgcn-amd-amdhsa--gfx950"
.text
.globl mega_kernel
.p2align 8
.type mega_kernel,@function
mega_kernel:
s_cmp_ge_u32 s2, 256
s_cbranch_scc1 mega_kernel_exit
s_load_dwordx2 s[84:85], s[0:1], 96
s_load_dwordx2 s[72:73], s[0:1], 88
s_getreg_b32 s90, hwreg(HW_REG_XCC_ID)
s_and_b32 s90, s90, 7
v_mov_b32 v1, 0
v_mov_b32 v2, 1
s_lshl_b32 s91, s90, 4
s_mov_b32 s95, 0
s_mov_b32 s99, 0
s_waitcnt lgkmcnt(0)
s_mov_b32 s86, 268435456
s_mov_b32 s87, 0x00020000
s_mov_b32 s74, 256
s_mov_b32 s75, 0x00020000
v_cmp_eq_u32 vcc, 0, v0
s_and_saveexec_b64 s[88:89], vcc
s_cbranch_execz mega_kernel_tkd
s_lshl_b32 s92, s2, 13
s_add_u32 s92, s92, 167772160
buffer_atomic_add v2, v1, s[72:75], s91 offen sc0
buffer_load_dword v251, v1, s[84:87], s92 offen offset:2048 sc1
s_waitcnt vmcnt(1)
ds_write_b32 v1, v2
s_waitcnt lgkmcnt(0)
mega_kernel_tkd:
s_mov_b64 exec, s[88:89]
s_barrier
ds_read_b32 v2, v1
s_waitcnt lgkmcnt(0)
v_readfirstlane_b32 s96, v2
s_barrier
s_cmp_lt_u32 s96, 32
s_cbranch_scc1 mega_kernel_spec
v_and_b32 v3, 15, v0
v_lshlrev_b32 v3, 4, v3
s_branch mega_kernel_syx
mega_kernel_syxw:
s_sleep 4
mega_kernel_syx:
buffer_load_dword v2, v3, s[72:75], 0 offen sc1
s_waitcnt vmcnt(0)
mega_kernel_syxp:
s_cmp_eq_u32 s95, 1
s_cbranch_scc0 mega_kernel_syxf
v_readlane_b32 s76, v2, 14
s_mov_b32 s98, 0
s_cmp_eq_u32 s76, 32
s_cbranch_scc0 mega_kernel_syxw
s_branch mega_kernel_syxd
mega_kernel_syxf:
s_mov_b32 s77, 0
s_mov_b32 s78, 0
v_readlane_b32 s76, v2, 0
s_add_u32 s77, s77, s76
s_xor_b32 s76, s76, 32
s_or_b32 s78, s78, s76
v_readlane_b32 s76, v2, 1
s_add_u32 s77, s77, s76
s_xor_b32 s76, s76, 32
s_or_b32 s78, s78, s76
v_readlane_b32 s76, v2, 2
s_add_u32 s77, s77, s76
s_xor_b32 s76, s76, 32
s_or_b32 s78, s78, s76
v_readlane_b32 s76, v2, 3
s_add_u32 s77, s77, s76
s_xor_b32 s76, s76, 32
s_or_b32 s78, s78, s76
v_readlane_b32 s76, v2, 4
s_add_u32 s77, s77, s76
s_xor_b32 s76, s76, 32
s_or_b32 s78, s78, s76
v_readlane_b32 s76, v2, 5
s_add_u32 s77, s77, s76
s_xor_b32 s76, s76, 32
s_or_b32 s78, s78, s76
v_readlane_b32 s76, v2, 6
s_add_u32 s77, s77, s76
s_xor_b32 s76, s76, 32
s_or_b32 s78, s78, s76
v_readlane_b32 s76, v2, 7
s_add_u32 s77, s77, s76
s_xor_b32 s76, s76, 32
s_or_b32 s78, s78, s76
s_cmp_eq_u32 s77, 256
s_cbranch_scc0 mega_kernel_syxw
v_mov_b32 v252, v2
s_cmp_eq_u32 s78, 0
s_cbranch_scc0 mega_kernel_slowent
v_readlane_b32 s76, v2, 10
v_readlane_b32 s77, v2, 8
s_cmp_eq_u32 s76, 32
s_cbranch_scc0 mega_kernel_syxw
s_cmp_gt_u32 s77, 16
s_cselect_b32 s98, 1, 0
mega_kernel_syxd:
mega_kernel_slowent:
s_mov_b64 exec, -1
s_waitcnt vmcnt(0) lgkmcnt(0)
s_barrier
s_mov_b32 s97, s96
v_readlane_b32 s76, v252, 0
s_cmp_gt_u32 s90, 0
s_cselect_b32 s76, s76, 0
s_add_u32 s97, s97, s76
v_readlane_b32 s76, v252, 1
s_cmp_gt_u32 s90, 1
s_cselect_b32 s76, s76, 0
s_add_u32 s97, s97, s76
v_readlane_b32 s76, v252, 2
s_cmp_gt_u32 s90, 2
s_cselect_b32 s76, s76, 0
s_add_u32 s97, s97, s76
v_readlane_b32 s76, v252, 3
s_cmp_gt_u32 s90, 3
s_cselect_b32 s76, s76, 0
s_add_u32 s97, s97, s76
v_readlane_b32 s76, v252, 4
s_cmp_gt_u32 s90, 4
s_cselect_b32 s76, s76, 0
s_add_u32 s97, s97, s76
v_readlane_b32 s76, v252, 5
s_cmp_gt_u32 s90, 5
s_cselect_b32 s76, s76, 0
s_add_u32 s97, s97, s76
v_readlane_b32 s76, v252, 6
s_cmp_gt_u32 s90, 6
s_cselect_b32 s76, s76, 0
s_add_u32 s97, s97, s76
v_mov_b32 v1, 0
v_mov_b32 v2, 1
v_cmp_eq_u32 vcc, 0, v0
s_and_saveexec_b64 s[88:89], vcc
s_cbranch_execz mega_kernel_sb1
buffer_atomic_add v2, v1, s[72:75], 0 offen offset:192 sc1
mega_kernel_sb1:
s_mov_b64 exec, s[88:89]
mega_kernel_sb2:
s_sleep 4
buffer_load_dword v2, v1, s[72:75], 0 offen offset:192 sc1
s_waitcnt vmcnt(0)
v_cmp_ne_u32 vcc, 256, v2
s_cbranch_vccnz mega_kernel_sb2
s_mov_b32 s95, 1
s_lshr_b32 s30, s97, 5
s_and_b32 s31, s97, 31
s_cmp_lt_u32 s97, 128
s_cbranch_scc1 mega_kernel_recs
s_sub_u32 s94, s97, 128
s_branch mega_kernel_bulk
mega_kernel_spec:
s_mov_b32 s30, s90
s_mov_b32 s31, s96
s_cmp_lt_u32 s90, 4
s_cbranch_scc1 mega_kernel_recf
s_sub_u32 s94, s90, 4
s_lshl_b32 s94, s94, 5
s_add_u32 s94, s94, s96
mega_kernel_bulk:
s_lshr_b32 s91, s94, 5
s_and_b32 s40, s94, 31
s_and_b32 s92, s91, 1
s_lshl_b32 s92, s92, 5
s_add_u32 s92, s92, s40
s_cmp_eq_u32 s91, 0
s_cbranch_scc1 mega_kernel_rk
s_cmp_eq_u32 s91, 1
s_cbranch_scc1 mega_kernel_rv
s_cmp_eq_u32 s91, 2
s_cbranch_scc1 mega_kernel_noinit
v_mov_b32 v8, -1
v_mov_b32 v9, -1
v_mov_b32 v10, -1
v_mov_b32 v11, -1
v_lshlrev_b32 v1, 4, v0
v_mov_b32 v2, 0
v_cmp_gt_u32 vcc, 64, v0
s_cbranch_vccz mega_kernel_nv
s_cmp_eq_u32 s95, 0
s_cbranch_scc0 mega_kernel_nv
s_lshr_b32 s60, s2, 1
s_lshl_b32 s60, s60, 14
s_and_b32 s61, s40, 1
s_lshl_b32 s66, s61, 13
s_add_u32 s60, s60, s66
s_and_b32 s66, s2, 1
s_lshl_b32 s66, s66, 10
s_add_u32 s60, s60, s66
s_add_u32 s60, s60, 167772160
s_mov_b32 s66, 0x7fffffff
s_mov_b32 s67, 0x7fffffff
s_mov_b64 exec, 0xff
s_waitcnt vmcnt(0)
s_memtime s[62:63]
s_waitcnt lgkmcnt(0)
buffer_store_dwordx4 v[8:11], v1, s[84:87], s60 offen offset:0 sc1
s_waitcnt vmcnt(0)
s_memtime s[64:65]
s_xor_b32 s60, s60, 8192
s_waitcnt lgkmcnt(0)
s_sub_u32 s64, s64, s62
s_min_u32 s66, s66, s64
s_memtime s[62:63]
s_waitcnt lgkmcnt(0)
buffer_store_dwordx4 v[8:11], v1, s[84:87], s60 offen offset:0 sc1
s_waitcnt vmcnt(0)
s_memtime s[64:65]
s_xor_b32 s60, s60, 8192
s_waitcnt lgkmcnt(0)
s_sub_u32 s64, s64, s62
s_min_u32 s67, s67, s64
s_memtime s[62:63]
s_waitcnt lgkmcnt(0)
buffer_store_dwordx4 v[8:11], v1, s[84:87], s60 offen offset:256 sc1
s_waitcnt vmcnt(0)
s_memtime s[64:65]
s_xor_b32 s60, s60, 8192
s_waitcnt lgkmcnt(0)
s_sub_u32 s64, s64, s62
s_min_u32 s66, s66, s64
s_memtime s[62:63]
s_waitcnt lgkmcnt(0)
buffer_store_dwordx4 v[8:11], v1, s[84:87], s60 offen offset:256 sc1
s_waitcnt vmcnt(0)
s_memtime s[64:65]
s_xor_b32 s60, s60, 8192
s_waitcnt lgkmcnt(0)
s_sub_u32 s64, s64, s62
s_min_u32 s67, s67, s64
s_cmp_lt_u32 s67, s66
s_cselect_b32 s60, 1, 0
s_xor_b32 s60, s60, s61
s_lshr_b32 s61, s90, 2
s_xor_b32 s60, s60, s61
v_mov_b32 v3, s60
s_mov_b64 exec, 1
buffer_atomic_add v3, v2, s[72:75], 0 offen offset:128 sc1
s_mov_b64 exec, -1
mega_kernel_nv:
s_barrier
s_lshl_b32 s60, s40, 12
s_add_u32 s60, s60, 67108864
buffer_store_dwordx4 v[8:11], v1, s[84:87], s60 offen sc1
s_add_u32 s60, s60, 131072
buffer_store_dwordx4 v[8:11], v1, s[84:87], s60 offen sc1
s_add_u32 s60, s60, 131072
buffer_store_dwordx4 v[8:11], v1, s[84:87], s60 offen sc1
s_add_u32 s60, s60, 131072
buffer_store_dwordx4 v[8:11], v1, s[84:87], s60 offen sc1
s_add_u32 s60, s60, 131072
buffer_store_dwordx4 v[8:11], v1, s[84:87], s60 offen sc1
s_add_u32 s60, s60, 131072
buffer_store_dwordx4 v[8:11], v1, s[84:87], s60 offen sc1
s_add_u32 s60, s60, 131072
buffer_store_dwordx4 v[8:11], v1, s[84:87], s60 offen sc1
s_add_u32 s60, s60, 131072
buffer_store_dwordx4 v[8:11], v1, s[84:87], s60 offen sc1
s_add_u32 s60, s60, 131072
buffer_store_dwordx4 v[8:11], v1, s[84:87], s60 offen sc1
s_add_u32 s60, s60, 131072
buffer_store_dwordx4 v[8:11], v1, s[84:87], s60 offen sc1
s_add_u32 s60, s60, 131072
buffer_store_dwordx4 v[8:11], v1, s[84:87], s60 offen sc1
s_add_u32 s60, s60, 131072
buffer_store_dwordx4 v[8:11], v1, s[84:87], s60 offen sc1
s_add_u32 s60, s60, 131072
buffer_store_dwordx4 v[8:11], v1, s[84:87], s60 offen sc1
s_add_u32 s60, s60, 131072
buffer_store_dwordx4 v[8:11], v1, s[84:87], s60 offen sc1
s_add_u32 s60, s60, 131072
buffer_store_dwordx4 v[8:11], v1, s[84:87], s60 offen sc1
s_add_u32 s60, s60, 131072
buffer_store_dwordx4 v[8:11], v1, s[84:87], s60 offen sc1
s_add_u32 s60, s60, 131072
s_lshr_b32 s62, s40, 1
s_and_b32 s63, s40, 1
s_add_u32 s63, s63, s62
s_lshl_b32 s62, s62, 19
s_and_b32 s64, s63, 14
s_lshl_b32 s64, s64, 13
s_add_u32 s62, s62, s64
s_and_b32 s64, s63, 1
s_lshl_b32 s64, s64, 12
s_add_u32 s62, s62, s64
s_add_u32 s62, s62, 150994944
s_add_u32 s62, s62, 8192
s_cmp_lt_u32 s40, 16
s_cbranch_scc0 mega_kernel_pz
buffer_store_dwordx4 v[8:11], v1, s[84:87], s60 offen sc1
mega_kernel_pz:
s_waitcnt vmcnt(0)
s_barrier
v_mov_b32 v3, 1
s_lshl_b32 s62, s95, 6
v_cmp_eq_u32 vcc, 0, v0
s_and_saveexec_b64 s[60:61], vcc
s_cbranch_execz mega_kernel_xps
buffer_atomic_add v3, v2, s[72:75], s62 offen offset:160 sc1
mega_kernel_xps:
s_mov_b64 exec, s[60:61]
mega_kernel_noinit:
s_cmp_eq_u32 s91, 2
s_cbranch_scc0 mega_kernel_rd
s_load_dwordx2 s[4:5], s[0:1], 16
s_load_dwordx2 s[8:9], s[0:1], 0
v_lshrrev_b32 v2, 6, v0
v_and_b32 v1, 63, v0
v_readfirstlane_b32 s41, v2
v_lshlrev_b32 v5, 4, v1
s_waitcnt lgkmcnt(0)
s_mov_b32 s6, 8388608
s_mov_b32 s7, 0x00020000
s_mov_b32 s10, 4194304
s_mov_b32 s11, 0x00020000
s_lshl_b32 s43, s40, 8
s_lshl_b32 s44, s41, 6
s_add_u32 s48, s43, s44
s_and_b32 s43, s48, 0x7ff
v_add_u32 v19, s43, v1
v_lshlrev_b32 v19, 7, v19
s_mov_b32 s43, 0
buffer_load_dword v250, v19, s[8:11], s43 offen
s_nop 0
v_lshrrev_b32 v2, 3, v1
s_lshl_b32 s43, s41, 3
v_add_u32 v2, s43, v2
v_bfe_u32 v3, v2, 1, 3
v_and_b32 v4, 7, v1
v_xor_b32 v3, v3, v4
v_lshlrev_b32 v6, 11, v2
v_lshl_add_u32 v6, v3, 4, v6
s_lshl_b32 s46, s41, 10
v_and_b32 v2, 15, v1
v_bfe_u32 v3, v2, 1, 3
v_lshrrev_b32 v4, 4, v1
v_xor_b32 v3, v3, v4
v_lshlrev_b32 v8, 7, v2
v_lshl_add_u32 v8, v3, 4, v8
v_xor_b32 v9, 64, v8
v_add_u32 v10, 0x10000, v8
v_add_u32 v11, 0x10000, v9
v_mov_b32 v7, v5
s_lshl_b32 s47, s40, 2
s_add_u32 s47, s47, s41
s_mov_b32 s42, 0
s_mov_b32 s50, 0
s_add_u32 m0, s46, 0
s_nop 0
buffer_load_dwordx4 v6, s[8:11], s50 offen offset:0 lds
s_add_u32 m0, s46, 3968
s_nop 0
buffer_load_dwordx4 v6, s[8:11], s50 offen offset:128 lds
s_add_u32 m0, s46, 7936
s_nop 0
buffer_load_dwordx4 v6, s[8:11], s50 offen offset:256 lds
s_add_u32 m0, s46, 11904
s_nop 0
buffer_load_dwordx4 v6, s[8:11], s50 offen offset:384 lds
s_add_u32 m0, s46, 15872
s_nop 0
buffer_load_dwordx4 v6, s[8:11], s50 offen offset:512 lds
s_add_u32 m0, s46, 19840
s_nop 0
buffer_load_dwordx4 v6, s[8:11], s50 offen offset:640 lds
s_add_u32 m0, s46, 23808
s_nop 0
buffer_load_dwordx4 v6, s[8:11], s50 offen offset:768 lds
s_add_u32 m0, s46, 27776
s_nop 0
buffer_load_dwordx4 v6, s[8:11], s50 offen offset:896 lds
s_add_u32 m0, s46, 31744
s_nop 0
buffer_load_dwordx4 v6, s[8:11], s50 offen offset:1024 lds
s_add_u32 m0, s46, 35712
s_nop 0
buffer_load_dwordx4 v6, s[8:11], s50 offen offset:1152 lds
s_add_u32 m0, s46, 39680
s_nop 0
buffer_load_dwordx4 v6, s[8:11], s50 offen offset:1280 lds
s_add_u32 m0, s46, 43648
s_nop 0
buffer_load_dwordx4 v6, s[8:11], s50 offen offset:1408 lds
s_add_u32 m0, s46, 47616
s_nop 0
buffer_load_dwordx4 v6, s[8:11], s50 offen offset:1536 lds
s_add_u32 m0, s46, 51584
s_nop 0
buffer_load_dwordx4 v6, s[8:11], s50 offen offset:1664 lds
s_add_u32 m0, s46, 55552
s_nop 0
buffer_load_dwordx4 v6, s[8:11], s50 offen offset:1792 lds
s_add_u32 m0, s46, 59520
s_nop 0
buffer_load_dwordx4 v6, s[8:11], s50 offen offset:1920 lds
v_lshrrev_b32 v2, 2, v1
v_and_b32 v3, 3, v1
v_lshlrev_b32 v16, 13, v2
v_lshl_add_u32 v16, v3, 4, v16
v_add_u32 v16, s48, v16
s_mul_i32 s45, s41, 24576
s_add_u32 s45, s45, 65536
v_bfe_u32 v17, v1, 2, 2
v_lshrrev_b32 v18, 4, v1
v_lshl_add_u32 v17, v18, 3, v17
v_lshlrev_b32 v17, 6, v17
v_lshl_add_u32 v17, v3, 4, v17
v_add_u32 v17, s45, v17
s_and_b32 s43, s40, 3
s_lshl_b32 s43, s43, 2
s_add_u32 s43, s43, s41
s_lshl_b32 s43, s43, 3
v_and_b32 v12, 7, v1
v_add_u32 v12, s43, v12
s_lshr_b32 s43, s40, 2
s_lshl_b32 s43, s43, 10
s_add_u32 s44, s43, 896
s_add_u32 s43, s43, 384
s_cmp_ge_u32 s40, 28
s_cselect_b32 s44, s44, s43
v_mov_b32 v13, s43
v_mov_b32 v14, s44
v_cmp_gt_u32 vcc, 32, v1
s_nop 1
v_cndmask_b32 v13, v14, v13, vcc
v_lshl_add_u32 v12, v12, 13, v13
s_mov_b32 s44, 0
buffer_load_dword v250, v12, s[4:7], s44 offen
s_add_u32 m0, s45, 0
s_mov_b32 s44, 0
buffer_load_dwordx4 v16, s[4:7], s44 offen lds
s_add_u32 m0, s45, 1024
s_mov_b32 s44, 131072
buffer_load_dwordx4 v16, s[4:7], s44 offen lds
s_add_u32 m0, s45, 2048
s_mov_b32 s44, 262144
buffer_load_dwordx4 v16, s[4:7], s44 offen lds
s_add_u32 m0, s45, 3072
s_mov_b32 s44, 393216
buffer_load_dwordx4 v16, s[4:7], s44 offen lds
s_add_u32 m0, s45, 4096
s_mov_b32 s44, 524288
buffer_load_dwordx4 v16, s[4:7], s44 offen lds
s_add_u32 m0, s45, 5120
s_mov_b32 s44, 655360
buffer_load_dwordx4 v16, s[4:7], s44 offen lds
s_add_u32 m0, s45, 6144
s_mov_b32 s44, 786432
buffer_load_dwordx4 v16, s[4:7], s44 offen lds
s_add_u32 m0, s45, 7168
s_mov_b32 s44, 917504
buffer_load_dwordx4 v16, s[4:7], s44 offen lds
s_mov_b32 s44, 1048576
buffer_load_dword v250, v12, s[4:7], s44 offen
s_add_u32 m0, s45, 8192
s_mov_b32 s44, 1048576
buffer_load_dwordx4 v16, s[4:7], s44 offen lds
s_add_u32 m0, s45, 9216
s_mov_b32 s44, 1179648
buffer_load_dwordx4 v16, s[4:7], s44 offen lds
s_add_u32 m0, s45, 10240
s_mov_b32 s44, 1310720
buffer_load_dwordx4 v16, s[4:7], s44 offen lds
s_add_u32 m0, s45, 11264
s_mov_b32 s44, 1441792
buffer_load_dwordx4 v16, s[4:7], s44 offen lds
s_add_u32 m0, s45, 12288
s_mov_b32 s44, 1572864
buffer_load_dwordx4 v16, s[4:7], s44 offen lds
s_add_u32 m0, s45, 13312
s_mov_b32 s44, 1703936
buffer_load_dwordx4 v16, s[4:7], s44 offen lds
s_add_u32 m0, s45, 14336
s_mov_b32 s44, 1835008
buffer_load_dwordx4 v16, s[4:7], s44 offen lds
s_add_u32 m0, s45, 15360
s_mov_b32 s44, 1966080
buffer_load_dwordx4 v16, s[4:7], s44 offen lds
s_mov_b32 s44, 2097152
buffer_load_dword v250, v12, s[4:7], s44 offen
s_add_u32 m0, s45, 16384
s_mov_b32 s44, 2097152
buffer_load_dwordx4 v16, s[4:7], s44 offen lds
s_add_u32 m0, s45, 17408
s_mov_b32 s44, 2228224
buffer_load_dwordx4 v16, s[4:7], s44 offen lds
s_add_u32 m0, s45, 18432
s_mov_b32 s44, 2359296
buffer_load_dwordx4 v16, s[4:7], s44 offen lds
s_add_u32 m0, s45, 19456
s_mov_b32 s44, 2490368
buffer_load_dwordx4 v16, s[4:7], s44 offen lds
s_add_u32 m0, s45, 20480
s_mov_b32 s44, 2621440
buffer_load_dwordx4 v16, s[4:7], s44 offen lds
s_add_u32 m0, s45, 21504
s_mov_b32 s44, 2752512
buffer_load_dwordx4 v16, s[4:7], s44 offen lds
s_add_u32 m0, s45, 22528
s_mov_b32 s44, 2883584
buffer_load_dwordx4 v16, s[4:7], s44 offen lds
s_add_u32 m0, s45, 23552
s_mov_b32 s44, 3014656
buffer_load_dwordx4 v16, s[4:7], s44 offen lds
s_waitcnt vmcnt(18)
s_barrier
ds_read_b64_tr_b16 a[0:1], v17 offset:0
ds_read_b64_tr_b16 a[2:3], v17 offset:256
ds_read_b64_tr_b16 a[4:5], v17 offset:8
ds_read_b64_tr_b16 a[6:7], v17 offset:264
ds_read_b64_tr_b16 a[8:9], v17 offset:2048
ds_read_b64_tr_b16 a[10:11], v17 offset:2304
ds_read_b64_tr_b16 a[12:13], v17 offset:2056
ds_read_b64_tr_b16 a[14:15], v17 offset:2312
s_waitcnt lgkmcnt(0)
ds_read_b64_tr_b16 a[16:17], v17 offset:4096
ds_read_b64_tr_b16 a[18:19], v17 offset:4352
ds_read_b64_tr_b16 a[20:21], v17 offset:4104
ds_read_b64_tr_b16 a[22:23], v17 offset:4360
ds_read_b64_tr_b16 a[24:25], v17 offset:6144
ds_read_b64_tr_b16 a[26:27], v17 offset:6400
ds_read_b64_tr_b16 a[28:29], v17 offset:6152
ds_read_b64_tr_b16 a[30:31], v17 offset:6408
s_waitcnt lgkmcnt(0)
s_mov_b32 s44, 3145728
buffer_load_dword v250, v12, s[4:7], s44 offen
s_add_u32 m0, s45, 0
s_mov_b32 s44, 3145728
buffer_load_dwordx4 v16, s[4:7], s44 offen lds
s_add_u32 m0, s45, 1024
s_mov_b32 s44, 3276800
buffer_load_dwordx4 v16, s[4:7], s44 offen lds
s_add_u32 m0, s45, 2048
s_mov_b32 s44, 3407872
buffer_load_dwordx4 v16, s[4:7], s44 offen lds
s_add_u32 m0, s45, 3072
s_mov_b32 s44, 3538944
buffer_load_dwordx4 v16, s[4:7], s44 offen lds
s_add_u32 m0, s45, 4096
s_mov_b32 s44, 3670016
buffer_load_dwordx4 v16, s[4:7], s44 offen lds
s_add_u32 m0, s45, 5120
s_mov_b32 s44, 3801088
buffer_load_dwordx4 v16, s[4:7], s44 offen lds
s_add_u32 m0, s45, 6144
s_mov_b32 s44, 3932160
buffer_load_dwordx4 v16, s[4:7], s44 offen lds
s_add_u32 m0, s45, 7168
s_mov_b32 s44, 4063232
buffer_load_dwordx4 v16, s[4:7], s44 offen lds
ds_read_b128 v[20:23], v8 offset:0
ds_read_b128 v[24:27], v8 offset:2048
ds_read_b128 v[28:31], v9 offset:0
ds_read_b128 v[32:35], v9 offset:2048
ds_read_b128 v[36:39], v8 offset:4096
ds_read_b128 v[40:43], v8 offset:6144
ds_read_b128 v[44:47], v9 offset:4096
ds_read_b128 v[48:51], v9 offset:6144
s_waitcnt lgkmcnt(0)
v_mfma_f32_16x16x32_bf16 v[52:55], a[0:3], v[20:23], 0
v_mfma_f32_16x16x32_bf16 v[56:59], a[4:7], v[20:23], 0
v_mfma_f32_16x16x32_bf16 v[60:63], a[0:3], v[24:27], 0
v_mfma_f32_16x16x32_bf16 v[64:67], a[4:7], v[24:27], 0
v_mfma_f32_16x16x32_bf16 v[52:55], a[8:11], v[28:31], v[52:55]
v_mfma_f32_16x16x32_bf16 v[56:59], a[12:15], v[28:31], v[56:59]
v_mfma_f32_16x16x32_bf16 v[60:63], a[8:11], v[32:35], v[60:63]
v_mfma_f32_16x16x32_bf16 v[64:67], a[12:15], v[32:35], v[64:67]
v_mfma_f32_16x16x32_bf16 v[52:55], a[16:19], v[36:39], v[52:55]
v_mfma_f32_16x16x32_bf16 v[56:59], a[20:23], v[36:39], v[56:59]
v_mfma_f32_16x16x32_bf16 v[60:63], a[16:19], v[40:43], v[60:63]
v_mfma_f32_16x16x32_bf16 v[64:67], a[20:23], v[40:43], v[64:67]
v_mfma_f32_16x16x32_bf16 v[52:55], a[24:27], v[44:47], v[52:55]
v_mfma_f32_16x16x32_bf16 v[56:59], a[28:31], v[44:47], v[56:59]
v_mfma_f32_16x16x32_bf16 v[60:63], a[24:27], v[48:51], v[60:63]
v_mfma_f32_16x16x32_bf16 v[64:67], a[28:31], v[48:51], v[64:67]
s_waitcnt vmcnt(18)
ds_read_b64_tr_b16 a[32:33], v17 offset:8192
ds_read_b64_tr_b16 a[34:35], v17 offset:8448
ds_read_b64_tr_b16 a[36:37], v17 offset:8200
ds_read_b64_tr_b16 a[38:39], v17 offset:8456
ds_read_b64_tr_b16 a[40:41], v17 offset:10240
ds_read_b64_tr_b16 a[42:43], v17 offset:10496
ds_read_b64_tr_b16 a[44:45], v17 offset:10248
ds_read_b64_tr_b16 a[46:47], v17 offset:10504
s_waitcnt lgkmcnt(0)
ds_read_b64_tr_b16 a[48:49], v17 offset:12288
ds_read_b64_tr_b16 a[50:51], v17 offset:12544
ds_read_b64_tr_b16 a[52:53], v17 offset:12296
ds_read_b64_tr_b16 a[54:55], v17 offset:12552
ds_read_b64_tr_b16 a[56:57], v17 offset:14336
ds_read_b64_tr_b16 a[58:59], v17 offset:14592
ds_read_b64_tr_b16 a[60:61], v17 offset:14344
ds_read_b64_tr_b16 a[62:63], v17 offset:14600
s_waitcnt lgkmcnt(0)
s_mov_b32 s44, 4194304
buffer_load_dword v250, v12, s[4:7], s44 offen
s_add_u32 m0, s45, 8192
s_mov_b32 s44, 4194304
buffer_load_dwordx4 v16, s[4:7], s44 offen lds
s_add_u32 m0, s45, 9216
s_mov_b32 s44, 4325376
buffer_load_dwordx4 v16, s[4:7], s44 offen lds
s_add_u32 m0, s45, 10240
s_mov_b32 s44, 4456448
buffer_load_dwordx4 v16, s[4:7], s44 offen lds
s_add_u32 m0, s45, 11264
s_mov_b32 s44, 4587520
buffer_load_dwordx4 v16, s[4:7], s44 offen lds
s_add_u32 m0, s45, 12288
s_mov_b32 s44, 4718592
buffer_load_dwordx4 v16, s[4:7], s44 offen lds
s_add_u32 m0, s45, 13312
s_mov_b32 s44, 4849664
buffer_load_dwordx4 v16, s[4:7], s44 offen lds
s_add_u32 m0, s45, 14336
s_mov_b32 s44, 4980736
buffer_load_dwordx4 v16, s[4:7], s44 offen lds
s_add_u32 m0, s45, 15360
s_mov_b32 s44, 5111808
buffer_load_dwordx4 v16, s[4:7], s44 offen lds
ds_read_b128 v[20:23], v8 offset:8192
ds_read_b128 v[24:27], v8 offset:10240
ds_read_b128 v[28:31], v9 offset:8192
ds_read_b128 v[32:35], v9 offset:10240
ds_read_b128 v[36:39], v8 offset:12288
ds_read_b128 v[40:43], v8 offset:14336
ds_read_b128 v[44:47], v9 offset:12288
ds_read_b128 v[48:51], v9 offset:14336
s_waitcnt lgkmcnt(0)
v_mfma_f32_16x16x32_bf16 v[52:55], a[32:35], v[20:23], v[52:55]
v_mfma_f32_16x16x32_bf16 v[56:59], a[36:39], v[20:23], v[56:59]
v_mfma_f32_16x16x32_bf16 v[60:63], a[32:35], v[24:27], v[60:63]
v_mfma_f32_16x16x32_bf16 v[64:67], a[36:39], v[24:27], v[64:67]
v_mfma_f32_16x16x32_bf16 v[52:55], a[40:43], v[28:31], v[52:55]
v_mfma_f32_16x16x32_bf16 v[56:59], a[44:47], v[28:31], v[56:59]
v_mfma_f32_16x16x32_bf16 v[60:63], a[40:43], v[32:35], v[60:63]
v_mfma_f32_16x16x32_bf16 v[64:67], a[44:47], v[32:35], v[64:67]
v_mfma_f32_16x16x32_bf16 v[52:55], a[48:51], v[36:39], v[52:55]
v_mfma_f32_16x16x32_bf16 v[56:59], a[52:55], v[36:39], v[56:59]
v_mfma_f32_16x16x32_bf16 v[60:63], a[48:51], v[40:43], v[60:63]
v_mfma_f32_16x16x32_bf16 v[64:67], a[52:55], v[40:43], v[64:67]
v_mfma_f32_16x16x32_bf16 v[52:55], a[56:59], v[44:47], v[52:55]
v_mfma_f32_16x16x32_bf16 v[56:59], a[60:63], v[44:47], v[56:59]
v_mfma_f32_16x16x32_bf16 v[60:63], a[56:59], v[48:51], v[60:63]
v_mfma_f32_16x16x32_bf16 v[64:67], a[60:63], v[48:51], v[64:67]
s_waitcnt vmcnt(18)
ds_read_b64_tr_b16 a[64:65], v17 offset:16384
ds_read_b64_tr_b16 a[66:67], v17 offset:16640
ds_read_b64_tr_b16 a[68:69], v17 offset:16392
ds_read_b64_tr_b16 a[70:71], v17 offset:16648
ds_read_b64_tr_b16 a[72:73], v17 offset:18432
ds_read_b64_tr_b16 a[74:75], v17 offset:18688
ds_read_b64_tr_b16 a[76:77], v17 offset:18440
ds_read_b64_tr_b16 a[78:79], v17 offset:18696
s_waitcnt lgkmcnt(0)
ds_read_b64_tr_b16 a[80:81], v17 offset:20480
ds_read_b64_tr_b16 a[82:83], v17 offset:20736
ds_read_b64_tr_b16 a[84:85], v17 offset:20488
ds_read_b64_tr_b16 a[86:87], v17 offset:20744
ds_read_b64_tr_b16 a[88:89], v17 offset:22528
ds_read_b64_tr_b16 a[90:91], v17 offset:22784
ds_read_b64_tr_b16 a[92:93], v17 offset:22536
ds_read_b64_tr_b16 a[94:95], v17 offset:22792
s_waitcnt lgkmcnt(0)
s_mov_b32 s44, 5242880
buffer_load_dword v250, v12, s[4:7], s44 offen
s_add_u32 m0, s45, 16384
s_mov_b32 s44, 5242880
buffer_load_dwordx4 v16, s[4:7], s44 offen lds
s_add_u32 m0, s45, 17408
s_mov_b32 s44, 5373952
buffer_load_dwordx4 v16, s[4:7], s44 offen lds
s_add_u32 m0, s45, 18432
s_mov_b32 s44, 5505024
buffer_load_dwordx4 v16, s[4:7], s44 offen lds
s_add_u32 m0, s45, 19456
s_mov_b32 s44, 5636096
buffer_load_dwordx4 v16, s[4:7], s44 offen lds
s_add_u32 m0, s45, 20480
s_mov_b32 s44, 5767168
buffer_load_dwordx4 v16, s[4:7], s44 offen lds
s_add_u32 m0, s45, 21504
s_mov_b32 s44, 5898240
buffer_load_dwordx4 v16, s[4:7], s44 offen lds
s_add_u32 m0, s45, 22528
s_mov_b32 s44, 6029312
buffer_load_dwordx4 v16, s[4:7], s44 offen lds
s_add_u32 m0, s45, 23552
s_mov_b32 s44, 6160384
buffer_load_dwordx4 v16, s[4:7], s44 offen lds
ds_read_b128 v[20:23], v8 offset:16384
ds_read_b128 v[24:27], v8 offset:18432
ds_read_b128 v[28:31], v9 offset:16384
ds_read_b128 v[32:35], v9 offset:18432
ds_read_b128 v[36:39], v8 offset:20480
ds_read_b128 v[40:43], v8 offset:22528
ds_read_b128 v[44:47], v9 offset:20480
ds_read_b128 v[48:51], v9 offset:22528
s_waitcnt lgkmcnt(0)
v_mfma_f32_16x16x32_bf16 v[52:55], a[64:67], v[20:23], v[52:55]
v_mfma_f32_16x16x32_bf16 v[56:59], a[68:71], v[20:23], v[56:59]
v_mfma_f32_16x16x32_bf16 v[60:63], a[64:67], v[24:27], v[60:63]
v_mfma_f32_16x16x32_bf16 v[64:67], a[68:71], v[24:27], v[64:67]
v_mfma_f32_16x16x32_bf16 v[52:55], a[72:75], v[28:31], v[52:55]
v_mfma_f32_16x16x32_bf16 v[56:59], a[76:79], v[28:31], v[56:59]
v_mfma_f32_16x16x32_bf16 v[60:63], a[72:75], v[32:35], v[60:63]
v_mfma_f32_16x16x32_bf16 v[64:67], a[76:79], v[32:35], v[64:67]
v_mfma_f32_16x16x32_bf16 v[52:55], a[80:83], v[36:39], v[52:55]
v_mfma_f32_16x16x32_bf16 v[56:59], a[84:87], v[36:39], v[56:59]
v_mfma_f32_16x16x32_bf16 v[60:63], a[80:83], v[40:43], v[60:63]
v_mfma_f32_16x16x32_bf16 v[64:67], a[84:87], v[40:43], v[64:67]
v_mfma_f32_16x16x32_bf16 v[52:55], a[88:91], v[44:47], v[52:55]
v_mfma_f32_16x16x32_bf16 v[56:59], a[92:95], v[44:47], v[56:59]
v_mfma_f32_16x16x32_bf16 v[60:63], a[88:91], v[48:51], v[60:63]
v_mfma_f32_16x16x32_bf16 v[64:67], a[92:95], v[48:51], v[64:67]
s_waitcnt vmcnt(18)
ds_read_b64_tr_b16 a[96:97], v17 offset:0
ds_read_b64_tr_b16 a[98:99], v17 offset:256
ds_read_b64_tr_b16 a[100:101], v17 offset:8
ds_read_b64_tr_b16 a[102:103], v17 offset:264
ds_read_b64_tr_b16 a[104:105], v17 offset:2048
ds_read_b64_tr_b16 a[106:107], v17 offset:2304
ds_read_b64_tr_b16 a[108:109], v17 offset:2056
ds_read_b64_tr_b16 a[110:111], v17 offset:2312
s_waitcnt lgkmcnt(0)
ds_read_b64_tr_b16 a[112:113], v17 offset:4096
ds_read_b64_tr_b16 a[114:115], v17 offset:4352
ds_read_b64_tr_b16 a[116:117], v17 offset:4104
ds_read_b64_tr_b16 a[118:119], v17 offset:4360
ds_read_b64_tr_b16 a[120:121], v17 offset:6144
ds_read_b64_tr_b16 a[122:123], v17 offset:6400
ds_read_b64_tr_b16 a[124:125], v17 offset:6152
ds_read_b64_tr_b16 a[126:127], v17 offset:6408
s_waitcnt lgkmcnt(0)
s_mov_b32 s44, 6291456
buffer_load_dword v250, v12, s[4:7], s44 offen
s_add_u32 m0, s45, 0
s_mov_b32 s44, 6291456
buffer_load_dwordx4 v16, s[4:7], s44 offen lds
s_add_u32 m0, s45, 1024
s_mov_b32 s44, 6422528
buffer_load_dwordx4 v16, s[4:7], s44 offen lds
s_add_u32 m0, s45, 2048
s_mov_b32 s44, 6553600
buffer_load_dwordx4 v16, s[4:7], s44 offen lds
s_add_u32 m0, s45, 3072
s_mov_b32 s44, 6684672
buffer_load_dwordx4 v16, s[4:7], s44 offen lds
s_add_u32 m0, s45, 4096
s_mov_b32 s44, 6815744
buffer_load_dwordx4 v16, s[4:7], s44 offen lds
s_add_u32 m0, s45, 5120
s_mov_b32 s44, 6946816
buffer_load_dwordx4 v16, s[4:7], s44 offen lds
s_add_u32 m0, s45, 6144
s_mov_b32 s44, 7077888
buffer_load_dwordx4 v16, s[4:7], s44 offen lds
s_add_u32 m0, s45, 7168
s_mov_b32 s44, 7208960
buffer_load_dwordx4 v16, s[4:7], s44 offen lds
ds_read_b128 v[20:23], v8 offset:24576
ds_read_b128 v[24:27], v8 offset:26624
ds_read_b128 v[28:31], v9 offset:24576
ds_read_b128 v[32:35], v9 offset:26624
ds_read_b128 v[36:39], v8 offset:28672
ds_read_b128 v[40:43], v8 offset:30720
ds_read_b128 v[44:47], v9 offset:28672
ds_read_b128 v[48:51], v9 offset:30720
s_waitcnt lgkmcnt(0)
v_mfma_f32_16x16x32_bf16 v[52:55], a[96:99], v[20:23], v[52:55]
v_mfma_f32_16x16x32_bf16 v[56:59], a[100:103], v[20:23], v[56:59]
v_mfma_f32_16x16x32_bf16 v[60:63], a[96:99], v[24:27], v[60:63]
v_mfma_f32_16x16x32_bf16 v[64:67], a[100:103], v[24:27], v[64:67]
v_mfma_f32_16x16x32_bf16 v[52:55], a[104:107], v[28:31], v[52:55]
v_mfma_f32_16x16x32_bf16 v[56:59], a[108:111], v[28:31], v[56:59]
v_mfma_f32_16x16x32_bf16 v[60:63], a[104:107], v[32:35], v[60:63]
v_mfma_f32_16x16x32_bf16 v[64:67], a[108:111], v[32:35], v[64:67]
v_mfma_f32_16x16x32_bf16 v[52:55], a[112:115], v[36:39], v[52:55]
v_mfma_f32_16x16x32_bf16 v[56:59], a[116:119], v[36:39], v[56:59]
v_mfma_f32_16x16x32_bf16 v[60:63], a[112:115], v[40:43], v[60:63]
v_mfma_f32_16x16x32_bf16 v[64:67], a[116:119], v[40:43], v[64:67]
v_mfma_f32_16x16x32_bf16 v[52:55], a[120:123], v[44:47], v[52:55]
v_mfma_f32_16x16x32_bf16 v[56:59], a[124:127], v[44:47], v[56:59]
v_mfma_f32_16x16x32_bf16 v[60:63], a[120:123], v[48:51], v[60:63]
v_mfma_f32_16x16x32_bf16 v[64:67], a[124:127], v[48:51], v[64:67]
s_waitcnt vmcnt(18)
ds_read_b64_tr_b16 a[128:129], v17 offset:8192
ds_read_b64_tr_b16 a[130:131], v17 offset:8448
ds_read_b64_tr_b16 a[132:133], v17 offset:8200
ds_read_b64_tr_b16 a[134:135], v17 offset:8456
ds_read_b64_tr_b16 a[136:137], v17 offset:10240
ds_read_b64_tr_b16 a[138:139], v17 offset:10496
ds_read_b64_tr_b16 a[140:141], v17 offset:10248
ds_read_b64_tr_b16 a[142:143], v17 offset:10504
s_waitcnt lgkmcnt(0)
ds_read_b64_tr_b16 a[144:145], v17 offset:12288
ds_read_b64_tr_b16 a[146:147], v17 offset:12544
ds_read_b64_tr_b16 a[148:149], v17 offset:12296
ds_read_b64_tr_b16 a[150:151], v17 offset:12552
ds_read_b64_tr_b16 a[152:153], v17 offset:14336
ds_read_b64_tr_b16 a[154:155], v17 offset:14592
ds_read_b64_tr_b16 a[156:157], v17 offset:14344
ds_read_b64_tr_b16 a[158:159], v17 offset:14600
s_waitcnt lgkmcnt(0)
s_mov_b32 s44, 7340032
buffer_load_dword v250, v12, s[4:7], s44 offen
s_add_u32 m0, s45, 8192
s_mov_b32 s44, 7340032
buffer_load_dwordx4 v16, s[4:7], s44 offen lds
s_add_u32 m0, s45, 9216
s_mov_b32 s44, 7471104
buffer_load_dwordx4 v16, s[4:7], s44 offen lds
s_add_u32 m0, s45, 10240
s_mov_b32 s44, 7602176
buffer_load_dwordx4 v16, s[4:7], s44 offen lds
s_add_u32 m0, s45, 11264
s_mov_b32 s44, 7733248
buffer_load_dwordx4 v16, s[4:7], s44 offen lds
s_add_u32 m0, s45, 12288
s_mov_b32 s44, 7864320
buffer_load_dwordx4 v16, s[4:7], s44 offen lds
s_add_u32 m0, s45, 13312
s_mov_b32 s44, 7995392
buffer_load_dwordx4 v16, s[4:7], s44 offen lds
s_add_u32 m0, s45, 14336
s_mov_b32 s44, 8126464
buffer_load_dwordx4 v16, s[4:7], s44 offen lds
s_add_u32 m0, s45, 15360
s_mov_b32 s44, 8257536
buffer_load_dwordx4 v16, s[4:7], s44 offen lds
ds_read_b128 v[20:23], v8 offset:32768
ds_read_b128 v[24:27], v8 offset:34816
ds_read_b128 v[28:31], v9 offset:32768
ds_read_b128 v[32:35], v9 offset:34816
ds_read_b128 v[36:39], v8 offset:36864
ds_read_b128 v[40:43], v8 offset:38912
ds_read_b128 v[44:47], v9 offset:36864
ds_read_b128 v[48:51], v9 offset:38912
s_waitcnt lgkmcnt(0)
v_mfma_f32_16x16x32_bf16 v[52:55], a[128:131], v[20:23], v[52:55]
v_mfma_f32_16x16x32_bf16 v[56:59], a[132:135], v[20:23], v[56:59]
v_mfma_f32_16x16x32_bf16 v[60:63], a[128:131], v[24:27], v[60:63]
v_mfma_f32_16x16x32_bf16 v[64:67], a[132:135], v[24:27], v[64:67]
v_mfma_f32_16x16x32_bf16 v[52:55], a[136:139], v[28:31], v[52:55]
v_mfma_f32_16x16x32_bf16 v[56:59], a[140:143], v[28:31], v[56:59]
v_mfma_f32_16x16x32_bf16 v[60:63], a[136:139], v[32:35], v[60:63]
v_mfma_f32_16x16x32_bf16 v[64:67], a[140:143], v[32:35], v[64:67]
v_mfma_f32_16x16x32_bf16 v[52:55], a[144:147], v[36:39], v[52:55]
v_mfma_f32_16x16x32_bf16 v[56:59], a[148:151], v[36:39], v[56:59]
v_mfma_f32_16x16x32_bf16 v[60:63], a[144:147], v[40:43], v[60:63]
v_mfma_f32_16x16x32_bf16 v[64:67], a[148:151], v[40:43], v[64:67]
v_mfma_f32_16x16x32_bf16 v[52:55], a[152:155], v[44:47], v[52:55]
v_mfma_f32_16x16x32_bf16 v[56:59], a[156:159], v[44:47], v[56:59]
v_mfma_f32_16x16x32_bf16 v[60:63], a[152:155], v[48:51], v[60:63]
v_mfma_f32_16x16x32_bf16 v[64:67], a[156:159], v[48:51], v[64:67]
s_waitcnt vmcnt(18)
ds_read_b64_tr_b16 a[160:161], v17 offset:16384
ds_read_b64_tr_b16 a[162:163], v17 offset:16640
ds_read_b64_tr_b16 a[164:165], v17 offset:16392
ds_read_b64_tr_b16 a[166:167], v17 offset:16648
ds_read_b64_tr_b16 a[168:169], v17 offset:18432
ds_read_b64_tr_b16 a[170:171], v17 offset:18688
ds_read_b64_tr_b16 a[172:173], v17 offset:18440
ds_read_b64_tr_b16 a[174:175], v17 offset:18696
s_waitcnt lgkmcnt(0)
ds_read_b64_tr_b16 a[176:177], v17 offset:20480
ds_read_b64_tr_b16 a[178:179], v17 offset:20736
ds_read_b64_tr_b16 a[180:181], v17 offset:20488
ds_read_b64_tr_b16 a[182:183], v17 offset:20744
ds_read_b64_tr_b16 a[184:185], v17 offset:22528
ds_read_b64_tr_b16 a[186:187], v17 offset:22784
ds_read_b64_tr_b16 a[188:189], v17 offset:22536
ds_read_b64_tr_b16 a[190:191], v17 offset:22792
s_waitcnt lgkmcnt(0)
ds_read_b128 v[20:23], v8 offset:40960
ds_read_b128 v[24:27], v8 offset:43008
ds_read_b128 v[28:31], v9 offset:40960
ds_read_b128 v[32:35], v9 offset:43008
ds_read_b128 v[36:39], v8 offset:45056
ds_read_b128 v[40:43], v8 offset:47104
ds_read_b128 v[44:47], v9 offset:45056
ds_read_b128 v[48:51], v9 offset:47104
s_waitcnt lgkmcnt(0)
v_mfma_f32_16x16x32_bf16 v[52:55], a[160:163], v[20:23], v[52:55]
v_mfma_f32_16x16x32_bf16 v[56:59], a[164:167], v[20:23], v[56:59]
v_mfma_f32_16x16x32_bf16 v[60:63], a[160:163], v[24:27], v[60:63]
v_mfma_f32_16x16x32_bf16 v[64:67], a[164:167], v[24:27], v[64:67]
v_mfma_f32_16x16x32_bf16 v[52:55], a[168:171], v[28:31], v[52:55]
v_mfma_f32_16x16x32_bf16 v[56:59], a[172:175], v[28:31], v[56:59]
v_mfma_f32_16x16x32_bf16 v[60:63], a[168:171], v[32:35], v[60:63]
v_mfma_f32_16x16x32_bf16 v[64:67], a[172:175], v[32:35], v[64:67]
v_mfma_f32_16x16x32_bf16 v[52:55], a[176:179], v[36:39], v[52:55]
v_mfma_f32_16x16x32_bf16 v[56:59], a[180:183], v[36:39], v[56:59]
v_mfma_f32_16x16x32_bf16 v[60:63], a[176:179], v[40:43], v[60:63]
v_mfma_f32_16x16x32_bf16 v[64:67], a[180:183], v[40:43], v[64:67]
v_mfma_f32_16x16x32_bf16 v[52:55], a[184:187], v[44:47], v[52:55]
v_mfma_f32_16x16x32_bf16 v[56:59], a[188:191], v[44:47], v[56:59]
v_mfma_f32_16x16x32_bf16 v[60:63], a[184:187], v[48:51], v[60:63]
v_mfma_f32_16x16x32_bf16 v[64:67], a[188:191], v[48:51], v[64:67]
s_waitcnt vmcnt(9)
ds_read_b64_tr_b16 a[192:193], v17 offset:0
ds_read_b64_tr_b16 a[194:195], v17 offset:256
ds_read_b64_tr_b16 a[196:197], v17 offset:8
ds_read_b64_tr_b16 a[198:199], v17 offset:264
ds_read_b64_tr_b16 a[200:201], v17 offset:2048
ds_read_b64_tr_b16 a[202:203], v17 offset:2304
ds_read_b64_tr_b16 a[204:205], v17 offset:2056
ds_read_b64_tr_b16 a[206:207], v17 offset:2312
s_waitcnt lgkmcnt(0)
ds_read_b64_tr_b16 a[208:209], v17 offset:4096
ds_read_b64_tr_b16 a[210:211], v17 offset:4352
ds_read_b64_tr_b16 a[212:213], v17 offset:4104
ds_read_b64_tr_b16 a[214:215], v17 offset:4360
ds_read_b64_tr_b16 a[216:217], v17 offset:6144
ds_read_b64_tr_b16 a[218:219], v17 offset:6400
ds_read_b64_tr_b16 a[220:221], v17 offset:6152
ds_read_b64_tr_b16 a[222:223], v17 offset:6408
s_waitcnt lgkmcnt(0)
ds_read_b128 v[20:23], v8 offset:49152
ds_read_b128 v[24:27], v8 offset:51200
ds_read_b128 v[28:31], v9 offset:49152
ds_read_b128 v[32:35], v9 offset:51200
ds_read_b128 v[36:39], v8 offset:53248
ds_read_b128 v[40:43], v8 offset:55296
ds_read_b128 v[44:47], v9 offset:53248
ds_read_b128 v[48:51], v9 offset:55296
s_waitcnt lgkmcnt(0)
v_mfma_f32_16x16x32_bf16 v[52:55], a[192:195], v[20:23], v[52:55]
v_mfma_f32_16x16x32_bf16 v[56:59], a[196:199], v[20:23], v[56:59]
v_mfma_f32_16x16x32_bf16 v[60:63], a[192:195], v[24:27], v[60:63]
v_mfma_f32_16x16x32_bf16 v[64:67], a[196:199], v[24:27], v[64:67]
v_mfma_f32_16x16x32_bf16 v[52:55], a[200:203], v[28:31], v[52:55]
v_mfma_f32_16x16x32_bf16 v[56:59], a[204:207], v[28:31], v[56:59]
v_mfma_f32_16x16x32_bf16 v[60:63], a[200:203], v[32:35], v[60:63]
v_mfma_f32_16x16x32_bf16 v[64:67], a[204:207], v[32:35], v[64:67]
v_mfma_f32_16x16x32_bf16 v[52:55], a[208:211], v[36:39], v[52:55]
v_mfma_f32_16x16x32_bf16 v[56:59], a[212:215], v[36:39], v[56:59]
v_mfma_f32_16x16x32_bf16 v[60:63], a[208:211], v[40:43], v[60:63]
v_mfma_f32_16x16x32_bf16 v[64:67], a[212:215], v[40:43], v[64:67]
v_mfma_f32_16x16x32_bf16 v[52:55], a[216:219], v[44:47], v[52:55]
v_mfma_f32_16x16x32_bf16 v[56:59], a[220:223], v[44:47], v[56:59]
v_mfma_f32_16x16x32_bf16 v[60:63], a[216:219], v[48:51], v[60:63]
v_mfma_f32_16x16x32_bf16 v[64:67], a[220:223], v[48:51], v[64:67]
s_waitcnt vmcnt(0)
ds_read_b64_tr_b16 a[224:225], v17 offset:8192
ds_read_b64_tr_b16 a[226:227], v17 offset:8448
ds_read_b64_tr_b16 a[228:229], v17 offset:8200
ds_read_b64_tr_b16 a[230:231], v17 offset:8456
ds_read_b64_tr_b16 a[232:233], v17 offset:10240
ds_read_b64_tr_b16 a[234:235], v17 offset:10496
ds_read_b64_tr_b16 a[236:237], v17 offset:10248
ds_read_b64_tr_b16 a[238:239], v17 offset:10504
s_waitcnt lgkmcnt(0)
ds_read_b64_tr_b16 a[240:241], v17 offset:12288
ds_read_b64_tr_b16 a[242:243], v17 offset:12544
ds_read_b64_tr_b16 a[244:245], v17 offset:12296
ds_read_b64_tr_b16 a[246:247], v17 offset:12552
ds_read_b64_tr_b16 a[248:249], v17 offset:14336
ds_read_b64_tr_b16 a[250:251], v17 offset:14592
ds_read_b64_tr_b16 a[252:253], v17 offset:14344
ds_read_b64_tr_b16 a[254:255], v17 offset:14600
s_waitcnt lgkmcnt(0)
ds_read_b128 v[20:23], v8 offset:57344
ds_read_b128 v[24:27], v8 offset:59392
ds_read_b128 v[28:31], v9 offset:57344
ds_read_b128 v[32:35], v9 offset:59392
ds_read_b128 v[36:39], v8 offset:61440
ds_read_b128 v[40:43], v8 offset:63488
ds_read_b128 v[44:47], v9 offset:61440
ds_read_b128 v[48:51], v9 offset:63488
s_waitcnt lgkmcnt(0)
v_mfma_f32_16x16x32_bf16 v[52:55], a[224:227], v[20:23], v[52:55]
v_mfma_f32_16x16x32_bf16 v[56:59], a[228:231], v[20:23], v[56:59]
v_mfma_f32_16x16x32_bf16 v[60:63], a[224:227], v[24:27], v[60:63]
v_mfma_f32_16x16x32_bf16 v[64:67], a[228:231], v[24:27], v[64:67]
v_mfma_f32_16x16x32_bf16 v[52:55], a[232:235], v[28:31], v[52:55]
v_mfma_f32_16x16x32_bf16 v[56:59], a[236:239], v[28:31], v[56:59]
v_mfma_f32_16x16x32_bf16 v[60:63], a[232:235], v[32:35], v[60:63]
v_mfma_f32_16x16x32_bf16 v[64:67], a[236:239], v[32:35], v[64:67]
v_mfma_f32_16x16x32_bf16 v[52:55], a[240:243], v[36:39], v[52:55]
v_mfma_f32_16x16x32_bf16 v[56:59], a[244:247], v[36:39], v[56:59]
v_mfma_f32_16x16x32_bf16 v[60:63], a[240:243], v[40:43], v[60:63]
v_mfma_f32_16x16x32_bf16 v[64:67], a[244:247], v[40:43], v[64:67]
v_mfma_f32_16x16x32_bf16 v[52:55], a[248:251], v[44:47], v[52:55]
v_mfma_f32_16x16x32_bf16 v[56:59], a[252:255], v[44:47], v[56:59]
v_mfma_f32_16x16x32_bf16 v[60:63], a[248:251], v[48:51], v[60:63]
v_mfma_f32_16x16x32_bf16 v[64:67], a[252:255], v[48:51], v[64:67]
s_barrier
s_mov_b32 s50, 0x10000
s_add_u32 m0, s46, 65536
s_nop 0
buffer_load_dwordx4 v6, s[8:11], s50 offen offset:0 lds
s_add_u32 m0, s46, 69504
s_nop 0
buffer_load_dwordx4 v6, s[8:11], s50 offen offset:128 lds
s_add_u32 m0, s46, 73472
s_nop 0
buffer_load_dwordx4 v6, s[8:11], s50 offen offset:256 lds
s_add_u32 m0, s46, 77440
s_nop 0
buffer_load_dwordx4 v6, s[8:11], s50 offen offset:384 lds
s_add_u32 m0, s46, 81408
s_nop 0
buffer_load_dwordx4 v6, s[8:11], s50 offen offset:512 lds
s_add_u32 m0, s46, 85376
s_nop 0
buffer_load_dwordx4 v6, s[8:11], s50 offen offset:640 lds
s_add_u32 m0, s46, 89344
s_nop 0
buffer_load_dwordx4 v6, s[8:11], s50 offen offset:768 lds
s_add_u32 m0, s46, 93312
s_nop 0
buffer_load_dwordx4 v6, s[8:11], s50 offen offset:896 lds
s_add_u32 m0, s46, 97280
s_nop 0
buffer_load_dwordx4 v6, s[8:11], s50 offen offset:1024 lds
s_add_u32 m0, s46, 101248
s_nop 0
buffer_load_dwordx4 v6, s[8:11], s50 offen offset:1152 lds
s_add_u32 m0, s46, 105216
s_nop 0
buffer_load_dwordx4 v6, s[8:11], s50 offen offset:1280 lds
s_add_u32 m0, s46, 109184
s_nop 0
buffer_load_dwordx4 v6, s[8:11], s50 offen offset:1408 lds
s_add_u32 m0, s46, 113152
s_nop 0
buffer_load_dwordx4 v6, s[8:11], s50 offen offset:1536 lds
s_add_u32 m0, s46, 117120
s_nop 0
buffer_load_dwordx4 v6, s[8:11], s50 offen offset:1664 lds
s_add_u32 m0, s46, 121088
s_nop 0
buffer_load_dwordx4 v6, s[8:11], s50 offen offset:1792 lds
s_add_u32 m0, s46, 125056
s_nop 0
buffer_load_dwordx4 v6, s[8:11], s50 offen offset:1920 lds
v_and_b32 v3, 15, v0
v_lshlrev_b32 v3, 4, v3
s_branch mega_kernel_syc
mega_kernel_sycw:
s_sleep 4
mega_kernel_syc:
buffer_load_dword v2, v3, s[72:75], 0 offen sc1
s_waitcnt vmcnt(0)
mega_kernel_sycp:
s_cmp_eq_u32 s95, 1
s_cbranch_scc0 mega_kernel_sycf
v_readlane_b32 s76, v2, 14
s_mov_b32 s98, 0
s_cmp_eq_u32 s76, 32
s_cbranch_scc0 mega_kernel_sycw
s_branch mega_kernel_sycd
mega_kernel_sycf:
s_mov_b32 s77, 0
s_mov_b32 s78, 0
v_readlane_b32 s76, v2, 0
s_add_u32 s77, s77, s76
s_xor_b32 s76, s76, 32
s_or_b32 s78, s78, s76
v_readlane_b32 s76, v2, 1
s_add_u32 s77, s77, s76
s_xor_b32 s76, s76, 32
s_or_b32 s78, s78, s76
v_readlane_b32 s76, v2, 2
s_add_u32 s77, s77, s76
s_xor_b32 s76, s76, 32
s_or_b32 s78, s78, s76
v_readlane_b32 s76, v2, 3
s_add_u32 s77, s77, s76
s_xor_b32 s76, s76, 32
s_or_b32 s78, s78, s76
v_readlane_b32 s76, v2, 4
s_add_u32 s77, s77, s76
s_xor_b32 s76, s76, 32
s_or_b32 s78, s78, s76
v_readlane_b32 s76, v2, 5
s_add_u32 s77, s77, s76
s_xor_b32 s76, s76, 32
s_or_b32 s78, s78, s76
v_readlane_b32 s76, v2, 6
s_add_u32 s77, s77, s76
s_xor_b32 s76, s76, 32
s_or_b32 s78, s78, s76
v_readlane_b32 s76, v2, 7
s_add_u32 s77, s77, s76
s_xor_b32 s76, s76, 32
s_or_b32 s78, s78, s76
s_cmp_eq_u32 s77, 256
s_cbranch_scc0 mega_kernel_sycw
v_mov_b32 v252, v2
s_cmp_eq_u32 s78, 0
s_cbranch_scc0 mega_kernel_slowent
v_readlane_b32 s76, v2, 10
v_readlane_b32 s77, v2, 8
s_cmp_eq_u32 s76, 32
s_cbranch_scc0 mega_kernel_sycw
s_cmp_gt_u32 s77, 16
s_cselect_b32 s98, 1, 0
mega_kernel_sycd:
v_lshrrev_b32 v92, 4, v1
v_and_b32 v93, 15, v1
s_and_b32 s52, s41, 1
s_lshr_b32 s53, s41, 1
s_mov_b32 s54, 0x3e0293ee
s_mov_b32 s55, 0
s_mov_b32 s56, 0
v_mov_b32 v97, 0xff800000
v_mov_b32 v241, 0xceabdc6e
v_and_b32 v2, 7, v93
v_lshlrev_b32 v94, 7, v92
v_lshl_add_u32 v94, v2, 4, v94
v_and_b32 v2, 31, v1
v_lshlrev_b32 v95, 3, v2
v_lshrrev_b32 v2, 1, v92
v_lshlrev_b32 v96, 10, v2
v_and_b32 v2, 1, v92
v_lshl_add_u32 v96, v2, 9, v96
v_lshl_add_u32 v96, v93, 4, v96
s_lshl_b32 s43, s40, 13
s_lshl_b32 s44, s53, 12
s_add_u32 s43, s43, s44
s_lshl_b32 s44, s52, 8
s_add_u32 s43, s43, s44
s_add_u32 s43, s43, 134217728
v_add_u32 v96, s43, v96
s_lshl_b32 s43, s52, 4
v_add_u32 v98, s43, v93
v_lshlrev_b32 v2, 2, v92
v_sub_u32 v98, v98, v2
s_mov_b32 s28, 0
s_mov_b32 s29, -1
s_xor_b32 s44, s98, 1
s_lshl_b32 s44, s44, 13
s_lshl_b32 s43, s40, 7
s_add_u32 s43, s43, s44
s_add_u32 s43, s43, 69206016
v_and_b32 v2, 3, v1
v_bfe_u32 v3, v1, 2, 1
v_lshlrev_b32 v99, 12, v3
v_lshl_add_u32 v99, v2, 2, v99
v_add_u32 v99, s43, v99
s_xor_b32 s62, s98, 1
s_lshl_b32 s62, s62, 13
s_lshr_b32 s44, s47, 6
s_lshl_b32 s44, s44, 14
s_add_u32 s62, s62, s44
s_and_b32 s44, s47, 63
s_lshl_b32 s44, s44, 7
s_add_u32 s62, s62, s44
s_add_u32 s62, s62, 69222400
s_lshl_b32 s49, s40, 7
s_lshl_b32 s44, s41, 2
s_add_u32 s49, s49, s44
s_lshl_b32 s44, s98, 13
s_add_u32 s49, s49, s44
s_add_u32 s49, s49, 69255168
s_lshl_b32 s43, s41, 11
s_add_u32 s43, s43, 131072
v_add_u32 v101, s43, v7
s_lshl_b32 s43, s52, 10
s_add_u32 s43, s43, 131072
v_add_u32 v102, s43, v5
v_mov_b32 v16, 0
s_mov_b32 s50, 0
v_mov_b32 v104, 0x3f803f80
v_mov_b32 v105, 0x3f803f80
v_mov_b32 v106, 0x3f803f80
v_mov_b32 v107, 0x3f803f80
v_cmp_gt_i32 s[12:13], 0, v98
v_cmp_gt_i32 s[14:15], 1, v98
v_cmp_gt_i32 s[16:17], 2, v98
v_cmp_gt_i32 s[18:19], 3, v98
v_cmp_gt_i32 s[20:21], 16, v98
v_cmp_gt_i32 s[22:23], 17, v98
v_cmp_gt_i32 s[24:25], 18, v98
v_cmp_gt_i32 s[26:27], 19, v98
s_lshr_b32 s44, s47, 3
s_xor_b32 s44, s44, s98
s_and_b32 s44, s44, 1
s_lshl_b32 s44, s44, 13
s_lshl_b32 s58, s47, 18
s_add_u32 s58, s58, s44
s_add_u32 s58, s58, 0
s_lshr_b32 s44, s47, 4
s_xor_b32 s44, s44, s98
s_and_b32 s44, s44, 1
s_lshl_b32 s44, s44, 13
s_lshl_b32 s59, s47, 17
s_add_u32 s59, s59, s44
s_add_u32 s59, s59, 71303168
s_lshl_b32 s60, s41, 11
s_add_u32 s60, s60, 139264
s_lshl_b32 s61, s41, 10
s_add_u32 s61, s61, 155648
v_add_u32 v94, 155648, v94
s_lshl_b32 s43, s53, 11
s_add_u32 s43, s43, 156160
v_add_u32 v95, s43, v95
v_add_u32 v103, 139264, v5
s_lshl_b32 s43, s53, 12
s_add_u32 s43, s43, 147456
v_add_u32 v240, s43, v5
s_waitcnt vmcnt(0)
v_mov_b32 v68, v52
v_mov_b32 v69, v53
v_mov_b32 v70, v54
v_mov_b32 v71, v55
v_mov_b32 v72, v56
v_mov_b32 v73, v57
v_mov_b32 v74, v58
v_mov_b32 v75, v59
v_mov_b32 v76, v60
v_mov_b32 v77, v61
v_mov_b32 v78, v62
v_mov_b32 v79, v63
v_mov_b32 v80, v64
v_mov_b32 v81, v65
v_mov_b32 v82, v66
v_mov_b32 v83, v67
mega_kernel_q_loop:
s_barrier
s_cmp_gt_i32 s55, s42
s_cbranch_scc1 mega_kernel_q_kv1k
mega_kernel_q_kv1w:
v_mov_b32 v2, 0
s_mov_b64 exec, 0xff
buffer_atomic_add v2, v99, s[84:87], 0 offen sc0 sc1
s_mov_b64 exec, -1
s_waitcnt vmcnt(0)
v_min_i32_dpp v2, v2, v2 quad_perm:[1,0,3,2] row_mask:0xf bank_mask:0xf
s_nop 1
v_min_i32_dpp v2, v2, v2 quad_perm:[2,3,0,1] row_mask:0xf bank_mask:0xf
s_nop 1
v_min_i32_dpp v2, v2, v2 row_half_mirror row_mask:0xf bank_mask:0xf
s_nop 0
v_readfirstlane_b32 s55, v2
s_cmp_gt_i32 s55, s42
s_cbranch_scc1 mega_kernel_q_kv1k
s_sleep 4
s_branch mega_kernel_q_kv1w
mega_kernel_q_kv1k:
ds_read_b128 v[20:23], v10 offset:0
ds_read_b128 v[24:27], v10 offset:2048
ds_read_b128 v[28:31], v11 offset:0
ds_read_b128 v[32:35], v11 offset:2048
ds_read_b128 v[36:39], v10 offset:4096
ds_read_b128 v[40:43], v10 offset:6144
s_add_u32 s51, s47, s42
s_bfe_u32 s57, s51, 0x40002
s_lshl_b32 s57, s57, 14
s_and_b32 s66, s51, 3
s_lshl_b32 s66, s66, 11
s_add_u32 s66, s66, s57
s_add_u32 s66, s66, s58
s_add_u32 s67, s66, 33554432
s_bfe_u32 s57, s51, 0x30003
s_lshl_b32 s57, s57, 14
s_and_b32 s68, s51, 7
s_lshl_b32 s68, s68, 10
s_add_u32 s68, s68, s57
s_add_u32 s68, s68, s59
s_add_u32 s50, s42, 2
s_min_u32 s50, s50, 63
s_lshl_b32 s50, s50, 16
s_cmp_gt_i32 s56, s42
s_cselect_b32 s30, 1, 0
s_add_u32 m0, s60, 0
s_waitcnt lgkmcnt(4)
v_mfma_f32_16x16x32_bf16 v[52:55], a[0:3], v[20:23], 0
ds_read_b128 v[44:47], v11 offset:4096
v_mfma_f32_16x16x32_bf16 v[56:59], a[4:7], v[20:23], 0
buffer_load_dwordx4 v5, s[84:87], s66 offen offset:0 sc1 lds
v_mfma_f32_16x16x32_bf16 v[60:63], a[0:3], v[24:27], 0
ds_read_b128 v[48:51], v11 offset:6144
v_mfma_f32_16x16x32_bf16 v[64:67], a[4:7], v[24:27], 0
s_add_u32 m0, s60, 0
s_waitcnt lgkmcnt(4)
v_mfma_f32_16x16x32_bf16 v[52:55], a[8:11], v[28:31], v[52:55]
ds_read_b128 v[20:23], v10 offset:8192
v_mfma_f32_16x16x32_bf16 v[56:59], a[12:15], v[28:31], v[56:59]
buffer_load_dwordx4 v5, s[84:87], s66 offen offset:1024 sc1 lds
v_mfma_f32_16x16x32_bf16 v[60:63], a[8:11], v[32:35], v[60:63]
ds_read_b128 v[24:27], v10 offset:10240
v_mfma_f32_16x16x32_bf16 v[64:67], a[12:15], v[32:35], v[64:67]
s_add_u32 m0, s60, 8192
s_waitcnt lgkmcnt(4)
v_mfma_f32_16x16x32_bf16 v[52:55], a[16:19], v[36:39], v[52:55]
ds_read_b128 v[28:31], v11 offset:8192
v_mfma_f32_16x16x32_bf16 v[56:59], a[20:23], v[36:39], v[56:59]
buffer_load_dwordx4 v5, s[84:87], s67 offen offset:0 sc1 lds
v_mfma_f32_16x16x32_bf16 v[60:63], a[16:19], v[40:43], v[60:63]
ds_read_b128 v[32:35], v11 offset:10240
v_mfma_f32_16x16x32_bf16 v[64:67], a[20:23], v[40:43], v[64:67]
s_add_u32 m0, s60, 8192
s_waitcnt lgkmcnt(4)
v_mfma_f32_16x16x32_bf16 v[52:55], a[24:27], v[44:47], v[52:55]
ds_read_b128 v[36:39], v10 offset:12288
v_mfma_f32_16x16x32_bf16 v[56:59], a[28:31], v[44:47], v[56:59]
buffer_load_dwordx4 v5, s[84:87], s67 offen offset:1024 sc1 lds
v_mfma_f32_16x16x32_bf16 v[60:63], a[24:27], v[48:51], v[60:63]
ds_read_b128 v[40:43], v10 offset:14336
v_mfma_f32_16x16x32_bf16 v[64:67], a[28:31], v[48:51], v[64:67]
s_waitcnt lgkmcnt(4)
v_mfma_f32_16x16x32_bf16 v[52:55], a[32:35], v[20:23], v[52:55]
ds_read_b128 v[44:47], v11 offset:12288
v_mfma_f32_16x16x32_bf16 v[56:59], a[36:39], v[20:23], v[56:59]
s_cmp_eq_u32 s30, 1
s_cbranch_scc0 mega_kernel_q_ke1
s_mov_b32 m0, s61
s_nop 0
buffer_load_dwordx4 v5, s[84:87], s68 offen sc1 lds
mega_kernel_q_ke1:
v_mfma_f32_16x16x32_bf16 v[60:63], a[32:35], v[24:27], v[60:63]
ds_read_b128 v[48:51], v11 offset:14336
v_mfma_f32_16x16x32_bf16 v[64:67], a[36:39], v[24:27], v[64:67]
s_add_u32 m0, s46, 0
s_waitcnt lgkmcnt(4)
v_mfma_f32_16x16x32_bf16 v[52:55], a[40:43], v[28:31], v[52:55]
ds_read_b128 v[20:23], v10 offset:16384
v_mfma_f32_16x16x32_bf16 v[56:59], a[44:47], v[28:31], v[56:59]
buffer_load_dwordx4 v6, s[8:11], s50 offen offset:0 lds
v_mfma_f32_16x16x32_bf16 v[60:63], a[40:43], v[32:35], v[60:63]
ds_read_b128 v[24:27], v10 offset:18432
v_mfma_f32_16x16x32_bf16 v[64:67], a[44:47], v[32:35], v[64:67]
s_add_u32 m0, s46, 3968
s_waitcnt lgkmcnt(4)
v_mfma_f32_16x16x32_bf16 v[52:55], a[48:51], v[36:39], v[52:55]
ds_read_b128 v[28:31], v11 offset:16384
v_mfma_f32_16x16x32_bf16 v[56:59], a[52:55], v[36:39], v[56:59]
buffer_load_dwordx4 v6, s[8:11], s50 offen offset:128 lds
v_mfma_f32_16x16x32_bf16 v[60:63], a[48:51], v[40:43], v[60:63]
ds_read_b128 v[32:35], v11 offset:18432
v_mfma_f32_16x16x32_bf16 v[64:67], a[52:55], v[40:43], v[64:67]
s_add_u32 m0, s46, 7936
s_waitcnt lgkmcnt(4)
v_mfma_f32_16x16x32_bf16 v[52:55], a[56:59], v[44:47], v[52:55]
ds_read_b128 v[36:39], v10 offset:20480
v_mfma_f32_16x16x32_bf16 v[56:59], a[60:63], v[44:47], v[56:59]
buffer_load_dwordx4 v6, s[8:11], s50 offen offset:256 lds
v_mfma_f32_16x16x32_bf16 v[60:63], a[56:59], v[48:51], v[60:63]
ds_read_b128 v[40:43], v10 offset:22528
v_mfma_f32_16x16x32_bf16 v[64:67], a[60:63], v[48:51], v[64:67]
s_add_u32 m0, s46, 11904
s_waitcnt lgkmcnt(4)
v_mfma_f32_16x16x32_bf16 v[52:55], a[64:67], v[20:23], v[52:55]
ds_read_b128 v[44:47], v11 offset:20480
v_mfma_f32_16x16x32_bf16 v[56:59], a[68:71], v[20:23], v[56:59]
buffer_load_dwordx4 v6, s[8:11], s50 offen offset:384 lds
v_mfma_f32_16x16x32_bf16 v[60:63], a[64:67], v[24:27], v[60:63]
ds_read_b128 v[48:51], v11 offset:22528
v_mfma_f32_16x16x32_bf16 v[64:67], a[68:71], v[24:27], v[64:67]
s_add_u32 m0, s46, 15872
s_waitcnt lgkmcnt(4)
v_mfma_f32_16x16x32_bf16 v[52:55], a[72:75], v[28:31], v[52:55]
ds_read_b128 v[20:23], v10 offset:24576
v_mfma_f32_16x16x32_bf16 v[56:59], a[76:79], v[28:31], v[56:59]
buffer_load_dwordx4 v6, s[8:11], s50 offen offset:512 lds
v_mfma_f32_16x16x32_bf16 v[60:63], a[72:75], v[32:35], v[60:63]
ds_read_b128 v[24:27], v10 offset:26624
v_mfma_f32_16x16x32_bf16 v[64:67], a[76:79], v[32:35], v[64:67]
s_add_u32 m0, s46, 19840
s_waitcnt lgkmcnt(4)
v_mfma_f32_16x16x32_bf16 v[52:55], a[80:83], v[36:39], v[52:55]
ds_read_b128 v[28:31], v11 offset:24576
v_mfma_f32_16x16x32_bf16 v[56:59], a[84:87], v[36:39], v[56:59]
buffer_load_dwordx4 v6, s[8:11], s50 offen offset:640 lds
v_mfma_f32_16x16x32_bf16 v[60:63], a[80:83], v[40:43], v[60:63]
ds_read_b128 v[32:35], v11 offset:26624
v_mfma_f32_16x16x32_bf16 v[64:67], a[84:87], v[40:43], v[64:67]
s_add_u32 m0, s46, 23808
s_waitcnt lgkmcnt(4)
v_mfma_f32_16x16x32_bf16 v[52:55], a[88:91], v[44:47], v[52:55]
ds_read_b128 v[36:39], v10 offset:28672
v_mfma_f32_16x16x32_bf16 v[56:59], a[92:95], v[44:47], v[56:59]
buffer_load_dwordx4 v6, s[8:11], s50 offen offset:768 lds
v_mfma_f32_16x16x32_bf16 v[60:63], a[88:91], v[48:51], v[60:63]
ds_read_b128 v[40:43], v10 offset:30720
v_mfma_f32_16x16x32_bf16 v[64:67], a[92:95], v[48:51], v[64:67]
s_add_u32 m0, s46, 27776
s_waitcnt lgkmcnt(4)
v_mfma_f32_16x16x32_bf16 v[52:55], a[96:99], v[20:23], v[52:55]
ds_read_b128 v[44:47], v11 offset:28672
v_mfma_f32_16x16x32_bf16 v[56:59], a[100:103], v[20:23], v[56:59]
buffer_load_dwordx4 v6, s[8:11], s50 offen offset:896 lds
v_mfma_f32_16x16x32_bf16 v[60:63], a[96:99], v[24:27], v[60:63]
ds_read_b128 v[48:51], v11 offset:30720
v_mfma_f32_16x16x32_bf16 v[64:67], a[100:103], v[24:27], v[64:67]
s_add_u32 m0, s46, 31744
s_waitcnt lgkmcnt(4)
v_mfma_f32_16x16x32_bf16 v[52:55], a[104:107], v[28:31], v[52:55]
ds_read_b128 v[20:23], v10 offset:32768
v_mfma_f32_16x16x32_bf16 v[56:59], a[108:111], v[28:31], v[56:59]
buffer_load_dwordx4 v6, s[8:11], s50 offen offset:1024 lds
v_mfma_f32_16x16x32_bf16 v[60:63], a[104:107], v[32:35], v[60:63]
ds_read_b128 v[24:27], v10 offset:34816
v_mfma_f32_16x16x32_bf16 v[64:67], a[108:111], v[32:35], v[64:67]
s_waitcnt vmcnt(13)
v_mov_b32 v17, s42
s_mov_b64 exec, 1
buffer_store_dword v17, v16, s[84:87], s49 offen sc1
s_mov_b64 exec, -1
s_add_u32 m0, s46, 35712
s_waitcnt lgkmcnt(4)
v_mfma_f32_16x16x32_bf16 v[52:55], a[112:115], v[36:39], v[52:55]
ds_read_b128 v[28:31], v11 offset:32768
v_mfma_f32_16x16x32_bf16 v[56:59], a[116:119], v[36:39], v[56:59]
buffer_load_dwordx4 v6, s[8:11], s50 offen offset:1152 lds
v_mfma_f32_16x16x32_bf16 v[60:63], a[112:115], v[40:43], v[60:63]
ds_read_b128 v[32:35], v11 offset:34816
v_mfma_f32_16x16x32_bf16 v[64:67], a[116:119], v[40:43], v[64:67]
v_mov_b32 v100, 0
s_mov_b64 exec, 1
buffer_atomic_add v100, v16, s[84:87], s62 offen sc0 sc1
s_mov_b64 exec, -1
s_add_u32 m0, s46, 39680
s_waitcnt lgkmcnt(4)
v_mfma_f32_16x16x32_bf16 v[52:55], a[120:123], v[44:47], v[52:55]
ds_read_b128 v[36:39], v10 offset:36864
v_mfma_f32_16x16x32_bf16 v[56:59], a[124:127], v[44:47], v[56:59]
buffer_load_dwordx4 v6, s[8:11], s50 offen offset:1280 lds
v_mfma_f32_16x16x32_bf16 v[60:63], a[120:123], v[48:51], v[60:63]
ds_read_b128 v[40:43], v10 offset:38912
v_mfma_f32_16x16x32_bf16 v[64:67], a[124:127], v[48:51], v[64:67]
s_add_u32 m0, s46, 43648
s_waitcnt lgkmcnt(4)
v_mfma_f32_16x16x32_bf16 v[52:55], a[128:131], v[20:23], v[52:55]
ds_read_b128 v[44:47], v11 offset:36864
v_mfma_f32_16x16x32_bf16 v[56:59], a[132:135], v[20:23], v[56:59]
buffer_load_dwordx4 v6, s[8:11], s50 offen offset:1408 lds
v_mfma_f32_16x16x32_bf16 v[60:63], a[128:131], v[24:27], v[60:63]
ds_read_b128 v[48:51], v11 offset:38912
v_mfma_f32_16x16x32_bf16 v[64:67], a[132:135], v[24:27], v[64:67]
s_add_u32 m0, s46, 47616
s_waitcnt lgkmcnt(4)
v_mfma_f32_16x16x32_bf16 v[52:55], a[136:139], v[28:31], v[52:55]
ds_read_b128 v[20:23], v10 offset:40960
v_mfma_f32_16x16x32_bf16 v[56:59], a[140:143], v[28:31], v[56:59]
buffer_load_dwordx4 v6, s[8:11], s50 offen offset:1536 lds
v_mfma_f32_16x16x32_bf16 v[60:63], a[136:139], v[32:35], v[60:63]
ds_read_b128 v[24:27], v10 offset:43008
v_mfma_f32_16x16x32_bf16 v[64:67], a[140:143], v[32:35], v[64:67]
s_add_u32 m0, s46, 51584
s_waitcnt lgkmcnt(4)
v_mfma_f32_16x16x32_bf16 v[52:55], a[144:147], v[36:39], v[52:55]
ds_read_b128 v[28:31], v11 offset:40960
v_mfma_f32_16x16x32_bf16 v[56:59], a[148:151], v[36:39], v[56:59]
buffer_load_dwordx4 v6, s[8:11], s50 offen offset:1664 lds
v_mfma_f32_16x16x32_bf16 v[60:63], a[144:147], v[40:43], v[60:63]
ds_read_b128 v[32:35], v11 offset:43008
v_mfma_f32_16x16x32_bf16 v[64:67], a[148:151], v[40:43], v[64:67]
s_add_u32 m0, s46, 55552
s_waitcnt lgkmcnt(4)
v_mfma_f32_16x16x32_bf16 v[52:55], a[152:155], v[44:47], v[52:55]
ds_read_b128 v[36:39], v10 offset:45056
v_mfma_f32_16x16x32_bf16 v[56:59], a[156:159], v[44:47], v[56:59]
buffer_load_dwordx4 v6, s[8:11], s50 offen offset:1792 lds
v_mfma_f32_16x16x32_bf16 v[60:63], a[152:155], v[48:51], v[60:63]
ds_read_b128 v[40:43], v10 offset:47104
v_mfma_f32_16x16x32_bf16 v[64:67], a[156:159], v[48:51], v[64:67]
s_add_u32 m0, s46, 59520
s_waitcnt lgkmcnt(4)
v_mfma_f32_16x16x32_bf16 v[52:55], a[160:163], v[20:23], v[52:55]
ds_read_b128 v[44:47], v11 offset:45056
v_mfma_f32_16x16x32_bf16 v[56:59], a[164:167], v[20:23], v[56:59]
buffer_load_dwordx4 v6, s[8:11], s50 offen offset:1920 lds
v_mfma_f32_16x16x32_bf16 v[60:63], a[160:163], v[24:27], v[60:63]
ds_read_b128 v[48:51], v11 offset:47104
v_mfma_f32_16x16x32_bf16 v[64:67], a[164:167], v[24:27], v[64:67]
s_waitcnt lgkmcnt(4)
v_mfma_f32_16x16x32_bf16 v[52:55], a[168:171], v[28:31], v[52:55]
ds_read_b128 v[20:23], v10 offset:49152
v_mfma_f32_16x16x32_bf16 v[56:59], a[172:175], v[28:31], v[56:59]
v_mfma_f32_16x16x32_bf16 v[60:63], a[168:171], v[32:35], v[60:63]
ds_read_b128 v[24:27], v10 offset:51200
v_mfma_f32_16x16x32_bf16 v[64:67], a[172:175], v[32:35], v[64:67]
v_cvt_pk_bf16_f32 v84, v68, v69
v_cvt_pk_bf16_f32 v85, v70, v71
s_waitcnt lgkmcnt(4)
v_mfma_f32_16x16x32_bf16 v[52:55], a[176:179], v[36:39], v[52:55]
ds_read_b128 v[28:31], v11 offset:49152
v_mfma_f32_16x16x32_bf16 v[56:59], a[180:183], v[36:39], v[56:59]
v_mfma_f32_16x16x32_bf16 v[60:63], a[176:179], v[40:43], v[60:63]
ds_read_b128 v[32:35], v11 offset:51200
v_mfma_f32_16x16x32_bf16 v[64:67], a[180:183], v[40:43], v[64:67]
v_cvt_pk_bf16_f32 v86, v72, v73
v_cvt_pk_bf16_f32 v87, v74, v75
s_waitcnt lgkmcnt(4)
v_mfma_f32_16x16x32_bf16 v[52:55], a[184:187], v[44:47], v[52:55]
ds_read_b128 v[36:39], v10 offset:53248
v_mfma_f32_16x16x32_bf16 v[56:59], a[188:191], v[44:47], v[56:59]
v_mfma_f32_16x16x32_bf16 v[60:63], a[184:187], v[48:51], v[60:63]
ds_read_b128 v[40:43], v10 offset:55296
v_mfma_f32_16x16x32_bf16 v[64:67], a[188:191], v[48:51], v[64:67]
v_cvt_pk_bf16_f32 v88, v76, v77
v_cvt_pk_bf16_f32 v89, v78, v79
s_waitcnt lgkmcnt(4)
v_mfma_f32_16x16x32_bf16 v[52:55], a[192:195], v[20:23], v[52:55]
ds_read_b128 v[44:47], v11 offset:53248
v_mfma_f32_16x16x32_bf16 v[56:59], a[196:199], v[20:23], v[56:59]
v_mfma_f32_16x16x32_bf16 v[60:63], a[192:195], v[24:27], v[60:63]
ds_read_b128 v[48:51], v11 offset:55296
v_mfma_f32_16x16x32_bf16 v[64:67], a[196:199], v[24:27], v[64:67]
v_cvt_pk_bf16_f32 v90, v80, v81
v_cvt_pk_bf16_f32 v91, v82, v83
s_waitcnt lgkmcnt(4)
v_mfma_f32_16x16x32_bf16 v[52:55], a[200:203], v[28:31], v[52:55]
ds_read_b128 v[20:23], v10 offset:57344
v_mfma_f32_16x16x32_bf16 v[56:59], a[204:207], v[28:31], v[56:59]
v_mfma_f32_16x16x32_bf16 v[60:63], a[200:203], v[32:35], v[60:63]
ds_read_b128 v[24:27], v10 offset:59392
v_mfma_f32_16x16x32_bf16 v[64:67], a[204:207], v[32:35], v[64:67]
s_waitcnt lgkmcnt(4)
v_mfma_f32_16x16x32_bf16 v[52:55], a[208:211], v[36:39], v[52:55]
ds_read_b128 v[28:31], v11 offset:57344
v_mfma_f32_16x16x32_bf16 v[56:59], a[212:215], v[36:39], v[56:59]
v_mfma_f32_16x16x32_bf16 v[60:63], a[208:211], v[40:43], v[60:63]
ds_read_b128 v[32:35], v11 offset:59392
v_mfma_f32_16x16x32_bf16 v[64:67], a[212:215], v[40:43], v[64:67]
s_waitcnt lgkmcnt(4)
v_mfma_f32_16x16x32_bf16 v[52:55], a[216:219], v[44:47], v[52:55]
ds_read_b128 v[36:39], v10 offset:61440
v_mfma_f32_16x16x32_bf16 v[56:59], a[220:223], v[44:47], v[56:59]
s_waitcnt vmcnt(6)
v_readfirstlane_b32 s56, v100
s_cmp_eq_u32 s30, 1
s_cbranch_scc1 mega_kernel_q_kf1
s_cmp_gt_i32 s56, s42
s_cbranch_scc0 mega_kernel_q_kf1
s_mov_b32 s30, 1
s_mov_b32 m0, s61
s_nop 0
buffer_load_dwordx4 v5, s[84:87], s68 offen sc1 lds
mega_kernel_q_kf1:
v_mfma_f32_16x16x32_bf16 v[60:63], a[216:219], v[48:51], v[60:63]
ds_read_b128 v[40:43], v10 offset:63488
v_mfma_f32_16x16x32_bf16 v[64:67], a[220:223], v[48:51], v[64:67]
s_waitcnt lgkmcnt(4)
v_mfma_f32_16x16x32_bf16 v[52:55], a[224:227], v[20:23], v[52:55]
ds_read_b128 v[44:47], v11 offset:61440
v_mfma_f32_16x16x32_bf16 v[56:59], a[228:231], v[20:23], v[56:59]
v_mfma_f32_16x16x32_bf16 v[60:63], a[224:227], v[24:27], v[60:63]
ds_read_b128 v[48:51], v11 offset:63488
v_mfma_f32_16x16x32_bf16 v[64:67], a[228:231], v[24:27], v[64:67]
s_waitcnt lgkmcnt(5)
v_mfma_f32_16x16x32_bf16 v[52:55], a[232:235], v[28:31], v[52:55]
v_mfma_f32_16x16x32_bf16 v[56:59], a[236:239], v[28:31], v[56:59]
s_waitcnt lgkmcnt(4)
v_mfma_f32_16x16x32_bf16 v[60:63], a[232:235], v[32:35], v[60:63]
v_mfma_f32_16x16x32_bf16 v[64:67], a[236:239], v[32:35], v[64:67]
s_waitcnt lgkmcnt(3)
v_mfma_f32_16x16x32_bf16 v[52:55], a[240:243], v[36:39], v[52:55]
v_mfma_f32_16x16x32_bf16 v[56:59], a[244:247], v[36:39], v[56:59]
s_waitcnt lgkmcnt(2)
v_mfma_f32_16x16x32_bf16 v[60:63], a[240:243], v[40:43], v[60:63]
v_mfma_f32_16x16x32_bf16 v[64:67], a[244:247], v[40:43], v[64:67]
ds_write_b128 v101, v[84:87]
ds_write_b128 v101, v[88:91] offset:1024
s_waitcnt lgkmcnt(1)
v_mfma_f32_16x16x32_bf16 v[68:71], a[248:251], v[44:47], v[52:55]
v_mfma_f32_16x16x32_bf16 v[72:75], a[252:255], v[44:47], v[56:59]
s_waitcnt lgkmcnt(0)
v_mfma_f32_16x16x32_bf16 v[76:79], a[248:251], v[48:51], v[60:63]
v_mfma_f32_16x16x32_bf16 v[80:83], a[252:255], v[48:51], v[64:67]
s_cmp_eq_u32 s30, 1
s_cbranch_scc1 mega_kernel_q_kl1
mega_kernel_q_kw1:
v_mov_b32 v100, 0
s_mov_b64 exec, 1
buffer_atomic_add v100, v16, s[84:87], s62 offen sc0 sc1
s_mov_b64 exec, -1
s_waitcnt vmcnt(0)
v_readfirstlane_b32 s56, v100
s_cmp_gt_i32 s56, s42
s_cbranch_scc0 mega_kernel_q_kw1
s_mov_b32 m0, s61
s_nop 0
buffer_load_dwordx4 v5, s[84:87], s68 offen sc1 lds
mega_kernel_q_kl1:
s_waitcnt lgkmcnt(0) vmcnt(0)
s_barrier
ds_read_b128 v[184:187], v102 offset:0
ds_read_b128 v[112:115], v103 offset:0
ds_read_b128 v[128:131], v103 offset:1024
ds_read_b128 v[188:191], v102 offset:2048
ds_read_b128 v[116:119], v103 offset:2048
ds_read_b128 v[132:135], v103 offset:3072
ds_read_b128 v[192:195], v102 offset:4096
ds_read_b128 v[120:123], v103 offset:4096
ds_read_b128 v[136:139], v103 offset:5120
ds_read_b128 v[196:199], v102 offset:6144
ds_read_b128 v[124:127], v103 offset:6144
ds_read_b128 v[140:143], v103 offset:7168
s_waitcnt lgkmcnt(9)
v_mfma_f32_16x16x32_bf16 v[200:203], v[112:115], v[184:187], 0
v_mfma_f32_16x16x32_bf16 v[204:207], v[128:131], v[184:187], 0
ds_read_b128 v[160:163], v94 offset:0
s_waitcnt lgkmcnt(7)
v_mfma_f32_16x16x32_bf16 v[200:203], v[116:119], v[188:191], v[200:203]
v_mfma_f32_16x16x32_bf16 v[204:207], v[132:135], v[188:191], v[204:207]
ds_read_b128 v[164:167], v94 offset:1024
s_waitcnt lgkmcnt(5)
v_mfma_f32_16x16x32_bf16 v[200:203], v[120:123], v[192:195], v[200:203]
v_mfma_f32_16x16x32_bf16 v[204:207], v[136:139], v[192:195], v[204:207]
ds_read_b128 v[168:171], v94 offset:2048
s_waitcnt lgkmcnt(3)
v_mfma_f32_16x16x32_bf16 v[200:203], v[124:127], v[196:199], v[200:203]
v_mfma_f32_16x16x32_bf16 v[204:207], v[140:143], v[196:199], v[204:207]
ds_read_b128 v[172:175], v94 offset:3072
s_waitcnt lgkmcnt(3)
v_mfma_f32_16x16x32_bf16 v[208:211], v[160:163], v[184:187], 0
ds_read_b128 v[144:147], v240 offset:0
ds_read_b64 v[176:177], v95 offset:0
s_waitcnt lgkmcnt(4)
v_mfma_f32_16x16x32_bf16 v[208:211], v[164:167], v[188:191], v[208:211]
ds_read_b128 v[148:151], v240 offset:1024
ds_read_b64 v[178:179], v95 offset:256
s_waitcnt lgkmcnt(5)
v_mfma_f32_16x16x32_bf16 v[208:211], v[168:171], v[192:195], v[208:211]
ds_read_b128 v[152:155], v240 offset:2048
ds_read_b64 v[180:181], v95 offset:1024
s_waitcnt lgkmcnt(6)
v_mfma_f32_16x16x32_bf16 v[208:211], v[172:175], v[196:199], v[208:211]
ds_read_b128 v[156:159], v240 offset:3072
ds_read_b64 v[182:183], v95 offset:1280
v_pk_mul_f32 v[200:201], v[200:201], s[54:55] op_sel_hi:[1,0]
v_pk_mul_f32 v[202:203], v[202:203], s[54:55] op_sel_hi:[1,0]
v_pk_mul_f32 v[204:205], v[204:205], s[54:55] op_sel_hi:[1,0]
v_pk_mul_f32 v[206:207], v[206:207], s[54:55] op_sel_hi:[1,0]
v_cndmask_b32 v200, v200, v241, s[12:13]
v_cndmask_b32 v201, v201, v241, s[14:15]
v_cndmask_b32 v202, v202, v241, s[16:17]
v_cndmask_b32 v203, v203, v241, s[18:19]
v_cndmask_b32 v204, v204, v241, s[20:21]
v_cndmask_b32 v205, v205, v241, s[22:23]
v_cndmask_b32 v206, v206, v241, s[24:25]
v_cndmask_b32 v207, v207, v241, s[26:27]
v_pk_mul_f32 v[208:209], v[208:209], s[54:55] op_sel_hi:[1,0]
v_pk_mul_f32 v[210:211], v[210:211], s[54:55] op_sel_hi:[1,0]
v_cndmask_b32 v208, v208, v97, s[28:29]
v_cndmask_b32 v209, v209, v97, s[28:29]
v_cndmask_b32 v210, v210, v97, s[28:29]
v_cndmask_b32 v211, v211, v97, s[28:29]
v_max3_f32 v236, v200, v201, v202
v_max3_f32 v236, v236, v203, v204
v_max3_f32 v236, v236, v205, v206
v_max3_f32 v236, v236, v207, v208
v_max3_f32 v236, v236, v209, v210
v_max_f32 v237, v236, v211
v_max_f32 v236, v236, v211
s_nop 1
v_permlane16_swap_b32 v236, v237
s_nop 0
v_max_f32 v238, v236, v237
v_max_f32 v239, v236, v237
s_nop 1
v_permlane32_swap_b32 v238, v239
s_nop 0
v_max_f32 v236, v238, v239
v_pk_add_f32 v[200:201], v[200:201], v[236:237] op_sel_hi:[1,0] neg_lo:[0,1] neg_hi:[0,1]
v_pk_add_f32 v[202:203], v[202:203], v[236:237] op_sel_hi:[1,0] neg_lo:[0,1] neg_hi:[0,1]
v_pk_add_f32 v[204:205], v[204:205], v[236:237] op_sel_hi:[1,0] neg_lo:[0,1] neg_hi:[0,1]
v_pk_add_f32 v[206:207], v[206:207], v[236:237] op_sel_hi:[1,0] neg_lo:[0,1] neg_hi:[0,1]
v_pk_add_f32 v[208:209], v[208:209], v[236:237] op_sel_hi:[1,0] neg_lo:[0,1] neg_hi:[0,1]
v_pk_add_f32 v[210:211], v[210:211], v[236:237] op_sel_hi:[1,0] neg_lo:[0,1] neg_hi:[0,1]
v_exp_f32 v200, v200
v_exp_f32 v201, v201
v_exp_f32 v202, v202
v_exp_f32 v203, v203
v_exp_f32 v204, v204
v_exp_f32 v205, v205
v_exp_f32 v206, v206
v_exp_f32 v207, v207
v_exp_f32 v208, v208
v_exp_f32 v209, v209
v_exp_f32 v210, v210
v_exp_f32 v211, v211
s_nop 0
v_cvt_pk_bf16_f32 v212, v200, v201
v_cvt_pk_bf16_f32 v213, v202, v203
v_cvt_pk_bf16_f32 v214, v204, v205
v_cvt_pk_bf16_f32 v215, v206, v207
v_cvt_pk_bf16_f32 v216, v208, v209
v_cvt_pk_bf16_f32 v217, v210, v211
s_waitcnt lgkmcnt(0)
s_nop 0
v_mfma_f32_16x16x32_bf16 v[108:111], v[104:107], v[212:215], 0
v_mfma_f32_16x16x32_bf16 v[220:223], v[144:147], v[212:215], 0
v_mfma_f32_16x16x32_bf16 v[224:227], v[148:151], v[212:215], 0
v_mfma_f32_16x16x32_bf16 v[228:231], v[152:155], v[212:215], 0
v_mfma_f32_16x16x32_bf16 v[232:235], v[156:159], v[212:215], 0
v_mfma_f32_16x16x16_bf16 v[108:111], v[104:105], v[216:217], v[108:111]
v_mfma_f32_16x16x16_bf16 v[220:223], v[176:177], v[216:217], v[220:223]
v_mfma_f32_16x16x16_bf16 v[224:227], v[178:179], v[216:217], v[224:227]
v_mfma_f32_16x16x16_bf16 v[228:231], v[180:181], v[216:217], v[228:231]
v_mfma_f32_16x16x16_bf16 v[232:235], v[182:183], v[216:217], v[232:235]
s_lshl_b32 s51, s42, 18
s_nop 2
v_rcp_f32 v238, v108
v_rcp_f32 v239, v109
s_nop 1
v_pk_mul_f32 v[220:221], v[220:221], v[238:239]
v_pk_mul_f32 v[222:223], v[222:223], v[238:239]
v_pk_mul_f32 v[224:225], v[224:225], v[238:239]
v_pk_mul_f32 v[226:227], v[226:227], v[238:239]
v_pk_mul_f32 v[228:229], v[228:229], v[238:239]
v_pk_mul_f32 v[230:231], v[230:231], v[238:239]
v_pk_mul_f32 v[232:233], v[232:233], v[238:239]
v_pk_mul_f32 v[234:235], v[234:235], v[238:239]
v_cvt_pk_bf16_f32 v200, v220, v221
v_cvt_pk_bf16_f32 v201, v222, v223
v_cvt_pk_bf16_f32 v202, v224, v225
v_cvt_pk_bf16_f32 v203, v226, v227
v_cvt_pk_bf16_f32 v204, v228, v229
v_cvt_pk_bf16_f32 v205, v230, v231
v_cvt_pk_bf16_f32 v206, v232, v233
v_cvt_pk_bf16_f32 v207, v234, v235
buffer_store_dwordx4 v[200:203], v96, s[84:87], s51 offen sc1
buffer_store_dwordx4 v[204:207], v96, s[84:87], s51 offen offset:2048 sc1
s_add_u32 s42, s42, 1
s_barrier
s_cmp_gt_i32 s55, s42
s_cbranch_scc1 mega_kernel_q_kv0k
mega_kernel_q_kv0w:
v_mov_b32 v2, 0
s_mov_b64 exec, 0xff
buffer_atomic_add v2, v99, s[84:87], 0 offen sc0 sc1
s_mov_b64 exec, -1
s_waitcnt vmcnt(0)
v_min_i32_dpp v2, v2, v2 quad_perm:[1,0,3,2] row_mask:0xf bank_mask:0xf
s_nop 1
v_min_i32_dpp v2, v2, v2 quad_perm:[2,3,0,1] row_mask:0xf bank_mask:0xf
s_nop 1
v_min_i32_dpp v2, v2, v2 row_half_mirror row_mask:0xf bank_mask:0xf
s_nop 0
v_readfirstlane_b32 s55, v2
s_cmp_gt_i32 s55, s42
s_cbranch_scc1 mega_kernel_q_kv0k
s_sleep 4
s_branch mega_kernel_q_kv0w
mega_kernel_q_kv0k:
s_cmp_eq_u32 s42, 63
s_cbranch_scc0 mega_kernel_q_nl
s_add_u32 s51, s47, s42
s_bfe_u32 s57, s51, 0x40002
s_lshl_b32 s57, s57, 14
s_and_b32 s66, s51, 3
s_lshl_b32 s66, s66, 11
s_add_u32 s66, s66, s57
s_add_u32 s66, s66, s58
s_add_u32 s67, s66, 33554432
s_bfe_u32 s57, s51, 0x30003
s_lshl_b32 s57, s57, 14
s_and_b32 s68, s51, 7
s_lshl_b32 s68, s68, 10
s_add_u32 s68, s68, s57
s_add_u32 s68, s68, s59
s_add_u32 s50, s42, 2
s_min_u32 s50, s50, 63
s_lshl_b32 s50, s50, 16
s_cmp_gt_i32 s56, s42
s_cselect_b32 s30, 1, 0
s_add_u32 m0, s60, 0
s_nop 0
buffer_load_dwordx4 v5, s[84:87], s66 offen offset:0 sc1 lds
s_add_u32 m0, s60, 0
s_nop 0
buffer_load_dwordx4 v5, s[84:87], s66 offen offset:1024 sc1 lds
s_add_u32 m0, s60, 8192
s_nop 0
buffer_load_dwordx4 v5, s[84:87], s67 offen offset:0 sc1 lds
s_add_u32 m0, s60, 8192
s_nop 0
buffer_load_dwordx4 v5, s[84:87], s67 offen offset:1024 sc1 lds
s_cmp_eq_u32 s30, 1
s_cbranch_scc0 mega_kernel_q_ke2
s_mov_b32 m0, s61
s_nop 0
buffer_load_dwordx4 v5, s[84:87], s68 offen sc1 lds
mega_kernel_q_ke2:
v_cvt_pk_bf16_f32 v84, v68, v69
v_cvt_pk_bf16_f32 v85, v70, v71
v_cvt_pk_bf16_f32 v86, v72, v73
v_cvt_pk_bf16_f32 v87, v74, v75
v_cvt_pk_bf16_f32 v88, v76, v77
v_cvt_pk_bf16_f32 v89, v78, v79
v_cvt_pk_bf16_f32 v90, v80, v81
v_cvt_pk_bf16_f32 v91, v82, v83
ds_write_b128 v101, v[84:87]
ds_write_b128 v101, v[88:91] offset:1024
s_waitcnt vmcnt(4)
v_mov_b32 v17, s42
s_mov_b64 exec, 1
buffer_store_dword v17, v16, s[84:87], s49 offen sc1
s_mov_b64 exec, -1
s_branch mega_kernel_q_jl
mega_kernel_q_nl:
ds_read_b128 v[20:23], v8 offset:0
ds_read_b128 v[24:27], v8 offset:2048
ds_read_b128 v[28:31], v9 offset:0
ds_read_b128 v[32:35], v9 offset:2048
ds_read_b128 v[36:39], v8 offset:4096
ds_read_b128 v[40:43], v8 offset:6144
s_add_u32 s51, s47, s42
s_bfe_u32 s57, s51, 0x40002
s_lshl_b32 s57, s57, 14
s_and_b32 s66, s51, 3
s_lshl_b32 s66, s66, 11
s_add_u32 s66, s66, s57
s_add_u32 s66, s66, s58
s_add_u32 s67, s66, 33554432
s_bfe_u32 s57, s51, 0x30003
s_lshl_b32 s57, s57, 14
s_and_b32 s68, s51, 7
s_lshl_b32 s68, s68, 10
s_add_u32 s68, s68, s57
s_add_u32 s68, s68, s59
s_add_u32 s50, s42, 2
s_min_u32 s50, s50, 63
s_lshl_b32 s50, s50, 16
s_cmp_gt_i32 s56, s42
s_cselect_b32 s30, 1, 0
s_add_u32 m0, s60, 0
s_waitcnt lgkmcnt(4)
v_mfma_f32_16x16x32_bf16 v[52:55], a[0:3], v[20:23], 0
ds_read_b128 v[44:47], v9 offset:4096
v_mfma_f32_16x16x32_bf16 v[56:59], a[4:7], v[20:23], 0
buffer_load_dwordx4 v5, s[84:87], s66 offen offset:0 sc1 lds
v_mfma_f32_16x16x32_bf16 v[60:63], a[0:3], v[24:27], 0
ds_read_b128 v[48:51], v9 offset:6144
v_mfma_f32_16x16x32_bf16 v[64:67], a[4:7], v[24:27], 0
s_add_u32 m0, s60, 0
s_waitcnt lgkmcnt(4)
v_mfma_f32_16x16x32_bf16 v[52:55], a[8:11], v[28:31], v[52:55]
ds_read_b128 v[20:23], v8 offset:8192
v_mfma_f32_16x16x32_bf16 v[56:59], a[12:15], v[28:31], v[56:59]
buffer_load_dwordx4 v5, s[84:87], s66 offen offset:1024 sc1 lds
v_mfma_f32_16x16x32_bf16 v[60:63], a[8:11], v[32:35], v[60:63]
ds_read_b128 v[24:27], v8 offset:10240
v_mfma_f32_16x16x32_bf16 v[64:67], a[12:15], v[32:35], v[64:67]
s_add_u32 m0, s60, 8192
s_waitcnt lgkmcnt(4)
v_mfma_f32_16x16x32_bf16 v[52:55], a[16:19], v[36:39], v[52:55]
ds_read_b128 v[28:31], v9 offset:8192
v_mfma_f32_16x16x32_bf16 v[56:59], a[20:23], v[36:39], v[56:59]
buffer_load_dwordx4 v5, s[84:87], s67 offen offset:0 sc1 lds
v_mfma_f32_16x16x32_bf16 v[60:63], a[16:19], v[40:43], v[60:63]
ds_read_b128 v[32:35], v9 offset:10240
v_mfma_f32_16x16x32_bf16 v[64:67], a[20:23], v[40:43], v[64:67]
s_add_u32 m0, s60, 8192
s_waitcnt lgkmcnt(4)
v_mfma_f32_16x16x32_bf16 v[52:55], a[24:27], v[44:47], v[52:55]
ds_read_b128 v[36:39], v8 offset:12288
v_mfma_f32_16x16x32_bf16 v[56:59], a[28:31], v[44:47], v[56:59]
buffer_load_dwordx4 v5, s[84:87], s67 offen offset:1024 sc1 lds
v_mfma_f32_16x16x32_bf16 v[60:63], a[24:27], v[48:51], v[60:63]
ds_read_b128 v[40:43], v8 offset:14336
v_mfma_f32_16x16x32_bf16 v[64:67], a[28:31], v[48:51], v[64:67]
s_waitcnt lgkmcnt(4)
v_mfma_f32_16x16x32_bf16 v[52:55], a[32:35], v[20:23], v[52:55]
ds_read_b128 v[44:47], v9 offset:12288
v_mfma_f32_16x16x32_bf16 v[56:59], a[36:39], v[20:23], v[56:59]
s_cmp_eq_u32 s30, 1
s_cbranch_scc0 mega_kernel_q_ke0
s_mov_b32 m0, s61
s_nop 0
buffer_load_dwordx4 v5, s[84:87], s68 offen sc1 lds
mega_kernel_q_ke0:
v_mfma_f32_16x16x32_bf16 v[60:63], a[32:35], v[24:27], v[60:63]
ds_read_b128 v[48:51], v9 offset:14336
v_mfma_f32_16x16x32_bf16 v[64:67], a[36:39], v[24:27], v[64:67]
s_add_u32 m0, s46, 65536
s_waitcnt lgkmcnt(4)
v_mfma_f32_16x16x32_bf16 v[52:55], a[40:43], v[28:31], v[52:55]
ds_read_b128 v[20:23], v8 offset:16384
v_mfma_f32_16x16x32_bf16 v[56:59], a[44:47], v[28:31], v[56:59]
buffer_load_dwordx4 v6, s[8:11], s50 offen offset:0 lds
v_mfma_f32_16x16x32_bf16 v[60:63], a[40:43], v[32:35], v[60:63]
ds_read_b128 v[24:27], v8 offset:18432
v_mfma_f32_16x16x32_bf16 v[64:67], a[44:47], v[32:35], v[64:67]
s_add_u32 m0, s46, 69504
s_waitcnt lgkmcnt(4)
v_mfma_f32_16x16x32_bf16 v[52:55], a[48:51], v[36:39], v[52:55]
ds_read_b128 v[28:31], v9 offset:16384
v_mfma_f32_16x16x32_bf16 v[56:59], a[52:55], v[36:39], v[56:59]
buffer_load_dwordx4 v6, s[8:11], s50 offen offset:128 lds
v_mfma_f32_16x16x32_bf16 v[60:63], a[48:51], v[40:43], v[60:63]
ds_read_b128 v[32:35], v9 offset:18432
v_mfma_f32_16x16x32_bf16 v[64:67], a[52:55], v[40:43], v[64:67]
s_add_u32 m0, s46, 73472
s_waitcnt lgkmcnt(4)
v_mfma_f32_16x16x32_bf16 v[52:55], a[56:59], v[44:47], v[52:55]
ds_read_b128 v[36:39], v8 offset:20480
v_mfma_f32_16x16x32_bf16 v[56:59], a[60:63], v[44:47], v[56:59]
buffer_load_dwordx4 v6, s[8:11], s50 offen offset:256 lds
v_mfma_f32_16x16x32_bf16 v[60:63], a[56:59], v[48:51], v[60:63]
ds_read_b128 v[40:43], v8 offset:22528
v_mfma_f32_16x16x32_bf16 v[64:67], a[60:63], v[48:51], v[64:67]
s_add_u32 m0, s46, 77440
s_waitcnt lgkmcnt(4)
v_mfma_f32_16x16x32_bf16 v[52:55], a[64:67], v[20:23], v[52:55]
ds_read_b128 v[44:47], v9 offset:20480
v_mfma_f32_16x16x32_bf16 v[56:59], a[68:71], v[20:23], v[56:59]
buffer_load_dwordx4 v6, s[8:11], s50 offen offset:384 lds
v_mfma_f32_16x16x32_bf16 v[60:63], a[64:67], v[24:27], v[60:63]
ds_read_b128 v[48:51], v9 offset:22528
v_mfma_f32_16x16x32_bf16 v[64:67], a[68:71], v[24:27], v[64:67]
s_add_u32 m0, s46, 81408
s_waitcnt lgkmcnt(4)
v_mfma_f32_16x16x32_bf16 v[52:55], a[72:75], v[28:31], v[52:55]
ds_read_b128 v[20:23], v8 offset:24576
v_mfma_f32_16x16x32_bf16 v[56:59], a[76:79], v[28:31], v[56:59]
buffer_load_dwordx4 v6, s[8:11], s50 offen offset:512 lds
v_mfma_f32_16x16x32_bf16 v[60:63], a[72:75], v[32:35], v[60:63]
ds_read_b128 v[24:27], v8 offset:26624
v_mfma_f32_16x16x32_bf16 v[64:67], a[76:79], v[32:35], v[64:67]
s_add_u32 m0, s46, 85376
s_waitcnt lgkmcnt(4)
v_mfma_f32_16x16x32_bf16 v[52:55], a[80:83], v[36:39], v[52:55]
ds_read_b128 v[28:31], v9 offset:24576
v_mfma_f32_16x16x32_bf16 v[56:59], a[84:87], v[36:39], v[56:59]
buffer_load_dwordx4 v6, s[8:11], s50 offen offset:640 lds
v_mfma_f32_16x16x32_bf16 v[60:63], a[80:83], v[40:43], v[60:63]
ds_read_b128 v[32:35], v9 offset:26624
v_mfma_f32_16x16x32_bf16 v[64:67], a[84:87], v[40:43], v[64:67]
s_add_u32 m0, s46, 89344
s_waitcnt lgkmcnt(4)
v_mfma_f32_16x16x32_bf16 v[52:55], a[88:91], v[44:47], v[52:55]
ds_read_b128 v[36:39], v8 offset:28672
v_mfma_f32_16x16x32_bf16 v[56:59], a[92:95], v[44:47], v[56:59]
buffer_load_dwordx4 v6, s[8:11], s50 offen offset:768 lds
v_mfma_f32_16x16x32_bf16 v[60:63], a[88:91], v[48:51], v[60:63]
ds_read_b128 v[40:43], v8 offset:30720
v_mfma_f32_16x16x32_bf16 v[64:67], a[92:95], v[48:51], v[64:67]
s_add_u32 m0, s46, 93312
s_waitcnt lgkmcnt(4)
v_mfma_f32_16x16x32_bf16 v[52:55], a[96:99], v[20:23], v[52:55]
ds_read_b128 v[44:47], v9 offset:28672
v_mfma_f32_16x16x32_bf16 v[56:59], a[100:103], v[20:23], v[56:59]
buffer_load_dwordx4 v6, s[8:11], s50 offen offset:896 lds
v_mfma_f32_16x16x32_bf16 v[60:63], a[96:99], v[24:27], v[60:63]
ds_read_b128 v[48:51], v9 offset:30720
v_mfma_f32_16x16x32_bf16 v[64:67], a[100:103], v[24:27], v[64:67]
s_add_u32 m0, s46, 97280
s_waitcnt lgkmcnt(4)
v_mfma_f32_16x16x32_bf16 v[52:55], a[104:107], v[28:31], v[52:55]
ds_read_b128 v[20:23], v8 offset:32768
v_mfma_f32_16x16x32_bf16 v[56:59], a[108:111], v[28:31], v[56:59]
buffer_load_dwordx4 v6, s[8:11], s50 offen offset:1024 lds
v_mfma_f32_16x16x32_bf16 v[60:63], a[104:107], v[32:35], v[60:63]
ds_read_b128 v[24:27], v8 offset:34816
v_mfma_f32_16x16x32_bf16 v[64:67], a[108:111], v[32:35], v[64:67]
s_waitcnt vmcnt(13)
v_mov_b32 v17, s42
s_mov_b64 exec, 1
buffer_store_dword v17, v16, s[84:87], s49 offen sc1
s_mov_b64 exec, -1
s_add_u32 m0, s46, 101248
s_waitcnt lgkmcnt(4)
v_mfma_f32_16x16x32_bf16 v[52:55], a[112:115], v[36:39], v[52:55]
ds_read_b128 v[28:31], v9 offset:32768
v_mfma_f32_16x16x32_bf16 v[56:59], a[116:119], v[36:39], v[56:59]
buffer_load_dwordx4 v6, s[8:11], s50 offen offset:1152 lds
v_mfma_f32_16x16x32_bf16 v[60:63], a[112:115], v[40:43], v[60:63]
ds_read_b128 v[32:35], v9 offset:34816
v_mfma_f32_16x16x32_bf16 v[64:67], a[116:119], v[40:43], v[64:67]
v_mov_b32 v100, 0
s_mov_b64 exec, 1
buffer_atomic_add v100, v16, s[84:87], s62 offen sc0 sc1
s_mov_b64 exec, -1
s_add_u32 m0, s46, 105216
s_waitcnt lgkmcnt(4)
v_mfma_f32_16x16x32_bf16 v[52:55], a[120:123], v[44:47], v[52:55]
ds_read_b128 v[36:39], v8 offset:36864
v_mfma_f32_16x16x32_bf16 v[56:59], a[124:127], v[44:47], v[56:59]
buffer_load_dwordx4 v6, s[8:11], s50 offen offset:1280 lds
v_mfma_f32_16x16x32_bf16 v[60:63], a[120:123], v[48:51], v[60:63]
ds_read_b128 v[40:43], v8 offset:38912
v_mfma_f32_16x16x32_bf16 v[64:67], a[124:127], v[48:51], v[64:67]
s_add_u32 m0, s46, 109184
s_waitcnt lgkmcnt(4)
v_mfma_f32_16x16x32_bf16 v[52:55], a[128:131], v[20:23], v[52:55]
ds_read_b128 v[44:47], v9 offset:36864
v_mfma_f32_16x16x32_bf16 v[56:59], a[132:135], v[20:23], v[56:59]
buffer_load_dwordx4 v6, s[8:11], s50 offen offset:1408 lds
v_mfma_f32_16x16x32_bf16 v[60:63], a[128:131], v[24:27], v[60:63]
ds_read_b128 v[48:51], v9 offset:38912
v_mfma_f32_16x16x32_bf16 v[64:67], a[132:135], v[24:27], v[64:67]
s_add_u32 m0, s46, 113152
s_waitcnt lgkmcnt(4)
v_mfma_f32_16x16x32_bf16 v[52:55], a[136:139], v[28:31], v[52:55]
ds_read_b128 v[20:23], v8 offset:40960
v_mfma_f32_16x16x32_bf16 v[56:59], a[140:143], v[28:31], v[56:59]
buffer_load_dwordx4 v6, s[8:11], s50 offen offset:1536 lds
v_mfma_f32_16x16x32_bf16 v[60:63], a[136:139], v[32:35], v[60:63]
ds_read_b128 v[24:27], v8 offset:43008
v_mfma_f32_16x16x32_bf16 v[64:67], a[140:143], v[32:35], v[64:67]
s_add_u32 m0, s46, 117120
s_waitcnt lgkmcnt(4)
v_mfma_f32_16x16x32_bf16 v[52:55], a[144:147], v[36:39], v[52:55]
ds_read_b128 v[28:31], v9 offset:40960
v_mfma_f32_16x16x32_bf16 v[56:59], a[148:151], v[36:39], v[56:59]
buffer_load_dwordx4 v6, s[8:11], s50 offen offset:1664 lds
v_mfma_f32_16x16x32_bf16 v[60:63], a[144:147], v[40:43], v[60:63]
ds_read_b128 v[32:35], v9 offset:43008
v_mfma_f32_16x16x32_bf16 v[64:67], a[148:151], v[40:43], v[64:67]
s_add_u32 m0, s46, 121088
s_waitcnt lgkmcnt(4)
v_mfma_f32_16x16x32_bf16 v[52:55], a[152:155], v[44:47], v[52:55]
ds_read_b128 v[36:39], v8 offset:45056
v_mfma_f32_16x16x32_bf16 v[56:59], a[156:159], v[44:47], v[56:59]
buffer_load_dwordx4 v6, s[8:11], s50 offen offset:1792 lds
v_mfma_f32_16x16x32_bf16 v[60:63], a[152:155], v[48:51], v[60:63]
ds_read_b128 v[40:43], v8 offset:47104
v_mfma_f32_16x16x32_bf16 v[64:67], a[156:159], v[48:51], v[64:67]
s_add_u32 m0, s46, 125056
s_waitcnt lgkmcnt(4)
v_mfma_f32_16x16x32_bf16 v[52:55], a[160:163], v[20:23], v[52:55]
ds_read_b128 v[44:47], v9 offset:45056
v_mfma_f32_16x16x32_bf16 v[56:59], a[164:167], v[20:23], v[56:59]
buffer_load_dwordx4 v6, s[8:11], s50 offen offset:1920 lds
v_mfma_f32_16x16x32_bf16 v[60:63], a[160:163], v[24:27], v[60:63]
ds_read_b128 v[48:51], v9 offset:47104
v_mfma_f32_16x16x32_bf16 v[64:67], a[164:167], v[24:27], v[64:67]
s_waitcnt lgkmcnt(4)
v_mfma_f32_16x16x32_bf16 v[52:55], a[168:171], v[28:31], v[52:55]
ds_read_b128 v[20:23], v8 offset:49152
v_mfma_f32_16x16x32_bf16 v[56:59], a[172:175], v[28:31], v[56:59]
v_mfma_f32_16x16x32_bf16 v[60:63], a[168:171], v[32:35], v[60:63]
ds_read_b128 v[24:27], v8 offset:51200
v_mfma_f32_16x16x32_bf16 v[64:67], a[172:175], v[32:35], v[64:67]
v_cvt_pk_bf16_f32 v84, v68, v69
v_cvt_pk_bf16_f32 v85, v70, v71
s_waitcnt lgkmcnt(4)
v_mfma_f32_16x16x32_bf16 v[52:55], a[176:179], v[36:39], v[52:55]
ds_read_b128 v[28:31], v9 offset:49152
v_mfma_f32_16x16x32_bf16 v[56:59], a[180:183], v[36:39], v[56:59]
v_mfma_f32_16x16x32_bf16 v[60:63], a[176:179], v[40:43], v[60:63]
ds_read_b128 v[32:35], v9 offset:51200
v_mfma_f32_16x16x32_bf16 v[64:67], a[180:183], v[40:43], v[64:67]
v_cvt_pk_bf16_f32 v86, v72, v73
v_cvt_pk_bf16_f32 v87, v74, v75
s_waitcnt lgkmcnt(4)
v_mfma_f32_16x16x32_bf16 v[52:55], a[184:187], v[44:47], v[52:55]
ds_read_b128 v[36:39], v8 offset:53248
v_mfma_f32_16x16x32_bf16 v[56:59], a[188:191], v[44:47], v[56:59]
v_mfma_f32_16x16x32_bf16 v[60:63], a[184:187], v[48:51], v[60:63]
ds_read_b128 v[40:43], v8 offset:55296
v_mfma_f32_16x16x32_bf16 v[64:67], a[188:191], v[48:51], v[64:67]
v_cvt_pk_bf16_f32 v88, v76, v77
v_cvt_pk_bf16_f32 v89, v78, v79
s_waitcnt lgkmcnt(4)
v_mfma_f32_16x16x32_bf16 v[52:55], a[192:195], v[20:23], v[52:55]
ds_read_b128 v[44:47], v9 offset:53248
v_mfma_f32_16x16x32_bf16 v[56:59], a[196:199], v[20:23], v[56:59]
v_mfma_f32_16x16x32_bf16 v[60:63], a[192:195], v[24:27], v[60:63]
ds_read_b128 v[48:51], v9 offset:55296
v_mfma_f32_16x16x32_bf16 v[64:67], a[196:199], v[24:27], v[64:67]
v_cvt_pk_bf16_f32 v90, v80, v81
v_cvt_pk_bf16_f32 v91, v82, v83
s_waitcnt lgkmcnt(4)
v_mfma_f32_16x16x32_bf16 v[52:55], a[200:203], v[28:31], v[52:55]
ds_read_b128 v[20:23], v8 offset:57344
v_mfma_f32_16x16x32_bf16 v[56:59], a[204:207], v[28:31], v[56:59]
v_mfma_f32_16x16x32_bf16 v[60:63], a[200:203], v[32:35], v[60:63]
ds_read_b128 v[24:27], v8 offset:59392
v_mfma_f32_16x16x32_bf16 v[64:67], a[204:207], v[32:35], v[64:67]
s_waitcnt lgkmcnt(4)
v_mfma_f32_16x16x32_bf16 v[52:55], a[208:211], v[36:39], v[52:55]
ds_read_b128 v[28:31], v9 offset:57344
v_mfma_f32_16x16x32_bf16 v[56:59], a[212:215], v[36:39], v[56:59]
v_mfma_f32_16x16x32_bf16 v[60:63], a[208:211], v[40:43], v[60:63]
ds_read_b128 v[32:35], v9 offset:59392
v_mfma_f32_16x16x32_bf16 v[64:67], a[212:215], v[40:43], v[64:67]
s_waitcnt lgkmcnt(4)
v_mfma_f32_16x16x32_bf16 v[52:55], a[216:219], v[44:47], v[52:55]
ds_read_b128 v[36:39], v8 offset:61440
v_mfma_f32_16x16x32_bf16 v[56:59], a[220:223], v[44:47], v[56:59]
s_waitcnt vmcnt(6)
v_readfirstlane_b32 s56, v100
s_cmp_eq_u32 s30, 1
s_cbranch_scc1 mega_kernel_q_kf0
s_cmp_gt_i32 s56, s42
s_cbranch_scc0 mega_kernel_q_kf0
s_mov_b32 s30, 1
s_mov_b32 m0, s61
s_nop 0
buffer_load_dwordx4 v5, s[84:87], s68 offen sc1 lds
mega_kernel_q_kf0:
v_mfma_f32_16x16x32_bf16 v[60:63], a[216:219], v[48:51], v[60:63]
ds_read_b128 v[40:43], v8 offset:63488
v_mfma_f32_16x16x32_bf16 v[64:67], a[220:223], v[48:51], v[64:67]
s_waitcnt lgkmcnt(4)
v_mfma_f32_16x16x32_bf16 v[52:55], a[224:227], v[20:23], v[52:55]
ds_read_b128 v[44:47], v9 offset:61440
v_mfma_f32_16x16x32_bf16 v[56:59], a[228:231], v[20:23], v[56:59]
v_mfma_f32_16x16x32_bf16 v[60:63], a[224:227], v[24:27], v[60:63]
ds_read_b128 v[48:51], v9 offset:63488
v_mfma_f32_16x16x32_bf16 v[64:67], a[228:231], v[24:27], v[64:67]
s_waitcnt lgkmcnt(5)
v_mfma_f32_16x16x32_bf16 v[52:55], a[232:235], v[28:31], v[52:55]
v_mfma_f32_16x16x32_bf16 v[56:59], a[236:239], v[28:31], v[56:59]
s_waitcnt lgkmcnt(4)
v_mfma_f32_16x16x32_bf16 v[60:63], a[232:235], v[32:35], v[60:63]
v_mfma_f32_16x16x32_bf16 v[64:67], a[236:239], v[32:35], v[64:67]
s_waitcnt lgkmcnt(3)
v_mfma_f32_16x16x32_bf16 v[52:55], a[240:243], v[36:39], v[52:55]
v_mfma_f32_16x16x32_bf16 v[56:59], a[244:247], v[36:39], v[56:59]
s_waitcnt lgkmcnt(2)
v_mfma_f32_16x16x32_bf16 v[60:63], a[240:243], v[40:43], v[60:63]
v_mfma_f32_16x16x32_bf16 v[64:67], a[244:247], v[40:43], v[64:67]
ds_write_b128 v101, v[84:87]
ds_write_b128 v101, v[88:91] offset:1024
s_waitcnt lgkmcnt(1)
v_mfma_f32_16x16x32_bf16 v[68:71], a[248:251], v[44:47], v[52:55]
v_mfma_f32_16x16x32_bf16 v[72:75], a[252:255], v[44:47], v[56:59]
s_waitcnt lgkmcnt(0)
v_mfma_f32_16x16x32_bf16 v[76:79], a[248:251], v[48:51], v[60:63]
v_mfma_f32_16x16x32_bf16 v[80:83], a[252:255], v[48:51], v[64:67]
mega_kernel_q_jl:
s_cmp_eq_u32 s30, 1
s_cbranch_scc1 mega_kernel_q_kl0
mega_kernel_q_kw0:
v_mov_b32 v100, 0
s_mov_b64 exec, 1
buffer_atomic_add v100, v16, s[84:87], s62 offen sc0 sc1
s_mov_b64 exec, -1
s_waitcnt vmcnt(0)
v_readfirstlane_b32 s56, v100
s_cmp_gt_i32 s56, s42
s_cbranch_scc0 mega_kernel_q_kw0
s_mov_b32 m0, s61
s_nop 0
buffer_load_dwordx4 v5, s[84:87], s68 offen sc1 lds
mega_kernel_q_kl0:
s_waitcnt lgkmcnt(0) vmcnt(0)
s_barrier
ds_read_b128 v[184:187], v102 offset:0
ds_read_b128 v[112:115], v103 offset:0
ds_read_b128 v[128:131], v103 offset:1024
ds_read_b128 v[188:191], v102 offset:2048
ds_read_b128 v[116:119], v103 offset:2048
ds_read_b128 v[132:135], v103 offset:3072
ds_read_b128 v[192:195], v102 offset:4096
ds_read_b128 v[120:123], v103 offset:4096
ds_read_b128 v[136:139], v103 offset:5120
ds_read_b128 v[196:199], v102 offset:6144
ds_read_b128 v[124:127], v103 offset:6144
ds_read_b128 v[140:143], v103 offset:7168
s_waitcnt lgkmcnt(9)
v_mfma_f32_16x16x32_bf16 v[200:203], v[112:115], v[184:187], 0
v_mfma_f32_16x16x32_bf16 v[204:207], v[128:131], v[184:187], 0
ds_read_b128 v[160:163], v94 offset:0
s_waitcnt lgkmcnt(7)
v_mfma_f32_16x16x32_bf16 v[200:203], v[116:119], v[188:191], v[200:203]
v_mfma_f32_16x16x32_bf16 v[204:207], v[132:135], v[188:191], v[204:207]
ds_read_b128 v[164:167], v94 offset:1024
s_waitcnt lgkmcnt(5)
v_mfma_f32_16x16x32_bf16 v[200:203], v[120:123], v[192:195], v[200:203]
v_mfma_f32_16x16x32_bf16 v[204:207], v[136:139], v[192:195], v[204:207]
ds_read_b128 v[168:171], v94 offset:2048
s_waitcnt lgkmcnt(3)
v_mfma_f32_16x16x32_bf16 v[200:203], v[124:127], v[196:199], v[200:203]
v_mfma_f32_16x16x32_bf16 v[204:207], v[140:143], v[196:199], v[204:207]
ds_read_b128 v[172:175], v94 offset:3072
s_waitcnt lgkmcnt(3)
v_mfma_f32_16x16x32_bf16 v[208:211], v[160:163], v[184:187], 0
ds_read_b128 v[144:147], v240 offset:0
ds_read_b64 v[176:177], v95 offset:0
s_waitcnt lgkmcnt(4)
v_mfma_f32_16x16x32_bf16 v[208:211], v[164:167], v[188:191], v[208:211]
ds_read_b128 v[148:151], v240 offset:1024
ds_read_b64 v[178:179], v95 offset:256
s_waitcnt lgkmcnt(5)
v_mfma_f32_16x16x32_bf16 v[208:211], v[168:171], v[192:195], v[208:211]
ds_read_b128 v[152:155], v240 offset:2048
ds_read_b64 v[180:181], v95 offset:1024
s_waitcnt lgkmcnt(6)
v_mfma_f32_16x16x32_bf16 v[208:211], v[172:175], v[196:199], v[208:211]
ds_read_b128 v[156:159], v240 offset:3072
ds_read_b64 v[182:183], v95 offset:1280
v_pk_mul_f32 v[200:201], v[200:201], s[54:55] op_sel_hi:[1,0]
v_pk_mul_f32 v[202:203], v[202:203], s[54:55] op_sel_hi:[1,0]
v_pk_mul_f32 v[204:205], v[204:205], s[54:55] op_sel_hi:[1,0]
v_pk_mul_f32 v[206:207], v[206:207], s[54:55] op_sel_hi:[1,0]
v_cndmask_b32 v200, v200, v241, s[12:13]
v_cndmask_b32 v201, v201, v241, s[14:15]
v_cndmask_b32 v202, v202, v241, s[16:17]
v_cndmask_b32 v203, v203, v241, s[18:19]
v_cndmask_b32 v204, v204, v241, s[20:21]
v_cndmask_b32 v205, v205, v241, s[22:23]
v_cndmask_b32 v206, v206, v241, s[24:25]
v_cndmask_b32 v207, v207, v241, s[26:27]
v_pk_mul_f32 v[208:209], v[208:209], s[54:55] op_sel_hi:[1,0]
v_pk_mul_f32 v[210:211], v[210:211], s[54:55] op_sel_hi:[1,0]
v_cndmask_b32 v208, v208, v97, s[28:29]
v_cndmask_b32 v209, v209, v97, s[28:29]
v_cndmask_b32 v210, v210, v97, s[28:29]
v_cndmask_b32 v211, v211, v97, s[28:29]
v_max3_f32 v236, v200, v201, v202
v_max3_f32 v236, v236, v203, v204
v_max3_f32 v236, v236, v205, v206
v_max3_f32 v236, v236, v207, v208
v_max3_f32 v236, v236, v209, v210
v_max_f32 v237, v236, v211
v_max_f32 v236, v236, v211
s_nop 1
v_permlane16_swap_b32 v236, v237
s_nop 0
v_max_f32 v238, v236, v237
v_max_f32 v239, v236, v237
s_nop 1
v_permlane32_swap_b32 v238, v239
s_nop 0
v_max_f32 v236, v238, v239
v_pk_add_f32 v[200:201], v[200:201], v[236:237] op_sel_hi:[1,0] neg_lo:[0,1] neg_hi:[0,1]
v_pk_add_f32 v[202:203], v[202:203], v[236:237] op_sel_hi:[1,0] neg_lo:[0,1] neg_hi:[0,1]
v_pk_add_f32 v[204:205], v[204:205], v[236:237] op_sel_hi:[1,0] neg_lo:[0,1] neg_hi:[0,1]
v_pk_add_f32 v[206:207], v[206:207], v[236:237] op_sel_hi:[1,0] neg_lo:[0,1] neg_hi:[0,1]
v_pk_add_f32 v[208:209], v[208:209], v[236:237] op_sel_hi:[1,0] neg_lo:[0,1] neg_hi:[0,1]
v_pk_add_f32 v[210:211], v[210:211], v[236:237] op_sel_hi:[1,0] neg_lo:[0,1] neg_hi:[0,1]
v_exp_f32 v200, v200
v_exp_f32 v201, v201
v_exp_f32 v202, v202
v_exp_f32 v203, v203
v_exp_f32 v204, v204
v_exp_f32 v205, v205
v_exp_f32 v206, v206
v_exp_f32 v207, v207
v_exp_f32 v208, v208
v_exp_f32 v209, v209
v_exp_f32 v210, v210
v_exp_f32 v211, v211
s_nop 0
v_cvt_pk_bf16_f32 v212, v200, v201
v_cvt_pk_bf16_f32 v213, v202, v203
v_cvt_pk_bf16_f32 v214, v204, v205
v_cvt_pk_bf16_f32 v215, v206, v207
v_cvt_pk_bf16_f32 v216, v208, v209
v_cvt_pk_bf16_f32 v217, v210, v211
s_waitcnt lgkmcnt(0)
s_nop 0
v_mfma_f32_16x16x32_bf16 v[108:111], v[104:107], v[212:215], 0
v_mfma_f32_16x16x32_bf16 v[220:223], v[144:147], v[212:215], 0
v_mfma_f32_16x16x32_bf16 v[224:227], v[148:151], v[212:215], 0
v_mfma_f32_16x16x32_bf16 v[228:231], v[152:155], v[212:215], 0
v_mfma_f32_16x16x32_bf16 v[232:235], v[156:159], v[212:215], 0
v_mfma_f32_16x16x16_bf16 v[108:111], v[104:105], v[216:217], v[108:111]
v_mfma_f32_16x16x16_bf16 v[220:223], v[176:177], v[216:217], v[220:223]
v_mfma_f32_16x16x16_bf16 v[224:227], v[178:179], v[216:217], v[224:227]
v_mfma_f32_16x16x16_bf16 v[228:231], v[180:181], v[216:217], v[228:231]
v_mfma_f32_16x16x16_bf16 v[232:235], v[182:183], v[216:217], v[232:235]
s_lshl_b32 s51, s42, 18
s_nop 2
v_rcp_f32 v238, v108
v_rcp_f32 v239, v109
s_nop 1
v_pk_mul_f32 v[220:221], v[220:221], v[238:239]
v_pk_mul_f32 v[222:223], v[222:223], v[238:239]
v_pk_mul_f32 v[224:225], v[224:225], v[238:239]
v_pk_mul_f32 v[226:227], v[226:227], v[238:239]
v_pk_mul_f32 v[228:229], v[228:229], v[238:239]
v_pk_mul_f32 v[230:231], v[230:231], v[238:239]
v_pk_mul_f32 v[232:233], v[232:233], v[238:239]
v_pk_mul_f32 v[234:235], v[234:235], v[238:239]
v_cvt_pk_bf16_f32 v200, v220, v221
v_cvt_pk_bf16_f32 v201, v222, v223
v_cvt_pk_bf16_f32 v202, v224, v225
v_cvt_pk_bf16_f32 v203, v226, v227
v_cvt_pk_bf16_f32 v204, v228, v229
v_cvt_pk_bf16_f32 v205, v230, v231
v_cvt_pk_bf16_f32 v206, v232, v233
v_cvt_pk_bf16_f32 v207, v234, v235
buffer_store_dwordx4 v[200:203], v96, s[84:87], s51 offen sc1
buffer_store_dwordx4 v[204:207], v96, s[84:87], s51 offen offset:2048 sc1
s_add_u32 s42, s42, 1
s_cmp_lt_u32 s42, 64
s_cbranch_scc1 mega_kernel_q_loop
s_waitcnt vmcnt(0)
v_mov_b32 v17, s42
s_mov_b64 exec, 1
buffer_store_dword v17, v16, s[84:87], s49 offen sc1
s_mov_b64 exec, -1
mega_kernel_q_quit:
s_endpgm
mega_kernel_rd:
s_mov_b32 s93, s40
s_load_dwordx2 s[4:5], s[0:1], 64
s_load_dwordx2 s[8:9], s[0:1], 72
v_and_b32 v1, 63, v0
v_lshrrev_b32 v2, 6, v0
v_mul_u32_u24 v3, 1026, v2
v_lshl_add_u32 v3, v1, 1, v3
v_mul_u32_u24 v4, 65, v1
v_add_u32 v4, v4, v2
v_lshlrev_b32 v4, 2, v4
v_lshrrev_b32 v7, 4, v0
v_and_b32 v8, 15, v0
v_mul_u32_u24 v5, 65, v7
v_lshl_add_u32 v5, v8, 2, v5
v_lshlrev_b32 v5, 2, v5
v_mul_u32_u24 v6, 8192, v7
v_lshl_add_u32 v6, v8, 4, v6
s_add_u32 s24, s84, 121634816
s_addc_u32 s25, s85, 0
s_mov_b32 s26, 4202496
s_mov_b32 s27, 0x00020000
s_waitcnt lgkmcnt(0)
s_mov_b32 s6, 2101248
s_mov_b32 s7, 0x00020000
s_mov_b32 s10, 2101248
s_mov_b32 s11, 0x00020000
s_cmp_lt_u32 s93, 288
s_cbranch_scc0 mega_kernel_f0_e
s_and_b32 s12, s93, 31
s_mul_i32 s12, s12, 65664
s_lshr_b32 s13, s93, 5
s_lshl_b32 s13, s13, 7
s_add_u32 s12, s12, s13
buffer_load_ushort v16, v3, s[4:7], s12 offen
buffer_load_ushort v32, v3, s[8:11], s12 offen
s_add_u32 s12, s12, 4104
buffer_load_ushort v17, v3, s[4:7], s12 offen
buffer_load_ushort v33, v3, s[8:11], s12 offen
s_add_u32 s12, s12, 4104
buffer_load_ushort v18, v3, s[4:7], s12 offen
buffer_load_ushort v34, v3, s[8:11], s12 offen
s_add_u32 s12, s12, 4104
buffer_load_ushort v19, v3, s[4:7], s12 offen
buffer_load_ushort v35, v3, s[8:11], s12 offen
s_add_u32 s12, s12, 4104
buffer_load_ushort v20, v3, s[4:7], s12 offen
buffer_load_ushort v36, v3, s[8:11], s12 offen
s_add_u32 s12, s12, 4104
buffer_load_ushort v21, v3, s[4:7], s12 offen
buffer_load_ushort v37, v3, s[8:11], s12 offen
s_add_u32 s12, s12, 4104
buffer_load_ushort v22, v3, s[4:7], s12 offen
buffer_load_ushort v38, v3, s[8:11], s12 offen
s_add_u32 s12, s12, 4104
buffer_load_ushort v23, v3, s[4:7], s12 offen
buffer_load_ushort v39, v3, s[8:11], s12 offen
s_add_u32 s12, s12, 4104
buffer_load_ushort v24, v3, s[4:7], s12 offen
buffer_load_ushort v40, v3, s[8:11], s12 offen
s_add_u32 s12, s12, 4104
buffer_load_ushort v25, v3, s[4:7], s12 offen
buffer_load_ushort v41, v3, s[8:11], s12 offen
s_add_u32 s12, s12, 4104
buffer_load_ushort v26, v3, s[4:7], s12 offen
buffer_load_ushort v42, v3, s[8:11], s12 offen
s_add_u32 s12, s12, 4104
buffer_load_ushort v27, v3, s[4:7], s12 offen
buffer_load_ushort v43, v3, s[8:11], s12 offen
s_add_u32 s12, s12, 4104
buffer_load_ushort v28, v3, s[4:7], s12 offen
buffer_load_ushort v44, v3, s[8:11], s12 offen
s_add_u32 s12, s12, 4104
buffer_load_ushort v29, v3, s[4:7], s12 offen
buffer_load_ushort v45, v3, s[8:11], s12 offen
s_add_u32 s12, s12, 4104
buffer_load_ushort v30, v3, s[4:7], s12 offen
buffer_load_ushort v46, v3, s[8:11], s12 offen
s_add_u32 s12, s12, 4104
buffer_load_ushort v31, v3, s[4:7], s12 offen
buffer_load_ushort v47, v3, s[8:11], s12 offen
s_add_u32 s12, s12, 4104
s_waitcnt vmcnt(0)
mega_kernel_f0_l:
s_add_u32 s21, s93, 32
s_cmp_lt_u32 s21, 288
s_cselect_b32 s22, s21, s93
s_waitcnt vmcnt(4)
v_lshl_or_b32 v48, v32, 16, v16
v_lshl_or_b32 v49, v33, 16, v17
v_lshl_or_b32 v50, v34, 16, v18
v_lshl_or_b32 v51, v35, 16, v19
v_lshl_or_b32 v52, v36, 16, v20
v_lshl_or_b32 v53, v37, 16, v21
v_lshl_or_b32 v54, v38, 16, v22
v_lshl_or_b32 v55, v39, 16, v23
v_lshl_or_b32 v56, v40, 16, v24
v_lshl_or_b32 v57, v41, 16, v25
v_lshl_or_b32 v58, v42, 16, v26
v_lshl_or_b32 v59, v43, 16, v27
v_lshl_or_b32 v60, v44, 16, v28
v_lshl_or_b32 v61, v45, 16, v29
v_lshl_or_b32 v62, v46, 16, v30
v_lshl_or_b32 v63, v47, 16, v31
s_and_b32 s12, s22, 31
s_mul_i32 s12, s12, 65664
s_lshr_b32 s13, s22, 5
s_lshl_b32 s13, s13, 7
s_add_u32 s12, s12, s13
buffer_load_ushort v16, v3, s[4:7], s12 offen
buffer_load_ushort v32, v3, s[8:11], s12 offen
s_add_u32 s12, s12, 4104
buffer_load_ushort v17, v3, s[4:7], s12 offen
buffer_load_ushort v33, v3, s[8:11], s12 offen
s_add_u32 s12, s12, 4104
buffer_load_ushort v18, v3, s[4:7], s12 offen
buffer_load_ushort v34, v3, s[8:11], s12 offen
s_add_u32 s12, s12, 4104
buffer_load_ushort v19, v3, s[4:7], s12 offen
buffer_load_ushort v35, v3, s[8:11], s12 offen
s_add_u32 s12, s12, 4104
buffer_load_ushort v20, v3, s[4:7], s12 offen
buffer_load_ushort v36, v3, s[8:11], s12 offen
s_add_u32 s12, s12, 4104
buffer_load_ushort v21, v3, s[4:7], s12 offen
buffer_load_ushort v37, v3, s[8:11], s12 offen
s_add_u32 s12, s12, 4104
buffer_load_ushort v22, v3, s[4:7], s12 offen
buffer_load_ushort v38, v3, s[8:11], s12 offen
s_add_u32 s12, s12, 4104
buffer_load_ushort v23, v3, s[4:7], s12 offen
buffer_load_ushort v39, v3, s[8:11], s12 offen
s_add_u32 s12, s12, 4104
buffer_load_ushort v24, v3, s[4:7], s12 offen
buffer_load_ushort v40, v3, s[8:11], s12 offen
s_add_u32 s12, s12, 4104
buffer_load_ushort v25, v3, s[4:7], s12 offen
buffer_load_ushort v41, v3, s[8:11], s12 offen
s_add_u32 s12, s12, 4104
buffer_load_ushort v26, v3, s[4:7], s12 offen
buffer_load_ushort v42, v3, s[8:11], s12 offen
s_add_u32 s12, s12, 4104
buffer_load_ushort v27, v3, s[4:7], s12 offen
buffer_load_ushort v43, v3, s[8:11], s12 offen
s_add_u32 s12, s12, 4104
buffer_load_ushort v28, v3, s[4:7], s12 offen
buffer_load_ushort v44, v3, s[8:11], s12 offen
s_add_u32 s12, s12, 4104
buffer_load_ushort v29, v3, s[4:7], s12 offen
buffer_load_ushort v45, v3, s[8:11], s12 offen
s_add_u32 s12, s12, 4104
buffer_load_ushort v30, v3, s[4:7], s12 offen
buffer_load_ushort v46, v3, s[8:11], s12 offen
s_add_u32 s12, s12, 4104
buffer_load_ushort v31, v3, s[4:7], s12 offen
buffer_load_ushort v47, v3, s[8:11], s12 offen
s_add_u32 s12, s12, 4104
s_barrier
ds_write_b32 v4, v48 offset:0
ds_write_b32 v4, v49 offset:16
ds_write_b32 v4, v50 offset:32
ds_write_b32 v4, v51 offset:48
ds_write_b32 v4, v52 offset:64
ds_write_b32 v4, v53 offset:80
ds_write_b32 v4, v54 offset:96
ds_write_b32 v4, v55 offset:112
ds_write_b32 v4, v56 offset:128
ds_write_b32 v4, v57 offset:144
ds_write_b32 v4, v58 offset:160
ds_write_b32 v4, v59 offset:176
s_waitcnt lgkmcnt(4)
ds_write_b32 v4, v60 offset:192
ds_write_b32 v4, v61 offset:208
ds_write_b32 v4, v62 offset:224
ds_write_b32 v4, v63 offset:240
s_waitcnt lgkmcnt(0)
s_barrier
ds_read2_b32 v[64:65], v5 offset0:0 offset1:1
ds_read_b32 v66, v5 offset:8
ds_read_b32 v67, v5 offset:12
ds_read_b32 v68, v5 offset:4160
ds_read_b32 v69, v5 offset:4164
ds_read_b32 v70, v5 offset:4168
ds_read_b32 v71, v5 offset:4172
ds_read_b32 v72, v5 offset:8320
ds_read_b32 v73, v5 offset:8324
ds_read_b32 v74, v5 offset:8328
ds_read_b32 v75, v5 offset:8332
ds_read_b32 v76, v5 offset:12480
ds_read_b32 v77, v5 offset:12484
ds_read_b32 v78, v5 offset:12488
ds_read_b32 v79, v5 offset:12492
s_and_b32 s14, s93, 31
s_lshl_b32 s14, s14, 8
s_lshr_b32 s15, s93, 5
s_mul_i32 s15, s15, 524288
s_add_u32 s14, s14, s15
s_waitcnt lgkmcnt(0)
buffer_store_dwordx4 v[64:67], v6, s[24:27], s14 offen sc1
s_add_u32 s14, s14, 131072
buffer_store_dwordx4 v[68:71], v6, s[24:27], s14 offen sc1
s_add_u32 s14, s14, 131072
buffer_store_dwordx4 v[72:75], v6, s[24:27], s14 offen sc1
s_add_u32 s14, s14, 131072
buffer_store_dwordx4 v[76:79], v6, s[24:27], s14 offen sc1
s_add_u32 s14, s14, 131072
s_mov_b32 s93, s21
s_cmp_lt_u32 s93, 288
s_cbranch_scc1 mega_kernel_f0_l
mega_kernel_f0_e:
s_mov_b32 s93, s40
s_waitcnt vmcnt(0)
s_load_dwordx2 s[4:5], s[0:1], 56
s_mov_b32 s48, 0x3f7ec46d
s_mov_b32 s49, 0x3dc8bd36
s_mov_b32 s50, 0x3f7b14be
s_mov_b32 s51, 0x3e47c5c2
s_mov_b32 s52, 0x3f74fa0b
s_mov_b32 s53, 0x3e94a031
s_mov_b32 s54, 0x3f6c835e
s_mov_b32 s55, 0x3ec3ef15
s_mov_b32 s56, 0x3f61c598
s_mov_b32 s57, 0x3ef15aea
s_mov_b32 s58, 0x3f54db31
s_mov_b32 s59, 0x3f0e39da
s_mov_b32 s60, 0x3f45e403
s_mov_b32 s61, 0x3f226799
s_mov_b32 s62, 0x3f3504f3
s_mov_b32 s63, 0x3f3504f3
v_and_b32 v1, 31, v0
v_lshrrev_b32 v2, 5, v0
v_cvt_f32_u32 v3, v1
v_mul_u32_u24 v10, 8448, v2
v_lshl_add_u32 v4, v1, 3, v10
v_mul_u32_u24 v5, 264, v1
v_add_u32 v5, v5, v10
v_and_b32 v11, 7, v0
v_lshrrev_b32 v9, 3, v0
v_mul_u32_u24 v10, 8448, v11
v_lshl_add_u32 v6, v9, 3, v10
v_lshlrev_b32 v7, 3, v9
v_sub_u32 v7, v10, v7
v_add_u32 v7, 4096, v7
v_mul_u32_u24 v8, 16384, v9
v_lshl_add_u32 v8, v11, 4, v8
v_mul_f32 v12, 0xba800000, v3
v_cos_f32 v82, v12
v_sin_f32 v83, v12
v_mul_f32 v12, 0xbb000000, v3
v_cos_f32 v84, v12
v_sin_f32 v85, v12
v_mul_f32 v12, 0xbb400000, v3
v_cos_f32 v86, v12
v_sin_f32 v87, v12
v_mul_f32 v12, 0xbb800000, v3
v_cos_f32 v88, v12
v_sin_f32 v89, v12
v_mul_f32 v12, 0xbba00000, v3
v_cos_f32 v90, v12
v_sin_f32 v91, v12
v_mul_f32 v12, 0xbbc00000, v3
v_cos_f32 v92, v12
v_sin_f32 v93, v12
v_mul_f32 v12, 0xbbe00000, v3
v_cos_f32 v94, v12
v_sin_f32 v95, v12
v_mul_f32 v12, 0xbc000000, v3
v_cos_f32 v96, v12
v_sin_f32 v97, v12
v_mul_f32 v12, 0xbc100000, v3
v_cos_f32 v98, v12
v_sin_f32 v99, v12
v_mul_f32 v12, 0xbc200000, v3
v_cos_f32 v100, v12
v_sin_f32 v101, v12
v_mul_f32 v12, 0xbc300000, v3
v_cos_f32 v102, v12
v_sin_f32 v103, v12
v_mul_f32 v12, 0xbc400000, v3
v_cos_f32 v104, v12
v_sin_f32 v105, v12
v_mul_f32 v12, 0xbc500000, v3
v_cos_f32 v106, v12
v_sin_f32 v107, v12
v_mul_f32 v12, 0xbc600000, v3
v_cos_f32 v108, v12
v_sin_f32 v109, v12
v_mul_f32 v12, 0xbc700000, v3
v_cos_f32 v110, v12
v_sin_f32 v111, v12
v_mul_f32 v12, 0xbc800000, v3
v_cos_f32 v112, v12
v_sin_f32 v113, v12
v_mul_f32 v12, 0xbc880000, v3
v_cos_f32 v114, v12
v_sin_f32 v115, v12
v_mul_f32 v12, 0xbc900000, v3
v_cos_f32 v116, v12
v_sin_f32 v117, v12
v_mul_f32 v12, 0xbc980000, v3
v_cos_f32 v118, v12
v_sin_f32 v119, v12
v_mul_f32 v12, 0xbca00000, v3
v_cos_f32 v120, v12
v_sin_f32 v121, v12
v_mul_f32 v12, 0xbca80000, v3
v_cos_f32 v122, v12
v_sin_f32 v123, v12
v_mul_f32 v12, 0xbcb00000, v3
v_cos_f32 v124, v12
v_sin_f32 v125, v12
v_mul_f32 v12, 0xbcb80000, v3
v_cos_f32 v126, v12
v_sin_f32 v127, v12
v_mul_f32 v12, 0xbcc00000, v3
v_cos_f32 v128, v12
v_sin_f32 v129, v12
v_mul_f32 v12, 0xbcc80000, v3
v_cos_f32 v130, v12
v_sin_f32 v131, v12
v_mul_f32 v12, 0xbcd00000, v3
v_cos_f32 v132, v12
v_sin_f32 v133, v12
v_mul_f32 v12, 0xbcd80000, v3
v_cos_f32 v134, v12
v_sin_f32 v135, v12
v_mul_f32 v12, 0xbce00000, v3
v_cos_f32 v136, v12
v_sin_f32 v137, v12
v_mul_f32 v12, 0xbce80000, v3
v_cos_f32 v138, v12
v_sin_f32 v139, v12
v_mul_f32 v12, 0xbcf00000, v3
v_cos_f32 v140, v12
v_sin_f32 v141, v12
v_mul_f32 v12, 0xbcf80000, v3
v_cos_f32 v142, v12
v_sin_f32 v143, v12
v_lshlrev_b32 v12, 12, v2
v_lshl_add_u32 v12, v1, 1, v12
s_waitcnt lgkmcnt(0)
s_mov_b32 s6, 4194304
s_mov_b32 s7, 0x00020000
v_mov_b32 v144, 0
v_mov_b32 v145, 0
v_mov_b32 v146, 0
v_mov_b32 v147, 0
v_mov_b32 v148, 0
v_mov_b32 v149, 0
v_mov_b32 v150, 0
v_mov_b32 v151, 0
v_mov_b32 v152, 0
v_mov_b32 v153, 0
v_mov_b32 v154, 0
v_mov_b32 v155, 0
v_mov_b32 v156, 0
v_mov_b32 v157, 0
v_mov_b32 v158, 0
v_mov_b32 v159, 0
v_mov_b32 v160, 0
v_mov_b32 v161, 0
v_mov_b32 v162, 0
v_mov_b32 v163, 0
v_mov_b32 v164, 0
v_mov_b32 v165, 0
v_mov_b32 v166, 0
v_mov_b32 v167, 0
v_mov_b32 v168, 0
v_mov_b32 v169, 0
v_mov_b32 v170, 0
v_mov_b32 v171, 0
v_mov_b32 v172, 0
v_mov_b32 v173, 0
v_mov_b32 v174, 0
v_mov_b32 v175, 0
v_mov_b32 v176, 0
v_mov_b32 v177, 0
v_mov_b32 v178, 0
v_mov_b32 v179, 0
v_mov_b32 v180, 0
v_mov_b32 v181, 0
v_mov_b32 v182, 0
v_mov_b32 v183, 0
v_mov_b32 v184, 0
v_mov_b32 v185, 0
v_mov_b32 v186, 0
v_mov_b32 v187, 0
v_mov_b32 v188, 0
v_mov_b32 v189, 0
v_mov_b32 v190, 0
v_mov_b32 v191, 0
v_mov_b32 v192, 0
v_mov_b32 v193, 0
v_mov_b32 v194, 0
v_mov_b32 v195, 0
v_mov_b32 v196, 0
v_mov_b32 v197, 0
v_mov_b32 v198, 0
v_mov_b32 v199, 0
v_mov_b32 v200, 0
v_mov_b32 v201, 0
v_mov_b32 v202, 0
v_mov_b32 v203, 0
v_mov_b32 v204, 0
v_mov_b32 v205, 0
v_mov_b32 v206, 0
v_mov_b32 v207, 0
s_cmp_lt_u32 s93, 128
s_cbranch_scc0 mega_kernel_f1_e
s_lshl_b32 s12, s93, 15
buffer_load_short_d16_hi v144, v12, s[4:7], s12 offen offset:0
buffer_load_short_d16_hi v145, v12, s[4:7], s12 offen offset:2048
buffer_load_short_d16_hi v176, v12, s[4:7], s12 offen offset:1024
buffer_load_short_d16_hi v177, v12, s[4:7], s12 offen offset:3072
buffer_load_short_d16_hi v146, v12, s[4:7], s12 offen offset:64
buffer_load_short_d16_hi v147, v12, s[4:7], s12 offen offset:2112
buffer_load_short_d16_hi v178, v12, s[4:7], s12 offen offset:1088
buffer_load_short_d16_hi v179, v12, s[4:7], s12 offen offset:3136
buffer_load_short_d16_hi v148, v12, s[4:7], s12 offen offset:128
buffer_load_short_d16_hi v149, v12, s[4:7], s12 offen offset:2176
buffer_load_short_d16_hi v180, v12, s[4:7], s12 offen offset:1152
buffer_load_short_d16_hi v181, v12, s[4:7], s12 offen offset:3200
buffer_load_short_d16_hi v150, v12, s[4:7], s12 offen offset:192
buffer_load_short_d16_hi v151, v12, s[4:7], s12 offen offset:2240
buffer_load_short_d16_hi v182, v12, s[4:7], s12 offen offset:1216
buffer_load_short_d16_hi v183, v12, s[4:7], s12 offen offset:3264
buffer_load_short_d16_hi v152, v12, s[4:7], s12 offen offset:256
buffer_load_short_d16_hi v153, v12, s[4:7], s12 offen offset:2304
buffer_load_short_d16_hi v184, v12, s[4:7], s12 offen offset:1280
buffer_load_short_d16_hi v185, v12, s[4:7], s12 offen offset:3328
buffer_load_short_d16_hi v154, v12, s[4:7], s12 offen offset:320
buffer_load_short_d16_hi v155, v12, s[4:7], s12 offen offset:2368
buffer_load_short_d16_hi v186, v12, s[4:7], s12 offen offset:1344
buffer_load_short_d16_hi v187, v12, s[4:7], s12 offen offset:3392
buffer_load_short_d16_hi v156, v12, s[4:7], s12 offen offset:384
buffer_load_short_d16_hi v157, v12, s[4:7], s12 offen offset:2432
buffer_load_short_d16_hi v188, v12, s[4:7], s12 offen offset:1408
buffer_load_short_d16_hi v189, v12, s[4:7], s12 offen offset:3456
buffer_load_short_d16_hi v158, v12, s[4:7], s12 offen offset:448
buffer_load_short_d16_hi v159, v12, s[4:7], s12 offen offset:2496
buffer_load_short_d16_hi v190, v12, s[4:7], s12 offen offset:1472
buffer_load_short_d16_hi v191, v12, s[4:7], s12 offen offset:3520
buffer_load_short_d16_hi v160, v12, s[4:7], s12 offen offset:512
buffer_load_short_d16_hi v161, v12, s[4:7], s12 offen offset:2560
buffer_load_short_d16_hi v192, v12, s[4:7], s12 offen offset:1536
buffer_load_short_d16_hi v193, v12, s[4:7], s12 offen offset:3584
buffer_load_short_d16_hi v162, v12, s[4:7], s12 offen offset:576
buffer_load_short_d16_hi v163, v12, s[4:7], s12 offen offset:2624
buffer_load_short_d16_hi v194, v12, s[4:7], s12 offen offset:1600
buffer_load_short_d16_hi v195, v12, s[4:7], s12 offen offset:3648
buffer_load_short_d16_hi v164, v12, s[4:7], s12 offen offset:640
buffer_load_short_d16_hi v165, v12, s[4:7], s12 offen offset:2688
buffer_load_short_d16_hi v196, v12, s[4:7], s12 offen offset:1664
buffer_load_short_d16_hi v197, v12, s[4:7], s12 offen offset:3712
buffer_load_short_d16_hi v166, v12, s[4:7], s12 offen offset:704
buffer_load_short_d16_hi v167, v12, s[4:7], s12 offen offset:2752
buffer_load_short_d16_hi v198, v12, s[4:7], s12 offen offset:1728
buffer_load_short_d16_hi v199, v12, s[4:7], s12 offen offset:3776
buffer_load_short_d16_hi v168, v12, s[4:7], s12 offen offset:768
buffer_load_short_d16_hi v169, v12, s[4:7], s12 offen offset:2816
buffer_load_short_d16_hi v200, v12, s[4:7], s12 offen offset:1792
buffer_load_short_d16_hi v201, v12, s[4:7], s12 offen offset:3840
buffer_load_short_d16_hi v170, v12, s[4:7], s12 offen offset:832
buffer_load_short_d16_hi v171, v12, s[4:7], s12 offen offset:2880
buffer_load_short_d16_hi v202, v12, s[4:7], s12 offen offset:1856
buffer_load_short_d16_hi v203, v12, s[4:7], s12 offen offset:3904
buffer_load_short_d16_hi v172, v12, s[4:7], s12 offen offset:896
buffer_load_short_d16_hi v173, v12, s[4:7], s12 offen offset:2944
buffer_load_short_d16_hi v204, v12, s[4:7], s12 offen offset:1920
buffer_load_short_d16_hi v205, v12, s[4:7], s12 offen offset:3968
buffer_load_short_d16_hi v174, v12, s[4:7], s12 offen offset:960
buffer_load_short_d16_hi v175, v12, s[4:7], s12 offen offset:3008
buffer_load_short_d16_hi v206, v12, s[4:7], s12 offen offset:1984
buffer_load_short_d16_hi v207, v12, s[4:7], s12 offen offset:4032
s_waitcnt vmcnt(0)
mega_kernel_f1_l:
s_add_u32 s21, s93, 32
s_cmp_lt_u32 s21, 128
s_cselect_b32 s22, s21, s93
s_waitcnt vmcnt(17)
v_pk_add_f32 v[48:49], v[144:145], v[176:177] neg_lo:[0,1] neg_hi:[0,1]
v_pk_add_f32 v[16:17], v[144:145], v[176:177]
v_pk_add_f32 v[14:15], v[146:147], v[178:179] neg_lo:[0,1] neg_hi:[0,1]
v_pk_add_f32 v[18:19], v[146:147], v[178:179]
v_pk_mul_f32 v[50:51], v[14:15], s[50:51] op_sel:[0,0] op_sel_hi:[0,1] neg_lo:[0,0] neg_hi:[0,1]
v_pk_fma_f32 v[50:51], v[14:15], s[50:51], v[50:51] op_sel:[1,1,0] op_sel_hi:[1,0,1] neg_lo:[0,0,0] neg_hi:[0,0,0]
v_pk_add_f32 v[14:15], v[148:149], v[180:181] neg_lo:[0,1] neg_hi:[0,1]
v_pk_add_f32 v[20:21], v[148:149], v[180:181]
v_pk_mul_f32 v[52:53], v[14:15], s[54:55] op_sel:[0,0] op_sel_hi:[0,1] neg_lo:[0,0] neg_hi:[0,1]
v_pk_fma_f32 v[52:53], v[14:15], s[54:55], v[52:53] op_sel:[1,1,0] op_sel_hi:[1,0,1] neg_lo:[0,0,0] neg_hi:[0,0,0]
v_pk_add_f32 v[14:15], v[150:151], v[182:183] neg_lo:[0,1] neg_hi:[0,1]
v_pk_add_f32 v[22:23], v[150:151], v[182:183]
v_pk_mul_f32 v[54:55], v[14:15], s[58:59] op_sel:[0,0] op_sel_hi:[0,1] neg_lo:[0,0] neg_hi:[0,1]
v_pk_fma_f32 v[54:55], v[14:15], s[58:59], v[54:55] op_sel:[1,1,0] op_sel_hi:[1,0,1] neg_lo:[0,0,0] neg_hi:[0,0,0]
v_pk_add_f32 v[14:15], v[152:153], v[184:185] neg_lo:[0,1] neg_hi:[0,1]
v_pk_add_f32 v[24:25], v[152:153], v[184:185]
v_pk_mul_f32 v[56:57], v[14:15], s[62:63] op_sel:[0,0] op_sel_hi:[0,1] neg_lo:[0,0] neg_hi:[0,1]
v_pk_fma_f32 v[56:57], v[14:15], s[62:63], v[56:57] op_sel:[1,1,0] op_sel_hi:[1,0,1] neg_lo:[0,0,0] neg_hi:[0,0,0]
v_pk_add_f32 v[14:15], v[154:155], v[186:187] neg_lo:[0,1] neg_hi:[0,1]
v_pk_add_f32 v[26:27], v[154:155], v[186:187]
v_pk_mul_f32 v[58:59], v[14:15], s[58:59] op_sel:[0,1] op_sel_hi:[0,0] neg_lo:[0,0] neg_hi:[0,1]
v_pk_fma_f32 v[58:59], v[14:15], s[58:59], v[58:59] op_sel:[1,0,0] op_sel_hi:[1,1,1] neg_lo:[0,0,0] neg_hi:[0,0,0]
v_pk_add_f32 v[14:15], v[156:157], v[188:189] neg_lo:[0,1] neg_hi:[0,1]
v_pk_add_f32 v[28:29], v[156:157], v[188:189]
v_pk_mul_f32 v[60:61], v[14:15], s[54:55] op_sel:[0,1] op_sel_hi:[0,0] neg_lo:[0,0] neg_hi:[0,1]
v_pk_fma_f32 v[60:61], v[14:15], s[54:55], v[60:61] op_sel:[1,0,0] op_sel_hi:[1,1,1] neg_lo:[0,0,0] neg_hi:[0,0,0]
v_pk_add_f32 v[14:15], v[158:159], v[190:191] neg_lo:[0,1] neg_hi:[0,1]
v_pk_add_f32 v[30:31], v[158:159], v[190:191]
v_pk_mul_f32 v[62:63], v[14:15], s[50:51] op_sel:[0,1] op_sel_hi:[0,0] neg_lo:[0,0] neg_hi:[0,1]
v_pk_fma_f32 v[62:63], v[14:15], s[50:51], v[62:63] op_sel:[1,0,0] op_sel_hi:[1,1,1] neg_lo:[0,0,0] neg_hi:[0,0,0]
v_pk_add_f32 v[64:65], v[160:161], v[192:193] op_sel:[1,1] op_sel_hi:[0,0] neg_lo:[0,1] neg_hi:[1,0]
v_pk_add_f32 v[32:33], v[160:161], v[192:193]
v_pk_add_f32 v[14:15], v[162:163], v[194:195] neg_lo:[0,1] neg_hi:[0,1]
v_pk_add_f32 v[34:35], v[162:163], v[194:195]
v_pk_mul_f32 v[66:67], v[14:15], s[50:51] op_sel:[0,1] op_sel_hi:[0,0] neg_lo:[0,1] neg_hi:[0,1]
v_pk_fma_f32 v[66:67], v[14:15], s[50:51], v[66:67] op_sel:[1,0,0] op_sel_hi:[1,1,1] neg_lo:[0,0,0] neg_hi:[0,1,0]
v_pk_add_f32 v[14:15], v[164:165], v[196:197] neg_lo:[0,1] neg_hi:[0,1]
v_pk_add_f32 v[36:37], v[164:165], v[196:197]
v_pk_mul_f32 v[68:69], v[14:15], s[54:55] op_sel:[0,1] op_sel_hi:[0,0] neg_lo:[0,1] neg_hi:[0,1]
v_pk_fma_f32 v[68:69], v[14:15], s[54:55], v[68:69] op_sel:[1,0,0] op_sel_hi:[1,1,1] neg_lo:[0,0,0] neg_hi:[0,1,0]
v_pk_add_f32 v[14:15], v[166:167], v[198:199] neg_lo:[0,1] neg_hi:[0,1]
v_pk_add_f32 v[38:39], v[166:167], v[198:199]
v_pk_mul_f32 v[70:71], v[14:15], s[58:59] op_sel:[0,1] op_sel_hi:[0,0] neg_lo:[0,1] neg_hi:[0,1]
v_pk_fma_f32 v[70:71], v[14:15], s[58:59], v[70:71] op_sel:[1,0,0] op_sel_hi:[1,1,1] neg_lo:[0,0,0] neg_hi:[0,1,0]
v_pk_add_f32 v[14:15], v[168:169], v[200:201] neg_lo:[0,1] neg_hi:[0,1]
v_pk_add_f32 v[40:41], v[168:169], v[200:201]
v_pk_mul_f32 v[72:73], v[14:15], s[62:63] op_sel:[0,0] op_sel_hi:[0,1] neg_lo:[0,1] neg_hi:[0,1]
v_pk_fma_f32 v[72:73], v[14:15], s[62:63], v[72:73] op_sel:[1,1,0] op_sel_hi:[1,0,1] neg_lo:[0,0,0] neg_hi:[0,1,0]
v_pk_add_f32 v[14:15], v[170:171], v[202:203] neg_lo:[0,1] neg_hi:[0,1]
v_pk_add_f32 v[42:43], v[170:171], v[202:203]
v_pk_mul_f32 v[74:75], v[14:15], s[58:59] op_sel:[0,0] op_sel_hi:[0,1] neg_lo:[0,1] neg_hi:[0,1]
v_pk_fma_f32 v[74:75], v[14:15], s[58:59], v[74:75] op_sel:[1,1,0] op_sel_hi:[1,0,1] neg_lo:[0,0,0] neg_hi:[0,1,0]
v_pk_add_f32 v[14:15], v[172:173], v[204:205] neg_lo:[0,1] neg_hi:[0,1]
v_pk_add_f32 v[44:45], v[172:173], v[204:205]
v_pk_mul_f32 v[76:77], v[14:15], s[54:55] op_sel:[0,0] op_sel_hi:[0,1] neg_lo:[0,1] neg_hi:[0,1]
v_pk_fma_f32 v[76:77], v[14:15], s[54:55], v[76:77] op_sel:[1,1,0] op_sel_hi:[1,0,1] neg_lo:[0,0,0] neg_hi:[0,1,0]
v_pk_add_f32 v[14:15], v[174:175], v[206:207] neg_lo:[0,1] neg_hi:[0,1]
v_pk_add_f32 v[46:47], v[174:175], v[206:207]
v_pk_mul_f32 v[78:79], v[14:15], s[50:51] op_sel:[0,0] op_sel_hi:[0,1] neg_lo:[0,1] neg_hi:[0,1]
v_pk_fma_f32 v[78:79], v[14:15], s[50:51], v[78:79] op_sel:[1,1,0] op_sel_hi:[1,0,1] neg_lo:[0,0,0] neg_hi:[0,1,0]
s_lshl_b32 s12, s22, 15
buffer_load_short_d16_hi v144, v12, s[4:7], s12 offen offset:0
buffer_load_short_d16_hi v145, v12, s[4:7], s12 offen offset:2048
buffer_load_short_d16_hi v176, v12, s[4:7], s12 offen offset:1024
buffer_load_short_d16_hi v177, v12, s[4:7], s12 offen offset:3072
buffer_load_short_d16_hi v146, v12, s[4:7], s12 offen offset:64
buffer_load_short_d16_hi v147, v12, s[4:7], s12 offen offset:2112
buffer_load_short_d16_hi v178, v12, s[4:7], s12 offen offset:1088
buffer_load_short_d16_hi v179, v12, s[4:7], s12 offen offset:3136
buffer_load_short_d16_hi v148, v12, s[4:7], s12 offen offset:128
buffer_load_short_d16_hi v149, v12, s[4:7], s12 offen offset:2176
buffer_load_short_d16_hi v180, v12, s[4:7], s12 offen offset:1152
buffer_load_short_d16_hi v181, v12, s[4:7], s12 offen offset:3200
buffer_load_short_d16_hi v150, v12, s[4:7], s12 offen offset:192
buffer_load_short_d16_hi v151, v12, s[4:7], s12 offen offset:2240
buffer_load_short_d16_hi v182, v12, s[4:7], s12 offen offset:1216
buffer_load_short_d16_hi v183, v12, s[4:7], s12 offen offset:3264
buffer_load_short_d16_hi v152, v12, s[4:7], s12 offen offset:256
buffer_load_short_d16_hi v153, v12, s[4:7], s12 offen offset:2304
buffer_load_short_d16_hi v184, v12, s[4:7], s12 offen offset:1280
buffer_load_short_d16_hi v185, v12, s[4:7], s12 offen offset:3328
buffer_load_short_d16_hi v154, v12, s[4:7], s12 offen offset:320
buffer_load_short_d16_hi v155, v12, s[4:7], s12 offen offset:2368
buffer_load_short_d16_hi v186, v12, s[4:7], s12 offen offset:1344
buffer_load_short_d16_hi v187, v12, s[4:7], s12 offen offset:3392
buffer_load_short_d16_hi v156, v12, s[4:7], s12 offen offset:384
buffer_load_short_d16_hi v157, v12, s[4:7], s12 offen offset:2432
buffer_load_short_d16_hi v188, v12, s[4:7], s12 offen offset:1408
buffer_load_short_d16_hi v189, v12, s[4:7], s12 offen offset:3456
buffer_load_short_d16_hi v158, v12, s[4:7], s12 offen offset:448
buffer_load_short_d16_hi v159, v12, s[4:7], s12 offen offset:2496
buffer_load_short_d16_hi v190, v12, s[4:7], s12 offen offset:1472
buffer_load_short_d16_hi v191, v12, s[4:7], s12 offen offset:3520
buffer_load_short_d16_hi v160, v12, s[4:7], s12 offen offset:512
buffer_load_short_d16_hi v161, v12, s[4:7], s12 offen offset:2560
buffer_load_short_d16_hi v192, v12, s[4:7], s12 offen offset:1536
buffer_load_short_d16_hi v193, v12, s[4:7], s12 offen offset:3584
buffer_load_short_d16_hi v162, v12, s[4:7], s12 offen offset:576
buffer_load_short_d16_hi v163, v12, s[4:7], s12 offen offset:2624
buffer_load_short_d16_hi v194, v12, s[4:7], s12 offen offset:1600
buffer_load_short_d16_hi v195, v12, s[4:7], s12 offen offset:3648
buffer_load_short_d16_hi v164, v12, s[4:7], s12 offen offset:640
buffer_load_short_d16_hi v165, v12, s[4:7], s12 offen offset:2688
buffer_load_short_d16_hi v196, v12, s[4:7], s12 offen offset:1664
buffer_load_short_d16_hi v197, v12, s[4:7], s12 offen offset:3712
buffer_load_short_d16_hi v166, v12, s[4:7], s12 offen offset:704
buffer_load_short_d16_hi v167, v12, s[4:7], s12 offen offset:2752
buffer_load_short_d16_hi v198, v12, s[4:7], s12 offen offset:1728
buffer_load_short_d16_hi v199, v12, s[4:7], s12 offen offset:3776
buffer_load_short_d16_hi v168, v12, s[4:7], s12 offen offset:768
buffer_load_short_d16_hi v169, v12, s[4:7], s12 offen offset:2816
buffer_load_short_d16_hi v200, v12, s[4:7], s12 offen offset:1792
buffer_load_short_d16_hi v201, v12, s[4:7], s12 offen offset:3840
buffer_load_short_d16_hi v170, v12, s[4:7], s12 offen offset:832
buffer_load_short_d16_hi v171, v12, s[4:7], s12 offen offset:2880
buffer_load_short_d16_hi v202, v12, s[4:7], s12 offen offset:1856
buffer_load_short_d16_hi v203, v12, s[4:7], s12 offen offset:3904
buffer_load_short_d16_hi v172, v12, s[4:7], s12 offen offset:896
buffer_load_short_d16_hi v173, v12, s[4:7], s12 offen offset:2944
buffer_load_short_d16_hi v204, v12, s[4:7], s12 offen offset:1920
buffer_load_short_d16_hi v205, v12, s[4:7], s12 offen offset:3968
buffer_load_short_d16_hi v174, v12, s[4:7], s12 offen offset:960
buffer_load_short_d16_hi v175, v12, s[4:7], s12 offen offset:3008
buffer_load_short_d16_hi v206, v12, s[4:7], s12 offen offset:1984
buffer_load_short_d16_hi v207, v12, s[4:7], s12 offen offset:4032
v_pk_add_f32 v[14:15], v[16:17], v[32:33] neg_lo:[0,1] neg_hi:[0,1]
v_pk_add_f32 v[16:17], v[16:17], v[32:33]
v_pk_add_f32 v[32:33], v[18:19], v[34:35] neg_lo:[0,1] neg_hi:[0,1]
v_pk_add_f32 v[18:19], v[18:19], v[34:35]
v_pk_mul_f32 v[34:35], v[32:33], s[54:55] op_sel:[0,0] op_sel_hi:[0,1] neg_lo:[0,0] neg_hi:[0,1]
v_pk_fma_f32 v[34:35], v[32:33], s[54:55], v[34:35] op_sel:[1,1,0] op_sel_hi:[1,0,1] neg_lo:[0,0,0] neg_hi:[0,0,0]
v_pk_add_f32 v[32:33], v[20:21], v[36:37] neg_lo:[0,1] neg_hi:[0,1]
v_pk_add_f32 v[20:21], v[20:21], v[36:37]
v_pk_mul_f32 v[36:37], v[32:33], s[62:63] op_sel:[0,0] op_sel_hi:[0,1] neg_lo:[0,0] neg_hi:[0,1]
v_pk_fma_f32 v[36:37], v[32:33], s[62:63], v[36:37] op_sel:[1,1,0] op_sel_hi:[1,0,1] neg_lo:[0,0,0] neg_hi:[0,0,0]
v_pk_add_f32 v[32:33], v[22:23], v[38:39] neg_lo:[0,1] neg_hi:[0,1]
v_pk_add_f32 v[22:23], v[22:23], v[38:39]
v_pk_mul_f32 v[38:39], v[32:33], s[54:55] op_sel:[0,1] op_sel_hi:[0,0] neg_lo:[0,0] neg_hi:[0,1]
v_pk_fma_f32 v[38:39], v[32:33], s[54:55], v[38:39] op_sel:[1,0,0] op_sel_hi:[1,1,1] neg_lo:[0,0,0] neg_hi:[0,0,0]
v_pk_add_f32 v[32:33], v[24:25], v[40:41] op_sel:[1,1] op_sel_hi:[0,0] neg_lo:[0,1] neg_hi:[1,0]
v_pk_add_f32 v[24:25], v[24:25], v[40:41]
v_pk_add_f32 v[40:41], v[26:27], v[42:43] neg_lo:[0,1] neg_hi:[0,1]
v_pk_add_f32 v[26:27], v[26:27], v[42:43]
v_pk_mul_f32 v[42:43], v[40:41], s[54:55] op_sel:[0,1] op_sel_hi:[0,0] neg_lo:[0,1] neg_hi:[0,1]
v_pk_fma_f32 v[42:43], v[40:41], s[54:55], v[42:43] op_sel:[1,0,0] op_sel_hi:[1,1,1] neg_lo:[0,0,0] neg_hi:[0,1,0]
v_pk_add_f32 v[40:41], v[28:29], v[44:45] neg_lo:[0,1] neg_hi:[0,1]
v_pk_add_f32 v[28:29], v[28:29], v[44:45]
v_pk_mul_f32 v[44:45], v[40:41], s[62:63] op_sel:[0,0] op_sel_hi:[0,1] neg_lo:[0,1] neg_hi:[0,1]
v_pk_fma_f32 v[44:45], v[40:41], s[62:63], v[44:45] op_sel:[1,1,0] op_sel_hi:[1,0,1] neg_lo:[0,0,0] neg_hi:[0,1,0]
v_pk_add_f32 v[40:41], v[30:31], v[46:47] neg_lo:[0,1] neg_hi:[0,1]
v_pk_add_f32 v[30:31], v[30:31], v[46:47]
v_pk_mul_f32 v[46:47], v[40:41], s[54:55] op_sel:[0,0] op_sel_hi:[0,1] neg_lo:[0,1] neg_hi:[0,1]
v_pk_fma_f32 v[46:47], v[40:41], s[54:55], v[46:47] op_sel:[1,1,0] op_sel_hi:[1,0,1] neg_lo:[0,0,0] neg_hi:[0,1,0]
v_pk_add_f32 v[40:41], v[48:49], v[64:65] neg_lo:[0,1] neg_hi:[0,1]
v_pk_add_f32 v[48:49], v[48:49], v[64:65]
v_pk_add_f32 v[64:65], v[50:51], v[66:67] neg_lo:[0,1] neg_hi:[0,1]
v_pk_add_f32 v[50:51], v[50:51], v[66:67]
v_pk_mul_f32 v[66:67], v[64:65], s[54:55] op_sel:[0,0] op_sel_hi:[0,1] neg_lo:[0,0] neg_hi:[0,1]
v_pk_fma_f32 v[66:67], v[64:65], s[54:55], v[66:67] op_sel:[1,1,0] op_sel_hi:[1,0,1] neg_lo:[0,0,0] neg_hi:[0,0,0]
v_pk_add_f32 v[64:65], v[52:53], v[68:69] neg_lo:[0,1] neg_hi:[0,1]
v_pk_add_f32 v[52:53], v[52:53], v[68:69]
v_pk_mul_f32 v[68:69], v[64:65], s[62:63] op_sel:[0,0] op_sel_hi:[0,1] neg_lo:[0,0] neg_hi:[0,1]
v_pk_fma_f32 v[68:69], v[64:65], s[62:63], v[68:69] op_sel:[1,1,0] op_sel_hi:[1,0,1] neg_lo:[0,0,0] neg_hi:[0,0,0]
v_pk_add_f32 v[64:65], v[54:55], v[70:71] neg_lo:[0,1] neg_hi:[0,1]
v_pk_add_f32 v[54:55], v[54:55], v[70:71]
v_pk_mul_f32 v[70:71], v[64:65], s[54:55] op_sel:[0,1] op_sel_hi:[0,0] neg_lo:[0,0] neg_hi:[0,1]
v_pk_fma_f32 v[70:71], v[64:65], s[54:55], v[70:71] op_sel:[1,0,0] op_sel_hi:[1,1,1] neg_lo:[0,0,0] neg_hi:[0,0,0]
v_pk_add_f32 v[64:65], v[56:57], v[72:73] op_sel:[1,1] op_sel_hi:[0,0] neg_lo:[0,1] neg_hi:[1,0]
v_pk_add_f32 v[56:57], v[56:57], v[72:73]
v_pk_add_f32 v[72:73], v[58:59], v[74:75] neg_lo:[0,1] neg_hi:[0,1]
v_pk_add_f32 v[58:59], v[58:59], v[74:75]
v_pk_mul_f32 v[74:75], v[72:73], s[54:55] op_sel:[0,1] op_sel_hi:[0,0] neg_lo:[0,1] neg_hi:[0,1]
v_pk_fma_f32 v[74:75], v[72:73], s[54:55], v[74:75] op_sel:[1,0,0] op_sel_hi:[1,1,1] neg_lo:[0,0,0] neg_hi:[0,1,0]
v_pk_add_f32 v[72:73], v[60:61], v[76:77] neg_lo:[0,1] neg_hi:[0,1]
v_pk_add_f32 v[60:61], v[60:61], v[76:77]
v_pk_mul_f32 v[76:77], v[72:73], s[62:63] op_sel:[0,0] op_sel_hi:[0,1] neg_lo:[0,1] neg_hi:[0,1]
v_pk_fma_f32 v[76:77], v[72:73], s[62:63], v[76:77] op_sel:[1,1,0] op_sel_hi:[1,0,1] neg_lo:[0,0,0] neg_hi:[0,1,0]
v_pk_add_f32 v[72:73], v[62:63], v[78:79] neg_lo:[0,1] neg_hi:[0,1]
v_pk_add_f32 v[62:63], v[62:63], v[78:79]
v_pk_mul_f32 v[78:79], v[72:73], s[54:55] op_sel:[0,0] op_sel_hi:[0,1] neg_lo:[0,1] neg_hi:[0,1]
v_pk_fma_f32 v[78:79], v[72:73], s[54:55], v[78:79] op_sel:[1,1,0] op_sel_hi:[1,0,1] neg_lo:[0,0,0] neg_hi:[0,1,0]
v_pk_add_f32 v[72:73], v[16:17], v[24:25] neg_lo:[0,1] neg_hi:[0,1]
v_pk_add_f32 v[16:17], v[16:17], v[24:25]
v_pk_add_f32 v[24:25], v[18:19], v[26:27] neg_lo:[0,1] neg_hi:[0,1]
v_pk_add_f32 v[18:19], v[18:19], v[26:27]
v_pk_mul_f32 v[26:27], v[24:25], s[62:63] op_sel:[0,0] op_sel_hi:[0,1] neg_lo:[0,0] neg_hi:[0,1]
v_pk_fma_f32 v[26:27], v[24:25], s[62:63], v[26:27] op_sel:[1,1,0] op_sel_hi:[1,0,1] neg_lo:[0,0,0] neg_hi:[0,0,0]
v_pk_add_f32 v[24:25], v[20:21], v[28:29] op_sel:[1,1] op_sel_hi:[0,0] neg_lo:[0,1] neg_hi:[1,0]
v_pk_add_f32 v[20:21], v[20:21], v[28:29]
v_pk_add_f32 v[28:29], v[22:23], v[30:31] neg_lo:[0,1] neg_hi:[0,1]
v_pk_add_f32 v[22:23], v[22:23], v[30:31]
v_pk_mul_f32 v[30:31], v[28:29], s[62:63] op_sel:[0,0] op_sel_hi:[0,1] neg_lo:[0,1] neg_hi:[0,1]
v_pk_fma_f32 v[30:31], v[28:29], s[62:63], v[30:31] op_sel:[1,1,0] op_sel_hi:[1,0,1] neg_lo:[0,0,0] neg_hi:[0,1,0]
v_pk_add_f32 v[28:29], v[14:15], v[32:33] neg_lo:[0,1] neg_hi:[0,1]
v_pk_add_f32 v[14:15], v[14:15], v[32:33]
v_pk_add_f32 v[32:33], v[34:35], v[42:43] neg_lo:[0,1] neg_hi:[0,1]
v_pk_add_f32 v[34:35], v[34:35], v[42:43]
v_pk_mul_f32 v[42:43], v[32:33], s[62:63] op_sel:[0,0] op_sel_hi:[0,1] neg_lo:[0,0] neg_hi:[0,1]
v_pk_fma_f32 v[42:43], v[32:33], s[62:63], v[42:43] op_sel:[1,1,0] op_sel_hi:[1,0,1] neg_lo:[0,0,0] neg_hi:[0,0,0]
v_pk_add_f32 v[32:33], v[36:37], v[44:45] op_sel:[1,1] op_sel_hi:[0,0] neg_lo:[0,1] neg_hi:[1,0]
v_pk_add_f32 v[36:37], v[36:37], v[44:45]
v_pk_add_f32 v[44:45], v[38:39], v[46:47] neg_lo:[0,1] neg_hi:[0,1]
v_pk_add_f32 v[38:39], v[38:39], v[46:47]
v_pk_mul_f32 v[46:47], v[44:45], s[62:63] op_sel:[0,0] op_sel_hi:[0,1] neg_lo:[0,1] neg_hi:[0,1]
v_pk_fma_f32 v[46:47], v[44:45], s[62:63], v[46:47] op_sel:[1,1,0] op_sel_hi:[1,0,1] neg_lo:[0,0,0] neg_hi:[0,1,0]
v_pk_add_f32 v[44:45], v[48:49], v[56:57] neg_lo:[0,1] neg_hi:[0,1]
v_pk_add_f32 v[48:49], v[48:49], v[56:57]
v_pk_add_f32 v[56:57], v[50:51], v[58:59] neg_lo:[0,1] neg_hi:[0,1]
v_pk_add_f32 v[50:51], v[50:51], v[58:59]
v_pk_mul_f32 v[58:59], v[56:57], s[62:63] op_sel:[0,0] op_sel_hi:[0,1] neg_lo:[0,0] neg_hi:[0,1]
v_pk_fma_f32 v[58:59], v[56:57], s[62:63], v[58:59] op_sel:[1,1,0] op_sel_hi:[1,0,1] neg_lo:[0,0,0] neg_hi:[0,0,0]
v_pk_add_f32 v[56:57], v[52:53], v[60:61] op_sel:[1,1] op_sel_hi:[0,0] neg_lo:[0,1] neg_hi:[1,0]
v_pk_add_f32 v[52:53], v[52:53], v[60:61]
v_pk_add_f32 v[60:61], v[54:55], v[62:63] neg_lo:[0,1] neg_hi:[0,1]
v_pk_add_f32 v[54:55], v[54:55], v[62:63]
v_pk_mul_f32 v[62:63], v[60:61], s[62:63] op_sel:[0,0] op_sel_hi:[0,1] neg_lo:[0,1] neg_hi:[0,1]
v_pk_fma_f32 v[62:63], v[60:61], s[62:63], v[62:63] op_sel:[1,1,0] op_sel_hi:[1,0,1] neg_lo:[0,0,0] neg_hi:[0,1,0]
v_pk_add_f32 v[60:61], v[40:41], v[64:65] neg_lo:[0,1] neg_hi:[0,1]
v_pk_add_f32 v[40:41], v[40:41], v[64:65]
v_pk_add_f32 v[64:65], v[66:67], v[74:75] neg_lo:[0,1] neg_hi:[0,1]
v_pk_add_f32 v[66:67], v[66:67], v[74:75]
v_pk_mul_f32 v[74:75], v[64:65], s[62:63] op_sel:[0,0] op_sel_hi:[0,1] neg_lo:[0,0] neg_hi:[0,1]
v_pk_fma_f32 v[74:75], v[64:65], s[62:63], v[74:75] op_sel:[1,1,0] op_sel_hi:[1,0,1] neg_lo:[0,0,0] neg_hi:[0,0,0]
v_pk_add_f32 v[64:65], v[68:69], v[76:77] op_sel:[1,1] op_sel_hi:[0,0] neg_lo:[0,1] neg_hi:[1,0]
v_pk_add_f32 v[68:69], v[68:69], v[76:77]
v_pk_add_f32 v[76:77], v[70:71], v[78:79] neg_lo:[0,1] neg_hi:[0,1]
v_pk_add_f32 v[70:71], v[70:71], v[78:79]
v_pk_mul_f32 v[78:79], v[76:77], s[62:63] op_sel:[0,0] op_sel_hi:[0,1] neg_lo:[0,1] neg_hi:[0,1]
v_pk_fma_f32 v[78:79], v[76:77], s[62:63], v[78:79] op_sel:[1,1,0] op_sel_hi:[1,0,1] neg_lo:[0,0,0] neg_hi:[0,1,0]
v_pk_add_f32 v[76:77], v[16:17], v[20:21] neg_lo:[0,1] neg_hi:[0,1]
v_pk_add_f32 v[16:17], v[16:17], v[20:21]
v_pk_add_f32 v[20:21], v[18:19], v[22:23] op_sel:[1,1] op_sel_hi:[0,0] neg_lo:[0,1] neg_hi:[1,0]
v_pk_add_f32 v[18:19], v[18:19], v[22:23]
v_pk_add_f32 v[22:23], v[72:73], v[24:25] neg_lo:[0,1] neg_hi:[0,1]
v_pk_add_f32 v[72:73], v[72:73], v[24:25]
v_pk_add_f32 v[24:25], v[26:27], v[30:31] op_sel:[1,1] op_sel_hi:[0,0] neg_lo:[0,1] neg_hi:[1,0]
v_pk_add_f32 v[26:27], v[26:27], v[30:31]
v_pk_add_f32 v[30:31], v[14:15], v[36:37] neg_lo:[0,1] neg_hi:[0,1]
v_pk_add_f32 v[14:15], v[14:15], v[36:37]
v_pk_add_f32 v[36:37], v[34:35], v[38:39] op_sel:[1,1] op_sel_hi:[0,0] neg_lo:[0,1] neg_hi:[1,0]
v_pk_add_f32 v[34:35], v[34:35], v[38:39]
v_pk_add_f32 v[38:39], v[28:29], v[32:33] neg_lo:[0,1] neg_hi:[0,1]
v_pk_add_f32 v[28:29], v[28:29], v[32:33]
v_pk_add_f32 v[32:33], v[42:43], v[46:47] op_sel:[1,1] op_sel_hi:[0,0] neg_lo:[0,1] neg_hi:[1,0]
v_pk_add_f32 v[42:43], v[42:43], v[46:47]
v_pk_add_f32 v[46:47], v[48:49], v[52:53] neg_lo:[0,1] neg_hi:[0,1]
v_pk_add_f32 v[48:49], v[48:49], v[52:53]
v_pk_add_f32 v[52:53], v[50:51], v[54:55] op_sel:[1,1] op_sel_hi:[0,0] neg_lo:[0,1] neg_hi:[1,0]
v_pk_add_f32 v[50:51], v[50:51], v[54:55]
v_pk_add_f32 v[54:55], v[44:45], v[56:57] neg_lo:[0,1] neg_hi:[0,1]
v_pk_add_f32 v[44:45], v[44:45], v[56:57]
v_pk_add_f32 v[56:57], v[58:59], v[62:63] op_sel:[1,1] op_sel_hi:[0,0] neg_lo:[0,1] neg_hi:[1,0]
v_pk_add_f32 v[58:59], v[58:59], v[62:63]
v_pk_add_f32 v[62:63], v[40:41], v[68:69] neg_lo:[0,1] neg_hi:[0,1]
v_pk_add_f32 v[40:41], v[40:41], v[68:69]
v_pk_add_f32 v[68:69], v[66:67], v[70:71] op_sel:[1,1] op_sel_hi:[0,0] neg_lo:[0,1] neg_hi:[1,0]
v_pk_add_f32 v[66:67], v[66:67], v[70:71]
v_pk_add_f32 v[70:71], v[60:61], v[64:65] neg_lo:[0,1] neg_hi:[0,1]
v_pk_add_f32 v[60:61], v[60:61], v[64:65]
v_pk_add_f32 v[64:65], v[74:75], v[78:79] op_sel:[1,1] op_sel_hi:[0,0] neg_lo:[0,1] neg_hi:[1,0]
v_pk_add_f32 v[74:75], v[74:75], v[78:79]
v_pk_add_f32 v[78:79], v[16:17], v[18:19] neg_lo:[0,1] neg_hi:[0,1]
v_pk_add_f32 v[16:17], v[16:17], v[18:19]
v_pk_add_f32 v[18:19], v[76:77], v[20:21] neg_lo:[0,1] neg_hi:[0,1]
v_pk_add_f32 v[76:77], v[76:77], v[20:21]
v_pk_add_f32 v[20:21], v[72:73], v[26:27] neg_lo:[0,1] neg_hi:[0,1]
v_pk_add_f32 v[72:73], v[72:73], v[26:27]
v_pk_add_f32 v[26:27], v[22:23], v[24:25] neg_lo:[0,1] neg_hi:[0,1]
v_pk_add_f32 v[22:23], v[22:23], v[24:25]
v_pk_add_f32 v[24:25], v[14:15], v[34:35] neg_lo:[0,1] neg_hi:[0,1]
v_pk_add_f32 v[14:15], v[14:15], v[34:35]
v_pk_add_f32 v[34:35], v[30:31], v[36:37] neg_lo:[0,1] neg_hi:[0,1]
v_pk_add_f32 v[30:31], v[30:31], v[36:37]
v_pk_add_f32 v[36:37], v[28:29], v[42:43] neg_lo:[0,1] neg_hi:[0,1]
v_pk_add_f32 v[28:29], v[28:29], v[42:43]
v_pk_add_f32 v[42:43], v[38:39], v[32:33] neg_lo:[0,1] neg_hi:[0,1]
v_pk_add_f32 v[38:39], v[38:39], v[32:33]
v_pk_add_f32 v[32:33], v[48:49], v[50:51] neg_lo:[0,1] neg_hi:[0,1]
v_pk_add_f32 v[48:49], v[48:49], v[50:51]
v_pk_add_f32 v[50:51], v[46:47], v[52:53] neg_lo:[0,1] neg_hi:[0,1]
v_pk_add_f32 v[46:47], v[46:47], v[52:53]
v_pk_add_f32 v[52:53], v[44:45], v[58:59] neg_lo:[0,1] neg_hi:[0,1]
v_pk_add_f32 v[44:45], v[44:45], v[58:59]
v_pk_add_f32 v[58:59], v[54:55], v[56:57] neg_lo:[0,1] neg_hi:[0,1]
v_pk_add_f32 v[54:55], v[54:55], v[56:57]
v_pk_add_f32 v[56:57], v[40:41], v[66:67] neg_lo:[0,1] neg_hi:[0,1]
v_pk_add_f32 v[40:41], v[40:41], v[66:67]
v_pk_add_f32 v[66:67], v[62:63], v[68:69] neg_lo:[0,1] neg_hi:[0,1]
v_pk_add_f32 v[62:63], v[62:63], v[68:69]
v_pk_add_f32 v[68:69], v[60:61], v[74:75] neg_lo:[0,1] neg_hi:[0,1]
v_pk_add_f32 v[60:61], v[60:61], v[74:75]
v_pk_add_f32 v[74:75], v[70:71], v[64:65] neg_lo:[0,1] neg_hi:[0,1]
v_pk_add_f32 v[70:71], v[70:71], v[64:65]
v_pk_mul_f32 v[64:65], v[48:49], v[82:83] op_sel:[0,0] op_sel_hi:[0,1] neg_lo:[0,0] neg_hi:[0,0]
v_pk_fma_f32 v[48:49], v[48:49], v[82:83], v[64:65] op_sel:[1,1,0] op_sel_hi:[1,0,1] neg_lo:[0,1,0] neg_hi:[0,0,0]
v_pk_mul_f32 v[64:65], v[14:15], v[84:85] op_sel:[0,0] op_sel_hi:[0,1] neg_lo:[0,0] neg_hi:[0,0]
v_pk_fma_f32 v[14:15], v[14:15], v[84:85], v[64:65] op_sel:[1,1,0] op_sel_hi:[1,0,1] neg_lo:[0,1,0] neg_hi:[0,0,0]
v_pk_mul_f32 v[64:65], v[40:41], v[86:87] op_sel:[0,0] op_sel_hi:[0,1] neg_lo:[0,0] neg_hi:[0,0]
v_pk_fma_f32 v[40:41], v[40:41], v[86:87], v[64:65] op_sel:[1,1,0] op_sel_hi:[1,0,1] neg_lo:[0,1,0] neg_hi:[0,0,0]
v_pk_mul_f32 v[64:65], v[72:73], v[88:89] op_sel:[0,0] op_sel_hi:[0,1] neg_lo:[0,0] neg_hi:[0,0]
v_pk_fma_f32 v[72:73], v[72:73], v[88:89], v[64:65] op_sel:[1,1,0] op_sel_hi:[1,0,1] neg_lo:[0,1,0] neg_hi:[0,0,0]
v_pk_mul_f32 v[64:65], v[44:45], v[90:91] op_sel:[0,0] op_sel_hi:[0,1] neg_lo:[0,0] neg_hi:[0,0]
v_pk_fma_f32 v[44:45], v[44:45], v[90:91], v[64:65] op_sel:[1,1,0] op_sel_hi:[1,0,1] neg_lo:[0,1,0] neg_hi:[0,0,0]
v_pk_mul_f32 v[64:65], v[28:29], v[92:93] op_sel:[0,0] op_sel_hi:[0,1] neg_lo:[0,0] neg_hi:[0,0]
v_pk_fma_f32 v[28:29], v[28:29], v[92:93], v[64:65] op_sel:[1,1,0] op_sel_hi:[1,0,1] neg_lo:[0,1,0] neg_hi:[0,0,0]
v_pk_mul_f32 v[64:65], v[60:61], v[94:95] op_sel:[0,0] op_sel_hi:[0,1] neg_lo:[0,0] neg_hi:[0,0]
v_pk_fma_f32 v[60:61], v[60:61], v[94:95], v[64:65] op_sel:[1,1,0] op_sel_hi:[1,0,1] neg_lo:[0,1,0] neg_hi:[0,0,0]
v_pk_mul_f32 v[64:65], v[76:77], v[96:97] op_sel:[0,0] op_sel_hi:[0,1] neg_lo:[0,0] neg_hi:[0,0]
v_pk_fma_f32 v[76:77], v[76:77], v[96:97], v[64:65] op_sel:[1,1,0] op_sel_hi:[1,0,1] neg_lo:[0,1,0] neg_hi:[0,0,0]
v_pk_mul_f32 v[64:65], v[46:47], v[98:99] op_sel:[0,0] op_sel_hi:[0,1] neg_lo:[0,0] neg_hi:[0,0]
v_pk_fma_f32 v[46:47], v[46:47], v[98:99], v[64:65] op_sel:[1,1,0] op_sel_hi:[1,0,1] neg_lo:[0,1,0] neg_hi:[0,0,0]
v_pk_mul_f32 v[64:65], v[30:31], v[100:101] op_sel:[0,0] op_sel_hi:[0,1] neg_lo:[0,0] neg_hi:[0,0]
v_pk_fma_f32 v[30:31], v[30:31], v[100:101], v[64:65] op_sel:[1,1,0] op_sel_hi:[1,0,1] neg_lo:[0,1,0] neg_hi:[0,0,0]
v_pk_mul_f32 v[64:65], v[62:63], v[102:103] op_sel:[0,0] op_sel_hi:[0,1] neg_lo:[0,0] neg_hi:[0,0]
v_pk_fma_f32 v[62:63], v[62:63], v[102:103], v[64:65] op_sel:[1,1,0] op_sel_hi:[1,0,1] neg_lo:[0,1,0] neg_hi:[0,0,0]
v_pk_mul_f32 v[64:65], v[22:23], v[104:105] op_sel:[0,0] op_sel_hi:[0,1] neg_lo:[0,0] neg_hi:[0,0]
v_pk_fma_f32 v[22:23], v[22:23], v[104:105], v[64:65] op_sel:[1,1,0] op_sel_hi:[1,0,1] neg_lo:[0,1,0] neg_hi:[0,0,0]
v_pk_mul_f32 v[64:65], v[54:55], v[106:107] op_sel:[0,0] op_sel_hi:[0,1] neg_lo:[0,0] neg_hi:[0,0]
v_pk_fma_f32 v[54:55], v[54:55], v[106:107], v[64:65] op_sel:[1,1,0] op_sel_hi:[1,0,1] neg_lo:[0,1,0] neg_hi:[0,0,0]
v_pk_mul_f32 v[64:65], v[38:39], v[108:109] op_sel:[0,0] op_sel_hi:[0,1] neg_lo:[0,0] neg_hi:[0,0]
v_pk_fma_f32 v[38:39], v[38:39], v[108:109], v[64:65] op_sel:[1,1,0] op_sel_hi:[1,0,1] neg_lo:[0,1,0] neg_hi:[0,0,0]
v_pk_mul_f32 v[64:65], v[70:71], v[110:111] op_sel:[0,0] op_sel_hi:[0,1] neg_lo:[0,0] neg_hi:[0,0]
v_pk_fma_f32 v[70:71], v[70:71], v[110:111], v[64:65] op_sel:[1,1,0] op_sel_hi:[1,0,1] neg_lo:[0,1,0] neg_hi:[0,0,0]
v_pk_mul_f32 v[64:65], v[78:79], v[112:113] op_sel:[0,0] op_sel_hi:[0,1] neg_lo:[0,0] neg_hi:[0,0]
v_pk_fma_f32 v[78:79], v[78:79], v[112:113], v[64:65] op_sel:[1,1,0] op_sel_hi:[1,0,1] neg_lo:[0,1,0] neg_hi:[0,0,0]
v_pk_mul_f32 v[64:65], v[32:33], v[114:115] op_sel:[0,0] op_sel_hi:[0,1] neg_lo:[0,0] neg_hi:[0,0]
v_pk_fma_f32 v[32:33], v[32:33], v[114:115], v[64:65] op_sel:[1,1,0] op_sel_hi:[1,0,1] neg_lo:[0,1,0] neg_hi:[0,0,0]
v_pk_mul_f32 v[64:65], v[24:25], v[116:117] op_sel:[0,0] op_sel_hi:[0,1] neg_lo:[0,0] neg_hi:[0,0]
v_pk_fma_f32 v[24:25], v[24:25], v[116:117], v[64:65] op_sel:[1,1,0] op_sel_hi:[1,0,1] neg_lo:[0,1,0] neg_hi:[0,0,0]
v_pk_mul_f32 v[64:65], v[56:57], v[118:119] op_sel:[0,0] op_sel_hi:[0,1] neg_lo:[0,0] neg_hi:[0,0]
v_pk_fma_f32 v[56:57], v[56:57], v[118:119], v[64:65] op_sel:[1,1,0] op_sel_hi:[1,0,1] neg_lo:[0,1,0] neg_hi:[0,0,0]
v_pk_mul_f32 v[64:65], v[20:21], v[120:121] op_sel:[0,0] op_sel_hi:[0,1] neg_lo:[0,0] neg_hi:[0,0]
v_pk_fma_f32 v[20:21], v[20:21], v[120:121], v[64:65] op_sel:[1,1,0] op_sel_hi:[1,0,1] neg_lo:[0,1,0] neg_hi:[0,0,0]
v_pk_mul_f32 v[64:65], v[52:53], v[122:123] op_sel:[0,0] op_sel_hi:[0,1] neg_lo:[0,0] neg_hi:[0,0]
v_pk_fma_f32 v[52:53], v[52:53], v[122:123], v[64:65] op_sel:[1,1,0] op_sel_hi:[1,0,1] neg_lo:[0,1,0] neg_hi:[0,0,0]
v_pk_mul_f32 v[64:65], v[36:37], v[124:125] op_sel:[0,0] op_sel_hi:[0,1] neg_lo:[0,0] neg_hi:[0,0]
v_pk_fma_f32 v[36:37], v[36:37], v[124:125], v[64:65] op_sel:[1,1,0] op_sel_hi:[1,0,1] neg_lo:[0,1,0] neg_hi:[0,0,0]
v_pk_mul_f32 v[64:65], v[68:69], v[126:127] op_sel:[0,0] op_sel_hi:[0,1] neg_lo:[0,0] neg_hi:[0,0]
v_pk_fma_f32 v[68:69], v[68:69], v[126:127], v[64:65] op_sel:[1,1,0] op_sel_hi:[1,0,1] neg_lo:[0,1,0] neg_hi:[0,0,0]
v_pk_mul_f32 v[64:65], v[18:19], v[128:129] op_sel:[0,0] op_sel_hi:[0,1] neg_lo:[0,0] neg_hi:[0,0]
v_pk_fma_f32 v[18:19], v[18:19], v[128:129], v[64:65] op_sel:[1,1,0] op_sel_hi:[1,0,1] neg_lo:[0,1,0] neg_hi:[0,0,0]
v_pk_mul_f32 v[64:65], v[50:51], v[130:131] op_sel:[0,0] op_sel_hi:[0,1] neg_lo:[0,0] neg_hi:[0,0]
v_pk_fma_f32 v[50:51], v[50:51], v[130:131], v[64:65] op_sel:[1,1,0] op_sel_hi:[1,0,1] neg_lo:[0,1,0] neg_hi:[0,0,0]
v_pk_mul_f32 v[64:65], v[34:35], v[132:133] op_sel:[0,0] op_sel_hi:[0,1] neg_lo:[0,0] neg_hi:[0,0]
v_pk_fma_f32 v[34:35], v[34:35], v[132:133], v[64:65] op_sel:[1,1,0] op_sel_hi:[1,0,1] neg_lo:[0,1,0] neg_hi:[0,0,0]
v_pk_mul_f32 v[64:65], v[66:67], v[134:135] op_sel:[0,0] op_sel_hi:[0,1] neg_lo:[0,0] neg_hi:[0,0]
v_pk_fma_f32 v[66:67], v[66:67], v[134:135], v[64:65] op_sel:[1,1,0] op_sel_hi:[1,0,1] neg_lo:[0,1,0] neg_hi:[0,0,0]
v_pk_mul_f32 v[64:65], v[26:27], v[136:137] op_sel:[0,0] op_sel_hi:[0,1] neg_lo:[0,0] neg_hi:[0,0]
v_pk_fma_f32 v[26:27], v[26:27], v[136:137], v[64:65] op_sel:[1,1,0] op_sel_hi:[1,0,1] neg_lo:[0,1,0] neg_hi:[0,0,0]
v_pk_mul_f32 v[64:65], v[58:59], v[138:139] op_sel:[0,0] op_sel_hi:[0,1] neg_lo:[0,0] neg_hi:[0,0]
v_pk_fma_f32 v[58:59], v[58:59], v[138:139], v[64:65] op_sel:[1,1,0] op_sel_hi:[1,0,1] neg_lo:[0,1,0] neg_hi:[0,0,0]
v_pk_mul_f32 v[64:65], v[42:43], v[140:141] op_sel:[0,0] op_sel_hi:[0,1] neg_lo:[0,0] neg_hi:[0,0]
v_pk_fma_f32 v[42:43], v[42:43], v[140:141], v[64:65] op_sel:[1,1,0] op_sel_hi:[1,0,1] neg_lo:[0,1,0] neg_hi:[0,0,0]
v_pk_mul_f32 v[64:65], v[74:75], v[142:143] op_sel:[0,0] op_sel_hi:[0,1] neg_lo:[0,0] neg_hi:[0,0]
v_pk_fma_f32 v[74:75], v[74:75], v[142:143], v[64:65] op_sel:[1,1,0] op_sel_hi:[1,0,1] neg_lo:[0,1,0] neg_hi:[0,0,0]
s_barrier
ds_write_b64 v4, v[16:17] offset:0
ds_write_b64 v4, v[48:49] offset:264
ds_write_b64 v4, v[14:15] offset:528
ds_write_b64 v4, v[40:41] offset:792
ds_write_b64 v4, v[72:73] offset:1056
ds_write_b64 v4, v[44:45] offset:1320
ds_write_b64 v4, v[28:29] offset:1584
ds_write_b64 v4, v[60:61] offset:1848
ds_write_b64 v4, v[76:77] offset:2112
ds_write_b64 v4, v[46:47] offset:2376
ds_write_b64 v4, v[30:31] offset:2640
ds_write_b64 v4, v[62:63] offset:2904
ds_write_b64 v4, v[22:23] offset:3168
ds_write_b64 v4, v[54:55] offset:3432
ds_write_b64 v4, v[38:39] offset:3696
ds_write_b64 v4, v[70:71] offset:3960
ds_write_b64 v4, v[78:79] offset:4224
ds_write_b64 v4, v[32:33] offset:4488
ds_write_b64 v4, v[24:25] offset:4752
ds_write_b64 v4, v[56:57] offset:5016
ds_write_b64 v4, v[20:21] offset:5280
ds_write_b64 v4, v[52:53] offset:5544
ds_write_b64 v4, v[36:37] offset:5808
ds_write_b64 v4, v[68:69] offset:6072
ds_write_b64 v4, v[18:19] offset:6336
ds_write_b64 v4, v[50:51] offset:6600
ds_write_b64 v4, v[34:35] offset:6864
ds_write_b64 v4, v[66:67] offset:7128
ds_write_b64 v4, v[26:27] offset:7392
ds_write_b64 v4, v[58:59] offset:7656
ds_write_b64 v4, v[42:43] offset:7920
ds_write_b64 v4, v[74:75] offset:8184
s_waitcnt lgkmcnt(0)
ds_read_b64 v[16:17], v5 offset:0
ds_read_b64 v[48:49], v5 offset:128
ds_read_b64 v[18:19], v5 offset:8
ds_read_b64 v[50:51], v5 offset:136
ds_read_b64 v[20:21], v5 offset:16
ds_read_b64 v[52:53], v5 offset:144
ds_read_b64 v[22:23], v5 offset:24
ds_read_b64 v[54:55], v5 offset:152
ds_read_b64 v[24:25], v5 offset:32
ds_read_b64 v[56:57], v5 offset:160
ds_read_b64 v[26:27], v5 offset:40
ds_read_b64 v[58:59], v5 offset:168
ds_read_b64 v[28:29], v5 offset:48
ds_read_b64 v[60:61], v5 offset:176
ds_read_b64 v[30:31], v5 offset:56
ds_read_b64 v[62:63], v5 offset:184
ds_read_b64 v[32:33], v5 offset:64
ds_read_b64 v[64:65], v5 offset:192
ds_read_b64 v[34:35], v5 offset:72
ds_read_b64 v[66:67], v5 offset:200
ds_read_b64 v[36:37], v5 offset:80
ds_read_b64 v[68:69], v5 offset:208
ds_read_b64 v[38:39], v5 offset:88
ds_read_b64 v[70:71], v5 offset:216
ds_read_b64 v[40:41], v5 offset:96
ds_read_b64 v[72:73], v5 offset:224
ds_read_b64 v[42:43], v5 offset:104
ds_read_b64 v[74:75], v5 offset:232
ds_read_b64 v[44:45], v5 offset:112
ds_read_b64 v[76:77], v5 offset:240
ds_read_b64 v[46:47], v5 offset:120
ds_read_b64 v[78:79], v5 offset:248
s_waitcnt lgkmcnt(0)
v_pk_add_f32 v[14:15], v[16:17], v[48:49] neg_lo:[0,1] neg_hi:[0,1]
v_pk_add_f32 v[16:17], v[16:17], v[48:49]
v_pk_add_f32 v[48:49], v[18:19], v[50:51] neg_lo:[0,1] neg_hi:[0,1]
v_pk_add_f32 v[18:19], v[18:19], v[50:51]
v_pk_mul_f32 v[50:51], v[48:49], s[50:51] op_sel:[0,0] op_sel_hi:[0,1] neg_lo:[0,0] neg_hi:[0,1]
v_pk_fma_f32 v[50:51], v[48:49], s[50:51], v[50:51] op_sel:[1,1,0] op_sel_hi:[1,0,1] neg_lo:[0,0,0] neg_hi:[0,0,0]
v_pk_add_f32 v[48:49], v[20:21], v[52:53] neg_lo:[0,1] neg_hi:[0,1]
v_pk_add_f32 v[20:21], v[20:21], v[52:53]
v_pk_mul_f32 v[52:53], v[48:49], s[54:55] op_sel:[0,0] op_sel_hi:[0,1] neg_lo:[0,0] neg_hi:[0,1]
v_pk_fma_f32 v[52:53], v[48:49], s[54:55], v[52:53] op_sel:[1,1,0] op_sel_hi:[1,0,1] neg_lo:[0,0,0] neg_hi:[0,0,0]
v_pk_add_f32 v[48:49], v[22:23], v[54:55] neg_lo:[0,1] neg_hi:[0,1]
v_pk_add_f32 v[22:23], v[22:23], v[54:55]
v_pk_mul_f32 v[54:55], v[48:49], s[58:59] op_sel:[0,0] op_sel_hi:[0,1] neg_lo:[0,0] neg_hi:[0,1]
v_pk_fma_f32 v[54:55], v[48:49], s[58:59], v[54:55] op_sel:[1,1,0] op_sel_hi:[1,0,1] neg_lo:[0,0,0] neg_hi:[0,0,0]
v_pk_add_f32 v[48:49], v[24:25], v[56:57] neg_lo:[0,1] neg_hi:[0,1]
v_pk_add_f32 v[24:25], v[24:25], v[56:57]
v_pk_mul_f32 v[56:57], v[48:49], s[62:63] op_sel:[0,0] op_sel_hi:[0,1] neg_lo:[0,0] neg_hi:[0,1]
v_pk_fma_f32 v[56:57], v[48:49], s[62:63], v[56:57] op_sel:[1,1,0] op_sel_hi:[1,0,1] neg_lo:[0,0,0] neg_hi:[0,0,0]
v_pk_add_f32 v[48:49], v[26:27], v[58:59] neg_lo:[0,1] neg_hi:[0,1]
v_pk_add_f32 v[26:27], v[26:27], v[58:59]
v_pk_mul_f32 v[58:59], v[48:49], s[58:59] op_sel:[0,1] op_sel_hi:[0,0] neg_lo:[0,0] neg_hi:[0,1]
v_pk_fma_f32 v[58:59], v[48:49], s[58:59], v[58:59] op_sel:[1,0,0] op_sel_hi:[1,1,1] neg_lo:[0,0,0] neg_hi:[0,0,0]
v_pk_add_f32 v[48:49], v[28:29], v[60:61] neg_lo:[0,1] neg_hi:[0,1]
v_pk_add_f32 v[28:29], v[28:29], v[60:61]
v_pk_mul_f32 v[60:61], v[48:49], s[54:55] op_sel:[0,1] op_sel_hi:[0,0] neg_lo:[0,0] neg_hi:[0,1]
v_pk_fma_f32 v[60:61], v[48:49], s[54:55], v[60:61] op_sel:[1,0,0] op_sel_hi:[1,1,1] neg_lo:[0,0,0] neg_hi:[0,0,0]
v_pk_add_f32 v[48:49], v[30:31], v[62:63] neg_lo:[0,1] neg_hi:[0,1]
v_pk_add_f32 v[30:31], v[30:31], v[62:63]
v_pk_mul_f32 v[62:63], v[48:49], s[50:51] op_sel:[0,1] op_sel_hi:[0,0] neg_lo:[0,0] neg_hi:[0,1]
v_pk_fma_f32 v[62:63], v[48:49], s[50:51], v[62:63] op_sel:[1,0,0] op_sel_hi:[1,1,1] neg_lo:[0,0,0] neg_hi:[0,0,0]
v_pk_add_f32 v[48:49], v[32:33], v[64:65] op_sel:[1,1] op_sel_hi:[0,0] neg_lo:[0,1] neg_hi:[1,0]
v_pk_add_f32 v[32:33], v[32:33], v[64:65]
v_pk_add_f32 v[64:65], v[34:35], v[66:67] neg_lo:[0,1] neg_hi:[0,1]
v_pk_add_f32 v[34:35], v[34:35], v[66:67]
v_pk_mul_f32 v[66:67], v[64:65], s[50:51] op_sel:[0,1] op_sel_hi:[0,0] neg_lo:[0,1] neg_hi:[0,1]
v_pk_fma_f32 v[66:67], v[64:65], s[50:51], v[66:67] op_sel:[1,0,0] op_sel_hi:[1,1,1] neg_lo:[0,0,0] neg_hi:[0,1,0]
v_pk_add_f32 v[64:65], v[36:37], v[68:69] neg_lo:[0,1] neg_hi:[0,1]
v_pk_add_f32 v[36:37], v[36:37], v[68:69]
v_pk_mul_f32 v[68:69], v[64:65], s[54:55] op_sel:[0,1] op_sel_hi:[0,0] neg_lo:[0,1] neg_hi:[0,1]
v_pk_fma_f32 v[68:69], v[64:65], s[54:55], v[68:69] op_sel:[1,0,0] op_sel_hi:[1,1,1] neg_lo:[0,0,0] neg_hi:[0,1,0]
v_pk_add_f32 v[64:65], v[38:39], v[70:71] neg_lo:[0,1] neg_hi:[0,1]
v_pk_add_f32 v[38:39], v[38:39], v[70:71]
v_pk_mul_f32 v[70:71], v[64:65], s[58:59] op_sel:[0,1] op_sel_hi:[0,0] neg_lo:[0,1] neg_hi:[0,1]
v_pk_fma_f32 v[70:71], v[64:65], s[58:59], v[70:71] op_sel:[1,0,0] op_sel_hi:[1,1,1] neg_lo:[0,0,0] neg_hi:[0,1,0]
v_pk_add_f32 v[64:65], v[40:41], v[72:73] neg_lo:[0,1] neg_hi:[0,1]
v_pk_add_f32 v[40:41], v[40:41], v[72:73]
v_pk_mul_f32 v[72:73], v[64:65], s[62:63] op_sel:[0,0] op_sel_hi:[0,1] neg_lo:[0,1] neg_hi:[0,1]
v_pk_fma_f32 v[72:73], v[64:65], s[62:63], v[72:73] op_sel:[1,1,0] op_sel_hi:[1,0,1] neg_lo:[0,0,0] neg_hi:[0,1,0]
v_pk_add_f32 v[64:65], v[42:43], v[74:75] neg_lo:[0,1] neg_hi:[0,1]
v_pk_add_f32 v[42:43], v[42:43], v[74:75]
v_pk_mul_f32 v[74:75], v[64:65], s[58:59] op_sel:[0,0] op_sel_hi:[0,1] neg_lo:[0,1] neg_hi:[0,1]
v_pk_fma_f32 v[74:75], v[64:65], s[58:59], v[74:75] op_sel:[1,1,0] op_sel_hi:[1,0,1] neg_lo:[0,0,0] neg_hi:[0,1,0]
v_pk_add_f32 v[64:65], v[44:45], v[76:77] neg_lo:[0,1] neg_hi:[0,1]
v_pk_add_f32 v[44:45], v[44:45], v[76:77]
v_pk_mul_f32 v[76:77], v[64:65], s[54:55] op_sel:[0,0] op_sel_hi:[0,1] neg_lo:[0,1] neg_hi:[0,1]
v_pk_fma_f32 v[76:77], v[64:65], s[54:55], v[76:77] op_sel:[1,1,0] op_sel_hi:[1,0,1] neg_lo:[0,0,0] neg_hi:[0,1,0]
v_pk_add_f32 v[64:65], v[46:47], v[78:79] neg_lo:[0,1] neg_hi:[0,1]
v_pk_add_f32 v[46:47], v[46:47], v[78:79]
v_pk_mul_f32 v[78:79], v[64:65], s[50:51] op_sel:[0,0] op_sel_hi:[0,1] neg_lo:[0,1] neg_hi:[0,1]
v_pk_fma_f32 v[78:79], v[64:65], s[50:51], v[78:79] op_sel:[1,1,0] op_sel_hi:[1,0,1] neg_lo:[0,0,0] neg_hi:[0,1,0]
v_pk_add_f32 v[64:65], v[16:17], v[32:33] neg_lo:[0,1] neg_hi:[0,1]
v_pk_add_f32 v[16:17], v[16:17], v[32:33]
v_pk_add_f32 v[32:33], v[18:19], v[34:35] neg_lo:[0,1] neg_hi:[0,1]
v_pk_add_f32 v[18:19], v[18:19], v[34:35]
v_pk_mul_f32 v[34:35], v[32:33], s[54:55] op_sel:[0,0] op_sel_hi:[0,1] neg_lo:[0,0] neg_hi:[0,1]
v_pk_fma_f32 v[34:35], v[32:33], s[54:55], v[34:35] op_sel:[1,1,0] op_sel_hi:[1,0,1] neg_lo:[0,0,0] neg_hi:[0,0,0]
v_pk_add_f32 v[32:33], v[20:21], v[36:37] neg_lo:[0,1] neg_hi:[0,1]
v_pk_add_f32 v[20:21], v[20:21], v[36:37]
v_pk_mul_f32 v[36:37], v[32:33], s[62:63] op_sel:[0,0] op_sel_hi:[0,1] neg_lo:[0,0] neg_hi:[0,1]
v_pk_fma_f32 v[36:37], v[32:33], s[62:63], v[36:37] op_sel:[1,1,0] op_sel_hi:[1,0,1] neg_lo:[0,0,0] neg_hi:[0,0,0]
v_pk_add_f32 v[32:33], v[22:23], v[38:39] neg_lo:[0,1] neg_hi:[0,1]
v_pk_add_f32 v[22:23], v[22:23], v[38:39]
v_pk_mul_f32 v[38:39], v[32:33], s[54:55] op_sel:[0,1] op_sel_hi:[0,0] neg_lo:[0,0] neg_hi:[0,1]
v_pk_fma_f32 v[38:39], v[32:33], s[54:55], v[38:39] op_sel:[1,0,0] op_sel_hi:[1,1,1] neg_lo:[0,0,0] neg_hi:[0,0,0]
v_pk_add_f32 v[32:33], v[24:25], v[40:41] op_sel:[1,1] op_sel_hi:[0,0] neg_lo:[0,1] neg_hi:[1,0]
v_pk_add_f32 v[24:25], v[24:25], v[40:41]
v_pk_add_f32 v[40:41], v[26:27], v[42:43] neg_lo:[0,1] neg_hi:[0,1]
v_pk_add_f32 v[26:27], v[26:27], v[42:43]
v_pk_mul_f32 v[42:43], v[40:41], s[54:55] op_sel:[0,1] op_sel_hi:[0,0] neg_lo:[0,1] neg_hi:[0,1]
v_pk_fma_f32 v[42:43], v[40:41], s[54:55], v[42:43] op_sel:[1,0,0] op_sel_hi:[1,1,1] neg_lo:[0,0,0] neg_hi:[0,1,0]
v_pk_add_f32 v[40:41], v[28:29], v[44:45] neg_lo:[0,1] neg_hi:[0,1]
v_pk_add_f32 v[28:29], v[28:29], v[44:45]
v_pk_mul_f32 v[44:45], v[40:41], s[62:63] op_sel:[0,0] op_sel_hi:[0,1] neg_lo:[0,1] neg_hi:[0,1]
v_pk_fma_f32 v[44:45], v[40:41], s[62:63], v[44:45] op_sel:[1,1,0] op_sel_hi:[1,0,1] neg_lo:[0,0,0] neg_hi:[0,1,0]
v_pk_add_f32 v[40:41], v[30:31], v[46:47] neg_lo:[0,1] neg_hi:[0,1]
v_pk_add_f32 v[30:31], v[30:31], v[46:47]
v_pk_mul_f32 v[46:47], v[40:41], s[54:55] op_sel:[0,0] op_sel_hi:[0,1] neg_lo:[0,1] neg_hi:[0,1]
v_pk_fma_f32 v[46:47], v[40:41], s[54:55], v[46:47] op_sel:[1,1,0] op_sel_hi:[1,0,1] neg_lo:[0,0,0] neg_hi:[0,1,0]
v_pk_add_f32 v[40:41], v[14:15], v[48:49] neg_lo:[0,1] neg_hi:[0,1]
v_pk_add_f32 v[14:15], v[14:15], v[48:49]
v_pk_add_f32 v[48:49], v[50:51], v[66:67] neg_lo:[0,1] neg_hi:[0,1]
v_pk_add_f32 v[50:51], v[50:51], v[66:67]
v_pk_mul_f32 v[66:67], v[48:49], s[54:55] op_sel:[0,0] op_sel_hi:[0,1] neg_lo:[0,0] neg_hi:[0,1]
v_pk_fma_f32 v[66:67], v[48:49], s[54:55], v[66:67] op_sel:[1,1,0] op_sel_hi:[1,0,1] neg_lo:[0,0,0] neg_hi:[0,0,0]
v_pk_add_f32 v[48:49], v[52:53], v[68:69] neg_lo:[0,1] neg_hi:[0,1]
v_pk_add_f32 v[52:53], v[52:53], v[68:69]
v_pk_mul_f32 v[68:69], v[48:49], s[62:63] op_sel:[0,0] op_sel_hi:[0,1] neg_lo:[0,0] neg_hi:[0,1]
v_pk_fma_f32 v[68:69], v[48:49], s[62:63], v[68:69] op_sel:[1,1,0] op_sel_hi:[1,0,1] neg_lo:[0,0,0] neg_hi:[0,0,0]
v_pk_add_f32 v[48:49], v[54:55], v[70:71] neg_lo:[0,1] neg_hi:[0,1]
v_pk_add_f32 v[54:55], v[54:55], v[70:71]
v_pk_mul_f32 v[70:71], v[48:49], s[54:55] op_sel:[0,1] op_sel_hi:[0,0] neg_lo:[0,0] neg_hi:[0,1]
v_pk_fma_f32 v[70:71], v[48:49], s[54:55], v[70:71] op_sel:[1,0,0] op_sel_hi:[1,1,1] neg_lo:[0,0,0] neg_hi:[0,0,0]
v_pk_add_f32 v[48:49], v[56:57], v[72:73] op_sel:[1,1] op_sel_hi:[0,0] neg_lo:[0,1] neg_hi:[1,0]
v_pk_add_f32 v[56:57], v[56:57], v[72:73]
v_pk_add_f32 v[72:73], v[58:59], v[74:75] neg_lo:[0,1] neg_hi:[0,1]
v_pk_add_f32 v[58:59], v[58:59], v[74:75]
v_pk_mul_f32 v[74:75], v[72:73], s[54:55] op_sel:[0,1] op_sel_hi:[0,0] neg_lo:[0,1] neg_hi:[0,1]
v_pk_fma_f32 v[74:75], v[72:73], s[54:55], v[74:75] op_sel:[1,0,0] op_sel_hi:[1,1,1] neg_lo:[0,0,0] neg_hi:[0,1,0]
v_pk_add_f32 v[72:73], v[60:61], v[76:77] neg_lo:[0,1] neg_hi:[0,1]
v_pk_add_f32 v[60:61], v[60:61], v[76:77]
v_pk_mul_f32 v[76:77], v[72:73], s[62:63] op_sel:[0,0] op_sel_hi:[0,1] neg_lo:[0,1] neg_hi:[0,1]
v_pk_fma_f32 v[76:77], v[72:73], s[62:63], v[76:77] op_sel:[1,1,0] op_sel_hi:[1,0,1] neg_lo:[0,0,0] neg_hi:[0,1,0]
v_pk_add_f32 v[72:73], v[62:63], v[78:79] neg_lo:[0,1] neg_hi:[0,1]
v_pk_add_f32 v[62:63], v[62:63], v[78:79]
v_pk_mul_f32 v[78:79], v[72:73], s[54:55] op_sel:[0,0] op_sel_hi:[0,1] neg_lo:[0,1] neg_hi:[0,1]
v_pk_fma_f32 v[78:79], v[72:73], s[54:55], v[78:79] op_sel:[1,1,0] op_sel_hi:[1,0,1] neg_lo:[0,0,0] neg_hi:[0,1,0]
v_pk_add_f32 v[72:73], v[16:17], v[24:25] neg_lo:[0,1] neg_hi:[0,1]
v_pk_add_f32 v[16:17], v[16:17], v[24:25]
v_pk_add_f32 v[24:25], v[18:19], v[26:27] neg_lo:[0,1] neg_hi:[0,1]
v_pk_add_f32 v[18:19], v[18:19], v[26:27]
v_pk_mul_f32 v[26:27], v[24:25], s[62:63] op_sel:[0,0] op_sel_hi:[0,1] neg_lo:[0,0] neg_hi:[0,1]
v_pk_fma_f32 v[26:27], v[24:25], s[62:63], v[26:27] op_sel:[1,1,0] op_sel_hi:[1,0,1] neg_lo:[0,0,0] neg_hi:[0,0,0]
v_pk_add_f32 v[24:25], v[20:21], v[28:29] op_sel:[1,1] op_sel_hi:[0,0] neg_lo:[0,1] neg_hi:[1,0]
v_pk_add_f32 v[20:21], v[20:21], v[28:29]
v_pk_add_f32 v[28:29], v[22:23], v[30:31] neg_lo:[0,1] neg_hi:[0,1]
v_pk_add_f32 v[22:23], v[22:23], v[30:31]
v_pk_mul_f32 v[30:31], v[28:29], s[62:63] op_sel:[0,0] op_sel_hi:[0,1] neg_lo:[0,1] neg_hi:[0,1]
v_pk_fma_f32 v[30:31], v[28:29], s[62:63], v[30:31] op_sel:[1,1,0] op_sel_hi:[1,0,1] neg_lo:[0,0,0] neg_hi:[0,1,0]
v_pk_add_f32 v[28:29], v[64:65], v[32:33] neg_lo:[0,1] neg_hi:[0,1]
v_pk_add_f32 v[64:65], v[64:65], v[32:33]
v_pk_add_f32 v[32:33], v[34:35], v[42:43] neg_lo:[0,1] neg_hi:[0,1]
v_pk_add_f32 v[34:35], v[34:35], v[42:43]
v_pk_mul_f32 v[42:43], v[32:33], s[62:63] op_sel:[0,0] op_sel_hi:[0,1] neg_lo:[0,0] neg_hi:[0,1]
v_pk_fma_f32 v[42:43], v[32:33], s[62:63], v[42:43] op_sel:[1,1,0] op_sel_hi:[1,0,1] neg_lo:[0,0,0] neg_hi:[0,0,0]
v_pk_add_f32 v[32:33], v[36:37], v[44:45] op_sel:[1,1] op_sel_hi:[0,0] neg_lo:[0,1] neg_hi:[1,0]
v_pk_add_f32 v[36:37], v[36:37], v[44:45]
v_pk_add_f32 v[44:45], v[38:39], v[46:47] neg_lo:[0,1] neg_hi:[0,1]
v_pk_add_f32 v[38:39], v[38:39], v[46:47]
v_pk_mul_f32 v[46:47], v[44:45], s[62:63] op_sel:[0,0] op_sel_hi:[0,1] neg_lo:[0,1] neg_hi:[0,1]
v_pk_fma_f32 v[46:47], v[44:45], s[62:63], v[46:47] op_sel:[1,1,0] op_sel_hi:[1,0,1] neg_lo:[0,0,0] neg_hi:[0,1,0]
v_pk_add_f32 v[44:45], v[14:15], v[56:57] neg_lo:[0,1] neg_hi:[0,1]
v_pk_add_f32 v[14:15], v[14:15], v[56:57]
v_pk_add_f32 v[56:57], v[50:51], v[58:59] neg_lo:[0,1] neg_hi:[0,1]
v_pk_add_f32 v[50:51], v[50:51], v[58:59]
v_pk_mul_f32 v[58:59], v[56:57], s[62:63] op_sel:[0,0] op_sel_hi:[0,1] neg_lo:[0,0] neg_hi:[0,1]
v_pk_fma_f32 v[58:59], v[56:57], s[62:63], v[58:59] op_sel:[1,1,0] op_sel_hi:[1,0,1] neg_lo:[0,0,0] neg_hi:[0,0,0]
v_pk_add_f32 v[56:57], v[52:53], v[60:61] op_sel:[1,1] op_sel_hi:[0,0] neg_lo:[0,1] neg_hi:[1,0]
v_pk_add_f32 v[52:53], v[52:53], v[60:61]
v_pk_add_f32 v[60:61], v[54:55], v[62:63] neg_lo:[0,1] neg_hi:[0,1]
v_pk_add_f32 v[54:55], v[54:55], v[62:63]
v_pk_mul_f32 v[62:63], v[60:61], s[62:63] op_sel:[0,0] op_sel_hi:[0,1] neg_lo:[0,1] neg_hi:[0,1]
v_pk_fma_f32 v[62:63], v[60:61], s[62:63], v[62:63] op_sel:[1,1,0] op_sel_hi:[1,0,1] neg_lo:[0,0,0] neg_hi:[0,1,0]
v_pk_add_f32 v[60:61], v[40:41], v[48:49] neg_lo:[0,1] neg_hi:[0,1]
v_pk_add_f32 v[40:41], v[40:41], v[48:49]
v_pk_add_f32 v[48:49], v[66:67], v[74:75] neg_lo:[0,1] neg_hi:[0,1]
v_pk_add_f32 v[66:67], v[66:67], v[74:75]
v_pk_mul_f32 v[74:75], v[48:49], s[62:63] op_sel:[0,0] op_sel_hi:[0,1] neg_lo:[0,0] neg_hi:[0,1]
v_pk_fma_f32 v[74:75], v[48:49], s[62:63], v[74:75] op_sel:[1,1,0] op_sel_hi:[1,0,1] neg_lo:[0,0,0] neg_hi:[0,0,0]
v_pk_add_f32 v[48:49], v[68:69], v[76:77] op_sel:[1,1] op_sel_hi:[0,0] neg_lo:[0,1] neg_hi:[1,0]
v_pk_add_f32 v[68:69], v[68:69], v[76:77]
v_pk_add_f32 v[76:77], v[70:71], v[78:79] neg_lo:[0,1] neg_hi:[0,1]
v_pk_add_f32 v[70:71], v[70:71], v[78:79]
v_pk_mul_f32 v[78:79], v[76:77], s[62:63] op_sel:[0,0] op_sel_hi:[0,1] neg_lo:[0,1] neg_hi:[0,1]
v_pk_fma_f32 v[78:79], v[76:77], s[62:63], v[78:79] op_sel:[1,1,0] op_sel_hi:[1,0,1] neg_lo:[0,0,0] neg_hi:[0,1,0]
v_pk_add_f32 v[76:77], v[16:17], v[20:21] neg_lo:[0,1] neg_hi:[0,1]
v_pk_add_f32 v[16:17], v[16:17], v[20:21]
v_pk_add_f32 v[20:21], v[18:19], v[22:23] op_sel:[1,1] op_sel_hi:[0,0] neg_lo:[0,1] neg_hi:[1,0]
v_pk_add_f32 v[18:19], v[18:19], v[22:23]
v_pk_add_f32 v[22:23], v[72:73], v[24:25] neg_lo:[0,1] neg_hi:[0,1]
v_pk_add_f32 v[72:73], v[72:73], v[24:25]
v_pk_add_f32 v[24:25], v[26:27], v[30:31] op_sel:[1,1] op_sel_hi:[0,0] neg_lo:[0,1] neg_hi:[1,0]
v_pk_add_f32 v[26:27], v[26:27], v[30:31]
v_pk_add_f32 v[30:31], v[64:65], v[36:37] neg_lo:[0,1] neg_hi:[0,1]
v_pk_add_f32 v[64:65], v[64:65], v[36:37]
v_pk_add_f32 v[36:37], v[34:35], v[38:39] op_sel:[1,1] op_sel_hi:[0,0] neg_lo:[0,1] neg_hi:[1,0]
v_pk_add_f32 v[34:35], v[34:35], v[38:39]
v_pk_add_f32 v[38:39], v[28:29], v[32:33] neg_lo:[0,1] neg_hi:[0,1]
v_pk_add_f32 v[28:29], v[28:29], v[32:33]
v_pk_add_f32 v[32:33], v[42:43], v[46:47] op_sel:[1,1] op_sel_hi:[0,0] neg_lo:[0,1] neg_hi:[1,0]
v_pk_add_f32 v[42:43], v[42:43], v[46:47]
v_pk_add_f32 v[46:47], v[14:15], v[52:53] neg_lo:[0,1] neg_hi:[0,1]
v_pk_add_f32 v[14:15], v[14:15], v[52:53]
v_pk_add_f32 v[52:53], v[50:51], v[54:55] op_sel:[1,1] op_sel_hi:[0,0] neg_lo:[0,1] neg_hi:[1,0]
v_pk_add_f32 v[50:51], v[50:51], v[54:55]
v_pk_add_f32 v[54:55], v[44:45], v[56:57] neg_lo:[0,1] neg_hi:[0,1]
v_pk_add_f32 v[44:45], v[44:45], v[56:57]
v_pk_add_f32 v[56:57], v[58:59], v[62:63] op_sel:[1,1] op_sel_hi:[0,0] neg_lo:[0,1] neg_hi:[1,0]
v_pk_add_f32 v[58:59], v[58:59], v[62:63]
v_pk_add_f32 v[62:63], v[40:41], v[68:69] neg_lo:[0,1] neg_hi:[0,1]
v_pk_add_f32 v[40:41], v[40:41], v[68:69]
v_pk_add_f32 v[68:69], v[66:67], v[70:71] op_sel:[1,1] op_sel_hi:[0,0] neg_lo:[0,1] neg_hi:[1,0]
v_pk_add_f32 v[66:67], v[66:67], v[70:71]
v_pk_add_f32 v[70:71], v[60:61], v[48:49] neg_lo:[0,1] neg_hi:[0,1]
v_pk_add_f32 v[60:61], v[60:61], v[48:49]
v_pk_add_f32 v[48:49], v[74:75], v[78:79] op_sel:[1,1] op_sel_hi:[0,0] neg_lo:[0,1] neg_hi:[1,0]
v_pk_add_f32 v[74:75], v[74:75], v[78:79]
v_pk_add_f32 v[78:79], v[16:17], v[18:19] neg_lo:[0,1] neg_hi:[0,1]
v_pk_add_f32 v[16:17], v[16:17], v[18:19]
v_pk_add_f32 v[18:19], v[76:77], v[20:21] neg_lo:[0,1] neg_hi:[0,1]
v_pk_add_f32 v[76:77], v[76:77], v[20:21]
v_pk_add_f32 v[20:21], v[72:73], v[26:27] neg_lo:[0,1] neg_hi:[0,1]
v_pk_add_f32 v[72:73], v[72:73], v[26:27]
v_pk_add_f32 v[26:27], v[22:23], v[24:25] neg_lo:[0,1] neg_hi:[0,1]
v_pk_add_f32 v[22:23], v[22:23], v[24:25]
v_pk_add_f32 v[24:25], v[64:65], v[34:35] neg_lo:[0,1] neg_hi:[0,1]
v_pk_add_f32 v[64:65], v[64:65], v[34:35]
v_pk_add_f32 v[34:35], v[30:31], v[36:37] neg_lo:[0,1] neg_hi:[0,1]
v_pk_add_f32 v[30:31], v[30:31], v[36:37]
v_pk_add_f32 v[36:37], v[28:29], v[42:43] neg_lo:[0,1] neg_hi:[0,1]
v_pk_add_f32 v[28:29], v[28:29], v[42:43]
v_pk_add_f32 v[42:43], v[38:39], v[32:33] neg_lo:[0,1] neg_hi:[0,1]
v_pk_add_f32 v[38:39], v[38:39], v[32:33]
v_pk_add_f32 v[32:33], v[14:15], v[50:51] neg_lo:[0,1] neg_hi:[0,1]
v_pk_add_f32 v[14:15], v[14:15], v[50:51]
v_pk_add_f32 v[50:51], v[46:47], v[52:53] neg_lo:[0,1] neg_hi:[0,1]
v_pk_add_f32 v[46:47], v[46:47], v[52:53]
v_pk_add_f32 v[52:53], v[44:45], v[58:59] neg_lo:[0,1] neg_hi:[0,1]
v_pk_add_f32 v[44:45], v[44:45], v[58:59]
v_pk_add_f32 v[58:59], v[54:55], v[56:57] neg_lo:[0,1] neg_hi:[0,1]
v_pk_add_f32 v[54:55], v[54:55], v[56:57]
v_pk_add_f32 v[56:57], v[40:41], v[66:67] neg_lo:[0,1] neg_hi:[0,1]
v_pk_add_f32 v[40:41], v[40:41], v[66:67]
v_pk_add_f32 v[66:67], v[62:63], v[68:69] neg_lo:[0,1] neg_hi:[0,1]
v_pk_add_f32 v[62:63], v[62:63], v[68:69]
v_pk_add_f32 v[68:69], v[60:61], v[74:75] neg_lo:[0,1] neg_hi:[0,1]
v_pk_add_f32 v[60:61], v[60:61], v[74:75]
v_pk_add_f32 v[74:75], v[70:71], v[48:49] neg_lo:[0,1] neg_hi:[0,1]
v_pk_add_f32 v[70:71], v[70:71], v[48:49]
ds_write_b64 v4, v[16:17] offset:0
ds_write_b64 v4, v[14:15] offset:256
ds_write_b64 v4, v[64:65] offset:512
ds_write_b64 v4, v[40:41] offset:768
ds_write_b64 v4, v[72:73] offset:1024
ds_write_b64 v4, v[44:45] offset:1280
ds_write_b64 v4, v[28:29] offset:1536
ds_write_b64 v4, v[60:61] offset:1792
ds_write_b64 v4, v[76:77] offset:2048
ds_write_b64 v4, v[46:47] offset:2304
ds_write_b64 v4, v[30:31] offset:2560
ds_write_b64 v4, v[62:63] offset:2816
ds_write_b64 v4, v[22:23] offset:3072
ds_write_b64 v4, v[54:55] offset:3328
ds_write_b64 v4, v[38:39] offset:3584
ds_write_b64 v4, v[70:71] offset:3840
ds_write_b64 v4, v[78:79] offset:4096
ds_write_b64 v4, v[32:33] offset:4352
ds_write_b64 v4, v[24:25] offset:4608
ds_write_b64 v4, v[56:57] offset:4864
ds_write_b64 v4, v[20:21] offset:5120
ds_write_b64 v4, v[52:53] offset:5376
ds_write_b64 v4, v[36:37] offset:5632
ds_write_b64 v4, v[68:69] offset:5888
ds_write_b64 v4, v[18:19] offset:6144
ds_write_b64 v4, v[50:51] offset:6400
ds_write_b64 v4, v[34:35] offset:6656
ds_write_b64 v4, v[66:67] offset:6912
ds_write_b64 v4, v[26:27] offset:7168
ds_write_b64 v4, v[58:59] offset:7424
ds_write_b64 v4, v[42:43] offset:7680
ds_write_b64 v4, v[74:75] offset:7936
ds_write_b64 v4, v[16:17] offset:8192
s_waitcnt lgkmcnt(0)
s_barrier
s_lshl_b32 s13, s93, 7
s_add_u32 s13, s13, 96468992
ds_read_b64 v[16:17], v6 offset:0
ds_read_b64 v[18:19], v7 offset:4096
ds_read_b64 v[20:21], v6 offset:256
ds_read_b64 v[22:23], v7 offset:3840
ds_read_b64 v[24:25], v6 offset:512
ds_read_b64 v[26:27], v7 offset:3584
ds_read_b64 v[28:29], v6 offset:768
ds_read_b64 v[30:31], v7 offset:3328
ds_read_b64 v[32:33], v6 offset:1024
ds_read_b64 v[34:35], v7 offset:3072
ds_read_b64 v[36:37], v6 offset:1280
ds_read_b64 v[38:39], v7 offset:2816
s_waitcnt lgkmcnt(10)
v_pk_add_f32 v[208:209], v[16:17], v[18:19] neg_hi:[0,1]
v_pk_add_f32 v[210:211], v[16:17], v[18:19] op_sel:[1,1] op_sel_hi:[0,0] neg_hi:[1,0]
ds_read_b64 v[40:41], v6 offset:1536
ds_read_b64 v[42:43], v7 offset:2560
buffer_store_dwordx4 v[208:211], v8, s[84:87], s13 offen sc1
s_add_u32 s13, s13, 524288
s_waitcnt lgkmcnt(10)
v_pk_add_f32 v[212:213], v[20:21], v[22:23] neg_hi:[0,1]
v_pk_add_f32 v[214:215], v[20:21], v[22:23] op_sel:[1,1] op_sel_hi:[0,0] neg_hi:[1,0]
ds_read_b64 v[44:45], v6 offset:1792
ds_read_b64 v[46:47], v7 offset:2304
buffer_store_dwordx4 v[212:215], v8, s[84:87], s13 offen sc1
s_add_u32 s13, s13, 524288
s_waitcnt lgkmcnt(10)
v_pk_add_f32 v[216:217], v[24:25], v[26:27] neg_hi:[0,1]
v_pk_add_f32 v[218:219], v[24:25], v[26:27] op_sel:[1,1] op_sel_hi:[0,0] neg_hi:[1,0]
ds_read_b64 v[16:17], v6 offset:2048
ds_read_b64 v[18:19], v7 offset:2048
buffer_store_dwordx4 v[216:219], v8, s[84:87], s13 offen sc1
s_add_u32 s13, s13, 524288
s_waitcnt lgkmcnt(10)
v_pk_add_f32 v[220:221], v[28:29], v[30:31] neg_hi:[0,1]
v_pk_add_f32 v[222:223], v[28:29], v[30:31] op_sel:[1,1] op_sel_hi:[0,0] neg_hi:[1,0]
ds_read_b64 v[20:21], v6 offset:2304
ds_read_b64 v[22:23], v7 offset:1792
buffer_store_dwordx4 v[220:223], v8, s[84:87], s13 offen sc1
s_add_u32 s13, s13, 524288
s_waitcnt lgkmcnt(10)
v_pk_add_f32 v[224:225], v[32:33], v[34:35] neg_hi:[0,1]
v_pk_add_f32 v[226:227], v[32:33], v[34:35] op_sel:[1,1] op_sel_hi:[0,0] neg_hi:[1,0]
ds_read_b64 v[24:25], v6 offset:2560
ds_read_b64 v[26:27], v7 offset:1536
buffer_store_dwordx4 v[224:227], v8, s[84:87], s13 offen sc1
s_add_u32 s13, s13, 524288
s_waitcnt lgkmcnt(10)
v_pk_add_f32 v[228:229], v[36:37], v[38:39] neg_hi:[0,1]
v_pk_add_f32 v[230:231], v[36:37], v[38:39] op_sel:[1,1] op_sel_hi:[0,0] neg_hi:[1,0]
ds_read_b64 v[28:29], v6 offset:2816
ds_read_b64 v[30:31], v7 offset:1280
buffer_store_dwordx4 v[228:231], v8, s[84:87], s13 offen sc1
s_add_u32 s13, s13, 524288
s_waitcnt lgkmcnt(10)
v_pk_add_f32 v[232:233], v[40:41], v[42:43] neg_hi:[0,1]
v_pk_add_f32 v[234:235], v[40:41], v[42:43] op_sel:[1,1] op_sel_hi:[0,0] neg_hi:[1,0]
ds_read_b64 v[32:33], v6 offset:3072
ds_read_b64 v[34:35], v7 offset:1024
buffer_store_dwordx4 v[232:235], v8, s[84:87], s13 offen sc1
s_add_u32 s13, s13, 524288
s_waitcnt lgkmcnt(10)
v_pk_add_f32 v[236:237], v[44:45], v[46:47] neg_hi:[0,1]
v_pk_add_f32 v[238:239], v[44:45], v[46:47] op_sel:[1,1] op_sel_hi:[0,0] neg_hi:[1,0]
ds_read_b64 v[36:37], v6 offset:3328
ds_read_b64 v[38:39], v7 offset:768
buffer_store_dwordx4 v[236:239], v8, s[84:87], s13 offen sc1
s_add_u32 s13, s13, 524288
s_waitcnt lgkmcnt(10)
v_pk_add_f32 v[208:209], v[16:17], v[18:19] neg_hi:[0,1]
v_pk_add_f32 v[210:211], v[16:17], v[18:19] op_sel:[1,1] op_sel_hi:[0,0] neg_hi:[1,0]
ds_read_b64 v[40:41], v6 offset:3584
ds_read_b64 v[42:43], v7 offset:512
buffer_store_dwordx4 v[208:211], v8, s[84:87], s13 offen sc1
s_add_u32 s13, s13, 524288
s_waitcnt lgkmcnt(10)
v_pk_add_f32 v[212:213], v[20:21], v[22:23] neg_hi:[0,1]
v_pk_add_f32 v[214:215], v[20:21], v[22:23] op_sel:[1,1] op_sel_hi:[0,0] neg_hi:[1,0]
ds_read_b64 v[44:45], v6 offset:3840
ds_read_b64 v[46:47], v7 offset:256
buffer_store_dwordx4 v[212:215], v8, s[84:87], s13 offen sc1
s_add_u32 s13, s13, 524288
s_waitcnt lgkmcnt(10)
v_pk_add_f32 v[216:217], v[24:25], v[26:27] neg_hi:[0,1]
v_pk_add_f32 v[218:219], v[24:25], v[26:27] op_sel:[1,1] op_sel_hi:[0,0] neg_hi:[1,0]
ds_read_b64 v[16:17], v6 offset:4096
ds_read_b64 v[18:19], v7 offset:0
buffer_store_dwordx4 v[216:219], v8, s[84:87], s13 offen sc1
s_add_u32 s13, s13, 524288
s_waitcnt lgkmcnt(10)
v_pk_add_f32 v[220:221], v[28:29], v[30:31] neg_hi:[0,1]
v_pk_add_f32 v[222:223], v[28:29], v[30:31] op_sel:[1,1] op_sel_hi:[0,0] neg_hi:[1,0]
buffer_store_dwordx4 v[220:223], v8, s[84:87], s13 offen sc1
s_add_u32 s13, s13, 524288
s_waitcnt lgkmcnt(8)
v_pk_add_f32 v[224:225], v[32:33], v[34:35] neg_hi:[0,1]
v_pk_add_f32 v[226:227], v[32:33], v[34:35] op_sel:[1,1] op_sel_hi:[0,0] neg_hi:[1,0]
buffer_store_dwordx4 v[224:227], v8, s[84:87], s13 offen sc1
s_add_u32 s13, s13, 524288
s_waitcnt lgkmcnt(6)
v_pk_add_f32 v[228:229], v[36:37], v[38:39] neg_hi:[0,1]
v_pk_add_f32 v[230:231], v[36:37], v[38:39] op_sel:[1,1] op_sel_hi:[0,0] neg_hi:[1,0]
buffer_store_dwordx4 v[228:231], v8, s[84:87], s13 offen sc1
s_add_u32 s13, s13, 524288
s_waitcnt lgkmcnt(4)
v_pk_add_f32 v[232:233], v[40:41], v[42:43] neg_hi:[0,1]
v_pk_add_f32 v[234:235], v[40:41], v[42:43] op_sel:[1,1] op_sel_hi:[0,0] neg_hi:[1,0]
buffer_store_dwordx4 v[232:235], v8, s[84:87], s13 offen sc1
s_add_u32 s13, s13, 524288
s_waitcnt lgkmcnt(2)
v_pk_add_f32 v[236:237], v[44:45], v[46:47] neg_hi:[0,1]
v_pk_add_f32 v[238:239], v[44:45], v[46:47] op_sel:[1,1] op_sel_hi:[0,0] neg_hi:[1,0]
buffer_store_dwordx4 v[236:239], v8, s[84:87], s13 offen sc1
s_add_u32 s13, s13, 524288
s_waitcnt lgkmcnt(0)
v_pk_add_f32 v[208:209], v[16:17], v[18:19] neg_hi:[0,1]
v_pk_add_f32 v[210:211], v[16:17], v[18:19] op_sel:[1,1] op_sel_hi:[0,0] neg_hi:[1,0]
v_cmp_eq_u32 vcc, 0, v9
s_nop 1
v_cndmask_b32 v13, -16, v8, vcc
buffer_store_dwordx4 v[208:211], v13, s[84:87], s13 offen sc1
s_add_u32 s13, s13, 524288
s_mov_b32 s93, s21
s_cmp_lt_u32 s93, 128
s_cbranch_scc1 mega_kernel_f1_l
mega_kernel_f1_e:
v_and_b32 v3, 15, v0
v_lshlrev_b32 v3, 4, v3
s_branch mega_kernel_syd
mega_kernel_sydw:
s_sleep 4
mega_kernel_syd:
buffer_load_dword v2, v3, s[72:75], 0 offen sc1
s_waitcnt vmcnt(0)
mega_kernel_sydp:
s_cmp_eq_u32 s95, 1
s_cbranch_scc0 mega_kernel_sydf
v_readlane_b32 s76, v2, 14
s_mov_b32 s98, 0
s_cmp_eq_u32 s76, 32
s_cbranch_scc0 mega_kernel_sydw
s_branch mega_kernel_sydd
mega_kernel_sydf:
s_mov_b32 s77, 0
s_mov_b32 s78, 0
v_readlane_b32 s76, v2, 0
s_add_u32 s77, s77, s76
s_xor_b32 s76, s76, 32
s_or_b32 s78, s78, s76
v_readlane_b32 s76, v2, 1
s_add_u32 s77, s77, s76
s_xor_b32 s76, s76, 32
s_or_b32 s78, s78, s76
v_readlane_b32 s76, v2, 2
s_add_u32 s77, s77, s76
s_xor_b32 s76, s76, 32
s_or_b32 s78, s78, s76
v_readlane_b32 s76, v2, 3
s_add_u32 s77, s77, s76
s_xor_b32 s76, s76, 32
s_or_b32 s78, s78, s76
v_readlane_b32 s76, v2, 4
s_add_u32 s77, s77, s76
s_xor_b32 s76, s76, 32
s_or_b32 s78, s78, s76
v_readlane_b32 s76, v2, 5
s_add_u32 s77, s77, s76
s_xor_b32 s76, s76, 32
s_or_b32 s78, s78, s76
v_readlane_b32 s76, v2, 6
s_add_u32 s77, s77, s76
s_xor_b32 s76, s76, 32
s_or_b32 s78, s78, s76
v_readlane_b32 s76, v2, 7
s_add_u32 s77, s77, s76
s_xor_b32 s76, s76, 32
s_or_b32 s78, s78, s76
s_cmp_eq_u32 s77, 256
s_cbranch_scc0 mega_kernel_sydw
v_mov_b32 v252, v2
s_cmp_eq_u32 s78, 0
s_cbranch_scc0 mega_kernel_slowent
v_readlane_b32 s76, v2, 10
v_readlane_b32 s77, v2, 8
s_cmp_eq_u32 s76, 32
s_cbranch_scc0 mega_kernel_sydw
s_cmp_gt_u32 s77, 16
s_cselect_b32 s98, 1, 0
mega_kernel_sydd:
s_waitcnt vmcnt(0)
s_barrier
v_mov_b32 v1, 0
v_mov_b32 v2, 1
s_mov_b32 s82, 69259264
v_cmp_eq_u32 vcc, 0, v0
s_and_saveexec_b64 s[80:81], vcc
s_cbranch_execz mega_kernel_sg0
buffer_atomic_add v2, v1, s[84:87], s82 offen sc1
mega_kernel_sg0:
s_mov_b64 exec, s[80:81]
s_add_u32 s38, s40, 129
s_mov_b32 s39, 32
s_mov_b32 s37, 129
s_cmp_lt_u32 s38, 129
s_cbranch_scc1 mega_kernel_f2s
s_branch mega_kernel_f2e
mega_kernel_rk:
s_load_dwordx2 s[4:5], s[0:1], 24
s_load_dwordx2 s[8:9], s[0:1], 0
v_lshrrev_b32 v2, 6, v0
v_and_b32 v1, 63, v0
v_readfirstlane_b32 s41, v2
v_lshlrev_b32 v5, 4, v1
s_waitcnt lgkmcnt(0)
s_mov_b32 s6, 8388608
s_mov_b32 s7, 0x00020000
s_mov_b32 s10, 4194304
s_mov_b32 s11, 0x00020000
s_lshl_b32 s43, s40, 8
s_lshl_b32 s44, s41, 6
s_add_u32 s48, s43, s44
s_and_b32 s43, s48, 0x7ff
v_add_u32 v19, s43, v1
v_lshlrev_b32 v19, 7, v19
s_mov_b32 s43, 131072
buffer_load_dword v250, v19, s[8:11], s43 offen
s_nop 0
v_lshrrev_b32 v2, 3, v1
s_lshl_b32 s43, s41, 3
v_add_u32 v2, s43, v2
v_bfe_u32 v3, v2, 1, 3
v_and_b32 v4, 7, v1
v_xor_b32 v3, v3, v4
v_lshlrev_b32 v6, 11, v2
v_lshl_add_u32 v6, v3, 4, v6
s_lshl_b32 s46, s41, 10
v_and_b32 v2, 15, v1
v_bfe_u32 v3, v2, 1, 3
v_lshrrev_b32 v4, 4, v1
v_xor_b32 v3, v3, v4
v_lshlrev_b32 v8, 7, v2
v_lshl_add_u32 v8, v3, 4, v8
v_xor_b32 v9, 64, v8
v_add_u32 v10, 0x10000, v8
v_add_u32 v11, 0x10000, v9
v_mov_b32 v7, v5
s_lshl_b32 s47, s40, 2
s_add_u32 s47, s47, s41
s_mov_b32 s42, 0
s_mov_b32 s50, 0
s_add_u32 m0, s46, 0
s_nop 0
buffer_load_dwordx4 v6, s[8:11], s50 offen offset:0 lds
s_add_u32 m0, s46, 3968
s_nop 0
buffer_load_dwordx4 v6, s[8:11], s50 offen offset:128 lds
s_add_u32 m0, s46, 7936
s_nop 0
buffer_load_dwordx4 v6, s[8:11], s50 offen offset:256 lds
s_add_u32 m0, s46, 11904
s_nop 0
buffer_load_dwordx4 v6, s[8:11], s50 offen offset:384 lds
s_add_u32 m0, s46, 15872
s_nop 0
buffer_load_dwordx4 v6, s[8:11], s50 offen offset:512 lds
s_add_u32 m0, s46, 19840
s_nop 0
buffer_load_dwordx4 v6, s[8:11], s50 offen offset:640 lds
s_add_u32 m0, s46, 23808
s_nop 0
buffer_load_dwordx4 v6, s[8:11], s50 offen offset:768 lds
s_add_u32 m0, s46, 27776
s_nop 0
buffer_load_dwordx4 v6, s[8:11], s50 offen offset:896 lds
s_add_u32 m0, s46, 31744
s_nop 0
buffer_load_dwordx4 v6, s[8:11], s50 offen offset:1024 lds
s_add_u32 m0, s46, 35712
s_nop 0
buffer_load_dwordx4 v6, s[8:11], s50 offen offset:1152 lds
s_add_u32 m0, s46, 39680
s_nop 0
buffer_load_dwordx4 v6, s[8:11], s50 offen offset:1280 lds
s_add_u32 m0, s46, 43648
s_nop 0
buffer_load_dwordx4 v6, s[8:11], s50 offen offset:1408 lds
s_add_u32 m0, s46, 47616
s_nop 0
buffer_load_dwordx4 v6, s[8:11], s50 offen offset:1536 lds
s_add_u32 m0, s46, 51584
s_nop 0
buffer_load_dwordx4 v6, s[8:11], s50 offen offset:1664 lds
s_add_u32 m0, s46, 55552
s_nop 0
buffer_load_dwordx4 v6, s[8:11], s50 offen offset:1792 lds
s_add_u32 m0, s46, 59520
s_nop 0
buffer_load_dwordx4 v6, s[8:11], s50 offen offset:1920 lds
s_mov_b32 s50, 0x10000
s_add_u32 m0, s46, 65536
s_nop 0
buffer_load_dwordx4 v6, s[8:11], s50 offen offset:0 lds
s_add_u32 m0, s46, 69504
s_nop 0
buffer_load_dwordx4 v6, s[8:11], s50 offen offset:128 lds
s_add_u32 m0, s46, 73472
s_nop 0
buffer_load_dwordx4 v6, s[8:11], s50 offen offset:256 lds
s_add_u32 m0, s46, 77440
s_nop 0
buffer_load_dwordx4 v6, s[8:11], s50 offen offset:384 lds
s_add_u32 m0, s46, 81408
s_nop 0
buffer_load_dwordx4 v6, s[8:11], s50 offen offset:512 lds
s_add_u32 m0, s46, 85376
s_nop 0
buffer_load_dwordx4 v6, s[8:11], s50 offen offset:640 lds
s_add_u32 m0, s46, 89344
s_nop 0
buffer_load_dwordx4 v6, s[8:11], s50 offen offset:768 lds
s_add_u32 m0, s46, 93312
s_nop 0
buffer_load_dwordx4 v6, s[8:11], s50 offen offset:896 lds
s_add_u32 m0, s46, 97280
s_nop 0
buffer_load_dwordx4 v6, s[8:11], s50 offen offset:1024 lds
s_add_u32 m0, s46, 101248
s_nop 0
buffer_load_dwordx4 v6, s[8:11], s50 offen offset:1152 lds
s_add_u32 m0, s46, 105216
s_nop 0
buffer_load_dwordx4 v6, s[8:11], s50 offen offset:1280 lds
s_add_u32 m0, s46, 109184
s_nop 0
buffer_load_dwordx4 v6, s[8:11], s50 offen offset:1408 lds
s_add_u32 m0, s46, 113152
s_nop 0
buffer_load_dwordx4 v6, s[8:11], s50 offen offset:1536 lds
s_add_u32 m0, s46, 117120
s_nop 0
buffer_load_dwordx4 v6, s[8:11], s50 offen offset:1664 lds
s_add_u32 m0, s46, 121088
s_nop 0
buffer_load_dwordx4 v6, s[8:11], s50 offen offset:1792 lds
s_add_u32 m0, s46, 125056
s_nop 0
buffer_load_dwordx4 v6, s[8:11], s50 offen offset:1920 lds
v_lshrrev_b32 v2, 2, v1
v_and_b32 v3, 3, v1
v_lshlrev_b32 v16, 13, v2
v_lshl_add_u32 v16, v3, 4, v16
v_add_u32 v16, s48, v16
s_mul_i32 s45, s41, 8192
s_add_u32 s45, s45, 131072
v_bfe_u32 v17, v1, 2, 2
v_lshrrev_b32 v18, 4, v1
v_lshl_add_u32 v17, v18, 3, v17
v_lshlrev_b32 v17, 6, v17
v_lshl_add_u32 v17, v3, 4, v17
v_add_u32 v17, s45, v17
s_and_b32 s43, s40, 3
s_lshl_b32 s43, s43, 2
s_add_u32 s43, s43, s41
s_lshl_b32 s43, s43, 3
v_and_b32 v12, 7, v1
v_add_u32 v12, s43, v12
s_lshr_b32 s43, s40, 2
s_lshl_b32 s43, s43, 10
s_add_u32 s44, s43, 896
s_add_u32 s43, s43, 384
s_cmp_ge_u32 s40, 28
s_cselect_b32 s44, s44, s43
v_mov_b32 v13, s43
v_mov_b32 v14, s44
v_cmp_gt_u32 vcc, 32, v1
s_nop 1
v_cndmask_b32 v13, v14, v13, vcc
v_lshl_add_u32 v12, v12, 13, v13
s_mov_b32 s44, 0
buffer_load_dword v250, v12, s[4:7], s44 offen
s_add_u32 m0, s45, 0
s_mov_b32 s44, 0
buffer_load_dwordx4 v16, s[4:7], s44 offen lds
s_add_u32 m0, s45, 1024
s_mov_b32 s44, 131072
buffer_load_dwordx4 v16, s[4:7], s44 offen lds
s_add_u32 m0, s45, 2048
s_mov_b32 s44, 262144
buffer_load_dwordx4 v16, s[4:7], s44 offen lds
s_add_u32 m0, s45, 3072
s_mov_b32 s44, 393216
buffer_load_dwordx4 v16, s[4:7], s44 offen lds
s_add_u32 m0, s45, 4096
s_mov_b32 s44, 524288
buffer_load_dwordx4 v16, s[4:7], s44 offen lds
s_add_u32 m0, s45, 5120
s_mov_b32 s44, 655360
buffer_load_dwordx4 v16, s[4:7], s44 offen lds
s_add_u32 m0, s45, 6144
s_mov_b32 s44, 786432
buffer_load_dwordx4 v16, s[4:7], s44 offen lds
s_add_u32 m0, s45, 7168
s_mov_b32 s44, 917504
buffer_load_dwordx4 v16, s[4:7], s44 offen lds
s_waitcnt vmcnt(4)
s_barrier
ds_read_b64_tr_b16 a[0:1], v17 offset:0
ds_read_b64_tr_b16 a[2:3], v17 offset:256
ds_read_b64_tr_b16 a[4:5], v17 offset:8
ds_read_b64_tr_b16 a[6:7], v17 offset:264
ds_read_b64_tr_b16 a[8:9], v17 offset:2048
ds_read_b64_tr_b16 a[10:11], v17 offset:2304
ds_read_b64_tr_b16 a[12:13], v17 offset:2056
ds_read_b64_tr_b16 a[14:15], v17 offset:2312
s_waitcnt lgkmcnt(0)
s_mov_b32 s44, 1048576
buffer_load_dword v250, v12, s[4:7], s44 offen
s_add_u32 m0, s45, 0
s_mov_b32 s44, 1048576
buffer_load_dwordx4 v16, s[4:7], s44 offen lds
s_add_u32 m0, s45, 1024
s_mov_b32 s44, 1179648
buffer_load_dwordx4 v16, s[4:7], s44 offen lds
s_add_u32 m0, s45, 2048
s_mov_b32 s44, 1310720
buffer_load_dwordx4 v16, s[4:7], s44 offen lds
s_add_u32 m0, s45, 3072
s_mov_b32 s44, 1441792
buffer_load_dwordx4 v16, s[4:7], s44 offen lds
ds_read_b128 v[20:23], v8 offset:0
ds_read_b128 v[24:27], v8 offset:2048
ds_read_b128 v[28:31], v9 offset:0
ds_read_b128 v[32:35], v9 offset:2048
ds_read_b128 v[36:39], v10 offset:0
ds_read_b128 v[40:43], v10 offset:2048
ds_read_b128 v[44:47], v11 offset:0
ds_read_b128 v[48:51], v11 offset:2048
s_waitcnt lgkmcnt(0)
v_mfma_f32_16x16x32_bf16 v[52:55], a[0:3], v[20:23], 0
v_mfma_f32_16x16x32_bf16 v[56:59], a[4:7], v[20:23], 0
v_mfma_f32_16x16x32_bf16 v[60:63], a[0:3], v[24:27], 0
v_mfma_f32_16x16x32_bf16 v[64:67], a[4:7], v[24:27], 0
v_mfma_f32_16x16x32_bf16 v[52:55], a[8:11], v[28:31], v[52:55]
v_mfma_f32_16x16x32_bf16 v[56:59], a[12:15], v[28:31], v[56:59]
v_mfma_f32_16x16x32_bf16 v[60:63], a[8:11], v[32:35], v[60:63]
v_mfma_f32_16x16x32_bf16 v[64:67], a[12:15], v[32:35], v[64:67]
v_mfma_f32_16x16x32_bf16 v[68:71], a[0:3], v[36:39], 0
v_mfma_f32_16x16x32_bf16 v[72:75], a[4:7], v[36:39], 0
v_mfma_f32_16x16x32_bf16 v[76:79], a[0:3], v[40:43], 0
v_mfma_f32_16x16x32_bf16 v[80:83], a[4:7], v[40:43], 0
v_mfma_f32_16x16x32_bf16 v[68:71], a[8:11], v[44:47], v[68:71]
v_mfma_f32_16x16x32_bf16 v[72:75], a[12:15], v[44:47], v[72:75]
v_mfma_f32_16x16x32_bf16 v[76:79], a[8:11], v[48:51], v[76:79]
v_mfma_f32_16x16x32_bf16 v[80:83], a[12:15], v[48:51], v[80:83]
s_waitcnt vmcnt(5)
ds_read_b64_tr_b16 a[16:17], v17 offset:4096
ds_read_b64_tr_b16 a[18:19], v17 offset:4352
ds_read_b64_tr_b16 a[20:21], v17 offset:4104
ds_read_b64_tr_b16 a[22:23], v17 offset:4360
ds_read_b64_tr_b16 a[24:25], v17 offset:6144
ds_read_b64_tr_b16 a[26:27], v17 offset:6400
ds_read_b64_tr_b16 a[28:29], v17 offset:6152
ds_read_b64_tr_b16 a[30:31], v17 offset:6408
s_waitcnt lgkmcnt(0)
s_add_u32 m0, s45, 4096
s_mov_b32 s44, 1572864
buffer_load_dwordx4 v16, s[4:7], s44 offen lds
s_add_u32 m0, s45, 5120
s_mov_b32 s44, 1703936
buffer_load_dwordx4 v16, s[4:7], s44 offen lds
s_add_u32 m0, s45, 6144
s_mov_b32 s44, 1835008
buffer_load_dwordx4 v16, s[4:7], s44 offen lds
s_add_u32 m0, s45, 7168
s_mov_b32 s44, 1966080
buffer_load_dwordx4 v16, s[4:7], s44 offen lds
ds_read_b128 v[20:23], v8 offset:4096
ds_read_b128 v[24:27], v8 offset:6144
ds_read_b128 v[28:31], v9 offset:4096
ds_read_b128 v[32:35], v9 offset:6144
ds_read_b128 v[36:39], v10 offset:4096
ds_read_b128 v[40:43], v10 offset:6144
ds_read_b128 v[44:47], v11 offset:4096
ds_read_b128 v[48:51], v11 offset:6144
s_waitcnt lgkmcnt(0)
v_mfma_f32_16x16x32_bf16 v[52:55], a[16:19], v[20:23], v[52:55]
v_mfma_f32_16x16x32_bf16 v[56:59], a[20:23], v[20:23], v[56:59]
v_mfma_f32_16x16x32_bf16 v[60:63], a[16:19], v[24:27], v[60:63]
v_mfma_f32_16x16x32_bf16 v[64:67], a[20:23], v[24:27], v[64:67]
v_mfma_f32_16x16x32_bf16 v[52:55], a[24:27], v[28:31], v[52:55]
v_mfma_f32_16x16x32_bf16 v[56:59], a[28:31], v[28:31], v[56:59]
v_mfma_f32_16x16x32_bf16 v[60:63], a[24:27], v[32:35], v[60:63]
v_mfma_f32_16x16x32_bf16 v[64:67], a[28:31], v[32:35], v[64:67]
v_mfma_f32_16x16x32_bf16 v[68:71], a[16:19], v[36:39], v[68:71]
v_mfma_f32_16x16x32_bf16 v[72:75], a[20:23], v[36:39], v[72:75]
v_mfma_f32_16x16x32_bf16 v[76:79], a[16:19], v[40:43], v[76:79]
v_mfma_f32_16x16x32_bf16 v[80:83], a[20:23], v[40:43], v[80:83]
v_mfma_f32_16x16x32_bf16 v[68:71], a[24:27], v[44:47], v[68:71]
v_mfma_f32_16x16x32_bf16 v[72:75], a[28:31], v[44:47], v[72:75]
v_mfma_f32_16x16x32_bf16 v[76:79], a[24:27], v[48:51], v[76:79]
v_mfma_f32_16x16x32_bf16 v[80:83], a[28:31], v[48:51], v[80:83]
s_waitcnt vmcnt(4)
ds_read_b64_tr_b16 a[32:33], v17 offset:0
ds_read_b64_tr_b16 a[34:35], v17 offset:256
ds_read_b64_tr_b16 a[36:37], v17 offset:8
ds_read_b64_tr_b16 a[38:39], v17 offset:264
ds_read_b64_tr_b16 a[40:41], v17 offset:2048
ds_read_b64_tr_b16 a[42:43], v17 offset:2304
ds_read_b64_tr_b16 a[44:45], v17 offset:2056
ds_read_b64_tr_b16 a[46:47], v17 offset:2312
s_waitcnt lgkmcnt(0)
s_mov_b32 s44, 2097152
buffer_load_dword v250, v12, s[4:7], s44 offen
s_add_u32 m0, s45, 0
s_mov_b32 s44, 2097152
buffer_load_dwordx4 v16, s[4:7], s44 offen lds
s_add_u32 m0, s45, 1024
s_mov_b32 s44, 2228224
buffer_load_dwordx4 v16, s[4:7], s44 offen lds
s_add_u32 m0, s45, 2048
s_mov_b32 s44, 2359296
buffer_load_dwordx4 v16, s[4:7], s44 offen lds
s_add_u32 m0, s45, 3072
s_mov_b32 s44, 2490368
buffer_load_dwordx4 v16, s[4:7], s44 offen lds
ds_read_b128 v[20:23], v8 offset:8192
ds_read_b128 v[24:27], v8 offset:10240
ds_read_b128 v[28:31], v9 offset:8192
ds_read_b128 v[32:35], v9 offset:10240
ds_read_b128 v[36:39], v10 offset:8192
ds_read_b128 v[40:43], v10 offset:10240
ds_read_b128 v[44:47], v11 offset:8192
ds_read_b128 v[48:51], v11 offset:10240
s_waitcnt lgkmcnt(0)
v_mfma_f32_16x16x32_bf16 v[52:55], a[32:35], v[20:23], v[52:55]
v_mfma_f32_16x16x32_bf16 v[56:59], a[36:39], v[20:23], v[56:59]
v_mfma_f32_16x16x32_bf16 v[60:63], a[32:35], v[24:27], v[60:63]
v_mfma_f32_16x16x32_bf16 v[64:67], a[36:39], v[24:27], v[64:67]
v_mfma_f32_16x16x32_bf16 v[52:55], a[40:43], v[28:31], v[52:55]
v_mfma_f32_16x16x32_bf16 v[56:59], a[44:47], v[28:31], v[56:59]
v_mfma_f32_16x16x32_bf16 v[60:63], a[40:43], v[32:35], v[60:63]
v_mfma_f32_16x16x32_bf16 v[64:67], a[44:47], v[32:35], v[64:67]
v_mfma_f32_16x16x32_bf16 v[68:71], a[32:35], v[36:39], v[68:71]
v_mfma_f32_16x16x32_bf16 v[72:75], a[36:39], v[36:39], v[72:75]
v_mfma_f32_16x16x32_bf16 v[76:79], a[32:35], v[40:43], v[76:79]
v_mfma_f32_16x16x32_bf16 v[80:83], a[36:39], v[40:43], v[80:83]
v_mfma_f32_16x16x32_bf16 v[68:71], a[40:43], v[44:47], v[68:71]
v_mfma_f32_16x16x32_bf16 v[72:75], a[44:47], v[44:47], v[72:75]
v_mfma_f32_16x16x32_bf16 v[76:79], a[40:43], v[48:51], v[76:79]
v_mfma_f32_16x16x32_bf16 v[80:83], a[44:47], v[48:51], v[80:83]
s_waitcnt vmcnt(5)
ds_read_b64_tr_b16 a[48:49], v17 offset:4096
ds_read_b64_tr_b16 a[50:51], v17 offset:4352
ds_read_b64_tr_b16 a[52:53], v17 offset:4104
ds_read_b64_tr_b16 a[54:55], v17 offset:4360
ds_read_b64_tr_b16 a[56:57], v17 offset:6144
ds_read_b64_tr_b16 a[58:59], v17 offset:6400
ds_read_b64_tr_b16 a[60:61], v17 offset:6152
ds_read_b64_tr_b16 a[62:63], v17 offset:6408
s_waitcnt lgkmcnt(0)
s_add_u32 m0, s45, 4096
s_mov_b32 s44, 2621440
buffer_load_dwordx4 v16, s[4:7], s44 offen lds
s_add_u32 m0, s45, 5120
s_mov_b32 s44, 2752512
buffer_load_dwordx4 v16, s[4:7], s44 offen lds
s_add_u32 m0, s45, 6144
s_mov_b32 s44, 2883584
buffer_load_dwordx4 v16, s[4:7], s44 offen lds
s_add_u32 m0, s45, 7168
s_mov_b32 s44, 3014656
buffer_load_dwordx4 v16, s[4:7], s44 offen lds
ds_read_b128 v[20:23], v8 offset:12288
ds_read_b128 v[24:27], v8 offset:14336
ds_read_b128 v[28:31], v9 offset:12288
ds_read_b128 v[32:35], v9 offset:14336
ds_read_b128 v[36:39], v10 offset:12288
ds_read_b128 v[40:43], v10 offset:14336
ds_read_b128 v[44:47], v11 offset:12288
ds_read_b128 v[48:51], v11 offset:14336
s_waitcnt lgkmcnt(0)
v_mfma_f32_16x16x32_bf16 v[52:55], a[48:51], v[20:23], v[52:55]
v_mfma_f32_16x16x32_bf16 v[56:59], a[52:55], v[20:23], v[56:59]
v_mfma_f32_16x16x32_bf16 v[60:63], a[48:51], v[24:27], v[60:63]
v_mfma_f32_16x16x32_bf16 v[64:67], a[52:55], v[24:27], v[64:67]
v_mfma_f32_16x16x32_bf16 v[52:55], a[56:59], v[28:31], v[52:55]
v_mfma_f32_16x16x32_bf16 v[56:59], a[60:63], v[28:31], v[56:59]
v_mfma_f32_16x16x32_bf16 v[60:63], a[56:59], v[32:35], v[60:63]
v_mfma_f32_16x16x32_bf16 v[64:67], a[60:63], v[32:35], v[64:67]
v_mfma_f32_16x16x32_bf16 v[68:71], a[48:51], v[36:39], v[68:71]
v_mfma_f32_16x16x32_bf16 v[72:75], a[52:55], v[36:39], v[72:75]
v_mfma_f32_16x16x32_bf16 v[76:79], a[48:51], v[40:43], v[76:79]
v_mfma_f32_16x16x32_bf16 v[80:83], a[52:55], v[40:43], v[80:83]
v_mfma_f32_16x16x32_bf16 v[68:71], a[56:59], v[44:47], v[68:71]
v_mfma_f32_16x16x32_bf16 v[72:75], a[60:63], v[44:47], v[72:75]
v_mfma_f32_16x16x32_bf16 v[76:79], a[56:59], v[48:51], v[76:79]
v_mfma_f32_16x16x32_bf16 v[80:83], a[60:63], v[48:51], v[80:83]
s_waitcnt vmcnt(4)
ds_read_b64_tr_b16 a[64:65], v17 offset:0
ds_read_b64_tr_b16 a[66:67], v17 offset:256
ds_read_b64_tr_b16 a[68:69], v17 offset:8
ds_read_b64_tr_b16 a[70:71], v17 offset:264
ds_read_b64_tr_b16 a[72:73], v17 offset:2048
ds_read_b64_tr_b16 a[74:75], v17 offset:2304
ds_read_b64_tr_b16 a[76:77], v17 offset:2056
ds_read_b64_tr_b16 a[78:79], v17 offset:2312
s_waitcnt lgkmcnt(0)
s_mov_b32 s44, 3145728
buffer_load_dword v250, v12, s[4:7], s44 offen
s_add_u32 m0, s45, 0
s_mov_b32 s44, 3145728
buffer_load_dwordx4 v16, s[4:7], s44 offen lds
s_add_u32 m0, s45, 1024
s_mov_b32 s44, 3276800
buffer_load_dwordx4 v16, s[4:7], s44 offen lds
s_add_u32 m0, s45, 2048
s_mov_b32 s44, 3407872
buffer_load_dwordx4 v16, s[4:7], s44 offen lds
s_add_u32 m0, s45, 3072
s_mov_b32 s44, 3538944
buffer_load_dwordx4 v16, s[4:7], s44 offen lds
ds_read_b128 v[20:23], v8 offset:16384
ds_read_b128 v[24:27], v8 offset:18432
ds_read_b128 v[28:31], v9 offset:16384
ds_read_b128 v[32:35], v9 offset:18432
ds_read_b128 v[36:39], v10 offset:16384
ds_read_b128 v[40:43], v10 offset:18432
ds_read_b128 v[44:47], v11 offset:16384
ds_read_b128 v[48:51], v11 offset:18432
s_waitcnt lgkmcnt(0)
v_mfma_f32_16x16x32_bf16 v[52:55], a[64:67], v[20:23], v[52:55]
v_mfma_f32_16x16x32_bf16 v[56:59], a[68:71], v[20:23], v[56:59]
v_mfma_f32_16x16x32_bf16 v[60:63], a[64:67], v[24:27], v[60:63]
v_mfma_f32_16x16x32_bf16 v[64:67], a[68:71], v[24:27], v[64:67]
v_mfma_f32_16x16x32_bf16 v[52:55], a[72:75], v[28:31], v[52:55]
v_mfma_f32_16x16x32_bf16 v[56:59], a[76:79], v[28:31], v[56:59]
v_mfma_f32_16x16x32_bf16 v[60:63], a[72:75], v[32:35], v[60:63]
v_mfma_f32_16x16x32_bf16 v[64:67], a[76:79], v[32:35], v[64:67]
v_mfma_f32_16x16x32_bf16 v[68:71], a[64:67], v[36:39], v[68:71]
v_mfma_f32_16x16x32_bf16 v[72:75], a[68:71], v[36:39], v[72:75]
v_mfma_f32_16x16x32_bf16 v[76:79], a[64:67], v[40:43], v[76:79]
v_mfma_f32_16x16x32_bf16 v[80:83], a[68:71], v[40:43], v[80:83]
v_mfma_f32_16x16x32_bf16 v[68:71], a[72:75], v[44:47], v[68:71]
v_mfma_f32_16x16x32_bf16 v[72:75], a[76:79], v[44:47], v[72:75]
v_mfma_f32_16x16x32_bf16 v[76:79], a[72:75], v[48:51], v[76:79]
v_mfma_f32_16x16x32_bf16 v[80:83], a[76:79], v[48:51], v[80:83]
s_waitcnt vmcnt(5)
ds_read_b64_tr_b16 a[80:81], v17 offset:4096
ds_read_b64_tr_b16 a[82:83], v17 offset:4352
ds_read_b64_tr_b16 a[84:85], v17 offset:4104
ds_read_b64_tr_b16 a[86:87], v17 offset:4360
ds_read_b64_tr_b16 a[88:89], v17 offset:6144
ds_read_b64_tr_b16 a[90:91], v17 offset:6400
ds_read_b64_tr_b16 a[92:93], v17 offset:6152
ds_read_b64_tr_b16 a[94:95], v17 offset:6408
s_waitcnt lgkmcnt(0)
s_add_u32 m0, s45, 4096
s_mov_b32 s44, 3670016
buffer_load_dwordx4 v16, s[4:7], s44 offen lds
s_add_u32 m0, s45, 5120
s_mov_b32 s44, 3801088
buffer_load_dwordx4 v16, s[4:7], s44 offen lds
s_add_u32 m0, s45, 6144
s_mov_b32 s44, 3932160
buffer_load_dwordx4 v16, s[4:7], s44 offen lds
s_add_u32 m0, s45, 7168
s_mov_b32 s44, 4063232
buffer_load_dwordx4 v16, s[4:7], s44 offen lds
ds_read_b128 v[20:23], v8 offset:20480
ds_read_b128 v[24:27], v8 offset:22528
ds_read_b128 v[28:31], v9 offset:20480
ds_read_b128 v[32:35], v9 offset:22528
ds_read_b128 v[36:39], v10 offset:20480
ds_read_b128 v[40:43], v10 offset:22528
ds_read_b128 v[44:47], v11 offset:20480
ds_read_b128 v[48:51], v11 offset:22528
s_waitcnt lgkmcnt(0)
v_mfma_f32_16x16x32_bf16 v[52:55], a[80:83], v[20:23], v[52:55]
v_mfma_f32_16x16x32_bf16 v[56:59], a[84:87], v[20:23], v[56:59]
v_mfma_f32_16x16x32_bf16 v[60:63], a[80:83], v[24:27], v[60:63]
v_mfma_f32_16x16x32_bf16 v[64:67], a[84:87], v[24:27], v[64:67]
v_mfma_f32_16x16x32_bf16 v[52:55], a[88:91], v[28:31], v[52:55]
v_mfma_f32_16x16x32_bf16 v[56:59], a[92:95], v[28:31], v[56:59]
v_mfma_f32_16x16x32_bf16 v[60:63], a[88:91], v[32:35], v[60:63]
v_mfma_f32_16x16x32_bf16 v[64:67], a[92:95], v[32:35], v[64:67]
v_mfma_f32_16x16x32_bf16 v[68:71], a[80:83], v[36:39], v[68:71]
v_mfma_f32_16x16x32_bf16 v[72:75], a[84:87], v[36:39], v[72:75]
v_mfma_f32_16x16x32_bf16 v[76:79], a[80:83], v[40:43], v[76:79]
v_mfma_f32_16x16x32_bf16 v[80:83], a[84:87], v[40:43], v[80:83]
v_mfma_f32_16x16x32_bf16 v[68:71], a[88:91], v[44:47], v[68:71]
v_mfma_f32_16x16x32_bf16 v[72:75], a[92:95], v[44:47], v[72:75]
v_mfma_f32_16x16x32_bf16 v[76:79], a[88:91], v[48:51], v[76:79]
v_mfma_f32_16x16x32_bf16 v[80:83], a[92:95], v[48:51], v[80:83]
s_waitcnt vmcnt(4)
ds_read_b64_tr_b16 a[96:97], v17 offset:0
ds_read_b64_tr_b16 a[98:99], v17 offset:256
ds_read_b64_tr_b16 a[100:101], v17 offset:8
ds_read_b64_tr_b16 a[102:103], v17 offset:264
ds_read_b64_tr_b16 a[104:105], v17 offset:2048
ds_read_b64_tr_b16 a[106:107], v17 offset:2304
ds_read_b64_tr_b16 a[108:109], v17 offset:2056
ds_read_b64_tr_b16 a[110:111], v17 offset:2312
s_waitcnt lgkmcnt(0)
s_mov_b32 s44, 4194304
buffer_load_dword v250, v12, s[4:7], s44 offen
s_add_u32 m0, s45, 0
s_mov_b32 s44, 4194304
buffer_load_dwordx4 v16, s[4:7], s44 offen lds
s_add_u32 m0, s45, 1024
s_mov_b32 s44, 4325376
buffer_load_dwordx4 v16, s[4:7], s44 offen lds
s_add_u32 m0, s45, 2048
s_mov_b32 s44, 4456448
buffer_load_dwordx4 v16, s[4:7], s44 offen lds
s_add_u32 m0, s45, 3072
s_mov_b32 s44, 4587520
buffer_load_dwordx4 v16, s[4:7], s44 offen lds
ds_read_b128 v[20:23], v8 offset:24576
ds_read_b128 v[24:27], v8 offset:26624
ds_read_b128 v[28:31], v9 offset:24576
ds_read_b128 v[32:35], v9 offset:26624
ds_read_b128 v[36:39], v10 offset:24576
ds_read_b128 v[40:43], v10 offset:26624
ds_read_b128 v[44:47], v11 offset:24576
ds_read_b128 v[48:51], v11 offset:26624
s_waitcnt lgkmcnt(0)
v_mfma_f32_16x16x32_bf16 v[52:55], a[96:99], v[20:23], v[52:55]
v_mfma_f32_16x16x32_bf16 v[56:59], a[100:103], v[20:23], v[56:59]
v_mfma_f32_16x16x32_bf16 v[60:63], a[96:99], v[24:27], v[60:63]
v_mfma_f32_16x16x32_bf16 v[64:67], a[100:103], v[24:27], v[64:67]
v_mfma_f32_16x16x32_bf16 v[52:55], a[104:107], v[28:31], v[52:55]
v_mfma_f32_16x16x32_bf16 v[56:59], a[108:111], v[28:31], v[56:59]
v_mfma_f32_16x16x32_bf16 v[60:63], a[104:107], v[32:35], v[60:63]
v_mfma_f32_16x16x32_bf16 v[64:67], a[108:111], v[32:35], v[64:67]
v_mfma_f32_16x16x32_bf16 v[68:71], a[96:99], v[36:39], v[68:71]
v_mfma_f32_16x16x32_bf16 v[72:75], a[100:103], v[36:39], v[72:75]
v_mfma_f32_16x16x32_bf16 v[76:79], a[96:99], v[40:43], v[76:79]
v_mfma_f32_16x16x32_bf16 v[80:83], a[100:103], v[40:43], v[80:83]
v_mfma_f32_16x16x32_bf16 v[68:71], a[104:107], v[44:47], v[68:71]
v_mfma_f32_16x16x32_bf16 v[72:75], a[108:111], v[44:47], v[72:75]
v_mfma_f32_16x16x32_bf16 v[76:79], a[104:107], v[48:51], v[76:79]
v_mfma_f32_16x16x32_bf16 v[80:83], a[108:111], v[48:51], v[80:83]
s_waitcnt vmcnt(5)
ds_read_b64_tr_b16 a[112:113], v17 offset:4096
ds_read_b64_tr_b16 a[114:115], v17 offset:4352
ds_read_b64_tr_b16 a[116:117], v17 offset:4104
ds_read_b64_tr_b16 a[118:119], v17 offset:4360
ds_read_b64_tr_b16 a[120:121], v17 offset:6144
ds_read_b64_tr_b16 a[122:123], v17 offset:6400
ds_read_b64_tr_b16 a[124:125], v17 offset:6152
ds_read_b64_tr_b16 a[126:127], v17 offset:6408
s_waitcnt lgkmcnt(0)
s_add_u32 m0, s45, 4096
s_mov_b32 s44, 4718592
buffer_load_dwordx4 v16, s[4:7], s44 offen lds
s_add_u32 m0, s45, 5120
s_mov_b32 s44, 4849664
buffer_load_dwordx4 v16, s[4:7], s44 offen lds
s_add_u32 m0, s45, 6144
s_mov_b32 s44, 4980736
buffer_load_dwordx4 v16, s[4:7], s44 offen lds
s_add_u32 m0, s45, 7168
s_mov_b32 s44, 5111808
buffer_load_dwordx4 v16, s[4:7], s44 offen lds
ds_read_b128 v[20:23], v8 offset:28672
ds_read_b128 v[24:27], v8 offset:30720
ds_read_b128 v[28:31], v9 offset:28672
ds_read_b128 v[32:35], v9 offset:30720
ds_read_b128 v[36:39], v10 offset:28672
ds_read_b128 v[40:43], v10 offset:30720
ds_read_b128 v[44:47], v11 offset:28672
ds_read_b128 v[48:51], v11 offset:30720
s_waitcnt lgkmcnt(0)
v_mfma_f32_16x16x32_bf16 v[52:55], a[112:115], v[20:23], v[52:55]
v_mfma_f32_16x16x32_bf16 v[56:59], a[116:119], v[20:23], v[56:59]
v_mfma_f32_16x16x32_bf16 v[60:63], a[112:115], v[24:27], v[60:63]
v_mfma_f32_16x16x32_bf16 v[64:67], a[116:119], v[24:27], v[64:67]
v_mfma_f32_16x16x32_bf16 v[52:55], a[120:123], v[28:31], v[52:55]
v_mfma_f32_16x16x32_bf16 v[56:59], a[124:127], v[28:31], v[56:59]
v_mfma_f32_16x16x32_bf16 v[60:63], a[120:123], v[32:35], v[60:63]
v_mfma_f32_16x16x32_bf16 v[64:67], a[124:127], v[32:35], v[64:67]
v_mfma_f32_16x16x32_bf16 v[68:71], a[112:115], v[36:39], v[68:71]
v_mfma_f32_16x16x32_bf16 v[72:75], a[116:119], v[36:39], v[72:75]
v_mfma_f32_16x16x32_bf16 v[76:79], a[112:115], v[40:43], v[76:79]
v_mfma_f32_16x16x32_bf16 v[80:83], a[116:119], v[40:43], v[80:83]
v_mfma_f32_16x16x32_bf16 v[68:71], a[120:123], v[44:47], v[68:71]
v_mfma_f32_16x16x32_bf16 v[72:75], a[124:127], v[44:47], v[72:75]
v_mfma_f32_16x16x32_bf16 v[76:79], a[120:123], v[48:51], v[76:79]
v_mfma_f32_16x16x32_bf16 v[80:83], a[124:127], v[48:51], v[80:83]
s_waitcnt vmcnt(4)
ds_read_b64_tr_b16 a[128:129], v17 offset:0
ds_read_b64_tr_b16 a[130:131], v17 offset:256
ds_read_b64_tr_b16 a[132:133], v17 offset:8
ds_read_b64_tr_b16 a[134:135], v17 offset:264
ds_read_b64_tr_b16 a[136:137], v17 offset:2048
ds_read_b64_tr_b16 a[138:139], v17 offset:2304
ds_read_b64_tr_b16 a[140:141], v17 offset:2056
ds_read_b64_tr_b16 a[142:143], v17 offset:2312
s_waitcnt lgkmcnt(0)
s_mov_b32 s44, 5242880
buffer_load_dword v250, v12, s[4:7], s44 offen
s_add_u32 m0, s45, 0
s_mov_b32 s44, 5242880
buffer_load_dwordx4 v16, s[4:7], s44 offen lds
s_add_u32 m0, s45, 1024
s_mov_b32 s44, 5373952
buffer_load_dwordx4 v16, s[4:7], s44 offen lds
s_add_u32 m0, s45, 2048
s_mov_b32 s44, 5505024
buffer_load_dwordx4 v16, s[4:7], s44 offen lds
s_add_u32 m0, s45, 3072
s_mov_b32 s44, 5636096
buffer_load_dwordx4 v16, s[4:7], s44 offen lds
ds_read_b128 v[20:23], v8 offset:32768
ds_read_b128 v[24:27], v8 offset:34816
ds_read_b128 v[28:31], v9 offset:32768
ds_read_b128 v[32:35], v9 offset:34816
ds_read_b128 v[36:39], v10 offset:32768
ds_read_b128 v[40:43], v10 offset:34816
ds_read_b128 v[44:47], v11 offset:32768
ds_read_b128 v[48:51], v11 offset:34816
s_waitcnt lgkmcnt(0)
v_mfma_f32_16x16x32_bf16 v[52:55], a[128:131], v[20:23], v[52:55]
v_mfma_f32_16x16x32_bf16 v[56:59], a[132:135], v[20:23], v[56:59]
v_mfma_f32_16x16x32_bf16 v[60:63], a[128:131], v[24:27], v[60:63]
v_mfma_f32_16x16x32_bf16 v[64:67], a[132:135], v[24:27], v[64:67]
v_mfma_f32_16x16x32_bf16 v[52:55], a[136:139], v[28:31], v[52:55]
v_mfma_f32_16x16x32_bf16 v[56:59], a[140:143], v[28:31], v[56:59]
v_mfma_f32_16x16x32_bf16 v[60:63], a[136:139], v[32:35], v[60:63]
v_mfma_f32_16x16x32_bf16 v[64:67], a[140:143], v[32:35], v[64:67]
v_mfma_f32_16x16x32_bf16 v[68:71], a[128:131], v[36:39], v[68:71]
v_mfma_f32_16x16x32_bf16 v[72:75], a[132:135], v[36:39], v[72:75]
v_mfma_f32_16x16x32_bf16 v[76:79], a[128:131], v[40:43], v[76:79]
v_mfma_f32_16x16x32_bf16 v[80:83], a[132:135], v[40:43], v[80:83]
v_mfma_f32_16x16x32_bf16 v[68:71], a[136:139], v[44:47], v[68:71]
v_mfma_f32_16x16x32_bf16 v[72:75], a[140:143], v[44:47], v[72:75]
v_mfma_f32_16x16x32_bf16 v[76:79], a[136:139], v[48:51], v[76:79]
v_mfma_f32_16x16x32_bf16 v[80:83], a[140:143], v[48:51], v[80:83]
s_waitcnt vmcnt(5)
ds_read_b64_tr_b16 a[144:145], v17 offset:4096
ds_read_b64_tr_b16 a[146:147], v17 offset:4352
ds_read_b64_tr_b16 a[148:149], v17 offset:4104
ds_read_b64_tr_b16 a[150:151], v17 offset:4360
ds_read_b64_tr_b16 a[152:153], v17 offset:6144
ds_read_b64_tr_b16 a[154:155], v17 offset:6400
ds_read_b64_tr_b16 a[156:157], v17 offset:6152
ds_read_b64_tr_b16 a[158:159], v17 offset:6408
s_waitcnt lgkmcnt(0)
s_add_u32 m0, s45, 4096
s_mov_b32 s44, 5767168
buffer_load_dwordx4 v16, s[4:7], s44 offen lds
s_add_u32 m0, s45, 5120
s_mov_b32 s44, 5898240
buffer_load_dwordx4 v16, s[4:7], s44 offen lds
s_add_u32 m0, s45, 6144
s_mov_b32 s44, 6029312
buffer_load_dwordx4 v16, s[4:7], s44 offen lds
s_add_u32 m0, s45, 7168
s_mov_b32 s44, 6160384
buffer_load_dwordx4 v16, s[4:7], s44 offen lds
ds_read_b128 v[20:23], v8 offset:36864
ds_read_b128 v[24:27], v8 offset:38912
ds_read_b128 v[28:31], v9 offset:36864
ds_read_b128 v[32:35], v9 offset:38912
ds_read_b128 v[36:39], v10 offset:36864
ds_read_b128 v[40:43], v10 offset:38912
ds_read_b128 v[44:47], v11 offset:36864
ds_read_b128 v[48:51], v11 offset:38912
s_waitcnt lgkmcnt(0)
v_mfma_f32_16x16x32_bf16 v[52:55], a[144:147], v[20:23], v[52:55]
v_mfma_f32_16x16x32_bf16 v[56:59], a[148:151], v[20:23], v[56:59]
v_mfma_f32_16x16x32_bf16 v[60:63], a[144:147], v[24:27], v[60:63]
v_mfma_f32_16x16x32_bf16 v[64:67], a[148:151], v[24:27], v[64:67]
v_mfma_f32_16x16x32_bf16 v[52:55], a[152:155], v[28:31], v[52:55]
v_mfma_f32_16x16x32_bf16 v[56:59], a[156:159], v[28:31], v[56:59]
v_mfma_f32_16x16x32_bf16 v[60:63], a[152:155], v[32:35], v[60:63]
v_mfma_f32_16x16x32_bf16 v[64:67], a[156:159], v[32:35], v[64:67]
v_mfma_f32_16x16x32_bf16 v[68:71], a[144:147], v[36:39], v[68:71]
v_mfma_f32_16x16x32_bf16 v[72:75], a[148:151], v[36:39], v[72:75]
v_mfma_f32_16x16x32_bf16 v[76:79], a[144:147], v[40:43], v[76:79]
v_mfma_f32_16x16x32_bf16 v[80:83], a[148:151], v[40:43], v[80:83]
v_mfma_f32_16x16x32_bf16 v[68:71], a[152:155], v[44:47], v[68:71]
v_mfma_f32_16x16x32_bf16 v[72:75], a[156:159], v[44:47], v[72:75]
v_mfma_f32_16x16x32_bf16 v[76:79], a[152:155], v[48:51], v[76:79]
v_mfma_f32_16x16x32_bf16 v[80:83], a[156:159], v[48:51], v[80:83]
s_waitcnt vmcnt(4)
ds_read_b64_tr_b16 a[160:161], v17 offset:0
ds_read_b64_tr_b16 a[162:163], v17 offset:256
ds_read_b64_tr_b16 a[164:165], v17 offset:8
ds_read_b64_tr_b16 a[166:167], v17 offset:264
ds_read_b64_tr_b16 a[168:169], v17 offset:2048
ds_read_b64_tr_b16 a[170:171], v17 offset:2304
ds_read_b64_tr_b16 a[172:173], v17 offset:2056
ds_read_b64_tr_b16 a[174:175], v17 offset:2312
s_waitcnt lgkmcnt(0)
s_mov_b32 s44, 6291456
buffer_load_dword v250, v12, s[4:7], s44 offen
s_add_u32 m0, s45, 0
s_mov_b32 s44, 6291456
buffer_load_dwordx4 v16, s[4:7], s44 offen lds
s_add_u32 m0, s45, 1024
s_mov_b32 s44, 6422528
buffer_load_dwordx4 v16, s[4:7], s44 offen lds
s_add_u32 m0, s45, 2048
s_mov_b32 s44, 6553600
buffer_load_dwordx4 v16, s[4:7], s44 offen lds
s_add_u32 m0, s45, 3072
s_mov_b32 s44, 6684672
buffer_load_dwordx4 v16, s[4:7], s44 offen lds
ds_read_b128 v[20:23], v8 offset:40960
ds_read_b128 v[24:27], v8 offset:43008
ds_read_b128 v[28:31], v9 offset:40960
ds_read_b128 v[32:35], v9 offset:43008
ds_read_b128 v[36:39], v10 offset:40960
ds_read_b128 v[40:43], v10 offset:43008
ds_read_b128 v[44:47], v11 offset:40960
ds_read_b128 v[48:51], v11 offset:43008
s_waitcnt lgkmcnt(0)
v_mfma_f32_16x16x32_bf16 v[52:55], a[160:163], v[20:23], v[52:55]
v_mfma_f32_16x16x32_bf16 v[56:59], a[164:167], v[20:23], v[56:59]
v_mfma_f32_16x16x32_bf16 v[60:63], a[160:163], v[24:27], v[60:63]
v_mfma_f32_16x16x32_bf16 v[64:67], a[164:167], v[24:27], v[64:67]
v_mfma_f32_16x16x32_bf16 v[52:55], a[168:171], v[28:31], v[52:55]
v_mfma_f32_16x16x32_bf16 v[56:59], a[172:175], v[28:31], v[56:59]
v_mfma_f32_16x16x32_bf16 v[60:63], a[168:171], v[32:35], v[60:63]
v_mfma_f32_16x16x32_bf16 v[64:67], a[172:175], v[32:35], v[64:67]
v_mfma_f32_16x16x32_bf16 v[68:71], a[160:163], v[36:39], v[68:71]
v_mfma_f32_16x16x32_bf16 v[72:75], a[164:167], v[36:39], v[72:75]
v_mfma_f32_16x16x32_bf16 v[76:79], a[160:163], v[40:43], v[76:79]
v_mfma_f32_16x16x32_bf16 v[80:83], a[164:167], v[40:43], v[80:83]
v_mfma_f32_16x16x32_bf16 v[68:71], a[168:171], v[44:47], v[68:71]
v_mfma_f32_16x16x32_bf16 v[72:75], a[172:175], v[44:47], v[72:75]
v_mfma_f32_16x16x32_bf16 v[76:79], a[168:171], v[48:51], v[76:79]
v_mfma_f32_16x16x32_bf16 v[80:83], a[172:175], v[48:51], v[80:83]
s_waitcnt vmcnt(5)
ds_read_b64_tr_b16 a[176:177], v17 offset:4096
ds_read_b64_tr_b16 a[178:179], v17 offset:4352
ds_read_b64_tr_b16 a[180:181], v17 offset:4104
ds_read_b64_tr_b16 a[182:183], v17 offset:4360
ds_read_b64_tr_b16 a[184:185], v17 offset:6144
ds_read_b64_tr_b16 a[186:187], v17 offset:6400
ds_read_b64_tr_b16 a[188:189], v17 offset:6152
ds_read_b64_tr_b16 a[190:191], v17 offset:6408
s_waitcnt lgkmcnt(0)
s_add_u32 m0, s45, 4096
s_mov_b32 s44, 6815744
buffer_load_dwordx4 v16, s[4:7], s44 offen lds
s_add_u32 m0, s45, 5120
s_mov_b32 s44, 6946816
buffer_load_dwordx4 v16, s[4:7], s44 offen lds
s_add_u32 m0, s45, 6144
s_mov_b32 s44, 7077888
buffer_load_dwordx4 v16, s[4:7], s44 offen lds
s_add_u32 m0, s45, 7168
s_mov_b32 s44, 7208960
buffer_load_dwordx4 v16, s[4:7], s44 offen lds
ds_read_b128 v[20:23], v8 offset:45056
ds_read_b128 v[24:27], v8 offset:47104
ds_read_b128 v[28:31], v9 offset:45056
ds_read_b128 v[32:35], v9 offset:47104
ds_read_b128 v[36:39], v10 offset:45056
ds_read_b128 v[40:43], v10 offset:47104
ds_read_b128 v[44:47], v11 offset:45056
ds_read_b128 v[48:51], v11 offset:47104
s_waitcnt lgkmcnt(0)
v_mfma_f32_16x16x32_bf16 v[52:55], a[176:179], v[20:23], v[52:55]
v_mfma_f32_16x16x32_bf16 v[56:59], a[180:183], v[20:23], v[56:59]
v_mfma_f32_16x16x32_bf16 v[60:63], a[176:179], v[24:27], v[60:63]
v_mfma_f32_16x16x32_bf16 v[64:67], a[180:183], v[24:27], v[64:67]
v_mfma_f32_16x16x32_bf16 v[52:55], a[184:187], v[28:31], v[52:55]
v_mfma_f32_16x16x32_bf16 v[56:59], a[188:191], v[28:31], v[56:59]
v_mfma_f32_16x16x32_bf16 v[60:63], a[184:187], v[32:35], v[60:63]
v_mfma_f32_16x16x32_bf16 v[64:67], a[188:191], v[32:35], v[64:67]
v_mfma_f32_16x16x32_bf16 v[68:71], a[176:179], v[36:39], v[68:71]
v_mfma_f32_16x16x32_bf16 v[72:75], a[180:183], v[36:39], v[72:75]
v_mfma_f32_16x16x32_bf16 v[76:79], a[176:179], v[40:43], v[76:79]
v_mfma_f32_16x16x32_bf16 v[80:83], a[180:183], v[40:43], v[80:83]
v_mfma_f32_16x16x32_bf16 v[68:71], a[184:187], v[44:47], v[68:71]
v_mfma_f32_16x16x32_bf16 v[72:75], a[188:191], v[44:47], v[72:75]
v_mfma_f32_16x16x32_bf16 v[76:79], a[184:187], v[48:51], v[76:79]
v_mfma_f32_16x16x32_bf16 v[80:83], a[188:191], v[48:51], v[80:83]
s_waitcnt vmcnt(4)
ds_read_b64_tr_b16 a[192:193], v17 offset:0
ds_read_b64_tr_b16 a[194:195], v17 offset:256
ds_read_b64_tr_b16 a[196:197], v17 offset:8
ds_read_b64_tr_b16 a[198:199], v17 offset:264
ds_read_b64_tr_b16 a[200:201], v17 offset:2048
ds_read_b64_tr_b16 a[202:203], v17 offset:2304
ds_read_b64_tr_b16 a[204:205], v17 offset:2056
ds_read_b64_tr_b16 a[206:207], v17 offset:2312
s_waitcnt lgkmcnt(0)
s_mov_b32 s44, 7340032
buffer_load_dword v250, v12, s[4:7], s44 offen
s_add_u32 m0, s45, 0
s_mov_b32 s44, 7340032
buffer_load_dwordx4 v16, s[4:7], s44 offen lds
s_add_u32 m0, s45, 1024
s_mov_b32 s44, 7471104
buffer_load_dwordx4 v16, s[4:7], s44 offen lds
s_add_u32 m0, s45, 2048
s_mov_b32 s44, 7602176
buffer_load_dwordx4 v16, s[4:7], s44 offen lds
s_add_u32 m0, s45, 3072
s_mov_b32 s44, 7733248
buffer_load_dwordx4 v16, s[4:7], s44 offen lds
ds_read_b128 v[20:23], v8 offset:49152
ds_read_b128 v[24:27], v8 offset:51200
ds_read_b128 v[28:31], v9 offset:49152
ds_read_b128 v[32:35], v9 offset:51200
ds_read_b128 v[36:39], v10 offset:49152
ds_read_b128 v[40:43], v10 offset:51200
ds_read_b128 v[44:47], v11 offset:49152
ds_read_b128 v[48:51], v11 offset:51200
s_waitcnt lgkmcnt(0)
v_mfma_f32_16x16x32_bf16 v[52:55], a[192:195], v[20:23], v[52:55]
v_mfma_f32_16x16x32_bf16 v[56:59], a[196:199], v[20:23], v[56:59]
v_mfma_f32_16x16x32_bf16 v[60:63], a[192:195], v[24:27], v[60:63]
v_mfma_f32_16x16x32_bf16 v[64:67], a[196:199], v[24:27], v[64:67]
v_mfma_f32_16x16x32_bf16 v[52:55], a[200:203], v[28:31], v[52:55]
v_mfma_f32_16x16x32_bf16 v[56:59], a[204:207], v[28:31], v[56:59]
v_mfma_f32_16x16x32_bf16 v[60:63], a[200:203], v[32:35], v[60:63]
v_mfma_f32_16x16x32_bf16 v[64:67], a[204:207], v[32:35], v[64:67]
v_mfma_f32_16x16x32_bf16 v[68:71], a[192:195], v[36:39], v[68:71]
v_mfma_f32_16x16x32_bf16 v[72:75], a[196:199], v[36:39], v[72:75]
v_mfma_f32_16x16x32_bf16 v[76:79], a[192:195], v[40:43], v[76:79]
v_mfma_f32_16x16x32_bf16 v[80:83], a[196:199], v[40:43], v[80:83]
v_mfma_f32_16x16x32_bf16 v[68:71], a[200:203], v[44:47], v[68:71]
v_mfma_f32_16x16x32_bf16 v[72:75], a[204:207], v[44:47], v[72:75]
v_mfma_f32_16x16x32_bf16 v[76:79], a[200:203], v[48:51], v[76:79]
v_mfma_f32_16x16x32_bf16 v[80:83], a[204:207], v[48:51], v[80:83]
s_waitcnt vmcnt(5)
ds_read_b64_tr_b16 a[208:209], v17 offset:4096
ds_read_b64_tr_b16 a[210:211], v17 offset:4352
ds_read_b64_tr_b16 a[212:213], v17 offset:4104
ds_read_b64_tr_b16 a[214:215], v17 offset:4360
ds_read_b64_tr_b16 a[216:217], v17 offset:6144
ds_read_b64_tr_b16 a[218:219], v17 offset:6400
ds_read_b64_tr_b16 a[220:221], v17 offset:6152
ds_read_b64_tr_b16 a[222:223], v17 offset:6408
s_waitcnt lgkmcnt(0)
v_and_b32 v247, 15, v0
v_lshlrev_b32 v247, 4, v247
buffer_load_dword v246, v247, s[72:75], 0 offen sc1
s_add_u32 m0, s45, 4096
s_mov_b32 s44, 7864320
buffer_load_dwordx4 v16, s[4:7], s44 offen lds
s_add_u32 m0, s45, 5120
s_mov_b32 s44, 7995392
buffer_load_dwordx4 v16, s[4:7], s44 offen lds
s_add_u32 m0, s45, 6144
s_mov_b32 s44, 8126464
buffer_load_dwordx4 v16, s[4:7], s44 offen lds
s_add_u32 m0, s45, 7168
s_mov_b32 s44, 8257536
buffer_load_dwordx4 v16, s[4:7], s44 offen lds
ds_read_b128 v[20:23], v8 offset:53248
ds_read_b128 v[24:27], v8 offset:55296
ds_read_b128 v[28:31], v9 offset:53248
ds_read_b128 v[32:35], v9 offset:55296
ds_read_b128 v[36:39], v10 offset:53248
ds_read_b128 v[40:43], v10 offset:55296
ds_read_b128 v[44:47], v11 offset:53248
ds_read_b128 v[48:51], v11 offset:55296
s_waitcnt lgkmcnt(0)
v_mfma_f32_16x16x32_bf16 v[52:55], a[208:211], v[20:23], v[52:55]
v_mfma_f32_16x16x32_bf16 v[56:59], a[212:215], v[20:23], v[56:59]
v_mfma_f32_16x16x32_bf16 v[60:63], a[208:211], v[24:27], v[60:63]
v_mfma_f32_16x16x32_bf16 v[64:67], a[212:215], v[24:27], v[64:67]
v_mfma_f32_16x16x32_bf16 v[52:55], a[216:219], v[28:31], v[52:55]
v_mfma_f32_16x16x32_bf16 v[56:59], a[220:223], v[28:31], v[56:59]
v_mfma_f32_16x16x32_bf16 v[60:63], a[216:219], v[32:35], v[60:63]
v_mfma_f32_16x16x32_bf16 v[64:67], a[220:223], v[32:35], v[64:67]
v_mfma_f32_16x16x32_bf16 v[68:71], a[208:211], v[36:39], v[68:71]
v_mfma_f32_16x16x32_bf16 v[72:75], a[212:215], v[36:39], v[72:75]
v_mfma_f32_16x16x32_bf16 v[76:79], a[208:211], v[40:43], v[76:79]
v_mfma_f32_16x16x32_bf16 v[80:83], a[212:215], v[40:43], v[80:83]
v_mfma_f32_16x16x32_bf16 v[68:71], a[216:219], v[44:47], v[68:71]
v_mfma_f32_16x16x32_bf16 v[72:75], a[220:223], v[44:47], v[72:75]
v_mfma_f32_16x16x32_bf16 v[76:79], a[216:219], v[48:51], v[76:79]
v_mfma_f32_16x16x32_bf16 v[80:83], a[220:223], v[48:51], v[80:83]
s_waitcnt vmcnt(4)
ds_read_b64_tr_b16 a[224:225], v17 offset:0
ds_read_b64_tr_b16 a[226:227], v17 offset:256
ds_read_b64_tr_b16 a[228:229], v17 offset:8
ds_read_b64_tr_b16 a[230:231], v17 offset:264
ds_read_b64_tr_b16 a[232:233], v17 offset:2048
ds_read_b64_tr_b16 a[234:235], v17 offset:2304
ds_read_b64_tr_b16 a[236:237], v17 offset:2056
ds_read_b64_tr_b16 a[238:239], v17 offset:2312
s_waitcnt lgkmcnt(0)
ds_read_b128 v[20:23], v8 offset:57344
ds_read_b128 v[24:27], v8 offset:59392
ds_read_b128 v[28:31], v9 offset:57344
ds_read_b128 v[32:35], v9 offset:59392
ds_read_b128 v[36:39], v10 offset:57344
ds_read_b128 v[40:43], v10 offset:59392
ds_read_b128 v[44:47], v11 offset:57344
ds_read_b128 v[48:51], v11 offset:59392
s_waitcnt lgkmcnt(0)
v_mfma_f32_16x16x32_bf16 v[52:55], a[224:227], v[20:23], v[52:55]
v_mfma_f32_16x16x32_bf16 v[56:59], a[228:231], v[20:23], v[56:59]
v_mfma_f32_16x16x32_bf16 v[60:63], a[224:227], v[24:27], v[60:63]
v_mfma_f32_16x16x32_bf16 v[64:67], a[228:231], v[24:27], v[64:67]
v_mfma_f32_16x16x32_bf16 v[52:55], a[232:235], v[28:31], v[52:55]
v_mfma_f32_16x16x32_bf16 v[56:59], a[236:239], v[28:31], v[56:59]
v_mfma_f32_16x16x32_bf16 v[60:63], a[232:235], v[32:35], v[60:63]
v_mfma_f32_16x16x32_bf16 v[64:67], a[236:239], v[32:35], v[64:67]
v_mfma_f32_16x16x32_bf16 v[68:71], a[224:227], v[36:39], v[68:71]
v_mfma_f32_16x16x32_bf16 v[72:75], a[228:231], v[36:39], v[72:75]
v_mfma_f32_16x16x32_bf16 v[76:79], a[224:227], v[40:43], v[76:79]
v_mfma_f32_16x16x32_bf16 v[80:83], a[228:231], v[40:43], v[80:83]
v_mfma_f32_16x16x32_bf16 v[68:71], a[232:235], v[44:47], v[68:71]
v_mfma_f32_16x16x32_bf16 v[72:75], a[236:239], v[44:47], v[72:75]
v_mfma_f32_16x16x32_bf16 v[76:79], a[232:235], v[48:51], v[76:79]
v_mfma_f32_16x16x32_bf16 v[80:83], a[236:239], v[48:51], v[80:83]
s_waitcnt vmcnt(0)
ds_read_b64_tr_b16 a[240:241], v17 offset:4096
ds_read_b64_tr_b16 a[242:243], v17 offset:4352
ds_read_b64_tr_b16 a[244:245], v17 offset:4104
ds_read_b64_tr_b16 a[246:247], v17 offset:4360
ds_read_b64_tr_b16 a[248:249], v17 offset:6144
ds_read_b64_tr_b16 a[250:251], v17 offset:6400
ds_read_b64_tr_b16 a[252:253], v17 offset:6152
ds_read_b64_tr_b16 a[254:255], v17 offset:6408
s_waitcnt lgkmcnt(0)
ds_read_b128 v[20:23], v8 offset:61440
ds_read_b128 v[24:27], v8 offset:63488
ds_read_b128 v[28:31], v9 offset:61440
ds_read_b128 v[32:35], v9 offset:63488
ds_read_b128 v[36:39], v10 offset:61440
ds_read_b128 v[40:43], v10 offset:63488
ds_read_b128 v[44:47], v11 offset:61440
ds_read_b128 v[48:51], v11 offset:63488
s_waitcnt lgkmcnt(0)
v_mfma_f32_16x16x32_bf16 v[52:55], a[240:243], v[20:23], v[52:55]
v_mfma_f32_16x16x32_bf16 v[56:59], a[244:247], v[20:23], v[56:59]
v_mfma_f32_16x16x32_bf16 v[60:63], a[240:243], v[24:27], v[60:63]
v_mfma_f32_16x16x32_bf16 v[64:67], a[244:247], v[24:27], v[64:67]
v_mfma_f32_16x16x32_bf16 v[52:55], a[248:251], v[28:31], v[52:55]
v_mfma_f32_16x16x32_bf16 v[56:59], a[252:255], v[28:31], v[56:59]
v_mfma_f32_16x16x32_bf16 v[60:63], a[248:251], v[32:35], v[60:63]
v_mfma_f32_16x16x32_bf16 v[64:67], a[252:255], v[32:35], v[64:67]
v_mfma_f32_16x16x32_bf16 v[68:71], a[240:243], v[36:39], v[68:71]
v_mfma_f32_16x16x32_bf16 v[72:75], a[244:247], v[36:39], v[72:75]
v_mfma_f32_16x16x32_bf16 v[76:79], a[240:243], v[40:43], v[76:79]
v_mfma_f32_16x16x32_bf16 v[80:83], a[244:247], v[40:43], v[80:83]
v_mfma_f32_16x16x32_bf16 v[68:71], a[248:251], v[44:47], v[68:71]
v_mfma_f32_16x16x32_bf16 v[72:75], a[252:255], v[44:47], v[72:75]
v_mfma_f32_16x16x32_bf16 v[76:79], a[248:251], v[48:51], v[76:79]
v_mfma_f32_16x16x32_bf16 v[80:83], a[252:255], v[48:51], v[80:83]
s_and_b32 s53, s47, 31
s_lshl_b32 s53, s53, 4
v_add_u32 v19, s53, v1
v_lshlrev_b32 v19, 7, v19
s_mov_b32 s42, 1
v_and_b32 v247, 15, v0
v_lshlrev_b32 v247, 4, v247
s_branch mega_kernel_sykp
mega_kernel_sykw:
s_sleep 4
mega_kernel_syk:
buffer_load_dword v246, v247, s[72:75], 0 offen sc1
s_waitcnt vmcnt(0)
mega_kernel_sykp:
s_cmp_eq_u32 s95, 1
s_cbranch_scc0 mega_kernel_sykf
v_readlane_b32 s76, v246, 14
s_mov_b32 s98, 0
s_cmp_eq_u32 s76, 32
s_cbranch_scc0 mega_kernel_sykw
s_branch mega_kernel_sykd
mega_kernel_sykf:
s_mov_b32 s77, 0
s_mov_b32 s78, 0
v_readlane_b32 s76, v246, 0
s_add_u32 s77, s77, s76
s_xor_b32 s76, s76, 32
s_or_b32 s78, s78, s76
v_readlane_b32 s76, v246, 1
s_add_u32 s77, s77, s76
s_xor_b32 s76, s76, 32
s_or_b32 s78, s78, s76
v_readlane_b32 s76, v246, 2
s_add_u32 s77, s77, s76
s_xor_b32 s76, s76, 32
s_or_b32 s78, s78, s76
v_readlane_b32 s76, v246, 3
s_add_u32 s77, s77, s76
s_xor_b32 s76, s76, 32
s_or_b32 s78, s78, s76
v_readlane_b32 s76, v246, 4
s_add_u32 s77, s77, s76
s_xor_b32 s76, s76, 32
s_or_b32 s78, s78, s76
v_readlane_b32 s76, v246, 5
s_add_u32 s77, s77, s76
s_xor_b32 s76, s76, 32
s_or_b32 s78, s78, s76
v_readlane_b32 s76, v246, 6
s_add_u32 s77, s77, s76
s_xor_b32 s76, s76, 32
s_or_b32 s78, s78, s76
v_readlane_b32 s76, v246, 7
s_add_u32 s77, s77, s76
s_xor_b32 s76, s76, 32
s_or_b32 s78, s78, s76
s_cmp_eq_u32 s77, 256
s_cbranch_scc0 mega_kernel_sykw
v_mov_b32 v252, v246
s_cmp_eq_u32 s78, 0
s_cbranch_scc0 mega_kernel_slowent
v_readlane_b32 s76, v246, 10
v_readlane_b32 s77, v246, 8
s_cmp_eq_u32 s76, 32
s_cbranch_scc0 mega_kernel_sykw
s_cmp_gt_u32 s77, 16
s_cselect_b32 s98, 1, 0
mega_kernel_sykd:
s_lshr_b32 s44, s47, 3
s_xor_b32 s44, s44, s98
s_and_b32 s44, s44, 1
s_lshl_b32 s44, s44, 13
s_lshl_b32 s48, s47, 18
s_add_u32 s48, s48, s44
s_add_u32 s48, s48, 0
s_xor_b32 s44, s98, 1
s_lshl_b32 s44, s44, 13
s_lshl_b32 s49, s40, 7
s_add_u32 s49, s49, s44
s_lshl_b32 s44, s41, 2
s_add_u32 s49, s49, s44
s_add_u32 s49, s49, 69206016
v_mov_b32 v16, 0
v_cvt_pk_bf16_f32 v84, v52, v53
v_cvt_pk_bf16_f32 v85, v54, v55
v_cvt_pk_bf16_f32 v86, v56, v57
v_cvt_pk_bf16_f32 v87, v58, v59
v_cvt_pk_bf16_f32 v88, v60, v61
v_cvt_pk_bf16_f32 v89, v62, v63
v_cvt_pk_bf16_f32 v90, v64, v65
v_cvt_pk_bf16_f32 v91, v66, v67
s_add_u32 s51, s42, s47
s_sub_u32 s51, s51, 1
s_bfe_u32 s52, s51, 0x40002
s_lshl_b32 s52, s52, 14
s_and_b32 s51, s51, 3
s_lshl_b32 s51, s51, 11
s_add_u32 s51, s51, s52
s_add_u32 s51, s51, s48
buffer_store_dwordx4 v[84:87], v7, s[84:87], s51 offen sc1
buffer_store_dwordx4 v[88:91], v7, s[84:87], s51 offen offset:1024 sc1
s_mov_b32 s42, 2
s_nop 1
v_cvt_pk_bf16_f32 v84, v68, v69
v_cvt_pk_bf16_f32 v85, v70, v71
v_cvt_pk_bf16_f32 v86, v72, v73
v_cvt_pk_bf16_f32 v87, v74, v75
v_cvt_pk_bf16_f32 v88, v76, v77
v_cvt_pk_bf16_f32 v89, v78, v79
v_cvt_pk_bf16_f32 v90, v80, v81
v_cvt_pk_bf16_f32 v91, v82, v83
s_add_u32 s51, s42, s47
s_sub_u32 s51, s51, 1
s_bfe_u32 s52, s51, 0x40002
s_lshl_b32 s52, s52, 14
s_and_b32 s51, s51, 3
s_lshl_b32 s51, s51, 11
s_add_u32 s51, s51, s52
s_add_u32 s51, s51, s48
buffer_store_dwordx4 v[84:87], v7, s[84:87], s51 offen sc1
buffer_store_dwordx4 v[88:91], v7, s[84:87], s51 offen offset:1024 sc1
s_barrier
s_mov_b32 s50, 0x20000
s_add_u32 m0, s46, 0
s_nop 0
buffer_load_dwordx4 v6, s[8:11], s50 offen offset:0 lds
s_add_u32 m0, s46, 3968
s_nop 0
buffer_load_dwordx4 v6, s[8:11], s50 offen offset:128 lds
s_add_u32 m0, s46, 7936
s_nop 0
buffer_load_dwordx4 v6, s[8:11], s50 offen offset:256 lds
s_add_u32 m0, s46, 11904
s_nop 0
buffer_load_dwordx4 v6, s[8:11], s50 offen offset:384 lds
s_add_u32 m0, s46, 15872
s_nop 0
buffer_load_dwordx4 v6, s[8:11], s50 offen offset:512 lds
s_add_u32 m0, s46, 19840
s_nop 0
buffer_load_dwordx4 v6, s[8:11], s50 offen offset:640 lds
s_add_u32 m0, s46, 23808
s_nop 0
buffer_load_dwordx4 v6, s[8:11], s50 offen offset:768 lds
s_add_u32 m0, s46, 27776
s_nop 0
buffer_load_dwordx4 v6, s[8:11], s50 offen offset:896 lds
s_add_u32 m0, s46, 31744
s_nop 0
buffer_load_dwordx4 v6, s[8:11], s50 offen offset:1024 lds
s_add_u32 m0, s46, 35712
s_nop 0
buffer_load_dwordx4 v6, s[8:11], s50 offen offset:1152 lds
s_add_u32 m0, s46, 39680
s_nop 0
buffer_load_dwordx4 v6, s[8:11], s50 offen offset:1280 lds
s_add_u32 m0, s46, 43648
s_nop 0
buffer_load_dwordx4 v6, s[8:11], s50 offen offset:1408 lds
s_add_u32 m0, s46, 47616
s_nop 0
buffer_load_dwordx4 v6, s[8:11], s50 offen offset:1536 lds
s_add_u32 m0, s46, 51584
s_nop 0
buffer_load_dwordx4 v6, s[8:11], s50 offen offset:1664 lds
s_add_u32 m0, s46, 55552
s_nop 0
buffer_load_dwordx4 v6, s[8:11], s50 offen offset:1792 lds
s_add_u32 m0, s46, 59520
s_nop 0
buffer_load_dwordx4 v6, s[8:11], s50 offen offset:1920 lds
s_waitcnt vmcnt(16)
v_mov_b32 v17, s42
s_mov_b64 exec, 1
buffer_store_dword v17, v16, s[84:87], s49 offen sc1
s_mov_b64 exec, -1
s_waitcnt vmcnt(1)
s_branch mega_kernel_k_mid
mega_kernel_k_loop:
s_waitcnt vmcnt(2)
s_barrier
s_add_u32 s50, s42, 1
s_min_u32 s50, s50, 63
s_lshl_b32 s50, s50, 16
ds_read_b128 v[20:23], v10 offset:0
ds_read_b128 v[24:27], v10 offset:2048
ds_read_b128 v[28:31], v11 offset:0
ds_read_b128 v[32:35], v11 offset:2048
ds_read_b128 v[36:39], v10 offset:4096
ds_read_b128 v[40:43], v10 offset:6144
s_waitcnt lgkmcnt(4)
v_mfma_f32_16x16x32_bf16 v[68:71], a[0:3], v[20:23], 0
ds_read_b128 v[44:47], v11 offset:4096
v_mfma_f32_16x16x32_bf16 v[72:75], a[4:7], v[20:23], 0
v_cvt_pk_bf16_f32 v84, v52, v53
v_cvt_pk_bf16_f32 v85, v54, v55
v_cvt_pk_bf16_f32 v86, v56, v57
v_mfma_f32_16x16x32_bf16 v[76:79], a[0:3], v[24:27], 0
ds_read_b128 v[48:51], v11 offset:6144
v_mfma_f32_16x16x32_bf16 v[80:83], a[4:7], v[24:27], 0
v_cvt_pk_bf16_f32 v87, v58, v59
v_cvt_pk_bf16_f32 v88, v60, v61
v_cvt_pk_bf16_f32 v89, v62, v63
s_waitcnt lgkmcnt(4)
v_mfma_f32_16x16x32_bf16 v[68:71], a[8:11], v[28:31], v[68:71]
ds_read_b128 v[20:23], v10 offset:8192
v_mfma_f32_16x16x32_bf16 v[72:75], a[12:15], v[28:31], v[72:75]
v_cvt_pk_bf16_f32 v90, v64, v65
v_cvt_pk_bf16_f32 v91, v66, v67
v_mfma_f32_16x16x32_bf16 v[76:79], a[8:11], v[32:35], v[76:79]
ds_read_b128 v[24:27], v10 offset:10240
v_mfma_f32_16x16x32_bf16 v[80:83], a[12:15], v[32:35], v[80:83]
s_add_u32 s51, s42, s47
s_sub_u32 s51, s51, 1
s_bfe_u32 s52, s51, 0x40002
s_lshl_b32 s52, s52, 14
s_waitcnt lgkmcnt(4)
v_mfma_f32_16x16x32_bf16 v[68:71], a[16:19], v[36:39], v[68:71]
ds_read_b128 v[28:31], v11 offset:8192
v_mfma_f32_16x16x32_bf16 v[72:75], a[20:23], v[36:39], v[72:75]
s_and_b32 s51, s51, 3
s_lshl_b32 s51, s51, 11
s_add_u32 s51, s51, s52
s_add_u32 s51, s51, s48
buffer_store_dwordx4 v[84:87], v7, s[84:87], s51 offen sc1
v_mfma_f32_16x16x32_bf16 v[76:79], a[16:19], v[40:43], v[76:79]
ds_read_b128 v[32:35], v11 offset:10240
v_mfma_f32_16x16x32_bf16 v[80:83], a[20:23], v[40:43], v[80:83]
buffer_store_dwordx4 v[88:91], v7, s[84:87], s51 offen offset:1024 sc1
s_waitcnt lgkmcnt(4)
v_mfma_f32_16x16x32_bf16 v[68:71], a[24:27], v[44:47], v[68:71]
ds_read_b128 v[36:39], v10 offset:12288
v_mfma_f32_16x16x32_bf16 v[72:75], a[28:31], v[44:47], v[72:75]
s_add_u32 m0, s46, 0
v_mfma_f32_16x16x32_bf16 v[76:79], a[24:27], v[48:51], v[76:79]
ds_read_b128 v[40:43], v10 offset:14336
v_mfma_f32_16x16x32_bf16 v[80:83], a[28:31], v[48:51], v[80:83]
buffer_load_dwordx4 v6, s[8:11], s50 offen offset:0 lds
s_waitcnt lgkmcnt(4)
v_mfma_f32_16x16x32_bf16 v[68:71], a[32:35], v[20:23], v[68:71]
ds_read_b128 v[44:47], v11 offset:12288
v_mfma_f32_16x16x32_bf16 v[72:75], a[36:39], v[20:23], v[72:75]
s_add_u32 m0, s46, 3968
v_mfma_f32_16x16x32_bf16 v[76:79], a[32:35], v[24:27], v[76:79]
ds_read_b128 v[48:51], v11 offset:14336
v_mfma_f32_16x16x32_bf16 v[80:83], a[36:39], v[24:27], v[80:83]
buffer_load_dwordx4 v6, s[8:11], s50 offen offset:128 lds
s_waitcnt lgkmcnt(4)
v_mfma_f32_16x16x32_bf16 v[68:71], a[40:43], v[28:31], v[68:71]
ds_read_b128 v[20:23], v10 offset:16384
v_mfma_f32_16x16x32_bf16 v[72:75], a[44:47], v[28:31], v[72:75]
s_add_u32 m0, s46, 7936
v_mfma_f32_16x16x32_bf16 v[76:79], a[40:43], v[32:35], v[76:79]
ds_read_b128 v[24:27], v10 offset:18432
v_mfma_f32_16x16x32_bf16 v[80:83], a[44:47], v[32:35], v[80:83]
buffer_load_dwordx4 v6, s[8:11], s50 offen offset:256 lds
s_waitcnt lgkmcnt(4)
v_mfma_f32_16x16x32_bf16 v[68:71], a[48:51], v[36:39], v[68:71]
ds_read_b128 v[28:31], v11 offset:16384
v_mfma_f32_16x16x32_bf16 v[72:75], a[52:55], v[36:39], v[72:75]
s_add_u32 m0, s46, 11904
v_mfma_f32_16x16x32_bf16 v[76:79], a[48:51], v[40:43], v[76:79]
ds_read_b128 v[32:35], v11 offset:18432
v_mfma_f32_16x16x32_bf16 v[80:83], a[52:55], v[40:43], v[80:83]
buffer_load_dwordx4 v6, s[8:11], s50 offen offset:384 lds
s_waitcnt lgkmcnt(4)
v_mfma_f32_16x16x32_bf16 v[68:71], a[56:59], v[44:47], v[68:71]
ds_read_b128 v[36:39], v10 offset:20480
v_mfma_f32_16x16x32_bf16 v[72:75], a[60:63], v[44:47], v[72:75]
s_add_u32 m0, s46, 15872
v_mfma_f32_16x16x32_bf16 v[76:79], a[56:59], v[48:51], v[76:79]
ds_read_b128 v[40:43], v10 offset:22528
v_mfma_f32_16x16x32_bf16 v[80:83], a[60:63], v[48:51], v[80:83]
buffer_load_dwordx4 v6, s[8:11], s50 offen offset:512 lds
s_waitcnt lgkmcnt(4)
v_mfma_f32_16x16x32_bf16 v[68:71], a[64:67], v[20:23], v[68:71]
ds_read_b128 v[44:47], v11 offset:20480
v_mfma_f32_16x16x32_bf16 v[72:75], a[68:71], v[20:23], v[72:75]
s_add_u32 m0, s46, 19840
v_mfma_f32_16x16x32_bf16 v[76:79], a[64:67], v[24:27], v[76:79]
ds_read_b128 v[48:51], v11 offset:22528
v_mfma_f32_16x16x32_bf16 v[80:83], a[68:71], v[24:27], v[80:83]
buffer_load_dwordx4 v6, s[8:11], s50 offen offset:640 lds
s_waitcnt lgkmcnt(4)
v_mfma_f32_16x16x32_bf16 v[68:71], a[72:75], v[28:31], v[68:71]
ds_read_b128 v[20:23], v10 offset:24576
v_mfma_f32_16x16x32_bf16 v[72:75], a[76:79], v[28:31], v[72:75]
s_add_u32 m0, s46, 23808
v_mfma_f32_16x16x32_bf16 v[76:79], a[72:75], v[32:35], v[76:79]
ds_read_b128 v[24:27], v10 offset:26624
v_mfma_f32_16x16x32_bf16 v[80:83], a[76:79], v[32:35], v[80:83]
buffer_load_dwordx4 v6, s[8:11], s50 offen offset:768 lds
s_waitcnt lgkmcnt(4)
v_mfma_f32_16x16x32_bf16 v[68:71], a[80:83], v[36:39], v[68:71]
ds_read_b128 v[28:31], v11 offset:24576
v_mfma_f32_16x16x32_bf16 v[72:75], a[84:87], v[36:39], v[72:75]
s_add_u32 m0, s46, 27776
v_mfma_f32_16x16x32_bf16 v[76:79], a[80:83], v[40:43], v[76:79]
ds_read_b128 v[32:35], v11 offset:26624
v_mfma_f32_16x16x32_bf16 v[80:83], a[84:87], v[40:43], v[80:83]
buffer_load_dwordx4 v6, s[8:11], s50 offen offset:896 lds
s_waitcnt lgkmcnt(4)
v_mfma_f32_16x16x32_bf16 v[68:71], a[88:91], v[44:47], v[68:71]
ds_read_b128 v[36:39], v10 offset:28672
v_mfma_f32_16x16x32_bf16 v[72:75], a[92:95], v[44:47], v[72:75]
s_add_u32 m0, s46, 31744
v_mfma_f32_16x16x32_bf16 v[76:79], a[88:91], v[48:51], v[76:79]
ds_read_b128 v[40:43], v10 offset:30720
v_mfma_f32_16x16x32_bf16 v[80:83], a[92:95], v[48:51], v[80:83]
buffer_load_dwordx4 v6, s[8:11], s50 offen offset:1024 lds
s_waitcnt lgkmcnt(4)
v_mfma_f32_16x16x32_bf16 v[68:71], a[96:99], v[20:23], v[68:71]
ds_read_b128 v[44:47], v11 offset:28672
v_mfma_f32_16x16x32_bf16 v[72:75], a[100:103], v[20:23], v[72:75]
s_add_u32 m0, s46, 35712
v_mfma_f32_16x16x32_bf16 v[76:79], a[96:99], v[24:27], v[76:79]
ds_read_b128 v[48:51], v11 offset:30720
v_mfma_f32_16x16x32_bf16 v[80:83], a[100:103], v[24:27], v[80:83]
buffer_load_dwordx4 v6, s[8:11], s50 offen offset:1152 lds
s_waitcnt lgkmcnt(4)
v_mfma_f32_16x16x32_bf16 v[68:71], a[104:107], v[28:31], v[68:71]
ds_read_b128 v[20:23], v10 offset:32768
v_mfma_f32_16x16x32_bf16 v[72:75], a[108:111], v[28:31], v[72:75]
s_add_u32 m0, s46, 39680
v_mfma_f32_16x16x32_bf16 v[76:79], a[104:107], v[32:35], v[76:79]
ds_read_b128 v[24:27], v10 offset:34816
v_mfma_f32_16x16x32_bf16 v[80:83], a[108:111], v[32:35], v[80:83]
buffer_load_dwordx4 v6, s[8:11], s50 offen offset:1280 lds
s_waitcnt lgkmcnt(4)
v_mfma_f32_16x16x32_bf16 v[68:71], a[112:115], v[36:39], v[68:71]
ds_read_b128 v[28:31], v11 offset:32768
v_mfma_f32_16x16x32_bf16 v[72:75], a[116:119], v[36:39], v[72:75]
s_add_u32 m0, s46, 43648
v_mfma_f32_16x16x32_bf16 v[76:79], a[112:115], v[40:43], v[76:79]
ds_read_b128 v[32:35], v11 offset:34816
v_mfma_f32_16x16x32_bf16 v[80:83], a[116:119], v[40:43], v[80:83]
buffer_load_dwordx4 v6, s[8:11], s50 offen offset:1408 lds
s_waitcnt lgkmcnt(4)
v_mfma_f32_16x16x32_bf16 v[68:71], a[120:123], v[44:47], v[68:71]
ds_read_b128 v[36:39], v10 offset:36864
v_mfma_f32_16x16x32_bf16 v[72:75], a[124:127], v[44:47], v[72:75]
s_add_u32 m0, s46, 47616
v_mfma_f32_16x16x32_bf16 v[76:79], a[120:123], v[48:51], v[76:79]
ds_read_b128 v[40:43], v10 offset:38912
v_mfma_f32_16x16x32_bf16 v[80:83], a[124:127], v[48:51], v[80:83]
buffer_load_dwordx4 v6, s[8:11], s50 offen offset:1536 lds
s_waitcnt lgkmcnt(4)
v_mfma_f32_16x16x32_bf16 v[68:71], a[128:131], v[20:23], v[68:71]
ds_read_b128 v[44:47], v11 offset:36864
v_mfma_f32_16x16x32_bf16 v[72:75], a[132:135], v[20:23], v[72:75]
s_add_u32 m0, s46, 51584
v_mfma_f32_16x16x32_bf16 v[76:79], a[128:131], v[24:27], v[76:79]
ds_read_b128 v[48:51], v11 offset:38912
v_mfma_f32_16x16x32_bf16 v[80:83], a[132:135], v[24:27], v[80:83]
buffer_load_dwordx4 v6, s[8:11], s50 offen offset:1664 lds
s_waitcnt lgkmcnt(4)
v_mfma_f32_16x16x32_bf16 v[68:71], a[136:139], v[28:31], v[68:71]
ds_read_b128 v[20:23], v10 offset:40960
v_mfma_f32_16x16x32_bf16 v[72:75], a[140:143], v[28:31], v[72:75]
s_add_u32 m0, s46, 55552
v_mfma_f32_16x16x32_bf16 v[76:79], a[136:139], v[32:35], v[76:79]
ds_read_b128 v[24:27], v10 offset:43008
v_mfma_f32_16x16x32_bf16 v[80:83], a[140:143], v[32:35], v[80:83]
buffer_load_dwordx4 v6, s[8:11], s50 offen offset:1792 lds
s_waitcnt lgkmcnt(4)
v_mfma_f32_16x16x32_bf16 v[68:71], a[144:147], v[36:39], v[68:71]
ds_read_b128 v[28:31], v11 offset:40960
v_mfma_f32_16x16x32_bf16 v[72:75], a[148:151], v[36:39], v[72:75]
s_add_u32 m0, s46, 59520
v_mfma_f32_16x16x32_bf16 v[76:79], a[144:147], v[40:43], v[76:79]
ds_read_b128 v[32:35], v11 offset:43008
v_mfma_f32_16x16x32_bf16 v[80:83], a[148:151], v[40:43], v[80:83]
buffer_load_dwordx4 v6, s[8:11], s50 offen offset:1920 lds
s_waitcnt lgkmcnt(4)
v_mfma_f32_16x16x32_bf16 v[68:71], a[152:155], v[44:47], v[68:71]
ds_read_b128 v[36:39], v10 offset:45056
v_mfma_f32_16x16x32_bf16 v[72:75], a[156:159], v[44:47], v[72:75]
v_mfma_f32_16x16x32_bf16 v[76:79], a[152:155], v[48:51], v[76:79]
ds_read_b128 v[40:43], v10 offset:47104
v_mfma_f32_16x16x32_bf16 v[80:83], a[156:159], v[48:51], v[80:83]
s_waitcnt lgkmcnt(4)
v_mfma_f32_16x16x32_bf16 v[68:71], a[160:163], v[20:23], v[68:71]
ds_read_b128 v[44:47], v11 offset:45056
v_mfma_f32_16x16x32_bf16 v[72:75], a[164:167], v[20:23], v[72:75]
v_mfma_f32_16x16x32_bf16 v[76:79], a[160:163], v[24:27], v[76:79]
ds_read_b128 v[48:51], v11 offset:47104
v_mfma_f32_16x16x32_bf16 v[80:83], a[164:167], v[24:27], v[80:83]
s_waitcnt lgkmcnt(4)
v_mfma_f32_16x16x32_bf16 v[68:71], a[168:171], v[28:31], v[68:71]
ds_read_b128 v[20:23], v10 offset:49152
v_mfma_f32_16x16x32_bf16 v[72:75], a[172:175], v[28:31], v[72:75]
s_waitcnt vmcnt(16)
v_mov_b32 v17, s42
s_mov_b64 exec, 1
buffer_store_dword v17, v16, s[84:87], s49 offen sc1
s_mov_b64 exec, -1
v_mfma_f32_16x16x32_bf16 v[76:79], a[168:171], v[32:35], v[76:79]
ds_read_b128 v[24:27], v10 offset:51200
v_mfma_f32_16x16x32_bf16 v[80:83], a[172:175], v[32:35], v[80:83]
s_waitcnt lgkmcnt(4)
v_mfma_f32_16x16x32_bf16 v[68:71], a[176:179], v[36:39], v[68:71]
ds_read_b128 v[28:31], v11 offset:49152
v_mfma_f32_16x16x32_bf16 v[72:75], a[180:183], v[36:39], v[72:75]
s_add_u32 s53, s42, 3
s_min_u32 s53, s53, 63
s_lshl_b32 s53, s53, 16
s_mov_b64 exec, 0xffff
buffer_load_dword v250, v19, s[8:11], s53 offen
s_mov_b64 exec, -1
v_mfma_f32_16x16x32_bf16 v[76:79], a[176:179], v[40:43], v[76:79]
ds_read_b128 v[32:35], v11 offset:51200
v_mfma_f32_16x16x32_bf16 v[80:83], a[180:183], v[40:43], v[80:83]
s_waitcnt lgkmcnt(4)
v_mfma_f32_16x16x32_bf16 v[68:71], a[184:187], v[44:47], v[68:71]
ds_read_b128 v[36:39], v10 offset:53248
v_mfma_f32_16x16x32_bf16 v[72:75], a[188:191], v[44:47], v[72:75]
v_mfma_f32_16x16x32_bf16 v[76:79], a[184:187], v[48:51], v[76:79]
ds_read_b128 v[40:43], v10 offset:55296
v_mfma_f32_16x16x32_bf16 v[80:83], a[188:191], v[48:51], v[80:83]
s_waitcnt lgkmcnt(4)
v_mfma_f32_16x16x32_bf16 v[68:71], a[192:195], v[20:23], v[68:71]
ds_read_b128 v[44:47], v11 offset:53248
v_mfma_f32_16x16x32_bf16 v[72:75], a[196:199], v[20:23], v[72:75]
v_mfma_f32_16x16x32_bf16 v[76:79], a[192:195], v[24:27], v[76:79]
ds_read_b128 v[48:51], v11 offset:55296
v_mfma_f32_16x16x32_bf16 v[80:83], a[196:199], v[24:27], v[80:83]
s_waitcnt lgkmcnt(4)
v_mfma_f32_16x16x32_bf16 v[68:71], a[200:203], v[28:31], v[68:71]
ds_read_b128 v[20:23], v10 offset:57344
v_mfma_f32_16x16x32_bf16 v[72:75], a[204:207], v[28:31], v[72:75]
v_mfma_f32_16x16x32_bf16 v[76:79], a[200:203], v[32:35], v[76:79]
ds_read_b128 v[24:27], v10 offset:59392
v_mfma_f32_16x16x32_bf16 v[80:83], a[204:207], v[32:35], v[80:83]
s_waitcnt lgkmcnt(4)
v_mfma_f32_16x16x32_bf16 v[68:71], a[208:211], v[36:39], v[68:71]
ds_read_b128 v[28:31], v11 offset:57344
v_mfma_f32_16x16x32_bf16 v[72:75], a[212:215], v[36:39], v[72:75]
v_mfma_f32_16x16x32_bf16 v[76:79], a[208:211], v[40:43], v[76:79]
ds_read_b128 v[32:35], v11 offset:59392
v_mfma_f32_16x16x32_bf16 v[80:83], a[212:215], v[40:43], v[80:83]
s_waitcnt lgkmcnt(4)
v_mfma_f32_16x16x32_bf16 v[68:71], a[216:219], v[44:47], v[68:71]
ds_read_b128 v[36:39], v10 offset:61440
v_mfma_f32_16x16x32_bf16 v[72:75], a[220:223], v[44:47], v[72:75]
v_mfma_f32_16x16x32_bf16 v[76:79], a[216:219], v[48:51], v[76:79]
ds_read_b128 v[40:43], v10 offset:63488
v_mfma_f32_16x16x32_bf16 v[80:83], a[220:223], v[48:51], v[80:83]
s_waitcnt lgkmcnt(4)
v_mfma_f32_16x16x32_bf16 v[68:71], a[224:227], v[20:23], v[68:71]
ds_read_b128 v[44:47], v11 offset:61440
v_mfma_f32_16x16x32_bf16 v[72:75], a[228:231], v[20:23], v[72:75]
v_mfma_f32_16x16x32_bf16 v[76:79], a[224:227], v[24:27], v[76:79]
ds_read_b128 v[48:51], v11 offset:63488
v_mfma_f32_16x16x32_bf16 v[80:83], a[228:231], v[24:27], v[80:83]
s_waitcnt lgkmcnt(5)
v_mfma_f32_16x16x32_bf16 v[68:71], a[232:235], v[28:31], v[68:71]
v_mfma_f32_16x16x32_bf16 v[72:75], a[236:239], v[28:31], v[72:75]
s_waitcnt lgkmcnt(4)
v_mfma_f32_16x16x32_bf16 v[76:79], a[232:235], v[32:35], v[76:79]
v_mfma_f32_16x16x32_bf16 v[80:83], a[236:239], v[32:35], v[80:83]
s_waitcnt lgkmcnt(3)
v_mfma_f32_16x16x32_bf16 v[68:71], a[240:243], v[36:39], v[68:71]
v_mfma_f32_16x16x32_bf16 v[72:75], a[244:247], v[36:39], v[72:75]
s_waitcnt lgkmcnt(2)
v_mfma_f32_16x16x32_bf16 v[76:79], a[240:243], v[40:43], v[76:79]
v_mfma_f32_16x16x32_bf16 v[80:83], a[244:247], v[40:43], v[80:83]
s_waitcnt lgkmcnt(1)
v_mfma_f32_16x16x32_bf16 v[68:71], a[248:251], v[44:47], v[68:71]
v_mfma_f32_16x16x32_bf16 v[72:75], a[252:255], v[44:47], v[72:75]
s_waitcnt lgkmcnt(0)
v_mfma_f32_16x16x32_bf16 v[76:79], a[248:251], v[48:51], v[76:79]
v_mfma_f32_16x16x32_bf16 v[80:83], a[252:255], v[48:51], v[80:83]
s_add_u32 s42, s42, 1
s_cmp_eq_u32 s42, 64
s_cbranch_scc1 mega_kernel_k_fin
mega_kernel_k_mid:
s_waitcnt vmcnt(2)
s_barrier
s_add_u32 s50, s42, 1
s_min_u32 s50, s50, 63
s_lshl_b32 s50, s50, 16
ds_read_b128 v[20:23], v8 offset:0
ds_read_b128 v[24:27], v8 offset:2048
ds_read_b128 v[28:31], v9 offset:0
ds_read_b128 v[32:35], v9 offset:2048
ds_read_b128 v[36:39], v8 offset:4096
ds_read_b128 v[40:43], v8 offset:6144
s_waitcnt lgkmcnt(4)
v_mfma_f32_16x16x32_bf16 v[52:55], a[0:3], v[20:23], 0
ds_read_b128 v[44:47], v9 offset:4096
v_mfma_f32_16x16x32_bf16 v[56:59], a[4:7], v[20:23], 0
v_cvt_pk_bf16_f32 v84, v68, v69
v_cvt_pk_bf16_f32 v85, v70, v71
v_cvt_pk_bf16_f32 v86, v72, v73
v_mfma_f32_16x16x32_bf16 v[60:63], a[0:3], v[24:27], 0
ds_read_b128 v[48:51], v9 offset:6144
v_mfma_f32_16x16x32_bf16 v[64:67], a[4:7], v[24:27], 0
v_cvt_pk_bf16_f32 v87, v74, v75
v_cvt_pk_bf16_f32 v88, v76, v77
v_cvt_pk_bf16_f32 v89, v78, v79
s_waitcnt lgkmcnt(4)
v_mfma_f32_16x16x32_bf16 v[52:55], a[8:11], v[28:31], v[52:55]
ds_read_b128 v[20:23], v8 offset:8192
v_mfma_f32_16x16x32_bf16 v[56:59], a[12:15], v[28:31], v[56:59]
v_cvt_pk_bf16_f32 v90, v80, v81
v_cvt_pk_bf16_f32 v91, v82, v83
v_mfma_f32_16x16x32_bf16 v[60:63], a[8:11], v[32:35], v[60:63]
ds_read_b128 v[24:27], v8 offset:10240
v_mfma_f32_16x16x32_bf16 v[64:67], a[12:15], v[32:35], v[64:67]
s_add_u32 s51, s42, s47
s_sub_u32 s51, s51, 1
s_bfe_u32 s52, s51, 0x40002
s_lshl_b32 s52, s52, 14
s_waitcnt lgkmcnt(4)
v_mfma_f32_16x16x32_bf16 v[52:55], a[16:19], v[36:39], v[52:55]
ds_read_b128 v[28:31], v9 offset:8192
v_mfma_f32_16x16x32_bf16 v[56:59], a[20:23], v[36:39], v[56:59]
s_and_b32 s51, s51, 3
s_lshl_b32 s51, s51, 11
s_add_u32 s51, s51, s52
s_add_u32 s51, s51, s48
buffer_store_dwordx4 v[84:87], v7, s[84:87], s51 offen sc1
v_mfma_f32_16x16x32_bf16 v[60:63], a[16:19], v[40:43], v[60:63]
ds_read_b128 v[32:35], v9 offset:10240
v_mfma_f32_16x16x32_bf16 v[64:67], a[20:23], v[40:43], v[64:67]
buffer_store_dwordx4 v[88:91], v7, s[84:87], s51 offen offset:1024 sc1
s_waitcnt lgkmcnt(4)
v_mfma_f32_16x16x32_bf16 v[52:55], a[24:27], v[44:47], v[52:55]
ds_read_b128 v[36:39], v8 offset:12288
v_mfma_f32_16x16x32_bf16 v[56:59], a[28:31], v[44:47], v[56:59]
s_add_u32 m0, s46, 65536
v_mfma_f32_16x16x32_bf16 v[60:63], a[24:27], v[48:51], v[60:63]
ds_read_b128 v[40:43], v8 offset:14336
v_mfma_f32_16x16x32_bf16 v[64:67], a[28:31], v[48:51], v[64:67]
buffer_load_dwordx4 v6, s[8:11], s50 offen offset:0 lds
s_waitcnt lgkmcnt(4)
v_mfma_f32_16x16x32_bf16 v[52:55], a[32:35], v[20:23], v[52:55]
ds_read_b128 v[44:47], v9 offset:12288
v_mfma_f32_16x16x32_bf16 v[56:59], a[36:39], v[20:23], v[56:59]
s_add_u32 m0, s46, 69504
v_mfma_f32_16x16x32_bf16 v[60:63], a[32:35], v[24:27], v[60:63]
ds_read_b128 v[48:51], v9 offset:14336
v_mfma_f32_16x16x32_bf16 v[64:67], a[36:39], v[24:27], v[64:67]
buffer_load_dwordx4 v6, s[8:11], s50 offen offset:128 lds
s_waitcnt lgkmcnt(4)
v_mfma_f32_16x16x32_bf16 v[52:55], a[40:43], v[28:31], v[52:55]
ds_read_b128 v[20:23], v8 offset:16384
v_mfma_f32_16x16x32_bf16 v[56:59], a[44:47], v[28:31], v[56:59]
s_add_u32 m0, s46, 73472
v_mfma_f32_16x16x32_bf16 v[60:63], a[40:43], v[32:35], v[60:63]
ds_read_b128 v[24:27], v8 offset:18432
v_mfma_f32_16x16x32_bf16 v[64:67], a[44:47], v[32:35], v[64:67]
buffer_load_dwordx4 v6, s[8:11], s50 offen offset:256 lds
s_waitcnt lgkmcnt(4)
v_mfma_f32_16x16x32_bf16 v[52:55], a[48:51], v[36:39], v[52:55]
ds_read_b128 v[28:31], v9 offset:16384
v_mfma_f32_16x16x32_bf16 v[56:59], a[52:55], v[36:39], v[56:59]
s_add_u32 m0, s46, 77440
v_mfma_f32_16x16x32_bf16 v[60:63], a[48:51], v[40:43], v[60:63]
ds_read_b128 v[32:35], v9 offset:18432
v_mfma_f32_16x16x32_bf16 v[64:67], a[52:55], v[40:43], v[64:67]
buffer_load_dwordx4 v6, s[8:11], s50 offen offset:384 lds
s_waitcnt lgkmcnt(4)
v_mfma_f32_16x16x32_bf16 v[52:55], a[56:59], v[44:47], v[52:55]
ds_read_b128 v[36:39], v8 offset:20480
v_mfma_f32_16x16x32_bf16 v[56:59], a[60:63], v[44:47], v[56:59]
s_add_u32 m0, s46, 81408
v_mfma_f32_16x16x32_bf16 v[60:63], a[56:59], v[48:51], v[60:63]
ds_read_b128 v[40:43], v8 offset:22528
v_mfma_f32_16x16x32_bf16 v[64:67], a[60:63], v[48:51], v[64:67]
buffer_load_dwordx4 v6, s[8:11], s50 offen offset:512 lds
s_waitcnt lgkmcnt(4)
v_mfma_f32_16x16x32_bf16 v[52:55], a[64:67], v[20:23], v[52:55]
ds_read_b128 v[44:47], v9 offset:20480
v_mfma_f32_16x16x32_bf16 v[56:59], a[68:71], v[20:23], v[56:59]
s_add_u32 m0, s46, 85376
v_mfma_f32_16x16x32_bf16 v[60:63], a[64:67], v[24:27], v[60:63]
ds_read_b128 v[48:51], v9 offset:22528
v_mfma_f32_16x16x32_bf16 v[64:67], a[68:71], v[24:27], v[64:67]
buffer_load_dwordx4 v6, s[8:11], s50 offen offset:640 lds
s_waitcnt lgkmcnt(4)
v_mfma_f32_16x16x32_bf16 v[52:55], a[72:75], v[28:31], v[52:55]
ds_read_b128 v[20:23], v8 offset:24576
v_mfma_f32_16x16x32_bf16 v[56:59], a[76:79], v[28:31], v[56:59]
s_add_u32 m0, s46, 89344
v_mfma_f32_16x16x32_bf16 v[60:63], a[72:75], v[32:35], v[60:63]
ds_read_b128 v[24:27], v8 offset:26624
v_mfma_f32_16x16x32_bf16 v[64:67], a[76:79], v[32:35], v[64:67]
buffer_load_dwordx4 v6, s[8:11], s50 offen offset:768 lds
s_waitcnt lgkmcnt(4)
v_mfma_f32_16x16x32_bf16 v[52:55], a[80:83], v[36:39], v[52:55]
ds_read_b128 v[28:31], v9 offset:24576
v_mfma_f32_16x16x32_bf16 v[56:59], a[84:87], v[36:39], v[56:59]
s_add_u32 m0, s46, 93312
v_mfma_f32_16x16x32_bf16 v[60:63], a[80:83], v[40:43], v[60:63]
ds_read_b128 v[32:35], v9 offset:26624
v_mfma_f32_16x16x32_bf16 v[64:67], a[84:87], v[40:43], v[64:67]
buffer_load_dwordx4 v6, s[8:11], s50 offen offset:896 lds
s_waitcnt lgkmcnt(4)
v_mfma_f32_16x16x32_bf16 v[52:55], a[88:91], v[44:47], v[52:55]
ds_read_b128 v[36:39], v8 offset:28672
v_mfma_f32_16x16x32_bf16 v[56:59], a[92:95], v[44:47], v[56:59]
s_add_u32 m0, s46, 97280
v_mfma_f32_16x16x32_bf16 v[60:63], a[88:91], v[48:51], v[60:63]
ds_read_b128 v[40:43], v8 offset:30720
v_mfma_f32_16x16x32_bf16 v[64:67], a[92:95], v[48:51], v[64:67]
buffer_load_dwordx4 v6, s[8:11], s50 offen offset:1024 lds
s_waitcnt lgkmcnt(4)
v_mfma_f32_16x16x32_bf16 v[52:55], a[96:99], v[20:23], v[52:55]
ds_read_b128 v[44:47], v9 offset:28672
v_mfma_f32_16x16x32_bf16 v[56:59], a[100:103], v[20:23], v[56:59]
s_add_u32 m0, s46, 101248
v_mfma_f32_16x16x32_bf16 v[60:63], a[96:99], v[24:27], v[60:63]
ds_read_b128 v[48:51], v9 offset:30720
v_mfma_f32_16x16x32_bf16 v[64:67], a[100:103], v[24:27], v[64:67]
buffer_load_dwordx4 v6, s[8:11], s50 offen offset:1152 lds
s_waitcnt lgkmcnt(4)
v_mfma_f32_16x16x32_bf16 v[52:55], a[104:107], v[28:31], v[52:55]
ds_read_b128 v[20:23], v8 offset:32768
v_mfma_f32_16x16x32_bf16 v[56:59], a[108:111], v[28:31], v[56:59]
s_add_u32 m0, s46, 105216
v_mfma_f32_16x16x32_bf16 v[60:63], a[104:107], v[32:35], v[60:63]
ds_read_b128 v[24:27], v8 offset:34816
v_mfma_f32_16x16x32_bf16 v[64:67], a[108:111], v[32:35], v[64:67]
buffer_load_dwordx4 v6, s[8:11], s50 offen offset:1280 lds
s_waitcnt lgkmcnt(4)
v_mfma_f32_16x16x32_bf16 v[52:55], a[112:115], v[36:39], v[52:55]
ds_read_b128 v[28:31], v9 offset:32768
v_mfma_f32_16x16x32_bf16 v[56:59], a[116:119], v[36:39], v[56:59]
s_add_u32 m0, s46, 109184
v_mfma_f32_16x16x32_bf16 v[60:63], a[112:115], v[40:43], v[60:63]
ds_read_b128 v[32:35], v9 offset:34816
v_mfma_f32_16x16x32_bf16 v[64:67], a[116:119], v[40:43], v[64:67]
buffer_load_dwordx4 v6, s[8:11], s50 offen offset:1408 lds
s_waitcnt lgkmcnt(4)
v_mfma_f32_16x16x32_bf16 v[52:55], a[120:123], v[44:47], v[52:55]
ds_read_b128 v[36:39], v8 offset:36864
v_mfma_f32_16x16x32_bf16 v[56:59], a[124:127], v[44:47], v[56:59]
s_add_u32 m0, s46, 113152
v_mfma_f32_16x16x32_bf16 v[60:63], a[120:123], v[48:51], v[60:63]
ds_read_b128 v[40:43], v8 offset:38912
v_mfma_f32_16x16x32_bf16 v[64:67], a[124:127], v[48:51], v[64:67]
buffer_load_dwordx4 v6, s[8:11], s50 offen offset:1536 lds
s_waitcnt lgkmcnt(4)
v_mfma_f32_16x16x32_bf16 v[52:55], a[128:131], v[20:23], v[52:55]
ds_read_b128 v[44:47], v9 offset:36864
v_mfma_f32_16x16x32_bf16 v[56:59], a[132:135], v[20:23], v[56:59]
s_add_u32 m0, s46, 117120
v_mfma_f32_16x16x32_bf16 v[60:63], a[128:131], v[24:27], v[60:63]
ds_read_b128 v[48:51], v9 offset:38912
v_mfma_f32_16x16x32_bf16 v[64:67], a[132:135], v[24:27], v[64:67]
buffer_load_dwordx4 v6, s[8:11], s50 offen offset:1664 lds
s_waitcnt lgkmcnt(4)
v_mfma_f32_16x16x32_bf16 v[52:55], a[136:139], v[28:31], v[52:55]
ds_read_b128 v[20:23], v8 offset:40960
v_mfma_f32_16x16x32_bf16 v[56:59], a[140:143], v[28:31], v[56:59]
s_add_u32 m0, s46, 121088
v_mfma_f32_16x16x32_bf16 v[60:63], a[136:139], v[32:35], v[60:63]
ds_read_b128 v[24:27], v8 offset:43008
v_mfma_f32_16x16x32_bf16 v[64:67], a[140:143], v[32:35], v[64:67]
buffer_load_dwordx4 v6, s[8:11], s50 offen offset:1792 lds
s_waitcnt lgkmcnt(4)
v_mfma_f32_16x16x32_bf16 v[52:55], a[144:147], v[36:39], v[52:55]
ds_read_b128 v[28:31], v9 offset:40960
v_mfma_f32_16x16x32_bf16 v[56:59], a[148:151], v[36:39], v[56:59]
s_add_u32 m0, s46, 125056
v_mfma_f32_16x16x32_bf16 v[60:63], a[144:147], v[40:43], v[60:63]
ds_read_b128 v[32:35], v9 offset:43008
v_mfma_f32_16x16x32_bf16 v[64:67], a[148:151], v[40:43], v[64:67]
buffer_load_dwordx4 v6, s[8:11], s50 offen offset:1920 lds
s_waitcnt lgkmcnt(4)
v_mfma_f32_16x16x32_bf16 v[52:55], a[152:155], v[44:47], v[52:55]
ds_read_b128 v[36:39], v8 offset:45056
v_mfma_f32_16x16x32_bf16 v[56:59], a[156:159], v[44:47], v[56:59]
v_mfma_f32_16x16x32_bf16 v[60:63], a[152:155], v[48:51], v[60:63]
ds_read_b128 v[40:43], v8 offset:47104
v_mfma_f32_16x16x32_bf16 v[64:67], a[156:159], v[48:51], v[64:67]
s_waitcnt lgkmcnt(4)
v_mfma_f32_16x16x32_bf16 v[52:55], a[160:163], v[20:23], v[52:55]
ds_read_b128 v[44:47], v9 offset:45056
v_mfma_f32_16x16x32_bf16 v[56:59], a[164:167], v[20:23], v[56:59]
v_mfma_f32_16x16x32_bf16 v[60:63], a[160:163], v[24:27], v[60:63]
ds_read_b128 v[48:51], v9 offset:47104
v_mfma_f32_16x16x32_bf16 v[64:67], a[164:167], v[24:27], v[64:67]
s_waitcnt lgkmcnt(4)
v_mfma_f32_16x16x32_bf16 v[52:55], a[168:171], v[28:31], v[52:55]
ds_read_b128 v[20:23], v8 offset:49152
v_mfma_f32_16x16x32_bf16 v[56:59], a[172:175], v[28:31], v[56:59]
s_waitcnt vmcnt(16)
v_mov_b32 v17, s42
s_mov_b64 exec, 1
buffer_store_dword v17, v16, s[84:87], s49 offen sc1
s_mov_b64 exec, -1
v_mfma_f32_16x16x32_bf16 v[60:63], a[168:171], v[32:35], v[60:63]
ds_read_b128 v[24:27], v8 offset:51200
v_mfma_f32_16x16x32_bf16 v[64:67], a[172:175], v[32:35], v[64:67]
s_waitcnt lgkmcnt(4)
v_mfma_f32_16x16x32_bf16 v[52:55], a[176:179], v[36:39], v[52:55]
ds_read_b128 v[28:31], v9 offset:49152
v_mfma_f32_16x16x32_bf16 v[56:59], a[180:183], v[36:39], v[56:59]
s_add_u32 s53, s42, 3
s_min_u32 s53, s53, 63
s_lshl_b32 s53, s53, 16
s_mov_b64 exec, 0xffff
buffer_load_dword v250, v19, s[8:11], s53 offen
s_mov_b64 exec, -1
v_mfma_f32_16x16x32_bf16 v[60:63], a[176:179], v[40:43], v[60:63]
ds_read_b128 v[32:35], v9 offset:51200
v_mfma_f32_16x16x32_bf16 v[64:67], a[180:183], v[40:43], v[64:67]
s_waitcnt lgkmcnt(4)
v_mfma_f32_16x16x32_bf16 v[52:55], a[184:187], v[44:47], v[52:55]
ds_read_b128 v[36:39], v8 offset:53248
v_mfma_f32_16x16x32_bf16 v[56:59], a[188:191], v[44:47], v[56:59]
v_mfma_f32_16x16x32_bf16 v[60:63], a[184:187], v[48:51], v[60:63]
ds_read_b128 v[40:43], v8 offset:55296
v_mfma_f32_16x16x32_bf16 v[64:67], a[188:191], v[48:51], v[64:67]
s_waitcnt lgkmcnt(4)
v_mfma_f32_16x16x32_bf16 v[52:55], a[192:195], v[20:23], v[52:55]
ds_read_b128 v[44:47], v9 offset:53248
v_mfma_f32_16x16x32_bf16 v[56:59], a[196:199], v[20:23], v[56:59]
v_mfma_f32_16x16x32_bf16 v[60:63], a[192:195], v[24:27], v[60:63]
ds_read_b128 v[48:51], v9 offset:55296
v_mfma_f32_16x16x32_bf16 v[64:67], a[196:199], v[24:27], v[64:67]
s_waitcnt lgkmcnt(4)
v_mfma_f32_16x16x32_bf16 v[52:55], a[200:203], v[28:31], v[52:55]
ds_read_b128 v[20:23], v8 offset:57344
v_mfma_f32_16x16x32_bf16 v[56:59], a[204:207], v[28:31], v[56:59]
v_mfma_f32_16x16x32_bf16 v[60:63], a[200:203], v[32:35], v[60:63]
ds_read_b128 v[24:27], v8 offset:59392
v_mfma_f32_16x16x32_bf16 v[64:67], a[204:207], v[32:35], v[64:67]
s_waitcnt lgkmcnt(4)
v_mfma_f32_16x16x32_bf16 v[52:55], a[208:211], v[36:39], v[52:55]
ds_read_b128 v[28:31], v9 offset:57344
v_mfma_f32_16x16x32_bf16 v[56:59], a[212:215], v[36:39], v[56:59]
v_mfma_f32_16x16x32_bf16 v[60:63], a[208:211], v[40:43], v[60:63]
ds_read_b128 v[32:35], v9 offset:59392
v_mfma_f32_16x16x32_bf16 v[64:67], a[212:215], v[40:43], v[64:67]
s_waitcnt lgkmcnt(4)
v_mfma_f32_16x16x32_bf16 v[52:55], a[216:219], v[44:47], v[52:55]
ds_read_b128 v[36:39], v8 offset:61440
v_mfma_f32_16x16x32_bf16 v[56:59], a[220:223], v[44:47], v[56:59]
v_mfma_f32_16x16x32_bf16 v[60:63], a[216:219], v[48:51], v[60:63]
ds_read_b128 v[40:43], v8 offset:63488
v_mfma_f32_16x16x32_bf16 v[64:67], a[220:223], v[48:51], v[64:67]
s_waitcnt lgkmcnt(4)
v_mfma_f32_16x16x32_bf16 v[52:55], a[224:227], v[20:23], v[52:55]
ds_read_b128 v[44:47], v9 offset:61440
v_mfma_f32_16x16x32_bf16 v[56:59], a[228:231], v[20:23], v[56:59]
v_mfma_f32_16x16x32_bf16 v[60:63], a[224:227], v[24:27], v[60:63]
ds_read_b128 v[48:51], v9 offset:63488
v_mfma_f32_16x16x32_bf16 v[64:67], a[228:231], v[24:27], v[64:67]
s_waitcnt lgkmcnt(5)
v_mfma_f32_16x16x32_bf16 v[52:55], a[232:235], v[28:31], v[52:55]
v_mfma_f32_16x16x32_bf16 v[56:59], a[236:239], v[28:31], v[56:59]
s_waitcnt lgkmcnt(4)
v_mfma_f32_16x16x32_bf16 v[60:63], a[232:235], v[32:35], v[60:63]
v_mfma_f32_16x16x32_bf16 v[64:67], a[236:239], v[32:35], v[64:67]
s_waitcnt lgkmcnt(3)
v_mfma_f32_16x16x32_bf16 v[52:55], a[240:243], v[36:39], v[52:55]
v_mfma_f32_16x16x32_bf16 v[56:59], a[244:247], v[36:39], v[56:59]
s_waitcnt lgkmcnt(2)
v_mfma_f32_16x16x32_bf16 v[60:63], a[240:243], v[40:43], v[60:63]
v_mfma_f32_16x16x32_bf16 v[64:67], a[244:247], v[40:43], v[64:67]
s_waitcnt lgkmcnt(1)
v_mfma_f32_16x16x32_bf16 v[52:55], a[248:251], v[44:47], v[52:55]
v_mfma_f32_16x16x32_bf16 v[56:59], a[252:255], v[44:47], v[56:59]
s_waitcnt lgkmcnt(0)
v_mfma_f32_16x16x32_bf16 v[60:63], a[248:251], v[48:51], v[60:63]
v_mfma_f32_16x16x32_bf16 v[64:67], a[252:255], v[48:51], v[64:67]
s_add_u32 s42, s42, 1
s_branch mega_kernel_k_loop
mega_kernel_k_fin:
s_nop 11
v_cvt_pk_bf16_f32 v84, v68, v69
v_cvt_pk_bf16_f32 v85, v70, v71
v_cvt_pk_bf16_f32 v86, v72, v73
v_cvt_pk_bf16_f32 v87, v74, v75
v_cvt_pk_bf16_f32 v88, v76, v77
v_cvt_pk_bf16_f32 v89, v78, v79
v_cvt_pk_bf16_f32 v90, v80, v81
v_cvt_pk_bf16_f32 v91, v82, v83
s_add_u32 s51, s42, s47
s_sub_u32 s51, s51, 1
s_bfe_u32 s52, s51, 0x40002
s_lshl_b32 s52, s52, 14
s_and_b32 s51, s51, 3
s_lshl_b32 s51, s51, 11
s_add_u32 s51, s51, s52
s_add_u32 s51, s51, s48
buffer_store_dwordx4 v[84:87], v7, s[84:87], s51 offen sc1
buffer_store_dwordx4 v[88:91], v7, s[84:87], s51 offen offset:1024 sc1
s_waitcnt vmcnt(0)
v_mov_b32 v17, s42
s_mov_b64 exec, 1
buffer_store_dword v17, v16, s[84:87], s49 offen sc1
s_mov_b64 exec, -1
s_waitcnt vmcnt(0)
s_barrier
s_branch mega_kernel_fft
mega_kernel_rv:
s_load_dwordx2 s[4:5], s[0:1], 32
s_load_dwordx2 s[8:9], s[0:1], 0
v_lshrrev_b32 v2, 6, v0
v_and_b32 v1, 63, v0
v_readfirstlane_b32 s41, v2
v_lshlrev_b32 v5, 4, v1
s_waitcnt lgkmcnt(0)
s_mov_b32 s6, 8388608
s_mov_b32 s7, 0x00020000
s_mov_b32 s10, 4194304
s_mov_b32 s11, 0x00020000
s_lshl_b32 s43, s40, 8
s_lshl_b32 s44, s41, 6
s_add_u32 s48, s43, s44
s_and_b32 s43, s48, 0x7ff
v_add_u32 v19, s43, v1
v_lshlrev_b32 v19, 7, v19
s_mov_b32 s43, 131072
buffer_load_dword v250, v19, s[8:11], s43 offen
s_nop 0
v_lshrrev_b32 v2, 3, v1
s_lshl_b32 s43, s41, 3
v_add_u32 v2, s43, v2
v_bfe_u32 v3, v2, 1, 3
v_and_b32 v4, 7, v1
v_xor_b32 v3, v3, v4
v_lshlrev_b32 v6, 11, v2
v_lshl_add_u32 v6, v3, 4, v6
s_lshl_b32 s46, s41, 10
v_and_b32 v2, 15, v1
v_bfe_u32 v3, v2, 1, 3
v_lshrrev_b32 v4, 4, v1
v_xor_b32 v3, v3, v4
v_lshlrev_b32 v8, 7, v2
v_lshl_add_u32 v8, v3, 4, v8
v_xor_b32 v9, 64, v8
v_add_u32 v10, 0x10000, v8
v_add_u32 v11, 0x10000, v9
v_mov_b32 v7, v5
s_lshl_b32 s47, s40, 2
s_add_u32 s47, s47, s41
s_mov_b32 s42, 0
s_mov_b32 s50, 0
s_add_u32 m0, s46, 0
s_nop 0
buffer_load_dwordx4 v6, s[8:11], s50 offen offset:0 lds
s_add_u32 m0, s46, 3968
s_nop 0
buffer_load_dwordx4 v6, s[8:11], s50 offen offset:128 lds
s_add_u32 m0, s46, 7936
s_nop 0
buffer_load_dwordx4 v6, s[8:11], s50 offen offset:256 lds
s_add_u32 m0, s46, 11904
s_nop 0
buffer_load_dwordx4 v6, s[8:11], s50 offen offset:384 lds
s_add_u32 m0, s46, 15872
s_nop 0
buffer_load_dwordx4 v6, s[8:11], s50 offen offset:512 lds
s_add_u32 m0, s46, 19840
s_nop 0
buffer_load_dwordx4 v6, s[8:11], s50 offen offset:640 lds
s_add_u32 m0, s46, 23808
s_nop 0
buffer_load_dwordx4 v6, s[8:11], s50 offen offset:768 lds
s_add_u32 m0, s46, 27776
s_nop 0
buffer_load_dwordx4 v6, s[8:11], s50 offen offset:896 lds
s_add_u32 m0, s46, 31744
s_nop 0
buffer_load_dwordx4 v6, s[8:11], s50 offen offset:1024 lds
s_add_u32 m0, s46, 35712
s_nop 0
buffer_load_dwordx4 v6, s[8:11], s50 offen offset:1152 lds
s_add_u32 m0, s46, 39680
s_nop 0
buffer_load_dwordx4 v6, s[8:11], s50 offen offset:1280 lds
s_add_u32 m0, s46, 43648
s_nop 0
buffer_load_dwordx4 v6, s[8:11], s50 offen offset:1408 lds
s_add_u32 m0, s46, 47616
s_nop 0
buffer_load_dwordx4 v6, s[8:11], s50 offen offset:1536 lds
s_add_u32 m0, s46, 51584
s_nop 0
buffer_load_dwordx4 v6, s[8:11], s50 offen offset:1664 lds
s_add_u32 m0, s46, 55552
s_nop 0
buffer_load_dwordx4 v6, s[8:11], s50 offen offset:1792 lds
s_add_u32 m0, s46, 59520
s_nop 0
buffer_load_dwordx4 v6, s[8:11], s50 offen offset:1920 lds
s_mov_b32 s50, 0x10000
s_add_u32 m0, s46, 65536
s_nop 0
buffer_load_dwordx4 v6, s[8:11], s50 offen offset:0 lds
s_add_u32 m0, s46, 69504
s_nop 0
buffer_load_dwordx4 v6, s[8:11], s50 offen offset:128 lds
s_add_u32 m0, s46, 73472
s_nop 0
buffer_load_dwordx4 v6, s[8:11], s50 offen offset:256 lds
s_add_u32 m0, s46, 77440
s_nop 0
buffer_load_dwordx4 v6, s[8:11], s50 offen offset:384 lds
s_add_u32 m0, s46, 81408
s_nop 0
buffer_load_dwordx4 v6, s[8:11], s50 offen offset:512 lds
s_add_u32 m0, s46, 85376
s_nop 0
buffer_load_dwordx4 v6, s[8:11], s50 offen offset:640 lds
s_add_u32 m0, s46, 89344
s_nop 0
buffer_load_dwordx4 v6, s[8:11], s50 offen offset:768 lds
s_add_u32 m0, s46, 93312
s_nop 0
buffer_load_dwordx4 v6, s[8:11], s50 offen offset:896 lds
s_add_u32 m0, s46, 97280
s_nop 0
buffer_load_dwordx4 v6, s[8:11], s50 offen offset:1024 lds
s_add_u32 m0, s46, 101248
s_nop 0
buffer_load_dwordx4 v6, s[8:11], s50 offen offset:1152 lds
s_add_u32 m0, s46, 105216
s_nop 0
buffer_load_dwordx4 v6, s[8:11], s50 offen offset:1280 lds
s_add_u32 m0, s46, 109184
s_nop 0
buffer_load_dwordx4 v6, s[8:11], s50 offen offset:1408 lds
s_add_u32 m0, s46, 113152
s_nop 0
buffer_load_dwordx4 v6, s[8:11], s50 offen offset:1536 lds
s_add_u32 m0, s46, 117120
s_nop 0
buffer_load_dwordx4 v6, s[8:11], s50 offen offset:1664 lds
s_add_u32 m0, s46, 121088
s_nop 0
buffer_load_dwordx4 v6, s[8:11], s50 offen offset:1792 lds
s_add_u32 m0, s46, 125056
s_nop 0
buffer_load_dwordx4 v6, s[8:11], s50 offen offset:1920 lds
v_lshrrev_b32 v2, 2, v1
v_and_b32 v3, 3, v1
v_lshlrev_b32 v16, 13, v2
v_lshl_add_u32 v16, v3, 4, v16
v_add_u32 v16, s48, v16
s_mul_i32 s45, s41, 8192
s_add_u32 s45, s45, 131072
v_bfe_u32 v17, v1, 2, 2
v_lshrrev_b32 v18, 4, v1
v_lshl_add_u32 v17, v18, 3, v17
v_lshlrev_b32 v17, 6, v17
v_lshl_add_u32 v17, v3, 3, v17
v_add_u32 v17, s45, v17
s_and_b32 s43, s40, 3
s_lshl_b32 s43, s43, 2
s_add_u32 s43, s43, s41
s_lshl_b32 s43, s43, 3
v_and_b32 v12, 7, v1
v_add_u32 v12, s43, v12
s_lshr_b32 s43, s40, 2
s_lshl_b32 s43, s43, 10
s_add_u32 s44, s43, 896
s_add_u32 s43, s43, 384
s_cmp_ge_u32 s40, 28
s_cselect_b32 s44, s44, s43
v_mov_b32 v13, s43
v_mov_b32 v14, s44
v_cmp_gt_u32 vcc, 32, v1
s_nop 1
v_cndmask_b32 v13, v14, v13, vcc
v_lshl_add_u32 v12, v12, 13, v13
s_mov_b32 s44, 0
buffer_load_dword v250, v12, s[4:7], s44 offen
s_add_u32 m0, s45, 0
s_mov_b32 s44, 0
buffer_load_dwordx4 v16, s[4:7], s44 offen lds
s_add_u32 m0, s45, 1024
s_mov_b32 s44, 131072
buffer_load_dwordx4 v16, s[4:7], s44 offen lds
s_add_u32 m0, s45, 2048
s_mov_b32 s44, 262144
buffer_load_dwordx4 v16, s[4:7], s44 offen lds
s_add_u32 m0, s45, 3072
s_mov_b32 s44, 393216
buffer_load_dwordx4 v16, s[4:7], s44 offen lds
s_add_u32 m0, s45, 4096
s_mov_b32 s44, 524288
buffer_load_dwordx4 v16, s[4:7], s44 offen lds
s_add_u32 m0, s45, 5120
s_mov_b32 s44, 655360
buffer_load_dwordx4 v16, s[4:7], s44 offen lds
s_add_u32 m0, s45, 6144
s_mov_b32 s44, 786432
buffer_load_dwordx4 v16, s[4:7], s44 offen lds
s_add_u32 m0, s45, 7168
s_mov_b32 s44, 917504
buffer_load_dwordx4 v16, s[4:7], s44 offen lds
s_waitcnt vmcnt(4)
s_barrier
ds_read_b64_tr_b16 a[0:1], v17 offset:0
ds_read_b64_tr_b16 a[2:3], v17 offset:256
ds_read_b64_tr_b16 a[4:5], v17 offset:32
ds_read_b64_tr_b16 a[6:7], v17 offset:288
ds_read_b64_tr_b16 a[8:9], v17 offset:2048
ds_read_b64_tr_b16 a[10:11], v17 offset:2304
ds_read_b64_tr_b16 a[12:13], v17 offset:2080
ds_read_b64_tr_b16 a[14:15], v17 offset:2336
s_waitcnt lgkmcnt(0)
s_mov_b32 s44, 1048576
buffer_load_dword v250, v12, s[4:7], s44 offen
s_add_u32 m0, s45, 0
s_mov_b32 s44, 1048576
buffer_load_dwordx4 v16, s[4:7], s44 offen lds
s_add_u32 m0, s45, 1024
s_mov_b32 s44, 1179648
buffer_load_dwordx4 v16, s[4:7], s44 offen lds
s_add_u32 m0, s45, 2048
s_mov_b32 s44, 1310720
buffer_load_dwordx4 v16, s[4:7], s44 offen lds
s_add_u32 m0, s45, 3072
s_mov_b32 s44, 1441792
buffer_load_dwordx4 v16, s[4:7], s44 offen lds
ds_read_b128 v[20:23], v8 offset:0
ds_read_b128 v[24:27], v8 offset:2048
ds_read_b128 v[28:31], v9 offset:0
ds_read_b128 v[32:35], v9 offset:2048
ds_read_b128 v[36:39], v10 offset:0
ds_read_b128 v[40:43], v10 offset:2048
ds_read_b128 v[44:47], v11 offset:0
ds_read_b128 v[48:51], v11 offset:2048
s_waitcnt lgkmcnt(0)
v_mfma_f32_16x16x32_bf16 v[52:55], v[20:23], a[0:3], 0
v_mfma_f32_16x16x32_bf16 v[56:59], v[20:23], a[4:7], 0
v_mfma_f32_16x16x32_bf16 v[60:63], v[24:27], a[0:3], 0
v_mfma_f32_16x16x32_bf16 v[64:67], v[24:27], a[4:7], 0
v_mfma_f32_16x16x32_bf16 v[52:55], v[28:31], a[8:11], v[52:55]
v_mfma_f32_16x16x32_bf16 v[56:59], v[28:31], a[12:15], v[56:59]
v_mfma_f32_16x16x32_bf16 v[60:63], v[32:35], a[8:11], v[60:63]
v_mfma_f32_16x16x32_bf16 v[64:67], v[32:35], a[12:15], v[64:67]
v_mfma_f32_16x16x32_bf16 v[68:71], v[36:39], a[0:3], 0
v_mfma_f32_16x16x32_bf16 v[72:75], v[36:39], a[4:7], 0
v_mfma_f32_16x16x32_bf16 v[76:79], v[40:43], a[0:3], 0
v_mfma_f32_16x16x32_bf16 v[80:83], v[40:43], a[4:7], 0
v_mfma_f32_16x16x32_bf16 v[68:71], v[44:47], a[8:11], v[68:71]
v_mfma_f32_16x16x32_bf16 v[72:75], v[44:47], a[12:15], v[72:75]
v_mfma_f32_16x16x32_bf16 v[76:79], v[48:51], a[8:11], v[76:79]
v_mfma_f32_16x16x32_bf16 v[80:83], v[48:51], a[12:15], v[80:83]
s_waitcnt vmcnt(5)
ds_read_b64_tr_b16 a[16:17], v17 offset:4096
ds_read_b64_tr_b16 a[18:19], v17 offset:4352
ds_read_b64_tr_b16 a[20:21], v17 offset:4128
ds_read_b64_tr_b16 a[22:23], v17 offset:4384
ds_read_b64_tr_b16 a[24:25], v17 offset:6144
ds_read_b64_tr_b16 a[26:27], v17 offset:6400
ds_read_b64_tr_b16 a[28:29], v17 offset:6176
ds_read_b64_tr_b16 a[30:31], v17 offset:6432
s_waitcnt lgkmcnt(0)
s_add_u32 m0, s45, 4096
s_mov_b32 s44, 1572864
buffer_load_dwordx4 v16, s[4:7], s44 offen lds
s_add_u32 m0, s45, 5120
s_mov_b32 s44, 1703936
buffer_load_dwordx4 v16, s[4:7], s44 offen lds
s_add_u32 m0, s45, 6144
s_mov_b32 s44, 1835008
buffer_load_dwordx4 v16, s[4:7], s44 offen lds
s_add_u32 m0, s45, 7168
s_mov_b32 s44, 1966080
buffer_load_dwordx4 v16, s[4:7], s44 offen lds
ds_read_b128 v[20:23], v8 offset:4096
ds_read_b128 v[24:27], v8 offset:6144
ds_read_b128 v[28:31], v9 offset:4096
ds_read_b128 v[32:35], v9 offset:6144
ds_read_b128 v[36:39], v10 offset:4096
ds_read_b128 v[40:43], v10 offset:6144
ds_read_b128 v[44:47], v11 offset:4096
ds_read_b128 v[48:51], v11 offset:6144
s_waitcnt lgkmcnt(0)
v_mfma_f32_16x16x32_bf16 v[52:55], v[20:23], a[16:19], v[52:55]
v_mfma_f32_16x16x32_bf16 v[56:59], v[20:23], a[20:23], v[56:59]
v_mfma_f32_16x16x32_bf16 v[60:63], v[24:27], a[16:19], v[60:63]
v_mfma_f32_16x16x32_bf16 v[64:67], v[24:27], a[20:23], v[64:67]
v_mfma_f32_16x16x32_bf16 v[52:55], v[28:31], a[24:27], v[52:55]
v_mfma_f32_16x16x32_bf16 v[56:59], v[28:31], a[28:31], v[56:59]
v_mfma_f32_16x16x32_bf16 v[60:63], v[32:35], a[24:27], v[60:63]
v_mfma_f32_16x16x32_bf16 v[64:67], v[32:35], a[28:31], v[64:67]
v_mfma_f32_16x16x32_bf16 v[68:71], v[36:39], a[16:19], v[68:71]
v_mfma_f32_16x16x32_bf16 v[72:75], v[36:39], a[20:23], v[72:75]
v_mfma_f32_16x16x32_bf16 v[76:79], v[40:43], a[16:19], v[76:79]
v_mfma_f32_16x16x32_bf16 v[80:83], v[40:43], a[20:23], v[80:83]
v_mfma_f32_16x16x32_bf16 v[68:71], v[44:47], a[24:27], v[68:71]
v_mfma_f32_16x16x32_bf16 v[72:75], v[44:47], a[28:31], v[72:75]
v_mfma_f32_16x16x32_bf16 v[76:79], v[48:51], a[24:27], v[76:79]
v_mfma_f32_16x16x32_bf16 v[80:83], v[48:51], a[28:31], v[80:83]
s_waitcnt vmcnt(4)
ds_read_b64_tr_b16 a[32:33], v17 offset:0
ds_read_b64_tr_b16 a[34:35], v17 offset:256
ds_read_b64_tr_b16 a[36:37], v17 offset:32
ds_read_b64_tr_b16 a[38:39], v17 offset:288
ds_read_b64_tr_b16 a[40:41], v17 offset:2048
ds_read_b64_tr_b16 a[42:43], v17 offset:2304
ds_read_b64_tr_b16 a[44:45], v17 offset:2080
ds_read_b64_tr_b16 a[46:47], v17 offset:2336
s_waitcnt lgkmcnt(0)
s_mov_b32 s44, 2097152
buffer_load_dword v250, v12, s[4:7], s44 offen
s_add_u32 m0, s45, 0
s_mov_b32 s44, 2097152
buffer_load_dwordx4 v16, s[4:7], s44 offen lds
s_add_u32 m0, s45, 1024
s_mov_b32 s44, 2228224
buffer_load_dwordx4 v16, s[4:7], s44 offen lds
s_add_u32 m0, s45, 2048
s_mov_b32 s44, 2359296
buffer_load_dwordx4 v16, s[4:7], s44 offen lds
s_add_u32 m0, s45, 3072
s_mov_b32 s44, 2490368
buffer_load_dwordx4 v16, s[4:7], s44 offen lds
ds_read_b128 v[20:23], v8 offset:8192
ds_read_b128 v[24:27], v8 offset:10240
ds_read_b128 v[28:31], v9 offset:8192
ds_read_b128 v[32:35], v9 offset:10240
ds_read_b128 v[36:39], v10 offset:8192
ds_read_b128 v[40:43], v10 offset:10240
ds_read_b128 v[44:47], v11 offset:8192
ds_read_b128 v[48:51], v11 offset:10240
s_waitcnt lgkmcnt(0)
v_mfma_f32_16x16x32_bf16 v[52:55], v[20:23], a[32:35], v[52:55]
v_mfma_f32_16x16x32_bf16 v[56:59], v[20:23], a[36:39], v[56:59]
v_mfma_f32_16x16x32_bf16 v[60:63], v[24:27], a[32:35], v[60:63]
v_mfma_f32_16x16x32_bf16 v[64:67], v[24:27], a[36:39], v[64:67]
v_mfma_f32_16x16x32_bf16 v[52:55], v[28:31], a[40:43], v[52:55]
v_mfma_f32_16x16x32_bf16 v[56:59], v[28:31], a[44:47], v[56:59]
v_mfma_f32_16x16x32_bf16 v[60:63], v[32:35], a[40:43], v[60:63]
v_mfma_f32_16x16x32_bf16 v[64:67], v[32:35], a[44:47], v[64:67]
v_mfma_f32_16x16x32_bf16 v[68:71], v[36:39], a[32:35], v[68:71]
v_mfma_f32_16x16x32_bf16 v[72:75], v[36:39], a[36:39], v[72:75]
v_mfma_f32_16x16x32_bf16 v[76:79], v[40:43], a[32:35], v[76:79]
v_mfma_f32_16x16x32_bf16 v[80:83], v[40:43], a[36:39], v[80:83]
v_mfma_f32_16x16x32_bf16 v[68:71], v[44:47], a[40:43], v[68:71]
v_mfma_f32_16x16x32_bf16 v[72:75], v[44:47], a[44:47], v[72:75]
v_mfma_f32_16x16x32_bf16 v[76:79], v[48:51], a[40:43], v[76:79]
v_mfma_f32_16x16x32_bf16 v[80:83], v[48:51], a[44:47], v[80:83]
s_waitcnt vmcnt(5)
ds_read_b64_tr_b16 a[48:49], v17 offset:4096
ds_read_b64_tr_b16 a[50:51], v17 offset:4352
ds_read_b64_tr_b16 a[52:53], v17 offset:4128
ds_read_b64_tr_b16 a[54:55], v17 offset:4384
ds_read_b64_tr_b16 a[56:57], v17 offset:6144
ds_read_b64_tr_b16 a[58:59], v17 offset:6400
ds_read_b64_tr_b16 a[60:61], v17 offset:6176
ds_read_b64_tr_b16 a[62:63], v17 offset:6432
s_waitcnt lgkmcnt(0)
s_add_u32 m0, s45, 4096
s_mov_b32 s44, 2621440
buffer_load_dwordx4 v16, s[4:7], s44 offen lds
s_add_u32 m0, s45, 5120
s_mov_b32 s44, 2752512
buffer_load_dwordx4 v16, s[4:7], s44 offen lds
s_add_u32 m0, s45, 6144
s_mov_b32 s44, 2883584
buffer_load_dwordx4 v16, s[4:7], s44 offen lds
s_add_u32 m0, s45, 7168
s_mov_b32 s44, 3014656
buffer_load_dwordx4 v16, s[4:7], s44 offen lds
ds_read_b128 v[20:23], v8 offset:12288
ds_read_b128 v[24:27], v8 offset:14336
ds_read_b128 v[28:31], v9 offset:12288
ds_read_b128 v[32:35], v9 offset:14336
ds_read_b128 v[36:39], v10 offset:12288
ds_read_b128 v[40:43], v10 offset:14336
ds_read_b128 v[44:47], v11 offset:12288
ds_read_b128 v[48:51], v11 offset:14336
s_waitcnt lgkmcnt(0)
v_mfma_f32_16x16x32_bf16 v[52:55], v[20:23], a[48:51], v[52:55]
v_mfma_f32_16x16x32_bf16 v[56:59], v[20:23], a[52:55], v[56:59]
v_mfma_f32_16x16x32_bf16 v[60:63], v[24:27], a[48:51], v[60:63]
v_mfma_f32_16x16x32_bf16 v[64:67], v[24:27], a[52:55], v[64:67]
v_mfma_f32_16x16x32_bf16 v[52:55], v[28:31], a[56:59], v[52:55]
v_mfma_f32_16x16x32_bf16 v[56:59], v[28:31], a[60:63], v[56:59]
v_mfma_f32_16x16x32_bf16 v[60:63], v[32:35], a[56:59], v[60:63]
v_mfma_f32_16x16x32_bf16 v[64:67], v[32:35], a[60:63], v[64:67]
v_mfma_f32_16x16x32_bf16 v[68:71], v[36:39], a[48:51], v[68:71]
v_mfma_f32_16x16x32_bf16 v[72:75], v[36:39], a[52:55], v[72:75]
v_mfma_f32_16x16x32_bf16 v[76:79], v[40:43], a[48:51], v[76:79]
v_mfma_f32_16x16x32_bf16 v[80:83], v[40:43], a[52:55], v[80:83]
v_mfma_f32_16x16x32_bf16 v[68:71], v[44:47], a[56:59], v[68:71]
v_mfma_f32_16x16x32_bf16 v[72:75], v[44:47], a[60:63], v[72:75]
v_mfma_f32_16x16x32_bf16 v[76:79], v[48:51], a[56:59], v[76:79]
v_mfma_f32_16x16x32_bf16 v[80:83], v[48:51], a[60:63], v[80:83]
s_waitcnt vmcnt(4)
ds_read_b64_tr_b16 a[64:65], v17 offset:0
ds_read_b64_tr_b16 a[66:67], v17 offset:256
ds_read_b64_tr_b16 a[68:69], v17 offset:32
ds_read_b64_tr_b16 a[70:71], v17 offset:288
ds_read_b64_tr_b16 a[72:73], v17 offset:2048
ds_read_b64_tr_b16 a[74:75], v17 offset:2304
ds_read_b64_tr_b16 a[76:77], v17 offset:2080
ds_read_b64_tr_b16 a[78:79], v17 offset:2336
s_waitcnt lgkmcnt(0)
s_mov_b32 s44, 3145728
buffer_load_dword v250, v12, s[4:7], s44 offen
s_add_u32 m0, s45, 0
s_mov_b32 s44, 3145728
buffer_load_dwordx4 v16, s[4:7], s44 offen lds
s_add_u32 m0, s45, 1024
s_mov_b32 s44, 3276800
buffer_load_dwordx4 v16, s[4:7], s44 offen lds
s_add_u32 m0, s45, 2048
s_mov_b32 s44, 3407872
buffer_load_dwordx4 v16, s[4:7], s44 offen lds
s_add_u32 m0, s45, 3072
s_mov_b32 s44, 3538944
buffer_load_dwordx4 v16, s[4:7], s44 offen lds
ds_read_b128 v[20:23], v8 offset:16384
ds_read_b128 v[24:27], v8 offset:18432
ds_read_b128 v[28:31], v9 offset:16384
ds_read_b128 v[32:35], v9 offset:18432
ds_read_b128 v[36:39], v10 offset:16384
ds_read_b128 v[40:43], v10 offset:18432
ds_read_b128 v[44:47], v11 offset:16384
ds_read_b128 v[48:51], v11 offset:18432
s_waitcnt lgkmcnt(0)
v_mfma_f32_16x16x32_bf16 v[52:55], v[20:23], a[64:67], v[52:55]
v_mfma_f32_16x16x32_bf16 v[56:59], v[20:23], a[68:71], v[56:59]
v_mfma_f32_16x16x32_bf16 v[60:63], v[24:27], a[64:67], v[60:63]
v_mfma_f32_16x16x32_bf16 v[64:67], v[24:27], a[68:71], v[64:67]
v_mfma_f32_16x16x32_bf16 v[52:55], v[28:31], a[72:75], v[52:55]
v_mfma_f32_16x16x32_bf16 v[56:59], v[28:31], a[76:79], v[56:59]
v_mfma_f32_16x16x32_bf16 v[60:63], v[32:35], a[72:75], v[60:63]
v_mfma_f32_16x16x32_bf16 v[64:67], v[32:35], a[76:79], v[64:67]
v_mfma_f32_16x16x32_bf16 v[68:71], v[36:39], a[64:67], v[68:71]
v_mfma_f32_16x16x32_bf16 v[72:75], v[36:39], a[68:71], v[72:75]
v_mfma_f32_16x16x32_bf16 v[76:79], v[40:43], a[64:67], v[76:79]
v_mfma_f32_16x16x32_bf16 v[80:83], v[40:43], a[68:71], v[80:83]
v_mfma_f32_16x16x32_bf16 v[68:71], v[44:47], a[72:75], v[68:71]
v_mfma_f32_16x16x32_bf16 v[72:75], v[44:47], a[76:79], v[72:75]
v_mfma_f32_16x16x32_bf16 v[76:79], v[48:51], a[72:75], v[76:79]
v_mfma_f32_16x16x32_bf16 v[80:83], v[48:51], a[76:79], v[80:83]
s_waitcnt vmcnt(5)
ds_read_b64_tr_b16 a[80:81], v17 offset:4096
ds_read_b64_tr_b16 a[82:83], v17 offset:4352
ds_read_b64_tr_b16 a[84:85], v17 offset:4128
ds_read_b64_tr_b16 a[86:87], v17 offset:4384
ds_read_b64_tr_b16 a[88:89], v17 offset:6144
ds_read_b64_tr_b16 a[90:91], v17 offset:6400
ds_read_b64_tr_b16 a[92:93], v17 offset:6176
ds_read_b64_tr_b16 a[94:95], v17 offset:6432
s_waitcnt lgkmcnt(0)
s_add_u32 m0, s45, 4096
s_mov_b32 s44, 3670016
buffer_load_dwordx4 v16, s[4:7], s44 offen lds
s_add_u32 m0, s45, 5120
s_mov_b32 s44, 3801088
buffer_load_dwordx4 v16, s[4:7], s44 offen lds
s_add_u32 m0, s45, 6144
s_mov_b32 s44, 3932160
buffer_load_dwordx4 v16, s[4:7], s44 offen lds
s_add_u32 m0, s45, 7168
s_mov_b32 s44, 4063232
buffer_load_dwordx4 v16, s[4:7], s44 offen lds
ds_read_b128 v[20:23], v8 offset:20480
ds_read_b128 v[24:27], v8 offset:22528
ds_read_b128 v[28:31], v9 offset:20480
ds_read_b128 v[32:35], v9 offset:22528
ds_read_b128 v[36:39], v10 offset:20480
ds_read_b128 v[40:43], v10 offset:22528
ds_read_b128 v[44:47], v11 offset:20480
ds_read_b128 v[48:51], v11 offset:22528
s_waitcnt lgkmcnt(0)
v_mfma_f32_16x16x32_bf16 v[52:55], v[20:23], a[80:83], v[52:55]
v_mfma_f32_16x16x32_bf16 v[56:59], v[20:23], a[84:87], v[56:59]
v_mfma_f32_16x16x32_bf16 v[60:63], v[24:27], a[80:83], v[60:63]
v_mfma_f32_16x16x32_bf16 v[64:67], v[24:27], a[84:87], v[64:67]
v_mfma_f32_16x16x32_bf16 v[52:55], v[28:31], a[88:91], v[52:55]
v_mfma_f32_16x16x32_bf16 v[56:59], v[28:31], a[92:95], v[56:59]
v_mfma_f32_16x16x32_bf16 v[60:63], v[32:35], a[88:91], v[60:63]
v_mfma_f32_16x16x32_bf16 v[64:67], v[32:35], a[92:95], v[64:67]
v_mfma_f32_16x16x32_bf16 v[68:71], v[36:39], a[80:83], v[68:71]
v_mfma_f32_16x16x32_bf16 v[72:75], v[36:39], a[84:87], v[72:75]
v_mfma_f32_16x16x32_bf16 v[76:79], v[40:43], a[80:83], v[76:79]
v_mfma_f32_16x16x32_bf16 v[80:83], v[40:43], a[84:87], v[80:83]
v_mfma_f32_16x16x32_bf16 v[68:71], v[44:47], a[88:91], v[68:71]
v_mfma_f32_16x16x32_bf16 v[72:75], v[44:47], a[92:95], v[72:75]
v_mfma_f32_16x16x32_bf16 v[76:79], v[48:51], a[88:91], v[76:79]
v_mfma_f32_16x16x32_bf16 v[80:83], v[48:51], a[92:95], v[80:83]
s_waitcnt vmcnt(4)
ds_read_b64_tr_b16 a[96:97], v17 offset:0
ds_read_b64_tr_b16 a[98:99], v17 offset:256
ds_read_b64_tr_b16 a[100:101], v17 offset:32
ds_read_b64_tr_b16 a[102:103], v17 offset:288
ds_read_b64_tr_b16 a[104:105], v17 offset:2048
ds_read_b64_tr_b16 a[106:107], v17 offset:2304
ds_read_b64_tr_b16 a[108:109], v17 offset:2080
ds_read_b64_tr_b16 a[110:111], v17 offset:2336
s_waitcnt lgkmcnt(0)
s_mov_b32 s44, 4194304
buffer_load_dword v250, v12, s[4:7], s44 offen
s_add_u32 m0, s45, 0
s_mov_b32 s44, 4194304
buffer_load_dwordx4 v16, s[4:7], s44 offen lds
s_add_u32 m0, s45, 1024
s_mov_b32 s44, 4325376
buffer_load_dwordx4 v16, s[4:7], s44 offen lds
s_add_u32 m0, s45, 2048
s_mov_b32 s44, 4456448
buffer_load_dwordx4 v16, s[4:7], s44 offen lds
s_add_u32 m0, s45, 3072
s_mov_b32 s44, 4587520
buffer_load_dwordx4 v16, s[4:7], s44 offen lds
ds_read_b128 v[20:23], v8 offset:24576
ds_read_b128 v[24:27], v8 offset:26624
ds_read_b128 v[28:31], v9 offset:24576
ds_read_b128 v[32:35], v9 offset:26624
ds_read_b128 v[36:39], v10 offset:24576
ds_read_b128 v[40:43], v10 offset:26624
ds_read_b128 v[44:47], v11 offset:24576
ds_read_b128 v[48:51], v11 offset:26624
s_waitcnt lgkmcnt(0)
v_mfma_f32_16x16x32_bf16 v[52:55], v[20:23], a[96:99], v[52:55]
v_mfma_f32_16x16x32_bf16 v[56:59], v[20:23], a[100:103], v[56:59]
v_mfma_f32_16x16x32_bf16 v[60:63], v[24:27], a[96:99], v[60:63]
v_mfma_f32_16x16x32_bf16 v[64:67], v[24:27], a[100:103], v[64:67]
v_mfma_f32_16x16x32_bf16 v[52:55], v[28:31], a[104:107], v[52:55]
v_mfma_f32_16x16x32_bf16 v[56:59], v[28:31], a[108:111], v[56:59]
v_mfma_f32_16x16x32_bf16 v[60:63], v[32:35], a[104:107], v[60:63]
v_mfma_f32_16x16x32_bf16 v[64:67], v[32:35], a[108:111], v[64:67]
v_mfma_f32_16x16x32_bf16 v[68:71], v[36:39], a[96:99], v[68:71]
v_mfma_f32_16x16x32_bf16 v[72:75], v[36:39], a[100:103], v[72:75]
v_mfma_f32_16x16x32_bf16 v[76:79], v[40:43], a[96:99], v[76:79]
v_mfma_f32_16x16x32_bf16 v[80:83], v[40:43], a[100:103], v[80:83]
v_mfma_f32_16x16x32_bf16 v[68:71], v[44:47], a[104:107], v[68:71]
v_mfma_f32_16x16x32_bf16 v[72:75], v[44:47], a[108:111], v[72:75]
v_mfma_f32_16x16x32_bf16 v[76:79], v[48:51], a[104:107], v[76:79]
v_mfma_f32_16x16x32_bf16 v[80:83], v[48:51], a[108:111], v[80:83]
s_waitcnt vmcnt(5)
ds_read_b64_tr_b16 a[112:113], v17 offset:4096
ds_read_b64_tr_b16 a[114:115], v17 offset:4352
ds_read_b64_tr_b16 a[116:117], v17 offset:4128
ds_read_b64_tr_b16 a[118:119], v17 offset:4384
ds_read_b64_tr_b16 a[120:121], v17 offset:6144
ds_read_b64_tr_b16 a[122:123], v17 offset:6400
ds_read_b64_tr_b16 a[124:125], v17 offset:6176
ds_read_b64_tr_b16 a[126:127], v17 offset:6432
s_waitcnt lgkmcnt(0)
s_add_u32 m0, s45, 4096
s_mov_b32 s44, 4718592
buffer_load_dwordx4 v16, s[4:7], s44 offen lds
s_add_u32 m0, s45, 5120
s_mov_b32 s44, 4849664
buffer_load_dwordx4 v16, s[4:7], s44 offen lds
s_add_u32 m0, s45, 6144
s_mov_b32 s44, 4980736
buffer_load_dwordx4 v16, s[4:7], s44 offen lds
s_add_u32 m0, s45, 7168
s_mov_b32 s44, 5111808
buffer_load_dwordx4 v16, s[4:7], s44 offen lds
ds_read_b128 v[20:23], v8 offset:28672
ds_read_b128 v[24:27], v8 offset:30720
ds_read_b128 v[28:31], v9 offset:28672
ds_read_b128 v[32:35], v9 offset:30720
ds_read_b128 v[36:39], v10 offset:28672
ds_read_b128 v[40:43], v10 offset:30720
ds_read_b128 v[44:47], v11 offset:28672
ds_read_b128 v[48:51], v11 offset:30720
s_waitcnt lgkmcnt(0)
v_mfma_f32_16x16x32_bf16 v[52:55], v[20:23], a[112:115], v[52:55]
v_mfma_f32_16x16x32_bf16 v[56:59], v[20:23], a[116:119], v[56:59]
v_mfma_f32_16x16x32_bf16 v[60:63], v[24:27], a[112:115], v[60:63]
v_mfma_f32_16x16x32_bf16 v[64:67], v[24:27], a[116:119], v[64:67]
v_mfma_f32_16x16x32_bf16 v[52:55], v[28:31], a[120:123], v[52:55]
v_mfma_f32_16x16x32_bf16 v[56:59], v[28:31], a[124:127], v[56:59]
v_mfma_f32_16x16x32_bf16 v[60:63], v[32:35], a[120:123], v[60:63]
v_mfma_f32_16x16x32_bf16 v[64:67], v[32:35], a[124:127], v[64:67]
v_mfma_f32_16x16x32_bf16 v[68:71], v[36:39], a[112:115], v[68:71]
v_mfma_f32_16x16x32_bf16 v[72:75], v[36:39], a[116:119], v[72:75]
v_mfma_f32_16x16x32_bf16 v[76:79], v[40:43], a[112:115], v[76:79]
v_mfma_f32_16x16x32_bf16 v[80:83], v[40:43], a[116:119], v[80:83]
v_mfma_f32_16x16x32_bf16 v[68:71], v[44:47], a[120:123], v[68:71]
v_mfma_f32_16x16x32_bf16 v[72:75], v[44:47], a[124:127], v[72:75]
v_mfma_f32_16x16x32_bf16 v[76:79], v[48:51], a[120:123], v[76:79]
v_mfma_f32_16x16x32_bf16 v[80:83], v[48:51], a[124:127], v[80:83]
s_waitcnt vmcnt(4)
ds_read_b64_tr_b16 a[128:129], v17 offset:0
ds_read_b64_tr_b16 a[130:131], v17 offset:256
ds_read_b64_tr_b16 a[132:133], v17 offset:32
ds_read_b64_tr_b16 a[134:135], v17 offset:288
ds_read_b64_tr_b16 a[136:137], v17 offset:2048
ds_read_b64_tr_b16 a[138:139], v17 offset:2304
ds_read_b64_tr_b16 a[140:141], v17 offset:2080
ds_read_b64_tr_b16 a[142:143], v17 offset:2336
s_waitcnt lgkmcnt(0)
s_mov_b32 s44, 5242880
buffer_load_dword v250, v12, s[4:7], s44 offen
s_add_u32 m0, s45, 0
s_mov_b32 s44, 5242880
buffer_load_dwordx4 v16, s[4:7], s44 offen lds
s_add_u32 m0, s45, 1024
s_mov_b32 s44, 5373952
buffer_load_dwordx4 v16, s[4:7], s44 offen lds
s_add_u32 m0, s45, 2048
s_mov_b32 s44, 5505024
buffer_load_dwordx4 v16, s[4:7], s44 offen lds
s_add_u32 m0, s45, 3072
s_mov_b32 s44, 5636096
buffer_load_dwordx4 v16, s[4:7], s44 offen lds
ds_read_b128 v[20:23], v8 offset:32768
ds_read_b128 v[24:27], v8 offset:34816
ds_read_b128 v[28:31], v9 offset:32768
ds_read_b128 v[32:35], v9 offset:34816
ds_read_b128 v[36:39], v10 offset:32768
ds_read_b128 v[40:43], v10 offset:34816
ds_read_b128 v[44:47], v11 offset:32768
ds_read_b128 v[48:51], v11 offset:34816
s_waitcnt lgkmcnt(0)
v_mfma_f32_16x16x32_bf16 v[52:55], v[20:23], a[128:131], v[52:55]
v_mfma_f32_16x16x32_bf16 v[56:59], v[20:23], a[132:135], v[56:59]
v_mfma_f32_16x16x32_bf16 v[60:63], v[24:27], a[128:131], v[60:63]
v_mfma_f32_16x16x32_bf16 v[64:67], v[24:27], a[132:135], v[64:67]
v_mfma_f32_16x16x32_bf16 v[52:55], v[28:31], a[136:139], v[52:55]
v_mfma_f32_16x16x32_bf16 v[56:59], v[28:31], a[140:143], v[56:59]
v_mfma_f32_16x16x32_bf16 v[60:63], v[32:35], a[136:139], v[60:63]
v_mfma_f32_16x16x32_bf16 v[64:67], v[32:35], a[140:143], v[64:67]
v_mfma_f32_16x16x32_bf16 v[68:71], v[36:39], a[128:131], v[68:71]
v_mfma_f32_16x16x32_bf16 v[72:75], v[36:39], a[132:135], v[72:75]
v_mfma_f32_16x16x32_bf16 v[76:79], v[40:43], a[128:131], v[76:79]
v_mfma_f32_16x16x32_bf16 v[80:83], v[40:43], a[132:135], v[80:83]
v_mfma_f32_16x16x32_bf16 v[68:71], v[44:47], a[136:139], v[68:71]
v_mfma_f32_16x16x32_bf16 v[72:75], v[44:47], a[140:143], v[72:75]
v_mfma_f32_16x16x32_bf16 v[76:79], v[48:51], a[136:139], v[76:79]
v_mfma_f32_16x16x32_bf16 v[80:83], v[48:51], a[140:143], v[80:83]
s_waitcnt vmcnt(5)
ds_read_b64_tr_b16 a[144:145], v17 offset:4096
ds_read_b64_tr_b16 a[146:147], v17 offset:4352
ds_read_b64_tr_b16 a[148:149], v17 offset:4128
ds_read_b64_tr_b16 a[150:151], v17 offset:4384
ds_read_b64_tr_b16 a[152:153], v17 offset:6144
ds_read_b64_tr_b16 a[154:155], v17 offset:6400
ds_read_b64_tr_b16 a[156:157], v17 offset:6176
ds_read_b64_tr_b16 a[158:159], v17 offset:6432
s_waitcnt lgkmcnt(0)
s_add_u32 m0, s45, 4096
s_mov_b32 s44, 5767168
buffer_load_dwordx4 v16, s[4:7], s44 offen lds
s_add_u32 m0, s45, 5120
s_mov_b32 s44, 5898240
buffer_load_dwordx4 v16, s[4:7], s44 offen lds
s_add_u32 m0, s45, 6144
s_mov_b32 s44, 6029312
buffer_load_dwordx4 v16, s[4:7], s44 offen lds
s_add_u32 m0, s45, 7168
s_mov_b32 s44, 6160384
buffer_load_dwordx4 v16, s[4:7], s44 offen lds
ds_read_b128 v[20:23], v8 offset:36864
ds_read_b128 v[24:27], v8 offset:38912
ds_read_b128 v[28:31], v9 offset:36864
ds_read_b128 v[32:35], v9 offset:38912
ds_read_b128 v[36:39], v10 offset:36864
ds_read_b128 v[40:43], v10 offset:38912
ds_read_b128 v[44:47], v11 offset:36864
ds_read_b128 v[48:51], v11 offset:38912
s_waitcnt lgkmcnt(0)
v_mfma_f32_16x16x32_bf16 v[52:55], v[20:23], a[144:147], v[52:55]
v_mfma_f32_16x16x32_bf16 v[56:59], v[20:23], a[148:151], v[56:59]
v_mfma_f32_16x16x32_bf16 v[60:63], v[24:27], a[144:147], v[60:63]
v_mfma_f32_16x16x32_bf16 v[64:67], v[24:27], a[148:151], v[64:67]
v_mfma_f32_16x16x32_bf16 v[52:55], v[28:31], a[152:155], v[52:55]
v_mfma_f32_16x16x32_bf16 v[56:59], v[28:31], a[156:159], v[56:59]
v_mfma_f32_16x16x32_bf16 v[60:63], v[32:35], a[152:155], v[60:63]
v_mfma_f32_16x16x32_bf16 v[64:67], v[32:35], a[156:159], v[64:67]
v_mfma_f32_16x16x32_bf16 v[68:71], v[36:39], a[144:147], v[68:71]
v_mfma_f32_16x16x32_bf16 v[72:75], v[36:39], a[148:151], v[72:75]
v_mfma_f32_16x16x32_bf16 v[76:79], v[40:43], a[144:147], v[76:79]
v_mfma_f32_16x16x32_bf16 v[80:83], v[40:43], a[148:151], v[80:83]
v_mfma_f32_16x16x32_bf16 v[68:71], v[44:47], a[152:155], v[68:71]
v_mfma_f32_16x16x32_bf16 v[72:75], v[44:47], a[156:159], v[72:75]
v_mfma_f32_16x16x32_bf16 v[76:79], v[48:51], a[152:155], v[76:79]
v_mfma_f32_16x16x32_bf16 v[80:83], v[48:51], a[156:159], v[80:83]
s_waitcnt vmcnt(4)
ds_read_b64_tr_b16 a[160:161], v17 offset:0
ds_read_b64_tr_b16 a[162:163], v17 offset:256
ds_read_b64_tr_b16 a[164:165], v17 offset:32
ds_read_b64_tr_b16 a[166:167], v17 offset:288
ds_read_b64_tr_b16 a[168:169], v17 offset:2048
ds_read_b64_tr_b16 a[170:171], v17 offset:2304
ds_read_b64_tr_b16 a[172:173], v17 offset:2080
ds_read_b64_tr_b16 a[174:175], v17 offset:2336
s_waitcnt lgkmcnt(0)
s_mov_b32 s44, 6291456
buffer_load_dword v250, v12, s[4:7], s44 offen
s_add_u32 m0, s45, 0
s_mov_b32 s44, 6291456
buffer_load_dwordx4 v16, s[4:7], s44 offen lds
s_add_u32 m0, s45, 1024
s_mov_b32 s44, 6422528
buffer_load_dwordx4 v16, s[4:7], s44 offen lds
s_add_u32 m0, s45, 2048
s_mov_b32 s44, 6553600
buffer_load_dwordx4 v16, s[4:7], s44 offen lds
s_add_u32 m0, s45, 3072
s_mov_b32 s44, 6684672
buffer_load_dwordx4 v16, s[4:7], s44 offen lds
ds_read_b128 v[20:23], v8 offset:40960
ds_read_b128 v[24:27], v8 offset:43008
ds_read_b128 v[28:31], v9 offset:40960
ds_read_b128 v[32:35], v9 offset:43008
ds_read_b128 v[36:39], v10 offset:40960
ds_read_b128 v[40:43], v10 offset:43008
ds_read_b128 v[44:47], v11 offset:40960
ds_read_b128 v[48:51], v11 offset:43008
s_waitcnt lgkmcnt(0)
v_mfma_f32_16x16x32_bf16 v[52:55], v[20:23], a[160:163], v[52:55]
v_mfma_f32_16x16x32_bf16 v[56:59], v[20:23], a[164:167], v[56:59]
v_mfma_f32_16x16x32_bf16 v[60:63], v[24:27], a[160:163], v[60:63]
v_mfma_f32_16x16x32_bf16 v[64:67], v[24:27], a[164:167], v[64:67]
v_mfma_f32_16x16x32_bf16 v[52:55], v[28:31], a[168:171], v[52:55]
v_mfma_f32_16x16x32_bf16 v[56:59], v[28:31], a[172:175], v[56:59]
v_mfma_f32_16x16x32_bf16 v[60:63], v[32:35], a[168:171], v[60:63]
v_mfma_f32_16x16x32_bf16 v[64:67], v[32:35], a[172:175], v[64:67]
v_mfma_f32_16x16x32_bf16 v[68:71], v[36:39], a[160:163], v[68:71]
v_mfma_f32_16x16x32_bf16 v[72:75], v[36:39], a[164:167], v[72:75]
v_mfma_f32_16x16x32_bf16 v[76:79], v[40:43], a[160:163], v[76:79]
v_mfma_f32_16x16x32_bf16 v[80:83], v[40:43], a[164:167], v[80:83]
v_mfma_f32_16x16x32_bf16 v[68:71], v[44:47], a[168:171], v[68:71]
v_mfma_f32_16x16x32_bf16 v[72:75], v[44:47], a[172:175], v[72:75]
v_mfma_f32_16x16x32_bf16 v[76:79], v[48:51], a[168:171], v[76:79]
v_mfma_f32_16x16x32_bf16 v[80:83], v[48:51], a[172:175], v[80:83]
s_waitcnt vmcnt(5)
ds_read_b64_tr_b16 a[176:177], v17 offset:4096
ds_read_b64_tr_b16 a[178:179], v17 offset:4352
ds_read_b64_tr_b16 a[180:181], v17 offset:4128
ds_read_b64_tr_b16 a[182:183], v17 offset:4384
ds_read_b64_tr_b16 a[184:185], v17 offset:6144
ds_read_b64_tr_b16 a[186:187], v17 offset:6400
ds_read_b64_tr_b16 a[188:189], v17 offset:6176
ds_read_b64_tr_b16 a[190:191], v17 offset:6432
s_waitcnt lgkmcnt(0)
s_add_u32 m0, s45, 4096
s_mov_b32 s44, 6815744
buffer_load_dwordx4 v16, s[4:7], s44 offen lds
s_add_u32 m0, s45, 5120
s_mov_b32 s44, 6946816
buffer_load_dwordx4 v16, s[4:7], s44 offen lds
s_add_u32 m0, s45, 6144
s_mov_b32 s44, 7077888
buffer_load_dwordx4 v16, s[4:7], s44 offen lds
s_add_u32 m0, s45, 7168
s_mov_b32 s44, 7208960
buffer_load_dwordx4 v16, s[4:7], s44 offen lds
ds_read_b128 v[20:23], v8 offset:45056
ds_read_b128 v[24:27], v8 offset:47104
ds_read_b128 v[28:31], v9 offset:45056
ds_read_b128 v[32:35], v9 offset:47104
ds_read_b128 v[36:39], v10 offset:45056
ds_read_b128 v[40:43], v10 offset:47104
ds_read_b128 v[44:47], v11 offset:45056
ds_read_b128 v[48:51], v11 offset:47104
s_waitcnt lgkmcnt(0)
v_mfma_f32_16x16x32_bf16 v[52:55], v[20:23], a[176:179], v[52:55]
v_mfma_f32_16x16x32_bf16 v[56:59], v[20:23], a[180:183], v[56:59]
v_mfma_f32_16x16x32_bf16 v[60:63], v[24:27], a[176:179], v[60:63]
v_mfma_f32_16x16x32_bf16 v[64:67], v[24:27], a[180:183], v[64:67]
v_mfma_f32_16x16x32_bf16 v[52:55], v[28:31], a[184:187], v[52:55]
v_mfma_f32_16x16x32_bf16 v[56:59], v[28:31], a[188:191], v[56:59]
v_mfma_f32_16x16x32_bf16 v[60:63], v[32:35], a[184:187], v[60:63]
v_mfma_f32_16x16x32_bf16 v[64:67], v[32:35], a[188:191], v[64:67]
v_mfma_f32_16x16x32_bf16 v[68:71], v[36:39], a[176:179], v[68:71]
v_mfma_f32_16x16x32_bf16 v[72:75], v[36:39], a[180:183], v[72:75]
v_mfma_f32_16x16x32_bf16 v[76:79], v[40:43], a[176:179], v[76:79]
v_mfma_f32_16x16x32_bf16 v[80:83], v[40:43], a[180:183], v[80:83]
v_mfma_f32_16x16x32_bf16 v[68:71], v[44:47], a[184:187], v[68:71]
v_mfma_f32_16x16x32_bf16 v[72:75], v[44:47], a[188:191], v[72:75]
v_mfma_f32_16x16x32_bf16 v[76:79], v[48:51], a[184:187], v[76:79]
v_mfma_f32_16x16x32_bf16 v[80:83], v[48:51], a[188:191], v[80:83]
s_waitcnt vmcnt(4)
ds_read_b64_tr_b16 a[192:193], v17 offset:0
ds_read_b64_tr_b16 a[194:195], v17 offset:256
ds_read_b64_tr_b16 a[196:197], v17 offset:32
ds_read_b64_tr_b16 a[198:199], v17 offset:288
ds_read_b64_tr_b16 a[200:201], v17 offset:2048
ds_read_b64_tr_b16 a[202:203], v17 offset:2304
ds_read_b64_tr_b16 a[204:205], v17 offset:2080
ds_read_b64_tr_b16 a[206:207], v17 offset:2336
s_waitcnt lgkmcnt(0)
s_mov_b32 s44, 7340032
buffer_load_dword v250, v12, s[4:7], s44 offen
s_add_u32 m0, s45, 0
s_mov_b32 s44, 7340032
buffer_load_dwordx4 v16, s[4:7], s44 offen lds
s_add_u32 m0, s45, 1024
s_mov_b32 s44, 7471104
buffer_load_dwordx4 v16, s[4:7], s44 offen lds
s_add_u32 m0, s45, 2048
s_mov_b32 s44, 7602176
buffer_load_dwordx4 v16, s[4:7], s44 offen lds
s_add_u32 m0, s45, 3072
s_mov_b32 s44, 7733248
buffer_load_dwordx4 v16, s[4:7], s44 offen lds
ds_read_b128 v[20:23], v8 offset:49152
ds_read_b128 v[24:27], v8 offset:51200
ds_read_b128 v[28:31], v9 offset:49152
ds_read_b128 v[32:35], v9 offset:51200
ds_read_b128 v[36:39], v10 offset:49152
ds_read_b128 v[40:43], v10 offset:51200
ds_read_b128 v[44:47], v11 offset:49152
ds_read_b128 v[48:51], v11 offset:51200
s_waitcnt lgkmcnt(0)
v_mfma_f32_16x16x32_bf16 v[52:55], v[20:23], a[192:195], v[52:55]
v_mfma_f32_16x16x32_bf16 v[56:59], v[20:23], a[196:199], v[56:59]
v_mfma_f32_16x16x32_bf16 v[60:63], v[24:27], a[192:195], v[60:63]
v_mfma_f32_16x16x32_bf16 v[64:67], v[24:27], a[196:199], v[64:67]
v_mfma_f32_16x16x32_bf16 v[52:55], v[28:31], a[200:203], v[52:55]
v_mfma_f32_16x16x32_bf16 v[56:59], v[28:31], a[204:207], v[56:59]
v_mfma_f32_16x16x32_bf16 v[60:63], v[32:35], a[200:203], v[60:63]
v_mfma_f32_16x16x32_bf16 v[64:67], v[32:35], a[204:207], v[64:67]
v_mfma_f32_16x16x32_bf16 v[68:71], v[36:39], a[192:195], v[68:71]
v_mfma_f32_16x16x32_bf16 v[72:75], v[36:39], a[196:199], v[72:75]
v_mfma_f32_16x16x32_bf16 v[76:79], v[40:43], a[192:195], v[76:79]
v_mfma_f32_16x16x32_bf16 v[80:83], v[40:43], a[196:199], v[80:83]
v_mfma_f32_16x16x32_bf16 v[68:71], v[44:47], a[200:203], v[68:71]
v_mfma_f32_16x16x32_bf16 v[72:75], v[44:47], a[204:207], v[72:75]
v_mfma_f32_16x16x32_bf16 v[76:79], v[48:51], a[200:203], v[76:79]
v_mfma_f32_16x16x32_bf16 v[80:83], v[48:51], a[204:207], v[80:83]
s_waitcnt vmcnt(5)
ds_read_b64_tr_b16 a[208:209], v17 offset:4096
ds_read_b64_tr_b16 a[210:211], v17 offset:4352
ds_read_b64_tr_b16 a[212:213], v17 offset:4128
ds_read_b64_tr_b16 a[214:215], v17 offset:4384
ds_read_b64_tr_b16 a[216:217], v17 offset:6144
ds_read_b64_tr_b16 a[218:219], v17 offset:6400
ds_read_b64_tr_b16 a[220:221], v17 offset:6176
ds_read_b64_tr_b16 a[222:223], v17 offset:6432
s_waitcnt lgkmcnt(0)
v_and_b32 v247, 15, v0
v_lshlrev_b32 v247, 4, v247
buffer_load_dword v246, v247, s[72:75], 0 offen sc1
s_add_u32 m0, s45, 4096
s_mov_b32 s44, 7864320
buffer_load_dwordx4 v16, s[4:7], s44 offen lds
s_add_u32 m0, s45, 5120
s_mov_b32 s44, 7995392
buffer_load_dwordx4 v16, s[4:7], s44 offen lds
s_add_u32 m0, s45, 6144
s_mov_b32 s44, 8126464
buffer_load_dwordx4 v16, s[4:7], s44 offen lds
s_add_u32 m0, s45, 7168
s_mov_b32 s44, 8257536
buffer_load_dwordx4 v16, s[4:7], s44 offen lds
ds_read_b128 v[20:23], v8 offset:53248
ds_read_b128 v[24:27], v8 offset:55296
ds_read_b128 v[28:31], v9 offset:53248
ds_read_b128 v[32:35], v9 offset:55296
ds_read_b128 v[36:39], v10 offset:53248
ds_read_b128 v[40:43], v10 offset:55296
ds_read_b128 v[44:47], v11 offset:53248
ds_read_b128 v[48:51], v11 offset:55296
s_waitcnt lgkmcnt(0)
v_mfma_f32_16x16x32_bf16 v[52:55], v[20:23], a[208:211], v[52:55]
v_mfma_f32_16x16x32_bf16 v[56:59], v[20:23], a[212:215], v[56:59]
v_mfma_f32_16x16x32_bf16 v[60:63], v[24:27], a[208:211], v[60:63]
v_mfma_f32_16x16x32_bf16 v[64:67], v[24:27], a[212:215], v[64:67]
v_mfma_f32_16x16x32_bf16 v[52:55], v[28:31], a[216:219], v[52:55]
v_mfma_f32_16x16x32_bf16 v[56:59], v[28:31], a[220:223], v[56:59]
v_mfma_f32_16x16x32_bf16 v[60:63], v[32:35], a[216:219], v[60:63]
v_mfma_f32_16x16x32_bf16 v[64:67], v[32:35], a[220:223], v[64:67]
v_mfma_f32_16x16x32_bf16 v[68:71], v[36:39], a[208:211], v[68:71]
v_mfma_f32_16x16x32_bf16 v[72:75], v[36:39], a[212:215], v[72:75]
v_mfma_f32_16x16x32_bf16 v[76:79], v[40:43], a[208:211], v[76:79]
v_mfma_f32_16x16x32_bf16 v[80:83], v[40:43], a[212:215], v[80:83]
v_mfma_f32_16x16x32_bf16 v[68:71], v[44:47], a[216:219], v[68:71]
v_mfma_f32_16x16x32_bf16 v[72:75], v[44:47], a[220:223], v[72:75]
v_mfma_f32_16x16x32_bf16 v[76:79], v[48:51], a[216:219], v[76:79]
v_mfma_f32_16x16x32_bf16 v[80:83], v[48:51], a[220:223], v[80:83]
s_waitcnt vmcnt(4)
ds_read_b64_tr_b16 a[224:225], v17 offset:0
ds_read_b64_tr_b16 a[226:227], v17 offset:256
ds_read_b64_tr_b16 a[228:229], v17 offset:32
ds_read_b64_tr_b16 a[230:231], v17 offset:288
ds_read_b64_tr_b16 a[232:233], v17 offset:2048
ds_read_b64_tr_b16 a[234:235], v17 offset:2304
ds_read_b64_tr_b16 a[236:237], v17 offset:2080
ds_read_b64_tr_b16 a[238:239], v17 offset:2336
s_waitcnt lgkmcnt(0)
ds_read_b128 v[20:23], v8 offset:57344
ds_read_b128 v[24:27], v8 offset:59392
ds_read_b128 v[28:31], v9 offset:57344
ds_read_b128 v[32:35], v9 offset:59392
ds_read_b128 v[36:39], v10 offset:57344
ds_read_b128 v[40:43], v10 offset:59392
ds_read_b128 v[44:47], v11 offset:57344
ds_read_b128 v[48:51], v11 offset:59392
s_waitcnt lgkmcnt(0)
v_mfma_f32_16x16x32_bf16 v[52:55], v[20:23], a[224:227], v[52:55]
v_mfma_f32_16x16x32_bf16 v[56:59], v[20:23], a[228:231], v[56:59]
v_mfma_f32_16x16x32_bf16 v[60:63], v[24:27], a[224:227], v[60:63]
v_mfma_f32_16x16x32_bf16 v[64:67], v[24:27], a[228:231], v[64:67]
v_mfma_f32_16x16x32_bf16 v[52:55], v[28:31], a[232:235], v[52:55]
v_mfma_f32_16x16x32_bf16 v[56:59], v[28:31], a[236:239], v[56:59]
v_mfma_f32_16x16x32_bf16 v[60:63], v[32:35], a[232:235], v[60:63]
v_mfma_f32_16x16x32_bf16 v[64:67], v[32:35], a[236:239], v[64:67]
v_mfma_f32_16x16x32_bf16 v[68:71], v[36:39], a[224:227], v[68:71]
v_mfma_f32_16x16x32_bf16 v[72:75], v[36:39], a[228:231], v[72:75]
v_mfma_f32_16x16x32_bf16 v[76:79], v[40:43], a[224:227], v[76:79]
v_mfma_f32_16x16x32_bf16 v[80:83], v[40:43], a[228:231], v[80:83]
v_mfma_f32_16x16x32_bf16 v[68:71], v[44:47], a[232:235], v[68:71]
v_mfma_f32_16x16x32_bf16 v[72:75], v[44:47], a[236:239], v[72:75]
v_mfma_f32_16x16x32_bf16 v[76:79], v[48:51], a[232:235], v[76:79]
v_mfma_f32_16x16x32_bf16 v[80:83], v[48:51], a[236:239], v[80:83]
s_waitcnt vmcnt(0)
ds_read_b64_tr_b16 a[240:241], v17 offset:4096
ds_read_b64_tr_b16 a[242:243], v17 offset:4352
ds_read_b64_tr_b16 a[244:245], v17 offset:4128
ds_read_b64_tr_b16 a[246:247], v17 offset:4384
ds_read_b64_tr_b16 a[248:249], v17 offset:6144
ds_read_b64_tr_b16 a[250:251], v17 offset:6400
ds_read_b64_tr_b16 a[252:253], v17 offset:6176
ds_read_b64_tr_b16 a[254:255], v17 offset:6432
s_waitcnt lgkmcnt(0)
ds_read_b128 v[20:23], v8 offset:61440
ds_read_b128 v[24:27], v8 offset:63488
ds_read_b128 v[28:31], v9 offset:61440
ds_read_b128 v[32:35], v9 offset:63488
ds_read_b128 v[36:39], v10 offset:61440
ds_read_b128 v[40:43], v10 offset:63488
ds_read_b128 v[44:47], v11 offset:61440
ds_read_b128 v[48:51], v11 offset:63488
s_waitcnt lgkmcnt(0)
v_mfma_f32_16x16x32_bf16 v[52:55], v[20:23], a[240:243], v[52:55]
v_mfma_f32_16x16x32_bf16 v[56:59], v[20:23], a[244:247], v[56:59]
v_mfma_f32_16x16x32_bf16 v[60:63], v[24:27], a[240:243], v[60:63]
v_mfma_f32_16x16x32_bf16 v[64:67], v[24:27], a[244:247], v[64:67]
v_mfma_f32_16x16x32_bf16 v[52:55], v[28:31], a[248:251], v[52:55]
v_mfma_f32_16x16x32_bf16 v[56:59], v[28:31], a[252:255], v[56:59]
v_mfma_f32_16x16x32_bf16 v[60:63], v[32:35], a[248:251], v[60:63]
v_mfma_f32_16x16x32_bf16 v[64:67], v[32:35], a[252:255], v[64:67]
v_mfma_f32_16x16x32_bf16 v[68:71], v[36:39], a[240:243], v[68:71]
v_mfma_f32_16x16x32_bf16 v[72:75], v[36:39], a[244:247], v[72:75]
v_mfma_f32_16x16x32_bf16 v[76:79], v[40:43], a[240:243], v[76:79]
v_mfma_f32_16x16x32_bf16 v[80:83], v[40:43], a[244:247], v[80:83]
v_mfma_f32_16x16x32_bf16 v[68:71], v[44:47], a[248:251], v[68:71]
v_mfma_f32_16x16x32_bf16 v[72:75], v[44:47], a[252:255], v[72:75]
v_mfma_f32_16x16x32_bf16 v[76:79], v[48:51], a[248:251], v[76:79]
v_mfma_f32_16x16x32_bf16 v[80:83], v[48:51], a[252:255], v[80:83]
s_and_b32 s53, s47, 31
s_lshl_b32 s53, s53, 4
v_add_u32 v19, s53, v1
v_lshlrev_b32 v19, 7, v19
s_mov_b32 s42, 1
v_and_b32 v247, 15, v0
v_lshlrev_b32 v247, 4, v247
s_branch mega_kernel_syvp
mega_kernel_syvw:
s_sleep 4
mega_kernel_syv:
buffer_load_dword v246, v247, s[72:75], 0 offen sc1
s_waitcnt vmcnt(0)
mega_kernel_syvp:
s_cmp_eq_u32 s95, 1
s_cbranch_scc0 mega_kernel_syvf
v_readlane_b32 s76, v246, 14
s_mov_b32 s98, 0
s_cmp_eq_u32 s76, 32
s_cbranch_scc0 mega_kernel_syvw
s_branch mega_kernel_syvd
mega_kernel_syvf:
s_mov_b32 s77, 0
s_mov_b32 s78, 0
v_readlane_b32 s76, v246, 0
s_add_u32 s77, s77, s76
s_xor_b32 s76, s76, 32
s_or_b32 s78, s78, s76
v_readlane_b32 s76, v246, 1
s_add_u32 s77, s77, s76
s_xor_b32 s76, s76, 32
s_or_b32 s78, s78, s76
v_readlane_b32 s76, v246, 2
s_add_u32 s77, s77, s76
s_xor_b32 s76, s76, 32
s_or_b32 s78, s78, s76
v_readlane_b32 s76, v246, 3
s_add_u32 s77, s77, s76
s_xor_b32 s76, s76, 32
s_or_b32 s78, s78, s76
v_readlane_b32 s76, v246, 4
s_add_u32 s77, s77, s76
s_xor_b32 s76, s76, 32
s_or_b32 s78, s78, s76
v_readlane_b32 s76, v246, 5
s_add_u32 s77, s77, s76
s_xor_b32 s76, s76, 32
s_or_b32 s78, s78, s76
v_readlane_b32 s76, v246, 6
s_add_u32 s77, s77, s76
s_xor_b32 s76, s76, 32
s_or_b32 s78, s78, s76
v_readlane_b32 s76, v246, 7
s_add_u32 s77, s77, s76
s_xor_b32 s76, s76, 32
s_or_b32 s78, s78, s76
s_cmp_eq_u32 s77, 256
s_cbranch_scc0 mega_kernel_syvw
v_mov_b32 v252, v246
s_cmp_eq_u32 s78, 0
s_cbranch_scc0 mega_kernel_slowent
v_readlane_b32 s76, v246, 10
v_readlane_b32 s77, v246, 8
s_cmp_eq_u32 s76, 32
s_cbranch_scc0 mega_kernel_syvw
s_cmp_gt_u32 s77, 16
s_cselect_b32 s98, 1, 0
mega_kernel_syvd:
s_lshr_b32 s44, s47, 3
s_xor_b32 s44, s44, s98
s_and_b32 s44, s44, 1
s_lshl_b32 s44, s44, 13
s_lshl_b32 s48, s47, 18
s_add_u32 s48, s48, s44
s_add_u32 s48, s48, 33554432
s_xor_b32 s44, s98, 1
s_lshl_b32 s44, s44, 13
s_lshl_b32 s49, s40, 7
s_add_u32 s49, s49, s44
s_lshl_b32 s44, s41, 2
s_add_u32 s49, s49, s44
s_add_u32 s49, s49, 69210112
v_mov_b32 v16, 0
v_cvt_pk_bf16_f32 v84, v52, v53
v_cvt_pk_bf16_f32 v85, v54, v55
v_cvt_pk_bf16_f32 v86, v60, v61
v_cvt_pk_bf16_f32 v87, v62, v63
v_cvt_pk_bf16_f32 v88, v56, v57
v_cvt_pk_bf16_f32 v89, v58, v59
v_cvt_pk_bf16_f32 v90, v64, v65
v_cvt_pk_bf16_f32 v91, v66, v67
s_add_u32 s51, s42, s47
s_sub_u32 s51, s51, 1
s_bfe_u32 s52, s51, 0x40002
s_lshl_b32 s52, s52, 14
s_and_b32 s51, s51, 3
s_lshl_b32 s51, s51, 11
s_add_u32 s51, s51, s52
s_add_u32 s51, s51, s48
buffer_store_dwordx4 v[84:87], v7, s[84:87], s51 offen sc1
buffer_store_dwordx4 v[88:91], v7, s[84:87], s51 offen offset:1024 sc1
s_mov_b32 s42, 2
s_nop 1
v_cvt_pk_bf16_f32 v84, v68, v69
v_cvt_pk_bf16_f32 v85, v70, v71
v_cvt_pk_bf16_f32 v86, v76, v77
v_cvt_pk_bf16_f32 v87, v78, v79
v_cvt_pk_bf16_f32 v88, v72, v73
v_cvt_pk_bf16_f32 v89, v74, v75
v_cvt_pk_bf16_f32 v90, v80, v81
v_cvt_pk_bf16_f32 v91, v82, v83
s_add_u32 s51, s42, s47
s_sub_u32 s51, s51, 1
s_bfe_u32 s52, s51, 0x40002
s_lshl_b32 s52, s52, 14
s_and_b32 s51, s51, 3
s_lshl_b32 s51, s51, 11
s_add_u32 s51, s51, s52
s_add_u32 s51, s51, s48
buffer_store_dwordx4 v[84:87], v7, s[84:87], s51 offen sc1
buffer_store_dwordx4 v[88:91], v7, s[84:87], s51 offen offset:1024 sc1
s_barrier
s_mov_b32 s50, 0x20000
s_add_u32 m0, s46, 0
s_nop 0
buffer_load_dwordx4 v6, s[8:11], s50 offen offset:0 lds
s_add_u32 m0, s46, 3968
s_nop 0
buffer_load_dwordx4 v6, s[8:11], s50 offen offset:128 lds
s_add_u32 m0, s46, 7936
s_nop 0
buffer_load_dwordx4 v6, s[8:11], s50 offen offset:256 lds
s_add_u32 m0, s46, 11904
s_nop 0
buffer_load_dwordx4 v6, s[8:11], s50 offen offset:384 lds
s_add_u32 m0, s46, 15872
s_nop 0
buffer_load_dwordx4 v6, s[8:11], s50 offen offset:512 lds
s_add_u32 m0, s46, 19840
s_nop 0
buffer_load_dwordx4 v6, s[8:11], s50 offen offset:640 lds
s_add_u32 m0, s46, 23808
s_nop 0
buffer_load_dwordx4 v6, s[8:11], s50 offen offset:768 lds
s_add_u32 m0, s46, 27776
s_nop 0
buffer_load_dwordx4 v6, s[8:11], s50 offen offset:896 lds
s_add_u32 m0, s46, 31744
s_nop 0
buffer_load_dwordx4 v6, s[8:11], s50 offen offset:1024 lds
s_add_u32 m0, s46, 35712
s_nop 0
buffer_load_dwordx4 v6, s[8:11], s50 offen offset:1152 lds
s_add_u32 m0, s46, 39680
s_nop 0
buffer_load_dwordx4 v6, s[8:11], s50 offen offset:1280 lds
s_add_u32 m0, s46, 43648
s_nop 0
buffer_load_dwordx4 v6, s[8:11], s50 offen offset:1408 lds
s_add_u32 m0, s46, 47616
s_nop 0
buffer_load_dwordx4 v6, s[8:11], s50 offen offset:1536 lds
s_add_u32 m0, s46, 51584
s_nop 0
buffer_load_dwordx4 v6, s[8:11], s50 offen offset:1664 lds
s_add_u32 m0, s46, 55552
s_nop 0
buffer_load_dwordx4 v6, s[8:11], s50 offen offset:1792 lds
s_add_u32 m0, s46, 59520
s_nop 0
buffer_load_dwordx4 v6, s[8:11], s50 offen offset:1920 lds
s_waitcnt vmcnt(16)
v_mov_b32 v17, s42
s_mov_b64 exec, 1
buffer_store_dword v17, v16, s[84:87], s49 offen sc1
s_mov_b64 exec, -1
s_waitcnt vmcnt(1)
s_branch mega_kernel_v_mid
mega_kernel_v_loop:
s_waitcnt vmcnt(2)
s_barrier
s_add_u32 s50, s42, 1
s_min_u32 s50, s50, 63
s_lshl_b32 s50, s50, 16
ds_read_b128 v[20:23], v10 offset:0
ds_read_b128 v[24:27], v10 offset:2048
ds_read_b128 v[28:31], v11 offset:0
ds_read_b128 v[32:35], v11 offset:2048
ds_read_b128 v[36:39], v10 offset:4096
ds_read_b128 v[40:43], v10 offset:6144
s_waitcnt lgkmcnt(4)
v_mfma_f32_16x16x32_bf16 v[68:71], v[20:23], a[0:3], 0
ds_read_b128 v[44:47], v11 offset:4096
v_mfma_f32_16x16x32_bf16 v[72:75], v[20:23], a[4:7], 0
v_cvt_pk_bf16_f32 v84, v52, v53
v_cvt_pk_bf16_f32 v85, v54, v55
v_cvt_pk_bf16_f32 v86, v60, v61
v_mfma_f32_16x16x32_bf16 v[76:79], v[24:27], a[0:3], 0
ds_read_b128 v[48:51], v11 offset:6144
v_mfma_f32_16x16x32_bf16 v[80:83], v[24:27], a[4:7], 0
v_cvt_pk_bf16_f32 v87, v62, v63
v_cvt_pk_bf16_f32 v88, v56, v57
v_cvt_pk_bf16_f32 v89, v58, v59
s_waitcnt lgkmcnt(4)
v_mfma_f32_16x16x32_bf16 v[68:71], v[28:31], a[8:11], v[68:71]
ds_read_b128 v[20:23], v10 offset:8192
v_mfma_f32_16x16x32_bf16 v[72:75], v[28:31], a[12:15], v[72:75]
v_cvt_pk_bf16_f32 v90, v64, v65
v_cvt_pk_bf16_f32 v91, v66, v67
v_mfma_f32_16x16x32_bf16 v[76:79], v[32:35], a[8:11], v[76:79]
ds_read_b128 v[24:27], v10 offset:10240
v_mfma_f32_16x16x32_bf16 v[80:83], v[32:35], a[12:15], v[80:83]
s_add_u32 s51, s42, s47
s_sub_u32 s51, s51, 1
s_bfe_u32 s52, s51, 0x40002
s_lshl_b32 s52, s52, 14
s_waitcnt lgkmcnt(4)
v_mfma_f32_16x16x32_bf16 v[68:71], v[36:39], a[16:19], v[68:71]
ds_read_b128 v[28:31], v11 offset:8192
v_mfma_f32_16x16x32_bf16 v[72:75], v[36:39], a[20:23], v[72:75]
s_and_b32 s51, s51, 3
s_lshl_b32 s51, s51, 11
s_add_u32 s51, s51, s52
s_add_u32 s51, s51, s48
buffer_store_dwordx4 v[84:87], v7, s[84:87], s51 offen sc1
v_mfma_f32_16x16x32_bf16 v[76:79], v[40:43], a[16:19], v[76:79]
ds_read_b128 v[32:35], v11 offset:10240
v_mfma_f32_16x16x32_bf16 v[80:83], v[40:43], a[20:23], v[80:83]
buffer_store_dwordx4 v[88:91], v7, s[84:87], s51 offen offset:1024 sc1
s_waitcnt lgkmcnt(4)
v_mfma_f32_16x16x32_bf16 v[68:71], v[44:47], a[24:27], v[68:71]
ds_read_b128 v[36:39], v10 offset:12288
v_mfma_f32_16x16x32_bf16 v[72:75], v[44:47], a[28:31], v[72:75]
s_add_u32 m0, s46, 0
v_mfma_f32_16x16x32_bf16 v[76:79], v[48:51], a[24:27], v[76:79]
ds_read_b128 v[40:43], v10 offset:14336
v_mfma_f32_16x16x32_bf16 v[80:83], v[48:51], a[28:31], v[80:83]
buffer_load_dwordx4 v6, s[8:11], s50 offen offset:0 lds
s_waitcnt lgkmcnt(4)
v_mfma_f32_16x16x32_bf16 v[68:71], v[20:23], a[32:35], v[68:71]
ds_read_b128 v[44:47], v11 offset:12288
v_mfma_f32_16x16x32_bf16 v[72:75], v[20:23], a[36:39], v[72:75]
s_add_u32 m0, s46, 3968
v_mfma_f32_16x16x32_bf16 v[76:79], v[24:27], a[32:35], v[76:79]
ds_read_b128 v[48:51], v11 offset:14336
v_mfma_f32_16x16x32_bf16 v[80:83], v[24:27], a[36:39], v[80:83]
buffer_load_dwordx4 v6, s[8:11], s50 offen offset:128 lds
s_waitcnt lgkmcnt(4)
v_mfma_f32_16x16x32_bf16 v[68:71], v[28:31], a[40:43], v[68:71]
ds_read_b128 v[20:23], v10 offset:16384
v_mfma_f32_16x16x32_bf16 v[72:75], v[28:31], a[44:47], v[72:75]
s_add_u32 m0, s46, 7936
v_mfma_f32_16x16x32_bf16 v[76:79], v[32:35], a[40:43], v[76:79]
ds_read_b128 v[24:27], v10 offset:18432
v_mfma_f32_16x16x32_bf16 v[80:83], v[32:35], a[44:47], v[80:83]
buffer_load_dwordx4 v6, s[8:11], s50 offen offset:256 lds
s_waitcnt lgkmcnt(4)
v_mfma_f32_16x16x32_bf16 v[68:71], v[36:39], a[48:51], v[68:71]
ds_read_b128 v[28:31], v11 offset:16384
v_mfma_f32_16x16x32_bf16 v[72:75], v[36:39], a[52:55], v[72:75]
s_add_u32 m0, s46, 11904
v_mfma_f32_16x16x32_bf16 v[76:79], v[40:43], a[48:51], v[76:79]
ds_read_b128 v[32:35], v11 offset:18432
v_mfma_f32_16x16x32_bf16 v[80:83], v[40:43], a[52:55], v[80:83]
buffer_load_dwordx4 v6, s[8:11], s50 offen offset:384 lds
s_waitcnt lgkmcnt(4)
v_mfma_f32_16x16x32_bf16 v[68:71], v[44:47], a[56:59], v[68:71]
ds_read_b128 v[36:39], v10 offset:20480
v_mfma_f32_16x16x32_bf16 v[72:75], v[44:47], a[60:63], v[72:75]
s_add_u32 m0, s46, 15872
v_mfma_f32_16x16x32_bf16 v[76:79], v[48:51], a[56:59], v[76:79]
ds_read_b128 v[40:43], v10 offset:22528
v_mfma_f32_16x16x32_bf16 v[80:83], v[48:51], a[60:63], v[80:83]
buffer_load_dwordx4 v6, s[8:11], s50 offen offset:512 lds
s_waitcnt lgkmcnt(4)
v_mfma_f32_16x16x32_bf16 v[68:71], v[20:23], a[64:67], v[68:71]
ds_read_b128 v[44:47], v11 offset:20480
v_mfma_f32_16x16x32_bf16 v[72:75], v[20:23], a[68:71], v[72:75]
s_add_u32 m0, s46, 19840
v_mfma_f32_16x16x32_bf16 v[76:79], v[24:27], a[64:67], v[76:79]
ds_read_b128 v[48:51], v11 offset:22528
v_mfma_f32_16x16x32_bf16 v[80:83], v[24:27], a[68:71], v[80:83]
buffer_load_dwordx4 v6, s[8:11], s50 offen offset:640 lds
s_waitcnt lgkmcnt(4)
v_mfma_f32_16x16x32_bf16 v[68:71], v[28:31], a[72:75], v[68:71]
ds_read_b128 v[20:23], v10 offset:24576
v_mfma_f32_16x16x32_bf16 v[72:75], v[28:31], a[76:79], v[72:75]
s_add_u32 m0, s46, 23808
v_mfma_f32_16x16x32_bf16 v[76:79], v[32:35], a[72:75], v[76:79]
ds_read_b128 v[24:27], v10 offset:26624
v_mfma_f32_16x16x32_bf16 v[80:83], v[32:35], a[76:79], v[80:83]
buffer_load_dwordx4 v6, s[8:11], s50 offen offset:768 lds
s_waitcnt lgkmcnt(4)
v_mfma_f32_16x16x32_bf16 v[68:71], v[36:39], a[80:83], v[68:71]
ds_read_b128 v[28:31], v11 offset:24576
v_mfma_f32_16x16x32_bf16 v[72:75], v[36:39], a[84:87], v[72:75]
s_add_u32 m0, s46, 27776
v_mfma_f32_16x16x32_bf16 v[76:79], v[40:43], a[80:83], v[76:79]
ds_read_b128 v[32:35], v11 offset:26624
v_mfma_f32_16x16x32_bf16 v[80:83], v[40:43], a[84:87], v[80:83]
buffer_load_dwordx4 v6, s[8:11], s50 offen offset:896 lds
s_waitcnt lgkmcnt(4)
v_mfma_f32_16x16x32_bf16 v[68:71], v[44:47], a[88:91], v[68:71]
ds_read_b128 v[36:39], v10 offset:28672
v_mfma_f32_16x16x32_bf16 v[72:75], v[44:47], a[92:95], v[72:75]
s_add_u32 m0, s46, 31744
v_mfma_f32_16x16x32_bf16 v[76:79], v[48:51], a[88:91], v[76:79]
ds_read_b128 v[40:43], v10 offset:30720
v_mfma_f32_16x16x32_bf16 v[80:83], v[48:51], a[92:95], v[80:83]
buffer_load_dwordx4 v6, s[8:11], s50 offen offset:1024 lds
s_waitcnt lgkmcnt(4)
v_mfma_f32_16x16x32_bf16 v[68:71], v[20:23], a[96:99], v[68:71]
ds_read_b128 v[44:47], v11 offset:28672
v_mfma_f32_16x16x32_bf16 v[72:75], v[20:23], a[100:103], v[72:75]
s_add_u32 m0, s46, 35712
v_mfma_f32_16x16x32_bf16 v[76:79], v[24:27], a[96:99], v[76:79]
ds_read_b128 v[48:51], v11 offset:30720
v_mfma_f32_16x16x32_bf16 v[80:83], v[24:27], a[100:103], v[80:83]
buffer_load_dwordx4 v6, s[8:11], s50 offen offset:1152 lds
s_waitcnt lgkmcnt(4)
v_mfma_f32_16x16x32_bf16 v[68:71], v[28:31], a[104:107], v[68:71]
ds_read_b128 v[20:23], v10 offset:32768
v_mfma_f32_16x16x32_bf16 v[72:75], v[28:31], a[108:111], v[72:75]
s_add_u32 m0, s46, 39680
v_mfma_f32_16x16x32_bf16 v[76:79], v[32:35], a[104:107], v[76:79]
ds_read_b128 v[24:27], v10 offset:34816
v_mfma_f32_16x16x32_bf16 v[80:83], v[32:35], a[108:111], v[80:83]
buffer_load_dwordx4 v6, s[8:11], s50 offen offset:1280 lds
s_waitcnt lgkmcnt(4)
v_mfma_f32_16x16x32_bf16 v[68:71], v[36:39], a[112:115], v[68:71]
ds_read_b128 v[28:31], v11 offset:32768
v_mfma_f32_16x16x32_bf16 v[72:75], v[36:39], a[116:119], v[72:75]
s_add_u32 m0, s46, 43648
v_mfma_f32_16x16x32_bf16 v[76:79], v[40:43], a[112:115], v[76:79]
ds_read_b128 v[32:35], v11 offset:34816
v_mfma_f32_16x16x32_bf16 v[80:83], v[40:43], a[116:119], v[80:83]
buffer_load_dwordx4 v6, s[8:11], s50 offen offset:1408 lds
s_waitcnt lgkmcnt(4)
v_mfma_f32_16x16x32_bf16 v[68:71], v[44:47], a[120:123], v[68:71]
ds_read_b128 v[36:39], v10 offset:36864
v_mfma_f32_16x16x32_bf16 v[72:75], v[44:47], a[124:127], v[72:75]
s_add_u32 m0, s46, 47616
v_mfma_f32_16x16x32_bf16 v[76:79], v[48:51], a[120:123], v[76:79]
ds_read_b128 v[40:43], v10 offset:38912
v_mfma_f32_16x16x32_bf16 v[80:83], v[48:51], a[124:127], v[80:83]
buffer_load_dwordx4 v6, s[8:11], s50 offen offset:1536 lds
s_waitcnt lgkmcnt(4)
v_mfma_f32_16x16x32_bf16 v[68:71], v[20:23], a[128:131], v[68:71]
ds_read_b128 v[44:47], v11 offset:36864
v_mfma_f32_16x16x32_bf16 v[72:75], v[20:23], a[132:135], v[72:75]
s_add_u32 m0, s46, 51584
v_mfma_f32_16x16x32_bf16 v[76:79], v[24:27], a[128:131], v[76:79]
ds_read_b128 v[48:51], v11 offset:38912
v_mfma_f32_16x16x32_bf16 v[80:83], v[24:27], a[132:135], v[80:83]
buffer_load_dwordx4 v6, s[8:11], s50 offen offset:1664 lds
s_waitcnt lgkmcnt(4)
v_mfma_f32_16x16x32_bf16 v[68:71], v[28:31], a[136:139], v[68:71]
ds_read_b128 v[20:23], v10 offset:40960
v_mfma_f32_16x16x32_bf16 v[72:75], v[28:31], a[140:143], v[72:75]
s_add_u32 m0, s46, 55552
v_mfma_f32_16x16x32_bf16 v[76:79], v[32:35], a[136:139], v[76:79]
ds_read_b128 v[24:27], v10 offset:43008
v_mfma_f32_16x16x32_bf16 v[80:83], v[32:35], a[140:143], v[80:83]
buffer_load_dwordx4 v6, s[8:11], s50 offen offset:1792 lds
s_waitcnt lgkmcnt(4)
v_mfma_f32_16x16x32_bf16 v[68:71], v[36:39], a[144:147], v[68:71]
ds_read_b128 v[28:31], v11 offset:40960
v_mfma_f32_16x16x32_bf16 v[72:75], v[36:39], a[148:151], v[72:75]
s_add_u32 m0, s46, 59520
v_mfma_f32_16x16x32_bf16 v[76:79], v[40:43], a[144:147], v[76:79]
ds_read_b128 v[32:35], v11 offset:43008
v_mfma_f32_16x16x32_bf16 v[80:83], v[40:43], a[148:151], v[80:83]
buffer_load_dwordx4 v6, s[8:11], s50 offen offset:1920 lds
s_waitcnt lgkmcnt(4)
v_mfma_f32_16x16x32_bf16 v[68:71], v[44:47], a[152:155], v[68:71]
ds_read_b128 v[36:39], v10 offset:45056
v_mfma_f32_16x16x32_bf16 v[72:75], v[44:47], a[156:159], v[72:75]
v_mfma_f32_16x16x32_bf16 v[76:79], v[48:51], a[152:155], v[76:79]
ds_read_b128 v[40:43], v10 offset:47104
v_mfma_f32_16x16x32_bf16 v[80:83], v[48:51], a[156:159], v[80:83]
s_waitcnt lgkmcnt(4)
v_mfma_f32_16x16x32_bf16 v[68:71], v[20:23], a[160:163], v[68:71]
ds_read_b128 v[44:47], v11 offset:45056
v_mfma_f32_16x16x32_bf16 v[72:75], v[20:23], a[164:167], v[72:75]
v_mfma_f32_16x16x32_bf16 v[76:79], v[24:27], a[160:163], v[76:79]
ds_read_b128 v[48:51], v11 offset:47104
v_mfma_f32_16x16x32_bf16 v[80:83], v[24:27], a[164:167], v[80:83]
s_waitcnt lgkmcnt(4)
v_mfma_f32_16x16x32_bf16 v[68:71], v[28:31], a[168:171], v[68:71]
ds_read_b128 v[20:23], v10 offset:49152
v_mfma_f32_16x16x32_bf16 v[72:75], v[28:31], a[172:175], v[72:75]
s_waitcnt vmcnt(16)
v_mov_b32 v17, s42
s_mov_b64 exec, 1
buffer_store_dword v17, v16, s[84:87], s49 offen sc1
s_mov_b64 exec, -1
v_mfma_f32_16x16x32_bf16 v[76:79], v[32:35], a[168:171], v[76:79]
ds_read_b128 v[24:27], v10 offset:51200
v_mfma_f32_16x16x32_bf16 v[80:83], v[32:35], a[172:175], v[80:83]
s_waitcnt lgkmcnt(4)
v_mfma_f32_16x16x32_bf16 v[68:71], v[36:39], a[176:179], v[68:71]
ds_read_b128 v[28:31], v11 offset:49152
v_mfma_f32_16x16x32_bf16 v[72:75], v[36:39], a[180:183], v[72:75]
s_add_u32 s53, s42, 3
s_min_u32 s53, s53, 63
s_lshl_b32 s53, s53, 16
s_mov_b64 exec, 0xffff
buffer_load_dword v250, v19, s[8:11], s53 offen
s_mov_b64 exec, -1
v_mfma_f32_16x16x32_bf16 v[76:79], v[40:43], a[176:179], v[76:79]
ds_read_b128 v[32:35], v11 offset:51200
v_mfma_f32_16x16x32_bf16 v[80:83], v[40:43], a[180:183], v[80:83]
s_waitcnt lgkmcnt(4)
v_mfma_f32_16x16x32_bf16 v[68:71], v[44:47], a[184:187], v[68:71]
ds_read_b128 v[36:39], v10 offset:53248
v_mfma_f32_16x16x32_bf16 v[72:75], v[44:47], a[188:191], v[72:75]
v_mfma_f32_16x16x32_bf16 v[76:79], v[48:51], a[184:187], v[76:79]
ds_read_b128 v[40:43], v10 offset:55296
v_mfma_f32_16x16x32_bf16 v[80:83], v[48:51], a[188:191], v[80:83]
s_waitcnt lgkmcnt(4)
v_mfma_f32_16x16x32_bf16 v[68:71], v[20:23], a[192:195], v[68:71]
ds_read_b128 v[44:47], v11 offset:53248
v_mfma_f32_16x16x32_bf16 v[72:75], v[20:23], a[196:199], v[72:75]
v_mfma_f32_16x16x32_bf16 v[76:79], v[24:27], a[192:195], v[76:79]
ds_read_b128 v[48:51], v11 offset:55296
v_mfma_f32_16x16x32_bf16 v[80:83], v[24:27], a[196:199], v[80:83]
s_waitcnt lgkmcnt(4)
v_mfma_f32_16x16x32_bf16 v[68:71], v[28:31], a[200:203], v[68:71]
ds_read_b128 v[20:23], v10 offset:57344
v_mfma_f32_16x16x32_bf16 v[72:75], v[28:31], a[204:207], v[72:75]
v_mfma_f32_16x16x32_bf16 v[76:79], v[32:35], a[200:203], v[76:79]
ds_read_b128 v[24:27], v10 offset:59392
v_mfma_f32_16x16x32_bf16 v[80:83], v[32:35], a[204:207], v[80:83]
s_waitcnt lgkmcnt(4)
v_mfma_f32_16x16x32_bf16 v[68:71], v[36:39], a[208:211], v[68:71]
ds_read_b128 v[28:31], v11 offset:57344
v_mfma_f32_16x16x32_bf16 v[72:75], v[36:39], a[212:215], v[72:75]
v_mfma_f32_16x16x32_bf16 v[76:79], v[40:43], a[208:211], v[76:79]
ds_read_b128 v[32:35], v11 offset:59392
v_mfma_f32_16x16x32_bf16 v[80:83], v[40:43], a[212:215], v[80:83]
s_waitcnt lgkmcnt(4)
v_mfma_f32_16x16x32_bf16 v[68:71], v[44:47], a[216:219], v[68:71]
ds_read_b128 v[36:39], v10 offset:61440
v_mfma_f32_16x16x32_bf16 v[72:75], v[44:47], a[220:223], v[72:75]
v_mfma_f32_16x16x32_bf16 v[76:79], v[48:51], a[216:219], v[76:79]
ds_read_b128 v[40:43], v10 offset:63488
v_mfma_f32_16x16x32_bf16 v[80:83], v[48:51], a[220:223], v[80:83]
s_waitcnt lgkmcnt(4)
v_mfma_f32_16x16x32_bf16 v[68:71], v[20:23], a[224:227], v[68:71]
ds_read_b128 v[44:47], v11 offset:61440
v_mfma_f32_16x16x32_bf16 v[72:75], v[20:23], a[228:231], v[72:75]
v_mfma_f32_16x16x32_bf16 v[76:79], v[24:27], a[224:227], v[76:79]
ds_read_b128 v[48:51], v11 offset:63488
v_mfma_f32_16x16x32_bf16 v[80:83], v[24:27], a[228:231], v[80:83]
s_waitcnt lgkmcnt(5)
v_mfma_f32_16x16x32_bf16 v[68:71], v[28:31], a[232:235], v[68:71]
v_mfma_f32_16x16x32_bf16 v[72:75], v[28:31], a[236:239], v[72:75]
s_waitcnt lgkmcnt(4)
v_mfma_f32_16x16x32_bf16 v[76:79], v[32:35], a[232:235], v[76:79]
v_mfma_f32_16x16x32_bf16 v[80:83], v[32:35], a[236:239], v[80:83]
s_waitcnt lgkmcnt(3)
v_mfma_f32_16x16x32_bf16 v[68:71], v[36:39], a[240:243], v[68:71]
v_mfma_f32_16x16x32_bf16 v[72:75], v[36:39], a[244:247], v[72:75]
s_waitcnt lgkmcnt(2)
v_mfma_f32_16x16x32_bf16 v[76:79], v[40:43], a[240:243], v[76:79]
v_mfma_f32_16x16x32_bf16 v[80:83], v[40:43], a[244:247], v[80:83]
s_waitcnt lgkmcnt(1)
v_mfma_f32_16x16x32_bf16 v[68:71], v[44:47], a[248:251], v[68:71]
v_mfma_f32_16x16x32_bf16 v[72:75], v[44:47], a[252:255], v[72:75]
s_waitcnt lgkmcnt(0)
v_mfma_f32_16x16x32_bf16 v[76:79], v[48:51], a[248:251], v[76:79]
v_mfma_f32_16x16x32_bf16 v[80:83], v[48:51], a[252:255], v[80:83]
s_add_u32 s42, s42, 1
s_cmp_eq_u32 s42, 64
s_cbranch_scc1 mega_kernel_v_fin
mega_kernel_v_mid:
s_waitcnt vmcnt(2)
s_barrier
s_add_u32 s50, s42, 1
s_min_u32 s50, s50, 63
s_lshl_b32 s50, s50, 16
ds_read_b128 v[20:23], v8 offset:0
ds_read_b128 v[24:27], v8 offset:2048
ds_read_b128 v[28:31], v9 offset:0
ds_read_b128 v[32:35], v9 offset:2048
ds_read_b128 v[36:39], v8 offset:4096
ds_read_b128 v[40:43], v8 offset:6144
s_waitcnt lgkmcnt(4)
v_mfma_f32_16x16x32_bf16 v[52:55], v[20:23], a[0:3], 0
ds_read_b128 v[44:47], v9 offset:4096
v_mfma_f32_16x16x32_bf16 v[56:59], v[20:23], a[4:7], 0
v_cvt_pk_bf16_f32 v84, v68, v69
v_cvt_pk_bf16_f32 v85, v70, v71
v_cvt_pk_bf16_f32 v86, v76, v77
v_mfma_f32_16x16x32_bf16 v[60:63], v[24:27], a[0:3], 0
ds_read_b128 v[48:51], v9 offset:6144
v_mfma_f32_16x16x32_bf16 v[64:67], v[24:27], a[4:7], 0
v_cvt_pk_bf16_f32 v87, v78, v79
v_cvt_pk_bf16_f32 v88, v72, v73
v_cvt_pk_bf16_f32 v89, v74, v75
s_waitcnt lgkmcnt(4)
v_mfma_f32_16x16x32_bf16 v[52:55], v[28:31], a[8:11], v[52:55]
ds_read_b128 v[20:23], v8 offset:8192
v_mfma_f32_16x16x32_bf16 v[56:59], v[28:31], a[12:15], v[56:59]
v_cvt_pk_bf16_f32 v90, v80, v81
v_cvt_pk_bf16_f32 v91, v82, v83
v_mfma_f32_16x16x32_bf16 v[60:63], v[32:35], a[8:11], v[60:63]
ds_read_b128 v[24:27], v8 offset:10240
v_mfma_f32_16x16x32_bf16 v[64:67], v[32:35], a[12:15], v[64:67]
s_add_u32 s51, s42, s47
s_sub_u32 s51, s51, 1
s_bfe_u32 s52, s51, 0x40002
s_lshl_b32 s52, s52, 14
s_waitcnt lgkmcnt(4)
v_mfma_f32_16x16x32_bf16 v[52:55], v[36:39], a[16:19], v[52:55]
ds_read_b128 v[28:31], v9 offset:8192
v_mfma_f32_16x16x32_bf16 v[56:59], v[36:39], a[20:23], v[56:59]
s_and_b32 s51, s51, 3
s_lshl_b32 s51, s51, 11
s_add_u32 s51, s51, s52
s_add_u32 s51, s51, s48
buffer_store_dwordx4 v[84:87], v7, s[84:87], s51 offen sc1
v_mfma_f32_16x16x32_bf16 v[60:63], v[40:43], a[16:19], v[60:63]
ds_read_b128 v[32:35], v9 offset:10240
v_mfma_f32_16x16x32_bf16 v[64:67], v[40:43], a[20:23], v[64:67]
buffer_store_dwordx4 v[88:91], v7, s[84:87], s51 offen offset:1024 sc1
s_waitcnt lgkmcnt(4)
v_mfma_f32_16x16x32_bf16 v[52:55], v[44:47], a[24:27], v[52:55]
ds_read_b128 v[36:39], v8 offset:12288
v_mfma_f32_16x16x32_bf16 v[56:59], v[44:47], a[28:31], v[56:59]
s_add_u32 m0, s46, 65536
v_mfma_f32_16x16x32_bf16 v[60:63], v[48:51], a[24:27], v[60:63]
ds_read_b128 v[40:43], v8 offset:14336
v_mfma_f32_16x16x32_bf16 v[64:67], v[48:51], a[28:31], v[64:67]
buffer_load_dwordx4 v6, s[8:11], s50 offen offset:0 lds
s_waitcnt lgkmcnt(4)
v_mfma_f32_16x16x32_bf16 v[52:55], v[20:23], a[32:35], v[52:55]
ds_read_b128 v[44:47], v9 offset:12288
v_mfma_f32_16x16x32_bf16 v[56:59], v[20:23], a[36:39], v[56:59]
s_add_u32 m0, s46, 69504
v_mfma_f32_16x16x32_bf16 v[60:63], v[24:27], a[32:35], v[60:63]
ds_read_b128 v[48:51], v9 offset:14336
v_mfma_f32_16x16x32_bf16 v[64:67], v[24:27], a[36:39], v[64:67]
buffer_load_dwordx4 v6, s[8:11], s50 offen offset:128 lds
s_waitcnt lgkmcnt(4)
v_mfma_f32_16x16x32_bf16 v[52:55], v[28:31], a[40:43], v[52:55]
ds_read_b128 v[20:23], v8 offset:16384
v_mfma_f32_16x16x32_bf16 v[56:59], v[28:31], a[44:47], v[56:59]
s_add_u32 m0, s46, 73472
v_mfma_f32_16x16x32_bf16 v[60:63], v[32:35], a[40:43], v[60:63]
ds_read_b128 v[24:27], v8 offset:18432
v_mfma_f32_16x16x32_bf16 v[64:67], v[32:35], a[44:47], v[64:67]
buffer_load_dwordx4 v6, s[8:11], s50 offen offset:256 lds
s_waitcnt lgkmcnt(4)
v_mfma_f32_16x16x32_bf16 v[52:55], v[36:39], a[48:51], v[52:55]
ds_read_b128 v[28:31], v9 offset:16384
v_mfma_f32_16x16x32_bf16 v[56:59], v[36:39], a[52:55], v[56:59]
s_add_u32 m0, s46, 77440
v_mfma_f32_16x16x32_bf16 v[60:63], v[40:43], a[48:51], v[60:63]
ds_read_b128 v[32:35], v9 offset:18432
v_mfma_f32_16x16x32_bf16 v[64:67], v[40:43], a[52:55], v[64:67]
buffer_load_dwordx4 v6, s[8:11], s50 offen offset:384 lds
s_waitcnt lgkmcnt(4)
v_mfma_f32_16x16x32_bf16 v[52:55], v[44:47], a[56:59], v[52:55]
ds_read_b128 v[36:39], v8 offset:20480
v_mfma_f32_16x16x32_bf16 v[56:59], v[44:47], a[60:63], v[56:59]
s_add_u32 m0, s46, 81408
v_mfma_f32_16x16x32_bf16 v[60:63], v[48:51], a[56:59], v[60:63]
ds_read_b128 v[40:43], v8 offset:22528
v_mfma_f32_16x16x32_bf16 v[64:67], v[48:51], a[60:63], v[64:67]
buffer_load_dwordx4 v6, s[8:11], s50 offen offset:512 lds
s_waitcnt lgkmcnt(4)
v_mfma_f32_16x16x32_bf16 v[52:55], v[20:23], a[64:67], v[52:55]
ds_read_b128 v[44:47], v9 offset:20480
v_mfma_f32_16x16x32_bf16 v[56:59], v[20:23], a[68:71], v[56:59]
s_add_u32 m0, s46, 85376
v_mfma_f32_16x16x32_bf16 v[60:63], v[24:27], a[64:67], v[60:63]
ds_read_b128 v[48:51], v9 offset:22528
v_mfma_f32_16x16x32_bf16 v[64:67], v[24:27], a[68:71], v[64:67]
buffer_load_dwordx4 v6, s[8:11], s50 offen offset:640 lds
s_waitcnt lgkmcnt(4)
v_mfma_f32_16x16x32_bf16 v[52:55], v[28:31], a[72:75], v[52:55]
ds_read_b128 v[20:23], v8 offset:24576
v_mfma_f32_16x16x32_bf16 v[56:59], v[28:31], a[76:79], v[56:59]
s_add_u32 m0, s46, 89344
v_mfma_f32_16x16x32_bf16 v[60:63], v[32:35], a[72:75], v[60:63]
ds_read_b128 v[24:27], v8 offset:26624
v_mfma_f32_16x16x32_bf16 v[64:67], v[32:35], a[76:79], v[64:67]
buffer_load_dwordx4 v6, s[8:11], s50 offen offset:768 lds
s_waitcnt lgkmcnt(4)
v_mfma_f32_16x16x32_bf16 v[52:55], v[36:39], a[80:83], v[52:55]
ds_read_b128 v[28:31], v9 offset:24576
v_mfma_f32_16x16x32_bf16 v[56:59], v[36:39], a[84:87], v[56:59]
s_add_u32 m0, s46, 93312
v_mfma_f32_16x16x32_bf16 v[60:63], v[40:43], a[80:83], v[60:63]
ds_read_b128 v[32:35], v9 offset:26624
v_mfma_f32_16x16x32_bf16 v[64:67], v[40:43], a[84:87], v[64:67]
buffer_load_dwordx4 v6, s[8:11], s50 offen offset:896 lds
s_waitcnt lgkmcnt(4)
v_mfma_f32_16x16x32_bf16 v[52:55], v[44:47], a[88:91], v[52:55]
ds_read_b128 v[36:39], v8 offset:28672
v_mfma_f32_16x16x32_bf16 v[56:59], v[44:47], a[92:95], v[56:59]
s_add_u32 m0, s46, 97280
v_mfma_f32_16x16x32_bf16 v[60:63], v[48:51], a[88:91], v[60:63]
ds_read_b128 v[40:43], v8 offset:30720
v_mfma_f32_16x16x32_bf16 v[64:67], v[48:51], a[92:95], v[64:67]
buffer_load_dwordx4 v6, s[8:11], s50 offen offset:1024 lds
s_waitcnt lgkmcnt(4)
v_mfma_f32_16x16x32_bf16 v[52:55], v[20:23], a[96:99], v[52:55]
ds_read_b128 v[44:47], v9 offset:28672
v_mfma_f32_16x16x32_bf16 v[56:59], v[20:23], a[100:103], v[56:59]
s_add_u32 m0, s46, 101248
v_mfma_f32_16x16x32_bf16 v[60:63], v[24:27], a[96:99], v[60:63]
ds_read_b128 v[48:51], v9 offset:30720
v_mfma_f32_16x16x32_bf16 v[64:67], v[24:27], a[100:103], v[64:67]
buffer_load_dwordx4 v6, s[8:11], s50 offen offset:1152 lds
s_waitcnt lgkmcnt(4)
v_mfma_f32_16x16x32_bf16 v[52:55], v[28:31], a[104:107], v[52:55]
ds_read_b128 v[20:23], v8 offset:32768
v_mfma_f32_16x16x32_bf16 v[56:59], v[28:31], a[108:111], v[56:59]
s_add_u32 m0, s46, 105216
v_mfma_f32_16x16x32_bf16 v[60:63], v[32:35], a[104:107], v[60:63]
ds_read_b128 v[24:27], v8 offset:34816
v_mfma_f32_16x16x32_bf16 v[64:67], v[32:35], a[108:111], v[64:67]
buffer_load_dwordx4 v6, s[8:11], s50 offen offset:1280 lds
s_waitcnt lgkmcnt(4)
v_mfma_f32_16x16x32_bf16 v[52:55], v[36:39], a[112:115], v[52:55]
ds_read_b128 v[28:31], v9 offset:32768
v_mfma_f32_16x16x32_bf16 v[56:59], v[36:39], a[116:119], v[56:59]
s_add_u32 m0, s46, 109184
v_mfma_f32_16x16x32_bf16 v[60:63], v[40:43], a[112:115], v[60:63]
ds_read_b128 v[32:35], v9 offset:34816
v_mfma_f32_16x16x32_bf16 v[64:67], v[40:43], a[116:119], v[64:67]
buffer_load_dwordx4 v6, s[8:11], s50 offen offset:1408 lds
s_waitcnt lgkmcnt(4)
v_mfma_f32_16x16x32_bf16 v[52:55], v[44:47], a[120:123], v[52:55]
ds_read_b128 v[36:39], v8 offset:36864
v_mfma_f32_16x16x32_bf16 v[56:59], v[44:47], a[124:127], v[56:59]
s_add_u32 m0, s46, 113152
v_mfma_f32_16x16x32_bf16 v[60:63], v[48:51], a[120:123], v[60:63]
ds_read_b128 v[40:43], v8 offset:38912
v_mfma_f32_16x16x32_bf16 v[64:67], v[48:51], a[124:127], v[64:67]
buffer_load_dwordx4 v6, s[8:11], s50 offen offset:1536 lds
s_waitcnt lgkmcnt(4)
v_mfma_f32_16x16x32_bf16 v[52:55], v[20:23], a[128:131], v[52:55]
ds_read_b128 v[44:47], v9 offset:36864
v_mfma_f32_16x16x32_bf16 v[56:59], v[20:23], a[132:135], v[56:59]
s_add_u32 m0, s46, 117120
v_mfma_f32_16x16x32_bf16 v[60:63], v[24:27], a[128:131], v[60:63]
ds_read_b128 v[48:51], v9 offset:38912
v_mfma_f32_16x16x32_bf16 v[64:67], v[24:27], a[132:135], v[64:67]
buffer_load_dwordx4 v6, s[8:11], s50 offen offset:1664 lds
s_waitcnt lgkmcnt(4)
v_mfma_f32_16x16x32_bf16 v[52:55], v[28:31], a[136:139], v[52:55]
ds_read_b128 v[20:23], v8 offset:40960
v_mfma_f32_16x16x32_bf16 v[56:59], v[28:31], a[140:143], v[56:59]
s_add_u32 m0, s46, 121088
v_mfma_f32_16x16x32_bf16 v[60:63], v[32:35], a[136:139], v[60:63]
ds_read_b128 v[24:27], v8 offset:43008
v_mfma_f32_16x16x32_bf16 v[64:67], v[32:35], a[140:143], v[64:67]
buffer_load_dwordx4 v6, s[8:11], s50 offen offset:1792 lds
s_waitcnt lgkmcnt(4)
v_mfma_f32_16x16x32_bf16 v[52:55], v[36:39], a[144:147], v[52:55]
ds_read_b128 v[28:31], v9 offset:40960
v_mfma_f32_16x16x32_bf16 v[56:59], v[36:39], a[148:151], v[56:59]
s_add_u32 m0, s46, 125056
v_mfma_f32_16x16x32_bf16 v[60:63], v[40:43], a[144:147], v[60:63]
ds_read_b128 v[32:35], v9 offset:43008
v_mfma_f32_16x16x32_bf16 v[64:67], v[40:43], a[148:151], v[64:67]
buffer_load_dwordx4 v6, s[8:11], s50 offen offset:1920 lds
s_waitcnt lgkmcnt(4)
v_mfma_f32_16x16x32_bf16 v[52:55], v[44:47], a[152:155], v[52:55]
ds_read_b128 v[36:39], v8 offset:45056
v_mfma_f32_16x16x32_bf16 v[56:59], v[44:47], a[156:159], v[56:59]
v_mfma_f32_16x16x32_bf16 v[60:63], v[48:51], a[152:155], v[60:63]
ds_read_b128 v[40:43], v8 offset:47104
v_mfma_f32_16x16x32_bf16 v[64:67], v[48:51], a[156:159], v[64:67]
s_waitcnt lgkmcnt(4)
v_mfma_f32_16x16x32_bf16 v[52:55], v[20:23], a[160:163], v[52:55]
ds_read_b128 v[44:47], v9 offset:45056
v_mfma_f32_16x16x32_bf16 v[56:59], v[20:23], a[164:167], v[56:59]
v_mfma_f32_16x16x32_bf16 v[60:63], v[24:27], a[160:163], v[60:63]
ds_read_b128 v[48:51], v9 offset:47104
v_mfma_f32_16x16x32_bf16 v[64:67], v[24:27], a[164:167], v[64:67]
s_waitcnt lgkmcnt(4)
v_mfma_f32_16x16x32_bf16 v[52:55], v[28:31], a[168:171], v[52:55]
ds_read_b128 v[20:23], v8 offset:49152
v_mfma_f32_16x16x32_bf16 v[56:59], v[28:31], a[172:175], v[56:59]
s_waitcnt vmcnt(16)
v_mov_b32 v17, s42
s_mov_b64 exec, 1
buffer_store_dword v17, v16, s[84:87], s49 offen sc1
s_mov_b64 exec, -1
v_mfma_f32_16x16x32_bf16 v[60:63], v[32:35], a[168:171], v[60:63]
ds_read_b128 v[24:27], v8 offset:51200
v_mfma_f32_16x16x32_bf16 v[64:67], v[32:35], a[172:175], v[64:67]
s_waitcnt lgkmcnt(4)
v_mfma_f32_16x16x32_bf16 v[52:55], v[36:39], a[176:179], v[52:55]
ds_read_b128 v[28:31], v9 offset:49152
v_mfma_f32_16x16x32_bf16 v[56:59], v[36:39], a[180:183], v[56:59]
s_add_u32 s53, s42, 3
s_min_u32 s53, s53, 63
s_lshl_b32 s53, s53, 16
s_mov_b64 exec, 0xffff
buffer_load_dword v250, v19, s[8:11], s53 offen
s_mov_b64 exec, -1
v_mfma_f32_16x16x32_bf16 v[60:63], v[40:43], a[176:179], v[60:63]
ds_read_b128 v[32:35], v9 offset:51200
v_mfma_f32_16x16x32_bf16 v[64:67], v[40:43], a[180:183], v[64:67]
s_waitcnt lgkmcnt(4)
v_mfma_f32_16x16x32_bf16 v[52:55], v[44:47], a[184:187], v[52:55]
ds_read_b128 v[36:39], v8 offset:53248
v_mfma_f32_16x16x32_bf16 v[56:59], v[44:47], a[188:191], v[56:59]
v_mfma_f32_16x16x32_bf16 v[60:63], v[48:51], a[184:187], v[60:63]
ds_read_b128 v[40:43], v8 offset:55296
v_mfma_f32_16x16x32_bf16 v[64:67], v[48:51], a[188:191], v[64:67]
s_waitcnt lgkmcnt(4)
v_mfma_f32_16x16x32_bf16 v[52:55], v[20:23], a[192:195], v[52:55]
ds_read_b128 v[44:47], v9 offset:53248
v_mfma_f32_16x16x32_bf16 v[56:59], v[20:23], a[196:199], v[56:59]
v_mfma_f32_16x16x32_bf16 v[60:63], v[24:27], a[192:195], v[60:63]
ds_read_b128 v[48:51], v9 offset:55296
v_mfma_f32_16x16x32_bf16 v[64:67], v[24:27], a[196:199], v[64:67]
s_waitcnt lgkmcnt(4)
v_mfma_f32_16x16x32_bf16 v[52:55], v[28:31], a[200:203], v[52:55]
ds_read_b128 v[20:23], v8 offset:57344
v_mfma_f32_16x16x32_bf16 v[56:59], v[28:31], a[204:207], v[56:59]
v_mfma_f32_16x16x32_bf16 v[60:63], v[32:35], a[200:203], v[60:63]
ds_read_b128 v[24:27], v8 offset:59392
v_mfma_f32_16x16x32_bf16 v[64:67], v[32:35], a[204:207], v[64:67]
s_waitcnt lgkmcnt(4)
v_mfma_f32_16x16x32_bf16 v[52:55], v[36:39], a[208:211], v[52:55]
ds_read_b128 v[28:31], v9 offset:57344
v_mfma_f32_16x16x32_bf16 v[56:59], v[36:39], a[212:215], v[56:59]
v_mfma_f32_16x16x32_bf16 v[60:63], v[40:43], a[208:211], v[60:63]
ds_read_b128 v[32:35], v9 offset:59392
v_mfma_f32_16x16x32_bf16 v[64:67], v[40:43], a[212:215], v[64:67]
s_waitcnt lgkmcnt(4)
v_mfma_f32_16x16x32_bf16 v[52:55], v[44:47], a[216:219], v[52:55]
ds_read_b128 v[36:39], v8 offset:61440
v_mfma_f32_16x16x32_bf16 v[56:59], v[44:47], a[220:223], v[56:59]
v_mfma_f32_16x16x32_bf16 v[60:63], v[48:51], a[216:219], v[60:63]
ds_read_b128 v[40:43], v8 offset:63488
v_mfma_f32_16x16x32_bf16 v[64:67], v[48:51], a[220:223], v[64:67]
s_waitcnt lgkmcnt(4)
v_mfma_f32_16x16x32_bf16 v[52:55], v[20:23], a[224:227], v[52:55]
ds_read_b128 v[44:47], v9 offset:61440
v_mfma_f32_16x16x32_bf16 v[56:59], v[20:23], a[228:231], v[56:59]
v_mfma_f32_16x16x32_bf16 v[60:63], v[24:27], a[224:227], v[60:63]
ds_read_b128 v[48:51], v9 offset:63488
v_mfma_f32_16x16x32_bf16 v[64:67], v[24:27], a[228:231], v[64:67]
s_waitcnt lgkmcnt(5)
v_mfma_f32_16x16x32_bf16 v[52:55], v[28:31], a[232:235], v[52:55]
v_mfma_f32_16x16x32_bf16 v[56:59], v[28:31], a[236:239], v[56:59]
s_waitcnt lgkmcnt(4)
v_mfma_f32_16x16x32_bf16 v[60:63], v[32:35], a[232:235], v[60:63]
v_mfma_f32_16x16x32_bf16 v[64:67], v[32:35], a[236:239], v[64:67]
s_waitcnt lgkmcnt(3)
v_mfma_f32_16x16x32_bf16 v[52:55], v[36:39], a[240:243], v[52:55]
v_mfma_f32_16x16x32_bf16 v[56:59], v[36:39], a[244:247], v[56:59]
s_waitcnt lgkmcnt(2)
v_mfma_f32_16x16x32_bf16 v[60:63], v[40:43], a[240:243], v[60:63]
v_mfma_f32_16x16x32_bf16 v[64:67], v[40:43], a[244:247], v[64:67]
s_waitcnt lgkmcnt(1)
v_mfma_f32_16x16x32_bf16 v[52:55], v[44:47], a[248:251], v[52:55]
v_mfma_f32_16x16x32_bf16 v[56:59], v[44:47], a[252:255], v[56:59]
s_waitcnt lgkmcnt(0)
v_mfma_f32_16x16x32_bf16 v[60:63], v[48:51], a[248:251], v[60:63]
v_mfma_f32_16x16x32_bf16 v[64:67], v[48:51], a[252:255], v[64:67]
s_add_u32 s42, s42, 1
s_branch mega_kernel_v_loop
mega_kernel_v_fin:
s_nop 11
v_cvt_pk_bf16_f32 v84, v68, v69
v_cvt_pk_bf16_f32 v85, v70, v71
v_cvt_pk_bf16_f32 v86, v76, v77
v_cvt_pk_bf16_f32 v87, v78, v79
v_cvt_pk_bf16_f32 v88, v72, v73
v_cvt_pk_bf16_f32 v89, v74, v75
v_cvt_pk_bf16_f32 v90, v80, v81
v_cvt_pk_bf16_f32 v91, v82, v83
s_add_u32 s51, s42, s47
s_sub_u32 s51, s51, 1
s_bfe_u32 s52, s51, 0x40002
s_lshl_b32 s52, s52, 14
s_and_b32 s51, s51, 3
s_lshl_b32 s51, s51, 11
s_add_u32 s51, s51, s52
s_add_u32 s51, s51, s48
buffer_store_dwordx4 v[84:87], v7, s[84:87], s51 offen sc1
buffer_store_dwordx4 v[88:91], v7, s[84:87], s51 offen offset:1024 sc1
s_waitcnt vmcnt(0)
v_mov_b32 v17, s42
s_mov_b64 exec, 1
buffer_store_dword v17, v16, s[84:87], s49 offen sc1
s_mov_b64 exec, -1
s_waitcnt vmcnt(0)
s_barrier
mega_kernel_fft:
s_mov_b32 s38, s92
s_mov_b32 s39, 64
s_mov_b32 s37, 129
mega_kernel_f2s:
v_mov_b32 v1, 0
s_mov_b32 s82, 69259264
mega_kernel_w0:
s_sleep 8
buffer_load_dword v2, v1, s[84:87], s82 offen sc1
s_waitcnt vmcnt(0)
v_cmp_ne_u32 vcc, 31, v2
s_cbranch_vccnz mega_kernel_w0
s_mov_b32 s48, 0x3f7ec46d
s_mov_b32 s49, 0x3dc8bd36
s_mov_b32 s50, 0x3f7b14be
s_mov_b32 s51, 0x3e47c5c2
s_mov_b32 s52, 0x3f74fa0b
s_mov_b32 s53, 0x3e94a031
s_mov_b32 s54, 0x3f6c835e
s_mov_b32 s55, 0x3ec3ef15
s_mov_b32 s56, 0x3f61c598
s_mov_b32 s57, 0x3ef15aea
s_mov_b32 s58, 0x3f54db31
s_mov_b32 s59, 0x3f0e39da
s_mov_b32 s60, 0x3f45e403
s_mov_b32 s61, 0x3f226799
s_mov_b32 s62, 0x3f3504f3
s_mov_b32 s63, 0x3f3504f3
v_lshrrev_b32 v10, 6, v0
v_and_b32 v1, 63, v0
v_readfirstlane_b32 s16, v10
v_cvt_f32_u32 v2, v1
v_lshlrev_b32 v5, 3, v1
s_mul_i32 s17, s16, 16896
v_add_u32 v3, s17, v5
v_and_b32 v7, 1, v1
v_lshrrev_b32 v6, 1, v1
v_cvt_f32_u32 v8, v6
v_cvt_f32_u32 v10, v7
v_mul_u32_u24 v4, 528, v6
v_lshl_add_u32 v4, v7, 3, v4
v_add_u32 v4, s17, v4
v_lshlrev_b32 v11, 12, v7
v_lshl_add_u32 v11, v6, 2, v11
v_fma_f32 v9, v10, 2.0, -1.0
v_sub_f32 v7, 0, v9
v_mul_f32 v13, v10, v8
v_mul_f32 v13, 0x3a000000, v13
s_mov_b32 s18, 0xaaaaaaaa
s_mov_b32 s19, 0xaaaaaaaa
v_mul_f32 v12, 0xba000000, v2
v_cos_f32 v82, v12
v_sin_f32 v83, v12
v_mul_f32 v12, 0xba800000, v2
v_cos_f32 v84, v12
v_sin_f32 v85, v12
v_mul_f32 v12, 0xbac00000, v2
v_cos_f32 v86, v12
v_sin_f32 v87, v12
v_mul_f32 v12, 0xbb000000, v2
v_cos_f32 v88, v12
v_sin_f32 v89, v12
v_mul_f32 v12, 0xbb200000, v2
v_cos_f32 v90, v12
v_sin_f32 v91, v12
v_mul_f32 v12, 0xbb400000, v2
v_cos_f32 v92, v12
v_sin_f32 v93, v12
v_mul_f32 v12, 0xbb600000, v2
v_cos_f32 v94, v12
v_sin_f32 v95, v12
v_mul_f32 v12, 0xbb800000, v2
v_cos_f32 v96, v12
v_sin_f32 v97, v12
v_mul_f32 v12, 0xbb900000, v2
v_cos_f32 v98, v12
v_sin_f32 v99, v12
v_mul_f32 v12, 0xbba00000, v2
v_cos_f32 v100, v12
v_sin_f32 v101, v12
v_mul_f32 v12, 0xbbb00000, v2
v_cos_f32 v102, v12
v_sin_f32 v103, v12
v_mul_f32 v12, 0xbbc00000, v2
v_cos_f32 v104, v12
v_sin_f32 v105, v12
v_mul_f32 v12, 0xbbd00000, v2
v_cos_f32 v106, v12
v_sin_f32 v107, v12
v_mul_f32 v12, 0xbbe00000, v2
v_cos_f32 v108, v12
v_sin_f32 v109, v12
v_mul_f32 v12, 0xbbf00000, v2
v_cos_f32 v110, v12
v_sin_f32 v111, v12
v_mul_f32 v12, 0xbc000000, v2
v_cos_f32 v112, v12
v_sin_f32 v113, v12
v_mul_f32 v12, 0xbc080000, v2
v_cos_f32 v114, v12
v_sin_f32 v115, v12
v_mul_f32 v12, 0xbc100000, v2
v_cos_f32 v116, v12
v_sin_f32 v117, v12
v_mul_f32 v12, 0xbc180000, v2
v_cos_f32 v118, v12
v_sin_f32 v119, v12
v_mul_f32 v12, 0xbc200000, v2
v_cos_f32 v120, v12
v_sin_f32 v121, v12
v_mul_f32 v12, 0xbc280000, v2
v_cos_f32 v122, v12
v_sin_f32 v123, v12
v_mul_f32 v12, 0xbc300000, v2
v_cos_f32 v124, v12
v_sin_f32 v125, v12
v_mul_f32 v12, 0xbc380000, v2
v_cos_f32 v126, v12
v_sin_f32 v127, v12
v_mul_f32 v12, 0xbc400000, v2
v_cos_f32 v128, v12
v_sin_f32 v129, v12
v_mul_f32 v12, 0xbc480000, v2
v_cos_f32 v130, v12
v_sin_f32 v131, v12
v_mul_f32 v12, 0xbc500000, v2
v_cos_f32 v132, v12
v_sin_f32 v133, v12
v_mul_f32 v12, 0xbc580000, v2
v_cos_f32 v134, v12
v_sin_f32 v135, v12
v_mul_f32 v12, 0xbc600000, v2
v_cos_f32 v136, v12
v_sin_f32 v137, v12
v_mul_f32 v12, 0xbc680000, v2
v_cos_f32 v138, v12
v_sin_f32 v139, v12
v_mul_f32 v12, 0xbc700000, v2
v_cos_f32 v140, v12
v_sin_f32 v141, v12
v_mul_f32 v12, 0xbc780000, v2
v_cos_f32 v142, v12
v_sin_f32 v143, v12
v_mov_b32 v12, v13
v_fmac_f32 v12, 0x00000000, v8
v_cos_f32 v144, v12
v_sin_f32 v145, v12
v_mov_b32 v12, v13
v_fmac_f32 v12, 0x3a800000, v8
v_cos_f32 v146, v12
v_sin_f32 v147, v12
v_mov_b32 v12, v13
v_fmac_f32 v12, 0x3b000000, v8
v_cos_f32 v148, v12
v_sin_f32 v149, v12
v_mov_b32 v12, v13
v_fmac_f32 v12, 0x3b400000, v8
v_cos_f32 v150, v12
v_sin_f32 v151, v12
v_mov_b32 v12, v13
v_fmac_f32 v12, 0x3b800000, v8
v_cos_f32 v152, v12
v_sin_f32 v153, v12
v_mov_b32 v12, v13
v_fmac_f32 v12, 0x3ba00000, v8
v_cos_f32 v154, v12
v_sin_f32 v155, v12
v_mov_b32 v12, v13
v_fmac_f32 v12, 0x3bc00000, v8
v_cos_f32 v156, v12
v_sin_f32 v157, v12
v_mov_b32 v12, v13
v_fmac_f32 v12, 0x3be00000, v8
v_cos_f32 v158, v12
v_sin_f32 v159, v12
v_mov_b32 v12, v13
v_fmac_f32 v12, 0x3c000000, v8
v_cos_f32 v160, v12
v_sin_f32 v161, v12
v_mov_b32 v12, v13
v_fmac_f32 v12, 0x3c100000, v8
v_cos_f32 v162, v12
v_sin_f32 v163, v12
v_mov_b32 v12, v13
v_fmac_f32 v12, 0x3c200000, v8
v_cos_f32 v164, v12
v_sin_f32 v165, v12
v_mov_b32 v12, v13
v_fmac_f32 v12, 0x3c300000, v8
v_cos_f32 v166, v12
v_sin_f32 v167, v12
v_mov_b32 v12, v13
v_fmac_f32 v12, 0x3c400000, v8
v_cos_f32 v168, v12
v_sin_f32 v169, v12
v_mov_b32 v12, v13
v_fmac_f32 v12, 0x3c500000, v8
v_cos_f32 v170, v12
v_sin_f32 v171, v12
v_mov_b32 v12, v13
v_fmac_f32 v12, 0x3c600000, v8
v_cos_f32 v172, v12
v_sin_f32 v173, v12
v_mov_b32 v12, v13
v_fmac_f32 v12, 0x3c700000, v8
v_cos_f32 v174, v12
v_sin_f32 v175, v12
v_mov_b32 v12, v13
v_fmac_f32 v12, 0x3c800000, v8
v_cos_f32 v176, v12
v_sin_f32 v177, v12
v_mov_b32 v12, v13
v_fmac_f32 v12, 0x3c880000, v8
v_cos_f32 v178, v12
v_sin_f32 v179, v12
v_mov_b32 v12, v13
v_fmac_f32 v12, 0x3c900000, v8
v_cos_f32 v180, v12
v_sin_f32 v181, v12
v_mov_b32 v12, v13
v_fmac_f32 v12, 0x3c980000, v8
v_cos_f32 v182, v12
v_sin_f32 v183, v12
v_mov_b32 v12, v13
v_fmac_f32 v12, 0x3ca00000, v8
v_cos_f32 v184, v12
v_sin_f32 v185, v12
v_mov_b32 v12, v13
v_fmac_f32 v12, 0x3ca80000, v8
v_cos_f32 v186, v12
v_sin_f32 v187, v12
v_mov_b32 v12, v13
v_fmac_f32 v12, 0x3cb00000, v8
v_cos_f32 v188, v12
v_sin_f32 v189, v12
v_mov_b32 v12, v13
v_fmac_f32 v12, 0x3cb80000, v8
v_cos_f32 v190, v12
v_sin_f32 v191, v12
v_mov_b32 v12, v13
v_fmac_f32 v12, 0x3cc00000, v8
v_cos_f32 v192, v12
v_sin_f32 v193, v12
v_mov_b32 v12, v13
v_fmac_f32 v12, 0x3cc80000, v8
v_cos_f32 v194, v12
v_sin_f32 v195, v12
v_mov_b32 v12, v13
v_fmac_f32 v12, 0x3cd00000, v8
v_cos_f32 v196, v12
v_sin_f32 v197, v12
v_mov_b32 v12, v13
v_fmac_f32 v12, 0x3cd80000, v8
v_cos_f32 v198, v12
v_sin_f32 v199, v12
v_mov_b32 v12, v13
v_fmac_f32 v12, 0x3ce00000, v8
v_cos_f32 v200, v12
v_sin_f32 v201, v12
v_mov_b32 v12, v13
v_fmac_f32 v12, 0x3ce80000, v8
v_cos_f32 v202, v12
v_sin_f32 v203, v12
v_mov_b32 v12, v13
v_fmac_f32 v12, 0x3cf00000, v8
v_cos_f32 v204, v12
v_sin_f32 v205, v12
v_mov_b32 v12, v13
v_fmac_f32 v12, 0x3cf80000, v8
v_cos_f32 v206, v12
v_sin_f32 v207, v12
s_nop 0
v_mul_f32 v144, 0x34800000, v144
v_mul_f32 v145, 0x34800000, v145
v_mul_f32 v146, 0x34800000, v146
v_mul_f32 v147, 0x34800000, v147
v_mul_f32 v148, 0x34800000, v148
v_mul_f32 v149, 0x34800000, v149
v_mul_f32 v150, 0x34800000, v150
v_mul_f32 v151, 0x34800000, v151
v_mul_f32 v152, 0x34800000, v152
v_mul_f32 v153, 0x34800000, v153
v_mul_f32 v154, 0x34800000, v154
v_mul_f32 v155, 0x34800000, v155
v_mul_f32 v156, 0x34800000, v156
v_mul_f32 v157, 0x34800000, v157
v_mul_f32 v158, 0x34800000, v158
v_mul_f32 v159, 0x34800000, v159
v_mul_f32 v160, 0x34800000, v160
v_mul_f32 v161, 0x34800000, v161
v_mul_f32 v162, 0x34800000, v162
v_mul_f32 v163, 0x34800000, v163
v_mul_f32 v164, 0x34800000, v164
v_mul_f32 v165, 0x34800000, v165
v_mul_f32 v166, 0x34800000, v166
v_mul_f32 v167, 0x34800000, v167
v_mul_f32 v168, 0x34800000, v168
v_mul_f32 v169, 0x34800000, v169
v_mul_f32 v170, 0x34800000, v170
v_mul_f32 v171, 0x34800000, v171
v_mul_f32 v172, 0x34800000, v172
v_mul_f32 v173, 0x34800000, v173
v_mul_f32 v174, 0x34800000, v174
v_mul_f32 v175, 0x34800000, v175
v_mul_f32 v176, 0x34800000, v176
v_mul_f32 v177, 0x34800000, v177
v_mul_f32 v178, 0x34800000, v178
v_mul_f32 v179, 0x34800000, v179
v_mul_f32 v180, 0x34800000, v180
v_mul_f32 v181, 0x34800000, v181
v_mul_f32 v182, 0x34800000, v182
v_mul_f32 v183, 0x34800000, v183
v_mul_f32 v184, 0x34800000, v184
v_mul_f32 v185, 0x34800000, v185
v_mul_f32 v186, 0x34800000, v186
v_mul_f32 v187, 0x34800000, v187
v_mul_f32 v188, 0x34800000, v188
v_mul_f32 v189, 0x34800000, v189
v_mul_f32 v190, 0x34800000, v190
v_mul_f32 v191, 0x34800000, v191
v_mul_f32 v192, 0x34800000, v192
v_mul_f32 v193, 0x34800000, v193
v_mul_f32 v194, 0x34800000, v194
v_mul_f32 v195, 0x34800000, v195
v_mul_f32 v196, 0x34800000, v196
v_mul_f32 v197, 0x34800000, v197
v_mul_f32 v198, 0x34800000, v198
v_mul_f32 v199, 0x34800000, v199
v_mul_f32 v200, 0x34800000, v200
v_mul_f32 v201, 0x34800000, v201
v_mul_f32 v202, 0x34800000, v202
v_mul_f32 v203, 0x34800000, v203
v_mul_f32 v204, 0x34800000, v204
v_mul_f32 v205, 0x34800000, v205
v_mul_f32 v206, 0x34800000, v206
v_mul_f32 v207, 0x34800000, v207
s_cmp_lt_u32 s38, s37
s_cbranch_scc0 mega_kernel_f2_e
s_lshl_b32 s12, s38, 2
s_add_u32 s12, s12, s16
s_min_u32 s12, s12, 512
s_mul_i32 s13, s12, 8192
s_mul_i32 s12, s12, 16384
s_add_u32 s12, s12, 96468992
s_add_u32 s13, s13, 121634816
buffer_load_dwordx2 a[0:1], v5, s[84:87], s12 offen offset:0 sc1
buffer_load_dwordx2 a[2:3], v5, s[84:87], s12 offen offset:512 sc1
buffer_load_dwordx2 a[4:5], v5, s[84:87], s12 offen offset:1024 sc1
buffer_load_dwordx2 a[6:7], v5, s[84:87], s12 offen offset:1536 sc1
buffer_load_dwordx2 a[8:9], v5, s[84:87], s12 offen offset:2048 sc1
buffer_load_dwordx2 a[10:11], v5, s[84:87], s12 offen offset:2560 sc1
buffer_load_dwordx2 a[12:13], v5, s[84:87], s12 offen offset:3072 sc1
buffer_load_dwordx2 a[14:15], v5, s[84:87], s12 offen offset:3584 sc1
s_add_u32 s12, s12, 4096
buffer_load_dwordx2 a[16:17], v5, s[84:87], s12 offen offset:0 sc1
buffer_load_dwordx2 a[18:19], v5, s[84:87], s12 offen offset:512 sc1
buffer_load_dwordx2 a[20:21], v5, s[84:87], s12 offen offset:1024 sc1
buffer_load_dwordx2 a[22:23], v5, s[84:87], s12 offen offset:1536 sc1
buffer_load_dwordx2 a[24:25], v5, s[84:87], s12 offen offset:2048 sc1
buffer_load_dwordx2 a[26:27], v5, s[84:87], s12 offen offset:2560 sc1
buffer_load_dwordx2 a[28:29], v5, s[84:87], s12 offen offset:3072 sc1
buffer_load_dwordx2 a[30:31], v5, s[84:87], s12 offen offset:3584 sc1
s_add_u32 s12, s12, 4096
buffer_load_dwordx2 a[32:33], v5, s[84:87], s12 offen offset:0 sc1
buffer_load_dwordx2 a[34:35], v5, s[84:87], s12 offen offset:512 sc1
buffer_load_dwordx2 a[36:37], v5, s[84:87], s12 offen offset:1024 sc1
buffer_load_dwordx2 a[38:39], v5, s[84:87], s12 offen offset:1536 sc1
buffer_load_dwordx2 a[40:41], v5, s[84:87], s12 offen offset:2048 sc1
buffer_load_dwordx2 a[42:43], v5, s[84:87], s12 offen offset:2560 sc1
buffer_load_dwordx2 a[44:45], v5, s[84:87], s12 offen offset:3072 sc1
buffer_load_dwordx2 a[46:47], v5, s[84:87], s12 offen offset:3584 sc1
s_add_u32 s12, s12, 4096
buffer_load_dwordx2 a[48:49], v5, s[84:87], s12 offen offset:0 sc1
buffer_load_dwordx2 a[50:51], v5, s[84:87], s12 offen offset:512 sc1
buffer_load_dwordx2 a[52:53], v5, s[84:87], s12 offen offset:1024 sc1
buffer_load_dwordx2 a[54:55], v5, s[84:87], s12 offen offset:1536 sc1
buffer_load_dwordx2 a[56:57], v5, s[84:87], s12 offen offset:2048 sc1
buffer_load_dwordx2 a[58:59], v5, s[84:87], s12 offen offset:2560 sc1
buffer_load_dwordx2 a[60:61], v5, s[84:87], s12 offen offset:3072 sc1
buffer_load_dwordx2 a[62:63], v5, s[84:87], s12 offen offset:3584 sc1
s_add_u32 s12, s12, 4096
buffer_load_dword a64, v11, s[84:87], s13 offen offset:0 sc1
buffer_load_dword a65, v11, s[84:87], s13 offen offset:128 sc1
buffer_load_dword a66, v11, s[84:87], s13 offen offset:256 sc1
buffer_load_dword a67, v11, s[84:87], s13 offen offset:384 sc1
buffer_load_dword a68, v11, s[84:87], s13 offen offset:512 sc1
buffer_load_dword a69, v11, s[84:87], s13 offen offset:640 sc1
buffer_load_dword a70, v11, s[84:87], s13 offen offset:768 sc1
buffer_load_dword a71, v11, s[84:87], s13 offen offset:896 sc1
buffer_load_dword a72, v11, s[84:87], s13 offen offset:1024 sc1
buffer_load_dword a73, v11, s[84:87], s13 offen offset:1152 sc1
buffer_load_dword a74, v11, s[84:87], s13 offen offset:1280 sc1
buffer_load_dword a75, v11, s[84:87], s13 offen offset:1408 sc1
buffer_load_dword a76, v11, s[84:87], s13 offen offset:1536 sc1
buffer_load_dword a77, v11, s[84:87], s13 offen offset:1664 sc1
buffer_load_dword a78, v11, s[84:87], s13 offen offset:1792 sc1
buffer_load_dword a79, v11, s[84:87], s13 offen offset:1920 sc1
buffer_load_dword a80, v11, s[84:87], s13 offen offset:2048 sc1
buffer_load_dword a81, v11, s[84:87], s13 offen offset:2176 sc1
buffer_load_dword a82, v11, s[84:87], s13 offen offset:2304 sc1
buffer_load_dword a83, v11, s[84:87], s13 offen offset:2432 sc1
buffer_load_dword a84, v11, s[84:87], s13 offen offset:2560 sc1
buffer_load_dword a85, v11, s[84:87], s13 offen offset:2688 sc1
buffer_load_dword a86, v11, s[84:87], s13 offen offset:2816 sc1
buffer_load_dword a87, v11, s[84:87], s13 offen offset:2944 sc1
buffer_load_dword a88, v11, s[84:87], s13 offen offset:3072 sc1
buffer_load_dword a89, v11, s[84:87], s13 offen offset:3200 sc1
buffer_load_dword a90, v11, s[84:87], s13 offen offset:3328 sc1
buffer_load_dword a91, v11, s[84:87], s13 offen offset:3456 sc1
buffer_load_dword a92, v11, s[84:87], s13 offen offset:3584 sc1
buffer_load_dword a93, v11, s[84:87], s13 offen offset:3712 sc1
buffer_load_dword a94, v11, s[84:87], s13 offen offset:3840 sc1
buffer_load_dword a95, v11, s[84:87], s13 offen offset:3968 sc1
s_waitcnt vmcnt(0)
mega_kernel_f2_l:
s_add_u32 s21, s38, s39
s_cmp_lt_u32 s21, s37
s_cselect_b32 s22, s21, s38
s_waitcnt vmcnt(32)
v_accvgpr_read_b32 v16, a0
v_accvgpr_read_b32 v17, a1
v_accvgpr_read_b32 v18, a2
v_accvgpr_read_b32 v19, a3
v_accvgpr_read_b32 v20, a4
v_accvgpr_read_b32 v21, a5
v_accvgpr_read_b32 v22, a6
v_accvgpr_read_b32 v23, a7
v_accvgpr_read_b32 v24, a8
v_accvgpr_read_b32 v25, a9
v_accvgpr_read_b32 v26, a10
v_accvgpr_read_b32 v27, a11
v_accvgpr_read_b32 v28, a12
v_accvgpr_read_b32 v29, a13
v_accvgpr_read_b32 v30, a14
v_accvgpr_read_b32 v31, a15
v_accvgpr_read_b32 v32, a16
v_accvgpr_read_b32 v33, a17
v_accvgpr_read_b32 v34, a18
v_accvgpr_read_b32 v35, a19
v_accvgpr_read_b32 v36, a20
v_accvgpr_read_b32 v37, a21
v_accvgpr_read_b32 v38, a22
v_accvgpr_read_b32 v39, a23
v_accvgpr_read_b32 v40, a24
v_accvgpr_read_b32 v41, a25
v_accvgpr_read_b32 v42, a26
v_accvgpr_read_b32 v43, a27
v_accvgpr_read_b32 v44, a28
v_accvgpr_read_b32 v45, a29
v_accvgpr_read_b32 v46, a30
v_accvgpr_read_b32 v47, a31
v_accvgpr_read_b32 v48, a32
v_accvgpr_read_b32 v49, a33
v_accvgpr_read_b32 v50, a34
v_accvgpr_read_b32 v51, a35
v_accvgpr_read_b32 v52, a36
v_accvgpr_read_b32 v53, a37
v_accvgpr_read_b32 v54, a38
v_accvgpr_read_b32 v55, a39
v_accvgpr_read_b32 v56, a40
v_accvgpr_read_b32 v57, a41
v_accvgpr_read_b32 v58, a42
v_accvgpr_read_b32 v59, a43
v_accvgpr_read_b32 v60, a44
v_accvgpr_read_b32 v61, a45
v_accvgpr_read_b32 v62, a46
v_accvgpr_read_b32 v63, a47
v_accvgpr_read_b32 v64, a48
v_accvgpr_read_b32 v65, a49
v_accvgpr_read_b32 v66, a50
v_accvgpr_read_b32 v67, a51
v_accvgpr_read_b32 v68, a52
v_accvgpr_read_b32 v69, a53
v_accvgpr_read_b32 v70, a54
v_accvgpr_read_b32 v71, a55
v_accvgpr_read_b32 v72, a56
v_accvgpr_read_b32 v73, a57
v_accvgpr_read_b32 v74, a58
v_accvgpr_read_b32 v75, a59
v_accvgpr_read_b32 v76, a60
v_accvgpr_read_b32 v77, a61
v_accvgpr_read_b32 v78, a62
v_accvgpr_read_b32 v79, a63
v_accvgpr_read_b32 v208, a64
v_accvgpr_read_b32 v209, a65
v_accvgpr_read_b32 v210, a66
v_accvgpr_read_b32 v211, a67
v_accvgpr_read_b32 v212, a68
v_accvgpr_read_b32 v213, a69
v_accvgpr_read_b32 v214, a70
v_accvgpr_read_b32 v215, a71
v_accvgpr_read_b32 v216, a72
v_accvgpr_read_b32 v217, a73
v_accvgpr_read_b32 v218, a74
v_accvgpr_read_b32 v219, a75
v_accvgpr_read_b32 v220, a76
v_accvgpr_read_b32 v221, a77
v_accvgpr_read_b32 v222, a78
v_accvgpr_read_b32 v223, a79
v_accvgpr_read_b32 v224, a80
v_accvgpr_read_b32 v225, a81
v_accvgpr_read_b32 v226, a82
v_accvgpr_read_b32 v227, a83
v_accvgpr_read_b32 v228, a84
v_accvgpr_read_b32 v229, a85
v_accvgpr_read_b32 v230, a86
v_accvgpr_read_b32 v231, a87
v_accvgpr_read_b32 v232, a88
v_accvgpr_read_b32 v233, a89
v_accvgpr_read_b32 v234, a90
v_accvgpr_read_b32 v235, a91
v_accvgpr_read_b32 v236, a92
v_accvgpr_read_b32 v237, a93
v_accvgpr_read_b32 v238, a94
v_accvgpr_read_b32 v239, a95
s_lshl_b32 s12, s22, 2
s_add_u32 s12, s12, s16
s_min_u32 s12, s12, 512
s_mul_i32 s13, s12, 8192
s_mul_i32 s12, s12, 16384
s_add_u32 s12, s12, 96468992
s_add_u32 s13, s13, 121634816
buffer_load_dwordx2 a[0:1], v5, s[84:87], s12 offen offset:0 sc1
buffer_load_dwordx2 a[2:3], v5, s[84:87], s12 offen offset:512 sc1
buffer_load_dwordx2 a[4:5], v5, s[84:87], s12 offen offset:1024 sc1
buffer_load_dwordx2 a[6:7], v5, s[84:87], s12 offen offset:1536 sc1
buffer_load_dwordx2 a[8:9], v5, s[84:87], s12 offen offset:2048 sc1
buffer_load_dwordx2 a[10:11], v5, s[84:87], s12 offen offset:2560 sc1
buffer_load_dwordx2 a[12:13], v5, s[84:87], s12 offen offset:3072 sc1
buffer_load_dwordx2 a[14:15], v5, s[84:87], s12 offen offset:3584 sc1
s_add_u32 s12, s12, 4096
buffer_load_dwordx2 a[16:17], v5, s[84:87], s12 offen offset:0 sc1
buffer_load_dwordx2 a[18:19], v5, s[84:87], s12 offen offset:512 sc1
buffer_load_dwordx2 a[20:21], v5, s[84:87], s12 offen offset:1024 sc1
buffer_load_dwordx2 a[22:23], v5, s[84:87], s12 offen offset:1536 sc1
buffer_load_dwordx2 a[24:25], v5, s[84:87], s12 offen offset:2048 sc1
buffer_load_dwordx2 a[26:27], v5, s[84:87], s12 offen offset:2560 sc1
buffer_load_dwordx2 a[28:29], v5, s[84:87], s12 offen offset:3072 sc1
buffer_load_dwordx2 a[30:31], v5, s[84:87], s12 offen offset:3584 sc1
s_add_u32 s12, s12, 4096
buffer_load_dwordx2 a[32:33], v5, s[84:87], s12 offen offset:0 sc1
buffer_load_dwordx2 a[34:35], v5, s[84:87], s12 offen offset:512 sc1
buffer_load_dwordx2 a[36:37], v5, s[84:87], s12 offen offset:1024 sc1
buffer_load_dwordx2 a[38:39], v5, s[84:87], s12 offen offset:1536 sc1
buffer_load_dwordx2 a[40:41], v5, s[84:87], s12 offen offset:2048 sc1
buffer_load_dwordx2 a[42:43], v5, s[84:87], s12 offen offset:2560 sc1
buffer_load_dwordx2 a[44:45], v5, s[84:87], s12 offen offset:3072 sc1
buffer_load_dwordx2 a[46:47], v5, s[84:87], s12 offen offset:3584 sc1
s_add_u32 s12, s12, 4096
buffer_load_dwordx2 a[48:49], v5, s[84:87], s12 offen offset:0 sc1
buffer_load_dwordx2 a[50:51], v5, s[84:87], s12 offen offset:512 sc1
buffer_load_dwordx2 a[52:53], v5, s[84:87], s12 offen offset:1024 sc1
buffer_load_dwordx2 a[54:55], v5, s[84:87], s12 offen offset:1536 sc1
buffer_load_dwordx2 a[56:57], v5, s[84:87], s12 offen offset:2048 sc1
buffer_load_dwordx2 a[58:59], v5, s[84:87], s12 offen offset:2560 sc1
buffer_load_dwordx2 a[60:61], v5, s[84:87], s12 offen offset:3072 sc1
buffer_load_dwordx2 a[62:63], v5, s[84:87], s12 offen offset:3584 sc1
s_add_u32 s12, s12, 4096
buffer_load_dword a64, v11, s[84:87], s13 offen offset:0 sc1
buffer_load_dword a65, v11, s[84:87], s13 offen offset:128 sc1
buffer_load_dword a66, v11, s[84:87], s13 offen offset:256 sc1
buffer_load_dword a67, v11, s[84:87], s13 offen offset:384 sc1
buffer_load_dword a68, v11, s[84:87], s13 offen offset:512 sc1
buffer_load_dword a69, v11, s[84:87], s13 offen offset:640 sc1
buffer_load_dword a70, v11, s[84:87], s13 offen offset:768 sc1
buffer_load_dword a71, v11, s[84:87], s13 offen offset:896 sc1
buffer_load_dword a72, v11, s[84:87], s13 offen offset:1024 sc1
buffer_load_dword a73, v11, s[84:87], s13 offen offset:1152 sc1
buffer_load_dword a74, v11, s[84:87], s13 offen offset:1280 sc1
buffer_load_dword a75, v11, s[84:87], s13 offen offset:1408 sc1
buffer_load_dword a76, v11, s[84:87], s13 offen offset:1536 sc1
buffer_load_dword a77, v11, s[84:87], s13 offen offset:1664 sc1
buffer_load_dword a78, v11, s[84:87], s13 offen offset:1792 sc1
buffer_load_dword a79, v11, s[84:87], s13 offen offset:1920 sc1
buffer_load_dword a80, v11, s[84:87], s13 offen offset:2048 sc1
buffer_load_dword a81, v11, s[84:87], s13 offen offset:2176 sc1
buffer_load_dword a82, v11, s[84:87], s13 offen offset:2304 sc1
buffer_load_dword a83, v11, s[84:87], s13 offen offset:2432 sc1
buffer_load_dword a84, v11, s[84:87], s13 offen offset:2560 sc1
buffer_load_dword a85, v11, s[84:87], s13 offen offset:2688 sc1
buffer_load_dword a86, v11, s[84:87], s13 offen offset:2816 sc1
buffer_load_dword a87, v11, s[84:87], s13 offen offset:2944 sc1
buffer_load_dword a88, v11, s[84:87], s13 offen offset:3072 sc1
buffer_load_dword a89, v11, s[84:87], s13 offen offset:3200 sc1
buffer_load_dword a90, v11, s[84:87], s13 offen offset:3328 sc1
buffer_load_dword a91, v11, s[84:87], s13 offen offset:3456 sc1
buffer_load_dword a92, v11, s[84:87], s13 offen offset:3584 sc1
buffer_load_dword a93, v11, s[84:87], s13 offen offset:3712 sc1
buffer_load_dword a94, v11, s[84:87], s13 offen offset:3840 sc1
buffer_load_dword a95, v11, s[84:87], s13 offen offset:3968 sc1
v_pk_add_f32 v[14:15], v[16:17], v[48:49] neg_lo:[0,1] neg_hi:[0,1]
v_pk_add_f32 v[16:17], v[16:17], v[48:49]
v_pk_add_f32 v[48:49], v[18:19], v[50:51] neg_lo:[0,1] neg_hi:[0,1]
v_pk_add_f32 v[18:19], v[18:19], v[50:51]
v_pk_mul_f32 v[50:51], v[48:49], s[50:51] op_sel:[0,0] op_sel_hi:[0,1] neg_lo:[0,0] neg_hi:[0,1]
v_pk_fma_f32 v[50:51], v[48:49], s[50:51], v[50:51] op_sel:[1,1,0] op_sel_hi:[1,0,1] neg_lo:[0,0,0] neg_hi:[0,0,0]
v_pk_add_f32 v[48:49], v[20:21], v[52:53] neg_lo:[0,1] neg_hi:[0,1]
v_pk_add_f32 v[20:21], v[20:21], v[52:53]
v_pk_mul_f32 v[52:53], v[48:49], s[54:55] op_sel:[0,0] op_sel_hi:[0,1] neg_lo:[0,0] neg_hi:[0,1]
v_pk_fma_f32 v[52:53], v[48:49], s[54:55], v[52:53] op_sel:[1,1,0] op_sel_hi:[1,0,1] neg_lo:[0,0,0] neg_hi:[0,0,0]
v_pk_add_f32 v[48:49], v[22:23], v[54:55] neg_lo:[0,1] neg_hi:[0,1]
v_pk_add_f32 v[22:23], v[22:23], v[54:55]
v_pk_mul_f32 v[54:55], v[48:49], s[58:59] op_sel:[0,0] op_sel_hi:[0,1] neg_lo:[0,0] neg_hi:[0,1]
v_pk_fma_f32 v[54:55], v[48:49], s[58:59], v[54:55] op_sel:[1,1,0] op_sel_hi:[1,0,1] neg_lo:[0,0,0] neg_hi:[0,0,0]
v_pk_add_f32 v[48:49], v[24:25], v[56:57] neg_lo:[0,1] neg_hi:[0,1]
v_pk_add_f32 v[24:25], v[24:25], v[56:57]
v_pk_mul_f32 v[56:57], v[48:49], s[62:63] op_sel:[0,0] op_sel_hi:[0,1] neg_lo:[0,0] neg_hi:[0,1]
v_pk_fma_f32 v[56:57], v[48:49], s[62:63], v[56:57] op_sel:[1,1,0] op_sel_hi:[1,0,1] neg_lo:[0,0,0] neg_hi:[0,0,0]
v_pk_add_f32 v[48:49], v[26:27], v[58:59] neg_lo:[0,1] neg_hi:[0,1]
v_pk_add_f32 v[26:27], v[26:27], v[58:59]
v_pk_mul_f32 v[58:59], v[48:49], s[58:59] op_sel:[0,1] op_sel_hi:[0,0] neg_lo:[0,0] neg_hi:[0,1]
v_pk_fma_f32 v[58:59], v[48:49], s[58:59], v[58:59] op_sel:[1,0,0] op_sel_hi:[1,1,1] neg_lo:[0,0,0] neg_hi:[0,0,0]
v_pk_add_f32 v[48:49], v[28:29], v[60:61] neg_lo:[0,1] neg_hi:[0,1]
v_pk_add_f32 v[28:29], v[28:29], v[60:61]
v_pk_mul_f32 v[60:61], v[48:49], s[54:55] op_sel:[0,1] op_sel_hi:[0,0] neg_lo:[0,0] neg_hi:[0,1]
v_pk_fma_f32 v[60:61], v[48:49], s[54:55], v[60:61] op_sel:[1,0,0] op_sel_hi:[1,1,1] neg_lo:[0,0,0] neg_hi:[0,0,0]
v_pk_add_f32 v[48:49], v[30:31], v[62:63] neg_lo:[0,1] neg_hi:[0,1]
v_pk_add_f32 v[30:31], v[30:31], v[62:63]
v_pk_mul_f32 v[62:63], v[48:49], s[50:51] op_sel:[0,1] op_sel_hi:[0,0] neg_lo:[0,0] neg_hi:[0,1]
v_pk_fma_f32 v[62:63], v[48:49], s[50:51], v[62:63] op_sel:[1,0,0] op_sel_hi:[1,1,1] neg_lo:[0,0,0] neg_hi:[0,0,0]
v_pk_add_f32 v[48:49], v[32:33], v[64:65] op_sel:[1,1] op_sel_hi:[0,0] neg_lo:[0,1] neg_hi:[1,0]
v_pk_add_f32 v[32:33], v[32:33], v[64:65]
v_pk_add_f32 v[64:65], v[34:35], v[66:67] neg_lo:[0,1] neg_hi:[0,1]
v_pk_add_f32 v[34:35], v[34:35], v[66:67]
v_pk_mul_f32 v[66:67], v[64:65], s[50:51] op_sel:[0,1] op_sel_hi:[0,0] neg_lo:[0,1] neg_hi:[0,1]
v_pk_fma_f32 v[66:67], v[64:65], s[50:51], v[66:67] op_sel:[1,0,0] op_sel_hi:[1,1,1] neg_lo:[0,0,0] neg_hi:[0,1,0]
v_pk_add_f32 v[64:65], v[36:37], v[68:69] neg_lo:[0,1] neg_hi:[0,1]
v_pk_add_f32 v[36:37], v[36:37], v[68:69]
v_pk_mul_f32 v[68:69], v[64:65], s[54:55] op_sel:[0,1] op_sel_hi:[0,0] neg_lo:[0,1] neg_hi:[0,1]
v_pk_fma_f32 v[68:69], v[64:65], s[54:55], v[68:69] op_sel:[1,0,0] op_sel_hi:[1,1,1] neg_lo:[0,0,0] neg_hi:[0,1,0]
v_pk_add_f32 v[64:65], v[38:39], v[70:71] neg_lo:[0,1] neg_hi:[0,1]
v_pk_add_f32 v[38:39], v[38:39], v[70:71]
v_pk_mul_f32 v[70:71], v[64:65], s[58:59] op_sel:[0,1] op_sel_hi:[0,0] neg_lo:[0,1] neg_hi:[0,1]
v_pk_fma_f32 v[70:71], v[64:65], s[58:59], v[70:71] op_sel:[1,0,0] op_sel_hi:[1,1,1] neg_lo:[0,0,0] neg_hi:[0,1,0]
v_pk_add_f32 v[64:65], v[40:41], v[72:73] neg_lo:[0,1] neg_hi:[0,1]
v_pk_add_f32 v[40:41], v[40:41], v[72:73]
v_pk_mul_f32 v[72:73], v[64:65], s[62:63] op_sel:[0,0] op_sel_hi:[0,1] neg_lo:[0,1] neg_hi:[0,1]
v_pk_fma_f32 v[72:73], v[64:65], s[62:63], v[72:73] op_sel:[1,1,0] op_sel_hi:[1,0,1] neg_lo:[0,0,0] neg_hi:[0,1,0]
v_pk_add_f32 v[64:65], v[42:43], v[74:75] neg_lo:[0,1] neg_hi:[0,1]
v_pk_add_f32 v[42:43], v[42:43], v[74:75]
v_pk_mul_f32 v[74:75], v[64:65], s[58:59] op_sel:[0,0] op_sel_hi:[0,1] neg_lo:[0,1] neg_hi:[0,1]
v_pk_fma_f32 v[74:75], v[64:65], s[58:59], v[74:75] op_sel:[1,1,0] op_sel_hi:[1,0,1] neg_lo:[0,0,0] neg_hi:[0,1,0]
v_pk_add_f32 v[64:65], v[44:45], v[76:77] neg_lo:[0,1] neg_hi:[0,1]
v_pk_add_f32 v[44:45], v[44:45], v[76:77]
v_pk_mul_f32 v[76:77], v[64:65], s[54:55] op_sel:[0,0] op_sel_hi:[0,1] neg_lo:[0,1] neg_hi:[0,1]
v_pk_fma_f32 v[76:77], v[64:65], s[54:55], v[76:77] op_sel:[1,1,0] op_sel_hi:[1,0,1] neg_lo:[0,0,0] neg_hi:[0,1,0]
v_pk_add_f32 v[64:65], v[46:47], v[78:79] neg_lo:[0,1] neg_hi:[0,1]
v_pk_add_f32 v[46:47], v[46:47], v[78:79]
v_pk_mul_f32 v[78:79], v[64:65], s[50:51] op_sel:[0,0] op_sel_hi:[0,1] neg_lo:[0,1] neg_hi:[0,1]
v_pk_fma_f32 v[78:79], v[64:65], s[50:51], v[78:79] op_sel:[1,1,0] op_sel_hi:[1,0,1] neg_lo:[0,0,0] neg_hi:[0,1,0]
v_pk_add_f32 v[64:65], v[16:17], v[32:33] neg_lo:[0,1] neg_hi:[0,1]
v_pk_add_f32 v[16:17], v[16:17], v[32:33]
v_pk_add_f32 v[32:33], v[18:19], v[34:35] neg_lo:[0,1] neg_hi:[0,1]
v_pk_add_f32 v[18:19], v[18:19], v[34:35]
v_pk_mul_f32 v[34:35], v[32:33], s[54:55] op_sel:[0,0] op_sel_hi:[0,1] neg_lo:[0,0] neg_hi:[0,1]
v_pk_fma_f32 v[34:35], v[32:33], s[54:55], v[34:35] op_sel:[1,1,0] op_sel_hi:[1,0,1] neg_lo:[0,0,0] neg_hi:[0,0,0]
v_pk_add_f32 v[32:33], v[20:21], v[36:37] neg_lo:[0,1] neg_hi:[0,1]
v_pk_add_f32 v[20:21], v[20:21], v[36:37]
v_pk_mul_f32 v[36:37], v[32:33], s[62:63] op_sel:[0,0] op_sel_hi:[0,1] neg_lo:[0,0] neg_hi:[0,1]
v_pk_fma_f32 v[36:37], v[32:33], s[62:63], v[36:37] op_sel:[1,1,0] op_sel_hi:[1,0,1] neg_lo:[0,0,0] neg_hi:[0,0,0]
v_pk_add_f32 v[32:33], v[22:23], v[38:39] neg_lo:[0,1] neg_hi:[0,1]
v_pk_add_f32 v[22:23], v[22:23], v[38:39]
v_pk_mul_f32 v[38:39], v[32:33], s[54:55] op_sel:[0,1] op_sel_hi:[0,0] neg_lo:[0,0] neg_hi:[0,1]
v_pk_fma_f32 v[38:39], v[32:33], s[54:55], v[38:39] op_sel:[1,0,0] op_sel_hi:[1,1,1] neg_lo:[0,0,0] neg_hi:[0,0,0]
v_pk_add_f32 v[32:33], v[24:25], v[40:41] op_sel:[1,1] op_sel_hi:[0,0] neg_lo:[0,1] neg_hi:[1,0]
v_pk_add_f32 v[24:25], v[24:25], v[40:41]
v_pk_add_f32 v[40:41], v[26:27], v[42:43] neg_lo:[0,1] neg_hi:[0,1]
v_pk_add_f32 v[26:27], v[26:27], v[42:43]
v_pk_mul_f32 v[42:43], v[40:41], s[54:55] op_sel:[0,1] op_sel_hi:[0,0] neg_lo:[0,1] neg_hi:[0,1]
v_pk_fma_f32 v[42:43], v[40:41], s[54:55], v[42:43] op_sel:[1,0,0] op_sel_hi:[1,1,1] neg_lo:[0,0,0] neg_hi:[0,1,0]
v_pk_add_f32 v[40:41], v[28:29], v[44:45] neg_lo:[0,1] neg_hi:[0,1]
v_pk_add_f32 v[28:29], v[28:29], v[44:45]
v_pk_mul_f32 v[44:45], v[40:41], s[62:63] op_sel:[0,0] op_sel_hi:[0,1] neg_lo:[0,1] neg_hi:[0,1]
v_pk_fma_f32 v[44:45], v[40:41], s[62:63], v[44:45] op_sel:[1,1,0] op_sel_hi:[1,0,1] neg_lo:[0,0,0] neg_hi:[0,1,0]
v_pk_add_f32 v[40:41], v[30:31], v[46:47] neg_lo:[0,1] neg_hi:[0,1]
v_pk_add_f32 v[30:31], v[30:31], v[46:47]
v_pk_mul_f32 v[46:47], v[40:41], s[54:55] op_sel:[0,0] op_sel_hi:[0,1] neg_lo:[0,1] neg_hi:[0,1]
v_pk_fma_f32 v[46:47], v[40:41], s[54:55], v[46:47] op_sel:[1,1,0] op_sel_hi:[1,0,1] neg_lo:[0,0,0] neg_hi:[0,1,0]
v_pk_add_f32 v[40:41], v[14:15], v[48:49] neg_lo:[0,1] neg_hi:[0,1]
v_pk_add_f32 v[14:15], v[14:15], v[48:49]
v_pk_add_f32 v[48:49], v[50:51], v[66:67] neg_lo:[0,1] neg_hi:[0,1]
v_pk_add_f32 v[50:51], v[50:51], v[66:67]
v_pk_mul_f32 v[66:67], v[48:49], s[54:55] op_sel:[0,0] op_sel_hi:[0,1] neg_lo:[0,0] neg_hi:[0,1]
v_pk_fma_f32 v[66:67], v[48:49], s[54:55], v[66:67] op_sel:[1,1,0] op_sel_hi:[1,0,1] neg_lo:[0,0,0] neg_hi:[0,0,0]
v_pk_add_f32 v[48:49], v[52:53], v[68:69] neg_lo:[0,1] neg_hi:[0,1]
v_pk_add_f32 v[52:53], v[52:53], v[68:69]
v_pk_mul_f32 v[68:69], v[48:49], s[62:63] op_sel:[0,0] op_sel_hi:[0,1] neg_lo:[0,0] neg_hi:[0,1]
v_pk_fma_f32 v[68:69], v[48:49], s[62:63], v[68:69] op_sel:[1,1,0] op_sel_hi:[1,0,1] neg_lo:[0,0,0] neg_hi:[0,0,0]
v_pk_add_f32 v[48:49], v[54:55], v[70:71] neg_lo:[0,1] neg_hi:[0,1]
v_pk_add_f32 v[54:55], v[54:55], v[70:71]
v_pk_mul_f32 v[70:71], v[48:49], s[54:55] op_sel:[0,1] op_sel_hi:[0,0] neg_lo:[0,0] neg_hi:[0,1]
v_pk_fma_f32 v[70:71], v[48:49], s[54:55], v[70:71] op_sel:[1,0,0] op_sel_hi:[1,1,1] neg_lo:[0,0,0] neg_hi:[0,0,0]
v_pk_add_f32 v[48:49], v[56:57], v[72:73] op_sel:[1,1] op_sel_hi:[0,0] neg_lo:[0,1] neg_hi:[1,0]
v_pk_add_f32 v[56:57], v[56:57], v[72:73]
v_pk_add_f32 v[72:73], v[58:59], v[74:75] neg_lo:[0,1] neg_hi:[0,1]
v_pk_add_f32 v[58:59], v[58:59], v[74:75]
v_pk_mul_f32 v[74:75], v[72:73], s[54:55] op_sel:[0,1] op_sel_hi:[0,0] neg_lo:[0,1] neg_hi:[0,1]
v_pk_fma_f32 v[74:75], v[72:73], s[54:55], v[74:75] op_sel:[1,0,0] op_sel_hi:[1,1,1] neg_lo:[0,0,0] neg_hi:[0,1,0]
v_pk_add_f32 v[72:73], v[60:61], v[76:77] neg_lo:[0,1] neg_hi:[0,1]
v_pk_add_f32 v[60:61], v[60:61], v[76:77]
v_pk_mul_f32 v[76:77], v[72:73], s[62:63] op_sel:[0,0] op_sel_hi:[0,1] neg_lo:[0,1] neg_hi:[0,1]
v_pk_fma_f32 v[76:77], v[72:73], s[62:63], v[76:77] op_sel:[1,1,0] op_sel_hi:[1,0,1] neg_lo:[0,0,0] neg_hi:[0,1,0]
v_pk_add_f32 v[72:73], v[62:63], v[78:79] neg_lo:[0,1] neg_hi:[0,1]
v_pk_add_f32 v[62:63], v[62:63], v[78:79]
v_pk_mul_f32 v[78:79], v[72:73], s[54:55] op_sel:[0,0] op_sel_hi:[0,1] neg_lo:[0,1] neg_hi:[0,1]
v_pk_fma_f32 v[78:79], v[72:73], s[54:55], v[78:79] op_sel:[1,1,0] op_sel_hi:[1,0,1] neg_lo:[0,0,0] neg_hi:[0,1,0]
v_pk_add_f32 v[72:73], v[16:17], v[24:25] neg_lo:[0,1] neg_hi:[0,1]
v_pk_add_f32 v[16:17], v[16:17], v[24:25]
v_pk_add_f32 v[24:25], v[18:19], v[26:27] neg_lo:[0,1] neg_hi:[0,1]
v_pk_add_f32 v[18:19], v[18:19], v[26:27]
v_pk_mul_f32 v[26:27], v[24:25], s[62:63] op_sel:[0,0] op_sel_hi:[0,1] neg_lo:[0,0] neg_hi:[0,1]
v_pk_fma_f32 v[26:27], v[24:25], s[62:63], v[26:27] op_sel:[1,1,0] op_sel_hi:[1,0,1] neg_lo:[0,0,0] neg_hi:[0,0,0]
v_pk_add_f32 v[24:25], v[20:21], v[28:29] op_sel:[1,1] op_sel_hi:[0,0] neg_lo:[0,1] neg_hi:[1,0]
v_pk_add_f32 v[20:21], v[20:21], v[28:29]
v_pk_add_f32 v[28:29], v[22:23], v[30:31] neg_lo:[0,1] neg_hi:[0,1]
v_pk_add_f32 v[22:23], v[22:23], v[30:31]
v_pk_mul_f32 v[30:31], v[28:29], s[62:63] op_sel:[0,0] op_sel_hi:[0,1] neg_lo:[0,1] neg_hi:[0,1]
v_pk_fma_f32 v[30:31], v[28:29], s[62:63], v[30:31] op_sel:[1,1,0] op_sel_hi:[1,0,1] neg_lo:[0,0,0] neg_hi:[0,1,0]
v_pk_add_f32 v[28:29], v[64:65], v[32:33] neg_lo:[0,1] neg_hi:[0,1]
v_pk_add_f32 v[64:65], v[64:65], v[32:33]
v_pk_add_f32 v[32:33], v[34:35], v[42:43] neg_lo:[0,1] neg_hi:[0,1]
v_pk_add_f32 v[34:35], v[34:35], v[42:43]
v_pk_mul_f32 v[42:43], v[32:33], s[62:63] op_sel:[0,0] op_sel_hi:[0,1] neg_lo:[0,0] neg_hi:[0,1]
v_pk_fma_f32 v[42:43], v[32:33], s[62:63], v[42:43] op_sel:[1,1,0] op_sel_hi:[1,0,1] neg_lo:[0,0,0] neg_hi:[0,0,0]
v_pk_add_f32 v[32:33], v[36:37], v[44:45] op_sel:[1,1] op_sel_hi:[0,0] neg_lo:[0,1] neg_hi:[1,0]
v_pk_add_f32 v[36:37], v[36:37], v[44:45]
v_pk_add_f32 v[44:45], v[38:39], v[46:47] neg_lo:[0,1] neg_hi:[0,1]
v_pk_add_f32 v[38:39], v[38:39], v[46:47]
v_pk_mul_f32 v[46:47], v[44:45], s[62:63] op_sel:[0,0] op_sel_hi:[0,1] neg_lo:[0,1] neg_hi:[0,1]
v_pk_fma_f32 v[46:47], v[44:45], s[62:63], v[46:47] op_sel:[1,1,0] op_sel_hi:[1,0,1] neg_lo:[0,0,0] neg_hi:[0,1,0]
v_pk_add_f32 v[44:45], v[14:15], v[56:57] neg_lo:[0,1] neg_hi:[0,1]
v_pk_add_f32 v[14:15], v[14:15], v[56:57]
v_pk_add_f32 v[56:57], v[50:51], v[58:59] neg_lo:[0,1] neg_hi:[0,1]
v_pk_add_f32 v[50:51], v[50:51], v[58:59]
v_pk_mul_f32 v[58:59], v[56:57], s[62:63] op_sel:[0,0] op_sel_hi:[0,1] neg_lo:[0,0] neg_hi:[0,1]
v_pk_fma_f32 v[58:59], v[56:57], s[62:63], v[58:59] op_sel:[1,1,0] op_sel_hi:[1,0,1] neg_lo:[0,0,0] neg_hi:[0,0,0]
v_pk_add_f32 v[56:57], v[52:53], v[60:61] op_sel:[1,1] op_sel_hi:[0,0] neg_lo:[0,1] neg_hi:[1,0]
v_pk_add_f32 v[52:53], v[52:53], v[60:61]
v_pk_add_f32 v[60:61], v[54:55], v[62:63] neg_lo:[0,1] neg_hi:[0,1]
v_pk_add_f32 v[54:55], v[54:55], v[62:63]
v_pk_mul_f32 v[62:63], v[60:61], s[62:63] op_sel:[0,0] op_sel_hi:[0,1] neg_lo:[0,1] neg_hi:[0,1]
v_pk_fma_f32 v[62:63], v[60:61], s[62:63], v[62:63] op_sel:[1,1,0] op_sel_hi:[1,0,1] neg_lo:[0,0,0] neg_hi:[0,1,0]
v_pk_add_f32 v[60:61], v[40:41], v[48:49] neg_lo:[0,1] neg_hi:[0,1]
v_pk_add_f32 v[40:41], v[40:41], v[48:49]
v_pk_add_f32 v[48:49], v[66:67], v[74:75] neg_lo:[0,1] neg_hi:[0,1]
v_pk_add_f32 v[66:67], v[66:67], v[74:75]
v_pk_mul_f32 v[74:75], v[48:49], s[62:63] op_sel:[0,0] op_sel_hi:[0,1] neg_lo:[0,0] neg_hi:[0,1]
v_pk_fma_f32 v[74:75], v[48:49], s[62:63], v[74:75] op_sel:[1,1,0] op_sel_hi:[1,0,1] neg_lo:[0,0,0] neg_hi:[0,0,0]
v_pk_add_f32 v[48:49], v[68:69], v[76:77] op_sel:[1,1] op_sel_hi:[0,0] neg_lo:[0,1] neg_hi:[1,0]
v_pk_add_f32 v[68:69], v[68:69], v[76:77]
v_pk_add_f32 v[76:77], v[70:71], v[78:79] neg_lo:[0,1] neg_hi:[0,1]
v_pk_add_f32 v[70:71], v[70:71], v[78:79]
v_pk_mul_f32 v[78:79], v[76:77], s[62:63] op_sel:[0,0] op_sel_hi:[0,1] neg_lo:[0,1] neg_hi:[0,1]
v_pk_fma_f32 v[78:79], v[76:77], s[62:63], v[78:79] op_sel:[1,1,0] op_sel_hi:[1,0,1] neg_lo:[0,0,0] neg_hi:[0,1,0]
v_pk_add_f32 v[76:77], v[16:17], v[20:21] neg_lo:[0,1] neg_hi:[0,1]
v_pk_add_f32 v[16:17], v[16:17], v[20:21]
v_pk_add_f32 v[20:21], v[18:19], v[22:23] op_sel:[1,1] op_sel_hi:[0,0] neg_lo:[0,1] neg_hi:[1,0]
v_pk_add_f32 v[18:19], v[18:19], v[22:23]
v_pk_add_f32 v[22:23], v[72:73], v[24:25] neg_lo:[0,1] neg_hi:[0,1]
v_pk_add_f32 v[72:73], v[72:73], v[24:25]
v_pk_add_f32 v[24:25], v[26:27], v[30:31] op_sel:[1,1] op_sel_hi:[0,0] neg_lo:[0,1] neg_hi:[1,0]
v_pk_add_f32 v[26:27], v[26:27], v[30:31]
v_pk_add_f32 v[30:31], v[64:65], v[36:37] neg_lo:[0,1] neg_hi:[0,1]
v_pk_add_f32 v[64:65], v[64:65], v[36:37]
v_pk_add_f32 v[36:37], v[34:35], v[38:39] op_sel:[1,1] op_sel_hi:[0,0] neg_lo:[0,1] neg_hi:[1,0]
v_pk_add_f32 v[34:35], v[34:35], v[38:39]
v_pk_add_f32 v[38:39], v[28:29], v[32:33] neg_lo:[0,1] neg_hi:[0,1]
v_pk_add_f32 v[28:29], v[28:29], v[32:33]
v_pk_add_f32 v[32:33], v[42:43], v[46:47] op_sel:[1,1] op_sel_hi:[0,0] neg_lo:[0,1] neg_hi:[1,0]
v_pk_add_f32 v[42:43], v[42:43], v[46:47]
v_pk_add_f32 v[46:47], v[14:15], v[52:53] neg_lo:[0,1] neg_hi:[0,1]
v_pk_add_f32 v[14:15], v[14:15], v[52:53]
v_pk_add_f32 v[52:53], v[50:51], v[54:55] op_sel:[1,1] op_sel_hi:[0,0] neg_lo:[0,1] neg_hi:[1,0]
v_pk_add_f32 v[50:51], v[50:51], v[54:55]
v_pk_add_f32 v[54:55], v[44:45], v[56:57] neg_lo:[0,1] neg_hi:[0,1]
v_pk_add_f32 v[44:45], v[44:45], v[56:57]
v_pk_add_f32 v[56:57], v[58:59], v[62:63] op_sel:[1,1] op_sel_hi:[0,0] neg_lo:[0,1] neg_hi:[1,0]
v_pk_add_f32 v[58:59], v[58:59], v[62:63]
v_pk_add_f32 v[62:63], v[40:41], v[68:69] neg_lo:[0,1] neg_hi:[0,1]
v_pk_add_f32 v[40:41], v[40:41], v[68:69]
v_pk_add_f32 v[68:69], v[66:67], v[70:71] op_sel:[1,1] op_sel_hi:[0,0] neg_lo:[0,1] neg_hi:[1,0]
v_pk_add_f32 v[66:67], v[66:67], v[70:71]
v_pk_add_f32 v[70:71], v[60:61], v[48:49] neg_lo:[0,1] neg_hi:[0,1]
v_pk_add_f32 v[60:61], v[60:61], v[48:49]
v_pk_add_f32 v[48:49], v[74:75], v[78:79] op_sel:[1,1] op_sel_hi:[0,0] neg_lo:[0,1] neg_hi:[1,0]
v_pk_add_f32 v[74:75], v[74:75], v[78:79]
v_pk_add_f32 v[78:79], v[16:17], v[18:19] neg_lo:[0,1] neg_hi:[0,1]
v_pk_add_f32 v[16:17], v[16:17], v[18:19]
v_pk_add_f32 v[18:19], v[76:77], v[20:21] neg_lo:[0,1] neg_hi:[0,1]
v_pk_add_f32 v[76:77], v[76:77], v[20:21]
v_pk_add_f32 v[20:21], v[72:73], v[26:27] neg_lo:[0,1] neg_hi:[0,1]
v_pk_add_f32 v[72:73], v[72:73], v[26:27]
v_pk_add_f32 v[26:27], v[22:23], v[24:25] neg_lo:[0,1] neg_hi:[0,1]
v_pk_add_f32 v[22:23], v[22:23], v[24:25]
v_pk_add_f32 v[24:25], v[64:65], v[34:35] neg_lo:[0,1] neg_hi:[0,1]
v_pk_add_f32 v[64:65], v[64:65], v[34:35]
v_pk_add_f32 v[34:35], v[30:31], v[36:37] neg_lo:[0,1] neg_hi:[0,1]
v_pk_add_f32 v[30:31], v[30:31], v[36:37]
v_pk_add_f32 v[36:37], v[28:29], v[42:43] neg_lo:[0,1] neg_hi:[0,1]
v_pk_add_f32 v[28:29], v[28:29], v[42:43]
v_pk_add_f32 v[42:43], v[38:39], v[32:33] neg_lo:[0,1] neg_hi:[0,1]
v_pk_add_f32 v[38:39], v[38:39], v[32:33]
v_pk_add_f32 v[32:33], v[14:15], v[50:51] neg_lo:[0,1] neg_hi:[0,1]
v_pk_add_f32 v[14:15], v[14:15], v[50:51]
v_pk_add_f32 v[50:51], v[46:47], v[52:53] neg_lo:[0,1] neg_hi:[0,1]
v_pk_add_f32 v[46:47], v[46:47], v[52:53]
v_pk_add_f32 v[52:53], v[44:45], v[58:59] neg_lo:[0,1] neg_hi:[0,1]
v_pk_add_f32 v[44:45], v[44:45], v[58:59]
v_pk_add_f32 v[58:59], v[54:55], v[56:57] neg_lo:[0,1] neg_hi:[0,1]
v_pk_add_f32 v[54:55], v[54:55], v[56:57]
v_pk_add_f32 v[56:57], v[40:41], v[66:67] neg_lo:[0,1] neg_hi:[0,1]
v_pk_add_f32 v[40:41], v[40:41], v[66:67]
v_pk_add_f32 v[66:67], v[62:63], v[68:69] neg_lo:[0,1] neg_hi:[0,1]
v_pk_add_f32 v[62:63], v[62:63], v[68:69]
v_pk_add_f32 v[68:69], v[60:61], v[74:75] neg_lo:[0,1] neg_hi:[0,1]
v_pk_add_f32 v[60:61], v[60:61], v[74:75]
v_pk_add_f32 v[74:75], v[70:71], v[48:49] neg_lo:[0,1] neg_hi:[0,1]
v_pk_add_f32 v[70:71], v[70:71], v[48:49]
v_pk_mul_f32 v[48:49], v[14:15], v[82:83] op_sel:[0,0] op_sel_hi:[0,1] neg_lo:[0,0] neg_hi:[0,0]
v_pk_fma_f32 v[14:15], v[14:15], v[82:83], v[48:49] op_sel:[1,1,0] op_sel_hi:[1,0,1] neg_lo:[0,1,0] neg_hi:[0,0,0]
v_pk_mul_f32 v[48:49], v[64:65], v[84:85] op_sel:[0,0] op_sel_hi:[0,1] neg_lo:[0,0] neg_hi:[0,0]
v_pk_fma_f32 v[64:65], v[64:65], v[84:85], v[48:49] op_sel:[1,1,0] op_sel_hi:[1,0,1] neg_lo:[0,1,0] neg_hi:[0,0,0]
v_pk_mul_f32 v[48:49], v[40:41], v[86:87] op_sel:[0,0] op_sel_hi:[0,1] neg_lo:[0,0] neg_hi:[0,0]
v_pk_fma_f32 v[40:41], v[40:41], v[86:87], v[48:49] op_sel:[1,1,0] op_sel_hi:[1,0,1] neg_lo:[0,1,0] neg_hi:[0,0,0]
v_pk_mul_f32 v[48:49], v[72:73], v[88:89] op_sel:[0,0] op_sel_hi:[0,1] neg_lo:[0,0] neg_hi:[0,0]
v_pk_fma_f32 v[72:73], v[72:73], v[88:89], v[48:49] op_sel:[1,1,0] op_sel_hi:[1,0,1] neg_lo:[0,1,0] neg_hi:[0,0,0]
v_pk_mul_f32 v[48:49], v[44:45], v[90:91] op_sel:[0,0] op_sel_hi:[0,1] neg_lo:[0,0] neg_hi:[0,0]
v_pk_fma_f32 v[44:45], v[44:45], v[90:91], v[48:49] op_sel:[1,1,0] op_sel_hi:[1,0,1] neg_lo:[0,1,0] neg_hi:[0,0,0]
v_pk_mul_f32 v[48:49], v[28:29], v[92:93] op_sel:[0,0] op_sel_hi:[0,1] neg_lo:[0,0] neg_hi:[0,0]
v_pk_fma_f32 v[28:29], v[28:29], v[92:93], v[48:49] op_sel:[1,1,0] op_sel_hi:[1,0,1] neg_lo:[0,1,0] neg_hi:[0,0,0]
v_pk_mul_f32 v[48:49], v[60:61], v[94:95] op_sel:[0,0] op_sel_hi:[0,1] neg_lo:[0,0] neg_hi:[0,0]
v_pk_fma_f32 v[60:61], v[60:61], v[94:95], v[48:49] op_sel:[1,1,0] op_sel_hi:[1,0,1] neg_lo:[0,1,0] neg_hi:[0,0,0]
v_pk_mul_f32 v[48:49], v[76:77], v[96:97] op_sel:[0,0] op_sel_hi:[0,1] neg_lo:[0,0] neg_hi:[0,0]
v_pk_fma_f32 v[76:77], v[76:77], v[96:97], v[48:49] op_sel:[1,1,0] op_sel_hi:[1,0,1] neg_lo:[0,1,0] neg_hi:[0,0,0]
v_pk_mul_f32 v[48:49], v[46:47], v[98:99] op_sel:[0,0] op_sel_hi:[0,1] neg_lo:[0,0] neg_hi:[0,0]
v_pk_fma_f32 v[46:47], v[46:47], v[98:99], v[48:49] op_sel:[1,1,0] op_sel_hi:[1,0,1] neg_lo:[0,1,0] neg_hi:[0,0,0]
v_pk_mul_f32 v[48:49], v[30:31], v[100:101] op_sel:[0,0] op_sel_hi:[0,1] neg_lo:[0,0] neg_hi:[0,0]
v_pk_fma_f32 v[30:31], v[30:31], v[100:101], v[48:49] op_sel:[1,1,0] op_sel_hi:[1,0,1] neg_lo:[0,1,0] neg_hi:[0,0,0]
v_pk_mul_f32 v[48:49], v[62:63], v[102:103] op_sel:[0,0] op_sel_hi:[0,1] neg_lo:[0,0] neg_hi:[0,0]
v_pk_fma_f32 v[62:63], v[62:63], v[102:103], v[48:49] op_sel:[1,1,0] op_sel_hi:[1,0,1] neg_lo:[0,1,0] neg_hi:[0,0,0]
v_pk_mul_f32 v[48:49], v[22:23], v[104:105] op_sel:[0,0] op_sel_hi:[0,1] neg_lo:[0,0] neg_hi:[0,0]
v_pk_fma_f32 v[22:23], v[22:23], v[104:105], v[48:49] op_sel:[1,1,0] op_sel_hi:[1,0,1] neg_lo:[0,1,0] neg_hi:[0,0,0]
v_pk_mul_f32 v[48:49], v[54:55], v[106:107] op_sel:[0,0] op_sel_hi:[0,1] neg_lo:[0,0] neg_hi:[0,0]
v_pk_fma_f32 v[54:55], v[54:55], v[106:107], v[48:49] op_sel:[1,1,0] op_sel_hi:[1,0,1] neg_lo:[0,1,0] neg_hi:[0,0,0]
v_pk_mul_f32 v[48:49], v[38:39], v[108:109] op_sel:[0,0] op_sel_hi:[0,1] neg_lo:[0,0] neg_hi:[0,0]
v_pk_fma_f32 v[38:39], v[38:39], v[108:109], v[48:49] op_sel:[1,1,0] op_sel_hi:[1,0,1] neg_lo:[0,1,0] neg_hi:[0,0,0]
v_pk_mul_f32 v[48:49], v[70:71], v[110:111] op_sel:[0,0] op_sel_hi:[0,1] neg_lo:[0,0] neg_hi:[0,0]
v_pk_fma_f32 v[70:71], v[70:71], v[110:111], v[48:49] op_sel:[1,1,0] op_sel_hi:[1,0,1] neg_lo:[0,1,0] neg_hi:[0,0,0]
v_pk_mul_f32 v[48:49], v[78:79], v[112:113] op_sel:[0,0] op_sel_hi:[0,1] neg_lo:[0,0] neg_hi:[0,0]
v_pk_fma_f32 v[78:79], v[78:79], v[112:113], v[48:49] op_sel:[1,1,0] op_sel_hi:[1,0,1] neg_lo:[0,1,0] neg_hi:[0,0,0]
v_pk_mul_f32 v[48:49], v[32:33], v[114:115] op_sel:[0,0] op_sel_hi:[0,1] neg_lo:[0,0] neg_hi:[0,0]
v_pk_fma_f32 v[32:33], v[32:33], v[114:115], v[48:49] op_sel:[1,1,0] op_sel_hi:[1,0,1] neg_lo:[0,1,0] neg_hi:[0,0,0]
v_pk_mul_f32 v[48:49], v[24:25], v[116:117] op_sel:[0,0] op_sel_hi:[0,1] neg_lo:[0,0] neg_hi:[0,0]
v_pk_fma_f32 v[24:25], v[24:25], v[116:117], v[48:49] op_sel:[1,1,0] op_sel_hi:[1,0,1] neg_lo:[0,1,0] neg_hi:[0,0,0]
v_pk_mul_f32 v[48:49], v[56:57], v[118:119] op_sel:[0,0] op_sel_hi:[0,1] neg_lo:[0,0] neg_hi:[0,0]
v_pk_fma_f32 v[56:57], v[56:57], v[118:119], v[48:49] op_sel:[1,1,0] op_sel_hi:[1,0,1] neg_lo:[0,1,0] neg_hi:[0,0,0]
v_pk_mul_f32 v[48:49], v[20:21], v[120:121] op_sel:[0,0] op_sel_hi:[0,1] neg_lo:[0,0] neg_hi:[0,0]
v_pk_fma_f32 v[20:21], v[20:21], v[120:121], v[48:49] op_sel:[1,1,0] op_sel_hi:[1,0,1] neg_lo:[0,1,0] neg_hi:[0,0,0]
v_pk_mul_f32 v[48:49], v[52:53], v[122:123] op_sel:[0,0] op_sel_hi:[0,1] neg_lo:[0,0] neg_hi:[0,0]
v_pk_fma_f32 v[52:53], v[52:53], v[122:123], v[48:49] op_sel:[1,1,0] op_sel_hi:[1,0,1] neg_lo:[0,1,0] neg_hi:[0,0,0]
v_pk_mul_f32 v[48:49], v[36:37], v[124:125] op_sel:[0,0] op_sel_hi:[0,1] neg_lo:[0,0] neg_hi:[0,0]
v_pk_fma_f32 v[36:37], v[36:37], v[124:125], v[48:49] op_sel:[1,1,0] op_sel_hi:[1,0,1] neg_lo:[0,1,0] neg_hi:[0,0,0]
v_pk_mul_f32 v[48:49], v[68:69], v[126:127] op_sel:[0,0] op_sel_hi:[0,1] neg_lo:[0,0] neg_hi:[0,0]
v_pk_fma_f32 v[68:69], v[68:69], v[126:127], v[48:49] op_sel:[1,1,0] op_sel_hi:[1,0,1] neg_lo:[0,1,0] neg_hi:[0,0,0]
v_pk_mul_f32 v[48:49], v[18:19], v[128:129] op_sel:[0,0] op_sel_hi:[0,1] neg_lo:[0,0] neg_hi:[0,0]
v_pk_fma_f32 v[18:19], v[18:19], v[128:129], v[48:49] op_sel:[1,1,0] op_sel_hi:[1,0,1] neg_lo:[0,1,0] neg_hi:[0,0,0]
v_pk_mul_f32 v[48:49], v[50:51], v[130:131] op_sel:[0,0] op_sel_hi:[0,1] neg_lo:[0,0] neg_hi:[0,0]
v_pk_fma_f32 v[50:51], v[50:51], v[130:131], v[48:49] op_sel:[1,1,0] op_sel_hi:[1,0,1] neg_lo:[0,1,0] neg_hi:[0,0,0]
v_pk_mul_f32 v[48:49], v[34:35], v[132:133] op_sel:[0,0] op_sel_hi:[0,1] neg_lo:[0,0] neg_hi:[0,0]
v_pk_fma_f32 v[34:35], v[34:35], v[132:133], v[48:49] op_sel:[1,1,0] op_sel_hi:[1,0,1] neg_lo:[0,1,0] neg_hi:[0,0,0]
v_pk_mul_f32 v[48:49], v[66:67], v[134:135] op_sel:[0,0] op_sel_hi:[0,1] neg_lo:[0,0] neg_hi:[0,0]
v_pk_fma_f32 v[66:67], v[66:67], v[134:135], v[48:49] op_sel:[1,1,0] op_sel_hi:[1,0,1] neg_lo:[0,1,0] neg_hi:[0,0,0]
v_pk_mul_f32 v[48:49], v[26:27], v[136:137] op_sel:[0,0] op_sel_hi:[0,1] neg_lo:[0,0] neg_hi:[0,0]
v_pk_fma_f32 v[26:27], v[26:27], v[136:137], v[48:49] op_sel:[1,1,0] op_sel_hi:[1,0,1] neg_lo:[0,1,0] neg_hi:[0,0,0]
v_pk_mul_f32 v[48:49], v[58:59], v[138:139] op_sel:[0,0] op_sel_hi:[0,1] neg_lo:[0,0] neg_hi:[0,0]
v_pk_fma_f32 v[58:59], v[58:59], v[138:139], v[48:49] op_sel:[1,1,0] op_sel_hi:[1,0,1] neg_lo:[0,1,0] neg_hi:[0,0,0]
v_pk_mul_f32 v[48:49], v[42:43], v[140:141] op_sel:[0,0] op_sel_hi:[0,1] neg_lo:[0,0] neg_hi:[0,0]
v_pk_fma_f32 v[42:43], v[42:43], v[140:141], v[48:49] op_sel:[1,1,0] op_sel_hi:[1,0,1] neg_lo:[0,1,0] neg_hi:[0,0,0]
v_pk_mul_f32 v[48:49], v[74:75], v[142:143] op_sel:[0,0] op_sel_hi:[0,1] neg_lo:[0,0] neg_hi:[0,0]
v_pk_fma_f32 v[74:75], v[74:75], v[142:143], v[48:49] op_sel:[1,1,0] op_sel_hi:[1,0,1] neg_lo:[0,1,0] neg_hi:[0,0,0]
ds_write_b64 v3, v[16:17] offset:0
ds_write_b64 v3, v[14:15] offset:528
ds_write_b64 v3, v[64:65] offset:1056
ds_write_b64 v3, v[40:41] offset:1584
ds_write_b64 v3, v[72:73] offset:2112
ds_write_b64 v3, v[44:45] offset:2640
ds_write_b64 v3, v[28:29] offset:3168
ds_write_b64 v3, v[60:61] offset:3696
ds_write_b64 v3, v[76:77] offset:4224
ds_write_b64 v3, v[46:47] offset:4752
ds_write_b64 v3, v[30:31] offset:5280
ds_write_b64 v3, v[62:63] offset:5808
ds_write_b64 v3, v[22:23] offset:6336
ds_write_b64 v3, v[54:55] offset:6864
ds_write_b64 v3, v[38:39] offset:7392
ds_write_b64 v3, v[70:71] offset:7920
ds_write_b64 v3, v[78:79] offset:8448
ds_write_b64 v3, v[32:33] offset:8976
ds_write_b64 v3, v[24:25] offset:9504
ds_write_b64 v3, v[56:57] offset:10032
ds_write_b64 v3, v[20:21] offset:10560
ds_write_b64 v3, v[52:53] offset:11088
ds_write_b64 v3, v[36:37] offset:11616
ds_write_b64 v3, v[68:69] offset:12144
ds_write_b64 v3, v[18:19] offset:12672
ds_write_b64 v3, v[50:51] offset:13200
ds_write_b64 v3, v[34:35] offset:13728
ds_write_b64 v3, v[66:67] offset:14256
ds_write_b64 v3, v[26:27] offset:14784
ds_write_b64 v3, v[58:59] offset:15312
ds_write_b64 v3, v[42:43] offset:15840
ds_write_b64 v3, v[74:75] offset:16368
s_waitcnt lgkmcnt(0)
ds_read_b64 v[16:17], v4 offset:0
ds_read_b64 v[48:49], v4 offset:256
ds_read_b64 v[18:19], v4 offset:16
ds_read_b64 v[50:51], v4 offset:272
ds_read_b64 v[20:21], v4 offset:32
ds_read_b64 v[52:53], v4 offset:288
ds_read_b64 v[22:23], v4 offset:48
ds_read_b64 v[54:55], v4 offset:304
ds_read_b64 v[24:25], v4 offset:64
ds_read_b64 v[56:57], v4 offset:320
ds_read_b64 v[26:27], v4 offset:80
ds_read_b64 v[58:59], v4 offset:336
ds_read_b64 v[28:29], v4 offset:96
ds_read_b64 v[60:61], v4 offset:352
ds_read_b64 v[30:31], v4 offset:112
ds_read_b64 v[62:63], v4 offset:368
ds_read_b64 v[32:33], v4 offset:128
ds_read_b64 v[64:65], v4 offset:384
ds_read_b64 v[34:35], v4 offset:144
ds_read_b64 v[66:67], v4 offset:400
ds_read_b64 v[36:37], v4 offset:160
ds_read_b64 v[68:69], v4 offset:416
ds_read_b64 v[38:39], v4 offset:176
ds_read_b64 v[70:71], v4 offset:432
ds_read_b64 v[40:41], v4 offset:192
ds_read_b64 v[72:73], v4 offset:448
ds_read_b64 v[42:43], v4 offset:208
ds_read_b64 v[74:75], v4 offset:464
ds_read_b64 v[44:45], v4 offset:224
ds_read_b64 v[76:77], v4 offset:480
ds_read_b64 v[46:47], v4 offset:240
ds_read_b64 v[78:79], v4 offset:496
s_waitcnt lgkmcnt(0)
v_pk_add_f32 v[14:15], v[16:17], v[48:49] neg_lo:[0,1] neg_hi:[0,1]
v_pk_add_f32 v[16:17], v[16:17], v[48:49]
v_pk_add_f32 v[48:49], v[18:19], v[50:51] neg_lo:[0,1] neg_hi:[0,1]
v_pk_add_f32 v[18:19], v[18:19], v[50:51]
v_pk_mul_f32 v[50:51], v[48:49], s[50:51] op_sel:[0,0] op_sel_hi:[0,1] neg_lo:[0,0] neg_hi:[0,1]
v_pk_fma_f32 v[50:51], v[48:49], s[50:51], v[50:51] op_sel:[1,1,0] op_sel_hi:[1,0,1] neg_lo:[0,0,0] neg_hi:[0,0,0]
v_pk_add_f32 v[48:49], v[20:21], v[52:53] neg_lo:[0,1] neg_hi:[0,1]
v_pk_add_f32 v[20:21], v[20:21], v[52:53]
v_pk_mul_f32 v[52:53], v[48:49], s[54:55] op_sel:[0,0] op_sel_hi:[0,1] neg_lo:[0,0] neg_hi:[0,1]
v_pk_fma_f32 v[52:53], v[48:49], s[54:55], v[52:53] op_sel:[1,1,0] op_sel_hi:[1,0,1] neg_lo:[0,0,0] neg_hi:[0,0,0]
v_pk_add_f32 v[48:49], v[22:23], v[54:55] neg_lo:[0,1] neg_hi:[0,1]
v_pk_add_f32 v[22:23], v[22:23], v[54:55]
v_pk_mul_f32 v[54:55], v[48:49], s[58:59] op_sel:[0,0] op_sel_hi:[0,1] neg_lo:[0,0] neg_hi:[0,1]
v_pk_fma_f32 v[54:55], v[48:49], s[58:59], v[54:55] op_sel:[1,1,0] op_sel_hi:[1,0,1] neg_lo:[0,0,0] neg_hi:[0,0,0]
v_pk_add_f32 v[48:49], v[24:25], v[56:57] neg_lo:[0,1] neg_hi:[0,1]
v_pk_add_f32 v[24:25], v[24:25], v[56:57]
v_pk_mul_f32 v[56:57], v[48:49], s[62:63] op_sel:[0,0] op_sel_hi:[0,1] neg_lo:[0,0] neg_hi:[0,1]
v_pk_fma_f32 v[56:57], v[48:49], s[62:63], v[56:57] op_sel:[1,1,0] op_sel_hi:[1,0,1] neg_lo:[0,0,0] neg_hi:[0,0,0]
v_pk_add_f32 v[48:49], v[26:27], v[58:59] neg_lo:[0,1] neg_hi:[0,1]
v_pk_add_f32 v[26:27], v[26:27], v[58:59]
v_pk_mul_f32 v[58:59], v[48:49], s[58:59] op_sel:[0,1] op_sel_hi:[0,0] neg_lo:[0,0] neg_hi:[0,1]
v_pk_fma_f32 v[58:59], v[48:49], s[58:59], v[58:59] op_sel:[1,0,0] op_sel_hi:[1,1,1] neg_lo:[0,0,0] neg_hi:[0,0,0]
v_pk_add_f32 v[48:49], v[28:29], v[60:61] neg_lo:[0,1] neg_hi:[0,1]
v_pk_add_f32 v[28:29], v[28:29], v[60:61]
v_pk_mul_f32 v[60:61], v[48:49], s[54:55] op_sel:[0,1] op_sel_hi:[0,0] neg_lo:[0,0] neg_hi:[0,1]
v_pk_fma_f32 v[60:61], v[48:49], s[54:55], v[60:61] op_sel:[1,0,0] op_sel_hi:[1,1,1] neg_lo:[0,0,0] neg_hi:[0,0,0]
v_pk_add_f32 v[48:49], v[30:31], v[62:63] neg_lo:[0,1] neg_hi:[0,1]
v_pk_add_f32 v[30:31], v[30:31], v[62:63]
v_pk_mul_f32 v[62:63], v[48:49], s[50:51] op_sel:[0,1] op_sel_hi:[0,0] neg_lo:[0,0] neg_hi:[0,1]
v_pk_fma_f32 v[62:63], v[48:49], s[50:51], v[62:63] op_sel:[1,0,0] op_sel_hi:[1,1,1] neg_lo:[0,0,0] neg_hi:[0,0,0]
v_pk_add_f32 v[48:49], v[32:33], v[64:65] op_sel:[1,1] op_sel_hi:[0,0] neg_lo:[0,1] neg_hi:[1,0]
v_pk_add_f32 v[32:33], v[32:33], v[64:65]
v_pk_add_f32 v[64:65], v[34:35], v[66:67] neg_lo:[0,1] neg_hi:[0,1]
v_pk_add_f32 v[34:35], v[34:35], v[66:67]
v_pk_mul_f32 v[66:67], v[64:65], s[50:51] op_sel:[0,1] op_sel_hi:[0,0] neg_lo:[0,1] neg_hi:[0,1]
v_pk_fma_f32 v[66:67], v[64:65], s[50:51], v[66:67] op_sel:[1,0,0] op_sel_hi:[1,1,1] neg_lo:[0,0,0] neg_hi:[0,1,0]
v_pk_add_f32 v[64:65], v[36:37], v[68:69] neg_lo:[0,1] neg_hi:[0,1]
v_pk_add_f32 v[36:37], v[36:37], v[68:69]
v_pk_mul_f32 v[68:69], v[64:65], s[54:55] op_sel:[0,1] op_sel_hi:[0,0] neg_lo:[0,1] neg_hi:[0,1]
v_pk_fma_f32 v[68:69], v[64:65], s[54:55], v[68:69] op_sel:[1,0,0] op_sel_hi:[1,1,1] neg_lo:[0,0,0] neg_hi:[0,1,0]
v_pk_add_f32 v[64:65], v[38:39], v[70:71] neg_lo:[0,1] neg_hi:[0,1]
v_pk_add_f32 v[38:39], v[38:39], v[70:71]
v_pk_mul_f32 v[70:71], v[64:65], s[58:59] op_sel:[0,1] op_sel_hi:[0,0] neg_lo:[0,1] neg_hi:[0,1]
v_pk_fma_f32 v[70:71], v[64:65], s[58:59], v[70:71] op_sel:[1,0,0] op_sel_hi:[1,1,1] neg_lo:[0,0,0] neg_hi:[0,1,0]
v_pk_add_f32 v[64:65], v[40:41], v[72:73] neg_lo:[0,1] neg_hi:[0,1]
v_pk_add_f32 v[40:41], v[40:41], v[72:73]
v_pk_mul_f32 v[72:73], v[64:65], s[62:63] op_sel:[0,0] op_sel_hi:[0,1] neg_lo:[0,1] neg_hi:[0,1]
v_pk_fma_f32 v[72:73], v[64:65], s[62:63], v[72:73] op_sel:[1,1,0] op_sel_hi:[1,0,1] neg_lo:[0,0,0] neg_hi:[0,1,0]
v_pk_add_f32 v[64:65], v[42:43], v[74:75] neg_lo:[0,1] neg_hi:[0,1]
v_pk_add_f32 v[42:43], v[42:43], v[74:75]
v_pk_mul_f32 v[74:75], v[64:65], s[58:59] op_sel:[0,0] op_sel_hi:[0,1] neg_lo:[0,1] neg_hi:[0,1]
v_pk_fma_f32 v[74:75], v[64:65], s[58:59], v[74:75] op_sel:[1,1,0] op_sel_hi:[1,0,1] neg_lo:[0,0,0] neg_hi:[0,1,0]
v_pk_add_f32 v[64:65], v[44:45], v[76:77] neg_lo:[0,1] neg_hi:[0,1]
v_pk_add_f32 v[44:45], v[44:45], v[76:77]
v_pk_mul_f32 v[76:77], v[64:65], s[54:55] op_sel:[0,0] op_sel_hi:[0,1] neg_lo:[0,1] neg_hi:[0,1]
v_pk_fma_f32 v[76:77], v[64:65], s[54:55], v[76:77] op_sel:[1,1,0] op_sel_hi:[1,0,1] neg_lo:[0,0,0] neg_hi:[0,1,0]
v_pk_add_f32 v[64:65], v[46:47], v[78:79] neg_lo:[0,1] neg_hi:[0,1]
v_pk_add_f32 v[46:47], v[46:47], v[78:79]
v_pk_mul_f32 v[78:79], v[64:65], s[50:51] op_sel:[0,0] op_sel_hi:[0,1] neg_lo:[0,1] neg_hi:[0,1]
v_pk_fma_f32 v[78:79], v[64:65], s[50:51], v[78:79] op_sel:[1,1,0] op_sel_hi:[1,0,1] neg_lo:[0,0,0] neg_hi:[0,1,0]
v_pk_add_f32 v[64:65], v[16:17], v[32:33] neg_lo:[0,1] neg_hi:[0,1]
v_pk_add_f32 v[16:17], v[16:17], v[32:33]
v_pk_add_f32 v[32:33], v[18:19], v[34:35] neg_lo:[0,1] neg_hi:[0,1]
v_pk_add_f32 v[18:19], v[18:19], v[34:35]
v_pk_mul_f32 v[34:35], v[32:33], s[54:55] op_sel:[0,0] op_sel_hi:[0,1] neg_lo:[0,0] neg_hi:[0,1]
v_pk_fma_f32 v[34:35], v[32:33], s[54:55], v[34:35] op_sel:[1,1,0] op_sel_hi:[1,0,1] neg_lo:[0,0,0] neg_hi:[0,0,0]
v_pk_add_f32 v[32:33], v[20:21], v[36:37] neg_lo:[0,1] neg_hi:[0,1]
v_pk_add_f32 v[20:21], v[20:21], v[36:37]
v_pk_mul_f32 v[36:37], v[32:33], s[62:63] op_sel:[0,0] op_sel_hi:[0,1] neg_lo:[0,0] neg_hi:[0,1]
v_pk_fma_f32 v[36:37], v[32:33], s[62:63], v[36:37] op_sel:[1,1,0] op_sel_hi:[1,0,1] neg_lo:[0,0,0] neg_hi:[0,0,0]
v_pk_add_f32 v[32:33], v[22:23], v[38:39] neg_lo:[0,1] neg_hi:[0,1]
v_pk_add_f32 v[22:23], v[22:23], v[38:39]
v_pk_mul_f32 v[38:39], v[32:33], s[54:55] op_sel:[0,1] op_sel_hi:[0,0] neg_lo:[0,0] neg_hi:[0,1]
v_pk_fma_f32 v[38:39], v[32:33], s[54:55], v[38:39] op_sel:[1,0,0] op_sel_hi:[1,1,1] neg_lo:[0,0,0] neg_hi:[0,0,0]
v_pk_add_f32 v[32:33], v[24:25], v[40:41] op_sel:[1,1] op_sel_hi:[0,0] neg_lo:[0,1] neg_hi:[1,0]
v_pk_add_f32 v[24:25], v[24:25], v[40:41]
v_pk_add_f32 v[40:41], v[26:27], v[42:43] neg_lo:[0,1] neg_hi:[0,1]
v_pk_add_f32 v[26:27], v[26:27], v[42:43]
v_pk_mul_f32 v[42:43], v[40:41], s[54:55] op_sel:[0,1] op_sel_hi:[0,0] neg_lo:[0,1] neg_hi:[0,1]
v_pk_fma_f32 v[42:43], v[40:41], s[54:55], v[42:43] op_sel:[1,0,0] op_sel_hi:[1,1,1] neg_lo:[0,0,0] neg_hi:[0,1,0]
v_pk_add_f32 v[40:41], v[28:29], v[44:45] neg_lo:[0,1] neg_hi:[0,1]
v_pk_add_f32 v[28:29], v[28:29], v[44:45]
v_pk_mul_f32 v[44:45], v[40:41], s[62:63] op_sel:[0,0] op_sel_hi:[0,1] neg_lo:[0,1] neg_hi:[0,1]
v_pk_fma_f32 v[44:45], v[40:41], s[62:63], v[44:45] op_sel:[1,1,0] op_sel_hi:[1,0,1] neg_lo:[0,0,0] neg_hi:[0,1,0]
v_pk_add_f32 v[40:41], v[30:31], v[46:47] neg_lo:[0,1] neg_hi:[0,1]
v_pk_add_f32 v[30:31], v[30:31], v[46:47]
v_pk_mul_f32 v[46:47], v[40:41], s[54:55] op_sel:[0,0] op_sel_hi:[0,1] neg_lo:[0,1] neg_hi:[0,1]
v_pk_fma_f32 v[46:47], v[40:41], s[54:55], v[46:47] op_sel:[1,1,0] op_sel_hi:[1,0,1] neg_lo:[0,0,0] neg_hi:[0,1,0]
v_pk_add_f32 v[40:41], v[14:15], v[48:49] neg_lo:[0,1] neg_hi:[0,1]
v_pk_add_f32 v[14:15], v[14:15], v[48:49]
v_pk_add_f32 v[48:49], v[50:51], v[66:67] neg_lo:[0,1] neg_hi:[0,1]
v_pk_add_f32 v[50:51], v[50:51], v[66:67]
v_pk_mul_f32 v[66:67], v[48:49], s[54:55] op_sel:[0,0] op_sel_hi:[0,1] neg_lo:[0,0] neg_hi:[0,1]
v_pk_fma_f32 v[66:67], v[48:49], s[54:55], v[66:67] op_sel:[1,1,0] op_sel_hi:[1,0,1] neg_lo:[0,0,0] neg_hi:[0,0,0]
v_pk_add_f32 v[48:49], v[52:53], v[68:69] neg_lo:[0,1] neg_hi:[0,1]
v_pk_add_f32 v[52:53], v[52:53], v[68:69]
v_pk_mul_f32 v[68:69], v[48:49], s[62:63] op_sel:[0,0] op_sel_hi:[0,1] neg_lo:[0,0] neg_hi:[0,1]
v_pk_fma_f32 v[68:69], v[48:49], s[62:63], v[68:69] op_sel:[1,1,0] op_sel_hi:[1,0,1] neg_lo:[0,0,0] neg_hi:[0,0,0]
v_pk_add_f32 v[48:49], v[54:55], v[70:71] neg_lo:[0,1] neg_hi:[0,1]
v_pk_add_f32 v[54:55], v[54:55], v[70:71]
v_pk_mul_f32 v[70:71], v[48:49], s[54:55] op_sel:[0,1] op_sel_hi:[0,0] neg_lo:[0,0] neg_hi:[0,1]
v_pk_fma_f32 v[70:71], v[48:49], s[54:55], v[70:71] op_sel:[1,0,0] op_sel_hi:[1,1,1] neg_lo:[0,0,0] neg_hi:[0,0,0]
v_pk_add_f32 v[48:49], v[56:57], v[72:73] op_sel:[1,1] op_sel_hi:[0,0] neg_lo:[0,1] neg_hi:[1,0]
v_pk_add_f32 v[56:57], v[56:57], v[72:73]
v_pk_add_f32 v[72:73], v[58:59], v[74:75] neg_lo:[0,1] neg_hi:[0,1]
v_pk_add_f32 v[58:59], v[58:59], v[74:75]
v_pk_mul_f32 v[74:75], v[72:73], s[54:55] op_sel:[0,1] op_sel_hi:[0,0] neg_lo:[0,1] neg_hi:[0,1]
v_pk_fma_f32 v[74:75], v[72:73], s[54:55], v[74:75] op_sel:[1,0,0] op_sel_hi:[1,1,1] neg_lo:[0,0,0] neg_hi:[0,1,0]
v_pk_add_f32 v[72:73], v[60:61], v[76:77] neg_lo:[0,1] neg_hi:[0,1]
v_pk_add_f32 v[60:61], v[60:61], v[76:77]
v_pk_mul_f32 v[76:77], v[72:73], s[62:63] op_sel:[0,0] op_sel_hi:[0,1] neg_lo:[0,1] neg_hi:[0,1]
v_pk_fma_f32 v[76:77], v[72:73], s[62:63], v[76:77] op_sel:[1,1,0] op_sel_hi:[1,0,1] neg_lo:[0,0,0] neg_hi:[0,1,0]
v_pk_add_f32 v[72:73], v[62:63], v[78:79] neg_lo:[0,1] neg_hi:[0,1]
v_pk_add_f32 v[62:63], v[62:63], v[78:79]
v_pk_mul_f32 v[78:79], v[72:73], s[54:55] op_sel:[0,0] op_sel_hi:[0,1] neg_lo:[0,1] neg_hi:[0,1]
v_pk_fma_f32 v[78:79], v[72:73], s[54:55], v[78:79] op_sel:[1,1,0] op_sel_hi:[1,0,1] neg_lo:[0,0,0] neg_hi:[0,1,0]
v_pk_add_f32 v[72:73], v[16:17], v[24:25] neg_lo:[0,1] neg_hi:[0,1]
v_pk_add_f32 v[16:17], v[16:17], v[24:25]
v_pk_add_f32 v[24:25], v[18:19], v[26:27] neg_lo:[0,1] neg_hi:[0,1]
v_pk_add_f32 v[18:19], v[18:19], v[26:27]
v_pk_mul_f32 v[26:27], v[24:25], s[62:63] op_sel:[0,0] op_sel_hi:[0,1] neg_lo:[0,0] neg_hi:[0,1]
v_pk_fma_f32 v[26:27], v[24:25], s[62:63], v[26:27] op_sel:[1,1,0] op_sel_hi:[1,0,1] neg_lo:[0,0,0] neg_hi:[0,0,0]
v_pk_add_f32 v[24:25], v[20:21], v[28:29] op_sel:[1,1] op_sel_hi:[0,0] neg_lo:[0,1] neg_hi:[1,0]
v_pk_add_f32 v[20:21], v[20:21], v[28:29]
v_pk_add_f32 v[28:29], v[22:23], v[30:31] neg_lo:[0,1] neg_hi:[0,1]
v_pk_add_f32 v[22:23], v[22:23], v[30:31]
v_pk_mul_f32 v[30:31], v[28:29], s[62:63] op_sel:[0,0] op_sel_hi:[0,1] neg_lo:[0,1] neg_hi:[0,1]
v_pk_fma_f32 v[30:31], v[28:29], s[62:63], v[30:31] op_sel:[1,1,0] op_sel_hi:[1,0,1] neg_lo:[0,0,0] neg_hi:[0,1,0]
v_pk_add_f32 v[28:29], v[64:65], v[32:33] neg_lo:[0,1] neg_hi:[0,1]
v_pk_add_f32 v[64:65], v[64:65], v[32:33]
v_pk_add_f32 v[32:33], v[34:35], v[42:43] neg_lo:[0,1] neg_hi:[0,1]
v_pk_add_f32 v[34:35], v[34:35], v[42:43]
v_pk_mul_f32 v[42:43], v[32:33], s[62:63] op_sel:[0,0] op_sel_hi:[0,1] neg_lo:[0,0] neg_hi:[0,1]
v_pk_fma_f32 v[42:43], v[32:33], s[62:63], v[42:43] op_sel:[1,1,0] op_sel_hi:[1,0,1] neg_lo:[0,0,0] neg_hi:[0,0,0]
v_pk_add_f32 v[32:33], v[36:37], v[44:45] op_sel:[1,1] op_sel_hi:[0,0] neg_lo:[0,1] neg_hi:[1,0]
v_pk_add_f32 v[36:37], v[36:37], v[44:45]
v_pk_add_f32 v[44:45], v[38:39], v[46:47] neg_lo:[0,1] neg_hi:[0,1]
v_pk_add_f32 v[38:39], v[38:39], v[46:47]
v_pk_mul_f32 v[46:47], v[44:45], s[62:63] op_sel:[0,0] op_sel_hi:[0,1] neg_lo:[0,1] neg_hi:[0,1]
v_pk_fma_f32 v[46:47], v[44:45], s[62:63], v[46:47] op_sel:[1,1,0] op_sel_hi:[1,0,1] neg_lo:[0,0,0] neg_hi:[0,1,0]
v_pk_add_f32 v[44:45], v[14:15], v[56:57] neg_lo:[0,1] neg_hi:[0,1]
v_pk_add_f32 v[14:15], v[14:15], v[56:57]
v_pk_add_f32 v[56:57], v[50:51], v[58:59] neg_lo:[0,1] neg_hi:[0,1]
v_pk_add_f32 v[50:51], v[50:51], v[58:59]
v_pk_mul_f32 v[58:59], v[56:57], s[62:63] op_sel:[0,0] op_sel_hi:[0,1] neg_lo:[0,0] neg_hi:[0,1]
v_pk_fma_f32 v[58:59], v[56:57], s[62:63], v[58:59] op_sel:[1,1,0] op_sel_hi:[1,0,1] neg_lo:[0,0,0] neg_hi:[0,0,0]
v_pk_add_f32 v[56:57], v[52:53], v[60:61] op_sel:[1,1] op_sel_hi:[0,0] neg_lo:[0,1] neg_hi:[1,0]
v_pk_add_f32 v[52:53], v[52:53], v[60:61]
v_pk_add_f32 v[60:61], v[54:55], v[62:63] neg_lo:[0,1] neg_hi:[0,1]
v_pk_add_f32 v[54:55], v[54:55], v[62:63]
v_pk_mul_f32 v[62:63], v[60:61], s[62:63] op_sel:[0,0] op_sel_hi:[0,1] neg_lo:[0,1] neg_hi:[0,1]
v_pk_fma_f32 v[62:63], v[60:61], s[62:63], v[62:63] op_sel:[1,1,0] op_sel_hi:[1,0,1] neg_lo:[0,0,0] neg_hi:[0,1,0]
v_pk_add_f32 v[60:61], v[40:41], v[48:49] neg_lo:[0,1] neg_hi:[0,1]
v_pk_add_f32 v[40:41], v[40:41], v[48:49]
v_pk_add_f32 v[48:49], v[66:67], v[74:75] neg_lo:[0,1] neg_hi:[0,1]
v_pk_add_f32 v[66:67], v[66:67], v[74:75]
v_pk_mul_f32 v[74:75], v[48:49], s[62:63] op_sel:[0,0] op_sel_hi:[0,1] neg_lo:[0,0] neg_hi:[0,1]
v_pk_fma_f32 v[74:75], v[48:49], s[62:63], v[74:75] op_sel:[1,1,0] op_sel_hi:[1,0,1] neg_lo:[0,0,0] neg_hi:[0,0,0]
v_pk_add_f32 v[48:49], v[68:69], v[76:77] op_sel:[1,1] op_sel_hi:[0,0] neg_lo:[0,1] neg_hi:[1,0]
v_pk_add_f32 v[68:69], v[68:69], v[76:77]
v_pk_add_f32 v[76:77], v[70:71], v[78:79] neg_lo:[0,1] neg_hi:[0,1]
v_pk_add_f32 v[70:71], v[70:71], v[78:79]
v_pk_mul_f32 v[78:79], v[76:77], s[62:63] op_sel:[0,0] op_sel_hi:[0,1] neg_lo:[0,1] neg_hi:[0,1]
v_pk_fma_f32 v[78:79], v[76:77], s[62:63], v[78:79] op_sel:[1,1,0] op_sel_hi:[1,0,1] neg_lo:[0,0,0] neg_hi:[0,1,0]
v_pk_add_f32 v[76:77], v[16:17], v[20:21] neg_lo:[0,1] neg_hi:[0,1]
v_pk_add_f32 v[16:17], v[16:17], v[20:21]
v_pk_add_f32 v[20:21], v[18:19], v[22:23] op_sel:[1,1] op_sel_hi:[0,0] neg_lo:[0,1] neg_hi:[1,0]
v_pk_add_f32 v[18:19], v[18:19], v[22:23]
v_pk_add_f32 v[22:23], v[72:73], v[24:25] neg_lo:[0,1] neg_hi:[0,1]
v_pk_add_f32 v[72:73], v[72:73], v[24:25]
v_pk_add_f32 v[24:25], v[26:27], v[30:31] op_sel:[1,1] op_sel_hi:[0,0] neg_lo:[0,1] neg_hi:[1,0]
v_pk_add_f32 v[26:27], v[26:27], v[30:31]
v_pk_add_f32 v[30:31], v[64:65], v[36:37] neg_lo:[0,1] neg_hi:[0,1]
v_pk_add_f32 v[64:65], v[64:65], v[36:37]
v_pk_add_f32 v[36:37], v[34:35], v[38:39] op_sel:[1,1] op_sel_hi:[0,0] neg_lo:[0,1] neg_hi:[1,0]
v_pk_add_f32 v[34:35], v[34:35], v[38:39]
v_pk_add_f32 v[38:39], v[28:29], v[32:33] neg_lo:[0,1] neg_hi:[0,1]
v_pk_add_f32 v[28:29], v[28:29], v[32:33]
v_pk_add_f32 v[32:33], v[42:43], v[46:47] op_sel:[1,1] op_sel_hi:[0,0] neg_lo:[0,1] neg_hi:[1,0]
v_pk_add_f32 v[42:43], v[42:43], v[46:47]
v_pk_add_f32 v[46:47], v[14:15], v[52:53] neg_lo:[0,1] neg_hi:[0,1]
v_pk_add_f32 v[14:15], v[14:15], v[52:53]
v_pk_add_f32 v[52:53], v[50:51], v[54:55] op_sel:[1,1] op_sel_hi:[0,0] neg_lo:[0,1] neg_hi:[1,0]
v_pk_add_f32 v[50:51], v[50:51], v[54:55]
v_pk_add_f32 v[54:55], v[44:45], v[56:57] neg_lo:[0,1] neg_hi:[0,1]
v_pk_add_f32 v[44:45], v[44:45], v[56:57]
v_pk_add_f32 v[56:57], v[58:59], v[62:63] op_sel:[1,1] op_sel_hi:[0,0] neg_lo:[0,1] neg_hi:[1,0]
v_pk_add_f32 v[58:59], v[58:59], v[62:63]
v_pk_add_f32 v[62:63], v[40:41], v[68:69] neg_lo:[0,1] neg_hi:[0,1]
v_pk_add_f32 v[40:41], v[40:41], v[68:69]
v_pk_add_f32 v[68:69], v[66:67], v[70:71] op_sel:[1,1] op_sel_hi:[0,0] neg_lo:[0,1] neg_hi:[1,0]
v_pk_add_f32 v[66:67], v[66:67], v[70:71]
v_pk_add_f32 v[70:71], v[60:61], v[48:49] neg_lo:[0,1] neg_hi:[0,1]
v_pk_add_f32 v[60:61], v[60:61], v[48:49]
v_pk_add_f32 v[48:49], v[74:75], v[78:79] op_sel:[1,1] op_sel_hi:[0,0] neg_lo:[0,1] neg_hi:[1,0]
v_pk_add_f32 v[74:75], v[74:75], v[78:79]
v_pk_add_f32 v[78:79], v[16:17], v[18:19] neg_lo:[0,1] neg_hi:[0,1]
v_pk_add_f32 v[16:17], v[16:17], v[18:19]
v_pk_add_f32 v[18:19], v[76:77], v[20:21] neg_lo:[0,1] neg_hi:[0,1]
v_pk_add_f32 v[76:77], v[76:77], v[20:21]
v_pk_add_f32 v[20:21], v[72:73], v[26:27] neg_lo:[0,1] neg_hi:[0,1]
v_pk_add_f32 v[72:73], v[72:73], v[26:27]
v_pk_add_f32 v[26:27], v[22:23], v[24:25] neg_lo:[0,1] neg_hi:[0,1]
v_pk_add_f32 v[22:23], v[22:23], v[24:25]
v_pk_add_f32 v[24:25], v[64:65], v[34:35] neg_lo:[0,1] neg_hi:[0,1]
v_pk_add_f32 v[64:65], v[64:65], v[34:35]
v_pk_add_f32 v[34:35], v[30:31], v[36:37] neg_lo:[0,1] neg_hi:[0,1]
v_pk_add_f32 v[30:31], v[30:31], v[36:37]
v_pk_add_f32 v[36:37], v[28:29], v[42:43] neg_lo:[0,1] neg_hi:[0,1]
v_pk_add_f32 v[28:29], v[28:29], v[42:43]
v_pk_add_f32 v[42:43], v[38:39], v[32:33] neg_lo:[0,1] neg_hi:[0,1]
v_pk_add_f32 v[38:39], v[38:39], v[32:33]
v_pk_add_f32 v[32:33], v[14:15], v[50:51] neg_lo:[0,1] neg_hi:[0,1]
v_pk_add_f32 v[14:15], v[14:15], v[50:51]
v_pk_add_f32 v[50:51], v[46:47], v[52:53] neg_lo:[0,1] neg_hi:[0,1]
v_pk_add_f32 v[46:47], v[46:47], v[52:53]
v_pk_add_f32 v[52:53], v[44:45], v[58:59] neg_lo:[0,1] neg_hi:[0,1]
v_pk_add_f32 v[44:45], v[44:45], v[58:59]
v_pk_add_f32 v[58:59], v[54:55], v[56:57] neg_lo:[0,1] neg_hi:[0,1]
v_pk_add_f32 v[54:55], v[54:55], v[56:57]
v_pk_add_f32 v[56:57], v[40:41], v[66:67] neg_lo:[0,1] neg_hi:[0,1]
v_pk_add_f32 v[40:41], v[40:41], v[66:67]
v_pk_add_f32 v[66:67], v[62:63], v[68:69] neg_lo:[0,1] neg_hi:[0,1]
v_pk_add_f32 v[62:63], v[62:63], v[68:69]
v_pk_add_f32 v[68:69], v[60:61], v[74:75] neg_lo:[0,1] neg_hi:[0,1]
v_pk_add_f32 v[60:61], v[60:61], v[74:75]
v_pk_add_f32 v[74:75], v[70:71], v[48:49] neg_lo:[0,1] neg_hi:[0,1]
v_pk_add_f32 v[70:71], v[70:71], v[48:49]
s_mov_b64 exec, s[18:19]
v_pk_add_f32 v[16:17], v[16:17], 0 neg_lo:[1,0] neg_hi:[1,0]
v_pk_mul_f32 v[48:49], v[14:15], s[48:49] op_sel:[0,0] op_sel_hi:[0,1] neg_lo:[0,1] neg_hi:[0,0]
v_pk_fma_f32 v[14:15], v[14:15], s[48:49], v[48:49] op_sel:[1,1,0] op_sel_hi:[1,0,1] neg_lo:[0,1,0] neg_hi:[0,1,0]
v_pk_mul_f32 v[48:49], v[64:65], s[50:51] op_sel:[0,0] op_sel_hi:[0,1] neg_lo:[0,1] neg_hi:[0,0]
v_pk_fma_f32 v[64:65], v[64:65], s[50:51], v[48:49] op_sel:[1,1,0] op_sel_hi:[1,0,1] neg_lo:[0,1,0] neg_hi:[0,1,0]
v_pk_mul_f32 v[48:49], v[40:41], s[52:53] op_sel:[0,0] op_sel_hi:[0,1] neg_lo:[0,1] neg_hi:[0,0]
v_pk_fma_f32 v[40:41], v[40:41], s[52:53], v[48:49] op_sel:[1,1,0] op_sel_hi:[1,0,1] neg_lo:[0,1,0] neg_hi:[0,1,0]
v_pk_mul_f32 v[48:49], v[72:73], s[54:55] op_sel:[0,0] op_sel_hi:[0,1] neg_lo:[0,1] neg_hi:[0,0]
v_pk_fma_f32 v[72:73], v[72:73], s[54:55], v[48:49] op_sel:[1,1,0] op_sel_hi:[1,0,1] neg_lo:[0,1,0] neg_hi:[0,1,0]
v_pk_mul_f32 v[48:49], v[44:45], s[56:57] op_sel:[0,0] op_sel_hi:[0,1] neg_lo:[0,1] neg_hi:[0,0]
v_pk_fma_f32 v[44:45], v[44:45], s[56:57], v[48:49] op_sel:[1,1,0] op_sel_hi:[1,0,1] neg_lo:[0,1,0] neg_hi:[0,1,0]
v_pk_mul_f32 v[48:49], v[28:29], s[58:59] op_sel:[0,0] op_sel_hi:[0,1] neg_lo:[0,1] neg_hi:[0,0]
v_pk_fma_f32 v[28:29], v[28:29], s[58:59], v[48:49] op_sel:[1,1,0] op_sel_hi:[1,0,1] neg_lo:[0,1,0] neg_hi:[0,1,0]
v_pk_mul_f32 v[48:49], v[60:61], s[60:61] op_sel:[0,0] op_sel_hi:[0,1] neg_lo:[0,1] neg_hi:[0,0]
v_pk_fma_f32 v[60:61], v[60:61], s[60:61], v[48:49] op_sel:[1,1,0] op_sel_hi:[1,0,1] neg_lo:[0,1,0] neg_hi:[0,1,0]
v_pk_mul_f32 v[48:49], v[76:77], s[62:63] op_sel:[0,0] op_sel_hi:[0,1] neg_lo:[0,1] neg_hi:[0,0]
v_pk_fma_f32 v[76:77], v[76:77], s[62:63], v[48:49] op_sel:[1,1,0] op_sel_hi:[1,0,1] neg_lo:[0,1,0] neg_hi:[0,1,0]
v_pk_mul_f32 v[48:49], v[46:47], s[60:61] op_sel:[0,1] op_sel_hi:[0,0] neg_lo:[0,1] neg_hi:[0,0]
v_pk_fma_f32 v[46:47], v[46:47], s[60:61], v[48:49] op_sel:[1,0,0] op_sel_hi:[1,1,1] neg_lo:[0,1,0] neg_hi:[0,1,0]
v_pk_mul_f32 v[48:49], v[30:31], s[58:59] op_sel:[0,1] op_sel_hi:[0,0] neg_lo:[0,1] neg_hi:[0,0]
v_pk_fma_f32 v[30:31], v[30:31], s[58:59], v[48:49] op_sel:[1,0,0] op_sel_hi:[1,1,1] neg_lo:[0,1,0] neg_hi:[0,1,0]
v_pk_mul_f32 v[48:49], v[62:63], s[56:57] op_sel:[0,1] op_sel_hi:[0,0] neg_lo:[0,1] neg_hi:[0,0]
v_pk_fma_f32 v[62:63], v[62:63], s[56:57], v[48:49] op_sel:[1,0,0] op_sel_hi:[1,1,1] neg_lo:[0,1,0] neg_hi:[0,1,0]
v_pk_mul_f32 v[48:49], v[22:23], s[54:55] op_sel:[0,1] op_sel_hi:[0,0] neg_lo:[0,1] neg_hi:[0,0]
v_pk_fma_f32 v[22:23], v[22:23], s[54:55], v[48:49] op_sel:[1,0,0] op_sel_hi:[1,1,1] neg_lo:[0,1,0] neg_hi:[0,1,0]
v_pk_mul_f32 v[48:49], v[54:55], s[52:53] op_sel:[0,1] op_sel_hi:[0,0] neg_lo:[0,1] neg_hi:[0,0]
v_pk_fma_f32 v[54:55], v[54:55], s[52:53], v[48:49] op_sel:[1,0,0] op_sel_hi:[1,1,1] neg_lo:[0,1,0] neg_hi:[0,1,0]
v_pk_mul_f32 v[48:49], v[38:39], s[50:51] op_sel:[0,1] op_sel_hi:[0,0] neg_lo:[0,1] neg_hi:[0,0]
v_pk_fma_f32 v[38:39], v[38:39], s[50:51], v[48:49] op_sel:[1,0,0] op_sel_hi:[1,1,1] neg_lo:[0,1,0] neg_hi:[0,1,0]
v_pk_mul_f32 v[48:49], v[70:71], s[48:49] op_sel:[0,1] op_sel_hi:[0,0] neg_lo:[0,1] neg_hi:[0,0]
v_pk_fma_f32 v[70:71], v[70:71], s[48:49], v[48:49] op_sel:[1,0,0] op_sel_hi:[1,1,1] neg_lo:[0,1,0] neg_hi:[0,1,0]
v_pk_add_f32 v[78:79], v[78:79], 0 op_sel:[1,0] op_sel_hi:[0,0] neg_lo:[1,0] neg_hi:[0,0]
v_pk_mul_f32 v[48:49], v[32:33], s[48:49] op_sel:[0,1] op_sel_hi:[0,0] neg_lo:[0,0] neg_hi:[0,0]
v_pk_fma_f32 v[32:33], v[32:33], s[48:49], v[48:49] op_sel:[1,0,0] op_sel_hi:[1,1,1] neg_lo:[0,1,0] neg_hi:[0,0,0]
v_pk_mul_f32 v[48:49], v[24:25], s[50:51] op_sel:[0,1] op_sel_hi:[0,0] neg_lo:[0,0] neg_hi:[0,0]
v_pk_fma_f32 v[24:25], v[24:25], s[50:51], v[48:49] op_sel:[1,0,0] op_sel_hi:[1,1,1] neg_lo:[0,1,0] neg_hi:[0,0,0]
v_pk_mul_f32 v[48:49], v[56:57], s[52:53] op_sel:[0,1] op_sel_hi:[0,0] neg_lo:[0,0] neg_hi:[0,0]
v_pk_fma_f32 v[56:57], v[56:57], s[52:53], v[48:49] op_sel:[1,0,0] op_sel_hi:[1,1,1] neg_lo:[0,1,0] neg_hi:[0,0,0]
v_pk_mul_f32 v[48:49], v[20:21], s[54:55] op_sel:[0,1] op_sel_hi:[0,0] neg_lo:[0,0] neg_hi:[0,0]
v_pk_fma_f32 v[20:21], v[20:21], s[54:55], v[48:49] op_sel:[1,0,0] op_sel_hi:[1,1,1] neg_lo:[0,1,0] neg_hi:[0,0,0]
v_pk_mul_f32 v[48:49], v[52:53], s[56:57] op_sel:[0,1] op_sel_hi:[0,0] neg_lo:[0,0] neg_hi:[0,0]
v_pk_fma_f32 v[52:53], v[52:53], s[56:57], v[48:49] op_sel:[1,0,0] op_sel_hi:[1,1,1] neg_lo:[0,1,0] neg_hi:[0,0,0]
v_pk_mul_f32 v[48:49], v[36:37], s[58:59] op_sel:[0,1] op_sel_hi:[0,0] neg_lo:[0,0] neg_hi:[0,0]
v_pk_fma_f32 v[36:37], v[36:37], s[58:59], v[48:49] op_sel:[1,0,0] op_sel_hi:[1,1,1] neg_lo:[0,1,0] neg_hi:[0,0,0]
v_pk_mul_f32 v[48:49], v[68:69], s[60:61] op_sel:[0,1] op_sel_hi:[0,0] neg_lo:[0,0] neg_hi:[0,0]
v_pk_fma_f32 v[68:69], v[68:69], s[60:61], v[48:49] op_sel:[1,0,0] op_sel_hi:[1,1,1] neg_lo:[0,1,0] neg_hi:[0,0,0]
v_pk_mul_f32 v[48:49], v[18:19], s[62:63] op_sel:[0,0] op_sel_hi:[0,1] neg_lo:[0,0] neg_hi:[0,0]
v_pk_fma_f32 v[18:19], v[18:19], s[62:63], v[48:49] op_sel:[1,1,0] op_sel_hi:[1,0,1] neg_lo:[0,1,0] neg_hi:[0,0,0]
v_pk_mul_f32 v[48:49], v[50:51], s[60:61] op_sel:[0,0] op_sel_hi:[0,1] neg_lo:[0,0] neg_hi:[0,0]
v_pk_fma_f32 v[50:51], v[50:51], s[60:61], v[48:49] op_sel:[1,1,0] op_sel_hi:[1,0,1] neg_lo:[0,1,0] neg_hi:[0,0,0]
v_pk_mul_f32 v[48:49], v[34:35], s[58:59] op_sel:[0,0] op_sel_hi:[0,1] neg_lo:[0,0] neg_hi:[0,0]
v_pk_fma_f32 v[34:35], v[34:35], s[58:59], v[48:49] op_sel:[1,1,0] op_sel_hi:[1,0,1] neg_lo:[0,1,0] neg_hi:[0,0,0]
v_pk_mul_f32 v[48:49], v[66:67], s[56:57] op_sel:[0,0] op_sel_hi:[0,1] neg_lo:[0,0] neg_hi:[0,0]
v_pk_fma_f32 v[66:67], v[66:67], s[56:57], v[48:49] op_sel:[1,1,0] op_sel_hi:[1,0,1] neg_lo:[0,1,0] neg_hi:[0,0,0]
v_pk_mul_f32 v[48:49], v[26:27], s[54:55] op_sel:[0,0] op_sel_hi:[0,1] neg_lo:[0,0] neg_hi:[0,0]
v_pk_fma_f32 v[26:27], v[26:27], s[54:55], v[48:49] op_sel:[1,1,0] op_sel_hi:[1,0,1] neg_lo:[0,1,0] neg_hi:[0,0,0]
v_pk_mul_f32 v[48:49], v[58:59], s[52:53] op_sel:[0,0] op_sel_hi:[0,1] neg_lo:[0,0] neg_hi:[0,0]
v_pk_fma_f32 v[58:59], v[58:59], s[52:53], v[48:49] op_sel:[1,1,0] op_sel_hi:[1,0,1] neg_lo:[0,1,0] neg_hi:[0,0,0]
v_pk_mul_f32 v[48:49], v[42:43], s[50:51] op_sel:[0,0] op_sel_hi:[0,1] neg_lo:[0,0] neg_hi:[0,0]
v_pk_fma_f32 v[42:43], v[42:43], s[50:51], v[48:49] op_sel:[1,1,0] op_sel_hi:[1,0,1] neg_lo:[0,1,0] neg_hi:[0,0,0]
v_pk_mul_f32 v[48:49], v[74:75], s[48:49] op_sel:[0,0] op_sel_hi:[0,1] neg_lo:[0,0] neg_hi:[0,0]
v_pk_fma_f32 v[74:75], v[74:75], s[48:49], v[48:49] op_sel:[1,1,0] op_sel_hi:[1,0,1] neg_lo:[0,1,0] neg_hi:[0,0,0]
s_mov_b64 exec, -1
v_fmac_f32_dpp v16, v16, v9 quad_perm:[1,0,3,2] row_mask:0xf bank_mask:0xf
v_fmac_f32_dpp v17, v17, v9 quad_perm:[1,0,3,2] row_mask:0xf bank_mask:0xf
v_fmac_f32_dpp v14, v14, v9 quad_perm:[1,0,3,2] row_mask:0xf bank_mask:0xf
v_fmac_f32_dpp v15, v15, v9 quad_perm:[1,0,3,2] row_mask:0xf bank_mask:0xf
v_fmac_f32_dpp v64, v64, v9 quad_perm:[1,0,3,2] row_mask:0xf bank_mask:0xf
v_fmac_f32_dpp v65, v65, v9 quad_perm:[1,0,3,2] row_mask:0xf bank_mask:0xf
v_fmac_f32_dpp v40, v40, v9 quad_perm:[1,0,3,2] row_mask:0xf bank_mask:0xf
v_fmac_f32_dpp v41, v41, v9 quad_perm:[1,0,3,2] row_mask:0xf bank_mask:0xf
v_fmac_f32_dpp v72, v72, v9 quad_perm:[1,0,3,2] row_mask:0xf bank_mask:0xf
v_fmac_f32_dpp v73, v73, v9 quad_perm:[1,0,3,2] row_mask:0xf bank_mask:0xf
v_fmac_f32_dpp v44, v44, v9 quad_perm:[1,0,3,2] row_mask:0xf bank_mask:0xf
v_fmac_f32_dpp v45, v45, v9 quad_perm:[1,0,3,2] row_mask:0xf bank_mask:0xf
v_fmac_f32_dpp v28, v28, v9 quad_perm:[1,0,3,2] row_mask:0xf bank_mask:0xf
v_fmac_f32_dpp v29, v29, v9 quad_perm:[1,0,3,2] row_mask:0xf bank_mask:0xf
v_fmac_f32_dpp v60, v60, v9 quad_perm:[1,0,3,2] row_mask:0xf bank_mask:0xf
v_fmac_f32_dpp v61, v61, v9 quad_perm:[1,0,3,2] row_mask:0xf bank_mask:0xf
v_fmac_f32_dpp v76, v76, v9 quad_perm:[1,0,3,2] row_mask:0xf bank_mask:0xf
v_fmac_f32_dpp v77, v77, v9 quad_perm:[1,0,3,2] row_mask:0xf bank_mask:0xf
v_fmac_f32_dpp v46, v46, v9 quad_perm:[1,0,3,2] row_mask:0xf bank_mask:0xf
v_fmac_f32_dpp v47, v47, v9 quad_perm:[1,0,3,2] row_mask:0xf bank_mask:0xf
v_fmac_f32_dpp v30, v30, v9 quad_perm:[1,0,3,2] row_mask:0xf bank_mask:0xf
v_fmac_f32_dpp v31, v31, v9 quad_perm:[1,0,3,2] row_mask:0xf bank_mask:0xf
v_fmac_f32_dpp v62, v62, v9 quad_perm:[1,0,3,2] row_mask:0xf bank_mask:0xf
v_fmac_f32_dpp v63, v63, v9 quad_perm:[1,0,3,2] row_mask:0xf bank_mask:0xf
v_fmac_f32_dpp v22, v22, v9 quad_perm:[1,0,3,2] row_mask:0xf bank_mask:0xf
v_fmac_f32_dpp v23, v23, v9 quad_perm:[1,0,3,2] row_mask:0xf bank_mask:0xf
v_fmac_f32_dpp v54, v54, v9 quad_perm:[1,0,3,2] row_mask:0xf bank_mask:0xf
v_fmac_f32_dpp v55, v55, v9 quad_perm:[1,0,3,2] row_mask:0xf bank_mask:0xf
v_fmac_f32_dpp v38, v38, v9 quad_perm:[1,0,3,2] row_mask:0xf bank_mask:0xf
v_fmac_f32_dpp v39, v39, v9 quad_perm:[1,0,3,2] row_mask:0xf bank_mask:0xf
v_fmac_f32_dpp v70, v70, v9 quad_perm:[1,0,3,2] row_mask:0xf bank_mask:0xf
v_fmac_f32_dpp v71, v71, v9 quad_perm:[1,0,3,2] row_mask:0xf bank_mask:0xf
v_fmac_f32_dpp v78, v78, v9 quad_perm:[1,0,3,2] row_mask:0xf bank_mask:0xf
v_fmac_f32_dpp v79, v79, v9 quad_perm:[1,0,3,2] row_mask:0xf bank_mask:0xf
v_fmac_f32_dpp v32, v32, v9 quad_perm:[1,0,3,2] row_mask:0xf bank_mask:0xf
v_fmac_f32_dpp v33, v33, v9 quad_perm:[1,0,3,2] row_mask:0xf bank_mask:0xf
v_fmac_f32_dpp v24, v24, v9 quad_perm:[1,0,3,2] row_mask:0xf bank_mask:0xf
v_fmac_f32_dpp v25, v25, v9 quad_perm:[1,0,3,2] row_mask:0xf bank_mask:0xf
v_fmac_f32_dpp v56, v56, v9 quad_perm:[1,0,3,2] row_mask:0xf bank_mask:0xf
v_fmac_f32_dpp v57, v57, v9 quad_perm:[1,0,3,2] row_mask:0xf bank_mask:0xf
v_fmac_f32_dpp v20, v20, v9 quad_perm:[1,0,3,2] row_mask:0xf bank_mask:0xf
v_fmac_f32_dpp v21, v21, v9 quad_perm:[1,0,3,2] row_mask:0xf bank_mask:0xf
v_fmac_f32_dpp v52, v52, v9 quad_perm:[1,0,3,2] row_mask:0xf bank_mask:0xf
v_fmac_f32_dpp v53, v53, v9 quad_perm:[1,0,3,2] row_mask:0xf bank_mask:0xf
v_fmac_f32_dpp v36, v36, v9 quad_perm:[1,0,3,2] row_mask:0xf bank_mask:0xf
v_fmac_f32_dpp v37, v37, v9 quad_perm:[1,0,3,2] row_mask:0xf bank_mask:0xf
v_fmac_f32_dpp v68, v68, v9 quad_perm:[1,0,3,2] row_mask:0xf bank_mask:0xf
v_fmac_f32_dpp v69, v69, v9 quad_perm:[1,0,3,2] row_mask:0xf bank_mask:0xf
v_fmac_f32_dpp v18, v18, v9 quad_perm:[1,0,3,2] row_mask:0xf bank_mask:0xf
v_fmac_f32_dpp v19, v19, v9 quad_perm:[1,0,3,2] row_mask:0xf bank_mask:0xf
v_fmac_f32_dpp v50, v50, v9 quad_perm:[1,0,3,2] row_mask:0xf bank_mask:0xf
v_fmac_f32_dpp v51, v51, v9 quad_perm:[1,0,3,2] row_mask:0xf bank_mask:0xf
v_fmac_f32_dpp v34, v34, v9 quad_perm:[1,0,3,2] row_mask:0xf bank_mask:0xf
v_fmac_f32_dpp v35, v35, v9 quad_perm:[1,0,3,2] row_mask:0xf bank_mask:0xf
v_fmac_f32_dpp v66, v66, v9 quad_perm:[1,0,3,2] row_mask:0xf bank_mask:0xf
v_fmac_f32_dpp v67, v67, v9 quad_perm:[1,0,3,2] row_mask:0xf bank_mask:0xf
v_fmac_f32_dpp v26, v26, v9 quad_perm:[1,0,3,2] row_mask:0xf bank_mask:0xf
v_fmac_f32_dpp v27, v27, v9 quad_perm:[1,0,3,2] row_mask:0xf bank_mask:0xf
v_fmac_f32_dpp v58, v58, v9 quad_perm:[1,0,3,2] row_mask:0xf bank_mask:0xf
v_fmac_f32_dpp v59, v59, v9 quad_perm:[1,0,3,2] row_mask:0xf bank_mask:0xf
v_fmac_f32_dpp v42, v42, v9 quad_perm:[1,0,3,2] row_mask:0xf bank_mask:0xf
v_fmac_f32_dpp v43, v43, v9 quad_perm:[1,0,3,2] row_mask:0xf bank_mask:0xf
v_fmac_f32_dpp v74, v74, v9 quad_perm:[1,0,3,2] row_mask:0xf bank_mask:0xf
v_fmac_f32_dpp v75, v75, v9 quad_perm:[1,0,3,2] row_mask:0xf bank_mask:0xf
v_lshlrev_b32 v240, 16, v208
v_and_b32 v241, 0xffff0000, v208
v_pk_mul_f32 v[48:49], v[16:17], v[240:241] op_sel:[0,0] op_sel_hi:[0,1] neg_lo:[0,0] neg_hi:[0,0]
v_pk_fma_f32 v[16:17], v[16:17], v[240:241], v[48:49] op_sel:[1,1,0] op_sel_hi:[1,0,1] neg_lo:[0,1,0] neg_hi:[0,0,0]
v_lshlrev_b32 v240, 16, v209
v_and_b32 v241, 0xffff0000, v209
v_pk_mul_f32 v[48:49], v[14:15], v[240:241] op_sel:[0,0] op_sel_hi:[0,1] neg_lo:[0,0] neg_hi:[0,0]
v_pk_fma_f32 v[14:15], v[14:15], v[240:241], v[48:49] op_sel:[1,1,0] op_sel_hi:[1,0,1] neg_lo:[0,1,0] neg_hi:[0,0,0]
v_lshlrev_b32 v240, 16, v210
v_and_b32 v241, 0xffff0000, v210
v_pk_mul_f32 v[48:49], v[64:65], v[240:241] op_sel:[0,0] op_sel_hi:[0,1] neg_lo:[0,0] neg_hi:[0,0]
v_pk_fma_f32 v[64:65], v[64:65], v[240:241], v[48:49] op_sel:[1,1,0] op_sel_hi:[1,0,1] neg_lo:[0,1,0] neg_hi:[0,0,0]
v_lshlrev_b32 v240, 16, v211
v_and_b32 v241, 0xffff0000, v211
v_pk_mul_f32 v[48:49], v[40:41], v[240:241] op_sel:[0,0] op_sel_hi:[0,1] neg_lo:[0,0] neg_hi:[0,0]
v_pk_fma_f32 v[40:41], v[40:41], v[240:241], v[48:49] op_sel:[1,1,0] op_sel_hi:[1,0,1] neg_lo:[0,1,0] neg_hi:[0,0,0]
v_lshlrev_b32 v240, 16, v212
v_and_b32 v241, 0xffff0000, v212
v_pk_mul_f32 v[48:49], v[72:73], v[240:241] op_sel:[0,0] op_sel_hi:[0,1] neg_lo:[0,0] neg_hi:[0,0]
v_pk_fma_f32 v[72:73], v[72:73], v[240:241], v[48:49] op_sel:[1,1,0] op_sel_hi:[1,0,1] neg_lo:[0,1,0] neg_hi:[0,0,0]
v_lshlrev_b32 v240, 16, v213
v_and_b32 v241, 0xffff0000, v213
v_pk_mul_f32 v[48:49], v[44:45], v[240:241] op_sel:[0,0] op_sel_hi:[0,1] neg_lo:[0,0] neg_hi:[0,0]
v_pk_fma_f32 v[44:45], v[44:45], v[240:241], v[48:49] op_sel:[1,1,0] op_sel_hi:[1,0,1] neg_lo:[0,1,0] neg_hi:[0,0,0]
v_lshlrev_b32 v240, 16, v214
v_and_b32 v241, 0xffff0000, v214
v_pk_mul_f32 v[48:49], v[28:29], v[240:241] op_sel:[0,0] op_sel_hi:[0,1] neg_lo:[0,0] neg_hi:[0,0]
v_pk_fma_f32 v[28:29], v[28:29], v[240:241], v[48:49] op_sel:[1,1,0] op_sel_hi:[1,0,1] neg_lo:[0,1,0] neg_hi:[0,0,0]
v_lshlrev_b32 v240, 16, v215
v_and_b32 v241, 0xffff0000, v215
v_pk_mul_f32 v[48:49], v[60:61], v[240:241] op_sel:[0,0] op_sel_hi:[0,1] neg_lo:[0,0] neg_hi:[0,0]
v_pk_fma_f32 v[60:61], v[60:61], v[240:241], v[48:49] op_sel:[1,1,0] op_sel_hi:[1,0,1] neg_lo:[0,1,0] neg_hi:[0,0,0]
v_lshlrev_b32 v240, 16, v216
v_and_b32 v241, 0xffff0000, v216
v_pk_mul_f32 v[48:49], v[76:77], v[240:241] op_sel:[0,0] op_sel_hi:[0,1] neg_lo:[0,0] neg_hi:[0,0]
v_pk_fma_f32 v[76:77], v[76:77], v[240:241], v[48:49] op_sel:[1,1,0] op_sel_hi:[1,0,1] neg_lo:[0,1,0] neg_hi:[0,0,0]
v_lshlrev_b32 v240, 16, v217
v_and_b32 v241, 0xffff0000, v217
v_pk_mul_f32 v[48:49], v[46:47], v[240:241] op_sel:[0,0] op_sel_hi:[0,1] neg_lo:[0,0] neg_hi:[0,0]
v_pk_fma_f32 v[46:47], v[46:47], v[240:241], v[48:49] op_sel:[1,1,0] op_sel_hi:[1,0,1] neg_lo:[0,1,0] neg_hi:[0,0,0]
v_lshlrev_b32 v240, 16, v218
v_and_b32 v241, 0xffff0000, v218
v_pk_mul_f32 v[48:49], v[30:31], v[240:241] op_sel:[0,0] op_sel_hi:[0,1] neg_lo:[0,0] neg_hi:[0,0]
v_pk_fma_f32 v[30:31], v[30:31], v[240:241], v[48:49] op_sel:[1,1,0] op_sel_hi:[1,0,1] neg_lo:[0,1,0] neg_hi:[0,0,0]
v_lshlrev_b32 v240, 16, v219
v_and_b32 v241, 0xffff0000, v219
v_pk_mul_f32 v[48:49], v[62:63], v[240:241] op_sel:[0,0] op_sel_hi:[0,1] neg_lo:[0,0] neg_hi:[0,0]
v_pk_fma_f32 v[62:63], v[62:63], v[240:241], v[48:49] op_sel:[1,1,0] op_sel_hi:[1,0,1] neg_lo:[0,1,0] neg_hi:[0,0,0]
v_lshlrev_b32 v240, 16, v220
v_and_b32 v241, 0xffff0000, v220
v_pk_mul_f32 v[48:49], v[22:23], v[240:241] op_sel:[0,0] op_sel_hi:[0,1] neg_lo:[0,0] neg_hi:[0,0]
v_pk_fma_f32 v[22:23], v[22:23], v[240:241], v[48:49] op_sel:[1,1,0] op_sel_hi:[1,0,1] neg_lo:[0,1,0] neg_hi:[0,0,0]
v_lshlrev_b32 v240, 16, v221
v_and_b32 v241, 0xffff0000, v221
v_pk_mul_f32 v[48:49], v[54:55], v[240:241] op_sel:[0,0] op_sel_hi:[0,1] neg_lo:[0,0] neg_hi:[0,0]
v_pk_fma_f32 v[54:55], v[54:55], v[240:241], v[48:49] op_sel:[1,1,0] op_sel_hi:[1,0,1] neg_lo:[0,1,0] neg_hi:[0,0,0]
v_lshlrev_b32 v240, 16, v222
v_and_b32 v241, 0xffff0000, v222
v_pk_mul_f32 v[48:49], v[38:39], v[240:241] op_sel:[0,0] op_sel_hi:[0,1] neg_lo:[0,0] neg_hi:[0,0]
v_pk_fma_f32 v[38:39], v[38:39], v[240:241], v[48:49] op_sel:[1,1,0] op_sel_hi:[1,0,1] neg_lo:[0,1,0] neg_hi:[0,0,0]
v_lshlrev_b32 v240, 16, v223
v_and_b32 v241, 0xffff0000, v223
v_pk_mul_f32 v[48:49], v[70:71], v[240:241] op_sel:[0,0] op_sel_hi:[0,1] neg_lo:[0,0] neg_hi:[0,0]
v_pk_fma_f32 v[70:71], v[70:71], v[240:241], v[48:49] op_sel:[1,1,0] op_sel_hi:[1,0,1] neg_lo:[0,1,0] neg_hi:[0,0,0]
v_lshlrev_b32 v240, 16, v224
v_and_b32 v241, 0xffff0000, v224
v_pk_mul_f32 v[48:49], v[78:79], v[240:241] op_sel:[0,0] op_sel_hi:[0,1] neg_lo:[0,0] neg_hi:[0,0]
v_pk_fma_f32 v[78:79], v[78:79], v[240:241], v[48:49] op_sel:[1,1,0] op_sel_hi:[1,0,1] neg_lo:[0,1,0] neg_hi:[0,0,0]
v_lshlrev_b32 v240, 16, v225
v_and_b32 v241, 0xffff0000, v225
v_pk_mul_f32 v[48:49], v[32:33], v[240:241] op_sel:[0,0] op_sel_hi:[0,1] neg_lo:[0,0] neg_hi:[0,0]
v_pk_fma_f32 v[32:33], v[32:33], v[240:241], v[48:49] op_sel:[1,1,0] op_sel_hi:[1,0,1] neg_lo:[0,1,0] neg_hi:[0,0,0]
v_lshlrev_b32 v240, 16, v226
v_and_b32 v241, 0xffff0000, v226
v_pk_mul_f32 v[48:49], v[24:25], v[240:241] op_sel:[0,0] op_sel_hi:[0,1] neg_lo:[0,0] neg_hi:[0,0]
v_pk_fma_f32 v[24:25], v[24:25], v[240:241], v[48:49] op_sel:[1,1,0] op_sel_hi:[1,0,1] neg_lo:[0,1,0] neg_hi:[0,0,0]
v_lshlrev_b32 v240, 16, v227
v_and_b32 v241, 0xffff0000, v227
v_pk_mul_f32 v[48:49], v[56:57], v[240:241] op_sel:[0,0] op_sel_hi:[0,1] neg_lo:[0,0] neg_hi:[0,0]
v_pk_fma_f32 v[56:57], v[56:57], v[240:241], v[48:49] op_sel:[1,1,0] op_sel_hi:[1,0,1] neg_lo:[0,1,0] neg_hi:[0,0,0]
v_lshlrev_b32 v240, 16, v228
v_and_b32 v241, 0xffff0000, v228
v_pk_mul_f32 v[48:49], v[20:21], v[240:241] op_sel:[0,0] op_sel_hi:[0,1] neg_lo:[0,0] neg_hi:[0,0]
v_pk_fma_f32 v[20:21], v[20:21], v[240:241], v[48:49] op_sel:[1,1,0] op_sel_hi:[1,0,1] neg_lo:[0,1,0] neg_hi:[0,0,0]
v_lshlrev_b32 v240, 16, v229
v_and_b32 v241, 0xffff0000, v229
v_pk_mul_f32 v[48:49], v[52:53], v[240:241] op_sel:[0,0] op_sel_hi:[0,1] neg_lo:[0,0] neg_hi:[0,0]
v_pk_fma_f32 v[52:53], v[52:53], v[240:241], v[48:49] op_sel:[1,1,0] op_sel_hi:[1,0,1] neg_lo:[0,1,0] neg_hi:[0,0,0]
v_lshlrev_b32 v240, 16, v230
v_and_b32 v241, 0xffff0000, v230
v_pk_mul_f32 v[48:49], v[36:37], v[240:241] op_sel:[0,0] op_sel_hi:[0,1] neg_lo:[0,0] neg_hi:[0,0]
v_pk_fma_f32 v[36:37], v[36:37], v[240:241], v[48:49] op_sel:[1,1,0] op_sel_hi:[1,0,1] neg_lo:[0,1,0] neg_hi:[0,0,0]
v_lshlrev_b32 v240, 16, v231
v_and_b32 v241, 0xffff0000, v231
v_pk_mul_f32 v[48:49], v[68:69], v[240:241] op_sel:[0,0] op_sel_hi:[0,1] neg_lo:[0,0] neg_hi:[0,0]
v_pk_fma_f32 v[68:69], v[68:69], v[240:241], v[48:49] op_sel:[1,1,0] op_sel_hi:[1,0,1] neg_lo:[0,1,0] neg_hi:[0,0,0]
v_lshlrev_b32 v240, 16, v232
v_and_b32 v241, 0xffff0000, v232
v_pk_mul_f32 v[48:49], v[18:19], v[240:241] op_sel:[0,0] op_sel_hi:[0,1] neg_lo:[0,0] neg_hi:[0,0]
v_pk_fma_f32 v[18:19], v[18:19], v[240:241], v[48:49] op_sel:[1,1,0] op_sel_hi:[1,0,1] neg_lo:[0,1,0] neg_hi:[0,0,0]
v_lshlrev_b32 v240, 16, v233
v_and_b32 v241, 0xffff0000, v233
v_pk_mul_f32 v[48:49], v[50:51], v[240:241] op_sel:[0,0] op_sel_hi:[0,1] neg_lo:[0,0] neg_hi:[0,0]
v_pk_fma_f32 v[50:51], v[50:51], v[240:241], v[48:49] op_sel:[1,1,0] op_sel_hi:[1,0,1] neg_lo:[0,1,0] neg_hi:[0,0,0]
v_lshlrev_b32 v240, 16, v234
v_and_b32 v241, 0xffff0000, v234
v_pk_mul_f32 v[48:49], v[34:35], v[240:241] op_sel:[0,0] op_sel_hi:[0,1] neg_lo:[0,0] neg_hi:[0,0]
v_pk_fma_f32 v[34:35], v[34:35], v[240:241], v[48:49] op_sel:[1,1,0] op_sel_hi:[1,0,1] neg_lo:[0,1,0] neg_hi:[0,0,0]
v_lshlrev_b32 v240, 16, v235
v_and_b32 v241, 0xffff0000, v235
v_pk_mul_f32 v[48:49], v[66:67], v[240:241] op_sel:[0,0] op_sel_hi:[0,1] neg_lo:[0,0] neg_hi:[0,0]
v_pk_fma_f32 v[66:67], v[66:67], v[240:241], v[48:49] op_sel:[1,1,0] op_sel_hi:[1,0,1] neg_lo:[0,1,0] neg_hi:[0,0,0]
v_lshlrev_b32 v240, 16, v236
v_and_b32 v241, 0xffff0000, v236
v_pk_mul_f32 v[48:49], v[26:27], v[240:241] op_sel:[0,0] op_sel_hi:[0,1] neg_lo:[0,0] neg_hi:[0,0]
v_pk_fma_f32 v[26:27], v[26:27], v[240:241], v[48:49] op_sel:[1,1,0] op_sel_hi:[1,0,1] neg_lo:[0,1,0] neg_hi:[0,0,0]
v_lshlrev_b32 v240, 16, v237
v_and_b32 v241, 0xffff0000, v237
v_pk_mul_f32 v[48:49], v[58:59], v[240:241] op_sel:[0,0] op_sel_hi:[0,1] neg_lo:[0,0] neg_hi:[0,0]
v_pk_fma_f32 v[58:59], v[58:59], v[240:241], v[48:49] op_sel:[1,1,0] op_sel_hi:[1,0,1] neg_lo:[0,1,0] neg_hi:[0,0,0]
v_lshlrev_b32 v240, 16, v238
v_and_b32 v241, 0xffff0000, v238
v_pk_mul_f32 v[48:49], v[42:43], v[240:241] op_sel:[0,0] op_sel_hi:[0,1] neg_lo:[0,0] neg_hi:[0,0]
v_pk_fma_f32 v[42:43], v[42:43], v[240:241], v[48:49] op_sel:[1,1,0] op_sel_hi:[1,0,1] neg_lo:[0,1,0] neg_hi:[0,0,0]
v_lshlrev_b32 v240, 16, v239
v_and_b32 v241, 0xffff0000, v239
v_pk_mul_f32 v[48:49], v[74:75], v[240:241] op_sel:[0,0] op_sel_hi:[0,1] neg_lo:[0,0] neg_hi:[0,0]
v_pk_fma_f32 v[74:75], v[74:75], v[240:241], v[48:49] op_sel:[1,1,0] op_sel_hi:[1,0,1] neg_lo:[0,1,0] neg_hi:[0,0,0]
v_fmac_f32_dpp v16, v16, v7 quad_perm:[1,0,3,2] row_mask:0xf bank_mask:0xf
v_fmac_f32_dpp v17, v17, v7 quad_perm:[1,0,3,2] row_mask:0xf bank_mask:0xf
v_fmac_f32_dpp v14, v14, v7 quad_perm:[1,0,3,2] row_mask:0xf bank_mask:0xf
v_fmac_f32_dpp v15, v15, v7 quad_perm:[1,0,3,2] row_mask:0xf bank_mask:0xf
v_fmac_f32_dpp v64, v64, v7 quad_perm:[1,0,3,2] row_mask:0xf bank_mask:0xf
v_fmac_f32_dpp v65, v65, v7 quad_perm:[1,0,3,2] row_mask:0xf bank_mask:0xf
v_fmac_f32_dpp v40, v40, v7 quad_perm:[1,0,3,2] row_mask:0xf bank_mask:0xf
v_fmac_f32_dpp v41, v41, v7 quad_perm:[1,0,3,2] row_mask:0xf bank_mask:0xf
v_fmac_f32_dpp v72, v72, v7 quad_perm:[1,0,3,2] row_mask:0xf bank_mask:0xf
v_fmac_f32_dpp v73, v73, v7 quad_perm:[1,0,3,2] row_mask:0xf bank_mask:0xf
v_fmac_f32_dpp v44, v44, v7 quad_perm:[1,0,3,2] row_mask:0xf bank_mask:0xf
v_fmac_f32_dpp v45, v45, v7 quad_perm:[1,0,3,2] row_mask:0xf bank_mask:0xf
v_fmac_f32_dpp v28, v28, v7 quad_perm:[1,0,3,2] row_mask:0xf bank_mask:0xf
v_fmac_f32_dpp v29, v29, v7 quad_perm:[1,0,3,2] row_mask:0xf bank_mask:0xf
v_fmac_f32_dpp v60, v60, v7 quad_perm:[1,0,3,2] row_mask:0xf bank_mask:0xf
v_fmac_f32_dpp v61, v61, v7 quad_perm:[1,0,3,2] row_mask:0xf bank_mask:0xf
v_fmac_f32_dpp v76, v76, v7 quad_perm:[1,0,3,2] row_mask:0xf bank_mask:0xf
v_fmac_f32_dpp v77, v77, v7 quad_perm:[1,0,3,2] row_mask:0xf bank_mask:0xf
v_fmac_f32_dpp v46, v46, v7 quad_perm:[1,0,3,2] row_mask:0xf bank_mask:0xf
v_fmac_f32_dpp v47, v47, v7 quad_perm:[1,0,3,2] row_mask:0xf bank_mask:0xf
v_fmac_f32_dpp v30, v30, v7 quad_perm:[1,0,3,2] row_mask:0xf bank_mask:0xf
v_fmac_f32_dpp v31, v31, v7 quad_perm:[1,0,3,2] row_mask:0xf bank_mask:0xf
v_fmac_f32_dpp v62, v62, v7 quad_perm:[1,0,3,2] row_mask:0xf bank_mask:0xf
v_fmac_f32_dpp v63, v63, v7 quad_perm:[1,0,3,2] row_mask:0xf bank_mask:0xf
v_fmac_f32_dpp v22, v22, v7 quad_perm:[1,0,3,2] row_mask:0xf bank_mask:0xf
v_fmac_f32_dpp v23, v23, v7 quad_perm:[1,0,3,2] row_mask:0xf bank_mask:0xf
v_fmac_f32_dpp v54, v54, v7 quad_perm:[1,0,3,2] row_mask:0xf bank_mask:0xf
v_fmac_f32_dpp v55, v55, v7 quad_perm:[1,0,3,2] row_mask:0xf bank_mask:0xf
v_fmac_f32_dpp v38, v38, v7 quad_perm:[1,0,3,2] row_mask:0xf bank_mask:0xf
v_fmac_f32_dpp v39, v39, v7 quad_perm:[1,0,3,2] row_mask:0xf bank_mask:0xf
v_fmac_f32_dpp v70, v70, v7 quad_perm:[1,0,3,2] row_mask:0xf bank_mask:0xf
v_fmac_f32_dpp v71, v71, v7 quad_perm:[1,0,3,2] row_mask:0xf bank_mask:0xf
v_fmac_f32_dpp v78, v78, v7 quad_perm:[1,0,3,2] row_mask:0xf bank_mask:0xf
v_fmac_f32_dpp v79, v79, v7 quad_perm:[1,0,3,2] row_mask:0xf bank_mask:0xf
v_fmac_f32_dpp v32, v32, v7 quad_perm:[1,0,3,2] row_mask:0xf bank_mask:0xf
v_fmac_f32_dpp v33, v33, v7 quad_perm:[1,0,3,2] row_mask:0xf bank_mask:0xf
v_fmac_f32_dpp v24, v24, v7 quad_perm:[1,0,3,2] row_mask:0xf bank_mask:0xf
v_fmac_f32_dpp v25, v25, v7 quad_perm:[1,0,3,2] row_mask:0xf bank_mask:0xf
v_fmac_f32_dpp v56, v56, v7 quad_perm:[1,0,3,2] row_mask:0xf bank_mask:0xf
v_fmac_f32_dpp v57, v57, v7 quad_perm:[1,0,3,2] row_mask:0xf bank_mask:0xf
v_fmac_f32_dpp v20, v20, v7 quad_perm:[1,0,3,2] row_mask:0xf bank_mask:0xf
v_fmac_f32_dpp v21, v21, v7 quad_perm:[1,0,3,2] row_mask:0xf bank_mask:0xf
v_fmac_f32_dpp v52, v52, v7 quad_perm:[1,0,3,2] row_mask:0xf bank_mask:0xf
v_fmac_f32_dpp v53, v53, v7 quad_perm:[1,0,3,2] row_mask:0xf bank_mask:0xf
v_fmac_f32_dpp v36, v36, v7 quad_perm:[1,0,3,2] row_mask:0xf bank_mask:0xf
v_fmac_f32_dpp v37, v37, v7 quad_perm:[1,0,3,2] row_mask:0xf bank_mask:0xf
v_fmac_f32_dpp v68, v68, v7 quad_perm:[1,0,3,2] row_mask:0xf bank_mask:0xf
v_fmac_f32_dpp v69, v69, v7 quad_perm:[1,0,3,2] row_mask:0xf bank_mask:0xf
v_fmac_f32_dpp v18, v18, v7 quad_perm:[1,0,3,2] row_mask:0xf bank_mask:0xf
v_fmac_f32_dpp v19, v19, v7 quad_perm:[1,0,3,2] row_mask:0xf bank_mask:0xf
v_fmac_f32_dpp v50, v50, v7 quad_perm:[1,0,3,2] row_mask:0xf bank_mask:0xf
v_fmac_f32_dpp v51, v51, v7 quad_perm:[1,0,3,2] row_mask:0xf bank_mask:0xf
v_fmac_f32_dpp v34, v34, v7 quad_perm:[1,0,3,2] row_mask:0xf bank_mask:0xf
v_fmac_f32_dpp v35, v35, v7 quad_perm:[1,0,3,2] row_mask:0xf bank_mask:0xf
v_fmac_f32_dpp v66, v66, v7 quad_perm:[1,0,3,2] row_mask:0xf bank_mask:0xf
v_fmac_f32_dpp v67, v67, v7 quad_perm:[1,0,3,2] row_mask:0xf bank_mask:0xf
v_fmac_f32_dpp v26, v26, v7 quad_perm:[1,0,3,2] row_mask:0xf bank_mask:0xf
v_fmac_f32_dpp v27, v27, v7 quad_perm:[1,0,3,2] row_mask:0xf bank_mask:0xf
v_fmac_f32_dpp v58, v58, v7 quad_perm:[1,0,3,2] row_mask:0xf bank_mask:0xf
v_fmac_f32_dpp v59, v59, v7 quad_perm:[1,0,3,2] row_mask:0xf bank_mask:0xf
v_fmac_f32_dpp v42, v42, v7 quad_perm:[1,0,3,2] row_mask:0xf bank_mask:0xf
v_fmac_f32_dpp v43, v43, v7 quad_perm:[1,0,3,2] row_mask:0xf bank_mask:0xf
v_fmac_f32_dpp v74, v74, v7 quad_perm:[1,0,3,2] row_mask:0xf bank_mask:0xf
v_fmac_f32_dpp v75, v75, v7 quad_perm:[1,0,3,2] row_mask:0xf bank_mask:0xf
s_mov_b64 exec, s[18:19]
v_pk_add_f32 v[16:17], v[16:17], 0 neg_lo:[1,0] neg_hi:[1,0]
v_pk_mul_f32 v[48:49], v[14:15], s[48:49] op_sel:[0,0] op_sel_hi:[0,1] neg_lo:[0,1] neg_hi:[0,1]
v_pk_fma_f32 v[14:15], v[14:15], s[48:49], v[48:49] op_sel:[1,1,0] op_sel_hi:[1,0,1] neg_lo:[0,0,0] neg_hi:[0,1,0]
v_pk_mul_f32 v[48:49], v[64:65], s[50:51] op_sel:[0,0] op_sel_hi:[0,1] neg_lo:[0,1] neg_hi:[0,1]
v_pk_fma_f32 v[64:65], v[64:65], s[50:51], v[48:49] op_sel:[1,1,0] op_sel_hi:[1,0,1] neg_lo:[0,0,0] neg_hi:[0,1,0]
v_pk_mul_f32 v[48:49], v[40:41], s[52:53] op_sel:[0,0] op_sel_hi:[0,1] neg_lo:[0,1] neg_hi:[0,1]
v_pk_fma_f32 v[40:41], v[40:41], s[52:53], v[48:49] op_sel:[1,1,0] op_sel_hi:[1,0,1] neg_lo:[0,0,0] neg_hi:[0,1,0]
v_pk_mul_f32 v[48:49], v[72:73], s[54:55] op_sel:[0,0] op_sel_hi:[0,1] neg_lo:[0,1] neg_hi:[0,1]
v_pk_fma_f32 v[72:73], v[72:73], s[54:55], v[48:49] op_sel:[1,1,0] op_sel_hi:[1,0,1] neg_lo:[0,0,0] neg_hi:[0,1,0]
v_pk_mul_f32 v[48:49], v[44:45], s[56:57] op_sel:[0,0] op_sel_hi:[0,1] neg_lo:[0,1] neg_hi:[0,1]
v_pk_fma_f32 v[44:45], v[44:45], s[56:57], v[48:49] op_sel:[1,1,0] op_sel_hi:[1,0,1] neg_lo:[0,0,0] neg_hi:[0,1,0]
v_pk_mul_f32 v[48:49], v[28:29], s[58:59] op_sel:[0,0] op_sel_hi:[0,1] neg_lo:[0,1] neg_hi:[0,1]
v_pk_fma_f32 v[28:29], v[28:29], s[58:59], v[48:49] op_sel:[1,1,0] op_sel_hi:[1,0,1] neg_lo:[0,0,0] neg_hi:[0,1,0]
v_pk_mul_f32 v[48:49], v[60:61], s[60:61] op_sel:[0,0] op_sel_hi:[0,1] neg_lo:[0,1] neg_hi:[0,1]
v_pk_fma_f32 v[60:61], v[60:61], s[60:61], v[48:49] op_sel:[1,1,0] op_sel_hi:[1,0,1] neg_lo:[0,0,0] neg_hi:[0,1,0]
v_pk_mul_f32 v[48:49], v[76:77], s[62:63] op_sel:[0,0] op_sel_hi:[0,1] neg_lo:[0,1] neg_hi:[0,1]
v_pk_fma_f32 v[76:77], v[76:77], s[62:63], v[48:49] op_sel:[1,1,0] op_sel_hi:[1,0,1] neg_lo:[0,0,0] neg_hi:[0,1,0]
v_pk_mul_f32 v[48:49], v[46:47], s[60:61] op_sel:[0,1] op_sel_hi:[0,0] neg_lo:[0,1] neg_hi:[0,1]
v_pk_fma_f32 v[46:47], v[46:47], s[60:61], v[48:49] op_sel:[1,0,0] op_sel_hi:[1,1,1] neg_lo:[0,0,0] neg_hi:[0,1,0]
v_pk_mul_f32 v[48:49], v[30:31], s[58:59] op_sel:[0,1] op_sel_hi:[0,0] neg_lo:[0,1] neg_hi:[0,1]
v_pk_fma_f32 v[30:31], v[30:31], s[58:59], v[48:49] op_sel:[1,0,0] op_sel_hi:[1,1,1] neg_lo:[0,0,0] neg_hi:[0,1,0]
v_pk_mul_f32 v[48:49], v[62:63], s[56:57] op_sel:[0,1] op_sel_hi:[0,0] neg_lo:[0,1] neg_hi:[0,1]
v_pk_fma_f32 v[62:63], v[62:63], s[56:57], v[48:49] op_sel:[1,0,0] op_sel_hi:[1,1,1] neg_lo:[0,0,0] neg_hi:[0,1,0]
v_pk_mul_f32 v[48:49], v[22:23], s[54:55] op_sel:[0,1] op_sel_hi:[0,0] neg_lo:[0,1] neg_hi:[0,1]
v_pk_fma_f32 v[22:23], v[22:23], s[54:55], v[48:49] op_sel:[1,0,0] op_sel_hi:[1,1,1] neg_lo:[0,0,0] neg_hi:[0,1,0]
v_pk_mul_f32 v[48:49], v[54:55], s[52:53] op_sel:[0,1] op_sel_hi:[0,0] neg_lo:[0,1] neg_hi:[0,1]
v_pk_fma_f32 v[54:55], v[54:55], s[52:53], v[48:49] op_sel:[1,0,0] op_sel_hi:[1,1,1] neg_lo:[0,0,0] neg_hi:[0,1,0]
v_pk_mul_f32 v[48:49], v[38:39], s[50:51] op_sel:[0,1] op_sel_hi:[0,0] neg_lo:[0,1] neg_hi:[0,1]
v_pk_fma_f32 v[38:39], v[38:39], s[50:51], v[48:49] op_sel:[1,0,0] op_sel_hi:[1,1,1] neg_lo:[0,0,0] neg_hi:[0,1,0]
v_pk_mul_f32 v[48:49], v[70:71], s[48:49] op_sel:[0,1] op_sel_hi:[0,0] neg_lo:[0,1] neg_hi:[0,1]
v_pk_fma_f32 v[70:71], v[70:71], s[48:49], v[48:49] op_sel:[1,0,0] op_sel_hi:[1,1,1] neg_lo:[0,0,0] neg_hi:[0,1,0]
v_pk_add_f32 v[78:79], v[78:79], 0 op_sel:[1,0] op_sel_hi:[0,0] neg_lo:[0,0] neg_hi:[1,0]
v_pk_mul_f32 v[48:49], v[32:33], s[48:49] op_sel:[0,1] op_sel_hi:[0,0] neg_lo:[0,0] neg_hi:[0,1]
v_pk_fma_f32 v[32:33], v[32:33], s[48:49], v[48:49] op_sel:[1,0,0] op_sel_hi:[1,1,1] neg_lo:[0,0,0] neg_hi:[0,0,0]
v_pk_mul_f32 v[48:49], v[24:25], s[50:51] op_sel:[0,1] op_sel_hi:[0,0] neg_lo:[0,0] neg_hi:[0,1]
v_pk_fma_f32 v[24:25], v[24:25], s[50:51], v[48:49] op_sel:[1,0,0] op_sel_hi:[1,1,1] neg_lo:[0,0,0] neg_hi:[0,0,0]
v_pk_mul_f32 v[48:49], v[56:57], s[52:53] op_sel:[0,1] op_sel_hi:[0,0] neg_lo:[0,0] neg_hi:[0,1]
v_pk_fma_f32 v[56:57], v[56:57], s[52:53], v[48:49] op_sel:[1,0,0] op_sel_hi:[1,1,1] neg_lo:[0,0,0] neg_hi:[0,0,0]
v_pk_mul_f32 v[48:49], v[20:21], s[54:55] op_sel:[0,1] op_sel_hi:[0,0] neg_lo:[0,0] neg_hi:[0,1]
v_pk_fma_f32 v[20:21], v[20:21], s[54:55], v[48:49] op_sel:[1,0,0] op_sel_hi:[1,1,1] neg_lo:[0,0,0] neg_hi:[0,0,0]
v_pk_mul_f32 v[48:49], v[52:53], s[56:57] op_sel:[0,1] op_sel_hi:[0,0] neg_lo:[0,0] neg_hi:[0,1]
v_pk_fma_f32 v[52:53], v[52:53], s[56:57], v[48:49] op_sel:[1,0,0] op_sel_hi:[1,1,1] neg_lo:[0,0,0] neg_hi:[0,0,0]
v_pk_mul_f32 v[48:49], v[36:37], s[58:59] op_sel:[0,1] op_sel_hi:[0,0] neg_lo:[0,0] neg_hi:[0,1]
v_pk_fma_f32 v[36:37], v[36:37], s[58:59], v[48:49] op_sel:[1,0,0] op_sel_hi:[1,1,1] neg_lo:[0,0,0] neg_hi:[0,0,0]
v_pk_mul_f32 v[48:49], v[68:69], s[60:61] op_sel:[0,1] op_sel_hi:[0,0] neg_lo:[0,0] neg_hi:[0,1]
v_pk_fma_f32 v[68:69], v[68:69], s[60:61], v[48:49] op_sel:[1,0,0] op_sel_hi:[1,1,1] neg_lo:[0,0,0] neg_hi:[0,0,0]
v_pk_mul_f32 v[48:49], v[18:19], s[62:63] op_sel:[0,0] op_sel_hi:[0,1] neg_lo:[0,0] neg_hi:[0,1]
v_pk_fma_f32 v[18:19], v[18:19], s[62:63], v[48:49] op_sel:[1,1,0] op_sel_hi:[1,0,1] neg_lo:[0,0,0] neg_hi:[0,0,0]
v_pk_mul_f32 v[48:49], v[50:51], s[60:61] op_sel:[0,0] op_sel_hi:[0,1] neg_lo:[0,0] neg_hi:[0,1]
v_pk_fma_f32 v[50:51], v[50:51], s[60:61], v[48:49] op_sel:[1,1,0] op_sel_hi:[1,0,1] neg_lo:[0,0,0] neg_hi:[0,0,0]
v_pk_mul_f32 v[48:49], v[34:35], s[58:59] op_sel:[0,0] op_sel_hi:[0,1] neg_lo:[0,0] neg_hi:[0,1]
v_pk_fma_f32 v[34:35], v[34:35], s[58:59], v[48:49] op_sel:[1,1,0] op_sel_hi:[1,0,1] neg_lo:[0,0,0] neg_hi:[0,0,0]
v_pk_mul_f32 v[48:49], v[66:67], s[56:57] op_sel:[0,0] op_sel_hi:[0,1] neg_lo:[0,0] neg_hi:[0,1]
v_pk_fma_f32 v[66:67], v[66:67], s[56:57], v[48:49] op_sel:[1,1,0] op_sel_hi:[1,0,1] neg_lo:[0,0,0] neg_hi:[0,0,0]
v_pk_mul_f32 v[48:49], v[26:27], s[54:55] op_sel:[0,0] op_sel_hi:[0,1] neg_lo:[0,0] neg_hi:[0,1]
v_pk_fma_f32 v[26:27], v[26:27], s[54:55], v[48:49] op_sel:[1,1,0] op_sel_hi:[1,0,1] neg_lo:[0,0,0] neg_hi:[0,0,0]
v_pk_mul_f32 v[48:49], v[58:59], s[52:53] op_sel:[0,0] op_sel_hi:[0,1] neg_lo:[0,0] neg_hi:[0,1]
v_pk_fma_f32 v[58:59], v[58:59], s[52:53], v[48:49] op_sel:[1,1,0] op_sel_hi:[1,0,1] neg_lo:[0,0,0] neg_hi:[0,0,0]
v_pk_mul_f32 v[48:49], v[42:43], s[50:51] op_sel:[0,0] op_sel_hi:[0,1] neg_lo:[0,0] neg_hi:[0,1]
v_pk_fma_f32 v[42:43], v[42:43], s[50:51], v[48:49] op_sel:[1,1,0] op_sel_hi:[1,0,1] neg_lo:[0,0,0] neg_hi:[0,0,0]
v_pk_mul_f32 v[48:49], v[74:75], s[48:49] op_sel:[0,0] op_sel_hi:[0,1] neg_lo:[0,0] neg_hi:[0,1]
v_pk_fma_f32 v[74:75], v[74:75], s[48:49], v[48:49] op_sel:[1,1,0] op_sel_hi:[1,0,1] neg_lo:[0,0,0] neg_hi:[0,0,0]
s_mov_b64 exec, -1
v_pk_add_f32 v[48:49], v[16:17], v[78:79] neg_lo:[0,1] neg_hi:[0,1]
v_pk_add_f32 v[16:17], v[16:17], v[78:79]
v_pk_add_f32 v[78:79], v[14:15], v[32:33] neg_lo:[0,1] neg_hi:[0,1]
v_pk_add_f32 v[14:15], v[14:15], v[32:33]
v_pk_mul_f32 v[32:33], v[78:79], s[50:51] op_sel:[0,0] op_sel_hi:[0,1] neg_lo:[0,0] neg_hi:[0,0]
v_pk_fma_f32 v[32:33], v[78:79], s[50:51], v[32:33] op_sel:[1,1,0] op_sel_hi:[1,0,1] neg_lo:[0,1,0] neg_hi:[0,0,0]
v_pk_add_f32 v[78:79], v[64:65], v[24:25] neg_lo:[0,1] neg_hi:[0,1]
v_pk_add_f32 v[64:65], v[64:65], v[24:25]
v_pk_mul_f32 v[24:25], v[78:79], s[54:55] op_sel:[0,0] op_sel_hi:[0,1] neg_lo:[0,0] neg_hi:[0,0]
v_pk_fma_f32 v[24:25], v[78:79], s[54:55], v[24:25] op_sel:[1,1,0] op_sel_hi:[1,0,1] neg_lo:[0,1,0] neg_hi:[0,0,0]
v_pk_add_f32 v[78:79], v[40:41], v[56:57] neg_lo:[0,1] neg_hi:[0,1]
v_pk_add_f32 v[40:41], v[40:41], v[56:57]
v_pk_mul_f32 v[56:57], v[78:79], s[58:59] op_sel:[0,0] op_sel_hi:[0,1] neg_lo:[0,0] neg_hi:[0,0]
v_pk_fma_f32 v[56:57], v[78:79], s[58:59], v[56:57] op_sel:[1,1,0] op_sel_hi:[1,0,1] neg_lo:[0,1,0] neg_hi:[0,0,0]
v_pk_add_f32 v[78:79], v[72:73], v[20:21] neg_lo:[0,1] neg_hi:[0,1]
v_pk_add_f32 v[72:73], v[72:73], v[20:21]
v_pk_mul_f32 v[20:21], v[78:79], s[62:63] op_sel:[0,0] op_sel_hi:[0,1] neg_lo:[0,0] neg_hi:[0,0]
v_pk_fma_f32 v[20:21], v[78:79], s[62:63], v[20:21] op_sel:[1,1,0] op_sel_hi:[1,0,1] neg_lo:[0,1,0] neg_hi:[0,0,0]
v_pk_add_f32 v[78:79], v[44:45], v[52:53] neg_lo:[0,1] neg_hi:[0,1]
v_pk_add_f32 v[44:45], v[44:45], v[52:53]
v_pk_mul_f32 v[52:53], v[78:79], s[58:59] op_sel:[0,1] op_sel_hi:[0,0] neg_lo:[0,0] neg_hi:[0,0]
v_pk_fma_f32 v[52:53], v[78:79], s[58:59], v[52:53] op_sel:[1,0,0] op_sel_hi:[1,1,1] neg_lo:[0,1,0] neg_hi:[0,0,0]
v_pk_add_f32 v[78:79], v[28:29], v[36:37] neg_lo:[0,1] neg_hi:[0,1]
v_pk_add_f32 v[28:29], v[28:29], v[36:37]
v_pk_mul_f32 v[36:37], v[78:79], s[54:55] op_sel:[0,1] op_sel_hi:[0,0] neg_lo:[0,0] neg_hi:[0,0]
v_pk_fma_f32 v[36:37], v[78:79], s[54:55], v[36:37] op_sel:[1,0,0] op_sel_hi:[1,1,1] neg_lo:[0,1,0] neg_hi:[0,0,0]
v_pk_add_f32 v[78:79], v[60:61], v[68:69] neg_lo:[0,1] neg_hi:[0,1]
v_pk_add_f32 v[60:61], v[60:61], v[68:69]
v_pk_mul_f32 v[68:69], v[78:79], s[50:51] op_sel:[0,1] op_sel_hi:[0,0] neg_lo:[0,0] neg_hi:[0,0]
v_pk_fma_f32 v[68:69], v[78:79], s[50:51], v[68:69] op_sel:[1,0,0] op_sel_hi:[1,1,1] neg_lo:[0,1,0] neg_hi:[0,0,0]
v_pk_add_f32 v[78:79], v[76:77], v[18:19] op_sel:[1,1] op_sel_hi:[0,0] neg_lo:[1,0] neg_hi:[0,1]
v_pk_add_f32 v[76:77], v[76:77], v[18:19]
v_pk_add_f32 v[18:19], v[46:47], v[50:51] neg_lo:[0,1] neg_hi:[0,1]
v_pk_add_f32 v[46:47], v[46:47], v[50:51]
v_pk_mul_f32 v[50:51], v[18:19], s[50:51] op_sel:[0,1] op_sel_hi:[0,0] neg_lo:[0,1] neg_hi:[0,0]
v_pk_fma_f32 v[50:51], v[18:19], s[50:51], v[50:51] op_sel:[1,0,0] op_sel_hi:[1,1,1] neg_lo:[0,1,0] neg_hi:[0,1,0]
v_pk_add_f32 v[18:19], v[30:31], v[34:35] neg_lo:[0,1] neg_hi:[0,1]
v_pk_add_f32 v[30:31], v[30:31], v[34:35]
v_pk_mul_f32 v[34:35], v[18:19], s[54:55] op_sel:[0,1] op_sel_hi:[0,0] neg_lo:[0,1] neg_hi:[0,0]
v_pk_fma_f32 v[34:35], v[18:19], s[54:55], v[34:35] op_sel:[1,0,0] op_sel_hi:[1,1,1] neg_lo:[0,1,0] neg_hi:[0,1,0]
v_pk_add_f32 v[18:19], v[62:63], v[66:67] neg_lo:[0,1] neg_hi:[0,1]
v_pk_add_f32 v[62:63], v[62:63], v[66:67]
v_pk_mul_f32 v[66:67], v[18:19], s[58:59] op_sel:[0,1] op_sel_hi:[0,0] neg_lo:[0,1] neg_hi:[0,0]
v_pk_fma_f32 v[66:67], v[18:19], s[58:59], v[66:67] op_sel:[1,0,0] op_sel_hi:[1,1,1] neg_lo:[0,1,0] neg_hi:[0,1,0]
v_pk_add_f32 v[18:19], v[22:23], v[26:27] neg_lo:[0,1] neg_hi:[0,1]
v_pk_add_f32 v[22:23], v[22:23], v[26:27]
v_pk_mul_f32 v[26:27], v[18:19], s[62:63] op_sel:[0,0] op_sel_hi:[0,1] neg_lo:[0,1] neg_hi:[0,0]
v_pk_fma_f32 v[26:27], v[18:19], s[62:63], v[26:27] op_sel:[1,1,0] op_sel_hi:[1,0,1] neg_lo:[0,1,0] neg_hi:[0,1,0]
v_pk_add_f32 v[18:19], v[54:55], v[58:59] neg_lo:[0,1] neg_hi:[0,1]
v_pk_add_f32 v[54:55], v[54:55], v[58:59]
v_pk_mul_f32 v[58:59], v[18:19], s[58:59] op_sel:[0,0] op_sel_hi:[0,1] neg_lo:[0,1] neg_hi:[0,0]
v_pk_fma_f32 v[58:59], v[18:19], s[58:59], v[58:59] op_sel:[1,1,0] op_sel_hi:[1,0,1] neg_lo:[0,1,0] neg_hi:[0,1,0]
v_pk_add_f32 v[18:19], v[38:39], v[42:43] neg_lo:[0,1] neg_hi:[0,1]
v_pk_add_f32 v[38:39], v[38:39], v[42:43]
v_pk_mul_f32 v[42:43], v[18:19], s[54:55] op_sel:[0,0] op_sel_hi:[0,1] neg_lo:[0,1] neg_hi:[0,0]
v_pk_fma_f32 v[42:43], v[18:19], s[54:55], v[42:43] op_sel:[1,1,0] op_sel_hi:[1,0,1] neg_lo:[0,1,0] neg_hi:[0,1,0]
v_pk_add_f32 v[18:19], v[70:71], v[74:75] neg_lo:[0,1] neg_hi:[0,1]
v_pk_add_f32 v[70:71], v[70:71], v[74:75]
v_pk_mul_f32 v[74:75], v[18:19], s[50:51] op_sel:[0,0] op_sel_hi:[0,1] neg_lo:[0,1] neg_hi:[0,0]
v_pk_fma_f32 v[74:75], v[18:19], s[50:51], v[74:75] op_sel:[1,1,0] op_sel_hi:[1,0,1] neg_lo:[0,1,0] neg_hi:[0,1,0]
v_pk_add_f32 v[18:19], v[16:17], v[76:77] neg_lo:[0,1] neg_hi:[0,1]
v_pk_add_f32 v[16:17], v[16:17], v[76:77]
v_pk_add_f32 v[76:77], v[14:15], v[46:47] neg_lo:[0,1] neg_hi:[0,1]
v_pk_add_f32 v[14:15], v[14:15], v[46:47]
v_pk_mul_f32 v[46:47], v[76:77], s[54:55] op_sel:[0,0] op_sel_hi:[0,1] neg_lo:[0,0] neg_hi:[0,0]
v_pk_fma_f32 v[46:47], v[76:77], s[54:55], v[46:47] op_sel:[1,1,0] op_sel_hi:[1,0,1] neg_lo:[0,1,0] neg_hi:[0,0,0]
v_pk_add_f32 v[76:77], v[64:65], v[30:31] neg_lo:[0,1] neg_hi:[0,1]
v_pk_add_f32 v[64:65], v[64:65], v[30:31]
v_pk_mul_f32 v[30:31], v[76:77], s[62:63] op_sel:[0,0] op_sel_hi:[0,1] neg_lo:[0,0] neg_hi:[0,0]
v_pk_fma_f32 v[30:31], v[76:77], s[62:63], v[30:31] op_sel:[1,1,0] op_sel_hi:[1,0,1] neg_lo:[0,1,0] neg_hi:[0,0,0]
v_pk_add_f32 v[76:77], v[40:41], v[62:63] neg_lo:[0,1] neg_hi:[0,1]
v_pk_add_f32 v[40:41], v[40:41], v[62:63]
v_pk_mul_f32 v[62:63], v[76:77], s[54:55] op_sel:[0,1] op_sel_hi:[0,0] neg_lo:[0,0] neg_hi:[0,0]
v_pk_fma_f32 v[62:63], v[76:77], s[54:55], v[62:63] op_sel:[1,0,0] op_sel_hi:[1,1,1] neg_lo:[0,1,0] neg_hi:[0,0,0]
v_pk_add_f32 v[76:77], v[72:73], v[22:23] op_sel:[1,1] op_sel_hi:[0,0] neg_lo:[1,0] neg_hi:[0,1]
v_pk_add_f32 v[72:73], v[72:73], v[22:23]
v_pk_add_f32 v[22:23], v[44:45], v[54:55] neg_lo:[0,1] neg_hi:[0,1]
v_pk_add_f32 v[44:45], v[44:45], v[54:55]
v_pk_mul_f32 v[54:55], v[22:23], s[54:55] op_sel:[0,1] op_sel_hi:[0,0] neg_lo:[0,1] neg_hi:[0,0]
v_pk_fma_f32 v[54:55], v[22:23], s[54:55], v[54:55] op_sel:[1,0,0] op_sel_hi:[1,1,1] neg_lo:[0,1,0] neg_hi:[0,1,0]
v_pk_add_f32 v[22:23], v[28:29], v[38:39] neg_lo:[0,1] neg_hi:[0,1]
v_pk_add_f32 v[28:29], v[28:29], v[38:39]
v_pk_mul_f32 v[38:39], v[22:23], s[62:63] op_sel:[0,0] op_sel_hi:[0,1] neg_lo:[0,1] neg_hi:[0,0]
v_pk_fma_f32 v[38:39], v[22:23], s[62:63], v[38:39] op_sel:[1,1,0] op_sel_hi:[1,0,1] neg_lo:[0,1,0] neg_hi:[0,1,0]
v_pk_add_f32 v[22:23], v[60:61], v[70:71] neg_lo:[0,1] neg_hi:[0,1]
v_pk_add_f32 v[60:61], v[60:61], v[70:71]
v_pk_mul_f32 v[70:71], v[22:23], s[54:55] op_sel:[0,0] op_sel_hi:[0,1] neg_lo:[0,1] neg_hi:[0,0]
v_pk_fma_f32 v[70:71], v[22:23], s[54:55], v[70:71] op_sel:[1,1,0] op_sel_hi:[1,0,1] neg_lo:[0,1,0] neg_hi:[0,1,0]
v_pk_add_f32 v[22:23], v[48:49], v[78:79] neg_lo:[0,1] neg_hi:[0,1]
v_pk_add_f32 v[48:49], v[48:49], v[78:79]
v_pk_add_f32 v[78:79], v[32:33], v[50:51] neg_lo:[0,1] neg_hi:[0,1]
v_pk_add_f32 v[32:33], v[32:33], v[50:51]
v_pk_mul_f32 v[50:51], v[78:79], s[54:55] op_sel:[0,0] op_sel_hi:[0,1] neg_lo:[0,0] neg_hi:[0,0]
v_pk_fma_f32 v[50:51], v[78:79], s[54:55], v[50:51] op_sel:[1,1,0] op_sel_hi:[1,0,1] neg_lo:[0,1,0] neg_hi:[0,0,0]
v_pk_add_f32 v[78:79], v[24:25], v[34:35] neg_lo:[0,1] neg_hi:[0,1]
v_pk_add_f32 v[24:25], v[24:25], v[34:35]
v_pk_mul_f32 v[34:35], v[78:79], s[62:63] op_sel:[0,0] op_sel_hi:[0,1] neg_lo:[0,0] neg_hi:[0,0]
v_pk_fma_f32 v[34:35], v[78:79], s[62:63], v[34:35] op_sel:[1,1,0] op_sel_hi:[1,0,1] neg_lo:[0,1,0] neg_hi:[0,0,0]
v_pk_add_f32 v[78:79], v[56:57], v[66:67] neg_lo:[0,1] neg_hi:[0,1]
v_pk_add_f32 v[56:57], v[56:57], v[66:67]
v_pk_mul_f32 v[66:67], v[78:79], s[54:55] op_sel:[0,1] op_sel_hi:[0,0] neg_lo:[0,0] neg_hi:[0,0]
v_pk_fma_f32 v[66:67], v[78:79], s[54:55], v[66:67] op_sel:[1,0,0] op_sel_hi:[1,1,1] neg_lo:[0,1,0] neg_hi:[0,0,0]
v_pk_add_f32 v[78:79], v[20:21], v[26:27] op_sel:[1,1] op_sel_hi:[0,0] neg_lo:[1,0] neg_hi:[0,1]
v_pk_add_f32 v[20:21], v[20:21], v[26:27]
v_pk_add_f32 v[26:27], v[52:53], v[58:59] neg_lo:[0,1] neg_hi:[0,1]
v_pk_add_f32 v[52:53], v[52:53], v[58:59]
v_pk_mul_f32 v[58:59], v[26:27], s[54:55] op_sel:[0,1] op_sel_hi:[0,0] neg_lo:[0,1] neg_hi:[0,0]
v_pk_fma_f32 v[58:59], v[26:27], s[54:55], v[58:59] op_sel:[1,0,0] op_sel_hi:[1,1,1] neg_lo:[0,1,0] neg_hi:[0,1,0]
v_pk_add_f32 v[26:27], v[36:37], v[42:43] neg_lo:[0,1] neg_hi:[0,1]
v_pk_add_f32 v[36:37], v[36:37], v[42:43]
v_pk_mul_f32 v[42:43], v[26:27], s[62:63] op_sel:[0,0] op_sel_hi:[0,1] neg_lo:[0,1] neg_hi:[0,0]
v_pk_fma_f32 v[42:43], v[26:27], s[62:63], v[42:43] op_sel:[1,1,0] op_sel_hi:[1,0,1] neg_lo:[0,1,0] neg_hi:[0,1,0]
v_pk_add_f32 v[26:27], v[68:69], v[74:75] neg_lo:[0,1] neg_hi:[0,1]
v_pk_add_f32 v[68:69], v[68:69], v[74:75]
v_pk_mul_f32 v[74:75], v[26:27], s[54:55] op_sel:[0,0] op_sel_hi:[0,1] neg_lo:[0,1] neg_hi:[0,0]
v_pk_fma_f32 v[74:75], v[26:27], s[54:55], v[74:75] op_sel:[1,1,0] op_sel_hi:[1,0,1] neg_lo:[0,1,0] neg_hi:[0,1,0]
v_pk_add_f32 v[26:27], v[16:17], v[72:73] neg_lo:[0,1] neg_hi:[0,1]
v_pk_add_f32 v[16:17], v[16:17], v[72:73]
v_pk_add_f32 v[72:73], v[14:15], v[44:45] neg_lo:[0,1] neg_hi:[0,1]
v_pk_add_f32 v[14:15], v[14:15], v[44:45]
v_pk_mul_f32 v[44:45], v[72:73], s[62:63] op_sel:[0,0] op_sel_hi:[0,1] neg_lo:[0,0] neg_hi:[0,0]
v_pk_fma_f32 v[44:45], v[72:73], s[62:63], v[44:45] op_sel:[1,1,0] op_sel_hi:[1,0,1] neg_lo:[0,1,0] neg_hi:[0,0,0]
v_pk_add_f32 v[72:73], v[64:65], v[28:29] op_sel:[1,1] op_sel_hi:[0,0] neg_lo:[1,0] neg_hi:[0,1]
v_pk_add_f32 v[64:65], v[64:65], v[28:29]
v_pk_add_f32 v[28:29], v[40:41], v[60:61] neg_lo:[0,1] neg_hi:[0,1]
v_pk_add_f32 v[40:41], v[40:41], v[60:61]
v_pk_mul_f32 v[60:61], v[28:29], s[62:63] op_sel:[0,0] op_sel_hi:[0,1] neg_lo:[0,1] neg_hi:[0,0]
v_pk_fma_f32 v[60:61], v[28:29], s[62:63], v[60:61] op_sel:[1,1,0] op_sel_hi:[1,0,1] neg_lo:[0,1,0] neg_hi:[0,1,0]
v_pk_add_f32 v[28:29], v[18:19], v[76:77] neg_lo:[0,1] neg_hi:[0,1]
v_pk_add_f32 v[18:19], v[18:19], v[76:77]
v_pk_add_f32 v[76:77], v[46:47], v[54:55] neg_lo:[0,1] neg_hi:[0,1]
v_pk_add_f32 v[46:47], v[46:47], v[54:55]
v_pk_mul_f32 v[54:55], v[76:77], s[62:63] op_sel:[0,0] op_sel_hi:[0,1] neg_lo:[0,0] neg_hi:[0,0]
v_pk_fma_f32 v[54:55], v[76:77], s[62:63], v[54:55] op_sel:[1,1,0] op_sel_hi:[1,0,1] neg_lo:[0,1,0] neg_hi:[0,0,0]
v_pk_add_f32 v[76:77], v[30:31], v[38:39] op_sel:[1,1] op_sel_hi:[0,0] neg_lo:[1,0] neg_hi:[0,1]
v_pk_add_f32 v[30:31], v[30:31], v[38:39]
v_pk_add_f32 v[38:39], v[62:63], v[70:71] neg_lo:[0,1] neg_hi:[0,1]
v_pk_add_f32 v[62:63], v[62:63], v[70:71]
v_pk_mul_f32 v[70:71], v[38:39], s[62:63] op_sel:[0,0] op_sel_hi:[0,1] neg_lo:[0,1] neg_hi:[0,0]
v_pk_fma_f32 v[70:71], v[38:39], s[62:63], v[70:71] op_sel:[1,1,0] op_sel_hi:[1,0,1] neg_lo:[0,1,0] neg_hi:[0,1,0]
v_pk_add_f32 v[38:39], v[48:49], v[20:21] neg_lo:[0,1] neg_hi:[0,1]
v_pk_add_f32 v[48:49], v[48:49], v[20:21]
v_pk_add_f32 v[20:21], v[32:33], v[52:53] neg_lo:[0,1] neg_hi:[0,1]
v_pk_add_f32 v[32:33], v[32:33], v[52:53]
v_pk_mul_f32 v[52:53], v[20:21], s[62:63] op_sel:[0,0] op_sel_hi:[0,1] neg_lo:[0,0] neg_hi:[0,0]
v_pk_fma_f32 v[52:53], v[20:21], s[62:63], v[52:53] op_sel:[1,1,0] op_sel_hi:[1,0,1] neg_lo:[0,1,0] neg_hi:[0,0,0]
v_pk_add_f32 v[20:21], v[24:25], v[36:37] op_sel:[1,1] op_sel_hi:[0,0] neg_lo:[1,0] neg_hi:[0,1]
v_pk_add_f32 v[24:25], v[24:25], v[36:37]
v_pk_add_f32 v[36:37], v[56:57], v[68:69] neg_lo:[0,1] neg_hi:[0,1]
v_pk_add_f32 v[56:57], v[56:57], v[68:69]
v_pk_mul_f32 v[68:69], v[36:37], s[62:63] op_sel:[0,0] op_sel_hi:[0,1] neg_lo:[0,1] neg_hi:[0,0]
v_pk_fma_f32 v[68:69], v[36:37], s[62:63], v[68:69] op_sel:[1,1,0] op_sel_hi:[1,0,1] neg_lo:[0,1,0] neg_hi:[0,1,0]
v_pk_add_f32 v[36:37], v[22:23], v[78:79] neg_lo:[0,1] neg_hi:[0,1]
v_pk_add_f32 v[22:23], v[22:23], v[78:79]
v_pk_add_f32 v[78:79], v[50:51], v[58:59] neg_lo:[0,1] neg_hi:[0,1]
v_pk_add_f32 v[50:51], v[50:51], v[58:59]
v_pk_mul_f32 v[58:59], v[78:79], s[62:63] op_sel:[0,0] op_sel_hi:[0,1] neg_lo:[0,0] neg_hi:[0,0]
v_pk_fma_f32 v[58:59], v[78:79], s[62:63], v[58:59] op_sel:[1,1,0] op_sel_hi:[1,0,1] neg_lo:[0,1,0] neg_hi:[0,0,0]
v_pk_add_f32 v[78:79], v[34:35], v[42:43] op_sel:[1,1] op_sel_hi:[0,0] neg_lo:[1,0] neg_hi:[0,1]
v_pk_add_f32 v[34:35], v[34:35], v[42:43]
v_pk_add_f32 v[42:43], v[66:67], v[74:75] neg_lo:[0,1] neg_hi:[0,1]
v_pk_add_f32 v[66:67], v[66:67], v[74:75]
v_pk_mul_f32 v[74:75], v[42:43], s[62:63] op_sel:[0,0] op_sel_hi:[0,1] neg_lo:[0,1] neg_hi:[0,0]
v_pk_fma_f32 v[74:75], v[42:43], s[62:63], v[74:75] op_sel:[1,1,0] op_sel_hi:[1,0,1] neg_lo:[0,1,0] neg_hi:[0,1,0]
v_pk_add_f32 v[42:43], v[16:17], v[64:65] neg_lo:[0,1] neg_hi:[0,1]
v_pk_add_f32 v[16:17], v[16:17], v[64:65]
v_pk_add_f32 v[64:65], v[14:15], v[40:41] op_sel:[1,1] op_sel_hi:[0,0] neg_lo:[1,0] neg_hi:[0,1]
v_pk_add_f32 v[14:15], v[14:15], v[40:41]
v_pk_add_f32 v[40:41], v[26:27], v[72:73] neg_lo:[0,1] neg_hi:[0,1]
v_pk_add_f32 v[26:27], v[26:27], v[72:73]
v_pk_add_f32 v[72:73], v[44:45], v[60:61] op_sel:[1,1] op_sel_hi:[0,0] neg_lo:[1,0] neg_hi:[0,1]
v_pk_add_f32 v[44:45], v[44:45], v[60:61]
v_pk_add_f32 v[60:61], v[18:19], v[30:31] neg_lo:[0,1] neg_hi:[0,1]
v_pk_add_f32 v[18:19], v[18:19], v[30:31]
v_pk_add_f32 v[30:31], v[46:47], v[62:63] op_sel:[1,1] op_sel_hi:[0,0] neg_lo:[1,0] neg_hi:[0,1]
v_pk_add_f32 v[46:47], v[46:47], v[62:63]
v_pk_add_f32 v[62:63], v[28:29], v[76:77] neg_lo:[0,1] neg_hi:[0,1]
v_pk_add_f32 v[28:29], v[28:29], v[76:77]
v_pk_add_f32 v[76:77], v[54:55], v[70:71] op_sel:[1,1] op_sel_hi:[0,0] neg_lo:[1,0] neg_hi:[0,1]
v_pk_add_f32 v[54:55], v[54:55], v[70:71]
v_pk_add_f32 v[70:71], v[48:49], v[24:25] neg_lo:[0,1] neg_hi:[0,1]
v_pk_add_f32 v[48:49], v[48:49], v[24:25]
v_pk_add_f32 v[24:25], v[32:33], v[56:57] op_sel:[1,1] op_sel_hi:[0,0] neg_lo:[1,0] neg_hi:[0,1]
v_pk_add_f32 v[32:33], v[32:33], v[56:57]
v_pk_add_f32 v[56:57], v[38:39], v[20:21] neg_lo:[0,1] neg_hi:[0,1]
v_pk_add_f32 v[38:39], v[38:39], v[20:21]
v_pk_add_f32 v[20:21], v[52:53], v[68:69] op_sel:[1,1] op_sel_hi:[0,0] neg_lo:[1,0] neg_hi:[0,1]
v_pk_add_f32 v[52:53], v[52:53], v[68:69]
v_pk_add_f32 v[68:69], v[22:23], v[34:35] neg_lo:[0,1] neg_hi:[0,1]
v_pk_add_f32 v[22:23], v[22:23], v[34:35]
v_pk_add_f32 v[34:35], v[50:51], v[66:67] op_sel:[1,1] op_sel_hi:[0,0] neg_lo:[1,0] neg_hi:[0,1]
v_pk_add_f32 v[50:51], v[50:51], v[66:67]
v_pk_add_f32 v[66:67], v[36:37], v[78:79] neg_lo:[0,1] neg_hi:[0,1]
v_pk_add_f32 v[36:37], v[36:37], v[78:79]
v_pk_add_f32 v[78:79], v[58:59], v[74:75] op_sel:[1,1] op_sel_hi:[0,0] neg_lo:[1,0] neg_hi:[0,1]
v_pk_add_f32 v[58:59], v[58:59], v[74:75]
v_pk_add_f32 v[74:75], v[16:17], v[14:15] neg_lo:[0,1] neg_hi:[0,1]
v_pk_add_f32 v[16:17], v[16:17], v[14:15]
v_pk_add_f32 v[14:15], v[42:43], v[64:65] neg_lo:[0,1] neg_hi:[0,1]
v_pk_add_f32 v[42:43], v[42:43], v[64:65]
v_pk_add_f32 v[64:65], v[26:27], v[44:45] neg_lo:[0,1] neg_hi:[0,1]
v_pk_add_f32 v[26:27], v[26:27], v[44:45]
v_pk_add_f32 v[44:45], v[40:41], v[72:73] neg_lo:[0,1] neg_hi:[0,1]
v_pk_add_f32 v[40:41], v[40:41], v[72:73]
v_pk_add_f32 v[72:73], v[18:19], v[46:47] neg_lo:[0,1] neg_hi:[0,1]
v_pk_add_f32 v[18:19], v[18:19], v[46:47]
v_pk_add_f32 v[46:47], v[60:61], v[30:31] neg_lo:[0,1] neg_hi:[0,1]
v_pk_add_f32 v[60:61], v[60:61], v[30:31]
v_pk_add_f32 v[30:31], v[28:29], v[54:55] neg_lo:[0,1] neg_hi:[0,1]
v_pk_add_f32 v[28:29], v[28:29], v[54:55]
v_pk_add_f32 v[54:55], v[62:63], v[76:77] neg_lo:[0,1] neg_hi:[0,1]
v_pk_add_f32 v[62:63], v[62:63], v[76:77]
v_pk_add_f32 v[76:77], v[48:49], v[32:33] neg_lo:[0,1] neg_hi:[0,1]
v_pk_add_f32 v[48:49], v[48:49], v[32:33]
v_pk_add_f32 v[32:33], v[70:71], v[24:25] neg_lo:[0,1] neg_hi:[0,1]
v_pk_add_f32 v[70:71], v[70:71], v[24:25]
v_pk_add_f32 v[24:25], v[38:39], v[52:53] neg_lo:[0,1] neg_hi:[0,1]
v_pk_add_f32 v[38:39], v[38:39], v[52:53]
v_pk_add_f32 v[52:53], v[56:57], v[20:21] neg_lo:[0,1] neg_hi:[0,1]
v_pk_add_f32 v[56:57], v[56:57], v[20:21]
v_pk_add_f32 v[20:21], v[22:23], v[50:51] neg_lo:[0,1] neg_hi:[0,1]
v_pk_add_f32 v[22:23], v[22:23], v[50:51]
v_pk_add_f32 v[50:51], v[68:69], v[34:35] neg_lo:[0,1] neg_hi:[0,1]
v_pk_add_f32 v[68:69], v[68:69], v[34:35]
v_pk_add_f32 v[34:35], v[36:37], v[58:59] neg_lo:[0,1] neg_hi:[0,1]
v_pk_add_f32 v[36:37], v[36:37], v[58:59]
v_pk_add_f32 v[58:59], v[66:67], v[78:79] neg_lo:[0,1] neg_hi:[0,1]
v_pk_add_f32 v[66:67], v[66:67], v[78:79]
v_pk_mul_f32 v[78:79], v[16:17], v[144:145] op_sel:[0,0] op_sel_hi:[0,1] neg_lo:[0,0] neg_hi:[0,0]
v_pk_fma_f32 v[16:17], v[16:17], v[144:145], v[78:79] op_sel:[1,1,0] op_sel_hi:[1,0,1] neg_lo:[0,1,0] neg_hi:[0,0,0]
v_pk_mul_f32 v[78:79], v[48:49], v[146:147] op_sel:[0,0] op_sel_hi:[0,1] neg_lo:[0,0] neg_hi:[0,0]
v_pk_fma_f32 v[48:49], v[48:49], v[146:147], v[78:79] op_sel:[1,1,0] op_sel_hi:[1,0,1] neg_lo:[0,1,0] neg_hi:[0,0,0]
v_pk_mul_f32 v[78:79], v[18:19], v[148:149] op_sel:[0,0] op_sel_hi:[0,1] neg_lo:[0,0] neg_hi:[0,0]
v_pk_fma_f32 v[18:19], v[18:19], v[148:149], v[78:79] op_sel:[1,1,0] op_sel_hi:[1,0,1] neg_lo:[0,1,0] neg_hi:[0,0,0]
v_pk_mul_f32 v[78:79], v[22:23], v[150:151] op_sel:[0,0] op_sel_hi:[0,1] neg_lo:[0,0] neg_hi:[0,0]
v_pk_fma_f32 v[22:23], v[22:23], v[150:151], v[78:79] op_sel:[1,1,0] op_sel_hi:[1,0,1] neg_lo:[0,1,0] neg_hi:[0,0,0]
v_pk_mul_f32 v[78:79], v[26:27], v[152:153] op_sel:[0,0] op_sel_hi:[0,1] neg_lo:[0,0] neg_hi:[0,0]
v_pk_fma_f32 v[26:27], v[26:27], v[152:153], v[78:79] op_sel:[1,1,0] op_sel_hi:[1,0,1] neg_lo:[0,1,0] neg_hi:[0,0,0]
v_pk_mul_f32 v[78:79], v[38:39], v[154:155] op_sel:[0,0] op_sel_hi:[0,1] neg_lo:[0,0] neg_hi:[0,0]
v_pk_fma_f32 v[38:39], v[38:39], v[154:155], v[78:79] op_sel:[1,1,0] op_sel_hi:[1,0,1] neg_lo:[0,1,0] neg_hi:[0,0,0]
v_pk_mul_f32 v[78:79], v[28:29], v[156:157] op_sel:[0,0] op_sel_hi:[0,1] neg_lo:[0,0] neg_hi:[0,0]
v_pk_fma_f32 v[28:29], v[28:29], v[156:157], v[78:79] op_sel:[1,1,0] op_sel_hi:[1,0,1] neg_lo:[0,1,0] neg_hi:[0,0,0]
v_pk_mul_f32 v[78:79], v[36:37], v[158:159] op_sel:[0,0] op_sel_hi:[0,1] neg_lo:[0,0] neg_hi:[0,0]
v_pk_fma_f32 v[36:37], v[36:37], v[158:159], v[78:79] op_sel:[1,1,0] op_sel_hi:[1,0,1] neg_lo:[0,1,0] neg_hi:[0,0,0]
v_pk_mul_f32 v[78:79], v[42:43], v[160:161] op_sel:[0,0] op_sel_hi:[0,1] neg_lo:[0,0] neg_hi:[0,0]
v_pk_fma_f32 v[42:43], v[42:43], v[160:161], v[78:79] op_sel:[1,1,0] op_sel_hi:[1,0,1] neg_lo:[0,1,0] neg_hi:[0,0,0]
v_pk_mul_f32 v[78:79], v[70:71], v[162:163] op_sel:[0,0] op_sel_hi:[0,1] neg_lo:[0,0] neg_hi:[0,0]
v_pk_fma_f32 v[70:71], v[70:71], v[162:163], v[78:79] op_sel:[1,1,0] op_sel_hi:[1,0,1] neg_lo:[0,1,0] neg_hi:[0,0,0]
v_pk_mul_f32 v[78:79], v[60:61], v[164:165] op_sel:[0,0] op_sel_hi:[0,1] neg_lo:[0,0] neg_hi:[0,0]
v_pk_fma_f32 v[60:61], v[60:61], v[164:165], v[78:79] op_sel:[1,1,0] op_sel_hi:[1,0,1] neg_lo:[0,1,0] neg_hi:[0,0,0]
v_pk_mul_f32 v[78:79], v[68:69], v[166:167] op_sel:[0,0] op_sel_hi:[0,1] neg_lo:[0,0] neg_hi:[0,0]
v_pk_fma_f32 v[68:69], v[68:69], v[166:167], v[78:79] op_sel:[1,1,0] op_sel_hi:[1,0,1] neg_lo:[0,1,0] neg_hi:[0,0,0]
v_pk_mul_f32 v[78:79], v[40:41], v[168:169] op_sel:[0,0] op_sel_hi:[0,1] neg_lo:[0,0] neg_hi:[0,0]
v_pk_fma_f32 v[40:41], v[40:41], v[168:169], v[78:79] op_sel:[1,1,0] op_sel_hi:[1,0,1] neg_lo:[0,1,0] neg_hi:[0,0,0]
v_pk_mul_f32 v[78:79], v[56:57], v[170:171] op_sel:[0,0] op_sel_hi:[0,1] neg_lo:[0,0] neg_hi:[0,0]
v_pk_fma_f32 v[56:57], v[56:57], v[170:171], v[78:79] op_sel:[1,1,0] op_sel_hi:[1,0,1] neg_lo:[0,1,0] neg_hi:[0,0,0]
v_pk_mul_f32 v[78:79], v[62:63], v[172:173] op_sel:[0,0] op_sel_hi:[0,1] neg_lo:[0,0] neg_hi:[0,0]
v_pk_fma_f32 v[62:63], v[62:63], v[172:173], v[78:79] op_sel:[1,1,0] op_sel_hi:[1,0,1] neg_lo:[0,1,0] neg_hi:[0,0,0]
v_pk_mul_f32 v[78:79], v[66:67], v[174:175] op_sel:[0,0] op_sel_hi:[0,1] neg_lo:[0,0] neg_hi:[0,0]
v_pk_fma_f32 v[66:67], v[66:67], v[174:175], v[78:79] op_sel:[1,1,0] op_sel_hi:[1,0,1] neg_lo:[0,1,0] neg_hi:[0,0,0]
v_pk_mul_f32 v[78:79], v[74:75], v[176:177] op_sel:[0,0] op_sel_hi:[0,1] neg_lo:[0,0] neg_hi:[0,0]
v_pk_fma_f32 v[74:75], v[74:75], v[176:177], v[78:79] op_sel:[1,1,0] op_sel_hi:[1,0,1] neg_lo:[0,1,0] neg_hi:[0,0,0]
v_pk_mul_f32 v[78:79], v[76:77], v[178:179] op_sel:[0,0] op_sel_hi:[0,1] neg_lo:[0,0] neg_hi:[0,0]
v_pk_fma_f32 v[76:77], v[76:77], v[178:179], v[78:79] op_sel:[1,1,0] op_sel_hi:[1,0,1] neg_lo:[0,1,0] neg_hi:[0,0,0]
v_pk_mul_f32 v[78:79], v[72:73], v[180:181] op_sel:[0,0] op_sel_hi:[0,1] neg_lo:[0,0] neg_hi:[0,0]
v_pk_fma_f32 v[72:73], v[72:73], v[180:181], v[78:79] op_sel:[1,1,0] op_sel_hi:[1,0,1] neg_lo:[0,1,0] neg_hi:[0,0,0]
v_pk_mul_f32 v[78:79], v[20:21], v[182:183] op_sel:[0,0] op_sel_hi:[0,1] neg_lo:[0,0] neg_hi:[0,0]
v_pk_fma_f32 v[20:21], v[20:21], v[182:183], v[78:79] op_sel:[1,1,0] op_sel_hi:[1,0,1] neg_lo:[0,1,0] neg_hi:[0,0,0]
v_pk_mul_f32 v[78:79], v[64:65], v[184:185] op_sel:[0,0] op_sel_hi:[0,1] neg_lo:[0,0] neg_hi:[0,0]
v_pk_fma_f32 v[64:65], v[64:65], v[184:185], v[78:79] op_sel:[1,1,0] op_sel_hi:[1,0,1] neg_lo:[0,1,0] neg_hi:[0,0,0]
v_pk_mul_f32 v[78:79], v[24:25], v[186:187] op_sel:[0,0] op_sel_hi:[0,1] neg_lo:[0,0] neg_hi:[0,0]
v_pk_fma_f32 v[24:25], v[24:25], v[186:187], v[78:79] op_sel:[1,1,0] op_sel_hi:[1,0,1] neg_lo:[0,1,0] neg_hi:[0,0,0]
v_pk_mul_f32 v[78:79], v[30:31], v[188:189] op_sel:[0,0] op_sel_hi:[0,1] neg_lo:[0,0] neg_hi:[0,0]
v_pk_fma_f32 v[30:31], v[30:31], v[188:189], v[78:79] op_sel:[1,1,0] op_sel_hi:[1,0,1] neg_lo:[0,1,0] neg_hi:[0,0,0]
v_pk_mul_f32 v[78:79], v[34:35], v[190:191] op_sel:[0,0] op_sel_hi:[0,1] neg_lo:[0,0] neg_hi:[0,0]
v_pk_fma_f32 v[34:35], v[34:35], v[190:191], v[78:79] op_sel:[1,1,0] op_sel_hi:[1,0,1] neg_lo:[0,1,0] neg_hi:[0,0,0]
v_pk_mul_f32 v[78:79], v[14:15], v[192:193] op_sel:[0,0] op_sel_hi:[0,1] neg_lo:[0,0] neg_hi:[0,0]
v_pk_fma_f32 v[14:15], v[14:15], v[192:193], v[78:79] op_sel:[1,1,0] op_sel_hi:[1,0,1] neg_lo:[0,1,0] neg_hi:[0,0,0]
v_pk_mul_f32 v[78:79], v[32:33], v[194:195] op_sel:[0,0] op_sel_hi:[0,1] neg_lo:[0,0] neg_hi:[0,0]
v_pk_fma_f32 v[32:33], v[32:33], v[194:195], v[78:79] op_sel:[1,1,0] op_sel_hi:[1,0,1] neg_lo:[0,1,0] neg_hi:[0,0,0]
v_pk_mul_f32 v[78:79], v[46:47], v[196:197] op_sel:[0,0] op_sel_hi:[0,1] neg_lo:[0,0] neg_hi:[0,0]
v_pk_fma_f32 v[46:47], v[46:47], v[196:197], v[78:79] op_sel:[1,1,0] op_sel_hi:[1,0,1] neg_lo:[0,1,0] neg_hi:[0,0,0]
v_pk_mul_f32 v[78:79], v[50:51], v[198:199] op_sel:[0,0] op_sel_hi:[0,1] neg_lo:[0,0] neg_hi:[0,0]
v_pk_fma_f32 v[50:51], v[50:51], v[198:199], v[78:79] op_sel:[1,1,0] op_sel_hi:[1,0,1] neg_lo:[0,1,0] neg_hi:[0,0,0]
v_pk_mul_f32 v[78:79], v[44:45], v[200:201] op_sel:[0,0] op_sel_hi:[0,1] neg_lo:[0,0] neg_hi:[0,0]
v_pk_fma_f32 v[44:45], v[44:45], v[200:201], v[78:79] op_sel:[1,1,0] op_sel_hi:[1,0,1] neg_lo:[0,1,0] neg_hi:[0,0,0]
v_pk_mul_f32 v[78:79], v[52:53], v[202:203] op_sel:[0,0] op_sel_hi:[0,1] neg_lo:[0,0] neg_hi:[0,0]
v_pk_fma_f32 v[52:53], v[52:53], v[202:203], v[78:79] op_sel:[1,1,0] op_sel_hi:[1,0,1] neg_lo:[0,1,0] neg_hi:[0,0,0]
v_pk_mul_f32 v[78:79], v[54:55], v[204:205] op_sel:[0,0] op_sel_hi:[0,1] neg_lo:[0,0] neg_hi:[0,0]
v_pk_fma_f32 v[54:55], v[54:55], v[204:205], v[78:79] op_sel:[1,1,0] op_sel_hi:[1,0,1] neg_lo:[0,1,0] neg_hi:[0,0,0]
v_pk_mul_f32 v[78:79], v[58:59], v[206:207] op_sel:[0,0] op_sel_hi:[0,1] neg_lo:[0,0] neg_hi:[0,0]
v_pk_fma_f32 v[58:59], v[58:59], v[206:207], v[78:79] op_sel:[1,1,0] op_sel_hi:[1,0,1] neg_lo:[0,1,0] neg_hi:[0,0,0]
ds_write_b64 v4, v[16:17] offset:0
ds_write_b64 v4, v[48:49] offset:16
ds_write_b64 v4, v[18:19] offset:32
ds_write_b64 v4, v[22:23] offset:48
ds_write_b64 v4, v[26:27] offset:64
ds_write_b64 v4, v[38:39] offset:80
ds_write_b64 v4, v[28:29] offset:96
ds_write_b64 v4, v[36:37] offset:112
ds_write_b64 v4, v[42:43] offset:128
ds_write_b64 v4, v[70:71] offset:144
ds_write_b64 v4, v[60:61] offset:160
ds_write_b64 v4, v[68:69] offset:176
ds_write_b64 v4, v[40:41] offset:192
ds_write_b64 v4, v[56:57] offset:208
ds_write_b64 v4, v[62:63] offset:224
ds_write_b64 v4, v[66:67] offset:240
ds_write_b64 v4, v[74:75] offset:256
ds_write_b64 v4, v[76:77] offset:272
ds_write_b64 v4, v[72:73] offset:288
ds_write_b64 v4, v[20:21] offset:304
ds_write_b64 v4, v[64:65] offset:320
ds_write_b64 v4, v[24:25] offset:336
ds_write_b64 v4, v[30:31] offset:352
ds_write_b64 v4, v[34:35] offset:368
ds_write_b64 v4, v[14:15] offset:384
ds_write_b64 v4, v[32:33] offset:400
ds_write_b64 v4, v[46:47] offset:416
ds_write_b64 v4, v[50:51] offset:432
ds_write_b64 v4, v[44:45] offset:448
ds_write_b64 v4, v[52:53] offset:464
ds_write_b64 v4, v[54:55] offset:480
ds_write_b64 v4, v[58:59] offset:496
s_waitcnt lgkmcnt(0)
ds_read_b64 v[16:17], v3 offset:0
ds_read_b64 v[48:49], v3 offset:8448
ds_read_b64 v[18:19], v3 offset:528
ds_read_b64 v[50:51], v3 offset:8976
ds_read_b64 v[20:21], v3 offset:1056
ds_read_b64 v[52:53], v3 offset:9504
ds_read_b64 v[22:23], v3 offset:1584
ds_read_b64 v[54:55], v3 offset:10032
ds_read_b64 v[24:25], v3 offset:2112
ds_read_b64 v[56:57], v3 offset:10560
ds_read_b64 v[26:27], v3 offset:2640
ds_read_b64 v[58:59], v3 offset:11088
ds_read_b64 v[28:29], v3 offset:3168
ds_read_b64 v[60:61], v3 offset:11616
ds_read_b64 v[30:31], v3 offset:3696
ds_read_b64 v[62:63], v3 offset:12144
ds_read_b64 v[32:33], v3 offset:4224
ds_read_b64 v[64:65], v3 offset:12672
ds_read_b64 v[34:35], v3 offset:4752
ds_read_b64 v[66:67], v3 offset:13200
ds_read_b64 v[36:37], v3 offset:5280
ds_read_b64 v[68:69], v3 offset:13728
ds_read_b64 v[38:39], v3 offset:5808
ds_read_b64 v[70:71], v3 offset:14256
ds_read_b64 v[40:41], v3 offset:6336
ds_read_b64 v[72:73], v3 offset:14784
ds_read_b64 v[42:43], v3 offset:6864
ds_read_b64 v[74:75], v3 offset:15312
ds_read_b64 v[44:45], v3 offset:7392
ds_read_b64 v[76:77], v3 offset:15840
ds_read_b64 v[46:47], v3 offset:7920
ds_read_b64 v[78:79], v3 offset:16368
s_waitcnt lgkmcnt(0)
v_pk_add_f32 v[14:15], v[16:17], v[48:49] neg_lo:[0,1] neg_hi:[0,1]
v_pk_add_f32 v[16:17], v[16:17], v[48:49]
v_pk_add_f32 v[48:49], v[18:19], v[50:51] neg_lo:[0,1] neg_hi:[0,1]
v_pk_add_f32 v[18:19], v[18:19], v[50:51]
v_pk_mul_f32 v[50:51], v[48:49], s[50:51] op_sel:[0,0] op_sel_hi:[0,1] neg_lo:[0,0] neg_hi:[0,0]
v_pk_fma_f32 v[50:51], v[48:49], s[50:51], v[50:51] op_sel:[1,1,0] op_sel_hi:[1,0,1] neg_lo:[0,1,0] neg_hi:[0,0,0]
v_pk_add_f32 v[48:49], v[20:21], v[52:53] neg_lo:[0,1] neg_hi:[0,1]
v_pk_add_f32 v[20:21], v[20:21], v[52:53]
v_pk_mul_f32 v[52:53], v[48:49], s[54:55] op_sel:[0,0] op_sel_hi:[0,1] neg_lo:[0,0] neg_hi:[0,0]
v_pk_fma_f32 v[52:53], v[48:49], s[54:55], v[52:53] op_sel:[1,1,0] op_sel_hi:[1,0,1] neg_lo:[0,1,0] neg_hi:[0,0,0]
v_pk_add_f32 v[48:49], v[22:23], v[54:55] neg_lo:[0,1] neg_hi:[0,1]
v_pk_add_f32 v[22:23], v[22:23], v[54:55]
v_pk_mul_f32 v[54:55], v[48:49], s[58:59] op_sel:[0,0] op_sel_hi:[0,1] neg_lo:[0,0] neg_hi:[0,0]
v_pk_fma_f32 v[54:55], v[48:49], s[58:59], v[54:55] op_sel:[1,1,0] op_sel_hi:[1,0,1] neg_lo:[0,1,0] neg_hi:[0,0,0]
v_pk_add_f32 v[48:49], v[24:25], v[56:57] neg_lo:[0,1] neg_hi:[0,1]
v_pk_add_f32 v[24:25], v[24:25], v[56:57]
v_pk_mul_f32 v[56:57], v[48:49], s[62:63] op_sel:[0,0] op_sel_hi:[0,1] neg_lo:[0,0] neg_hi:[0,0]
v_pk_fma_f32 v[56:57], v[48:49], s[62:63], v[56:57] op_sel:[1,1,0] op_sel_hi:[1,0,1] neg_lo:[0,1,0] neg_hi:[0,0,0]
v_pk_add_f32 v[48:49], v[26:27], v[58:59] neg_lo:[0,1] neg_hi:[0,1]
v_pk_add_f32 v[26:27], v[26:27], v[58:59]
v_pk_mul_f32 v[58:59], v[48:49], s[58:59] op_sel:[0,1] op_sel_hi:[0,0] neg_lo:[0,0] neg_hi:[0,0]
v_pk_fma_f32 v[58:59], v[48:49], s[58:59], v[58:59] op_sel:[1,0,0] op_sel_hi:[1,1,1] neg_lo:[0,1,0] neg_hi:[0,0,0]
v_pk_add_f32 v[48:49], v[28:29], v[60:61] neg_lo:[0,1] neg_hi:[0,1]
v_pk_add_f32 v[28:29], v[28:29], v[60:61]
v_pk_mul_f32 v[60:61], v[48:49], s[54:55] op_sel:[0,1] op_sel_hi:[0,0] neg_lo:[0,0] neg_hi:[0,0]
v_pk_fma_f32 v[60:61], v[48:49], s[54:55], v[60:61] op_sel:[1,0,0] op_sel_hi:[1,1,1] neg_lo:[0,1,0] neg_hi:[0,0,0]
v_pk_add_f32 v[48:49], v[30:31], v[62:63] neg_lo:[0,1] neg_hi:[0,1]
v_pk_add_f32 v[30:31], v[30:31], v[62:63]
v_pk_mul_f32 v[62:63], v[48:49], s[50:51] op_sel:[0,1] op_sel_hi:[0,0] neg_lo:[0,0] neg_hi:[0,0]
v_pk_fma_f32 v[62:63], v[48:49], s[50:51], v[62:63] op_sel:[1,0,0] op_sel_hi:[1,1,1] neg_lo:[0,1,0] neg_hi:[0,0,0]
v_pk_add_f32 v[48:49], v[32:33], v[64:65] op_sel:[1,1] op_sel_hi:[0,0] neg_lo:[1,0] neg_hi:[0,1]
v_pk_add_f32 v[32:33], v[32:33], v[64:65]
v_pk_add_f32 v[64:65], v[34:35], v[66:67] neg_lo:[0,1] neg_hi:[0,1]
v_pk_add_f32 v[34:35], v[34:35], v[66:67]
v_pk_mul_f32 v[66:67], v[64:65], s[50:51] op_sel:[0,1] op_sel_hi:[0,0] neg_lo:[0,1] neg_hi:[0,0]
v_pk_fma_f32 v[66:67], v[64:65], s[50:51], v[66:67] op_sel:[1,0,0] op_sel_hi:[1,1,1] neg_lo:[0,1,0] neg_hi:[0,1,0]
v_pk_add_f32 v[64:65], v[36:37], v[68:69] neg_lo:[0,1] neg_hi:[0,1]
v_pk_add_f32 v[36:37], v[36:37], v[68:69]
v_pk_mul_f32 v[68:69], v[64:65], s[54:55] op_sel:[0,1] op_sel_hi:[0,0] neg_lo:[0,1] neg_hi:[0,0]
v_pk_fma_f32 v[68:69], v[64:65], s[54:55], v[68:69] op_sel:[1,0,0] op_sel_hi:[1,1,1] neg_lo:[0,1,0] neg_hi:[0,1,0]
v_pk_add_f32 v[64:65], v[38:39], v[70:71] neg_lo:[0,1] neg_hi:[0,1]
v_pk_add_f32 v[38:39], v[38:39], v[70:71]
v_pk_mul_f32 v[70:71], v[64:65], s[58:59] op_sel:[0,1] op_sel_hi:[0,0] neg_lo:[0,1] neg_hi:[0,0]
v_pk_fma_f32 v[70:71], v[64:65], s[58:59], v[70:71] op_sel:[1,0,0] op_sel_hi:[1,1,1] neg_lo:[0,1,0] neg_hi:[0,1,0]
v_pk_add_f32 v[64:65], v[40:41], v[72:73] neg_lo:[0,1] neg_hi:[0,1]
v_pk_add_f32 v[40:41], v[40:41], v[72:73]
v_pk_mul_f32 v[72:73], v[64:65], s[62:63] op_sel:[0,0] op_sel_hi:[0,1] neg_lo:[0,1] neg_hi:[0,0]
v_pk_fma_f32 v[72:73], v[64:65], s[62:63], v[72:73] op_sel:[1,1,0] op_sel_hi:[1,0,1] neg_lo:[0,1,0] neg_hi:[0,1,0]
v_pk_add_f32 v[64:65], v[42:43], v[74:75] neg_lo:[0,1] neg_hi:[0,1]
v_pk_add_f32 v[42:43], v[42:43], v[74:75]
v_pk_mul_f32 v[74:75], v[64:65], s[58:59] op_sel:[0,0] op_sel_hi:[0,1] neg_lo:[0,1] neg_hi:[0,0]
v_pk_fma_f32 v[74:75], v[64:65], s[58:59], v[74:75] op_sel:[1,1,0] op_sel_hi:[1,0,1] neg_lo:[0,1,0] neg_hi:[0,1,0]
v_pk_add_f32 v[64:65], v[44:45], v[76:77] neg_lo:[0,1] neg_hi:[0,1]
v_pk_add_f32 v[44:45], v[44:45], v[76:77]
v_pk_mul_f32 v[76:77], v[64:65], s[54:55] op_sel:[0,0] op_sel_hi:[0,1] neg_lo:[0,1] neg_hi:[0,0]
v_pk_fma_f32 v[76:77], v[64:65], s[54:55], v[76:77] op_sel:[1,1,0] op_sel_hi:[1,0,1] neg_lo:[0,1,0] neg_hi:[0,1,0]
v_pk_add_f32 v[64:65], v[46:47], v[78:79] neg_lo:[0,1] neg_hi:[0,1]
v_pk_add_f32 v[46:47], v[46:47], v[78:79]
v_pk_mul_f32 v[78:79], v[64:65], s[50:51] op_sel:[0,0] op_sel_hi:[0,1] neg_lo:[0,1] neg_hi:[0,0]
v_pk_fma_f32 v[78:79], v[64:65], s[50:51], v[78:79] op_sel:[1,1,0] op_sel_hi:[1,0,1] neg_lo:[0,1,0] neg_hi:[0,1,0]
v_pk_add_f32 v[64:65], v[16:17], v[32:33] neg_lo:[0,1] neg_hi:[0,1]
v_pk_add_f32 v[16:17], v[16:17], v[32:33]
v_pk_add_f32 v[32:33], v[18:19], v[34:35] neg_lo:[0,1] neg_hi:[0,1]
v_pk_add_f32 v[18:19], v[18:19], v[34:35]
v_pk_mul_f32 v[34:35], v[32:33], s[54:55] op_sel:[0,0] op_sel_hi:[0,1] neg_lo:[0,0] neg_hi:[0,0]
v_pk_fma_f32 v[34:35], v[32:33], s[54:55], v[34:35] op_sel:[1,1,0] op_sel_hi:[1,0,1] neg_lo:[0,1,0] neg_hi:[0,0,0]
v_pk_add_f32 v[32:33], v[20:21], v[36:37] neg_lo:[0,1] neg_hi:[0,1]
v_pk_add_f32 v[20:21], v[20:21], v[36:37]
v_pk_mul_f32 v[36:37], v[32:33], s[62:63] op_sel:[0,0] op_sel_hi:[0,1] neg_lo:[0,0] neg_hi:[0,0]
v_pk_fma_f32 v[36:37], v[32:33], s[62:63], v[36:37] op_sel:[1,1,0] op_sel_hi:[1,0,1] neg_lo:[0,1,0] neg_hi:[0,0,0]
v_pk_add_f32 v[32:33], v[22:23], v[38:39] neg_lo:[0,1] neg_hi:[0,1]
v_pk_add_f32 v[22:23], v[22:23], v[38:39]
v_pk_mul_f32 v[38:39], v[32:33], s[54:55] op_sel:[0,1] op_sel_hi:[0,0] neg_lo:[0,0] neg_hi:[0,0]
v_pk_fma_f32 v[38:39], v[32:33], s[54:55], v[38:39] op_sel:[1,0,0] op_sel_hi:[1,1,1] neg_lo:[0,1,0] neg_hi:[0,0,0]
v_pk_add_f32 v[32:33], v[24:25], v[40:41] op_sel:[1,1] op_sel_hi:[0,0] neg_lo:[1,0] neg_hi:[0,1]
v_pk_add_f32 v[24:25], v[24:25], v[40:41]
v_pk_add_f32 v[40:41], v[26:27], v[42:43] neg_lo:[0,1] neg_hi:[0,1]
v_pk_add_f32 v[26:27], v[26:27], v[42:43]
v_pk_mul_f32 v[42:43], v[40:41], s[54:55] op_sel:[0,1] op_sel_hi:[0,0] neg_lo:[0,1] neg_hi:[0,0]
v_pk_fma_f32 v[42:43], v[40:41], s[54:55], v[42:43] op_sel:[1,0,0] op_sel_hi:[1,1,1] neg_lo:[0,1,0] neg_hi:[0,1,0]
v_pk_add_f32 v[40:41], v[28:29], v[44:45] neg_lo:[0,1] neg_hi:[0,1]
v_pk_add_f32 v[28:29], v[28:29], v[44:45]
v_pk_mul_f32 v[44:45], v[40:41], s[62:63] op_sel:[0,0] op_sel_hi:[0,1] neg_lo:[0,1] neg_hi:[0,0]
v_pk_fma_f32 v[44:45], v[40:41], s[62:63], v[44:45] op_sel:[1,1,0] op_sel_hi:[1,0,1] neg_lo:[0,1,0] neg_hi:[0,1,0]
v_pk_add_f32 v[40:41], v[30:31], v[46:47] neg_lo:[0,1] neg_hi:[0,1]
v_pk_add_f32 v[30:31], v[30:31], v[46:47]
v_pk_mul_f32 v[46:47], v[40:41], s[54:55] op_sel:[0,0] op_sel_hi:[0,1] neg_lo:[0,1] neg_hi:[0,0]
v_pk_fma_f32 v[46:47], v[40:41], s[54:55], v[46:47] op_sel:[1,1,0] op_sel_hi:[1,0,1] neg_lo:[0,1,0] neg_hi:[0,1,0]
v_pk_add_f32 v[40:41], v[14:15], v[48:49] neg_lo:[0,1] neg_hi:[0,1]
v_pk_add_f32 v[14:15], v[14:15], v[48:49]
v_pk_add_f32 v[48:49], v[50:51], v[66:67] neg_lo:[0,1] neg_hi:[0,1]
v_pk_add_f32 v[50:51], v[50:51], v[66:67]
v_pk_mul_f32 v[66:67], v[48:49], s[54:55] op_sel:[0,0] op_sel_hi:[0,1] neg_lo:[0,0] neg_hi:[0,0]
v_pk_fma_f32 v[66:67], v[48:49], s[54:55], v[66:67] op_sel:[1,1,0] op_sel_hi:[1,0,1] neg_lo:[0,1,0] neg_hi:[0,0,0]
v_pk_add_f32 v[48:49], v[52:53], v[68:69] neg_lo:[0,1] neg_hi:[0,1]
v_pk_add_f32 v[52:53], v[52:53], v[68:69]
v_pk_mul_f32 v[68:69], v[48:49], s[62:63] op_sel:[0,0] op_sel_hi:[0,1] neg_lo:[0,0] neg_hi:[0,0]
v_pk_fma_f32 v[68:69], v[48:49], s[62:63], v[68:69] op_sel:[1,1,0] op_sel_hi:[1,0,1] neg_lo:[0,1,0] neg_hi:[0,0,0]
v_pk_add_f32 v[48:49], v[54:55], v[70:71] neg_lo:[0,1] neg_hi:[0,1]
v_pk_add_f32 v[54:55], v[54:55], v[70:71]
v_pk_mul_f32 v[70:71], v[48:49], s[54:55] op_sel:[0,1] op_sel_hi:[0,0] neg_lo:[0,0] neg_hi:[0,0]
v_pk_fma_f32 v[70:71], v[48:49], s[54:55], v[70:71] op_sel:[1,0,0] op_sel_hi:[1,1,1] neg_lo:[0,1,0] neg_hi:[0,0,0]
v_pk_add_f32 v[48:49], v[56:57], v[72:73] op_sel:[1,1] op_sel_hi:[0,0] neg_lo:[1,0] neg_hi:[0,1]
v_pk_add_f32 v[56:57], v[56:57], v[72:73]
v_pk_add_f32 v[72:73], v[58:59], v[74:75] neg_lo:[0,1] neg_hi:[0,1]
v_pk_add_f32 v[58:59], v[58:59], v[74:75]
v_pk_mul_f32 v[74:75], v[72:73], s[54:55] op_sel:[0,1] op_sel_hi:[0,0] neg_lo:[0,1] neg_hi:[0,0]
v_pk_fma_f32 v[74:75], v[72:73], s[54:55], v[74:75] op_sel:[1,0,0] op_sel_hi:[1,1,1] neg_lo:[0,1,0] neg_hi:[0,1,0]
v_pk_add_f32 v[72:73], v[60:61], v[76:77] neg_lo:[0,1] neg_hi:[0,1]
v_pk_add_f32 v[60:61], v[60:61], v[76:77]
v_pk_mul_f32 v[76:77], v[72:73], s[62:63] op_sel:[0,0] op_sel_hi:[0,1] neg_lo:[0,1] neg_hi:[0,0]
v_pk_fma_f32 v[76:77], v[72:73], s[62:63], v[76:77] op_sel:[1,1,0] op_sel_hi:[1,0,1] neg_lo:[0,1,0] neg_hi:[0,1,0]
v_pk_add_f32 v[72:73], v[62:63], v[78:79] neg_lo:[0,1] neg_hi:[0,1]
v_pk_add_f32 v[62:63], v[62:63], v[78:79]
v_pk_mul_f32 v[78:79], v[72:73], s[54:55] op_sel:[0,0] op_sel_hi:[0,1] neg_lo:[0,1] neg_hi:[0,0]
v_pk_fma_f32 v[78:79], v[72:73], s[54:55], v[78:79] op_sel:[1,1,0] op_sel_hi:[1,0,1] neg_lo:[0,1,0] neg_hi:[0,1,0]
v_pk_add_f32 v[72:73], v[16:17], v[24:25] neg_lo:[0,1] neg_hi:[0,1]
v_pk_add_f32 v[16:17], v[16:17], v[24:25]
v_pk_add_f32 v[24:25], v[18:19], v[26:27] neg_lo:[0,1] neg_hi:[0,1]
v_pk_add_f32 v[18:19], v[18:19], v[26:27]
v_pk_mul_f32 v[26:27], v[24:25], s[62:63] op_sel:[0,0] op_sel_hi:[0,1] neg_lo:[0,0] neg_hi:[0,0]
v_pk_fma_f32 v[26:27], v[24:25], s[62:63], v[26:27] op_sel:[1,1,0] op_sel_hi:[1,0,1] neg_lo:[0,1,0] neg_hi:[0,0,0]
v_pk_add_f32 v[24:25], v[20:21], v[28:29] op_sel:[1,1] op_sel_hi:[0,0] neg_lo:[1,0] neg_hi:[0,1]
v_pk_add_f32 v[20:21], v[20:21], v[28:29]
v_pk_add_f32 v[28:29], v[22:23], v[30:31] neg_lo:[0,1] neg_hi:[0,1]
v_pk_add_f32 v[22:23], v[22:23], v[30:31]
v_pk_mul_f32 v[30:31], v[28:29], s[62:63] op_sel:[0,0] op_sel_hi:[0,1] neg_lo:[0,1] neg_hi:[0,0]
v_pk_fma_f32 v[30:31], v[28:29], s[62:63], v[30:31] op_sel:[1,1,0] op_sel_hi:[1,0,1] neg_lo:[0,1,0] neg_hi:[0,1,0]
v_pk_add_f32 v[28:29], v[64:65], v[32:33] neg_lo:[0,1] neg_hi:[0,1]
v_pk_add_f32 v[64:65], v[64:65], v[32:33]
v_pk_add_f32 v[32:33], v[34:35], v[42:43] neg_lo:[0,1] neg_hi:[0,1]
v_pk_add_f32 v[34:35], v[34:35], v[42:43]
v_pk_mul_f32 v[42:43], v[32:33], s[62:63] op_sel:[0,0] op_sel_hi:[0,1] neg_lo:[0,0] neg_hi:[0,0]
v_pk_fma_f32 v[42:43], v[32:33], s[62:63], v[42:43] op_sel:[1,1,0] op_sel_hi:[1,0,1] neg_lo:[0,1,0] neg_hi:[0,0,0]
v_pk_add_f32 v[32:33], v[36:37], v[44:45] op_sel:[1,1] op_sel_hi:[0,0] neg_lo:[1,0] neg_hi:[0,1]
v_pk_add_f32 v[36:37], v[36:37], v[44:45]
v_pk_add_f32 v[44:45], v[38:39], v[46:47] neg_lo:[0,1] neg_hi:[0,1]
v_pk_add_f32 v[38:39], v[38:39], v[46:47]
v_pk_mul_f32 v[46:47], v[44:45], s[62:63] op_sel:[0,0] op_sel_hi:[0,1] neg_lo:[0,1] neg_hi:[0,0]
v_pk_fma_f32 v[46:47], v[44:45], s[62:63], v[46:47] op_sel:[1,1,0] op_sel_hi:[1,0,1] neg_lo:[0,1,0] neg_hi:[0,1,0]
v_pk_add_f32 v[44:45], v[14:15], v[56:57] neg_lo:[0,1] neg_hi:[0,1]
v_pk_add_f32 v[14:15], v[14:15], v[56:57]
v_pk_add_f32 v[56:57], v[50:51], v[58:59] neg_lo:[0,1] neg_hi:[0,1]
v_pk_add_f32 v[50:51], v[50:51], v[58:59]
v_pk_mul_f32 v[58:59], v[56:57], s[62:63] op_sel:[0,0] op_sel_hi:[0,1] neg_lo:[0,0] neg_hi:[0,0]
v_pk_fma_f32 v[58:59], v[56:57], s[62:63], v[58:59] op_sel:[1,1,0] op_sel_hi:[1,0,1] neg_lo:[0,1,0] neg_hi:[0,0,0]
v_pk_add_f32 v[56:57], v[52:53], v[60:61] op_sel:[1,1] op_sel_hi:[0,0] neg_lo:[1,0] neg_hi:[0,1]
v_pk_add_f32 v[52:53], v[52:53], v[60:61]
v_pk_add_f32 v[60:61], v[54:55], v[62:63] neg_lo:[0,1] neg_hi:[0,1]
v_pk_add_f32 v[54:55], v[54:55], v[62:63]
v_pk_mul_f32 v[62:63], v[60:61], s[62:63] op_sel:[0,0] op_sel_hi:[0,1] neg_lo:[0,1] neg_hi:[0,0]
v_pk_fma_f32 v[62:63], v[60:61], s[62:63], v[62:63] op_sel:[1,1,0] op_sel_hi:[1,0,1] neg_lo:[0,1,0] neg_hi:[0,1,0]
v_pk_add_f32 v[60:61], v[40:41], v[48:49] neg_lo:[0,1] neg_hi:[0,1]
v_pk_add_f32 v[40:41], v[40:41], v[48:49]
v_pk_add_f32 v[48:49], v[66:67], v[74:75] neg_lo:[0,1] neg_hi:[0,1]
v_pk_add_f32 v[66:67], v[66:67], v[74:75]
v_pk_mul_f32 v[74:75], v[48:49], s[62:63] op_sel:[0,0] op_sel_hi:[0,1] neg_lo:[0,0] neg_hi:[0,0]
v_pk_fma_f32 v[74:75], v[48:49], s[62:63], v[74:75] op_sel:[1,1,0] op_sel_hi:[1,0,1] neg_lo:[0,1,0] neg_hi:[0,0,0]
v_pk_add_f32 v[48:49], v[68:69], v[76:77] op_sel:[1,1] op_sel_hi:[0,0] neg_lo:[1,0] neg_hi:[0,1]
v_pk_add_f32 v[68:69], v[68:69], v[76:77]
v_pk_add_f32 v[76:77], v[70:71], v[78:79] neg_lo:[0,1] neg_hi:[0,1]
v_pk_add_f32 v[70:71], v[70:71], v[78:79]
v_pk_mul_f32 v[78:79], v[76:77], s[62:63] op_sel:[0,0] op_sel_hi:[0,1] neg_lo:[0,1] neg_hi:[0,0]
v_pk_fma_f32 v[78:79], v[76:77], s[62:63], v[78:79] op_sel:[1,1,0] op_sel_hi:[1,0,1] neg_lo:[0,1,0] neg_hi:[0,1,0]
v_pk_add_f32 v[76:77], v[16:17], v[20:21] neg_lo:[0,1] neg_hi:[0,1]
v_pk_add_f32 v[16:17], v[16:17], v[20:21]
v_pk_add_f32 v[20:21], v[18:19], v[22:23] op_sel:[1,1] op_sel_hi:[0,0] neg_lo:[1,0] neg_hi:[0,1]
v_pk_add_f32 v[18:19], v[18:19], v[22:23]
v_pk_add_f32 v[22:23], v[72:73], v[24:25] neg_lo:[0,1] neg_hi:[0,1]
v_pk_add_f32 v[72:73], v[72:73], v[24:25]
v_pk_add_f32 v[24:25], v[26:27], v[30:31] op_sel:[1,1] op_sel_hi:[0,0] neg_lo:[1,0] neg_hi:[0,1]
v_pk_add_f32 v[26:27], v[26:27], v[30:31]
v_pk_add_f32 v[30:31], v[64:65], v[36:37] neg_lo:[0,1] neg_hi:[0,1]
v_pk_add_f32 v[64:65], v[64:65], v[36:37]
v_pk_add_f32 v[36:37], v[34:35], v[38:39] op_sel:[1,1] op_sel_hi:[0,0] neg_lo:[1,0] neg_hi:[0,1]
v_pk_add_f32 v[34:35], v[34:35], v[38:39]
v_pk_add_f32 v[38:39], v[28:29], v[32:33] neg_lo:[0,1] neg_hi:[0,1]
v_pk_add_f32 v[28:29], v[28:29], v[32:33]
v_pk_add_f32 v[32:33], v[42:43], v[46:47] op_sel:[1,1] op_sel_hi:[0,0] neg_lo:[1,0] neg_hi:[0,1]
v_pk_add_f32 v[42:43], v[42:43], v[46:47]
v_pk_add_f32 v[46:47], v[14:15], v[52:53] neg_lo:[0,1] neg_hi:[0,1]
v_pk_add_f32 v[14:15], v[14:15], v[52:53]
v_pk_add_f32 v[52:53], v[50:51], v[54:55] op_sel:[1,1] op_sel_hi:[0,0] neg_lo:[1,0] neg_hi:[0,1]
v_pk_add_f32 v[50:51], v[50:51], v[54:55]
v_pk_add_f32 v[54:55], v[44:45], v[56:57] neg_lo:[0,1] neg_hi:[0,1]
v_pk_add_f32 v[44:45], v[44:45], v[56:57]
v_pk_add_f32 v[56:57], v[58:59], v[62:63] op_sel:[1,1] op_sel_hi:[0,0] neg_lo:[1,0] neg_hi:[0,1]
v_pk_add_f32 v[58:59], v[58:59], v[62:63]
v_pk_add_f32 v[62:63], v[40:41], v[68:69] neg_lo:[0,1] neg_hi:[0,1]
v_pk_add_f32 v[40:41], v[40:41], v[68:69]
v_pk_add_f32 v[68:69], v[66:67], v[70:71] op_sel:[1,1] op_sel_hi:[0,0] neg_lo:[1,0] neg_hi:[0,1]
v_pk_add_f32 v[66:67], v[66:67], v[70:71]
v_pk_add_f32 v[70:71], v[60:61], v[48:49] neg_lo:[0,1] neg_hi:[0,1]
v_pk_add_f32 v[60:61], v[60:61], v[48:49]
v_pk_add_f32 v[48:49], v[74:75], v[78:79] op_sel:[1,1] op_sel_hi:[0,0] neg_lo:[1,0] neg_hi:[0,1]
v_pk_add_f32 v[74:75], v[74:75], v[78:79]
v_pk_add_f32 v[78:79], v[16:17], v[18:19] neg_lo:[0,1] neg_hi:[0,1]
v_pk_add_f32 v[16:17], v[16:17], v[18:19]
v_pk_add_f32 v[18:19], v[76:77], v[20:21] neg_lo:[0,1] neg_hi:[0,1]
v_pk_add_f32 v[76:77], v[76:77], v[20:21]
v_pk_add_f32 v[20:21], v[72:73], v[26:27] neg_lo:[0,1] neg_hi:[0,1]
v_pk_add_f32 v[72:73], v[72:73], v[26:27]
v_pk_add_f32 v[26:27], v[22:23], v[24:25] neg_lo:[0,1] neg_hi:[0,1]
v_pk_add_f32 v[22:23], v[22:23], v[24:25]
v_pk_add_f32 v[24:25], v[64:65], v[34:35] neg_lo:[0,1] neg_hi:[0,1]
v_pk_add_f32 v[64:65], v[64:65], v[34:35]
v_pk_add_f32 v[34:35], v[30:31], v[36:37] neg_lo:[0,1] neg_hi:[0,1]
v_pk_add_f32 v[30:31], v[30:31], v[36:37]
v_pk_add_f32 v[36:37], v[28:29], v[42:43] neg_lo:[0,1] neg_hi:[0,1]
v_pk_add_f32 v[28:29], v[28:29], v[42:43]
v_pk_add_f32 v[42:43], v[38:39], v[32:33] neg_lo:[0,1] neg_hi:[0,1]
v_pk_add_f32 v[38:39], v[38:39], v[32:33]
v_pk_add_f32 v[32:33], v[14:15], v[50:51] neg_lo:[0,1] neg_hi:[0,1]
v_pk_add_f32 v[14:15], v[14:15], v[50:51]
v_pk_add_f32 v[50:51], v[46:47], v[52:53] neg_lo:[0,1] neg_hi:[0,1]
v_pk_add_f32 v[46:47], v[46:47], v[52:53]
v_pk_add_f32 v[52:53], v[44:45], v[58:59] neg_lo:[0,1] neg_hi:[0,1]
v_pk_add_f32 v[44:45], v[44:45], v[58:59]
v_pk_add_f32 v[58:59], v[54:55], v[56:57] neg_lo:[0,1] neg_hi:[0,1]
v_pk_add_f32 v[54:55], v[54:55], v[56:57]
v_pk_add_f32 v[56:57], v[40:41], v[66:67] neg_lo:[0,1] neg_hi:[0,1]
v_pk_add_f32 v[40:41], v[40:41], v[66:67]
v_pk_add_f32 v[66:67], v[62:63], v[68:69] neg_lo:[0,1] neg_hi:[0,1]
v_pk_add_f32 v[62:63], v[62:63], v[68:69]
v_pk_add_f32 v[68:69], v[60:61], v[74:75] neg_lo:[0,1] neg_hi:[0,1]
v_pk_add_f32 v[60:61], v[60:61], v[74:75]
v_pk_add_f32 v[74:75], v[70:71], v[48:49] neg_lo:[0,1] neg_hi:[0,1]
v_pk_add_f32 v[70:71], v[70:71], v[48:49]
s_lshl_b32 s12, s38, 2
s_add_u32 s12, s12, s16
s_min_u32 s12, s12, 512
s_mul_i32 s12, s12, 16384
s_add_u32 s12, s12, 109051904
buffer_store_dwordx2 v[16:17], v5, s[84:87], s12 offen offset:0 sc1
buffer_store_dwordx2 v[14:15], v5, s[84:87], s12 offen offset:512 sc1
buffer_store_dwordx2 v[64:65], v5, s[84:87], s12 offen offset:1024 sc1
buffer_store_dwordx2 v[40:41], v5, s[84:87], s12 offen offset:1536 sc1
buffer_store_dwordx2 v[72:73], v5, s[84:87], s12 offen offset:2048 sc1
buffer_store_dwordx2 v[44:45], v5, s[84:87], s12 offen offset:2560 sc1
buffer_store_dwordx2 v[28:29], v5, s[84:87], s12 offen offset:3072 sc1
buffer_store_dwordx2 v[60:61], v5, s[84:87], s12 offen offset:3584 sc1
s_add_u32 s12, s12, 4096
buffer_store_dwordx2 v[76:77], v5, s[84:87], s12 offen offset:0 sc1
buffer_store_dwordx2 v[46:47], v5, s[84:87], s12 offen offset:512 sc1
buffer_store_dwordx2 v[30:31], v5, s[84:87], s12 offen offset:1024 sc1
buffer_store_dwordx2 v[62:63], v5, s[84:87], s12 offen offset:1536 sc1
buffer_store_dwordx2 v[22:23], v5, s[84:87], s12 offen offset:2048 sc1
buffer_store_dwordx2 v[54:55], v5, s[84:87], s12 offen offset:2560 sc1
buffer_store_dwordx2 v[38:39], v5, s[84:87], s12 offen offset:3072 sc1
buffer_store_dwordx2 v[70:71], v5, s[84:87], s12 offen offset:3584 sc1
s_add_u32 s12, s12, 4096
buffer_store_dwordx2 v[78:79], v5, s[84:87], s12 offen offset:0 sc1
buffer_store_dwordx2 v[32:33], v5, s[84:87], s12 offen offset:512 sc1
buffer_store_dwordx2 v[24:25], v5, s[84:87], s12 offen offset:1024 sc1
buffer_store_dwordx2 v[56:57], v5, s[84:87], s12 offen offset:1536 sc1
buffer_store_dwordx2 v[20:21], v5, s[84:87], s12 offen offset:2048 sc1
buffer_store_dwordx2 v[52:53], v5, s[84:87], s12 offen offset:2560 sc1
buffer_store_dwordx2 v[36:37], v5, s[84:87], s12 offen offset:3072 sc1
buffer_store_dwordx2 v[68:69], v5, s[84:87], s12 offen offset:3584 sc1
s_add_u32 s12, s12, 4096
buffer_store_dwordx2 v[18:19], v5, s[84:87], s12 offen offset:0 sc1
buffer_store_dwordx2 v[50:51], v5, s[84:87], s12 offen offset:512 sc1
buffer_store_dwordx2 v[34:35], v5, s[84:87], s12 offen offset:1024 sc1
buffer_store_dwordx2 v[66:67], v5, s[84:87], s12 offen offset:1536 sc1
buffer_store_dwordx2 v[26:27], v5, s[84:87], s12 offen offset:2048 sc1
buffer_store_dwordx2 v[58:59], v5, s[84:87], s12 offen offset:2560 sc1
buffer_store_dwordx2 v[42:43], v5, s[84:87], s12 offen offset:3072 sc1
buffer_store_dwordx2 v[74:75], v5, s[84:87], s12 offen offset:3584 sc1
s_add_u32 s12, s12, 4096
s_mov_b32 s38, s21
s_cmp_lt_u32 s38, s37
s_cbranch_scc1 mega_kernel_f2_l
mega_kernel_f2_e:
mega_kernel_f2e:
s_waitcnt vmcnt(0)
s_barrier
v_mov_b32 v1, 0
v_mov_b32 v2, 1
s_mov_b32 s82, 69259392
v_cmp_eq_u32 vcc, 0, v0
s_and_saveexec_b64 s[80:81], vcc
s_cbranch_execz mega_kernel_sg1
buffer_atomic_add v2, v1, s[84:87], s82 offen sc1
mega_kernel_sg1:
s_mov_b64 exec, s[80:81]
s_mov_b32 s64, 0
s_mov_b32 s65, 58
s_lshl_b32 s66, s40, 13
s_add_u32 s66, s66, 67633152
s_mov_b32 s67, 0
s_mov_b32 s68, 0
s_cmp_eq_u32 s91, 3
s_cbranch_scc1 mega_kernel_out
s_cmp_lt_u32 s92, 1
s_cbranch_scc1 mega_kernel_back
s_mov_b32 s68, 1
s_branch mega_kernel_out
mega_kernel_back:
s_lshl_b32 s68, s68, 1
s_mov_b32 s93, s92
s_load_dwordx2 s[4:5], s[0:1], 80
s_mov_b32 s48, 0x3f7ec46d
s_mov_b32 s49, 0x3dc8bd36
s_mov_b32 s50, 0x3f7b14be
s_mov_b32 s51, 0x3e47c5c2
s_mov_b32 s52, 0x3f74fa0b
s_mov_b32 s53, 0x3e94a031
s_mov_b32 s54, 0x3f6c835e
s_mov_b32 s55, 0x3ec3ef15
s_mov_b32 s56, 0x3f61c598
s_mov_b32 s57, 0x3ef15aea
s_mov_b32 s58, 0x3f54db31
s_mov_b32 s59, 0x3f0e39da
s_mov_b32 s60, 0x3f45e403
s_mov_b32 s61, 0x3f226799
s_mov_b32 s62, 0x3f3504f3
s_mov_b32 s63, 0x3f3504f3
v_and_b32 v1, 31, v0
v_lshrrev_b32 v2, 5, v0
v_cvt_f32_u32 v3, v1
v_mul_u32_u24 v10, 8448, v2
v_lshl_add_u32 v4, v1, 3, v10
v_mul_u32_u24 v5, 264, v1
v_add_u32 v5, v5, v10
v_and_b32 v11, 7, v0
v_lshrrev_b32 v9, 3, v0
v_mul_u32_u24 v10, 8448, v11
v_lshl_add_u32 v6, v9, 3, v10
v_lshlrev_b32 v7, 3, v9
v_sub_u32 v7, v10, v7
v_add_u32 v7, 4096, v7
v_mul_u32_u24 v8, 16384, v9
v_lshl_add_u32 v8, v11, 4, v8
v_mul_f32 v12, 0x3a800000, v3
v_cos_f32 v82, v12
v_sin_f32 v83, v12
v_mul_f32 v12, 0x3b000000, v3
v_cos_f32 v84, v12
v_sin_f32 v85, v12
v_mul_f32 v12, 0x3b400000, v3
v_cos_f32 v86, v12
v_sin_f32 v87, v12
v_mul_f32 v12, 0x3b800000, v3
v_cos_f32 v88, v12
v_sin_f32 v89, v12
v_mul_f32 v12, 0x3ba00000, v3
v_cos_f32 v90, v12
v_sin_f32 v91, v12
v_mul_f32 v12, 0x3bc00000, v3
v_cos_f32 v92, v12
v_sin_f32 v93, v12
v_mul_f32 v12, 0x3be00000, v3
v_cos_f32 v94, v12
v_sin_f32 v95, v12
v_mul_f32 v12, 0x3c000000, v3
v_cos_f32 v96, v12
v_sin_f32 v97, v12
v_mul_f32 v12, 0x3c100000, v3
v_cos_f32 v98, v12
v_sin_f32 v99, v12
v_mul_f32 v12, 0x3c200000, v3
v_cos_f32 v100, v12
v_sin_f32 v101, v12
v_mul_f32 v12, 0x3c300000, v3
v_cos_f32 v102, v12
v_sin_f32 v103, v12
v_mul_f32 v12, 0x3c400000, v3
v_cos_f32 v104, v12
v_sin_f32 v105, v12
v_mul_f32 v12, 0x3c500000, v3
v_cos_f32 v106, v12
v_sin_f32 v107, v12
v_mul_f32 v12, 0x3c600000, v3
v_cos_f32 v108, v12
v_sin_f32 v109, v12
v_mul_f32 v12, 0x3c700000, v3
v_cos_f32 v110, v12
v_sin_f32 v111, v12
v_mul_f32 v12, 0x3c800000, v3
v_cos_f32 v112, v12
v_sin_f32 v113, v12
v_mul_f32 v12, 0x3c880000, v3
v_cos_f32 v114, v12
v_sin_f32 v115, v12
v_mul_f32 v12, 0x3c900000, v3
v_cos_f32 v116, v12
v_sin_f32 v117, v12
v_mul_f32 v12, 0x3c980000, v3
v_cos_f32 v118, v12
v_sin_f32 v119, v12
v_mul_f32 v12, 0x3ca00000, v3
v_cos_f32 v120, v12
v_sin_f32 v121, v12
v_mul_f32 v12, 0x3ca80000, v3
v_cos_f32 v122, v12
v_sin_f32 v123, v12
v_mul_f32 v12, 0x3cb00000, v3
v_cos_f32 v124, v12
v_sin_f32 v125, v12
v_mul_f32 v12, 0x3cb80000, v3
v_cos_f32 v126, v12
v_sin_f32 v127, v12
v_mul_f32 v12, 0x3cc00000, v3
v_cos_f32 v128, v12
v_sin_f32 v129, v12
v_mul_f32 v12, 0x3cc80000, v3
v_cos_f32 v130, v12
v_sin_f32 v131, v12
v_mul_f32 v12, 0x3cd00000, v3
v_cos_f32 v132, v12
v_sin_f32 v133, v12
v_mul_f32 v12, 0x3cd80000, v3
v_cos_f32 v134, v12
v_sin_f32 v135, v12
v_mul_f32 v12, 0x3ce00000, v3
v_cos_f32 v136, v12
v_sin_f32 v137, v12
v_mul_f32 v12, 0x3ce80000, v3
v_cos_f32 v138, v12
v_sin_f32 v139, v12
v_mul_f32 v12, 0x3cf00000, v3
v_cos_f32 v140, v12
v_sin_f32 v141, v12
v_mul_f32 v12, 0x3cf80000, v3
v_cos_f32 v142, v12
v_sin_f32 v143, v12
v_lshlrev_b32 v12, 2, v1
v_sub_u32 v12, v4, v12
v_and_b32 v10, 127, v0
v_lshrrev_b32 v11, 7, v0
v_lshlrev_b32 v2, 5, v10
v_lshl_add_u32 v2, v11, 12, v2
v_lshlrev_b32 v3, 4, v10
v_lshl_add_u32 v3, v11, 12, v3
v_add_u32 v3, 2048, v3
v_cmp_eq_u32 s[14:15], 0, v9
s_waitcnt lgkmcnt(0)
s_mov_b32 s6, 8388608
s_mov_b32 s7, 0x00020000
v_mov_b32 v250, 0
s_mov_b32 s82, 69259392
mega_kernel_w1:
s_sleep 8
buffer_load_dword v251, v250, s[84:87], s82 offen sc1
s_waitcnt vmcnt(0)
v_cmp_ne_u32 vcc, 95, v251
s_cbranch_vccnz mega_kernel_w1
s_cmp_lt_u32 s93, 128
s_cbranch_scc0 mega_kernel_f3_e
s_lshl_b32 s12, s93, 7
s_add_u32 s12, s12, 109051904
buffer_load_dwordx4 v[144:147], v8, s[84:87], s12 offen sc1
s_add_u32 s12, s12, 524288
buffer_load_dwordx4 v[148:151], v8, s[84:87], s12 offen sc1
s_add_u32 s12, s12, 524288
buffer_load_dwordx4 v[152:155], v8, s[84:87], s12 offen sc1
s_add_u32 s12, s12, 524288
buffer_load_dwordx4 v[156:159], v8, s[84:87], s12 offen sc1
s_add_u32 s12, s12, 524288
buffer_load_dwordx4 v[160:163], v8, s[84:87], s12 offen sc1
s_add_u32 s12, s12, 524288
buffer_load_dwordx4 v[164:167], v8, s[84:87], s12 offen sc1
s_add_u32 s12, s12, 524288
buffer_load_dwordx4 v[168:171], v8, s[84:87], s12 offen sc1
s_add_u32 s12, s12, 524288
buffer_load_dwordx4 v[172:175], v8, s[84:87], s12 offen sc1
s_add_u32 s12, s12, 524288
buffer_load_dwordx4 v[176:179], v8, s[84:87], s12 offen sc1
s_add_u32 s12, s12, 524288
buffer_load_dwordx4 v[180:183], v8, s[84:87], s12 offen sc1
s_add_u32 s12, s12, 524288
buffer_load_dwordx4 v[184:187], v8, s[84:87], s12 offen sc1
s_add_u32 s12, s12, 524288
buffer_load_dwordx4 v[188:191], v8, s[84:87], s12 offen sc1
s_add_u32 s12, s12, 524288
buffer_load_dwordx4 v[192:195], v8, s[84:87], s12 offen sc1
s_add_u32 s12, s12, 524288
buffer_load_dwordx4 v[196:199], v8, s[84:87], s12 offen sc1
s_add_u32 s12, s12, 524288
buffer_load_dwordx4 v[200:203], v8, s[84:87], s12 offen sc1
s_add_u32 s12, s12, 524288
buffer_load_dwordx4 v[204:207], v8, s[84:87], s12 offen sc1
s_add_u32 s12, s12, 524288
buffer_load_dwordx4 v[208:211], v8, s[84:87], s12 offen sc1
s_add_u32 s12, s12, 524288
s_waitcnt vmcnt(0)
mega_kernel_f3_l:
s_add_u32 s21, s93, 64
s_cmp_lt_u32 s21, 128
s_cselect_b32 s22, s21, s93
s_waitcnt vmcnt(8)
s_barrier
v_cndmask_b32 v145, v145, 0, s[14:15]
v_cndmask_b32 v147, v147, 0, s[14:15]
v_cndmask_b32 v209, v209, 0, s[14:15]
v_cndmask_b32 v211, v211, 0, s[14:15]
v_pk_add_f32 v[16:17], v[144:145], v[146:147] op_sel:[0,1] op_sel_hi:[1,0] neg_lo:[0,1]
v_pk_add_f32 v[18:19], v[144:145], v[146:147] op_sel:[0,1] op_sel_hi:[1,0] neg_hi:[1,0]
ds_write_b64 v6, v[16:17] offset:0
ds_write_b64 v7, v[18:19] offset:4096
v_pk_add_f32 v[20:21], v[148:149], v[150:151] op_sel:[0,1] op_sel_hi:[1,0] neg_lo:[0,1]
v_pk_add_f32 v[22:23], v[148:149], v[150:151] op_sel:[0,1] op_sel_hi:[1,0] neg_hi:[1,0]
ds_write_b64 v6, v[20:21] offset:256
ds_write_b64 v7, v[22:23] offset:3840
v_pk_add_f32 v[24:25], v[152:153], v[154:155] op_sel:[0,1] op_sel_hi:[1,0] neg_lo:[0,1]
v_pk_add_f32 v[26:27], v[152:153], v[154:155] op_sel:[0,1] op_sel_hi:[1,0] neg_hi:[1,0]
ds_write_b64 v6, v[24:25] offset:512
ds_write_b64 v7, v[26:27] offset:3584
v_pk_add_f32 v[28:29], v[156:157], v[158:159] op_sel:[0,1] op_sel_hi:[1,0] neg_lo:[0,1]
v_pk_add_f32 v[30:31], v[156:157], v[158:159] op_sel:[0,1] op_sel_hi:[1,0] neg_hi:[1,0]
ds_write_b64 v6, v[28:29] offset:768
ds_write_b64 v7, v[30:31] offset:3328
v_pk_add_f32 v[32:33], v[160:161], v[162:163] op_sel:[0,1] op_sel_hi:[1,0] neg_lo:[0,1]
v_pk_add_f32 v[34:35], v[160:161], v[162:163] op_sel:[0,1] op_sel_hi:[1,0] neg_hi:[1,0]
ds_write_b64 v6, v[32:33] offset:1024
ds_write_b64 v7, v[34:35] offset:3072
v_pk_add_f32 v[36:37], v[164:165], v[166:167] op_sel:[0,1] op_sel_hi:[1,0] neg_lo:[0,1]
v_pk_add_f32 v[38:39], v[164:165], v[166:167] op_sel:[0,1] op_sel_hi:[1,0] neg_hi:[1,0]
ds_write_b64 v6, v[36:37] offset:1280
ds_write_b64 v7, v[38:39] offset:2816
v_pk_add_f32 v[40:41], v[168:169], v[170:171] op_sel:[0,1] op_sel_hi:[1,0] neg_lo:[0,1]
v_pk_add_f32 v[42:43], v[168:169], v[170:171] op_sel:[0,1] op_sel_hi:[1,0] neg_hi:[1,0]
ds_write_b64 v6, v[40:41] offset:1536
ds_write_b64 v7, v[42:43] offset:2560
v_pk_add_f32 v[44:45], v[172:173], v[174:175] op_sel:[0,1] op_sel_hi:[1,0] neg_lo:[0,1]
v_pk_add_f32 v[46:47], v[172:173], v[174:175] op_sel:[0,1] op_sel_hi:[1,0] neg_hi:[1,0]
ds_write_b64 v6, v[44:45] offset:1792
ds_write_b64 v7, v[46:47] offset:2304
v_pk_add_f32 v[48:49], v[176:177], v[178:179] op_sel:[0,1] op_sel_hi:[1,0] neg_lo:[0,1]
v_pk_add_f32 v[50:51], v[176:177], v[178:179] op_sel:[0,1] op_sel_hi:[1,0] neg_hi:[1,0]
ds_write_b64 v6, v[48:49] offset:2048
ds_write_b64 v7, v[50:51] offset:2048
v_pk_add_f32 v[52:53], v[180:181], v[182:183] op_sel:[0,1] op_sel_hi:[1,0] neg_lo:[0,1]
v_pk_add_f32 v[54:55], v[180:181], v[182:183] op_sel:[0,1] op_sel_hi:[1,0] neg_hi:[1,0]
ds_write_b64 v6, v[52:53] offset:2304
ds_write_b64 v7, v[54:55] offset:1792
v_pk_add_f32 v[56:57], v[184:185], v[186:187] op_sel:[0,1] op_sel_hi:[1,0] neg_lo:[0,1]
v_pk_add_f32 v[58:59], v[184:185], v[186:187] op_sel:[0,1] op_sel_hi:[1,0] neg_hi:[1,0]
ds_write_b64 v6, v[56:57] offset:2560
ds_write_b64 v7, v[58:59] offset:1536
v_pk_add_f32 v[60:61], v[188:189], v[190:191] op_sel:[0,1] op_sel_hi:[1,0] neg_lo:[0,1]
v_pk_add_f32 v[62:63], v[188:189], v[190:191] op_sel:[0,1] op_sel_hi:[1,0] neg_hi:[1,0]
ds_write_b64 v6, v[60:61] offset:2816
ds_write_b64 v7, v[62:63] offset:1280
v_pk_add_f32 v[64:65], v[192:193], v[194:195] op_sel:[0,1] op_sel_hi:[1,0] neg_lo:[0,1]
v_pk_add_f32 v[66:67], v[192:193], v[194:195] op_sel:[0,1] op_sel_hi:[1,0] neg_hi:[1,0]
ds_write_b64 v6, v[64:65] offset:3072
ds_write_b64 v7, v[66:67] offset:1024
v_pk_add_f32 v[68:69], v[196:197], v[198:199] op_sel:[0,1] op_sel_hi:[1,0] neg_lo:[0,1]
v_pk_add_f32 v[70:71], v[196:197], v[198:199] op_sel:[0,1] op_sel_hi:[1,0] neg_hi:[1,0]
ds_write_b64 v6, v[68:69] offset:3328
ds_write_b64 v7, v[70:71] offset:768
v_pk_add_f32 v[72:73], v[200:201], v[202:203] op_sel:[0,1] op_sel_hi:[1,0] neg_lo:[0,1]
v_pk_add_f32 v[74:75], v[200:201], v[202:203] op_sel:[0,1] op_sel_hi:[1,0] neg_hi:[1,0]
ds_write_b64 v6, v[72:73] offset:3584
ds_write_b64 v7, v[74:75] offset:512
s_waitcnt lgkmcnt(8)
v_pk_add_f32 v[76:77], v[204:205], v[206:207] op_sel:[0,1] op_sel_hi:[1,0] neg_lo:[0,1]
v_pk_add_f32 v[78:79], v[204:205], v[206:207] op_sel:[0,1] op_sel_hi:[1,0] neg_hi:[1,0]
ds_write_b64 v6, v[76:77] offset:3840
ds_write_b64 v7, v[78:79] offset:256
v_pk_add_f32 v[16:17], v[208:209], v[210:211] op_sel:[0,1] op_sel_hi:[1,0] neg_lo:[0,1]
v_pk_add_f32 v[18:19], v[208:209], v[210:211] op_sel:[0,1] op_sel_hi:[1,0] neg_hi:[1,0]
s_mov_b64 exec, s[14:15]
ds_write_b64 v6, v[16:17] offset:4096
s_mov_b64 exec, -1
s_lshl_b32 s12, s22, 7
s_add_u32 s12, s12, 109051904
buffer_load_dwordx4 v[144:147], v8, s[84:87], s12 offen sc1
s_add_u32 s12, s12, 524288
buffer_load_dwordx4 v[148:151], v8, s[84:87], s12 offen sc1
s_add_u32 s12, s12, 524288
buffer_load_dwordx4 v[152:155], v8, s[84:87], s12 offen sc1
s_add_u32 s12, s12, 524288
buffer_load_dwordx4 v[156:159], v8, s[84:87], s12 offen sc1
s_add_u32 s12, s12, 524288
buffer_load_dwordx4 v[160:163], v8, s[84:87], s12 offen sc1
s_add_u32 s12, s12, 524288
buffer_load_dwordx4 v[164:167], v8, s[84:87], s12 offen sc1
s_add_u32 s12, s12, 524288
buffer_load_dwordx4 v[168:171], v8, s[84:87], s12 offen sc1
s_add_u32 s12, s12, 524288
buffer_load_dwordx4 v[172:175], v8, s[84:87], s12 offen sc1
s_add_u32 s12, s12, 524288
buffer_load_dwordx4 v[176:179], v8, s[84:87], s12 offen sc1
s_add_u32 s12, s12, 524288
buffer_load_dwordx4 v[180:183], v8, s[84:87], s12 offen sc1
s_add_u32 s12, s12, 524288
buffer_load_dwordx4 v[184:187], v8, s[84:87], s12 offen sc1
s_add_u32 s12, s12, 524288
buffer_load_dwordx4 v[188:191], v8, s[84:87], s12 offen sc1
s_add_u32 s12, s12, 524288
buffer_load_dwordx4 v[192:195], v8, s[84:87], s12 offen sc1
s_add_u32 s12, s12, 524288
buffer_load_dwordx4 v[196:199], v8, s[84:87], s12 offen sc1
s_add_u32 s12, s12, 524288
buffer_load_dwordx4 v[200:203], v8, s[84:87], s12 offen sc1
s_add_u32 s12, s12, 524288
buffer_load_dwordx4 v[204:207], v8, s[84:87], s12 offen sc1
s_add_u32 s12, s12, 524288
buffer_load_dwordx4 v[208:211], v8, s[84:87], s12 offen sc1
s_add_u32 s12, s12, 524288
s_waitcnt lgkmcnt(0)
s_barrier
ds_read_b64 v[16:17], v4 offset:0
ds_read_b64 v[48:49], v4 offset:4096
ds_read_b64 v[18:19], v4 offset:256
ds_read_b64 v[50:51], v4 offset:4352
ds_read_b64 v[20:21], v4 offset:512
ds_read_b64 v[52:53], v4 offset:4608
ds_read_b64 v[22:23], v4 offset:768
ds_read_b64 v[54:55], v4 offset:4864
ds_read_b64 v[24:25], v4 offset:1024
ds_read_b64 v[56:57], v4 offset:5120
ds_read_b64 v[26:27], v4 offset:1280
ds_read_b64 v[58:59], v4 offset:5376
ds_read_b64 v[28:29], v4 offset:1536
ds_read_b64 v[60:61], v4 offset:5632
ds_read_b64 v[30:31], v4 offset:1792
ds_read_b64 v[62:63], v4 offset:5888
ds_read_b64 v[32:33], v4 offset:2048
ds_read_b64 v[64:65], v4 offset:6144
ds_read_b64 v[34:35], v4 offset:2304
ds_read_b64 v[66:67], v4 offset:6400
ds_read_b64 v[36:37], v4 offset:2560
ds_read_b64 v[68:69], v4 offset:6656
ds_read_b64 v[38:39], v4 offset:2816
ds_read_b64 v[70:71], v4 offset:6912
ds_read_b64 v[40:41], v4 offset:3072
ds_read_b64 v[72:73], v4 offset:7168
ds_read_b64 v[42:43], v4 offset:3328
ds_read_b64 v[74:75], v4 offset:7424
ds_read_b64 v[44:45], v4 offset:3584
ds_read_b64 v[76:77], v4 offset:7680
ds_read_b64 v[46:47], v4 offset:3840
ds_read_b64 v[78:79], v4 offset:7936
s_waitcnt lgkmcnt(0)
v_pk_add_f32 v[14:15], v[16:17], v[48:49] neg_lo:[0,1] neg_hi:[0,1]
v_pk_add_f32 v[16:17], v[16:17], v[48:49]
v_pk_add_f32 v[48:49], v[18:19], v[50:51] neg_lo:[0,1] neg_hi:[0,1]
v_pk_add_f32 v[18:19], v[18:19], v[50:51]
v_pk_mul_f32 v[50:51], v[48:49], s[50:51] op_sel:[0,0] op_sel_hi:[0,1] neg_lo:[0,0] neg_hi:[0,0]
v_pk_fma_f32 v[50:51], v[48:49], s[50:51], v[50:51] op_sel:[1,1,0] op_sel_hi:[1,0,1] neg_lo:[0,1,0] neg_hi:[0,0,0]
v_pk_add_f32 v[48:49], v[20:21], v[52:53] neg_lo:[0,1] neg_hi:[0,1]
v_pk_add_f32 v[20:21], v[20:21], v[52:53]
v_pk_mul_f32 v[52:53], v[48:49], s[54:55] op_sel:[0,0] op_sel_hi:[0,1] neg_lo:[0,0] neg_hi:[0,0]
v_pk_fma_f32 v[52:53], v[48:49], s[54:55], v[52:53] op_sel:[1,1,0] op_sel_hi:[1,0,1] neg_lo:[0,1,0] neg_hi:[0,0,0]
v_pk_add_f32 v[48:49], v[22:23], v[54:55] neg_lo:[0,1] neg_hi:[0,1]
v_pk_add_f32 v[22:23], v[22:23], v[54:55]
v_pk_mul_f32 v[54:55], v[48:49], s[58:59] op_sel:[0,0] op_sel_hi:[0,1] neg_lo:[0,0] neg_hi:[0,0]
v_pk_fma_f32 v[54:55], v[48:49], s[58:59], v[54:55] op_sel:[1,1,0] op_sel_hi:[1,0,1] neg_lo:[0,1,0] neg_hi:[0,0,0]
v_pk_add_f32 v[48:49], v[24:25], v[56:57] neg_lo:[0,1] neg_hi:[0,1]
v_pk_add_f32 v[24:25], v[24:25], v[56:57]
v_pk_mul_f32 v[56:57], v[48:49], s[62:63] op_sel:[0,0] op_sel_hi:[0,1] neg_lo:[0,0] neg_hi:[0,0]
v_pk_fma_f32 v[56:57], v[48:49], s[62:63], v[56:57] op_sel:[1,1,0] op_sel_hi:[1,0,1] neg_lo:[0,1,0] neg_hi:[0,0,0]
v_pk_add_f32 v[48:49], v[26:27], v[58:59] neg_lo:[0,1] neg_hi:[0,1]
v_pk_add_f32 v[26:27], v[26:27], v[58:59]
v_pk_mul_f32 v[58:59], v[48:49], s[58:59] op_sel:[0,1] op_sel_hi:[0,0] neg_lo:[0,0] neg_hi:[0,0]
v_pk_fma_f32 v[58:59], v[48:49], s[58:59], v[58:59] op_sel:[1,0,0] op_sel_hi:[1,1,1] neg_lo:[0,1,0] neg_hi:[0,0,0]
v_pk_add_f32 v[48:49], v[28:29], v[60:61] neg_lo:[0,1] neg_hi:[0,1]
v_pk_add_f32 v[28:29], v[28:29], v[60:61]
v_pk_mul_f32 v[60:61], v[48:49], s[54:55] op_sel:[0,1] op_sel_hi:[0,0] neg_lo:[0,0] neg_hi:[0,0]
v_pk_fma_f32 v[60:61], v[48:49], s[54:55], v[60:61] op_sel:[1,0,0] op_sel_hi:[1,1,1] neg_lo:[0,1,0] neg_hi:[0,0,0]
v_pk_add_f32 v[48:49], v[30:31], v[62:63] neg_lo:[0,1] neg_hi:[0,1]
v_pk_add_f32 v[30:31], v[30:31], v[62:63]
v_pk_mul_f32 v[62:63], v[48:49], s[50:51] op_sel:[0,1] op_sel_hi:[0,0] neg_lo:[0,0] neg_hi:[0,0]
v_pk_fma_f32 v[62:63], v[48:49], s[50:51], v[62:63] op_sel:[1,0,0] op_sel_hi:[1,1,1] neg_lo:[0,1,0] neg_hi:[0,0,0]
v_pk_add_f32 v[48:49], v[32:33], v[64:65] op_sel:[1,1] op_sel_hi:[0,0] neg_lo:[1,0] neg_hi:[0,1]
v_pk_add_f32 v[32:33], v[32:33], v[64:65]
v_pk_add_f32 v[64:65], v[34:35], v[66:67] neg_lo:[0,1] neg_hi:[0,1]
v_pk_add_f32 v[34:35], v[34:35], v[66:67]
v_pk_mul_f32 v[66:67], v[64:65], s[50:51] op_sel:[0,1] op_sel_hi:[0,0] neg_lo:[0,1] neg_hi:[0,0]
v_pk_fma_f32 v[66:67], v[64:65], s[50:51], v[66:67] op_sel:[1,0,0] op_sel_hi:[1,1,1] neg_lo:[0,1,0] neg_hi:[0,1,0]
v_pk_add_f32 v[64:65], v[36:37], v[68:69] neg_lo:[0,1] neg_hi:[0,1]
v_pk_add_f32 v[36:37], v[36:37], v[68:69]
v_pk_mul_f32 v[68:69], v[64:65], s[54:55] op_sel:[0,1] op_sel_hi:[0,0] neg_lo:[0,1] neg_hi:[0,0]
v_pk_fma_f32 v[68:69], v[64:65], s[54:55], v[68:69] op_sel:[1,0,0] op_sel_hi:[1,1,1] neg_lo:[0,1,0] neg_hi:[0,1,0]
v_pk_add_f32 v[64:65], v[38:39], v[70:71] neg_lo:[0,1] neg_hi:[0,1]
v_pk_add_f32 v[38:39], v[38:39], v[70:71]
v_pk_mul_f32 v[70:71], v[64:65], s[58:59] op_sel:[0,1] op_sel_hi:[0,0] neg_lo:[0,1] neg_hi:[0,0]
v_pk_fma_f32 v[70:71], v[64:65], s[58:59], v[70:71] op_sel:[1,0,0] op_sel_hi:[1,1,1] neg_lo:[0,1,0] neg_hi:[0,1,0]
v_pk_add_f32 v[64:65], v[40:41], v[72:73] neg_lo:[0,1] neg_hi:[0,1]
v_pk_add_f32 v[40:41], v[40:41], v[72:73]
v_pk_mul_f32 v[72:73], v[64:65], s[62:63] op_sel:[0,0] op_sel_hi:[0,1] neg_lo:[0,1] neg_hi:[0,0]
v_pk_fma_f32 v[72:73], v[64:65], s[62:63], v[72:73] op_sel:[1,1,0] op_sel_hi:[1,0,1] neg_lo:[0,1,0] neg_hi:[0,1,0]
v_pk_add_f32 v[64:65], v[42:43], v[74:75] neg_lo:[0,1] neg_hi:[0,1]
v_pk_add_f32 v[42:43], v[42:43], v[74:75]
v_pk_mul_f32 v[74:75], v[64:65], s[58:59] op_sel:[0,0] op_sel_hi:[0,1] neg_lo:[0,1] neg_hi:[0,0]
v_pk_fma_f32 v[74:75], v[64:65], s[58:59], v[74:75] op_sel:[1,1,0] op_sel_hi:[1,0,1] neg_lo:[0,1,0] neg_hi:[0,1,0]
v_pk_add_f32 v[64:65], v[44:45], v[76:77] neg_lo:[0,1] neg_hi:[0,1]
v_pk_add_f32 v[44:45], v[44:45], v[76:77]
v_pk_mul_f32 v[76:77], v[64:65], s[54:55] op_sel:[0,0] op_sel_hi:[0,1] neg_lo:[0,1] neg_hi:[0,0]
v_pk_fma_f32 v[76:77], v[64:65], s[54:55], v[76:77] op_sel:[1,1,0] op_sel_hi:[1,0,1] neg_lo:[0,1,0] neg_hi:[0,1,0]
v_pk_add_f32 v[64:65], v[46:47], v[78:79] neg_lo:[0,1] neg_hi:[0,1]
v_pk_add_f32 v[46:47], v[46:47], v[78:79]
v_pk_mul_f32 v[78:79], v[64:65], s[50:51] op_sel:[0,0] op_sel_hi:[0,1] neg_lo:[0,1] neg_hi:[0,0]
v_pk_fma_f32 v[78:79], v[64:65], s[50:51], v[78:79] op_sel:[1,1,0] op_sel_hi:[1,0,1] neg_lo:[0,1,0] neg_hi:[0,1,0]
v_pk_add_f32 v[64:65], v[16:17], v[32:33] neg_lo:[0,1] neg_hi:[0,1]
v_pk_add_f32 v[16:17], v[16:17], v[32:33]
v_pk_add_f32 v[32:33], v[18:19], v[34:35] neg_lo:[0,1] neg_hi:[0,1]
v_pk_add_f32 v[18:19], v[18:19], v[34:35]
v_pk_mul_f32 v[34:35], v[32:33], s[54:55] op_sel:[0,0] op_sel_hi:[0,1] neg_lo:[0,0] neg_hi:[0,0]
v_pk_fma_f32 v[34:35], v[32:33], s[54:55], v[34:35] op_sel:[1,1,0] op_sel_hi:[1,0,1] neg_lo:[0,1,0] neg_hi:[0,0,0]
v_pk_add_f32 v[32:33], v[20:21], v[36:37] neg_lo:[0,1] neg_hi:[0,1]
v_pk_add_f32 v[20:21], v[20:21], v[36:37]
v_pk_mul_f32 v[36:37], v[32:33], s[62:63] op_sel:[0,0] op_sel_hi:[0,1] neg_lo:[0,0] neg_hi:[0,0]
v_pk_fma_f32 v[36:37], v[32:33], s[62:63], v[36:37] op_sel:[1,1,0] op_sel_hi:[1,0,1] neg_lo:[0,1,0] neg_hi:[0,0,0]
v_pk_add_f32 v[32:33], v[22:23], v[38:39] neg_lo:[0,1] neg_hi:[0,1]
v_pk_add_f32 v[22:23], v[22:23], v[38:39]
v_pk_mul_f32 v[38:39], v[32:33], s[54:55] op_sel:[0,1] op_sel_hi:[0,0] neg_lo:[0,0] neg_hi:[0,0]
v_pk_fma_f32 v[38:39], v[32:33], s[54:55], v[38:39] op_sel:[1,0,0] op_sel_hi:[1,1,1] neg_lo:[0,1,0] neg_hi:[0,0,0]
v_pk_add_f32 v[32:33], v[24:25], v[40:41] op_sel:[1,1] op_sel_hi:[0,0] neg_lo:[1,0] neg_hi:[0,1]
v_pk_add_f32 v[24:25], v[24:25], v[40:41]
v_pk_add_f32 v[40:41], v[26:27], v[42:43] neg_lo:[0,1] neg_hi:[0,1]
v_pk_add_f32 v[26:27], v[26:27], v[42:43]
v_pk_mul_f32 v[42:43], v[40:41], s[54:55] op_sel:[0,1] op_sel_hi:[0,0] neg_lo:[0,1] neg_hi:[0,0]
v_pk_fma_f32 v[42:43], v[40:41], s[54:55], v[42:43] op_sel:[1,0,0] op_sel_hi:[1,1,1] neg_lo:[0,1,0] neg_hi:[0,1,0]
v_pk_add_f32 v[40:41], v[28:29], v[44:45] neg_lo:[0,1] neg_hi:[0,1]
v_pk_add_f32 v[28:29], v[28:29], v[44:45]
v_pk_mul_f32 v[44:45], v[40:41], s[62:63] op_sel:[0,0] op_sel_hi:[0,1] neg_lo:[0,1] neg_hi:[0,0]
v_pk_fma_f32 v[44:45], v[40:41], s[62:63], v[44:45] op_sel:[1,1,0] op_sel_hi:[1,0,1] neg_lo:[0,1,0] neg_hi:[0,1,0]
v_pk_add_f32 v[40:41], v[30:31], v[46:47] neg_lo:[0,1] neg_hi:[0,1]
v_pk_add_f32 v[30:31], v[30:31], v[46:47]
v_pk_mul_f32 v[46:47], v[40:41], s[54:55] op_sel:[0,0] op_sel_hi:[0,1] neg_lo:[0,1] neg_hi:[0,0]
v_pk_fma_f32 v[46:47], v[40:41], s[54:55], v[46:47] op_sel:[1,1,0] op_sel_hi:[1,0,1] neg_lo:[0,1,0] neg_hi:[0,1,0]
v_pk_add_f32 v[40:41], v[14:15], v[48:49] neg_lo:[0,1] neg_hi:[0,1]
v_pk_add_f32 v[14:15], v[14:15], v[48:49]
v_pk_add_f32 v[48:49], v[50:51], v[66:67] neg_lo:[0,1] neg_hi:[0,1]
v_pk_add_f32 v[50:51], v[50:51], v[66:67]
v_pk_mul_f32 v[66:67], v[48:49], s[54:55] op_sel:[0,0] op_sel_hi:[0,1] neg_lo:[0,0] neg_hi:[0,0]
v_pk_fma_f32 v[66:67], v[48:49], s[54:55], v[66:67] op_sel:[1,1,0] op_sel_hi:[1,0,1] neg_lo:[0,1,0] neg_hi:[0,0,0]
v_pk_add_f32 v[48:49], v[52:53], v[68:69] neg_lo:[0,1] neg_hi:[0,1]
v_pk_add_f32 v[52:53], v[52:53], v[68:69]
v_pk_mul_f32 v[68:69], v[48:49], s[62:63] op_sel:[0,0] op_sel_hi:[0,1] neg_lo:[0,0] neg_hi:[0,0]
v_pk_fma_f32 v[68:69], v[48:49], s[62:63], v[68:69] op_sel:[1,1,0] op_sel_hi:[1,0,1] neg_lo:[0,1,0] neg_hi:[0,0,0]
v_pk_add_f32 v[48:49], v[54:55], v[70:71] neg_lo:[0,1] neg_hi:[0,1]
v_pk_add_f32 v[54:55], v[54:55], v[70:71]
v_pk_mul_f32 v[70:71], v[48:49], s[54:55] op_sel:[0,1] op_sel_hi:[0,0] neg_lo:[0,0] neg_hi:[0,0]
v_pk_fma_f32 v[70:71], v[48:49], s[54:55], v[70:71] op_sel:[1,0,0] op_sel_hi:[1,1,1] neg_lo:[0,1,0] neg_hi:[0,0,0]
v_pk_add_f32 v[48:49], v[56:57], v[72:73] op_sel:[1,1] op_sel_hi:[0,0] neg_lo:[1,0] neg_hi:[0,1]
v_pk_add_f32 v[56:57], v[56:57], v[72:73]
v_pk_add_f32 v[72:73], v[58:59], v[74:75] neg_lo:[0,1] neg_hi:[0,1]
v_pk_add_f32 v[58:59], v[58:59], v[74:75]
v_pk_mul_f32 v[74:75], v[72:73], s[54:55] op_sel:[0,1] op_sel_hi:[0,0] neg_lo:[0,1] neg_hi:[0,0]
v_pk_fma_f32 v[74:75], v[72:73], s[54:55], v[74:75] op_sel:[1,0,0] op_sel_hi:[1,1,1] neg_lo:[0,1,0] neg_hi:[0,1,0]
v_pk_add_f32 v[72:73], v[60:61], v[76:77] neg_lo:[0,1] neg_hi:[0,1]
v_pk_add_f32 v[60:61], v[60:61], v[76:77]
v_pk_mul_f32 v[76:77], v[72:73], s[62:63] op_sel:[0,0] op_sel_hi:[0,1] neg_lo:[0,1] neg_hi:[0,0]
v_pk_fma_f32 v[76:77], v[72:73], s[62:63], v[76:77] op_sel:[1,1,0] op_sel_hi:[1,0,1] neg_lo:[0,1,0] neg_hi:[0,1,0]
v_pk_add_f32 v[72:73], v[62:63], v[78:79] neg_lo:[0,1] neg_hi:[0,1]
v_pk_add_f32 v[62:63], v[62:63], v[78:79]
v_pk_mul_f32 v[78:79], v[72:73], s[54:55] op_sel:[0,0] op_sel_hi:[0,1] neg_lo:[0,1] neg_hi:[0,0]
v_pk_fma_f32 v[78:79], v[72:73], s[54:55], v[78:79] op_sel:[1,1,0] op_sel_hi:[1,0,1] neg_lo:[0,1,0] neg_hi:[0,1,0]
v_pk_add_f32 v[72:73], v[16:17], v[24:25] neg_lo:[0,1] neg_hi:[0,1]
v_pk_add_f32 v[16:17], v[16:17], v[24:25]
v_pk_add_f32 v[24:25], v[18:19], v[26:27] neg_lo:[0,1] neg_hi:[0,1]
v_pk_add_f32 v[18:19], v[18:19], v[26:27]
v_pk_mul_f32 v[26:27], v[24:25], s[62:63] op_sel:[0,0] op_sel_hi:[0,1] neg_lo:[0,0] neg_hi:[0,0]
v_pk_fma_f32 v[26:27], v[24:25], s[62:63], v[26:27] op_sel:[1,1,0] op_sel_hi:[1,0,1] neg_lo:[0,1,0] neg_hi:[0,0,0]
v_pk_add_f32 v[24:25], v[20:21], v[28:29] op_sel:[1,1] op_sel_hi:[0,0] neg_lo:[1,0] neg_hi:[0,1]
v_pk_add_f32 v[20:21], v[20:21], v[28:29]
v_pk_add_f32 v[28:29], v[22:23], v[30:31] neg_lo:[0,1] neg_hi:[0,1]
v_pk_add_f32 v[22:23], v[22:23], v[30:31]
v_pk_mul_f32 v[30:31], v[28:29], s[62:63] op_sel:[0,0] op_sel_hi:[0,1] neg_lo:[0,1] neg_hi:[0,0]
v_pk_fma_f32 v[30:31], v[28:29], s[62:63], v[30:31] op_sel:[1,1,0] op_sel_hi:[1,0,1] neg_lo:[0,1,0] neg_hi:[0,1,0]
v_pk_add_f32 v[28:29], v[64:65], v[32:33] neg_lo:[0,1] neg_hi:[0,1]
v_pk_add_f32 v[64:65], v[64:65], v[32:33]
v_pk_add_f32 v[32:33], v[34:35], v[42:43] neg_lo:[0,1] neg_hi:[0,1]
v_pk_add_f32 v[34:35], v[34:35], v[42:43]
v_pk_mul_f32 v[42:43], v[32:33], s[62:63] op_sel:[0,0] op_sel_hi:[0,1] neg_lo:[0,0] neg_hi:[0,0]
v_pk_fma_f32 v[42:43], v[32:33], s[62:63], v[42:43] op_sel:[1,1,0] op_sel_hi:[1,0,1] neg_lo:[0,1,0] neg_hi:[0,0,0]
v_pk_add_f32 v[32:33], v[36:37], v[44:45] op_sel:[1,1] op_sel_hi:[0,0] neg_lo:[1,0] neg_hi:[0,1]
v_pk_add_f32 v[36:37], v[36:37], v[44:45]
v_pk_add_f32 v[44:45], v[38:39], v[46:47] neg_lo:[0,1] neg_hi:[0,1]
v_pk_add_f32 v[38:39], v[38:39], v[46:47]
v_pk_mul_f32 v[46:47], v[44:45], s[62:63] op_sel:[0,0] op_sel_hi:[0,1] neg_lo:[0,1] neg_hi:[0,0]
v_pk_fma_f32 v[46:47], v[44:45], s[62:63], v[46:47] op_sel:[1,1,0] op_sel_hi:[1,0,1] neg_lo:[0,1,0] neg_hi:[0,1,0]
v_pk_add_f32 v[44:45], v[14:15], v[56:57] neg_lo:[0,1] neg_hi:[0,1]
v_pk_add_f32 v[14:15], v[14:15], v[56:57]
v_pk_add_f32 v[56:57], v[50:51], v[58:59] neg_lo:[0,1] neg_hi:[0,1]
v_pk_add_f32 v[50:51], v[50:51], v[58:59]
v_pk_mul_f32 v[58:59], v[56:57], s[62:63] op_sel:[0,0] op_sel_hi:[0,1] neg_lo:[0,0] neg_hi:[0,0]
v_pk_fma_f32 v[58:59], v[56:57], s[62:63], v[58:59] op_sel:[1,1,0] op_sel_hi:[1,0,1] neg_lo:[0,1,0] neg_hi:[0,0,0]
v_pk_add_f32 v[56:57], v[52:53], v[60:61] op_sel:[1,1] op_sel_hi:[0,0] neg_lo:[1,0] neg_hi:[0,1]
v_pk_add_f32 v[52:53], v[52:53], v[60:61]
v_pk_add_f32 v[60:61], v[54:55], v[62:63] neg_lo:[0,1] neg_hi:[0,1]
v_pk_add_f32 v[54:55], v[54:55], v[62:63]
v_pk_mul_f32 v[62:63], v[60:61], s[62:63] op_sel:[0,0] op_sel_hi:[0,1] neg_lo:[0,1] neg_hi:[0,0]
v_pk_fma_f32 v[62:63], v[60:61], s[62:63], v[62:63] op_sel:[1,1,0] op_sel_hi:[1,0,1] neg_lo:[0,1,0] neg_hi:[0,1,0]
v_pk_add_f32 v[60:61], v[40:41], v[48:49] neg_lo:[0,1] neg_hi:[0,1]
v_pk_add_f32 v[40:41], v[40:41], v[48:49]
v_pk_add_f32 v[48:49], v[66:67], v[74:75] neg_lo:[0,1] neg_hi:[0,1]
v_pk_add_f32 v[66:67], v[66:67], v[74:75]
v_pk_mul_f32 v[74:75], v[48:49], s[62:63] op_sel:[0,0] op_sel_hi:[0,1] neg_lo:[0,0] neg_hi:[0,0]
v_pk_fma_f32 v[74:75], v[48:49], s[62:63], v[74:75] op_sel:[1,1,0] op_sel_hi:[1,0,1] neg_lo:[0,1,0] neg_hi:[0,0,0]
v_pk_add_f32 v[48:49], v[68:69], v[76:77] op_sel:[1,1] op_sel_hi:[0,0] neg_lo:[1,0] neg_hi:[0,1]
v_pk_add_f32 v[68:69], v[68:69], v[76:77]
v_pk_add_f32 v[76:77], v[70:71], v[78:79] neg_lo:[0,1] neg_hi:[0,1]
v_pk_add_f32 v[70:71], v[70:71], v[78:79]
v_pk_mul_f32 v[78:79], v[76:77], s[62:63] op_sel:[0,0] op_sel_hi:[0,1] neg_lo:[0,1] neg_hi:[0,0]
v_pk_fma_f32 v[78:79], v[76:77], s[62:63], v[78:79] op_sel:[1,1,0] op_sel_hi:[1,0,1] neg_lo:[0,1,0] neg_hi:[0,1,0]
v_pk_add_f32 v[76:77], v[16:17], v[20:21] neg_lo:[0,1] neg_hi:[0,1]
v_pk_add_f32 v[16:17], v[16:17], v[20:21]
v_pk_add_f32 v[20:21], v[18:19], v[22:23] op_sel:[1,1] op_sel_hi:[0,0] neg_lo:[1,0] neg_hi:[0,1]
v_pk_add_f32 v[18:19], v[18:19], v[22:23]
v_pk_add_f32 v[22:23], v[72:73], v[24:25] neg_lo:[0,1] neg_hi:[0,1]
v_pk_add_f32 v[72:73], v[72:73], v[24:25]
v_pk_add_f32 v[24:25], v[26:27], v[30:31] op_sel:[1,1] op_sel_hi:[0,0] neg_lo:[1,0] neg_hi:[0,1]
v_pk_add_f32 v[26:27], v[26:27], v[30:31]
v_pk_add_f32 v[30:31], v[64:65], v[36:37] neg_lo:[0,1] neg_hi:[0,1]
v_pk_add_f32 v[64:65], v[64:65], v[36:37]
v_pk_add_f32 v[36:37], v[34:35], v[38:39] op_sel:[1,1] op_sel_hi:[0,0] neg_lo:[1,0] neg_hi:[0,1]
v_pk_add_f32 v[34:35], v[34:35], v[38:39]
v_pk_add_f32 v[38:39], v[28:29], v[32:33] neg_lo:[0,1] neg_hi:[0,1]
v_pk_add_f32 v[28:29], v[28:29], v[32:33]
v_pk_add_f32 v[32:33], v[42:43], v[46:47] op_sel:[1,1] op_sel_hi:[0,0] neg_lo:[1,0] neg_hi:[0,1]
v_pk_add_f32 v[42:43], v[42:43], v[46:47]
v_pk_add_f32 v[46:47], v[14:15], v[52:53] neg_lo:[0,1] neg_hi:[0,1]
v_pk_add_f32 v[14:15], v[14:15], v[52:53]
v_pk_add_f32 v[52:53], v[50:51], v[54:55] op_sel:[1,1] op_sel_hi:[0,0] neg_lo:[1,0] neg_hi:[0,1]
v_pk_add_f32 v[50:51], v[50:51], v[54:55]
v_pk_add_f32 v[54:55], v[44:45], v[56:57] neg_lo:[0,1] neg_hi:[0,1]
v_pk_add_f32 v[44:45], v[44:45], v[56:57]
v_pk_add_f32 v[56:57], v[58:59], v[62:63] op_sel:[1,1] op_sel_hi:[0,0] neg_lo:[1,0] neg_hi:[0,1]
v_pk_add_f32 v[58:59], v[58:59], v[62:63]
v_pk_add_f32 v[62:63], v[40:41], v[68:69] neg_lo:[0,1] neg_hi:[0,1]
v_pk_add_f32 v[40:41], v[40:41], v[68:69]
v_pk_add_f32 v[68:69], v[66:67], v[70:71] op_sel:[1,1] op_sel_hi:[0,0] neg_lo:[1,0] neg_hi:[0,1]
v_pk_add_f32 v[66:67], v[66:67], v[70:71]
v_pk_add_f32 v[70:71], v[60:61], v[48:49] neg_lo:[0,1] neg_hi:[0,1]
v_pk_add_f32 v[60:61], v[60:61], v[48:49]
v_pk_add_f32 v[48:49], v[74:75], v[78:79] op_sel:[1,1] op_sel_hi:[0,0] neg_lo:[1,0] neg_hi:[0,1]
v_pk_add_f32 v[74:75], v[74:75], v[78:79]
v_pk_add_f32 v[78:79], v[16:17], v[18:19] neg_lo:[0,1] neg_hi:[0,1]
v_pk_add_f32 v[16:17], v[16:17], v[18:19]
v_pk_add_f32 v[18:19], v[76:77], v[20:21] neg_lo:[0,1] neg_hi:[0,1]
v_pk_add_f32 v[76:77], v[76:77], v[20:21]
v_pk_add_f32 v[20:21], v[72:73], v[26:27] neg_lo:[0,1] neg_hi:[0,1]
v_pk_add_f32 v[72:73], v[72:73], v[26:27]
v_pk_add_f32 v[26:27], v[22:23], v[24:25] neg_lo:[0,1] neg_hi:[0,1]
v_pk_add_f32 v[22:23], v[22:23], v[24:25]
v_pk_add_f32 v[24:25], v[64:65], v[34:35] neg_lo:[0,1] neg_hi:[0,1]
v_pk_add_f32 v[64:65], v[64:65], v[34:35]
v_pk_add_f32 v[34:35], v[30:31], v[36:37] neg_lo:[0,1] neg_hi:[0,1]
v_pk_add_f32 v[30:31], v[30:31], v[36:37]
v_pk_add_f32 v[36:37], v[28:29], v[42:43] neg_lo:[0,1] neg_hi:[0,1]
v_pk_add_f32 v[28:29], v[28:29], v[42:43]
v_pk_add_f32 v[42:43], v[38:39], v[32:33] neg_lo:[0,1] neg_hi:[0,1]
v_pk_add_f32 v[38:39], v[38:39], v[32:33]
v_pk_add_f32 v[32:33], v[14:15], v[50:51] neg_lo:[0,1] neg_hi:[0,1]
v_pk_add_f32 v[14:15], v[14:15], v[50:51]
v_pk_add_f32 v[50:51], v[46:47], v[52:53] neg_lo:[0,1] neg_hi:[0,1]
v_pk_add_f32 v[46:47], v[46:47], v[52:53]
v_pk_add_f32 v[52:53], v[44:45], v[58:59] neg_lo:[0,1] neg_hi:[0,1]
v_pk_add_f32 v[44:45], v[44:45], v[58:59]
v_pk_add_f32 v[58:59], v[54:55], v[56:57] neg_lo:[0,1] neg_hi:[0,1]
v_pk_add_f32 v[54:55], v[54:55], v[56:57]
v_pk_add_f32 v[56:57], v[40:41], v[66:67] neg_lo:[0,1] neg_hi:[0,1]
v_pk_add_f32 v[40:41], v[40:41], v[66:67]
v_pk_add_f32 v[66:67], v[62:63], v[68:69] neg_lo:[0,1] neg_hi:[0,1]
v_pk_add_f32 v[62:63], v[62:63], v[68:69]
v_pk_add_f32 v[68:69], v[60:61], v[74:75] neg_lo:[0,1] neg_hi:[0,1]
v_pk_add_f32 v[60:61], v[60:61], v[74:75]
v_pk_add_f32 v[74:75], v[70:71], v[48:49] neg_lo:[0,1] neg_hi:[0,1]
v_pk_add_f32 v[70:71], v[70:71], v[48:49]
v_pk_mul_f32 v[48:49], v[14:15], v[82:83] op_sel:[0,0] op_sel_hi:[0,1] neg_lo:[0,0] neg_hi:[0,0]
v_pk_fma_f32 v[14:15], v[14:15], v[82:83], v[48:49] op_sel:[1,1,0] op_sel_hi:[1,0,1] neg_lo:[0,1,0] neg_hi:[0,0,0]
v_pk_mul_f32 v[48:49], v[64:65], v[84:85] op_sel:[0,0] op_sel_hi:[0,1] neg_lo:[0,0] neg_hi:[0,0]
v_pk_fma_f32 v[64:65], v[64:65], v[84:85], v[48:49] op_sel:[1,1,0] op_sel_hi:[1,0,1] neg_lo:[0,1,0] neg_hi:[0,0,0]
v_pk_mul_f32 v[48:49], v[40:41], v[86:87] op_sel:[0,0] op_sel_hi:[0,1] neg_lo:[0,0] neg_hi:[0,0]
v_pk_fma_f32 v[40:41], v[40:41], v[86:87], v[48:49] op_sel:[1,1,0] op_sel_hi:[1,0,1] neg_lo:[0,1,0] neg_hi:[0,0,0]
v_pk_mul_f32 v[48:49], v[72:73], v[88:89] op_sel:[0,0] op_sel_hi:[0,1] neg_lo:[0,0] neg_hi:[0,0]
v_pk_fma_f32 v[72:73], v[72:73], v[88:89], v[48:49] op_sel:[1,1,0] op_sel_hi:[1,0,1] neg_lo:[0,1,0] neg_hi:[0,0,0]
v_pk_mul_f32 v[48:49], v[44:45], v[90:91] op_sel:[0,0] op_sel_hi:[0,1] neg_lo:[0,0] neg_hi:[0,0]
v_pk_fma_f32 v[44:45], v[44:45], v[90:91], v[48:49] op_sel:[1,1,0] op_sel_hi:[1,0,1] neg_lo:[0,1,0] neg_hi:[0,0,0]
v_pk_mul_f32 v[48:49], v[28:29], v[92:93] op_sel:[0,0] op_sel_hi:[0,1] neg_lo:[0,0] neg_hi:[0,0]
v_pk_fma_f32 v[28:29], v[28:29], v[92:93], v[48:49] op_sel:[1,1,0] op_sel_hi:[1,0,1] neg_lo:[0,1,0] neg_hi:[0,0,0]
v_pk_mul_f32 v[48:49], v[60:61], v[94:95] op_sel:[0,0] op_sel_hi:[0,1] neg_lo:[0,0] neg_hi:[0,0]
v_pk_fma_f32 v[60:61], v[60:61], v[94:95], v[48:49] op_sel:[1,1,0] op_sel_hi:[1,0,1] neg_lo:[0,1,0] neg_hi:[0,0,0]
v_pk_mul_f32 v[48:49], v[76:77], v[96:97] op_sel:[0,0] op_sel_hi:[0,1] neg_lo:[0,0] neg_hi:[0,0]
v_pk_fma_f32 v[76:77], v[76:77], v[96:97], v[48:49] op_sel:[1,1,0] op_sel_hi:[1,0,1] neg_lo:[0,1,0] neg_hi:[0,0,0]
v_pk_mul_f32 v[48:49], v[46:47], v[98:99] op_sel:[0,0] op_sel_hi:[0,1] neg_lo:[0,0] neg_hi:[0,0]
v_pk_fma_f32 v[46:47], v[46:47], v[98:99], v[48:49] op_sel:[1,1,0] op_sel_hi:[1,0,1] neg_lo:[0,1,0] neg_hi:[0,0,0]
v_pk_mul_f32 v[48:49], v[30:31], v[100:101] op_sel:[0,0] op_sel_hi:[0,1] neg_lo:[0,0] neg_hi:[0,0]
v_pk_fma_f32 v[30:31], v[30:31], v[100:101], v[48:49] op_sel:[1,1,0] op_sel_hi:[1,0,1] neg_lo:[0,1,0] neg_hi:[0,0,0]
v_pk_mul_f32 v[48:49], v[62:63], v[102:103] op_sel:[0,0] op_sel_hi:[0,1] neg_lo:[0,0] neg_hi:[0,0]
v_pk_fma_f32 v[62:63], v[62:63], v[102:103], v[48:49] op_sel:[1,1,0] op_sel_hi:[1,0,1] neg_lo:[0,1,0] neg_hi:[0,0,0]
v_pk_mul_f32 v[48:49], v[22:23], v[104:105] op_sel:[0,0] op_sel_hi:[0,1] neg_lo:[0,0] neg_hi:[0,0]
v_pk_fma_f32 v[22:23], v[22:23], v[104:105], v[48:49] op_sel:[1,1,0] op_sel_hi:[1,0,1] neg_lo:[0,1,0] neg_hi:[0,0,0]
v_pk_mul_f32 v[48:49], v[54:55], v[106:107] op_sel:[0,0] op_sel_hi:[0,1] neg_lo:[0,0] neg_hi:[0,0]
v_pk_fma_f32 v[54:55], v[54:55], v[106:107], v[48:49] op_sel:[1,1,0] op_sel_hi:[1,0,1] neg_lo:[0,1,0] neg_hi:[0,0,0]
v_pk_mul_f32 v[48:49], v[38:39], v[108:109] op_sel:[0,0] op_sel_hi:[0,1] neg_lo:[0,0] neg_hi:[0,0]
v_pk_fma_f32 v[38:39], v[38:39], v[108:109], v[48:49] op_sel:[1,1,0] op_sel_hi:[1,0,1] neg_lo:[0,1,0] neg_hi:[0,0,0]
v_pk_mul_f32 v[48:49], v[70:71], v[110:111] op_sel:[0,0] op_sel_hi:[0,1] neg_lo:[0,0] neg_hi:[0,0]
v_pk_fma_f32 v[70:71], v[70:71], v[110:111], v[48:49] op_sel:[1,1,0] op_sel_hi:[1,0,1] neg_lo:[0,1,0] neg_hi:[0,0,0]
v_pk_mul_f32 v[48:49], v[78:79], v[112:113] op_sel:[0,0] op_sel_hi:[0,1] neg_lo:[0,0] neg_hi:[0,0]
v_pk_fma_f32 v[78:79], v[78:79], v[112:113], v[48:49] op_sel:[1,1,0] op_sel_hi:[1,0,1] neg_lo:[0,1,0] neg_hi:[0,0,0]
v_pk_mul_f32 v[48:49], v[32:33], v[114:115] op_sel:[0,0] op_sel_hi:[0,1] neg_lo:[0,0] neg_hi:[0,0]
v_pk_fma_f32 v[32:33], v[32:33], v[114:115], v[48:49] op_sel:[1,1,0] op_sel_hi:[1,0,1] neg_lo:[0,1,0] neg_hi:[0,0,0]
v_pk_mul_f32 v[48:49], v[24:25], v[116:117] op_sel:[0,0] op_sel_hi:[0,1] neg_lo:[0,0] neg_hi:[0,0]
v_pk_fma_f32 v[24:25], v[24:25], v[116:117], v[48:49] op_sel:[1,1,0] op_sel_hi:[1,0,1] neg_lo:[0,1,0] neg_hi:[0,0,0]
v_pk_mul_f32 v[48:49], v[56:57], v[118:119] op_sel:[0,0] op_sel_hi:[0,1] neg_lo:[0,0] neg_hi:[0,0]
v_pk_fma_f32 v[56:57], v[56:57], v[118:119], v[48:49] op_sel:[1,1,0] op_sel_hi:[1,0,1] neg_lo:[0,1,0] neg_hi:[0,0,0]
v_pk_mul_f32 v[48:49], v[20:21], v[120:121] op_sel:[0,0] op_sel_hi:[0,1] neg_lo:[0,0] neg_hi:[0,0]
v_pk_fma_f32 v[20:21], v[20:21], v[120:121], v[48:49] op_sel:[1,1,0] op_sel_hi:[1,0,1] neg_lo:[0,1,0] neg_hi:[0,0,0]
v_pk_mul_f32 v[48:49], v[52:53], v[122:123] op_sel:[0,0] op_sel_hi:[0,1] neg_lo:[0,0] neg_hi:[0,0]
v_pk_fma_f32 v[52:53], v[52:53], v[122:123], v[48:49] op_sel:[1,1,0] op_sel_hi:[1,0,1] neg_lo:[0,1,0] neg_hi:[0,0,0]
v_pk_mul_f32 v[48:49], v[36:37], v[124:125] op_sel:[0,0] op_sel_hi:[0,1] neg_lo:[0,0] neg_hi:[0,0]
v_pk_fma_f32 v[36:37], v[36:37], v[124:125], v[48:49] op_sel:[1,1,0] op_sel_hi:[1,0,1] neg_lo:[0,1,0] neg_hi:[0,0,0]
v_pk_mul_f32 v[48:49], v[68:69], v[126:127] op_sel:[0,0] op_sel_hi:[0,1] neg_lo:[0,0] neg_hi:[0,0]
v_pk_fma_f32 v[68:69], v[68:69], v[126:127], v[48:49] op_sel:[1,1,0] op_sel_hi:[1,0,1] neg_lo:[0,1,0] neg_hi:[0,0,0]
v_pk_mul_f32 v[48:49], v[18:19], v[128:129] op_sel:[0,0] op_sel_hi:[0,1] neg_lo:[0,0] neg_hi:[0,0]
v_pk_fma_f32 v[18:19], v[18:19], v[128:129], v[48:49] op_sel:[1,1,0] op_sel_hi:[1,0,1] neg_lo:[0,1,0] neg_hi:[0,0,0]
v_pk_mul_f32 v[48:49], v[50:51], v[130:131] op_sel:[0,0] op_sel_hi:[0,1] neg_lo:[0,0] neg_hi:[0,0]
v_pk_fma_f32 v[50:51], v[50:51], v[130:131], v[48:49] op_sel:[1,1,0] op_sel_hi:[1,0,1] neg_lo:[0,1,0] neg_hi:[0,0,0]
v_pk_mul_f32 v[48:49], v[34:35], v[132:133] op_sel:[0,0] op_sel_hi:[0,1] neg_lo:[0,0] neg_hi:[0,0]
v_pk_fma_f32 v[34:35], v[34:35], v[132:133], v[48:49] op_sel:[1,1,0] op_sel_hi:[1,0,1] neg_lo:[0,1,0] neg_hi:[0,0,0]
v_pk_mul_f32 v[48:49], v[66:67], v[134:135] op_sel:[0,0] op_sel_hi:[0,1] neg_lo:[0,0] neg_hi:[0,0]
v_pk_fma_f32 v[66:67], v[66:67], v[134:135], v[48:49] op_sel:[1,1,0] op_sel_hi:[1,0,1] neg_lo:[0,1,0] neg_hi:[0,0,0]
v_pk_mul_f32 v[48:49], v[26:27], v[136:137] op_sel:[0,0] op_sel_hi:[0,1] neg_lo:[0,0] neg_hi:[0,0]
v_pk_fma_f32 v[26:27], v[26:27], v[136:137], v[48:49] op_sel:[1,1,0] op_sel_hi:[1,0,1] neg_lo:[0,1,0] neg_hi:[0,0,0]
v_pk_mul_f32 v[48:49], v[58:59], v[138:139] op_sel:[0,0] op_sel_hi:[0,1] neg_lo:[0,0] neg_hi:[0,0]
v_pk_fma_f32 v[58:59], v[58:59], v[138:139], v[48:49] op_sel:[1,1,0] op_sel_hi:[1,0,1] neg_lo:[0,1,0] neg_hi:[0,0,0]
v_pk_mul_f32 v[48:49], v[42:43], v[140:141] op_sel:[0,0] op_sel_hi:[0,1] neg_lo:[0,0] neg_hi:[0,0]
v_pk_fma_f32 v[42:43], v[42:43], v[140:141], v[48:49] op_sel:[1,1,0] op_sel_hi:[1,0,1] neg_lo:[0,1,0] neg_hi:[0,0,0]
v_pk_mul_f32 v[48:49], v[74:75], v[142:143] op_sel:[0,0] op_sel_hi:[0,1] neg_lo:[0,0] neg_hi:[0,0]
v_pk_fma_f32 v[74:75], v[74:75], v[142:143], v[48:49] op_sel:[1,1,0] op_sel_hi:[1,0,1] neg_lo:[0,1,0] neg_hi:[0,0,0]
ds_write_b64 v4, v[16:17] offset:0
ds_write_b64 v4, v[14:15] offset:264
ds_write_b64 v4, v[64:65] offset:528
ds_write_b64 v4, v[40:41] offset:792
ds_write_b64 v4, v[72:73] offset:1056
ds_write_b64 v4, v[44:45] offset:1320
ds_write_b64 v4, v[28:29] offset:1584
ds_write_b64 v4, v[60:61] offset:1848
ds_write_b64 v4, v[76:77] offset:2112
ds_write_b64 v4, v[46:47] offset:2376
ds_write_b64 v4, v[30:31] offset:2640
ds_write_b64 v4, v[62:63] offset:2904
ds_write_b64 v4, v[22:23] offset:3168
ds_write_b64 v4, v[54:55] offset:3432
ds_write_b64 v4, v[38:39] offset:3696
ds_write_b64 v4, v[70:71] offset:3960
ds_write_b64 v4, v[78:79] offset:4224
ds_write_b64 v4, v[32:33] offset:4488
ds_write_b64 v4, v[24:25] offset:4752
ds_write_b64 v4, v[56:57] offset:5016
ds_write_b64 v4, v[20:21] offset:5280
ds_write_b64 v4, v[52:53] offset:5544
ds_write_b64 v4, v[36:37] offset:5808
ds_write_b64 v4, v[68:69] offset:6072
ds_write_b64 v4, v[18:19] offset:6336
ds_write_b64 v4, v[50:51] offset:6600
ds_write_b64 v4, v[34:35] offset:6864
ds_write_b64 v4, v[66:67] offset:7128
ds_write_b64 v4, v[26:27] offset:7392
ds_write_b64 v4, v[58:59] offset:7656
ds_write_b64 v4, v[42:43] offset:7920
ds_write_b64 v4, v[74:75] offset:8184
s_waitcnt lgkmcnt(0)
ds_read_b64 v[16:17], v5 offset:0
ds_read_b64 v[48:49], v5 offset:128
ds_read_b64 v[18:19], v5 offset:8
ds_read_b64 v[50:51], v5 offset:136
ds_read_b64 v[20:21], v5 offset:16
ds_read_b64 v[52:53], v5 offset:144
ds_read_b64 v[22:23], v5 offset:24
ds_read_b64 v[54:55], v5 offset:152
ds_read_b64 v[24:25], v5 offset:32
ds_read_b64 v[56:57], v5 offset:160
ds_read_b64 v[26:27], v5 offset:40
ds_read_b64 v[58:59], v5 offset:168
ds_read_b64 v[28:29], v5 offset:48
ds_read_b64 v[60:61], v5 offset:176
ds_read_b64 v[30:31], v5 offset:56
ds_read_b64 v[62:63], v5 offset:184
ds_read_b64 v[32:33], v5 offset:64
ds_read_b64 v[64:65], v5 offset:192
ds_read_b64 v[34:35], v5 offset:72
ds_read_b64 v[66:67], v5 offset:200
ds_read_b64 v[36:37], v5 offset:80
ds_read_b64 v[68:69], v5 offset:208
ds_read_b64 v[38:39], v5 offset:88
ds_read_b64 v[70:71], v5 offset:216
ds_read_b64 v[40:41], v5 offset:96
ds_read_b64 v[72:73], v5 offset:224
ds_read_b64 v[42:43], v5 offset:104
ds_read_b64 v[74:75], v5 offset:232
ds_read_b64 v[44:45], v5 offset:112
ds_read_b64 v[76:77], v5 offset:240
ds_read_b64 v[46:47], v5 offset:120
ds_read_b64 v[78:79], v5 offset:248
s_waitcnt lgkmcnt(0)
v_pk_add_f32 v[14:15], v[16:17], v[48:49] neg_lo:[0,1] neg_hi:[0,1]
v_pk_add_f32 v[16:17], v[16:17], v[48:49]
v_pk_add_f32 v[48:49], v[18:19], v[50:51] neg_lo:[0,1] neg_hi:[0,1]
v_pk_add_f32 v[18:19], v[18:19], v[50:51]
v_pk_mul_f32 v[50:51], v[48:49], s[50:51] op_sel:[0,0] op_sel_hi:[0,1] neg_lo:[0,0] neg_hi:[0,0]
v_pk_fma_f32 v[50:51], v[48:49], s[50:51], v[50:51] op_sel:[1,1,0] op_sel_hi:[1,0,1] neg_lo:[0,1,0] neg_hi:[0,0,0]
v_pk_add_f32 v[48:49], v[20:21], v[52:53] neg_lo:[0,1] neg_hi:[0,1]
v_pk_add_f32 v[20:21], v[20:21], v[52:53]
v_pk_mul_f32 v[52:53], v[48:49], s[54:55] op_sel:[0,0] op_sel_hi:[0,1] neg_lo:[0,0] neg_hi:[0,0]
v_pk_fma_f32 v[52:53], v[48:49], s[54:55], v[52:53] op_sel:[1,1,0] op_sel_hi:[1,0,1] neg_lo:[0,1,0] neg_hi:[0,0,0]
v_pk_add_f32 v[48:49], v[22:23], v[54:55] neg_lo:[0,1] neg_hi:[0,1]
v_pk_add_f32 v[22:23], v[22:23], v[54:55]
v_pk_mul_f32 v[54:55], v[48:49], s[58:59] op_sel:[0,0] op_sel_hi:[0,1] neg_lo:[0,0] neg_hi:[0,0]
v_pk_fma_f32 v[54:55], v[48:49], s[58:59], v[54:55] op_sel:[1,1,0] op_sel_hi:[1,0,1] neg_lo:[0,1,0] neg_hi:[0,0,0]
v_pk_add_f32 v[48:49], v[24:25], v[56:57] neg_lo:[0,1] neg_hi:[0,1]
v_pk_add_f32 v[24:25], v[24:25], v[56:57]
v_pk_mul_f32 v[56:57], v[48:49], s[62:63] op_sel:[0,0] op_sel_hi:[0,1] neg_lo:[0,0] neg_hi:[0,0]
v_pk_fma_f32 v[56:57], v[48:49], s[62:63], v[56:57] op_sel:[1,1,0] op_sel_hi:[1,0,1] neg_lo:[0,1,0] neg_hi:[0,0,0]
v_pk_add_f32 v[48:49], v[26:27], v[58:59] neg_lo:[0,1] neg_hi:[0,1]
v_pk_add_f32 v[26:27], v[26:27], v[58:59]
v_pk_mul_f32 v[58:59], v[48:49], s[58:59] op_sel:[0,1] op_sel_hi:[0,0] neg_lo:[0,0] neg_hi:[0,0]
v_pk_fma_f32 v[58:59], v[48:49], s[58:59], v[58:59] op_sel:[1,0,0] op_sel_hi:[1,1,1] neg_lo:[0,1,0] neg_hi:[0,0,0]
v_pk_add_f32 v[48:49], v[28:29], v[60:61] neg_lo:[0,1] neg_hi:[0,1]
v_pk_add_f32 v[28:29], v[28:29], v[60:61]
v_pk_mul_f32 v[60:61], v[48:49], s[54:55] op_sel:[0,1] op_sel_hi:[0,0] neg_lo:[0,0] neg_hi:[0,0]
v_pk_fma_f32 v[60:61], v[48:49], s[54:55], v[60:61] op_sel:[1,0,0] op_sel_hi:[1,1,1] neg_lo:[0,1,0] neg_hi:[0,0,0]
v_pk_add_f32 v[48:49], v[30:31], v[62:63] neg_lo:[0,1] neg_hi:[0,1]
v_pk_add_f32 v[30:31], v[30:31], v[62:63]
v_pk_mul_f32 v[62:63], v[48:49], s[50:51] op_sel:[0,1] op_sel_hi:[0,0] neg_lo:[0,0] neg_hi:[0,0]
v_pk_fma_f32 v[62:63], v[48:49], s[50:51], v[62:63] op_sel:[1,0,0] op_sel_hi:[1,1,1] neg_lo:[0,1,0] neg_hi:[0,0,0]
v_pk_add_f32 v[48:49], v[32:33], v[64:65] op_sel:[1,1] op_sel_hi:[0,0] neg_lo:[1,0] neg_hi:[0,1]
v_pk_add_f32 v[32:33], v[32:33], v[64:65]
v_pk_add_f32 v[64:65], v[34:35], v[66:67] neg_lo:[0,1] neg_hi:[0,1]
v_pk_add_f32 v[34:35], v[34:35], v[66:67]
v_pk_mul_f32 v[66:67], v[64:65], s[50:51] op_sel:[0,1] op_sel_hi:[0,0] neg_lo:[0,1] neg_hi:[0,0]
v_pk_fma_f32 v[66:67], v[64:65], s[50:51], v[66:67] op_sel:[1,0,0] op_sel_hi:[1,1,1] neg_lo:[0,1,0] neg_hi:[0,1,0]
v_pk_add_f32 v[64:65], v[36:37], v[68:69] neg_lo:[0,1] neg_hi:[0,1]
v_pk_add_f32 v[36:37], v[36:37], v[68:69]
v_pk_mul_f32 v[68:69], v[64:65], s[54:55] op_sel:[0,1] op_sel_hi:[0,0] neg_lo:[0,1] neg_hi:[0,0]
v_pk_fma_f32 v[68:69], v[64:65], s[54:55], v[68:69] op_sel:[1,0,0] op_sel_hi:[1,1,1] neg_lo:[0,1,0] neg_hi:[0,1,0]
v_pk_add_f32 v[64:65], v[38:39], v[70:71] neg_lo:[0,1] neg_hi:[0,1]
v_pk_add_f32 v[38:39], v[38:39], v[70:71]
v_pk_mul_f32 v[70:71], v[64:65], s[58:59] op_sel:[0,1] op_sel_hi:[0,0] neg_lo:[0,1] neg_hi:[0,0]
v_pk_fma_f32 v[70:71], v[64:65], s[58:59], v[70:71] op_sel:[1,0,0] op_sel_hi:[1,1,1] neg_lo:[0,1,0] neg_hi:[0,1,0]
v_pk_add_f32 v[64:65], v[40:41], v[72:73] neg_lo:[0,1] neg_hi:[0,1]
v_pk_add_f32 v[40:41], v[40:41], v[72:73]
v_pk_mul_f32 v[72:73], v[64:65], s[62:63] op_sel:[0,0] op_sel_hi:[0,1] neg_lo:[0,1] neg_hi:[0,0]
v_pk_fma_f32 v[72:73], v[64:65], s[62:63], v[72:73] op_sel:[1,1,0] op_sel_hi:[1,0,1] neg_lo:[0,1,0] neg_hi:[0,1,0]
v_pk_add_f32 v[64:65], v[42:43], v[74:75] neg_lo:[0,1] neg_hi:[0,1]
v_pk_add_f32 v[42:43], v[42:43], v[74:75]
v_pk_mul_f32 v[74:75], v[64:65], s[58:59] op_sel:[0,0] op_sel_hi:[0,1] neg_lo:[0,1] neg_hi:[0,0]
v_pk_fma_f32 v[74:75], v[64:65], s[58:59], v[74:75] op_sel:[1,1,0] op_sel_hi:[1,0,1] neg_lo:[0,1,0] neg_hi:[0,1,0]
v_pk_add_f32 v[64:65], v[44:45], v[76:77] neg_lo:[0,1] neg_hi:[0,1]
v_pk_add_f32 v[44:45], v[44:45], v[76:77]
v_pk_mul_f32 v[76:77], v[64:65], s[54:55] op_sel:[0,0] op_sel_hi:[0,1] neg_lo:[0,1] neg_hi:[0,0]
v_pk_fma_f32 v[76:77], v[64:65], s[54:55], v[76:77] op_sel:[1,1,0] op_sel_hi:[1,0,1] neg_lo:[0,1,0] neg_hi:[0,1,0]
v_pk_add_f32 v[64:65], v[46:47], v[78:79] neg_lo:[0,1] neg_hi:[0,1]
v_pk_add_f32 v[46:47], v[46:47], v[78:79]
v_pk_mul_f32 v[78:79], v[64:65], s[50:51] op_sel:[0,0] op_sel_hi:[0,1] neg_lo:[0,1] neg_hi:[0,0]
v_pk_fma_f32 v[78:79], v[64:65], s[50:51], v[78:79] op_sel:[1,1,0] op_sel_hi:[1,0,1] neg_lo:[0,1,0] neg_hi:[0,1,0]
v_pk_add_f32 v[64:65], v[16:17], v[32:33] neg_lo:[0,1] neg_hi:[0,1]
v_pk_add_f32 v[16:17], v[16:17], v[32:33]
v_pk_add_f32 v[32:33], v[18:19], v[34:35] neg_lo:[0,1] neg_hi:[0,1]
v_pk_add_f32 v[18:19], v[18:19], v[34:35]
v_pk_mul_f32 v[34:35], v[32:33], s[54:55] op_sel:[0,0] op_sel_hi:[0,1] neg_lo:[0,0] neg_hi:[0,0]
v_pk_fma_f32 v[34:35], v[32:33], s[54:55], v[34:35] op_sel:[1,1,0] op_sel_hi:[1,0,1] neg_lo:[0,1,0] neg_hi:[0,0,0]
v_pk_add_f32 v[32:33], v[20:21], v[36:37] neg_lo:[0,1] neg_hi:[0,1]
v_pk_add_f32 v[20:21], v[20:21], v[36:37]
v_pk_mul_f32 v[36:37], v[32:33], s[62:63] op_sel:[0,0] op_sel_hi:[0,1] neg_lo:[0,0] neg_hi:[0,0]
v_pk_fma_f32 v[36:37], v[32:33], s[62:63], v[36:37] op_sel:[1,1,0] op_sel_hi:[1,0,1] neg_lo:[0,1,0] neg_hi:[0,0,0]
v_pk_add_f32 v[32:33], v[22:23], v[38:39] neg_lo:[0,1] neg_hi:[0,1]
v_pk_add_f32 v[22:23], v[22:23], v[38:39]
v_pk_mul_f32 v[38:39], v[32:33], s[54:55] op_sel:[0,1] op_sel_hi:[0,0] neg_lo:[0,0] neg_hi:[0,0]
v_pk_fma_f32 v[38:39], v[32:33], s[54:55], v[38:39] op_sel:[1,0,0] op_sel_hi:[1,1,1] neg_lo:[0,1,0] neg_hi:[0,0,0]
v_pk_add_f32 v[32:33], v[24:25], v[40:41] op_sel:[1,1] op_sel_hi:[0,0] neg_lo:[1,0] neg_hi:[0,1]
v_pk_add_f32 v[24:25], v[24:25], v[40:41]
v_pk_add_f32 v[40:41], v[26:27], v[42:43] neg_lo:[0,1] neg_hi:[0,1]
v_pk_add_f32 v[26:27], v[26:27], v[42:43]
v_pk_mul_f32 v[42:43], v[40:41], s[54:55] op_sel:[0,1] op_sel_hi:[0,0] neg_lo:[0,1] neg_hi:[0,0]
v_pk_fma_f32 v[42:43], v[40:41], s[54:55], v[42:43] op_sel:[1,0,0] op_sel_hi:[1,1,1] neg_lo:[0,1,0] neg_hi:[0,1,0]
v_pk_add_f32 v[40:41], v[28:29], v[44:45] neg_lo:[0,1] neg_hi:[0,1]
v_pk_add_f32 v[28:29], v[28:29], v[44:45]
v_pk_mul_f32 v[44:45], v[40:41], s[62:63] op_sel:[0,0] op_sel_hi:[0,1] neg_lo:[0,1] neg_hi:[0,0]
v_pk_fma_f32 v[44:45], v[40:41], s[62:63], v[44:45] op_sel:[1,1,0] op_sel_hi:[1,0,1] neg_lo:[0,1,0] neg_hi:[0,1,0]
v_pk_add_f32 v[40:41], v[30:31], v[46:47] neg_lo:[0,1] neg_hi:[0,1]
v_pk_add_f32 v[30:31], v[30:31], v[46:47]
v_pk_mul_f32 v[46:47], v[40:41], s[54:55] op_sel:[0,0] op_sel_hi:[0,1] neg_lo:[0,1] neg_hi:[0,0]
v_pk_fma_f32 v[46:47], v[40:41], s[54:55], v[46:47] op_sel:[1,1,0] op_sel_hi:[1,0,1] neg_lo:[0,1,0] neg_hi:[0,1,0]
v_pk_add_f32 v[40:41], v[14:15], v[48:49] neg_lo:[0,1] neg_hi:[0,1]
v_pk_add_f32 v[14:15], v[14:15], v[48:49]
v_pk_add_f32 v[48:49], v[50:51], v[66:67] neg_lo:[0,1] neg_hi:[0,1]
v_pk_add_f32 v[50:51], v[50:51], v[66:67]
v_pk_mul_f32 v[66:67], v[48:49], s[54:55] op_sel:[0,0] op_sel_hi:[0,1] neg_lo:[0,0] neg_hi:[0,0]
v_pk_fma_f32 v[66:67], v[48:49], s[54:55], v[66:67] op_sel:[1,1,0] op_sel_hi:[1,0,1] neg_lo:[0,1,0] neg_hi:[0,0,0]
v_pk_add_f32 v[48:49], v[52:53], v[68:69] neg_lo:[0,1] neg_hi:[0,1]
v_pk_add_f32 v[52:53], v[52:53], v[68:69]
v_pk_mul_f32 v[68:69], v[48:49], s[62:63] op_sel:[0,0] op_sel_hi:[0,1] neg_lo:[0,0] neg_hi:[0,0]
v_pk_fma_f32 v[68:69], v[48:49], s[62:63], v[68:69] op_sel:[1,1,0] op_sel_hi:[1,0,1] neg_lo:[0,1,0] neg_hi:[0,0,0]
v_pk_add_f32 v[48:49], v[54:55], v[70:71] neg_lo:[0,1] neg_hi:[0,1]
v_pk_add_f32 v[54:55], v[54:55], v[70:71]
v_pk_mul_f32 v[70:71], v[48:49], s[54:55] op_sel:[0,1] op_sel_hi:[0,0] neg_lo:[0,0] neg_hi:[0,0]
v_pk_fma_f32 v[70:71], v[48:49], s[54:55], v[70:71] op_sel:[1,0,0] op_sel_hi:[1,1,1] neg_lo:[0,1,0] neg_hi:[0,0,0]
v_pk_add_f32 v[48:49], v[56:57], v[72:73] op_sel:[1,1] op_sel_hi:[0,0] neg_lo:[1,0] neg_hi:[0,1]
v_pk_add_f32 v[56:57], v[56:57], v[72:73]
v_pk_add_f32 v[72:73], v[58:59], v[74:75] neg_lo:[0,1] neg_hi:[0,1]
v_pk_add_f32 v[58:59], v[58:59], v[74:75]
v_pk_mul_f32 v[74:75], v[72:73], s[54:55] op_sel:[0,1] op_sel_hi:[0,0] neg_lo:[0,1] neg_hi:[0,0]
v_pk_fma_f32 v[74:75], v[72:73], s[54:55], v[74:75] op_sel:[1,0,0] op_sel_hi:[1,1,1] neg_lo:[0,1,0] neg_hi:[0,1,0]
v_pk_add_f32 v[72:73], v[60:61], v[76:77] neg_lo:[0,1] neg_hi:[0,1]
v_pk_add_f32 v[60:61], v[60:61], v[76:77]
v_pk_mul_f32 v[76:77], v[72:73], s[62:63] op_sel:[0,0] op_sel_hi:[0,1] neg_lo:[0,1] neg_hi:[0,0]
v_pk_fma_f32 v[76:77], v[72:73], s[62:63], v[76:77] op_sel:[1,1,0] op_sel_hi:[1,0,1] neg_lo:[0,1,0] neg_hi:[0,1,0]
v_pk_add_f32 v[72:73], v[62:63], v[78:79] neg_lo:[0,1] neg_hi:[0,1]
v_pk_add_f32 v[62:63], v[62:63], v[78:79]
v_pk_mul_f32 v[78:79], v[72:73], s[54:55] op_sel:[0,0] op_sel_hi:[0,1] neg_lo:[0,1] neg_hi:[0,0]
v_pk_fma_f32 v[78:79], v[72:73], s[54:55], v[78:79] op_sel:[1,1,0] op_sel_hi:[1,0,1] neg_lo:[0,1,0] neg_hi:[0,1,0]
v_pk_add_f32 v[72:73], v[16:17], v[24:25] neg_lo:[0,1] neg_hi:[0,1]
v_pk_add_f32 v[16:17], v[16:17], v[24:25]
v_pk_add_f32 v[24:25], v[18:19], v[26:27] neg_lo:[0,1] neg_hi:[0,1]
v_pk_add_f32 v[18:19], v[18:19], v[26:27]
v_pk_mul_f32 v[26:27], v[24:25], s[62:63] op_sel:[0,0] op_sel_hi:[0,1] neg_lo:[0,0] neg_hi:[0,0]
v_pk_fma_f32 v[26:27], v[24:25], s[62:63], v[26:27] op_sel:[1,1,0] op_sel_hi:[1,0,1] neg_lo:[0,1,0] neg_hi:[0,0,0]
v_pk_add_f32 v[24:25], v[20:21], v[28:29] op_sel:[1,1] op_sel_hi:[0,0] neg_lo:[1,0] neg_hi:[0,1]
v_pk_add_f32 v[20:21], v[20:21], v[28:29]
v_pk_add_f32 v[28:29], v[22:23], v[30:31] neg_lo:[0,1] neg_hi:[0,1]
v_pk_add_f32 v[22:23], v[22:23], v[30:31]
v_pk_mul_f32 v[30:31], v[28:29], s[62:63] op_sel:[0,0] op_sel_hi:[0,1] neg_lo:[0,1] neg_hi:[0,0]
v_pk_fma_f32 v[30:31], v[28:29], s[62:63], v[30:31] op_sel:[1,1,0] op_sel_hi:[1,0,1] neg_lo:[0,1,0] neg_hi:[0,1,0]
v_pk_add_f32 v[28:29], v[64:65], v[32:33] neg_lo:[0,1] neg_hi:[0,1]
v_pk_add_f32 v[64:65], v[64:65], v[32:33]
v_pk_add_f32 v[32:33], v[34:35], v[42:43] neg_lo:[0,1] neg_hi:[0,1]
v_pk_add_f32 v[34:35], v[34:35], v[42:43]
v_pk_mul_f32 v[42:43], v[32:33], s[62:63] op_sel:[0,0] op_sel_hi:[0,1] neg_lo:[0,0] neg_hi:[0,0]
v_pk_fma_f32 v[42:43], v[32:33], s[62:63], v[42:43] op_sel:[1,1,0] op_sel_hi:[1,0,1] neg_lo:[0,1,0] neg_hi:[0,0,0]
v_pk_add_f32 v[32:33], v[36:37], v[44:45] op_sel:[1,1] op_sel_hi:[0,0] neg_lo:[1,0] neg_hi:[0,1]
v_pk_add_f32 v[36:37], v[36:37], v[44:45]
v_pk_add_f32 v[44:45], v[38:39], v[46:47] neg_lo:[0,1] neg_hi:[0,1]
v_pk_add_f32 v[38:39], v[38:39], v[46:47]
v_pk_mul_f32 v[46:47], v[44:45], s[62:63] op_sel:[0,0] op_sel_hi:[0,1] neg_lo:[0,1] neg_hi:[0,0]
v_pk_fma_f32 v[46:47], v[44:45], s[62:63], v[46:47] op_sel:[1,1,0] op_sel_hi:[1,0,1] neg_lo:[0,1,0] neg_hi:[0,1,0]
v_pk_add_f32 v[44:45], v[14:15], v[56:57] neg_lo:[0,1] neg_hi:[0,1]
v_pk_add_f32 v[14:15], v[14:15], v[56:57]
v_pk_add_f32 v[56:57], v[50:51], v[58:59] neg_lo:[0,1] neg_hi:[0,1]
v_pk_add_f32 v[50:51], v[50:51], v[58:59]
v_pk_mul_f32 v[58:59], v[56:57], s[62:63] op_sel:[0,0] op_sel_hi:[0,1] neg_lo:[0,0] neg_hi:[0,0]
v_pk_fma_f32 v[58:59], v[56:57], s[62:63], v[58:59] op_sel:[1,1,0] op_sel_hi:[1,0,1] neg_lo:[0,1,0] neg_hi:[0,0,0]
v_pk_add_f32 v[56:57], v[52:53], v[60:61] op_sel:[1,1] op_sel_hi:[0,0] neg_lo:[1,0] neg_hi:[0,1]
v_pk_add_f32 v[52:53], v[52:53], v[60:61]
v_pk_add_f32 v[60:61], v[54:55], v[62:63] neg_lo:[0,1] neg_hi:[0,1]
v_pk_add_f32 v[54:55], v[54:55], v[62:63]
v_pk_mul_f32 v[62:63], v[60:61], s[62:63] op_sel:[0,0] op_sel_hi:[0,1] neg_lo:[0,1] neg_hi:[0,0]
v_pk_fma_f32 v[62:63], v[60:61], s[62:63], v[62:63] op_sel:[1,1,0] op_sel_hi:[1,0,1] neg_lo:[0,1,0] neg_hi:[0,1,0]
v_pk_add_f32 v[60:61], v[40:41], v[48:49] neg_lo:[0,1] neg_hi:[0,1]
v_pk_add_f32 v[40:41], v[40:41], v[48:49]
v_pk_add_f32 v[48:49], v[66:67], v[74:75] neg_lo:[0,1] neg_hi:[0,1]
v_pk_add_f32 v[66:67], v[66:67], v[74:75]
v_pk_mul_f32 v[74:75], v[48:49], s[62:63] op_sel:[0,0] op_sel_hi:[0,1] neg_lo:[0,0] neg_hi:[0,0]
v_pk_fma_f32 v[74:75], v[48:49], s[62:63], v[74:75] op_sel:[1,1,0] op_sel_hi:[1,0,1] neg_lo:[0,1,0] neg_hi:[0,0,0]
v_pk_add_f32 v[48:49], v[68:69], v[76:77] op_sel:[1,1] op_sel_hi:[0,0] neg_lo:[1,0] neg_hi:[0,1]
v_pk_add_f32 v[68:69], v[68:69], v[76:77]
v_pk_add_f32 v[76:77], v[70:71], v[78:79] neg_lo:[0,1] neg_hi:[0,1]
v_pk_add_f32 v[70:71], v[70:71], v[78:79]
v_pk_mul_f32 v[78:79], v[76:77], s[62:63] op_sel:[0,0] op_sel_hi:[0,1] neg_lo:[0,1] neg_hi:[0,0]
v_pk_fma_f32 v[78:79], v[76:77], s[62:63], v[78:79] op_sel:[1,1,0] op_sel_hi:[1,0,1] neg_lo:[0,1,0] neg_hi:[0,1,0]
v_pk_add_f32 v[76:77], v[16:17], v[20:21] neg_lo:[0,1] neg_hi:[0,1]
v_pk_add_f32 v[16:17], v[16:17], v[20:21]
v_pk_add_f32 v[20:21], v[18:19], v[22:23] op_sel:[1,1] op_sel_hi:[0,0] neg_lo:[1,0] neg_hi:[0,1]
v_pk_add_f32 v[18:19], v[18:19], v[22:23]
v_pk_add_f32 v[22:23], v[72:73], v[24:25] neg_lo:[0,1] neg_hi:[0,1]
v_pk_add_f32 v[72:73], v[72:73], v[24:25]
v_pk_add_f32 v[24:25], v[26:27], v[30:31] op_sel:[1,1] op_sel_hi:[0,0] neg_lo:[1,0] neg_hi:[0,1]
v_pk_add_f32 v[26:27], v[26:27], v[30:31]
v_pk_add_f32 v[30:31], v[64:65], v[36:37] neg_lo:[0,1] neg_hi:[0,1]
v_pk_add_f32 v[64:65], v[64:65], v[36:37]
v_pk_add_f32 v[36:37], v[34:35], v[38:39] op_sel:[1,1] op_sel_hi:[0,0] neg_lo:[1,0] neg_hi:[0,1]
v_pk_add_f32 v[34:35], v[34:35], v[38:39]
v_pk_add_f32 v[38:39], v[28:29], v[32:33] neg_lo:[0,1] neg_hi:[0,1]
v_pk_add_f32 v[28:29], v[28:29], v[32:33]
v_pk_add_f32 v[32:33], v[42:43], v[46:47] op_sel:[1,1] op_sel_hi:[0,0] neg_lo:[1,0] neg_hi:[0,1]
v_pk_add_f32 v[42:43], v[42:43], v[46:47]
v_pk_add_f32 v[46:47], v[14:15], v[52:53] neg_lo:[0,1] neg_hi:[0,1]
v_pk_add_f32 v[14:15], v[14:15], v[52:53]
v_pk_add_f32 v[52:53], v[50:51], v[54:55] op_sel:[1,1] op_sel_hi:[0,0] neg_lo:[1,0] neg_hi:[0,1]
v_pk_add_f32 v[50:51], v[50:51], v[54:55]
v_pk_add_f32 v[54:55], v[44:45], v[56:57] neg_lo:[0,1] neg_hi:[0,1]
v_pk_add_f32 v[44:45], v[44:45], v[56:57]
v_pk_add_f32 v[56:57], v[58:59], v[62:63] op_sel:[1,1] op_sel_hi:[0,0] neg_lo:[1,0] neg_hi:[0,1]
v_pk_add_f32 v[58:59], v[58:59], v[62:63]
v_pk_add_f32 v[62:63], v[40:41], v[68:69] neg_lo:[0,1] neg_hi:[0,1]
v_pk_add_f32 v[40:41], v[40:41], v[68:69]
v_pk_add_f32 v[68:69], v[66:67], v[70:71] op_sel:[1,1] op_sel_hi:[0,0] neg_lo:[1,0] neg_hi:[0,1]
v_pk_add_f32 v[66:67], v[66:67], v[70:71]
v_pk_add_f32 v[70:71], v[60:61], v[48:49] neg_lo:[0,1] neg_hi:[0,1]
v_pk_add_f32 v[60:61], v[60:61], v[48:49]
v_pk_add_f32 v[48:49], v[74:75], v[78:79] op_sel:[1,1] op_sel_hi:[0,0] neg_lo:[1,0] neg_hi:[0,1]
v_pk_add_f32 v[74:75], v[74:75], v[78:79]
v_pk_add_f32 v[78:79], v[16:17], v[18:19] neg_lo:[0,1] neg_hi:[0,1]
v_pk_add_f32 v[16:17], v[16:17], v[18:19]
v_pk_add_f32 v[18:19], v[76:77], v[20:21] neg_lo:[0,1] neg_hi:[0,1]
v_pk_add_f32 v[76:77], v[76:77], v[20:21]
v_pk_add_f32 v[20:21], v[72:73], v[26:27] neg_lo:[0,1] neg_hi:[0,1]
v_pk_add_f32 v[72:73], v[72:73], v[26:27]
v_pk_add_f32 v[26:27], v[22:23], v[24:25] neg_lo:[0,1] neg_hi:[0,1]
v_pk_add_f32 v[22:23], v[22:23], v[24:25]
v_pk_add_f32 v[24:25], v[64:65], v[34:35] neg_lo:[0,1] neg_hi:[0,1]
v_pk_add_f32 v[64:65], v[64:65], v[34:35]
v_pk_add_f32 v[34:35], v[30:31], v[36:37] neg_lo:[0,1] neg_hi:[0,1]
v_pk_add_f32 v[30:31], v[30:31], v[36:37]
v_pk_add_f32 v[36:37], v[28:29], v[42:43] neg_lo:[0,1] neg_hi:[0,1]
v_pk_add_f32 v[28:29], v[28:29], v[42:43]
v_pk_add_f32 v[42:43], v[38:39], v[32:33] neg_lo:[0,1] neg_hi:[0,1]
v_pk_add_f32 v[38:39], v[38:39], v[32:33]
v_pk_add_f32 v[32:33], v[14:15], v[50:51] neg_lo:[0,1] neg_hi:[0,1]
v_pk_add_f32 v[14:15], v[14:15], v[50:51]
v_pk_add_f32 v[50:51], v[46:47], v[52:53] neg_lo:[0,1] neg_hi:[0,1]
v_pk_add_f32 v[46:47], v[46:47], v[52:53]
v_pk_add_f32 v[52:53], v[44:45], v[58:59] neg_lo:[0,1] neg_hi:[0,1]
v_pk_add_f32 v[44:45], v[44:45], v[58:59]
v_pk_add_f32 v[58:59], v[54:55], v[56:57] neg_lo:[0,1] neg_hi:[0,1]
v_pk_add_f32 v[54:55], v[54:55], v[56:57]
v_pk_add_f32 v[56:57], v[40:41], v[66:67] neg_lo:[0,1] neg_hi:[0,1]
v_pk_add_f32 v[40:41], v[40:41], v[66:67]
v_pk_add_f32 v[66:67], v[62:63], v[68:69] neg_lo:[0,1] neg_hi:[0,1]
v_pk_add_f32 v[62:63], v[62:63], v[68:69]
v_pk_add_f32 v[68:69], v[60:61], v[74:75] neg_lo:[0,1] neg_hi:[0,1]
v_pk_add_f32 v[60:61], v[60:61], v[74:75]
v_pk_add_f32 v[74:75], v[70:71], v[48:49] neg_lo:[0,1] neg_hi:[0,1]
v_pk_add_f32 v[70:71], v[70:71], v[48:49]
ds_write2st64_b32 v12, v16, v17 offset0:0 offset1:16
ds_write_b32 v12, v14 offset:128
ds_write_b32 v12, v15 offset:4224
ds_write_b32 v12, v64 offset:256
ds_write_b32 v12, v65 offset:4352
ds_write_b32 v12, v40 offset:384
ds_write_b32 v12, v41 offset:4480
ds_write_b32 v12, v72 offset:512
ds_write_b32 v12, v73 offset:4608
ds_write_b32 v12, v44 offset:640
ds_write_b32 v12, v45 offset:4736
ds_write_b32 v12, v28 offset:768
ds_write_b32 v12, v29 offset:4864
ds_write_b32 v12, v60 offset:896
ds_write_b32 v12, v61 offset:4992
ds_write_b32 v12, v76 offset:1024
ds_write_b32 v12, v77 offset:5120
ds_write_b32 v12, v46 offset:1152
ds_write_b32 v12, v47 offset:5248
ds_write_b32 v12, v30 offset:1280
ds_write_b32 v12, v31 offset:5376
ds_write_b32 v12, v62 offset:1408
ds_write_b32 v12, v63 offset:5504
ds_write_b32 v12, v22 offset:1536
ds_write_b32 v12, v23 offset:5632
ds_write_b32 v12, v54 offset:1664
ds_write_b32 v12, v55 offset:5760
ds_write_b32 v12, v38 offset:1792
ds_write_b32 v12, v39 offset:5888
ds_write_b32 v12, v70 offset:1920
ds_write_b32 v12, v71 offset:6016
ds_write_b32 v12, v78 offset:2048
ds_write_b32 v12, v79 offset:6144
ds_write_b32 v12, v32 offset:2176
ds_write_b32 v12, v33 offset:6272
ds_write_b32 v12, v24 offset:2304
ds_write_b32 v12, v25 offset:6400
ds_write_b32 v12, v56 offset:2432
ds_write_b32 v12, v57 offset:6528
ds_write_b32 v12, v20 offset:2560
ds_write_b32 v12, v21 offset:6656
ds_write_b32 v12, v52 offset:2688
ds_write_b32 v12, v53 offset:6784
ds_write_b32 v12, v36 offset:2816
ds_write_b32 v12, v37 offset:6912
ds_write_b32 v12, v68 offset:2944
ds_write_b32 v12, v69 offset:7040
ds_write_b32 v12, v18 offset:3072
ds_write_b32 v12, v19 offset:7168
ds_write_b32 v12, v50 offset:3200
ds_write_b32 v12, v51 offset:7296
ds_write_b32 v12, v34 offset:3328
ds_write_b32 v12, v35 offset:7424
ds_write_b32 v12, v66 offset:3456
ds_write_b32 v12, v67 offset:7552
ds_write_b32 v12, v26 offset:3584
ds_write_b32 v12, v27 offset:7680
ds_write_b32 v12, v58 offset:3712
ds_write_b32 v12, v59 offset:7808
ds_write_b32 v12, v42 offset:3840
ds_write_b32 v12, v43 offset:7936
ds_write_b32 v12, v74 offset:3968
ds_write_b32 v12, v75 offset:8064
s_waitcnt lgkmcnt(0)
s_barrier
s_lshl_b32 s13, s93, 16
ds_read_b128 v[16:19], v2 offset:0
ds_read_b128 v[20:23], v2 offset:16
ds_read_b128 v[24:27], v2 offset:8448
ds_read_b128 v[28:31], v2 offset:8464
ds_read_b128 v[32:35], v2 offset:16896
ds_read_b128 v[36:39], v2 offset:16912
ds_read_b128 v[40:43], v2 offset:25344
ds_read_b128 v[44:47], v2 offset:25360
ds_read_b128 v[48:51], v2 offset:33792
ds_read_b128 v[52:55], v2 offset:33808
ds_read_b128 v[56:59], v2 offset:42240
ds_read_b128 v[60:63], v2 offset:42256
ds_read_b128 v[64:67], v2 offset:50688
ds_read_b128 v[68:71], v2 offset:50704
s_waitcnt lgkmcnt(12)
ds_read_b128 v[72:75], v2 offset:59136
ds_read_b128 v[76:79], v2 offset:59152
s_waitcnt lgkmcnt(14)
v_cvt_pk_bf16_f32 v216, v16, v17
v_cvt_pk_bf16_f32 v217, v18, v19
v_cvt_pk_bf16_f32 v218, v20, v21
v_cvt_pk_bf16_f32 v219, v22, v23
buffer_store_dwordx4 v[216:219], v3, s[4:7], s13 offen sc1
s_add_u32 s13, s13, 8192
s_waitcnt lgkmcnt(12)
v_cvt_pk_bf16_f32 v220, v24, v25
v_cvt_pk_bf16_f32 v221, v26, v27
v_cvt_pk_bf16_f32 v222, v28, v29
v_cvt_pk_bf16_f32 v223, v30, v31
buffer_store_dwordx4 v[220:223], v3, s[4:7], s13 offen sc1
s_add_u32 s13, s13, 8192
s_waitcnt lgkmcnt(10)
v_cvt_pk_bf16_f32 v224, v32, v33
v_cvt_pk_bf16_f32 v225, v34, v35
v_cvt_pk_bf16_f32 v226, v36, v37
v_cvt_pk_bf16_f32 v227, v38, v39
buffer_store_dwordx4 v[224:227], v3, s[4:7], s13 offen sc1
s_add_u32 s13, s13, 8192
s_waitcnt lgkmcnt(8)
v_cvt_pk_bf16_f32 v228, v40, v41
v_cvt_pk_bf16_f32 v229, v42, v43
v_cvt_pk_bf16_f32 v230, v44, v45
v_cvt_pk_bf16_f32 v231, v46, v47
buffer_store_dwordx4 v[228:231], v3, s[4:7], s13 offen sc1
s_add_u32 s13, s13, 8192
s_waitcnt lgkmcnt(6)
v_cvt_pk_bf16_f32 v232, v48, v49
v_cvt_pk_bf16_f32 v233, v50, v51
v_cvt_pk_bf16_f32 v234, v52, v53
v_cvt_pk_bf16_f32 v235, v54, v55
buffer_store_dwordx4 v[232:235], v3, s[4:7], s13 offen sc1
s_add_u32 s13, s13, 8192
s_waitcnt lgkmcnt(4)
v_cvt_pk_bf16_f32 v236, v56, v57
v_cvt_pk_bf16_f32 v237, v58, v59
v_cvt_pk_bf16_f32 v238, v60, v61
v_cvt_pk_bf16_f32 v239, v62, v63
buffer_store_dwordx4 v[236:239], v3, s[4:7], s13 offen sc1
s_add_u32 s13, s13, 8192
s_waitcnt lgkmcnt(2)
v_cvt_pk_bf16_f32 v240, v64, v65
v_cvt_pk_bf16_f32 v241, v66, v67
v_cvt_pk_bf16_f32 v242, v68, v69
v_cvt_pk_bf16_f32 v243, v70, v71
buffer_store_dwordx4 v[240:243], v3, s[4:7], s13 offen sc1
s_add_u32 s13, s13, 8192
s_waitcnt lgkmcnt(0)
v_cvt_pk_bf16_f32 v244, v72, v73
v_cvt_pk_bf16_f32 v245, v74, v75
v_cvt_pk_bf16_f32 v246, v76, v77
v_cvt_pk_bf16_f32 v247, v78, v79
buffer_store_dwordx4 v[244:247], v3, s[4:7], s13 offen sc1
s_add_u32 s13, s13, 8192
s_mov_b32 s93, s21
s_cmp_lt_u32 s93, 128
s_cbranch_scc1 mega_kernel_f3_l
mega_kernel_f3_e:
s_waitcnt vmcnt(0)
s_barrier
s_add_u32 s64, s91, 58
s_mov_b32 s65, 64
s_mov_b32 s67, 1
s_add_u32 s66, s66, 262144
s_cmp_eq_u32 s91, 0
s_cbranch_scc1 mega_kernel_out
s_lshr_b32 s66, s40, 2
s_lshl_b32 s66, s66, 16
s_and_b32 s76, s40, 3
s_lshl_b32 s76, s76, 13
s_add_u32 s66, s66, s76
s_add_u32 s66, s66, 67141632
mega_kernel_out:
s_load_dwordx2 s[4:5], s[0:1], 40
s_load_dwordx2 s[8:9], s[0:1], 80
v_lshrrev_b32 v2, 6, v0
v_and_b32 v1, 63, v0
v_readfirstlane_b32 s41, v2
v_lshlrev_b32 v5, 4, v1
s_waitcnt lgkmcnt(0)
s_mov_b32 s6, 8388608
s_mov_b32 s7, 0x00020000
s_mov_b32 s10, 8388608
s_mov_b32 s11, 0x00020000
s_and_b32 s58, s40, 1
s_lshr_b32 s59, s40, 1
s_lshl_b32 s43, s58, 22
s_lshl_b32 s44, s41, 20
s_add_u32 s43, s43, s44
s_lshl_b32 s44, s59, 7
s_add_u32 s48, s43, s44
s_and_b32 s56, s59, 7
s_lshl_b32 s56, s56, 6
s_cmp_eq_u32 s68, 2
s_cbranch_scc1 mega_kernel_o_hw
v_lshrrev_b32 v2, 3, v1
v_and_b32 v3, 7, v1
v_lshlrev_b32 v16, 11, v2
v_lshl_add_u32 v16, v3, 4, v16
v_add_u32 v16, s48, v16
v_and_b32 v3, 3, v1
s_lshl_b32 s45, s41, 15
v_bfe_u32 v17, v1, 2, 2
v_lshrrev_b32 v18, 5, v1
v_mul_u32_u24 v18, 4, v18
v_add_u32 v17, v17, v18
v_lshlrev_b32 v17, 7, v17
v_bfe_u32 v18, v1, 4, 1
v_lshl_add_u32 v17, v18, 5, v17
v_lshl_add_u32 v17, v3, 3, v17
v_add_u32 v17, s45, v17
s_add_u32 m0, s45, 0
s_add_u32 s44, s56, 0
s_and_b32 s44, s44, 511
s_lshl_b32 s44, s44, 11
buffer_load_dwordx4 v16, s[4:7], s44 offen lds
s_add_u32 m0, s45, 1024
s_add_u32 s44, s56, 8
s_and_b32 s44, s44, 511
s_lshl_b32 s44, s44, 11
buffer_load_dwordx4 v16, s[4:7], s44 offen lds
s_add_u32 m0, s45, 2048
s_add_u32 s44, s56, 16
s_and_b32 s44, s44, 511
s_lshl_b32 s44, s44, 11
buffer_load_dwordx4 v16, s[4:7], s44 offen lds
s_add_u32 m0, s45, 3072
s_add_u32 s44, s56, 24
s_and_b32 s44, s44, 511
s_lshl_b32 s44, s44, 11
buffer_load_dwordx4 v16, s[4:7], s44 offen lds
s_add_u32 m0, s45, 4096
s_add_u32 s44, s56, 32
s_and_b32 s44, s44, 511
s_lshl_b32 s44, s44, 11
buffer_load_dwordx4 v16, s[4:7], s44 offen lds
s_add_u32 m0, s45, 5120
s_add_u32 s44, s56, 40
s_and_b32 s44, s44, 511
s_lshl_b32 s44, s44, 11
buffer_load_dwordx4 v16, s[4:7], s44 offen lds
s_add_u32 m0, s45, 6144
s_add_u32 s44, s56, 48
s_and_b32 s44, s44, 511
s_lshl_b32 s44, s44, 11
buffer_load_dwordx4 v16, s[4:7], s44 offen lds
s_add_u32 m0, s45, 7168
s_add_u32 s44, s56, 56
s_and_b32 s44, s44, 511
s_lshl_b32 s44, s44, 11
buffer_load_dwordx4 v16, s[4:7], s44 offen lds
s_add_u32 m0, s45, 8192
s_add_u32 s44, s56, 64
s_and_b32 s44, s44, 511
s_lshl_b32 s44, s44, 11
buffer_load_dwordx4 v16, s[4:7], s44 offen lds
s_add_u32 m0, s45, 9216
s_add_u32 s44, s56, 72
s_and_b32 s44, s44, 511
s_lshl_b32 s44, s44, 11
buffer_load_dwordx4 v16, s[4:7], s44 offen lds
s_add_u32 m0, s45, 10240
s_add_u32 s44, s56, 80
s_and_b32 s44, s44, 511
s_lshl_b32 s44, s44, 11
buffer_load_dwordx4 v16, s[4:7], s44 offen lds
s_add_u32 m0, s45, 11264
s_add_u32 s44, s56, 88
s_and_b32 s44, s44, 511
s_lshl_b32 s44, s44, 11
buffer_load_dwordx4 v16, s[4:7], s44 offen lds
s_add_u32 m0, s45, 12288
s_add_u32 s44, s56, 96
s_and_b32 s44, s44, 511
s_lshl_b32 s44, s44, 11
buffer_load_dwordx4 v16, s[4:7], s44 offen lds
s_add_u32 m0, s45, 13312
s_add_u32 s44, s56, 104
s_and_b32 s44, s44, 511
s_lshl_b32 s44, s44, 11
buffer_load_dwordx4 v16, s[4:7], s44 offen lds
s_add_u32 m0, s45, 14336
s_add_u32 s44, s56, 112
s_and_b32 s44, s44, 511
s_lshl_b32 s44, s44, 11
buffer_load_dwordx4 v16, s[4:7], s44 offen lds
s_add_u32 m0, s45, 15360
s_add_u32 s44, s56, 120
s_and_b32 s44, s44, 511
s_lshl_b32 s44, s44, 11
buffer_load_dwordx4 v16, s[4:7], s44 offen lds
s_add_u32 m0, s45, 16384
s_add_u32 s44, s56, 128
s_and_b32 s44, s44, 511
s_lshl_b32 s44, s44, 11
buffer_load_dwordx4 v16, s[4:7], s44 offen lds
s_add_u32 m0, s45, 17408
s_add_u32 s44, s56, 136
s_and_b32 s44, s44, 511
s_lshl_b32 s44, s44, 11
buffer_load_dwordx4 v16, s[4:7], s44 offen lds
s_add_u32 m0, s45, 18432
s_add_u32 s44, s56, 144
s_and_b32 s44, s44, 511
s_lshl_b32 s44, s44, 11
buffer_load_dwordx4 v16, s[4:7], s44 offen lds
s_add_u32 m0, s45, 19456
s_add_u32 s44, s56, 152
s_and_b32 s44, s44, 511
s_lshl_b32 s44, s44, 11
buffer_load_dwordx4 v16, s[4:7], s44 offen lds
s_add_u32 m0, s45, 20480
s_add_u32 s44, s56, 160
s_and_b32 s44, s44, 511
s_lshl_b32 s44, s44, 11
buffer_load_dwordx4 v16, s[4:7], s44 offen lds
s_add_u32 m0, s45, 21504
s_add_u32 s44, s56, 168
s_and_b32 s44, s44, 511
s_lshl_b32 s44, s44, 11
buffer_load_dwordx4 v16, s[4:7], s44 offen lds
s_add_u32 m0, s45, 22528
s_add_u32 s44, s56, 176
s_and_b32 s44, s44, 511
s_lshl_b32 s44, s44, 11
buffer_load_dwordx4 v16, s[4:7], s44 offen lds
s_add_u32 m0, s45, 23552
s_add_u32 s44, s56, 184
s_and_b32 s44, s44, 511
s_lshl_b32 s44, s44, 11
buffer_load_dwordx4 v16, s[4:7], s44 offen lds
s_add_u32 m0, s45, 24576
s_add_u32 s44, s56, 192
s_and_b32 s44, s44, 511
s_lshl_b32 s44, s44, 11
buffer_load_dwordx4 v16, s[4:7], s44 offen lds
s_add_u32 m0, s45, 25600
s_add_u32 s44, s56, 200
s_and_b32 s44, s44, 511
s_lshl_b32 s44, s44, 11
buffer_load_dwordx4 v16, s[4:7], s44 offen lds
s_add_u32 m0, s45, 26624
s_add_u32 s44, s56, 208
s_and_b32 s44, s44, 511
s_lshl_b32 s44, s44, 11
buffer_load_dwordx4 v16, s[4:7], s44 offen lds
s_add_u32 m0, s45, 27648
s_add_u32 s44, s56, 216
s_and_b32 s44, s44, 511
s_lshl_b32 s44, s44, 11
buffer_load_dwordx4 v16, s[4:7], s44 offen lds
s_add_u32 m0, s45, 28672
s_add_u32 s44, s56, 224
s_and_b32 s44, s44, 511
s_lshl_b32 s44, s44, 11
buffer_load_dwordx4 v16, s[4:7], s44 offen lds
s_add_u32 m0, s45, 29696
s_add_u32 s44, s56, 232
s_and_b32 s44, s44, 511
s_lshl_b32 s44, s44, 11
buffer_load_dwordx4 v16, s[4:7], s44 offen lds
s_add_u32 m0, s45, 30720
s_add_u32 s44, s56, 240
s_and_b32 s44, s44, 511
s_lshl_b32 s44, s44, 11
buffer_load_dwordx4 v16, s[4:7], s44 offen lds
s_add_u32 m0, s45, 31744
s_add_u32 s44, s56, 248
s_and_b32 s44, s44, 511
s_lshl_b32 s44, s44, 11
buffer_load_dwordx4 v16, s[4:7], s44 offen lds
s_waitcnt vmcnt(16)
ds_read_b64_tr_b16 a[0:1], v17 offset:0
ds_read_b64_tr_b16 a[2:3], v17 offset:2048
ds_read_b64_tr_b16 a[4:5], v17 offset:64
ds_read_b64_tr_b16 a[6:7], v17 offset:2112
ds_read_b64_tr_b16 a[8:9], v17 offset:1024
ds_read_b64_tr_b16 a[10:11], v17 offset:3072
ds_read_b64_tr_b16 a[12:13], v17 offset:1088
ds_read_b64_tr_b16 a[14:15], v17 offset:3136
s_waitcnt lgkmcnt(0)
ds_read_b64_tr_b16 a[16:17], v17 offset:4096
ds_read_b64_tr_b16 a[18:19], v17 offset:6144
ds_read_b64_tr_b16 a[20:21], v17 offset:4160
ds_read_b64_tr_b16 a[22:23], v17 offset:6208
ds_read_b64_tr_b16 a[24:25], v17 offset:5120
ds_read_b64_tr_b16 a[26:27], v17 offset:7168
ds_read_b64_tr_b16 a[28:29], v17 offset:5184
ds_read_b64_tr_b16 a[30:31], v17 offset:7232
s_waitcnt lgkmcnt(0)
ds_read_b64_tr_b16 a[32:33], v17 offset:8192
ds_read_b64_tr_b16 a[34:35], v17 offset:10240
ds_read_b64_tr_b16 a[36:37], v17 offset:8256
ds_read_b64_tr_b16 a[38:39], v17 offset:10304
ds_read_b64_tr_b16 a[40:41], v17 offset:9216
ds_read_b64_tr_b16 a[42:43], v17 offset:11264
ds_read_b64_tr_b16 a[44:45], v17 offset:9280
ds_read_b64_tr_b16 a[46:47], v17 offset:11328
s_waitcnt lgkmcnt(0)
ds_read_b64_tr_b16 a[48:49], v17 offset:12288
ds_read_b64_tr_b16 a[50:51], v17 offset:14336
ds_read_b64_tr_b16 a[52:53], v17 offset:12352
ds_read_b64_tr_b16 a[54:55], v17 offset:14400
ds_read_b64_tr_b16 a[56:57], v17 offset:13312
ds_read_b64_tr_b16 a[58:59], v17 offset:15360
ds_read_b64_tr_b16 a[60:61], v17 offset:13376
ds_read_b64_tr_b16 a[62:63], v17 offset:15424
s_waitcnt lgkmcnt(0)
s_add_u32 m0, s45, 0
s_add_u32 s44, s56, 256
s_and_b32 s44, s44, 511
s_lshl_b32 s44, s44, 11
buffer_load_dwordx4 v16, s[4:7], s44 offen lds
s_add_u32 m0, s45, 1024
s_add_u32 s44, s56, 264
s_and_b32 s44, s44, 511
s_lshl_b32 s44, s44, 11
buffer_load_dwordx4 v16, s[4:7], s44 offen lds
s_add_u32 m0, s45, 2048
s_add_u32 s44, s56, 272
s_and_b32 s44, s44, 511
s_lshl_b32 s44, s44, 11
buffer_load_dwordx4 v16, s[4:7], s44 offen lds
s_add_u32 m0, s45, 3072
s_add_u32 s44, s56, 280
s_and_b32 s44, s44, 511
s_lshl_b32 s44, s44, 11
buffer_load_dwordx4 v16, s[4:7], s44 offen lds
s_add_u32 m0, s45, 4096
s_add_u32 s44, s56, 288
s_and_b32 s44, s44, 511
s_lshl_b32 s44, s44, 11
buffer_load_dwordx4 v16, s[4:7], s44 offen lds
s_add_u32 m0, s45, 5120
s_add_u32 s44, s56, 296
s_and_b32 s44, s44, 511
s_lshl_b32 s44, s44, 11
buffer_load_dwordx4 v16, s[4:7], s44 offen lds
s_add_u32 m0, s45, 6144
s_add_u32 s44, s56, 304
s_and_b32 s44, s44, 511
s_lshl_b32 s44, s44, 11
buffer_load_dwordx4 v16, s[4:7], s44 offen lds
s_add_u32 m0, s45, 7168
s_add_u32 s44, s56, 312
s_and_b32 s44, s44, 511
s_lshl_b32 s44, s44, 11
buffer_load_dwordx4 v16, s[4:7], s44 offen lds
s_add_u32 m0, s45, 8192
s_add_u32 s44, s56, 320
s_and_b32 s44, s44, 511
s_lshl_b32 s44, s44, 11
buffer_load_dwordx4 v16, s[4:7], s44 offen lds
s_add_u32 m0, s45, 9216
s_add_u32 s44, s56, 328
s_and_b32 s44, s44, 511
s_lshl_b32 s44, s44, 11
buffer_load_dwordx4 v16, s[4:7], s44 offen lds
s_add_u32 m0, s45, 10240
s_add_u32 s44, s56, 336
s_and_b32 s44, s44, 511
s_lshl_b32 s44, s44, 11
buffer_load_dwordx4 v16, s[4:7], s44 offen lds
s_add_u32 m0, s45, 11264
s_add_u32 s44, s56, 344
s_and_b32 s44, s44, 511
s_lshl_b32 s44, s44, 11
buffer_load_dwordx4 v16, s[4:7], s44 offen lds
s_add_u32 m0, s45, 12288
s_add_u32 s44, s56, 352
s_and_b32 s44, s44, 511
s_lshl_b32 s44, s44, 11
buffer_load_dwordx4 v16, s[4:7], s44 offen lds
s_add_u32 m0, s45, 13312
s_add_u32 s44, s56, 360
s_and_b32 s44, s44, 511
s_lshl_b32 s44, s44, 11
buffer_load_dwordx4 v16, s[4:7], s44 offen lds
s_add_u32 m0, s45, 14336
s_add_u32 s44, s56, 368
s_and_b32 s44, s44, 511
s_lshl_b32 s44, s44, 11
buffer_load_dwordx4 v16, s[4:7], s44 offen lds
s_add_u32 m0, s45, 15360
s_add_u32 s44, s56, 376
s_and_b32 s44, s44, 511
s_lshl_b32 s44, s44, 11
buffer_load_dwordx4 v16, s[4:7], s44 offen lds
s_waitcnt vmcnt(16)
ds_read_b64_tr_b16 a[64:65], v17 offset:16384
ds_read_b64_tr_b16 a[66:67], v17 offset:18432
ds_read_b64_tr_b16 a[68:69], v17 offset:16448
ds_read_b64_tr_b16 a[70:71], v17 offset:18496
ds_read_b64_tr_b16 a[72:73], v17 offset:17408
ds_read_b64_tr_b16 a[74:75], v17 offset:19456
ds_read_b64_tr_b16 a[76:77], v17 offset:17472
ds_read_b64_tr_b16 a[78:79], v17 offset:19520
s_waitcnt lgkmcnt(0)
ds_read_b64_tr_b16 a[80:81], v17 offset:20480
ds_read_b64_tr_b16 a[82:83], v17 offset:22528
ds_read_b64_tr_b16 a[84:85], v17 offset:20544
ds_read_b64_tr_b16 a[86:87], v17 offset:22592
ds_read_b64_tr_b16 a[88:89], v17 offset:21504
ds_read_b64_tr_b16 a[90:91], v17 offset:23552
ds_read_b64_tr_b16 a[92:93], v17 offset:21568
ds_read_b64_tr_b16 a[94:95], v17 offset:23616
s_waitcnt lgkmcnt(0)
ds_read_b64_tr_b16 a[96:97], v17 offset:24576
ds_read_b64_tr_b16 a[98:99], v17 offset:26624
ds_read_b64_tr_b16 a[100:101], v17 offset:24640
ds_read_b64_tr_b16 a[102:103], v17 offset:26688
ds_read_b64_tr_b16 a[104:105], v17 offset:25600
ds_read_b64_tr_b16 a[106:107], v17 offset:27648
ds_read_b64_tr_b16 a[108:109], v17 offset:25664
ds_read_b64_tr_b16 a[110:111], v17 offset:27712
s_waitcnt lgkmcnt(0)
ds_read_b64_tr_b16 a[112:113], v17 offset:28672
ds_read_b64_tr_b16 a[114:115], v17 offset:30720
ds_read_b64_tr_b16 a[116:117], v17 offset:28736
ds_read_b64_tr_b16 a[118:119], v17 offset:30784
ds_read_b64_tr_b16 a[120:121], v17 offset:29696
ds_read_b64_tr_b16 a[122:123], v17 offset:31744
ds_read_b64_tr_b16 a[124:125], v17 offset:29760
ds_read_b64_tr_b16 a[126:127], v17 offset:31808
s_waitcnt lgkmcnt(0)
s_add_u32 m0, s45, 16384
s_add_u32 s44, s56, 384
s_and_b32 s44, s44, 511
s_lshl_b32 s44, s44, 11
buffer_load_dwordx4 v16, s[4:7], s44 offen lds
s_add_u32 m0, s45, 17408
s_add_u32 s44, s56, 392
s_and_b32 s44, s44, 511
s_lshl_b32 s44, s44, 11
buffer_load_dwordx4 v16, s[4:7], s44 offen lds
s_add_u32 m0, s45, 18432
s_add_u32 s44, s56, 400
s_and_b32 s44, s44, 511
s_lshl_b32 s44, s44, 11
buffer_load_dwordx4 v16, s[4:7], s44 offen lds
s_add_u32 m0, s45, 19456
s_add_u32 s44, s56, 408
s_and_b32 s44, s44, 511
s_lshl_b32 s44, s44, 11
buffer_load_dwordx4 v16, s[4:7], s44 offen lds
s_add_u32 m0, s45, 20480
s_add_u32 s44, s56, 416
s_and_b32 s44, s44, 511
s_lshl_b32 s44, s44, 11
buffer_load_dwordx4 v16, s[4:7], s44 offen lds
s_add_u32 m0, s45, 21504
s_add_u32 s44, s56, 424
s_and_b32 s44, s44, 511
s_lshl_b32 s44, s44, 11
buffer_load_dwordx4 v16, s[4:7], s44 offen lds
s_add_u32 m0, s45, 22528
s_add_u32 s44, s56, 432
s_and_b32 s44, s44, 511
s_lshl_b32 s44, s44, 11
buffer_load_dwordx4 v16, s[4:7], s44 offen lds
s_add_u32 m0, s45, 23552
s_add_u32 s44, s56, 440
s_and_b32 s44, s44, 511
s_lshl_b32 s44, s44, 11
buffer_load_dwordx4 v16, s[4:7], s44 offen lds
s_add_u32 m0, s45, 24576
s_add_u32 s44, s56, 448
s_and_b32 s44, s44, 511
s_lshl_b32 s44, s44, 11
buffer_load_dwordx4 v16, s[4:7], s44 offen lds
s_add_u32 m0, s45, 25600
s_add_u32 s44, s56, 456
s_and_b32 s44, s44, 511
s_lshl_b32 s44, s44, 11
buffer_load_dwordx4 v16, s[4:7], s44 offen lds
s_add_u32 m0, s45, 26624
s_add_u32 s44, s56, 464
s_and_b32 s44, s44, 511
s_lshl_b32 s44, s44, 11
buffer_load_dwordx4 v16, s[4:7], s44 offen lds
s_add_u32 m0, s45, 27648
s_add_u32 s44, s56, 472
s_and_b32 s44, s44, 511
s_lshl_b32 s44, s44, 11
buffer_load_dwordx4 v16, s[4:7], s44 offen lds
s_add_u32 m0, s45, 28672
s_add_u32 s44, s56, 480
s_and_b32 s44, s44, 511
s_lshl_b32 s44, s44, 11
buffer_load_dwordx4 v16, s[4:7], s44 offen lds
s_add_u32 m0, s45, 29696
s_add_u32 s44, s56, 488
s_and_b32 s44, s44, 511
s_lshl_b32 s44, s44, 11
buffer_load_dwordx4 v16, s[4:7], s44 offen lds
s_add_u32 m0, s45, 30720
s_add_u32 s44, s56, 496
s_and_b32 s44, s44, 511
s_lshl_b32 s44, s44, 11
buffer_load_dwordx4 v16, s[4:7], s44 offen lds
s_add_u32 m0, s45, 31744
s_add_u32 s44, s56, 504
s_and_b32 s44, s44, 511
s_lshl_b32 s44, s44, 11
buffer_load_dwordx4 v16, s[4:7], s44 offen lds
s_waitcnt vmcnt(16)
ds_read_b64_tr_b16 a[128:129], v17 offset:0
ds_read_b64_tr_b16 a[130:131], v17 offset:2048
ds_read_b64_tr_b16 a[132:133], v17 offset:64
ds_read_b64_tr_b16 a[134:135], v17 offset:2112
ds_read_b64_tr_b16 a[136:137], v17 offset:1024
ds_read_b64_tr_b16 a[138:139], v17 offset:3072
ds_read_b64_tr_b16 a[140:141], v17 offset:1088
ds_read_b64_tr_b16 a[142:143], v17 offset:3136
s_waitcnt lgkmcnt(0)
ds_read_b64_tr_b16 a[144:145], v17 offset:4096
ds_read_b64_tr_b16 a[146:147], v17 offset:6144
ds_read_b64_tr_b16 a[148:149], v17 offset:4160
ds_read_b64_tr_b16 a[150:151], v17 offset:6208
ds_read_b64_tr_b16 a[152:153], v17 offset:5120
ds_read_b64_tr_b16 a[154:155], v17 offset:7168
ds_read_b64_tr_b16 a[156:157], v17 offset:5184
ds_read_b64_tr_b16 a[158:159], v17 offset:7232
s_waitcnt lgkmcnt(0)
ds_read_b64_tr_b16 a[160:161], v17 offset:8192
ds_read_b64_tr_b16 a[162:163], v17 offset:10240
ds_read_b64_tr_b16 a[164:165], v17 offset:8256
ds_read_b64_tr_b16 a[166:167], v17 offset:10304
ds_read_b64_tr_b16 a[168:169], v17 offset:9216
ds_read_b64_tr_b16 a[170:171], v17 offset:11264
ds_read_b64_tr_b16 a[172:173], v17 offset:9280
ds_read_b64_tr_b16 a[174:175], v17 offset:11328
s_waitcnt lgkmcnt(0)
ds_read_b64_tr_b16 a[176:177], v17 offset:12288
ds_read_b64_tr_b16 a[178:179], v17 offset:14336
ds_read_b64_tr_b16 a[180:181], v17 offset:12352
ds_read_b64_tr_b16 a[182:183], v17 offset:14400
ds_read_b64_tr_b16 a[184:185], v17 offset:13312
ds_read_b64_tr_b16 a[186:187], v17 offset:15360
ds_read_b64_tr_b16 a[188:189], v17 offset:13376
ds_read_b64_tr_b16 a[190:191], v17 offset:15424
s_waitcnt lgkmcnt(0)
s_waitcnt vmcnt(0)
ds_read_b64_tr_b16 a[192:193], v17 offset:16384
ds_read_b64_tr_b16 a[194:195], v17 offset:18432
ds_read_b64_tr_b16 a[196:197], v17 offset:16448
ds_read_b64_tr_b16 a[198:199], v17 offset:18496
ds_read_b64_tr_b16 a[200:201], v17 offset:17408
ds_read_b64_tr_b16 a[202:203], v17 offset:19456
ds_read_b64_tr_b16 a[204:205], v17 offset:17472
ds_read_b64_tr_b16 a[206:207], v17 offset:19520
s_waitcnt lgkmcnt(0)
ds_read_b64_tr_b16 a[208:209], v17 offset:20480
ds_read_b64_tr_b16 a[210:211], v17 offset:22528
ds_read_b64_tr_b16 a[212:213], v17 offset:20544
ds_read_b64_tr_b16 a[214:215], v17 offset:22592
ds_read_b64_tr_b16 a[216:217], v17 offset:21504
ds_read_b64_tr_b16 a[218:219], v17 offset:23552
ds_read_b64_tr_b16 a[220:221], v17 offset:21568
ds_read_b64_tr_b16 a[222:223], v17 offset:23616
s_waitcnt lgkmcnt(0)
ds_read_b64_tr_b16 a[224:225], v17 offset:24576
ds_read_b64_tr_b16 a[226:227], v17 offset:26624
ds_read_b64_tr_b16 a[228:229], v17 offset:24640
ds_read_b64_tr_b16 a[230:231], v17 offset:26688
ds_read_b64_tr_b16 a[232:233], v17 offset:25600
ds_read_b64_tr_b16 a[234:235], v17 offset:27648
ds_read_b64_tr_b16 a[236:237], v17 offset:25664
ds_read_b64_tr_b16 a[238:239], v17 offset:27712
s_waitcnt lgkmcnt(0)
ds_read_b64_tr_b16 a[240:241], v17 offset:28672
ds_read_b64_tr_b16 a[242:243], v17 offset:30720
ds_read_b64_tr_b16 a[244:245], v17 offset:28736
ds_read_b64_tr_b16 a[246:247], v17 offset:30784
ds_read_b64_tr_b16 a[248:249], v17 offset:29696
ds_read_b64_tr_b16 a[250:251], v17 offset:31744
ds_read_b64_tr_b16 a[252:253], v17 offset:29760
ds_read_b64_tr_b16 a[254:255], v17 offset:31808
s_waitcnt lgkmcnt(0)
s_barrier
s_cmp_eq_u32 s68, 1
s_cbranch_scc1 mega_kernel_back
mega_kernel_o_hw:
s_lshl_b32 s56, s56, 6
s_lshl_b32 s43, s58, 17
s_lshl_b32 s44, s41, 15
s_add_u32 s43, s43, s44
s_add_u32 s43, s43, 134217728
v_add_u32 v6, s43, v5
v_and_b32 v2, 3, v1
v_lshlrev_b32 v7, 2, v2
v_bfe_u32 v2, v1, 2, 2
v_lshl_add_u32 v7, v2, 7, v7
s_lshl_b32 s43, s58, 11
s_lshl_b32 s44, s41, 9
s_add_u32 s43, s43, s44
s_lshl_b32 s44, s98, 13
s_add_u32 s43, s43, s44
s_add_u32 s43, s43, 69255168
v_add_u32 v7, s43, v7
s_mul_i32 s43, s41, 8704
v_lshrrev_b32 v2, 5, v1
v_lshl_add_u32 v8, v2, 5, v5
v_add_u32 v8, s43, v8
v_and_b32 v2, 7, v1
v_mul_u32_u24 v9, 544, v2
v_lshrrev_b32 v3, 3, v1
v_lshl_add_u32 v9, v3, 4, v9
s_lshl_b32 s43, s41, 7
v_add_u32 v9, s43, v9
s_mul_i32 s43, s58, 4352
s_sub_u32 s44, 4352, s43
v_add_u32 v10, s44, v9
v_add_u32 v9, s43, v9
s_lshl_b32 s43, s41, 15
s_lshl_b32 s44, s40, 6
s_add_u32 s43, s43, s44
v_lshlrev_b32 v11, 12, v3
v_and_b32 v2, 7, v1
v_lshl_add_u32 v11, v2, 3, v11
v_add_u32 v11, s43, v11
s_lshl_b32 s44, s41, 10
s_add_u32 s43, s66, s44
v_add_u32 v13, s43, v5
v_xor_b32 v12, 8192, v13
s_lshl_b32 s71, 1, s67
s_mov_b32 s42, s64
s_mov_b32 s52, 0
s_mov_b32 s53, 0
s_mov_b32 s57, 0
mega_kernel_o_cold:
s_cmp_gt_i32 s52, s42
s_cbranch_scc1 mega_kernel_o_fk
mega_kernel_o_fw:
buffer_load_dword v2, v7, s[84:87], 0 offen sc1
s_waitcnt vmcnt(0)
v_min_i32_dpp v2, v2, v2 quad_perm:[1,0,3,2] row_mask:0xf bank_mask:0xf
s_nop 1
v_min_i32_dpp v2, v2, v2 quad_perm:[2,3,0,1] row_mask:0xf bank_mask:0xf
s_nop 1
v_min_i32_dpp v2, v2, v2 row_ror:4 row_mask:0xf bank_mask:0xf
s_nop 1
v_min_i32_dpp v2, v2, v2 row_ror:8 row_mask:0xf bank_mask:0xf
s_nop 0
v_readfirstlane_b32 s52, v2
s_min_i32 s52, s52, s65
s_cmp_gt_i32 s52, s42
s_cbranch_scc1 mega_kernel_o_fk
s_sleep 2
s_add_u32 s43, s52, 2
s_cmp_gt_i32 s43, s42
s_cbranch_scc1 mega_kernel_o_fw
s_sleep 48
s_branch mega_kernel_o_fw
mega_kernel_o_fk:
s_add_u32 s54, s42, s71
s_cmp_gt_i32 s52, s54
s_cbranch_scc0 mega_kernel_o_c0
s_lshl_b32 s50, s42, 18
s_add_u32 s51, s56, 0
s_and_b32 s51, s51, 0x7fff
s_add_u32 s51, s51, s50
buffer_load_dwordx4 v[96:99], v6, s[84:87], s51 offen offset:0 sc1
buffer_load_dwordx4 v[100:103], v6, s[84:87], s51 offen offset:1024 sc1
buffer_load_dwordx4 v[104:107], v6, s[84:87], s51 offen offset:2048 sc1
buffer_load_dwordx4 v[108:111], v6, s[84:87], s51 offen offset:3072 sc1
s_add_u32 s51, s56, 4096
s_and_b32 s51, s51, 0x7fff
s_add_u32 s51, s51, s50
buffer_load_dwordx4 v[112:115], v6, s[84:87], s51 offen offset:0 sc1
buffer_load_dwordx4 v[116:119], v6, s[84:87], s51 offen offset:1024 sc1
buffer_load_dwordx4 v[120:123], v6, s[84:87], s51 offen offset:2048 sc1
buffer_load_dwordx4 v[124:127], v6, s[84:87], s51 offen offset:3072 sc1
s_add_u32 s51, s56, 8192
s_and_b32 s51, s51, 0x7fff
s_add_u32 s51, s51, s50
buffer_load_dwordx4 v[128:131], v6, s[84:87], s51 offen offset:0 sc1
buffer_load_dwordx4 v[132:135], v6, s[84:87], s51 offen offset:1024 sc1
buffer_load_dwordx4 v[136:139], v6, s[84:87], s51 offen offset:2048 sc1
buffer_load_dwordx4 v[140:143], v6, s[84:87], s51 offen offset:3072 sc1
s_add_u32 s51, s56, 12288
s_and_b32 s51, s51, 0x7fff
s_add_u32 s51, s51, s50
buffer_load_dwordx4 v[144:147], v6, s[84:87], s51 offen offset:0 sc1
buffer_load_dwordx4 v[148:151], v6, s[84:87], s51 offen offset:1024 sc1
buffer_load_dwordx4 v[152:155], v6, s[84:87], s51 offen offset:2048 sc1
buffer_load_dwordx4 v[156:159], v6, s[84:87], s51 offen offset:3072 sc1
s_add_u32 s51, s56, 16384
s_and_b32 s51, s51, 0x7fff
s_add_u32 s51, s51, s50
buffer_load_dwordx4 v[160:163], v6, s[84:87], s51 offen offset:0 sc1
buffer_load_dwordx4 v[164:167], v6, s[84:87], s51 offen offset:1024 sc1
buffer_load_dwordx4 v[168:171], v6, s[84:87], s51 offen offset:2048 sc1
buffer_load_dwordx4 v[172:175], v6, s[84:87], s51 offen offset:3072 sc1
s_add_u32 s51, s56, 20480
s_and_b32 s51, s51, 0x7fff
s_add_u32 s51, s51, s50
buffer_load_dwordx4 v[176:179], v6, s[84:87], s51 offen offset:0 sc1
buffer_load_dwordx4 v[180:183], v6, s[84:87], s51 offen offset:1024 sc1
buffer_load_dwordx4 v[184:187], v6, s[84:87], s51 offen offset:2048 sc1
buffer_load_dwordx4 v[188:191], v6, s[84:87], s51 offen offset:3072 sc1
s_add_u32 s51, s56, 24576
s_and_b32 s51, s51, 0x7fff
s_add_u32 s51, s51, s50
buffer_load_dwordx4 v[192:195], v6, s[84:87], s51 offen offset:0 sc1
buffer_load_dwordx4 v[196:199], v6, s[84:87], s51 offen offset:1024 sc1
buffer_load_dwordx4 v[200:203], v6, s[84:87], s51 offen offset:2048 sc1
buffer_load_dwordx4 v[204:207], v6, s[84:87], s51 offen offset:3072 sc1
s_add_u32 s51, s56, 28672
s_and_b32 s51, s51, 0x7fff
s_add_u32 s51, s51, s50
buffer_load_dwordx4 v[208:211], v6, s[84:87], s51 offen offset:0 sc1
buffer_load_dwordx4 v[212:215], v6, s[84:87], s51 offen offset:1024 sc1
buffer_load_dwordx4 v[216:219], v6, s[84:87], s51 offen offset:2048 sc1
buffer_load_dwordx4 v[220:223], v6, s[84:87], s51 offen offset:3072 sc1
mega_kernel_o_w0:
s_add_u32 s54, s42, s71
s_sub_u32 s62, s42, s71
s_lshl_b32 s50, s54, 18
s_cmp_gt_i32 s52, s54
s_cbranch_scc0 mega_kernel_o_n0
s_waitcnt vmcnt(31)
v_mfma_f32_32x32x16_bf16 v[20:35], a[0:3], v[96:99], 0
v_mfma_f32_32x32x16_bf16 v[36:51], a[4:7], v[96:99], 0
s_add_u32 s51, s56, 0
s_and_b32 s51, s51, 0x7fff
s_add_u32 s51, s51, s50
buffer_load_dwordx4 v[96:99], v6, s[84:87], s51 offen offset:0 sc1
s_waitcnt vmcnt(31)
v_mfma_f32_32x32x16_bf16 v[20:35], a[8:11], v[100:103], v[20:35]
v_mfma_f32_32x32x16_bf16 v[36:51], a[12:15], v[100:103], v[36:51]
buffer_load_dwordx4 v[100:103], v6, s[84:87], s51 offen offset:1024 sc1
s_waitcnt vmcnt(31)
v_mfma_f32_32x32x16_bf16 v[20:35], a[16:19], v[104:107], v[20:35]
v_mfma_f32_32x32x16_bf16 v[36:51], a[20:23], v[104:107], v[36:51]
buffer_load_dwordx4 v[104:107], v6, s[84:87], s51 offen offset:2048 sc1
s_waitcnt vmcnt(31)
v_mfma_f32_32x32x16_bf16 v[20:35], a[24:27], v[108:111], v[20:35]
v_mfma_f32_32x32x16_bf16 v[36:51], a[28:31], v[108:111], v[36:51]
buffer_load_dwordx4 v[108:111], v6, s[84:87], s51 offen offset:3072 sc1
s_waitcnt vmcnt(31)
v_mfma_f32_32x32x16_bf16 v[20:35], a[32:35], v[112:115], v[20:35]
v_mfma_f32_32x32x16_bf16 v[36:51], a[36:39], v[112:115], v[36:51]
s_add_u32 s51, s56, 4096
s_and_b32 s51, s51, 0x7fff
s_add_u32 s51, s51, s50
buffer_load_dwordx4 v[112:115], v6, s[84:87], s51 offen offset:0 sc1
s_waitcnt vmcnt(31)
v_mfma_f32_32x32x16_bf16 v[20:35], a[40:43], v[116:119], v[20:35]
v_mfma_f32_32x32x16_bf16 v[36:51], a[44:47], v[116:119], v[36:51]
buffer_load_dwordx4 v[116:119], v6, s[84:87], s51 offen offset:1024 sc1
s_waitcnt vmcnt(31)
v_mfma_f32_32x32x16_bf16 v[20:35], a[48:51], v[120:123], v[20:35]
v_mfma_f32_32x32x16_bf16 v[36:51], a[52:55], v[120:123], v[36:51]
buffer_load_dwordx4 v[120:123], v6, s[84:87], s51 offen offset:2048 sc1
s_waitcnt vmcnt(31)
v_mfma_f32_32x32x16_bf16 v[20:35], a[56:59], v[124:127], v[20:35]
v_mfma_f32_32x32x16_bf16 v[36:51], a[60:63], v[124:127], v[36:51]
buffer_load_dwordx4 v[124:127], v6, s[84:87], s51 offen offset:3072 sc1
s_waitcnt vmcnt(31)
v_mfma_f32_32x32x16_bf16 v[20:35], a[64:67], v[128:131], v[20:35]
v_mfma_f32_32x32x16_bf16 v[36:51], a[68:71], v[128:131], v[36:51]
s_add_u32 s51, s56, 8192
s_and_b32 s51, s51, 0x7fff
s_add_u32 s51, s51, s50
buffer_load_dwordx4 v[128:131], v6, s[84:87], s51 offen offset:0 sc1
s_waitcnt vmcnt(31)
v_mfma_f32_32x32x16_bf16 v[20:35], a[72:75], v[132:135], v[20:35]
v_mfma_f32_32x32x16_bf16 v[36:51], a[76:79], v[132:135], v[36:51]
buffer_load_dwordx4 v[132:135], v6, s[84:87], s51 offen offset:1024 sc1
s_waitcnt vmcnt(31)
v_mfma_f32_32x32x16_bf16 v[20:35], a[80:83], v[136:139], v[20:35]
v_mfma_f32_32x32x16_bf16 v[36:51], a[84:87], v[136:139], v[36:51]
buffer_load_dwordx4 v[136:139], v6, s[84:87], s51 offen offset:2048 sc1
s_waitcnt vmcnt(31)
v_mfma_f32_32x32x16_bf16 v[20:35], a[88:91], v[140:143], v[20:35]
v_mfma_f32_32x32x16_bf16 v[36:51], a[92:95], v[140:143], v[36:51]
buffer_load_dwordx4 v[140:143], v6, s[84:87], s51 offen offset:3072 sc1
s_waitcnt vmcnt(31)
v_mfma_f32_32x32x16_bf16 v[20:35], a[96:99], v[144:147], v[20:35]
v_mfma_f32_32x32x16_bf16 v[36:51], a[100:103], v[144:147], v[36:51]
s_add_u32 s51, s56, 12288
s_and_b32 s51, s51, 0x7fff
s_add_u32 s51, s51, s50
buffer_load_dwordx4 v[144:147], v6, s[84:87], s51 offen offset:0 sc1
s_waitcnt vmcnt(31)
v_mfma_f32_32x32x16_bf16 v[20:35], a[104:107], v[148:151], v[20:35]
v_mfma_f32_32x32x16_bf16 v[36:51], a[108:111], v[148:151], v[36:51]
buffer_load_dwordx4 v[148:151], v6, s[84:87], s51 offen offset:1024 sc1
s_waitcnt vmcnt(31)
v_mfma_f32_32x32x16_bf16 v[20:35], a[112:115], v[152:155], v[20:35]
v_mfma_f32_32x32x16_bf16 v[36:51], a[116:119], v[152:155], v[36:51]
buffer_load_dwordx4 v[152:155], v6, s[84:87], s51 offen offset:2048 sc1
s_waitcnt vmcnt(31)
v_mfma_f32_32x32x16_bf16 v[20:35], a[120:123], v[156:159], v[20:35]
v_mfma_f32_32x32x16_bf16 v[36:51], a[124:127], v[156:159], v[36:51]
buffer_load_dwordx4 v[156:159], v6, s[84:87], s51 offen offset:3072 sc1
s_waitcnt vmcnt(31)
v_mfma_f32_32x32x16_bf16 v[20:35], a[128:131], v[160:163], v[20:35]
v_mfma_f32_32x32x16_bf16 v[36:51], a[132:135], v[160:163], v[36:51]
s_add_u32 s51, s56, 16384
s_and_b32 s51, s51, 0x7fff
s_add_u32 s51, s51, s50
buffer_load_dwordx4 v[160:163], v6, s[84:87], s51 offen offset:0 sc1
s_waitcnt vmcnt(31)
v_mfma_f32_32x32x16_bf16 v[20:35], a[136:139], v[164:167], v[20:35]
v_mfma_f32_32x32x16_bf16 v[36:51], a[140:143], v[164:167], v[36:51]
buffer_load_dwordx4 v[164:167], v6, s[84:87], s51 offen offset:1024 sc1
s_waitcnt vmcnt(31)
v_mfma_f32_32x32x16_bf16 v[20:35], a[144:147], v[168:171], v[20:35]
v_mfma_f32_32x32x16_bf16 v[36:51], a[148:151], v[168:171], v[36:51]
buffer_load_dwordx4 v[168:171], v6, s[84:87], s51 offen offset:2048 sc1
s_waitcnt vmcnt(31)
v_mfma_f32_32x32x16_bf16 v[20:35], a[152:155], v[172:175], v[20:35]
v_mfma_f32_32x32x16_bf16 v[36:51], a[156:159], v[172:175], v[36:51]
buffer_load_dwordx4 v[172:175], v6, s[84:87], s51 offen offset:3072 sc1
s_waitcnt vmcnt(31)
v_mfma_f32_32x32x16_bf16 v[20:35], a[160:163], v[176:179], v[20:35]
v_mfma_f32_32x32x16_bf16 v[36:51], a[164:167], v[176:179], v[36:51]
s_add_u32 s51, s56, 20480
s_and_b32 s51, s51, 0x7fff
s_add_u32 s51, s51, s50
buffer_load_dwordx4 v[176:179], v6, s[84:87], s51 offen offset:0 sc1
s_waitcnt vmcnt(31)
v_mfma_f32_32x32x16_bf16 v[20:35], a[168:171], v[180:183], v[20:35]
v_mfma_f32_32x32x16_bf16 v[36:51], a[172:175], v[180:183], v[36:51]
buffer_load_dwordx4 v[180:183], v6, s[84:87], s51 offen offset:1024 sc1
s_waitcnt vmcnt(31)
v_mfma_f32_32x32x16_bf16 v[20:35], a[176:179], v[184:187], v[20:35]
v_mfma_f32_32x32x16_bf16 v[36:51], a[180:183], v[184:187], v[36:51]
buffer_load_dwordx4 v[184:187], v6, s[84:87], s51 offen offset:2048 sc1
s_waitcnt vmcnt(31)
v_mfma_f32_32x32x16_bf16 v[20:35], a[184:187], v[188:191], v[20:35]
v_mfma_f32_32x32x16_bf16 v[36:51], a[188:191], v[188:191], v[36:51]
buffer_load_dwordx4 v[188:191], v6, s[84:87], s51 offen offset:3072 sc1
s_waitcnt vmcnt(31)
v_mfma_f32_32x32x16_bf16 v[20:35], a[192:195], v[192:195], v[20:35]
v_mfma_f32_32x32x16_bf16 v[36:51], a[196:199], v[192:195], v[36:51]
s_add_u32 s51, s56, 24576
s_and_b32 s51, s51, 0x7fff
s_add_u32 s51, s51, s50
buffer_load_dwordx4 v[192:195], v6, s[84:87], s51 offen offset:0 sc1
s_waitcnt vmcnt(31)
v_mfma_f32_32x32x16_bf16 v[20:35], a[200:203], v[196:199], v[20:35]
v_mfma_f32_32x32x16_bf16 v[36:51], a[204:207], v[196:199], v[36:51]
buffer_load_dwordx4 v[196:199], v6, s[84:87], s51 offen offset:1024 sc1
s_waitcnt vmcnt(31)
v_mfma_f32_32x32x16_bf16 v[20:35], a[208:211], v[200:203], v[20:35]
v_mfma_f32_32x32x16_bf16 v[36:51], a[212:215], v[200:203], v[36:51]
buffer_load_dwordx4 v[200:203], v6, s[84:87], s51 offen offset:2048 sc1
s_waitcnt vmcnt(31)
v_mfma_f32_32x32x16_bf16 v[20:35], a[216:219], v[204:207], v[20:35]
v_mfma_f32_32x32x16_bf16 v[36:51], a[220:223], v[204:207], v[36:51]
buffer_load_dwordx4 v[204:207], v6, s[84:87], s51 offen offset:3072 sc1
s_waitcnt vmcnt(31)
v_mfma_f32_32x32x16_bf16 v[20:35], a[224:227], v[208:211], v[20:35]
v_mfma_f32_32x32x16_bf16 v[36:51], a[228:231], v[208:211], v[36:51]
s_add_u32 s51, s56, 28672
s_and_b32 s51, s51, 0x7fff
s_add_u32 s51, s51, s50
buffer_load_dwordx4 v[208:211], v6, s[84:87], s51 offen offset:0 sc1
s_waitcnt vmcnt(31)
v_mfma_f32_32x32x16_bf16 v[20:35], a[232:235], v[212:215], v[20:35]
v_mfma_f32_32x32x16_bf16 v[36:51], a[236:239], v[212:215], v[36:51]
buffer_load_dwordx4 v[212:215], v6, s[84:87], s51 offen offset:1024 sc1
s_waitcnt vmcnt(31)
v_mfma_f32_32x32x16_bf16 v[20:35], a[240:243], v[216:219], v[20:35]
v_mfma_f32_32x32x16_bf16 v[36:51], a[244:247], v[216:219], v[36:51]
buffer_load_dwordx4 v[216:219], v6, s[84:87], s51 offen offset:2048 sc1
s_waitcnt vmcnt(31)
v_mfma_f32_32x32x16_bf16 v[224:239], a[248:251], v[220:223], v[20:35]
v_mfma_f32_32x32x16_bf16 v[240:255], a[252:255], v[220:223], v[36:51]
buffer_load_dwordx4 v[220:223], v6, s[84:87], s51 offen offset:3072 sc1
s_add_u32 s42, s42, s71
s_branch mega_kernel_o_w1
mega_kernel_o_n0:
s_waitcnt vmcnt(31)
v_mfma_f32_32x32x16_bf16 v[20:35], a[0:3], v[96:99], 0
v_mfma_f32_32x32x16_bf16 v[36:51], a[4:7], v[96:99], 0
s_waitcnt vmcnt(30)
v_mfma_f32_32x32x16_bf16 v[20:35], a[8:11], v[100:103], v[20:35]
v_mfma_f32_32x32x16_bf16 v[36:51], a[12:15], v[100:103], v[36:51]
s_waitcnt vmcnt(29)
v_mfma_f32_32x32x16_bf16 v[20:35], a[16:19], v[104:107], v[20:35]
v_mfma_f32_32x32x16_bf16 v[36:51], a[20:23], v[104:107], v[36:51]
s_waitcnt vmcnt(28)
v_mfma_f32_32x32x16_bf16 v[20:35], a[24:27], v[108:111], v[20:35]
v_mfma_f32_32x32x16_bf16 v[36:51], a[28:31], v[108:111], v[36:51]
s_waitcnt vmcnt(27)
v_mfma_f32_32x32x16_bf16 v[20:35], a[32:35], v[112:115], v[20:35]
v_mfma_f32_32x32x16_bf16 v[36:51], a[36:39], v[112:115], v[36:51]
s_waitcnt vmcnt(26)
v_mfma_f32_32x32x16_bf16 v[20:35], a[40:43], v[116:119], v[20:35]
v_mfma_f32_32x32x16_bf16 v[36:51], a[44:47], v[116:119], v[36:51]
s_waitcnt vmcnt(25)
v_mfma_f32_32x32x16_bf16 v[20:35], a[48:51], v[120:123], v[20:35]
v_mfma_f32_32x32x16_bf16 v[36:51], a[52:55], v[120:123], v[36:51]
s_waitcnt vmcnt(24)
v_mfma_f32_32x32x16_bf16 v[20:35], a[56:59], v[124:127], v[20:35]
v_mfma_f32_32x32x16_bf16 v[36:51], a[60:63], v[124:127], v[36:51]
s_waitcnt vmcnt(23)
v_mfma_f32_32x32x16_bf16 v[20:35], a[64:67], v[128:131], v[20:35]
v_mfma_f32_32x32x16_bf16 v[36:51], a[68:71], v[128:131], v[36:51]
s_waitcnt vmcnt(22)
v_mfma_f32_32x32x16_bf16 v[20:35], a[72:75], v[132:135], v[20:35]
v_mfma_f32_32x32x16_bf16 v[36:51], a[76:79], v[132:135], v[36:51]
s_waitcnt vmcnt(21)
v_mfma_f32_32x32x16_bf16 v[20:35], a[80:83], v[136:139], v[20:35]
v_mfma_f32_32x32x16_bf16 v[36:51], a[84:87], v[136:139], v[36:51]
s_waitcnt vmcnt(20)
v_mfma_f32_32x32x16_bf16 v[20:35], a[88:91], v[140:143], v[20:35]
v_mfma_f32_32x32x16_bf16 v[36:51], a[92:95], v[140:143], v[36:51]
s_waitcnt vmcnt(19)
v_mfma_f32_32x32x16_bf16 v[20:35], a[96:99], v[144:147], v[20:35]
v_mfma_f32_32x32x16_bf16 v[36:51], a[100:103], v[144:147], v[36:51]
s_waitcnt vmcnt(18)
v_mfma_f32_32x32x16_bf16 v[20:35], a[104:107], v[148:151], v[20:35]
v_mfma_f32_32x32x16_bf16 v[36:51], a[108:111], v[148:151], v[36:51]
s_waitcnt vmcnt(17)
v_mfma_f32_32x32x16_bf16 v[20:35], a[112:115], v[152:155], v[20:35]
v_mfma_f32_32x32x16_bf16 v[36:51], a[116:119], v[152:155], v[36:51]
s_waitcnt vmcnt(16)
v_mfma_f32_32x32x16_bf16 v[20:35], a[120:123], v[156:159], v[20:35]
v_mfma_f32_32x32x16_bf16 v[36:51], a[124:127], v[156:159], v[36:51]
s_waitcnt vmcnt(15)
v_mfma_f32_32x32x16_bf16 v[20:35], a[128:131], v[160:163], v[20:35]
v_mfma_f32_32x32x16_bf16 v[36:51], a[132:135], v[160:163], v[36:51]
s_waitcnt vmcnt(14)
v_mfma_f32_32x32x16_bf16 v[20:35], a[136:139], v[164:167], v[20:35]
v_mfma_f32_32x32x16_bf16 v[36:51], a[140:143], v[164:167], v[36:51]
s_waitcnt vmcnt(13)
v_mfma_f32_32x32x16_bf16 v[20:35], a[144:147], v[168:171], v[20:35]
v_mfma_f32_32x32x16_bf16 v[36:51], a[148:151], v[168:171], v[36:51]
s_waitcnt vmcnt(12)
v_mfma_f32_32x32x16_bf16 v[20:35], a[152:155], v[172:175], v[20:35]
v_mfma_f32_32x32x16_bf16 v[36:51], a[156:159], v[172:175], v[36:51]
s_waitcnt vmcnt(11)
v_mfma_f32_32x32x16_bf16 v[20:35], a[160:163], v[176:179], v[20:35]
v_mfma_f32_32x32x16_bf16 v[36:51], a[164:167], v[176:179], v[36:51]
buffer_load_dword v15, v7, s[84:87], 0 offen sc1
s_waitcnt vmcnt(10)
v_mfma_f32_32x32x16_bf16 v[20:35], a[168:171], v[180:183], v[20:35]
v_mfma_f32_32x32x16_bf16 v[36:51], a[172:175], v[180:183], v[36:51]
s_waitcnt vmcnt(9)
v_mfma_f32_32x32x16_bf16 v[20:35], a[176:179], v[184:187], v[20:35]
v_mfma_f32_32x32x16_bf16 v[36:51], a[180:183], v[184:187], v[36:51]
s_waitcnt vmcnt(8)
v_mfma_f32_32x32x16_bf16 v[20:35], a[184:187], v[188:191], v[20:35]
v_mfma_f32_32x32x16_bf16 v[36:51], a[188:191], v[188:191], v[36:51]
s_waitcnt vmcnt(7)
v_mfma_f32_32x32x16_bf16 v[20:35], a[192:195], v[192:195], v[20:35]
v_mfma_f32_32x32x16_bf16 v[36:51], a[196:199], v[192:195], v[36:51]
s_waitcnt vmcnt(6)
v_mfma_f32_32x32x16_bf16 v[20:35], a[200:203], v[196:199], v[20:35]
v_mfma_f32_32x32x16_bf16 v[36:51], a[204:207], v[196:199], v[36:51]
s_waitcnt vmcnt(5)
v_mfma_f32_32x32x16_bf16 v[20:35], a[208:211], v[200:203], v[20:35]
v_mfma_f32_32x32x16_bf16 v[36:51], a[212:215], v[200:203], v[36:51]
s_waitcnt vmcnt(4)
v_mfma_f32_32x32x16_bf16 v[20:35], a[216:219], v[204:207], v[20:35]
v_mfma_f32_32x32x16_bf16 v[36:51], a[220:223], v[204:207], v[36:51]
s_waitcnt vmcnt(3)
v_mfma_f32_32x32x16_bf16 v[20:35], a[224:227], v[208:211], v[20:35]
v_mfma_f32_32x32x16_bf16 v[36:51], a[228:231], v[208:211], v[36:51]
s_waitcnt vmcnt(2)
v_mfma_f32_32x32x16_bf16 v[20:35], a[232:235], v[212:215], v[20:35]
v_mfma_f32_32x32x16_bf16 v[36:51], a[236:239], v[212:215], v[36:51]
s_waitcnt vmcnt(1)
v_mfma_f32_32x32x16_bf16 v[20:35], a[240:243], v[216:219], v[20:35]
v_mfma_f32_32x32x16_bf16 v[36:51], a[244:247], v[216:219], v[36:51]
s_waitcnt vmcnt(0)
v_mfma_f32_32x32x16_bf16 v[224:239], a[248:251], v[220:223], v[20:35]
v_mfma_f32_32x32x16_bf16 v[240:255], a[252:255], v[220:223], v[36:51]
s_branch mega_kernel_o_imm
mega_kernel_o_w1:
s_add_u32 s54, s42, s71
s_sub_u32 s62, s42, s71
s_lshl_b32 s50, s54, 18
s_cmp_gt_i32 s52, s54
s_cbranch_scc0 mega_kernel_o_n1
s_waitcnt vmcnt(31)
v_mfma_f32_32x32x16_bf16 v[20:35], a[0:3], v[96:99], 0
v_mfma_f32_32x32x16_bf16 v[36:51], a[4:7], v[96:99], 0
s_add_u32 s51, s56, 0
s_and_b32 s51, s51, 0x7fff
s_add_u32 s51, s51, s50
buffer_load_dwordx4 v[96:99], v6, s[84:87], s51 offen offset:0 sc1
s_waitcnt vmcnt(31)
v_mfma_f32_32x32x16_bf16 v[20:35], a[8:11], v[100:103], v[20:35]
v_mfma_f32_32x32x16_bf16 v[36:51], a[12:15], v[100:103], v[36:51]
buffer_load_dwordx4 v[100:103], v6, s[84:87], s51 offen offset:1024 sc1
v_add_u32 v2, s53, v8
v_add_u32 v3, s53, v9
v_add_u32 v4, s53, v10
s_waitcnt vmcnt(31)
v_mfma_f32_32x32x16_bf16 v[20:35], a[16:19], v[104:107], v[20:35]
v_mfma_f32_32x32x16_bf16 v[36:51], a[20:23], v[104:107], v[36:51]
buffer_load_dwordx4 v[104:107], v6, s[84:87], s51 offen offset:2048 sc1
ds_write_b128 v2, v[224:227] offset:0
ds_write_b128 v2, v[228:231] offset:1088
s_waitcnt vmcnt(31)
v_mfma_f32_32x32x16_bf16 v[20:35], a[24:27], v[108:111], v[20:35]
v_mfma_f32_32x32x16_bf16 v[36:51], a[28:31], v[108:111], v[36:51]
buffer_load_dwordx4 v[108:111], v6, s[84:87], s51 offen offset:3072 sc1
ds_write_b128 v2, v[232:235] offset:2176
ds_write_b128 v2, v[236:239] offset:3264
s_waitcnt vmcnt(31)
v_mfma_f32_32x32x16_bf16 v[20:35], a[32:35], v[112:115], v[20:35]
v_mfma_f32_32x32x16_bf16 v[36:51], a[36:39], v[112:115], v[36:51]
s_add_u32 s51, s56, 4096
s_and_b32 s51, s51, 0x7fff
s_add_u32 s51, s51, s50
buffer_load_dwordx4 v[112:115], v6, s[84:87], s51 offen offset:0 sc1
ds_write_b128 v2, v[240:243] offset:4352
ds_write_b128 v2, v[244:247] offset:5440
s_waitcnt vmcnt(31)
v_mfma_f32_32x32x16_bf16 v[20:35], a[40:43], v[116:119], v[20:35]
v_mfma_f32_32x32x16_bf16 v[36:51], a[44:47], v[116:119], v[36:51]
buffer_load_dwordx4 v[116:119], v6, s[84:87], s51 offen offset:1024 sc1
ds_write_b128 v2, v[248:251] offset:6528
ds_write_b128 v2, v[252:255] offset:7616
s_waitcnt vmcnt(31)
v_mfma_f32_32x32x16_bf16 v[20:35], a[48:51], v[120:123], v[20:35]
v_mfma_f32_32x32x16_bf16 v[36:51], a[52:55], v[120:123], v[36:51]
buffer_load_dwordx4 v[120:123], v6, s[84:87], s51 offen offset:2048 sc1
s_waitcnt vmcnt(31)
v_mfma_f32_32x32x16_bf16 v[20:35], a[56:59], v[124:127], v[20:35]
v_mfma_f32_32x32x16_bf16 v[36:51], a[60:63], v[124:127], v[36:51]
buffer_load_dwordx4 v[124:127], v6, s[84:87], s51 offen offset:3072 sc1
s_waitcnt lgkmcnt(0)
s_barrier
ds_read_b128 v[52:55], v4 offset:0
ds_read_b128 v[56:59], v4 offset:8704
ds_read_b128 v[60:63], v4 offset:17408
ds_read_b128 v[64:67], v4 offset:26112
s_waitcnt vmcnt(31)
v_mfma_f32_32x32x16_bf16 v[20:35], a[64:67], v[128:131], v[20:35]
v_mfma_f32_32x32x16_bf16 v[36:51], a[68:71], v[128:131], v[36:51]
s_add_u32 s51, s56, 8192
s_and_b32 s51, s51, 0x7fff
s_add_u32 s51, s51, s50
buffer_load_dwordx4 v[128:131], v6, s[84:87], s51 offen offset:0 sc1
ds_read_b128 v[68:71], v3 offset:0
ds_read_b128 v[72:75], v3 offset:8704
ds_read_b128 v[76:79], v3 offset:17408
ds_read_b128 v[80:83], v3 offset:26112
s_sub_u32 s53, 34816, s53
s_sub_u32 s60, s62, s64
s_lshr_b32 s60, s60, s67
s_bfe_u32 s61, s60, 0x10001
s_and_b32 s60, s60, 1
s_lshl_b32 s60, s60, 12
s_waitcnt vmcnt(31)
v_mfma_f32_32x32x16_bf16 v[20:35], a[72:75], v[132:135], v[20:35]
v_mfma_f32_32x32x16_bf16 v[36:51], a[76:79], v[132:135], v[36:51]
buffer_load_dwordx4 v[132:135], v6, s[84:87], s51 offen offset:1024 sc1
s_waitcnt vmcnt(31)
v_mfma_f32_32x32x16_bf16 v[20:35], a[80:83], v[136:139], v[20:35]
v_mfma_f32_32x32x16_bf16 v[36:51], a[84:87], v[136:139], v[36:51]
buffer_load_dwordx4 v[136:139], v6, s[84:87], s51 offen offset:2048 sc1
s_waitcnt lgkmcnt(4)
v_add_f32 v52, v52, v56
v_add_f32 v60, v60, v64
v_add_f32 v53, v53, v57
v_add_f32 v61, v61, v65
v_add_f32 v54, v54, v58
v_add_f32 v62, v62, v66
v_add_f32 v55, v55, v59
v_add_f32 v63, v63, v67
s_waitcnt vmcnt(31)
v_mfma_f32_32x32x16_bf16 v[20:35], a[88:91], v[140:143], v[20:35]
v_mfma_f32_32x32x16_bf16 v[36:51], a[92:95], v[140:143], v[36:51]
buffer_load_dwordx4 v[140:143], v6, s[84:87], s51 offen offset:3072 sc1
v_add_f32 v52, v52, v60
v_add_f32 v53, v53, v61
v_add_f32 v54, v54, v62
v_add_f32 v55, v55, v63
v_and_or_b32 v52, v52, -2, s61
s_cmp_eq_u32 s95, 0
s_cbranch_scc1 mega_kernel_o_sa1
buffer_store_dwordx4 v[52:55], v12, s[84:87], s60 offen sc1
s_branch mega_kernel_o_sb1
mega_kernel_o_sa1:
buffer_store_dwordx4 v[52:55], v12, s[84:87], s60 offen
mega_kernel_o_sb1:
s_waitcnt vmcnt(31)
v_mfma_f32_32x32x16_bf16 v[20:35], a[96:99], v[144:147], v[20:35]
v_mfma_f32_32x32x16_bf16 v[36:51], a[100:103], v[144:147], v[36:51]
s_add_u32 s51, s56, 12288
s_and_b32 s51, s51, 0x7fff
s_add_u32 s51, s51, s50
buffer_load_dwordx4 v[144:147], v6, s[84:87], s51 offen offset:0 sc1
s_waitcnt lgkmcnt(0)
v_add_f32 v68, v68, v72
v_add_f32 v76, v76, v80
v_add_f32 v69, v69, v73
v_add_f32 v77, v77, v81
v_add_f32 v70, v70, v74
v_add_f32 v78, v78, v82
v_add_f32 v71, v71, v75
v_add_f32 v79, v79, v83
s_waitcnt vmcnt(31)
v_mfma_f32_32x32x16_bf16 v[20:35], a[104:107], v[148:151], v[20:35]
v_mfma_f32_32x32x16_bf16 v[36:51], a[108:111], v[148:151], v[36:51]
buffer_load_dwordx4 v[148:151], v6, s[84:87], s51 offen offset:1024 sc1
v_add_f32 v84, v68, v76
v_add_f32 v85, v69, v77
v_add_f32 v86, v70, v78
v_add_f32 v87, v71, v79
s_waitcnt vmcnt(31)
v_mfma_f32_32x32x16_bf16 v[20:35], a[112:115], v[152:155], v[20:35]
v_mfma_f32_32x32x16_bf16 v[36:51], a[116:119], v[152:155], v[36:51]
buffer_load_dwordx4 v[152:155], v6, s[84:87], s51 offen offset:2048 sc1
s_waitcnt vmcnt(31)
v_mfma_f32_32x32x16_bf16 v[20:35], a[120:123], v[156:159], v[20:35]
v_mfma_f32_32x32x16_bf16 v[36:51], a[124:127], v[156:159], v[36:51]
buffer_load_dwordx4 v[156:159], v6, s[84:87], s51 offen offset:3072 sc1
s_waitcnt vmcnt(31)
v_mfma_f32_32x32x16_bf16 v[20:35], a[128:131], v[160:163], v[20:35]
v_mfma_f32_32x32x16_bf16 v[36:51], a[132:135], v[160:163], v[36:51]
s_add_u32 s51, s56, 16384
s_and_b32 s51, s51, 0x7fff
s_add_u32 s51, s51, s50
buffer_load_dwordx4 v[160:163], v6, s[84:87], s51 offen offset:0 sc1
s_waitcnt vmcnt(31)
v_mfma_f32_32x32x16_bf16 v[20:35], a[136:139], v[164:167], v[20:35]
v_mfma_f32_32x32x16_bf16 v[36:51], a[140:143], v[164:167], v[36:51]
buffer_load_dwordx4 v[164:167], v6, s[84:87], s51 offen offset:1024 sc1
s_waitcnt vmcnt(31)
v_mfma_f32_32x32x16_bf16 v[20:35], a[144:147], v[168:171], v[20:35]
v_mfma_f32_32x32x16_bf16 v[36:51], a[148:151], v[168:171], v[36:51]
buffer_load_dwordx4 v[168:171], v6, s[84:87], s51 offen offset:2048 sc1
s_waitcnt vmcnt(31)
v_mfma_f32_32x32x16_bf16 v[20:35], a[152:155], v[172:175], v[20:35]
v_mfma_f32_32x32x16_bf16 v[36:51], a[156:159], v[172:175], v[36:51]
buffer_load_dwordx4 v[172:175], v6, s[84:87], s51 offen offset:3072 sc1
s_waitcnt vmcnt(31)
v_mfma_f32_32x32x16_bf16 v[20:35], a[160:163], v[176:179], v[20:35]
v_mfma_f32_32x32x16_bf16 v[36:51], a[164:167], v[176:179], v[36:51]
s_add_u32 s51, s56, 20480
s_and_b32 s51, s51, 0x7fff
s_add_u32 s51, s51, s50
buffer_load_dwordx4 v[176:179], v6, s[84:87], s51 offen offset:0 sc1
s_waitcnt vmcnt(31)
v_mfma_f32_32x32x16_bf16 v[20:35], a[168:171], v[180:183], v[20:35]
v_mfma_f32_32x32x16_bf16 v[36:51], a[172:175], v[180:183], v[36:51]
buffer_load_dwordx4 v[180:183], v6, s[84:87], s51 offen offset:1024 sc1
s_waitcnt vmcnt(31)
v_mfma_f32_32x32x16_bf16 v[20:35], a[176:179], v[184:187], v[20:35]
v_mfma_f32_32x32x16_bf16 v[36:51], a[180:183], v[184:187], v[36:51]
buffer_load_dwordx4 v[184:187], v6, s[84:87], s51 offen offset:2048 sc1
s_waitcnt vmcnt(31)
v_mfma_f32_32x32x16_bf16 v[20:35], a[184:187], v[188:191], v[20:35]
v_mfma_f32_32x32x16_bf16 v[36:51], a[188:191], v[188:191], v[36:51]
buffer_load_dwordx4 v[188:191], v6, s[84:87], s51 offen offset:3072 sc1
s_waitcnt vmcnt(31)
v_mfma_f32_32x32x16_bf16 v[20:35], a[192:195], v[192:195], v[20:35]
v_mfma_f32_32x32x16_bf16 v[36:51], a[196:199], v[192:195], v[36:51]
s_add_u32 s51, s56, 24576
s_and_b32 s51, s51, 0x7fff
s_add_u32 s51, s51, s50
buffer_load_dwordx4 v[192:195], v6, s[84:87], s51 offen offset:0 sc1
s_waitcnt vmcnt(31)
v_mfma_f32_32x32x16_bf16 v[20:35], a[200:203], v[196:199], v[20:35]
v_mfma_f32_32x32x16_bf16 v[36:51], a[204:207], v[196:199], v[36:51]
buffer_load_dwordx4 v[196:199], v6, s[84:87], s51 offen offset:1024 sc1
s_waitcnt vmcnt(31)
v_mfma_f32_32x32x16_bf16 v[20:35], a[208:211], v[200:203], v[20:35]
v_mfma_f32_32x32x16_bf16 v[36:51], a[212:215], v[200:203], v[36:51]
buffer_load_dwordx4 v[200:203], v6, s[84:87], s51 offen offset:2048 sc1
s_waitcnt vmcnt(31)
v_mfma_f32_32x32x16_bf16 v[20:35], a[216:219], v[204:207], v[20:35]
v_mfma_f32_32x32x16_bf16 v[36:51], a[220:223], v[204:207], v[36:51]
buffer_load_dwordx4 v[204:207], v6, s[84:87], s51 offen offset:3072 sc1
s_sub_u32 s60, s62, s64
s_lshr_b32 s60, s60, s67
s_bfe_u32 s61, s60, 0x10001
s_and_b32 s60, s60, 1
s_lshl_b32 s60, s60, 12
buffer_load_dwordx4 v[88:91], v13, s[84:87], s60 offen sc1
s_waitcnt vmcnt(31)
v_mfma_f32_32x32x16_bf16 v[20:35], a[224:227], v[208:211], v[20:35]
v_mfma_f32_32x32x16_bf16 v[36:51], a[228:231], v[208:211], v[36:51]
s_add_u32 s51, s56, 28672
s_and_b32 s51, s51, 0x7fff
s_add_u32 s51, s51, s50
buffer_load_dwordx4 v[208:211], v6, s[84:87], s51 offen offset:0 sc1
s_waitcnt vmcnt(31)
v_mfma_f32_32x32x16_bf16 v[20:35], a[232:235], v[212:215], v[20:35]
v_mfma_f32_32x32x16_bf16 v[36:51], a[236:239], v[212:215], v[36:51]
buffer_load_dwordx4 v[212:215], v6, s[84:87], s51 offen offset:1024 sc1
s_waitcnt vmcnt(31)
v_mfma_f32_32x32x16_bf16 v[20:35], a[240:243], v[216:219], v[20:35]
v_mfma_f32_32x32x16_bf16 v[36:51], a[244:247], v[216:219], v[36:51]
buffer_load_dwordx4 v[216:219], v6, s[84:87], s51 offen offset:2048 sc1
s_waitcnt vmcnt(31)
v_mfma_f32_32x32x16_bf16 v[224:239], a[248:251], v[220:223], v[20:35]
v_mfma_f32_32x32x16_bf16 v[240:255], a[252:255], v[220:223], v[36:51]
buffer_load_dwordx4 v[220:223], v6, s[84:87], s51 offen offset:3072 sc1
s_waitcnt vmcnt(4)
mega_kernel_o_f1c:
v_and_b32 v14, 1, v88
v_cmp_ne_u32 vcc, s61, v14
s_cbranch_vccz mega_kernel_o_f1k
s_sub_u32 s60, s62, s64
s_lshr_b32 s60, s60, s67
s_bfe_u32 s61, s60, 0x10001
s_and_b32 s60, s60, 1
s_lshl_b32 s60, s60, 12
buffer_load_dwordx4 v[88:91], v13, s[84:87], s60 offen sc1
s_waitcnt vmcnt(0)
s_branch mega_kernel_o_f1c
mega_kernel_o_f1k:
v_pk_add_f32 v[88:89], v[88:89], v[84:85]
v_pk_add_f32 v[90:91], v[90:91], v[86:87]
s_lshl_b32 s60, s62, 17
v_cvt_pk_bf16_f32 v92, v88, v89
v_cvt_pk_bf16_f32 v93, v90, v91
buffer_store_dwordx2 v[92:93], v11, s[8:11], s60 offen sc1
s_add_u32 s42, s42, s71
s_branch mega_kernel_o_w1
mega_kernel_o_n1:
s_waitcnt vmcnt(31)
v_mfma_f32_32x32x16_bf16 v[20:35], a[0:3], v[96:99], 0
v_mfma_f32_32x32x16_bf16 v[36:51], a[4:7], v[96:99], 0
s_waitcnt vmcnt(30)
v_mfma_f32_32x32x16_bf16 v[20:35], a[8:11], v[100:103], v[20:35]
v_mfma_f32_32x32x16_bf16 v[36:51], a[12:15], v[100:103], v[36:51]
v_add_u32 v2, s53, v8
v_add_u32 v3, s53, v9
v_add_u32 v4, s53, v10
s_waitcnt vmcnt(29)
v_mfma_f32_32x32x16_bf16 v[20:35], a[16:19], v[104:107], v[20:35]
v_mfma_f32_32x32x16_bf16 v[36:51], a[20:23], v[104:107], v[36:51]
ds_write_b128 v2, v[224:227] offset:0
ds_write_b128 v2, v[228:231] offset:1088
s_waitcnt vmcnt(28)
v_mfma_f32_32x32x16_bf16 v[20:35], a[24:27], v[108:111], v[20:35]
v_mfma_f32_32x32x16_bf16 v[36:51], a[28:31], v[108:111], v[36:51]
ds_write_b128 v2, v[232:235] offset:2176
ds_write_b128 v2, v[236:239] offset:3264
s_waitcnt vmcnt(27)
v_mfma_f32_32x32x16_bf16 v[20:35], a[32:35], v[112:115], v[20:35]
v_mfma_f32_32x32x16_bf16 v[36:51], a[36:39], v[112:115], v[36:51]
ds_write_b128 v2, v[240:243] offset:4352
ds_write_b128 v2, v[244:247] offset:5440
s_waitcnt vmcnt(26)
v_mfma_f32_32x32x16_bf16 v[20:35], a[40:43], v[116:119], v[20:35]
v_mfma_f32_32x32x16_bf16 v[36:51], a[44:47], v[116:119], v[36:51]
ds_write_b128 v2, v[248:251] offset:6528
ds_write_b128 v2, v[252:255] offset:7616
s_waitcnt vmcnt(25)
v_mfma_f32_32x32x16_bf16 v[20:35], a[48:51], v[120:123], v[20:35]
v_mfma_f32_32x32x16_bf16 v[36:51], a[52:55], v[120:123], v[36:51]
s_waitcnt vmcnt(24)
v_mfma_f32_32x32x16_bf16 v[20:35], a[56:59], v[124:127], v[20:35]
v_mfma_f32_32x32x16_bf16 v[36:51], a[60:63], v[124:127], v[36:51]
s_waitcnt lgkmcnt(0)
s_barrier
ds_read_b128 v[52:55], v4 offset:0
ds_read_b128 v[56:59], v4 offset:8704
ds_read_b128 v[60:63], v4 offset:17408
ds_read_b128 v[64:67], v4 offset:26112
s_waitcnt vmcnt(23)
v_mfma_f32_32x32x16_bf16 v[20:35], a[64:67], v[128:131], v[20:35]
v_mfma_f32_32x32x16_bf16 v[36:51], a[68:71], v[128:131], v[36:51]
ds_read_b128 v[68:71], v3 offset:0
ds_read_b128 v[72:75], v3 offset:8704
ds_read_b128 v[76:79], v3 offset:17408
ds_read_b128 v[80:83], v3 offset:26112
s_sub_u32 s53, 34816, s53
s_sub_u32 s60, s62, s64
s_lshr_b32 s60, s60, s67
s_bfe_u32 s61, s60, 0x10001
s_and_b32 s60, s60, 1
s_lshl_b32 s60, s60, 12
s_waitcnt vmcnt(22)
v_mfma_f32_32x32x16_bf16 v[20:35], a[72:75], v[132:135], v[20:35]
v_mfma_f32_32x32x16_bf16 v[36:51], a[76:79], v[132:135], v[36:51]
s_waitcnt vmcnt(21)
v_mfma_f32_32x32x16_bf16 v[20:35], a[80:83], v[136:139], v[20:35]
v_mfma_f32_32x32x16_bf16 v[36:51], a[84:87], v[136:139], v[36:51]
s_waitcnt lgkmcnt(4)
v_add_f32 v52, v52, v56
v_add_f32 v60, v60, v64
v_add_f32 v53, v53, v57
v_add_f32 v61, v61, v65
v_add_f32 v54, v54, v58
v_add_f32 v62, v62, v66
v_add_f32 v55, v55, v59
v_add_f32 v63, v63, v67
s_waitcnt vmcnt(20)
v_mfma_f32_32x32x16_bf16 v[20:35], a[88:91], v[140:143], v[20:35]
v_mfma_f32_32x32x16_bf16 v[36:51], a[92:95], v[140:143], v[36:51]
v_add_f32 v52, v52, v60
v_add_f32 v53, v53, v61
v_add_f32 v54, v54, v62
v_add_f32 v55, v55, v63
v_and_or_b32 v52, v52, -2, s61
s_cmp_eq_u32 s95, 0
s_cbranch_scc1 mega_kernel_o_sa2
buffer_store_dwordx4 v[52:55], v12, s[84:87], s60 offen sc1
s_branch mega_kernel_o_sb2
mega_kernel_o_sa2:
buffer_store_dwordx4 v[52:55], v12, s[84:87], s60 offen
mega_kernel_o_sb2:
s_waitcnt vmcnt(19)
v_mfma_f32_32x32x16_bf16 v[20:35], a[96:99], v[144:147], v[20:35]
v_mfma_f32_32x32x16_bf16 v[36:51], a[100:103], v[144:147], v[36:51]
s_waitcnt lgkmcnt(0)
v_add_f32 v68, v68, v72
v_add_f32 v76, v76, v80
v_add_f32 v69, v69, v73
v_add_f32 v77, v77, v81
v_add_f32 v70, v70, v74
v_add_f32 v78, v78, v82
v_add_f32 v71, v71, v75
v_add_f32 v79, v79, v83
s_waitcnt vmcnt(18)
v_mfma_f32_32x32x16_bf16 v[20:35], a[104:107], v[148:151], v[20:35]
v_mfma_f32_32x32x16_bf16 v[36:51], a[108:111], v[148:151], v[36:51]
v_add_f32 v84, v68, v76
v_add_f32 v85, v69, v77
v_add_f32 v86, v70, v78
v_add_f32 v87, v71, v79
s_waitcnt vmcnt(17)
v_mfma_f32_32x32x16_bf16 v[20:35], a[112:115], v[152:155], v[20:35]
v_mfma_f32_32x32x16_bf16 v[36:51], a[116:119], v[152:155], v[36:51]
s_waitcnt vmcnt(16)
v_mfma_f32_32x32x16_bf16 v[20:35], a[120:123], v[156:159], v[20:35]
v_mfma_f32_32x32x16_bf16 v[36:51], a[124:127], v[156:159], v[36:51]
s_waitcnt vmcnt(15)
v_mfma_f32_32x32x16_bf16 v[20:35], a[128:131], v[160:163], v[20:35]
v_mfma_f32_32x32x16_bf16 v[36:51], a[132:135], v[160:163], v[36:51]
s_waitcnt vmcnt(14)
v_mfma_f32_32x32x16_bf16 v[20:35], a[136:139], v[164:167], v[20:35]
v_mfma_f32_32x32x16_bf16 v[36:51], a[140:143], v[164:167], v[36:51]
s_waitcnt vmcnt(13)
v_mfma_f32_32x32x16_bf16 v[20:35], a[144:147], v[168:171], v[20:35]
v_mfma_f32_32x32x16_bf16 v[36:51], a[148:151], v[168:171], v[36:51]
s_waitcnt vmcnt(12)
v_mfma_f32_32x32x16_bf16 v[20:35], a[152:155], v[172:175], v[20:35]
v_mfma_f32_32x32x16_bf16 v[36:51], a[156:159], v[172:175], v[36:51]
s_waitcnt vmcnt(11)
v_mfma_f32_32x32x16_bf16 v[20:35], a[160:163], v[176:179], v[20:35]
v_mfma_f32_32x32x16_bf16 v[36:51], a[164:167], v[176:179], v[36:51]
buffer_load_dword v15, v7, s[84:87], 0 offen sc1
s_waitcnt vmcnt(10)
v_mfma_f32_32x32x16_bf16 v[20:35], a[168:171], v[180:183], v[20:35]
v_mfma_f32_32x32x16_bf16 v[36:51], a[172:175], v[180:183], v[36:51]
s_waitcnt vmcnt(9)
v_mfma_f32_32x32x16_bf16 v[20:35], a[176:179], v[184:187], v[20:35]
v_mfma_f32_32x32x16_bf16 v[36:51], a[180:183], v[184:187], v[36:51]
s_waitcnt vmcnt(8)
v_mfma_f32_32x32x16_bf16 v[20:35], a[184:187], v[188:191], v[20:35]
v_mfma_f32_32x32x16_bf16 v[36:51], a[188:191], v[188:191], v[36:51]
s_waitcnt vmcnt(7)
v_mfma_f32_32x32x16_bf16 v[20:35], a[192:195], v[192:195], v[20:35]
v_mfma_f32_32x32x16_bf16 v[36:51], a[196:199], v[192:195], v[36:51]
s_waitcnt vmcnt(6)
v_mfma_f32_32x32x16_bf16 v[20:35], a[200:203], v[196:199], v[20:35]
v_mfma_f32_32x32x16_bf16 v[36:51], a[204:207], v[196:199], v[36:51]
s_waitcnt vmcnt(5)
v_mfma_f32_32x32x16_bf16 v[20:35], a[208:211], v[200:203], v[20:35]
v_mfma_f32_32x32x16_bf16 v[36:51], a[212:215], v[200:203], v[36:51]
s_waitcnt vmcnt(4)
v_mfma_f32_32x32x16_bf16 v[20:35], a[216:219], v[204:207], v[20:35]
v_mfma_f32_32x32x16_bf16 v[36:51], a[220:223], v[204:207], v[36:51]
s_sub_u32 s60, s62, s64
s_lshr_b32 s60, s60, s67
s_bfe_u32 s61, s60, 0x10001
s_and_b32 s60, s60, 1
s_lshl_b32 s60, s60, 12
buffer_load_dwordx4 v[88:91], v13, s[84:87], s60 offen sc1
s_waitcnt vmcnt(3)
v_mfma_f32_32x32x16_bf16 v[20:35], a[224:227], v[208:211], v[20:35]
v_mfma_f32_32x32x16_bf16 v[36:51], a[228:231], v[208:211], v[36:51]
s_waitcnt vmcnt(2)
v_mfma_f32_32x32x16_bf16 v[20:35], a[232:235], v[212:215], v[20:35]
v_mfma_f32_32x32x16_bf16 v[36:51], a[236:239], v[212:215], v[36:51]
s_waitcnt vmcnt(1)
v_mfma_f32_32x32x16_bf16 v[20:35], a[240:243], v[216:219], v[20:35]
v_mfma_f32_32x32x16_bf16 v[36:51], a[244:247], v[216:219], v[36:51]
s_waitcnt vmcnt(0)
v_mfma_f32_32x32x16_bf16 v[224:239], a[248:251], v[220:223], v[20:35]
v_mfma_f32_32x32x16_bf16 v[240:255], a[252:255], v[220:223], v[36:51]
s_waitcnt vmcnt(0)
mega_kernel_o_f0c:
v_and_b32 v14, 1, v88
v_cmp_ne_u32 vcc, s61, v14
s_cbranch_vccz mega_kernel_o_f0k
s_sub_u32 s60, s62, s64
s_lshr_b32 s60, s60, s67
s_bfe_u32 s61, s60, 0x10001
s_and_b32 s60, s60, 1
s_lshl_b32 s60, s60, 12
buffer_load_dwordx4 v[88:91], v13, s[84:87], s60 offen sc1
s_waitcnt vmcnt(0)
s_branch mega_kernel_o_f0c
mega_kernel_o_f0k:
v_pk_add_f32 v[88:89], v[88:89], v[84:85]
v_pk_add_f32 v[90:91], v[90:91], v[86:87]
s_lshl_b32 s60, s62, 17
v_cvt_pk_bf16_f32 v92, v88, v89
v_cvt_pk_bf16_f32 v93, v90, v91
buffer_store_dwordx2 v[92:93], v11, s[8:11], s60 offen sc1
mega_kernel_o_imm:
s_waitcnt vmcnt(1)
v_min_i32_dpp v15, v15, v15 quad_perm:[1,0,3,2] row_mask:0xf bank_mask:0xf
s_nop 1
v_min_i32_dpp v15, v15, v15 quad_perm:[2,3,0,1] row_mask:0xf bank_mask:0xf
s_nop 1
v_min_i32_dpp v15, v15, v15 row_ror:4 row_mask:0xf bank_mask:0xf
s_nop 1
v_min_i32_dpp v15, v15, v15 row_ror:8 row_mask:0xf bank_mask:0xf
s_nop 0
v_readfirstlane_b32 s52, v15
s_min_i32 s52, s52, s65
s_cmp_gt_i32 s52, s54
s_cbranch_scc0 mega_kernel_o_im2
s_add_u32 s42, s42, s71
s_add_u32 s54, s54, s71
s_cmp_gt_i32 s52, s54
s_cbranch_scc0 mega_kernel_o_c1
s_add_u32 s51, s56, 0
s_and_b32 s51, s51, 0x7fff
s_add_u32 s51, s51, s50
buffer_load_dwordx4 v[96:99], v6, s[84:87], s51 offen offset:0 sc1
buffer_load_dwordx4 v[100:103], v6, s[84:87], s51 offen offset:1024 sc1
buffer_load_dwordx4 v[104:107], v6, s[84:87], s51 offen offset:2048 sc1
buffer_load_dwordx4 v[108:111], v6, s[84:87], s51 offen offset:3072 sc1
s_add_u32 s51, s56, 4096
s_and_b32 s51, s51, 0x7fff
s_add_u32 s51, s51, s50
buffer_load_dwordx4 v[112:115], v6, s[84:87], s51 offen offset:0 sc1
buffer_load_dwordx4 v[116:119], v6, s[84:87], s51 offen offset:1024 sc1
buffer_load_dwordx4 v[120:123], v6, s[84:87], s51 offen offset:2048 sc1
buffer_load_dwordx4 v[124:127], v6, s[84:87], s51 offen offset:3072 sc1
s_add_u32 s51, s56, 8192
s_and_b32 s51, s51, 0x7fff
s_add_u32 s51, s51, s50
buffer_load_dwordx4 v[128:131], v6, s[84:87], s51 offen offset:0 sc1
buffer_load_dwordx4 v[132:135], v6, s[84:87], s51 offen offset:1024 sc1
buffer_load_dwordx4 v[136:139], v6, s[84:87], s51 offen offset:2048 sc1
buffer_load_dwordx4 v[140:143], v6, s[84:87], s51 offen offset:3072 sc1
s_add_u32 s51, s56, 12288
s_and_b32 s51, s51, 0x7fff
s_add_u32 s51, s51, s50
buffer_load_dwordx4 v[144:147], v6, s[84:87], s51 offen offset:0 sc1
buffer_load_dwordx4 v[148:151], v6, s[84:87], s51 offen offset:1024 sc1
buffer_load_dwordx4 v[152:155], v6, s[84:87], s51 offen offset:2048 sc1
buffer_load_dwordx4 v[156:159], v6, s[84:87], s51 offen offset:3072 sc1
s_add_u32 s51, s56, 16384
s_and_b32 s51, s51, 0x7fff
s_add_u32 s51, s51, s50
buffer_load_dwordx4 v[160:163], v6, s[84:87], s51 offen offset:0 sc1
buffer_load_dwordx4 v[164:167], v6, s[84:87], s51 offen offset:1024 sc1
buffer_load_dwordx4 v[168:171], v6, s[84:87], s51 offen offset:2048 sc1
buffer_load_dwordx4 v[172:175], v6, s[84:87], s51 offen offset:3072 sc1
s_add_u32 s51, s56, 20480
s_and_b32 s51, s51, 0x7fff
s_add_u32 s51, s51, s50
buffer_load_dwordx4 v[176:179], v6, s[84:87], s51 offen offset:0 sc1
buffer_load_dwordx4 v[180:183], v6, s[84:87], s51 offen offset:1024 sc1
buffer_load_dwordx4 v[184:187], v6, s[84:87], s51 offen offset:2048 sc1
buffer_load_dwordx4 v[188:191], v6, s[84:87], s51 offen offset:3072 sc1
s_add_u32 s51, s56, 24576
s_and_b32 s51, s51, 0x7fff
s_add_u32 s51, s51, s50
buffer_load_dwordx4 v[192:195], v6, s[84:87], s51 offen offset:0 sc1
buffer_load_dwordx4 v[196:199], v6, s[84:87], s51 offen offset:1024 sc1
buffer_load_dwordx4 v[200:203], v6, s[84:87], s51 offen offset:2048 sc1
buffer_load_dwordx4 v[204:207], v6, s[84:87], s51 offen offset:3072 sc1
s_add_u32 s51, s56, 28672
s_and_b32 s51, s51, 0x7fff
s_add_u32 s51, s51, s50
buffer_load_dwordx4 v[208:211], v6, s[84:87], s51 offen offset:0 sc1
buffer_load_dwordx4 v[212:215], v6, s[84:87], s51 offen offset:1024 sc1
buffer_load_dwordx4 v[216:219], v6, s[84:87], s51 offen offset:2048 sc1
buffer_load_dwordx4 v[220:223], v6, s[84:87], s51 offen offset:3072 sc1
s_branch mega_kernel_o_w1
mega_kernel_o_c0:
s_add_u32 s54, s42, s71
s_sub_u32 s62, s42, s71
s_lshl_b32 s50, s42, 18
s_add_u32 s51, s56, 0
s_and_b32 s51, s51, 0x7fff
s_add_u32 s51, s51, s50
buffer_load_dwordx4 v[96:99], v6, s[84:87], s51 offen offset:0 sc1
buffer_load_dwordx4 v[100:103], v6, s[84:87], s51 offen offset:1024 sc1
buffer_load_dwordx4 v[104:107], v6, s[84:87], s51 offen offset:2048 sc1
buffer_load_dwordx4 v[108:111], v6, s[84:87], s51 offen offset:3072 sc1
s_add_u32 s51, s56, 4096
s_and_b32 s51, s51, 0x7fff
s_add_u32 s51, s51, s50
buffer_load_dwordx4 v[112:115], v6, s[84:87], s51 offen offset:0 sc1
buffer_load_dwordx4 v[116:119], v6, s[84:87], s51 offen offset:1024 sc1
buffer_load_dwordx4 v[120:123], v6, s[84:87], s51 offen offset:2048 sc1
buffer_load_dwordx4 v[124:127], v6, s[84:87], s51 offen offset:3072 sc1
s_waitcnt vmcnt(7)
v_mfma_f32_32x32x16_bf16 v[20:35], a[0:3], v[96:99], 0
v_mfma_f32_32x32x16_bf16 v[36:51], a[4:7], v[96:99], 0
s_add_u32 s51, s56, 8192
s_and_b32 s51, s51, 0x7fff
s_add_u32 s51, s51, s50
buffer_load_dwordx4 v[128:131], v6, s[84:87], s51 offen offset:0 sc1
s_waitcnt vmcnt(7)
v_mfma_f32_32x32x16_bf16 v[20:35], a[8:11], v[100:103], v[20:35]
v_mfma_f32_32x32x16_bf16 v[36:51], a[12:15], v[100:103], v[36:51]
buffer_load_dwordx4 v[132:135], v6, s[84:87], s51 offen offset:1024 sc1
s_waitcnt vmcnt(7)
v_mfma_f32_32x32x16_bf16 v[20:35], a[16:19], v[104:107], v[20:35]
v_mfma_f32_32x32x16_bf16 v[36:51], a[20:23], v[104:107], v[36:51]
buffer_load_dwordx4 v[136:139], v6, s[84:87], s51 offen offset:2048 sc1
s_waitcnt vmcnt(7)
v_mfma_f32_32x32x16_bf16 v[20:35], a[24:27], v[108:111], v[20:35]
v_mfma_f32_32x32x16_bf16 v[36:51], a[28:31], v[108:111], v[36:51]
buffer_load_dwordx4 v[140:143], v6, s[84:87], s51 offen offset:3072 sc1
s_waitcnt vmcnt(7)
v_mfma_f32_32x32x16_bf16 v[20:35], a[32:35], v[112:115], v[20:35]
v_mfma_f32_32x32x16_bf16 v[36:51], a[36:39], v[112:115], v[36:51]
s_add_u32 s51, s56, 12288
s_and_b32 s51, s51, 0x7fff
s_add_u32 s51, s51, s50
buffer_load_dwordx4 v[144:147], v6, s[84:87], s51 offen offset:0 sc1
s_waitcnt vmcnt(7)
v_mfma_f32_32x32x16_bf16 v[20:35], a[40:43], v[116:119], v[20:35]
v_mfma_f32_32x32x16_bf16 v[36:51], a[44:47], v[116:119], v[36:51]
buffer_load_dwordx4 v[148:151], v6, s[84:87], s51 offen offset:1024 sc1
s_waitcnt vmcnt(7)
v_mfma_f32_32x32x16_bf16 v[20:35], a[48:51], v[120:123], v[20:35]
v_mfma_f32_32x32x16_bf16 v[36:51], a[52:55], v[120:123], v[36:51]
buffer_load_dwordx4 v[152:155], v6, s[84:87], s51 offen offset:2048 sc1
s_waitcnt vmcnt(7)
v_mfma_f32_32x32x16_bf16 v[20:35], a[56:59], v[124:127], v[20:35]
v_mfma_f32_32x32x16_bf16 v[36:51], a[60:63], v[124:127], v[36:51]
buffer_load_dwordx4 v[156:159], v6, s[84:87], s51 offen offset:3072 sc1
s_waitcnt vmcnt(7)
v_mfma_f32_32x32x16_bf16 v[20:35], a[64:67], v[128:131], v[20:35]
v_mfma_f32_32x32x16_bf16 v[36:51], a[68:71], v[128:131], v[36:51]
s_add_u32 s51, s56, 16384
s_and_b32 s51, s51, 0x7fff
s_add_u32 s51, s51, s50
buffer_load_dwordx4 v[160:163], v6, s[84:87], s51 offen offset:0 sc1
s_waitcnt vmcnt(7)
v_mfma_f32_32x32x16_bf16 v[20:35], a[72:75], v[132:135], v[20:35]
v_mfma_f32_32x32x16_bf16 v[36:51], a[76:79], v[132:135], v[36:51]
buffer_load_dwordx4 v[164:167], v6, s[84:87], s51 offen offset:1024 sc1
s_waitcnt vmcnt(7)
v_mfma_f32_32x32x16_bf16 v[20:35], a[80:83], v[136:139], v[20:35]
v_mfma_f32_32x32x16_bf16 v[36:51], a[84:87], v[136:139], v[36:51]
buffer_load_dwordx4 v[168:171], v6, s[84:87], s51 offen offset:2048 sc1
s_waitcnt vmcnt(7)
v_mfma_f32_32x32x16_bf16 v[20:35], a[88:91], v[140:143], v[20:35]
v_mfma_f32_32x32x16_bf16 v[36:51], a[92:95], v[140:143], v[36:51]
buffer_load_dwordx4 v[172:175], v6, s[84:87], s51 offen offset:3072 sc1
s_waitcnt vmcnt(7)
v_mfma_f32_32x32x16_bf16 v[20:35], a[96:99], v[144:147], v[20:35]
v_mfma_f32_32x32x16_bf16 v[36:51], a[100:103], v[144:147], v[36:51]
s_add_u32 s51, s56, 20480
s_and_b32 s51, s51, 0x7fff
s_add_u32 s51, s51, s50
buffer_load_dwordx4 v[176:179], v6, s[84:87], s51 offen offset:0 sc1
s_waitcnt vmcnt(7)
v_mfma_f32_32x32x16_bf16 v[20:35], a[104:107], v[148:151], v[20:35]
v_mfma_f32_32x32x16_bf16 v[36:51], a[108:111], v[148:151], v[36:51]
buffer_load_dwordx4 v[180:183], v6, s[84:87], s51 offen offset:1024 sc1
s_waitcnt vmcnt(7)
v_mfma_f32_32x32x16_bf16 v[20:35], a[112:115], v[152:155], v[20:35]
v_mfma_f32_32x32x16_bf16 v[36:51], a[116:119], v[152:155], v[36:51]
buffer_load_dwordx4 v[184:187], v6, s[84:87], s51 offen offset:2048 sc1
s_waitcnt vmcnt(7)
v_mfma_f32_32x32x16_bf16 v[20:35], a[120:123], v[156:159], v[20:35]
v_mfma_f32_32x32x16_bf16 v[36:51], a[124:127], v[156:159], v[36:51]
buffer_load_dwordx4 v[188:191], v6, s[84:87], s51 offen offset:3072 sc1
s_waitcnt vmcnt(7)
v_mfma_f32_32x32x16_bf16 v[20:35], a[128:131], v[160:163], v[20:35]
v_mfma_f32_32x32x16_bf16 v[36:51], a[132:135], v[160:163], v[36:51]
s_add_u32 s51, s56, 24576
s_and_b32 s51, s51, 0x7fff
s_add_u32 s51, s51, s50
buffer_load_dwordx4 v[192:195], v6, s[84:87], s51 offen offset:0 sc1
s_waitcnt vmcnt(7)
v_mfma_f32_32x32x16_bf16 v[20:35], a[136:139], v[164:167], v[20:35]
v_mfma_f32_32x32x16_bf16 v[36:51], a[140:143], v[164:167], v[36:51]
buffer_load_dwordx4 v[196:199], v6, s[84:87], s51 offen offset:1024 sc1
s_waitcnt vmcnt(7)
v_mfma_f32_32x32x16_bf16 v[20:35], a[144:147], v[168:171], v[20:35]
v_mfma_f32_32x32x16_bf16 v[36:51], a[148:151], v[168:171], v[36:51]
buffer_load_dwordx4 v[200:203], v6, s[84:87], s51 offen offset:2048 sc1
s_waitcnt vmcnt(7)
v_mfma_f32_32x32x16_bf16 v[20:35], a[152:155], v[172:175], v[20:35]
v_mfma_f32_32x32x16_bf16 v[36:51], a[156:159], v[172:175], v[36:51]
buffer_load_dwordx4 v[204:207], v6, s[84:87], s51 offen offset:3072 sc1
s_waitcnt vmcnt(7)
v_mfma_f32_32x32x16_bf16 v[20:35], a[160:163], v[176:179], v[20:35]
v_mfma_f32_32x32x16_bf16 v[36:51], a[164:167], v[176:179], v[36:51]
s_add_u32 s51, s56, 28672
s_and_b32 s51, s51, 0x7fff
s_add_u32 s51, s51, s50
buffer_load_dwordx4 v[208:211], v6, s[84:87], s51 offen offset:0 sc1
s_waitcnt vmcnt(7)
v_mfma_f32_32x32x16_bf16 v[20:35], a[168:171], v[180:183], v[20:35]
v_mfma_f32_32x32x16_bf16 v[36:51], a[172:175], v[180:183], v[36:51]
buffer_load_dwordx4 v[212:215], v6, s[84:87], s51 offen offset:1024 sc1
s_waitcnt vmcnt(7)
v_mfma_f32_32x32x16_bf16 v[20:35], a[176:179], v[184:187], v[20:35]
v_mfma_f32_32x32x16_bf16 v[36:51], a[180:183], v[184:187], v[36:51]
buffer_load_dwordx4 v[216:219], v6, s[84:87], s51 offen offset:2048 sc1
s_waitcnt vmcnt(7)
v_mfma_f32_32x32x16_bf16 v[20:35], a[184:187], v[188:191], v[20:35]
v_mfma_f32_32x32x16_bf16 v[36:51], a[188:191], v[188:191], v[36:51]
buffer_load_dwordx4 v[220:223], v6, s[84:87], s51 offen offset:3072 sc1
s_waitcnt vmcnt(7)
v_mfma_f32_32x32x16_bf16 v[20:35], a[192:195], v[192:195], v[20:35]
v_mfma_f32_32x32x16_bf16 v[36:51], a[196:199], v[192:195], v[36:51]
buffer_load_dword v15, v7, s[84:87], 0 offen sc1
s_waitcnt vmcnt(6)
v_mfma_f32_32x32x16_bf16 v[20:35], a[200:203], v[196:199], v[20:35]
v_mfma_f32_32x32x16_bf16 v[36:51], a[204:207], v[196:199], v[36:51]
s_waitcnt vmcnt(5)
v_mfma_f32_32x32x16_bf16 v[20:35], a[208:211], v[200:203], v[20:35]
v_mfma_f32_32x32x16_bf16 v[36:51], a[212:215], v[200:203], v[36:51]
s_waitcnt vmcnt(4)
v_mfma_f32_32x32x16_bf16 v[20:35], a[216:219], v[204:207], v[20:35]
v_mfma_f32_32x32x16_bf16 v[36:51], a[220:223], v[204:207], v[36:51]
s_waitcnt vmcnt(3)
v_mfma_f32_32x32x16_bf16 v[20:35], a[224:227], v[208:211], v[20:35]
v_mfma_f32_32x32x16_bf16 v[36:51], a[228:231], v[208:211], v[36:51]
s_waitcnt vmcnt(2)
v_mfma_f32_32x32x16_bf16 v[20:35], a[232:235], v[212:215], v[20:35]
v_mfma_f32_32x32x16_bf16 v[36:51], a[236:239], v[212:215], v[36:51]
s_waitcnt vmcnt(1)
v_mfma_f32_32x32x16_bf16 v[20:35], a[240:243], v[216:219], v[20:35]
v_mfma_f32_32x32x16_bf16 v[36:51], a[244:247], v[216:219], v[36:51]
s_waitcnt vmcnt(0)
v_mfma_f32_32x32x16_bf16 v[224:239], a[248:251], v[220:223], v[20:35]
v_mfma_f32_32x32x16_bf16 v[240:255], a[252:255], v[220:223], v[36:51]
s_lshl_b32 s50, s54, 18
s_branch mega_kernel_o_imm
mega_kernel_o_c1:
s_add_u32 s54, s42, s71
s_sub_u32 s62, s42, s71
s_lshl_b32 s50, s42, 18
s_add_u32 s51, s56, 0
s_and_b32 s51, s51, 0x7fff
s_add_u32 s51, s51, s50
buffer_load_dwordx4 v[96:99], v6, s[84:87], s51 offen offset:0 sc1
buffer_load_dwordx4 v[100:103], v6, s[84:87], s51 offen offset:1024 sc1
buffer_load_dwordx4 v[104:107], v6, s[84:87], s51 offen offset:2048 sc1
buffer_load_dwordx4 v[108:111], v6, s[84:87], s51 offen offset:3072 sc1
s_add_u32 s51, s56, 4096
s_and_b32 s51, s51, 0x7fff
s_add_u32 s51, s51, s50
buffer_load_dwordx4 v[112:115], v6, s[84:87], s51 offen offset:0 sc1
buffer_load_dwordx4 v[116:119], v6, s[84:87], s51 offen offset:1024 sc1
buffer_load_dwordx4 v[120:123], v6, s[84:87], s51 offen offset:2048 sc1
buffer_load_dwordx4 v[124:127], v6, s[84:87], s51 offen offset:3072 sc1
v_add_u32 v2, s53, v8
v_add_u32 v3, s53, v9
v_add_u32 v4, s53, v10
ds_write_b128 v2, v[224:227] offset:0
ds_write_b128 v2, v[228:231] offset:1088
ds_write_b128 v2, v[232:235] offset:2176
ds_write_b128 v2, v[236:239] offset:3264
ds_write_b128 v2, v[240:243] offset:4352
ds_write_b128 v2, v[244:247] offset:5440
ds_write_b128 v2, v[248:251] offset:6528
ds_write_b128 v2, v[252:255] offset:7616
s_waitcnt lgkmcnt(0)
s_barrier
ds_read_b128 v[52:55], v4 offset:0
ds_read_b128 v[56:59], v4 offset:8704
ds_read_b128 v[60:63], v4 offset:17408
ds_read_b128 v[64:67], v4 offset:26112
ds_read_b128 v[68:71], v3 offset:0
ds_read_b128 v[72:75], v3 offset:8704
ds_read_b128 v[76:79], v3 offset:17408
ds_read_b128 v[80:83], v3 offset:26112
s_sub_u32 s53, 34816, s53
s_sub_u32 s60, s62, s64
s_lshr_b32 s60, s60, s67
s_bfe_u32 s61, s60, 0x10001
s_and_b32 s60, s60, 1
s_lshl_b32 s60, s60, 12
s_waitcnt lgkmcnt(4)
v_add_f32 v52, v52, v56
v_add_f32 v60, v60, v64
v_add_f32 v53, v53, v57
v_add_f32 v61, v61, v65
v_add_f32 v54, v54, v58
v_add_f32 v62, v62, v66
v_add_f32 v55, v55, v59
v_add_f32 v63, v63, v67
v_add_f32 v52, v52, v60
v_add_f32 v53, v53, v61
v_add_f32 v54, v54, v62
v_add_f32 v55, v55, v63
v_and_or_b32 v52, v52, -2, s61
s_cmp_eq_u32 s95, 0
s_cbranch_scc1 mega_kernel_o_sa3
buffer_store_dwordx4 v[52:55], v12, s[84:87], s60 offen sc1
s_branch mega_kernel_o_sb3
mega_kernel_o_sa3:
buffer_store_dwordx4 v[52:55], v12, s[84:87], s60 offen
mega_kernel_o_sb3:
s_waitcnt lgkmcnt(0)
v_add_f32 v68, v68, v72
v_add_f32 v76, v76, v80
v_add_f32 v69, v69, v73
v_add_f32 v77, v77, v81
v_add_f32 v70, v70, v74
v_add_f32 v78, v78, v82
v_add_f32 v71, v71, v75
v_add_f32 v79, v79, v83
v_add_f32 v84, v68, v76
v_add_f32 v85, v69, v77
v_add_f32 v86, v70, v78
v_add_f32 v87, v71, v79
s_waitcnt vmcnt(7)
v_mfma_f32_32x32x16_bf16 v[20:35], a[0:3], v[96:99], 0
v_mfma_f32_32x32x16_bf16 v[36:51], a[4:7], v[96:99], 0
s_add_u32 s51, s56, 8192
s_and_b32 s51, s51, 0x7fff
s_add_u32 s51, s51, s50
buffer_load_dwordx4 v[128:131], v6, s[84:87], s51 offen offset:0 sc1
s_waitcnt vmcnt(7)
v_mfma_f32_32x32x16_bf16 v[20:35], a[8:11], v[100:103], v[20:35]
v_mfma_f32_32x32x16_bf16 v[36:51], a[12:15], v[100:103], v[36:51]
buffer_load_dwordx4 v[132:135], v6, s[84:87], s51 offen offset:1024 sc1
s_waitcnt vmcnt(7)
v_mfma_f32_32x32x16_bf16 v[20:35], a[16:19], v[104:107], v[20:35]
v_mfma_f32_32x32x16_bf16 v[36:51], a[20:23], v[104:107], v[36:51]
buffer_load_dwordx4 v[136:139], v6, s[84:87], s51 offen offset:2048 sc1
s_waitcnt vmcnt(7)
v_mfma_f32_32x32x16_bf16 v[20:35], a[24:27], v[108:111], v[20:35]
v_mfma_f32_32x32x16_bf16 v[36:51], a[28:31], v[108:111], v[36:51]
buffer_load_dwordx4 v[140:143], v6, s[84:87], s51 offen offset:3072 sc1
s_waitcnt vmcnt(7)
v_mfma_f32_32x32x16_bf16 v[20:35], a[32:35], v[112:115], v[20:35]
v_mfma_f32_32x32x16_bf16 v[36:51], a[36:39], v[112:115], v[36:51]
s_add_u32 s51, s56, 12288
s_and_b32 s51, s51, 0x7fff
s_add_u32 s51, s51, s50
buffer_load_dwordx4 v[144:147], v6, s[84:87], s51 offen offset:0 sc1
s_waitcnt vmcnt(7)
v_mfma_f32_32x32x16_bf16 v[20:35], a[40:43], v[116:119], v[20:35]
v_mfma_f32_32x32x16_bf16 v[36:51], a[44:47], v[116:119], v[36:51]
buffer_load_dwordx4 v[148:151], v6, s[84:87], s51 offen offset:1024 sc1
s_waitcnt vmcnt(7)
v_mfma_f32_32x32x16_bf16 v[20:35], a[48:51], v[120:123], v[20:35]
v_mfma_f32_32x32x16_bf16 v[36:51], a[52:55], v[120:123], v[36:51]
buffer_load_dwordx4 v[152:155], v6, s[84:87], s51 offen offset:2048 sc1
s_waitcnt vmcnt(7)
v_mfma_f32_32x32x16_bf16 v[20:35], a[56:59], v[124:127], v[20:35]
v_mfma_f32_32x32x16_bf16 v[36:51], a[60:63], v[124:127], v[36:51]
buffer_load_dwordx4 v[156:159], v6, s[84:87], s51 offen offset:3072 sc1
s_waitcnt vmcnt(7)
v_mfma_f32_32x32x16_bf16 v[20:35], a[64:67], v[128:131], v[20:35]
v_mfma_f32_32x32x16_bf16 v[36:51], a[68:71], v[128:131], v[36:51]
s_add_u32 s51, s56, 16384
s_and_b32 s51, s51, 0x7fff
s_add_u32 s51, s51, s50
buffer_load_dwordx4 v[160:163], v6, s[84:87], s51 offen offset:0 sc1
s_waitcnt vmcnt(7)
v_mfma_f32_32x32x16_bf16 v[20:35], a[72:75], v[132:135], v[20:35]
v_mfma_f32_32x32x16_bf16 v[36:51], a[76:79], v[132:135], v[36:51]
buffer_load_dwordx4 v[164:167], v6, s[84:87], s51 offen offset:1024 sc1
s_waitcnt vmcnt(7)
v_mfma_f32_32x32x16_bf16 v[20:35], a[80:83], v[136:139], v[20:35]
v_mfma_f32_32x32x16_bf16 v[36:51], a[84:87], v[136:139], v[36:51]
buffer_load_dwordx4 v[168:171], v6, s[84:87], s51 offen offset:2048 sc1
s_waitcnt vmcnt(7)
v_mfma_f32_32x32x16_bf16 v[20:35], a[88:91], v[140:143], v[20:35]
v_mfma_f32_32x32x16_bf16 v[36:51], a[92:95], v[140:143], v[36:51]
buffer_load_dwordx4 v[172:175], v6, s[84:87], s51 offen offset:3072 sc1
s_waitcnt vmcnt(7)
v_mfma_f32_32x32x16_bf16 v[20:35], a[96:99], v[144:147], v[20:35]
v_mfma_f32_32x32x16_bf16 v[36:51], a[100:103], v[144:147], v[36:51]
s_add_u32 s51, s56, 20480
s_and_b32 s51, s51, 0x7fff
s_add_u32 s51, s51, s50
buffer_load_dwordx4 v[176:179], v6, s[84:87], s51 offen offset:0 sc1
s_waitcnt vmcnt(7)
v_mfma_f32_32x32x16_bf16 v[20:35], a[104:107], v[148:151], v[20:35]
v_mfma_f32_32x32x16_bf16 v[36:51], a[108:111], v[148:151], v[36:51]
buffer_load_dwordx4 v[180:183], v6, s[84:87], s51 offen offset:1024 sc1
s_waitcnt vmcnt(7)
v_mfma_f32_32x32x16_bf16 v[20:35], a[112:115], v[152:155], v[20:35]
v_mfma_f32_32x32x16_bf16 v[36:51], a[116:119], v[152:155], v[36:51]
buffer_load_dwordx4 v[184:187], v6, s[84:87], s51 offen offset:2048 sc1
s_waitcnt vmcnt(7)
v_mfma_f32_32x32x16_bf16 v[20:35], a[120:123], v[156:159], v[20:35]
v_mfma_f32_32x32x16_bf16 v[36:51], a[124:127], v[156:159], v[36:51]
buffer_load_dwordx4 v[188:191], v6, s[84:87], s51 offen offset:3072 sc1
s_waitcnt vmcnt(7)
v_mfma_f32_32x32x16_bf16 v[20:35], a[128:131], v[160:163], v[20:35]
v_mfma_f32_32x32x16_bf16 v[36:51], a[132:135], v[160:163], v[36:51]
s_add_u32 s51, s56, 24576
s_and_b32 s51, s51, 0x7fff
s_add_u32 s51, s51, s50
buffer_load_dwordx4 v[192:195], v6, s[84:87], s51 offen offset:0 sc1
s_waitcnt vmcnt(7)
v_mfma_f32_32x32x16_bf16 v[20:35], a[136:139], v[164:167], v[20:35]
v_mfma_f32_32x32x16_bf16 v[36:51], a[140:143], v[164:167], v[36:51]
buffer_load_dwordx4 v[196:199], v6, s[84:87], s51 offen offset:1024 sc1
s_waitcnt vmcnt(7)
v_mfma_f32_32x32x16_bf16 v[20:35], a[144:147], v[168:171], v[20:35]
v_mfma_f32_32x32x16_bf16 v[36:51], a[148:151], v[168:171], v[36:51]
buffer_load_dwordx4 v[200:203], v6, s[84:87], s51 offen offset:2048 sc1
s_waitcnt vmcnt(7)
v_mfma_f32_32x32x16_bf16 v[20:35], a[152:155], v[172:175], v[20:35]
v_mfma_f32_32x32x16_bf16 v[36:51], a[156:159], v[172:175], v[36:51]
buffer_load_dwordx4 v[204:207], v6, s[84:87], s51 offen offset:3072 sc1
s_waitcnt vmcnt(7)
v_mfma_f32_32x32x16_bf16 v[20:35], a[160:163], v[176:179], v[20:35]
v_mfma_f32_32x32x16_bf16 v[36:51], a[164:167], v[176:179], v[36:51]
s_add_u32 s51, s56, 28672
s_and_b32 s51, s51, 0x7fff
s_add_u32 s51, s51, s50
buffer_load_dwordx4 v[208:211], v6, s[84:87], s51 offen offset:0 sc1
s_waitcnt vmcnt(7)
v_mfma_f32_32x32x16_bf16 v[20:35], a[168:171], v[180:183], v[20:35]
v_mfma_f32_32x32x16_bf16 v[36:51], a[172:175], v[180:183], v[36:51]
buffer_load_dwordx4 v[212:215], v6, s[84:87], s51 offen offset:1024 sc1
s_waitcnt vmcnt(7)
v_mfma_f32_32x32x16_bf16 v[20:35], a[176:179], v[184:187], v[20:35]
v_mfma_f32_32x32x16_bf16 v[36:51], a[180:183], v[184:187], v[36:51]
buffer_load_dwordx4 v[216:219], v6, s[84:87], s51 offen offset:2048 sc1
s_waitcnt vmcnt(7)
v_mfma_f32_32x32x16_bf16 v[20:35], a[184:187], v[188:191], v[20:35]
v_mfma_f32_32x32x16_bf16 v[36:51], a[188:191], v[188:191], v[36:51]
buffer_load_dwordx4 v[220:223], v6, s[84:87], s51 offen offset:3072 sc1
s_waitcnt vmcnt(7)
v_mfma_f32_32x32x16_bf16 v[20:35], a[192:195], v[192:195], v[20:35]
v_mfma_f32_32x32x16_bf16 v[36:51], a[196:199], v[192:195], v[36:51]
s_sub_u32 s60, s62, s64
s_lshr_b32 s60, s60, s67
s_bfe_u32 s61, s60, 0x10001
s_and_b32 s60, s60, 1
s_lshl_b32 s60, s60, 12
buffer_load_dwordx4 v[88:91], v13, s[84:87], s60 offen sc1
buffer_load_dword v15, v7, s[84:87], 0 offen sc1
s_waitcnt vmcnt(6)
v_mfma_f32_32x32x16_bf16 v[20:35], a[200:203], v[196:199], v[20:35]
v_mfma_f32_32x32x16_bf16 v[36:51], a[204:207], v[196:199], v[36:51]
s_waitcnt vmcnt(5)
v_mfma_f32_32x32x16_bf16 v[20:35], a[208:211], v[200:203], v[20:35]
v_mfma_f32_32x32x16_bf16 v[36:51], a[212:215], v[200:203], v[36:51]
s_waitcnt vmcnt(4)
v_mfma_f32_32x32x16_bf16 v[20:35], a[216:219], v[204:207], v[20:35]
v_mfma_f32_32x32x16_bf16 v[36:51], a[220:223], v[204:207], v[36:51]
s_waitcnt vmcnt(3)
v_mfma_f32_32x32x16_bf16 v[20:35], a[224:227], v[208:211], v[20:35]
v_mfma_f32_32x32x16_bf16 v[36:51], a[228:231], v[208:211], v[36:51]
s_waitcnt vmcnt(2)
v_mfma_f32_32x32x16_bf16 v[20:35], a[232:235], v[212:215], v[20:35]
v_mfma_f32_32x32x16_bf16 v[36:51], a[236:239], v[212:215], v[36:51]
s_waitcnt vmcnt(1)
v_mfma_f32_32x32x16_bf16 v[20:35], a[240:243], v[216:219], v[20:35]
v_mfma_f32_32x32x16_bf16 v[36:51], a[244:247], v[216:219], v[36:51]
s_waitcnt vmcnt(0)
v_mfma_f32_32x32x16_bf16 v[224:239], a[248:251], v[220:223], v[20:35]
v_mfma_f32_32x32x16_bf16 v[240:255], a[252:255], v[220:223], v[36:51]
s_waitcnt vmcnt(0)
mega_kernel_o_fcc:
v_and_b32 v14, 1, v88
v_cmp_ne_u32 vcc, s61, v14
s_cbranch_vccz mega_kernel_o_fck
s_sub_u32 s60, s62, s64
s_lshr_b32 s60, s60, s67
s_bfe_u32 s61, s60, 0x10001
s_and_b32 s60, s60, 1
s_lshl_b32 s60, s60, 12
buffer_load_dwordx4 v[88:91], v13, s[84:87], s60 offen sc1
s_waitcnt vmcnt(0)
s_branch mega_kernel_o_fcc
mega_kernel_o_fck:
v_pk_add_f32 v[88:89], v[88:89], v[84:85]
v_pk_add_f32 v[90:91], v[90:91], v[86:87]
s_lshl_b32 s60, s62, 17
v_cvt_pk_bf16_f32 v92, v88, v89
v_cvt_pk_bf16_f32 v93, v90, v91
buffer_store_dwordx2 v[92:93], v11, s[8:11], s60 offen sc1
s_lshl_b32 s50, s54, 18
s_branch mega_kernel_o_imm
mega_kernel_o_im2:
v_add_u32 v2, s53, v8
v_add_u32 v3, s53, v9
v_add_u32 v4, s53, v10
ds_write_b128 v2, v[224:227] offset:0
ds_write_b128 v2, v[228:231] offset:1088
ds_write_b128 v2, v[232:235] offset:2176
ds_write_b128 v2, v[236:239] offset:3264
ds_write_b128 v2, v[240:243] offset:4352
ds_write_b128 v2, v[244:247] offset:5440
ds_write_b128 v2, v[248:251] offset:6528
ds_write_b128 v2, v[252:255] offset:7616
s_waitcnt lgkmcnt(0)
s_barrier
ds_read_b128 v[52:55], v4 offset:0
ds_read_b128 v[56:59], v4 offset:8704
ds_read_b128 v[60:63], v4 offset:17408
ds_read_b128 v[64:67], v4 offset:26112
ds_read_b128 v[68:71], v3 offset:0
ds_read_b128 v[72:75], v3 offset:8704
ds_read_b128 v[76:79], v3 offset:17408
ds_read_b128 v[80:83], v3 offset:26112
s_sub_u32 s53, 34816, s53
s_sub_u32 s60, s42, s64
s_lshr_b32 s60, s60, s67
s_bfe_u32 s61, s60, 0x10001
s_and_b32 s60, s60, 1
s_lshl_b32 s60, s60, 12
s_waitcnt lgkmcnt(4)
v_add_f32 v52, v52, v56
v_add_f32 v60, v60, v64
v_add_f32 v53, v53, v57
v_add_f32 v61, v61, v65
v_add_f32 v54, v54, v58
v_add_f32 v62, v62, v66
v_add_f32 v55, v55, v59
v_add_f32 v63, v63, v67
v_add_f32 v52, v52, v60
v_add_f32 v53, v53, v61
v_add_f32 v54, v54, v62
v_add_f32 v55, v55, v63
v_and_or_b32 v52, v52, -2, s61
s_cmp_eq_u32 s95, 0
s_cbranch_scc1 mega_kernel_o_sa4
buffer_store_dwordx4 v[52:55], v12, s[84:87], s60 offen sc1
s_branch mega_kernel_o_sb4
mega_kernel_o_sa4:
buffer_store_dwordx4 v[52:55], v12, s[84:87], s60 offen
mega_kernel_o_sb4:
s_waitcnt lgkmcnt(0)
v_add_f32 v68, v68, v72
v_add_f32 v76, v76, v80
v_add_f32 v69, v69, v73
v_add_f32 v77, v77, v81
v_add_f32 v70, v70, v74
v_add_f32 v78, v78, v82
v_add_f32 v71, v71, v75
v_add_f32 v79, v79, v83
v_add_f32 v84, v68, v76
v_add_f32 v85, v69, v77
v_add_f32 v86, v70, v78
v_add_f32 v87, v71, v79
s_sub_u32 s60, s42, s64
s_lshr_b32 s60, s60, s67
s_bfe_u32 s61, s60, 0x10001
s_and_b32 s60, s60, 1
s_lshl_b32 s60, s60, 12
buffer_load_dwordx4 v[88:91], v13, s[84:87], s60 offen sc1
s_waitcnt vmcnt(0)
mega_kernel_o_f2c:
v_and_b32 v14, 1, v88
v_cmp_ne_u32 vcc, s61, v14
s_cbranch_vccz mega_kernel_o_f2k
s_sub_u32 s60, s42, s64
s_lshr_b32 s60, s60, s67
s_bfe_u32 s61, s60, 0x10001
s_and_b32 s60, s60, 1
s_lshl_b32 s60, s60, 12
buffer_load_dwordx4 v[88:91], v13, s[84:87], s60 offen sc1
s_waitcnt vmcnt(0)
s_branch mega_kernel_o_f2c
mega_kernel_o_f2k:
v_pk_add_f32 v[88:89], v[88:89], v[84:85]
v_pk_add_f32 v[90:91], v[90:91], v[86:87]
s_lshl_b32 s60, s42, 17
v_cvt_pk_bf16_f32 v92, v88, v89
v_cvt_pk_bf16_f32 v93, v90, v91
buffer_store_dwordx2 v[92:93], v11, s[8:11], s60 offen sc1
s_add_u32 s42, s42, s71
s_cmp_lt_u32 s42, s65
s_cbranch_scc1 mega_kernel_o_cold
mega_kernel_o_quit:
s_endpgm
mega_kernel_exit:
s_endpgm
mega_kernel_recf:
s_load_dwordx2 s[20:21], s[0:1], 8
s_load_dwordx2 s[16:17], s[0:1], 40
s_load_dwordx2 s[4:5], s[0:1], 16
s_load_dwordx2 s[8:9], s[0:1], 24
s_load_dwordx2 s[12:13], s[0:1], 32
v_lshrrev_b32 v4, 6, v0
v_and_b32 v1, 63, v0
v_readfirstlane_b32 s24, v4
v_lshrrev_b32 v2, 4, v1
v_and_b32 v3, 15, v1
v_lshlrev_b32 v17, 4, v1
s_lshr_b32 s28, s31, 2
s_lshl_b32 s25, s30, 3
s_add_u32 s25, s25, s28
s_and_b32 s26, s31, 3
s_waitcnt lgkmcnt(0)
s_mov_b32 s22, 16384
s_mov_b32 s23, 0x00020000
s_mov_b32 s18, 8388608
s_mov_b32 s19, 0x00020000
s_mov_b32 s6, 8388608
s_mov_b32 s7, 0x00020000
s_mov_b32 s10, 8388608
s_mov_b32 s11, 0x00020000
s_mov_b32 s14, 8388608
s_mov_b32 s15, 0x00020000
s_lshl_b32 s28, s25, 8
s_lshr_b32 s29, s26, 0
s_lshl_b32 s29, s29, 6
s_add_u32 s28, s28, s29
s_lshl_b32 s29, s24, 21
s_add_u32 s28, s28, s29
v_lshrrev_b32 v4, 2, v1
v_and_b32 v5, 3, v1
v_lshlrev_b32 v40, 13, v4
v_lshl_add_u32 v40, v5, 4, v40
v_add_u32 v40, s28, v40
s_lshl_b32 s28, s30, 21
s_lshl_b32 s29, s24, 19
s_add_u32 s28, s28, s29
s_lshr_b32 s29, s31, 0
s_lshl_b32 s29, s29, 6
s_add_u32 s28, s28, s29
v_lshlrev_b32 v41, 11, v4
v_lshl_add_u32 v41, v5, 4, v41
v_add_u32 v41, s28, v41
s_lshl_b32 s47, s24, 15
s_add_u32 s47, s47, 32768
s_lshl_b32 s28, s31, 18
s_lshl_b32 s29, s24, 16
s_add_u32 s28, s28, s29
s_lshl_b32 s29, s30, 11
s_add_u32 s28, s28, s29
v_lshlrev_b32 v48, 13, v2
v_lshl_add_u32 v48, v3, 7, v48
v_add_u32 v48, s28, v48
s_lshl_b32 s28, s30, 21
s_lshl_b32 s29, s31, 16
s_add_u32 s28, s28, s29
s_lshl_b32 s29, s24, 14
s_add_u32 s28, s28, s29
v_lshlrev_b32 v49, 7, v1
v_add_u32 v49, s28, v49
s_and_b32 s76, s31, 1
s_mul_i32 s76, s76, 8
s_and_b32 s28, s31, 15
s_lshl_b32 s28, s28, 4
s_lshl_b32 s29, s24, 8
s_add_u32 s28, s28, s29
v_add_u32 v53, s28, v3
s_lshr_b32 s28, s31, 4
s_lshl_b32 s28, s28, 10
s_add_u32 s28, s28, 384
v_mov_b32 v54, s28
v_mov_b32 v55, 1920
v_cmp_gt_u32 vcc, 32, v1
s_nop 1
v_cndmask_b32 v54, v55, v54, vcc
s_lshl_b32 s29, s30, 11
v_lshl_add_u32 v51, v53, 13, v54
v_add_u32 v51, s29, v51
s_lshl_b32 s29, s30, 21
v_lshl_add_u32 v52, v53, 11, v54
v_add_u32 v52, s29, v52
buffer_load_dword v50, v51, s[8:11], 0 offen
s_xor_b32 s29, s76, 0
s_lshl_b32 s28, s29, 10
s_add_u32 s28, s28, s47
s_add_u32 m0, s28, 0
s_lshl_b32 s29, s29, 17
buffer_load_dwordx4 v40, s[8:11], s29 offen lds
s_xor_b32 s29, s76, 1
s_lshl_b32 s28, s29, 10
s_add_u32 s28, s28, s47
s_add_u32 m0, s28, 0
s_lshl_b32 s29, s29, 17
buffer_load_dwordx4 v40, s[8:11], s29 offen lds
s_xor_b32 s29, s76, 2
s_lshl_b32 s28, s29, 10
s_add_u32 s28, s28, s47
s_add_u32 m0, s28, 0
s_lshl_b32 s29, s29, 17
buffer_load_dwordx4 v40, s[8:11], s29 offen lds
s_xor_b32 s29, s76, 3
s_lshl_b32 s28, s29, 10
s_add_u32 s28, s28, s47
s_add_u32 m0, s28, 0
s_lshl_b32 s29, s29, 17
buffer_load_dwordx4 v40, s[8:11], s29 offen lds
s_xor_b32 s29, s76, 4
s_lshl_b32 s28, s29, 10
s_add_u32 s28, s28, s47
s_add_u32 m0, s28, 0
s_lshl_b32 s29, s29, 17
buffer_load_dwordx4 v40, s[8:11], s29 offen lds
s_xor_b32 s29, s76, 5
s_lshl_b32 s28, s29, 10
s_add_u32 s28, s28, s47
s_add_u32 m0, s28, 0
s_lshl_b32 s29, s29, 17
buffer_load_dwordx4 v40, s[8:11], s29 offen lds
s_xor_b32 s29, s76, 6
s_lshl_b32 s28, s29, 10
s_add_u32 s28, s28, s47
s_add_u32 m0, s28, 0
s_lshl_b32 s29, s29, 17
buffer_load_dwordx4 v40, s[8:11], s29 offen lds
s_xor_b32 s29, s76, 7
s_lshl_b32 s28, s29, 10
s_add_u32 s28, s28, s47
s_add_u32 m0, s28, 0
s_lshl_b32 s29, s29, 17
buffer_load_dwordx4 v40, s[8:11], s29 offen lds
s_xor_b32 s29, s76, 8
s_lshl_b32 s28, s29, 10
s_add_u32 s28, s28, s47
s_add_u32 m0, s28, 0
s_lshl_b32 s29, s29, 17
buffer_load_dwordx4 v40, s[8:11], s29 offen lds
s_xor_b32 s29, s76, 9
s_lshl_b32 s28, s29, 10
s_add_u32 s28, s28, s47
s_add_u32 m0, s28, 0
s_lshl_b32 s29, s29, 17
buffer_load_dwordx4 v40, s[8:11], s29 offen lds
s_xor_b32 s29, s76, 10
s_lshl_b32 s28, s29, 10
s_add_u32 s28, s28, s47
s_add_u32 m0, s28, 0
s_lshl_b32 s29, s29, 17
buffer_load_dwordx4 v40, s[8:11], s29 offen lds
s_xor_b32 s29, s76, 11
s_lshl_b32 s28, s29, 10
s_add_u32 s28, s28, s47
s_add_u32 m0, s28, 0
s_lshl_b32 s29, s29, 17
buffer_load_dwordx4 v40, s[8:11], s29 offen lds
s_xor_b32 s29, s76, 12
s_lshl_b32 s28, s29, 10
s_add_u32 s28, s28, s47
s_add_u32 m0, s28, 0
s_lshl_b32 s29, s29, 17
buffer_load_dwordx4 v40, s[8:11], s29 offen lds
s_xor_b32 s29, s76, 13
s_lshl_b32 s28, s29, 10
s_add_u32 s28, s28, s47
s_add_u32 m0, s28, 0
s_lshl_b32 s29, s29, 17
buffer_load_dwordx4 v40, s[8:11], s29 offen lds
s_xor_b32 s29, s76, 14
s_lshl_b32 s28, s29, 10
s_add_u32 s28, s28, s47
s_add_u32 m0, s28, 0
s_lshl_b32 s29, s29, 17
buffer_load_dwordx4 v40, s[8:11], s29 offen lds
s_xor_b32 s29, s76, 15
s_lshl_b32 s28, s29, 10
s_add_u32 s28, s28, s47
s_add_u32 m0, s28, 0
s_lshl_b32 s29, s29, 17
buffer_load_dwordx4 v40, s[8:11], s29 offen lds
buffer_load_dword v50, v51, s[12:15], 0 offen
s_xor_b32 s29, s76, 0
s_lshl_b32 s28, s29, 10
s_add_u32 s28, s28, s47
s_add_u32 m0, s28, 16384
s_lshl_b32 s29, s29, 17
buffer_load_dwordx4 v40, s[12:15], s29 offen lds
s_xor_b32 s29, s76, 1
s_lshl_b32 s28, s29, 10
s_add_u32 s28, s28, s47
s_add_u32 m0, s28, 16384
s_lshl_b32 s29, s29, 17
buffer_load_dwordx4 v40, s[12:15], s29 offen lds
s_xor_b32 s29, s76, 2
s_lshl_b32 s28, s29, 10
s_add_u32 s28, s28, s47
s_add_u32 m0, s28, 16384
s_lshl_b32 s29, s29, 17
buffer_load_dwordx4 v40, s[12:15], s29 offen lds
s_xor_b32 s29, s76, 3
s_lshl_b32 s28, s29, 10
s_add_u32 s28, s28, s47
s_add_u32 m0, s28, 16384
s_lshl_b32 s29, s29, 17
buffer_load_dwordx4 v40, s[12:15], s29 offen lds
s_xor_b32 s29, s76, 4
s_lshl_b32 s28, s29, 10
s_add_u32 s28, s28, s47
s_add_u32 m0, s28, 16384
s_lshl_b32 s29, s29, 17
buffer_load_dwordx4 v40, s[12:15], s29 offen lds
s_xor_b32 s29, s76, 5
s_lshl_b32 s28, s29, 10
s_add_u32 s28, s28, s47
s_add_u32 m0, s28, 16384
s_lshl_b32 s29, s29, 17
buffer_load_dwordx4 v40, s[12:15], s29 offen lds
s_xor_b32 s29, s76, 6
s_lshl_b32 s28, s29, 10
s_add_u32 s28, s28, s47
s_add_u32 m0, s28, 16384
s_lshl_b32 s29, s29, 17
buffer_load_dwordx4 v40, s[12:15], s29 offen lds
s_xor_b32 s29, s76, 7
s_lshl_b32 s28, s29, 10
s_add_u32 s28, s28, s47
s_add_u32 m0, s28, 16384
s_lshl_b32 s29, s29, 17
buffer_load_dwordx4 v40, s[12:15], s29 offen lds
s_xor_b32 s29, s76, 8
s_lshl_b32 s28, s29, 10
s_add_u32 s28, s28, s47
s_add_u32 m0, s28, 16384
s_lshl_b32 s29, s29, 17
buffer_load_dwordx4 v40, s[12:15], s29 offen lds
s_xor_b32 s29, s76, 9
s_lshl_b32 s28, s29, 10
s_add_u32 s28, s28, s47
s_add_u32 m0, s28, 16384
s_lshl_b32 s29, s29, 17
buffer_load_dwordx4 v40, s[12:15], s29 offen lds
s_xor_b32 s29, s76, 10
s_lshl_b32 s28, s29, 10
s_add_u32 s28, s28, s47
s_add_u32 m0, s28, 16384
s_lshl_b32 s29, s29, 17
buffer_load_dwordx4 v40, s[12:15], s29 offen lds
s_xor_b32 s29, s76, 11
s_lshl_b32 s28, s29, 10
s_add_u32 s28, s28, s47
s_add_u32 m0, s28, 16384
s_lshl_b32 s29, s29, 17
buffer_load_dwordx4 v40, s[12:15], s29 offen lds
s_xor_b32 s29, s76, 12
s_lshl_b32 s28, s29, 10
s_add_u32 s28, s28, s47
s_add_u32 m0, s28, 16384
s_lshl_b32 s29, s29, 17
buffer_load_dwordx4 v40, s[12:15], s29 offen lds
s_xor_b32 s29, s76, 13
s_lshl_b32 s28, s29, 10
s_add_u32 s28, s28, s47
s_add_u32 m0, s28, 16384
s_lshl_b32 s29, s29, 17
buffer_load_dwordx4 v40, s[12:15], s29 offen lds
s_xor_b32 s29, s76, 14
s_lshl_b32 s28, s29, 10
s_add_u32 s28, s28, s47
s_add_u32 m0, s28, 16384
s_lshl_b32 s29, s29, 17
buffer_load_dwordx4 v40, s[12:15], s29 offen lds
s_xor_b32 s29, s76, 15
s_lshl_b32 s28, s29, 10
s_add_u32 s28, s28, s47
s_add_u32 m0, s28, 16384
s_lshl_b32 s29, s29, 17
buffer_load_dwordx4 v40, s[12:15], s29 offen lds
s_mov_b32 s40, 0x00ff00ff
s_mov_b32 s41, 0x00ff00ff
s_mov_b32 s48, 0xff00ff00
s_mov_b32 s49, 0xff00ff00
s_mov_b32 s42, 0
s_mov_b32 s43, 0x00ff00ff
s_mov_b32 s32, 0x3e0293ee
v_mov_b32 v23, 0xff800000
v_mov_b32 v6, 0x4444
v_mov_b32 v4, 0xeeee
v_cndmask_b32 v6, v6, v4, s[48:49]
v_mov_b32 v28, -1
v_mov_b32 v29, -1
v_mov_b32 v30, -1
v_mov_b32 v31, -1
s_mul_i32 s28, s24, 4096
v_add_u32 v7, s28, v17
v_and_b32 v4, 7, v1
v_lshlrev_b32 v8, 11, v4
v_lshrrev_b32 v5, 3, v1
v_lshl_add_u32 v8, v5, 4, v8
s_lshl_b32 s28, s24, 9
v_add_u32 v8, s28, v8
s_lshl_b32 s28, s31, 9
s_lshr_b32 s29, s31, 3
s_mul_i32 s29, s29, 0
s_add_u32 s28, s28, s29
v_lshlrev_b32 v9, 3, v1
v_add_u32 v9, s28, v9
v_and_b32 v4, 7, v3
v_lshlrev_b32 v11, 7, v2
v_lshl_add_u32 v11, v4, 4, v11
v_add_u32 v22, 0, v11
s_add_u32 s28, s28, 24576
v_add_u32 v11, s28, v11
v_and_b32 v5, 1, v2
v_lshlrev_b32 v10, 7, v5
v_lshl_add_u32 v10, v4, 4, v10
v_add_u32 v10, 1024, v10
s_xor_b32 s37, s31, 1
s_mul_i32 s37, s37, 2048
s_add_u32 s37, s37, 49152
s_xor_b32 s38, s31, 2
s_mul_i32 s38, s38, 2048
s_add_u32 s38, s38, 49152
s_xor_b32 s39, s31, 3
s_mul_i32 s39, s39, 2048
s_add_u32 s39, s39, 49152
v_and_b32 v4, 1, v2
v_mul_u32_u24 v14, 576, v4
v_lshrrev_b32 v5, 1, v2
v_lshl_add_u32 v5, v5, 4, v3
v_lshl_add_u32 v14, v5, 2, v14
s_mul_i32 s28, s24, 1152
s_add_u32 s28, s28, 13312
v_add_u32 v18, s28, v14
s_mul_i32 s28, s24, 2304
v_add_u32 v14, s28, v14
v_add_u32 v15, 1152, v14
v_mul_u32_u24 v16, 144, v3
v_lshl_add_u32 v16, v2, 5, v16
v_bfe_u32 v4, v1, 1, 3
v_mul_u32_u24 v19, 144, v4
v_lshl_add_u32 v19, v2, 5, v19
v_and_b32 v4, 1, v1
v_lshl_add_u32 v19, v4, 4, v19
v_add_u32 v19, 13312, v19
s_lshl_b32 s28, s24, 10
s_add_u32 s28, s28, 9216
v_add_u32 v20, s28, v17
v_and_b32 v4, 31, v1
v_lshlrev_b32 v21, 3, v4
v_add_u32 v21, 17920, v21
v_lshrrev_b32 v4, 2, v3
v_and_b32 v42, 1, v4
v_lshrrev_b32 v43, 1, v4
v_lshrrev_b32 v44, 1, v2
v_and_b32 v45, 1, v2
v_lshl_add_u32 v46, v44, 4, v42
v_lshl_add_u32 v46, v45, 2, v46
v_lshl_add_u32 v46, v43, 3, v46
v_lshl_add_u32 v47, v44, 3, v42
v_lshl_add_u32 v47, v45, 4, v47
v_lshl_add_u32 v47, v43, 2, v47
v_and_b32 v5, 3, v3
v_lshlrev_b32 v5, 3, v5
v_lshl_add_u32 v46, v46, 6, v5
v_lshl_add_u32 v47, v47, 6, v5
s_and_b32 s28, s31, 0
s_lshl_b32 s28, s28, 6
s_add_u32 s28, s28, s47
v_add_u32 v46, s28, v46
v_add_u32 v47, s28, v47
s_waitcnt vmcnt(17)
ds_read_b64_tr_b16 a[64:65], v46 offset:0
ds_read_b64_tr_b16 a[66:67], v46 offset:128
ds_read_b64_tr_b16 a[68:69], v46 offset:2048
ds_read_b64_tr_b16 a[70:71], v46 offset:2176
ds_read_b64_tr_b16 a[72:73], v46 offset:4096
ds_read_b64_tr_b16 a[74:75], v46 offset:4224
ds_read_b64_tr_b16 a[76:77], v46 offset:6144
ds_read_b64_tr_b16 a[78:79], v46 offset:6272
s_waitcnt lgkmcnt(0)
ds_read_b64_tr_b16 a[80:81], v46 offset:8192
ds_read_b64_tr_b16 a[82:83], v46 offset:8320
ds_read_b64_tr_b16 a[84:85], v46 offset:10240
ds_read_b64_tr_b16 a[86:87], v46 offset:10368
ds_read_b64_tr_b16 a[88:89], v46 offset:12288
ds_read_b64_tr_b16 a[90:91], v46 offset:12416
ds_read_b64_tr_b16 a[92:93], v46 offset:14336
ds_read_b64_tr_b16 a[94:95], v46 offset:14464
s_waitcnt lgkmcnt(0)
ds_read_b64_tr_b16 a[96:97], v46 offset:32
ds_read_b64_tr_b16 a[98:99], v46 offset:160
ds_read_b64_tr_b16 a[100:101], v46 offset:2080
ds_read_b64_tr_b16 a[102:103], v46 offset:2208
ds_read_b64_tr_b16 a[104:105], v46 offset:4128
ds_read_b64_tr_b16 a[106:107], v46 offset:4256
ds_read_b64_tr_b16 a[108:109], v46 offset:6176
ds_read_b64_tr_b16 a[110:111], v46 offset:6304
s_waitcnt lgkmcnt(0)
ds_read_b64_tr_b16 a[112:113], v46 offset:8224
ds_read_b64_tr_b16 a[114:115], v46 offset:8352
ds_read_b64_tr_b16 a[116:117], v46 offset:10272
ds_read_b64_tr_b16 a[118:119], v46 offset:10400
ds_read_b64_tr_b16 a[120:121], v46 offset:12320
ds_read_b64_tr_b16 a[122:123], v46 offset:12448
ds_read_b64_tr_b16 a[124:125], v46 offset:14368
ds_read_b64_tr_b16 a[126:127], v46 offset:14496
s_waitcnt lgkmcnt(0)
buffer_load_dword v50, v51, s[4:7], 0 offen
s_xor_b32 s29, s76, 0
s_lshl_b32 s28, s29, 10
s_add_u32 s28, s28, s47
s_add_u32 m0, s28, 0
s_lshl_b32 s29, s29, 17
buffer_load_dwordx4 v40, s[4:7], s29 offen lds
s_xor_b32 s29, s76, 1
s_lshl_b32 s28, s29, 10
s_add_u32 s28, s28, s47
s_add_u32 m0, s28, 0
s_lshl_b32 s29, s29, 17
buffer_load_dwordx4 v40, s[4:7], s29 offen lds
s_xor_b32 s29, s76, 2
s_lshl_b32 s28, s29, 10
s_add_u32 s28, s28, s47
s_add_u32 m0, s28, 0
s_lshl_b32 s29, s29, 17
buffer_load_dwordx4 v40, s[4:7], s29 offen lds
s_xor_b32 s29, s76, 3
s_lshl_b32 s28, s29, 10
s_add_u32 s28, s28, s47
s_add_u32 m0, s28, 0
s_lshl_b32 s29, s29, 17
buffer_load_dwordx4 v40, s[4:7], s29 offen lds
s_xor_b32 s29, s76, 4
s_lshl_b32 s28, s29, 10
s_add_u32 s28, s28, s47
s_add_u32 m0, s28, 0
s_lshl_b32 s29, s29, 17
buffer_load_dwordx4 v40, s[4:7], s29 offen lds
s_xor_b32 s29, s76, 5
s_lshl_b32 s28, s29, 10
s_add_u32 s28, s28, s47
s_add_u32 m0, s28, 0
s_lshl_b32 s29, s29, 17
buffer_load_dwordx4 v40, s[4:7], s29 offen lds
s_xor_b32 s29, s76, 6
s_lshl_b32 s28, s29, 10
s_add_u32 s28, s28, s47
s_add_u32 m0, s28, 0
s_lshl_b32 s29, s29, 17
buffer_load_dwordx4 v40, s[4:7], s29 offen lds
s_xor_b32 s29, s76, 7
s_lshl_b32 s28, s29, 10
s_add_u32 s28, s28, s47
s_add_u32 m0, s28, 0
s_lshl_b32 s29, s29, 17
buffer_load_dwordx4 v40, s[4:7], s29 offen lds
s_xor_b32 s29, s76, 8
s_lshl_b32 s28, s29, 10
s_add_u32 s28, s28, s47
s_add_u32 m0, s28, 0
s_lshl_b32 s29, s29, 17
buffer_load_dwordx4 v40, s[4:7], s29 offen lds
s_xor_b32 s29, s76, 9
s_lshl_b32 s28, s29, 10
s_add_u32 s28, s28, s47
s_add_u32 m0, s28, 0
s_lshl_b32 s29, s29, 17
buffer_load_dwordx4 v40, s[4:7], s29 offen lds
s_xor_b32 s29, s76, 10
s_lshl_b32 s28, s29, 10
s_add_u32 s28, s28, s47
s_add_u32 m0, s28, 0
s_lshl_b32 s29, s29, 17
buffer_load_dwordx4 v40, s[4:7], s29 offen lds
s_xor_b32 s29, s76, 11
s_lshl_b32 s28, s29, 10
s_add_u32 s28, s28, s47
s_add_u32 m0, s28, 0
s_lshl_b32 s29, s29, 17
buffer_load_dwordx4 v40, s[4:7], s29 offen lds
s_xor_b32 s29, s76, 12
s_lshl_b32 s28, s29, 10
s_add_u32 s28, s28, s47
s_add_u32 m0, s28, 0
s_lshl_b32 s29, s29, 17
buffer_load_dwordx4 v40, s[4:7], s29 offen lds
s_xor_b32 s29, s76, 13
s_lshl_b32 s28, s29, 10
s_add_u32 s28, s28, s47
s_add_u32 m0, s28, 0
s_lshl_b32 s29, s29, 17
buffer_load_dwordx4 v40, s[4:7], s29 offen lds
s_xor_b32 s29, s76, 14
s_lshl_b32 s28, s29, 10
s_add_u32 s28, s28, s47
s_add_u32 m0, s28, 0
s_lshl_b32 s29, s29, 17
buffer_load_dwordx4 v40, s[4:7], s29 offen lds
s_xor_b32 s29, s76, 15
s_lshl_b32 s28, s29, 10
s_add_u32 s28, s28, s47
s_add_u32 m0, s28, 0
s_lshl_b32 s29, s29, 17
buffer_load_dwordx4 v40, s[4:7], s29 offen lds
s_waitcnt vmcnt(17)
ds_read_b64_tr_b16 a[128:129], v46 offset:16384
ds_read_b64_tr_b16 a[130:131], v46 offset:16512
ds_read_b64_tr_b16 a[132:133], v46 offset:18432
ds_read_b64_tr_b16 a[134:135], v46 offset:18560
ds_read_b64_tr_b16 a[136:137], v46 offset:20480
ds_read_b64_tr_b16 a[138:139], v46 offset:20608
ds_read_b64_tr_b16 a[140:141], v46 offset:22528
ds_read_b64_tr_b16 a[142:143], v46 offset:22656
s_waitcnt lgkmcnt(0)
ds_read_b64_tr_b16 a[144:145], v46 offset:24576
ds_read_b64_tr_b16 a[146:147], v46 offset:24704
ds_read_b64_tr_b16 a[148:149], v46 offset:26624
ds_read_b64_tr_b16 a[150:151], v46 offset:26752
ds_read_b64_tr_b16 a[152:153], v46 offset:28672
ds_read_b64_tr_b16 a[154:155], v46 offset:28800
ds_read_b64_tr_b16 a[156:157], v46 offset:30720
ds_read_b64_tr_b16 a[158:159], v46 offset:30848
s_waitcnt lgkmcnt(0)
ds_read_b64_tr_b16 a[160:161], v46 offset:16416
ds_read_b64_tr_b16 a[162:163], v46 offset:16544
ds_read_b64_tr_b16 a[164:165], v46 offset:18464
ds_read_b64_tr_b16 a[166:167], v46 offset:18592
ds_read_b64_tr_b16 a[168:169], v46 offset:20512
ds_read_b64_tr_b16 a[170:171], v46 offset:20640
ds_read_b64_tr_b16 a[172:173], v46 offset:22560
ds_read_b64_tr_b16 a[174:175], v46 offset:22688
s_waitcnt lgkmcnt(0)
ds_read_b64_tr_b16 a[176:177], v46 offset:24608
ds_read_b64_tr_b16 a[178:179], v46 offset:24736
ds_read_b64_tr_b16 a[180:181], v46 offset:26656
ds_read_b64_tr_b16 a[182:183], v46 offset:26784
ds_read_b64_tr_b16 a[184:185], v46 offset:28704
ds_read_b64_tr_b16 a[186:187], v46 offset:28832
ds_read_b64_tr_b16 a[188:189], v46 offset:30752
ds_read_b64_tr_b16 a[190:191], v46 offset:30880
s_waitcnt lgkmcnt(0)
buffer_load_dword v50, v52, s[16:19], 0 offen
s_xor_b32 s29, s76, 0
s_lshl_b32 s28, s29, 10
s_add_u32 s28, s28, s47
s_add_u32 m0, s28, 16384
s_lshl_b32 s29, s29, 15
buffer_load_dwordx4 v41, s[16:19], s29 offen lds
s_xor_b32 s29, s76, 1
s_lshl_b32 s28, s29, 10
s_add_u32 s28, s28, s47
s_add_u32 m0, s28, 16384
s_lshl_b32 s29, s29, 15
buffer_load_dwordx4 v41, s[16:19], s29 offen lds
s_xor_b32 s29, s76, 2
s_lshl_b32 s28, s29, 10
s_add_u32 s28, s28, s47
s_add_u32 m0, s28, 16384
s_lshl_b32 s29, s29, 15
buffer_load_dwordx4 v41, s[16:19], s29 offen lds
s_xor_b32 s29, s76, 3
s_lshl_b32 s28, s29, 10
s_add_u32 s28, s28, s47
s_add_u32 m0, s28, 16384
s_lshl_b32 s29, s29, 15
buffer_load_dwordx4 v41, s[16:19], s29 offen lds
s_xor_b32 s29, s76, 4
s_lshl_b32 s28, s29, 10
s_add_u32 s28, s28, s47
s_add_u32 m0, s28, 16384
s_lshl_b32 s29, s29, 15
buffer_load_dwordx4 v41, s[16:19], s29 offen lds
s_xor_b32 s29, s76, 5
s_lshl_b32 s28, s29, 10
s_add_u32 s28, s28, s47
s_add_u32 m0, s28, 16384
s_lshl_b32 s29, s29, 15
buffer_load_dwordx4 v41, s[16:19], s29 offen lds
s_xor_b32 s29, s76, 6
s_lshl_b32 s28, s29, 10
s_add_u32 s28, s28, s47
s_add_u32 m0, s28, 16384
s_lshl_b32 s29, s29, 15
buffer_load_dwordx4 v41, s[16:19], s29 offen lds
s_xor_b32 s29, s76, 7
s_lshl_b32 s28, s29, 10
s_add_u32 s28, s28, s47
s_add_u32 m0, s28, 16384
s_lshl_b32 s29, s29, 15
buffer_load_dwordx4 v41, s[16:19], s29 offen lds
s_xor_b32 s29, s76, 8
s_lshl_b32 s28, s29, 10
s_add_u32 s28, s28, s47
s_add_u32 m0, s28, 16384
s_lshl_b32 s29, s29, 15
buffer_load_dwordx4 v41, s[16:19], s29 offen lds
s_xor_b32 s29, s76, 9
s_lshl_b32 s28, s29, 10
s_add_u32 s28, s28, s47
s_add_u32 m0, s28, 16384
s_lshl_b32 s29, s29, 15
buffer_load_dwordx4 v41, s[16:19], s29 offen lds
s_xor_b32 s29, s76, 10
s_lshl_b32 s28, s29, 10
s_add_u32 s28, s28, s47
s_add_u32 m0, s28, 16384
s_lshl_b32 s29, s29, 15
buffer_load_dwordx4 v41, s[16:19], s29 offen lds
s_xor_b32 s29, s76, 11
s_lshl_b32 s28, s29, 10
s_add_u32 s28, s28, s47
s_add_u32 m0, s28, 16384
s_lshl_b32 s29, s29, 15
buffer_load_dwordx4 v41, s[16:19], s29 offen lds
s_xor_b32 s29, s76, 12
s_lshl_b32 s28, s29, 10
s_add_u32 s28, s28, s47
s_add_u32 m0, s28, 16384
s_lshl_b32 s29, s29, 15
buffer_load_dwordx4 v41, s[16:19], s29 offen lds
s_xor_b32 s29, s76, 13
s_lshl_b32 s28, s29, 10
s_add_u32 s28, s28, s47
s_add_u32 m0, s28, 16384
s_lshl_b32 s29, s29, 15
buffer_load_dwordx4 v41, s[16:19], s29 offen lds
s_xor_b32 s29, s76, 14
s_lshl_b32 s28, s29, 10
s_add_u32 s28, s28, s47
s_add_u32 m0, s28, 16384
s_lshl_b32 s29, s29, 15
buffer_load_dwordx4 v41, s[16:19], s29 offen lds
s_xor_b32 s29, s76, 15
s_lshl_b32 s28, s29, 10
s_add_u32 s28, s28, s47
s_add_u32 m0, s28, 16384
s_lshl_b32 s29, s29, 15
buffer_load_dwordx4 v41, s[16:19], s29 offen lds
s_waitcnt vmcnt(17)
ds_read_b64_tr_b16 a[0:1], v46 offset:0
ds_read_b64_tr_b16 a[2:3], v46 offset:128
ds_read_b64_tr_b16 a[4:5], v46 offset:2048
ds_read_b64_tr_b16 a[6:7], v46 offset:2176
ds_read_b64_tr_b16 a[8:9], v46 offset:4096
ds_read_b64_tr_b16 a[10:11], v46 offset:4224
ds_read_b64_tr_b16 a[12:13], v46 offset:6144
ds_read_b64_tr_b16 a[14:15], v46 offset:6272
s_waitcnt lgkmcnt(0)
ds_read_b64_tr_b16 a[16:17], v46 offset:8192
ds_read_b64_tr_b16 a[18:19], v46 offset:8320
ds_read_b64_tr_b16 a[20:21], v46 offset:10240
ds_read_b64_tr_b16 a[22:23], v46 offset:10368
ds_read_b64_tr_b16 a[24:25], v46 offset:12288
ds_read_b64_tr_b16 a[26:27], v46 offset:12416
ds_read_b64_tr_b16 a[28:29], v46 offset:14336
ds_read_b64_tr_b16 a[30:31], v46 offset:14464
s_waitcnt lgkmcnt(0)
ds_read_b64_tr_b16 a[32:33], v46 offset:32
ds_read_b64_tr_b16 a[34:35], v46 offset:160
ds_read_b64_tr_b16 a[36:37], v46 offset:2080
ds_read_b64_tr_b16 a[38:39], v46 offset:2208
ds_read_b64_tr_b16 a[40:41], v46 offset:4128
ds_read_b64_tr_b16 a[42:43], v46 offset:4256
ds_read_b64_tr_b16 a[44:45], v46 offset:6176
ds_read_b64_tr_b16 a[46:47], v46 offset:6304
s_waitcnt lgkmcnt(0)
ds_read_b64_tr_b16 a[48:49], v46 offset:8224
ds_read_b64_tr_b16 a[50:51], v46 offset:8352
ds_read_b64_tr_b16 a[52:53], v46 offset:10272
ds_read_b64_tr_b16 a[54:55], v46 offset:10400
ds_read_b64_tr_b16 a[56:57], v46 offset:12320
ds_read_b64_tr_b16 a[58:59], v46 offset:12448
ds_read_b64_tr_b16 a[60:61], v46 offset:14368
ds_read_b64_tr_b16 a[62:63], v46 offset:14496
s_waitcnt lgkmcnt(0)
v_and_b32 v247, 15, v0
v_lshlrev_b32 v247, 4, v247
buffer_load_dword v246, v247, s[72:75], 0 offen sc1
s_waitcnt vmcnt(0)
ds_read_b64_tr_b16 a[192:193], v47 offset:16384
ds_read_b64_tr_b16 a[194:195], v47 offset:16512
ds_read_b64_tr_b16 a[196:197], v47 offset:18432
ds_read_b64_tr_b16 a[198:199], v47 offset:18560
ds_read_b64_tr_b16 a[200:201], v47 offset:20480
ds_read_b64_tr_b16 a[202:203], v47 offset:20608
ds_read_b64_tr_b16 a[204:205], v47 offset:22528
ds_read_b64_tr_b16 a[206:207], v47 offset:22656
s_waitcnt lgkmcnt(0)
ds_read_b64_tr_b16 a[208:209], v47 offset:24576
ds_read_b64_tr_b16 a[210:211], v47 offset:24704
ds_read_b64_tr_b16 a[212:213], v47 offset:26624
ds_read_b64_tr_b16 a[214:215], v47 offset:26752
ds_read_b64_tr_b16 a[216:217], v47 offset:28672
ds_read_b64_tr_b16 a[218:219], v47 offset:28800
ds_read_b64_tr_b16 a[220:221], v47 offset:30720
ds_read_b64_tr_b16 a[222:223], v47 offset:30848
s_waitcnt lgkmcnt(0)
ds_read_b64_tr_b16 a[224:225], v47 offset:16416
ds_read_b64_tr_b16 a[226:227], v47 offset:16544
ds_read_b64_tr_b16 a[228:229], v47 offset:18464
ds_read_b64_tr_b16 a[230:231], v47 offset:18592
ds_read_b64_tr_b16 a[232:233], v47 offset:20512
ds_read_b64_tr_b16 a[234:235], v47 offset:20640
ds_read_b64_tr_b16 a[236:237], v47 offset:22560
ds_read_b64_tr_b16 a[238:239], v47 offset:22688
s_waitcnt lgkmcnt(0)
ds_read_b64_tr_b16 a[240:241], v47 offset:24608
ds_read_b64_tr_b16 a[242:243], v47 offset:24736
ds_read_b64_tr_b16 a[244:245], v47 offset:26656
ds_read_b64_tr_b16 a[246:247], v47 offset:26784
ds_read_b64_tr_b16 a[248:249], v47 offset:28704
ds_read_b64_tr_b16 a[250:251], v47 offset:28832
ds_read_b64_tr_b16 a[252:253], v47 offset:30752
ds_read_b64_tr_b16 a[254:255], v47 offset:30880
s_waitcnt lgkmcnt(0)
v_and_b32 v247, 15, v0
v_lshlrev_b32 v247, 4, v247
s_branch mega_kernel_syrp
mega_kernel_syrw:
s_sleep 4
mega_kernel_syr:
buffer_load_dword v246, v247, s[72:75], 0 offen sc1
s_waitcnt vmcnt(0)
mega_kernel_syrp:
s_cmp_eq_u32 s95, 1
s_cbranch_scc0 mega_kernel_syrf
v_readlane_b32 s76, v246, 14
s_mov_b32 s98, 0
s_cmp_eq_u32 s76, 32
s_cbranch_scc0 mega_kernel_syrw
s_branch mega_kernel_syrd
mega_kernel_syrf:
s_mov_b32 s77, 0
s_mov_b32 s78, 0
v_readlane_b32 s76, v246, 0
s_add_u32 s77, s77, s76
s_xor_b32 s76, s76, 32
s_or_b32 s78, s78, s76
v_readlane_b32 s76, v246, 1
s_add_u32 s77, s77, s76
s_xor_b32 s76, s76, 32
s_or_b32 s78, s78, s76
v_readlane_b32 s76, v246, 2
s_add_u32 s77, s77, s76
s_xor_b32 s76, s76, 32
s_or_b32 s78, s78, s76
v_readlane_b32 s76, v246, 3
s_add_u32 s77, s77, s76
s_xor_b32 s76, s76, 32
s_or_b32 s78, s78, s76
v_readlane_b32 s76, v246, 4
s_add_u32 s77, s77, s76
s_xor_b32 s76, s76, 32
s_or_b32 s78, s78, s76
v_readlane_b32 s76, v246, 5
s_add_u32 s77, s77, s76
s_xor_b32 s76, s76, 32
s_or_b32 s78, s78, s76
v_readlane_b32 s76, v246, 6
s_add_u32 s77, s77, s76
s_xor_b32 s76, s76, 32
s_or_b32 s78, s78, s76
v_readlane_b32 s76, v246, 7
s_add_u32 s77, s77, s76
s_xor_b32 s76, s76, 32
s_or_b32 s78, s78, s76
s_cmp_eq_u32 s77, 256
s_cbranch_scc0 mega_kernel_syrw
v_mov_b32 v252, v246
s_cmp_eq_u32 s78, 0
s_cbranch_scc0 mega_kernel_slowent
v_readlane_b32 s76, v246, 10
v_readlane_b32 s77, v246, 8
s_cmp_eq_u32 s76, 32
s_cbranch_scc0 mega_kernel_syrw
s_cmp_gt_u32 s77, 16
s_cselect_b32 s98, 1, 0
mega_kernel_syrd:
s_lshr_b32 s28, s31, 4
s_lshl_b32 s28, s28, 14
s_lshl_b32 s29, s98, 13
s_add_u32 s28, s28, s29
s_and_b32 s29, s31, 15
s_lshl_b32 s29, s29, 9
s_add_u32 s28, s28, s29
s_lshl_b32 s29, s30, 16
s_add_u32 s28, s28, s29
s_add_u32 s28, s28, 67108864
v_lshrrev_b32 v12, 1, v17
v_add_u32 v12, s28, v12
v_xor_b32 v25, 0x10000, v12
v_xor_b32 v26, 0x20000, v12
v_xor_b32 v27, 0x30000, v12
v_add_u32 v25, 0, v25
v_add_u32 v26, 0, v26
v_add_u32 v27, 0, v27
s_lshl_b32 s28, s25, 2
s_add_u32 s28, s28, s26
s_mov_b32 s82, s28
s_lshr_b32 s29, s28, 3
s_xor_b32 s29, s29, s98
s_and_b32 s29, s29, 1
s_lshl_b32 s29, s29, 13
s_lshl_b32 s76, s28, 18
s_add_u32 s76, s76, s29
s_mov_b32 s83, s76
v_add_u32 v240, s76, v17
v_add_u32 v241, 33554432, v240
s_lshr_b32 s29, s28, 4
s_xor_b32 s29, s29, s98
s_and_b32 s29, s29, 1
s_lshl_b32 s29, s29, 13
s_lshl_b32 s79, s28, 17
s_add_u32 s79, s79, s29
s_add_u32 s79, s79, 71303168
s_xor_b32 s29, s98, 1
s_lshl_b32 s29, s29, 13
s_lshl_b32 s28, s25, 7
s_add_u32 s28, s28, s29
s_add_u32 s28, s28, 69206016
v_and_b32 v4, 1, v1
v_lshlrev_b32 v24, 12, v4
v_add_u32 v24, s28, v24
s_lshl_b32 s29, s26, 2
v_add_u32 v24, s29, v24
s_xor_b32 s81, s98, 1
s_lshl_b32 s81, s81, 13
s_lshr_b32 s29, s82, 6
s_lshl_b32 s29, s29, 14
s_add_u32 s81, s81, s29
s_and_b32 s29, s82, 63
s_lshl_b32 s29, s29, 7
s_add_u32 s81, s81, s29
s_add_u32 s81, s81, 69222400
v_mov_b32 v220, 0x3f803f80
v_mov_b32 v221, 0x3f803f80
v_mov_b32 v222, 0x3f803f80
v_mov_b32 v223, 0x3f803f80
v_mov_b32 v228, 0
s_mov_b32 s27, 0
s_mov_b32 s46, 0
s_mov_b32 s89, 0
s_mov_b32 s88, 0
s_mov_b32 s44, 18432
s_mov_b32 s45, 18432
s_cmp_eq_u32 s24, 3
s_cbranch_scc0 mega_kernel_rf_pfi
s_mov_b32 s76, 0
s_cmp_gt_i32 s46, s76
s_cbranch_scc1 mega_kernel_rf_pf0ok
mega_kernel_rf_pf0w:
v_mov_b32 v4, 0
s_mov_b64 exec, 3
buffer_atomic_add v4, v24, s[84:87], 0 offen sc0 sc1
s_mov_b64 exec, -1
s_waitcnt vmcnt(0)
v_readlane_b32 s46, v4, 0
v_readlane_b32 s28, v4, 1
s_nop 1
s_min_i32 s46, s46, s28
s_cmp_gt_i32 s46, s76
s_cbranch_scc0 mega_kernel_rf_pf0w
mega_kernel_rf_pf0ok:
s_add_u32 s77, s76, s82
s_bfe_u32 s28, s77, 0x40002
s_lshl_b32 s28, s28, 14
s_and_b32 s77, s77, 3
s_lshl_b32 s77, s77, 11
s_add_u32 s28, s28, s77
s_add_u32 m0, s45, 0
s_nop 0
buffer_load_dwordx4 v240, s[84:87], s28 offen offset:0 sc1 lds
s_add_u32 m0, s45, 0
s_nop 0
buffer_load_dwordx4 v240, s[84:87], s28 offen offset:1024 sc1 lds
s_add_u32 m0, s45, 2048
s_nop 0
buffer_load_dwordx4 v241, s[84:87], s28 offen offset:0 sc1 lds
s_add_u32 m0, s45, 2048
s_nop 0
buffer_load_dwordx4 v241, s[84:87], s28 offen offset:1024 sc1 lds
s_add_u32 s45, s45, 4096
s_cmp_eq_u32 s45, 30720
s_cselect_b32 s45, 18432, s45
s_waitcnt vmcnt(0) lgkmcnt(0)
mega_kernel_rf_pfi:
v_mov_b32 v184, 0
v_mov_b32 v185, 0
v_mov_b32 v186, 0
v_mov_b32 v187, 0
v_mov_b32 v188, 0
v_mov_b32 v189, 0
v_mov_b32 v190, 0
v_mov_b32 v191, 0
v_mov_b32 v192, 0
v_mov_b32 v193, 0
v_mov_b32 v194, 0
v_mov_b32 v195, 0
v_mov_b32 v196, 0
v_mov_b32 v197, 0
v_mov_b32 v198, 0
v_mov_b32 v199, 0
v_mov_b32 v200, 0
v_mov_b32 v201, 0
v_mov_b32 v202, 0
v_mov_b32 v203, 0
v_mov_b32 v204, 0
v_mov_b32 v205, 0
v_mov_b32 v206, 0
v_mov_b32 v207, 0
v_mov_b32 v249, 0
v_mov_b32 v96, 0
v_mov_b32 v97, 0
v_mov_b32 v98, 0
v_mov_b32 v99, 0
v_mov_b32 v100, 0
v_mov_b32 v101, 0
v_mov_b32 v102, 0
v_mov_b32 v103, 0
v_mov_b32 v104, 0
v_mov_b32 v105, 0
v_mov_b32 v106, 0
v_mov_b32 v107, 0
v_mov_b32 v108, 0
v_mov_b32 v109, 0
v_mov_b32 v110, 0
v_mov_b32 v111, 0
v_mov_b32 v112, 0
v_mov_b32 v113, 0
v_mov_b32 v114, 0
v_mov_b32 v115, 0
v_mov_b32 v116, 0
v_mov_b32 v117, 0
v_mov_b32 v118, 0
v_mov_b32 v119, 0
s_barrier
s_and_b32 s29, s27, 1
s_lshl_b32 s33, s29, 17
s_lshl_b32 s28, s30, 18
s_add_u32 s33, s33, s28
s_add_u32 s33, s33, 68157440
s_xor_b32 s34, s33, 131072
s_lshl_b32 s35, s29, 18
s_bfe_u32 s47, s27, 0x10001
s_branch mega_kernel_rf_first
.p2align 6
s_nop 0
s_nop 0
mega_kernel_rf_loop:
buffer_load_dwordx4 v[32:35], v7, s[84:87], s33 offen offset:0 sc1
v_add_u32 v5, s44, v17
ds_read_b128 v[156:159], v5 offset:0
ds_read_b128 v[160:163], v5 offset:1024
ds_read_b128 v[164:167], v5 offset:2048
ds_read_b128 v[168:171], v5 offset:3072
s_nop 4
buffer_load_dwordx4 v[36:39], v7, s[84:87], s33 offen offset:1024 sc1
s_nop 9
buffer_load_dwordx4 v[40:43], v7, s[84:87], s33 offen offset:2048 sc1
s_nop 9
buffer_load_dwordx4 v[44:47], v7, s[84:87], s33 offen offset:3072 sc1
s_waitcnt vmcnt(3)
v_max_u32 v4, v32, v34
v_cmp_eq_u32 vcc, -1, v4
s_cbranch_vccnz mega_kernel_rf_pa_15_0f
v_smfmac_f32_16x16x64_bf16 v[96:99], v[32:35], a[0:7], v6
v_smfmac_f32_16x16x64_bf16 v[100:103], v[32:35], a[32:39], v6
v_smfmac_f32_16x16x64_bf16 v[104:107], v[32:35], a[64:71], v6
s_waitcnt vmcnt(2)
v_max_u32 v4, v36, v38
v_cmp_eq_u32 vcc, -1, v4
v_smfmac_f32_16x16x64_bf16 v[108:111], v[32:35], a[96:103], v6
s_cbranch_vccnz mega_kernel_rf_pa_14_1f
v_smfmac_f32_16x16x64_bf16 v[96:99], v[36:39], a[8:15], v6
v_smfmac_f32_16x16x64_bf16 v[100:103], v[36:39], a[40:47], v6
v_smfmac_f32_16x16x64_bf16 v[104:107], v[36:39], a[72:79], v6
s_waitcnt vmcnt(1)
v_max_u32 v4, v40, v42
v_cmp_eq_u32 vcc, -1, v4
v_smfmac_f32_16x16x64_bf16 v[108:111], v[36:39], a[104:111], v6
s_cbranch_vccnz mega_kernel_rf_pa_12_2f
v_smfmac_f32_16x16x64_bf16 v[96:99], v[40:43], a[16:23], v6
v_smfmac_f32_16x16x64_bf16 v[100:103], v[40:43], a[48:55], v6
v_smfmac_f32_16x16x64_bf16 v[104:107], v[40:43], a[80:87], v6
s_waitcnt vmcnt(0)
v_max_u32 v4, v44, v46
v_cmp_eq_u32 vcc, -1, v4
v_smfmac_f32_16x16x64_bf16 v[108:111], v[40:43], a[112:119], v6
s_cbranch_vccnz mega_kernel_rf_pa_8_3f
v_smfmac_f32_16x16x64_bf16 v[96:99], v[44:47], a[24:31], v6
v_smfmac_f32_16x16x64_bf16 v[100:103], v[44:47], a[56:63], v6
v_smfmac_f32_16x16x64_bf16 v[104:107], v[44:47], a[88:95], v6
v_smfmac_f32_16x16x64_bf16 v[108:111], v[44:47], a[120:127], v6
mega_kernel_rf_pa_d:
mega_kernel_rf_adone:
s_nop 5
v_permlane32_swap_b32 v96, v100
v_permlane32_swap_b32 v97, v101
v_permlane32_swap_b32 v98, v102
v_permlane32_swap_b32 v99, v103
v_pk_add_f32 v[96:97], v[96:97], v[100:101]
v_pk_add_f32 v[98:99], v[98:99], v[102:103]
ds_write2_b32 v14, v96, v97 offset0:0 offset1:36
ds_write2_b32 v14, v98, v99 offset0:72 offset1:108
v_permlane32_swap_b32 v104, v108
v_permlane32_swap_b32 v105, v109
v_permlane32_swap_b32 v106, v110
v_permlane32_swap_b32 v107, v111
v_pk_add_f32 v[104:105], v[104:105], v[108:109]
v_pk_add_f32 v[106:107], v[106:107], v[110:111]
ds_write2_b32 v15, v104, v105 offset0:0 offset1:36
ds_write2_b32 v15, v106, v107 offset0:72 offset1:108
v_smfmac_f32_16x16x64_bf16 v[112:115], v[32:35], a[128:135], v6
v_smfmac_f32_16x16x64_bf16 v[116:119], v[32:35], a[160:167], v6
v_smfmac_f32_16x16x64_bf16 v[112:115], v[36:39], a[136:143], v6
v_smfmac_f32_16x16x64_bf16 v[116:119], v[36:39], a[168:175], v6
s_waitcnt lgkmcnt(0)
s_barrier
s_cmp_lg_u32 s24, 0
s_cbranch_scc1 mega_kernel_rf_side
ds_read_b128 v[120:123], v16 offset:0
ds_read_b128 v[124:127], v16 offset:16
ds_read_b128 v[128:131], v16 offset:2304
ds_read_b128 v[132:135], v16 offset:2320
ds_read_b128 v[136:139], v16 offset:4608
ds_read_b128 v[140:143], v16 offset:4624
ds_read_b128 v[144:147], v16 offset:6912
ds_read_b128 v[148:151], v16 offset:6928
v_smfmac_f32_16x16x64_bf16 v[112:115], v[40:43], a[144:151], v6
v_smfmac_f32_16x16x64_bf16 v[116:119], v[40:43], a[176:183], v6
v_smfmac_f32_16x16x64_bf16 v[112:115], v[44:47], a[152:159], v6
v_smfmac_f32_16x16x64_bf16 v[116:119], v[44:47], a[184:191], v6
s_mul_i32 s28, s31, 2048
s_add_u32 s28, s28, s33
s_add_u32 s28, s28, 49152
s_add_u32 s76, s37, s33
s_add_u32 s77, s38, s33
s_add_u32 s78, s39, s33
s_waitcnt lgkmcnt(4)
v_pk_add_f32 v[120:121], v[120:121], v[128:129]
v_pk_add_f32 v[122:123], v[122:123], v[130:131]
v_pk_add_f32 v[124:125], v[124:125], v[132:133]
v_pk_add_f32 v[126:127], v[126:127], v[134:135]
s_waitcnt lgkmcnt(0)
v_pk_add_f32 v[136:137], v[136:137], v[144:145]
v_pk_add_f32 v[138:139], v[138:139], v[146:147]
v_pk_add_f32 v[140:141], v[140:141], v[148:149]
v_pk_add_f32 v[142:143], v[142:143], v[150:151]
v_pk_add_f32 v[120:121], v[120:121], v[136:137]
v_pk_add_f32 v[122:123], v[122:123], v[138:139]
v_pk_add_f32 v[124:125], v[124:125], v[140:141]
v_pk_add_f32 v[126:127], v[126:127], v[142:143]
v_cvt_pk_bf16_f32 v152, v120, v121
v_cvt_pk_bf16_f32 v153, v122, v123
v_cvt_pk_bf16_f32 v154, v124, v125
v_cvt_pk_bf16_f32 v155, v126, v127
s_nop 1
v_mfma_f32_16x16x32_bf16 v[176:179], v[160:163], v[152:155], 0
v_mfma_f32_16x16x32_bf16 v[172:175], v[156:159], v[152:155], 0
v_mfma_f32_16x16x32_bf16 v[180:183], v[152:155], v[152:155], 0
s_cmp_eq_u32 s27, 63
s_cbranch_scc1 mega_kernel_rf_w0last
s_nop 4
v_mov_b32_dpp v172, v176 row_shr:8 row_mask:0xf bank_mask:0xc
v_mov_b32_dpp v173, v177 row_shr:8 row_mask:0xf bank_mask:0xc
v_mov_b32_dpp v174, v178 row_shr:8 row_mask:0xf bank_mask:0xc
v_mov_b32_dpp v175, v179 row_shr:8 row_mask:0xf bank_mask:0xc
v_min_u32 v180, -2, v180
v_min_u32 v172, -2, v172
s_mov_b64 exec, s[42:43]
buffer_store_dwordx4 v[180:183], v10, s[84:87], s28 offen
s_mov_b64 exec, -1
buffer_store_dwordx4 v[172:175], v17, s[84:87], s28 offen
v_permlane32_swap_b32 v112, v116
v_permlane32_swap_b32 v113, v117
v_permlane32_swap_b32 v114, v118
v_permlane32_swap_b32 v115, v119
v_pk_add_f32 v[112:113], v[112:113], v[116:117]
v_pk_add_f32 v[114:115], v[114:115], v[118:119]
ds_write_b128 v20, v[112:115]
s_waitcnt lgkmcnt(0)
s_barrier
v_mov_b32 v96, 0
v_mov_b32 v97, 0
v_mov_b32 v98, 0
v_mov_b32 v99, 0
v_mov_b32 v100, 0
v_mov_b32 v101, 0
v_mov_b32 v102, 0
v_mov_b32 v103, 0
v_cndmask_b32 v176, v23, v180, s[42:43]
v_cndmask_b32 v177, v23, v181, s[42:43]
v_cndmask_b32 v178, v23, v182, s[42:43]
v_cndmask_b32 v179, v23, v183, s[42:43]
s_mov_b64 exec, s[42:43]
buffer_load_dwordx4 v[188:191], v10, s[84:87], s76 offen sc1
buffer_load_dwordx4 v[196:199], v10, s[84:87], s77 offen sc1
buffer_load_dwordx4 v[204:207], v10, s[84:87], s78 offen sc1
s_mov_b64 exec, -1
buffer_load_dwordx4 v[184:187], v17, s[84:87], s76 offen sc1
buffer_load_dwordx4 v[192:195], v17, s[84:87], s77 offen sc1
buffer_load_dwordx4 v[200:203], v17, s[84:87], s78 offen sc1
v_pk_mul_f32 v[172:173], v[172:173], s[32:33] op_sel_hi:[1,0]
v_pk_mul_f32 v[174:175], v[174:175], s[32:33] op_sel_hi:[1,0]
v_pk_mul_f32 v[176:177], v[176:177], s[32:33] op_sel_hi:[1,0]
v_pk_mul_f32 v[178:179], v[178:179], s[32:33] op_sel_hi:[1,0]
s_lshl_b32 s89, s47, 31
s_or_b32 s89, s89, 0x3b39999a
s_nop 15
s_nop 1
s_mov_b64 exec, s[42:43]
buffer_load_dwordx4 v[188:191], v10, s[84:87], s76 offen sc1
buffer_load_dwordx4 v[196:199], v10, s[84:87], s77 offen sc1
buffer_load_dwordx4 v[204:207], v10, s[84:87], s78 offen sc1
s_mov_b64 exec, -1
buffer_load_dwordx4 v[184:187], v17, s[84:87], s76 offen sc1
buffer_load_dwordx4 v[192:195], v17, s[84:87], s77 offen sc1
buffer_load_dwordx4 v[200:203], v17, s[84:87], s78 offen sc1
mega_kernel_rf_p2:
s_waitcnt vmcnt(6)
v_max3_u32 v4, v184, v188, v192
v_max3_u32 v5, v196, v200, v204
v_max_u32 v4, v4, v5
v_cmp_eq_u32 vcc, -1, v4
s_cbranch_vccnz mega_kernel_rf_p2r
v_pk_add_f32 v[124:125], v[196:197], v[204:205]
v_pk_add_f32 v[126:127], v[198:199], v[206:207]
v_pk_add_f32 v[120:121], v[192:193], v[200:201]
v_pk_add_f32 v[122:123], v[194:195], v[202:203]
v_pk_add_f32 v[124:125], v[124:125], v[188:189]
v_pk_add_f32 v[126:127], v[126:127], v[190:191]
v_pk_add_f32 v[120:121], v[120:121], v[184:185]
v_pk_add_f32 v[122:123], v[122:123], v[186:187]
v_pk_fma_f32 v[176:177], v[124:125], s[32:33], v[176:177] op_sel_hi:[1,0,1]
v_pk_fma_f32 v[178:179], v[126:127], s[32:33], v[178:179] op_sel_hi:[1,0,1]
v_pk_fma_f32 v[172:173], v[120:121], s[32:33], v[172:173] op_sel_hi:[1,0,1]
v_pk_fma_f32 v[174:175], v[122:123], s[32:33], v[174:175] op_sel_hi:[1,0,1]
v_max3_f32 v232, v172, v173, v174
v_max3_f32 v233, v176, v177, v178
v_max3_f32 v232, v232, v175, v179
v_max_f32 v234, v232, v233
s_barrier
ds_read2_b64 v[208:211], v21 offset0:0 offset1:32
v_max_f32_dpp v232, v234, v234 row_ror:8 row_mask:0xf bank_mask:0xf
v_max_f32_dpp v233, v234, v234 row_ror:8 row_mask:0xf bank_mask:0xf
s_nop 1
v_permlane16_swap_b32 v232, v233
s_nop 0
v_max_f32 v234, v232, v233
v_max_f32 v235, v232, v233
s_nop 1
v_permlane32_swap_b32 v234, v235
s_nop 0
v_max_f32 v232, v234, v235
v_pk_add_f32 v[176:177], v[176:177], v[232:233] op_sel_hi:[1,0] neg_lo:[0,1] neg_hi:[0,1]
v_pk_add_f32 v[178:179], v[178:179], v[232:233] op_sel_hi:[1,0] neg_lo:[0,1] neg_hi:[0,1]
v_pk_add_f32 v[172:173], v[172:173], v[232:233] op_sel_hi:[1,0] neg_lo:[0,1] neg_hi:[0,1]
v_pk_add_f32 v[174:175], v[174:175], v[232:233] op_sel_hi:[1,0] neg_lo:[0,1] neg_hi:[0,1]
v_exp_f32 v176, v176
v_exp_f32 v177, v177
v_exp_f32 v178, v178
v_exp_f32 v179, v179
v_exp_f32 v172, v172
v_cvt_pk_bf16_f32 v216, v176, v177
v_cvt_pk_bf16_f32 v217, v178, v179
v_exp_f32 v173, v173
v_exp_f32 v174, v174
v_mfma_f32_16x16x16_bf16 v[224:227], v[220:221], v[216:217], 0
v_exp_f32 v175, v175
v_cvt_pk_bf16_f32 v212, v172, v173
s_waitcnt lgkmcnt(0)
v_mfma_f32_16x16x16_bf16 v[120:123], v[208:209], v[216:217], 0
v_cvt_pk_bf16_f32 v213, v174, v175
v_mfma_f32_16x16x16_bf16 v[124:127], v[210:211], v[216:217], 0
v_mov_b32_dpp v214, v212 row_ror:8 row_mask:0xf bank_mask:0xf
v_mov_b32_dpp v215, v213 row_ror:8 row_mask:0xf bank_mask:0xf
s_nop 1
v_mfma_f32_16x16x32_bf16 v[224:227], v[220:223], v[212:215], v[224:227]
v_mfma_f32_16x16x32_bf16 v[120:123], v[164:167], v[212:215], v[120:123]
v_mfma_f32_16x16x32_bf16 v[124:127], v[168:171], v[212:215], v[124:127]
s_add_u32 s29, s33, 24576
s_nop 4
v_rcp_f32 v234, v224
s_nop 0
v_pk_mul_f32 v[120:121], v[120:121], v[234:235] op_sel_hi:[1,0]
v_pk_mul_f32 v[122:123], v[122:123], v[234:235] op_sel_hi:[1,0]
v_pk_mul_f32 v[124:125], v[124:125], v[234:235] op_sel_hi:[1,0]
v_pk_mul_f32 v[126:127], v[126:127], v[234:235] op_sel_hi:[1,0]
v_cvt_pk_bf16_f32 v212, v120, v121
v_cvt_pk_bf16_f32 v213, v122, v123
v_cvt_pk_bf16_f32 v214, v124, v125
v_cvt_pk_bf16_f32 v215, v126, v127
v_min_u32 v212, -2, v212
s_mov_b64 exec, s[40:41]
buffer_store_dwordx4 v[212:215], v11, s[84:87], s33 offen
s_mov_b64 exec, -1
mega_kernel_rf_b3:
s_barrier
s_nop 15
buffer_load_dwordx4 v[32:35], v7, s[84:87], s29 offen offset:0 sc1
s_nop 9
buffer_load_dwordx4 v[36:39], v7, s[84:87], s29 offen offset:1024 sc1
s_nop 9
buffer_load_dwordx4 v[40:43], v7, s[84:87], s29 offen offset:2048 sc1
s_nop 9
buffer_load_dwordx4 v[44:47], v7, s[84:87], s29 offen offset:3072 sc1
mega_kernel_rf_pc_15_0:
s_waitcnt vmcnt(3)
v_cmp_eq_u32 vcc, -1, v32
s_cbranch_vccnz mega_kernel_rf_pc_15_0f
v_smfmac_f32_16x16x64_bf16 v[96:99], v[32:35], a[192:199], v6
v_smfmac_f32_16x16x64_bf16 v[100:103], v[32:35], a[224:231], v6
mega_kernel_rf_pc_14_1:
s_waitcnt vmcnt(2)
v_cmp_eq_u32 vcc, -1, v36
s_cbranch_vccnz mega_kernel_rf_pc_14_1f
v_smfmac_f32_16x16x64_bf16 v[96:99], v[36:39], a[200:207], v6
v_smfmac_f32_16x16x64_bf16 v[100:103], v[36:39], a[232:239], v6
mega_kernel_rf_pc_12_2:
s_waitcnt vmcnt(1)
v_cmp_eq_u32 vcc, -1, v40
s_cbranch_vccnz mega_kernel_rf_pc_12_2f
v_smfmac_f32_16x16x64_bf16 v[96:99], v[40:43], a[208:215], v6
v_smfmac_f32_16x16x64_bf16 v[100:103], v[40:43], a[240:247], v6
mega_kernel_rf_pc_8_3:
s_waitcnt vmcnt(0)
v_cmp_eq_u32 vcc, -1, v44
s_cbranch_vccnz mega_kernel_rf_pc_8_3f
v_smfmac_f32_16x16x64_bf16 v[96:99], v[44:47], a[216:223], v6
v_smfmac_f32_16x16x64_bf16 v[100:103], v[44:47], a[248:255], v6
mega_kernel_rf_pc_d:
s_nop 7
v_permlane32_swap_b32 v96, v100
v_permlane32_swap_b32 v97, v101
v_permlane32_swap_b32 v98, v102
v_permlane32_swap_b32 v99, v103
v_pk_add_f32 v[96:97], v[96:97], v[100:101]
v_pk_add_f32 v[98:99], v[98:99], v[102:103]
ds_write2_b32 v18, v96, v97 offset0:0 offset1:36
ds_write2_b32 v18, v98, v99 offset0:72 offset1:108
s_waitcnt lgkmcnt(0)
s_barrier
s_cmp_lg_u32 s24, 0
s_cbranch_scc1 mega_kernel_rf_x1
ds_read_b128 v[120:123], v19 offset:0
ds_read_b128 v[124:127], v19 offset:1152
ds_read_b128 v[128:131], v19 offset:2304
ds_read_b128 v[132:135], v19 offset:3456
s_waitcnt lgkmcnt(2)
v_pk_add_f32 v[120:121], v[120:121], v[124:125]
v_pk_add_f32 v[122:123], v[122:123], v[126:127]
s_waitcnt lgkmcnt(0)
v_pk_add_f32 v[128:129], v[128:129], v[132:133]
v_pk_add_f32 v[130:131], v[130:131], v[134:135]
v_pk_add_f32 v[120:121], v[120:121], v[128:129]
v_pk_add_f32 v[122:123], v[122:123], v[130:131]
v_fma_f32 v212, v120, s89, v120
v_cvt_pk_bf16_f32 v213, v122, v123
v_cvt_pk_bf16_f32 v212, v212, v121
v_and_or_b32 v212, v212, -2, s47
buffer_store_dwordx2 v[212:213], v12, s[84:87], s35 offen sc1
s_mov_b32 s77, 0x3f80
s_mov_b32 s78, 0x3f800000
s_xor_b32 s76, s47, 1
v_mov_b32 v48, s76
v_mov_b32 v50, s76
v_mov_b32 v52, s76
s_nop 8
v_mov_b32 v96, 0
v_mov_b32 v97, 0
v_mov_b32 v98, 0
v_mov_b32 v99, 0
v_mov_b32 v100, 0
v_mov_b32 v101, 0
v_mov_b32 v102, 0
v_mov_b32 v103, 0
v_mov_b32 v104, 0
v_mov_b32 v105, 0
v_mov_b32 v106, 0
v_mov_b32 v107, 0
v_mov_b32 v108, 0
v_mov_b32 v109, 0
v_mov_b32 v110, 0
v_mov_b32 v111, 0
v_mov_b32 v112, 0
v_mov_b32 v113, 0
v_mov_b32 v114, 0
v_mov_b32 v115, 0
v_mov_b32 v116, 0
v_mov_b32 v117, 0
v_mov_b32 v118, 0
v_mov_b32 v119, 0
s_nop 15
s_nop 7
s_cmp_eq_u32 s47, 1
s_cbranch_scc1 mega_kernel_rf_p4_1
.p2align 6
mega_kernel_rf_p4_0:
buffer_load_dwordx2 v[48:49], v25, s[84:87], s35 offen sc1
buffer_load_dwordx2 v[50:51], v26, s[84:87], s35 offen sc1
buffer_load_dwordx2 v[52:53], v27, s[84:87], s35 offen sc1
s_waitcnt vmcnt(12)
mega_kernel_rf_p4c_0:
v_bitop3_b32 v4, v48, v50, v52 bitop3:0xfe
v_and_b32 v4, 1, v4
v_cmp_ne_u32 vcc, 0, v4
s_cbranch_vccnz mega_kernel_rf_p4_0
v_dot2_f32_bf16 v120, v48, s77, v120
v_dot2_f32_bf16 v121, v48, s78, v121
v_dot2_f32_bf16 v122, v49, s77, v122
v_dot2_f32_bf16 v123, v49, s78, v123
v_dot2_f32_bf16 v120, v50, s77, v120
v_dot2_f32_bf16 v121, v50, s78, v121
v_dot2_f32_bf16 v122, v51, s77, v122
v_dot2_f32_bf16 v123, v51, s78, v123
v_dot2_f32_bf16 v120, v52, s77, v120
v_dot2_f32_bf16 v121, v52, s78, v121
v_dot2_f32_bf16 v122, v53, s77, v122
v_dot2_f32_bf16 v123, v53, s78, v123
s_nop 0
v_cvt_pk_bf16_f32 v212, v120, v121
v_min_u32 v212, -2, v212
v_cvt_pk_bf16_f32 v213, v122, v123
buffer_store_dwordx2 v[212:213], v9, s[84:87], s34 offen
s_branch mega_kernel_rf_p4d
.p2align 6
mega_kernel_rf_p4_1:
buffer_load_dwordx2 v[48:49], v25, s[84:87], s35 offen sc1
buffer_load_dwordx2 v[50:51], v26, s[84:87], s35 offen sc1
buffer_load_dwordx2 v[52:53], v27, s[84:87], s35 offen sc1
s_waitcnt vmcnt(12)
mega_kernel_rf_p4c_1:
v_bitop3_b32 v4, v48, v50, v52 bitop3:0x80
v_and_b32 v4, 1, v4
v_cmp_ne_u32 vcc, 1, v4
s_cbranch_vccnz mega_kernel_rf_p4_1
v_dot2_f32_bf16 v120, v48, s77, v120
v_dot2_f32_bf16 v121, v48, s78, v121
v_dot2_f32_bf16 v122, v49, s77, v122
v_dot2_f32_bf16 v123, v49, s78, v123
v_dot2_f32_bf16 v120, v50, s77, v120
v_dot2_f32_bf16 v121, v50, s78, v121
v_dot2_f32_bf16 v122, v51, s77, v122
v_dot2_f32_bf16 v123, v51, s78, v123
v_dot2_f32_bf16 v120, v52, s77, v120
v_dot2_f32_bf16 v121, v52, s78, v121
v_dot2_f32_bf16 v122, v53, s77, v122
v_dot2_f32_bf16 v123, v53, s78, v123
s_nop 0
v_cvt_pk_bf16_f32 v212, v120, v121
v_min_u32 v212, -2, v212
v_cvt_pk_bf16_f32 v213, v122, v123
buffer_store_dwordx2 v[212:213], v9, s[84:87], s34 offen
mega_kernel_rf_p4d:
mega_kernel_rf_b5:
s_add_u32 s27, s27, 1
s_add_u32 s44, s44, 4096
s_cmp_eq_u32 s44, 30720
s_cselect_b32 s44, 18432, s44
s_mov_b32 s28, s33
s_mov_b32 s33, s34
s_mov_b32 s34, s28
s_xor_b32 s35, s35, 262144
s_bfe_u32 s47, s27, 0x10001
s_barrier
s_nop 15
s_branch mega_kernel_rf_loop
mega_kernel_rf_x1:
s_cmp_eq_u32 s24, 1
s_cbranch_scc0 mega_kernel_rf_x2
s_add_u32 s76, s27, 1
v_mov_b32 v5, s76
s_mov_b64 exec, 1
buffer_store_dword v5, v228, s[84:87], s81 offen sc1
s_mov_b64 exec, -1
mega_kernel_rf_x2:
s_cmp_eq_u32 s24, 3
s_cbranch_scc0 mega_kernel_rf_x4
s_cmp_eq_u32 s36, 1
s_cbranch_scc0 mega_kernel_rf_x5
s_add_u32 s76, s27, 1
s_cmp_gt_i32 s46, s76
s_cbranch_scc1 mega_kernel_rf_pf1ok
mega_kernel_rf_pf1w:
v_mov_b32 v4, 0
s_mov_b64 exec, 3
buffer_atomic_add v4, v24, s[84:87], 0 offen sc0 sc1
s_mov_b64 exec, -1
s_waitcnt vmcnt(0)
v_readlane_b32 s46, v4, 0
v_readlane_b32 s28, v4, 1
s_nop 1
s_min_i32 s46, s46, s28
s_cmp_gt_i32 s46, s76
s_cbranch_scc0 mega_kernel_rf_pf1w
mega_kernel_rf_pf1ok:
s_add_u32 s77, s76, s82
s_bfe_u32 s28, s77, 0x40002
s_lshl_b32 s28, s28, 14
s_and_b32 s77, s77, 3
s_lshl_b32 s77, s77, 11
s_add_u32 s28, s28, s77
s_add_u32 m0, s45, 0
s_nop 0
buffer_load_dwordx4 v240, s[84:87], s28 offen offset:0 sc1 lds
s_add_u32 m0, s45, 0
s_nop 0
buffer_load_dwordx4 v240, s[84:87], s28 offen offset:1024 sc1 lds
s_add_u32 m0, s45, 2048
s_nop 0
buffer_load_dwordx4 v241, s[84:87], s28 offen offset:0 sc1 lds
s_add_u32 m0, s45, 2048
s_nop 0
buffer_load_dwordx4 v241, s[84:87], s28 offen offset:1024 sc1 lds
s_add_u32 s45, s45, 4096
s_cmp_eq_u32 s45, 30720
s_cselect_b32 s45, 18432, s45
s_waitcnt vmcnt(0)
mega_kernel_rf_x5:
s_add_u32 s76, s27, 4
s_min_u32 s76, s76, 63
s_cmp_gt_i32 s46, s76
s_cbranch_scc1 mega_kernel_rf_x6
v_mov_b32 v249, 0
s_mov_b64 exec, 3
buffer_atomic_add v249, v24, s[84:87], 0 offen sc0 sc1
s_mov_b64 exec, -1
mega_kernel_rf_x6:
s_add_u32 s76, s27, 2
s_cmp_lt_u32 s76, 63
s_cbranch_scc0 mega_kernel_rf_x4
s_cmp_gt_i32 s46, s76
s_cbranch_scc0 mega_kernel_rf_x4
s_add_u32 s77, s76, s82
s_bfe_u32 s28, s77, 0x40002
s_lshl_b32 s28, s28, 14
s_and_b32 s77, s77, 3
s_lshl_b32 s77, s77, 11
s_add_u32 s28, s28, s77
s_add_u32 s28, s28, s83
s_add_u32 s28, s28, 33554432
s_buffer_load_dword s78, s[84:87], s28 offset:0
s_buffer_load_dword s78, s[84:87], s28 offset:128
s_buffer_load_dword s78, s[84:87], s28 offset:256
s_buffer_load_dword s78, s[84:87], s28 offset:384
s_buffer_load_dword s78, s[84:87], s28 offset:512
s_buffer_load_dword s78, s[84:87], s28 offset:640
s_buffer_load_dword s78, s[84:87], s28 offset:768
s_buffer_load_dword s78, s[84:87], s28 offset:896
s_buffer_load_dword s78, s[84:87], s28 offset:1024
s_buffer_load_dword s78, s[84:87], s28 offset:1152
s_buffer_load_dword s78, s[84:87], s28 offset:1280
s_buffer_load_dword s78, s[84:87], s28 offset:1408
s_buffer_load_dword s78, s[84:87], s28 offset:1536
s_buffer_load_dword s78, s[84:87], s28 offset:1664
s_buffer_load_dword s78, s[84:87], s28 offset:1792
s_buffer_load_dword s78, s[84:87], s28 offset:1920
s_mov_b32 s89, s76
mega_kernel_rf_x4:
v_mov_b32 v96, 0
v_mov_b32 v97, 0
v_mov_b32 v98, 0
v_mov_b32 v99, 0
v_mov_b32 v100, 0
v_mov_b32 v101, 0
v_mov_b32 v102, 0
v_mov_b32 v103, 0
v_mov_b32 v104, 0
v_mov_b32 v105, 0
v_mov_b32 v106, 0
v_mov_b32 v107, 0
v_mov_b32 v108, 0
v_mov_b32 v109, 0
v_mov_b32 v110, 0
v_mov_b32 v111, 0
v_mov_b32 v112, 0
v_mov_b32 v113, 0
v_mov_b32 v114, 0
v_mov_b32 v115, 0
v_mov_b32 v116, 0
v_mov_b32 v117, 0
v_mov_b32 v118, 0
v_mov_b32 v119, 0
s_branch mega_kernel_rf_b5
mega_kernel_rf_p2r:
s_mov_b64 exec, s[42:43]
buffer_load_dwordx4 v[188:191], v10, s[84:87], s76 offen sc1
buffer_load_dwordx4 v[196:199], v10, s[84:87], s77 offen sc1
buffer_load_dwordx4 v[204:207], v10, s[84:87], s78 offen sc1
s_mov_b64 exec, -1
buffer_load_dwordx4 v[184:187], v17, s[84:87], s76 offen sc1
buffer_load_dwordx4 v[192:195], v17, s[84:87], s77 offen sc1
buffer_load_dwordx4 v[200:203], v17, s[84:87], s78 offen sc1
s_branch mega_kernel_rf_p2
.p2align 5
mega_kernel_rf_pa_1_0f:
s_mov_b64 exec, vcc
buffer_load_dwordx4 v[32:35], v7, s[84:87], s33 offen offset:0 sc1
s_mov_b64 exec, -1
s_branch mega_kernel_rf_pa_1_0
.p2align 5
mega_kernel_rf_pa_1_0:
s_waitcnt vmcnt(0)
v_max_u32 v4, v32, v34
v_cmp_eq_u32 vcc, -1, v4
s_cbranch_vccnz mega_kernel_rf_pa_1_0f
v_smfmac_f32_16x16x64_bf16 v[96:99], v[32:35], a[0:7], v6
v_smfmac_f32_16x16x64_bf16 v[100:103], v[32:35], a[32:39], v6
v_smfmac_f32_16x16x64_bf16 v[104:107], v[32:35], a[64:71], v6
v_smfmac_f32_16x16x64_bf16 v[108:111], v[32:35], a[96:103], v6
s_branch mega_kernel_rf_pa_d
.p2align 5
mega_kernel_rf_pa_2_1f:
s_mov_b64 exec, vcc
buffer_load_dwordx4 v[36:39], v7, s[84:87], s33 offen offset:1024 sc1
s_mov_b64 exec, -1
s_branch mega_kernel_rf_pa_2_1
.p2align 5
mega_kernel_rf_pa_2_1:
s_waitcnt vmcnt(0)
v_max_u32 v4, v36, v38
v_cmp_eq_u32 vcc, -1, v4
s_cbranch_vccnz mega_kernel_rf_pa_2_1f
v_smfmac_f32_16x16x64_bf16 v[96:99], v[36:39], a[8:15], v6
v_smfmac_f32_16x16x64_bf16 v[100:103], v[36:39], a[40:47], v6
v_smfmac_f32_16x16x64_bf16 v[104:107], v[36:39], a[72:79], v6
v_smfmac_f32_16x16x64_bf16 v[108:111], v[36:39], a[104:111], v6
s_branch mega_kernel_rf_pa_d
.p2align 5
mega_kernel_rf_pa_3_0f:
s_mov_b64 exec, vcc
buffer_load_dwordx4 v[32:35], v7, s[84:87], s33 offen offset:0 sc1
s_mov_b64 exec, -1
s_branch mega_kernel_rf_pa_3_1
.p2align 5
mega_kernel_rf_pa_3_0:
s_waitcnt vmcnt(1)
v_max_u32 v4, v32, v34
v_cmp_eq_u32 vcc, -1, v4
s_cbranch_vccnz mega_kernel_rf_pa_3_0f
v_smfmac_f32_16x16x64_bf16 v[96:99], v[32:35], a[0:7], v6
v_smfmac_f32_16x16x64_bf16 v[100:103], v[32:35], a[32:39], v6
v_smfmac_f32_16x16x64_bf16 v[104:107], v[32:35], a[64:71], v6
v_smfmac_f32_16x16x64_bf16 v[108:111], v[32:35], a[96:103], v6
s_branch mega_kernel_rf_pa_2_1
.p2align 5
mega_kernel_rf_pa_3_1f:
s_mov_b64 exec, vcc
buffer_load_dwordx4 v[36:39], v7, s[84:87], s33 offen offset:1024 sc1
s_mov_b64 exec, -1
s_branch mega_kernel_rf_pa_3_0
.p2align 5
mega_kernel_rf_pa_3_1:
s_waitcnt vmcnt(1)
v_max_u32 v4, v36, v38
v_cmp_eq_u32 vcc, -1, v4
s_cbranch_vccnz mega_kernel_rf_pa_3_1f
v_smfmac_f32_16x16x64_bf16 v[96:99], v[36:39], a[8:15], v6
v_smfmac_f32_16x16x64_bf16 v[100:103], v[36:39], a[40:47], v6
v_smfmac_f32_16x16x64_bf16 v[104:107], v[36:39], a[72:79], v6
v_smfmac_f32_16x16x64_bf16 v[108:111], v[36:39], a[104:111], v6
s_branch mega_kernel_rf_pa_1_0
.p2align 5
mega_kernel_rf_pa_4_2f:
s_mov_b64 exec, vcc
buffer_load_dwordx4 v[40:43], v7, s[84:87], s33 offen offset:2048 sc1
s_mov_b64 exec, -1
s_branch mega_kernel_rf_pa_4_2
.p2align 5
mega_kernel_rf_pa_4_2:
s_waitcnt vmcnt(0)
v_max_u32 v4, v40, v42
v_cmp_eq_u32 vcc, -1, v4
s_cbranch_vccnz mega_kernel_rf_pa_4_2f
v_smfmac_f32_16x16x64_bf16 v[96:99], v[40:43], a[16:23], v6
v_smfmac_f32_16x16x64_bf16 v[100:103], v[40:43], a[48:55], v6
v_smfmac_f32_16x16x64_bf16 v[104:107], v[40:43], a[80:87], v6
v_smfmac_f32_16x16x64_bf16 v[108:111], v[40:43], a[112:119], v6
s_branch mega_kernel_rf_pa_d
.p2align 5
mega_kernel_rf_pa_5_0f:
s_mov_b64 exec, vcc
buffer_load_dwordx4 v[32:35], v7, s[84:87], s33 offen offset:0 sc1
s_mov_b64 exec, -1
s_branch mega_kernel_rf_pa_5_2
.p2align 5
mega_kernel_rf_pa_5_0:
s_waitcnt vmcnt(1)
v_max_u32 v4, v32, v34
v_cmp_eq_u32 vcc, -1, v4
s_cbranch_vccnz mega_kernel_rf_pa_5_0f
v_smfmac_f32_16x16x64_bf16 v[96:99], v[32:35], a[0:7], v6
v_smfmac_f32_16x16x64_bf16 v[100:103], v[32:35], a[32:39], v6
v_smfmac_f32_16x16x64_bf16 v[104:107], v[32:35], a[64:71], v6
v_smfmac_f32_16x16x64_bf16 v[108:111], v[32:35], a[96:103], v6
s_branch mega_kernel_rf_pa_4_2
.p2align 5
mega_kernel_rf_pa_5_2f:
s_mov_b64 exec, vcc
buffer_load_dwordx4 v[40:43], v7, s[84:87], s33 offen offset:2048 sc1
s_mov_b64 exec, -1
s_branch mega_kernel_rf_pa_5_0
.p2align 5
mega_kernel_rf_pa_5_2:
s_waitcnt vmcnt(1)
v_max_u32 v4, v40, v42
v_cmp_eq_u32 vcc, -1, v4
s_cbranch_vccnz mega_kernel_rf_pa_5_2f
v_smfmac_f32_16x16x64_bf16 v[96:99], v[40:43], a[16:23], v6
v_smfmac_f32_16x16x64_bf16 v[100:103], v[40:43], a[48:55], v6
v_smfmac_f32_16x16x64_bf16 v[104:107], v[40:43], a[80:87], v6
v_smfmac_f32_16x16x64_bf16 v[108:111], v[40:43], a[112:119], v6
s_branch mega_kernel_rf_pa_1_0
.p2align 5
mega_kernel_rf_pa_6_1f:
s_mov_b64 exec, vcc
buffer_load_dwordx4 v[36:39], v7, s[84:87], s33 offen offset:1024 sc1
s_mov_b64 exec, -1
s_branch mega_kernel_rf_pa_6_2
.p2align 5
mega_kernel_rf_pa_6_1:
s_waitcnt vmcnt(1)
v_max_u32 v4, v36, v38
v_cmp_eq_u32 vcc, -1, v4
s_cbranch_vccnz mega_kernel_rf_pa_6_1f
v_smfmac_f32_16x16x64_bf16 v[96:99], v[36:39], a[8:15], v6
v_smfmac_f32_16x16x64_bf16 v[100:103], v[36:39], a[40:47], v6
v_smfmac_f32_16x16x64_bf16 v[104:107], v[36:39], a[72:79], v6
v_smfmac_f32_16x16x64_bf16 v[108:111], v[36:39], a[104:111], v6
s_branch mega_kernel_rf_pa_4_2
.p2align 5
mega_kernel_rf_pa_6_2f:
s_mov_b64 exec, vcc
buffer_load_dwordx4 v[40:43], v7, s[84:87], s33 offen offset:2048 sc1
s_mov_b64 exec, -1
s_branch mega_kernel_rf_pa_6_1
.p2align 5
mega_kernel_rf_pa_6_2:
s_waitcnt vmcnt(1)
v_max_u32 v4, v40, v42
v_cmp_eq_u32 vcc, -1, v4
s_cbranch_vccnz mega_kernel_rf_pa_6_2f
v_smfmac_f32_16x16x64_bf16 v[96:99], v[40:43], a[16:23], v6
v_smfmac_f32_16x16x64_bf16 v[100:103], v[40:43], a[48:55], v6
v_smfmac_f32_16x16x64_bf16 v[104:107], v[40:43], a[80:87], v6
v_smfmac_f32_16x16x64_bf16 v[108:111], v[40:43], a[112:119], v6
s_branch mega_kernel_rf_pa_2_1
.p2align 5
mega_kernel_rf_pa_7_0f:
s_mov_b64 exec, vcc
buffer_load_dwordx4 v[32:35], v7, s[84:87], s33 offen offset:0 sc1
s_mov_b64 exec, -1
s_branch mega_kernel_rf_pa_7_1
.p2align 5
mega_kernel_rf_pa_7_0:
s_waitcnt vmcnt(2)
v_max_u32 v4, v32, v34
v_cmp_eq_u32 vcc, -1, v4
s_cbranch_vccnz mega_kernel_rf_pa_7_0f
v_smfmac_f32_16x16x64_bf16 v[96:99], v[32:35], a[0:7], v6
v_smfmac_f32_16x16x64_bf16 v[100:103], v[32:35], a[32:39], v6
v_smfmac_f32_16x16x64_bf16 v[104:107], v[32:35], a[64:71], v6
v_smfmac_f32_16x16x64_bf16 v[108:111], v[32:35], a[96:103], v6
s_branch mega_kernel_rf_pa_6_1
.p2align 5
mega_kernel_rf_pa_7_1f:
s_mov_b64 exec, vcc
buffer_load_dwordx4 v[36:39], v7, s[84:87], s33 offen offset:1024 sc1
s_mov_b64 exec, -1
s_branch mega_kernel_rf_pa_7_2
.p2align 5
mega_kernel_rf_pa_7_1:
s_waitcnt vmcnt(2)
v_max_u32 v4, v36, v38
v_cmp_eq_u32 vcc, -1, v4
s_cbranch_vccnz mega_kernel_rf_pa_7_1f
v_smfmac_f32_16x16x64_bf16 v[96:99], v[36:39], a[8:15], v6
v_smfmac_f32_16x16x64_bf16 v[100:103], v[36:39], a[40:47], v6
v_smfmac_f32_16x16x64_bf16 v[104:107], v[36:39], a[72:79], v6
v_smfmac_f32_16x16x64_bf16 v[108:111], v[36:39], a[104:111], v6
s_branch mega_kernel_rf_pa_5_2
.p2align 5
mega_kernel_rf_pa_7_2f:
s_mov_b64 exec, vcc
buffer_load_dwordx4 v[40:43], v7, s[84:87], s33 offen offset:2048 sc1
s_mov_b64 exec, -1
s_branch mega_kernel_rf_pa_7_0
.p2align 5
mega_kernel_rf_pa_7_2:
s_waitcnt vmcnt(2)
v_max_u32 v4, v40, v42
v_cmp_eq_u32 vcc, -1, v4
s_cbranch_vccnz mega_kernel_rf_pa_7_2f
v_smfmac_f32_16x16x64_bf16 v[96:99], v[40:43], a[16:23], v6
v_smfmac_f32_16x16x64_bf16 v[100:103], v[40:43], a[48:55], v6
v_smfmac_f32_16x16x64_bf16 v[104:107], v[40:43], a[80:87], v6
v_smfmac_f32_16x16x64_bf16 v[108:111], v[40:43], a[112:119], v6
s_branch mega_kernel_rf_pa_3_0
.p2align 5
mega_kernel_rf_pa_8_3f:
s_mov_b64 exec, vcc
buffer_load_dwordx4 v[44:47], v7, s[84:87], s33 offen offset:3072 sc1
s_mov_b64 exec, -1
s_branch mega_kernel_rf_pa_8_3
.p2align 5
mega_kernel_rf_pa_8_3:
s_waitcnt vmcnt(0)
v_max_u32 v4, v44, v46
v_cmp_eq_u32 vcc, -1, v4
s_cbranch_vccnz mega_kernel_rf_pa_8_3f
v_smfmac_f32_16x16x64_bf16 v[96:99], v[44:47], a[24:31], v6
v_smfmac_f32_16x16x64_bf16 v[100:103], v[44:47], a[56:63], v6
v_smfmac_f32_16x16x64_bf16 v[104:107], v[44:47], a[88:95], v6
v_smfmac_f32_16x16x64_bf16 v[108:111], v[44:47], a[120:127], v6
s_branch mega_kernel_rf_pa_d
.p2align 5
mega_kernel_rf_pa_9_0f:
s_mov_b64 exec, vcc
buffer_load_dwordx4 v[32:35], v7, s[84:87], s33 offen offset:0 sc1
s_mov_b64 exec, -1
s_branch mega_kernel_rf_pa_9_3
.p2align 5
mega_kernel_rf_pa_9_0:
s_waitcnt vmcnt(1)
v_max_u32 v4, v32, v34
v_cmp_eq_u32 vcc, -1, v4
s_cbranch_vccnz mega_kernel_rf_pa_9_0f
v_smfmac_f32_16x16x64_bf16 v[96:99], v[32:35], a[0:7], v6
v_smfmac_f32_16x16x64_bf16 v[100:103], v[32:35], a[32:39], v6
v_smfmac_f32_16x16x64_bf16 v[104:107], v[32:35], a[64:71], v6
v_smfmac_f32_16x16x64_bf16 v[108:111], v[32:35], a[96:103], v6
s_branch mega_kernel_rf_pa_8_3
.p2align 5
mega_kernel_rf_pa_9_3f:
s_mov_b64 exec, vcc
buffer_load_dwordx4 v[44:47], v7, s[84:87], s33 offen offset:3072 sc1
s_mov_b64 exec, -1
s_branch mega_kernel_rf_pa_9_0
.p2align 5
mega_kernel_rf_pa_9_3:
s_waitcnt vmcnt(1)
v_max_u32 v4, v44, v46
v_cmp_eq_u32 vcc, -1, v4
s_cbranch_vccnz mega_kernel_rf_pa_9_3f
v_smfmac_f32_16x16x64_bf16 v[96:99], v[44:47], a[24:31], v6
v_smfmac_f32_16x16x64_bf16 v[100:103], v[44:47], a[56:63], v6
v_smfmac_f32_16x16x64_bf16 v[104:107], v[44:47], a[88:95], v6
v_smfmac_f32_16x16x64_bf16 v[108:111], v[44:47], a[120:127], v6
s_branch mega_kernel_rf_pa_1_0
.p2align 5
mega_kernel_rf_pa_10_1f:
s_mov_b64 exec, vcc
buffer_load_dwordx4 v[36:39], v7, s[84:87], s33 offen offset:1024 sc1
s_mov_b64 exec, -1
s_branch mega_kernel_rf_pa_10_3
.p2align 5
mega_kernel_rf_pa_10_1:
s_waitcnt vmcnt(1)
v_max_u32 v4, v36, v38
v_cmp_eq_u32 vcc, -1, v4
s_cbranch_vccnz mega_kernel_rf_pa_10_1f
v_smfmac_f32_16x16x64_bf16 v[96:99], v[36:39], a[8:15], v6
v_smfmac_f32_16x16x64_bf16 v[100:103], v[36:39], a[40:47], v6
v_smfmac_f32_16x16x64_bf16 v[104:107], v[36:39], a[72:79], v6
v_smfmac_f32_16x16x64_bf16 v[108:111], v[36:39], a[104:111], v6
s_branch mega_kernel_rf_pa_8_3
.p2align 5
mega_kernel_rf_pa_10_3f:
s_mov_b64 exec, vcc
buffer_load_dwordx4 v[44:47], v7, s[84:87], s33 offen offset:3072 sc1
s_mov_b64 exec, -1
s_branch mega_kernel_rf_pa_10_1
.p2align 5
mega_kernel_rf_pa_10_3:
s_waitcnt vmcnt(1)
v_max_u32 v4, v44, v46
v_cmp_eq_u32 vcc, -1, v4
s_cbranch_vccnz mega_kernel_rf_pa_10_3f
v_smfmac_f32_16x16x64_bf16 v[96:99], v[44:47], a[24:31], v6
v_smfmac_f32_16x16x64_bf16 v[100:103], v[44:47], a[56:63], v6
v_smfmac_f32_16x16x64_bf16 v[104:107], v[44:47], a[88:95], v6
v_smfmac_f32_16x16x64_bf16 v[108:111], v[44:47], a[120:127], v6
s_branch mega_kernel_rf_pa_2_1
.p2align 5
mega_kernel_rf_pa_11_0f:
s_mov_b64 exec, vcc
buffer_load_dwordx4 v[32:35], v7, s[84:87], s33 offen offset:0 sc1
s_mov_b64 exec, -1
s_branch mega_kernel_rf_pa_11_1
.p2align 5
mega_kernel_rf_pa_11_0:
s_waitcnt vmcnt(2)
v_max_u32 v4, v32, v34
v_cmp_eq_u32 vcc, -1, v4
s_cbranch_vccnz mega_kernel_rf_pa_11_0f
v_smfmac_f32_16x16x64_bf16 v[96:99], v[32:35], a[0:7], v6
v_smfmac_f32_16x16x64_bf16 v[100:103], v[32:35], a[32:39], v6
v_smfmac_f32_16x16x64_bf16 v[104:107], v[32:35], a[64:71], v6
v_smfmac_f32_16x16x64_bf16 v[108:111], v[32:35], a[96:103], v6
s_branch mega_kernel_rf_pa_10_1
.p2align 5
mega_kernel_rf_pa_11_1f:
s_mov_b64 exec, vcc
buffer_load_dwordx4 v[36:39], v7, s[84:87], s33 offen offset:1024 sc1
s_mov_b64 exec, -1
s_branch mega_kernel_rf_pa_11_3
.p2align 5
mega_kernel_rf_pa_11_1:
s_waitcnt vmcnt(2)
v_max_u32 v4, v36, v38
v_cmp_eq_u32 vcc, -1, v4
s_cbranch_vccnz mega_kernel_rf_pa_11_1f
v_smfmac_f32_16x16x64_bf16 v[96:99], v[36:39], a[8:15], v6
v_smfmac_f32_16x16x64_bf16 v[100:103], v[36:39], a[40:47], v6
v_smfmac_f32_16x16x64_bf16 v[104:107], v[36:39], a[72:79], v6
v_smfmac_f32_16x16x64_bf16 v[108:111], v[36:39], a[104:111], v6
s_branch mega_kernel_rf_pa_9_3
.p2align 5
mega_kernel_rf_pa_11_3f:
s_mov_b64 exec, vcc
buffer_load_dwordx4 v[44:47], v7, s[84:87], s33 offen offset:3072 sc1
s_mov_b64 exec, -1
s_branch mega_kernel_rf_pa_11_0
.p2align 5
mega_kernel_rf_pa_11_3:
s_waitcnt vmcnt(2)
v_max_u32 v4, v44, v46
v_cmp_eq_u32 vcc, -1, v4
s_cbranch_vccnz mega_kernel_rf_pa_11_3f
v_smfmac_f32_16x16x64_bf16 v[96:99], v[44:47], a[24:31], v6
v_smfmac_f32_16x16x64_bf16 v[100:103], v[44:47], a[56:63], v6
v_smfmac_f32_16x16x64_bf16 v[104:107], v[44:47], a[88:95], v6
v_smfmac_f32_16x16x64_bf16 v[108:111], v[44:47], a[120:127], v6
s_branch mega_kernel_rf_pa_3_0
.p2align 5
mega_kernel_rf_pa_12_2f:
s_mov_b64 exec, vcc
buffer_load_dwordx4 v[40:43], v7, s[84:87], s33 offen offset:2048 sc1
s_mov_b64 exec, -1
s_branch mega_kernel_rf_pa_12_3
.p2align 5
mega_kernel_rf_pa_12_2:
s_waitcnt vmcnt(1)
v_max_u32 v4, v40, v42
v_cmp_eq_u32 vcc, -1, v4
s_cbranch_vccnz mega_kernel_rf_pa_12_2f
v_smfmac_f32_16x16x64_bf16 v[96:99], v[40:43], a[16:23], v6
v_smfmac_f32_16x16x64_bf16 v[100:103], v[40:43], a[48:55], v6
v_smfmac_f32_16x16x64_bf16 v[104:107], v[40:43], a[80:87], v6
v_smfmac_f32_16x16x64_bf16 v[108:111], v[40:43], a[112:119], v6
s_branch mega_kernel_rf_pa_8_3
.p2align 5
mega_kernel_rf_pa_12_3f:
s_mov_b64 exec, vcc
buffer_load_dwordx4 v[44:47], v7, s[84:87], s33 offen offset:3072 sc1
s_mov_b64 exec, -1
s_branch mega_kernel_rf_pa_12_2
.p2align 5
mega_kernel_rf_pa_12_3:
s_waitcnt vmcnt(1)
v_max_u32 v4, v44, v46
v_cmp_eq_u32 vcc, -1, v4
s_cbranch_vccnz mega_kernel_rf_pa_12_3f
v_smfmac_f32_16x16x64_bf16 v[96:99], v[44:47], a[24:31], v6
v_smfmac_f32_16x16x64_bf16 v[100:103], v[44:47], a[56:63], v6
v_smfmac_f32_16x16x64_bf16 v[104:107], v[44:47], a[88:95], v6
v_smfmac_f32_16x16x64_bf16 v[108:111], v[44:47], a[120:127], v6
s_branch mega_kernel_rf_pa_4_2
.p2align 5
mega_kernel_rf_pa_13_0f:
s_mov_b64 exec, vcc
buffer_load_dwordx4 v[32:35], v7, s[84:87], s33 offen offset:0 sc1
s_mov_b64 exec, -1
s_branch mega_kernel_rf_pa_13_2
.p2align 5
mega_kernel_rf_pa_13_0:
s_waitcnt vmcnt(2)
v_max_u32 v4, v32, v34
v_cmp_eq_u32 vcc, -1, v4
s_cbranch_vccnz mega_kernel_rf_pa_13_0f
v_smfmac_f32_16x16x64_bf16 v[96:99], v[32:35], a[0:7], v6
v_smfmac_f32_16x16x64_bf16 v[100:103], v[32:35], a[32:39], v6
v_smfmac_f32_16x16x64_bf16 v[104:107], v[32:35], a[64:71], v6
v_smfmac_f32_16x16x64_bf16 v[108:111], v[32:35], a[96:103], v6
s_branch mega_kernel_rf_pa_12_2
.p2align 5
mega_kernel_rf_pa_13_2f:
s_mov_b64 exec, vcc
buffer_load_dwordx4 v[40:43], v7, s[84:87], s33 offen offset:2048 sc1
s_mov_b64 exec, -1
s_branch mega_kernel_rf_pa_13_3
.p2align 5
mega_kernel_rf_pa_13_2:
s_waitcnt vmcnt(2)
v_max_u32 v4, v40, v42
v_cmp_eq_u32 vcc, -1, v4
s_cbranch_vccnz mega_kernel_rf_pa_13_2f
v_smfmac_f32_16x16x64_bf16 v[96:99], v[40:43], a[16:23], v6
v_smfmac_f32_16x16x64_bf16 v[100:103], v[40:43], a[48:55], v6
v_smfmac_f32_16x16x64_bf16 v[104:107], v[40:43], a[80:87], v6
v_smfmac_f32_16x16x64_bf16 v[108:111], v[40:43], a[112:119], v6
s_branch mega_kernel_rf_pa_9_3
.p2align 5
mega_kernel_rf_pa_13_3f:
s_mov_b64 exec, vcc
buffer_load_dwordx4 v[44:47], v7, s[84:87], s33 offen offset:3072 sc1
s_mov_b64 exec, -1
s_branch mega_kernel_rf_pa_13_0
.p2align 5
mega_kernel_rf_pa_13_3:
s_waitcnt vmcnt(2)
v_max_u32 v4, v44, v46
v_cmp_eq_u32 vcc, -1, v4
s_cbranch_vccnz mega_kernel_rf_pa_13_3f
v_smfmac_f32_16x16x64_bf16 v[96:99], v[44:47], a[24:31], v6
v_smfmac_f32_16x16x64_bf16 v[100:103], v[44:47], a[56:63], v6
v_smfmac_f32_16x16x64_bf16 v[104:107], v[44:47], a[88:95], v6
v_smfmac_f32_16x16x64_bf16 v[108:111], v[44:47], a[120:127], v6
s_branch mega_kernel_rf_pa_5_0
.p2align 5
mega_kernel_rf_pa_14_1f:
s_mov_b64 exec, vcc
buffer_load_dwordx4 v[36:39], v7, s[84:87], s33 offen offset:1024 sc1
s_mov_b64 exec, -1
s_branch mega_kernel_rf_pa_14_2
.p2align 5
mega_kernel_rf_pa_14_1:
s_waitcnt vmcnt(2)
v_max_u32 v4, v36, v38
v_cmp_eq_u32 vcc, -1, v4
s_cbranch_vccnz mega_kernel_rf_pa_14_1f
v_smfmac_f32_16x16x64_bf16 v[96:99], v[36:39], a[8:15], v6
v_smfmac_f32_16x16x64_bf16 v[100:103], v[36:39], a[40:47], v6
v_smfmac_f32_16x16x64_bf16 v[104:107], v[36:39], a[72:79], v6
v_smfmac_f32_16x16x64_bf16 v[108:111], v[36:39], a[104:111], v6
s_branch mega_kernel_rf_pa_12_2
.p2align 5
mega_kernel_rf_pa_14_2f:
s_mov_b64 exec, vcc
buffer_load_dwordx4 v[40:43], v7, s[84:87], s33 offen offset:2048 sc1
s_mov_b64 exec, -1
s_branch mega_kernel_rf_pa_14_3
.p2align 5
mega_kernel_rf_pa_14_2:
s_waitcnt vmcnt(2)
v_max_u32 v4, v40, v42
v_cmp_eq_u32 vcc, -1, v4
s_cbranch_vccnz mega_kernel_rf_pa_14_2f
v_smfmac_f32_16x16x64_bf16 v[96:99], v[40:43], a[16:23], v6
v_smfmac_f32_16x16x64_bf16 v[100:103], v[40:43], a[48:55], v6
v_smfmac_f32_16x16x64_bf16 v[104:107], v[40:43], a[80:87], v6
v_smfmac_f32_16x16x64_bf16 v[108:111], v[40:43], a[112:119], v6
s_branch mega_kernel_rf_pa_10_3
.p2align 5
mega_kernel_rf_pa_14_3f:
s_mov_b64 exec, vcc
buffer_load_dwordx4 v[44:47], v7, s[84:87], s33 offen offset:3072 sc1
s_mov_b64 exec, -1
s_branch mega_kernel_rf_pa_14_1
.p2align 5
mega_kernel_rf_pa_14_3:
s_waitcnt vmcnt(2)
v_max_u32 v4, v44, v46
v_cmp_eq_u32 vcc, -1, v4
s_cbranch_vccnz mega_kernel_rf_pa_14_3f
v_smfmac_f32_16x16x64_bf16 v[96:99], v[44:47], a[24:31], v6
v_smfmac_f32_16x16x64_bf16 v[100:103], v[44:47], a[56:63], v6
v_smfmac_f32_16x16x64_bf16 v[104:107], v[44:47], a[88:95], v6
v_smfmac_f32_16x16x64_bf16 v[108:111], v[44:47], a[120:127], v6
s_branch mega_kernel_rf_pa_6_1
.p2align 5
mega_kernel_rf_pa_15_0f:
s_mov_b64 exec, vcc
buffer_load_dwordx4 v[32:35], v7, s[84:87], s33 offen offset:0 sc1
s_mov_b64 exec, -1
s_branch mega_kernel_rf_pa_15_1
.p2align 5
mega_kernel_rf_pa_15_0:
s_waitcnt vmcnt(3)
v_max_u32 v4, v32, v34
v_cmp_eq_u32 vcc, -1, v4
s_cbranch_vccnz mega_kernel_rf_pa_15_0f
v_smfmac_f32_16x16x64_bf16 v[96:99], v[32:35], a[0:7], v6
v_smfmac_f32_16x16x64_bf16 v[100:103], v[32:35], a[32:39], v6
v_smfmac_f32_16x16x64_bf16 v[104:107], v[32:35], a[64:71], v6
v_smfmac_f32_16x16x64_bf16 v[108:111], v[32:35], a[96:103], v6
s_branch mega_kernel_rf_pa_14_1
.p2align 5
mega_kernel_rf_pa_15_1f:
s_mov_b64 exec, vcc
buffer_load_dwordx4 v[36:39], v7, s[84:87], s33 offen offset:1024 sc1
s_mov_b64 exec, -1
s_branch mega_kernel_rf_pa_15_2
.p2align 5
mega_kernel_rf_pa_15_1:
s_waitcnt vmcnt(3)
v_max_u32 v4, v36, v38
v_cmp_eq_u32 vcc, -1, v4
s_cbranch_vccnz mega_kernel_rf_pa_15_1f
v_smfmac_f32_16x16x64_bf16 v[96:99], v[36:39], a[8:15], v6
v_smfmac_f32_16x16x64_bf16 v[100:103], v[36:39], a[40:47], v6
v_smfmac_f32_16x16x64_bf16 v[104:107], v[36:39], a[72:79], v6
v_smfmac_f32_16x16x64_bf16 v[108:111], v[36:39], a[104:111], v6
s_branch mega_kernel_rf_pa_13_2
.p2align 5
mega_kernel_rf_pa_15_2f:
s_mov_b64 exec, vcc
buffer_load_dwordx4 v[40:43], v7, s[84:87], s33 offen offset:2048 sc1
s_mov_b64 exec, -1
s_branch mega_kernel_rf_pa_15_3
.p2align 5
mega_kernel_rf_pa_15_2:
s_waitcnt vmcnt(3)
v_max_u32 v4, v40, v42
v_cmp_eq_u32 vcc, -1, v4
s_cbranch_vccnz mega_kernel_rf_pa_15_2f
v_smfmac_f32_16x16x64_bf16 v[96:99], v[40:43], a[16:23], v6
v_smfmac_f32_16x16x64_bf16 v[100:103], v[40:43], a[48:55], v6
v_smfmac_f32_16x16x64_bf16 v[104:107], v[40:43], a[80:87], v6
v_smfmac_f32_16x16x64_bf16 v[108:111], v[40:43], a[112:119], v6
s_branch mega_kernel_rf_pa_11_3
.p2align 5
mega_kernel_rf_pa_15_3f:
s_mov_b64 exec, vcc
buffer_load_dwordx4 v[44:47], v7, s[84:87], s33 offen offset:3072 sc1
s_mov_b64 exec, -1
s_branch mega_kernel_rf_pa_15_0
.p2align 5
mega_kernel_rf_pa_15_3:
s_waitcnt vmcnt(3)
v_max_u32 v4, v44, v46
v_cmp_eq_u32 vcc, -1, v4
s_cbranch_vccnz mega_kernel_rf_pa_15_3f
v_smfmac_f32_16x16x64_bf16 v[96:99], v[44:47], a[24:31], v6
v_smfmac_f32_16x16x64_bf16 v[100:103], v[44:47], a[56:63], v6
v_smfmac_f32_16x16x64_bf16 v[104:107], v[44:47], a[88:95], v6
v_smfmac_f32_16x16x64_bf16 v[108:111], v[44:47], a[120:127], v6
s_branch mega_kernel_rf_pa_7_0
.p2align 5
mega_kernel_rf_pc_1_0f:
s_mov_b64 exec, vcc
buffer_load_dwordx4 v[32:35], v7, s[84:87], s29 offen offset:0 sc1
s_mov_b64 exec, -1
s_branch mega_kernel_rf_pc_1_0
.p2align 5
mega_kernel_rf_pc_1_0:
s_waitcnt vmcnt(0)
v_cmp_eq_u32 vcc, -1, v32
s_cbranch_vccnz mega_kernel_rf_pc_1_0f
v_smfmac_f32_16x16x64_bf16 v[96:99], v[32:35], a[192:199], v6
v_smfmac_f32_16x16x64_bf16 v[100:103], v[32:35], a[224:231], v6
s_branch mega_kernel_rf_pc_d
.p2align 5
mega_kernel_rf_pc_2_1f:
s_mov_b64 exec, vcc
buffer_load_dwordx4 v[36:39], v7, s[84:87], s29 offen offset:1024 sc1
s_mov_b64 exec, -1
s_branch mega_kernel_rf_pc_2_1
.p2align 5
mega_kernel_rf_pc_2_1:
s_waitcnt vmcnt(0)
v_cmp_eq_u32 vcc, -1, v36
s_cbranch_vccnz mega_kernel_rf_pc_2_1f
v_smfmac_f32_16x16x64_bf16 v[96:99], v[36:39], a[200:207], v6
v_smfmac_f32_16x16x64_bf16 v[100:103], v[36:39], a[232:239], v6
s_branch mega_kernel_rf_pc_d
.p2align 5
mega_kernel_rf_pc_3_0f:
s_mov_b64 exec, vcc
buffer_load_dwordx4 v[32:35], v7, s[84:87], s29 offen offset:0 sc1
s_mov_b64 exec, -1
s_branch mega_kernel_rf_pc_3_1
.p2align 5
mega_kernel_rf_pc_3_0:
s_waitcnt vmcnt(1)
v_cmp_eq_u32 vcc, -1, v32
s_cbranch_vccnz mega_kernel_rf_pc_3_0f
v_smfmac_f32_16x16x64_bf16 v[96:99], v[32:35], a[192:199], v6
v_smfmac_f32_16x16x64_bf16 v[100:103], v[32:35], a[224:231], v6
s_branch mega_kernel_rf_pc_2_1
.p2align 5
mega_kernel_rf_pc_3_1f:
s_mov_b64 exec, vcc
buffer_load_dwordx4 v[36:39], v7, s[84:87], s29 offen offset:1024 sc1
s_mov_b64 exec, -1
s_branch mega_kernel_rf_pc_3_0
.p2align 5
mega_kernel_rf_pc_3_1:
s_waitcnt vmcnt(1)
v_cmp_eq_u32 vcc, -1, v36
s_cbranch_vccnz mega_kernel_rf_pc_3_1f
v_smfmac_f32_16x16x64_bf16 v[96:99], v[36:39], a[200:207], v6
v_smfmac_f32_16x16x64_bf16 v[100:103], v[36:39], a[232:239], v6
s_branch mega_kernel_rf_pc_1_0
.p2align 5
mega_kernel_rf_pc_4_2f:
s_mov_b64 exec, vcc
buffer_load_dwordx4 v[40:43], v7, s[84:87], s29 offen offset:2048 sc1
s_mov_b64 exec, -1
s_branch mega_kernel_rf_pc_4_2
.p2align 5
mega_kernel_rf_pc_4_2:
s_waitcnt vmcnt(0)
v_cmp_eq_u32 vcc, -1, v40
s_cbranch_vccnz mega_kernel_rf_pc_4_2f
v_smfmac_f32_16x16x64_bf16 v[96:99], v[40:43], a[208:215], v6
v_smfmac_f32_16x16x64_bf16 v[100:103], v[40:43], a[240:247], v6
s_branch mega_kernel_rf_pc_d
.p2align 5
mega_kernel_rf_pc_5_0f:
s_mov_b64 exec, vcc
buffer_load_dwordx4 v[32:35], v7, s[84:87], s29 offen offset:0 sc1
s_mov_b64 exec, -1
s_branch mega_kernel_rf_pc_5_2
.p2align 5
mega_kernel_rf_pc_5_0:
s_waitcnt vmcnt(1)
v_cmp_eq_u32 vcc, -1, v32
s_cbranch_vccnz mega_kernel_rf_pc_5_0f
v_smfmac_f32_16x16x64_bf16 v[96:99], v[32:35], a[192:199], v6
v_smfmac_f32_16x16x64_bf16 v[100:103], v[32:35], a[224:231], v6
s_branch mega_kernel_rf_pc_4_2
.p2align 5
mega_kernel_rf_pc_5_2f:
s_mov_b64 exec, vcc
buffer_load_dwordx4 v[40:43], v7, s[84:87], s29 offen offset:2048 sc1
s_mov_b64 exec, -1
s_branch mega_kernel_rf_pc_5_0
.p2align 5
mega_kernel_rf_pc_5_2:
s_waitcnt vmcnt(1)
v_cmp_eq_u32 vcc, -1, v40
s_cbranch_vccnz mega_kernel_rf_pc_5_2f
v_smfmac_f32_16x16x64_bf16 v[96:99], v[40:43], a[208:215], v6
v_smfmac_f32_16x16x64_bf16 v[100:103], v[40:43], a[240:247], v6
s_branch mega_kernel_rf_pc_1_0
.p2align 5
mega_kernel_rf_pc_6_1f:
s_mov_b64 exec, vcc
buffer_load_dwordx4 v[36:39], v7, s[84:87], s29 offen offset:1024 sc1
s_mov_b64 exec, -1
s_branch mega_kernel_rf_pc_6_2
.p2align 5
mega_kernel_rf_pc_6_1:
s_waitcnt vmcnt(1)
v_cmp_eq_u32 vcc, -1, v36
s_cbranch_vccnz mega_kernel_rf_pc_6_1f
v_smfmac_f32_16x16x64_bf16 v[96:99], v[36:39], a[200:207], v6
v_smfmac_f32_16x16x64_bf16 v[100:103], v[36:39], a[232:239], v6
s_branch mega_kernel_rf_pc_4_2
.p2align 5
mega_kernel_rf_pc_6_2f:
s_mov_b64 exec, vcc
buffer_load_dwordx4 v[40:43], v7, s[84:87], s29 offen offset:2048 sc1
s_mov_b64 exec, -1
s_branch mega_kernel_rf_pc_6_1
.p2align 5
mega_kernel_rf_pc_6_2:
s_waitcnt vmcnt(1)
v_cmp_eq_u32 vcc, -1, v40
s_cbranch_vccnz mega_kernel_rf_pc_6_2f
v_smfmac_f32_16x16x64_bf16 v[96:99], v[40:43], a[208:215], v6
v_smfmac_f32_16x16x64_bf16 v[100:103], v[40:43], a[240:247], v6
s_branch mega_kernel_rf_pc_2_1
.p2align 5
mega_kernel_rf_pc_7_0f:
s_mov_b64 exec, vcc
buffer_load_dwordx4 v[32:35], v7, s[84:87], s29 offen offset:0 sc1
s_mov_b64 exec, -1
s_branch mega_kernel_rf_pc_7_1
.p2align 5
mega_kernel_rf_pc_7_0:
s_waitcnt vmcnt(2)
v_cmp_eq_u32 vcc, -1, v32
s_cbranch_vccnz mega_kernel_rf_pc_7_0f
v_smfmac_f32_16x16x64_bf16 v[96:99], v[32:35], a[192:199], v6
v_smfmac_f32_16x16x64_bf16 v[100:103], v[32:35], a[224:231], v6
s_branch mega_kernel_rf_pc_6_1
.p2align 5
mega_kernel_rf_pc_7_1f:
s_mov_b64 exec, vcc
buffer_load_dwordx4 v[36:39], v7, s[84:87], s29 offen offset:1024 sc1
s_mov_b64 exec, -1
s_branch mega_kernel_rf_pc_7_2
.p2align 5
mega_kernel_rf_pc_7_1:
s_waitcnt vmcnt(2)
v_cmp_eq_u32 vcc, -1, v36
s_cbranch_vccnz mega_kernel_rf_pc_7_1f
v_smfmac_f32_16x16x64_bf16 v[96:99], v[36:39], a[200:207], v6
v_smfmac_f32_16x16x64_bf16 v[100:103], v[36:39], a[232:239], v6
s_branch mega_kernel_rf_pc_5_2
.p2align 5
mega_kernel_rf_pc_7_2f:
s_mov_b64 exec, vcc
buffer_load_dwordx4 v[40:43], v7, s[84:87], s29 offen offset:2048 sc1
s_mov_b64 exec, -1
s_branch mega_kernel_rf_pc_7_0
.p2align 5
mega_kernel_rf_pc_7_2:
s_waitcnt vmcnt(2)
v_cmp_eq_u32 vcc, -1, v40
s_cbranch_vccnz mega_kernel_rf_pc_7_2f
v_smfmac_f32_16x16x64_bf16 v[96:99], v[40:43], a[208:215], v6
v_smfmac_f32_16x16x64_bf16 v[100:103], v[40:43], a[240:247], v6
s_branch mega_kernel_rf_pc_3_0
.p2align 5
mega_kernel_rf_pc_8_3f:
s_mov_b64 exec, vcc
buffer_load_dwordx4 v[44:47], v7, s[84:87], s29 offen offset:3072 sc1
s_mov_b64 exec, -1
s_branch mega_kernel_rf_pc_8_3
.p2align 5
mega_kernel_rf_pc_9_0f:
s_mov_b64 exec, vcc
buffer_load_dwordx4 v[32:35], v7, s[84:87], s29 offen offset:0 sc1
s_mov_b64 exec, -1
s_branch mega_kernel_rf_pc_9_3
.p2align 5
mega_kernel_rf_pc_9_0:
s_waitcnt vmcnt(1)
v_cmp_eq_u32 vcc, -1, v32
s_cbranch_vccnz mega_kernel_rf_pc_9_0f
v_smfmac_f32_16x16x64_bf16 v[96:99], v[32:35], a[192:199], v6
v_smfmac_f32_16x16x64_bf16 v[100:103], v[32:35], a[224:231], v6
s_branch mega_kernel_rf_pc_8_3
.p2align 5
mega_kernel_rf_pc_9_3f:
s_mov_b64 exec, vcc
buffer_load_dwordx4 v[44:47], v7, s[84:87], s29 offen offset:3072 sc1
s_mov_b64 exec, -1
s_branch mega_kernel_rf_pc_9_0
.p2align 5
mega_kernel_rf_pc_9_3:
s_waitcnt vmcnt(1)
v_cmp_eq_u32 vcc, -1, v44
s_cbranch_vccnz mega_kernel_rf_pc_9_3f
v_smfmac_f32_16x16x64_bf16 v[96:99], v[44:47], a[216:223], v6
v_smfmac_f32_16x16x64_bf16 v[100:103], v[44:47], a[248:255], v6
s_branch mega_kernel_rf_pc_1_0
.p2align 5
mega_kernel_rf_pc_10_1f:
s_mov_b64 exec, vcc
buffer_load_dwordx4 v[36:39], v7, s[84:87], s29 offen offset:1024 sc1
s_mov_b64 exec, -1
s_branch mega_kernel_rf_pc_10_3
.p2align 5
mega_kernel_rf_pc_10_1:
s_waitcnt vmcnt(1)
v_cmp_eq_u32 vcc, -1, v36
s_cbranch_vccnz mega_kernel_rf_pc_10_1f
v_smfmac_f32_16x16x64_bf16 v[96:99], v[36:39], a[200:207], v6
v_smfmac_f32_16x16x64_bf16 v[100:103], v[36:39], a[232:239], v6
s_branch mega_kernel_rf_pc_8_3
.p2align 5
mega_kernel_rf_pc_10_3f:
s_mov_b64 exec, vcc
buffer_load_dwordx4 v[44:47], v7, s[84:87], s29 offen offset:3072 sc1
s_mov_b64 exec, -1
s_branch mega_kernel_rf_pc_10_1
.p2align 5
mega_kernel_rf_pc_10_3:
s_waitcnt vmcnt(1)
v_cmp_eq_u32 vcc, -1, v44
s_cbranch_vccnz mega_kernel_rf_pc_10_3f
v_smfmac_f32_16x16x64_bf16 v[96:99], v[44:47], a[216:223], v6
v_smfmac_f32_16x16x64_bf16 v[100:103], v[44:47], a[248:255], v6
s_branch mega_kernel_rf_pc_2_1
.p2align 5
mega_kernel_rf_pc_11_0f:
s_mov_b64 exec, vcc
buffer_load_dwordx4 v[32:35], v7, s[84:87], s29 offen offset:0 sc1
s_mov_b64 exec, -1
s_branch mega_kernel_rf_pc_11_1
.p2align 5
mega_kernel_rf_pc_11_0:
s_waitcnt vmcnt(2)
v_cmp_eq_u32 vcc, -1, v32
s_cbranch_vccnz mega_kernel_rf_pc_11_0f
v_smfmac_f32_16x16x64_bf16 v[96:99], v[32:35], a[192:199], v6
v_smfmac_f32_16x16x64_bf16 v[100:103], v[32:35], a[224:231], v6
s_branch mega_kernel_rf_pc_10_1
.p2align 5
mega_kernel_rf_pc_11_1f:
s_mov_b64 exec, vcc
buffer_load_dwordx4 v[36:39], v7, s[84:87], s29 offen offset:1024 sc1
s_mov_b64 exec, -1
s_branch mega_kernel_rf_pc_11_3
.p2align 5
mega_kernel_rf_pc_11_1:
s_waitcnt vmcnt(2)
v_cmp_eq_u32 vcc, -1, v36
s_cbranch_vccnz mega_kernel_rf_pc_11_1f
v_smfmac_f32_16x16x64_bf16 v[96:99], v[36:39], a[200:207], v6
v_smfmac_f32_16x16x64_bf16 v[100:103], v[36:39], a[232:239], v6
s_branch mega_kernel_rf_pc_9_3
.p2align 5
mega_kernel_rf_pc_11_3f:
s_mov_b64 exec, vcc
buffer_load_dwordx4 v[44:47], v7, s[84:87], s29 offen offset:3072 sc1
s_mov_b64 exec, -1
s_branch mega_kernel_rf_pc_11_0
.p2align 5
mega_kernel_rf_pc_11_3:
s_waitcnt vmcnt(2)
v_cmp_eq_u32 vcc, -1, v44
s_cbranch_vccnz mega_kernel_rf_pc_11_3f
v_smfmac_f32_16x16x64_bf16 v[96:99], v[44:47], a[216:223], v6
v_smfmac_f32_16x16x64_bf16 v[100:103], v[44:47], a[248:255], v6
s_branch mega_kernel_rf_pc_3_0
.p2align 5
mega_kernel_rf_pc_12_2f:
s_mov_b64 exec, vcc
buffer_load_dwordx4 v[40:43], v7, s[84:87], s29 offen offset:2048 sc1
s_mov_b64 exec, -1
s_branch mega_kernel_rf_pc_12_3
.p2align 5
mega_kernel_rf_pc_12_3f:
s_mov_b64 exec, vcc
buffer_load_dwordx4 v[44:47], v7, s[84:87], s29 offen offset:3072 sc1
s_mov_b64 exec, -1
s_branch mega_kernel_rf_pc_12_2
.p2align 5
mega_kernel_rf_pc_12_3:
s_waitcnt vmcnt(1)
v_cmp_eq_u32 vcc, -1, v44
s_cbranch_vccnz mega_kernel_rf_pc_12_3f
v_smfmac_f32_16x16x64_bf16 v[96:99], v[44:47], a[216:223], v6
v_smfmac_f32_16x16x64_bf16 v[100:103], v[44:47], a[248:255], v6
s_branch mega_kernel_rf_pc_4_2
.p2align 5
mega_kernel_rf_pc_13_0f:
s_mov_b64 exec, vcc
buffer_load_dwordx4 v[32:35], v7, s[84:87], s29 offen offset:0 sc1
s_mov_b64 exec, -1
s_branch mega_kernel_rf_pc_13_2
.p2align 5
mega_kernel_rf_pc_13_0:
s_waitcnt vmcnt(2)
v_cmp_eq_u32 vcc, -1, v32
s_cbranch_vccnz mega_kernel_rf_pc_13_0f
v_smfmac_f32_16x16x64_bf16 v[96:99], v[32:35], a[192:199], v6
v_smfmac_f32_16x16x64_bf16 v[100:103], v[32:35], a[224:231], v6
s_branch mega_kernel_rf_pc_12_2
.p2align 5
mega_kernel_rf_pc_13_2f:
s_mov_b64 exec, vcc
buffer_load_dwordx4 v[40:43], v7, s[84:87], s29 offen offset:2048 sc1
s_mov_b64 exec, -1
s_branch mega_kernel_rf_pc_13_3
.p2align 5
mega_kernel_rf_pc_13_2:
s_waitcnt vmcnt(2)
v_cmp_eq_u32 vcc, -1, v40
s_cbranch_vccnz mega_kernel_rf_pc_13_2f
v_smfmac_f32_16x16x64_bf16 v[96:99], v[40:43], a[208:215], v6
v_smfmac_f32_16x16x64_bf16 v[100:103], v[40:43], a[240:247], v6
s_branch mega_kernel_rf_pc_9_3
.p2align 5
mega_kernel_rf_pc_13_3f:
s_mov_b64 exec, vcc
buffer_load_dwordx4 v[44:47], v7, s[84:87], s29 offen offset:3072 sc1
s_mov_b64 exec, -1
s_branch mega_kernel_rf_pc_13_0
.p2align 5
mega_kernel_rf_pc_13_3:
s_waitcnt vmcnt(2)
v_cmp_eq_u32 vcc, -1, v44
s_cbranch_vccnz mega_kernel_rf_pc_13_3f
v_smfmac_f32_16x16x64_bf16 v[96:99], v[44:47], a[216:223], v6
v_smfmac_f32_16x16x64_bf16 v[100:103], v[44:47], a[248:255], v6
s_branch mega_kernel_rf_pc_5_0
.p2align 5
mega_kernel_rf_pc_14_1f:
s_mov_b64 exec, vcc
buffer_load_dwordx4 v[36:39], v7, s[84:87], s29 offen offset:1024 sc1
s_mov_b64 exec, -1
s_branch mega_kernel_rf_pc_14_2
.p2align 5
mega_kernel_rf_pc_14_2f:
s_mov_b64 exec, vcc
buffer_load_dwordx4 v[40:43], v7, s[84:87], s29 offen offset:2048 sc1
s_mov_b64 exec, -1
s_branch mega_kernel_rf_pc_14_3
.p2align 5
mega_kernel_rf_pc_14_2:
s_waitcnt vmcnt(2)
v_cmp_eq_u32 vcc, -1, v40
s_cbranch_vccnz mega_kernel_rf_pc_14_2f
v_smfmac_f32_16x16x64_bf16 v[96:99], v[40:43], a[208:215], v6
v_smfmac_f32_16x16x64_bf16 v[100:103], v[40:43], a[240:247], v6
s_branch mega_kernel_rf_pc_10_3
.p2align 5
mega_kernel_rf_pc_14_3f:
s_mov_b64 exec, vcc
buffer_load_dwordx4 v[44:47], v7, s[84:87], s29 offen offset:3072 sc1
s_mov_b64 exec, -1
s_branch mega_kernel_rf_pc_14_1
.p2align 5
mega_kernel_rf_pc_14_3:
s_waitcnt vmcnt(2)
v_cmp_eq_u32 vcc, -1, v44
s_cbranch_vccnz mega_kernel_rf_pc_14_3f
v_smfmac_f32_16x16x64_bf16 v[96:99], v[44:47], a[216:223], v6
v_smfmac_f32_16x16x64_bf16 v[100:103], v[44:47], a[248:255], v6
s_branch mega_kernel_rf_pc_6_1
.p2align 5
mega_kernel_rf_pc_15_0f:
s_mov_b64 exec, vcc
buffer_load_dwordx4 v[32:35], v7, s[84:87], s29 offen offset:0 sc1
s_mov_b64 exec, -1
s_branch mega_kernel_rf_pc_15_1
.p2align 5
mega_kernel_rf_pc_15_1f:
s_mov_b64 exec, vcc
buffer_load_dwordx4 v[36:39], v7, s[84:87], s29 offen offset:1024 sc1
s_mov_b64 exec, -1
s_branch mega_kernel_rf_pc_15_2
.p2align 5
mega_kernel_rf_pc_15_1:
s_waitcnt vmcnt(3)
v_cmp_eq_u32 vcc, -1, v36
s_cbranch_vccnz mega_kernel_rf_pc_15_1f
v_smfmac_f32_16x16x64_bf16 v[96:99], v[36:39], a[200:207], v6
v_smfmac_f32_16x16x64_bf16 v[100:103], v[36:39], a[232:239], v6
s_branch mega_kernel_rf_pc_13_2
.p2align 5
mega_kernel_rf_pc_15_2f:
s_mov_b64 exec, vcc
buffer_load_dwordx4 v[40:43], v7, s[84:87], s29 offen offset:2048 sc1
s_mov_b64 exec, -1
s_branch mega_kernel_rf_pc_15_3
.p2align 5
mega_kernel_rf_pc_15_2:
s_waitcnt vmcnt(3)
v_cmp_eq_u32 vcc, -1, v40
s_cbranch_vccnz mega_kernel_rf_pc_15_2f
v_smfmac_f32_16x16x64_bf16 v[96:99], v[40:43], a[208:215], v6
v_smfmac_f32_16x16x64_bf16 v[100:103], v[40:43], a[240:247], v6
s_branch mega_kernel_rf_pc_11_3
.p2align 5
mega_kernel_rf_pc_15_3f:
s_mov_b64 exec, vcc
buffer_load_dwordx4 v[44:47], v7, s[84:87], s29 offen offset:3072 sc1
s_mov_b64 exec, -1
s_branch mega_kernel_rf_pc_15_0
.p2align 5
mega_kernel_rf_pc_15_3:
s_waitcnt vmcnt(3)
v_cmp_eq_u32 vcc, -1, v44
s_cbranch_vccnz mega_kernel_rf_pc_15_3f
v_smfmac_f32_16x16x64_bf16 v[96:99], v[44:47], a[216:223], v6
v_smfmac_f32_16x16x64_bf16 v[100:103], v[44:47], a[248:255], v6
s_branch mega_kernel_rf_pc_7_0
mega_kernel_rf_w0last:
s_nop 7
v_permlane32_swap_b32 v112, v116
v_permlane32_swap_b32 v113, v117
v_permlane32_swap_b32 v114, v118
v_permlane32_swap_b32 v115, v119
v_pk_add_f32 v[112:113], v[112:113], v[116:117]
v_pk_add_f32 v[114:115], v[114:115], v[118:119]
ds_write_b128 v20, v[112:115]
s_waitcnt lgkmcnt(0)
s_barrier
s_branch mega_kernel_rf_end
mega_kernel_rf_side:
s_cmp_eq_u32 s24, 3
s_cbranch_scc1 mega_kernel_rf_sd3
s_cmp_eq_u32 s24, 2
s_cbranch_scc0 mega_kernel_rf_sd4
s_mov_b64 exec, s[40:41]
buffer_store_dwordx4 v[28:31], v11, s[84:87], s34 offen
s_mov_b64 exec, -1
buffer_store_dwordx2 v[28:29], v9, s[84:87], s34 offen
s_mul_i32 s28, s31, 2048
s_add_u32 s28, s28, s34
s_add_u32 s28, s28, 49152
buffer_store_dwordx4 v[28:31], v17, s[84:87], s28 offen
buffer_store_dwordx4 v[28:31], v10, s[84:87], s28 offen
s_branch mega_kernel_rf_sd4
mega_kernel_rf_sd3:
v_readlane_b32 s76, v249, 0
v_readlane_b32 s77, v249, 1
s_min_i32 s76, s76, s77
s_max_i32 s46, s46, s76
s_mov_b32 s36, 0
s_add_u32 s76, s27, 1
s_cmp_lt_u32 s76, 63
s_cbranch_scc0 mega_kernel_rf_sd4
s_cmp_ge_u32 s76, 0
s_cbranch_scc0 mega_kernel_rf_sd4
s_cmp_gt_i32 s46, s76
s_cselect_b32 s36, 0, 1
s_cbranch_scc0 mega_kernel_rf_sd4
s_add_u32 s77, s76, s82
s_bfe_u32 s28, s77, 0x40002
s_lshl_b32 s28, s28, 14
s_and_b32 s77, s77, 3
s_lshl_b32 s77, s77, 11
s_add_u32 s28, s28, s77
s_add_u32 m0, s45, 0
s_nop 0
buffer_load_dwordx4 v240, s[84:87], s28 offen offset:0 sc1 lds
s_add_u32 m0, s45, 0
s_nop 0
buffer_load_dwordx4 v240, s[84:87], s28 offen offset:1024 sc1 lds
s_add_u32 m0, s45, 2048
s_nop 0
buffer_load_dwordx4 v241, s[84:87], s28 offen offset:0 sc1 lds
s_add_u32 m0, s45, 2048
s_nop 0
buffer_load_dwordx4 v241, s[84:87], s28 offen offset:1024 sc1 lds
s_add_u32 s45, s45, 4096
s_cmp_eq_u32 s45, 30720
s_cselect_b32 s45, 18432, s45
mega_kernel_rf_sd4:
v_smfmac_f32_16x16x64_bf16 v[112:115], v[40:43], a[144:151], v6
v_smfmac_f32_16x16x64_bf16 v[116:119], v[40:43], a[176:183], v6
v_smfmac_f32_16x16x64_bf16 v[112:115], v[44:47], a[152:159], v6
v_smfmac_f32_16x16x64_bf16 v[116:119], v[44:47], a[184:191], v6
s_nop 7
v_permlane32_swap_b32 v112, v116
v_permlane32_swap_b32 v113, v117
v_permlane32_swap_b32 v114, v118
v_permlane32_swap_b32 v115, v119
v_pk_add_f32 v[112:113], v[112:113], v[116:117]
v_pk_add_f32 v[114:115], v[114:115], v[118:119]
ds_write_b128 v20, v[112:115]
v_mov_b32 v96, 0
v_mov_b32 v97, 0
v_mov_b32 v98, 0
v_mov_b32 v99, 0
v_mov_b32 v100, 0
v_mov_b32 v101, 0
v_mov_b32 v102, 0
v_mov_b32 v103, 0
s_cmp_eq_u32 s24, 1
s_cbranch_scc0 mega_kernel_rf_s1
s_waitcnt lgkmcnt(0)
ds_read_b128 v[120:123], v16 offset:0
ds_read_b128 v[124:127], v16 offset:16
ds_read_b128 v[128:131], v16 offset:2304
ds_read_b128 v[132:135], v16 offset:2320
ds_read_b128 v[136:139], v16 offset:4608
ds_read_b128 v[140:143], v16 offset:4624
ds_read_b128 v[144:147], v16 offset:6912
ds_read_b128 v[148:151], v16 offset:6928
s_waitcnt lgkmcnt(4)
v_pk_add_f32 v[120:121], v[120:121], v[128:129]
v_pk_add_f32 v[122:123], v[122:123], v[130:131]
v_pk_add_f32 v[124:125], v[124:125], v[132:133]
v_pk_add_f32 v[126:127], v[126:127], v[134:135]
s_waitcnt lgkmcnt(0)
v_pk_add_f32 v[136:137], v[136:137], v[144:145]
v_pk_add_f32 v[138:139], v[138:139], v[146:147]
v_pk_add_f32 v[140:141], v[140:141], v[148:149]
v_pk_add_f32 v[142:143], v[142:143], v[150:151]
v_pk_add_f32 v[120:121], v[120:121], v[136:137]
v_pk_add_f32 v[122:123], v[122:123], v[138:139]
v_pk_add_f32 v[124:125], v[124:125], v[140:141]
v_pk_add_f32 v[126:127], v[126:127], v[142:143]
v_cvt_pk_bf16_f32 v244, v120, v121
v_cvt_pk_bf16_f32 v245, v122, v123
v_cvt_pk_bf16_f32 v246, v124, v125
v_cvt_pk_bf16_f32 v247, v126, v127
mega_kernel_rf_s1:
v_add_u32 v5, 9216, v17
s_waitcnt lgkmcnt(0)
s_barrier
s_cmp_eq_u32 s24, 2
s_cbranch_scc1 mega_kernel_rf_s2
s_cmp_eq_u32 s24, 3
s_cbranch_scc0 mega_kernel_rf_s3
s_add_u32 s76, s27, 2
s_cmp_lt_u32 s76, 63
s_cbranch_scc0 mega_kernel_rf_s3
s_cmp_gt_i32 s46, s76
s_cbranch_scc0 mega_kernel_rf_s3
s_add_u32 s77, s76, s82
s_bfe_u32 s28, s77, 0x40002
s_lshl_b32 s28, s28, 14
s_and_b32 s77, s77, 3
s_lshl_b32 s77, s77, 11
s_add_u32 s28, s28, s77
s_add_u32 s28, s28, s83
s_buffer_load_dword s78, s[84:87], s28 offset:0
s_buffer_load_dword s78, s[84:87], s28 offset:128
s_buffer_load_dword s78, s[84:87], s28 offset:256
s_buffer_load_dword s78, s[84:87], s28 offset:384
s_buffer_load_dword s78, s[84:87], s28 offset:512
s_buffer_load_dword s78, s[84:87], s28 offset:640
s_buffer_load_dword s78, s[84:87], s28 offset:768
s_buffer_load_dword s78, s[84:87], s28 offset:896
s_buffer_load_dword s78, s[84:87], s28 offset:1024
s_buffer_load_dword s78, s[84:87], s28 offset:1152
s_buffer_load_dword s78, s[84:87], s28 offset:1280
s_buffer_load_dword s78, s[84:87], s28 offset:1408
s_buffer_load_dword s78, s[84:87], s28 offset:1536
s_buffer_load_dword s78, s[84:87], s28 offset:1664
s_buffer_load_dword s78, s[84:87], s28 offset:1792
s_buffer_load_dword s78, s[84:87], s28 offset:1920
s_mov_b32 s88, s76
s_branch mega_kernel_rf_s3
mega_kernel_rf_s2:
ds_read_b128 v[120:123], v5 offset:0
ds_read_b128 v[124:127], v5 offset:1024
ds_read_b128 v[128:131], v5 offset:2048
ds_read_b128 v[132:135], v5 offset:3072
v_lshrrev_b32 v5, 1, v17
s_waitcnt lgkmcnt(2)
v_pk_add_f32 v[120:121], v[120:121], v[124:125]
v_pk_add_f32 v[122:123], v[122:123], v[126:127]
s_waitcnt lgkmcnt(0)
v_pk_add_f32 v[128:129], v[128:129], v[132:133]
v_pk_add_f32 v[130:131], v[130:131], v[134:135]
v_pk_add_f32 v[120:121], v[120:121], v[128:129]
v_pk_add_f32 v[122:123], v[122:123], v[130:131]
v_cvt_pk_bf16_f32 v244, v120, v121
v_cvt_pk_bf16_f32 v245, v122, v123
ds_write_b64 v5, v[244:245] offset:17920
s_waitcnt lgkmcnt(0) vmcnt(0)
mega_kernel_rf_s3:
s_cmp_eq_u32 s27, 63
s_cbranch_scc1 mega_kernel_rf_slast
s_add_u32 s29, s33, 24576
s_barrier
s_cmp_eq_u32 s24, 3
s_cbranch_scc1 mega_kernel_rf_y3
s_add_u32 s77, s27, s82
s_bfe_u32 s28, s77, 0x30003
s_lshl_b32 s28, s28, 14
s_and_b32 s77, s77, 7
s_lshl_b32 s77, s77, 10
s_add_u32 s28, s28, s77
s_add_u32 s28, s28, s79
s_cmp_eq_u32 s24, 2
s_cbranch_scc1 mega_kernel_rf_kv2a
s_mov_b64 exec, s[48:49]
buffer_store_dwordx4 v[244:247], v22, s[84:87], s28 offen sc1
s_mov_b64 exec, -1
s_branch mega_kernel_rf_kvda
mega_kernel_rf_kv2a:
v_lshlrev_b32 v4, 3, v1
buffer_store_dwordx2 v[244:245], v4, s[84:87], s28 offen offset:512 sc1
mega_kernel_rf_kvda:
s_branch mega_kernel_rf_y4
mega_kernel_rf_y3:
s_add_u32 s76, s27, 2
s_cmp_lt_u32 s76, 63
s_cbranch_scc0 mega_kernel_rf_y4
mega_kernel_rf_y4:
s_branch mega_kernel_rf_b3
mega_kernel_rf_first:
buffer_load_dwordx4 v[32:35], v8, s[20:23], 0 offen offset:0
buffer_load_dwordx4 v[36:39], v8, s[20:23], 0 offen offset:128
buffer_load_dwordx4 v[40:43], v8, s[20:23], 0 offen offset:256
buffer_load_dwordx4 v[44:47], v8, s[20:23], 0 offen offset:384
v_add_u32 v5, s44, v17
ds_read_b128 v[156:159], v5 offset:0
ds_read_b128 v[160:163], v5 offset:1024
ds_read_b128 v[164:167], v5 offset:2048
ds_read_b128 v[168:171], v5 offset:3072
s_waitcnt vmcnt(0)
v_smfmac_f32_16x16x64_bf16 v[96:99], v[32:35], a[0:7], v6
v_smfmac_f32_16x16x64_bf16 v[100:103], v[32:35], a[32:39], v6
v_smfmac_f32_16x16x64_bf16 v[104:107], v[32:35], a[64:71], v6
v_smfmac_f32_16x16x64_bf16 v[108:111], v[32:35], a[96:103], v6
v_smfmac_f32_16x16x64_bf16 v[96:99], v[36:39], a[8:15], v6
v_smfmac_f32_16x16x64_bf16 v[100:103], v[36:39], a[40:47], v6
v_smfmac_f32_16x16x64_bf16 v[104:107], v[36:39], a[72:79], v6
v_smfmac_f32_16x16x64_bf16 v[108:111], v[36:39], a[104:111], v6
v_smfmac_f32_16x16x64_bf16 v[96:99], v[40:43], a[16:23], v6
v_smfmac_f32_16x16x64_bf16 v[100:103], v[40:43], a[48:55], v6
v_smfmac_f32_16x16x64_bf16 v[104:107], v[40:43], a[80:87], v6
v_smfmac_f32_16x16x64_bf16 v[108:111], v[40:43], a[112:119], v6
v_smfmac_f32_16x16x64_bf16 v[96:99], v[44:47], a[24:31], v6
v_smfmac_f32_16x16x64_bf16 v[100:103], v[44:47], a[56:63], v6
v_smfmac_f32_16x16x64_bf16 v[104:107], v[44:47], a[88:95], v6
v_smfmac_f32_16x16x64_bf16 v[108:111], v[44:47], a[120:127], v6
s_nop 1
s_branch mega_kernel_rf_adone
mega_kernel_rf_slast:
s_cmp_eq_u32 s24, 3
s_cbranch_scc1 mega_kernel_rf_end
s_add_u32 s77, s27, s82
s_bfe_u32 s28, s77, 0x30003
s_lshl_b32 s28, s28, 14
s_and_b32 s77, s77, 7
s_lshl_b32 s77, s77, 10
s_add_u32 s28, s28, s77
s_add_u32 s28, s28, s79
s_cmp_eq_u32 s24, 2
s_cbranch_scc1 mega_kernel_rf_kv2b
s_mov_b64 exec, s[48:49]
buffer_store_dwordx4 v[244:247], v22, s[84:87], s28 offen sc1
s_mov_b64 exec, -1
s_branch mega_kernel_rf_kvdb
mega_kernel_rf_kv2b:
v_lshlrev_b32 v4, 3, v1
buffer_store_dwordx2 v[244:245], v4, s[84:87], s28 offen offset:512 sc1
mega_kernel_rf_kvdb:
s_waitcnt vmcnt(0)
s_barrier
s_mov_b32 s76, 64
s_cmp_eq_u32 s24, 1
s_cbranch_scc0 mega_kernel_rf_end
v_mov_b32 v5, s76
s_mov_b64 exec, 1
buffer_store_dword v5, v228, s[84:87], s81 offen sc1
s_mov_b64 exec, -1
mega_kernel_rf_end:
s_endpgm
mega_kernel_recs:
s_load_dwordx2 s[20:21], s[0:1], 8
s_load_dwordx2 s[16:17], s[0:1], 40
s_load_dwordx2 s[4:5], s[0:1], 16
s_load_dwordx2 s[8:9], s[0:1], 24
s_load_dwordx2 s[12:13], s[0:1], 32
v_lshrrev_b32 v4, 6, v0
v_and_b32 v1, 63, v0
v_readfirstlane_b32 s24, v4
v_lshrrev_b32 v2, 4, v1
v_and_b32 v3, 15, v1
v_lshlrev_b32 v17, 4, v1
s_lshr_b32 s28, s31, 2
s_lshl_b32 s25, s30, 3
s_add_u32 s25, s25, s28
s_and_b32 s26, s31, 3
s_waitcnt lgkmcnt(0)
s_mov_b32 s22, 16384
s_mov_b32 s23, 0x00020000
s_mov_b32 s18, 8388608
s_mov_b32 s19, 0x00020000
s_mov_b32 s6, 8388608
s_mov_b32 s7, 0x00020000
s_mov_b32 s10, 8388608
s_mov_b32 s11, 0x00020000
s_mov_b32 s14, 8388608
s_mov_b32 s15, 0x00020000
s_lshl_b32 s28, s25, 8
s_lshr_b32 s29, s26, 0
s_lshl_b32 s29, s29, 6
s_add_u32 s28, s28, s29
s_lshl_b32 s29, s24, 21
s_add_u32 s28, s28, s29
v_lshrrev_b32 v4, 2, v1
v_and_b32 v5, 3, v1
v_lshlrev_b32 v40, 13, v4
v_lshl_add_u32 v40, v5, 4, v40
v_add_u32 v40, s28, v40
s_lshl_b32 s28, s30, 21
s_lshl_b32 s29, s24, 19
s_add_u32 s28, s28, s29
s_lshr_b32 s29, s31, 0
s_lshl_b32 s29, s29, 6
s_add_u32 s28, s28, s29
v_lshlrev_b32 v41, 11, v4
v_lshl_add_u32 v41, v5, 4, v41
v_add_u32 v41, s28, v41
s_lshl_b32 s47, s24, 15
s_add_u32 s47, s47, 32768
s_lshl_b32 s28, s31, 18
s_lshl_b32 s29, s24, 16
s_add_u32 s28, s28, s29
s_lshl_b32 s29, s30, 11
s_add_u32 s28, s28, s29
v_lshlrev_b32 v48, 13, v2
v_lshl_add_u32 v48, v3, 7, v48
v_add_u32 v48, s28, v48
s_lshl_b32 s28, s30, 21
s_lshl_b32 s29, s31, 16
s_add_u32 s28, s28, s29
s_lshl_b32 s29, s24, 14
s_add_u32 s28, s28, s29
v_lshlrev_b32 v49, 7, v1
v_add_u32 v49, s28, v49
s_and_b32 s76, s31, 1
s_mul_i32 s76, s76, 8
s_and_b32 s28, s31, 15
s_lshl_b32 s28, s28, 4
s_lshl_b32 s29, s24, 8
s_add_u32 s28, s28, s29
v_add_u32 v53, s28, v3
s_lshr_b32 s28, s31, 4
s_lshl_b32 s28, s28, 10
s_add_u32 s28, s28, 384
v_mov_b32 v54, s28
v_mov_b32 v55, 1920
v_cmp_gt_u32 vcc, 32, v1
s_nop 1
v_cndmask_b32 v54, v55, v54, vcc
s_lshl_b32 s29, s30, 11
v_lshl_add_u32 v51, v53, 13, v54
v_add_u32 v51, s29, v51
s_lshl_b32 s29, s30, 21
v_lshl_add_u32 v52, v53, 11, v54
v_add_u32 v52, s29, v52
buffer_load_dword v50, v51, s[8:11], 0 offen
s_xor_b32 s29, s76, 0
s_lshl_b32 s28, s29, 10
s_add_u32 s28, s28, s47
s_add_u32 m0, s28, 0
s_lshl_b32 s29, s29, 17
buffer_load_dwordx4 v40, s[8:11], s29 offen lds
s_xor_b32 s29, s76, 1
s_lshl_b32 s28, s29, 10
s_add_u32 s28, s28, s47
s_add_u32 m0, s28, 0
s_lshl_b32 s29, s29, 17
buffer_load_dwordx4 v40, s[8:11], s29 offen lds
s_xor_b32 s29, s76, 2
s_lshl_b32 s28, s29, 10
s_add_u32 s28, s28, s47
s_add_u32 m0, s28, 0
s_lshl_b32 s29, s29, 17
buffer_load_dwordx4 v40, s[8:11], s29 offen lds
s_xor_b32 s29, s76, 3
s_lshl_b32 s28, s29, 10
s_add_u32 s28, s28, s47
s_add_u32 m0, s28, 0
s_lshl_b32 s29, s29, 17
buffer_load_dwordx4 v40, s[8:11], s29 offen lds
s_xor_b32 s29, s76, 4
s_lshl_b32 s28, s29, 10
s_add_u32 s28, s28, s47
s_add_u32 m0, s28, 0
s_lshl_b32 s29, s29, 17
buffer_load_dwordx4 v40, s[8:11], s29 offen lds
s_xor_b32 s29, s76, 5
s_lshl_b32 s28, s29, 10
s_add_u32 s28, s28, s47
s_add_u32 m0, s28, 0
s_lshl_b32 s29, s29, 17
buffer_load_dwordx4 v40, s[8:11], s29 offen lds
s_xor_b32 s29, s76, 6
s_lshl_b32 s28, s29, 10
s_add_u32 s28, s28, s47
s_add_u32 m0, s28, 0
s_lshl_b32 s29, s29, 17
buffer_load_dwordx4 v40, s[8:11], s29 offen lds
s_xor_b32 s29, s76, 7
s_lshl_b32 s28, s29, 10
s_add_u32 s28, s28, s47
s_add_u32 m0, s28, 0
s_lshl_b32 s29, s29, 17
buffer_load_dwordx4 v40, s[8:11], s29 offen lds
s_xor_b32 s29, s76, 8
s_lshl_b32 s28, s29, 10
s_add_u32 s28, s28, s47
s_add_u32 m0, s28, 0
s_lshl_b32 s29, s29, 17
buffer_load_dwordx4 v40, s[8:11], s29 offen lds
s_xor_b32 s29, s76, 9
s_lshl_b32 s28, s29, 10
s_add_u32 s28, s28, s47
s_add_u32 m0, s28, 0
s_lshl_b32 s29, s29, 17
buffer_load_dwordx4 v40, s[8:11], s29 offen lds
s_xor_b32 s29, s76, 10
s_lshl_b32 s28, s29, 10
s_add_u32 s28, s28, s47
s_add_u32 m0, s28, 0
s_lshl_b32 s29, s29, 17
buffer_load_dwordx4 v40, s[8:11], s29 offen lds
s_xor_b32 s29, s76, 11
s_lshl_b32 s28, s29, 10
s_add_u32 s28, s28, s47
s_add_u32 m0, s28, 0
s_lshl_b32 s29, s29, 17
buffer_load_dwordx4 v40, s[8:11], s29 offen lds
s_xor_b32 s29, s76, 12
s_lshl_b32 s28, s29, 10
s_add_u32 s28, s28, s47
s_add_u32 m0, s28, 0
s_lshl_b32 s29, s29, 17
buffer_load_dwordx4 v40, s[8:11], s29 offen lds
s_xor_b32 s29, s76, 13
s_lshl_b32 s28, s29, 10
s_add_u32 s28, s28, s47
s_add_u32 m0, s28, 0
s_lshl_b32 s29, s29, 17
buffer_load_dwordx4 v40, s[8:11], s29 offen lds
s_xor_b32 s29, s76, 14
s_lshl_b32 s28, s29, 10
s_add_u32 s28, s28, s47
s_add_u32 m0, s28, 0
s_lshl_b32 s29, s29, 17
buffer_load_dwordx4 v40, s[8:11], s29 offen lds
s_xor_b32 s29, s76, 15
s_lshl_b32 s28, s29, 10
s_add_u32 s28, s28, s47
s_add_u32 m0, s28, 0
s_lshl_b32 s29, s29, 17
buffer_load_dwordx4 v40, s[8:11], s29 offen lds
buffer_load_dword v50, v51, s[12:15], 0 offen
s_xor_b32 s29, s76, 0
s_lshl_b32 s28, s29, 10
s_add_u32 s28, s28, s47
s_add_u32 m0, s28, 16384
s_lshl_b32 s29, s29, 17
buffer_load_dwordx4 v40, s[12:15], s29 offen lds
s_xor_b32 s29, s76, 1
s_lshl_b32 s28, s29, 10
s_add_u32 s28, s28, s47
s_add_u32 m0, s28, 16384
s_lshl_b32 s29, s29, 17
buffer_load_dwordx4 v40, s[12:15], s29 offen lds
s_xor_b32 s29, s76, 2
s_lshl_b32 s28, s29, 10
s_add_u32 s28, s28, s47
s_add_u32 m0, s28, 16384
s_lshl_b32 s29, s29, 17
buffer_load_dwordx4 v40, s[12:15], s29 offen lds
s_xor_b32 s29, s76, 3
s_lshl_b32 s28, s29, 10
s_add_u32 s28, s28, s47
s_add_u32 m0, s28, 16384
s_lshl_b32 s29, s29, 17
buffer_load_dwordx4 v40, s[12:15], s29 offen lds
s_xor_b32 s29, s76, 4
s_lshl_b32 s28, s29, 10
s_add_u32 s28, s28, s47
s_add_u32 m0, s28, 16384
s_lshl_b32 s29, s29, 17
buffer_load_dwordx4 v40, s[12:15], s29 offen lds
s_xor_b32 s29, s76, 5
s_lshl_b32 s28, s29, 10
s_add_u32 s28, s28, s47
s_add_u32 m0, s28, 16384
s_lshl_b32 s29, s29, 17
buffer_load_dwordx4 v40, s[12:15], s29 offen lds
s_xor_b32 s29, s76, 6
s_lshl_b32 s28, s29, 10
s_add_u32 s28, s28, s47
s_add_u32 m0, s28, 16384
s_lshl_b32 s29, s29, 17
buffer_load_dwordx4 v40, s[12:15], s29 offen lds
s_xor_b32 s29, s76, 7
s_lshl_b32 s28, s29, 10
s_add_u32 s28, s28, s47
s_add_u32 m0, s28, 16384
s_lshl_b32 s29, s29, 17
buffer_load_dwordx4 v40, s[12:15], s29 offen lds
s_xor_b32 s29, s76, 8
s_lshl_b32 s28, s29, 10
s_add_u32 s28, s28, s47
s_add_u32 m0, s28, 16384
s_lshl_b32 s29, s29, 17
buffer_load_dwordx4 v40, s[12:15], s29 offen lds
s_xor_b32 s29, s76, 9
s_lshl_b32 s28, s29, 10
s_add_u32 s28, s28, s47
s_add_u32 m0, s28, 16384
s_lshl_b32 s29, s29, 17
buffer_load_dwordx4 v40, s[12:15], s29 offen lds
s_xor_b32 s29, s76, 10
s_lshl_b32 s28, s29, 10
s_add_u32 s28, s28, s47
s_add_u32 m0, s28, 16384
s_lshl_b32 s29, s29, 17
buffer_load_dwordx4 v40, s[12:15], s29 offen lds
s_xor_b32 s29, s76, 11
s_lshl_b32 s28, s29, 10
s_add_u32 s28, s28, s47
s_add_u32 m0, s28, 16384
s_lshl_b32 s29, s29, 17
buffer_load_dwordx4 v40, s[12:15], s29 offen lds
s_xor_b32 s29, s76, 12
s_lshl_b32 s28, s29, 10
s_add_u32 s28, s28, s47
s_add_u32 m0, s28, 16384
s_lshl_b32 s29, s29, 17
buffer_load_dwordx4 v40, s[12:15], s29 offen lds
s_xor_b32 s29, s76, 13
s_lshl_b32 s28, s29, 10
s_add_u32 s28, s28, s47
s_add_u32 m0, s28, 16384
s_lshl_b32 s29, s29, 17
buffer_load_dwordx4 v40, s[12:15], s29 offen lds
s_xor_b32 s29, s76, 14
s_lshl_b32 s28, s29, 10
s_add_u32 s28, s28, s47
s_add_u32 m0, s28, 16384
s_lshl_b32 s29, s29, 17
buffer_load_dwordx4 v40, s[12:15], s29 offen lds
s_xor_b32 s29, s76, 15
s_lshl_b32 s28, s29, 10
s_add_u32 s28, s28, s47
s_add_u32 m0, s28, 16384
s_lshl_b32 s29, s29, 17
buffer_load_dwordx4 v40, s[12:15], s29 offen lds
s_mov_b32 s40, 0x00ff00ff
s_mov_b32 s41, 0x00ff00ff
s_mov_b32 s48, 0xff00ff00
s_mov_b32 s49, 0xff00ff00
s_mov_b32 s42, 0
s_mov_b32 s43, 0x00ff00ff
s_mov_b32 s32, 0x3e0293ee
v_mov_b32 v23, 0xff800000
v_mov_b32 v6, 0x4444
v_mov_b32 v4, 0xeeee
v_cndmask_b32 v6, v6, v4, s[48:49]
v_mov_b32 v28, -1
v_mov_b32 v29, -1
v_mov_b32 v30, -1
v_mov_b32 v31, -1
s_mul_i32 s28, s24, 4096
v_add_u32 v7, s28, v17
v_and_b32 v4, 7, v1
v_lshlrev_b32 v8, 11, v4
v_lshrrev_b32 v5, 3, v1
v_lshl_add_u32 v8, v5, 4, v8
s_lshl_b32 s28, s24, 9
v_add_u32 v8, s28, v8
s_lshl_b32 s28, s31, 9
s_lshr_b32 s29, s31, 3
s_mul_i32 s29, s29, 0
s_add_u32 s28, s28, s29
v_lshlrev_b32 v9, 3, v1
v_add_u32 v9, s28, v9
v_and_b32 v4, 7, v3
v_lshlrev_b32 v11, 7, v2
v_lshl_add_u32 v11, v4, 4, v11
v_add_u32 v22, 0, v11
s_add_u32 s28, s28, 24576
v_add_u32 v11, s28, v11
v_and_b32 v5, 1, v2
v_lshlrev_b32 v10, 7, v5
v_lshl_add_u32 v10, v4, 4, v10
v_add_u32 v10, 1024, v10
s_xor_b32 s37, s31, 1
s_mul_i32 s37, s37, 2048
s_add_u32 s37, s37, 49152
s_xor_b32 s38, s31, 2
s_mul_i32 s38, s38, 2048
s_add_u32 s38, s38, 49152
s_xor_b32 s39, s31, 3
s_mul_i32 s39, s39, 2048
s_add_u32 s39, s39, 49152
v_and_b32 v4, 1, v2
v_mul_u32_u24 v14, 576, v4
v_lshrrev_b32 v5, 1, v2
v_lshl_add_u32 v5, v5, 4, v3
v_lshl_add_u32 v14, v5, 2, v14
s_mul_i32 s28, s24, 1152
s_add_u32 s28, s28, 13312
v_add_u32 v18, s28, v14
s_mul_i32 s28, s24, 2304
v_add_u32 v14, s28, v14
v_add_u32 v15, 1152, v14
v_mul_u32_u24 v16, 144, v3
v_lshl_add_u32 v16, v2, 5, v16
v_bfe_u32 v4, v1, 1, 3
v_mul_u32_u24 v19, 144, v4
v_lshl_add_u32 v19, v2, 5, v19
v_and_b32 v4, 1, v1
v_lshl_add_u32 v19, v4, 4, v19
v_add_u32 v19, 13312, v19
s_lshl_b32 s28, s24, 10
s_add_u32 s28, s28, 9216
v_add_u32 v20, s28, v17
v_and_b32 v4, 31, v1
v_lshlrev_b32 v21, 3, v4
v_add_u32 v21, 17920, v21
v_lshrrev_b32 v4, 2, v3
v_and_b32 v42, 1, v4
v_lshrrev_b32 v43, 1, v4
v_lshrrev_b32 v44, 1, v2
v_and_b32 v45, 1, v2
v_lshl_add_u32 v46, v44, 4, v42
v_lshl_add_u32 v46, v45, 2, v46
v_lshl_add_u32 v46, v43, 3, v46
v_lshl_add_u32 v47, v44, 3, v42
v_lshl_add_u32 v47, v45, 4, v47
v_lshl_add_u32 v47, v43, 2, v47
v_and_b32 v5, 3, v3
v_lshlrev_b32 v5, 3, v5
v_lshl_add_u32 v46, v46, 6, v5
v_lshl_add_u32 v47, v47, 6, v5
s_and_b32 s28, s31, 0
s_lshl_b32 s28, s28, 6
s_add_u32 s28, s28, s47
v_add_u32 v46, s28, v46
v_add_u32 v47, s28, v47
s_waitcnt vmcnt(17)
ds_read_b64_tr_b16 a[64:65], v46 offset:0
ds_read_b64_tr_b16 a[66:67], v46 offset:128
ds_read_b64_tr_b16 a[68:69], v46 offset:2048
ds_read_b64_tr_b16 a[70:71], v46 offset:2176
ds_read_b64_tr_b16 a[72:73], v46 offset:4096
ds_read_b64_tr_b16 a[74:75], v46 offset:4224
ds_read_b64_tr_b16 a[76:77], v46 offset:6144
ds_read_b64_tr_b16 a[78:79], v46 offset:6272
s_waitcnt lgkmcnt(0)
ds_read_b64_tr_b16 a[80:81], v46 offset:8192
ds_read_b64_tr_b16 a[82:83], v46 offset:8320
ds_read_b64_tr_b16 a[84:85], v46 offset:10240
ds_read_b64_tr_b16 a[86:87], v46 offset:10368
ds_read_b64_tr_b16 a[88:89], v46 offset:12288
ds_read_b64_tr_b16 a[90:91], v46 offset:12416
ds_read_b64_tr_b16 a[92:93], v46 offset:14336
ds_read_b64_tr_b16 a[94:95], v46 offset:14464
s_waitcnt lgkmcnt(0)
ds_read_b64_tr_b16 a[96:97], v46 offset:32
ds_read_b64_tr_b16 a[98:99], v46 offset:160
ds_read_b64_tr_b16 a[100:101], v46 offset:2080
ds_read_b64_tr_b16 a[102:103], v46 offset:2208
ds_read_b64_tr_b16 a[104:105], v46 offset:4128
ds_read_b64_tr_b16 a[106:107], v46 offset:4256
ds_read_b64_tr_b16 a[108:109], v46 offset:6176
ds_read_b64_tr_b16 a[110:111], v46 offset:6304
s_waitcnt lgkmcnt(0)
ds_read_b64_tr_b16 a[112:113], v46 offset:8224
ds_read_b64_tr_b16 a[114:115], v46 offset:8352
ds_read_b64_tr_b16 a[116:117], v46 offset:10272
ds_read_b64_tr_b16 a[118:119], v46 offset:10400
ds_read_b64_tr_b16 a[120:121], v46 offset:12320
ds_read_b64_tr_b16 a[122:123], v46 offset:12448
ds_read_b64_tr_b16 a[124:125], v46 offset:14368
ds_read_b64_tr_b16 a[126:127], v46 offset:14496
s_waitcnt lgkmcnt(0)
buffer_load_dword v50, v51, s[4:7], 0 offen
s_xor_b32 s29, s76, 0
s_lshl_b32 s28, s29, 10
s_add_u32 s28, s28, s47
s_add_u32 m0, s28, 0
s_lshl_b32 s29, s29, 17
buffer_load_dwordx4 v40, s[4:7], s29 offen lds
s_xor_b32 s29, s76, 1
s_lshl_b32 s28, s29, 10
s_add_u32 s28, s28, s47
s_add_u32 m0, s28, 0
s_lshl_b32 s29, s29, 17
buffer_load_dwordx4 v40, s[4:7], s29 offen lds
s_xor_b32 s29, s76, 2
s_lshl_b32 s28, s29, 10
s_add_u32 s28, s28, s47
s_add_u32 m0, s28, 0
s_lshl_b32 s29, s29, 17
buffer_load_dwordx4 v40, s[4:7], s29 offen lds
s_xor_b32 s29, s76, 3
s_lshl_b32 s28, s29, 10
s_add_u32 s28, s28, s47
s_add_u32 m0, s28, 0
s_lshl_b32 s29, s29, 17
buffer_load_dwordx4 v40, s[4:7], s29 offen lds
s_xor_b32 s29, s76, 4
s_lshl_b32 s28, s29, 10
s_add_u32 s28, s28, s47
s_add_u32 m0, s28, 0
s_lshl_b32 s29, s29, 17
buffer_load_dwordx4 v40, s[4:7], s29 offen lds
s_xor_b32 s29, s76, 5
s_lshl_b32 s28, s29, 10
s_add_u32 s28, s28, s47
s_add_u32 m0, s28, 0
s_lshl_b32 s29, s29, 17
buffer_load_dwordx4 v40, s[4:7], s29 offen lds
s_xor_b32 s29, s76, 6
s_lshl_b32 s28, s29, 10
s_add_u32 s28, s28, s47
s_add_u32 m0, s28, 0
s_lshl_b32 s29, s29, 17
buffer_load_dwordx4 v40, s[4:7], s29 offen lds
s_xor_b32 s29, s76, 7
s_lshl_b32 s28, s29, 10
s_add_u32 s28, s28, s47
s_add_u32 m0, s28, 0
s_lshl_b32 s29, s29, 17
buffer_load_dwordx4 v40, s[4:7], s29 offen lds
s_xor_b32 s29, s76, 8
s_lshl_b32 s28, s29, 10
s_add_u32 s28, s28, s47
s_add_u32 m0, s28, 0
s_lshl_b32 s29, s29, 17
buffer_load_dwordx4 v40, s[4:7], s29 offen lds
s_xor_b32 s29, s76, 9
s_lshl_b32 s28, s29, 10
s_add_u32 s28, s28, s47
s_add_u32 m0, s28, 0
s_lshl_b32 s29, s29, 17
buffer_load_dwordx4 v40, s[4:7], s29 offen lds
s_xor_b32 s29, s76, 10
s_lshl_b32 s28, s29, 10
s_add_u32 s28, s28, s47
s_add_u32 m0, s28, 0
s_lshl_b32 s29, s29, 17
buffer_load_dwordx4 v40, s[4:7], s29 offen lds
s_xor_b32 s29, s76, 11
s_lshl_b32 s28, s29, 10
s_add_u32 s28, s28, s47
s_add_u32 m0, s28, 0
s_lshl_b32 s29, s29, 17
buffer_load_dwordx4 v40, s[4:7], s29 offen lds
s_xor_b32 s29, s76, 12
s_lshl_b32 s28, s29, 10
s_add_u32 s28, s28, s47
s_add_u32 m0, s28, 0
s_lshl_b32 s29, s29, 17
buffer_load_dwordx4 v40, s[4:7], s29 offen lds
s_xor_b32 s29, s76, 13
s_lshl_b32 s28, s29, 10
s_add_u32 s28, s28, s47
s_add_u32 m0, s28, 0
s_lshl_b32 s29, s29, 17
buffer_load_dwordx4 v40, s[4:7], s29 offen lds
s_xor_b32 s29, s76, 14
s_lshl_b32 s28, s29, 10
s_add_u32 s28, s28, s47
s_add_u32 m0, s28, 0
s_lshl_b32 s29, s29, 17
buffer_load_dwordx4 v40, s[4:7], s29 offen lds
s_xor_b32 s29, s76, 15
s_lshl_b32 s28, s29, 10
s_add_u32 s28, s28, s47
s_add_u32 m0, s28, 0
s_lshl_b32 s29, s29, 17
buffer_load_dwordx4 v40, s[4:7], s29 offen lds
s_waitcnt vmcnt(17)
ds_read_b64_tr_b16 a[128:129], v46 offset:16384
ds_read_b64_tr_b16 a[130:131], v46 offset:16512
ds_read_b64_tr_b16 a[132:133], v46 offset:18432
ds_read_b64_tr_b16 a[134:135], v46 offset:18560
ds_read_b64_tr_b16 a[136:137], v46 offset:20480
ds_read_b64_tr_b16 a[138:139], v46 offset:20608
ds_read_b64_tr_b16 a[140:141], v46 offset:22528
ds_read_b64_tr_b16 a[142:143], v46 offset:22656
s_waitcnt lgkmcnt(0)
ds_read_b64_tr_b16 a[144:145], v46 offset:24576
ds_read_b64_tr_b16 a[146:147], v46 offset:24704
ds_read_b64_tr_b16 a[148:149], v46 offset:26624
ds_read_b64_tr_b16 a[150:151], v46 offset:26752
ds_read_b64_tr_b16 a[152:153], v46 offset:28672
ds_read_b64_tr_b16 a[154:155], v46 offset:28800
ds_read_b64_tr_b16 a[156:157], v46 offset:30720
ds_read_b64_tr_b16 a[158:159], v46 offset:30848
s_waitcnt lgkmcnt(0)
ds_read_b64_tr_b16 a[160:161], v46 offset:16416
ds_read_b64_tr_b16 a[162:163], v46 offset:16544
ds_read_b64_tr_b16 a[164:165], v46 offset:18464
ds_read_b64_tr_b16 a[166:167], v46 offset:18592
ds_read_b64_tr_b16 a[168:169], v46 offset:20512
ds_read_b64_tr_b16 a[170:171], v46 offset:20640
ds_read_b64_tr_b16 a[172:173], v46 offset:22560
ds_read_b64_tr_b16 a[174:175], v46 offset:22688
s_waitcnt lgkmcnt(0)
ds_read_b64_tr_b16 a[176:177], v46 offset:24608
ds_read_b64_tr_b16 a[178:179], v46 offset:24736
ds_read_b64_tr_b16 a[180:181], v46 offset:26656
ds_read_b64_tr_b16 a[182:183], v46 offset:26784
ds_read_b64_tr_b16 a[184:185], v46 offset:28704
ds_read_b64_tr_b16 a[186:187], v46 offset:28832
ds_read_b64_tr_b16 a[188:189], v46 offset:30752
ds_read_b64_tr_b16 a[190:191], v46 offset:30880
s_waitcnt lgkmcnt(0)
buffer_load_dword v50, v52, s[16:19], 0 offen
s_xor_b32 s29, s76, 0
s_lshl_b32 s28, s29, 10
s_add_u32 s28, s28, s47
s_add_u32 m0, s28, 16384
s_lshl_b32 s29, s29, 15
buffer_load_dwordx4 v41, s[16:19], s29 offen lds
s_xor_b32 s29, s76, 1
s_lshl_b32 s28, s29, 10
s_add_u32 s28, s28, s47
s_add_u32 m0, s28, 16384
s_lshl_b32 s29, s29, 15
buffer_load_dwordx4 v41, s[16:19], s29 offen lds
s_xor_b32 s29, s76, 2
s_lshl_b32 s28, s29, 10
s_add_u32 s28, s28, s47
s_add_u32 m0, s28, 16384
s_lshl_b32 s29, s29, 15
buffer_load_dwordx4 v41, s[16:19], s29 offen lds
s_xor_b32 s29, s76, 3
s_lshl_b32 s28, s29, 10
s_add_u32 s28, s28, s47
s_add_u32 m0, s28, 16384
s_lshl_b32 s29, s29, 15
buffer_load_dwordx4 v41, s[16:19], s29 offen lds
s_xor_b32 s29, s76, 4
s_lshl_b32 s28, s29, 10
s_add_u32 s28, s28, s47
s_add_u32 m0, s28, 16384
s_lshl_b32 s29, s29, 15
buffer_load_dwordx4 v41, s[16:19], s29 offen lds
s_xor_b32 s29, s76, 5
s_lshl_b32 s28, s29, 10
s_add_u32 s28, s28, s47
s_add_u32 m0, s28, 16384
s_lshl_b32 s29, s29, 15
buffer_load_dwordx4 v41, s[16:19], s29 offen lds
s_xor_b32 s29, s76, 6
s_lshl_b32 s28, s29, 10
s_add_u32 s28, s28, s47
s_add_u32 m0, s28, 16384
s_lshl_b32 s29, s29, 15
buffer_load_dwordx4 v41, s[16:19], s29 offen lds
s_xor_b32 s29, s76, 7
s_lshl_b32 s28, s29, 10
s_add_u32 s28, s28, s47
s_add_u32 m0, s28, 16384
s_lshl_b32 s29, s29, 15
buffer_load_dwordx4 v41, s[16:19], s29 offen lds
s_xor_b32 s29, s76, 8
s_lshl_b32 s28, s29, 10
s_add_u32 s28, s28, s47
s_add_u32 m0, s28, 16384
s_lshl_b32 s29, s29, 15
buffer_load_dwordx4 v41, s[16:19], s29 offen lds
s_xor_b32 s29, s76, 9
s_lshl_b32 s28, s29, 10
s_add_u32 s28, s28, s47
s_add_u32 m0, s28, 16384
s_lshl_b32 s29, s29, 15
buffer_load_dwordx4 v41, s[16:19], s29 offen lds
s_xor_b32 s29, s76, 10
s_lshl_b32 s28, s29, 10
s_add_u32 s28, s28, s47
s_add_u32 m0, s28, 16384
s_lshl_b32 s29, s29, 15
buffer_load_dwordx4 v41, s[16:19], s29 offen lds
s_xor_b32 s29, s76, 11
s_lshl_b32 s28, s29, 10
s_add_u32 s28, s28, s47
s_add_u32 m0, s28, 16384
s_lshl_b32 s29, s29, 15
buffer_load_dwordx4 v41, s[16:19], s29 offen lds
s_xor_b32 s29, s76, 12
s_lshl_b32 s28, s29, 10
s_add_u32 s28, s28, s47
s_add_u32 m0, s28, 16384
s_lshl_b32 s29, s29, 15
buffer_load_dwordx4 v41, s[16:19], s29 offen lds
s_xor_b32 s29, s76, 13
s_lshl_b32 s28, s29, 10
s_add_u32 s28, s28, s47
s_add_u32 m0, s28, 16384
s_lshl_b32 s29, s29, 15
buffer_load_dwordx4 v41, s[16:19], s29 offen lds
s_xor_b32 s29, s76, 14
s_lshl_b32 s28, s29, 10
s_add_u32 s28, s28, s47
s_add_u32 m0, s28, 16384
s_lshl_b32 s29, s29, 15
buffer_load_dwordx4 v41, s[16:19], s29 offen lds
s_xor_b32 s29, s76, 15
s_lshl_b32 s28, s29, 10
s_add_u32 s28, s28, s47
s_add_u32 m0, s28, 16384
s_lshl_b32 s29, s29, 15
buffer_load_dwordx4 v41, s[16:19], s29 offen lds
s_waitcnt vmcnt(17)
ds_read_b64_tr_b16 a[0:1], v46 offset:0
ds_read_b64_tr_b16 a[2:3], v46 offset:128
ds_read_b64_tr_b16 a[4:5], v46 offset:2048
ds_read_b64_tr_b16 a[6:7], v46 offset:2176
ds_read_b64_tr_b16 a[8:9], v46 offset:4096
ds_read_b64_tr_b16 a[10:11], v46 offset:4224
ds_read_b64_tr_b16 a[12:13], v46 offset:6144
ds_read_b64_tr_b16 a[14:15], v46 offset:6272
s_waitcnt lgkmcnt(0)
ds_read_b64_tr_b16 a[16:17], v46 offset:8192
ds_read_b64_tr_b16 a[18:19], v46 offset:8320
ds_read_b64_tr_b16 a[20:21], v46 offset:10240
ds_read_b64_tr_b16 a[22:23], v46 offset:10368
ds_read_b64_tr_b16 a[24:25], v46 offset:12288
ds_read_b64_tr_b16 a[26:27], v46 offset:12416
ds_read_b64_tr_b16 a[28:29], v46 offset:14336
ds_read_b64_tr_b16 a[30:31], v46 offset:14464
s_waitcnt lgkmcnt(0)
ds_read_b64_tr_b16 a[32:33], v46 offset:32
ds_read_b64_tr_b16 a[34:35], v46 offset:160
ds_read_b64_tr_b16 a[36:37], v46 offset:2080
ds_read_b64_tr_b16 a[38:39], v46 offset:2208
ds_read_b64_tr_b16 a[40:41], v46 offset:4128
ds_read_b64_tr_b16 a[42:43], v46 offset:4256
ds_read_b64_tr_b16 a[44:45], v46 offset:6176
ds_read_b64_tr_b16 a[46:47], v46 offset:6304
s_waitcnt lgkmcnt(0)
ds_read_b64_tr_b16 a[48:49], v46 offset:8224
ds_read_b64_tr_b16 a[50:51], v46 offset:8352
ds_read_b64_tr_b16 a[52:53], v46 offset:10272
ds_read_b64_tr_b16 a[54:55], v46 offset:10400
ds_read_b64_tr_b16 a[56:57], v46 offset:12320
ds_read_b64_tr_b16 a[58:59], v46 offset:12448
ds_read_b64_tr_b16 a[60:61], v46 offset:14368
ds_read_b64_tr_b16 a[62:63], v46 offset:14496
s_waitcnt lgkmcnt(0)
v_and_b32 v247, 15, v0
v_lshlrev_b32 v247, 4, v247
buffer_load_dword v246, v247, s[72:75], 0 offen sc1
s_waitcnt vmcnt(0)
ds_read_b64_tr_b16 a[192:193], v47 offset:16384
ds_read_b64_tr_b16 a[194:195], v47 offset:16512
ds_read_b64_tr_b16 a[196:197], v47 offset:18432
ds_read_b64_tr_b16 a[198:199], v47 offset:18560
ds_read_b64_tr_b16 a[200:201], v47 offset:20480
ds_read_b64_tr_b16 a[202:203], v47 offset:20608
ds_read_b64_tr_b16 a[204:205], v47 offset:22528
ds_read_b64_tr_b16 a[206:207], v47 offset:22656
s_waitcnt lgkmcnt(0)
ds_read_b64_tr_b16 a[208:209], v47 offset:24576
ds_read_b64_tr_b16 a[210:211], v47 offset:24704
ds_read_b64_tr_b16 a[212:213], v47 offset:26624
ds_read_b64_tr_b16 a[214:215], v47 offset:26752
ds_read_b64_tr_b16 a[216:217], v47 offset:28672
ds_read_b64_tr_b16 a[218:219], v47 offset:28800
ds_read_b64_tr_b16 a[220:221], v47 offset:30720
ds_read_b64_tr_b16 a[222:223], v47 offset:30848
s_waitcnt lgkmcnt(0)
ds_read_b64_tr_b16 a[224:225], v47 offset:16416
ds_read_b64_tr_b16 a[226:227], v47 offset:16544
ds_read_b64_tr_b16 a[228:229], v47 offset:18464
ds_read_b64_tr_b16 a[230:231], v47 offset:18592
ds_read_b64_tr_b16 a[232:233], v47 offset:20512
ds_read_b64_tr_b16 a[234:235], v47 offset:20640
ds_read_b64_tr_b16 a[236:237], v47 offset:22560
ds_read_b64_tr_b16 a[238:239], v47 offset:22688
s_waitcnt lgkmcnt(0)
ds_read_b64_tr_b16 a[240:241], v47 offset:24608
ds_read_b64_tr_b16 a[242:243], v47 offset:24736
ds_read_b64_tr_b16 a[244:245], v47 offset:26656
ds_read_b64_tr_b16 a[246:247], v47 offset:26784
ds_read_b64_tr_b16 a[248:249], v47 offset:28704
ds_read_b64_tr_b16 a[250:251], v47 offset:28832
ds_read_b64_tr_b16 a[252:253], v47 offset:30752
ds_read_b64_tr_b16 a[254:255], v47 offset:30880
s_waitcnt lgkmcnt(0)
v_and_b32 v247, 15, v0
v_lshlrev_b32 v247, 4, v247
s_branch mega_kernel_sysp
mega_kernel_sysw:
s_sleep 4
mega_kernel_sys:
buffer_load_dword v246, v247, s[72:75], 0 offen sc1
s_waitcnt vmcnt(0)
mega_kernel_sysp:
s_cmp_eq_u32 s95, 1
s_cbranch_scc0 mega_kernel_sysf
v_readlane_b32 s76, v246, 14
s_mov_b32 s98, 0
s_cmp_eq_u32 s76, 32
s_cbranch_scc0 mega_kernel_sysw
s_branch mega_kernel_sysd
mega_kernel_sysf:
s_mov_b32 s77, 0
s_mov_b32 s78, 0
v_readlane_b32 s76, v246, 0
s_add_u32 s77, s77, s76
s_xor_b32 s76, s76, 32
s_or_b32 s78, s78, s76
v_readlane_b32 s76, v246, 1
s_add_u32 s77, s77, s76
s_xor_b32 s76, s76, 32
s_or_b32 s78, s78, s76
v_readlane_b32 s76, v246, 2
s_add_u32 s77, s77, s76
s_xor_b32 s76, s76, 32
s_or_b32 s78, s78, s76
v_readlane_b32 s76, v246, 3
s_add_u32 s77, s77, s76
s_xor_b32 s76, s76, 32
s_or_b32 s78, s78, s76
v_readlane_b32 s76, v246, 4
s_add_u32 s77, s77, s76
s_xor_b32 s76, s76, 32
s_or_b32 s78, s78, s76
v_readlane_b32 s76, v246, 5
s_add_u32 s77, s77, s76
s_xor_b32 s76, s76, 32
s_or_b32 s78, s78, s76
v_readlane_b32 s76, v246, 6
s_add_u32 s77, s77, s76
s_xor_b32 s76, s76, 32
s_or_b32 s78, s78, s76
v_readlane_b32 s76, v246, 7
s_add_u32 s77, s77, s76
s_xor_b32 s76, s76, 32
s_or_b32 s78, s78, s76
s_cmp_eq_u32 s77, 256
s_cbranch_scc0 mega_kernel_sysw
v_mov_b32 v252, v246
s_cmp_eq_u32 s78, 0
s_cbranch_scc0 mega_kernel_slowent
v_readlane_b32 s76, v246, 10
v_readlane_b32 s77, v246, 8
s_cmp_eq_u32 s76, 32
s_cbranch_scc0 mega_kernel_sysw
s_cmp_gt_u32 s77, 16
s_cselect_b32 s98, 1, 0
mega_kernel_sysd:
s_lshr_b32 s28, s31, 4
s_lshl_b32 s28, s28, 14
s_lshl_b32 s29, s98, 13
s_add_u32 s28, s28, s29
s_and_b32 s29, s31, 15
s_lshl_b32 s29, s29, 9
s_add_u32 s28, s28, s29
s_lshl_b32 s29, s30, 16
s_add_u32 s28, s28, s29
s_add_u32 s28, s28, 67108864
v_lshrrev_b32 v12, 1, v17
v_add_u32 v12, s28, v12
v_xor_b32 v25, 0x10000, v12
v_xor_b32 v26, 0x20000, v12
v_xor_b32 v27, 0x30000, v12
v_add_u32 v25, 0, v25
v_add_u32 v26, 0, v26
v_add_u32 v27, 0, v27
s_lshl_b32 s28, s25, 2
s_add_u32 s28, s28, s26
s_mov_b32 s82, s28
s_lshr_b32 s29, s28, 3
s_xor_b32 s29, s29, s98
s_and_b32 s29, s29, 1
s_lshl_b32 s29, s29, 13
s_lshl_b32 s76, s28, 18
s_add_u32 s76, s76, s29
s_mov_b32 s83, s76
v_add_u32 v240, s76, v17
v_add_u32 v241, 33554432, v240
s_lshr_b32 s29, s28, 4
s_xor_b32 s29, s29, s98
s_and_b32 s29, s29, 1
s_lshl_b32 s29, s29, 13
s_lshl_b32 s79, s28, 17
s_add_u32 s79, s79, s29
s_add_u32 s79, s79, 71303168
s_xor_b32 s29, s98, 1
s_lshl_b32 s29, s29, 13
s_lshl_b32 s28, s25, 7
s_add_u32 s28, s28, s29
s_add_u32 s28, s28, 69206016
v_and_b32 v4, 1, v1
v_lshlrev_b32 v24, 12, v4
v_add_u32 v24, s28, v24
s_lshl_b32 s29, s26, 2
v_add_u32 v24, s29, v24
s_xor_b32 s81, s98, 1
s_lshl_b32 s81, s81, 13
s_lshr_b32 s29, s82, 6
s_lshl_b32 s29, s29, 14
s_add_u32 s81, s81, s29
s_and_b32 s29, s82, 63
s_lshl_b32 s29, s29, 7
s_add_u32 s81, s81, s29
s_add_u32 s81, s81, 69222400
v_mov_b32 v220, 0x3f803f80
v_mov_b32 v221, 0x3f803f80
v_mov_b32 v222, 0x3f803f80
v_mov_b32 v223, 0x3f803f80
v_mov_b32 v228, 0
s_mov_b32 s27, 0
s_mov_b32 s46, 0
s_mov_b32 s89, 0
s_mov_b32 s88, 0
s_mov_b32 s44, 18432
s_mov_b32 s45, 18432
s_cmp_eq_u32 s24, 3
s_cbranch_scc0 mega_kernel_rs_pfi
s_mov_b32 s76, 0
s_cmp_gt_i32 s46, s76
s_cbranch_scc1 mega_kernel_rs_pf0ok
mega_kernel_rs_pf0w:
v_mov_b32 v4, 0
s_mov_b64 exec, 3
buffer_atomic_add v4, v24, s[84:87], 0 offen sc0 sc1
s_mov_b64 exec, -1
s_waitcnt vmcnt(0)
v_readlane_b32 s46, v4, 0
v_readlane_b32 s28, v4, 1
s_nop 1
s_min_i32 s46, s46, s28
s_cmp_gt_i32 s46, s76
s_cbranch_scc0 mega_kernel_rs_pf0w
mega_kernel_rs_pf0ok:
s_add_u32 s77, s76, s82
s_bfe_u32 s28, s77, 0x40002
s_lshl_b32 s28, s28, 14
s_and_b32 s77, s77, 3
s_lshl_b32 s77, s77, 11
s_add_u32 s28, s28, s77
s_add_u32 m0, s45, 0
s_nop 0
buffer_load_dwordx4 v240, s[84:87], s28 offen offset:0 sc1 lds
s_add_u32 m0, s45, 0
s_nop 0
buffer_load_dwordx4 v240, s[84:87], s28 offen offset:1024 sc1 lds
s_add_u32 m0, s45, 2048
s_nop 0
buffer_load_dwordx4 v241, s[84:87], s28 offen offset:0 sc1 lds
s_add_u32 m0, s45, 2048
s_nop 0
buffer_load_dwordx4 v241, s[84:87], s28 offen offset:1024 sc1 lds
s_add_u32 s45, s45, 4096
s_cmp_eq_u32 s45, 30720
s_cselect_b32 s45, 18432, s45
s_waitcnt vmcnt(0) lgkmcnt(0)
mega_kernel_rs_pfi:
v_mov_b32 v184, 0
v_mov_b32 v185, 0
v_mov_b32 v186, 0
v_mov_b32 v187, 0
v_mov_b32 v188, 0
v_mov_b32 v189, 0
v_mov_b32 v190, 0
v_mov_b32 v191, 0
v_mov_b32 v192, 0
v_mov_b32 v193, 0
v_mov_b32 v194, 0
v_mov_b32 v195, 0
v_mov_b32 v196, 0
v_mov_b32 v197, 0
v_mov_b32 v198, 0
v_mov_b32 v199, 0
v_mov_b32 v200, 0
v_mov_b32 v201, 0
v_mov_b32 v202, 0
v_mov_b32 v203, 0
v_mov_b32 v204, 0
v_mov_b32 v205, 0
v_mov_b32 v206, 0
v_mov_b32 v207, 0
v_mov_b32 v249, 0
v_mov_b32 v96, 0
v_mov_b32 v97, 0
v_mov_b32 v98, 0
v_mov_b32 v99, 0
v_mov_b32 v100, 0
v_mov_b32 v101, 0
v_mov_b32 v102, 0
v_mov_b32 v103, 0
v_mov_b32 v104, 0
v_mov_b32 v105, 0
v_mov_b32 v106, 0
v_mov_b32 v107, 0
v_mov_b32 v108, 0
v_mov_b32 v109, 0
v_mov_b32 v110, 0
v_mov_b32 v111, 0
v_mov_b32 v112, 0
v_mov_b32 v113, 0
v_mov_b32 v114, 0
v_mov_b32 v115, 0
v_mov_b32 v116, 0
v_mov_b32 v117, 0
v_mov_b32 v118, 0
v_mov_b32 v119, 0
s_barrier
s_and_b32 s29, s27, 1
s_lshl_b32 s33, s29, 17
s_lshl_b32 s28, s30, 18
s_add_u32 s33, s33, s28
s_add_u32 s33, s33, 68157440
s_xor_b32 s34, s33, 131072
s_lshl_b32 s35, s29, 18
s_bfe_u32 s47, s27, 0x10001
s_branch mega_kernel_rs_first
.p2align 6
s_nop 0
s_nop 0
mega_kernel_rs_loop:
buffer_load_dwordx4 v[32:35], v7, s[84:87], s33 offen offset:0 sc1
v_add_u32 v5, s44, v17
ds_read_b128 v[156:159], v5 offset:0
ds_read_b128 v[160:163], v5 offset:1024
ds_read_b128 v[164:167], v5 offset:2048
ds_read_b128 v[168:171], v5 offset:3072
s_nop 4
buffer_load_dwordx4 v[36:39], v7, s[84:87], s33 offen offset:1024 sc1
s_nop 9
buffer_load_dwordx4 v[40:43], v7, s[84:87], s33 offen offset:2048 sc1
s_nop 9
buffer_load_dwordx4 v[44:47], v7, s[84:87], s33 offen offset:3072 sc1
s_waitcnt vmcnt(3)
v_max_u32 v4, v32, v34
v_cmp_eq_u32 vcc, -1, v4
s_cbranch_vccnz mega_kernel_rs_pa_15_0f
v_smfmac_f32_16x16x64_bf16 v[96:99], v[32:35], a[0:7], v6
v_smfmac_f32_16x16x64_bf16 v[100:103], v[32:35], a[32:39], v6
v_smfmac_f32_16x16x64_bf16 v[104:107], v[32:35], a[64:71], v6
s_waitcnt vmcnt(2)
v_max_u32 v4, v36, v38
v_cmp_eq_u32 vcc, -1, v4
v_smfmac_f32_16x16x64_bf16 v[108:111], v[32:35], a[96:103], v6
s_cbranch_vccnz mega_kernel_rs_pa_14_1f
v_smfmac_f32_16x16x64_bf16 v[96:99], v[36:39], a[8:15], v6
v_smfmac_f32_16x16x64_bf16 v[100:103], v[36:39], a[40:47], v6
v_smfmac_f32_16x16x64_bf16 v[104:107], v[36:39], a[72:79], v6
s_waitcnt vmcnt(1)
v_max_u32 v4, v40, v42
v_cmp_eq_u32 vcc, -1, v4
v_smfmac_f32_16x16x64_bf16 v[108:111], v[36:39], a[104:111], v6
s_cbranch_vccnz mega_kernel_rs_pa_12_2f
v_smfmac_f32_16x16x64_bf16 v[96:99], v[40:43], a[16:23], v6
v_smfmac_f32_16x16x64_bf16 v[100:103], v[40:43], a[48:55], v6
v_smfmac_f32_16x16x64_bf16 v[104:107], v[40:43], a[80:87], v6
s_waitcnt vmcnt(0)
v_max_u32 v4, v44, v46
v_cmp_eq_u32 vcc, -1, v4
v_smfmac_f32_16x16x64_bf16 v[108:111], v[40:43], a[112:119], v6
s_cbranch_vccnz mega_kernel_rs_pa_8_3f
v_smfmac_f32_16x16x64_bf16 v[96:99], v[44:47], a[24:31], v6
v_smfmac_f32_16x16x64_bf16 v[100:103], v[44:47], a[56:63], v6
v_smfmac_f32_16x16x64_bf16 v[104:107], v[44:47], a[88:95], v6
v_smfmac_f32_16x16x64_bf16 v[108:111], v[44:47], a[120:127], v6
mega_kernel_rs_pa_d:
mega_kernel_rs_adone:
s_nop 5
v_permlane32_swap_b32 v96, v100
v_permlane32_swap_b32 v97, v101
v_permlane32_swap_b32 v98, v102
v_permlane32_swap_b32 v99, v103
v_pk_add_f32 v[96:97], v[96:97], v[100:101]
v_pk_add_f32 v[98:99], v[98:99], v[102:103]
ds_write2_b32 v14, v96, v97 offset0:0 offset1:36
ds_write2_b32 v14, v98, v99 offset0:72 offset1:108
v_permlane32_swap_b32 v104, v108
v_permlane32_swap_b32 v105, v109
v_permlane32_swap_b32 v106, v110
v_permlane32_swap_b32 v107, v111
v_pk_add_f32 v[104:105], v[104:105], v[108:109]
v_pk_add_f32 v[106:107], v[106:107], v[110:111]
ds_write2_b32 v15, v104, v105 offset0:0 offset1:36
ds_write2_b32 v15, v106, v107 offset0:72 offset1:108
v_smfmac_f32_16x16x64_bf16 v[112:115], v[32:35], a[128:135], v6
v_smfmac_f32_16x16x64_bf16 v[116:119], v[32:35], a[160:167], v6
v_smfmac_f32_16x16x64_bf16 v[112:115], v[36:39], a[136:143], v6
v_smfmac_f32_16x16x64_bf16 v[116:119], v[36:39], a[168:175], v6
s_waitcnt lgkmcnt(0)
s_barrier
s_cmp_lg_u32 s24, 0
s_cbranch_scc1 mega_kernel_rs_side
ds_read_b128 v[120:123], v16 offset:0
ds_read_b128 v[124:127], v16 offset:16
ds_read_b128 v[128:131], v16 offset:2304
ds_read_b128 v[132:135], v16 offset:2320
ds_read_b128 v[136:139], v16 offset:4608
ds_read_b128 v[140:143], v16 offset:4624
ds_read_b128 v[144:147], v16 offset:6912
ds_read_b128 v[148:151], v16 offset:6928
v_smfmac_f32_16x16x64_bf16 v[112:115], v[40:43], a[144:151], v6
v_smfmac_f32_16x16x64_bf16 v[116:119], v[40:43], a[176:183], v6
v_smfmac_f32_16x16x64_bf16 v[112:115], v[44:47], a[152:159], v6
v_smfmac_f32_16x16x64_bf16 v[116:119], v[44:47], a[184:191], v6
s_mul_i32 s28, s31, 2048
s_add_u32 s28, s28, s33
s_add_u32 s28, s28, 49152
s_add_u32 s76, s37, s33
s_add_u32 s77, s38, s33
s_add_u32 s78, s39, s33
s_waitcnt lgkmcnt(4)
v_pk_add_f32 v[120:121], v[120:121], v[128:129]
v_pk_add_f32 v[122:123], v[122:123], v[130:131]
v_pk_add_f32 v[124:125], v[124:125], v[132:133]
v_pk_add_f32 v[126:127], v[126:127], v[134:135]
s_waitcnt lgkmcnt(0)
v_pk_add_f32 v[136:137], v[136:137], v[144:145]
v_pk_add_f32 v[138:139], v[138:139], v[146:147]
v_pk_add_f32 v[140:141], v[140:141], v[148:149]
v_pk_add_f32 v[142:143], v[142:143], v[150:151]
v_pk_add_f32 v[120:121], v[120:121], v[136:137]
v_pk_add_f32 v[122:123], v[122:123], v[138:139]
v_pk_add_f32 v[124:125], v[124:125], v[140:141]
v_pk_add_f32 v[126:127], v[126:127], v[142:143]
v_cvt_pk_bf16_f32 v152, v120, v121
v_cvt_pk_bf16_f32 v153, v122, v123
v_cvt_pk_bf16_f32 v154, v124, v125
v_cvt_pk_bf16_f32 v155, v126, v127
s_nop 1
v_mfma_f32_16x16x32_bf16 v[176:179], v[160:163], v[152:155], 0
v_mfma_f32_16x16x32_bf16 v[172:175], v[156:159], v[152:155], 0
v_mfma_f32_16x16x32_bf16 v[180:183], v[152:155], v[152:155], 0
s_cmp_eq_u32 s27, 63
s_cbranch_scc1 mega_kernel_rs_w0last
s_nop 4
v_mov_b32_dpp v172, v176 row_shr:8 row_mask:0xf bank_mask:0xc
v_mov_b32_dpp v173, v177 row_shr:8 row_mask:0xf bank_mask:0xc
v_mov_b32_dpp v174, v178 row_shr:8 row_mask:0xf bank_mask:0xc
v_mov_b32_dpp v175, v179 row_shr:8 row_mask:0xf bank_mask:0xc
v_min_u32 v180, -2, v180
v_min_u32 v172, -2, v172
s_mov_b64 exec, s[42:43]
buffer_store_dwordx4 v[180:183], v10, s[84:87], s28 offen sc1
s_mov_b64 exec, -1
buffer_store_dwordx4 v[172:175], v17, s[84:87], s28 offen sc1
v_permlane32_swap_b32 v112, v116
v_permlane32_swap_b32 v113, v117
v_permlane32_swap_b32 v114, v118
v_permlane32_swap_b32 v115, v119
v_pk_add_f32 v[112:113], v[112:113], v[116:117]
v_pk_add_f32 v[114:115], v[114:115], v[118:119]
ds_write_b128 v20, v[112:115]
s_waitcnt lgkmcnt(0)
s_barrier
v_mov_b32 v96, 0
v_mov_b32 v97, 0
v_mov_b32 v98, 0
v_mov_b32 v99, 0
v_mov_b32 v100, 0
v_mov_b32 v101, 0
v_mov_b32 v102, 0
v_mov_b32 v103, 0
v_cndmask_b32 v176, v23, v180, s[42:43]
v_cndmask_b32 v177, v23, v181, s[42:43]
v_cndmask_b32 v178, v23, v182, s[42:43]
v_cndmask_b32 v179, v23, v183, s[42:43]
s_mov_b64 exec, s[42:43]
buffer_load_dwordx4 v[188:191], v10, s[84:87], s76 offen sc1
buffer_load_dwordx4 v[196:199], v10, s[84:87], s77 offen sc1
buffer_load_dwordx4 v[204:207], v10, s[84:87], s78 offen sc1
s_mov_b64 exec, -1
buffer_load_dwordx4 v[184:187], v17, s[84:87], s76 offen sc1
buffer_load_dwordx4 v[192:195], v17, s[84:87], s77 offen sc1
buffer_load_dwordx4 v[200:203], v17, s[84:87], s78 offen sc1
v_pk_mul_f32 v[172:173], v[172:173], s[32:33] op_sel_hi:[1,0]
v_pk_mul_f32 v[174:175], v[174:175], s[32:33] op_sel_hi:[1,0]
v_pk_mul_f32 v[176:177], v[176:177], s[32:33] op_sel_hi:[1,0]
v_pk_mul_f32 v[178:179], v[178:179], s[32:33] op_sel_hi:[1,0]
s_lshl_b32 s89, s47, 31
s_or_b32 s89, s89, 0x3b39999a
s_nop 15
s_nop 1
s_mov_b64 exec, s[42:43]
buffer_load_dwordx4 v[188:191], v10, s[84:87], s76 offen sc1
buffer_load_dwordx4 v[196:199], v10, s[84:87], s77 offen sc1
buffer_load_dwordx4 v[204:207], v10, s[84:87], s78 offen sc1
s_mov_b64 exec, -1
buffer_load_dwordx4 v[184:187], v17, s[84:87], s76 offen sc1
buffer_load_dwordx4 v[192:195], v17, s[84:87], s77 offen sc1
buffer_load_dwordx4 v[200:203], v17, s[84:87], s78 offen sc1
mega_kernel_rs_p2:
s_waitcnt vmcnt(6)
v_max3_u32 v4, v184, v188, v192
v_max3_u32 v5, v196, v200, v204
v_max_u32 v4, v4, v5
v_cmp_eq_u32 vcc, -1, v4
s_cbranch_vccnz mega_kernel_rs_p2r
v_pk_add_f32 v[124:125], v[196:197], v[204:205]
v_pk_add_f32 v[126:127], v[198:199], v[206:207]
v_pk_add_f32 v[120:121], v[192:193], v[200:201]
v_pk_add_f32 v[122:123], v[194:195], v[202:203]
v_pk_add_f32 v[124:125], v[124:125], v[188:189]
v_pk_add_f32 v[126:127], v[126:127], v[190:191]
v_pk_add_f32 v[120:121], v[120:121], v[184:185]
v_pk_add_f32 v[122:123], v[122:123], v[186:187]
v_pk_fma_f32 v[176:177], v[124:125], s[32:33], v[176:177] op_sel_hi:[1,0,1]
v_pk_fma_f32 v[178:179], v[126:127], s[32:33], v[178:179] op_sel_hi:[1,0,1]
v_pk_fma_f32 v[172:173], v[120:121], s[32:33], v[172:173] op_sel_hi:[1,0,1]
v_pk_fma_f32 v[174:175], v[122:123], s[32:33], v[174:175] op_sel_hi:[1,0,1]
v_max3_f32 v232, v172, v173, v174
v_max3_f32 v233, v176, v177, v178
v_max3_f32 v232, v232, v175, v179
v_max_f32 v234, v232, v233
s_barrier
ds_read2_b64 v[208:211], v21 offset0:0 offset1:32
v_max_f32_dpp v232, v234, v234 row_ror:8 row_mask:0xf bank_mask:0xf
v_max_f32_dpp v233, v234, v234 row_ror:8 row_mask:0xf bank_mask:0xf
s_nop 1
v_permlane16_swap_b32 v232, v233
s_nop 0
v_max_f32 v234, v232, v233
v_max_f32 v235, v232, v233
s_nop 1
v_permlane32_swap_b32 v234, v235
s_nop 0
v_max_f32 v232, v234, v235
v_pk_add_f32 v[176:177], v[176:177], v[232:233] op_sel_hi:[1,0] neg_lo:[0,1] neg_hi:[0,1]
v_pk_add_f32 v[178:179], v[178:179], v[232:233] op_sel_hi:[1,0] neg_lo:[0,1] neg_hi:[0,1]
v_pk_add_f32 v[172:173], v[172:173], v[232:233] op_sel_hi:[1,0] neg_lo:[0,1] neg_hi:[0,1]
v_pk_add_f32 v[174:175], v[174:175], v[232:233] op_sel_hi:[1,0] neg_lo:[0,1] neg_hi:[0,1]
v_exp_f32 v176, v176
v_exp_f32 v177, v177
v_exp_f32 v178, v178
v_exp_f32 v179, v179
v_exp_f32 v172, v172
v_cvt_pk_bf16_f32 v216, v176, v177
v_cvt_pk_bf16_f32 v217, v178, v179
v_exp_f32 v173, v173
v_exp_f32 v174, v174
v_mfma_f32_16x16x16_bf16 v[224:227], v[220:221], v[216:217], 0
v_exp_f32 v175, v175
v_cvt_pk_bf16_f32 v212, v172, v173
s_waitcnt lgkmcnt(0)
v_mfma_f32_16x16x16_bf16 v[120:123], v[208:209], v[216:217], 0
v_cvt_pk_bf16_f32 v213, v174, v175
v_mfma_f32_16x16x16_bf16 v[124:127], v[210:211], v[216:217], 0
v_mov_b32_dpp v214, v212 row_ror:8 row_mask:0xf bank_mask:0xf
v_mov_b32_dpp v215, v213 row_ror:8 row_mask:0xf bank_mask:0xf
s_nop 1
v_mfma_f32_16x16x32_bf16 v[224:227], v[220:223], v[212:215], v[224:227]
v_mfma_f32_16x16x32_bf16 v[120:123], v[164:167], v[212:215], v[120:123]
v_mfma_f32_16x16x32_bf16 v[124:127], v[168:171], v[212:215], v[124:127]
s_add_u32 s29, s33, 24576
s_nop 4
v_rcp_f32 v234, v224
s_nop 0
v_pk_mul_f32 v[120:121], v[120:121], v[234:235] op_sel_hi:[1,0]
v_pk_mul_f32 v[122:123], v[122:123], v[234:235] op_sel_hi:[1,0]
v_pk_mul_f32 v[124:125], v[124:125], v[234:235] op_sel_hi:[1,0]
v_pk_mul_f32 v[126:127], v[126:127], v[234:235] op_sel_hi:[1,0]
v_cvt_pk_bf16_f32 v212, v120, v121
v_cvt_pk_bf16_f32 v213, v122, v123
v_cvt_pk_bf16_f32 v214, v124, v125
v_cvt_pk_bf16_f32 v215, v126, v127
v_min_u32 v212, -2, v212
s_mov_b64 exec, s[40:41]
buffer_store_dwordx4 v[212:215], v11, s[84:87], s33 offen sc1
s_mov_b64 exec, -1
mega_kernel_rs_b3:
s_barrier
s_nop 15
buffer_load_dwordx4 v[32:35], v7, s[84:87], s29 offen offset:0 sc1
s_nop 9
buffer_load_dwordx4 v[36:39], v7, s[84:87], s29 offen offset:1024 sc1
s_nop 9
buffer_load_dwordx4 v[40:43], v7, s[84:87], s29 offen offset:2048 sc1
s_nop 9
buffer_load_dwordx4 v[44:47], v7, s[84:87], s29 offen offset:3072 sc1
mega_kernel_rs_pc_15_0:
s_waitcnt vmcnt(3)
v_cmp_eq_u32 vcc, -1, v32
s_cbranch_vccnz mega_kernel_rs_pc_15_0f
v_smfmac_f32_16x16x64_bf16 v[96:99], v[32:35], a[192:199], v6
v_smfmac_f32_16x16x64_bf16 v[100:103], v[32:35], a[224:231], v6
mega_kernel_rs_pc_14_1:
s_waitcnt vmcnt(2)
v_cmp_eq_u32 vcc, -1, v36
s_cbranch_vccnz mega_kernel_rs_pc_14_1f
v_smfmac_f32_16x16x64_bf16 v[96:99], v[36:39], a[200:207], v6
v_smfmac_f32_16x16x64_bf16 v[100:103], v[36:39], a[232:239], v6
mega_kernel_rs_pc_12_2:
s_waitcnt vmcnt(1)
v_cmp_eq_u32 vcc, -1, v40
s_cbranch_vccnz mega_kernel_rs_pc_12_2f
v_smfmac_f32_16x16x64_bf16 v[96:99], v[40:43], a[208:215], v6
v_smfmac_f32_16x16x64_bf16 v[100:103], v[40:43], a[240:247], v6
mega_kernel_rs_pc_8_3:
s_waitcnt vmcnt(0)
v_cmp_eq_u32 vcc, -1, v44
s_cbranch_vccnz mega_kernel_rs_pc_8_3f
v_smfmac_f32_16x16x64_bf16 v[96:99], v[44:47], a[216:223], v6
v_smfmac_f32_16x16x64_bf16 v[100:103], v[44:47], a[248:255], v6
mega_kernel_rs_pc_d:
s_nop 7
v_permlane32_swap_b32 v96, v100
v_permlane32_swap_b32 v97, v101
v_permlane32_swap_b32 v98, v102
v_permlane32_swap_b32 v99, v103
v_pk_add_f32 v[96:97], v[96:97], v[100:101]
v_pk_add_f32 v[98:99], v[98:99], v[102:103]
ds_write2_b32 v18, v96, v97 offset0:0 offset1:36
ds_write2_b32 v18, v98, v99 offset0:72 offset1:108
s_waitcnt lgkmcnt(0)
s_barrier
s_cmp_lg_u32 s24, 0
s_cbranch_scc1 mega_kernel_rs_x1
ds_read_b128 v[120:123], v19 offset:0
ds_read_b128 v[124:127], v19 offset:1152
ds_read_b128 v[128:131], v19 offset:2304
ds_read_b128 v[132:135], v19 offset:3456
s_waitcnt lgkmcnt(2)
v_pk_add_f32 v[120:121], v[120:121], v[124:125]
v_pk_add_f32 v[122:123], v[122:123], v[126:127]
s_waitcnt lgkmcnt(0)
v_pk_add_f32 v[128:129], v[128:129], v[132:133]
v_pk_add_f32 v[130:131], v[130:131], v[134:135]
v_pk_add_f32 v[120:121], v[120:121], v[128:129]
v_pk_add_f32 v[122:123], v[122:123], v[130:131]
v_fma_f32 v212, v120, s89, v120
v_cvt_pk_bf16_f32 v213, v122, v123
v_cvt_pk_bf16_f32 v212, v212, v121
v_and_or_b32 v212, v212, -2, s47
buffer_store_dwordx2 v[212:213], v12, s[84:87], s35 offen sc1
s_mov_b32 s77, 0x3f80
s_mov_b32 s78, 0x3f800000
s_xor_b32 s76, s47, 1
v_mov_b32 v48, s76
v_mov_b32 v50, s76
v_mov_b32 v52, s76
s_nop 8
v_mov_b32 v96, 0
v_mov_b32 v97, 0
v_mov_b32 v98, 0
v_mov_b32 v99, 0
v_mov_b32 v100, 0
v_mov_b32 v101, 0
v_mov_b32 v102, 0
v_mov_b32 v103, 0
v_mov_b32 v104, 0
v_mov_b32 v105, 0
v_mov_b32 v106, 0
v_mov_b32 v107, 0
v_mov_b32 v108, 0
v_mov_b32 v109, 0
v_mov_b32 v110, 0
v_mov_b32 v111, 0
v_mov_b32 v112, 0
v_mov_b32 v113, 0
v_mov_b32 v114, 0
v_mov_b32 v115, 0
v_mov_b32 v116, 0
v_mov_b32 v117, 0
v_mov_b32 v118, 0
v_mov_b32 v119, 0
s_nop 15
s_nop 7
s_cmp_eq_u32 s47, 1
s_cbranch_scc1 mega_kernel_rs_p4_1
.p2align 6
mega_kernel_rs_p4_0:
buffer_load_dwordx2 v[48:49], v25, s[84:87], s35 offen sc1
buffer_load_dwordx2 v[50:51], v26, s[84:87], s35 offen sc1
buffer_load_dwordx2 v[52:53], v27, s[84:87], s35 offen sc1
s_waitcnt vmcnt(12)
mega_kernel_rs_p4c_0:
v_bitop3_b32 v4, v48, v50, v52 bitop3:0xfe
v_and_b32 v4, 1, v4
v_cmp_ne_u32 vcc, 0, v4
s_cbranch_vccnz mega_kernel_rs_p4_0
v_dot2_f32_bf16 v120, v48, s77, v120
v_dot2_f32_bf16 v121, v48, s78, v121
v_dot2_f32_bf16 v122, v49, s77, v122
v_dot2_f32_bf16 v123, v49, s78, v123
v_dot2_f32_bf16 v120, v50, s77, v120
v_dot2_f32_bf16 v121, v50, s78, v121
v_dot2_f32_bf16 v122, v51, s77, v122
v_dot2_f32_bf16 v123, v51, s78, v123
v_dot2_f32_bf16 v120, v52, s77, v120
v_dot2_f32_bf16 v121, v52, s78, v121
v_dot2_f32_bf16 v122, v53, s77, v122
v_dot2_f32_bf16 v123, v53, s78, v123
s_nop 0
v_cvt_pk_bf16_f32 v212, v120, v121
v_min_u32 v212, -2, v212
v_cvt_pk_bf16_f32 v213, v122, v123
buffer_store_dwordx2 v[212:213], v9, s[84:87], s34 offen sc1
s_branch mega_kernel_rs_p4d
.p2align 6
mega_kernel_rs_p4_1:
buffer_load_dwordx2 v[48:49], v25, s[84:87], s35 offen sc1
buffer_load_dwordx2 v[50:51], v26, s[84:87], s35 offen sc1
buffer_load_dwordx2 v[52:53], v27, s[84:87], s35 offen sc1
s_waitcnt vmcnt(12)
mega_kernel_rs_p4c_1:
v_bitop3_b32 v4, v48, v50, v52 bitop3:0x80
v_and_b32 v4, 1, v4
v_cmp_ne_u32 vcc, 1, v4
s_cbranch_vccnz mega_kernel_rs_p4_1
v_dot2_f32_bf16 v120, v48, s77, v120
v_dot2_f32_bf16 v121, v48, s78, v121
v_dot2_f32_bf16 v122, v49, s77, v122
v_dot2_f32_bf16 v123, v49, s78, v123
v_dot2_f32_bf16 v120, v50, s77, v120
v_dot2_f32_bf16 v121, v50, s78, v121
v_dot2_f32_bf16 v122, v51, s77, v122
v_dot2_f32_bf16 v123, v51, s78, v123
v_dot2_f32_bf16 v120, v52, s77, v120
v_dot2_f32_bf16 v121, v52, s78, v121
v_dot2_f32_bf16 v122, v53, s77, v122
v_dot2_f32_bf16 v123, v53, s78, v123
s_nop 0
v_cvt_pk_bf16_f32 v212, v120, v121
v_min_u32 v212, -2, v212
v_cvt_pk_bf16_f32 v213, v122, v123
buffer_store_dwordx2 v[212:213], v9, s[84:87], s34 offen sc1
mega_kernel_rs_p4d:
mega_kernel_rs_b5:
s_add_u32 s27, s27, 1
s_add_u32 s44, s44, 4096
s_cmp_eq_u32 s44, 30720
s_cselect_b32 s44, 18432, s44
s_mov_b32 s28, s33
s_mov_b32 s33, s34
s_mov_b32 s34, s28
s_xor_b32 s35, s35, 262144
s_bfe_u32 s47, s27, 0x10001
s_barrier
s_nop 15
s_branch mega_kernel_rs_loop
mega_kernel_rs_x1:
s_cmp_eq_u32 s24, 1
s_cbranch_scc0 mega_kernel_rs_x2
s_add_u32 s76, s27, 1
v_mov_b32 v5, s76
s_mov_b64 exec, 1
buffer_store_dword v5, v228, s[84:87], s81 offen sc1
s_mov_b64 exec, -1
mega_kernel_rs_x2:
s_cmp_eq_u32 s24, 3
s_cbranch_scc0 mega_kernel_rs_x4
s_cmp_eq_u32 s36, 1
s_cbranch_scc0 mega_kernel_rs_x5
s_add_u32 s76, s27, 1
s_cmp_gt_i32 s46, s76
s_cbranch_scc1 mega_kernel_rs_pf1ok
mega_kernel_rs_pf1w:
v_mov_b32 v4, 0
s_mov_b64 exec, 3
buffer_atomic_add v4, v24, s[84:87], 0 offen sc0 sc1
s_mov_b64 exec, -1
s_waitcnt vmcnt(0)
v_readlane_b32 s46, v4, 0
v_readlane_b32 s28, v4, 1
s_nop 1
s_min_i32 s46, s46, s28
s_cmp_gt_i32 s46, s76
s_cbranch_scc0 mega_kernel_rs_pf1w
mega_kernel_rs_pf1ok:
s_add_u32 s77, s76, s82
s_bfe_u32 s28, s77, 0x40002
s_lshl_b32 s28, s28, 14
s_and_b32 s77, s77, 3
s_lshl_b32 s77, s77, 11
s_add_u32 s28, s28, s77
s_add_u32 m0, s45, 0
s_nop 0
buffer_load_dwordx4 v240, s[84:87], s28 offen offset:0 sc1 lds
s_add_u32 m0, s45, 0
s_nop 0
buffer_load_dwordx4 v240, s[84:87], s28 offen offset:1024 sc1 lds
s_add_u32 m0, s45, 2048
s_nop 0
buffer_load_dwordx4 v241, s[84:87], s28 offen offset:0 sc1 lds
s_add_u32 m0, s45, 2048
s_nop 0
buffer_load_dwordx4 v241, s[84:87], s28 offen offset:1024 sc1 lds
s_add_u32 s45, s45, 4096
s_cmp_eq_u32 s45, 30720
s_cselect_b32 s45, 18432, s45
s_waitcnt vmcnt(0)
mega_kernel_rs_x5:
s_add_u32 s76, s27, 4
s_min_u32 s76, s76, 63
s_cmp_gt_i32 s46, s76
s_cbranch_scc1 mega_kernel_rs_x6
v_mov_b32 v249, 0
s_mov_b64 exec, 3
buffer_atomic_add v249, v24, s[84:87], 0 offen sc0 sc1
s_mov_b64 exec, -1
mega_kernel_rs_x6:
s_add_u32 s76, s27, 2
s_cmp_lt_u32 s76, 63
s_cbranch_scc0 mega_kernel_rs_x4
s_cmp_gt_i32 s46, s76
s_cbranch_scc0 mega_kernel_rs_x4
s_add_u32 s77, s76, s82
s_bfe_u32 s28, s77, 0x40002
s_lshl_b32 s28, s28, 14
s_and_b32 s77, s77, 3
s_lshl_b32 s77, s77, 11
s_add_u32 s28, s28, s77
s_add_u32 s28, s28, s83
s_add_u32 s28, s28, 33554432
s_buffer_load_dword s78, s[84:87], s28 offset:0
s_buffer_load_dword s78, s[84:87], s28 offset:128
s_buffer_load_dword s78, s[84:87], s28 offset:256
s_buffer_load_dword s78, s[84:87], s28 offset:384
s_buffer_load_dword s78, s[84:87], s28 offset:512
s_buffer_load_dword s78, s[84:87], s28 offset:640
s_buffer_load_dword s78, s[84:87], s28 offset:768
s_buffer_load_dword s78, s[84:87], s28 offset:896
s_buffer_load_dword s78, s[84:87], s28 offset:1024
s_buffer_load_dword s78, s[84:87], s28 offset:1152
s_buffer_load_dword s78, s[84:87], s28 offset:1280
s_buffer_load_dword s78, s[84:87], s28 offset:1408
s_buffer_load_dword s78, s[84:87], s28 offset:1536
s_buffer_load_dword s78, s[84:87], s28 offset:1664
s_buffer_load_dword s78, s[84:87], s28 offset:1792
s_buffer_load_dword s78, s[84:87], s28 offset:1920
s_mov_b32 s89, s76
mega_kernel_rs_x4:
v_mov_b32 v96, 0
v_mov_b32 v97, 0
v_mov_b32 v98, 0
v_mov_b32 v99, 0
v_mov_b32 v100, 0
v_mov_b32 v101, 0
v_mov_b32 v102, 0
v_mov_b32 v103, 0
v_mov_b32 v104, 0
v_mov_b32 v105, 0
v_mov_b32 v106, 0
v_mov_b32 v107, 0
v_mov_b32 v108, 0
v_mov_b32 v109, 0
v_mov_b32 v110, 0
v_mov_b32 v111, 0
v_mov_b32 v112, 0
v_mov_b32 v113, 0
v_mov_b32 v114, 0
v_mov_b32 v115, 0
v_mov_b32 v116, 0
v_mov_b32 v117, 0
v_mov_b32 v118, 0
v_mov_b32 v119, 0
s_branch mega_kernel_rs_b5
mega_kernel_rs_p2r:
s_mov_b64 exec, s[42:43]
buffer_load_dwordx4 v[188:191], v10, s[84:87], s76 offen sc1
buffer_load_dwordx4 v[196:199], v10, s[84:87], s77 offen sc1
buffer_load_dwordx4 v[204:207], v10, s[84:87], s78 offen sc1
s_mov_b64 exec, -1
buffer_load_dwordx4 v[184:187], v17, s[84:87], s76 offen sc1
buffer_load_dwordx4 v[192:195], v17, s[84:87], s77 offen sc1
buffer_load_dwordx4 v[200:203], v17, s[84:87], s78 offen sc1
s_branch mega_kernel_rs_p2
.p2align 5
mega_kernel_rs_pa_1_0f:
s_mov_b64 exec, vcc
buffer_load_dwordx4 v[32:35], v7, s[84:87], s33 offen offset:0 sc1
s_mov_b64 exec, -1
s_branch mega_kernel_rs_pa_1_0
.p2align 5
mega_kernel_rs_pa_1_0:
s_waitcnt vmcnt(0)
v_max_u32 v4, v32, v34
v_cmp_eq_u32 vcc, -1, v4
s_cbranch_vccnz mega_kernel_rs_pa_1_0f
v_smfmac_f32_16x16x64_bf16 v[96:99], v[32:35], a[0:7], v6
v_smfmac_f32_16x16x64_bf16 v[100:103], v[32:35], a[32:39], v6
v_smfmac_f32_16x16x64_bf16 v[104:107], v[32:35], a[64:71], v6
v_smfmac_f32_16x16x64_bf16 v[108:111], v[32:35], a[96:103], v6
s_branch mega_kernel_rs_pa_d
.p2align 5
mega_kernel_rs_pa_2_1f:
s_mov_b64 exec, vcc
buffer_load_dwordx4 v[36:39], v7, s[84:87], s33 offen offset:1024 sc1
s_mov_b64 exec, -1
s_branch mega_kernel_rs_pa_2_1
.p2align 5
mega_kernel_rs_pa_2_1:
s_waitcnt vmcnt(0)
v_max_u32 v4, v36, v38
v_cmp_eq_u32 vcc, -1, v4
s_cbranch_vccnz mega_kernel_rs_pa_2_1f
v_smfmac_f32_16x16x64_bf16 v[96:99], v[36:39], a[8:15], v6
v_smfmac_f32_16x16x64_bf16 v[100:103], v[36:39], a[40:47], v6
v_smfmac_f32_16x16x64_bf16 v[104:107], v[36:39], a[72:79], v6
v_smfmac_f32_16x16x64_bf16 v[108:111], v[36:39], a[104:111], v6
s_branch mega_kernel_rs_pa_d
.p2align 5
mega_kernel_rs_pa_3_0f:
s_mov_b64 exec, vcc
buffer_load_dwordx4 v[32:35], v7, s[84:87], s33 offen offset:0 sc1
s_mov_b64 exec, -1
s_branch mega_kernel_rs_pa_3_1
.p2align 5
mega_kernel_rs_pa_3_0:
s_waitcnt vmcnt(1)
v_max_u32 v4, v32, v34
v_cmp_eq_u32 vcc, -1, v4
s_cbranch_vccnz mega_kernel_rs_pa_3_0f
v_smfmac_f32_16x16x64_bf16 v[96:99], v[32:35], a[0:7], v6
v_smfmac_f32_16x16x64_bf16 v[100:103], v[32:35], a[32:39], v6
v_smfmac_f32_16x16x64_bf16 v[104:107], v[32:35], a[64:71], v6
v_smfmac_f32_16x16x64_bf16 v[108:111], v[32:35], a[96:103], v6
s_branch mega_kernel_rs_pa_2_1
.p2align 5
mega_kernel_rs_pa_3_1f:
s_mov_b64 exec, vcc
buffer_load_dwordx4 v[36:39], v7, s[84:87], s33 offen offset:1024 sc1
s_mov_b64 exec, -1
s_branch mega_kernel_rs_pa_3_0
.p2align 5
mega_kernel_rs_pa_3_1:
s_waitcnt vmcnt(1)
v_max_u32 v4, v36, v38
v_cmp_eq_u32 vcc, -1, v4
s_cbranch_vccnz mega_kernel_rs_pa_3_1f
v_smfmac_f32_16x16x64_bf16 v[96:99], v[36:39], a[8:15], v6
v_smfmac_f32_16x16x64_bf16 v[100:103], v[36:39], a[40:47], v6
v_smfmac_f32_16x16x64_bf16 v[104:107], v[36:39], a[72:79], v6
v_smfmac_f32_16x16x64_bf16 v[108:111], v[36:39], a[104:111], v6
s_branch mega_kernel_rs_pa_1_0
.p2align 5
mega_kernel_rs_pa_4_2f:
s_mov_b64 exec, vcc
buffer_load_dwordx4 v[40:43], v7, s[84:87], s33 offen offset:2048 sc1
s_mov_b64 exec, -1
s_branch mega_kernel_rs_pa_4_2
.p2align 5
mega_kernel_rs_pa_4_2:
s_waitcnt vmcnt(0)
v_max_u32 v4, v40, v42
v_cmp_eq_u32 vcc, -1, v4
s_cbranch_vccnz mega_kernel_rs_pa_4_2f
v_smfmac_f32_16x16x64_bf16 v[96:99], v[40:43], a[16:23], v6
v_smfmac_f32_16x16x64_bf16 v[100:103], v[40:43], a[48:55], v6
v_smfmac_f32_16x16x64_bf16 v[104:107], v[40:43], a[80:87], v6
v_smfmac_f32_16x16x64_bf16 v[108:111], v[40:43], a[112:119], v6
s_branch mega_kernel_rs_pa_d
.p2align 5
mega_kernel_rs_pa_5_0f:
s_mov_b64 exec, vcc
buffer_load_dwordx4 v[32:35], v7, s[84:87], s33 offen offset:0 sc1
s_mov_b64 exec, -1
s_branch mega_kernel_rs_pa_5_2
.p2align 5
mega_kernel_rs_pa_5_0:
s_waitcnt vmcnt(1)
v_max_u32 v4, v32, v34
v_cmp_eq_u32 vcc, -1, v4
s_cbranch_vccnz mega_kernel_rs_pa_5_0f
v_smfmac_f32_16x16x64_bf16 v[96:99], v[32:35], a[0:7], v6
v_smfmac_f32_16x16x64_bf16 v[100:103], v[32:35], a[32:39], v6
v_smfmac_f32_16x16x64_bf16 v[104:107], v[32:35], a[64:71], v6
v_smfmac_f32_16x16x64_bf16 v[108:111], v[32:35], a[96:103], v6
s_branch mega_kernel_rs_pa_4_2
.p2align 5
mega_kernel_rs_pa_5_2f:
s_mov_b64 exec, vcc
buffer_load_dwordx4 v[40:43], v7, s[84:87], s33 offen offset:2048 sc1
s_mov_b64 exec, -1
s_branch mega_kernel_rs_pa_5_0
.p2align 5
mega_kernel_rs_pa_5_2:
s_waitcnt vmcnt(1)
v_max_u32 v4, v40, v42
v_cmp_eq_u32 vcc, -1, v4
s_cbranch_vccnz mega_kernel_rs_pa_5_2f
v_smfmac_f32_16x16x64_bf16 v[96:99], v[40:43], a[16:23], v6
v_smfmac_f32_16x16x64_bf16 v[100:103], v[40:43], a[48:55], v6
v_smfmac_f32_16x16x64_bf16 v[104:107], v[40:43], a[80:87], v6
v_smfmac_f32_16x16x64_bf16 v[108:111], v[40:43], a[112:119], v6
s_branch mega_kernel_rs_pa_1_0
.p2align 5
mega_kernel_rs_pa_6_1f:
s_mov_b64 exec, vcc
buffer_load_dwordx4 v[36:39], v7, s[84:87], s33 offen offset:1024 sc1
s_mov_b64 exec, -1
s_branch mega_kernel_rs_pa_6_2
.p2align 5
mega_kernel_rs_pa_6_1:
s_waitcnt vmcnt(1)
v_max_u32 v4, v36, v38
v_cmp_eq_u32 vcc, -1, v4
s_cbranch_vccnz mega_kernel_rs_pa_6_1f
v_smfmac_f32_16x16x64_bf16 v[96:99], v[36:39], a[8:15], v6
v_smfmac_f32_16x16x64_bf16 v[100:103], v[36:39], a[40:47], v6
v_smfmac_f32_16x16x64_bf16 v[104:107], v[36:39], a[72:79], v6
v_smfmac_f32_16x16x64_bf16 v[108:111], v[36:39], a[104:111], v6
s_branch mega_kernel_rs_pa_4_2
.p2align 5
mega_kernel_rs_pa_6_2f:
s_mov_b64 exec, vcc
buffer_load_dwordx4 v[40:43], v7, s[84:87], s33 offen offset:2048 sc1
s_mov_b64 exec, -1
s_branch mega_kernel_rs_pa_6_1
.p2align 5
mega_kernel_rs_pa_6_2:
s_waitcnt vmcnt(1)
v_max_u32 v4, v40, v42
v_cmp_eq_u32 vcc, -1, v4
s_cbranch_vccnz mega_kernel_rs_pa_6_2f
v_smfmac_f32_16x16x64_bf16 v[96:99], v[40:43], a[16:23], v6
v_smfmac_f32_16x16x64_bf16 v[100:103], v[40:43], a[48:55], v6
v_smfmac_f32_16x16x64_bf16 v[104:107], v[40:43], a[80:87], v6
v_smfmac_f32_16x16x64_bf16 v[108:111], v[40:43], a[112:119], v6
s_branch mega_kernel_rs_pa_2_1
.p2align 5
mega_kernel_rs_pa_7_0f:
s_mov_b64 exec, vcc
buffer_load_dwordx4 v[32:35], v7, s[84:87], s33 offen offset:0 sc1
s_mov_b64 exec, -1
s_branch mega_kernel_rs_pa_7_1
.p2align 5
mega_kernel_rs_pa_7_0:
s_waitcnt vmcnt(2)
v_max_u32 v4, v32, v34
v_cmp_eq_u32 vcc, -1, v4
s_cbranch_vccnz mega_kernel_rs_pa_7_0f
v_smfmac_f32_16x16x64_bf16 v[96:99], v[32:35], a[0:7], v6
v_smfmac_f32_16x16x64_bf16 v[100:103], v[32:35], a[32:39], v6
v_smfmac_f32_16x16x64_bf16 v[104:107], v[32:35], a[64:71], v6
v_smfmac_f32_16x16x64_bf16 v[108:111], v[32:35], a[96:103], v6
s_branch mega_kernel_rs_pa_6_1
.p2align 5
mega_kernel_rs_pa_7_1f:
s_mov_b64 exec, vcc
buffer_load_dwordx4 v[36:39], v7, s[84:87], s33 offen offset:1024 sc1
s_mov_b64 exec, -1
s_branch mega_kernel_rs_pa_7_2
.p2align 5
mega_kernel_rs_pa_7_1:
s_waitcnt vmcnt(2)
v_max_u32 v4, v36, v38
v_cmp_eq_u32 vcc, -1, v4
s_cbranch_vccnz mega_kernel_rs_pa_7_1f
v_smfmac_f32_16x16x64_bf16 v[96:99], v[36:39], a[8:15], v6
v_smfmac_f32_16x16x64_bf16 v[100:103], v[36:39], a[40:47], v6
v_smfmac_f32_16x16x64_bf16 v[104:107], v[36:39], a[72:79], v6
v_smfmac_f32_16x16x64_bf16 v[108:111], v[36:39], a[104:111], v6
s_branch mega_kernel_rs_pa_5_2
.p2align 5
mega_kernel_rs_pa_7_2f:
s_mov_b64 exec, vcc
buffer_load_dwordx4 v[40:43], v7, s[84:87], s33 offen offset:2048 sc1
s_mov_b64 exec, -1
s_branch mega_kernel_rs_pa_7_0
.p2align 5
mega_kernel_rs_pa_7_2:
s_waitcnt vmcnt(2)
v_max_u32 v4, v40, v42
v_cmp_eq_u32 vcc, -1, v4
s_cbranch_vccnz mega_kernel_rs_pa_7_2f
v_smfmac_f32_16x16x64_bf16 v[96:99], v[40:43], a[16:23], v6
v_smfmac_f32_16x16x64_bf16 v[100:103], v[40:43], a[48:55], v6
v_smfmac_f32_16x16x64_bf16 v[104:107], v[40:43], a[80:87], v6
v_smfmac_f32_16x16x64_bf16 v[108:111], v[40:43], a[112:119], v6
s_branch mega_kernel_rs_pa_3_0
.p2align 5
mega_kernel_rs_pa_8_3f:
s_mov_b64 exec, vcc
buffer_load_dwordx4 v[44:47], v7, s[84:87], s33 offen offset:3072 sc1
s_mov_b64 exec, -1
s_branch mega_kernel_rs_pa_8_3
.p2align 5
mega_kernel_rs_pa_8_3:
s_waitcnt vmcnt(0)
v_max_u32 v4, v44, v46
v_cmp_eq_u32 vcc, -1, v4
s_cbranch_vccnz mega_kernel_rs_pa_8_3f
v_smfmac_f32_16x16x64_bf16 v[96:99], v[44:47], a[24:31], v6
v_smfmac_f32_16x16x64_bf16 v[100:103], v[44:47], a[56:63], v6
v_smfmac_f32_16x16x64_bf16 v[104:107], v[44:47], a[88:95], v6
v_smfmac_f32_16x16x64_bf16 v[108:111], v[44:47], a[120:127], v6
s_branch mega_kernel_rs_pa_d
.p2align 5
mega_kernel_rs_pa_9_0f:
s_mov_b64 exec, vcc
buffer_load_dwordx4 v[32:35], v7, s[84:87], s33 offen offset:0 sc1
s_mov_b64 exec, -1
s_branch mega_kernel_rs_pa_9_3
.p2align 5
mega_kernel_rs_pa_9_0:
s_waitcnt vmcnt(1)
v_max_u32 v4, v32, v34
v_cmp_eq_u32 vcc, -1, v4
s_cbranch_vccnz mega_kernel_rs_pa_9_0f
v_smfmac_f32_16x16x64_bf16 v[96:99], v[32:35], a[0:7], v6
v_smfmac_f32_16x16x64_bf16 v[100:103], v[32:35], a[32:39], v6
v_smfmac_f32_16x16x64_bf16 v[104:107], v[32:35], a[64:71], v6
v_smfmac_f32_16x16x64_bf16 v[108:111], v[32:35], a[96:103], v6
s_branch mega_kernel_rs_pa_8_3
.p2align 5
mega_kernel_rs_pa_9_3f:
s_mov_b64 exec, vcc
buffer_load_dwordx4 v[44:47], v7, s[84:87], s33 offen offset:3072 sc1
s_mov_b64 exec, -1
s_branch mega_kernel_rs_pa_9_0
.p2align 5
mega_kernel_rs_pa_9_3:
s_waitcnt vmcnt(1)
v_max_u32 v4, v44, v46
v_cmp_eq_u32 vcc, -1, v4
s_cbranch_vccnz mega_kernel_rs_pa_9_3f
v_smfmac_f32_16x16x64_bf16 v[96:99], v[44:47], a[24:31], v6
v_smfmac_f32_16x16x64_bf16 v[100:103], v[44:47], a[56:63], v6
v_smfmac_f32_16x16x64_bf16 v[104:107], v[44:47], a[88:95], v6
v_smfmac_f32_16x16x64_bf16 v[108:111], v[44:47], a[120:127], v6
s_branch mega_kernel_rs_pa_1_0
.p2align 5
mega_kernel_rs_pa_10_1f:
s_mov_b64 exec, vcc
buffer_load_dwordx4 v[36:39], v7, s[84:87], s33 offen offset:1024 sc1
s_mov_b64 exec, -1
s_branch mega_kernel_rs_pa_10_3
.p2align 5
mega_kernel_rs_pa_10_1:
s_waitcnt vmcnt(1)
v_max_u32 v4, v36, v38
v_cmp_eq_u32 vcc, -1, v4
s_cbranch_vccnz mega_kernel_rs_pa_10_1f
v_smfmac_f32_16x16x64_bf16 v[96:99], v[36:39], a[8:15], v6
v_smfmac_f32_16x16x64_bf16 v[100:103], v[36:39], a[40:47], v6
v_smfmac_f32_16x16x64_bf16 v[104:107], v[36:39], a[72:79], v6
v_smfmac_f32_16x16x64_bf16 v[108:111], v[36:39], a[104:111], v6
s_branch mega_kernel_rs_pa_8_3
.p2align 5
mega_kernel_rs_pa_10_3f:
s_mov_b64 exec, vcc
buffer_load_dwordx4 v[44:47], v7, s[84:87], s33 offen offset:3072 sc1
s_mov_b64 exec, -1
s_branch mega_kernel_rs_pa_10_1
.p2align 5
mega_kernel_rs_pa_10_3:
s_waitcnt vmcnt(1)
v_max_u32 v4, v44, v46
v_cmp_eq_u32 vcc, -1, v4
s_cbranch_vccnz mega_kernel_rs_pa_10_3f
v_smfmac_f32_16x16x64_bf16 v[96:99], v[44:47], a[24:31], v6
v_smfmac_f32_16x16x64_bf16 v[100:103], v[44:47], a[56:63], v6
v_smfmac_f32_16x16x64_bf16 v[104:107], v[44:47], a[88:95], v6
v_smfmac_f32_16x16x64_bf16 v[108:111], v[44:47], a[120:127], v6
s_branch mega_kernel_rs_pa_2_1
.p2align 5
mega_kernel_rs_pa_11_0f:
s_mov_b64 exec, vcc
buffer_load_dwordx4 v[32:35], v7, s[84:87], s33 offen offset:0 sc1
s_mov_b64 exec, -1
s_branch mega_kernel_rs_pa_11_1
.p2align 5
mega_kernel_rs_pa_11_0:
s_waitcnt vmcnt(2)
v_max_u32 v4, v32, v34
v_cmp_eq_u32 vcc, -1, v4
s_cbranch_vccnz mega_kernel_rs_pa_11_0f
v_smfmac_f32_16x16x64_bf16 v[96:99], v[32:35], a[0:7], v6
v_smfmac_f32_16x16x64_bf16 v[100:103], v[32:35], a[32:39], v6
v_smfmac_f32_16x16x64_bf16 v[104:107], v[32:35], a[64:71], v6
v_smfmac_f32_16x16x64_bf16 v[108:111], v[32:35], a[96:103], v6
s_branch mega_kernel_rs_pa_10_1
.p2align 5
mega_kernel_rs_pa_11_1f:
s_mov_b64 exec, vcc
buffer_load_dwordx4 v[36:39], v7, s[84:87], s33 offen offset:1024 sc1
s_mov_b64 exec, -1
s_branch mega_kernel_rs_pa_11_3
.p2align 5
mega_kernel_rs_pa_11_1:
s_waitcnt vmcnt(2)
v_max_u32 v4, v36, v38
v_cmp_eq_u32 vcc, -1, v4
s_cbranch_vccnz mega_kernel_rs_pa_11_1f
v_smfmac_f32_16x16x64_bf16 v[96:99], v[36:39], a[8:15], v6
v_smfmac_f32_16x16x64_bf16 v[100:103], v[36:39], a[40:47], v6
v_smfmac_f32_16x16x64_bf16 v[104:107], v[36:39], a[72:79], v6
v_smfmac_f32_16x16x64_bf16 v[108:111], v[36:39], a[104:111], v6
s_branch mega_kernel_rs_pa_9_3
.p2align 5
mega_kernel_rs_pa_11_3f:
s_mov_b64 exec, vcc
buffer_load_dwordx4 v[44:47], v7, s[84:87], s33 offen offset:3072 sc1
s_mov_b64 exec, -1
s_branch mega_kernel_rs_pa_11_0
.p2align 5
mega_kernel_rs_pa_11_3:
s_waitcnt vmcnt(2)
v_max_u32 v4, v44, v46
v_cmp_eq_u32 vcc, -1, v4
s_cbranch_vccnz mega_kernel_rs_pa_11_3f
v_smfmac_f32_16x16x64_bf16 v[96:99], v[44:47], a[24:31], v6
v_smfmac_f32_16x16x64_bf16 v[100:103], v[44:47], a[56:63], v6
v_smfmac_f32_16x16x64_bf16 v[104:107], v[44:47], a[88:95], v6
v_smfmac_f32_16x16x64_bf16 v[108:111], v[44:47], a[120:127], v6
s_branch mega_kernel_rs_pa_3_0
.p2align 5
mega_kernel_rs_pa_12_2f:
s_mov_b64 exec, vcc
buffer_load_dwordx4 v[40:43], v7, s[84:87], s33 offen offset:2048 sc1
s_mov_b64 exec, -1
s_branch mega_kernel_rs_pa_12_3
.p2align 5
mega_kernel_rs_pa_12_2:
s_waitcnt vmcnt(1)
v_max_u32 v4, v40, v42
v_cmp_eq_u32 vcc, -1, v4
s_cbranch_vccnz mega_kernel_rs_pa_12_2f
v_smfmac_f32_16x16x64_bf16 v[96:99], v[40:43], a[16:23], v6
v_smfmac_f32_16x16x64_bf16 v[100:103], v[40:43], a[48:55], v6
v_smfmac_f32_16x16x64_bf16 v[104:107], v[40:43], a[80:87], v6
v_smfmac_f32_16x16x64_bf16 v[108:111], v[40:43], a[112:119], v6
s_branch mega_kernel_rs_pa_8_3
.p2align 5
mega_kernel_rs_pa_12_3f:
s_mov_b64 exec, vcc
buffer_load_dwordx4 v[44:47], v7, s[84:87], s33 offen offset:3072 sc1
s_mov_b64 exec, -1
s_branch mega_kernel_rs_pa_12_2
.p2align 5
mega_kernel_rs_pa_12_3:
s_waitcnt vmcnt(1)
v_max_u32 v4, v44, v46
v_cmp_eq_u32 vcc, -1, v4
s_cbranch_vccnz mega_kernel_rs_pa_12_3f
v_smfmac_f32_16x16x64_bf16 v[96:99], v[44:47], a[24:31], v6
v_smfmac_f32_16x16x64_bf16 v[100:103], v[44:47], a[56:63], v6
v_smfmac_f32_16x16x64_bf16 v[104:107], v[44:47], a[88:95], v6
v_smfmac_f32_16x16x64_bf16 v[108:111], v[44:47], a[120:127], v6
s_branch mega_kernel_rs_pa_4_2
.p2align 5
mega_kernel_rs_pa_13_0f:
s_mov_b64 exec, vcc
buffer_load_dwordx4 v[32:35], v7, s[84:87], s33 offen offset:0 sc1
s_mov_b64 exec, -1
s_branch mega_kernel_rs_pa_13_2
.p2align 5
mega_kernel_rs_pa_13_0:
s_waitcnt vmcnt(2)
v_max_u32 v4, v32, v34
v_cmp_eq_u32 vcc, -1, v4
s_cbranch_vccnz mega_kernel_rs_pa_13_0f
v_smfmac_f32_16x16x64_bf16 v[96:99], v[32:35], a[0:7], v6
v_smfmac_f32_16x16x64_bf16 v[100:103], v[32:35], a[32:39], v6
v_smfmac_f32_16x16x64_bf16 v[104:107], v[32:35], a[64:71], v6
v_smfmac_f32_16x16x64_bf16 v[108:111], v[32:35], a[96:103], v6
s_branch mega_kernel_rs_pa_12_2
.p2align 5
mega_kernel_rs_pa_13_2f:
s_mov_b64 exec, vcc
buffer_load_dwordx4 v[40:43], v7, s[84:87], s33 offen offset:2048 sc1
s_mov_b64 exec, -1
s_branch mega_kernel_rs_pa_13_3
.p2align 5
mega_kernel_rs_pa_13_2:
s_waitcnt vmcnt(2)
v_max_u32 v4, v40, v42
v_cmp_eq_u32 vcc, -1, v4
s_cbranch_vccnz mega_kernel_rs_pa_13_2f
v_smfmac_f32_16x16x64_bf16 v[96:99], v[40:43], a[16:23], v6
v_smfmac_f32_16x16x64_bf16 v[100:103], v[40:43], a[48:55], v6
v_smfmac_f32_16x16x64_bf16 v[104:107], v[40:43], a[80:87], v6
v_smfmac_f32_16x16x64_bf16 v[108:111], v[40:43], a[112:119], v6
s_branch mega_kernel_rs_pa_9_3
.p2align 5
mega_kernel_rs_pa_13_3f:
s_mov_b64 exec, vcc
buffer_load_dwordx4 v[44:47], v7, s[84:87], s33 offen offset:3072 sc1
s_mov_b64 exec, -1
s_branch mega_kernel_rs_pa_13_0
.p2align 5
mega_kernel_rs_pa_13_3:
s_waitcnt vmcnt(2)
v_max_u32 v4, v44, v46
v_cmp_eq_u32 vcc, -1, v4
s_cbranch_vccnz mega_kernel_rs_pa_13_3f
v_smfmac_f32_16x16x64_bf16 v[96:99], v[44:47], a[24:31], v6
v_smfmac_f32_16x16x64_bf16 v[100:103], v[44:47], a[56:63], v6
v_smfmac_f32_16x16x64_bf16 v[104:107], v[44:47], a[88:95], v6
v_smfmac_f32_16x16x64_bf16 v[108:111], v[44:47], a[120:127], v6
s_branch mega_kernel_rs_pa_5_0
.p2align 5
mega_kernel_rs_pa_14_1f:
s_mov_b64 exec, vcc
buffer_load_dwordx4 v[36:39], v7, s[84:87], s33 offen offset:1024 sc1
s_mov_b64 exec, -1
s_branch mega_kernel_rs_pa_14_2
.p2align 5
mega_kernel_rs_pa_14_1:
s_waitcnt vmcnt(2)
v_max_u32 v4, v36, v38
v_cmp_eq_u32 vcc, -1, v4
s_cbranch_vccnz mega_kernel_rs_pa_14_1f
v_smfmac_f32_16x16x64_bf16 v[96:99], v[36:39], a[8:15], v6
v_smfmac_f32_16x16x64_bf16 v[100:103], v[36:39], a[40:47], v6
v_smfmac_f32_16x16x64_bf16 v[104:107], v[36:39], a[72:79], v6
v_smfmac_f32_16x16x64_bf16 v[108:111], v[36:39], a[104:111], v6
s_branch mega_kernel_rs_pa_12_2
.p2align 5
mega_kernel_rs_pa_14_2f:
s_mov_b64 exec, vcc
buffer_load_dwordx4 v[40:43], v7, s[84:87], s33 offen offset:2048 sc1
s_mov_b64 exec, -1
s_branch mega_kernel_rs_pa_14_3
.p2align 5
mega_kernel_rs_pa_14_2:
s_waitcnt vmcnt(2)
v_max_u32 v4, v40, v42
v_cmp_eq_u32 vcc, -1, v4
s_cbranch_vccnz mega_kernel_rs_pa_14_2f
v_smfmac_f32_16x16x64_bf16 v[96:99], v[40:43], a[16:23], v6
v_smfmac_f32_16x16x64_bf16 v[100:103], v[40:43], a[48:55], v6
v_smfmac_f32_16x16x64_bf16 v[104:107], v[40:43], a[80:87], v6
v_smfmac_f32_16x16x64_bf16 v[108:111], v[40:43], a[112:119], v6
s_branch mega_kernel_rs_pa_10_3
.p2align 5
mega_kernel_rs_pa_14_3f:
s_mov_b64 exec, vcc
buffer_load_dwordx4 v[44:47], v7, s[84:87], s33 offen offset:3072 sc1
s_mov_b64 exec, -1
s_branch mega_kernel_rs_pa_14_1
.p2align 5
mega_kernel_rs_pa_14_3:
s_waitcnt vmcnt(2)
v_max_u32 v4, v44, v46
v_cmp_eq_u32 vcc, -1, v4
s_cbranch_vccnz mega_kernel_rs_pa_14_3f
v_smfmac_f32_16x16x64_bf16 v[96:99], v[44:47], a[24:31], v6
v_smfmac_f32_16x16x64_bf16 v[100:103], v[44:47], a[56:63], v6
v_smfmac_f32_16x16x64_bf16 v[104:107], v[44:47], a[88:95], v6
v_smfmac_f32_16x16x64_bf16 v[108:111], v[44:47], a[120:127], v6
s_branch mega_kernel_rs_pa_6_1
.p2align 5
mega_kernel_rs_pa_15_0f:
s_mov_b64 exec, vcc
buffer_load_dwordx4 v[32:35], v7, s[84:87], s33 offen offset:0 sc1
s_mov_b64 exec, -1
s_branch mega_kernel_rs_pa_15_1
.p2align 5
mega_kernel_rs_pa_15_0:
s_waitcnt vmcnt(3)
v_max_u32 v4, v32, v34
v_cmp_eq_u32 vcc, -1, v4
s_cbranch_vccnz mega_kernel_rs_pa_15_0f
v_smfmac_f32_16x16x64_bf16 v[96:99], v[32:35], a[0:7], v6
v_smfmac_f32_16x16x64_bf16 v[100:103], v[32:35], a[32:39], v6
v_smfmac_f32_16x16x64_bf16 v[104:107], v[32:35], a[64:71], v6
v_smfmac_f32_16x16x64_bf16 v[108:111], v[32:35], a[96:103], v6
s_branch mega_kernel_rs_pa_14_1
.p2align 5
mega_kernel_rs_pa_15_1f:
s_mov_b64 exec, vcc
buffer_load_dwordx4 v[36:39], v7, s[84:87], s33 offen offset:1024 sc1
s_mov_b64 exec, -1
s_branch mega_kernel_rs_pa_15_2
.p2align 5
mega_kernel_rs_pa_15_1:
s_waitcnt vmcnt(3)
v_max_u32 v4, v36, v38
v_cmp_eq_u32 vcc, -1, v4
s_cbranch_vccnz mega_kernel_rs_pa_15_1f
v_smfmac_f32_16x16x64_bf16 v[96:99], v[36:39], a[8:15], v6
v_smfmac_f32_16x16x64_bf16 v[100:103], v[36:39], a[40:47], v6
v_smfmac_f32_16x16x64_bf16 v[104:107], v[36:39], a[72:79], v6
v_smfmac_f32_16x16x64_bf16 v[108:111], v[36:39], a[104:111], v6
s_branch mega_kernel_rs_pa_13_2
.p2align 5
mega_kernel_rs_pa_15_2f:
s_mov_b64 exec, vcc
buffer_load_dwordx4 v[40:43], v7, s[84:87], s33 offen offset:2048 sc1
s_mov_b64 exec, -1
s_branch mega_kernel_rs_pa_15_3
.p2align 5
mega_kernel_rs_pa_15_2:
s_waitcnt vmcnt(3)
v_max_u32 v4, v40, v42
v_cmp_eq_u32 vcc, -1, v4
s_cbranch_vccnz mega_kernel_rs_pa_15_2f
v_smfmac_f32_16x16x64_bf16 v[96:99], v[40:43], a[16:23], v6
v_smfmac_f32_16x16x64_bf16 v[100:103], v[40:43], a[48:55], v6
v_smfmac_f32_16x16x64_bf16 v[104:107], v[40:43], a[80:87], v6
v_smfmac_f32_16x16x64_bf16 v[108:111], v[40:43], a[112:119], v6
s_branch mega_kernel_rs_pa_11_3
.p2align 5
mega_kernel_rs_pa_15_3f:
s_mov_b64 exec, vcc
buffer_load_dwordx4 v[44:47], v7, s[84:87], s33 offen offset:3072 sc1
s_mov_b64 exec, -1
s_branch mega_kernel_rs_pa_15_0
.p2align 5
mega_kernel_rs_pa_15_3:
s_waitcnt vmcnt(3)
v_max_u32 v4, v44, v46
v_cmp_eq_u32 vcc, -1, v4
s_cbranch_vccnz mega_kernel_rs_pa_15_3f
v_smfmac_f32_16x16x64_bf16 v[96:99], v[44:47], a[24:31], v6
v_smfmac_f32_16x16x64_bf16 v[100:103], v[44:47], a[56:63], v6
v_smfmac_f32_16x16x64_bf16 v[104:107], v[44:47], a[88:95], v6
v_smfmac_f32_16x16x64_bf16 v[108:111], v[44:47], a[120:127], v6
s_branch mega_kernel_rs_pa_7_0
.p2align 5
mega_kernel_rs_pc_1_0f:
s_mov_b64 exec, vcc
buffer_load_dwordx4 v[32:35], v7, s[84:87], s29 offen offset:0 sc1
s_mov_b64 exec, -1
s_branch mega_kernel_rs_pc_1_0
.p2align 5
mega_kernel_rs_pc_1_0:
s_waitcnt vmcnt(0)
v_cmp_eq_u32 vcc, -1, v32
s_cbranch_vccnz mega_kernel_rs_pc_1_0f
v_smfmac_f32_16x16x64_bf16 v[96:99], v[32:35], a[192:199], v6
v_smfmac_f32_16x16x64_bf16 v[100:103], v[32:35], a[224:231], v6
s_branch mega_kernel_rs_pc_d
.p2align 5
mega_kernel_rs_pc_2_1f:
s_mov_b64 exec, vcc
buffer_load_dwordx4 v[36:39], v7, s[84:87], s29 offen offset:1024 sc1
s_mov_b64 exec, -1
s_branch mega_kernel_rs_pc_2_1
.p2align 5
mega_kernel_rs_pc_2_1:
s_waitcnt vmcnt(0)
v_cmp_eq_u32 vcc, -1, v36
s_cbranch_vccnz mega_kernel_rs_pc_2_1f
v_smfmac_f32_16x16x64_bf16 v[96:99], v[36:39], a[200:207], v6
v_smfmac_f32_16x16x64_bf16 v[100:103], v[36:39], a[232:239], v6
s_branch mega_kernel_rs_pc_d
.p2align 5
mega_kernel_rs_pc_3_0f:
s_mov_b64 exec, vcc
buffer_load_dwordx4 v[32:35], v7, s[84:87], s29 offen offset:0 sc1
s_mov_b64 exec, -1
s_branch mega_kernel_rs_pc_3_1
.p2align 5
mega_kernel_rs_pc_3_0:
s_waitcnt vmcnt(1)
v_cmp_eq_u32 vcc, -1, v32
s_cbranch_vccnz mega_kernel_rs_pc_3_0f
v_smfmac_f32_16x16x64_bf16 v[96:99], v[32:35], a[192:199], v6
v_smfmac_f32_16x16x64_bf16 v[100:103], v[32:35], a[224:231], v6
s_branch mega_kernel_rs_pc_2_1
.p2align 5
mega_kernel_rs_pc_3_1f:
s_mov_b64 exec, vcc
buffer_load_dwordx4 v[36:39], v7, s[84:87], s29 offen offset:1024 sc1
s_mov_b64 exec, -1
s_branch mega_kernel_rs_pc_3_0
.p2align 5
mega_kernel_rs_pc_3_1:
s_waitcnt vmcnt(1)
v_cmp_eq_u32 vcc, -1, v36
s_cbranch_vccnz mega_kernel_rs_pc_3_1f
v_smfmac_f32_16x16x64_bf16 v[96:99], v[36:39], a[200:207], v6
v_smfmac_f32_16x16x64_bf16 v[100:103], v[36:39], a[232:239], v6
s_branch mega_kernel_rs_pc_1_0
.p2align 5
mega_kernel_rs_pc_4_2f:
s_mov_b64 exec, vcc
buffer_load_dwordx4 v[40:43], v7, s[84:87], s29 offen offset:2048 sc1
s_mov_b64 exec, -1
s_branch mega_kernel_rs_pc_4_2
.p2align 5
mega_kernel_rs_pc_4_2:
s_waitcnt vmcnt(0)
v_cmp_eq_u32 vcc, -1, v40
s_cbranch_vccnz mega_kernel_rs_pc_4_2f
v_smfmac_f32_16x16x64_bf16 v[96:99], v[40:43], a[208:215], v6
v_smfmac_f32_16x16x64_bf16 v[100:103], v[40:43], a[240:247], v6
s_branch mega_kernel_rs_pc_d
.p2align 5
mega_kernel_rs_pc_5_0f:
s_mov_b64 exec, vcc
buffer_load_dwordx4 v[32:35], v7, s[84:87], s29 offen offset:0 sc1
s_mov_b64 exec, -1
s_branch mega_kernel_rs_pc_5_2
.p2align 5
mega_kernel_rs_pc_5_0:
s_waitcnt vmcnt(1)
v_cmp_eq_u32 vcc, -1, v32
s_cbranch_vccnz mega_kernel_rs_pc_5_0f
v_smfmac_f32_16x16x64_bf16 v[96:99], v[32:35], a[192:199], v6
v_smfmac_f32_16x16x64_bf16 v[100:103], v[32:35], a[224:231], v6
s_branch mega_kernel_rs_pc_4_2
.p2align 5
mega_kernel_rs_pc_5_2f:
s_mov_b64 exec, vcc
buffer_load_dwordx4 v[40:43], v7, s[84:87], s29 offen offset:2048 sc1
s_mov_b64 exec, -1
s_branch mega_kernel_rs_pc_5_0
.p2align 5
mega_kernel_rs_pc_5_2:
s_waitcnt vmcnt(1)
v_cmp_eq_u32 vcc, -1, v40
s_cbranch_vccnz mega_kernel_rs_pc_5_2f
v_smfmac_f32_16x16x64_bf16 v[96:99], v[40:43], a[208:215], v6
v_smfmac_f32_16x16x64_bf16 v[100:103], v[40:43], a[240:247], v6
s_branch mega_kernel_rs_pc_1_0
.p2align 5
mega_kernel_rs_pc_6_1f:
s_mov_b64 exec, vcc
buffer_load_dwordx4 v[36:39], v7, s[84:87], s29 offen offset:1024 sc1
s_mov_b64 exec, -1
s_branch mega_kernel_rs_pc_6_2
.p2align 5
mega_kernel_rs_pc_6_1:
s_waitcnt vmcnt(1)
v_cmp_eq_u32 vcc, -1, v36
s_cbranch_vccnz mega_kernel_rs_pc_6_1f
v_smfmac_f32_16x16x64_bf16 v[96:99], v[36:39], a[200:207], v6
v_smfmac_f32_16x16x64_bf16 v[100:103], v[36:39], a[232:239], v6
s_branch mega_kernel_rs_pc_4_2
.p2align 5
mega_kernel_rs_pc_6_2f:
s_mov_b64 exec, vcc
buffer_load_dwordx4 v[40:43], v7, s[84:87], s29 offen offset:2048 sc1
s_mov_b64 exec, -1
s_branch mega_kernel_rs_pc_6_1
.p2align 5
mega_kernel_rs_pc_6_2:
s_waitcnt vmcnt(1)
v_cmp_eq_u32 vcc, -1, v40
s_cbranch_vccnz mega_kernel_rs_pc_6_2f
v_smfmac_f32_16x16x64_bf16 v[96:99], v[40:43], a[208:215], v6
v_smfmac_f32_16x16x64_bf16 v[100:103], v[40:43], a[240:247], v6
s_branch mega_kernel_rs_pc_2_1
.p2align 5
mega_kernel_rs_pc_7_0f:
s_mov_b64 exec, vcc
buffer_load_dwordx4 v[32:35], v7, s[84:87], s29 offen offset:0 sc1
s_mov_b64 exec, -1
s_branch mega_kernel_rs_pc_7_1
.p2align 5
mega_kernel_rs_pc_7_0:
s_waitcnt vmcnt(2)
v_cmp_eq_u32 vcc, -1, v32
s_cbranch_vccnz mega_kernel_rs_pc_7_0f
v_smfmac_f32_16x16x64_bf16 v[96:99], v[32:35], a[192:199], v6
v_smfmac_f32_16x16x64_bf16 v[100:103], v[32:35], a[224:231], v6
s_branch mega_kernel_rs_pc_6_1
.p2align 5
mega_kernel_rs_pc_7_1f:
s_mov_b64 exec, vcc
buffer_load_dwordx4 v[36:39], v7, s[84:87], s29 offen offset:1024 sc1
s_mov_b64 exec, -1
s_branch mega_kernel_rs_pc_7_2
.p2align 5
mega_kernel_rs_pc_7_1:
s_waitcnt vmcnt(2)
v_cmp_eq_u32 vcc, -1, v36
s_cbranch_vccnz mega_kernel_rs_pc_7_1f
v_smfmac_f32_16x16x64_bf16 v[96:99], v[36:39], a[200:207], v6
v_smfmac_f32_16x16x64_bf16 v[100:103], v[36:39], a[232:239], v6
s_branch mega_kernel_rs_pc_5_2
.p2align 5
mega_kernel_rs_pc_7_2f:
s_mov_b64 exec, vcc
buffer_load_dwordx4 v[40:43], v7, s[84:87], s29 offen offset:2048 sc1
s_mov_b64 exec, -1
s_branch mega_kernel_rs_pc_7_0
.p2align 5
mega_kernel_rs_pc_7_2:
s_waitcnt vmcnt(2)
v_cmp_eq_u32 vcc, -1, v40
s_cbranch_vccnz mega_kernel_rs_pc_7_2f
v_smfmac_f32_16x16x64_bf16 v[96:99], v[40:43], a[208:215], v6
v_smfmac_f32_16x16x64_bf16 v[100:103], v[40:43], a[240:247], v6
s_branch mega_kernel_rs_pc_3_0
.p2align 5
mega_kernel_rs_pc_8_3f:
s_mov_b64 exec, vcc
buffer_load_dwordx4 v[44:47], v7, s[84:87], s29 offen offset:3072 sc1
s_mov_b64 exec, -1
s_branch mega_kernel_rs_pc_8_3
.p2align 5
mega_kernel_rs_pc_9_0f:
s_mov_b64 exec, vcc
buffer_load_dwordx4 v[32:35], v7, s[84:87], s29 offen offset:0 sc1
s_mov_b64 exec, -1
s_branch mega_kernel_rs_pc_9_3
.p2align 5
mega_kernel_rs_pc_9_0:
s_waitcnt vmcnt(1)
v_cmp_eq_u32 vcc, -1, v32
s_cbranch_vccnz mega_kernel_rs_pc_9_0f
v_smfmac_f32_16x16x64_bf16 v[96:99], v[32:35], a[192:199], v6
v_smfmac_f32_16x16x64_bf16 v[100:103], v[32:35], a[224:231], v6
s_branch mega_kernel_rs_pc_8_3
.p2align 5
mega_kernel_rs_pc_9_3f:
s_mov_b64 exec, vcc
buffer_load_dwordx4 v[44:47], v7, s[84:87], s29 offen offset:3072 sc1
s_mov_b64 exec, -1
s_branch mega_kernel_rs_pc_9_0
.p2align 5
mega_kernel_rs_pc_9_3:
s_waitcnt vmcnt(1)
v_cmp_eq_u32 vcc, -1, v44
s_cbranch_vccnz mega_kernel_rs_pc_9_3f
v_smfmac_f32_16x16x64_bf16 v[96:99], v[44:47], a[216:223], v6
v_smfmac_f32_16x16x64_bf16 v[100:103], v[44:47], a[248:255], v6
s_branch mega_kernel_rs_pc_1_0
.p2align 5
mega_kernel_rs_pc_10_1f:
s_mov_b64 exec, vcc
buffer_load_dwordx4 v[36:39], v7, s[84:87], s29 offen offset:1024 sc1
s_mov_b64 exec, -1
s_branch mega_kernel_rs_pc_10_3
.p2align 5
mega_kernel_rs_pc_10_1:
s_waitcnt vmcnt(1)
v_cmp_eq_u32 vcc, -1, v36
s_cbranch_vccnz mega_kernel_rs_pc_10_1f
v_smfmac_f32_16x16x64_bf16 v[96:99], v[36:39], a[200:207], v6
v_smfmac_f32_16x16x64_bf16 v[100:103], v[36:39], a[232:239], v6
s_branch mega_kernel_rs_pc_8_3
.p2align 5
mega_kernel_rs_pc_10_3f:
s_mov_b64 exec, vcc
buffer_load_dwordx4 v[44:47], v7, s[84:87], s29 offen offset:3072 sc1
s_mov_b64 exec, -1
s_branch mega_kernel_rs_pc_10_1
.p2align 5
mega_kernel_rs_pc_10_3:
s_waitcnt vmcnt(1)
v_cmp_eq_u32 vcc, -1, v44
s_cbranch_vccnz mega_kernel_rs_pc_10_3f
v_smfmac_f32_16x16x64_bf16 v[96:99], v[44:47], a[216:223], v6
v_smfmac_f32_16x16x64_bf16 v[100:103], v[44:47], a[248:255], v6
s_branch mega_kernel_rs_pc_2_1
.p2align 5
mega_kernel_rs_pc_11_0f:
s_mov_b64 exec, vcc
buffer_load_dwordx4 v[32:35], v7, s[84:87], s29 offen offset:0 sc1
s_mov_b64 exec, -1
s_branch mega_kernel_rs_pc_11_1
.p2align 5
mega_kernel_rs_pc_11_0:
s_waitcnt vmcnt(2)
v_cmp_eq_u32 vcc, -1, v32
s_cbranch_vccnz mega_kernel_rs_pc_11_0f
v_smfmac_f32_16x16x64_bf16 v[96:99], v[32:35], a[192:199], v6
v_smfmac_f32_16x16x64_bf16 v[100:103], v[32:35], a[224:231], v6
s_branch mega_kernel_rs_pc_10_1
.p2align 5
mega_kernel_rs_pc_11_1f:
s_mov_b64 exec, vcc
buffer_load_dwordx4 v[36:39], v7, s[84:87], s29 offen offset:1024 sc1
s_mov_b64 exec, -1
s_branch mega_kernel_rs_pc_11_3
.p2align 5
mega_kernel_rs_pc_11_1:
s_waitcnt vmcnt(2)
v_cmp_eq_u32 vcc, -1, v36
s_cbranch_vccnz mega_kernel_rs_pc_11_1f
v_smfmac_f32_16x16x64_bf16 v[96:99], v[36:39], a[200:207], v6
v_smfmac_f32_16x16x64_bf16 v[100:103], v[36:39], a[232:239], v6
s_branch mega_kernel_rs_pc_9_3
.p2align 5
mega_kernel_rs_pc_11_3f:
s_mov_b64 exec, vcc
buffer_load_dwordx4 v[44:47], v7, s[84:87], s29 offen offset:3072 sc1
s_mov_b64 exec, -1
s_branch mega_kernel_rs_pc_11_0
.p2align 5
mega_kernel_rs_pc_11_3:
s_waitcnt vmcnt(2)
v_cmp_eq_u32 vcc, -1, v44
s_cbranch_vccnz mega_kernel_rs_pc_11_3f
v_smfmac_f32_16x16x64_bf16 v[96:99], v[44:47], a[216:223], v6
v_smfmac_f32_16x16x64_bf16 v[100:103], v[44:47], a[248:255], v6
s_branch mega_kernel_rs_pc_3_0
.p2align 5
mega_kernel_rs_pc_12_2f:
s_mov_b64 exec, vcc
buffer_load_dwordx4 v[40:43], v7, s[84:87], s29 offen offset:2048 sc1
s_mov_b64 exec, -1
s_branch mega_kernel_rs_pc_12_3
.p2align 5
mega_kernel_rs_pc_12_3f:
s_mov_b64 exec, vcc
buffer_load_dwordx4 v[44:47], v7, s[84:87], s29 offen offset:3072 sc1
s_mov_b64 exec, -1
s_branch mega_kernel_rs_pc_12_2
.p2align 5
mega_kernel_rs_pc_12_3:
s_waitcnt vmcnt(1)
v_cmp_eq_u32 vcc, -1, v44
s_cbranch_vccnz mega_kernel_rs_pc_12_3f
v_smfmac_f32_16x16x64_bf16 v[96:99], v[44:47], a[216:223], v6
v_smfmac_f32_16x16x64_bf16 v[100:103], v[44:47], a[248:255], v6
s_branch mega_kernel_rs_pc_4_2
.p2align 5
mega_kernel_rs_pc_13_0f:
s_mov_b64 exec, vcc
buffer_load_dwordx4 v[32:35], v7, s[84:87], s29 offen offset:0 sc1
s_mov_b64 exec, -1
s_branch mega_kernel_rs_pc_13_2
.p2align 5
mega_kernel_rs_pc_13_0:
s_waitcnt vmcnt(2)
v_cmp_eq_u32 vcc, -1, v32
s_cbranch_vccnz mega_kernel_rs_pc_13_0f
v_smfmac_f32_16x16x64_bf16 v[96:99], v[32:35], a[192:199], v6
v_smfmac_f32_16x16x64_bf16 v[100:103], v[32:35], a[224:231], v6
s_branch mega_kernel_rs_pc_12_2
.p2align 5
mega_kernel_rs_pc_13_2f:
s_mov_b64 exec, vcc
buffer_load_dwordx4 v[40:43], v7, s[84:87], s29 offen offset:2048 sc1
s_mov_b64 exec, -1
s_branch mega_kernel_rs_pc_13_3
.p2align 5
mega_kernel_rs_pc_13_2:
s_waitcnt vmcnt(2)
v_cmp_eq_u32 vcc, -1, v40
s_cbranch_vccnz mega_kernel_rs_pc_13_2f
v_smfmac_f32_16x16x64_bf16 v[96:99], v[40:43], a[208:215], v6
v_smfmac_f32_16x16x64_bf16 v[100:103], v[40:43], a[240:247], v6
s_branch mega_kernel_rs_pc_9_3
.p2align 5
mega_kernel_rs_pc_13_3f:
s_mov_b64 exec, vcc
buffer_load_dwordx4 v[44:47], v7, s[84:87], s29 offen offset:3072 sc1
s_mov_b64 exec, -1
s_branch mega_kernel_rs_pc_13_0
.p2align 5
mega_kernel_rs_pc_13_3:
s_waitcnt vmcnt(2)
v_cmp_eq_u32 vcc, -1, v44
s_cbranch_vccnz mega_kernel_rs_pc_13_3f
v_smfmac_f32_16x16x64_bf16 v[96:99], v[44:47], a[216:223], v6
v_smfmac_f32_16x16x64_bf16 v[100:103], v[44:47], a[248:255], v6
s_branch mega_kernel_rs_pc_5_0
.p2align 5
mega_kernel_rs_pc_14_1f:
s_mov_b64 exec, vcc
buffer_load_dwordx4 v[36:39], v7, s[84:87], s29 offen offset:1024 sc1
s_mov_b64 exec, -1
s_branch mega_kernel_rs_pc_14_2
.p2align 5
mega_kernel_rs_pc_14_2f:
s_mov_b64 exec, vcc
buffer_load_dwordx4 v[40:43], v7, s[84:87], s29 offen offset:2048 sc1
s_mov_b64 exec, -1
s_branch mega_kernel_rs_pc_14_3
.p2align 5
mega_kernel_rs_pc_14_2:
s_waitcnt vmcnt(2)
v_cmp_eq_u32 vcc, -1, v40
s_cbranch_vccnz mega_kernel_rs_pc_14_2f
v_smfmac_f32_16x16x64_bf16 v[96:99], v[40:43], a[208:215], v6
v_smfmac_f32_16x16x64_bf16 v[100:103], v[40:43], a[240:247], v6
s_branch mega_kernel_rs_pc_10_3
.p2align 5
mega_kernel_rs_pc_14_3f:
s_mov_b64 exec, vcc
buffer_load_dwordx4 v[44:47], v7, s[84:87], s29 offen offset:3072 sc1
s_mov_b64 exec, -1
s_branch mega_kernel_rs_pc_14_1
.p2align 5
mega_kernel_rs_pc_14_3:
s_waitcnt vmcnt(2)
v_cmp_eq_u32 vcc, -1, v44
s_cbranch_vccnz mega_kernel_rs_pc_14_3f
v_smfmac_f32_16x16x64_bf16 v[96:99], v[44:47], a[216:223], v6
v_smfmac_f32_16x16x64_bf16 v[100:103], v[44:47], a[248:255], v6
s_branch mega_kernel_rs_pc_6_1
.p2align 5
mega_kernel_rs_pc_15_0f:
s_mov_b64 exec, vcc
buffer_load_dwordx4 v[32:35], v7, s[84:87], s29 offen offset:0 sc1
s_mov_b64 exec, -1
s_branch mega_kernel_rs_pc_15_1
.p2align 5
mega_kernel_rs_pc_15_1f:
s_mov_b64 exec, vcc
buffer_load_dwordx4 v[36:39], v7, s[84:87], s29 offen offset:1024 sc1
s_mov_b64 exec, -1
s_branch mega_kernel_rs_pc_15_2
.p2align 5
mega_kernel_rs_pc_15_1:
s_waitcnt vmcnt(3)
v_cmp_eq_u32 vcc, -1, v36
s_cbranch_vccnz mega_kernel_rs_pc_15_1f
v_smfmac_f32_16x16x64_bf16 v[96:99], v[36:39], a[200:207], v6
v_smfmac_f32_16x16x64_bf16 v[100:103], v[36:39], a[232:239], v6
s_branch mega_kernel_rs_pc_13_2
.p2align 5
mega_kernel_rs_pc_15_2f:
s_mov_b64 exec, vcc
buffer_load_dwordx4 v[40:43], v7, s[84:87], s29 offen offset:2048 sc1
s_mov_b64 exec, -1
s_branch mega_kernel_rs_pc_15_3
.p2align 5
mega_kernel_rs_pc_15_2:
s_waitcnt vmcnt(3)
v_cmp_eq_u32 vcc, -1, v40
s_cbranch_vccnz mega_kernel_rs_pc_15_2f
v_smfmac_f32_16x16x64_bf16 v[96:99], v[40:43], a[208:215], v6
v_smfmac_f32_16x16x64_bf16 v[100:103], v[40:43], a[240:247], v6
s_branch mega_kernel_rs_pc_11_3
.p2align 5
mega_kernel_rs_pc_15_3f:
s_mov_b64 exec, vcc
buffer_load_dwordx4 v[44:47], v7, s[84:87], s29 offen offset:3072 sc1
s_mov_b64 exec, -1
s_branch mega_kernel_rs_pc_15_0
.p2align 5
mega_kernel_rs_pc_15_3:
s_waitcnt vmcnt(3)
v_cmp_eq_u32 vcc, -1, v44
s_cbranch_vccnz mega_kernel_rs_pc_15_3f
v_smfmac_f32_16x16x64_bf16 v[96:99], v[44:47], a[216:223], v6
v_smfmac_f32_16x16x64_bf16 v[100:103], v[44:47], a[248:255], v6
s_branch mega_kernel_rs_pc_7_0
mega_kernel_rs_w0last:
s_nop 7
v_permlane32_swap_b32 v112, v116
v_permlane32_swap_b32 v113, v117
v_permlane32_swap_b32 v114, v118
v_permlane32_swap_b32 v115, v119
v_pk_add_f32 v[112:113], v[112:113], v[116:117]
v_pk_add_f32 v[114:115], v[114:115], v[118:119]
ds_write_b128 v20, v[112:115]
s_waitcnt lgkmcnt(0)
s_barrier
s_branch mega_kernel_rs_end
mega_kernel_rs_side:
s_cmp_eq_u32 s24, 3
s_cbranch_scc1 mega_kernel_rs_sd3
s_cmp_eq_u32 s24, 2
s_cbranch_scc0 mega_kernel_rs_sd4
s_mov_b64 exec, s[40:41]
buffer_store_dwordx4 v[28:31], v11, s[84:87], s34 offen sc1
s_mov_b64 exec, -1
buffer_store_dwordx2 v[28:29], v9, s[84:87], s34 offen sc1
s_mul_i32 s28, s31, 2048
s_add_u32 s28, s28, s34
s_add_u32 s28, s28, 49152
buffer_store_dwordx4 v[28:31], v17, s[84:87], s28 offen sc1
buffer_store_dwordx4 v[28:31], v10, s[84:87], s28 offen sc1
s_branch mega_kernel_rs_sd4
mega_kernel_rs_sd3:
v_readlane_b32 s76, v249, 0
v_readlane_b32 s77, v249, 1
s_min_i32 s76, s76, s77
s_max_i32 s46, s46, s76
s_mov_b32 s36, 0
s_add_u32 s76, s27, 1
s_cmp_lt_u32 s76, 63
s_cbranch_scc0 mega_kernel_rs_sd4
s_cmp_ge_u32 s76, 0
s_cbranch_scc0 mega_kernel_rs_sd4
s_cmp_gt_i32 s46, s76
s_cselect_b32 s36, 0, 1
s_cbranch_scc0 mega_kernel_rs_sd4
s_add_u32 s77, s76, s82
s_bfe_u32 s28, s77, 0x40002
s_lshl_b32 s28, s28, 14
s_and_b32 s77, s77, 3
s_lshl_b32 s77, s77, 11
s_add_u32 s28, s28, s77
s_add_u32 m0, s45, 0
s_nop 0
buffer_load_dwordx4 v240, s[84:87], s28 offen offset:0 sc1 lds
s_add_u32 m0, s45, 0
s_nop 0
buffer_load_dwordx4 v240, s[84:87], s28 offen offset:1024 sc1 lds
s_add_u32 m0, s45, 2048
s_nop 0
buffer_load_dwordx4 v241, s[84:87], s28 offen offset:0 sc1 lds
s_add_u32 m0, s45, 2048
s_nop 0
buffer_load_dwordx4 v241, s[84:87], s28 offen offset:1024 sc1 lds
s_add_u32 s45, s45, 4096
s_cmp_eq_u32 s45, 30720
s_cselect_b32 s45, 18432, s45
mega_kernel_rs_sd4:
v_smfmac_f32_16x16x64_bf16 v[112:115], v[40:43], a[144:151], v6
v_smfmac_f32_16x16x64_bf16 v[116:119], v[40:43], a[176:183], v6
v_smfmac_f32_16x16x64_bf16 v[112:115], v[44:47], a[152:159], v6
v_smfmac_f32_16x16x64_bf16 v[116:119], v[44:47], a[184:191], v6
s_nop 7
v_permlane32_swap_b32 v112, v116
v_permlane32_swap_b32 v113, v117
v_permlane32_swap_b32 v114, v118
v_permlane32_swap_b32 v115, v119
v_pk_add_f32 v[112:113], v[112:113], v[116:117]
v_pk_add_f32 v[114:115], v[114:115], v[118:119]
ds_write_b128 v20, v[112:115]
v_mov_b32 v96, 0
v_mov_b32 v97, 0
v_mov_b32 v98, 0
v_mov_b32 v99, 0
v_mov_b32 v100, 0
v_mov_b32 v101, 0
v_mov_b32 v102, 0
v_mov_b32 v103, 0
s_cmp_eq_u32 s24, 1
s_cbranch_scc0 mega_kernel_rs_s1
s_waitcnt lgkmcnt(0)
ds_read_b128 v[120:123], v16 offset:0
ds_read_b128 v[124:127], v16 offset:16
ds_read_b128 v[128:131], v16 offset:2304
ds_read_b128 v[132:135], v16 offset:2320
ds_read_b128 v[136:139], v16 offset:4608
ds_read_b128 v[140:143], v16 offset:4624
ds_read_b128 v[144:147], v16 offset:6912
ds_read_b128 v[148:151], v16 offset:6928
s_waitcnt lgkmcnt(4)
v_pk_add_f32 v[120:121], v[120:121], v[128:129]
v_pk_add_f32 v[122:123], v[122:123], v[130:131]
v_pk_add_f32 v[124:125], v[124:125], v[132:133]
v_pk_add_f32 v[126:127], v[126:127], v[134:135]
s_waitcnt lgkmcnt(0)
v_pk_add_f32 v[136:137], v[136:137], v[144:145]
v_pk_add_f32 v[138:139], v[138:139], v[146:147]
v_pk_add_f32 v[140:141], v[140:141], v[148:149]
v_pk_add_f32 v[142:143], v[142:143], v[150:151]
v_pk_add_f32 v[120:121], v[120:121], v[136:137]
v_pk_add_f32 v[122:123], v[122:123], v[138:139]
v_pk_add_f32 v[124:125], v[124:125], v[140:141]
v_pk_add_f32 v[126:127], v[126:127], v[142:143]
v_cvt_pk_bf16_f32 v244, v120, v121
v_cvt_pk_bf16_f32 v245, v122, v123
v_cvt_pk_bf16_f32 v246, v124, v125
v_cvt_pk_bf16_f32 v247, v126, v127
mega_kernel_rs_s1:
v_add_u32 v5, 9216, v17
s_waitcnt lgkmcnt(0)
s_barrier
s_cmp_eq_u32 s24, 2
s_cbranch_scc1 mega_kernel_rs_s2
s_cmp_eq_u32 s24, 3
s_cbranch_scc0 mega_kernel_rs_s3
s_add_u32 s76, s27, 2
s_cmp_lt_u32 s76, 63
s_cbranch_scc0 mega_kernel_rs_s3
s_cmp_gt_i32 s46, s76
s_cbranch_scc0 mega_kernel_rs_s3
s_add_u32 s77, s76, s82
s_bfe_u32 s28, s77, 0x40002
s_lshl_b32 s28, s28, 14
s_and_b32 s77, s77, 3
s_lshl_b32 s77, s77, 11
s_add_u32 s28, s28, s77
s_add_u32 s28, s28, s83
s_buffer_load_dword s78, s[84:87], s28 offset:0
s_buffer_load_dword s78, s[84:87], s28 offset:128
s_buffer_load_dword s78, s[84:87], s28 offset:256
s_buffer_load_dword s78, s[84:87], s28 offset:384
s_buffer_load_dword s78, s[84:87], s28 offset:512
s_buffer_load_dword s78, s[84:87], s28 offset:640
s_buffer_load_dword s78, s[84:87], s28 offset:768
s_buffer_load_dword s78, s[84:87], s28 offset:896
s_buffer_load_dword s78, s[84:87], s28 offset:1024
s_buffer_load_dword s78, s[84:87], s28 offset:1152
s_buffer_load_dword s78, s[84:87], s28 offset:1280
s_buffer_load_dword s78, s[84:87], s28 offset:1408
s_buffer_load_dword s78, s[84:87], s28 offset:1536
s_buffer_load_dword s78, s[84:87], s28 offset:1664
s_buffer_load_dword s78, s[84:87], s28 offset:1792
s_buffer_load_dword s78, s[84:87], s28 offset:1920
s_mov_b32 s88, s76
s_branch mega_kernel_rs_s3
mega_kernel_rs_s2:
ds_read_b128 v[120:123], v5 offset:0
ds_read_b128 v[124:127], v5 offset:1024
ds_read_b128 v[128:131], v5 offset:2048
ds_read_b128 v[132:135], v5 offset:3072
v_lshrrev_b32 v5, 1, v17
s_waitcnt lgkmcnt(2)
v_pk_add_f32 v[120:121], v[120:121], v[124:125]
v_pk_add_f32 v[122:123], v[122:123], v[126:127]
s_waitcnt lgkmcnt(0)
v_pk_add_f32 v[128:129], v[128:129], v[132:133]
v_pk_add_f32 v[130:131], v[130:131], v[134:135]
v_pk_add_f32 v[120:121], v[120:121], v[128:129]
v_pk_add_f32 v[122:123], v[122:123], v[130:131]
v_cvt_pk_bf16_f32 v244, v120, v121
v_cvt_pk_bf16_f32 v245, v122, v123
ds_write_b64 v5, v[244:245] offset:17920
s_waitcnt lgkmcnt(0) vmcnt(0)
mega_kernel_rs_s3:
s_cmp_eq_u32 s27, 63
s_cbranch_scc1 mega_kernel_rs_slast
s_add_u32 s29, s33, 24576
s_barrier
s_cmp_eq_u32 s24, 3
s_cbranch_scc1 mega_kernel_rs_y3
s_add_u32 s77, s27, s82
s_bfe_u32 s28, s77, 0x30003
s_lshl_b32 s28, s28, 14
s_and_b32 s77, s77, 7
s_lshl_b32 s77, s77, 10
s_add_u32 s28, s28, s77
s_add_u32 s28, s28, s79
s_cmp_eq_u32 s24, 2
s_cbranch_scc1 mega_kernel_rs_kv2a
s_mov_b64 exec, s[48:49]
buffer_store_dwordx4 v[244:247], v22, s[84:87], s28 offen sc1
s_mov_b64 exec, -1
s_branch mega_kernel_rs_kvda
mega_kernel_rs_kv2a:
v_lshlrev_b32 v4, 3, v1
buffer_store_dwordx2 v[244:245], v4, s[84:87], s28 offen offset:512 sc1
mega_kernel_rs_kvda:
s_branch mega_kernel_rs_y4
mega_kernel_rs_y3:
s_add_u32 s76, s27, 2
s_cmp_lt_u32 s76, 63
s_cbranch_scc0 mega_kernel_rs_y4
mega_kernel_rs_y4:
s_branch mega_kernel_rs_b3
mega_kernel_rs_first:
buffer_load_dwordx4 v[32:35], v8, s[20:23], 0 offen offset:0
buffer_load_dwordx4 v[36:39], v8, s[20:23], 0 offen offset:128
buffer_load_dwordx4 v[40:43], v8, s[20:23], 0 offen offset:256
buffer_load_dwordx4 v[44:47], v8, s[20:23], 0 offen offset:384
v_add_u32 v5, s44, v17
ds_read_b128 v[156:159], v5 offset:0
ds_read_b128 v[160:163], v5 offset:1024
ds_read_b128 v[164:167], v5 offset:2048
ds_read_b128 v[168:171], v5 offset:3072
s_waitcnt vmcnt(0)
v_smfmac_f32_16x16x64_bf16 v[96:99], v[32:35], a[0:7], v6
v_smfmac_f32_16x16x64_bf16 v[100:103], v[32:35], a[32:39], v6
v_smfmac_f32_16x16x64_bf16 v[104:107], v[32:35], a[64:71], v6
v_smfmac_f32_16x16x64_bf16 v[108:111], v[32:35], a[96:103], v6
v_smfmac_f32_16x16x64_bf16 v[96:99], v[36:39], a[8:15], v6
v_smfmac_f32_16x16x64_bf16 v[100:103], v[36:39], a[40:47], v6
v_smfmac_f32_16x16x64_bf16 v[104:107], v[36:39], a[72:79], v6
v_smfmac_f32_16x16x64_bf16 v[108:111], v[36:39], a[104:111], v6
v_smfmac_f32_16x16x64_bf16 v[96:99], v[40:43], a[16:23], v6
v_smfmac_f32_16x16x64_bf16 v[100:103], v[40:43], a[48:55], v6
v_smfmac_f32_16x16x64_bf16 v[104:107], v[40:43], a[80:87], v6
v_smfmac_f32_16x16x64_bf16 v[108:111], v[40:43], a[112:119], v6
v_smfmac_f32_16x16x64_bf16 v[96:99], v[44:47], a[24:31], v6
v_smfmac_f32_16x16x64_bf16 v[100:103], v[44:47], a[56:63], v6
v_smfmac_f32_16x16x64_bf16 v[104:107], v[44:47], a[88:95], v6
v_smfmac_f32_16x16x64_bf16 v[108:111], v[44:47], a[120:127], v6
s_nop 1
s_branch mega_kernel_rs_adone
mega_kernel_rs_slast:
s_cmp_eq_u32 s24, 3
s_cbranch_scc1 mega_kernel_rs_end
s_add_u32 s77, s27, s82
s_bfe_u32 s28, s77, 0x30003
s_lshl_b32 s28, s28, 14
s_and_b32 s77, s77, 7
s_lshl_b32 s77, s77, 10
s_add_u32 s28, s28, s77
s_add_u32 s28, s28, s79
s_cmp_eq_u32 s24, 2
s_cbranch_scc1 mega_kernel_rs_kv2b
s_mov_b64 exec, s[48:49]
buffer_store_dwordx4 v[244:247], v22, s[84:87], s28 offen sc1
s_mov_b64 exec, -1
s_branch mega_kernel_rs_kvdb
mega_kernel_rs_kv2b:
v_lshlrev_b32 v4, 3, v1
buffer_store_dwordx2 v[244:245], v4, s[84:87], s28 offen offset:512 sc1
mega_kernel_rs_kvdb:
s_waitcnt vmcnt(0)
s_barrier
s_mov_b32 s76, 64
s_cmp_eq_u32 s24, 1
s_cbranch_scc0 mega_kernel_rs_end
v_mov_b32 v5, s76
s_mov_b64 exec, 1
buffer_store_dword v5, v228, s[84:87], s81 offen sc1
s_mov_b64 exec, -1
mega_kernel_rs_end:
s_endpgm
.section .rodata,"a"
.p2align 6
.amdhsa_kernel mega_kernel
  .amdhsa_next_free_vgpr 512
  .amdhsa_next_free_sgpr 102
  .amdhsa_accum_offset 256
  .amdhsa_group_segment_fixed_size 0
  .amdhsa_kernarg_size 104
  .amdhsa_user_sgpr_count 2
  .amdhsa_user_sgpr_kernarg_segment_ptr 1
  .amdhsa_system_sgpr_workgroup_id_x 1
.end_amdhsa_kernel
```

```asm
; @launch kernel=mega_kernel grid=(256,1,1) block=(256,1,1) lds=163840
.amdgcn_target "amdgcn-amd-amdhsa--gfx950"
.text
.globl mega_kernel
.p2align 8
.type mega_kernel,@function
mega_kernel:
s_cmp_ge_u32 s2, 256
s_cbranch_scc1 mega_kernel_exit
s_load_dwordx2 s[84:85], s[0:1], 96
s_load_dwordx2 s[72:73], s[0:1], 88
s_getreg_b32 s90, hwreg(HW_REG_XCC_ID)
s_and_b32 s90, s90, 7
v_mov_b32 v1, 0
v_mov_b32 v2, 1
s_lshl_b32 s91, s90, 4
s_mov_b32 s95, 0
s_mov_b32 s99, 0
s_waitcnt lgkmcnt(0)
s_mov_b32 s86, 268435456
s_mov_b32 s87, 0x00020000
s_mov_b32 s74, 256
s_mov_b32 s75, 0x00020000
v_cmp_eq_u32 vcc, 0, v0
s_and_saveexec_b64 s[88:89], vcc
s_cbranch_execz mega_kernel_tkd
s_lshl_b32 s92, s2, 13
s_add_u32 s92, s92, 167772160
buffer_atomic_add v2, v1, s[72:75], s91 offen sc0
buffer_load_dword v251, v1, s[84:87], s92 offen offset:2048 sc1
s_waitcnt vmcnt(1)
ds_write_b32 v1, v2
s_waitcnt lgkmcnt(0)
mega_kernel_tkd:
s_mov_b64 exec, s[88:89]
s_barrier
ds_read_b32 v2, v1
s_waitcnt lgkmcnt(0)
v_readfirstlane_b32 s96, v2
s_barrier
s_cmp_lt_u32 s96, 32
s_cbranch_scc1 mega_kernel_spec
v_and_b32 v3, 15, v0
v_lshlrev_b32 v3, 4, v3
s_branch mega_kernel_syx
mega_kernel_syxw:
s_sleep 4
mega_kernel_syx:
buffer_load_dword v2, v3, s[72:75], 0 offen sc1
s_waitcnt vmcnt(0)
mega_kernel_syxp:
s_cmp_eq_u32 s95, 1
s_cbranch_scc0 mega_kernel_syxf
v_readlane_b32 s76, v2, 14
s_mov_b32 s98, 0
s_cmp_eq_u32 s76, 32
s_cbranch_scc0 mega_kernel_syxw
s_branch mega_kernel_syxd
mega_kernel_syxf:
s_mov_b32 s77, 0
s_mov_b32 s78, 0
v_readlane_b32 s76, v2, 0
s_add_u32 s77, s77, s76
s_xor_b32 s76, s76, 32
s_or_b32 s78, s78, s76
v_readlane_b32 s76, v2, 1
s_add_u32 s77, s77, s76
s_xor_b32 s76, s76, 32
s_or_b32 s78, s78, s76
v_readlane_b32 s76, v2, 2
s_add_u32 s77, s77, s76
s_xor_b32 s76, s76, 32
s_or_b32 s78, s78, s76
v_readlane_b32 s76, v2, 3
s_add_u32 s77, s77, s76
s_xor_b32 s76, s76, 32
s_or_b32 s78, s78, s76
v_readlane_b32 s76, v2, 4
s_add_u32 s77, s77, s76
s_xor_b32 s76, s76, 32
s_or_b32 s78, s78, s76
v_readlane_b32 s76, v2, 5
s_add_u32 s77, s77, s76
s_xor_b32 s76, s76, 32
s_or_b32 s78, s78, s76
v_readlane_b32 s76, v2, 6
s_add_u32 s77, s77, s76
s_xor_b32 s76, s76, 32
s_or_b32 s78, s78, s76
v_readlane_b32 s76, v2, 7
s_add_u32 s77, s77, s76
s_xor_b32 s76, s76, 32
s_or_b32 s78, s78, s76
s_cmp_eq_u32 s77, 256
s_cbranch_scc0 mega_kernel_syxw
v_mov_b32 v252, v2
s_cmp_eq_u32 s78, 0
s_cbranch_scc0 mega_kernel_slowent
v_readlane_b32 s76, v2, 10
v_readlane_b32 s77, v2, 8
s_cmp_eq_u32 s76, 32
s_cbranch_scc0 mega_kernel_syxw
s_cmp_gt_u32 s77, 16
s_cselect_b32 s98, 1, 0
mega_kernel_syxd:
mega_kernel_slowent:
s_mov_b64 exec, -1
s_waitcnt vmcnt(0) lgkmcnt(0)
s_barrier
s_mov_b32 s97, s96
v_readlane_b32 s76, v252, 0
s_cmp_gt_u32 s90, 0
s_cselect_b32 s76, s76, 0
s_add_u32 s97, s97, s76
v_readlane_b32 s76, v252, 1
s_cmp_gt_u32 s90, 1
s_cselect_b32 s76, s76, 0
s_add_u32 s97, s97, s76
v_readlane_b32 s76, v252, 2
s_cmp_gt_u32 s90, 2
s_cselect_b32 s76, s76, 0
s_add_u32 s97, s97, s76
v_readlane_b32 s76, v252, 3
s_cmp_gt_u32 s90, 3
s_cselect_b32 s76, s76, 0
s_add_u32 s97, s97, s76
v_readlane_b32 s76, v252, 4
s_cmp_gt_u32 s90, 4
s_cselect_b32 s76, s76, 0
s_add_u32 s97, s97, s76
v_readlane_b32 s76, v252, 5
s_cmp_gt_u32 s90, 5
s_cselect_b32 s76, s76, 0
s_add_u32 s97, s97, s76
v_readlane_b32 s76, v252, 6
s_cmp_gt_u32 s90, 6
s_cselect_b32 s76, s76, 0
s_add_u32 s97, s97, s76
v_mov_b32 v1, 0
v_mov_b32 v2, 1
v_cmp_eq_u32 vcc, 0, v0
s_and_saveexec_b64 s[88:89], vcc
s_cbranch_execz mega_kernel_sb1
buffer_atomic_add v2, v1, s[72:75], 0 offen offset:192 sc1
mega_kernel_sb1:
s_mov_b64 exec, s[88:89]
mega_kernel_sb2:
s_sleep 4
buffer_load_dword v2, v1, s[72:75], 0 offen offset:192 sc1
s_waitcnt vmcnt(0)
v_cmp_ne_u32 vcc, 256, v2
s_cbranch_vccnz mega_kernel_sb2
s_mov_b32 s95, 1
s_lshr_b32 s30, s97, 5
s_and_b32 s31, s97, 31
s_cmp_lt_u32 s97, 128
s_cbranch_scc1 mega_kernel_recs
s_sub_u32 s94, s97, 128
s_branch mega_kernel_bulk
mega_kernel_spec:
s_mov_b32 s30, s90
s_mov_b32 s31, s96
s_cmp_lt_u32 s90, 4
s_cbranch_scc1 mega_kernel_recf
s_sub_u32 s94, s90, 4
s_lshl_b32 s94, s94, 5
s_add_u32 s94, s94, s96
mega_kernel_bulk:
s_lshr_b32 s91, s94, 5
s_and_b32 s40, s94, 31
s_and_b32 s92, s91, 1
s_lshl_b32 s92, s92, 5
s_add_u32 s92, s92, s40
s_cmp_eq_u32 s91, 0
s_cbranch_scc1 mega_kernel_rk
s_cmp_eq_u32 s91, 1
s_cbranch_scc1 mega_kernel_rv
s_cmp_eq_u32 s91, 2
s_cbranch_scc1 mega_kernel_noinit
v_mov_b32 v8, -1
v_mov_b32 v9, -1
v_mov_b32 v10, -1
v_mov_b32 v11, -1
v_lshlrev_b32 v1, 4, v0
v_mov_b32 v2, 0
v_cmp_gt_u32 vcc, 64, v0
s_cbranch_vccz mega_kernel_nv
s_cmp_eq_u32 s95, 0
s_cbranch_scc0 mega_kernel_nv
s_lshr_b32 s60, s2, 1
s_lshl_b32 s60, s60, 14
s_and_b32 s61, s40, 1
s_lshl_b32 s66, s61, 13
s_add_u32 s60, s60, s66
s_and_b32 s66, s2, 1
s_lshl_b32 s66, s66, 10
s_add_u32 s60, s60, s66
s_add_u32 s60, s60, 167772160
s_mov_b32 s66, 0x7fffffff
s_mov_b32 s67, 0x7fffffff
s_mov_b64 exec, 0xff
s_waitcnt vmcnt(0)
s_memtime s[62:63]
s_waitcnt lgkmcnt(0)
buffer_store_dwordx4 v[8:11], v1, s[84:87], s60 offen offset:0 sc1
s_waitcnt vmcnt(0)
s_memtime s[64:65]
s_xor_b32 s60, s60, 8192
s_waitcnt lgkmcnt(0)
s_sub_u32 s64, s64, s62
s_min_u32 s66, s66, s64
s_memtime s[62:63]
s_waitcnt lgkmcnt(0)
buffer_store_dwordx4 v[8:11], v1, s[84:87], s60 offen offset:0 sc1
s_waitcnt vmcnt(0)
s_memtime s[64:65]
s_xor_b32 s60, s60, 8192
s_waitcnt lgkmcnt(0)
s_sub_u32 s64, s64, s62
s_min_u32 s67, s67, s64
s_memtime s[62:63]
s_waitcnt lgkmcnt(0)
buffer_store_dwordx4 v[8:11], v1, s[84:87], s60 offen offset:256 sc1
s_waitcnt vmcnt(0)
s_memtime s[64:65]
s_xor_b32 s60, s60, 8192
s_waitcnt lgkmcnt(0)
s_sub_u32 s64, s64, s62
s_min_u32 s66, s66, s64
s_memtime s[62:63]
s_waitcnt lgkmcnt(0)
buffer_store_dwordx4 v[8:11], v1, s[84:87], s60 offen offset:256 sc1
s_waitcnt vmcnt(0)
s_memtime s[64:65]
s_xor_b32 s60, s60, 8192
s_waitcnt lgkmcnt(0)
s_sub_u32 s64, s64, s62
s_min_u32 s67, s67, s64
s_cmp_lt_u32 s67, s66
s_cselect_b32 s60, 1, 0
s_xor_b32 s60, s60, s61
s_lshr_b32 s61, s90, 2
s_xor_b32 s60, s60, s61
v_mov_b32 v3, s60
s_mov_b64 exec, 1
buffer_atomic_add v3, v2, s[72:75], 0 offen offset:128 sc1
s_mov_b64 exec, -1
mega_kernel_nv:
s_barrier
s_lshl_b32 s60, s40, 12
s_add_u32 s60, s60, 67108864
buffer_store_dwordx4 v[8:11], v1, s[84:87], s60 offen sc1
s_add_u32 s60, s60, 131072
buffer_store_dwordx4 v[8:11], v1, s[84:87], s60 offen sc1
s_add_u32 s60, s60, 131072
buffer_store_dwordx4 v[8:11], v1, s[84:87], s60 offen sc1
s_add_u32 s60, s60, 131072
buffer_store_dwordx4 v[8:11], v1, s[84:87], s60 offen sc1
s_add_u32 s60, s60, 131072
buffer_store_dwordx4 v[8:11], v1, s[84:87], s60 offen sc1
s_add_u32 s60, s60, 131072
buffer_store_dwordx4 v[8:11], v1, s[84:87], s60 offen sc1
s_add_u32 s60, s60, 131072
buffer_store_dwordx4 v[8:11], v1, s[84:87], s60 offen sc1
s_add_u32 s60, s60, 131072
buffer_store_dwordx4 v[8:11], v1, s[84:87], s60 offen sc1
s_add_u32 s60, s60, 131072
buffer_store_dwordx4 v[8:11], v1, s[84:87], s60 offen sc1
s_add_u32 s60, s60, 131072
buffer_store_dwordx4 v[8:11], v1, s[84:87], s60 offen sc1
s_add_u32 s60, s60, 131072
buffer_store_dwordx4 v[8:11], v1, s[84:87], s60 offen sc1
s_add_u32 s60, s60, 131072
buffer_store_dwordx4 v[8:11], v1, s[84:87], s60 offen sc1
s_add_u32 s60, s60, 131072
buffer_store_dwordx4 v[8:11], v1, s[84:87], s60 offen sc1
s_add_u32 s60, s60, 131072
buffer_store_dwordx4 v[8:11], v1, s[84:87], s60 offen sc1
s_add_u32 s60, s60, 131072
buffer_store_dwordx4 v[8:11], v1, s[84:87], s60 offen sc1
s_add_u32 s60, s60, 131072
buffer_store_dwordx4 v[8:11], v1, s[84:87], s60 offen sc1
s_add_u32 s60, s60, 131072
s_lshr_b32 s62, s40, 1
s_and_b32 s63, s40, 1
s_add_u32 s63, s63, s62
s_lshl_b32 s62, s62, 19
s_and_b32 s64, s63, 14
s_lshl_b32 s64, s64, 13
s_add_u32 s62, s62, s64
s_and_b32 s64, s63, 1
s_lshl_b32 s64, s64, 12
s_add_u32 s62, s62, s64
s_add_u32 s62, s62, 150994944
s_add_u32 s62, s62, 8192
s_cmp_lt_u32 s40, 16
s_cbranch_scc0 mega_kernel_pz
buffer_store_dwordx4 v[8:11], v1, s[84:87], s60 offen sc1
mega_kernel_pz:
s_waitcnt vmcnt(0)
s_barrier
v_mov_b32 v3, 1
s_lshl_b32 s62, s95, 6
v_cmp_eq_u32 vcc, 0, v0
s_and_saveexec_b64 s[60:61], vcc
s_cbranch_execz mega_kernel_xps
buffer_atomic_add v3, v2, s[72:75], s62 offen offset:160 sc1
mega_kernel_xps:
s_mov_b64 exec, s[60:61]
mega_kernel_noinit:
s_cmp_eq_u32 s91, 2
s_cbranch_scc0 mega_kernel_rd
s_load_dwordx2 s[4:5], s[0:1], 16
s_load_dwordx2 s[8:9], s[0:1], 0
v_lshrrev_b32 v2, 6, v0
v_and_b32 v1, 63, v0
v_readfirstlane_b32 s41, v2
v_lshlrev_b32 v5, 4, v1
s_waitcnt lgkmcnt(0)
s_mov_b32 s6, 8388608
s_mov_b32 s7, 0x00020000
s_mov_b32 s10, 4194304
s_mov_b32 s11, 0x00020000
s_lshl_b32 s43, s40, 8
s_lshl_b32 s44, s41, 6
s_add_u32 s48, s43, s44
s_and_b32 s43, s48, 0x7ff
v_add_u32 v19, s43, v1
v_lshlrev_b32 v19, 7, v19
s_mov_b32 s43, 0
buffer_load_dword v250, v19, s[8:11], s43 offen
s_nop 0
v_lshrrev_b32 v2, 3, v1
s_lshl_b32 s43, s41, 3
v_add_u32 v2, s43, v2
v_bfe_u32 v3, v2, 1, 3
v_and_b32 v4, 7, v1
v_xor_b32 v3, v3, v4
v_lshlrev_b32 v6, 11, v2
v_lshl_add_u32 v6, v3, 4, v6
s_lshl_b32 s46, s41, 10
v_and_b32 v2, 15, v1
v_bfe_u32 v3, v2, 1, 3
v_lshrrev_b32 v4, 4, v1
v_xor_b32 v3, v3, v4
v_lshlrev_b32 v8, 7, v2
v_lshl_add_u32 v8, v3, 4, v8
v_xor_b32 v9, 64, v8
v_add_u32 v10, 0x10000, v8
v_add_u32 v11, 0x10000, v9
v_mov_b32 v7, v5
s_lshl_b32 s47, s40, 2
s_add_u32 s47, s47, s41
s_mov_b32 s42, 0
s_mov_b32 s50, 0
s_add_u32 m0, s46, 0
s_nop 0
buffer_load_dwordx4 v6, s[8:11], s50 offen offset:0 lds
s_add_u32 m0, s46, 3968
s_nop 0
buffer_load_dwordx4 v6, s[8:11], s50 offen offset:128 lds
s_add_u32 m0, s46, 7936
s_nop 0
buffer_load_dwordx4 v6, s[8:11], s50 offen offset:256 lds
s_add_u32 m0, s46, 11904
s_nop 0
buffer_load_dwordx4 v6, s[8:11], s50 offen offset:384 lds
s_add_u32 m0, s46, 15872
s_nop 0
buffer_load_dwordx4 v6, s[8:11], s50 offen offset:512 lds
s_add_u32 m0, s46, 19840
s_nop 0
buffer_load_dwordx4 v6, s[8:11], s50 offen offset:640 lds
s_add_u32 m0, s46, 23808
s_nop 0
buffer_load_dwordx4 v6, s[8:11], s50 offen offset:768 lds
s_add_u32 m0, s46, 27776
s_nop 0
buffer_load_dwordx4 v6, s[8:11], s50 offen offset:896 lds
s_add_u32 m0, s46, 31744
s_nop 0
buffer_load_dwordx4 v6, s[8:11], s50 offen offset:1024 lds
s_add_u32 m0, s46, 35712
s_nop 0
buffer_load_dwordx4 v6, s[8:11], s50 offen offset:1152 lds
s_add_u32 m0, s46, 39680
s_nop 0
buffer_load_dwordx4 v6, s[8:11], s50 offen offset:1280 lds
s_add_u32 m0, s46, 43648
s_nop 0
buffer_load_dwordx4 v6, s[8:11], s50 offen offset:1408 lds
s_add_u32 m0, s46, 47616
s_nop 0
buffer_load_dwordx4 v6, s[8:11], s50 offen offset:1536 lds
s_add_u32 m0, s46, 51584
s_nop 0
buffer_load_dwordx4 v6, s[8:11], s50 offen offset:1664 lds
s_add_u32 m0, s46, 55552
s_nop 0
buffer_load_dwordx4 v6, s[8:11], s50 offen offset:1792 lds
s_add_u32 m0, s46, 59520
s_nop 0
buffer_load_dwordx4 v6, s[8:11], s50 offen offset:1920 lds
v_lshrrev_b32 v2, 2, v1
v_and_b32 v3, 3, v1
v_lshlrev_b32 v16, 13, v2
v_lshl_add_u32 v16, v3, 4, v16
v_add_u32 v16, s48, v16
s_mul_i32 s45, s41, 24576
s_add_u32 s45, s45, 65536
v_bfe_u32 v17, v1, 2, 2
v_lshrrev_b32 v18, 4, v1
v_lshl_add_u32 v17, v18, 3, v17
v_lshlrev_b32 v17, 6, v17
v_lshl_add_u32 v17, v3, 4, v17
v_add_u32 v17, s45, v17
s_and_b32 s43, s40, 3
s_lshl_b32 s43, s43, 2
s_add_u32 s43, s43, s41
s_lshl_b32 s43, s43, 3
v_and_b32 v12, 7, v1
v_add_u32 v12, s43, v12
s_lshr_b32 s43, s40, 2
s_lshl_b32 s43, s43, 10
s_add_u32 s44, s43, 896
s_add_u32 s43, s43, 384
s_cmp_ge_u32 s40, 28
s_cselect_b32 s44, s44, s43
v_mov_b32 v13, s43
v_mov_b32 v14, s44
v_cmp_gt_u32 vcc, 32, v1
s_nop 1
v_cndmask_b32 v13, v14, v13, vcc
v_lshl_add_u32 v12, v12, 13, v13
s_mov_b32 s44, 0
buffer_load_dword v250, v12, s[4:7], s44 offen
s_add_u32 m0, s45, 0
s_mov_b32 s44, 0
buffer_load_dwordx4 v16, s[4:7], s44 offen lds
s_add_u32 m0, s45, 1024
s_mov_b32 s44, 131072
buffer_load_dwordx4 v16, s[4:7], s44 offen lds
s_add_u32 m0, s45, 2048
s_mov_b32 s44, 262144
buffer_load_dwordx4 v16, s[4:7], s44 offen lds
s_add_u32 m0, s45, 3072
s_mov_b32 s44, 393216
buffer_load_dwordx4 v16, s[4:7], s44 offen lds
s_add_u32 m0, s45, 4096
s_mov_b32 s44, 524288
buffer_load_dwordx4 v16, s[4:7], s44 offen lds
s_add_u32 m0, s45, 5120
s_mov_b32 s44, 655360
buffer_load_dwordx4 v16, s[4:7], s44 offen lds
s_add_u32 m0, s45, 6144
s_mov_b32 s44, 786432
buffer_load_dwordx4 v16, s[4:7], s44 offen lds
s_add_u32 m0, s45, 7168
s_mov_b32 s44, 917504
buffer_load_dwordx4 v16, s[4:7], s44 offen lds
s_mov_b32 s44, 1048576
buffer_load_dword v250, v12, s[4:7], s44 offen
s_add_u32 m0, s45, 8192
s_mov_b32 s44, 1048576
buffer_load_dwordx4 v16, s[4:7], s44 offen lds
s_add_u32 m0, s45, 9216
s_mov_b32 s44, 1179648
buffer_load_dwordx4 v16, s[4:7], s44 offen lds
s_add_u32 m0, s45, 10240
s_mov_b32 s44, 1310720
buffer_load_dwordx4 v16, s[4:7], s44 offen lds
s_add_u32 m0, s45, 11264
s_mov_b32 s44, 1441792
buffer_load_dwordx4 v16, s[4:7], s44 offen lds
s_add_u32 m0, s45, 12288
s_mov_b32 s44, 1572864
buffer_load_dwordx4 v16, s[4:7], s44 offen lds
s_add_u32 m0, s45, 13312
s_mov_b32 s44, 1703936
buffer_load_dwordx4 v16, s[4:7], s44 offen lds
s_add_u32 m0, s45, 14336
s_mov_b32 s44, 1835008
buffer_load_dwordx4 v16, s[4:7], s44 offen lds
s_add_u32 m0, s45, 15360
s_mov_b32 s44, 1966080
buffer_load_dwordx4 v16, s[4:7], s44 offen lds
s_mov_b32 s44, 2097152
buffer_load_dword v250, v12, s[4:7], s44 offen
s_add_u32 m0, s45, 16384
s_mov_b32 s44, 2097152
buffer_load_dwordx4 v16, s[4:7], s44 offen lds
s_add_u32 m0, s45, 17408
s_mov_b32 s44, 2228224
buffer_load_dwordx4 v16, s[4:7], s44 offen lds
s_add_u32 m0, s45, 18432
s_mov_b32 s44, 2359296
buffer_load_dwordx4 v16, s[4:7], s44 offen lds
s_add_u32 m0, s45, 19456
s_mov_b32 s44, 2490368
buffer_load_dwordx4 v16, s[4:7], s44 offen lds
s_add_u32 m0, s45, 20480
s_mov_b32 s44, 2621440
buffer_load_dwordx4 v16, s[4:7], s44 offen lds
s_add_u32 m0, s45, 21504
s_mov_b32 s44, 2752512
buffer_load_dwordx4 v16, s[4:7], s44 offen lds
s_add_u32 m0, s45, 22528
s_mov_b32 s44, 2883584
buffer_load_dwordx4 v16, s[4:7], s44 offen lds
s_add_u32 m0, s45, 23552
s_mov_b32 s44, 3014656
buffer_load_dwordx4 v16, s[4:7], s44 offen lds
s_waitcnt vmcnt(18)
s_barrier
ds_read_b64_tr_b16 a[0:1], v17 offset:0
ds_read_b64_tr_b16 a[2:3], v17 offset:256
ds_read_b64_tr_b16 a[4:5], v17 offset:8
ds_read_b64_tr_b16 a[6:7], v17 offset:264
ds_read_b64_tr_b16 a[8:9], v17 offset:2048
ds_read_b64_tr_b16 a[10:11], v17 offset:2304
ds_read_b64_tr_b16 a[12:13], v17 offset:2056
ds_read_b64_tr_b16 a[14:15], v17 offset:2312
s_waitcnt lgkmcnt(0)
ds_read_b64_tr_b16 a[16:17], v17 offset:4096
ds_read_b64_tr_b16 a[18:19], v17 offset:4352
ds_read_b64_tr_b16 a[20:21], v17 offset:4104
ds_read_b64_tr_b16 a[22:23], v17 offset:4360
ds_read_b64_tr_b16 a[24:25], v17 offset:6144
ds_read_b64_tr_b16 a[26:27], v17 offset:6400
ds_read_b64_tr_b16 a[28:29], v17 offset:6152
ds_read_b64_tr_b16 a[30:31], v17 offset:6408
s_waitcnt lgkmcnt(0)
s_mov_b32 s44, 3145728
buffer_load_dword v250, v12, s[4:7], s44 offen
s_add_u32 m0, s45, 0
s_mov_b32 s44, 3145728
buffer_load_dwordx4 v16, s[4:7], s44 offen lds
s_add_u32 m0, s45, 1024
s_mov_b32 s44, 3276800
buffer_load_dwordx4 v16, s[4:7], s44 offen lds
s_add_u32 m0, s45, 2048
s_mov_b32 s44, 3407872
buffer_load_dwordx4 v16, s[4:7], s44 offen lds
s_add_u32 m0, s45, 3072
s_mov_b32 s44, 3538944
buffer_load_dwordx4 v16, s[4:7], s44 offen lds
s_add_u32 m0, s45, 4096
s_mov_b32 s44, 3670016
buffer_load_dwordx4 v16, s[4:7], s44 offen lds
s_add_u32 m0, s45, 5120
s_mov_b32 s44, 3801088
buffer_load_dwordx4 v16, s[4:7], s44 offen lds
s_add_u32 m0, s45, 6144
s_mov_b32 s44, 3932160
buffer_load_dwordx4 v16, s[4:7], s44 offen lds
s_add_u32 m0, s45, 7168
s_mov_b32 s44, 4063232
buffer_load_dwordx4 v16, s[4:7], s44 offen lds
ds_read_b128 v[20:23], v8 offset:0
ds_read_b128 v[24:27], v8 offset:2048
ds_read_b128 v[28:31], v9 offset:0
ds_read_b128 v[32:35], v9 offset:2048
ds_read_b128 v[36:39], v8 offset:4096
ds_read_b128 v[40:43], v8 offset:6144
ds_read_b128 v[44:47], v9 offset:4096
ds_read_b128 v[48:51], v9 offset:6144
s_waitcnt lgkmcnt(0)
v_mfma_f32_16x16x32_bf16 v[52:55], a[0:3], v[20:23], 0
v_mfma_f32_16x16x32_bf16 v[56:59], a[4:7], v[20:23], 0
v_mfma_f32_16x16x32_bf16 v[60:63], a[0:3], v[24:27], 0
v_mfma_f32_16x16x32_bf16 v[64:67], a[4:7], v[24:27], 0
v_mfma_f32_16x16x32_bf16 v[52:55], a[8:11], v[28:31], v[52:55]
v_mfma_f32_16x16x32_bf16 v[56:59], a[12:15], v[28:31], v[56:59]
v_mfma_f32_16x16x32_bf16 v[60:63], a[8:11], v[32:35], v[60:63]
v_mfma_f32_16x16x32_bf16 v[64:67], a[12:15], v[32:35], v[64:67]
v_mfma_f32_16x16x32_bf16 v[52:55], a[16:19], v[36:39], v[52:55]
v_mfma_f32_16x16x32_bf16 v[56:59], a[20:23], v[36:39], v[56:59]
v_mfma_f32_16x16x32_bf16 v[60:63], a[16:19], v[40:43], v[60:63]
v_mfma_f32_16x16x32_bf16 v[64:67], a[20:23], v[40:43], v[64:67]
v_mfma_f32_16x16x32_bf16 v[52:55], a[24:27], v[44:47], v[52:55]
v_mfma_f32_16x16x32_bf16 v[56:59], a[28:31], v[44:47], v[56:59]
v_mfma_f32_16x16x32_bf16 v[60:63], a[24:27], v[48:51], v[60:63]
v_mfma_f32_16x16x32_bf16 v[64:67], a[28:31], v[48:51], v[64:67]
s_waitcnt vmcnt(18)
ds_read_b64_tr_b16 a[32:33], v17 offset:8192
ds_read_b64_tr_b16 a[34:35], v17 offset:8448
ds_read_b64_tr_b16 a[36:37], v17 offset:8200
ds_read_b64_tr_b16 a[38:39], v17 offset:8456
ds_read_b64_tr_b16 a[40:41], v17 offset:10240
ds_read_b64_tr_b16 a[42:43], v17 offset:10496
ds_read_b64_tr_b16 a[44:45], v17 offset:10248
ds_read_b64_tr_b16 a[46:47], v17 offset:10504
s_waitcnt lgkmcnt(0)
ds_read_b64_tr_b16 a[48:49], v17 offset:12288
ds_read_b64_tr_b16 a[50:51], v17 offset:12544
ds_read_b64_tr_b16 a[52:53], v17 offset:12296
ds_read_b64_tr_b16 a[54:55], v17 offset:12552
ds_read_b64_tr_b16 a[56:57], v17 offset:14336
ds_read_b64_tr_b16 a[58:59], v17 offset:14592
ds_read_b64_tr_b16 a[60:61], v17 offset:14344
ds_read_b64_tr_b16 a[62:63], v17 offset:14600
s_waitcnt lgkmcnt(0)
s_mov_b32 s44, 4194304
buffer_load_dword v250, v12, s[4:7], s44 offen
s_add_u32 m0, s45, 8192
s_mov_b32 s44, 4194304
buffer_load_dwordx4 v16, s[4:7], s44 offen lds
s_add_u32 m0, s45, 9216
s_mov_b32 s44, 4325376
buffer_load_dwordx4 v16, s[4:7], s44 offen lds
s_add_u32 m0, s45, 10240
s_mov_b32 s44, 4456448
buffer_load_dwordx4 v16, s[4:7], s44 offen lds
s_add_u32 m0, s45, 11264
s_mov_b32 s44, 4587520
buffer_load_dwordx4 v16, s[4:7], s44 offen lds
s_add_u32 m0, s45, 12288
s_mov_b32 s44, 4718592
buffer_load_dwordx4 v16, s[4:7], s44 offen lds
s_add_u32 m0, s45, 13312
s_mov_b32 s44, 4849664
buffer_load_dwordx4 v16, s[4:7], s44 offen lds
s_add_u32 m0, s45, 14336
s_mov_b32 s44, 4980736
buffer_load_dwordx4 v16, s[4:7], s44 offen lds
s_add_u32 m0, s45, 15360
s_mov_b32 s44, 5111808
buffer_load_dwordx4 v16, s[4:7], s44 offen lds
ds_read_b128 v[20:23], v8 offset:8192
ds_read_b128 v[24:27], v8 offset:10240
ds_read_b128 v[28:31], v9 offset:8192
ds_read_b128 v[32:35], v9 offset:10240
ds_read_b128 v[36:39], v8 offset:12288
ds_read_b128 v[40:43], v8 offset:14336
ds_read_b128 v[44:47], v9 offset:12288
ds_read_b128 v[48:51], v9 offset:14336
s_waitcnt lgkmcnt(0)
v_mfma_f32_16x16x32_bf16 v[52:55], a[32:35], v[20:23], v[52:55]
v_mfma_f32_16x16x32_bf16 v[56:59], a[36:39], v[20:23], v[56:59]
v_mfma_f32_16x16x32_bf16 v[60:63], a[32:35], v[24:27], v[60:63]
v_mfma_f32_16x16x32_bf16 v[64:67], a[36:39], v[24:27], v[64:67]
v_mfma_f32_16x16x32_bf16 v[52:55], a[40:43], v[28:31], v[52:55]
v_mfma_f32_16x16x32_bf16 v[56:59], a[44:47], v[28:31], v[56:59]
v_mfma_f32_16x16x32_bf16 v[60:63], a[40:43], v[32:35], v[60:63]
v_mfma_f32_16x16x32_bf16 v[64:67], a[44:47], v[32:35], v[64:67]
v_mfma_f32_16x16x32_bf16 v[52:55], a[48:51], v[36:39], v[52:55]
v_mfma_f32_16x16x32_bf16 v[56:59], a[52:55], v[36:39], v[56:59]
v_mfma_f32_16x16x32_bf16 v[60:63], a[48:51], v[40:43], v[60:63]
v_mfma_f32_16x16x32_bf16 v[64:67], a[52:55], v[40:43], v[64:67]
v_mfma_f32_16x16x32_bf16 v[52:55], a[56:59], v[44:47], v[52:55]
v_mfma_f32_16x16x32_bf16 v[56:59], a[60:63], v[44:47], v[56:59]
v_mfma_f32_16x16x32_bf16 v[60:63], a[56:59], v[48:51], v[60:63]
v_mfma_f32_16x16x32_bf16 v[64:67], a[60:63], v[48:51], v[64:67]
s_waitcnt vmcnt(18)
ds_read_b64_tr_b16 a[64:65], v17 offset:16384
ds_read_b64_tr_b16 a[66:67], v17 offset:16640
ds_read_b64_tr_b16 a[68:69], v17 offset:16392
ds_read_b64_tr_b16 a[70:71], v17 offset:16648
ds_read_b64_tr_b16 a[72:73], v17 offset:18432
ds_read_b64_tr_b16 a[74:75], v17 offset:18688
ds_read_b64_tr_b16 a[76:77], v17 offset:18440
ds_read_b64_tr_b16 a[78:79], v17 offset:18696
s_waitcnt lgkmcnt(0)
ds_read_b64_tr_b16 a[80:81], v17 offset:20480
ds_read_b64_tr_b16 a[82:83], v17 offset:20736
ds_read_b64_tr_b16 a[84:85], v17 offset:20488
ds_read_b64_tr_b16 a[86:87], v17 offset:20744
ds_read_b64_tr_b16 a[88:89], v17 offset:22528
ds_read_b64_tr_b16 a[90:91], v17 offset:22784
ds_read_b64_tr_b16 a[92:93], v17 offset:22536
ds_read_b64_tr_b16 a[94:95], v17 offset:22792
s_waitcnt lgkmcnt(0)
s_mov_b32 s44, 5242880
buffer_load_dword v250, v12, s[4:7], s44 offen
s_add_u32 m0, s45, 16384
s_mov_b32 s44, 5242880
buffer_load_dwordx4 v16, s[4:7], s44 offen lds
s_add_u32 m0, s45, 17408
s_mov_b32 s44, 5373952
buffer_load_dwordx4 v16, s[4:7], s44 offen lds
s_add_u32 m0, s45, 18432
s_mov_b32 s44, 5505024
buffer_load_dwordx4 v16, s[4:7], s44 offen lds
s_add_u32 m0, s45, 19456
s_mov_b32 s44, 5636096
buffer_load_dwordx4 v16, s[4:7], s44 offen lds
s_add_u32 m0, s45, 20480
s_mov_b32 s44, 5767168
buffer_load_dwordx4 v16, s[4:7], s44 offen lds
s_add_u32 m0, s45, 21504
s_mov_b32 s44, 5898240
buffer_load_dwordx4 v16, s[4:7], s44 offen lds
s_add_u32 m0, s45, 22528
s_mov_b32 s44, 6029312
buffer_load_dwordx4 v16, s[4:7], s44 offen lds
s_add_u32 m0, s45, 23552
s_mov_b32 s44, 6160384
buffer_load_dwordx4 v16, s[4:7], s44 offen lds
ds_read_b128 v[20:23], v8 offset:16384
ds_read_b128 v[24:27], v8 offset:18432
ds_read_b128 v[28:31], v9 offset:16384
ds_read_b128 v[32:35], v9 offset:18432
ds_read_b128 v[36:39], v8 offset:20480
ds_read_b128 v[40:43], v8 offset:22528
ds_read_b128 v[44:47], v9 offset:20480
ds_read_b128 v[48:51], v9 offset:22528
s_waitcnt lgkmcnt(0)
v_mfma_f32_16x16x32_bf16 v[52:55], a[64:67], v[20:23], v[52:55]
v_mfma_f32_16x16x32_bf16 v[56:59], a[68:71], v[20:23], v[56:59]
v_mfma_f32_16x16x32_bf16 v[60:63], a[64:67], v[24:27], v[60:63]
v_mfma_f32_16x16x32_bf16 v[64:67], a[68:71], v[24:27], v[64:67]
v_mfma_f32_16x16x32_bf16 v[52:55], a[72:75], v[28:31], v[52:55]
v_mfma_f32_16x16x32_bf16 v[56:59], a[76:79], v[28:31], v[56:59]
v_mfma_f32_16x16x32_bf16 v[60:63], a[72:75], v[32:35], v[60:63]
v_mfma_f32_16x16x32_bf16 v[64:67], a[76:79], v[32:35], v[64:67]
v_mfma_f32_16x16x32_bf16 v[52:55], a[80:83], v[36:39], v[52:55]
v_mfma_f32_16x16x32_bf16 v[56:59], a[84:87], v[36:39], v[56:59]
v_mfma_f32_16x16x32_bf16 v[60:63], a[80:83], v[40:43], v[60:63]
v_mfma_f32_16x16x32_bf16 v[64:67], a[84:87], v[40:43], v[64:67]
v_mfma_f32_16x16x32_bf16 v[52:55], a[88:91], v[44:47], v[52:55]
v_mfma_f32_16x16x32_bf16 v[56:59], a[92:95], v[44:47], v[56:59]
v_mfma_f32_16x16x32_bf16 v[60:63], a[88:91], v[48:51], v[60:63]
v_mfma_f32_16x16x32_bf16 v[64:67], a[92:95], v[48:51], v[64:67]
s_waitcnt vmcnt(18)
ds_read_b64_tr_b16 a[96:97], v17 offset:0
ds_read_b64_tr_b16 a[98:99], v17 offset:256
ds_read_b64_tr_b16 a[100:101], v17 offset:8
ds_read_b64_tr_b16 a[102:103], v17 offset:264
ds_read_b64_tr_b16 a[104:105], v17 offset:2048
ds_read_b64_tr_b16 a[106:107], v17 offset:2304
ds_read_b64_tr_b16 a[108:109], v17 offset:2056
ds_read_b64_tr_b16 a[110:111], v17 offset:2312
s_waitcnt lgkmcnt(0)
ds_read_b64_tr_b16 a[112:113], v17 offset:4096
ds_read_b64_tr_b16 a[114:115], v17 offset:4352
ds_read_b64_tr_b16 a[116:117], v17 offset:4104
ds_read_b64_tr_b16 a[118:119], v17 offset:4360
ds_read_b64_tr_b16 a[120:121], v17 offset:6144
ds_read_b64_tr_b16 a[122:123], v17 offset:6400
ds_read_b64_tr_b16 a[124:125], v17 offset:6152
ds_read_b64_tr_b16 a[126:127], v17 offset:6408
s_waitcnt lgkmcnt(0)
s_mov_b32 s44, 6291456
buffer_load_dword v250, v12, s[4:7], s44 offen
s_add_u32 m0, s45, 0
s_mov_b32 s44, 6291456
buffer_load_dwordx4 v16, s[4:7], s44 offen lds
s_add_u32 m0, s45, 1024
s_mov_b32 s44, 6422528
buffer_load_dwordx4 v16, s[4:7], s44 offen lds
s_add_u32 m0, s45, 2048
s_mov_b32 s44, 6553600
buffer_load_dwordx4 v16, s[4:7], s44 offen lds
s_add_u32 m0, s45, 3072
s_mov_b32 s44, 6684672
buffer_load_dwordx4 v16, s[4:7], s44 offen lds
s_add_u32 m0, s45, 4096
s_mov_b32 s44, 6815744
buffer_load_dwordx4 v16, s[4:7], s44 offen lds
s_add_u32 m0, s45, 5120
s_mov_b32 s44, 6946816
buffer_load_dwordx4 v16, s[4:7], s44 offen lds
s_add_u32 m0, s45, 6144
s_mov_b32 s44, 7077888
buffer_load_dwordx4 v16, s[4:7], s44 offen lds
s_add_u32 m0, s45, 7168
s_mov_b32 s44, 7208960
buffer_load_dwordx4 v16, s[4:7], s44 offen lds
ds_read_b128 v[20:23], v8 offset:24576
ds_read_b128 v[24:27], v8 offset:26624
ds_read_b128 v[28:31], v9 offset:24576
ds_read_b128 v[32:35], v9 offset:26624
ds_read_b128 v[36:39], v8 offset:28672
ds_read_b128 v[40:43], v8 offset:30720
ds_read_b128 v[44:47], v9 offset:28672
ds_read_b128 v[48:51], v9 offset:30720
s_waitcnt lgkmcnt(0)
v_mfma_f32_16x16x32_bf16 v[52:55], a[96:99], v[20:23], v[52:55]
v_mfma_f32_16x16x32_bf16 v[56:59], a[100:103], v[20:23], v[56:59]
v_mfma_f32_16x16x32_bf16 v[60:63], a[96:99], v[24:27], v[60:63]
v_mfma_f32_16x16x32_bf16 v[64:67], a[100:103], v[24:27], v[64:67]
v_mfma_f32_16x16x32_bf16 v[52:55], a[104:107], v[28:31], v[52:55]
v_mfma_f32_16x16x32_bf16 v[56:59], a[108:111], v[28:31], v[56:59]
v_mfma_f32_16x16x32_bf16 v[60:63], a[104:107], v[32:35], v[60:63]
v_mfma_f32_16x16x32_bf16 v[64:67], a[108:111], v[32:35], v[64:67]
v_mfma_f32_16x16x32_bf16 v[52:55], a[112:115], v[36:39], v[52:55]
v_mfma_f32_16x16x32_bf16 v[56:59], a[116:119], v[36:39], v[56:59]
v_mfma_f32_16x16x32_bf16 v[60:63], a[112:115], v[40:43], v[60:63]
v_mfma_f32_16x16x32_bf16 v[64:67], a[116:119], v[40:43], v[64:67]
v_mfma_f32_16x16x32_bf16 v[52:55], a[120:123], v[44:47], v[52:55]
v_mfma_f32_16x16x32_bf16 v[56:59], a[124:127], v[44:47], v[56:59]
v_mfma_f32_16x16x32_bf16 v[60:63], a[120:123], v[48:51], v[60:63]
v_mfma_f32_16x16x32_bf16 v[64:67], a[124:127], v[48:51], v[64:67]
s_waitcnt vmcnt(18)
ds_read_b64_tr_b16 a[128:129], v17 offset:8192
ds_read_b64_tr_b16 a[130:131], v17 offset:8448
ds_read_b64_tr_b16 a[132:133], v17 offset:8200
ds_read_b64_tr_b16 a[134:135], v17 offset:8456
ds_read_b64_tr_b16 a[136:137], v17 offset:10240
ds_read_b64_tr_b16 a[138:139], v17 offset:10496
ds_read_b64_tr_b16 a[140:141], v17 offset:10248
ds_read_b64_tr_b16 a[142:143], v17 offset:10504
s_waitcnt lgkmcnt(0)
ds_read_b64_tr_b16 a[144:145], v17 offset:12288
ds_read_b64_tr_b16 a[146:147], v17 offset:12544
ds_read_b64_tr_b16 a[148:149], v17 offset:12296
ds_read_b64_tr_b16 a[150:151], v17 offset:12552
ds_read_b64_tr_b16 a[152:153], v17 offset:14336
ds_read_b64_tr_b16 a[154:155], v17 offset:14592
ds_read_b64_tr_b16 a[156:157], v17 offset:14344
ds_read_b64_tr_b16 a[158:159], v17 offset:14600
s_waitcnt lgkmcnt(0)
s_mov_b32 s44, 7340032
buffer_load_dword v250, v12, s[4:7], s44 offen
s_add_u32 m0, s45, 8192
s_mov_b32 s44, 7340032
buffer_load_dwordx4 v16, s[4:7], s44 offen lds
s_add_u32 m0, s45, 9216
s_mov_b32 s44, 7471104
buffer_load_dwordx4 v16, s[4:7], s44 offen lds
s_add_u32 m0, s45, 10240
s_mov_b32 s44, 7602176
buffer_load_dwordx4 v16, s[4:7], s44 offen lds
s_add_u32 m0, s45, 11264
s_mov_b32 s44, 7733248
buffer_load_dwordx4 v16, s[4:7], s44 offen lds
s_add_u32 m0, s45, 12288
s_mov_b32 s44, 7864320
buffer_load_dwordx4 v16, s[4:7], s44 offen lds
s_add_u32 m0, s45, 13312
s_mov_b32 s44, 7995392
buffer_load_dwordx4 v16, s[4:7], s44 offen lds
s_add_u32 m0, s45, 14336
s_mov_b32 s44, 8126464
buffer_load_dwordx4 v16, s[4:7], s44 offen lds
s_add_u32 m0, s45, 15360
s_mov_b32 s44, 8257536
buffer_load_dwordx4 v16, s[4:7], s44 offen lds
ds_read_b128 v[20:23], v8 offset:32768
ds_read_b128 v[24:27], v8 offset:34816
ds_read_b128 v[28:31], v9 offset:32768
ds_read_b128 v[32:35], v9 offset:34816
ds_read_b128 v[36:39], v8 offset:36864
ds_read_b128 v[40:43], v8 offset:38912
ds_read_b128 v[44:47], v9 offset:36864
ds_read_b128 v[48:51], v9 offset:38912
s_waitcnt lgkmcnt(0)
v_mfma_f32_16x16x32_bf16 v[52:55], a[128:131], v[20:23], v[52:55]
v_mfma_f32_16x16x32_bf16 v[56:59], a[132:135], v[20:23], v[56:59]
v_mfma_f32_16x16x32_bf16 v[60:63], a[128:131], v[24:27], v[60:63]
v_mfma_f32_16x16x32_bf16 v[64:67], a[132:135], v[24:27], v[64:67]
v_mfma_f32_16x16x32_bf16 v[52:55], a[136:139], v[28:31], v[52:55]
v_mfma_f32_16x16x32_bf16 v[56:59], a[140:143], v[28:31], v[56:59]
v_mfma_f32_16x16x32_bf16 v[60:63], a[136:139], v[32:35], v[60:63]
v_mfma_f32_16x16x32_bf16 v[64:67], a[140:143], v[32:35], v[64:67]
v_mfma_f32_16x16x32_bf16 v[52:55], a[144:147], v[36:39], v[52:55]
v_mfma_f32_16x16x32_bf16 v[56:59], a[148:151], v[36:39], v[56:59]
v_mfma_f32_16x16x32_bf16 v[60:63], a[144:147], v[40:43], v[60:63]
v_mfma_f32_16x16x32_bf16 v[64:67], a[148:151], v[40:43], v[64:67]
v_mfma_f32_16x16x32_bf16 v[52:55], a[152:155], v[44:47], v[52:55]
v_mfma_f32_16x16x32_bf16 v[56:59], a[156:159], v[44:47], v[56:59]
v_mfma_f32_16x16x32_bf16 v[60:63], a[152:155], v[48:51], v[60:63]
v_mfma_f32_16x16x32_bf16 v[64:67], a[156:159], v[48:51], v[64:67]
s_waitcnt vmcnt(18)
ds_read_b64_tr_b16 a[160:161], v17 offset:16384
ds_read_b64_tr_b16 a[162:163], v17 offset:16640
ds_read_b64_tr_b16 a[164:165], v17 offset:16392
ds_read_b64_tr_b16 a[166:167], v17 offset:16648
ds_read_b64_tr_b16 a[168:169], v17 offset:18432
ds_read_b64_tr_b16 a[170:171], v17 offset:18688
ds_read_b64_tr_b16 a[172:173], v17 offset:18440
ds_read_b64_tr_b16 a[174:175], v17 offset:18696
s_waitcnt lgkmcnt(0)
ds_read_b64_tr_b16 a[176:177], v17 offset:20480
ds_read_b64_tr_b16 a[178:179], v17 offset:20736
ds_read_b64_tr_b16 a[180:181], v17 offset:20488
ds_read_b64_tr_b16 a[182:183], v17 offset:20744
ds_read_b64_tr_b16 a[184:185], v17 offset:22528
ds_read_b64_tr_b16 a[186:187], v17 offset:22784
ds_read_b64_tr_b16 a[188:189], v17 offset:22536
ds_read_b64_tr_b16 a[190:191], v17 offset:22792
s_waitcnt lgkmcnt(0)
ds_read_b128 v[20:23], v8 offset:40960
ds_read_b128 v[24:27], v8 offset:43008
ds_read_b128 v[28:31], v9 offset:40960
ds_read_b128 v[32:35], v9 offset:43008
ds_read_b128 v[36:39], v8 offset:45056
ds_read_b128 v[40:43], v8 offset:47104
ds_read_b128 v[44:47], v9 offset:45056
ds_read_b128 v[48:51], v9 offset:47104
s_waitcnt lgkmcnt(0)
v_mfma_f32_16x16x32_bf16 v[52:55], a[160:163], v[20:23], v[52:55]
v_mfma_f32_16x16x32_bf16 v[56:59], a[164:167], v[20:23], v[56:59]
v_mfma_f32_16x16x32_bf16 v[60:63], a[160:163], v[24:27], v[60:63]
v_mfma_f32_16x16x32_bf16 v[64:67], a[164:167], v[24:27], v[64:67]
v_mfma_f32_16x16x32_bf16 v[52:55], a[168:171], v[28:31], v[52:55]
v_mfma_f32_16x16x32_bf16 v[56:59], a[172:175], v[28:31], v[56:59]
v_mfma_f32_16x16x32_bf16 v[60:63], a[168:171], v[32:35], v[60:63]
v_mfma_f32_16x16x32_bf16 v[64:67], a[172:175], v[32:35], v[64:67]
v_mfma_f32_16x16x32_bf16 v[52:55], a[176:179], v[36:39], v[52:55]
v_mfma_f32_16x16x32_bf16 v[56:59], a[180:183], v[36:39], v[56:59]
v_mfma_f32_16x16x32_bf16 v[60:63], a[176:179], v[40:43], v[60:63]
v_mfma_f32_16x16x32_bf16 v[64:67], a[180:183], v[40:43], v[64:67]
v_mfma_f32_16x16x32_bf16 v[52:55], a[184:187], v[44:47], v[52:55]
v_mfma_f32_16x16x32_bf16 v[56:59], a[188:191], v[44:47], v[56:59]
v_mfma_f32_16x16x32_bf16 v[60:63], a[184:187], v[48:51], v[60:63]
v_mfma_f32_16x16x32_bf16 v[64:67], a[188:191], v[48:51], v[64:67]
s_waitcnt vmcnt(9)
ds_read_b64_tr_b16 a[192:193], v17 offset:0
ds_read_b64_tr_b16 a[194:195], v17 offset:256
ds_read_b64_tr_b16 a[196:197], v17 offset:8
ds_read_b64_tr_b16 a[198:199], v17 offset:264
ds_read_b64_tr_b16 a[200:201], v17 offset:2048
ds_read_b64_tr_b16 a[202:203], v17 offset:2304
ds_read_b64_tr_b16 a[204:205], v17 offset:2056
ds_read_b64_tr_b16 a[206:207], v17 offset:2312
s_waitcnt lgkmcnt(0)
ds_read_b64_tr_b16 a[208:209], v17 offset:4096
ds_read_b64_tr_b16 a[210:211], v17 offset:4352
ds_read_b64_tr_b16 a[212:213], v17 offset:4104
ds_read_b64_tr_b16 a[214:215], v17 offset:4360
ds_read_b64_tr_b16 a[216:217], v17 offset:6144
ds_read_b64_tr_b16 a[218:219], v17 offset:6400
ds_read_b64_tr_b16 a[220:221], v17 offset:6152
ds_read_b64_tr_b16 a[222:223], v17 offset:6408
s_waitcnt lgkmcnt(0)
ds_read_b128 v[20:23], v8 offset:49152
ds_read_b128 v[24:27], v8 offset:51200
ds_read_b128 v[28:31], v9 offset:49152
ds_read_b128 v[32:35], v9 offset:51200
ds_read_b128 v[36:39], v8 offset:53248
ds_read_b128 v[40:43], v8 offset:55296
ds_read_b128 v[44:47], v9 offset:53248
ds_read_b128 v[48:51], v9 offset:55296
s_waitcnt lgkmcnt(0)
v_mfma_f32_16x16x32_bf16 v[52:55], a[192:195], v[20:23], v[52:55]
v_mfma_f32_16x16x32_bf16 v[56:59], a[196:199], v[20:23], v[56:59]
v_mfma_f32_16x16x32_bf16 v[60:63], a[192:195], v[24:27], v[60:63]
v_mfma_f32_16x16x32_bf16 v[64:67], a[196:199], v[24:27], v[64:67]
v_mfma_f32_16x16x32_bf16 v[52:55], a[200:203], v[28:31], v[52:55]
v_mfma_f32_16x16x32_bf16 v[56:59], a[204:207], v[28:31], v[56:59]
v_mfma_f32_16x16x32_bf16 v[60:63], a[200:203], v[32:35], v[60:63]
v_mfma_f32_16x16x32_bf16 v[64:67], a[204:207], v[32:35], v[64:67]
v_mfma_f32_16x16x32_bf16 v[52:55], a[208:211], v[36:39], v[52:55]
v_mfma_f32_16x16x32_bf16 v[56:59], a[212:215], v[36:39], v[56:59]
v_mfma_f32_16x16x32_bf16 v[60:63], a[208:211], v[40:43], v[60:63]
v_mfma_f32_16x16x32_bf16 v[64:67], a[212:215], v[40:43], v[64:67]
v_mfma_f32_16x16x32_bf16 v[52:55], a[216:219], v[44:47], v[52:55]
v_mfma_f32_16x16x32_bf16 v[56:59], a[220:223], v[44:47], v[56:59]
v_mfma_f32_16x16x32_bf16 v[60:63], a[216:219], v[48:51], v[60:63]
v_mfma_f32_16x16x32_bf16 v[64:67], a[220:223], v[48:51], v[64:67]
s_waitcnt vmcnt(0)
ds_read_b64_tr_b16 a[224:225], v17 offset:8192
ds_read_b64_tr_b16 a[226:227], v17 offset:8448
ds_read_b64_tr_b16 a[228:229], v17 offset:8200
ds_read_b64_tr_b16 a[230:231], v17 offset:8456
ds_read_b64_tr_b16 a[232:233], v17 offset:10240
ds_read_b64_tr_b16 a[234:235], v17 offset:10496
ds_read_b64_tr_b16 a[236:237], v17 offset:10248
ds_read_b64_tr_b16 a[238:239], v17 offset:10504
s_waitcnt lgkmcnt(0)
ds_read_b64_tr_b16 a[240:241], v17 offset:12288
ds_read_b64_tr_b16 a[242:243], v17 offset:12544
ds_read_b64_tr_b16 a[244:245], v17 offset:12296
ds_read_b64_tr_b16 a[246:247], v17 offset:12552
ds_read_b64_tr_b16 a[248:249], v17 offset:14336
ds_read_b64_tr_b16 a[250:251], v17 offset:14592
ds_read_b64_tr_b16 a[252:253], v17 offset:14344
ds_read_b64_tr_b16 a[254:255], v17 offset:14600
s_waitcnt lgkmcnt(0)
ds_read_b128 v[20:23], v8 offset:57344
ds_read_b128 v[24:27], v8 offset:59392
ds_read_b128 v[28:31], v9 offset:57344
ds_read_b128 v[32:35], v9 offset:59392
ds_read_b128 v[36:39], v8 offset:61440
ds_read_b128 v[40:43], v8 offset:63488
ds_read_b128 v[44:47], v9 offset:61440
ds_read_b128 v[48:51], v9 offset:63488
s_waitcnt lgkmcnt(0)
v_mfma_f32_16x16x32_bf16 v[52:55], a[224:227], v[20:23], v[52:55]
v_mfma_f32_16x16x32_bf16 v[56:59], a[228:231], v[20:23], v[56:59]
v_mfma_f32_16x16x32_bf16 v[60:63], a[224:227], v[24:27], v[60:63]
v_mfma_f32_16x16x32_bf16 v[64:67], a[228:231], v[24:27], v[64:67]
v_mfma_f32_16x16x32_bf16 v[52:55], a[232:235], v[28:31], v[52:55]
v_mfma_f32_16x16x32_bf16 v[56:59], a[236:239], v[28:31], v[56:59]
v_mfma_f32_16x16x32_bf16 v[60:63], a[232:235], v[32:35], v[60:63]
v_mfma_f32_16x16x32_bf16 v[64:67], a[236:239], v[32:35], v[64:67]
v_mfma_f32_16x16x32_bf16 v[52:55], a[240:243], v[36:39], v[52:55]
v_mfma_f32_16x16x32_bf16 v[56:59], a[244:247], v[36:39], v[56:59]
v_mfma_f32_16x16x32_bf16 v[60:63], a[240:243], v[40:43], v[60:63]
v_mfma_f32_16x16x32_bf16 v[64:67], a[244:247], v[40:43], v[64:67]
v_mfma_f32_16x16x32_bf16 v[52:55], a[248:251], v[44:47], v[52:55]
v_mfma_f32_16x16x32_bf16 v[56:59], a[252:255], v[44:47], v[56:59]
v_mfma_f32_16x16x32_bf16 v[60:63], a[248:251], v[48:51], v[60:63]
v_mfma_f32_16x16x32_bf16 v[64:67], a[252:255], v[48:51], v[64:67]
s_barrier
s_mov_b32 s50, 0x10000
s_add_u32 m0, s46, 65536
s_nop 0
buffer_load_dwordx4 v6, s[8:11], s50 offen offset:0 lds
s_add_u32 m0, s46, 69504
s_nop 0
buffer_load_dwordx4 v6, s[8:11], s50 offen offset:128 lds
s_add_u32 m0, s46, 73472
s_nop 0
buffer_load_dwordx4 v6, s[8:11], s50 offen offset:256 lds
s_add_u32 m0, s46, 77440
s_nop 0
buffer_load_dwordx4 v6, s[8:11], s50 offen offset:384 lds
s_add_u32 m0, s46, 81408
s_nop 0
buffer_load_dwordx4 v6, s[8:11], s50 offen offset:512 lds
s_add_u32 m0, s46, 85376
s_nop 0
buffer_load_dwordx4 v6, s[8:11], s50 offen offset:640 lds
s_add_u32 m0, s46, 89344
s_nop 0
buffer_load_dwordx4 v6, s[8:11], s50 offen offset:768 lds
s_add_u32 m0, s46, 93312
s_nop 0
buffer_load_dwordx4 v6, s[8:11], s50 offen offset:896 lds
s_add_u32 m0, s46, 97280
s_nop 0
buffer_load_dwordx4 v6, s[8:11], s50 offen offset:1024 lds
s_add_u32 m0, s46, 101248
s_nop 0
buffer_load_dwordx4 v6, s[8:11], s50 offen offset:1152 lds
s_add_u32 m0, s46, 105216
s_nop 0
buffer_load_dwordx4 v6, s[8:11], s50 offen offset:1280 lds
s_add_u32 m0, s46, 109184
s_nop 0
buffer_load_dwordx4 v6, s[8:11], s50 offen offset:1408 lds
s_add_u32 m0, s46, 113152
s_nop 0
buffer_load_dwordx4 v6, s[8:11], s50 offen offset:1536 lds
s_add_u32 m0, s46, 117120
s_nop 0
buffer_load_dwordx4 v6, s[8:11], s50 offen offset:1664 lds
s_add_u32 m0, s46, 121088
s_nop 0
buffer_load_dwordx4 v6, s[8:11], s50 offen offset:1792 lds
s_add_u32 m0, s46, 125056
s_nop 0
buffer_load_dwordx4 v6, s[8:11], s50 offen offset:1920 lds
v_and_b32 v3, 15, v0
v_lshlrev_b32 v3, 4, v3
s_branch mega_kernel_syc
mega_kernel_sycw:
s_sleep 4
mega_kernel_syc:
buffer_load_dword v2, v3, s[72:75], 0 offen sc1
s_waitcnt vmcnt(0)
mega_kernel_sycp:
s_cmp_eq_u32 s95, 1
s_cbranch_scc0 mega_kernel_sycf
v_readlane_b32 s76, v2, 14
s_mov_b32 s98, 0
s_cmp_eq_u32 s76, 32
s_cbranch_scc0 mega_kernel_sycw
s_branch mega_kernel_sycd
mega_kernel_sycf:
s_mov_b32 s77, 0
s_mov_b32 s78, 0
v_readlane_b32 s76, v2, 0
s_add_u32 s77, s77, s76
s_xor_b32 s76, s76, 32
s_or_b32 s78, s78, s76
v_readlane_b32 s76, v2, 1
s_add_u32 s77, s77, s76
s_xor_b32 s76, s76, 32
s_or_b32 s78, s78, s76
v_readlane_b32 s76, v2, 2
s_add_u32 s77, s77, s76
s_xor_b32 s76, s76, 32
s_or_b32 s78, s78, s76
v_readlane_b32 s76, v2, 3
s_add_u32 s77, s77, s76
s_xor_b32 s76, s76, 32
s_or_b32 s78, s78, s76
v_readlane_b32 s76, v2, 4
s_add_u32 s77, s77, s76
s_xor_b32 s76, s76, 32
s_or_b32 s78, s78, s76
v_readlane_b32 s76, v2, 5
s_add_u32 s77, s77, s76
s_xor_b32 s76, s76, 32
s_or_b32 s78, s78, s76
v_readlane_b32 s76, v2, 6
s_add_u32 s77, s77, s76
s_xor_b32 s76, s76, 32
s_or_b32 s78, s78, s76
v_readlane_b32 s76, v2, 7
s_add_u32 s77, s77, s76
s_xor_b32 s76, s76, 32
s_or_b32 s78, s78, s76
s_cmp_eq_u32 s77, 256
s_cbranch_scc0 mega_kernel_sycw
v_mov_b32 v252, v2
s_cmp_eq_u32 s78, 0
s_cbranch_scc0 mega_kernel_slowent
v_readlane_b32 s76, v2, 10
v_readlane_b32 s77, v2, 8
s_cmp_eq_u32 s76, 32
s_cbranch_scc0 mega_kernel_sycw
s_cmp_gt_u32 s77, 16
s_cselect_b32 s98, 1, 0
mega_kernel_sycd:
v_lshrrev_b32 v92, 4, v1
v_and_b32 v93, 15, v1
s_and_b32 s52, s41, 1
s_lshr_b32 s53, s41, 1
s_mov_b32 s54, 0x3e0293ee
s_mov_b32 s55, 0
s_mov_b32 s56, 0
v_mov_b32 v97, 0xff800000
v_mov_b32 v241, 0xceabdc6e
v_and_b32 v2, 7, v93
v_lshlrev_b32 v94, 7, v92
v_lshl_add_u32 v94, v2, 4, v94
v_and_b32 v2, 31, v1
v_lshlrev_b32 v95, 3, v2
v_lshrrev_b32 v2, 1, v92
v_lshlrev_b32 v96, 10, v2
v_and_b32 v2, 1, v92
v_lshl_add_u32 v96, v2, 9, v96
v_lshl_add_u32 v96, v93, 4, v96
s_lshl_b32 s43, s40, 13
s_lshl_b32 s44, s53, 12
s_add_u32 s43, s43, s44
s_lshl_b32 s44, s52, 8
s_add_u32 s43, s43, s44
s_add_u32 s43, s43, 134217728
v_add_u32 v96, s43, v96
s_lshl_b32 s43, s52, 4
v_add_u32 v98, s43, v93
v_lshlrev_b32 v2, 2, v92
v_sub_u32 v98, v98, v2
s_mov_b32 s28, 0
s_mov_b32 s29, -1
s_xor_b32 s44, s98, 1
s_lshl_b32 s44, s44, 13
s_lshl_b32 s43, s40, 7
s_add_u32 s43, s43, s44
s_add_u32 s43, s43, 69206016
v_and_b32 v2, 3, v1
v_bfe_u32 v3, v1, 2, 1
v_lshlrev_b32 v99, 12, v3
v_lshl_add_u32 v99, v2, 2, v99
v_add_u32 v99, s43, v99
s_xor_b32 s62, s98, 1
s_lshl_b32 s62, s62, 13
s_lshr_b32 s44, s47, 6
s_lshl_b32 s44, s44, 14
s_add_u32 s62, s62, s44
s_and_b32 s44, s47, 63
s_lshl_b32 s44, s44, 7
s_add_u32 s62, s62, s44
s_add_u32 s62, s62, 69222400
s_lshl_b32 s49, s40, 7
s_lshl_b32 s44, s41, 2
s_add_u32 s49, s49, s44
s_lshl_b32 s44, s98, 13
s_add_u32 s49, s49, s44
s_add_u32 s49, s49, 69255168
s_lshl_b32 s43, s41, 11
s_add_u32 s43, s43, 131072
v_add_u32 v101, s43, v7
s_lshl_b32 s43, s52, 10
s_add_u32 s43, s43, 131072
v_add_u32 v102, s43, v5
v_mov_b32 v16, 0
s_mov_b32 s50, 0
v_mov_b32 v104, 0x3f803f80
v_mov_b32 v105, 0x3f803f80
v_mov_b32 v106, 0x3f803f80
v_mov_b32 v107, 0x3f803f80
v_cmp_gt_i32 s[12:13], 0, v98
v_cmp_gt_i32 s[14:15], 1, v98
v_cmp_gt_i32 s[16:17], 2, v98
v_cmp_gt_i32 s[18:19], 3, v98
v_cmp_gt_i32 s[20:21], 16, v98
v_cmp_gt_i32 s[22:23], 17, v98
v_cmp_gt_i32 s[24:25], 18, v98
v_cmp_gt_i32 s[26:27], 19, v98
s_lshr_b32 s44, s47, 3
s_xor_b32 s44, s44, s98
s_and_b32 s44, s44, 1
s_lshl_b32 s44, s44, 13
s_lshl_b32 s58, s47, 18
s_add_u32 s58, s58, s44
s_add_u32 s58, s58, 0
s_lshr_b32 s44, s47, 4
s_xor_b32 s44, s44, s98
s_and_b32 s44, s44, 1
s_lshl_b32 s44, s44, 13
s_lshl_b32 s59, s47, 17
s_add_u32 s59, s59, s44
s_add_u32 s59, s59, 71303168
s_lshl_b32 s60, s41, 11
s_add_u32 s60, s60, 139264
s_lshl_b32 s61, s41, 10
s_add_u32 s61, s61, 155648
v_add_u32 v94, 155648, v94
s_lshl_b32 s43, s53, 11
s_add_u32 s43, s43, 156160
v_add_u32 v95, s43, v95
v_add_u32 v103, 139264, v5
s_lshl_b32 s43, s53, 12
s_add_u32 s43, s43, 147456
v_add_u32 v240, s43, v5
s_waitcnt vmcnt(0)
v_cvt_pk_bf16_f32 v220, v52, v53
v_cvt_pk_bf16_f32 v221, v54, v55
v_cvt_pk_bf16_f32 v222, v56, v57
v_cvt_pk_bf16_f32 v223, v58, v59
v_cvt_pk_bf16_f32 v224, v60, v61
v_cvt_pk_bf16_f32 v225, v62, v63
v_cvt_pk_bf16_f32 v226, v64, v65
v_cvt_pk_bf16_f32 v227, v66, v67
s_barrier
s_mov_b32 s50, 0x20000
ds_read_b128 v[20:23], v10 offset:0
ds_read_b128 v[24:27], v10 offset:2048
ds_read_b128 v[28:31], v11 offset:0
ds_read_b128 v[32:35], v11 offset:2048
ds_read_b128 v[36:39], v10 offset:4096
ds_read_b128 v[40:43], v10 offset:6144
s_add_u32 m0, s46, 0
s_waitcnt lgkmcnt(4)
v_mfma_f32_16x16x32_bf16 v[52:55], a[0:3], v[20:23], 0
ds_read_b128 v[44:47], v11 offset:4096
v_mfma_f32_16x16x32_bf16 v[56:59], a[4:7], v[20:23], 0
buffer_load_dwordx4 v6, s[8:11], s50 offen offset:0 lds
v_mfma_f32_16x16x32_bf16 v[60:63], a[0:3], v[24:27], 0
ds_read_b128 v[48:51], v11 offset:6144
v_mfma_f32_16x16x32_bf16 v[64:67], a[4:7], v[24:27], 0
s_add_u32 m0, s46, 3968
s_waitcnt lgkmcnt(4)
v_mfma_f32_16x16x32_bf16 v[52:55], a[8:11], v[28:31], v[52:55]
ds_read_b128 v[20:23], v10 offset:8192
v_mfma_f32_16x16x32_bf16 v[56:59], a[12:15], v[28:31], v[56:59]
buffer_load_dwordx4 v6, s[8:11], s50 offen offset:128 lds
v_mfma_f32_16x16x32_bf16 v[60:63], a[8:11], v[32:35], v[60:63]
ds_read_b128 v[24:27], v10 offset:10240
v_mfma_f32_16x16x32_bf16 v[64:67], a[12:15], v[32:35], v[64:67]
s_add_u32 m0, s46, 7936
s_waitcnt lgkmcnt(4)
v_mfma_f32_16x16x32_bf16 v[52:55], a[16:19], v[36:39], v[52:55]
ds_read_b128 v[28:31], v11 offset:8192
v_mfma_f32_16x16x32_bf16 v[56:59], a[20:23], v[36:39], v[56:59]
buffer_load_dwordx4 v6, s[8:11], s50 offen offset:256 lds
v_mfma_f32_16x16x32_bf16 v[60:63], a[16:19], v[40:43], v[60:63]
ds_read_b128 v[32:35], v11 offset:10240
v_mfma_f32_16x16x32_bf16 v[64:67], a[20:23], v[40:43], v[64:67]
s_add_u32 m0, s46, 11904
s_waitcnt lgkmcnt(4)
v_mfma_f32_16x16x32_bf16 v[52:55], a[24:27], v[44:47], v[52:55]
ds_read_b128 v[36:39], v10 offset:12288
v_mfma_f32_16x16x32_bf16 v[56:59], a[28:31], v[44:47], v[56:59]
buffer_load_dwordx4 v6, s[8:11], s50 offen offset:384 lds
v_mfma_f32_16x16x32_bf16 v[60:63], a[24:27], v[48:51], v[60:63]
ds_read_b128 v[40:43], v10 offset:14336
v_mfma_f32_16x16x32_bf16 v[64:67], a[28:31], v[48:51], v[64:67]
s_add_u32 m0, s46, 15872
s_waitcnt lgkmcnt(4)
v_mfma_f32_16x16x32_bf16 v[52:55], a[32:35], v[20:23], v[52:55]
ds_read_b128 v[44:47], v11 offset:12288
v_mfma_f32_16x16x32_bf16 v[56:59], a[36:39], v[20:23], v[56:59]
buffer_load_dwordx4 v6, s[8:11], s50 offen offset:512 lds
v_mfma_f32_16x16x32_bf16 v[60:63], a[32:35], v[24:27], v[60:63]
ds_read_b128 v[48:51], v11 offset:14336
v_mfma_f32_16x16x32_bf16 v[64:67], a[36:39], v[24:27], v[64:67]
s_add_u32 m0, s46, 19840
s_waitcnt lgkmcnt(4)
v_mfma_f32_16x16x32_bf16 v[52:55], a[40:43], v[28:31], v[52:55]
ds_read_b128 v[20:23], v10 offset:16384
v_mfma_f32_16x16x32_bf16 v[56:59], a[44:47], v[28:31], v[56:59]
buffer_load_dwordx4 v6, s[8:11], s50 offen offset:640 lds
v_mfma_f32_16x16x32_bf16 v[60:63], a[40:43], v[32:35], v[60:63]
ds_read_b128 v[24:27], v10 offset:18432
v_mfma_f32_16x16x32_bf16 v[64:67], a[44:47], v[32:35], v[64:67]
s_add_u32 m0, s46, 23808
s_waitcnt lgkmcnt(4)
v_mfma_f32_16x16x32_bf16 v[52:55], a[48:51], v[36:39], v[52:55]
ds_read_b128 v[28:31], v11 offset:16384
v_mfma_f32_16x16x32_bf16 v[56:59], a[52:55], v[36:39], v[56:59]
buffer_load_dwordx4 v6, s[8:11], s50 offen offset:768 lds
v_mfma_f32_16x16x32_bf16 v[60:63], a[48:51], v[40:43], v[60:63]
ds_read_b128 v[32:35], v11 offset:18432
v_mfma_f32_16x16x32_bf16 v[64:67], a[52:55], v[40:43], v[64:67]
s_add_u32 m0, s46, 27776
s_waitcnt lgkmcnt(4)
v_mfma_f32_16x16x32_bf16 v[52:55], a[56:59], v[44:47], v[52:55]
ds_read_b128 v[36:39], v10 offset:20480
v_mfma_f32_16x16x32_bf16 v[56:59], a[60:63], v[44:47], v[56:59]
buffer_load_dwordx4 v6, s[8:11], s50 offen offset:896 lds
v_mfma_f32_16x16x32_bf16 v[60:63], a[56:59], v[48:51], v[60:63]
ds_read_b128 v[40:43], v10 offset:22528
v_mfma_f32_16x16x32_bf16 v[64:67], a[60:63], v[48:51], v[64:67]
s_add_u32 m0, s46, 31744
s_waitcnt lgkmcnt(4)
v_mfma_f32_16x16x32_bf16 v[52:55], a[64:67], v[20:23], v[52:55]
ds_read_b128 v[44:47], v11 offset:20480
v_mfma_f32_16x16x32_bf16 v[56:59], a[68:71], v[20:23], v[56:59]
buffer_load_dwordx4 v6, s[8:11], s50 offen offset:1024 lds
v_mfma_f32_16x16x32_bf16 v[60:63], a[64:67], v[24:27], v[60:63]
ds_read_b128 v[48:51], v11 offset:22528
v_mfma_f32_16x16x32_bf16 v[64:67], a[68:71], v[24:27], v[64:67]
s_add_u32 m0, s46, 35712
s_waitcnt lgkmcnt(4)
v_mfma_f32_16x16x32_bf16 v[52:55], a[72:75], v[28:31], v[52:55]
ds_read_b128 v[20:23], v10 offset:24576
v_mfma_f32_16x16x32_bf16 v[56:59], a[76:79], v[28:31], v[56:59]
buffer_load_dwordx4 v6, s[8:11], s50 offen offset:1152 lds
v_mfma_f32_16x16x32_bf16 v[60:63], a[72:75], v[32:35], v[60:63]
ds_read_b128 v[24:27], v10 offset:26624
v_mfma_f32_16x16x32_bf16 v[64:67], a[76:79], v[32:35], v[64:67]
s_add_u32 m0, s46, 39680
s_waitcnt lgkmcnt(4)
v_mfma_f32_16x16x32_bf16 v[52:55], a[80:83], v[36:39], v[52:55]
ds_read_b128 v[28:31], v11 offset:24576
v_mfma_f32_16x16x32_bf16 v[56:59], a[84:87], v[36:39], v[56:59]
buffer_load_dwordx4 v6, s[8:11], s50 offen offset:1280 lds
v_mfma_f32_16x16x32_bf16 v[60:63], a[80:83], v[40:43], v[60:63]
ds_read_b128 v[32:35], v11 offset:26624
v_mfma_f32_16x16x32_bf16 v[64:67], a[84:87], v[40:43], v[64:67]
s_add_u32 m0, s46, 43648
s_waitcnt lgkmcnt(4)
v_mfma_f32_16x16x32_bf16 v[52:55], a[88:91], v[44:47], v[52:55]
ds_read_b128 v[36:39], v10 offset:28672
v_mfma_f32_16x16x32_bf16 v[56:59], a[92:95], v[44:47], v[56:59]
buffer_load_dwordx4 v6, s[8:11], s50 offen offset:1408 lds
v_mfma_f32_16x16x32_bf16 v[60:63], a[88:91], v[48:51], v[60:63]
ds_read_b128 v[40:43], v10 offset:30720
v_mfma_f32_16x16x32_bf16 v[64:67], a[92:95], v[48:51], v[64:67]
s_add_u32 m0, s46, 47616
s_waitcnt lgkmcnt(4)
v_mfma_f32_16x16x32_bf16 v[52:55], a[96:99], v[20:23], v[52:55]
ds_read_b128 v[44:47], v11 offset:28672
v_mfma_f32_16x16x32_bf16 v[56:59], a[100:103], v[20:23], v[56:59]
buffer_load_dwordx4 v6, s[8:11], s50 offen offset:1536 lds
v_mfma_f32_16x16x32_bf16 v[60:63], a[96:99], v[24:27], v[60:63]
ds_read_b128 v[48:51], v11 offset:30720
v_mfma_f32_16x16x32_bf16 v[64:67], a[100:103], v[24:27], v[64:67]
s_add_u32 m0, s46, 51584
s_waitcnt lgkmcnt(4)
v_mfma_f32_16x16x32_bf16 v[52:55], a[104:107], v[28:31], v[52:55]
ds_read_b128 v[20:23], v10 offset:32768
v_mfma_f32_16x16x32_bf16 v[56:59], a[108:111], v[28:31], v[56:59]
buffer_load_dwordx4 v6, s[8:11], s50 offen offset:1664 lds
v_mfma_f32_16x16x32_bf16 v[60:63], a[104:107], v[32:35], v[60:63]
ds_read_b128 v[24:27], v10 offset:34816
v_mfma_f32_16x16x32_bf16 v[64:67], a[108:111], v[32:35], v[64:67]
s_add_u32 m0, s46, 55552
s_waitcnt lgkmcnt(4)
v_mfma_f32_16x16x32_bf16 v[52:55], a[112:115], v[36:39], v[52:55]
ds_read_b128 v[28:31], v11 offset:32768
v_mfma_f32_16x16x32_bf16 v[56:59], a[116:119], v[36:39], v[56:59]
buffer_load_dwordx4 v6, s[8:11], s50 offen offset:1792 lds
v_mfma_f32_16x16x32_bf16 v[60:63], a[112:115], v[40:43], v[60:63]
ds_read_b128 v[32:35], v11 offset:34816
v_mfma_f32_16x16x32_bf16 v[64:67], a[116:119], v[40:43], v[64:67]
s_add_u32 m0, s46, 59520
s_waitcnt lgkmcnt(4)
v_mfma_f32_16x16x32_bf16 v[52:55], a[120:123], v[44:47], v[52:55]
ds_read_b128 v[36:39], v10 offset:36864
v_mfma_f32_16x16x32_bf16 v[56:59], a[124:127], v[44:47], v[56:59]
buffer_load_dwordx4 v6, s[8:11], s50 offen offset:1920 lds
v_mfma_f32_16x16x32_bf16 v[60:63], a[120:123], v[48:51], v[60:63]
ds_read_b128 v[40:43], v10 offset:38912
v_mfma_f32_16x16x32_bf16 v[64:67], a[124:127], v[48:51], v[64:67]
s_waitcnt lgkmcnt(4)
v_mfma_f32_16x16x32_bf16 v[52:55], a[128:131], v[20:23], v[52:55]
ds_read_b128 v[44:47], v11 offset:36864
v_mfma_f32_16x16x32_bf16 v[56:59], a[132:135], v[20:23], v[56:59]
v_mfma_f32_16x16x32_bf16 v[60:63], a[128:131], v[24:27], v[60:63]
ds_read_b128 v[48:51], v11 offset:38912
v_mfma_f32_16x16x32_bf16 v[64:67], a[132:135], v[24:27], v[64:67]
s_waitcnt lgkmcnt(4)
v_mfma_f32_16x16x32_bf16 v[52:55], a[136:139], v[28:31], v[52:55]
ds_read_b128 v[20:23], v10 offset:40960
v_mfma_f32_16x16x32_bf16 v[56:59], a[140:143], v[28:31], v[56:59]
v_mfma_f32_16x16x32_bf16 v[60:63], a[136:139], v[32:35], v[60:63]
ds_read_b128 v[24:27], v10 offset:43008
v_mfma_f32_16x16x32_bf16 v[64:67], a[140:143], v[32:35], v[64:67]
s_waitcnt lgkmcnt(4)
v_mfma_f32_16x16x32_bf16 v[52:55], a[144:147], v[36:39], v[52:55]
ds_read_b128 v[28:31], v11 offset:40960
v_mfma_f32_16x16x32_bf16 v[56:59], a[148:151], v[36:39], v[56:59]
v_mfma_f32_16x16x32_bf16 v[60:63], a[144:147], v[40:43], v[60:63]
ds_read_b128 v[32:35], v11 offset:43008
v_mfma_f32_16x16x32_bf16 v[64:67], a[148:151], v[40:43], v[64:67]
s_waitcnt lgkmcnt(4)
v_mfma_f32_16x16x32_bf16 v[52:55], a[152:155], v[44:47], v[52:55]
ds_read_b128 v[36:39], v10 offset:45056
v_mfma_f32_16x16x32_bf16 v[56:59], a[156:159], v[44:47], v[56:59]
v_mfma_f32_16x16x32_bf16 v[60:63], a[152:155], v[48:51], v[60:63]
ds_read_b128 v[40:43], v10 offset:47104
v_mfma_f32_16x16x32_bf16 v[64:67], a[156:159], v[48:51], v[64:67]
s_waitcnt lgkmcnt(4)
v_mfma_f32_16x16x32_bf16 v[52:55], a[160:163], v[20:23], v[52:55]
ds_read_b128 v[44:47], v11 offset:45056
v_mfma_f32_16x16x32_bf16 v[56:59], a[164:167], v[20:23], v[56:59]
v_mfma_f32_16x16x32_bf16 v[60:63], a[160:163], v[24:27], v[60:63]
ds_read_b128 v[48:51], v11 offset:47104
v_mfma_f32_16x16x32_bf16 v[64:67], a[164:167], v[24:27], v[64:67]
s_waitcnt lgkmcnt(4)
v_mfma_f32_16x16x32_bf16 v[52:55], a[168:171], v[28:31], v[52:55]
ds_read_b128 v[20:23], v10 offset:49152
v_mfma_f32_16x16x32_bf16 v[56:59], a[172:175], v[28:31], v[56:59]
v_mfma_f32_16x16x32_bf16 v[60:63], a[168:171], v[32:35], v[60:63]
ds_read_b128 v[24:27], v10 offset:51200
v_mfma_f32_16x16x32_bf16 v[64:67], a[172:175], v[32:35], v[64:67]
s_waitcnt lgkmcnt(4)
v_mfma_f32_16x16x32_bf16 v[52:55], a[176:179], v[36:39], v[52:55]
ds_read_b128 v[28:31], v11 offset:49152
v_mfma_f32_16x16x32_bf16 v[56:59], a[180:183], v[36:39], v[56:59]
v_mfma_f32_16x16x32_bf16 v[60:63], a[176:179], v[40:43], v[60:63]
ds_read_b128 v[32:35], v11 offset:51200
v_mfma_f32_16x16x32_bf16 v[64:67], a[180:183], v[40:43], v[64:67]
s_waitcnt lgkmcnt(4)
v_mfma_f32_16x16x32_bf16 v[52:55], a[184:187], v[44:47], v[52:55]
ds_read_b128 v[36:39], v10 offset:53248
v_mfma_f32_16x16x32_bf16 v[56:59], a[188:191], v[44:47], v[56:59]
v_mfma_f32_16x16x32_bf16 v[60:63], a[184:187], v[48:51], v[60:63]
ds_read_b128 v[40:43], v10 offset:55296
v_mfma_f32_16x16x32_bf16 v[64:67], a[188:191], v[48:51], v[64:67]
s_waitcnt lgkmcnt(4)
v_mfma_f32_16x16x32_bf16 v[52:55], a[192:195], v[20:23], v[52:55]
ds_read_b128 v[44:47], v11 offset:53248
v_mfma_f32_16x16x32_bf16 v[56:59], a[196:199], v[20:23], v[56:59]
v_mfma_f32_16x16x32_bf16 v[60:63], a[192:195], v[24:27], v[60:63]
ds_read_b128 v[48:51], v11 offset:55296
v_mfma_f32_16x16x32_bf16 v[64:67], a[196:199], v[24:27], v[64:67]
s_waitcnt lgkmcnt(4)
v_mfma_f32_16x16x32_bf16 v[52:55], a[200:203], v[28:31], v[52:55]
ds_read_b128 v[20:23], v10 offset:57344
v_mfma_f32_16x16x32_bf16 v[56:59], a[204:207], v[28:31], v[56:59]
v_mfma_f32_16x16x32_bf16 v[60:63], a[200:203], v[32:35], v[60:63]
ds_read_b128 v[24:27], v10 offset:59392
v_mfma_f32_16x16x32_bf16 v[64:67], a[204:207], v[32:35], v[64:67]
s_waitcnt lgkmcnt(4)
v_mfma_f32_16x16x32_bf16 v[52:55], a[208:211], v[36:39], v[52:55]
ds_read_b128 v[28:31], v11 offset:57344
v_mfma_f32_16x16x32_bf16 v[56:59], a[212:215], v[36:39], v[56:59]
v_mfma_f32_16x16x32_bf16 v[60:63], a[208:211], v[40:43], v[60:63]
ds_read_b128 v[32:35], v11 offset:59392
v_mfma_f32_16x16x32_bf16 v[64:67], a[212:215], v[40:43], v[64:67]
s_waitcnt lgkmcnt(4)
v_mfma_f32_16x16x32_bf16 v[52:55], a[216:219], v[44:47], v[52:55]
ds_read_b128 v[36:39], v10 offset:61440
v_mfma_f32_16x16x32_bf16 v[56:59], a[220:223], v[44:47], v[56:59]
v_mfma_f32_16x16x32_bf16 v[60:63], a[216:219], v[48:51], v[60:63]
ds_read_b128 v[40:43], v10 offset:63488
v_mfma_f32_16x16x32_bf16 v[64:67], a[220:223], v[48:51], v[64:67]
s_waitcnt lgkmcnt(4)
v_mfma_f32_16x16x32_bf16 v[52:55], a[224:227], v[20:23], v[52:55]
ds_read_b128 v[44:47], v11 offset:61440
v_mfma_f32_16x16x32_bf16 v[56:59], a[228:231], v[20:23], v[56:59]
v_mfma_f32_16x16x32_bf16 v[60:63], a[224:227], v[24:27], v[60:63]
ds_read_b128 v[48:51], v11 offset:63488
v_mfma_f32_16x16x32_bf16 v[64:67], a[228:231], v[24:27], v[64:67]
s_waitcnt lgkmcnt(5)
v_mfma_f32_16x16x32_bf16 v[52:55], a[232:235], v[28:31], v[52:55]
v_mfma_f32_16x16x32_bf16 v[56:59], a[236:239], v[28:31], v[56:59]
s_waitcnt lgkmcnt(4)
v_mfma_f32_16x16x32_bf16 v[60:63], a[232:235], v[32:35], v[60:63]
v_mfma_f32_16x16x32_bf16 v[64:67], a[236:239], v[32:35], v[64:67]
s_waitcnt lgkmcnt(3)
v_mfma_f32_16x16x32_bf16 v[52:55], a[240:243], v[36:39], v[52:55]
v_mfma_f32_16x16x32_bf16 v[56:59], a[244:247], v[36:39], v[56:59]
s_waitcnt lgkmcnt(2)
v_mfma_f32_16x16x32_bf16 v[60:63], a[240:243], v[40:43], v[60:63]
v_mfma_f32_16x16x32_bf16 v[64:67], a[244:247], v[40:43], v[64:67]
s_waitcnt lgkmcnt(1)
v_mfma_f32_16x16x32_bf16 v[52:55], a[248:251], v[44:47], v[52:55]
v_mfma_f32_16x16x32_bf16 v[56:59], a[252:255], v[44:47], v[56:59]
s_waitcnt lgkmcnt(0)
v_mfma_f32_16x16x32_bf16 v[60:63], a[248:251], v[48:51], v[60:63]
v_mfma_f32_16x16x32_bf16 v[64:67], a[252:255], v[48:51], v[64:67]
s_waitcnt vmcnt(0)
s_barrier
s_mov_b32 s50, 0x30000
s_nop 5
v_cvt_pk_bf16_f32 v228, v52, v53
v_cvt_pk_bf16_f32 v229, v54, v55
v_cvt_pk_bf16_f32 v230, v56, v57
v_cvt_pk_bf16_f32 v231, v58, v59
v_cvt_pk_bf16_f32 v232, v60, v61
v_cvt_pk_bf16_f32 v233, v62, v63
v_cvt_pk_bf16_f32 v234, v64, v65
v_cvt_pk_bf16_f32 v235, v66, v67
ds_read_b128 v[20:23], v8 offset:0
ds_read_b128 v[24:27], v8 offset:2048
ds_read_b128 v[28:31], v9 offset:0
ds_read_b128 v[32:35], v9 offset:2048
ds_read_b128 v[36:39], v8 offset:4096
ds_read_b128 v[40:43], v8 offset:6144
s_add_u32 m0, s46, 65536
s_waitcnt lgkmcnt(4)
v_mfma_f32_16x16x32_bf16 v[52:55], a[0:3], v[20:23], 0
ds_read_b128 v[44:47], v9 offset:4096
v_mfma_f32_16x16x32_bf16 v[56:59], a[4:7], v[20:23], 0
buffer_load_dwordx4 v6, s[8:11], s50 offen offset:0 lds
v_mfma_f32_16x16x32_bf16 v[60:63], a[0:3], v[24:27], 0
ds_read_b128 v[48:51], v9 offset:6144
v_mfma_f32_16x16x32_bf16 v[64:67], a[4:7], v[24:27], 0
s_add_u32 m0, s46, 69504
s_waitcnt lgkmcnt(4)
v_mfma_f32_16x16x32_bf16 v[52:55], a[8:11], v[28:31], v[52:55]
ds_read_b128 v[20:23], v8 offset:8192
v_mfma_f32_16x16x32_bf16 v[56:59], a[12:15], v[28:31], v[56:59]
buffer_load_dwordx4 v6, s[8:11], s50 offen offset:128 lds
v_mfma_f32_16x16x32_bf16 v[60:63], a[8:11], v[32:35], v[60:63]
ds_read_b128 v[24:27], v8 offset:10240
v_mfma_f32_16x16x32_bf16 v[64:67], a[12:15], v[32:35], v[64:67]
s_add_u32 m0, s46, 73472
s_waitcnt lgkmcnt(4)
v_mfma_f32_16x16x32_bf16 v[52:55], a[16:19], v[36:39], v[52:55]
ds_read_b128 v[28:31], v9 offset:8192
v_mfma_f32_16x16x32_bf16 v[56:59], a[20:23], v[36:39], v[56:59]
buffer_load_dwordx4 v6, s[8:11], s50 offen offset:256 lds
v_mfma_f32_16x16x32_bf16 v[60:63], a[16:19], v[40:43], v[60:63]
ds_read_b128 v[32:35], v9 offset:10240
v_mfma_f32_16x16x32_bf16 v[64:67], a[20:23], v[40:43], v[64:67]
s_add_u32 m0, s46, 77440
s_waitcnt lgkmcnt(4)
v_mfma_f32_16x16x32_bf16 v[52:55], a[24:27], v[44:47], v[52:55]
ds_read_b128 v[36:39], v8 offset:12288
v_mfma_f32_16x16x32_bf16 v[56:59], a[28:31], v[44:47], v[56:59]
buffer_load_dwordx4 v6, s[8:11], s50 offen offset:384 lds
v_mfma_f32_16x16x32_bf16 v[60:63], a[24:27], v[48:51], v[60:63]
ds_read_b128 v[40:43], v8 offset:14336
v_mfma_f32_16x16x32_bf16 v[64:67], a[28:31], v[48:51], v[64:67]
s_add_u32 m0, s46, 81408
s_waitcnt lgkmcnt(4)
v_mfma_f32_16x16x32_bf16 v[52:55], a[32:35], v[20:23], v[52:55]
ds_read_b128 v[44:47], v9 offset:12288
v_mfma_f32_16x16x32_bf16 v[56:59], a[36:39], v[20:23], v[56:59]
buffer_load_dwordx4 v6, s[8:11], s50 offen offset:512 lds
v_mfma_f32_16x16x32_bf16 v[60:63], a[32:35], v[24:27], v[60:63]
ds_read_b128 v[48:51], v9 offset:14336
v_mfma_f32_16x16x32_bf16 v[64:67], a[36:39], v[24:27], v[64:67]
s_add_u32 m0, s46, 85376
s_waitcnt lgkmcnt(4)
v_mfma_f32_16x16x32_bf16 v[52:55], a[40:43], v[28:31], v[52:55]
ds_read_b128 v[20:23], v8 offset:16384
v_mfma_f32_16x16x32_bf16 v[56:59], a[44:47], v[28:31], v[56:59]
buffer_load_dwordx4 v6, s[8:11], s50 offen offset:640 lds
v_mfma_f32_16x16x32_bf16 v[60:63], a[40:43], v[32:35], v[60:63]
ds_read_b128 v[24:27], v8 offset:18432
v_mfma_f32_16x16x32_bf16 v[64:67], a[44:47], v[32:35], v[64:67]
s_add_u32 m0, s46, 89344
s_waitcnt lgkmcnt(4)
v_mfma_f32_16x16x32_bf16 v[52:55], a[48:51], v[36:39], v[52:55]
ds_read_b128 v[28:31], v9 offset:16384
v_mfma_f32_16x16x32_bf16 v[56:59], a[52:55], v[36:39], v[56:59]
buffer_load_dwordx4 v6, s[8:11], s50 offen offset:768 lds
v_mfma_f32_16x16x32_bf16 v[60:63], a[48:51], v[40:43], v[60:63]
ds_read_b128 v[32:35], v9 offset:18432
v_mfma_f32_16x16x32_bf16 v[64:67], a[52:55], v[40:43], v[64:67]
s_add_u32 m0, s46, 93312
s_waitcnt lgkmcnt(4)
v_mfma_f32_16x16x32_bf16 v[52:55], a[56:59], v[44:47], v[52:55]
ds_read_b128 v[36:39], v8 offset:20480
v_mfma_f32_16x16x32_bf16 v[56:59], a[60:63], v[44:47], v[56:59]
buffer_load_dwordx4 v6, s[8:11], s50 offen offset:896 lds
v_mfma_f32_16x16x32_bf16 v[60:63], a[56:59], v[48:51], v[60:63]
ds_read_b128 v[40:43], v8 offset:22528
v_mfma_f32_16x16x32_bf16 v[64:67], a[60:63], v[48:51], v[64:67]
s_add_u32 m0, s46, 97280
s_waitcnt lgkmcnt(4)
v_mfma_f32_16x16x32_bf16 v[52:55], a[64:67], v[20:23], v[52:55]
ds_read_b128 v[44:47], v9 offset:20480
v_mfma_f32_16x16x32_bf16 v[56:59], a[68:71], v[20:23], v[56:59]
buffer_load_dwordx4 v6, s[8:11], s50 offen offset:1024 lds
v_mfma_f32_16x16x32_bf16 v[60:63], a[64:67], v[24:27], v[60:63]
ds_read_b128 v[48:51], v9 offset:22528
v_mfma_f32_16x16x32_bf16 v[64:67], a[68:71], v[24:27], v[64:67]
s_add_u32 m0, s46, 101248
s_waitcnt lgkmcnt(4)
v_mfma_f32_16x16x32_bf16 v[52:55], a[72:75], v[28:31], v[52:55]
ds_read_b128 v[20:23], v8 offset:24576
v_mfma_f32_16x16x32_bf16 v[56:59], a[76:79], v[28:31], v[56:59]
buffer_load_dwordx4 v6, s[8:11], s50 offen offset:1152 lds
v_mfma_f32_16x16x32_bf16 v[60:63], a[72:75], v[32:35], v[60:63]
ds_read_b128 v[24:27], v8 offset:26624
v_mfma_f32_16x16x32_bf16 v[64:67], a[76:79], v[32:35], v[64:67]
s_add_u32 m0, s46, 105216
s_waitcnt lgkmcnt(4)
v_mfma_f32_16x16x32_bf16 v[52:55], a[80:83], v[36:39], v[52:55]
ds_read_b128 v[28:31], v9 offset:24576
v_mfma_f32_16x16x32_bf16 v[56:59], a[84:87], v[36:39], v[56:59]
buffer_load_dwordx4 v6, s[8:11], s50 offen offset:1280 lds
v_mfma_f32_16x16x32_bf16 v[60:63], a[80:83], v[40:43], v[60:63]
ds_read_b128 v[32:35], v9 offset:26624
v_mfma_f32_16x16x32_bf16 v[64:67], a[84:87], v[40:43], v[64:67]
s_add_u32 m0, s46, 109184
s_waitcnt lgkmcnt(4)
v_mfma_f32_16x16x32_bf16 v[52:55], a[88:91], v[44:47], v[52:55]
ds_read_b128 v[36:39], v8 offset:28672
v_mfma_f32_16x16x32_bf16 v[56:59], a[92:95], v[44:47], v[56:59]
buffer_load_dwordx4 v6, s[8:11], s50 offen offset:1408 lds
v_mfma_f32_16x16x32_bf16 v[60:63], a[88:91], v[48:51], v[60:63]
ds_read_b128 v[40:43], v8 offset:30720
v_mfma_f32_16x16x32_bf16 v[64:67], a[92:95], v[48:51], v[64:67]
s_add_u32 m0, s46, 113152
s_waitcnt lgkmcnt(4)
v_mfma_f32_16x16x32_bf16 v[52:55], a[96:99], v[20:23], v[52:55]
ds_read_b128 v[44:47], v9 offset:28672
v_mfma_f32_16x16x32_bf16 v[56:59], a[100:103], v[20:23], v[56:59]
buffer_load_dwordx4 v6, s[8:11], s50 offen offset:1536 lds
v_mfma_f32_16x16x32_bf16 v[60:63], a[96:99], v[24:27], v[60:63]
ds_read_b128 v[48:51], v9 offset:30720
v_mfma_f32_16x16x32_bf16 v[64:67], a[100:103], v[24:27], v[64:67]
s_add_u32 m0, s46, 117120
s_waitcnt lgkmcnt(4)
v_mfma_f32_16x16x32_bf16 v[52:55], a[104:107], v[28:31], v[52:55]
ds_read_b128 v[20:23], v8 offset:32768
v_mfma_f32_16x16x32_bf16 v[56:59], a[108:111], v[28:31], v[56:59]
buffer_load_dwordx4 v6, s[8:11], s50 offen offset:1664 lds
v_mfma_f32_16x16x32_bf16 v[60:63], a[104:107], v[32:35], v[60:63]
ds_read_b128 v[24:27], v8 offset:34816
v_mfma_f32_16x16x32_bf16 v[64:67], a[108:111], v[32:35], v[64:67]
s_add_u32 m0, s46, 121088
s_waitcnt lgkmcnt(4)
v_mfma_f32_16x16x32_bf16 v[52:55], a[112:115], v[36:39], v[52:55]
ds_read_b128 v[28:31], v9 offset:32768
v_mfma_f32_16x16x32_bf16 v[56:59], a[116:119], v[36:39], v[56:59]
buffer_load_dwordx4 v6, s[8:11], s50 offen offset:1792 lds
v_mfma_f32_16x16x32_bf16 v[60:63], a[112:115], v[40:43], v[60:63]
ds_read_b128 v[32:35], v9 offset:34816
v_mfma_f32_16x16x32_bf16 v[64:67], a[116:119], v[40:43], v[64:67]
s_add_u32 m0, s46, 125056
s_waitcnt lgkmcnt(4)
v_mfma_f32_16x16x32_bf16 v[52:55], a[120:123], v[44:47], v[52:55]
ds_read_b128 v[36:39], v8 offset:36864
v_mfma_f32_16x16x32_bf16 v[56:59], a[124:127], v[44:47], v[56:59]
buffer_load_dwordx4 v6, s[8:11], s50 offen offset:1920 lds
v_mfma_f32_16x16x32_bf16 v[60:63], a[120:123], v[48:51], v[60:63]
ds_read_b128 v[40:43], v8 offset:38912
v_mfma_f32_16x16x32_bf16 v[64:67], a[124:127], v[48:51], v[64:67]
s_waitcnt lgkmcnt(4)
v_mfma_f32_16x16x32_bf16 v[52:55], a[128:131], v[20:23], v[52:55]
ds_read_b128 v[44:47], v9 offset:36864
v_mfma_f32_16x16x32_bf16 v[56:59], a[132:135], v[20:23], v[56:59]
v_mfma_f32_16x16x32_bf16 v[60:63], a[128:131], v[24:27], v[60:63]
ds_read_b128 v[48:51], v9 offset:38912
v_mfma_f32_16x16x32_bf16 v[64:67], a[132:135], v[24:27], v[64:67]
s_waitcnt lgkmcnt(4)
v_mfma_f32_16x16x32_bf16 v[52:55], a[136:139], v[28:31], v[52:55]
ds_read_b128 v[20:23], v8 offset:40960
v_mfma_f32_16x16x32_bf16 v[56:59], a[140:143], v[28:31], v[56:59]
v_mfma_f32_16x16x32_bf16 v[60:63], a[136:139], v[32:35], v[60:63]
ds_read_b128 v[24:27], v8 offset:43008
v_mfma_f32_16x16x32_bf16 v[64:67], a[140:143], v[32:35], v[64:67]
s_waitcnt lgkmcnt(4)
v_mfma_f32_16x16x32_bf16 v[52:55], a[144:147], v[36:39], v[52:55]
ds_read_b128 v[28:31], v9 offset:40960
v_mfma_f32_16x16x32_bf16 v[56:59], a[148:151], v[36:39], v[56:59]
v_mfma_f32_16x16x32_bf16 v[60:63], a[144:147], v[40:43], v[60:63]
ds_read_b128 v[32:35], v9 offset:43008
v_mfma_f32_16x16x32_bf16 v[64:67], a[148:151], v[40:43], v[64:67]
s_waitcnt lgkmcnt(4)
v_mfma_f32_16x16x32_bf16 v[52:55], a[152:155], v[44:47], v[52:55]
ds_read_b128 v[36:39], v8 offset:45056
v_mfma_f32_16x16x32_bf16 v[56:59], a[156:159], v[44:47], v[56:59]
v_mfma_f32_16x16x32_bf16 v[60:63], a[152:155], v[48:51], v[60:63]
ds_read_b128 v[40:43], v8 offset:47104
v_mfma_f32_16x16x32_bf16 v[64:67], a[156:159], v[48:51], v[64:67]
s_waitcnt lgkmcnt(4)
v_mfma_f32_16x16x32_bf16 v[52:55], a[160:163], v[20:23], v[52:55]
ds_read_b128 v[44:47], v9 offset:45056
v_mfma_f32_16x16x32_bf16 v[56:59], a[164:167], v[20:23], v[56:59]
v_mfma_f32_16x16x32_bf16 v[60:63], a[160:163], v[24:27], v[60:63]
ds_read_b128 v[48:51], v9 offset:47104
v_mfma_f32_16x16x32_bf16 v[64:67], a[164:167], v[24:27], v[64:67]
s_waitcnt lgkmcnt(4)
v_mfma_f32_16x16x32_bf16 v[52:55], a[168:171], v[28:31], v[52:55]
ds_read_b128 v[20:23], v8 offset:49152
v_mfma_f32_16x16x32_bf16 v[56:59], a[172:175], v[28:31], v[56:59]
v_mfma_f32_16x16x32_bf16 v[60:63], a[168:171], v[32:35], v[60:63]
ds_read_b128 v[24:27], v8 offset:51200
v_mfma_f32_16x16x32_bf16 v[64:67], a[172:175], v[32:35], v[64:67]
s_waitcnt lgkmcnt(4)
v_mfma_f32_16x16x32_bf16 v[52:55], a[176:179], v[36:39], v[52:55]
ds_read_b128 v[28:31], v9 offset:49152
v_mfma_f32_16x16x32_bf16 v[56:59], a[180:183], v[36:39], v[56:59]
v_mfma_f32_16x16x32_bf16 v[60:63], a[176:179], v[40:43], v[60:63]
ds_read_b128 v[32:35], v9 offset:51200
v_mfma_f32_16x16x32_bf16 v[64:67], a[180:183], v[40:43], v[64:67]
s_waitcnt lgkmcnt(4)
v_mfma_f32_16x16x32_bf16 v[52:55], a[184:187], v[44:47], v[52:55]
ds_read_b128 v[36:39], v8 offset:53248
v_mfma_f32_16x16x32_bf16 v[56:59], a[188:191], v[44:47], v[56:59]
v_mfma_f32_16x16x32_bf16 v[60:63], a[184:187], v[48:51], v[60:63]
ds_read_b128 v[40:43], v8 offset:55296
v_mfma_f32_16x16x32_bf16 v[64:67], a[188:191], v[48:51], v[64:67]
s_waitcnt lgkmcnt(4)
v_mfma_f32_16x16x32_bf16 v[52:55], a[192:195], v[20:23], v[52:55]
ds_read_b128 v[44:47], v9 offset:53248
v_mfma_f32_16x16x32_bf16 v[56:59], a[196:199], v[20:23], v[56:59]
v_mfma_f32_16x16x32_bf16 v[60:63], a[192:195], v[24:27], v[60:63]
ds_read_b128 v[48:51], v9 offset:55296
v_mfma_f32_16x16x32_bf16 v[64:67], a[196:199], v[24:27], v[64:67]
s_waitcnt lgkmcnt(4)
v_mfma_f32_16x16x32_bf16 v[52:55], a[200:203], v[28:31], v[52:55]
ds_read_b128 v[20:23], v8 offset:57344
v_mfma_f32_16x16x32_bf16 v[56:59], a[204:207], v[28:31], v[56:59]
v_mfma_f32_16x16x32_bf16 v[60:63], a[200:203], v[32:35], v[60:63]
ds_read_b128 v[24:27], v8 offset:59392
v_mfma_f32_16x16x32_bf16 v[64:67], a[204:207], v[32:35], v[64:67]
s_waitcnt lgkmcnt(4)
v_mfma_f32_16x16x32_bf16 v[52:55], a[208:211], v[36:39], v[52:55]
ds_read_b128 v[28:31], v9 offset:57344
v_mfma_f32_16x16x32_bf16 v[56:59], a[212:215], v[36:39], v[56:59]
v_mfma_f32_16x16x32_bf16 v[60:63], a[208:211], v[40:43], v[60:63]
ds_read_b128 v[32:35], v9 offset:59392
v_mfma_f32_16x16x32_bf16 v[64:67], a[212:215], v[40:43], v[64:67]
s_waitcnt lgkmcnt(4)
v_mfma_f32_16x16x32_bf16 v[52:55], a[216:219], v[44:47], v[52:55]
ds_read_b128 v[36:39], v8 offset:61440
v_mfma_f32_16x16x32_bf16 v[56:59], a[220:223], v[44:47], v[56:59]
v_mfma_f32_16x16x32_bf16 v[60:63], a[216:219], v[48:51], v[60:63]
ds_read_b128 v[40:43], v8 offset:63488
v_mfma_f32_16x16x32_bf16 v[64:67], a[220:223], v[48:51], v[64:67]
s_waitcnt lgkmcnt(4)
v_mfma_f32_16x16x32_bf16 v[52:55], a[224:227], v[20:23], v[52:55]
ds_read_b128 v[44:47], v9 offset:61440
v_mfma_f32_16x16x32_bf16 v[56:59], a[228:231], v[20:23], v[56:59]
v_mfma_f32_16x16x32_bf16 v[60:63], a[224:227], v[24:27], v[60:63]
ds_read_b128 v[48:51], v9 offset:63488
v_mfma_f32_16x16x32_bf16 v[64:67], a[228:231], v[24:27], v[64:67]
s_waitcnt lgkmcnt(5)
v_mfma_f32_16x16x32_bf16 v[52:55], a[232:235], v[28:31], v[52:55]
v_mfma_f32_16x16x32_bf16 v[56:59], a[236:239], v[28:31], v[56:59]
s_waitcnt lgkmcnt(4)
v_mfma_f32_16x16x32_bf16 v[60:63], a[232:235], v[32:35], v[60:63]
v_mfma_f32_16x16x32_bf16 v[64:67], a[236:239], v[32:35], v[64:67]
s_waitcnt lgkmcnt(3)
v_mfma_f32_16x16x32_bf16 v[52:55], a[240:243], v[36:39], v[52:55]
v_mfma_f32_16x16x32_bf16 v[56:59], a[244:247], v[36:39], v[56:59]
s_waitcnt lgkmcnt(2)
v_mfma_f32_16x16x32_bf16 v[60:63], a[240:243], v[40:43], v[60:63]
v_mfma_f32_16x16x32_bf16 v[64:67], a[244:247], v[40:43], v[64:67]
s_waitcnt lgkmcnt(1)
v_mfma_f32_16x16x32_bf16 v[68:71], a[248:251], v[44:47], v[52:55]
v_mfma_f32_16x16x32_bf16 v[72:75], a[252:255], v[44:47], v[56:59]
s_waitcnt lgkmcnt(0)
v_mfma_f32_16x16x32_bf16 v[76:79], a[248:251], v[48:51], v[60:63]
v_mfma_f32_16x16x32_bf16 v[80:83], a[252:255], v[48:51], v[64:67]
s_waitcnt vmcnt(0)
mega_kernel_q_loop:
s_barrier
s_cmp_gt_i32 s55, s42
s_cbranch_scc1 mega_kernel_q_kv1k
mega_kernel_q_kv1w:
v_mov_b32 v2, 0
s_mov_b64 exec, 0xff
buffer_atomic_add v2, v99, s[84:87], 0 offen sc0 sc1
s_mov_b64 exec, -1
s_waitcnt vmcnt(0)
v_min_i32_dpp v2, v2, v2 quad_perm:[1,0,3,2] row_mask:0xf bank_mask:0xf
s_nop 1
v_min_i32_dpp v2, v2, v2 quad_perm:[2,3,0,1] row_mask:0xf bank_mask:0xf
s_nop 1
v_min_i32_dpp v2, v2, v2 row_half_mirror row_mask:0xf bank_mask:0xf
s_nop 0
v_readfirstlane_b32 s55, v2
s_cmp_gt_i32 s55, s42
s_cbranch_scc1 mega_kernel_q_kv1k
s_sleep 4
s_branch mega_kernel_q_kv1w
mega_kernel_q_kv1k:
s_cmp_ge_u32 s42, 61
s_cbranch_scc0 mega_kernel_q_nl1
s_add_u32 s51, s47, s42
s_bfe_u32 s57, s51, 0x40002
s_lshl_b32 s57, s57, 14
s_and_b32 s66, s51, 3
s_lshl_b32 s66, s66, 11
s_add_u32 s66, s66, s57
s_add_u32 s66, s66, s58
s_add_u32 s67, s66, 33554432
s_bfe_u32 s57, s51, 0x30003
s_lshl_b32 s57, s57, 14
s_and_b32 s68, s51, 7
s_lshl_b32 s68, s68, 10
s_add_u32 s68, s68, s57
s_add_u32 s68, s68, s59
s_add_u32 s50, s42, 4
s_min_u32 s50, s50, 63
s_lshl_b32 s50, s50, 16
s_cmp_gt_i32 s56, s42
s_cselect_b32 s30, 1, 0
s_add_u32 m0, s60, 0
s_nop 0
buffer_load_dwordx4 v5, s[84:87], s66 offen offset:0 sc1 lds
s_add_u32 m0, s60, 0
s_nop 0
buffer_load_dwordx4 v5, s[84:87], s66 offen offset:1024 sc1 lds
s_add_u32 m0, s60, 8192
s_nop 0
buffer_load_dwordx4 v5, s[84:87], s67 offen offset:0 sc1 lds
s_add_u32 m0, s60, 8192
s_nop 0
buffer_load_dwordx4 v5, s[84:87], s67 offen offset:1024 sc1 lds
s_cmp_eq_u32 s30, 1
s_cbranch_scc0 mega_kernel_q_kx1
s_mov_b32 m0, s61
s_nop 0
buffer_load_dwordx4 v5, s[84:87], s68 offen sc1 lds
mega_kernel_q_kx1:
v_mov_b64 v[84:85], v[220:221]
v_mov_b64 v[86:87], v[222:223]
v_mov_b64 v[88:89], v[224:225]
v_mov_b64 v[90:91], v[226:227]
v_mov_b64 v[220:221], v[228:229]
v_mov_b64 v[222:223], v[230:231]
v_mov_b64 v[224:225], v[232:233]
v_mov_b64 v[226:227], v[234:235]
v_cvt_pk_bf16_f32 v228, v68, v69
v_cvt_pk_bf16_f32 v229, v70, v71
v_cvt_pk_bf16_f32 v230, v72, v73
v_cvt_pk_bf16_f32 v231, v74, v75
v_cvt_pk_bf16_f32 v232, v76, v77
v_cvt_pk_bf16_f32 v233, v78, v79
v_cvt_pk_bf16_f32 v234, v80, v81
v_cvt_pk_bf16_f32 v235, v82, v83
ds_write_b128 v101, v[84:87]
ds_write_b128 v101, v[88:91] offset:1024
s_waitcnt vmcnt(4)
v_mov_b32 v17, s42
s_mov_b64 exec, 1
buffer_store_dword v17, v16, s[84:87], s49 offen sc1
s_mov_b64 exec, -1
s_branch mega_kernel_q_jl1
mega_kernel_q_nl1:
ds_read_b128 v[20:23], v10 offset:0
ds_read_b128 v[24:27], v10 offset:2048
ds_read_b128 v[28:31], v11 offset:0
ds_read_b128 v[32:35], v11 offset:2048
ds_read_b128 v[36:39], v10 offset:4096
ds_read_b128 v[40:43], v10 offset:6144
s_add_u32 s51, s47, s42
s_bfe_u32 s57, s51, 0x40002
s_lshl_b32 s57, s57, 14
s_and_b32 s66, s51, 3
s_lshl_b32 s66, s66, 11
s_add_u32 s66, s66, s57
s_add_u32 s66, s66, s58
s_add_u32 s67, s66, 33554432
s_bfe_u32 s57, s51, 0x30003
s_lshl_b32 s57, s57, 14
s_and_b32 s68, s51, 7
s_lshl_b32 s68, s68, 10
s_add_u32 s68, s68, s57
s_add_u32 s68, s68, s59
s_add_u32 s50, s42, 4
s_min_u32 s50, s50, 63
s_lshl_b32 s50, s50, 16
s_cmp_gt_i32 s56, s42
s_cselect_b32 s30, 1, 0
s_add_u32 m0, s60, 0
s_waitcnt lgkmcnt(4)
v_mfma_f32_16x16x32_bf16 v[52:55], a[0:3], v[20:23], 0
ds_read_b128 v[44:47], v11 offset:4096
v_mfma_f32_16x16x32_bf16 v[56:59], a[4:7], v[20:23], 0
buffer_load_dwordx4 v5, s[84:87], s66 offen offset:0 sc1 lds
v_mfma_f32_16x16x32_bf16 v[60:63], a[0:3], v[24:27], 0
ds_read_b128 v[48:51], v11 offset:6144
v_mfma_f32_16x16x32_bf16 v[64:67], a[4:7], v[24:27], 0
s_add_u32 m0, s60, 0
s_waitcnt lgkmcnt(4)
v_mfma_f32_16x16x32_bf16 v[52:55], a[8:11], v[28:31], v[52:55]
ds_read_b128 v[20:23], v10 offset:8192
v_mfma_f32_16x16x32_bf16 v[56:59], a[12:15], v[28:31], v[56:59]
buffer_load_dwordx4 v5, s[84:87], s66 offen offset:1024 sc1 lds
v_mfma_f32_16x16x32_bf16 v[60:63], a[8:11], v[32:35], v[60:63]
ds_read_b128 v[24:27], v10 offset:10240
v_mfma_f32_16x16x32_bf16 v[64:67], a[12:15], v[32:35], v[64:67]
s_add_u32 m0, s60, 8192
s_waitcnt lgkmcnt(4)
v_mfma_f32_16x16x32_bf16 v[52:55], a[16:19], v[36:39], v[52:55]
ds_read_b128 v[28:31], v11 offset:8192
v_mfma_f32_16x16x32_bf16 v[56:59], a[20:23], v[36:39], v[56:59]
buffer_load_dwordx4 v5, s[84:87], s67 offen offset:0 sc1 lds
v_mfma_f32_16x16x32_bf16 v[60:63], a[16:19], v[40:43], v[60:63]
ds_read_b128 v[32:35], v11 offset:10240
v_mfma_f32_16x16x32_bf16 v[64:67], a[20:23], v[40:43], v[64:67]
s_add_u32 m0, s60, 8192
s_waitcnt lgkmcnt(4)
v_mfma_f32_16x16x32_bf16 v[52:55], a[24:27], v[44:47], v[52:55]
ds_read_b128 v[36:39], v10 offset:12288
v_mfma_f32_16x16x32_bf16 v[56:59], a[28:31], v[44:47], v[56:59]
buffer_load_dwordx4 v5, s[84:87], s67 offen offset:1024 sc1 lds
v_mfma_f32_16x16x32_bf16 v[60:63], a[24:27], v[48:51], v[60:63]
ds_read_b128 v[40:43], v10 offset:14336
v_mfma_f32_16x16x32_bf16 v[64:67], a[28:31], v[48:51], v[64:67]
s_waitcnt lgkmcnt(4)
v_mfma_f32_16x16x32_bf16 v[52:55], a[32:35], v[20:23], v[52:55]
ds_read_b128 v[44:47], v11 offset:12288
v_mfma_f32_16x16x32_bf16 v[56:59], a[36:39], v[20:23], v[56:59]
s_cmp_eq_u32 s30, 1
s_cbranch_scc0 mega_kernel_q_ke1
s_mov_b32 m0, s61
s_nop 0
buffer_load_dwordx4 v5, s[84:87], s68 offen sc1 lds
mega_kernel_q_ke1:
v_mfma_f32_16x16x32_bf16 v[60:63], a[32:35], v[24:27], v[60:63]
ds_read_b128 v[48:51], v11 offset:14336
v_mfma_f32_16x16x32_bf16 v[64:67], a[36:39], v[24:27], v[64:67]
s_add_u32 m0, s46, 0
s_waitcnt lgkmcnt(4)
v_mfma_f32_16x16x32_bf16 v[52:55], a[40:43], v[28:31], v[52:55]
ds_read_b128 v[20:23], v10 offset:16384
v_mfma_f32_16x16x32_bf16 v[56:59], a[44:47], v[28:31], v[56:59]
buffer_load_dwordx4 v6, s[8:11], s50 offen offset:0 lds
v_mfma_f32_16x16x32_bf16 v[60:63], a[40:43], v[32:35], v[60:63]
ds_read_b128 v[24:27], v10 offset:18432
v_mfma_f32_16x16x32_bf16 v[64:67], a[44:47], v[32:35], v[64:67]
s_add_u32 m0, s46, 3968
s_waitcnt lgkmcnt(4)
v_mfma_f32_16x16x32_bf16 v[52:55], a[48:51], v[36:39], v[52:55]
ds_read_b128 v[28:31], v11 offset:16384
v_mfma_f32_16x16x32_bf16 v[56:59], a[52:55], v[36:39], v[56:59]
buffer_load_dwordx4 v6, s[8:11], s50 offen offset:128 lds
v_mfma_f32_16x16x32_bf16 v[60:63], a[48:51], v[40:43], v[60:63]
ds_read_b128 v[32:35], v11 offset:18432
v_mfma_f32_16x16x32_bf16 v[64:67], a[52:55], v[40:43], v[64:67]
s_add_u32 m0, s46, 7936
s_waitcnt lgkmcnt(4)
v_mfma_f32_16x16x32_bf16 v[52:55], a[56:59], v[44:47], v[52:55]
ds_read_b128 v[36:39], v10 offset:20480
v_mfma_f32_16x16x32_bf16 v[56:59], a[60:63], v[44:47], v[56:59]
buffer_load_dwordx4 v6, s[8:11], s50 offen offset:256 lds
v_mfma_f32_16x16x32_bf16 v[60:63], a[56:59], v[48:51], v[60:63]
ds_read_b128 v[40:43], v10 offset:22528
v_mfma_f32_16x16x32_bf16 v[64:67], a[60:63], v[48:51], v[64:67]
s_add_u32 m0, s46, 11904
s_waitcnt lgkmcnt(4)
v_mfma_f32_16x16x32_bf16 v[52:55], a[64:67], v[20:23], v[52:55]
ds_read_b128 v[44:47], v11 offset:20480
v_mfma_f32_16x16x32_bf16 v[56:59], a[68:71], v[20:23], v[56:59]
buffer_load_dwordx4 v6, s[8:11], s50 offen offset:384 lds
v_mfma_f32_16x16x32_bf16 v[60:63], a[64:67], v[24:27], v[60:63]
ds_read_b128 v[48:51], v11 offset:22528
v_mfma_f32_16x16x32_bf16 v[64:67], a[68:71], v[24:27], v[64:67]
s_add_u32 m0, s46, 15872
s_waitcnt lgkmcnt(4)
v_mfma_f32_16x16x32_bf16 v[52:55], a[72:75], v[28:31], v[52:55]
ds_read_b128 v[20:23], v10 offset:24576
v_mfma_f32_16x16x32_bf16 v[56:59], a[76:79], v[28:31], v[56:59]
buffer_load_dwordx4 v6, s[8:11], s50 offen offset:512 lds
v_mfma_f32_16x16x32_bf16 v[60:63], a[72:75], v[32:35], v[60:63]
ds_read_b128 v[24:27], v10 offset:26624
v_mfma_f32_16x16x32_bf16 v[64:67], a[76:79], v[32:35], v[64:67]
s_add_u32 m0, s46, 19840
s_waitcnt lgkmcnt(4)
v_mfma_f32_16x16x32_bf16 v[52:55], a[80:83], v[36:39], v[52:55]
ds_read_b128 v[28:31], v11 offset:24576
v_mfma_f32_16x16x32_bf16 v[56:59], a[84:87], v[36:39], v[56:59]
buffer_load_dwordx4 v6, s[8:11], s50 offen offset:640 lds
v_mfma_f32_16x16x32_bf16 v[60:63], a[80:83], v[40:43], v[60:63]
ds_read_b128 v[32:35], v11 offset:26624
v_mfma_f32_16x16x32_bf16 v[64:67], a[84:87], v[40:43], v[64:67]
s_add_u32 m0, s46, 23808
s_waitcnt lgkmcnt(4)
v_mfma_f32_16x16x32_bf16 v[52:55], a[88:91], v[44:47], v[52:55]
ds_read_b128 v[36:39], v10 offset:28672
v_mfma_f32_16x16x32_bf16 v[56:59], a[92:95], v[44:47], v[56:59]
buffer_load_dwordx4 v6, s[8:11], s50 offen offset:768 lds
v_mfma_f32_16x16x32_bf16 v[60:63], a[88:91], v[48:51], v[60:63]
ds_read_b128 v[40:43], v10 offset:30720
v_mfma_f32_16x16x32_bf16 v[64:67], a[92:95], v[48:51], v[64:67]
s_add_u32 m0, s46, 27776
s_waitcnt lgkmcnt(4)
v_mfma_f32_16x16x32_bf16 v[52:55], a[96:99], v[20:23], v[52:55]
ds_read_b128 v[44:47], v11 offset:28672
v_mfma_f32_16x16x32_bf16 v[56:59], a[100:103], v[20:23], v[56:59]
buffer_load_dwordx4 v6, s[8:11], s50 offen offset:896 lds
v_mfma_f32_16x16x32_bf16 v[60:63], a[96:99], v[24:27], v[60:63]
ds_read_b128 v[48:51], v11 offset:30720
v_mfma_f32_16x16x32_bf16 v[64:67], a[100:103], v[24:27], v[64:67]
s_add_u32 m0, s46, 31744
s_waitcnt lgkmcnt(4)
v_mfma_f32_16x16x32_bf16 v[52:55], a[104:107], v[28:31], v[52:55]
ds_read_b128 v[20:23], v10 offset:32768
v_mfma_f32_16x16x32_bf16 v[56:59], a[108:111], v[28:31], v[56:59]
buffer_load_dwordx4 v6, s[8:11], s50 offen offset:1024 lds
v_mfma_f32_16x16x32_bf16 v[60:63], a[104:107], v[32:35], v[60:63]
ds_read_b128 v[24:27], v10 offset:34816
v_mfma_f32_16x16x32_bf16 v[64:67], a[108:111], v[32:35], v[64:67]
s_waitcnt vmcnt(13)
v_mov_b32 v17, s42
s_mov_b64 exec, 1
buffer_store_dword v17, v16, s[84:87], s49 offen sc1
s_mov_b64 exec, -1
s_add_u32 m0, s46, 35712
s_waitcnt lgkmcnt(4)
v_mfma_f32_16x16x32_bf16 v[52:55], a[112:115], v[36:39], v[52:55]
ds_read_b128 v[28:31], v11 offset:32768
v_mfma_f32_16x16x32_bf16 v[56:59], a[116:119], v[36:39], v[56:59]
buffer_load_dwordx4 v6, s[8:11], s50 offen offset:1152 lds
v_mfma_f32_16x16x32_bf16 v[60:63], a[112:115], v[40:43], v[60:63]
ds_read_b128 v[32:35], v11 offset:34816
v_mfma_f32_16x16x32_bf16 v[64:67], a[116:119], v[40:43], v[64:67]
v_mov_b32 v100, 0
s_mov_b64 exec, 1
buffer_atomic_add v100, v16, s[84:87], s62 offen sc0 sc1
s_mov_b64 exec, -1
s_add_u32 m0, s46, 39680
s_waitcnt lgkmcnt(4)
v_mfma_f32_16x16x32_bf16 v[52:55], a[120:123], v[44:47], v[52:55]
ds_read_b128 v[36:39], v10 offset:36864
v_mfma_f32_16x16x32_bf16 v[56:59], a[124:127], v[44:47], v[56:59]
buffer_load_dwordx4 v6, s[8:11], s50 offen offset:1280 lds
v_mfma_f32_16x16x32_bf16 v[60:63], a[120:123], v[48:51], v[60:63]
ds_read_b128 v[40:43], v10 offset:38912
v_mfma_f32_16x16x32_bf16 v[64:67], a[124:127], v[48:51], v[64:67]
s_add_u32 m0, s46, 43648
s_waitcnt lgkmcnt(4)
v_mfma_f32_16x16x32_bf16 v[52:55], a[128:131], v[20:23], v[52:55]
ds_read_b128 v[44:47], v11 offset:36864
v_mfma_f32_16x16x32_bf16 v[56:59], a[132:135], v[20:23], v[56:59]
buffer_load_dwordx4 v6, s[8:11], s50 offen offset:1408 lds
v_mfma_f32_16x16x32_bf16 v[60:63], a[128:131], v[24:27], v[60:63]
ds_read_b128 v[48:51], v11 offset:38912
v_mfma_f32_16x16x32_bf16 v[64:67], a[132:135], v[24:27], v[64:67]
s_add_u32 m0, s46, 47616
s_waitcnt lgkmcnt(4)
v_mfma_f32_16x16x32_bf16 v[52:55], a[136:139], v[28:31], v[52:55]
ds_read_b128 v[20:23], v10 offset:40960
v_mfma_f32_16x16x32_bf16 v[56:59], a[140:143], v[28:31], v[56:59]
buffer_load_dwordx4 v6, s[8:11], s50 offen offset:1536 lds
v_mfma_f32_16x16x32_bf16 v[60:63], a[136:139], v[32:35], v[60:63]
ds_read_b128 v[24:27], v10 offset:43008
v_mfma_f32_16x16x32_bf16 v[64:67], a[140:143], v[32:35], v[64:67]
s_add_u32 m0, s46, 51584
s_waitcnt lgkmcnt(4)
v_mfma_f32_16x16x32_bf16 v[52:55], a[144:147], v[36:39], v[52:55]
ds_read_b128 v[28:31], v11 offset:40960
v_mfma_f32_16x16x32_bf16 v[56:59], a[148:151], v[36:39], v[56:59]
buffer_load_dwordx4 v6, s[8:11], s50 offen offset:1664 lds
v_mfma_f32_16x16x32_bf16 v[60:63], a[144:147], v[40:43], v[60:63]
ds_read_b128 v[32:35], v11 offset:43008
v_mfma_f32_16x16x32_bf16 v[64:67], a[148:151], v[40:43], v[64:67]
s_add_u32 m0, s46, 55552
s_waitcnt lgkmcnt(4)
v_mfma_f32_16x16x32_bf16 v[52:55], a[152:155], v[44:47], v[52:55]
ds_read_b128 v[36:39], v10 offset:45056
v_mfma_f32_16x16x32_bf16 v[56:59], a[156:159], v[44:47], v[56:59]
buffer_load_dwordx4 v6, s[8:11], s50 offen offset:1792 lds
v_mfma_f32_16x16x32_bf16 v[60:63], a[152:155], v[48:51], v[60:63]
ds_read_b128 v[40:43], v10 offset:47104
v_mfma_f32_16x16x32_bf16 v[64:67], a[156:159], v[48:51], v[64:67]
s_add_u32 m0, s46, 59520
s_waitcnt lgkmcnt(4)
v_mfma_f32_16x16x32_bf16 v[52:55], a[160:163], v[20:23], v[52:55]
ds_read_b128 v[44:47], v11 offset:45056
v_mfma_f32_16x16x32_bf16 v[56:59], a[164:167], v[20:23], v[56:59]
buffer_load_dwordx4 v6, s[8:11], s50 offen offset:1920 lds
v_mfma_f32_16x16x32_bf16 v[60:63], a[160:163], v[24:27], v[60:63]
ds_read_b128 v[48:51], v11 offset:47104
v_mfma_f32_16x16x32_bf16 v[64:67], a[164:167], v[24:27], v[64:67]
s_waitcnt lgkmcnt(4)
v_mfma_f32_16x16x32_bf16 v[52:55], a[168:171], v[28:31], v[52:55]
ds_read_b128 v[20:23], v10 offset:49152
v_mfma_f32_16x16x32_bf16 v[56:59], a[172:175], v[28:31], v[56:59]
v_mov_b64 v[84:85], v[220:221]
v_mov_b64 v[86:87], v[222:223]
v_mfma_f32_16x16x32_bf16 v[60:63], a[168:171], v[32:35], v[60:63]
ds_read_b128 v[24:27], v10 offset:51200
v_mfma_f32_16x16x32_bf16 v[64:67], a[172:175], v[32:35], v[64:67]
v_mov_b64 v[88:89], v[224:225]
v_mov_b64 v[90:91], v[226:227]
s_waitcnt lgkmcnt(4)
v_mfma_f32_16x16x32_bf16 v[52:55], a[176:179], v[36:39], v[52:55]
ds_read_b128 v[28:31], v11 offset:49152
v_mfma_f32_16x16x32_bf16 v[56:59], a[180:183], v[36:39], v[56:59]
v_mov_b64 v[220:221], v[228:229]
v_mov_b64 v[222:223], v[230:231]
v_mfma_f32_16x16x32_bf16 v[60:63], a[176:179], v[40:43], v[60:63]
ds_read_b128 v[32:35], v11 offset:51200
v_mfma_f32_16x16x32_bf16 v[64:67], a[180:183], v[40:43], v[64:67]
v_mov_b64 v[224:225], v[232:233]
v_mov_b64 v[226:227], v[234:235]
s_waitcnt lgkmcnt(4)
v_mfma_f32_16x16x32_bf16 v[52:55], a[184:187], v[44:47], v[52:55]
ds_read_b128 v[36:39], v10 offset:53248
v_mfma_f32_16x16x32_bf16 v[56:59], a[188:191], v[44:47], v[56:59]
v_cvt_pk_bf16_f32 v228, v68, v69
v_cvt_pk_bf16_f32 v229, v70, v71
v_mfma_f32_16x16x32_bf16 v[60:63], a[184:187], v[48:51], v[60:63]
ds_read_b128 v[40:43], v10 offset:55296
v_mfma_f32_16x16x32_bf16 v[64:67], a[188:191], v[48:51], v[64:67]
v_cvt_pk_bf16_f32 v230, v72, v73
v_cvt_pk_bf16_f32 v231, v74, v75
s_waitcnt lgkmcnt(4)
v_mfma_f32_16x16x32_bf16 v[52:55], a[192:195], v[20:23], v[52:55]
ds_read_b128 v[44:47], v11 offset:53248
v_mfma_f32_16x16x32_bf16 v[56:59], a[196:199], v[20:23], v[56:59]
v_cvt_pk_bf16_f32 v232, v76, v77
v_cvt_pk_bf16_f32 v233, v78, v79
v_mfma_f32_16x16x32_bf16 v[60:63], a[192:195], v[24:27], v[60:63]
ds_read_b128 v[48:51], v11 offset:55296
v_mfma_f32_16x16x32_bf16 v[64:67], a[196:199], v[24:27], v[64:67]
v_cvt_pk_bf16_f32 v234, v80, v81
v_cvt_pk_bf16_f32 v235, v82, v83
s_waitcnt lgkmcnt(4)
v_mfma_f32_16x16x32_bf16 v[52:55], a[200:203], v[28:31], v[52:55]
ds_read_b128 v[20:23], v10 offset:57344
v_mfma_f32_16x16x32_bf16 v[56:59], a[204:207], v[28:31], v[56:59]
v_mfma_f32_16x16x32_bf16 v[60:63], a[200:203], v[32:35], v[60:63]
ds_read_b128 v[24:27], v10 offset:59392
v_mfma_f32_16x16x32_bf16 v[64:67], a[204:207], v[32:35], v[64:67]
s_waitcnt lgkmcnt(4)
v_mfma_f32_16x16x32_bf16 v[52:55], a[208:211], v[36:39], v[52:55]
ds_read_b128 v[28:31], v11 offset:57344
v_mfma_f32_16x16x32_bf16 v[56:59], a[212:215], v[36:39], v[56:59]
v_mfma_f32_16x16x32_bf16 v[60:63], a[208:211], v[40:43], v[60:63]
ds_read_b128 v[32:35], v11 offset:59392
v_mfma_f32_16x16x32_bf16 v[64:67], a[212:215], v[40:43], v[64:67]
s_waitcnt lgkmcnt(4)
v_mfma_f32_16x16x32_bf16 v[52:55], a[216:219], v[44:47], v[52:55]
ds_read_b128 v[36:39], v10 offset:61440
v_mfma_f32_16x16x32_bf16 v[56:59], a[220:223], v[44:47], v[56:59]
s_waitcnt vmcnt(6)
v_readfirstlane_b32 s56, v100
s_cmp_eq_u32 s30, 1
s_cbranch_scc1 mega_kernel_q_kf1
s_cmp_gt_i32 s56, s42
s_cbranch_scc0 mega_kernel_q_kf1
s_mov_b32 s30, 1
s_mov_b32 m0, s61
s_nop 0
buffer_load_dwordx4 v5, s[84:87], s68 offen sc1 lds
mega_kernel_q_kf1:
v_mfma_f32_16x16x32_bf16 v[60:63], a[216:219], v[48:51], v[60:63]
ds_read_b128 v[40:43], v10 offset:63488
v_mfma_f32_16x16x32_bf16 v[64:67], a[220:223], v[48:51], v[64:67]
s_waitcnt lgkmcnt(4)
v_mfma_f32_16x16x32_bf16 v[52:55], a[224:227], v[20:23], v[52:55]
ds_read_b128 v[44:47], v11 offset:61440
v_mfma_f32_16x16x32_bf16 v[56:59], a[228:231], v[20:23], v[56:59]
v_mfma_f32_16x16x32_bf16 v[60:63], a[224:227], v[24:27], v[60:63]
ds_read_b128 v[48:51], v11 offset:63488
v_mfma_f32_16x16x32_bf16 v[64:67], a[228:231], v[24:27], v[64:67]
s_waitcnt lgkmcnt(5)
v_mfma_f32_16x16x32_bf16 v[52:55], a[232:235], v[28:31], v[52:55]
v_mfma_f32_16x16x32_bf16 v[56:59], a[236:239], v[28:31], v[56:59]
s_waitcnt lgkmcnt(4)
v_mfma_f32_16x16x32_bf16 v[60:63], a[232:235], v[32:35], v[60:63]
v_mfma_f32_16x16x32_bf16 v[64:67], a[236:239], v[32:35], v[64:67]
s_waitcnt lgkmcnt(3)
v_mfma_f32_16x16x32_bf16 v[52:55], a[240:243], v[36:39], v[52:55]
v_mfma_f32_16x16x32_bf16 v[56:59], a[244:247], v[36:39], v[56:59]
s_waitcnt lgkmcnt(2)
v_mfma_f32_16x16x32_bf16 v[60:63], a[240:243], v[40:43], v[60:63]
v_mfma_f32_16x16x32_bf16 v[64:67], a[244:247], v[40:43], v[64:67]
ds_write_b128 v101, v[84:87]
ds_write_b128 v101, v[88:91] offset:1024
s_waitcnt lgkmcnt(1)
v_mfma_f32_16x16x32_bf16 v[68:71], a[248:251], v[44:47], v[52:55]
v_mfma_f32_16x16x32_bf16 v[72:75], a[252:255], v[44:47], v[56:59]
s_waitcnt lgkmcnt(0)
v_mfma_f32_16x16x32_bf16 v[76:79], a[248:251], v[48:51], v[60:63]
v_mfma_f32_16x16x32_bf16 v[80:83], a[252:255], v[48:51], v[64:67]
mega_kernel_q_jl1:
s_cmp_eq_u32 s30, 1
s_cbranch_scc1 mega_kernel_q_kl1
mega_kernel_q_kw1:
v_mov_b32 v100, 0
s_mov_b64 exec, 1
buffer_atomic_add v100, v16, s[84:87], s62 offen sc0 sc1
s_mov_b64 exec, -1
s_waitcnt vmcnt(0)
v_readfirstlane_b32 s56, v100
s_cmp_gt_i32 s56, s42
s_cbranch_scc0 mega_kernel_q_kw1
s_mov_b32 m0, s61
s_nop 0
buffer_load_dwordx4 v5, s[84:87], s68 offen sc1 lds
mega_kernel_q_kl1:
s_waitcnt lgkmcnt(0) vmcnt(0)
s_barrier
ds_read_b128 v[184:187], v102 offset:0
ds_read_b128 v[112:115], v103 offset:0
ds_read_b128 v[128:131], v103 offset:1024
ds_read_b128 v[188:191], v102 offset:2048
ds_read_b128 v[116:119], v103 offset:2048
ds_read_b128 v[132:135], v103 offset:3072
ds_read_b128 v[192:195], v102 offset:4096
ds_read_b128 v[120:123], v103 offset:4096
ds_read_b128 v[136:139], v103 offset:5120
ds_read_b128 v[196:199], v102 offset:6144
ds_read_b128 v[124:127], v103 offset:6144
ds_read_b128 v[140:143], v103 offset:7168
s_waitcnt lgkmcnt(9)
v_mfma_f32_16x16x32_bf16 v[200:203], v[112:115], v[184:187], 0
v_mfma_f32_16x16x32_bf16 v[204:207], v[128:131], v[184:187], 0
ds_read_b128 v[160:163], v94 offset:0
s_waitcnt lgkmcnt(7)
v_mfma_f32_16x16x32_bf16 v[200:203], v[116:119], v[188:191], v[200:203]
v_mfma_f32_16x16x32_bf16 v[204:207], v[132:135], v[188:191], v[204:207]
ds_read_b128 v[164:167], v94 offset:1024
s_waitcnt lgkmcnt(5)
v_mfma_f32_16x16x32_bf16 v[200:203], v[120:123], v[192:195], v[200:203]
v_mfma_f32_16x16x32_bf16 v[204:207], v[136:139], v[192:195], v[204:207]
ds_read_b128 v[168:171], v94 offset:2048
s_waitcnt lgkmcnt(3)
v_mfma_f32_16x16x32_bf16 v[200:203], v[124:127], v[196:199], v[200:203]
v_mfma_f32_16x16x32_bf16 v[204:207], v[140:143], v[196:199], v[204:207]
ds_read_b128 v[172:175], v94 offset:3072
s_waitcnt lgkmcnt(3)
v_mfma_f32_16x16x32_bf16 v[208:211], v[160:163], v[184:187], 0
ds_read_b128 v[144:147], v240 offset:0
ds_read_b64 v[176:177], v95 offset:0
s_waitcnt lgkmcnt(4)
v_mfma_f32_16x16x32_bf16 v[208:211], v[164:167], v[188:191], v[208:211]
ds_read_b128 v[148:151], v240 offset:1024
ds_read_b64 v[178:179], v95 offset:256
s_waitcnt lgkmcnt(5)
v_mfma_f32_16x16x32_bf16 v[208:211], v[168:171], v[192:195], v[208:211]
ds_read_b128 v[152:155], v240 offset:2048
ds_read_b64 v[180:181], v95 offset:1024
s_waitcnt lgkmcnt(6)
v_mfma_f32_16x16x32_bf16 v[208:211], v[172:175], v[196:199], v[208:211]
ds_read_b128 v[156:159], v240 offset:3072
ds_read_b64 v[182:183], v95 offset:1280
v_pk_mul_f32 v[200:201], v[200:201], s[54:55] op_sel_hi:[1,0]
v_pk_mul_f32 v[202:203], v[202:203], s[54:55] op_sel_hi:[1,0]
v_pk_mul_f32 v[204:205], v[204:205], s[54:55] op_sel_hi:[1,0]
v_pk_mul_f32 v[206:207], v[206:207], s[54:55] op_sel_hi:[1,0]
v_cndmask_b32 v200, v200, v241, s[12:13]
v_cndmask_b32 v201, v201, v241, s[14:15]
v_cndmask_b32 v202, v202, v241, s[16:17]
v_cndmask_b32 v203, v203, v241, s[18:19]
v_cndmask_b32 v204, v204, v241, s[20:21]
v_cndmask_b32 v205, v205, v241, s[22:23]
v_cndmask_b32 v206, v206, v241, s[24:25]
v_cndmask_b32 v207, v207, v241, s[26:27]
v_pk_mul_f32 v[208:209], v[208:209], s[54:55] op_sel_hi:[1,0]
v_pk_mul_f32 v[210:211], v[210:211], s[54:55] op_sel_hi:[1,0]
v_cndmask_b32 v208, v208, v97, s[28:29]
v_cndmask_b32 v209, v209, v97, s[28:29]
v_cndmask_b32 v210, v210, v97, s[28:29]
v_cndmask_b32 v211, v211, v97, s[28:29]
v_max3_f32 v236, v200, v201, v202
v_max3_f32 v236, v236, v203, v204
v_max3_f32 v236, v236, v205, v206
v_max3_f32 v236, v236, v207, v208
v_max3_f32 v236, v236, v209, v210
v_max_f32 v237, v236, v211
v_max_f32 v236, v236, v211
s_nop 1
v_permlane16_swap_b32 v236, v237
s_nop 0
v_max_f32 v238, v236, v237
v_max_f32 v239, v236, v237
s_nop 1
v_permlane32_swap_b32 v238, v239
s_nop 0
v_max_f32 v236, v238, v239
v_pk_add_f32 v[200:201], v[200:201], v[236:237] op_sel_hi:[1,0] neg_lo:[0,1] neg_hi:[0,1]
v_pk_add_f32 v[202:203], v[202:203], v[236:237] op_sel_hi:[1,0] neg_lo:[0,1] neg_hi:[0,1]
v_pk_add_f32 v[204:205], v[204:205], v[236:237] op_sel_hi:[1,0] neg_lo:[0,1] neg_hi:[0,1]
v_pk_add_f32 v[206:207], v[206:207], v[236:237] op_sel_hi:[1,0] neg_lo:[0,1] neg_hi:[0,1]
v_pk_add_f32 v[208:209], v[208:209], v[236:237] op_sel_hi:[1,0] neg_lo:[0,1] neg_hi:[0,1]
v_pk_add_f32 v[210:211], v[210:211], v[236:237] op_sel_hi:[1,0] neg_lo:[0,1] neg_hi:[0,1]
v_exp_f32 v200, v200
v_exp_f32 v201, v201
v_exp_f32 v202, v202
v_exp_f32 v203, v203
v_exp_f32 v204, v204
v_exp_f32 v205, v205
v_exp_f32 v206, v206
v_exp_f32 v207, v207
v_exp_f32 v208, v208
v_exp_f32 v209, v209
v_exp_f32 v210, v210
v_exp_f32 v211, v211
s_nop 0
v_cvt_pk_bf16_f32 v212, v200, v201
v_cvt_pk_bf16_f32 v213, v202, v203
v_cvt_pk_bf16_f32 v214, v204, v205
v_cvt_pk_bf16_f32 v215, v206, v207
v_cvt_pk_bf16_f32 v216, v208, v209
v_cvt_pk_bf16_f32 v217, v210, v211
s_waitcnt lgkmcnt(0)
s_nop 0
v_mfma_f32_16x16x32_bf16 v[108:111], v[104:107], v[212:215], 0
v_mfma_f32_16x16x32_bf16 v[112:115], v[144:147], v[212:215], 0
v_mfma_f32_16x16x32_bf16 v[116:119], v[148:151], v[212:215], 0
v_mfma_f32_16x16x32_bf16 v[120:123], v[152:155], v[212:215], 0
v_mfma_f32_16x16x32_bf16 v[124:127], v[156:159], v[212:215], 0
v_mfma_f32_16x16x16_bf16 v[108:111], v[104:105], v[216:217], v[108:111]
v_mfma_f32_16x16x16_bf16 v[112:115], v[176:177], v[216:217], v[112:115]
v_mfma_f32_16x16x16_bf16 v[116:119], v[178:179], v[216:217], v[116:119]
v_mfma_f32_16x16x16_bf16 v[120:123], v[180:181], v[216:217], v[120:123]
v_mfma_f32_16x16x16_bf16 v[124:127], v[182:183], v[216:217], v[124:127]
s_lshl_b32 s51, s42, 18
s_nop 2
v_rcp_f32 v238, v108
v_rcp_f32 v239, v109
s_nop 1
v_pk_mul_f32 v[112:113], v[112:113], v[238:239]
v_pk_mul_f32 v[114:115], v[114:115], v[238:239]
v_pk_mul_f32 v[116:117], v[116:117], v[238:239]
v_pk_mul_f32 v[118:119], v[118:119], v[238:239]
v_pk_mul_f32 v[120:121], v[120:121], v[238:239]
v_pk_mul_f32 v[122:123], v[122:123], v[238:239]
v_pk_mul_f32 v[124:125], v[124:125], v[238:239]
v_pk_mul_f32 v[126:127], v[126:127], v[238:239]
v_cvt_pk_bf16_f32 v200, v112, v113
v_cvt_pk_bf16_f32 v201, v114, v115
v_cvt_pk_bf16_f32 v202, v116, v117
v_cvt_pk_bf16_f32 v203, v118, v119
v_cvt_pk_bf16_f32 v204, v120, v121
v_cvt_pk_bf16_f32 v205, v122, v123
v_cvt_pk_bf16_f32 v206, v124, v125
v_cvt_pk_bf16_f32 v207, v126, v127
buffer_store_dwordx4 v[200:203], v96, s[84:87], s51 offen sc1
buffer_store_dwordx4 v[204:207], v96, s[84:87], s51 offen offset:2048 sc1
s_add_u32 s42, s42, 1
s_barrier
s_cmp_gt_i32 s55, s42
s_cbranch_scc1 mega_kernel_q_kv0k
mega_kernel_q_kv0w:
v_mov_b32 v2, 0
s_mov_b64 exec, 0xff
buffer_atomic_add v2, v99, s[84:87], 0 offen sc0 sc1
s_mov_b64 exec, -1
s_waitcnt vmcnt(0)
v_min_i32_dpp v2, v2, v2 quad_perm:[1,0,3,2] row_mask:0xf bank_mask:0xf
s_nop 1
v_min_i32_dpp v2, v2, v2 quad_perm:[2,3,0,1] row_mask:0xf bank_mask:0xf
s_nop 1
v_min_i32_dpp v2, v2, v2 row_half_mirror row_mask:0xf bank_mask:0xf
s_nop 0
v_readfirstlane_b32 s55, v2
s_cmp_gt_i32 s55, s42
s_cbranch_scc1 mega_kernel_q_kv0k
s_sleep 4
s_branch mega_kernel_q_kv0w
mega_kernel_q_kv0k:
s_cmp_ge_u32 s42, 61
s_cbranch_scc0 mega_kernel_q_nl0
s_add_u32 s51, s47, s42
s_bfe_u32 s57, s51, 0x40002
s_lshl_b32 s57, s57, 14
s_and_b32 s66, s51, 3
s_lshl_b32 s66, s66, 11
s_add_u32 s66, s66, s57
s_add_u32 s66, s66, s58
s_add_u32 s67, s66, 33554432
s_bfe_u32 s57, s51, 0x30003
s_lshl_b32 s57, s57, 14
s_and_b32 s68, s51, 7
s_lshl_b32 s68, s68, 10
s_add_u32 s68, s68, s57
s_add_u32 s68, s68, s59
s_add_u32 s50, s42, 4
s_min_u32 s50, s50, 63
s_lshl_b32 s50, s50, 16
s_cmp_gt_i32 s56, s42
s_cselect_b32 s30, 1, 0
s_add_u32 m0, s60, 0
s_nop 0
buffer_load_dwordx4 v5, s[84:87], s66 offen offset:0 sc1 lds
s_add_u32 m0, s60, 0
s_nop 0
buffer_load_dwordx4 v5, s[84:87], s66 offen offset:1024 sc1 lds
s_add_u32 m0, s60, 8192
s_nop 0
buffer_load_dwordx4 v5, s[84:87], s67 offen offset:0 sc1 lds
s_add_u32 m0, s60, 8192
s_nop 0
buffer_load_dwordx4 v5, s[84:87], s67 offen offset:1024 sc1 lds
s_cmp_eq_u32 s30, 1
s_cbranch_scc0 mega_kernel_q_kx0
s_mov_b32 m0, s61
s_nop 0
buffer_load_dwordx4 v5, s[84:87], s68 offen sc1 lds
mega_kernel_q_kx0:
v_mov_b64 v[84:85], v[220:221]
v_mov_b64 v[86:87], v[222:223]
v_mov_b64 v[88:89], v[224:225]
v_mov_b64 v[90:91], v[226:227]
v_mov_b64 v[220:221], v[228:229]
v_mov_b64 v[222:223], v[230:231]
v_mov_b64 v[224:225], v[232:233]
v_mov_b64 v[226:227], v[234:235]
v_cvt_pk_bf16_f32 v228, v68, v69
v_cvt_pk_bf16_f32 v229, v70, v71
v_cvt_pk_bf16_f32 v230, v72, v73
v_cvt_pk_bf16_f32 v231, v74, v75
v_cvt_pk_bf16_f32 v232, v76, v77
v_cvt_pk_bf16_f32 v233, v78, v79
v_cvt_pk_bf16_f32 v234, v80, v81
v_cvt_pk_bf16_f32 v235, v82, v83
ds_write_b128 v101, v[84:87]
ds_write_b128 v101, v[88:91] offset:1024
s_waitcnt vmcnt(4)
v_mov_b32 v17, s42
s_mov_b64 exec, 1
buffer_store_dword v17, v16, s[84:87], s49 offen sc1
s_mov_b64 exec, -1
s_branch mega_kernel_q_jl0
mega_kernel_q_nl0:
ds_read_b128 v[20:23], v8 offset:0
ds_read_b128 v[24:27], v8 offset:2048
ds_read_b128 v[28:31], v9 offset:0
ds_read_b128 v[32:35], v9 offset:2048
ds_read_b128 v[36:39], v8 offset:4096
ds_read_b128 v[40:43], v8 offset:6144
s_add_u32 s51, s47, s42
s_bfe_u32 s57, s51, 0x40002
s_lshl_b32 s57, s57, 14
s_and_b32 s66, s51, 3
s_lshl_b32 s66, s66, 11
s_add_u32 s66, s66, s57
s_add_u32 s66, s66, s58
s_add_u32 s67, s66, 33554432
s_bfe_u32 s57, s51, 0x30003
s_lshl_b32 s57, s57, 14
s_and_b32 s68, s51, 7
s_lshl_b32 s68, s68, 10
s_add_u32 s68, s68, s57
s_add_u32 s68, s68, s59
s_add_u32 s50, s42, 4
s_min_u32 s50, s50, 63
s_lshl_b32 s50, s50, 16
s_cmp_gt_i32 s56, s42
s_cselect_b32 s30, 1, 0
s_add_u32 m0, s60, 0
s_waitcnt lgkmcnt(4)
v_mfma_f32_16x16x32_bf16 v[52:55], a[0:3], v[20:23], 0
ds_read_b128 v[44:47], v9 offset:4096
v_mfma_f32_16x16x32_bf16 v[56:59], a[4:7], v[20:23], 0
buffer_load_dwordx4 v5, s[84:87], s66 offen offset:0 sc1 lds
v_mfma_f32_16x16x32_bf16 v[60:63], a[0:3], v[24:27], 0
ds_read_b128 v[48:51], v9 offset:6144
v_mfma_f32_16x16x32_bf16 v[64:67], a[4:7], v[24:27], 0
s_add_u32 m0, s60, 0
s_waitcnt lgkmcnt(4)
v_mfma_f32_16x16x32_bf16 v[52:55], a[8:11], v[28:31], v[52:55]
ds_read_b128 v[20:23], v8 offset:8192
v_mfma_f32_16x16x32_bf16 v[56:59], a[12:15], v[28:31], v[56:59]
buffer_load_dwordx4 v5, s[84:87], s66 offen offset:1024 sc1 lds
v_mfma_f32_16x16x32_bf16 v[60:63], a[8:11], v[32:35], v[60:63]
ds_read_b128 v[24:27], v8 offset:10240
v_mfma_f32_16x16x32_bf16 v[64:67], a[12:15], v[32:35], v[64:67]
s_add_u32 m0, s60, 8192
s_waitcnt lgkmcnt(4)
v_mfma_f32_16x16x32_bf16 v[52:55], a[16:19], v[36:39], v[52:55]
ds_read_b128 v[28:31], v9 offset:8192
v_mfma_f32_16x16x32_bf16 v[56:59], a[20:23], v[36:39], v[56:59]
buffer_load_dwordx4 v5, s[84:87], s67 offen offset:0 sc1 lds
v_mfma_f32_16x16x32_bf16 v[60:63], a[16:19], v[40:43], v[60:63]
ds_read_b128 v[32:35], v9 offset:10240
v_mfma_f32_16x16x32_bf16 v[64:67], a[20:23], v[40:43], v[64:67]
s_add_u32 m0, s60, 8192
s_waitcnt lgkmcnt(4)
v_mfma_f32_16x16x32_bf16 v[52:55], a[24:27], v[44:47], v[52:55]
ds_read_b128 v[36:39], v8 offset:12288
v_mfma_f32_16x16x32_bf16 v[56:59], a[28:31], v[44:47], v[56:59]
buffer_load_dwordx4 v5, s[84:87], s67 offen offset:1024 sc1 lds
v_mfma_f32_16x16x32_bf16 v[60:63], a[24:27], v[48:51], v[60:63]
ds_read_b128 v[40:43], v8 offset:14336
v_mfma_f32_16x16x32_bf16 v[64:67], a[28:31], v[48:51], v[64:67]
s_waitcnt lgkmcnt(4)
v_mfma_f32_16x16x32_bf16 v[52:55], a[32:35], v[20:23], v[52:55]
ds_read_b128 v[44:47], v9 offset:12288
v_mfma_f32_16x16x32_bf16 v[56:59], a[36:39], v[20:23], v[56:59]
s_cmp_eq_u32 s30, 1
s_cbranch_scc0 mega_kernel_q_ke0
s_mov_b32 m0, s61
s_nop 0
buffer_load_dwordx4 v5, s[84:87], s68 offen sc1 lds
mega_kernel_q_ke0:
v_mfma_f32_16x16x32_bf16 v[60:63], a[32:35], v[24:27], v[60:63]
ds_read_b128 v[48:51], v9 offset:14336
v_mfma_f32_16x16x32_bf16 v[64:67], a[36:39], v[24:27], v[64:67]
s_add_u32 m0, s46, 65536
s_waitcnt lgkmcnt(4)
v_mfma_f32_16x16x32_bf16 v[52:55], a[40:43], v[28:31], v[52:55]
ds_read_b128 v[20:23], v8 offset:16384
v_mfma_f32_16x16x32_bf16 v[56:59], a[44:47], v[28:31], v[56:59]
buffer_load_dwordx4 v6, s[8:11], s50 offen offset:0 lds
v_mfma_f32_16x16x32_bf16 v[60:63], a[40:43], v[32:35], v[60:63]
ds_read_b128 v[24:27], v8 offset:18432
v_mfma_f32_16x16x32_bf16 v[64:67], a[44:47], v[32:35], v[64:67]
s_add_u32 m0, s46, 69504
s_waitcnt lgkmcnt(4)
v_mfma_f32_16x16x32_bf16 v[52:55], a[48:51], v[36:39], v[52:55]
ds_read_b128 v[28:31], v9 offset:16384
v_mfma_f32_16x16x32_bf16 v[56:59], a[52:55], v[36:39], v[56:59]
buffer_load_dwordx4 v6, s[8:11], s50 offen offset:128 lds
v_mfma_f32_16x16x32_bf16 v[60:63], a[48:51], v[40:43], v[60:63]
ds_read_b128 v[32:35], v9 offset:18432
v_mfma_f32_16x16x32_bf16 v[64:67], a[52:55], v[40:43], v[64:67]
s_add_u32 m0, s46, 73472
s_waitcnt lgkmcnt(4)
v_mfma_f32_16x16x32_bf16 v[52:55], a[56:59], v[44:47], v[52:55]
ds_read_b128 v[36:39], v8 offset:20480
v_mfma_f32_16x16x32_bf16 v[56:59], a[60:63], v[44:47], v[56:59]
buffer_load_dwordx4 v6, s[8:11], s50 offen offset:256 lds
v_mfma_f32_16x16x32_bf16 v[60:63], a[56:59], v[48:51], v[60:63]
ds_read_b128 v[40:43], v8 offset:22528
v_mfma_f32_16x16x32_bf16 v[64:67], a[60:63], v[48:51], v[64:67]
s_add_u32 m0, s46, 77440
s_waitcnt lgkmcnt(4)
v_mfma_f32_16x16x32_bf16 v[52:55], a[64:67], v[20:23], v[52:55]
ds_read_b128 v[44:47], v9 offset:20480
v_mfma_f32_16x16x32_bf16 v[56:59], a[68:71], v[20:23], v[56:59]
buffer_load_dwordx4 v6, s[8:11], s50 offen offset:384 lds
v_mfma_f32_16x16x32_bf16 v[60:63], a[64:67], v[24:27], v[60:63]
ds_read_b128 v[48:51], v9 offset:22528
v_mfma_f32_16x16x32_bf16 v[64:67], a[68:71], v[24:27], v[64:67]
s_add_u32 m0, s46, 81408
s_waitcnt lgkmcnt(4)
v_mfma_f32_16x16x32_bf16 v[52:55], a[72:75], v[28:31], v[52:55]
ds_read_b128 v[20:23], v8 offset:24576
v_mfma_f32_16x16x32_bf16 v[56:59], a[76:79], v[28:31], v[56:59]
buffer_load_dwordx4 v6, s[8:11], s50 offen offset:512 lds
v_mfma_f32_16x16x32_bf16 v[60:63], a[72:75], v[32:35], v[60:63]
ds_read_b128 v[24:27], v8 offset:26624
v_mfma_f32_16x16x32_bf16 v[64:67], a[76:79], v[32:35], v[64:67]
s_add_u32 m0, s46, 85376
s_waitcnt lgkmcnt(4)
v_mfma_f32_16x16x32_bf16 v[52:55], a[80:83], v[36:39], v[52:55]
ds_read_b128 v[28:31], v9 offset:24576
v_mfma_f32_16x16x32_bf16 v[56:59], a[84:87], v[36:39], v[56:59]
buffer_load_dwordx4 v6, s[8:11], s50 offen offset:640 lds
v_mfma_f32_16x16x32_bf16 v[60:63], a[80:83], v[40:43], v[60:63]
ds_read_b128 v[32:35], v9 offset:26624
v_mfma_f32_16x16x32_bf16 v[64:67], a[84:87], v[40:43], v[64:67]
s_add_u32 m0, s46, 89344
s_waitcnt lgkmcnt(4)
v_mfma_f32_16x16x32_bf16 v[52:55], a[88:91], v[44:47], v[52:55]
ds_read_b128 v[36:39], v8 offset:28672
v_mfma_f32_16x16x32_bf16 v[56:59], a[92:95], v[44:47], v[56:59]
buffer_load_dwordx4 v6, s[8:11], s50 offen offset:768 lds
v_mfma_f32_16x16x32_bf16 v[60:63], a[88:91], v[48:51], v[60:63]
ds_read_b128 v[40:43], v8 offset:30720
v_mfma_f32_16x16x32_bf16 v[64:67], a[92:95], v[48:51], v[64:67]
s_add_u32 m0, s46, 93312
s_waitcnt lgkmcnt(4)
v_mfma_f32_16x16x32_bf16 v[52:55], a[96:99], v[20:23], v[52:55]
ds_read_b128 v[44:47], v9 offset:28672
v_mfma_f32_16x16x32_bf16 v[56:59], a[100:103], v[20:23], v[56:59]
buffer_load_dwordx4 v6, s[8:11], s50 offen offset:896 lds
v_mfma_f32_16x16x32_bf16 v[60:63], a[96:99], v[24:27], v[60:63]
ds_read_b128 v[48:51], v9 offset:30720
v_mfma_f32_16x16x32_bf16 v[64:67], a[100:103], v[24:27], v[64:67]
s_add_u32 m0, s46, 97280
s_waitcnt lgkmcnt(4)
v_mfma_f32_16x16x32_bf16 v[52:55], a[104:107], v[28:31], v[52:55]
ds_read_b128 v[20:23], v8 offset:32768
v_mfma_f32_16x16x32_bf16 v[56:59], a[108:111], v[28:31], v[56:59]
buffer_load_dwordx4 v6, s[8:11], s50 offen offset:1024 lds
v_mfma_f32_16x16x32_bf16 v[60:63], a[104:107], v[32:35], v[60:63]
ds_read_b128 v[24:27], v8 offset:34816
v_mfma_f32_16x16x32_bf16 v[64:67], a[108:111], v[32:35], v[64:67]
s_waitcnt vmcnt(13)
v_mov_b32 v17, s42
s_mov_b64 exec, 1
buffer_store_dword v17, v16, s[84:87], s49 offen sc1
s_mov_b64 exec, -1
s_add_u32 m0, s46, 101248
s_waitcnt lgkmcnt(4)
v_mfma_f32_16x16x32_bf16 v[52:55], a[112:115], v[36:39], v[52:55]
ds_read_b128 v[28:31], v9 offset:32768
v_mfma_f32_16x16x32_bf16 v[56:59], a[116:119], v[36:39], v[56:59]
buffer_load_dwordx4 v6, s[8:11], s50 offen offset:1152 lds
v_mfma_f32_16x16x32_bf16 v[60:63], a[112:115], v[40:43], v[60:63]
ds_read_b128 v[32:35], v9 offset:34816
v_mfma_f32_16x16x32_bf16 v[64:67], a[116:119], v[40:43], v[64:67]
v_mov_b32 v100, 0
s_mov_b64 exec, 1
buffer_atomic_add v100, v16, s[84:87], s62 offen sc0 sc1
s_mov_b64 exec, -1
s_add_u32 m0, s46, 105216
s_waitcnt lgkmcnt(4)
v_mfma_f32_16x16x32_bf16 v[52:55], a[120:123], v[44:47], v[52:55]
ds_read_b128 v[36:39], v8 offset:36864
v_mfma_f32_16x16x32_bf16 v[56:59], a[124:127], v[44:47], v[56:59]
buffer_load_dwordx4 v6, s[8:11], s50 offen offset:1280 lds
v_mfma_f32_16x16x32_bf16 v[60:63], a[120:123], v[48:51], v[60:63]
ds_read_b128 v[40:43], v8 offset:38912
v_mfma_f32_16x16x32_bf16 v[64:67], a[124:127], v[48:51], v[64:67]
s_add_u32 m0, s46, 109184
s_waitcnt lgkmcnt(4)
v_mfma_f32_16x16x32_bf16 v[52:55], a[128:131], v[20:23], v[52:55]
ds_read_b128 v[44:47], v9 offset:36864
v_mfma_f32_16x16x32_bf16 v[56:59], a[132:135], v[20:23], v[56:59]
buffer_load_dwordx4 v6, s[8:11], s50 offen offset:1408 lds
v_mfma_f32_16x16x32_bf16 v[60:63], a[128:131], v[24:27], v[60:63]
ds_read_b128 v[48:51], v9 offset:38912
v_mfma_f32_16x16x32_bf16 v[64:67], a[132:135], v[24:27], v[64:67]
s_add_u32 m0, s46, 113152
s_waitcnt lgkmcnt(4)
v_mfma_f32_16x16x32_bf16 v[52:55], a[136:139], v[28:31], v[52:55]
ds_read_b128 v[20:23], v8 offset:40960
v_mfma_f32_16x16x32_bf16 v[56:59], a[140:143], v[28:31], v[56:59]
buffer_load_dwordx4 v6, s[8:11], s50 offen offset:1536 lds
v_mfma_f32_16x16x32_bf16 v[60:63], a[136:139], v[32:35], v[60:63]
ds_read_b128 v[24:27], v8 offset:43008
v_mfma_f32_16x16x32_bf16 v[64:67], a[140:143], v[32:35], v[64:67]
s_add_u32 m0, s46, 117120
s_waitcnt lgkmcnt(4)
v_mfma_f32_16x16x32_bf16 v[52:55], a[144:147], v[36:39], v[52:55]
ds_read_b128 v[28:31], v9 offset:40960
v_mfma_f32_16x16x32_bf16 v[56:59], a[148:151], v[36:39], v[56:59]
buffer_load_dwordx4 v6, s[8:11], s50 offen offset:1664 lds
v_mfma_f32_16x16x32_bf16 v[60:63], a[144:147], v[40:43], v[60:63]
ds_read_b128 v[32:35], v9 offset:43008
v_mfma_f32_16x16x32_bf16 v[64:67], a[148:151], v[40:43], v[64:67]
s_add_u32 m0, s46, 121088
s_waitcnt lgkmcnt(4)
v_mfma_f32_16x16x32_bf16 v[52:55], a[152:155], v[44:47], v[52:55]
ds_read_b128 v[36:39], v8 offset:45056
v_mfma_f32_16x16x32_bf16 v[56:59], a[156:159], v[44:47], v[56:59]
buffer_load_dwordx4 v6, s[8:11], s50 offen offset:1792 lds
v_mfma_f32_16x16x32_bf16 v[60:63], a[152:155], v[48:51], v[60:63]
ds_read_b128 v[40:43], v8 offset:47104
v_mfma_f32_16x16x32_bf16 v[64:67], a[156:159], v[48:51], v[64:67]
s_add_u32 m0, s46, 125056
s_waitcnt lgkmcnt(4)
v_mfma_f32_16x16x32_bf16 v[52:55], a[160:163], v[20:23], v[52:55]
ds_read_b128 v[44:47], v9 offset:45056
v_mfma_f32_16x16x32_bf16 v[56:59], a[164:167], v[20:23], v[56:59]
buffer_load_dwordx4 v6, s[8:11], s50 offen offset:1920 lds
v_mfma_f32_16x16x32_bf16 v[60:63], a[160:163], v[24:27], v[60:63]
ds_read_b128 v[48:51], v9 offset:47104
v_mfma_f32_16x16x32_bf16 v[64:67], a[164:167], v[24:27], v[64:67]
s_waitcnt lgkmcnt(4)
v_mfma_f32_16x16x32_bf16 v[52:55], a[168:171], v[28:31], v[52:55]
ds_read_b128 v[20:23], v8 offset:49152
v_mfma_f32_16x16x32_bf16 v[56:59], a[172:175], v[28:31], v[56:59]
v_mov_b64 v[84:85], v[220:221]
v_mov_b64 v[86:87], v[222:223]
v_mfma_f32_16x16x32_bf16 v[60:63], a[168:171], v[32:35], v[60:63]
ds_read_b128 v[24:27], v8 offset:51200
v_mfma_f32_16x16x32_bf16 v[64:67], a[172:175], v[32:35], v[64:67]
v_mov_b64 v[88:89], v[224:225]
v_mov_b64 v[90:91], v[226:227]
s_waitcnt lgkmcnt(4)
v_mfma_f32_16x16x32_bf16 v[52:55], a[176:179], v[36:39], v[52:55]
ds_read_b128 v[28:31], v9 offset:49152
v_mfma_f32_16x16x32_bf16 v[56:59], a[180:183], v[36:39], v[56:59]
v_mov_b64 v[220:221], v[228:229]
v_mov_b64 v[222:223], v[230:231]
v_mfma_f32_16x16x32_bf16 v[60:63], a[176:179], v[40:43], v[60:63]
ds_read_b128 v[32:35], v9 offset:51200
v_mfma_f32_16x16x32_bf16 v[64:67], a[180:183], v[40:43], v[64:67]
v_mov_b64 v[224:225], v[232:233]
v_mov_b64 v[226:227], v[234:235]
s_waitcnt lgkmcnt(4)
v_mfma_f32_16x16x32_bf16 v[52:55], a[184:187], v[44:47], v[52:55]
ds_read_b128 v[36:39], v8 offset:53248
v_mfma_f32_16x16x32_bf16 v[56:59], a[188:191], v[44:47], v[56:59]
v_cvt_pk_bf16_f32 v228, v68, v69
v_cvt_pk_bf16_f32 v229, v70, v71
v_mfma_f32_16x16x32_bf16 v[60:63], a[184:187], v[48:51], v[60:63]
ds_read_b128 v[40:43], v8 offset:55296
v_mfma_f32_16x16x32_bf16 v[64:67], a[188:191], v[48:51], v[64:67]
v_cvt_pk_bf16_f32 v230, v72, v73
v_cvt_pk_bf16_f32 v231, v74, v75
s_waitcnt lgkmcnt(4)
v_mfma_f32_16x16x32_bf16 v[52:55], a[192:195], v[20:23], v[52:55]
ds_read_b128 v[44:47], v9 offset:53248
v_mfma_f32_16x16x32_bf16 v[56:59], a[196:199], v[20:23], v[56:59]
v_cvt_pk_bf16_f32 v232, v76, v77
v_cvt_pk_bf16_f32 v233, v78, v79
v_mfma_f32_16x16x32_bf16 v[60:63], a[192:195], v[24:27], v[60:63]
ds_read_b128 v[48:51], v9 offset:55296
v_mfma_f32_16x16x32_bf16 v[64:67], a[196:199], v[24:27], v[64:67]
v_cvt_pk_bf16_f32 v234, v80, v81
v_cvt_pk_bf16_f32 v235, v82, v83
s_waitcnt lgkmcnt(4)
v_mfma_f32_16x16x32_bf16 v[52:55], a[200:203], v[28:31], v[52:55]
ds_read_b128 v[20:23], v8 offset:57344
v_mfma_f32_16x16x32_bf16 v[56:59], a[204:207], v[28:31], v[56:59]
v_mfma_f32_16x16x32_bf16 v[60:63], a[200:203], v[32:35], v[60:63]
ds_read_b128 v[24:27], v8 offset:59392
v_mfma_f32_16x16x32_bf16 v[64:67], a[204:207], v[32:35], v[64:67]
s_waitcnt lgkmcnt(4)
v_mfma_f32_16x16x32_bf16 v[52:55], a[208:211], v[36:39], v[52:55]
ds_read_b128 v[28:31], v9 offset:57344
v_mfma_f32_16x16x32_bf16 v[56:59], a[212:215], v[36:39], v[56:59]
v_mfma_f32_16x16x32_bf16 v[60:63], a[208:211], v[40:43], v[60:63]
ds_read_b128 v[32:35], v9 offset:59392
v_mfma_f32_16x16x32_bf16 v[64:67], a[212:215], v[40:43], v[64:67]
s_waitcnt lgkmcnt(4)
v_mfma_f32_16x16x32_bf16 v[52:55], a[216:219], v[44:47], v[52:55]
ds_read_b128 v[36:39], v8 offset:61440
v_mfma_f32_16x16x32_bf16 v[56:59], a[220:223], v[44:47], v[56:59]
s_waitcnt vmcnt(6)
v_readfirstlane_b32 s56, v100
s_cmp_eq_u32 s30, 1
s_cbranch_scc1 mega_kernel_q_kf0
s_cmp_gt_i32 s56, s42
s_cbranch_scc0 mega_kernel_q_kf0
s_mov_b32 s30, 1
s_mov_b32 m0, s61
s_nop 0
buffer_load_dwordx4 v5, s[84:87], s68 offen sc1 lds
mega_kernel_q_kf0:
v_mfma_f32_16x16x32_bf16 v[60:63], a[216:219], v[48:51], v[60:63]
ds_read_b128 v[40:43], v8 offset:63488
v_mfma_f32_16x16x32_bf16 v[64:67], a[220:223], v[48:51], v[64:67]
s_waitcnt lgkmcnt(4)
v_mfma_f32_16x16x32_bf16 v[52:55], a[224:227], v[20:23], v[52:55]
ds_read_b128 v[44:47], v9 offset:61440
v_mfma_f32_16x16x32_bf16 v[56:59], a[228:231], v[20:23], v[56:59]
v_mfma_f32_16x16x32_bf16 v[60:63], a[224:227], v[24:27], v[60:63]
ds_read_b128 v[48:51], v9 offset:63488
v_mfma_f32_16x16x32_bf16 v[64:67], a[228:231], v[24:27], v[64:67]
s_waitcnt lgkmcnt(5)
v_mfma_f32_16x16x32_bf16 v[52:55], a[232:235], v[28:31], v[52:55]
v_mfma_f32_16x16x32_bf16 v[56:59], a[236:239], v[28:31], v[56:59]
s_waitcnt lgkmcnt(4)
v_mfma_f32_16x16x32_bf16 v[60:63], a[232:235], v[32:35], v[60:63]
v_mfma_f32_16x16x32_bf16 v[64:67], a[236:239], v[32:35], v[64:67]
s_waitcnt lgkmcnt(3)
v_mfma_f32_16x16x32_bf16 v[52:55], a[240:243], v[36:39], v[52:55]
v_mfma_f32_16x16x32_bf16 v[56:59], a[244:247], v[36:39], v[56:59]
s_waitcnt lgkmcnt(2)
v_mfma_f32_16x16x32_bf16 v[60:63], a[240:243], v[40:43], v[60:63]
v_mfma_f32_16x16x32_bf16 v[64:67], a[244:247], v[40:43], v[64:67]
ds_write_b128 v101, v[84:87]
ds_write_b128 v101, v[88:91] offset:1024
s_waitcnt lgkmcnt(1)
v_mfma_f32_16x16x32_bf16 v[68:71], a[248:251], v[44:47], v[52:55]
v_mfma_f32_16x16x32_bf16 v[72:75], a[252:255], v[44:47], v[56:59]
s_waitcnt lgkmcnt(0)
v_mfma_f32_16x16x32_bf16 v[76:79], a[248:251], v[48:51], v[60:63]
v_mfma_f32_16x16x32_bf16 v[80:83], a[252:255], v[48:51], v[64:67]
mega_kernel_q_jl0:
s_cmp_eq_u32 s30, 1
s_cbranch_scc1 mega_kernel_q_kl0
mega_kernel_q_kw0:
v_mov_b32 v100, 0
s_mov_b64 exec, 1
buffer_atomic_add v100, v16, s[84:87], s62 offen sc0 sc1
s_mov_b64 exec, -1
s_waitcnt vmcnt(0)
v_readfirstlane_b32 s56, v100
s_cmp_gt_i32 s56, s42
s_cbranch_scc0 mega_kernel_q_kw0
s_mov_b32 m0, s61
s_nop 0
buffer_load_dwordx4 v5, s[84:87], s68 offen sc1 lds
mega_kernel_q_kl0:
s_waitcnt lgkmcnt(0) vmcnt(0)
s_barrier
ds_read_b128 v[184:187], v102 offset:0
ds_read_b128 v[112:115], v103 offset:0
ds_read_b128 v[128:131], v103 offset:1024
ds_read_b128 v[188:191], v102 offset:2048
ds_read_b128 v[116:119], v103 offset:2048
ds_read_b128 v[132:135], v103 offset:3072
ds_read_b128 v[192:195], v102 offset:4096
ds_read_b128 v[120:123], v103 offset:4096
ds_read_b128 v[136:139], v103 offset:5120
ds_read_b128 v[196:199], v102 offset:6144
ds_read_b128 v[124:127], v103 offset:6144
ds_read_b128 v[140:143], v103 offset:7168
s_waitcnt lgkmcnt(9)
v_mfma_f32_16x16x32_bf16 v[200:203], v[112:115], v[184:187], 0
v_mfma_f32_16x16x32_bf16 v[204:207], v[128:131], v[184:187], 0
ds_read_b128 v[160:163], v94 offset:0
s_waitcnt lgkmcnt(7)
v_mfma_f32_16x16x32_bf16 v[200:203], v[116:119], v[188:191], v[200:203]
v_mfma_f32_16x16x32_bf16 v[204:207], v[132:135], v[188:191], v[204:207]
ds_read_b128 v[164:167], v94 offset:1024
s_waitcnt lgkmcnt(5)
v_mfma_f32_16x16x32_bf16 v[200:203], v[120:123], v[192:195], v[200:203]
v_mfma_f32_16x16x32_bf16 v[204:207], v[136:139], v[192:195], v[204:207]
ds_read_b128 v[168:171], v94 offset:2048
s_waitcnt lgkmcnt(3)
v_mfma_f32_16x16x32_bf16 v[200:203], v[124:127], v[196:199], v[200:203]
v_mfma_f32_16x16x32_bf16 v[204:207], v[140:143], v[196:199], v[204:207]
ds_read_b128 v[172:175], v94 offset:3072
s_waitcnt lgkmcnt(3)
v_mfma_f32_16x16x32_bf16 v[208:211], v[160:163], v[184:187], 0
ds_read_b128 v[144:147], v240 offset:0
ds_read_b64 v[176:177], v95 offset:0
s_waitcnt lgkmcnt(4)
v_mfma_f32_16x16x32_bf16 v[208:211], v[164:167], v[188:191], v[208:211]
ds_read_b128 v[148:151], v240 offset:1024
ds_read_b64 v[178:179], v95 offset:256
s_waitcnt lgkmcnt(5)
v_mfma_f32_16x16x32_bf16 v[208:211], v[168:171], v[192:195], v[208:211]
ds_read_b128 v[152:155], v240 offset:2048
ds_read_b64 v[180:181], v95 offset:1024
s_waitcnt lgkmcnt(6)
v_mfma_f32_16x16x32_bf16 v[208:211], v[172:175], v[196:199], v[208:211]
ds_read_b128 v[156:159], v240 offset:3072
ds_read_b64 v[182:183], v95 offset:1280
v_pk_mul_f32 v[200:201], v[200:201], s[54:55] op_sel_hi:[1,0]
v_pk_mul_f32 v[202:203], v[202:203], s[54:55] op_sel_hi:[1,0]
v_pk_mul_f32 v[204:205], v[204:205], s[54:55] op_sel_hi:[1,0]
v_pk_mul_f32 v[206:207], v[206:207], s[54:55] op_sel_hi:[1,0]
v_cndmask_b32 v200, v200, v241, s[12:13]
v_cndmask_b32 v201, v201, v241, s[14:15]
v_cndmask_b32 v202, v202, v241, s[16:17]
v_cndmask_b32 v203, v203, v241, s[18:19]
v_cndmask_b32 v204, v204, v241, s[20:21]
v_cndmask_b32 v205, v205, v241, s[22:23]
v_cndmask_b32 v206, v206, v241, s[24:25]
v_cndmask_b32 v207, v207, v241, s[26:27]
v_pk_mul_f32 v[208:209], v[208:209], s[54:55] op_sel_hi:[1,0]
v_pk_mul_f32 v[210:211], v[210:211], s[54:55] op_sel_hi:[1,0]
v_cndmask_b32 v208, v208, v97, s[28:29]
v_cndmask_b32 v209, v209, v97, s[28:29]
v_cndmask_b32 v210, v210, v97, s[28:29]
v_cndmask_b32 v211, v211, v97, s[28:29]
v_max3_f32 v236, v200, v201, v202
v_max3_f32 v236, v236, v203, v204
v_max3_f32 v236, v236, v205, v206
v_max3_f32 v236, v236, v207, v208
v_max3_f32 v236, v236, v209, v210
v_max_f32 v237, v236, v211
v_max_f32 v236, v236, v211
s_nop 1
v_permlane16_swap_b32 v236, v237
s_nop 0
v_max_f32 v238, v236, v237
v_max_f32 v239, v236, v237
s_nop 1
v_permlane32_swap_b32 v238, v239
s_nop 0
v_max_f32 v236, v238, v239
v_pk_add_f32 v[200:201], v[200:201], v[236:237] op_sel_hi:[1,0] neg_lo:[0,1] neg_hi:[0,1]
v_pk_add_f32 v[202:203], v[202:203], v[236:237] op_sel_hi:[1,0] neg_lo:[0,1] neg_hi:[0,1]
v_pk_add_f32 v[204:205], v[204:205], v[236:237] op_sel_hi:[1,0] neg_lo:[0,1] neg_hi:[0,1]
v_pk_add_f32 v[206:207], v[206:207], v[236:237] op_sel_hi:[1,0] neg_lo:[0,1] neg_hi:[0,1]
v_pk_add_f32 v[208:209], v[208:209], v[236:237] op_sel_hi:[1,0] neg_lo:[0,1] neg_hi:[0,1]
v_pk_add_f32 v[210:211], v[210:211], v[236:237] op_sel_hi:[1,0] neg_lo:[0,1] neg_hi:[0,1]
v_exp_f32 v200, v200
v_exp_f32 v201, v201
v_exp_f32 v202, v202
v_exp_f32 v203, v203
v_exp_f32 v204, v204
v_exp_f32 v205, v205
v_exp_f32 v206, v206
v_exp_f32 v207, v207
v_exp_f32 v208, v208
v_exp_f32 v209, v209
v_exp_f32 v210, v210
v_exp_f32 v211, v211
s_nop 0
v_cvt_pk_bf16_f32 v212, v200, v201
v_cvt_pk_bf16_f32 v213, v202, v203
v_cvt_pk_bf16_f32 v214, v204, v205
v_cvt_pk_bf16_f32 v215, v206, v207
v_cvt_pk_bf16_f32 v216, v208, v209
v_cvt_pk_bf16_f32 v217, v210, v211
s_waitcnt lgkmcnt(0)
s_nop 0
v_mfma_f32_16x16x32_bf16 v[108:111], v[104:107], v[212:215], 0
v_mfma_f32_16x16x32_bf16 v[112:115], v[144:147], v[212:215], 0
v_mfma_f32_16x16x32_bf16 v[116:119], v[148:151], v[212:215], 0
v_mfma_f32_16x16x32_bf16 v[120:123], v[152:155], v[212:215], 0
v_mfma_f32_16x16x32_bf16 v[124:127], v[156:159], v[212:215], 0
v_mfma_f32_16x16x16_bf16 v[108:111], v[104:105], v[216:217], v[108:111]
v_mfma_f32_16x16x16_bf16 v[112:115], v[176:177], v[216:217], v[112:115]
v_mfma_f32_16x16x16_bf16 v[116:119], v[178:179], v[216:217], v[116:119]
v_mfma_f32_16x16x16_bf16 v[120:123], v[180:181], v[216:217], v[120:123]
v_mfma_f32_16x16x16_bf16 v[124:127], v[182:183], v[216:217], v[124:127]
s_lshl_b32 s51, s42, 18
s_nop 2
v_rcp_f32 v238, v108
v_rcp_f32 v239, v109
s_nop 1
v_pk_mul_f32 v[112:113], v[112:113], v[238:239]
v_pk_mul_f32 v[114:115], v[114:115], v[238:239]
v_pk_mul_f32 v[116:117], v[116:117], v[238:239]
v_pk_mul_f32 v[118:119], v[118:119], v[238:239]
v_pk_mul_f32 v[120:121], v[120:121], v[238:239]
v_pk_mul_f32 v[122:123], v[122:123], v[238:239]
v_pk_mul_f32 v[124:125], v[124:125], v[238:239]
v_pk_mul_f32 v[126:127], v[126:127], v[238:239]
v_cvt_pk_bf16_f32 v200, v112, v113
v_cvt_pk_bf16_f32 v201, v114, v115
v_cvt_pk_bf16_f32 v202, v116, v117
v_cvt_pk_bf16_f32 v203, v118, v119
v_cvt_pk_bf16_f32 v204, v120, v121
v_cvt_pk_bf16_f32 v205, v122, v123
v_cvt_pk_bf16_f32 v206, v124, v125
v_cvt_pk_bf16_f32 v207, v126, v127
buffer_store_dwordx4 v[200:203], v96, s[84:87], s51 offen sc1
buffer_store_dwordx4 v[204:207], v96, s[84:87], s51 offen offset:2048 sc1
s_add_u32 s42, s42, 1
s_cmp_lt_u32 s42, 64
s_cbranch_scc1 mega_kernel_q_loop
s_waitcnt vmcnt(0)
v_mov_b32 v17, s42
s_mov_b64 exec, 1
buffer_store_dword v17, v16, s[84:87], s49 offen sc1
s_mov_b64 exec, -1
mega_kernel_q_quit:
s_endpgm
mega_kernel_rd:
s_mov_b32 s93, s40
s_load_dwordx2 s[4:5], s[0:1], 64
s_load_dwordx2 s[8:9], s[0:1], 72
v_and_b32 v1, 63, v0
v_lshrrev_b32 v2, 6, v0
v_mul_u32_u24 v3, 1026, v2
v_lshl_add_u32 v3, v1, 1, v3
v_mul_u32_u24 v4, 65, v1
v_add_u32 v4, v4, v2
v_lshlrev_b32 v4, 2, v4
v_lshrrev_b32 v7, 4, v0
v_and_b32 v8, 15, v0
v_mul_u32_u24 v5, 65, v7
v_lshl_add_u32 v5, v8, 2, v5
v_lshlrev_b32 v5, 2, v5
v_mul_u32_u24 v6, 8192, v7
v_lshl_add_u32 v6, v8, 4, v6
s_add_u32 s24, s84, 121634816
s_addc_u32 s25, s85, 0
s_mov_b32 s26, 4202496
s_mov_b32 s27, 0x00020000
s_waitcnt lgkmcnt(0)
s_mov_b32 s6, 2101248
s_mov_b32 s7, 0x00020000
s_mov_b32 s10, 2101248
s_mov_b32 s11, 0x00020000
s_cmp_lt_u32 s93, 288
s_cbranch_scc0 mega_kernel_f0_e
s_and_b32 s12, s93, 31
s_mul_i32 s12, s12, 65664
s_lshr_b32 s13, s93, 5
s_lshl_b32 s13, s13, 7
s_add_u32 s12, s12, s13
buffer_load_ushort v16, v3, s[4:7], s12 offen
buffer_load_ushort v32, v3, s[8:11], s12 offen
s_add_u32 s12, s12, 4104
buffer_load_ushort v17, v3, s[4:7], s12 offen
buffer_load_ushort v33, v3, s[8:11], s12 offen
s_add_u32 s12, s12, 4104
buffer_load_ushort v18, v3, s[4:7], s12 offen
buffer_load_ushort v34, v3, s[8:11], s12 offen
s_add_u32 s12, s12, 4104
buffer_load_ushort v19, v3, s[4:7], s12 offen
buffer_load_ushort v35, v3, s[8:11], s12 offen
s_add_u32 s12, s12, 4104
buffer_load_ushort v20, v3, s[4:7], s12 offen
buffer_load_ushort v36, v3, s[8:11], s12 offen
s_add_u32 s12, s12, 4104
buffer_load_ushort v21, v3, s[4:7], s12 offen
buffer_load_ushort v37, v3, s[8:11], s12 offen
s_add_u32 s12, s12, 4104
buffer_load_ushort v22, v3, s[4:7], s12 offen
buffer_load_ushort v38, v3, s[8:11], s12 offen
s_add_u32 s12, s12, 4104
buffer_load_ushort v23, v3, s[4:7], s12 offen
buffer_load_ushort v39, v3, s[8:11], s12 offen
s_add_u32 s12, s12, 4104
buffer_load_ushort v24, v3, s[4:7], s12 offen
buffer_load_ushort v40, v3, s[8:11], s12 offen
s_add_u32 s12, s12, 4104
buffer_load_ushort v25, v3, s[4:7], s12 offen
buffer_load_ushort v41, v3, s[8:11], s12 offen
s_add_u32 s12, s12, 4104
buffer_load_ushort v26, v3, s[4:7], s12 offen
buffer_load_ushort v42, v3, s[8:11], s12 offen
s_add_u32 s12, s12, 4104
buffer_load_ushort v27, v3, s[4:7], s12 offen
buffer_load_ushort v43, v3, s[8:11], s12 offen
s_add_u32 s12, s12, 4104
buffer_load_ushort v28, v3, s[4:7], s12 offen
buffer_load_ushort v44, v3, s[8:11], s12 offen
s_add_u32 s12, s12, 4104
buffer_load_ushort v29, v3, s[4:7], s12 offen
buffer_load_ushort v45, v3, s[8:11], s12 offen
s_add_u32 s12, s12, 4104
buffer_load_ushort v30, v3, s[4:7], s12 offen
buffer_load_ushort v46, v3, s[8:11], s12 offen
s_add_u32 s12, s12, 4104
buffer_load_ushort v31, v3, s[4:7], s12 offen
buffer_load_ushort v47, v3, s[8:11], s12 offen
s_add_u32 s12, s12, 4104
s_waitcnt vmcnt(0)
mega_kernel_f0_l:
s_add_u32 s21, s93, 32
s_cmp_lt_u32 s21, 288
s_cselect_b32 s22, s21, s93
s_waitcnt vmcnt(4)
v_lshl_or_b32 v48, v32, 16, v16
v_lshl_or_b32 v49, v33, 16, v17
v_lshl_or_b32 v50, v34, 16, v18
v_lshl_or_b32 v51, v35, 16, v19
v_lshl_or_b32 v52, v36, 16, v20
v_lshl_or_b32 v53, v37, 16, v21
v_lshl_or_b32 v54, v38, 16, v22
v_lshl_or_b32 v55, v39, 16, v23
v_lshl_or_b32 v56, v40, 16, v24
v_lshl_or_b32 v57, v41, 16, v25
v_lshl_or_b32 v58, v42, 16, v26
v_lshl_or_b32 v59, v43, 16, v27
v_lshl_or_b32 v60, v44, 16, v28
v_lshl_or_b32 v61, v45, 16, v29
v_lshl_or_b32 v62, v46, 16, v30
v_lshl_or_b32 v63, v47, 16, v31
s_and_b32 s12, s22, 31
s_mul_i32 s12, s12, 65664
s_lshr_b32 s13, s22, 5
s_lshl_b32 s13, s13, 7
s_add_u32 s12, s12, s13
buffer_load_ushort v16, v3, s[4:7], s12 offen
buffer_load_ushort v32, v3, s[8:11], s12 offen
s_add_u32 s12, s12, 4104
buffer_load_ushort v17, v3, s[4:7], s12 offen
buffer_load_ushort v33, v3, s[8:11], s12 offen
s_add_u32 s12, s12, 4104
buffer_load_ushort v18, v3, s[4:7], s12 offen
buffer_load_ushort v34, v3, s[8:11], s12 offen
s_add_u32 s12, s12, 4104
buffer_load_ushort v19, v3, s[4:7], s12 offen
buffer_load_ushort v35, v3, s[8:11], s12 offen
s_add_u32 s12, s12, 4104
buffer_load_ushort v20, v3, s[4:7], s12 offen
buffer_load_ushort v36, v3, s[8:11], s12 offen
s_add_u32 s12, s12, 4104
buffer_load_ushort v21, v3, s[4:7], s12 offen
buffer_load_ushort v37, v3, s[8:11], s12 offen
s_add_u32 s12, s12, 4104
buffer_load_ushort v22, v3, s[4:7], s12 offen
buffer_load_ushort v38, v3, s[8:11], s12 offen
s_add_u32 s12, s12, 4104
buffer_load_ushort v23, v3, s[4:7], s12 offen
buffer_load_ushort v39, v3, s[8:11], s12 offen
s_add_u32 s12, s12, 4104
buffer_load_ushort v24, v3, s[4:7], s12 offen
buffer_load_ushort v40, v3, s[8:11], s12 offen
s_add_u32 s12, s12, 4104
buffer_load_ushort v25, v3, s[4:7], s12 offen
buffer_load_ushort v41, v3, s[8:11], s12 offen
s_add_u32 s12, s12, 4104
buffer_load_ushort v26, v3, s[4:7], s12 offen
buffer_load_ushort v42, v3, s[8:11], s12 offen
s_add_u32 s12, s12, 4104
buffer_load_ushort v27, v3, s[4:7], s12 offen
buffer_load_ushort v43, v3, s[8:11], s12 offen
s_add_u32 s12, s12, 4104
buffer_load_ushort v28, v3, s[4:7], s12 offen
buffer_load_ushort v44, v3, s[8:11], s12 offen
s_add_u32 s12, s12, 4104
buffer_load_ushort v29, v3, s[4:7], s12 offen
buffer_load_ushort v45, v3, s[8:11], s12 offen
s_add_u32 s12, s12, 4104
buffer_load_ushort v30, v3, s[4:7], s12 offen
buffer_load_ushort v46, v3, s[8:11], s12 offen
s_add_u32 s12, s12, 4104
buffer_load_ushort v31, v3, s[4:7], s12 offen
buffer_load_ushort v47, v3, s[8:11], s12 offen
s_add_u32 s12, s12, 4104
s_barrier
ds_write_b32 v4, v48 offset:0
ds_write_b32 v4, v49 offset:16
ds_write_b32 v4, v50 offset:32
ds_write_b32 v4, v51 offset:48
ds_write_b32 v4, v52 offset:64
ds_write_b32 v4, v53 offset:80
ds_write_b32 v4, v54 offset:96
ds_write_b32 v4, v55 offset:112
ds_write_b32 v4, v56 offset:128
ds_write_b32 v4, v57 offset:144
ds_write_b32 v4, v58 offset:160
ds_write_b32 v4, v59 offset:176
s_waitcnt lgkmcnt(4)
ds_write_b32 v4, v60 offset:192
ds_write_b32 v4, v61 offset:208
ds_write_b32 v4, v62 offset:224
ds_write_b32 v4, v63 offset:240
s_waitcnt lgkmcnt(0)
s_barrier
ds_read2_b32 v[64:65], v5 offset0:0 offset1:1
ds_read_b32 v66, v5 offset:8
ds_read_b32 v67, v5 offset:12
ds_read_b32 v68, v5 offset:4160
ds_read_b32 v69, v5 offset:4164
ds_read_b32 v70, v5 offset:4168
ds_read_b32 v71, v5 offset:4172
ds_read_b32 v72, v5 offset:8320
ds_read_b32 v73, v5 offset:8324
ds_read_b32 v74, v5 offset:8328
ds_read_b32 v75, v5 offset:8332
ds_read_b32 v76, v5 offset:12480
ds_read_b32 v77, v5 offset:12484
ds_read_b32 v78, v5 offset:12488
ds_read_b32 v79, v5 offset:12492
s_and_b32 s14, s93, 31
s_lshl_b32 s14, s14, 8
s_lshr_b32 s15, s93, 5
s_mul_i32 s15, s15, 524288
s_add_u32 s14, s14, s15
s_waitcnt lgkmcnt(0)
buffer_store_dwordx4 v[64:67], v6, s[24:27], s14 offen sc1
s_add_u32 s14, s14, 131072
buffer_store_dwordx4 v[68:71], v6, s[24:27], s14 offen sc1
s_add_u32 s14, s14, 131072
buffer_store_dwordx4 v[72:75], v6, s[24:27], s14 offen sc1
s_add_u32 s14, s14, 131072
buffer_store_dwordx4 v[76:79], v6, s[24:27], s14 offen sc1
s_add_u32 s14, s14, 131072
s_mov_b32 s93, s21
s_cmp_lt_u32 s93, 288
s_cbranch_scc1 mega_kernel_f0_l
mega_kernel_f0_e:
s_mov_b32 s93, s40
s_waitcnt vmcnt(0)
s_load_dwordx2 s[4:5], s[0:1], 56
s_mov_b32 s48, 0x3f7ec46d
s_mov_b32 s49, 0x3dc8bd36
s_mov_b32 s50, 0x3f7b14be
s_mov_b32 s51, 0x3e47c5c2
s_mov_b32 s52, 0x3f74fa0b
s_mov_b32 s53, 0x3e94a031
s_mov_b32 s54, 0x3f6c835e
s_mov_b32 s55, 0x3ec3ef15
s_mov_b32 s56, 0x3f61c598
s_mov_b32 s57, 0x3ef15aea
s_mov_b32 s58, 0x3f54db31
s_mov_b32 s59, 0x3f0e39da
s_mov_b32 s60, 0x3f45e403
s_mov_b32 s61, 0x3f226799
s_mov_b32 s62, 0x3f3504f3
s_mov_b32 s63, 0x3f3504f3
v_and_b32 v1, 31, v0
v_lshrrev_b32 v2, 5, v0
v_cvt_f32_u32 v3, v1
v_mul_u32_u24 v10, 8448, v2
v_lshl_add_u32 v4, v1, 3, v10
v_mul_u32_u24 v5, 264, v1
v_add_u32 v5, v5, v10
v_and_b32 v11, 7, v0
v_lshrrev_b32 v9, 3, v0
v_mul_u32_u24 v10, 8448, v11
v_lshl_add_u32 v6, v9, 3, v10
v_lshlrev_b32 v7, 3, v9
v_sub_u32 v7, v10, v7
v_add_u32 v7, 4096, v7
v_mul_u32_u24 v8, 16384, v9
v_lshl_add_u32 v8, v11, 4, v8
v_mul_f32 v12, 0xba800000, v3
v_cos_f32 v82, v12
v_sin_f32 v83, v12
v_mul_f32 v12, 0xbb000000, v3
v_cos_f32 v84, v12
v_sin_f32 v85, v12
v_mul_f32 v12, 0xbb400000, v3
v_cos_f32 v86, v12
v_sin_f32 v87, v12
v_mul_f32 v12, 0xbb800000, v3
v_cos_f32 v88, v12
v_sin_f32 v89, v12
v_mul_f32 v12, 0xbba00000, v3
v_cos_f32 v90, v12
v_sin_f32 v91, v12
v_mul_f32 v12, 0xbbc00000, v3
v_cos_f32 v92, v12
v_sin_f32 v93, v12
v_mul_f32 v12, 0xbbe00000, v3
v_cos_f32 v94, v12
v_sin_f32 v95, v12
v_mul_f32 v12, 0xbc000000, v3
v_cos_f32 v96, v12
v_sin_f32 v97, v12
v_mul_f32 v12, 0xbc100000, v3
v_cos_f32 v98, v12
v_sin_f32 v99, v12
v_mul_f32 v12, 0xbc200000, v3
v_cos_f32 v100, v12
v_sin_f32 v101, v12
v_mul_f32 v12, 0xbc300000, v3
v_cos_f32 v102, v12
v_sin_f32 v103, v12
v_mul_f32 v12, 0xbc400000, v3
v_cos_f32 v104, v12
v_sin_f32 v105, v12
v_mul_f32 v12, 0xbc500000, v3
v_cos_f32 v106, v12
v_sin_f32 v107, v12
v_mul_f32 v12, 0xbc600000, v3
v_cos_f32 v108, v12
v_sin_f32 v109, v12
v_mul_f32 v12, 0xbc700000, v3
v_cos_f32 v110, v12
v_sin_f32 v111, v12
v_mul_f32 v12, 0xbc800000, v3
v_cos_f32 v112, v12
v_sin_f32 v113, v12
v_mul_f32 v12, 0xbc880000, v3
v_cos_f32 v114, v12
v_sin_f32 v115, v12
v_mul_f32 v12, 0xbc900000, v3
v_cos_f32 v116, v12
v_sin_f32 v117, v12
v_mul_f32 v12, 0xbc980000, v3
v_cos_f32 v118, v12
v_sin_f32 v119, v12
v_mul_f32 v12, 0xbca00000, v3
v_cos_f32 v120, v12
v_sin_f32 v121, v12
v_mul_f32 v12, 0xbca80000, v3
v_cos_f32 v122, v12
v_sin_f32 v123, v12
v_mul_f32 v12, 0xbcb00000, v3
v_cos_f32 v124, v12
v_sin_f32 v125, v12
v_mul_f32 v12, 0xbcb80000, v3
v_cos_f32 v126, v12
v_sin_f32 v127, v12
v_mul_f32 v12, 0xbcc00000, v3
v_cos_f32 v128, v12
v_sin_f32 v129, v12
v_mul_f32 v12, 0xbcc80000, v3
v_cos_f32 v130, v12
v_sin_f32 v131, v12
v_mul_f32 v12, 0xbcd00000, v3
v_cos_f32 v132, v12
v_sin_f32 v133, v12
v_mul_f32 v12, 0xbcd80000, v3
v_cos_f32 v134, v12
v_sin_f32 v135, v12
v_mul_f32 v12, 0xbce00000, v3
v_cos_f32 v136, v12
v_sin_f32 v137, v12
v_mul_f32 v12, 0xbce80000, v3
v_cos_f32 v138, v12
v_sin_f32 v139, v12
v_mul_f32 v12, 0xbcf00000, v3
v_cos_f32 v140, v12
v_sin_f32 v141, v12
v_mul_f32 v12, 0xbcf80000, v3
v_cos_f32 v142, v12
v_sin_f32 v143, v12
v_lshlrev_b32 v12, 12, v2
v_lshl_add_u32 v12, v1, 1, v12
s_waitcnt lgkmcnt(0)
s_mov_b32 s6, 4194304
s_mov_b32 s7, 0x00020000
v_mov_b32 v144, 0
v_mov_b32 v145, 0
v_mov_b32 v146, 0
v_mov_b32 v147, 0
v_mov_b32 v148, 0
v_mov_b32 v149, 0
v_mov_b32 v150, 0
v_mov_b32 v151, 0
v_mov_b32 v152, 0
v_mov_b32 v153, 0
v_mov_b32 v154, 0
v_mov_b32 v155, 0
v_mov_b32 v156, 0
v_mov_b32 v157, 0
v_mov_b32 v158, 0
v_mov_b32 v159, 0
v_mov_b32 v160, 0
v_mov_b32 v161, 0
v_mov_b32 v162, 0
v_mov_b32 v163, 0
v_mov_b32 v164, 0
v_mov_b32 v165, 0
v_mov_b32 v166, 0
v_mov_b32 v167, 0
v_mov_b32 v168, 0
v_mov_b32 v169, 0
v_mov_b32 v170, 0
v_mov_b32 v171, 0
v_mov_b32 v172, 0
v_mov_b32 v173, 0
v_mov_b32 v174, 0
v_mov_b32 v175, 0
v_mov_b32 v176, 0
v_mov_b32 v177, 0
v_mov_b32 v178, 0
v_mov_b32 v179, 0
v_mov_b32 v180, 0
v_mov_b32 v181, 0
v_mov_b32 v182, 0
v_mov_b32 v183, 0
v_mov_b32 v184, 0
v_mov_b32 v185, 0
v_mov_b32 v186, 0
v_mov_b32 v187, 0
v_mov_b32 v188, 0
v_mov_b32 v189, 0
v_mov_b32 v190, 0
v_mov_b32 v191, 0
v_mov_b32 v192, 0
v_mov_b32 v193, 0
v_mov_b32 v194, 0
v_mov_b32 v195, 0
v_mov_b32 v196, 0
v_mov_b32 v197, 0
v_mov_b32 v198, 0
v_mov_b32 v199, 0
v_mov_b32 v200, 0
v_mov_b32 v201, 0
v_mov_b32 v202, 0
v_mov_b32 v203, 0
v_mov_b32 v204, 0
v_mov_b32 v205, 0
v_mov_b32 v206, 0
v_mov_b32 v207, 0
s_cmp_lt_u32 s93, 128
s_cbranch_scc0 mega_kernel_f1_e
s_lshl_b32 s12, s93, 15
buffer_load_short_d16_hi v144, v12, s[4:7], s12 offen offset:0
buffer_load_short_d16_hi v145, v12, s[4:7], s12 offen offset:2048
buffer_load_short_d16_hi v176, v12, s[4:7], s12 offen offset:1024
buffer_load_short_d16_hi v177, v12, s[4:7], s12 offen offset:3072
buffer_load_short_d16_hi v146, v12, s[4:7], s12 offen offset:64
buffer_load_short_d16_hi v147, v12, s[4:7], s12 offen offset:2112
buffer_load_short_d16_hi v178, v12, s[4:7], s12 offen offset:1088
buffer_load_short_d16_hi v179, v12, s[4:7], s12 offen offset:3136
buffer_load_short_d16_hi v148, v12, s[4:7], s12 offen offset:128
buffer_load_short_d16_hi v149, v12, s[4:7], s12 offen offset:2176
buffer_load_short_d16_hi v180, v12, s[4:7], s12 offen offset:1152
buffer_load_short_d16_hi v181, v12, s[4:7], s12 offen offset:3200
buffer_load_short_d16_hi v150, v12, s[4:7], s12 offen offset:192
buffer_load_short_d16_hi v151, v12, s[4:7], s12 offen offset:2240
buffer_load_short_d16_hi v182, v12, s[4:7], s12 offen offset:1216
buffer_load_short_d16_hi v183, v12, s[4:7], s12 offen offset:3264
buffer_load_short_d16_hi v152, v12, s[4:7], s12 offen offset:256
buffer_load_short_d16_hi v153, v12, s[4:7], s12 offen offset:2304
buffer_load_short_d16_hi v184, v12, s[4:7], s12 offen offset:1280
buffer_load_short_d16_hi v185, v12, s[4:7], s12 offen offset:3328
buffer_load_short_d16_hi v154, v12, s[4:7], s12 offen offset:320
buffer_load_short_d16_hi v155, v12, s[4:7], s12 offen offset:2368
buffer_load_short_d16_hi v186, v12, s[4:7], s12 offen offset:1344
buffer_load_short_d16_hi v187, v12, s[4:7], s12 offen offset:3392
buffer_load_short_d16_hi v156, v12, s[4:7], s12 offen offset:384
buffer_load_short_d16_hi v157, v12, s[4:7], s12 offen offset:2432
buffer_load_short_d16_hi v188, v12, s[4:7], s12 offen offset:1408
buffer_load_short_d16_hi v189, v12, s[4:7], s12 offen offset:3456
buffer_load_short_d16_hi v158, v12, s[4:7], s12 offen offset:448
buffer_load_short_d16_hi v159, v12, s[4:7], s12 offen offset:2496
buffer_load_short_d16_hi v190, v12, s[4:7], s12 offen offset:1472
buffer_load_short_d16_hi v191, v12, s[4:7], s12 offen offset:3520
buffer_load_short_d16_hi v160, v12, s[4:7], s12 offen offset:512
buffer_load_short_d16_hi v161, v12, s[4:7], s12 offen offset:2560
buffer_load_short_d16_hi v192, v12, s[4:7], s12 offen offset:1536
buffer_load_short_d16_hi v193, v12, s[4:7], s12 offen offset:3584
buffer_load_short_d16_hi v162, v12, s[4:7], s12 offen offset:576
buffer_load_short_d16_hi v163, v12, s[4:7], s12 offen offset:2624
buffer_load_short_d16_hi v194, v12, s[4:7], s12 offen offset:1600
buffer_load_short_d16_hi v195, v12, s[4:7], s12 offen offset:3648
buffer_load_short_d16_hi v164, v12, s[4:7], s12 offen offset:640
buffer_load_short_d16_hi v165, v12, s[4:7], s12 offen offset:2688
buffer_load_short_d16_hi v196, v12, s[4:7], s12 offen offset:1664
buffer_load_short_d16_hi v197, v12, s[4:7], s12 offen offset:3712
buffer_load_short_d16_hi v166, v12, s[4:7], s12 offen offset:704
buffer_load_short_d16_hi v167, v12, s[4:7], s12 offen offset:2752
buffer_load_short_d16_hi v198, v12, s[4:7], s12 offen offset:1728
buffer_load_short_d16_hi v199, v12, s[4:7], s12 offen offset:3776
buffer_load_short_d16_hi v168, v12, s[4:7], s12 offen offset:768
buffer_load_short_d16_hi v169, v12, s[4:7], s12 offen offset:2816
buffer_load_short_d16_hi v200, v12, s[4:7], s12 offen offset:1792
buffer_load_short_d16_hi v201, v12, s[4:7], s12 offen offset:3840
buffer_load_short_d16_hi v170, v12, s[4:7], s12 offen offset:832
buffer_load_short_d16_hi v171, v12, s[4:7], s12 offen offset:2880
buffer_load_short_d16_hi v202, v12, s[4:7], s12 offen offset:1856
buffer_load_short_d16_hi v203, v12, s[4:7], s12 offen offset:3904
buffer_load_short_d16_hi v172, v12, s[4:7], s12 offen offset:896
buffer_load_short_d16_hi v173, v12, s[4:7], s12 offen offset:2944
buffer_load_short_d16_hi v204, v12, s[4:7], s12 offen offset:1920
buffer_load_short_d16_hi v205, v12, s[4:7], s12 offen offset:3968
buffer_load_short_d16_hi v174, v12, s[4:7], s12 offen offset:960
buffer_load_short_d16_hi v175, v12, s[4:7], s12 offen offset:3008
buffer_load_short_d16_hi v206, v12, s[4:7], s12 offen offset:1984
buffer_load_short_d16_hi v207, v12, s[4:7], s12 offen offset:4032
s_waitcnt vmcnt(0)
mega_kernel_f1_l:
s_add_u32 s21, s93, 32
s_cmp_lt_u32 s21, 128
s_cselect_b32 s22, s21, s93
s_waitcnt vmcnt(17)
v_pk_add_f32 v[48:49], v[144:145], v[176:177] neg_lo:[0,1] neg_hi:[0,1]
v_pk_add_f32 v[16:17], v[144:145], v[176:177]
v_pk_add_f32 v[14:15], v[146:147], v[178:179] neg_lo:[0,1] neg_hi:[0,1]
v_pk_add_f32 v[18:19], v[146:147], v[178:179]
v_pk_mul_f32 v[50:51], v[14:15], s[50:51] op_sel:[0,0] op_sel_hi:[0,1] neg_lo:[0,0] neg_hi:[0,1]
v_pk_fma_f32 v[50:51], v[14:15], s[50:51], v[50:51] op_sel:[1,1,0] op_sel_hi:[1,0,1] neg_lo:[0,0,0] neg_hi:[0,0,0]
v_pk_add_f32 v[14:15], v[148:149], v[180:181] neg_lo:[0,1] neg_hi:[0,1]
v_pk_add_f32 v[20:21], v[148:149], v[180:181]
v_pk_mul_f32 v[52:53], v[14:15], s[54:55] op_sel:[0,0] op_sel_hi:[0,1] neg_lo:[0,0] neg_hi:[0,1]
v_pk_fma_f32 v[52:53], v[14:15], s[54:55], v[52:53] op_sel:[1,1,0] op_sel_hi:[1,0,1] neg_lo:[0,0,0] neg_hi:[0,0,0]
v_pk_add_f32 v[14:15], v[150:151], v[182:183] neg_lo:[0,1] neg_hi:[0,1]
v_pk_add_f32 v[22:23], v[150:151], v[182:183]
v_pk_mul_f32 v[54:55], v[14:15], s[58:59] op_sel:[0,0] op_sel_hi:[0,1] neg_lo:[0,0] neg_hi:[0,1]
v_pk_fma_f32 v[54:55], v[14:15], s[58:59], v[54:55] op_sel:[1,1,0] op_sel_hi:[1,0,1] neg_lo:[0,0,0] neg_hi:[0,0,0]
v_pk_add_f32 v[14:15], v[152:153], v[184:185] neg_lo:[0,1] neg_hi:[0,1]
v_pk_add_f32 v[24:25], v[152:153], v[184:185]
v_pk_mul_f32 v[56:57], v[14:15], s[62:63] op_sel:[0,0] op_sel_hi:[0,1] neg_lo:[0,0] neg_hi:[0,1]
v_pk_fma_f32 v[56:57], v[14:15], s[62:63], v[56:57] op_sel:[1,1,0] op_sel_hi:[1,0,1] neg_lo:[0,0,0] neg_hi:[0,0,0]
v_pk_add_f32 v[14:15], v[154:155], v[186:187] neg_lo:[0,1] neg_hi:[0,1]
v_pk_add_f32 v[26:27], v[154:155], v[186:187]
v_pk_mul_f32 v[58:59], v[14:15], s[58:59] op_sel:[0,1] op_sel_hi:[0,0] neg_lo:[0,0] neg_hi:[0,1]
v_pk_fma_f32 v[58:59], v[14:15], s[58:59], v[58:59] op_sel:[1,0,0] op_sel_hi:[1,1,1] neg_lo:[0,0,0] neg_hi:[0,0,0]
v_pk_add_f32 v[14:15], v[156:157], v[188:189] neg_lo:[0,1] neg_hi:[0,1]
v_pk_add_f32 v[28:29], v[156:157], v[188:189]
v_pk_mul_f32 v[60:61], v[14:15], s[54:55] op_sel:[0,1] op_sel_hi:[0,0] neg_lo:[0,0] neg_hi:[0,1]
v_pk_fma_f32 v[60:61], v[14:15], s[54:55], v[60:61] op_sel:[1,0,0] op_sel_hi:[1,1,1] neg_lo:[0,0,0] neg_hi:[0,0,0]
v_pk_add_f32 v[14:15], v[158:159], v[190:191] neg_lo:[0,1] neg_hi:[0,1]
v_pk_add_f32 v[30:31], v[158:159], v[190:191]
v_pk_mul_f32 v[62:63], v[14:15], s[50:51] op_sel:[0,1] op_sel_hi:[0,0] neg_lo:[0,0] neg_hi:[0,1]
v_pk_fma_f32 v[62:63], v[14:15], s[50:51], v[62:63] op_sel:[1,0,0] op_sel_hi:[1,1,1] neg_lo:[0,0,0] neg_hi:[0,0,0]
v_pk_add_f32 v[64:65], v[160:161], v[192:193] op_sel:[1,1] op_sel_hi:[0,0] neg_lo:[0,1] neg_hi:[1,0]
v_pk_add_f32 v[32:33], v[160:161], v[192:193]
v_pk_add_f32 v[14:15], v[162:163], v[194:195] neg_lo:[0,1] neg_hi:[0,1]
v_pk_add_f32 v[34:35], v[162:163], v[194:195]
v_pk_mul_f32 v[66:67], v[14:15], s[50:51] op_sel:[0,1] op_sel_hi:[0,0] neg_lo:[0,1] neg_hi:[0,1]
v_pk_fma_f32 v[66:67], v[14:15], s[50:51], v[66:67] op_sel:[1,0,0] op_sel_hi:[1,1,1] neg_lo:[0,0,0] neg_hi:[0,1,0]
v_pk_add_f32 v[14:15], v[164:165], v[196:197] neg_lo:[0,1] neg_hi:[0,1]
v_pk_add_f32 v[36:37], v[164:165], v[196:197]
v_pk_mul_f32 v[68:69], v[14:15], s[54:55] op_sel:[0,1] op_sel_hi:[0,0] neg_lo:[0,1] neg_hi:[0,1]
v_pk_fma_f32 v[68:69], v[14:15], s[54:55], v[68:69] op_sel:[1,0,0] op_sel_hi:[1,1,1] neg_lo:[0,0,0] neg_hi:[0,1,0]
v_pk_add_f32 v[14:15], v[166:167], v[198:199] neg_lo:[0,1] neg_hi:[0,1]
v_pk_add_f32 v[38:39], v[166:167], v[198:199]
v_pk_mul_f32 v[70:71], v[14:15], s[58:59] op_sel:[0,1] op_sel_hi:[0,0] neg_lo:[0,1] neg_hi:[0,1]
v_pk_fma_f32 v[70:71], v[14:15], s[58:59], v[70:71] op_sel:[1,0,0] op_sel_hi:[1,1,1] neg_lo:[0,0,0] neg_hi:[0,1,0]
v_pk_add_f32 v[14:15], v[168:169], v[200:201] neg_lo:[0,1] neg_hi:[0,1]
v_pk_add_f32 v[40:41], v[168:169], v[200:201]
v_pk_mul_f32 v[72:73], v[14:15], s[62:63] op_sel:[0,0] op_sel_hi:[0,1] neg_lo:[0,1] neg_hi:[0,1]
v_pk_fma_f32 v[72:73], v[14:15], s[62:63], v[72:73] op_sel:[1,1,0] op_sel_hi:[1,0,1] neg_lo:[0,0,0] neg_hi:[0,1,0]
v_pk_add_f32 v[14:15], v[170:171], v[202:203] neg_lo:[0,1] neg_hi:[0,1]
v_pk_add_f32 v[42:43], v[170:171], v[202:203]
v_pk_mul_f32 v[74:75], v[14:15], s[58:59] op_sel:[0,0] op_sel_hi:[0,1] neg_lo:[0,1] neg_hi:[0,1]
v_pk_fma_f32 v[74:75], v[14:15], s[58:59], v[74:75] op_sel:[1,1,0] op_sel_hi:[1,0,1] neg_lo:[0,0,0] neg_hi:[0,1,0]
v_pk_add_f32 v[14:15], v[172:173], v[204:205] neg_lo:[0,1] neg_hi:[0,1]
v_pk_add_f32 v[44:45], v[172:173], v[204:205]
v_pk_mul_f32 v[76:77], v[14:15], s[54:55] op_sel:[0,0] op_sel_hi:[0,1] neg_lo:[0,1] neg_hi:[0,1]
v_pk_fma_f32 v[76:77], v[14:15], s[54:55], v[76:77] op_sel:[1,1,0] op_sel_hi:[1,0,1] neg_lo:[0,0,0] neg_hi:[0,1,0]
v_pk_add_f32 v[14:15], v[174:175], v[206:207] neg_lo:[0,1] neg_hi:[0,1]
v_pk_add_f32 v[46:47], v[174:175], v[206:207]
v_pk_mul_f32 v[78:79], v[14:15], s[50:51] op_sel:[0,0] op_sel_hi:[0,1] neg_lo:[0,1] neg_hi:[0,1]
v_pk_fma_f32 v[78:79], v[14:15], s[50:51], v[78:79] op_sel:[1,1,0] op_sel_hi:[1,0,1] neg_lo:[0,0,0] neg_hi:[0,1,0]
s_lshl_b32 s12, s22, 15
buffer_load_short_d16_hi v144, v12, s[4:7], s12 offen offset:0
buffer_load_short_d16_hi v145, v12, s[4:7], s12 offen offset:2048
buffer_load_short_d16_hi v176, v12, s[4:7], s12 offen offset:1024
buffer_load_short_d16_hi v177, v12, s[4:7], s12 offen offset:3072
buffer_load_short_d16_hi v146, v12, s[4:7], s12 offen offset:64
buffer_load_short_d16_hi v147, v12, s[4:7], s12 offen offset:2112
buffer_load_short_d16_hi v178, v12, s[4:7], s12 offen offset:1088
buffer_load_short_d16_hi v179, v12, s[4:7], s12 offen offset:3136
buffer_load_short_d16_hi v148, v12, s[4:7], s12 offen offset:128
buffer_load_short_d16_hi v149, v12, s[4:7], s12 offen offset:2176
buffer_load_short_d16_hi v180, v12, s[4:7], s12 offen offset:1152
buffer_load_short_d16_hi v181, v12, s[4:7], s12 offen offset:3200
buffer_load_short_d16_hi v150, v12, s[4:7], s12 offen offset:192
buffer_load_short_d16_hi v151, v12, s[4:7], s12 offen offset:2240
buffer_load_short_d16_hi v182, v12, s[4:7], s12 offen offset:1216
buffer_load_short_d16_hi v183, v12, s[4:7], s12 offen offset:3264
buffer_load_short_d16_hi v152, v12, s[4:7], s12 offen offset:256
buffer_load_short_d16_hi v153, v12, s[4:7], s12 offen offset:2304
buffer_load_short_d16_hi v184, v12, s[4:7], s12 offen offset:1280
buffer_load_short_d16_hi v185, v12, s[4:7], s12 offen offset:3328
buffer_load_short_d16_hi v154, v12, s[4:7], s12 offen offset:320
buffer_load_short_d16_hi v155, v12, s[4:7], s12 offen offset:2368
buffer_load_short_d16_hi v186, v12, s[4:7], s12 offen offset:1344
buffer_load_short_d16_hi v187, v12, s[4:7], s12 offen offset:3392
buffer_load_short_d16_hi v156, v12, s[4:7], s12 offen offset:384
buffer_load_short_d16_hi v157, v12, s[4:7], s12 offen offset:2432
buffer_load_short_d16_hi v188, v12, s[4:7], s12 offen offset:1408
buffer_load_short_d16_hi v189, v12, s[4:7], s12 offen offset:3456
buffer_load_short_d16_hi v158, v12, s[4:7], s12 offen offset:448
buffer_load_short_d16_hi v159, v12, s[4:7], s12 offen offset:2496
buffer_load_short_d16_hi v190, v12, s[4:7], s12 offen offset:1472
buffer_load_short_d16_hi v191, v12, s[4:7], s12 offen offset:3520
buffer_load_short_d16_hi v160, v12, s[4:7], s12 offen offset:512
buffer_load_short_d16_hi v161, v12, s[4:7], s12 offen offset:2560
buffer_load_short_d16_hi v192, v12, s[4:7], s12 offen offset:1536
buffer_load_short_d16_hi v193, v12, s[4:7], s12 offen offset:3584
buffer_load_short_d16_hi v162, v12, s[4:7], s12 offen offset:576
buffer_load_short_d16_hi v163, v12, s[4:7], s12 offen offset:2624
buffer_load_short_d16_hi v194, v12, s[4:7], s12 offen offset:1600
buffer_load_short_d16_hi v195, v12, s[4:7], s12 offen offset:3648
buffer_load_short_d16_hi v164, v12, s[4:7], s12 offen offset:640
buffer_load_short_d16_hi v165, v12, s[4:7], s12 offen offset:2688
buffer_load_short_d16_hi v196, v12, s[4:7], s12 offen offset:1664
buffer_load_short_d16_hi v197, v12, s[4:7], s12 offen offset:3712
buffer_load_short_d16_hi v166, v12, s[4:7], s12 offen offset:704
buffer_load_short_d16_hi v167, v12, s[4:7], s12 offen offset:2752
buffer_load_short_d16_hi v198, v12, s[4:7], s12 offen offset:1728
buffer_load_short_d16_hi v199, v12, s[4:7], s12 offen offset:3776
buffer_load_short_d16_hi v168, v12, s[4:7], s12 offen offset:768
buffer_load_short_d16_hi v169, v12, s[4:7], s12 offen offset:2816
buffer_load_short_d16_hi v200, v12, s[4:7], s12 offen offset:1792
buffer_load_short_d16_hi v201, v12, s[4:7], s12 offen offset:3840
buffer_load_short_d16_hi v170, v12, s[4:7], s12 offen offset:832
buffer_load_short_d16_hi v171, v12, s[4:7], s12 offen offset:2880
buffer_load_short_d16_hi v202, v12, s[4:7], s12 offen offset:1856
buffer_load_short_d16_hi v203, v12, s[4:7], s12 offen offset:3904
buffer_load_short_d16_hi v172, v12, s[4:7], s12 offen offset:896
buffer_load_short_d16_hi v173, v12, s[4:7], s12 offen offset:2944
buffer_load_short_d16_hi v204, v12, s[4:7], s12 offen offset:1920
buffer_load_short_d16_hi v205, v12, s[4:7], s12 offen offset:3968
buffer_load_short_d16_hi v174, v12, s[4:7], s12 offen offset:960
buffer_load_short_d16_hi v175, v12, s[4:7], s12 offen offset:3008
buffer_load_short_d16_hi v206, v12, s[4:7], s12 offen offset:1984
buffer_load_short_d16_hi v207, v12, s[4:7], s12 offen offset:4032
v_pk_add_f32 v[14:15], v[16:17], v[32:33] neg_lo:[0,1] neg_hi:[0,1]
v_pk_add_f32 v[16:17], v[16:17], v[32:33]
v_pk_add_f32 v[32:33], v[18:19], v[34:35] neg_lo:[0,1] neg_hi:[0,1]
v_pk_add_f32 v[18:19], v[18:19], v[34:35]
v_pk_mul_f32 v[34:35], v[32:33], s[54:55] op_sel:[0,0] op_sel_hi:[0,1] neg_lo:[0,0] neg_hi:[0,1]
v_pk_fma_f32 v[34:35], v[32:33], s[54:55], v[34:35] op_sel:[1,1,0] op_sel_hi:[1,0,1] neg_lo:[0,0,0] neg_hi:[0,0,0]
v_pk_add_f32 v[32:33], v[20:21], v[36:37] neg_lo:[0,1] neg_hi:[0,1]
v_pk_add_f32 v[20:21], v[20:21], v[36:37]
v_pk_mul_f32 v[36:37], v[32:33], s[62:63] op_sel:[0,0] op_sel_hi:[0,1] neg_lo:[0,0] neg_hi:[0,1]
v_pk_fma_f32 v[36:37], v[32:33], s[62:63], v[36:37] op_sel:[1,1,0] op_sel_hi:[1,0,1] neg_lo:[0,0,0] neg_hi:[0,0,0]
v_pk_add_f32 v[32:33], v[22:23], v[38:39] neg_lo:[0,1] neg_hi:[0,1]
v_pk_add_f32 v[22:23], v[22:23], v[38:39]
v_pk_mul_f32 v[38:39], v[32:33], s[54:55] op_sel:[0,1] op_sel_hi:[0,0] neg_lo:[0,0] neg_hi:[0,1]
v_pk_fma_f32 v[38:39], v[32:33], s[54:55], v[38:39] op_sel:[1,0,0] op_sel_hi:[1,1,1] neg_lo:[0,0,0] neg_hi:[0,0,0]
v_pk_add_f32 v[32:33], v[24:25], v[40:41] op_sel:[1,1] op_sel_hi:[0,0] neg_lo:[0,1] neg_hi:[1,0]
v_pk_add_f32 v[24:25], v[24:25], v[40:41]
v_pk_add_f32 v[40:41], v[26:27], v[42:43] neg_lo:[0,1] neg_hi:[0,1]
v_pk_add_f32 v[26:27], v[26:27], v[42:43]
v_pk_mul_f32 v[42:43], v[40:41], s[54:55] op_sel:[0,1] op_sel_hi:[0,0] neg_lo:[0,1] neg_hi:[0,1]
v_pk_fma_f32 v[42:43], v[40:41], s[54:55], v[42:43] op_sel:[1,0,0] op_sel_hi:[1,1,1] neg_lo:[0,0,0] neg_hi:[0,1,0]
v_pk_add_f32 v[40:41], v[28:29], v[44:45] neg_lo:[0,1] neg_hi:[0,1]
v_pk_add_f32 v[28:29], v[28:29], v[44:45]
v_pk_mul_f32 v[44:45], v[40:41], s[62:63] op_sel:[0,0] op_sel_hi:[0,1] neg_lo:[0,1] neg_hi:[0,1]
v_pk_fma_f32 v[44:45], v[40:41], s[62:63], v[44:45] op_sel:[1,1,0] op_sel_hi:[1,0,1] neg_lo:[0,0,0] neg_hi:[0,1,0]
v_pk_add_f32 v[40:41], v[30:31], v[46:47] neg_lo:[0,1] neg_hi:[0,1]
v_pk_add_f32 v[30:31], v[30:31], v[46:47]
v_pk_mul_f32 v[46:47], v[40:41], s[54:55] op_sel:[0,0] op_sel_hi:[0,1] neg_lo:[0,1] neg_hi:[0,1]
v_pk_fma_f32 v[46:47], v[40:41], s[54:55], v[46:47] op_sel:[1,1,0] op_sel_hi:[1,0,1] neg_lo:[0,0,0] neg_hi:[0,1,0]
v_pk_add_f32 v[40:41], v[48:49], v[64:65] neg_lo:[0,1] neg_hi:[0,1]
v_pk_add_f32 v[48:49], v[48:49], v[64:65]
v_pk_add_f32 v[64:65], v[50:51], v[66:67] neg_lo:[0,1] neg_hi:[0,1]
v_pk_add_f32 v[50:51], v[50:51], v[66:67]
v_pk_mul_f32 v[66:67], v[64:65], s[54:55] op_sel:[0,0] op_sel_hi:[0,1] neg_lo:[0,0] neg_hi:[0,1]
v_pk_fma_f32 v[66:67], v[64:65], s[54:55], v[66:67] op_sel:[1,1,0] op_sel_hi:[1,0,1] neg_lo:[0,0,0] neg_hi:[0,0,0]
v_pk_add_f32 v[64:65], v[52:53], v[68:69] neg_lo:[0,1] neg_hi:[0,1]
v_pk_add_f32 v[52:53], v[52:53], v[68:69]
v_pk_mul_f32 v[68:69], v[64:65], s[62:63] op_sel:[0,0] op_sel_hi:[0,1] neg_lo:[0,0] neg_hi:[0,1]
v_pk_fma_f32 v[68:69], v[64:65], s[62:63], v[68:69] op_sel:[1,1,0] op_sel_hi:[1,0,1] neg_lo:[0,0,0] neg_hi:[0,0,0]
v_pk_add_f32 v[64:65], v[54:55], v[70:71] neg_lo:[0,1] neg_hi:[0,1]
v_pk_add_f32 v[54:55], v[54:55], v[70:71]
v_pk_mul_f32 v[70:71], v[64:65], s[54:55] op_sel:[0,1] op_sel_hi:[0,0] neg_lo:[0,0] neg_hi:[0,1]
v_pk_fma_f32 v[70:71], v[64:65], s[54:55], v[70:71] op_sel:[1,0,0] op_sel_hi:[1,1,1] neg_lo:[0,0,0] neg_hi:[0,0,0]
v_pk_add_f32 v[64:65], v[56:57], v[72:73] op_sel:[1,1] op_sel_hi:[0,0] neg_lo:[0,1] neg_hi:[1,0]
v_pk_add_f32 v[56:57], v[56:57], v[72:73]
v_pk_add_f32 v[72:73], v[58:59], v[74:75] neg_lo:[0,1] neg_hi:[0,1]
v_pk_add_f32 v[58:59], v[58:59], v[74:75]
v_pk_mul_f32 v[74:75], v[72:73], s[54:55] op_sel:[0,1] op_sel_hi:[0,0] neg_lo:[0,1] neg_hi:[0,1]
v_pk_fma_f32 v[74:75], v[72:73], s[54:55], v[74:75] op_sel:[1,0,0] op_sel_hi:[1,1,1] neg_lo:[0,0,0] neg_hi:[0,1,0]
v_pk_add_f32 v[72:73], v[60:61], v[76:77] neg_lo:[0,1] neg_hi:[0,1]
v_pk_add_f32 v[60:61], v[60:61], v[76:77]
v_pk_mul_f32 v[76:77], v[72:73], s[62:63] op_sel:[0,0] op_sel_hi:[0,1] neg_lo:[0,1] neg_hi:[0,1]
v_pk_fma_f32 v[76:77], v[72:73], s[62:63], v[76:77] op_sel:[1,1,0] op_sel_hi:[1,0,1] neg_lo:[0,0,0] neg_hi:[0,1,0]
v_pk_add_f32 v[72:73], v[62:63], v[78:79] neg_lo:[0,1] neg_hi:[0,1]
v_pk_add_f32 v[62:63], v[62:63], v[78:79]
v_pk_mul_f32 v[78:79], v[72:73], s[54:55] op_sel:[0,0] op_sel_hi:[0,1] neg_lo:[0,1] neg_hi:[0,1]
v_pk_fma_f32 v[78:79], v[72:73], s[54:55], v[78:79] op_sel:[1,1,0] op_sel_hi:[1,0,1] neg_lo:[0,0,0] neg_hi:[0,1,0]
v_pk_add_f32 v[72:73], v[16:17], v[24:25] neg_lo:[0,1] neg_hi:[0,1]
v_pk_add_f32 v[16:17], v[16:17], v[24:25]
v_pk_add_f32 v[24:25], v[18:19], v[26:27] neg_lo:[0,1] neg_hi:[0,1]
v_pk_add_f32 v[18:19], v[18:19], v[26:27]
v_pk_mul_f32 v[26:27], v[24:25], s[62:63] op_sel:[0,0] op_sel_hi:[0,1] neg_lo:[0,0] neg_hi:[0,1]
v_pk_fma_f32 v[26:27], v[24:25], s[62:63], v[26:27] op_sel:[1,1,0] op_sel_hi:[1,0,1] neg_lo:[0,0,0] neg_hi:[0,0,0]
v_pk_add_f32 v[24:25], v[20:21], v[28:29] op_sel:[1,1] op_sel_hi:[0,0] neg_lo:[0,1] neg_hi:[1,0]
v_pk_add_f32 v[20:21], v[20:21], v[28:29]
v_pk_add_f32 v[28:29], v[22:23], v[30:31] neg_lo:[0,1] neg_hi:[0,1]
v_pk_add_f32 v[22:23], v[22:23], v[30:31]
v_pk_mul_f32 v[30:31], v[28:29], s[62:63] op_sel:[0,0] op_sel_hi:[0,1] neg_lo:[0,1] neg_hi:[0,1]
v_pk_fma_f32 v[30:31], v[28:29], s[62:63], v[30:31] op_sel:[1,1,0] op_sel_hi:[1,0,1] neg_lo:[0,0,0] neg_hi:[0,1,0]
v_pk_add_f32 v[28:29], v[14:15], v[32:33] neg_lo:[0,1] neg_hi:[0,1]
v_pk_add_f32 v[14:15], v[14:15], v[32:33]
v_pk_add_f32 v[32:33], v[34:35], v[42:43] neg_lo:[0,1] neg_hi:[0,1]
v_pk_add_f32 v[34:35], v[34:35], v[42:43]
v_pk_mul_f32 v[42:43], v[32:33], s[62:63] op_sel:[0,0] op_sel_hi:[0,1] neg_lo:[0,0] neg_hi:[0,1]
v_pk_fma_f32 v[42:43], v[32:33], s[62:63], v[42:43] op_sel:[1,1,0] op_sel_hi:[1,0,1] neg_lo:[0,0,0] neg_hi:[0,0,0]
v_pk_add_f32 v[32:33], v[36:37], v[44:45] op_sel:[1,1] op_sel_hi:[0,0] neg_lo:[0,1] neg_hi:[1,0]
v_pk_add_f32 v[36:37], v[36:37], v[44:45]
v_pk_add_f32 v[44:45], v[38:39], v[46:47] neg_lo:[0,1] neg_hi:[0,1]
v_pk_add_f32 v[38:39], v[38:39], v[46:47]
v_pk_mul_f32 v[46:47], v[44:45], s[62:63] op_sel:[0,0] op_sel_hi:[0,1] neg_lo:[0,1] neg_hi:[0,1]
v_pk_fma_f32 v[46:47], v[44:45], s[62:63], v[46:47] op_sel:[1,1,0] op_sel_hi:[1,0,1] neg_lo:[0,0,0] neg_hi:[0,1,0]
v_pk_add_f32 v[44:45], v[48:49], v[56:57] neg_lo:[0,1] neg_hi:[0,1]
v_pk_add_f32 v[48:49], v[48:49], v[56:57]
v_pk_add_f32 v[56:57], v[50:51], v[58:59] neg_lo:[0,1] neg_hi:[0,1]
v_pk_add_f32 v[50:51], v[50:51], v[58:59]
v_pk_mul_f32 v[58:59], v[56:57], s[62:63] op_sel:[0,0] op_sel_hi:[0,1] neg_lo:[0,0] neg_hi:[0,1]
v_pk_fma_f32 v[58:59], v[56:57], s[62:63], v[58:59] op_sel:[1,1,0] op_sel_hi:[1,0,1] neg_lo:[0,0,0] neg_hi:[0,0,0]
v_pk_add_f32 v[56:57], v[52:53], v[60:61] op_sel:[1,1] op_sel_hi:[0,0] neg_lo:[0,1] neg_hi:[1,0]
v_pk_add_f32 v[52:53], v[52:53], v[60:61]
v_pk_add_f32 v[60:61], v[54:55], v[62:63] neg_lo:[0,1] neg_hi:[0,1]
v_pk_add_f32 v[54:55], v[54:55], v[62:63]
v_pk_mul_f32 v[62:63], v[60:61], s[62:63] op_sel:[0,0] op_sel_hi:[0,1] neg_lo:[0,1] neg_hi:[0,1]
v_pk_fma_f32 v[62:63], v[60:61], s[62:63], v[62:63] op_sel:[1,1,0] op_sel_hi:[1,0,1] neg_lo:[0,0,0] neg_hi:[0,1,0]
v_pk_add_f32 v[60:61], v[40:41], v[64:65] neg_lo:[0,1] neg_hi:[0,1]
v_pk_add_f32 v[40:41], v[40:41], v[64:65]
v_pk_add_f32 v[64:65], v[66:67], v[74:75] neg_lo:[0,1] neg_hi:[0,1]
v_pk_add_f32 v[66:67], v[66:67], v[74:75]
v_pk_mul_f32 v[74:75], v[64:65], s[62:63] op_sel:[0,0] op_sel_hi:[0,1] neg_lo:[0,0] neg_hi:[0,1]
v_pk_fma_f32 v[74:75], v[64:65], s[62:63], v[74:75] op_sel:[1,1,0] op_sel_hi:[1,0,1] neg_lo:[0,0,0] neg_hi:[0,0,0]
v_pk_add_f32 v[64:65], v[68:69], v[76:77] op_sel:[1,1] op_sel_hi:[0,0] neg_lo:[0,1] neg_hi:[1,0]
v_pk_add_f32 v[68:69], v[68:69], v[76:77]
v_pk_add_f32 v[76:77], v[70:71], v[78:79] neg_lo:[0,1] neg_hi:[0,1]
v_pk_add_f32 v[70:71], v[70:71], v[78:79]
v_pk_mul_f32 v[78:79], v[76:77], s[62:63] op_sel:[0,0] op_sel_hi:[0,1] neg_lo:[0,1] neg_hi:[0,1]
v_pk_fma_f32 v[78:79], v[76:77], s[62:63], v[78:79] op_sel:[1,1,0] op_sel_hi:[1,0,1] neg_lo:[0,0,0] neg_hi:[0,1,0]
v_pk_add_f32 v[76:77], v[16:17], v[20:21] neg_lo:[0,1] neg_hi:[0,1]
v_pk_add_f32 v[16:17], v[16:17], v[20:21]
v_pk_add_f32 v[20:21], v[18:19], v[22:23] op_sel:[1,1] op_sel_hi:[0,0] neg_lo:[0,1] neg_hi:[1,0]
v_pk_add_f32 v[18:19], v[18:19], v[22:23]
v_pk_add_f32 v[22:23], v[72:73], v[24:25] neg_lo:[0,1] neg_hi:[0,1]
v_pk_add_f32 v[72:73], v[72:73], v[24:25]
v_pk_add_f32 v[24:25], v[26:27], v[30:31] op_sel:[1,1] op_sel_hi:[0,0] neg_lo:[0,1] neg_hi:[1,0]
v_pk_add_f32 v[26:27], v[26:27], v[30:31]
v_pk_add_f32 v[30:31], v[14:15], v[36:37] neg_lo:[0,1] neg_hi:[0,1]
v_pk_add_f32 v[14:15], v[14:15], v[36:37]
v_pk_add_f32 v[36:37], v[34:35], v[38:39] op_sel:[1,1] op_sel_hi:[0,0] neg_lo:[0,1] neg_hi:[1,0]
v_pk_add_f32 v[34:35], v[34:35], v[38:39]
v_pk_add_f32 v[38:39], v[28:29], v[32:33] neg_lo:[0,1] neg_hi:[0,1]
v_pk_add_f32 v[28:29], v[28:29], v[32:33]
v_pk_add_f32 v[32:33], v[42:43], v[46:47] op_sel:[1,1] op_sel_hi:[0,0] neg_lo:[0,1] neg_hi:[1,0]
v_pk_add_f32 v[42:43], v[42:43], v[46:47]
v_pk_add_f32 v[46:47], v[48:49], v[52:53] neg_lo:[0,1] neg_hi:[0,1]
v_pk_add_f32 v[48:49], v[48:49], v[52:53]
v_pk_add_f32 v[52:53], v[50:51], v[54:55] op_sel:[1,1] op_sel_hi:[0,0] neg_lo:[0,1] neg_hi:[1,0]
v_pk_add_f32 v[50:51], v[50:51], v[54:55]
v_pk_add_f32 v[54:55], v[44:45], v[56:57] neg_lo:[0,1] neg_hi:[0,1]
v_pk_add_f32 v[44:45], v[44:45], v[56:57]
v_pk_add_f32 v[56:57], v[58:59], v[62:63] op_sel:[1,1] op_sel_hi:[0,0] neg_lo:[0,1] neg_hi:[1,0]
v_pk_add_f32 v[58:59], v[58:59], v[62:63]
v_pk_add_f32 v[62:63], v[40:41], v[68:69] neg_lo:[0,1] neg_hi:[0,1]
v_pk_add_f32 v[40:41], v[40:41], v[68:69]
v_pk_add_f32 v[68:69], v[66:67], v[70:71] op_sel:[1,1] op_sel_hi:[0,0] neg_lo:[0,1] neg_hi:[1,0]
v_pk_add_f32 v[66:67], v[66:67], v[70:71]
v_pk_add_f32 v[70:71], v[60:61], v[64:65] neg_lo:[0,1] neg_hi:[0,1]
v_pk_add_f32 v[60:61], v[60:61], v[64:65]
v_pk_add_f32 v[64:65], v[74:75], v[78:79] op_sel:[1,1] op_sel_hi:[0,0] neg_lo:[0,1] neg_hi:[1,0]
v_pk_add_f32 v[74:75], v[74:75], v[78:79]
v_pk_add_f32 v[78:79], v[16:17], v[18:19] neg_lo:[0,1] neg_hi:[0,1]
v_pk_add_f32 v[16:17], v[16:17], v[18:19]
v_pk_add_f32 v[18:19], v[76:77], v[20:21] neg_lo:[0,1] neg_hi:[0,1]
v_pk_add_f32 v[76:77], v[76:77], v[20:21]
v_pk_add_f32 v[20:21], v[72:73], v[26:27] neg_lo:[0,1] neg_hi:[0,1]
v_pk_add_f32 v[72:73], v[72:73], v[26:27]
v_pk_add_f32 v[26:27], v[22:23], v[24:25] neg_lo:[0,1] neg_hi:[0,1]
v_pk_add_f32 v[22:23], v[22:23], v[24:25]
v_pk_add_f32 v[24:25], v[14:15], v[34:35] neg_lo:[0,1] neg_hi:[0,1]
v_pk_add_f32 v[14:15], v[14:15], v[34:35]
v_pk_add_f32 v[34:35], v[30:31], v[36:37] neg_lo:[0,1] neg_hi:[0,1]
v_pk_add_f32 v[30:31], v[30:31], v[36:37]
v_pk_add_f32 v[36:37], v[28:29], v[42:43] neg_lo:[0,1] neg_hi:[0,1]
v_pk_add_f32 v[28:29], v[28:29], v[42:43]
v_pk_add_f32 v[42:43], v[38:39], v[32:33] neg_lo:[0,1] neg_hi:[0,1]
v_pk_add_f32 v[38:39], v[38:39], v[32:33]
v_pk_add_f32 v[32:33], v[48:49], v[50:51] neg_lo:[0,1] neg_hi:[0,1]
v_pk_add_f32 v[48:49], v[48:49], v[50:51]
v_pk_add_f32 v[50:51], v[46:47], v[52:53] neg_lo:[0,1] neg_hi:[0,1]
v_pk_add_f32 v[46:47], v[46:47], v[52:53]
v_pk_add_f32 v[52:53], v[44:45], v[58:59] neg_lo:[0,1] neg_hi:[0,1]
v_pk_add_f32 v[44:45], v[44:45], v[58:59]
v_pk_add_f32 v[58:59], v[54:55], v[56:57] neg_lo:[0,1] neg_hi:[0,1]
v_pk_add_f32 v[54:55], v[54:55], v[56:57]
v_pk_add_f32 v[56:57], v[40:41], v[66:67] neg_lo:[0,1] neg_hi:[0,1]
v_pk_add_f32 v[40:41], v[40:41], v[66:67]
v_pk_add_f32 v[66:67], v[62:63], v[68:69] neg_lo:[0,1] neg_hi:[0,1]
v_pk_add_f32 v[62:63], v[62:63], v[68:69]
v_pk_add_f32 v[68:69], v[60:61], v[74:75] neg_lo:[0,1] neg_hi:[0,1]
v_pk_add_f32 v[60:61], v[60:61], v[74:75]
v_pk_add_f32 v[74:75], v[70:71], v[64:65] neg_lo:[0,1] neg_hi:[0,1]
v_pk_add_f32 v[70:71], v[70:71], v[64:65]
v_pk_mul_f32 v[64:65], v[48:49], v[82:83] op_sel:[0,0] op_sel_hi:[0,1] neg_lo:[0,0] neg_hi:[0,0]
v_pk_fma_f32 v[48:49], v[48:49], v[82:83], v[64:65] op_sel:[1,1,0] op_sel_hi:[1,0,1] neg_lo:[0,1,0] neg_hi:[0,0,0]
v_pk_mul_f32 v[64:65], v[14:15], v[84:85] op_sel:[0,0] op_sel_hi:[0,1] neg_lo:[0,0] neg_hi:[0,0]
v_pk_fma_f32 v[14:15], v[14:15], v[84:85], v[64:65] op_sel:[1,1,0] op_sel_hi:[1,0,1] neg_lo:[0,1,0] neg_hi:[0,0,0]
v_pk_mul_f32 v[64:65], v[40:41], v[86:87] op_sel:[0,0] op_sel_hi:[0,1] neg_lo:[0,0] neg_hi:[0,0]
v_pk_fma_f32 v[40:41], v[40:41], v[86:87], v[64:65] op_sel:[1,1,0] op_sel_hi:[1,0,1] neg_lo:[0,1,0] neg_hi:[0,0,0]
v_pk_mul_f32 v[64:65], v[72:73], v[88:89] op_sel:[0,0] op_sel_hi:[0,1] neg_lo:[0,0] neg_hi:[0,0]
v_pk_fma_f32 v[72:73], v[72:73], v[88:89], v[64:65] op_sel:[1,1,0] op_sel_hi:[1,0,1] neg_lo:[0,1,0] neg_hi:[0,0,0]
v_pk_mul_f32 v[64:65], v[44:45], v[90:91] op_sel:[0,0] op_sel_hi:[0,1] neg_lo:[0,0] neg_hi:[0,0]
v_pk_fma_f32 v[44:45], v[44:45], v[90:91], v[64:65] op_sel:[1,1,0] op_sel_hi:[1,0,1] neg_lo:[0,1,0] neg_hi:[0,0,0]
v_pk_mul_f32 v[64:65], v[28:29], v[92:93] op_sel:[0,0] op_sel_hi:[0,1] neg_lo:[0,0] neg_hi:[0,0]
v_pk_fma_f32 v[28:29], v[28:29], v[92:93], v[64:65] op_sel:[1,1,0] op_sel_hi:[1,0,1] neg_lo:[0,1,0] neg_hi:[0,0,0]
v_pk_mul_f32 v[64:65], v[60:61], v[94:95] op_sel:[0,0] op_sel_hi:[0,1] neg_lo:[0,0] neg_hi:[0,0]
v_pk_fma_f32 v[60:61], v[60:61], v[94:95], v[64:65] op_sel:[1,1,0] op_sel_hi:[1,0,1] neg_lo:[0,1,0] neg_hi:[0,0,0]
v_pk_mul_f32 v[64:65], v[76:77], v[96:97] op_sel:[0,0] op_sel_hi:[0,1] neg_lo:[0,0] neg_hi:[0,0]
v_pk_fma_f32 v[76:77], v[76:77], v[96:97], v[64:65] op_sel:[1,1,0] op_sel_hi:[1,0,1] neg_lo:[0,1,0] neg_hi:[0,0,0]
v_pk_mul_f32 v[64:65], v[46:47], v[98:99] op_sel:[0,0] op_sel_hi:[0,1] neg_lo:[0,0] neg_hi:[0,0]
v_pk_fma_f32 v[46:47], v[46:47], v[98:99], v[64:65] op_sel:[1,1,0] op_sel_hi:[1,0,1] neg_lo:[0,1,0] neg_hi:[0,0,0]
v_pk_mul_f32 v[64:65], v[30:31], v[100:101] op_sel:[0,0] op_sel_hi:[0,1] neg_lo:[0,0] neg_hi:[0,0]
v_pk_fma_f32 v[30:31], v[30:31], v[100:101], v[64:65] op_sel:[1,1,0] op_sel_hi:[1,0,1] neg_lo:[0,1,0] neg_hi:[0,0,0]
v_pk_mul_f32 v[64:65], v[62:63], v[102:103] op_sel:[0,0] op_sel_hi:[0,1] neg_lo:[0,0] neg_hi:[0,0]
v_pk_fma_f32 v[62:63], v[62:63], v[102:103], v[64:65] op_sel:[1,1,0] op_sel_hi:[1,0,1] neg_lo:[0,1,0] neg_hi:[0,0,0]
v_pk_mul_f32 v[64:65], v[22:23], v[104:105] op_sel:[0,0] op_sel_hi:[0,1] neg_lo:[0,0] neg_hi:[0,0]
v_pk_fma_f32 v[22:23], v[22:23], v[104:105], v[64:65] op_sel:[1,1,0] op_sel_hi:[1,0,1] neg_lo:[0,1,0] neg_hi:[0,0,0]
v_pk_mul_f32 v[64:65], v[54:55], v[106:107] op_sel:[0,0] op_sel_hi:[0,1] neg_lo:[0,0] neg_hi:[0,0]
v_pk_fma_f32 v[54:55], v[54:55], v[106:107], v[64:65] op_sel:[1,1,0] op_sel_hi:[1,0,1] neg_lo:[0,1,0] neg_hi:[0,0,0]
v_pk_mul_f32 v[64:65], v[38:39], v[108:109] op_sel:[0,0] op_sel_hi:[0,1] neg_lo:[0,0] neg_hi:[0,0]
v_pk_fma_f32 v[38:39], v[38:39], v[108:109], v[64:65] op_sel:[1,1,0] op_sel_hi:[1,0,1] neg_lo:[0,1,0] neg_hi:[0,0,0]
v_pk_mul_f32 v[64:65], v[70:71], v[110:111] op_sel:[0,0] op_sel_hi:[0,1] neg_lo:[0,0] neg_hi:[0,0]
v_pk_fma_f32 v[70:71], v[70:71], v[110:111], v[64:65] op_sel:[1,1,0] op_sel_hi:[1,0,1] neg_lo:[0,1,0] neg_hi:[0,0,0]
v_pk_mul_f32 v[64:65], v[78:79], v[112:113] op_sel:[0,0] op_sel_hi:[0,1] neg_lo:[0,0] neg_hi:[0,0]
v_pk_fma_f32 v[78:79], v[78:79], v[112:113], v[64:65] op_sel:[1,1,0] op_sel_hi:[1,0,1] neg_lo:[0,1,0] neg_hi:[0,0,0]
v_pk_mul_f32 v[64:65], v[32:33], v[114:115] op_sel:[0,0] op_sel_hi:[0,1] neg_lo:[0,0] neg_hi:[0,0]
v_pk_fma_f32 v[32:33], v[32:33], v[114:115], v[64:65] op_sel:[1,1,0] op_sel_hi:[1,0,1] neg_lo:[0,1,0] neg_hi:[0,0,0]
v_pk_mul_f32 v[64:65], v[24:25], v[116:117] op_sel:[0,0] op_sel_hi:[0,1] neg_lo:[0,0] neg_hi:[0,0]
v_pk_fma_f32 v[24:25], v[24:25], v[116:117], v[64:65] op_sel:[1,1,0] op_sel_hi:[1,0,1] neg_lo:[0,1,0] neg_hi:[0,0,0]
v_pk_mul_f32 v[64:65], v[56:57], v[118:119] op_sel:[0,0] op_sel_hi:[0,1] neg_lo:[0,0] neg_hi:[0,0]
v_pk_fma_f32 v[56:57], v[56:57], v[118:119], v[64:65] op_sel:[1,1,0] op_sel_hi:[1,0,1] neg_lo:[0,1,0] neg_hi:[0,0,0]
v_pk_mul_f32 v[64:65], v[20:21], v[120:121] op_sel:[0,0] op_sel_hi:[0,1] neg_lo:[0,0] neg_hi:[0,0]
v_pk_fma_f32 v[20:21], v[20:21], v[120:121], v[64:65] op_sel:[1,1,0] op_sel_hi:[1,0,1] neg_lo:[0,1,0] neg_hi:[0,0,0]
v_pk_mul_f32 v[64:65], v[52:53], v[122:123] op_sel:[0,0] op_sel_hi:[0,1] neg_lo:[0,0] neg_hi:[0,0]
v_pk_fma_f32 v[52:53], v[52:53], v[122:123], v[64:65] op_sel:[1,1,0] op_sel_hi:[1,0,1] neg_lo:[0,1,0] neg_hi:[0,0,0]
v_pk_mul_f32 v[64:65], v[36:37], v[124:125] op_sel:[0,0] op_sel_hi:[0,1] neg_lo:[0,0] neg_hi:[0,0]
v_pk_fma_f32 v[36:37], v[36:37], v[124:125], v[64:65] op_sel:[1,1,0] op_sel_hi:[1,0,1] neg_lo:[0,1,0] neg_hi:[0,0,0]
v_pk_mul_f32 v[64:65], v[68:69], v[126:127] op_sel:[0,0] op_sel_hi:[0,1] neg_lo:[0,0] neg_hi:[0,0]
v_pk_fma_f32 v[68:69], v[68:69], v[126:127], v[64:65] op_sel:[1,1,0] op_sel_hi:[1,0,1] neg_lo:[0,1,0] neg_hi:[0,0,0]
v_pk_mul_f32 v[64:65], v[18:19], v[128:129] op_sel:[0,0] op_sel_hi:[0,1] neg_lo:[0,0] neg_hi:[0,0]
v_pk_fma_f32 v[18:19], v[18:19], v[128:129], v[64:65] op_sel:[1,1,0] op_sel_hi:[1,0,1] neg_lo:[0,1,0] neg_hi:[0,0,0]
v_pk_mul_f32 v[64:65], v[50:51], v[130:131] op_sel:[0,0] op_sel_hi:[0,1] neg_lo:[0,0] neg_hi:[0,0]
v_pk_fma_f32 v[50:51], v[50:51], v[130:131], v[64:65] op_sel:[1,1,0] op_sel_hi:[1,0,1] neg_lo:[0,1,0] neg_hi:[0,0,0]
v_pk_mul_f32 v[64:65], v[34:35], v[132:133] op_sel:[0,0] op_sel_hi:[0,1] neg_lo:[0,0] neg_hi:[0,0]
v_pk_fma_f32 v[34:35], v[34:35], v[132:133], v[64:65] op_sel:[1,1,0] op_sel_hi:[1,0,1] neg_lo:[0,1,0] neg_hi:[0,0,0]
v_pk_mul_f32 v[64:65], v[66:67], v[134:135] op_sel:[0,0] op_sel_hi:[0,1] neg_lo:[0,0] neg_hi:[0,0]
v_pk_fma_f32 v[66:67], v[66:67], v[134:135], v[64:65] op_sel:[1,1,0] op_sel_hi:[1,0,1] neg_lo:[0,1,0] neg_hi:[0,0,0]
v_pk_mul_f32 v[64:65], v[26:27], v[136:137] op_sel:[0,0] op_sel_hi:[0,1] neg_lo:[0,0] neg_hi:[0,0]
v_pk_fma_f32 v[26:27], v[26:27], v[136:137], v[64:65] op_sel:[1,1,0] op_sel_hi:[1,0,1] neg_lo:[0,1,0] neg_hi:[0,0,0]
v_pk_mul_f32 v[64:65], v[58:59], v[138:139] op_sel:[0,0] op_sel_hi:[0,1] neg_lo:[0,0] neg_hi:[0,0]
v_pk_fma_f32 v[58:59], v[58:59], v[138:139], v[64:65] op_sel:[1,1,0] op_sel_hi:[1,0,1] neg_lo:[0,1,0] neg_hi:[0,0,0]
v_pk_mul_f32 v[64:65], v[42:43], v[140:141] op_sel:[0,0] op_sel_hi:[0,1] neg_lo:[0,0] neg_hi:[0,0]
v_pk_fma_f32 v[42:43], v[42:43], v[140:141], v[64:65] op_sel:[1,1,0] op_sel_hi:[1,0,1] neg_lo:[0,1,0] neg_hi:[0,0,0]
v_pk_mul_f32 v[64:65], v[74:75], v[142:143] op_sel:[0,0] op_sel_hi:[0,1] neg_lo:[0,0] neg_hi:[0,0]
v_pk_fma_f32 v[74:75], v[74:75], v[142:143], v[64:65] op_sel:[1,1,0] op_sel_hi:[1,0,1] neg_lo:[0,1,0] neg_hi:[0,0,0]
s_barrier
ds_write_b64 v4, v[16:17] offset:0
ds_write_b64 v4, v[48:49] offset:264
ds_write_b64 v4, v[14:15] offset:528
ds_write_b64 v4, v[40:41] offset:792
ds_write_b64 v4, v[72:73] offset:1056
ds_write_b64 v4, v[44:45] offset:1320
ds_write_b64 v4, v[28:29] offset:1584
ds_write_b64 v4, v[60:61] offset:1848
ds_write_b64 v4, v[76:77] offset:2112
ds_write_b64 v4, v[46:47] offset:2376
ds_write_b64 v4, v[30:31] offset:2640
ds_write_b64 v4, v[62:63] offset:2904
ds_write_b64 v4, v[22:23] offset:3168
ds_write_b64 v4, v[54:55] offset:3432
ds_write_b64 v4, v[38:39] offset:3696
ds_write_b64 v4, v[70:71] offset:3960
ds_write_b64 v4, v[78:79] offset:4224
ds_write_b64 v4, v[32:33] offset:4488
ds_write_b64 v4, v[24:25] offset:4752
ds_write_b64 v4, v[56:57] offset:5016
ds_write_b64 v4, v[20:21] offset:5280
ds_write_b64 v4, v[52:53] offset:5544
ds_write_b64 v4, v[36:37] offset:5808
ds_write_b64 v4, v[68:69] offset:6072
ds_write_b64 v4, v[18:19] offset:6336
ds_write_b64 v4, v[50:51] offset:6600
ds_write_b64 v4, v[34:35] offset:6864
ds_write_b64 v4, v[66:67] offset:7128
ds_write_b64 v4, v[26:27] offset:7392
ds_write_b64 v4, v[58:59] offset:7656
ds_write_b64 v4, v[42:43] offset:7920
ds_write_b64 v4, v[74:75] offset:8184
s_waitcnt lgkmcnt(0)
ds_read_b64 v[16:17], v5 offset:0
ds_read_b64 v[48:49], v5 offset:128
ds_read_b64 v[18:19], v5 offset:8
ds_read_b64 v[50:51], v5 offset:136
ds_read_b64 v[20:21], v5 offset:16
ds_read_b64 v[52:53], v5 offset:144
ds_read_b64 v[22:23], v5 offset:24
ds_read_b64 v[54:55], v5 offset:152
ds_read_b64 v[24:25], v5 offset:32
ds_read_b64 v[56:57], v5 offset:160
ds_read_b64 v[26:27], v5 offset:40
ds_read_b64 v[58:59], v5 offset:168
ds_read_b64 v[28:29], v5 offset:48
ds_read_b64 v[60:61], v5 offset:176
ds_read_b64 v[30:31], v5 offset:56
ds_read_b64 v[62:63], v5 offset:184
ds_read_b64 v[32:33], v5 offset:64
ds_read_b64 v[64:65], v5 offset:192
ds_read_b64 v[34:35], v5 offset:72
ds_read_b64 v[66:67], v5 offset:200
ds_read_b64 v[36:37], v5 offset:80
ds_read_b64 v[68:69], v5 offset:208
ds_read_b64 v[38:39], v5 offset:88
ds_read_b64 v[70:71], v5 offset:216
ds_read_b64 v[40:41], v5 offset:96
ds_read_b64 v[72:73], v5 offset:224
ds_read_b64 v[42:43], v5 offset:104
ds_read_b64 v[74:75], v5 offset:232
ds_read_b64 v[44:45], v5 offset:112
ds_read_b64 v[76:77], v5 offset:240
ds_read_b64 v[46:47], v5 offset:120
ds_read_b64 v[78:79], v5 offset:248
s_waitcnt lgkmcnt(0)
v_pk_add_f32 v[14:15], v[16:17], v[48:49] neg_lo:[0,1] neg_hi:[0,1]
v_pk_add_f32 v[16:17], v[16:17], v[48:49]
v_pk_add_f32 v[48:49], v[18:19], v[50:51] neg_lo:[0,1] neg_hi:[0,1]
v_pk_add_f32 v[18:19], v[18:19], v[50:51]
v_pk_mul_f32 v[50:51], v[48:49], s[50:51] op_sel:[0,0] op_sel_hi:[0,1] neg_lo:[0,0] neg_hi:[0,1]
v_pk_fma_f32 v[50:51], v[48:49], s[50:51], v[50:51] op_sel:[1,1,0] op_sel_hi:[1,0,1] neg_lo:[0,0,0] neg_hi:[0,0,0]
v_pk_add_f32 v[48:49], v[20:21], v[52:53] neg_lo:[0,1] neg_hi:[0,1]
v_pk_add_f32 v[20:21], v[20:21], v[52:53]
v_pk_mul_f32 v[52:53], v[48:49], s[54:55] op_sel:[0,0] op_sel_hi:[0,1] neg_lo:[0,0] neg_hi:[0,1]
v_pk_fma_f32 v[52:53], v[48:49], s[54:55], v[52:53] op_sel:[1,1,0] op_sel_hi:[1,0,1] neg_lo:[0,0,0] neg_hi:[0,0,0]
v_pk_add_f32 v[48:49], v[22:23], v[54:55] neg_lo:[0,1] neg_hi:[0,1]
v_pk_add_f32 v[22:23], v[22:23], v[54:55]
v_pk_mul_f32 v[54:55], v[48:49], s[58:59] op_sel:[0,0] op_sel_hi:[0,1] neg_lo:[0,0] neg_hi:[0,1]
v_pk_fma_f32 v[54:55], v[48:49], s[58:59], v[54:55] op_sel:[1,1,0] op_sel_hi:[1,0,1] neg_lo:[0,0,0] neg_hi:[0,0,0]
v_pk_add_f32 v[48:49], v[24:25], v[56:57] neg_lo:[0,1] neg_hi:[0,1]
v_pk_add_f32 v[24:25], v[24:25], v[56:57]
v_pk_mul_f32 v[56:57], v[48:49], s[62:63] op_sel:[0,0] op_sel_hi:[0,1] neg_lo:[0,0] neg_hi:[0,1]
v_pk_fma_f32 v[56:57], v[48:49], s[62:63], v[56:57] op_sel:[1,1,0] op_sel_hi:[1,0,1] neg_lo:[0,0,0] neg_hi:[0,0,0]
v_pk_add_f32 v[48:49], v[26:27], v[58:59] neg_lo:[0,1] neg_hi:[0,1]
v_pk_add_f32 v[26:27], v[26:27], v[58:59]
v_pk_mul_f32 v[58:59], v[48:49], s[58:59] op_sel:[0,1] op_sel_hi:[0,0] neg_lo:[0,0] neg_hi:[0,1]
v_pk_fma_f32 v[58:59], v[48:49], s[58:59], v[58:59] op_sel:[1,0,0] op_sel_hi:[1,1,1] neg_lo:[0,0,0] neg_hi:[0,0,0]
v_pk_add_f32 v[48:49], v[28:29], v[60:61] neg_lo:[0,1] neg_hi:[0,1]
v_pk_add_f32 v[28:29], v[28:29], v[60:61]
v_pk_mul_f32 v[60:61], v[48:49], s[54:55] op_sel:[0,1] op_sel_hi:[0,0] neg_lo:[0,0] neg_hi:[0,1]
v_pk_fma_f32 v[60:61], v[48:49], s[54:55], v[60:61] op_sel:[1,0,0] op_sel_hi:[1,1,1] neg_lo:[0,0,0] neg_hi:[0,0,0]
v_pk_add_f32 v[48:49], v[30:31], v[62:63] neg_lo:[0,1] neg_hi:[0,1]
v_pk_add_f32 v[30:31], v[30:31], v[62:63]
v_pk_mul_f32 v[62:63], v[48:49], s[50:51] op_sel:[0,1] op_sel_hi:[0,0] neg_lo:[0,0] neg_hi:[0,1]
v_pk_fma_f32 v[62:63], v[48:49], s[50:51], v[62:63] op_sel:[1,0,0] op_sel_hi:[1,1,1] neg_lo:[0,0,0] neg_hi:[0,0,0]
v_pk_add_f32 v[48:49], v[32:33], v[64:65] op_sel:[1,1] op_sel_hi:[0,0] neg_lo:[0,1] neg_hi:[1,0]
v_pk_add_f32 v[32:33], v[32:33], v[64:65]
v_pk_add_f32 v[64:65], v[34:35], v[66:67] neg_lo:[0,1] neg_hi:[0,1]
v_pk_add_f32 v[34:35], v[34:35], v[66:67]
v_pk_mul_f32 v[66:67], v[64:65], s[50:51] op_sel:[0,1] op_sel_hi:[0,0] neg_lo:[0,1] neg_hi:[0,1]
v_pk_fma_f32 v[66:67], v[64:65], s[50:51], v[66:67] op_sel:[1,0,0] op_sel_hi:[1,1,1] neg_lo:[0,0,0] neg_hi:[0,1,0]
v_pk_add_f32 v[64:65], v[36:37], v[68:69] neg_lo:[0,1] neg_hi:[0,1]
v_pk_add_f32 v[36:37], v[36:37], v[68:69]
v_pk_mul_f32 v[68:69], v[64:65], s[54:55] op_sel:[0,1] op_sel_hi:[0,0] neg_lo:[0,1] neg_hi:[0,1]
v_pk_fma_f32 v[68:69], v[64:65], s[54:55], v[68:69] op_sel:[1,0,0] op_sel_hi:[1,1,1] neg_lo:[0,0,0] neg_hi:[0,1,0]
v_pk_add_f32 v[64:65], v[38:39], v[70:71] neg_lo:[0,1] neg_hi:[0,1]
v_pk_add_f32 v[38:39], v[38:39], v[70:71]
v_pk_mul_f32 v[70:71], v[64:65], s[58:59] op_sel:[0,1] op_sel_hi:[0,0] neg_lo:[0,1] neg_hi:[0,1]
v_pk_fma_f32 v[70:71], v[64:65], s[58:59], v[70:71] op_sel:[1,0,0] op_sel_hi:[1,1,1] neg_lo:[0,0,0] neg_hi:[0,1,0]
v_pk_add_f32 v[64:65], v[40:41], v[72:73] neg_lo:[0,1] neg_hi:[0,1]
v_pk_add_f32 v[40:41], v[40:41], v[72:73]
v_pk_mul_f32 v[72:73], v[64:65], s[62:63] op_sel:[0,0] op_sel_hi:[0,1] neg_lo:[0,1] neg_hi:[0,1]
v_pk_fma_f32 v[72:73], v[64:65], s[62:63], v[72:73] op_sel:[1,1,0] op_sel_hi:[1,0,1] neg_lo:[0,0,0] neg_hi:[0,1,0]
v_pk_add_f32 v[64:65], v[42:43], v[74:75] neg_lo:[0,1] neg_hi:[0,1]
v_pk_add_f32 v[42:43], v[42:43], v[74:75]
v_pk_mul_f32 v[74:75], v[64:65], s[58:59] op_sel:[0,0] op_sel_hi:[0,1] neg_lo:[0,1] neg_hi:[0,1]
v_pk_fma_f32 v[74:75], v[64:65], s[58:59], v[74:75] op_sel:[1,1,0] op_sel_hi:[1,0,1] neg_lo:[0,0,0] neg_hi:[0,1,0]
v_pk_add_f32 v[64:65], v[44:45], v[76:77] neg_lo:[0,1] neg_hi:[0,1]
v_pk_add_f32 v[44:45], v[44:45], v[76:77]
v_pk_mul_f32 v[76:77], v[64:65], s[54:55] op_sel:[0,0] op_sel_hi:[0,1] neg_lo:[0,1] neg_hi:[0,1]
v_pk_fma_f32 v[76:77], v[64:65], s[54:55], v[76:77] op_sel:[1,1,0] op_sel_hi:[1,0,1] neg_lo:[0,0,0] neg_hi:[0,1,0]
v_pk_add_f32 v[64:65], v[46:47], v[78:79] neg_lo:[0,1] neg_hi:[0,1]
v_pk_add_f32 v[46:47], v[46:47], v[78:79]
v_pk_mul_f32 v[78:79], v[64:65], s[50:51] op_sel:[0,0] op_sel_hi:[0,1] neg_lo:[0,1] neg_hi:[0,1]
v_pk_fma_f32 v[78:79], v[64:65], s[50:51], v[78:79] op_sel:[1,1,0] op_sel_hi:[1,0,1] neg_lo:[0,0,0] neg_hi:[0,1,0]
v_pk_add_f32 v[64:65], v[16:17], v[32:33] neg_lo:[0,1] neg_hi:[0,1]
v_pk_add_f32 v[16:17], v[16:17], v[32:33]
v_pk_add_f32 v[32:33], v[18:19], v[34:35] neg_lo:[0,1] neg_hi:[0,1]
v_pk_add_f32 v[18:19], v[18:19], v[34:35]
v_pk_mul_f32 v[34:35], v[32:33], s[54:55] op_sel:[0,0] op_sel_hi:[0,1] neg_lo:[0,0] neg_hi:[0,1]
v_pk_fma_f32 v[34:35], v[32:33], s[54:55], v[34:35] op_sel:[1,1,0] op_sel_hi:[1,0,1] neg_lo:[0,0,0] neg_hi:[0,0,0]
v_pk_add_f32 v[32:33], v[20:21], v[36:37] neg_lo:[0,1] neg_hi:[0,1]
v_pk_add_f32 v[20:21], v[20:21], v[36:37]
v_pk_mul_f32 v[36:37], v[32:33], s[62:63] op_sel:[0,0] op_sel_hi:[0,1] neg_lo:[0,0] neg_hi:[0,1]
v_pk_fma_f32 v[36:37], v[32:33], s[62:63], v[36:37] op_sel:[1,1,0] op_sel_hi:[1,0,1] neg_lo:[0,0,0] neg_hi:[0,0,0]
v_pk_add_f32 v[32:33], v[22:23], v[38:39] neg_lo:[0,1] neg_hi:[0,1]
v_pk_add_f32 v[22:23], v[22:23], v[38:39]
v_pk_mul_f32 v[38:39], v[32:33], s[54:55] op_sel:[0,1] op_sel_hi:[0,0] neg_lo:[0,0] neg_hi:[0,1]
v_pk_fma_f32 v[38:39], v[32:33], s[54:55], v[38:39] op_sel:[1,0,0] op_sel_hi:[1,1,1] neg_lo:[0,0,0] neg_hi:[0,0,0]
v_pk_add_f32 v[32:33], v[24:25], v[40:41] op_sel:[1,1] op_sel_hi:[0,0] neg_lo:[0,1] neg_hi:[1,0]
v_pk_add_f32 v[24:25], v[24:25], v[40:41]
v_pk_add_f32 v[40:41], v[26:27], v[42:43] neg_lo:[0,1] neg_hi:[0,1]
v_pk_add_f32 v[26:27], v[26:27], v[42:43]
v_pk_mul_f32 v[42:43], v[40:41], s[54:55] op_sel:[0,1] op_sel_hi:[0,0] neg_lo:[0,1] neg_hi:[0,1]
v_pk_fma_f32 v[42:43], v[40:41], s[54:55], v[42:43] op_sel:[1,0,0] op_sel_hi:[1,1,1] neg_lo:[0,0,0] neg_hi:[0,1,0]
v_pk_add_f32 v[40:41], v[28:29], v[44:45] neg_lo:[0,1] neg_hi:[0,1]
v_pk_add_f32 v[28:29], v[28:29], v[44:45]
v_pk_mul_f32 v[44:45], v[40:41], s[62:63] op_sel:[0,0] op_sel_hi:[0,1] neg_lo:[0,1] neg_hi:[0,1]
v_pk_fma_f32 v[44:45], v[40:41], s[62:63], v[44:45] op_sel:[1,1,0] op_sel_hi:[1,0,1] neg_lo:[0,0,0] neg_hi:[0,1,0]
v_pk_add_f32 v[40:41], v[30:31], v[46:47] neg_lo:[0,1] neg_hi:[0,1]
v_pk_add_f32 v[30:31], v[30:31], v[46:47]
v_pk_mul_f32 v[46:47], v[40:41], s[54:55] op_sel:[0,0] op_sel_hi:[0,1] neg_lo:[0,1] neg_hi:[0,1]
v_pk_fma_f32 v[46:47], v[40:41], s[54:55], v[46:47] op_sel:[1,1,0] op_sel_hi:[1,0,1] neg_lo:[0,0,0] neg_hi:[0,1,0]
v_pk_add_f32 v[40:41], v[14:15], v[48:49] neg_lo:[0,1] neg_hi:[0,1]
v_pk_add_f32 v[14:15], v[14:15], v[48:49]
v_pk_add_f32 v[48:49], v[50:51], v[66:67] neg_lo:[0,1] neg_hi:[0,1]
v_pk_add_f32 v[50:51], v[50:51], v[66:67]
v_pk_mul_f32 v[66:67], v[48:49], s[54:55] op_sel:[0,0] op_sel_hi:[0,1] neg_lo:[0,0] neg_hi:[0,1]
v_pk_fma_f32 v[66:67], v[48:49], s[54:55], v[66:67] op_sel:[1,1,0] op_sel_hi:[1,0,1] neg_lo:[0,0,0] neg_hi:[0,0,0]
v_pk_add_f32 v[48:49], v[52:53], v[68:69] neg_lo:[0,1] neg_hi:[0,1]
v_pk_add_f32 v[52:53], v[52:53], v[68:69]
v_pk_mul_f32 v[68:69], v[48:49], s[62:63] op_sel:[0,0] op_sel_hi:[0,1] neg_lo:[0,0] neg_hi:[0,1]
v_pk_fma_f32 v[68:69], v[48:49], s[62:63], v[68:69] op_sel:[1,1,0] op_sel_hi:[1,0,1] neg_lo:[0,0,0] neg_hi:[0,0,0]
v_pk_add_f32 v[48:49], v[54:55], v[70:71] neg_lo:[0,1] neg_hi:[0,1]
v_pk_add_f32 v[54:55], v[54:55], v[70:71]
v_pk_mul_f32 v[70:71], v[48:49], s[54:55] op_sel:[0,1] op_sel_hi:[0,0] neg_lo:[0,0] neg_hi:[0,1]
v_pk_fma_f32 v[70:71], v[48:49], s[54:55], v[70:71] op_sel:[1,0,0] op_sel_hi:[1,1,1] neg_lo:[0,0,0] neg_hi:[0,0,0]
v_pk_add_f32 v[48:49], v[56:57], v[72:73] op_sel:[1,1] op_sel_hi:[0,0] neg_lo:[0,1] neg_hi:[1,0]
v_pk_add_f32 v[56:57], v[56:57], v[72:73]
v_pk_add_f32 v[72:73], v[58:59], v[74:75] neg_lo:[0,1] neg_hi:[0,1]
v_pk_add_f32 v[58:59], v[58:59], v[74:75]
v_pk_mul_f32 v[74:75], v[72:73], s[54:55] op_sel:[0,1] op_sel_hi:[0,0] neg_lo:[0,1] neg_hi:[0,1]
v_pk_fma_f32 v[74:75], v[72:73], s[54:55], v[74:75] op_sel:[1,0,0] op_sel_hi:[1,1,1] neg_lo:[0,0,0] neg_hi:[0,1,0]
v_pk_add_f32 v[72:73], v[60:61], v[76:77] neg_lo:[0,1] neg_hi:[0,1]
v_pk_add_f32 v[60:61], v[60:61], v[76:77]
v_pk_mul_f32 v[76:77], v[72:73], s[62:63] op_sel:[0,0] op_sel_hi:[0,1] neg_lo:[0,1] neg_hi:[0,1]
v_pk_fma_f32 v[76:77], v[72:73], s[62:63], v[76:77] op_sel:[1,1,0] op_sel_hi:[1,0,1] neg_lo:[0,0,0] neg_hi:[0,1,0]
v_pk_add_f32 v[72:73], v[62:63], v[78:79] neg_lo:[0,1] neg_hi:[0,1]
v_pk_add_f32 v[62:63], v[62:63], v[78:79]
v_pk_mul_f32 v[78:79], v[72:73], s[54:55] op_sel:[0,0] op_sel_hi:[0,1] neg_lo:[0,1] neg_hi:[0,1]
v_pk_fma_f32 v[78:79], v[72:73], s[54:55], v[78:79] op_sel:[1,1,0] op_sel_hi:[1,0,1] neg_lo:[0,0,0] neg_hi:[0,1,0]
v_pk_add_f32 v[72:73], v[16:17], v[24:25] neg_lo:[0,1] neg_hi:[0,1]
v_pk_add_f32 v[16:17], v[16:17], v[24:25]
v_pk_add_f32 v[24:25], v[18:19], v[26:27] neg_lo:[0,1] neg_hi:[0,1]
v_pk_add_f32 v[18:19], v[18:19], v[26:27]
v_pk_mul_f32 v[26:27], v[24:25], s[62:63] op_sel:[0,0] op_sel_hi:[0,1] neg_lo:[0,0] neg_hi:[0,1]
v_pk_fma_f32 v[26:27], v[24:25], s[62:63], v[26:27] op_sel:[1,1,0] op_sel_hi:[1,0,1] neg_lo:[0,0,0] neg_hi:[0,0,0]
v_pk_add_f32 v[24:25], v[20:21], v[28:29] op_sel:[1,1] op_sel_hi:[0,0] neg_lo:[0,1] neg_hi:[1,0]
v_pk_add_f32 v[20:21], v[20:21], v[28:29]
v_pk_add_f32 v[28:29], v[22:23], v[30:31] neg_lo:[0,1] neg_hi:[0,1]
v_pk_add_f32 v[22:23], v[22:23], v[30:31]
v_pk_mul_f32 v[30:31], v[28:29], s[62:63] op_sel:[0,0] op_sel_hi:[0,1] neg_lo:[0,1] neg_hi:[0,1]
v_pk_fma_f32 v[30:31], v[28:29], s[62:63], v[30:31] op_sel:[1,1,0] op_sel_hi:[1,0,1] neg_lo:[0,0,0] neg_hi:[0,1,0]
v_pk_add_f32 v[28:29], v[64:65], v[32:33] neg_lo:[0,1] neg_hi:[0,1]
v_pk_add_f32 v[64:65], v[64:65], v[32:33]
v_pk_add_f32 v[32:33], v[34:35], v[42:43] neg_lo:[0,1] neg_hi:[0,1]
v_pk_add_f32 v[34:35], v[34:35], v[42:43]
v_pk_mul_f32 v[42:43], v[32:33], s[62:63] op_sel:[0,0] op_sel_hi:[0,1] neg_lo:[0,0] neg_hi:[0,1]
v_pk_fma_f32 v[42:43], v[32:33], s[62:63], v[42:43] op_sel:[1,1,0] op_sel_hi:[1,0,1] neg_lo:[0,0,0] neg_hi:[0,0,0]
v_pk_add_f32 v[32:33], v[36:37], v[44:45] op_sel:[1,1] op_sel_hi:[0,0] neg_lo:[0,1] neg_hi:[1,0]
v_pk_add_f32 v[36:37], v[36:37], v[44:45]
v_pk_add_f32 v[44:45], v[38:39], v[46:47] neg_lo:[0,1] neg_hi:[0,1]
v_pk_add_f32 v[38:39], v[38:39], v[46:47]
v_pk_mul_f32 v[46:47], v[44:45], s[62:63] op_sel:[0,0] op_sel_hi:[0,1] neg_lo:[0,1] neg_hi:[0,1]
v_pk_fma_f32 v[46:47], v[44:45], s[62:63], v[46:47] op_sel:[1,1,0] op_sel_hi:[1,0,1] neg_lo:[0,0,0] neg_hi:[0,1,0]
v_pk_add_f32 v[44:45], v[14:15], v[56:57] neg_lo:[0,1] neg_hi:[0,1]
v_pk_add_f32 v[14:15], v[14:15], v[56:57]
v_pk_add_f32 v[56:57], v[50:51], v[58:59] neg_lo:[0,1] neg_hi:[0,1]
v_pk_add_f32 v[50:51], v[50:51], v[58:59]
v_pk_mul_f32 v[58:59], v[56:57], s[62:63] op_sel:[0,0] op_sel_hi:[0,1] neg_lo:[0,0] neg_hi:[0,1]
v_pk_fma_f32 v[58:59], v[56:57], s[62:63], v[58:59] op_sel:[1,1,0] op_sel_hi:[1,0,1] neg_lo:[0,0,0] neg_hi:[0,0,0]
v_pk_add_f32 v[56:57], v[52:53], v[60:61] op_sel:[1,1] op_sel_hi:[0,0] neg_lo:[0,1] neg_hi:[1,0]
v_pk_add_f32 v[52:53], v[52:53], v[60:61]
v_pk_add_f32 v[60:61], v[54:55], v[62:63] neg_lo:[0,1] neg_hi:[0,1]
v_pk_add_f32 v[54:55], v[54:55], v[62:63]
v_pk_mul_f32 v[62:63], v[60:61], s[62:63] op_sel:[0,0] op_sel_hi:[0,1] neg_lo:[0,1] neg_hi:[0,1]
v_pk_fma_f32 v[62:63], v[60:61], s[62:63], v[62:63] op_sel:[1,1,0] op_sel_hi:[1,0,1] neg_lo:[0,0,0] neg_hi:[0,1,0]
v_pk_add_f32 v[60:61], v[40:41], v[48:49] neg_lo:[0,1] neg_hi:[0,1]
v_pk_add_f32 v[40:41], v[40:41], v[48:49]
v_pk_add_f32 v[48:49], v[66:67], v[74:75] neg_lo:[0,1] neg_hi:[0,1]
v_pk_add_f32 v[66:67], v[66:67], v[74:75]
v_pk_mul_f32 v[74:75], v[48:49], s[62:63] op_sel:[0,0] op_sel_hi:[0,1] neg_lo:[0,0] neg_hi:[0,1]
v_pk_fma_f32 v[74:75], v[48:49], s[62:63], v[74:75] op_sel:[1,1,0] op_sel_hi:[1,0,1] neg_lo:[0,0,0] neg_hi:[0,0,0]
v_pk_add_f32 v[48:49], v[68:69], v[76:77] op_sel:[1,1] op_sel_hi:[0,0] neg_lo:[0,1] neg_hi:[1,0]
v_pk_add_f32 v[68:69], v[68:69], v[76:77]
v_pk_add_f32 v[76:77], v[70:71], v[78:79] neg_lo:[0,1] neg_hi:[0,1]
v_pk_add_f32 v[70:71], v[70:71], v[78:79]
v_pk_mul_f32 v[78:79], v[76:77], s[62:63] op_sel:[0,0] op_sel_hi:[0,1] neg_lo:[0,1] neg_hi:[0,1]
v_pk_fma_f32 v[78:79], v[76:77], s[62:63], v[78:79] op_sel:[1,1,0] op_sel_hi:[1,0,1] neg_lo:[0,0,0] neg_hi:[0,1,0]
v_pk_add_f32 v[76:77], v[16:17], v[20:21] neg_lo:[0,1] neg_hi:[0,1]
v_pk_add_f32 v[16:17], v[16:17], v[20:21]
v_pk_add_f32 v[20:21], v[18:19], v[22:23] op_sel:[1,1] op_sel_hi:[0,0] neg_lo:[0,1] neg_hi:[1,0]
v_pk_add_f32 v[18:19], v[18:19], v[22:23]
v_pk_add_f32 v[22:23], v[72:73], v[24:25] neg_lo:[0,1] neg_hi:[0,1]
v_pk_add_f32 v[72:73], v[72:73], v[24:25]
v_pk_add_f32 v[24:25], v[26:27], v[30:31] op_sel:[1,1] op_sel_hi:[0,0] neg_lo:[0,1] neg_hi:[1,0]
v_pk_add_f32 v[26:27], v[26:27], v[30:31]
v_pk_add_f32 v[30:31], v[64:65], v[36:37] neg_lo:[0,1] neg_hi:[0,1]
v_pk_add_f32 v[64:65], v[64:65], v[36:37]
v_pk_add_f32 v[36:37], v[34:35], v[38:39] op_sel:[1,1] op_sel_hi:[0,0] neg_lo:[0,1] neg_hi:[1,0]
v_pk_add_f32 v[34:35], v[34:35], v[38:39]
v_pk_add_f32 v[38:39], v[28:29], v[32:33] neg_lo:[0,1] neg_hi:[0,1]
v_pk_add_f32 v[28:29], v[28:29], v[32:33]
v_pk_add_f32 v[32:33], v[42:43], v[46:47] op_sel:[1,1] op_sel_hi:[0,0] neg_lo:[0,1] neg_hi:[1,0]
v_pk_add_f32 v[42:43], v[42:43], v[46:47]
v_pk_add_f32 v[46:47], v[14:15], v[52:53] neg_lo:[0,1] neg_hi:[0,1]
v_pk_add_f32 v[14:15], v[14:15], v[52:53]
v_pk_add_f32 v[52:53], v[50:51], v[54:55] op_sel:[1,1] op_sel_hi:[0,0] neg_lo:[0,1] neg_hi:[1,0]
v_pk_add_f32 v[50:51], v[50:51], v[54:55]
v_pk_add_f32 v[54:55], v[44:45], v[56:57] neg_lo:[0,1] neg_hi:[0,1]
v_pk_add_f32 v[44:45], v[44:45], v[56:57]
v_pk_add_f32 v[56:57], v[58:59], v[62:63] op_sel:[1,1] op_sel_hi:[0,0] neg_lo:[0,1] neg_hi:[1,0]
v_pk_add_f32 v[58:59], v[58:59], v[62:63]
v_pk_add_f32 v[62:63], v[40:41], v[68:69] neg_lo:[0,1] neg_hi:[0,1]
v_pk_add_f32 v[40:41], v[40:41], v[68:69]
v_pk_add_f32 v[68:69], v[66:67], v[70:71] op_sel:[1,1] op_sel_hi:[0,0] neg_lo:[0,1] neg_hi:[1,0]
v_pk_add_f32 v[66:67], v[66:67], v[70:71]
v_pk_add_f32 v[70:71], v[60:61], v[48:49] neg_lo:[0,1] neg_hi:[0,1]
v_pk_add_f32 v[60:61], v[60:61], v[48:49]
v_pk_add_f32 v[48:49], v[74:75], v[78:79] op_sel:[1,1] op_sel_hi:[0,0] neg_lo:[0,1] neg_hi:[1,0]
v_pk_add_f32 v[74:75], v[74:75], v[78:79]
v_pk_add_f32 v[78:79], v[16:17], v[18:19] neg_lo:[0,1] neg_hi:[0,1]
v_pk_add_f32 v[16:17], v[16:17], v[18:19]
v_pk_add_f32 v[18:19], v[76:77], v[20:21] neg_lo:[0,1] neg_hi:[0,1]
v_pk_add_f32 v[76:77], v[76:77], v[20:21]
v_pk_add_f32 v[20:21], v[72:73], v[26:27] neg_lo:[0,1] neg_hi:[0,1]
v_pk_add_f32 v[72:73], v[72:73], v[26:27]
v_pk_add_f32 v[26:27], v[22:23], v[24:25] neg_lo:[0,1] neg_hi:[0,1]
v_pk_add_f32 v[22:23], v[22:23], v[24:25]
v_pk_add_f32 v[24:25], v[64:65], v[34:35] neg_lo:[0,1] neg_hi:[0,1]
v_pk_add_f32 v[64:65], v[64:65], v[34:35]
v_pk_add_f32 v[34:35], v[30:31], v[36:37] neg_lo:[0,1] neg_hi:[0,1]
v_pk_add_f32 v[30:31], v[30:31], v[36:37]
v_pk_add_f32 v[36:37], v[28:29], v[42:43] neg_lo:[0,1] neg_hi:[0,1]
v_pk_add_f32 v[28:29], v[28:29], v[42:43]
v_pk_add_f32 v[42:43], v[38:39], v[32:33] neg_lo:[0,1] neg_hi:[0,1]
v_pk_add_f32 v[38:39], v[38:39], v[32:33]
v_pk_add_f32 v[32:33], v[14:15], v[50:51] neg_lo:[0,1] neg_hi:[0,1]
v_pk_add_f32 v[14:15], v[14:15], v[50:51]
v_pk_add_f32 v[50:51], v[46:47], v[52:53] neg_lo:[0,1] neg_hi:[0,1]
v_pk_add_f32 v[46:47], v[46:47], v[52:53]
v_pk_add_f32 v[52:53], v[44:45], v[58:59] neg_lo:[0,1] neg_hi:[0,1]
v_pk_add_f32 v[44:45], v[44:45], v[58:59]
v_pk_add_f32 v[58:59], v[54:55], v[56:57] neg_lo:[0,1] neg_hi:[0,1]
v_pk_add_f32 v[54:55], v[54:55], v[56:57]
v_pk_add_f32 v[56:57], v[40:41], v[66:67] neg_lo:[0,1] neg_hi:[0,1]
v_pk_add_f32 v[40:41], v[40:41], v[66:67]
v_pk_add_f32 v[66:67], v[62:63], v[68:69] neg_lo:[0,1] neg_hi:[0,1]
v_pk_add_f32 v[62:63], v[62:63], v[68:69]
v_pk_add_f32 v[68:69], v[60:61], v[74:75] neg_lo:[0,1] neg_hi:[0,1]
v_pk_add_f32 v[60:61], v[60:61], v[74:75]
v_pk_add_f32 v[74:75], v[70:71], v[48:49] neg_lo:[0,1] neg_hi:[0,1]
v_pk_add_f32 v[70:71], v[70:71], v[48:49]
ds_write_b64 v4, v[16:17] offset:0
ds_write_b64 v4, v[14:15] offset:256
ds_write_b64 v4, v[64:65] offset:512
ds_write_b64 v4, v[40:41] offset:768
ds_write_b64 v4, v[72:73] offset:1024
ds_write_b64 v4, v[44:45] offset:1280
ds_write_b64 v4, v[28:29] offset:1536
ds_write_b64 v4, v[60:61] offset:1792
ds_write_b64 v4, v[76:77] offset:2048
ds_write_b64 v4, v[46:47] offset:2304
ds_write_b64 v4, v[30:31] offset:2560
ds_write_b64 v4, v[62:63] offset:2816
ds_write_b64 v4, v[22:23] offset:3072
ds_write_b64 v4, v[54:55] offset:3328
ds_write_b64 v4, v[38:39] offset:3584
ds_write_b64 v4, v[70:71] offset:3840
ds_write_b64 v4, v[78:79] offset:4096
ds_write_b64 v4, v[32:33] offset:4352
ds_write_b64 v4, v[24:25] offset:4608
ds_write_b64 v4, v[56:57] offset:4864
ds_write_b64 v4, v[20:21] offset:5120
ds_write_b64 v4, v[52:53] offset:5376
ds_write_b64 v4, v[36:37] offset:5632
ds_write_b64 v4, v[68:69] offset:5888
ds_write_b64 v4, v[18:19] offset:6144
ds_write_b64 v4, v[50:51] offset:6400
ds_write_b64 v4, v[34:35] offset:6656
ds_write_b64 v4, v[66:67] offset:6912
ds_write_b64 v4, v[26:27] offset:7168
ds_write_b64 v4, v[58:59] offset:7424
ds_write_b64 v4, v[42:43] offset:7680
ds_write_b64 v4, v[74:75] offset:7936
ds_write_b64 v4, v[16:17] offset:8192
s_waitcnt lgkmcnt(0)
s_barrier
s_lshl_b32 s13, s93, 7
s_add_u32 s13, s13, 96468992
ds_read_b64 v[16:17], v6 offset:0
ds_read_b64 v[18:19], v7 offset:4096
ds_read_b64 v[20:21], v6 offset:256
ds_read_b64 v[22:23], v7 offset:3840
ds_read_b64 v[24:25], v6 offset:512
ds_read_b64 v[26:27], v7 offset:3584
ds_read_b64 v[28:29], v6 offset:768
ds_read_b64 v[30:31], v7 offset:3328
ds_read_b64 v[32:33], v6 offset:1024
ds_read_b64 v[34:35], v7 offset:3072
ds_read_b64 v[36:37], v6 offset:1280
ds_read_b64 v[38:39], v7 offset:2816
s_waitcnt lgkmcnt(10)
v_pk_add_f32 v[208:209], v[16:17], v[18:19] neg_hi:[0,1]
v_pk_add_f32 v[210:211], v[16:17], v[18:19] op_sel:[1,1] op_sel_hi:[0,0] neg_hi:[1,0]
ds_read_b64 v[40:41], v6 offset:1536
ds_read_b64 v[42:43], v7 offset:2560
buffer_store_dwordx4 v[208:211], v8, s[84:87], s13 offen sc1
s_add_u32 s13, s13, 524288
s_waitcnt lgkmcnt(10)
v_pk_add_f32 v[212:213], v[20:21], v[22:23] neg_hi:[0,1]
v_pk_add_f32 v[214:215], v[20:21], v[22:23] op_sel:[1,1] op_sel_hi:[0,0] neg_hi:[1,0]
ds_read_b64 v[44:45], v6 offset:1792
ds_read_b64 v[46:47], v7 offset:2304
buffer_store_dwordx4 v[212:215], v8, s[84:87], s13 offen sc1
s_add_u32 s13, s13, 524288
s_waitcnt lgkmcnt(10)
v_pk_add_f32 v[216:217], v[24:25], v[26:27] neg_hi:[0,1]
v_pk_add_f32 v[218:219], v[24:25], v[26:27] op_sel:[1,1] op_sel_hi:[0,0] neg_hi:[1,0]
ds_read_b64 v[16:17], v6 offset:2048
ds_read_b64 v[18:19], v7 offset:2048
buffer_store_dwordx4 v[216:219], v8, s[84:87], s13 offen sc1
s_add_u32 s13, s13, 524288
s_waitcnt lgkmcnt(10)
v_pk_add_f32 v[220:221], v[28:29], v[30:31] neg_hi:[0,1]
v_pk_add_f32 v[222:223], v[28:29], v[30:31] op_sel:[1,1] op_sel_hi:[0,0] neg_hi:[1,0]
ds_read_b64 v[20:21], v6 offset:2304
ds_read_b64 v[22:23], v7 offset:1792
buffer_store_dwordx4 v[220:223], v8, s[84:87], s13 offen sc1
s_add_u32 s13, s13, 524288
s_waitcnt lgkmcnt(10)
v_pk_add_f32 v[224:225], v[32:33], v[34:35] neg_hi:[0,1]
v_pk_add_f32 v[226:227], v[32:33], v[34:35] op_sel:[1,1] op_sel_hi:[0,0] neg_hi:[1,0]
ds_read_b64 v[24:25], v6 offset:2560
ds_read_b64 v[26:27], v7 offset:1536
buffer_store_dwordx4 v[224:227], v8, s[84:87], s13 offen sc1
s_add_u32 s13, s13, 524288
s_waitcnt lgkmcnt(10)
v_pk_add_f32 v[228:229], v[36:37], v[38:39] neg_hi:[0,1]
v_pk_add_f32 v[230:231], v[36:37], v[38:39] op_sel:[1,1] op_sel_hi:[0,0] neg_hi:[1,0]
ds_read_b64 v[28:29], v6 offset:2816
ds_read_b64 v[30:31], v7 offset:1280
buffer_store_dwordx4 v[228:231], v8, s[84:87], s13 offen sc1
s_add_u32 s13, s13, 524288
s_waitcnt lgkmcnt(10)
v_pk_add_f32 v[232:233], v[40:41], v[42:43] neg_hi:[0,1]
v_pk_add_f32 v[234:235], v[40:41], v[42:43] op_sel:[1,1] op_sel_hi:[0,0] neg_hi:[1,0]
ds_read_b64 v[32:33], v6 offset:3072
ds_read_b64 v[34:35], v7 offset:1024
buffer_store_dwordx4 v[232:235], v8, s[84:87], s13 offen sc1
s_add_u32 s13, s13, 524288
s_waitcnt lgkmcnt(10)
v_pk_add_f32 v[236:237], v[44:45], v[46:47] neg_hi:[0,1]
v_pk_add_f32 v[238:239], v[44:45], v[46:47] op_sel:[1,1] op_sel_hi:[0,0] neg_hi:[1,0]
ds_read_b64 v[36:37], v6 offset:3328
ds_read_b64 v[38:39], v7 offset:768
buffer_store_dwordx4 v[236:239], v8, s[84:87], s13 offen sc1
s_add_u32 s13, s13, 524288
s_waitcnt lgkmcnt(10)
v_pk_add_f32 v[208:209], v[16:17], v[18:19] neg_hi:[0,1]
v_pk_add_f32 v[210:211], v[16:17], v[18:19] op_sel:[1,1] op_sel_hi:[0,0] neg_hi:[1,0]
ds_read_b64 v[40:41], v6 offset:3584
ds_read_b64 v[42:43], v7 offset:512
buffer_store_dwordx4 v[208:211], v8, s[84:87], s13 offen sc1
s_add_u32 s13, s13, 524288
s_waitcnt lgkmcnt(10)
v_pk_add_f32 v[212:213], v[20:21], v[22:23] neg_hi:[0,1]
v_pk_add_f32 v[214:215], v[20:21], v[22:23] op_sel:[1,1] op_sel_hi:[0,0] neg_hi:[1,0]
ds_read_b64 v[44:45], v6 offset:3840
ds_read_b64 v[46:47], v7 offset:256
buffer_store_dwordx4 v[212:215], v8, s[84:87], s13 offen sc1
s_add_u32 s13, s13, 524288
s_waitcnt lgkmcnt(10)
v_pk_add_f32 v[216:217], v[24:25], v[26:27] neg_hi:[0,1]
v_pk_add_f32 v[218:219], v[24:25], v[26:27] op_sel:[1,1] op_sel_hi:[0,0] neg_hi:[1,0]
ds_read_b64 v[16:17], v6 offset:4096
ds_read_b64 v[18:19], v7 offset:0
buffer_store_dwordx4 v[216:219], v8, s[84:87], s13 offen sc1
s_add_u32 s13, s13, 524288
s_waitcnt lgkmcnt(10)
v_pk_add_f32 v[220:221], v[28:29], v[30:31] neg_hi:[0,1]
v_pk_add_f32 v[222:223], v[28:29], v[30:31] op_sel:[1,1] op_sel_hi:[0,0] neg_hi:[1,0]
buffer_store_dwordx4 v[220:223], v8, s[84:87], s13 offen sc1
s_add_u32 s13, s13, 524288
s_waitcnt lgkmcnt(8)
v_pk_add_f32 v[224:225], v[32:33], v[34:35] neg_hi:[0,1]
v_pk_add_f32 v[226:227], v[32:33], v[34:35] op_sel:[1,1] op_sel_hi:[0,0] neg_hi:[1,0]
buffer_store_dwordx4 v[224:227], v8, s[84:87], s13 offen sc1
s_add_u32 s13, s13, 524288
s_waitcnt lgkmcnt(6)
v_pk_add_f32 v[228:229], v[36:37], v[38:39] neg_hi:[0,1]
v_pk_add_f32 v[230:231], v[36:37], v[38:39] op_sel:[1,1] op_sel_hi:[0,0] neg_hi:[1,0]
buffer_store_dwordx4 v[228:231], v8, s[84:87], s13 offen sc1
s_add_u32 s13, s13, 524288
s_waitcnt lgkmcnt(4)
v_pk_add_f32 v[232:233], v[40:41], v[42:43] neg_hi:[0,1]
v_pk_add_f32 v[234:235], v[40:41], v[42:43] op_sel:[1,1] op_sel_hi:[0,0] neg_hi:[1,0]
buffer_store_dwordx4 v[232:235], v8, s[84:87], s13 offen sc1
s_add_u32 s13, s13, 524288
s_waitcnt lgkmcnt(2)
v_pk_add_f32 v[236:237], v[44:45], v[46:47] neg_hi:[0,1]
v_pk_add_f32 v[238:239], v[44:45], v[46:47] op_sel:[1,1] op_sel_hi:[0,0] neg_hi:[1,0]
buffer_store_dwordx4 v[236:239], v8, s[84:87], s13 offen sc1
s_add_u32 s13, s13, 524288
s_waitcnt lgkmcnt(0)
v_pk_add_f32 v[208:209], v[16:17], v[18:19] neg_hi:[0,1]
v_pk_add_f32 v[210:211], v[16:17], v[18:19] op_sel:[1,1] op_sel_hi:[0,0] neg_hi:[1,0]
v_cmp_eq_u32 vcc, 0, v9
s_nop 1
v_cndmask_b32 v13, -16, v8, vcc
buffer_store_dwordx4 v[208:211], v13, s[84:87], s13 offen sc1
s_add_u32 s13, s13, 524288
s_mov_b32 s93, s21
s_cmp_lt_u32 s93, 128
s_cbranch_scc1 mega_kernel_f1_l
mega_kernel_f1_e:
v_and_b32 v3, 15, v0
v_lshlrev_b32 v3, 4, v3
s_branch mega_kernel_syd
mega_kernel_sydw:
s_sleep 4
mega_kernel_syd:
buffer_load_dword v2, v3, s[72:75], 0 offen sc1
s_waitcnt vmcnt(0)
mega_kernel_sydp:
s_cmp_eq_u32 s95, 1
s_cbranch_scc0 mega_kernel_sydf
v_readlane_b32 s76, v2, 14
s_mov_b32 s98, 0
s_cmp_eq_u32 s76, 32
s_cbranch_scc0 mega_kernel_sydw
s_branch mega_kernel_sydd
mega_kernel_sydf:
s_mov_b32 s77, 0
s_mov_b32 s78, 0
v_readlane_b32 s76, v2, 0
s_add_u32 s77, s77, s76
s_xor_b32 s76, s76, 32
s_or_b32 s78, s78, s76
v_readlane_b32 s76, v2, 1
s_add_u32 s77, s77, s76
s_xor_b32 s76, s76, 32
s_or_b32 s78, s78, s76
v_readlane_b32 s76, v2, 2
s_add_u32 s77, s77, s76
s_xor_b32 s76, s76, 32
s_or_b32 s78, s78, s76
v_readlane_b32 s76, v2, 3
s_add_u32 s77, s77, s76
s_xor_b32 s76, s76, 32
s_or_b32 s78, s78, s76
v_readlane_b32 s76, v2, 4
s_add_u32 s77, s77, s76
s_xor_b32 s76, s76, 32
s_or_b32 s78, s78, s76
v_readlane_b32 s76, v2, 5
s_add_u32 s77, s77, s76
s_xor_b32 s76, s76, 32
s_or_b32 s78, s78, s76
v_readlane_b32 s76, v2, 6
s_add_u32 s77, s77, s76
s_xor_b32 s76, s76, 32
s_or_b32 s78, s78, s76
v_readlane_b32 s76, v2, 7
s_add_u32 s77, s77, s76
s_xor_b32 s76, s76, 32
s_or_b32 s78, s78, s76
s_cmp_eq_u32 s77, 256
s_cbranch_scc0 mega_kernel_sydw
v_mov_b32 v252, v2
s_cmp_eq_u32 s78, 0
s_cbranch_scc0 mega_kernel_slowent
v_readlane_b32 s76, v2, 10
v_readlane_b32 s77, v2, 8
s_cmp_eq_u32 s76, 32
s_cbranch_scc0 mega_kernel_sydw
s_cmp_gt_u32 s77, 16
s_cselect_b32 s98, 1, 0
mega_kernel_sydd:
s_waitcnt vmcnt(0)
s_barrier
v_mov_b32 v1, 0
v_mov_b32 v2, 1
s_mov_b32 s82, 69259264
v_cmp_eq_u32 vcc, 0, v0
s_and_saveexec_b64 s[80:81], vcc
s_cbranch_execz mega_kernel_sg0
buffer_atomic_add v2, v1, s[84:87], s82 offen sc1
mega_kernel_sg0:
s_mov_b64 exec, s[80:81]
s_add_u32 s38, s40, 129
s_mov_b32 s39, 32
s_mov_b32 s37, 129
s_cmp_lt_u32 s38, 129
s_cbranch_scc1 mega_kernel_f2s
s_branch mega_kernel_f2e
mega_kernel_rk:
s_load_dwordx2 s[4:5], s[0:1], 24
s_load_dwordx2 s[8:9], s[0:1], 0
v_lshrrev_b32 v2, 6, v0
v_and_b32 v1, 63, v0
v_readfirstlane_b32 s41, v2
v_lshlrev_b32 v5, 4, v1
s_waitcnt lgkmcnt(0)
s_mov_b32 s6, 8388608
s_mov_b32 s7, 0x00020000
s_mov_b32 s10, 4194304
s_mov_b32 s11, 0x00020000
s_lshl_b32 s43, s40, 8
s_lshl_b32 s44, s41, 6
s_add_u32 s48, s43, s44
s_and_b32 s43, s48, 0x7ff
v_add_u32 v19, s43, v1
v_lshlrev_b32 v19, 7, v19
s_mov_b32 s43, 0
buffer_load_dword v250, v19, s[8:11], s43 offen
s_nop 0
v_lshrrev_b32 v2, 3, v1
s_lshl_b32 s43, s41, 3
v_add_u32 v2, s43, v2
v_bfe_u32 v3, v2, 1, 3
v_and_b32 v4, 7, v1
v_xor_b32 v3, v3, v4
v_lshlrev_b32 v6, 11, v2
v_lshl_add_u32 v6, v3, 4, v6
s_lshl_b32 s46, s41, 10
v_and_b32 v2, 15, v1
v_bfe_u32 v3, v2, 1, 3
v_lshrrev_b32 v4, 4, v1
v_xor_b32 v3, v3, v4
v_lshlrev_b32 v8, 7, v2
v_lshl_add_u32 v8, v3, 4, v8
v_xor_b32 v9, 64, v8
v_add_u32 v10, 0x10000, v8
v_add_u32 v11, 0x10000, v9
v_mov_b32 v7, v5
s_lshl_b32 s47, s40, 2
s_add_u32 s47, s47, s41
s_mov_b32 s42, 0
s_mov_b32 s50, 0
s_add_u32 m0, s46, 0
s_nop 0
buffer_load_dwordx4 v6, s[8:11], s50 offen offset:0 lds
s_add_u32 m0, s46, 3968
s_nop 0
buffer_load_dwordx4 v6, s[8:11], s50 offen offset:128 lds
s_add_u32 m0, s46, 7936
s_nop 0
buffer_load_dwordx4 v6, s[8:11], s50 offen offset:256 lds
s_add_u32 m0, s46, 11904
s_nop 0
buffer_load_dwordx4 v6, s[8:11], s50 offen offset:384 lds
s_add_u32 m0, s46, 15872
s_nop 0
buffer_load_dwordx4 v6, s[8:11], s50 offen offset:512 lds
s_add_u32 m0, s46, 19840
s_nop 0
buffer_load_dwordx4 v6, s[8:11], s50 offen offset:640 lds
s_add_u32 m0, s46, 23808
s_nop 0
buffer_load_dwordx4 v6, s[8:11], s50 offen offset:768 lds
s_add_u32 m0, s46, 27776
s_nop 0
buffer_load_dwordx4 v6, s[8:11], s50 offen offset:896 lds
s_add_u32 m0, s46, 31744
s_nop 0
buffer_load_dwordx4 v6, s[8:11], s50 offen offset:1024 lds
s_add_u32 m0, s46, 35712
s_nop 0
buffer_load_dwordx4 v6, s[8:11], s50 offen offset:1152 lds
s_add_u32 m0, s46, 39680
s_nop 0
buffer_load_dwordx4 v6, s[8:11], s50 offen offset:1280 lds
s_add_u32 m0, s46, 43648
s_nop 0
buffer_load_dwordx4 v6, s[8:11], s50 offen offset:1408 lds
s_add_u32 m0, s46, 47616
s_nop 0
buffer_load_dwordx4 v6, s[8:11], s50 offen offset:1536 lds
s_add_u32 m0, s46, 51584
s_nop 0
buffer_load_dwordx4 v6, s[8:11], s50 offen offset:1664 lds
s_add_u32 m0, s46, 55552
s_nop 0
buffer_load_dwordx4 v6, s[8:11], s50 offen offset:1792 lds
s_add_u32 m0, s46, 59520
s_nop 0
buffer_load_dwordx4 v6, s[8:11], s50 offen offset:1920 lds
v_lshrrev_b32 v2, 2, v1
v_and_b32 v3, 3, v1
v_lshlrev_b32 v16, 13, v2
v_lshl_add_u32 v16, v3, 4, v16
v_add_u32 v16, s48, v16
s_mul_i32 s45, s41, 24576
s_add_u32 s45, s45, 65536
v_bfe_u32 v17, v1, 2, 2
v_lshrrev_b32 v18, 4, v1
v_lshl_add_u32 v17, v18, 3, v17
v_lshlrev_b32 v17, 6, v17
v_lshl_add_u32 v17, v3, 4, v17
v_add_u32 v17, s45, v17
s_and_b32 s43, s40, 3
s_lshl_b32 s43, s43, 2
s_add_u32 s43, s43, s41
s_lshl_b32 s43, s43, 3
v_and_b32 v12, 7, v1
v_add_u32 v12, s43, v12
s_lshr_b32 s43, s40, 2
s_lshl_b32 s43, s43, 10
s_add_u32 s44, s43, 896
s_add_u32 s43, s43, 384
s_cmp_ge_u32 s40, 28
s_cselect_b32 s44, s44, s43
v_mov_b32 v13, s43
v_mov_b32 v14, s44
v_cmp_gt_u32 vcc, 32, v1
s_nop 1
v_cndmask_b32 v13, v14, v13, vcc
v_lshl_add_u32 v12, v12, 13, v13
s_mov_b32 s44, 0
buffer_load_dword v250, v12, s[4:7], s44 offen
s_add_u32 m0, s45, 0
s_mov_b32 s44, 0
buffer_load_dwordx4 v16, s[4:7], s44 offen lds
s_add_u32 m0, s45, 1024
s_mov_b32 s44, 131072
buffer_load_dwordx4 v16, s[4:7], s44 offen lds
s_add_u32 m0, s45, 2048
s_mov_b32 s44, 262144
buffer_load_dwordx4 v16, s[4:7], s44 offen lds
s_add_u32 m0, s45, 3072
s_mov_b32 s44, 393216
buffer_load_dwordx4 v16, s[4:7], s44 offen lds
s_add_u32 m0, s45, 4096
s_mov_b32 s44, 524288
buffer_load_dwordx4 v16, s[4:7], s44 offen lds
s_add_u32 m0, s45, 5120
s_mov_b32 s44, 655360
buffer_load_dwordx4 v16, s[4:7], s44 offen lds
s_add_u32 m0, s45, 6144
s_mov_b32 s44, 786432
buffer_load_dwordx4 v16, s[4:7], s44 offen lds
s_add_u32 m0, s45, 7168
s_mov_b32 s44, 917504
buffer_load_dwordx4 v16, s[4:7], s44 offen lds
s_mov_b32 s44, 1048576
buffer_load_dword v250, v12, s[4:7], s44 offen
s_add_u32 m0, s45, 8192
s_mov_b32 s44, 1048576
buffer_load_dwordx4 v16, s[4:7], s44 offen lds
s_add_u32 m0, s45, 9216
s_mov_b32 s44, 1179648
buffer_load_dwordx4 v16, s[4:7], s44 offen lds
s_add_u32 m0, s45, 10240
s_mov_b32 s44, 1310720
buffer_load_dwordx4 v16, s[4:7], s44 offen lds
s_add_u32 m0, s45, 11264
s_mov_b32 s44, 1441792
buffer_load_dwordx4 v16, s[4:7], s44 offen lds
s_add_u32 m0, s45, 12288
s_mov_b32 s44, 1572864
buffer_load_dwordx4 v16, s[4:7], s44 offen lds
s_add_u32 m0, s45, 13312
s_mov_b32 s44, 1703936
buffer_load_dwordx4 v16, s[4:7], s44 offen lds
s_add_u32 m0, s45, 14336
s_mov_b32 s44, 1835008
buffer_load_dwordx4 v16, s[4:7], s44 offen lds
s_add_u32 m0, s45, 15360
s_mov_b32 s44, 1966080
buffer_load_dwordx4 v16, s[4:7], s44 offen lds
s_mov_b32 s44, 2097152
buffer_load_dword v250, v12, s[4:7], s44 offen
s_add_u32 m0, s45, 16384
s_mov_b32 s44, 2097152
buffer_load_dwordx4 v16, s[4:7], s44 offen lds
s_add_u32 m0, s45, 17408
s_mov_b32 s44, 2228224
buffer_load_dwordx4 v16, s[4:7], s44 offen lds
s_add_u32 m0, s45, 18432
s_mov_b32 s44, 2359296
buffer_load_dwordx4 v16, s[4:7], s44 offen lds
s_add_u32 m0, s45, 19456
s_mov_b32 s44, 2490368
buffer_load_dwordx4 v16, s[4:7], s44 offen lds
s_add_u32 m0, s45, 20480
s_mov_b32 s44, 2621440
buffer_load_dwordx4 v16, s[4:7], s44 offen lds
s_add_u32 m0, s45, 21504
s_mov_b32 s44, 2752512
buffer_load_dwordx4 v16, s[4:7], s44 offen lds
s_add_u32 m0, s45, 22528
s_mov_b32 s44, 2883584
buffer_load_dwordx4 v16, s[4:7], s44 offen lds
s_add_u32 m0, s45, 23552
s_mov_b32 s44, 3014656
buffer_load_dwordx4 v16, s[4:7], s44 offen lds
s_waitcnt vmcnt(18)
s_barrier
ds_read_b64_tr_b16 a[0:1], v17 offset:0
ds_read_b64_tr_b16 a[2:3], v17 offset:256
ds_read_b64_tr_b16 a[4:5], v17 offset:8
ds_read_b64_tr_b16 a[6:7], v17 offset:264
ds_read_b64_tr_b16 a[8:9], v17 offset:2048
ds_read_b64_tr_b16 a[10:11], v17 offset:2304
ds_read_b64_tr_b16 a[12:13], v17 offset:2056
ds_read_b64_tr_b16 a[14:15], v17 offset:2312
s_waitcnt lgkmcnt(0)
ds_read_b64_tr_b16 a[16:17], v17 offset:4096
ds_read_b64_tr_b16 a[18:19], v17 offset:4352
ds_read_b64_tr_b16 a[20:21], v17 offset:4104
ds_read_b64_tr_b16 a[22:23], v17 offset:4360
ds_read_b64_tr_b16 a[24:25], v17 offset:6144
ds_read_b64_tr_b16 a[26:27], v17 offset:6400
ds_read_b64_tr_b16 a[28:29], v17 offset:6152
ds_read_b64_tr_b16 a[30:31], v17 offset:6408
s_waitcnt lgkmcnt(0)
s_mov_b32 s44, 3145728
buffer_load_dword v250, v12, s[4:7], s44 offen
s_add_u32 m0, s45, 0
s_mov_b32 s44, 3145728
buffer_load_dwordx4 v16, s[4:7], s44 offen lds
s_add_u32 m0, s45, 1024
s_mov_b32 s44, 3276800
buffer_load_dwordx4 v16, s[4:7], s44 offen lds
s_add_u32 m0, s45, 2048
s_mov_b32 s44, 3407872
buffer_load_dwordx4 v16, s[4:7], s44 offen lds
s_add_u32 m0, s45, 3072
s_mov_b32 s44, 3538944
buffer_load_dwordx4 v16, s[4:7], s44 offen lds
s_add_u32 m0, s45, 4096
s_mov_b32 s44, 3670016
buffer_load_dwordx4 v16, s[4:7], s44 offen lds
s_add_u32 m0, s45, 5120
s_mov_b32 s44, 3801088
buffer_load_dwordx4 v16, s[4:7], s44 offen lds
s_add_u32 m0, s45, 6144
s_mov_b32 s44, 3932160
buffer_load_dwordx4 v16, s[4:7], s44 offen lds
s_add_u32 m0, s45, 7168
s_mov_b32 s44, 4063232
buffer_load_dwordx4 v16, s[4:7], s44 offen lds
ds_read_b128 v[20:23], v8 offset:0
ds_read_b128 v[24:27], v8 offset:2048
ds_read_b128 v[28:31], v9 offset:0
ds_read_b128 v[32:35], v9 offset:2048
ds_read_b128 v[36:39], v8 offset:4096
ds_read_b128 v[40:43], v8 offset:6144
ds_read_b128 v[44:47], v9 offset:4096
ds_read_b128 v[48:51], v9 offset:6144
s_waitcnt lgkmcnt(0)
v_mfma_f32_16x16x32_bf16 v[52:55], a[0:3], v[20:23], 0
v_mfma_f32_16x16x32_bf16 v[56:59], a[4:7], v[20:23], 0
v_mfma_f32_16x16x32_bf16 v[60:63], a[0:3], v[24:27], 0
v_mfma_f32_16x16x32_bf16 v[64:67], a[4:7], v[24:27], 0
v_mfma_f32_16x16x32_bf16 v[52:55], a[8:11], v[28:31], v[52:55]
v_mfma_f32_16x16x32_bf16 v[56:59], a[12:15], v[28:31], v[56:59]
v_mfma_f32_16x16x32_bf16 v[60:63], a[8:11], v[32:35], v[60:63]
v_mfma_f32_16x16x32_bf16 v[64:67], a[12:15], v[32:35], v[64:67]
v_mfma_f32_16x16x32_bf16 v[52:55], a[16:19], v[36:39], v[52:55]
v_mfma_f32_16x16x32_bf16 v[56:59], a[20:23], v[36:39], v[56:59]
v_mfma_f32_16x16x32_bf16 v[60:63], a[16:19], v[40:43], v[60:63]
v_mfma_f32_16x16x32_bf16 v[64:67], a[20:23], v[40:43], v[64:67]
v_mfma_f32_16x16x32_bf16 v[52:55], a[24:27], v[44:47], v[52:55]
v_mfma_f32_16x16x32_bf16 v[56:59], a[28:31], v[44:47], v[56:59]
v_mfma_f32_16x16x32_bf16 v[60:63], a[24:27], v[48:51], v[60:63]
v_mfma_f32_16x16x32_bf16 v[64:67], a[28:31], v[48:51], v[64:67]
s_waitcnt vmcnt(18)
ds_read_b64_tr_b16 a[32:33], v17 offset:8192
ds_read_b64_tr_b16 a[34:35], v17 offset:8448
ds_read_b64_tr_b16 a[36:37], v17 offset:8200
ds_read_b64_tr_b16 a[38:39], v17 offset:8456
ds_read_b64_tr_b16 a[40:41], v17 offset:10240
ds_read_b64_tr_b16 a[42:43], v17 offset:10496
ds_read_b64_tr_b16 a[44:45], v17 offset:10248
ds_read_b64_tr_b16 a[46:47], v17 offset:10504
s_waitcnt lgkmcnt(0)
ds_read_b64_tr_b16 a[48:49], v17 offset:12288
ds_read_b64_tr_b16 a[50:51], v17 offset:12544
ds_read_b64_tr_b16 a[52:53], v17 offset:12296
ds_read_b64_tr_b16 a[54:55], v17 offset:12552
ds_read_b64_tr_b16 a[56:57], v17 offset:14336
ds_read_b64_tr_b16 a[58:59], v17 offset:14592
ds_read_b64_tr_b16 a[60:61], v17 offset:14344
ds_read_b64_tr_b16 a[62:63], v17 offset:14600
s_waitcnt lgkmcnt(0)
s_mov_b32 s44, 4194304
buffer_load_dword v250, v12, s[4:7], s44 offen
s_add_u32 m0, s45, 8192
s_mov_b32 s44, 4194304
buffer_load_dwordx4 v16, s[4:7], s44 offen lds
s_add_u32 m0, s45, 9216
s_mov_b32 s44, 4325376
buffer_load_dwordx4 v16, s[4:7], s44 offen lds
s_add_u32 m0, s45, 10240
s_mov_b32 s44, 4456448
buffer_load_dwordx4 v16, s[4:7], s44 offen lds
s_add_u32 m0, s45, 11264
s_mov_b32 s44, 4587520
buffer_load_dwordx4 v16, s[4:7], s44 offen lds
s_add_u32 m0, s45, 12288
s_mov_b32 s44, 4718592
buffer_load_dwordx4 v16, s[4:7], s44 offen lds
s_add_u32 m0, s45, 13312
s_mov_b32 s44, 4849664
buffer_load_dwordx4 v16, s[4:7], s44 offen lds
s_add_u32 m0, s45, 14336
s_mov_b32 s44, 4980736
buffer_load_dwordx4 v16, s[4:7], s44 offen lds
s_add_u32 m0, s45, 15360
s_mov_b32 s44, 5111808
buffer_load_dwordx4 v16, s[4:7], s44 offen lds
ds_read_b128 v[20:23], v8 offset:8192
ds_read_b128 v[24:27], v8 offset:10240
ds_read_b128 v[28:31], v9 offset:8192
ds_read_b128 v[32:35], v9 offset:10240
ds_read_b128 v[36:39], v8 offset:12288
ds_read_b128 v[40:43], v8 offset:14336
ds_read_b128 v[44:47], v9 offset:12288
ds_read_b128 v[48:51], v9 offset:14336
s_waitcnt lgkmcnt(0)
v_mfma_f32_16x16x32_bf16 v[52:55], a[32:35], v[20:23], v[52:55]
v_mfma_f32_16x16x32_bf16 v[56:59], a[36:39], v[20:23], v[56:59]
v_mfma_f32_16x16x32_bf16 v[60:63], a[32:35], v[24:27], v[60:63]
v_mfma_f32_16x16x32_bf16 v[64:67], a[36:39], v[24:27], v[64:67]
v_mfma_f32_16x16x32_bf16 v[52:55], a[40:43], v[28:31], v[52:55]
v_mfma_f32_16x16x32_bf16 v[56:59], a[44:47], v[28:31], v[56:59]
v_mfma_f32_16x16x32_bf16 v[60:63], a[40:43], v[32:35], v[60:63]
v_mfma_f32_16x16x32_bf16 v[64:67], a[44:47], v[32:35], v[64:67]
v_mfma_f32_16x16x32_bf16 v[52:55], a[48:51], v[36:39], v[52:55]
v_mfma_f32_16x16x32_bf16 v[56:59], a[52:55], v[36:39], v[56:59]
v_mfma_f32_16x16x32_bf16 v[60:63], a[48:51], v[40:43], v[60:63]
v_mfma_f32_16x16x32_bf16 v[64:67], a[52:55], v[40:43], v[64:67]
v_mfma_f32_16x16x32_bf16 v[52:55], a[56:59], v[44:47], v[52:55]
v_mfma_f32_16x16x32_bf16 v[56:59], a[60:63], v[44:47], v[56:59]
v_mfma_f32_16x16x32_bf16 v[60:63], a[56:59], v[48:51], v[60:63]
v_mfma_f32_16x16x32_bf16 v[64:67], a[60:63], v[48:51], v[64:67]
s_waitcnt vmcnt(18)
ds_read_b64_tr_b16 a[64:65], v17 offset:16384
ds_read_b64_tr_b16 a[66:67], v17 offset:16640
ds_read_b64_tr_b16 a[68:69], v17 offset:16392
ds_read_b64_tr_b16 a[70:71], v17 offset:16648
ds_read_b64_tr_b16 a[72:73], v17 offset:18432
ds_read_b64_tr_b16 a[74:75], v17 offset:18688
ds_read_b64_tr_b16 a[76:77], v17 offset:18440
ds_read_b64_tr_b16 a[78:79], v17 offset:18696
s_waitcnt lgkmcnt(0)
ds_read_b64_tr_b16 a[80:81], v17 offset:20480
ds_read_b64_tr_b16 a[82:83], v17 offset:20736
ds_read_b64_tr_b16 a[84:85], v17 offset:20488
ds_read_b64_tr_b16 a[86:87], v17 offset:20744
ds_read_b64_tr_b16 a[88:89], v17 offset:22528
ds_read_b64_tr_b16 a[90:91], v17 offset:22784
ds_read_b64_tr_b16 a[92:93], v17 offset:22536
ds_read_b64_tr_b16 a[94:95], v17 offset:22792
s_waitcnt lgkmcnt(0)
s_mov_b32 s44, 5242880
buffer_load_dword v250, v12, s[4:7], s44 offen
s_add_u32 m0, s45, 16384
s_mov_b32 s44, 5242880
buffer_load_dwordx4 v16, s[4:7], s44 offen lds
s_add_u32 m0, s45, 17408
s_mov_b32 s44, 5373952
buffer_load_dwordx4 v16, s[4:7], s44 offen lds
s_add_u32 m0, s45, 18432
s_mov_b32 s44, 5505024
buffer_load_dwordx4 v16, s[4:7], s44 offen lds
s_add_u32 m0, s45, 19456
s_mov_b32 s44, 5636096
buffer_load_dwordx4 v16, s[4:7], s44 offen lds
s_add_u32 m0, s45, 20480
s_mov_b32 s44, 5767168
buffer_load_dwordx4 v16, s[4:7], s44 offen lds
s_add_u32 m0, s45, 21504
s_mov_b32 s44, 5898240
buffer_load_dwordx4 v16, s[4:7], s44 offen lds
s_add_u32 m0, s45, 22528
s_mov_b32 s44, 6029312
buffer_load_dwordx4 v16, s[4:7], s44 offen lds
s_add_u32 m0, s45, 23552
s_mov_b32 s44, 6160384
buffer_load_dwordx4 v16, s[4:7], s44 offen lds
ds_read_b128 v[20:23], v8 offset:16384
ds_read_b128 v[24:27], v8 offset:18432
ds_read_b128 v[28:31], v9 offset:16384
ds_read_b128 v[32:35], v9 offset:18432
ds_read_b128 v[36:39], v8 offset:20480
ds_read_b128 v[40:43], v8 offset:22528
ds_read_b128 v[44:47], v9 offset:20480
ds_read_b128 v[48:51], v9 offset:22528
s_waitcnt lgkmcnt(0)
v_mfma_f32_16x16x32_bf16 v[52:55], a[64:67], v[20:23], v[52:55]
v_mfma_f32_16x16x32_bf16 v[56:59], a[68:71], v[20:23], v[56:59]
v_mfma_f32_16x16x32_bf16 v[60:63], a[64:67], v[24:27], v[60:63]
v_mfma_f32_16x16x32_bf16 v[64:67], a[68:71], v[24:27], v[64:67]
v_mfma_f32_16x16x32_bf16 v[52:55], a[72:75], v[28:31], v[52:55]
v_mfma_f32_16x16x32_bf16 v[56:59], a[76:79], v[28:31], v[56:59]
v_mfma_f32_16x16x32_bf16 v[60:63], a[72:75], v[32:35], v[60:63]
v_mfma_f32_16x16x32_bf16 v[64:67], a[76:79], v[32:35], v[64:67]
v_mfma_f32_16x16x32_bf16 v[52:55], a[80:83], v[36:39], v[52:55]
v_mfma_f32_16x16x32_bf16 v[56:59], a[84:87], v[36:39], v[56:59]
v_mfma_f32_16x16x32_bf16 v[60:63], a[80:83], v[40:43], v[60:63]
v_mfma_f32_16x16x32_bf16 v[64:67], a[84:87], v[40:43], v[64:67]
v_mfma_f32_16x16x32_bf16 v[52:55], a[88:91], v[44:47], v[52:55]
v_mfma_f32_16x16x32_bf16 v[56:59], a[92:95], v[44:47], v[56:59]
v_mfma_f32_16x16x32_bf16 v[60:63], a[88:91], v[48:51], v[60:63]
v_mfma_f32_16x16x32_bf16 v[64:67], a[92:95], v[48:51], v[64:67]
s_waitcnt vmcnt(18)
ds_read_b64_tr_b16 a[96:97], v17 offset:0
ds_read_b64_tr_b16 a[98:99], v17 offset:256
ds_read_b64_tr_b16 a[100:101], v17 offset:8
ds_read_b64_tr_b16 a[102:103], v17 offset:264
ds_read_b64_tr_b16 a[104:105], v17 offset:2048
ds_read_b64_tr_b16 a[106:107], v17 offset:2304
ds_read_b64_tr_b16 a[108:109], v17 offset:2056
ds_read_b64_tr_b16 a[110:111], v17 offset:2312
s_waitcnt lgkmcnt(0)
ds_read_b64_tr_b16 a[112:113], v17 offset:4096
ds_read_b64_tr_b16 a[114:115], v17 offset:4352
ds_read_b64_tr_b16 a[116:117], v17 offset:4104
ds_read_b64_tr_b16 a[118:119], v17 offset:4360
ds_read_b64_tr_b16 a[120:121], v17 offset:6144
ds_read_b64_tr_b16 a[122:123], v17 offset:6400
ds_read_b64_tr_b16 a[124:125], v17 offset:6152
ds_read_b64_tr_b16 a[126:127], v17 offset:6408
s_waitcnt lgkmcnt(0)
s_mov_b32 s44, 6291456
buffer_load_dword v250, v12, s[4:7], s44 offen
s_add_u32 m0, s45, 0
s_mov_b32 s44, 6291456
buffer_load_dwordx4 v16, s[4:7], s44 offen lds
s_add_u32 m0, s45, 1024
s_mov_b32 s44, 6422528
buffer_load_dwordx4 v16, s[4:7], s44 offen lds
s_add_u32 m0, s45, 2048
s_mov_b32 s44, 6553600
buffer_load_dwordx4 v16, s[4:7], s44 offen lds
s_add_u32 m0, s45, 3072
s_mov_b32 s44, 6684672
buffer_load_dwordx4 v16, s[4:7], s44 offen lds
s_add_u32 m0, s45, 4096
s_mov_b32 s44, 6815744
buffer_load_dwordx4 v16, s[4:7], s44 offen lds
s_add_u32 m0, s45, 5120
s_mov_b32 s44, 6946816
buffer_load_dwordx4 v16, s[4:7], s44 offen lds
s_add_u32 m0, s45, 6144
s_mov_b32 s44, 7077888
buffer_load_dwordx4 v16, s[4:7], s44 offen lds
s_add_u32 m0, s45, 7168
s_mov_b32 s44, 7208960
buffer_load_dwordx4 v16, s[4:7], s44 offen lds
ds_read_b128 v[20:23], v8 offset:24576
ds_read_b128 v[24:27], v8 offset:26624
ds_read_b128 v[28:31], v9 offset:24576
ds_read_b128 v[32:35], v9 offset:26624
ds_read_b128 v[36:39], v8 offset:28672
ds_read_b128 v[40:43], v8 offset:30720
ds_read_b128 v[44:47], v9 offset:28672
ds_read_b128 v[48:51], v9 offset:30720
s_waitcnt lgkmcnt(0)
v_mfma_f32_16x16x32_bf16 v[52:55], a[96:99], v[20:23], v[52:55]
v_mfma_f32_16x16x32_bf16 v[56:59], a[100:103], v[20:23], v[56:59]
v_mfma_f32_16x16x32_bf16 v[60:63], a[96:99], v[24:27], v[60:63]
v_mfma_f32_16x16x32_bf16 v[64:67], a[100:103], v[24:27], v[64:67]
v_mfma_f32_16x16x32_bf16 v[52:55], a[104:107], v[28:31], v[52:55]
v_mfma_f32_16x16x32_bf16 v[56:59], a[108:111], v[28:31], v[56:59]
v_mfma_f32_16x16x32_bf16 v[60:63], a[104:107], v[32:35], v[60:63]
v_mfma_f32_16x16x32_bf16 v[64:67], a[108:111], v[32:35], v[64:67]
v_mfma_f32_16x16x32_bf16 v[52:55], a[112:115], v[36:39], v[52:55]
v_mfma_f32_16x16x32_bf16 v[56:59], a[116:119], v[36:39], v[56:59]
v_mfma_f32_16x16x32_bf16 v[60:63], a[112:115], v[40:43], v[60:63]
v_mfma_f32_16x16x32_bf16 v[64:67], a[116:119], v[40:43], v[64:67]
v_mfma_f32_16x16x32_bf16 v[52:55], a[120:123], v[44:47], v[52:55]
v_mfma_f32_16x16x32_bf16 v[56:59], a[124:127], v[44:47], v[56:59]
v_mfma_f32_16x16x32_bf16 v[60:63], a[120:123], v[48:51], v[60:63]
v_mfma_f32_16x16x32_bf16 v[64:67], a[124:127], v[48:51], v[64:67]
s_waitcnt vmcnt(18)
ds_read_b64_tr_b16 a[128:129], v17 offset:8192
ds_read_b64_tr_b16 a[130:131], v17 offset:8448
ds_read_b64_tr_b16 a[132:133], v17 offset:8200
ds_read_b64_tr_b16 a[134:135], v17 offset:8456
ds_read_b64_tr_b16 a[136:137], v17 offset:10240
ds_read_b64_tr_b16 a[138:139], v17 offset:10496
ds_read_b64_tr_b16 a[140:141], v17 offset:10248
ds_read_b64_tr_b16 a[142:143], v17 offset:10504
s_waitcnt lgkmcnt(0)
ds_read_b64_tr_b16 a[144:145], v17 offset:12288
ds_read_b64_tr_b16 a[146:147], v17 offset:12544
ds_read_b64_tr_b16 a[148:149], v17 offset:12296
ds_read_b64_tr_b16 a[150:151], v17 offset:12552
ds_read_b64_tr_b16 a[152:153], v17 offset:14336
ds_read_b64_tr_b16 a[154:155], v17 offset:14592
ds_read_b64_tr_b16 a[156:157], v17 offset:14344
ds_read_b64_tr_b16 a[158:159], v17 offset:14600
s_waitcnt lgkmcnt(0)
s_mov_b32 s44, 7340032
buffer_load_dword v250, v12, s[4:7], s44 offen
s_add_u32 m0, s45, 8192
s_mov_b32 s44, 7340032
buffer_load_dwordx4 v16, s[4:7], s44 offen lds
s_add_u32 m0, s45, 9216
s_mov_b32 s44, 7471104
buffer_load_dwordx4 v16, s[4:7], s44 offen lds
s_add_u32 m0, s45, 10240
s_mov_b32 s44, 7602176
buffer_load_dwordx4 v16, s[4:7], s44 offen lds
s_add_u32 m0, s45, 11264
s_mov_b32 s44, 7733248
buffer_load_dwordx4 v16, s[4:7], s44 offen lds
s_add_u32 m0, s45, 12288
s_mov_b32 s44, 7864320
buffer_load_dwordx4 v16, s[4:7], s44 offen lds
s_add_u32 m0, s45, 13312
s_mov_b32 s44, 7995392
buffer_load_dwordx4 v16, s[4:7], s44 offen lds
s_add_u32 m0, s45, 14336
s_mov_b32 s44, 8126464
buffer_load_dwordx4 v16, s[4:7], s44 offen lds
s_add_u32 m0, s45, 15360
s_mov_b32 s44, 8257536
buffer_load_dwordx4 v16, s[4:7], s44 offen lds
ds_read_b128 v[20:23], v8 offset:32768
ds_read_b128 v[24:27], v8 offset:34816
ds_read_b128 v[28:31], v9 offset:32768
ds_read_b128 v[32:35], v9 offset:34816
ds_read_b128 v[36:39], v8 offset:36864
ds_read_b128 v[40:43], v8 offset:38912
ds_read_b128 v[44:47], v9 offset:36864
ds_read_b128 v[48:51], v9 offset:38912
s_waitcnt lgkmcnt(0)
v_mfma_f32_16x16x32_bf16 v[52:55], a[128:131], v[20:23], v[52:55]
v_mfma_f32_16x16x32_bf16 v[56:59], a[132:135], v[20:23], v[56:59]
v_mfma_f32_16x16x32_bf16 v[60:63], a[128:131], v[24:27], v[60:63]
v_mfma_f32_16x16x32_bf16 v[64:67], a[132:135], v[24:27], v[64:67]
v_mfma_f32_16x16x32_bf16 v[52:55], a[136:139], v[28:31], v[52:55]
v_mfma_f32_16x16x32_bf16 v[56:59], a[140:143], v[28:31], v[56:59]
v_mfma_f32_16x16x32_bf16 v[60:63], a[136:139], v[32:35], v[60:63]
v_mfma_f32_16x16x32_bf16 v[64:67], a[140:143], v[32:35], v[64:67]
v_mfma_f32_16x16x32_bf16 v[52:55], a[144:147], v[36:39], v[52:55]
v_mfma_f32_16x16x32_bf16 v[56:59], a[148:151], v[36:39], v[56:59]
v_mfma_f32_16x16x32_bf16 v[60:63], a[144:147], v[40:43], v[60:63]
v_mfma_f32_16x16x32_bf16 v[64:67], a[148:151], v[40:43], v[64:67]
v_mfma_f32_16x16x32_bf16 v[52:55], a[152:155], v[44:47], v[52:55]
v_mfma_f32_16x16x32_bf16 v[56:59], a[156:159], v[44:47], v[56:59]
v_mfma_f32_16x16x32_bf16 v[60:63], a[152:155], v[48:51], v[60:63]
v_mfma_f32_16x16x32_bf16 v[64:67], a[156:159], v[48:51], v[64:67]
s_waitcnt vmcnt(18)
ds_read_b64_tr_b16 a[160:161], v17 offset:16384
ds_read_b64_tr_b16 a[162:163], v17 offset:16640
ds_read_b64_tr_b16 a[164:165], v17 offset:16392
ds_read_b64_tr_b16 a[166:167], v17 offset:16648
ds_read_b64_tr_b16 a[168:169], v17 offset:18432
ds_read_b64_tr_b16 a[170:171], v17 offset:18688
ds_read_b64_tr_b16 a[172:173], v17 offset:18440
ds_read_b64_tr_b16 a[174:175], v17 offset:18696
s_waitcnt lgkmcnt(0)
ds_read_b64_tr_b16 a[176:177], v17 offset:20480
ds_read_b64_tr_b16 a[178:179], v17 offset:20736
ds_read_b64_tr_b16 a[180:181], v17 offset:20488
ds_read_b64_tr_b16 a[182:183], v17 offset:20744
ds_read_b64_tr_b16 a[184:185], v17 offset:22528
ds_read_b64_tr_b16 a[186:187], v17 offset:22784
ds_read_b64_tr_b16 a[188:189], v17 offset:22536
ds_read_b64_tr_b16 a[190:191], v17 offset:22792
s_waitcnt lgkmcnt(0)
ds_read_b128 v[20:23], v8 offset:40960
ds_read_b128 v[24:27], v8 offset:43008
ds_read_b128 v[28:31], v9 offset:40960
ds_read_b128 v[32:35], v9 offset:43008
ds_read_b128 v[36:39], v8 offset:45056
ds_read_b128 v[40:43], v8 offset:47104
ds_read_b128 v[44:47], v9 offset:45056
ds_read_b128 v[48:51], v9 offset:47104
s_waitcnt lgkmcnt(0)
v_mfma_f32_16x16x32_bf16 v[52:55], a[160:163], v[20:23], v[52:55]
v_mfma_f32_16x16x32_bf16 v[56:59], a[164:167], v[20:23], v[56:59]
v_mfma_f32_16x16x32_bf16 v[60:63], a[160:163], v[24:27], v[60:63]
v_mfma_f32_16x16x32_bf16 v[64:67], a[164:167], v[24:27], v[64:67]
v_mfma_f32_16x16x32_bf16 v[52:55], a[168:171], v[28:31], v[52:55]
v_mfma_f32_16x16x32_bf16 v[56:59], a[172:175], v[28:31], v[56:59]
v_mfma_f32_16x16x32_bf16 v[60:63], a[168:171], v[32:35], v[60:63]
v_mfma_f32_16x16x32_bf16 v[64:67], a[172:175], v[32:35], v[64:67]
v_mfma_f32_16x16x32_bf16 v[52:55], a[176:179], v[36:39], v[52:55]
v_mfma_f32_16x16x32_bf16 v[56:59], a[180:183], v[36:39], v[56:59]
v_mfma_f32_16x16x32_bf16 v[60:63], a[176:179], v[40:43], v[60:63]
v_mfma_f32_16x16x32_bf16 v[64:67], a[180:183], v[40:43], v[64:67]
v_mfma_f32_16x16x32_bf16 v[52:55], a[184:187], v[44:47], v[52:55]
v_mfma_f32_16x16x32_bf16 v[56:59], a[188:191], v[44:47], v[56:59]
v_mfma_f32_16x16x32_bf16 v[60:63], a[184:187], v[48:51], v[60:63]
v_mfma_f32_16x16x32_bf16 v[64:67], a[188:191], v[48:51], v[64:67]
s_waitcnt vmcnt(9)
ds_read_b64_tr_b16 a[192:193], v17 offset:0
ds_read_b64_tr_b16 a[194:195], v17 offset:256
ds_read_b64_tr_b16 a[196:197], v17 offset:8
ds_read_b64_tr_b16 a[198:199], v17 offset:264
ds_read_b64_tr_b16 a[200:201], v17 offset:2048
ds_read_b64_tr_b16 a[202:203], v17 offset:2304
ds_read_b64_tr_b16 a[204:205], v17 offset:2056
ds_read_b64_tr_b16 a[206:207], v17 offset:2312
s_waitcnt lgkmcnt(0)
ds_read_b64_tr_b16 a[208:209], v17 offset:4096
ds_read_b64_tr_b16 a[210:211], v17 offset:4352
ds_read_b64_tr_b16 a[212:213], v17 offset:4104
ds_read_b64_tr_b16 a[214:215], v17 offset:4360
ds_read_b64_tr_b16 a[216:217], v17 offset:6144
ds_read_b64_tr_b16 a[218:219], v17 offset:6400
ds_read_b64_tr_b16 a[220:221], v17 offset:6152
ds_read_b64_tr_b16 a[222:223], v17 offset:6408
s_waitcnt lgkmcnt(0)
ds_read_b128 v[20:23], v8 offset:49152
ds_read_b128 v[24:27], v8 offset:51200
ds_read_b128 v[28:31], v9 offset:49152
ds_read_b128 v[32:35], v9 offset:51200
ds_read_b128 v[36:39], v8 offset:53248
ds_read_b128 v[40:43], v8 offset:55296
ds_read_b128 v[44:47], v9 offset:53248
ds_read_b128 v[48:51], v9 offset:55296
s_waitcnt lgkmcnt(0)
v_mfma_f32_16x16x32_bf16 v[52:55], a[192:195], v[20:23], v[52:55]
v_mfma_f32_16x16x32_bf16 v[56:59], a[196:199], v[20:23], v[56:59]
v_mfma_f32_16x16x32_bf16 v[60:63], a[192:195], v[24:27], v[60:63]
v_mfma_f32_16x16x32_bf16 v[64:67], a[196:199], v[24:27], v[64:67]
v_mfma_f32_16x16x32_bf16 v[52:55], a[200:203], v[28:31], v[52:55]
v_mfma_f32_16x16x32_bf16 v[56:59], a[204:207], v[28:31], v[56:59]
v_mfma_f32_16x16x32_bf16 v[60:63], a[200:203], v[32:35], v[60:63]
v_mfma_f32_16x16x32_bf16 v[64:67], a[204:207], v[32:35], v[64:67]
v_mfma_f32_16x16x32_bf16 v[52:55], a[208:211], v[36:39], v[52:55]
v_mfma_f32_16x16x32_bf16 v[56:59], a[212:215], v[36:39], v[56:59]
v_mfma_f32_16x16x32_bf16 v[60:63], a[208:211], v[40:43], v[60:63]
v_mfma_f32_16x16x32_bf16 v[64:67], a[212:215], v[40:43], v[64:67]
v_mfma_f32_16x16x32_bf16 v[52:55], a[216:219], v[44:47], v[52:55]
v_mfma_f32_16x16x32_bf16 v[56:59], a[220:223], v[44:47], v[56:59]
v_mfma_f32_16x16x32_bf16 v[60:63], a[216:219], v[48:51], v[60:63]
v_mfma_f32_16x16x32_bf16 v[64:67], a[220:223], v[48:51], v[64:67]
s_waitcnt vmcnt(0)
ds_read_b64_tr_b16 a[224:225], v17 offset:8192
ds_read_b64_tr_b16 a[226:227], v17 offset:8448
ds_read_b64_tr_b16 a[228:229], v17 offset:8200
ds_read_b64_tr_b16 a[230:231], v17 offset:8456
ds_read_b64_tr_b16 a[232:233], v17 offset:10240
ds_read_b64_tr_b16 a[234:235], v17 offset:10496
ds_read_b64_tr_b16 a[236:237], v17 offset:10248
ds_read_b64_tr_b16 a[238:239], v17 offset:10504
s_waitcnt lgkmcnt(0)
ds_read_b64_tr_b16 a[240:241], v17 offset:12288
ds_read_b64_tr_b16 a[242:243], v17 offset:12544
ds_read_b64_tr_b16 a[244:245], v17 offset:12296
ds_read_b64_tr_b16 a[246:247], v17 offset:12552
ds_read_b64_tr_b16 a[248:249], v17 offset:14336
ds_read_b64_tr_b16 a[250:251], v17 offset:14592
ds_read_b64_tr_b16 a[252:253], v17 offset:14344
ds_read_b64_tr_b16 a[254:255], v17 offset:14600
s_waitcnt lgkmcnt(0)
ds_read_b128 v[20:23], v8 offset:57344
ds_read_b128 v[24:27], v8 offset:59392
ds_read_b128 v[28:31], v9 offset:57344
ds_read_b128 v[32:35], v9 offset:59392
ds_read_b128 v[36:39], v8 offset:61440
ds_read_b128 v[40:43], v8 offset:63488
ds_read_b128 v[44:47], v9 offset:61440
ds_read_b128 v[48:51], v9 offset:63488
s_waitcnt lgkmcnt(0)
v_mfma_f32_16x16x32_bf16 v[52:55], a[224:227], v[20:23], v[52:55]
v_mfma_f32_16x16x32_bf16 v[56:59], a[228:231], v[20:23], v[56:59]
v_mfma_f32_16x16x32_bf16 v[60:63], a[224:227], v[24:27], v[60:63]
v_mfma_f32_16x16x32_bf16 v[64:67], a[228:231], v[24:27], v[64:67]
v_mfma_f32_16x16x32_bf16 v[52:55], a[232:235], v[28:31], v[52:55]
v_mfma_f32_16x16x32_bf16 v[56:59], a[236:239], v[28:31], v[56:59]
v_mfma_f32_16x16x32_bf16 v[60:63], a[232:235], v[32:35], v[60:63]
v_mfma_f32_16x16x32_bf16 v[64:67], a[236:239], v[32:35], v[64:67]
v_mfma_f32_16x16x32_bf16 v[52:55], a[240:243], v[36:39], v[52:55]
v_mfma_f32_16x16x32_bf16 v[56:59], a[244:247], v[36:39], v[56:59]
v_mfma_f32_16x16x32_bf16 v[60:63], a[240:243], v[40:43], v[60:63]
v_mfma_f32_16x16x32_bf16 v[64:67], a[244:247], v[40:43], v[64:67]
v_mfma_f32_16x16x32_bf16 v[52:55], a[248:251], v[44:47], v[52:55]
v_mfma_f32_16x16x32_bf16 v[56:59], a[252:255], v[44:47], v[56:59]
v_mfma_f32_16x16x32_bf16 v[60:63], a[248:251], v[48:51], v[60:63]
v_mfma_f32_16x16x32_bf16 v[64:67], a[252:255], v[48:51], v[64:67]
s_barrier
s_mov_b32 s50, 0x10000
s_add_u32 m0, s46, 65536
s_nop 0
buffer_load_dwordx4 v6, s[8:11], s50 offen offset:0 lds
s_add_u32 m0, s46, 69504
s_nop 0
buffer_load_dwordx4 v6, s[8:11], s50 offen offset:128 lds
s_add_u32 m0, s46, 73472
s_nop 0
buffer_load_dwordx4 v6, s[8:11], s50 offen offset:256 lds
s_add_u32 m0, s46, 77440
s_nop 0
buffer_load_dwordx4 v6, s[8:11], s50 offen offset:384 lds
s_add_u32 m0, s46, 81408
s_nop 0
buffer_load_dwordx4 v6, s[8:11], s50 offen offset:512 lds
s_add_u32 m0, s46, 85376
s_nop 0
buffer_load_dwordx4 v6, s[8:11], s50 offen offset:640 lds
s_add_u32 m0, s46, 89344
s_nop 0
buffer_load_dwordx4 v6, s[8:11], s50 offen offset:768 lds
s_add_u32 m0, s46, 93312
s_nop 0
buffer_load_dwordx4 v6, s[8:11], s50 offen offset:896 lds
s_add_u32 m0, s46, 97280
s_nop 0
buffer_load_dwordx4 v6, s[8:11], s50 offen offset:1024 lds
s_add_u32 m0, s46, 101248
s_nop 0
buffer_load_dwordx4 v6, s[8:11], s50 offen offset:1152 lds
s_add_u32 m0, s46, 105216
s_nop 0
buffer_load_dwordx4 v6, s[8:11], s50 offen offset:1280 lds
s_add_u32 m0, s46, 109184
s_nop 0
buffer_load_dwordx4 v6, s[8:11], s50 offen offset:1408 lds
s_add_u32 m0, s46, 113152
s_nop 0
buffer_load_dwordx4 v6, s[8:11], s50 offen offset:1536 lds
s_add_u32 m0, s46, 117120
s_nop 0
buffer_load_dwordx4 v6, s[8:11], s50 offen offset:1664 lds
s_add_u32 m0, s46, 121088
s_nop 0
buffer_load_dwordx4 v6, s[8:11], s50 offen offset:1792 lds
s_add_u32 m0, s46, 125056
s_nop 0
buffer_load_dwordx4 v6, s[8:11], s50 offen offset:1920 lds
s_and_b32 s53, s47, 31
s_lshl_b32 s53, s53, 4
v_add_u32 v19, s53, v1
v_lshlrev_b32 v19, 7, v19
s_mov_b32 s42, 1
v_and_b32 v3, 15, v0
v_lshlrev_b32 v3, 4, v3
s_branch mega_kernel_syk
mega_kernel_sykw:
s_sleep 4
mega_kernel_syk:
buffer_load_dword v2, v3, s[72:75], 0 offen sc1
s_waitcnt vmcnt(0)
mega_kernel_sykp:
s_cmp_eq_u32 s95, 1
s_cbranch_scc0 mega_kernel_sykf
v_readlane_b32 s76, v2, 14
s_mov_b32 s98, 0
s_cmp_eq_u32 s76, 32
s_cbranch_scc0 mega_kernel_sykw
s_branch mega_kernel_sykd
mega_kernel_sykf:
s_mov_b32 s77, 0
s_mov_b32 s78, 0
v_readlane_b32 s76, v2, 0
s_add_u32 s77, s77, s76
s_xor_b32 s76, s76, 32
s_or_b32 s78, s78, s76
v_readlane_b32 s76, v2, 1
s_add_u32 s77, s77, s76
s_xor_b32 s76, s76, 32
s_or_b32 s78, s78, s76
v_readlane_b32 s76, v2, 2
s_add_u32 s77, s77, s76
s_xor_b32 s76, s76, 32
s_or_b32 s78, s78, s76
v_readlane_b32 s76, v2, 3
s_add_u32 s77, s77, s76
s_xor_b32 s76, s76, 32
s_or_b32 s78, s78, s76
v_readlane_b32 s76, v2, 4
s_add_u32 s77, s77, s76
s_xor_b32 s76, s76, 32
s_or_b32 s78, s78, s76
v_readlane_b32 s76, v2, 5
s_add_u32 s77, s77, s76
s_xor_b32 s76, s76, 32
s_or_b32 s78, s78, s76
v_readlane_b32 s76, v2, 6
s_add_u32 s77, s77, s76
s_xor_b32 s76, s76, 32
s_or_b32 s78, s78, s76
v_readlane_b32 s76, v2, 7
s_add_u32 s77, s77, s76
s_xor_b32 s76, s76, 32
s_or_b32 s78, s78, s76
s_cmp_eq_u32 s77, 256
s_cbranch_scc0 mega_kernel_sykw
v_mov_b32 v252, v2
s_cmp_eq_u32 s78, 0
s_cbranch_scc0 mega_kernel_slowent
v_readlane_b32 s76, v2, 10
v_readlane_b32 s77, v2, 8
s_cmp_eq_u32 s76, 32
s_cbranch_scc0 mega_kernel_sykw
s_cmp_gt_u32 s77, 16
s_cselect_b32 s98, 1, 0
mega_kernel_sykd:
s_lshr_b32 s44, s47, 3
s_xor_b32 s44, s44, s98
s_and_b32 s44, s44, 1
s_lshl_b32 s44, s44, 13
s_lshl_b32 s48, s47, 18
s_add_u32 s48, s48, s44
s_add_u32 s48, s48, 0
s_xor_b32 s44, s98, 1
s_lshl_b32 s44, s44, 13
s_lshl_b32 s49, s40, 7
s_add_u32 s49, s49, s44
s_lshl_b32 s44, s41, 2
s_add_u32 s49, s49, s44
s_add_u32 s49, s49, 69206016
v_mov_b32 v16, 0
v_cvt_pk_bf16_f32 v84, v52, v53
v_cvt_pk_bf16_f32 v85, v54, v55
v_cvt_pk_bf16_f32 v86, v56, v57
v_cvt_pk_bf16_f32 v87, v58, v59
v_cvt_pk_bf16_f32 v88, v60, v61
v_cvt_pk_bf16_f32 v89, v62, v63
v_cvt_pk_bf16_f32 v90, v64, v65
v_cvt_pk_bf16_f32 v91, v66, v67
s_add_u32 s51, s42, s47
s_sub_u32 s51, s51, 1
s_bfe_u32 s52, s51, 0x40002
s_lshl_b32 s52, s52, 14
s_and_b32 s51, s51, 3
s_lshl_b32 s51, s51, 11
s_add_u32 s51, s51, s52
s_add_u32 s51, s51, s48
buffer_store_dwordx4 v[84:87], v7, s[84:87], s51 offen sc1
buffer_store_dwordx4 v[88:91], v7, s[84:87], s51 offen offset:1024 sc1
s_waitcnt vmcnt(0)
v_mov_b32 v17, s42
s_mov_b64 exec, 1
buffer_store_dword v17, v16, s[84:87], s49 offen sc1
s_mov_b64 exec, -1
mega_kernel_k_loop:
s_waitcnt vmcnt(2)
s_barrier
s_add_u32 s50, s42, 1
s_min_u32 s50, s50, 63
s_lshl_b32 s50, s50, 16
ds_read_b128 v[20:23], v10 offset:0
ds_read_b128 v[24:27], v10 offset:2048
ds_read_b128 v[28:31], v11 offset:0
ds_read_b128 v[32:35], v11 offset:2048
ds_read_b128 v[36:39], v10 offset:4096
ds_read_b128 v[40:43], v10 offset:6144
s_waitcnt lgkmcnt(4)
v_mfma_f32_16x16x32_bf16 v[68:71], a[0:3], v[20:23], 0
ds_read_b128 v[44:47], v11 offset:4096
v_mfma_f32_16x16x32_bf16 v[72:75], a[4:7], v[20:23], 0
v_cvt_pk_bf16_f32 v84, v52, v53
v_cvt_pk_bf16_f32 v85, v54, v55
v_cvt_pk_bf16_f32 v86, v56, v57
v_mfma_f32_16x16x32_bf16 v[76:79], a[0:3], v[24:27], 0
ds_read_b128 v[48:51], v11 offset:6144
v_mfma_f32_16x16x32_bf16 v[80:83], a[4:7], v[24:27], 0
v_cvt_pk_bf16_f32 v87, v58, v59
v_cvt_pk_bf16_f32 v88, v60, v61
v_cvt_pk_bf16_f32 v89, v62, v63
s_waitcnt lgkmcnt(4)
v_mfma_f32_16x16x32_bf16 v[68:71], a[8:11], v[28:31], v[68:71]
ds_read_b128 v[20:23], v10 offset:8192
v_mfma_f32_16x16x32_bf16 v[72:75], a[12:15], v[28:31], v[72:75]
v_cvt_pk_bf16_f32 v90, v64, v65
v_cvt_pk_bf16_f32 v91, v66, v67
v_mfma_f32_16x16x32_bf16 v[76:79], a[8:11], v[32:35], v[76:79]
ds_read_b128 v[24:27], v10 offset:10240
v_mfma_f32_16x16x32_bf16 v[80:83], a[12:15], v[32:35], v[80:83]
s_add_u32 s51, s42, s47
s_sub_u32 s51, s51, 1
s_bfe_u32 s52, s51, 0x40002
s_lshl_b32 s52, s52, 14
s_waitcnt lgkmcnt(4)
v_mfma_f32_16x16x32_bf16 v[68:71], a[16:19], v[36:39], v[68:71]
ds_read_b128 v[28:31], v11 offset:8192
v_mfma_f32_16x16x32_bf16 v[72:75], a[20:23], v[36:39], v[72:75]
s_and_b32 s51, s51, 3
s_lshl_b32 s51, s51, 11
s_add_u32 s51, s51, s52
s_add_u32 s51, s51, s48
buffer_store_dwordx4 v[84:87], v7, s[84:87], s51 offen sc1
v_mfma_f32_16x16x32_bf16 v[76:79], a[16:19], v[40:43], v[76:79]
ds_read_b128 v[32:35], v11 offset:10240
v_mfma_f32_16x16x32_bf16 v[80:83], a[20:23], v[40:43], v[80:83]
buffer_store_dwordx4 v[88:91], v7, s[84:87], s51 offen offset:1024 sc1
s_waitcnt lgkmcnt(4)
v_mfma_f32_16x16x32_bf16 v[68:71], a[24:27], v[44:47], v[68:71]
ds_read_b128 v[36:39], v10 offset:12288
v_mfma_f32_16x16x32_bf16 v[72:75], a[28:31], v[44:47], v[72:75]
s_add_u32 m0, s46, 0
v_mfma_f32_16x16x32_bf16 v[76:79], a[24:27], v[48:51], v[76:79]
ds_read_b128 v[40:43], v10 offset:14336
v_mfma_f32_16x16x32_bf16 v[80:83], a[28:31], v[48:51], v[80:83]
buffer_load_dwordx4 v6, s[8:11], s50 offen offset:0 lds
s_waitcnt lgkmcnt(4)
v_mfma_f32_16x16x32_bf16 v[68:71], a[32:35], v[20:23], v[68:71]
ds_read_b128 v[44:47], v11 offset:12288
v_mfma_f32_16x16x32_bf16 v[72:75], a[36:39], v[20:23], v[72:75]
s_add_u32 m0, s46, 3968
v_mfma_f32_16x16x32_bf16 v[76:79], a[32:35], v[24:27], v[76:79]
ds_read_b128 v[48:51], v11 offset:14336
v_mfma_f32_16x16x32_bf16 v[80:83], a[36:39], v[24:27], v[80:83]
buffer_load_dwordx4 v6, s[8:11], s50 offen offset:128 lds
s_waitcnt lgkmcnt(4)
v_mfma_f32_16x16x32_bf16 v[68:71], a[40:43], v[28:31], v[68:71]
ds_read_b128 v[20:23], v10 offset:16384
v_mfma_f32_16x16x32_bf16 v[72:75], a[44:47], v[28:31], v[72:75]
s_add_u32 m0, s46, 7936
v_mfma_f32_16x16x32_bf16 v[76:79], a[40:43], v[32:35], v[76:79]
ds_read_b128 v[24:27], v10 offset:18432
v_mfma_f32_16x16x32_bf16 v[80:83], a[44:47], v[32:35], v[80:83]
buffer_load_dwordx4 v6, s[8:11], s50 offen offset:256 lds
s_waitcnt lgkmcnt(4)
v_mfma_f32_16x16x32_bf16 v[68:71], a[48:51], v[36:39], v[68:71]
ds_read_b128 v[28:31], v11 offset:16384
v_mfma_f32_16x16x32_bf16 v[72:75], a[52:55], v[36:39], v[72:75]
s_add_u32 m0, s46, 11904
v_mfma_f32_16x16x32_bf16 v[76:79], a[48:51], v[40:43], v[76:79]
ds_read_b128 v[32:35], v11 offset:18432
v_mfma_f32_16x16x32_bf16 v[80:83], a[52:55], v[40:43], v[80:83]
buffer_load_dwordx4 v6, s[8:11], s50 offen offset:384 lds
s_waitcnt lgkmcnt(4)
v_mfma_f32_16x16x32_bf16 v[68:71], a[56:59], v[44:47], v[68:71]
ds_read_b128 v[36:39], v10 offset:20480
v_mfma_f32_16x16x32_bf16 v[72:75], a[60:63], v[44:47], v[72:75]
s_add_u32 m0, s46, 15872
v_mfma_f32_16x16x32_bf16 v[76:79], a[56:59], v[48:51], v[76:79]
ds_read_b128 v[40:43], v10 offset:22528
v_mfma_f32_16x16x32_bf16 v[80:83], a[60:63], v[48:51], v[80:83]
buffer_load_dwordx4 v6, s[8:11], s50 offen offset:512 lds
s_waitcnt lgkmcnt(4)
v_mfma_f32_16x16x32_bf16 v[68:71], a[64:67], v[20:23], v[68:71]
ds_read_b128 v[44:47], v11 offset:20480
v_mfma_f32_16x16x32_bf16 v[72:75], a[68:71], v[20:23], v[72:75]
s_add_u32 m0, s46, 19840
v_mfma_f32_16x16x32_bf16 v[76:79], a[64:67], v[24:27], v[76:79]
ds_read_b128 v[48:51], v11 offset:22528
v_mfma_f32_16x16x32_bf16 v[80:83], a[68:71], v[24:27], v[80:83]
buffer_load_dwordx4 v6, s[8:11], s50 offen offset:640 lds
s_waitcnt lgkmcnt(4)
v_mfma_f32_16x16x32_bf16 v[68:71], a[72:75], v[28:31], v[68:71]
ds_read_b128 v[20:23], v10 offset:24576
v_mfma_f32_16x16x32_bf16 v[72:75], a[76:79], v[28:31], v[72:75]
s_add_u32 m0, s46, 23808
v_mfma_f32_16x16x32_bf16 v[76:79], a[72:75], v[32:35], v[76:79]
ds_read_b128 v[24:27], v10 offset:26624
v_mfma_f32_16x16x32_bf16 v[80:83], a[76:79], v[32:35], v[80:83]
buffer_load_dwordx4 v6, s[8:11], s50 offen offset:768 lds
s_waitcnt lgkmcnt(4)
v_mfma_f32_16x16x32_bf16 v[68:71], a[80:83], v[36:39], v[68:71]
ds_read_b128 v[28:31], v11 offset:24576
v_mfma_f32_16x16x32_bf16 v[72:75], a[84:87], v[36:39], v[72:75]
s_add_u32 m0, s46, 27776
v_mfma_f32_16x16x32_bf16 v[76:79], a[80:83], v[40:43], v[76:79]
ds_read_b128 v[32:35], v11 offset:26624
v_mfma_f32_16x16x32_bf16 v[80:83], a[84:87], v[40:43], v[80:83]
buffer_load_dwordx4 v6, s[8:11], s50 offen offset:896 lds
s_waitcnt lgkmcnt(4)
v_mfma_f32_16x16x32_bf16 v[68:71], a[88:91], v[44:47], v[68:71]
ds_read_b128 v[36:39], v10 offset:28672
v_mfma_f32_16x16x32_bf16 v[72:75], a[92:95], v[44:47], v[72:75]
s_add_u32 m0, s46, 31744
v_mfma_f32_16x16x32_bf16 v[76:79], a[88:91], v[48:51], v[76:79]
ds_read_b128 v[40:43], v10 offset:30720
v_mfma_f32_16x16x32_bf16 v[80:83], a[92:95], v[48:51], v[80:83]
buffer_load_dwordx4 v6, s[8:11], s50 offen offset:1024 lds
s_waitcnt lgkmcnt(4)
v_mfma_f32_16x16x32_bf16 v[68:71], a[96:99], v[20:23], v[68:71]
ds_read_b128 v[44:47], v11 offset:28672
v_mfma_f32_16x16x32_bf16 v[72:75], a[100:103], v[20:23], v[72:75]
s_add_u32 m0, s46, 35712
v_mfma_f32_16x16x32_bf16 v[76:79], a[96:99], v[24:27], v[76:79]
ds_read_b128 v[48:51], v11 offset:30720
v_mfma_f32_16x16x32_bf16 v[80:83], a[100:103], v[24:27], v[80:83]
buffer_load_dwordx4 v6, s[8:11], s50 offen offset:1152 lds
s_waitcnt lgkmcnt(4)
v_mfma_f32_16x16x32_bf16 v[68:71], a[104:107], v[28:31], v[68:71]
ds_read_b128 v[20:23], v10 offset:32768
v_mfma_f32_16x16x32_bf16 v[72:75], a[108:111], v[28:31], v[72:75]
s_add_u32 m0, s46, 39680
v_mfma_f32_16x16x32_bf16 v[76:79], a[104:107], v[32:35], v[76:79]
ds_read_b128 v[24:27], v10 offset:34816
v_mfma_f32_16x16x32_bf16 v[80:83], a[108:111], v[32:35], v[80:83]
buffer_load_dwordx4 v6, s[8:11], s50 offen offset:1280 lds
s_waitcnt lgkmcnt(4)
v_mfma_f32_16x16x32_bf16 v[68:71], a[112:115], v[36:39], v[68:71]
ds_read_b128 v[28:31], v11 offset:32768
v_mfma_f32_16x16x32_bf16 v[72:75], a[116:119], v[36:39], v[72:75]
s_add_u32 m0, s46, 43648
v_mfma_f32_16x16x32_bf16 v[76:79], a[112:115], v[40:43], v[76:79]
ds_read_b128 v[32:35], v11 offset:34816
v_mfma_f32_16x16x32_bf16 v[80:83], a[116:119], v[40:43], v[80:83]
buffer_load_dwordx4 v6, s[8:11], s50 offen offset:1408 lds
s_waitcnt lgkmcnt(4)
v_mfma_f32_16x16x32_bf16 v[68:71], a[120:123], v[44:47], v[68:71]
ds_read_b128 v[36:39], v10 offset:36864
v_mfma_f32_16x16x32_bf16 v[72:75], a[124:127], v[44:47], v[72:75]
s_add_u32 m0, s46, 47616
v_mfma_f32_16x16x32_bf16 v[76:79], a[120:123], v[48:51], v[76:79]
ds_read_b128 v[40:43], v10 offset:38912
v_mfma_f32_16x16x32_bf16 v[80:83], a[124:127], v[48:51], v[80:83]
buffer_load_dwordx4 v6, s[8:11], s50 offen offset:1536 lds
s_waitcnt lgkmcnt(4)
v_mfma_f32_16x16x32_bf16 v[68:71], a[128:131], v[20:23], v[68:71]
ds_read_b128 v[44:47], v11 offset:36864
v_mfma_f32_16x16x32_bf16 v[72:75], a[132:135], v[20:23], v[72:75]
s_add_u32 m0, s46, 51584
v_mfma_f32_16x16x32_bf16 v[76:79], a[128:131], v[24:27], v[76:79]
ds_read_b128 v[48:51], v11 offset:38912
v_mfma_f32_16x16x32_bf16 v[80:83], a[132:135], v[24:27], v[80:83]
buffer_load_dwordx4 v6, s[8:11], s50 offen offset:1664 lds
s_waitcnt lgkmcnt(4)
v_mfma_f32_16x16x32_bf16 v[68:71], a[136:139], v[28:31], v[68:71]
ds_read_b128 v[20:23], v10 offset:40960
v_mfma_f32_16x16x32_bf16 v[72:75], a[140:143], v[28:31], v[72:75]
s_add_u32 m0, s46, 55552
v_mfma_f32_16x16x32_bf16 v[76:79], a[136:139], v[32:35], v[76:79]
ds_read_b128 v[24:27], v10 offset:43008
v_mfma_f32_16x16x32_bf16 v[80:83], a[140:143], v[32:35], v[80:83]
buffer_load_dwordx4 v6, s[8:11], s50 offen offset:1792 lds
s_waitcnt lgkmcnt(4)
v_mfma_f32_16x16x32_bf16 v[68:71], a[144:147], v[36:39], v[68:71]
ds_read_b128 v[28:31], v11 offset:40960
v_mfma_f32_16x16x32_bf16 v[72:75], a[148:151], v[36:39], v[72:75]
s_add_u32 m0, s46, 59520
v_mfma_f32_16x16x32_bf16 v[76:79], a[144:147], v[40:43], v[76:79]
ds_read_b128 v[32:35], v11 offset:43008
v_mfma_f32_16x16x32_bf16 v[80:83], a[148:151], v[40:43], v[80:83]
buffer_load_dwordx4 v6, s[8:11], s50 offen offset:1920 lds
s_waitcnt lgkmcnt(4)
v_mfma_f32_16x16x32_bf16 v[68:71], a[152:155], v[44:47], v[68:71]
ds_read_b128 v[36:39], v10 offset:45056
v_mfma_f32_16x16x32_bf16 v[72:75], a[156:159], v[44:47], v[72:75]
v_mfma_f32_16x16x32_bf16 v[76:79], a[152:155], v[48:51], v[76:79]
ds_read_b128 v[40:43], v10 offset:47104
v_mfma_f32_16x16x32_bf16 v[80:83], a[156:159], v[48:51], v[80:83]
s_waitcnt lgkmcnt(4)
v_mfma_f32_16x16x32_bf16 v[68:71], a[160:163], v[20:23], v[68:71]
ds_read_b128 v[44:47], v11 offset:45056
v_mfma_f32_16x16x32_bf16 v[72:75], a[164:167], v[20:23], v[72:75]
v_mfma_f32_16x16x32_bf16 v[76:79], a[160:163], v[24:27], v[76:79]
ds_read_b128 v[48:51], v11 offset:47104
v_mfma_f32_16x16x32_bf16 v[80:83], a[164:167], v[24:27], v[80:83]
s_waitcnt lgkmcnt(4)
v_mfma_f32_16x16x32_bf16 v[68:71], a[168:171], v[28:31], v[68:71]
ds_read_b128 v[20:23], v10 offset:49152
v_mfma_f32_16x16x32_bf16 v[72:75], a[172:175], v[28:31], v[72:75]
s_waitcnt vmcnt(16)
v_mov_b32 v17, s42
s_mov_b64 exec, 1
buffer_store_dword v17, v16, s[84:87], s49 offen sc1
s_mov_b64 exec, -1
v_mfma_f32_16x16x32_bf16 v[76:79], a[168:171], v[32:35], v[76:79]
ds_read_b128 v[24:27], v10 offset:51200
v_mfma_f32_16x16x32_bf16 v[80:83], a[172:175], v[32:35], v[80:83]
s_waitcnt lgkmcnt(4)
v_mfma_f32_16x16x32_bf16 v[68:71], a[176:179], v[36:39], v[68:71]
ds_read_b128 v[28:31], v11 offset:49152
v_mfma_f32_16x16x32_bf16 v[72:75], a[180:183], v[36:39], v[72:75]
s_add_u32 s53, s42, 3
s_min_u32 s53, s53, 63
s_lshl_b32 s53, s53, 16
s_mov_b64 exec, 0xffff
buffer_load_dword v250, v19, s[8:11], s53 offen
s_mov_b64 exec, -1
v_mfma_f32_16x16x32_bf16 v[76:79], a[176:179], v[40:43], v[76:79]
ds_read_b128 v[32:35], v11 offset:51200
v_mfma_f32_16x16x32_bf16 v[80:83], a[180:183], v[40:43], v[80:83]
s_waitcnt lgkmcnt(4)
v_mfma_f32_16x16x32_bf16 v[68:71], a[184:187], v[44:47], v[68:71]
ds_read_b128 v[36:39], v10 offset:53248
v_mfma_f32_16x16x32_bf16 v[72:75], a[188:191], v[44:47], v[72:75]
v_mfma_f32_16x16x32_bf16 v[76:79], a[184:187], v[48:51], v[76:79]
ds_read_b128 v[40:43], v10 offset:55296
v_mfma_f32_16x16x32_bf16 v[80:83], a[188:191], v[48:51], v[80:83]
s_waitcnt lgkmcnt(4)
v_mfma_f32_16x16x32_bf16 v[68:71], a[192:195], v[20:23], v[68:71]
ds_read_b128 v[44:47], v11 offset:53248
v_mfma_f32_16x16x32_bf16 v[72:75], a[196:199], v[20:23], v[72:75]
v_mfma_f32_16x16x32_bf16 v[76:79], a[192:195], v[24:27], v[76:79]
ds_read_b128 v[48:51], v11 offset:55296
v_mfma_f32_16x16x32_bf16 v[80:83], a[196:199], v[24:27], v[80:83]
s_waitcnt lgkmcnt(4)
v_mfma_f32_16x16x32_bf16 v[68:71], a[200:203], v[28:31], v[68:71]
ds_read_b128 v[20:23], v10 offset:57344
v_mfma_f32_16x16x32_bf16 v[72:75], a[204:207], v[28:31], v[72:75]
v_mfma_f32_16x16x32_bf16 v[76:79], a[200:203], v[32:35], v[76:79]
ds_read_b128 v[24:27], v10 offset:59392
v_mfma_f32_16x16x32_bf16 v[80:83], a[204:207], v[32:35], v[80:83]
s_waitcnt lgkmcnt(4)
v_mfma_f32_16x16x32_bf16 v[68:71], a[208:211], v[36:39], v[68:71]
ds_read_b128 v[28:31], v11 offset:57344
v_mfma_f32_16x16x32_bf16 v[72:75], a[212:215], v[36:39], v[72:75]
v_mfma_f32_16x16x32_bf16 v[76:79], a[208:211], v[40:43], v[76:79]
ds_read_b128 v[32:35], v11 offset:59392
v_mfma_f32_16x16x32_bf16 v[80:83], a[212:215], v[40:43], v[80:83]
s_waitcnt lgkmcnt(4)
v_mfma_f32_16x16x32_bf16 v[68:71], a[216:219], v[44:47], v[68:71]
ds_read_b128 v[36:39], v10 offset:61440
v_mfma_f32_16x16x32_bf16 v[72:75], a[220:223], v[44:47], v[72:75]
v_mfma_f32_16x16x32_bf16 v[76:79], a[216:219], v[48:51], v[76:79]
ds_read_b128 v[40:43], v10 offset:63488
v_mfma_f32_16x16x32_bf16 v[80:83], a[220:223], v[48:51], v[80:83]
s_waitcnt lgkmcnt(4)
v_mfma_f32_16x16x32_bf16 v[68:71], a[224:227], v[20:23], v[68:71]
ds_read_b128 v[44:47], v11 offset:61440
v_mfma_f32_16x16x32_bf16 v[72:75], a[228:231], v[20:23], v[72:75]
v_mfma_f32_16x16x32_bf16 v[76:79], a[224:227], v[24:27], v[76:79]
ds_read_b128 v[48:51], v11 offset:63488
v_mfma_f32_16x16x32_bf16 v[80:83], a[228:231], v[24:27], v[80:83]
s_waitcnt lgkmcnt(5)
v_mfma_f32_16x16x32_bf16 v[68:71], a[232:235], v[28:31], v[68:71]
v_mfma_f32_16x16x32_bf16 v[72:75], a[236:239], v[28:31], v[72:75]
s_waitcnt lgkmcnt(4)
v_mfma_f32_16x16x32_bf16 v[76:79], a[232:235], v[32:35], v[76:79]
v_mfma_f32_16x16x32_bf16 v[80:83], a[236:239], v[32:35], v[80:83]
s_waitcnt lgkmcnt(3)
v_mfma_f32_16x16x32_bf16 v[68:71], a[240:243], v[36:39], v[68:71]
v_mfma_f32_16x16x32_bf16 v[72:75], a[244:247], v[36:39], v[72:75]
s_waitcnt lgkmcnt(2)
v_mfma_f32_16x16x32_bf16 v[76:79], a[240:243], v[40:43], v[76:79]
v_mfma_f32_16x16x32_bf16 v[80:83], a[244:247], v[40:43], v[80:83]
s_waitcnt lgkmcnt(1)
v_mfma_f32_16x16x32_bf16 v[68:71], a[248:251], v[44:47], v[68:71]
v_mfma_f32_16x16x32_bf16 v[72:75], a[252:255], v[44:47], v[72:75]
s_waitcnt lgkmcnt(0)
v_mfma_f32_16x16x32_bf16 v[76:79], a[248:251], v[48:51], v[76:79]
v_mfma_f32_16x16x32_bf16 v[80:83], a[252:255], v[48:51], v[80:83]
s_add_u32 s42, s42, 1
s_cmp_eq_u32 s42, 64
s_cbranch_scc1 mega_kernel_k_fin
mega_kernel_k_mid:
s_waitcnt vmcnt(2)
s_barrier
s_add_u32 s50, s42, 1
s_min_u32 s50, s50, 63
s_lshl_b32 s50, s50, 16
ds_read_b128 v[20:23], v8 offset:0
ds_read_b128 v[24:27], v8 offset:2048
ds_read_b128 v[28:31], v9 offset:0
ds_read_b128 v[32:35], v9 offset:2048
ds_read_b128 v[36:39], v8 offset:4096
ds_read_b128 v[40:43], v8 offset:6144
s_waitcnt lgkmcnt(4)
v_mfma_f32_16x16x32_bf16 v[52:55], a[0:3], v[20:23], 0
ds_read_b128 v[44:47], v9 offset:4096
v_mfma_f32_16x16x32_bf16 v[56:59], a[4:7], v[20:23], 0
v_cvt_pk_bf16_f32 v84, v68, v69
v_cvt_pk_bf16_f32 v85, v70, v71
v_cvt_pk_bf16_f32 v86, v72, v73
v_mfma_f32_16x16x32_bf16 v[60:63], a[0:3], v[24:27], 0
ds_read_b128 v[48:51], v9 offset:6144
v_mfma_f32_16x16x32_bf16 v[64:67], a[4:7], v[24:27], 0
v_cvt_pk_bf16_f32 v87, v74, v75
v_cvt_pk_bf16_f32 v88, v76, v77
v_cvt_pk_bf16_f32 v89, v78, v79
s_waitcnt lgkmcnt(4)
v_mfma_f32_16x16x32_bf16 v[52:55], a[8:11], v[28:31], v[52:55]
ds_read_b128 v[20:23], v8 offset:8192
v_mfma_f32_16x16x32_bf16 v[56:59], a[12:15], v[28:31], v[56:59]
v_cvt_pk_bf16_f32 v90, v80, v81
v_cvt_pk_bf16_f32 v91, v82, v83
v_mfma_f32_16x16x32_bf16 v[60:63], a[8:11], v[32:35], v[60:63]
ds_read_b128 v[24:27], v8 offset:10240
v_mfma_f32_16x16x32_bf16 v[64:67], a[12:15], v[32:35], v[64:67]
s_add_u32 s51, s42, s47
s_sub_u32 s51, s51, 1
s_bfe_u32 s52, s51, 0x40002
s_lshl_b32 s52, s52, 14
s_waitcnt lgkmcnt(4)
v_mfma_f32_16x16x32_bf16 v[52:55], a[16:19], v[36:39], v[52:55]
ds_read_b128 v[28:31], v9 offset:8192
v_mfma_f32_16x16x32_bf16 v[56:59], a[20:23], v[36:39], v[56:59]
s_and_b32 s51, s51, 3
s_lshl_b32 s51, s51, 11
s_add_u32 s51, s51, s52
s_add_u32 s51, s51, s48
buffer_store_dwordx4 v[84:87], v7, s[84:87], s51 offen sc1
v_mfma_f32_16x16x32_bf16 v[60:63], a[16:19], v[40:43], v[60:63]
ds_read_b128 v[32:35], v9 offset:10240
v_mfma_f32_16x16x32_bf16 v[64:67], a[20:23], v[40:43], v[64:67]
buffer_store_dwordx4 v[88:91], v7, s[84:87], s51 offen offset:1024 sc1
s_waitcnt lgkmcnt(4)
v_mfma_f32_16x16x32_bf16 v[52:55], a[24:27], v[44:47], v[52:55]
ds_read_b128 v[36:39], v8 offset:12288
v_mfma_f32_16x16x32_bf16 v[56:59], a[28:31], v[44:47], v[56:59]
s_add_u32 m0, s46, 65536
v_mfma_f32_16x16x32_bf16 v[60:63], a[24:27], v[48:51], v[60:63]
ds_read_b128 v[40:43], v8 offset:14336
v_mfma_f32_16x16x32_bf16 v[64:67], a[28:31], v[48:51], v[64:67]
buffer_load_dwordx4 v6, s[8:11], s50 offen offset:0 lds
s_waitcnt lgkmcnt(4)
v_mfma_f32_16x16x32_bf16 v[52:55], a[32:35], v[20:23], v[52:55]
ds_read_b128 v[44:47], v9 offset:12288
v_mfma_f32_16x16x32_bf16 v[56:59], a[36:39], v[20:23], v[56:59]
s_add_u32 m0, s46, 69504
v_mfma_f32_16x16x32_bf16 v[60:63], a[32:35], v[24:27], v[60:63]
ds_read_b128 v[48:51], v9 offset:14336
v_mfma_f32_16x16x32_bf16 v[64:67], a[36:39], v[24:27], v[64:67]
buffer_load_dwordx4 v6, s[8:11], s50 offen offset:128 lds
s_waitcnt lgkmcnt(4)
v_mfma_f32_16x16x32_bf16 v[52:55], a[40:43], v[28:31], v[52:55]
ds_read_b128 v[20:23], v8 offset:16384
v_mfma_f32_16x16x32_bf16 v[56:59], a[44:47], v[28:31], v[56:59]
s_add_u32 m0, s46, 73472
v_mfma_f32_16x16x32_bf16 v[60:63], a[40:43], v[32:35], v[60:63]
ds_read_b128 v[24:27], v8 offset:18432
v_mfma_f32_16x16x32_bf16 v[64:67], a[44:47], v[32:35], v[64:67]
buffer_load_dwordx4 v6, s[8:11], s50 offen offset:256 lds
s_waitcnt lgkmcnt(4)
v_mfma_f32_16x16x32_bf16 v[52:55], a[48:51], v[36:39], v[52:55]
ds_read_b128 v[28:31], v9 offset:16384
v_mfma_f32_16x16x32_bf16 v[56:59], a[52:55], v[36:39], v[56:59]
s_add_u32 m0, s46, 77440
v_mfma_f32_16x16x32_bf16 v[60:63], a[48:51], v[40:43], v[60:63]
ds_read_b128 v[32:35], v9 offset:18432
v_mfma_f32_16x16x32_bf16 v[64:67], a[52:55], v[40:43], v[64:67]
buffer_load_dwordx4 v6, s[8:11], s50 offen offset:384 lds
s_waitcnt lgkmcnt(4)
v_mfma_f32_16x16x32_bf16 v[52:55], a[56:59], v[44:47], v[52:55]
ds_read_b128 v[36:39], v8 offset:20480
v_mfma_f32_16x16x32_bf16 v[56:59], a[60:63], v[44:47], v[56:59]
s_add_u32 m0, s46, 81408
v_mfma_f32_16x16x32_bf16 v[60:63], a[56:59], v[48:51], v[60:63]
ds_read_b128 v[40:43], v8 offset:22528
v_mfma_f32_16x16x32_bf16 v[64:67], a[60:63], v[48:51], v[64:67]
buffer_load_dwordx4 v6, s[8:11], s50 offen offset:512 lds
s_waitcnt lgkmcnt(4)
v_mfma_f32_16x16x32_bf16 v[52:55], a[64:67], v[20:23], v[52:55]
ds_read_b128 v[44:47], v9 offset:20480
v_mfma_f32_16x16x32_bf16 v[56:59], a[68:71], v[20:23], v[56:59]
s_add_u32 m0, s46, 85376
v_mfma_f32_16x16x32_bf16 v[60:63], a[64:67], v[24:27], v[60:63]
ds_read_b128 v[48:51], v9 offset:22528
v_mfma_f32_16x16x32_bf16 v[64:67], a[68:71], v[24:27], v[64:67]
buffer_load_dwordx4 v6, s[8:11], s50 offen offset:640 lds
s_waitcnt lgkmcnt(4)
v_mfma_f32_16x16x32_bf16 v[52:55], a[72:75], v[28:31], v[52:55]
ds_read_b128 v[20:23], v8 offset:24576
v_mfma_f32_16x16x32_bf16 v[56:59], a[76:79], v[28:31], v[56:59]
s_add_u32 m0, s46, 89344
v_mfma_f32_16x16x32_bf16 v[60:63], a[72:75], v[32:35], v[60:63]
ds_read_b128 v[24:27], v8 offset:26624
v_mfma_f32_16x16x32_bf16 v[64:67], a[76:79], v[32:35], v[64:67]
buffer_load_dwordx4 v6, s[8:11], s50 offen offset:768 lds
s_waitcnt lgkmcnt(4)
v_mfma_f32_16x16x32_bf16 v[52:55], a[80:83], v[36:39], v[52:55]
ds_read_b128 v[28:31], v9 offset:24576
v_mfma_f32_16x16x32_bf16 v[56:59], a[84:87], v[36:39], v[56:59]
s_add_u32 m0, s46, 93312
v_mfma_f32_16x16x32_bf16 v[60:63], a[80:83], v[40:43], v[60:63]
ds_read_b128 v[32:35], v9 offset:26624
v_mfma_f32_16x16x32_bf16 v[64:67], a[84:87], v[40:43], v[64:67]
buffer_load_dwordx4 v6, s[8:11], s50 offen offset:896 lds
s_waitcnt lgkmcnt(4)
v_mfma_f32_16x16x32_bf16 v[52:55], a[88:91], v[44:47], v[52:55]
ds_read_b128 v[36:39], v8 offset:28672
v_mfma_f32_16x16x32_bf16 v[56:59], a[92:95], v[44:47], v[56:59]
s_add_u32 m0, s46, 97280
v_mfma_f32_16x16x32_bf16 v[60:63], a[88:91], v[48:51], v[60:63]
ds_read_b128 v[40:43], v8 offset:30720
v_mfma_f32_16x16x32_bf16 v[64:67], a[92:95], v[48:51], v[64:67]
buffer_load_dwordx4 v6, s[8:11], s50 offen offset:1024 lds
s_waitcnt lgkmcnt(4)
v_mfma_f32_16x16x32_bf16 v[52:55], a[96:99], v[20:23], v[52:55]
ds_read_b128 v[44:47], v9 offset:28672
v_mfma_f32_16x16x32_bf16 v[56:59], a[100:103], v[20:23], v[56:59]
s_add_u32 m0, s46, 101248
v_mfma_f32_16x16x32_bf16 v[60:63], a[96:99], v[24:27], v[60:63]
ds_read_b128 v[48:51], v9 offset:30720
v_mfma_f32_16x16x32_bf16 v[64:67], a[100:103], v[24:27], v[64:67]
buffer_load_dwordx4 v6, s[8:11], s50 offen offset:1152 lds
s_waitcnt lgkmcnt(4)
v_mfma_f32_16x16x32_bf16 v[52:55], a[104:107], v[28:31], v[52:55]
ds_read_b128 v[20:23], v8 offset:32768
v_mfma_f32_16x16x32_bf16 v[56:59], a[108:111], v[28:31], v[56:59]
s_add_u32 m0, s46, 105216
v_mfma_f32_16x16x32_bf16 v[60:63], a[104:107], v[32:35], v[60:63]
ds_read_b128 v[24:27], v8 offset:34816
v_mfma_f32_16x16x32_bf16 v[64:67], a[108:111], v[32:35], v[64:67]
buffer_load_dwordx4 v6, s[8:11], s50 offen offset:1280 lds
s_waitcnt lgkmcnt(4)
v_mfma_f32_16x16x32_bf16 v[52:55], a[112:115], v[36:39], v[52:55]
ds_read_b128 v[28:31], v9 offset:32768
v_mfma_f32_16x16x32_bf16 v[56:59], a[116:119], v[36:39], v[56:59]
s_add_u32 m0, s46, 109184
v_mfma_f32_16x16x32_bf16 v[60:63], a[112:115], v[40:43], v[60:63]
ds_read_b128 v[32:35], v9 offset:34816
v_mfma_f32_16x16x32_bf16 v[64:67], a[116:119], v[40:43], v[64:67]
buffer_load_dwordx4 v6, s[8:11], s50 offen offset:1408 lds
s_waitcnt lgkmcnt(4)
v_mfma_f32_16x16x32_bf16 v[52:55], a[120:123], v[44:47], v[52:55]
ds_read_b128 v[36:39], v8 offset:36864
v_mfma_f32_16x16x32_bf16 v[56:59], a[124:127], v[44:47], v[56:59]
s_add_u32 m0, s46, 113152
v_mfma_f32_16x16x32_bf16 v[60:63], a[120:123], v[48:51], v[60:63]
ds_read_b128 v[40:43], v8 offset:38912
v_mfma_f32_16x16x32_bf16 v[64:67], a[124:127], v[48:51], v[64:67]
buffer_load_dwordx4 v6, s[8:11], s50 offen offset:1536 lds
s_waitcnt lgkmcnt(4)
v_mfma_f32_16x16x32_bf16 v[52:55], a[128:131], v[20:23], v[52:55]
ds_read_b128 v[44:47], v9 offset:36864
v_mfma_f32_16x16x32_bf16 v[56:59], a[132:135], v[20:23], v[56:59]
s_add_u32 m0, s46, 117120
v_mfma_f32_16x16x32_bf16 v[60:63], a[128:131], v[24:27], v[60:63]
ds_read_b128 v[48:51], v9 offset:38912
v_mfma_f32_16x16x32_bf16 v[64:67], a[132:135], v[24:27], v[64:67]
buffer_load_dwordx4 v6, s[8:11], s50 offen offset:1664 lds
s_waitcnt lgkmcnt(4)
v_mfma_f32_16x16x32_bf16 v[52:55], a[136:139], v[28:31], v[52:55]
ds_read_b128 v[20:23], v8 offset:40960
v_mfma_f32_16x16x32_bf16 v[56:59], a[140:143], v[28:31], v[56:59]
s_add_u32 m0, s46, 121088
v_mfma_f32_16x16x32_bf16 v[60:63], a[136:139], v[32:35], v[60:63]
ds_read_b128 v[24:27], v8 offset:43008
v_mfma_f32_16x16x32_bf16 v[64:67], a[140:143], v[32:35], v[64:67]
buffer_load_dwordx4 v6, s[8:11], s50 offen offset:1792 lds
s_waitcnt lgkmcnt(4)
v_mfma_f32_16x16x32_bf16 v[52:55], a[144:147], v[36:39], v[52:55]
ds_read_b128 v[28:31], v9 offset:40960
v_mfma_f32_16x16x32_bf16 v[56:59], a[148:151], v[36:39], v[56:59]
s_add_u32 m0, s46, 125056
v_mfma_f32_16x16x32_bf16 v[60:63], a[144:147], v[40:43], v[60:63]
ds_read_b128 v[32:35], v9 offset:43008
v_mfma_f32_16x16x32_bf16 v[64:67], a[148:151], v[40:43], v[64:67]
buffer_load_dwordx4 v6, s[8:11], s50 offen offset:1920 lds
s_waitcnt lgkmcnt(4)
v_mfma_f32_16x16x32_bf16 v[52:55], a[152:155], v[44:47], v[52:55]
ds_read_b128 v[36:39], v8 offset:45056
v_mfma_f32_16x16x32_bf16 v[56:59], a[156:159], v[44:47], v[56:59]
v_mfma_f32_16x16x32_bf16 v[60:63], a[152:155], v[48:51], v[60:63]
ds_read_b128 v[40:43], v8 offset:47104
v_mfma_f32_16x16x32_bf16 v[64:67], a[156:159], v[48:51], v[64:67]
s_waitcnt lgkmcnt(4)
v_mfma_f32_16x16x32_bf16 v[52:55], a[160:163], v[20:23], v[52:55]
ds_read_b128 v[44:47], v9 offset:45056
v_mfma_f32_16x16x32_bf16 v[56:59], a[164:167], v[20:23], v[56:59]
v_mfma_f32_16x16x32_bf16 v[60:63], a[160:163], v[24:27], v[60:63]
ds_read_b128 v[48:51], v9 offset:47104
v_mfma_f32_16x16x32_bf16 v[64:67], a[164:167], v[24:27], v[64:67]
s_waitcnt lgkmcnt(4)
v_mfma_f32_16x16x32_bf16 v[52:55], a[168:171], v[28:31], v[52:55]
ds_read_b128 v[20:23], v8 offset:49152
v_mfma_f32_16x16x32_bf16 v[56:59], a[172:175], v[28:31], v[56:59]
s_waitcnt vmcnt(16)
v_mov_b32 v17, s42
s_mov_b64 exec, 1
buffer_store_dword v17, v16, s[84:87], s49 offen sc1
s_mov_b64 exec, -1
v_mfma_f32_16x16x32_bf16 v[60:63], a[168:171], v[32:35], v[60:63]
ds_read_b128 v[24:27], v8 offset:51200
v_mfma_f32_16x16x32_bf16 v[64:67], a[172:175], v[32:35], v[64:67]
s_waitcnt lgkmcnt(4)
v_mfma_f32_16x16x32_bf16 v[52:55], a[176:179], v[36:39], v[52:55]
ds_read_b128 v[28:31], v9 offset:49152
v_mfma_f32_16x16x32_bf16 v[56:59], a[180:183], v[36:39], v[56:59]
s_add_u32 s53, s42, 3
s_min_u32 s53, s53, 63
s_lshl_b32 s53, s53, 16
s_mov_b64 exec, 0xffff
buffer_load_dword v250, v19, s[8:11], s53 offen
s_mov_b64 exec, -1
v_mfma_f32_16x16x32_bf16 v[60:63], a[176:179], v[40:43], v[60:63]
ds_read_b128 v[32:35], v9 offset:51200
v_mfma_f32_16x16x32_bf16 v[64:67], a[180:183], v[40:43], v[64:67]
s_waitcnt lgkmcnt(4)
v_mfma_f32_16x16x32_bf16 v[52:55], a[184:187], v[44:47], v[52:55]
ds_read_b128 v[36:39], v8 offset:53248
v_mfma_f32_16x16x32_bf16 v[56:59], a[188:191], v[44:47], v[56:59]
v_mfma_f32_16x16x32_bf16 v[60:63], a[184:187], v[48:51], v[60:63]
ds_read_b128 v[40:43], v8 offset:55296
v_mfma_f32_16x16x32_bf16 v[64:67], a[188:191], v[48:51], v[64:67]
s_waitcnt lgkmcnt(4)
v_mfma_f32_16x16x32_bf16 v[52:55], a[192:195], v[20:23], v[52:55]
ds_read_b128 v[44:47], v9 offset:53248
v_mfma_f32_16x16x32_bf16 v[56:59], a[196:199], v[20:23], v[56:59]
v_mfma_f32_16x16x32_bf16 v[60:63], a[192:195], v[24:27], v[60:63]
ds_read_b128 v[48:51], v9 offset:55296
v_mfma_f32_16x16x32_bf16 v[64:67], a[196:199], v[24:27], v[64:67]
s_waitcnt lgkmcnt(4)
v_mfma_f32_16x16x32_bf16 v[52:55], a[200:203], v[28:31], v[52:55]
ds_read_b128 v[20:23], v8 offset:57344
v_mfma_f32_16x16x32_bf16 v[56:59], a[204:207], v[28:31], v[56:59]
v_mfma_f32_16x16x32_bf16 v[60:63], a[200:203], v[32:35], v[60:63]
ds_read_b128 v[24:27], v8 offset:59392
v_mfma_f32_16x16x32_bf16 v[64:67], a[204:207], v[32:35], v[64:67]
s_waitcnt lgkmcnt(4)
v_mfma_f32_16x16x32_bf16 v[52:55], a[208:211], v[36:39], v[52:55]
ds_read_b128 v[28:31], v9 offset:57344
v_mfma_f32_16x16x32_bf16 v[56:59], a[212:215], v[36:39], v[56:59]
v_mfma_f32_16x16x32_bf16 v[60:63], a[208:211], v[40:43], v[60:63]
ds_read_b128 v[32:35], v9 offset:59392
v_mfma_f32_16x16x32_bf16 v[64:67], a[212:215], v[40:43], v[64:67]
s_waitcnt lgkmcnt(4)
v_mfma_f32_16x16x32_bf16 v[52:55], a[216:219], v[44:47], v[52:55]
ds_read_b128 v[36:39], v8 offset:61440
v_mfma_f32_16x16x32_bf16 v[56:59], a[220:223], v[44:47], v[56:59]
v_mfma_f32_16x16x32_bf16 v[60:63], a[216:219], v[48:51], v[60:63]
ds_read_b128 v[40:43], v8 offset:63488
v_mfma_f32_16x16x32_bf16 v[64:67], a[220:223], v[48:51], v[64:67]
s_waitcnt lgkmcnt(4)
v_mfma_f32_16x16x32_bf16 v[52:55], a[224:227], v[20:23], v[52:55]
ds_read_b128 v[44:47], v9 offset:61440
v_mfma_f32_16x16x32_bf16 v[56:59], a[228:231], v[20:23], v[56:59]
v_mfma_f32_16x16x32_bf16 v[60:63], a[224:227], v[24:27], v[60:63]
ds_read_b128 v[48:51], v9 offset:63488
v_mfma_f32_16x16x32_bf16 v[64:67], a[228:231], v[24:27], v[64:67]
s_waitcnt lgkmcnt(5)
v_mfma_f32_16x16x32_bf16 v[52:55], a[232:235], v[28:31], v[52:55]
v_mfma_f32_16x16x32_bf16 v[56:59], a[236:239], v[28:31], v[56:59]
s_waitcnt lgkmcnt(4)
v_mfma_f32_16x16x32_bf16 v[60:63], a[232:235], v[32:35], v[60:63]
v_mfma_f32_16x16x32_bf16 v[64:67], a[236:239], v[32:35], v[64:67]
s_waitcnt lgkmcnt(3)
v_mfma_f32_16x16x32_bf16 v[52:55], a[240:243], v[36:39], v[52:55]
v_mfma_f32_16x16x32_bf16 v[56:59], a[244:247], v[36:39], v[56:59]
s_waitcnt lgkmcnt(2)
v_mfma_f32_16x16x32_bf16 v[60:63], a[240:243], v[40:43], v[60:63]
v_mfma_f32_16x16x32_bf16 v[64:67], a[244:247], v[40:43], v[64:67]
s_waitcnt lgkmcnt(1)
v_mfma_f32_16x16x32_bf16 v[52:55], a[248:251], v[44:47], v[52:55]
v_mfma_f32_16x16x32_bf16 v[56:59], a[252:255], v[44:47], v[56:59]
s_waitcnt lgkmcnt(0)
v_mfma_f32_16x16x32_bf16 v[60:63], a[248:251], v[48:51], v[60:63]
v_mfma_f32_16x16x32_bf16 v[64:67], a[252:255], v[48:51], v[64:67]
s_add_u32 s42, s42, 1
s_branch mega_kernel_k_loop
mega_kernel_k_fin:
s_nop 11
v_cvt_pk_bf16_f32 v84, v68, v69
v_cvt_pk_bf16_f32 v85, v70, v71
v_cvt_pk_bf16_f32 v86, v72, v73
v_cvt_pk_bf16_f32 v87, v74, v75
v_cvt_pk_bf16_f32 v88, v76, v77
v_cvt_pk_bf16_f32 v89, v78, v79
v_cvt_pk_bf16_f32 v90, v80, v81
v_cvt_pk_bf16_f32 v91, v82, v83
s_add_u32 s51, s42, s47
s_sub_u32 s51, s51, 1
s_bfe_u32 s52, s51, 0x40002
s_lshl_b32 s52, s52, 14
s_and_b32 s51, s51, 3
s_lshl_b32 s51, s51, 11
s_add_u32 s51, s51, s52
s_add_u32 s51, s51, s48
buffer_store_dwordx4 v[84:87], v7, s[84:87], s51 offen sc1
buffer_store_dwordx4 v[88:91], v7, s[84:87], s51 offen offset:1024 sc1
s_waitcnt vmcnt(0)
v_mov_b32 v17, s42
s_mov_b64 exec, 1
buffer_store_dword v17, v16, s[84:87], s49 offen sc1
s_mov_b64 exec, -1
s_waitcnt vmcnt(0)
s_barrier
s_branch mega_kernel_fft
mega_kernel_rv:
s_load_dwordx2 s[4:5], s[0:1], 32
s_load_dwordx2 s[8:9], s[0:1], 0
v_lshrrev_b32 v2, 6, v0
v_and_b32 v1, 63, v0
v_readfirstlane_b32 s41, v2
v_lshlrev_b32 v5, 4, v1
s_waitcnt lgkmcnt(0)
s_mov_b32 s6, 8388608
s_mov_b32 s7, 0x00020000
s_mov_b32 s10, 4194304
s_mov_b32 s11, 0x00020000
s_lshl_b32 s43, s40, 8
s_lshl_b32 s44, s41, 6
s_add_u32 s48, s43, s44
s_and_b32 s43, s48, 0x7ff
v_add_u32 v19, s43, v1
v_lshlrev_b32 v19, 7, v19
s_mov_b32 s43, 0
buffer_load_dword v250, v19, s[8:11], s43 offen
s_nop 0
v_lshrrev_b32 v2, 3, v1
s_lshl_b32 s43, s41, 3
v_add_u32 v2, s43, v2
v_bfe_u32 v3, v2, 1, 3
v_and_b32 v4, 7, v1
v_xor_b32 v3, v3, v4
v_lshlrev_b32 v6, 11, v2
v_lshl_add_u32 v6, v3, 4, v6
s_lshl_b32 s46, s41, 10
v_and_b32 v2, 15, v1
v_bfe_u32 v3, v2, 1, 3
v_lshrrev_b32 v4, 4, v1
v_xor_b32 v3, v3, v4
v_lshlrev_b32 v8, 7, v2
v_lshl_add_u32 v8, v3, 4, v8
v_xor_b32 v9, 64, v8
v_add_u32 v10, 0x10000, v8
v_add_u32 v11, 0x10000, v9
v_mov_b32 v7, v5
s_lshl_b32 s47, s40, 2
s_add_u32 s47, s47, s41
s_mov_b32 s42, 0
s_mov_b32 s50, 0
s_add_u32 m0, s46, 0
s_nop 0
buffer_load_dwordx4 v6, s[8:11], s50 offen offset:0 lds
s_add_u32 m0, s46, 3968
s_nop 0
buffer_load_dwordx4 v6, s[8:11], s50 offen offset:128 lds
s_add_u32 m0, s46, 7936
s_nop 0
buffer_load_dwordx4 v6, s[8:11], s50 offen offset:256 lds
s_add_u32 m0, s46, 11904
s_nop 0
buffer_load_dwordx4 v6, s[8:11], s50 offen offset:384 lds
s_add_u32 m0, s46, 15872
s_nop 0
buffer_load_dwordx4 v6, s[8:11], s50 offen offset:512 lds
s_add_u32 m0, s46, 19840
s_nop 0
buffer_load_dwordx4 v6, s[8:11], s50 offen offset:640 lds
s_add_u32 m0, s46, 23808
s_nop 0
buffer_load_dwordx4 v6, s[8:11], s50 offen offset:768 lds
s_add_u32 m0, s46, 27776
s_nop 0
buffer_load_dwordx4 v6, s[8:11], s50 offen offset:896 lds
s_add_u32 m0, s46, 31744
s_nop 0
buffer_load_dwordx4 v6, s[8:11], s50 offen offset:1024 lds
s_add_u32 m0, s46, 35712
s_nop 0
buffer_load_dwordx4 v6, s[8:11], s50 offen offset:1152 lds
s_add_u32 m0, s46, 39680
s_nop 0
buffer_load_dwordx4 v6, s[8:11], s50 offen offset:1280 lds
s_add_u32 m0, s46, 43648
s_nop 0
buffer_load_dwordx4 v6, s[8:11], s50 offen offset:1408 lds
s_add_u32 m0, s46, 47616
s_nop 0
buffer_load_dwordx4 v6, s[8:11], s50 offen offset:1536 lds
s_add_u32 m0, s46, 51584
s_nop 0
buffer_load_dwordx4 v6, s[8:11], s50 offen offset:1664 lds
s_add_u32 m0, s46, 55552
s_nop 0
buffer_load_dwordx4 v6, s[8:11], s50 offen offset:1792 lds
s_add_u32 m0, s46, 59520
s_nop 0
buffer_load_dwordx4 v6, s[8:11], s50 offen offset:1920 lds
v_lshrrev_b32 v2, 2, v1
v_and_b32 v3, 3, v1
v_lshlrev_b32 v16, 13, v2
v_lshl_add_u32 v16, v3, 4, v16
v_add_u32 v16, s48, v16
s_mul_i32 s45, s41, 24576
s_add_u32 s45, s45, 65536
v_bfe_u32 v17, v1, 2, 2
v_lshrrev_b32 v18, 4, v1
v_lshl_add_u32 v17, v18, 3, v17
v_lshlrev_b32 v17, 6, v17
v_lshl_add_u32 v17, v3, 3, v17
v_add_u32 v17, s45, v17
s_and_b32 s43, s40, 3
s_lshl_b32 s43, s43, 2
s_add_u32 s43, s43, s41
s_lshl_b32 s43, s43, 3
v_and_b32 v12, 7, v1
v_add_u32 v12, s43, v12
s_lshr_b32 s43, s40, 2
s_lshl_b32 s43, s43, 10
s_add_u32 s44, s43, 896
s_add_u32 s43, s43, 384
s_cmp_ge_u32 s40, 28
s_cselect_b32 s44, s44, s43
v_mov_b32 v13, s43
v_mov_b32 v14, s44
v_cmp_gt_u32 vcc, 32, v1
s_nop 1
v_cndmask_b32 v13, v14, v13, vcc
v_lshl_add_u32 v12, v12, 13, v13
s_mov_b32 s44, 0
buffer_load_dword v250, v12, s[4:7], s44 offen
s_add_u32 m0, s45, 0
s_mov_b32 s44, 0
buffer_load_dwordx4 v16, s[4:7], s44 offen lds
s_add_u32 m0, s45, 1024
s_mov_b32 s44, 131072
buffer_load_dwordx4 v16, s[4:7], s44 offen lds
s_add_u32 m0, s45, 2048
s_mov_b32 s44, 262144
buffer_load_dwordx4 v16, s[4:7], s44 offen lds
s_add_u32 m0, s45, 3072
s_mov_b32 s44, 393216
buffer_load_dwordx4 v16, s[4:7], s44 offen lds
s_add_u32 m0, s45, 4096
s_mov_b32 s44, 524288
buffer_load_dwordx4 v16, s[4:7], s44 offen lds
s_add_u32 m0, s45, 5120
s_mov_b32 s44, 655360
buffer_load_dwordx4 v16, s[4:7], s44 offen lds
s_add_u32 m0, s45, 6144
s_mov_b32 s44, 786432
buffer_load_dwordx4 v16, s[4:7], s44 offen lds
s_add_u32 m0, s45, 7168
s_mov_b32 s44, 917504
buffer_load_dwordx4 v16, s[4:7], s44 offen lds
s_mov_b32 s44, 1048576
buffer_load_dword v250, v12, s[4:7], s44 offen
s_add_u32 m0, s45, 8192
s_mov_b32 s44, 1048576
buffer_load_dwordx4 v16, s[4:7], s44 offen lds
s_add_u32 m0, s45, 9216
s_mov_b32 s44, 1179648
buffer_load_dwordx4 v16, s[4:7], s44 offen lds
s_add_u32 m0, s45, 10240
s_mov_b32 s44, 1310720
buffer_load_dwordx4 v16, s[4:7], s44 offen lds
s_add_u32 m0, s45, 11264
s_mov_b32 s44, 1441792
buffer_load_dwordx4 v16, s[4:7], s44 offen lds
s_add_u32 m0, s45, 12288
s_mov_b32 s44, 1572864
buffer_load_dwordx4 v16, s[4:7], s44 offen lds
s_add_u32 m0, s45, 13312
s_mov_b32 s44, 1703936
buffer_load_dwordx4 v16, s[4:7], s44 offen lds
s_add_u32 m0, s45, 14336
s_mov_b32 s44, 1835008
buffer_load_dwordx4 v16, s[4:7], s44 offen lds
s_add_u32 m0, s45, 15360
s_mov_b32 s44, 1966080
buffer_load_dwordx4 v16, s[4:7], s44 offen lds
s_mov_b32 s44, 2097152
buffer_load_dword v250, v12, s[4:7], s44 offen
s_add_u32 m0, s45, 16384
s_mov_b32 s44, 2097152
buffer_load_dwordx4 v16, s[4:7], s44 offen lds
s_add_u32 m0, s45, 17408
s_mov_b32 s44, 2228224
buffer_load_dwordx4 v16, s[4:7], s44 offen lds
s_add_u32 m0, s45, 18432
s_mov_b32 s44, 2359296
buffer_load_dwordx4 v16, s[4:7], s44 offen lds
s_add_u32 m0, s45, 19456
s_mov_b32 s44, 2490368
buffer_load_dwordx4 v16, s[4:7], s44 offen lds
s_add_u32 m0, s45, 20480
s_mov_b32 s44, 2621440
buffer_load_dwordx4 v16, s[4:7], s44 offen lds
s_add_u32 m0, s45, 21504
s_mov_b32 s44, 2752512
buffer_load_dwordx4 v16, s[4:7], s44 offen lds
s_add_u32 m0, s45, 22528
s_mov_b32 s44, 2883584
buffer_load_dwordx4 v16, s[4:7], s44 offen lds
s_add_u32 m0, s45, 23552
s_mov_b32 s44, 3014656
buffer_load_dwordx4 v16, s[4:7], s44 offen lds
s_waitcnt vmcnt(18)
s_barrier
ds_read_b64_tr_b16 a[0:1], v17 offset:0
ds_read_b64_tr_b16 a[2:3], v17 offset:256
ds_read_b64_tr_b16 a[4:5], v17 offset:32
ds_read_b64_tr_b16 a[6:7], v17 offset:288
ds_read_b64_tr_b16 a[8:9], v17 offset:2048
ds_read_b64_tr_b16 a[10:11], v17 offset:2304
ds_read_b64_tr_b16 a[12:13], v17 offset:2080
ds_read_b64_tr_b16 a[14:15], v17 offset:2336
s_waitcnt lgkmcnt(0)
ds_read_b64_tr_b16 a[16:17], v17 offset:4096
ds_read_b64_tr_b16 a[18:19], v17 offset:4352
ds_read_b64_tr_b16 a[20:21], v17 offset:4128
ds_read_b64_tr_b16 a[22:23], v17 offset:4384
ds_read_b64_tr_b16 a[24:25], v17 offset:6144
ds_read_b64_tr_b16 a[26:27], v17 offset:6400
ds_read_b64_tr_b16 a[28:29], v17 offset:6176
ds_read_b64_tr_b16 a[30:31], v17 offset:6432
s_waitcnt lgkmcnt(0)
s_mov_b32 s44, 3145728
buffer_load_dword v250, v12, s[4:7], s44 offen
s_add_u32 m0, s45, 0
s_mov_b32 s44, 3145728
buffer_load_dwordx4 v16, s[4:7], s44 offen lds
s_add_u32 m0, s45, 1024
s_mov_b32 s44, 3276800
buffer_load_dwordx4 v16, s[4:7], s44 offen lds
s_add_u32 m0, s45, 2048
s_mov_b32 s44, 3407872
buffer_load_dwordx4 v16, s[4:7], s44 offen lds
s_add_u32 m0, s45, 3072
s_mov_b32 s44, 3538944
buffer_load_dwordx4 v16, s[4:7], s44 offen lds
s_add_u32 m0, s45, 4096
s_mov_b32 s44, 3670016
buffer_load_dwordx4 v16, s[4:7], s44 offen lds
s_add_u32 m0, s45, 5120
s_mov_b32 s44, 3801088
buffer_load_dwordx4 v16, s[4:7], s44 offen lds
s_add_u32 m0, s45, 6144
s_mov_b32 s44, 3932160
buffer_load_dwordx4 v16, s[4:7], s44 offen lds
s_add_u32 m0, s45, 7168
s_mov_b32 s44, 4063232
buffer_load_dwordx4 v16, s[4:7], s44 offen lds
ds_read_b128 v[20:23], v8 offset:0
ds_read_b128 v[24:27], v8 offset:2048
ds_read_b128 v[28:31], v9 offset:0
ds_read_b128 v[32:35], v9 offset:2048
ds_read_b128 v[36:39], v8 offset:4096
ds_read_b128 v[40:43], v8 offset:6144
ds_read_b128 v[44:47], v9 offset:4096
ds_read_b128 v[48:51], v9 offset:6144
s_waitcnt lgkmcnt(0)
v_mfma_f32_16x16x32_bf16 v[52:55], v[20:23], a[0:3], 0
v_mfma_f32_16x16x32_bf16 v[56:59], v[20:23], a[4:7], 0
v_mfma_f32_16x16x32_bf16 v[60:63], v[24:27], a[0:3], 0
v_mfma_f32_16x16x32_bf16 v[64:67], v[24:27], a[4:7], 0
v_mfma_f32_16x16x32_bf16 v[52:55], v[28:31], a[8:11], v[52:55]
v_mfma_f32_16x16x32_bf16 v[56:59], v[28:31], a[12:15], v[56:59]
v_mfma_f32_16x16x32_bf16 v[60:63], v[32:35], a[8:11], v[60:63]
v_mfma_f32_16x16x32_bf16 v[64:67], v[32:35], a[12:15], v[64:67]
v_mfma_f32_16x16x32_bf16 v[52:55], v[36:39], a[16:19], v[52:55]
v_mfma_f32_16x16x32_bf16 v[56:59], v[36:39], a[20:23], v[56:59]
v_mfma_f32_16x16x32_bf16 v[60:63], v[40:43], a[16:19], v[60:63]
v_mfma_f32_16x16x32_bf16 v[64:67], v[40:43], a[20:23], v[64:67]
v_mfma_f32_16x16x32_bf16 v[52:55], v[44:47], a[24:27], v[52:55]
v_mfma_f32_16x16x32_bf16 v[56:59], v[44:47], a[28:31], v[56:59]
v_mfma_f32_16x16x32_bf16 v[60:63], v[48:51], a[24:27], v[60:63]
v_mfma_f32_16x16x32_bf16 v[64:67], v[48:51], a[28:31], v[64:67]
s_waitcnt vmcnt(18)
ds_read_b64_tr_b16 a[32:33], v17 offset:8192
ds_read_b64_tr_b16 a[34:35], v17 offset:8448
ds_read_b64_tr_b16 a[36:37], v17 offset:8224
ds_read_b64_tr_b16 a[38:39], v17 offset:8480
ds_read_b64_tr_b16 a[40:41], v17 offset:10240
ds_read_b64_tr_b16 a[42:43], v17 offset:10496
ds_read_b64_tr_b16 a[44:45], v17 offset:10272
ds_read_b64_tr_b16 a[46:47], v17 offset:10528
s_waitcnt lgkmcnt(0)
ds_read_b64_tr_b16 a[48:49], v17 offset:12288
ds_read_b64_tr_b16 a[50:51], v17 offset:12544
ds_read_b64_tr_b16 a[52:53], v17 offset:12320
ds_read_b64_tr_b16 a[54:55], v17 offset:12576
ds_read_b64_tr_b16 a[56:57], v17 offset:14336
ds_read_b64_tr_b16 a[58:59], v17 offset:14592
ds_read_b64_tr_b16 a[60:61], v17 offset:14368
ds_read_b64_tr_b16 a[62:63], v17 offset:14624
s_waitcnt lgkmcnt(0)
s_mov_b32 s44, 4194304
buffer_load_dword v250, v12, s[4:7], s44 offen
s_add_u32 m0, s45, 8192
s_mov_b32 s44, 4194304
buffer_load_dwordx4 v16, s[4:7], s44 offen lds
s_add_u32 m0, s45, 9216
s_mov_b32 s44, 4325376
buffer_load_dwordx4 v16, s[4:7], s44 offen lds
s_add_u32 m0, s45, 10240
s_mov_b32 s44, 4456448
buffer_load_dwordx4 v16, s[4:7], s44 offen lds
s_add_u32 m0, s45, 11264
s_mov_b32 s44, 4587520
buffer_load_dwordx4 v16, s[4:7], s44 offen lds
s_add_u32 m0, s45, 12288
s_mov_b32 s44, 4718592
buffer_load_dwordx4 v16, s[4:7], s44 offen lds
s_add_u32 m0, s45, 13312
s_mov_b32 s44, 4849664
buffer_load_dwordx4 v16, s[4:7], s44 offen lds
s_add_u32 m0, s45, 14336
s_mov_b32 s44, 4980736
buffer_load_dwordx4 v16, s[4:7], s44 offen lds
s_add_u32 m0, s45, 15360
s_mov_b32 s44, 5111808
buffer_load_dwordx4 v16, s[4:7], s44 offen lds
ds_read_b128 v[20:23], v8 offset:8192
ds_read_b128 v[24:27], v8 offset:10240
ds_read_b128 v[28:31], v9 offset:8192
ds_read_b128 v[32:35], v9 offset:10240
ds_read_b128 v[36:39], v8 offset:12288
ds_read_b128 v[40:43], v8 offset:14336
ds_read_b128 v[44:47], v9 offset:12288
ds_read_b128 v[48:51], v9 offset:14336
s_waitcnt lgkmcnt(0)
v_mfma_f32_16x16x32_bf16 v[52:55], v[20:23], a[32:35], v[52:55]
v_mfma_f32_16x16x32_bf16 v[56:59], v[20:23], a[36:39], v[56:59]
v_mfma_f32_16x16x32_bf16 v[60:63], v[24:27], a[32:35], v[60:63]
v_mfma_f32_16x16x32_bf16 v[64:67], v[24:27], a[36:39], v[64:67]
v_mfma_f32_16x16x32_bf16 v[52:55], v[28:31], a[40:43], v[52:55]
v_mfma_f32_16x16x32_bf16 v[56:59], v[28:31], a[44:47], v[56:59]
v_mfma_f32_16x16x32_bf16 v[60:63], v[32:35], a[40:43], v[60:63]
v_mfma_f32_16x16x32_bf16 v[64:67], v[32:35], a[44:47], v[64:67]
v_mfma_f32_16x16x32_bf16 v[52:55], v[36:39], a[48:51], v[52:55]
v_mfma_f32_16x16x32_bf16 v[56:59], v[36:39], a[52:55], v[56:59]
v_mfma_f32_16x16x32_bf16 v[60:63], v[40:43], a[48:51], v[60:63]
v_mfma_f32_16x16x32_bf16 v[64:67], v[40:43], a[52:55], v[64:67]
v_mfma_f32_16x16x32_bf16 v[52:55], v[44:47], a[56:59], v[52:55]
v_mfma_f32_16x16x32_bf16 v[56:59], v[44:47], a[60:63], v[56:59]
v_mfma_f32_16x16x32_bf16 v[60:63], v[48:51], a[56:59], v[60:63]
v_mfma_f32_16x16x32_bf16 v[64:67], v[48:51], a[60:63], v[64:67]
s_waitcnt vmcnt(18)
ds_read_b64_tr_b16 a[64:65], v17 offset:16384
ds_read_b64_tr_b16 a[66:67], v17 offset:16640
ds_read_b64_tr_b16 a[68:69], v17 offset:16416
ds_read_b64_tr_b16 a[70:71], v17 offset:16672
ds_read_b64_tr_b16 a[72:73], v17 offset:18432
ds_read_b64_tr_b16 a[74:75], v17 offset:18688
ds_read_b64_tr_b16 a[76:77], v17 offset:18464
ds_read_b64_tr_b16 a[78:79], v17 offset:18720
s_waitcnt lgkmcnt(0)
ds_read_b64_tr_b16 a[80:81], v17 offset:20480
ds_read_b64_tr_b16 a[82:83], v17 offset:20736
ds_read_b64_tr_b16 a[84:85], v17 offset:20512
ds_read_b64_tr_b16 a[86:87], v17 offset:20768
ds_read_b64_tr_b16 a[88:89], v17 offset:22528
ds_read_b64_tr_b16 a[90:91], v17 offset:22784
ds_read_b64_tr_b16 a[92:93], v17 offset:22560
ds_read_b64_tr_b16 a[94:95], v17 offset:22816
s_waitcnt lgkmcnt(0)
s_mov_b32 s44, 5242880
buffer_load_dword v250, v12, s[4:7], s44 offen
s_add_u32 m0, s45, 16384
s_mov_b32 s44, 5242880
buffer_load_dwordx4 v16, s[4:7], s44 offen lds
s_add_u32 m0, s45, 17408
s_mov_b32 s44, 5373952
buffer_load_dwordx4 v16, s[4:7], s44 offen lds
s_add_u32 m0, s45, 18432
s_mov_b32 s44, 5505024
buffer_load_dwordx4 v16, s[4:7], s44 offen lds
s_add_u32 m0, s45, 19456
s_mov_b32 s44, 5636096
buffer_load_dwordx4 v16, s[4:7], s44 offen lds
s_add_u32 m0, s45, 20480
s_mov_b32 s44, 5767168
buffer_load_dwordx4 v16, s[4:7], s44 offen lds
s_add_u32 m0, s45, 21504
s_mov_b32 s44, 5898240
buffer_load_dwordx4 v16, s[4:7], s44 offen lds
s_add_u32 m0, s45, 22528
s_mov_b32 s44, 6029312
buffer_load_dwordx4 v16, s[4:7], s44 offen lds
s_add_u32 m0, s45, 23552
s_mov_b32 s44, 6160384
buffer_load_dwordx4 v16, s[4:7], s44 offen lds
ds_read_b128 v[20:23], v8 offset:16384
ds_read_b128 v[24:27], v8 offset:18432
ds_read_b128 v[28:31], v9 offset:16384
ds_read_b128 v[32:35], v9 offset:18432
ds_read_b128 v[36:39], v8 offset:20480
ds_read_b128 v[40:43], v8 offset:22528
ds_read_b128 v[44:47], v9 offset:20480
ds_read_b128 v[48:51], v9 offset:22528
s_waitcnt lgkmcnt(0)
v_mfma_f32_16x16x32_bf16 v[52:55], v[20:23], a[64:67], v[52:55]
v_mfma_f32_16x16x32_bf16 v[56:59], v[20:23], a[68:71], v[56:59]
v_mfma_f32_16x16x32_bf16 v[60:63], v[24:27], a[64:67], v[60:63]
v_mfma_f32_16x16x32_bf16 v[64:67], v[24:27], a[68:71], v[64:67]
v_mfma_f32_16x16x32_bf16 v[52:55], v[28:31], a[72:75], v[52:55]
v_mfma_f32_16x16x32_bf16 v[56:59], v[28:31], a[76:79], v[56:59]
v_mfma_f32_16x16x32_bf16 v[60:63], v[32:35], a[72:75], v[60:63]
v_mfma_f32_16x16x32_bf16 v[64:67], v[32:35], a[76:79], v[64:67]
v_mfma_f32_16x16x32_bf16 v[52:55], v[36:39], a[80:83], v[52:55]
v_mfma_f32_16x16x32_bf16 v[56:59], v[36:39], a[84:87], v[56:59]
v_mfma_f32_16x16x32_bf16 v[60:63], v[40:43], a[80:83], v[60:63]
v_mfma_f32_16x16x32_bf16 v[64:67], v[40:43], a[84:87], v[64:67]
v_mfma_f32_16x16x32_bf16 v[52:55], v[44:47], a[88:91], v[52:55]
v_mfma_f32_16x16x32_bf16 v[56:59], v[44:47], a[92:95], v[56:59]
v_mfma_f32_16x16x32_bf16 v[60:63], v[48:51], a[88:91], v[60:63]
v_mfma_f32_16x16x32_bf16 v[64:67], v[48:51], a[92:95], v[64:67]
s_waitcnt vmcnt(18)
ds_read_b64_tr_b16 a[96:97], v17 offset:0
ds_read_b64_tr_b16 a[98:99], v17 offset:256
ds_read_b64_tr_b16 a[100:101], v17 offset:32
ds_read_b64_tr_b16 a[102:103], v17 offset:288
ds_read_b64_tr_b16 a[104:105], v17 offset:2048
ds_read_b64_tr_b16 a[106:107], v17 offset:2304
ds_read_b64_tr_b16 a[108:109], v17 offset:2080
ds_read_b64_tr_b16 a[110:111], v17 offset:2336
s_waitcnt lgkmcnt(0)
ds_read_b64_tr_b16 a[112:113], v17 offset:4096
ds_read_b64_tr_b16 a[114:115], v17 offset:4352
ds_read_b64_tr_b16 a[116:117], v17 offset:4128
ds_read_b64_tr_b16 a[118:119], v17 offset:4384
ds_read_b64_tr_b16 a[120:121], v17 offset:6144
ds_read_b64_tr_b16 a[122:123], v17 offset:6400
ds_read_b64_tr_b16 a[124:125], v17 offset:6176
ds_read_b64_tr_b16 a[126:127], v17 offset:6432
s_waitcnt lgkmcnt(0)
s_mov_b32 s44, 6291456
buffer_load_dword v250, v12, s[4:7], s44 offen
s_add_u32 m0, s45, 0
s_mov_b32 s44, 6291456
buffer_load_dwordx4 v16, s[4:7], s44 offen lds
s_add_u32 m0, s45, 1024
s_mov_b32 s44, 6422528
buffer_load_dwordx4 v16, s[4:7], s44 offen lds
s_add_u32 m0, s45, 2048
s_mov_b32 s44, 6553600
buffer_load_dwordx4 v16, s[4:7], s44 offen lds
s_add_u32 m0, s45, 3072
s_mov_b32 s44, 6684672
buffer_load_dwordx4 v16, s[4:7], s44 offen lds
s_add_u32 m0, s45, 4096
s_mov_b32 s44, 6815744
buffer_load_dwordx4 v16, s[4:7], s44 offen lds
s_add_u32 m0, s45, 5120
s_mov_b32 s44, 6946816
buffer_load_dwordx4 v16, s[4:7], s44 offen lds
s_add_u32 m0, s45, 6144
s_mov_b32 s44, 7077888
buffer_load_dwordx4 v16, s[4:7], s44 offen lds
s_add_u32 m0, s45, 7168
s_mov_b32 s44, 7208960
buffer_load_dwordx4 v16, s[4:7], s44 offen lds
ds_read_b128 v[20:23], v8 offset:24576
ds_read_b128 v[24:27], v8 offset:26624
ds_read_b128 v[28:31], v9 offset:24576
ds_read_b128 v[32:35], v9 offset:26624
ds_read_b128 v[36:39], v8 offset:28672
ds_read_b128 v[40:43], v8 offset:30720
ds_read_b128 v[44:47], v9 offset:28672
ds_read_b128 v[48:51], v9 offset:30720
s_waitcnt lgkmcnt(0)
v_mfma_f32_16x16x32_bf16 v[52:55], v[20:23], a[96:99], v[52:55]
v_mfma_f32_16x16x32_bf16 v[56:59], v[20:23], a[100:103], v[56:59]
v_mfma_f32_16x16x32_bf16 v[60:63], v[24:27], a[96:99], v[60:63]
v_mfma_f32_16x16x32_bf16 v[64:67], v[24:27], a[100:103], v[64:67]
v_mfma_f32_16x16x32_bf16 v[52:55], v[28:31], a[104:107], v[52:55]
v_mfma_f32_16x16x32_bf16 v[56:59], v[28:31], a[108:111], v[56:59]
v_mfma_f32_16x16x32_bf16 v[60:63], v[32:35], a[104:107], v[60:63]
v_mfma_f32_16x16x32_bf16 v[64:67], v[32:35], a[108:111], v[64:67]
v_mfma_f32_16x16x32_bf16 v[52:55], v[36:39], a[112:115], v[52:55]
v_mfma_f32_16x16x32_bf16 v[56:59], v[36:39], a[116:119], v[56:59]
v_mfma_f32_16x16x32_bf16 v[60:63], v[40:43], a[112:115], v[60:63]
v_mfma_f32_16x16x32_bf16 v[64:67], v[40:43], a[116:119], v[64:67]
v_mfma_f32_16x16x32_bf16 v[52:55], v[44:47], a[120:123], v[52:55]
v_mfma_f32_16x16x32_bf16 v[56:59], v[44:47], a[124:127], v[56:59]
v_mfma_f32_16x16x32_bf16 v[60:63], v[48:51], a[120:123], v[60:63]
v_mfma_f32_16x16x32_bf16 v[64:67], v[48:51], a[124:127], v[64:67]
s_waitcnt vmcnt(18)
ds_read_b64_tr_b16 a[128:129], v17 offset:8192
ds_read_b64_tr_b16 a[130:131], v17 offset:8448
ds_read_b64_tr_b16 a[132:133], v17 offset:8224
ds_read_b64_tr_b16 a[134:135], v17 offset:8480
ds_read_b64_tr_b16 a[136:137], v17 offset:10240
ds_read_b64_tr_b16 a[138:139], v17 offset:10496
ds_read_b64_tr_b16 a[140:141], v17 offset:10272
ds_read_b64_tr_b16 a[142:143], v17 offset:10528
s_waitcnt lgkmcnt(0)
ds_read_b64_tr_b16 a[144:145], v17 offset:12288
ds_read_b64_tr_b16 a[146:147], v17 offset:12544
ds_read_b64_tr_b16 a[148:149], v17 offset:12320
ds_read_b64_tr_b16 a[150:151], v17 offset:12576
ds_read_b64_tr_b16 a[152:153], v17 offset:14336
ds_read_b64_tr_b16 a[154:155], v17 offset:14592
ds_read_b64_tr_b16 a[156:157], v17 offset:14368
ds_read_b64_tr_b16 a[158:159], v17 offset:14624
s_waitcnt lgkmcnt(0)
s_mov_b32 s44, 7340032
buffer_load_dword v250, v12, s[4:7], s44 offen
s_add_u32 m0, s45, 8192
s_mov_b32 s44, 7340032
buffer_load_dwordx4 v16, s[4:7], s44 offen lds
s_add_u32 m0, s45, 9216
s_mov_b32 s44, 7471104
buffer_load_dwordx4 v16, s[4:7], s44 offen lds
s_add_u32 m0, s45, 10240
s_mov_b32 s44, 7602176
buffer_load_dwordx4 v16, s[4:7], s44 offen lds
s_add_u32 m0, s45, 11264
s_mov_b32 s44, 7733248
buffer_load_dwordx4 v16, s[4:7], s44 offen lds
s_add_u32 m0, s45, 12288
s_mov_b32 s44, 7864320
buffer_load_dwordx4 v16, s[4:7], s44 offen lds
s_add_u32 m0, s45, 13312
s_mov_b32 s44, 7995392
buffer_load_dwordx4 v16, s[4:7], s44 offen lds
s_add_u32 m0, s45, 14336
s_mov_b32 s44, 8126464
buffer_load_dwordx4 v16, s[4:7], s44 offen lds
s_add_u32 m0, s45, 15360
s_mov_b32 s44, 8257536
buffer_load_dwordx4 v16, s[4:7], s44 offen lds
ds_read_b128 v[20:23], v8 offset:32768
ds_read_b128 v[24:27], v8 offset:34816
ds_read_b128 v[28:31], v9 offset:32768
ds_read_b128 v[32:35], v9 offset:34816
ds_read_b128 v[36:39], v8 offset:36864
ds_read_b128 v[40:43], v8 offset:38912
ds_read_b128 v[44:47], v9 offset:36864
ds_read_b128 v[48:51], v9 offset:38912
s_waitcnt lgkmcnt(0)
v_mfma_f32_16x16x32_bf16 v[52:55], v[20:23], a[128:131], v[52:55]
v_mfma_f32_16x16x32_bf16 v[56:59], v[20:23], a[132:135], v[56:59]
v_mfma_f32_16x16x32_bf16 v[60:63], v[24:27], a[128:131], v[60:63]
v_mfma_f32_16x16x32_bf16 v[64:67], v[24:27], a[132:135], v[64:67]
v_mfma_f32_16x16x32_bf16 v[52:55], v[28:31], a[136:139], v[52:55]
v_mfma_f32_16x16x32_bf16 v[56:59], v[28:31], a[140:143], v[56:59]
v_mfma_f32_16x16x32_bf16 v[60:63], v[32:35], a[136:139], v[60:63]
v_mfma_f32_16x16x32_bf16 v[64:67], v[32:35], a[140:143], v[64:67]
v_mfma_f32_16x16x32_bf16 v[52:55], v[36:39], a[144:147], v[52:55]
v_mfma_f32_16x16x32_bf16 v[56:59], v[36:39], a[148:151], v[56:59]
v_mfma_f32_16x16x32_bf16 v[60:63], v[40:43], a[144:147], v[60:63]
v_mfma_f32_16x16x32_bf16 v[64:67], v[40:43], a[148:151], v[64:67]
v_mfma_f32_16x16x32_bf16 v[52:55], v[44:47], a[152:155], v[52:55]
v_mfma_f32_16x16x32_bf16 v[56:59], v[44:47], a[156:159], v[56:59]
v_mfma_f32_16x16x32_bf16 v[60:63], v[48:51], a[152:155], v[60:63]
v_mfma_f32_16x16x32_bf16 v[64:67], v[48:51], a[156:159], v[64:67]
s_waitcnt vmcnt(18)
ds_read_b64_tr_b16 a[160:161], v17 offset:16384
ds_read_b64_tr_b16 a[162:163], v17 offset:16640
ds_read_b64_tr_b16 a[164:165], v17 offset:16416
ds_read_b64_tr_b16 a[166:167], v17 offset:16672
ds_read_b64_tr_b16 a[168:169], v17 offset:18432
ds_read_b64_tr_b16 a[170:171], v17 offset:18688
ds_read_b64_tr_b16 a[172:173], v17 offset:18464
ds_read_b64_tr_b16 a[174:175], v17 offset:18720
s_waitcnt lgkmcnt(0)
ds_read_b64_tr_b16 a[176:177], v17 offset:20480
ds_read_b64_tr_b16 a[178:179], v17 offset:20736
ds_read_b64_tr_b16 a[180:181], v17 offset:20512
ds_read_b64_tr_b16 a[182:183], v17 offset:20768
ds_read_b64_tr_b16 a[184:185], v17 offset:22528
ds_read_b64_tr_b16 a[186:187], v17 offset:22784
ds_read_b64_tr_b16 a[188:189], v17 offset:22560
ds_read_b64_tr_b16 a[190:191], v17 offset:22816
s_waitcnt lgkmcnt(0)
ds_read_b128 v[20:23], v8 offset:40960
ds_read_b128 v[24:27], v8 offset:43008
ds_read_b128 v[28:31], v9 offset:40960
ds_read_b128 v[32:35], v9 offset:43008
ds_read_b128 v[36:39], v8 offset:45056
ds_read_b128 v[40:43], v8 offset:47104
ds_read_b128 v[44:47], v9 offset:45056
ds_read_b128 v[48:51], v9 offset:47104
s_waitcnt lgkmcnt(0)
v_mfma_f32_16x16x32_bf16 v[52:55], v[20:23], a[160:163], v[52:55]
v_mfma_f32_16x16x32_bf16 v[56:59], v[20:23], a[164:167], v[56:59]
v_mfma_f32_16x16x32_bf16 v[60:63], v[24:27], a[160:163], v[60:63]
v_mfma_f32_16x16x32_bf16 v[64:67], v[24:27], a[164:167], v[64:67]
v_mfma_f32_16x16x32_bf16 v[52:55], v[28:31], a[168:171], v[52:55]
v_mfma_f32_16x16x32_bf16 v[56:59], v[28:31], a[172:175], v[56:59]
v_mfma_f32_16x16x32_bf16 v[60:63], v[32:35], a[168:171], v[60:63]
v_mfma_f32_16x16x32_bf16 v[64:67], v[32:35], a[172:175], v[64:67]
v_mfma_f32_16x16x32_bf16 v[52:55], v[36:39], a[176:179], v[52:55]
v_mfma_f32_16x16x32_bf16 v[56:59], v[36:39], a[180:183], v[56:59]
v_mfma_f32_16x16x32_bf16 v[60:63], v[40:43], a[176:179], v[60:63]
v_mfma_f32_16x16x32_bf16 v[64:67], v[40:43], a[180:183], v[64:67]
v_mfma_f32_16x16x32_bf16 v[52:55], v[44:47], a[184:187], v[52:55]
v_mfma_f32_16x16x32_bf16 v[56:59], v[44:47], a[188:191], v[56:59]
v_mfma_f32_16x16x32_bf16 v[60:63], v[48:51], a[184:187], v[60:63]
v_mfma_f32_16x16x32_bf16 v[64:67], v[48:51], a[188:191], v[64:67]
s_waitcnt vmcnt(9)
ds_read_b64_tr_b16 a[192:193], v17 offset:0
ds_read_b64_tr_b16 a[194:195], v17 offset:256
ds_read_b64_tr_b16 a[196:197], v17 offset:32
ds_read_b64_tr_b16 a[198:199], v17 offset:288
ds_read_b64_tr_b16 a[200:201], v17 offset:2048
ds_read_b64_tr_b16 a[202:203], v17 offset:2304
ds_read_b64_tr_b16 a[204:205], v17 offset:2080
ds_read_b64_tr_b16 a[206:207], v17 offset:2336
s_waitcnt lgkmcnt(0)
ds_read_b64_tr_b16 a[208:209], v17 offset:4096
ds_read_b64_tr_b16 a[210:211], v17 offset:4352
ds_read_b64_tr_b16 a[212:213], v17 offset:4128
ds_read_b64_tr_b16 a[214:215], v17 offset:4384
ds_read_b64_tr_b16 a[216:217], v17 offset:6144
ds_read_b64_tr_b16 a[218:219], v17 offset:6400
ds_read_b64_tr_b16 a[220:221], v17 offset:6176
ds_read_b64_tr_b16 a[222:223], v17 offset:6432
s_waitcnt lgkmcnt(0)
ds_read_b128 v[20:23], v8 offset:49152
ds_read_b128 v[24:27], v8 offset:51200
ds_read_b128 v[28:31], v9 offset:49152
ds_read_b128 v[32:35], v9 offset:51200
ds_read_b128 v[36:39], v8 offset:53248
ds_read_b128 v[40:43], v8 offset:55296
ds_read_b128 v[44:47], v9 offset:53248
ds_read_b128 v[48:51], v9 offset:55296
s_waitcnt lgkmcnt(0)
v_mfma_f32_16x16x32_bf16 v[52:55], v[20:23], a[192:195], v[52:55]
v_mfma_f32_16x16x32_bf16 v[56:59], v[20:23], a[196:199], v[56:59]
v_mfma_f32_16x16x32_bf16 v[60:63], v[24:27], a[192:195], v[60:63]
v_mfma_f32_16x16x32_bf16 v[64:67], v[24:27], a[196:199], v[64:67]
v_mfma_f32_16x16x32_bf16 v[52:55], v[28:31], a[200:203], v[52:55]
v_mfma_f32_16x16x32_bf16 v[56:59], v[28:31], a[204:207], v[56:59]
v_mfma_f32_16x16x32_bf16 v[60:63], v[32:35], a[200:203], v[60:63]
v_mfma_f32_16x16x32_bf16 v[64:67], v[32:35], a[204:207], v[64:67]
v_mfma_f32_16x16x32_bf16 v[52:55], v[36:39], a[208:211], v[52:55]
v_mfma_f32_16x16x32_bf16 v[56:59], v[36:39], a[212:215], v[56:59]
v_mfma_f32_16x16x32_bf16 v[60:63], v[40:43], a[208:211], v[60:63]
v_mfma_f32_16x16x32_bf16 v[64:67], v[40:43], a[212:215], v[64:67]
v_mfma_f32_16x16x32_bf16 v[52:55], v[44:47], a[216:219], v[52:55]
v_mfma_f32_16x16x32_bf16 v[56:59], v[44:47], a[220:223], v[56:59]
v_mfma_f32_16x16x32_bf16 v[60:63], v[48:51], a[216:219], v[60:63]
v_mfma_f32_16x16x32_bf16 v[64:67], v[48:51], a[220:223], v[64:67]
s_waitcnt vmcnt(0)
ds_read_b64_tr_b16 a[224:225], v17 offset:8192
ds_read_b64_tr_b16 a[226:227], v17 offset:8448
ds_read_b64_tr_b16 a[228:229], v17 offset:8224
ds_read_b64_tr_b16 a[230:231], v17 offset:8480
ds_read_b64_tr_b16 a[232:233], v17 offset:10240
ds_read_b64_tr_b16 a[234:235], v17 offset:10496
ds_read_b64_tr_b16 a[236:237], v17 offset:10272
ds_read_b64_tr_b16 a[238:239], v17 offset:10528
s_waitcnt lgkmcnt(0)
ds_read_b64_tr_b16 a[240:241], v17 offset:12288
ds_read_b64_tr_b16 a[242:243], v17 offset:12544
ds_read_b64_tr_b16 a[244:245], v17 offset:12320
ds_read_b64_tr_b16 a[246:247], v17 offset:12576
ds_read_b64_tr_b16 a[248:249], v17 offset:14336
ds_read_b64_tr_b16 a[250:251], v17 offset:14592
ds_read_b64_tr_b16 a[252:253], v17 offset:14368
ds_read_b64_tr_b16 a[254:255], v17 offset:14624
s_waitcnt lgkmcnt(0)
ds_read_b128 v[20:23], v8 offset:57344
ds_read_b128 v[24:27], v8 offset:59392
ds_read_b128 v[28:31], v9 offset:57344
ds_read_b128 v[32:35], v9 offset:59392
ds_read_b128 v[36:39], v8 offset:61440
ds_read_b128 v[40:43], v8 offset:63488
ds_read_b128 v[44:47], v9 offset:61440
ds_read_b128 v[48:51], v9 offset:63488
s_waitcnt lgkmcnt(0)
v_mfma_f32_16x16x32_bf16 v[52:55], v[20:23], a[224:227], v[52:55]
v_mfma_f32_16x16x32_bf16 v[56:59], v[20:23], a[228:231], v[56:59]
v_mfma_f32_16x16x32_bf16 v[60:63], v[24:27], a[224:227], v[60:63]
v_mfma_f32_16x16x32_bf16 v[64:67], v[24:27], a[228:231], v[64:67]
v_mfma_f32_16x16x32_bf16 v[52:55], v[28:31], a[232:235], v[52:55]
v_mfma_f32_16x16x32_bf16 v[56:59], v[28:31], a[236:239], v[56:59]
v_mfma_f32_16x16x32_bf16 v[60:63], v[32:35], a[232:235], v[60:63]
v_mfma_f32_16x16x32_bf16 v[64:67], v[32:35], a[236:239], v[64:67]
v_mfma_f32_16x16x32_bf16 v[52:55], v[36:39], a[240:243], v[52:55]
v_mfma_f32_16x16x32_bf16 v[56:59], v[36:39], a[244:247], v[56:59]
v_mfma_f32_16x16x32_bf16 v[60:63], v[40:43], a[240:243], v[60:63]
v_mfma_f32_16x16x32_bf16 v[64:67], v[40:43], a[244:247], v[64:67]
v_mfma_f32_16x16x32_bf16 v[52:55], v[44:47], a[248:251], v[52:55]
v_mfma_f32_16x16x32_bf16 v[56:59], v[44:47], a[252:255], v[56:59]
v_mfma_f32_16x16x32_bf16 v[60:63], v[48:51], a[248:251], v[60:63]
v_mfma_f32_16x16x32_bf16 v[64:67], v[48:51], a[252:255], v[64:67]
s_barrier
s_mov_b32 s50, 0x10000
s_add_u32 m0, s46, 65536
s_nop 0
buffer_load_dwordx4 v6, s[8:11], s50 offen offset:0 lds
s_add_u32 m0, s46, 69504
s_nop 0
buffer_load_dwordx4 v6, s[8:11], s50 offen offset:128 lds
s_add_u32 m0, s46, 73472
s_nop 0
buffer_load_dwordx4 v6, s[8:11], s50 offen offset:256 lds
s_add_u32 m0, s46, 77440
s_nop 0
buffer_load_dwordx4 v6, s[8:11], s50 offen offset:384 lds
s_add_u32 m0, s46, 81408
s_nop 0
buffer_load_dwordx4 v6, s[8:11], s50 offen offset:512 lds
s_add_u32 m0, s46, 85376
s_nop 0
buffer_load_dwordx4 v6, s[8:11], s50 offen offset:640 lds
s_add_u32 m0, s46, 89344
s_nop 0
buffer_load_dwordx4 v6, s[8:11], s50 offen offset:768 lds
s_add_u32 m0, s46, 93312
s_nop 0
buffer_load_dwordx4 v6, s[8:11], s50 offen offset:896 lds
s_add_u32 m0, s46, 97280
s_nop 0
buffer_load_dwordx4 v6, s[8:11], s50 offen offset:1024 lds
s_add_u32 m0, s46, 101248
s_nop 0
buffer_load_dwordx4 v6, s[8:11], s50 offen offset:1152 lds
s_add_u32 m0, s46, 105216
s_nop 0
buffer_load_dwordx4 v6, s[8:11], s50 offen offset:1280 lds
s_add_u32 m0, s46, 109184
s_nop 0
buffer_load_dwordx4 v6, s[8:11], s50 offen offset:1408 lds
s_add_u32 m0, s46, 113152
s_nop 0
buffer_load_dwordx4 v6, s[8:11], s50 offen offset:1536 lds
s_add_u32 m0, s46, 117120
s_nop 0
buffer_load_dwordx4 v6, s[8:11], s50 offen offset:1664 lds
s_add_u32 m0, s46, 121088
s_nop 0
buffer_load_dwordx4 v6, s[8:11], s50 offen offset:1792 lds
s_add_u32 m0, s46, 125056
s_nop 0
buffer_load_dwordx4 v6, s[8:11], s50 offen offset:1920 lds
s_and_b32 s53, s47, 31
s_lshl_b32 s53, s53, 4
v_add_u32 v19, s53, v1
v_lshlrev_b32 v19, 7, v19
s_mov_b32 s42, 1
v_and_b32 v3, 15, v0
v_lshlrev_b32 v3, 4, v3
s_branch mega_kernel_syv
mega_kernel_syvw:
s_sleep 4
mega_kernel_syv:
buffer_load_dword v2, v3, s[72:75], 0 offen sc1
s_waitcnt vmcnt(0)
mega_kernel_syvp:
s_cmp_eq_u32 s95, 1
s_cbranch_scc0 mega_kernel_syvf
v_readlane_b32 s76, v2, 14
s_mov_b32 s98, 0
s_cmp_eq_u32 s76, 32
s_cbranch_scc0 mega_kernel_syvw
s_branch mega_kernel_syvd
mega_kernel_syvf:
s_mov_b32 s77, 0
s_mov_b32 s78, 0
v_readlane_b32 s76, v2, 0
s_add_u32 s77, s77, s76
s_xor_b32 s76, s76, 32
s_or_b32 s78, s78, s76
v_readlane_b32 s76, v2, 1
s_add_u32 s77, s77, s76
s_xor_b32 s76, s76, 32
s_or_b32 s78, s78, s76
v_readlane_b32 s76, v2, 2
s_add_u32 s77, s77, s76
s_xor_b32 s76, s76, 32
s_or_b32 s78, s78, s76
v_readlane_b32 s76, v2, 3
s_add_u32 s77, s77, s76
s_xor_b32 s76, s76, 32
s_or_b32 s78, s78, s76
v_readlane_b32 s76, v2, 4
s_add_u32 s77, s77, s76
s_xor_b32 s76, s76, 32
s_or_b32 s78, s78, s76
v_readlane_b32 s76, v2, 5
s_add_u32 s77, s77, s76
s_xor_b32 s76, s76, 32
s_or_b32 s78, s78, s76
v_readlane_b32 s76, v2, 6
s_add_u32 s77, s77, s76
s_xor_b32 s76, s76, 32
s_or_b32 s78, s78, s76
v_readlane_b32 s76, v2, 7
s_add_u32 s77, s77, s76
s_xor_b32 s76, s76, 32
s_or_b32 s78, s78, s76
s_cmp_eq_u32 s77, 256
s_cbranch_scc0 mega_kernel_syvw
v_mov_b32 v252, v2
s_cmp_eq_u32 s78, 0
s_cbranch_scc0 mega_kernel_slowent
v_readlane_b32 s76, v2, 10
v_readlane_b32 s77, v2, 8
s_cmp_eq_u32 s76, 32
s_cbranch_scc0 mega_kernel_syvw
s_cmp_gt_u32 s77, 16
s_cselect_b32 s98, 1, 0
mega_kernel_syvd:
s_lshr_b32 s44, s47, 3
s_xor_b32 s44, s44, s98
s_and_b32 s44, s44, 1
s_lshl_b32 s44, s44, 13
s_lshl_b32 s48, s47, 18
s_add_u32 s48, s48, s44
s_add_u32 s48, s48, 33554432
s_xor_b32 s44, s98, 1
s_lshl_b32 s44, s44, 13
s_lshl_b32 s49, s40, 7
s_add_u32 s49, s49, s44
s_lshl_b32 s44, s41, 2
s_add_u32 s49, s49, s44
s_add_u32 s49, s49, 69210112
v_mov_b32 v16, 0
v_cvt_pk_bf16_f32 v84, v52, v53
v_cvt_pk_bf16_f32 v85, v54, v55
v_cvt_pk_bf16_f32 v86, v60, v61
v_cvt_pk_bf16_f32 v87, v62, v63
v_cvt_pk_bf16_f32 v88, v56, v57
v_cvt_pk_bf16_f32 v89, v58, v59
v_cvt_pk_bf16_f32 v90, v64, v65
v_cvt_pk_bf16_f32 v91, v66, v67
s_add_u32 s51, s42, s47
s_sub_u32 s51, s51, 1
s_bfe_u32 s52, s51, 0x40002
s_lshl_b32 s52, s52, 14
s_and_b32 s51, s51, 3
s_lshl_b32 s51, s51, 11
s_add_u32 s51, s51, s52
s_add_u32 s51, s51, s48
buffer_store_dwordx4 v[84:87], v7, s[84:87], s51 offen sc1
buffer_store_dwordx4 v[88:91], v7, s[84:87], s51 offen offset:1024 sc1
s_waitcnt vmcnt(0)
v_mov_b32 v17, s42
s_mov_b64 exec, 1
buffer_store_dword v17, v16, s[84:87], s49 offen sc1
s_mov_b64 exec, -1
mega_kernel_v_loop:
s_waitcnt vmcnt(2)
s_barrier
s_add_u32 s50, s42, 1
s_min_u32 s50, s50, 63
s_lshl_b32 s50, s50, 16
ds_read_b128 v[20:23], v10 offset:0
ds_read_b128 v[24:27], v10 offset:2048
ds_read_b128 v[28:31], v11 offset:0
ds_read_b128 v[32:35], v11 offset:2048
ds_read_b128 v[36:39], v10 offset:4096
ds_read_b128 v[40:43], v10 offset:6144
s_waitcnt lgkmcnt(4)
v_mfma_f32_16x16x32_bf16 v[68:71], v[20:23], a[0:3], 0
ds_read_b128 v[44:47], v11 offset:4096
v_mfma_f32_16x16x32_bf16 v[72:75], v[20:23], a[4:7], 0
v_cvt_pk_bf16_f32 v84, v52, v53
v_cvt_pk_bf16_f32 v85, v54, v55
v_cvt_pk_bf16_f32 v86, v60, v61
v_mfma_f32_16x16x32_bf16 v[76:79], v[24:27], a[0:3], 0
ds_read_b128 v[48:51], v11 offset:6144
v_mfma_f32_16x16x32_bf16 v[80:83], v[24:27], a[4:7], 0
v_cvt_pk_bf16_f32 v87, v62, v63
v_cvt_pk_bf16_f32 v88, v56, v57
v_cvt_pk_bf16_f32 v89, v58, v59
s_waitcnt lgkmcnt(4)
v_mfma_f32_16x16x32_bf16 v[68:71], v[28:31], a[8:11], v[68:71]
ds_read_b128 v[20:23], v10 offset:8192
v_mfma_f32_16x16x32_bf16 v[72:75], v[28:31], a[12:15], v[72:75]
v_cvt_pk_bf16_f32 v90, v64, v65
v_cvt_pk_bf16_f32 v91, v66, v67
v_mfma_f32_16x16x32_bf16 v[76:79], v[32:35], a[8:11], v[76:79]
ds_read_b128 v[24:27], v10 offset:10240
v_mfma_f32_16x16x32_bf16 v[80:83], v[32:35], a[12:15], v[80:83]
s_add_u32 s51, s42, s47
s_sub_u32 s51, s51, 1
s_bfe_u32 s52, s51, 0x40002
s_lshl_b32 s52, s52, 14
s_waitcnt lgkmcnt(4)
v_mfma_f32_16x16x32_bf16 v[68:71], v[36:39], a[16:19], v[68:71]
ds_read_b128 v[28:31], v11 offset:8192
v_mfma_f32_16x16x32_bf16 v[72:75], v[36:39], a[20:23], v[72:75]
s_and_b32 s51, s51, 3
s_lshl_b32 s51, s51, 11
s_add_u32 s51, s51, s52
s_add_u32 s51, s51, s48
buffer_store_dwordx4 v[84:87], v7, s[84:87], s51 offen sc1
v_mfma_f32_16x16x32_bf16 v[76:79], v[40:43], a[16:19], v[76:79]
ds_read_b128 v[32:35], v11 offset:10240
v_mfma_f32_16x16x32_bf16 v[80:83], v[40:43], a[20:23], v[80:83]
buffer_store_dwordx4 v[88:91], v7, s[84:87], s51 offen offset:1024 sc1
s_waitcnt lgkmcnt(4)
v_mfma_f32_16x16x32_bf16 v[68:71], v[44:47], a[24:27], v[68:71]
ds_read_b128 v[36:39], v10 offset:12288
v_mfma_f32_16x16x32_bf16 v[72:75], v[44:47], a[28:31], v[72:75]
s_add_u32 m0, s46, 0
v_mfma_f32_16x16x32_bf16 v[76:79], v[48:51], a[24:27], v[76:79]
ds_read_b128 v[40:43], v10 offset:14336
v_mfma_f32_16x16x32_bf16 v[80:83], v[48:51], a[28:31], v[80:83]
buffer_load_dwordx4 v6, s[8:11], s50 offen offset:0 lds
s_waitcnt lgkmcnt(4)
v_mfma_f32_16x16x32_bf16 v[68:71], v[20:23], a[32:35], v[68:71]
ds_read_b128 v[44:47], v11 offset:12288
v_mfma_f32_16x16x32_bf16 v[72:75], v[20:23], a[36:39], v[72:75]
s_add_u32 m0, s46, 3968
v_mfma_f32_16x16x32_bf16 v[76:79], v[24:27], a[32:35], v[76:79]
ds_read_b128 v[48:51], v11 offset:14336
v_mfma_f32_16x16x32_bf16 v[80:83], v[24:27], a[36:39], v[80:83]
buffer_load_dwordx4 v6, s[8:11], s50 offen offset:128 lds
s_waitcnt lgkmcnt(4)
v_mfma_f32_16x16x32_bf16 v[68:71], v[28:31], a[40:43], v[68:71]
ds_read_b128 v[20:23], v10 offset:16384
v_mfma_f32_16x16x32_bf16 v[72:75], v[28:31], a[44:47], v[72:75]
s_add_u32 m0, s46, 7936
v_mfma_f32_16x16x32_bf16 v[76:79], v[32:35], a[40:43], v[76:79]
ds_read_b128 v[24:27], v10 offset:18432
v_mfma_f32_16x16x32_bf16 v[80:83], v[32:35], a[44:47], v[80:83]
buffer_load_dwordx4 v6, s[8:11], s50 offen offset:256 lds
s_waitcnt lgkmcnt(4)
v_mfma_f32_16x16x32_bf16 v[68:71], v[36:39], a[48:51], v[68:71]
ds_read_b128 v[28:31], v11 offset:16384
v_mfma_f32_16x16x32_bf16 v[72:75], v[36:39], a[52:55], v[72:75]
s_add_u32 m0, s46, 11904
v_mfma_f32_16x16x32_bf16 v[76:79], v[40:43], a[48:51], v[76:79]
ds_read_b128 v[32:35], v11 offset:18432
v_mfma_f32_16x16x32_bf16 v[80:83], v[40:43], a[52:55], v[80:83]
buffer_load_dwordx4 v6, s[8:11], s50 offen offset:384 lds
s_waitcnt lgkmcnt(4)
v_mfma_f32_16x16x32_bf16 v[68:71], v[44:47], a[56:59], v[68:71]
ds_read_b128 v[36:39], v10 offset:20480
v_mfma_f32_16x16x32_bf16 v[72:75], v[44:47], a[60:63], v[72:75]
s_add_u32 m0, s46, 15872
v_mfma_f32_16x16x32_bf16 v[76:79], v[48:51], a[56:59], v[76:79]
ds_read_b128 v[40:43], v10 offset:22528
v_mfma_f32_16x16x32_bf16 v[80:83], v[48:51], a[60:63], v[80:83]
buffer_load_dwordx4 v6, s[8:11], s50 offen offset:512 lds
s_waitcnt lgkmcnt(4)
v_mfma_f32_16x16x32_bf16 v[68:71], v[20:23], a[64:67], v[68:71]
ds_read_b128 v[44:47], v11 offset:20480
v_mfma_f32_16x16x32_bf16 v[72:75], v[20:23], a[68:71], v[72:75]
s_add_u32 m0, s46, 19840
v_mfma_f32_16x16x32_bf16 v[76:79], v[24:27], a[64:67], v[76:79]
ds_read_b128 v[48:51], v11 offset:22528
v_mfma_f32_16x16x32_bf16 v[80:83], v[24:27], a[68:71], v[80:83]
buffer_load_dwordx4 v6, s[8:11], s50 offen offset:640 lds
s_waitcnt lgkmcnt(4)
v_mfma_f32_16x16x32_bf16 v[68:71], v[28:31], a[72:75], v[68:71]
ds_read_b128 v[20:23], v10 offset:24576
v_mfma_f32_16x16x32_bf16 v[72:75], v[28:31], a[76:79], v[72:75]
s_add_u32 m0, s46, 23808
v_mfma_f32_16x16x32_bf16 v[76:79], v[32:35], a[72:75], v[76:79]
ds_read_b128 v[24:27], v10 offset:26624
v_mfma_f32_16x16x32_bf16 v[80:83], v[32:35], a[76:79], v[80:83]
buffer_load_dwordx4 v6, s[8:11], s50 offen offset:768 lds
s_waitcnt lgkmcnt(4)
v_mfma_f32_16x16x32_bf16 v[68:71], v[36:39], a[80:83], v[68:71]
ds_read_b128 v[28:31], v11 offset:24576
v_mfma_f32_16x16x32_bf16 v[72:75], v[36:39], a[84:87], v[72:75]
s_add_u32 m0, s46, 27776
v_mfma_f32_16x16x32_bf16 v[76:79], v[40:43], a[80:83], v[76:79]
ds_read_b128 v[32:35], v11 offset:26624
v_mfma_f32_16x16x32_bf16 v[80:83], v[40:43], a[84:87], v[80:83]
buffer_load_dwordx4 v6, s[8:11], s50 offen offset:896 lds
s_waitcnt lgkmcnt(4)
v_mfma_f32_16x16x32_bf16 v[68:71], v[44:47], a[88:91], v[68:71]
ds_read_b128 v[36:39], v10 offset:28672
v_mfma_f32_16x16x32_bf16 v[72:75], v[44:47], a[92:95], v[72:75]
s_add_u32 m0, s46, 31744
v_mfma_f32_16x16x32_bf16 v[76:79], v[48:51], a[88:91], v[76:79]
ds_read_b128 v[40:43], v10 offset:30720
v_mfma_f32_16x16x32_bf16 v[80:83], v[48:51], a[92:95], v[80:83]
buffer_load_dwordx4 v6, s[8:11], s50 offen offset:1024 lds
s_waitcnt lgkmcnt(4)
v_mfma_f32_16x16x32_bf16 v[68:71], v[20:23], a[96:99], v[68:71]
ds_read_b128 v[44:47], v11 offset:28672
v_mfma_f32_16x16x32_bf16 v[72:75], v[20:23], a[100:103], v[72:75]
s_add_u32 m0, s46, 35712
v_mfma_f32_16x16x32_bf16 v[76:79], v[24:27], a[96:99], v[76:79]
ds_read_b128 v[48:51], v11 offset:30720
v_mfma_f32_16x16x32_bf16 v[80:83], v[24:27], a[100:103], v[80:83]
buffer_load_dwordx4 v6, s[8:11], s50 offen offset:1152 lds
s_waitcnt lgkmcnt(4)
v_mfma_f32_16x16x32_bf16 v[68:71], v[28:31], a[104:107], v[68:71]
ds_read_b128 v[20:23], v10 offset:32768
v_mfma_f32_16x16x32_bf16 v[72:75], v[28:31], a[108:111], v[72:75]
s_add_u32 m0, s46, 39680
v_mfma_f32_16x16x32_bf16 v[76:79], v[32:35], a[104:107], v[76:79]
ds_read_b128 v[24:27], v10 offset:34816
v_mfma_f32_16x16x32_bf16 v[80:83], v[32:35], a[108:111], v[80:83]
buffer_load_dwordx4 v6, s[8:11], s50 offen offset:1280 lds
s_waitcnt lgkmcnt(4)
v_mfma_f32_16x16x32_bf16 v[68:71], v[36:39], a[112:115], v[68:71]
ds_read_b128 v[28:31], v11 offset:32768
v_mfma_f32_16x16x32_bf16 v[72:75], v[36:39], a[116:119], v[72:75]
s_add_u32 m0, s46, 43648
v_mfma_f32_16x16x32_bf16 v[76:79], v[40:43], a[112:115], v[76:79]
ds_read_b128 v[32:35], v11 offset:34816
v_mfma_f32_16x16x32_bf16 v[80:83], v[40:43], a[116:119], v[80:83]
buffer_load_dwordx4 v6, s[8:11], s50 offen offset:1408 lds
s_waitcnt lgkmcnt(4)
v_mfma_f32_16x16x32_bf16 v[68:71], v[44:47], a[120:123], v[68:71]
ds_read_b128 v[36:39], v10 offset:36864
v_mfma_f32_16x16x32_bf16 v[72:75], v[44:47], a[124:127], v[72:75]
s_add_u32 m0, s46, 47616
v_mfma_f32_16x16x32_bf16 v[76:79], v[48:51], a[120:123], v[76:79]
ds_read_b128 v[40:43], v10 offset:38912
v_mfma_f32_16x16x32_bf16 v[80:83], v[48:51], a[124:127], v[80:83]
buffer_load_dwordx4 v6, s[8:11], s50 offen offset:1536 lds
s_waitcnt lgkmcnt(4)
v_mfma_f32_16x16x32_bf16 v[68:71], v[20:23], a[128:131], v[68:71]
ds_read_b128 v[44:47], v11 offset:36864
v_mfma_f32_16x16x32_bf16 v[72:75], v[20:23], a[132:135], v[72:75]
s_add_u32 m0, s46, 51584
v_mfma_f32_16x16x32_bf16 v[76:79], v[24:27], a[128:131], v[76:79]
ds_read_b128 v[48:51], v11 offset:38912
v_mfma_f32_16x16x32_bf16 v[80:83], v[24:27], a[132:135], v[80:83]
buffer_load_dwordx4 v6, s[8:11], s50 offen offset:1664 lds
s_waitcnt lgkmcnt(4)
v_mfma_f32_16x16x32_bf16 v[68:71], v[28:31], a[136:139], v[68:71]
ds_read_b128 v[20:23], v10 offset:40960
v_mfma_f32_16x16x32_bf16 v[72:75], v[28:31], a[140:143], v[72:75]
s_add_u32 m0, s46, 55552
v_mfma_f32_16x16x32_bf16 v[76:79], v[32:35], a[136:139], v[76:79]
ds_read_b128 v[24:27], v10 offset:43008
v_mfma_f32_16x16x32_bf16 v[80:83], v[32:35], a[140:143], v[80:83]
buffer_load_dwordx4 v6, s[8:11], s50 offen offset:1792 lds
s_waitcnt lgkmcnt(4)
v_mfma_f32_16x16x32_bf16 v[68:71], v[36:39], a[144:147], v[68:71]
ds_read_b128 v[28:31], v11 offset:40960
v_mfma_f32_16x16x32_bf16 v[72:75], v[36:39], a[148:151], v[72:75]
s_add_u32 m0, s46, 59520
v_mfma_f32_16x16x32_bf16 v[76:79], v[40:43], a[144:147], v[76:79]
ds_read_b128 v[32:35], v11 offset:43008
v_mfma_f32_16x16x32_bf16 v[80:83], v[40:43], a[148:151], v[80:83]
buffer_load_dwordx4 v6, s[8:11], s50 offen offset:1920 lds
s_waitcnt lgkmcnt(4)
v_mfma_f32_16x16x32_bf16 v[68:71], v[44:47], a[152:155], v[68:71]
ds_read_b128 v[36:39], v10 offset:45056
v_mfma_f32_16x16x32_bf16 v[72:75], v[44:47], a[156:159], v[72:75]
v_mfma_f32_16x16x32_bf16 v[76:79], v[48:51], a[152:155], v[76:79]
ds_read_b128 v[40:43], v10 offset:47104
v_mfma_f32_16x16x32_bf16 v[80:83], v[48:51], a[156:159], v[80:83]
s_waitcnt lgkmcnt(4)
v_mfma_f32_16x16x32_bf16 v[68:71], v[20:23], a[160:163], v[68:71]
ds_read_b128 v[44:47], v11 offset:45056
v_mfma_f32_16x16x32_bf16 v[72:75], v[20:23], a[164:167], v[72:75]
v_mfma_f32_16x16x32_bf16 v[76:79], v[24:27], a[160:163], v[76:79]
ds_read_b128 v[48:51], v11 offset:47104
v_mfma_f32_16x16x32_bf16 v[80:83], v[24:27], a[164:167], v[80:83]
s_waitcnt lgkmcnt(4)
v_mfma_f32_16x16x32_bf16 v[68:71], v[28:31], a[168:171], v[68:71]
ds_read_b128 v[20:23], v10 offset:49152
v_mfma_f32_16x16x32_bf16 v[72:75], v[28:31], a[172:175], v[72:75]
s_waitcnt vmcnt(16)
v_mov_b32 v17, s42
s_mov_b64 exec, 1
buffer_store_dword v17, v16, s[84:87], s49 offen sc1
s_mov_b64 exec, -1
v_mfma_f32_16x16x32_bf16 v[76:79], v[32:35], a[168:171], v[76:79]
ds_read_b128 v[24:27], v10 offset:51200
v_mfma_f32_16x16x32_bf16 v[80:83], v[32:35], a[172:175], v[80:83]
s_waitcnt lgkmcnt(4)
v_mfma_f32_16x16x32_bf16 v[68:71], v[36:39], a[176:179], v[68:71]
ds_read_b128 v[28:31], v11 offset:49152
v_mfma_f32_16x16x32_bf16 v[72:75], v[36:39], a[180:183], v[72:75]
s_add_u32 s53, s42, 3
s_min_u32 s53, s53, 63
s_lshl_b32 s53, s53, 16
s_mov_b64 exec, 0xffff
buffer_load_dword v250, v19, s[8:11], s53 offen
s_mov_b64 exec, -1
v_mfma_f32_16x16x32_bf16 v[76:79], v[40:43], a[176:179], v[76:79]
ds_read_b128 v[32:35], v11 offset:51200
v_mfma_f32_16x16x32_bf16 v[80:83], v[40:43], a[180:183], v[80:83]
s_waitcnt lgkmcnt(4)
v_mfma_f32_16x16x32_bf16 v[68:71], v[44:47], a[184:187], v[68:71]
ds_read_b128 v[36:39], v10 offset:53248
v_mfma_f32_16x16x32_bf16 v[72:75], v[44:47], a[188:191], v[72:75]
v_mfma_f32_16x16x32_bf16 v[76:79], v[48:51], a[184:187], v[76:79]
ds_read_b128 v[40:43], v10 offset:55296
v_mfma_f32_16x16x32_bf16 v[80:83], v[48:51], a[188:191], v[80:83]
s_waitcnt lgkmcnt(4)
v_mfma_f32_16x16x32_bf16 v[68:71], v[20:23], a[192:195], v[68:71]
ds_read_b128 v[44:47], v11 offset:53248
v_mfma_f32_16x16x32_bf16 v[72:75], v[20:23], a[196:199], v[72:75]
v_mfma_f32_16x16x32_bf16 v[76:79], v[24:27], a[192:195], v[76:79]
ds_read_b128 v[48:51], v11 offset:55296
v_mfma_f32_16x16x32_bf16 v[80:83], v[24:27], a[196:199], v[80:83]
s_waitcnt lgkmcnt(4)
v_mfma_f32_16x16x32_bf16 v[68:71], v[28:31], a[200:203], v[68:71]
ds_read_b128 v[20:23], v10 offset:57344
v_mfma_f32_16x16x32_bf16 v[72:75], v[28:31], a[204:207], v[72:75]
v_mfma_f32_16x16x32_bf16 v[76:79], v[32:35], a[200:203], v[76:79]
ds_read_b128 v[24:27], v10 offset:59392
v_mfma_f32_16x16x32_bf16 v[80:83], v[32:35], a[204:207], v[80:83]
s_waitcnt lgkmcnt(4)
v_mfma_f32_16x16x32_bf16 v[68:71], v[36:39], a[208:211], v[68:71]
ds_read_b128 v[28:31], v11 offset:57344
v_mfma_f32_16x16x32_bf16 v[72:75], v[36:39], a[212:215], v[72:75]
v_mfma_f32_16x16x32_bf16 v[76:79], v[40:43], a[208:211], v[76:79]
ds_read_b128 v[32:35], v11 offset:59392
v_mfma_f32_16x16x32_bf16 v[80:83], v[40:43], a[212:215], v[80:83]
s_waitcnt lgkmcnt(4)
v_mfma_f32_16x16x32_bf16 v[68:71], v[44:47], a[216:219], v[68:71]
ds_read_b128 v[36:39], v10 offset:61440
v_mfma_f32_16x16x32_bf16 v[72:75], v[44:47], a[220:223], v[72:75]
v_mfma_f32_16x16x32_bf16 v[76:79], v[48:51], a[216:219], v[76:79]
ds_read_b128 v[40:43], v10 offset:63488
v_mfma_f32_16x16x32_bf16 v[80:83], v[48:51], a[220:223], v[80:83]
s_waitcnt lgkmcnt(4)
v_mfma_f32_16x16x32_bf16 v[68:71], v[20:23], a[224:227], v[68:71]
ds_read_b128 v[44:47], v11 offset:61440
v_mfma_f32_16x16x32_bf16 v[72:75], v[20:23], a[228:231], v[72:75]
v_mfma_f32_16x16x32_bf16 v[76:79], v[24:27], a[224:227], v[76:79]
ds_read_b128 v[48:51], v11 offset:63488
v_mfma_f32_16x16x32_bf16 v[80:83], v[24:27], a[228:231], v[80:83]
s_waitcnt lgkmcnt(5)
v_mfma_f32_16x16x32_bf16 v[68:71], v[28:31], a[232:235], v[68:71]
v_mfma_f32_16x16x32_bf16 v[72:75], v[28:31], a[236:239], v[72:75]
s_waitcnt lgkmcnt(4)
v_mfma_f32_16x16x32_bf16 v[76:79], v[32:35], a[232:235], v[76:79]
v_mfma_f32_16x16x32_bf16 v[80:83], v[32:35], a[236:239], v[80:83]
s_waitcnt lgkmcnt(3)
v_mfma_f32_16x16x32_bf16 v[68:71], v[36:39], a[240:243], v[68:71]
v_mfma_f32_16x16x32_bf16 v[72:75], v[36:39], a[244:247], v[72:75]
s_waitcnt lgkmcnt(2)
v_mfma_f32_16x16x32_bf16 v[76:79], v[40:43], a[240:243], v[76:79]
v_mfma_f32_16x16x32_bf16 v[80:83], v[40:43], a[244:247], v[80:83]
s_waitcnt lgkmcnt(1)
v_mfma_f32_16x16x32_bf16 v[68:71], v[44:47], a[248:251], v[68:71]
v_mfma_f32_16x16x32_bf16 v[72:75], v[44:47], a[252:255], v[72:75]
s_waitcnt lgkmcnt(0)
v_mfma_f32_16x16x32_bf16 v[76:79], v[48:51], a[248:251], v[76:79]
v_mfma_f32_16x16x32_bf16 v[80:83], v[48:51], a[252:255], v[80:83]
s_add_u32 s42, s42, 1
s_cmp_eq_u32 s42, 64
s_cbranch_scc1 mega_kernel_v_fin
mega_kernel_v_mid:
s_waitcnt vmcnt(2)
s_barrier
s_add_u32 s50, s42, 1
s_min_u32 s50, s50, 63
s_lshl_b32 s50, s50, 16
ds_read_b128 v[20:23], v8 offset:0
ds_read_b128 v[24:27], v8 offset:2048
ds_read_b128 v[28:31], v9 offset:0
ds_read_b128 v[32:35], v9 offset:2048
ds_read_b128 v[36:39], v8 offset:4096
ds_read_b128 v[40:43], v8 offset:6144
s_waitcnt lgkmcnt(4)
v_mfma_f32_16x16x32_bf16 v[52:55], v[20:23], a[0:3], 0
ds_read_b128 v[44:47], v9 offset:4096
v_mfma_f32_16x16x32_bf16 v[56:59], v[20:23], a[4:7], 0
v_cvt_pk_bf16_f32 v84, v68, v69
v_cvt_pk_bf16_f32 v85, v70, v71
v_cvt_pk_bf16_f32 v86, v76, v77
v_mfma_f32_16x16x32_bf16 v[60:63], v[24:27], a[0:3], 0
ds_read_b128 v[48:51], v9 offset:6144
v_mfma_f32_16x16x32_bf16 v[64:67], v[24:27], a[4:7], 0
v_cvt_pk_bf16_f32 v87, v78, v79
v_cvt_pk_bf16_f32 v88, v72, v73
v_cvt_pk_bf16_f32 v89, v74, v75
s_waitcnt lgkmcnt(4)
v_mfma_f32_16x16x32_bf16 v[52:55], v[28:31], a[8:11], v[52:55]
ds_read_b128 v[20:23], v8 offset:8192
v_mfma_f32_16x16x32_bf16 v[56:59], v[28:31], a[12:15], v[56:59]
v_cvt_pk_bf16_f32 v90, v80, v81
v_cvt_pk_bf16_f32 v91, v82, v83
v_mfma_f32_16x16x32_bf16 v[60:63], v[32:35], a[8:11], v[60:63]
ds_read_b128 v[24:27], v8 offset:10240
v_mfma_f32_16x16x32_bf16 v[64:67], v[32:35], a[12:15], v[64:67]
s_add_u32 s51, s42, s47
s_sub_u32 s51, s51, 1
s_bfe_u32 s52, s51, 0x40002
s_lshl_b32 s52, s52, 14
s_waitcnt lgkmcnt(4)
v_mfma_f32_16x16x32_bf16 v[52:55], v[36:39], a[16:19], v[52:55]
ds_read_b128 v[28:31], v9 offset:8192
v_mfma_f32_16x16x32_bf16 v[56:59], v[36:39], a[20:23], v[56:59]
s_and_b32 s51, s51, 3
s_lshl_b32 s51, s51, 11
s_add_u32 s51, s51, s52
s_add_u32 s51, s51, s48
buffer_store_dwordx4 v[84:87], v7, s[84:87], s51 offen sc1
v_mfma_f32_16x16x32_bf16 v[60:63], v[40:43], a[16:19], v[60:63]
ds_read_b128 v[32:35], v9 offset:10240
v_mfma_f32_16x16x32_bf16 v[64:67], v[40:43], a[20:23], v[64:67]
buffer_store_dwordx4 v[88:91], v7, s[84:87], s51 offen offset:1024 sc1
s_waitcnt lgkmcnt(4)
v_mfma_f32_16x16x32_bf16 v[52:55], v[44:47], a[24:27], v[52:55]
ds_read_b128 v[36:39], v8 offset:12288
v_mfma_f32_16x16x32_bf16 v[56:59], v[44:47], a[28:31], v[56:59]
s_add_u32 m0, s46, 65536
v_mfma_f32_16x16x32_bf16 v[60:63], v[48:51], a[24:27], v[60:63]
ds_read_b128 v[40:43], v8 offset:14336
v_mfma_f32_16x16x32_bf16 v[64:67], v[48:51], a[28:31], v[64:67]
buffer_load_dwordx4 v6, s[8:11], s50 offen offset:0 lds
s_waitcnt lgkmcnt(4)
v_mfma_f32_16x16x32_bf16 v[52:55], v[20:23], a[32:35], v[52:55]
ds_read_b128 v[44:47], v9 offset:12288
v_mfma_f32_16x16x32_bf16 v[56:59], v[20:23], a[36:39], v[56:59]
s_add_u32 m0, s46, 69504
v_mfma_f32_16x16x32_bf16 v[60:63], v[24:27], a[32:35], v[60:63]
ds_read_b128 v[48:51], v9 offset:14336
v_mfma_f32_16x16x32_bf16 v[64:67], v[24:27], a[36:39], v[64:67]
buffer_load_dwordx4 v6, s[8:11], s50 offen offset:128 lds
s_waitcnt lgkmcnt(4)
v_mfma_f32_16x16x32_bf16 v[52:55], v[28:31], a[40:43], v[52:55]
ds_read_b128 v[20:23], v8 offset:16384
v_mfma_f32_16x16x32_bf16 v[56:59], v[28:31], a[44:47], v[56:59]
s_add_u32 m0, s46, 73472
v_mfma_f32_16x16x32_bf16 v[60:63], v[32:35], a[40:43], v[60:63]
ds_read_b128 v[24:27], v8 offset:18432
v_mfma_f32_16x16x32_bf16 v[64:67], v[32:35], a[44:47], v[64:67]
buffer_load_dwordx4 v6, s[8:11], s50 offen offset:256 lds
s_waitcnt lgkmcnt(4)
v_mfma_f32_16x16x32_bf16 v[52:55], v[36:39], a[48:51], v[52:55]
ds_read_b128 v[28:31], v9 offset:16384
v_mfma_f32_16x16x32_bf16 v[56:59], v[36:39], a[52:55], v[56:59]
s_add_u32 m0, s46, 77440
v_mfma_f32_16x16x32_bf16 v[60:63], v[40:43], a[48:51], v[60:63]
ds_read_b128 v[32:35], v9 offset:18432
v_mfma_f32_16x16x32_bf16 v[64:67], v[40:43], a[52:55], v[64:67]
buffer_load_dwordx4 v6, s[8:11], s50 offen offset:384 lds
s_waitcnt lgkmcnt(4)
v_mfma_f32_16x16x32_bf16 v[52:55], v[44:47], a[56:59], v[52:55]
ds_read_b128 v[36:39], v8 offset:20480
v_mfma_f32_16x16x32_bf16 v[56:59], v[44:47], a[60:63], v[56:59]
s_add_u32 m0, s46, 81408
v_mfma_f32_16x16x32_bf16 v[60:63], v[48:51], a[56:59], v[60:63]
ds_read_b128 v[40:43], v8 offset:22528
v_mfma_f32_16x16x32_bf16 v[64:67], v[48:51], a[60:63], v[64:67]
buffer_load_dwordx4 v6, s[8:11], s50 offen offset:512 lds
s_waitcnt lgkmcnt(4)
v_mfma_f32_16x16x32_bf16 v[52:55], v[20:23], a[64:67], v[52:55]
ds_read_b128 v[44:47], v9 offset:20480
v_mfma_f32_16x16x32_bf16 v[56:59], v[20:23], a[68:71], v[56:59]
s_add_u32 m0, s46, 85376
v_mfma_f32_16x16x32_bf16 v[60:63], v[24:27], a[64:67], v[60:63]
ds_read_b128 v[48:51], v9 offset:22528
v_mfma_f32_16x16x32_bf16 v[64:67], v[24:27], a[68:71], v[64:67]
buffer_load_dwordx4 v6, s[8:11], s50 offen offset:640 lds
s_waitcnt lgkmcnt(4)
v_mfma_f32_16x16x32_bf16 v[52:55], v[28:31], a[72:75], v[52:55]
ds_read_b128 v[20:23], v8 offset:24576
v_mfma_f32_16x16x32_bf16 v[56:59], v[28:31], a[76:79], v[56:59]
s_add_u32 m0, s46, 89344
v_mfma_f32_16x16x32_bf16 v[60:63], v[32:35], a[72:75], v[60:63]
ds_read_b128 v[24:27], v8 offset:26624
v_mfma_f32_16x16x32_bf16 v[64:67], v[32:35], a[76:79], v[64:67]
buffer_load_dwordx4 v6, s[8:11], s50 offen offset:768 lds
s_waitcnt lgkmcnt(4)
v_mfma_f32_16x16x32_bf16 v[52:55], v[36:39], a[80:83], v[52:55]
ds_read_b128 v[28:31], v9 offset:24576
v_mfma_f32_16x16x32_bf16 v[56:59], v[36:39], a[84:87], v[56:59]
s_add_u32 m0, s46, 93312
v_mfma_f32_16x16x32_bf16 v[60:63], v[40:43], a[80:83], v[60:63]
ds_read_b128 v[32:35], v9 offset:26624
v_mfma_f32_16x16x32_bf16 v[64:67], v[40:43], a[84:87], v[64:67]
buffer_load_dwordx4 v6, s[8:11], s50 offen offset:896 lds
s_waitcnt lgkmcnt(4)
v_mfma_f32_16x16x32_bf16 v[52:55], v[44:47], a[88:91], v[52:55]
ds_read_b128 v[36:39], v8 offset:28672
v_mfma_f32_16x16x32_bf16 v[56:59], v[44:47], a[92:95], v[56:59]
s_add_u32 m0, s46, 97280
v_mfma_f32_16x16x32_bf16 v[60:63], v[48:51], a[88:91], v[60:63]
ds_read_b128 v[40:43], v8 offset:30720
v_mfma_f32_16x16x32_bf16 v[64:67], v[48:51], a[92:95], v[64:67]
buffer_load_dwordx4 v6, s[8:11], s50 offen offset:1024 lds
s_waitcnt lgkmcnt(4)
v_mfma_f32_16x16x32_bf16 v[52:55], v[20:23], a[96:99], v[52:55]
ds_read_b128 v[44:47], v9 offset:28672
v_mfma_f32_16x16x32_bf16 v[56:59], v[20:23], a[100:103], v[56:59]
s_add_u32 m0, s46, 101248
v_mfma_f32_16x16x32_bf16 v[60:63], v[24:27], a[96:99], v[60:63]
ds_read_b128 v[48:51], v9 offset:30720
v_mfma_f32_16x16x32_bf16 v[64:67], v[24:27], a[100:103], v[64:67]
buffer_load_dwordx4 v6, s[8:11], s50 offen offset:1152 lds
s_waitcnt lgkmcnt(4)
v_mfma_f32_16x16x32_bf16 v[52:55], v[28:31], a[104:107], v[52:55]
ds_read_b128 v[20:23], v8 offset:32768
v_mfma_f32_16x16x32_bf16 v[56:59], v[28:31], a[108:111], v[56:59]
s_add_u32 m0, s46, 105216
v_mfma_f32_16x16x32_bf16 v[60:63], v[32:35], a[104:107], v[60:63]
ds_read_b128 v[24:27], v8 offset:34816
v_mfma_f32_16x16x32_bf16 v[64:67], v[32:35], a[108:111], v[64:67]
buffer_load_dwordx4 v6, s[8:11], s50 offen offset:1280 lds
s_waitcnt lgkmcnt(4)
v_mfma_f32_16x16x32_bf16 v[52:55], v[36:39], a[112:115], v[52:55]
ds_read_b128 v[28:31], v9 offset:32768
v_mfma_f32_16x16x32_bf16 v[56:59], v[36:39], a[116:119], v[56:59]
s_add_u32 m0, s46, 109184
v_mfma_f32_16x16x32_bf16 v[60:63], v[40:43], a[112:115], v[60:63]
ds_read_b128 v[32:35], v9 offset:34816
v_mfma_f32_16x16x32_bf16 v[64:67], v[40:43], a[116:119], v[64:67]
buffer_load_dwordx4 v6, s[8:11], s50 offen offset:1408 lds
s_waitcnt lgkmcnt(4)
v_mfma_f32_16x16x32_bf16 v[52:55], v[44:47], a[120:123], v[52:55]
ds_read_b128 v[36:39], v8 offset:36864
v_mfma_f32_16x16x32_bf16 v[56:59], v[44:47], a[124:127], v[56:59]
s_add_u32 m0, s46, 113152
v_mfma_f32_16x16x32_bf16 v[60:63], v[48:51], a[120:123], v[60:63]
ds_read_b128 v[40:43], v8 offset:38912
v_mfma_f32_16x16x32_bf16 v[64:67], v[48:51], a[124:127], v[64:67]
buffer_load_dwordx4 v6, s[8:11], s50 offen offset:1536 lds
s_waitcnt lgkmcnt(4)
v_mfma_f32_16x16x32_bf16 v[52:55], v[20:23], a[128:131], v[52:55]
ds_read_b128 v[44:47], v9 offset:36864
v_mfma_f32_16x16x32_bf16 v[56:59], v[20:23], a[132:135], v[56:59]
s_add_u32 m0, s46, 117120
v_mfma_f32_16x16x32_bf16 v[60:63], v[24:27], a[128:131], v[60:63]
ds_read_b128 v[48:51], v9 offset:38912
v_mfma_f32_16x16x32_bf16 v[64:67], v[24:27], a[132:135], v[64:67]
buffer_load_dwordx4 v6, s[8:11], s50 offen offset:1664 lds
s_waitcnt lgkmcnt(4)
v_mfma_f32_16x16x32_bf16 v[52:55], v[28:31], a[136:139], v[52:55]
ds_read_b128 v[20:23], v8 offset:40960
v_mfma_f32_16x16x32_bf16 v[56:59], v[28:31], a[140:143], v[56:59]
s_add_u32 m0, s46, 121088
v_mfma_f32_16x16x32_bf16 v[60:63], v[32:35], a[136:139], v[60:63]
ds_read_b128 v[24:27], v8 offset:43008
v_mfma_f32_16x16x32_bf16 v[64:67], v[32:35], a[140:143], v[64:67]
buffer_load_dwordx4 v6, s[8:11], s50 offen offset:1792 lds
s_waitcnt lgkmcnt(4)
v_mfma_f32_16x16x32_bf16 v[52:55], v[36:39], a[144:147], v[52:55]
ds_read_b128 v[28:31], v9 offset:40960
v_mfma_f32_16x16x32_bf16 v[56:59], v[36:39], a[148:151], v[56:59]
s_add_u32 m0, s46, 125056
v_mfma_f32_16x16x32_bf16 v[60:63], v[40:43], a[144:147], v[60:63]
ds_read_b128 v[32:35], v9 offset:43008
v_mfma_f32_16x16x32_bf16 v[64:67], v[40:43], a[148:151], v[64:67]
buffer_load_dwordx4 v6, s[8:11], s50 offen offset:1920 lds
s_waitcnt lgkmcnt(4)
v_mfma_f32_16x16x32_bf16 v[52:55], v[44:47], a[152:155], v[52:55]
ds_read_b128 v[36:39], v8 offset:45056
v_mfma_f32_16x16x32_bf16 v[56:59], v[44:47], a[156:159], v[56:59]
v_mfma_f32_16x16x32_bf16 v[60:63], v[48:51], a[152:155], v[60:63]
ds_read_b128 v[40:43], v8 offset:47104
v_mfma_f32_16x16x32_bf16 v[64:67], v[48:51], a[156:159], v[64:67]
s_waitcnt lgkmcnt(4)
v_mfma_f32_16x16x32_bf16 v[52:55], v[20:23], a[160:163], v[52:55]
ds_read_b128 v[44:47], v9 offset:45056
v_mfma_f32_16x16x32_bf16 v[56:59], v[20:23], a[164:167], v[56:59]
v_mfma_f32_16x16x32_bf16 v[60:63], v[24:27], a[160:163], v[60:63]
ds_read_b128 v[48:51], v9 offset:47104
v_mfma_f32_16x16x32_bf16 v[64:67], v[24:27], a[164:167], v[64:67]
s_waitcnt lgkmcnt(4)
v_mfma_f32_16x16x32_bf16 v[52:55], v[28:31], a[168:171], v[52:55]
ds_read_b128 v[20:23], v8 offset:49152
v_mfma_f32_16x16x32_bf16 v[56:59], v[28:31], a[172:175], v[56:59]
s_waitcnt vmcnt(16)
v_mov_b32 v17, s42
s_mov_b64 exec, 1
buffer_store_dword v17, v16, s[84:87], s49 offen sc1
s_mov_b64 exec, -1
v_mfma_f32_16x16x32_bf16 v[60:63], v[32:35], a[168:171], v[60:63]
ds_read_b128 v[24:27], v8 offset:51200
v_mfma_f32_16x16x32_bf16 v[64:67], v[32:35], a[172:175], v[64:67]
s_waitcnt lgkmcnt(4)
v_mfma_f32_16x16x32_bf16 v[52:55], v[36:39], a[176:179], v[52:55]
ds_read_b128 v[28:31], v9 offset:49152
v_mfma_f32_16x16x32_bf16 v[56:59], v[36:39], a[180:183], v[56:59]
s_add_u32 s53, s42, 3
s_min_u32 s53, s53, 63
s_lshl_b32 s53, s53, 16
s_mov_b64 exec, 0xffff
buffer_load_dword v250, v19, s[8:11], s53 offen
s_mov_b64 exec, -1
v_mfma_f32_16x16x32_bf16 v[60:63], v[40:43], a[176:179], v[60:63]
ds_read_b128 v[32:35], v9 offset:51200
v_mfma_f32_16x16x32_bf16 v[64:67], v[40:43], a[180:183], v[64:67]
s_waitcnt lgkmcnt(4)
v_mfma_f32_16x16x32_bf16 v[52:55], v[44:47], a[184:187], v[52:55]
ds_read_b128 v[36:39], v8 offset:53248
v_mfma_f32_16x16x32_bf16 v[56:59], v[44:47], a[188:191], v[56:59]
v_mfma_f32_16x16x32_bf16 v[60:63], v[48:51], a[184:187], v[60:63]
ds_read_b128 v[40:43], v8 offset:55296
v_mfma_f32_16x16x32_bf16 v[64:67], v[48:51], a[188:191], v[64:67]
s_waitcnt lgkmcnt(4)
v_mfma_f32_16x16x32_bf16 v[52:55], v[20:23], a[192:195], v[52:55]
ds_read_b128 v[44:47], v9 offset:53248
v_mfma_f32_16x16x32_bf16 v[56:59], v[20:23], a[196:199], v[56:59]
v_mfma_f32_16x16x32_bf16 v[60:63], v[24:27], a[192:195], v[60:63]
ds_read_b128 v[48:51], v9 offset:55296
v_mfma_f32_16x16x32_bf16 v[64:67], v[24:27], a[196:199], v[64:67]
s_waitcnt lgkmcnt(4)
v_mfma_f32_16x16x32_bf16 v[52:55], v[28:31], a[200:203], v[52:55]
ds_read_b128 v[20:23], v8 offset:57344
v_mfma_f32_16x16x32_bf16 v[56:59], v[28:31], a[204:207], v[56:59]
v_mfma_f32_16x16x32_bf16 v[60:63], v[32:35], a[200:203], v[60:63]
ds_read_b128 v[24:27], v8 offset:59392
v_mfma_f32_16x16x32_bf16 v[64:67], v[32:35], a[204:207], v[64:67]
s_waitcnt lgkmcnt(4)
v_mfma_f32_16x16x32_bf16 v[52:55], v[36:39], a[208:211], v[52:55]
ds_read_b128 v[28:31], v9 offset:57344
v_mfma_f32_16x16x32_bf16 v[56:59], v[36:39], a[212:215], v[56:59]
v_mfma_f32_16x16x32_bf16 v[60:63], v[40:43], a[208:211], v[60:63]
ds_read_b128 v[32:35], v9 offset:59392
v_mfma_f32_16x16x32_bf16 v[64:67], v[40:43], a[212:215], v[64:67]
s_waitcnt lgkmcnt(4)
v_mfma_f32_16x16x32_bf16 v[52:55], v[44:47], a[216:219], v[52:55]
ds_read_b128 v[36:39], v8 offset:61440
v_mfma_f32_16x16x32_bf16 v[56:59], v[44:47], a[220:223], v[56:59]
v_mfma_f32_16x16x32_bf16 v[60:63], v[48:51], a[216:219], v[60:63]
ds_read_b128 v[40:43], v8 offset:63488
v_mfma_f32_16x16x32_bf16 v[64:67], v[48:51], a[220:223], v[64:67]
s_waitcnt lgkmcnt(4)
v_mfma_f32_16x16x32_bf16 v[52:55], v[20:23], a[224:227], v[52:55]
ds_read_b128 v[44:47], v9 offset:61440
v_mfma_f32_16x16x32_bf16 v[56:59], v[20:23], a[228:231], v[56:59]
v_mfma_f32_16x16x32_bf16 v[60:63], v[24:27], a[224:227], v[60:63]
ds_read_b128 v[48:51], v9 offset:63488
v_mfma_f32_16x16x32_bf16 v[64:67], v[24:27], a[228:231], v[64:67]
s_waitcnt lgkmcnt(5)
v_mfma_f32_16x16x32_bf16 v[52:55], v[28:31], a[232:235], v[52:55]
v_mfma_f32_16x16x32_bf16 v[56:59], v[28:31], a[236:239], v[56:59]
s_waitcnt lgkmcnt(4)
v_mfma_f32_16x16x32_bf16 v[60:63], v[32:35], a[232:235], v[60:63]
v_mfma_f32_16x16x32_bf16 v[64:67], v[32:35], a[236:239], v[64:67]
s_waitcnt lgkmcnt(3)
v_mfma_f32_16x16x32_bf16 v[52:55], v[36:39], a[240:243], v[52:55]
v_mfma_f32_16x16x32_bf16 v[56:59], v[36:39], a[244:247], v[56:59]
s_waitcnt lgkmcnt(2)
v_mfma_f32_16x16x32_bf16 v[60:63], v[40:43], a[240:243], v[60:63]
v_mfma_f32_16x16x32_bf16 v[64:67], v[40:43], a[244:247], v[64:67]
s_waitcnt lgkmcnt(1)
v_mfma_f32_16x16x32_bf16 v[52:55], v[44:47], a[248:251], v[52:55]
v_mfma_f32_16x16x32_bf16 v[56:59], v[44:47], a[252:255], v[56:59]
s_waitcnt lgkmcnt(0)
v_mfma_f32_16x16x32_bf16 v[60:63], v[48:51], a[248:251], v[60:63]
v_mfma_f32_16x16x32_bf16 v[64:67], v[48:51], a[252:255], v[64:67]
s_add_u32 s42, s42, 1
s_branch mega_kernel_v_loop
mega_kernel_v_fin:
s_nop 11
v_cvt_pk_bf16_f32 v84, v68, v69
v_cvt_pk_bf16_f32 v85, v70, v71
v_cvt_pk_bf16_f32 v86, v76, v77
v_cvt_pk_bf16_f32 v87, v78, v79
v_cvt_pk_bf16_f32 v88, v72, v73
v_cvt_pk_bf16_f32 v89, v74, v75
v_cvt_pk_bf16_f32 v90, v80, v81
v_cvt_pk_bf16_f32 v91, v82, v83
s_add_u32 s51, s42, s47
s_sub_u32 s51, s51, 1
s_bfe_u32 s52, s51, 0x40002
s_lshl_b32 s52, s52, 14
s_and_b32 s51, s51, 3
s_lshl_b32 s51, s51, 11
s_add_u32 s51, s51, s52
s_add_u32 s51, s51, s48
buffer_store_dwordx4 v[84:87], v7, s[84:87], s51 offen sc1
buffer_store_dwordx4 v[88:91], v7, s[84:87], s51 offen offset:1024 sc1
s_waitcnt vmcnt(0)
v_mov_b32 v17, s42
s_mov_b64 exec, 1
buffer_store_dword v17, v16, s[84:87], s49 offen sc1
s_mov_b64 exec, -1
s_waitcnt vmcnt(0)
s_barrier
mega_kernel_fft:
s_mov_b32 s38, s92
s_mov_b32 s39, 64
s_mov_b32 s37, 129
mega_kernel_f2s:
v_mov_b32 v1, 0
s_mov_b32 s82, 69259264
mega_kernel_w0:
s_sleep 8
buffer_load_dword v2, v1, s[84:87], s82 offen sc1
s_waitcnt vmcnt(0)
v_cmp_ne_u32 vcc, 31, v2
s_cbranch_vccnz mega_kernel_w0
s_mov_b32 s48, 0x3f7ec46d
s_mov_b32 s49, 0x3dc8bd36
s_mov_b32 s50, 0x3f7b14be
s_mov_b32 s51, 0x3e47c5c2
s_mov_b32 s52, 0x3f74fa0b
s_mov_b32 s53, 0x3e94a031
s_mov_b32 s54, 0x3f6c835e
s_mov_b32 s55, 0x3ec3ef15
s_mov_b32 s56, 0x3f61c598
s_mov_b32 s57, 0x3ef15aea
s_mov_b32 s58, 0x3f54db31
s_mov_b32 s59, 0x3f0e39da
s_mov_b32 s60, 0x3f45e403
s_mov_b32 s61, 0x3f226799
s_mov_b32 s62, 0x3f3504f3
s_mov_b32 s63, 0x3f3504f3
v_lshrrev_b32 v10, 6, v0
v_and_b32 v1, 63, v0
v_readfirstlane_b32 s16, v10
v_cvt_f32_u32 v2, v1
v_lshlrev_b32 v5, 3, v1
s_mul_i32 s17, s16, 16896
v_add_u32 v3, s17, v5
v_and_b32 v7, 1, v1
v_lshrrev_b32 v6, 1, v1
v_cvt_f32_u32 v8, v6
v_cvt_f32_u32 v10, v7
v_mul_u32_u24 v4, 528, v6
v_lshl_add_u32 v4, v7, 3, v4
v_add_u32 v4, s17, v4
v_lshlrev_b32 v11, 12, v7
v_lshl_add_u32 v11, v6, 2, v11
v_fma_f32 v9, v10, 2.0, -1.0
v_sub_f32 v7, 0, v9
v_mul_f32 v13, v10, v8
v_mul_f32 v13, 0x3a000000, v13
s_mov_b32 s18, 0xaaaaaaaa
s_mov_b32 s19, 0xaaaaaaaa
v_mul_f32 v12, 0xba000000, v2
v_cos_f32 v82, v12
v_sin_f32 v83, v12
v_mul_f32 v12, 0xba800000, v2
v_cos_f32 v84, v12
v_sin_f32 v85, v12
v_mul_f32 v12, 0xbac00000, v2
v_cos_f32 v86, v12
v_sin_f32 v87, v12
v_mul_f32 v12, 0xbb000000, v2
v_cos_f32 v88, v12
v_sin_f32 v89, v12
v_mul_f32 v12, 0xbb200000, v2
v_cos_f32 v90, v12
v_sin_f32 v91, v12
v_mul_f32 v12, 0xbb400000, v2
v_cos_f32 v92, v12
v_sin_f32 v93, v12
v_mul_f32 v12, 0xbb600000, v2
v_cos_f32 v94, v12
v_sin_f32 v95, v12
v_mul_f32 v12, 0xbb800000, v2
v_cos_f32 v96, v12
v_sin_f32 v97, v12
v_mul_f32 v12, 0xbb900000, v2
v_cos_f32 v98, v12
v_sin_f32 v99, v12
v_mul_f32 v12, 0xbba00000, v2
v_cos_f32 v100, v12
v_sin_f32 v101, v12
v_mul_f32 v12, 0xbbb00000, v2
v_cos_f32 v102, v12
v_sin_f32 v103, v12
v_mul_f32 v12, 0xbbc00000, v2
v_cos_f32 v104, v12
v_sin_f32 v105, v12
v_mul_f32 v12, 0xbbd00000, v2
v_cos_f32 v106, v12
v_sin_f32 v107, v12
v_mul_f32 v12, 0xbbe00000, v2
v_cos_f32 v108, v12
v_sin_f32 v109, v12
v_mul_f32 v12, 0xbbf00000, v2
v_cos_f32 v110, v12
v_sin_f32 v111, v12
v_mul_f32 v12, 0xbc000000, v2
v_cos_f32 v112, v12
v_sin_f32 v113, v12
v_mul_f32 v12, 0xbc080000, v2
v_cos_f32 v114, v12
v_sin_f32 v115, v12
v_mul_f32 v12, 0xbc100000, v2
v_cos_f32 v116, v12
v_sin_f32 v117, v12
v_mul_f32 v12, 0xbc180000, v2
v_cos_f32 v118, v12
v_sin_f32 v119, v12
v_mul_f32 v12, 0xbc200000, v2
v_cos_f32 v120, v12
v_sin_f32 v121, v12
v_mul_f32 v12, 0xbc280000, v2
v_cos_f32 v122, v12
v_sin_f32 v123, v12
v_mul_f32 v12, 0xbc300000, v2
v_cos_f32 v124, v12
v_sin_f32 v125, v12
v_mul_f32 v12, 0xbc380000, v2
v_cos_f32 v126, v12
v_sin_f32 v127, v12
v_mul_f32 v12, 0xbc400000, v2
v_cos_f32 v128, v12
v_sin_f32 v129, v12
v_mul_f32 v12, 0xbc480000, v2
v_cos_f32 v130, v12
v_sin_f32 v131, v12
v_mul_f32 v12, 0xbc500000, v2
v_cos_f32 v132, v12
v_sin_f32 v133, v12
v_mul_f32 v12, 0xbc580000, v2
v_cos_f32 v134, v12
v_sin_f32 v135, v12
v_mul_f32 v12, 0xbc600000, v2
v_cos_f32 v136, v12
v_sin_f32 v137, v12
v_mul_f32 v12, 0xbc680000, v2
v_cos_f32 v138, v12
v_sin_f32 v139, v12
v_mul_f32 v12, 0xbc700000, v2
v_cos_f32 v140, v12
v_sin_f32 v141, v12
v_mul_f32 v12, 0xbc780000, v2
v_cos_f32 v142, v12
v_sin_f32 v143, v12
v_mov_b32 v12, v13
v_fmac_f32 v12, 0x00000000, v8
v_cos_f32 v144, v12
v_sin_f32 v145, v12
v_mov_b32 v12, v13
v_fmac_f32 v12, 0x3a800000, v8
v_cos_f32 v146, v12
v_sin_f32 v147, v12
v_mov_b32 v12, v13
v_fmac_f32 v12, 0x3b000000, v8
v_cos_f32 v148, v12
v_sin_f32 v149, v12
v_mov_b32 v12, v13
v_fmac_f32 v12, 0x3b400000, v8
v_cos_f32 v150, v12
v_sin_f32 v151, v12
v_mov_b32 v12, v13
v_fmac_f32 v12, 0x3b800000, v8
v_cos_f32 v152, v12
v_sin_f32 v153, v12
v_mov_b32 v12, v13
v_fmac_f32 v12, 0x3ba00000, v8
v_cos_f32 v154, v12
v_sin_f32 v155, v12
v_mov_b32 v12, v13
v_fmac_f32 v12, 0x3bc00000, v8
v_cos_f32 v156, v12
v_sin_f32 v157, v12
v_mov_b32 v12, v13
v_fmac_f32 v12, 0x3be00000, v8
v_cos_f32 v158, v12
v_sin_f32 v159, v12
v_mov_b32 v12, v13
v_fmac_f32 v12, 0x3c000000, v8
v_cos_f32 v160, v12
v_sin_f32 v161, v12
v_mov_b32 v12, v13
v_fmac_f32 v12, 0x3c100000, v8
v_cos_f32 v162, v12
v_sin_f32 v163, v12
v_mov_b32 v12, v13
v_fmac_f32 v12, 0x3c200000, v8
v_cos_f32 v164, v12
v_sin_f32 v165, v12
v_mov_b32 v12, v13
v_fmac_f32 v12, 0x3c300000, v8
v_cos_f32 v166, v12
v_sin_f32 v167, v12
v_mov_b32 v12, v13
v_fmac_f32 v12, 0x3c400000, v8
v_cos_f32 v168, v12
v_sin_f32 v169, v12
v_mov_b32 v12, v13
v_fmac_f32 v12, 0x3c500000, v8
v_cos_f32 v170, v12
v_sin_f32 v171, v12
v_mov_b32 v12, v13
v_fmac_f32 v12, 0x3c600000, v8
v_cos_f32 v172, v12
v_sin_f32 v173, v12
v_mov_b32 v12, v13
v_fmac_f32 v12, 0x3c700000, v8
v_cos_f32 v174, v12
v_sin_f32 v175, v12
v_mov_b32 v12, v13
v_fmac_f32 v12, 0x3c800000, v8
v_cos_f32 v176, v12
v_sin_f32 v177, v12
v_mov_b32 v12, v13
v_fmac_f32 v12, 0x3c880000, v8
v_cos_f32 v178, v12
v_sin_f32 v179, v12
v_mov_b32 v12, v13
v_fmac_f32 v12, 0x3c900000, v8
v_cos_f32 v180, v12
v_sin_f32 v181, v12
v_mov_b32 v12, v13
v_fmac_f32 v12, 0x3c980000, v8
v_cos_f32 v182, v12
v_sin_f32 v183, v12
v_mov_b32 v12, v13
v_fmac_f32 v12, 0x3ca00000, v8
v_cos_f32 v184, v12
v_sin_f32 v185, v12
v_mov_b32 v12, v13
v_fmac_f32 v12, 0x3ca80000, v8
v_cos_f32 v186, v12
v_sin_f32 v187, v12
v_mov_b32 v12, v13
v_fmac_f32 v12, 0x3cb00000, v8
v_cos_f32 v188, v12
v_sin_f32 v189, v12
v_mov_b32 v12, v13
v_fmac_f32 v12, 0x3cb80000, v8
v_cos_f32 v190, v12
v_sin_f32 v191, v12
v_mov_b32 v12, v13
v_fmac_f32 v12, 0x3cc00000, v8
v_cos_f32 v192, v12
v_sin_f32 v193, v12
v_mov_b32 v12, v13
v_fmac_f32 v12, 0x3cc80000, v8
v_cos_f32 v194, v12
v_sin_f32 v195, v12
v_mov_b32 v12, v13
v_fmac_f32 v12, 0x3cd00000, v8
v_cos_f32 v196, v12
v_sin_f32 v197, v12
v_mov_b32 v12, v13
v_fmac_f32 v12, 0x3cd80000, v8
v_cos_f32 v198, v12
v_sin_f32 v199, v12
v_mov_b32 v12, v13
v_fmac_f32 v12, 0x3ce00000, v8
v_cos_f32 v200, v12
v_sin_f32 v201, v12
v_mov_b32 v12, v13
v_fmac_f32 v12, 0x3ce80000, v8
v_cos_f32 v202, v12
v_sin_f32 v203, v12
v_mov_b32 v12, v13
v_fmac_f32 v12, 0x3cf00000, v8
v_cos_f32 v204, v12
v_sin_f32 v205, v12
v_mov_b32 v12, v13
v_fmac_f32 v12, 0x3cf80000, v8
v_cos_f32 v206, v12
v_sin_f32 v207, v12
s_nop 0
v_mul_f32 v144, 0x34800000, v144
v_mul_f32 v145, 0x34800000, v145
v_mul_f32 v146, 0x34800000, v146
v_mul_f32 v147, 0x34800000, v147
v_mul_f32 v148, 0x34800000, v148
v_mul_f32 v149, 0x34800000, v149
v_mul_f32 v150, 0x34800000, v150
v_mul_f32 v151, 0x34800000, v151
v_mul_f32 v152, 0x34800000, v152
v_mul_f32 v153, 0x34800000, v153
v_mul_f32 v154, 0x34800000, v154
v_mul_f32 v155, 0x34800000, v155
v_mul_f32 v156, 0x34800000, v156
v_mul_f32 v157, 0x34800000, v157
v_mul_f32 v158, 0x34800000, v158
v_mul_f32 v159, 0x34800000, v159
v_mul_f32 v160, 0x34800000, v160
v_mul_f32 v161, 0x34800000, v161
v_mul_f32 v162, 0x34800000, v162
v_mul_f32 v163, 0x34800000, v163
v_mul_f32 v164, 0x34800000, v164
v_mul_f32 v165, 0x34800000, v165
v_mul_f32 v166, 0x34800000, v166
v_mul_f32 v167, 0x34800000, v167
v_mul_f32 v168, 0x34800000, v168
v_mul_f32 v169, 0x34800000, v169
v_mul_f32 v170, 0x34800000, v170
v_mul_f32 v171, 0x34800000, v171
v_mul_f32 v172, 0x34800000, v172
v_mul_f32 v173, 0x34800000, v173
v_mul_f32 v174, 0x34800000, v174
v_mul_f32 v175, 0x34800000, v175
v_mul_f32 v176, 0x34800000, v176
v_mul_f32 v177, 0x34800000, v177
v_mul_f32 v178, 0x34800000, v178
v_mul_f32 v179, 0x34800000, v179
v_mul_f32 v180, 0x34800000, v180
v_mul_f32 v181, 0x34800000, v181
v_mul_f32 v182, 0x34800000, v182
v_mul_f32 v183, 0x34800000, v183
v_mul_f32 v184, 0x34800000, v184
v_mul_f32 v185, 0x34800000, v185
v_mul_f32 v186, 0x34800000, v186
v_mul_f32 v187, 0x34800000, v187
v_mul_f32 v188, 0x34800000, v188
v_mul_f32 v189, 0x34800000, v189
v_mul_f32 v190, 0x34800000, v190
v_mul_f32 v191, 0x34800000, v191
v_mul_f32 v192, 0x34800000, v192
v_mul_f32 v193, 0x34800000, v193
v_mul_f32 v194, 0x34800000, v194
v_mul_f32 v195, 0x34800000, v195
v_mul_f32 v196, 0x34800000, v196
v_mul_f32 v197, 0x34800000, v197
v_mul_f32 v198, 0x34800000, v198
v_mul_f32 v199, 0x34800000, v199
v_mul_f32 v200, 0x34800000, v200
v_mul_f32 v201, 0x34800000, v201
v_mul_f32 v202, 0x34800000, v202
v_mul_f32 v203, 0x34800000, v203
v_mul_f32 v204, 0x34800000, v204
v_mul_f32 v205, 0x34800000, v205
v_mul_f32 v206, 0x34800000, v206
v_mul_f32 v207, 0x34800000, v207
s_cmp_lt_u32 s38, s37
s_cbranch_scc0 mega_kernel_f2_e
s_lshl_b32 s12, s38, 2
s_add_u32 s12, s12, s16
s_min_u32 s12, s12, 512
s_mul_i32 s13, s12, 8192
s_mul_i32 s12, s12, 16384
s_add_u32 s12, s12, 96468992
s_add_u32 s13, s13, 121634816
buffer_load_dwordx2 a[0:1], v5, s[84:87], s12 offen offset:0 sc1
buffer_load_dwordx2 a[2:3], v5, s[84:87], s12 offen offset:512 sc1
buffer_load_dwordx2 a[4:5], v5, s[84:87], s12 offen offset:1024 sc1
buffer_load_dwordx2 a[6:7], v5, s[84:87], s12 offen offset:1536 sc1
buffer_load_dwordx2 a[8:9], v5, s[84:87], s12 offen offset:2048 sc1
buffer_load_dwordx2 a[10:11], v5, s[84:87], s12 offen offset:2560 sc1
buffer_load_dwordx2 a[12:13], v5, s[84:87], s12 offen offset:3072 sc1
buffer_load_dwordx2 a[14:15], v5, s[84:87], s12 offen offset:3584 sc1
s_add_u32 s12, s12, 4096
buffer_load_dwordx2 a[16:17], v5, s[84:87], s12 offen offset:0 sc1
buffer_load_dwordx2 a[18:19], v5, s[84:87], s12 offen offset:512 sc1
buffer_load_dwordx2 a[20:21], v5, s[84:87], s12 offen offset:1024 sc1
buffer_load_dwordx2 a[22:23], v5, s[84:87], s12 offen offset:1536 sc1
buffer_load_dwordx2 a[24:25], v5, s[84:87], s12 offen offset:2048 sc1
buffer_load_dwordx2 a[26:27], v5, s[84:87], s12 offen offset:2560 sc1
buffer_load_dwordx2 a[28:29], v5, s[84:87], s12 offen offset:3072 sc1
buffer_load_dwordx2 a[30:31], v5, s[84:87], s12 offen offset:3584 sc1
s_add_u32 s12, s12, 4096
buffer_load_dwordx2 a[32:33], v5, s[84:87], s12 offen offset:0 sc1
buffer_load_dwordx2 a[34:35], v5, s[84:87], s12 offen offset:512 sc1
buffer_load_dwordx2 a[36:37], v5, s[84:87], s12 offen offset:1024 sc1
buffer_load_dwordx2 a[38:39], v5, s[84:87], s12 offen offset:1536 sc1
buffer_load_dwordx2 a[40:41], v5, s[84:87], s12 offen offset:2048 sc1
buffer_load_dwordx2 a[42:43], v5, s[84:87], s12 offen offset:2560 sc1
buffer_load_dwordx2 a[44:45], v5, s[84:87], s12 offen offset:3072 sc1
buffer_load_dwordx2 a[46:47], v5, s[84:87], s12 offen offset:3584 sc1
s_add_u32 s12, s12, 4096
buffer_load_dwordx2 a[48:49], v5, s[84:87], s12 offen offset:0 sc1
buffer_load_dwordx2 a[50:51], v5, s[84:87], s12 offen offset:512 sc1
buffer_load_dwordx2 a[52:53], v5, s[84:87], s12 offen offset:1024 sc1
buffer_load_dwordx2 a[54:55], v5, s[84:87], s12 offen offset:1536 sc1
buffer_load_dwordx2 a[56:57], v5, s[84:87], s12 offen offset:2048 sc1
buffer_load_dwordx2 a[58:59], v5, s[84:87], s12 offen offset:2560 sc1
buffer_load_dwordx2 a[60:61], v5, s[84:87], s12 offen offset:3072 sc1
buffer_load_dwordx2 a[62:63], v5, s[84:87], s12 offen offset:3584 sc1
s_add_u32 s12, s12, 4096
buffer_load_dword a64, v11, s[84:87], s13 offen offset:0 sc1
buffer_load_dword a65, v11, s[84:87], s13 offen offset:128 sc1
buffer_load_dword a66, v11, s[84:87], s13 offen offset:256 sc1
buffer_load_dword a67, v11, s[84:87], s13 offen offset:384 sc1
buffer_load_dword a68, v11, s[84:87], s13 offen offset:512 sc1
buffer_load_dword a69, v11, s[84:87], s13 offen offset:640 sc1
buffer_load_dword a70, v11, s[84:87], s13 offen offset:768 sc1
buffer_load_dword a71, v11, s[84:87], s13 offen offset:896 sc1
buffer_load_dword a72, v11, s[84:87], s13 offen offset:1024 sc1
buffer_load_dword a73, v11, s[84:87], s13 offen offset:1152 sc1
buffer_load_dword a74, v11, s[84:87], s13 offen offset:1280 sc1
buffer_load_dword a75, v11, s[84:87], s13 offen offset:1408 sc1
buffer_load_dword a76, v11, s[84:87], s13 offen offset:1536 sc1
buffer_load_dword a77, v11, s[84:87], s13 offen offset:1664 sc1
buffer_load_dword a78, v11, s[84:87], s13 offen offset:1792 sc1
buffer_load_dword a79, v11, s[84:87], s13 offen offset:1920 sc1
buffer_load_dword a80, v11, s[84:87], s13 offen offset:2048 sc1
buffer_load_dword a81, v11, s[84:87], s13 offen offset:2176 sc1
buffer_load_dword a82, v11, s[84:87], s13 offen offset:2304 sc1
buffer_load_dword a83, v11, s[84:87], s13 offen offset:2432 sc1
buffer_load_dword a84, v11, s[84:87], s13 offen offset:2560 sc1
buffer_load_dword a85, v11, s[84:87], s13 offen offset:2688 sc1
buffer_load_dword a86, v11, s[84:87], s13 offen offset:2816 sc1
buffer_load_dword a87, v11, s[84:87], s13 offen offset:2944 sc1
buffer_load_dword a88, v11, s[84:87], s13 offen offset:3072 sc1
buffer_load_dword a89, v11, s[84:87], s13 offen offset:3200 sc1
buffer_load_dword a90, v11, s[84:87], s13 offen offset:3328 sc1
buffer_load_dword a91, v11, s[84:87], s13 offen offset:3456 sc1
buffer_load_dword a92, v11, s[84:87], s13 offen offset:3584 sc1
buffer_load_dword a93, v11, s[84:87], s13 offen offset:3712 sc1
buffer_load_dword a94, v11, s[84:87], s13 offen offset:3840 sc1
buffer_load_dword a95, v11, s[84:87], s13 offen offset:3968 sc1
s_waitcnt vmcnt(0)
mega_kernel_f2_l:
s_add_u32 s21, s38, s39
s_cmp_lt_u32 s21, s37
s_cselect_b32 s22, s21, s38
s_waitcnt vmcnt(32)
v_accvgpr_read_b32 v16, a0
v_accvgpr_read_b32 v17, a1
v_accvgpr_read_b32 v18, a2
v_accvgpr_read_b32 v19, a3
v_accvgpr_read_b32 v20, a4
v_accvgpr_read_b32 v21, a5
v_accvgpr_read_b32 v22, a6
v_accvgpr_read_b32 v23, a7
v_accvgpr_read_b32 v24, a8
v_accvgpr_read_b32 v25, a9
v_accvgpr_read_b32 v26, a10
v_accvgpr_read_b32 v27, a11
v_accvgpr_read_b32 v28, a12
v_accvgpr_read_b32 v29, a13
v_accvgpr_read_b32 v30, a14
v_accvgpr_read_b32 v31, a15
v_accvgpr_read_b32 v32, a16
v_accvgpr_read_b32 v33, a17
v_accvgpr_read_b32 v34, a18
v_accvgpr_read_b32 v35, a19
v_accvgpr_read_b32 v36, a20
v_accvgpr_read_b32 v37, a21
v_accvgpr_read_b32 v38, a22
v_accvgpr_read_b32 v39, a23
v_accvgpr_read_b32 v40, a24
v_accvgpr_read_b32 v41, a25
v_accvgpr_read_b32 v42, a26
v_accvgpr_read_b32 v43, a27
v_accvgpr_read_b32 v44, a28
v_accvgpr_read_b32 v45, a29
v_accvgpr_read_b32 v46, a30
v_accvgpr_read_b32 v47, a31
v_accvgpr_read_b32 v48, a32
v_accvgpr_read_b32 v49, a33
v_accvgpr_read_b32 v50, a34
v_accvgpr_read_b32 v51, a35
v_accvgpr_read_b32 v52, a36
v_accvgpr_read_b32 v53, a37
v_accvgpr_read_b32 v54, a38
v_accvgpr_read_b32 v55, a39
v_accvgpr_read_b32 v56, a40
v_accvgpr_read_b32 v57, a41
v_accvgpr_read_b32 v58, a42
v_accvgpr_read_b32 v59, a43
v_accvgpr_read_b32 v60, a44
v_accvgpr_read_b32 v61, a45
v_accvgpr_read_b32 v62, a46
v_accvgpr_read_b32 v63, a47
v_accvgpr_read_b32 v64, a48
v_accvgpr_read_b32 v65, a49
v_accvgpr_read_b32 v66, a50
v_accvgpr_read_b32 v67, a51
v_accvgpr_read_b32 v68, a52
v_accvgpr_read_b32 v69, a53
v_accvgpr_read_b32 v70, a54
v_accvgpr_read_b32 v71, a55
v_accvgpr_read_b32 v72, a56
v_accvgpr_read_b32 v73, a57
v_accvgpr_read_b32 v74, a58
v_accvgpr_read_b32 v75, a59
v_accvgpr_read_b32 v76, a60
v_accvgpr_read_b32 v77, a61
v_accvgpr_read_b32 v78, a62
v_accvgpr_read_b32 v79, a63
v_accvgpr_read_b32 v208, a64
v_accvgpr_read_b32 v209, a65
v_accvgpr_read_b32 v210, a66
v_accvgpr_read_b32 v211, a67
v_accvgpr_read_b32 v212, a68
v_accvgpr_read_b32 v213, a69
v_accvgpr_read_b32 v214, a70
v_accvgpr_read_b32 v215, a71
v_accvgpr_read_b32 v216, a72
v_accvgpr_read_b32 v217, a73
v_accvgpr_read_b32 v218, a74
v_accvgpr_read_b32 v219, a75
v_accvgpr_read_b32 v220, a76
v_accvgpr_read_b32 v221, a77
v_accvgpr_read_b32 v222, a78
v_accvgpr_read_b32 v223, a79
v_accvgpr_read_b32 v224, a80
v_accvgpr_read_b32 v225, a81
v_accvgpr_read_b32 v226, a82
v_accvgpr_read_b32 v227, a83
v_accvgpr_read_b32 v228, a84
v_accvgpr_read_b32 v229, a85
v_accvgpr_read_b32 v230, a86
v_accvgpr_read_b32 v231, a87
v_accvgpr_read_b32 v232, a88
v_accvgpr_read_b32 v233, a89
v_accvgpr_read_b32 v234, a90
v_accvgpr_read_b32 v235, a91
v_accvgpr_read_b32 v236, a92
v_accvgpr_read_b32 v237, a93
v_accvgpr_read_b32 v238, a94
v_accvgpr_read_b32 v239, a95
s_lshl_b32 s12, s22, 2
s_add_u32 s12, s12, s16
s_min_u32 s12, s12, 512
s_mul_i32 s13, s12, 8192
s_mul_i32 s12, s12, 16384
s_add_u32 s12, s12, 96468992
s_add_u32 s13, s13, 121634816
buffer_load_dwordx2 a[0:1], v5, s[84:87], s12 offen offset:0 sc1
buffer_load_dwordx2 a[2:3], v5, s[84:87], s12 offen offset:512 sc1
buffer_load_dwordx2 a[4:5], v5, s[84:87], s12 offen offset:1024 sc1
buffer_load_dwordx2 a[6:7], v5, s[84:87], s12 offen offset:1536 sc1
buffer_load_dwordx2 a[8:9], v5, s[84:87], s12 offen offset:2048 sc1
buffer_load_dwordx2 a[10:11], v5, s[84:87], s12 offen offset:2560 sc1
buffer_load_dwordx2 a[12:13], v5, s[84:87], s12 offen offset:3072 sc1
buffer_load_dwordx2 a[14:15], v5, s[84:87], s12 offen offset:3584 sc1
s_add_u32 s12, s12, 4096
buffer_load_dwordx2 a[16:17], v5, s[84:87], s12 offen offset:0 sc1
buffer_load_dwordx2 a[18:19], v5, s[84:87], s12 offen offset:512 sc1
buffer_load_dwordx2 a[20:21], v5, s[84:87], s12 offen offset:1024 sc1
buffer_load_dwordx2 a[22:23], v5, s[84:87], s12 offen offset:1536 sc1
buffer_load_dwordx2 a[24:25], v5, s[84:87], s12 offen offset:2048 sc1
buffer_load_dwordx2 a[26:27], v5, s[84:87], s12 offen offset:2560 sc1
buffer_load_dwordx2 a[28:29], v5, s[84:87], s12 offen offset:3072 sc1
buffer_load_dwordx2 a[30:31], v5, s[84:87], s12 offen offset:3584 sc1
s_add_u32 s12, s12, 4096
buffer_load_dwordx2 a[32:33], v5, s[84:87], s12 offen offset:0 sc1
buffer_load_dwordx2 a[34:35], v5, s[84:87], s12 offen offset:512 sc1
buffer_load_dwordx2 a[36:37], v5, s[84:87], s12 offen offset:1024 sc1
buffer_load_dwordx2 a[38:39], v5, s[84:87], s12 offen offset:1536 sc1
buffer_load_dwordx2 a[40:41], v5, s[84:87], s12 offen offset:2048 sc1
buffer_load_dwordx2 a[42:43], v5, s[84:87], s12 offen offset:2560 sc1
buffer_load_dwordx2 a[44:45], v5, s[84:87], s12 offen offset:3072 sc1
buffer_load_dwordx2 a[46:47], v5, s[84:87], s12 offen offset:3584 sc1
s_add_u32 s12, s12, 4096
buffer_load_dwordx2 a[48:49], v5, s[84:87], s12 offen offset:0 sc1
buffer_load_dwordx2 a[50:51], v5, s[84:87], s12 offen offset:512 sc1
buffer_load_dwordx2 a[52:53], v5, s[84:87], s12 offen offset:1024 sc1
buffer_load_dwordx2 a[54:55], v5, s[84:87], s12 offen offset:1536 sc1
buffer_load_dwordx2 a[56:57], v5, s[84:87], s12 offen offset:2048 sc1
buffer_load_dwordx2 a[58:59], v5, s[84:87], s12 offen offset:2560 sc1
buffer_load_dwordx2 a[60:61], v5, s[84:87], s12 offen offset:3072 sc1
buffer_load_dwordx2 a[62:63], v5, s[84:87], s12 offen offset:3584 sc1
s_add_u32 s12, s12, 4096
buffer_load_dword a64, v11, s[84:87], s13 offen offset:0 sc1
buffer_load_dword a65, v11, s[84:87], s13 offen offset:128 sc1
buffer_load_dword a66, v11, s[84:87], s13 offen offset:256 sc1
buffer_load_dword a67, v11, s[84:87], s13 offen offset:384 sc1
buffer_load_dword a68, v11, s[84:87], s13 offen offset:512 sc1
buffer_load_dword a69, v11, s[84:87], s13 offen offset:640 sc1
buffer_load_dword a70, v11, s[84:87], s13 offen offset:768 sc1
buffer_load_dword a71, v11, s[84:87], s13 offen offset:896 sc1
buffer_load_dword a72, v11, s[84:87], s13 offen offset:1024 sc1
buffer_load_dword a73, v11, s[84:87], s13 offen offset:1152 sc1
buffer_load_dword a74, v11, s[84:87], s13 offen offset:1280 sc1
buffer_load_dword a75, v11, s[84:87], s13 offen offset:1408 sc1
buffer_load_dword a76, v11, s[84:87], s13 offen offset:1536 sc1
buffer_load_dword a77, v11, s[84:87], s13 offen offset:1664 sc1
buffer_load_dword a78, v11, s[84:87], s13 offen offset:1792 sc1
buffer_load_dword a79, v11, s[84:87], s13 offen offset:1920 sc1
buffer_load_dword a80, v11, s[84:87], s13 offen offset:2048 sc1
buffer_load_dword a81, v11, s[84:87], s13 offen offset:2176 sc1
buffer_load_dword a82, v11, s[84:87], s13 offen offset:2304 sc1
buffer_load_dword a83, v11, s[84:87], s13 offen offset:2432 sc1
buffer_load_dword a84, v11, s[84:87], s13 offen offset:2560 sc1
buffer_load_dword a85, v11, s[84:87], s13 offen offset:2688 sc1
buffer_load_dword a86, v11, s[84:87], s13 offen offset:2816 sc1
buffer_load_dword a87, v11, s[84:87], s13 offen offset:2944 sc1
buffer_load_dword a88, v11, s[84:87], s13 offen offset:3072 sc1
buffer_load_dword a89, v11, s[84:87], s13 offen offset:3200 sc1
buffer_load_dword a90, v11, s[84:87], s13 offen offset:3328 sc1
buffer_load_dword a91, v11, s[84:87], s13 offen offset:3456 sc1
buffer_load_dword a92, v11, s[84:87], s13 offen offset:3584 sc1
buffer_load_dword a93, v11, s[84:87], s13 offen offset:3712 sc1
buffer_load_dword a94, v11, s[84:87], s13 offen offset:3840 sc1
buffer_load_dword a95, v11, s[84:87], s13 offen offset:3968 sc1
v_pk_add_f32 v[14:15], v[16:17], v[48:49] neg_lo:[0,1] neg_hi:[0,1]
v_pk_add_f32 v[16:17], v[16:17], v[48:49]
v_pk_add_f32 v[48:49], v[18:19], v[50:51] neg_lo:[0,1] neg_hi:[0,1]
v_pk_add_f32 v[18:19], v[18:19], v[50:51]
v_pk_mul_f32 v[50:51], v[48:49], s[50:51] op_sel:[0,0] op_sel_hi:[0,1] neg_lo:[0,0] neg_hi:[0,1]
v_pk_fma_f32 v[50:51], v[48:49], s[50:51], v[50:51] op_sel:[1,1,0] op_sel_hi:[1,0,1] neg_lo:[0,0,0] neg_hi:[0,0,0]
v_pk_add_f32 v[48:49], v[20:21], v[52:53] neg_lo:[0,1] neg_hi:[0,1]
v_pk_add_f32 v[20:21], v[20:21], v[52:53]
v_pk_mul_f32 v[52:53], v[48:49], s[54:55] op_sel:[0,0] op_sel_hi:[0,1] neg_lo:[0,0] neg_hi:[0,1]
v_pk_fma_f32 v[52:53], v[48:49], s[54:55], v[52:53] op_sel:[1,1,0] op_sel_hi:[1,0,1] neg_lo:[0,0,0] neg_hi:[0,0,0]
v_pk_add_f32 v[48:49], v[22:23], v[54:55] neg_lo:[0,1] neg_hi:[0,1]
v_pk_add_f32 v[22:23], v[22:23], v[54:55]
v_pk_mul_f32 v[54:55], v[48:49], s[58:59] op_sel:[0,0] op_sel_hi:[0,1] neg_lo:[0,0] neg_hi:[0,1]
v_pk_fma_f32 v[54:55], v[48:49], s[58:59], v[54:55] op_sel:[1,1,0] op_sel_hi:[1,0,1] neg_lo:[0,0,0] neg_hi:[0,0,0]
v_pk_add_f32 v[48:49], v[24:25], v[56:57] neg_lo:[0,1] neg_hi:[0,1]
v_pk_add_f32 v[24:25], v[24:25], v[56:57]
v_pk_mul_f32 v[56:57], v[48:49], s[62:63] op_sel:[0,0] op_sel_hi:[0,1] neg_lo:[0,0] neg_hi:[0,1]
v_pk_fma_f32 v[56:57], v[48:49], s[62:63], v[56:57] op_sel:[1,1,0] op_sel_hi:[1,0,1] neg_lo:[0,0,0] neg_hi:[0,0,0]
v_pk_add_f32 v[48:49], v[26:27], v[58:59] neg_lo:[0,1] neg_hi:[0,1]
v_pk_add_f32 v[26:27], v[26:27], v[58:59]
v_pk_mul_f32 v[58:59], v[48:49], s[58:59] op_sel:[0,1] op_sel_hi:[0,0] neg_lo:[0,0] neg_hi:[0,1]
v_pk_fma_f32 v[58:59], v[48:49], s[58:59], v[58:59] op_sel:[1,0,0] op_sel_hi:[1,1,1] neg_lo:[0,0,0] neg_hi:[0,0,0]
v_pk_add_f32 v[48:49], v[28:29], v[60:61] neg_lo:[0,1] neg_hi:[0,1]
v_pk_add_f32 v[28:29], v[28:29], v[60:61]
v_pk_mul_f32 v[60:61], v[48:49], s[54:55] op_sel:[0,1] op_sel_hi:[0,0] neg_lo:[0,0] neg_hi:[0,1]
v_pk_fma_f32 v[60:61], v[48:49], s[54:55], v[60:61] op_sel:[1,0,0] op_sel_hi:[1,1,1] neg_lo:[0,0,0] neg_hi:[0,0,0]
v_pk_add_f32 v[48:49], v[30:31], v[62:63] neg_lo:[0,1] neg_hi:[0,1]
v_pk_add_f32 v[30:31], v[30:31], v[62:63]
v_pk_mul_f32 v[62:63], v[48:49], s[50:51] op_sel:[0,1] op_sel_hi:[0,0] neg_lo:[0,0] neg_hi:[0,1]
v_pk_fma_f32 v[62:63], v[48:49], s[50:51], v[62:63] op_sel:[1,0,0] op_sel_hi:[1,1,1] neg_lo:[0,0,0] neg_hi:[0,0,0]
v_pk_add_f32 v[48:49], v[32:33], v[64:65] op_sel:[1,1] op_sel_hi:[0,0] neg_lo:[0,1] neg_hi:[1,0]
v_pk_add_f32 v[32:33], v[32:33], v[64:65]
v_pk_add_f32 v[64:65], v[34:35], v[66:67] neg_lo:[0,1] neg_hi:[0,1]
v_pk_add_f32 v[34:35], v[34:35], v[66:67]
v_pk_mul_f32 v[66:67], v[64:65], s[50:51] op_sel:[0,1] op_sel_hi:[0,0] neg_lo:[0,1] neg_hi:[0,1]
v_pk_fma_f32 v[66:67], v[64:65], s[50:51], v[66:67] op_sel:[1,0,0] op_sel_hi:[1,1,1] neg_lo:[0,0,0] neg_hi:[0,1,0]
v_pk_add_f32 v[64:65], v[36:37], v[68:69] neg_lo:[0,1] neg_hi:[0,1]
v_pk_add_f32 v[36:37], v[36:37], v[68:69]
v_pk_mul_f32 v[68:69], v[64:65], s[54:55] op_sel:[0,1] op_sel_hi:[0,0] neg_lo:[0,1] neg_hi:[0,1]
v_pk_fma_f32 v[68:69], v[64:65], s[54:55], v[68:69] op_sel:[1,0,0] op_sel_hi:[1,1,1] neg_lo:[0,0,0] neg_hi:[0,1,0]
v_pk_add_f32 v[64:65], v[38:39], v[70:71] neg_lo:[0,1] neg_hi:[0,1]
v_pk_add_f32 v[38:39], v[38:39], v[70:71]
v_pk_mul_f32 v[70:71], v[64:65], s[58:59] op_sel:[0,1] op_sel_hi:[0,0] neg_lo:[0,1] neg_hi:[0,1]
v_pk_fma_f32 v[70:71], v[64:65], s[58:59], v[70:71] op_sel:[1,0,0] op_sel_hi:[1,1,1] neg_lo:[0,0,0] neg_hi:[0,1,0]
v_pk_add_f32 v[64:65], v[40:41], v[72:73] neg_lo:[0,1] neg_hi:[0,1]
v_pk_add_f32 v[40:41], v[40:41], v[72:73]
v_pk_mul_f32 v[72:73], v[64:65], s[62:63] op_sel:[0,0] op_sel_hi:[0,1] neg_lo:[0,1] neg_hi:[0,1]
v_pk_fma_f32 v[72:73], v[64:65], s[62:63], v[72:73] op_sel:[1,1,0] op_sel_hi:[1,0,1] neg_lo:[0,0,0] neg_hi:[0,1,0]
v_pk_add_f32 v[64:65], v[42:43], v[74:75] neg_lo:[0,1] neg_hi:[0,1]
v_pk_add_f32 v[42:43], v[42:43], v[74:75]
v_pk_mul_f32 v[74:75], v[64:65], s[58:59] op_sel:[0,0] op_sel_hi:[0,1] neg_lo:[0,1] neg_hi:[0,1]
v_pk_fma_f32 v[74:75], v[64:65], s[58:59], v[74:75] op_sel:[1,1,0] op_sel_hi:[1,0,1] neg_lo:[0,0,0] neg_hi:[0,1,0]
v_pk_add_f32 v[64:65], v[44:45], v[76:77] neg_lo:[0,1] neg_hi:[0,1]
v_pk_add_f32 v[44:45], v[44:45], v[76:77]
v_pk_mul_f32 v[76:77], v[64:65], s[54:55] op_sel:[0,0] op_sel_hi:[0,1] neg_lo:[0,1] neg_hi:[0,1]
v_pk_fma_f32 v[76:77], v[64:65], s[54:55], v[76:77] op_sel:[1,1,0] op_sel_hi:[1,0,1] neg_lo:[0,0,0] neg_hi:[0,1,0]
v_pk_add_f32 v[64:65], v[46:47], v[78:79] neg_lo:[0,1] neg_hi:[0,1]
v_pk_add_f32 v[46:47], v[46:47], v[78:79]
v_pk_mul_f32 v[78:79], v[64:65], s[50:51] op_sel:[0,0] op_sel_hi:[0,1] neg_lo:[0,1] neg_hi:[0,1]
v_pk_fma_f32 v[78:79], v[64:65], s[50:51], v[78:79] op_sel:[1,1,0] op_sel_hi:[1,0,1] neg_lo:[0,0,0] neg_hi:[0,1,0]
v_pk_add_f32 v[64:65], v[16:17], v[32:33] neg_lo:[0,1] neg_hi:[0,1]
v_pk_add_f32 v[16:17], v[16:17], v[32:33]
v_pk_add_f32 v[32:33], v[18:19], v[34:35] neg_lo:[0,1] neg_hi:[0,1]
v_pk_add_f32 v[18:19], v[18:19], v[34:35]
v_pk_mul_f32 v[34:35], v[32:33], s[54:55] op_sel:[0,0] op_sel_hi:[0,1] neg_lo:[0,0] neg_hi:[0,1]
v_pk_fma_f32 v[34:35], v[32:33], s[54:55], v[34:35] op_sel:[1,1,0] op_sel_hi:[1,0,1] neg_lo:[0,0,0] neg_hi:[0,0,0]
v_pk_add_f32 v[32:33], v[20:21], v[36:37] neg_lo:[0,1] neg_hi:[0,1]
v_pk_add_f32 v[20:21], v[20:21], v[36:37]
v_pk_mul_f32 v[36:37], v[32:33], s[62:63] op_sel:[0,0] op_sel_hi:[0,1] neg_lo:[0,0] neg_hi:[0,1]
v_pk_fma_f32 v[36:37], v[32:33], s[62:63], v[36:37] op_sel:[1,1,0] op_sel_hi:[1,0,1] neg_lo:[0,0,0] neg_hi:[0,0,0]
v_pk_add_f32 v[32:33], v[22:23], v[38:39] neg_lo:[0,1] neg_hi:[0,1]
v_pk_add_f32 v[22:23], v[22:23], v[38:39]
v_pk_mul_f32 v[38:39], v[32:33], s[54:55] op_sel:[0,1] op_sel_hi:[0,0] neg_lo:[0,0] neg_hi:[0,1]
v_pk_fma_f32 v[38:39], v[32:33], s[54:55], v[38:39] op_sel:[1,0,0] op_sel_hi:[1,1,1] neg_lo:[0,0,0] neg_hi:[0,0,0]
v_pk_add_f32 v[32:33], v[24:25], v[40:41] op_sel:[1,1] op_sel_hi:[0,0] neg_lo:[0,1] neg_hi:[1,0]
v_pk_add_f32 v[24:25], v[24:25], v[40:41]
v_pk_add_f32 v[40:41], v[26:27], v[42:43] neg_lo:[0,1] neg_hi:[0,1]
v_pk_add_f32 v[26:27], v[26:27], v[42:43]
v_pk_mul_f32 v[42:43], v[40:41], s[54:55] op_sel:[0,1] op_sel_hi:[0,0] neg_lo:[0,1] neg_hi:[0,1]
v_pk_fma_f32 v[42:43], v[40:41], s[54:55], v[42:43] op_sel:[1,0,0] op_sel_hi:[1,1,1] neg_lo:[0,0,0] neg_hi:[0,1,0]
v_pk_add_f32 v[40:41], v[28:29], v[44:45] neg_lo:[0,1] neg_hi:[0,1]
v_pk_add_f32 v[28:29], v[28:29], v[44:45]
v_pk_mul_f32 v[44:45], v[40:41], s[62:63] op_sel:[0,0] op_sel_hi:[0,1] neg_lo:[0,1] neg_hi:[0,1]
v_pk_fma_f32 v[44:45], v[40:41], s[62:63], v[44:45] op_sel:[1,1,0] op_sel_hi:[1,0,1] neg_lo:[0,0,0] neg_hi:[0,1,0]
v_pk_add_f32 v[40:41], v[30:31], v[46:47] neg_lo:[0,1] neg_hi:[0,1]
v_pk_add_f32 v[30:31], v[30:31], v[46:47]
v_pk_mul_f32 v[46:47], v[40:41], s[54:55] op_sel:[0,0] op_sel_hi:[0,1] neg_lo:[0,1] neg_hi:[0,1]
v_pk_fma_f32 v[46:47], v[40:41], s[54:55], v[46:47] op_sel:[1,1,0] op_sel_hi:[1,0,1] neg_lo:[0,0,0] neg_hi:[0,1,0]
v_pk_add_f32 v[40:41], v[14:15], v[48:49] neg_lo:[0,1] neg_hi:[0,1]
v_pk_add_f32 v[14:15], v[14:15], v[48:49]
v_pk_add_f32 v[48:49], v[50:51], v[66:67] neg_lo:[0,1] neg_hi:[0,1]
v_pk_add_f32 v[50:51], v[50:51], v[66:67]
v_pk_mul_f32 v[66:67], v[48:49], s[54:55] op_sel:[0,0] op_sel_hi:[0,1] neg_lo:[0,0] neg_hi:[0,1]
v_pk_fma_f32 v[66:67], v[48:49], s[54:55], v[66:67] op_sel:[1,1,0] op_sel_hi:[1,0,1] neg_lo:[0,0,0] neg_hi:[0,0,0]
v_pk_add_f32 v[48:49], v[52:53], v[68:69] neg_lo:[0,1] neg_hi:[0,1]
v_pk_add_f32 v[52:53], v[52:53], v[68:69]
v_pk_mul_f32 v[68:69], v[48:49], s[62:63] op_sel:[0,0] op_sel_hi:[0,1] neg_lo:[0,0] neg_hi:[0,1]
v_pk_fma_f32 v[68:69], v[48:49], s[62:63], v[68:69] op_sel:[1,1,0] op_sel_hi:[1,0,1] neg_lo:[0,0,0] neg_hi:[0,0,0]
v_pk_add_f32 v[48:49], v[54:55], v[70:71] neg_lo:[0,1] neg_hi:[0,1]
v_pk_add_f32 v[54:55], v[54:55], v[70:71]
v_pk_mul_f32 v[70:71], v[48:49], s[54:55] op_sel:[0,1] op_sel_hi:[0,0] neg_lo:[0,0] neg_hi:[0,1]
v_pk_fma_f32 v[70:71], v[48:49], s[54:55], v[70:71] op_sel:[1,0,0] op_sel_hi:[1,1,1] neg_lo:[0,0,0] neg_hi:[0,0,0]
v_pk_add_f32 v[48:49], v[56:57], v[72:73] op_sel:[1,1] op_sel_hi:[0,0] neg_lo:[0,1] neg_hi:[1,0]
v_pk_add_f32 v[56:57], v[56:57], v[72:73]
v_pk_add_f32 v[72:73], v[58:59], v[74:75] neg_lo:[0,1] neg_hi:[0,1]
v_pk_add_f32 v[58:59], v[58:59], v[74:75]
v_pk_mul_f32 v[74:75], v[72:73], s[54:55] op_sel:[0,1] op_sel_hi:[0,0] neg_lo:[0,1] neg_hi:[0,1]
v_pk_fma_f32 v[74:75], v[72:73], s[54:55], v[74:75] op_sel:[1,0,0] op_sel_hi:[1,1,1] neg_lo:[0,0,0] neg_hi:[0,1,0]
v_pk_add_f32 v[72:73], v[60:61], v[76:77] neg_lo:[0,1] neg_hi:[0,1]
v_pk_add_f32 v[60:61], v[60:61], v[76:77]
v_pk_mul_f32 v[76:77], v[72:73], s[62:63] op_sel:[0,0] op_sel_hi:[0,1] neg_lo:[0,1] neg_hi:[0,1]
v_pk_fma_f32 v[76:77], v[72:73], s[62:63], v[76:77] op_sel:[1,1,0] op_sel_hi:[1,0,1] neg_lo:[0,0,0] neg_hi:[0,1,0]
v_pk_add_f32 v[72:73], v[62:63], v[78:79] neg_lo:[0,1] neg_hi:[0,1]
v_pk_add_f32 v[62:63], v[62:63], v[78:79]
v_pk_mul_f32 v[78:79], v[72:73], s[54:55] op_sel:[0,0] op_sel_hi:[0,1] neg_lo:[0,1] neg_hi:[0,1]
v_pk_fma_f32 v[78:79], v[72:73], s[54:55], v[78:79] op_sel:[1,1,0] op_sel_hi:[1,0,1] neg_lo:[0,0,0] neg_hi:[0,1,0]
v_pk_add_f32 v[72:73], v[16:17], v[24:25] neg_lo:[0,1] neg_hi:[0,1]
v_pk_add_f32 v[16:17], v[16:17], v[24:25]
v_pk_add_f32 v[24:25], v[18:19], v[26:27] neg_lo:[0,1] neg_hi:[0,1]
v_pk_add_f32 v[18:19], v[18:19], v[26:27]
v_pk_mul_f32 v[26:27], v[24:25], s[62:63] op_sel:[0,0] op_sel_hi:[0,1] neg_lo:[0,0] neg_hi:[0,1]
v_pk_fma_f32 v[26:27], v[24:25], s[62:63], v[26:27] op_sel:[1,1,0] op_sel_hi:[1,0,1] neg_lo:[0,0,0] neg_hi:[0,0,0]
v_pk_add_f32 v[24:25], v[20:21], v[28:29] op_sel:[1,1] op_sel_hi:[0,0] neg_lo:[0,1] neg_hi:[1,0]
v_pk_add_f32 v[20:21], v[20:21], v[28:29]
v_pk_add_f32 v[28:29], v[22:23], v[30:31] neg_lo:[0,1] neg_hi:[0,1]
v_pk_add_f32 v[22:23], v[22:23], v[30:31]
v_pk_mul_f32 v[30:31], v[28:29], s[62:63] op_sel:[0,0] op_sel_hi:[0,1] neg_lo:[0,1] neg_hi:[0,1]
v_pk_fma_f32 v[30:31], v[28:29], s[62:63], v[30:31] op_sel:[1,1,0] op_sel_hi:[1,0,1] neg_lo:[0,0,0] neg_hi:[0,1,0]
v_pk_add_f32 v[28:29], v[64:65], v[32:33] neg_lo:[0,1] neg_hi:[0,1]
v_pk_add_f32 v[64:65], v[64:65], v[32:33]
v_pk_add_f32 v[32:33], v[34:35], v[42:43] neg_lo:[0,1] neg_hi:[0,1]
v_pk_add_f32 v[34:35], v[34:35], v[42:43]
v_pk_mul_f32 v[42:43], v[32:33], s[62:63] op_sel:[0,0] op_sel_hi:[0,1] neg_lo:[0,0] neg_hi:[0,1]
v_pk_fma_f32 v[42:43], v[32:33], s[62:63], v[42:43] op_sel:[1,1,0] op_sel_hi:[1,0,1] neg_lo:[0,0,0] neg_hi:[0,0,0]
v_pk_add_f32 v[32:33], v[36:37], v[44:45] op_sel:[1,1] op_sel_hi:[0,0] neg_lo:[0,1] neg_hi:[1,0]
v_pk_add_f32 v[36:37], v[36:37], v[44:45]
v_pk_add_f32 v[44:45], v[38:39], v[46:47] neg_lo:[0,1] neg_hi:[0,1]
v_pk_add_f32 v[38:39], v[38:39], v[46:47]
v_pk_mul_f32 v[46:47], v[44:45], s[62:63] op_sel:[0,0] op_sel_hi:[0,1] neg_lo:[0,1] neg_hi:[0,1]
v_pk_fma_f32 v[46:47], v[44:45], s[62:63], v[46:47] op_sel:[1,1,0] op_sel_hi:[1,0,1] neg_lo:[0,0,0] neg_hi:[0,1,0]
v_pk_add_f32 v[44:45], v[14:15], v[56:57] neg_lo:[0,1] neg_hi:[0,1]
v_pk_add_f32 v[14:15], v[14:15], v[56:57]
v_pk_add_f32 v[56:57], v[50:51], v[58:59] neg_lo:[0,1] neg_hi:[0,1]
v_pk_add_f32 v[50:51], v[50:51], v[58:59]
v_pk_mul_f32 v[58:59], v[56:57], s[62:63] op_sel:[0,0] op_sel_hi:[0,1] neg_lo:[0,0] neg_hi:[0,1]
v_pk_fma_f32 v[58:59], v[56:57], s[62:63], v[58:59] op_sel:[1,1,0] op_sel_hi:[1,0,1] neg_lo:[0,0,0] neg_hi:[0,0,0]
v_pk_add_f32 v[56:57], v[52:53], v[60:61] op_sel:[1,1] op_sel_hi:[0,0] neg_lo:[0,1] neg_hi:[1,0]
v_pk_add_f32 v[52:53], v[52:53], v[60:61]
v_pk_add_f32 v[60:61], v[54:55], v[62:63] neg_lo:[0,1] neg_hi:[0,1]
v_pk_add_f32 v[54:55], v[54:55], v[62:63]
v_pk_mul_f32 v[62:63], v[60:61], s[62:63] op_sel:[0,0] op_sel_hi:[0,1] neg_lo:[0,1] neg_hi:[0,1]
v_pk_fma_f32 v[62:63], v[60:61], s[62:63], v[62:63] op_sel:[1,1,0] op_sel_hi:[1,0,1] neg_lo:[0,0,0] neg_hi:[0,1,0]
v_pk_add_f32 v[60:61], v[40:41], v[48:49] neg_lo:[0,1] neg_hi:[0,1]
v_pk_add_f32 v[40:41], v[40:41], v[48:49]
v_pk_add_f32 v[48:49], v[66:67], v[74:75] neg_lo:[0,1] neg_hi:[0,1]
v_pk_add_f32 v[66:67], v[66:67], v[74:75]
v_pk_mul_f32 v[74:75], v[48:49], s[62:63] op_sel:[0,0] op_sel_hi:[0,1] neg_lo:[0,0] neg_hi:[0,1]
v_pk_fma_f32 v[74:75], v[48:49], s[62:63], v[74:75] op_sel:[1,1,0] op_sel_hi:[1,0,1] neg_lo:[0,0,0] neg_hi:[0,0,0]
v_pk_add_f32 v[48:49], v[68:69], v[76:77] op_sel:[1,1] op_sel_hi:[0,0] neg_lo:[0,1] neg_hi:[1,0]
v_pk_add_f32 v[68:69], v[68:69], v[76:77]
v_pk_add_f32 v[76:77], v[70:71], v[78:79] neg_lo:[0,1] neg_hi:[0,1]
v_pk_add_f32 v[70:71], v[70:71], v[78:79]
v_pk_mul_f32 v[78:79], v[76:77], s[62:63] op_sel:[0,0] op_sel_hi:[0,1] neg_lo:[0,1] neg_hi:[0,1]
v_pk_fma_f32 v[78:79], v[76:77], s[62:63], v[78:79] op_sel:[1,1,0] op_sel_hi:[1,0,1] neg_lo:[0,0,0] neg_hi:[0,1,0]
v_pk_add_f32 v[76:77], v[16:17], v[20:21] neg_lo:[0,1] neg_hi:[0,1]
v_pk_add_f32 v[16:17], v[16:17], v[20:21]
v_pk_add_f32 v[20:21], v[18:19], v[22:23] op_sel:[1,1] op_sel_hi:[0,0] neg_lo:[0,1] neg_hi:[1,0]
v_pk_add_f32 v[18:19], v[18:19], v[22:23]
v_pk_add_f32 v[22:23], v[72:73], v[24:25] neg_lo:[0,1] neg_hi:[0,1]
v_pk_add_f32 v[72:73], v[72:73], v[24:25]
v_pk_add_f32 v[24:25], v[26:27], v[30:31] op_sel:[1,1] op_sel_hi:[0,0] neg_lo:[0,1] neg_hi:[1,0]
v_pk_add_f32 v[26:27], v[26:27], v[30:31]
v_pk_add_f32 v[30:31], v[64:65], v[36:37] neg_lo:[0,1] neg_hi:[0,1]
v_pk_add_f32 v[64:65], v[64:65], v[36:37]
v_pk_add_f32 v[36:37], v[34:35], v[38:39] op_sel:[1,1] op_sel_hi:[0,0] neg_lo:[0,1] neg_hi:[1,0]
v_pk_add_f32 v[34:35], v[34:35], v[38:39]
v_pk_add_f32 v[38:39], v[28:29], v[32:33] neg_lo:[0,1] neg_hi:[0,1]
v_pk_add_f32 v[28:29], v[28:29], v[32:33]
v_pk_add_f32 v[32:33], v[42:43], v[46:47] op_sel:[1,1] op_sel_hi:[0,0] neg_lo:[0,1] neg_hi:[1,0]
v_pk_add_f32 v[42:43], v[42:43], v[46:47]
v_pk_add_f32 v[46:47], v[14:15], v[52:53] neg_lo:[0,1] neg_hi:[0,1]
v_pk_add_f32 v[14:15], v[14:15], v[52:53]
v_pk_add_f32 v[52:53], v[50:51], v[54:55] op_sel:[1,1] op_sel_hi:[0,0] neg_lo:[0,1] neg_hi:[1,0]
v_pk_add_f32 v[50:51], v[50:51], v[54:55]
v_pk_add_f32 v[54:55], v[44:45], v[56:57] neg_lo:[0,1] neg_hi:[0,1]
v_pk_add_f32 v[44:45], v[44:45], v[56:57]
v_pk_add_f32 v[56:57], v[58:59], v[62:63] op_sel:[1,1] op_sel_hi:[0,0] neg_lo:[0,1] neg_hi:[1,0]
v_pk_add_f32 v[58:59], v[58:59], v[62:63]
v_pk_add_f32 v[62:63], v[40:41], v[68:69] neg_lo:[0,1] neg_hi:[0,1]
v_pk_add_f32 v[40:41], v[40:41], v[68:69]
v_pk_add_f32 v[68:69], v[66:67], v[70:71] op_sel:[1,1] op_sel_hi:[0,0] neg_lo:[0,1] neg_hi:[1,0]
v_pk_add_f32 v[66:67], v[66:67], v[70:71]
v_pk_add_f32 v[70:71], v[60:61], v[48:49] neg_lo:[0,1] neg_hi:[0,1]
v_pk_add_f32 v[60:61], v[60:61], v[48:49]
v_pk_add_f32 v[48:49], v[74:75], v[78:79] op_sel:[1,1] op_sel_hi:[0,0] neg_lo:[0,1] neg_hi:[1,0]
v_pk_add_f32 v[74:75], v[74:75], v[78:79]
v_pk_add_f32 v[78:79], v[16:17], v[18:19] neg_lo:[0,1] neg_hi:[0,1]
v_pk_add_f32 v[16:17], v[16:17], v[18:19]
v_pk_add_f32 v[18:19], v[76:77], v[20:21] neg_lo:[0,1] neg_hi:[0,1]
v_pk_add_f32 v[76:77], v[76:77], v[20:21]
v_pk_add_f32 v[20:21], v[72:73], v[26:27] neg_lo:[0,1] neg_hi:[0,1]
v_pk_add_f32 v[72:73], v[72:73], v[26:27]
v_pk_add_f32 v[26:27], v[22:23], v[24:25] neg_lo:[0,1] neg_hi:[0,1]
v_pk_add_f32 v[22:23], v[22:23], v[24:25]
v_pk_add_f32 v[24:25], v[64:65], v[34:35] neg_lo:[0,1] neg_hi:[0,1]
v_pk_add_f32 v[64:65], v[64:65], v[34:35]
v_pk_add_f32 v[34:35], v[30:31], v[36:37] neg_lo:[0,1] neg_hi:[0,1]
v_pk_add_f32 v[30:31], v[30:31], v[36:37]
v_pk_add_f32 v[36:37], v[28:29], v[42:43] neg_lo:[0,1] neg_hi:[0,1]
v_pk_add_f32 v[28:29], v[28:29], v[42:43]
v_pk_add_f32 v[42:43], v[38:39], v[32:33] neg_lo:[0,1] neg_hi:[0,1]
v_pk_add_f32 v[38:39], v[38:39], v[32:33]
v_pk_add_f32 v[32:33], v[14:15], v[50:51] neg_lo:[0,1] neg_hi:[0,1]
v_pk_add_f32 v[14:15], v[14:15], v[50:51]
v_pk_add_f32 v[50:51], v[46:47], v[52:53] neg_lo:[0,1] neg_hi:[0,1]
v_pk_add_f32 v[46:47], v[46:47], v[52:53]
v_pk_add_f32 v[52:53], v[44:45], v[58:59] neg_lo:[0,1] neg_hi:[0,1]
v_pk_add_f32 v[44:45], v[44:45], v[58:59]
v_pk_add_f32 v[58:59], v[54:55], v[56:57] neg_lo:[0,1] neg_hi:[0,1]
v_pk_add_f32 v[54:55], v[54:55], v[56:57]
v_pk_add_f32 v[56:57], v[40:41], v[66:67] neg_lo:[0,1] neg_hi:[0,1]
v_pk_add_f32 v[40:41], v[40:41], v[66:67]
v_pk_add_f32 v[66:67], v[62:63], v[68:69] neg_lo:[0,1] neg_hi:[0,1]
v_pk_add_f32 v[62:63], v[62:63], v[68:69]
v_pk_add_f32 v[68:69], v[60:61], v[74:75] neg_lo:[0,1] neg_hi:[0,1]
v_pk_add_f32 v[60:61], v[60:61], v[74:75]
v_pk_add_f32 v[74:75], v[70:71], v[48:49] neg_lo:[0,1] neg_hi:[0,1]
v_pk_add_f32 v[70:71], v[70:71], v[48:49]
v_pk_mul_f32 v[48:49], v[14:15], v[82:83] op_sel:[0,0] op_sel_hi:[0,1] neg_lo:[0,0] neg_hi:[0,0]
v_pk_fma_f32 v[14:15], v[14:15], v[82:83], v[48:49] op_sel:[1,1,0] op_sel_hi:[1,0,1] neg_lo:[0,1,0] neg_hi:[0,0,0]
v_pk_mul_f32 v[48:49], v[64:65], v[84:85] op_sel:[0,0] op_sel_hi:[0,1] neg_lo:[0,0] neg_hi:[0,0]
v_pk_fma_f32 v[64:65], v[64:65], v[84:85], v[48:49] op_sel:[1,1,0] op_sel_hi:[1,0,1] neg_lo:[0,1,0] neg_hi:[0,0,0]
v_pk_mul_f32 v[48:49], v[40:41], v[86:87] op_sel:[0,0] op_sel_hi:[0,1] neg_lo:[0,0] neg_hi:[0,0]
v_pk_fma_f32 v[40:41], v[40:41], v[86:87], v[48:49] op_sel:[1,1,0] op_sel_hi:[1,0,1] neg_lo:[0,1,0] neg_hi:[0,0,0]
v_pk_mul_f32 v[48:49], v[72:73], v[88:89] op_sel:[0,0] op_sel_hi:[0,1] neg_lo:[0,0] neg_hi:[0,0]
v_pk_fma_f32 v[72:73], v[72:73], v[88:89], v[48:49] op_sel:[1,1,0] op_sel_hi:[1,0,1] neg_lo:[0,1,0] neg_hi:[0,0,0]
v_pk_mul_f32 v[48:49], v[44:45], v[90:91] op_sel:[0,0] op_sel_hi:[0,1] neg_lo:[0,0] neg_hi:[0,0]
v_pk_fma_f32 v[44:45], v[44:45], v[90:91], v[48:49] op_sel:[1,1,0] op_sel_hi:[1,0,1] neg_lo:[0,1,0] neg_hi:[0,0,0]
v_pk_mul_f32 v[48:49], v[28:29], v[92:93] op_sel:[0,0] op_sel_hi:[0,1] neg_lo:[0,0] neg_hi:[0,0]
v_pk_fma_f32 v[28:29], v[28:29], v[92:93], v[48:49] op_sel:[1,1,0] op_sel_hi:[1,0,1] neg_lo:[0,1,0] neg_hi:[0,0,0]
v_pk_mul_f32 v[48:49], v[60:61], v[94:95] op_sel:[0,0] op_sel_hi:[0,1] neg_lo:[0,0] neg_hi:[0,0]
v_pk_fma_f32 v[60:61], v[60:61], v[94:95], v[48:49] op_sel:[1,1,0] op_sel_hi:[1,0,1] neg_lo:[0,1,0] neg_hi:[0,0,0]
v_pk_mul_f32 v[48:49], v[76:77], v[96:97] op_sel:[0,0] op_sel_hi:[0,1] neg_lo:[0,0] neg_hi:[0,0]
v_pk_fma_f32 v[76:77], v[76:77], v[96:97], v[48:49] op_sel:[1,1,0] op_sel_hi:[1,0,1] neg_lo:[0,1,0] neg_hi:[0,0,0]
v_pk_mul_f32 v[48:49], v[46:47], v[98:99] op_sel:[0,0] op_sel_hi:[0,1] neg_lo:[0,0] neg_hi:[0,0]
v_pk_fma_f32 v[46:47], v[46:47], v[98:99], v[48:49] op_sel:[1,1,0] op_sel_hi:[1,0,1] neg_lo:[0,1,0] neg_hi:[0,0,0]
v_pk_mul_f32 v[48:49], v[30:31], v[100:101] op_sel:[0,0] op_sel_hi:[0,1] neg_lo:[0,0] neg_hi:[0,0]
v_pk_fma_f32 v[30:31], v[30:31], v[100:101], v[48:49] op_sel:[1,1,0] op_sel_hi:[1,0,1] neg_lo:[0,1,0] neg_hi:[0,0,0]
v_pk_mul_f32 v[48:49], v[62:63], v[102:103] op_sel:[0,0] op_sel_hi:[0,1] neg_lo:[0,0] neg_hi:[0,0]
v_pk_fma_f32 v[62:63], v[62:63], v[102:103], v[48:49] op_sel:[1,1,0] op_sel_hi:[1,0,1] neg_lo:[0,1,0] neg_hi:[0,0,0]
v_pk_mul_f32 v[48:49], v[22:23], v[104:105] op_sel:[0,0] op_sel_hi:[0,1] neg_lo:[0,0] neg_hi:[0,0]
v_pk_fma_f32 v[22:23], v[22:23], v[104:105], v[48:49] op_sel:[1,1,0] op_sel_hi:[1,0,1] neg_lo:[0,1,0] neg_hi:[0,0,0]
v_pk_mul_f32 v[48:49], v[54:55], v[106:107] op_sel:[0,0] op_sel_hi:[0,1] neg_lo:[0,0] neg_hi:[0,0]
v_pk_fma_f32 v[54:55], v[54:55], v[106:107], v[48:49] op_sel:[1,1,0] op_sel_hi:[1,0,1] neg_lo:[0,1,0] neg_hi:[0,0,0]
v_pk_mul_f32 v[48:49], v[38:39], v[108:109] op_sel:[0,0] op_sel_hi:[0,1] neg_lo:[0,0] neg_hi:[0,0]
v_pk_fma_f32 v[38:39], v[38:39], v[108:109], v[48:49] op_sel:[1,1,0] op_sel_hi:[1,0,1] neg_lo:[0,1,0] neg_hi:[0,0,0]
v_pk_mul_f32 v[48:49], v[70:71], v[110:111] op_sel:[0,0] op_sel_hi:[0,1] neg_lo:[0,0] neg_hi:[0,0]
v_pk_fma_f32 v[70:71], v[70:71], v[110:111], v[48:49] op_sel:[1,1,0] op_sel_hi:[1,0,1] neg_lo:[0,1,0] neg_hi:[0,0,0]
v_pk_mul_f32 v[48:49], v[78:79], v[112:113] op_sel:[0,0] op_sel_hi:[0,1] neg_lo:[0,0] neg_hi:[0,0]
v_pk_fma_f32 v[78:79], v[78:79], v[112:113], v[48:49] op_sel:[1,1,0] op_sel_hi:[1,0,1] neg_lo:[0,1,0] neg_hi:[0,0,0]
v_pk_mul_f32 v[48:49], v[32:33], v[114:115] op_sel:[0,0] op_sel_hi:[0,1] neg_lo:[0,0] neg_hi:[0,0]
v_pk_fma_f32 v[32:33], v[32:33], v[114:115], v[48:49] op_sel:[1,1,0] op_sel_hi:[1,0,1] neg_lo:[0,1,0] neg_hi:[0,0,0]
v_pk_mul_f32 v[48:49], v[24:25], v[116:117] op_sel:[0,0] op_sel_hi:[0,1] neg_lo:[0,0] neg_hi:[0,0]
v_pk_fma_f32 v[24:25], v[24:25], v[116:117], v[48:49] op_sel:[1,1,0] op_sel_hi:[1,0,1] neg_lo:[0,1,0] neg_hi:[0,0,0]
v_pk_mul_f32 v[48:49], v[56:57], v[118:119] op_sel:[0,0] op_sel_hi:[0,1] neg_lo:[0,0] neg_hi:[0,0]
v_pk_fma_f32 v[56:57], v[56:57], v[118:119], v[48:49] op_sel:[1,1,0] op_sel_hi:[1,0,1] neg_lo:[0,1,0] neg_hi:[0,0,0]
v_pk_mul_f32 v[48:49], v[20:21], v[120:121] op_sel:[0,0] op_sel_hi:[0,1] neg_lo:[0,0] neg_hi:[0,0]
v_pk_fma_f32 v[20:21], v[20:21], v[120:121], v[48:49] op_sel:[1,1,0] op_sel_hi:[1,0,1] neg_lo:[0,1,0] neg_hi:[0,0,0]
v_pk_mul_f32 v[48:49], v[52:53], v[122:123] op_sel:[0,0] op_sel_hi:[0,1] neg_lo:[0,0] neg_hi:[0,0]
v_pk_fma_f32 v[52:53], v[52:53], v[122:123], v[48:49] op_sel:[1,1,0] op_sel_hi:[1,0,1] neg_lo:[0,1,0] neg_hi:[0,0,0]
v_pk_mul_f32 v[48:49], v[36:37], v[124:125] op_sel:[0,0] op_sel_hi:[0,1] neg_lo:[0,0] neg_hi:[0,0]
v_pk_fma_f32 v[36:37], v[36:37], v[124:125], v[48:49] op_sel:[1,1,0] op_sel_hi:[1,0,1] neg_lo:[0,1,0] neg_hi:[0,0,0]
v_pk_mul_f32 v[48:49], v[68:69], v[126:127] op_sel:[0,0] op_sel_hi:[0,1] neg_lo:[0,0] neg_hi:[0,0]
v_pk_fma_f32 v[68:69], v[68:69], v[126:127], v[48:49] op_sel:[1,1,0] op_sel_hi:[1,0,1] neg_lo:[0,1,0] neg_hi:[0,0,0]
v_pk_mul_f32 v[48:49], v[18:19], v[128:129] op_sel:[0,0] op_sel_hi:[0,1] neg_lo:[0,0] neg_hi:[0,0]
v_pk_fma_f32 v[18:19], v[18:19], v[128:129], v[48:49] op_sel:[1,1,0] op_sel_hi:[1,0,1] neg_lo:[0,1,0] neg_hi:[0,0,0]
v_pk_mul_f32 v[48:49], v[50:51], v[130:131] op_sel:[0,0] op_sel_hi:[0,1] neg_lo:[0,0] neg_hi:[0,0]
v_pk_fma_f32 v[50:51], v[50:51], v[130:131], v[48:49] op_sel:[1,1,0] op_sel_hi:[1,0,1] neg_lo:[0,1,0] neg_hi:[0,0,0]
v_pk_mul_f32 v[48:49], v[34:35], v[132:133] op_sel:[0,0] op_sel_hi:[0,1] neg_lo:[0,0] neg_hi:[0,0]
v_pk_fma_f32 v[34:35], v[34:35], v[132:133], v[48:49] op_sel:[1,1,0] op_sel_hi:[1,0,1] neg_lo:[0,1,0] neg_hi:[0,0,0]
v_pk_mul_f32 v[48:49], v[66:67], v[134:135] op_sel:[0,0] op_sel_hi:[0,1] neg_lo:[0,0] neg_hi:[0,0]
v_pk_fma_f32 v[66:67], v[66:67], v[134:135], v[48:49] op_sel:[1,1,0] op_sel_hi:[1,0,1] neg_lo:[0,1,0] neg_hi:[0,0,0]
v_pk_mul_f32 v[48:49], v[26:27], v[136:137] op_sel:[0,0] op_sel_hi:[0,1] neg_lo:[0,0] neg_hi:[0,0]
v_pk_fma_f32 v[26:27], v[26:27], v[136:137], v[48:49] op_sel:[1,1,0] op_sel_hi:[1,0,1] neg_lo:[0,1,0] neg_hi:[0,0,0]
v_pk_mul_f32 v[48:49], v[58:59], v[138:139] op_sel:[0,0] op_sel_hi:[0,1] neg_lo:[0,0] neg_hi:[0,0]
v_pk_fma_f32 v[58:59], v[58:59], v[138:139], v[48:49] op_sel:[1,1,0] op_sel_hi:[1,0,1] neg_lo:[0,1,0] neg_hi:[0,0,0]
v_pk_mul_f32 v[48:49], v[42:43], v[140:141] op_sel:[0,0] op_sel_hi:[0,1] neg_lo:[0,0] neg_hi:[0,0]
v_pk_fma_f32 v[42:43], v[42:43], v[140:141], v[48:49] op_sel:[1,1,0] op_sel_hi:[1,0,1] neg_lo:[0,1,0] neg_hi:[0,0,0]
v_pk_mul_f32 v[48:49], v[74:75], v[142:143] op_sel:[0,0] op_sel_hi:[0,1] neg_lo:[0,0] neg_hi:[0,0]
v_pk_fma_f32 v[74:75], v[74:75], v[142:143], v[48:49] op_sel:[1,1,0] op_sel_hi:[1,0,1] neg_lo:[0,1,0] neg_hi:[0,0,0]
ds_write_b64 v3, v[16:17] offset:0
ds_write_b64 v3, v[14:15] offset:528
ds_write_b64 v3, v[64:65] offset:1056
ds_write_b64 v3, v[40:41] offset:1584
ds_write_b64 v3, v[72:73] offset:2112
ds_write_b64 v3, v[44:45] offset:2640
ds_write_b64 v3, v[28:29] offset:3168
ds_write_b64 v3, v[60:61] offset:3696
ds_write_b64 v3, v[76:77] offset:4224
ds_write_b64 v3, v[46:47] offset:4752
ds_write_b64 v3, v[30:31] offset:5280
ds_write_b64 v3, v[62:63] offset:5808
ds_write_b64 v3, v[22:23] offset:6336
ds_write_b64 v3, v[54:55] offset:6864
ds_write_b64 v3, v[38:39] offset:7392
ds_write_b64 v3, v[70:71] offset:7920
ds_write_b64 v3, v[78:79] offset:8448
ds_write_b64 v3, v[32:33] offset:8976
ds_write_b64 v3, v[24:25] offset:9504
ds_write_b64 v3, v[56:57] offset:10032
ds_write_b64 v3, v[20:21] offset:10560
ds_write_b64 v3, v[52:53] offset:11088
ds_write_b64 v3, v[36:37] offset:11616
ds_write_b64 v3, v[68:69] offset:12144
ds_write_b64 v3, v[18:19] offset:12672
ds_write_b64 v3, v[50:51] offset:13200
ds_write_b64 v3, v[34:35] offset:13728
ds_write_b64 v3, v[66:67] offset:14256
ds_write_b64 v3, v[26:27] offset:14784
ds_write_b64 v3, v[58:59] offset:15312
ds_write_b64 v3, v[42:43] offset:15840
ds_write_b64 v3, v[74:75] offset:16368
s_waitcnt lgkmcnt(0)
ds_read_b64 v[16:17], v4 offset:0
ds_read_b64 v[48:49], v4 offset:256
ds_read_b64 v[18:19], v4 offset:16
ds_read_b64 v[50:51], v4 offset:272
ds_read_b64 v[20:21], v4 offset:32
ds_read_b64 v[52:53], v4 offset:288
ds_read_b64 v[22:23], v4 offset:48
ds_read_b64 v[54:55], v4 offset:304
ds_read_b64 v[24:25], v4 offset:64
ds_read_b64 v[56:57], v4 offset:320
ds_read_b64 v[26:27], v4 offset:80
ds_read_b64 v[58:59], v4 offset:336
ds_read_b64 v[28:29], v4 offset:96
ds_read_b64 v[60:61], v4 offset:352
ds_read_b64 v[30:31], v4 offset:112
ds_read_b64 v[62:63], v4 offset:368
ds_read_b64 v[32:33], v4 offset:128
ds_read_b64 v[64:65], v4 offset:384
ds_read_b64 v[34:35], v4 offset:144
ds_read_b64 v[66:67], v4 offset:400
ds_read_b64 v[36:37], v4 offset:160
ds_read_b64 v[68:69], v4 offset:416
ds_read_b64 v[38:39], v4 offset:176
ds_read_b64 v[70:71], v4 offset:432
ds_read_b64 v[40:41], v4 offset:192
ds_read_b64 v[72:73], v4 offset:448
ds_read_b64 v[42:43], v4 offset:208
ds_read_b64 v[74:75], v4 offset:464
ds_read_b64 v[44:45], v4 offset:224
ds_read_b64 v[76:77], v4 offset:480
ds_read_b64 v[46:47], v4 offset:240
ds_read_b64 v[78:79], v4 offset:496
s_waitcnt lgkmcnt(0)
v_pk_add_f32 v[14:15], v[16:17], v[48:49] neg_lo:[0,1] neg_hi:[0,1]
v_pk_add_f32 v[16:17], v[16:17], v[48:49]
v_pk_add_f32 v[48:49], v[18:19], v[50:51] neg_lo:[0,1] neg_hi:[0,1]
v_pk_add_f32 v[18:19], v[18:19], v[50:51]
v_pk_mul_f32 v[50:51], v[48:49], s[50:51] op_sel:[0,0] op_sel_hi:[0,1] neg_lo:[0,0] neg_hi:[0,1]
v_pk_fma_f32 v[50:51], v[48:49], s[50:51], v[50:51] op_sel:[1,1,0] op_sel_hi:[1,0,1] neg_lo:[0,0,0] neg_hi:[0,0,0]
v_pk_add_f32 v[48:49], v[20:21], v[52:53] neg_lo:[0,1] neg_hi:[0,1]
v_pk_add_f32 v[20:21], v[20:21], v[52:53]
v_pk_mul_f32 v[52:53], v[48:49], s[54:55] op_sel:[0,0] op_sel_hi:[0,1] neg_lo:[0,0] neg_hi:[0,1]
v_pk_fma_f32 v[52:53], v[48:49], s[54:55], v[52:53] op_sel:[1,1,0] op_sel_hi:[1,0,1] neg_lo:[0,0,0] neg_hi:[0,0,0]
v_pk_add_f32 v[48:49], v[22:23], v[54:55] neg_lo:[0,1] neg_hi:[0,1]
v_pk_add_f32 v[22:23], v[22:23], v[54:55]
v_pk_mul_f32 v[54:55], v[48:49], s[58:59] op_sel:[0,0] op_sel_hi:[0,1] neg_lo:[0,0] neg_hi:[0,1]
v_pk_fma_f32 v[54:55], v[48:49], s[58:59], v[54:55] op_sel:[1,1,0] op_sel_hi:[1,0,1] neg_lo:[0,0,0] neg_hi:[0,0,0]
v_pk_add_f32 v[48:49], v[24:25], v[56:57] neg_lo:[0,1] neg_hi:[0,1]
v_pk_add_f32 v[24:25], v[24:25], v[56:57]
v_pk_mul_f32 v[56:57], v[48:49], s[62:63] op_sel:[0,0] op_sel_hi:[0,1] neg_lo:[0,0] neg_hi:[0,1]
v_pk_fma_f32 v[56:57], v[48:49], s[62:63], v[56:57] op_sel:[1,1,0] op_sel_hi:[1,0,1] neg_lo:[0,0,0] neg_hi:[0,0,0]
v_pk_add_f32 v[48:49], v[26:27], v[58:59] neg_lo:[0,1] neg_hi:[0,1]
v_pk_add_f32 v[26:27], v[26:27], v[58:59]
v_pk_mul_f32 v[58:59], v[48:49], s[58:59] op_sel:[0,1] op_sel_hi:[0,0] neg_lo:[0,0] neg_hi:[0,1]
v_pk_fma_f32 v[58:59], v[48:49], s[58:59], v[58:59] op_sel:[1,0,0] op_sel_hi:[1,1,1] neg_lo:[0,0,0] neg_hi:[0,0,0]
v_pk_add_f32 v[48:49], v[28:29], v[60:61] neg_lo:[0,1] neg_hi:[0,1]
v_pk_add_f32 v[28:29], v[28:29], v[60:61]
v_pk_mul_f32 v[60:61], v[48:49], s[54:55] op_sel:[0,1] op_sel_hi:[0,0] neg_lo:[0,0] neg_hi:[0,1]
v_pk_fma_f32 v[60:61], v[48:49], s[54:55], v[60:61] op_sel:[1,0,0] op_sel_hi:[1,1,1] neg_lo:[0,0,0] neg_hi:[0,0,0]
v_pk_add_f32 v[48:49], v[30:31], v[62:63] neg_lo:[0,1] neg_hi:[0,1]
v_pk_add_f32 v[30:31], v[30:31], v[62:63]
v_pk_mul_f32 v[62:63], v[48:49], s[50:51] op_sel:[0,1] op_sel_hi:[0,0] neg_lo:[0,0] neg_hi:[0,1]
v_pk_fma_f32 v[62:63], v[48:49], s[50:51], v[62:63] op_sel:[1,0,0] op_sel_hi:[1,1,1] neg_lo:[0,0,0] neg_hi:[0,0,0]
v_pk_add_f32 v[48:49], v[32:33], v[64:65] op_sel:[1,1] op_sel_hi:[0,0] neg_lo:[0,1] neg_hi:[1,0]
v_pk_add_f32 v[32:33], v[32:33], v[64:65]
v_pk_add_f32 v[64:65], v[34:35], v[66:67] neg_lo:[0,1] neg_hi:[0,1]
v_pk_add_f32 v[34:35], v[34:35], v[66:67]
v_pk_mul_f32 v[66:67], v[64:65], s[50:51] op_sel:[0,1] op_sel_hi:[0,0] neg_lo:[0,1] neg_hi:[0,1]
v_pk_fma_f32 v[66:67], v[64:65], s[50:51], v[66:67] op_sel:[1,0,0] op_sel_hi:[1,1,1] neg_lo:[0,0,0] neg_hi:[0,1,0]
v_pk_add_f32 v[64:65], v[36:37], v[68:69] neg_lo:[0,1] neg_hi:[0,1]
v_pk_add_f32 v[36:37], v[36:37], v[68:69]
v_pk_mul_f32 v[68:69], v[64:65], s[54:55] op_sel:[0,1] op_sel_hi:[0,0] neg_lo:[0,1] neg_hi:[0,1]
v_pk_fma_f32 v[68:69], v[64:65], s[54:55], v[68:69] op_sel:[1,0,0] op_sel_hi:[1,1,1] neg_lo:[0,0,0] neg_hi:[0,1,0]
v_pk_add_f32 v[64:65], v[38:39], v[70:71] neg_lo:[0,1] neg_hi:[0,1]
v_pk_add_f32 v[38:39], v[38:39], v[70:71]
v_pk_mul_f32 v[70:71], v[64:65], s[58:59] op_sel:[0,1] op_sel_hi:[0,0] neg_lo:[0,1] neg_hi:[0,1]
v_pk_fma_f32 v[70:71], v[64:65], s[58:59], v[70:71] op_sel:[1,0,0] op_sel_hi:[1,1,1] neg_lo:[0,0,0] neg_hi:[0,1,0]
v_pk_add_f32 v[64:65], v[40:41], v[72:73] neg_lo:[0,1] neg_hi:[0,1]
v_pk_add_f32 v[40:41], v[40:41], v[72:73]
v_pk_mul_f32 v[72:73], v[64:65], s[62:63] op_sel:[0,0] op_sel_hi:[0,1] neg_lo:[0,1] neg_hi:[0,1]
v_pk_fma_f32 v[72:73], v[64:65], s[62:63], v[72:73] op_sel:[1,1,0] op_sel_hi:[1,0,1] neg_lo:[0,0,0] neg_hi:[0,1,0]
v_pk_add_f32 v[64:65], v[42:43], v[74:75] neg_lo:[0,1] neg_hi:[0,1]
v_pk_add_f32 v[42:43], v[42:43], v[74:75]
v_pk_mul_f32 v[74:75], v[64:65], s[58:59] op_sel:[0,0] op_sel_hi:[0,1] neg_lo:[0,1] neg_hi:[0,1]
v_pk_fma_f32 v[74:75], v[64:65], s[58:59], v[74:75] op_sel:[1,1,0] op_sel_hi:[1,0,1] neg_lo:[0,0,0] neg_hi:[0,1,0]
v_pk_add_f32 v[64:65], v[44:45], v[76:77] neg_lo:[0,1] neg_hi:[0,1]
v_pk_add_f32 v[44:45], v[44:45], v[76:77]
v_pk_mul_f32 v[76:77], v[64:65], s[54:55] op_sel:[0,0] op_sel_hi:[0,1] neg_lo:[0,1] neg_hi:[0,1]
v_pk_fma_f32 v[76:77], v[64:65], s[54:55], v[76:77] op_sel:[1,1,0] op_sel_hi:[1,0,1] neg_lo:[0,0,0] neg_hi:[0,1,0]
v_pk_add_f32 v[64:65], v[46:47], v[78:79] neg_lo:[0,1] neg_hi:[0,1]
v_pk_add_f32 v[46:47], v[46:47], v[78:79]
v_pk_mul_f32 v[78:79], v[64:65], s[50:51] op_sel:[0,0] op_sel_hi:[0,1] neg_lo:[0,1] neg_hi:[0,1]
v_pk_fma_f32 v[78:79], v[64:65], s[50:51], v[78:79] op_sel:[1,1,0] op_sel_hi:[1,0,1] neg_lo:[0,0,0] neg_hi:[0,1,0]
v_pk_add_f32 v[64:65], v[16:17], v[32:33] neg_lo:[0,1] neg_hi:[0,1]
v_pk_add_f32 v[16:17], v[16:17], v[32:33]
v_pk_add_f32 v[32:33], v[18:19], v[34:35] neg_lo:[0,1] neg_hi:[0,1]
v_pk_add_f32 v[18:19], v[18:19], v[34:35]
v_pk_mul_f32 v[34:35], v[32:33], s[54:55] op_sel:[0,0] op_sel_hi:[0,1] neg_lo:[0,0] neg_hi:[0,1]
v_pk_fma_f32 v[34:35], v[32:33], s[54:55], v[34:35] op_sel:[1,1,0] op_sel_hi:[1,0,1] neg_lo:[0,0,0] neg_hi:[0,0,0]
v_pk_add_f32 v[32:33], v[20:21], v[36:37] neg_lo:[0,1] neg_hi:[0,1]
v_pk_add_f32 v[20:21], v[20:21], v[36:37]
v_pk_mul_f32 v[36:37], v[32:33], s[62:63] op_sel:[0,0] op_sel_hi:[0,1] neg_lo:[0,0] neg_hi:[0,1]
v_pk_fma_f32 v[36:37], v[32:33], s[62:63], v[36:37] op_sel:[1,1,0] op_sel_hi:[1,0,1] neg_lo:[0,0,0] neg_hi:[0,0,0]
v_pk_add_f32 v[32:33], v[22:23], v[38:39] neg_lo:[0,1] neg_hi:[0,1]
v_pk_add_f32 v[22:23], v[22:23], v[38:39]
v_pk_mul_f32 v[38:39], v[32:33], s[54:55] op_sel:[0,1] op_sel_hi:[0,0] neg_lo:[0,0] neg_hi:[0,1]
v_pk_fma_f32 v[38:39], v[32:33], s[54:55], v[38:39] op_sel:[1,0,0] op_sel_hi:[1,1,1] neg_lo:[0,0,0] neg_hi:[0,0,0]
v_pk_add_f32 v[32:33], v[24:25], v[40:41] op_sel:[1,1] op_sel_hi:[0,0] neg_lo:[0,1] neg_hi:[1,0]
v_pk_add_f32 v[24:25], v[24:25], v[40:41]
v_pk_add_f32 v[40:41], v[26:27], v[42:43] neg_lo:[0,1] neg_hi:[0,1]
v_pk_add_f32 v[26:27], v[26:27], v[42:43]
v_pk_mul_f32 v[42:43], v[40:41], s[54:55] op_sel:[0,1] op_sel_hi:[0,0] neg_lo:[0,1] neg_hi:[0,1]
v_pk_fma_f32 v[42:43], v[40:41], s[54:55], v[42:43] op_sel:[1,0,0] op_sel_hi:[1,1,1] neg_lo:[0,0,0] neg_hi:[0,1,0]
v_pk_add_f32 v[40:41], v[28:29], v[44:45] neg_lo:[0,1] neg_hi:[0,1]
v_pk_add_f32 v[28:29], v[28:29], v[44:45]
v_pk_mul_f32 v[44:45], v[40:41], s[62:63] op_sel:[0,0] op_sel_hi:[0,1] neg_lo:[0,1] neg_hi:[0,1]
v_pk_fma_f32 v[44:45], v[40:41], s[62:63], v[44:45] op_sel:[1,1,0] op_sel_hi:[1,0,1] neg_lo:[0,0,0] neg_hi:[0,1,0]
v_pk_add_f32 v[40:41], v[30:31], v[46:47] neg_lo:[0,1] neg_hi:[0,1]
v_pk_add_f32 v[30:31], v[30:31], v[46:47]
v_pk_mul_f32 v[46:47], v[40:41], s[54:55] op_sel:[0,0] op_sel_hi:[0,1] neg_lo:[0,1] neg_hi:[0,1]
v_pk_fma_f32 v[46:47], v[40:41], s[54:55], v[46:47] op_sel:[1,1,0] op_sel_hi:[1,0,1] neg_lo:[0,0,0] neg_hi:[0,1,0]
v_pk_add_f32 v[40:41], v[14:15], v[48:49] neg_lo:[0,1] neg_hi:[0,1]
v_pk_add_f32 v[14:15], v[14:15], v[48:49]
v_pk_add_f32 v[48:49], v[50:51], v[66:67] neg_lo:[0,1] neg_hi:[0,1]
v_pk_add_f32 v[50:51], v[50:51], v[66:67]
v_pk_mul_f32 v[66:67], v[48:49], s[54:55] op_sel:[0,0] op_sel_hi:[0,1] neg_lo:[0,0] neg_hi:[0,1]
v_pk_fma_f32 v[66:67], v[48:49], s[54:55], v[66:67] op_sel:[1,1,0] op_sel_hi:[1,0,1] neg_lo:[0,0,0] neg_hi:[0,0,0]
v_pk_add_f32 v[48:49], v[52:53], v[68:69] neg_lo:[0,1] neg_hi:[0,1]
v_pk_add_f32 v[52:53], v[52:53], v[68:69]
v_pk_mul_f32 v[68:69], v[48:49], s[62:63] op_sel:[0,0] op_sel_hi:[0,1] neg_lo:[0,0] neg_hi:[0,1]
v_pk_fma_f32 v[68:69], v[48:49], s[62:63], v[68:69] op_sel:[1,1,0] op_sel_hi:[1,0,1] neg_lo:[0,0,0] neg_hi:[0,0,0]
v_pk_add_f32 v[48:49], v[54:55], v[70:71] neg_lo:[0,1] neg_hi:[0,1]
v_pk_add_f32 v[54:55], v[54:55], v[70:71]
v_pk_mul_f32 v[70:71], v[48:49], s[54:55] op_sel:[0,1] op_sel_hi:[0,0] neg_lo:[0,0] neg_hi:[0,1]
v_pk_fma_f32 v[70:71], v[48:49], s[54:55], v[70:71] op_sel:[1,0,0] op_sel_hi:[1,1,1] neg_lo:[0,0,0] neg_hi:[0,0,0]
v_pk_add_f32 v[48:49], v[56:57], v[72:73] op_sel:[1,1] op_sel_hi:[0,0] neg_lo:[0,1] neg_hi:[1,0]
v_pk_add_f32 v[56:57], v[56:57], v[72:73]
v_pk_add_f32 v[72:73], v[58:59], v[74:75] neg_lo:[0,1] neg_hi:[0,1]
v_pk_add_f32 v[58:59], v[58:59], v[74:75]
v_pk_mul_f32 v[74:75], v[72:73], s[54:55] op_sel:[0,1] op_sel_hi:[0,0] neg_lo:[0,1] neg_hi:[0,1]
v_pk_fma_f32 v[74:75], v[72:73], s[54:55], v[74:75] op_sel:[1,0,0] op_sel_hi:[1,1,1] neg_lo:[0,0,0] neg_hi:[0,1,0]
v_pk_add_f32 v[72:73], v[60:61], v[76:77] neg_lo:[0,1] neg_hi:[0,1]
v_pk_add_f32 v[60:61], v[60:61], v[76:77]
v_pk_mul_f32 v[76:77], v[72:73], s[62:63] op_sel:[0,0] op_sel_hi:[0,1] neg_lo:[0,1] neg_hi:[0,1]
v_pk_fma_f32 v[76:77], v[72:73], s[62:63], v[76:77] op_sel:[1,1,0] op_sel_hi:[1,0,1] neg_lo:[0,0,0] neg_hi:[0,1,0]
v_pk_add_f32 v[72:73], v[62:63], v[78:79] neg_lo:[0,1] neg_hi:[0,1]
v_pk_add_f32 v[62:63], v[62:63], v[78:79]
v_pk_mul_f32 v[78:79], v[72:73], s[54:55] op_sel:[0,0] op_sel_hi:[0,1] neg_lo:[0,1] neg_hi:[0,1]
v_pk_fma_f32 v[78:79], v[72:73], s[54:55], v[78:79] op_sel:[1,1,0] op_sel_hi:[1,0,1] neg_lo:[0,0,0] neg_hi:[0,1,0]
v_pk_add_f32 v[72:73], v[16:17], v[24:25] neg_lo:[0,1] neg_hi:[0,1]
v_pk_add_f32 v[16:17], v[16:17], v[24:25]
v_pk_add_f32 v[24:25], v[18:19], v[26:27] neg_lo:[0,1] neg_hi:[0,1]
v_pk_add_f32 v[18:19], v[18:19], v[26:27]
v_pk_mul_f32 v[26:27], v[24:25], s[62:63] op_sel:[0,0] op_sel_hi:[0,1] neg_lo:[0,0] neg_hi:[0,1]
v_pk_fma_f32 v[26:27], v[24:25], s[62:63], v[26:27] op_sel:[1,1,0] op_sel_hi:[1,0,1] neg_lo:[0,0,0] neg_hi:[0,0,0]
v_pk_add_f32 v[24:25], v[20:21], v[28:29] op_sel:[1,1] op_sel_hi:[0,0] neg_lo:[0,1] neg_hi:[1,0]
v_pk_add_f32 v[20:21], v[20:21], v[28:29]
v_pk_add_f32 v[28:29], v[22:23], v[30:31] neg_lo:[0,1] neg_hi:[0,1]
v_pk_add_f32 v[22:23], v[22:23], v[30:31]
v_pk_mul_f32 v[30:31], v[28:29], s[62:63] op_sel:[0,0] op_sel_hi:[0,1] neg_lo:[0,1] neg_hi:[0,1]
v_pk_fma_f32 v[30:31], v[28:29], s[62:63], v[30:31] op_sel:[1,1,0] op_sel_hi:[1,0,1] neg_lo:[0,0,0] neg_hi:[0,1,0]
v_pk_add_f32 v[28:29], v[64:65], v[32:33] neg_lo:[0,1] neg_hi:[0,1]
v_pk_add_f32 v[64:65], v[64:65], v[32:33]
v_pk_add_f32 v[32:33], v[34:35], v[42:43] neg_lo:[0,1] neg_hi:[0,1]
v_pk_add_f32 v[34:35], v[34:35], v[42:43]
v_pk_mul_f32 v[42:43], v[32:33], s[62:63] op_sel:[0,0] op_sel_hi:[0,1] neg_lo:[0,0] neg_hi:[0,1]
v_pk_fma_f32 v[42:43], v[32:33], s[62:63], v[42:43] op_sel:[1,1,0] op_sel_hi:[1,0,1] neg_lo:[0,0,0] neg_hi:[0,0,0]
v_pk_add_f32 v[32:33], v[36:37], v[44:45] op_sel:[1,1] op_sel_hi:[0,0] neg_lo:[0,1] neg_hi:[1,0]
v_pk_add_f32 v[36:37], v[36:37], v[44:45]
v_pk_add_f32 v[44:45], v[38:39], v[46:47] neg_lo:[0,1] neg_hi:[0,1]
v_pk_add_f32 v[38:39], v[38:39], v[46:47]
v_pk_mul_f32 v[46:47], v[44:45], s[62:63] op_sel:[0,0] op_sel_hi:[0,1] neg_lo:[0,1] neg_hi:[0,1]
v_pk_fma_f32 v[46:47], v[44:45], s[62:63], v[46:47] op_sel:[1,1,0] op_sel_hi:[1,0,1] neg_lo:[0,0,0] neg_hi:[0,1,0]
v_pk_add_f32 v[44:45], v[14:15], v[56:57] neg_lo:[0,1] neg_hi:[0,1]
v_pk_add_f32 v[14:15], v[14:15], v[56:57]
v_pk_add_f32 v[56:57], v[50:51], v[58:59] neg_lo:[0,1] neg_hi:[0,1]
v_pk_add_f32 v[50:51], v[50:51], v[58:59]
v_pk_mul_f32 v[58:59], v[56:57], s[62:63] op_sel:[0,0] op_sel_hi:[0,1] neg_lo:[0,0] neg_hi:[0,1]
v_pk_fma_f32 v[58:59], v[56:57], s[62:63], v[58:59] op_sel:[1,1,0] op_sel_hi:[1,0,1] neg_lo:[0,0,0] neg_hi:[0,0,0]
v_pk_add_f32 v[56:57], v[52:53], v[60:61] op_sel:[1,1] op_sel_hi:[0,0] neg_lo:[0,1] neg_hi:[1,0]
v_pk_add_f32 v[52:53], v[52:53], v[60:61]
v_pk_add_f32 v[60:61], v[54:55], v[62:63] neg_lo:[0,1] neg_hi:[0,1]
v_pk_add_f32 v[54:55], v[54:55], v[62:63]
v_pk_mul_f32 v[62:63], v[60:61], s[62:63] op_sel:[0,0] op_sel_hi:[0,1] neg_lo:[0,1] neg_hi:[0,1]
v_pk_fma_f32 v[62:63], v[60:61], s[62:63], v[62:63] op_sel:[1,1,0] op_sel_hi:[1,0,1] neg_lo:[0,0,0] neg_hi:[0,1,0]
v_pk_add_f32 v[60:61], v[40:41], v[48:49] neg_lo:[0,1] neg_hi:[0,1]
v_pk_add_f32 v[40:41], v[40:41], v[48:49]
v_pk_add_f32 v[48:49], v[66:67], v[74:75] neg_lo:[0,1] neg_hi:[0,1]
v_pk_add_f32 v[66:67], v[66:67], v[74:75]
v_pk_mul_f32 v[74:75], v[48:49], s[62:63] op_sel:[0,0] op_sel_hi:[0,1] neg_lo:[0,0] neg_hi:[0,1]
v_pk_fma_f32 v[74:75], v[48:49], s[62:63], v[74:75] op_sel:[1,1,0] op_sel_hi:[1,0,1] neg_lo:[0,0,0] neg_hi:[0,0,0]
v_pk_add_f32 v[48:49], v[68:69], v[76:77] op_sel:[1,1] op_sel_hi:[0,0] neg_lo:[0,1] neg_hi:[1,0]
v_pk_add_f32 v[68:69], v[68:69], v[76:77]
v_pk_add_f32 v[76:77], v[70:71], v[78:79] neg_lo:[0,1] neg_hi:[0,1]
v_pk_add_f32 v[70:71], v[70:71], v[78:79]
v_pk_mul_f32 v[78:79], v[76:77], s[62:63] op_sel:[0,0] op_sel_hi:[0,1] neg_lo:[0,1] neg_hi:[0,1]
v_pk_fma_f32 v[78:79], v[76:77], s[62:63], v[78:79] op_sel:[1,1,0] op_sel_hi:[1,0,1] neg_lo:[0,0,0] neg_hi:[0,1,0]
v_pk_add_f32 v[76:77], v[16:17], v[20:21] neg_lo:[0,1] neg_hi:[0,1]
v_pk_add_f32 v[16:17], v[16:17], v[20:21]
v_pk_add_f32 v[20:21], v[18:19], v[22:23] op_sel:[1,1] op_sel_hi:[0,0] neg_lo:[0,1] neg_hi:[1,0]
v_pk_add_f32 v[18:19], v[18:19], v[22:23]
v_pk_add_f32 v[22:23], v[72:73], v[24:25] neg_lo:[0,1] neg_hi:[0,1]
v_pk_add_f32 v[72:73], v[72:73], v[24:25]
v_pk_add_f32 v[24:25], v[26:27], v[30:31] op_sel:[1,1] op_sel_hi:[0,0] neg_lo:[0,1] neg_hi:[1,0]
v_pk_add_f32 v[26:27], v[26:27], v[30:31]
v_pk_add_f32 v[30:31], v[64:65], v[36:37] neg_lo:[0,1] neg_hi:[0,1]
v_pk_add_f32 v[64:65], v[64:65], v[36:37]
v_pk_add_f32 v[36:37], v[34:35], v[38:39] op_sel:[1,1] op_sel_hi:[0,0] neg_lo:[0,1] neg_hi:[1,0]
v_pk_add_f32 v[34:35], v[34:35], v[38:39]
v_pk_add_f32 v[38:39], v[28:29], v[32:33] neg_lo:[0,1] neg_hi:[0,1]
v_pk_add_f32 v[28:29], v[28:29], v[32:33]
v_pk_add_f32 v[32:33], v[42:43], v[46:47] op_sel:[1,1] op_sel_hi:[0,0] neg_lo:[0,1] neg_hi:[1,0]
v_pk_add_f32 v[42:43], v[42:43], v[46:47]
v_pk_add_f32 v[46:47], v[14:15], v[52:53] neg_lo:[0,1] neg_hi:[0,1]
v_pk_add_f32 v[14:15], v[14:15], v[52:53]
v_pk_add_f32 v[52:53], v[50:51], v[54:55] op_sel:[1,1] op_sel_hi:[0,0] neg_lo:[0,1] neg_hi:[1,0]
v_pk_add_f32 v[50:51], v[50:51], v[54:55]
v_pk_add_f32 v[54:55], v[44:45], v[56:57] neg_lo:[0,1] neg_hi:[0,1]
v_pk_add_f32 v[44:45], v[44:45], v[56:57]
v_pk_add_f32 v[56:57], v[58:59], v[62:63] op_sel:[1,1] op_sel_hi:[0,0] neg_lo:[0,1] neg_hi:[1,0]
v_pk_add_f32 v[58:59], v[58:59], v[62:63]
v_pk_add_f32 v[62:63], v[40:41], v[68:69] neg_lo:[0,1] neg_hi:[0,1]
v_pk_add_f32 v[40:41], v[40:41], v[68:69]
v_pk_add_f32 v[68:69], v[66:67], v[70:71] op_sel:[1,1] op_sel_hi:[0,0] neg_lo:[0,1] neg_hi:[1,0]
v_pk_add_f32 v[66:67], v[66:67], v[70:71]
v_pk_add_f32 v[70:71], v[60:61], v[48:49] neg_lo:[0,1] neg_hi:[0,1]
v_pk_add_f32 v[60:61], v[60:61], v[48:49]
v_pk_add_f32 v[48:49], v[74:75], v[78:79] op_sel:[1,1] op_sel_hi:[0,0] neg_lo:[0,1] neg_hi:[1,0]
v_pk_add_f32 v[74:75], v[74:75], v[78:79]
v_pk_add_f32 v[78:79], v[16:17], v[18:19] neg_lo:[0,1] neg_hi:[0,1]
v_pk_add_f32 v[16:17], v[16:17], v[18:19]
v_pk_add_f32 v[18:19], v[76:77], v[20:21] neg_lo:[0,1] neg_hi:[0,1]
v_pk_add_f32 v[76:77], v[76:77], v[20:21]
v_pk_add_f32 v[20:21], v[72:73], v[26:27] neg_lo:[0,1] neg_hi:[0,1]
v_pk_add_f32 v[72:73], v[72:73], v[26:27]
v_pk_add_f32 v[26:27], v[22:23], v[24:25] neg_lo:[0,1] neg_hi:[0,1]
v_pk_add_f32 v[22:23], v[22:23], v[24:25]
v_pk_add_f32 v[24:25], v[64:65], v[34:35] neg_lo:[0,1] neg_hi:[0,1]
v_pk_add_f32 v[64:65], v[64:65], v[34:35]
v_pk_add_f32 v[34:35], v[30:31], v[36:37] neg_lo:[0,1] neg_hi:[0,1]
v_pk_add_f32 v[30:31], v[30:31], v[36:37]
v_pk_add_f32 v[36:37], v[28:29], v[42:43] neg_lo:[0,1] neg_hi:[0,1]
v_pk_add_f32 v[28:29], v[28:29], v[42:43]
v_pk_add_f32 v[42:43], v[38:39], v[32:33] neg_lo:[0,1] neg_hi:[0,1]
v_pk_add_f32 v[38:39], v[38:39], v[32:33]
v_pk_add_f32 v[32:33], v[14:15], v[50:51] neg_lo:[0,1] neg_hi:[0,1]
v_pk_add_f32 v[14:15], v[14:15], v[50:51]
v_pk_add_f32 v[50:51], v[46:47], v[52:53] neg_lo:[0,1] neg_hi:[0,1]
v_pk_add_f32 v[46:47], v[46:47], v[52:53]
v_pk_add_f32 v[52:53], v[44:45], v[58:59] neg_lo:[0,1] neg_hi:[0,1]
v_pk_add_f32 v[44:45], v[44:45], v[58:59]
v_pk_add_f32 v[58:59], v[54:55], v[56:57] neg_lo:[0,1] neg_hi:[0,1]
v_pk_add_f32 v[54:55], v[54:55], v[56:57]
v_pk_add_f32 v[56:57], v[40:41], v[66:67] neg_lo:[0,1] neg_hi:[0,1]
v_pk_add_f32 v[40:41], v[40:41], v[66:67]
v_pk_add_f32 v[66:67], v[62:63], v[68:69] neg_lo:[0,1] neg_hi:[0,1]
v_pk_add_f32 v[62:63], v[62:63], v[68:69]
v_pk_add_f32 v[68:69], v[60:61], v[74:75] neg_lo:[0,1] neg_hi:[0,1]
v_pk_add_f32 v[60:61], v[60:61], v[74:75]
v_pk_add_f32 v[74:75], v[70:71], v[48:49] neg_lo:[0,1] neg_hi:[0,1]
v_pk_add_f32 v[70:71], v[70:71], v[48:49]
s_mov_b64 exec, s[18:19]
v_pk_add_f32 v[16:17], v[16:17], 0 neg_lo:[1,0] neg_hi:[1,0]
v_pk_mul_f32 v[48:49], v[14:15], s[48:49] op_sel:[0,0] op_sel_hi:[0,1] neg_lo:[0,1] neg_hi:[0,0]
v_pk_fma_f32 v[14:15], v[14:15], s[48:49], v[48:49] op_sel:[1,1,0] op_sel_hi:[1,0,1] neg_lo:[0,1,0] neg_hi:[0,1,0]
v_pk_mul_f32 v[48:49], v[64:65], s[50:51] op_sel:[0,0] op_sel_hi:[0,1] neg_lo:[0,1] neg_hi:[0,0]
v_pk_fma_f32 v[64:65], v[64:65], s[50:51], v[48:49] op_sel:[1,1,0] op_sel_hi:[1,0,1] neg_lo:[0,1,0] neg_hi:[0,1,0]
v_pk_mul_f32 v[48:49], v[40:41], s[52:53] op_sel:[0,0] op_sel_hi:[0,1] neg_lo:[0,1] neg_hi:[0,0]
v_pk_fma_f32 v[40:41], v[40:41], s[52:53], v[48:49] op_sel:[1,1,0] op_sel_hi:[1,0,1] neg_lo:[0,1,0] neg_hi:[0,1,0]
v_pk_mul_f32 v[48:49], v[72:73], s[54:55] op_sel:[0,0] op_sel_hi:[0,1] neg_lo:[0,1] neg_hi:[0,0]
v_pk_fma_f32 v[72:73], v[72:73], s[54:55], v[48:49] op_sel:[1,1,0] op_sel_hi:[1,0,1] neg_lo:[0,1,0] neg_hi:[0,1,0]
v_pk_mul_f32 v[48:49], v[44:45], s[56:57] op_sel:[0,0] op_sel_hi:[0,1] neg_lo:[0,1] neg_hi:[0,0]
v_pk_fma_f32 v[44:45], v[44:45], s[56:57], v[48:49] op_sel:[1,1,0] op_sel_hi:[1,0,1] neg_lo:[0,1,0] neg_hi:[0,1,0]
v_pk_mul_f32 v[48:49], v[28:29], s[58:59] op_sel:[0,0] op_sel_hi:[0,1] neg_lo:[0,1] neg_hi:[0,0]
v_pk_fma_f32 v[28:29], v[28:29], s[58:59], v[48:49] op_sel:[1,1,0] op_sel_hi:[1,0,1] neg_lo:[0,1,0] neg_hi:[0,1,0]
v_pk_mul_f32 v[48:49], v[60:61], s[60:61] op_sel:[0,0] op_sel_hi:[0,1] neg_lo:[0,1] neg_hi:[0,0]
v_pk_fma_f32 v[60:61], v[60:61], s[60:61], v[48:49] op_sel:[1,1,0] op_sel_hi:[1,0,1] neg_lo:[0,1,0] neg_hi:[0,1,0]
v_pk_mul_f32 v[48:49], v[76:77], s[62:63] op_sel:[0,0] op_sel_hi:[0,1] neg_lo:[0,1] neg_hi:[0,0]
v_pk_fma_f32 v[76:77], v[76:77], s[62:63], v[48:49] op_sel:[1,1,0] op_sel_hi:[1,0,1] neg_lo:[0,1,0] neg_hi:[0,1,0]
v_pk_mul_f32 v[48:49], v[46:47], s[60:61] op_sel:[0,1] op_sel_hi:[0,0] neg_lo:[0,1] neg_hi:[0,0]
v_pk_fma_f32 v[46:47], v[46:47], s[60:61], v[48:49] op_sel:[1,0,0] op_sel_hi:[1,1,1] neg_lo:[0,1,0] neg_hi:[0,1,0]
v_pk_mul_f32 v[48:49], v[30:31], s[58:59] op_sel:[0,1] op_sel_hi:[0,0] neg_lo:[0,1] neg_hi:[0,0]
v_pk_fma_f32 v[30:31], v[30:31], s[58:59], v[48:49] op_sel:[1,0,0] op_sel_hi:[1,1,1] neg_lo:[0,1,0] neg_hi:[0,1,0]
v_pk_mul_f32 v[48:49], v[62:63], s[56:57] op_sel:[0,1] op_sel_hi:[0,0] neg_lo:[0,1] neg_hi:[0,0]
v_pk_fma_f32 v[62:63], v[62:63], s[56:57], v[48:49] op_sel:[1,0,0] op_sel_hi:[1,1,1] neg_lo:[0,1,0] neg_hi:[0,1,0]
v_pk_mul_f32 v[48:49], v[22:23], s[54:55] op_sel:[0,1] op_sel_hi:[0,0] neg_lo:[0,1] neg_hi:[0,0]
v_pk_fma_f32 v[22:23], v[22:23], s[54:55], v[48:49] op_sel:[1,0,0] op_sel_hi:[1,1,1] neg_lo:[0,1,0] neg_hi:[0,1,0]
v_pk_mul_f32 v[48:49], v[54:55], s[52:53] op_sel:[0,1] op_sel_hi:[0,0] neg_lo:[0,1] neg_hi:[0,0]
v_pk_fma_f32 v[54:55], v[54:55], s[52:53], v[48:49] op_sel:[1,0,0] op_sel_hi:[1,1,1] neg_lo:[0,1,0] neg_hi:[0,1,0]
v_pk_mul_f32 v[48:49], v[38:39], s[50:51] op_sel:[0,1] op_sel_hi:[0,0] neg_lo:[0,1] neg_hi:[0,0]
v_pk_fma_f32 v[38:39], v[38:39], s[50:51], v[48:49] op_sel:[1,0,0] op_sel_hi:[1,1,1] neg_lo:[0,1,0] neg_hi:[0,1,0]
v_pk_mul_f32 v[48:49], v[70:71], s[48:49] op_sel:[0,1] op_sel_hi:[0,0] neg_lo:[0,1] neg_hi:[0,0]
v_pk_fma_f32 v[70:71], v[70:71], s[48:49], v[48:49] op_sel:[1,0,0] op_sel_hi:[1,1,1] neg_lo:[0,1,0] neg_hi:[0,1,0]
v_pk_add_f32 v[78:79], v[78:79], 0 op_sel:[1,0] op_sel_hi:[0,0] neg_lo:[1,0] neg_hi:[0,0]
v_pk_mul_f32 v[48:49], v[32:33], s[48:49] op_sel:[0,1] op_sel_hi:[0,0] neg_lo:[0,0] neg_hi:[0,0]
v_pk_fma_f32 v[32:33], v[32:33], s[48:49], v[48:49] op_sel:[1,0,0] op_sel_hi:[1,1,1] neg_lo:[0,1,0] neg_hi:[0,0,0]
v_pk_mul_f32 v[48:49], v[24:25], s[50:51] op_sel:[0,1] op_sel_hi:[0,0] neg_lo:[0,0] neg_hi:[0,0]
v_pk_fma_f32 v[24:25], v[24:25], s[50:51], v[48:49] op_sel:[1,0,0] op_sel_hi:[1,1,1] neg_lo:[0,1,0] neg_hi:[0,0,0]
v_pk_mul_f32 v[48:49], v[56:57], s[52:53] op_sel:[0,1] op_sel_hi:[0,0] neg_lo:[0,0] neg_hi:[0,0]
v_pk_fma_f32 v[56:57], v[56:57], s[52:53], v[48:49] op_sel:[1,0,0] op_sel_hi:[1,1,1] neg_lo:[0,1,0] neg_hi:[0,0,0]
v_pk_mul_f32 v[48:49], v[20:21], s[54:55] op_sel:[0,1] op_sel_hi:[0,0] neg_lo:[0,0] neg_hi:[0,0]
v_pk_fma_f32 v[20:21], v[20:21], s[54:55], v[48:49] op_sel:[1,0,0] op_sel_hi:[1,1,1] neg_lo:[0,1,0] neg_hi:[0,0,0]
v_pk_mul_f32 v[48:49], v[52:53], s[56:57] op_sel:[0,1] op_sel_hi:[0,0] neg_lo:[0,0] neg_hi:[0,0]
v_pk_fma_f32 v[52:53], v[52:53], s[56:57], v[48:49] op_sel:[1,0,0] op_sel_hi:[1,1,1] neg_lo:[0,1,0] neg_hi:[0,0,0]
v_pk_mul_f32 v[48:49], v[36:37], s[58:59] op_sel:[0,1] op_sel_hi:[0,0] neg_lo:[0,0] neg_hi:[0,0]
v_pk_fma_f32 v[36:37], v[36:37], s[58:59], v[48:49] op_sel:[1,0,0] op_sel_hi:[1,1,1] neg_lo:[0,1,0] neg_hi:[0,0,0]
v_pk_mul_f32 v[48:49], v[68:69], s[60:61] op_sel:[0,1] op_sel_hi:[0,0] neg_lo:[0,0] neg_hi:[0,0]
v_pk_fma_f32 v[68:69], v[68:69], s[60:61], v[48:49] op_sel:[1,0,0] op_sel_hi:[1,1,1] neg_lo:[0,1,0] neg_hi:[0,0,0]
v_pk_mul_f32 v[48:49], v[18:19], s[62:63] op_sel:[0,0] op_sel_hi:[0,1] neg_lo:[0,0] neg_hi:[0,0]
v_pk_fma_f32 v[18:19], v[18:19], s[62:63], v[48:49] op_sel:[1,1,0] op_sel_hi:[1,0,1] neg_lo:[0,1,0] neg_hi:[0,0,0]
v_pk_mul_f32 v[48:49], v[50:51], s[60:61] op_sel:[0,0] op_sel_hi:[0,1] neg_lo:[0,0] neg_hi:[0,0]
v_pk_fma_f32 v[50:51], v[50:51], s[60:61], v[48:49] op_sel:[1,1,0] op_sel_hi:[1,0,1] neg_lo:[0,1,0] neg_hi:[0,0,0]
v_pk_mul_f32 v[48:49], v[34:35], s[58:59] op_sel:[0,0] op_sel_hi:[0,1] neg_lo:[0,0] neg_hi:[0,0]
v_pk_fma_f32 v[34:35], v[34:35], s[58:59], v[48:49] op_sel:[1,1,0] op_sel_hi:[1,0,1] neg_lo:[0,1,0] neg_hi:[0,0,0]
v_pk_mul_f32 v[48:49], v[66:67], s[56:57] op_sel:[0,0] op_sel_hi:[0,1] neg_lo:[0,0] neg_hi:[0,0]
v_pk_fma_f32 v[66:67], v[66:67], s[56:57], v[48:49] op_sel:[1,1,0] op_sel_hi:[1,0,1] neg_lo:[0,1,0] neg_hi:[0,0,0]
v_pk_mul_f32 v[48:49], v[26:27], s[54:55] op_sel:[0,0] op_sel_hi:[0,1] neg_lo:[0,0] neg_hi:[0,0]
v_pk_fma_f32 v[26:27], v[26:27], s[54:55], v[48:49] op_sel:[1,1,0] op_sel_hi:[1,0,1] neg_lo:[0,1,0] neg_hi:[0,0,0]
v_pk_mul_f32 v[48:49], v[58:59], s[52:53] op_sel:[0,0] op_sel_hi:[0,1] neg_lo:[0,0] neg_hi:[0,0]
v_pk_fma_f32 v[58:59], v[58:59], s[52:53], v[48:49] op_sel:[1,1,0] op_sel_hi:[1,0,1] neg_lo:[0,1,0] neg_hi:[0,0,0]
v_pk_mul_f32 v[48:49], v[42:43], s[50:51] op_sel:[0,0] op_sel_hi:[0,1] neg_lo:[0,0] neg_hi:[0,0]
v_pk_fma_f32 v[42:43], v[42:43], s[50:51], v[48:49] op_sel:[1,1,0] op_sel_hi:[1,0,1] neg_lo:[0,1,0] neg_hi:[0,0,0]
v_pk_mul_f32 v[48:49], v[74:75], s[48:49] op_sel:[0,0] op_sel_hi:[0,1] neg_lo:[0,0] neg_hi:[0,0]
v_pk_fma_f32 v[74:75], v[74:75], s[48:49], v[48:49] op_sel:[1,1,0] op_sel_hi:[1,0,1] neg_lo:[0,1,0] neg_hi:[0,0,0]
s_mov_b64 exec, -1
v_fmac_f32_dpp v16, v16, v9 quad_perm:[1,0,3,2] row_mask:0xf bank_mask:0xf
v_fmac_f32_dpp v17, v17, v9 quad_perm:[1,0,3,2] row_mask:0xf bank_mask:0xf
v_fmac_f32_dpp v14, v14, v9 quad_perm:[1,0,3,2] row_mask:0xf bank_mask:0xf
v_fmac_f32_dpp v15, v15, v9 quad_perm:[1,0,3,2] row_mask:0xf bank_mask:0xf
v_fmac_f32_dpp v64, v64, v9 quad_perm:[1,0,3,2] row_mask:0xf bank_mask:0xf
v_fmac_f32_dpp v65, v65, v9 quad_perm:[1,0,3,2] row_mask:0xf bank_mask:0xf
v_fmac_f32_dpp v40, v40, v9 quad_perm:[1,0,3,2] row_mask:0xf bank_mask:0xf
v_fmac_f32_dpp v41, v41, v9 quad_perm:[1,0,3,2] row_mask:0xf bank_mask:0xf
v_fmac_f32_dpp v72, v72, v9 quad_perm:[1,0,3,2] row_mask:0xf bank_mask:0xf
v_fmac_f32_dpp v73, v73, v9 quad_perm:[1,0,3,2] row_mask:0xf bank_mask:0xf
v_fmac_f32_dpp v44, v44, v9 quad_perm:[1,0,3,2] row_mask:0xf bank_mask:0xf
v_fmac_f32_dpp v45, v45, v9 quad_perm:[1,0,3,2] row_mask:0xf bank_mask:0xf
v_fmac_f32_dpp v28, v28, v9 quad_perm:[1,0,3,2] row_mask:0xf bank_mask:0xf
v_fmac_f32_dpp v29, v29, v9 quad_perm:[1,0,3,2] row_mask:0xf bank_mask:0xf
v_fmac_f32_dpp v60, v60, v9 quad_perm:[1,0,3,2] row_mask:0xf bank_mask:0xf
v_fmac_f32_dpp v61, v61, v9 quad_perm:[1,0,3,2] row_mask:0xf bank_mask:0xf
v_fmac_f32_dpp v76, v76, v9 quad_perm:[1,0,3,2] row_mask:0xf bank_mask:0xf
v_fmac_f32_dpp v77, v77, v9 quad_perm:[1,0,3,2] row_mask:0xf bank_mask:0xf
v_fmac_f32_dpp v46, v46, v9 quad_perm:[1,0,3,2] row_mask:0xf bank_mask:0xf
v_fmac_f32_dpp v47, v47, v9 quad_perm:[1,0,3,2] row_mask:0xf bank_mask:0xf
v_fmac_f32_dpp v30, v30, v9 quad_perm:[1,0,3,2] row_mask:0xf bank_mask:0xf
v_fmac_f32_dpp v31, v31, v9 quad_perm:[1,0,3,2] row_mask:0xf bank_mask:0xf
v_fmac_f32_dpp v62, v62, v9 quad_perm:[1,0,3,2] row_mask:0xf bank_mask:0xf
v_fmac_f32_dpp v63, v63, v9 quad_perm:[1,0,3,2] row_mask:0xf bank_mask:0xf
v_fmac_f32_dpp v22, v22, v9 quad_perm:[1,0,3,2] row_mask:0xf bank_mask:0xf
v_fmac_f32_dpp v23, v23, v9 quad_perm:[1,0,3,2] row_mask:0xf bank_mask:0xf
v_fmac_f32_dpp v54, v54, v9 quad_perm:[1,0,3,2] row_mask:0xf bank_mask:0xf
v_fmac_f32_dpp v55, v55, v9 quad_perm:[1,0,3,2] row_mask:0xf bank_mask:0xf
v_fmac_f32_dpp v38, v38, v9 quad_perm:[1,0,3,2] row_mask:0xf bank_mask:0xf
v_fmac_f32_dpp v39, v39, v9 quad_perm:[1,0,3,2] row_mask:0xf bank_mask:0xf
v_fmac_f32_dpp v70, v70, v9 quad_perm:[1,0,3,2] row_mask:0xf bank_mask:0xf
v_fmac_f32_dpp v71, v71, v9 quad_perm:[1,0,3,2] row_mask:0xf bank_mask:0xf
v_fmac_f32_dpp v78, v78, v9 quad_perm:[1,0,3,2] row_mask:0xf bank_mask:0xf
v_fmac_f32_dpp v79, v79, v9 quad_perm:[1,0,3,2] row_mask:0xf bank_mask:0xf
v_fmac_f32_dpp v32, v32, v9 quad_perm:[1,0,3,2] row_mask:0xf bank_mask:0xf
v_fmac_f32_dpp v33, v33, v9 quad_perm:[1,0,3,2] row_mask:0xf bank_mask:0xf
v_fmac_f32_dpp v24, v24, v9 quad_perm:[1,0,3,2] row_mask:0xf bank_mask:0xf
v_fmac_f32_dpp v25, v25, v9 quad_perm:[1,0,3,2] row_mask:0xf bank_mask:0xf
v_fmac_f32_dpp v56, v56, v9 quad_perm:[1,0,3,2] row_mask:0xf bank_mask:0xf
v_fmac_f32_dpp v57, v57, v9 quad_perm:[1,0,3,2] row_mask:0xf bank_mask:0xf
v_fmac_f32_dpp v20, v20, v9 quad_perm:[1,0,3,2] row_mask:0xf bank_mask:0xf
v_fmac_f32_dpp v21, v21, v9 quad_perm:[1,0,3,2] row_mask:0xf bank_mask:0xf
v_fmac_f32_dpp v52, v52, v9 quad_perm:[1,0,3,2] row_mask:0xf bank_mask:0xf
v_fmac_f32_dpp v53, v53, v9 quad_perm:[1,0,3,2] row_mask:0xf bank_mask:0xf
v_fmac_f32_dpp v36, v36, v9 quad_perm:[1,0,3,2] row_mask:0xf bank_mask:0xf
v_fmac_f32_dpp v37, v37, v9 quad_perm:[1,0,3,2] row_mask:0xf bank_mask:0xf
v_fmac_f32_dpp v68, v68, v9 quad_perm:[1,0,3,2] row_mask:0xf bank_mask:0xf
v_fmac_f32_dpp v69, v69, v9 quad_perm:[1,0,3,2] row_mask:0xf bank_mask:0xf
v_fmac_f32_dpp v18, v18, v9 quad_perm:[1,0,3,2] row_mask:0xf bank_mask:0xf
v_fmac_f32_dpp v19, v19, v9 quad_perm:[1,0,3,2] row_mask:0xf bank_mask:0xf
v_fmac_f32_dpp v50, v50, v9 quad_perm:[1,0,3,2] row_mask:0xf bank_mask:0xf
v_fmac_f32_dpp v51, v51, v9 quad_perm:[1,0,3,2] row_mask:0xf bank_mask:0xf
v_fmac_f32_dpp v34, v34, v9 quad_perm:[1,0,3,2] row_mask:0xf bank_mask:0xf
v_fmac_f32_dpp v35, v35, v9 quad_perm:[1,0,3,2] row_mask:0xf bank_mask:0xf
v_fmac_f32_dpp v66, v66, v9 quad_perm:[1,0,3,2] row_mask:0xf bank_mask:0xf
v_fmac_f32_dpp v67, v67, v9 quad_perm:[1,0,3,2] row_mask:0xf bank_mask:0xf
v_fmac_f32_dpp v26, v26, v9 quad_perm:[1,0,3,2] row_mask:0xf bank_mask:0xf
v_fmac_f32_dpp v27, v27, v9 quad_perm:[1,0,3,2] row_mask:0xf bank_mask:0xf
v_fmac_f32_dpp v58, v58, v9 quad_perm:[1,0,3,2] row_mask:0xf bank_mask:0xf
v_fmac_f32_dpp v59, v59, v9 quad_perm:[1,0,3,2] row_mask:0xf bank_mask:0xf
v_fmac_f32_dpp v42, v42, v9 quad_perm:[1,0,3,2] row_mask:0xf bank_mask:0xf
v_fmac_f32_dpp v43, v43, v9 quad_perm:[1,0,3,2] row_mask:0xf bank_mask:0xf
v_fmac_f32_dpp v74, v74, v9 quad_perm:[1,0,3,2] row_mask:0xf bank_mask:0xf
v_fmac_f32_dpp v75, v75, v9 quad_perm:[1,0,3,2] row_mask:0xf bank_mask:0xf
v_lshlrev_b32 v240, 16, v208
v_and_b32 v241, 0xffff0000, v208
v_pk_mul_f32 v[48:49], v[16:17], v[240:241] op_sel:[0,0] op_sel_hi:[0,1] neg_lo:[0,0] neg_hi:[0,0]
v_pk_fma_f32 v[16:17], v[16:17], v[240:241], v[48:49] op_sel:[1,1,0] op_sel_hi:[1,0,1] neg_lo:[0,1,0] neg_hi:[0,0,0]
v_lshlrev_b32 v240, 16, v209
v_and_b32 v241, 0xffff0000, v209
v_pk_mul_f32 v[48:49], v[14:15], v[240:241] op_sel:[0,0] op_sel_hi:[0,1] neg_lo:[0,0] neg_hi:[0,0]
v_pk_fma_f32 v[14:15], v[14:15], v[240:241], v[48:49] op_sel:[1,1,0] op_sel_hi:[1,0,1] neg_lo:[0,1,0] neg_hi:[0,0,0]
v_lshlrev_b32 v240, 16, v210
v_and_b32 v241, 0xffff0000, v210
v_pk_mul_f32 v[48:49], v[64:65], v[240:241] op_sel:[0,0] op_sel_hi:[0,1] neg_lo:[0,0] neg_hi:[0,0]
v_pk_fma_f32 v[64:65], v[64:65], v[240:241], v[48:49] op_sel:[1,1,0] op_sel_hi:[1,0,1] neg_lo:[0,1,0] neg_hi:[0,0,0]
v_lshlrev_b32 v240, 16, v211
v_and_b32 v241, 0xffff0000, v211
v_pk_mul_f32 v[48:49], v[40:41], v[240:241] op_sel:[0,0] op_sel_hi:[0,1] neg_lo:[0,0] neg_hi:[0,0]
v_pk_fma_f32 v[40:41], v[40:41], v[240:241], v[48:49] op_sel:[1,1,0] op_sel_hi:[1,0,1] neg_lo:[0,1,0] neg_hi:[0,0,0]
v_lshlrev_b32 v240, 16, v212
v_and_b32 v241, 0xffff0000, v212
v_pk_mul_f32 v[48:49], v[72:73], v[240:241] op_sel:[0,0] op_sel_hi:[0,1] neg_lo:[0,0] neg_hi:[0,0]
v_pk_fma_f32 v[72:73], v[72:73], v[240:241], v[48:49] op_sel:[1,1,0] op_sel_hi:[1,0,1] neg_lo:[0,1,0] neg_hi:[0,0,0]
v_lshlrev_b32 v240, 16, v213
v_and_b32 v241, 0xffff0000, v213
v_pk_mul_f32 v[48:49], v[44:45], v[240:241] op_sel:[0,0] op_sel_hi:[0,1] neg_lo:[0,0] neg_hi:[0,0]
v_pk_fma_f32 v[44:45], v[44:45], v[240:241], v[48:49] op_sel:[1,1,0] op_sel_hi:[1,0,1] neg_lo:[0,1,0] neg_hi:[0,0,0]
v_lshlrev_b32 v240, 16, v214
v_and_b32 v241, 0xffff0000, v214
v_pk_mul_f32 v[48:49], v[28:29], v[240:241] op_sel:[0,0] op_sel_hi:[0,1] neg_lo:[0,0] neg_hi:[0,0]
v_pk_fma_f32 v[28:29], v[28:29], v[240:241], v[48:49] op_sel:[1,1,0] op_sel_hi:[1,0,1] neg_lo:[0,1,0] neg_hi:[0,0,0]
v_lshlrev_b32 v240, 16, v215
v_and_b32 v241, 0xffff0000, v215
v_pk_mul_f32 v[48:49], v[60:61], v[240:241] op_sel:[0,0] op_sel_hi:[0,1] neg_lo:[0,0] neg_hi:[0,0]
v_pk_fma_f32 v[60:61], v[60:61], v[240:241], v[48:49] op_sel:[1,1,0] op_sel_hi:[1,0,1] neg_lo:[0,1,0] neg_hi:[0,0,0]
v_lshlrev_b32 v240, 16, v216
v_and_b32 v241, 0xffff0000, v216
v_pk_mul_f32 v[48:49], v[76:77], v[240:241] op_sel:[0,0] op_sel_hi:[0,1] neg_lo:[0,0] neg_hi:[0,0]
v_pk_fma_f32 v[76:77], v[76:77], v[240:241], v[48:49] op_sel:[1,1,0] op_sel_hi:[1,0,1] neg_lo:[0,1,0] neg_hi:[0,0,0]
v_lshlrev_b32 v240, 16, v217
v_and_b32 v241, 0xffff0000, v217
v_pk_mul_f32 v[48:49], v[46:47], v[240:241] op_sel:[0,0] op_sel_hi:[0,1] neg_lo:[0,0] neg_hi:[0,0]
v_pk_fma_f32 v[46:47], v[46:47], v[240:241], v[48:49] op_sel:[1,1,0] op_sel_hi:[1,0,1] neg_lo:[0,1,0] neg_hi:[0,0,0]
v_lshlrev_b32 v240, 16, v218
v_and_b32 v241, 0xffff0000, v218
v_pk_mul_f32 v[48:49], v[30:31], v[240:241] op_sel:[0,0] op_sel_hi:[0,1] neg_lo:[0,0] neg_hi:[0,0]
v_pk_fma_f32 v[30:31], v[30:31], v[240:241], v[48:49] op_sel:[1,1,0] op_sel_hi:[1,0,1] neg_lo:[0,1,0] neg_hi:[0,0,0]
v_lshlrev_b32 v240, 16, v219
v_and_b32 v241, 0xffff0000, v219
v_pk_mul_f32 v[48:49], v[62:63], v[240:241] op_sel:[0,0] op_sel_hi:[0,1] neg_lo:[0,0] neg_hi:[0,0]
v_pk_fma_f32 v[62:63], v[62:63], v[240:241], v[48:49] op_sel:[1,1,0] op_sel_hi:[1,0,1] neg_lo:[0,1,0] neg_hi:[0,0,0]
v_lshlrev_b32 v240, 16, v220
v_and_b32 v241, 0xffff0000, v220
v_pk_mul_f32 v[48:49], v[22:23], v[240:241] op_sel:[0,0] op_sel_hi:[0,1] neg_lo:[0,0] neg_hi:[0,0]
v_pk_fma_f32 v[22:23], v[22:23], v[240:241], v[48:49] op_sel:[1,1,0] op_sel_hi:[1,0,1] neg_lo:[0,1,0] neg_hi:[0,0,0]
v_lshlrev_b32 v240, 16, v221
v_and_b32 v241, 0xffff0000, v221
v_pk_mul_f32 v[48:49], v[54:55], v[240:241] op_sel:[0,0] op_sel_hi:[0,1] neg_lo:[0,0] neg_hi:[0,0]
v_pk_fma_f32 v[54:55], v[54:55], v[240:241], v[48:49] op_sel:[1,1,0] op_sel_hi:[1,0,1] neg_lo:[0,1,0] neg_hi:[0,0,0]
v_lshlrev_b32 v240, 16, v222
v_and_b32 v241, 0xffff0000, v222
v_pk_mul_f32 v[48:49], v[38:39], v[240:241] op_sel:[0,0] op_sel_hi:[0,1] neg_lo:[0,0] neg_hi:[0,0]
v_pk_fma_f32 v[38:39], v[38:39], v[240:241], v[48:49] op_sel:[1,1,0] op_sel_hi:[1,0,1] neg_lo:[0,1,0] neg_hi:[0,0,0]
v_lshlrev_b32 v240, 16, v223
v_and_b32 v241, 0xffff0000, v223
v_pk_mul_f32 v[48:49], v[70:71], v[240:241] op_sel:[0,0] op_sel_hi:[0,1] neg_lo:[0,0] neg_hi:[0,0]
v_pk_fma_f32 v[70:71], v[70:71], v[240:241], v[48:49] op_sel:[1,1,0] op_sel_hi:[1,0,1] neg_lo:[0,1,0] neg_hi:[0,0,0]
v_lshlrev_b32 v240, 16, v224
v_and_b32 v241, 0xffff0000, v224
v_pk_mul_f32 v[48:49], v[78:79], v[240:241] op_sel:[0,0] op_sel_hi:[0,1] neg_lo:[0,0] neg_hi:[0,0]
v_pk_fma_f32 v[78:79], v[78:79], v[240:241], v[48:49] op_sel:[1,1,0] op_sel_hi:[1,0,1] neg_lo:[0,1,0] neg_hi:[0,0,0]
v_lshlrev_b32 v240, 16, v225
v_and_b32 v241, 0xffff0000, v225
v_pk_mul_f32 v[48:49], v[32:33], v[240:241] op_sel:[0,0] op_sel_hi:[0,1] neg_lo:[0,0] neg_hi:[0,0]
v_pk_fma_f32 v[32:33], v[32:33], v[240:241], v[48:49] op_sel:[1,1,0] op_sel_hi:[1,0,1] neg_lo:[0,1,0] neg_hi:[0,0,0]
v_lshlrev_b32 v240, 16, v226
v_and_b32 v241, 0xffff0000, v226
v_pk_mul_f32 v[48:49], v[24:25], v[240:241] op_sel:[0,0] op_sel_hi:[0,1] neg_lo:[0,0] neg_hi:[0,0]
v_pk_fma_f32 v[24:25], v[24:25], v[240:241], v[48:49] op_sel:[1,1,0] op_sel_hi:[1,0,1] neg_lo:[0,1,0] neg_hi:[0,0,0]
v_lshlrev_b32 v240, 16, v227
v_and_b32 v241, 0xffff0000, v227
v_pk_mul_f32 v[48:49], v[56:57], v[240:241] op_sel:[0,0] op_sel_hi:[0,1] neg_lo:[0,0] neg_hi:[0,0]
v_pk_fma_f32 v[56:57], v[56:57], v[240:241], v[48:49] op_sel:[1,1,0] op_sel_hi:[1,0,1] neg_lo:[0,1,0] neg_hi:[0,0,0]
v_lshlrev_b32 v240, 16, v228
v_and_b32 v241, 0xffff0000, v228
v_pk_mul_f32 v[48:49], v[20:21], v[240:241] op_sel:[0,0] op_sel_hi:[0,1] neg_lo:[0,0] neg_hi:[0,0]
v_pk_fma_f32 v[20:21], v[20:21], v[240:241], v[48:49] op_sel:[1,1,0] op_sel_hi:[1,0,1] neg_lo:[0,1,0] neg_hi:[0,0,0]
v_lshlrev_b32 v240, 16, v229
v_and_b32 v241, 0xffff0000, v229
v_pk_mul_f32 v[48:49], v[52:53], v[240:241] op_sel:[0,0] op_sel_hi:[0,1] neg_lo:[0,0] neg_hi:[0,0]
v_pk_fma_f32 v[52:53], v[52:53], v[240:241], v[48:49] op_sel:[1,1,0] op_sel_hi:[1,0,1] neg_lo:[0,1,0] neg_hi:[0,0,0]
v_lshlrev_b32 v240, 16, v230
v_and_b32 v241, 0xffff0000, v230
v_pk_mul_f32 v[48:49], v[36:37], v[240:241] op_sel:[0,0] op_sel_hi:[0,1] neg_lo:[0,0] neg_hi:[0,0]
v_pk_fma_f32 v[36:37], v[36:37], v[240:241], v[48:49] op_sel:[1,1,0] op_sel_hi:[1,0,1] neg_lo:[0,1,0] neg_hi:[0,0,0]
v_lshlrev_b32 v240, 16, v231
v_and_b32 v241, 0xffff0000, v231
v_pk_mul_f32 v[48:49], v[68:69], v[240:241] op_sel:[0,0] op_sel_hi:[0,1] neg_lo:[0,0] neg_hi:[0,0]
v_pk_fma_f32 v[68:69], v[68:69], v[240:241], v[48:49] op_sel:[1,1,0] op_sel_hi:[1,0,1] neg_lo:[0,1,0] neg_hi:[0,0,0]
v_lshlrev_b32 v240, 16, v232
v_and_b32 v241, 0xffff0000, v232
v_pk_mul_f32 v[48:49], v[18:19], v[240:241] op_sel:[0,0] op_sel_hi:[0,1] neg_lo:[0,0] neg_hi:[0,0]
v_pk_fma_f32 v[18:19], v[18:19], v[240:241], v[48:49] op_sel:[1,1,0] op_sel_hi:[1,0,1] neg_lo:[0,1,0] neg_hi:[0,0,0]
v_lshlrev_b32 v240, 16, v233
v_and_b32 v241, 0xffff0000, v233
v_pk_mul_f32 v[48:49], v[50:51], v[240:241] op_sel:[0,0] op_sel_hi:[0,1] neg_lo:[0,0] neg_hi:[0,0]
v_pk_fma_f32 v[50:51], v[50:51], v[240:241], v[48:49] op_sel:[1,1,0] op_sel_hi:[1,0,1] neg_lo:[0,1,0] neg_hi:[0,0,0]
v_lshlrev_b32 v240, 16, v234
v_and_b32 v241, 0xffff0000, v234
v_pk_mul_f32 v[48:49], v[34:35], v[240:241] op_sel:[0,0] op_sel_hi:[0,1] neg_lo:[0,0] neg_hi:[0,0]
v_pk_fma_f32 v[34:35], v[34:35], v[240:241], v[48:49] op_sel:[1,1,0] op_sel_hi:[1,0,1] neg_lo:[0,1,0] neg_hi:[0,0,0]
v_lshlrev_b32 v240, 16, v235
v_and_b32 v241, 0xffff0000, v235
v_pk_mul_f32 v[48:49], v[66:67], v[240:241] op_sel:[0,0] op_sel_hi:[0,1] neg_lo:[0,0] neg_hi:[0,0]
v_pk_fma_f32 v[66:67], v[66:67], v[240:241], v[48:49] op_sel:[1,1,0] op_sel_hi:[1,0,1] neg_lo:[0,1,0] neg_hi:[0,0,0]
v_lshlrev_b32 v240, 16, v236
v_and_b32 v241, 0xffff0000, v236
v_pk_mul_f32 v[48:49], v[26:27], v[240:241] op_sel:[0,0] op_sel_hi:[0,1] neg_lo:[0,0] neg_hi:[0,0]
v_pk_fma_f32 v[26:27], v[26:27], v[240:241], v[48:49] op_sel:[1,1,0] op_sel_hi:[1,0,1] neg_lo:[0,1,0] neg_hi:[0,0,0]
v_lshlrev_b32 v240, 16, v237
v_and_b32 v241, 0xffff0000, v237
v_pk_mul_f32 v[48:49], v[58:59], v[240:241] op_sel:[0,0] op_sel_hi:[0,1] neg_lo:[0,0] neg_hi:[0,0]
v_pk_fma_f32 v[58:59], v[58:59], v[240:241], v[48:49] op_sel:[1,1,0] op_sel_hi:[1,0,1] neg_lo:[0,1,0] neg_hi:[0,0,0]
v_lshlrev_b32 v240, 16, v238
v_and_b32 v241, 0xffff0000, v238
v_pk_mul_f32 v[48:49], v[42:43], v[240:241] op_sel:[0,0] op_sel_hi:[0,1] neg_lo:[0,0] neg_hi:[0,0]
v_pk_fma_f32 v[42:43], v[42:43], v[240:241], v[48:49] op_sel:[1,1,0] op_sel_hi:[1,0,1] neg_lo:[0,1,0] neg_hi:[0,0,0]
v_lshlrev_b32 v240, 16, v239
v_and_b32 v241, 0xffff0000, v239
v_pk_mul_f32 v[48:49], v[74:75], v[240:241] op_sel:[0,0] op_sel_hi:[0,1] neg_lo:[0,0] neg_hi:[0,0]
v_pk_fma_f32 v[74:75], v[74:75], v[240:241], v[48:49] op_sel:[1,1,0] op_sel_hi:[1,0,1] neg_lo:[0,1,0] neg_hi:[0,0,0]
v_fmac_f32_dpp v16, v16, v7 quad_perm:[1,0,3,2] row_mask:0xf bank_mask:0xf
v_fmac_f32_dpp v17, v17, v7 quad_perm:[1,0,3,2] row_mask:0xf bank_mask:0xf
v_fmac_f32_dpp v14, v14, v7 quad_perm:[1,0,3,2] row_mask:0xf bank_mask:0xf
v_fmac_f32_dpp v15, v15, v7 quad_perm:[1,0,3,2] row_mask:0xf bank_mask:0xf
v_fmac_f32_dpp v64, v64, v7 quad_perm:[1,0,3,2] row_mask:0xf bank_mask:0xf
v_fmac_f32_dpp v65, v65, v7 quad_perm:[1,0,3,2] row_mask:0xf bank_mask:0xf
v_fmac_f32_dpp v40, v40, v7 quad_perm:[1,0,3,2] row_mask:0xf bank_mask:0xf
v_fmac_f32_dpp v41, v41, v7 quad_perm:[1,0,3,2] row_mask:0xf bank_mask:0xf
v_fmac_f32_dpp v72, v72, v7 quad_perm:[1,0,3,2] row_mask:0xf bank_mask:0xf
v_fmac_f32_dpp v73, v73, v7 quad_perm:[1,0,3,2] row_mask:0xf bank_mask:0xf
v_fmac_f32_dpp v44, v44, v7 quad_perm:[1,0,3,2] row_mask:0xf bank_mask:0xf
v_fmac_f32_dpp v45, v45, v7 quad_perm:[1,0,3,2] row_mask:0xf bank_mask:0xf
v_fmac_f32_dpp v28, v28, v7 quad_perm:[1,0,3,2] row_mask:0xf bank_mask:0xf
v_fmac_f32_dpp v29, v29, v7 quad_perm:[1,0,3,2] row_mask:0xf bank_mask:0xf
v_fmac_f32_dpp v60, v60, v7 quad_perm:[1,0,3,2] row_mask:0xf bank_mask:0xf
v_fmac_f32_dpp v61, v61, v7 quad_perm:[1,0,3,2] row_mask:0xf bank_mask:0xf
v_fmac_f32_dpp v76, v76, v7 quad_perm:[1,0,3,2] row_mask:0xf bank_mask:0xf
v_fmac_f32_dpp v77, v77, v7 quad_perm:[1,0,3,2] row_mask:0xf bank_mask:0xf
v_fmac_f32_dpp v46, v46, v7 quad_perm:[1,0,3,2] row_mask:0xf bank_mask:0xf
v_fmac_f32_dpp v47, v47, v7 quad_perm:[1,0,3,2] row_mask:0xf bank_mask:0xf
v_fmac_f32_dpp v30, v30, v7 quad_perm:[1,0,3,2] row_mask:0xf bank_mask:0xf
v_fmac_f32_dpp v31, v31, v7 quad_perm:[1,0,3,2] row_mask:0xf bank_mask:0xf
v_fmac_f32_dpp v62, v62, v7 quad_perm:[1,0,3,2] row_mask:0xf bank_mask:0xf
v_fmac_f32_dpp v63, v63, v7 quad_perm:[1,0,3,2] row_mask:0xf bank_mask:0xf
v_fmac_f32_dpp v22, v22, v7 quad_perm:[1,0,3,2] row_mask:0xf bank_mask:0xf
v_fmac_f32_dpp v23, v23, v7 quad_perm:[1,0,3,2] row_mask:0xf bank_mask:0xf
v_fmac_f32_dpp v54, v54, v7 quad_perm:[1,0,3,2] row_mask:0xf bank_mask:0xf
v_fmac_f32_dpp v55, v55, v7 quad_perm:[1,0,3,2] row_mask:0xf bank_mask:0xf
v_fmac_f32_dpp v38, v38, v7 quad_perm:[1,0,3,2] row_mask:0xf bank_mask:0xf
v_fmac_f32_dpp v39, v39, v7 quad_perm:[1,0,3,2] row_mask:0xf bank_mask:0xf
v_fmac_f32_dpp v70, v70, v7 quad_perm:[1,0,3,2] row_mask:0xf bank_mask:0xf
v_fmac_f32_dpp v71, v71, v7 quad_perm:[1,0,3,2] row_mask:0xf bank_mask:0xf
v_fmac_f32_dpp v78, v78, v7 quad_perm:[1,0,3,2] row_mask:0xf bank_mask:0xf
v_fmac_f32_dpp v79, v79, v7 quad_perm:[1,0,3,2] row_mask:0xf bank_mask:0xf
v_fmac_f32_dpp v32, v32, v7 quad_perm:[1,0,3,2] row_mask:0xf bank_mask:0xf
v_fmac_f32_dpp v33, v33, v7 quad_perm:[1,0,3,2] row_mask:0xf bank_mask:0xf
v_fmac_f32_dpp v24, v24, v7 quad_perm:[1,0,3,2] row_mask:0xf bank_mask:0xf
v_fmac_f32_dpp v25, v25, v7 quad_perm:[1,0,3,2] row_mask:0xf bank_mask:0xf
v_fmac_f32_dpp v56, v56, v7 quad_perm:[1,0,3,2] row_mask:0xf bank_mask:0xf
v_fmac_f32_dpp v57, v57, v7 quad_perm:[1,0,3,2] row_mask:0xf bank_mask:0xf
v_fmac_f32_dpp v20, v20, v7 quad_perm:[1,0,3,2] row_mask:0xf bank_mask:0xf
v_fmac_f32_dpp v21, v21, v7 quad_perm:[1,0,3,2] row_mask:0xf bank_mask:0xf
v_fmac_f32_dpp v52, v52, v7 quad_perm:[1,0,3,2] row_mask:0xf bank_mask:0xf
v_fmac_f32_dpp v53, v53, v7 quad_perm:[1,0,3,2] row_mask:0xf bank_mask:0xf
v_fmac_f32_dpp v36, v36, v7 quad_perm:[1,0,3,2] row_mask:0xf bank_mask:0xf
v_fmac_f32_dpp v37, v37, v7 quad_perm:[1,0,3,2] row_mask:0xf bank_mask:0xf
v_fmac_f32_dpp v68, v68, v7 quad_perm:[1,0,3,2] row_mask:0xf bank_mask:0xf
v_fmac_f32_dpp v69, v69, v7 quad_perm:[1,0,3,2] row_mask:0xf bank_mask:0xf
v_fmac_f32_dpp v18, v18, v7 quad_perm:[1,0,3,2] row_mask:0xf bank_mask:0xf
v_fmac_f32_dpp v19, v19, v7 quad_perm:[1,0,3,2] row_mask:0xf bank_mask:0xf
v_fmac_f32_dpp v50, v50, v7 quad_perm:[1,0,3,2] row_mask:0xf bank_mask:0xf
v_fmac_f32_dpp v51, v51, v7 quad_perm:[1,0,3,2] row_mask:0xf bank_mask:0xf
v_fmac_f32_dpp v34, v34, v7 quad_perm:[1,0,3,2] row_mask:0xf bank_mask:0xf
v_fmac_f32_dpp v35, v35, v7 quad_perm:[1,0,3,2] row_mask:0xf bank_mask:0xf
v_fmac_f32_dpp v66, v66, v7 quad_perm:[1,0,3,2] row_mask:0xf bank_mask:0xf
v_fmac_f32_dpp v67, v67, v7 quad_perm:[1,0,3,2] row_mask:0xf bank_mask:0xf
v_fmac_f32_dpp v26, v26, v7 quad_perm:[1,0,3,2] row_mask:0xf bank_mask:0xf
v_fmac_f32_dpp v27, v27, v7 quad_perm:[1,0,3,2] row_mask:0xf bank_mask:0xf
v_fmac_f32_dpp v58, v58, v7 quad_perm:[1,0,3,2] row_mask:0xf bank_mask:0xf
v_fmac_f32_dpp v59, v59, v7 quad_perm:[1,0,3,2] row_mask:0xf bank_mask:0xf
v_fmac_f32_dpp v42, v42, v7 quad_perm:[1,0,3,2] row_mask:0xf bank_mask:0xf
v_fmac_f32_dpp v43, v43, v7 quad_perm:[1,0,3,2] row_mask:0xf bank_mask:0xf
v_fmac_f32_dpp v74, v74, v7 quad_perm:[1,0,3,2] row_mask:0xf bank_mask:0xf
v_fmac_f32_dpp v75, v75, v7 quad_perm:[1,0,3,2] row_mask:0xf bank_mask:0xf
s_mov_b64 exec, s[18:19]
v_pk_add_f32 v[16:17], v[16:17], 0 neg_lo:[1,0] neg_hi:[1,0]
v_pk_mul_f32 v[48:49], v[14:15], s[48:49] op_sel:[0,0] op_sel_hi:[0,1] neg_lo:[0,1] neg_hi:[0,1]
v_pk_fma_f32 v[14:15], v[14:15], s[48:49], v[48:49] op_sel:[1,1,0] op_sel_hi:[1,0,1] neg_lo:[0,0,0] neg_hi:[0,1,0]
v_pk_mul_f32 v[48:49], v[64:65], s[50:51] op_sel:[0,0] op_sel_hi:[0,1] neg_lo:[0,1] neg_hi:[0,1]
v_pk_fma_f32 v[64:65], v[64:65], s[50:51], v[48:49] op_sel:[1,1,0] op_sel_hi:[1,0,1] neg_lo:[0,0,0] neg_hi:[0,1,0]
v_pk_mul_f32 v[48:49], v[40:41], s[52:53] op_sel:[0,0] op_sel_hi:[0,1] neg_lo:[0,1] neg_hi:[0,1]
v_pk_fma_f32 v[40:41], v[40:41], s[52:53], v[48:49] op_sel:[1,1,0] op_sel_hi:[1,0,1] neg_lo:[0,0,0] neg_hi:[0,1,0]
v_pk_mul_f32 v[48:49], v[72:73], s[54:55] op_sel:[0,0] op_sel_hi:[0,1] neg_lo:[0,1] neg_hi:[0,1]
v_pk_fma_f32 v[72:73], v[72:73], s[54:55], v[48:49] op_sel:[1,1,0] op_sel_hi:[1,0,1] neg_lo:[0,0,0] neg_hi:[0,1,0]
v_pk_mul_f32 v[48:49], v[44:45], s[56:57] op_sel:[0,0] op_sel_hi:[0,1] neg_lo:[0,1] neg_hi:[0,1]
v_pk_fma_f32 v[44:45], v[44:45], s[56:57], v[48:49] op_sel:[1,1,0] op_sel_hi:[1,0,1] neg_lo:[0,0,0] neg_hi:[0,1,0]
v_pk_mul_f32 v[48:49], v[28:29], s[58:59] op_sel:[0,0] op_sel_hi:[0,1] neg_lo:[0,1] neg_hi:[0,1]
v_pk_fma_f32 v[28:29], v[28:29], s[58:59], v[48:49] op_sel:[1,1,0] op_sel_hi:[1,0,1] neg_lo:[0,0,0] neg_hi:[0,1,0]
v_pk_mul_f32 v[48:49], v[60:61], s[60:61] op_sel:[0,0] op_sel_hi:[0,1] neg_lo:[0,1] neg_hi:[0,1]
v_pk_fma_f32 v[60:61], v[60:61], s[60:61], v[48:49] op_sel:[1,1,0] op_sel_hi:[1,0,1] neg_lo:[0,0,0] neg_hi:[0,1,0]
v_pk_mul_f32 v[48:49], v[76:77], s[62:63] op_sel:[0,0] op_sel_hi:[0,1] neg_lo:[0,1] neg_hi:[0,1]
v_pk_fma_f32 v[76:77], v[76:77], s[62:63], v[48:49] op_sel:[1,1,0] op_sel_hi:[1,0,1] neg_lo:[0,0,0] neg_hi:[0,1,0]
v_pk_mul_f32 v[48:49], v[46:47], s[60:61] op_sel:[0,1] op_sel_hi:[0,0] neg_lo:[0,1] neg_hi:[0,1]
v_pk_fma_f32 v[46:47], v[46:47], s[60:61], v[48:49] op_sel:[1,0,0] op_sel_hi:[1,1,1] neg_lo:[0,0,0] neg_hi:[0,1,0]
v_pk_mul_f32 v[48:49], v[30:31], s[58:59] op_sel:[0,1] op_sel_hi:[0,0] neg_lo:[0,1] neg_hi:[0,1]
v_pk_fma_f32 v[30:31], v[30:31], s[58:59], v[48:49] op_sel:[1,0,0] op_sel_hi:[1,1,1] neg_lo:[0,0,0] neg_hi:[0,1,0]
v_pk_mul_f32 v[48:49], v[62:63], s[56:57] op_sel:[0,1] op_sel_hi:[0,0] neg_lo:[0,1] neg_hi:[0,1]
v_pk_fma_f32 v[62:63], v[62:63], s[56:57], v[48:49] op_sel:[1,0,0] op_sel_hi:[1,1,1] neg_lo:[0,0,0] neg_hi:[0,1,0]
v_pk_mul_f32 v[48:49], v[22:23], s[54:55] op_sel:[0,1] op_sel_hi:[0,0] neg_lo:[0,1] neg_hi:[0,1]
v_pk_fma_f32 v[22:23], v[22:23], s[54:55], v[48:49] op_sel:[1,0,0] op_sel_hi:[1,1,1] neg_lo:[0,0,0] neg_hi:[0,1,0]
v_pk_mul_f32 v[48:49], v[54:55], s[52:53] op_sel:[0,1] op_sel_hi:[0,0] neg_lo:[0,1] neg_hi:[0,1]
v_pk_fma_f32 v[54:55], v[54:55], s[52:53], v[48:49] op_sel:[1,0,0] op_sel_hi:[1,1,1] neg_lo:[0,0,0] neg_hi:[0,1,0]
v_pk_mul_f32 v[48:49], v[38:39], s[50:51] op_sel:[0,1] op_sel_hi:[0,0] neg_lo:[0,1] neg_hi:[0,1]
v_pk_fma_f32 v[38:39], v[38:39], s[50:51], v[48:49] op_sel:[1,0,0] op_sel_hi:[1,1,1] neg_lo:[0,0,0] neg_hi:[0,1,0]
v_pk_mul_f32 v[48:49], v[70:71], s[48:49] op_sel:[0,1] op_sel_hi:[0,0] neg_lo:[0,1] neg_hi:[0,1]
v_pk_fma_f32 v[70:71], v[70:71], s[48:49], v[48:49] op_sel:[1,0,0] op_sel_hi:[1,1,1] neg_lo:[0,0,0] neg_hi:[0,1,0]
v_pk_add_f32 v[78:79], v[78:79], 0 op_sel:[1,0] op_sel_hi:[0,0] neg_lo:[0,0] neg_hi:[1,0]
v_pk_mul_f32 v[48:49], v[32:33], s[48:49] op_sel:[0,1] op_sel_hi:[0,0] neg_lo:[0,0] neg_hi:[0,1]
v_pk_fma_f32 v[32:33], v[32:33], s[48:49], v[48:49] op_sel:[1,0,0] op_sel_hi:[1,1,1] neg_lo:[0,0,0] neg_hi:[0,0,0]
v_pk_mul_f32 v[48:49], v[24:25], s[50:51] op_sel:[0,1] op_sel_hi:[0,0] neg_lo:[0,0] neg_hi:[0,1]
v_pk_fma_f32 v[24:25], v[24:25], s[50:51], v[48:49] op_sel:[1,0,0] op_sel_hi:[1,1,1] neg_lo:[0,0,0] neg_hi:[0,0,0]
v_pk_mul_f32 v[48:49], v[56:57], s[52:53] op_sel:[0,1] op_sel_hi:[0,0] neg_lo:[0,0] neg_hi:[0,1]
v_pk_fma_f32 v[56:57], v[56:57], s[52:53], v[48:49] op_sel:[1,0,0] op_sel_hi:[1,1,1] neg_lo:[0,0,0] neg_hi:[0,0,0]
v_pk_mul_f32 v[48:49], v[20:21], s[54:55] op_sel:[0,1] op_sel_hi:[0,0] neg_lo:[0,0] neg_hi:[0,1]
v_pk_fma_f32 v[20:21], v[20:21], s[54:55], v[48:49] op_sel:[1,0,0] op_sel_hi:[1,1,1] neg_lo:[0,0,0] neg_hi:[0,0,0]
v_pk_mul_f32 v[48:49], v[52:53], s[56:57] op_sel:[0,1] op_sel_hi:[0,0] neg_lo:[0,0] neg_hi:[0,1]
v_pk_fma_f32 v[52:53], v[52:53], s[56:57], v[48:49] op_sel:[1,0,0] op_sel_hi:[1,1,1] neg_lo:[0,0,0] neg_hi:[0,0,0]
v_pk_mul_f32 v[48:49], v[36:37], s[58:59] op_sel:[0,1] op_sel_hi:[0,0] neg_lo:[0,0] neg_hi:[0,1]
v_pk_fma_f32 v[36:37], v[36:37], s[58:59], v[48:49] op_sel:[1,0,0] op_sel_hi:[1,1,1] neg_lo:[0,0,0] neg_hi:[0,0,0]
v_pk_mul_f32 v[48:49], v[68:69], s[60:61] op_sel:[0,1] op_sel_hi:[0,0] neg_lo:[0,0] neg_hi:[0,1]
v_pk_fma_f32 v[68:69], v[68:69], s[60:61], v[48:49] op_sel:[1,0,0] op_sel_hi:[1,1,1] neg_lo:[0,0,0] neg_hi:[0,0,0]
v_pk_mul_f32 v[48:49], v[18:19], s[62:63] op_sel:[0,0] op_sel_hi:[0,1] neg_lo:[0,0] neg_hi:[0,1]
v_pk_fma_f32 v[18:19], v[18:19], s[62:63], v[48:49] op_sel:[1,1,0] op_sel_hi:[1,0,1] neg_lo:[0,0,0] neg_hi:[0,0,0]
v_pk_mul_f32 v[48:49], v[50:51], s[60:61] op_sel:[0,0] op_sel_hi:[0,1] neg_lo:[0,0] neg_hi:[0,1]
v_pk_fma_f32 v[50:51], v[50:51], s[60:61], v[48:49] op_sel:[1,1,0] op_sel_hi:[1,0,1] neg_lo:[0,0,0] neg_hi:[0,0,0]
v_pk_mul_f32 v[48:49], v[34:35], s[58:59] op_sel:[0,0] op_sel_hi:[0,1] neg_lo:[0,0] neg_hi:[0,1]
v_pk_fma_f32 v[34:35], v[34:35], s[58:59], v[48:49] op_sel:[1,1,0] op_sel_hi:[1,0,1] neg_lo:[0,0,0] neg_hi:[0,0,0]
v_pk_mul_f32 v[48:49], v[66:67], s[56:57] op_sel:[0,0] op_sel_hi:[0,1] neg_lo:[0,0] neg_hi:[0,1]
v_pk_fma_f32 v[66:67], v[66:67], s[56:57], v[48:49] op_sel:[1,1,0] op_sel_hi:[1,0,1] neg_lo:[0,0,0] neg_hi:[0,0,0]
v_pk_mul_f32 v[48:49], v[26:27], s[54:55] op_sel:[0,0] op_sel_hi:[0,1] neg_lo:[0,0] neg_hi:[0,1]
v_pk_fma_f32 v[26:27], v[26:27], s[54:55], v[48:49] op_sel:[1,1,0] op_sel_hi:[1,0,1] neg_lo:[0,0,0] neg_hi:[0,0,0]
v_pk_mul_f32 v[48:49], v[58:59], s[52:53] op_sel:[0,0] op_sel_hi:[0,1] neg_lo:[0,0] neg_hi:[0,1]
v_pk_fma_f32 v[58:59], v[58:59], s[52:53], v[48:49] op_sel:[1,1,0] op_sel_hi:[1,0,1] neg_lo:[0,0,0] neg_hi:[0,0,0]
v_pk_mul_f32 v[48:49], v[42:43], s[50:51] op_sel:[0,0] op_sel_hi:[0,1] neg_lo:[0,0] neg_hi:[0,1]
v_pk_fma_f32 v[42:43], v[42:43], s[50:51], v[48:49] op_sel:[1,1,0] op_sel_hi:[1,0,1] neg_lo:[0,0,0] neg_hi:[0,0,0]
v_pk_mul_f32 v[48:49], v[74:75], s[48:49] op_sel:[0,0] op_sel_hi:[0,1] neg_lo:[0,0] neg_hi:[0,1]
v_pk_fma_f32 v[74:75], v[74:75], s[48:49], v[48:49] op_sel:[1,1,0] op_sel_hi:[1,0,1] neg_lo:[0,0,0] neg_hi:[0,0,0]
s_mov_b64 exec, -1
v_pk_add_f32 v[48:49], v[16:17], v[78:79] neg_lo:[0,1] neg_hi:[0,1]
v_pk_add_f32 v[16:17], v[16:17], v[78:79]
v_pk_add_f32 v[78:79], v[14:15], v[32:33] neg_lo:[0,1] neg_hi:[0,1]
v_pk_add_f32 v[14:15], v[14:15], v[32:33]
v_pk_mul_f32 v[32:33], v[78:79], s[50:51] op_sel:[0,0] op_sel_hi:[0,1] neg_lo:[0,0] neg_hi:[0,0]
v_pk_fma_f32 v[32:33], v[78:79], s[50:51], v[32:33] op_sel:[1,1,0] op_sel_hi:[1,0,1] neg_lo:[0,1,0] neg_hi:[0,0,0]
v_pk_add_f32 v[78:79], v[64:65], v[24:25] neg_lo:[0,1] neg_hi:[0,1]
v_pk_add_f32 v[64:65], v[64:65], v[24:25]
v_pk_mul_f32 v[24:25], v[78:79], s[54:55] op_sel:[0,0] op_sel_hi:[0,1] neg_lo:[0,0] neg_hi:[0,0]
v_pk_fma_f32 v[24:25], v[78:79], s[54:55], v[24:25] op_sel:[1,1,0] op_sel_hi:[1,0,1] neg_lo:[0,1,0] neg_hi:[0,0,0]
v_pk_add_f32 v[78:79], v[40:41], v[56:57] neg_lo:[0,1] neg_hi:[0,1]
v_pk_add_f32 v[40:41], v[40:41], v[56:57]
v_pk_mul_f32 v[56:57], v[78:79], s[58:59] op_sel:[0,0] op_sel_hi:[0,1] neg_lo:[0,0] neg_hi:[0,0]
v_pk_fma_f32 v[56:57], v[78:79], s[58:59], v[56:57] op_sel:[1,1,0] op_sel_hi:[1,0,1] neg_lo:[0,1,0] neg_hi:[0,0,0]
v_pk_add_f32 v[78:79], v[72:73], v[20:21] neg_lo:[0,1] neg_hi:[0,1]
v_pk_add_f32 v[72:73], v[72:73], v[20:21]
v_pk_mul_f32 v[20:21], v[78:79], s[62:63] op_sel:[0,0] op_sel_hi:[0,1] neg_lo:[0,0] neg_hi:[0,0]
v_pk_fma_f32 v[20:21], v[78:79], s[62:63], v[20:21] op_sel:[1,1,0] op_sel_hi:[1,0,1] neg_lo:[0,1,0] neg_hi:[0,0,0]
v_pk_add_f32 v[78:79], v[44:45], v[52:53] neg_lo:[0,1] neg_hi:[0,1]
v_pk_add_f32 v[44:45], v[44:45], v[52:53]
v_pk_mul_f32 v[52:53], v[78:79], s[58:59] op_sel:[0,1] op_sel_hi:[0,0] neg_lo:[0,0] neg_hi:[0,0]
v_pk_fma_f32 v[52:53], v[78:79], s[58:59], v[52:53] op_sel:[1,0,0] op_sel_hi:[1,1,1] neg_lo:[0,1,0] neg_hi:[0,0,0]
v_pk_add_f32 v[78:79], v[28:29], v[36:37] neg_lo:[0,1] neg_hi:[0,1]
v_pk_add_f32 v[28:29], v[28:29], v[36:37]
v_pk_mul_f32 v[36:37], v[78:79], s[54:55] op_sel:[0,1] op_sel_hi:[0,0] neg_lo:[0,0] neg_hi:[0,0]
v_pk_fma_f32 v[36:37], v[78:79], s[54:55], v[36:37] op_sel:[1,0,0] op_sel_hi:[1,1,1] neg_lo:[0,1,0] neg_hi:[0,0,0]
v_pk_add_f32 v[78:79], v[60:61], v[68:69] neg_lo:[0,1] neg_hi:[0,1]
v_pk_add_f32 v[60:61], v[60:61], v[68:69]
v_pk_mul_f32 v[68:69], v[78:79], s[50:51] op_sel:[0,1] op_sel_hi:[0,0] neg_lo:[0,0] neg_hi:[0,0]
v_pk_fma_f32 v[68:69], v[78:79], s[50:51], v[68:69] op_sel:[1,0,0] op_sel_hi:[1,1,1] neg_lo:[0,1,0] neg_hi:[0,0,0]
v_pk_add_f32 v[78:79], v[76:77], v[18:19] op_sel:[1,1] op_sel_hi:[0,0] neg_lo:[1,0] neg_hi:[0,1]
v_pk_add_f32 v[76:77], v[76:77], v[18:19]
v_pk_add_f32 v[18:19], v[46:47], v[50:51] neg_lo:[0,1] neg_hi:[0,1]
v_pk_add_f32 v[46:47], v[46:47], v[50:51]
v_pk_mul_f32 v[50:51], v[18:19], s[50:51] op_sel:[0,1] op_sel_hi:[0,0] neg_lo:[0,1] neg_hi:[0,0]
v_pk_fma_f32 v[50:51], v[18:19], s[50:51], v[50:51] op_sel:[1,0,0] op_sel_hi:[1,1,1] neg_lo:[0,1,0] neg_hi:[0,1,0]
v_pk_add_f32 v[18:19], v[30:31], v[34:35] neg_lo:[0,1] neg_hi:[0,1]
v_pk_add_f32 v[30:31], v[30:31], v[34:35]
v_pk_mul_f32 v[34:35], v[18:19], s[54:55] op_sel:[0,1] op_sel_hi:[0,0] neg_lo:[0,1] neg_hi:[0,0]
v_pk_fma_f32 v[34:35], v[18:19], s[54:55], v[34:35] op_sel:[1,0,0] op_sel_hi:[1,1,1] neg_lo:[0,1,0] neg_hi:[0,1,0]
v_pk_add_f32 v[18:19], v[62:63], v[66:67] neg_lo:[0,1] neg_hi:[0,1]
v_pk_add_f32 v[62:63], v[62:63], v[66:67]
v_pk_mul_f32 v[66:67], v[18:19], s[58:59] op_sel:[0,1] op_sel_hi:[0,0] neg_lo:[0,1] neg_hi:[0,0]
v_pk_fma_f32 v[66:67], v[18:19], s[58:59], v[66:67] op_sel:[1,0,0] op_sel_hi:[1,1,1] neg_lo:[0,1,0] neg_hi:[0,1,0]
v_pk_add_f32 v[18:19], v[22:23], v[26:27] neg_lo:[0,1] neg_hi:[0,1]
v_pk_add_f32 v[22:23], v[22:23], v[26:27]
v_pk_mul_f32 v[26:27], v[18:19], s[62:63] op_sel:[0,0] op_sel_hi:[0,1] neg_lo:[0,1] neg_hi:[0,0]
v_pk_fma_f32 v[26:27], v[18:19], s[62:63], v[26:27] op_sel:[1,1,0] op_sel_hi:[1,0,1] neg_lo:[0,1,0] neg_hi:[0,1,0]
v_pk_add_f32 v[18:19], v[54:55], v[58:59] neg_lo:[0,1] neg_hi:[0,1]
v_pk_add_f32 v[54:55], v[54:55], v[58:59]
v_pk_mul_f32 v[58:59], v[18:19], s[58:59] op_sel:[0,0] op_sel_hi:[0,1] neg_lo:[0,1] neg_hi:[0,0]
v_pk_fma_f32 v[58:59], v[18:19], s[58:59], v[58:59] op_sel:[1,1,0] op_sel_hi:[1,0,1] neg_lo:[0,1,0] neg_hi:[0,1,0]
v_pk_add_f32 v[18:19], v[38:39], v[42:43] neg_lo:[0,1] neg_hi:[0,1]
v_pk_add_f32 v[38:39], v[38:39], v[42:43]
v_pk_mul_f32 v[42:43], v[18:19], s[54:55] op_sel:[0,0] op_sel_hi:[0,1] neg_lo:[0,1] neg_hi:[0,0]
v_pk_fma_f32 v[42:43], v[18:19], s[54:55], v[42:43] op_sel:[1,1,0] op_sel_hi:[1,0,1] neg_lo:[0,1,0] neg_hi:[0,1,0]
v_pk_add_f32 v[18:19], v[70:71], v[74:75] neg_lo:[0,1] neg_hi:[0,1]
v_pk_add_f32 v[70:71], v[70:71], v[74:75]
v_pk_mul_f32 v[74:75], v[18:19], s[50:51] op_sel:[0,0] op_sel_hi:[0,1] neg_lo:[0,1] neg_hi:[0,0]
v_pk_fma_f32 v[74:75], v[18:19], s[50:51], v[74:75] op_sel:[1,1,0] op_sel_hi:[1,0,1] neg_lo:[0,1,0] neg_hi:[0,1,0]
v_pk_add_f32 v[18:19], v[16:17], v[76:77] neg_lo:[0,1] neg_hi:[0,1]
v_pk_add_f32 v[16:17], v[16:17], v[76:77]
v_pk_add_f32 v[76:77], v[14:15], v[46:47] neg_lo:[0,1] neg_hi:[0,1]
v_pk_add_f32 v[14:15], v[14:15], v[46:47]
v_pk_mul_f32 v[46:47], v[76:77], s[54:55] op_sel:[0,0] op_sel_hi:[0,1] neg_lo:[0,0] neg_hi:[0,0]
v_pk_fma_f32 v[46:47], v[76:77], s[54:55], v[46:47] op_sel:[1,1,0] op_sel_hi:[1,0,1] neg_lo:[0,1,0] neg_hi:[0,0,0]
v_pk_add_f32 v[76:77], v[64:65], v[30:31] neg_lo:[0,1] neg_hi:[0,1]
v_pk_add_f32 v[64:65], v[64:65], v[30:31]
v_pk_mul_f32 v[30:31], v[76:77], s[62:63] op_sel:[0,0] op_sel_hi:[0,1] neg_lo:[0,0] neg_hi:[0,0]
v_pk_fma_f32 v[30:31], v[76:77], s[62:63], v[30:31] op_sel:[1,1,0] op_sel_hi:[1,0,1] neg_lo:[0,1,0] neg_hi:[0,0,0]
v_pk_add_f32 v[76:77], v[40:41], v[62:63] neg_lo:[0,1] neg_hi:[0,1]
v_pk_add_f32 v[40:41], v[40:41], v[62:63]
v_pk_mul_f32 v[62:63], v[76:77], s[54:55] op_sel:[0,1] op_sel_hi:[0,0] neg_lo:[0,0] neg_hi:[0,0]
v_pk_fma_f32 v[62:63], v[76:77], s[54:55], v[62:63] op_sel:[1,0,0] op_sel_hi:[1,1,1] neg_lo:[0,1,0] neg_hi:[0,0,0]
v_pk_add_f32 v[76:77], v[72:73], v[22:23] op_sel:[1,1] op_sel_hi:[0,0] neg_lo:[1,0] neg_hi:[0,1]
v_pk_add_f32 v[72:73], v[72:73], v[22:23]
v_pk_add_f32 v[22:23], v[44:45], v[54:55] neg_lo:[0,1] neg_hi:[0,1]
v_pk_add_f32 v[44:45], v[44:45], v[54:55]
v_pk_mul_f32 v[54:55], v[22:23], s[54:55] op_sel:[0,1] op_sel_hi:[0,0] neg_lo:[0,1] neg_hi:[0,0]
v_pk_fma_f32 v[54:55], v[22:23], s[54:55], v[54:55] op_sel:[1,0,0] op_sel_hi:[1,1,1] neg_lo:[0,1,0] neg_hi:[0,1,0]
v_pk_add_f32 v[22:23], v[28:29], v[38:39] neg_lo:[0,1] neg_hi:[0,1]
v_pk_add_f32 v[28:29], v[28:29], v[38:39]
v_pk_mul_f32 v[38:39], v[22:23], s[62:63] op_sel:[0,0] op_sel_hi:[0,1] neg_lo:[0,1] neg_hi:[0,0]
v_pk_fma_f32 v[38:39], v[22:23], s[62:63], v[38:39] op_sel:[1,1,0] op_sel_hi:[1,0,1] neg_lo:[0,1,0] neg_hi:[0,1,0]
v_pk_add_f32 v[22:23], v[60:61], v[70:71] neg_lo:[0,1] neg_hi:[0,1]
v_pk_add_f32 v[60:61], v[60:61], v[70:71]
v_pk_mul_f32 v[70:71], v[22:23], s[54:55] op_sel:[0,0] op_sel_hi:[0,1] neg_lo:[0,1] neg_hi:[0,0]
v_pk_fma_f32 v[70:71], v[22:23], s[54:55], v[70:71] op_sel:[1,1,0] op_sel_hi:[1,0,1] neg_lo:[0,1,0] neg_hi:[0,1,0]
v_pk_add_f32 v[22:23], v[48:49], v[78:79] neg_lo:[0,1] neg_hi:[0,1]
v_pk_add_f32 v[48:49], v[48:49], v[78:79]
v_pk_add_f32 v[78:79], v[32:33], v[50:51] neg_lo:[0,1] neg_hi:[0,1]
v_pk_add_f32 v[32:33], v[32:33], v[50:51]
v_pk_mul_f32 v[50:51], v[78:79], s[54:55] op_sel:[0,0] op_sel_hi:[0,1] neg_lo:[0,0] neg_hi:[0,0]
v_pk_fma_f32 v[50:51], v[78:79], s[54:55], v[50:51] op_sel:[1,1,0] op_sel_hi:[1,0,1] neg_lo:[0,1,0] neg_hi:[0,0,0]
v_pk_add_f32 v[78:79], v[24:25], v[34:35] neg_lo:[0,1] neg_hi:[0,1]
v_pk_add_f32 v[24:25], v[24:25], v[34:35]
v_pk_mul_f32 v[34:35], v[78:79], s[62:63] op_sel:[0,0] op_sel_hi:[0,1] neg_lo:[0,0] neg_hi:[0,0]
v_pk_fma_f32 v[34:35], v[78:79], s[62:63], v[34:35] op_sel:[1,1,0] op_sel_hi:[1,0,1] neg_lo:[0,1,0] neg_hi:[0,0,0]
v_pk_add_f32 v[78:79], v[56:57], v[66:67] neg_lo:[0,1] neg_hi:[0,1]
v_pk_add_f32 v[56:57], v[56:57], v[66:67]
v_pk_mul_f32 v[66:67], v[78:79], s[54:55] op_sel:[0,1] op_sel_hi:[0,0] neg_lo:[0,0] neg_hi:[0,0]
v_pk_fma_f32 v[66:67], v[78:79], s[54:55], v[66:67] op_sel:[1,0,0] op_sel_hi:[1,1,1] neg_lo:[0,1,0] neg_hi:[0,0,0]
v_pk_add_f32 v[78:79], v[20:21], v[26:27] op_sel:[1,1] op_sel_hi:[0,0] neg_lo:[1,0] neg_hi:[0,1]
v_pk_add_f32 v[20:21], v[20:21], v[26:27]
v_pk_add_f32 v[26:27], v[52:53], v[58:59] neg_lo:[0,1] neg_hi:[0,1]
v_pk_add_f32 v[52:53], v[52:53], v[58:59]
v_pk_mul_f32 v[58:59], v[26:27], s[54:55] op_sel:[0,1] op_sel_hi:[0,0] neg_lo:[0,1] neg_hi:[0,0]
v_pk_fma_f32 v[58:59], v[26:27], s[54:55], v[58:59] op_sel:[1,0,0] op_sel_hi:[1,1,1] neg_lo:[0,1,0] neg_hi:[0,1,0]
v_pk_add_f32 v[26:27], v[36:37], v[42:43] neg_lo:[0,1] neg_hi:[0,1]
v_pk_add_f32 v[36:37], v[36:37], v[42:43]
v_pk_mul_f32 v[42:43], v[26:27], s[62:63] op_sel:[0,0] op_sel_hi:[0,1] neg_lo:[0,1] neg_hi:[0,0]
v_pk_fma_f32 v[42:43], v[26:27], s[62:63], v[42:43] op_sel:[1,1,0] op_sel_hi:[1,0,1] neg_lo:[0,1,0] neg_hi:[0,1,0]
v_pk_add_f32 v[26:27], v[68:69], v[74:75] neg_lo:[0,1] neg_hi:[0,1]
v_pk_add_f32 v[68:69], v[68:69], v[74:75]
v_pk_mul_f32 v[74:75], v[26:27], s[54:55] op_sel:[0,0] op_sel_hi:[0,1] neg_lo:[0,1] neg_hi:[0,0]
v_pk_fma_f32 v[74:75], v[26:27], s[54:55], v[74:75] op_sel:[1,1,0] op_sel_hi:[1,0,1] neg_lo:[0,1,0] neg_hi:[0,1,0]
v_pk_add_f32 v[26:27], v[16:17], v[72:73] neg_lo:[0,1] neg_hi:[0,1]
v_pk_add_f32 v[16:17], v[16:17], v[72:73]
v_pk_add_f32 v[72:73], v[14:15], v[44:45] neg_lo:[0,1] neg_hi:[0,1]
v_pk_add_f32 v[14:15], v[14:15], v[44:45]
v_pk_mul_f32 v[44:45], v[72:73], s[62:63] op_sel:[0,0] op_sel_hi:[0,1] neg_lo:[0,0] neg_hi:[0,0]
v_pk_fma_f32 v[44:45], v[72:73], s[62:63], v[44:45] op_sel:[1,1,0] op_sel_hi:[1,0,1] neg_lo:[0,1,0] neg_hi:[0,0,0]
v_pk_add_f32 v[72:73], v[64:65], v[28:29] op_sel:[1,1] op_sel_hi:[0,0] neg_lo:[1,0] neg_hi:[0,1]
v_pk_add_f32 v[64:65], v[64:65], v[28:29]
v_pk_add_f32 v[28:29], v[40:41], v[60:61] neg_lo:[0,1] neg_hi:[0,1]
v_pk_add_f32 v[40:41], v[40:41], v[60:61]
v_pk_mul_f32 v[60:61], v[28:29], s[62:63] op_sel:[0,0] op_sel_hi:[0,1] neg_lo:[0,1] neg_hi:[0,0]
v_pk_fma_f32 v[60:61], v[28:29], s[62:63], v[60:61] op_sel:[1,1,0] op_sel_hi:[1,0,1] neg_lo:[0,1,0] neg_hi:[0,1,0]
v_pk_add_f32 v[28:29], v[18:19], v[76:77] neg_lo:[0,1] neg_hi:[0,1]
v_pk_add_f32 v[18:19], v[18:19], v[76:77]
v_pk_add_f32 v[76:77], v[46:47], v[54:55] neg_lo:[0,1] neg_hi:[0,1]
v_pk_add_f32 v[46:47], v[46:47], v[54:55]
v_pk_mul_f32 v[54:55], v[76:77], s[62:63] op_sel:[0,0] op_sel_hi:[0,1] neg_lo:[0,0] neg_hi:[0,0]
v_pk_fma_f32 v[54:55], v[76:77], s[62:63], v[54:55] op_sel:[1,1,0] op_sel_hi:[1,0,1] neg_lo:[0,1,0] neg_hi:[0,0,0]
v_pk_add_f32 v[76:77], v[30:31], v[38:39] op_sel:[1,1] op_sel_hi:[0,0] neg_lo:[1,0] neg_hi:[0,1]
v_pk_add_f32 v[30:31], v[30:31], v[38:39]
v_pk_add_f32 v[38:39], v[62:63], v[70:71] neg_lo:[0,1] neg_hi:[0,1]
v_pk_add_f32 v[62:63], v[62:63], v[70:71]
v_pk_mul_f32 v[70:71], v[38:39], s[62:63] op_sel:[0,0] op_sel_hi:[0,1] neg_lo:[0,1] neg_hi:[0,0]
v_pk_fma_f32 v[70:71], v[38:39], s[62:63], v[70:71] op_sel:[1,1,0] op_sel_hi:[1,0,1] neg_lo:[0,1,0] neg_hi:[0,1,0]
v_pk_add_f32 v[38:39], v[48:49], v[20:21] neg_lo:[0,1] neg_hi:[0,1]
v_pk_add_f32 v[48:49], v[48:49], v[20:21]
v_pk_add_f32 v[20:21], v[32:33], v[52:53] neg_lo:[0,1] neg_hi:[0,1]
v_pk_add_f32 v[32:33], v[32:33], v[52:53]
v_pk_mul_f32 v[52:53], v[20:21], s[62:63] op_sel:[0,0] op_sel_hi:[0,1] neg_lo:[0,0] neg_hi:[0,0]
v_pk_fma_f32 v[52:53], v[20:21], s[62:63], v[52:53] op_sel:[1,1,0] op_sel_hi:[1,0,1] neg_lo:[0,1,0] neg_hi:[0,0,0]
v_pk_add_f32 v[20:21], v[24:25], v[36:37] op_sel:[1,1] op_sel_hi:[0,0] neg_lo:[1,0] neg_hi:[0,1]
v_pk_add_f32 v[24:25], v[24:25], v[36:37]
v_pk_add_f32 v[36:37], v[56:57], v[68:69] neg_lo:[0,1] neg_hi:[0,1]
v_pk_add_f32 v[56:57], v[56:57], v[68:69]
v_pk_mul_f32 v[68:69], v[36:37], s[62:63] op_sel:[0,0] op_sel_hi:[0,1] neg_lo:[0,1] neg_hi:[0,0]
v_pk_fma_f32 v[68:69], v[36:37], s[62:63], v[68:69] op_sel:[1,1,0] op_sel_hi:[1,0,1] neg_lo:[0,1,0] neg_hi:[0,1,0]
v_pk_add_f32 v[36:37], v[22:23], v[78:79] neg_lo:[0,1] neg_hi:[0,1]
v_pk_add_f32 v[22:23], v[22:23], v[78:79]
v_pk_add_f32 v[78:79], v[50:51], v[58:59] neg_lo:[0,1] neg_hi:[0,1]
v_pk_add_f32 v[50:51], v[50:51], v[58:59]
v_pk_mul_f32 v[58:59], v[78:79], s[62:63] op_sel:[0,0] op_sel_hi:[0,1] neg_lo:[0,0] neg_hi:[0,0]
v_pk_fma_f32 v[58:59], v[78:79], s[62:63], v[58:59] op_sel:[1,1,0] op_sel_hi:[1,0,1] neg_lo:[0,1,0] neg_hi:[0,0,0]
v_pk_add_f32 v[78:79], v[34:35], v[42:43] op_sel:[1,1] op_sel_hi:[0,0] neg_lo:[1,0] neg_hi:[0,1]
v_pk_add_f32 v[34:35], v[34:35], v[42:43]
v_pk_add_f32 v[42:43], v[66:67], v[74:75] neg_lo:[0,1] neg_hi:[0,1]
v_pk_add_f32 v[66:67], v[66:67], v[74:75]
v_pk_mul_f32 v[74:75], v[42:43], s[62:63] op_sel:[0,0] op_sel_hi:[0,1] neg_lo:[0,1] neg_hi:[0,0]
v_pk_fma_f32 v[74:75], v[42:43], s[62:63], v[74:75] op_sel:[1,1,0] op_sel_hi:[1,0,1] neg_lo:[0,1,0] neg_hi:[0,1,0]
v_pk_add_f32 v[42:43], v[16:17], v[64:65] neg_lo:[0,1] neg_hi:[0,1]
v_pk_add_f32 v[16:17], v[16:17], v[64:65]
v_pk_add_f32 v[64:65], v[14:15], v[40:41] op_sel:[1,1] op_sel_hi:[0,0] neg_lo:[1,0] neg_hi:[0,1]
v_pk_add_f32 v[14:15], v[14:15], v[40:41]
v_pk_add_f32 v[40:41], v[26:27], v[72:73] neg_lo:[0,1] neg_hi:[0,1]
v_pk_add_f32 v[26:27], v[26:27], v[72:73]
v_pk_add_f32 v[72:73], v[44:45], v[60:61] op_sel:[1,1] op_sel_hi:[0,0] neg_lo:[1,0] neg_hi:[0,1]
v_pk_add_f32 v[44:45], v[44:45], v[60:61]
v_pk_add_f32 v[60:61], v[18:19], v[30:31] neg_lo:[0,1] neg_hi:[0,1]
v_pk_add_f32 v[18:19], v[18:19], v[30:31]
v_pk_add_f32 v[30:31], v[46:47], v[62:63] op_sel:[1,1] op_sel_hi:[0,0] neg_lo:[1,0] neg_hi:[0,1]
v_pk_add_f32 v[46:47], v[46:47], v[62:63]
v_pk_add_f32 v[62:63], v[28:29], v[76:77] neg_lo:[0,1] neg_hi:[0,1]
v_pk_add_f32 v[28:29], v[28:29], v[76:77]
v_pk_add_f32 v[76:77], v[54:55], v[70:71] op_sel:[1,1] op_sel_hi:[0,0] neg_lo:[1,0] neg_hi:[0,1]
v_pk_add_f32 v[54:55], v[54:55], v[70:71]
v_pk_add_f32 v[70:71], v[48:49], v[24:25] neg_lo:[0,1] neg_hi:[0,1]
v_pk_add_f32 v[48:49], v[48:49], v[24:25]
v_pk_add_f32 v[24:25], v[32:33], v[56:57] op_sel:[1,1] op_sel_hi:[0,0] neg_lo:[1,0] neg_hi:[0,1]
v_pk_add_f32 v[32:33], v[32:33], v[56:57]
v_pk_add_f32 v[56:57], v[38:39], v[20:21] neg_lo:[0,1] neg_hi:[0,1]
v_pk_add_f32 v[38:39], v[38:39], v[20:21]
v_pk_add_f32 v[20:21], v[52:53], v[68:69] op_sel:[1,1] op_sel_hi:[0,0] neg_lo:[1,0] neg_hi:[0,1]
v_pk_add_f32 v[52:53], v[52:53], v[68:69]
v_pk_add_f32 v[68:69], v[22:23], v[34:35] neg_lo:[0,1] neg_hi:[0,1]
v_pk_add_f32 v[22:23], v[22:23], v[34:35]
v_pk_add_f32 v[34:35], v[50:51], v[66:67] op_sel:[1,1] op_sel_hi:[0,0] neg_lo:[1,0] neg_hi:[0,1]
v_pk_add_f32 v[50:51], v[50:51], v[66:67]
v_pk_add_f32 v[66:67], v[36:37], v[78:79] neg_lo:[0,1] neg_hi:[0,1]
v_pk_add_f32 v[36:37], v[36:37], v[78:79]
v_pk_add_f32 v[78:79], v[58:59], v[74:75] op_sel:[1,1] op_sel_hi:[0,0] neg_lo:[1,0] neg_hi:[0,1]
v_pk_add_f32 v[58:59], v[58:59], v[74:75]
v_pk_add_f32 v[74:75], v[16:17], v[14:15] neg_lo:[0,1] neg_hi:[0,1]
v_pk_add_f32 v[16:17], v[16:17], v[14:15]
v_pk_add_f32 v[14:15], v[42:43], v[64:65] neg_lo:[0,1] neg_hi:[0,1]
v_pk_add_f32 v[42:43], v[42:43], v[64:65]
v_pk_add_f32 v[64:65], v[26:27], v[44:45] neg_lo:[0,1] neg_hi:[0,1]
v_pk_add_f32 v[26:27], v[26:27], v[44:45]
v_pk_add_f32 v[44:45], v[40:41], v[72:73] neg_lo:[0,1] neg_hi:[0,1]
v_pk_add_f32 v[40:41], v[40:41], v[72:73]
v_pk_add_f32 v[72:73], v[18:19], v[46:47] neg_lo:[0,1] neg_hi:[0,1]
v_pk_add_f32 v[18:19], v[18:19], v[46:47]
v_pk_add_f32 v[46:47], v[60:61], v[30:31] neg_lo:[0,1] neg_hi:[0,1]
v_pk_add_f32 v[60:61], v[60:61], v[30:31]
v_pk_add_f32 v[30:31], v[28:29], v[54:55] neg_lo:[0,1] neg_hi:[0,1]
v_pk_add_f32 v[28:29], v[28:29], v[54:55]
v_pk_add_f32 v[54:55], v[62:63], v[76:77] neg_lo:[0,1] neg_hi:[0,1]
v_pk_add_f32 v[62:63], v[62:63], v[76:77]
v_pk_add_f32 v[76:77], v[48:49], v[32:33] neg_lo:[0,1] neg_hi:[0,1]
v_pk_add_f32 v[48:49], v[48:49], v[32:33]
v_pk_add_f32 v[32:33], v[70:71], v[24:25] neg_lo:[0,1] neg_hi:[0,1]
v_pk_add_f32 v[70:71], v[70:71], v[24:25]
v_pk_add_f32 v[24:25], v[38:39], v[52:53] neg_lo:[0,1] neg_hi:[0,1]
v_pk_add_f32 v[38:39], v[38:39], v[52:53]
v_pk_add_f32 v[52:53], v[56:57], v[20:21] neg_lo:[0,1] neg_hi:[0,1]
v_pk_add_f32 v[56:57], v[56:57], v[20:21]
v_pk_add_f32 v[20:21], v[22:23], v[50:51] neg_lo:[0,1] neg_hi:[0,1]
v_pk_add_f32 v[22:23], v[22:23], v[50:51]
v_pk_add_f32 v[50:51], v[68:69], v[34:35] neg_lo:[0,1] neg_hi:[0,1]
v_pk_add_f32 v[68:69], v[68:69], v[34:35]
v_pk_add_f32 v[34:35], v[36:37], v[58:59] neg_lo:[0,1] neg_hi:[0,1]
v_pk_add_f32 v[36:37], v[36:37], v[58:59]
v_pk_add_f32 v[58:59], v[66:67], v[78:79] neg_lo:[0,1] neg_hi:[0,1]
v_pk_add_f32 v[66:67], v[66:67], v[78:79]
v_pk_mul_f32 v[78:79], v[16:17], v[144:145] op_sel:[0,0] op_sel_hi:[0,1] neg_lo:[0,0] neg_hi:[0,0]
v_pk_fma_f32 v[16:17], v[16:17], v[144:145], v[78:79] op_sel:[1,1,0] op_sel_hi:[1,0,1] neg_lo:[0,1,0] neg_hi:[0,0,0]
v_pk_mul_f32 v[78:79], v[48:49], v[146:147] op_sel:[0,0] op_sel_hi:[0,1] neg_lo:[0,0] neg_hi:[0,0]
v_pk_fma_f32 v[48:49], v[48:49], v[146:147], v[78:79] op_sel:[1,1,0] op_sel_hi:[1,0,1] neg_lo:[0,1,0] neg_hi:[0,0,0]
v_pk_mul_f32 v[78:79], v[18:19], v[148:149] op_sel:[0,0] op_sel_hi:[0,1] neg_lo:[0,0] neg_hi:[0,0]
v_pk_fma_f32 v[18:19], v[18:19], v[148:149], v[78:79] op_sel:[1,1,0] op_sel_hi:[1,0,1] neg_lo:[0,1,0] neg_hi:[0,0,0]
v_pk_mul_f32 v[78:79], v[22:23], v[150:151] op_sel:[0,0] op_sel_hi:[0,1] neg_lo:[0,0] neg_hi:[0,0]
v_pk_fma_f32 v[22:23], v[22:23], v[150:151], v[78:79] op_sel:[1,1,0] op_sel_hi:[1,0,1] neg_lo:[0,1,0] neg_hi:[0,0,0]
v_pk_mul_f32 v[78:79], v[26:27], v[152:153] op_sel:[0,0] op_sel_hi:[0,1] neg_lo:[0,0] neg_hi:[0,0]
v_pk_fma_f32 v[26:27], v[26:27], v[152:153], v[78:79] op_sel:[1,1,0] op_sel_hi:[1,0,1] neg_lo:[0,1,0] neg_hi:[0,0,0]
v_pk_mul_f32 v[78:79], v[38:39], v[154:155] op_sel:[0,0] op_sel_hi:[0,1] neg_lo:[0,0] neg_hi:[0,0]
v_pk_fma_f32 v[38:39], v[38:39], v[154:155], v[78:79] op_sel:[1,1,0] op_sel_hi:[1,0,1] neg_lo:[0,1,0] neg_hi:[0,0,0]
v_pk_mul_f32 v[78:79], v[28:29], v[156:157] op_sel:[0,0] op_sel_hi:[0,1] neg_lo:[0,0] neg_hi:[0,0]
v_pk_fma_f32 v[28:29], v[28:29], v[156:157], v[78:79] op_sel:[1,1,0] op_sel_hi:[1,0,1] neg_lo:[0,1,0] neg_hi:[0,0,0]
v_pk_mul_f32 v[78:79], v[36:37], v[158:159] op_sel:[0,0] op_sel_hi:[0,1] neg_lo:[0,0] neg_hi:[0,0]
v_pk_fma_f32 v[36:37], v[36:37], v[158:159], v[78:79] op_sel:[1,1,0] op_sel_hi:[1,0,1] neg_lo:[0,1,0] neg_hi:[0,0,0]
v_pk_mul_f32 v[78:79], v[42:43], v[160:161] op_sel:[0,0] op_sel_hi:[0,1] neg_lo:[0,0] neg_hi:[0,0]
v_pk_fma_f32 v[42:43], v[42:43], v[160:161], v[78:79] op_sel:[1,1,0] op_sel_hi:[1,0,1] neg_lo:[0,1,0] neg_hi:[0,0,0]
v_pk_mul_f32 v[78:79], v[70:71], v[162:163] op_sel:[0,0] op_sel_hi:[0,1] neg_lo:[0,0] neg_hi:[0,0]
v_pk_fma_f32 v[70:71], v[70:71], v[162:163], v[78:79] op_sel:[1,1,0] op_sel_hi:[1,0,1] neg_lo:[0,1,0] neg_hi:[0,0,0]
v_pk_mul_f32 v[78:79], v[60:61], v[164:165] op_sel:[0,0] op_sel_hi:[0,1] neg_lo:[0,0] neg_hi:[0,0]
v_pk_fma_f32 v[60:61], v[60:61], v[164:165], v[78:79] op_sel:[1,1,0] op_sel_hi:[1,0,1] neg_lo:[0,1,0] neg_hi:[0,0,0]
v_pk_mul_f32 v[78:79], v[68:69], v[166:167] op_sel:[0,0] op_sel_hi:[0,1] neg_lo:[0,0] neg_hi:[0,0]
v_pk_fma_f32 v[68:69], v[68:69], v[166:167], v[78:79] op_sel:[1,1,0] op_sel_hi:[1,0,1] neg_lo:[0,1,0] neg_hi:[0,0,0]
v_pk_mul_f32 v[78:79], v[40:41], v[168:169] op_sel:[0,0] op_sel_hi:[0,1] neg_lo:[0,0] neg_hi:[0,0]
v_pk_fma_f32 v[40:41], v[40:41], v[168:169], v[78:79] op_sel:[1,1,0] op_sel_hi:[1,0,1] neg_lo:[0,1,0] neg_hi:[0,0,0]
v_pk_mul_f32 v[78:79], v[56:57], v[170:171] op_sel:[0,0] op_sel_hi:[0,1] neg_lo:[0,0] neg_hi:[0,0]
v_pk_fma_f32 v[56:57], v[56:57], v[170:171], v[78:79] op_sel:[1,1,0] op_sel_hi:[1,0,1] neg_lo:[0,1,0] neg_hi:[0,0,0]
v_pk_mul_f32 v[78:79], v[62:63], v[172:173] op_sel:[0,0] op_sel_hi:[0,1] neg_lo:[0,0] neg_hi:[0,0]
v_pk_fma_f32 v[62:63], v[62:63], v[172:173], v[78:79] op_sel:[1,1,0] op_sel_hi:[1,0,1] neg_lo:[0,1,0] neg_hi:[0,0,0]
v_pk_mul_f32 v[78:79], v[66:67], v[174:175] op_sel:[0,0] op_sel_hi:[0,1] neg_lo:[0,0] neg_hi:[0,0]
v_pk_fma_f32 v[66:67], v[66:67], v[174:175], v[78:79] op_sel:[1,1,0] op_sel_hi:[1,0,1] neg_lo:[0,1,0] neg_hi:[0,0,0]
v_pk_mul_f32 v[78:79], v[74:75], v[176:177] op_sel:[0,0] op_sel_hi:[0,1] neg_lo:[0,0] neg_hi:[0,0]
v_pk_fma_f32 v[74:75], v[74:75], v[176:177], v[78:79] op_sel:[1,1,0] op_sel_hi:[1,0,1] neg_lo:[0,1,0] neg_hi:[0,0,0]
v_pk_mul_f32 v[78:79], v[76:77], v[178:179] op_sel:[0,0] op_sel_hi:[0,1] neg_lo:[0,0] neg_hi:[0,0]
v_pk_fma_f32 v[76:77], v[76:77], v[178:179], v[78:79] op_sel:[1,1,0] op_sel_hi:[1,0,1] neg_lo:[0,1,0] neg_hi:[0,0,0]
v_pk_mul_f32 v[78:79], v[72:73], v[180:181] op_sel:[0,0] op_sel_hi:[0,1] neg_lo:[0,0] neg_hi:[0,0]
v_pk_fma_f32 v[72:73], v[72:73], v[180:181], v[78:79] op_sel:[1,1,0] op_sel_hi:[1,0,1] neg_lo:[0,1,0] neg_hi:[0,0,0]
v_pk_mul_f32 v[78:79], v[20:21], v[182:183] op_sel:[0,0] op_sel_hi:[0,1] neg_lo:[0,0] neg_hi:[0,0]
v_pk_fma_f32 v[20:21], v[20:21], v[182:183], v[78:79] op_sel:[1,1,0] op_sel_hi:[1,0,1] neg_lo:[0,1,0] neg_hi:[0,0,0]
v_pk_mul_f32 v[78:79], v[64:65], v[184:185] op_sel:[0,0] op_sel_hi:[0,1] neg_lo:[0,0] neg_hi:[0,0]
v_pk_fma_f32 v[64:65], v[64:65], v[184:185], v[78:79] op_sel:[1,1,0] op_sel_hi:[1,0,1] neg_lo:[0,1,0] neg_hi:[0,0,0]
v_pk_mul_f32 v[78:79], v[24:25], v[186:187] op_sel:[0,0] op_sel_hi:[0,1] neg_lo:[0,0] neg_hi:[0,0]
v_pk_fma_f32 v[24:25], v[24:25], v[186:187], v[78:79] op_sel:[1,1,0] op_sel_hi:[1,0,1] neg_lo:[0,1,0] neg_hi:[0,0,0]
v_pk_mul_f32 v[78:79], v[30:31], v[188:189] op_sel:[0,0] op_sel_hi:[0,1] neg_lo:[0,0] neg_hi:[0,0]
v_pk_fma_f32 v[30:31], v[30:31], v[188:189], v[78:79] op_sel:[1,1,0] op_sel_hi:[1,0,1] neg_lo:[0,1,0] neg_hi:[0,0,0]
v_pk_mul_f32 v[78:79], v[34:35], v[190:191] op_sel:[0,0] op_sel_hi:[0,1] neg_lo:[0,0] neg_hi:[0,0]
v_pk_fma_f32 v[34:35], v[34:35], v[190:191], v[78:79] op_sel:[1,1,0] op_sel_hi:[1,0,1] neg_lo:[0,1,0] neg_hi:[0,0,0]
v_pk_mul_f32 v[78:79], v[14:15], v[192:193] op_sel:[0,0] op_sel_hi:[0,1] neg_lo:[0,0] neg_hi:[0,0]
v_pk_fma_f32 v[14:15], v[14:15], v[192:193], v[78:79] op_sel:[1,1,0] op_sel_hi:[1,0,1] neg_lo:[0,1,0] neg_hi:[0,0,0]
v_pk_mul_f32 v[78:79], v[32:33], v[194:195] op_sel:[0,0] op_sel_hi:[0,1] neg_lo:[0,0] neg_hi:[0,0]
v_pk_fma_f32 v[32:33], v[32:33], v[194:195], v[78:79] op_sel:[1,1,0] op_sel_hi:[1,0,1] neg_lo:[0,1,0] neg_hi:[0,0,0]
v_pk_mul_f32 v[78:79], v[46:47], v[196:197] op_sel:[0,0] op_sel_hi:[0,1] neg_lo:[0,0] neg_hi:[0,0]
v_pk_fma_f32 v[46:47], v[46:47], v[196:197], v[78:79] op_sel:[1,1,0] op_sel_hi:[1,0,1] neg_lo:[0,1,0] neg_hi:[0,0,0]
v_pk_mul_f32 v[78:79], v[50:51], v[198:199] op_sel:[0,0] op_sel_hi:[0,1] neg_lo:[0,0] neg_hi:[0,0]
v_pk_fma_f32 v[50:51], v[50:51], v[198:199], v[78:79] op_sel:[1,1,0] op_sel_hi:[1,0,1] neg_lo:[0,1,0] neg_hi:[0,0,0]
v_pk_mul_f32 v[78:79], v[44:45], v[200:201] op_sel:[0,0] op_sel_hi:[0,1] neg_lo:[0,0] neg_hi:[0,0]
v_pk_fma_f32 v[44:45], v[44:45], v[200:201], v[78:79] op_sel:[1,1,0] op_sel_hi:[1,0,1] neg_lo:[0,1,0] neg_hi:[0,0,0]
v_pk_mul_f32 v[78:79], v[52:53], v[202:203] op_sel:[0,0] op_sel_hi:[0,1] neg_lo:[0,0] neg_hi:[0,0]
v_pk_fma_f32 v[52:53], v[52:53], v[202:203], v[78:79] op_sel:[1,1,0] op_sel_hi:[1,0,1] neg_lo:[0,1,0] neg_hi:[0,0,0]
v_pk_mul_f32 v[78:79], v[54:55], v[204:205] op_sel:[0,0] op_sel_hi:[0,1] neg_lo:[0,0] neg_hi:[0,0]
v_pk_fma_f32 v[54:55], v[54:55], v[204:205], v[78:79] op_sel:[1,1,0] op_sel_hi:[1,0,1] neg_lo:[0,1,0] neg_hi:[0,0,0]
v_pk_mul_f32 v[78:79], v[58:59], v[206:207] op_sel:[0,0] op_sel_hi:[0,1] neg_lo:[0,0] neg_hi:[0,0]
v_pk_fma_f32 v[58:59], v[58:59], v[206:207], v[78:79] op_sel:[1,1,0] op_sel_hi:[1,0,1] neg_lo:[0,1,0] neg_hi:[0,0,0]
ds_write_b64 v4, v[16:17] offset:0
ds_write_b64 v4, v[48:49] offset:16
ds_write_b64 v4, v[18:19] offset:32
ds_write_b64 v4, v[22:23] offset:48
ds_write_b64 v4, v[26:27] offset:64
ds_write_b64 v4, v[38:39] offset:80
ds_write_b64 v4, v[28:29] offset:96
ds_write_b64 v4, v[36:37] offset:112
ds_write_b64 v4, v[42:43] offset:128
ds_write_b64 v4, v[70:71] offset:144
ds_write_b64 v4, v[60:61] offset:160
ds_write_b64 v4, v[68:69] offset:176
ds_write_b64 v4, v[40:41] offset:192
ds_write_b64 v4, v[56:57] offset:208
ds_write_b64 v4, v[62:63] offset:224
ds_write_b64 v4, v[66:67] offset:240
ds_write_b64 v4, v[74:75] offset:256
ds_write_b64 v4, v[76:77] offset:272
ds_write_b64 v4, v[72:73] offset:288
ds_write_b64 v4, v[20:21] offset:304
ds_write_b64 v4, v[64:65] offset:320
ds_write_b64 v4, v[24:25] offset:336
ds_write_b64 v4, v[30:31] offset:352
ds_write_b64 v4, v[34:35] offset:368
ds_write_b64 v4, v[14:15] offset:384
ds_write_b64 v4, v[32:33] offset:400
ds_write_b64 v4, v[46:47] offset:416
ds_write_b64 v4, v[50:51] offset:432
ds_write_b64 v4, v[44:45] offset:448
ds_write_b64 v4, v[52:53] offset:464
ds_write_b64 v4, v[54:55] offset:480
ds_write_b64 v4, v[58:59] offset:496
s_waitcnt lgkmcnt(0)
ds_read_b64 v[16:17], v3 offset:0
ds_read_b64 v[48:49], v3 offset:8448
ds_read_b64 v[18:19], v3 offset:528
ds_read_b64 v[50:51], v3 offset:8976
ds_read_b64 v[20:21], v3 offset:1056
ds_read_b64 v[52:53], v3 offset:9504
ds_read_b64 v[22:23], v3 offset:1584
ds_read_b64 v[54:55], v3 offset:10032
ds_read_b64 v[24:25], v3 offset:2112
ds_read_b64 v[56:57], v3 offset:10560
ds_read_b64 v[26:27], v3 offset:2640
ds_read_b64 v[58:59], v3 offset:11088
ds_read_b64 v[28:29], v3 offset:3168
ds_read_b64 v[60:61], v3 offset:11616
ds_read_b64 v[30:31], v3 offset:3696
ds_read_b64 v[62:63], v3 offset:12144
ds_read_b64 v[32:33], v3 offset:4224
ds_read_b64 v[64:65], v3 offset:12672
ds_read_b64 v[34:35], v3 offset:4752
ds_read_b64 v[66:67], v3 offset:13200
ds_read_b64 v[36:37], v3 offset:5280
ds_read_b64 v[68:69], v3 offset:13728
ds_read_b64 v[38:39], v3 offset:5808
ds_read_b64 v[70:71], v3 offset:14256
ds_read_b64 v[40:41], v3 offset:6336
ds_read_b64 v[72:73], v3 offset:14784
ds_read_b64 v[42:43], v3 offset:6864
ds_read_b64 v[74:75], v3 offset:15312
ds_read_b64 v[44:45], v3 offset:7392
ds_read_b64 v[76:77], v3 offset:15840
ds_read_b64 v[46:47], v3 offset:7920
ds_read_b64 v[78:79], v3 offset:16368
s_waitcnt lgkmcnt(0)
v_pk_add_f32 v[14:15], v[16:17], v[48:49] neg_lo:[0,1] neg_hi:[0,1]
v_pk_add_f32 v[16:17], v[16:17], v[48:49]
v_pk_add_f32 v[48:49], v[18:19], v[50:51] neg_lo:[0,1] neg_hi:[0,1]
v_pk_add_f32 v[18:19], v[18:19], v[50:51]
v_pk_mul_f32 v[50:51], v[48:49], s[50:51] op_sel:[0,0] op_sel_hi:[0,1] neg_lo:[0,0] neg_hi:[0,0]
v_pk_fma_f32 v[50:51], v[48:49], s[50:51], v[50:51] op_sel:[1,1,0] op_sel_hi:[1,0,1] neg_lo:[0,1,0] neg_hi:[0,0,0]
v_pk_add_f32 v[48:49], v[20:21], v[52:53] neg_lo:[0,1] neg_hi:[0,1]
v_pk_add_f32 v[20:21], v[20:21], v[52:53]
v_pk_mul_f32 v[52:53], v[48:49], s[54:55] op_sel:[0,0] op_sel_hi:[0,1] neg_lo:[0,0] neg_hi:[0,0]
v_pk_fma_f32 v[52:53], v[48:49], s[54:55], v[52:53] op_sel:[1,1,0] op_sel_hi:[1,0,1] neg_lo:[0,1,0] neg_hi:[0,0,0]
v_pk_add_f32 v[48:49], v[22:23], v[54:55] neg_lo:[0,1] neg_hi:[0,1]
v_pk_add_f32 v[22:23], v[22:23], v[54:55]
v_pk_mul_f32 v[54:55], v[48:49], s[58:59] op_sel:[0,0] op_sel_hi:[0,1] neg_lo:[0,0] neg_hi:[0,0]
v_pk_fma_f32 v[54:55], v[48:49], s[58:59], v[54:55] op_sel:[1,1,0] op_sel_hi:[1,0,1] neg_lo:[0,1,0] neg_hi:[0,0,0]
v_pk_add_f32 v[48:49], v[24:25], v[56:57] neg_lo:[0,1] neg_hi:[0,1]
v_pk_add_f32 v[24:25], v[24:25], v[56:57]
v_pk_mul_f32 v[56:57], v[48:49], s[62:63] op_sel:[0,0] op_sel_hi:[0,1] neg_lo:[0,0] neg_hi:[0,0]
v_pk_fma_f32 v[56:57], v[48:49], s[62:63], v[56:57] op_sel:[1,1,0] op_sel_hi:[1,0,1] neg_lo:[0,1,0] neg_hi:[0,0,0]
v_pk_add_f32 v[48:49], v[26:27], v[58:59] neg_lo:[0,1] neg_hi:[0,1]
v_pk_add_f32 v[26:27], v[26:27], v[58:59]
v_pk_mul_f32 v[58:59], v[48:49], s[58:59] op_sel:[0,1] op_sel_hi:[0,0] neg_lo:[0,0] neg_hi:[0,0]
v_pk_fma_f32 v[58:59], v[48:49], s[58:59], v[58:59] op_sel:[1,0,0] op_sel_hi:[1,1,1] neg_lo:[0,1,0] neg_hi:[0,0,0]
v_pk_add_f32 v[48:49], v[28:29], v[60:61] neg_lo:[0,1] neg_hi:[0,1]
v_pk_add_f32 v[28:29], v[28:29], v[60:61]
v_pk_mul_f32 v[60:61], v[48:49], s[54:55] op_sel:[0,1] op_sel_hi:[0,0] neg_lo:[0,0] neg_hi:[0,0]
v_pk_fma_f32 v[60:61], v[48:49], s[54:55], v[60:61] op_sel:[1,0,0] op_sel_hi:[1,1,1] neg_lo:[0,1,0] neg_hi:[0,0,0]
v_pk_add_f32 v[48:49], v[30:31], v[62:63] neg_lo:[0,1] neg_hi:[0,1]
v_pk_add_f32 v[30:31], v[30:31], v[62:63]
v_pk_mul_f32 v[62:63], v[48:49], s[50:51] op_sel:[0,1] op_sel_hi:[0,0] neg_lo:[0,0] neg_hi:[0,0]
v_pk_fma_f32 v[62:63], v[48:49], s[50:51], v[62:63] op_sel:[1,0,0] op_sel_hi:[1,1,1] neg_lo:[0,1,0] neg_hi:[0,0,0]
v_pk_add_f32 v[48:49], v[32:33], v[64:65] op_sel:[1,1] op_sel_hi:[0,0] neg_lo:[1,0] neg_hi:[0,1]
v_pk_add_f32 v[32:33], v[32:33], v[64:65]
v_pk_add_f32 v[64:65], v[34:35], v[66:67] neg_lo:[0,1] neg_hi:[0,1]
v_pk_add_f32 v[34:35], v[34:35], v[66:67]
v_pk_mul_f32 v[66:67], v[64:65], s[50:51] op_sel:[0,1] op_sel_hi:[0,0] neg_lo:[0,1] neg_hi:[0,0]
v_pk_fma_f32 v[66:67], v[64:65], s[50:51], v[66:67] op_sel:[1,0,0] op_sel_hi:[1,1,1] neg_lo:[0,1,0] neg_hi:[0,1,0]
v_pk_add_f32 v[64:65], v[36:37], v[68:69] neg_lo:[0,1] neg_hi:[0,1]
v_pk_add_f32 v[36:37], v[36:37], v[68:69]
v_pk_mul_f32 v[68:69], v[64:65], s[54:55] op_sel:[0,1] op_sel_hi:[0,0] neg_lo:[0,1] neg_hi:[0,0]
v_pk_fma_f32 v[68:69], v[64:65], s[54:55], v[68:69] op_sel:[1,0,0] op_sel_hi:[1,1,1] neg_lo:[0,1,0] neg_hi:[0,1,0]
v_pk_add_f32 v[64:65], v[38:39], v[70:71] neg_lo:[0,1] neg_hi:[0,1]
v_pk_add_f32 v[38:39], v[38:39], v[70:71]
v_pk_mul_f32 v[70:71], v[64:65], s[58:59] op_sel:[0,1] op_sel_hi:[0,0] neg_lo:[0,1] neg_hi:[0,0]
v_pk_fma_f32 v[70:71], v[64:65], s[58:59], v[70:71] op_sel:[1,0,0] op_sel_hi:[1,1,1] neg_lo:[0,1,0] neg_hi:[0,1,0]
v_pk_add_f32 v[64:65], v[40:41], v[72:73] neg_lo:[0,1] neg_hi:[0,1]
v_pk_add_f32 v[40:41], v[40:41], v[72:73]
v_pk_mul_f32 v[72:73], v[64:65], s[62:63] op_sel:[0,0] op_sel_hi:[0,1] neg_lo:[0,1] neg_hi:[0,0]
v_pk_fma_f32 v[72:73], v[64:65], s[62:63], v[72:73] op_sel:[1,1,0] op_sel_hi:[1,0,1] neg_lo:[0,1,0] neg_hi:[0,1,0]
v_pk_add_f32 v[64:65], v[42:43], v[74:75] neg_lo:[0,1] neg_hi:[0,1]
v_pk_add_f32 v[42:43], v[42:43], v[74:75]
v_pk_mul_f32 v[74:75], v[64:65], s[58:59] op_sel:[0,0] op_sel_hi:[0,1] neg_lo:[0,1] neg_hi:[0,0]
v_pk_fma_f32 v[74:75], v[64:65], s[58:59], v[74:75] op_sel:[1,1,0] op_sel_hi:[1,0,1] neg_lo:[0,1,0] neg_hi:[0,1,0]
v_pk_add_f32 v[64:65], v[44:45], v[76:77] neg_lo:[0,1] neg_hi:[0,1]
v_pk_add_f32 v[44:45], v[44:45], v[76:77]
v_pk_mul_f32 v[76:77], v[64:65], s[54:55] op_sel:[0,0] op_sel_hi:[0,1] neg_lo:[0,1] neg_hi:[0,0]
v_pk_fma_f32 v[76:77], v[64:65], s[54:55], v[76:77] op_sel:[1,1,0] op_sel_hi:[1,0,1] neg_lo:[0,1,0] neg_hi:[0,1,0]
v_pk_add_f32 v[64:65], v[46:47], v[78:79] neg_lo:[0,1] neg_hi:[0,1]
v_pk_add_f32 v[46:47], v[46:47], v[78:79]
v_pk_mul_f32 v[78:79], v[64:65], s[50:51] op_sel:[0,0] op_sel_hi:[0,1] neg_lo:[0,1] neg_hi:[0,0]
v_pk_fma_f32 v[78:79], v[64:65], s[50:51], v[78:79] op_sel:[1,1,0] op_sel_hi:[1,0,1] neg_lo:[0,1,0] neg_hi:[0,1,0]
v_pk_add_f32 v[64:65], v[16:17], v[32:33] neg_lo:[0,1] neg_hi:[0,1]
v_pk_add_f32 v[16:17], v[16:17], v[32:33]
v_pk_add_f32 v[32:33], v[18:19], v[34:35] neg_lo:[0,1] neg_hi:[0,1]
v_pk_add_f32 v[18:19], v[18:19], v[34:35]
v_pk_mul_f32 v[34:35], v[32:33], s[54:55] op_sel:[0,0] op_sel_hi:[0,1] neg_lo:[0,0] neg_hi:[0,0]
v_pk_fma_f32 v[34:35], v[32:33], s[54:55], v[34:35] op_sel:[1,1,0] op_sel_hi:[1,0,1] neg_lo:[0,1,0] neg_hi:[0,0,0]
v_pk_add_f32 v[32:33], v[20:21], v[36:37] neg_lo:[0,1] neg_hi:[0,1]
v_pk_add_f32 v[20:21], v[20:21], v[36:37]
v_pk_mul_f32 v[36:37], v[32:33], s[62:63] op_sel:[0,0] op_sel_hi:[0,1] neg_lo:[0,0] neg_hi:[0,0]
v_pk_fma_f32 v[36:37], v[32:33], s[62:63], v[36:37] op_sel:[1,1,0] op_sel_hi:[1,0,1] neg_lo:[0,1,0] neg_hi:[0,0,0]
v_pk_add_f32 v[32:33], v[22:23], v[38:39] neg_lo:[0,1] neg_hi:[0,1]
v_pk_add_f32 v[22:23], v[22:23], v[38:39]
v_pk_mul_f32 v[38:39], v[32:33], s[54:55] op_sel:[0,1] op_sel_hi:[0,0] neg_lo:[0,0] neg_hi:[0,0]
v_pk_fma_f32 v[38:39], v[32:33], s[54:55], v[38:39] op_sel:[1,0,0] op_sel_hi:[1,1,1] neg_lo:[0,1,0] neg_hi:[0,0,0]
v_pk_add_f32 v[32:33], v[24:25], v[40:41] op_sel:[1,1] op_sel_hi:[0,0] neg_lo:[1,0] neg_hi:[0,1]
v_pk_add_f32 v[24:25], v[24:25], v[40:41]
v_pk_add_f32 v[40:41], v[26:27], v[42:43] neg_lo:[0,1] neg_hi:[0,1]
v_pk_add_f32 v[26:27], v[26:27], v[42:43]
v_pk_mul_f32 v[42:43], v[40:41], s[54:55] op_sel:[0,1] op_sel_hi:[0,0] neg_lo:[0,1] neg_hi:[0,0]
v_pk_fma_f32 v[42:43], v[40:41], s[54:55], v[42:43] op_sel:[1,0,0] op_sel_hi:[1,1,1] neg_lo:[0,1,0] neg_hi:[0,1,0]
v_pk_add_f32 v[40:41], v[28:29], v[44:45] neg_lo:[0,1] neg_hi:[0,1]
v_pk_add_f32 v[28:29], v[28:29], v[44:45]
v_pk_mul_f32 v[44:45], v[40:41], s[62:63] op_sel:[0,0] op_sel_hi:[0,1] neg_lo:[0,1] neg_hi:[0,0]
v_pk_fma_f32 v[44:45], v[40:41], s[62:63], v[44:45] op_sel:[1,1,0] op_sel_hi:[1,0,1] neg_lo:[0,1,0] neg_hi:[0,1,0]
v_pk_add_f32 v[40:41], v[30:31], v[46:47] neg_lo:[0,1] neg_hi:[0,1]
v_pk_add_f32 v[30:31], v[30:31], v[46:47]
v_pk_mul_f32 v[46:47], v[40:41], s[54:55] op_sel:[0,0] op_sel_hi:[0,1] neg_lo:[0,1] neg_hi:[0,0]
v_pk_fma_f32 v[46:47], v[40:41], s[54:55], v[46:47] op_sel:[1,1,0] op_sel_hi:[1,0,1] neg_lo:[0,1,0] neg_hi:[0,1,0]
v_pk_add_f32 v[40:41], v[14:15], v[48:49] neg_lo:[0,1] neg_hi:[0,1]
v_pk_add_f32 v[14:15], v[14:15], v[48:49]
v_pk_add_f32 v[48:49], v[50:51], v[66:67] neg_lo:[0,1] neg_hi:[0,1]
v_pk_add_f32 v[50:51], v[50:51], v[66:67]
v_pk_mul_f32 v[66:67], v[48:49], s[54:55] op_sel:[0,0] op_sel_hi:[0,1] neg_lo:[0,0] neg_hi:[0,0]
v_pk_fma_f32 v[66:67], v[48:49], s[54:55], v[66:67] op_sel:[1,1,0] op_sel_hi:[1,0,1] neg_lo:[0,1,0] neg_hi:[0,0,0]
v_pk_add_f32 v[48:49], v[52:53], v[68:69] neg_lo:[0,1] neg_hi:[0,1]
v_pk_add_f32 v[52:53], v[52:53], v[68:69]
v_pk_mul_f32 v[68:69], v[48:49], s[62:63] op_sel:[0,0] op_sel_hi:[0,1] neg_lo:[0,0] neg_hi:[0,0]
v_pk_fma_f32 v[68:69], v[48:49], s[62:63], v[68:69] op_sel:[1,1,0] op_sel_hi:[1,0,1] neg_lo:[0,1,0] neg_hi:[0,0,0]
v_pk_add_f32 v[48:49], v[54:55], v[70:71] neg_lo:[0,1] neg_hi:[0,1]
v_pk_add_f32 v[54:55], v[54:55], v[70:71]
v_pk_mul_f32 v[70:71], v[48:49], s[54:55] op_sel:[0,1] op_sel_hi:[0,0] neg_lo:[0,0] neg_hi:[0,0]
v_pk_fma_f32 v[70:71], v[48:49], s[54:55], v[70:71] op_sel:[1,0,0] op_sel_hi:[1,1,1] neg_lo:[0,1,0] neg_hi:[0,0,0]
v_pk_add_f32 v[48:49], v[56:57], v[72:73] op_sel:[1,1] op_sel_hi:[0,0] neg_lo:[1,0] neg_hi:[0,1]
v_pk_add_f32 v[56:57], v[56:57], v[72:73]
v_pk_add_f32 v[72:73], v[58:59], v[74:75] neg_lo:[0,1] neg_hi:[0,1]
v_pk_add_f32 v[58:59], v[58:59], v[74:75]
v_pk_mul_f32 v[74:75], v[72:73], s[54:55] op_sel:[0,1] op_sel_hi:[0,0] neg_lo:[0,1] neg_hi:[0,0]
v_pk_fma_f32 v[74:75], v[72:73], s[54:55], v[74:75] op_sel:[1,0,0] op_sel_hi:[1,1,1] neg_lo:[0,1,0] neg_hi:[0,1,0]
v_pk_add_f32 v[72:73], v[60:61], v[76:77] neg_lo:[0,1] neg_hi:[0,1]
v_pk_add_f32 v[60:61], v[60:61], v[76:77]
v_pk_mul_f32 v[76:77], v[72:73], s[62:63] op_sel:[0,0] op_sel_hi:[0,1] neg_lo:[0,1] neg_hi:[0,0]
v_pk_fma_f32 v[76:77], v[72:73], s[62:63], v[76:77] op_sel:[1,1,0] op_sel_hi:[1,0,1] neg_lo:[0,1,0] neg_hi:[0,1,0]
v_pk_add_f32 v[72:73], v[62:63], v[78:79] neg_lo:[0,1] neg_hi:[0,1]
v_pk_add_f32 v[62:63], v[62:63], v[78:79]
v_pk_mul_f32 v[78:79], v[72:73], s[54:55] op_sel:[0,0] op_sel_hi:[0,1] neg_lo:[0,1] neg_hi:[0,0]
v_pk_fma_f32 v[78:79], v[72:73], s[54:55], v[78:79] op_sel:[1,1,0] op_sel_hi:[1,0,1] neg_lo:[0,1,0] neg_hi:[0,1,0]
v_pk_add_f32 v[72:73], v[16:17], v[24:25] neg_lo:[0,1] neg_hi:[0,1]
v_pk_add_f32 v[16:17], v[16:17], v[24:25]
v_pk_add_f32 v[24:25], v[18:19], v[26:27] neg_lo:[0,1] neg_hi:[0,1]
v_pk_add_f32 v[18:19], v[18:19], v[26:27]
v_pk_mul_f32 v[26:27], v[24:25], s[62:63] op_sel:[0,0] op_sel_hi:[0,1] neg_lo:[0,0] neg_hi:[0,0]
v_pk_fma_f32 v[26:27], v[24:25], s[62:63], v[26:27] op_sel:[1,1,0] op_sel_hi:[1,0,1] neg_lo:[0,1,0] neg_hi:[0,0,0]
v_pk_add_f32 v[24:25], v[20:21], v[28:29] op_sel:[1,1] op_sel_hi:[0,0] neg_lo:[1,0] neg_hi:[0,1]
v_pk_add_f32 v[20:21], v[20:21], v[28:29]
v_pk_add_f32 v[28:29], v[22:23], v[30:31] neg_lo:[0,1] neg_hi:[0,1]
v_pk_add_f32 v[22:23], v[22:23], v[30:31]
v_pk_mul_f32 v[30:31], v[28:29], s[62:63] op_sel:[0,0] op_sel_hi:[0,1] neg_lo:[0,1] neg_hi:[0,0]
v_pk_fma_f32 v[30:31], v[28:29], s[62:63], v[30:31] op_sel:[1,1,0] op_sel_hi:[1,0,1] neg_lo:[0,1,0] neg_hi:[0,1,0]
v_pk_add_f32 v[28:29], v[64:65], v[32:33] neg_lo:[0,1] neg_hi:[0,1]
v_pk_add_f32 v[64:65], v[64:65], v[32:33]
v_pk_add_f32 v[32:33], v[34:35], v[42:43] neg_lo:[0,1] neg_hi:[0,1]
v_pk_add_f32 v[34:35], v[34:35], v[42:43]
v_pk_mul_f32 v[42:43], v[32:33], s[62:63] op_sel:[0,0] op_sel_hi:[0,1] neg_lo:[0,0] neg_hi:[0,0]
v_pk_fma_f32 v[42:43], v[32:33], s[62:63], v[42:43] op_sel:[1,1,0] op_sel_hi:[1,0,1] neg_lo:[0,1,0] neg_hi:[0,0,0]
v_pk_add_f32 v[32:33], v[36:37], v[44:45] op_sel:[1,1] op_sel_hi:[0,0] neg_lo:[1,0] neg_hi:[0,1]
v_pk_add_f32 v[36:37], v[36:37], v[44:45]
v_pk_add_f32 v[44:45], v[38:39], v[46:47] neg_lo:[0,1] neg_hi:[0,1]
v_pk_add_f32 v[38:39], v[38:39], v[46:47]
v_pk_mul_f32 v[46:47], v[44:45], s[62:63] op_sel:[0,0] op_sel_hi:[0,1] neg_lo:[0,1] neg_hi:[0,0]
v_pk_fma_f32 v[46:47], v[44:45], s[62:63], v[46:47] op_sel:[1,1,0] op_sel_hi:[1,0,1] neg_lo:[0,1,0] neg_hi:[0,1,0]
v_pk_add_f32 v[44:45], v[14:15], v[56:57] neg_lo:[0,1] neg_hi:[0,1]
v_pk_add_f32 v[14:15], v[14:15], v[56:57]
v_pk_add_f32 v[56:57], v[50:51], v[58:59] neg_lo:[0,1] neg_hi:[0,1]
v_pk_add_f32 v[50:51], v[50:51], v[58:59]
v_pk_mul_f32 v[58:59], v[56:57], s[62:63] op_sel:[0,0] op_sel_hi:[0,1] neg_lo:[0,0] neg_hi:[0,0]
v_pk_fma_f32 v[58:59], v[56:57], s[62:63], v[58:59] op_sel:[1,1,0] op_sel_hi:[1,0,1] neg_lo:[0,1,0] neg_hi:[0,0,0]
v_pk_add_f32 v[56:57], v[52:53], v[60:61] op_sel:[1,1] op_sel_hi:[0,0] neg_lo:[1,0] neg_hi:[0,1]
v_pk_add_f32 v[52:53], v[52:53], v[60:61]
v_pk_add_f32 v[60:61], v[54:55], v[62:63] neg_lo:[0,1] neg_hi:[0,1]
v_pk_add_f32 v[54:55], v[54:55], v[62:63]
v_pk_mul_f32 v[62:63], v[60:61], s[62:63] op_sel:[0,0] op_sel_hi:[0,1] neg_lo:[0,1] neg_hi:[0,0]
v_pk_fma_f32 v[62:63], v[60:61], s[62:63], v[62:63] op_sel:[1,1,0] op_sel_hi:[1,0,1] neg_lo:[0,1,0] neg_hi:[0,1,0]
v_pk_add_f32 v[60:61], v[40:41], v[48:49] neg_lo:[0,1] neg_hi:[0,1]
v_pk_add_f32 v[40:41], v[40:41], v[48:49]
v_pk_add_f32 v[48:49], v[66:67], v[74:75] neg_lo:[0,1] neg_hi:[0,1]
v_pk_add_f32 v[66:67], v[66:67], v[74:75]
v_pk_mul_f32 v[74:75], v[48:49], s[62:63] op_sel:[0,0] op_sel_hi:[0,1] neg_lo:[0,0] neg_hi:[0,0]
v_pk_fma_f32 v[74:75], v[48:49], s[62:63], v[74:75] op_sel:[1,1,0] op_sel_hi:[1,0,1] neg_lo:[0,1,0] neg_hi:[0,0,0]
v_pk_add_f32 v[48:49], v[68:69], v[76:77] op_sel:[1,1] op_sel_hi:[0,0] neg_lo:[1,0] neg_hi:[0,1]
v_pk_add_f32 v[68:69], v[68:69], v[76:77]
v_pk_add_f32 v[76:77], v[70:71], v[78:79] neg_lo:[0,1] neg_hi:[0,1]
v_pk_add_f32 v[70:71], v[70:71], v[78:79]
v_pk_mul_f32 v[78:79], v[76:77], s[62:63] op_sel:[0,0] op_sel_hi:[0,1] neg_lo:[0,1] neg_hi:[0,0]
v_pk_fma_f32 v[78:79], v[76:77], s[62:63], v[78:79] op_sel:[1,1,0] op_sel_hi:[1,0,1] neg_lo:[0,1,0] neg_hi:[0,1,0]
v_pk_add_f32 v[76:77], v[16:17], v[20:21] neg_lo:[0,1] neg_hi:[0,1]
v_pk_add_f32 v[16:17], v[16:17], v[20:21]
v_pk_add_f32 v[20:21], v[18:19], v[22:23] op_sel:[1,1] op_sel_hi:[0,0] neg_lo:[1,0] neg_hi:[0,1]
v_pk_add_f32 v[18:19], v[18:19], v[22:23]
v_pk_add_f32 v[22:23], v[72:73], v[24:25] neg_lo:[0,1] neg_hi:[0,1]
v_pk_add_f32 v[72:73], v[72:73], v[24:25]
v_pk_add_f32 v[24:25], v[26:27], v[30:31] op_sel:[1,1] op_sel_hi:[0,0] neg_lo:[1,0] neg_hi:[0,1]
v_pk_add_f32 v[26:27], v[26:27], v[30:31]
v_pk_add_f32 v[30:31], v[64:65], v[36:37] neg_lo:[0,1] neg_hi:[0,1]
v_pk_add_f32 v[64:65], v[64:65], v[36:37]
v_pk_add_f32 v[36:37], v[34:35], v[38:39] op_sel:[1,1] op_sel_hi:[0,0] neg_lo:[1,0] neg_hi:[0,1]
v_pk_add_f32 v[34:35], v[34:35], v[38:39]
v_pk_add_f32 v[38:39], v[28:29], v[32:33] neg_lo:[0,1] neg_hi:[0,1]
v_pk_add_f32 v[28:29], v[28:29], v[32:33]
v_pk_add_f32 v[32:33], v[42:43], v[46:47] op_sel:[1,1] op_sel_hi:[0,0] neg_lo:[1,0] neg_hi:[0,1]
v_pk_add_f32 v[42:43], v[42:43], v[46:47]
v_pk_add_f32 v[46:47], v[14:15], v[52:53] neg_lo:[0,1] neg_hi:[0,1]
v_pk_add_f32 v[14:15], v[14:15], v[52:53]
v_pk_add_f32 v[52:53], v[50:51], v[54:55] op_sel:[1,1] op_sel_hi:[0,0] neg_lo:[1,0] neg_hi:[0,1]
v_pk_add_f32 v[50:51], v[50:51], v[54:55]
v_pk_add_f32 v[54:55], v[44:45], v[56:57] neg_lo:[0,1] neg_hi:[0,1]
v_pk_add_f32 v[44:45], v[44:45], v[56:57]
v_pk_add_f32 v[56:57], v[58:59], v[62:63] op_sel:[1,1] op_sel_hi:[0,0] neg_lo:[1,0] neg_hi:[0,1]
v_pk_add_f32 v[58:59], v[58:59], v[62:63]
v_pk_add_f32 v[62:63], v[40:41], v[68:69] neg_lo:[0,1] neg_hi:[0,1]
v_pk_add_f32 v[40:41], v[40:41], v[68:69]
v_pk_add_f32 v[68:69], v[66:67], v[70:71] op_sel:[1,1] op_sel_hi:[0,0] neg_lo:[1,0] neg_hi:[0,1]
v_pk_add_f32 v[66:67], v[66:67], v[70:71]
v_pk_add_f32 v[70:71], v[60:61], v[48:49] neg_lo:[0,1] neg_hi:[0,1]
v_pk_add_f32 v[60:61], v[60:61], v[48:49]
v_pk_add_f32 v[48:49], v[74:75], v[78:79] op_sel:[1,1] op_sel_hi:[0,0] neg_lo:[1,0] neg_hi:[0,1]
v_pk_add_f32 v[74:75], v[74:75], v[78:79]
v_pk_add_f32 v[78:79], v[16:17], v[18:19] neg_lo:[0,1] neg_hi:[0,1]
v_pk_add_f32 v[16:17], v[16:17], v[18:19]
v_pk_add_f32 v[18:19], v[76:77], v[20:21] neg_lo:[0,1] neg_hi:[0,1]
v_pk_add_f32 v[76:77], v[76:77], v[20:21]
v_pk_add_f32 v[20:21], v[72:73], v[26:27] neg_lo:[0,1] neg_hi:[0,1]
v_pk_add_f32 v[72:73], v[72:73], v[26:27]
v_pk_add_f32 v[26:27], v[22:23], v[24:25] neg_lo:[0,1] neg_hi:[0,1]
v_pk_add_f32 v[22:23], v[22:23], v[24:25]
v_pk_add_f32 v[24:25], v[64:65], v[34:35] neg_lo:[0,1] neg_hi:[0,1]
v_pk_add_f32 v[64:65], v[64:65], v[34:35]
v_pk_add_f32 v[34:35], v[30:31], v[36:37] neg_lo:[0,1] neg_hi:[0,1]
v_pk_add_f32 v[30:31], v[30:31], v[36:37]
v_pk_add_f32 v[36:37], v[28:29], v[42:43] neg_lo:[0,1] neg_hi:[0,1]
v_pk_add_f32 v[28:29], v[28:29], v[42:43]
v_pk_add_f32 v[42:43], v[38:39], v[32:33] neg_lo:[0,1] neg_hi:[0,1]
v_pk_add_f32 v[38:39], v[38:39], v[32:33]
v_pk_add_f32 v[32:33], v[14:15], v[50:51] neg_lo:[0,1] neg_hi:[0,1]
v_pk_add_f32 v[14:15], v[14:15], v[50:51]
v_pk_add_f32 v[50:51], v[46:47], v[52:53] neg_lo:[0,1] neg_hi:[0,1]
v_pk_add_f32 v[46:47], v[46:47], v[52:53]
v_pk_add_f32 v[52:53], v[44:45], v[58:59] neg_lo:[0,1] neg_hi:[0,1]
v_pk_add_f32 v[44:45], v[44:45], v[58:59]
v_pk_add_f32 v[58:59], v[54:55], v[56:57] neg_lo:[0,1] neg_hi:[0,1]
v_pk_add_f32 v[54:55], v[54:55], v[56:57]
v_pk_add_f32 v[56:57], v[40:41], v[66:67] neg_lo:[0,1] neg_hi:[0,1]
v_pk_add_f32 v[40:41], v[40:41], v[66:67]
v_pk_add_f32 v[66:67], v[62:63], v[68:69] neg_lo:[0,1] neg_hi:[0,1]
v_pk_add_f32 v[62:63], v[62:63], v[68:69]
v_pk_add_f32 v[68:69], v[60:61], v[74:75] neg_lo:[0,1] neg_hi:[0,1]
v_pk_add_f32 v[60:61], v[60:61], v[74:75]
v_pk_add_f32 v[74:75], v[70:71], v[48:49] neg_lo:[0,1] neg_hi:[0,1]
v_pk_add_f32 v[70:71], v[70:71], v[48:49]
s_lshl_b32 s12, s38, 2
s_add_u32 s12, s12, s16
s_min_u32 s12, s12, 512
s_mul_i32 s12, s12, 16384
s_add_u32 s12, s12, 109051904
buffer_store_dwordx2 v[16:17], v5, s[84:87], s12 offen offset:0 sc1
buffer_store_dwordx2 v[14:15], v5, s[84:87], s12 offen offset:512 sc1
buffer_store_dwordx2 v[64:65], v5, s[84:87], s12 offen offset:1024 sc1
buffer_store_dwordx2 v[40:41], v5, s[84:87], s12 offen offset:1536 sc1
buffer_store_dwordx2 v[72:73], v5, s[84:87], s12 offen offset:2048 sc1
buffer_store_dwordx2 v[44:45], v5, s[84:87], s12 offen offset:2560 sc1
buffer_store_dwordx2 v[28:29], v5, s[84:87], s12 offen offset:3072 sc1
buffer_store_dwordx2 v[60:61], v5, s[84:87], s12 offen offset:3584 sc1
s_add_u32 s12, s12, 4096
buffer_store_dwordx2 v[76:77], v5, s[84:87], s12 offen offset:0 sc1
buffer_store_dwordx2 v[46:47], v5, s[84:87], s12 offen offset:512 sc1
buffer_store_dwordx2 v[30:31], v5, s[84:87], s12 offen offset:1024 sc1
buffer_store_dwordx2 v[62:63], v5, s[84:87], s12 offen offset:1536 sc1
buffer_store_dwordx2 v[22:23], v5, s[84:87], s12 offen offset:2048 sc1
buffer_store_dwordx2 v[54:55], v5, s[84:87], s12 offen offset:2560 sc1
buffer_store_dwordx2 v[38:39], v5, s[84:87], s12 offen offset:3072 sc1
buffer_store_dwordx2 v[70:71], v5, s[84:87], s12 offen offset:3584 sc1
s_add_u32 s12, s12, 4096
buffer_store_dwordx2 v[78:79], v5, s[84:87], s12 offen offset:0 sc1
buffer_store_dwordx2 v[32:33], v5, s[84:87], s12 offen offset:512 sc1
buffer_store_dwordx2 v[24:25], v5, s[84:87], s12 offen offset:1024 sc1
buffer_store_dwordx2 v[56:57], v5, s[84:87], s12 offen offset:1536 sc1
buffer_store_dwordx2 v[20:21], v5, s[84:87], s12 offen offset:2048 sc1
buffer_store_dwordx2 v[52:53], v5, s[84:87], s12 offen offset:2560 sc1
buffer_store_dwordx2 v[36:37], v5, s[84:87], s12 offen offset:3072 sc1
buffer_store_dwordx2 v[68:69], v5, s[84:87], s12 offen offset:3584 sc1
s_add_u32 s12, s12, 4096
buffer_store_dwordx2 v[18:19], v5, s[84:87], s12 offen offset:0 sc1
buffer_store_dwordx2 v[50:51], v5, s[84:87], s12 offen offset:512 sc1
buffer_store_dwordx2 v[34:35], v5, s[84:87], s12 offen offset:1024 sc1
buffer_store_dwordx2 v[66:67], v5, s[84:87], s12 offen offset:1536 sc1
buffer_store_dwordx2 v[26:27], v5, s[84:87], s12 offen offset:2048 sc1
buffer_store_dwordx2 v[58:59], v5, s[84:87], s12 offen offset:2560 sc1
buffer_store_dwordx2 v[42:43], v5, s[84:87], s12 offen offset:3072 sc1
buffer_store_dwordx2 v[74:75], v5, s[84:87], s12 offen offset:3584 sc1
s_add_u32 s12, s12, 4096
s_mov_b32 s38, s21
s_cmp_lt_u32 s38, s37
s_cbranch_scc1 mega_kernel_f2_l
mega_kernel_f2_e:
mega_kernel_f2e:
s_waitcnt vmcnt(0)
s_barrier
v_mov_b32 v1, 0
v_mov_b32 v2, 1
s_mov_b32 s82, 69259392
v_cmp_eq_u32 vcc, 0, v0
s_and_saveexec_b64 s[80:81], vcc
s_cbranch_execz mega_kernel_sg1
buffer_atomic_add v2, v1, s[84:87], s82 offen sc1
mega_kernel_sg1:
s_mov_b64 exec, s[80:81]
s_mov_b32 s64, 0
s_mov_b32 s65, 58
s_lshl_b32 s66, s40, 13
s_add_u32 s66, s66, 67633152
s_mov_b32 s67, 0
s_mov_b32 s68, 0
s_cmp_eq_u32 s91, 3
s_cbranch_scc1 mega_kernel_out
s_cmp_lt_u32 s92, 1
s_cbranch_scc1 mega_kernel_back
s_mov_b32 s68, 1
s_branch mega_kernel_out
mega_kernel_back:
s_lshl_b32 s68, s68, 1
s_mov_b32 s93, s92
s_load_dwordx2 s[4:5], s[0:1], 80
s_mov_b32 s48, 0x3f7ec46d
s_mov_b32 s49, 0x3dc8bd36
s_mov_b32 s50, 0x3f7b14be
s_mov_b32 s51, 0x3e47c5c2
s_mov_b32 s52, 0x3f74fa0b
s_mov_b32 s53, 0x3e94a031
s_mov_b32 s54, 0x3f6c835e
s_mov_b32 s55, 0x3ec3ef15
s_mov_b32 s56, 0x3f61c598
s_mov_b32 s57, 0x3ef15aea
s_mov_b32 s58, 0x3f54db31
s_mov_b32 s59, 0x3f0e39da
s_mov_b32 s60, 0x3f45e403
s_mov_b32 s61, 0x3f226799
s_mov_b32 s62, 0x3f3504f3
s_mov_b32 s63, 0x3f3504f3
v_and_b32 v1, 31, v0
v_lshrrev_b32 v2, 5, v0
v_cvt_f32_u32 v3, v1
v_mul_u32_u24 v10, 8448, v2
v_lshl_add_u32 v4, v1, 3, v10
v_mul_u32_u24 v5, 264, v1
v_add_u32 v5, v5, v10
v_and_b32 v11, 7, v0
v_lshrrev_b32 v9, 3, v0
v_mul_u32_u24 v10, 8448, v11
v_lshl_add_u32 v6, v9, 3, v10
v_lshlrev_b32 v7, 3, v9
v_sub_u32 v7, v10, v7
v_add_u32 v7, 4096, v7
v_mul_u32_u24 v8, 16384, v9
v_lshl_add_u32 v8, v11, 4, v8
v_mul_f32 v12, 0x3a800000, v3
v_cos_f32 v82, v12
v_sin_f32 v83, v12
v_mul_f32 v12, 0x3b000000, v3
v_cos_f32 v84, v12
v_sin_f32 v85, v12
v_mul_f32 v12, 0x3b400000, v3
v_cos_f32 v86, v12
v_sin_f32 v87, v12
v_mul_f32 v12, 0x3b800000, v3
v_cos_f32 v88, v12
v_sin_f32 v89, v12
v_mul_f32 v12, 0x3ba00000, v3
v_cos_f32 v90, v12
v_sin_f32 v91, v12
v_mul_f32 v12, 0x3bc00000, v3
v_cos_f32 v92, v12
v_sin_f32 v93, v12
v_mul_f32 v12, 0x3be00000, v3
v_cos_f32 v94, v12
v_sin_f32 v95, v12
v_mul_f32 v12, 0x3c000000, v3
v_cos_f32 v96, v12
v_sin_f32 v97, v12
v_mul_f32 v12, 0x3c100000, v3
v_cos_f32 v98, v12
v_sin_f32 v99, v12
v_mul_f32 v12, 0x3c200000, v3
v_cos_f32 v100, v12
v_sin_f32 v101, v12
v_mul_f32 v12, 0x3c300000, v3
v_cos_f32 v102, v12
v_sin_f32 v103, v12
v_mul_f32 v12, 0x3c400000, v3
v_cos_f32 v104, v12
v_sin_f32 v105, v12
v_mul_f32 v12, 0x3c500000, v3
v_cos_f32 v106, v12
v_sin_f32 v107, v12
v_mul_f32 v12, 0x3c600000, v3
v_cos_f32 v108, v12
v_sin_f32 v109, v12
v_mul_f32 v12, 0x3c700000, v3
v_cos_f32 v110, v12
v_sin_f32 v111, v12
v_mul_f32 v12, 0x3c800000, v3
v_cos_f32 v112, v12
v_sin_f32 v113, v12
v_mul_f32 v12, 0x3c880000, v3
v_cos_f32 v114, v12
v_sin_f32 v115, v12
v_mul_f32 v12, 0x3c900000, v3
v_cos_f32 v116, v12
v_sin_f32 v117, v12
v_mul_f32 v12, 0x3c980000, v3
v_cos_f32 v118, v12
v_sin_f32 v119, v12
v_mul_f32 v12, 0x3ca00000, v3
v_cos_f32 v120, v12
v_sin_f32 v121, v12
v_mul_f32 v12, 0x3ca80000, v3
v_cos_f32 v122, v12
v_sin_f32 v123, v12
v_mul_f32 v12, 0x3cb00000, v3
v_cos_f32 v124, v12
v_sin_f32 v125, v12
v_mul_f32 v12, 0x3cb80000, v3
v_cos_f32 v126, v12
v_sin_f32 v127, v12
v_mul_f32 v12, 0x3cc00000, v3
v_cos_f32 v128, v12
v_sin_f32 v129, v12
v_mul_f32 v12, 0x3cc80000, v3
v_cos_f32 v130, v12
v_sin_f32 v131, v12
v_mul_f32 v12, 0x3cd00000, v3
v_cos_f32 v132, v12
v_sin_f32 v133, v12
v_mul_f32 v12, 0x3cd80000, v3
v_cos_f32 v134, v12
v_sin_f32 v135, v12
v_mul_f32 v12, 0x3ce00000, v3
v_cos_f32 v136, v12
v_sin_f32 v137, v12
v_mul_f32 v12, 0x3ce80000, v3
v_cos_f32 v138, v12
v_sin_f32 v139, v12
v_mul_f32 v12, 0x3cf00000, v3
v_cos_f32 v140, v12
v_sin_f32 v141, v12
v_mul_f32 v12, 0x3cf80000, v3
v_cos_f32 v142, v12
v_sin_f32 v143, v12
v_lshlrev_b32 v12, 2, v1
v_sub_u32 v12, v4, v12
v_and_b32 v10, 127, v0
v_lshrrev_b32 v11, 7, v0
v_lshlrev_b32 v2, 5, v10
v_lshl_add_u32 v2, v11, 12, v2
v_lshlrev_b32 v3, 4, v10
v_lshl_add_u32 v3, v11, 12, v3
v_add_u32 v3, 2048, v3
v_cmp_eq_u32 s[14:15], 0, v9
s_waitcnt lgkmcnt(0)
s_mov_b32 s6, 8388608
s_mov_b32 s7, 0x00020000
v_mov_b32 v250, 0
s_mov_b32 s82, 69259392
mega_kernel_w1:
s_sleep 8
buffer_load_dword v251, v250, s[84:87], s82 offen sc1
s_waitcnt vmcnt(0)
v_cmp_ne_u32 vcc, 95, v251
s_cbranch_vccnz mega_kernel_w1
s_cmp_lt_u32 s93, 128
s_cbranch_scc0 mega_kernel_f3_e
s_lshl_b32 s12, s93, 7
s_add_u32 s12, s12, 109051904
buffer_load_dwordx4 v[144:147], v8, s[84:87], s12 offen sc1
s_add_u32 s12, s12, 524288
buffer_load_dwordx4 v[148:151], v8, s[84:87], s12 offen sc1
s_add_u32 s12, s12, 524288
buffer_load_dwordx4 v[152:155], v8, s[84:87], s12 offen sc1
s_add_u32 s12, s12, 524288
buffer_load_dwordx4 v[156:159], v8, s[84:87], s12 offen sc1
s_add_u32 s12, s12, 524288
buffer_load_dwordx4 v[160:163], v8, s[84:87], s12 offen sc1
s_add_u32 s12, s12, 524288
buffer_load_dwordx4 v[164:167], v8, s[84:87], s12 offen sc1
s_add_u32 s12, s12, 524288
buffer_load_dwordx4 v[168:171], v8, s[84:87], s12 offen sc1
s_add_u32 s12, s12, 524288
buffer_load_dwordx4 v[172:175], v8, s[84:87], s12 offen sc1
s_add_u32 s12, s12, 524288
buffer_load_dwordx4 v[176:179], v8, s[84:87], s12 offen sc1
s_add_u32 s12, s12, 524288
buffer_load_dwordx4 v[180:183], v8, s[84:87], s12 offen sc1
s_add_u32 s12, s12, 524288
buffer_load_dwordx4 v[184:187], v8, s[84:87], s12 offen sc1
s_add_u32 s12, s12, 524288
buffer_load_dwordx4 v[188:191], v8, s[84:87], s12 offen sc1
s_add_u32 s12, s12, 524288
buffer_load_dwordx4 v[192:195], v8, s[84:87], s12 offen sc1
s_add_u32 s12, s12, 524288
buffer_load_dwordx4 v[196:199], v8, s[84:87], s12 offen sc1
s_add_u32 s12, s12, 524288
buffer_load_dwordx4 v[200:203], v8, s[84:87], s12 offen sc1
s_add_u32 s12, s12, 524288
buffer_load_dwordx4 v[204:207], v8, s[84:87], s12 offen sc1
s_add_u32 s12, s12, 524288
buffer_load_dwordx4 v[208:211], v8, s[84:87], s12 offen sc1
s_add_u32 s12, s12, 524288
s_waitcnt vmcnt(0)
mega_kernel_f3_l:
s_add_u32 s21, s93, 64
s_cmp_lt_u32 s21, 128
s_cselect_b32 s22, s21, s93
s_waitcnt vmcnt(8)
s_barrier
v_cndmask_b32 v145, v145, 0, s[14:15]
v_cndmask_b32 v147, v147, 0, s[14:15]
v_cndmask_b32 v209, v209, 0, s[14:15]
v_cndmask_b32 v211, v211, 0, s[14:15]
v_pk_add_f32 v[16:17], v[144:145], v[146:147] op_sel:[0,1] op_sel_hi:[1,0] neg_lo:[0,1]
v_pk_add_f32 v[18:19], v[144:145], v[146:147] op_sel:[0,1] op_sel_hi:[1,0] neg_hi:[1,0]
ds_write_b64 v6, v[16:17] offset:0
ds_write_b64 v7, v[18:19] offset:4096
v_pk_add_f32 v[20:21], v[148:149], v[150:151] op_sel:[0,1] op_sel_hi:[1,0] neg_lo:[0,1]
v_pk_add_f32 v[22:23], v[148:149], v[150:151] op_sel:[0,1] op_sel_hi:[1,0] neg_hi:[1,0]
ds_write_b64 v6, v[20:21] offset:256
ds_write_b64 v7, v[22:23] offset:3840
v_pk_add_f32 v[24:25], v[152:153], v[154:155] op_sel:[0,1] op_sel_hi:[1,0] neg_lo:[0,1]
v_pk_add_f32 v[26:27], v[152:153], v[154:155] op_sel:[0,1] op_sel_hi:[1,0] neg_hi:[1,0]
ds_write_b64 v6, v[24:25] offset:512
ds_write_b64 v7, v[26:27] offset:3584
v_pk_add_f32 v[28:29], v[156:157], v[158:159] op_sel:[0,1] op_sel_hi:[1,0] neg_lo:[0,1]
v_pk_add_f32 v[30:31], v[156:157], v[158:159] op_sel:[0,1] op_sel_hi:[1,0] neg_hi:[1,0]
ds_write_b64 v6, v[28:29] offset:768
ds_write_b64 v7, v[30:31] offset:3328
v_pk_add_f32 v[32:33], v[160:161], v[162:163] op_sel:[0,1] op_sel_hi:[1,0] neg_lo:[0,1]
v_pk_add_f32 v[34:35], v[160:161], v[162:163] op_sel:[0,1] op_sel_hi:[1,0] neg_hi:[1,0]
ds_write_b64 v6, v[32:33] offset:1024
ds_write_b64 v7, v[34:35] offset:3072
v_pk_add_f32 v[36:37], v[164:165], v[166:167] op_sel:[0,1] op_sel_hi:[1,0] neg_lo:[0,1]
v_pk_add_f32 v[38:39], v[164:165], v[166:167] op_sel:[0,1] op_sel_hi:[1,0] neg_hi:[1,0]
ds_write_b64 v6, v[36:37] offset:1280
ds_write_b64 v7, v[38:39] offset:2816
v_pk_add_f32 v[40:41], v[168:169], v[170:171] op_sel:[0,1] op_sel_hi:[1,0] neg_lo:[0,1]
v_pk_add_f32 v[42:43], v[168:169], v[170:171] op_sel:[0,1] op_sel_hi:[1,0] neg_hi:[1,0]
ds_write_b64 v6, v[40:41] offset:1536
ds_write_b64 v7, v[42:43] offset:2560
v_pk_add_f32 v[44:45], v[172:173], v[174:175] op_sel:[0,1] op_sel_hi:[1,0] neg_lo:[0,1]
v_pk_add_f32 v[46:47], v[172:173], v[174:175] op_sel:[0,1] op_sel_hi:[1,0] neg_hi:[1,0]
ds_write_b64 v6, v[44:45] offset:1792
ds_write_b64 v7, v[46:47] offset:2304
v_pk_add_f32 v[48:49], v[176:177], v[178:179] op_sel:[0,1] op_sel_hi:[1,0] neg_lo:[0,1]
v_pk_add_f32 v[50:51], v[176:177], v[178:179] op_sel:[0,1] op_sel_hi:[1,0] neg_hi:[1,0]
ds_write_b64 v6, v[48:49] offset:2048
ds_write_b64 v7, v[50:51] offset:2048
v_pk_add_f32 v[52:53], v[180:181], v[182:183] op_sel:[0,1] op_sel_hi:[1,0] neg_lo:[0,1]
v_pk_add_f32 v[54:55], v[180:181], v[182:183] op_sel:[0,1] op_sel_hi:[1,0] neg_hi:[1,0]
ds_write_b64 v6, v[52:53] offset:2304
ds_write_b64 v7, v[54:55] offset:1792
v_pk_add_f32 v[56:57], v[184:185], v[186:187] op_sel:[0,1] op_sel_hi:[1,0] neg_lo:[0,1]
v_pk_add_f32 v[58:59], v[184:185], v[186:187] op_sel:[0,1] op_sel_hi:[1,0] neg_hi:[1,0]
ds_write_b64 v6, v[56:57] offset:2560
ds_write_b64 v7, v[58:59] offset:1536
v_pk_add_f32 v[60:61], v[188:189], v[190:191] op_sel:[0,1] op_sel_hi:[1,0] neg_lo:[0,1]
v_pk_add_f32 v[62:63], v[188:189], v[190:191] op_sel:[0,1] op_sel_hi:[1,0] neg_hi:[1,0]
ds_write_b64 v6, v[60:61] offset:2816
ds_write_b64 v7, v[62:63] offset:1280
v_pk_add_f32 v[64:65], v[192:193], v[194:195] op_sel:[0,1] op_sel_hi:[1,0] neg_lo:[0,1]
v_pk_add_f32 v[66:67], v[192:193], v[194:195] op_sel:[0,1] op_sel_hi:[1,0] neg_hi:[1,0]
ds_write_b64 v6, v[64:65] offset:3072
ds_write_b64 v7, v[66:67] offset:1024
v_pk_add_f32 v[68:69], v[196:197], v[198:199] op_sel:[0,1] op_sel_hi:[1,0] neg_lo:[0,1]
v_pk_add_f32 v[70:71], v[196:197], v[198:199] op_sel:[0,1] op_sel_hi:[1,0] neg_hi:[1,0]
ds_write_b64 v6, v[68:69] offset:3328
ds_write_b64 v7, v[70:71] offset:768
v_pk_add_f32 v[72:73], v[200:201], v[202:203] op_sel:[0,1] op_sel_hi:[1,0] neg_lo:[0,1]
v_pk_add_f32 v[74:75], v[200:201], v[202:203] op_sel:[0,1] op_sel_hi:[1,0] neg_hi:[1,0]
ds_write_b64 v6, v[72:73] offset:3584
ds_write_b64 v7, v[74:75] offset:512
s_waitcnt lgkmcnt(8)
v_pk_add_f32 v[76:77], v[204:205], v[206:207] op_sel:[0,1] op_sel_hi:[1,0] neg_lo:[0,1]
v_pk_add_f32 v[78:79], v[204:205], v[206:207] op_sel:[0,1] op_sel_hi:[1,0] neg_hi:[1,0]
ds_write_b64 v6, v[76:77] offset:3840
ds_write_b64 v7, v[78:79] offset:256
v_pk_add_f32 v[16:17], v[208:209], v[210:211] op_sel:[0,1] op_sel_hi:[1,0] neg_lo:[0,1]
v_pk_add_f32 v[18:19], v[208:209], v[210:211] op_sel:[0,1] op_sel_hi:[1,0] neg_hi:[1,0]
s_mov_b64 exec, s[14:15]
ds_write_b64 v6, v[16:17] offset:4096
s_mov_b64 exec, -1
s_lshl_b32 s12, s22, 7
s_add_u32 s12, s12, 109051904
buffer_load_dwordx4 v[144:147], v8, s[84:87], s12 offen sc1
s_add_u32 s12, s12, 524288
buffer_load_dwordx4 v[148:151], v8, s[84:87], s12 offen sc1
s_add_u32 s12, s12, 524288
buffer_load_dwordx4 v[152:155], v8, s[84:87], s12 offen sc1
s_add_u32 s12, s12, 524288
buffer_load_dwordx4 v[156:159], v8, s[84:87], s12 offen sc1
s_add_u32 s12, s12, 524288
buffer_load_dwordx4 v[160:163], v8, s[84:87], s12 offen sc1
s_add_u32 s12, s12, 524288
buffer_load_dwordx4 v[164:167], v8, s[84:87], s12 offen sc1
s_add_u32 s12, s12, 524288
buffer_load_dwordx4 v[168:171], v8, s[84:87], s12 offen sc1
s_add_u32 s12, s12, 524288
buffer_load_dwordx4 v[172:175], v8, s[84:87], s12 offen sc1
s_add_u32 s12, s12, 524288
buffer_load_dwordx4 v[176:179], v8, s[84:87], s12 offen sc1
s_add_u32 s12, s12, 524288
buffer_load_dwordx4 v[180:183], v8, s[84:87], s12 offen sc1
s_add_u32 s12, s12, 524288
buffer_load_dwordx4 v[184:187], v8, s[84:87], s12 offen sc1
s_add_u32 s12, s12, 524288
buffer_load_dwordx4 v[188:191], v8, s[84:87], s12 offen sc1
s_add_u32 s12, s12, 524288
buffer_load_dwordx4 v[192:195], v8, s[84:87], s12 offen sc1
s_add_u32 s12, s12, 524288
buffer_load_dwordx4 v[196:199], v8, s[84:87], s12 offen sc1
s_add_u32 s12, s12, 524288
buffer_load_dwordx4 v[200:203], v8, s[84:87], s12 offen sc1
s_add_u32 s12, s12, 524288
buffer_load_dwordx4 v[204:207], v8, s[84:87], s12 offen sc1
s_add_u32 s12, s12, 524288
buffer_load_dwordx4 v[208:211], v8, s[84:87], s12 offen sc1
s_add_u32 s12, s12, 524288
s_waitcnt lgkmcnt(0)
s_barrier
ds_read_b64 v[16:17], v4 offset:0
ds_read_b64 v[48:49], v4 offset:4096
ds_read_b64 v[18:19], v4 offset:256
ds_read_b64 v[50:51], v4 offset:4352
ds_read_b64 v[20:21], v4 offset:512
ds_read_b64 v[52:53], v4 offset:4608
ds_read_b64 v[22:23], v4 offset:768
ds_read_b64 v[54:55], v4 offset:4864
ds_read_b64 v[24:25], v4 offset:1024
ds_read_b64 v[56:57], v4 offset:5120
ds_read_b64 v[26:27], v4 offset:1280
ds_read_b64 v[58:59], v4 offset:5376
ds_read_b64 v[28:29], v4 offset:1536
ds_read_b64 v[60:61], v4 offset:5632
ds_read_b64 v[30:31], v4 offset:1792
ds_read_b64 v[62:63], v4 offset:5888
ds_read_b64 v[32:33], v4 offset:2048
ds_read_b64 v[64:65], v4 offset:6144
ds_read_b64 v[34:35], v4 offset:2304
ds_read_b64 v[66:67], v4 offset:6400
ds_read_b64 v[36:37], v4 offset:2560
ds_read_b64 v[68:69], v4 offset:6656
ds_read_b64 v[38:39], v4 offset:2816
ds_read_b64 v[70:71], v4 offset:6912
ds_read_b64 v[40:41], v4 offset:3072
ds_read_b64 v[72:73], v4 offset:7168
ds_read_b64 v[42:43], v4 offset:3328
ds_read_b64 v[74:75], v4 offset:7424
ds_read_b64 v[44:45], v4 offset:3584
ds_read_b64 v[76:77], v4 offset:7680
ds_read_b64 v[46:47], v4 offset:3840
ds_read_b64 v[78:79], v4 offset:7936
s_waitcnt lgkmcnt(0)
v_pk_add_f32 v[14:15], v[16:17], v[48:49] neg_lo:[0,1] neg_hi:[0,1]
v_pk_add_f32 v[16:17], v[16:17], v[48:49]
v_pk_add_f32 v[48:49], v[18:19], v[50:51] neg_lo:[0,1] neg_hi:[0,1]
v_pk_add_f32 v[18:19], v[18:19], v[50:51]
v_pk_mul_f32 v[50:51], v[48:49], s[50:51] op_sel:[0,0] op_sel_hi:[0,1] neg_lo:[0,0] neg_hi:[0,0]
v_pk_fma_f32 v[50:51], v[48:49], s[50:51], v[50:51] op_sel:[1,1,0] op_sel_hi:[1,0,1] neg_lo:[0,1,0] neg_hi:[0,0,0]
v_pk_add_f32 v[48:49], v[20:21], v[52:53] neg_lo:[0,1] neg_hi:[0,1]
v_pk_add_f32 v[20:21], v[20:21], v[52:53]
v_pk_mul_f32 v[52:53], v[48:49], s[54:55] op_sel:[0,0] op_sel_hi:[0,1] neg_lo:[0,0] neg_hi:[0,0]
v_pk_fma_f32 v[52:53], v[48:49], s[54:55], v[52:53] op_sel:[1,1,0] op_sel_hi:[1,0,1] neg_lo:[0,1,0] neg_hi:[0,0,0]
v_pk_add_f32 v[48:49], v[22:23], v[54:55] neg_lo:[0,1] neg_hi:[0,1]
v_pk_add_f32 v[22:23], v[22:23], v[54:55]
v_pk_mul_f32 v[54:55], v[48:49], s[58:59] op_sel:[0,0] op_sel_hi:[0,1] neg_lo:[0,0] neg_hi:[0,0]
v_pk_fma_f32 v[54:55], v[48:49], s[58:59], v[54:55] op_sel:[1,1,0] op_sel_hi:[1,0,1] neg_lo:[0,1,0] neg_hi:[0,0,0]
v_pk_add_f32 v[48:49], v[24:25], v[56:57] neg_lo:[0,1] neg_hi:[0,1]
v_pk_add_f32 v[24:25], v[24:25], v[56:57]
v_pk_mul_f32 v[56:57], v[48:49], s[62:63] op_sel:[0,0] op_sel_hi:[0,1] neg_lo:[0,0] neg_hi:[0,0]
v_pk_fma_f32 v[56:57], v[48:49], s[62:63], v[56:57] op_sel:[1,1,0] op_sel_hi:[1,0,1] neg_lo:[0,1,0] neg_hi:[0,0,0]
v_pk_add_f32 v[48:49], v[26:27], v[58:59] neg_lo:[0,1] neg_hi:[0,1]
v_pk_add_f32 v[26:27], v[26:27], v[58:59]
v_pk_mul_f32 v[58:59], v[48:49], s[58:59] op_sel:[0,1] op_sel_hi:[0,0] neg_lo:[0,0] neg_hi:[0,0]
v_pk_fma_f32 v[58:59], v[48:49], s[58:59], v[58:59] op_sel:[1,0,0] op_sel_hi:[1,1,1] neg_lo:[0,1,0] neg_hi:[0,0,0]
v_pk_add_f32 v[48:49], v[28:29], v[60:61] neg_lo:[0,1] neg_hi:[0,1]
v_pk_add_f32 v[28:29], v[28:29], v[60:61]
v_pk_mul_f32 v[60:61], v[48:49], s[54:55] op_sel:[0,1] op_sel_hi:[0,0] neg_lo:[0,0] neg_hi:[0,0]
v_pk_fma_f32 v[60:61], v[48:49], s[54:55], v[60:61] op_sel:[1,0,0] op_sel_hi:[1,1,1] neg_lo:[0,1,0] neg_hi:[0,0,0]
v_pk_add_f32 v[48:49], v[30:31], v[62:63] neg_lo:[0,1] neg_hi:[0,1]
v_pk_add_f32 v[30:31], v[30:31], v[62:63]
v_pk_mul_f32 v[62:63], v[48:49], s[50:51] op_sel:[0,1] op_sel_hi:[0,0] neg_lo:[0,0] neg_hi:[0,0]
v_pk_fma_f32 v[62:63], v[48:49], s[50:51], v[62:63] op_sel:[1,0,0] op_sel_hi:[1,1,1] neg_lo:[0,1,0] neg_hi:[0,0,0]
v_pk_add_f32 v[48:49], v[32:33], v[64:65] op_sel:[1,1] op_sel_hi:[0,0] neg_lo:[1,0] neg_hi:[0,1]
v_pk_add_f32 v[32:33], v[32:33], v[64:65]
v_pk_add_f32 v[64:65], v[34:35], v[66:67] neg_lo:[0,1] neg_hi:[0,1]
v_pk_add_f32 v[34:35], v[34:35], v[66:67]
v_pk_mul_f32 v[66:67], v[64:65], s[50:51] op_sel:[0,1] op_sel_hi:[0,0] neg_lo:[0,1] neg_hi:[0,0]
v_pk_fma_f32 v[66:67], v[64:65], s[50:51], v[66:67] op_sel:[1,0,0] op_sel_hi:[1,1,1] neg_lo:[0,1,0] neg_hi:[0,1,0]
v_pk_add_f32 v[64:65], v[36:37], v[68:69] neg_lo:[0,1] neg_hi:[0,1]
v_pk_add_f32 v[36:37], v[36:37], v[68:69]
v_pk_mul_f32 v[68:69], v[64:65], s[54:55] op_sel:[0,1] op_sel_hi:[0,0] neg_lo:[0,1] neg_hi:[0,0]
v_pk_fma_f32 v[68:69], v[64:65], s[54:55], v[68:69] op_sel:[1,0,0] op_sel_hi:[1,1,1] neg_lo:[0,1,0] neg_hi:[0,1,0]
v_pk_add_f32 v[64:65], v[38:39], v[70:71] neg_lo:[0,1] neg_hi:[0,1]
v_pk_add_f32 v[38:39], v[38:39], v[70:71]
v_pk_mul_f32 v[70:71], v[64:65], s[58:59] op_sel:[0,1] op_sel_hi:[0,0] neg_lo:[0,1] neg_hi:[0,0]
v_pk_fma_f32 v[70:71], v[64:65], s[58:59], v[70:71] op_sel:[1,0,0] op_sel_hi:[1,1,1] neg_lo:[0,1,0] neg_hi:[0,1,0]
v_pk_add_f32 v[64:65], v[40:41], v[72:73] neg_lo:[0,1] neg_hi:[0,1]
v_pk_add_f32 v[40:41], v[40:41], v[72:73]
v_pk_mul_f32 v[72:73], v[64:65], s[62:63] op_sel:[0,0] op_sel_hi:[0,1] neg_lo:[0,1] neg_hi:[0,0]
v_pk_fma_f32 v[72:73], v[64:65], s[62:63], v[72:73] op_sel:[1,1,0] op_sel_hi:[1,0,1] neg_lo:[0,1,0] neg_hi:[0,1,0]
v_pk_add_f32 v[64:65], v[42:43], v[74:75] neg_lo:[0,1] neg_hi:[0,1]
v_pk_add_f32 v[42:43], v[42:43], v[74:75]
v_pk_mul_f32 v[74:75], v[64:65], s[58:59] op_sel:[0,0] op_sel_hi:[0,1] neg_lo:[0,1] neg_hi:[0,0]
v_pk_fma_f32 v[74:75], v[64:65], s[58:59], v[74:75] op_sel:[1,1,0] op_sel_hi:[1,0,1] neg_lo:[0,1,0] neg_hi:[0,1,0]
v_pk_add_f32 v[64:65], v[44:45], v[76:77] neg_lo:[0,1] neg_hi:[0,1]
v_pk_add_f32 v[44:45], v[44:45], v[76:77]
v_pk_mul_f32 v[76:77], v[64:65], s[54:55] op_sel:[0,0] op_sel_hi:[0,1] neg_lo:[0,1] neg_hi:[0,0]
v_pk_fma_f32 v[76:77], v[64:65], s[54:55], v[76:77] op_sel:[1,1,0] op_sel_hi:[1,0,1] neg_lo:[0,1,0] neg_hi:[0,1,0]
v_pk_add_f32 v[64:65], v[46:47], v[78:79] neg_lo:[0,1] neg_hi:[0,1]
v_pk_add_f32 v[46:47], v[46:47], v[78:79]
v_pk_mul_f32 v[78:79], v[64:65], s[50:51] op_sel:[0,0] op_sel_hi:[0,1] neg_lo:[0,1] neg_hi:[0,0]
v_pk_fma_f32 v[78:79], v[64:65], s[50:51], v[78:79] op_sel:[1,1,0] op_sel_hi:[1,0,1] neg_lo:[0,1,0] neg_hi:[0,1,0]
v_pk_add_f32 v[64:65], v[16:17], v[32:33] neg_lo:[0,1] neg_hi:[0,1]
v_pk_add_f32 v[16:17], v[16:17], v[32:33]
v_pk_add_f32 v[32:33], v[18:19], v[34:35] neg_lo:[0,1] neg_hi:[0,1]
v_pk_add_f32 v[18:19], v[18:19], v[34:35]
v_pk_mul_f32 v[34:35], v[32:33], s[54:55] op_sel:[0,0] op_sel_hi:[0,1] neg_lo:[0,0] neg_hi:[0,0]
v_pk_fma_f32 v[34:35], v[32:33], s[54:55], v[34:35] op_sel:[1,1,0] op_sel_hi:[1,0,1] neg_lo:[0,1,0] neg_hi:[0,0,0]
v_pk_add_f32 v[32:33], v[20:21], v[36:37] neg_lo:[0,1] neg_hi:[0,1]
v_pk_add_f32 v[20:21], v[20:21], v[36:37]
v_pk_mul_f32 v[36:37], v[32:33], s[62:63] op_sel:[0,0] op_sel_hi:[0,1] neg_lo:[0,0] neg_hi:[0,0]
v_pk_fma_f32 v[36:37], v[32:33], s[62:63], v[36:37] op_sel:[1,1,0] op_sel_hi:[1,0,1] neg_lo:[0,1,0] neg_hi:[0,0,0]
v_pk_add_f32 v[32:33], v[22:23], v[38:39] neg_lo:[0,1] neg_hi:[0,1]
v_pk_add_f32 v[22:23], v[22:23], v[38:39]
v_pk_mul_f32 v[38:39], v[32:33], s[54:55] op_sel:[0,1] op_sel_hi:[0,0] neg_lo:[0,0] neg_hi:[0,0]
v_pk_fma_f32 v[38:39], v[32:33], s[54:55], v[38:39] op_sel:[1,0,0] op_sel_hi:[1,1,1] neg_lo:[0,1,0] neg_hi:[0,0,0]
v_pk_add_f32 v[32:33], v[24:25], v[40:41] op_sel:[1,1] op_sel_hi:[0,0] neg_lo:[1,0] neg_hi:[0,1]
v_pk_add_f32 v[24:25], v[24:25], v[40:41]
v_pk_add_f32 v[40:41], v[26:27], v[42:43] neg_lo:[0,1] neg_hi:[0,1]
v_pk_add_f32 v[26:27], v[26:27], v[42:43]
v_pk_mul_f32 v[42:43], v[40:41], s[54:55] op_sel:[0,1] op_sel_hi:[0,0] neg_lo:[0,1] neg_hi:[0,0]
v_pk_fma_f32 v[42:43], v[40:41], s[54:55], v[42:43] op_sel:[1,0,0] op_sel_hi:[1,1,1] neg_lo:[0,1,0] neg_hi:[0,1,0]
v_pk_add_f32 v[40:41], v[28:29], v[44:45] neg_lo:[0,1] neg_hi:[0,1]
v_pk_add_f32 v[28:29], v[28:29], v[44:45]
v_pk_mul_f32 v[44:45], v[40:41], s[62:63] op_sel:[0,0] op_sel_hi:[0,1] neg_lo:[0,1] neg_hi:[0,0]
v_pk_fma_f32 v[44:45], v[40:41], s[62:63], v[44:45] op_sel:[1,1,0] op_sel_hi:[1,0,1] neg_lo:[0,1,0] neg_hi:[0,1,0]
v_pk_add_f32 v[40:41], v[30:31], v[46:47] neg_lo:[0,1] neg_hi:[0,1]
v_pk_add_f32 v[30:31], v[30:31], v[46:47]
v_pk_mul_f32 v[46:47], v[40:41], s[54:55] op_sel:[0,0] op_sel_hi:[0,1] neg_lo:[0,1] neg_hi:[0,0]
v_pk_fma_f32 v[46:47], v[40:41], s[54:55], v[46:47] op_sel:[1,1,0] op_sel_hi:[1,0,1] neg_lo:[0,1,0] neg_hi:[0,1,0]
v_pk_add_f32 v[40:41], v[14:15], v[48:49] neg_lo:[0,1] neg_hi:[0,1]
v_pk_add_f32 v[14:15], v[14:15], v[48:49]
v_pk_add_f32 v[48:49], v[50:51], v[66:67] neg_lo:[0,1] neg_hi:[0,1]
v_pk_add_f32 v[50:51], v[50:51], v[66:67]
v_pk_mul_f32 v[66:67], v[48:49], s[54:55] op_sel:[0,0] op_sel_hi:[0,1] neg_lo:[0,0] neg_hi:[0,0]
v_pk_fma_f32 v[66:67], v[48:49], s[54:55], v[66:67] op_sel:[1,1,0] op_sel_hi:[1,0,1] neg_lo:[0,1,0] neg_hi:[0,0,0]
v_pk_add_f32 v[48:49], v[52:53], v[68:69] neg_lo:[0,1] neg_hi:[0,1]
v_pk_add_f32 v[52:53], v[52:53], v[68:69]
v_pk_mul_f32 v[68:69], v[48:49], s[62:63] op_sel:[0,0] op_sel_hi:[0,1] neg_lo:[0,0] neg_hi:[0,0]
v_pk_fma_f32 v[68:69], v[48:49], s[62:63], v[68:69] op_sel:[1,1,0] op_sel_hi:[1,0,1] neg_lo:[0,1,0] neg_hi:[0,0,0]
v_pk_add_f32 v[48:49], v[54:55], v[70:71] neg_lo:[0,1] neg_hi:[0,1]
v_pk_add_f32 v[54:55], v[54:55], v[70:71]
v_pk_mul_f32 v[70:71], v[48:49], s[54:55] op_sel:[0,1] op_sel_hi:[0,0] neg_lo:[0,0] neg_hi:[0,0]
v_pk_fma_f32 v[70:71], v[48:49], s[54:55], v[70:71] op_sel:[1,0,0] op_sel_hi:[1,1,1] neg_lo:[0,1,0] neg_hi:[0,0,0]
v_pk_add_f32 v[48:49], v[56:57], v[72:73] op_sel:[1,1] op_sel_hi:[0,0] neg_lo:[1,0] neg_hi:[0,1]
v_pk_add_f32 v[56:57], v[56:57], v[72:73]
v_pk_add_f32 v[72:73], v[58:59], v[74:75] neg_lo:[0,1] neg_hi:[0,1]
v_pk_add_f32 v[58:59], v[58:59], v[74:75]
v_pk_mul_f32 v[74:75], v[72:73], s[54:55] op_sel:[0,1] op_sel_hi:[0,0] neg_lo:[0,1] neg_hi:[0,0]
v_pk_fma_f32 v[74:75], v[72:73], s[54:55], v[74:75] op_sel:[1,0,0] op_sel_hi:[1,1,1] neg_lo:[0,1,0] neg_hi:[0,1,0]
v_pk_add_f32 v[72:73], v[60:61], v[76:77] neg_lo:[0,1] neg_hi:[0,1]
v_pk_add_f32 v[60:61], v[60:61], v[76:77]
v_pk_mul_f32 v[76:77], v[72:73], s[62:63] op_sel:[0,0] op_sel_hi:[0,1] neg_lo:[0,1] neg_hi:[0,0]
v_pk_fma_f32 v[76:77], v[72:73], s[62:63], v[76:77] op_sel:[1,1,0] op_sel_hi:[1,0,1] neg_lo:[0,1,0] neg_hi:[0,1,0]
v_pk_add_f32 v[72:73], v[62:63], v[78:79] neg_lo:[0,1] neg_hi:[0,1]
v_pk_add_f32 v[62:63], v[62:63], v[78:79]
v_pk_mul_f32 v[78:79], v[72:73], s[54:55] op_sel:[0,0] op_sel_hi:[0,1] neg_lo:[0,1] neg_hi:[0,0]
v_pk_fma_f32 v[78:79], v[72:73], s[54:55], v[78:79] op_sel:[1,1,0] op_sel_hi:[1,0,1] neg_lo:[0,1,0] neg_hi:[0,1,0]
v_pk_add_f32 v[72:73], v[16:17], v[24:25] neg_lo:[0,1] neg_hi:[0,1]
v_pk_add_f32 v[16:17], v[16:17], v[24:25]
v_pk_add_f32 v[24:25], v[18:19], v[26:27] neg_lo:[0,1] neg_hi:[0,1]
v_pk_add_f32 v[18:19], v[18:19], v[26:27]
v_pk_mul_f32 v[26:27], v[24:25], s[62:63] op_sel:[0,0] op_sel_hi:[0,1] neg_lo:[0,0] neg_hi:[0,0]
v_pk_fma_f32 v[26:27], v[24:25], s[62:63], v[26:27] op_sel:[1,1,0] op_sel_hi:[1,0,1] neg_lo:[0,1,0] neg_hi:[0,0,0]
v_pk_add_f32 v[24:25], v[20:21], v[28:29] op_sel:[1,1] op_sel_hi:[0,0] neg_lo:[1,0] neg_hi:[0,1]
v_pk_add_f32 v[20:21], v[20:21], v[28:29]
v_pk_add_f32 v[28:29], v[22:23], v[30:31] neg_lo:[0,1] neg_hi:[0,1]
v_pk_add_f32 v[22:23], v[22:23], v[30:31]
v_pk_mul_f32 v[30:31], v[28:29], s[62:63] op_sel:[0,0] op_sel_hi:[0,1] neg_lo:[0,1] neg_hi:[0,0]
v_pk_fma_f32 v[30:31], v[28:29], s[62:63], v[30:31] op_sel:[1,1,0] op_sel_hi:[1,0,1] neg_lo:[0,1,0] neg_hi:[0,1,0]
v_pk_add_f32 v[28:29], v[64:65], v[32:33] neg_lo:[0,1] neg_hi:[0,1]
v_pk_add_f32 v[64:65], v[64:65], v[32:33]
v_pk_add_f32 v[32:33], v[34:35], v[42:43] neg_lo:[0,1] neg_hi:[0,1]
v_pk_add_f32 v[34:35], v[34:35], v[42:43]
v_pk_mul_f32 v[42:43], v[32:33], s[62:63] op_sel:[0,0] op_sel_hi:[0,1] neg_lo:[0,0] neg_hi:[0,0]
v_pk_fma_f32 v[42:43], v[32:33], s[62:63], v[42:43] op_sel:[1,1,0] op_sel_hi:[1,0,1] neg_lo:[0,1,0] neg_hi:[0,0,0]
v_pk_add_f32 v[32:33], v[36:37], v[44:45] op_sel:[1,1] op_sel_hi:[0,0] neg_lo:[1,0] neg_hi:[0,1]
v_pk_add_f32 v[36:37], v[36:37], v[44:45]
v_pk_add_f32 v[44:45], v[38:39], v[46:47] neg_lo:[0,1] neg_hi:[0,1]
v_pk_add_f32 v[38:39], v[38:39], v[46:47]
v_pk_mul_f32 v[46:47], v[44:45], s[62:63] op_sel:[0,0] op_sel_hi:[0,1] neg_lo:[0,1] neg_hi:[0,0]
v_pk_fma_f32 v[46:47], v[44:45], s[62:63], v[46:47] op_sel:[1,1,0] op_sel_hi:[1,0,1] neg_lo:[0,1,0] neg_hi:[0,1,0]
v_pk_add_f32 v[44:45], v[14:15], v[56:57] neg_lo:[0,1] neg_hi:[0,1]
v_pk_add_f32 v[14:15], v[14:15], v[56:57]
v_pk_add_f32 v[56:57], v[50:51], v[58:59] neg_lo:[0,1] neg_hi:[0,1]
v_pk_add_f32 v[50:51], v[50:51], v[58:59]
v_pk_mul_f32 v[58:59], v[56:57], s[62:63] op_sel:[0,0] op_sel_hi:[0,1] neg_lo:[0,0] neg_hi:[0,0]
v_pk_fma_f32 v[58:59], v[56:57], s[62:63], v[58:59] op_sel:[1,1,0] op_sel_hi:[1,0,1] neg_lo:[0,1,0] neg_hi:[0,0,0]
v_pk_add_f32 v[56:57], v[52:53], v[60:61] op_sel:[1,1] op_sel_hi:[0,0] neg_lo:[1,0] neg_hi:[0,1]
v_pk_add_f32 v[52:53], v[52:53], v[60:61]
v_pk_add_f32 v[60:61], v[54:55], v[62:63] neg_lo:[0,1] neg_hi:[0,1]
v_pk_add_f32 v[54:55], v[54:55], v[62:63]
v_pk_mul_f32 v[62:63], v[60:61], s[62:63] op_sel:[0,0] op_sel_hi:[0,1] neg_lo:[0,1] neg_hi:[0,0]
v_pk_fma_f32 v[62:63], v[60:61], s[62:63], v[62:63] op_sel:[1,1,0] op_sel_hi:[1,0,1] neg_lo:[0,1,0] neg_hi:[0,1,0]
v_pk_add_f32 v[60:61], v[40:41], v[48:49] neg_lo:[0,1] neg_hi:[0,1]
v_pk_add_f32 v[40:41], v[40:41], v[48:49]
v_pk_add_f32 v[48:49], v[66:67], v[74:75] neg_lo:[0,1] neg_hi:[0,1]
v_pk_add_f32 v[66:67], v[66:67], v[74:75]
v_pk_mul_f32 v[74:75], v[48:49], s[62:63] op_sel:[0,0] op_sel_hi:[0,1] neg_lo:[0,0] neg_hi:[0,0]
v_pk_fma_f32 v[74:75], v[48:49], s[62:63], v[74:75] op_sel:[1,1,0] op_sel_hi:[1,0,1] neg_lo:[0,1,0] neg_hi:[0,0,0]
v_pk_add_f32 v[48:49], v[68:69], v[76:77] op_sel:[1,1] op_sel_hi:[0,0] neg_lo:[1,0] neg_hi:[0,1]
v_pk_add_f32 v[68:69], v[68:69], v[76:77]
v_pk_add_f32 v[76:77], v[70:71], v[78:79] neg_lo:[0,1] neg_hi:[0,1]
v_pk_add_f32 v[70:71], v[70:71], v[78:79]
v_pk_mul_f32 v[78:79], v[76:77], s[62:63] op_sel:[0,0] op_sel_hi:[0,1] neg_lo:[0,1] neg_hi:[0,0]
v_pk_fma_f32 v[78:79], v[76:77], s[62:63], v[78:79] op_sel:[1,1,0] op_sel_hi:[1,0,1] neg_lo:[0,1,0] neg_hi:[0,1,0]
v_pk_add_f32 v[76:77], v[16:17], v[20:21] neg_lo:[0,1] neg_hi:[0,1]
v_pk_add_f32 v[16:17], v[16:17], v[20:21]
v_pk_add_f32 v[20:21], v[18:19], v[22:23] op_sel:[1,1] op_sel_hi:[0,0] neg_lo:[1,0] neg_hi:[0,1]
v_pk_add_f32 v[18:19], v[18:19], v[22:23]
v_pk_add_f32 v[22:23], v[72:73], v[24:25] neg_lo:[0,1] neg_hi:[0,1]
v_pk_add_f32 v[72:73], v[72:73], v[24:25]
v_pk_add_f32 v[24:25], v[26:27], v[30:31] op_sel:[1,1] op_sel_hi:[0,0] neg_lo:[1,0] neg_hi:[0,1]
v_pk_add_f32 v[26:27], v[26:27], v[30:31]
v_pk_add_f32 v[30:31], v[64:65], v[36:37] neg_lo:[0,1] neg_hi:[0,1]
v_pk_add_f32 v[64:65], v[64:65], v[36:37]
v_pk_add_f32 v[36:37], v[34:35], v[38:39] op_sel:[1,1] op_sel_hi:[0,0] neg_lo:[1,0] neg_hi:[0,1]
v_pk_add_f32 v[34:35], v[34:35], v[38:39]
v_pk_add_f32 v[38:39], v[28:29], v[32:33] neg_lo:[0,1] neg_hi:[0,1]
v_pk_add_f32 v[28:29], v[28:29], v[32:33]
v_pk_add_f32 v[32:33], v[42:43], v[46:47] op_sel:[1,1] op_sel_hi:[0,0] neg_lo:[1,0] neg_hi:[0,1]
v_pk_add_f32 v[42:43], v[42:43], v[46:47]
v_pk_add_f32 v[46:47], v[14:15], v[52:53] neg_lo:[0,1] neg_hi:[0,1]
v_pk_add_f32 v[14:15], v[14:15], v[52:53]
v_pk_add_f32 v[52:53], v[50:51], v[54:55] op_sel:[1,1] op_sel_hi:[0,0] neg_lo:[1,0] neg_hi:[0,1]
v_pk_add_f32 v[50:51], v[50:51], v[54:55]
v_pk_add_f32 v[54:55], v[44:45], v[56:57] neg_lo:[0,1] neg_hi:[0,1]
v_pk_add_f32 v[44:45], v[44:45], v[56:57]
v_pk_add_f32 v[56:57], v[58:59], v[62:63] op_sel:[1,1] op_sel_hi:[0,0] neg_lo:[1,0] neg_hi:[0,1]
v_pk_add_f32 v[58:59], v[58:59], v[62:63]
v_pk_add_f32 v[62:63], v[40:41], v[68:69] neg_lo:[0,1] neg_hi:[0,1]
v_pk_add_f32 v[40:41], v[40:41], v[68:69]
v_pk_add_f32 v[68:69], v[66:67], v[70:71] op_sel:[1,1] op_sel_hi:[0,0] neg_lo:[1,0] neg_hi:[0,1]
v_pk_add_f32 v[66:67], v[66:67], v[70:71]
v_pk_add_f32 v[70:71], v[60:61], v[48:49] neg_lo:[0,1] neg_hi:[0,1]
v_pk_add_f32 v[60:61], v[60:61], v[48:49]
v_pk_add_f32 v[48:49], v[74:75], v[78:79] op_sel:[1,1] op_sel_hi:[0,0] neg_lo:[1,0] neg_hi:[0,1]
v_pk_add_f32 v[74:75], v[74:75], v[78:79]
v_pk_add_f32 v[78:79], v[16:17], v[18:19] neg_lo:[0,1] neg_hi:[0,1]
v_pk_add_f32 v[16:17], v[16:17], v[18:19]
v_pk_add_f32 v[18:19], v[76:77], v[20:21] neg_lo:[0,1] neg_hi:[0,1]
v_pk_add_f32 v[76:77], v[76:77], v[20:21]
v_pk_add_f32 v[20:21], v[72:73], v[26:27] neg_lo:[0,1] neg_hi:[0,1]
v_pk_add_f32 v[72:73], v[72:73], v[26:27]
v_pk_add_f32 v[26:27], v[22:23], v[24:25] neg_lo:[0,1] neg_hi:[0,1]
v_pk_add_f32 v[22:23], v[22:23], v[24:25]
v_pk_add_f32 v[24:25], v[64:65], v[34:35] neg_lo:[0,1] neg_hi:[0,1]
v_pk_add_f32 v[64:65], v[64:65], v[34:35]
v_pk_add_f32 v[34:35], v[30:31], v[36:37] neg_lo:[0,1] neg_hi:[0,1]
v_pk_add_f32 v[30:31], v[30:31], v[36:37]
v_pk_add_f32 v[36:37], v[28:29], v[42:43] neg_lo:[0,1] neg_hi:[0,1]
v_pk_add_f32 v[28:29], v[28:29], v[42:43]
v_pk_add_f32 v[42:43], v[38:39], v[32:33] neg_lo:[0,1] neg_hi:[0,1]
v_pk_add_f32 v[38:39], v[38:39], v[32:33]
v_pk_add_f32 v[32:33], v[14:15], v[50:51] neg_lo:[0,1] neg_hi:[0,1]
v_pk_add_f32 v[14:15], v[14:15], v[50:51]
v_pk_add_f32 v[50:51], v[46:47], v[52:53] neg_lo:[0,1] neg_hi:[0,1]
v_pk_add_f32 v[46:47], v[46:47], v[52:53]
v_pk_add_f32 v[52:53], v[44:45], v[58:59] neg_lo:[0,1] neg_hi:[0,1]
v_pk_add_f32 v[44:45], v[44:45], v[58:59]
v_pk_add_f32 v[58:59], v[54:55], v[56:57] neg_lo:[0,1] neg_hi:[0,1]
v_pk_add_f32 v[54:55], v[54:55], v[56:57]
v_pk_add_f32 v[56:57], v[40:41], v[66:67] neg_lo:[0,1] neg_hi:[0,1]
v_pk_add_f32 v[40:41], v[40:41], v[66:67]
v_pk_add_f32 v[66:67], v[62:63], v[68:69] neg_lo:[0,1] neg_hi:[0,1]
v_pk_add_f32 v[62:63], v[62:63], v[68:69]
v_pk_add_f32 v[68:69], v[60:61], v[74:75] neg_lo:[0,1] neg_hi:[0,1]
v_pk_add_f32 v[60:61], v[60:61], v[74:75]
v_pk_add_f32 v[74:75], v[70:71], v[48:49] neg_lo:[0,1] neg_hi:[0,1]
v_pk_add_f32 v[70:71], v[70:71], v[48:49]
v_pk_mul_f32 v[48:49], v[14:15], v[82:83] op_sel:[0,0] op_sel_hi:[0,1] neg_lo:[0,0] neg_hi:[0,0]
v_pk_fma_f32 v[14:15], v[14:15], v[82:83], v[48:49] op_sel:[1,1,0] op_sel_hi:[1,0,1] neg_lo:[0,1,0] neg_hi:[0,0,0]
v_pk_mul_f32 v[48:49], v[64:65], v[84:85] op_sel:[0,0] op_sel_hi:[0,1] neg_lo:[0,0] neg_hi:[0,0]
v_pk_fma_f32 v[64:65], v[64:65], v[84:85], v[48:49] op_sel:[1,1,0] op_sel_hi:[1,0,1] neg_lo:[0,1,0] neg_hi:[0,0,0]
v_pk_mul_f32 v[48:49], v[40:41], v[86:87] op_sel:[0,0] op_sel_hi:[0,1] neg_lo:[0,0] neg_hi:[0,0]
v_pk_fma_f32 v[40:41], v[40:41], v[86:87], v[48:49] op_sel:[1,1,0] op_sel_hi:[1,0,1] neg_lo:[0,1,0] neg_hi:[0,0,0]
v_pk_mul_f32 v[48:49], v[72:73], v[88:89] op_sel:[0,0] op_sel_hi:[0,1] neg_lo:[0,0] neg_hi:[0,0]
v_pk_fma_f32 v[72:73], v[72:73], v[88:89], v[48:49] op_sel:[1,1,0] op_sel_hi:[1,0,1] neg_lo:[0,1,0] neg_hi:[0,0,0]
v_pk_mul_f32 v[48:49], v[44:45], v[90:91] op_sel:[0,0] op_sel_hi:[0,1] neg_lo:[0,0] neg_hi:[0,0]
v_pk_fma_f32 v[44:45], v[44:45], v[90:91], v[48:49] op_sel:[1,1,0] op_sel_hi:[1,0,1] neg_lo:[0,1,0] neg_hi:[0,0,0]
v_pk_mul_f32 v[48:49], v[28:29], v[92:93] op_sel:[0,0] op_sel_hi:[0,1] neg_lo:[0,0] neg_hi:[0,0]
v_pk_fma_f32 v[28:29], v[28:29], v[92:93], v[48:49] op_sel:[1,1,0] op_sel_hi:[1,0,1] neg_lo:[0,1,0] neg_hi:[0,0,0]
v_pk_mul_f32 v[48:49], v[60:61], v[94:95] op_sel:[0,0] op_sel_hi:[0,1] neg_lo:[0,0] neg_hi:[0,0]
v_pk_fma_f32 v[60:61], v[60:61], v[94:95], v[48:49] op_sel:[1,1,0] op_sel_hi:[1,0,1] neg_lo:[0,1,0] neg_hi:[0,0,0]
v_pk_mul_f32 v[48:49], v[76:77], v[96:97] op_sel:[0,0] op_sel_hi:[0,1] neg_lo:[0,0] neg_hi:[0,0]
v_pk_fma_f32 v[76:77], v[76:77], v[96:97], v[48:49] op_sel:[1,1,0] op_sel_hi:[1,0,1] neg_lo:[0,1,0] neg_hi:[0,0,0]
v_pk_mul_f32 v[48:49], v[46:47], v[98:99] op_sel:[0,0] op_sel_hi:[0,1] neg_lo:[0,0] neg_hi:[0,0]
v_pk_fma_f32 v[46:47], v[46:47], v[98:99], v[48:49] op_sel:[1,1,0] op_sel_hi:[1,0,1] neg_lo:[0,1,0] neg_hi:[0,0,0]
v_pk_mul_f32 v[48:49], v[30:31], v[100:101] op_sel:[0,0] op_sel_hi:[0,1] neg_lo:[0,0] neg_hi:[0,0]
v_pk_fma_f32 v[30:31], v[30:31], v[100:101], v[48:49] op_sel:[1,1,0] op_sel_hi:[1,0,1] neg_lo:[0,1,0] neg_hi:[0,0,0]
v_pk_mul_f32 v[48:49], v[62:63], v[102:103] op_sel:[0,0] op_sel_hi:[0,1] neg_lo:[0,0] neg_hi:[0,0]
v_pk_fma_f32 v[62:63], v[62:63], v[102:103], v[48:49] op_sel:[1,1,0] op_sel_hi:[1,0,1] neg_lo:[0,1,0] neg_hi:[0,0,0]
v_pk_mul_f32 v[48:49], v[22:23], v[104:105] op_sel:[0,0] op_sel_hi:[0,1] neg_lo:[0,0] neg_hi:[0,0]
v_pk_fma_f32 v[22:23], v[22:23], v[104:105], v[48:49] op_sel:[1,1,0] op_sel_hi:[1,0,1] neg_lo:[0,1,0] neg_hi:[0,0,0]
v_pk_mul_f32 v[48:49], v[54:55], v[106:107] op_sel:[0,0] op_sel_hi:[0,1] neg_lo:[0,0] neg_hi:[0,0]
v_pk_fma_f32 v[54:55], v[54:55], v[106:107], v[48:49] op_sel:[1,1,0] op_sel_hi:[1,0,1] neg_lo:[0,1,0] neg_hi:[0,0,0]
v_pk_mul_f32 v[48:49], v[38:39], v[108:109] op_sel:[0,0] op_sel_hi:[0,1] neg_lo:[0,0] neg_hi:[0,0]
v_pk_fma_f32 v[38:39], v[38:39], v[108:109], v[48:49] op_sel:[1,1,0] op_sel_hi:[1,0,1] neg_lo:[0,1,0] neg_hi:[0,0,0]
v_pk_mul_f32 v[48:49], v[70:71], v[110:111] op_sel:[0,0] op_sel_hi:[0,1] neg_lo:[0,0] neg_hi:[0,0]
v_pk_fma_f32 v[70:71], v[70:71], v[110:111], v[48:49] op_sel:[1,1,0] op_sel_hi:[1,0,1] neg_lo:[0,1,0] neg_hi:[0,0,0]
v_pk_mul_f32 v[48:49], v[78:79], v[112:113] op_sel:[0,0] op_sel_hi:[0,1] neg_lo:[0,0] neg_hi:[0,0]
v_pk_fma_f32 v[78:79], v[78:79], v[112:113], v[48:49] op_sel:[1,1,0] op_sel_hi:[1,0,1] neg_lo:[0,1,0] neg_hi:[0,0,0]
v_pk_mul_f32 v[48:49], v[32:33], v[114:115] op_sel:[0,0] op_sel_hi:[0,1] neg_lo:[0,0] neg_hi:[0,0]
v_pk_fma_f32 v[32:33], v[32:33], v[114:115], v[48:49] op_sel:[1,1,0] op_sel_hi:[1,0,1] neg_lo:[0,1,0] neg_hi:[0,0,0]
v_pk_mul_f32 v[48:49], v[24:25], v[116:117] op_sel:[0,0] op_sel_hi:[0,1] neg_lo:[0,0] neg_hi:[0,0]
v_pk_fma_f32 v[24:25], v[24:25], v[116:117], v[48:49] op_sel:[1,1,0] op_sel_hi:[1,0,1] neg_lo:[0,1,0] neg_hi:[0,0,0]
v_pk_mul_f32 v[48:49], v[56:57], v[118:119] op_sel:[0,0] op_sel_hi:[0,1] neg_lo:[0,0] neg_hi:[0,0]
v_pk_fma_f32 v[56:57], v[56:57], v[118:119], v[48:49] op_sel:[1,1,0] op_sel_hi:[1,0,1] neg_lo:[0,1,0] neg_hi:[0,0,0]
v_pk_mul_f32 v[48:49], v[20:21], v[120:121] op_sel:[0,0] op_sel_hi:[0,1] neg_lo:[0,0] neg_hi:[0,0]
v_pk_fma_f32 v[20:21], v[20:21], v[120:121], v[48:49] op_sel:[1,1,0] op_sel_hi:[1,0,1] neg_lo:[0,1,0] neg_hi:[0,0,0]
v_pk_mul_f32 v[48:49], v[52:53], v[122:123] op_sel:[0,0] op_sel_hi:[0,1] neg_lo:[0,0] neg_hi:[0,0]
v_pk_fma_f32 v[52:53], v[52:53], v[122:123], v[48:49] op_sel:[1,1,0] op_sel_hi:[1,0,1] neg_lo:[0,1,0] neg_hi:[0,0,0]
v_pk_mul_f32 v[48:49], v[36:37], v[124:125] op_sel:[0,0] op_sel_hi:[0,1] neg_lo:[0,0] neg_hi:[0,0]
v_pk_fma_f32 v[36:37], v[36:37], v[124:125], v[48:49] op_sel:[1,1,0] op_sel_hi:[1,0,1] neg_lo:[0,1,0] neg_hi:[0,0,0]
v_pk_mul_f32 v[48:49], v[68:69], v[126:127] op_sel:[0,0] op_sel_hi:[0,1] neg_lo:[0,0] neg_hi:[0,0]
v_pk_fma_f32 v[68:69], v[68:69], v[126:127], v[48:49] op_sel:[1,1,0] op_sel_hi:[1,0,1] neg_lo:[0,1,0] neg_hi:[0,0,0]
v_pk_mul_f32 v[48:49], v[18:19], v[128:129] op_sel:[0,0] op_sel_hi:[0,1] neg_lo:[0,0] neg_hi:[0,0]
v_pk_fma_f32 v[18:19], v[18:19], v[128:129], v[48:49] op_sel:[1,1,0] op_sel_hi:[1,0,1] neg_lo:[0,1,0] neg_hi:[0,0,0]
v_pk_mul_f32 v[48:49], v[50:51], v[130:131] op_sel:[0,0] op_sel_hi:[0,1] neg_lo:[0,0] neg_hi:[0,0]
v_pk_fma_f32 v[50:51], v[50:51], v[130:131], v[48:49] op_sel:[1,1,0] op_sel_hi:[1,0,1] neg_lo:[0,1,0] neg_hi:[0,0,0]
v_pk_mul_f32 v[48:49], v[34:35], v[132:133] op_sel:[0,0] op_sel_hi:[0,1] neg_lo:[0,0] neg_hi:[0,0]
v_pk_fma_f32 v[34:35], v[34:35], v[132:133], v[48:49] op_sel:[1,1,0] op_sel_hi:[1,0,1] neg_lo:[0,1,0] neg_hi:[0,0,0]
v_pk_mul_f32 v[48:49], v[66:67], v[134:135] op_sel:[0,0] op_sel_hi:[0,1] neg_lo:[0,0] neg_hi:[0,0]
v_pk_fma_f32 v[66:67], v[66:67], v[134:135], v[48:49] op_sel:[1,1,0] op_sel_hi:[1,0,1] neg_lo:[0,1,0] neg_hi:[0,0,0]
v_pk_mul_f32 v[48:49], v[26:27], v[136:137] op_sel:[0,0] op_sel_hi:[0,1] neg_lo:[0,0] neg_hi:[0,0]
v_pk_fma_f32 v[26:27], v[26:27], v[136:137], v[48:49] op_sel:[1,1,0] op_sel_hi:[1,0,1] neg_lo:[0,1,0] neg_hi:[0,0,0]
v_pk_mul_f32 v[48:49], v[58:59], v[138:139] op_sel:[0,0] op_sel_hi:[0,1] neg_lo:[0,0] neg_hi:[0,0]
v_pk_fma_f32 v[58:59], v[58:59], v[138:139], v[48:49] op_sel:[1,1,0] op_sel_hi:[1,0,1] neg_lo:[0,1,0] neg_hi:[0,0,0]
v_pk_mul_f32 v[48:49], v[42:43], v[140:141] op_sel:[0,0] op_sel_hi:[0,1] neg_lo:[0,0] neg_hi:[0,0]
v_pk_fma_f32 v[42:43], v[42:43], v[140:141], v[48:49] op_sel:[1,1,0] op_sel_hi:[1,0,1] neg_lo:[0,1,0] neg_hi:[0,0,0]
v_pk_mul_f32 v[48:49], v[74:75], v[142:143] op_sel:[0,0] op_sel_hi:[0,1] neg_lo:[0,0] neg_hi:[0,0]
v_pk_fma_f32 v[74:75], v[74:75], v[142:143], v[48:49] op_sel:[1,1,0] op_sel_hi:[1,0,1] neg_lo:[0,1,0] neg_hi:[0,0,0]
ds_write_b64 v4, v[16:17] offset:0
ds_write_b64 v4, v[14:15] offset:264
ds_write_b64 v4, v[64:65] offset:528
ds_write_b64 v4, v[40:41] offset:792
ds_write_b64 v4, v[72:73] offset:1056
ds_write_b64 v4, v[44:45] offset:1320
ds_write_b64 v4, v[28:29] offset:1584
ds_write_b64 v4, v[60:61] offset:1848
ds_write_b64 v4, v[76:77] offset:2112
ds_write_b64 v4, v[46:47] offset:2376
ds_write_b64 v4, v[30:31] offset:2640
ds_write_b64 v4, v[62:63] offset:2904
ds_write_b64 v4, v[22:23] offset:3168
ds_write_b64 v4, v[54:55] offset:3432
ds_write_b64 v4, v[38:39] offset:3696
ds_write_b64 v4, v[70:71] offset:3960
ds_write_b64 v4, v[78:79] offset:4224
ds_write_b64 v4, v[32:33] offset:4488
ds_write_b64 v4, v[24:25] offset:4752
ds_write_b64 v4, v[56:57] offset:5016
ds_write_b64 v4, v[20:21] offset:5280
ds_write_b64 v4, v[52:53] offset:5544
ds_write_b64 v4, v[36:37] offset:5808
ds_write_b64 v4, v[68:69] offset:6072
ds_write_b64 v4, v[18:19] offset:6336
ds_write_b64 v4, v[50:51] offset:6600
ds_write_b64 v4, v[34:35] offset:6864
ds_write_b64 v4, v[66:67] offset:7128
ds_write_b64 v4, v[26:27] offset:7392
ds_write_b64 v4, v[58:59] offset:7656
ds_write_b64 v4, v[42:43] offset:7920
ds_write_b64 v4, v[74:75] offset:8184
s_waitcnt lgkmcnt(0)
ds_read_b64 v[16:17], v5 offset:0
ds_read_b64 v[48:49], v5 offset:128
ds_read_b64 v[18:19], v5 offset:8
ds_read_b64 v[50:51], v5 offset:136
ds_read_b64 v[20:21], v5 offset:16
ds_read_b64 v[52:53], v5 offset:144
ds_read_b64 v[22:23], v5 offset:24
ds_read_b64 v[54:55], v5 offset:152
ds_read_b64 v[24:25], v5 offset:32
ds_read_b64 v[56:57], v5 offset:160
ds_read_b64 v[26:27], v5 offset:40
ds_read_b64 v[58:59], v5 offset:168
ds_read_b64 v[28:29], v5 offset:48
ds_read_b64 v[60:61], v5 offset:176
ds_read_b64 v[30:31], v5 offset:56
ds_read_b64 v[62:63], v5 offset:184
ds_read_b64 v[32:33], v5 offset:64
ds_read_b64 v[64:65], v5 offset:192
ds_read_b64 v[34:35], v5 offset:72
ds_read_b64 v[66:67], v5 offset:200
ds_read_b64 v[36:37], v5 offset:80
ds_read_b64 v[68:69], v5 offset:208
ds_read_b64 v[38:39], v5 offset:88
ds_read_b64 v[70:71], v5 offset:216
ds_read_b64 v[40:41], v5 offset:96
ds_read_b64 v[72:73], v5 offset:224
ds_read_b64 v[42:43], v5 offset:104
ds_read_b64 v[74:75], v5 offset:232
ds_read_b64 v[44:45], v5 offset:112
ds_read_b64 v[76:77], v5 offset:240
ds_read_b64 v[46:47], v5 offset:120
ds_read_b64 v[78:79], v5 offset:248
s_waitcnt lgkmcnt(0)
v_pk_add_f32 v[14:15], v[16:17], v[48:49] neg_lo:[0,1] neg_hi:[0,1]
v_pk_add_f32 v[16:17], v[16:17], v[48:49]
v_pk_add_f32 v[48:49], v[18:19], v[50:51] neg_lo:[0,1] neg_hi:[0,1]
v_pk_add_f32 v[18:19], v[18:19], v[50:51]
v_pk_mul_f32 v[50:51], v[48:49], s[50:51] op_sel:[0,0] op_sel_hi:[0,1] neg_lo:[0,0] neg_hi:[0,0]
v_pk_fma_f32 v[50:51], v[48:49], s[50:51], v[50:51] op_sel:[1,1,0] op_sel_hi:[1,0,1] neg_lo:[0,1,0] neg_hi:[0,0,0]
v_pk_add_f32 v[48:49], v[20:21], v[52:53] neg_lo:[0,1] neg_hi:[0,1]
v_pk_add_f32 v[20:21], v[20:21], v[52:53]
v_pk_mul_f32 v[52:53], v[48:49], s[54:55] op_sel:[0,0] op_sel_hi:[0,1] neg_lo:[0,0] neg_hi:[0,0]
v_pk_fma_f32 v[52:53], v[48:49], s[54:55], v[52:53] op_sel:[1,1,0] op_sel_hi:[1,0,1] neg_lo:[0,1,0] neg_hi:[0,0,0]
v_pk_add_f32 v[48:49], v[22:23], v[54:55] neg_lo:[0,1] neg_hi:[0,1]
v_pk_add_f32 v[22:23], v[22:23], v[54:55]
v_pk_mul_f32 v[54:55], v[48:49], s[58:59] op_sel:[0,0] op_sel_hi:[0,1] neg_lo:[0,0] neg_hi:[0,0]
v_pk_fma_f32 v[54:55], v[48:49], s[58:59], v[54:55] op_sel:[1,1,0] op_sel_hi:[1,0,1] neg_lo:[0,1,0] neg_hi:[0,0,0]
v_pk_add_f32 v[48:49], v[24:25], v[56:57] neg_lo:[0,1] neg_hi:[0,1]
v_pk_add_f32 v[24:25], v[24:25], v[56:57]
v_pk_mul_f32 v[56:57], v[48:49], s[62:63] op_sel:[0,0] op_sel_hi:[0,1] neg_lo:[0,0] neg_hi:[0,0]
v_pk_fma_f32 v[56:57], v[48:49], s[62:63], v[56:57] op_sel:[1,1,0] op_sel_hi:[1,0,1] neg_lo:[0,1,0] neg_hi:[0,0,0]
v_pk_add_f32 v[48:49], v[26:27], v[58:59] neg_lo:[0,1] neg_hi:[0,1]
v_pk_add_f32 v[26:27], v[26:27], v[58:59]
v_pk_mul_f32 v[58:59], v[48:49], s[58:59] op_sel:[0,1] op_sel_hi:[0,0] neg_lo:[0,0] neg_hi:[0,0]
v_pk_fma_f32 v[58:59], v[48:49], s[58:59], v[58:59] op_sel:[1,0,0] op_sel_hi:[1,1,1] neg_lo:[0,1,0] neg_hi:[0,0,0]
v_pk_add_f32 v[48:49], v[28:29], v[60:61] neg_lo:[0,1] neg_hi:[0,1]
v_pk_add_f32 v[28:29], v[28:29], v[60:61]
v_pk_mul_f32 v[60:61], v[48:49], s[54:55] op_sel:[0,1] op_sel_hi:[0,0] neg_lo:[0,0] neg_hi:[0,0]
v_pk_fma_f32 v[60:61], v[48:49], s[54:55], v[60:61] op_sel:[1,0,0] op_sel_hi:[1,1,1] neg_lo:[0,1,0] neg_hi:[0,0,0]
v_pk_add_f32 v[48:49], v[30:31], v[62:63] neg_lo:[0,1] neg_hi:[0,1]
v_pk_add_f32 v[30:31], v[30:31], v[62:63]
v_pk_mul_f32 v[62:63], v[48:49], s[50:51] op_sel:[0,1] op_sel_hi:[0,0] neg_lo:[0,0] neg_hi:[0,0]
v_pk_fma_f32 v[62:63], v[48:49], s[50:51], v[62:63] op_sel:[1,0,0] op_sel_hi:[1,1,1] neg_lo:[0,1,0] neg_hi:[0,0,0]
v_pk_add_f32 v[48:49], v[32:33], v[64:65] op_sel:[1,1] op_sel_hi:[0,0] neg_lo:[1,0] neg_hi:[0,1]
v_pk_add_f32 v[32:33], v[32:33], v[64:65]
v_pk_add_f32 v[64:65], v[34:35], v[66:67] neg_lo:[0,1] neg_hi:[0,1]
v_pk_add_f32 v[34:35], v[34:35], v[66:67]
v_pk_mul_f32 v[66:67], v[64:65], s[50:51] op_sel:[0,1] op_sel_hi:[0,0] neg_lo:[0,1] neg_hi:[0,0]
v_pk_fma_f32 v[66:67], v[64:65], s[50:51], v[66:67] op_sel:[1,0,0] op_sel_hi:[1,1,1] neg_lo:[0,1,0] neg_hi:[0,1,0]
v_pk_add_f32 v[64:65], v[36:37], v[68:69] neg_lo:[0,1] neg_hi:[0,1]
v_pk_add_f32 v[36:37], v[36:37], v[68:69]
v_pk_mul_f32 v[68:69], v[64:65], s[54:55] op_sel:[0,1] op_sel_hi:[0,0] neg_lo:[0,1] neg_hi:[0,0]
v_pk_fma_f32 v[68:69], v[64:65], s[54:55], v[68:69] op_sel:[1,0,0] op_sel_hi:[1,1,1] neg_lo:[0,1,0] neg_hi:[0,1,0]
v_pk_add_f32 v[64:65], v[38:39], v[70:71] neg_lo:[0,1] neg_hi:[0,1]
v_pk_add_f32 v[38:39], v[38:39], v[70:71]
v_pk_mul_f32 v[70:71], v[64:65], s[58:59] op_sel:[0,1] op_sel_hi:[0,0] neg_lo:[0,1] neg_hi:[0,0]
v_pk_fma_f32 v[70:71], v[64:65], s[58:59], v[70:71] op_sel:[1,0,0] op_sel_hi:[1,1,1] neg_lo:[0,1,0] neg_hi:[0,1,0]
v_pk_add_f32 v[64:65], v[40:41], v[72:73] neg_lo:[0,1] neg_hi:[0,1]
v_pk_add_f32 v[40:41], v[40:41], v[72:73]
v_pk_mul_f32 v[72:73], v[64:65], s[62:63] op_sel:[0,0] op_sel_hi:[0,1] neg_lo:[0,1] neg_hi:[0,0]
v_pk_fma_f32 v[72:73], v[64:65], s[62:63], v[72:73] op_sel:[1,1,0] op_sel_hi:[1,0,1] neg_lo:[0,1,0] neg_hi:[0,1,0]
v_pk_add_f32 v[64:65], v[42:43], v[74:75] neg_lo:[0,1] neg_hi:[0,1]
v_pk_add_f32 v[42:43], v[42:43], v[74:75]
v_pk_mul_f32 v[74:75], v[64:65], s[58:59] op_sel:[0,0] op_sel_hi:[0,1] neg_lo:[0,1] neg_hi:[0,0]
v_pk_fma_f32 v[74:75], v[64:65], s[58:59], v[74:75] op_sel:[1,1,0] op_sel_hi:[1,0,1] neg_lo:[0,1,0] neg_hi:[0,1,0]
v_pk_add_f32 v[64:65], v[44:45], v[76:77] neg_lo:[0,1] neg_hi:[0,1]
v_pk_add_f32 v[44:45], v[44:45], v[76:77]
v_pk_mul_f32 v[76:77], v[64:65], s[54:55] op_sel:[0,0] op_sel_hi:[0,1] neg_lo:[0,1] neg_hi:[0,0]
v_pk_fma_f32 v[76:77], v[64:65], s[54:55], v[76:77] op_sel:[1,1,0] op_sel_hi:[1,0,1] neg_lo:[0,1,0] neg_hi:[0,1,0]
v_pk_add_f32 v[64:65], v[46:47], v[78:79] neg_lo:[0,1] neg_hi:[0,1]
v_pk_add_f32 v[46:47], v[46:47], v[78:79]
v_pk_mul_f32 v[78:79], v[64:65], s[50:51] op_sel:[0,0] op_sel_hi:[0,1] neg_lo:[0,1] neg_hi:[0,0]
v_pk_fma_f32 v[78:79], v[64:65], s[50:51], v[78:79] op_sel:[1,1,0] op_sel_hi:[1,0,1] neg_lo:[0,1,0] neg_hi:[0,1,0]
v_pk_add_f32 v[64:65], v[16:17], v[32:33] neg_lo:[0,1] neg_hi:[0,1]
v_pk_add_f32 v[16:17], v[16:17], v[32:33]
v_pk_add_f32 v[32:33], v[18:19], v[34:35] neg_lo:[0,1] neg_hi:[0,1]
v_pk_add_f32 v[18:19], v[18:19], v[34:35]
v_pk_mul_f32 v[34:35], v[32:33], s[54:55] op_sel:[0,0] op_sel_hi:[0,1] neg_lo:[0,0] neg_hi:[0,0]
v_pk_fma_f32 v[34:35], v[32:33], s[54:55], v[34:35] op_sel:[1,1,0] op_sel_hi:[1,0,1] neg_lo:[0,1,0] neg_hi:[0,0,0]
v_pk_add_f32 v[32:33], v[20:21], v[36:37] neg_lo:[0,1] neg_hi:[0,1]
v_pk_add_f32 v[20:21], v[20:21], v[36:37]
v_pk_mul_f32 v[36:37], v[32:33], s[62:63] op_sel:[0,0] op_sel_hi:[0,1] neg_lo:[0,0] neg_hi:[0,0]
v_pk_fma_f32 v[36:37], v[32:33], s[62:63], v[36:37] op_sel:[1,1,0] op_sel_hi:[1,0,1] neg_lo:[0,1,0] neg_hi:[0,0,0]
v_pk_add_f32 v[32:33], v[22:23], v[38:39] neg_lo:[0,1] neg_hi:[0,1]
v_pk_add_f32 v[22:23], v[22:23], v[38:39]
v_pk_mul_f32 v[38:39], v[32:33], s[54:55] op_sel:[0,1] op_sel_hi:[0,0] neg_lo:[0,0] neg_hi:[0,0]
v_pk_fma_f32 v[38:39], v[32:33], s[54:55], v[38:39] op_sel:[1,0,0] op_sel_hi:[1,1,1] neg_lo:[0,1,0] neg_hi:[0,0,0]
v_pk_add_f32 v[32:33], v[24:25], v[40:41] op_sel:[1,1] op_sel_hi:[0,0] neg_lo:[1,0] neg_hi:[0,1]
v_pk_add_f32 v[24:25], v[24:25], v[40:41]
v_pk_add_f32 v[40:41], v[26:27], v[42:43] neg_lo:[0,1] neg_hi:[0,1]
v_pk_add_f32 v[26:27], v[26:27], v[42:43]
v_pk_mul_f32 v[42:43], v[40:41], s[54:55] op_sel:[0,1] op_sel_hi:[0,0] neg_lo:[0,1] neg_hi:[0,0]
v_pk_fma_f32 v[42:43], v[40:41], s[54:55], v[42:43] op_sel:[1,0,0] op_sel_hi:[1,1,1] neg_lo:[0,1,0] neg_hi:[0,1,0]
v_pk_add_f32 v[40:41], v[28:29], v[44:45] neg_lo:[0,1] neg_hi:[0,1]
v_pk_add_f32 v[28:29], v[28:29], v[44:45]
v_pk_mul_f32 v[44:45], v[40:41], s[62:63] op_sel:[0,0] op_sel_hi:[0,1] neg_lo:[0,1] neg_hi:[0,0]
v_pk_fma_f32 v[44:45], v[40:41], s[62:63], v[44:45] op_sel:[1,1,0] op_sel_hi:[1,0,1] neg_lo:[0,1,0] neg_hi:[0,1,0]
v_pk_add_f32 v[40:41], v[30:31], v[46:47] neg_lo:[0,1] neg_hi:[0,1]
v_pk_add_f32 v[30:31], v[30:31], v[46:47]
v_pk_mul_f32 v[46:47], v[40:41], s[54:55] op_sel:[0,0] op_sel_hi:[0,1] neg_lo:[0,1] neg_hi:[0,0]
v_pk_fma_f32 v[46:47], v[40:41], s[54:55], v[46:47] op_sel:[1,1,0] op_sel_hi:[1,0,1] neg_lo:[0,1,0] neg_hi:[0,1,0]
v_pk_add_f32 v[40:41], v[14:15], v[48:49] neg_lo:[0,1] neg_hi:[0,1]
v_pk_add_f32 v[14:15], v[14:15], v[48:49]
v_pk_add_f32 v[48:49], v[50:51], v[66:67] neg_lo:[0,1] neg_hi:[0,1]
v_pk_add_f32 v[50:51], v[50:51], v[66:67]
v_pk_mul_f32 v[66:67], v[48:49], s[54:55] op_sel:[0,0] op_sel_hi:[0,1] neg_lo:[0,0] neg_hi:[0,0]
v_pk_fma_f32 v[66:67], v[48:49], s[54:55], v[66:67] op_sel:[1,1,0] op_sel_hi:[1,0,1] neg_lo:[0,1,0] neg_hi:[0,0,0]
v_pk_add_f32 v[48:49], v[52:53], v[68:69] neg_lo:[0,1] neg_hi:[0,1]
v_pk_add_f32 v[52:53], v[52:53], v[68:69]
v_pk_mul_f32 v[68:69], v[48:49], s[62:63] op_sel:[0,0] op_sel_hi:[0,1] neg_lo:[0,0] neg_hi:[0,0]
v_pk_fma_f32 v[68:69], v[48:49], s[62:63], v[68:69] op_sel:[1,1,0] op_sel_hi:[1,0,1] neg_lo:[0,1,0] neg_hi:[0,0,0]
v_pk_add_f32 v[48:49], v[54:55], v[70:71] neg_lo:[0,1] neg_hi:[0,1]
v_pk_add_f32 v[54:55], v[54:55], v[70:71]
v_pk_mul_f32 v[70:71], v[48:49], s[54:55] op_sel:[0,1] op_sel_hi:[0,0] neg_lo:[0,0] neg_hi:[0,0]
v_pk_fma_f32 v[70:71], v[48:49], s[54:55], v[70:71] op_sel:[1,0,0] op_sel_hi:[1,1,1] neg_lo:[0,1,0] neg_hi:[0,0,0]
v_pk_add_f32 v[48:49], v[56:57], v[72:73] op_sel:[1,1] op_sel_hi:[0,0] neg_lo:[1,0] neg_hi:[0,1]
v_pk_add_f32 v[56:57], v[56:57], v[72:73]
v_pk_add_f32 v[72:73], v[58:59], v[74:75] neg_lo:[0,1] neg_hi:[0,1]
v_pk_add_f32 v[58:59], v[58:59], v[74:75]
v_pk_mul_f32 v[74:75], v[72:73], s[54:55] op_sel:[0,1] op_sel_hi:[0,0] neg_lo:[0,1] neg_hi:[0,0]
v_pk_fma_f32 v[74:75], v[72:73], s[54:55], v[74:75] op_sel:[1,0,0] op_sel_hi:[1,1,1] neg_lo:[0,1,0] neg_hi:[0,1,0]
v_pk_add_f32 v[72:73], v[60:61], v[76:77] neg_lo:[0,1] neg_hi:[0,1]
v_pk_add_f32 v[60:61], v[60:61], v[76:77]
v_pk_mul_f32 v[76:77], v[72:73], s[62:63] op_sel:[0,0] op_sel_hi:[0,1] neg_lo:[0,1] neg_hi:[0,0]
v_pk_fma_f32 v[76:77], v[72:73], s[62:63], v[76:77] op_sel:[1,1,0] op_sel_hi:[1,0,1] neg_lo:[0,1,0] neg_hi:[0,1,0]
v_pk_add_f32 v[72:73], v[62:63], v[78:79] neg_lo:[0,1] neg_hi:[0,1]
v_pk_add_f32 v[62:63], v[62:63], v[78:79]
v_pk_mul_f32 v[78:79], v[72:73], s[54:55] op_sel:[0,0] op_sel_hi:[0,1] neg_lo:[0,1] neg_hi:[0,0]
v_pk_fma_f32 v[78:79], v[72:73], s[54:55], v[78:79] op_sel:[1,1,0] op_sel_hi:[1,0,1] neg_lo:[0,1,0] neg_hi:[0,1,0]
v_pk_add_f32 v[72:73], v[16:17], v[24:25] neg_lo:[0,1] neg_hi:[0,1]
v_pk_add_f32 v[16:17], v[16:17], v[24:25]
v_pk_add_f32 v[24:25], v[18:19], v[26:27] neg_lo:[0,1] neg_hi:[0,1]
v_pk_add_f32 v[18:19], v[18:19], v[26:27]
v_pk_mul_f32 v[26:27], v[24:25], s[62:63] op_sel:[0,0] op_sel_hi:[0,1] neg_lo:[0,0] neg_hi:[0,0]
v_pk_fma_f32 v[26:27], v[24:25], s[62:63], v[26:27] op_sel:[1,1,0] op_sel_hi:[1,0,1] neg_lo:[0,1,0] neg_hi:[0,0,0]
v_pk_add_f32 v[24:25], v[20:21], v[28:29] op_sel:[1,1] op_sel_hi:[0,0] neg_lo:[1,0] neg_hi:[0,1]
v_pk_add_f32 v[20:21], v[20:21], v[28:29]
v_pk_add_f32 v[28:29], v[22:23], v[30:31] neg_lo:[0,1] neg_hi:[0,1]
v_pk_add_f32 v[22:23], v[22:23], v[30:31]
v_pk_mul_f32 v[30:31], v[28:29], s[62:63] op_sel:[0,0] op_sel_hi:[0,1] neg_lo:[0,1] neg_hi:[0,0]
v_pk_fma_f32 v[30:31], v[28:29], s[62:63], v[30:31] op_sel:[1,1,0] op_sel_hi:[1,0,1] neg_lo:[0,1,0] neg_hi:[0,1,0]
v_pk_add_f32 v[28:29], v[64:65], v[32:33] neg_lo:[0,1] neg_hi:[0,1]
v_pk_add_f32 v[64:65], v[64:65], v[32:33]
v_pk_add_f32 v[32:33], v[34:35], v[42:43] neg_lo:[0,1] neg_hi:[0,1]
v_pk_add_f32 v[34:35], v[34:35], v[42:43]
v_pk_mul_f32 v[42:43], v[32:33], s[62:63] op_sel:[0,0] op_sel_hi:[0,1] neg_lo:[0,0] neg_hi:[0,0]
v_pk_fma_f32 v[42:43], v[32:33], s[62:63], v[42:43] op_sel:[1,1,0] op_sel_hi:[1,0,1] neg_lo:[0,1,0] neg_hi:[0,0,0]
v_pk_add_f32 v[32:33], v[36:37], v[44:45] op_sel:[1,1] op_sel_hi:[0,0] neg_lo:[1,0] neg_hi:[0,1]
v_pk_add_f32 v[36:37], v[36:37], v[44:45]
v_pk_add_f32 v[44:45], v[38:39], v[46:47] neg_lo:[0,1] neg_hi:[0,1]
v_pk_add_f32 v[38:39], v[38:39], v[46:47]
v_pk_mul_f32 v[46:47], v[44:45], s[62:63] op_sel:[0,0] op_sel_hi:[0,1] neg_lo:[0,1] neg_hi:[0,0]
v_pk_fma_f32 v[46:47], v[44:45], s[62:63], v[46:47] op_sel:[1,1,0] op_sel_hi:[1,0,1] neg_lo:[0,1,0] neg_hi:[0,1,0]
v_pk_add_f32 v[44:45], v[14:15], v[56:57] neg_lo:[0,1] neg_hi:[0,1]
v_pk_add_f32 v[14:15], v[14:15], v[56:57]
v_pk_add_f32 v[56:57], v[50:51], v[58:59] neg_lo:[0,1] neg_hi:[0,1]
v_pk_add_f32 v[50:51], v[50:51], v[58:59]
v_pk_mul_f32 v[58:59], v[56:57], s[62:63] op_sel:[0,0] op_sel_hi:[0,1] neg_lo:[0,0] neg_hi:[0,0]
v_pk_fma_f32 v[58:59], v[56:57], s[62:63], v[58:59] op_sel:[1,1,0] op_sel_hi:[1,0,1] neg_lo:[0,1,0] neg_hi:[0,0,0]
v_pk_add_f32 v[56:57], v[52:53], v[60:61] op_sel:[1,1] op_sel_hi:[0,0] neg_lo:[1,0] neg_hi:[0,1]
v_pk_add_f32 v[52:53], v[52:53], v[60:61]
v_pk_add_f32 v[60:61], v[54:55], v[62:63] neg_lo:[0,1] neg_hi:[0,1]
v_pk_add_f32 v[54:55], v[54:55], v[62:63]
v_pk_mul_f32 v[62:63], v[60:61], s[62:63] op_sel:[0,0] op_sel_hi:[0,1] neg_lo:[0,1] neg_hi:[0,0]
v_pk_fma_f32 v[62:63], v[60:61], s[62:63], v[62:63] op_sel:[1,1,0] op_sel_hi:[1,0,1] neg_lo:[0,1,0] neg_hi:[0,1,0]
v_pk_add_f32 v[60:61], v[40:41], v[48:49] neg_lo:[0,1] neg_hi:[0,1]
v_pk_add_f32 v[40:41], v[40:41], v[48:49]
v_pk_add_f32 v[48:49], v[66:67], v[74:75] neg_lo:[0,1] neg_hi:[0,1]
v_pk_add_f32 v[66:67], v[66:67], v[74:75]
v_pk_mul_f32 v[74:75], v[48:49], s[62:63] op_sel:[0,0] op_sel_hi:[0,1] neg_lo:[0,0] neg_hi:[0,0]
v_pk_fma_f32 v[74:75], v[48:49], s[62:63], v[74:75] op_sel:[1,1,0] op_sel_hi:[1,0,1] neg_lo:[0,1,0] neg_hi:[0,0,0]
v_pk_add_f32 v[48:49], v[68:69], v[76:77] op_sel:[1,1] op_sel_hi:[0,0] neg_lo:[1,0] neg_hi:[0,1]
v_pk_add_f32 v[68:69], v[68:69], v[76:77]
v_pk_add_f32 v[76:77], v[70:71], v[78:79] neg_lo:[0,1] neg_hi:[0,1]
v_pk_add_f32 v[70:71], v[70:71], v[78:79]
v_pk_mul_f32 v[78:79], v[76:77], s[62:63] op_sel:[0,0] op_sel_hi:[0,1] neg_lo:[0,1] neg_hi:[0,0]
v_pk_fma_f32 v[78:79], v[76:77], s[62:63], v[78:79] op_sel:[1,1,0] op_sel_hi:[1,0,1] neg_lo:[0,1,0] neg_hi:[0,1,0]
v_pk_add_f32 v[76:77], v[16:17], v[20:21] neg_lo:[0,1] neg_hi:[0,1]
v_pk_add_f32 v[16:17], v[16:17], v[20:21]
v_pk_add_f32 v[20:21], v[18:19], v[22:23] op_sel:[1,1] op_sel_hi:[0,0] neg_lo:[1,0] neg_hi:[0,1]
v_pk_add_f32 v[18:19], v[18:19], v[22:23]
v_pk_add_f32 v[22:23], v[72:73], v[24:25] neg_lo:[0,1] neg_hi:[0,1]
v_pk_add_f32 v[72:73], v[72:73], v[24:25]
v_pk_add_f32 v[24:25], v[26:27], v[30:31] op_sel:[1,1] op_sel_hi:[0,0] neg_lo:[1,0] neg_hi:[0,1]
v_pk_add_f32 v[26:27], v[26:27], v[30:31]
v_pk_add_f32 v[30:31], v[64:65], v[36:37] neg_lo:[0,1] neg_hi:[0,1]
v_pk_add_f32 v[64:65], v[64:65], v[36:37]
v_pk_add_f32 v[36:37], v[34:35], v[38:39] op_sel:[1,1] op_sel_hi:[0,0] neg_lo:[1,0] neg_hi:[0,1]
v_pk_add_f32 v[34:35], v[34:35], v[38:39]
v_pk_add_f32 v[38:39], v[28:29], v[32:33] neg_lo:[0,1] neg_hi:[0,1]
v_pk_add_f32 v[28:29], v[28:29], v[32:33]
v_pk_add_f32 v[32:33], v[42:43], v[46:47] op_sel:[1,1] op_sel_hi:[0,0] neg_lo:[1,0] neg_hi:[0,1]
v_pk_add_f32 v[42:43], v[42:43], v[46:47]
v_pk_add_f32 v[46:47], v[14:15], v[52:53] neg_lo:[0,1] neg_hi:[0,1]
v_pk_add_f32 v[14:15], v[14:15], v[52:53]
v_pk_add_f32 v[52:53], v[50:51], v[54:55] op_sel:[1,1] op_sel_hi:[0,0] neg_lo:[1,0] neg_hi:[0,1]
v_pk_add_f32 v[50:51], v[50:51], v[54:55]
v_pk_add_f32 v[54:55], v[44:45], v[56:57] neg_lo:[0,1] neg_hi:[0,1]
v_pk_add_f32 v[44:45], v[44:45], v[56:57]
v_pk_add_f32 v[56:57], v[58:59], v[62:63] op_sel:[1,1] op_sel_hi:[0,0] neg_lo:[1,0] neg_hi:[0,1]
v_pk_add_f32 v[58:59], v[58:59], v[62:63]
v_pk_add_f32 v[62:63], v[40:41], v[68:69] neg_lo:[0,1] neg_hi:[0,1]
v_pk_add_f32 v[40:41], v[40:41], v[68:69]
v_pk_add_f32 v[68:69], v[66:67], v[70:71] op_sel:[1,1] op_sel_hi:[0,0] neg_lo:[1,0] neg_hi:[0,1]
v_pk_add_f32 v[66:67], v[66:67], v[70:71]
v_pk_add_f32 v[70:71], v[60:61], v[48:49] neg_lo:[0,1] neg_hi:[0,1]
v_pk_add_f32 v[60:61], v[60:61], v[48:49]
v_pk_add_f32 v[48:49], v[74:75], v[78:79] op_sel:[1,1] op_sel_hi:[0,0] neg_lo:[1,0] neg_hi:[0,1]
v_pk_add_f32 v[74:75], v[74:75], v[78:79]
v_pk_add_f32 v[78:79], v[16:17], v[18:19] neg_lo:[0,1] neg_hi:[0,1]
v_pk_add_f32 v[16:17], v[16:17], v[18:19]
v_pk_add_f32 v[18:19], v[76:77], v[20:21] neg_lo:[0,1] neg_hi:[0,1]
v_pk_add_f32 v[76:77], v[76:77], v[20:21]
v_pk_add_f32 v[20:21], v[72:73], v[26:27] neg_lo:[0,1] neg_hi:[0,1]
v_pk_add_f32 v[72:73], v[72:73], v[26:27]
v_pk_add_f32 v[26:27], v[22:23], v[24:25] neg_lo:[0,1] neg_hi:[0,1]
v_pk_add_f32 v[22:23], v[22:23], v[24:25]
v_pk_add_f32 v[24:25], v[64:65], v[34:35] neg_lo:[0,1] neg_hi:[0,1]
v_pk_add_f32 v[64:65], v[64:65], v[34:35]
v_pk_add_f32 v[34:35], v[30:31], v[36:37] neg_lo:[0,1] neg_hi:[0,1]
v_pk_add_f32 v[30:31], v[30:31], v[36:37]
v_pk_add_f32 v[36:37], v[28:29], v[42:43] neg_lo:[0,1] neg_hi:[0,1]
v_pk_add_f32 v[28:29], v[28:29], v[42:43]
v_pk_add_f32 v[42:43], v[38:39], v[32:33] neg_lo:[0,1] neg_hi:[0,1]
v_pk_add_f32 v[38:39], v[38:39], v[32:33]
v_pk_add_f32 v[32:33], v[14:15], v[50:51] neg_lo:[0,1] neg_hi:[0,1]
v_pk_add_f32 v[14:15], v[14:15], v[50:51]
v_pk_add_f32 v[50:51], v[46:47], v[52:53] neg_lo:[0,1] neg_hi:[0,1]
v_pk_add_f32 v[46:47], v[46:47], v[52:53]
v_pk_add_f32 v[52:53], v[44:45], v[58:59] neg_lo:[0,1] neg_hi:[0,1]
v_pk_add_f32 v[44:45], v[44:45], v[58:59]
v_pk_add_f32 v[58:59], v[54:55], v[56:57] neg_lo:[0,1] neg_hi:[0,1]
v_pk_add_f32 v[54:55], v[54:55], v[56:57]
v_pk_add_f32 v[56:57], v[40:41], v[66:67] neg_lo:[0,1] neg_hi:[0,1]
v_pk_add_f32 v[40:41], v[40:41], v[66:67]
v_pk_add_f32 v[66:67], v[62:63], v[68:69] neg_lo:[0,1] neg_hi:[0,1]
v_pk_add_f32 v[62:63], v[62:63], v[68:69]
v_pk_add_f32 v[68:69], v[60:61], v[74:75] neg_lo:[0,1] neg_hi:[0,1]
v_pk_add_f32 v[60:61], v[60:61], v[74:75]
v_pk_add_f32 v[74:75], v[70:71], v[48:49] neg_lo:[0,1] neg_hi:[0,1]
v_pk_add_f32 v[70:71], v[70:71], v[48:49]
ds_write2st64_b32 v12, v16, v17 offset0:0 offset1:16
ds_write_b32 v12, v14 offset:128
ds_write_b32 v12, v15 offset:4224
ds_write_b32 v12, v64 offset:256
ds_write_b32 v12, v65 offset:4352
ds_write_b32 v12, v40 offset:384
ds_write_b32 v12, v41 offset:4480
ds_write_b32 v12, v72 offset:512
ds_write_b32 v12, v73 offset:4608
ds_write_b32 v12, v44 offset:640
ds_write_b32 v12, v45 offset:4736
ds_write_b32 v12, v28 offset:768
ds_write_b32 v12, v29 offset:4864
ds_write_b32 v12, v60 offset:896
ds_write_b32 v12, v61 offset:4992
ds_write_b32 v12, v76 offset:1024
ds_write_b32 v12, v77 offset:5120
ds_write_b32 v12, v46 offset:1152
ds_write_b32 v12, v47 offset:5248
ds_write_b32 v12, v30 offset:1280
ds_write_b32 v12, v31 offset:5376
ds_write_b32 v12, v62 offset:1408
ds_write_b32 v12, v63 offset:5504
ds_write_b32 v12, v22 offset:1536
ds_write_b32 v12, v23 offset:5632
ds_write_b32 v12, v54 offset:1664
ds_write_b32 v12, v55 offset:5760
ds_write_b32 v12, v38 offset:1792
ds_write_b32 v12, v39 offset:5888
ds_write_b32 v12, v70 offset:1920
ds_write_b32 v12, v71 offset:6016
ds_write_b32 v12, v78 offset:2048
ds_write_b32 v12, v79 offset:6144
ds_write_b32 v12, v32 offset:2176
ds_write_b32 v12, v33 offset:6272
ds_write_b32 v12, v24 offset:2304
ds_write_b32 v12, v25 offset:6400
ds_write_b32 v12, v56 offset:2432
ds_write_b32 v12, v57 offset:6528
ds_write_b32 v12, v20 offset:2560
ds_write_b32 v12, v21 offset:6656
ds_write_b32 v12, v52 offset:2688
ds_write_b32 v12, v53 offset:6784
ds_write_b32 v12, v36 offset:2816
ds_write_b32 v12, v37 offset:6912
ds_write_b32 v12, v68 offset:2944
ds_write_b32 v12, v69 offset:7040
ds_write_b32 v12, v18 offset:3072
ds_write_b32 v12, v19 offset:7168
ds_write_b32 v12, v50 offset:3200
ds_write_b32 v12, v51 offset:7296
ds_write_b32 v12, v34 offset:3328
ds_write_b32 v12, v35 offset:7424
ds_write_b32 v12, v66 offset:3456
ds_write_b32 v12, v67 offset:7552
ds_write_b32 v12, v26 offset:3584
ds_write_b32 v12, v27 offset:7680
ds_write_b32 v12, v58 offset:3712
ds_write_b32 v12, v59 offset:7808
ds_write_b32 v12, v42 offset:3840
ds_write_b32 v12, v43 offset:7936
ds_write_b32 v12, v74 offset:3968
ds_write_b32 v12, v75 offset:8064
s_waitcnt lgkmcnt(0)
s_barrier
s_lshl_b32 s13, s93, 16
ds_read_b128 v[16:19], v2 offset:0
ds_read_b128 v[20:23], v2 offset:16
ds_read_b128 v[24:27], v2 offset:8448
ds_read_b128 v[28:31], v2 offset:8464
ds_read_b128 v[32:35], v2 offset:16896
ds_read_b128 v[36:39], v2 offset:16912
ds_read_b128 v[40:43], v2 offset:25344
ds_read_b128 v[44:47], v2 offset:25360
ds_read_b128 v[48:51], v2 offset:33792
ds_read_b128 v[52:55], v2 offset:33808
ds_read_b128 v[56:59], v2 offset:42240
ds_read_b128 v[60:63], v2 offset:42256
ds_read_b128 v[64:67], v2 offset:50688
ds_read_b128 v[68:71], v2 offset:50704
s_waitcnt lgkmcnt(12)
ds_read_b128 v[72:75], v2 offset:59136
ds_read_b128 v[76:79], v2 offset:59152
s_waitcnt lgkmcnt(14)
v_cvt_pk_bf16_f32 v216, v16, v17
v_cvt_pk_bf16_f32 v217, v18, v19
v_cvt_pk_bf16_f32 v218, v20, v21
v_cvt_pk_bf16_f32 v219, v22, v23
buffer_store_dwordx4 v[216:219], v3, s[4:7], s13 offen sc1
s_add_u32 s13, s13, 8192
s_waitcnt lgkmcnt(12)
v_cvt_pk_bf16_f32 v220, v24, v25
v_cvt_pk_bf16_f32 v221, v26, v27
v_cvt_pk_bf16_f32 v222, v28, v29
v_cvt_pk_bf16_f32 v223, v30, v31
buffer_store_dwordx4 v[220:223], v3, s[4:7], s13 offen sc1
s_add_u32 s13, s13, 8192
s_waitcnt lgkmcnt(10)
v_cvt_pk_bf16_f32 v224, v32, v33
v_cvt_pk_bf16_f32 v225, v34, v35
v_cvt_pk_bf16_f32 v226, v36, v37
v_cvt_pk_bf16_f32 v227, v38, v39
buffer_store_dwordx4 v[224:227], v3, s[4:7], s13 offen sc1
s_add_u32 s13, s13, 8192
s_waitcnt lgkmcnt(8)
v_cvt_pk_bf16_f32 v228, v40, v41
v_cvt_pk_bf16_f32 v229, v42, v43
v_cvt_pk_bf16_f32 v230, v44, v45
v_cvt_pk_bf16_f32 v231, v46, v47
buffer_store_dwordx4 v[228:231], v3, s[4:7], s13 offen sc1
s_add_u32 s13, s13, 8192
s_waitcnt lgkmcnt(6)
v_cvt_pk_bf16_f32 v232, v48, v49
v_cvt_pk_bf16_f32 v233, v50, v51
v_cvt_pk_bf16_f32 v234, v52, v53
v_cvt_pk_bf16_f32 v235, v54, v55
buffer_store_dwordx4 v[232:235], v3, s[4:7], s13 offen sc1
s_add_u32 s13, s13, 8192
s_waitcnt lgkmcnt(4)
v_cvt_pk_bf16_f32 v236, v56, v57
v_cvt_pk_bf16_f32 v237, v58, v59
v_cvt_pk_bf16_f32 v238, v60, v61
v_cvt_pk_bf16_f32 v239, v62, v63
buffer_store_dwordx4 v[236:239], v3, s[4:7], s13 offen sc1
s_add_u32 s13, s13, 8192
s_waitcnt lgkmcnt(2)
v_cvt_pk_bf16_f32 v240, v64, v65
v_cvt_pk_bf16_f32 v241, v66, v67
v_cvt_pk_bf16_f32 v242, v68, v69
v_cvt_pk_bf16_f32 v243, v70, v71
buffer_store_dwordx4 v[240:243], v3, s[4:7], s13 offen sc1
s_add_u32 s13, s13, 8192
s_waitcnt lgkmcnt(0)
v_cvt_pk_bf16_f32 v244, v72, v73
v_cvt_pk_bf16_f32 v245, v74, v75
v_cvt_pk_bf16_f32 v246, v76, v77
v_cvt_pk_bf16_f32 v247, v78, v79
buffer_store_dwordx4 v[244:247], v3, s[4:7], s13 offen sc1
s_add_u32 s13, s13, 8192
s_mov_b32 s93, s21
s_cmp_lt_u32 s93, 128
s_cbranch_scc1 mega_kernel_f3_l
mega_kernel_f3_e:
s_waitcnt vmcnt(0)
s_barrier
s_add_u32 s64, s91, 58
s_mov_b32 s65, 64
s_mov_b32 s67, 1
s_add_u32 s66, s66, 262144
s_cmp_eq_u32 s91, 0
s_cbranch_scc1 mega_kernel_out
s_lshr_b32 s66, s40, 2
s_lshl_b32 s66, s66, 16
s_and_b32 s76, s40, 3
s_lshl_b32 s76, s76, 13
s_add_u32 s66, s66, s76
s_add_u32 s66, s66, 67141632
mega_kernel_out:
s_load_dwordx2 s[4:5], s[0:1], 40
s_load_dwordx2 s[8:9], s[0:1], 80
v_lshrrev_b32 v2, 6, v0
v_and_b32 v1, 63, v0
v_readfirstlane_b32 s41, v2
v_lshlrev_b32 v5, 4, v1
s_waitcnt lgkmcnt(0)
s_mov_b32 s6, 8388608
s_mov_b32 s7, 0x00020000
s_mov_b32 s10, 8388608
s_mov_b32 s11, 0x00020000
s_and_b32 s58, s40, 1
s_lshr_b32 s59, s40, 1
s_lshl_b32 s43, s58, 22
s_lshl_b32 s44, s41, 20
s_add_u32 s43, s43, s44
s_lshl_b32 s44, s59, 7
s_add_u32 s48, s43, s44
s_and_b32 s56, s59, 7
s_lshl_b32 s56, s56, 6
s_cmp_eq_u32 s68, 2
s_cbranch_scc1 mega_kernel_o_hw
v_lshrrev_b32 v2, 3, v1
v_and_b32 v3, 7, v1
v_lshlrev_b32 v16, 11, v2
v_lshl_add_u32 v16, v3, 4, v16
v_add_u32 v16, s48, v16
v_and_b32 v3, 3, v1
s_lshl_b32 s45, s41, 15
v_bfe_u32 v17, v1, 2, 2
v_lshrrev_b32 v18, 5, v1
v_mul_u32_u24 v18, 4, v18
v_add_u32 v17, v17, v18
v_lshlrev_b32 v17, 7, v17
v_bfe_u32 v18, v1, 4, 1
v_lshl_add_u32 v17, v18, 5, v17
v_lshl_add_u32 v17, v3, 3, v17
v_add_u32 v17, s45, v17
s_add_u32 m0, s45, 0
s_add_u32 s44, s56, 0
s_and_b32 s44, s44, 511
s_lshl_b32 s44, s44, 11
buffer_load_dwordx4 v16, s[4:7], s44 offen lds
s_add_u32 m0, s45, 1024
s_add_u32 s44, s56, 8
s_and_b32 s44, s44, 511
s_lshl_b32 s44, s44, 11
buffer_load_dwordx4 v16, s[4:7], s44 offen lds
s_add_u32 m0, s45, 2048
s_add_u32 s44, s56, 16
s_and_b32 s44, s44, 511
s_lshl_b32 s44, s44, 11
buffer_load_dwordx4 v16, s[4:7], s44 offen lds
s_add_u32 m0, s45, 3072
s_add_u32 s44, s56, 24
s_and_b32 s44, s44, 511
s_lshl_b32 s44, s44, 11
buffer_load_dwordx4 v16, s[4:7], s44 offen lds
s_add_u32 m0, s45, 4096
s_add_u32 s44, s56, 32
s_and_b32 s44, s44, 511
s_lshl_b32 s44, s44, 11
buffer_load_dwordx4 v16, s[4:7], s44 offen lds
s_add_u32 m0, s45, 5120
s_add_u32 s44, s56, 40
s_and_b32 s44, s44, 511
s_lshl_b32 s44, s44, 11
buffer_load_dwordx4 v16, s[4:7], s44 offen lds
s_add_u32 m0, s45, 6144
s_add_u32 s44, s56, 48
s_and_b32 s44, s44, 511
s_lshl_b32 s44, s44, 11
buffer_load_dwordx4 v16, s[4:7], s44 offen lds
s_add_u32 m0, s45, 7168
s_add_u32 s44, s56, 56
s_and_b32 s44, s44, 511
s_lshl_b32 s44, s44, 11
buffer_load_dwordx4 v16, s[4:7], s44 offen lds
s_add_u32 m0, s45, 8192
s_add_u32 s44, s56, 64
s_and_b32 s44, s44, 511
s_lshl_b32 s44, s44, 11
buffer_load_dwordx4 v16, s[4:7], s44 offen lds
s_add_u32 m0, s45, 9216
s_add_u32 s44, s56, 72
s_and_b32 s44, s44, 511
s_lshl_b32 s44, s44, 11
buffer_load_dwordx4 v16, s[4:7], s44 offen lds
s_add_u32 m0, s45, 10240
s_add_u32 s44, s56, 80
s_and_b32 s44, s44, 511
s_lshl_b32 s44, s44, 11
buffer_load_dwordx4 v16, s[4:7], s44 offen lds
s_add_u32 m0, s45, 11264
s_add_u32 s44, s56, 88
s_and_b32 s44, s44, 511
s_lshl_b32 s44, s44, 11
buffer_load_dwordx4 v16, s[4:7], s44 offen lds
s_add_u32 m0, s45, 12288
s_add_u32 s44, s56, 96
s_and_b32 s44, s44, 511
s_lshl_b32 s44, s44, 11
buffer_load_dwordx4 v16, s[4:7], s44 offen lds
s_add_u32 m0, s45, 13312
s_add_u32 s44, s56, 104
s_and_b32 s44, s44, 511
s_lshl_b32 s44, s44, 11
buffer_load_dwordx4 v16, s[4:7], s44 offen lds
s_add_u32 m0, s45, 14336
s_add_u32 s44, s56, 112
s_and_b32 s44, s44, 511
s_lshl_b32 s44, s44, 11
buffer_load_dwordx4 v16, s[4:7], s44 offen lds
s_add_u32 m0, s45, 15360
s_add_u32 s44, s56, 120
s_and_b32 s44, s44, 511
s_lshl_b32 s44, s44, 11
buffer_load_dwordx4 v16, s[4:7], s44 offen lds
s_add_u32 m0, s45, 16384
s_add_u32 s44, s56, 128
s_and_b32 s44, s44, 511
s_lshl_b32 s44, s44, 11
buffer_load_dwordx4 v16, s[4:7], s44 offen lds
s_add_u32 m0, s45, 17408
s_add_u32 s44, s56, 136
s_and_b32 s44, s44, 511
s_lshl_b32 s44, s44, 11
buffer_load_dwordx4 v16, s[4:7], s44 offen lds
s_add_u32 m0, s45, 18432
s_add_u32 s44, s56, 144
s_and_b32 s44, s44, 511
s_lshl_b32 s44, s44, 11
buffer_load_dwordx4 v16, s[4:7], s44 offen lds
s_add_u32 m0, s45, 19456
s_add_u32 s44, s56, 152
s_and_b32 s44, s44, 511
s_lshl_b32 s44, s44, 11
buffer_load_dwordx4 v16, s[4:7], s44 offen lds
s_add_u32 m0, s45, 20480
s_add_u32 s44, s56, 160
s_and_b32 s44, s44, 511
s_lshl_b32 s44, s44, 11
buffer_load_dwordx4 v16, s[4:7], s44 offen lds
s_add_u32 m0, s45, 21504
s_add_u32 s44, s56, 168
s_and_b32 s44, s44, 511
s_lshl_b32 s44, s44, 11
buffer_load_dwordx4 v16, s[4:7], s44 offen lds
s_add_u32 m0, s45, 22528
s_add_u32 s44, s56, 176
s_and_b32 s44, s44, 511
s_lshl_b32 s44, s44, 11
buffer_load_dwordx4 v16, s[4:7], s44 offen lds
s_add_u32 m0, s45, 23552
s_add_u32 s44, s56, 184
s_and_b32 s44, s44, 511
s_lshl_b32 s44, s44, 11
buffer_load_dwordx4 v16, s[4:7], s44 offen lds
s_add_u32 m0, s45, 24576
s_add_u32 s44, s56, 192
s_and_b32 s44, s44, 511
s_lshl_b32 s44, s44, 11
buffer_load_dwordx4 v16, s[4:7], s44 offen lds
s_add_u32 m0, s45, 25600
s_add_u32 s44, s56, 200
s_and_b32 s44, s44, 511
s_lshl_b32 s44, s44, 11
buffer_load_dwordx4 v16, s[4:7], s44 offen lds
s_add_u32 m0, s45, 26624
s_add_u32 s44, s56, 208
s_and_b32 s44, s44, 511
s_lshl_b32 s44, s44, 11
buffer_load_dwordx4 v16, s[4:7], s44 offen lds
s_add_u32 m0, s45, 27648
s_add_u32 s44, s56, 216
s_and_b32 s44, s44, 511
s_lshl_b32 s44, s44, 11
buffer_load_dwordx4 v16, s[4:7], s44 offen lds
s_add_u32 m0, s45, 28672
s_add_u32 s44, s56, 224
s_and_b32 s44, s44, 511
s_lshl_b32 s44, s44, 11
buffer_load_dwordx4 v16, s[4:7], s44 offen lds
s_add_u32 m0, s45, 29696
s_add_u32 s44, s56, 232
s_and_b32 s44, s44, 511
s_lshl_b32 s44, s44, 11
buffer_load_dwordx4 v16, s[4:7], s44 offen lds
s_add_u32 m0, s45, 30720
s_add_u32 s44, s56, 240
s_and_b32 s44, s44, 511
s_lshl_b32 s44, s44, 11
buffer_load_dwordx4 v16, s[4:7], s44 offen lds
s_add_u32 m0, s45, 31744
s_add_u32 s44, s56, 248
s_and_b32 s44, s44, 511
s_lshl_b32 s44, s44, 11
buffer_load_dwordx4 v16, s[4:7], s44 offen lds
s_waitcnt vmcnt(16)
ds_read_b64_tr_b16 a[0:1], v17 offset:0
ds_read_b64_tr_b16 a[2:3], v17 offset:2048
ds_read_b64_tr_b16 a[4:5], v17 offset:64
ds_read_b64_tr_b16 a[6:7], v17 offset:2112
ds_read_b64_tr_b16 a[8:9], v17 offset:1024
ds_read_b64_tr_b16 a[10:11], v17 offset:3072
ds_read_b64_tr_b16 a[12:13], v17 offset:1088
ds_read_b64_tr_b16 a[14:15], v17 offset:3136
s_waitcnt lgkmcnt(0)
ds_read_b64_tr_b16 a[16:17], v17 offset:4096
ds_read_b64_tr_b16 a[18:19], v17 offset:6144
ds_read_b64_tr_b16 a[20:21], v17 offset:4160
ds_read_b64_tr_b16 a[22:23], v17 offset:6208
ds_read_b64_tr_b16 a[24:25], v17 offset:5120
ds_read_b64_tr_b16 a[26:27], v17 offset:7168
ds_read_b64_tr_b16 a[28:29], v17 offset:5184
ds_read_b64_tr_b16 a[30:31], v17 offset:7232
s_waitcnt lgkmcnt(0)
ds_read_b64_tr_b16 a[32:33], v17 offset:8192
ds_read_b64_tr_b16 a[34:35], v17 offset:10240
ds_read_b64_tr_b16 a[36:37], v17 offset:8256
ds_read_b64_tr_b16 a[38:39], v17 offset:10304
ds_read_b64_tr_b16 a[40:41], v17 offset:9216
ds_read_b64_tr_b16 a[42:43], v17 offset:11264
ds_read_b64_tr_b16 a[44:45], v17 offset:9280
ds_read_b64_tr_b16 a[46:47], v17 offset:11328
s_waitcnt lgkmcnt(0)
ds_read_b64_tr_b16 a[48:49], v17 offset:12288
ds_read_b64_tr_b16 a[50:51], v17 offset:14336
ds_read_b64_tr_b16 a[52:53], v17 offset:12352
ds_read_b64_tr_b16 a[54:55], v17 offset:14400
ds_read_b64_tr_b16 a[56:57], v17 offset:13312
ds_read_b64_tr_b16 a[58:59], v17 offset:15360
ds_read_b64_tr_b16 a[60:61], v17 offset:13376
ds_read_b64_tr_b16 a[62:63], v17 offset:15424
s_waitcnt lgkmcnt(0)
s_add_u32 m0, s45, 0
s_add_u32 s44, s56, 256
s_and_b32 s44, s44, 511
s_lshl_b32 s44, s44, 11
buffer_load_dwordx4 v16, s[4:7], s44 offen lds
s_add_u32 m0, s45, 1024
s_add_u32 s44, s56, 264
s_and_b32 s44, s44, 511
s_lshl_b32 s44, s44, 11
buffer_load_dwordx4 v16, s[4:7], s44 offen lds
s_add_u32 m0, s45, 2048
s_add_u32 s44, s56, 272
s_and_b32 s44, s44, 511
s_lshl_b32 s44, s44, 11
buffer_load_dwordx4 v16, s[4:7], s44 offen lds
s_add_u32 m0, s45, 3072
s_add_u32 s44, s56, 280
s_and_b32 s44, s44, 511
s_lshl_b32 s44, s44, 11
buffer_load_dwordx4 v16, s[4:7], s44 offen lds
s_add_u32 m0, s45, 4096
s_add_u32 s44, s56, 288
s_and_b32 s44, s44, 511
s_lshl_b32 s44, s44, 11
buffer_load_dwordx4 v16, s[4:7], s44 offen lds
s_add_u32 m0, s45, 5120
s_add_u32 s44, s56, 296
s_and_b32 s44, s44, 511
s_lshl_b32 s44, s44, 11
buffer_load_dwordx4 v16, s[4:7], s44 offen lds
s_add_u32 m0, s45, 6144
s_add_u32 s44, s56, 304
s_and_b32 s44, s44, 511
s_lshl_b32 s44, s44, 11
buffer_load_dwordx4 v16, s[4:7], s44 offen lds
s_add_u32 m0, s45, 7168
s_add_u32 s44, s56, 312
s_and_b32 s44, s44, 511
s_lshl_b32 s44, s44, 11
buffer_load_dwordx4 v16, s[4:7], s44 offen lds
s_add_u32 m0, s45, 8192
s_add_u32 s44, s56, 320
s_and_b32 s44, s44, 511
s_lshl_b32 s44, s44, 11
buffer_load_dwordx4 v16, s[4:7], s44 offen lds
s_add_u32 m0, s45, 9216
s_add_u32 s44, s56, 328
s_and_b32 s44, s44, 511
s_lshl_b32 s44, s44, 11
buffer_load_dwordx4 v16, s[4:7], s44 offen lds
s_add_u32 m0, s45, 10240
s_add_u32 s44, s56, 336
s_and_b32 s44, s44, 511
s_lshl_b32 s44, s44, 11
buffer_load_dwordx4 v16, s[4:7], s44 offen lds
s_add_u32 m0, s45, 11264
s_add_u32 s44, s56, 344
s_and_b32 s44, s44, 511
s_lshl_b32 s44, s44, 11
buffer_load_dwordx4 v16, s[4:7], s44 offen lds
s_add_u32 m0, s45, 12288
s_add_u32 s44, s56, 352
s_and_b32 s44, s44, 511
s_lshl_b32 s44, s44, 11
buffer_load_dwordx4 v16, s[4:7], s44 offen lds
s_add_u32 m0, s45, 13312
s_add_u32 s44, s56, 360
s_and_b32 s44, s44, 511
s_lshl_b32 s44, s44, 11
buffer_load_dwordx4 v16, s[4:7], s44 offen lds
s_add_u32 m0, s45, 14336
s_add_u32 s44, s56, 368
s_and_b32 s44, s44, 511
s_lshl_b32 s44, s44, 11
buffer_load_dwordx4 v16, s[4:7], s44 offen lds
s_add_u32 m0, s45, 15360
s_add_u32 s44, s56, 376
s_and_b32 s44, s44, 511
s_lshl_b32 s44, s44, 11
buffer_load_dwordx4 v16, s[4:7], s44 offen lds
s_waitcnt vmcnt(16)
ds_read_b64_tr_b16 a[64:65], v17 offset:16384
ds_read_b64_tr_b16 a[66:67], v17 offset:18432
ds_read_b64_tr_b16 a[68:69], v17 offset:16448
ds_read_b64_tr_b16 a[70:71], v17 offset:18496
ds_read_b64_tr_b16 a[72:73], v17 offset:17408
ds_read_b64_tr_b16 a[74:75], v17 offset:19456
ds_read_b64_tr_b16 a[76:77], v17 offset:17472
ds_read_b64_tr_b16 a[78:79], v17 offset:19520
s_waitcnt lgkmcnt(0)
ds_read_b64_tr_b16 a[80:81], v17 offset:20480
ds_read_b64_tr_b16 a[82:83], v17 offset:22528
ds_read_b64_tr_b16 a[84:85], v17 offset:20544
ds_read_b64_tr_b16 a[86:87], v17 offset:22592
ds_read_b64_tr_b16 a[88:89], v17 offset:21504
ds_read_b64_tr_b16 a[90:91], v17 offset:23552
ds_read_b64_tr_b16 a[92:93], v17 offset:21568
ds_read_b64_tr_b16 a[94:95], v17 offset:23616
s_waitcnt lgkmcnt(0)
ds_read_b64_tr_b16 a[96:97], v17 offset:24576
ds_read_b64_tr_b16 a[98:99], v17 offset:26624
ds_read_b64_tr_b16 a[100:101], v17 offset:24640
ds_read_b64_tr_b16 a[102:103], v17 offset:26688
ds_read_b64_tr_b16 a[104:105], v17 offset:25600
ds_read_b64_tr_b16 a[106:107], v17 offset:27648
ds_read_b64_tr_b16 a[108:109], v17 offset:25664
ds_read_b64_tr_b16 a[110:111], v17 offset:27712
s_waitcnt lgkmcnt(0)
ds_read_b64_tr_b16 a[112:113], v17 offset:28672
ds_read_b64_tr_b16 a[114:115], v17 offset:30720
ds_read_b64_tr_b16 a[116:117], v17 offset:28736
ds_read_b64_tr_b16 a[118:119], v17 offset:30784
ds_read_b64_tr_b16 a[120:121], v17 offset:29696
ds_read_b64_tr_b16 a[122:123], v17 offset:31744
ds_read_b64_tr_b16 a[124:125], v17 offset:29760
ds_read_b64_tr_b16 a[126:127], v17 offset:31808
s_waitcnt lgkmcnt(0)
s_add_u32 m0, s45, 16384
s_add_u32 s44, s56, 384
s_and_b32 s44, s44, 511
s_lshl_b32 s44, s44, 11
buffer_load_dwordx4 v16, s[4:7], s44 offen lds
s_add_u32 m0, s45, 17408
s_add_u32 s44, s56, 392
s_and_b32 s44, s44, 511
s_lshl_b32 s44, s44, 11
buffer_load_dwordx4 v16, s[4:7], s44 offen lds
s_add_u32 m0, s45, 18432
s_add_u32 s44, s56, 400
s_and_b32 s44, s44, 511
s_lshl_b32 s44, s44, 11
buffer_load_dwordx4 v16, s[4:7], s44 offen lds
s_add_u32 m0, s45, 19456
s_add_u32 s44, s56, 408
s_and_b32 s44, s44, 511
s_lshl_b32 s44, s44, 11
buffer_load_dwordx4 v16, s[4:7], s44 offen lds
s_add_u32 m0, s45, 20480
s_add_u32 s44, s56, 416
s_and_b32 s44, s44, 511
s_lshl_b32 s44, s44, 11
buffer_load_dwordx4 v16, s[4:7], s44 offen lds
s_add_u32 m0, s45, 21504
s_add_u32 s44, s56, 424
s_and_b32 s44, s44, 511
s_lshl_b32 s44, s44, 11
buffer_load_dwordx4 v16, s[4:7], s44 offen lds
s_add_u32 m0, s45, 22528
s_add_u32 s44, s56, 432
s_and_b32 s44, s44, 511
s_lshl_b32 s44, s44, 11
buffer_load_dwordx4 v16, s[4:7], s44 offen lds
s_add_u32 m0, s45, 23552
s_add_u32 s44, s56, 440
s_and_b32 s44, s44, 511
s_lshl_b32 s44, s44, 11
buffer_load_dwordx4 v16, s[4:7], s44 offen lds
s_add_u32 m0, s45, 24576
s_add_u32 s44, s56, 448
s_and_b32 s44, s44, 511
s_lshl_b32 s44, s44, 11
buffer_load_dwordx4 v16, s[4:7], s44 offen lds
s_add_u32 m0, s45, 25600
s_add_u32 s44, s56, 456
s_and_b32 s44, s44, 511
s_lshl_b32 s44, s44, 11
buffer_load_dwordx4 v16, s[4:7], s44 offen lds
s_add_u32 m0, s45, 26624
s_add_u32 s44, s56, 464
s_and_b32 s44, s44, 511
s_lshl_b32 s44, s44, 11
buffer_load_dwordx4 v16, s[4:7], s44 offen lds
s_add_u32 m0, s45, 27648
s_add_u32 s44, s56, 472
s_and_b32 s44, s44, 511
s_lshl_b32 s44, s44, 11
buffer_load_dwordx4 v16, s[4:7], s44 offen lds
s_add_u32 m0, s45, 28672
s_add_u32 s44, s56, 480
s_and_b32 s44, s44, 511
s_lshl_b32 s44, s44, 11
buffer_load_dwordx4 v16, s[4:7], s44 offen lds
s_add_u32 m0, s45, 29696
s_add_u32 s44, s56, 488
s_and_b32 s44, s44, 511
s_lshl_b32 s44, s44, 11
buffer_load_dwordx4 v16, s[4:7], s44 offen lds
s_add_u32 m0, s45, 30720
s_add_u32 s44, s56, 496
s_and_b32 s44, s44, 511
s_lshl_b32 s44, s44, 11
buffer_load_dwordx4 v16, s[4:7], s44 offen lds
s_add_u32 m0, s45, 31744
s_add_u32 s44, s56, 504
s_and_b32 s44, s44, 511
s_lshl_b32 s44, s44, 11
buffer_load_dwordx4 v16, s[4:7], s44 offen lds
s_waitcnt vmcnt(16)
ds_read_b64_tr_b16 a[128:129], v17 offset:0
ds_read_b64_tr_b16 a[130:131], v17 offset:2048
ds_read_b64_tr_b16 a[132:133], v17 offset:64
ds_read_b64_tr_b16 a[134:135], v17 offset:2112
ds_read_b64_tr_b16 a[136:137], v17 offset:1024
ds_read_b64_tr_b16 a[138:139], v17 offset:3072
ds_read_b64_tr_b16 a[140:141], v17 offset:1088
ds_read_b64_tr_b16 a[142:143], v17 offset:3136
s_waitcnt lgkmcnt(0)
ds_read_b64_tr_b16 a[144:145], v17 offset:4096
ds_read_b64_tr_b16 a[146:147], v17 offset:6144
ds_read_b64_tr_b16 a[148:149], v17 offset:4160
ds_read_b64_tr_b16 a[150:151], v17 offset:6208
ds_read_b64_tr_b16 a[152:153], v17 offset:5120
ds_read_b64_tr_b16 a[154:155], v17 offset:7168
ds_read_b64_tr_b16 a[156:157], v17 offset:5184
ds_read_b64_tr_b16 a[158:159], v17 offset:7232
s_waitcnt lgkmcnt(0)
ds_read_b64_tr_b16 a[160:161], v17 offset:8192
ds_read_b64_tr_b16 a[162:163], v17 offset:10240
ds_read_b64_tr_b16 a[164:165], v17 offset:8256
ds_read_b64_tr_b16 a[166:167], v17 offset:10304
ds_read_b64_tr_b16 a[168:169], v17 offset:9216
ds_read_b64_tr_b16 a[170:171], v17 offset:11264
ds_read_b64_tr_b16 a[172:173], v17 offset:9280
ds_read_b64_tr_b16 a[174:175], v17 offset:11328
s_waitcnt lgkmcnt(0)
ds_read_b64_tr_b16 a[176:177], v17 offset:12288
ds_read_b64_tr_b16 a[178:179], v17 offset:14336
ds_read_b64_tr_b16 a[180:181], v17 offset:12352
ds_read_b64_tr_b16 a[182:183], v17 offset:14400
ds_read_b64_tr_b16 a[184:185], v17 offset:13312
ds_read_b64_tr_b16 a[186:187], v17 offset:15360
ds_read_b64_tr_b16 a[188:189], v17 offset:13376
ds_read_b64_tr_b16 a[190:191], v17 offset:15424
s_waitcnt lgkmcnt(0)
s_waitcnt vmcnt(0)
ds_read_b64_tr_b16 a[192:193], v17 offset:16384
ds_read_b64_tr_b16 a[194:195], v17 offset:18432
ds_read_b64_tr_b16 a[196:197], v17 offset:16448
ds_read_b64_tr_b16 a[198:199], v17 offset:18496
ds_read_b64_tr_b16 a[200:201], v17 offset:17408
ds_read_b64_tr_b16 a[202:203], v17 offset:19456
ds_read_b64_tr_b16 a[204:205], v17 offset:17472
ds_read_b64_tr_b16 a[206:207], v17 offset:19520
s_waitcnt lgkmcnt(0)
ds_read_b64_tr_b16 a[208:209], v17 offset:20480
ds_read_b64_tr_b16 a[210:211], v17 offset:22528
ds_read_b64_tr_b16 a[212:213], v17 offset:20544
ds_read_b64_tr_b16 a[214:215], v17 offset:22592
ds_read_b64_tr_b16 a[216:217], v17 offset:21504
ds_read_b64_tr_b16 a[218:219], v17 offset:23552
ds_read_b64_tr_b16 a[220:221], v17 offset:21568
ds_read_b64_tr_b16 a[222:223], v17 offset:23616
s_waitcnt lgkmcnt(0)
ds_read_b64_tr_b16 a[224:225], v17 offset:24576
ds_read_b64_tr_b16 a[226:227], v17 offset:26624
ds_read_b64_tr_b16 a[228:229], v17 offset:24640
ds_read_b64_tr_b16 a[230:231], v17 offset:26688
ds_read_b64_tr_b16 a[232:233], v17 offset:25600
ds_read_b64_tr_b16 a[234:235], v17 offset:27648
ds_read_b64_tr_b16 a[236:237], v17 offset:25664
ds_read_b64_tr_b16 a[238:239], v17 offset:27712
s_waitcnt lgkmcnt(0)
ds_read_b64_tr_b16 a[240:241], v17 offset:28672
ds_read_b64_tr_b16 a[242:243], v17 offset:30720
ds_read_b64_tr_b16 a[244:245], v17 offset:28736
ds_read_b64_tr_b16 a[246:247], v17 offset:30784
ds_read_b64_tr_b16 a[248:249], v17 offset:29696
ds_read_b64_tr_b16 a[250:251], v17 offset:31744
ds_read_b64_tr_b16 a[252:253], v17 offset:29760
ds_read_b64_tr_b16 a[254:255], v17 offset:31808
s_waitcnt lgkmcnt(0)
s_barrier
s_cmp_eq_u32 s68, 1
s_cbranch_scc1 mega_kernel_back
mega_kernel_o_hw:
s_lshl_b32 s56, s56, 6
s_lshl_b32 s43, s58, 17
s_lshl_b32 s44, s41, 15
s_add_u32 s43, s43, s44
s_add_u32 s43, s43, 134217728
v_add_u32 v6, s43, v5
v_and_b32 v2, 3, v1
v_lshlrev_b32 v7, 2, v2
v_bfe_u32 v2, v1, 2, 2
v_lshl_add_u32 v7, v2, 7, v7
s_lshl_b32 s43, s58, 11
s_lshl_b32 s44, s41, 9
s_add_u32 s43, s43, s44
s_lshl_b32 s44, s98, 13
s_add_u32 s43, s43, s44
s_add_u32 s43, s43, 69255168
v_add_u32 v7, s43, v7
s_mul_i32 s43, s41, 8704
v_lshrrev_b32 v2, 5, v1
v_lshl_add_u32 v8, v2, 5, v5
v_add_u32 v8, s43, v8
v_and_b32 v2, 7, v1
v_mul_u32_u24 v9, 544, v2
v_lshrrev_b32 v3, 3, v1
v_lshl_add_u32 v9, v3, 4, v9
s_lshl_b32 s43, s41, 7
v_add_u32 v9, s43, v9
s_mul_i32 s43, s58, 4352
s_sub_u32 s44, 4352, s43
v_add_u32 v10, s44, v9
v_add_u32 v9, s43, v9
s_lshl_b32 s43, s41, 15
s_lshl_b32 s44, s40, 6
s_add_u32 s43, s43, s44
v_lshlrev_b32 v11, 12, v3
v_and_b32 v2, 7, v1
v_lshl_add_u32 v11, v2, 3, v11
v_add_u32 v11, s43, v11
s_lshl_b32 s44, s41, 10
s_add_u32 s43, s66, s44
v_add_u32 v13, s43, v5
v_xor_b32 v12, 8192, v13
s_lshl_b32 s71, 1, s67
s_mov_b32 s42, s64
s_mov_b32 s52, 0
s_mov_b32 s53, 0
s_mov_b32 s57, 0
mega_kernel_o_cold:
s_cmp_gt_i32 s52, s42
s_cbranch_scc1 mega_kernel_o_fk
mega_kernel_o_fw:
buffer_load_dword v2, v7, s[84:87], 0 offen sc1
s_waitcnt vmcnt(0)
v_min_i32_dpp v2, v2, v2 quad_perm:[1,0,3,2] row_mask:0xf bank_mask:0xf
s_nop 1
v_min_i32_dpp v2, v2, v2 quad_perm:[2,3,0,1] row_mask:0xf bank_mask:0xf
s_nop 1
v_min_i32_dpp v2, v2, v2 row_ror:4 row_mask:0xf bank_mask:0xf
s_nop 1
v_min_i32_dpp v2, v2, v2 row_ror:8 row_mask:0xf bank_mask:0xf
s_nop 0
v_readfirstlane_b32 s52, v2
s_min_i32 s52, s52, s65
s_cmp_gt_i32 s52, s42
s_cbranch_scc1 mega_kernel_o_fk
s_sleep 2
s_add_u32 s43, s52, 2
s_cmp_gt_i32 s43, s42
s_cbranch_scc1 mega_kernel_o_fw
s_sleep 48
s_branch mega_kernel_o_fw
mega_kernel_o_fk:
s_add_u32 s54, s42, s71
s_cmp_gt_i32 s52, s54
s_cbranch_scc0 mega_kernel_o_c0
s_lshl_b32 s50, s42, 18
s_add_u32 s51, s56, 0
s_and_b32 s51, s51, 0x7fff
s_add_u32 s51, s51, s50
buffer_load_dwordx4 v[96:99], v6, s[84:87], s51 offen offset:0 sc1
buffer_load_dwordx4 v[100:103], v6, s[84:87], s51 offen offset:1024 sc1
buffer_load_dwordx4 v[104:107], v6, s[84:87], s51 offen offset:2048 sc1
buffer_load_dwordx4 v[108:111], v6, s[84:87], s51 offen offset:3072 sc1
s_add_u32 s51, s56, 4096
s_and_b32 s51, s51, 0x7fff
s_add_u32 s51, s51, s50
buffer_load_dwordx4 v[112:115], v6, s[84:87], s51 offen offset:0 sc1
buffer_load_dwordx4 v[116:119], v6, s[84:87], s51 offen offset:1024 sc1
buffer_load_dwordx4 v[120:123], v6, s[84:87], s51 offen offset:2048 sc1
buffer_load_dwordx4 v[124:127], v6, s[84:87], s51 offen offset:3072 sc1
s_add_u32 s51, s56, 8192
s_and_b32 s51, s51, 0x7fff
s_add_u32 s51, s51, s50
buffer_load_dwordx4 v[128:131], v6, s[84:87], s51 offen offset:0 sc1
buffer_load_dwordx4 v[132:135], v6, s[84:87], s51 offen offset:1024 sc1
buffer_load_dwordx4 v[136:139], v6, s[84:87], s51 offen offset:2048 sc1
buffer_load_dwordx4 v[140:143], v6, s[84:87], s51 offen offset:3072 sc1
s_add_u32 s51, s56, 12288
s_and_b32 s51, s51, 0x7fff
s_add_u32 s51, s51, s50
buffer_load_dwordx4 v[144:147], v6, s[84:87], s51 offen offset:0 sc1
buffer_load_dwordx4 v[148:151], v6, s[84:87], s51 offen offset:1024 sc1
buffer_load_dwordx4 v[152:155], v6, s[84:87], s51 offen offset:2048 sc1
buffer_load_dwordx4 v[156:159], v6, s[84:87], s51 offen offset:3072 sc1
s_add_u32 s51, s56, 16384
s_and_b32 s51, s51, 0x7fff
s_add_u32 s51, s51, s50
buffer_load_dwordx4 v[160:163], v6, s[84:87], s51 offen offset:0 sc1
buffer_load_dwordx4 v[164:167], v6, s[84:87], s51 offen offset:1024 sc1
buffer_load_dwordx4 v[168:171], v6, s[84:87], s51 offen offset:2048 sc1
buffer_load_dwordx4 v[172:175], v6, s[84:87], s51 offen offset:3072 sc1
s_add_u32 s51, s56, 20480
s_and_b32 s51, s51, 0x7fff
s_add_u32 s51, s51, s50
buffer_load_dwordx4 v[176:179], v6, s[84:87], s51 offen offset:0 sc1
buffer_load_dwordx4 v[180:183], v6, s[84:87], s51 offen offset:1024 sc1
buffer_load_dwordx4 v[184:187], v6, s[84:87], s51 offen offset:2048 sc1
buffer_load_dwordx4 v[188:191], v6, s[84:87], s51 offen offset:3072 sc1
s_add_u32 s51, s56, 24576
s_and_b32 s51, s51, 0x7fff
s_add_u32 s51, s51, s50
buffer_load_dwordx4 v[192:195], v6, s[84:87], s51 offen offset:0 sc1
buffer_load_dwordx4 v[196:199], v6, s[84:87], s51 offen offset:1024 sc1
buffer_load_dwordx4 v[200:203], v6, s[84:87], s51 offen offset:2048 sc1
buffer_load_dwordx4 v[204:207], v6, s[84:87], s51 offen offset:3072 sc1
s_add_u32 s51, s56, 28672
s_and_b32 s51, s51, 0x7fff
s_add_u32 s51, s51, s50
buffer_load_dwordx4 v[208:211], v6, s[84:87], s51 offen offset:0 sc1
buffer_load_dwordx4 v[212:215], v6, s[84:87], s51 offen offset:1024 sc1
buffer_load_dwordx4 v[216:219], v6, s[84:87], s51 offen offset:2048 sc1
buffer_load_dwordx4 v[220:223], v6, s[84:87], s51 offen offset:3072 sc1
mega_kernel_o_w0:
s_add_u32 s54, s42, s71
s_sub_u32 s62, s42, s71
s_lshl_b32 s50, s54, 18
s_cmp_gt_i32 s52, s54
s_cbranch_scc0 mega_kernel_o_n0
s_waitcnt vmcnt(31)
v_mfma_f32_32x32x16_bf16 v[20:35], a[0:3], v[96:99], 0
v_mfma_f32_32x32x16_bf16 v[36:51], a[4:7], v[96:99], 0
s_add_u32 s51, s56, 0
s_and_b32 s51, s51, 0x7fff
s_add_u32 s51, s51, s50
buffer_load_dwordx4 v[96:99], v6, s[84:87], s51 offen offset:0 sc1
s_waitcnt vmcnt(31)
v_mfma_f32_32x32x16_bf16 v[20:35], a[8:11], v[100:103], v[20:35]
v_mfma_f32_32x32x16_bf16 v[36:51], a[12:15], v[100:103], v[36:51]
buffer_load_dwordx4 v[100:103], v6, s[84:87], s51 offen offset:1024 sc1
s_waitcnt vmcnt(31)
v_mfma_f32_32x32x16_bf16 v[20:35], a[16:19], v[104:107], v[20:35]
v_mfma_f32_32x32x16_bf16 v[36:51], a[20:23], v[104:107], v[36:51]
buffer_load_dwordx4 v[104:107], v6, s[84:87], s51 offen offset:2048 sc1
s_waitcnt vmcnt(31)
v_mfma_f32_32x32x16_bf16 v[20:35], a[24:27], v[108:111], v[20:35]
v_mfma_f32_32x32x16_bf16 v[36:51], a[28:31], v[108:111], v[36:51]
buffer_load_dwordx4 v[108:111], v6, s[84:87], s51 offen offset:3072 sc1
s_waitcnt vmcnt(31)
v_mfma_f32_32x32x16_bf16 v[20:35], a[32:35], v[112:115], v[20:35]
v_mfma_f32_32x32x16_bf16 v[36:51], a[36:39], v[112:115], v[36:51]
s_add_u32 s51, s56, 4096
s_and_b32 s51, s51, 0x7fff
s_add_u32 s51, s51, s50
buffer_load_dwordx4 v[112:115], v6, s[84:87], s51 offen offset:0 sc1
s_waitcnt vmcnt(31)
v_mfma_f32_32x32x16_bf16 v[20:35], a[40:43], v[116:119], v[20:35]
v_mfma_f32_32x32x16_bf16 v[36:51], a[44:47], v[116:119], v[36:51]
buffer_load_dwordx4 v[116:119], v6, s[84:87], s51 offen offset:1024 sc1
s_waitcnt vmcnt(31)
v_mfma_f32_32x32x16_bf16 v[20:35], a[48:51], v[120:123], v[20:35]
v_mfma_f32_32x32x16_bf16 v[36:51], a[52:55], v[120:123], v[36:51]
buffer_load_dwordx4 v[120:123], v6, s[84:87], s51 offen offset:2048 sc1
s_waitcnt vmcnt(31)
v_mfma_f32_32x32x16_bf16 v[20:35], a[56:59], v[124:127], v[20:35]
v_mfma_f32_32x32x16_bf16 v[36:51], a[60:63], v[124:127], v[36:51]
buffer_load_dwordx4 v[124:127], v6, s[84:87], s51 offen offset:3072 sc1
s_waitcnt vmcnt(31)
v_mfma_f32_32x32x16_bf16 v[20:35], a[64:67], v[128:131], v[20:35]
v_mfma_f32_32x32x16_bf16 v[36:51], a[68:71], v[128:131], v[36:51]
s_add_u32 s51, s56, 8192
s_and_b32 s51, s51, 0x7fff
s_add_u32 s51, s51, s50
buffer_load_dwordx4 v[128:131], v6, s[84:87], s51 offen offset:0 sc1
s_waitcnt vmcnt(31)
v_mfma_f32_32x32x16_bf16 v[20:35], a[72:75], v[132:135], v[20:35]
v_mfma_f32_32x32x16_bf16 v[36:51], a[76:79], v[132:135], v[36:51]
buffer_load_dwordx4 v[132:135], v6, s[84:87], s51 offen offset:1024 sc1
s_waitcnt vmcnt(31)
v_mfma_f32_32x32x16_bf16 v[20:35], a[80:83], v[136:139], v[20:35]
v_mfma_f32_32x32x16_bf16 v[36:51], a[84:87], v[136:139], v[36:51]
buffer_load_dwordx4 v[136:139], v6, s[84:87], s51 offen offset:2048 sc1
s_waitcnt vmcnt(31)
v_mfma_f32_32x32x16_bf16 v[20:35], a[88:91], v[140:143], v[20:35]
v_mfma_f32_32x32x16_bf16 v[36:51], a[92:95], v[140:143], v[36:51]
buffer_load_dwordx4 v[140:143], v6, s[84:87], s51 offen offset:3072 sc1
s_waitcnt vmcnt(31)
v_mfma_f32_32x32x16_bf16 v[20:35], a[96:99], v[144:147], v[20:35]
v_mfma_f32_32x32x16_bf16 v[36:51], a[100:103], v[144:147], v[36:51]
s_add_u32 s51, s56, 12288
s_and_b32 s51, s51, 0x7fff
s_add_u32 s51, s51, s50
buffer_load_dwordx4 v[144:147], v6, s[84:87], s51 offen offset:0 sc1
s_waitcnt vmcnt(31)
v_mfma_f32_32x32x16_bf16 v[20:35], a[104:107], v[148:151], v[20:35]
v_mfma_f32_32x32x16_bf16 v[36:51], a[108:111], v[148:151], v[36:51]
buffer_load_dwordx4 v[148:151], v6, s[84:87], s51 offen offset:1024 sc1
s_waitcnt vmcnt(31)
v_mfma_f32_32x32x16_bf16 v[20:35], a[112:115], v[152:155], v[20:35]
v_mfma_f32_32x32x16_bf16 v[36:51], a[116:119], v[152:155], v[36:51]
buffer_load_dwordx4 v[152:155], v6, s[84:87], s51 offen offset:2048 sc1
s_waitcnt vmcnt(31)
v_mfma_f32_32x32x16_bf16 v[20:35], a[120:123], v[156:159], v[20:35]
v_mfma_f32_32x32x16_bf16 v[36:51], a[124:127], v[156:159], v[36:51]
buffer_load_dwordx4 v[156:159], v6, s[84:87], s51 offen offset:3072 sc1
s_waitcnt vmcnt(31)
v_mfma_f32_32x32x16_bf16 v[20:35], a[128:131], v[160:163], v[20:35]
v_mfma_f32_32x32x16_bf16 v[36:51], a[132:135], v[160:163], v[36:51]
s_add_u32 s51, s56, 16384
s_and_b32 s51, s51, 0x7fff
s_add_u32 s51, s51, s50
buffer_load_dwordx4 v[160:163], v6, s[84:87], s51 offen offset:0 sc1
s_waitcnt vmcnt(31)
v_mfma_f32_32x32x16_bf16 v[20:35], a[136:139], v[164:167], v[20:35]
v_mfma_f32_32x32x16_bf16 v[36:51], a[140:143], v[164:167], v[36:51]
buffer_load_dwordx4 v[164:167], v6, s[84:87], s51 offen offset:1024 sc1
s_waitcnt vmcnt(31)
v_mfma_f32_32x32x16_bf16 v[20:35], a[144:147], v[168:171], v[20:35]
v_mfma_f32_32x32x16_bf16 v[36:51], a[148:151], v[168:171], v[36:51]
buffer_load_dwordx4 v[168:171], v6, s[84:87], s51 offen offset:2048 sc1
s_waitcnt vmcnt(31)
v_mfma_f32_32x32x16_bf16 v[20:35], a[152:155], v[172:175], v[20:35]
v_mfma_f32_32x32x16_bf16 v[36:51], a[156:159], v[172:175], v[36:51]
buffer_load_dwordx4 v[172:175], v6, s[84:87], s51 offen offset:3072 sc1
s_waitcnt vmcnt(31)
v_mfma_f32_32x32x16_bf16 v[20:35], a[160:163], v[176:179], v[20:35]
v_mfma_f32_32x32x16_bf16 v[36:51], a[164:167], v[176:179], v[36:51]
s_add_u32 s51, s56, 20480
s_and_b32 s51, s51, 0x7fff
s_add_u32 s51, s51, s50
buffer_load_dwordx4 v[176:179], v6, s[84:87], s51 offen offset:0 sc1
s_waitcnt vmcnt(31)
v_mfma_f32_32x32x16_bf16 v[20:35], a[168:171], v[180:183], v[20:35]
v_mfma_f32_32x32x16_bf16 v[36:51], a[172:175], v[180:183], v[36:51]
buffer_load_dwordx4 v[180:183], v6, s[84:87], s51 offen offset:1024 sc1
s_waitcnt vmcnt(31)
v_mfma_f32_32x32x16_bf16 v[20:35], a[176:179], v[184:187], v[20:35]
v_mfma_f32_32x32x16_bf16 v[36:51], a[180:183], v[184:187], v[36:51]
buffer_load_dwordx4 v[184:187], v6, s[84:87], s51 offen offset:2048 sc1
s_waitcnt vmcnt(31)
v_mfma_f32_32x32x16_bf16 v[20:35], a[184:187], v[188:191], v[20:35]
v_mfma_f32_32x32x16_bf16 v[36:51], a[188:191], v[188:191], v[36:51]
buffer_load_dwordx4 v[188:191], v6, s[84:87], s51 offen offset:3072 sc1
s_waitcnt vmcnt(31)
v_mfma_f32_32x32x16_bf16 v[20:35], a[192:195], v[192:195], v[20:35]
v_mfma_f32_32x32x16_bf16 v[36:51], a[196:199], v[192:195], v[36:51]
s_add_u32 s51, s56, 24576
s_and_b32 s51, s51, 0x7fff
s_add_u32 s51, s51, s50
buffer_load_dwordx4 v[192:195], v6, s[84:87], s51 offen offset:0 sc1
s_waitcnt vmcnt(31)
v_mfma_f32_32x32x16_bf16 v[20:35], a[200:203], v[196:199], v[20:35]
v_mfma_f32_32x32x16_bf16 v[36:51], a[204:207], v[196:199], v[36:51]
buffer_load_dwordx4 v[196:199], v6, s[84:87], s51 offen offset:1024 sc1
s_waitcnt vmcnt(31)
v_mfma_f32_32x32x16_bf16 v[20:35], a[208:211], v[200:203], v[20:35]
v_mfma_f32_32x32x16_bf16 v[36:51], a[212:215], v[200:203], v[36:51]
buffer_load_dwordx4 v[200:203], v6, s[84:87], s51 offen offset:2048 sc1
s_waitcnt vmcnt(31)
v_mfma_f32_32x32x16_bf16 v[20:35], a[216:219], v[204:207], v[20:35]
v_mfma_f32_32x32x16_bf16 v[36:51], a[220:223], v[204:207], v[36:51]
buffer_load_dwordx4 v[204:207], v6, s[84:87], s51 offen offset:3072 sc1
s_waitcnt vmcnt(31)
v_mfma_f32_32x32x16_bf16 v[20:35], a[224:227], v[208:211], v[20:35]
v_mfma_f32_32x32x16_bf16 v[36:51], a[228:231], v[208:211], v[36:51]
s_add_u32 s51, s56, 28672
s_and_b32 s51, s51, 0x7fff
s_add_u32 s51, s51, s50
buffer_load_dwordx4 v[208:211], v6, s[84:87], s51 offen offset:0 sc1
s_waitcnt vmcnt(31)
v_mfma_f32_32x32x16_bf16 v[20:35], a[232:235], v[212:215], v[20:35]
v_mfma_f32_32x32x16_bf16 v[36:51], a[236:239], v[212:215], v[36:51]
buffer_load_dwordx4 v[212:215], v6, s[84:87], s51 offen offset:1024 sc1
s_waitcnt vmcnt(31)
v_mfma_f32_32x32x16_bf16 v[20:35], a[240:243], v[216:219], v[20:35]
v_mfma_f32_32x32x16_bf16 v[36:51], a[244:247], v[216:219], v[36:51]
buffer_load_dwordx4 v[216:219], v6, s[84:87], s51 offen offset:2048 sc1
s_waitcnt vmcnt(31)
v_mfma_f32_32x32x16_bf16 v[224:239], a[248:251], v[220:223], v[20:35]
v_mfma_f32_32x32x16_bf16 v[240:255], a[252:255], v[220:223], v[36:51]
buffer_load_dwordx4 v[220:223], v6, s[84:87], s51 offen offset:3072 sc1
s_add_u32 s42, s42, s71
s_branch mega_kernel_o_w1
mega_kernel_o_n0:
s_waitcnt vmcnt(31)
v_mfma_f32_32x32x16_bf16 v[20:35], a[0:3], v[96:99], 0
v_mfma_f32_32x32x16_bf16 v[36:51], a[4:7], v[96:99], 0
s_waitcnt vmcnt(30)
v_mfma_f32_32x32x16_bf16 v[20:35], a[8:11], v[100:103], v[20:35]
v_mfma_f32_32x32x16_bf16 v[36:51], a[12:15], v[100:103], v[36:51]
s_waitcnt vmcnt(29)
v_mfma_f32_32x32x16_bf16 v[20:35], a[16:19], v[104:107], v[20:35]
v_mfma_f32_32x32x16_bf16 v[36:51], a[20:23], v[104:107], v[36:51]
s_waitcnt vmcnt(28)
v_mfma_f32_32x32x16_bf16 v[20:35], a[24:27], v[108:111], v[20:35]
v_mfma_f32_32x32x16_bf16 v[36:51], a[28:31], v[108:111], v[36:51]
s_waitcnt vmcnt(27)
v_mfma_f32_32x32x16_bf16 v[20:35], a[32:35], v[112:115], v[20:35]
v_mfma_f32_32x32x16_bf16 v[36:51], a[36:39], v[112:115], v[36:51]
s_waitcnt vmcnt(26)
v_mfma_f32_32x32x16_bf16 v[20:35], a[40:43], v[116:119], v[20:35]
v_mfma_f32_32x32x16_bf16 v[36:51], a[44:47], v[116:119], v[36:51]
s_waitcnt vmcnt(25)
v_mfma_f32_32x32x16_bf16 v[20:35], a[48:51], v[120:123], v[20:35]
v_mfma_f32_32x32x16_bf16 v[36:51], a[52:55], v[120:123], v[36:51]
s_waitcnt vmcnt(24)
v_mfma_f32_32x32x16_bf16 v[20:35], a[56:59], v[124:127], v[20:35]
v_mfma_f32_32x32x16_bf16 v[36:51], a[60:63], v[124:127], v[36:51]
s_waitcnt vmcnt(23)
v_mfma_f32_32x32x16_bf16 v[20:35], a[64:67], v[128:131], v[20:35]
v_mfma_f32_32x32x16_bf16 v[36:51], a[68:71], v[128:131], v[36:51]
s_waitcnt vmcnt(22)
v_mfma_f32_32x32x16_bf16 v[20:35], a[72:75], v[132:135], v[20:35]
v_mfma_f32_32x32x16_bf16 v[36:51], a[76:79], v[132:135], v[36:51]
s_waitcnt vmcnt(21)
v_mfma_f32_32x32x16_bf16 v[20:35], a[80:83], v[136:139], v[20:35]
v_mfma_f32_32x32x16_bf16 v[36:51], a[84:87], v[136:139], v[36:51]
s_waitcnt vmcnt(20)
v_mfma_f32_32x32x16_bf16 v[20:35], a[88:91], v[140:143], v[20:35]
v_mfma_f32_32x32x16_bf16 v[36:51], a[92:95], v[140:143], v[36:51]
s_waitcnt vmcnt(19)
v_mfma_f32_32x32x16_bf16 v[20:35], a[96:99], v[144:147], v[20:35]
v_mfma_f32_32x32x16_bf16 v[36:51], a[100:103], v[144:147], v[36:51]
s_waitcnt vmcnt(18)
v_mfma_f32_32x32x16_bf16 v[20:35], a[104:107], v[148:151], v[20:35]
v_mfma_f32_32x32x16_bf16 v[36:51], a[108:111], v[148:151], v[36:51]
s_waitcnt vmcnt(17)
v_mfma_f32_32x32x16_bf16 v[20:35], a[112:115], v[152:155], v[20:35]
v_mfma_f32_32x32x16_bf16 v[36:51], a[116:119], v[152:155], v[36:51]
s_waitcnt vmcnt(16)
v_mfma_f32_32x32x16_bf16 v[20:35], a[120:123], v[156:159], v[20:35]
v_mfma_f32_32x32x16_bf16 v[36:51], a[124:127], v[156:159], v[36:51]
s_waitcnt vmcnt(15)
v_mfma_f32_32x32x16_bf16 v[20:35], a[128:131], v[160:163], v[20:35]
v_mfma_f32_32x32x16_bf16 v[36:51], a[132:135], v[160:163], v[36:51]
s_waitcnt vmcnt(14)
v_mfma_f32_32x32x16_bf16 v[20:35], a[136:139], v[164:167], v[20:35]
v_mfma_f32_32x32x16_bf16 v[36:51], a[140:143], v[164:167], v[36:51]
s_waitcnt vmcnt(13)
v_mfma_f32_32x32x16_bf16 v[20:35], a[144:147], v[168:171], v[20:35]
v_mfma_f32_32x32x16_bf16 v[36:51], a[148:151], v[168:171], v[36:51]
s_waitcnt vmcnt(12)
v_mfma_f32_32x32x16_bf16 v[20:35], a[152:155], v[172:175], v[20:35]
v_mfma_f32_32x32x16_bf16 v[36:51], a[156:159], v[172:175], v[36:51]
s_waitcnt vmcnt(11)
v_mfma_f32_32x32x16_bf16 v[20:35], a[160:163], v[176:179], v[20:35]
v_mfma_f32_32x32x16_bf16 v[36:51], a[164:167], v[176:179], v[36:51]
buffer_load_dword v15, v7, s[84:87], 0 offen sc1
s_waitcnt vmcnt(10)
v_mfma_f32_32x32x16_bf16 v[20:35], a[168:171], v[180:183], v[20:35]
v_mfma_f32_32x32x16_bf16 v[36:51], a[172:175], v[180:183], v[36:51]
s_waitcnt vmcnt(9)
v_mfma_f32_32x32x16_bf16 v[20:35], a[176:179], v[184:187], v[20:35]
v_mfma_f32_32x32x16_bf16 v[36:51], a[180:183], v[184:187], v[36:51]
s_waitcnt vmcnt(8)
v_mfma_f32_32x32x16_bf16 v[20:35], a[184:187], v[188:191], v[20:35]
v_mfma_f32_32x32x16_bf16 v[36:51], a[188:191], v[188:191], v[36:51]
s_waitcnt vmcnt(7)
v_mfma_f32_32x32x16_bf16 v[20:35], a[192:195], v[192:195], v[20:35]
v_mfma_f32_32x32x16_bf16 v[36:51], a[196:199], v[192:195], v[36:51]
s_waitcnt vmcnt(6)
v_mfma_f32_32x32x16_bf16 v[20:35], a[200:203], v[196:199], v[20:35]
v_mfma_f32_32x32x16_bf16 v[36:51], a[204:207], v[196:199], v[36:51]
s_waitcnt vmcnt(5)
v_mfma_f32_32x32x16_bf16 v[20:35], a[208:211], v[200:203], v[20:35]
v_mfma_f32_32x32x16_bf16 v[36:51], a[212:215], v[200:203], v[36:51]
s_waitcnt vmcnt(4)
v_mfma_f32_32x32x16_bf16 v[20:35], a[216:219], v[204:207], v[20:35]
v_mfma_f32_32x32x16_bf16 v[36:51], a[220:223], v[204:207], v[36:51]
s_waitcnt vmcnt(3)
v_mfma_f32_32x32x16_bf16 v[20:35], a[224:227], v[208:211], v[20:35]
v_mfma_f32_32x32x16_bf16 v[36:51], a[228:231], v[208:211], v[36:51]
s_waitcnt vmcnt(2)
v_mfma_f32_32x32x16_bf16 v[20:35], a[232:235], v[212:215], v[20:35]
v_mfma_f32_32x32x16_bf16 v[36:51], a[236:239], v[212:215], v[36:51]
s_waitcnt vmcnt(1)
v_mfma_f32_32x32x16_bf16 v[20:35], a[240:243], v[216:219], v[20:35]
v_mfma_f32_32x32x16_bf16 v[36:51], a[244:247], v[216:219], v[36:51]
s_waitcnt vmcnt(0)
v_mfma_f32_32x32x16_bf16 v[224:239], a[248:251], v[220:223], v[20:35]
v_mfma_f32_32x32x16_bf16 v[240:255], a[252:255], v[220:223], v[36:51]
s_branch mega_kernel_o_imm
mega_kernel_o_w1:
s_add_u32 s54, s42, s71
s_sub_u32 s62, s42, s71
s_lshl_b32 s50, s54, 18
s_cmp_gt_i32 s52, s54
s_cbranch_scc0 mega_kernel_o_n1
s_waitcnt vmcnt(31)
v_mfma_f32_32x32x16_bf16 v[20:35], a[0:3], v[96:99], 0
v_mfma_f32_32x32x16_bf16 v[36:51], a[4:7], v[96:99], 0
s_add_u32 s51, s56, 0
s_and_b32 s51, s51, 0x7fff
s_add_u32 s51, s51, s50
buffer_load_dwordx4 v[96:99], v6, s[84:87], s51 offen offset:0 sc1
s_waitcnt vmcnt(31)
v_mfma_f32_32x32x16_bf16 v[20:35], a[8:11], v[100:103], v[20:35]
v_mfma_f32_32x32x16_bf16 v[36:51], a[12:15], v[100:103], v[36:51]
buffer_load_dwordx4 v[100:103], v6, s[84:87], s51 offen offset:1024 sc1
v_add_u32 v2, s53, v8
v_add_u32 v3, s53, v9
v_add_u32 v4, s53, v10
s_waitcnt vmcnt(31)
v_mfma_f32_32x32x16_bf16 v[20:35], a[16:19], v[104:107], v[20:35]
v_mfma_f32_32x32x16_bf16 v[36:51], a[20:23], v[104:107], v[36:51]
buffer_load_dwordx4 v[104:107], v6, s[84:87], s51 offen offset:2048 sc1
ds_write_b128 v2, v[224:227] offset:0
ds_write_b128 v2, v[228:231] offset:1088
s_waitcnt vmcnt(31)
v_mfma_f32_32x32x16_bf16 v[20:35], a[24:27], v[108:111], v[20:35]
v_mfma_f32_32x32x16_bf16 v[36:51], a[28:31], v[108:111], v[36:51]
buffer_load_dwordx4 v[108:111], v6, s[84:87], s51 offen offset:3072 sc1
ds_write_b128 v2, v[232:235] offset:2176
ds_write_b128 v2, v[236:239] offset:3264
s_waitcnt vmcnt(31)
v_mfma_f32_32x32x16_bf16 v[20:35], a[32:35], v[112:115], v[20:35]
v_mfma_f32_32x32x16_bf16 v[36:51], a[36:39], v[112:115], v[36:51]
s_add_u32 s51, s56, 4096
s_and_b32 s51, s51, 0x7fff
s_add_u32 s51, s51, s50
buffer_load_dwordx4 v[112:115], v6, s[84:87], s51 offen offset:0 sc1
ds_write_b128 v2, v[240:243] offset:4352
ds_write_b128 v2, v[244:247] offset:5440
s_waitcnt vmcnt(31)
v_mfma_f32_32x32x16_bf16 v[20:35], a[40:43], v[116:119], v[20:35]
v_mfma_f32_32x32x16_bf16 v[36:51], a[44:47], v[116:119], v[36:51]
buffer_load_dwordx4 v[116:119], v6, s[84:87], s51 offen offset:1024 sc1
ds_write_b128 v2, v[248:251] offset:6528
ds_write_b128 v2, v[252:255] offset:7616
s_waitcnt vmcnt(31)
v_mfma_f32_32x32x16_bf16 v[20:35], a[48:51], v[120:123], v[20:35]
v_mfma_f32_32x32x16_bf16 v[36:51], a[52:55], v[120:123], v[36:51]
buffer_load_dwordx4 v[120:123], v6, s[84:87], s51 offen offset:2048 sc1
s_waitcnt vmcnt(31)
v_mfma_f32_32x32x16_bf16 v[20:35], a[56:59], v[124:127], v[20:35]
v_mfma_f32_32x32x16_bf16 v[36:51], a[60:63], v[124:127], v[36:51]
buffer_load_dwordx4 v[124:127], v6, s[84:87], s51 offen offset:3072 sc1
s_waitcnt lgkmcnt(0)
s_barrier
ds_read_b128 v[52:55], v4 offset:0
ds_read_b128 v[56:59], v4 offset:8704
ds_read_b128 v[60:63], v4 offset:17408
ds_read_b128 v[64:67], v4 offset:26112
s_waitcnt vmcnt(31)
v_mfma_f32_32x32x16_bf16 v[20:35], a[64:67], v[128:131], v[20:35]
v_mfma_f32_32x32x16_bf16 v[36:51], a[68:71], v[128:131], v[36:51]
s_add_u32 s51, s56, 8192
s_and_b32 s51, s51, 0x7fff
s_add_u32 s51, s51, s50
buffer_load_dwordx4 v[128:131], v6, s[84:87], s51 offen offset:0 sc1
ds_read_b128 v[68:71], v3 offset:0
ds_read_b128 v[72:75], v3 offset:8704
ds_read_b128 v[76:79], v3 offset:17408
ds_read_b128 v[80:83], v3 offset:26112
s_sub_u32 s53, 34816, s53
s_sub_u32 s60, s62, s64
s_lshr_b32 s60, s60, s67
s_bfe_u32 s61, s60, 0x10001
s_and_b32 s60, s60, 1
s_lshl_b32 s60, s60, 12
s_waitcnt vmcnt(31)
v_mfma_f32_32x32x16_bf16 v[20:35], a[72:75], v[132:135], v[20:35]
v_mfma_f32_32x32x16_bf16 v[36:51], a[76:79], v[132:135], v[36:51]
buffer_load_dwordx4 v[132:135], v6, s[84:87], s51 offen offset:1024 sc1
s_waitcnt vmcnt(31)
v_mfma_f32_32x32x16_bf16 v[20:35], a[80:83], v[136:139], v[20:35]
v_mfma_f32_32x32x16_bf16 v[36:51], a[84:87], v[136:139], v[36:51]
buffer_load_dwordx4 v[136:139], v6, s[84:87], s51 offen offset:2048 sc1
s_waitcnt lgkmcnt(4)
v_add_f32 v52, v52, v56
v_add_f32 v60, v60, v64
v_add_f32 v53, v53, v57
v_add_f32 v61, v61, v65
v_add_f32 v54, v54, v58
v_add_f32 v62, v62, v66
v_add_f32 v55, v55, v59
v_add_f32 v63, v63, v67
s_waitcnt vmcnt(31)
v_mfma_f32_32x32x16_bf16 v[20:35], a[88:91], v[140:143], v[20:35]
v_mfma_f32_32x32x16_bf16 v[36:51], a[92:95], v[140:143], v[36:51]
buffer_load_dwordx4 v[140:143], v6, s[84:87], s51 offen offset:3072 sc1
v_add_f32 v52, v52, v60
v_add_f32 v53, v53, v61
v_add_f32 v54, v54, v62
v_add_f32 v55, v55, v63
v_and_or_b32 v52, v52, -2, s61
s_cmp_eq_u32 s95, 0
s_cbranch_scc1 mega_kernel_o_sa1
buffer_store_dwordx4 v[52:55], v12, s[84:87], s60 offen sc1
s_branch mega_kernel_o_sb1
mega_kernel_o_sa1:
buffer_store_dwordx4 v[52:55], v12, s[84:87], s60 offen
mega_kernel_o_sb1:
s_waitcnt vmcnt(31)
v_mfma_f32_32x32x16_bf16 v[20:35], a[96:99], v[144:147], v[20:35]
v_mfma_f32_32x32x16_bf16 v[36:51], a[100:103], v[144:147], v[36:51]
s_add_u32 s51, s56, 12288
s_and_b32 s51, s51, 0x7fff
s_add_u32 s51, s51, s50
buffer_load_dwordx4 v[144:147], v6, s[84:87], s51 offen offset:0 sc1
s_waitcnt lgkmcnt(0)
v_add_f32 v68, v68, v72
v_add_f32 v76, v76, v80
v_add_f32 v69, v69, v73
v_add_f32 v77, v77, v81
v_add_f32 v70, v70, v74
v_add_f32 v78, v78, v82
v_add_f32 v71, v71, v75
v_add_f32 v79, v79, v83
s_waitcnt vmcnt(31)
v_mfma_f32_32x32x16_bf16 v[20:35], a[104:107], v[148:151], v[20:35]
v_mfma_f32_32x32x16_bf16 v[36:51], a[108:111], v[148:151], v[36:51]
buffer_load_dwordx4 v[148:151], v6, s[84:87], s51 offen offset:1024 sc1
v_add_f32 v84, v68, v76
v_add_f32 v85, v69, v77
v_add_f32 v86, v70, v78
v_add_f32 v87, v71, v79
s_waitcnt vmcnt(31)
v_mfma_f32_32x32x16_bf16 v[20:35], a[112:115], v[152:155], v[20:35]
v_mfma_f32_32x32x16_bf16 v[36:51], a[116:119], v[152:155], v[36:51]
buffer_load_dwordx4 v[152:155], v6, s[84:87], s51 offen offset:2048 sc1
s_waitcnt vmcnt(31)
v_mfma_f32_32x32x16_bf16 v[20:35], a[120:123], v[156:159], v[20:35]
v_mfma_f32_32x32x16_bf16 v[36:51], a[124:127], v[156:159], v[36:51]
buffer_load_dwordx4 v[156:159], v6, s[84:87], s51 offen offset:3072 sc1
s_waitcnt vmcnt(31)
v_mfma_f32_32x32x16_bf16 v[20:35], a[128:131], v[160:163], v[20:35]
v_mfma_f32_32x32x16_bf16 v[36:51], a[132:135], v[160:163], v[36:51]
s_add_u32 s51, s56, 16384
s_and_b32 s51, s51, 0x7fff
s_add_u32 s51, s51, s50
buffer_load_dwordx4 v[160:163], v6, s[84:87], s51 offen offset:0 sc1
s_waitcnt vmcnt(31)
v_mfma_f32_32x32x16_bf16 v[20:35], a[136:139], v[164:167], v[20:35]
v_mfma_f32_32x32x16_bf16 v[36:51], a[140:143], v[164:167], v[36:51]
buffer_load_dwordx4 v[164:167], v6, s[84:87], s51 offen offset:1024 sc1
s_waitcnt vmcnt(31)
v_mfma_f32_32x32x16_bf16 v[20:35], a[144:147], v[168:171], v[20:35]
v_mfma_f32_32x32x16_bf16 v[36:51], a[148:151], v[168:171], v[36:51]
buffer_load_dwordx4 v[168:171], v6, s[84:87], s51 offen offset:2048 sc1
s_waitcnt vmcnt(31)
v_mfma_f32_32x32x16_bf16 v[20:35], a[152:155], v[172:175], v[20:35]
v_mfma_f32_32x32x16_bf16 v[36:51], a[156:159], v[172:175], v[36:51]
buffer_load_dwordx4 v[172:175], v6, s[84:87], s51 offen offset:3072 sc1
s_waitcnt vmcnt(31)
v_mfma_f32_32x32x16_bf16 v[20:35], a[160:163], v[176:179], v[20:35]
v_mfma_f32_32x32x16_bf16 v[36:51], a[164:167], v[176:179], v[36:51]
s_add_u32 s51, s56, 20480
s_and_b32 s51, s51, 0x7fff
s_add_u32 s51, s51, s50
buffer_load_dwordx4 v[176:179], v6, s[84:87], s51 offen offset:0 sc1
s_waitcnt vmcnt(31)
v_mfma_f32_32x32x16_bf16 v[20:35], a[168:171], v[180:183], v[20:35]
v_mfma_f32_32x32x16_bf16 v[36:51], a[172:175], v[180:183], v[36:51]
buffer_load_dwordx4 v[180:183], v6, s[84:87], s51 offen offset:1024 sc1
s_waitcnt vmcnt(31)
v_mfma_f32_32x32x16_bf16 v[20:35], a[176:179], v[184:187], v[20:35]
v_mfma_f32_32x32x16_bf16 v[36:51], a[180:183], v[184:187], v[36:51]
buffer_load_dwordx4 v[184:187], v6, s[84:87], s51 offen offset:2048 sc1
s_waitcnt vmcnt(31)
v_mfma_f32_32x32x16_bf16 v[20:35], a[184:187], v[188:191], v[20:35]
v_mfma_f32_32x32x16_bf16 v[36:51], a[188:191], v[188:191], v[36:51]
buffer_load_dwordx4 v[188:191], v6, s[84:87], s51 offen offset:3072 sc1
s_waitcnt vmcnt(31)
v_mfma_f32_32x32x16_bf16 v[20:35], a[192:195], v[192:195], v[20:35]
v_mfma_f32_32x32x16_bf16 v[36:51], a[196:199], v[192:195], v[36:51]
s_add_u32 s51, s56, 24576
s_and_b32 s51, s51, 0x7fff
s_add_u32 s51, s51, s50
buffer_load_dwordx4 v[192:195], v6, s[84:87], s51 offen offset:0 sc1
s_waitcnt vmcnt(31)
v_mfma_f32_32x32x16_bf16 v[20:35], a[200:203], v[196:199], v[20:35]
v_mfma_f32_32x32x16_bf16 v[36:51], a[204:207], v[196:199], v[36:51]
buffer_load_dwordx4 v[196:199], v6, s[84:87], s51 offen offset:1024 sc1
s_waitcnt vmcnt(31)
v_mfma_f32_32x32x16_bf16 v[20:35], a[208:211], v[200:203], v[20:35]
v_mfma_f32_32x32x16_bf16 v[36:51], a[212:215], v[200:203], v[36:51]
buffer_load_dwordx4 v[200:203], v6, s[84:87], s51 offen offset:2048 sc1
s_waitcnt vmcnt(31)
v_mfma_f32_32x32x16_bf16 v[20:35], a[216:219], v[204:207], v[20:35]
v_mfma_f32_32x32x16_bf16 v[36:51], a[220:223], v[204:207], v[36:51]
buffer_load_dwordx4 v[204:207], v6, s[84:87], s51 offen offset:3072 sc1
s_sub_u32 s60, s62, s64
s_lshr_b32 s60, s60, s67
s_bfe_u32 s61, s60, 0x10001
s_and_b32 s60, s60, 1
s_lshl_b32 s60, s60, 12
buffer_load_dwordx4 v[88:91], v13, s[84:87], s60 offen sc1
s_waitcnt vmcnt(31)
v_mfma_f32_32x32x16_bf16 v[20:35], a[224:227], v[208:211], v[20:35]
v_mfma_f32_32x32x16_bf16 v[36:51], a[228:231], v[208:211], v[36:51]
s_add_u32 s51, s56, 28672
s_and_b32 s51, s51, 0x7fff
s_add_u32 s51, s51, s50
buffer_load_dwordx4 v[208:211], v6, s[84:87], s51 offen offset:0 sc1
s_waitcnt vmcnt(31)
v_mfma_f32_32x32x16_bf16 v[20:35], a[232:235], v[212:215], v[20:35]
v_mfma_f32_32x32x16_bf16 v[36:51], a[236:239], v[212:215], v[36:51]
buffer_load_dwordx4 v[212:215], v6, s[84:87], s51 offen offset:1024 sc1
s_waitcnt vmcnt(31)
v_mfma_f32_32x32x16_bf16 v[20:35], a[240:243], v[216:219], v[20:35]
v_mfma_f32_32x32x16_bf16 v[36:51], a[244:247], v[216:219], v[36:51]
buffer_load_dwordx4 v[216:219], v6, s[84:87], s51 offen offset:2048 sc1
s_waitcnt vmcnt(31)
v_mfma_f32_32x32x16_bf16 v[224:239], a[248:251], v[220:223], v[20:35]
v_mfma_f32_32x32x16_bf16 v[240:255], a[252:255], v[220:223], v[36:51]
buffer_load_dwordx4 v[220:223], v6, s[84:87], s51 offen offset:3072 sc1
s_waitcnt vmcnt(4)
mega_kernel_o_f1c:
v_and_b32 v14, 1, v88
v_cmp_ne_u32 vcc, s61, v14
s_cbranch_vccz mega_kernel_o_f1k
s_sub_u32 s60, s62, s64
s_lshr_b32 s60, s60, s67
s_bfe_u32 s61, s60, 0x10001
s_and_b32 s60, s60, 1
s_lshl_b32 s60, s60, 12
buffer_load_dwordx4 v[88:91], v13, s[84:87], s60 offen sc1
s_waitcnt vmcnt(0)
s_branch mega_kernel_o_f1c
mega_kernel_o_f1k:
v_pk_add_f32 v[88:89], v[88:89], v[84:85]
v_pk_add_f32 v[90:91], v[90:91], v[86:87]
s_lshl_b32 s60, s62, 17
v_cvt_pk_bf16_f32 v92, v88, v89
v_cvt_pk_bf16_f32 v93, v90, v91
buffer_store_dwordx2 v[92:93], v11, s[8:11], s60 offen sc1
s_add_u32 s42, s42, s71
s_branch mega_kernel_o_w1
mega_kernel_o_n1:
s_waitcnt vmcnt(31)
v_mfma_f32_32x32x16_bf16 v[20:35], a[0:3], v[96:99], 0
v_mfma_f32_32x32x16_bf16 v[36:51], a[4:7], v[96:99], 0
s_waitcnt vmcnt(30)
v_mfma_f32_32x32x16_bf16 v[20:35], a[8:11], v[100:103], v[20:35]
v_mfma_f32_32x32x16_bf16 v[36:51], a[12:15], v[100:103], v[36:51]
v_add_u32 v2, s53, v8
v_add_u32 v3, s53, v9
v_add_u32 v4, s53, v10
s_waitcnt vmcnt(29)
v_mfma_f32_32x32x16_bf16 v[20:35], a[16:19], v[104:107], v[20:35]
v_mfma_f32_32x32x16_bf16 v[36:51], a[20:23], v[104:107], v[36:51]
ds_write_b128 v2, v[224:227] offset:0
ds_write_b128 v2, v[228:231] offset:1088
s_waitcnt vmcnt(28)
v_mfma_f32_32x32x16_bf16 v[20:35], a[24:27], v[108:111], v[20:35]
v_mfma_f32_32x32x16_bf16 v[36:51], a[28:31], v[108:111], v[36:51]
ds_write_b128 v2, v[232:235] offset:2176
ds_write_b128 v2, v[236:239] offset:3264
s_waitcnt vmcnt(27)
v_mfma_f32_32x32x16_bf16 v[20:35], a[32:35], v[112:115], v[20:35]
v_mfma_f32_32x32x16_bf16 v[36:51], a[36:39], v[112:115], v[36:51]
ds_write_b128 v2, v[240:243] offset:4352
ds_write_b128 v2, v[244:247] offset:5440
s_waitcnt vmcnt(26)
v_mfma_f32_32x32x16_bf16 v[20:35], a[40:43], v[116:119], v[20:35]
v_mfma_f32_32x32x16_bf16 v[36:51], a[44:47], v[116:119], v[36:51]
ds_write_b128 v2, v[248:251] offset:6528
ds_write_b128 v2, v[252:255] offset:7616
s_waitcnt vmcnt(25)
v_mfma_f32_32x32x16_bf16 v[20:35], a[48:51], v[120:123], v[20:35]
v_mfma_f32_32x32x16_bf16 v[36:51], a[52:55], v[120:123], v[36:51]
s_waitcnt vmcnt(24)
v_mfma_f32_32x32x16_bf16 v[20:35], a[56:59], v[124:127], v[20:35]
v_mfma_f32_32x32x16_bf16 v[36:51], a[60:63], v[124:127], v[36:51]
s_waitcnt lgkmcnt(0)
s_barrier
ds_read_b128 v[52:55], v4 offset:0
ds_read_b128 v[56:59], v4 offset:8704
ds_read_b128 v[60:63], v4 offset:17408
ds_read_b128 v[64:67], v4 offset:26112
s_waitcnt vmcnt(23)
v_mfma_f32_32x32x16_bf16 v[20:35], a[64:67], v[128:131], v[20:35]
v_mfma_f32_32x32x16_bf16 v[36:51], a[68:71], v[128:131], v[36:51]
ds_read_b128 v[68:71], v3 offset:0
ds_read_b128 v[72:75], v3 offset:8704
ds_read_b128 v[76:79], v3 offset:17408
ds_read_b128 v[80:83], v3 offset:26112
s_sub_u32 s53, 34816, s53
s_sub_u32 s60, s62, s64
s_lshr_b32 s60, s60, s67
s_bfe_u32 s61, s60, 0x10001
s_and_b32 s60, s60, 1
s_lshl_b32 s60, s60, 12
s_waitcnt vmcnt(22)
v_mfma_f32_32x32x16_bf16 v[20:35], a[72:75], v[132:135], v[20:35]
v_mfma_f32_32x32x16_bf16 v[36:51], a[76:79], v[132:135], v[36:51]
s_waitcnt vmcnt(21)
v_mfma_f32_32x32x16_bf16 v[20:35], a[80:83], v[136:139], v[20:35]
v_mfma_f32_32x32x16_bf16 v[36:51], a[84:87], v[136:139], v[36:51]
s_waitcnt lgkmcnt(4)
v_add_f32 v52, v52, v56
v_add_f32 v60, v60, v64
v_add_f32 v53, v53, v57
v_add_f32 v61, v61, v65
v_add_f32 v54, v54, v58
v_add_f32 v62, v62, v66
v_add_f32 v55, v55, v59
v_add_f32 v63, v63, v67
s_waitcnt vmcnt(20)
v_mfma_f32_32x32x16_bf16 v[20:35], a[88:91], v[140:143], v[20:35]
v_mfma_f32_32x32x16_bf16 v[36:51], a[92:95], v[140:143], v[36:51]
v_add_f32 v52, v52, v60
v_add_f32 v53, v53, v61
v_add_f32 v54, v54, v62
v_add_f32 v55, v55, v63
v_and_or_b32 v52, v52, -2, s61
s_cmp_eq_u32 s95, 0
s_cbranch_scc1 mega_kernel_o_sa2
buffer_store_dwordx4 v[52:55], v12, s[84:87], s60 offen sc1
s_branch mega_kernel_o_sb2
mega_kernel_o_sa2:
buffer_store_dwordx4 v[52:55], v12, s[84:87], s60 offen
mega_kernel_o_sb2:
s_waitcnt vmcnt(19)
v_mfma_f32_32x32x16_bf16 v[20:35], a[96:99], v[144:147], v[20:35]
v_mfma_f32_32x32x16_bf16 v[36:51], a[100:103], v[144:147], v[36:51]
s_waitcnt lgkmcnt(0)
v_add_f32 v68, v68, v72
v_add_f32 v76, v76, v80
v_add_f32 v69, v69, v73
v_add_f32 v77, v77, v81
v_add_f32 v70, v70, v74
v_add_f32 v78, v78, v82
v_add_f32 v71, v71, v75
v_add_f32 v79, v79, v83
s_waitcnt vmcnt(18)
v_mfma_f32_32x32x16_bf16 v[20:35], a[104:107], v[148:151], v[20:35]
v_mfma_f32_32x32x16_bf16 v[36:51], a[108:111], v[148:151], v[36:51]
v_add_f32 v84, v68, v76
v_add_f32 v85, v69, v77
v_add_f32 v86, v70, v78
v_add_f32 v87, v71, v79
s_waitcnt vmcnt(17)
v_mfma_f32_32x32x16_bf16 v[20:35], a[112:115], v[152:155], v[20:35]
v_mfma_f32_32x32x16_bf16 v[36:51], a[116:119], v[152:155], v[36:51]
s_waitcnt vmcnt(16)
v_mfma_f32_32x32x16_bf16 v[20:35], a[120:123], v[156:159], v[20:35]
v_mfma_f32_32x32x16_bf16 v[36:51], a[124:127], v[156:159], v[36:51]
s_waitcnt vmcnt(15)
v_mfma_f32_32x32x16_bf16 v[20:35], a[128:131], v[160:163], v[20:35]
v_mfma_f32_32x32x16_bf16 v[36:51], a[132:135], v[160:163], v[36:51]
s_waitcnt vmcnt(14)
v_mfma_f32_32x32x16_bf16 v[20:35], a[136:139], v[164:167], v[20:35]
v_mfma_f32_32x32x16_bf16 v[36:51], a[140:143], v[164:167], v[36:51]
s_waitcnt vmcnt(13)
v_mfma_f32_32x32x16_bf16 v[20:35], a[144:147], v[168:171], v[20:35]
v_mfma_f32_32x32x16_bf16 v[36:51], a[148:151], v[168:171], v[36:51]
s_waitcnt vmcnt(12)
v_mfma_f32_32x32x16_bf16 v[20:35], a[152:155], v[172:175], v[20:35]
v_mfma_f32_32x32x16_bf16 v[36:51], a[156:159], v[172:175], v[36:51]
s_waitcnt vmcnt(11)
v_mfma_f32_32x32x16_bf16 v[20:35], a[160:163], v[176:179], v[20:35]
v_mfma_f32_32x32x16_bf16 v[36:51], a[164:167], v[176:179], v[36:51]
buffer_load_dword v15, v7, s[84:87], 0 offen sc1
s_waitcnt vmcnt(10)
v_mfma_f32_32x32x16_bf16 v[20:35], a[168:171], v[180:183], v[20:35]
v_mfma_f32_32x32x16_bf16 v[36:51], a[172:175], v[180:183], v[36:51]
s_waitcnt vmcnt(9)
v_mfma_f32_32x32x16_bf16 v[20:35], a[176:179], v[184:187], v[20:35]
v_mfma_f32_32x32x16_bf16 v[36:51], a[180:183], v[184:187], v[36:51]
s_waitcnt vmcnt(8)
v_mfma_f32_32x32x16_bf16 v[20:35], a[184:187], v[188:191], v[20:35]
v_mfma_f32_32x32x16_bf16 v[36:51], a[188:191], v[188:191], v[36:51]
s_waitcnt vmcnt(7)
v_mfma_f32_32x32x16_bf16 v[20:35], a[192:195], v[192:195], v[20:35]
v_mfma_f32_32x32x16_bf16 v[36:51], a[196:199], v[192:195], v[36:51]
s_waitcnt vmcnt(6)
v_mfma_f32_32x32x16_bf16 v[20:35], a[200:203], v[196:199], v[20:35]
v_mfma_f32_32x32x16_bf16 v[36:51], a[204:207], v[196:199], v[36:51]
s_waitcnt vmcnt(5)
v_mfma_f32_32x32x16_bf16 v[20:35], a[208:211], v[200:203], v[20:35]
v_mfma_f32_32x32x16_bf16 v[36:51], a[212:215], v[200:203], v[36:51]
s_waitcnt vmcnt(4)
v_mfma_f32_32x32x16_bf16 v[20:35], a[216:219], v[204:207], v[20:35]
v_mfma_f32_32x32x16_bf16 v[36:51], a[220:223], v[204:207], v[36:51]
s_sub_u32 s60, s62, s64
s_lshr_b32 s60, s60, s67
s_bfe_u32 s61, s60, 0x10001
s_and_b32 s60, s60, 1
s_lshl_b32 s60, s60, 12
buffer_load_dwordx4 v[88:91], v13, s[84:87], s60 offen sc1
s_waitcnt vmcnt(3)
v_mfma_f32_32x32x16_bf16 v[20:35], a[224:227], v[208:211], v[20:35]
v_mfma_f32_32x32x16_bf16 v[36:51], a[228:231], v[208:211], v[36:51]
s_waitcnt vmcnt(2)
v_mfma_f32_32x32x16_bf16 v[20:35], a[232:235], v[212:215], v[20:35]
v_mfma_f32_32x32x16_bf16 v[36:51], a[236:239], v[212:215], v[36:51]
s_waitcnt vmcnt(1)
v_mfma_f32_32x32x16_bf16 v[20:35], a[240:243], v[216:219], v[20:35]
v_mfma_f32_32x32x16_bf16 v[36:51], a[244:247], v[216:219], v[36:51]
s_waitcnt vmcnt(0)
v_mfma_f32_32x32x16_bf16 v[224:239], a[248:251], v[220:223], v[20:35]
v_mfma_f32_32x32x16_bf16 v[240:255], a[252:255], v[220:223], v[36:51]
s_waitcnt vmcnt(0)
mega_kernel_o_f0c:
v_and_b32 v14, 1, v88
v_cmp_ne_u32 vcc, s61, v14
s_cbranch_vccz mega_kernel_o_f0k
s_sub_u32 s60, s62, s64
s_lshr_b32 s60, s60, s67
s_bfe_u32 s61, s60, 0x10001
s_and_b32 s60, s60, 1
s_lshl_b32 s60, s60, 12
buffer_load_dwordx4 v[88:91], v13, s[84:87], s60 offen sc1
s_waitcnt vmcnt(0)
s_branch mega_kernel_o_f0c
mega_kernel_o_f0k:
v_pk_add_f32 v[88:89], v[88:89], v[84:85]
v_pk_add_f32 v[90:91], v[90:91], v[86:87]
s_lshl_b32 s60, s62, 17
v_cvt_pk_bf16_f32 v92, v88, v89
v_cvt_pk_bf16_f32 v93, v90, v91
buffer_store_dwordx2 v[92:93], v11, s[8:11], s60 offen sc1
mega_kernel_o_imm:
s_waitcnt vmcnt(1)
v_min_i32_dpp v15, v15, v15 quad_perm:[1,0,3,2] row_mask:0xf bank_mask:0xf
s_nop 1
v_min_i32_dpp v15, v15, v15 quad_perm:[2,3,0,1] row_mask:0xf bank_mask:0xf
s_nop 1
v_min_i32_dpp v15, v15, v15 row_ror:4 row_mask:0xf bank_mask:0xf
s_nop 1
v_min_i32_dpp v15, v15, v15 row_ror:8 row_mask:0xf bank_mask:0xf
s_nop 0
v_readfirstlane_b32 s52, v15
s_min_i32 s52, s52, s65
s_cmp_gt_i32 s52, s54
s_cbranch_scc0 mega_kernel_o_im2
s_add_u32 s42, s42, s71
s_add_u32 s54, s54, s71
s_cmp_gt_i32 s52, s54
s_cbranch_scc0 mega_kernel_o_c1
s_add_u32 s51, s56, 0
s_and_b32 s51, s51, 0x7fff
s_add_u32 s51, s51, s50
buffer_load_dwordx4 v[96:99], v6, s[84:87], s51 offen offset:0 sc1
buffer_load_dwordx4 v[100:103], v6, s[84:87], s51 offen offset:1024 sc1
buffer_load_dwordx4 v[104:107], v6, s[84:87], s51 offen offset:2048 sc1
buffer_load_dwordx4 v[108:111], v6, s[84:87], s51 offen offset:3072 sc1
s_add_u32 s51, s56, 4096
s_and_b32 s51, s51, 0x7fff
s_add_u32 s51, s51, s50
buffer_load_dwordx4 v[112:115], v6, s[84:87], s51 offen offset:0 sc1
buffer_load_dwordx4 v[116:119], v6, s[84:87], s51 offen offset:1024 sc1
buffer_load_dwordx4 v[120:123], v6, s[84:87], s51 offen offset:2048 sc1
buffer_load_dwordx4 v[124:127], v6, s[84:87], s51 offen offset:3072 sc1
s_add_u32 s51, s56, 8192
s_and_b32 s51, s51, 0x7fff
s_add_u32 s51, s51, s50
buffer_load_dwordx4 v[128:131], v6, s[84:87], s51 offen offset:0 sc1
buffer_load_dwordx4 v[132:135], v6, s[84:87], s51 offen offset:1024 sc1
buffer_load_dwordx4 v[136:139], v6, s[84:87], s51 offen offset:2048 sc1
buffer_load_dwordx4 v[140:143], v6, s[84:87], s51 offen offset:3072 sc1
s_add_u32 s51, s56, 12288
s_and_b32 s51, s51, 0x7fff
s_add_u32 s51, s51, s50
buffer_load_dwordx4 v[144:147], v6, s[84:87], s51 offen offset:0 sc1
buffer_load_dwordx4 v[148:151], v6, s[84:87], s51 offen offset:1024 sc1
buffer_load_dwordx4 v[152:155], v6, s[84:87], s51 offen offset:2048 sc1
buffer_load_dwordx4 v[156:159], v6, s[84:87], s51 offen offset:3072 sc1
s_add_u32 s51, s56, 16384
s_and_b32 s51, s51, 0x7fff
s_add_u32 s51, s51, s50
buffer_load_dwordx4 v[160:163], v6, s[84:87], s51 offen offset:0 sc1
buffer_load_dwordx4 v[164:167], v6, s[84:87], s51 offen offset:1024 sc1
buffer_load_dwordx4 v[168:171], v6, s[84:87], s51 offen offset:2048 sc1
buffer_load_dwordx4 v[172:175], v6, s[84:87], s51 offen offset:3072 sc1
s_add_u32 s51, s56, 20480
s_and_b32 s51, s51, 0x7fff
s_add_u32 s51, s51, s50
buffer_load_dwordx4 v[176:179], v6, s[84:87], s51 offen offset:0 sc1
buffer_load_dwordx4 v[180:183], v6, s[84:87], s51 offen offset:1024 sc1
buffer_load_dwordx4 v[184:187], v6, s[84:87], s51 offen offset:2048 sc1
buffer_load_dwordx4 v[188:191], v6, s[84:87], s51 offen offset:3072 sc1
s_add_u32 s51, s56, 24576
s_and_b32 s51, s51, 0x7fff
s_add_u32 s51, s51, s50
buffer_load_dwordx4 v[192:195], v6, s[84:87], s51 offen offset:0 sc1
buffer_load_dwordx4 v[196:199], v6, s[84:87], s51 offen offset:1024 sc1
buffer_load_dwordx4 v[200:203], v6, s[84:87], s51 offen offset:2048 sc1
buffer_load_dwordx4 v[204:207], v6, s[84:87], s51 offen offset:3072 sc1
s_add_u32 s51, s56, 28672
s_and_b32 s51, s51, 0x7fff
s_add_u32 s51, s51, s50
buffer_load_dwordx4 v[208:211], v6, s[84:87], s51 offen offset:0 sc1
buffer_load_dwordx4 v[212:215], v6, s[84:87], s51 offen offset:1024 sc1
buffer_load_dwordx4 v[216:219], v6, s[84:87], s51 offen offset:2048 sc1
buffer_load_dwordx4 v[220:223], v6, s[84:87], s51 offen offset:3072 sc1
s_branch mega_kernel_o_w1
mega_kernel_o_c0:
s_add_u32 s54, s42, s71
s_sub_u32 s62, s42, s71
s_lshl_b32 s50, s42, 18
s_add_u32 s51, s56, 0
s_and_b32 s51, s51, 0x7fff
s_add_u32 s51, s51, s50
buffer_load_dwordx4 v[96:99], v6, s[84:87], s51 offen offset:0 sc1
buffer_load_dwordx4 v[100:103], v6, s[84:87], s51 offen offset:1024 sc1
buffer_load_dwordx4 v[104:107], v6, s[84:87], s51 offen offset:2048 sc1
buffer_load_dwordx4 v[108:111], v6, s[84:87], s51 offen offset:3072 sc1
s_add_u32 s51, s56, 4096
s_and_b32 s51, s51, 0x7fff
s_add_u32 s51, s51, s50
buffer_load_dwordx4 v[112:115], v6, s[84:87], s51 offen offset:0 sc1
buffer_load_dwordx4 v[116:119], v6, s[84:87], s51 offen offset:1024 sc1
buffer_load_dwordx4 v[120:123], v6, s[84:87], s51 offen offset:2048 sc1
buffer_load_dwordx4 v[124:127], v6, s[84:87], s51 offen offset:3072 sc1
s_waitcnt vmcnt(7)
v_mfma_f32_32x32x16_bf16 v[20:35], a[0:3], v[96:99], 0
v_mfma_f32_32x32x16_bf16 v[36:51], a[4:7], v[96:99], 0
s_add_u32 s51, s56, 8192
s_and_b32 s51, s51, 0x7fff
s_add_u32 s51, s51, s50
buffer_load_dwordx4 v[128:131], v6, s[84:87], s51 offen offset:0 sc1
s_waitcnt vmcnt(7)
v_mfma_f32_32x32x16_bf16 v[20:35], a[8:11], v[100:103], v[20:35]
v_mfma_f32_32x32x16_bf16 v[36:51], a[12:15], v[100:103], v[36:51]
buffer_load_dwordx4 v[132:135], v6, s[84:87], s51 offen offset:1024 sc1
s_waitcnt vmcnt(7)
v_mfma_f32_32x32x16_bf16 v[20:35], a[16:19], v[104:107], v[20:35]
v_mfma_f32_32x32x16_bf16 v[36:51], a[20:23], v[104:107], v[36:51]
buffer_load_dwordx4 v[136:139], v6, s[84:87], s51 offen offset:2048 sc1
s_waitcnt vmcnt(7)
v_mfma_f32_32x32x16_bf16 v[20:35], a[24:27], v[108:111], v[20:35]
v_mfma_f32_32x32x16_bf16 v[36:51], a[28:31], v[108:111], v[36:51]
buffer_load_dwordx4 v[140:143], v6, s[84:87], s51 offen offset:3072 sc1
s_waitcnt vmcnt(7)
v_mfma_f32_32x32x16_bf16 v[20:35], a[32:35], v[112:115], v[20:35]
v_mfma_f32_32x32x16_bf16 v[36:51], a[36:39], v[112:115], v[36:51]
s_add_u32 s51, s56, 12288
s_and_b32 s51, s51, 0x7fff
s_add_u32 s51, s51, s50
buffer_load_dwordx4 v[144:147], v6, s[84:87], s51 offen offset:0 sc1
s_waitcnt vmcnt(7)
v_mfma_f32_32x32x16_bf16 v[20:35], a[40:43], v[116:119], v[20:35]
v_mfma_f32_32x32x16_bf16 v[36:51], a[44:47], v[116:119], v[36:51]
buffer_load_dwordx4 v[148:151], v6, s[84:87], s51 offen offset:1024 sc1
s_waitcnt vmcnt(7)
v_mfma_f32_32x32x16_bf16 v[20:35], a[48:51], v[120:123], v[20:35]
v_mfma_f32_32x32x16_bf16 v[36:51], a[52:55], v[120:123], v[36:51]
buffer_load_dwordx4 v[152:155], v6, s[84:87], s51 offen offset:2048 sc1
s_waitcnt vmcnt(7)
v_mfma_f32_32x32x16_bf16 v[20:35], a[56:59], v[124:127], v[20:35]
v_mfma_f32_32x32x16_bf16 v[36:51], a[60:63], v[124:127], v[36:51]
buffer_load_dwordx4 v[156:159], v6, s[84:87], s51 offen offset:3072 sc1
s_waitcnt vmcnt(7)
v_mfma_f32_32x32x16_bf16 v[20:35], a[64:67], v[128:131], v[20:35]
v_mfma_f32_32x32x16_bf16 v[36:51], a[68:71], v[128:131], v[36:51]
s_add_u32 s51, s56, 16384
s_and_b32 s51, s51, 0x7fff
s_add_u32 s51, s51, s50
buffer_load_dwordx4 v[160:163], v6, s[84:87], s51 offen offset:0 sc1
s_waitcnt vmcnt(7)
v_mfma_f32_32x32x16_bf16 v[20:35], a[72:75], v[132:135], v[20:35]
v_mfma_f32_32x32x16_bf16 v[36:51], a[76:79], v[132:135], v[36:51]
buffer_load_dwordx4 v[164:167], v6, s[84:87], s51 offen offset:1024 sc1
s_waitcnt vmcnt(7)
v_mfma_f32_32x32x16_bf16 v[20:35], a[80:83], v[136:139], v[20:35]
v_mfma_f32_32x32x16_bf16 v[36:51], a[84:87], v[136:139], v[36:51]
buffer_load_dwordx4 v[168:171], v6, s[84:87], s51 offen offset:2048 sc1
s_waitcnt vmcnt(7)
v_mfma_f32_32x32x16_bf16 v[20:35], a[88:91], v[140:143], v[20:35]
v_mfma_f32_32x32x16_bf16 v[36:51], a[92:95], v[140:143], v[36:51]
buffer_load_dwordx4 v[172:175], v6, s[84:87], s51 offen offset:3072 sc1
s_waitcnt vmcnt(7)
v_mfma_f32_32x32x16_bf16 v[20:35], a[96:99], v[144:147], v[20:35]
v_mfma_f32_32x32x16_bf16 v[36:51], a[100:103], v[144:147], v[36:51]
s_add_u32 s51, s56, 20480
s_and_b32 s51, s51, 0x7fff
s_add_u32 s51, s51, s50
buffer_load_dwordx4 v[176:179], v6, s[84:87], s51 offen offset:0 sc1
s_waitcnt vmcnt(7)
v_mfma_f32_32x32x16_bf16 v[20:35], a[104:107], v[148:151], v[20:35]
v_mfma_f32_32x32x16_bf16 v[36:51], a[108:111], v[148:151], v[36:51]
buffer_load_dwordx4 v[180:183], v6, s[84:87], s51 offen offset:1024 sc1
s_waitcnt vmcnt(7)
v_mfma_f32_32x32x16_bf16 v[20:35], a[112:115], v[152:155], v[20:35]
v_mfma_f32_32x32x16_bf16 v[36:51], a[116:119], v[152:155], v[36:51]
buffer_load_dwordx4 v[184:187], v6, s[84:87], s51 offen offset:2048 sc1
s_waitcnt vmcnt(7)
v_mfma_f32_32x32x16_bf16 v[20:35], a[120:123], v[156:159], v[20:35]
v_mfma_f32_32x32x16_bf16 v[36:51], a[124:127], v[156:159], v[36:51]
buffer_load_dwordx4 v[188:191], v6, s[84:87], s51 offen offset:3072 sc1
s_waitcnt vmcnt(7)
v_mfma_f32_32x32x16_bf16 v[20:35], a[128:131], v[160:163], v[20:35]
v_mfma_f32_32x32x16_bf16 v[36:51], a[132:135], v[160:163], v[36:51]
s_add_u32 s51, s56, 24576
s_and_b32 s51, s51, 0x7fff
s_add_u32 s51, s51, s50
buffer_load_dwordx4 v[192:195], v6, s[84:87], s51 offen offset:0 sc1
s_waitcnt vmcnt(7)
v_mfma_f32_32x32x16_bf16 v[20:35], a[136:139], v[164:167], v[20:35]
v_mfma_f32_32x32x16_bf16 v[36:51], a[140:143], v[164:167], v[36:51]
buffer_load_dwordx4 v[196:199], v6, s[84:87], s51 offen offset:1024 sc1
s_waitcnt vmcnt(7)
v_mfma_f32_32x32x16_bf16 v[20:35], a[144:147], v[168:171], v[20:35]
v_mfma_f32_32x32x16_bf16 v[36:51], a[148:151], v[168:171], v[36:51]
buffer_load_dwordx4 v[200:203], v6, s[84:87], s51 offen offset:2048 sc1
s_waitcnt vmcnt(7)
v_mfma_f32_32x32x16_bf16 v[20:35], a[152:155], v[172:175], v[20:35]
v_mfma_f32_32x32x16_bf16 v[36:51], a[156:159], v[172:175], v[36:51]
buffer_load_dwordx4 v[204:207], v6, s[84:87], s51 offen offset:3072 sc1
s_waitcnt vmcnt(7)
v_mfma_f32_32x32x16_bf16 v[20:35], a[160:163], v[176:179], v[20:35]
v_mfma_f32_32x32x16_bf16 v[36:51], a[164:167], v[176:179], v[36:51]
s_add_u32 s51, s56, 28672
s_and_b32 s51, s51, 0x7fff
s_add_u32 s51, s51, s50
buffer_load_dwordx4 v[208:211], v6, s[84:87], s51 offen offset:0 sc1
s_waitcnt vmcnt(7)
v_mfma_f32_32x32x16_bf16 v[20:35], a[168:171], v[180:183], v[20:35]
v_mfma_f32_32x32x16_bf16 v[36:51], a[172:175], v[180:183], v[36:51]
buffer_load_dwordx4 v[212:215], v6, s[84:87], s51 offen offset:1024 sc1
s_waitcnt vmcnt(7)
v_mfma_f32_32x32x16_bf16 v[20:35], a[176:179], v[184:187], v[20:35]
v_mfma_f32_32x32x16_bf16 v[36:51], a[180:183], v[184:187], v[36:51]
buffer_load_dwordx4 v[216:219], v6, s[84:87], s51 offen offset:2048 sc1
s_waitcnt vmcnt(7)
v_mfma_f32_32x32x16_bf16 v[20:35], a[184:187], v[188:191], v[20:35]
v_mfma_f32_32x32x16_bf16 v[36:51], a[188:191], v[188:191], v[36:51]
buffer_load_dwordx4 v[220:223], v6, s[84:87], s51 offen offset:3072 sc1
s_waitcnt vmcnt(7)
v_mfma_f32_32x32x16_bf16 v[20:35], a[192:195], v[192:195], v[20:35]
v_mfma_f32_32x32x16_bf16 v[36:51], a[196:199], v[192:195], v[36:51]
buffer_load_dword v15, v7, s[84:87], 0 offen sc1
s_waitcnt vmcnt(6)
v_mfma_f32_32x32x16_bf16 v[20:35], a[200:203], v[196:199], v[20:35]
v_mfma_f32_32x32x16_bf16 v[36:51], a[204:207], v[196:199], v[36:51]
s_waitcnt vmcnt(5)
v_mfma_f32_32x32x16_bf16 v[20:35], a[208:211], v[200:203], v[20:35]
v_mfma_f32_32x32x16_bf16 v[36:51], a[212:215], v[200:203], v[36:51]
s_waitcnt vmcnt(4)
v_mfma_f32_32x32x16_bf16 v[20:35], a[216:219], v[204:207], v[20:35]
v_mfma_f32_32x32x16_bf16 v[36:51], a[220:223], v[204:207], v[36:51]
s_waitcnt vmcnt(3)
v_mfma_f32_32x32x16_bf16 v[20:35], a[224:227], v[208:211], v[20:35]
v_mfma_f32_32x32x16_bf16 v[36:51], a[228:231], v[208:211], v[36:51]
s_waitcnt vmcnt(2)
v_mfma_f32_32x32x16_bf16 v[20:35], a[232:235], v[212:215], v[20:35]
v_mfma_f32_32x32x16_bf16 v[36:51], a[236:239], v[212:215], v[36:51]
s_waitcnt vmcnt(1)
v_mfma_f32_32x32x16_bf16 v[20:35], a[240:243], v[216:219], v[20:35]
v_mfma_f32_32x32x16_bf16 v[36:51], a[244:247], v[216:219], v[36:51]
s_waitcnt vmcnt(0)
v_mfma_f32_32x32x16_bf16 v[224:239], a[248:251], v[220:223], v[20:35]
v_mfma_f32_32x32x16_bf16 v[240:255], a[252:255], v[220:223], v[36:51]
s_lshl_b32 s50, s54, 18
s_branch mega_kernel_o_imm
mega_kernel_o_c1:
s_add_u32 s54, s42, s71
s_sub_u32 s62, s42, s71
s_lshl_b32 s50, s42, 18
s_add_u32 s51, s56, 0
s_and_b32 s51, s51, 0x7fff
s_add_u32 s51, s51, s50
buffer_load_dwordx4 v[96:99], v6, s[84:87], s51 offen offset:0 sc1
buffer_load_dwordx4 v[100:103], v6, s[84:87], s51 offen offset:1024 sc1
buffer_load_dwordx4 v[104:107], v6, s[84:87], s51 offen offset:2048 sc1
buffer_load_dwordx4 v[108:111], v6, s[84:87], s51 offen offset:3072 sc1
s_add_u32 s51, s56, 4096
s_and_b32 s51, s51, 0x7fff
s_add_u32 s51, s51, s50
buffer_load_dwordx4 v[112:115], v6, s[84:87], s51 offen offset:0 sc1
buffer_load_dwordx4 v[116:119], v6, s[84:87], s51 offen offset:1024 sc1
buffer_load_dwordx4 v[120:123], v6, s[84:87], s51 offen offset:2048 sc1
buffer_load_dwordx4 v[124:127], v6, s[84:87], s51 offen offset:3072 sc1
v_add_u32 v2, s53, v8
v_add_u32 v3, s53, v9
v_add_u32 v4, s53, v10
ds_write_b128 v2, v[224:227] offset:0
ds_write_b128 v2, v[228:231] offset:1088
ds_write_b128 v2, v[232:235] offset:2176
ds_write_b128 v2, v[236:239] offset:3264
ds_write_b128 v2, v[240:243] offset:4352
ds_write_b128 v2, v[244:247] offset:5440
ds_write_b128 v2, v[248:251] offset:6528
ds_write_b128 v2, v[252:255] offset:7616
s_waitcnt lgkmcnt(0)
s_barrier
ds_read_b128 v[52:55], v4 offset:0
ds_read_b128 v[56:59], v4 offset:8704
ds_read_b128 v[60:63], v4 offset:17408
ds_read_b128 v[64:67], v4 offset:26112
ds_read_b128 v[68:71], v3 offset:0
ds_read_b128 v[72:75], v3 offset:8704
ds_read_b128 v[76:79], v3 offset:17408
ds_read_b128 v[80:83], v3 offset:26112
s_sub_u32 s53, 34816, s53
s_sub_u32 s60, s62, s64
s_lshr_b32 s60, s60, s67
s_bfe_u32 s61, s60, 0x10001
s_and_b32 s60, s60, 1
s_lshl_b32 s60, s60, 12
s_waitcnt lgkmcnt(4)
v_add_f32 v52, v52, v56
v_add_f32 v60, v60, v64
v_add_f32 v53, v53, v57
v_add_f32 v61, v61, v65
v_add_f32 v54, v54, v58
v_add_f32 v62, v62, v66
v_add_f32 v55, v55, v59
v_add_f32 v63, v63, v67
v_add_f32 v52, v52, v60
v_add_f32 v53, v53, v61
v_add_f32 v54, v54, v62
v_add_f32 v55, v55, v63
v_and_or_b32 v52, v52, -2, s61
s_cmp_eq_u32 s95, 0
s_cbranch_scc1 mega_kernel_o_sa3
buffer_store_dwordx4 v[52:55], v12, s[84:87], s60 offen sc1
s_branch mega_kernel_o_sb3
mega_kernel_o_sa3:
buffer_store_dwordx4 v[52:55], v12, s[84:87], s60 offen
mega_kernel_o_sb3:
s_waitcnt lgkmcnt(0)
v_add_f32 v68, v68, v72
v_add_f32 v76, v76, v80
v_add_f32 v69, v69, v73
v_add_f32 v77, v77, v81
v_add_f32 v70, v70, v74
v_add_f32 v78, v78, v82
v_add_f32 v71, v71, v75
v_add_f32 v79, v79, v83
v_add_f32 v84, v68, v76
v_add_f32 v85, v69, v77
v_add_f32 v86, v70, v78
v_add_f32 v87, v71, v79
s_waitcnt vmcnt(7)
v_mfma_f32_32x32x16_bf16 v[20:35], a[0:3], v[96:99], 0
v_mfma_f32_32x32x16_bf16 v[36:51], a[4:7], v[96:99], 0
s_add_u32 s51, s56, 8192
s_and_b32 s51, s51, 0x7fff
s_add_u32 s51, s51, s50
buffer_load_dwordx4 v[128:131], v6, s[84:87], s51 offen offset:0 sc1
s_waitcnt vmcnt(7)
v_mfma_f32_32x32x16_bf16 v[20:35], a[8:11], v[100:103], v[20:35]
v_mfma_f32_32x32x16_bf16 v[36:51], a[12:15], v[100:103], v[36:51]
buffer_load_dwordx4 v[132:135], v6, s[84:87], s51 offen offset:1024 sc1
s_waitcnt vmcnt(7)
v_mfma_f32_32x32x16_bf16 v[20:35], a[16:19], v[104:107], v[20:35]
v_mfma_f32_32x32x16_bf16 v[36:51], a[20:23], v[104:107], v[36:51]
buffer_load_dwordx4 v[136:139], v6, s[84:87], s51 offen offset:2048 sc1
s_waitcnt vmcnt(7)
v_mfma_f32_32x32x16_bf16 v[20:35], a[24:27], v[108:111], v[20:35]
v_mfma_f32_32x32x16_bf16 v[36:51], a[28:31], v[108:111], v[36:51]
buffer_load_dwordx4 v[140:143], v6, s[84:87], s51 offen offset:3072 sc1
s_waitcnt vmcnt(7)
v_mfma_f32_32x32x16_bf16 v[20:35], a[32:35], v[112:115], v[20:35]
v_mfma_f32_32x32x16_bf16 v[36:51], a[36:39], v[112:115], v[36:51]
s_add_u32 s51, s56, 12288
s_and_b32 s51, s51, 0x7fff
s_add_u32 s51, s51, s50
buffer_load_dwordx4 v[144:147], v6, s[84:87], s51 offen offset:0 sc1
s_waitcnt vmcnt(7)
v_mfma_f32_32x32x16_bf16 v[20:35], a[40:43], v[116:119], v[20:35]
v_mfma_f32_32x32x16_bf16 v[36:51], a[44:47], v[116:119], v[36:51]
buffer_load_dwordx4 v[148:151], v6, s[84:87], s51 offen offset:1024 sc1
s_waitcnt vmcnt(7)
v_mfma_f32_32x32x16_bf16 v[20:35], a[48:51], v[120:123], v[20:35]
v_mfma_f32_32x32x16_bf16 v[36:51], a[52:55], v[120:123], v[36:51]
buffer_load_dwordx4 v[152:155], v6, s[84:87], s51 offen offset:2048 sc1
s_waitcnt vmcnt(7)
v_mfma_f32_32x32x16_bf16 v[20:35], a[56:59], v[124:127], v[20:35]
v_mfma_f32_32x32x16_bf16 v[36:51], a[60:63], v[124:127], v[36:51]
buffer_load_dwordx4 v[156:159], v6, s[84:87], s51 offen offset:3072 sc1
s_waitcnt vmcnt(7)
v_mfma_f32_32x32x16_bf16 v[20:35], a[64:67], v[128:131], v[20:35]
v_mfma_f32_32x32x16_bf16 v[36:51], a[68:71], v[128:131], v[36:51]
s_add_u32 s51, s56, 16384
s_and_b32 s51, s51, 0x7fff
s_add_u32 s51, s51, s50
buffer_load_dwordx4 v[160:163], v6, s[84:87], s51 offen offset:0 sc1
s_waitcnt vmcnt(7)
v_mfma_f32_32x32x16_bf16 v[20:35], a[72:75], v[132:135], v[20:35]
v_mfma_f32_32x32x16_bf16 v[36:51], a[76:79], v[132:135], v[36:51]
buffer_load_dwordx4 v[164:167], v6, s[84:87], s51 offen offset:1024 sc1
s_waitcnt vmcnt(7)
v_mfma_f32_32x32x16_bf16 v[20:35], a[80:83], v[136:139], v[20:35]
v_mfma_f32_32x32x16_bf16 v[36:51], a[84:87], v[136:139], v[36:51]
buffer_load_dwordx4 v[168:171], v6, s[84:87], s51 offen offset:2048 sc1
s_waitcnt vmcnt(7)
v_mfma_f32_32x32x16_bf16 v[20:35], a[88:91], v[140:143], v[20:35]
v_mfma_f32_32x32x16_bf16 v[36:51], a[92:95], v[140:143], v[36:51]
buffer_load_dwordx4 v[172:175], v6, s[84:87], s51 offen offset:3072 sc1
s_waitcnt vmcnt(7)
v_mfma_f32_32x32x16_bf16 v[20:35], a[96:99], v[144:147], v[20:35]
v_mfma_f32_32x32x16_bf16 v[36:51], a[100:103], v[144:147], v[36:51]
s_add_u32 s51, s56, 20480
s_and_b32 s51, s51, 0x7fff
s_add_u32 s51, s51, s50
buffer_load_dwordx4 v[176:179], v6, s[84:87], s51 offen offset:0 sc1
s_waitcnt vmcnt(7)
v_mfma_f32_32x32x16_bf16 v[20:35], a[104:107], v[148:151], v[20:35]
v_mfma_f32_32x32x16_bf16 v[36:51], a[108:111], v[148:151], v[36:51]
buffer_load_dwordx4 v[180:183], v6, s[84:87], s51 offen offset:1024 sc1
s_waitcnt vmcnt(7)
v_mfma_f32_32x32x16_bf16 v[20:35], a[112:115], v[152:155], v[20:35]
v_mfma_f32_32x32x16_bf16 v[36:51], a[116:119], v[152:155], v[36:51]
buffer_load_dwordx4 v[184:187], v6, s[84:87], s51 offen offset:2048 sc1
s_waitcnt vmcnt(7)
v_mfma_f32_32x32x16_bf16 v[20:35], a[120:123], v[156:159], v[20:35]
v_mfma_f32_32x32x16_bf16 v[36:51], a[124:127], v[156:159], v[36:51]
buffer_load_dwordx4 v[188:191], v6, s[84:87], s51 offen offset:3072 sc1
s_waitcnt vmcnt(7)
v_mfma_f32_32x32x16_bf16 v[20:35], a[128:131], v[160:163], v[20:35]
v_mfma_f32_32x32x16_bf16 v[36:51], a[132:135], v[160:163], v[36:51]
s_add_u32 s51, s56, 24576
s_and_b32 s51, s51, 0x7fff
s_add_u32 s51, s51, s50
buffer_load_dwordx4 v[192:195], v6, s[84:87], s51 offen offset:0 sc1
s_waitcnt vmcnt(7)
v_mfma_f32_32x32x16_bf16 v[20:35], a[136:139], v[164:167], v[20:35]
v_mfma_f32_32x32x16_bf16 v[36:51], a[140:143], v[164:167], v[36:51]
buffer_load_dwordx4 v[196:199], v6, s[84:87], s51 offen offset:1024 sc1
s_waitcnt vmcnt(7)
v_mfma_f32_32x32x16_bf16 v[20:35], a[144:147], v[168:171], v[20:35]
v_mfma_f32_32x32x16_bf16 v[36:51], a[148:151], v[168:171], v[36:51]
buffer_load_dwordx4 v[200:203], v6, s[84:87], s51 offen offset:2048 sc1
s_waitcnt vmcnt(7)
v_mfma_f32_32x32x16_bf16 v[20:35], a[152:155], v[172:175], v[20:35]
v_mfma_f32_32x32x16_bf16 v[36:51], a[156:159], v[172:175], v[36:51]
buffer_load_dwordx4 v[204:207], v6, s[84:87], s51 offen offset:3072 sc1
s_waitcnt vmcnt(7)
v_mfma_f32_32x32x16_bf16 v[20:35], a[160:163], v[176:179], v[20:35]
v_mfma_f32_32x32x16_bf16 v[36:51], a[164:167], v[176:179], v[36:51]
s_add_u32 s51, s56, 28672
s_and_b32 s51, s51, 0x7fff
s_add_u32 s51, s51, s50
buffer_load_dwordx4 v[208:211], v6, s[84:87], s51 offen offset:0 sc1
s_waitcnt vmcnt(7)
v_mfma_f32_32x32x16_bf16 v[20:35], a[168:171], v[180:183], v[20:35]
v_mfma_f32_32x32x16_bf16 v[36:51], a[172:175], v[180:183], v[36:51]
buffer_load_dwordx4 v[212:215], v6, s[84:87], s51 offen offset:1024 sc1
s_waitcnt vmcnt(7)
v_mfma_f32_32x32x16_bf16 v[20:35], a[176:179], v[184:187], v[20:35]
v_mfma_f32_32x32x16_bf16 v[36:51], a[180:183], v[184:187], v[36:51]
buffer_load_dwordx4 v[216:219], v6, s[84:87], s51 offen offset:2048 sc1
s_waitcnt vmcnt(7)
v_mfma_f32_32x32x16_bf16 v[20:35], a[184:187], v[188:191], v[20:35]
v_mfma_f32_32x32x16_bf16 v[36:51], a[188:191], v[188:191], v[36:51]
buffer_load_dwordx4 v[220:223], v6, s[84:87], s51 offen offset:3072 sc1
s_waitcnt vmcnt(7)
v_mfma_f32_32x32x16_bf16 v[20:35], a[192:195], v[192:195], v[20:35]
v_mfma_f32_32x32x16_bf16 v[36:51], a[196:199], v[192:195], v[36:51]
s_sub_u32 s60, s62, s64
s_lshr_b32 s60, s60, s67
s_bfe_u32 s61, s60, 0x10001
s_and_b32 s60, s60, 1
s_lshl_b32 s60, s60, 12
buffer_load_dwordx4 v[88:91], v13, s[84:87], s60 offen sc1
buffer_load_dword v15, v7, s[84:87], 0 offen sc1
s_waitcnt vmcnt(6)
v_mfma_f32_32x32x16_bf16 v[20:35], a[200:203], v[196:199], v[20:35]
v_mfma_f32_32x32x16_bf16 v[36:51], a[204:207], v[196:199], v[36:51]
s_waitcnt vmcnt(5)
v_mfma_f32_32x32x16_bf16 v[20:35], a[208:211], v[200:203], v[20:35]
v_mfma_f32_32x32x16_bf16 v[36:51], a[212:215], v[200:203], v[36:51]
s_waitcnt vmcnt(4)
v_mfma_f32_32x32x16_bf16 v[20:35], a[216:219], v[204:207], v[20:35]
v_mfma_f32_32x32x16_bf16 v[36:51], a[220:223], v[204:207], v[36:51]
s_waitcnt vmcnt(3)
v_mfma_f32_32x32x16_bf16 v[20:35], a[224:227], v[208:211], v[20:35]
v_mfma_f32_32x32x16_bf16 v[36:51], a[228:231], v[208:211], v[36:51]
s_waitcnt vmcnt(2)
v_mfma_f32_32x32x16_bf16 v[20:35], a[232:235], v[212:215], v[20:35]
v_mfma_f32_32x32x16_bf16 v[36:51], a[236:239], v[212:215], v[36:51]
s_waitcnt vmcnt(1)
v_mfma_f32_32x32x16_bf16 v[20:35], a[240:243], v[216:219], v[20:35]
v_mfma_f32_32x32x16_bf16 v[36:51], a[244:247], v[216:219], v[36:51]
s_waitcnt vmcnt(0)
v_mfma_f32_32x32x16_bf16 v[224:239], a[248:251], v[220:223], v[20:35]
v_mfma_f32_32x32x16_bf16 v[240:255], a[252:255], v[220:223], v[36:51]
s_waitcnt vmcnt(0)
mega_kernel_o_fcc:
v_and_b32 v14, 1, v88
v_cmp_ne_u32 vcc, s61, v14
s_cbranch_vccz mega_kernel_o_fck
s_sub_u32 s60, s62, s64
s_lshr_b32 s60, s60, s67
s_bfe_u32 s61, s60, 0x10001
s_and_b32 s60, s60, 1
s_lshl_b32 s60, s60, 12
buffer_load_dwordx4 v[88:91], v13, s[84:87], s60 offen sc1
s_waitcnt vmcnt(0)
s_branch mega_kernel_o_fcc
mega_kernel_o_fck:
v_pk_add_f32 v[88:89], v[88:89], v[84:85]
v_pk_add_f32 v[90:91], v[90:91], v[86:87]
s_lshl_b32 s60, s62, 17
v_cvt_pk_bf16_f32 v92, v88, v89
v_cvt_pk_bf16_f32 v93, v90, v91
buffer_store_dwordx2 v[92:93], v11, s[8:11], s60 offen sc1
s_lshl_b32 s50, s54, 18
s_branch mega_kernel_o_imm
mega_kernel_o_im2:
v_add_u32 v2, s53, v8
v_add_u32 v3, s53, v9
v_add_u32 v4, s53, v10
ds_write_b128 v2, v[224:227] offset:0
ds_write_b128 v2, v[228:231] offset:1088
ds_write_b128 v2, v[232:235] offset:2176
ds_write_b128 v2, v[236:239] offset:3264
ds_write_b128 v2, v[240:243] offset:4352
ds_write_b128 v2, v[244:247] offset:5440
ds_write_b128 v2, v[248:251] offset:6528
ds_write_b128 v2, v[252:255] offset:7616
s_waitcnt lgkmcnt(0)
s_barrier
ds_read_b128 v[52:55], v4 offset:0
ds_read_b128 v[56:59], v4 offset:8704
ds_read_b128 v[60:63], v4 offset:17408
ds_read_b128 v[64:67], v4 offset:26112
ds_read_b128 v[68:71], v3 offset:0
ds_read_b128 v[72:75], v3 offset:8704
ds_read_b128 v[76:79], v3 offset:17408
ds_read_b128 v[80:83], v3 offset:26112
s_sub_u32 s53, 34816, s53
s_sub_u32 s60, s42, s64
s_lshr_b32 s60, s60, s67
s_bfe_u32 s61, s60, 0x10001
s_and_b32 s60, s60, 1
s_lshl_b32 s60, s60, 12
s_waitcnt lgkmcnt(4)
v_add_f32 v52, v52, v56
v_add_f32 v60, v60, v64
v_add_f32 v53, v53, v57
v_add_f32 v61, v61, v65
v_add_f32 v54, v54, v58
v_add_f32 v62, v62, v66
v_add_f32 v55, v55, v59
v_add_f32 v63, v63, v67
v_add_f32 v52, v52, v60
v_add_f32 v53, v53, v61
v_add_f32 v54, v54, v62
v_add_f32 v55, v55, v63
v_and_or_b32 v52, v52, -2, s61
s_cmp_eq_u32 s95, 0
s_cbranch_scc1 mega_kernel_o_sa4
buffer_store_dwordx4 v[52:55], v12, s[84:87], s60 offen sc1
s_branch mega_kernel_o_sb4
mega_kernel_o_sa4:
buffer_store_dwordx4 v[52:55], v12, s[84:87], s60 offen
mega_kernel_o_sb4:
s_waitcnt lgkmcnt(0)
v_add_f32 v68, v68, v72
v_add_f32 v76, v76, v80
v_add_f32 v69, v69, v73
v_add_f32 v77, v77, v81
v_add_f32 v70, v70, v74
v_add_f32 v78, v78, v82
v_add_f32 v71, v71, v75
v_add_f32 v79, v79, v83
v_add_f32 v84, v68, v76
v_add_f32 v85, v69, v77
v_add_f32 v86, v70, v78
v_add_f32 v87, v71, v79
s_sub_u32 s60, s42, s64
s_lshr_b32 s60, s60, s67
s_bfe_u32 s61, s60, 0x10001
s_and_b32 s60, s60, 1
s_lshl_b32 s60, s60, 12
buffer_load_dwordx4 v[88:91], v13, s[84:87], s60 offen sc1
s_waitcnt vmcnt(0)
mega_kernel_o_f2c:
v_and_b32 v14, 1, v88
v_cmp_ne_u32 vcc, s61, v14
s_cbranch_vccz mega_kernel_o_f2k
s_sub_u32 s60, s42, s64
s_lshr_b32 s60, s60, s67
s_bfe_u32 s61, s60, 0x10001
s_and_b32 s60, s60, 1
s_lshl_b32 s60, s60, 12
buffer_load_dwordx4 v[88:91], v13, s[84:87], s60 offen sc1
s_waitcnt vmcnt(0)
s_branch mega_kernel_o_f2c
mega_kernel_o_f2k:
v_pk_add_f32 v[88:89], v[88:89], v[84:85]
v_pk_add_f32 v[90:91], v[90:91], v[86:87]
s_lshl_b32 s60, s42, 17
v_cvt_pk_bf16_f32 v92, v88, v89
v_cvt_pk_bf16_f32 v93, v90, v91
buffer_store_dwordx2 v[92:93], v11, s[8:11], s60 offen sc1
s_add_u32 s42, s42, s71
s_cmp_lt_u32 s42, s65
s_cbranch_scc1 mega_kernel_o_cold
mega_kernel_o_quit:
s_endpgm
mega_kernel_exit:
s_endpgm
mega_kernel_recf:
s_load_dwordx2 s[20:21], s[0:1], 8
s_load_dwordx2 s[16:17], s[0:1], 40
s_load_dwordx2 s[4:5], s[0:1], 16
s_load_dwordx2 s[8:9], s[0:1], 24
s_load_dwordx2 s[12:13], s[0:1], 32
v_lshrrev_b32 v4, 6, v0
v_and_b32 v1, 63, v0
v_readfirstlane_b32 s24, v4
v_lshrrev_b32 v2, 4, v1
v_and_b32 v3, 15, v1
v_lshlrev_b32 v17, 4, v1
s_lshr_b32 s28, s31, 2
s_lshl_b32 s25, s30, 3
s_add_u32 s25, s25, s28
s_and_b32 s26, s31, 3
s_waitcnt lgkmcnt(0)
s_mov_b32 s22, 16384
s_mov_b32 s23, 0x00020000
s_mov_b32 s18, 8388608
s_mov_b32 s19, 0x00020000
s_mov_b32 s6, 8388608
s_mov_b32 s7, 0x00020000
s_mov_b32 s10, 8388608
s_mov_b32 s11, 0x00020000
s_mov_b32 s14, 8388608
s_mov_b32 s15, 0x00020000
s_lshl_b32 s28, s25, 8
s_lshr_b32 s29, s26, 0
s_lshl_b32 s29, s29, 6
s_add_u32 s28, s28, s29
s_lshl_b32 s29, s24, 21
s_add_u32 s28, s28, s29
v_lshrrev_b32 v4, 2, v1
v_and_b32 v5, 3, v1
v_lshlrev_b32 v40, 13, v4
v_lshl_add_u32 v40, v5, 4, v40
v_add_u32 v40, s28, v40
s_lshl_b32 s28, s30, 21
s_lshl_b32 s29, s24, 19
s_add_u32 s28, s28, s29
s_lshr_b32 s29, s31, 0
s_lshl_b32 s29, s29, 6
s_add_u32 s28, s28, s29
v_lshlrev_b32 v41, 11, v4
v_lshl_add_u32 v41, v5, 4, v41
v_add_u32 v41, s28, v41
s_lshl_b32 s47, s24, 15
s_add_u32 s47, s47, 32768
s_lshl_b32 s28, s31, 18
s_lshl_b32 s29, s24, 16
s_add_u32 s28, s28, s29
s_lshl_b32 s29, s30, 11
s_add_u32 s28, s28, s29
v_lshlrev_b32 v48, 13, v2
v_lshl_add_u32 v48, v3, 7, v48
v_add_u32 v48, s28, v48
s_lshl_b32 s28, s30, 21
s_lshl_b32 s29, s31, 16
s_add_u32 s28, s28, s29
s_lshl_b32 s29, s24, 14
s_add_u32 s28, s28, s29
v_lshlrev_b32 v49, 7, v1
v_add_u32 v49, s28, v49
s_and_b32 s76, s31, 1
s_mul_i32 s76, s76, 8
s_and_b32 s28, s31, 15
s_lshl_b32 s28, s28, 4
s_lshl_b32 s29, s24, 8
s_add_u32 s28, s28, s29
v_add_u32 v53, s28, v3
s_lshr_b32 s28, s31, 4
s_lshl_b32 s28, s28, 10
s_add_u32 s28, s28, 384
v_mov_b32 v54, s28
v_mov_b32 v55, 1920
v_cmp_gt_u32 vcc, 32, v1
s_nop 1
v_cndmask_b32 v54, v55, v54, vcc
s_lshl_b32 s29, s30, 11
v_lshl_add_u32 v51, v53, 13, v54
v_add_u32 v51, s29, v51
s_lshl_b32 s29, s30, 21
v_lshl_add_u32 v52, v53, 11, v54
v_add_u32 v52, s29, v52
buffer_load_dword v50, v51, s[8:11], 0 offen
s_xor_b32 s29, s76, 0
s_lshl_b32 s28, s29, 10
s_add_u32 s28, s28, s47
s_add_u32 m0, s28, 0
s_lshl_b32 s29, s29, 17
buffer_load_dwordx4 v40, s[8:11], s29 offen lds
s_xor_b32 s29, s76, 1
s_lshl_b32 s28, s29, 10
s_add_u32 s28, s28, s47
s_add_u32 m0, s28, 0
s_lshl_b32 s29, s29, 17
buffer_load_dwordx4 v40, s[8:11], s29 offen lds
s_xor_b32 s29, s76, 2
s_lshl_b32 s28, s29, 10
s_add_u32 s28, s28, s47
s_add_u32 m0, s28, 0
s_lshl_b32 s29, s29, 17
buffer_load_dwordx4 v40, s[8:11], s29 offen lds
s_xor_b32 s29, s76, 3
s_lshl_b32 s28, s29, 10
s_add_u32 s28, s28, s47
s_add_u32 m0, s28, 0
s_lshl_b32 s29, s29, 17
buffer_load_dwordx4 v40, s[8:11], s29 offen lds
s_xor_b32 s29, s76, 4
s_lshl_b32 s28, s29, 10
s_add_u32 s28, s28, s47
s_add_u32 m0, s28, 0
s_lshl_b32 s29, s29, 17
buffer_load_dwordx4 v40, s[8:11], s29 offen lds
s_xor_b32 s29, s76, 5
s_lshl_b32 s28, s29, 10
s_add_u32 s28, s28, s47
s_add_u32 m0, s28, 0
s_lshl_b32 s29, s29, 17
buffer_load_dwordx4 v40, s[8:11], s29 offen lds
s_xor_b32 s29, s76, 6
s_lshl_b32 s28, s29, 10
s_add_u32 s28, s28, s47
s_add_u32 m0, s28, 0
s_lshl_b32 s29, s29, 17
buffer_load_dwordx4 v40, s[8:11], s29 offen lds
s_xor_b32 s29, s76, 7
s_lshl_b32 s28, s29, 10
s_add_u32 s28, s28, s47
s_add_u32 m0, s28, 0
s_lshl_b32 s29, s29, 17
buffer_load_dwordx4 v40, s[8:11], s29 offen lds
s_xor_b32 s29, s76, 8
s_lshl_b32 s28, s29, 10
s_add_u32 s28, s28, s47
s_add_u32 m0, s28, 0
s_lshl_b32 s29, s29, 17
buffer_load_dwordx4 v40, s[8:11], s29 offen lds
s_xor_b32 s29, s76, 9
s_lshl_b32 s28, s29, 10
s_add_u32 s28, s28, s47
s_add_u32 m0, s28, 0
s_lshl_b32 s29, s29, 17
buffer_load_dwordx4 v40, s[8:11], s29 offen lds
s_xor_b32 s29, s76, 10
s_lshl_b32 s28, s29, 10
s_add_u32 s28, s28, s47
s_add_u32 m0, s28, 0
s_lshl_b32 s29, s29, 17
buffer_load_dwordx4 v40, s[8:11], s29 offen lds
s_xor_b32 s29, s76, 11
s_lshl_b32 s28, s29, 10
s_add_u32 s28, s28, s47
s_add_u32 m0, s28, 0
s_lshl_b32 s29, s29, 17
buffer_load_dwordx4 v40, s[8:11], s29 offen lds
s_xor_b32 s29, s76, 12
s_lshl_b32 s28, s29, 10
s_add_u32 s28, s28, s47
s_add_u32 m0, s28, 0
s_lshl_b32 s29, s29, 17
buffer_load_dwordx4 v40, s[8:11], s29 offen lds
s_xor_b32 s29, s76, 13
s_lshl_b32 s28, s29, 10
s_add_u32 s28, s28, s47
s_add_u32 m0, s28, 0
s_lshl_b32 s29, s29, 17
buffer_load_dwordx4 v40, s[8:11], s29 offen lds
s_xor_b32 s29, s76, 14
s_lshl_b32 s28, s29, 10
s_add_u32 s28, s28, s47
s_add_u32 m0, s28, 0
s_lshl_b32 s29, s29, 17
buffer_load_dwordx4 v40, s[8:11], s29 offen lds
s_xor_b32 s29, s76, 15
s_lshl_b32 s28, s29, 10
s_add_u32 s28, s28, s47
s_add_u32 m0, s28, 0
s_lshl_b32 s29, s29, 17
buffer_load_dwordx4 v40, s[8:11], s29 offen lds
buffer_load_dword v50, v51, s[12:15], 0 offen
s_xor_b32 s29, s76, 0
s_lshl_b32 s28, s29, 10
s_add_u32 s28, s28, s47
s_add_u32 m0, s28, 16384
s_lshl_b32 s29, s29, 17
buffer_load_dwordx4 v40, s[12:15], s29 offen lds
s_xor_b32 s29, s76, 1
s_lshl_b32 s28, s29, 10
s_add_u32 s28, s28, s47
s_add_u32 m0, s28, 16384
s_lshl_b32 s29, s29, 17
buffer_load_dwordx4 v40, s[12:15], s29 offen lds
s_xor_b32 s29, s76, 2
s_lshl_b32 s28, s29, 10
s_add_u32 s28, s28, s47
s_add_u32 m0, s28, 16384
s_lshl_b32 s29, s29, 17
buffer_load_dwordx4 v40, s[12:15], s29 offen lds
s_xor_b32 s29, s76, 3
s_lshl_b32 s28, s29, 10
s_add_u32 s28, s28, s47
s_add_u32 m0, s28, 16384
s_lshl_b32 s29, s29, 17
buffer_load_dwordx4 v40, s[12:15], s29 offen lds
s_xor_b32 s29, s76, 4
s_lshl_b32 s28, s29, 10
s_add_u32 s28, s28, s47
s_add_u32 m0, s28, 16384
s_lshl_b32 s29, s29, 17
buffer_load_dwordx4 v40, s[12:15], s29 offen lds
s_xor_b32 s29, s76, 5
s_lshl_b32 s28, s29, 10
s_add_u32 s28, s28, s47
s_add_u32 m0, s28, 16384
s_lshl_b32 s29, s29, 17
buffer_load_dwordx4 v40, s[12:15], s29 offen lds
s_xor_b32 s29, s76, 6
s_lshl_b32 s28, s29, 10
s_add_u32 s28, s28, s47
s_add_u32 m0, s28, 16384
s_lshl_b32 s29, s29, 17
buffer_load_dwordx4 v40, s[12:15], s29 offen lds
s_xor_b32 s29, s76, 7
s_lshl_b32 s28, s29, 10
s_add_u32 s28, s28, s47
s_add_u32 m0, s28, 16384
s_lshl_b32 s29, s29, 17
buffer_load_dwordx4 v40, s[12:15], s29 offen lds
s_xor_b32 s29, s76, 8
s_lshl_b32 s28, s29, 10
s_add_u32 s28, s28, s47
s_add_u32 m0, s28, 16384
s_lshl_b32 s29, s29, 17
buffer_load_dwordx4 v40, s[12:15], s29 offen lds
s_xor_b32 s29, s76, 9
s_lshl_b32 s28, s29, 10
s_add_u32 s28, s28, s47
s_add_u32 m0, s28, 16384
s_lshl_b32 s29, s29, 17
buffer_load_dwordx4 v40, s[12:15], s29 offen lds
s_xor_b32 s29, s76, 10
s_lshl_b32 s28, s29, 10
s_add_u32 s28, s28, s47
s_add_u32 m0, s28, 16384
s_lshl_b32 s29, s29, 17
buffer_load_dwordx4 v40, s[12:15], s29 offen lds
s_xor_b32 s29, s76, 11
s_lshl_b32 s28, s29, 10
s_add_u32 s28, s28, s47
s_add_u32 m0, s28, 16384
s_lshl_b32 s29, s29, 17
buffer_load_dwordx4 v40, s[12:15], s29 offen lds
s_xor_b32 s29, s76, 12
s_lshl_b32 s28, s29, 10
s_add_u32 s28, s28, s47
s_add_u32 m0, s28, 16384
s_lshl_b32 s29, s29, 17
buffer_load_dwordx4 v40, s[12:15], s29 offen lds
s_xor_b32 s29, s76, 13
s_lshl_b32 s28, s29, 10
s_add_u32 s28, s28, s47
s_add_u32 m0, s28, 16384
s_lshl_b32 s29, s29, 17
buffer_load_dwordx4 v40, s[12:15], s29 offen lds
s_xor_b32 s29, s76, 14
s_lshl_b32 s28, s29, 10
s_add_u32 s28, s28, s47
s_add_u32 m0, s28, 16384
s_lshl_b32 s29, s29, 17
buffer_load_dwordx4 v40, s[12:15], s29 offen lds
s_xor_b32 s29, s76, 15
s_lshl_b32 s28, s29, 10
s_add_u32 s28, s28, s47
s_add_u32 m0, s28, 16384
s_lshl_b32 s29, s29, 17
buffer_load_dwordx4 v40, s[12:15], s29 offen lds
s_mov_b32 s40, 0x00ff00ff
s_mov_b32 s41, 0x00ff00ff
s_mov_b32 s48, 0xff00ff00
s_mov_b32 s49, 0xff00ff00
s_mov_b32 s42, 0
s_mov_b32 s43, 0x00ff00ff
s_mov_b32 s32, 0x3e0293ee
v_mov_b32 v23, 0xff800000
v_mov_b32 v6, 0x4444
v_mov_b32 v4, 0xeeee
v_cndmask_b32 v6, v6, v4, s[48:49]
v_mov_b32 v28, -1
v_mov_b32 v29, -1
v_mov_b32 v30, -1
v_mov_b32 v31, -1
s_mul_i32 s28, s24, 4096
v_add_u32 v7, s28, v17
v_and_b32 v4, 7, v1
v_lshlrev_b32 v8, 11, v4
v_lshrrev_b32 v5, 3, v1
v_lshl_add_u32 v8, v5, 4, v8
s_lshl_b32 s28, s24, 9
v_add_u32 v8, s28, v8
s_lshl_b32 s28, s31, 9
s_lshr_b32 s29, s31, 3
s_mul_i32 s29, s29, 0
s_add_u32 s28, s28, s29
v_lshlrev_b32 v9, 3, v1
v_add_u32 v9, s28, v9
v_and_b32 v4, 7, v3
v_lshlrev_b32 v11, 7, v2
v_lshl_add_u32 v11, v4, 4, v11
v_add_u32 v22, 0, v11
s_add_u32 s28, s28, 24576
v_add_u32 v11, s28, v11
v_and_b32 v5, 1, v2
v_lshlrev_b32 v10, 7, v5
v_lshl_add_u32 v10, v4, 4, v10
v_add_u32 v10, 1024, v10
s_xor_b32 s37, s31, 1
s_mul_i32 s37, s37, 2048
s_add_u32 s37, s37, 49152
s_xor_b32 s38, s31, 2
s_mul_i32 s38, s38, 2048
s_add_u32 s38, s38, 49152
s_xor_b32 s39, s31, 3
s_mul_i32 s39, s39, 2048
s_add_u32 s39, s39, 49152
v_and_b32 v4, 1, v2
v_mul_u32_u24 v14, 576, v4
v_lshrrev_b32 v5, 1, v2
v_lshl_add_u32 v5, v5, 4, v3
v_lshl_add_u32 v14, v5, 2, v14
s_mul_i32 s28, s24, 1152
s_add_u32 s28, s28, 13312
v_add_u32 v18, s28, v14
s_mul_i32 s28, s24, 2304
v_add_u32 v14, s28, v14
v_add_u32 v15, 1152, v14
v_mul_u32_u24 v16, 144, v3
v_lshl_add_u32 v16, v2, 5, v16
v_bfe_u32 v4, v1, 1, 3
v_mul_u32_u24 v19, 144, v4
v_lshl_add_u32 v19, v2, 5, v19
v_and_b32 v4, 1, v1
v_lshl_add_u32 v19, v4, 4, v19
v_add_u32 v19, 13312, v19
s_lshl_b32 s28, s24, 10
s_add_u32 s28, s28, 9216
v_add_u32 v20, s28, v17
v_and_b32 v4, 31, v1
v_lshlrev_b32 v21, 3, v4
v_add_u32 v21, 17920, v21
v_lshrrev_b32 v4, 2, v3
v_and_b32 v42, 1, v4
v_lshrrev_b32 v43, 1, v4
v_lshrrev_b32 v44, 1, v2
v_and_b32 v45, 1, v2
v_lshl_add_u32 v46, v44, 4, v42
v_lshl_add_u32 v46, v45, 2, v46
v_lshl_add_u32 v46, v43, 3, v46
v_lshl_add_u32 v47, v44, 3, v42
v_lshl_add_u32 v47, v45, 4, v47
v_lshl_add_u32 v47, v43, 2, v47
v_and_b32 v5, 3, v3
v_lshlrev_b32 v5, 3, v5
v_lshl_add_u32 v46, v46, 6, v5
v_lshl_add_u32 v47, v47, 6, v5
s_and_b32 s28, s31, 0
s_lshl_b32 s28, s28, 6
s_add_u32 s28, s28, s47
v_add_u32 v46, s28, v46
v_add_u32 v47, s28, v47
s_waitcnt vmcnt(17)
ds_read_b64_tr_b16 a[64:65], v46 offset:0
ds_read_b64_tr_b16 a[66:67], v46 offset:128
ds_read_b64_tr_b16 a[68:69], v46 offset:2048
ds_read_b64_tr_b16 a[70:71], v46 offset:2176
ds_read_b64_tr_b16 a[72:73], v46 offset:4096
ds_read_b64_tr_b16 a[74:75], v46 offset:4224
ds_read_b64_tr_b16 a[76:77], v46 offset:6144
ds_read_b64_tr_b16 a[78:79], v46 offset:6272
s_waitcnt lgkmcnt(0)
ds_read_b64_tr_b16 a[80:81], v46 offset:8192
ds_read_b64_tr_b16 a[82:83], v46 offset:8320
ds_read_b64_tr_b16 a[84:85], v46 offset:10240
ds_read_b64_tr_b16 a[86:87], v46 offset:10368
ds_read_b64_tr_b16 a[88:89], v46 offset:12288
ds_read_b64_tr_b16 a[90:91], v46 offset:12416
ds_read_b64_tr_b16 a[92:93], v46 offset:14336
ds_read_b64_tr_b16 a[94:95], v46 offset:14464
s_waitcnt lgkmcnt(0)
ds_read_b64_tr_b16 a[96:97], v46 offset:32
ds_read_b64_tr_b16 a[98:99], v46 offset:160
ds_read_b64_tr_b16 a[100:101], v46 offset:2080
ds_read_b64_tr_b16 a[102:103], v46 offset:2208
ds_read_b64_tr_b16 a[104:105], v46 offset:4128
ds_read_b64_tr_b16 a[106:107], v46 offset:4256
ds_read_b64_tr_b16 a[108:109], v46 offset:6176
ds_read_b64_tr_b16 a[110:111], v46 offset:6304
s_waitcnt lgkmcnt(0)
ds_read_b64_tr_b16 a[112:113], v46 offset:8224
ds_read_b64_tr_b16 a[114:115], v46 offset:8352
ds_read_b64_tr_b16 a[116:117], v46 offset:10272
ds_read_b64_tr_b16 a[118:119], v46 offset:10400
ds_read_b64_tr_b16 a[120:121], v46 offset:12320
ds_read_b64_tr_b16 a[122:123], v46 offset:12448
ds_read_b64_tr_b16 a[124:125], v46 offset:14368
ds_read_b64_tr_b16 a[126:127], v46 offset:14496
s_waitcnt lgkmcnt(0)
buffer_load_dword v50, v51, s[4:7], 0 offen
s_xor_b32 s29, s76, 0
s_lshl_b32 s28, s29, 10
s_add_u32 s28, s28, s47
s_add_u32 m0, s28, 0
s_lshl_b32 s29, s29, 17
buffer_load_dwordx4 v40, s[4:7], s29 offen lds
s_xor_b32 s29, s76, 1
s_lshl_b32 s28, s29, 10
s_add_u32 s28, s28, s47
s_add_u32 m0, s28, 0
s_lshl_b32 s29, s29, 17
buffer_load_dwordx4 v40, s[4:7], s29 offen lds
s_xor_b32 s29, s76, 2
s_lshl_b32 s28, s29, 10
s_add_u32 s28, s28, s47
s_add_u32 m0, s28, 0
s_lshl_b32 s29, s29, 17
buffer_load_dwordx4 v40, s[4:7], s29 offen lds
s_xor_b32 s29, s76, 3
s_lshl_b32 s28, s29, 10
s_add_u32 s28, s28, s47
s_add_u32 m0, s28, 0
s_lshl_b32 s29, s29, 17
buffer_load_dwordx4 v40, s[4:7], s29 offen lds
s_xor_b32 s29, s76, 4
s_lshl_b32 s28, s29, 10
s_add_u32 s28, s28, s47
s_add_u32 m0, s28, 0
s_lshl_b32 s29, s29, 17
buffer_load_dwordx4 v40, s[4:7], s29 offen lds
s_xor_b32 s29, s76, 5
s_lshl_b32 s28, s29, 10
s_add_u32 s28, s28, s47
s_add_u32 m0, s28, 0
s_lshl_b32 s29, s29, 17
buffer_load_dwordx4 v40, s[4:7], s29 offen lds
s_xor_b32 s29, s76, 6
s_lshl_b32 s28, s29, 10
s_add_u32 s28, s28, s47
s_add_u32 m0, s28, 0
s_lshl_b32 s29, s29, 17
buffer_load_dwordx4 v40, s[4:7], s29 offen lds
s_xor_b32 s29, s76, 7
s_lshl_b32 s28, s29, 10
s_add_u32 s28, s28, s47
s_add_u32 m0, s28, 0
s_lshl_b32 s29, s29, 17
buffer_load_dwordx4 v40, s[4:7], s29 offen lds
s_xor_b32 s29, s76, 8
s_lshl_b32 s28, s29, 10
s_add_u32 s28, s28, s47
s_add_u32 m0, s28, 0
s_lshl_b32 s29, s29, 17
buffer_load_dwordx4 v40, s[4:7], s29 offen lds
s_xor_b32 s29, s76, 9
s_lshl_b32 s28, s29, 10
s_add_u32 s28, s28, s47
s_add_u32 m0, s28, 0
s_lshl_b32 s29, s29, 17
buffer_load_dwordx4 v40, s[4:7], s29 offen lds
s_xor_b32 s29, s76, 10
s_lshl_b32 s28, s29, 10
s_add_u32 s28, s28, s47
s_add_u32 m0, s28, 0
s_lshl_b32 s29, s29, 17
buffer_load_dwordx4 v40, s[4:7], s29 offen lds
s_xor_b32 s29, s76, 11
s_lshl_b32 s28, s29, 10
s_add_u32 s28, s28, s47
s_add_u32 m0, s28, 0
s_lshl_b32 s29, s29, 17
buffer_load_dwordx4 v40, s[4:7], s29 offen lds
s_xor_b32 s29, s76, 12
s_lshl_b32 s28, s29, 10
s_add_u32 s28, s28, s47
s_add_u32 m0, s28, 0
s_lshl_b32 s29, s29, 17
buffer_load_dwordx4 v40, s[4:7], s29 offen lds
s_xor_b32 s29, s76, 13
s_lshl_b32 s28, s29, 10
s_add_u32 s28, s28, s47
s_add_u32 m0, s28, 0
s_lshl_b32 s29, s29, 17
buffer_load_dwordx4 v40, s[4:7], s29 offen lds
s_xor_b32 s29, s76, 14
s_lshl_b32 s28, s29, 10
s_add_u32 s28, s28, s47
s_add_u32 m0, s28, 0
s_lshl_b32 s29, s29, 17
buffer_load_dwordx4 v40, s[4:7], s29 offen lds
s_xor_b32 s29, s76, 15
s_lshl_b32 s28, s29, 10
s_add_u32 s28, s28, s47
s_add_u32 m0, s28, 0
s_lshl_b32 s29, s29, 17
buffer_load_dwordx4 v40, s[4:7], s29 offen lds
s_waitcnt vmcnt(17)
ds_read_b64_tr_b16 a[128:129], v46 offset:16384
ds_read_b64_tr_b16 a[130:131], v46 offset:16512
ds_read_b64_tr_b16 a[132:133], v46 offset:18432
ds_read_b64_tr_b16 a[134:135], v46 offset:18560
ds_read_b64_tr_b16 a[136:137], v46 offset:20480
ds_read_b64_tr_b16 a[138:139], v46 offset:20608
ds_read_b64_tr_b16 a[140:141], v46 offset:22528
ds_read_b64_tr_b16 a[142:143], v46 offset:22656
s_waitcnt lgkmcnt(0)
ds_read_b64_tr_b16 a[144:145], v46 offset:24576
ds_read_b64_tr_b16 a[146:147], v46 offset:24704
ds_read_b64_tr_b16 a[148:149], v46 offset:26624
ds_read_b64_tr_b16 a[150:151], v46 offset:26752
ds_read_b64_tr_b16 a[152:153], v46 offset:28672
ds_read_b64_tr_b16 a[154:155], v46 offset:28800
ds_read_b64_tr_b16 a[156:157], v46 offset:30720
ds_read_b64_tr_b16 a[158:159], v46 offset:30848
s_waitcnt lgkmcnt(0)
ds_read_b64_tr_b16 a[160:161], v46 offset:16416
ds_read_b64_tr_b16 a[162:163], v46 offset:16544
ds_read_b64_tr_b16 a[164:165], v46 offset:18464
ds_read_b64_tr_b16 a[166:167], v46 offset:18592
ds_read_b64_tr_b16 a[168:169], v46 offset:20512
ds_read_b64_tr_b16 a[170:171], v46 offset:20640
ds_read_b64_tr_b16 a[172:173], v46 offset:22560
ds_read_b64_tr_b16 a[174:175], v46 offset:22688
s_waitcnt lgkmcnt(0)
ds_read_b64_tr_b16 a[176:177], v46 offset:24608
ds_read_b64_tr_b16 a[178:179], v46 offset:24736
ds_read_b64_tr_b16 a[180:181], v46 offset:26656
ds_read_b64_tr_b16 a[182:183], v46 offset:26784
ds_read_b64_tr_b16 a[184:185], v46 offset:28704
ds_read_b64_tr_b16 a[186:187], v46 offset:28832
ds_read_b64_tr_b16 a[188:189], v46 offset:30752
ds_read_b64_tr_b16 a[190:191], v46 offset:30880
s_waitcnt lgkmcnt(0)
buffer_load_dword v50, v52, s[16:19], 0 offen
s_xor_b32 s29, s76, 0
s_lshl_b32 s28, s29, 10
s_add_u32 s28, s28, s47
s_add_u32 m0, s28, 16384
s_lshl_b32 s29, s29, 15
buffer_load_dwordx4 v41, s[16:19], s29 offen lds
s_xor_b32 s29, s76, 1
s_lshl_b32 s28, s29, 10
s_add_u32 s28, s28, s47
s_add_u32 m0, s28, 16384
s_lshl_b32 s29, s29, 15
buffer_load_dwordx4 v41, s[16:19], s29 offen lds
s_xor_b32 s29, s76, 2
s_lshl_b32 s28, s29, 10
s_add_u32 s28, s28, s47
s_add_u32 m0, s28, 16384
s_lshl_b32 s29, s29, 15
buffer_load_dwordx4 v41, s[16:19], s29 offen lds
s_xor_b32 s29, s76, 3
s_lshl_b32 s28, s29, 10
s_add_u32 s28, s28, s47
s_add_u32 m0, s28, 16384
s_lshl_b32 s29, s29, 15
buffer_load_dwordx4 v41, s[16:19], s29 offen lds
s_xor_b32 s29, s76, 4
s_lshl_b32 s28, s29, 10
s_add_u32 s28, s28, s47
s_add_u32 m0, s28, 16384
s_lshl_b32 s29, s29, 15
buffer_load_dwordx4 v41, s[16:19], s29 offen lds
s_xor_b32 s29, s76, 5
s_lshl_b32 s28, s29, 10
s_add_u32 s28, s28, s47
s_add_u32 m0, s28, 16384
s_lshl_b32 s29, s29, 15
buffer_load_dwordx4 v41, s[16:19], s29 offen lds
s_xor_b32 s29, s76, 6
s_lshl_b32 s28, s29, 10
s_add_u32 s28, s28, s47
s_add_u32 m0, s28, 16384
s_lshl_b32 s29, s29, 15
buffer_load_dwordx4 v41, s[16:19], s29 offen lds
s_xor_b32 s29, s76, 7
s_lshl_b32 s28, s29, 10
s_add_u32 s28, s28, s47
s_add_u32 m0, s28, 16384
s_lshl_b32 s29, s29, 15
buffer_load_dwordx4 v41, s[16:19], s29 offen lds
s_xor_b32 s29, s76, 8
s_lshl_b32 s28, s29, 10
s_add_u32 s28, s28, s47
s_add_u32 m0, s28, 16384
s_lshl_b32 s29, s29, 15
buffer_load_dwordx4 v41, s[16:19], s29 offen lds
s_xor_b32 s29, s76, 9
s_lshl_b32 s28, s29, 10
s_add_u32 s28, s28, s47
s_add_u32 m0, s28, 16384
s_lshl_b32 s29, s29, 15
buffer_load_dwordx4 v41, s[16:19], s29 offen lds
s_xor_b32 s29, s76, 10
s_lshl_b32 s28, s29, 10
s_add_u32 s28, s28, s47
s_add_u32 m0, s28, 16384
s_lshl_b32 s29, s29, 15
buffer_load_dwordx4 v41, s[16:19], s29 offen lds
s_xor_b32 s29, s76, 11
s_lshl_b32 s28, s29, 10
s_add_u32 s28, s28, s47
s_add_u32 m0, s28, 16384
s_lshl_b32 s29, s29, 15
buffer_load_dwordx4 v41, s[16:19], s29 offen lds
s_xor_b32 s29, s76, 12
s_lshl_b32 s28, s29, 10
s_add_u32 s28, s28, s47
s_add_u32 m0, s28, 16384
s_lshl_b32 s29, s29, 15
buffer_load_dwordx4 v41, s[16:19], s29 offen lds
s_xor_b32 s29, s76, 13
s_lshl_b32 s28, s29, 10
s_add_u32 s28, s28, s47
s_add_u32 m0, s28, 16384
s_lshl_b32 s29, s29, 15
buffer_load_dwordx4 v41, s[16:19], s29 offen lds
s_xor_b32 s29, s76, 14
s_lshl_b32 s28, s29, 10
s_add_u32 s28, s28, s47
s_add_u32 m0, s28, 16384
s_lshl_b32 s29, s29, 15
buffer_load_dwordx4 v41, s[16:19], s29 offen lds
s_xor_b32 s29, s76, 15
s_lshl_b32 s28, s29, 10
s_add_u32 s28, s28, s47
s_add_u32 m0, s28, 16384
s_lshl_b32 s29, s29, 15
buffer_load_dwordx4 v41, s[16:19], s29 offen lds
s_waitcnt vmcnt(17)
ds_read_b64_tr_b16 a[0:1], v46 offset:0
ds_read_b64_tr_b16 a[2:3], v46 offset:128
ds_read_b64_tr_b16 a[4:5], v46 offset:2048
ds_read_b64_tr_b16 a[6:7], v46 offset:2176
ds_read_b64_tr_b16 a[8:9], v46 offset:4096
ds_read_b64_tr_b16 a[10:11], v46 offset:4224
ds_read_b64_tr_b16 a[12:13], v46 offset:6144
ds_read_b64_tr_b16 a[14:15], v46 offset:6272
s_waitcnt lgkmcnt(0)
ds_read_b64_tr_b16 a[16:17], v46 offset:8192
ds_read_b64_tr_b16 a[18:19], v46 offset:8320
ds_read_b64_tr_b16 a[20:21], v46 offset:10240
ds_read_b64_tr_b16 a[22:23], v46 offset:10368
ds_read_b64_tr_b16 a[24:25], v46 offset:12288
ds_read_b64_tr_b16 a[26:27], v46 offset:12416
ds_read_b64_tr_b16 a[28:29], v46 offset:14336
ds_read_b64_tr_b16 a[30:31], v46 offset:14464
s_waitcnt lgkmcnt(0)
ds_read_b64_tr_b16 a[32:33], v46 offset:32
ds_read_b64_tr_b16 a[34:35], v46 offset:160
ds_read_b64_tr_b16 a[36:37], v46 offset:2080
ds_read_b64_tr_b16 a[38:39], v46 offset:2208
ds_read_b64_tr_b16 a[40:41], v46 offset:4128
ds_read_b64_tr_b16 a[42:43], v46 offset:4256
ds_read_b64_tr_b16 a[44:45], v46 offset:6176
ds_read_b64_tr_b16 a[46:47], v46 offset:6304
s_waitcnt lgkmcnt(0)
ds_read_b64_tr_b16 a[48:49], v46 offset:8224
ds_read_b64_tr_b16 a[50:51], v46 offset:8352
ds_read_b64_tr_b16 a[52:53], v46 offset:10272
ds_read_b64_tr_b16 a[54:55], v46 offset:10400
ds_read_b64_tr_b16 a[56:57], v46 offset:12320
ds_read_b64_tr_b16 a[58:59], v46 offset:12448
ds_read_b64_tr_b16 a[60:61], v46 offset:14368
ds_read_b64_tr_b16 a[62:63], v46 offset:14496
s_waitcnt lgkmcnt(0)
v_and_b32 v247, 15, v0
v_lshlrev_b32 v247, 4, v247
buffer_load_dword v246, v247, s[72:75], 0 offen sc1
s_waitcnt vmcnt(0)
ds_read_b64_tr_b16 a[192:193], v47 offset:16384
ds_read_b64_tr_b16 a[194:195], v47 offset:16512
ds_read_b64_tr_b16 a[196:197], v47 offset:18432
ds_read_b64_tr_b16 a[198:199], v47 offset:18560
ds_read_b64_tr_b16 a[200:201], v47 offset:20480
ds_read_b64_tr_b16 a[202:203], v47 offset:20608
ds_read_b64_tr_b16 a[204:205], v47 offset:22528
ds_read_b64_tr_b16 a[206:207], v47 offset:22656
s_waitcnt lgkmcnt(0)
ds_read_b64_tr_b16 a[208:209], v47 offset:24576
ds_read_b64_tr_b16 a[210:211], v47 offset:24704
ds_read_b64_tr_b16 a[212:213], v47 offset:26624
ds_read_b64_tr_b16 a[214:215], v47 offset:26752
ds_read_b64_tr_b16 a[216:217], v47 offset:28672
ds_read_b64_tr_b16 a[218:219], v47 offset:28800
ds_read_b64_tr_b16 a[220:221], v47 offset:30720
ds_read_b64_tr_b16 a[222:223], v47 offset:30848
s_waitcnt lgkmcnt(0)
ds_read_b64_tr_b16 a[224:225], v47 offset:16416
ds_read_b64_tr_b16 a[226:227], v47 offset:16544
ds_read_b64_tr_b16 a[228:229], v47 offset:18464
ds_read_b64_tr_b16 a[230:231], v47 offset:18592
ds_read_b64_tr_b16 a[232:233], v47 offset:20512
ds_read_b64_tr_b16 a[234:235], v47 offset:20640
ds_read_b64_tr_b16 a[236:237], v47 offset:22560
ds_read_b64_tr_b16 a[238:239], v47 offset:22688
s_waitcnt lgkmcnt(0)
ds_read_b64_tr_b16 a[240:241], v47 offset:24608
ds_read_b64_tr_b16 a[242:243], v47 offset:24736
ds_read_b64_tr_b16 a[244:245], v47 offset:26656
ds_read_b64_tr_b16 a[246:247], v47 offset:26784
ds_read_b64_tr_b16 a[248:249], v47 offset:28704
ds_read_b64_tr_b16 a[250:251], v47 offset:28832
ds_read_b64_tr_b16 a[252:253], v47 offset:30752
ds_read_b64_tr_b16 a[254:255], v47 offset:30880
s_waitcnt lgkmcnt(0)
v_and_b32 v247, 15, v0
v_lshlrev_b32 v247, 4, v247
s_branch mega_kernel_syrp
mega_kernel_syrw:
s_sleep 4
mega_kernel_syr:
buffer_load_dword v246, v247, s[72:75], 0 offen sc1
s_waitcnt vmcnt(0)
mega_kernel_syrp:
s_cmp_eq_u32 s95, 1
s_cbranch_scc0 mega_kernel_syrf
v_readlane_b32 s76, v246, 14
s_mov_b32 s98, 0
s_cmp_eq_u32 s76, 32
s_cbranch_scc0 mega_kernel_syrw
s_branch mega_kernel_syrd
mega_kernel_syrf:
s_mov_b32 s77, 0
s_mov_b32 s78, 0
v_readlane_b32 s76, v246, 0
s_add_u32 s77, s77, s76
s_xor_b32 s76, s76, 32
s_or_b32 s78, s78, s76
v_readlane_b32 s76, v246, 1
s_add_u32 s77, s77, s76
s_xor_b32 s76, s76, 32
s_or_b32 s78, s78, s76
v_readlane_b32 s76, v246, 2
s_add_u32 s77, s77, s76
s_xor_b32 s76, s76, 32
s_or_b32 s78, s78, s76
v_readlane_b32 s76, v246, 3
s_add_u32 s77, s77, s76
s_xor_b32 s76, s76, 32
s_or_b32 s78, s78, s76
v_readlane_b32 s76, v246, 4
s_add_u32 s77, s77, s76
s_xor_b32 s76, s76, 32
s_or_b32 s78, s78, s76
v_readlane_b32 s76, v246, 5
s_add_u32 s77, s77, s76
s_xor_b32 s76, s76, 32
s_or_b32 s78, s78, s76
v_readlane_b32 s76, v246, 6
s_add_u32 s77, s77, s76
s_xor_b32 s76, s76, 32
s_or_b32 s78, s78, s76
v_readlane_b32 s76, v246, 7
s_add_u32 s77, s77, s76
s_xor_b32 s76, s76, 32
s_or_b32 s78, s78, s76
s_cmp_eq_u32 s77, 256
s_cbranch_scc0 mega_kernel_syrw
v_mov_b32 v252, v246
s_cmp_eq_u32 s78, 0
s_cbranch_scc0 mega_kernel_slowent
v_readlane_b32 s76, v246, 10
v_readlane_b32 s77, v246, 8
s_cmp_eq_u32 s76, 32
s_cbranch_scc0 mega_kernel_syrw
s_cmp_gt_u32 s77, 16
s_cselect_b32 s98, 1, 0
mega_kernel_syrd:
s_lshr_b32 s28, s31, 4
s_lshl_b32 s28, s28, 14
s_lshl_b32 s29, s98, 13
s_add_u32 s28, s28, s29
s_and_b32 s29, s31, 15
s_lshl_b32 s29, s29, 9
s_add_u32 s28, s28, s29
s_lshl_b32 s29, s30, 16
s_add_u32 s28, s28, s29
s_add_u32 s28, s28, 67108864
v_lshrrev_b32 v12, 1, v17
v_add_u32 v12, s28, v12
v_xor_b32 v25, 0x10000, v12
v_xor_b32 v26, 0x20000, v12
v_xor_b32 v27, 0x30000, v12
v_add_u32 v25, 0, v25
v_add_u32 v26, 0, v26
v_add_u32 v27, 0, v27
s_lshl_b32 s28, s25, 2
s_add_u32 s28, s28, s26
s_mov_b32 s82, s28
s_lshr_b32 s29, s28, 3
s_xor_b32 s29, s29, s98
s_and_b32 s29, s29, 1
s_lshl_b32 s29, s29, 13
s_lshl_b32 s76, s28, 18
s_add_u32 s76, s76, s29
s_mov_b32 s83, s76
v_add_u32 v240, s76, v17
v_add_u32 v241, 33554432, v240
s_lshr_b32 s29, s28, 4
s_xor_b32 s29, s29, s98
s_and_b32 s29, s29, 1
s_lshl_b32 s29, s29, 13
s_lshl_b32 s79, s28, 17
s_add_u32 s79, s79, s29
s_add_u32 s79, s79, 71303168
s_xor_b32 s29, s98, 1
s_lshl_b32 s29, s29, 13
s_lshl_b32 s28, s25, 7
s_add_u32 s28, s28, s29
s_add_u32 s28, s28, 69206016
v_and_b32 v4, 1, v1
v_lshlrev_b32 v24, 12, v4
v_add_u32 v24, s28, v24
s_lshl_b32 s29, s26, 2
v_add_u32 v24, s29, v24
s_xor_b32 s81, s98, 1
s_lshl_b32 s81, s81, 13
s_lshr_b32 s29, s82, 6
s_lshl_b32 s29, s29, 14
s_add_u32 s81, s81, s29
s_and_b32 s29, s82, 63
s_lshl_b32 s29, s29, 7
s_add_u32 s81, s81, s29
s_add_u32 s81, s81, 69222400
v_mov_b32 v220, 0x3f803f80
v_mov_b32 v221, 0x3f803f80
v_mov_b32 v222, 0x3f803f80
v_mov_b32 v223, 0x3f803f80
v_mov_b32 v228, 0
s_mov_b32 s27, 0
s_mov_b32 s46, 0
s_mov_b32 s89, 0
s_mov_b32 s88, 0
s_mov_b32 s44, 18432
s_mov_b32 s45, 18432
s_cmp_eq_u32 s24, 3
s_cbranch_scc0 mega_kernel_rf_pfi
s_mov_b32 s76, 0
s_cmp_gt_i32 s46, s76
s_cbranch_scc1 mega_kernel_rf_pf0ok
mega_kernel_rf_pf0w:
v_mov_b32 v4, 0
s_mov_b64 exec, 3
buffer_atomic_add v4, v24, s[84:87], 0 offen sc0 sc1
s_mov_b64 exec, -1
s_waitcnt vmcnt(0)
v_readlane_b32 s46, v4, 0
v_readlane_b32 s28, v4, 1
s_nop 1
s_min_i32 s46, s46, s28
s_cmp_gt_i32 s46, s76
s_cbranch_scc0 mega_kernel_rf_pf0w
mega_kernel_rf_pf0ok:
s_add_u32 s77, s76, s82
s_bfe_u32 s28, s77, 0x40002
s_lshl_b32 s28, s28, 14
s_and_b32 s77, s77, 3
s_lshl_b32 s77, s77, 11
s_add_u32 s28, s28, s77
s_add_u32 m0, s45, 0
s_nop 0
buffer_load_dwordx4 v240, s[84:87], s28 offen offset:0 sc1 lds
s_add_u32 m0, s45, 0
s_nop 0
buffer_load_dwordx4 v240, s[84:87], s28 offen offset:1024 sc1 lds
s_add_u32 m0, s45, 2048
s_nop 0
buffer_load_dwordx4 v241, s[84:87], s28 offen offset:0 sc1 lds
s_add_u32 m0, s45, 2048
s_nop 0
buffer_load_dwordx4 v241, s[84:87], s28 offen offset:1024 sc1 lds
s_add_u32 s45, s45, 4096
s_cmp_eq_u32 s45, 30720
s_cselect_b32 s45, 18432, s45
s_waitcnt vmcnt(0) lgkmcnt(0)
mega_kernel_rf_pfi:
v_mov_b32 v184, 0
v_mov_b32 v185, 0
v_mov_b32 v186, 0
v_mov_b32 v187, 0
v_mov_b32 v188, 0
v_mov_b32 v189, 0
v_mov_b32 v190, 0
v_mov_b32 v191, 0
v_mov_b32 v192, 0
v_mov_b32 v193, 0
v_mov_b32 v194, 0
v_mov_b32 v195, 0
v_mov_b32 v196, 0
v_mov_b32 v197, 0
v_mov_b32 v198, 0
v_mov_b32 v199, 0
v_mov_b32 v200, 0
v_mov_b32 v201, 0
v_mov_b32 v202, 0
v_mov_b32 v203, 0
v_mov_b32 v204, 0
v_mov_b32 v205, 0
v_mov_b32 v206, 0
v_mov_b32 v207, 0
v_mov_b32 v249, 0
v_mov_b32 v96, 0
v_mov_b32 v97, 0
v_mov_b32 v98, 0
v_mov_b32 v99, 0
v_mov_b32 v100, 0
v_mov_b32 v101, 0
v_mov_b32 v102, 0
v_mov_b32 v103, 0
v_mov_b32 v104, 0
v_mov_b32 v105, 0
v_mov_b32 v106, 0
v_mov_b32 v107, 0
v_mov_b32 v108, 0
v_mov_b32 v109, 0
v_mov_b32 v110, 0
v_mov_b32 v111, 0
v_mov_b32 v112, 0
v_mov_b32 v113, 0
v_mov_b32 v114, 0
v_mov_b32 v115, 0
v_mov_b32 v116, 0
v_mov_b32 v117, 0
v_mov_b32 v118, 0
v_mov_b32 v119, 0
s_barrier
s_and_b32 s29, s27, 1
s_lshl_b32 s33, s29, 17
s_lshl_b32 s28, s30, 18
s_add_u32 s33, s33, s28
s_add_u32 s33, s33, 68157440
s_xor_b32 s34, s33, 131072
s_lshl_b32 s35, s29, 18
s_bfe_u32 s47, s27, 0x10001
s_branch mega_kernel_rf_first
.p2align 6
s_nop 0
s_nop 0
mega_kernel_rf_loop:
buffer_load_dwordx4 v[32:35], v7, s[84:87], s33 offen offset:0 sc1
v_add_u32 v5, s44, v17
ds_read_b128 v[156:159], v5 offset:0
ds_read_b128 v[160:163], v5 offset:1024
ds_read_b128 v[164:167], v5 offset:2048
ds_read_b128 v[168:171], v5 offset:3072
s_nop 4
buffer_load_dwordx4 v[36:39], v7, s[84:87], s33 offen offset:1024 sc1
s_nop 9
buffer_load_dwordx4 v[40:43], v7, s[84:87], s33 offen offset:2048 sc1
s_nop 9
buffer_load_dwordx4 v[44:47], v7, s[84:87], s33 offen offset:3072 sc1
s_waitcnt vmcnt(3)
v_max_u32 v4, v32, v34
v_cmp_eq_u32 vcc, -1, v4
s_cbranch_vccnz mega_kernel_rf_pa_15_0f
v_smfmac_f32_16x16x64_bf16 v[96:99], v[32:35], a[0:7], v6
v_smfmac_f32_16x16x64_bf16 v[100:103], v[32:35], a[32:39], v6
v_smfmac_f32_16x16x64_bf16 v[104:107], v[32:35], a[64:71], v6
s_waitcnt vmcnt(2)
v_max_u32 v4, v36, v38
v_cmp_eq_u32 vcc, -1, v4
v_smfmac_f32_16x16x64_bf16 v[108:111], v[32:35], a[96:103], v6
s_cbranch_vccnz mega_kernel_rf_pa_14_1f
v_smfmac_f32_16x16x64_bf16 v[96:99], v[36:39], a[8:15], v6
v_smfmac_f32_16x16x64_bf16 v[100:103], v[36:39], a[40:47], v6
v_smfmac_f32_16x16x64_bf16 v[104:107], v[36:39], a[72:79], v6
s_waitcnt vmcnt(1)
v_max_u32 v4, v40, v42
v_cmp_eq_u32 vcc, -1, v4
v_smfmac_f32_16x16x64_bf16 v[108:111], v[36:39], a[104:111], v6
s_cbranch_vccnz mega_kernel_rf_pa_12_2f
v_smfmac_f32_16x16x64_bf16 v[96:99], v[40:43], a[16:23], v6
v_smfmac_f32_16x16x64_bf16 v[100:103], v[40:43], a[48:55], v6
v_smfmac_f32_16x16x64_bf16 v[104:107], v[40:43], a[80:87], v6
s_waitcnt vmcnt(0)
v_max_u32 v4, v44, v46
v_cmp_eq_u32 vcc, -1, v4
v_smfmac_f32_16x16x64_bf16 v[108:111], v[40:43], a[112:119], v6
s_cbranch_vccnz mega_kernel_rf_pa_8_3f
v_smfmac_f32_16x16x64_bf16 v[96:99], v[44:47], a[24:31], v6
v_smfmac_f32_16x16x64_bf16 v[100:103], v[44:47], a[56:63], v6
v_smfmac_f32_16x16x64_bf16 v[104:107], v[44:47], a[88:95], v6
v_smfmac_f32_16x16x64_bf16 v[108:111], v[44:47], a[120:127], v6
mega_kernel_rf_pa_d:
mega_kernel_rf_adone:
s_nop 5
v_permlane32_swap_b32 v96, v100
v_permlane32_swap_b32 v97, v101
v_permlane32_swap_b32 v98, v102
v_permlane32_swap_b32 v99, v103
v_pk_add_f32 v[96:97], v[96:97], v[100:101]
v_pk_add_f32 v[98:99], v[98:99], v[102:103]
ds_write2_b32 v14, v96, v97 offset0:0 offset1:36
ds_write2_b32 v14, v98, v99 offset0:72 offset1:108
v_permlane32_swap_b32 v104, v108
v_permlane32_swap_b32 v105, v109
v_permlane32_swap_b32 v106, v110
v_permlane32_swap_b32 v107, v111
v_pk_add_f32 v[104:105], v[104:105], v[108:109]
v_pk_add_f32 v[106:107], v[106:107], v[110:111]
ds_write2_b32 v15, v104, v105 offset0:0 offset1:36
ds_write2_b32 v15, v106, v107 offset0:72 offset1:108
v_smfmac_f32_16x16x64_bf16 v[112:115], v[32:35], a[128:135], v6
v_smfmac_f32_16x16x64_bf16 v[116:119], v[32:35], a[160:167], v6
v_smfmac_f32_16x16x64_bf16 v[112:115], v[36:39], a[136:143], v6
v_smfmac_f32_16x16x64_bf16 v[116:119], v[36:39], a[168:175], v6
s_waitcnt lgkmcnt(0)
s_barrier
s_cmp_lg_u32 s24, 0
s_cbranch_scc1 mega_kernel_rf_side
ds_read_b128 v[120:123], v16 offset:0
ds_read_b128 v[124:127], v16 offset:16
ds_read_b128 v[128:131], v16 offset:2304
ds_read_b128 v[132:135], v16 offset:2320
ds_read_b128 v[136:139], v16 offset:4608
ds_read_b128 v[140:143], v16 offset:4624
ds_read_b128 v[144:147], v16 offset:6912
ds_read_b128 v[148:151], v16 offset:6928
v_smfmac_f32_16x16x64_bf16 v[112:115], v[40:43], a[144:151], v6
v_smfmac_f32_16x16x64_bf16 v[116:119], v[40:43], a[176:183], v6
v_smfmac_f32_16x16x64_bf16 v[112:115], v[44:47], a[152:159], v6
v_smfmac_f32_16x16x64_bf16 v[116:119], v[44:47], a[184:191], v6
s_mul_i32 s28, s31, 2048
s_add_u32 s28, s28, s33
s_add_u32 s28, s28, 49152
s_add_u32 s76, s37, s33
s_add_u32 s77, s38, s33
s_add_u32 s78, s39, s33
s_waitcnt lgkmcnt(4)
v_pk_add_f32 v[120:121], v[120:121], v[128:129]
v_pk_add_f32 v[122:123], v[122:123], v[130:131]
v_pk_add_f32 v[124:125], v[124:125], v[132:133]
v_pk_add_f32 v[126:127], v[126:127], v[134:135]
s_waitcnt lgkmcnt(0)
v_pk_add_f32 v[136:137], v[136:137], v[144:145]
v_pk_add_f32 v[138:139], v[138:139], v[146:147]
v_pk_add_f32 v[140:141], v[140:141], v[148:149]
v_pk_add_f32 v[142:143], v[142:143], v[150:151]
v_pk_add_f32 v[120:121], v[120:121], v[136:137]
v_pk_add_f32 v[122:123], v[122:123], v[138:139]
v_pk_add_f32 v[124:125], v[124:125], v[140:141]
v_pk_add_f32 v[126:127], v[126:127], v[142:143]
v_cvt_pk_bf16_f32 v152, v120, v121
v_cvt_pk_bf16_f32 v153, v122, v123
v_cvt_pk_bf16_f32 v154, v124, v125
v_cvt_pk_bf16_f32 v155, v126, v127
s_nop 1
v_mfma_f32_16x16x32_bf16 v[176:179], v[160:163], v[152:155], 0
v_mfma_f32_16x16x32_bf16 v[172:175], v[156:159], v[152:155], 0
v_mfma_f32_16x16x32_bf16 v[180:183], v[152:155], v[152:155], 0
s_cmp_eq_u32 s27, 63
s_cbranch_scc1 mega_kernel_rf_w0last
s_nop 4
v_mov_b32_dpp v172, v176 row_shr:8 row_mask:0xf bank_mask:0xc
v_mov_b32_dpp v173, v177 row_shr:8 row_mask:0xf bank_mask:0xc
v_mov_b32_dpp v174, v178 row_shr:8 row_mask:0xf bank_mask:0xc
v_mov_b32_dpp v175, v179 row_shr:8 row_mask:0xf bank_mask:0xc
v_min_u32 v180, -2, v180
v_min_u32 v172, -2, v172
s_mov_b64 exec, s[42:43]
buffer_store_dwordx4 v[180:183], v10, s[84:87], s28 offen
s_mov_b64 exec, -1
buffer_store_dwordx4 v[172:175], v17, s[84:87], s28 offen
v_permlane32_swap_b32 v112, v116
v_permlane32_swap_b32 v113, v117
v_permlane32_swap_b32 v114, v118
v_permlane32_swap_b32 v115, v119
v_pk_add_f32 v[112:113], v[112:113], v[116:117]
v_pk_add_f32 v[114:115], v[114:115], v[118:119]
ds_write_b128 v20, v[112:115]
s_waitcnt lgkmcnt(0)
s_barrier
v_mov_b32 v96, 0
v_mov_b32 v97, 0
v_mov_b32 v98, 0
v_mov_b32 v99, 0
v_mov_b32 v100, 0
v_mov_b32 v101, 0
v_mov_b32 v102, 0
v_mov_b32 v103, 0
v_cndmask_b32 v176, v23, v180, s[42:43]
v_cndmask_b32 v177, v23, v181, s[42:43]
v_cndmask_b32 v178, v23, v182, s[42:43]
v_cndmask_b32 v179, v23, v183, s[42:43]
s_mov_b64 exec, s[42:43]
buffer_load_dwordx4 v[188:191], v10, s[84:87], s76 offen sc1
buffer_load_dwordx4 v[196:199], v10, s[84:87], s77 offen sc1
buffer_load_dwordx4 v[204:207], v10, s[84:87], s78 offen sc1
s_mov_b64 exec, -1
buffer_load_dwordx4 v[184:187], v17, s[84:87], s76 offen sc1
buffer_load_dwordx4 v[192:195], v17, s[84:87], s77 offen sc1
buffer_load_dwordx4 v[200:203], v17, s[84:87], s78 offen sc1
v_pk_mul_f32 v[172:173], v[172:173], s[32:33] op_sel_hi:[1,0]
v_pk_mul_f32 v[174:175], v[174:175], s[32:33] op_sel_hi:[1,0]
v_pk_mul_f32 v[176:177], v[176:177], s[32:33] op_sel_hi:[1,0]
v_pk_mul_f32 v[178:179], v[178:179], s[32:33] op_sel_hi:[1,0]
s_lshl_b32 s89, s47, 31
s_or_b32 s89, s89, 0x3b39999a
s_nop 15
s_nop 1
s_mov_b64 exec, s[42:43]
buffer_load_dwordx4 v[188:191], v10, s[84:87], s76 offen sc1
buffer_load_dwordx4 v[196:199], v10, s[84:87], s77 offen sc1
buffer_load_dwordx4 v[204:207], v10, s[84:87], s78 offen sc1
s_mov_b64 exec, -1
buffer_load_dwordx4 v[184:187], v17, s[84:87], s76 offen sc1
buffer_load_dwordx4 v[192:195], v17, s[84:87], s77 offen sc1
buffer_load_dwordx4 v[200:203], v17, s[84:87], s78 offen sc1
mega_kernel_rf_p2:
s_waitcnt vmcnt(6)
v_max3_u32 v4, v184, v188, v192
v_max3_u32 v5, v196, v200, v204
v_max_u32 v4, v4, v5
v_cmp_eq_u32 vcc, -1, v4
s_cbranch_vccnz mega_kernel_rf_p2r
v_pk_add_f32 v[124:125], v[196:197], v[204:205]
v_pk_add_f32 v[126:127], v[198:199], v[206:207]
v_pk_add_f32 v[120:121], v[192:193], v[200:201]
v_pk_add_f32 v[122:123], v[194:195], v[202:203]
v_pk_add_f32 v[124:125], v[124:125], v[188:189]
v_pk_add_f32 v[126:127], v[126:127], v[190:191]
v_pk_add_f32 v[120:121], v[120:121], v[184:185]
v_pk_add_f32 v[122:123], v[122:123], v[186:187]
v_pk_fma_f32 v[176:177], v[124:125], s[32:33], v[176:177] op_sel_hi:[1,0,1]
v_pk_fma_f32 v[178:179], v[126:127], s[32:33], v[178:179] op_sel_hi:[1,0,1]
v_pk_fma_f32 v[172:173], v[120:121], s[32:33], v[172:173] op_sel_hi:[1,0,1]
v_pk_fma_f32 v[174:175], v[122:123], s[32:33], v[174:175] op_sel_hi:[1,0,1]
v_max3_f32 v232, v172, v173, v174
v_max3_f32 v233, v176, v177, v178
v_max3_f32 v232, v232, v175, v179
v_max_f32 v234, v232, v233
s_barrier
ds_read2_b64 v[208:211], v21 offset0:0 offset1:32
v_max_f32_dpp v232, v234, v234 row_ror:8 row_mask:0xf bank_mask:0xf
v_max_f32_dpp v233, v234, v234 row_ror:8 row_mask:0xf bank_mask:0xf
s_nop 1
v_permlane16_swap_b32 v232, v233
s_nop 0
v_max_f32 v234, v232, v233
v_max_f32 v235, v232, v233
s_nop 1
v_permlane32_swap_b32 v234, v235
s_nop 0
v_max_f32 v232, v234, v235
v_pk_add_f32 v[176:177], v[176:177], v[232:233] op_sel_hi:[1,0] neg_lo:[0,1] neg_hi:[0,1]
v_pk_add_f32 v[178:179], v[178:179], v[232:233] op_sel_hi:[1,0] neg_lo:[0,1] neg_hi:[0,1]
v_pk_add_f32 v[172:173], v[172:173], v[232:233] op_sel_hi:[1,0] neg_lo:[0,1] neg_hi:[0,1]
v_pk_add_f32 v[174:175], v[174:175], v[232:233] op_sel_hi:[1,0] neg_lo:[0,1] neg_hi:[0,1]
v_exp_f32 v176, v176
v_exp_f32 v177, v177
v_exp_f32 v178, v178
v_exp_f32 v179, v179
v_exp_f32 v172, v172
v_cvt_pk_bf16_f32 v216, v176, v177
v_cvt_pk_bf16_f32 v217, v178, v179
v_exp_f32 v173, v173
v_exp_f32 v174, v174
v_mfma_f32_16x16x16_bf16 v[224:227], v[220:221], v[216:217], 0
v_exp_f32 v175, v175
v_cvt_pk_bf16_f32 v212, v172, v173
s_waitcnt lgkmcnt(0)
v_mfma_f32_16x16x16_bf16 v[120:123], v[208:209], v[216:217], 0
v_cvt_pk_bf16_f32 v213, v174, v175
v_mfma_f32_16x16x16_bf16 v[124:127], v[210:211], v[216:217], 0
v_mov_b32_dpp v214, v212 row_ror:8 row_mask:0xf bank_mask:0xf
v_mov_b32_dpp v215, v213 row_ror:8 row_mask:0xf bank_mask:0xf
s_nop 1
v_mfma_f32_16x16x32_bf16 v[224:227], v[220:223], v[212:215], v[224:227]
v_mfma_f32_16x16x32_bf16 v[120:123], v[164:167], v[212:215], v[120:123]
v_mfma_f32_16x16x32_bf16 v[124:127], v[168:171], v[212:215], v[124:127]
s_add_u32 s29, s33, 24576
s_nop 4
v_rcp_f32 v234, v224
s_nop 0
v_pk_mul_f32 v[120:121], v[120:121], v[234:235] op_sel_hi:[1,0]
v_pk_mul_f32 v[122:123], v[122:123], v[234:235] op_sel_hi:[1,0]
v_pk_mul_f32 v[124:125], v[124:125], v[234:235] op_sel_hi:[1,0]
v_pk_mul_f32 v[126:127], v[126:127], v[234:235] op_sel_hi:[1,0]
v_cvt_pk_bf16_f32 v212, v120, v121
v_cvt_pk_bf16_f32 v213, v122, v123
v_cvt_pk_bf16_f32 v214, v124, v125
v_cvt_pk_bf16_f32 v215, v126, v127
v_min_u32 v212, -2, v212
s_mov_b64 exec, s[40:41]
buffer_store_dwordx4 v[212:215], v11, s[84:87], s33 offen
s_mov_b64 exec, -1
mega_kernel_rf_b3:
s_barrier
s_nop 15
buffer_load_dwordx4 v[32:35], v7, s[84:87], s29 offen offset:0 sc1
s_nop 9
buffer_load_dwordx4 v[36:39], v7, s[84:87], s29 offen offset:1024 sc1
s_nop 9
buffer_load_dwordx4 v[40:43], v7, s[84:87], s29 offen offset:2048 sc1
s_nop 9
buffer_load_dwordx4 v[44:47], v7, s[84:87], s29 offen offset:3072 sc1
mega_kernel_rf_pc_15_0:
s_waitcnt vmcnt(3)
v_cmp_eq_u32 vcc, -1, v32
s_cbranch_vccnz mega_kernel_rf_pc_15_0f
v_smfmac_f32_16x16x64_bf16 v[96:99], v[32:35], a[192:199], v6
v_smfmac_f32_16x16x64_bf16 v[100:103], v[32:35], a[224:231], v6
mega_kernel_rf_pc_14_1:
s_waitcnt vmcnt(2)
v_cmp_eq_u32 vcc, -1, v36
s_cbranch_vccnz mega_kernel_rf_pc_14_1f
v_smfmac_f32_16x16x64_bf16 v[96:99], v[36:39], a[200:207], v6
v_smfmac_f32_16x16x64_bf16 v[100:103], v[36:39], a[232:239], v6
mega_kernel_rf_pc_12_2:
s_waitcnt vmcnt(1)
v_cmp_eq_u32 vcc, -1, v40
s_cbranch_vccnz mega_kernel_rf_pc_12_2f
v_smfmac_f32_16x16x64_bf16 v[96:99], v[40:43], a[208:215], v6
v_smfmac_f32_16x16x64_bf16 v[100:103], v[40:43], a[240:247], v6
mega_kernel_rf_pc_8_3:
s_waitcnt vmcnt(0)
v_cmp_eq_u32 vcc, -1, v44
s_cbranch_vccnz mega_kernel_rf_pc_8_3f
v_smfmac_f32_16x16x64_bf16 v[96:99], v[44:47], a[216:223], v6
v_smfmac_f32_16x16x64_bf16 v[100:103], v[44:47], a[248:255], v6
mega_kernel_rf_pc_d:
s_nop 7
v_permlane32_swap_b32 v96, v100
v_permlane32_swap_b32 v97, v101
v_permlane32_swap_b32 v98, v102
v_permlane32_swap_b32 v99, v103
v_pk_add_f32 v[96:97], v[96:97], v[100:101]
v_pk_add_f32 v[98:99], v[98:99], v[102:103]
ds_write2_b32 v18, v96, v97 offset0:0 offset1:36
ds_write2_b32 v18, v98, v99 offset0:72 offset1:108
s_waitcnt lgkmcnt(0)
s_barrier
s_cmp_lg_u32 s24, 0
s_cbranch_scc1 mega_kernel_rf_x1
ds_read_b128 v[120:123], v19 offset:0
ds_read_b128 v[124:127], v19 offset:1152
ds_read_b128 v[128:131], v19 offset:2304
ds_read_b128 v[132:135], v19 offset:3456
s_waitcnt lgkmcnt(2)
v_pk_add_f32 v[120:121], v[120:121], v[124:125]
v_pk_add_f32 v[122:123], v[122:123], v[126:127]
s_waitcnt lgkmcnt(0)
v_pk_add_f32 v[128:129], v[128:129], v[132:133]
v_pk_add_f32 v[130:131], v[130:131], v[134:135]
v_pk_add_f32 v[120:121], v[120:121], v[128:129]
v_pk_add_f32 v[122:123], v[122:123], v[130:131]
v_fma_f32 v212, v120, s89, v120
v_cvt_pk_bf16_f32 v213, v122, v123
v_cvt_pk_bf16_f32 v212, v212, v121
v_and_or_b32 v212, v212, -2, s47
buffer_store_dwordx2 v[212:213], v12, s[84:87], s35 offen sc1
s_mov_b32 s77, 0x3f80
s_mov_b32 s78, 0x3f800000
s_xor_b32 s76, s47, 1
v_mov_b32 v48, s76
v_mov_b32 v50, s76
v_mov_b32 v52, s76
s_nop 8
v_mov_b32 v96, 0
v_mov_b32 v97, 0
v_mov_b32 v98, 0
v_mov_b32 v99, 0
v_mov_b32 v100, 0
v_mov_b32 v101, 0
v_mov_b32 v102, 0
v_mov_b32 v103, 0
v_mov_b32 v104, 0
v_mov_b32 v105, 0
v_mov_b32 v106, 0
v_mov_b32 v107, 0
v_mov_b32 v108, 0
v_mov_b32 v109, 0
v_mov_b32 v110, 0
v_mov_b32 v111, 0
v_mov_b32 v112, 0
v_mov_b32 v113, 0
v_mov_b32 v114, 0
v_mov_b32 v115, 0
v_mov_b32 v116, 0
v_mov_b32 v117, 0
v_mov_b32 v118, 0
v_mov_b32 v119, 0
s_nop 15
s_nop 7
s_cmp_eq_u32 s47, 1
s_cbranch_scc1 mega_kernel_rf_p4_1
.p2align 6
mega_kernel_rf_p4_0:
buffer_load_dwordx2 v[48:49], v25, s[84:87], s35 offen sc1
buffer_load_dwordx2 v[50:51], v26, s[84:87], s35 offen sc1
buffer_load_dwordx2 v[52:53], v27, s[84:87], s35 offen sc1
s_waitcnt vmcnt(12)
mega_kernel_rf_p4c_0:
v_bitop3_b32 v4, v48, v50, v52 bitop3:0xfe
v_and_b32 v4, 1, v4
v_cmp_ne_u32 vcc, 0, v4
s_cbranch_vccnz mega_kernel_rf_p4_0
v_dot2_f32_bf16 v120, v48, s77, v120
v_dot2_f32_bf16 v121, v48, s78, v121
v_dot2_f32_bf16 v122, v49, s77, v122
v_dot2_f32_bf16 v123, v49, s78, v123
v_dot2_f32_bf16 v120, v50, s77, v120
v_dot2_f32_bf16 v121, v50, s78, v121
v_dot2_f32_bf16 v122, v51, s77, v122
v_dot2_f32_bf16 v123, v51, s78, v123
v_dot2_f32_bf16 v120, v52, s77, v120
v_dot2_f32_bf16 v121, v52, s78, v121
v_dot2_f32_bf16 v122, v53, s77, v122
v_dot2_f32_bf16 v123, v53, s78, v123
s_nop 0
v_cvt_pk_bf16_f32 v212, v120, v121
v_min_u32 v212, -2, v212
v_cvt_pk_bf16_f32 v213, v122, v123
buffer_store_dwordx2 v[212:213], v9, s[84:87], s34 offen
s_branch mega_kernel_rf_p4d
.p2align 6
mega_kernel_rf_p4_1:
buffer_load_dwordx2 v[48:49], v25, s[84:87], s35 offen sc1
buffer_load_dwordx2 v[50:51], v26, s[84:87], s35 offen sc1
buffer_load_dwordx2 v[52:53], v27, s[84:87], s35 offen sc1
s_waitcnt vmcnt(12)
mega_kernel_rf_p4c_1:
v_bitop3_b32 v4, v48, v50, v52 bitop3:0x80
v_and_b32 v4, 1, v4
v_cmp_ne_u32 vcc, 1, v4
s_cbranch_vccnz mega_kernel_rf_p4_1
v_dot2_f32_bf16 v120, v48, s77, v120
v_dot2_f32_bf16 v121, v48, s78, v121
v_dot2_f32_bf16 v122, v49, s77, v122
v_dot2_f32_bf16 v123, v49, s78, v123
v_dot2_f32_bf16 v120, v50, s77, v120
v_dot2_f32_bf16 v121, v50, s78, v121
v_dot2_f32_bf16 v122, v51, s77, v122
v_dot2_f32_bf16 v123, v51, s78, v123
v_dot2_f32_bf16 v120, v52, s77, v120
v_dot2_f32_bf16 v121, v52, s78, v121
v_dot2_f32_bf16 v122, v53, s77, v122
v_dot2_f32_bf16 v123, v53, s78, v123
s_nop 0
v_cvt_pk_bf16_f32 v212, v120, v121
v_min_u32 v212, -2, v212
v_cvt_pk_bf16_f32 v213, v122, v123
buffer_store_dwordx2 v[212:213], v9, s[84:87], s34 offen
mega_kernel_rf_p4d:
mega_kernel_rf_b5:
s_add_u32 s27, s27, 1
s_add_u32 s44, s44, 4096
s_cmp_eq_u32 s44, 30720
s_cselect_b32 s44, 18432, s44
s_mov_b32 s28, s33
s_mov_b32 s33, s34
s_mov_b32 s34, s28
s_xor_b32 s35, s35, 262144
s_bfe_u32 s47, s27, 0x10001
s_barrier
s_nop 15
s_branch mega_kernel_rf_loop
mega_kernel_rf_x1:
s_cmp_eq_u32 s24, 1
s_cbranch_scc0 mega_kernel_rf_x2
s_add_u32 s76, s27, 1
v_mov_b32 v5, s76
s_mov_b64 exec, 1
buffer_store_dword v5, v228, s[84:87], s81 offen sc1
s_mov_b64 exec, -1
mega_kernel_rf_x2:
s_cmp_eq_u32 s24, 3
s_cbranch_scc0 mega_kernel_rf_x4
s_cmp_eq_u32 s36, 1
s_cbranch_scc0 mega_kernel_rf_x5
s_add_u32 s76, s27, 1
s_cmp_gt_i32 s46, s76
s_cbranch_scc1 mega_kernel_rf_pf1ok
mega_kernel_rf_pf1w:
v_mov_b32 v4, 0
s_mov_b64 exec, 3
buffer_atomic_add v4, v24, s[84:87], 0 offen sc0 sc1
s_mov_b64 exec, -1
s_waitcnt vmcnt(0)
v_readlane_b32 s46, v4, 0
v_readlane_b32 s28, v4, 1
s_nop 1
s_min_i32 s46, s46, s28
s_cmp_gt_i32 s46, s76
s_cbranch_scc0 mega_kernel_rf_pf1w
mega_kernel_rf_pf1ok:
s_add_u32 s77, s76, s82
s_bfe_u32 s28, s77, 0x40002
s_lshl_b32 s28, s28, 14
s_and_b32 s77, s77, 3
s_lshl_b32 s77, s77, 11
s_add_u32 s28, s28, s77
s_add_u32 m0, s45, 0
s_nop 0
buffer_load_dwordx4 v240, s[84:87], s28 offen offset:0 sc1 lds
s_add_u32 m0, s45, 0
s_nop 0
buffer_load_dwordx4 v240, s[84:87], s28 offen offset:1024 sc1 lds
s_add_u32 m0, s45, 2048
s_nop 0
buffer_load_dwordx4 v241, s[84:87], s28 offen offset:0 sc1 lds
s_add_u32 m0, s45, 2048
s_nop 0
buffer_load_dwordx4 v241, s[84:87], s28 offen offset:1024 sc1 lds
s_add_u32 s45, s45, 4096
s_cmp_eq_u32 s45, 30720
s_cselect_b32 s45, 18432, s45
s_waitcnt vmcnt(0)
mega_kernel_rf_x5:
s_add_u32 s76, s27, 4
s_min_u32 s76, s76, 63
s_cmp_gt_i32 s46, s76
s_cbranch_scc1 mega_kernel_rf_x6
v_mov_b32 v249, 0
s_mov_b64 exec, 3
buffer_atomic_add v249, v24, s[84:87], 0 offen sc0 sc1
s_mov_b64 exec, -1
mega_kernel_rf_x6:
s_add_u32 s76, s27, 2
s_cmp_lt_u32 s76, 63
s_cbranch_scc0 mega_kernel_rf_x4
s_cmp_gt_i32 s46, s76
s_cbranch_scc0 mega_kernel_rf_x4
s_add_u32 s77, s76, s82
s_bfe_u32 s28, s77, 0x40002
s_lshl_b32 s28, s28, 14
s_and_b32 s77, s77, 3
s_lshl_b32 s77, s77, 11
s_add_u32 s28, s28, s77
s_add_u32 s28, s28, s83
s_add_u32 s28, s28, 33554432
s_buffer_load_dword s78, s[84:87], s28 offset:0
s_buffer_load_dword s78, s[84:87], s28 offset:128
s_buffer_load_dword s78, s[84:87], s28 offset:256
s_buffer_load_dword s78, s[84:87], s28 offset:384
s_buffer_load_dword s78, s[84:87], s28 offset:512
s_buffer_load_dword s78, s[84:87], s28 offset:640
s_buffer_load_dword s78, s[84:87], s28 offset:768
s_buffer_load_dword s78, s[84:87], s28 offset:896
s_buffer_load_dword s78, s[84:87], s28 offset:1024
s_buffer_load_dword s78, s[84:87], s28 offset:1152
s_buffer_load_dword s78, s[84:87], s28 offset:1280
s_buffer_load_dword s78, s[84:87], s28 offset:1408
s_buffer_load_dword s78, s[84:87], s28 offset:1536
s_buffer_load_dword s78, s[84:87], s28 offset:1664
s_buffer_load_dword s78, s[84:87], s28 offset:1792
s_buffer_load_dword s78, s[84:87], s28 offset:1920
s_mov_b32 s89, s76
mega_kernel_rf_x4:
v_mov_b32 v96, 0
v_mov_b32 v97, 0
v_mov_b32 v98, 0
v_mov_b32 v99, 0
v_mov_b32 v100, 0
v_mov_b32 v101, 0
v_mov_b32 v102, 0
v_mov_b32 v103, 0
v_mov_b32 v104, 0
v_mov_b32 v105, 0
v_mov_b32 v106, 0
v_mov_b32 v107, 0
v_mov_b32 v108, 0
v_mov_b32 v109, 0
v_mov_b32 v110, 0
v_mov_b32 v111, 0
v_mov_b32 v112, 0
v_mov_b32 v113, 0
v_mov_b32 v114, 0
v_mov_b32 v115, 0
v_mov_b32 v116, 0
v_mov_b32 v117, 0
v_mov_b32 v118, 0
v_mov_b32 v119, 0
s_branch mega_kernel_rf_b5
mega_kernel_rf_p2r:
s_mov_b64 exec, s[42:43]
buffer_load_dwordx4 v[188:191], v10, s[84:87], s76 offen sc1
buffer_load_dwordx4 v[196:199], v10, s[84:87], s77 offen sc1
buffer_load_dwordx4 v[204:207], v10, s[84:87], s78 offen sc1
s_mov_b64 exec, -1
buffer_load_dwordx4 v[184:187], v17, s[84:87], s76 offen sc1
buffer_load_dwordx4 v[192:195], v17, s[84:87], s77 offen sc1
buffer_load_dwordx4 v[200:203], v17, s[84:87], s78 offen sc1
s_branch mega_kernel_rf_p2
.p2align 5
mega_kernel_rf_pa_1_0f:
s_mov_b64 exec, vcc
buffer_load_dwordx4 v[32:35], v7, s[84:87], s33 offen offset:0 sc1
s_mov_b64 exec, -1
s_branch mega_kernel_rf_pa_1_0
.p2align 5
mega_kernel_rf_pa_1_0:
s_waitcnt vmcnt(0)
v_max_u32 v4, v32, v34
v_cmp_eq_u32 vcc, -1, v4
s_cbranch_vccnz mega_kernel_rf_pa_1_0f
v_smfmac_f32_16x16x64_bf16 v[96:99], v[32:35], a[0:7], v6
v_smfmac_f32_16x16x64_bf16 v[100:103], v[32:35], a[32:39], v6
v_smfmac_f32_16x16x64_bf16 v[104:107], v[32:35], a[64:71], v6
v_smfmac_f32_16x16x64_bf16 v[108:111], v[32:35], a[96:103], v6
s_branch mega_kernel_rf_pa_d
.p2align 5
mega_kernel_rf_pa_2_1f:
s_mov_b64 exec, vcc
buffer_load_dwordx4 v[36:39], v7, s[84:87], s33 offen offset:1024 sc1
s_mov_b64 exec, -1
s_branch mega_kernel_rf_pa_2_1
.p2align 5
mega_kernel_rf_pa_2_1:
s_waitcnt vmcnt(0)
v_max_u32 v4, v36, v38
v_cmp_eq_u32 vcc, -1, v4
s_cbranch_vccnz mega_kernel_rf_pa_2_1f
v_smfmac_f32_16x16x64_bf16 v[96:99], v[36:39], a[8:15], v6
v_smfmac_f32_16x16x64_bf16 v[100:103], v[36:39], a[40:47], v6
v_smfmac_f32_16x16x64_bf16 v[104:107], v[36:39], a[72:79], v6
v_smfmac_f32_16x16x64_bf16 v[108:111], v[36:39], a[104:111], v6
s_branch mega_kernel_rf_pa_d
.p2align 5
mega_kernel_rf_pa_3_0f:
s_mov_b64 exec, vcc
buffer_load_dwordx4 v[32:35], v7, s[84:87], s33 offen offset:0 sc1
s_mov_b64 exec, -1
s_branch mega_kernel_rf_pa_3_1
.p2align 5
mega_kernel_rf_pa_3_0:
s_waitcnt vmcnt(1)
v_max_u32 v4, v32, v34
v_cmp_eq_u32 vcc, -1, v4
s_cbranch_vccnz mega_kernel_rf_pa_3_0f
v_smfmac_f32_16x16x64_bf16 v[96:99], v[32:35], a[0:7], v6
v_smfmac_f32_16x16x64_bf16 v[100:103], v[32:35], a[32:39], v6
v_smfmac_f32_16x16x64_bf16 v[104:107], v[32:35], a[64:71], v6
v_smfmac_f32_16x16x64_bf16 v[108:111], v[32:35], a[96:103], v6
s_branch mega_kernel_rf_pa_2_1
.p2align 5
mega_kernel_rf_pa_3_1f:
s_mov_b64 exec, vcc
buffer_load_dwordx4 v[36:39], v7, s[84:87], s33 offen offset:1024 sc1
s_mov_b64 exec, -1
s_branch mega_kernel_rf_pa_3_0
.p2align 5
mega_kernel_rf_pa_3_1:
s_waitcnt vmcnt(1)
v_max_u32 v4, v36, v38
v_cmp_eq_u32 vcc, -1, v4
s_cbranch_vccnz mega_kernel_rf_pa_3_1f
v_smfmac_f32_16x16x64_bf16 v[96:99], v[36:39], a[8:15], v6
v_smfmac_f32_16x16x64_bf16 v[100:103], v[36:39], a[40:47], v6
v_smfmac_f32_16x16x64_bf16 v[104:107], v[36:39], a[72:79], v6
v_smfmac_f32_16x16x64_bf16 v[108:111], v[36:39], a[104:111], v6
s_branch mega_kernel_rf_pa_1_0
.p2align 5
mega_kernel_rf_pa_4_2f:
s_mov_b64 exec, vcc
buffer_load_dwordx4 v[40:43], v7, s[84:87], s33 offen offset:2048 sc1
s_mov_b64 exec, -1
s_branch mega_kernel_rf_pa_4_2
.p2align 5
mega_kernel_rf_pa_4_2:
s_waitcnt vmcnt(0)
v_max_u32 v4, v40, v42
v_cmp_eq_u32 vcc, -1, v4
s_cbranch_vccnz mega_kernel_rf_pa_4_2f
v_smfmac_f32_16x16x64_bf16 v[96:99], v[40:43], a[16:23], v6
v_smfmac_f32_16x16x64_bf16 v[100:103], v[40:43], a[48:55], v6
v_smfmac_f32_16x16x64_bf16 v[104:107], v[40:43], a[80:87], v6
v_smfmac_f32_16x16x64_bf16 v[108:111], v[40:43], a[112:119], v6
s_branch mega_kernel_rf_pa_d
.p2align 5
mega_kernel_rf_pa_5_0f:
s_mov_b64 exec, vcc
buffer_load_dwordx4 v[32:35], v7, s[84:87], s33 offen offset:0 sc1
s_mov_b64 exec, -1
s_branch mega_kernel_rf_pa_5_2
.p2align 5
mega_kernel_rf_pa_5_0:
s_waitcnt vmcnt(1)
v_max_u32 v4, v32, v34
v_cmp_eq_u32 vcc, -1, v4
s_cbranch_vccnz mega_kernel_rf_pa_5_0f
v_smfmac_f32_16x16x64_bf16 v[96:99], v[32:35], a[0:7], v6
v_smfmac_f32_16x16x64_bf16 v[100:103], v[32:35], a[32:39], v6
v_smfmac_f32_16x16x64_bf16 v[104:107], v[32:35], a[64:71], v6
v_smfmac_f32_16x16x64_bf16 v[108:111], v[32:35], a[96:103], v6
s_branch mega_kernel_rf_pa_4_2
.p2align 5
mega_kernel_rf_pa_5_2f:
s_mov_b64 exec, vcc
buffer_load_dwordx4 v[40:43], v7, s[84:87], s33 offen offset:2048 sc1
s_mov_b64 exec, -1
s_branch mega_kernel_rf_pa_5_0
.p2align 5
mega_kernel_rf_pa_5_2:
s_waitcnt vmcnt(1)
v_max_u32 v4, v40, v42
v_cmp_eq_u32 vcc, -1, v4
s_cbranch_vccnz mega_kernel_rf_pa_5_2f
v_smfmac_f32_16x16x64_bf16 v[96:99], v[40:43], a[16:23], v6
v_smfmac_f32_16x16x64_bf16 v[100:103], v[40:43], a[48:55], v6
v_smfmac_f32_16x16x64_bf16 v[104:107], v[40:43], a[80:87], v6
v_smfmac_f32_16x16x64_bf16 v[108:111], v[40:43], a[112:119], v6
s_branch mega_kernel_rf_pa_1_0
.p2align 5
mega_kernel_rf_pa_6_1f:
s_mov_b64 exec, vcc
buffer_load_dwordx4 v[36:39], v7, s[84:87], s33 offen offset:1024 sc1
s_mov_b64 exec, -1
s_branch mega_kernel_rf_pa_6_2
.p2align 5
mega_kernel_rf_pa_6_1:
s_waitcnt vmcnt(1)
v_max_u32 v4, v36, v38
v_cmp_eq_u32 vcc, -1, v4
s_cbranch_vccnz mega_kernel_rf_pa_6_1f
v_smfmac_f32_16x16x64_bf16 v[96:99], v[36:39], a[8:15], v6
v_smfmac_f32_16x16x64_bf16 v[100:103], v[36:39], a[40:47], v6
v_smfmac_f32_16x16x64_bf16 v[104:107], v[36:39], a[72:79], v6
v_smfmac_f32_16x16x64_bf16 v[108:111], v[36:39], a[104:111], v6
s_branch mega_kernel_rf_pa_4_2
.p2align 5
mega_kernel_rf_pa_6_2f:
s_mov_b64 exec, vcc
buffer_load_dwordx4 v[40:43], v7, s[84:87], s33 offen offset:2048 sc1
s_mov_b64 exec, -1
s_branch mega_kernel_rf_pa_6_1
.p2align 5
mega_kernel_rf_pa_6_2:
s_waitcnt vmcnt(1)
v_max_u32 v4, v40, v42
v_cmp_eq_u32 vcc, -1, v4
s_cbranch_vccnz mega_kernel_rf_pa_6_2f
v_smfmac_f32_16x16x64_bf16 v[96:99], v[40:43], a[16:23], v6
v_smfmac_f32_16x16x64_bf16 v[100:103], v[40:43], a[48:55], v6
v_smfmac_f32_16x16x64_bf16 v[104:107], v[40:43], a[80:87], v6
v_smfmac_f32_16x16x64_bf16 v[108:111], v[40:43], a[112:119], v6
s_branch mega_kernel_rf_pa_2_1
.p2align 5
mega_kernel_rf_pa_7_0f:
s_mov_b64 exec, vcc
buffer_load_dwordx4 v[32:35], v7, s[84:87], s33 offen offset:0 sc1
s_mov_b64 exec, -1
s_branch mega_kernel_rf_pa_7_1
.p2align 5
mega_kernel_rf_pa_7_0:
s_waitcnt vmcnt(2)
v_max_u32 v4, v32, v34
v_cmp_eq_u32 vcc, -1, v4
s_cbranch_vccnz mega_kernel_rf_pa_7_0f
v_smfmac_f32_16x16x64_bf16 v[96:99], v[32:35], a[0:7], v6
v_smfmac_f32_16x16x64_bf16 v[100:103], v[32:35], a[32:39], v6
v_smfmac_f32_16x16x64_bf16 v[104:107], v[32:35], a[64:71], v6
v_smfmac_f32_16x16x64_bf16 v[108:111], v[32:35], a[96:103], v6
s_branch mega_kernel_rf_pa_6_1
.p2align 5
mega_kernel_rf_pa_7_1f:
s_mov_b64 exec, vcc
buffer_load_dwordx4 v[36:39], v7, s[84:87], s33 offen offset:1024 sc1
s_mov_b64 exec, -1
s_branch mega_kernel_rf_pa_7_2
.p2align 5
mega_kernel_rf_pa_7_1:
s_waitcnt vmcnt(2)
v_max_u32 v4, v36, v38
v_cmp_eq_u32 vcc, -1, v4
s_cbranch_vccnz mega_kernel_rf_pa_7_1f
v_smfmac_f32_16x16x64_bf16 v[96:99], v[36:39], a[8:15], v6
v_smfmac_f32_16x16x64_bf16 v[100:103], v[36:39], a[40:47], v6
v_smfmac_f32_16x16x64_bf16 v[104:107], v[36:39], a[72:79], v6
v_smfmac_f32_16x16x64_bf16 v[108:111], v[36:39], a[104:111], v6
s_branch mega_kernel_rf_pa_5_2
.p2align 5
mega_kernel_rf_pa_7_2f:
s_mov_b64 exec, vcc
buffer_load_dwordx4 v[40:43], v7, s[84:87], s33 offen offset:2048 sc1
s_mov_b64 exec, -1
s_branch mega_kernel_rf_pa_7_0
.p2align 5
mega_kernel_rf_pa_7_2:
s_waitcnt vmcnt(2)
v_max_u32 v4, v40, v42
v_cmp_eq_u32 vcc, -1, v4
s_cbranch_vccnz mega_kernel_rf_pa_7_2f
v_smfmac_f32_16x16x64_bf16 v[96:99], v[40:43], a[16:23], v6
v_smfmac_f32_16x16x64_bf16 v[100:103], v[40:43], a[48:55], v6
v_smfmac_f32_16x16x64_bf16 v[104:107], v[40:43], a[80:87], v6
v_smfmac_f32_16x16x64_bf16 v[108:111], v[40:43], a[112:119], v6
s_branch mega_kernel_rf_pa_3_0
.p2align 5
mega_kernel_rf_pa_8_3f:
s_mov_b64 exec, vcc
buffer_load_dwordx4 v[44:47], v7, s[84:87], s33 offen offset:3072 sc1
s_mov_b64 exec, -1
s_branch mega_kernel_rf_pa_8_3
.p2align 5
mega_kernel_rf_pa_8_3:
s_waitcnt vmcnt(0)
v_max_u32 v4, v44, v46
v_cmp_eq_u32 vcc, -1, v4
s_cbranch_vccnz mega_kernel_rf_pa_8_3f
v_smfmac_f32_16x16x64_bf16 v[96:99], v[44:47], a[24:31], v6
v_smfmac_f32_16x16x64_bf16 v[100:103], v[44:47], a[56:63], v6
v_smfmac_f32_16x16x64_bf16 v[104:107], v[44:47], a[88:95], v6
v_smfmac_f32_16x16x64_bf16 v[108:111], v[44:47], a[120:127], v6
s_branch mega_kernel_rf_pa_d
.p2align 5
mega_kernel_rf_pa_9_0f:
s_mov_b64 exec, vcc
buffer_load_dwordx4 v[32:35], v7, s[84:87], s33 offen offset:0 sc1
s_mov_b64 exec, -1
s_branch mega_kernel_rf_pa_9_3
.p2align 5
mega_kernel_rf_pa_9_0:
s_waitcnt vmcnt(1)
v_max_u32 v4, v32, v34
v_cmp_eq_u32 vcc, -1, v4
s_cbranch_vccnz mega_kernel_rf_pa_9_0f
v_smfmac_f32_16x16x64_bf16 v[96:99], v[32:35], a[0:7], v6
v_smfmac_f32_16x16x64_bf16 v[100:103], v[32:35], a[32:39], v6
v_smfmac_f32_16x16x64_bf16 v[104:107], v[32:35], a[64:71], v6
v_smfmac_f32_16x16x64_bf16 v[108:111], v[32:35], a[96:103], v6
s_branch mega_kernel_rf_pa_8_3
.p2align 5
mega_kernel_rf_pa_9_3f:
s_mov_b64 exec, vcc
buffer_load_dwordx4 v[44:47], v7, s[84:87], s33 offen offset:3072 sc1
s_mov_b64 exec, -1
s_branch mega_kernel_rf_pa_9_0
.p2align 5
mega_kernel_rf_pa_9_3:
s_waitcnt vmcnt(1)
v_max_u32 v4, v44, v46
v_cmp_eq_u32 vcc, -1, v4
s_cbranch_vccnz mega_kernel_rf_pa_9_3f
v_smfmac_f32_16x16x64_bf16 v[96:99], v[44:47], a[24:31], v6
v_smfmac_f32_16x16x64_bf16 v[100:103], v[44:47], a[56:63], v6
v_smfmac_f32_16x16x64_bf16 v[104:107], v[44:47], a[88:95], v6
v_smfmac_f32_16x16x64_bf16 v[108:111], v[44:47], a[120:127], v6
s_branch mega_kernel_rf_pa_1_0
.p2align 5
mega_kernel_rf_pa_10_1f:
s_mov_b64 exec, vcc
buffer_load_dwordx4 v[36:39], v7, s[84:87], s33 offen offset:1024 sc1
s_mov_b64 exec, -1
s_branch mega_kernel_rf_pa_10_3
.p2align 5
mega_kernel_rf_pa_10_1:
s_waitcnt vmcnt(1)
v_max_u32 v4, v36, v38
v_cmp_eq_u32 vcc, -1, v4
s_cbranch_vccnz mega_kernel_rf_pa_10_1f
v_smfmac_f32_16x16x64_bf16 v[96:99], v[36:39], a[8:15], v6
v_smfmac_f32_16x16x64_bf16 v[100:103], v[36:39], a[40:47], v6
v_smfmac_f32_16x16x64_bf16 v[104:107], v[36:39], a[72:79], v6
v_smfmac_f32_16x16x64_bf16 v[108:111], v[36:39], a[104:111], v6
s_branch mega_kernel_rf_pa_8_3
.p2align 5
mega_kernel_rf_pa_10_3f:
s_mov_b64 exec, vcc
buffer_load_dwordx4 v[44:47], v7, s[84:87], s33 offen offset:3072 sc1
s_mov_b64 exec, -1
s_branch mega_kernel_rf_pa_10_1
.p2align 5
mega_kernel_rf_pa_10_3:
s_waitcnt vmcnt(1)
v_max_u32 v4, v44, v46
v_cmp_eq_u32 vcc, -1, v4
s_cbranch_vccnz mega_kernel_rf_pa_10_3f
v_smfmac_f32_16x16x64_bf16 v[96:99], v[44:47], a[24:31], v6
v_smfmac_f32_16x16x64_bf16 v[100:103], v[44:47], a[56:63], v6
v_smfmac_f32_16x16x64_bf16 v[104:107], v[44:47], a[88:95], v6
v_smfmac_f32_16x16x64_bf16 v[108:111], v[44:47], a[120:127], v6
s_branch mega_kernel_rf_pa_2_1
.p2align 5
mega_kernel_rf_pa_11_0f:
s_mov_b64 exec, vcc
buffer_load_dwordx4 v[32:35], v7, s[84:87], s33 offen offset:0 sc1
s_mov_b64 exec, -1
s_branch mega_kernel_rf_pa_11_1
.p2align 5
mega_kernel_rf_pa_11_0:
s_waitcnt vmcnt(2)
v_max_u32 v4, v32, v34
v_cmp_eq_u32 vcc, -1, v4
s_cbranch_vccnz mega_kernel_rf_pa_11_0f
v_smfmac_f32_16x16x64_bf16 v[96:99], v[32:35], a[0:7], v6
v_smfmac_f32_16x16x64_bf16 v[100:103], v[32:35], a[32:39], v6
v_smfmac_f32_16x16x64_bf16 v[104:107], v[32:35], a[64:71], v6
v_smfmac_f32_16x16x64_bf16 v[108:111], v[32:35], a[96:103], v6
s_branch mega_kernel_rf_pa_10_1
.p2align 5
mega_kernel_rf_pa_11_1f:
s_mov_b64 exec, vcc
buffer_load_dwordx4 v[36:39], v7, s[84:87], s33 offen offset:1024 sc1
s_mov_b64 exec, -1
s_branch mega_kernel_rf_pa_11_3
.p2align 5
mega_kernel_rf_pa_11_1:
s_waitcnt vmcnt(2)
v_max_u32 v4, v36, v38
v_cmp_eq_u32 vcc, -1, v4
s_cbranch_vccnz mega_kernel_rf_pa_11_1f
v_smfmac_f32_16x16x64_bf16 v[96:99], v[36:39], a[8:15], v6
v_smfmac_f32_16x16x64_bf16 v[100:103], v[36:39], a[40:47], v6
v_smfmac_f32_16x16x64_bf16 v[104:107], v[36:39], a[72:79], v6
v_smfmac_f32_16x16x64_bf16 v[108:111], v[36:39], a[104:111], v6
s_branch mega_kernel_rf_pa_9_3
.p2align 5
mega_kernel_rf_pa_11_3f:
s_mov_b64 exec, vcc
buffer_load_dwordx4 v[44:47], v7, s[84:87], s33 offen offset:3072 sc1
s_mov_b64 exec, -1
s_branch mega_kernel_rf_pa_11_0
.p2align 5
mega_kernel_rf_pa_11_3:
s_waitcnt vmcnt(2)
v_max_u32 v4, v44, v46
v_cmp_eq_u32 vcc, -1, v4
s_cbranch_vccnz mega_kernel_rf_pa_11_3f
v_smfmac_f32_16x16x64_bf16 v[96:99], v[44:47], a[24:31], v6
v_smfmac_f32_16x16x64_bf16 v[100:103], v[44:47], a[56:63], v6
v_smfmac_f32_16x16x64_bf16 v[104:107], v[44:47], a[88:95], v6
v_smfmac_f32_16x16x64_bf16 v[108:111], v[44:47], a[120:127], v6
s_branch mega_kernel_rf_pa_3_0
.p2align 5
mega_kernel_rf_pa_12_2f:
s_mov_b64 exec, vcc
buffer_load_dwordx4 v[40:43], v7, s[84:87], s33 offen offset:2048 sc1
s_mov_b64 exec, -1
s_branch mega_kernel_rf_pa_12_3
.p2align 5
mega_kernel_rf_pa_12_2:
s_waitcnt vmcnt(1)
v_max_u32 v4, v40, v42
v_cmp_eq_u32 vcc, -1, v4
s_cbranch_vccnz mega_kernel_rf_pa_12_2f
v_smfmac_f32_16x16x64_bf16 v[96:99], v[40:43], a[16:23], v6
v_smfmac_f32_16x16x64_bf16 v[100:103], v[40:43], a[48:55], v6
v_smfmac_f32_16x16x64_bf16 v[104:107], v[40:43], a[80:87], v6
v_smfmac_f32_16x16x64_bf16 v[108:111], v[40:43], a[112:119], v6
s_branch mega_kernel_rf_pa_8_3
.p2align 5
mega_kernel_rf_pa_12_3f:
s_mov_b64 exec, vcc
buffer_load_dwordx4 v[44:47], v7, s[84:87], s33 offen offset:3072 sc1
s_mov_b64 exec, -1
s_branch mega_kernel_rf_pa_12_2
.p2align 5
mega_kernel_rf_pa_12_3:
s_waitcnt vmcnt(1)
v_max_u32 v4, v44, v46
v_cmp_eq_u32 vcc, -1, v4
s_cbranch_vccnz mega_kernel_rf_pa_12_3f
v_smfmac_f32_16x16x64_bf16 v[96:99], v[44:47], a[24:31], v6
v_smfmac_f32_16x16x64_bf16 v[100:103], v[44:47], a[56:63], v6
v_smfmac_f32_16x16x64_bf16 v[104:107], v[44:47], a[88:95], v6
v_smfmac_f32_16x16x64_bf16 v[108:111], v[44:47], a[120:127], v6
s_branch mega_kernel_rf_pa_4_2
.p2align 5
mega_kernel_rf_pa_13_0f:
s_mov_b64 exec, vcc
buffer_load_dwordx4 v[32:35], v7, s[84:87], s33 offen offset:0 sc1
s_mov_b64 exec, -1
s_branch mega_kernel_rf_pa_13_2
.p2align 5
mega_kernel_rf_pa_13_0:
s_waitcnt vmcnt(2)
v_max_u32 v4, v32, v34
v_cmp_eq_u32 vcc, -1, v4
s_cbranch_vccnz mega_kernel_rf_pa_13_0f
v_smfmac_f32_16x16x64_bf16 v[96:99], v[32:35], a[0:7], v6
v_smfmac_f32_16x16x64_bf16 v[100:103], v[32:35], a[32:39], v6
v_smfmac_f32_16x16x64_bf16 v[104:107], v[32:35], a[64:71], v6
v_smfmac_f32_16x16x64_bf16 v[108:111], v[32:35], a[96:103], v6
s_branch mega_kernel_rf_pa_12_2
.p2align 5
mega_kernel_rf_pa_13_2f:
s_mov_b64 exec, vcc
buffer_load_dwordx4 v[40:43], v7, s[84:87], s33 offen offset:2048 sc1
s_mov_b64 exec, -1
s_branch mega_kernel_rf_pa_13_3
.p2align 5
mega_kernel_rf_pa_13_2:
s_waitcnt vmcnt(2)
v_max_u32 v4, v40, v42
v_cmp_eq_u32 vcc, -1, v4
s_cbranch_vccnz mega_kernel_rf_pa_13_2f
v_smfmac_f32_16x16x64_bf16 v[96:99], v[40:43], a[16:23], v6
v_smfmac_f32_16x16x64_bf16 v[100:103], v[40:43], a[48:55], v6
v_smfmac_f32_16x16x64_bf16 v[104:107], v[40:43], a[80:87], v6
v_smfmac_f32_16x16x64_bf16 v[108:111], v[40:43], a[112:119], v6
s_branch mega_kernel_rf_pa_9_3
.p2align 5
mega_kernel_rf_pa_13_3f:
s_mov_b64 exec, vcc
buffer_load_dwordx4 v[44:47], v7, s[84:87], s33 offen offset:3072 sc1
s_mov_b64 exec, -1
s_branch mega_kernel_rf_pa_13_0
.p2align 5
mega_kernel_rf_pa_13_3:
s_waitcnt vmcnt(2)
v_max_u32 v4, v44, v46
v_cmp_eq_u32 vcc, -1, v4
s_cbranch_vccnz mega_kernel_rf_pa_13_3f
v_smfmac_f32_16x16x64_bf16 v[96:99], v[44:47], a[24:31], v6
v_smfmac_f32_16x16x64_bf16 v[100:103], v[44:47], a[56:63], v6
v_smfmac_f32_16x16x64_bf16 v[104:107], v[44:47], a[88:95], v6
v_smfmac_f32_16x16x64_bf16 v[108:111], v[44:47], a[120:127], v6
s_branch mega_kernel_rf_pa_5_0
.p2align 5
mega_kernel_rf_pa_14_1f:
s_mov_b64 exec, vcc
buffer_load_dwordx4 v[36:39], v7, s[84:87], s33 offen offset:1024 sc1
s_mov_b64 exec, -1
s_branch mega_kernel_rf_pa_14_2
.p2align 5
mega_kernel_rf_pa_14_1:
s_waitcnt vmcnt(2)
v_max_u32 v4, v36, v38
v_cmp_eq_u32 vcc, -1, v4
s_cbranch_vccnz mega_kernel_rf_pa_14_1f
v_smfmac_f32_16x16x64_bf16 v[96:99], v[36:39], a[8:15], v6
v_smfmac_f32_16x16x64_bf16 v[100:103], v[36:39], a[40:47], v6
v_smfmac_f32_16x16x64_bf16 v[104:107], v[36:39], a[72:79], v6
v_smfmac_f32_16x16x64_bf16 v[108:111], v[36:39], a[104:111], v6
s_branch mega_kernel_rf_pa_12_2
.p2align 5
mega_kernel_rf_pa_14_2f:
s_mov_b64 exec, vcc
buffer_load_dwordx4 v[40:43], v7, s[84:87], s33 offen offset:2048 sc1
s_mov_b64 exec, -1
s_branch mega_kernel_rf_pa_14_3
.p2align 5
mega_kernel_rf_pa_14_2:
s_waitcnt vmcnt(2)
v_max_u32 v4, v40, v42
v_cmp_eq_u32 vcc, -1, v4
s_cbranch_vccnz mega_kernel_rf_pa_14_2f
v_smfmac_f32_16x16x64_bf16 v[96:99], v[40:43], a[16:23], v6
v_smfmac_f32_16x16x64_bf16 v[100:103], v[40:43], a[48:55], v6
v_smfmac_f32_16x16x64_bf16 v[104:107], v[40:43], a[80:87], v6
v_smfmac_f32_16x16x64_bf16 v[108:111], v[40:43], a[112:119], v6
s_branch mega_kernel_rf_pa_10_3
.p2align 5
mega_kernel_rf_pa_14_3f:
s_mov_b64 exec, vcc
buffer_load_dwordx4 v[44:47], v7, s[84:87], s33 offen offset:3072 sc1
s_mov_b64 exec, -1
s_branch mega_kernel_rf_pa_14_1
.p2align 5
mega_kernel_rf_pa_14_3:
s_waitcnt vmcnt(2)
v_max_u32 v4, v44, v46
v_cmp_eq_u32 vcc, -1, v4
s_cbranch_vccnz mega_kernel_rf_pa_14_3f
v_smfmac_f32_16x16x64_bf16 v[96:99], v[44:47], a[24:31], v6
v_smfmac_f32_16x16x64_bf16 v[100:103], v[44:47], a[56:63], v6
v_smfmac_f32_16x16x64_bf16 v[104:107], v[44:47], a[88:95], v6
v_smfmac_f32_16x16x64_bf16 v[108:111], v[44:47], a[120:127], v6
s_branch mega_kernel_rf_pa_6_1
.p2align 5
mega_kernel_rf_pa_15_0f:
s_mov_b64 exec, vcc
buffer_load_dwordx4 v[32:35], v7, s[84:87], s33 offen offset:0 sc1
s_mov_b64 exec, -1
s_branch mega_kernel_rf_pa_15_1
.p2align 5
mega_kernel_rf_pa_15_0:
s_waitcnt vmcnt(3)
v_max_u32 v4, v32, v34
v_cmp_eq_u32 vcc, -1, v4
s_cbranch_vccnz mega_kernel_rf_pa_15_0f
v_smfmac_f32_16x16x64_bf16 v[96:99], v[32:35], a[0:7], v6
v_smfmac_f32_16x16x64_bf16 v[100:103], v[32:35], a[32:39], v6
v_smfmac_f32_16x16x64_bf16 v[104:107], v[32:35], a[64:71], v6
v_smfmac_f32_16x16x64_bf16 v[108:111], v[32:35], a[96:103], v6
s_branch mega_kernel_rf_pa_14_1
.p2align 5
mega_kernel_rf_pa_15_1f:
s_mov_b64 exec, vcc
buffer_load_dwordx4 v[36:39], v7, s[84:87], s33 offen offset:1024 sc1
s_mov_b64 exec, -1
s_branch mega_kernel_rf_pa_15_2
.p2align 5
mega_kernel_rf_pa_15_1:
s_waitcnt vmcnt(3)
v_max_u32 v4, v36, v38
v_cmp_eq_u32 vcc, -1, v4
s_cbranch_vccnz mega_kernel_rf_pa_15_1f
v_smfmac_f32_16x16x64_bf16 v[96:99], v[36:39], a[8:15], v6
v_smfmac_f32_16x16x64_bf16 v[100:103], v[36:39], a[40:47], v6
v_smfmac_f32_16x16x64_bf16 v[104:107], v[36:39], a[72:79], v6
v_smfmac_f32_16x16x64_bf16 v[108:111], v[36:39], a[104:111], v6
s_branch mega_kernel_rf_pa_13_2
.p2align 5
mega_kernel_rf_pa_15_2f:
s_mov_b64 exec, vcc
buffer_load_dwordx4 v[40:43], v7, s[84:87], s33 offen offset:2048 sc1
s_mov_b64 exec, -1
s_branch mega_kernel_rf_pa_15_3
.p2align 5
mega_kernel_rf_pa_15_2:
s_waitcnt vmcnt(3)
v_max_u32 v4, v40, v42
v_cmp_eq_u32 vcc, -1, v4
s_cbranch_vccnz mega_kernel_rf_pa_15_2f
v_smfmac_f32_16x16x64_bf16 v[96:99], v[40:43], a[16:23], v6
v_smfmac_f32_16x16x64_bf16 v[100:103], v[40:43], a[48:55], v6
v_smfmac_f32_16x16x64_bf16 v[104:107], v[40:43], a[80:87], v6
v_smfmac_f32_16x16x64_bf16 v[108:111], v[40:43], a[112:119], v6
s_branch mega_kernel_rf_pa_11_3
.p2align 5
mega_kernel_rf_pa_15_3f:
s_mov_b64 exec, vcc
buffer_load_dwordx4 v[44:47], v7, s[84:87], s33 offen offset:3072 sc1
s_mov_b64 exec, -1
s_branch mega_kernel_rf_pa_15_0
.p2align 5
mega_kernel_rf_pa_15_3:
s_waitcnt vmcnt(3)
v_max_u32 v4, v44, v46
v_cmp_eq_u32 vcc, -1, v4
s_cbranch_vccnz mega_kernel_rf_pa_15_3f
v_smfmac_f32_16x16x64_bf16 v[96:99], v[44:47], a[24:31], v6
v_smfmac_f32_16x16x64_bf16 v[100:103], v[44:47], a[56:63], v6
v_smfmac_f32_16x16x64_bf16 v[104:107], v[44:47], a[88:95], v6
v_smfmac_f32_16x16x64_bf16 v[108:111], v[44:47], a[120:127], v6
s_branch mega_kernel_rf_pa_7_0
.p2align 5
mega_kernel_rf_pc_1_0f:
s_mov_b64 exec, vcc
buffer_load_dwordx4 v[32:35], v7, s[84:87], s29 offen offset:0 sc1
s_mov_b64 exec, -1
s_branch mega_kernel_rf_pc_1_0
.p2align 5
mega_kernel_rf_pc_1_0:
s_waitcnt vmcnt(0)
v_cmp_eq_u32 vcc, -1, v32
s_cbranch_vccnz mega_kernel_rf_pc_1_0f
v_smfmac_f32_16x16x64_bf16 v[96:99], v[32:35], a[192:199], v6
v_smfmac_f32_16x16x64_bf16 v[100:103], v[32:35], a[224:231], v6
s_branch mega_kernel_rf_pc_d
.p2align 5
mega_kernel_rf_pc_2_1f:
s_mov_b64 exec, vcc
buffer_load_dwordx4 v[36:39], v7, s[84:87], s29 offen offset:1024 sc1
s_mov_b64 exec, -1
s_branch mega_kernel_rf_pc_2_1
.p2align 5
mega_kernel_rf_pc_2_1:
s_waitcnt vmcnt(0)
v_cmp_eq_u32 vcc, -1, v36
s_cbranch_vccnz mega_kernel_rf_pc_2_1f
v_smfmac_f32_16x16x64_bf16 v[96:99], v[36:39], a[200:207], v6
v_smfmac_f32_16x16x64_bf16 v[100:103], v[36:39], a[232:239], v6
s_branch mega_kernel_rf_pc_d
.p2align 5
mega_kernel_rf_pc_3_0f:
s_mov_b64 exec, vcc
buffer_load_dwordx4 v[32:35], v7, s[84:87], s29 offen offset:0 sc1
s_mov_b64 exec, -1
s_branch mega_kernel_rf_pc_3_1
.p2align 5
mega_kernel_rf_pc_3_0:
s_waitcnt vmcnt(1)
v_cmp_eq_u32 vcc, -1, v32
s_cbranch_vccnz mega_kernel_rf_pc_3_0f
v_smfmac_f32_16x16x64_bf16 v[96:99], v[32:35], a[192:199], v6
v_smfmac_f32_16x16x64_bf16 v[100:103], v[32:35], a[224:231], v6
s_branch mega_kernel_rf_pc_2_1
.p2align 5
mega_kernel_rf_pc_3_1f:
s_mov_b64 exec, vcc
buffer_load_dwordx4 v[36:39], v7, s[84:87], s29 offen offset:1024 sc1
s_mov_b64 exec, -1
s_branch mega_kernel_rf_pc_3_0
.p2align 5
mega_kernel_rf_pc_3_1:
s_waitcnt vmcnt(1)
v_cmp_eq_u32 vcc, -1, v36
s_cbranch_vccnz mega_kernel_rf_pc_3_1f
v_smfmac_f32_16x16x64_bf16 v[96:99], v[36:39], a[200:207], v6
v_smfmac_f32_16x16x64_bf16 v[100:103], v[36:39], a[232:239], v6
s_branch mega_kernel_rf_pc_1_0
.p2align 5
mega_kernel_rf_pc_4_2f:
s_mov_b64 exec, vcc
buffer_load_dwordx4 v[40:43], v7, s[84:87], s29 offen offset:2048 sc1
s_mov_b64 exec, -1
s_branch mega_kernel_rf_pc_4_2
.p2align 5
mega_kernel_rf_pc_4_2:
s_waitcnt vmcnt(0)
v_cmp_eq_u32 vcc, -1, v40
s_cbranch_vccnz mega_kernel_rf_pc_4_2f
v_smfmac_f32_16x16x64_bf16 v[96:99], v[40:43], a[208:215], v6
v_smfmac_f32_16x16x64_bf16 v[100:103], v[40:43], a[240:247], v6
s_branch mega_kernel_rf_pc_d
.p2align 5
mega_kernel_rf_pc_5_0f:
s_mov_b64 exec, vcc
buffer_load_dwordx4 v[32:35], v7, s[84:87], s29 offen offset:0 sc1
s_mov_b64 exec, -1
s_branch mega_kernel_rf_pc_5_2
.p2align 5
mega_kernel_rf_pc_5_0:
s_waitcnt vmcnt(1)
v_cmp_eq_u32 vcc, -1, v32
s_cbranch_vccnz mega_kernel_rf_pc_5_0f
v_smfmac_f32_16x16x64_bf16 v[96:99], v[32:35], a[192:199], v6
v_smfmac_f32_16x16x64_bf16 v[100:103], v[32:35], a[224:231], v6
s_branch mega_kernel_rf_pc_4_2
.p2align 5
mega_kernel_rf_pc_5_2f:
s_mov_b64 exec, vcc
buffer_load_dwordx4 v[40:43], v7, s[84:87], s29 offen offset:2048 sc1
s_mov_b64 exec, -1
s_branch mega_kernel_rf_pc_5_0
.p2align 5
mega_kernel_rf_pc_5_2:
s_waitcnt vmcnt(1)
v_cmp_eq_u32 vcc, -1, v40
s_cbranch_vccnz mega_kernel_rf_pc_5_2f
v_smfmac_f32_16x16x64_bf16 v[96:99], v[40:43], a[208:215], v6
v_smfmac_f32_16x16x64_bf16 v[100:103], v[40:43], a[240:247], v6
s_branch mega_kernel_rf_pc_1_0
.p2align 5
mega_kernel_rf_pc_6_1f:
s_mov_b64 exec, vcc
buffer_load_dwordx4 v[36:39], v7, s[84:87], s29 offen offset:1024 sc1
s_mov_b64 exec, -1
s_branch mega_kernel_rf_pc_6_2
.p2align 5
mega_kernel_rf_pc_6_1:
s_waitcnt vmcnt(1)
v_cmp_eq_u32 vcc, -1, v36
s_cbranch_vccnz mega_kernel_rf_pc_6_1f
v_smfmac_f32_16x16x64_bf16 v[96:99], v[36:39], a[200:207], v6
v_smfmac_f32_16x16x64_bf16 v[100:103], v[36:39], a[232:239], v6
s_branch mega_kernel_rf_pc_4_2
.p2align 5
mega_kernel_rf_pc_6_2f:
s_mov_b64 exec, vcc
buffer_load_dwordx4 v[40:43], v7, s[84:87], s29 offen offset:2048 sc1
s_mov_b64 exec, -1
s_branch mega_kernel_rf_pc_6_1
.p2align 5
mega_kernel_rf_pc_6_2:
s_waitcnt vmcnt(1)
v_cmp_eq_u32 vcc, -1, v40
s_cbranch_vccnz mega_kernel_rf_pc_6_2f
v_smfmac_f32_16x16x64_bf16 v[96:99], v[40:43], a[208:215], v6
v_smfmac_f32_16x16x64_bf16 v[100:103], v[40:43], a[240:247], v6
s_branch mega_kernel_rf_pc_2_1
.p2align 5
mega_kernel_rf_pc_7_0f:
s_mov_b64 exec, vcc
buffer_load_dwordx4 v[32:35], v7, s[84:87], s29 offen offset:0 sc1
s_mov_b64 exec, -1
s_branch mega_kernel_rf_pc_7_1
.p2align 5
mega_kernel_rf_pc_7_0:
s_waitcnt vmcnt(2)
v_cmp_eq_u32 vcc, -1, v32
s_cbranch_vccnz mega_kernel_rf_pc_7_0f
v_smfmac_f32_16x16x64_bf16 v[96:99], v[32:35], a[192:199], v6
v_smfmac_f32_16x16x64_bf16 v[100:103], v[32:35], a[224:231], v6
s_branch mega_kernel_rf_pc_6_1
.p2align 5
mega_kernel_rf_pc_7_1f:
s_mov_b64 exec, vcc
buffer_load_dwordx4 v[36:39], v7, s[84:87], s29 offen offset:1024 sc1
s_mov_b64 exec, -1
s_branch mega_kernel_rf_pc_7_2
.p2align 5
mega_kernel_rf_pc_7_1:
s_waitcnt vmcnt(2)
v_cmp_eq_u32 vcc, -1, v36
s_cbranch_vccnz mega_kernel_rf_pc_7_1f
v_smfmac_f32_16x16x64_bf16 v[96:99], v[36:39], a[200:207], v6
v_smfmac_f32_16x16x64_bf16 v[100:103], v[36:39], a[232:239], v6
s_branch mega_kernel_rf_pc_5_2
.p2align 5
mega_kernel_rf_pc_7_2f:
s_mov_b64 exec, vcc
buffer_load_dwordx4 v[40:43], v7, s[84:87], s29 offen offset:2048 sc1
s_mov_b64 exec, -1
s_branch mega_kernel_rf_pc_7_0
.p2align 5
mega_kernel_rf_pc_7_2:
s_waitcnt vmcnt(2)
v_cmp_eq_u32 vcc, -1, v40
s_cbranch_vccnz mega_kernel_rf_pc_7_2f
v_smfmac_f32_16x16x64_bf16 v[96:99], v[40:43], a[208:215], v6
v_smfmac_f32_16x16x64_bf16 v[100:103], v[40:43], a[240:247], v6
s_branch mega_kernel_rf_pc_3_0
.p2align 5
mega_kernel_rf_pc_8_3f:
s_mov_b64 exec, vcc
buffer_load_dwordx4 v[44:47], v7, s[84:87], s29 offen offset:3072 sc1
s_mov_b64 exec, -1
s_branch mega_kernel_rf_pc_8_3
.p2align 5
mega_kernel_rf_pc_9_0f:
s_mov_b64 exec, vcc
buffer_load_dwordx4 v[32:35], v7, s[84:87], s29 offen offset:0 sc1
s_mov_b64 exec, -1
s_branch mega_kernel_rf_pc_9_3
.p2align 5
mega_kernel_rf_pc_9_0:
s_waitcnt vmcnt(1)
v_cmp_eq_u32 vcc, -1, v32
s_cbranch_vccnz mega_kernel_rf_pc_9_0f
v_smfmac_f32_16x16x64_bf16 v[96:99], v[32:35], a[192:199], v6
v_smfmac_f32_16x16x64_bf16 v[100:103], v[32:35], a[224:231], v6
s_branch mega_kernel_rf_pc_8_3
.p2align 5
mega_kernel_rf_pc_9_3f:
s_mov_b64 exec, vcc
buffer_load_dwordx4 v[44:47], v7, s[84:87], s29 offen offset:3072 sc1
s_mov_b64 exec, -1
s_branch mega_kernel_rf_pc_9_0
.p2align 5
mega_kernel_rf_pc_9_3:
s_waitcnt vmcnt(1)
v_cmp_eq_u32 vcc, -1, v44
s_cbranch_vccnz mega_kernel_rf_pc_9_3f
v_smfmac_f32_16x16x64_bf16 v[96:99], v[44:47], a[216:223], v6
v_smfmac_f32_16x16x64_bf16 v[100:103], v[44:47], a[248:255], v6
s_branch mega_kernel_rf_pc_1_0
.p2align 5
mega_kernel_rf_pc_10_1f:
s_mov_b64 exec, vcc
buffer_load_dwordx4 v[36:39], v7, s[84:87], s29 offen offset:1024 sc1
s_mov_b64 exec, -1
s_branch mega_kernel_rf_pc_10_3
.p2align 5
mega_kernel_rf_pc_10_1:
s_waitcnt vmcnt(1)
v_cmp_eq_u32 vcc, -1, v36
s_cbranch_vccnz mega_kernel_rf_pc_10_1f
v_smfmac_f32_16x16x64_bf16 v[96:99], v[36:39], a[200:207], v6
v_smfmac_f32_16x16x64_bf16 v[100:103], v[36:39], a[232:239], v6
s_branch mega_kernel_rf_pc_8_3
.p2align 5
mega_kernel_rf_pc_10_3f:
s_mov_b64 exec, vcc
buffer_load_dwordx4 v[44:47], v7, s[84:87], s29 offen offset:3072 sc1
s_mov_b64 exec, -1
s_branch mega_kernel_rf_pc_10_1
.p2align 5
mega_kernel_rf_pc_10_3:
s_waitcnt vmcnt(1)
v_cmp_eq_u32 vcc, -1, v44
s_cbranch_vccnz mega_kernel_rf_pc_10_3f
v_smfmac_f32_16x16x64_bf16 v[96:99], v[44:47], a[216:223], v6
v_smfmac_f32_16x16x64_bf16 v[100:103], v[44:47], a[248:255], v6
s_branch mega_kernel_rf_pc_2_1
.p2align 5
mega_kernel_rf_pc_11_0f:
s_mov_b64 exec, vcc
buffer_load_dwordx4 v[32:35], v7, s[84:87], s29 offen offset:0 sc1
s_mov_b64 exec, -1
s_branch mega_kernel_rf_pc_11_1
.p2align 5
mega_kernel_rf_pc_11_0:
s_waitcnt vmcnt(2)
v_cmp_eq_u32 vcc, -1, v32
s_cbranch_vccnz mega_kernel_rf_pc_11_0f
v_smfmac_f32_16x16x64_bf16 v[96:99], v[32:35], a[192:199], v6
v_smfmac_f32_16x16x64_bf16 v[100:103], v[32:35], a[224:231], v6
s_branch mega_kernel_rf_pc_10_1
.p2align 5
mega_kernel_rf_pc_11_1f:
s_mov_b64 exec, vcc
buffer_load_dwordx4 v[36:39], v7, s[84:87], s29 offen offset:1024 sc1
s_mov_b64 exec, -1
s_branch mega_kernel_rf_pc_11_3
.p2align 5
mega_kernel_rf_pc_11_1:
s_waitcnt vmcnt(2)
v_cmp_eq_u32 vcc, -1, v36
s_cbranch_vccnz mega_kernel_rf_pc_11_1f
v_smfmac_f32_16x16x64_bf16 v[96:99], v[36:39], a[200:207], v6
v_smfmac_f32_16x16x64_bf16 v[100:103], v[36:39], a[232:239], v6
s_branch mega_kernel_rf_pc_9_3
.p2align 5
mega_kernel_rf_pc_11_3f:
s_mov_b64 exec, vcc
buffer_load_dwordx4 v[44:47], v7, s[84:87], s29 offen offset:3072 sc1
s_mov_b64 exec, -1
s_branch mega_kernel_rf_pc_11_0
.p2align 5
mega_kernel_rf_pc_11_3:
s_waitcnt vmcnt(2)
v_cmp_eq_u32 vcc, -1, v44
s_cbranch_vccnz mega_kernel_rf_pc_11_3f
v_smfmac_f32_16x16x64_bf16 v[96:99], v[44:47], a[216:223], v6
v_smfmac_f32_16x16x64_bf16 v[100:103], v[44:47], a[248:255], v6
s_branch mega_kernel_rf_pc_3_0
.p2align 5
mega_kernel_rf_pc_12_2f:
s_mov_b64 exec, vcc
buffer_load_dwordx4 v[40:43], v7, s[84:87], s29 offen offset:2048 sc1
s_mov_b64 exec, -1
s_branch mega_kernel_rf_pc_12_3
.p2align 5
mega_kernel_rf_pc_12_3f:
s_mov_b64 exec, vcc
buffer_load_dwordx4 v[44:47], v7, s[84:87], s29 offen offset:3072 sc1
s_mov_b64 exec, -1
s_branch mega_kernel_rf_pc_12_2
.p2align 5
mega_kernel_rf_pc_12_3:
s_waitcnt vmcnt(1)
v_cmp_eq_u32 vcc, -1, v44
s_cbranch_vccnz mega_kernel_rf_pc_12_3f
v_smfmac_f32_16x16x64_bf16 v[96:99], v[44:47], a[216:223], v6
v_smfmac_f32_16x16x64_bf16 v[100:103], v[44:47], a[248:255], v6
s_branch mega_kernel_rf_pc_4_2
.p2align 5
mega_kernel_rf_pc_13_0f:
s_mov_b64 exec, vcc
buffer_load_dwordx4 v[32:35], v7, s[84:87], s29 offen offset:0 sc1
s_mov_b64 exec, -1
s_branch mega_kernel_rf_pc_13_2
.p2align 5
mega_kernel_rf_pc_13_0:
s_waitcnt vmcnt(2)
v_cmp_eq_u32 vcc, -1, v32
s_cbranch_vccnz mega_kernel_rf_pc_13_0f
v_smfmac_f32_16x16x64_bf16 v[96:99], v[32:35], a[192:199], v6
v_smfmac_f32_16x16x64_bf16 v[100:103], v[32:35], a[224:231], v6
s_branch mega_kernel_rf_pc_12_2
.p2align 5
mega_kernel_rf_pc_13_2f:
s_mov_b64 exec, vcc
buffer_load_dwordx4 v[40:43], v7, s[84:87], s29 offen offset:2048 sc1
s_mov_b64 exec, -1
s_branch mega_kernel_rf_pc_13_3
.p2align 5
mega_kernel_rf_pc_13_2:
s_waitcnt vmcnt(2)
v_cmp_eq_u32 vcc, -1, v40
s_cbranch_vccnz mega_kernel_rf_pc_13_2f
v_smfmac_f32_16x16x64_bf16 v[96:99], v[40:43], a[208:215], v6
v_smfmac_f32_16x16x64_bf16 v[100:103], v[40:43], a[240:247], v6
s_branch mega_kernel_rf_pc_9_3
.p2align 5
mega_kernel_rf_pc_13_3f:
s_mov_b64 exec, vcc
buffer_load_dwordx4 v[44:47], v7, s[84:87], s29 offen offset:3072 sc1
s_mov_b64 exec, -1
s_branch mega_kernel_rf_pc_13_0
.p2align 5
mega_kernel_rf_pc_13_3:
s_waitcnt vmcnt(2)
v_cmp_eq_u32 vcc, -1, v44
s_cbranch_vccnz mega_kernel_rf_pc_13_3f
v_smfmac_f32_16x16x64_bf16 v[96:99], v[44:47], a[216:223], v6
v_smfmac_f32_16x16x64_bf16 v[100:103], v[44:47], a[248:255], v6
s_branch mega_kernel_rf_pc_5_0
.p2align 5
mega_kernel_rf_pc_14_1f:
s_mov_b64 exec, vcc
buffer_load_dwordx4 v[36:39], v7, s[84:87], s29 offen offset:1024 sc1
s_mov_b64 exec, -1
s_branch mega_kernel_rf_pc_14_2
.p2align 5
mega_kernel_rf_pc_14_2f:
s_mov_b64 exec, vcc
buffer_load_dwordx4 v[40:43], v7, s[84:87], s29 offen offset:2048 sc1
s_mov_b64 exec, -1
s_branch mega_kernel_rf_pc_14_3
.p2align 5
mega_kernel_rf_pc_14_2:
s_waitcnt vmcnt(2)
v_cmp_eq_u32 vcc, -1, v40
s_cbranch_vccnz mega_kernel_rf_pc_14_2f
v_smfmac_f32_16x16x64_bf16 v[96:99], v[40:43], a[208:215], v6
v_smfmac_f32_16x16x64_bf16 v[100:103], v[40:43], a[240:247], v6
s_branch mega_kernel_rf_pc_10_3
.p2align 5
mega_kernel_rf_pc_14_3f:
s_mov_b64 exec, vcc
buffer_load_dwordx4 v[44:47], v7, s[84:87], s29 offen offset:3072 sc1
s_mov_b64 exec, -1
s_branch mega_kernel_rf_pc_14_1
.p2align 5
mega_kernel_rf_pc_14_3:
s_waitcnt vmcnt(2)
v_cmp_eq_u32 vcc, -1, v44
s_cbranch_vccnz mega_kernel_rf_pc_14_3f
v_smfmac_f32_16x16x64_bf16 v[96:99], v[44:47], a[216:223], v6
v_smfmac_f32_16x16x64_bf16 v[100:103], v[44:47], a[248:255], v6
s_branch mega_kernel_rf_pc_6_1
.p2align 5
mega_kernel_rf_pc_15_0f:
s_mov_b64 exec, vcc
buffer_load_dwordx4 v[32:35], v7, s[84:87], s29 offen offset:0 sc1
s_mov_b64 exec, -1
s_branch mega_kernel_rf_pc_15_1
.p2align 5
mega_kernel_rf_pc_15_1f:
s_mov_b64 exec, vcc
buffer_load_dwordx4 v[36:39], v7, s[84:87], s29 offen offset:1024 sc1
s_mov_b64 exec, -1
s_branch mega_kernel_rf_pc_15_2
.p2align 5
mega_kernel_rf_pc_15_1:
s_waitcnt vmcnt(3)
v_cmp_eq_u32 vcc, -1, v36
s_cbranch_vccnz mega_kernel_rf_pc_15_1f
v_smfmac_f32_16x16x64_bf16 v[96:99], v[36:39], a[200:207], v6
v_smfmac_f32_16x16x64_bf16 v[100:103], v[36:39], a[232:239], v6
s_branch mega_kernel_rf_pc_13_2
.p2align 5
mega_kernel_rf_pc_15_2f:
s_mov_b64 exec, vcc
buffer_load_dwordx4 v[40:43], v7, s[84:87], s29 offen offset:2048 sc1
s_mov_b64 exec, -1
s_branch mega_kernel_rf_pc_15_3
.p2align 5
mega_kernel_rf_pc_15_2:
s_waitcnt vmcnt(3)
v_cmp_eq_u32 vcc, -1, v40
s_cbranch_vccnz mega_kernel_rf_pc_15_2f
v_smfmac_f32_16x16x64_bf16 v[96:99], v[40:43], a[208:215], v6
v_smfmac_f32_16x16x64_bf16 v[100:103], v[40:43], a[240:247], v6
s_branch mega_kernel_rf_pc_11_3
.p2align 5
mega_kernel_rf_pc_15_3f:
s_mov_b64 exec, vcc
buffer_load_dwordx4 v[44:47], v7, s[84:87], s29 offen offset:3072 sc1
s_mov_b64 exec, -1
s_branch mega_kernel_rf_pc_15_0
.p2align 5
mega_kernel_rf_pc_15_3:
s_waitcnt vmcnt(3)
v_cmp_eq_u32 vcc, -1, v44
s_cbranch_vccnz mega_kernel_rf_pc_15_3f
v_smfmac_f32_16x16x64_bf16 v[96:99], v[44:47], a[216:223], v6
v_smfmac_f32_16x16x64_bf16 v[100:103], v[44:47], a[248:255], v6
s_branch mega_kernel_rf_pc_7_0
mega_kernel_rf_w0last:
s_nop 7
v_permlane32_swap_b32 v112, v116
v_permlane32_swap_b32 v113, v117
v_permlane32_swap_b32 v114, v118
v_permlane32_swap_b32 v115, v119
v_pk_add_f32 v[112:113], v[112:113], v[116:117]
v_pk_add_f32 v[114:115], v[114:115], v[118:119]
ds_write_b128 v20, v[112:115]
s_waitcnt lgkmcnt(0)
s_barrier
s_branch mega_kernel_rf_end
mega_kernel_rf_side:
s_cmp_eq_u32 s24, 3
s_cbranch_scc1 mega_kernel_rf_sd3
s_cmp_eq_u32 s24, 2
s_cbranch_scc0 mega_kernel_rf_sd4
s_mov_b64 exec, s[40:41]
buffer_store_dwordx4 v[28:31], v11, s[84:87], s34 offen
s_mov_b64 exec, -1
buffer_store_dwordx2 v[28:29], v9, s[84:87], s34 offen
s_mul_i32 s28, s31, 2048
s_add_u32 s28, s28, s34
s_add_u32 s28, s28, 49152
buffer_store_dwordx4 v[28:31], v17, s[84:87], s28 offen
buffer_store_dwordx4 v[28:31], v10, s[84:87], s28 offen
s_branch mega_kernel_rf_sd4
mega_kernel_rf_sd3:
v_readlane_b32 s76, v249, 0
v_readlane_b32 s77, v249, 1
s_min_i32 s76, s76, s77
s_max_i32 s46, s46, s76
s_mov_b32 s36, 0
s_add_u32 s76, s27, 1
s_cmp_lt_u32 s76, 63
s_cbranch_scc0 mega_kernel_rf_sd4
s_cmp_ge_u32 s76, 0
s_cbranch_scc0 mega_kernel_rf_sd4
s_cmp_gt_i32 s46, s76
s_cselect_b32 s36, 0, 1
s_cbranch_scc0 mega_kernel_rf_sd4
s_add_u32 s77, s76, s82
s_bfe_u32 s28, s77, 0x40002
s_lshl_b32 s28, s28, 14
s_and_b32 s77, s77, 3
s_lshl_b32 s77, s77, 11
s_add_u32 s28, s28, s77
s_add_u32 m0, s45, 0
s_nop 0
buffer_load_dwordx4 v240, s[84:87], s28 offen offset:0 sc1 lds
s_add_u32 m0, s45, 0
s_nop 0
buffer_load_dwordx4 v240, s[84:87], s28 offen offset:1024 sc1 lds
s_add_u32 m0, s45, 2048
s_nop 0
buffer_load_dwordx4 v241, s[84:87], s28 offen offset:0 sc1 lds
s_add_u32 m0, s45, 2048
s_nop 0
buffer_load_dwordx4 v241, s[84:87], s28 offen offset:1024 sc1 lds
s_add_u32 s45, s45, 4096
s_cmp_eq_u32 s45, 30720
s_cselect_b32 s45, 18432, s45
mega_kernel_rf_sd4:
v_smfmac_f32_16x16x64_bf16 v[112:115], v[40:43], a[144:151], v6
v_smfmac_f32_16x16x64_bf16 v[116:119], v[40:43], a[176:183], v6
v_smfmac_f32_16x16x64_bf16 v[112:115], v[44:47], a[152:159], v6
v_smfmac_f32_16x16x64_bf16 v[116:119], v[44:47], a[184:191], v6
s_nop 7
v_permlane32_swap_b32 v112, v116
v_permlane32_swap_b32 v113, v117
v_permlane32_swap_b32 v114, v118
v_permlane32_swap_b32 v115, v119
v_pk_add_f32 v[112:113], v[112:113], v[116:117]
v_pk_add_f32 v[114:115], v[114:115], v[118:119]
ds_write_b128 v20, v[112:115]
v_mov_b32 v96, 0
v_mov_b32 v97, 0
v_mov_b32 v98, 0
v_mov_b32 v99, 0
v_mov_b32 v100, 0
v_mov_b32 v101, 0
v_mov_b32 v102, 0
v_mov_b32 v103, 0
s_cmp_eq_u32 s24, 1
s_cbranch_scc0 mega_kernel_rf_s1
s_waitcnt lgkmcnt(0)
ds_read_b128 v[120:123], v16 offset:0
ds_read_b128 v[124:127], v16 offset:16
ds_read_b128 v[128:131], v16 offset:2304
ds_read_b128 v[132:135], v16 offset:2320
ds_read_b128 v[136:139], v16 offset:4608
ds_read_b128 v[140:143], v16 offset:4624
ds_read_b128 v[144:147], v16 offset:6912
ds_read_b128 v[148:151], v16 offset:6928
s_waitcnt lgkmcnt(4)
v_pk_add_f32 v[120:121], v[120:121], v[128:129]
v_pk_add_f32 v[122:123], v[122:123], v[130:131]
v_pk_add_f32 v[124:125], v[124:125], v[132:133]
v_pk_add_f32 v[126:127], v[126:127], v[134:135]
s_waitcnt lgkmcnt(0)
v_pk_add_f32 v[136:137], v[136:137], v[144:145]
v_pk_add_f32 v[138:139], v[138:139], v[146:147]
v_pk_add_f32 v[140:141], v[140:141], v[148:149]
v_pk_add_f32 v[142:143], v[142:143], v[150:151]
v_pk_add_f32 v[120:121], v[120:121], v[136:137]
v_pk_add_f32 v[122:123], v[122:123], v[138:139]
v_pk_add_f32 v[124:125], v[124:125], v[140:141]
v_pk_add_f32 v[126:127], v[126:127], v[142:143]
v_cvt_pk_bf16_f32 v244, v120, v121
v_cvt_pk_bf16_f32 v245, v122, v123
v_cvt_pk_bf16_f32 v246, v124, v125
v_cvt_pk_bf16_f32 v247, v126, v127
mega_kernel_rf_s1:
v_add_u32 v5, 9216, v17
s_waitcnt lgkmcnt(0)
s_barrier
s_cmp_eq_u32 s24, 2
s_cbranch_scc1 mega_kernel_rf_s2
s_cmp_eq_u32 s24, 3
s_cbranch_scc0 mega_kernel_rf_s3
s_add_u32 s76, s27, 2
s_cmp_lt_u32 s76, 63
s_cbranch_scc0 mega_kernel_rf_s3
s_cmp_gt_i32 s46, s76
s_cbranch_scc0 mega_kernel_rf_s3
s_add_u32 s77, s76, s82
s_bfe_u32 s28, s77, 0x40002
s_lshl_b32 s28, s28, 14
s_and_b32 s77, s77, 3
s_lshl_b32 s77, s77, 11
s_add_u32 s28, s28, s77
s_add_u32 s28, s28, s83
s_buffer_load_dword s78, s[84:87], s28 offset:0
s_buffer_load_dword s78, s[84:87], s28 offset:128
s_buffer_load_dword s78, s[84:87], s28 offset:256
s_buffer_load_dword s78, s[84:87], s28 offset:384
s_buffer_load_dword s78, s[84:87], s28 offset:512
s_buffer_load_dword s78, s[84:87], s28 offset:640
s_buffer_load_dword s78, s[84:87], s28 offset:768
s_buffer_load_dword s78, s[84:87], s28 offset:896
s_buffer_load_dword s78, s[84:87], s28 offset:1024
s_buffer_load_dword s78, s[84:87], s28 offset:1152
s_buffer_load_dword s78, s[84:87], s28 offset:1280
s_buffer_load_dword s78, s[84:87], s28 offset:1408
s_buffer_load_dword s78, s[84:87], s28 offset:1536
s_buffer_load_dword s78, s[84:87], s28 offset:1664
s_buffer_load_dword s78, s[84:87], s28 offset:1792
s_buffer_load_dword s78, s[84:87], s28 offset:1920
s_mov_b32 s88, s76
s_branch mega_kernel_rf_s3
mega_kernel_rf_s2:
ds_read_b128 v[120:123], v5 offset:0
ds_read_b128 v[124:127], v5 offset:1024
ds_read_b128 v[128:131], v5 offset:2048
ds_read_b128 v[132:135], v5 offset:3072
v_lshrrev_b32 v5, 1, v17
s_waitcnt lgkmcnt(2)
v_pk_add_f32 v[120:121], v[120:121], v[124:125]
v_pk_add_f32 v[122:123], v[122:123], v[126:127]
s_waitcnt lgkmcnt(0)
v_pk_add_f32 v[128:129], v[128:129], v[132:133]
v_pk_add_f32 v[130:131], v[130:131], v[134:135]
v_pk_add_f32 v[120:121], v[120:121], v[128:129]
v_pk_add_f32 v[122:123], v[122:123], v[130:131]
v_cvt_pk_bf16_f32 v244, v120, v121
v_cvt_pk_bf16_f32 v245, v122, v123
ds_write_b64 v5, v[244:245] offset:17920
s_waitcnt lgkmcnt(0) vmcnt(0)
mega_kernel_rf_s3:
s_cmp_eq_u32 s27, 63
s_cbranch_scc1 mega_kernel_rf_slast
s_add_u32 s29, s33, 24576
s_barrier
s_cmp_eq_u32 s24, 3
s_cbranch_scc1 mega_kernel_rf_y3
s_add_u32 s77, s27, s82
s_bfe_u32 s28, s77, 0x30003
s_lshl_b32 s28, s28, 14
s_and_b32 s77, s77, 7
s_lshl_b32 s77, s77, 10
s_add_u32 s28, s28, s77
s_add_u32 s28, s28, s79
s_cmp_eq_u32 s24, 2
s_cbranch_scc1 mega_kernel_rf_kv2a
s_mov_b64 exec, s[48:49]
buffer_store_dwordx4 v[244:247], v22, s[84:87], s28 offen sc1
s_mov_b64 exec, -1
s_branch mega_kernel_rf_kvda
mega_kernel_rf_kv2a:
v_lshlrev_b32 v4, 3, v1
buffer_store_dwordx2 v[244:245], v4, s[84:87], s28 offen offset:512 sc1
mega_kernel_rf_kvda:
s_branch mega_kernel_rf_y4
mega_kernel_rf_y3:
s_add_u32 s76, s27, 2
s_cmp_lt_u32 s76, 63
s_cbranch_scc0 mega_kernel_rf_y4
mega_kernel_rf_y4:
s_branch mega_kernel_rf_b3
mega_kernel_rf_first:
buffer_load_dwordx4 v[32:35], v8, s[20:23], 0 offen offset:0
buffer_load_dwordx4 v[36:39], v8, s[20:23], 0 offen offset:128
buffer_load_dwordx4 v[40:43], v8, s[20:23], 0 offen offset:256
buffer_load_dwordx4 v[44:47], v8, s[20:23], 0 offen offset:384
v_add_u32 v5, s44, v17
ds_read_b128 v[156:159], v5 offset:0
ds_read_b128 v[160:163], v5 offset:1024
ds_read_b128 v[164:167], v5 offset:2048
ds_read_b128 v[168:171], v5 offset:3072
s_waitcnt vmcnt(0)
v_smfmac_f32_16x16x64_bf16 v[96:99], v[32:35], a[0:7], v6
v_smfmac_f32_16x16x64_bf16 v[100:103], v[32:35], a[32:39], v6
v_smfmac_f32_16x16x64_bf16 v[104:107], v[32:35], a[64:71], v6
v_smfmac_f32_16x16x64_bf16 v[108:111], v[32:35], a[96:103], v6
v_smfmac_f32_16x16x64_bf16 v[96:99], v[36:39], a[8:15], v6
v_smfmac_f32_16x16x64_bf16 v[100:103], v[36:39], a[40:47], v6
v_smfmac_f32_16x16x64_bf16 v[104:107], v[36:39], a[72:79], v6
v_smfmac_f32_16x16x64_bf16 v[108:111], v[36:39], a[104:111], v6
v_smfmac_f32_16x16x64_bf16 v[96:99], v[40:43], a[16:23], v6
v_smfmac_f32_16x16x64_bf16 v[100:103], v[40:43], a[48:55], v6
v_smfmac_f32_16x16x64_bf16 v[104:107], v[40:43], a[80:87], v6
v_smfmac_f32_16x16x64_bf16 v[108:111], v[40:43], a[112:119], v6
v_smfmac_f32_16x16x64_bf16 v[96:99], v[44:47], a[24:31], v6
v_smfmac_f32_16x16x64_bf16 v[100:103], v[44:47], a[56:63], v6
v_smfmac_f32_16x16x64_bf16 v[104:107], v[44:47], a[88:95], v6
v_smfmac_f32_16x16x64_bf16 v[108:111], v[44:47], a[120:127], v6
s_nop 1
s_branch mega_kernel_rf_adone
mega_kernel_rf_slast:
s_cmp_eq_u32 s24, 3
s_cbranch_scc1 mega_kernel_rf_end
s_add_u32 s77, s27, s82
s_bfe_u32 s28, s77, 0x30003
s_lshl_b32 s28, s28, 14
s_and_b32 s77, s77, 7
s_lshl_b32 s77, s77, 10
s_add_u32 s28, s28, s77
s_add_u32 s28, s28, s79
s_cmp_eq_u32 s24, 2
s_cbranch_scc1 mega_kernel_rf_kv2b
s_mov_b64 exec, s[48:49]
buffer_store_dwordx4 v[244:247], v22, s[84:87], s28 offen sc1
s_mov_b64 exec, -1
s_branch mega_kernel_rf_kvdb
mega_kernel_rf_kv2b:
v_lshlrev_b32 v4, 3, v1
buffer_store_dwordx2 v[244:245], v4, s[84:87], s28 offen offset:512 sc1
mega_kernel_rf_kvdb:
s_waitcnt vmcnt(0)
s_barrier
s_mov_b32 s76, 64
s_cmp_eq_u32 s24, 1
s_cbranch_scc0 mega_kernel_rf_end
v_mov_b32 v5, s76
s_mov_b64 exec, 1
buffer_store_dword v5, v228, s[84:87], s81 offen sc1
s_mov_b64 exec, -1
mega_kernel_rf_end:
s_endpgm
mega_kernel_recs:
s_load_dwordx2 s[20:21], s[0:1], 8
s_load_dwordx2 s[16:17], s[0:1], 40
s_load_dwordx2 s[4:5], s[0:1], 16
s_load_dwordx2 s[8:9], s[0:1], 24
s_load_dwordx2 s[12:13], s[0:1], 32
v_lshrrev_b32 v4, 6, v0
v_and_b32 v1, 63, v0
v_readfirstlane_b32 s24, v4
v_lshrrev_b32 v2, 4, v1
v_and_b32 v3, 15, v1
v_lshlrev_b32 v17, 4, v1
s_lshr_b32 s28, s31, 2
s_lshl_b32 s25, s30, 3
s_add_u32 s25, s25, s28
s_and_b32 s26, s31, 3
s_waitcnt lgkmcnt(0)
s_mov_b32 s22, 16384
s_mov_b32 s23, 0x00020000
s_mov_b32 s18, 8388608
s_mov_b32 s19, 0x00020000
s_mov_b32 s6, 8388608
s_mov_b32 s7, 0x00020000
s_mov_b32 s10, 8388608
s_mov_b32 s11, 0x00020000
s_mov_b32 s14, 8388608
s_mov_b32 s15, 0x00020000
s_lshl_b32 s28, s25, 8
s_lshr_b32 s29, s26, 0
s_lshl_b32 s29, s29, 6
s_add_u32 s28, s28, s29
s_lshl_b32 s29, s24, 21
s_add_u32 s28, s28, s29
v_lshrrev_b32 v4, 2, v1
v_and_b32 v5, 3, v1
v_lshlrev_b32 v40, 13, v4
v_lshl_add_u32 v40, v5, 4, v40
v_add_u32 v40, s28, v40
s_lshl_b32 s28, s30, 21
s_lshl_b32 s29, s24, 19
s_add_u32 s28, s28, s29
s_lshr_b32 s29, s31, 0
s_lshl_b32 s29, s29, 6
s_add_u32 s28, s28, s29
v_lshlrev_b32 v41, 11, v4
v_lshl_add_u32 v41, v5, 4, v41
v_add_u32 v41, s28, v41
s_lshl_b32 s47, s24, 15
s_add_u32 s47, s47, 32768
s_lshl_b32 s28, s31, 18
s_lshl_b32 s29, s24, 16
s_add_u32 s28, s28, s29
s_lshl_b32 s29, s30, 11
s_add_u32 s28, s28, s29
v_lshlrev_b32 v48, 13, v2
v_lshl_add_u32 v48, v3, 7, v48
v_add_u32 v48, s28, v48
s_lshl_b32 s28, s30, 21
s_lshl_b32 s29, s31, 16
s_add_u32 s28, s28, s29
s_lshl_b32 s29, s24, 14
s_add_u32 s28, s28, s29
v_lshlrev_b32 v49, 7, v1
v_add_u32 v49, s28, v49
s_and_b32 s76, s31, 1
s_mul_i32 s76, s76, 8
s_and_b32 s28, s31, 15
s_lshl_b32 s28, s28, 4
s_lshl_b32 s29, s24, 8
s_add_u32 s28, s28, s29
v_add_u32 v53, s28, v3
s_lshr_b32 s28, s31, 4
s_lshl_b32 s28, s28, 10
s_add_u32 s28, s28, 384
v_mov_b32 v54, s28
v_mov_b32 v55, 1920
v_cmp_gt_u32 vcc, 32, v1
s_nop 1
v_cndmask_b32 v54, v55, v54, vcc
s_lshl_b32 s29, s30, 11
v_lshl_add_u32 v51, v53, 13, v54
v_add_u32 v51, s29, v51
s_lshl_b32 s29, s30, 21
v_lshl_add_u32 v52, v53, 11, v54
v_add_u32 v52, s29, v52
buffer_load_dword v50, v51, s[8:11], 0 offen
s_xor_b32 s29, s76, 0
s_lshl_b32 s28, s29, 10
s_add_u32 s28, s28, s47
s_add_u32 m0, s28, 0
s_lshl_b32 s29, s29, 17
buffer_load_dwordx4 v40, s[8:11], s29 offen lds
s_xor_b32 s29, s76, 1
s_lshl_b32 s28, s29, 10
s_add_u32 s28, s28, s47
s_add_u32 m0, s28, 0
s_lshl_b32 s29, s29, 17
buffer_load_dwordx4 v40, s[8:11], s29 offen lds
s_xor_b32 s29, s76, 2
s_lshl_b32 s28, s29, 10
s_add_u32 s28, s28, s47
s_add_u32 m0, s28, 0
s_lshl_b32 s29, s29, 17
buffer_load_dwordx4 v40, s[8:11], s29 offen lds
s_xor_b32 s29, s76, 3
s_lshl_b32 s28, s29, 10
s_add_u32 s28, s28, s47
s_add_u32 m0, s28, 0
s_lshl_b32 s29, s29, 17
buffer_load_dwordx4 v40, s[8:11], s29 offen lds
s_xor_b32 s29, s76, 4
s_lshl_b32 s28, s29, 10
s_add_u32 s28, s28, s47
s_add_u32 m0, s28, 0
s_lshl_b32 s29, s29, 17
buffer_load_dwordx4 v40, s[8:11], s29 offen lds
s_xor_b32 s29, s76, 5
s_lshl_b32 s28, s29, 10
s_add_u32 s28, s28, s47
s_add_u32 m0, s28, 0
s_lshl_b32 s29, s29, 17
buffer_load_dwordx4 v40, s[8:11], s29 offen lds
s_xor_b32 s29, s76, 6
s_lshl_b32 s28, s29, 10
s_add_u32 s28, s28, s47
s_add_u32 m0, s28, 0
s_lshl_b32 s29, s29, 17
buffer_load_dwordx4 v40, s[8:11], s29 offen lds
s_xor_b32 s29, s76, 7
s_lshl_b32 s28, s29, 10
s_add_u32 s28, s28, s47
s_add_u32 m0, s28, 0
s_lshl_b32 s29, s29, 17
buffer_load_dwordx4 v40, s[8:11], s29 offen lds
s_xor_b32 s29, s76, 8
s_lshl_b32 s28, s29, 10
s_add_u32 s28, s28, s47
s_add_u32 m0, s28, 0
s_lshl_b32 s29, s29, 17
buffer_load_dwordx4 v40, s[8:11], s29 offen lds
s_xor_b32 s29, s76, 9
s_lshl_b32 s28, s29, 10
s_add_u32 s28, s28, s47
s_add_u32 m0, s28, 0
s_lshl_b32 s29, s29, 17
buffer_load_dwordx4 v40, s[8:11], s29 offen lds
s_xor_b32 s29, s76, 10
s_lshl_b32 s28, s29, 10
s_add_u32 s28, s28, s47
s_add_u32 m0, s28, 0
s_lshl_b32 s29, s29, 17
buffer_load_dwordx4 v40, s[8:11], s29 offen lds
s_xor_b32 s29, s76, 11
s_lshl_b32 s28, s29, 10
s_add_u32 s28, s28, s47
s_add_u32 m0, s28, 0
s_lshl_b32 s29, s29, 17
buffer_load_dwordx4 v40, s[8:11], s29 offen lds
s_xor_b32 s29, s76, 12
s_lshl_b32 s28, s29, 10
s_add_u32 s28, s28, s47
s_add_u32 m0, s28, 0
s_lshl_b32 s29, s29, 17
buffer_load_dwordx4 v40, s[8:11], s29 offen lds
s_xor_b32 s29, s76, 13
s_lshl_b32 s28, s29, 10
s_add_u32 s28, s28, s47
s_add_u32 m0, s28, 0
s_lshl_b32 s29, s29, 17
buffer_load_dwordx4 v40, s[8:11], s29 offen lds
s_xor_b32 s29, s76, 14
s_lshl_b32 s28, s29, 10
s_add_u32 s28, s28, s47
s_add_u32 m0, s28, 0
s_lshl_b32 s29, s29, 17
buffer_load_dwordx4 v40, s[8:11], s29 offen lds
s_xor_b32 s29, s76, 15
s_lshl_b32 s28, s29, 10
s_add_u32 s28, s28, s47
s_add_u32 m0, s28, 0
s_lshl_b32 s29, s29, 17
buffer_load_dwordx4 v40, s[8:11], s29 offen lds
buffer_load_dword v50, v51, s[12:15], 0 offen
s_xor_b32 s29, s76, 0
s_lshl_b32 s28, s29, 10
s_add_u32 s28, s28, s47
s_add_u32 m0, s28, 16384
s_lshl_b32 s29, s29, 17
buffer_load_dwordx4 v40, s[12:15], s29 offen lds
s_xor_b32 s29, s76, 1
s_lshl_b32 s28, s29, 10
s_add_u32 s28, s28, s47
s_add_u32 m0, s28, 16384
s_lshl_b32 s29, s29, 17
buffer_load_dwordx4 v40, s[12:15], s29 offen lds
s_xor_b32 s29, s76, 2
s_lshl_b32 s28, s29, 10
s_add_u32 s28, s28, s47
s_add_u32 m0, s28, 16384
s_lshl_b32 s29, s29, 17
buffer_load_dwordx4 v40, s[12:15], s29 offen lds
s_xor_b32 s29, s76, 3
s_lshl_b32 s28, s29, 10
s_add_u32 s28, s28, s47
s_add_u32 m0, s28, 16384
s_lshl_b32 s29, s29, 17
buffer_load_dwordx4 v40, s[12:15], s29 offen lds
s_xor_b32 s29, s76, 4
s_lshl_b32 s28, s29, 10
s_add_u32 s28, s28, s47
s_add_u32 m0, s28, 16384
s_lshl_b32 s29, s29, 17
buffer_load_dwordx4 v40, s[12:15], s29 offen lds
s_xor_b32 s29, s76, 5
s_lshl_b32 s28, s29, 10
s_add_u32 s28, s28, s47
s_add_u32 m0, s28, 16384
s_lshl_b32 s29, s29, 17
buffer_load_dwordx4 v40, s[12:15], s29 offen lds
s_xor_b32 s29, s76, 6
s_lshl_b32 s28, s29, 10
s_add_u32 s28, s28, s47
s_add_u32 m0, s28, 16384
s_lshl_b32 s29, s29, 17
buffer_load_dwordx4 v40, s[12:15], s29 offen lds
s_xor_b32 s29, s76, 7
s_lshl_b32 s28, s29, 10
s_add_u32 s28, s28, s47
s_add_u32 m0, s28, 16384
s_lshl_b32 s29, s29, 17
buffer_load_dwordx4 v40, s[12:15], s29 offen lds
s_xor_b32 s29, s76, 8
s_lshl_b32 s28, s29, 10
s_add_u32 s28, s28, s47
s_add_u32 m0, s28, 16384
s_lshl_b32 s29, s29, 17
buffer_load_dwordx4 v40, s[12:15], s29 offen lds
s_xor_b32 s29, s76, 9
s_lshl_b32 s28, s29, 10
s_add_u32 s28, s28, s47
s_add_u32 m0, s28, 16384
s_lshl_b32 s29, s29, 17
buffer_load_dwordx4 v40, s[12:15], s29 offen lds
s_xor_b32 s29, s76, 10
s_lshl_b32 s28, s29, 10
s_add_u32 s28, s28, s47
s_add_u32 m0, s28, 16384
s_lshl_b32 s29, s29, 17
buffer_load_dwordx4 v40, s[12:15], s29 offen lds
s_xor_b32 s29, s76, 11
s_lshl_b32 s28, s29, 10
s_add_u32 s28, s28, s47
s_add_u32 m0, s28, 16384
s_lshl_b32 s29, s29, 17
buffer_load_dwordx4 v40, s[12:15], s29 offen lds
s_xor_b32 s29, s76, 12
s_lshl_b32 s28, s29, 10
s_add_u32 s28, s28, s47
s_add_u32 m0, s28, 16384
s_lshl_b32 s29, s29, 17
buffer_load_dwordx4 v40, s[12:15], s29 offen lds
s_xor_b32 s29, s76, 13
s_lshl_b32 s28, s29, 10
s_add_u32 s28, s28, s47
s_add_u32 m0, s28, 16384
s_lshl_b32 s29, s29, 17
buffer_load_dwordx4 v40, s[12:15], s29 offen lds
s_xor_b32 s29, s76, 14
s_lshl_b32 s28, s29, 10
s_add_u32 s28, s28, s47
s_add_u32 m0, s28, 16384
s_lshl_b32 s29, s29, 17
buffer_load_dwordx4 v40, s[12:15], s29 offen lds
s_xor_b32 s29, s76, 15
s_lshl_b32 s28, s29, 10
s_add_u32 s28, s28, s47
s_add_u32 m0, s28, 16384
s_lshl_b32 s29, s29, 17
buffer_load_dwordx4 v40, s[12:15], s29 offen lds
s_mov_b32 s40, 0x00ff00ff
s_mov_b32 s41, 0x00ff00ff
s_mov_b32 s48, 0xff00ff00
s_mov_b32 s49, 0xff00ff00
s_mov_b32 s42, 0
s_mov_b32 s43, 0x00ff00ff
s_mov_b32 s32, 0x3e0293ee
v_mov_b32 v23, 0xff800000
v_mov_b32 v6, 0x4444
v_mov_b32 v4, 0xeeee
v_cndmask_b32 v6, v6, v4, s[48:49]
v_mov_b32 v28, -1
v_mov_b32 v29, -1
v_mov_b32 v30, -1
v_mov_b32 v31, -1
s_mul_i32 s28, s24, 4096
v_add_u32 v7, s28, v17
v_and_b32 v4, 7, v1
v_lshlrev_b32 v8, 11, v4
v_lshrrev_b32 v5, 3, v1
v_lshl_add_u32 v8, v5, 4, v8
s_lshl_b32 s28, s24, 9
v_add_u32 v8, s28, v8
s_lshl_b32 s28, s31, 9
s_lshr_b32 s29, s31, 3
s_mul_i32 s29, s29, 0
s_add_u32 s28, s28, s29
v_lshlrev_b32 v9, 3, v1
v_add_u32 v9, s28, v9
v_and_b32 v4, 7, v3
v_lshlrev_b32 v11, 7, v2
v_lshl_add_u32 v11, v4, 4, v11
v_add_u32 v22, 0, v11
s_add_u32 s28, s28, 24576
v_add_u32 v11, s28, v11
v_and_b32 v5, 1, v2
v_lshlrev_b32 v10, 7, v5
v_lshl_add_u32 v10, v4, 4, v10
v_add_u32 v10, 1024, v10
s_xor_b32 s37, s31, 1
s_mul_i32 s37, s37, 2048
s_add_u32 s37, s37, 49152
s_xor_b32 s38, s31, 2
s_mul_i32 s38, s38, 2048
s_add_u32 s38, s38, 49152
s_xor_b32 s39, s31, 3
s_mul_i32 s39, s39, 2048
s_add_u32 s39, s39, 49152
v_and_b32 v4, 1, v2
v_mul_u32_u24 v14, 576, v4
v_lshrrev_b32 v5, 1, v2
v_lshl_add_u32 v5, v5, 4, v3
v_lshl_add_u32 v14, v5, 2, v14
s_mul_i32 s28, s24, 1152
s_add_u32 s28, s28, 13312
v_add_u32 v18, s28, v14
s_mul_i32 s28, s24, 2304
v_add_u32 v14, s28, v14
v_add_u32 v15, 1152, v14
v_mul_u32_u24 v16, 144, v3
v_lshl_add_u32 v16, v2, 5, v16
v_bfe_u32 v4, v1, 1, 3
v_mul_u32_u24 v19, 144, v4
v_lshl_add_u32 v19, v2, 5, v19
v_and_b32 v4, 1, v1
v_lshl_add_u32 v19, v4, 4, v19
v_add_u32 v19, 13312, v19
s_lshl_b32 s28, s24, 10
s_add_u32 s28, s28, 9216
v_add_u32 v20, s28, v17
v_and_b32 v4, 31, v1
v_lshlrev_b32 v21, 3, v4
v_add_u32 v21, 17920, v21
v_lshrrev_b32 v4, 2, v3
v_and_b32 v42, 1, v4
v_lshrrev_b32 v43, 1, v4
v_lshrrev_b32 v44, 1, v2
v_and_b32 v45, 1, v2
v_lshl_add_u32 v46, v44, 4, v42
v_lshl_add_u32 v46, v45, 2, v46
v_lshl_add_u32 v46, v43, 3, v46
v_lshl_add_u32 v47, v44, 3, v42
v_lshl_add_u32 v47, v45, 4, v47
v_lshl_add_u32 v47, v43, 2, v47
v_and_b32 v5, 3, v3
v_lshlrev_b32 v5, 3, v5
v_lshl_add_u32 v46, v46, 6, v5
v_lshl_add_u32 v47, v47, 6, v5
s_and_b32 s28, s31, 0
s_lshl_b32 s28, s28, 6
s_add_u32 s28, s28, s47
v_add_u32 v46, s28, v46
v_add_u32 v47, s28, v47
s_waitcnt vmcnt(17)
ds_read_b64_tr_b16 a[64:65], v46 offset:0
ds_read_b64_tr_b16 a[66:67], v46 offset:128
ds_read_b64_tr_b16 a[68:69], v46 offset:2048
ds_read_b64_tr_b16 a[70:71], v46 offset:2176
ds_read_b64_tr_b16 a[72:73], v46 offset:4096
ds_read_b64_tr_b16 a[74:75], v46 offset:4224
ds_read_b64_tr_b16 a[76:77], v46 offset:6144
ds_read_b64_tr_b16 a[78:79], v46 offset:6272
s_waitcnt lgkmcnt(0)
ds_read_b64_tr_b16 a[80:81], v46 offset:8192
ds_read_b64_tr_b16 a[82:83], v46 offset:8320
ds_read_b64_tr_b16 a[84:85], v46 offset:10240
ds_read_b64_tr_b16 a[86:87], v46 offset:10368
ds_read_b64_tr_b16 a[88:89], v46 offset:12288
ds_read_b64_tr_b16 a[90:91], v46 offset:12416
ds_read_b64_tr_b16 a[92:93], v46 offset:14336
ds_read_b64_tr_b16 a[94:95], v46 offset:14464
s_waitcnt lgkmcnt(0)
ds_read_b64_tr_b16 a[96:97], v46 offset:32
ds_read_b64_tr_b16 a[98:99], v46 offset:160
ds_read_b64_tr_b16 a[100:101], v46 offset:2080
ds_read_b64_tr_b16 a[102:103], v46 offset:2208
ds_read_b64_tr_b16 a[104:105], v46 offset:4128
ds_read_b64_tr_b16 a[106:107], v46 offset:4256
ds_read_b64_tr_b16 a[108:109], v46 offset:6176
ds_read_b64_tr_b16 a[110:111], v46 offset:6304
s_waitcnt lgkmcnt(0)
ds_read_b64_tr_b16 a[112:113], v46 offset:8224
ds_read_b64_tr_b16 a[114:115], v46 offset:8352
ds_read_b64_tr_b16 a[116:117], v46 offset:10272
ds_read_b64_tr_b16 a[118:119], v46 offset:10400
ds_read_b64_tr_b16 a[120:121], v46 offset:12320
ds_read_b64_tr_b16 a[122:123], v46 offset:12448
ds_read_b64_tr_b16 a[124:125], v46 offset:14368
ds_read_b64_tr_b16 a[126:127], v46 offset:14496
s_waitcnt lgkmcnt(0)
buffer_load_dword v50, v51, s[4:7], 0 offen
s_xor_b32 s29, s76, 0
s_lshl_b32 s28, s29, 10
s_add_u32 s28, s28, s47
s_add_u32 m0, s28, 0
s_lshl_b32 s29, s29, 17
buffer_load_dwordx4 v40, s[4:7], s29 offen lds
s_xor_b32 s29, s76, 1
s_lshl_b32 s28, s29, 10
s_add_u32 s28, s28, s47
s_add_u32 m0, s28, 0
s_lshl_b32 s29, s29, 17
buffer_load_dwordx4 v40, s[4:7], s29 offen lds
s_xor_b32 s29, s76, 2
s_lshl_b32 s28, s29, 10
s_add_u32 s28, s28, s47
s_add_u32 m0, s28, 0
s_lshl_b32 s29, s29, 17
buffer_load_dwordx4 v40, s[4:7], s29 offen lds
s_xor_b32 s29, s76, 3
s_lshl_b32 s28, s29, 10
s_add_u32 s28, s28, s47
s_add_u32 m0, s28, 0
s_lshl_b32 s29, s29, 17
buffer_load_dwordx4 v40, s[4:7], s29 offen lds
s_xor_b32 s29, s76, 4
s_lshl_b32 s28, s29, 10
s_add_u32 s28, s28, s47
s_add_u32 m0, s28, 0
s_lshl_b32 s29, s29, 17
buffer_load_dwordx4 v40, s[4:7], s29 offen lds
s_xor_b32 s29, s76, 5
s_lshl_b32 s28, s29, 10
s_add_u32 s28, s28, s47
s_add_u32 m0, s28, 0
s_lshl_b32 s29, s29, 17
buffer_load_dwordx4 v40, s[4:7], s29 offen lds
s_xor_b32 s29, s76, 6
s_lshl_b32 s28, s29, 10
s_add_u32 s28, s28, s47
s_add_u32 m0, s28, 0
s_lshl_b32 s29, s29, 17
buffer_load_dwordx4 v40, s[4:7], s29 offen lds
s_xor_b32 s29, s76, 7
s_lshl_b32 s28, s29, 10
s_add_u32 s28, s28, s47
s_add_u32 m0, s28, 0
s_lshl_b32 s29, s29, 17
buffer_load_dwordx4 v40, s[4:7], s29 offen lds
s_xor_b32 s29, s76, 8
s_lshl_b32 s28, s29, 10
s_add_u32 s28, s28, s47
s_add_u32 m0, s28, 0
s_lshl_b32 s29, s29, 17
buffer_load_dwordx4 v40, s[4:7], s29 offen lds
s_xor_b32 s29, s76, 9
s_lshl_b32 s28, s29, 10
s_add_u32 s28, s28, s47
s_add_u32 m0, s28, 0
s_lshl_b32 s29, s29, 17
buffer_load_dwordx4 v40, s[4:7], s29 offen lds
s_xor_b32 s29, s76, 10
s_lshl_b32 s28, s29, 10
s_add_u32 s28, s28, s47
s_add_u32 m0, s28, 0
s_lshl_b32 s29, s29, 17
buffer_load_dwordx4 v40, s[4:7], s29 offen lds
s_xor_b32 s29, s76, 11
s_lshl_b32 s28, s29, 10
s_add_u32 s28, s28, s47
s_add_u32 m0, s28, 0
s_lshl_b32 s29, s29, 17
buffer_load_dwordx4 v40, s[4:7], s29 offen lds
s_xor_b32 s29, s76, 12
s_lshl_b32 s28, s29, 10
s_add_u32 s28, s28, s47
s_add_u32 m0, s28, 0
s_lshl_b32 s29, s29, 17
buffer_load_dwordx4 v40, s[4:7], s29 offen lds
s_xor_b32 s29, s76, 13
s_lshl_b32 s28, s29, 10
s_add_u32 s28, s28, s47
s_add_u32 m0, s28, 0
s_lshl_b32 s29, s29, 17
buffer_load_dwordx4 v40, s[4:7], s29 offen lds
s_xor_b32 s29, s76, 14
s_lshl_b32 s28, s29, 10
s_add_u32 s28, s28, s47
s_add_u32 m0, s28, 0
s_lshl_b32 s29, s29, 17
buffer_load_dwordx4 v40, s[4:7], s29 offen lds
s_xor_b32 s29, s76, 15
s_lshl_b32 s28, s29, 10
s_add_u32 s28, s28, s47
s_add_u32 m0, s28, 0
s_lshl_b32 s29, s29, 17
buffer_load_dwordx4 v40, s[4:7], s29 offen lds
s_waitcnt vmcnt(17)
ds_read_b64_tr_b16 a[128:129], v46 offset:16384
ds_read_b64_tr_b16 a[130:131], v46 offset:16512
ds_read_b64_tr_b16 a[132:133], v46 offset:18432
ds_read_b64_tr_b16 a[134:135], v46 offset:18560
ds_read_b64_tr_b16 a[136:137], v46 offset:20480
ds_read_b64_tr_b16 a[138:139], v46 offset:20608
ds_read_b64_tr_b16 a[140:141], v46 offset:22528
ds_read_b64_tr_b16 a[142:143], v46 offset:22656
s_waitcnt lgkmcnt(0)
ds_read_b64_tr_b16 a[144:145], v46 offset:24576
ds_read_b64_tr_b16 a[146:147], v46 offset:24704
ds_read_b64_tr_b16 a[148:149], v46 offset:26624
ds_read_b64_tr_b16 a[150:151], v46 offset:26752
ds_read_b64_tr_b16 a[152:153], v46 offset:28672
ds_read_b64_tr_b16 a[154:155], v46 offset:28800
ds_read_b64_tr_b16 a[156:157], v46 offset:30720
ds_read_b64_tr_b16 a[158:159], v46 offset:30848
s_waitcnt lgkmcnt(0)
ds_read_b64_tr_b16 a[160:161], v46 offset:16416
ds_read_b64_tr_b16 a[162:163], v46 offset:16544
ds_read_b64_tr_b16 a[164:165], v46 offset:18464
ds_read_b64_tr_b16 a[166:167], v46 offset:18592
ds_read_b64_tr_b16 a[168:169], v46 offset:20512
ds_read_b64_tr_b16 a[170:171], v46 offset:20640
ds_read_b64_tr_b16 a[172:173], v46 offset:22560
ds_read_b64_tr_b16 a[174:175], v46 offset:22688
s_waitcnt lgkmcnt(0)
ds_read_b64_tr_b16 a[176:177], v46 offset:24608
ds_read_b64_tr_b16 a[178:179], v46 offset:24736
ds_read_b64_tr_b16 a[180:181], v46 offset:26656
ds_read_b64_tr_b16 a[182:183], v46 offset:26784
ds_read_b64_tr_b16 a[184:185], v46 offset:28704
ds_read_b64_tr_b16 a[186:187], v46 offset:28832
ds_read_b64_tr_b16 a[188:189], v46 offset:30752
ds_read_b64_tr_b16 a[190:191], v46 offset:30880
s_waitcnt lgkmcnt(0)
buffer_load_dword v50, v52, s[16:19], 0 offen
s_xor_b32 s29, s76, 0
s_lshl_b32 s28, s29, 10
s_add_u32 s28, s28, s47
s_add_u32 m0, s28, 16384
s_lshl_b32 s29, s29, 15
buffer_load_dwordx4 v41, s[16:19], s29 offen lds
s_xor_b32 s29, s76, 1
s_lshl_b32 s28, s29, 10
s_add_u32 s28, s28, s47
s_add_u32 m0, s28, 16384
s_lshl_b32 s29, s29, 15
buffer_load_dwordx4 v41, s[16:19], s29 offen lds
s_xor_b32 s29, s76, 2
s_lshl_b32 s28, s29, 10
s_add_u32 s28, s28, s47
s_add_u32 m0, s28, 16384
s_lshl_b32 s29, s29, 15
buffer_load_dwordx4 v41, s[16:19], s29 offen lds
s_xor_b32 s29, s76, 3
s_lshl_b32 s28, s29, 10
s_add_u32 s28, s28, s47
s_add_u32 m0, s28, 16384
s_lshl_b32 s29, s29, 15
buffer_load_dwordx4 v41, s[16:19], s29 offen lds
s_xor_b32 s29, s76, 4
s_lshl_b32 s28, s29, 10
s_add_u32 s28, s28, s47
s_add_u32 m0, s28, 16384
s_lshl_b32 s29, s29, 15
buffer_load_dwordx4 v41, s[16:19], s29 offen lds
s_xor_b32 s29, s76, 5
s_lshl_b32 s28, s29, 10
s_add_u32 s28, s28, s47
s_add_u32 m0, s28, 16384
s_lshl_b32 s29, s29, 15
buffer_load_dwordx4 v41, s[16:19], s29 offen lds
s_xor_b32 s29, s76, 6
s_lshl_b32 s28, s29, 10
s_add_u32 s28, s28, s47
s_add_u32 m0, s28, 16384
s_lshl_b32 s29, s29, 15
buffer_load_dwordx4 v41, s[16:19], s29 offen lds
s_xor_b32 s29, s76, 7
s_lshl_b32 s28, s29, 10
s_add_u32 s28, s28, s47
s_add_u32 m0, s28, 16384
s_lshl_b32 s29, s29, 15
buffer_load_dwordx4 v41, s[16:19], s29 offen lds
s_xor_b32 s29, s76, 8
s_lshl_b32 s28, s29, 10
s_add_u32 s28, s28, s47
s_add_u32 m0, s28, 16384
s_lshl_b32 s29, s29, 15
buffer_load_dwordx4 v41, s[16:19], s29 offen lds
s_xor_b32 s29, s76, 9
s_lshl_b32 s28, s29, 10
s_add_u32 s28, s28, s47
s_add_u32 m0, s28, 16384
s_lshl_b32 s29, s29, 15
buffer_load_dwordx4 v41, s[16:19], s29 offen lds
s_xor_b32 s29, s76, 10
s_lshl_b32 s28, s29, 10
s_add_u32 s28, s28, s47
s_add_u32 m0, s28, 16384
s_lshl_b32 s29, s29, 15
buffer_load_dwordx4 v41, s[16:19], s29 offen lds
s_xor_b32 s29, s76, 11
s_lshl_b32 s28, s29, 10
s_add_u32 s28, s28, s47
s_add_u32 m0, s28, 16384
s_lshl_b32 s29, s29, 15
buffer_load_dwordx4 v41, s[16:19], s29 offen lds
s_xor_b32 s29, s76, 12
s_lshl_b32 s28, s29, 10
s_add_u32 s28, s28, s47
s_add_u32 m0, s28, 16384
s_lshl_b32 s29, s29, 15
buffer_load_dwordx4 v41, s[16:19], s29 offen lds
s_xor_b32 s29, s76, 13
s_lshl_b32 s28, s29, 10
s_add_u32 s28, s28, s47
s_add_u32 m0, s28, 16384
s_lshl_b32 s29, s29, 15
buffer_load_dwordx4 v41, s[16:19], s29 offen lds
s_xor_b32 s29, s76, 14
s_lshl_b32 s28, s29, 10
s_add_u32 s28, s28, s47
s_add_u32 m0, s28, 16384
s_lshl_b32 s29, s29, 15
buffer_load_dwordx4 v41, s[16:19], s29 offen lds
s_xor_b32 s29, s76, 15
s_lshl_b32 s28, s29, 10
s_add_u32 s28, s28, s47
s_add_u32 m0, s28, 16384
s_lshl_b32 s29, s29, 15
buffer_load_dwordx4 v41, s[16:19], s29 offen lds
s_waitcnt vmcnt(17)
ds_read_b64_tr_b16 a[0:1], v46 offset:0
ds_read_b64_tr_b16 a[2:3], v46 offset:128
ds_read_b64_tr_b16 a[4:5], v46 offset:2048
ds_read_b64_tr_b16 a[6:7], v46 offset:2176
ds_read_b64_tr_b16 a[8:9], v46 offset:4096
ds_read_b64_tr_b16 a[10:11], v46 offset:4224
ds_read_b64_tr_b16 a[12:13], v46 offset:6144
ds_read_b64_tr_b16 a[14:15], v46 offset:6272
s_waitcnt lgkmcnt(0)
ds_read_b64_tr_b16 a[16:17], v46 offset:8192
ds_read_b64_tr_b16 a[18:19], v46 offset:8320
ds_read_b64_tr_b16 a[20:21], v46 offset:10240
ds_read_b64_tr_b16 a[22:23], v46 offset:10368
ds_read_b64_tr_b16 a[24:25], v46 offset:12288
ds_read_b64_tr_b16 a[26:27], v46 offset:12416
ds_read_b64_tr_b16 a[28:29], v46 offset:14336
ds_read_b64_tr_b16 a[30:31], v46 offset:14464
s_waitcnt lgkmcnt(0)
ds_read_b64_tr_b16 a[32:33], v46 offset:32
ds_read_b64_tr_b16 a[34:35], v46 offset:160
ds_read_b64_tr_b16 a[36:37], v46 offset:2080
ds_read_b64_tr_b16 a[38:39], v46 offset:2208
ds_read_b64_tr_b16 a[40:41], v46 offset:4128
ds_read_b64_tr_b16 a[42:43], v46 offset:4256
ds_read_b64_tr_b16 a[44:45], v46 offset:6176
ds_read_b64_tr_b16 a[46:47], v46 offset:6304
s_waitcnt lgkmcnt(0)
ds_read_b64_tr_b16 a[48:49], v46 offset:8224
ds_read_b64_tr_b16 a[50:51], v46 offset:8352
ds_read_b64_tr_b16 a[52:53], v46 offset:10272
ds_read_b64_tr_b16 a[54:55], v46 offset:10400
ds_read_b64_tr_b16 a[56:57], v46 offset:12320
ds_read_b64_tr_b16 a[58:59], v46 offset:12448
ds_read_b64_tr_b16 a[60:61], v46 offset:14368
ds_read_b64_tr_b16 a[62:63], v46 offset:14496
s_waitcnt lgkmcnt(0)
v_and_b32 v247, 15, v0
v_lshlrev_b32 v247, 4, v247
buffer_load_dword v246, v247, s[72:75], 0 offen sc1
s_waitcnt vmcnt(0)
ds_read_b64_tr_b16 a[192:193], v47 offset:16384
ds_read_b64_tr_b16 a[194:195], v47 offset:16512
ds_read_b64_tr_b16 a[196:197], v47 offset:18432
ds_read_b64_tr_b16 a[198:199], v47 offset:18560
ds_read_b64_tr_b16 a[200:201], v47 offset:20480
ds_read_b64_tr_b16 a[202:203], v47 offset:20608
ds_read_b64_tr_b16 a[204:205], v47 offset:22528
ds_read_b64_tr_b16 a[206:207], v47 offset:22656
s_waitcnt lgkmcnt(0)
ds_read_b64_tr_b16 a[208:209], v47 offset:24576
ds_read_b64_tr_b16 a[210:211], v47 offset:24704
ds_read_b64_tr_b16 a[212:213], v47 offset:26624
ds_read_b64_tr_b16 a[214:215], v47 offset:26752
ds_read_b64_tr_b16 a[216:217], v47 offset:28672
ds_read_b64_tr_b16 a[218:219], v47 offset:28800
ds_read_b64_tr_b16 a[220:221], v47 offset:30720
ds_read_b64_tr_b16 a[222:223], v47 offset:30848
s_waitcnt lgkmcnt(0)
ds_read_b64_tr_b16 a[224:225], v47 offset:16416
ds_read_b64_tr_b16 a[226:227], v47 offset:16544
ds_read_b64_tr_b16 a[228:229], v47 offset:18464
ds_read_b64_tr_b16 a[230:231], v47 offset:18592
ds_read_b64_tr_b16 a[232:233], v47 offset:20512
ds_read_b64_tr_b16 a[234:235], v47 offset:20640
ds_read_b64_tr_b16 a[236:237], v47 offset:22560
ds_read_b64_tr_b16 a[238:239], v47 offset:22688
s_waitcnt lgkmcnt(0)
ds_read_b64_tr_b16 a[240:241], v47 offset:24608
ds_read_b64_tr_b16 a[242:243], v47 offset:24736
ds_read_b64_tr_b16 a[244:245], v47 offset:26656
ds_read_b64_tr_b16 a[246:247], v47 offset:26784
ds_read_b64_tr_b16 a[248:249], v47 offset:28704
ds_read_b64_tr_b16 a[250:251], v47 offset:28832
ds_read_b64_tr_b16 a[252:253], v47 offset:30752
ds_read_b64_tr_b16 a[254:255], v47 offset:30880
s_waitcnt lgkmcnt(0)
v_and_b32 v247, 15, v0
v_lshlrev_b32 v247, 4, v247
s_branch mega_kernel_sysp
mega_kernel_sysw:
s_sleep 4
mega_kernel_sys:
buffer_load_dword v246, v247, s[72:75], 0 offen sc1
s_waitcnt vmcnt(0)
mega_kernel_sysp:
s_cmp_eq_u32 s95, 1
s_cbranch_scc0 mega_kernel_sysf
v_readlane_b32 s76, v246, 14
s_mov_b32 s98, 0
s_cmp_eq_u32 s76, 32
s_cbranch_scc0 mega_kernel_sysw
s_branch mega_kernel_sysd
mega_kernel_sysf:
s_mov_b32 s77, 0
s_mov_b32 s78, 0
v_readlane_b32 s76, v246, 0
s_add_u32 s77, s77, s76
s_xor_b32 s76, s76, 32
s_or_b32 s78, s78, s76
v_readlane_b32 s76, v246, 1
s_add_u32 s77, s77, s76
s_xor_b32 s76, s76, 32
s_or_b32 s78, s78, s76
v_readlane_b32 s76, v246, 2
s_add_u32 s77, s77, s76
s_xor_b32 s76, s76, 32
s_or_b32 s78, s78, s76
v_readlane_b32 s76, v246, 3
s_add_u32 s77, s77, s76
s_xor_b32 s76, s76, 32
s_or_b32 s78, s78, s76
v_readlane_b32 s76, v246, 4
s_add_u32 s77, s77, s76
s_xor_b32 s76, s76, 32
s_or_b32 s78, s78, s76
v_readlane_b32 s76, v246, 5
s_add_u32 s77, s77, s76
s_xor_b32 s76, s76, 32
s_or_b32 s78, s78, s76
v_readlane_b32 s76, v246, 6
s_add_u32 s77, s77, s76
s_xor_b32 s76, s76, 32
s_or_b32 s78, s78, s76
v_readlane_b32 s76, v246, 7
s_add_u32 s77, s77, s76
s_xor_b32 s76, s76, 32
s_or_b32 s78, s78, s76
s_cmp_eq_u32 s77, 256
s_cbranch_scc0 mega_kernel_sysw
v_mov_b32 v252, v246
s_cmp_eq_u32 s78, 0
s_cbranch_scc0 mega_kernel_slowent
v_readlane_b32 s76, v246, 10
v_readlane_b32 s77, v246, 8
s_cmp_eq_u32 s76, 32
s_cbranch_scc0 mega_kernel_sysw
s_cmp_gt_u32 s77, 16
s_cselect_b32 s98, 1, 0
mega_kernel_sysd:
s_lshr_b32 s28, s31, 4
s_lshl_b32 s28, s28, 14
s_lshl_b32 s29, s98, 13
s_add_u32 s28, s28, s29
s_and_b32 s29, s31, 15
s_lshl_b32 s29, s29, 9
s_add_u32 s28, s28, s29
s_lshl_b32 s29, s30, 16
s_add_u32 s28, s28, s29
s_add_u32 s28, s28, 67108864
v_lshrrev_b32 v12, 1, v17
v_add_u32 v12, s28, v12
v_xor_b32 v25, 0x10000, v12
v_xor_b32 v26, 0x20000, v12
v_xor_b32 v27, 0x30000, v12
v_add_u32 v25, 0, v25
v_add_u32 v26, 0, v26
v_add_u32 v27, 0, v27
s_lshl_b32 s28, s25, 2
s_add_u32 s28, s28, s26
s_mov_b32 s82, s28
s_lshr_b32 s29, s28, 3
s_xor_b32 s29, s29, s98
s_and_b32 s29, s29, 1
s_lshl_b32 s29, s29, 13
s_lshl_b32 s76, s28, 18
s_add_u32 s76, s76, s29
s_mov_b32 s83, s76
v_add_u32 v240, s76, v17
v_add_u32 v241, 33554432, v240
s_lshr_b32 s29, s28, 4
s_xor_b32 s29, s29, s98
s_and_b32 s29, s29, 1
s_lshl_b32 s29, s29, 13
s_lshl_b32 s79, s28, 17
s_add_u32 s79, s79, s29
s_add_u32 s79, s79, 71303168
s_xor_b32 s29, s98, 1
s_lshl_b32 s29, s29, 13
s_lshl_b32 s28, s25, 7
s_add_u32 s28, s28, s29
s_add_u32 s28, s28, 69206016
v_and_b32 v4, 1, v1
v_lshlrev_b32 v24, 12, v4
v_add_u32 v24, s28, v24
s_lshl_b32 s29, s26, 2
v_add_u32 v24, s29, v24
s_xor_b32 s81, s98, 1
s_lshl_b32 s81, s81, 13
s_lshr_b32 s29, s82, 6
s_lshl_b32 s29, s29, 14
s_add_u32 s81, s81, s29
s_and_b32 s29, s82, 63
s_lshl_b32 s29, s29, 7
s_add_u32 s81, s81, s29
s_add_u32 s81, s81, 69222400
v_mov_b32 v220, 0x3f803f80
v_mov_b32 v221, 0x3f803f80
v_mov_b32 v222, 0x3f803f80
v_mov_b32 v223, 0x3f803f80
v_mov_b32 v228, 0
s_mov_b32 s27, 0
s_mov_b32 s46, 0
s_mov_b32 s89, 0
s_mov_b32 s88, 0
s_mov_b32 s44, 18432
s_mov_b32 s45, 18432
s_cmp_eq_u32 s24, 3
s_cbranch_scc0 mega_kernel_rs_pfi
s_mov_b32 s76, 0
s_cmp_gt_i32 s46, s76
s_cbranch_scc1 mega_kernel_rs_pf0ok
mega_kernel_rs_pf0w:
v_mov_b32 v4, 0
s_mov_b64 exec, 3
buffer_atomic_add v4, v24, s[84:87], 0 offen sc0 sc1
s_mov_b64 exec, -1
s_waitcnt vmcnt(0)
v_readlane_b32 s46, v4, 0
v_readlane_b32 s28, v4, 1
s_nop 1
s_min_i32 s46, s46, s28
s_cmp_gt_i32 s46, s76
s_cbranch_scc0 mega_kernel_rs_pf0w
mega_kernel_rs_pf0ok:
s_add_u32 s77, s76, s82
s_bfe_u32 s28, s77, 0x40002
s_lshl_b32 s28, s28, 14
s_and_b32 s77, s77, 3
s_lshl_b32 s77, s77, 11
s_add_u32 s28, s28, s77
s_add_u32 m0, s45, 0
s_nop 0
buffer_load_dwordx4 v240, s[84:87], s28 offen offset:0 sc1 lds
s_add_u32 m0, s45, 0
s_nop 0
buffer_load_dwordx4 v240, s[84:87], s28 offen offset:1024 sc1 lds
s_add_u32 m0, s45, 2048
s_nop 0
buffer_load_dwordx4 v241, s[84:87], s28 offen offset:0 sc1 lds
s_add_u32 m0, s45, 2048
s_nop 0
buffer_load_dwordx4 v241, s[84:87], s28 offen offset:1024 sc1 lds
s_add_u32 s45, s45, 4096
s_cmp_eq_u32 s45, 30720
s_cselect_b32 s45, 18432, s45
s_waitcnt vmcnt(0) lgkmcnt(0)
mega_kernel_rs_pfi:
v_mov_b32 v184, 0
v_mov_b32 v185, 0
v_mov_b32 v186, 0
v_mov_b32 v187, 0
v_mov_b32 v188, 0
v_mov_b32 v189, 0
v_mov_b32 v190, 0
v_mov_b32 v191, 0
v_mov_b32 v192, 0
v_mov_b32 v193, 0
v_mov_b32 v194, 0
v_mov_b32 v195, 0
v_mov_b32 v196, 0
v_mov_b32 v197, 0
v_mov_b32 v198, 0
v_mov_b32 v199, 0
v_mov_b32 v200, 0
v_mov_b32 v201, 0
v_mov_b32 v202, 0
v_mov_b32 v203, 0
v_mov_b32 v204, 0
v_mov_b32 v205, 0
v_mov_b32 v206, 0
v_mov_b32 v207, 0
v_mov_b32 v249, 0
v_mov_b32 v96, 0
v_mov_b32 v97, 0
v_mov_b32 v98, 0
v_mov_b32 v99, 0
v_mov_b32 v100, 0
v_mov_b32 v101, 0
v_mov_b32 v102, 0
v_mov_b32 v103, 0
v_mov_b32 v104, 0
v_mov_b32 v105, 0
v_mov_b32 v106, 0
v_mov_b32 v107, 0
v_mov_b32 v108, 0
v_mov_b32 v109, 0
v_mov_b32 v110, 0
v_mov_b32 v111, 0
v_mov_b32 v112, 0
v_mov_b32 v113, 0
v_mov_b32 v114, 0
v_mov_b32 v115, 0
v_mov_b32 v116, 0
v_mov_b32 v117, 0
v_mov_b32 v118, 0
v_mov_b32 v119, 0
s_barrier
s_and_b32 s29, s27, 1
s_lshl_b32 s33, s29, 17
s_lshl_b32 s28, s30, 18
s_add_u32 s33, s33, s28
s_add_u32 s33, s33, 68157440
s_xor_b32 s34, s33, 131072
s_lshl_b32 s35, s29, 18
s_bfe_u32 s47, s27, 0x10001
s_branch mega_kernel_rs_first
.p2align 6
s_nop 0
s_nop 0
mega_kernel_rs_loop:
buffer_load_dwordx4 v[32:35], v7, s[84:87], s33 offen offset:0 sc1
v_add_u32 v5, s44, v17
ds_read_b128 v[156:159], v5 offset:0
ds_read_b128 v[160:163], v5 offset:1024
ds_read_b128 v[164:167], v5 offset:2048
ds_read_b128 v[168:171], v5 offset:3072
s_nop 4
buffer_load_dwordx4 v[36:39], v7, s[84:87], s33 offen offset:1024 sc1
s_nop 9
buffer_load_dwordx4 v[40:43], v7, s[84:87], s33 offen offset:2048 sc1
s_nop 9
buffer_load_dwordx4 v[44:47], v7, s[84:87], s33 offen offset:3072 sc1
s_waitcnt vmcnt(3)
v_max_u32 v4, v32, v34
v_cmp_eq_u32 vcc, -1, v4
s_cbranch_vccnz mega_kernel_rs_pa_15_0f
v_smfmac_f32_16x16x64_bf16 v[96:99], v[32:35], a[0:7], v6
v_smfmac_f32_16x16x64_bf16 v[100:103], v[32:35], a[32:39], v6
v_smfmac_f32_16x16x64_bf16 v[104:107], v[32:35], a[64:71], v6
s_waitcnt vmcnt(2)
v_max_u32 v4, v36, v38
v_cmp_eq_u32 vcc, -1, v4
v_smfmac_f32_16x16x64_bf16 v[108:111], v[32:35], a[96:103], v6
s_cbranch_vccnz mega_kernel_rs_pa_14_1f
v_smfmac_f32_16x16x64_bf16 v[96:99], v[36:39], a[8:15], v6
v_smfmac_f32_16x16x64_bf16 v[100:103], v[36:39], a[40:47], v6
v_smfmac_f32_16x16x64_bf16 v[104:107], v[36:39], a[72:79], v6
s_waitcnt vmcnt(1)
v_max_u32 v4, v40, v42
v_cmp_eq_u32 vcc, -1, v4
v_smfmac_f32_16x16x64_bf16 v[108:111], v[36:39], a[104:111], v6
s_cbranch_vccnz mega_kernel_rs_pa_12_2f
v_smfmac_f32_16x16x64_bf16 v[96:99], v[40:43], a[16:23], v6
v_smfmac_f32_16x16x64_bf16 v[100:103], v[40:43], a[48:55], v6
v_smfmac_f32_16x16x64_bf16 v[104:107], v[40:43], a[80:87], v6
s_waitcnt vmcnt(0)
v_max_u32 v4, v44, v46
v_cmp_eq_u32 vcc, -1, v4
v_smfmac_f32_16x16x64_bf16 v[108:111], v[40:43], a[112:119], v6
s_cbranch_vccnz mega_kernel_rs_pa_8_3f
v_smfmac_f32_16x16x64_bf16 v[96:99], v[44:47], a[24:31], v6
v_smfmac_f32_16x16x64_bf16 v[100:103], v[44:47], a[56:63], v6
v_smfmac_f32_16x16x64_bf16 v[104:107], v[44:47], a[88:95], v6
v_smfmac_f32_16x16x64_bf16 v[108:111], v[44:47], a[120:127], v6
mega_kernel_rs_pa_d:
mega_kernel_rs_adone:
s_nop 5
v_permlane32_swap_b32 v96, v100
v_permlane32_swap_b32 v97, v101
v_permlane32_swap_b32 v98, v102
v_permlane32_swap_b32 v99, v103
v_pk_add_f32 v[96:97], v[96:97], v[100:101]
v_pk_add_f32 v[98:99], v[98:99], v[102:103]
ds_write2_b32 v14, v96, v97 offset0:0 offset1:36
ds_write2_b32 v14, v98, v99 offset0:72 offset1:108
v_permlane32_swap_b32 v104, v108
v_permlane32_swap_b32 v105, v109
v_permlane32_swap_b32 v106, v110
v_permlane32_swap_b32 v107, v111
v_pk_add_f32 v[104:105], v[104:105], v[108:109]
v_pk_add_f32 v[106:107], v[106:107], v[110:111]
ds_write2_b32 v15, v104, v105 offset0:0 offset1:36
ds_write2_b32 v15, v106, v107 offset0:72 offset1:108
v_smfmac_f32_16x16x64_bf16 v[112:115], v[32:35], a[128:135], v6
v_smfmac_f32_16x16x64_bf16 v[116:119], v[32:35], a[160:167], v6
v_smfmac_f32_16x16x64_bf16 v[112:115], v[36:39], a[136:143], v6
v_smfmac_f32_16x16x64_bf16 v[116:119], v[36:39], a[168:175], v6
s_waitcnt lgkmcnt(0)
s_barrier
s_cmp_lg_u32 s24, 0
s_cbranch_scc1 mega_kernel_rs_side
ds_read_b128 v[120:123], v16 offset:0
ds_read_b128 v[124:127], v16 offset:16
ds_read_b128 v[128:131], v16 offset:2304
ds_read_b128 v[132:135], v16 offset:2320
ds_read_b128 v[136:139], v16 offset:4608
ds_read_b128 v[140:143], v16 offset:4624
ds_read_b128 v[144:147], v16 offset:6912
ds_read_b128 v[148:151], v16 offset:6928
v_smfmac_f32_16x16x64_bf16 v[112:115], v[40:43], a[144:151], v6
v_smfmac_f32_16x16x64_bf16 v[116:119], v[40:43], a[176:183], v6
v_smfmac_f32_16x16x64_bf16 v[112:115], v[44:47], a[152:159], v6
v_smfmac_f32_16x16x64_bf16 v[116:119], v[44:47], a[184:191], v6
s_mul_i32 s28, s31, 2048
s_add_u32 s28, s28, s33
s_add_u32 s28, s28, 49152
s_add_u32 s76, s37, s33
s_add_u32 s77, s38, s33
s_add_u32 s78, s39, s33
s_waitcnt lgkmcnt(4)
v_pk_add_f32 v[120:121], v[120:121], v[128:129]
v_pk_add_f32 v[122:123], v[122:123], v[130:131]
v_pk_add_f32 v[124:125], v[124:125], v[132:133]
v_pk_add_f32 v[126:127], v[126:127], v[134:135]
s_waitcnt lgkmcnt(0)
v_pk_add_f32 v[136:137], v[136:137], v[144:145]
v_pk_add_f32 v[138:139], v[138:139], v[146:147]
v_pk_add_f32 v[140:141], v[140:141], v[148:149]
v_pk_add_f32 v[142:143], v[142:143], v[150:151]
v_pk_add_f32 v[120:121], v[120:121], v[136:137]
v_pk_add_f32 v[122:123], v[122:123], v[138:139]
v_pk_add_f32 v[124:125], v[124:125], v[140:141]
v_pk_add_f32 v[126:127], v[126:127], v[142:143]
v_cvt_pk_bf16_f32 v152, v120, v121
v_cvt_pk_bf16_f32 v153, v122, v123
v_cvt_pk_bf16_f32 v154, v124, v125
v_cvt_pk_bf16_f32 v155, v126, v127
s_nop 1
v_mfma_f32_16x16x32_bf16 v[176:179], v[160:163], v[152:155], 0
v_mfma_f32_16x16x32_bf16 v[172:175], v[156:159], v[152:155], 0
v_mfma_f32_16x16x32_bf16 v[180:183], v[152:155], v[152:155], 0
s_cmp_eq_u32 s27, 63
s_cbranch_scc1 mega_kernel_rs_w0last
s_nop 4
v_mov_b32_dpp v172, v176 row_shr:8 row_mask:0xf bank_mask:0xc
v_mov_b32_dpp v173, v177 row_shr:8 row_mask:0xf bank_mask:0xc
v_mov_b32_dpp v174, v178 row_shr:8 row_mask:0xf bank_mask:0xc
v_mov_b32_dpp v175, v179 row_shr:8 row_mask:0xf bank_mask:0xc
v_min_u32 v180, -2, v180
v_min_u32 v172, -2, v172
s_mov_b64 exec, s[42:43]
buffer_store_dwordx4 v[180:183], v10, s[84:87], s28 offen sc1
s_mov_b64 exec, -1
buffer_store_dwordx4 v[172:175], v17, s[84:87], s28 offen sc1
v_permlane32_swap_b32 v112, v116
v_permlane32_swap_b32 v113, v117
v_permlane32_swap_b32 v114, v118
v_permlane32_swap_b32 v115, v119
v_pk_add_f32 v[112:113], v[112:113], v[116:117]
v_pk_add_f32 v[114:115], v[114:115], v[118:119]
ds_write_b128 v20, v[112:115]
s_waitcnt lgkmcnt(0)
s_barrier
v_mov_b32 v96, 0
v_mov_b32 v97, 0
v_mov_b32 v98, 0
v_mov_b32 v99, 0
v_mov_b32 v100, 0
v_mov_b32 v101, 0
v_mov_b32 v102, 0
v_mov_b32 v103, 0
v_cndmask_b32 v176, v23, v180, s[42:43]
v_cndmask_b32 v177, v23, v181, s[42:43]
v_cndmask_b32 v178, v23, v182, s[42:43]
v_cndmask_b32 v179, v23, v183, s[42:43]
s_mov_b64 exec, s[42:43]
buffer_load_dwordx4 v[188:191], v10, s[84:87], s76 offen sc1
buffer_load_dwordx4 v[196:199], v10, s[84:87], s77 offen sc1
buffer_load_dwordx4 v[204:207], v10, s[84:87], s78 offen sc1
s_mov_b64 exec, -1
buffer_load_dwordx4 v[184:187], v17, s[84:87], s76 offen sc1
buffer_load_dwordx4 v[192:195], v17, s[84:87], s77 offen sc1
buffer_load_dwordx4 v[200:203], v17, s[84:87], s78 offen sc1
v_pk_mul_f32 v[172:173], v[172:173], s[32:33] op_sel_hi:[1,0]
v_pk_mul_f32 v[174:175], v[174:175], s[32:33] op_sel_hi:[1,0]
v_pk_mul_f32 v[176:177], v[176:177], s[32:33] op_sel_hi:[1,0]
v_pk_mul_f32 v[178:179], v[178:179], s[32:33] op_sel_hi:[1,0]
s_lshl_b32 s89, s47, 31
s_or_b32 s89, s89, 0x3b39999a
s_nop 15
s_nop 1
s_mov_b64 exec, s[42:43]
buffer_load_dwordx4 v[188:191], v10, s[84:87], s76 offen sc1
buffer_load_dwordx4 v[196:199], v10, s[84:87], s77 offen sc1
buffer_load_dwordx4 v[204:207], v10, s[84:87], s78 offen sc1
s_mov_b64 exec, -1
buffer_load_dwordx4 v[184:187], v17, s[84:87], s76 offen sc1
buffer_load_dwordx4 v[192:195], v17, s[84:87], s77 offen sc1
buffer_load_dwordx4 v[200:203], v17, s[84:87], s78 offen sc1
mega_kernel_rs_p2:
s_waitcnt vmcnt(6)
v_max3_u32 v4, v184, v188, v192
v_max3_u32 v5, v196, v200, v204
v_max_u32 v4, v4, v5
v_cmp_eq_u32 vcc, -1, v4
s_cbranch_vccnz mega_kernel_rs_p2r
v_pk_add_f32 v[124:125], v[196:197], v[204:205]
v_pk_add_f32 v[126:127], v[198:199], v[206:207]
v_pk_add_f32 v[120:121], v[192:193], v[200:201]
v_pk_add_f32 v[122:123], v[194:195], v[202:203]
v_pk_add_f32 v[124:125], v[124:125], v[188:189]
v_pk_add_f32 v[126:127], v[126:127], v[190:191]
v_pk_add_f32 v[120:121], v[120:121], v[184:185]
v_pk_add_f32 v[122:123], v[122:123], v[186:187]
v_pk_fma_f32 v[176:177], v[124:125], s[32:33], v[176:177] op_sel_hi:[1,0,1]
v_pk_fma_f32 v[178:179], v[126:127], s[32:33], v[178:179] op_sel_hi:[1,0,1]
v_pk_fma_f32 v[172:173], v[120:121], s[32:33], v[172:173] op_sel_hi:[1,0,1]
v_pk_fma_f32 v[174:175], v[122:123], s[32:33], v[174:175] op_sel_hi:[1,0,1]
v_max3_f32 v232, v172, v173, v174
v_max3_f32 v233, v176, v177, v178
v_max3_f32 v232, v232, v175, v179
v_max_f32 v234, v232, v233
s_barrier
ds_read2_b64 v[208:211], v21 offset0:0 offset1:32
v_max_f32_dpp v232, v234, v234 row_ror:8 row_mask:0xf bank_mask:0xf
v_max_f32_dpp v233, v234, v234 row_ror:8 row_mask:0xf bank_mask:0xf
s_nop 1
v_permlane16_swap_b32 v232, v233
s_nop 0
v_max_f32 v234, v232, v233
v_max_f32 v235, v232, v233
s_nop 1
v_permlane32_swap_b32 v234, v235
s_nop 0
v_max_f32 v232, v234, v235
v_pk_add_f32 v[176:177], v[176:177], v[232:233] op_sel_hi:[1,0] neg_lo:[0,1] neg_hi:[0,1]
v_pk_add_f32 v[178:179], v[178:179], v[232:233] op_sel_hi:[1,0] neg_lo:[0,1] neg_hi:[0,1]
v_pk_add_f32 v[172:173], v[172:173], v[232:233] op_sel_hi:[1,0] neg_lo:[0,1] neg_hi:[0,1]
v_pk_add_f32 v[174:175], v[174:175], v[232:233] op_sel_hi:[1,0] neg_lo:[0,1] neg_hi:[0,1]
v_exp_f32 v176, v176
v_exp_f32 v177, v177
v_exp_f32 v178, v178
v_exp_f32 v179, v179
v_exp_f32 v172, v172
v_cvt_pk_bf16_f32 v216, v176, v177
v_cvt_pk_bf16_f32 v217, v178, v179
v_exp_f32 v173, v173
v_exp_f32 v174, v174
v_mfma_f32_16x16x16_bf16 v[224:227], v[220:221], v[216:217], 0
v_exp_f32 v175, v175
v_cvt_pk_bf16_f32 v212, v172, v173
s_waitcnt lgkmcnt(0)
v_mfma_f32_16x16x16_bf16 v[120:123], v[208:209], v[216:217], 0
v_cvt_pk_bf16_f32 v213, v174, v175
v_mfma_f32_16x16x16_bf16 v[124:127], v[210:211], v[216:217], 0
v_mov_b32_dpp v214, v212 row_ror:8 row_mask:0xf bank_mask:0xf
v_mov_b32_dpp v215, v213 row_ror:8 row_mask:0xf bank_mask:0xf
s_nop 1
v_mfma_f32_16x16x32_bf16 v[224:227], v[220:223], v[212:215], v[224:227]
v_mfma_f32_16x16x32_bf16 v[120:123], v[164:167], v[212:215], v[120:123]
v_mfma_f32_16x16x32_bf16 v[124:127], v[168:171], v[212:215], v[124:127]
s_add_u32 s29, s33, 24576
s_nop 4
v_rcp_f32 v234, v224
s_nop 0
v_pk_mul_f32 v[120:121], v[120:121], v[234:235] op_sel_hi:[1,0]
v_pk_mul_f32 v[122:123], v[122:123], v[234:235] op_sel_hi:[1,0]
v_pk_mul_f32 v[124:125], v[124:125], v[234:235] op_sel_hi:[1,0]
v_pk_mul_f32 v[126:127], v[126:127], v[234:235] op_sel_hi:[1,0]
v_cvt_pk_bf16_f32 v212, v120, v121
v_cvt_pk_bf16_f32 v213, v122, v123
v_cvt_pk_bf16_f32 v214, v124, v125
v_cvt_pk_bf16_f32 v215, v126, v127
v_min_u32 v212, -2, v212
s_mov_b64 exec, s[40:41]
buffer_store_dwordx4 v[212:215], v11, s[84:87], s33 offen sc1
s_mov_b64 exec, -1
mega_kernel_rs_b3:
s_barrier
s_nop 15
buffer_load_dwordx4 v[32:35], v7, s[84:87], s29 offen offset:0 sc1
s_nop 9
buffer_load_dwordx4 v[36:39], v7, s[84:87], s29 offen offset:1024 sc1
s_nop 9
buffer_load_dwordx4 v[40:43], v7, s[84:87], s29 offen offset:2048 sc1
s_nop 9
buffer_load_dwordx4 v[44:47], v7, s[84:87], s29 offen offset:3072 sc1
mega_kernel_rs_pc_15_0:
s_waitcnt vmcnt(3)
v_cmp_eq_u32 vcc, -1, v32
s_cbranch_vccnz mega_kernel_rs_pc_15_0f
v_smfmac_f32_16x16x64_bf16 v[96:99], v[32:35], a[192:199], v6
v_smfmac_f32_16x16x64_bf16 v[100:103], v[32:35], a[224:231], v6
mega_kernel_rs_pc_14_1:
s_waitcnt vmcnt(2)
v_cmp_eq_u32 vcc, -1, v36
s_cbranch_vccnz mega_kernel_rs_pc_14_1f
v_smfmac_f32_16x16x64_bf16 v[96:99], v[36:39], a[200:207], v6
v_smfmac_f32_16x16x64_bf16 v[100:103], v[36:39], a[232:239], v6
mega_kernel_rs_pc_12_2:
s_waitcnt vmcnt(1)
v_cmp_eq_u32 vcc, -1, v40
s_cbranch_vccnz mega_kernel_rs_pc_12_2f
v_smfmac_f32_16x16x64_bf16 v[96:99], v[40:43], a[208:215], v6
v_smfmac_f32_16x16x64_bf16 v[100:103], v[40:43], a[240:247], v6
mega_kernel_rs_pc_8_3:
s_waitcnt vmcnt(0)
v_cmp_eq_u32 vcc, -1, v44
s_cbranch_vccnz mega_kernel_rs_pc_8_3f
v_smfmac_f32_16x16x64_bf16 v[96:99], v[44:47], a[216:223], v6
v_smfmac_f32_16x16x64_bf16 v[100:103], v[44:47], a[248:255], v6
mega_kernel_rs_pc_d:
s_nop 7
v_permlane32_swap_b32 v96, v100
v_permlane32_swap_b32 v97, v101
v_permlane32_swap_b32 v98, v102
v_permlane32_swap_b32 v99, v103
v_pk_add_f32 v[96:97], v[96:97], v[100:101]
v_pk_add_f32 v[98:99], v[98:99], v[102:103]
ds_write2_b32 v18, v96, v97 offset0:0 offset1:36
ds_write2_b32 v18, v98, v99 offset0:72 offset1:108
s_waitcnt lgkmcnt(0)
s_barrier
s_cmp_lg_u32 s24, 0
s_cbranch_scc1 mega_kernel_rs_x1
ds_read_b128 v[120:123], v19 offset:0
ds_read_b128 v[124:127], v19 offset:1152
ds_read_b128 v[128:131], v19 offset:2304
ds_read_b128 v[132:135], v19 offset:3456
s_waitcnt lgkmcnt(2)
v_pk_add_f32 v[120:121], v[120:121], v[124:125]
v_pk_add_f32 v[122:123], v[122:123], v[126:127]
s_waitcnt lgkmcnt(0)
v_pk_add_f32 v[128:129], v[128:129], v[132:133]
v_pk_add_f32 v[130:131], v[130:131], v[134:135]
v_pk_add_f32 v[120:121], v[120:121], v[128:129]
v_pk_add_f32 v[122:123], v[122:123], v[130:131]
v_fma_f32 v212, v120, s89, v120
v_cvt_pk_bf16_f32 v213, v122, v123
v_cvt_pk_bf16_f32 v212, v212, v121
v_and_or_b32 v212, v212, -2, s47
buffer_store_dwordx2 v[212:213], v12, s[84:87], s35 offen sc1
s_mov_b32 s77, 0x3f80
s_mov_b32 s78, 0x3f800000
s_xor_b32 s76, s47, 1
v_mov_b32 v48, s76
v_mov_b32 v50, s76
v_mov_b32 v52, s76
s_nop 8
v_mov_b32 v96, 0
v_mov_b32 v97, 0
v_mov_b32 v98, 0
v_mov_b32 v99, 0
v_mov_b32 v100, 0
v_mov_b32 v101, 0
v_mov_b32 v102, 0
v_mov_b32 v103, 0
v_mov_b32 v104, 0
v_mov_b32 v105, 0
v_mov_b32 v106, 0
v_mov_b32 v107, 0
v_mov_b32 v108, 0
v_mov_b32 v109, 0
v_mov_b32 v110, 0
v_mov_b32 v111, 0
v_mov_b32 v112, 0
v_mov_b32 v113, 0
v_mov_b32 v114, 0
v_mov_b32 v115, 0
v_mov_b32 v116, 0
v_mov_b32 v117, 0
v_mov_b32 v118, 0
v_mov_b32 v119, 0
s_nop 15
s_nop 7
s_cmp_eq_u32 s47, 1
s_cbranch_scc1 mega_kernel_rs_p4_1
.p2align 6
mega_kernel_rs_p4_0:
buffer_load_dwordx2 v[48:49], v25, s[84:87], s35 offen sc1
buffer_load_dwordx2 v[50:51], v26, s[84:87], s35 offen sc1
buffer_load_dwordx2 v[52:53], v27, s[84:87], s35 offen sc1
s_waitcnt vmcnt(12)
mega_kernel_rs_p4c_0:
v_bitop3_b32 v4, v48, v50, v52 bitop3:0xfe
v_and_b32 v4, 1, v4
v_cmp_ne_u32 vcc, 0, v4
s_cbranch_vccnz mega_kernel_rs_p4_0
v_dot2_f32_bf16 v120, v48, s77, v120
v_dot2_f32_bf16 v121, v48, s78, v121
v_dot2_f32_bf16 v122, v49, s77, v122
v_dot2_f32_bf16 v123, v49, s78, v123
v_dot2_f32_bf16 v120, v50, s77, v120
v_dot2_f32_bf16 v121, v50, s78, v121
v_dot2_f32_bf16 v122, v51, s77, v122
v_dot2_f32_bf16 v123, v51, s78, v123
v_dot2_f32_bf16 v120, v52, s77, v120
v_dot2_f32_bf16 v121, v52, s78, v121
v_dot2_f32_bf16 v122, v53, s77, v122
v_dot2_f32_bf16 v123, v53, s78, v123
s_nop 0
v_cvt_pk_bf16_f32 v212, v120, v121
v_min_u32 v212, -2, v212
v_cvt_pk_bf16_f32 v213, v122, v123
buffer_store_dwordx2 v[212:213], v9, s[84:87], s34 offen sc1
s_branch mega_kernel_rs_p4d
.p2align 6
mega_kernel_rs_p4_1:
buffer_load_dwordx2 v[48:49], v25, s[84:87], s35 offen sc1
buffer_load_dwordx2 v[50:51], v26, s[84:87], s35 offen sc1
buffer_load_dwordx2 v[52:53], v27, s[84:87], s35 offen sc1
s_waitcnt vmcnt(12)
mega_kernel_rs_p4c_1:
v_bitop3_b32 v4, v48, v50, v52 bitop3:0x80
v_and_b32 v4, 1, v4
v_cmp_ne_u32 vcc, 1, v4
s_cbranch_vccnz mega_kernel_rs_p4_1
v_dot2_f32_bf16 v120, v48, s77, v120
v_dot2_f32_bf16 v121, v48, s78, v121
v_dot2_f32_bf16 v122, v49, s77, v122
v_dot2_f32_bf16 v123, v49, s78, v123
v_dot2_f32_bf16 v120, v50, s77, v120
v_dot2_f32_bf16 v121, v50, s78, v121
v_dot2_f32_bf16 v122, v51, s77, v122
v_dot2_f32_bf16 v123, v51, s78, v123
v_dot2_f32_bf16 v120, v52, s77, v120
v_dot2_f32_bf16 v121, v52, s78, v121
v_dot2_f32_bf16 v122, v53, s77, v122
v_dot2_f32_bf16 v123, v53, s78, v123
s_nop 0
v_cvt_pk_bf16_f32 v212, v120, v121
v_min_u32 v212, -2, v212
v_cvt_pk_bf16_f32 v213, v122, v123
buffer_store_dwordx2 v[212:213], v9, s[84:87], s34 offen sc1
mega_kernel_rs_p4d:
mega_kernel_rs_b5:
s_add_u32 s27, s27, 1
s_add_u32 s44, s44, 4096
s_cmp_eq_u32 s44, 30720
s_cselect_b32 s44, 18432, s44
s_mov_b32 s28, s33
s_mov_b32 s33, s34
s_mov_b32 s34, s28
s_xor_b32 s35, s35, 262144
s_bfe_u32 s47, s27, 0x10001
s_barrier
s_nop 15
s_branch mega_kernel_rs_loop
mega_kernel_rs_x1:
s_cmp_eq_u32 s24, 1
s_cbranch_scc0 mega_kernel_rs_x2
s_add_u32 s76, s27, 1
v_mov_b32 v5, s76
s_mov_b64 exec, 1
buffer_store_dword v5, v228, s[84:87], s81 offen sc1
s_mov_b64 exec, -1
mega_kernel_rs_x2:
s_cmp_eq_u32 s24, 3
s_cbranch_scc0 mega_kernel_rs_x4
s_cmp_eq_u32 s36, 1
s_cbranch_scc0 mega_kernel_rs_x5
s_add_u32 s76, s27, 1
s_cmp_gt_i32 s46, s76
s_cbranch_scc1 mega_kernel_rs_pf1ok
mega_kernel_rs_pf1w:
v_mov_b32 v4, 0
s_mov_b64 exec, 3
buffer_atomic_add v4, v24, s[84:87], 0 offen sc0 sc1
s_mov_b64 exec, -1
s_waitcnt vmcnt(0)
v_readlane_b32 s46, v4, 0
v_readlane_b32 s28, v4, 1
s_nop 1
s_min_i32 s46, s46, s28
s_cmp_gt_i32 s46, s76
s_cbranch_scc0 mega_kernel_rs_pf1w
mega_kernel_rs_pf1ok:
s_add_u32 s77, s76, s82
s_bfe_u32 s28, s77, 0x40002
s_lshl_b32 s28, s28, 14
s_and_b32 s77, s77, 3
s_lshl_b32 s77, s77, 11
s_add_u32 s28, s28, s77
s_add_u32 m0, s45, 0
s_nop 0
buffer_load_dwordx4 v240, s[84:87], s28 offen offset:0 sc1 lds
s_add_u32 m0, s45, 0
s_nop 0
buffer_load_dwordx4 v240, s[84:87], s28 offen offset:1024 sc1 lds
s_add_u32 m0, s45, 2048
s_nop 0
buffer_load_dwordx4 v241, s[84:87], s28 offen offset:0 sc1 lds
s_add_u32 m0, s45, 2048
s_nop 0
buffer_load_dwordx4 v241, s[84:87], s28 offen offset:1024 sc1 lds
s_add_u32 s45, s45, 4096
s_cmp_eq_u32 s45, 30720
s_cselect_b32 s45, 18432, s45
s_waitcnt vmcnt(0)
mega_kernel_rs_x5:
s_add_u32 s76, s27, 4
s_min_u32 s76, s76, 63
s_cmp_gt_i32 s46, s76
s_cbranch_scc1 mega_kernel_rs_x6
v_mov_b32 v249, 0
s_mov_b64 exec, 3
buffer_atomic_add v249, v24, s[84:87], 0 offen sc0 sc1
s_mov_b64 exec, -1
mega_kernel_rs_x6:
s_add_u32 s76, s27, 2
s_cmp_lt_u32 s76, 63
s_cbranch_scc0 mega_kernel_rs_x4
s_cmp_gt_i32 s46, s76
s_cbranch_scc0 mega_kernel_rs_x4
s_add_u32 s77, s76, s82
s_bfe_u32 s28, s77, 0x40002
s_lshl_b32 s28, s28, 14
s_and_b32 s77, s77, 3
s_lshl_b32 s77, s77, 11
s_add_u32 s28, s28, s77
s_add_u32 s28, s28, s83
s_add_u32 s28, s28, 33554432
s_buffer_load_dword s78, s[84:87], s28 offset:0
s_buffer_load_dword s78, s[84:87], s28 offset:128
s_buffer_load_dword s78, s[84:87], s28 offset:256
s_buffer_load_dword s78, s[84:87], s28 offset:384
s_buffer_load_dword s78, s[84:87], s28 offset:512
s_buffer_load_dword s78, s[84:87], s28 offset:640
s_buffer_load_dword s78, s[84:87], s28 offset:768
s_buffer_load_dword s78, s[84:87], s28 offset:896
s_buffer_load_dword s78, s[84:87], s28 offset:1024
s_buffer_load_dword s78, s[84:87], s28 offset:1152
s_buffer_load_dword s78, s[84:87], s28 offset:1280
s_buffer_load_dword s78, s[84:87], s28 offset:1408
s_buffer_load_dword s78, s[84:87], s28 offset:1536
s_buffer_load_dword s78, s[84:87], s28 offset:1664
s_buffer_load_dword s78, s[84:87], s28 offset:1792
s_buffer_load_dword s78, s[84:87], s28 offset:1920
s_mov_b32 s89, s76
mega_kernel_rs_x4:
v_mov_b32 v96, 0
v_mov_b32 v97, 0
v_mov_b32 v98, 0
v_mov_b32 v99, 0
v_mov_b32 v100, 0
v_mov_b32 v101, 0
v_mov_b32 v102, 0
v_mov_b32 v103, 0
v_mov_b32 v104, 0
v_mov_b32 v105, 0
v_mov_b32 v106, 0
v_mov_b32 v107, 0
v_mov_b32 v108, 0
v_mov_b32 v109, 0
v_mov_b32 v110, 0
v_mov_b32 v111, 0
v_mov_b32 v112, 0
v_mov_b32 v113, 0
v_mov_b32 v114, 0
v_mov_b32 v115, 0
v_mov_b32 v116, 0
v_mov_b32 v117, 0
v_mov_b32 v118, 0
v_mov_b32 v119, 0
s_branch mega_kernel_rs_b5
mega_kernel_rs_p2r:
s_mov_b64 exec, s[42:43]
buffer_load_dwordx4 v[188:191], v10, s[84:87], s76 offen sc1
buffer_load_dwordx4 v[196:199], v10, s[84:87], s77 offen sc1
buffer_load_dwordx4 v[204:207], v10, s[84:87], s78 offen sc1
s_mov_b64 exec, -1
buffer_load_dwordx4 v[184:187], v17, s[84:87], s76 offen sc1
buffer_load_dwordx4 v[192:195], v17, s[84:87], s77 offen sc1
buffer_load_dwordx4 v[200:203], v17, s[84:87], s78 offen sc1
s_branch mega_kernel_rs_p2
.p2align 5
mega_kernel_rs_pa_1_0f:
s_mov_b64 exec, vcc
buffer_load_dwordx4 v[32:35], v7, s[84:87], s33 offen offset:0 sc1
s_mov_b64 exec, -1
s_branch mega_kernel_rs_pa_1_0
.p2align 5
mega_kernel_rs_pa_1_0:
s_waitcnt vmcnt(0)
v_max_u32 v4, v32, v34
v_cmp_eq_u32 vcc, -1, v4
s_cbranch_vccnz mega_kernel_rs_pa_1_0f
v_smfmac_f32_16x16x64_bf16 v[96:99], v[32:35], a[0:7], v6
v_smfmac_f32_16x16x64_bf16 v[100:103], v[32:35], a[32:39], v6
v_smfmac_f32_16x16x64_bf16 v[104:107], v[32:35], a[64:71], v6
v_smfmac_f32_16x16x64_bf16 v[108:111], v[32:35], a[96:103], v6
s_branch mega_kernel_rs_pa_d
.p2align 5
mega_kernel_rs_pa_2_1f:
s_mov_b64 exec, vcc
buffer_load_dwordx4 v[36:39], v7, s[84:87], s33 offen offset:1024 sc1
s_mov_b64 exec, -1
s_branch mega_kernel_rs_pa_2_1
.p2align 5
mega_kernel_rs_pa_2_1:
s_waitcnt vmcnt(0)
v_max_u32 v4, v36, v38
v_cmp_eq_u32 vcc, -1, v4
s_cbranch_vccnz mega_kernel_rs_pa_2_1f
v_smfmac_f32_16x16x64_bf16 v[96:99], v[36:39], a[8:15], v6
v_smfmac_f32_16x16x64_bf16 v[100:103], v[36:39], a[40:47], v6
v_smfmac_f32_16x16x64_bf16 v[104:107], v[36:39], a[72:79], v6
v_smfmac_f32_16x16x64_bf16 v[108:111], v[36:39], a[104:111], v6
s_branch mega_kernel_rs_pa_d
.p2align 5
mega_kernel_rs_pa_3_0f:
s_mov_b64 exec, vcc
buffer_load_dwordx4 v[32:35], v7, s[84:87], s33 offen offset:0 sc1
s_mov_b64 exec, -1
s_branch mega_kernel_rs_pa_3_1
.p2align 5
mega_kernel_rs_pa_3_0:
s_waitcnt vmcnt(1)
v_max_u32 v4, v32, v34
v_cmp_eq_u32 vcc, -1, v4
s_cbranch_vccnz mega_kernel_rs_pa_3_0f
v_smfmac_f32_16x16x64_bf16 v[96:99], v[32:35], a[0:7], v6
v_smfmac_f32_16x16x64_bf16 v[100:103], v[32:35], a[32:39], v6
v_smfmac_f32_16x16x64_bf16 v[104:107], v[32:35], a[64:71], v6
v_smfmac_f32_16x16x64_bf16 v[108:111], v[32:35], a[96:103], v6
s_branch mega_kernel_rs_pa_2_1
.p2align 5
mega_kernel_rs_pa_3_1f:
s_mov_b64 exec, vcc
buffer_load_dwordx4 v[36:39], v7, s[84:87], s33 offen offset:1024 sc1
s_mov_b64 exec, -1
s_branch mega_kernel_rs_pa_3_0
.p2align 5
mega_kernel_rs_pa_3_1:
s_waitcnt vmcnt(1)
v_max_u32 v4, v36, v38
v_cmp_eq_u32 vcc, -1, v4
s_cbranch_vccnz mega_kernel_rs_pa_3_1f
v_smfmac_f32_16x16x64_bf16 v[96:99], v[36:39], a[8:15], v6
v_smfmac_f32_16x16x64_bf16 v[100:103], v[36:39], a[40:47], v6
v_smfmac_f32_16x16x64_bf16 v[104:107], v[36:39], a[72:79], v6
v_smfmac_f32_16x16x64_bf16 v[108:111], v[36:39], a[104:111], v6
s_branch mega_kernel_rs_pa_1_0
.p2align 5
mega_kernel_rs_pa_4_2f:
s_mov_b64 exec, vcc
buffer_load_dwordx4 v[40:43], v7, s[84:87], s33 offen offset:2048 sc1
s_mov_b64 exec, -1
s_branch mega_kernel_rs_pa_4_2
.p2align 5
mega_kernel_rs_pa_4_2:
s_waitcnt vmcnt(0)
v_max_u32 v4, v40, v42
v_cmp_eq_u32 vcc, -1, v4
s_cbranch_vccnz mega_kernel_rs_pa_4_2f
v_smfmac_f32_16x16x64_bf16 v[96:99], v[40:43], a[16:23], v6
v_smfmac_f32_16x16x64_bf16 v[100:103], v[40:43], a[48:55], v6
v_smfmac_f32_16x16x64_bf16 v[104:107], v[40:43], a[80:87], v6
v_smfmac_f32_16x16x64_bf16 v[108:111], v[40:43], a[112:119], v6
s_branch mega_kernel_rs_pa_d
.p2align 5
mega_kernel_rs_pa_5_0f:
s_mov_b64 exec, vcc
buffer_load_dwordx4 v[32:35], v7, s[84:87], s33 offen offset:0 sc1
s_mov_b64 exec, -1
s_branch mega_kernel_rs_pa_5_2
.p2align 5
mega_kernel_rs_pa_5_0:
s_waitcnt vmcnt(1)
v_max_u32 v4, v32, v34
v_cmp_eq_u32 vcc, -1, v4
s_cbranch_vccnz mega_kernel_rs_pa_5_0f
v_smfmac_f32_16x16x64_bf16 v[96:99], v[32:35], a[0:7], v6
v_smfmac_f32_16x16x64_bf16 v[100:103], v[32:35], a[32:39], v6
v_smfmac_f32_16x16x64_bf16 v[104:107], v[32:35], a[64:71], v6
v_smfmac_f32_16x16x64_bf16 v[108:111], v[32:35], a[96:103], v6
s_branch mega_kernel_rs_pa_4_2
.p2align 5
mega_kernel_rs_pa_5_2f:
s_mov_b64 exec, vcc
buffer_load_dwordx4 v[40:43], v7, s[84:87], s33 offen offset:2048 sc1
s_mov_b64 exec, -1
s_branch mega_kernel_rs_pa_5_0
.p2align 5
mega_kernel_rs_pa_5_2:
s_waitcnt vmcnt(1)
v_max_u32 v4, v40, v42
v_cmp_eq_u32 vcc, -1, v4
s_cbranch_vccnz mega_kernel_rs_pa_5_2f
v_smfmac_f32_16x16x64_bf16 v[96:99], v[40:43], a[16:23], v6
v_smfmac_f32_16x16x64_bf16 v[100:103], v[40:43], a[48:55], v6
v_smfmac_f32_16x16x64_bf16 v[104:107], v[40:43], a[80:87], v6
v_smfmac_f32_16x16x64_bf16 v[108:111], v[40:43], a[112:119], v6
s_branch mega_kernel_rs_pa_1_0
.p2align 5
mega_kernel_rs_pa_6_1f:
s_mov_b64 exec, vcc
buffer_load_dwordx4 v[36:39], v7, s[84:87], s33 offen offset:1024 sc1
s_mov_b64 exec, -1
s_branch mega_kernel_rs_pa_6_2
.p2align 5
mega_kernel_rs_pa_6_1:
s_waitcnt vmcnt(1)
v_max_u32 v4, v36, v38
v_cmp_eq_u32 vcc, -1, v4
s_cbranch_vccnz mega_kernel_rs_pa_6_1f
v_smfmac_f32_16x16x64_bf16 v[96:99], v[36:39], a[8:15], v6
v_smfmac_f32_16x16x64_bf16 v[100:103], v[36:39], a[40:47], v6
v_smfmac_f32_16x16x64_bf16 v[104:107], v[36:39], a[72:79], v6
v_smfmac_f32_16x16x64_bf16 v[108:111], v[36:39], a[104:111], v6
s_branch mega_kernel_rs_pa_4_2
.p2align 5
mega_kernel_rs_pa_6_2f:
s_mov_b64 exec, vcc
buffer_load_dwordx4 v[40:43], v7, s[84:87], s33 offen offset:2048 sc1
s_mov_b64 exec, -1
s_branch mega_kernel_rs_pa_6_1
.p2align 5
mega_kernel_rs_pa_6_2:
s_waitcnt vmcnt(1)
v_max_u32 v4, v40, v42
v_cmp_eq_u32 vcc, -1, v4
s_cbranch_vccnz mega_kernel_rs_pa_6_2f
v_smfmac_f32_16x16x64_bf16 v[96:99], v[40:43], a[16:23], v6
v_smfmac_f32_16x16x64_bf16 v[100:103], v[40:43], a[48:55], v6
v_smfmac_f32_16x16x64_bf16 v[104:107], v[40:43], a[80:87], v6
v_smfmac_f32_16x16x64_bf16 v[108:111], v[40:43], a[112:119], v6
s_branch mega_kernel_rs_pa_2_1
.p2align 5
mega_kernel_rs_pa_7_0f:
s_mov_b64 exec, vcc
buffer_load_dwordx4 v[32:35], v7, s[84:87], s33 offen offset:0 sc1
s_mov_b64 exec, -1
s_branch mega_kernel_rs_pa_7_1
.p2align 5
mega_kernel_rs_pa_7_0:
s_waitcnt vmcnt(2)
v_max_u32 v4, v32, v34
v_cmp_eq_u32 vcc, -1, v4
s_cbranch_vccnz mega_kernel_rs_pa_7_0f
v_smfmac_f32_16x16x64_bf16 v[96:99], v[32:35], a[0:7], v6
v_smfmac_f32_16x16x64_bf16 v[100:103], v[32:35], a[32:39], v6
v_smfmac_f32_16x16x64_bf16 v[104:107], v[32:35], a[64:71], v6
v_smfmac_f32_16x16x64_bf16 v[108:111], v[32:35], a[96:103], v6
s_branch mega_kernel_rs_pa_6_1
.p2align 5
mega_kernel_rs_pa_7_1f:
s_mov_b64 exec, vcc
buffer_load_dwordx4 v[36:39], v7, s[84:87], s33 offen offset:1024 sc1
s_mov_b64 exec, -1
s_branch mega_kernel_rs_pa_7_2
.p2align 5
mega_kernel_rs_pa_7_1:
s_waitcnt vmcnt(2)
v_max_u32 v4, v36, v38
v_cmp_eq_u32 vcc, -1, v4
s_cbranch_vccnz mega_kernel_rs_pa_7_1f
v_smfmac_f32_16x16x64_bf16 v[96:99], v[36:39], a[8:15], v6
v_smfmac_f32_16x16x64_bf16 v[100:103], v[36:39], a[40:47], v6
v_smfmac_f32_16x16x64_bf16 v[104:107], v[36:39], a[72:79], v6
v_smfmac_f32_16x16x64_bf16 v[108:111], v[36:39], a[104:111], v6
s_branch mega_kernel_rs_pa_5_2
.p2align 5
mega_kernel_rs_pa_7_2f:
s_mov_b64 exec, vcc
buffer_load_dwordx4 v[40:43], v7, s[84:87], s33 offen offset:2048 sc1
s_mov_b64 exec, -1
s_branch mega_kernel_rs_pa_7_0
.p2align 5
mega_kernel_rs_pa_7_2:
s_waitcnt vmcnt(2)
v_max_u32 v4, v40, v42
v_cmp_eq_u32 vcc, -1, v4
s_cbranch_vccnz mega_kernel_rs_pa_7_2f
v_smfmac_f32_16x16x64_bf16 v[96:99], v[40:43], a[16:23], v6
v_smfmac_f32_16x16x64_bf16 v[100:103], v[40:43], a[48:55], v6
v_smfmac_f32_16x16x64_bf16 v[104:107], v[40:43], a[80:87], v6
v_smfmac_f32_16x16x64_bf16 v[108:111], v[40:43], a[112:119], v6
s_branch mega_kernel_rs_pa_3_0
.p2align 5
mega_kernel_rs_pa_8_3f:
s_mov_b64 exec, vcc
buffer_load_dwordx4 v[44:47], v7, s[84:87], s33 offen offset:3072 sc1
s_mov_b64 exec, -1
s_branch mega_kernel_rs_pa_8_3
.p2align 5
mega_kernel_rs_pa_8_3:
s_waitcnt vmcnt(0)
v_max_u32 v4, v44, v46
v_cmp_eq_u32 vcc, -1, v4
s_cbranch_vccnz mega_kernel_rs_pa_8_3f
v_smfmac_f32_16x16x64_bf16 v[96:99], v[44:47], a[24:31], v6
v_smfmac_f32_16x16x64_bf16 v[100:103], v[44:47], a[56:63], v6
v_smfmac_f32_16x16x64_bf16 v[104:107], v[44:47], a[88:95], v6
v_smfmac_f32_16x16x64_bf16 v[108:111], v[44:47], a[120:127], v6
s_branch mega_kernel_rs_pa_d
.p2align 5
mega_kernel_rs_pa_9_0f:
s_mov_b64 exec, vcc
buffer_load_dwordx4 v[32:35], v7, s[84:87], s33 offen offset:0 sc1
s_mov_b64 exec, -1
s_branch mega_kernel_rs_pa_9_3
.p2align 5
mega_kernel_rs_pa_9_0:
s_waitcnt vmcnt(1)
v_max_u32 v4, v32, v34
v_cmp_eq_u32 vcc, -1, v4
s_cbranch_vccnz mega_kernel_rs_pa_9_0f
v_smfmac_f32_16x16x64_bf16 v[96:99], v[32:35], a[0:7], v6
v_smfmac_f32_16x16x64_bf16 v[100:103], v[32:35], a[32:39], v6
v_smfmac_f32_16x16x64_bf16 v[104:107], v[32:35], a[64:71], v6
v_smfmac_f32_16x16x64_bf16 v[108:111], v[32:35], a[96:103], v6
s_branch mega_kernel_rs_pa_8_3
.p2align 5
mega_kernel_rs_pa_9_3f:
s_mov_b64 exec, vcc
buffer_load_dwordx4 v[44:47], v7, s[84:87], s33 offen offset:3072 sc1
s_mov_b64 exec, -1
s_branch mega_kernel_rs_pa_9_0
.p2align 5
mega_kernel_rs_pa_9_3:
s_waitcnt vmcnt(1)
v_max_u32 v4, v44, v46
v_cmp_eq_u32 vcc, -1, v4
s_cbranch_vccnz mega_kernel_rs_pa_9_3f
v_smfmac_f32_16x16x64_bf16 v[96:99], v[44:47], a[24:31], v6
v_smfmac_f32_16x16x64_bf16 v[100:103], v[44:47], a[56:63], v6
v_smfmac_f32_16x16x64_bf16 v[104:107], v[44:47], a[88:95], v6
v_smfmac_f32_16x16x64_bf16 v[108:111], v[44:47], a[120:127], v6
s_branch mega_kernel_rs_pa_1_0
.p2align 5
mega_kernel_rs_pa_10_1f:
s_mov_b64 exec, vcc
buffer_load_dwordx4 v[36:39], v7, s[84:87], s33 offen offset:1024 sc1
s_mov_b64 exec, -1
s_branch mega_kernel_rs_pa_10_3
.p2align 5
mega_kernel_rs_pa_10_1:
s_waitcnt vmcnt(1)
v_max_u32 v4, v36, v38
v_cmp_eq_u32 vcc, -1, v4
s_cbranch_vccnz mega_kernel_rs_pa_10_1f
v_smfmac_f32_16x16x64_bf16 v[96:99], v[36:39], a[8:15], v6
v_smfmac_f32_16x16x64_bf16 v[100:103], v[36:39], a[40:47], v6
v_smfmac_f32_16x16x64_bf16 v[104:107], v[36:39], a[72:79], v6
v_smfmac_f32_16x16x64_bf16 v[108:111], v[36:39], a[104:111], v6
s_branch mega_kernel_rs_pa_8_3
.p2align 5
mega_kernel_rs_pa_10_3f:
s_mov_b64 exec, vcc
buffer_load_dwordx4 v[44:47], v7, s[84:87], s33 offen offset:3072 sc1
s_mov_b64 exec, -1
s_branch mega_kernel_rs_pa_10_1
.p2align 5
mega_kernel_rs_pa_10_3:
s_waitcnt vmcnt(1)
v_max_u32 v4, v44, v46
v_cmp_eq_u32 vcc, -1, v4
s_cbranch_vccnz mega_kernel_rs_pa_10_3f
v_smfmac_f32_16x16x64_bf16 v[96:99], v[44:47], a[24:31], v6
v_smfmac_f32_16x16x64_bf16 v[100:103], v[44:47], a[56:63], v6
v_smfmac_f32_16x16x64_bf16 v[104:107], v[44:47], a[88:95], v6
v_smfmac_f32_16x16x64_bf16 v[108:111], v[44:47], a[120:127], v6
s_branch mega_kernel_rs_pa_2_1
.p2align 5
mega_kernel_rs_pa_11_0f:
s_mov_b64 exec, vcc
buffer_load_dwordx4 v[32:35], v7, s[84:87], s33 offen offset:0 sc1
s_mov_b64 exec, -1
s_branch mega_kernel_rs_pa_11_1
.p2align 5
mega_kernel_rs_pa_11_0:
s_waitcnt vmcnt(2)
v_max_u32 v4, v32, v34
v_cmp_eq_u32 vcc, -1, v4
s_cbranch_vccnz mega_kernel_rs_pa_11_0f
v_smfmac_f32_16x16x64_bf16 v[96:99], v[32:35], a[0:7], v6
v_smfmac_f32_16x16x64_bf16 v[100:103], v[32:35], a[32:39], v6
v_smfmac_f32_16x16x64_bf16 v[104:107], v[32:35], a[64:71], v6
v_smfmac_f32_16x16x64_bf16 v[108:111], v[32:35], a[96:103], v6
s_branch mega_kernel_rs_pa_10_1
.p2align 5
mega_kernel_rs_pa_11_1f:
s_mov_b64 exec, vcc
buffer_load_dwordx4 v[36:39], v7, s[84:87], s33 offen offset:1024 sc1
s_mov_b64 exec, -1
s_branch mega_kernel_rs_pa_11_3
.p2align 5
mega_kernel_rs_pa_11_1:
s_waitcnt vmcnt(2)
v_max_u32 v4, v36, v38
v_cmp_eq_u32 vcc, -1, v4
s_cbranch_vccnz mega_kernel_rs_pa_11_1f
v_smfmac_f32_16x16x64_bf16 v[96:99], v[36:39], a[8:15], v6
v_smfmac_f32_16x16x64_bf16 v[100:103], v[36:39], a[40:47], v6
v_smfmac_f32_16x16x64_bf16 v[104:107], v[36:39], a[72:79], v6
v_smfmac_f32_16x16x64_bf16 v[108:111], v[36:39], a[104:111], v6
s_branch mega_kernel_rs_pa_9_3
.p2align 5
mega_kernel_rs_pa_11_3f:
s_mov_b64 exec, vcc
buffer_load_dwordx4 v[44:47], v7, s[84:87], s33 offen offset:3072 sc1
s_mov_b64 exec, -1
s_branch mega_kernel_rs_pa_11_0
.p2align 5
mega_kernel_rs_pa_11_3:
s_waitcnt vmcnt(2)
v_max_u32 v4, v44, v46
v_cmp_eq_u32 vcc, -1, v4
s_cbranch_vccnz mega_kernel_rs_pa_11_3f
v_smfmac_f32_16x16x64_bf16 v[96:99], v[44:47], a[24:31], v6
v_smfmac_f32_16x16x64_bf16 v[100:103], v[44:47], a[56:63], v6
v_smfmac_f32_16x16x64_bf16 v[104:107], v[44:47], a[88:95], v6
v_smfmac_f32_16x16x64_bf16 v[108:111], v[44:47], a[120:127], v6
s_branch mega_kernel_rs_pa_3_0
.p2align 5
mega_kernel_rs_pa_12_2f:
s_mov_b64 exec, vcc
buffer_load_dwordx4 v[40:43], v7, s[84:87], s33 offen offset:2048 sc1
s_mov_b64 exec, -1
s_branch mega_kernel_rs_pa_12_3
.p2align 5
mega_kernel_rs_pa_12_2:
s_waitcnt vmcnt(1)
v_max_u32 v4, v40, v42
v_cmp_eq_u32 vcc, -1, v4
s_cbranch_vccnz mega_kernel_rs_pa_12_2f
v_smfmac_f32_16x16x64_bf16 v[96:99], v[40:43], a[16:23], v6
v_smfmac_f32_16x16x64_bf16 v[100:103], v[40:43], a[48:55], v6
v_smfmac_f32_16x16x64_bf16 v[104:107], v[40:43], a[80:87], v6
v_smfmac_f32_16x16x64_bf16 v[108:111], v[40:43], a[112:119], v6
s_branch mega_kernel_rs_pa_8_3
.p2align 5
mega_kernel_rs_pa_12_3f:
s_mov_b64 exec, vcc
buffer_load_dwordx4 v[44:47], v7, s[84:87], s33 offen offset:3072 sc1
s_mov_b64 exec, -1
s_branch mega_kernel_rs_pa_12_2
.p2align 5
mega_kernel_rs_pa_12_3:
s_waitcnt vmcnt(1)
v_max_u32 v4, v44, v46
v_cmp_eq_u32 vcc, -1, v4
s_cbranch_vccnz mega_kernel_rs_pa_12_3f
v_smfmac_f32_16x16x64_bf16 v[96:99], v[44:47], a[24:31], v6
v_smfmac_f32_16x16x64_bf16 v[100:103], v[44:47], a[56:63], v6
v_smfmac_f32_16x16x64_bf16 v[104:107], v[44:47], a[88:95], v6
v_smfmac_f32_16x16x64_bf16 v[108:111], v[44:47], a[120:127], v6
s_branch mega_kernel_rs_pa_4_2
.p2align 5
mega_kernel_rs_pa_13_0f:
s_mov_b64 exec, vcc
buffer_load_dwordx4 v[32:35], v7, s[84:87], s33 offen offset:0 sc1
s_mov_b64 exec, -1
s_branch mega_kernel_rs_pa_13_2
.p2align 5
mega_kernel_rs_pa_13_0:
s_waitcnt vmcnt(2)
v_max_u32 v4, v32, v34
v_cmp_eq_u32 vcc, -1, v4
s_cbranch_vccnz mega_kernel_rs_pa_13_0f
v_smfmac_f32_16x16x64_bf16 v[96:99], v[32:35], a[0:7], v6
v_smfmac_f32_16x16x64_bf16 v[100:103], v[32:35], a[32:39], v6
v_smfmac_f32_16x16x64_bf16 v[104:107], v[32:35], a[64:71], v6
v_smfmac_f32_16x16x64_bf16 v[108:111], v[32:35], a[96:103], v6
s_branch mega_kernel_rs_pa_12_2
.p2align 5
mega_kernel_rs_pa_13_2f:
s_mov_b64 exec, vcc
buffer_load_dwordx4 v[40:43], v7, s[84:87], s33 offen offset:2048 sc1
s_mov_b64 exec, -1
s_branch mega_kernel_rs_pa_13_3
.p2align 5
mega_kernel_rs_pa_13_2:
s_waitcnt vmcnt(2)
v_max_u32 v4, v40, v42
v_cmp_eq_u32 vcc, -1, v4
s_cbranch_vccnz mega_kernel_rs_pa_13_2f
v_smfmac_f32_16x16x64_bf16 v[96:99], v[40:43], a[16:23], v6
v_smfmac_f32_16x16x64_bf16 v[100:103], v[40:43], a[48:55], v6
v_smfmac_f32_16x16x64_bf16 v[104:107], v[40:43], a[80:87], v6
v_smfmac_f32_16x16x64_bf16 v[108:111], v[40:43], a[112:119], v6
s_branch mega_kernel_rs_pa_9_3
.p2align 5
mega_kernel_rs_pa_13_3f:
s_mov_b64 exec, vcc
buffer_load_dwordx4 v[44:47], v7, s[84:87], s33 offen offset:3072 sc1
s_mov_b64 exec, -1
s_branch mega_kernel_rs_pa_13_0
.p2align 5
mega_kernel_rs_pa_13_3:
s_waitcnt vmcnt(2)
v_max_u32 v4, v44, v46
v_cmp_eq_u32 vcc, -1, v4
s_cbranch_vccnz mega_kernel_rs_pa_13_3f
v_smfmac_f32_16x16x64_bf16 v[96:99], v[44:47], a[24:31], v6
v_smfmac_f32_16x16x64_bf16 v[100:103], v[44:47], a[56:63], v6
v_smfmac_f32_16x16x64_bf16 v[104:107], v[44:47], a[88:95], v6
v_smfmac_f32_16x16x64_bf16 v[108:111], v[44:47], a[120:127], v6
s_branch mega_kernel_rs_pa_5_0
.p2align 5
mega_kernel_rs_pa_14_1f:
s_mov_b64 exec, vcc
buffer_load_dwordx4 v[36:39], v7, s[84:87], s33 offen offset:1024 sc1
s_mov_b64 exec, -1
s_branch mega_kernel_rs_pa_14_2
.p2align 5
mega_kernel_rs_pa_14_1:
s_waitcnt vmcnt(2)
v_max_u32 v4, v36, v38
v_cmp_eq_u32 vcc, -1, v4
s_cbranch_vccnz mega_kernel_rs_pa_14_1f
v_smfmac_f32_16x16x64_bf16 v[96:99], v[36:39], a[8:15], v6
v_smfmac_f32_16x16x64_bf16 v[100:103], v[36:39], a[40:47], v6
v_smfmac_f32_16x16x64_bf16 v[104:107], v[36:39], a[72:79], v6
v_smfmac_f32_16x16x64_bf16 v[108:111], v[36:39], a[104:111], v6
s_branch mega_kernel_rs_pa_12_2
.p2align 5
mega_kernel_rs_pa_14_2f:
s_mov_b64 exec, vcc
buffer_load_dwordx4 v[40:43], v7, s[84:87], s33 offen offset:2048 sc1
s_mov_b64 exec, -1
s_branch mega_kernel_rs_pa_14_3
.p2align 5
mega_kernel_rs_pa_14_2:
s_waitcnt vmcnt(2)
v_max_u32 v4, v40, v42
v_cmp_eq_u32 vcc, -1, v4
s_cbranch_vccnz mega_kernel_rs_pa_14_2f
v_smfmac_f32_16x16x64_bf16 v[96:99], v[40:43], a[16:23], v6
v_smfmac_f32_16x16x64_bf16 v[100:103], v[40:43], a[48:55], v6
v_smfmac_f32_16x16x64_bf16 v[104:107], v[40:43], a[80:87], v6
v_smfmac_f32_16x16x64_bf16 v[108:111], v[40:43], a[112:119], v6
s_branch mega_kernel_rs_pa_10_3
.p2align 5
mega_kernel_rs_pa_14_3f:
s_mov_b64 exec, vcc
buffer_load_dwordx4 v[44:47], v7, s[84:87], s33 offen offset:3072 sc1
s_mov_b64 exec, -1
s_branch mega_kernel_rs_pa_14_1
.p2align 5
mega_kernel_rs_pa_14_3:
s_waitcnt vmcnt(2)
v_max_u32 v4, v44, v46
v_cmp_eq_u32 vcc, -1, v4
s_cbranch_vccnz mega_kernel_rs_pa_14_3f
v_smfmac_f32_16x16x64_bf16 v[96:99], v[44:47], a[24:31], v6
v_smfmac_f32_16x16x64_bf16 v[100:103], v[44:47], a[56:63], v6
v_smfmac_f32_16x16x64_bf16 v[104:107], v[44:47], a[88:95], v6
v_smfmac_f32_16x16x64_bf16 v[108:111], v[44:47], a[120:127], v6
s_branch mega_kernel_rs_pa_6_1
.p2align 5
mega_kernel_rs_pa_15_0f:
s_mov_b64 exec, vcc
buffer_load_dwordx4 v[32:35], v7, s[84:87], s33 offen offset:0 sc1
s_mov_b64 exec, -1
s_branch mega_kernel_rs_pa_15_1
.p2align 5
mega_kernel_rs_pa_15_0:
s_waitcnt vmcnt(3)
v_max_u32 v4, v32, v34
v_cmp_eq_u32 vcc, -1, v4
s_cbranch_vccnz mega_kernel_rs_pa_15_0f
v_smfmac_f32_16x16x64_bf16 v[96:99], v[32:35], a[0:7], v6
v_smfmac_f32_16x16x64_bf16 v[100:103], v[32:35], a[32:39], v6
v_smfmac_f32_16x16x64_bf16 v[104:107], v[32:35], a[64:71], v6
v_smfmac_f32_16x16x64_bf16 v[108:111], v[32:35], a[96:103], v6
s_branch mega_kernel_rs_pa_14_1
.p2align 5
mega_kernel_rs_pa_15_1f:
s_mov_b64 exec, vcc
buffer_load_dwordx4 v[36:39], v7, s[84:87], s33 offen offset:1024 sc1
s_mov_b64 exec, -1
s_branch mega_kernel_rs_pa_15_2
.p2align 5
mega_kernel_rs_pa_15_1:
s_waitcnt vmcnt(3)
v_max_u32 v4, v36, v38
v_cmp_eq_u32 vcc, -1, v4
s_cbranch_vccnz mega_kernel_rs_pa_15_1f
v_smfmac_f32_16x16x64_bf16 v[96:99], v[36:39], a[8:15], v6
v_smfmac_f32_16x16x64_bf16 v[100:103], v[36:39], a[40:47], v6
v_smfmac_f32_16x16x64_bf16 v[104:107], v[36:39], a[72:79], v6
v_smfmac_f32_16x16x64_bf16 v[108:111], v[36:39], a[104:111], v6
s_branch mega_kernel_rs_pa_13_2
.p2align 5
mega_kernel_rs_pa_15_2f:
s_mov_b64 exec, vcc
buffer_load_dwordx4 v[40:43], v7, s[84:87], s33 offen offset:2048 sc1
s_mov_b64 exec, -1
s_branch mega_kernel_rs_pa_15_3
.p2align 5
mega_kernel_rs_pa_15_2:
s_waitcnt vmcnt(3)
v_max_u32 v4, v40, v42
v_cmp_eq_u32 vcc, -1, v4
s_cbranch_vccnz mega_kernel_rs_pa_15_2f
v_smfmac_f32_16x16x64_bf16 v[96:99], v[40:43], a[16:23], v6
v_smfmac_f32_16x16x64_bf16 v[100:103], v[40:43], a[48:55], v6
v_smfmac_f32_16x16x64_bf16 v[104:107], v[40:43], a[80:87], v6
v_smfmac_f32_16x16x64_bf16 v[108:111], v[40:43], a[112:119], v6
s_branch mega_kernel_rs_pa_11_3
.p2align 5
mega_kernel_rs_pa_15_3f:
s_mov_b64 exec, vcc
buffer_load_dwordx4 v[44:47], v7, s[84:87], s33 offen offset:3072 sc1
s_mov_b64 exec, -1
s_branch mega_kernel_rs_pa_15_0
.p2align 5
mega_kernel_rs_pa_15_3:
s_waitcnt vmcnt(3)
v_max_u32 v4, v44, v46
v_cmp_eq_u32 vcc, -1, v4
s_cbranch_vccnz mega_kernel_rs_pa_15_3f
v_smfmac_f32_16x16x64_bf16 v[96:99], v[44:47], a[24:31], v6
v_smfmac_f32_16x16x64_bf16 v[100:103], v[44:47], a[56:63], v6
v_smfmac_f32_16x16x64_bf16 v[104:107], v[44:47], a[88:95], v6
v_smfmac_f32_16x16x64_bf16 v[108:111], v[44:47], a[120:127], v6
s_branch mega_kernel_rs_pa_7_0
.p2align 5
mega_kernel_rs_pc_1_0f:
s_mov_b64 exec, vcc
buffer_load_dwordx4 v[32:35], v7, s[84:87], s29 offen offset:0 sc1
s_mov_b64 exec, -1
s_branch mega_kernel_rs_pc_1_0
.p2align 5
mega_kernel_rs_pc_1_0:
s_waitcnt vmcnt(0)
v_cmp_eq_u32 vcc, -1, v32
s_cbranch_vccnz mega_kernel_rs_pc_1_0f
v_smfmac_f32_16x16x64_bf16 v[96:99], v[32:35], a[192:199], v6
v_smfmac_f32_16x16x64_bf16 v[100:103], v[32:35], a[224:231], v6
s_branch mega_kernel_rs_pc_d
.p2align 5
mega_kernel_rs_pc_2_1f:
s_mov_b64 exec, vcc
buffer_load_dwordx4 v[36:39], v7, s[84:87], s29 offen offset:1024 sc1
s_mov_b64 exec, -1
s_branch mega_kernel_rs_pc_2_1
.p2align 5
mega_kernel_rs_pc_2_1:
s_waitcnt vmcnt(0)
v_cmp_eq_u32 vcc, -1, v36
s_cbranch_vccnz mega_kernel_rs_pc_2_1f
v_smfmac_f32_16x16x64_bf16 v[96:99], v[36:39], a[200:207], v6
v_smfmac_f32_16x16x64_bf16 v[100:103], v[36:39], a[232:239], v6
s_branch mega_kernel_rs_pc_d
.p2align 5
mega_kernel_rs_pc_3_0f:
s_mov_b64 exec, vcc
buffer_load_dwordx4 v[32:35], v7, s[84:87], s29 offen offset:0 sc1
s_mov_b64 exec, -1
s_branch mega_kernel_rs_pc_3_1
.p2align 5
mega_kernel_rs_pc_3_0:
s_waitcnt vmcnt(1)
v_cmp_eq_u32 vcc, -1, v32
s_cbranch_vccnz mega_kernel_rs_pc_3_0f
v_smfmac_f32_16x16x64_bf16 v[96:99], v[32:35], a[192:199], v6
v_smfmac_f32_16x16x64_bf16 v[100:103], v[32:35], a[224:231], v6
s_branch mega_kernel_rs_pc_2_1
.p2align 5
mega_kernel_rs_pc_3_1f:
s_mov_b64 exec, vcc
buffer_load_dwordx4 v[36:39], v7, s[84:87], s29 offen offset:1024 sc1
s_mov_b64 exec, -1
s_branch mega_kernel_rs_pc_3_0
.p2align 5
mega_kernel_rs_pc_3_1:
s_waitcnt vmcnt(1)
v_cmp_eq_u32 vcc, -1, v36
s_cbranch_vccnz mega_kernel_rs_pc_3_1f
v_smfmac_f32_16x16x64_bf16 v[96:99], v[36:39], a[200:207], v6
v_smfmac_f32_16x16x64_bf16 v[100:103], v[36:39], a[232:239], v6
s_branch mega_kernel_rs_pc_1_0
.p2align 5
mega_kernel_rs_pc_4_2f:
s_mov_b64 exec, vcc
buffer_load_dwordx4 v[40:43], v7, s[84:87], s29 offen offset:2048 sc1
s_mov_b64 exec, -1
s_branch mega_kernel_rs_pc_4_2
.p2align 5
mega_kernel_rs_pc_4_2:
s_waitcnt vmcnt(0)
v_cmp_eq_u32 vcc, -1, v40
s_cbranch_vccnz mega_kernel_rs_pc_4_2f
v_smfmac_f32_16x16x64_bf16 v[96:99], v[40:43], a[208:215], v6
v_smfmac_f32_16x16x64_bf16 v[100:103], v[40:43], a[240:247], v6
s_branch mega_kernel_rs_pc_d
.p2align 5
mega_kernel_rs_pc_5_0f:
s_mov_b64 exec, vcc
buffer_load_dwordx4 v[32:35], v7, s[84:87], s29 offen offset:0 sc1
s_mov_b64 exec, -1
s_branch mega_kernel_rs_pc_5_2
.p2align 5
mega_kernel_rs_pc_5_0:
s_waitcnt vmcnt(1)
v_cmp_eq_u32 vcc, -1, v32
s_cbranch_vccnz mega_kernel_rs_pc_5_0f
v_smfmac_f32_16x16x64_bf16 v[96:99], v[32:35], a[192:199], v6
v_smfmac_f32_16x16x64_bf16 v[100:103], v[32:35], a[224:231], v6
s_branch mega_kernel_rs_pc_4_2
.p2align 5
mega_kernel_rs_pc_5_2f:
s_mov_b64 exec, vcc
buffer_load_dwordx4 v[40:43], v7, s[84:87], s29 offen offset:2048 sc1
s_mov_b64 exec, -1
s_branch mega_kernel_rs_pc_5_0
.p2align 5
mega_kernel_rs_pc_5_2:
s_waitcnt vmcnt(1)
v_cmp_eq_u32 vcc, -1, v40
s_cbranch_vccnz mega_kernel_rs_pc_5_2f
v_smfmac_f32_16x16x64_bf16 v[96:99], v[40:43], a[208:215], v6
v_smfmac_f32_16x16x64_bf16 v[100:103], v[40:43], a[240:247], v6
s_branch mega_kernel_rs_pc_1_0
.p2align 5
mega_kernel_rs_pc_6_1f:
s_mov_b64 exec, vcc
buffer_load_dwordx4 v[36:39], v7, s[84:87], s29 offen offset:1024 sc1
s_mov_b64 exec, -1
s_branch mega_kernel_rs_pc_6_2
.p2align 5
mega_kernel_rs_pc_6_1:
s_waitcnt vmcnt(1)
v_cmp_eq_u32 vcc, -1, v36
s_cbranch_vccnz mega_kernel_rs_pc_6_1f
v_smfmac_f32_16x16x64_bf16 v[96:99], v[36:39], a[200:207], v6
v_smfmac_f32_16x16x64_bf16 v[100:103], v[36:39], a[232:239], v6
s_branch mega_kernel_rs_pc_4_2
.p2align 5
mega_kernel_rs_pc_6_2f:
s_mov_b64 exec, vcc
buffer_load_dwordx4 v[40:43], v7, s[84:87], s29 offen offset:2048 sc1
s_mov_b64 exec, -1
s_branch mega_kernel_rs_pc_6_1
.p2align 5
mega_kernel_rs_pc_6_2:
s_waitcnt vmcnt(1)
v_cmp_eq_u32 vcc, -1, v40
s_cbranch_vccnz mega_kernel_rs_pc_6_2f
v_smfmac_f32_16x16x64_bf16 v[96:99], v[40:43], a[208:215], v6
v_smfmac_f32_16x16x64_bf16 v[100:103], v[40:43], a[240:247], v6
s_branch mega_kernel_rs_pc_2_1
.p2align 5
mega_kernel_rs_pc_7_0f:
s_mov_b64 exec, vcc
buffer_load_dwordx4 v[32:35], v7, s[84:87], s29 offen offset:0 sc1
s_mov_b64 exec, -1
s_branch mega_kernel_rs_pc_7_1
.p2align 5
mega_kernel_rs_pc_7_0:
s_waitcnt vmcnt(2)
v_cmp_eq_u32 vcc, -1, v32
s_cbranch_vccnz mega_kernel_rs_pc_7_0f
v_smfmac_f32_16x16x64_bf16 v[96:99], v[32:35], a[192:199], v6
v_smfmac_f32_16x16x64_bf16 v[100:103], v[32:35], a[224:231], v6
s_branch mega_kernel_rs_pc_6_1
.p2align 5
mega_kernel_rs_pc_7_1f:
s_mov_b64 exec, vcc
buffer_load_dwordx4 v[36:39], v7, s[84:87], s29 offen offset:1024 sc1
s_mov_b64 exec, -1
s_branch mega_kernel_rs_pc_7_2
.p2align 5
mega_kernel_rs_pc_7_1:
s_waitcnt vmcnt(2)
v_cmp_eq_u32 vcc, -1, v36
s_cbranch_vccnz mega_kernel_rs_pc_7_1f
v_smfmac_f32_16x16x64_bf16 v[96:99], v[36:39], a[200:207], v6
v_smfmac_f32_16x16x64_bf16 v[100:103], v[36:39], a[232:239], v6
s_branch mega_kernel_rs_pc_5_2
.p2align 5
mega_kernel_rs_pc_7_2f:
s_mov_b64 exec, vcc
buffer_load_dwordx4 v[40:43], v7, s[84:87], s29 offen offset:2048 sc1
s_mov_b64 exec, -1
s_branch mega_kernel_rs_pc_7_0
.p2align 5
mega_kernel_rs_pc_7_2:
s_waitcnt vmcnt(2)
v_cmp_eq_u32 vcc, -1, v40
s_cbranch_vccnz mega_kernel_rs_pc_7_2f
v_smfmac_f32_16x16x64_bf16 v[96:99], v[40:43], a[208:215], v6
v_smfmac_f32_16x16x64_bf16 v[100:103], v[40:43], a[240:247], v6
s_branch mega_kernel_rs_pc_3_0
.p2align 5
mega_kernel_rs_pc_8_3f:
s_mov_b64 exec, vcc
buffer_load_dwordx4 v[44:47], v7, s[84:87], s29 offen offset:3072 sc1
s_mov_b64 exec, -1
s_branch mega_kernel_rs_pc_8_3
.p2align 5
mega_kernel_rs_pc_9_0f:
s_mov_b64 exec, vcc
buffer_load_dwordx4 v[32:35], v7, s[84:87], s29 offen offset:0 sc1
s_mov_b64 exec, -1
s_branch mega_kernel_rs_pc_9_3
.p2align 5
mega_kernel_rs_pc_9_0:
s_waitcnt vmcnt(1)
v_cmp_eq_u32 vcc, -1, v32
s_cbranch_vccnz mega_kernel_rs_pc_9_0f
v_smfmac_f32_16x16x64_bf16 v[96:99], v[32:35], a[192:199], v6
v_smfmac_f32_16x16x64_bf16 v[100:103], v[32:35], a[224:231], v6
s_branch mega_kernel_rs_pc_8_3
.p2align 5
mega_kernel_rs_pc_9_3f:
s_mov_b64 exec, vcc
buffer_load_dwordx4 v[44:47], v7, s[84:87], s29 offen offset:3072 sc1
s_mov_b64 exec, -1
s_branch mega_kernel_rs_pc_9_0
.p2align 5
mega_kernel_rs_pc_9_3:
s_waitcnt vmcnt(1)
v_cmp_eq_u32 vcc, -1, v44
s_cbranch_vccnz mega_kernel_rs_pc_9_3f
v_smfmac_f32_16x16x64_bf16 v[96:99], v[44:47], a[216:223], v6
v_smfmac_f32_16x16x64_bf16 v[100:103], v[44:47], a[248:255], v6
s_branch mega_kernel_rs_pc_1_0
.p2align 5
mega_kernel_rs_pc_10_1f:
s_mov_b64 exec, vcc
buffer_load_dwordx4 v[36:39], v7, s[84:87], s29 offen offset:1024 sc1
s_mov_b64 exec, -1
s_branch mega_kernel_rs_pc_10_3
.p2align 5
mega_kernel_rs_pc_10_1:
s_waitcnt vmcnt(1)
v_cmp_eq_u32 vcc, -1, v36
s_cbranch_vccnz mega_kernel_rs_pc_10_1f
v_smfmac_f32_16x16x64_bf16 v[96:99], v[36:39], a[200:207], v6
v_smfmac_f32_16x16x64_bf16 v[100:103], v[36:39], a[232:239], v6
s_branch mega_kernel_rs_pc_8_3
.p2align 5
mega_kernel_rs_pc_10_3f:
s_mov_b64 exec, vcc
buffer_load_dwordx4 v[44:47], v7, s[84:87], s29 offen offset:3072 sc1
s_mov_b64 exec, -1
s_branch mega_kernel_rs_pc_10_1
.p2align 5
mega_kernel_rs_pc_10_3:
s_waitcnt vmcnt(1)
v_cmp_eq_u32 vcc, -1, v44
s_cbranch_vccnz mega_kernel_rs_pc_10_3f
v_smfmac_f32_16x16x64_bf16 v[96:99], v[44:47], a[216:223], v6
v_smfmac_f32_16x16x64_bf16 v[100:103], v[44:47], a[248:255], v6
s_branch mega_kernel_rs_pc_2_1
.p2align 5
mega_kernel_rs_pc_11_0f:
s_mov_b64 exec, vcc
buffer_load_dwordx4 v[32:35], v7, s[84:87], s29 offen offset:0 sc1
s_mov_b64 exec, -1
s_branch mega_kernel_rs_pc_11_1
.p2align 5
mega_kernel_rs_pc_11_0:
s_waitcnt vmcnt(2)
v_cmp_eq_u32 vcc, -1, v32
s_cbranch_vccnz mega_kernel_rs_pc_11_0f
v_smfmac_f32_16x16x64_bf16 v[96:99], v[32:35], a[192:199], v6
v_smfmac_f32_16x16x64_bf16 v[100:103], v[32:35], a[224:231], v6
s_branch mega_kernel_rs_pc_10_1
.p2align 5
mega_kernel_rs_pc_11_1f:
s_mov_b64 exec, vcc
buffer_load_dwordx4 v[36:39], v7, s[84:87], s29 offen offset:1024 sc1
s_mov_b64 exec, -1
s_branch mega_kernel_rs_pc_11_3
.p2align 5
mega_kernel_rs_pc_11_1:
s_waitcnt vmcnt(2)
v_cmp_eq_u32 vcc, -1, v36
s_cbranch_vccnz mega_kernel_rs_pc_11_1f
v_smfmac_f32_16x16x64_bf16 v[96:99], v[36:39], a[200:207], v6
v_smfmac_f32_16x16x64_bf16 v[100:103], v[36:39], a[232:239], v6
s_branch mega_kernel_rs_pc_9_3
.p2align 5
mega_kernel_rs_pc_11_3f:
s_mov_b64 exec, vcc
buffer_load_dwordx4 v[44:47], v7, s[84:87], s29 offen offset:3072 sc1
s_mov_b64 exec, -1
s_branch mega_kernel_rs_pc_11_0
.p2align 5
mega_kernel_rs_pc_11_3:
s_waitcnt vmcnt(2)
v_cmp_eq_u32 vcc, -1, v44
s_cbranch_vccnz mega_kernel_rs_pc_11_3f
v_smfmac_f32_16x16x64_bf16 v[96:99], v[44:47], a[216:223], v6
v_smfmac_f32_16x16x64_bf16 v[100:103], v[44:47], a[248:255], v6
s_branch mega_kernel_rs_pc_3_0
.p2align 5
mega_kernel_rs_pc_12_2f:
s_mov_b64 exec, vcc
buffer_load_dwordx4 v[40:43], v7, s[84:87], s29 offen offset:2048 sc1
s_mov_b64 exec, -1
s_branch mega_kernel_rs_pc_12_3
.p2align 5
mega_kernel_rs_pc_12_3f:
s_mov_b64 exec, vcc
buffer_load_dwordx4 v[44:47], v7, s[84:87], s29 offen offset:3072 sc1
s_mov_b64 exec, -1
s_branch mega_kernel_rs_pc_12_2
.p2align 5
mega_kernel_rs_pc_12_3:
s_waitcnt vmcnt(1)
v_cmp_eq_u32 vcc, -1, v44
s_cbranch_vccnz mega_kernel_rs_pc_12_3f
v_smfmac_f32_16x16x64_bf16 v[96:99], v[44:47], a[216:223], v6
v_smfmac_f32_16x16x64_bf16 v[100:103], v[44:47], a[248:255], v6
s_branch mega_kernel_rs_pc_4_2
.p2align 5
mega_kernel_rs_pc_13_0f:
s_mov_b64 exec, vcc
buffer_load_dwordx4 v[32:35], v7, s[84:87], s29 offen offset:0 sc1
s_mov_b64 exec, -1
s_branch mega_kernel_rs_pc_13_2
.p2align 5
mega_kernel_rs_pc_13_0:
s_waitcnt vmcnt(2)
v_cmp_eq_u32 vcc, -1, v32
s_cbranch_vccnz mega_kernel_rs_pc_13_0f
v_smfmac_f32_16x16x64_bf16 v[96:99], v[32:35], a[192:199], v6
v_smfmac_f32_16x16x64_bf16 v[100:103], v[32:35], a[224:231], v6
s_branch mega_kernel_rs_pc_12_2
.p2align 5
mega_kernel_rs_pc_13_2f:
s_mov_b64 exec, vcc
buffer_load_dwordx4 v[40:43], v7, s[84:87], s29 offen offset:2048 sc1
s_mov_b64 exec, -1
s_branch mega_kernel_rs_pc_13_3
.p2align 5
mega_kernel_rs_pc_13_2:
s_waitcnt vmcnt(2)
v_cmp_eq_u32 vcc, -1, v40
s_cbranch_vccnz mega_kernel_rs_pc_13_2f
v_smfmac_f32_16x16x64_bf16 v[96:99], v[40:43], a[208:215], v6
v_smfmac_f32_16x16x64_bf16 v[100:103], v[40:43], a[240:247], v6
s_branch mega_kernel_rs_pc_9_3
.p2align 5
mega_kernel_rs_pc_13_3f:
s_mov_b64 exec, vcc
buffer_load_dwordx4 v[44:47], v7, s[84:87], s29 offen offset:3072 sc1
s_mov_b64 exec, -1
s_branch mega_kernel_rs_pc_13_0
.p2align 5
mega_kernel_rs_pc_13_3:
s_waitcnt vmcnt(2)
v_cmp_eq_u32 vcc, -1, v44
s_cbranch_vccnz mega_kernel_rs_pc_13_3f
v_smfmac_f32_16x16x64_bf16 v[96:99], v[44:47], a[216:223], v6
v_smfmac_f32_16x16x64_bf16 v[100:103], v[44:47], a[248:255], v6
s_branch mega_kernel_rs_pc_5_0
.p2align 5
mega_kernel_rs_pc_14_1f:
s_mov_b64 exec, vcc
buffer_load_dwordx4 v[36:39], v7, s[84:87], s29 offen offset:1024 sc1
s_mov_b64 exec, -1
s_branch mega_kernel_rs_pc_14_2
.p2align 5
mega_kernel_rs_pc_14_2f:
s_mov_b64 exec, vcc
buffer_load_dwordx4 v[40:43], v7, s[84:87], s29 offen offset:2048 sc1
s_mov_b64 exec, -1
s_branch mega_kernel_rs_pc_14_3
.p2align 5
mega_kernel_rs_pc_14_2:
s_waitcnt vmcnt(2)
v_cmp_eq_u32 vcc, -1, v40
s_cbranch_vccnz mega_kernel_rs_pc_14_2f
v_smfmac_f32_16x16x64_bf16 v[96:99], v[40:43], a[208:215], v6
v_smfmac_f32_16x16x64_bf16 v[100:103], v[40:43], a[240:247], v6
s_branch mega_kernel_rs_pc_10_3
.p2align 5
mega_kernel_rs_pc_14_3f:
s_mov_b64 exec, vcc
buffer_load_dwordx4 v[44:47], v7, s[84:87], s29 offen offset:3072 sc1
s_mov_b64 exec, -1
s_branch mega_kernel_rs_pc_14_1
.p2align 5
mega_kernel_rs_pc_14_3:
s_waitcnt vmcnt(2)
v_cmp_eq_u32 vcc, -1, v44
s_cbranch_vccnz mega_kernel_rs_pc_14_3f
v_smfmac_f32_16x16x64_bf16 v[96:99], v[44:47], a[216:223], v6
v_smfmac_f32_16x16x64_bf16 v[100:103], v[44:47], a[248:255], v6
s_branch mega_kernel_rs_pc_6_1
.p2align 5
mega_kernel_rs_pc_15_0f:
s_mov_b64 exec, vcc
buffer_load_dwordx4 v[32:35], v7, s[84:87], s29 offen offset:0 sc1
s_mov_b64 exec, -1
s_branch mega_kernel_rs_pc_15_1
.p2align 5
mega_kernel_rs_pc_15_1f:
s_mov_b64 exec, vcc
buffer_load_dwordx4 v[36:39], v7, s[84:87], s29 offen offset:1024 sc1
s_mov_b64 exec, -1
s_branch mega_kernel_rs_pc_15_2
.p2align 5
mega_kernel_rs_pc_15_1:
s_waitcnt vmcnt(3)
v_cmp_eq_u32 vcc, -1, v36
s_cbranch_vccnz mega_kernel_rs_pc_15_1f
v_smfmac_f32_16x16x64_bf16 v[96:99], v[36:39], a[200:207], v6
v_smfmac_f32_16x16x64_bf16 v[100:103], v[36:39], a[232:239], v6
s_branch mega_kernel_rs_pc_13_2
.p2align 5
mega_kernel_rs_pc_15_2f:
s_mov_b64 exec, vcc
buffer_load_dwordx4 v[40:43], v7, s[84:87], s29 offen offset:2048 sc1
s_mov_b64 exec, -1
s_branch mega_kernel_rs_pc_15_3
.p2align 5
mega_kernel_rs_pc_15_2:
s_waitcnt vmcnt(3)
v_cmp_eq_u32 vcc, -1, v40
s_cbranch_vccnz mega_kernel_rs_pc_15_2f
v_smfmac_f32_16x16x64_bf16 v[96:99], v[40:43], a[208:215], v6
v_smfmac_f32_16x16x64_bf16 v[100:103], v[40:43], a[240:247], v6
s_branch mega_kernel_rs_pc_11_3
.p2align 5
mega_kernel_rs_pc_15_3f:
s_mov_b64 exec, vcc
buffer_load_dwordx4 v[44:47], v7, s[84:87], s29 offen offset:3072 sc1
s_mov_b64 exec, -1
s_branch mega_kernel_rs_pc_15_0
.p2align 5
mega_kernel_rs_pc_15_3:
s_waitcnt vmcnt(3)
v_cmp_eq_u32 vcc, -1, v44
s_cbranch_vccnz mega_kernel_rs_pc_15_3f
v_smfmac_f32_16x16x64_bf16 v[96:99], v[44:47], a[216:223], v6
v_smfmac_f32_16x16x64_bf16 v[100:103], v[44:47], a[248:255], v6
s_branch mega_kernel_rs_pc_7_0
mega_kernel_rs_w0last:
s_nop 7
v_permlane32_swap_b32 v112, v116
v_permlane32_swap_b32 v113, v117
v_permlane32_swap_b32 v114, v118
v_permlane32_swap_b32 v115, v119
v_pk_add_f32 v[112:113], v[112:113], v[116:117]
v_pk_add_f32 v[114:115], v[114:115], v[118:119]
ds_write_b128 v20, v[112:115]
s_waitcnt lgkmcnt(0)
s_barrier
s_branch mega_kernel_rs_end
mega_kernel_rs_side:
s_cmp_eq_u32 s24, 3
s_cbranch_scc1 mega_kernel_rs_sd3
s_cmp_eq_u32 s24, 2
s_cbranch_scc0 mega_kernel_rs_sd4
s_mov_b64 exec, s[40:41]
buffer_store_dwordx4 v[28:31], v11, s[84:87], s34 offen sc1
s_mov_b64 exec, -1
buffer_store_dwordx2 v[28:29], v9, s[84:87], s34 offen sc1
s_mul_i32 s28, s31, 2048
s_add_u32 s28, s28, s34
s_add_u32 s28, s28, 49152
buffer_store_dwordx4 v[28:31], v17, s[84:87], s28 offen sc1
buffer_store_dwordx4 v[28:31], v10, s[84:87], s28 offen sc1
s_branch mega_kernel_rs_sd4
mega_kernel_rs_sd3:
v_readlane_b32 s76, v249, 0
v_readlane_b32 s77, v249, 1
s_min_i32 s76, s76, s77
s_max_i32 s46, s46, s76
s_mov_b32 s36, 0
s_add_u32 s76, s27, 1
s_cmp_lt_u32 s76, 63
s_cbranch_scc0 mega_kernel_rs_sd4
s_cmp_ge_u32 s76, 0
s_cbranch_scc0 mega_kernel_rs_sd4
s_cmp_gt_i32 s46, s76
s_cselect_b32 s36, 0, 1
s_cbranch_scc0 mega_kernel_rs_sd4
s_add_u32 s77, s76, s82
s_bfe_u32 s28, s77, 0x40002
s_lshl_b32 s28, s28, 14
s_and_b32 s77, s77, 3
s_lshl_b32 s77, s77, 11
s_add_u32 s28, s28, s77
s_add_u32 m0, s45, 0
s_nop 0
buffer_load_dwordx4 v240, s[84:87], s28 offen offset:0 sc1 lds
s_add_u32 m0, s45, 0
s_nop 0
buffer_load_dwordx4 v240, s[84:87], s28 offen offset:1024 sc1 lds
s_add_u32 m0, s45, 2048
s_nop 0
buffer_load_dwordx4 v241, s[84:87], s28 offen offset:0 sc1 lds
s_add_u32 m0, s45, 2048
s_nop 0
buffer_load_dwordx4 v241, s[84:87], s28 offen offset:1024 sc1 lds
s_add_u32 s45, s45, 4096
s_cmp_eq_u32 s45, 30720
s_cselect_b32 s45, 18432, s45
mega_kernel_rs_sd4:
v_smfmac_f32_16x16x64_bf16 v[112:115], v[40:43], a[144:151], v6
v_smfmac_f32_16x16x64_bf16 v[116:119], v[40:43], a[176:183], v6
v_smfmac_f32_16x16x64_bf16 v[112:115], v[44:47], a[152:159], v6
v_smfmac_f32_16x16x64_bf16 v[116:119], v[44:47], a[184:191], v6
s_nop 7
v_permlane32_swap_b32 v112, v116
v_permlane32_swap_b32 v113, v117
v_permlane32_swap_b32 v114, v118
v_permlane32_swap_b32 v115, v119
v_pk_add_f32 v[112:113], v[112:113], v[116:117]
v_pk_add_f32 v[114:115], v[114:115], v[118:119]
ds_write_b128 v20, v[112:115]
v_mov_b32 v96, 0
v_mov_b32 v97, 0
v_mov_b32 v98, 0
v_mov_b32 v99, 0
v_mov_b32 v100, 0
v_mov_b32 v101, 0
v_mov_b32 v102, 0
v_mov_b32 v103, 0
s_cmp_eq_u32 s24, 1
s_cbranch_scc0 mega_kernel_rs_s1
s_waitcnt lgkmcnt(0)
ds_read_b128 v[120:123], v16 offset:0
ds_read_b128 v[124:127], v16 offset:16
ds_read_b128 v[128:131], v16 offset:2304
ds_read_b128 v[132:135], v16 offset:2320
ds_read_b128 v[136:139], v16 offset:4608
ds_read_b128 v[140:143], v16 offset:4624
ds_read_b128 v[144:147], v16 offset:6912
ds_read_b128 v[148:151], v16 offset:6928
s_waitcnt lgkmcnt(4)
v_pk_add_f32 v[120:121], v[120:121], v[128:129]
v_pk_add_f32 v[122:123], v[122:123], v[130:131]
v_pk_add_f32 v[124:125], v[124:125], v[132:133]
v_pk_add_f32 v[126:127], v[126:127], v[134:135]
s_waitcnt lgkmcnt(0)
v_pk_add_f32 v[136:137], v[136:137], v[144:145]
v_pk_add_f32 v[138:139], v[138:139], v[146:147]
v_pk_add_f32 v[140:141], v[140:141], v[148:149]
v_pk_add_f32 v[142:143], v[142:143], v[150:151]
v_pk_add_f32 v[120:121], v[120:121], v[136:137]
v_pk_add_f32 v[122:123], v[122:123], v[138:139]
v_pk_add_f32 v[124:125], v[124:125], v[140:141]
v_pk_add_f32 v[126:127], v[126:127], v[142:143]
v_cvt_pk_bf16_f32 v244, v120, v121
v_cvt_pk_bf16_f32 v245, v122, v123
v_cvt_pk_bf16_f32 v246, v124, v125
v_cvt_pk_bf16_f32 v247, v126, v127
mega_kernel_rs_s1:
v_add_u32 v5, 9216, v17
s_waitcnt lgkmcnt(0)
s_barrier
s_cmp_eq_u32 s24, 2
s_cbranch_scc1 mega_kernel_rs_s2
s_cmp_eq_u32 s24, 3
s_cbranch_scc0 mega_kernel_rs_s3
s_add_u32 s76, s27, 2
s_cmp_lt_u32 s76, 63
s_cbranch_scc0 mega_kernel_rs_s3
s_cmp_gt_i32 s46, s76
s_cbranch_scc0 mega_kernel_rs_s3
s_add_u32 s77, s76, s82
s_bfe_u32 s28, s77, 0x40002
s_lshl_b32 s28, s28, 14
s_and_b32 s77, s77, 3
s_lshl_b32 s77, s77, 11
s_add_u32 s28, s28, s77
s_add_u32 s28, s28, s83
s_buffer_load_dword s78, s[84:87], s28 offset:0
s_buffer_load_dword s78, s[84:87], s28 offset:128
s_buffer_load_dword s78, s[84:87], s28 offset:256
s_buffer_load_dword s78, s[84:87], s28 offset:384
s_buffer_load_dword s78, s[84:87], s28 offset:512
s_buffer_load_dword s78, s[84:87], s28 offset:640
s_buffer_load_dword s78, s[84:87], s28 offset:768
s_buffer_load_dword s78, s[84:87], s28 offset:896
s_buffer_load_dword s78, s[84:87], s28 offset:1024
s_buffer_load_dword s78, s[84:87], s28 offset:1152
s_buffer_load_dword s78, s[84:87], s28 offset:1280
s_buffer_load_dword s78, s[84:87], s28 offset:1408
s_buffer_load_dword s78, s[84:87], s28 offset:1536
s_buffer_load_dword s78, s[84:87], s28 offset:1664
s_buffer_load_dword s78, s[84:87], s28 offset:1792
s_buffer_load_dword s78, s[84:87], s28 offset:1920
s_mov_b32 s88, s76
s_branch mega_kernel_rs_s3
mega_kernel_rs_s2:
ds_read_b128 v[120:123], v5 offset:0
ds_read_b128 v[124:127], v5 offset:1024
ds_read_b128 v[128:131], v5 offset:2048
ds_read_b128 v[132:135], v5 offset:3072
v_lshrrev_b32 v5, 1, v17
s_waitcnt lgkmcnt(2)
v_pk_add_f32 v[120:121], v[120:121], v[124:125]
v_pk_add_f32 v[122:123], v[122:123], v[126:127]
s_waitcnt lgkmcnt(0)
v_pk_add_f32 v[128:129], v[128:129], v[132:133]
v_pk_add_f32 v[130:131], v[130:131], v[134:135]
v_pk_add_f32 v[120:121], v[120:121], v[128:129]
v_pk_add_f32 v[122:123], v[122:123], v[130:131]
v_cvt_pk_bf16_f32 v244, v120, v121
v_cvt_pk_bf16_f32 v245, v122, v123
ds_write_b64 v5, v[244:245] offset:17920
s_waitcnt lgkmcnt(0) vmcnt(0)
mega_kernel_rs_s3:
s_cmp_eq_u32 s27, 63
s_cbranch_scc1 mega_kernel_rs_slast
s_add_u32 s29, s33, 24576
s_barrier
s_cmp_eq_u32 s24, 3
s_cbranch_scc1 mega_kernel_rs_y3
s_add_u32 s77, s27, s82
s_bfe_u32 s28, s77, 0x30003
s_lshl_b32 s28, s28, 14
s_and_b32 s77, s77, 7
s_lshl_b32 s77, s77, 10
s_add_u32 s28, s28, s77
s_add_u32 s28, s28, s79
s_cmp_eq_u32 s24, 2
s_cbranch_scc1 mega_kernel_rs_kv2a
s_mov_b64 exec, s[48:49]
buffer_store_dwordx4 v[244:247], v22, s[84:87], s28 offen sc1
s_mov_b64 exec, -1
s_branch mega_kernel_rs_kvda
mega_kernel_rs_kv2a:
v_lshlrev_b32 v4, 3, v1
buffer_store_dwordx2 v[244:245], v4, s[84:87], s28 offen offset:512 sc1
mega_kernel_rs_kvda:
s_branch mega_kernel_rs_y4
mega_kernel_rs_y3:
s_add_u32 s76, s27, 2
s_cmp_lt_u32 s76, 63
s_cbranch_scc0 mega_kernel_rs_y4
mega_kernel_rs_y4:
s_branch mega_kernel_rs_b3
mega_kernel_rs_first:
buffer_load_dwordx4 v[32:35], v8, s[20:23], 0 offen offset:0
buffer_load_dwordx4 v[36:39], v8, s[20:23], 0 offen offset:128
buffer_load_dwordx4 v[40:43], v8, s[20:23], 0 offen offset:256
buffer_load_dwordx4 v[44:47], v8, s[20:23], 0 offen offset:384
v_add_u32 v5, s44, v17
ds_read_b128 v[156:159], v5 offset:0
ds_read_b128 v[160:163], v5 offset:1024
ds_read_b128 v[164:167], v5 offset:2048
ds_read_b128 v[168:171], v5 offset:3072
s_waitcnt vmcnt(0)
v_smfmac_f32_16x16x64_bf16 v[96:99], v[32:35], a[0:7], v6
v_smfmac_f32_16x16x64_bf16 v[100:103], v[32:35], a[32:39], v6
v_smfmac_f32_16x16x64_bf16 v[104:107], v[32:35], a[64:71], v6
v_smfmac_f32_16x16x64_bf16 v[108:111], v[32:35], a[96:103], v6
v_smfmac_f32_16x16x64_bf16 v[96:99], v[36:39], a[8:15], v6
v_smfmac_f32_16x16x64_bf16 v[100:103], v[36:39], a[40:47], v6
v_smfmac_f32_16x16x64_bf16 v[104:107], v[36:39], a[72:79], v6
v_smfmac_f32_16x16x64_bf16 v[108:111], v[36:39], a[104:111], v6
v_smfmac_f32_16x16x64_bf16 v[96:99], v[40:43], a[16:23], v6
v_smfmac_f32_16x16x64_bf16 v[100:103], v[40:43], a[48:55], v6
v_smfmac_f32_16x16x64_bf16 v[104:107], v[40:43], a[80:87], v6
v_smfmac_f32_16x16x64_bf16 v[108:111], v[40:43], a[112:119], v6
v_smfmac_f32_16x16x64_bf16 v[96:99], v[44:47], a[24:31], v6
v_smfmac_f32_16x16x64_bf16 v[100:103], v[44:47], a[56:63], v6
v_smfmac_f32_16x16x64_bf16 v[104:107], v[44:47], a[88:95], v6
v_smfmac_f32_16x16x64_bf16 v[108:111], v[44:47], a[120:127], v6
s_nop 1
s_branch mega_kernel_rs_adone
mega_kernel_rs_slast:
s_cmp_eq_u32 s24, 3
s_cbranch_scc1 mega_kernel_rs_end
s_add_u32 s77, s27, s82
s_bfe_u32 s28, s77, 0x30003
s_lshl_b32 s28, s28, 14
s_and_b32 s77, s77, 7
s_lshl_b32 s77, s77, 10
s_add_u32 s28, s28, s77
s_add_u32 s28, s28, s79
s_cmp_eq_u32 s24, 2
s_cbranch_scc1 mega_kernel_rs_kv2b
s_mov_b64 exec, s[48:49]
buffer_store_dwordx4 v[244:247], v22, s[84:87], s28 offen sc1
s_mov_b64 exec, -1
s_branch mega_kernel_rs_kvdb
mega_kernel_rs_kv2b:
v_lshlrev_b32 v4, 3, v1
buffer_store_dwordx2 v[244:245], v4, s[84:87], s28 offen offset:512 sc1
mega_kernel_rs_kvdb:
s_waitcnt vmcnt(0)
s_barrier
s_mov_b32 s76, 64
s_cmp_eq_u32 s24, 1
s_cbranch_scc0 mega_kernel_rs_end
v_mov_b32 v5, s76
s_mov_b64 exec, 1
buffer_store_dword v5, v228, s[84:87], s81 offen sc1
s_mov_b64 exec, -1
mega_kernel_rs_end:
s_endpgm
.section .rodata,"a"
.p2align 6
.amdhsa_kernel mega_kernel
  .amdhsa_next_free_vgpr 512
  .amdhsa_next_free_sgpr 102
  .amdhsa_accum_offset 256
  .amdhsa_group_segment_fixed_size 0
  .amdhsa_kernarg_size 104
  .amdhsa_user_sgpr_count 2
  .amdhsa_user_sgpr_kernarg_segment_ptr 1
  .amdhsa_system_sgpr_workgroup_id_x 1
.end_amdhsa_kernel
```

```asm
; @launch kernel=mega_kernel grid=(256,1,1) block=(256,1,1) lds=163840
.amdgcn_target "amdgcn-amd-amdhsa--gfx950"
.text
.globl mega_kernel
.p2align 8
.type mega_kernel,@function
mega_kernel:
s_cmp_ge_u32 s2, 256
s_cbranch_scc1 mega_kernel_exit
s_load_dwordx2 s[84:85], s[0:1], 96
s_load_dwordx2 s[72:73], s[0:1], 88
s_getreg_b32 s90, hwreg(HW_REG_XCC_ID)
s_and_b32 s90, s90, 7
v_mov_b32 v1, 0
v_mov_b32 v2, 1
s_lshl_b32 s91, s90, 4
s_mov_b32 s95, 0
s_mov_b32 s99, 0
s_waitcnt lgkmcnt(0)
s_mov_b32 s86, 268435456
s_mov_b32 s87, 0x00020000
s_mov_b32 s74, 256
s_mov_b32 s75, 0x00020000
v_cmp_eq_u32 vcc, 0, v0
s_and_saveexec_b64 s[88:89], vcc
s_cbranch_execz mega_kernel_tkd
s_lshl_b32 s92, s2, 13
s_add_u32 s92, s92, 167772160
buffer_atomic_add v2, v1, s[72:75], s91 offen sc0
buffer_load_dword v251, v1, s[84:87], s92 offen offset:2048 sc1
s_waitcnt vmcnt(1)
ds_write_b32 v1, v2
s_waitcnt lgkmcnt(0)
mega_kernel_tkd:
s_mov_b64 exec, s[88:89]
s_barrier
ds_read_b32 v2, v1
s_waitcnt lgkmcnt(0)
v_readfirstlane_b32 s96, v2
s_barrier
s_cmp_lt_u32 s96, 32
s_cbranch_scc1 mega_kernel_spec
v_and_b32 v3, 15, v0
v_lshlrev_b32 v3, 4, v3
s_branch mega_kernel_syx
mega_kernel_syxw:
s_sleep 4
mega_kernel_syx:
buffer_load_dword v2, v3, s[72:75], 0 offen sc1
s_waitcnt vmcnt(0)
mega_kernel_syxp:
s_cmp_eq_u32 s95, 1
s_cbranch_scc0 mega_kernel_syxf
v_readlane_b32 s76, v2, 14
s_mov_b32 s98, 0
s_cmp_eq_u32 s76, 32
s_cbranch_scc0 mega_kernel_syxw
s_branch mega_kernel_syxd
mega_kernel_syxf:
s_mov_b32 s77, 0
s_mov_b32 s78, 0
v_readlane_b32 s76, v2, 0
s_add_u32 s77, s77, s76
s_xor_b32 s76, s76, 32
s_or_b32 s78, s78, s76
v_readlane_b32 s76, v2, 1
s_add_u32 s77, s77, s76
s_xor_b32 s76, s76, 32
s_or_b32 s78, s78, s76
v_readlane_b32 s76, v2, 2
s_add_u32 s77, s77, s76
s_xor_b32 s76, s76, 32
s_or_b32 s78, s78, s76
v_readlane_b32 s76, v2, 3
s_add_u32 s77, s77, s76
s_xor_b32 s76, s76, 32
s_or_b32 s78, s78, s76
v_readlane_b32 s76, v2, 4
s_add_u32 s77, s77, s76
s_xor_b32 s76, s76, 32
s_or_b32 s78, s78, s76
v_readlane_b32 s76, v2, 5
s_add_u32 s77, s77, s76
s_xor_b32 s76, s76, 32
s_or_b32 s78, s78, s76
v_readlane_b32 s76, v2, 6
s_add_u32 s77, s77, s76
s_xor_b32 s76, s76, 32
s_or_b32 s78, s78, s76
v_readlane_b32 s76, v2, 7
s_add_u32 s77, s77, s76
s_xor_b32 s76, s76, 32
s_or_b32 s78, s78, s76
s_cmp_eq_u32 s77, 256
s_cbranch_scc0 mega_kernel_syxw
v_mov_b32 v252, v2
s_cmp_eq_u32 s78, 0
s_cbranch_scc0 mega_kernel_slowent
v_readlane_b32 s76, v2, 10
v_readlane_b32 s77, v2, 8
s_cmp_eq_u32 s76, 32
s_cbranch_scc0 mega_kernel_syxw
s_cmp_gt_u32 s77, 16
s_cselect_b32 s98, 1, 0
mega_kernel_syxd:
mega_kernel_slowent:
s_mov_b64 exec, -1
s_waitcnt vmcnt(0) lgkmcnt(0)
s_barrier
s_mov_b32 s97, s96
v_readlane_b32 s76, v252, 0
s_cmp_gt_u32 s90, 0
s_cselect_b32 s76, s76, 0
s_add_u32 s97, s97, s76
v_readlane_b32 s76, v252, 1
s_cmp_gt_u32 s90, 1
s_cselect_b32 s76, s76, 0
s_add_u32 s97, s97, s76
v_readlane_b32 s76, v252, 2
s_cmp_gt_u32 s90, 2
s_cselect_b32 s76, s76, 0
s_add_u32 s97, s97, s76
v_readlane_b32 s76, v252, 3
s_cmp_gt_u32 s90, 3
s_cselect_b32 s76, s76, 0
s_add_u32 s97, s97, s76
v_readlane_b32 s76, v252, 4
s_cmp_gt_u32 s90, 4
s_cselect_b32 s76, s76, 0
s_add_u32 s97, s97, s76
v_readlane_b32 s76, v252, 5
s_cmp_gt_u32 s90, 5
s_cselect_b32 s76, s76, 0
s_add_u32 s97, s97, s76
v_readlane_b32 s76, v252, 6
s_cmp_gt_u32 s90, 6
s_cselect_b32 s76, s76, 0
s_add_u32 s97, s97, s76
v_mov_b32 v1, 0
v_mov_b32 v2, 1
v_cmp_eq_u32 vcc, 0, v0
s_and_saveexec_b64 s[88:89], vcc
s_cbranch_execz mega_kernel_sb1
buffer_atomic_add v2, v1, s[72:75], 0 offen offset:192 sc1
mega_kernel_sb1:
s_mov_b64 exec, s[88:89]
mega_kernel_sb2:
s_sleep 4
buffer_load_dword v2, v1, s[72:75], 0 offen offset:192 sc1
s_waitcnt vmcnt(0)
v_cmp_ne_u32 vcc, 256, v2
s_cbranch_vccnz mega_kernel_sb2
s_mov_b32 s95, 1
s_lshr_b32 s30, s97, 5
s_and_b32 s31, s97, 31
s_cmp_lt_u32 s97, 128
s_cbranch_scc1 mega_kernel_recs
s_sub_u32 s94, s97, 128
s_branch mega_kernel_bulk
mega_kernel_spec:
s_mov_b32 s30, s90
s_mov_b32 s31, s96
s_cmp_lt_u32 s90, 4
s_cbranch_scc1 mega_kernel_recf
s_sub_u32 s94, s90, 4
s_lshl_b32 s94, s94, 5
s_add_u32 s94, s94, s96
mega_kernel_bulk:
s_lshr_b32 s91, s94, 5
s_and_b32 s40, s94, 31
s_and_b32 s92, s91, 1
s_lshl_b32 s92, s92, 5
s_add_u32 s92, s92, s40
s_cmp_eq_u32 s91, 0
s_cbranch_scc1 mega_kernel_rk
s_cmp_eq_u32 s91, 1
s_cbranch_scc1 mega_kernel_rv
s_cmp_eq_u32 s91, 2
s_cbranch_scc1 mega_kernel_noinit
v_mov_b32 v8, -1
v_mov_b32 v9, -1
v_mov_b32 v10, -1
v_mov_b32 v11, -1
v_lshlrev_b32 v1, 4, v0
v_mov_b32 v2, 0
v_cmp_gt_u32 vcc, 64, v0
s_cbranch_vccz mega_kernel_nv
s_cmp_eq_u32 s95, 0
s_cbranch_scc0 mega_kernel_nv
s_lshr_b32 s60, s2, 1
s_lshl_b32 s60, s60, 14
s_and_b32 s61, s40, 1
s_lshl_b32 s66, s61, 13
s_add_u32 s60, s60, s66
s_and_b32 s66, s2, 1
s_lshl_b32 s66, s66, 10
s_add_u32 s60, s60, s66
s_add_u32 s60, s60, 167772160
s_mov_b32 s66, 0x7fffffff
s_mov_b32 s67, 0x7fffffff
s_mov_b64 exec, 0xff
s_waitcnt vmcnt(0)
s_memtime s[62:63]
s_waitcnt lgkmcnt(0)
buffer_store_dwordx4 v[8:11], v1, s[84:87], s60 offen offset:0 sc1
s_waitcnt vmcnt(0)
s_memtime s[64:65]
s_xor_b32 s60, s60, 8192
s_waitcnt lgkmcnt(0)
s_sub_u32 s64, s64, s62
s_min_u32 s66, s66, s64
s_memtime s[62:63]
s_waitcnt lgkmcnt(0)
buffer_store_dwordx4 v[8:11], v1, s[84:87], s60 offen offset:0 sc1
s_waitcnt vmcnt(0)
s_memtime s[64:65]
s_xor_b32 s60, s60, 8192
s_waitcnt lgkmcnt(0)
s_sub_u32 s64, s64, s62
s_min_u32 s67, s67, s64
s_memtime s[62:63]
s_waitcnt lgkmcnt(0)
buffer_store_dwordx4 v[8:11], v1, s[84:87], s60 offen offset:256 sc1
s_waitcnt vmcnt(0)
s_memtime s[64:65]
s_xor_b32 s60, s60, 8192
s_waitcnt lgkmcnt(0)
s_sub_u32 s64, s64, s62
s_min_u32 s66, s66, s64
s_memtime s[62:63]
s_waitcnt lgkmcnt(0)
buffer_store_dwordx4 v[8:11], v1, s[84:87], s60 offen offset:256 sc1
s_waitcnt vmcnt(0)
s_memtime s[64:65]
s_xor_b32 s60, s60, 8192
s_waitcnt lgkmcnt(0)
s_sub_u32 s64, s64, s62
s_min_u32 s67, s67, s64
s_cmp_lt_u32 s67, s66
s_cselect_b32 s60, 1, 0
s_xor_b32 s60, s60, s61
s_lshr_b32 s61, s90, 2
s_xor_b32 s60, s60, s61
v_mov_b32 v3, s60
s_mov_b64 exec, 1
buffer_atomic_add v3, v2, s[72:75], 0 offen offset:128 sc1
s_mov_b64 exec, -1
mega_kernel_nv:
s_barrier
s_lshl_b32 s60, s40, 12
s_add_u32 s60, s60, 67108864
buffer_store_dwordx4 v[8:11], v1, s[84:87], s60 offen sc1
s_add_u32 s60, s60, 131072
buffer_store_dwordx4 v[8:11], v1, s[84:87], s60 offen sc1
s_add_u32 s60, s60, 131072
buffer_store_dwordx4 v[8:11], v1, s[84:87], s60 offen sc1
s_add_u32 s60, s60, 131072
buffer_store_dwordx4 v[8:11], v1, s[84:87], s60 offen sc1
s_add_u32 s60, s60, 131072
buffer_store_dwordx4 v[8:11], v1, s[84:87], s60 offen sc1
s_add_u32 s60, s60, 131072
buffer_store_dwordx4 v[8:11], v1, s[84:87], s60 offen sc1
s_add_u32 s60, s60, 131072
buffer_store_dwordx4 v[8:11], v1, s[84:87], s60 offen sc1
s_add_u32 s60, s60, 131072
buffer_store_dwordx4 v[8:11], v1, s[84:87], s60 offen sc1
s_add_u32 s60, s60, 131072
buffer_store_dwordx4 v[8:11], v1, s[84:87], s60 offen sc1
s_add_u32 s60, s60, 131072
buffer_store_dwordx4 v[8:11], v1, s[84:87], s60 offen sc1
s_add_u32 s60, s60, 131072
buffer_store_dwordx4 v[8:11], v1, s[84:87], s60 offen sc1
s_add_u32 s60, s60, 131072
buffer_store_dwordx4 v[8:11], v1, s[84:87], s60 offen sc1
s_add_u32 s60, s60, 131072
buffer_store_dwordx4 v[8:11], v1, s[84:87], s60 offen sc1
s_add_u32 s60, s60, 131072
buffer_store_dwordx4 v[8:11], v1, s[84:87], s60 offen sc1
s_add_u32 s60, s60, 131072
buffer_store_dwordx4 v[8:11], v1, s[84:87], s60 offen sc1
s_add_u32 s60, s60, 131072
buffer_store_dwordx4 v[8:11], v1, s[84:87], s60 offen sc1
s_add_u32 s60, s60, 131072
s_lshr_b32 s62, s40, 1
s_and_b32 s63, s40, 1
s_add_u32 s63, s63, s62
s_lshl_b32 s62, s62, 19
s_and_b32 s64, s63, 14
s_lshl_b32 s64, s64, 13
s_add_u32 s62, s62, s64
s_and_b32 s64, s63, 1
s_lshl_b32 s64, s64, 12
s_add_u32 s62, s62, s64
s_add_u32 s62, s62, 150994944
s_add_u32 s62, s62, 8192
s_cmp_lt_u32 s40, 16
s_cbranch_scc0 mega_kernel_pz
buffer_store_dwordx4 v[8:11], v1, s[84:87], s60 offen sc1
mega_kernel_pz:
s_waitcnt vmcnt(0)
s_barrier
v_mov_b32 v3, 1
s_lshl_b32 s62, s95, 6
v_cmp_eq_u32 vcc, 0, v0
s_and_saveexec_b64 s[60:61], vcc
s_cbranch_execz mega_kernel_xps
buffer_atomic_add v3, v2, s[72:75], s62 offen offset:160 sc1
mega_kernel_xps:
s_mov_b64 exec, s[60:61]
mega_kernel_noinit:
s_cmp_eq_u32 s91, 2
s_cbranch_scc1 mega_kernel_nohold
v_and_b32 v3, 15, v0
v_lshlrev_b32 v3, 4, v3
s_branch mega_kernel_syh
mega_kernel_syhw:
s_sleep 4
mega_kernel_syh:
buffer_load_dword v2, v3, s[72:75], 0 offen sc1
s_waitcnt vmcnt(0)
mega_kernel_syhp:
s_cmp_eq_u32 s95, 1
s_cbranch_scc0 mega_kernel_syhf
v_readlane_b32 s76, v2, 14
s_mov_b32 s98, 0
s_cmp_eq_u32 s76, 32
s_cbranch_scc0 mega_kernel_syhw
s_branch mega_kernel_syhd
mega_kernel_syhf:
s_mov_b32 s77, 0
s_mov_b32 s78, 0
v_readlane_b32 s76, v2, 0
s_add_u32 s77, s77, s76
s_xor_b32 s76, s76, 32
s_or_b32 s78, s78, s76
v_readlane_b32 s76, v2, 1
s_add_u32 s77, s77, s76
s_xor_b32 s76, s76, 32
s_or_b32 s78, s78, s76
v_readlane_b32 s76, v2, 2
s_add_u32 s77, s77, s76
s_xor_b32 s76, s76, 32
s_or_b32 s78, s78, s76
v_readlane_b32 s76, v2, 3
s_add_u32 s77, s77, s76
s_xor_b32 s76, s76, 32
s_or_b32 s78, s78, s76
v_readlane_b32 s76, v2, 4
s_add_u32 s77, s77, s76
s_xor_b32 s76, s76, 32
s_or_b32 s78, s78, s76
v_readlane_b32 s76, v2, 5
s_add_u32 s77, s77, s76
s_xor_b32 s76, s76, 32
s_or_b32 s78, s78, s76
v_readlane_b32 s76, v2, 6
s_add_u32 s77, s77, s76
s_xor_b32 s76, s76, 32
s_or_b32 s78, s78, s76
v_readlane_b32 s76, v2, 7
s_add_u32 s77, s77, s76
s_xor_b32 s76, s76, 32
s_or_b32 s78, s78, s76
s_cmp_eq_u32 s77, 256
s_cbranch_scc0 mega_kernel_syhw
v_mov_b32 v252, v2
s_cmp_eq_u32 s78, 0
s_cbranch_scc0 mega_kernel_slowent
v_readlane_b32 s76, v2, 10
v_readlane_b32 s77, v2, 8
s_cmp_eq_u32 s76, 32
s_cbranch_scc0 mega_kernel_syhw
s_cmp_gt_u32 s77, 16
s_cselect_b32 s98, 1, 0
mega_kernel_syhd:
s_xor_b32 s76, s98, 1
s_lshl_b32 s76, s76, 13
s_lshl_b32 s77, s40, 7
s_add_u32 s76, s76, s77
s_add_u32 s76, s76, 69206016
v_mov_b32 v1, 0
mega_kernel_hold:
s_sleep 12
buffer_load_dword v2, v1, s[84:87], s76 offen sc1
s_waitcnt vmcnt(0)
v_cmp_gt_i32 vcc, 1, v2
s_cbranch_vccnz mega_kernel_hold
mega_kernel_nohold:
s_cmp_eq_u32 s91, 2
s_cbranch_scc0 mega_kernel_rd
s_load_dwordx2 s[4:5], s[0:1], 16
s_load_dwordx2 s[8:9], s[0:1], 0
v_lshrrev_b32 v2, 6, v0
v_and_b32 v1, 63, v0
v_readfirstlane_b32 s41, v2
v_lshlrev_b32 v5, 4, v1
s_waitcnt lgkmcnt(0)
s_mov_b32 s6, 8388608
s_mov_b32 s7, 0x00020000
s_mov_b32 s10, 4194304
s_mov_b32 s11, 0x00020000
s_lshl_b32 s43, s40, 8
s_lshl_b32 s44, s41, 6
s_add_u32 s48, s43, s44
s_and_b32 s43, s48, 0x7ff
v_add_u32 v19, s43, v1
v_lshlrev_b32 v19, 7, v19
s_mov_b32 s43, 0
buffer_load_dword v250, v19, s[8:11], s43 offen
s_nop 0
v_lshrrev_b32 v2, 3, v1
s_lshl_b32 s43, s41, 3
v_add_u32 v2, s43, v2
v_bfe_u32 v3, v2, 1, 3
v_and_b32 v4, 7, v1
v_xor_b32 v3, v3, v4
v_lshlrev_b32 v6, 11, v2
v_lshl_add_u32 v6, v3, 4, v6
s_lshl_b32 s46, s41, 10
v_and_b32 v2, 15, v1
v_bfe_u32 v3, v2, 1, 3
v_lshrrev_b32 v4, 4, v1
v_xor_b32 v3, v3, v4
v_lshlrev_b32 v8, 7, v2
v_lshl_add_u32 v8, v3, 4, v8
v_xor_b32 v9, 64, v8
v_add_u32 v10, 0x10000, v8
v_add_u32 v11, 0x10000, v9
v_mov_b32 v7, v5
s_lshl_b32 s47, s40, 2
s_add_u32 s47, s47, s41
s_mov_b32 s42, 0
s_mov_b32 s50, 0
s_add_u32 m0, s46, 0
s_nop 0
buffer_load_dwordx4 v6, s[8:11], s50 offen offset:0 lds
s_add_u32 m0, s46, 3968
s_nop 0
buffer_load_dwordx4 v6, s[8:11], s50 offen offset:128 lds
s_add_u32 m0, s46, 7936
s_nop 0
buffer_load_dwordx4 v6, s[8:11], s50 offen offset:256 lds
s_add_u32 m0, s46, 11904
s_nop 0
buffer_load_dwordx4 v6, s[8:11], s50 offen offset:384 lds
s_add_u32 m0, s46, 15872
s_nop 0
buffer_load_dwordx4 v6, s[8:11], s50 offen offset:512 lds
s_add_u32 m0, s46, 19840
s_nop 0
buffer_load_dwordx4 v6, s[8:11], s50 offen offset:640 lds
s_add_u32 m0, s46, 23808
s_nop 0
buffer_load_dwordx4 v6, s[8:11], s50 offen offset:768 lds
s_add_u32 m0, s46, 27776
s_nop 0
buffer_load_dwordx4 v6, s[8:11], s50 offen offset:896 lds
s_add_u32 m0, s46, 31744
s_nop 0
buffer_load_dwordx4 v6, s[8:11], s50 offen offset:1024 lds
s_add_u32 m0, s46, 35712
s_nop 0
buffer_load_dwordx4 v6, s[8:11], s50 offen offset:1152 lds
s_add_u32 m0, s46, 39680
s_nop 0
buffer_load_dwordx4 v6, s[8:11], s50 offen offset:1280 lds
s_add_u32 m0, s46, 43648
s_nop 0
buffer_load_dwordx4 v6, s[8:11], s50 offen offset:1408 lds
s_add_u32 m0, s46, 47616
s_nop 0
buffer_load_dwordx4 v6, s[8:11], s50 offen offset:1536 lds
s_add_u32 m0, s46, 51584
s_nop 0
buffer_load_dwordx4 v6, s[8:11], s50 offen offset:1664 lds
s_add_u32 m0, s46, 55552
s_nop 0
buffer_load_dwordx4 v6, s[8:11], s50 offen offset:1792 lds
s_add_u32 m0, s46, 59520
s_nop 0
buffer_load_dwordx4 v6, s[8:11], s50 offen offset:1920 lds
v_lshrrev_b32 v2, 2, v1
v_and_b32 v3, 3, v1
v_lshlrev_b32 v16, 13, v2
v_lshl_add_u32 v16, v3, 4, v16
v_add_u32 v16, s48, v16
s_mul_i32 s45, s41, 24576
s_add_u32 s45, s45, 65536
v_bfe_u32 v17, v1, 2, 2
v_lshrrev_b32 v18, 4, v1
v_lshl_add_u32 v17, v18, 3, v17
v_lshlrev_b32 v17, 6, v17
v_lshl_add_u32 v17, v3, 4, v17
v_add_u32 v17, s45, v17
s_and_b32 s43, s40, 3
s_lshl_b32 s43, s43, 2
s_add_u32 s43, s43, s41
s_lshl_b32 s43, s43, 3
v_and_b32 v12, 7, v1
v_add_u32 v12, s43, v12
s_lshr_b32 s43, s40, 2
s_lshl_b32 s43, s43, 10
s_add_u32 s44, s43, 896
s_add_u32 s43, s43, 384
s_cmp_ge_u32 s40, 28
s_cselect_b32 s44, s44, s43
v_mov_b32 v13, s43
v_mov_b32 v14, s44
v_cmp_gt_u32 vcc, 32, v1
s_nop 1
v_cndmask_b32 v13, v14, v13, vcc
v_lshl_add_u32 v12, v12, 13, v13
s_mov_b32 s44, 0
buffer_load_dword v250, v12, s[4:7], s44 offen
s_add_u32 m0, s45, 0
s_mov_b32 s44, 0
buffer_load_dwordx4 v16, s[4:7], s44 offen lds
s_add_u32 m0, s45, 1024
s_mov_b32 s44, 131072
buffer_load_dwordx4 v16, s[4:7], s44 offen lds
s_add_u32 m0, s45, 2048
s_mov_b32 s44, 262144
buffer_load_dwordx4 v16, s[4:7], s44 offen lds
s_add_u32 m0, s45, 3072
s_mov_b32 s44, 393216
buffer_load_dwordx4 v16, s[4:7], s44 offen lds
s_add_u32 m0, s45, 4096
s_mov_b32 s44, 524288
buffer_load_dwordx4 v16, s[4:7], s44 offen lds
s_add_u32 m0, s45, 5120
s_mov_b32 s44, 655360
buffer_load_dwordx4 v16, s[4:7], s44 offen lds
s_add_u32 m0, s45, 6144
s_mov_b32 s44, 786432
buffer_load_dwordx4 v16, s[4:7], s44 offen lds
s_add_u32 m0, s45, 7168
s_mov_b32 s44, 917504
buffer_load_dwordx4 v16, s[4:7], s44 offen lds
s_mov_b32 s44, 1048576
buffer_load_dword v250, v12, s[4:7], s44 offen
s_add_u32 m0, s45, 8192
s_mov_b32 s44, 1048576
buffer_load_dwordx4 v16, s[4:7], s44 offen lds
s_add_u32 m0, s45, 9216
s_mov_b32 s44, 1179648
buffer_load_dwordx4 v16, s[4:7], s44 offen lds
s_add_u32 m0, s45, 10240
s_mov_b32 s44, 1310720
buffer_load_dwordx4 v16, s[4:7], s44 offen lds
s_add_u32 m0, s45, 11264
s_mov_b32 s44, 1441792
buffer_load_dwordx4 v16, s[4:7], s44 offen lds
s_add_u32 m0, s45, 12288
s_mov_b32 s44, 1572864
buffer_load_dwordx4 v16, s[4:7], s44 offen lds
s_add_u32 m0, s45, 13312
s_mov_b32 s44, 1703936
buffer_load_dwordx4 v16, s[4:7], s44 offen lds
s_add_u32 m0, s45, 14336
s_mov_b32 s44, 1835008
buffer_load_dwordx4 v16, s[4:7], s44 offen lds
s_add_u32 m0, s45, 15360
s_mov_b32 s44, 1966080
buffer_load_dwordx4 v16, s[4:7], s44 offen lds
s_mov_b32 s44, 2097152
buffer_load_dword v250, v12, s[4:7], s44 offen
s_add_u32 m0, s45, 16384
s_mov_b32 s44, 2097152
buffer_load_dwordx4 v16, s[4:7], s44 offen lds
s_add_u32 m0, s45, 17408
s_mov_b32 s44, 2228224
buffer_load_dwordx4 v16, s[4:7], s44 offen lds
s_add_u32 m0, s45, 18432
s_mov_b32 s44, 2359296
buffer_load_dwordx4 v16, s[4:7], s44 offen lds
s_add_u32 m0, s45, 19456
s_mov_b32 s44, 2490368
buffer_load_dwordx4 v16, s[4:7], s44 offen lds
s_add_u32 m0, s45, 20480
s_mov_b32 s44, 2621440
buffer_load_dwordx4 v16, s[4:7], s44 offen lds
s_add_u32 m0, s45, 21504
s_mov_b32 s44, 2752512
buffer_load_dwordx4 v16, s[4:7], s44 offen lds
s_add_u32 m0, s45, 22528
s_mov_b32 s44, 2883584
buffer_load_dwordx4 v16, s[4:7], s44 offen lds
s_add_u32 m0, s45, 23552
s_mov_b32 s44, 3014656
buffer_load_dwordx4 v16, s[4:7], s44 offen lds
s_waitcnt vmcnt(18)
s_barrier
ds_read_b64_tr_b16 a[0:1], v17 offset:0
ds_read_b64_tr_b16 a[2:3], v17 offset:256
ds_read_b64_tr_b16 a[4:5], v17 offset:8
ds_read_b64_tr_b16 a[6:7], v17 offset:264
ds_read_b64_tr_b16 a[8:9], v17 offset:2048
ds_read_b64_tr_b16 a[10:11], v17 offset:2304
ds_read_b64_tr_b16 a[12:13], v17 offset:2056
ds_read_b64_tr_b16 a[14:15], v17 offset:2312
s_waitcnt lgkmcnt(0)
ds_read_b64_tr_b16 a[16:17], v17 offset:4096
ds_read_b64_tr_b16 a[18:19], v17 offset:4352
ds_read_b64_tr_b16 a[20:21], v17 offset:4104
ds_read_b64_tr_b16 a[22:23], v17 offset:4360
ds_read_b64_tr_b16 a[24:25], v17 offset:6144
ds_read_b64_tr_b16 a[26:27], v17 offset:6400
ds_read_b64_tr_b16 a[28:29], v17 offset:6152
ds_read_b64_tr_b16 a[30:31], v17 offset:6408
s_waitcnt lgkmcnt(0)
s_mov_b32 s44, 3145728
buffer_load_dword v250, v12, s[4:7], s44 offen
s_add_u32 m0, s45, 0
s_mov_b32 s44, 3145728
buffer_load_dwordx4 v16, s[4:7], s44 offen lds
s_add_u32 m0, s45, 1024
s_mov_b32 s44, 3276800
buffer_load_dwordx4 v16, s[4:7], s44 offen lds
s_add_u32 m0, s45, 2048
s_mov_b32 s44, 3407872
buffer_load_dwordx4 v16, s[4:7], s44 offen lds
s_add_u32 m0, s45, 3072
s_mov_b32 s44, 3538944
buffer_load_dwordx4 v16, s[4:7], s44 offen lds
s_add_u32 m0, s45, 4096
s_mov_b32 s44, 3670016
buffer_load_dwordx4 v16, s[4:7], s44 offen lds
s_add_u32 m0, s45, 5120
s_mov_b32 s44, 3801088
buffer_load_dwordx4 v16, s[4:7], s44 offen lds
s_add_u32 m0, s45, 6144
s_mov_b32 s44, 3932160
buffer_load_dwordx4 v16, s[4:7], s44 offen lds
s_add_u32 m0, s45, 7168
s_mov_b32 s44, 4063232
buffer_load_dwordx4 v16, s[4:7], s44 offen lds
ds_read_b128 v[20:23], v8 offset:0
ds_read_b128 v[24:27], v8 offset:2048
ds_read_b128 v[28:31], v9 offset:0
ds_read_b128 v[32:35], v9 offset:2048
ds_read_b128 v[36:39], v8 offset:4096
ds_read_b128 v[40:43], v8 offset:6144
ds_read_b128 v[44:47], v9 offset:4096
ds_read_b128 v[48:51], v9 offset:6144
s_waitcnt lgkmcnt(0)
v_mfma_f32_16x16x32_bf16 v[52:55], a[0:3], v[20:23], 0
v_mfma_f32_16x16x32_bf16 v[56:59], a[4:7], v[20:23], 0
v_mfma_f32_16x16x32_bf16 v[60:63], a[0:3], v[24:27], 0
v_mfma_f32_16x16x32_bf16 v[64:67], a[4:7], v[24:27], 0
v_mfma_f32_16x16x32_bf16 v[52:55], a[8:11], v[28:31], v[52:55]
v_mfma_f32_16x16x32_bf16 v[56:59], a[12:15], v[28:31], v[56:59]
v_mfma_f32_16x16x32_bf16 v[60:63], a[8:11], v[32:35], v[60:63]
v_mfma_f32_16x16x32_bf16 v[64:67], a[12:15], v[32:35], v[64:67]
v_mfma_f32_16x16x32_bf16 v[52:55], a[16:19], v[36:39], v[52:55]
v_mfma_f32_16x16x32_bf16 v[56:59], a[20:23], v[36:39], v[56:59]
v_mfma_f32_16x16x32_bf16 v[60:63], a[16:19], v[40:43], v[60:63]
v_mfma_f32_16x16x32_bf16 v[64:67], a[20:23], v[40:43], v[64:67]
v_mfma_f32_16x16x32_bf16 v[52:55], a[24:27], v[44:47], v[52:55]
v_mfma_f32_16x16x32_bf16 v[56:59], a[28:31], v[44:47], v[56:59]
v_mfma_f32_16x16x32_bf16 v[60:63], a[24:27], v[48:51], v[60:63]
v_mfma_f32_16x16x32_bf16 v[64:67], a[28:31], v[48:51], v[64:67]
s_waitcnt vmcnt(18)
ds_read_b64_tr_b16 a[32:33], v17 offset:8192
ds_read_b64_tr_b16 a[34:35], v17 offset:8448
ds_read_b64_tr_b16 a[36:37], v17 offset:8200
ds_read_b64_tr_b16 a[38:39], v17 offset:8456
ds_read_b64_tr_b16 a[40:41], v17 offset:10240
ds_read_b64_tr_b16 a[42:43], v17 offset:10496
ds_read_b64_tr_b16 a[44:45], v17 offset:10248
ds_read_b64_tr_b16 a[46:47], v17 offset:10504
s_waitcnt lgkmcnt(0)
ds_read_b64_tr_b16 a[48:49], v17 offset:12288
ds_read_b64_tr_b16 a[50:51], v17 offset:12544
ds_read_b64_tr_b16 a[52:53], v17 offset:12296
ds_read_b64_tr_b16 a[54:55], v17 offset:12552
ds_read_b64_tr_b16 a[56:57], v17 offset:14336
ds_read_b64_tr_b16 a[58:59], v17 offset:14592
ds_read_b64_tr_b16 a[60:61], v17 offset:14344
ds_read_b64_tr_b16 a[62:63], v17 offset:14600
s_waitcnt lgkmcnt(0)
s_mov_b32 s44, 4194304
buffer_load_dword v250, v12, s[4:7], s44 offen
s_add_u32 m0, s45, 8192
s_mov_b32 s44, 4194304
buffer_load_dwordx4 v16, s[4:7], s44 offen lds
s_add_u32 m0, s45, 9216
s_mov_b32 s44, 4325376
buffer_load_dwordx4 v16, s[4:7], s44 offen lds
s_add_u32 m0, s45, 10240
s_mov_b32 s44, 4456448
buffer_load_dwordx4 v16, s[4:7], s44 offen lds
s_add_u32 m0, s45, 11264
s_mov_b32 s44, 4587520
buffer_load_dwordx4 v16, s[4:7], s44 offen lds
s_add_u32 m0, s45, 12288
s_mov_b32 s44, 4718592
buffer_load_dwordx4 v16, s[4:7], s44 offen lds
s_add_u32 m0, s45, 13312
s_mov_b32 s44, 4849664
buffer_load_dwordx4 v16, s[4:7], s44 offen lds
s_add_u32 m0, s45, 14336
s_mov_b32 s44, 4980736
buffer_load_dwordx4 v16, s[4:7], s44 offen lds
s_add_u32 m0, s45, 15360
s_mov_b32 s44, 5111808
buffer_load_dwordx4 v16, s[4:7], s44 offen lds
ds_read_b128 v[20:23], v8 offset:8192
ds_read_b128 v[24:27], v8 offset:10240
ds_read_b128 v[28:31], v9 offset:8192
ds_read_b128 v[32:35], v9 offset:10240
ds_read_b128 v[36:39], v8 offset:12288
ds_read_b128 v[40:43], v8 offset:14336
ds_read_b128 v[44:47], v9 offset:12288
ds_read_b128 v[48:51], v9 offset:14336
s_waitcnt lgkmcnt(0)
v_mfma_f32_16x16x32_bf16 v[52:55], a[32:35], v[20:23], v[52:55]
v_mfma_f32_16x16x32_bf16 v[56:59], a[36:39], v[20:23], v[56:59]
v_mfma_f32_16x16x32_bf16 v[60:63], a[32:35], v[24:27], v[60:63]
v_mfma_f32_16x16x32_bf16 v[64:67], a[36:39], v[24:27], v[64:67]
v_mfma_f32_16x16x32_bf16 v[52:55], a[40:43], v[28:31], v[52:55]
v_mfma_f32_16x16x32_bf16 v[56:59], a[44:47], v[28:31], v[56:59]
v_mfma_f32_16x16x32_bf16 v[60:63], a[40:43], v[32:35], v[60:63]
v_mfma_f32_16x16x32_bf16 v[64:67], a[44:47], v[32:35], v[64:67]
v_mfma_f32_16x16x32_bf16 v[52:55], a[48:51], v[36:39], v[52:55]
v_mfma_f32_16x16x32_bf16 v[56:59], a[52:55], v[36:39], v[56:59]
v_mfma_f32_16x16x32_bf16 v[60:63], a[48:51], v[40:43], v[60:63]
v_mfma_f32_16x16x32_bf16 v[64:67], a[52:55], v[40:43], v[64:67]
v_mfma_f32_16x16x32_bf16 v[52:55], a[56:59], v[44:47], v[52:55]
v_mfma_f32_16x16x32_bf16 v[56:59], a[60:63], v[44:47], v[56:59]
v_mfma_f32_16x16x32_bf16 v[60:63], a[56:59], v[48:51], v[60:63]
v_mfma_f32_16x16x32_bf16 v[64:67], a[60:63], v[48:51], v[64:67]
s_waitcnt vmcnt(18)
ds_read_b64_tr_b16 a[64:65], v17 offset:16384
ds_read_b64_tr_b16 a[66:67], v17 offset:16640
ds_read_b64_tr_b16 a[68:69], v17 offset:16392
ds_read_b64_tr_b16 a[70:71], v17 offset:16648
ds_read_b64_tr_b16 a[72:73], v17 offset:18432
ds_read_b64_tr_b16 a[74:75], v17 offset:18688
ds_read_b64_tr_b16 a[76:77], v17 offset:18440
ds_read_b64_tr_b16 a[78:79], v17 offset:18696
s_waitcnt lgkmcnt(0)
ds_read_b64_tr_b16 a[80:81], v17 offset:20480
ds_read_b64_tr_b16 a[82:83], v17 offset:20736
ds_read_b64_tr_b16 a[84:85], v17 offset:20488
ds_read_b64_tr_b16 a[86:87], v17 offset:20744
ds_read_b64_tr_b16 a[88:89], v17 offset:22528
ds_read_b64_tr_b16 a[90:91], v17 offset:22784
ds_read_b64_tr_b16 a[92:93], v17 offset:22536
ds_read_b64_tr_b16 a[94:95], v17 offset:22792
s_waitcnt lgkmcnt(0)
s_mov_b32 s44, 5242880
buffer_load_dword v250, v12, s[4:7], s44 offen
s_add_u32 m0, s45, 16384
s_mov_b32 s44, 5242880
buffer_load_dwordx4 v16, s[4:7], s44 offen lds
s_add_u32 m0, s45, 17408
s_mov_b32 s44, 5373952
buffer_load_dwordx4 v16, s[4:7], s44 offen lds
s_add_u32 m0, s45, 18432
s_mov_b32 s44, 5505024
buffer_load_dwordx4 v16, s[4:7], s44 offen lds
s_add_u32 m0, s45, 19456
s_mov_b32 s44, 5636096
buffer_load_dwordx4 v16, s[4:7], s44 offen lds
s_add_u32 m0, s45, 20480
s_mov_b32 s44, 5767168
buffer_load_dwordx4 v16, s[4:7], s44 offen lds
s_add_u32 m0, s45, 21504
s_mov_b32 s44, 5898240
buffer_load_dwordx4 v16, s[4:7], s44 offen lds
s_add_u32 m0, s45, 22528
s_mov_b32 s44, 6029312
buffer_load_dwordx4 v16, s[4:7], s44 offen lds
s_add_u32 m0, s45, 23552
s_mov_b32 s44, 6160384
buffer_load_dwordx4 v16, s[4:7], s44 offen lds
ds_read_b128 v[20:23], v8 offset:16384
ds_read_b128 v[24:27], v8 offset:18432
ds_read_b128 v[28:31], v9 offset:16384
ds_read_b128 v[32:35], v9 offset:18432
ds_read_b128 v[36:39], v8 offset:20480
ds_read_b128 v[40:43], v8 offset:22528
ds_read_b128 v[44:47], v9 offset:20480
ds_read_b128 v[48:51], v9 offset:22528
s_waitcnt lgkmcnt(0)
v_mfma_f32_16x16x32_bf16 v[52:55], a[64:67], v[20:23], v[52:55]
v_mfma_f32_16x16x32_bf16 v[56:59], a[68:71], v[20:23], v[56:59]
v_mfma_f32_16x16x32_bf16 v[60:63], a[64:67], v[24:27], v[60:63]
v_mfma_f32_16x16x32_bf16 v[64:67], a[68:71], v[24:27], v[64:67]
v_mfma_f32_16x16x32_bf16 v[52:55], a[72:75], v[28:31], v[52:55]
v_mfma_f32_16x16x32_bf16 v[56:59], a[76:79], v[28:31], v[56:59]
v_mfma_f32_16x16x32_bf16 v[60:63], a[72:75], v[32:35], v[60:63]
v_mfma_f32_16x16x32_bf16 v[64:67], a[76:79], v[32:35], v[64:67]
v_mfma_f32_16x16x32_bf16 v[52:55], a[80:83], v[36:39], v[52:55]
v_mfma_f32_16x16x32_bf16 v[56:59], a[84:87], v[36:39], v[56:59]
v_mfma_f32_16x16x32_bf16 v[60:63], a[80:83], v[40:43], v[60:63]
v_mfma_f32_16x16x32_bf16 v[64:67], a[84:87], v[40:43], v[64:67]
v_mfma_f32_16x16x32_bf16 v[52:55], a[88:91], v[44:47], v[52:55]
v_mfma_f32_16x16x32_bf16 v[56:59], a[92:95], v[44:47], v[56:59]
v_mfma_f32_16x16x32_bf16 v[60:63], a[88:91], v[48:51], v[60:63]
v_mfma_f32_16x16x32_bf16 v[64:67], a[92:95], v[48:51], v[64:67]
s_waitcnt vmcnt(18)
ds_read_b64_tr_b16 a[96:97], v17 offset:0
ds_read_b64_tr_b16 a[98:99], v17 offset:256
ds_read_b64_tr_b16 a[100:101], v17 offset:8
ds_read_b64_tr_b16 a[102:103], v17 offset:264
ds_read_b64_tr_b16 a[104:105], v17 offset:2048
ds_read_b64_tr_b16 a[106:107], v17 offset:2304
ds_read_b64_tr_b16 a[108:109], v17 offset:2056
ds_read_b64_tr_b16 a[110:111], v17 offset:2312
s_waitcnt lgkmcnt(0)
ds_read_b64_tr_b16 a[112:113], v17 offset:4096
ds_read_b64_tr_b16 a[114:115], v17 offset:4352
ds_read_b64_tr_b16 a[116:117], v17 offset:4104
ds_read_b64_tr_b16 a[118:119], v17 offset:4360
ds_read_b64_tr_b16 a[120:121], v17 offset:6144
ds_read_b64_tr_b16 a[122:123], v17 offset:6400
ds_read_b64_tr_b16 a[124:125], v17 offset:6152
ds_read_b64_tr_b16 a[126:127], v17 offset:6408
s_waitcnt lgkmcnt(0)
s_mov_b32 s44, 6291456
buffer_load_dword v250, v12, s[4:7], s44 offen
s_add_u32 m0, s45, 0
s_mov_b32 s44, 6291456
buffer_load_dwordx4 v16, s[4:7], s44 offen lds
s_add_u32 m0, s45, 1024
s_mov_b32 s44, 6422528
buffer_load_dwordx4 v16, s[4:7], s44 offen lds
s_add_u32 m0, s45, 2048
s_mov_b32 s44, 6553600
buffer_load_dwordx4 v16, s[4:7], s44 offen lds
s_add_u32 m0, s45, 3072
s_mov_b32 s44, 6684672
buffer_load_dwordx4 v16, s[4:7], s44 offen lds
s_add_u32 m0, s45, 4096
s_mov_b32 s44, 6815744
buffer_load_dwordx4 v16, s[4:7], s44 offen lds
s_add_u32 m0, s45, 5120
s_mov_b32 s44, 6946816
buffer_load_dwordx4 v16, s[4:7], s44 offen lds
s_add_u32 m0, s45, 6144
s_mov_b32 s44, 7077888
buffer_load_dwordx4 v16, s[4:7], s44 offen lds
s_add_u32 m0, s45, 7168
s_mov_b32 s44, 7208960
buffer_load_dwordx4 v16, s[4:7], s44 offen lds
ds_read_b128 v[20:23], v8 offset:24576
ds_read_b128 v[24:27], v8 offset:26624
ds_read_b128 v[28:31], v9 offset:24576
ds_read_b128 v[32:35], v9 offset:26624
ds_read_b128 v[36:39], v8 offset:28672
ds_read_b128 v[40:43], v8 offset:30720
ds_read_b128 v[44:47], v9 offset:28672
ds_read_b128 v[48:51], v9 offset:30720
s_waitcnt lgkmcnt(0)
v_mfma_f32_16x16x32_bf16 v[52:55], a[96:99], v[20:23], v[52:55]
v_mfma_f32_16x16x32_bf16 v[56:59], a[100:103], v[20:23], v[56:59]
v_mfma_f32_16x16x32_bf16 v[60:63], a[96:99], v[24:27], v[60:63]
v_mfma_f32_16x16x32_bf16 v[64:67], a[100:103], v[24:27], v[64:67]
v_mfma_f32_16x16x32_bf16 v[52:55], a[104:107], v[28:31], v[52:55]
v_mfma_f32_16x16x32_bf16 v[56:59], a[108:111], v[28:31], v[56:59]
v_mfma_f32_16x16x32_bf16 v[60:63], a[104:107], v[32:35], v[60:63]
v_mfma_f32_16x16x32_bf16 v[64:67], a[108:111], v[32:35], v[64:67]
v_mfma_f32_16x16x32_bf16 v[52:55], a[112:115], v[36:39], v[52:55]
v_mfma_f32_16x16x32_bf16 v[56:59], a[116:119], v[36:39], v[56:59]
v_mfma_f32_16x16x32_bf16 v[60:63], a[112:115], v[40:43], v[60:63]
v_mfma_f32_16x16x32_bf16 v[64:67], a[116:119], v[40:43], v[64:67]
v_mfma_f32_16x16x32_bf16 v[52:55], a[120:123], v[44:47], v[52:55]
v_mfma_f32_16x16x32_bf16 v[56:59], a[124:127], v[44:47], v[56:59]
v_mfma_f32_16x16x32_bf16 v[60:63], a[120:123], v[48:51], v[60:63]
v_mfma_f32_16x16x32_bf16 v[64:67], a[124:127], v[48:51], v[64:67]
s_waitcnt vmcnt(18)
ds_read_b64_tr_b16 a[128:129], v17 offset:8192
ds_read_b64_tr_b16 a[130:131], v17 offset:8448
ds_read_b64_tr_b16 a[132:133], v17 offset:8200
ds_read_b64_tr_b16 a[134:135], v17 offset:8456
ds_read_b64_tr_b16 a[136:137], v17 offset:10240
ds_read_b64_tr_b16 a[138:139], v17 offset:10496
ds_read_b64_tr_b16 a[140:141], v17 offset:10248
ds_read_b64_tr_b16 a[142:143], v17 offset:10504
s_waitcnt lgkmcnt(0)
ds_read_b64_tr_b16 a[144:145], v17 offset:12288
ds_read_b64_tr_b16 a[146:147], v17 offset:12544
ds_read_b64_tr_b16 a[148:149], v17 offset:12296
ds_read_b64_tr_b16 a[150:151], v17 offset:12552
ds_read_b64_tr_b16 a[152:153], v17 offset:14336
ds_read_b64_tr_b16 a[154:155], v17 offset:14592
ds_read_b64_tr_b16 a[156:157], v17 offset:14344
ds_read_b64_tr_b16 a[158:159], v17 offset:14600
s_waitcnt lgkmcnt(0)
s_mov_b32 s44, 7340032
buffer_load_dword v250, v12, s[4:7], s44 offen
s_add_u32 m0, s45, 8192
s_mov_b32 s44, 7340032
buffer_load_dwordx4 v16, s[4:7], s44 offen lds
s_add_u32 m0, s45, 9216
s_mov_b32 s44, 7471104
buffer_load_dwordx4 v16, s[4:7], s44 offen lds
s_add_u32 m0, s45, 10240
s_mov_b32 s44, 7602176
buffer_load_dwordx4 v16, s[4:7], s44 offen lds
s_add_u32 m0, s45, 11264
s_mov_b32 s44, 7733248
buffer_load_dwordx4 v16, s[4:7], s44 offen lds
s_add_u32 m0, s45, 12288
s_mov_b32 s44, 7864320
buffer_load_dwordx4 v16, s[4:7], s44 offen lds
s_add_u32 m0, s45, 13312
s_mov_b32 s44, 7995392
buffer_load_dwordx4 v16, s[4:7], s44 offen lds
s_add_u32 m0, s45, 14336
s_mov_b32 s44, 8126464
buffer_load_dwordx4 v16, s[4:7], s44 offen lds
s_add_u32 m0, s45, 15360
s_mov_b32 s44, 8257536
buffer_load_dwordx4 v16, s[4:7], s44 offen lds
ds_read_b128 v[20:23], v8 offset:32768
ds_read_b128 v[24:27], v8 offset:34816
ds_read_b128 v[28:31], v9 offset:32768
ds_read_b128 v[32:35], v9 offset:34816
ds_read_b128 v[36:39], v8 offset:36864
ds_read_b128 v[40:43], v8 offset:38912
ds_read_b128 v[44:47], v9 offset:36864
ds_read_b128 v[48:51], v9 offset:38912
s_waitcnt lgkmcnt(0)
v_mfma_f32_16x16x32_bf16 v[52:55], a[128:131], v[20:23], v[52:55]
v_mfma_f32_16x16x32_bf16 v[56:59], a[132:135], v[20:23], v[56:59]
v_mfma_f32_16x16x32_bf16 v[60:63], a[128:131], v[24:27], v[60:63]
v_mfma_f32_16x16x32_bf16 v[64:67], a[132:135], v[24:27], v[64:67]
v_mfma_f32_16x16x32_bf16 v[52:55], a[136:139], v[28:31], v[52:55]
v_mfma_f32_16x16x32_bf16 v[56:59], a[140:143], v[28:31], v[56:59]
v_mfma_f32_16x16x32_bf16 v[60:63], a[136:139], v[32:35], v[60:63]
v_mfma_f32_16x16x32_bf16 v[64:67], a[140:143], v[32:35], v[64:67]
v_mfma_f32_16x16x32_bf16 v[52:55], a[144:147], v[36:39], v[52:55]
v_mfma_f32_16x16x32_bf16 v[56:59], a[148:151], v[36:39], v[56:59]
v_mfma_f32_16x16x32_bf16 v[60:63], a[144:147], v[40:43], v[60:63]
v_mfma_f32_16x16x32_bf16 v[64:67], a[148:151], v[40:43], v[64:67]
v_mfma_f32_16x16x32_bf16 v[52:55], a[152:155], v[44:47], v[52:55]
v_mfma_f32_16x16x32_bf16 v[56:59], a[156:159], v[44:47], v[56:59]
v_mfma_f32_16x16x32_bf16 v[60:63], a[152:155], v[48:51], v[60:63]
v_mfma_f32_16x16x32_bf16 v[64:67], a[156:159], v[48:51], v[64:67]
s_waitcnt vmcnt(18)
ds_read_b64_tr_b16 a[160:161], v17 offset:16384
ds_read_b64_tr_b16 a[162:163], v17 offset:16640
ds_read_b64_tr_b16 a[164:165], v17 offset:16392
ds_read_b64_tr_b16 a[166:167], v17 offset:16648
ds_read_b64_tr_b16 a[168:169], v17 offset:18432
ds_read_b64_tr_b16 a[170:171], v17 offset:18688
ds_read_b64_tr_b16 a[172:173], v17 offset:18440
ds_read_b64_tr_b16 a[174:175], v17 offset:18696
s_waitcnt lgkmcnt(0)
ds_read_b64_tr_b16 a[176:177], v17 offset:20480
ds_read_b64_tr_b16 a[178:179], v17 offset:20736
ds_read_b64_tr_b16 a[180:181], v17 offset:20488
ds_read_b64_tr_b16 a[182:183], v17 offset:20744
ds_read_b64_tr_b16 a[184:185], v17 offset:22528
ds_read_b64_tr_b16 a[186:187], v17 offset:22784
ds_read_b64_tr_b16 a[188:189], v17 offset:22536
ds_read_b64_tr_b16 a[190:191], v17 offset:22792
s_waitcnt lgkmcnt(0)
ds_read_b128 v[20:23], v8 offset:40960
ds_read_b128 v[24:27], v8 offset:43008
ds_read_b128 v[28:31], v9 offset:40960
ds_read_b128 v[32:35], v9 offset:43008
ds_read_b128 v[36:39], v8 offset:45056
ds_read_b128 v[40:43], v8 offset:47104
ds_read_b128 v[44:47], v9 offset:45056
ds_read_b128 v[48:51], v9 offset:47104
s_waitcnt lgkmcnt(0)
v_mfma_f32_16x16x32_bf16 v[52:55], a[160:163], v[20:23], v[52:55]
v_mfma_f32_16x16x32_bf16 v[56:59], a[164:167], v[20:23], v[56:59]
v_mfma_f32_16x16x32_bf16 v[60:63], a[160:163], v[24:27], v[60:63]
v_mfma_f32_16x16x32_bf16 v[64:67], a[164:167], v[24:27], v[64:67]
v_mfma_f32_16x16x32_bf16 v[52:55], a[168:171], v[28:31], v[52:55]
v_mfma_f32_16x16x32_bf16 v[56:59], a[172:175], v[28:31], v[56:59]
v_mfma_f32_16x16x32_bf16 v[60:63], a[168:171], v[32:35], v[60:63]
v_mfma_f32_16x16x32_bf16 v[64:67], a[172:175], v[32:35], v[64:67]
v_mfma_f32_16x16x32_bf16 v[52:55], a[176:179], v[36:39], v[52:55]
v_mfma_f32_16x16x32_bf16 v[56:59], a[180:183], v[36:39], v[56:59]
v_mfma_f32_16x16x32_bf16 v[60:63], a[176:179], v[40:43], v[60:63]
v_mfma_f32_16x16x32_bf16 v[64:67], a[180:183], v[40:43], v[64:67]
v_mfma_f32_16x16x32_bf16 v[52:55], a[184:187], v[44:47], v[52:55]
v_mfma_f32_16x16x32_bf16 v[56:59], a[188:191], v[44:47], v[56:59]
v_mfma_f32_16x16x32_bf16 v[60:63], a[184:187], v[48:51], v[60:63]
v_mfma_f32_16x16x32_bf16 v[64:67], a[188:191], v[48:51], v[64:67]
s_waitcnt vmcnt(9)
ds_read_b64_tr_b16 a[192:193], v17 offset:0
ds_read_b64_tr_b16 a[194:195], v17 offset:256
ds_read_b64_tr_b16 a[196:197], v17 offset:8
ds_read_b64_tr_b16 a[198:199], v17 offset:264
ds_read_b64_tr_b16 a[200:201], v17 offset:2048
ds_read_b64_tr_b16 a[202:203], v17 offset:2304
ds_read_b64_tr_b16 a[204:205], v17 offset:2056
ds_read_b64_tr_b16 a[206:207], v17 offset:2312
s_waitcnt lgkmcnt(0)
ds_read_b64_tr_b16 a[208:209], v17 offset:4096
ds_read_b64_tr_b16 a[210:211], v17 offset:4352
ds_read_b64_tr_b16 a[212:213], v17 offset:4104
ds_read_b64_tr_b16 a[214:215], v17 offset:4360
ds_read_b64_tr_b16 a[216:217], v17 offset:6144
ds_read_b64_tr_b16 a[218:219], v17 offset:6400
ds_read_b64_tr_b16 a[220:221], v17 offset:6152
ds_read_b64_tr_b16 a[222:223], v17 offset:6408
s_waitcnt lgkmcnt(0)
ds_read_b128 v[20:23], v8 offset:49152
ds_read_b128 v[24:27], v8 offset:51200
ds_read_b128 v[28:31], v9 offset:49152
ds_read_b128 v[32:35], v9 offset:51200
ds_read_b128 v[36:39], v8 offset:53248
ds_read_b128 v[40:43], v8 offset:55296
ds_read_b128 v[44:47], v9 offset:53248
ds_read_b128 v[48:51], v9 offset:55296
s_waitcnt lgkmcnt(0)
v_mfma_f32_16x16x32_bf16 v[52:55], a[192:195], v[20:23], v[52:55]
v_mfma_f32_16x16x32_bf16 v[56:59], a[196:199], v[20:23], v[56:59]
v_mfma_f32_16x16x32_bf16 v[60:63], a[192:195], v[24:27], v[60:63]
v_mfma_f32_16x16x32_bf16 v[64:67], a[196:199], v[24:27], v[64:67]
v_mfma_f32_16x16x32_bf16 v[52:55], a[200:203], v[28:31], v[52:55]
v_mfma_f32_16x16x32_bf16 v[56:59], a[204:207], v[28:31], v[56:59]
v_mfma_f32_16x16x32_bf16 v[60:63], a[200:203], v[32:35], v[60:63]
v_mfma_f32_16x16x32_bf16 v[64:67], a[204:207], v[32:35], v[64:67]
v_mfma_f32_16x16x32_bf16 v[52:55], a[208:211], v[36:39], v[52:55]
v_mfma_f32_16x16x32_bf16 v[56:59], a[212:215], v[36:39], v[56:59]
v_mfma_f32_16x16x32_bf16 v[60:63], a[208:211], v[40:43], v[60:63]
v_mfma_f32_16x16x32_bf16 v[64:67], a[212:215], v[40:43], v[64:67]
v_mfma_f32_16x16x32_bf16 v[52:55], a[216:219], v[44:47], v[52:55]
v_mfma_f32_16x16x32_bf16 v[56:59], a[220:223], v[44:47], v[56:59]
v_mfma_f32_16x16x32_bf16 v[60:63], a[216:219], v[48:51], v[60:63]
v_mfma_f32_16x16x32_bf16 v[64:67], a[220:223], v[48:51], v[64:67]
s_waitcnt vmcnt(0)
ds_read_b64_tr_b16 a[224:225], v17 offset:8192
ds_read_b64_tr_b16 a[226:227], v17 offset:8448
ds_read_b64_tr_b16 a[228:229], v17 offset:8200
ds_read_b64_tr_b16 a[230:231], v17 offset:8456
ds_read_b64_tr_b16 a[232:233], v17 offset:10240
ds_read_b64_tr_b16 a[234:235], v17 offset:10496
ds_read_b64_tr_b16 a[236:237], v17 offset:10248
ds_read_b64_tr_b16 a[238:239], v17 offset:10504
s_waitcnt lgkmcnt(0)
ds_read_b64_tr_b16 a[240:241], v17 offset:12288
ds_read_b64_tr_b16 a[242:243], v17 offset:12544
ds_read_b64_tr_b16 a[244:245], v17 offset:12296
ds_read_b64_tr_b16 a[246:247], v17 offset:12552
ds_read_b64_tr_b16 a[248:249], v17 offset:14336
ds_read_b64_tr_b16 a[250:251], v17 offset:14592
ds_read_b64_tr_b16 a[252:253], v17 offset:14344
ds_read_b64_tr_b16 a[254:255], v17 offset:14600
s_waitcnt lgkmcnt(0)
ds_read_b128 v[20:23], v8 offset:57344
ds_read_b128 v[24:27], v8 offset:59392
ds_read_b128 v[28:31], v9 offset:57344
ds_read_b128 v[32:35], v9 offset:59392
ds_read_b128 v[36:39], v8 offset:61440
ds_read_b128 v[40:43], v8 offset:63488
ds_read_b128 v[44:47], v9 offset:61440
ds_read_b128 v[48:51], v9 offset:63488
s_waitcnt lgkmcnt(0)
v_mfma_f32_16x16x32_bf16 v[52:55], a[224:227], v[20:23], v[52:55]
v_mfma_f32_16x16x32_bf16 v[56:59], a[228:231], v[20:23], v[56:59]
v_mfma_f32_16x16x32_bf16 v[60:63], a[224:227], v[24:27], v[60:63]
v_mfma_f32_16x16x32_bf16 v[64:67], a[228:231], v[24:27], v[64:67]
v_mfma_f32_16x16x32_bf16 v[52:55], a[232:235], v[28:31], v[52:55]
v_mfma_f32_16x16x32_bf16 v[56:59], a[236:239], v[28:31], v[56:59]
v_mfma_f32_16x16x32_bf16 v[60:63], a[232:235], v[32:35], v[60:63]
v_mfma_f32_16x16x32_bf16 v[64:67], a[236:239], v[32:35], v[64:67]
v_mfma_f32_16x16x32_bf16 v[52:55], a[240:243], v[36:39], v[52:55]
v_mfma_f32_16x16x32_bf16 v[56:59], a[244:247], v[36:39], v[56:59]
v_mfma_f32_16x16x32_bf16 v[60:63], a[240:243], v[40:43], v[60:63]
v_mfma_f32_16x16x32_bf16 v[64:67], a[244:247], v[40:43], v[64:67]
v_mfma_f32_16x16x32_bf16 v[52:55], a[248:251], v[44:47], v[52:55]
v_mfma_f32_16x16x32_bf16 v[56:59], a[252:255], v[44:47], v[56:59]
v_mfma_f32_16x16x32_bf16 v[60:63], a[248:251], v[48:51], v[60:63]
v_mfma_f32_16x16x32_bf16 v[64:67], a[252:255], v[48:51], v[64:67]
s_barrier
s_mov_b32 s50, 0x10000
s_add_u32 m0, s46, 65536
s_nop 0
buffer_load_dwordx4 v6, s[8:11], s50 offen offset:0 lds
s_add_u32 m0, s46, 69504
s_nop 0
buffer_load_dwordx4 v6, s[8:11], s50 offen offset:128 lds
s_add_u32 m0, s46, 73472
s_nop 0
buffer_load_dwordx4 v6, s[8:11], s50 offen offset:256 lds
s_add_u32 m0, s46, 77440
s_nop 0
buffer_load_dwordx4 v6, s[8:11], s50 offen offset:384 lds
s_add_u32 m0, s46, 81408
s_nop 0
buffer_load_dwordx4 v6, s[8:11], s50 offen offset:512 lds
s_add_u32 m0, s46, 85376
s_nop 0
buffer_load_dwordx4 v6, s[8:11], s50 offen offset:640 lds
s_add_u32 m0, s46, 89344
s_nop 0
buffer_load_dwordx4 v6, s[8:11], s50 offen offset:768 lds
s_add_u32 m0, s46, 93312
s_nop 0
buffer_load_dwordx4 v6, s[8:11], s50 offen offset:896 lds
s_add_u32 m0, s46, 97280
s_nop 0
buffer_load_dwordx4 v6, s[8:11], s50 offen offset:1024 lds
s_add_u32 m0, s46, 101248
s_nop 0
buffer_load_dwordx4 v6, s[8:11], s50 offen offset:1152 lds
s_add_u32 m0, s46, 105216
s_nop 0
buffer_load_dwordx4 v6, s[8:11], s50 offen offset:1280 lds
s_add_u32 m0, s46, 109184
s_nop 0
buffer_load_dwordx4 v6, s[8:11], s50 offen offset:1408 lds
s_add_u32 m0, s46, 113152
s_nop 0
buffer_load_dwordx4 v6, s[8:11], s50 offen offset:1536 lds
s_add_u32 m0, s46, 117120
s_nop 0
buffer_load_dwordx4 v6, s[8:11], s50 offen offset:1664 lds
s_add_u32 m0, s46, 121088
s_nop 0
buffer_load_dwordx4 v6, s[8:11], s50 offen offset:1792 lds
s_add_u32 m0, s46, 125056
s_nop 0
buffer_load_dwordx4 v6, s[8:11], s50 offen offset:1920 lds
v_and_b32 v3, 15, v0
v_lshlrev_b32 v3, 4, v3
s_branch mega_kernel_syc
mega_kernel_sycw:
s_sleep 4
mega_kernel_syc:
buffer_load_dword v2, v3, s[72:75], 0 offen sc1
s_waitcnt vmcnt(0)
mega_kernel_sycp:
s_cmp_eq_u32 s95, 1
s_cbranch_scc0 mega_kernel_sycf
v_readlane_b32 s76, v2, 14
s_mov_b32 s98, 0
s_cmp_eq_u32 s76, 32
s_cbranch_scc0 mega_kernel_sycw
s_branch mega_kernel_sycd
mega_kernel_sycf:
s_mov_b32 s77, 0
s_mov_b32 s78, 0
v_readlane_b32 s76, v2, 0
s_add_u32 s77, s77, s76
s_xor_b32 s76, s76, 32
s_or_b32 s78, s78, s76
v_readlane_b32 s76, v2, 1
s_add_u32 s77, s77, s76
s_xor_b32 s76, s76, 32
s_or_b32 s78, s78, s76
v_readlane_b32 s76, v2, 2
s_add_u32 s77, s77, s76
s_xor_b32 s76, s76, 32
s_or_b32 s78, s78, s76
v_readlane_b32 s76, v2, 3
s_add_u32 s77, s77, s76
s_xor_b32 s76, s76, 32
s_or_b32 s78, s78, s76
v_readlane_b32 s76, v2, 4
s_add_u32 s77, s77, s76
s_xor_b32 s76, s76, 32
s_or_b32 s78, s78, s76
v_readlane_b32 s76, v2, 5
s_add_u32 s77, s77, s76
s_xor_b32 s76, s76, 32
s_or_b32 s78, s78, s76
v_readlane_b32 s76, v2, 6
s_add_u32 s77, s77, s76
s_xor_b32 s76, s76, 32
s_or_b32 s78, s78, s76
v_readlane_b32 s76, v2, 7
s_add_u32 s77, s77, s76
s_xor_b32 s76, s76, 32
s_or_b32 s78, s78, s76
s_cmp_eq_u32 s77, 256
s_cbranch_scc0 mega_kernel_sycw
v_mov_b32 v252, v2
s_cmp_eq_u32 s78, 0
s_cbranch_scc0 mega_kernel_slowent
v_readlane_b32 s76, v2, 10
v_readlane_b32 s77, v2, 8
s_cmp_eq_u32 s76, 32
s_cbranch_scc0 mega_kernel_sycw
s_cmp_gt_u32 s77, 16
s_cselect_b32 s98, 1, 0
mega_kernel_sycd:
v_lshrrev_b32 v92, 4, v1
v_and_b32 v93, 15, v1
s_and_b32 s52, s41, 1
s_lshr_b32 s53, s41, 1
s_mov_b32 s54, 0x3e0293ee
s_mov_b32 s55, 0
s_mov_b32 s56, 0
v_mov_b32 v97, 0xff800000
v_mov_b32 v241, 0xceabdc6e
v_and_b32 v2, 7, v93
v_lshlrev_b32 v94, 7, v92
v_lshl_add_u32 v94, v2, 4, v94
v_and_b32 v2, 31, v1
v_lshlrev_b32 v95, 3, v2
v_lshrrev_b32 v2, 1, v92
v_lshlrev_b32 v96, 10, v2
v_and_b32 v2, 1, v92
v_lshl_add_u32 v96, v2, 9, v96
v_lshl_add_u32 v96, v93, 4, v96
s_lshl_b32 s43, s40, 13
s_lshl_b32 s44, s53, 12
s_add_u32 s43, s43, s44
s_lshl_b32 s44, s52, 8
s_add_u32 s43, s43, s44
s_add_u32 s43, s43, 134217728
v_add_u32 v96, s43, v96
s_lshl_b32 s43, s52, 4
v_add_u32 v98, s43, v93
v_lshlrev_b32 v2, 2, v92
v_sub_u32 v98, v98, v2
s_mov_b32 s28, 0
s_mov_b32 s29, -1
s_xor_b32 s44, s98, 1
s_lshl_b32 s44, s44, 13
s_lshl_b32 s43, s40, 7
s_add_u32 s43, s43, s44
s_add_u32 s43, s43, 69206016
v_and_b32 v2, 3, v1
v_bfe_u32 v3, v1, 2, 1
v_lshlrev_b32 v99, 12, v3
v_lshl_add_u32 v99, v2, 2, v99
v_add_u32 v99, s43, v99
s_xor_b32 s62, s98, 1
s_lshl_b32 s62, s62, 13
s_lshr_b32 s44, s47, 6
s_lshl_b32 s44, s44, 14
s_add_u32 s62, s62, s44
s_and_b32 s44, s47, 63
s_lshl_b32 s44, s44, 7
s_add_u32 s62, s62, s44
s_add_u32 s62, s62, 69222400
s_lshl_b32 s49, s40, 7
s_lshl_b32 s44, s41, 2
s_add_u32 s49, s49, s44
s_lshl_b32 s44, s98, 13
s_add_u32 s49, s49, s44
s_add_u32 s49, s49, 69255168
s_lshl_b32 s43, s41, 11
s_add_u32 s43, s43, 131072
v_add_u32 v101, s43, v7
s_lshl_b32 s43, s52, 10
s_add_u32 s43, s43, 131072
v_add_u32 v102, s43, v5
v_mov_b32 v16, 0
s_mov_b32 s50, 0
v_mov_b32 v104, 0x3f803f80
v_mov_b32 v105, 0x3f803f80
v_mov_b32 v106, 0x3f803f80
v_mov_b32 v107, 0x3f803f80
v_cmp_gt_i32 s[12:13], 0, v98
v_cmp_gt_i32 s[14:15], 1, v98
v_cmp_gt_i32 s[16:17], 2, v98
v_cmp_gt_i32 s[18:19], 3, v98
v_cmp_gt_i32 s[20:21], 16, v98
v_cmp_gt_i32 s[22:23], 17, v98
v_cmp_gt_i32 s[24:25], 18, v98
v_cmp_gt_i32 s[26:27], 19, v98
s_lshr_b32 s44, s47, 3
s_xor_b32 s44, s44, s98
s_and_b32 s44, s44, 1
s_lshl_b32 s44, s44, 13
s_lshl_b32 s58, s47, 18
s_add_u32 s58, s58, s44
s_add_u32 s58, s58, 0
s_lshr_b32 s44, s47, 4
s_xor_b32 s44, s44, s98
s_and_b32 s44, s44, 1
s_lshl_b32 s44, s44, 13
s_lshl_b32 s59, s47, 17
s_add_u32 s59, s59, s44
s_add_u32 s59, s59, 71303168
s_lshl_b32 s60, s41, 11
s_add_u32 s60, s60, 139264
s_lshl_b32 s61, s41, 10
s_add_u32 s61, s61, 155648
v_add_u32 v94, 155648, v94
s_lshl_b32 s43, s53, 11
s_add_u32 s43, s43, 156160
v_add_u32 v95, s43, v95
v_add_u32 v103, 139264, v5
s_lshl_b32 s43, s53, 12
s_add_u32 s43, s43, 147456
v_add_u32 v240, s43, v5
s_waitcnt vmcnt(0)
v_cvt_pk_bf16_f32 v220, v52, v53
v_cvt_pk_bf16_f32 v221, v54, v55
v_cvt_pk_bf16_f32 v222, v56, v57
v_cvt_pk_bf16_f32 v223, v58, v59
v_cvt_pk_bf16_f32 v224, v60, v61
v_cvt_pk_bf16_f32 v225, v62, v63
v_cvt_pk_bf16_f32 v226, v64, v65
v_cvt_pk_bf16_f32 v227, v66, v67
s_barrier
s_mov_b32 s50, 0x20000
ds_read_b128 v[20:23], v10 offset:0
ds_read_b128 v[24:27], v10 offset:2048
ds_read_b128 v[28:31], v11 offset:0
ds_read_b128 v[32:35], v11 offset:2048
ds_read_b128 v[36:39], v10 offset:4096
ds_read_b128 v[40:43], v10 offset:6144
s_add_u32 m0, s46, 0
s_waitcnt lgkmcnt(4)
v_mfma_f32_16x16x32_bf16 v[52:55], a[0:3], v[20:23], 0
ds_read_b128 v[44:47], v11 offset:4096
v_mfma_f32_16x16x32_bf16 v[56:59], a[4:7], v[20:23], 0
buffer_load_dwordx4 v6, s[8:11], s50 offen offset:0 lds
v_mfma_f32_16x16x32_bf16 v[60:63], a[0:3], v[24:27], 0
ds_read_b128 v[48:51], v11 offset:6144
v_mfma_f32_16x16x32_bf16 v[64:67], a[4:7], v[24:27], 0
s_add_u32 m0, s46, 3968
s_waitcnt lgkmcnt(4)
v_mfma_f32_16x16x32_bf16 v[52:55], a[8:11], v[28:31], v[52:55]
ds_read_b128 v[20:23], v10 offset:8192
v_mfma_f32_16x16x32_bf16 v[56:59], a[12:15], v[28:31], v[56:59]
buffer_load_dwordx4 v6, s[8:11], s50 offen offset:128 lds
v_mfma_f32_16x16x32_bf16 v[60:63], a[8:11], v[32:35], v[60:63]
ds_read_b128 v[24:27], v10 offset:10240
v_mfma_f32_16x16x32_bf16 v[64:67], a[12:15], v[32:35], v[64:67]
s_add_u32 m0, s46, 7936
s_waitcnt lgkmcnt(4)
v_mfma_f32_16x16x32_bf16 v[52:55], a[16:19], v[36:39], v[52:55]
ds_read_b128 v[28:31], v11 offset:8192
v_mfma_f32_16x16x32_bf16 v[56:59], a[20:23], v[36:39], v[56:59]
buffer_load_dwordx4 v6, s[8:11], s50 offen offset:256 lds
v_mfma_f32_16x16x32_bf16 v[60:63], a[16:19], v[40:43], v[60:63]
ds_read_b128 v[32:35], v11 offset:10240
v_mfma_f32_16x16x32_bf16 v[64:67], a[20:23], v[40:43], v[64:67]
s_add_u32 m0, s46, 11904
s_waitcnt lgkmcnt(4)
v_mfma_f32_16x16x32_bf16 v[52:55], a[24:27], v[44:47], v[52:55]
ds_read_b128 v[36:39], v10 offset:12288
v_mfma_f32_16x16x32_bf16 v[56:59], a[28:31], v[44:47], v[56:59]
buffer_load_dwordx4 v6, s[8:11], s50 offen offset:384 lds
v_mfma_f32_16x16x32_bf16 v[60:63], a[24:27], v[48:51], v[60:63]
ds_read_b128 v[40:43], v10 offset:14336
v_mfma_f32_16x16x32_bf16 v[64:67], a[28:31], v[48:51], v[64:67]
s_add_u32 m0, s46, 15872
s_waitcnt lgkmcnt(4)
v_mfma_f32_16x16x32_bf16 v[52:55], a[32:35], v[20:23], v[52:55]
ds_read_b128 v[44:47], v11 offset:12288
v_mfma_f32_16x16x32_bf16 v[56:59], a[36:39], v[20:23], v[56:59]
buffer_load_dwordx4 v6, s[8:11], s50 offen offset:512 lds
v_mfma_f32_16x16x32_bf16 v[60:63], a[32:35], v[24:27], v[60:63]
ds_read_b128 v[48:51], v11 offset:14336
v_mfma_f32_16x16x32_bf16 v[64:67], a[36:39], v[24:27], v[64:67]
s_add_u32 m0, s46, 19840
s_waitcnt lgkmcnt(4)
v_mfma_f32_16x16x32_bf16 v[52:55], a[40:43], v[28:31], v[52:55]
ds_read_b128 v[20:23], v10 offset:16384
v_mfma_f32_16x16x32_bf16 v[56:59], a[44:47], v[28:31], v[56:59]
buffer_load_dwordx4 v6, s[8:11], s50 offen offset:640 lds
v_mfma_f32_16x16x32_bf16 v[60:63], a[40:43], v[32:35], v[60:63]
ds_read_b128 v[24:27], v10 offset:18432
v_mfma_f32_16x16x32_bf16 v[64:67], a[44:47], v[32:35], v[64:67]
s_add_u32 m0, s46, 23808
s_waitcnt lgkmcnt(4)
v_mfma_f32_16x16x32_bf16 v[52:55], a[48:51], v[36:39], v[52:55]
ds_read_b128 v[28:31], v11 offset:16384
v_mfma_f32_16x16x32_bf16 v[56:59], a[52:55], v[36:39], v[56:59]
buffer_load_dwordx4 v6, s[8:11], s50 offen offset:768 lds
v_mfma_f32_16x16x32_bf16 v[60:63], a[48:51], v[40:43], v[60:63]
ds_read_b128 v[32:35], v11 offset:18432
v_mfma_f32_16x16x32_bf16 v[64:67], a[52:55], v[40:43], v[64:67]
s_add_u32 m0, s46, 27776
s_waitcnt lgkmcnt(4)
v_mfma_f32_16x16x32_bf16 v[52:55], a[56:59], v[44:47], v[52:55]
ds_read_b128 v[36:39], v10 offset:20480
v_mfma_f32_16x16x32_bf16 v[56:59], a[60:63], v[44:47], v[56:59]
buffer_load_dwordx4 v6, s[8:11], s50 offen offset:896 lds
v_mfma_f32_16x16x32_bf16 v[60:63], a[56:59], v[48:51], v[60:63]
ds_read_b128 v[40:43], v10 offset:22528
v_mfma_f32_16x16x32_bf16 v[64:67], a[60:63], v[48:51], v[64:67]
s_add_u32 m0, s46, 31744
s_waitcnt lgkmcnt(4)
v_mfma_f32_16x16x32_bf16 v[52:55], a[64:67], v[20:23], v[52:55]
ds_read_b128 v[44:47], v11 offset:20480
v_mfma_f32_16x16x32_bf16 v[56:59], a[68:71], v[20:23], v[56:59]
buffer_load_dwordx4 v6, s[8:11], s50 offen offset:1024 lds
v_mfma_f32_16x16x32_bf16 v[60:63], a[64:67], v[24:27], v[60:63]
ds_read_b128 v[48:51], v11 offset:22528
v_mfma_f32_16x16x32_bf16 v[64:67], a[68:71], v[24:27], v[64:67]
s_add_u32 m0, s46, 35712
s_waitcnt lgkmcnt(4)
v_mfma_f32_16x16x32_bf16 v[52:55], a[72:75], v[28:31], v[52:55]
ds_read_b128 v[20:23], v10 offset:24576
v_mfma_f32_16x16x32_bf16 v[56:59], a[76:79], v[28:31], v[56:59]
buffer_load_dwordx4 v6, s[8:11], s50 offen offset:1152 lds
v_mfma_f32_16x16x32_bf16 v[60:63], a[72:75], v[32:35], v[60:63]
ds_read_b128 v[24:27], v10 offset:26624
v_mfma_f32_16x16x32_bf16 v[64:67], a[76:79], v[32:35], v[64:67]
s_add_u32 m0, s46, 39680
s_waitcnt lgkmcnt(4)
v_mfma_f32_16x16x32_bf16 v[52:55], a[80:83], v[36:39], v[52:55]
ds_read_b128 v[28:31], v11 offset:24576
v_mfma_f32_16x16x32_bf16 v[56:59], a[84:87], v[36:39], v[56:59]
buffer_load_dwordx4 v6, s[8:11], s50 offen offset:1280 lds
v_mfma_f32_16x16x32_bf16 v[60:63], a[80:83], v[40:43], v[60:63]
ds_read_b128 v[32:35], v11 offset:26624
v_mfma_f32_16x16x32_bf16 v[64:67], a[84:87], v[40:43], v[64:67]
s_add_u32 m0, s46, 43648
s_waitcnt lgkmcnt(4)
v_mfma_f32_16x16x32_bf16 v[52:55], a[88:91], v[44:47], v[52:55]
ds_read_b128 v[36:39], v10 offset:28672
v_mfma_f32_16x16x32_bf16 v[56:59], a[92:95], v[44:47], v[56:59]
buffer_load_dwordx4 v6, s[8:11], s50 offen offset:1408 lds
v_mfma_f32_16x16x32_bf16 v[60:63], a[88:91], v[48:51], v[60:63]
ds_read_b128 v[40:43], v10 offset:30720
v_mfma_f32_16x16x32_bf16 v[64:67], a[92:95], v[48:51], v[64:67]
s_add_u32 m0, s46, 47616
s_waitcnt lgkmcnt(4)
v_mfma_f32_16x16x32_bf16 v[52:55], a[96:99], v[20:23], v[52:55]
ds_read_b128 v[44:47], v11 offset:28672
v_mfma_f32_16x16x32_bf16 v[56:59], a[100:103], v[20:23], v[56:59]
buffer_load_dwordx4 v6, s[8:11], s50 offen offset:1536 lds
v_mfma_f32_16x16x32_bf16 v[60:63], a[96:99], v[24:27], v[60:63]
ds_read_b128 v[48:51], v11 offset:30720
v_mfma_f32_16x16x32_bf16 v[64:67], a[100:103], v[24:27], v[64:67]
s_add_u32 m0, s46, 51584
s_waitcnt lgkmcnt(4)
v_mfma_f32_16x16x32_bf16 v[52:55], a[104:107], v[28:31], v[52:55]
ds_read_b128 v[20:23], v10 offset:32768
v_mfma_f32_16x16x32_bf16 v[56:59], a[108:111], v[28:31], v[56:59]
buffer_load_dwordx4 v6, s[8:11], s50 offen offset:1664 lds
v_mfma_f32_16x16x32_bf16 v[60:63], a[104:107], v[32:35], v[60:63]
ds_read_b128 v[24:27], v10 offset:34816
v_mfma_f32_16x16x32_bf16 v[64:67], a[108:111], v[32:35], v[64:67]
s_add_u32 m0, s46, 55552
s_waitcnt lgkmcnt(4)
v_mfma_f32_16x16x32_bf16 v[52:55], a[112:115], v[36:39], v[52:55]
ds_read_b128 v[28:31], v11 offset:32768
v_mfma_f32_16x16x32_bf16 v[56:59], a[116:119], v[36:39], v[56:59]
buffer_load_dwordx4 v6, s[8:11], s50 offen offset:1792 lds
v_mfma_f32_16x16x32_bf16 v[60:63], a[112:115], v[40:43], v[60:63]
ds_read_b128 v[32:35], v11 offset:34816
v_mfma_f32_16x16x32_bf16 v[64:67], a[116:119], v[40:43], v[64:67]
s_add_u32 m0, s46, 59520
s_waitcnt lgkmcnt(4)
v_mfma_f32_16x16x32_bf16 v[52:55], a[120:123], v[44:47], v[52:55]
ds_read_b128 v[36:39], v10 offset:36864
v_mfma_f32_16x16x32_bf16 v[56:59], a[124:127], v[44:47], v[56:59]
buffer_load_dwordx4 v6, s[8:11], s50 offen offset:1920 lds
v_mfma_f32_16x16x32_bf16 v[60:63], a[120:123], v[48:51], v[60:63]
ds_read_b128 v[40:43], v10 offset:38912
v_mfma_f32_16x16x32_bf16 v[64:67], a[124:127], v[48:51], v[64:67]
s_waitcnt lgkmcnt(4)
v_mfma_f32_16x16x32_bf16 v[52:55], a[128:131], v[20:23], v[52:55]
ds_read_b128 v[44:47], v11 offset:36864
v_mfma_f32_16x16x32_bf16 v[56:59], a[132:135], v[20:23], v[56:59]
v_mfma_f32_16x16x32_bf16 v[60:63], a[128:131], v[24:27], v[60:63]
ds_read_b128 v[48:51], v11 offset:38912
v_mfma_f32_16x16x32_bf16 v[64:67], a[132:135], v[24:27], v[64:67]
s_waitcnt lgkmcnt(4)
v_mfma_f32_16x16x32_bf16 v[52:55], a[136:139], v[28:31], v[52:55]
ds_read_b128 v[20:23], v10 offset:40960
v_mfma_f32_16x16x32_bf16 v[56:59], a[140:143], v[28:31], v[56:59]
v_mfma_f32_16x16x32_bf16 v[60:63], a[136:139], v[32:35], v[60:63]
ds_read_b128 v[24:27], v10 offset:43008
v_mfma_f32_16x16x32_bf16 v[64:67], a[140:143], v[32:35], v[64:67]
s_waitcnt lgkmcnt(4)
v_mfma_f32_16x16x32_bf16 v[52:55], a[144:147], v[36:39], v[52:55]
ds_read_b128 v[28:31], v11 offset:40960
v_mfma_f32_16x16x32_bf16 v[56:59], a[148:151], v[36:39], v[56:59]
v_mfma_f32_16x16x32_bf16 v[60:63], a[144:147], v[40:43], v[60:63]
ds_read_b128 v[32:35], v11 offset:43008
v_mfma_f32_16x16x32_bf16 v[64:67], a[148:151], v[40:43], v[64:67]
s_waitcnt lgkmcnt(4)
v_mfma_f32_16x16x32_bf16 v[52:55], a[152:155], v[44:47], v[52:55]
ds_read_b128 v[36:39], v10 offset:45056
v_mfma_f32_16x16x32_bf16 v[56:59], a[156:159], v[44:47], v[56:59]
v_mfma_f32_16x16x32_bf16 v[60:63], a[152:155], v[48:51], v[60:63]
ds_read_b128 v[40:43], v10 offset:47104
v_mfma_f32_16x16x32_bf16 v[64:67], a[156:159], v[48:51], v[64:67]
s_waitcnt lgkmcnt(4)
v_mfma_f32_16x16x32_bf16 v[52:55], a[160:163], v[20:23], v[52:55]
ds_read_b128 v[44:47], v11 offset:45056
v_mfma_f32_16x16x32_bf16 v[56:59], a[164:167], v[20:23], v[56:59]
v_mfma_f32_16x16x32_bf16 v[60:63], a[160:163], v[24:27], v[60:63]
ds_read_b128 v[48:51], v11 offset:47104
v_mfma_f32_16x16x32_bf16 v[64:67], a[164:167], v[24:27], v[64:67]
s_waitcnt lgkmcnt(4)
v_mfma_f32_16x16x32_bf16 v[52:55], a[168:171], v[28:31], v[52:55]
ds_read_b128 v[20:23], v10 offset:49152
v_mfma_f32_16x16x32_bf16 v[56:59], a[172:175], v[28:31], v[56:59]
v_mfma_f32_16x16x32_bf16 v[60:63], a[168:171], v[32:35], v[60:63]
ds_read_b128 v[24:27], v10 offset:51200
v_mfma_f32_16x16x32_bf16 v[64:67], a[172:175], v[32:35], v[64:67]
s_waitcnt lgkmcnt(4)
v_mfma_f32_16x16x32_bf16 v[52:55], a[176:179], v[36:39], v[52:55]
ds_read_b128 v[28:31], v11 offset:49152
v_mfma_f32_16x16x32_bf16 v[56:59], a[180:183], v[36:39], v[56:59]
v_mfma_f32_16x16x32_bf16 v[60:63], a[176:179], v[40:43], v[60:63]
ds_read_b128 v[32:35], v11 offset:51200
v_mfma_f32_16x16x32_bf16 v[64:67], a[180:183], v[40:43], v[64:67]
s_waitcnt lgkmcnt(4)
v_mfma_f32_16x16x32_bf16 v[52:55], a[184:187], v[44:47], v[52:55]
ds_read_b128 v[36:39], v10 offset:53248
v_mfma_f32_16x16x32_bf16 v[56:59], a[188:191], v[44:47], v[56:59]
v_mfma_f32_16x16x32_bf16 v[60:63], a[184:187], v[48:51], v[60:63]
ds_read_b128 v[40:43], v10 offset:55296
v_mfma_f32_16x16x32_bf16 v[64:67], a[188:191], v[48:51], v[64:67]
s_waitcnt lgkmcnt(4)
v_mfma_f32_16x16x32_bf16 v[52:55], a[192:195], v[20:23], v[52:55]
ds_read_b128 v[44:47], v11 offset:53248
v_mfma_f32_16x16x32_bf16 v[56:59], a[196:199], v[20:23], v[56:59]
v_mfma_f32_16x16x32_bf16 v[60:63], a[192:195], v[24:27], v[60:63]
ds_read_b128 v[48:51], v11 offset:55296
v_mfma_f32_16x16x32_bf16 v[64:67], a[196:199], v[24:27], v[64:67]
s_waitcnt lgkmcnt(4)
v_mfma_f32_16x16x32_bf16 v[52:55], a[200:203], v[28:31], v[52:55]
ds_read_b128 v[20:23], v10 offset:57344
v_mfma_f32_16x16x32_bf16 v[56:59], a[204:207], v[28:31], v[56:59]
v_mfma_f32_16x16x32_bf16 v[60:63], a[200:203], v[32:35], v[60:63]
ds_read_b128 v[24:27], v10 offset:59392
v_mfma_f32_16x16x32_bf16 v[64:67], a[204:207], v[32:35], v[64:67]
s_waitcnt lgkmcnt(4)
v_mfma_f32_16x16x32_bf16 v[52:55], a[208:211], v[36:39], v[52:55]
ds_read_b128 v[28:31], v11 offset:57344
v_mfma_f32_16x16x32_bf16 v[56:59], a[212:215], v[36:39], v[56:59]
v_mfma_f32_16x16x32_bf16 v[60:63], a[208:211], v[40:43], v[60:63]
ds_read_b128 v[32:35], v11 offset:59392
v_mfma_f32_16x16x32_bf16 v[64:67], a[212:215], v[40:43], v[64:67]
s_waitcnt lgkmcnt(4)
v_mfma_f32_16x16x32_bf16 v[52:55], a[216:219], v[44:47], v[52:55]
ds_read_b128 v[36:39], v10 offset:61440
v_mfma_f32_16x16x32_bf16 v[56:59], a[220:223], v[44:47], v[56:59]
v_mfma_f32_16x16x32_bf16 v[60:63], a[216:219], v[48:51], v[60:63]
ds_read_b128 v[40:43], v10 offset:63488
v_mfma_f32_16x16x32_bf16 v[64:67], a[220:223], v[48:51], v[64:67]
s_waitcnt lgkmcnt(4)
v_mfma_f32_16x16x32_bf16 v[52:55], a[224:227], v[20:23], v[52:55]
ds_read_b128 v[44:47], v11 offset:61440
v_mfma_f32_16x16x32_bf16 v[56:59], a[228:231], v[20:23], v[56:59]
v_mfma_f32_16x16x32_bf16 v[60:63], a[224:227], v[24:27], v[60:63]
ds_read_b128 v[48:51], v11 offset:63488
v_mfma_f32_16x16x32_bf16 v[64:67], a[228:231], v[24:27], v[64:67]
s_waitcnt lgkmcnt(5)
v_mfma_f32_16x16x32_bf16 v[52:55], a[232:235], v[28:31], v[52:55]
v_mfma_f32_16x16x32_bf16 v[56:59], a[236:239], v[28:31], v[56:59]
s_waitcnt lgkmcnt(4)
v_mfma_f32_16x16x32_bf16 v[60:63], a[232:235], v[32:35], v[60:63]
v_mfma_f32_16x16x32_bf16 v[64:67], a[236:239], v[32:35], v[64:67]
s_waitcnt lgkmcnt(3)
v_mfma_f32_16x16x32_bf16 v[52:55], a[240:243], v[36:39], v[52:55]
v_mfma_f32_16x16x32_bf16 v[56:59], a[244:247], v[36:39], v[56:59]
s_waitcnt lgkmcnt(2)
v_mfma_f32_16x16x32_bf16 v[60:63], a[240:243], v[40:43], v[60:63]
v_mfma_f32_16x16x32_bf16 v[64:67], a[244:247], v[40:43], v[64:67]
s_waitcnt lgkmcnt(1)
v_mfma_f32_16x16x32_bf16 v[52:55], a[248:251], v[44:47], v[52:55]
v_mfma_f32_16x16x32_bf16 v[56:59], a[252:255], v[44:47], v[56:59]
s_waitcnt lgkmcnt(0)
v_mfma_f32_16x16x32_bf16 v[60:63], a[248:251], v[48:51], v[60:63]
v_mfma_f32_16x16x32_bf16 v[64:67], a[252:255], v[48:51], v[64:67]
s_waitcnt vmcnt(0)
s_barrier
s_mov_b32 s50, 0x30000
s_nop 5
v_cvt_pk_bf16_f32 v228, v52, v53
v_cvt_pk_bf16_f32 v229, v54, v55
v_cvt_pk_bf16_f32 v230, v56, v57
v_cvt_pk_bf16_f32 v231, v58, v59
v_cvt_pk_bf16_f32 v232, v60, v61
v_cvt_pk_bf16_f32 v233, v62, v63
v_cvt_pk_bf16_f32 v234, v64, v65
v_cvt_pk_bf16_f32 v235, v66, v67
ds_read_b128 v[20:23], v8 offset:0
ds_read_b128 v[24:27], v8 offset:2048
ds_read_b128 v[28:31], v9 offset:0
ds_read_b128 v[32:35], v9 offset:2048
ds_read_b128 v[36:39], v8 offset:4096
ds_read_b128 v[40:43], v8 offset:6144
s_add_u32 m0, s46, 65536
s_waitcnt lgkmcnt(4)
v_mfma_f32_16x16x32_bf16 v[52:55], a[0:3], v[20:23], 0
ds_read_b128 v[44:47], v9 offset:4096
v_mfma_f32_16x16x32_bf16 v[56:59], a[4:7], v[20:23], 0
buffer_load_dwordx4 v6, s[8:11], s50 offen offset:0 lds
v_mfma_f32_16x16x32_bf16 v[60:63], a[0:3], v[24:27], 0
ds_read_b128 v[48:51], v9 offset:6144
v_mfma_f32_16x16x32_bf16 v[64:67], a[4:7], v[24:27], 0
s_add_u32 m0, s46, 69504
s_waitcnt lgkmcnt(4)
v_mfma_f32_16x16x32_bf16 v[52:55], a[8:11], v[28:31], v[52:55]
ds_read_b128 v[20:23], v8 offset:8192
v_mfma_f32_16x16x32_bf16 v[56:59], a[12:15], v[28:31], v[56:59]
buffer_load_dwordx4 v6, s[8:11], s50 offen offset:128 lds
v_mfma_f32_16x16x32_bf16 v[60:63], a[8:11], v[32:35], v[60:63]
ds_read_b128 v[24:27], v8 offset:10240
v_mfma_f32_16x16x32_bf16 v[64:67], a[12:15], v[32:35], v[64:67]
s_add_u32 m0, s46, 73472
s_waitcnt lgkmcnt(4)
v_mfma_f32_16x16x32_bf16 v[52:55], a[16:19], v[36:39], v[52:55]
ds_read_b128 v[28:31], v9 offset:8192
v_mfma_f32_16x16x32_bf16 v[56:59], a[20:23], v[36:39], v[56:59]
buffer_load_dwordx4 v6, s[8:11], s50 offen offset:256 lds
v_mfma_f32_16x16x32_bf16 v[60:63], a[16:19], v[40:43], v[60:63]
ds_read_b128 v[32:35], v9 offset:10240
v_mfma_f32_16x16x32_bf16 v[64:67], a[20:23], v[40:43], v[64:67]
s_add_u32 m0, s46, 77440
s_waitcnt lgkmcnt(4)
v_mfma_f32_16x16x32_bf16 v[52:55], a[24:27], v[44:47], v[52:55]
ds_read_b128 v[36:39], v8 offset:12288
v_mfma_f32_16x16x32_bf16 v[56:59], a[28:31], v[44:47], v[56:59]
buffer_load_dwordx4 v6, s[8:11], s50 offen offset:384 lds
v_mfma_f32_16x16x32_bf16 v[60:63], a[24:27], v[48:51], v[60:63]
ds_read_b128 v[40:43], v8 offset:14336
v_mfma_f32_16x16x32_bf16 v[64:67], a[28:31], v[48:51], v[64:67]
s_add_u32 m0, s46, 81408
s_waitcnt lgkmcnt(4)
v_mfma_f32_16x16x32_bf16 v[52:55], a[32:35], v[20:23], v[52:55]
ds_read_b128 v[44:47], v9 offset:12288
v_mfma_f32_16x16x32_bf16 v[56:59], a[36:39], v[20:23], v[56:59]
buffer_load_dwordx4 v6, s[8:11], s50 offen offset:512 lds
v_mfma_f32_16x16x32_bf16 v[60:63], a[32:35], v[24:27], v[60:63]
ds_read_b128 v[48:51], v9 offset:14336
v_mfma_f32_16x16x32_bf16 v[64:67], a[36:39], v[24:27], v[64:67]
s_add_u32 m0, s46, 85376
s_waitcnt lgkmcnt(4)
v_mfma_f32_16x16x32_bf16 v[52:55], a[40:43], v[28:31], v[52:55]
ds_read_b128 v[20:23], v8 offset:16384
v_mfma_f32_16x16x32_bf16 v[56:59], a[44:47], v[28:31], v[56:59]
buffer_load_dwordx4 v6, s[8:11], s50 offen offset:640 lds
v_mfma_f32_16x16x32_bf16 v[60:63], a[40:43], v[32:35], v[60:63]
ds_read_b128 v[24:27], v8 offset:18432
v_mfma_f32_16x16x32_bf16 v[64:67], a[44:47], v[32:35], v[64:67]
s_add_u32 m0, s46, 89344
s_waitcnt lgkmcnt(4)
v_mfma_f32_16x16x32_bf16 v[52:55], a[48:51], v[36:39], v[52:55]
ds_read_b128 v[28:31], v9 offset:16384
v_mfma_f32_16x16x32_bf16 v[56:59], a[52:55], v[36:39], v[56:59]
buffer_load_dwordx4 v6, s[8:11], s50 offen offset:768 lds
v_mfma_f32_16x16x32_bf16 v[60:63], a[48:51], v[40:43], v[60:63]
ds_read_b128 v[32:35], v9 offset:18432
v_mfma_f32_16x16x32_bf16 v[64:67], a[52:55], v[40:43], v[64:67]
s_add_u32 m0, s46, 93312
s_waitcnt lgkmcnt(4)
v_mfma_f32_16x16x32_bf16 v[52:55], a[56:59], v[44:47], v[52:55]
ds_read_b128 v[36:39], v8 offset:20480
v_mfma_f32_16x16x32_bf16 v[56:59], a[60:63], v[44:47], v[56:59]
buffer_load_dwordx4 v6, s[8:11], s50 offen offset:896 lds
v_mfma_f32_16x16x32_bf16 v[60:63], a[56:59], v[48:51], v[60:63]
ds_read_b128 v[40:43], v8 offset:22528
v_mfma_f32_16x16x32_bf16 v[64:67], a[60:63], v[48:51], v[64:67]
s_add_u32 m0, s46, 97280
s_waitcnt lgkmcnt(4)
v_mfma_f32_16x16x32_bf16 v[52:55], a[64:67], v[20:23], v[52:55]
ds_read_b128 v[44:47], v9 offset:20480
v_mfma_f32_16x16x32_bf16 v[56:59], a[68:71], v[20:23], v[56:59]
buffer_load_dwordx4 v6, s[8:11], s50 offen offset:1024 lds
v_mfma_f32_16x16x32_bf16 v[60:63], a[64:67], v[24:27], v[60:63]
ds_read_b128 v[48:51], v9 offset:22528
v_mfma_f32_16x16x32_bf16 v[64:67], a[68:71], v[24:27], v[64:67]
s_add_u32 m0, s46, 101248
s_waitcnt lgkmcnt(4)
v_mfma_f32_16x16x32_bf16 v[52:55], a[72:75], v[28:31], v[52:55]
ds_read_b128 v[20:23], v8 offset:24576
v_mfma_f32_16x16x32_bf16 v[56:59], a[76:79], v[28:31], v[56:59]
buffer_load_dwordx4 v6, s[8:11], s50 offen offset:1152 lds
v_mfma_f32_16x16x32_bf16 v[60:63], a[72:75], v[32:35], v[60:63]
ds_read_b128 v[24:27], v8 offset:26624
v_mfma_f32_16x16x32_bf16 v[64:67], a[76:79], v[32:35], v[64:67]
s_add_u32 m0, s46, 105216
s_waitcnt lgkmcnt(4)
v_mfma_f32_16x16x32_bf16 v[52:55], a[80:83], v[36:39], v[52:55]
ds_read_b128 v[28:31], v9 offset:24576
v_mfma_f32_16x16x32_bf16 v[56:59], a[84:87], v[36:39], v[56:59]
buffer_load_dwordx4 v6, s[8:11], s50 offen offset:1280 lds
v_mfma_f32_16x16x32_bf16 v[60:63], a[80:83], v[40:43], v[60:63]
ds_read_b128 v[32:35], v9 offset:26624
v_mfma_f32_16x16x32_bf16 v[64:67], a[84:87], v[40:43], v[64:67]
s_add_u32 m0, s46, 109184
s_waitcnt lgkmcnt(4)
v_mfma_f32_16x16x32_bf16 v[52:55], a[88:91], v[44:47], v[52:55]
ds_read_b128 v[36:39], v8 offset:28672
v_mfma_f32_16x16x32_bf16 v[56:59], a[92:95], v[44:47], v[56:59]
buffer_load_dwordx4 v6, s[8:11], s50 offen offset:1408 lds
v_mfma_f32_16x16x32_bf16 v[60:63], a[88:91], v[48:51], v[60:63]
ds_read_b128 v[40:43], v8 offset:30720
v_mfma_f32_16x16x32_bf16 v[64:67], a[92:95], v[48:51], v[64:67]
s_add_u32 m0, s46, 113152
s_waitcnt lgkmcnt(4)
v_mfma_f32_16x16x32_bf16 v[52:55], a[96:99], v[20:23], v[52:55]
ds_read_b128 v[44:47], v9 offset:28672
v_mfma_f32_16x16x32_bf16 v[56:59], a[100:103], v[20:23], v[56:59]
buffer_load_dwordx4 v6, s[8:11], s50 offen offset:1536 lds
v_mfma_f32_16x16x32_bf16 v[60:63], a[96:99], v[24:27], v[60:63]
ds_read_b128 v[48:51], v9 offset:30720
v_mfma_f32_16x16x32_bf16 v[64:67], a[100:103], v[24:27], v[64:67]
s_add_u32 m0, s46, 117120
s_waitcnt lgkmcnt(4)
v_mfma_f32_16x16x32_bf16 v[52:55], a[104:107], v[28:31], v[52:55]
ds_read_b128 v[20:23], v8 offset:32768
v_mfma_f32_16x16x32_bf16 v[56:59], a[108:111], v[28:31], v[56:59]
buffer_load_dwordx4 v6, s[8:11], s50 offen offset:1664 lds
v_mfma_f32_16x16x32_bf16 v[60:63], a[104:107], v[32:35], v[60:63]
ds_read_b128 v[24:27], v8 offset:34816
v_mfma_f32_16x16x32_bf16 v[64:67], a[108:111], v[32:35], v[64:67]
s_add_u32 m0, s46, 121088
s_waitcnt lgkmcnt(4)
v_mfma_f32_16x16x32_bf16 v[52:55], a[112:115], v[36:39], v[52:55]
ds_read_b128 v[28:31], v9 offset:32768
v_mfma_f32_16x16x32_bf16 v[56:59], a[116:119], v[36:39], v[56:59]
buffer_load_dwordx4 v6, s[8:11], s50 offen offset:1792 lds
v_mfma_f32_16x16x32_bf16 v[60:63], a[112:115], v[40:43], v[60:63]
ds_read_b128 v[32:35], v9 offset:34816
v_mfma_f32_16x16x32_bf16 v[64:67], a[116:119], v[40:43], v[64:67]
s_add_u32 m0, s46, 125056
s_waitcnt lgkmcnt(4)
v_mfma_f32_16x16x32_bf16 v[52:55], a[120:123], v[44:47], v[52:55]
ds_read_b128 v[36:39], v8 offset:36864
v_mfma_f32_16x16x32_bf16 v[56:59], a[124:127], v[44:47], v[56:59]
buffer_load_dwordx4 v6, s[8:11], s50 offen offset:1920 lds
v_mfma_f32_16x16x32_bf16 v[60:63], a[120:123], v[48:51], v[60:63]
ds_read_b128 v[40:43], v8 offset:38912
v_mfma_f32_16x16x32_bf16 v[64:67], a[124:127], v[48:51], v[64:67]
s_waitcnt lgkmcnt(4)
v_mfma_f32_16x16x32_bf16 v[52:55], a[128:131], v[20:23], v[52:55]
ds_read_b128 v[44:47], v9 offset:36864
v_mfma_f32_16x16x32_bf16 v[56:59], a[132:135], v[20:23], v[56:59]
v_mfma_f32_16x16x32_bf16 v[60:63], a[128:131], v[24:27], v[60:63]
ds_read_b128 v[48:51], v9 offset:38912
v_mfma_f32_16x16x32_bf16 v[64:67], a[132:135], v[24:27], v[64:67]
s_waitcnt lgkmcnt(4)
v_mfma_f32_16x16x32_bf16 v[52:55], a[136:139], v[28:31], v[52:55]
ds_read_b128 v[20:23], v8 offset:40960
v_mfma_f32_16x16x32_bf16 v[56:59], a[140:143], v[28:31], v[56:59]
v_mfma_f32_16x16x32_bf16 v[60:63], a[136:139], v[32:35], v[60:63]
ds_read_b128 v[24:27], v8 offset:43008
v_mfma_f32_16x16x32_bf16 v[64:67], a[140:143], v[32:35], v[64:67]
s_waitcnt lgkmcnt(4)
v_mfma_f32_16x16x32_bf16 v[52:55], a[144:147], v[36:39], v[52:55]
ds_read_b128 v[28:31], v9 offset:40960
v_mfma_f32_16x16x32_bf16 v[56:59], a[148:151], v[36:39], v[56:59]
v_mfma_f32_16x16x32_bf16 v[60:63], a[144:147], v[40:43], v[60:63]
ds_read_b128 v[32:35], v9 offset:43008
v_mfma_f32_16x16x32_bf16 v[64:67], a[148:151], v[40:43], v[64:67]
s_waitcnt lgkmcnt(4)
v_mfma_f32_16x16x32_bf16 v[52:55], a[152:155], v[44:47], v[52:55]
ds_read_b128 v[36:39], v8 offset:45056
v_mfma_f32_16x16x32_bf16 v[56:59], a[156:159], v[44:47], v[56:59]
v_mfma_f32_16x16x32_bf16 v[60:63], a[152:155], v[48:51], v[60:63]
ds_read_b128 v[40:43], v8 offset:47104
v_mfma_f32_16x16x32_bf16 v[64:67], a[156:159], v[48:51], v[64:67]
s_waitcnt lgkmcnt(4)
v_mfma_f32_16x16x32_bf16 v[52:55], a[160:163], v[20:23], v[52:55]
ds_read_b128 v[44:47], v9 offset:45056
v_mfma_f32_16x16x32_bf16 v[56:59], a[164:167], v[20:23], v[56:59]
v_mfma_f32_16x16x32_bf16 v[60:63], a[160:163], v[24:27], v[60:63]
ds_read_b128 v[48:51], v9 offset:47104
v_mfma_f32_16x16x32_bf16 v[64:67], a[164:167], v[24:27], v[64:67]
s_waitcnt lgkmcnt(4)
v_mfma_f32_16x16x32_bf16 v[52:55], a[168:171], v[28:31], v[52:55]
ds_read_b128 v[20:23], v8 offset:49152
v_mfma_f32_16x16x32_bf16 v[56:59], a[172:175], v[28:31], v[56:59]
v_mfma_f32_16x16x32_bf16 v[60:63], a[168:171], v[32:35], v[60:63]
ds_read_b128 v[24:27], v8 offset:51200
v_mfma_f32_16x16x32_bf16 v[64:67], a[172:175], v[32:35], v[64:67]
s_waitcnt lgkmcnt(4)
v_mfma_f32_16x16x32_bf16 v[52:55], a[176:179], v[36:39], v[52:55]
ds_read_b128 v[28:31], v9 offset:49152
v_mfma_f32_16x16x32_bf16 v[56:59], a[180:183], v[36:39], v[56:59]
v_mfma_f32_16x16x32_bf16 v[60:63], a[176:179], v[40:43], v[60:63]
ds_read_b128 v[32:35], v9 offset:51200
v_mfma_f32_16x16x32_bf16 v[64:67], a[180:183], v[40:43], v[64:67]
s_waitcnt lgkmcnt(4)
v_mfma_f32_16x16x32_bf16 v[52:55], a[184:187], v[44:47], v[52:55]
ds_read_b128 v[36:39], v8 offset:53248
v_mfma_f32_16x16x32_bf16 v[56:59], a[188:191], v[44:47], v[56:59]
v_mfma_f32_16x16x32_bf16 v[60:63], a[184:187], v[48:51], v[60:63]
ds_read_b128 v[40:43], v8 offset:55296
v_mfma_f32_16x16x32_bf16 v[64:67], a[188:191], v[48:51], v[64:67]
s_waitcnt lgkmcnt(4)
v_mfma_f32_16x16x32_bf16 v[52:55], a[192:195], v[20:23], v[52:55]
ds_read_b128 v[44:47], v9 offset:53248
v_mfma_f32_16x16x32_bf16 v[56:59], a[196:199], v[20:23], v[56:59]
v_mfma_f32_16x16x32_bf16 v[60:63], a[192:195], v[24:27], v[60:63]
ds_read_b128 v[48:51], v9 offset:55296
v_mfma_f32_16x16x32_bf16 v[64:67], a[196:199], v[24:27], v[64:67]
s_waitcnt lgkmcnt(4)
v_mfma_f32_16x16x32_bf16 v[52:55], a[200:203], v[28:31], v[52:55]
ds_read_b128 v[20:23], v8 offset:57344
v_mfma_f32_16x16x32_bf16 v[56:59], a[204:207], v[28:31], v[56:59]
v_mfma_f32_16x16x32_bf16 v[60:63], a[200:203], v[32:35], v[60:63]
ds_read_b128 v[24:27], v8 offset:59392
v_mfma_f32_16x16x32_bf16 v[64:67], a[204:207], v[32:35], v[64:67]
s_waitcnt lgkmcnt(4)
v_mfma_f32_16x16x32_bf16 v[52:55], a[208:211], v[36:39], v[52:55]
ds_read_b128 v[28:31], v9 offset:57344
v_mfma_f32_16x16x32_bf16 v[56:59], a[212:215], v[36:39], v[56:59]
v_mfma_f32_16x16x32_bf16 v[60:63], a[208:211], v[40:43], v[60:63]
ds_read_b128 v[32:35], v9 offset:59392
v_mfma_f32_16x16x32_bf16 v[64:67], a[212:215], v[40:43], v[64:67]
s_waitcnt lgkmcnt(4)
v_mfma_f32_16x16x32_bf16 v[52:55], a[216:219], v[44:47], v[52:55]
ds_read_b128 v[36:39], v8 offset:61440
v_mfma_f32_16x16x32_bf16 v[56:59], a[220:223], v[44:47], v[56:59]
v_mfma_f32_16x16x32_bf16 v[60:63], a[216:219], v[48:51], v[60:63]
ds_read_b128 v[40:43], v8 offset:63488
v_mfma_f32_16x16x32_bf16 v[64:67], a[220:223], v[48:51], v[64:67]
s_waitcnt lgkmcnt(4)
v_mfma_f32_16x16x32_bf16 v[52:55], a[224:227], v[20:23], v[52:55]
ds_read_b128 v[44:47], v9 offset:61440
v_mfma_f32_16x16x32_bf16 v[56:59], a[228:231], v[20:23], v[56:59]
v_mfma_f32_16x16x32_bf16 v[60:63], a[224:227], v[24:27], v[60:63]
ds_read_b128 v[48:51], v9 offset:63488
v_mfma_f32_16x16x32_bf16 v[64:67], a[228:231], v[24:27], v[64:67]
s_waitcnt lgkmcnt(5)
v_mfma_f32_16x16x32_bf16 v[52:55], a[232:235], v[28:31], v[52:55]
v_mfma_f32_16x16x32_bf16 v[56:59], a[236:239], v[28:31], v[56:59]
s_waitcnt lgkmcnt(4)
v_mfma_f32_16x16x32_bf16 v[60:63], a[232:235], v[32:35], v[60:63]
v_mfma_f32_16x16x32_bf16 v[64:67], a[236:239], v[32:35], v[64:67]
s_waitcnt lgkmcnt(3)
v_mfma_f32_16x16x32_bf16 v[52:55], a[240:243], v[36:39], v[52:55]
v_mfma_f32_16x16x32_bf16 v[56:59], a[244:247], v[36:39], v[56:59]
s_waitcnt lgkmcnt(2)
v_mfma_f32_16x16x32_bf16 v[60:63], a[240:243], v[40:43], v[60:63]
v_mfma_f32_16x16x32_bf16 v[64:67], a[244:247], v[40:43], v[64:67]
s_waitcnt lgkmcnt(1)
v_mfma_f32_16x16x32_bf16 v[68:71], a[248:251], v[44:47], v[52:55]
v_mfma_f32_16x16x32_bf16 v[72:75], a[252:255], v[44:47], v[56:59]
s_waitcnt lgkmcnt(0)
v_mfma_f32_16x16x32_bf16 v[76:79], a[248:251], v[48:51], v[60:63]
v_mfma_f32_16x16x32_bf16 v[80:83], a[252:255], v[48:51], v[64:67]
s_waitcnt vmcnt(0)
mega_kernel_q_loop:
s_barrier
s_cmp_gt_i32 s55, s42
s_cbranch_scc1 mega_kernel_q_kv1k
mega_kernel_q_kv1w:
v_mov_b32 v2, 0
s_mov_b64 exec, 0xff
buffer_atomic_add v2, v99, s[84:87], 0 offen sc0 sc1
s_mov_b64 exec, -1
s_waitcnt vmcnt(0)
v_min_i32_dpp v2, v2, v2 quad_perm:[1,0,3,2] row_mask:0xf bank_mask:0xf
s_nop 1
v_min_i32_dpp v2, v2, v2 quad_perm:[2,3,0,1] row_mask:0xf bank_mask:0xf
s_nop 1
v_min_i32_dpp v2, v2, v2 row_half_mirror row_mask:0xf bank_mask:0xf
s_nop 0
v_readfirstlane_b32 s55, v2
s_cmp_gt_i32 s55, s42
s_cbranch_scc1 mega_kernel_q_kv1k
s_sleep 4
s_branch mega_kernel_q_kv1w
mega_kernel_q_kv1k:
s_cmp_ge_u32 s42, 61
s_cbranch_scc0 mega_kernel_q_nl1
s_add_u32 s51, s47, s42
s_bfe_u32 s57, s51, 0x40002
s_lshl_b32 s57, s57, 14
s_and_b32 s66, s51, 3
s_lshl_b32 s66, s66, 11
s_add_u32 s66, s66, s57
s_add_u32 s66, s66, s58
s_add_u32 s67, s66, 33554432
s_bfe_u32 s57, s51, 0x30003
s_lshl_b32 s57, s57, 14
s_and_b32 s68, s51, 7
s_lshl_b32 s68, s68, 10
s_add_u32 s68, s68, s57
s_add_u32 s68, s68, s59
s_add_u32 s50, s42, 4
s_min_u32 s50, s50, 63
s_lshl_b32 s50, s50, 16
s_cmp_gt_i32 s56, s42
s_cselect_b32 s30, 1, 0
s_add_u32 m0, s60, 0
s_nop 0
buffer_load_dwordx4 v5, s[84:87], s66 offen offset:0 sc1 lds
s_add_u32 m0, s60, 0
s_nop 0
buffer_load_dwordx4 v5, s[84:87], s66 offen offset:1024 sc1 lds
s_add_u32 m0, s60, 8192
s_nop 0
buffer_load_dwordx4 v5, s[84:87], s67 offen offset:0 sc1 lds
s_add_u32 m0, s60, 8192
s_nop 0
buffer_load_dwordx4 v5, s[84:87], s67 offen offset:1024 sc1 lds
s_cmp_eq_u32 s30, 1
s_cbranch_scc0 mega_kernel_q_kx1
s_mov_b32 m0, s61
s_nop 0
buffer_load_dwordx4 v5, s[84:87], s68 offen sc1 lds
mega_kernel_q_kx1:
v_mov_b64 v[84:85], v[220:221]
v_mov_b64 v[86:87], v[222:223]
v_mov_b64 v[88:89], v[224:225]
v_mov_b64 v[90:91], v[226:227]
v_mov_b64 v[220:221], v[228:229]
v_mov_b64 v[222:223], v[230:231]
v_mov_b64 v[224:225], v[232:233]
v_mov_b64 v[226:227], v[234:235]
v_cvt_pk_bf16_f32 v228, v68, v69
v_cvt_pk_bf16_f32 v229, v70, v71
v_cvt_pk_bf16_f32 v230, v72, v73
v_cvt_pk_bf16_f32 v231, v74, v75
v_cvt_pk_bf16_f32 v232, v76, v77
v_cvt_pk_bf16_f32 v233, v78, v79
v_cvt_pk_bf16_f32 v234, v80, v81
v_cvt_pk_bf16_f32 v235, v82, v83
ds_write_b128 v101, v[84:87]
ds_write_b128 v101, v[88:91] offset:1024
s_waitcnt vmcnt(4)
v_mov_b32 v17, s42
s_mov_b64 exec, 1
buffer_store_dword v17, v16, s[84:87], s49 offen sc1
s_mov_b64 exec, -1
s_branch mega_kernel_q_jl1
mega_kernel_q_nl1:
ds_read_b128 v[20:23], v10 offset:0
ds_read_b128 v[24:27], v10 offset:2048
ds_read_b128 v[28:31], v11 offset:0
ds_read_b128 v[32:35], v11 offset:2048
ds_read_b128 v[36:39], v10 offset:4096
ds_read_b128 v[40:43], v10 offset:6144
s_add_u32 s51, s47, s42
s_bfe_u32 s57, s51, 0x40002
s_lshl_b32 s57, s57, 14
s_and_b32 s66, s51, 3
s_lshl_b32 s66, s66, 11
s_add_u32 s66, s66, s57
s_add_u32 s66, s66, s58
s_add_u32 s67, s66, 33554432
s_bfe_u32 s57, s51, 0x30003
s_lshl_b32 s57, s57, 14
s_and_b32 s68, s51, 7
s_lshl_b32 s68, s68, 10
s_add_u32 s68, s68, s57
s_add_u32 s68, s68, s59
s_add_u32 s50, s42, 4
s_min_u32 s50, s50, 63
s_lshl_b32 s50, s50, 16
s_cmp_gt_i32 s56, s42
s_cselect_b32 s30, 1, 0
s_add_u32 m0, s60, 0
s_waitcnt lgkmcnt(4)
v_mfma_f32_16x16x32_bf16 v[52:55], a[0:3], v[20:23], 0
ds_read_b128 v[44:47], v11 offset:4096
v_mfma_f32_16x16x32_bf16 v[56:59], a[4:7], v[20:23], 0
buffer_load_dwordx4 v5, s[84:87], s66 offen offset:0 sc1 lds
v_mfma_f32_16x16x32_bf16 v[60:63], a[0:3], v[24:27], 0
ds_read_b128 v[48:51], v11 offset:6144
v_mfma_f32_16x16x32_bf16 v[64:67], a[4:7], v[24:27], 0
s_add_u32 m0, s60, 0
s_waitcnt lgkmcnt(4)
v_mfma_f32_16x16x32_bf16 v[52:55], a[8:11], v[28:31], v[52:55]
ds_read_b128 v[20:23], v10 offset:8192
v_mfma_f32_16x16x32_bf16 v[56:59], a[12:15], v[28:31], v[56:59]
buffer_load_dwordx4 v5, s[84:87], s66 offen offset:1024 sc1 lds
v_mfma_f32_16x16x32_bf16 v[60:63], a[8:11], v[32:35], v[60:63]
ds_read_b128 v[24:27], v10 offset:10240
v_mfma_f32_16x16x32_bf16 v[64:67], a[12:15], v[32:35], v[64:67]
s_add_u32 m0, s60, 8192
s_waitcnt lgkmcnt(4)
v_mfma_f32_16x16x32_bf16 v[52:55], a[16:19], v[36:39], v[52:55]
ds_read_b128 v[28:31], v11 offset:8192
v_mfma_f32_16x16x32_bf16 v[56:59], a[20:23], v[36:39], v[56:59]
buffer_load_dwordx4 v5, s[84:87], s67 offen offset:0 sc1 lds
v_mfma_f32_16x16x32_bf16 v[60:63], a[16:19], v[40:43], v[60:63]
ds_read_b128 v[32:35], v11 offset:10240
v_mfma_f32_16x16x32_bf16 v[64:67], a[20:23], v[40:43], v[64:67]
s_add_u32 m0, s60, 8192
s_waitcnt lgkmcnt(4)
v_mfma_f32_16x16x32_bf16 v[52:55], a[24:27], v[44:47], v[52:55]
ds_read_b128 v[36:39], v10 offset:12288
v_mfma_f32_16x16x32_bf16 v[56:59], a[28:31], v[44:47], v[56:59]
buffer_load_dwordx4 v5, s[84:87], s67 offen offset:1024 sc1 lds
v_mfma_f32_16x16x32_bf16 v[60:63], a[24:27], v[48:51], v[60:63]
ds_read_b128 v[40:43], v10 offset:14336
v_mfma_f32_16x16x32_bf16 v[64:67], a[28:31], v[48:51], v[64:67]
s_waitcnt lgkmcnt(4)
v_mfma_f32_16x16x32_bf16 v[52:55], a[32:35], v[20:23], v[52:55]
ds_read_b128 v[44:47], v11 offset:12288
v_mfma_f32_16x16x32_bf16 v[56:59], a[36:39], v[20:23], v[56:59]
s_cmp_eq_u32 s30, 1
s_cbranch_scc0 mega_kernel_q_ke1
s_mov_b32 m0, s61
s_nop 0
buffer_load_dwordx4 v5, s[84:87], s68 offen sc1 lds
mega_kernel_q_ke1:
v_mfma_f32_16x16x32_bf16 v[60:63], a[32:35], v[24:27], v[60:63]
ds_read_b128 v[48:51], v11 offset:14336
v_mfma_f32_16x16x32_bf16 v[64:67], a[36:39], v[24:27], v[64:67]
s_add_u32 m0, s46, 0
s_waitcnt lgkmcnt(4)
v_mfma_f32_16x16x32_bf16 v[52:55], a[40:43], v[28:31], v[52:55]
ds_read_b128 v[20:23], v10 offset:16384
v_mfma_f32_16x16x32_bf16 v[56:59], a[44:47], v[28:31], v[56:59]
buffer_load_dwordx4 v6, s[8:11], s50 offen offset:0 lds
v_mfma_f32_16x16x32_bf16 v[60:63], a[40:43], v[32:35], v[60:63]
ds_read_b128 v[24:27], v10 offset:18432
v_mfma_f32_16x16x32_bf16 v[64:67], a[44:47], v[32:35], v[64:67]
s_add_u32 m0, s46, 3968
s_waitcnt lgkmcnt(4)
v_mfma_f32_16x16x32_bf16 v[52:55], a[48:51], v[36:39], v[52:55]
ds_read_b128 v[28:31], v11 offset:16384
v_mfma_f32_16x16x32_bf16 v[56:59], a[52:55], v[36:39], v[56:59]
buffer_load_dwordx4 v6, s[8:11], s50 offen offset:128 lds
v_mfma_f32_16x16x32_bf16 v[60:63], a[48:51], v[40:43], v[60:63]
ds_read_b128 v[32:35], v11 offset:18432
v_mfma_f32_16x16x32_bf16 v[64:67], a[52:55], v[40:43], v[64:67]
s_add_u32 m0, s46, 7936
s_waitcnt lgkmcnt(4)
v_mfma_f32_16x16x32_bf16 v[52:55], a[56:59], v[44:47], v[52:55]
ds_read_b128 v[36:39], v10 offset:20480
v_mfma_f32_16x16x32_bf16 v[56:59], a[60:63], v[44:47], v[56:59]
buffer_load_dwordx4 v6, s[8:11], s50 offen offset:256 lds
v_mfma_f32_16x16x32_bf16 v[60:63], a[56:59], v[48:51], v[60:63]
ds_read_b128 v[40:43], v10 offset:22528
v_mfma_f32_16x16x32_bf16 v[64:67], a[60:63], v[48:51], v[64:67]
s_add_u32 m0, s46, 11904
s_waitcnt lgkmcnt(4)
v_mfma_f32_16x16x32_bf16 v[52:55], a[64:67], v[20:23], v[52:55]
ds_read_b128 v[44:47], v11 offset:20480
v_mfma_f32_16x16x32_bf16 v[56:59], a[68:71], v[20:23], v[56:59]
buffer_load_dwordx4 v6, s[8:11], s50 offen offset:384 lds
v_mfma_f32_16x16x32_bf16 v[60:63], a[64:67], v[24:27], v[60:63]
ds_read_b128 v[48:51], v11 offset:22528
v_mfma_f32_16x16x32_bf16 v[64:67], a[68:71], v[24:27], v[64:67]
s_add_u32 m0, s46, 15872
s_waitcnt lgkmcnt(4)
v_mfma_f32_16x16x32_bf16 v[52:55], a[72:75], v[28:31], v[52:55]
ds_read_b128 v[20:23], v10 offset:24576
v_mfma_f32_16x16x32_bf16 v[56:59], a[76:79], v[28:31], v[56:59]
buffer_load_dwordx4 v6, s[8:11], s50 offen offset:512 lds
v_mfma_f32_16x16x32_bf16 v[60:63], a[72:75], v[32:35], v[60:63]
ds_read_b128 v[24:27], v10 offset:26624
v_mfma_f32_16x16x32_bf16 v[64:67], a[76:79], v[32:35], v[64:67]
s_add_u32 m0, s46, 19840
s_waitcnt lgkmcnt(4)
v_mfma_f32_16x16x32_bf16 v[52:55], a[80:83], v[36:39], v[52:55]
ds_read_b128 v[28:31], v11 offset:24576
v_mfma_f32_16x16x32_bf16 v[56:59], a[84:87], v[36:39], v[56:59]
buffer_load_dwordx4 v6, s[8:11], s50 offen offset:640 lds
v_mfma_f32_16x16x32_bf16 v[60:63], a[80:83], v[40:43], v[60:63]
ds_read_b128 v[32:35], v11 offset:26624
v_mfma_f32_16x16x32_bf16 v[64:67], a[84:87], v[40:43], v[64:67]
s_add_u32 m0, s46, 23808
s_waitcnt lgkmcnt(4)
v_mfma_f32_16x16x32_bf16 v[52:55], a[88:91], v[44:47], v[52:55]
ds_read_b128 v[36:39], v10 offset:28672
v_mfma_f32_16x16x32_bf16 v[56:59], a[92:95], v[44:47], v[56:59]
buffer_load_dwordx4 v6, s[8:11], s50 offen offset:768 lds
v_mfma_f32_16x16x32_bf16 v[60:63], a[88:91], v[48:51], v[60:63]
ds_read_b128 v[40:43], v10 offset:30720
v_mfma_f32_16x16x32_bf16 v[64:67], a[92:95], v[48:51], v[64:67]
s_add_u32 m0, s46, 27776
s_waitcnt lgkmcnt(4)
v_mfma_f32_16x16x32_bf16 v[52:55], a[96:99], v[20:23], v[52:55]
ds_read_b128 v[44:47], v11 offset:28672
v_mfma_f32_16x16x32_bf16 v[56:59], a[100:103], v[20:23], v[56:59]
buffer_load_dwordx4 v6, s[8:11], s50 offen offset:896 lds
v_mfma_f32_16x16x32_bf16 v[60:63], a[96:99], v[24:27], v[60:63]
ds_read_b128 v[48:51], v11 offset:30720
v_mfma_f32_16x16x32_bf16 v[64:67], a[100:103], v[24:27], v[64:67]
s_add_u32 m0, s46, 31744
s_waitcnt lgkmcnt(4)
v_mfma_f32_16x16x32_bf16 v[52:55], a[104:107], v[28:31], v[52:55]
ds_read_b128 v[20:23], v10 offset:32768
v_mfma_f32_16x16x32_bf16 v[56:59], a[108:111], v[28:31], v[56:59]
buffer_load_dwordx4 v6, s[8:11], s50 offen offset:1024 lds
v_mfma_f32_16x16x32_bf16 v[60:63], a[104:107], v[32:35], v[60:63]
ds_read_b128 v[24:27], v10 offset:34816
v_mfma_f32_16x16x32_bf16 v[64:67], a[108:111], v[32:35], v[64:67]
s_waitcnt vmcnt(13)
v_mov_b32 v17, s42
s_mov_b64 exec, 1
buffer_store_dword v17, v16, s[84:87], s49 offen sc1
s_mov_b64 exec, -1
s_add_u32 m0, s46, 35712
s_waitcnt lgkmcnt(4)
v_mfma_f32_16x16x32_bf16 v[52:55], a[112:115], v[36:39], v[52:55]
ds_read_b128 v[28:31], v11 offset:32768
v_mfma_f32_16x16x32_bf16 v[56:59], a[116:119], v[36:39], v[56:59]
buffer_load_dwordx4 v6, s[8:11], s50 offen offset:1152 lds
v_mfma_f32_16x16x32_bf16 v[60:63], a[112:115], v[40:43], v[60:63]
ds_read_b128 v[32:35], v11 offset:34816
v_mfma_f32_16x16x32_bf16 v[64:67], a[116:119], v[40:43], v[64:67]
v_mov_b32 v100, 0
s_mov_b64 exec, 1
buffer_atomic_add v100, v16, s[84:87], s62 offen sc0 sc1
s_mov_b64 exec, -1
s_add_u32 m0, s46, 39680
s_waitcnt lgkmcnt(4)
v_mfma_f32_16x16x32_bf16 v[52:55], a[120:123], v[44:47], v[52:55]
ds_read_b128 v[36:39], v10 offset:36864
v_mfma_f32_16x16x32_bf16 v[56:59], a[124:127], v[44:47], v[56:59]
buffer_load_dwordx4 v6, s[8:11], s50 offen offset:1280 lds
v_mfma_f32_16x16x32_bf16 v[60:63], a[120:123], v[48:51], v[60:63]
ds_read_b128 v[40:43], v10 offset:38912
v_mfma_f32_16x16x32_bf16 v[64:67], a[124:127], v[48:51], v[64:67]
s_add_u32 m0, s46, 43648
s_waitcnt lgkmcnt(4)
v_mfma_f32_16x16x32_bf16 v[52:55], a[128:131], v[20:23], v[52:55]
ds_read_b128 v[44:47], v11 offset:36864
v_mfma_f32_16x16x32_bf16 v[56:59], a[132:135], v[20:23], v[56:59]
buffer_load_dwordx4 v6, s[8:11], s50 offen offset:1408 lds
v_mfma_f32_16x16x32_bf16 v[60:63], a[128:131], v[24:27], v[60:63]
ds_read_b128 v[48:51], v11 offset:38912
v_mfma_f32_16x16x32_bf16 v[64:67], a[132:135], v[24:27], v[64:67]
s_add_u32 m0, s46, 47616
s_waitcnt lgkmcnt(4)
v_mfma_f32_16x16x32_bf16 v[52:55], a[136:139], v[28:31], v[52:55]
ds_read_b128 v[20:23], v10 offset:40960
v_mfma_f32_16x16x32_bf16 v[56:59], a[140:143], v[28:31], v[56:59]
buffer_load_dwordx4 v6, s[8:11], s50 offen offset:1536 lds
v_mfma_f32_16x16x32_bf16 v[60:63], a[136:139], v[32:35], v[60:63]
ds_read_b128 v[24:27], v10 offset:43008
v_mfma_f32_16x16x32_bf16 v[64:67], a[140:143], v[32:35], v[64:67]
s_add_u32 m0, s46, 51584
s_waitcnt lgkmcnt(4)
v_mfma_f32_16x16x32_bf16 v[52:55], a[144:147], v[36:39], v[52:55]
ds_read_b128 v[28:31], v11 offset:40960
v_mfma_f32_16x16x32_bf16 v[56:59], a[148:151], v[36:39], v[56:59]
buffer_load_dwordx4 v6, s[8:11], s50 offen offset:1664 lds
v_mfma_f32_16x16x32_bf16 v[60:63], a[144:147], v[40:43], v[60:63]
ds_read_b128 v[32:35], v11 offset:43008
v_mfma_f32_16x16x32_bf16 v[64:67], a[148:151], v[40:43], v[64:67]
s_add_u32 m0, s46, 55552
s_waitcnt lgkmcnt(4)
v_mfma_f32_16x16x32_bf16 v[52:55], a[152:155], v[44:47], v[52:55]
ds_read_b128 v[36:39], v10 offset:45056
v_mfma_f32_16x16x32_bf16 v[56:59], a[156:159], v[44:47], v[56:59]
buffer_load_dwordx4 v6, s[8:11], s50 offen offset:1792 lds
v_mfma_f32_16x16x32_bf16 v[60:63], a[152:155], v[48:51], v[60:63]
ds_read_b128 v[40:43], v10 offset:47104
v_mfma_f32_16x16x32_bf16 v[64:67], a[156:159], v[48:51], v[64:67]
s_add_u32 m0, s46, 59520
s_waitcnt lgkmcnt(4)
v_mfma_f32_16x16x32_bf16 v[52:55], a[160:163], v[20:23], v[52:55]
ds_read_b128 v[44:47], v11 offset:45056
v_mfma_f32_16x16x32_bf16 v[56:59], a[164:167], v[20:23], v[56:59]
buffer_load_dwordx4 v6, s[8:11], s50 offen offset:1920 lds
v_mfma_f32_16x16x32_bf16 v[60:63], a[160:163], v[24:27], v[60:63]
ds_read_b128 v[48:51], v11 offset:47104
v_mfma_f32_16x16x32_bf16 v[64:67], a[164:167], v[24:27], v[64:67]
s_waitcnt lgkmcnt(4)
v_mfma_f32_16x16x32_bf16 v[52:55], a[168:171], v[28:31], v[52:55]
ds_read_b128 v[20:23], v10 offset:49152
v_mfma_f32_16x16x32_bf16 v[56:59], a[172:175], v[28:31], v[56:59]
v_mov_b64 v[84:85], v[220:221]
v_mov_b64 v[86:87], v[222:223]
v_mfma_f32_16x16x32_bf16 v[60:63], a[168:171], v[32:35], v[60:63]
ds_read_b128 v[24:27], v10 offset:51200
v_mfma_f32_16x16x32_bf16 v[64:67], a[172:175], v[32:35], v[64:67]
v_mov_b64 v[88:89], v[224:225]
v_mov_b64 v[90:91], v[226:227]
s_waitcnt lgkmcnt(4)
v_mfma_f32_16x16x32_bf16 v[52:55], a[176:179], v[36:39], v[52:55]
ds_read_b128 v[28:31], v11 offset:49152
v_mfma_f32_16x16x32_bf16 v[56:59], a[180:183], v[36:39], v[56:59]
v_mov_b64 v[220:221], v[228:229]
v_mov_b64 v[222:223], v[230:231]
v_mfma_f32_16x16x32_bf16 v[60:63], a[176:179], v[40:43], v[60:63]
ds_read_b128 v[32:35], v11 offset:51200
v_mfma_f32_16x16x32_bf16 v[64:67], a[180:183], v[40:43], v[64:67]
v_mov_b64 v[224:225], v[232:233]
v_mov_b64 v[226:227], v[234:235]
s_waitcnt lgkmcnt(4)
v_mfma_f32_16x16x32_bf16 v[52:55], a[184:187], v[44:47], v[52:55]
ds_read_b128 v[36:39], v10 offset:53248
v_mfma_f32_16x16x32_bf16 v[56:59], a[188:191], v[44:47], v[56:59]
v_cvt_pk_bf16_f32 v228, v68, v69
v_cvt_pk_bf16_f32 v229, v70, v71
v_mfma_f32_16x16x32_bf16 v[60:63], a[184:187], v[48:51], v[60:63]
ds_read_b128 v[40:43], v10 offset:55296
v_mfma_f32_16x16x32_bf16 v[64:67], a[188:191], v[48:51], v[64:67]
v_cvt_pk_bf16_f32 v230, v72, v73
v_cvt_pk_bf16_f32 v231, v74, v75
s_waitcnt lgkmcnt(4)
v_mfma_f32_16x16x32_bf16 v[52:55], a[192:195], v[20:23], v[52:55]
ds_read_b128 v[44:47], v11 offset:53248
v_mfma_f32_16x16x32_bf16 v[56:59], a[196:199], v[20:23], v[56:59]
v_cvt_pk_bf16_f32 v232, v76, v77
v_cvt_pk_bf16_f32 v233, v78, v79
v_mfma_f32_16x16x32_bf16 v[60:63], a[192:195], v[24:27], v[60:63]
ds_read_b128 v[48:51], v11 offset:55296
v_mfma_f32_16x16x32_bf16 v[64:67], a[196:199], v[24:27], v[64:67]
v_cvt_pk_bf16_f32 v234, v80, v81
v_cvt_pk_bf16_f32 v235, v82, v83
s_waitcnt lgkmcnt(4)
v_mfma_f32_16x16x32_bf16 v[52:55], a[200:203], v[28:31], v[52:55]
ds_read_b128 v[20:23], v10 offset:57344
v_mfma_f32_16x16x32_bf16 v[56:59], a[204:207], v[28:31], v[56:59]
v_mfma_f32_16x16x32_bf16 v[60:63], a[200:203], v[32:35], v[60:63]
ds_read_b128 v[24:27], v10 offset:59392
v_mfma_f32_16x16x32_bf16 v[64:67], a[204:207], v[32:35], v[64:67]
s_waitcnt lgkmcnt(4)
v_mfma_f32_16x16x32_bf16 v[52:55], a[208:211], v[36:39], v[52:55]
ds_read_b128 v[28:31], v11 offset:57344
v_mfma_f32_16x16x32_bf16 v[56:59], a[212:215], v[36:39], v[56:59]
v_mfma_f32_16x16x32_bf16 v[60:63], a[208:211], v[40:43], v[60:63]
ds_read_b128 v[32:35], v11 offset:59392
v_mfma_f32_16x16x32_bf16 v[64:67], a[212:215], v[40:43], v[64:67]
s_waitcnt lgkmcnt(4)
v_mfma_f32_16x16x32_bf16 v[52:55], a[216:219], v[44:47], v[52:55]
ds_read_b128 v[36:39], v10 offset:61440
v_mfma_f32_16x16x32_bf16 v[56:59], a[220:223], v[44:47], v[56:59]
s_waitcnt vmcnt(6)
v_readfirstlane_b32 s56, v100
s_cmp_eq_u32 s30, 1
s_cbranch_scc1 mega_kernel_q_kf1
s_cmp_gt_i32 s56, s42
s_cbranch_scc0 mega_kernel_q_kf1
s_mov_b32 s30, 1
s_mov_b32 m0, s61
s_nop 0
buffer_load_dwordx4 v5, s[84:87], s68 offen sc1 lds
mega_kernel_q_kf1:
v_mfma_f32_16x16x32_bf16 v[60:63], a[216:219], v[48:51], v[60:63]
ds_read_b128 v[40:43], v10 offset:63488
v_mfma_f32_16x16x32_bf16 v[64:67], a[220:223], v[48:51], v[64:67]
s_waitcnt lgkmcnt(4)
v_mfma_f32_16x16x32_bf16 v[52:55], a[224:227], v[20:23], v[52:55]
ds_read_b128 v[44:47], v11 offset:61440
v_mfma_f32_16x16x32_bf16 v[56:59], a[228:231], v[20:23], v[56:59]
v_mfma_f32_16x16x32_bf16 v[60:63], a[224:227], v[24:27], v[60:63]
ds_read_b128 v[48:51], v11 offset:63488
v_mfma_f32_16x16x32_bf16 v[64:67], a[228:231], v[24:27], v[64:67]
s_waitcnt lgkmcnt(5)
v_mfma_f32_16x16x32_bf16 v[52:55], a[232:235], v[28:31], v[52:55]
v_mfma_f32_16x16x32_bf16 v[56:59], a[236:239], v[28:31], v[56:59]
s_waitcnt lgkmcnt(4)
v_mfma_f32_16x16x32_bf16 v[60:63], a[232:235], v[32:35], v[60:63]
v_mfma_f32_16x16x32_bf16 v[64:67], a[236:239], v[32:35], v[64:67]
s_waitcnt lgkmcnt(3)
v_mfma_f32_16x16x32_bf16 v[52:55], a[240:243], v[36:39], v[52:55]
v_mfma_f32_16x16x32_bf16 v[56:59], a[244:247], v[36:39], v[56:59]
s_waitcnt lgkmcnt(2)
v_mfma_f32_16x16x32_bf16 v[60:63], a[240:243], v[40:43], v[60:63]
v_mfma_f32_16x16x32_bf16 v[64:67], a[244:247], v[40:43], v[64:67]
ds_write_b128 v101, v[84:87]
ds_write_b128 v101, v[88:91] offset:1024
s_waitcnt lgkmcnt(1)
v_mfma_f32_16x16x32_bf16 v[68:71], a[248:251], v[44:47], v[52:55]
v_mfma_f32_16x16x32_bf16 v[72:75], a[252:255], v[44:47], v[56:59]
s_waitcnt lgkmcnt(0)
v_mfma_f32_16x16x32_bf16 v[76:79], a[248:251], v[48:51], v[60:63]
v_mfma_f32_16x16x32_bf16 v[80:83], a[252:255], v[48:51], v[64:67]
mega_kernel_q_jl1:
s_cmp_eq_u32 s30, 1
s_cbranch_scc1 mega_kernel_q_kl1
mega_kernel_q_kw1:
v_mov_b32 v100, 0
s_mov_b64 exec, 1
buffer_atomic_add v100, v16, s[84:87], s62 offen sc0 sc1
s_mov_b64 exec, -1
s_waitcnt vmcnt(0)
v_readfirstlane_b32 s56, v100
s_cmp_gt_i32 s56, s42
s_cbranch_scc0 mega_kernel_q_kw1
s_mov_b32 m0, s61
s_nop 0
buffer_load_dwordx4 v5, s[84:87], s68 offen sc1 lds
mega_kernel_q_kl1:
s_waitcnt lgkmcnt(0) vmcnt(0)
s_barrier
ds_read_b128 v[184:187], v102 offset:0
ds_read_b128 v[112:115], v103 offset:0
ds_read_b128 v[128:131], v103 offset:1024
ds_read_b128 v[188:191], v102 offset:2048
ds_read_b128 v[116:119], v103 offset:2048
ds_read_b128 v[132:135], v103 offset:3072
ds_read_b128 v[192:195], v102 offset:4096
ds_read_b128 v[120:123], v103 offset:4096
ds_read_b128 v[136:139], v103 offset:5120
ds_read_b128 v[196:199], v102 offset:6144
ds_read_b128 v[124:127], v103 offset:6144
ds_read_b128 v[140:143], v103 offset:7168
s_waitcnt lgkmcnt(9)
v_mfma_f32_16x16x32_bf16 v[200:203], v[112:115], v[184:187], 0
v_mfma_f32_16x16x32_bf16 v[204:207], v[128:131], v[184:187], 0
ds_read_b128 v[160:163], v94 offset:0
s_waitcnt lgkmcnt(7)
v_mfma_f32_16x16x32_bf16 v[200:203], v[116:119], v[188:191], v[200:203]
v_mfma_f32_16x16x32_bf16 v[204:207], v[132:135], v[188:191], v[204:207]
ds_read_b128 v[164:167], v94 offset:1024
s_waitcnt lgkmcnt(5)
v_mfma_f32_16x16x32_bf16 v[200:203], v[120:123], v[192:195], v[200:203]
v_mfma_f32_16x16x32_bf16 v[204:207], v[136:139], v[192:195], v[204:207]
ds_read_b128 v[168:171], v94 offset:2048
s_waitcnt lgkmcnt(3)
v_mfma_f32_16x16x32_bf16 v[200:203], v[124:127], v[196:199], v[200:203]
v_mfma_f32_16x16x32_bf16 v[204:207], v[140:143], v[196:199], v[204:207]
ds_read_b128 v[172:175], v94 offset:3072
s_waitcnt lgkmcnt(3)
v_mfma_f32_16x16x32_bf16 v[208:211], v[160:163], v[184:187], 0
ds_read_b128 v[144:147], v240 offset:0
ds_read_b64 v[176:177], v95 offset:0
s_waitcnt lgkmcnt(4)
v_mfma_f32_16x16x32_bf16 v[208:211], v[164:167], v[188:191], v[208:211]
ds_read_b128 v[148:151], v240 offset:1024
ds_read_b64 v[178:179], v95 offset:256
s_waitcnt lgkmcnt(5)
v_mfma_f32_16x16x32_bf16 v[208:211], v[168:171], v[192:195], v[208:211]
ds_read_b128 v[152:155], v240 offset:2048
ds_read_b64 v[180:181], v95 offset:1024
s_waitcnt lgkmcnt(6)
v_mfma_f32_16x16x32_bf16 v[208:211], v[172:175], v[196:199], v[208:211]
ds_read_b128 v[156:159], v240 offset:3072
ds_read_b64 v[182:183], v95 offset:1280
v_pk_mul_f32 v[200:201], v[200:201], s[54:55] op_sel_hi:[1,0]
v_pk_mul_f32 v[202:203], v[202:203], s[54:55] op_sel_hi:[1,0]
v_pk_mul_f32 v[204:205], v[204:205], s[54:55] op_sel_hi:[1,0]
v_pk_mul_f32 v[206:207], v[206:207], s[54:55] op_sel_hi:[1,0]
v_cndmask_b32 v200, v200, v241, s[12:13]
v_cndmask_b32 v201, v201, v241, s[14:15]
v_cndmask_b32 v202, v202, v241, s[16:17]
v_cndmask_b32 v203, v203, v241, s[18:19]
v_cndmask_b32 v204, v204, v241, s[20:21]
v_cndmask_b32 v205, v205, v241, s[22:23]
v_cndmask_b32 v206, v206, v241, s[24:25]
v_cndmask_b32 v207, v207, v241, s[26:27]
v_pk_mul_f32 v[208:209], v[208:209], s[54:55] op_sel_hi:[1,0]
v_pk_mul_f32 v[210:211], v[210:211], s[54:55] op_sel_hi:[1,0]
v_cndmask_b32 v208, v208, v97, s[28:29]
v_cndmask_b32 v209, v209, v97, s[28:29]
v_cndmask_b32 v210, v210, v97, s[28:29]
v_cndmask_b32 v211, v211, v97, s[28:29]
v_max3_f32 v236, v200, v201, v202
v_max3_f32 v236, v236, v203, v204
v_max3_f32 v236, v236, v205, v206
v_max3_f32 v236, v236, v207, v208
v_max3_f32 v236, v236, v209, v210
v_max_f32 v237, v236, v211
v_max_f32 v236, v236, v211
s_nop 1
v_permlane16_swap_b32 v236, v237
s_nop 0
v_max_f32 v238, v236, v237
v_max_f32 v239, v236, v237
s_nop 1
v_permlane32_swap_b32 v238, v239
s_nop 0
v_max_f32 v236, v238, v239
v_pk_add_f32 v[200:201], v[200:201], v[236:237] op_sel_hi:[1,0] neg_lo:[0,1] neg_hi:[0,1]
v_pk_add_f32 v[202:203], v[202:203], v[236:237] op_sel_hi:[1,0] neg_lo:[0,1] neg_hi:[0,1]
v_pk_add_f32 v[204:205], v[204:205], v[236:237] op_sel_hi:[1,0] neg_lo:[0,1] neg_hi:[0,1]
v_pk_add_f32 v[206:207], v[206:207], v[236:237] op_sel_hi:[1,0] neg_lo:[0,1] neg_hi:[0,1]
v_pk_add_f32 v[208:209], v[208:209], v[236:237] op_sel_hi:[1,0] neg_lo:[0,1] neg_hi:[0,1]
v_pk_add_f32 v[210:211], v[210:211], v[236:237] op_sel_hi:[1,0] neg_lo:[0,1] neg_hi:[0,1]
v_exp_f32 v200, v200
v_exp_f32 v201, v201
v_exp_f32 v202, v202
v_exp_f32 v203, v203
v_exp_f32 v204, v204
v_exp_f32 v205, v205
v_exp_f32 v206, v206
v_exp_f32 v207, v207
v_exp_f32 v208, v208
v_exp_f32 v209, v209
v_exp_f32 v210, v210
v_exp_f32 v211, v211
s_nop 0
v_cvt_pk_bf16_f32 v212, v200, v201
v_cvt_pk_bf16_f32 v213, v202, v203
v_cvt_pk_bf16_f32 v214, v204, v205
v_cvt_pk_bf16_f32 v215, v206, v207
v_cvt_pk_bf16_f32 v216, v208, v209
v_cvt_pk_bf16_f32 v217, v210, v211
s_waitcnt lgkmcnt(0)
s_nop 0
v_mfma_f32_16x16x32_bf16 v[108:111], v[104:107], v[212:215], 0
v_mfma_f32_16x16x32_bf16 v[112:115], v[144:147], v[212:215], 0
v_mfma_f32_16x16x32_bf16 v[116:119], v[148:151], v[212:215], 0
v_mfma_f32_16x16x32_bf16 v[120:123], v[152:155], v[212:215], 0
v_mfma_f32_16x16x32_bf16 v[124:127], v[156:159], v[212:215], 0
v_mfma_f32_16x16x16_bf16 v[108:111], v[104:105], v[216:217], v[108:111]
v_mfma_f32_16x16x16_bf16 v[112:115], v[176:177], v[216:217], v[112:115]
v_mfma_f32_16x16x16_bf16 v[116:119], v[178:179], v[216:217], v[116:119]
v_mfma_f32_16x16x16_bf16 v[120:123], v[180:181], v[216:217], v[120:123]
v_mfma_f32_16x16x16_bf16 v[124:127], v[182:183], v[216:217], v[124:127]
s_lshl_b32 s51, s42, 18
s_nop 2
v_rcp_f32 v238, v108
v_rcp_f32 v239, v109
s_nop 1
v_pk_mul_f32 v[112:113], v[112:113], v[238:239]
v_pk_mul_f32 v[114:115], v[114:115], v[238:239]
v_pk_mul_f32 v[116:117], v[116:117], v[238:239]
v_pk_mul_f32 v[118:119], v[118:119], v[238:239]
v_pk_mul_f32 v[120:121], v[120:121], v[238:239]
v_pk_mul_f32 v[122:123], v[122:123], v[238:239]
v_pk_mul_f32 v[124:125], v[124:125], v[238:239]
v_pk_mul_f32 v[126:127], v[126:127], v[238:239]
v_cvt_pk_bf16_f32 v200, v112, v113
v_cvt_pk_bf16_f32 v201, v114, v115
v_cvt_pk_bf16_f32 v202, v116, v117
v_cvt_pk_bf16_f32 v203, v118, v119
v_cvt_pk_bf16_f32 v204, v120, v121
v_cvt_pk_bf16_f32 v205, v122, v123
v_cvt_pk_bf16_f32 v206, v124, v125
v_cvt_pk_bf16_f32 v207, v126, v127
buffer_store_dwordx4 v[200:203], v96, s[84:87], s51 offen sc1
buffer_store_dwordx4 v[204:207], v96, s[84:87], s51 offen offset:2048 sc1
s_add_u32 s42, s42, 1
s_barrier
s_cmp_gt_i32 s55, s42
s_cbranch_scc1 mega_kernel_q_kv0k
mega_kernel_q_kv0w:
v_mov_b32 v2, 0
s_mov_b64 exec, 0xff
buffer_atomic_add v2, v99, s[84:87], 0 offen sc0 sc1
s_mov_b64 exec, -1
s_waitcnt vmcnt(0)
v_min_i32_dpp v2, v2, v2 quad_perm:[1,0,3,2] row_mask:0xf bank_mask:0xf
s_nop 1
v_min_i32_dpp v2, v2, v2 quad_perm:[2,3,0,1] row_mask:0xf bank_mask:0xf
s_nop 1
v_min_i32_dpp v2, v2, v2 row_half_mirror row_mask:0xf bank_mask:0xf
s_nop 0
v_readfirstlane_b32 s55, v2
s_cmp_gt_i32 s55, s42
s_cbranch_scc1 mega_kernel_q_kv0k
s_sleep 4
s_branch mega_kernel_q_kv0w
mega_kernel_q_kv0k:
s_cmp_ge_u32 s42, 61
s_cbranch_scc0 mega_kernel_q_nl0
s_add_u32 s51, s47, s42
s_bfe_u32 s57, s51, 0x40002
s_lshl_b32 s57, s57, 14
s_and_b32 s66, s51, 3
s_lshl_b32 s66, s66, 11
s_add_u32 s66, s66, s57
s_add_u32 s66, s66, s58
s_add_u32 s67, s66, 33554432
s_bfe_u32 s57, s51, 0x30003
s_lshl_b32 s57, s57, 14
s_and_b32 s68, s51, 7
s_lshl_b32 s68, s68, 10
s_add_u32 s68, s68, s57
s_add_u32 s68, s68, s59
s_add_u32 s50, s42, 4
s_min_u32 s50, s50, 63
s_lshl_b32 s50, s50, 16
s_cmp_gt_i32 s56, s42
s_cselect_b32 s30, 1, 0
s_add_u32 m0, s60, 0
s_nop 0
buffer_load_dwordx4 v5, s[84:87], s66 offen offset:0 sc1 lds
s_add_u32 m0, s60, 0
s_nop 0
buffer_load_dwordx4 v5, s[84:87], s66 offen offset:1024 sc1 lds
s_add_u32 m0, s60, 8192
s_nop 0
buffer_load_dwordx4 v5, s[84:87], s67 offen offset:0 sc1 lds
s_add_u32 m0, s60, 8192
s_nop 0
buffer_load_dwordx4 v5, s[84:87], s67 offen offset:1024 sc1 lds
s_cmp_eq_u32 s30, 1
s_cbranch_scc0 mega_kernel_q_kx0
s_mov_b32 m0, s61
s_nop 0
buffer_load_dwordx4 v5, s[84:87], s68 offen sc1 lds
mega_kernel_q_kx0:
v_mov_b64 v[84:85], v[220:221]
v_mov_b64 v[86:87], v[222:223]
v_mov_b64 v[88:89], v[224:225]
v_mov_b64 v[90:91], v[226:227]
v_mov_b64 v[220:221], v[228:229]
v_mov_b64 v[222:223], v[230:231]
v_mov_b64 v[224:225], v[232:233]
v_mov_b64 v[226:227], v[234:235]
v_cvt_pk_bf16_f32 v228, v68, v69
v_cvt_pk_bf16_f32 v229, v70, v71
v_cvt_pk_bf16_f32 v230, v72, v73
v_cvt_pk_bf16_f32 v231, v74, v75
v_cvt_pk_bf16_f32 v232, v76, v77
v_cvt_pk_bf16_f32 v233, v78, v79
v_cvt_pk_bf16_f32 v234, v80, v81
v_cvt_pk_bf16_f32 v235, v82, v83
ds_write_b128 v101, v[84:87]
ds_write_b128 v101, v[88:91] offset:1024
s_waitcnt vmcnt(4)
v_mov_b32 v17, s42
s_mov_b64 exec, 1
buffer_store_dword v17, v16, s[84:87], s49 offen sc1
s_mov_b64 exec, -1
s_branch mega_kernel_q_jl0
mega_kernel_q_nl0:
ds_read_b128 v[20:23], v8 offset:0
ds_read_b128 v[24:27], v8 offset:2048
ds_read_b128 v[28:31], v9 offset:0
ds_read_b128 v[32:35], v9 offset:2048
ds_read_b128 v[36:39], v8 offset:4096
ds_read_b128 v[40:43], v8 offset:6144
s_add_u32 s51, s47, s42
s_bfe_u32 s57, s51, 0x40002
s_lshl_b32 s57, s57, 14
s_and_b32 s66, s51, 3
s_lshl_b32 s66, s66, 11
s_add_u32 s66, s66, s57
s_add_u32 s66, s66, s58
s_add_u32 s67, s66, 33554432
s_bfe_u32 s57, s51, 0x30003
s_lshl_b32 s57, s57, 14
s_and_b32 s68, s51, 7
s_lshl_b32 s68, s68, 10
s_add_u32 s68, s68, s57
s_add_u32 s68, s68, s59
s_add_u32 s50, s42, 4
s_min_u32 s50, s50, 63
s_lshl_b32 s50, s50, 16
s_cmp_gt_i32 s56, s42
s_cselect_b32 s30, 1, 0
s_add_u32 m0, s60, 0
s_waitcnt lgkmcnt(4)
v_mfma_f32_16x16x32_bf16 v[52:55], a[0:3], v[20:23], 0
ds_read_b128 v[44:47], v9 offset:4096
v_mfma_f32_16x16x32_bf16 v[56:59], a[4:7], v[20:23], 0
buffer_load_dwordx4 v5, s[84:87], s66 offen offset:0 sc1 lds
v_mfma_f32_16x16x32_bf16 v[60:63], a[0:3], v[24:27], 0
ds_read_b128 v[48:51], v9 offset:6144
v_mfma_f32_16x16x32_bf16 v[64:67], a[4:7], v[24:27], 0
s_add_u32 m0, s60, 0
s_waitcnt lgkmcnt(4)
v_mfma_f32_16x16x32_bf16 v[52:55], a[8:11], v[28:31], v[52:55]
ds_read_b128 v[20:23], v8 offset:8192
v_mfma_f32_16x16x32_bf16 v[56:59], a[12:15], v[28:31], v[56:59]
buffer_load_dwordx4 v5, s[84:87], s66 offen offset:1024 sc1 lds
v_mfma_f32_16x16x32_bf16 v[60:63], a[8:11], v[32:35], v[60:63]
ds_read_b128 v[24:27], v8 offset:10240
v_mfma_f32_16x16x32_bf16 v[64:67], a[12:15], v[32:35], v[64:67]
s_add_u32 m0, s60, 8192
s_waitcnt lgkmcnt(4)
v_mfma_f32_16x16x32_bf16 v[52:55], a[16:19], v[36:39], v[52:55]
ds_read_b128 v[28:31], v9 offset:8192
v_mfma_f32_16x16x32_bf16 v[56:59], a[20:23], v[36:39], v[56:59]
buffer_load_dwordx4 v5, s[84:87], s67 offen offset:0 sc1 lds
v_mfma_f32_16x16x32_bf16 v[60:63], a[16:19], v[40:43], v[60:63]
ds_read_b128 v[32:35], v9 offset:10240
v_mfma_f32_16x16x32_bf16 v[64:67], a[20:23], v[40:43], v[64:67]
s_add_u32 m0, s60, 8192
s_waitcnt lgkmcnt(4)
v_mfma_f32_16x16x32_bf16 v[52:55], a[24:27], v[44:47], v[52:55]
ds_read_b128 v[36:39], v8 offset:12288
v_mfma_f32_16x16x32_bf16 v[56:59], a[28:31], v[44:47], v[56:59]
buffer_load_dwordx4 v5, s[84:87], s67 offen offset:1024 sc1 lds
v_mfma_f32_16x16x32_bf16 v[60:63], a[24:27], v[48:51], v[60:63]
ds_read_b128 v[40:43], v8 offset:14336
v_mfma_f32_16x16x32_bf16 v[64:67], a[28:31], v[48:51], v[64:67]
s_waitcnt lgkmcnt(4)
v_mfma_f32_16x16x32_bf16 v[52:55], a[32:35], v[20:23], v[52:55]
ds_read_b128 v[44:47], v9 offset:12288
v_mfma_f32_16x16x32_bf16 v[56:59], a[36:39], v[20:23], v[56:59]
s_cmp_eq_u32 s30, 1
s_cbranch_scc0 mega_kernel_q_ke0
s_mov_b32 m0, s61
s_nop 0
buffer_load_dwordx4 v5, s[84:87], s68 offen sc1 lds
mega_kernel_q_ke0:
v_mfma_f32_16x16x32_bf16 v[60:63], a[32:35], v[24:27], v[60:63]
ds_read_b128 v[48:51], v9 offset:14336
v_mfma_f32_16x16x32_bf16 v[64:67], a[36:39], v[24:27], v[64:67]
s_add_u32 m0, s46, 65536
s_waitcnt lgkmcnt(4)
v_mfma_f32_16x16x32_bf16 v[52:55], a[40:43], v[28:31], v[52:55]
ds_read_b128 v[20:23], v8 offset:16384
v_mfma_f32_16x16x32_bf16 v[56:59], a[44:47], v[28:31], v[56:59]
buffer_load_dwordx4 v6, s[8:11], s50 offen offset:0 lds
v_mfma_f32_16x16x32_bf16 v[60:63], a[40:43], v[32:35], v[60:63]
ds_read_b128 v[24:27], v8 offset:18432
v_mfma_f32_16x16x32_bf16 v[64:67], a[44:47], v[32:35], v[64:67]
s_add_u32 m0, s46, 69504
s_waitcnt lgkmcnt(4)
v_mfma_f32_16x16x32_bf16 v[52:55], a[48:51], v[36:39], v[52:55]
ds_read_b128 v[28:31], v9 offset:16384
v_mfma_f32_16x16x32_bf16 v[56:59], a[52:55], v[36:39], v[56:59]
buffer_load_dwordx4 v6, s[8:11], s50 offen offset:128 lds
v_mfma_f32_16x16x32_bf16 v[60:63], a[48:51], v[40:43], v[60:63]
ds_read_b128 v[32:35], v9 offset:18432
v_mfma_f32_16x16x32_bf16 v[64:67], a[52:55], v[40:43], v[64:67]
s_add_u32 m0, s46, 73472
s_waitcnt lgkmcnt(4)
v_mfma_f32_16x16x32_bf16 v[52:55], a[56:59], v[44:47], v[52:55]
ds_read_b128 v[36:39], v8 offset:20480
v_mfma_f32_16x16x32_bf16 v[56:59], a[60:63], v[44:47], v[56:59]
buffer_load_dwordx4 v6, s[8:11], s50 offen offset:256 lds
v_mfma_f32_16x16x32_bf16 v[60:63], a[56:59], v[48:51], v[60:63]
ds_read_b128 v[40:43], v8 offset:22528
v_mfma_f32_16x16x32_bf16 v[64:67], a[60:63], v[48:51], v[64:67]
s_add_u32 m0, s46, 77440
s_waitcnt lgkmcnt(4)
v_mfma_f32_16x16x32_bf16 v[52:55], a[64:67], v[20:23], v[52:55]
ds_read_b128 v[44:47], v9 offset:20480
v_mfma_f32_16x16x32_bf16 v[56:59], a[68:71], v[20:23], v[56:59]
buffer_load_dwordx4 v6, s[8:11], s50 offen offset:384 lds
v_mfma_f32_16x16x32_bf16 v[60:63], a[64:67], v[24:27], v[60:63]
ds_read_b128 v[48:51], v9 offset:22528
v_mfma_f32_16x16x32_bf16 v[64:67], a[68:71], v[24:27], v[64:67]
s_add_u32 m0, s46, 81408
s_waitcnt lgkmcnt(4)
v_mfma_f32_16x16x32_bf16 v[52:55], a[72:75], v[28:31], v[52:55]
ds_read_b128 v[20:23], v8 offset:24576
v_mfma_f32_16x16x32_bf16 v[56:59], a[76:79], v[28:31], v[56:59]
buffer_load_dwordx4 v6, s[8:11], s50 offen offset:512 lds
v_mfma_f32_16x16x32_bf16 v[60:63], a[72:75], v[32:35], v[60:63]
ds_read_b128 v[24:27], v8 offset:26624
v_mfma_f32_16x16x32_bf16 v[64:67], a[76:79], v[32:35], v[64:67]
s_add_u32 m0, s46, 85376
s_waitcnt lgkmcnt(4)
v_mfma_f32_16x16x32_bf16 v[52:55], a[80:83], v[36:39], v[52:55]
ds_read_b128 v[28:31], v9 offset:24576
v_mfma_f32_16x16x32_bf16 v[56:59], a[84:87], v[36:39], v[56:59]
buffer_load_dwordx4 v6, s[8:11], s50 offen offset:640 lds
v_mfma_f32_16x16x32_bf16 v[60:63], a[80:83], v[40:43], v[60:63]
ds_read_b128 v[32:35], v9 offset:26624
v_mfma_f32_16x16x32_bf16 v[64:67], a[84:87], v[40:43], v[64:67]
s_add_u32 m0, s46, 89344
s_waitcnt lgkmcnt(4)
v_mfma_f32_16x16x32_bf16 v[52:55], a[88:91], v[44:47], v[52:55]
ds_read_b128 v[36:39], v8 offset:28672
v_mfma_f32_16x16x32_bf16 v[56:59], a[92:95], v[44:47], v[56:59]
buffer_load_dwordx4 v6, s[8:11], s50 offen offset:768 lds
v_mfma_f32_16x16x32_bf16 v[60:63], a[88:91], v[48:51], v[60:63]
ds_read_b128 v[40:43], v8 offset:30720
v_mfma_f32_16x16x32_bf16 v[64:67], a[92:95], v[48:51], v[64:67]
s_add_u32 m0, s46, 93312
s_waitcnt lgkmcnt(4)
v_mfma_f32_16x16x32_bf16 v[52:55], a[96:99], v[20:23], v[52:55]
ds_read_b128 v[44:47], v9 offset:28672
v_mfma_f32_16x16x32_bf16 v[56:59], a[100:103], v[20:23], v[56:59]
buffer_load_dwordx4 v6, s[8:11], s50 offen offset:896 lds
v_mfma_f32_16x16x32_bf16 v[60:63], a[96:99], v[24:27], v[60:63]
ds_read_b128 v[48:51], v9 offset:30720
v_mfma_f32_16x16x32_bf16 v[64:67], a[100:103], v[24:27], v[64:67]
s_add_u32 m0, s46, 97280
s_waitcnt lgkmcnt(4)
v_mfma_f32_16x16x32_bf16 v[52:55], a[104:107], v[28:31], v[52:55]
ds_read_b128 v[20:23], v8 offset:32768
v_mfma_f32_16x16x32_bf16 v[56:59], a[108:111], v[28:31], v[56:59]
buffer_load_dwordx4 v6, s[8:11], s50 offen offset:1024 lds
v_mfma_f32_16x16x32_bf16 v[60:63], a[104:107], v[32:35], v[60:63]
ds_read_b128 v[24:27], v8 offset:34816
v_mfma_f32_16x16x32_bf16 v[64:67], a[108:111], v[32:35], v[64:67]
s_waitcnt vmcnt(13)
v_mov_b32 v17, s42
s_mov_b64 exec, 1
buffer_store_dword v17, v16, s[84:87], s49 offen sc1
s_mov_b64 exec, -1
s_add_u32 m0, s46, 101248
s_waitcnt lgkmcnt(4)
v_mfma_f32_16x16x32_bf16 v[52:55], a[112:115], v[36:39], v[52:55]
ds_read_b128 v[28:31], v9 offset:32768
v_mfma_f32_16x16x32_bf16 v[56:59], a[116:119], v[36:39], v[56:59]
buffer_load_dwordx4 v6, s[8:11], s50 offen offset:1152 lds
v_mfma_f32_16x16x32_bf16 v[60:63], a[112:115], v[40:43], v[60:63]
ds_read_b128 v[32:35], v9 offset:34816
v_mfma_f32_16x16x32_bf16 v[64:67], a[116:119], v[40:43], v[64:67]
v_mov_b32 v100, 0
s_mov_b64 exec, 1
buffer_atomic_add v100, v16, s[84:87], s62 offen sc0 sc1
s_mov_b64 exec, -1
s_add_u32 m0, s46, 105216
s_waitcnt lgkmcnt(4)
v_mfma_f32_16x16x32_bf16 v[52:55], a[120:123], v[44:47], v[52:55]
ds_read_b128 v[36:39], v8 offset:36864
v_mfma_f32_16x16x32_bf16 v[56:59], a[124:127], v[44:47], v[56:59]
buffer_load_dwordx4 v6, s[8:11], s50 offen offset:1280 lds
v_mfma_f32_16x16x32_bf16 v[60:63], a[120:123], v[48:51], v[60:63]
ds_read_b128 v[40:43], v8 offset:38912
v_mfma_f32_16x16x32_bf16 v[64:67], a[124:127], v[48:51], v[64:67]
s_add_u32 m0, s46, 109184
s_waitcnt lgkmcnt(4)
v_mfma_f32_16x16x32_bf16 v[52:55], a[128:131], v[20:23], v[52:55]
ds_read_b128 v[44:47], v9 offset:36864
v_mfma_f32_16x16x32_bf16 v[56:59], a[132:135], v[20:23], v[56:59]
buffer_load_dwordx4 v6, s[8:11], s50 offen offset:1408 lds
v_mfma_f32_16x16x32_bf16 v[60:63], a[128:131], v[24:27], v[60:63]
ds_read_b128 v[48:51], v9 offset:38912
v_mfma_f32_16x16x32_bf16 v[64:67], a[132:135], v[24:27], v[64:67]
s_add_u32 m0, s46, 113152
s_waitcnt lgkmcnt(4)
v_mfma_f32_16x16x32_bf16 v[52:55], a[136:139], v[28:31], v[52:55]
ds_read_b128 v[20:23], v8 offset:40960
v_mfma_f32_16x16x32_bf16 v[56:59], a[140:143], v[28:31], v[56:59]
buffer_load_dwordx4 v6, s[8:11], s50 offen offset:1536 lds
v_mfma_f32_16x16x32_bf16 v[60:63], a[136:139], v[32:35], v[60:63]
ds_read_b128 v[24:27], v8 offset:43008
v_mfma_f32_16x16x32_bf16 v[64:67], a[140:143], v[32:35], v[64:67]
s_add_u32 m0, s46, 117120
s_waitcnt lgkmcnt(4)
v_mfma_f32_16x16x32_bf16 v[52:55], a[144:147], v[36:39], v[52:55]
ds_read_b128 v[28:31], v9 offset:40960
v_mfma_f32_16x16x32_bf16 v[56:59], a[148:151], v[36:39], v[56:59]
buffer_load_dwordx4 v6, s[8:11], s50 offen offset:1664 lds
v_mfma_f32_16x16x32_bf16 v[60:63], a[144:147], v[40:43], v[60:63]
ds_read_b128 v[32:35], v9 offset:43008
v_mfma_f32_16x16x32_bf16 v[64:67], a[148:151], v[40:43], v[64:67]
s_add_u32 m0, s46, 121088
s_waitcnt lgkmcnt(4)
v_mfma_f32_16x16x32_bf16 v[52:55], a[152:155], v[44:47], v[52:55]
ds_read_b128 v[36:39], v8 offset:45056
v_mfma_f32_16x16x32_bf16 v[56:59], a[156:159], v[44:47], v[56:59]
buffer_load_dwordx4 v6, s[8:11], s50 offen offset:1792 lds
v_mfma_f32_16x16x32_bf16 v[60:63], a[152:155], v[48:51], v[60:63]
ds_read_b128 v[40:43], v8 offset:47104
v_mfma_f32_16x16x32_bf16 v[64:67], a[156:159], v[48:51], v[64:67]
s_add_u32 m0, s46, 125056
s_waitcnt lgkmcnt(4)
v_mfma_f32_16x16x32_bf16 v[52:55], a[160:163], v[20:23], v[52:55]
ds_read_b128 v[44:47], v9 offset:45056
v_mfma_f32_16x16x32_bf16 v[56:59], a[164:167], v[20:23], v[56:59]
buffer_load_dwordx4 v6, s[8:11], s50 offen offset:1920 lds
v_mfma_f32_16x16x32_bf16 v[60:63], a[160:163], v[24:27], v[60:63]
ds_read_b128 v[48:51], v9 offset:47104
v_mfma_f32_16x16x32_bf16 v[64:67], a[164:167], v[24:27], v[64:67]
s_waitcnt lgkmcnt(4)
v_mfma_f32_16x16x32_bf16 v[52:55], a[168:171], v[28:31], v[52:55]
ds_read_b128 v[20:23], v8 offset:49152
v_mfma_f32_16x16x32_bf16 v[56:59], a[172:175], v[28:31], v[56:59]
v_mov_b64 v[84:85], v[220:221]
v_mov_b64 v[86:87], v[222:223]
v_mfma_f32_16x16x32_bf16 v[60:63], a[168:171], v[32:35], v[60:63]
ds_read_b128 v[24:27], v8 offset:51200
v_mfma_f32_16x16x32_bf16 v[64:67], a[172:175], v[32:35], v[64:67]
v_mov_b64 v[88:89], v[224:225]
v_mov_b64 v[90:91], v[226:227]
s_waitcnt lgkmcnt(4)
v_mfma_f32_16x16x32_bf16 v[52:55], a[176:179], v[36:39], v[52:55]
ds_read_b128 v[28:31], v9 offset:49152
v_mfma_f32_16x16x32_bf16 v[56:59], a[180:183], v[36:39], v[56:59]
v_mov_b64 v[220:221], v[228:229]
v_mov_b64 v[222:223], v[230:231]
v_mfma_f32_16x16x32_bf16 v[60:63], a[176:179], v[40:43], v[60:63]
ds_read_b128 v[32:35], v9 offset:51200
v_mfma_f32_16x16x32_bf16 v[64:67], a[180:183], v[40:43], v[64:67]
v_mov_b64 v[224:225], v[232:233]
v_mov_b64 v[226:227], v[234:235]
s_waitcnt lgkmcnt(4)
v_mfma_f32_16x16x32_bf16 v[52:55], a[184:187], v[44:47], v[52:55]
ds_read_b128 v[36:39], v8 offset:53248
v_mfma_f32_16x16x32_bf16 v[56:59], a[188:191], v[44:47], v[56:59]
v_cvt_pk_bf16_f32 v228, v68, v69
v_cvt_pk_bf16_f32 v229, v70, v71
v_mfma_f32_16x16x32_bf16 v[60:63], a[184:187], v[48:51], v[60:63]
ds_read_b128 v[40:43], v8 offset:55296
v_mfma_f32_16x16x32_bf16 v[64:67], a[188:191], v[48:51], v[64:67]
v_cvt_pk_bf16_f32 v230, v72, v73
v_cvt_pk_bf16_f32 v231, v74, v75
s_waitcnt lgkmcnt(4)
v_mfma_f32_16x16x32_bf16 v[52:55], a[192:195], v[20:23], v[52:55]
ds_read_b128 v[44:47], v9 offset:53248
v_mfma_f32_16x16x32_bf16 v[56:59], a[196:199], v[20:23], v[56:59]
v_cvt_pk_bf16_f32 v232, v76, v77
v_cvt_pk_bf16_f32 v233, v78, v79
v_mfma_f32_16x16x32_bf16 v[60:63], a[192:195], v[24:27], v[60:63]
ds_read_b128 v[48:51], v9 offset:55296
v_mfma_f32_16x16x32_bf16 v[64:67], a[196:199], v[24:27], v[64:67]
v_cvt_pk_bf16_f32 v234, v80, v81
v_cvt_pk_bf16_f32 v235, v82, v83
s_waitcnt lgkmcnt(4)
v_mfma_f32_16x16x32_bf16 v[52:55], a[200:203], v[28:31], v[52:55]
ds_read_b128 v[20:23], v8 offset:57344
v_mfma_f32_16x16x32_bf16 v[56:59], a[204:207], v[28:31], v[56:59]
v_mfma_f32_16x16x32_bf16 v[60:63], a[200:203], v[32:35], v[60:63]
ds_read_b128 v[24:27], v8 offset:59392
v_mfma_f32_16x16x32_bf16 v[64:67], a[204:207], v[32:35], v[64:67]
s_waitcnt lgkmcnt(4)
v_mfma_f32_16x16x32_bf16 v[52:55], a[208:211], v[36:39], v[52:55]
ds_read_b128 v[28:31], v9 offset:57344
v_mfma_f32_16x16x32_bf16 v[56:59], a[212:215], v[36:39], v[56:59]
v_mfma_f32_16x16x32_bf16 v[60:63], a[208:211], v[40:43], v[60:63]
ds_read_b128 v[32:35], v9 offset:59392
v_mfma_f32_16x16x32_bf16 v[64:67], a[212:215], v[40:43], v[64:67]
s_waitcnt lgkmcnt(4)
v_mfma_f32_16x16x32_bf16 v[52:55], a[216:219], v[44:47], v[52:55]
ds_read_b128 v[36:39], v8 offset:61440
v_mfma_f32_16x16x32_bf16 v[56:59], a[220:223], v[44:47], v[56:59]
s_waitcnt vmcnt(6)
v_readfirstlane_b32 s56, v100
s_cmp_eq_u32 s30, 1
s_cbranch_scc1 mega_kernel_q_kf0
s_cmp_gt_i32 s56, s42
s_cbranch_scc0 mega_kernel_q_kf0
s_mov_b32 s30, 1
s_mov_b32 m0, s61
s_nop 0
buffer_load_dwordx4 v5, s[84:87], s68 offen sc1 lds
mega_kernel_q_kf0:
v_mfma_f32_16x16x32_bf16 v[60:63], a[216:219], v[48:51], v[60:63]
ds_read_b128 v[40:43], v8 offset:63488
v_mfma_f32_16x16x32_bf16 v[64:67], a[220:223], v[48:51], v[64:67]
s_waitcnt lgkmcnt(4)
v_mfma_f32_16x16x32_bf16 v[52:55], a[224:227], v[20:23], v[52:55]
ds_read_b128 v[44:47], v9 offset:61440
v_mfma_f32_16x16x32_bf16 v[56:59], a[228:231], v[20:23], v[56:59]
v_mfma_f32_16x16x32_bf16 v[60:63], a[224:227], v[24:27], v[60:63]
ds_read_b128 v[48:51], v9 offset:63488
v_mfma_f32_16x16x32_bf16 v[64:67], a[228:231], v[24:27], v[64:67]
s_waitcnt lgkmcnt(5)
v_mfma_f32_16x16x32_bf16 v[52:55], a[232:235], v[28:31], v[52:55]
v_mfma_f32_16x16x32_bf16 v[56:59], a[236:239], v[28:31], v[56:59]
s_waitcnt lgkmcnt(4)
v_mfma_f32_16x16x32_bf16 v[60:63], a[232:235], v[32:35], v[60:63]
v_mfma_f32_16x16x32_bf16 v[64:67], a[236:239], v[32:35], v[64:67]
s_waitcnt lgkmcnt(3)
v_mfma_f32_16x16x32_bf16 v[52:55], a[240:243], v[36:39], v[52:55]
v_mfma_f32_16x16x32_bf16 v[56:59], a[244:247], v[36:39], v[56:59]
s_waitcnt lgkmcnt(2)
v_mfma_f32_16x16x32_bf16 v[60:63], a[240:243], v[40:43], v[60:63]
v_mfma_f32_16x16x32_bf16 v[64:67], a[244:247], v[40:43], v[64:67]
ds_write_b128 v101, v[84:87]
ds_write_b128 v101, v[88:91] offset:1024
s_waitcnt lgkmcnt(1)
v_mfma_f32_16x16x32_bf16 v[68:71], a[248:251], v[44:47], v[52:55]
v_mfma_f32_16x16x32_bf16 v[72:75], a[252:255], v[44:47], v[56:59]
s_waitcnt lgkmcnt(0)
v_mfma_f32_16x16x32_bf16 v[76:79], a[248:251], v[48:51], v[60:63]
v_mfma_f32_16x16x32_bf16 v[80:83], a[252:255], v[48:51], v[64:67]
mega_kernel_q_jl0:
s_cmp_eq_u32 s30, 1
s_cbranch_scc1 mega_kernel_q_kl0
mega_kernel_q_kw0:
v_mov_b32 v100, 0
s_mov_b64 exec, 1
buffer_atomic_add v100, v16, s[84:87], s62 offen sc0 sc1
s_mov_b64 exec, -1
s_waitcnt vmcnt(0)
v_readfirstlane_b32 s56, v100
s_cmp_gt_i32 s56, s42
s_cbranch_scc0 mega_kernel_q_kw0
s_mov_b32 m0, s61
s_nop 0
buffer_load_dwordx4 v5, s[84:87], s68 offen sc1 lds
mega_kernel_q_kl0:
s_waitcnt lgkmcnt(0) vmcnt(0)
s_barrier
ds_read_b128 v[184:187], v102 offset:0
ds_read_b128 v[112:115], v103 offset:0
ds_read_b128 v[128:131], v103 offset:1024
ds_read_b128 v[188:191], v102 offset:2048
ds_read_b128 v[116:119], v103 offset:2048
ds_read_b128 v[132:135], v103 offset:3072
ds_read_b128 v[192:195], v102 offset:4096
ds_read_b128 v[120:123], v103 offset:4096
ds_read_b128 v[136:139], v103 offset:5120
ds_read_b128 v[196:199], v102 offset:6144
ds_read_b128 v[124:127], v103 offset:6144
ds_read_b128 v[140:143], v103 offset:7168
s_waitcnt lgkmcnt(9)
v_mfma_f32_16x16x32_bf16 v[200:203], v[112:115], v[184:187], 0
v_mfma_f32_16x16x32_bf16 v[204:207], v[128:131], v[184:187], 0
ds_read_b128 v[160:163], v94 offset:0
s_waitcnt lgkmcnt(7)
v_mfma_f32_16x16x32_bf16 v[200:203], v[116:119], v[188:191], v[200:203]
v_mfma_f32_16x16x32_bf16 v[204:207], v[132:135], v[188:191], v[204:207]
ds_read_b128 v[164:167], v94 offset:1024
s_waitcnt lgkmcnt(5)
v_mfma_f32_16x16x32_bf16 v[200:203], v[120:123], v[192:195], v[200:203]
v_mfma_f32_16x16x32_bf16 v[204:207], v[136:139], v[192:195], v[204:207]
ds_read_b128 v[168:171], v94 offset:2048
s_waitcnt lgkmcnt(3)
v_mfma_f32_16x16x32_bf16 v[200:203], v[124:127], v[196:199], v[200:203]
v_mfma_f32_16x16x32_bf16 v[204:207], v[140:143], v[196:199], v[204:207]
ds_read_b128 v[172:175], v94 offset:3072
s_waitcnt lgkmcnt(3)
v_mfma_f32_16x16x32_bf16 v[208:211], v[160:163], v[184:187], 0
ds_read_b128 v[144:147], v240 offset:0
ds_read_b64 v[176:177], v95 offset:0
s_waitcnt lgkmcnt(4)
v_mfma_f32_16x16x32_bf16 v[208:211], v[164:167], v[188:191], v[208:211]
ds_read_b128 v[148:151], v240 offset:1024
ds_read_b64 v[178:179], v95 offset:256
s_waitcnt lgkmcnt(5)
v_mfma_f32_16x16x32_bf16 v[208:211], v[168:171], v[192:195], v[208:211]
ds_read_b128 v[152:155], v240 offset:2048
ds_read_b64 v[180:181], v95 offset:1024
s_waitcnt lgkmcnt(6)
v_mfma_f32_16x16x32_bf16 v[208:211], v[172:175], v[196:199], v[208:211]
ds_read_b128 v[156:159], v240 offset:3072
ds_read_b64 v[182:183], v95 offset:1280
v_pk_mul_f32 v[200:201], v[200:201], s[54:55] op_sel_hi:[1,0]
v_pk_mul_f32 v[202:203], v[202:203], s[54:55] op_sel_hi:[1,0]
v_pk_mul_f32 v[204:205], v[204:205], s[54:55] op_sel_hi:[1,0]
v_pk_mul_f32 v[206:207], v[206:207], s[54:55] op_sel_hi:[1,0]
v_cndmask_b32 v200, v200, v241, s[12:13]
v_cndmask_b32 v201, v201, v241, s[14:15]
v_cndmask_b32 v202, v202, v241, s[16:17]
v_cndmask_b32 v203, v203, v241, s[18:19]
v_cndmask_b32 v204, v204, v241, s[20:21]
v_cndmask_b32 v205, v205, v241, s[22:23]
v_cndmask_b32 v206, v206, v241, s[24:25]
v_cndmask_b32 v207, v207, v241, s[26:27]
v_pk_mul_f32 v[208:209], v[208:209], s[54:55] op_sel_hi:[1,0]
v_pk_mul_f32 v[210:211], v[210:211], s[54:55] op_sel_hi:[1,0]
v_cndmask_b32 v208, v208, v97, s[28:29]
v_cndmask_b32 v209, v209, v97, s[28:29]
v_cndmask_b32 v210, v210, v97, s[28:29]
v_cndmask_b32 v211, v211, v97, s[28:29]
v_max3_f32 v236, v200, v201, v202
v_max3_f32 v236, v236, v203, v204
v_max3_f32 v236, v236, v205, v206
v_max3_f32 v236, v236, v207, v208
v_max3_f32 v236, v236, v209, v210
v_max_f32 v237, v236, v211
v_max_f32 v236, v236, v211
s_nop 1
v_permlane16_swap_b32 v236, v237
s_nop 0
v_max_f32 v238, v236, v237
v_max_f32 v239, v236, v237
s_nop 1
v_permlane32_swap_b32 v238, v239
s_nop 0
v_max_f32 v236, v238, v239
v_pk_add_f32 v[200:201], v[200:201], v[236:237] op_sel_hi:[1,0] neg_lo:[0,1] neg_hi:[0,1]
v_pk_add_f32 v[202:203], v[202:203], v[236:237] op_sel_hi:[1,0] neg_lo:[0,1] neg_hi:[0,1]
v_pk_add_f32 v[204:205], v[204:205], v[236:237] op_sel_hi:[1,0] neg_lo:[0,1] neg_hi:[0,1]
v_pk_add_f32 v[206:207], v[206:207], v[236:237] op_sel_hi:[1,0] neg_lo:[0,1] neg_hi:[0,1]
v_pk_add_f32 v[208:209], v[208:209], v[236:237] op_sel_hi:[1,0] neg_lo:[0,1] neg_hi:[0,1]
v_pk_add_f32 v[210:211], v[210:211], v[236:237] op_sel_hi:[1,0] neg_lo:[0,1] neg_hi:[0,1]
v_exp_f32 v200, v200
v_exp_f32 v201, v201
v_exp_f32 v202, v202
v_exp_f32 v203, v203
v_exp_f32 v204, v204
v_exp_f32 v205, v205
v_exp_f32 v206, v206
v_exp_f32 v207, v207
v_exp_f32 v208, v208
v_exp_f32 v209, v209
v_exp_f32 v210, v210
v_exp_f32 v211, v211
s_nop 0
v_cvt_pk_bf16_f32 v212, v200, v201
v_cvt_pk_bf16_f32 v213, v202, v203
v_cvt_pk_bf16_f32 v214, v204, v205
v_cvt_pk_bf16_f32 v215, v206, v207
v_cvt_pk_bf16_f32 v216, v208, v209
v_cvt_pk_bf16_f32 v217, v210, v211
s_waitcnt lgkmcnt(0)
s_nop 0
v_mfma_f32_16x16x32_bf16 v[108:111], v[104:107], v[212:215], 0
v_mfma_f32_16x16x32_bf16 v[112:115], v[144:147], v[212:215], 0
v_mfma_f32_16x16x32_bf16 v[116:119], v[148:151], v[212:215], 0
v_mfma_f32_16x16x32_bf16 v[120:123], v[152:155], v[212:215], 0
v_mfma_f32_16x16x32_bf16 v[124:127], v[156:159], v[212:215], 0
v_mfma_f32_16x16x16_bf16 v[108:111], v[104:105], v[216:217], v[108:111]
v_mfma_f32_16x16x16_bf16 v[112:115], v[176:177], v[216:217], v[112:115]
v_mfma_f32_16x16x16_bf16 v[116:119], v[178:179], v[216:217], v[116:119]
v_mfma_f32_16x16x16_bf16 v[120:123], v[180:181], v[216:217], v[120:123]
v_mfma_f32_16x16x16_bf16 v[124:127], v[182:183], v[216:217], v[124:127]
s_lshl_b32 s51, s42, 18
s_nop 2
v_rcp_f32 v238, v108
v_rcp_f32 v239, v109
s_nop 1
v_pk_mul_f32 v[112:113], v[112:113], v[238:239]
v_pk_mul_f32 v[114:115], v[114:115], v[238:239]
v_pk_mul_f32 v[116:117], v[116:117], v[238:239]
v_pk_mul_f32 v[118:119], v[118:119], v[238:239]
v_pk_mul_f32 v[120:121], v[120:121], v[238:239]
v_pk_mul_f32 v[122:123], v[122:123], v[238:239]
v_pk_mul_f32 v[124:125], v[124:125], v[238:239]
v_pk_mul_f32 v[126:127], v[126:127], v[238:239]
v_cvt_pk_bf16_f32 v200, v112, v113
v_cvt_pk_bf16_f32 v201, v114, v115
v_cvt_pk_bf16_f32 v202, v116, v117
v_cvt_pk_bf16_f32 v203, v118, v119
v_cvt_pk_bf16_f32 v204, v120, v121
v_cvt_pk_bf16_f32 v205, v122, v123
v_cvt_pk_bf16_f32 v206, v124, v125
v_cvt_pk_bf16_f32 v207, v126, v127
buffer_store_dwordx4 v[200:203], v96, s[84:87], s51 offen sc1
buffer_store_dwordx4 v[204:207], v96, s[84:87], s51 offen offset:2048 sc1
s_add_u32 s42, s42, 1
s_cmp_lt_u32 s42, 64
s_cbranch_scc1 mega_kernel_q_loop
s_waitcnt vmcnt(0)
v_mov_b32 v17, s42
s_mov_b64 exec, 1
buffer_store_dword v17, v16, s[84:87], s49 offen sc1
s_mov_b64 exec, -1
mega_kernel_q_quit:
s_endpgm
mega_kernel_rd:
s_mov_b32 s93, s40
s_load_dwordx2 s[4:5], s[0:1], 56
s_mov_b32 s48, 0x3f7ec46d
s_mov_b32 s49, 0x3dc8bd36
s_mov_b32 s50, 0x3f7b14be
s_mov_b32 s51, 0x3e47c5c2
s_mov_b32 s52, 0x3f74fa0b
s_mov_b32 s53, 0x3e94a031
s_mov_b32 s54, 0x3f6c835e
s_mov_b32 s55, 0x3ec3ef15
s_mov_b32 s56, 0x3f61c598
s_mov_b32 s57, 0x3ef15aea
s_mov_b32 s58, 0x3f54db31
s_mov_b32 s59, 0x3f0e39da
s_mov_b32 s60, 0x3f45e403
s_mov_b32 s61, 0x3f226799
s_mov_b32 s62, 0x3f3504f3
s_mov_b32 s63, 0x3f3504f3
v_and_b32 v1, 31, v0
v_lshrrev_b32 v2, 5, v0
v_cvt_f32_u32 v3, v1
v_mul_u32_u24 v10, 8448, v2
v_lshl_add_u32 v4, v1, 3, v10
v_mul_u32_u24 v5, 264, v1
v_add_u32 v5, v5, v10
v_and_b32 v11, 7, v0
v_lshrrev_b32 v9, 3, v0
v_mul_u32_u24 v10, 8448, v11
v_lshl_add_u32 v6, v9, 3, v10
v_lshlrev_b32 v7, 3, v9
v_sub_u32 v7, v10, v7
v_add_u32 v7, 4096, v7
v_mul_u32_u24 v8, 16384, v9
v_lshl_add_u32 v8, v11, 4, v8
v_mul_f32 v12, 0xba800000, v3
v_cos_f32 v82, v12
v_sin_f32 v83, v12
v_mul_f32 v12, 0xbb000000, v3
v_cos_f32 v84, v12
v_sin_f32 v85, v12
v_mul_f32 v12, 0xbb400000, v3
v_cos_f32 v86, v12
v_sin_f32 v87, v12
v_mul_f32 v12, 0xbb800000, v3
v_cos_f32 v88, v12
v_sin_f32 v89, v12
v_mul_f32 v12, 0xbba00000, v3
v_cos_f32 v90, v12
v_sin_f32 v91, v12
v_mul_f32 v12, 0xbbc00000, v3
v_cos_f32 v92, v12
v_sin_f32 v93, v12
v_mul_f32 v12, 0xbbe00000, v3
v_cos_f32 v94, v12
v_sin_f32 v95, v12
v_mul_f32 v12, 0xbc000000, v3
v_cos_f32 v96, v12
v_sin_f32 v97, v12
v_mul_f32 v12, 0xbc100000, v3
v_cos_f32 v98, v12
v_sin_f32 v99, v12
v_mul_f32 v12, 0xbc200000, v3
v_cos_f32 v100, v12
v_sin_f32 v101, v12
v_mul_f32 v12, 0xbc300000, v3
v_cos_f32 v102, v12
v_sin_f32 v103, v12
v_mul_f32 v12, 0xbc400000, v3
v_cos_f32 v104, v12
v_sin_f32 v105, v12
v_mul_f32 v12, 0xbc500000, v3
v_cos_f32 v106, v12
v_sin_f32 v107, v12
v_mul_f32 v12, 0xbc600000, v3
v_cos_f32 v108, v12
v_sin_f32 v109, v12
v_mul_f32 v12, 0xbc700000, v3
v_cos_f32 v110, v12
v_sin_f32 v111, v12
v_mul_f32 v12, 0xbc800000, v3
v_cos_f32 v112, v12
v_sin_f32 v113, v12
v_mul_f32 v12, 0xbc880000, v3
v_cos_f32 v114, v12
v_sin_f32 v115, v12
v_mul_f32 v12, 0xbc900000, v3
v_cos_f32 v116, v12
v_sin_f32 v117, v12
v_mul_f32 v12, 0xbc980000, v3
v_cos_f32 v118, v12
v_sin_f32 v119, v12
v_mul_f32 v12, 0xbca00000, v3
v_cos_f32 v120, v12
v_sin_f32 v121, v12
v_mul_f32 v12, 0xbca80000, v3
v_cos_f32 v122, v12
v_sin_f32 v123, v12
v_mul_f32 v12, 0xbcb00000, v3
v_cos_f32 v124, v12
v_sin_f32 v125, v12
v_mul_f32 v12, 0xbcb80000, v3
v_cos_f32 v126, v12
v_sin_f32 v127, v12
v_mul_f32 v12, 0xbcc00000, v3
v_cos_f32 v128, v12
v_sin_f32 v129, v12
v_mul_f32 v12, 0xbcc80000, v3
v_cos_f32 v130, v12
v_sin_f32 v131, v12
v_mul_f32 v12, 0xbcd00000, v3
v_cos_f32 v132, v12
v_sin_f32 v133, v12
v_mul_f32 v12, 0xbcd80000, v3
v_cos_f32 v134, v12
v_sin_f32 v135, v12
v_mul_f32 v12, 0xbce00000, v3
v_cos_f32 v136, v12
v_sin_f32 v137, v12
v_mul_f32 v12, 0xbce80000, v3
v_cos_f32 v138, v12
v_sin_f32 v139, v12
v_mul_f32 v12, 0xbcf00000, v3
v_cos_f32 v140, v12
v_sin_f32 v141, v12
v_mul_f32 v12, 0xbcf80000, v3
v_cos_f32 v142, v12
v_sin_f32 v143, v12
v_lshlrev_b32 v12, 12, v2
v_lshl_add_u32 v12, v1, 1, v12
s_waitcnt lgkmcnt(0)
s_mov_b32 s6, 4194304
s_mov_b32 s7, 0x00020000
v_mov_b32 v144, 0
v_mov_b32 v145, 0
v_mov_b32 v146, 0
v_mov_b32 v147, 0
v_mov_b32 v148, 0
v_mov_b32 v149, 0
v_mov_b32 v150, 0
v_mov_b32 v151, 0
v_mov_b32 v152, 0
v_mov_b32 v153, 0
v_mov_b32 v154, 0
v_mov_b32 v155, 0
v_mov_b32 v156, 0
v_mov_b32 v157, 0
v_mov_b32 v158, 0
v_mov_b32 v159, 0
v_mov_b32 v160, 0
v_mov_b32 v161, 0
v_mov_b32 v162, 0
v_mov_b32 v163, 0
v_mov_b32 v164, 0
v_mov_b32 v165, 0
v_mov_b32 v166, 0
v_mov_b32 v167, 0
v_mov_b32 v168, 0
v_mov_b32 v169, 0
v_mov_b32 v170, 0
v_mov_b32 v171, 0
v_mov_b32 v172, 0
v_mov_b32 v173, 0
v_mov_b32 v174, 0
v_mov_b32 v175, 0
v_mov_b32 v176, 0
v_mov_b32 v177, 0
v_mov_b32 v178, 0
v_mov_b32 v179, 0
v_mov_b32 v180, 0
v_mov_b32 v181, 0
v_mov_b32 v182, 0
v_mov_b32 v183, 0
v_mov_b32 v184, 0
v_mov_b32 v185, 0
v_mov_b32 v186, 0
v_mov_b32 v187, 0
v_mov_b32 v188, 0
v_mov_b32 v189, 0
v_mov_b32 v190, 0
v_mov_b32 v191, 0
v_mov_b32 v192, 0
v_mov_b32 v193, 0
v_mov_b32 v194, 0
v_mov_b32 v195, 0
v_mov_b32 v196, 0
v_mov_b32 v197, 0
v_mov_b32 v198, 0
v_mov_b32 v199, 0
v_mov_b32 v200, 0
v_mov_b32 v201, 0
v_mov_b32 v202, 0
v_mov_b32 v203, 0
v_mov_b32 v204, 0
v_mov_b32 v205, 0
v_mov_b32 v206, 0
v_mov_b32 v207, 0
s_cmp_lt_u32 s93, 128
s_cbranch_scc0 mega_kernel_f1_e
s_lshl_b32 s12, s93, 15
buffer_load_short_d16_hi v144, v12, s[4:7], s12 offen offset:0
buffer_load_short_d16_hi v145, v12, s[4:7], s12 offen offset:2048
buffer_load_short_d16_hi v176, v12, s[4:7], s12 offen offset:1024
buffer_load_short_d16_hi v177, v12, s[4:7], s12 offen offset:3072
buffer_load_short_d16_hi v146, v12, s[4:7], s12 offen offset:64
buffer_load_short_d16_hi v147, v12, s[4:7], s12 offen offset:2112
buffer_load_short_d16_hi v178, v12, s[4:7], s12 offen offset:1088
buffer_load_short_d16_hi v179, v12, s[4:7], s12 offen offset:3136
buffer_load_short_d16_hi v148, v12, s[4:7], s12 offen offset:128
buffer_load_short_d16_hi v149, v12, s[4:7], s12 offen offset:2176
buffer_load_short_d16_hi v180, v12, s[4:7], s12 offen offset:1152
buffer_load_short_d16_hi v181, v12, s[4:7], s12 offen offset:3200
buffer_load_short_d16_hi v150, v12, s[4:7], s12 offen offset:192
buffer_load_short_d16_hi v151, v12, s[4:7], s12 offen offset:2240
buffer_load_short_d16_hi v182, v12, s[4:7], s12 offen offset:1216
buffer_load_short_d16_hi v183, v12, s[4:7], s12 offen offset:3264
buffer_load_short_d16_hi v152, v12, s[4:7], s12 offen offset:256
buffer_load_short_d16_hi v153, v12, s[4:7], s12 offen offset:2304
buffer_load_short_d16_hi v184, v12, s[4:7], s12 offen offset:1280
buffer_load_short_d16_hi v185, v12, s[4:7], s12 offen offset:3328
buffer_load_short_d16_hi v154, v12, s[4:7], s12 offen offset:320
buffer_load_short_d16_hi v155, v12, s[4:7], s12 offen offset:2368
buffer_load_short_d16_hi v186, v12, s[4:7], s12 offen offset:1344
buffer_load_short_d16_hi v187, v12, s[4:7], s12 offen offset:3392
buffer_load_short_d16_hi v156, v12, s[4:7], s12 offen offset:384
buffer_load_short_d16_hi v157, v12, s[4:7], s12 offen offset:2432
buffer_load_short_d16_hi v188, v12, s[4:7], s12 offen offset:1408
buffer_load_short_d16_hi v189, v12, s[4:7], s12 offen offset:3456
buffer_load_short_d16_hi v158, v12, s[4:7], s12 offen offset:448
buffer_load_short_d16_hi v159, v12, s[4:7], s12 offen offset:2496
buffer_load_short_d16_hi v190, v12, s[4:7], s12 offen offset:1472
buffer_load_short_d16_hi v191, v12, s[4:7], s12 offen offset:3520
buffer_load_short_d16_hi v160, v12, s[4:7], s12 offen offset:512
buffer_load_short_d16_hi v161, v12, s[4:7], s12 offen offset:2560
buffer_load_short_d16_hi v192, v12, s[4:7], s12 offen offset:1536
buffer_load_short_d16_hi v193, v12, s[4:7], s12 offen offset:3584
buffer_load_short_d16_hi v162, v12, s[4:7], s12 offen offset:576
buffer_load_short_d16_hi v163, v12, s[4:7], s12 offen offset:2624
buffer_load_short_d16_hi v194, v12, s[4:7], s12 offen offset:1600
buffer_load_short_d16_hi v195, v12, s[4:7], s12 offen offset:3648
buffer_load_short_d16_hi v164, v12, s[4:7], s12 offen offset:640
buffer_load_short_d16_hi v165, v12, s[4:7], s12 offen offset:2688
buffer_load_short_d16_hi v196, v12, s[4:7], s12 offen offset:1664
buffer_load_short_d16_hi v197, v12, s[4:7], s12 offen offset:3712
buffer_load_short_d16_hi v166, v12, s[4:7], s12 offen offset:704
buffer_load_short_d16_hi v167, v12, s[4:7], s12 offen offset:2752
buffer_load_short_d16_hi v198, v12, s[4:7], s12 offen offset:1728
buffer_load_short_d16_hi v199, v12, s[4:7], s12 offen offset:3776
buffer_load_short_d16_hi v168, v12, s[4:7], s12 offen offset:768
buffer_load_short_d16_hi v169, v12, s[4:7], s12 offen offset:2816
buffer_load_short_d16_hi v200, v12, s[4:7], s12 offen offset:1792
buffer_load_short_d16_hi v201, v12, s[4:7], s12 offen offset:3840
buffer_load_short_d16_hi v170, v12, s[4:7], s12 offen offset:832
buffer_load_short_d16_hi v171, v12, s[4:7], s12 offen offset:2880
buffer_load_short_d16_hi v202, v12, s[4:7], s12 offen offset:1856
buffer_load_short_d16_hi v203, v12, s[4:7], s12 offen offset:3904
buffer_load_short_d16_hi v172, v12, s[4:7], s12 offen offset:896
buffer_load_short_d16_hi v173, v12, s[4:7], s12 offen offset:2944
buffer_load_short_d16_hi v204, v12, s[4:7], s12 offen offset:1920
buffer_load_short_d16_hi v205, v12, s[4:7], s12 offen offset:3968
buffer_load_short_d16_hi v174, v12, s[4:7], s12 offen offset:960
buffer_load_short_d16_hi v175, v12, s[4:7], s12 offen offset:3008
buffer_load_short_d16_hi v206, v12, s[4:7], s12 offen offset:1984
buffer_load_short_d16_hi v207, v12, s[4:7], s12 offen offset:4032
s_waitcnt vmcnt(0)
mega_kernel_f1_l:
s_add_u32 s21, s93, 32
s_cmp_lt_u32 s21, 128
s_cselect_b32 s22, s21, s93
s_waitcnt vmcnt(17)
v_pk_add_f32 v[48:49], v[144:145], v[176:177] neg_lo:[0,1] neg_hi:[0,1]
v_pk_add_f32 v[16:17], v[144:145], v[176:177]
v_pk_add_f32 v[14:15], v[146:147], v[178:179] neg_lo:[0,1] neg_hi:[0,1]
v_pk_add_f32 v[18:19], v[146:147], v[178:179]
v_pk_mul_f32 v[50:51], v[14:15], s[50:51] op_sel:[0,0] op_sel_hi:[0,1] neg_lo:[0,0] neg_hi:[0,1]
v_pk_fma_f32 v[50:51], v[14:15], s[50:51], v[50:51] op_sel:[1,1,0] op_sel_hi:[1,0,1] neg_lo:[0,0,0] neg_hi:[0,0,0]
v_pk_add_f32 v[14:15], v[148:149], v[180:181] neg_lo:[0,1] neg_hi:[0,1]
v_pk_add_f32 v[20:21], v[148:149], v[180:181]
v_pk_mul_f32 v[52:53], v[14:15], s[54:55] op_sel:[0,0] op_sel_hi:[0,1] neg_lo:[0,0] neg_hi:[0,1]
v_pk_fma_f32 v[52:53], v[14:15], s[54:55], v[52:53] op_sel:[1,1,0] op_sel_hi:[1,0,1] neg_lo:[0,0,0] neg_hi:[0,0,0]
v_pk_add_f32 v[14:15], v[150:151], v[182:183] neg_lo:[0,1] neg_hi:[0,1]
v_pk_add_f32 v[22:23], v[150:151], v[182:183]
v_pk_mul_f32 v[54:55], v[14:15], s[58:59] op_sel:[0,0] op_sel_hi:[0,1] neg_lo:[0,0] neg_hi:[0,1]
v_pk_fma_f32 v[54:55], v[14:15], s[58:59], v[54:55] op_sel:[1,1,0] op_sel_hi:[1,0,1] neg_lo:[0,0,0] neg_hi:[0,0,0]
v_pk_add_f32 v[14:15], v[152:153], v[184:185] neg_lo:[0,1] neg_hi:[0,1]
v_pk_add_f32 v[24:25], v[152:153], v[184:185]
v_pk_mul_f32 v[56:57], v[14:15], s[62:63] op_sel:[0,0] op_sel_hi:[0,1] neg_lo:[0,0] neg_hi:[0,1]
v_pk_fma_f32 v[56:57], v[14:15], s[62:63], v[56:57] op_sel:[1,1,0] op_sel_hi:[1,0,1] neg_lo:[0,0,0] neg_hi:[0,0,0]
v_pk_add_f32 v[14:15], v[154:155], v[186:187] neg_lo:[0,1] neg_hi:[0,1]
v_pk_add_f32 v[26:27], v[154:155], v[186:187]
v_pk_mul_f32 v[58:59], v[14:15], s[58:59] op_sel:[0,1] op_sel_hi:[0,0] neg_lo:[0,0] neg_hi:[0,1]
v_pk_fma_f32 v[58:59], v[14:15], s[58:59], v[58:59] op_sel:[1,0,0] op_sel_hi:[1,1,1] neg_lo:[0,0,0] neg_hi:[0,0,0]
v_pk_add_f32 v[14:15], v[156:157], v[188:189] neg_lo:[0,1] neg_hi:[0,1]
v_pk_add_f32 v[28:29], v[156:157], v[188:189]
v_pk_mul_f32 v[60:61], v[14:15], s[54:55] op_sel:[0,1] op_sel_hi:[0,0] neg_lo:[0,0] neg_hi:[0,1]
v_pk_fma_f32 v[60:61], v[14:15], s[54:55], v[60:61] op_sel:[1,0,0] op_sel_hi:[1,1,1] neg_lo:[0,0,0] neg_hi:[0,0,0]
v_pk_add_f32 v[14:15], v[158:159], v[190:191] neg_lo:[0,1] neg_hi:[0,1]
v_pk_add_f32 v[30:31], v[158:159], v[190:191]
v_pk_mul_f32 v[62:63], v[14:15], s[50:51] op_sel:[0,1] op_sel_hi:[0,0] neg_lo:[0,0] neg_hi:[0,1]
v_pk_fma_f32 v[62:63], v[14:15], s[50:51], v[62:63] op_sel:[1,0,0] op_sel_hi:[1,1,1] neg_lo:[0,0,0] neg_hi:[0,0,0]
v_pk_add_f32 v[64:65], v[160:161], v[192:193] op_sel:[1,1] op_sel_hi:[0,0] neg_lo:[0,1] neg_hi:[1,0]
v_pk_add_f32 v[32:33], v[160:161], v[192:193]
v_pk_add_f32 v[14:15], v[162:163], v[194:195] neg_lo:[0,1] neg_hi:[0,1]
v_pk_add_f32 v[34:35], v[162:163], v[194:195]
v_pk_mul_f32 v[66:67], v[14:15], s[50:51] op_sel:[0,1] op_sel_hi:[0,0] neg_lo:[0,1] neg_hi:[0,1]
v_pk_fma_f32 v[66:67], v[14:15], s[50:51], v[66:67] op_sel:[1,0,0] op_sel_hi:[1,1,1] neg_lo:[0,0,0] neg_hi:[0,1,0]
v_pk_add_f32 v[14:15], v[164:165], v[196:197] neg_lo:[0,1] neg_hi:[0,1]
v_pk_add_f32 v[36:37], v[164:165], v[196:197]
v_pk_mul_f32 v[68:69], v[14:15], s[54:55] op_sel:[0,1] op_sel_hi:[0,0] neg_lo:[0,1] neg_hi:[0,1]
v_pk_fma_f32 v[68:69], v[14:15], s[54:55], v[68:69] op_sel:[1,0,0] op_sel_hi:[1,1,1] neg_lo:[0,0,0] neg_hi:[0,1,0]
v_pk_add_f32 v[14:15], v[166:167], v[198:199] neg_lo:[0,1] neg_hi:[0,1]
v_pk_add_f32 v[38:39], v[166:167], v[198:199]
v_pk_mul_f32 v[70:71], v[14:15], s[58:59] op_sel:[0,1] op_sel_hi:[0,0] neg_lo:[0,1] neg_hi:[0,1]
v_pk_fma_f32 v[70:71], v[14:15], s[58:59], v[70:71] op_sel:[1,0,0] op_sel_hi:[1,1,1] neg_lo:[0,0,0] neg_hi:[0,1,0]
v_pk_add_f32 v[14:15], v[168:169], v[200:201] neg_lo:[0,1] neg_hi:[0,1]
v_pk_add_f32 v[40:41], v[168:169], v[200:201]
v_pk_mul_f32 v[72:73], v[14:15], s[62:63] op_sel:[0,0] op_sel_hi:[0,1] neg_lo:[0,1] neg_hi:[0,1]
v_pk_fma_f32 v[72:73], v[14:15], s[62:63], v[72:73] op_sel:[1,1,0] op_sel_hi:[1,0,1] neg_lo:[0,0,0] neg_hi:[0,1,0]
v_pk_add_f32 v[14:15], v[170:171], v[202:203] neg_lo:[0,1] neg_hi:[0,1]
v_pk_add_f32 v[42:43], v[170:171], v[202:203]
v_pk_mul_f32 v[74:75], v[14:15], s[58:59] op_sel:[0,0] op_sel_hi:[0,1] neg_lo:[0,1] neg_hi:[0,1]
v_pk_fma_f32 v[74:75], v[14:15], s[58:59], v[74:75] op_sel:[1,1,0] op_sel_hi:[1,0,1] neg_lo:[0,0,0] neg_hi:[0,1,0]
v_pk_add_f32 v[14:15], v[172:173], v[204:205] neg_lo:[0,1] neg_hi:[0,1]
v_pk_add_f32 v[44:45], v[172:173], v[204:205]
v_pk_mul_f32 v[76:77], v[14:15], s[54:55] op_sel:[0,0] op_sel_hi:[0,1] neg_lo:[0,1] neg_hi:[0,1]
v_pk_fma_f32 v[76:77], v[14:15], s[54:55], v[76:77] op_sel:[1,1,0] op_sel_hi:[1,0,1] neg_lo:[0,0,0] neg_hi:[0,1,0]
v_pk_add_f32 v[14:15], v[174:175], v[206:207] neg_lo:[0,1] neg_hi:[0,1]
v_pk_add_f32 v[46:47], v[174:175], v[206:207]
v_pk_mul_f32 v[78:79], v[14:15], s[50:51] op_sel:[0,0] op_sel_hi:[0,1] neg_lo:[0,1] neg_hi:[0,1]
v_pk_fma_f32 v[78:79], v[14:15], s[50:51], v[78:79] op_sel:[1,1,0] op_sel_hi:[1,0,1] neg_lo:[0,0,0] neg_hi:[0,1,0]
s_lshl_b32 s12, s22, 15
buffer_load_short_d16_hi v144, v12, s[4:7], s12 offen offset:0
buffer_load_short_d16_hi v145, v12, s[4:7], s12 offen offset:2048
buffer_load_short_d16_hi v176, v12, s[4:7], s12 offen offset:1024
buffer_load_short_d16_hi v177, v12, s[4:7], s12 offen offset:3072
buffer_load_short_d16_hi v146, v12, s[4:7], s12 offen offset:64
buffer_load_short_d16_hi v147, v12, s[4:7], s12 offen offset:2112
buffer_load_short_d16_hi v178, v12, s[4:7], s12 offen offset:1088
buffer_load_short_d16_hi v179, v12, s[4:7], s12 offen offset:3136
buffer_load_short_d16_hi v148, v12, s[4:7], s12 offen offset:128
buffer_load_short_d16_hi v149, v12, s[4:7], s12 offen offset:2176
buffer_load_short_d16_hi v180, v12, s[4:7], s12 offen offset:1152
buffer_load_short_d16_hi v181, v12, s[4:7], s12 offen offset:3200
buffer_load_short_d16_hi v150, v12, s[4:7], s12 offen offset:192
buffer_load_short_d16_hi v151, v12, s[4:7], s12 offen offset:2240
buffer_load_short_d16_hi v182, v12, s[4:7], s12 offen offset:1216
buffer_load_short_d16_hi v183, v12, s[4:7], s12 offen offset:3264
buffer_load_short_d16_hi v152, v12, s[4:7], s12 offen offset:256
buffer_load_short_d16_hi v153, v12, s[4:7], s12 offen offset:2304
buffer_load_short_d16_hi v184, v12, s[4:7], s12 offen offset:1280
buffer_load_short_d16_hi v185, v12, s[4:7], s12 offen offset:3328
buffer_load_short_d16_hi v154, v12, s[4:7], s12 offen offset:320
buffer_load_short_d16_hi v155, v12, s[4:7], s12 offen offset:2368
buffer_load_short_d16_hi v186, v12, s[4:7], s12 offen offset:1344
buffer_load_short_d16_hi v187, v12, s[4:7], s12 offen offset:3392
buffer_load_short_d16_hi v156, v12, s[4:7], s12 offen offset:384
buffer_load_short_d16_hi v157, v12, s[4:7], s12 offen offset:2432
buffer_load_short_d16_hi v188, v12, s[4:7], s12 offen offset:1408
buffer_load_short_d16_hi v189, v12, s[4:7], s12 offen offset:3456
buffer_load_short_d16_hi v158, v12, s[4:7], s12 offen offset:448
buffer_load_short_d16_hi v159, v12, s[4:7], s12 offen offset:2496
buffer_load_short_d16_hi v190, v12, s[4:7], s12 offen offset:1472
buffer_load_short_d16_hi v191, v12, s[4:7], s12 offen offset:3520
buffer_load_short_d16_hi v160, v12, s[4:7], s12 offen offset:512
buffer_load_short_d16_hi v161, v12, s[4:7], s12 offen offset:2560
buffer_load_short_d16_hi v192, v12, s[4:7], s12 offen offset:1536
buffer_load_short_d16_hi v193, v12, s[4:7], s12 offen offset:3584
buffer_load_short_d16_hi v162, v12, s[4:7], s12 offen offset:576
buffer_load_short_d16_hi v163, v12, s[4:7], s12 offen offset:2624
buffer_load_short_d16_hi v194, v12, s[4:7], s12 offen offset:1600
buffer_load_short_d16_hi v195, v12, s[4:7], s12 offen offset:3648
buffer_load_short_d16_hi v164, v12, s[4:7], s12 offen offset:640
buffer_load_short_d16_hi v165, v12, s[4:7], s12 offen offset:2688
buffer_load_short_d16_hi v196, v12, s[4:7], s12 offen offset:1664
buffer_load_short_d16_hi v197, v12, s[4:7], s12 offen offset:3712
buffer_load_short_d16_hi v166, v12, s[4:7], s12 offen offset:704
buffer_load_short_d16_hi v167, v12, s[4:7], s12 offen offset:2752
buffer_load_short_d16_hi v198, v12, s[4:7], s12 offen offset:1728
buffer_load_short_d16_hi v199, v12, s[4:7], s12 offen offset:3776
buffer_load_short_d16_hi v168, v12, s[4:7], s12 offen offset:768
buffer_load_short_d16_hi v169, v12, s[4:7], s12 offen offset:2816
buffer_load_short_d16_hi v200, v12, s[4:7], s12 offen offset:1792
buffer_load_short_d16_hi v201, v12, s[4:7], s12 offen offset:3840
buffer_load_short_d16_hi v170, v12, s[4:7], s12 offen offset:832
buffer_load_short_d16_hi v171, v12, s[4:7], s12 offen offset:2880
buffer_load_short_d16_hi v202, v12, s[4:7], s12 offen offset:1856
buffer_load_short_d16_hi v203, v12, s[4:7], s12 offen offset:3904
buffer_load_short_d16_hi v172, v12, s[4:7], s12 offen offset:896
buffer_load_short_d16_hi v173, v12, s[4:7], s12 offen offset:2944
buffer_load_short_d16_hi v204, v12, s[4:7], s12 offen offset:1920
buffer_load_short_d16_hi v205, v12, s[4:7], s12 offen offset:3968
buffer_load_short_d16_hi v174, v12, s[4:7], s12 offen offset:960
buffer_load_short_d16_hi v175, v12, s[4:7], s12 offen offset:3008
buffer_load_short_d16_hi v206, v12, s[4:7], s12 offen offset:1984
buffer_load_short_d16_hi v207, v12, s[4:7], s12 offen offset:4032
v_pk_add_f32 v[14:15], v[16:17], v[32:33] neg_lo:[0,1] neg_hi:[0,1]
v_pk_add_f32 v[16:17], v[16:17], v[32:33]
v_pk_add_f32 v[32:33], v[18:19], v[34:35] neg_lo:[0,1] neg_hi:[0,1]
v_pk_add_f32 v[18:19], v[18:19], v[34:35]
v_pk_mul_f32 v[34:35], v[32:33], s[54:55] op_sel:[0,0] op_sel_hi:[0,1] neg_lo:[0,0] neg_hi:[0,1]
v_pk_fma_f32 v[34:35], v[32:33], s[54:55], v[34:35] op_sel:[1,1,0] op_sel_hi:[1,0,1] neg_lo:[0,0,0] neg_hi:[0,0,0]
v_pk_add_f32 v[32:33], v[20:21], v[36:37] neg_lo:[0,1] neg_hi:[0,1]
v_pk_add_f32 v[20:21], v[20:21], v[36:37]
v_pk_mul_f32 v[36:37], v[32:33], s[62:63] op_sel:[0,0] op_sel_hi:[0,1] neg_lo:[0,0] neg_hi:[0,1]
v_pk_fma_f32 v[36:37], v[32:33], s[62:63], v[36:37] op_sel:[1,1,0] op_sel_hi:[1,0,1] neg_lo:[0,0,0] neg_hi:[0,0,0]
v_pk_add_f32 v[32:33], v[22:23], v[38:39] neg_lo:[0,1] neg_hi:[0,1]
v_pk_add_f32 v[22:23], v[22:23], v[38:39]
v_pk_mul_f32 v[38:39], v[32:33], s[54:55] op_sel:[0,1] op_sel_hi:[0,0] neg_lo:[0,0] neg_hi:[0,1]
v_pk_fma_f32 v[38:39], v[32:33], s[54:55], v[38:39] op_sel:[1,0,0] op_sel_hi:[1,1,1] neg_lo:[0,0,0] neg_hi:[0,0,0]
v_pk_add_f32 v[32:33], v[24:25], v[40:41] op_sel:[1,1] op_sel_hi:[0,0] neg_lo:[0,1] neg_hi:[1,0]
v_pk_add_f32 v[24:25], v[24:25], v[40:41]
v_pk_add_f32 v[40:41], v[26:27], v[42:43] neg_lo:[0,1] neg_hi:[0,1]
v_pk_add_f32 v[26:27], v[26:27], v[42:43]
v_pk_mul_f32 v[42:43], v[40:41], s[54:55] op_sel:[0,1] op_sel_hi:[0,0] neg_lo:[0,1] neg_hi:[0,1]
v_pk_fma_f32 v[42:43], v[40:41], s[54:55], v[42:43] op_sel:[1,0,0] op_sel_hi:[1,1,1] neg_lo:[0,0,0] neg_hi:[0,1,0]
v_pk_add_f32 v[40:41], v[28:29], v[44:45] neg_lo:[0,1] neg_hi:[0,1]
v_pk_add_f32 v[28:29], v[28:29], v[44:45]
v_pk_mul_f32 v[44:45], v[40:41], s[62:63] op_sel:[0,0] op_sel_hi:[0,1] neg_lo:[0,1] neg_hi:[0,1]
v_pk_fma_f32 v[44:45], v[40:41], s[62:63], v[44:45] op_sel:[1,1,0] op_sel_hi:[1,0,1] neg_lo:[0,0,0] neg_hi:[0,1,0]
v_pk_add_f32 v[40:41], v[30:31], v[46:47] neg_lo:[0,1] neg_hi:[0,1]
v_pk_add_f32 v[30:31], v[30:31], v[46:47]
v_pk_mul_f32 v[46:47], v[40:41], s[54:55] op_sel:[0,0] op_sel_hi:[0,1] neg_lo:[0,1] neg_hi:[0,1]
v_pk_fma_f32 v[46:47], v[40:41], s[54:55], v[46:47] op_sel:[1,1,0] op_sel_hi:[1,0,1] neg_lo:[0,0,0] neg_hi:[0,1,0]
v_pk_add_f32 v[40:41], v[48:49], v[64:65] neg_lo:[0,1] neg_hi:[0,1]
v_pk_add_f32 v[48:49], v[48:49], v[64:65]
v_pk_add_f32 v[64:65], v[50:51], v[66:67] neg_lo:[0,1] neg_hi:[0,1]
v_pk_add_f32 v[50:51], v[50:51], v[66:67]
v_pk_mul_f32 v[66:67], v[64:65], s[54:55] op_sel:[0,0] op_sel_hi:[0,1] neg_lo:[0,0] neg_hi:[0,1]
v_pk_fma_f32 v[66:67], v[64:65], s[54:55], v[66:67] op_sel:[1,1,0] op_sel_hi:[1,0,1] neg_lo:[0,0,0] neg_hi:[0,0,0]
v_pk_add_f32 v[64:65], v[52:53], v[68:69] neg_lo:[0,1] neg_hi:[0,1]
v_pk_add_f32 v[52:53], v[52:53], v[68:69]
v_pk_mul_f32 v[68:69], v[64:65], s[62:63] op_sel:[0,0] op_sel_hi:[0,1] neg_lo:[0,0] neg_hi:[0,1]
v_pk_fma_f32 v[68:69], v[64:65], s[62:63], v[68:69] op_sel:[1,1,0] op_sel_hi:[1,0,1] neg_lo:[0,0,0] neg_hi:[0,0,0]
v_pk_add_f32 v[64:65], v[54:55], v[70:71] neg_lo:[0,1] neg_hi:[0,1]
v_pk_add_f32 v[54:55], v[54:55], v[70:71]
v_pk_mul_f32 v[70:71], v[64:65], s[54:55] op_sel:[0,1] op_sel_hi:[0,0] neg_lo:[0,0] neg_hi:[0,1]
v_pk_fma_f32 v[70:71], v[64:65], s[54:55], v[70:71] op_sel:[1,0,0] op_sel_hi:[1,1,1] neg_lo:[0,0,0] neg_hi:[0,0,0]
v_pk_add_f32 v[64:65], v[56:57], v[72:73] op_sel:[1,1] op_sel_hi:[0,0] neg_lo:[0,1] neg_hi:[1,0]
v_pk_add_f32 v[56:57], v[56:57], v[72:73]
v_pk_add_f32 v[72:73], v[58:59], v[74:75] neg_lo:[0,1] neg_hi:[0,1]
v_pk_add_f32 v[58:59], v[58:59], v[74:75]
v_pk_mul_f32 v[74:75], v[72:73], s[54:55] op_sel:[0,1] op_sel_hi:[0,0] neg_lo:[0,1] neg_hi:[0,1]
v_pk_fma_f32 v[74:75], v[72:73], s[54:55], v[74:75] op_sel:[1,0,0] op_sel_hi:[1,1,1] neg_lo:[0,0,0] neg_hi:[0,1,0]
v_pk_add_f32 v[72:73], v[60:61], v[76:77] neg_lo:[0,1] neg_hi:[0,1]
v_pk_add_f32 v[60:61], v[60:61], v[76:77]
v_pk_mul_f32 v[76:77], v[72:73], s[62:63] op_sel:[0,0] op_sel_hi:[0,1] neg_lo:[0,1] neg_hi:[0,1]
v_pk_fma_f32 v[76:77], v[72:73], s[62:63], v[76:77] op_sel:[1,1,0] op_sel_hi:[1,0,1] neg_lo:[0,0,0] neg_hi:[0,1,0]
v_pk_add_f32 v[72:73], v[62:63], v[78:79] neg_lo:[0,1] neg_hi:[0,1]
v_pk_add_f32 v[62:63], v[62:63], v[78:79]
v_pk_mul_f32 v[78:79], v[72:73], s[54:55] op_sel:[0,0] op_sel_hi:[0,1] neg_lo:[0,1] neg_hi:[0,1]
v_pk_fma_f32 v[78:79], v[72:73], s[54:55], v[78:79] op_sel:[1,1,0] op_sel_hi:[1,0,1] neg_lo:[0,0,0] neg_hi:[0,1,0]
v_pk_add_f32 v[72:73], v[16:17], v[24:25] neg_lo:[0,1] neg_hi:[0,1]
v_pk_add_f32 v[16:17], v[16:17], v[24:25]
v_pk_add_f32 v[24:25], v[18:19], v[26:27] neg_lo:[0,1] neg_hi:[0,1]
v_pk_add_f32 v[18:19], v[18:19], v[26:27]
v_pk_mul_f32 v[26:27], v[24:25], s[62:63] op_sel:[0,0] op_sel_hi:[0,1] neg_lo:[0,0] neg_hi:[0,1]
v_pk_fma_f32 v[26:27], v[24:25], s[62:63], v[26:27] op_sel:[1,1,0] op_sel_hi:[1,0,1] neg_lo:[0,0,0] neg_hi:[0,0,0]
v_pk_add_f32 v[24:25], v[20:21], v[28:29] op_sel:[1,1] op_sel_hi:[0,0] neg_lo:[0,1] neg_hi:[1,0]
v_pk_add_f32 v[20:21], v[20:21], v[28:29]
v_pk_add_f32 v[28:29], v[22:23], v[30:31] neg_lo:[0,1] neg_hi:[0,1]
v_pk_add_f32 v[22:23], v[22:23], v[30:31]
v_pk_mul_f32 v[30:31], v[28:29], s[62:63] op_sel:[0,0] op_sel_hi:[0,1] neg_lo:[0,1] neg_hi:[0,1]
v_pk_fma_f32 v[30:31], v[28:29], s[62:63], v[30:31] op_sel:[1,1,0] op_sel_hi:[1,0,1] neg_lo:[0,0,0] neg_hi:[0,1,0]
v_pk_add_f32 v[28:29], v[14:15], v[32:33] neg_lo:[0,1] neg_hi:[0,1]
v_pk_add_f32 v[14:15], v[14:15], v[32:33]
v_pk_add_f32 v[32:33], v[34:35], v[42:43] neg_lo:[0,1] neg_hi:[0,1]
v_pk_add_f32 v[34:35], v[34:35], v[42:43]
v_pk_mul_f32 v[42:43], v[32:33], s[62:63] op_sel:[0,0] op_sel_hi:[0,1] neg_lo:[0,0] neg_hi:[0,1]
v_pk_fma_f32 v[42:43], v[32:33], s[62:63], v[42:43] op_sel:[1,1,0] op_sel_hi:[1,0,1] neg_lo:[0,0,0] neg_hi:[0,0,0]
v_pk_add_f32 v[32:33], v[36:37], v[44:45] op_sel:[1,1] op_sel_hi:[0,0] neg_lo:[0,1] neg_hi:[1,0]
v_pk_add_f32 v[36:37], v[36:37], v[44:45]
v_pk_add_f32 v[44:45], v[38:39], v[46:47] neg_lo:[0,1] neg_hi:[0,1]
v_pk_add_f32 v[38:39], v[38:39], v[46:47]
v_pk_mul_f32 v[46:47], v[44:45], s[62:63] op_sel:[0,0] op_sel_hi:[0,1] neg_lo:[0,1] neg_hi:[0,1]
v_pk_fma_f32 v[46:47], v[44:45], s[62:63], v[46:47] op_sel:[1,1,0] op_sel_hi:[1,0,1] neg_lo:[0,0,0] neg_hi:[0,1,0]
v_pk_add_f32 v[44:45], v[48:49], v[56:57] neg_lo:[0,1] neg_hi:[0,1]
v_pk_add_f32 v[48:49], v[48:49], v[56:57]
v_pk_add_f32 v[56:57], v[50:51], v[58:59] neg_lo:[0,1] neg_hi:[0,1]
v_pk_add_f32 v[50:51], v[50:51], v[58:59]
v_pk_mul_f32 v[58:59], v[56:57], s[62:63] op_sel:[0,0] op_sel_hi:[0,1] neg_lo:[0,0] neg_hi:[0,1]
v_pk_fma_f32 v[58:59], v[56:57], s[62:63], v[58:59] op_sel:[1,1,0] op_sel_hi:[1,0,1] neg_lo:[0,0,0] neg_hi:[0,0,0]
v_pk_add_f32 v[56:57], v[52:53], v[60:61] op_sel:[1,1] op_sel_hi:[0,0] neg_lo:[0,1] neg_hi:[1,0]
v_pk_add_f32 v[52:53], v[52:53], v[60:61]
v_pk_add_f32 v[60:61], v[54:55], v[62:63] neg_lo:[0,1] neg_hi:[0,1]
v_pk_add_f32 v[54:55], v[54:55], v[62:63]
v_pk_mul_f32 v[62:63], v[60:61], s[62:63] op_sel:[0,0] op_sel_hi:[0,1] neg_lo:[0,1] neg_hi:[0,1]
v_pk_fma_f32 v[62:63], v[60:61], s[62:63], v[62:63] op_sel:[1,1,0] op_sel_hi:[1,0,1] neg_lo:[0,0,0] neg_hi:[0,1,0]
v_pk_add_f32 v[60:61], v[40:41], v[64:65] neg_lo:[0,1] neg_hi:[0,1]
v_pk_add_f32 v[40:41], v[40:41], v[64:65]
v_pk_add_f32 v[64:65], v[66:67], v[74:75] neg_lo:[0,1] neg_hi:[0,1]
v_pk_add_f32 v[66:67], v[66:67], v[74:75]
v_pk_mul_f32 v[74:75], v[64:65], s[62:63] op_sel:[0,0] op_sel_hi:[0,1] neg_lo:[0,0] neg_hi:[0,1]
v_pk_fma_f32 v[74:75], v[64:65], s[62:63], v[74:75] op_sel:[1,1,0] op_sel_hi:[1,0,1] neg_lo:[0,0,0] neg_hi:[0,0,0]
v_pk_add_f32 v[64:65], v[68:69], v[76:77] op_sel:[1,1] op_sel_hi:[0,0] neg_lo:[0,1] neg_hi:[1,0]
v_pk_add_f32 v[68:69], v[68:69], v[76:77]
v_pk_add_f32 v[76:77], v[70:71], v[78:79] neg_lo:[0,1] neg_hi:[0,1]
v_pk_add_f32 v[70:71], v[70:71], v[78:79]
v_pk_mul_f32 v[78:79], v[76:77], s[62:63] op_sel:[0,0] op_sel_hi:[0,1] neg_lo:[0,1] neg_hi:[0,1]
v_pk_fma_f32 v[78:79], v[76:77], s[62:63], v[78:79] op_sel:[1,1,0] op_sel_hi:[1,0,1] neg_lo:[0,0,0] neg_hi:[0,1,0]
v_pk_add_f32 v[76:77], v[16:17], v[20:21] neg_lo:[0,1] neg_hi:[0,1]
v_pk_add_f32 v[16:17], v[16:17], v[20:21]
v_pk_add_f32 v[20:21], v[18:19], v[22:23] op_sel:[1,1] op_sel_hi:[0,0] neg_lo:[0,1] neg_hi:[1,0]
v_pk_add_f32 v[18:19], v[18:19], v[22:23]
v_pk_add_f32 v[22:23], v[72:73], v[24:25] neg_lo:[0,1] neg_hi:[0,1]
v_pk_add_f32 v[72:73], v[72:73], v[24:25]
v_pk_add_f32 v[24:25], v[26:27], v[30:31] op_sel:[1,1] op_sel_hi:[0,0] neg_lo:[0,1] neg_hi:[1,0]
v_pk_add_f32 v[26:27], v[26:27], v[30:31]
v_pk_add_f32 v[30:31], v[14:15], v[36:37] neg_lo:[0,1] neg_hi:[0,1]
v_pk_add_f32 v[14:15], v[14:15], v[36:37]
v_pk_add_f32 v[36:37], v[34:35], v[38:39] op_sel:[1,1] op_sel_hi:[0,0] neg_lo:[0,1] neg_hi:[1,0]
v_pk_add_f32 v[34:35], v[34:35], v[38:39]
v_pk_add_f32 v[38:39], v[28:29], v[32:33] neg_lo:[0,1] neg_hi:[0,1]
v_pk_add_f32 v[28:29], v[28:29], v[32:33]
v_pk_add_f32 v[32:33], v[42:43], v[46:47] op_sel:[1,1] op_sel_hi:[0,0] neg_lo:[0,1] neg_hi:[1,0]
v_pk_add_f32 v[42:43], v[42:43], v[46:47]
v_pk_add_f32 v[46:47], v[48:49], v[52:53] neg_lo:[0,1] neg_hi:[0,1]
v_pk_add_f32 v[48:49], v[48:49], v[52:53]
v_pk_add_f32 v[52:53], v[50:51], v[54:55] op_sel:[1,1] op_sel_hi:[0,0] neg_lo:[0,1] neg_hi:[1,0]
v_pk_add_f32 v[50:51], v[50:51], v[54:55]
v_pk_add_f32 v[54:55], v[44:45], v[56:57] neg_lo:[0,1] neg_hi:[0,1]
v_pk_add_f32 v[44:45], v[44:45], v[56:57]
v_pk_add_f32 v[56:57], v[58:59], v[62:63] op_sel:[1,1] op_sel_hi:[0,0] neg_lo:[0,1] neg_hi:[1,0]
v_pk_add_f32 v[58:59], v[58:59], v[62:63]
v_pk_add_f32 v[62:63], v[40:41], v[68:69] neg_lo:[0,1] neg_hi:[0,1]
v_pk_add_f32 v[40:41], v[40:41], v[68:69]
v_pk_add_f32 v[68:69], v[66:67], v[70:71] op_sel:[1,1] op_sel_hi:[0,0] neg_lo:[0,1] neg_hi:[1,0]
v_pk_add_f32 v[66:67], v[66:67], v[70:71]
v_pk_add_f32 v[70:71], v[60:61], v[64:65] neg_lo:[0,1] neg_hi:[0,1]
v_pk_add_f32 v[60:61], v[60:61], v[64:65]
v_pk_add_f32 v[64:65], v[74:75], v[78:79] op_sel:[1,1] op_sel_hi:[0,0] neg_lo:[0,1] neg_hi:[1,0]
v_pk_add_f32 v[74:75], v[74:75], v[78:79]
v_pk_add_f32 v[78:79], v[16:17], v[18:19] neg_lo:[0,1] neg_hi:[0,1]
v_pk_add_f32 v[16:17], v[16:17], v[18:19]
v_pk_add_f32 v[18:19], v[76:77], v[20:21] neg_lo:[0,1] neg_hi:[0,1]
v_pk_add_f32 v[76:77], v[76:77], v[20:21]
v_pk_add_f32 v[20:21], v[72:73], v[26:27] neg_lo:[0,1] neg_hi:[0,1]
v_pk_add_f32 v[72:73], v[72:73], v[26:27]
v_pk_add_f32 v[26:27], v[22:23], v[24:25] neg_lo:[0,1] neg_hi:[0,1]
v_pk_add_f32 v[22:23], v[22:23], v[24:25]
v_pk_add_f32 v[24:25], v[14:15], v[34:35] neg_lo:[0,1] neg_hi:[0,1]
v_pk_add_f32 v[14:15], v[14:15], v[34:35]
v_pk_add_f32 v[34:35], v[30:31], v[36:37] neg_lo:[0,1] neg_hi:[0,1]
v_pk_add_f32 v[30:31], v[30:31], v[36:37]
v_pk_add_f32 v[36:37], v[28:29], v[42:43] neg_lo:[0,1] neg_hi:[0,1]
v_pk_add_f32 v[28:29], v[28:29], v[42:43]
v_pk_add_f32 v[42:43], v[38:39], v[32:33] neg_lo:[0,1] neg_hi:[0,1]
v_pk_add_f32 v[38:39], v[38:39], v[32:33]
v_pk_add_f32 v[32:33], v[48:49], v[50:51] neg_lo:[0,1] neg_hi:[0,1]
v_pk_add_f32 v[48:49], v[48:49], v[50:51]
v_pk_add_f32 v[50:51], v[46:47], v[52:53] neg_lo:[0,1] neg_hi:[0,1]
v_pk_add_f32 v[46:47], v[46:47], v[52:53]
v_pk_add_f32 v[52:53], v[44:45], v[58:59] neg_lo:[0,1] neg_hi:[0,1]
v_pk_add_f32 v[44:45], v[44:45], v[58:59]
v_pk_add_f32 v[58:59], v[54:55], v[56:57] neg_lo:[0,1] neg_hi:[0,1]
v_pk_add_f32 v[54:55], v[54:55], v[56:57]
v_pk_add_f32 v[56:57], v[40:41], v[66:67] neg_lo:[0,1] neg_hi:[0,1]
v_pk_add_f32 v[40:41], v[40:41], v[66:67]
v_pk_add_f32 v[66:67], v[62:63], v[68:69] neg_lo:[0,1] neg_hi:[0,1]
v_pk_add_f32 v[62:63], v[62:63], v[68:69]
v_pk_add_f32 v[68:69], v[60:61], v[74:75] neg_lo:[0,1] neg_hi:[0,1]
v_pk_add_f32 v[60:61], v[60:61], v[74:75]
v_pk_add_f32 v[74:75], v[70:71], v[64:65] neg_lo:[0,1] neg_hi:[0,1]
v_pk_add_f32 v[70:71], v[70:71], v[64:65]
v_pk_mul_f32 v[64:65], v[48:49], v[82:83] op_sel:[0,0] op_sel_hi:[0,1] neg_lo:[0,0] neg_hi:[0,0]
v_pk_fma_f32 v[48:49], v[48:49], v[82:83], v[64:65] op_sel:[1,1,0] op_sel_hi:[1,0,1] neg_lo:[0,1,0] neg_hi:[0,0,0]
v_pk_mul_f32 v[64:65], v[14:15], v[84:85] op_sel:[0,0] op_sel_hi:[0,1] neg_lo:[0,0] neg_hi:[0,0]
v_pk_fma_f32 v[14:15], v[14:15], v[84:85], v[64:65] op_sel:[1,1,0] op_sel_hi:[1,0,1] neg_lo:[0,1,0] neg_hi:[0,0,0]
v_pk_mul_f32 v[64:65], v[40:41], v[86:87] op_sel:[0,0] op_sel_hi:[0,1] neg_lo:[0,0] neg_hi:[0,0]
v_pk_fma_f32 v[40:41], v[40:41], v[86:87], v[64:65] op_sel:[1,1,0] op_sel_hi:[1,0,1] neg_lo:[0,1,0] neg_hi:[0,0,0]
v_pk_mul_f32 v[64:65], v[72:73], v[88:89] op_sel:[0,0] op_sel_hi:[0,1] neg_lo:[0,0] neg_hi:[0,0]
v_pk_fma_f32 v[72:73], v[72:73], v[88:89], v[64:65] op_sel:[1,1,0] op_sel_hi:[1,0,1] neg_lo:[0,1,0] neg_hi:[0,0,0]
v_pk_mul_f32 v[64:65], v[44:45], v[90:91] op_sel:[0,0] op_sel_hi:[0,1] neg_lo:[0,0] neg_hi:[0,0]
v_pk_fma_f32 v[44:45], v[44:45], v[90:91], v[64:65] op_sel:[1,1,0] op_sel_hi:[1,0,1] neg_lo:[0,1,0] neg_hi:[0,0,0]
v_pk_mul_f32 v[64:65], v[28:29], v[92:93] op_sel:[0,0] op_sel_hi:[0,1] neg_lo:[0,0] neg_hi:[0,0]
v_pk_fma_f32 v[28:29], v[28:29], v[92:93], v[64:65] op_sel:[1,1,0] op_sel_hi:[1,0,1] neg_lo:[0,1,0] neg_hi:[0,0,0]
v_pk_mul_f32 v[64:65], v[60:61], v[94:95] op_sel:[0,0] op_sel_hi:[0,1] neg_lo:[0,0] neg_hi:[0,0]
v_pk_fma_f32 v[60:61], v[60:61], v[94:95], v[64:65] op_sel:[1,1,0] op_sel_hi:[1,0,1] neg_lo:[0,1,0] neg_hi:[0,0,0]
v_pk_mul_f32 v[64:65], v[76:77], v[96:97] op_sel:[0,0] op_sel_hi:[0,1] neg_lo:[0,0] neg_hi:[0,0]
v_pk_fma_f32 v[76:77], v[76:77], v[96:97], v[64:65] op_sel:[1,1,0] op_sel_hi:[1,0,1] neg_lo:[0,1,0] neg_hi:[0,0,0]
v_pk_mul_f32 v[64:65], v[46:47], v[98:99] op_sel:[0,0] op_sel_hi:[0,1] neg_lo:[0,0] neg_hi:[0,0]
v_pk_fma_f32 v[46:47], v[46:47], v[98:99], v[64:65] op_sel:[1,1,0] op_sel_hi:[1,0,1] neg_lo:[0,1,0] neg_hi:[0,0,0]
v_pk_mul_f32 v[64:65], v[30:31], v[100:101] op_sel:[0,0] op_sel_hi:[0,1] neg_lo:[0,0] neg_hi:[0,0]
v_pk_fma_f32 v[30:31], v[30:31], v[100:101], v[64:65] op_sel:[1,1,0] op_sel_hi:[1,0,1] neg_lo:[0,1,0] neg_hi:[0,0,0]
v_pk_mul_f32 v[64:65], v[62:63], v[102:103] op_sel:[0,0] op_sel_hi:[0,1] neg_lo:[0,0] neg_hi:[0,0]
v_pk_fma_f32 v[62:63], v[62:63], v[102:103], v[64:65] op_sel:[1,1,0] op_sel_hi:[1,0,1] neg_lo:[0,1,0] neg_hi:[0,0,0]
v_pk_mul_f32 v[64:65], v[22:23], v[104:105] op_sel:[0,0] op_sel_hi:[0,1] neg_lo:[0,0] neg_hi:[0,0]
v_pk_fma_f32 v[22:23], v[22:23], v[104:105], v[64:65] op_sel:[1,1,0] op_sel_hi:[1,0,1] neg_lo:[0,1,0] neg_hi:[0,0,0]
v_pk_mul_f32 v[64:65], v[54:55], v[106:107] op_sel:[0,0] op_sel_hi:[0,1] neg_lo:[0,0] neg_hi:[0,0]
v_pk_fma_f32 v[54:55], v[54:55], v[106:107], v[64:65] op_sel:[1,1,0] op_sel_hi:[1,0,1] neg_lo:[0,1,0] neg_hi:[0,0,0]
v_pk_mul_f32 v[64:65], v[38:39], v[108:109] op_sel:[0,0] op_sel_hi:[0,1] neg_lo:[0,0] neg_hi:[0,0]
v_pk_fma_f32 v[38:39], v[38:39], v[108:109], v[64:65] op_sel:[1,1,0] op_sel_hi:[1,0,1] neg_lo:[0,1,0] neg_hi:[0,0,0]
v_pk_mul_f32 v[64:65], v[70:71], v[110:111] op_sel:[0,0] op_sel_hi:[0,1] neg_lo:[0,0] neg_hi:[0,0]
v_pk_fma_f32 v[70:71], v[70:71], v[110:111], v[64:65] op_sel:[1,1,0] op_sel_hi:[1,0,1] neg_lo:[0,1,0] neg_hi:[0,0,0]
v_pk_mul_f32 v[64:65], v[78:79], v[112:113] op_sel:[0,0] op_sel_hi:[0,1] neg_lo:[0,0] neg_hi:[0,0]
v_pk_fma_f32 v[78:79], v[78:79], v[112:113], v[64:65] op_sel:[1,1,0] op_sel_hi:[1,0,1] neg_lo:[0,1,0] neg_hi:[0,0,0]
v_pk_mul_f32 v[64:65], v[32:33], v[114:115] op_sel:[0,0] op_sel_hi:[0,1] neg_lo:[0,0] neg_hi:[0,0]
v_pk_fma_f32 v[32:33], v[32:33], v[114:115], v[64:65] op_sel:[1,1,0] op_sel_hi:[1,0,1] neg_lo:[0,1,0] neg_hi:[0,0,0]
v_pk_mul_f32 v[64:65], v[24:25], v[116:117] op_sel:[0,0] op_sel_hi:[0,1] neg_lo:[0,0] neg_hi:[0,0]
v_pk_fma_f32 v[24:25], v[24:25], v[116:117], v[64:65] op_sel:[1,1,0] op_sel_hi:[1,0,1] neg_lo:[0,1,0] neg_hi:[0,0,0]
v_pk_mul_f32 v[64:65], v[56:57], v[118:119] op_sel:[0,0] op_sel_hi:[0,1] neg_lo:[0,0] neg_hi:[0,0]
v_pk_fma_f32 v[56:57], v[56:57], v[118:119], v[64:65] op_sel:[1,1,0] op_sel_hi:[1,0,1] neg_lo:[0,1,0] neg_hi:[0,0,0]
v_pk_mul_f32 v[64:65], v[20:21], v[120:121] op_sel:[0,0] op_sel_hi:[0,1] neg_lo:[0,0] neg_hi:[0,0]
v_pk_fma_f32 v[20:21], v[20:21], v[120:121], v[64:65] op_sel:[1,1,0] op_sel_hi:[1,0,1] neg_lo:[0,1,0] neg_hi:[0,0,0]
v_pk_mul_f32 v[64:65], v[52:53], v[122:123] op_sel:[0,0] op_sel_hi:[0,1] neg_lo:[0,0] neg_hi:[0,0]
v_pk_fma_f32 v[52:53], v[52:53], v[122:123], v[64:65] op_sel:[1,1,0] op_sel_hi:[1,0,1] neg_lo:[0,1,0] neg_hi:[0,0,0]
v_pk_mul_f32 v[64:65], v[36:37], v[124:125] op_sel:[0,0] op_sel_hi:[0,1] neg_lo:[0,0] neg_hi:[0,0]
v_pk_fma_f32 v[36:37], v[36:37], v[124:125], v[64:65] op_sel:[1,1,0] op_sel_hi:[1,0,1] neg_lo:[0,1,0] neg_hi:[0,0,0]
v_pk_mul_f32 v[64:65], v[68:69], v[126:127] op_sel:[0,0] op_sel_hi:[0,1] neg_lo:[0,0] neg_hi:[0,0]
v_pk_fma_f32 v[68:69], v[68:69], v[126:127], v[64:65] op_sel:[1,1,0] op_sel_hi:[1,0,1] neg_lo:[0,1,0] neg_hi:[0,0,0]
v_pk_mul_f32 v[64:65], v[18:19], v[128:129] op_sel:[0,0] op_sel_hi:[0,1] neg_lo:[0,0] neg_hi:[0,0]
v_pk_fma_f32 v[18:19], v[18:19], v[128:129], v[64:65] op_sel:[1,1,0] op_sel_hi:[1,0,1] neg_lo:[0,1,0] neg_hi:[0,0,0]
v_pk_mul_f32 v[64:65], v[50:51], v[130:131] op_sel:[0,0] op_sel_hi:[0,1] neg_lo:[0,0] neg_hi:[0,0]
v_pk_fma_f32 v[50:51], v[50:51], v[130:131], v[64:65] op_sel:[1,1,0] op_sel_hi:[1,0,1] neg_lo:[0,1,0] neg_hi:[0,0,0]
v_pk_mul_f32 v[64:65], v[34:35], v[132:133] op_sel:[0,0] op_sel_hi:[0,1] neg_lo:[0,0] neg_hi:[0,0]
v_pk_fma_f32 v[34:35], v[34:35], v[132:133], v[64:65] op_sel:[1,1,0] op_sel_hi:[1,0,1] neg_lo:[0,1,0] neg_hi:[0,0,0]
v_pk_mul_f32 v[64:65], v[66:67], v[134:135] op_sel:[0,0] op_sel_hi:[0,1] neg_lo:[0,0] neg_hi:[0,0]
v_pk_fma_f32 v[66:67], v[66:67], v[134:135], v[64:65] op_sel:[1,1,0] op_sel_hi:[1,0,1] neg_lo:[0,1,0] neg_hi:[0,0,0]
v_pk_mul_f32 v[64:65], v[26:27], v[136:137] op_sel:[0,0] op_sel_hi:[0,1] neg_lo:[0,0] neg_hi:[0,0]
v_pk_fma_f32 v[26:27], v[26:27], v[136:137], v[64:65] op_sel:[1,1,0] op_sel_hi:[1,0,1] neg_lo:[0,1,0] neg_hi:[0,0,0]
v_pk_mul_f32 v[64:65], v[58:59], v[138:139] op_sel:[0,0] op_sel_hi:[0,1] neg_lo:[0,0] neg_hi:[0,0]
v_pk_fma_f32 v[58:59], v[58:59], v[138:139], v[64:65] op_sel:[1,1,0] op_sel_hi:[1,0,1] neg_lo:[0,1,0] neg_hi:[0,0,0]
v_pk_mul_f32 v[64:65], v[42:43], v[140:141] op_sel:[0,0] op_sel_hi:[0,1] neg_lo:[0,0] neg_hi:[0,0]
v_pk_fma_f32 v[42:43], v[42:43], v[140:141], v[64:65] op_sel:[1,1,0] op_sel_hi:[1,0,1] neg_lo:[0,1,0] neg_hi:[0,0,0]
v_pk_mul_f32 v[64:65], v[74:75], v[142:143] op_sel:[0,0] op_sel_hi:[0,1] neg_lo:[0,0] neg_hi:[0,0]
v_pk_fma_f32 v[74:75], v[74:75], v[142:143], v[64:65] op_sel:[1,1,0] op_sel_hi:[1,0,1] neg_lo:[0,1,0] neg_hi:[0,0,0]
s_barrier
ds_write_b64 v4, v[16:17] offset:0
ds_write_b64 v4, v[48:49] offset:264
ds_write_b64 v4, v[14:15] offset:528
ds_write_b64 v4, v[40:41] offset:792
ds_write_b64 v4, v[72:73] offset:1056
ds_write_b64 v4, v[44:45] offset:1320
ds_write_b64 v4, v[28:29] offset:1584
ds_write_b64 v4, v[60:61] offset:1848
ds_write_b64 v4, v[76:77] offset:2112
ds_write_b64 v4, v[46:47] offset:2376
ds_write_b64 v4, v[30:31] offset:2640
ds_write_b64 v4, v[62:63] offset:2904
ds_write_b64 v4, v[22:23] offset:3168
ds_write_b64 v4, v[54:55] offset:3432
ds_write_b64 v4, v[38:39] offset:3696
ds_write_b64 v4, v[70:71] offset:3960
ds_write_b64 v4, v[78:79] offset:4224
ds_write_b64 v4, v[32:33] offset:4488
ds_write_b64 v4, v[24:25] offset:4752
ds_write_b64 v4, v[56:57] offset:5016
ds_write_b64 v4, v[20:21] offset:5280
ds_write_b64 v4, v[52:53] offset:5544
ds_write_b64 v4, v[36:37] offset:5808
ds_write_b64 v4, v[68:69] offset:6072
ds_write_b64 v4, v[18:19] offset:6336
ds_write_b64 v4, v[50:51] offset:6600
ds_write_b64 v4, v[34:35] offset:6864
ds_write_b64 v4, v[66:67] offset:7128
ds_write_b64 v4, v[26:27] offset:7392
ds_write_b64 v4, v[58:59] offset:7656
ds_write_b64 v4, v[42:43] offset:7920
ds_write_b64 v4, v[74:75] offset:8184
s_waitcnt lgkmcnt(0)
ds_read_b64 v[16:17], v5 offset:0
ds_read_b64 v[48:49], v5 offset:128
ds_read_b64 v[18:19], v5 offset:8
ds_read_b64 v[50:51], v5 offset:136
ds_read_b64 v[20:21], v5 offset:16
ds_read_b64 v[52:53], v5 offset:144
ds_read_b64 v[22:23], v5 offset:24
ds_read_b64 v[54:55], v5 offset:152
ds_read_b64 v[24:25], v5 offset:32
ds_read_b64 v[56:57], v5 offset:160
ds_read_b64 v[26:27], v5 offset:40
ds_read_b64 v[58:59], v5 offset:168
ds_read_b64 v[28:29], v5 offset:48
ds_read_b64 v[60:61], v5 offset:176
ds_read_b64 v[30:31], v5 offset:56
ds_read_b64 v[62:63], v5 offset:184
ds_read_b64 v[32:33], v5 offset:64
ds_read_b64 v[64:65], v5 offset:192
ds_read_b64 v[34:35], v5 offset:72
ds_read_b64 v[66:67], v5 offset:200
ds_read_b64 v[36:37], v5 offset:80
ds_read_b64 v[68:69], v5 offset:208
ds_read_b64 v[38:39], v5 offset:88
ds_read_b64 v[70:71], v5 offset:216
ds_read_b64 v[40:41], v5 offset:96
ds_read_b64 v[72:73], v5 offset:224
ds_read_b64 v[42:43], v5 offset:104
ds_read_b64 v[74:75], v5 offset:232
ds_read_b64 v[44:45], v5 offset:112
ds_read_b64 v[76:77], v5 offset:240
ds_read_b64 v[46:47], v5 offset:120
ds_read_b64 v[78:79], v5 offset:248
s_waitcnt lgkmcnt(0)
v_pk_add_f32 v[14:15], v[16:17], v[48:49] neg_lo:[0,1] neg_hi:[0,1]
v_pk_add_f32 v[16:17], v[16:17], v[48:49]
v_pk_add_f32 v[48:49], v[18:19], v[50:51] neg_lo:[0,1] neg_hi:[0,1]
v_pk_add_f32 v[18:19], v[18:19], v[50:51]
v_pk_mul_f32 v[50:51], v[48:49], s[50:51] op_sel:[0,0] op_sel_hi:[0,1] neg_lo:[0,0] neg_hi:[0,1]
v_pk_fma_f32 v[50:51], v[48:49], s[50:51], v[50:51] op_sel:[1,1,0] op_sel_hi:[1,0,1] neg_lo:[0,0,0] neg_hi:[0,0,0]
v_pk_add_f32 v[48:49], v[20:21], v[52:53] neg_lo:[0,1] neg_hi:[0,1]
v_pk_add_f32 v[20:21], v[20:21], v[52:53]
v_pk_mul_f32 v[52:53], v[48:49], s[54:55] op_sel:[0,0] op_sel_hi:[0,1] neg_lo:[0,0] neg_hi:[0,1]
v_pk_fma_f32 v[52:53], v[48:49], s[54:55], v[52:53] op_sel:[1,1,0] op_sel_hi:[1,0,1] neg_lo:[0,0,0] neg_hi:[0,0,0]
v_pk_add_f32 v[48:49], v[22:23], v[54:55] neg_lo:[0,1] neg_hi:[0,1]
v_pk_add_f32 v[22:23], v[22:23], v[54:55]
v_pk_mul_f32 v[54:55], v[48:49], s[58:59] op_sel:[0,0] op_sel_hi:[0,1] neg_lo:[0,0] neg_hi:[0,1]
v_pk_fma_f32 v[54:55], v[48:49], s[58:59], v[54:55] op_sel:[1,1,0] op_sel_hi:[1,0,1] neg_lo:[0,0,0] neg_hi:[0,0,0]
v_pk_add_f32 v[48:49], v[24:25], v[56:57] neg_lo:[0,1] neg_hi:[0,1]
v_pk_add_f32 v[24:25], v[24:25], v[56:57]
v_pk_mul_f32 v[56:57], v[48:49], s[62:63] op_sel:[0,0] op_sel_hi:[0,1] neg_lo:[0,0] neg_hi:[0,1]
v_pk_fma_f32 v[56:57], v[48:49], s[62:63], v[56:57] op_sel:[1,1,0] op_sel_hi:[1,0,1] neg_lo:[0,0,0] neg_hi:[0,0,0]
v_pk_add_f32 v[48:49], v[26:27], v[58:59] neg_lo:[0,1] neg_hi:[0,1]
v_pk_add_f32 v[26:27], v[26:27], v[58:59]
v_pk_mul_f32 v[58:59], v[48:49], s[58:59] op_sel:[0,1] op_sel_hi:[0,0] neg_lo:[0,0] neg_hi:[0,1]
v_pk_fma_f32 v[58:59], v[48:49], s[58:59], v[58:59] op_sel:[1,0,0] op_sel_hi:[1,1,1] neg_lo:[0,0,0] neg_hi:[0,0,0]
v_pk_add_f32 v[48:49], v[28:29], v[60:61] neg_lo:[0,1] neg_hi:[0,1]
v_pk_add_f32 v[28:29], v[28:29], v[60:61]
v_pk_mul_f32 v[60:61], v[48:49], s[54:55] op_sel:[0,1] op_sel_hi:[0,0] neg_lo:[0,0] neg_hi:[0,1]
v_pk_fma_f32 v[60:61], v[48:49], s[54:55], v[60:61] op_sel:[1,0,0] op_sel_hi:[1,1,1] neg_lo:[0,0,0] neg_hi:[0,0,0]
v_pk_add_f32 v[48:49], v[30:31], v[62:63] neg_lo:[0,1] neg_hi:[0,1]
v_pk_add_f32 v[30:31], v[30:31], v[62:63]
v_pk_mul_f32 v[62:63], v[48:49], s[50:51] op_sel:[0,1] op_sel_hi:[0,0] neg_lo:[0,0] neg_hi:[0,1]
v_pk_fma_f32 v[62:63], v[48:49], s[50:51], v[62:63] op_sel:[1,0,0] op_sel_hi:[1,1,1] neg_lo:[0,0,0] neg_hi:[0,0,0]
v_pk_add_f32 v[48:49], v[32:33], v[64:65] op_sel:[1,1] op_sel_hi:[0,0] neg_lo:[0,1] neg_hi:[1,0]
v_pk_add_f32 v[32:33], v[32:33], v[64:65]
v_pk_add_f32 v[64:65], v[34:35], v[66:67] neg_lo:[0,1] neg_hi:[0,1]
v_pk_add_f32 v[34:35], v[34:35], v[66:67]
v_pk_mul_f32 v[66:67], v[64:65], s[50:51] op_sel:[0,1] op_sel_hi:[0,0] neg_lo:[0,1] neg_hi:[0,1]
v_pk_fma_f32 v[66:67], v[64:65], s[50:51], v[66:67] op_sel:[1,0,0] op_sel_hi:[1,1,1] neg_lo:[0,0,0] neg_hi:[0,1,0]
v_pk_add_f32 v[64:65], v[36:37], v[68:69] neg_lo:[0,1] neg_hi:[0,1]
v_pk_add_f32 v[36:37], v[36:37], v[68:69]
v_pk_mul_f32 v[68:69], v[64:65], s[54:55] op_sel:[0,1] op_sel_hi:[0,0] neg_lo:[0,1] neg_hi:[0,1]
v_pk_fma_f32 v[68:69], v[64:65], s[54:55], v[68:69] op_sel:[1,0,0] op_sel_hi:[1,1,1] neg_lo:[0,0,0] neg_hi:[0,1,0]
v_pk_add_f32 v[64:65], v[38:39], v[70:71] neg_lo:[0,1] neg_hi:[0,1]
v_pk_add_f32 v[38:39], v[38:39], v[70:71]
v_pk_mul_f32 v[70:71], v[64:65], s[58:59] op_sel:[0,1] op_sel_hi:[0,0] neg_lo:[0,1] neg_hi:[0,1]
v_pk_fma_f32 v[70:71], v[64:65], s[58:59], v[70:71] op_sel:[1,0,0] op_sel_hi:[1,1,1] neg_lo:[0,0,0] neg_hi:[0,1,0]
v_pk_add_f32 v[64:65], v[40:41], v[72:73] neg_lo:[0,1] neg_hi:[0,1]
v_pk_add_f32 v[40:41], v[40:41], v[72:73]
v_pk_mul_f32 v[72:73], v[64:65], s[62:63] op_sel:[0,0] op_sel_hi:[0,1] neg_lo:[0,1] neg_hi:[0,1]
v_pk_fma_f32 v[72:73], v[64:65], s[62:63], v[72:73] op_sel:[1,1,0] op_sel_hi:[1,0,1] neg_lo:[0,0,0] neg_hi:[0,1,0]
v_pk_add_f32 v[64:65], v[42:43], v[74:75] neg_lo:[0,1] neg_hi:[0,1]
v_pk_add_f32 v[42:43], v[42:43], v[74:75]
v_pk_mul_f32 v[74:75], v[64:65], s[58:59] op_sel:[0,0] op_sel_hi:[0,1] neg_lo:[0,1] neg_hi:[0,1]
v_pk_fma_f32 v[74:75], v[64:65], s[58:59], v[74:75] op_sel:[1,1,0] op_sel_hi:[1,0,1] neg_lo:[0,0,0] neg_hi:[0,1,0]
v_pk_add_f32 v[64:65], v[44:45], v[76:77] neg_lo:[0,1] neg_hi:[0,1]
v_pk_add_f32 v[44:45], v[44:45], v[76:77]
v_pk_mul_f32 v[76:77], v[64:65], s[54:55] op_sel:[0,0] op_sel_hi:[0,1] neg_lo:[0,1] neg_hi:[0,1]
v_pk_fma_f32 v[76:77], v[64:65], s[54:55], v[76:77] op_sel:[1,1,0] op_sel_hi:[1,0,1] neg_lo:[0,0,0] neg_hi:[0,1,0]
v_pk_add_f32 v[64:65], v[46:47], v[78:79] neg_lo:[0,1] neg_hi:[0,1]
v_pk_add_f32 v[46:47], v[46:47], v[78:79]
v_pk_mul_f32 v[78:79], v[64:65], s[50:51] op_sel:[0,0] op_sel_hi:[0,1] neg_lo:[0,1] neg_hi:[0,1]
v_pk_fma_f32 v[78:79], v[64:65], s[50:51], v[78:79] op_sel:[1,1,0] op_sel_hi:[1,0,1] neg_lo:[0,0,0] neg_hi:[0,1,0]
v_pk_add_f32 v[64:65], v[16:17], v[32:33] neg_lo:[0,1] neg_hi:[0,1]
v_pk_add_f32 v[16:17], v[16:17], v[32:33]
v_pk_add_f32 v[32:33], v[18:19], v[34:35] neg_lo:[0,1] neg_hi:[0,1]
v_pk_add_f32 v[18:19], v[18:19], v[34:35]
v_pk_mul_f32 v[34:35], v[32:33], s[54:55] op_sel:[0,0] op_sel_hi:[0,1] neg_lo:[0,0] neg_hi:[0,1]
v_pk_fma_f32 v[34:35], v[32:33], s[54:55], v[34:35] op_sel:[1,1,0] op_sel_hi:[1,0,1] neg_lo:[0,0,0] neg_hi:[0,0,0]
v_pk_add_f32 v[32:33], v[20:21], v[36:37] neg_lo:[0,1] neg_hi:[0,1]
v_pk_add_f32 v[20:21], v[20:21], v[36:37]
v_pk_mul_f32 v[36:37], v[32:33], s[62:63] op_sel:[0,0] op_sel_hi:[0,1] neg_lo:[0,0] neg_hi:[0,1]
v_pk_fma_f32 v[36:37], v[32:33], s[62:63], v[36:37] op_sel:[1,1,0] op_sel_hi:[1,0,1] neg_lo:[0,0,0] neg_hi:[0,0,0]
v_pk_add_f32 v[32:33], v[22:23], v[38:39] neg_lo:[0,1] neg_hi:[0,1]
v_pk_add_f32 v[22:23], v[22:23], v[38:39]
v_pk_mul_f32 v[38:39], v[32:33], s[54:55] op_sel:[0,1] op_sel_hi:[0,0] neg_lo:[0,0] neg_hi:[0,1]
v_pk_fma_f32 v[38:39], v[32:33], s[54:55], v[38:39] op_sel:[1,0,0] op_sel_hi:[1,1,1] neg_lo:[0,0,0] neg_hi:[0,0,0]
v_pk_add_f32 v[32:33], v[24:25], v[40:41] op_sel:[1,1] op_sel_hi:[0,0] neg_lo:[0,1] neg_hi:[1,0]
v_pk_add_f32 v[24:25], v[24:25], v[40:41]
v_pk_add_f32 v[40:41], v[26:27], v[42:43] neg_lo:[0,1] neg_hi:[0,1]
v_pk_add_f32 v[26:27], v[26:27], v[42:43]
v_pk_mul_f32 v[42:43], v[40:41], s[54:55] op_sel:[0,1] op_sel_hi:[0,0] neg_lo:[0,1] neg_hi:[0,1]
v_pk_fma_f32 v[42:43], v[40:41], s[54:55], v[42:43] op_sel:[1,0,0] op_sel_hi:[1,1,1] neg_lo:[0,0,0] neg_hi:[0,1,0]
v_pk_add_f32 v[40:41], v[28:29], v[44:45] neg_lo:[0,1] neg_hi:[0,1]
v_pk_add_f32 v[28:29], v[28:29], v[44:45]
v_pk_mul_f32 v[44:45], v[40:41], s[62:63] op_sel:[0,0] op_sel_hi:[0,1] neg_lo:[0,1] neg_hi:[0,1]
v_pk_fma_f32 v[44:45], v[40:41], s[62:63], v[44:45] op_sel:[1,1,0] op_sel_hi:[1,0,1] neg_lo:[0,0,0] neg_hi:[0,1,0]
v_pk_add_f32 v[40:41], v[30:31], v[46:47] neg_lo:[0,1] neg_hi:[0,1]
v_pk_add_f32 v[30:31], v[30:31], v[46:47]
v_pk_mul_f32 v[46:47], v[40:41], s[54:55] op_sel:[0,0] op_sel_hi:[0,1] neg_lo:[0,1] neg_hi:[0,1]
v_pk_fma_f32 v[46:47], v[40:41], s[54:55], v[46:47] op_sel:[1,1,0] op_sel_hi:[1,0,1] neg_lo:[0,0,0] neg_hi:[0,1,0]
v_pk_add_f32 v[40:41], v[14:15], v[48:49] neg_lo:[0,1] neg_hi:[0,1]
v_pk_add_f32 v[14:15], v[14:15], v[48:49]
v_pk_add_f32 v[48:49], v[50:51], v[66:67] neg_lo:[0,1] neg_hi:[0,1]
v_pk_add_f32 v[50:51], v[50:51], v[66:67]
v_pk_mul_f32 v[66:67], v[48:49], s[54:55] op_sel:[0,0] op_sel_hi:[0,1] neg_lo:[0,0] neg_hi:[0,1]
v_pk_fma_f32 v[66:67], v[48:49], s[54:55], v[66:67] op_sel:[1,1,0] op_sel_hi:[1,0,1] neg_lo:[0,0,0] neg_hi:[0,0,0]
v_pk_add_f32 v[48:49], v[52:53], v[68:69] neg_lo:[0,1] neg_hi:[0,1]
v_pk_add_f32 v[52:53], v[52:53], v[68:69]
v_pk_mul_f32 v[68:69], v[48:49], s[62:63] op_sel:[0,0] op_sel_hi:[0,1] neg_lo:[0,0] neg_hi:[0,1]
v_pk_fma_f32 v[68:69], v[48:49], s[62:63], v[68:69] op_sel:[1,1,0] op_sel_hi:[1,0,1] neg_lo:[0,0,0] neg_hi:[0,0,0]
v_pk_add_f32 v[48:49], v[54:55], v[70:71] neg_lo:[0,1] neg_hi:[0,1]
v_pk_add_f32 v[54:55], v[54:55], v[70:71]
v_pk_mul_f32 v[70:71], v[48:49], s[54:55] op_sel:[0,1] op_sel_hi:[0,0] neg_lo:[0,0] neg_hi:[0,1]
v_pk_fma_f32 v[70:71], v[48:49], s[54:55], v[70:71] op_sel:[1,0,0] op_sel_hi:[1,1,1] neg_lo:[0,0,0] neg_hi:[0,0,0]
v_pk_add_f32 v[48:49], v[56:57], v[72:73] op_sel:[1,1] op_sel_hi:[0,0] neg_lo:[0,1] neg_hi:[1,0]
v_pk_add_f32 v[56:57], v[56:57], v[72:73]
v_pk_add_f32 v[72:73], v[58:59], v[74:75] neg_lo:[0,1] neg_hi:[0,1]
v_pk_add_f32 v[58:59], v[58:59], v[74:75]
v_pk_mul_f32 v[74:75], v[72:73], s[54:55] op_sel:[0,1] op_sel_hi:[0,0] neg_lo:[0,1] neg_hi:[0,1]
v_pk_fma_f32 v[74:75], v[72:73], s[54:55], v[74:75] op_sel:[1,0,0] op_sel_hi:[1,1,1] neg_lo:[0,0,0] neg_hi:[0,1,0]
v_pk_add_f32 v[72:73], v[60:61], v[76:77] neg_lo:[0,1] neg_hi:[0,1]
v_pk_add_f32 v[60:61], v[60:61], v[76:77]
v_pk_mul_f32 v[76:77], v[72:73], s[62:63] op_sel:[0,0] op_sel_hi:[0,1] neg_lo:[0,1] neg_hi:[0,1]
v_pk_fma_f32 v[76:77], v[72:73], s[62:63], v[76:77] op_sel:[1,1,0] op_sel_hi:[1,0,1] neg_lo:[0,0,0] neg_hi:[0,1,0]
v_pk_add_f32 v[72:73], v[62:63], v[78:79] neg_lo:[0,1] neg_hi:[0,1]
v_pk_add_f32 v[62:63], v[62:63], v[78:79]
v_pk_mul_f32 v[78:79], v[72:73], s[54:55] op_sel:[0,0] op_sel_hi:[0,1] neg_lo:[0,1] neg_hi:[0,1]
v_pk_fma_f32 v[78:79], v[72:73], s[54:55], v[78:79] op_sel:[1,1,0] op_sel_hi:[1,0,1] neg_lo:[0,0,0] neg_hi:[0,1,0]
v_pk_add_f32 v[72:73], v[16:17], v[24:25] neg_lo:[0,1] neg_hi:[0,1]
v_pk_add_f32 v[16:17], v[16:17], v[24:25]
v_pk_add_f32 v[24:25], v[18:19], v[26:27] neg_lo:[0,1] neg_hi:[0,1]
v_pk_add_f32 v[18:19], v[18:19], v[26:27]
v_pk_mul_f32 v[26:27], v[24:25], s[62:63] op_sel:[0,0] op_sel_hi:[0,1] neg_lo:[0,0] neg_hi:[0,1]
v_pk_fma_f32 v[26:27], v[24:25], s[62:63], v[26:27] op_sel:[1,1,0] op_sel_hi:[1,0,1] neg_lo:[0,0,0] neg_hi:[0,0,0]
v_pk_add_f32 v[24:25], v[20:21], v[28:29] op_sel:[1,1] op_sel_hi:[0,0] neg_lo:[0,1] neg_hi:[1,0]
v_pk_add_f32 v[20:21], v[20:21], v[28:29]
v_pk_add_f32 v[28:29], v[22:23], v[30:31] neg_lo:[0,1] neg_hi:[0,1]
v_pk_add_f32 v[22:23], v[22:23], v[30:31]
v_pk_mul_f32 v[30:31], v[28:29], s[62:63] op_sel:[0,0] op_sel_hi:[0,1] neg_lo:[0,1] neg_hi:[0,1]
v_pk_fma_f32 v[30:31], v[28:29], s[62:63], v[30:31] op_sel:[1,1,0] op_sel_hi:[1,0,1] neg_lo:[0,0,0] neg_hi:[0,1,0]
v_pk_add_f32 v[28:29], v[64:65], v[32:33] neg_lo:[0,1] neg_hi:[0,1]
v_pk_add_f32 v[64:65], v[64:65], v[32:33]
v_pk_add_f32 v[32:33], v[34:35], v[42:43] neg_lo:[0,1] neg_hi:[0,1]
v_pk_add_f32 v[34:35], v[34:35], v[42:43]
v_pk_mul_f32 v[42:43], v[32:33], s[62:63] op_sel:[0,0] op_sel_hi:[0,1] neg_lo:[0,0] neg_hi:[0,1]
v_pk_fma_f32 v[42:43], v[32:33], s[62:63], v[42:43] op_sel:[1,1,0] op_sel_hi:[1,0,1] neg_lo:[0,0,0] neg_hi:[0,0,0]
v_pk_add_f32 v[32:33], v[36:37], v[44:45] op_sel:[1,1] op_sel_hi:[0,0] neg_lo:[0,1] neg_hi:[1,0]
v_pk_add_f32 v[36:37], v[36:37], v[44:45]
v_pk_add_f32 v[44:45], v[38:39], v[46:47] neg_lo:[0,1] neg_hi:[0,1]
v_pk_add_f32 v[38:39], v[38:39], v[46:47]
v_pk_mul_f32 v[46:47], v[44:45], s[62:63] op_sel:[0,0] op_sel_hi:[0,1] neg_lo:[0,1] neg_hi:[0,1]
v_pk_fma_f32 v[46:47], v[44:45], s[62:63], v[46:47] op_sel:[1,1,0] op_sel_hi:[1,0,1] neg_lo:[0,0,0] neg_hi:[0,1,0]
v_pk_add_f32 v[44:45], v[14:15], v[56:57] neg_lo:[0,1] neg_hi:[0,1]
v_pk_add_f32 v[14:15], v[14:15], v[56:57]
v_pk_add_f32 v[56:57], v[50:51], v[58:59] neg_lo:[0,1] neg_hi:[0,1]
v_pk_add_f32 v[50:51], v[50:51], v[58:59]
v_pk_mul_f32 v[58:59], v[56:57], s[62:63] op_sel:[0,0] op_sel_hi:[0,1] neg_lo:[0,0] neg_hi:[0,1]
v_pk_fma_f32 v[58:59], v[56:57], s[62:63], v[58:59] op_sel:[1,1,0] op_sel_hi:[1,0,1] neg_lo:[0,0,0] neg_hi:[0,0,0]
v_pk_add_f32 v[56:57], v[52:53], v[60:61] op_sel:[1,1] op_sel_hi:[0,0] neg_lo:[0,1] neg_hi:[1,0]
v_pk_add_f32 v[52:53], v[52:53], v[60:61]
v_pk_add_f32 v[60:61], v[54:55], v[62:63] neg_lo:[0,1] neg_hi:[0,1]
v_pk_add_f32 v[54:55], v[54:55], v[62:63]
v_pk_mul_f32 v[62:63], v[60:61], s[62:63] op_sel:[0,0] op_sel_hi:[0,1] neg_lo:[0,1] neg_hi:[0,1]
v_pk_fma_f32 v[62:63], v[60:61], s[62:63], v[62:63] op_sel:[1,1,0] op_sel_hi:[1,0,1] neg_lo:[0,0,0] neg_hi:[0,1,0]
v_pk_add_f32 v[60:61], v[40:41], v[48:49] neg_lo:[0,1] neg_hi:[0,1]
v_pk_add_f32 v[40:41], v[40:41], v[48:49]
v_pk_add_f32 v[48:49], v[66:67], v[74:75] neg_lo:[0,1] neg_hi:[0,1]
v_pk_add_f32 v[66:67], v[66:67], v[74:75]
v_pk_mul_f32 v[74:75], v[48:49], s[62:63] op_sel:[0,0] op_sel_hi:[0,1] neg_lo:[0,0] neg_hi:[0,1]
v_pk_fma_f32 v[74:75], v[48:49], s[62:63], v[74:75] op_sel:[1,1,0] op_sel_hi:[1,0,1] neg_lo:[0,0,0] neg_hi:[0,0,0]
v_pk_add_f32 v[48:49], v[68:69], v[76:77] op_sel:[1,1] op_sel_hi:[0,0] neg_lo:[0,1] neg_hi:[1,0]
v_pk_add_f32 v[68:69], v[68:69], v[76:77]
v_pk_add_f32 v[76:77], v[70:71], v[78:79] neg_lo:[0,1] neg_hi:[0,1]
v_pk_add_f32 v[70:71], v[70:71], v[78:79]
v_pk_mul_f32 v[78:79], v[76:77], s[62:63] op_sel:[0,0] op_sel_hi:[0,1] neg_lo:[0,1] neg_hi:[0,1]
v_pk_fma_f32 v[78:79], v[76:77], s[62:63], v[78:79] op_sel:[1,1,0] op_sel_hi:[1,0,1] neg_lo:[0,0,0] neg_hi:[0,1,0]
v_pk_add_f32 v[76:77], v[16:17], v[20:21] neg_lo:[0,1] neg_hi:[0,1]
v_pk_add_f32 v[16:17], v[16:17], v[20:21]
v_pk_add_f32 v[20:21], v[18:19], v[22:23] op_sel:[1,1] op_sel_hi:[0,0] neg_lo:[0,1] neg_hi:[1,0]
v_pk_add_f32 v[18:19], v[18:19], v[22:23]
v_pk_add_f32 v[22:23], v[72:73], v[24:25] neg_lo:[0,1] neg_hi:[0,1]
v_pk_add_f32 v[72:73], v[72:73], v[24:25]
v_pk_add_f32 v[24:25], v[26:27], v[30:31] op_sel:[1,1] op_sel_hi:[0,0] neg_lo:[0,1] neg_hi:[1,0]
v_pk_add_f32 v[26:27], v[26:27], v[30:31]
v_pk_add_f32 v[30:31], v[64:65], v[36:37] neg_lo:[0,1] neg_hi:[0,1]
v_pk_add_f32 v[64:65], v[64:65], v[36:37]
v_pk_add_f32 v[36:37], v[34:35], v[38:39] op_sel:[1,1] op_sel_hi:[0,0] neg_lo:[0,1] neg_hi:[1,0]
v_pk_add_f32 v[34:35], v[34:35], v[38:39]
v_pk_add_f32 v[38:39], v[28:29], v[32:33] neg_lo:[0,1] neg_hi:[0,1]
v_pk_add_f32 v[28:29], v[28:29], v[32:33]
v_pk_add_f32 v[32:33], v[42:43], v[46:47] op_sel:[1,1] op_sel_hi:[0,0] neg_lo:[0,1] neg_hi:[1,0]
v_pk_add_f32 v[42:43], v[42:43], v[46:47]
v_pk_add_f32 v[46:47], v[14:15], v[52:53] neg_lo:[0,1] neg_hi:[0,1]
v_pk_add_f32 v[14:15], v[14:15], v[52:53]
v_pk_add_f32 v[52:53], v[50:51], v[54:55] op_sel:[1,1] op_sel_hi:[0,0] neg_lo:[0,1] neg_hi:[1,0]
v_pk_add_f32 v[50:51], v[50:51], v[54:55]
v_pk_add_f32 v[54:55], v[44:45], v[56:57] neg_lo:[0,1] neg_hi:[0,1]
v_pk_add_f32 v[44:45], v[44:45], v[56:57]
v_pk_add_f32 v[56:57], v[58:59], v[62:63] op_sel:[1,1] op_sel_hi:[0,0] neg_lo:[0,1] neg_hi:[1,0]
v_pk_add_f32 v[58:59], v[58:59], v[62:63]
v_pk_add_f32 v[62:63], v[40:41], v[68:69] neg_lo:[0,1] neg_hi:[0,1]
v_pk_add_f32 v[40:41], v[40:41], v[68:69]
v_pk_add_f32 v[68:69], v[66:67], v[70:71] op_sel:[1,1] op_sel_hi:[0,0] neg_lo:[0,1] neg_hi:[1,0]
v_pk_add_f32 v[66:67], v[66:67], v[70:71]
v_pk_add_f32 v[70:71], v[60:61], v[48:49] neg_lo:[0,1] neg_hi:[0,1]
v_pk_add_f32 v[60:61], v[60:61], v[48:49]
v_pk_add_f32 v[48:49], v[74:75], v[78:79] op_sel:[1,1] op_sel_hi:[0,0] neg_lo:[0,1] neg_hi:[1,0]
v_pk_add_f32 v[74:75], v[74:75], v[78:79]
v_pk_add_f32 v[78:79], v[16:17], v[18:19] neg_lo:[0,1] neg_hi:[0,1]
v_pk_add_f32 v[16:17], v[16:17], v[18:19]
v_pk_add_f32 v[18:19], v[76:77], v[20:21] neg_lo:[0,1] neg_hi:[0,1]
v_pk_add_f32 v[76:77], v[76:77], v[20:21]
v_pk_add_f32 v[20:21], v[72:73], v[26:27] neg_lo:[0,1] neg_hi:[0,1]
v_pk_add_f32 v[72:73], v[72:73], v[26:27]
v_pk_add_f32 v[26:27], v[22:23], v[24:25] neg_lo:[0,1] neg_hi:[0,1]
v_pk_add_f32 v[22:23], v[22:23], v[24:25]
v_pk_add_f32 v[24:25], v[64:65], v[34:35] neg_lo:[0,1] neg_hi:[0,1]
v_pk_add_f32 v[64:65], v[64:65], v[34:35]
v_pk_add_f32 v[34:35], v[30:31], v[36:37] neg_lo:[0,1] neg_hi:[0,1]
v_pk_add_f32 v[30:31], v[30:31], v[36:37]
v_pk_add_f32 v[36:37], v[28:29], v[42:43] neg_lo:[0,1] neg_hi:[0,1]
v_pk_add_f32 v[28:29], v[28:29], v[42:43]
v_pk_add_f32 v[42:43], v[38:39], v[32:33] neg_lo:[0,1] neg_hi:[0,1]
v_pk_add_f32 v[38:39], v[38:39], v[32:33]
v_pk_add_f32 v[32:33], v[14:15], v[50:51] neg_lo:[0,1] neg_hi:[0,1]
v_pk_add_f32 v[14:15], v[14:15], v[50:51]
v_pk_add_f32 v[50:51], v[46:47], v[52:53] neg_lo:[0,1] neg_hi:[0,1]
v_pk_add_f32 v[46:47], v[46:47], v[52:53]
v_pk_add_f32 v[52:53], v[44:45], v[58:59] neg_lo:[0,1] neg_hi:[0,1]
v_pk_add_f32 v[44:45], v[44:45], v[58:59]
v_pk_add_f32 v[58:59], v[54:55], v[56:57] neg_lo:[0,1] neg_hi:[0,1]
v_pk_add_f32 v[54:55], v[54:55], v[56:57]
v_pk_add_f32 v[56:57], v[40:41], v[66:67] neg_lo:[0,1] neg_hi:[0,1]
v_pk_add_f32 v[40:41], v[40:41], v[66:67]
v_pk_add_f32 v[66:67], v[62:63], v[68:69] neg_lo:[0,1] neg_hi:[0,1]
v_pk_add_f32 v[62:63], v[62:63], v[68:69]
v_pk_add_f32 v[68:69], v[60:61], v[74:75] neg_lo:[0,1] neg_hi:[0,1]
v_pk_add_f32 v[60:61], v[60:61], v[74:75]
v_pk_add_f32 v[74:75], v[70:71], v[48:49] neg_lo:[0,1] neg_hi:[0,1]
v_pk_add_f32 v[70:71], v[70:71], v[48:49]
ds_write_b64 v4, v[16:17] offset:0
ds_write_b64 v4, v[14:15] offset:256
ds_write_b64 v4, v[64:65] offset:512
ds_write_b64 v4, v[40:41] offset:768
ds_write_b64 v4, v[72:73] offset:1024
ds_write_b64 v4, v[44:45] offset:1280
ds_write_b64 v4, v[28:29] offset:1536
ds_write_b64 v4, v[60:61] offset:1792
ds_write_b64 v4, v[76:77] offset:2048
ds_write_b64 v4, v[46:47] offset:2304
ds_write_b64 v4, v[30:31] offset:2560
ds_write_b64 v4, v[62:63] offset:2816
ds_write_b64 v4, v[22:23] offset:3072
ds_write_b64 v4, v[54:55] offset:3328
ds_write_b64 v4, v[38:39] offset:3584
ds_write_b64 v4, v[70:71] offset:3840
ds_write_b64 v4, v[78:79] offset:4096
ds_write_b64 v4, v[32:33] offset:4352
ds_write_b64 v4, v[24:25] offset:4608
ds_write_b64 v4, v[56:57] offset:4864
ds_write_b64 v4, v[20:21] offset:5120
ds_write_b64 v4, v[52:53] offset:5376
ds_write_b64 v4, v[36:37] offset:5632
ds_write_b64 v4, v[68:69] offset:5888
ds_write_b64 v4, v[18:19] offset:6144
ds_write_b64 v4, v[50:51] offset:6400
ds_write_b64 v4, v[34:35] offset:6656
ds_write_b64 v4, v[66:67] offset:6912
ds_write_b64 v4, v[26:27] offset:7168
ds_write_b64 v4, v[58:59] offset:7424
ds_write_b64 v4, v[42:43] offset:7680
ds_write_b64 v4, v[74:75] offset:7936
ds_write_b64 v4, v[16:17] offset:8192
s_waitcnt lgkmcnt(0)
s_barrier
s_lshl_b32 s13, s93, 7
s_add_u32 s13, s13, 96468992
ds_read_b64 v[16:17], v6 offset:0
ds_read_b64 v[18:19], v7 offset:4096
ds_read_b64 v[20:21], v6 offset:256
ds_read_b64 v[22:23], v7 offset:3840
ds_read_b64 v[24:25], v6 offset:512
ds_read_b64 v[26:27], v7 offset:3584
ds_read_b64 v[28:29], v6 offset:768
ds_read_b64 v[30:31], v7 offset:3328
ds_read_b64 v[32:33], v6 offset:1024
ds_read_b64 v[34:35], v7 offset:3072
ds_read_b64 v[36:37], v6 offset:1280
ds_read_b64 v[38:39], v7 offset:2816
s_waitcnt lgkmcnt(10)
v_pk_add_f32 v[208:209], v[16:17], v[18:19] neg_hi:[0,1]
v_pk_add_f32 v[210:211], v[16:17], v[18:19] op_sel:[1,1] op_sel_hi:[0,0] neg_hi:[1,0]
ds_read_b64 v[40:41], v6 offset:1536
ds_read_b64 v[42:43], v7 offset:2560
buffer_store_dwordx4 v[208:211], v8, s[84:87], s13 offen sc1
s_add_u32 s13, s13, 524288
s_waitcnt lgkmcnt(10)
v_pk_add_f32 v[212:213], v[20:21], v[22:23] neg_hi:[0,1]
v_pk_add_f32 v[214:215], v[20:21], v[22:23] op_sel:[1,1] op_sel_hi:[0,0] neg_hi:[1,0]
ds_read_b64 v[44:45], v6 offset:1792
ds_read_b64 v[46:47], v7 offset:2304
buffer_store_dwordx4 v[212:215], v8, s[84:87], s13 offen sc1
s_add_u32 s13, s13, 524288
s_waitcnt lgkmcnt(10)
v_pk_add_f32 v[216:217], v[24:25], v[26:27] neg_hi:[0,1]
v_pk_add_f32 v[218:219], v[24:25], v[26:27] op_sel:[1,1] op_sel_hi:[0,0] neg_hi:[1,0]
ds_read_b64 v[16:17], v6 offset:2048
ds_read_b64 v[18:19], v7 offset:2048
buffer_store_dwordx4 v[216:219], v8, s[84:87], s13 offen sc1
s_add_u32 s13, s13, 524288
s_waitcnt lgkmcnt(10)
v_pk_add_f32 v[220:221], v[28:29], v[30:31] neg_hi:[0,1]
v_pk_add_f32 v[222:223], v[28:29], v[30:31] op_sel:[1,1] op_sel_hi:[0,0] neg_hi:[1,0]
ds_read_b64 v[20:21], v6 offset:2304
ds_read_b64 v[22:23], v7 offset:1792
buffer_store_dwordx4 v[220:223], v8, s[84:87], s13 offen sc1
s_add_u32 s13, s13, 524288
s_waitcnt lgkmcnt(10)
v_pk_add_f32 v[224:225], v[32:33], v[34:35] neg_hi:[0,1]
v_pk_add_f32 v[226:227], v[32:33], v[34:35] op_sel:[1,1] op_sel_hi:[0,0] neg_hi:[1,0]
ds_read_b64 v[24:25], v6 offset:2560
ds_read_b64 v[26:27], v7 offset:1536
buffer_store_dwordx4 v[224:227], v8, s[84:87], s13 offen sc1
s_add_u32 s13, s13, 524288
s_waitcnt lgkmcnt(10)
v_pk_add_f32 v[228:229], v[36:37], v[38:39] neg_hi:[0,1]
v_pk_add_f32 v[230:231], v[36:37], v[38:39] op_sel:[1,1] op_sel_hi:[0,0] neg_hi:[1,0]
ds_read_b64 v[28:29], v6 offset:2816
ds_read_b64 v[30:31], v7 offset:1280
buffer_store_dwordx4 v[228:231], v8, s[84:87], s13 offen sc1
s_add_u32 s13, s13, 524288
s_waitcnt lgkmcnt(10)
v_pk_add_f32 v[232:233], v[40:41], v[42:43] neg_hi:[0,1]
v_pk_add_f32 v[234:235], v[40:41], v[42:43] op_sel:[1,1] op_sel_hi:[0,0] neg_hi:[1,0]
ds_read_b64 v[32:33], v6 offset:3072
ds_read_b64 v[34:35], v7 offset:1024
buffer_store_dwordx4 v[232:235], v8, s[84:87], s13 offen sc1
s_add_u32 s13, s13, 524288
s_waitcnt lgkmcnt(10)
v_pk_add_f32 v[236:237], v[44:45], v[46:47] neg_hi:[0,1]
v_pk_add_f32 v[238:239], v[44:45], v[46:47] op_sel:[1,1] op_sel_hi:[0,0] neg_hi:[1,0]
ds_read_b64 v[36:37], v6 offset:3328
ds_read_b64 v[38:39], v7 offset:768
buffer_store_dwordx4 v[236:239], v8, s[84:87], s13 offen sc1
s_add_u32 s13, s13, 524288
s_waitcnt lgkmcnt(10)
v_pk_add_f32 v[208:209], v[16:17], v[18:19] neg_hi:[0,1]
v_pk_add_f32 v[210:211], v[16:17], v[18:19] op_sel:[1,1] op_sel_hi:[0,0] neg_hi:[1,0]
ds_read_b64 v[40:41], v6 offset:3584
ds_read_b64 v[42:43], v7 offset:512
buffer_store_dwordx4 v[208:211], v8, s[84:87], s13 offen sc1
s_add_u32 s13, s13, 524288
s_waitcnt lgkmcnt(10)
v_pk_add_f32 v[212:213], v[20:21], v[22:23] neg_hi:[0,1]
v_pk_add_f32 v[214:215], v[20:21], v[22:23] op_sel:[1,1] op_sel_hi:[0,0] neg_hi:[1,0]
ds_read_b64 v[44:45], v6 offset:3840
ds_read_b64 v[46:47], v7 offset:256
buffer_store_dwordx4 v[212:215], v8, s[84:87], s13 offen sc1
s_add_u32 s13, s13, 524288
s_waitcnt lgkmcnt(10)
v_pk_add_f32 v[216:217], v[24:25], v[26:27] neg_hi:[0,1]
v_pk_add_f32 v[218:219], v[24:25], v[26:27] op_sel:[1,1] op_sel_hi:[0,0] neg_hi:[1,0]
ds_read_b64 v[16:17], v6 offset:4096
ds_read_b64 v[18:19], v7 offset:0
buffer_store_dwordx4 v[216:219], v8, s[84:87], s13 offen sc1
s_add_u32 s13, s13, 524288
s_waitcnt lgkmcnt(10)
v_pk_add_f32 v[220:221], v[28:29], v[30:31] neg_hi:[0,1]
v_pk_add_f32 v[222:223], v[28:29], v[30:31] op_sel:[1,1] op_sel_hi:[0,0] neg_hi:[1,0]
buffer_store_dwordx4 v[220:223], v8, s[84:87], s13 offen sc1
s_add_u32 s13, s13, 524288
s_waitcnt lgkmcnt(8)
v_pk_add_f32 v[224:225], v[32:33], v[34:35] neg_hi:[0,1]
v_pk_add_f32 v[226:227], v[32:33], v[34:35] op_sel:[1,1] op_sel_hi:[0,0] neg_hi:[1,0]
buffer_store_dwordx4 v[224:227], v8, s[84:87], s13 offen sc1
s_add_u32 s13, s13, 524288
s_waitcnt lgkmcnt(6)
v_pk_add_f32 v[228:229], v[36:37], v[38:39] neg_hi:[0,1]
v_pk_add_f32 v[230:231], v[36:37], v[38:39] op_sel:[1,1] op_sel_hi:[0,0] neg_hi:[1,0]
buffer_store_dwordx4 v[228:231], v8, s[84:87], s13 offen sc1
s_add_u32 s13, s13, 524288
s_waitcnt lgkmcnt(4)
v_pk_add_f32 v[232:233], v[40:41], v[42:43] neg_hi:[0,1]
v_pk_add_f32 v[234:235], v[40:41], v[42:43] op_sel:[1,1] op_sel_hi:[0,0] neg_hi:[1,0]
buffer_store_dwordx4 v[232:235], v8, s[84:87], s13 offen sc1
s_add_u32 s13, s13, 524288
s_waitcnt lgkmcnt(2)
v_pk_add_f32 v[236:237], v[44:45], v[46:47] neg_hi:[0,1]
v_pk_add_f32 v[238:239], v[44:45], v[46:47] op_sel:[1,1] op_sel_hi:[0,0] neg_hi:[1,0]
buffer_store_dwordx4 v[236:239], v8, s[84:87], s13 offen sc1
s_add_u32 s13, s13, 524288
s_waitcnt lgkmcnt(0)
v_pk_add_f32 v[208:209], v[16:17], v[18:19] neg_hi:[0,1]
v_pk_add_f32 v[210:211], v[16:17], v[18:19] op_sel:[1,1] op_sel_hi:[0,0] neg_hi:[1,0]
v_cmp_eq_u32 vcc, 0, v9
s_nop 1
v_cndmask_b32 v13, -16, v8, vcc
buffer_store_dwordx4 v[208:211], v13, s[84:87], s13 offen sc1
s_add_u32 s13, s13, 524288
s_mov_b32 s93, s21
s_cmp_lt_u32 s93, 128
s_cbranch_scc1 mega_kernel_f1_l
mega_kernel_f1_e:
s_mov_b32 s93, s40
s_waitcnt vmcnt(0)
s_load_dwordx2 s[4:5], s[0:1], 64
s_load_dwordx2 s[8:9], s[0:1], 72
v_and_b32 v1, 63, v0
v_lshrrev_b32 v2, 6, v0
v_mul_u32_u24 v3, 1026, v2
v_lshl_add_u32 v3, v1, 1, v3
v_mul_u32_u24 v4, 65, v1
v_add_u32 v4, v4, v2
v_lshlrev_b32 v4, 2, v4
v_lshrrev_b32 v7, 4, v0
v_and_b32 v8, 15, v0
v_mul_u32_u24 v5, 65, v7
v_lshl_add_u32 v5, v8, 2, v5
v_lshlrev_b32 v5, 2, v5
v_mul_u32_u24 v6, 8192, v7
v_lshl_add_u32 v6, v8, 4, v6
s_add_u32 s24, s84, 121634816
s_addc_u32 s25, s85, 0
s_mov_b32 s26, 4202496
s_mov_b32 s27, 0x00020000
s_waitcnt lgkmcnt(0)
s_mov_b32 s6, 2101248
s_mov_b32 s7, 0x00020000
s_mov_b32 s10, 2101248
s_mov_b32 s11, 0x00020000
v_lshlrev_b32 v9, 7, v0
s_and_b32 s12, s93, 31
s_mul_i32 s12, s12, 65664
buffer_load_dword v250, v9, s[4:7], s12 offen
buffer_load_dword v250, v9, s[8:11], s12 offen
s_add_u32 s12, s12, 32768
buffer_load_dword v250, v9, s[4:7], s12 offen
buffer_load_dword v250, v9, s[8:11], s12 offen
s_add_u32 s12, s12, 32768
s_cmp_lt_u32 s93, 288
s_cbranch_scc0 mega_kernel_f0_e
s_and_b32 s12, s93, 31
s_mul_i32 s12, s12, 65664
s_lshr_b32 s13, s93, 5
s_lshl_b32 s13, s13, 7
s_add_u32 s12, s12, s13
buffer_load_ushort v16, v3, s[4:7], s12 offen
buffer_load_ushort v32, v3, s[8:11], s12 offen
s_add_u32 s12, s12, 4104
buffer_load_ushort v17, v3, s[4:7], s12 offen
buffer_load_ushort v33, v3, s[8:11], s12 offen
s_add_u32 s12, s12, 4104
buffer_load_ushort v18, v3, s[4:7], s12 offen
buffer_load_ushort v34, v3, s[8:11], s12 offen
s_add_u32 s12, s12, 4104
buffer_load_ushort v19, v3, s[4:7], s12 offen
buffer_load_ushort v35, v3, s[8:11], s12 offen
s_add_u32 s12, s12, 4104
buffer_load_ushort v20, v3, s[4:7], s12 offen
buffer_load_ushort v36, v3, s[8:11], s12 offen
s_add_u32 s12, s12, 4104
buffer_load_ushort v21, v3, s[4:7], s12 offen
buffer_load_ushort v37, v3, s[8:11], s12 offen
s_add_u32 s12, s12, 4104
buffer_load_ushort v22, v3, s[4:7], s12 offen
buffer_load_ushort v38, v3, s[8:11], s12 offen
s_add_u32 s12, s12, 4104
buffer_load_ushort v23, v3, s[4:7], s12 offen
buffer_load_ushort v39, v3, s[8:11], s12 offen
s_add_u32 s12, s12, 4104
buffer_load_ushort v24, v3, s[4:7], s12 offen
buffer_load_ushort v40, v3, s[8:11], s12 offen
s_add_u32 s12, s12, 4104
buffer_load_ushort v25, v3, s[4:7], s12 offen
buffer_load_ushort v41, v3, s[8:11], s12 offen
s_add_u32 s12, s12, 4104
buffer_load_ushort v26, v3, s[4:7], s12 offen
buffer_load_ushort v42, v3, s[8:11], s12 offen
s_add_u32 s12, s12, 4104
buffer_load_ushort v27, v3, s[4:7], s12 offen
buffer_load_ushort v43, v3, s[8:11], s12 offen
s_add_u32 s12, s12, 4104
buffer_load_ushort v28, v3, s[4:7], s12 offen
buffer_load_ushort v44, v3, s[8:11], s12 offen
s_add_u32 s12, s12, 4104
buffer_load_ushort v29, v3, s[4:7], s12 offen
buffer_load_ushort v45, v3, s[8:11], s12 offen
s_add_u32 s12, s12, 4104
buffer_load_ushort v30, v3, s[4:7], s12 offen
buffer_load_ushort v46, v3, s[8:11], s12 offen
s_add_u32 s12, s12, 4104
buffer_load_ushort v31, v3, s[4:7], s12 offen
buffer_load_ushort v47, v3, s[8:11], s12 offen
s_add_u32 s12, s12, 4104
s_waitcnt vmcnt(0)
mega_kernel_f0_l:
s_add_u32 s21, s93, 32
s_cmp_lt_u32 s21, 288
s_cselect_b32 s22, s21, s93
s_waitcnt vmcnt(4)
v_lshl_or_b32 v48, v32, 16, v16
v_lshl_or_b32 v49, v33, 16, v17
v_lshl_or_b32 v50, v34, 16, v18
v_lshl_or_b32 v51, v35, 16, v19
v_lshl_or_b32 v52, v36, 16, v20
v_lshl_or_b32 v53, v37, 16, v21
v_lshl_or_b32 v54, v38, 16, v22
v_lshl_or_b32 v55, v39, 16, v23
v_lshl_or_b32 v56, v40, 16, v24
v_lshl_or_b32 v57, v41, 16, v25
v_lshl_or_b32 v58, v42, 16, v26
v_lshl_or_b32 v59, v43, 16, v27
v_lshl_or_b32 v60, v44, 16, v28
v_lshl_or_b32 v61, v45, 16, v29
v_lshl_or_b32 v62, v46, 16, v30
v_lshl_or_b32 v63, v47, 16, v31
s_and_b32 s12, s22, 31
s_mul_i32 s12, s12, 65664
s_lshr_b32 s13, s22, 5
s_lshl_b32 s13, s13, 7
s_add_u32 s12, s12, s13
buffer_load_ushort v16, v3, s[4:7], s12 offen
buffer_load_ushort v32, v3, s[8:11], s12 offen
s_add_u32 s12, s12, 4104
buffer_load_ushort v17, v3, s[4:7], s12 offen
buffer_load_ushort v33, v3, s[8:11], s12 offen
s_add_u32 s12, s12, 4104
buffer_load_ushort v18, v3, s[4:7], s12 offen
buffer_load_ushort v34, v3, s[8:11], s12 offen
s_add_u32 s12, s12, 4104
buffer_load_ushort v19, v3, s[4:7], s12 offen
buffer_load_ushort v35, v3, s[8:11], s12 offen
s_add_u32 s12, s12, 4104
buffer_load_ushort v20, v3, s[4:7], s12 offen
buffer_load_ushort v36, v3, s[8:11], s12 offen
s_add_u32 s12, s12, 4104
buffer_load_ushort v21, v3, s[4:7], s12 offen
buffer_load_ushort v37, v3, s[8:11], s12 offen
s_add_u32 s12, s12, 4104
buffer_load_ushort v22, v3, s[4:7], s12 offen
buffer_load_ushort v38, v3, s[8:11], s12 offen
s_add_u32 s12, s12, 4104
buffer_load_ushort v23, v3, s[4:7], s12 offen
buffer_load_ushort v39, v3, s[8:11], s12 offen
s_add_u32 s12, s12, 4104
buffer_load_ushort v24, v3, s[4:7], s12 offen
buffer_load_ushort v40, v3, s[8:11], s12 offen
s_add_u32 s12, s12, 4104
buffer_load_ushort v25, v3, s[4:7], s12 offen
buffer_load_ushort v41, v3, s[8:11], s12 offen
s_add_u32 s12, s12, 4104
buffer_load_ushort v26, v3, s[4:7], s12 offen
buffer_load_ushort v42, v3, s[8:11], s12 offen
s_add_u32 s12, s12, 4104
buffer_load_ushort v27, v3, s[4:7], s12 offen
buffer_load_ushort v43, v3, s[8:11], s12 offen
s_add_u32 s12, s12, 4104
buffer_load_ushort v28, v3, s[4:7], s12 offen
buffer_load_ushort v44, v3, s[8:11], s12 offen
s_add_u32 s12, s12, 4104
buffer_load_ushort v29, v3, s[4:7], s12 offen
buffer_load_ushort v45, v3, s[8:11], s12 offen
s_add_u32 s12, s12, 4104
buffer_load_ushort v30, v3, s[4:7], s12 offen
buffer_load_ushort v46, v3, s[8:11], s12 offen
s_add_u32 s12, s12, 4104
buffer_load_ushort v31, v3, s[4:7], s12 offen
buffer_load_ushort v47, v3, s[8:11], s12 offen
s_add_u32 s12, s12, 4104
s_barrier
ds_write_b32 v4, v48 offset:0
ds_write_b32 v4, v49 offset:16
ds_write_b32 v4, v50 offset:32
ds_write_b32 v4, v51 offset:48
ds_write_b32 v4, v52 offset:64
ds_write_b32 v4, v53 offset:80
ds_write_b32 v4, v54 offset:96
ds_write_b32 v4, v55 offset:112
ds_write_b32 v4, v56 offset:128
ds_write_b32 v4, v57 offset:144
ds_write_b32 v4, v58 offset:160
ds_write_b32 v4, v59 offset:176
s_waitcnt lgkmcnt(4)
ds_write_b32 v4, v60 offset:192
ds_write_b32 v4, v61 offset:208
ds_write_b32 v4, v62 offset:224
ds_write_b32 v4, v63 offset:240
s_waitcnt lgkmcnt(0)
s_barrier
ds_read2_b32 v[64:65], v5 offset0:0 offset1:1
ds_read_b32 v66, v5 offset:8
ds_read_b32 v67, v5 offset:12
ds_read_b32 v68, v5 offset:4160
ds_read_b32 v69, v5 offset:4164
ds_read_b32 v70, v5 offset:4168
ds_read_b32 v71, v5 offset:4172
ds_read_b32 v72, v5 offset:8320
ds_read_b32 v73, v5 offset:8324
ds_read_b32 v74, v5 offset:8328
ds_read_b32 v75, v5 offset:8332
ds_read_b32 v76, v5 offset:12480
ds_read_b32 v77, v5 offset:12484
ds_read_b32 v78, v5 offset:12488
ds_read_b32 v79, v5 offset:12492
s_and_b32 s14, s93, 31
s_lshl_b32 s14, s14, 8
s_lshr_b32 s15, s93, 5
s_mul_i32 s15, s15, 524288
s_add_u32 s14, s14, s15
s_waitcnt lgkmcnt(0)
buffer_store_dwordx4 v[64:67], v6, s[24:27], s14 offen sc1
s_add_u32 s14, s14, 131072
buffer_store_dwordx4 v[68:71], v6, s[24:27], s14 offen sc1
s_add_u32 s14, s14, 131072
buffer_store_dwordx4 v[72:75], v6, s[24:27], s14 offen sc1
s_add_u32 s14, s14, 131072
buffer_store_dwordx4 v[76:79], v6, s[24:27], s14 offen sc1
s_add_u32 s14, s14, 131072
s_mov_b32 s93, s21
s_cmp_lt_u32 s93, 288
s_cbranch_scc1 mega_kernel_f0_l
mega_kernel_f0_e:
v_and_b32 v3, 15, v0
v_lshlrev_b32 v3, 4, v3
s_branch mega_kernel_syd
mega_kernel_sydw:
s_sleep 4
mega_kernel_syd:
buffer_load_dword v2, v3, s[72:75], 0 offen sc1
s_waitcnt vmcnt(0)
mega_kernel_sydp:
s_cmp_eq_u32 s95, 1
s_cbranch_scc0 mega_kernel_sydf
v_readlane_b32 s76, v2, 14
s_mov_b32 s98, 0
s_cmp_eq_u32 s76, 32
s_cbranch_scc0 mega_kernel_sydw
s_branch mega_kernel_sydd
mega_kernel_sydf:
s_mov_b32 s77, 0
s_mov_b32 s78, 0
v_readlane_b32 s76, v2, 0
s_add_u32 s77, s77, s76
s_xor_b32 s76, s76, 32
s_or_b32 s78, s78, s76
v_readlane_b32 s76, v2, 1
s_add_u32 s77, s77, s76
s_xor_b32 s76, s76, 32
s_or_b32 s78, s78, s76
v_readlane_b32 s76, v2, 2
s_add_u32 s77, s77, s76
s_xor_b32 s76, s76, 32
s_or_b32 s78, s78, s76
v_readlane_b32 s76, v2, 3
s_add_u32 s77, s77, s76
s_xor_b32 s76, s76, 32
s_or_b32 s78, s78, s76
v_readlane_b32 s76, v2, 4
s_add_u32 s77, s77, s76
s_xor_b32 s76, s76, 32
s_or_b32 s78, s78, s76
v_readlane_b32 s76, v2, 5
s_add_u32 s77, s77, s76
s_xor_b32 s76, s76, 32
s_or_b32 s78, s78, s76
v_readlane_b32 s76, v2, 6
s_add_u32 s77, s77, s76
s_xor_b32 s76, s76, 32
s_or_b32 s78, s78, s76
v_readlane_b32 s76, v2, 7
s_add_u32 s77, s77, s76
s_xor_b32 s76, s76, 32
s_or_b32 s78, s78, s76
s_cmp_eq_u32 s77, 256
s_cbranch_scc0 mega_kernel_sydw
v_mov_b32 v252, v2
s_cmp_eq_u32 s78, 0
s_cbranch_scc0 mega_kernel_slowent
v_readlane_b32 s76, v2, 10
v_readlane_b32 s77, v2, 8
s_cmp_eq_u32 s76, 32
s_cbranch_scc0 mega_kernel_sydw
s_cmp_gt_u32 s77, 16
s_cselect_b32 s98, 1, 0
mega_kernel_sydd:
s_waitcnt vmcnt(0)
s_barrier
v_mov_b32 v1, 0
v_mov_b32 v2, 1
s_mov_b32 s82, 69259264
v_cmp_eq_u32 vcc, 0, v0
s_and_saveexec_b64 s[80:81], vcc
s_cbranch_execz mega_kernel_sg0
buffer_atomic_add v2, v1, s[84:87], s82 offen sc1
mega_kernel_sg0:
s_mov_b64 exec, s[80:81]
s_add_u32 s38, s40, 129
s_mov_b32 s39, 32
s_mov_b32 s37, 129
s_cmp_lt_u32 s38, 129
s_cbranch_scc1 mega_kernel_f2s
s_branch mega_kernel_f2e
mega_kernel_rk:
s_load_dwordx2 s[4:5], s[0:1], 24
s_load_dwordx2 s[8:9], s[0:1], 0
v_lshrrev_b32 v2, 6, v0
v_and_b32 v1, 63, v0
v_readfirstlane_b32 s41, v2
v_lshlrev_b32 v5, 4, v1
s_waitcnt lgkmcnt(0)
s_mov_b32 s6, 8388608
s_mov_b32 s7, 0x00020000
s_mov_b32 s10, 4194304
s_mov_b32 s11, 0x00020000
s_lshl_b32 s43, s40, 8
s_lshl_b32 s44, s41, 6
s_add_u32 s48, s43, s44
s_and_b32 s43, s48, 0x7ff
v_add_u32 v19, s43, v1
v_lshlrev_b32 v19, 7, v19
s_mov_b32 s43, 0
buffer_load_dword v250, v19, s[8:11], s43 offen
s_nop 0
v_lshrrev_b32 v2, 3, v1
s_lshl_b32 s43, s41, 3
v_add_u32 v2, s43, v2
v_bfe_u32 v3, v2, 1, 3
v_and_b32 v4, 7, v1
v_xor_b32 v3, v3, v4
v_lshlrev_b32 v6, 11, v2
v_lshl_add_u32 v6, v3, 4, v6
s_lshl_b32 s46, s41, 10
v_and_b32 v2, 15, v1
v_bfe_u32 v3, v2, 1, 3
v_lshrrev_b32 v4, 4, v1
v_xor_b32 v3, v3, v4
v_lshlrev_b32 v8, 7, v2
v_lshl_add_u32 v8, v3, 4, v8
v_xor_b32 v9, 64, v8
v_add_u32 v10, 0x10000, v8
v_add_u32 v11, 0x10000, v9
v_mov_b32 v7, v5
s_lshl_b32 s47, s40, 2
s_add_u32 s47, s47, s41
s_mov_b32 s42, 0
s_mov_b32 s50, 0
s_add_u32 m0, s46, 0
s_nop 0
buffer_load_dwordx4 v6, s[8:11], s50 offen offset:0 lds
s_add_u32 m0, s46, 3968
s_nop 0
buffer_load_dwordx4 v6, s[8:11], s50 offen offset:128 lds
s_add_u32 m0, s46, 7936
s_nop 0
buffer_load_dwordx4 v6, s[8:11], s50 offen offset:256 lds
s_add_u32 m0, s46, 11904
s_nop 0
buffer_load_dwordx4 v6, s[8:11], s50 offen offset:384 lds
s_add_u32 m0, s46, 15872
s_nop 0
buffer_load_dwordx4 v6, s[8:11], s50 offen offset:512 lds
s_add_u32 m0, s46, 19840
s_nop 0
buffer_load_dwordx4 v6, s[8:11], s50 offen offset:640 lds
s_add_u32 m0, s46, 23808
s_nop 0
buffer_load_dwordx4 v6, s[8:11], s50 offen offset:768 lds
s_add_u32 m0, s46, 27776
s_nop 0
buffer_load_dwordx4 v6, s[8:11], s50 offen offset:896 lds
s_add_u32 m0, s46, 31744
s_nop 0
buffer_load_dwordx4 v6, s[8:11], s50 offen offset:1024 lds
s_add_u32 m0, s46, 35712
s_nop 0
buffer_load_dwordx4 v6, s[8:11], s50 offen offset:1152 lds
s_add_u32 m0, s46, 39680
s_nop 0
buffer_load_dwordx4 v6, s[8:11], s50 offen offset:1280 lds
s_add_u32 m0, s46, 43648
s_nop 0
buffer_load_dwordx4 v6, s[8:11], s50 offen offset:1408 lds
s_add_u32 m0, s46, 47616
s_nop 0
buffer_load_dwordx4 v6, s[8:11], s50 offen offset:1536 lds
s_add_u32 m0, s46, 51584
s_nop 0
buffer_load_dwordx4 v6, s[8:11], s50 offen offset:1664 lds
s_add_u32 m0, s46, 55552
s_nop 0
buffer_load_dwordx4 v6, s[8:11], s50 offen offset:1792 lds
s_add_u32 m0, s46, 59520
s_nop 0
buffer_load_dwordx4 v6, s[8:11], s50 offen offset:1920 lds
v_lshrrev_b32 v2, 2, v1
v_and_b32 v3, 3, v1
v_lshlrev_b32 v16, 13, v2
v_lshl_add_u32 v16, v3, 4, v16
v_add_u32 v16, s48, v16
s_mul_i32 s45, s41, 24576
s_add_u32 s45, s45, 65536
v_bfe_u32 v17, v1, 2, 2
v_lshrrev_b32 v18, 4, v1
v_lshl_add_u32 v17, v18, 3, v17
v_lshlrev_b32 v17, 6, v17
v_lshl_add_u32 v17, v3, 4, v17
v_add_u32 v17, s45, v17
s_and_b32 s43, s40, 3
s_lshl_b32 s43, s43, 2
s_add_u32 s43, s43, s41
s_lshl_b32 s43, s43, 3
v_and_b32 v12, 7, v1
v_add_u32 v12, s43, v12
s_lshr_b32 s43, s40, 2
s_lshl_b32 s43, s43, 10
s_add_u32 s44, s43, 896
s_add_u32 s43, s43, 384
s_cmp_ge_u32 s40, 28
s_cselect_b32 s44, s44, s43
v_mov_b32 v13, s43
v_mov_b32 v14, s44
v_cmp_gt_u32 vcc, 32, v1
s_nop 1
v_cndmask_b32 v13, v14, v13, vcc
v_lshl_add_u32 v12, v12, 13, v13
s_mov_b32 s44, 0
buffer_load_dword v250, v12, s[4:7], s44 offen
s_add_u32 m0, s45, 0
s_mov_b32 s44, 0
buffer_load_dwordx4 v16, s[4:7], s44 offen lds
s_add_u32 m0, s45, 1024
s_mov_b32 s44, 131072
buffer_load_dwordx4 v16, s[4:7], s44 offen lds
s_add_u32 m0, s45, 2048
s_mov_b32 s44, 262144
buffer_load_dwordx4 v16, s[4:7], s44 offen lds
s_add_u32 m0, s45, 3072
s_mov_b32 s44, 393216
buffer_load_dwordx4 v16, s[4:7], s44 offen lds
s_add_u32 m0, s45, 4096
s_mov_b32 s44, 524288
buffer_load_dwordx4 v16, s[4:7], s44 offen lds
s_add_u32 m0, s45, 5120
s_mov_b32 s44, 655360
buffer_load_dwordx4 v16, s[4:7], s44 offen lds
s_add_u32 m0, s45, 6144
s_mov_b32 s44, 786432
buffer_load_dwordx4 v16, s[4:7], s44 offen lds
s_add_u32 m0, s45, 7168
s_mov_b32 s44, 917504
buffer_load_dwordx4 v16, s[4:7], s44 offen lds
s_mov_b32 s44, 1048576
buffer_load_dword v250, v12, s[4:7], s44 offen
s_add_u32 m0, s45, 8192
s_mov_b32 s44, 1048576
buffer_load_dwordx4 v16, s[4:7], s44 offen lds
s_add_u32 m0, s45, 9216
s_mov_b32 s44, 1179648
buffer_load_dwordx4 v16, s[4:7], s44 offen lds
s_add_u32 m0, s45, 10240
s_mov_b32 s44, 1310720
buffer_load_dwordx4 v16, s[4:7], s44 offen lds
s_add_u32 m0, s45, 11264
s_mov_b32 s44, 1441792
buffer_load_dwordx4 v16, s[4:7], s44 offen lds
s_add_u32 m0, s45, 12288
s_mov_b32 s44, 1572864
buffer_load_dwordx4 v16, s[4:7], s44 offen lds
s_add_u32 m0, s45, 13312
s_mov_b32 s44, 1703936
buffer_load_dwordx4 v16, s[4:7], s44 offen lds
s_add_u32 m0, s45, 14336
s_mov_b32 s44, 1835008
buffer_load_dwordx4 v16, s[4:7], s44 offen lds
s_add_u32 m0, s45, 15360
s_mov_b32 s44, 1966080
buffer_load_dwordx4 v16, s[4:7], s44 offen lds
s_mov_b32 s44, 2097152
buffer_load_dword v250, v12, s[4:7], s44 offen
s_add_u32 m0, s45, 16384
s_mov_b32 s44, 2097152
buffer_load_dwordx4 v16, s[4:7], s44 offen lds
s_add_u32 m0, s45, 17408
s_mov_b32 s44, 2228224
buffer_load_dwordx4 v16, s[4:7], s44 offen lds
s_add_u32 m0, s45, 18432
s_mov_b32 s44, 2359296
buffer_load_dwordx4 v16, s[4:7], s44 offen lds
s_add_u32 m0, s45, 19456
s_mov_b32 s44, 2490368
buffer_load_dwordx4 v16, s[4:7], s44 offen lds
s_add_u32 m0, s45, 20480
s_mov_b32 s44, 2621440
buffer_load_dwordx4 v16, s[4:7], s44 offen lds
s_add_u32 m0, s45, 21504
s_mov_b32 s44, 2752512
buffer_load_dwordx4 v16, s[4:7], s44 offen lds
s_add_u32 m0, s45, 22528
s_mov_b32 s44, 2883584
buffer_load_dwordx4 v16, s[4:7], s44 offen lds
s_add_u32 m0, s45, 23552
s_mov_b32 s44, 3014656
buffer_load_dwordx4 v16, s[4:7], s44 offen lds
s_waitcnt vmcnt(18)
s_barrier
ds_read_b64_tr_b16 a[0:1], v17 offset:0
ds_read_b64_tr_b16 a[2:3], v17 offset:256
ds_read_b64_tr_b16 a[4:5], v17 offset:8
ds_read_b64_tr_b16 a[6:7], v17 offset:264
ds_read_b64_tr_b16 a[8:9], v17 offset:2048
ds_read_b64_tr_b16 a[10:11], v17 offset:2304
ds_read_b64_tr_b16 a[12:13], v17 offset:2056
ds_read_b64_tr_b16 a[14:15], v17 offset:2312
s_waitcnt lgkmcnt(0)
ds_read_b64_tr_b16 a[16:17], v17 offset:4096
ds_read_b64_tr_b16 a[18:19], v17 offset:4352
ds_read_b64_tr_b16 a[20:21], v17 offset:4104
ds_read_b64_tr_b16 a[22:23], v17 offset:4360
ds_read_b64_tr_b16 a[24:25], v17 offset:6144
ds_read_b64_tr_b16 a[26:27], v17 offset:6400
ds_read_b64_tr_b16 a[28:29], v17 offset:6152
ds_read_b64_tr_b16 a[30:31], v17 offset:6408
s_waitcnt lgkmcnt(0)
s_mov_b32 s44, 3145728
buffer_load_dword v250, v12, s[4:7], s44 offen
s_add_u32 m0, s45, 0
s_mov_b32 s44, 3145728
buffer_load_dwordx4 v16, s[4:7], s44 offen lds
s_add_u32 m0, s45, 1024
s_mov_b32 s44, 3276800
buffer_load_dwordx4 v16, s[4:7], s44 offen lds
s_add_u32 m0, s45, 2048
s_mov_b32 s44, 3407872
buffer_load_dwordx4 v16, s[4:7], s44 offen lds
s_add_u32 m0, s45, 3072
s_mov_b32 s44, 3538944
buffer_load_dwordx4 v16, s[4:7], s44 offen lds
s_add_u32 m0, s45, 4096
s_mov_b32 s44, 3670016
buffer_load_dwordx4 v16, s[4:7], s44 offen lds
s_add_u32 m0, s45, 5120
s_mov_b32 s44, 3801088
buffer_load_dwordx4 v16, s[4:7], s44 offen lds
s_add_u32 m0, s45, 6144
s_mov_b32 s44, 3932160
buffer_load_dwordx4 v16, s[4:7], s44 offen lds
s_add_u32 m0, s45, 7168
s_mov_b32 s44, 4063232
buffer_load_dwordx4 v16, s[4:7], s44 offen lds
ds_read_b128 v[20:23], v8 offset:0
ds_read_b128 v[24:27], v8 offset:2048
ds_read_b128 v[28:31], v9 offset:0
ds_read_b128 v[32:35], v9 offset:2048
ds_read_b128 v[36:39], v8 offset:4096
ds_read_b128 v[40:43], v8 offset:6144
ds_read_b128 v[44:47], v9 offset:4096
ds_read_b128 v[48:51], v9 offset:6144
s_waitcnt lgkmcnt(0)
v_mfma_f32_16x16x32_bf16 v[52:55], a[0:3], v[20:23], 0
v_mfma_f32_16x16x32_bf16 v[56:59], a[4:7], v[20:23], 0
v_mfma_f32_16x16x32_bf16 v[60:63], a[0:3], v[24:27], 0
v_mfma_f32_16x16x32_bf16 v[64:67], a[4:7], v[24:27], 0
v_mfma_f32_16x16x32_bf16 v[52:55], a[8:11], v[28:31], v[52:55]
v_mfma_f32_16x16x32_bf16 v[56:59], a[12:15], v[28:31], v[56:59]
v_mfma_f32_16x16x32_bf16 v[60:63], a[8:11], v[32:35], v[60:63]
v_mfma_f32_16x16x32_bf16 v[64:67], a[12:15], v[32:35], v[64:67]
v_mfma_f32_16x16x32_bf16 v[52:55], a[16:19], v[36:39], v[52:55]
v_mfma_f32_16x16x32_bf16 v[56:59], a[20:23], v[36:39], v[56:59]
v_mfma_f32_16x16x32_bf16 v[60:63], a[16:19], v[40:43], v[60:63]
v_mfma_f32_16x16x32_bf16 v[64:67], a[20:23], v[40:43], v[64:67]
v_mfma_f32_16x16x32_bf16 v[52:55], a[24:27], v[44:47], v[52:55]
v_mfma_f32_16x16x32_bf16 v[56:59], a[28:31], v[44:47], v[56:59]
v_mfma_f32_16x16x32_bf16 v[60:63], a[24:27], v[48:51], v[60:63]
v_mfma_f32_16x16x32_bf16 v[64:67], a[28:31], v[48:51], v[64:67]
s_waitcnt vmcnt(18)
ds_read_b64_tr_b16 a[32:33], v17 offset:8192
ds_read_b64_tr_b16 a[34:35], v17 offset:8448
ds_read_b64_tr_b16 a[36:37], v17 offset:8200
ds_read_b64_tr_b16 a[38:39], v17 offset:8456
ds_read_b64_tr_b16 a[40:41], v17 offset:10240
ds_read_b64_tr_b16 a[42:43], v17 offset:10496
ds_read_b64_tr_b16 a[44:45], v17 offset:10248
ds_read_b64_tr_b16 a[46:47], v17 offset:10504
s_waitcnt lgkmcnt(0)
ds_read_b64_tr_b16 a[48:49], v17 offset:12288
ds_read_b64_tr_b16 a[50:51], v17 offset:12544
ds_read_b64_tr_b16 a[52:53], v17 offset:12296
ds_read_b64_tr_b16 a[54:55], v17 offset:12552
ds_read_b64_tr_b16 a[56:57], v17 offset:14336
ds_read_b64_tr_b16 a[58:59], v17 offset:14592
ds_read_b64_tr_b16 a[60:61], v17 offset:14344
ds_read_b64_tr_b16 a[62:63], v17 offset:14600
s_waitcnt lgkmcnt(0)
s_mov_b32 s44, 4194304
buffer_load_dword v250, v12, s[4:7], s44 offen
s_add_u32 m0, s45, 8192
s_mov_b32 s44, 4194304
buffer_load_dwordx4 v16, s[4:7], s44 offen lds
s_add_u32 m0, s45, 9216
s_mov_b32 s44, 4325376
buffer_load_dwordx4 v16, s[4:7], s44 offen lds
s_add_u32 m0, s45, 10240
s_mov_b32 s44, 4456448
buffer_load_dwordx4 v16, s[4:7], s44 offen lds
s_add_u32 m0, s45, 11264
s_mov_b32 s44, 4587520
buffer_load_dwordx4 v16, s[4:7], s44 offen lds
s_add_u32 m0, s45, 12288
s_mov_b32 s44, 4718592
buffer_load_dwordx4 v16, s[4:7], s44 offen lds
s_add_u32 m0, s45, 13312
s_mov_b32 s44, 4849664
buffer_load_dwordx4 v16, s[4:7], s44 offen lds
s_add_u32 m0, s45, 14336
s_mov_b32 s44, 4980736
buffer_load_dwordx4 v16, s[4:7], s44 offen lds
s_add_u32 m0, s45, 15360
s_mov_b32 s44, 5111808
buffer_load_dwordx4 v16, s[4:7], s44 offen lds
ds_read_b128 v[20:23], v8 offset:8192
ds_read_b128 v[24:27], v8 offset:10240
ds_read_b128 v[28:31], v9 offset:8192
ds_read_b128 v[32:35], v9 offset:10240
ds_read_b128 v[36:39], v8 offset:12288
ds_read_b128 v[40:43], v8 offset:14336
ds_read_b128 v[44:47], v9 offset:12288
ds_read_b128 v[48:51], v9 offset:14336
s_waitcnt lgkmcnt(0)
v_mfma_f32_16x16x32_bf16 v[52:55], a[32:35], v[20:23], v[52:55]
v_mfma_f32_16x16x32_bf16 v[56:59], a[36:39], v[20:23], v[56:59]
v_mfma_f32_16x16x32_bf16 v[60:63], a[32:35], v[24:27], v[60:63]
v_mfma_f32_16x16x32_bf16 v[64:67], a[36:39], v[24:27], v[64:67]
v_mfma_f32_16x16x32_bf16 v[52:55], a[40:43], v[28:31], v[52:55]
v_mfma_f32_16x16x32_bf16 v[56:59], a[44:47], v[28:31], v[56:59]
v_mfma_f32_16x16x32_bf16 v[60:63], a[40:43], v[32:35], v[60:63]
v_mfma_f32_16x16x32_bf16 v[64:67], a[44:47], v[32:35], v[64:67]
v_mfma_f32_16x16x32_bf16 v[52:55], a[48:51], v[36:39], v[52:55]
v_mfma_f32_16x16x32_bf16 v[56:59], a[52:55], v[36:39], v[56:59]
v_mfma_f32_16x16x32_bf16 v[60:63], a[48:51], v[40:43], v[60:63]
v_mfma_f32_16x16x32_bf16 v[64:67], a[52:55], v[40:43], v[64:67]
v_mfma_f32_16x16x32_bf16 v[52:55], a[56:59], v[44:47], v[52:55]
v_mfma_f32_16x16x32_bf16 v[56:59], a[60:63], v[44:47], v[56:59]
v_mfma_f32_16x16x32_bf16 v[60:63], a[56:59], v[48:51], v[60:63]
v_mfma_f32_16x16x32_bf16 v[64:67], a[60:63], v[48:51], v[64:67]
s_waitcnt vmcnt(18)
ds_read_b64_tr_b16 a[64:65], v17 offset:16384
ds_read_b64_tr_b16 a[66:67], v17 offset:16640
ds_read_b64_tr_b16 a[68:69], v17 offset:16392
ds_read_b64_tr_b16 a[70:71], v17 offset:16648
ds_read_b64_tr_b16 a[72:73], v17 offset:18432
ds_read_b64_tr_b16 a[74:75], v17 offset:18688
ds_read_b64_tr_b16 a[76:77], v17 offset:18440
ds_read_b64_tr_b16 a[78:79], v17 offset:18696
s_waitcnt lgkmcnt(0)
ds_read_b64_tr_b16 a[80:81], v17 offset:20480
ds_read_b64_tr_b16 a[82:83], v17 offset:20736
ds_read_b64_tr_b16 a[84:85], v17 offset:20488
ds_read_b64_tr_b16 a[86:87], v17 offset:20744
ds_read_b64_tr_b16 a[88:89], v17 offset:22528
ds_read_b64_tr_b16 a[90:91], v17 offset:22784
ds_read_b64_tr_b16 a[92:93], v17 offset:22536
ds_read_b64_tr_b16 a[94:95], v17 offset:22792
s_waitcnt lgkmcnt(0)
s_mov_b32 s44, 5242880
buffer_load_dword v250, v12, s[4:7], s44 offen
s_add_u32 m0, s45, 16384
s_mov_b32 s44, 5242880
buffer_load_dwordx4 v16, s[4:7], s44 offen lds
s_add_u32 m0, s45, 17408
s_mov_b32 s44, 5373952
buffer_load_dwordx4 v16, s[4:7], s44 offen lds
s_add_u32 m0, s45, 18432
s_mov_b32 s44, 5505024
buffer_load_dwordx4 v16, s[4:7], s44 offen lds
s_add_u32 m0, s45, 19456
s_mov_b32 s44, 5636096
buffer_load_dwordx4 v16, s[4:7], s44 offen lds
s_add_u32 m0, s45, 20480
s_mov_b32 s44, 5767168
buffer_load_dwordx4 v16, s[4:7], s44 offen lds
s_add_u32 m0, s45, 21504
s_mov_b32 s44, 5898240
buffer_load_dwordx4 v16, s[4:7], s44 offen lds
s_add_u32 m0, s45, 22528
s_mov_b32 s44, 6029312
buffer_load_dwordx4 v16, s[4:7], s44 offen lds
s_add_u32 m0, s45, 23552
s_mov_b32 s44, 6160384
buffer_load_dwordx4 v16, s[4:7], s44 offen lds
ds_read_b128 v[20:23], v8 offset:16384
ds_read_b128 v[24:27], v8 offset:18432
ds_read_b128 v[28:31], v9 offset:16384
ds_read_b128 v[32:35], v9 offset:18432
ds_read_b128 v[36:39], v8 offset:20480
ds_read_b128 v[40:43], v8 offset:22528
ds_read_b128 v[44:47], v9 offset:20480
ds_read_b128 v[48:51], v9 offset:22528
s_waitcnt lgkmcnt(0)
v_mfma_f32_16x16x32_bf16 v[52:55], a[64:67], v[20:23], v[52:55]
v_mfma_f32_16x16x32_bf16 v[56:59], a[68:71], v[20:23], v[56:59]
v_mfma_f32_16x16x32_bf16 v[60:63], a[64:67], v[24:27], v[60:63]
v_mfma_f32_16x16x32_bf16 v[64:67], a[68:71], v[24:27], v[64:67]
v_mfma_f32_16x16x32_bf16 v[52:55], a[72:75], v[28:31], v[52:55]
v_mfma_f32_16x16x32_bf16 v[56:59], a[76:79], v[28:31], v[56:59]
v_mfma_f32_16x16x32_bf16 v[60:63], a[72:75], v[32:35], v[60:63]
v_mfma_f32_16x16x32_bf16 v[64:67], a[76:79], v[32:35], v[64:67]
v_mfma_f32_16x16x32_bf16 v[52:55], a[80:83], v[36:39], v[52:55]
v_mfma_f32_16x16x32_bf16 v[56:59], a[84:87], v[36:39], v[56:59]
v_mfma_f32_16x16x32_bf16 v[60:63], a[80:83], v[40:43], v[60:63]
v_mfma_f32_16x16x32_bf16 v[64:67], a[84:87], v[40:43], v[64:67]
v_mfma_f32_16x16x32_bf16 v[52:55], a[88:91], v[44:47], v[52:55]
v_mfma_f32_16x16x32_bf16 v[56:59], a[92:95], v[44:47], v[56:59]
v_mfma_f32_16x16x32_bf16 v[60:63], a[88:91], v[48:51], v[60:63]
v_mfma_f32_16x16x32_bf16 v[64:67], a[92:95], v[48:51], v[64:67]
s_waitcnt vmcnt(18)
ds_read_b64_tr_b16 a[96:97], v17 offset:0
ds_read_b64_tr_b16 a[98:99], v17 offset:256
ds_read_b64_tr_b16 a[100:101], v17 offset:8
ds_read_b64_tr_b16 a[102:103], v17 offset:264
ds_read_b64_tr_b16 a[104:105], v17 offset:2048
ds_read_b64_tr_b16 a[106:107], v17 offset:2304
ds_read_b64_tr_b16 a[108:109], v17 offset:2056
ds_read_b64_tr_b16 a[110:111], v17 offset:2312
s_waitcnt lgkmcnt(0)
ds_read_b64_tr_b16 a[112:113], v17 offset:4096
ds_read_b64_tr_b16 a[114:115], v17 offset:4352
ds_read_b64_tr_b16 a[116:117], v17 offset:4104
ds_read_b64_tr_b16 a[118:119], v17 offset:4360
ds_read_b64_tr_b16 a[120:121], v17 offset:6144
ds_read_b64_tr_b16 a[122:123], v17 offset:6400
ds_read_b64_tr_b16 a[124:125], v17 offset:6152
ds_read_b64_tr_b16 a[126:127], v17 offset:6408
s_waitcnt lgkmcnt(0)
s_mov_b32 s44, 6291456
buffer_load_dword v250, v12, s[4:7], s44 offen
s_add_u32 m0, s45, 0
s_mov_b32 s44, 6291456
buffer_load_dwordx4 v16, s[4:7], s44 offen lds
s_add_u32 m0, s45, 1024
s_mov_b32 s44, 6422528
buffer_load_dwordx4 v16, s[4:7], s44 offen lds
s_add_u32 m0, s45, 2048
s_mov_b32 s44, 6553600
buffer_load_dwordx4 v16, s[4:7], s44 offen lds
s_add_u32 m0, s45, 3072
s_mov_b32 s44, 6684672
buffer_load_dwordx4 v16, s[4:7], s44 offen lds
s_add_u32 m0, s45, 4096
s_mov_b32 s44, 6815744
buffer_load_dwordx4 v16, s[4:7], s44 offen lds
s_add_u32 m0, s45, 5120
s_mov_b32 s44, 6946816
buffer_load_dwordx4 v16, s[4:7], s44 offen lds
s_add_u32 m0, s45, 6144
s_mov_b32 s44, 7077888
buffer_load_dwordx4 v16, s[4:7], s44 offen lds
s_add_u32 m0, s45, 7168
s_mov_b32 s44, 7208960
buffer_load_dwordx4 v16, s[4:7], s44 offen lds
ds_read_b128 v[20:23], v8 offset:24576
ds_read_b128 v[24:27], v8 offset:26624
ds_read_b128 v[28:31], v9 offset:24576
ds_read_b128 v[32:35], v9 offset:26624
ds_read_b128 v[36:39], v8 offset:28672
ds_read_b128 v[40:43], v8 offset:30720
ds_read_b128 v[44:47], v9 offset:28672
ds_read_b128 v[48:51], v9 offset:30720
s_waitcnt lgkmcnt(0)
v_mfma_f32_16x16x32_bf16 v[52:55], a[96:99], v[20:23], v[52:55]
v_mfma_f32_16x16x32_bf16 v[56:59], a[100:103], v[20:23], v[56:59]
v_mfma_f32_16x16x32_bf16 v[60:63], a[96:99], v[24:27], v[60:63]
v_mfma_f32_16x16x32_bf16 v[64:67], a[100:103], v[24:27], v[64:67]
v_mfma_f32_16x16x32_bf16 v[52:55], a[104:107], v[28:31], v[52:55]
v_mfma_f32_16x16x32_bf16 v[56:59], a[108:111], v[28:31], v[56:59]
v_mfma_f32_16x16x32_bf16 v[60:63], a[104:107], v[32:35], v[60:63]
v_mfma_f32_16x16x32_bf16 v[64:67], a[108:111], v[32:35], v[64:67]
v_mfma_f32_16x16x32_bf16 v[52:55], a[112:115], v[36:39], v[52:55]
v_mfma_f32_16x16x32_bf16 v[56:59], a[116:119], v[36:39], v[56:59]
v_mfma_f32_16x16x32_bf16 v[60:63], a[112:115], v[40:43], v[60:63]
v_mfma_f32_16x16x32_bf16 v[64:67], a[116:119], v[40:43], v[64:67]
v_mfma_f32_16x16x32_bf16 v[52:55], a[120:123], v[44:47], v[52:55]
v_mfma_f32_16x16x32_bf16 v[56:59], a[124:127], v[44:47], v[56:59]
v_mfma_f32_16x16x32_bf16 v[60:63], a[120:123], v[48:51], v[60:63]
v_mfma_f32_16x16x32_bf16 v[64:67], a[124:127], v[48:51], v[64:67]
s_waitcnt vmcnt(18)
ds_read_b64_tr_b16 a[128:129], v17 offset:8192
ds_read_b64_tr_b16 a[130:131], v17 offset:8448
ds_read_b64_tr_b16 a[132:133], v17 offset:8200
ds_read_b64_tr_b16 a[134:135], v17 offset:8456
ds_read_b64_tr_b16 a[136:137], v17 offset:10240
ds_read_b64_tr_b16 a[138:139], v17 offset:10496
ds_read_b64_tr_b16 a[140:141], v17 offset:10248
ds_read_b64_tr_b16 a[142:143], v17 offset:10504
s_waitcnt lgkmcnt(0)
ds_read_b64_tr_b16 a[144:145], v17 offset:12288
ds_read_b64_tr_b16 a[146:147], v17 offset:12544
ds_read_b64_tr_b16 a[148:149], v17 offset:12296
ds_read_b64_tr_b16 a[150:151], v17 offset:12552
ds_read_b64_tr_b16 a[152:153], v17 offset:14336
ds_read_b64_tr_b16 a[154:155], v17 offset:14592
ds_read_b64_tr_b16 a[156:157], v17 offset:14344
ds_read_b64_tr_b16 a[158:159], v17 offset:14600
s_waitcnt lgkmcnt(0)
s_mov_b32 s44, 7340032
buffer_load_dword v250, v12, s[4:7], s44 offen
s_add_u32 m0, s45, 8192
s_mov_b32 s44, 7340032
buffer_load_dwordx4 v16, s[4:7], s44 offen lds
s_add_u32 m0, s45, 9216
s_mov_b32 s44, 7471104
buffer_load_dwordx4 v16, s[4:7], s44 offen lds
s_add_u32 m0, s45, 10240
s_mov_b32 s44, 7602176
buffer_load_dwordx4 v16, s[4:7], s44 offen lds
s_add_u32 m0, s45, 11264
s_mov_b32 s44, 7733248
buffer_load_dwordx4 v16, s[4:7], s44 offen lds
s_add_u32 m0, s45, 12288
s_mov_b32 s44, 7864320
buffer_load_dwordx4 v16, s[4:7], s44 offen lds
s_add_u32 m0, s45, 13312
s_mov_b32 s44, 7995392
buffer_load_dwordx4 v16, s[4:7], s44 offen lds
s_add_u32 m0, s45, 14336
s_mov_b32 s44, 8126464
buffer_load_dwordx4 v16, s[4:7], s44 offen lds
s_add_u32 m0, s45, 15360
s_mov_b32 s44, 8257536
buffer_load_dwordx4 v16, s[4:7], s44 offen lds
ds_read_b128 v[20:23], v8 offset:32768
ds_read_b128 v[24:27], v8 offset:34816
ds_read_b128 v[28:31], v9 offset:32768
ds_read_b128 v[32:35], v9 offset:34816
ds_read_b128 v[36:39], v8 offset:36864
ds_read_b128 v[40:43], v8 offset:38912
ds_read_b128 v[44:47], v9 offset:36864
ds_read_b128 v[48:51], v9 offset:38912
s_waitcnt lgkmcnt(0)
v_mfma_f32_16x16x32_bf16 v[52:55], a[128:131], v[20:23], v[52:55]
v_mfma_f32_16x16x32_bf16 v[56:59], a[132:135], v[20:23], v[56:59]
v_mfma_f32_16x16x32_bf16 v[60:63], a[128:131], v[24:27], v[60:63]
v_mfma_f32_16x16x32_bf16 v[64:67], a[132:135], v[24:27], v[64:67]
v_mfma_f32_16x16x32_bf16 v[52:55], a[136:139], v[28:31], v[52:55]
v_mfma_f32_16x16x32_bf16 v[56:59], a[140:143], v[28:31], v[56:59]
v_mfma_f32_16x16x32_bf16 v[60:63], a[136:139], v[32:35], v[60:63]
v_mfma_f32_16x16x32_bf16 v[64:67], a[140:143], v[32:35], v[64:67]
v_mfma_f32_16x16x32_bf16 v[52:55], a[144:147], v[36:39], v[52:55]
v_mfma_f32_16x16x32_bf16 v[56:59], a[148:151], v[36:39], v[56:59]
v_mfma_f32_16x16x32_bf16 v[60:63], a[144:147], v[40:43], v[60:63]
v_mfma_f32_16x16x32_bf16 v[64:67], a[148:151], v[40:43], v[64:67]
v_mfma_f32_16x16x32_bf16 v[52:55], a[152:155], v[44:47], v[52:55]
v_mfma_f32_16x16x32_bf16 v[56:59], a[156:159], v[44:47], v[56:59]
v_mfma_f32_16x16x32_bf16 v[60:63], a[152:155], v[48:51], v[60:63]
v_mfma_f32_16x16x32_bf16 v[64:67], a[156:159], v[48:51], v[64:67]
s_waitcnt vmcnt(18)
ds_read_b64_tr_b16 a[160:161], v17 offset:16384
ds_read_b64_tr_b16 a[162:163], v17 offset:16640
ds_read_b64_tr_b16 a[164:165], v17 offset:16392
ds_read_b64_tr_b16 a[166:167], v17 offset:16648
ds_read_b64_tr_b16 a[168:169], v17 offset:18432
ds_read_b64_tr_b16 a[170:171], v17 offset:18688
ds_read_b64_tr_b16 a[172:173], v17 offset:18440
ds_read_b64_tr_b16 a[174:175], v17 offset:18696
s_waitcnt lgkmcnt(0)
ds_read_b64_tr_b16 a[176:177], v17 offset:20480
ds_read_b64_tr_b16 a[178:179], v17 offset:20736
ds_read_b64_tr_b16 a[180:181], v17 offset:20488
ds_read_b64_tr_b16 a[182:183], v17 offset:20744
ds_read_b64_tr_b16 a[184:185], v17 offset:22528
ds_read_b64_tr_b16 a[186:187], v17 offset:22784
ds_read_b64_tr_b16 a[188:189], v17 offset:22536
ds_read_b64_tr_b16 a[190:191], v17 offset:22792
s_waitcnt lgkmcnt(0)
ds_read_b128 v[20:23], v8 offset:40960
ds_read_b128 v[24:27], v8 offset:43008
ds_read_b128 v[28:31], v9 offset:40960
ds_read_b128 v[32:35], v9 offset:43008
ds_read_b128 v[36:39], v8 offset:45056
ds_read_b128 v[40:43], v8 offset:47104
ds_read_b128 v[44:47], v9 offset:45056
ds_read_b128 v[48:51], v9 offset:47104
s_waitcnt lgkmcnt(0)
v_mfma_f32_16x16x32_bf16 v[52:55], a[160:163], v[20:23], v[52:55]
v_mfma_f32_16x16x32_bf16 v[56:59], a[164:167], v[20:23], v[56:59]
v_mfma_f32_16x16x32_bf16 v[60:63], a[160:163], v[24:27], v[60:63]
v_mfma_f32_16x16x32_bf16 v[64:67], a[164:167], v[24:27], v[64:67]
v_mfma_f32_16x16x32_bf16 v[52:55], a[168:171], v[28:31], v[52:55]
v_mfma_f32_16x16x32_bf16 v[56:59], a[172:175], v[28:31], v[56:59]
v_mfma_f32_16x16x32_bf16 v[60:63], a[168:171], v[32:35], v[60:63]
v_mfma_f32_16x16x32_bf16 v[64:67], a[172:175], v[32:35], v[64:67]
v_mfma_f32_16x16x32_bf16 v[52:55], a[176:179], v[36:39], v[52:55]
v_mfma_f32_16x16x32_bf16 v[56:59], a[180:183], v[36:39], v[56:59]
v_mfma_f32_16x16x32_bf16 v[60:63], a[176:179], v[40:43], v[60:63]
v_mfma_f32_16x16x32_bf16 v[64:67], a[180:183], v[40:43], v[64:67]
v_mfma_f32_16x16x32_bf16 v[52:55], a[184:187], v[44:47], v[52:55]
v_mfma_f32_16x16x32_bf16 v[56:59], a[188:191], v[44:47], v[56:59]
v_mfma_f32_16x16x32_bf16 v[60:63], a[184:187], v[48:51], v[60:63]
v_mfma_f32_16x16x32_bf16 v[64:67], a[188:191], v[48:51], v[64:67]
s_waitcnt vmcnt(9)
ds_read_b64_tr_b16 a[192:193], v17 offset:0
ds_read_b64_tr_b16 a[194:195], v17 offset:256
ds_read_b64_tr_b16 a[196:197], v17 offset:8
ds_read_b64_tr_b16 a[198:199], v17 offset:264
ds_read_b64_tr_b16 a[200:201], v17 offset:2048
ds_read_b64_tr_b16 a[202:203], v17 offset:2304
ds_read_b64_tr_b16 a[204:205], v17 offset:2056
ds_read_b64_tr_b16 a[206:207], v17 offset:2312
s_waitcnt lgkmcnt(0)
ds_read_b64_tr_b16 a[208:209], v17 offset:4096
ds_read_b64_tr_b16 a[210:211], v17 offset:4352
ds_read_b64_tr_b16 a[212:213], v17 offset:4104
ds_read_b64_tr_b16 a[214:215], v17 offset:4360
ds_read_b64_tr_b16 a[216:217], v17 offset:6144
ds_read_b64_tr_b16 a[218:219], v17 offset:6400
ds_read_b64_tr_b16 a[220:221], v17 offset:6152
ds_read_b64_tr_b16 a[222:223], v17 offset:6408
s_waitcnt lgkmcnt(0)
ds_read_b128 v[20:23], v8 offset:49152
ds_read_b128 v[24:27], v8 offset:51200
ds_read_b128 v[28:31], v9 offset:49152
ds_read_b128 v[32:35], v9 offset:51200
ds_read_b128 v[36:39], v8 offset:53248
ds_read_b128 v[40:43], v8 offset:55296
ds_read_b128 v[44:47], v9 offset:53248
ds_read_b128 v[48:51], v9 offset:55296
s_waitcnt lgkmcnt(0)
v_mfma_f32_16x16x32_bf16 v[52:55], a[192:195], v[20:23], v[52:55]
v_mfma_f32_16x16x32_bf16 v[56:59], a[196:199], v[20:23], v[56:59]
v_mfma_f32_16x16x32_bf16 v[60:63], a[192:195], v[24:27], v[60:63]
v_mfma_f32_16x16x32_bf16 v[64:67], a[196:199], v[24:27], v[64:67]
v_mfma_f32_16x16x32_bf16 v[52:55], a[200:203], v[28:31], v[52:55]
v_mfma_f32_16x16x32_bf16 v[56:59], a[204:207], v[28:31], v[56:59]
v_mfma_f32_16x16x32_bf16 v[60:63], a[200:203], v[32:35], v[60:63]
v_mfma_f32_16x16x32_bf16 v[64:67], a[204:207], v[32:35], v[64:67]
v_mfma_f32_16x16x32_bf16 v[52:55], a[208:211], v[36:39], v[52:55]
v_mfma_f32_16x16x32_bf16 v[56:59], a[212:215], v[36:39], v[56:59]
v_mfma_f32_16x16x32_bf16 v[60:63], a[208:211], v[40:43], v[60:63]
v_mfma_f32_16x16x32_bf16 v[64:67], a[212:215], v[40:43], v[64:67]
v_mfma_f32_16x16x32_bf16 v[52:55], a[216:219], v[44:47], v[52:55]
v_mfma_f32_16x16x32_bf16 v[56:59], a[220:223], v[44:47], v[56:59]
v_mfma_f32_16x16x32_bf16 v[60:63], a[216:219], v[48:51], v[60:63]
v_mfma_f32_16x16x32_bf16 v[64:67], a[220:223], v[48:51], v[64:67]
s_waitcnt vmcnt(0)
ds_read_b64_tr_b16 a[224:225], v17 offset:8192
ds_read_b64_tr_b16 a[226:227], v17 offset:8448
ds_read_b64_tr_b16 a[228:229], v17 offset:8200
ds_read_b64_tr_b16 a[230:231], v17 offset:8456
ds_read_b64_tr_b16 a[232:233], v17 offset:10240
ds_read_b64_tr_b16 a[234:235], v17 offset:10496
ds_read_b64_tr_b16 a[236:237], v17 offset:10248
ds_read_b64_tr_b16 a[238:239], v17 offset:10504
s_waitcnt lgkmcnt(0)
ds_read_b64_tr_b16 a[240:241], v17 offset:12288
ds_read_b64_tr_b16 a[242:243], v17 offset:12544
ds_read_b64_tr_b16 a[244:245], v17 offset:12296
ds_read_b64_tr_b16 a[246:247], v17 offset:12552
ds_read_b64_tr_b16 a[248:249], v17 offset:14336
ds_read_b64_tr_b16 a[250:251], v17 offset:14592
ds_read_b64_tr_b16 a[252:253], v17 offset:14344
ds_read_b64_tr_b16 a[254:255], v17 offset:14600
s_waitcnt lgkmcnt(0)
ds_read_b128 v[20:23], v8 offset:57344
ds_read_b128 v[24:27], v8 offset:59392
ds_read_b128 v[28:31], v9 offset:57344
ds_read_b128 v[32:35], v9 offset:59392
ds_read_b128 v[36:39], v8 offset:61440
ds_read_b128 v[40:43], v8 offset:63488
ds_read_b128 v[44:47], v9 offset:61440
ds_read_b128 v[48:51], v9 offset:63488
s_waitcnt lgkmcnt(0)
v_mfma_f32_16x16x32_bf16 v[52:55], a[224:227], v[20:23], v[52:55]
v_mfma_f32_16x16x32_bf16 v[56:59], a[228:231], v[20:23], v[56:59]
v_mfma_f32_16x16x32_bf16 v[60:63], a[224:227], v[24:27], v[60:63]
v_mfma_f32_16x16x32_bf16 v[64:67], a[228:231], v[24:27], v[64:67]
v_mfma_f32_16x16x32_bf16 v[52:55], a[232:235], v[28:31], v[52:55]
v_mfma_f32_16x16x32_bf16 v[56:59], a[236:239], v[28:31], v[56:59]
v_mfma_f32_16x16x32_bf16 v[60:63], a[232:235], v[32:35], v[60:63]
v_mfma_f32_16x16x32_bf16 v[64:67], a[236:239], v[32:35], v[64:67]
v_mfma_f32_16x16x32_bf16 v[52:55], a[240:243], v[36:39], v[52:55]
v_mfma_f32_16x16x32_bf16 v[56:59], a[244:247], v[36:39], v[56:59]
v_mfma_f32_16x16x32_bf16 v[60:63], a[240:243], v[40:43], v[60:63]
v_mfma_f32_16x16x32_bf16 v[64:67], a[244:247], v[40:43], v[64:67]
v_mfma_f32_16x16x32_bf16 v[52:55], a[248:251], v[44:47], v[52:55]
v_mfma_f32_16x16x32_bf16 v[56:59], a[252:255], v[44:47], v[56:59]
v_mfma_f32_16x16x32_bf16 v[60:63], a[248:251], v[48:51], v[60:63]
v_mfma_f32_16x16x32_bf16 v[64:67], a[252:255], v[48:51], v[64:67]
s_barrier
s_mov_b32 s50, 0x10000
s_add_u32 m0, s46, 65536
s_nop 0
buffer_load_dwordx4 v6, s[8:11], s50 offen offset:0 lds
s_add_u32 m0, s46, 69504
s_nop 0
buffer_load_dwordx4 v6, s[8:11], s50 offen offset:128 lds
s_add_u32 m0, s46, 73472
s_nop 0
buffer_load_dwordx4 v6, s[8:11], s50 offen offset:256 lds
s_add_u32 m0, s46, 77440
s_nop 0
buffer_load_dwordx4 v6, s[8:11], s50 offen offset:384 lds
s_add_u32 m0, s46, 81408
s_nop 0
buffer_load_dwordx4 v6, s[8:11], s50 offen offset:512 lds
s_add_u32 m0, s46, 85376
s_nop 0
buffer_load_dwordx4 v6, s[8:11], s50 offen offset:640 lds
s_add_u32 m0, s46, 89344
s_nop 0
buffer_load_dwordx4 v6, s[8:11], s50 offen offset:768 lds
s_add_u32 m0, s46, 93312
s_nop 0
buffer_load_dwordx4 v6, s[8:11], s50 offen offset:896 lds
s_add_u32 m0, s46, 97280
s_nop 0
buffer_load_dwordx4 v6, s[8:11], s50 offen offset:1024 lds
s_add_u32 m0, s46, 101248
s_nop 0
buffer_load_dwordx4 v6, s[8:11], s50 offen offset:1152 lds
s_add_u32 m0, s46, 105216
s_nop 0
buffer_load_dwordx4 v6, s[8:11], s50 offen offset:1280 lds
s_add_u32 m0, s46, 109184
s_nop 0
buffer_load_dwordx4 v6, s[8:11], s50 offen offset:1408 lds
s_add_u32 m0, s46, 113152
s_nop 0
buffer_load_dwordx4 v6, s[8:11], s50 offen offset:1536 lds
s_add_u32 m0, s46, 117120
s_nop 0
buffer_load_dwordx4 v6, s[8:11], s50 offen offset:1664 lds
s_add_u32 m0, s46, 121088
s_nop 0
buffer_load_dwordx4 v6, s[8:11], s50 offen offset:1792 lds
s_add_u32 m0, s46, 125056
s_nop 0
buffer_load_dwordx4 v6, s[8:11], s50 offen offset:1920 lds
s_and_b32 s53, s47, 31
s_lshl_b32 s53, s53, 4
v_add_u32 v19, s53, v1
v_lshlrev_b32 v19, 7, v19
s_mov_b32 s42, 1
v_and_b32 v3, 15, v0
v_lshlrev_b32 v3, 4, v3
s_branch mega_kernel_syk
mega_kernel_sykw:
s_sleep 4
mega_kernel_syk:
buffer_load_dword v2, v3, s[72:75], 0 offen sc1
s_waitcnt vmcnt(0)
mega_kernel_sykp:
s_cmp_eq_u32 s95, 1
s_cbranch_scc0 mega_kernel_sykf
v_readlane_b32 s76, v2, 14
s_mov_b32 s98, 0
s_cmp_eq_u32 s76, 32
s_cbranch_scc0 mega_kernel_sykw
s_branch mega_kernel_sykd
mega_kernel_sykf:
s_mov_b32 s77, 0
s_mov_b32 s78, 0
v_readlane_b32 s76, v2, 0
s_add_u32 s77, s77, s76
s_xor_b32 s76, s76, 32
s_or_b32 s78, s78, s76
v_readlane_b32 s76, v2, 1
s_add_u32 s77, s77, s76
s_xor_b32 s76, s76, 32
s_or_b32 s78, s78, s76
v_readlane_b32 s76, v2, 2
s_add_u32 s77, s77, s76
s_xor_b32 s76, s76, 32
s_or_b32 s78, s78, s76
v_readlane_b32 s76, v2, 3
s_add_u32 s77, s77, s76
s_xor_b32 s76, s76, 32
s_or_b32 s78, s78, s76
v_readlane_b32 s76, v2, 4
s_add_u32 s77, s77, s76
s_xor_b32 s76, s76, 32
s_or_b32 s78, s78, s76
v_readlane_b32 s76, v2, 5
s_add_u32 s77, s77, s76
s_xor_b32 s76, s76, 32
s_or_b32 s78, s78, s76
v_readlane_b32 s76, v2, 6
s_add_u32 s77, s77, s76
s_xor_b32 s76, s76, 32
s_or_b32 s78, s78, s76
v_readlane_b32 s76, v2, 7
s_add_u32 s77, s77, s76
s_xor_b32 s76, s76, 32
s_or_b32 s78, s78, s76
s_cmp_eq_u32 s77, 256
s_cbranch_scc0 mega_kernel_sykw
v_mov_b32 v252, v2
s_cmp_eq_u32 s78, 0
s_cbranch_scc0 mega_kernel_slowent
v_readlane_b32 s76, v2, 10
v_readlane_b32 s77, v2, 8
s_cmp_eq_u32 s76, 32
s_cbranch_scc0 mega_kernel_sykw
s_cmp_gt_u32 s77, 16
s_cselect_b32 s98, 1, 0
mega_kernel_sykd:
s_lshr_b32 s44, s47, 3
s_xor_b32 s44, s44, s98
s_and_b32 s44, s44, 1
s_lshl_b32 s44, s44, 13
s_lshl_b32 s48, s47, 18
s_add_u32 s48, s48, s44
s_add_u32 s48, s48, 0
s_xor_b32 s44, s98, 1
s_lshl_b32 s44, s44, 13
s_lshl_b32 s49, s40, 7
s_add_u32 s49, s49, s44
s_lshl_b32 s44, s41, 2
s_add_u32 s49, s49, s44
s_add_u32 s49, s49, 69206016
v_mov_b32 v16, 0
v_cvt_pk_bf16_f32 v84, v52, v53
v_cvt_pk_bf16_f32 v85, v54, v55
v_cvt_pk_bf16_f32 v86, v56, v57
v_cvt_pk_bf16_f32 v87, v58, v59
v_cvt_pk_bf16_f32 v88, v60, v61
v_cvt_pk_bf16_f32 v89, v62, v63
v_cvt_pk_bf16_f32 v90, v64, v65
v_cvt_pk_bf16_f32 v91, v66, v67
s_add_u32 s51, s42, s47
s_sub_u32 s51, s51, 1
s_bfe_u32 s52, s51, 0x40002
s_lshl_b32 s52, s52, 14
s_and_b32 s51, s51, 3
s_lshl_b32 s51, s51, 11
s_add_u32 s51, s51, s52
s_add_u32 s51, s51, s48
buffer_store_dwordx4 v[84:87], v7, s[84:87], s51 offen sc1
buffer_store_dwordx4 v[88:91], v7, s[84:87], s51 offen offset:1024 sc1
s_waitcnt vmcnt(0)
v_mov_b32 v17, s42
s_mov_b64 exec, 1
buffer_store_dword v17, v16, s[84:87], s49 offen sc1
s_mov_b64 exec, -1
mega_kernel_k_loop:
s_waitcnt vmcnt(2)
s_barrier
s_add_u32 s50, s42, 1
s_min_u32 s50, s50, 63
s_lshl_b32 s50, s50, 16
ds_read_b128 v[20:23], v10 offset:0
ds_read_b128 v[24:27], v10 offset:2048
ds_read_b128 v[28:31], v11 offset:0
ds_read_b128 v[32:35], v11 offset:2048
ds_read_b128 v[36:39], v10 offset:4096
ds_read_b128 v[40:43], v10 offset:6144
s_waitcnt lgkmcnt(4)
v_mfma_f32_16x16x32_bf16 v[68:71], a[0:3], v[20:23], 0
ds_read_b128 v[44:47], v11 offset:4096
v_mfma_f32_16x16x32_bf16 v[72:75], a[4:7], v[20:23], 0
v_cvt_pk_bf16_f32 v84, v52, v53
v_cvt_pk_bf16_f32 v85, v54, v55
v_cvt_pk_bf16_f32 v86, v56, v57
v_mfma_f32_16x16x32_bf16 v[76:79], a[0:3], v[24:27], 0
ds_read_b128 v[48:51], v11 offset:6144
v_mfma_f32_16x16x32_bf16 v[80:83], a[4:7], v[24:27], 0
v_cvt_pk_bf16_f32 v87, v58, v59
v_cvt_pk_bf16_f32 v88, v60, v61
v_cvt_pk_bf16_f32 v89, v62, v63
s_waitcnt lgkmcnt(4)
v_mfma_f32_16x16x32_bf16 v[68:71], a[8:11], v[28:31], v[68:71]
ds_read_b128 v[20:23], v10 offset:8192
v_mfma_f32_16x16x32_bf16 v[72:75], a[12:15], v[28:31], v[72:75]
v_cvt_pk_bf16_f32 v90, v64, v65
v_cvt_pk_bf16_f32 v91, v66, v67
v_mfma_f32_16x16x32_bf16 v[76:79], a[8:11], v[32:35], v[76:79]
ds_read_b128 v[24:27], v10 offset:10240
v_mfma_f32_16x16x32_bf16 v[80:83], a[12:15], v[32:35], v[80:83]
s_add_u32 s51, s42, s47
s_sub_u32 s51, s51, 1
s_bfe_u32 s52, s51, 0x40002
s_lshl_b32 s52, s52, 14
s_waitcnt lgkmcnt(4)
v_mfma_f32_16x16x32_bf16 v[68:71], a[16:19], v[36:39], v[68:71]
ds_read_b128 v[28:31], v11 offset:8192
v_mfma_f32_16x16x32_bf16 v[72:75], a[20:23], v[36:39], v[72:75]
s_and_b32 s51, s51, 3
s_lshl_b32 s51, s51, 11
s_add_u32 s51, s51, s52
s_add_u32 s51, s51, s48
buffer_store_dwordx4 v[84:87], v7, s[84:87], s51 offen sc1
v_mfma_f32_16x16x32_bf16 v[76:79], a[16:19], v[40:43], v[76:79]
ds_read_b128 v[32:35], v11 offset:10240
v_mfma_f32_16x16x32_bf16 v[80:83], a[20:23], v[40:43], v[80:83]
buffer_store_dwordx4 v[88:91], v7, s[84:87], s51 offen offset:1024 sc1
s_waitcnt lgkmcnt(4)
v_mfma_f32_16x16x32_bf16 v[68:71], a[24:27], v[44:47], v[68:71]
ds_read_b128 v[36:39], v10 offset:12288
v_mfma_f32_16x16x32_bf16 v[72:75], a[28:31], v[44:47], v[72:75]
s_add_u32 m0, s46, 0
v_mfma_f32_16x16x32_bf16 v[76:79], a[24:27], v[48:51], v[76:79]
ds_read_b128 v[40:43], v10 offset:14336
v_mfma_f32_16x16x32_bf16 v[80:83], a[28:31], v[48:51], v[80:83]
buffer_load_dwordx4 v6, s[8:11], s50 offen offset:0 lds
s_waitcnt lgkmcnt(4)
v_mfma_f32_16x16x32_bf16 v[68:71], a[32:35], v[20:23], v[68:71]
ds_read_b128 v[44:47], v11 offset:12288
v_mfma_f32_16x16x32_bf16 v[72:75], a[36:39], v[20:23], v[72:75]
s_add_u32 m0, s46, 3968
v_mfma_f32_16x16x32_bf16 v[76:79], a[32:35], v[24:27], v[76:79]
ds_read_b128 v[48:51], v11 offset:14336
v_mfma_f32_16x16x32_bf16 v[80:83], a[36:39], v[24:27], v[80:83]
buffer_load_dwordx4 v6, s[8:11], s50 offen offset:128 lds
s_waitcnt lgkmcnt(4)
v_mfma_f32_16x16x32_bf16 v[68:71], a[40:43], v[28:31], v[68:71]
ds_read_b128 v[20:23], v10 offset:16384
v_mfma_f32_16x16x32_bf16 v[72:75], a[44:47], v[28:31], v[72:75]
s_add_u32 m0, s46, 7936
v_mfma_f32_16x16x32_bf16 v[76:79], a[40:43], v[32:35], v[76:79]
ds_read_b128 v[24:27], v10 offset:18432
v_mfma_f32_16x16x32_bf16 v[80:83], a[44:47], v[32:35], v[80:83]
buffer_load_dwordx4 v6, s[8:11], s50 offen offset:256 lds
s_waitcnt lgkmcnt(4)
v_mfma_f32_16x16x32_bf16 v[68:71], a[48:51], v[36:39], v[68:71]
ds_read_b128 v[28:31], v11 offset:16384
v_mfma_f32_16x16x32_bf16 v[72:75], a[52:55], v[36:39], v[72:75]
s_add_u32 m0, s46, 11904
v_mfma_f32_16x16x32_bf16 v[76:79], a[48:51], v[40:43], v[76:79]
ds_read_b128 v[32:35], v11 offset:18432
v_mfma_f32_16x16x32_bf16 v[80:83], a[52:55], v[40:43], v[80:83]
buffer_load_dwordx4 v6, s[8:11], s50 offen offset:384 lds
s_waitcnt lgkmcnt(4)
v_mfma_f32_16x16x32_bf16 v[68:71], a[56:59], v[44:47], v[68:71]
ds_read_b128 v[36:39], v10 offset:20480
v_mfma_f32_16x16x32_bf16 v[72:75], a[60:63], v[44:47], v[72:75]
s_add_u32 m0, s46, 15872
v_mfma_f32_16x16x32_bf16 v[76:79], a[56:59], v[48:51], v[76:79]
ds_read_b128 v[40:43], v10 offset:22528
v_mfma_f32_16x16x32_bf16 v[80:83], a[60:63], v[48:51], v[80:83]
buffer_load_dwordx4 v6, s[8:11], s50 offen offset:512 lds
s_waitcnt lgkmcnt(4)
v_mfma_f32_16x16x32_bf16 v[68:71], a[64:67], v[20:23], v[68:71]
ds_read_b128 v[44:47], v11 offset:20480
v_mfma_f32_16x16x32_bf16 v[72:75], a[68:71], v[20:23], v[72:75]
s_add_u32 m0, s46, 19840
v_mfma_f32_16x16x32_bf16 v[76:79], a[64:67], v[24:27], v[76:79]
ds_read_b128 v[48:51], v11 offset:22528
v_mfma_f32_16x16x32_bf16 v[80:83], a[68:71], v[24:27], v[80:83]
buffer_load_dwordx4 v6, s[8:11], s50 offen offset:640 lds
s_waitcnt lgkmcnt(4)
v_mfma_f32_16x16x32_bf16 v[68:71], a[72:75], v[28:31], v[68:71]
ds_read_b128 v[20:23], v10 offset:24576
v_mfma_f32_16x16x32_bf16 v[72:75], a[76:79], v[28:31], v[72:75]
s_add_u32 m0, s46, 23808
v_mfma_f32_16x16x32_bf16 v[76:79], a[72:75], v[32:35], v[76:79]
ds_read_b128 v[24:27], v10 offset:26624
v_mfma_f32_16x16x32_bf16 v[80:83], a[76:79], v[32:35], v[80:83]
buffer_load_dwordx4 v6, s[8:11], s50 offen offset:768 lds
s_waitcnt lgkmcnt(4)
v_mfma_f32_16x16x32_bf16 v[68:71], a[80:83], v[36:39], v[68:71]
ds_read_b128 v[28:31], v11 offset:24576
v_mfma_f32_16x16x32_bf16 v[72:75], a[84:87], v[36:39], v[72:75]
s_add_u32 m0, s46, 27776
v_mfma_f32_16x16x32_bf16 v[76:79], a[80:83], v[40:43], v[76:79]
ds_read_b128 v[32:35], v11 offset:26624
v_mfma_f32_16x16x32_bf16 v[80:83], a[84:87], v[40:43], v[80:83]
buffer_load_dwordx4 v6, s[8:11], s50 offen offset:896 lds
s_waitcnt lgkmcnt(4)
v_mfma_f32_16x16x32_bf16 v[68:71], a[88:91], v[44:47], v[68:71]
ds_read_b128 v[36:39], v10 offset:28672
v_mfma_f32_16x16x32_bf16 v[72:75], a[92:95], v[44:47], v[72:75]
s_add_u32 m0, s46, 31744
v_mfma_f32_16x16x32_bf16 v[76:79], a[88:91], v[48:51], v[76:79]
ds_read_b128 v[40:43], v10 offset:30720
v_mfma_f32_16x16x32_bf16 v[80:83], a[92:95], v[48:51], v[80:83]
buffer_load_dwordx4 v6, s[8:11], s50 offen offset:1024 lds
s_waitcnt lgkmcnt(4)
v_mfma_f32_16x16x32_bf16 v[68:71], a[96:99], v[20:23], v[68:71]
ds_read_b128 v[44:47], v11 offset:28672
v_mfma_f32_16x16x32_bf16 v[72:75], a[100:103], v[20:23], v[72:75]
s_add_u32 m0, s46, 35712
v_mfma_f32_16x16x32_bf16 v[76:79], a[96:99], v[24:27], v[76:79]
ds_read_b128 v[48:51], v11 offset:30720
v_mfma_f32_16x16x32_bf16 v[80:83], a[100:103], v[24:27], v[80:83]
buffer_load_dwordx4 v6, s[8:11], s50 offen offset:1152 lds
s_waitcnt lgkmcnt(4)
v_mfma_f32_16x16x32_bf16 v[68:71], a[104:107], v[28:31], v[68:71]
ds_read_b128 v[20:23], v10 offset:32768
v_mfma_f32_16x16x32_bf16 v[72:75], a[108:111], v[28:31], v[72:75]
s_add_u32 m0, s46, 39680
v_mfma_f32_16x16x32_bf16 v[76:79], a[104:107], v[32:35], v[76:79]
ds_read_b128 v[24:27], v10 offset:34816
v_mfma_f32_16x16x32_bf16 v[80:83], a[108:111], v[32:35], v[80:83]
buffer_load_dwordx4 v6, s[8:11], s50 offen offset:1280 lds
s_waitcnt lgkmcnt(4)
v_mfma_f32_16x16x32_bf16 v[68:71], a[112:115], v[36:39], v[68:71]
ds_read_b128 v[28:31], v11 offset:32768
v_mfma_f32_16x16x32_bf16 v[72:75], a[116:119], v[36:39], v[72:75]
s_add_u32 m0, s46, 43648
v_mfma_f32_16x16x32_bf16 v[76:79], a[112:115], v[40:43], v[76:79]
ds_read_b128 v[32:35], v11 offset:34816
v_mfma_f32_16x16x32_bf16 v[80:83], a[116:119], v[40:43], v[80:83]
buffer_load_dwordx4 v6, s[8:11], s50 offen offset:1408 lds
s_waitcnt lgkmcnt(4)
v_mfma_f32_16x16x32_bf16 v[68:71], a[120:123], v[44:47], v[68:71]
ds_read_b128 v[36:39], v10 offset:36864
v_mfma_f32_16x16x32_bf16 v[72:75], a[124:127], v[44:47], v[72:75]
s_add_u32 m0, s46, 47616
v_mfma_f32_16x16x32_bf16 v[76:79], a[120:123], v[48:51], v[76:79]
ds_read_b128 v[40:43], v10 offset:38912
v_mfma_f32_16x16x32_bf16 v[80:83], a[124:127], v[48:51], v[80:83]
buffer_load_dwordx4 v6, s[8:11], s50 offen offset:1536 lds
s_waitcnt lgkmcnt(4)
v_mfma_f32_16x16x32_bf16 v[68:71], a[128:131], v[20:23], v[68:71]
ds_read_b128 v[44:47], v11 offset:36864
v_mfma_f32_16x16x32_bf16 v[72:75], a[132:135], v[20:23], v[72:75]
s_add_u32 m0, s46, 51584
v_mfma_f32_16x16x32_bf16 v[76:79], a[128:131], v[24:27], v[76:79]
ds_read_b128 v[48:51], v11 offset:38912
v_mfma_f32_16x16x32_bf16 v[80:83], a[132:135], v[24:27], v[80:83]
buffer_load_dwordx4 v6, s[8:11], s50 offen offset:1664 lds
s_waitcnt lgkmcnt(4)
v_mfma_f32_16x16x32_bf16 v[68:71], a[136:139], v[28:31], v[68:71]
ds_read_b128 v[20:23], v10 offset:40960
v_mfma_f32_16x16x32_bf16 v[72:75], a[140:143], v[28:31], v[72:75]
s_add_u32 m0, s46, 55552
v_mfma_f32_16x16x32_bf16 v[76:79], a[136:139], v[32:35], v[76:79]
ds_read_b128 v[24:27], v10 offset:43008
v_mfma_f32_16x16x32_bf16 v[80:83], a[140:143], v[32:35], v[80:83]
buffer_load_dwordx4 v6, s[8:11], s50 offen offset:1792 lds
s_waitcnt lgkmcnt(4)
v_mfma_f32_16x16x32_bf16 v[68:71], a[144:147], v[36:39], v[68:71]
ds_read_b128 v[28:31], v11 offset:40960
v_mfma_f32_16x16x32_bf16 v[72:75], a[148:151], v[36:39], v[72:75]
s_add_u32 m0, s46, 59520
v_mfma_f32_16x16x32_bf16 v[76:79], a[144:147], v[40:43], v[76:79]
ds_read_b128 v[32:35], v11 offset:43008
v_mfma_f32_16x16x32_bf16 v[80:83], a[148:151], v[40:43], v[80:83]
buffer_load_dwordx4 v6, s[8:11], s50 offen offset:1920 lds
s_waitcnt lgkmcnt(4)
v_mfma_f32_16x16x32_bf16 v[68:71], a[152:155], v[44:47], v[68:71]
ds_read_b128 v[36:39], v10 offset:45056
v_mfma_f32_16x16x32_bf16 v[72:75], a[156:159], v[44:47], v[72:75]
v_mfma_f32_16x16x32_bf16 v[76:79], a[152:155], v[48:51], v[76:79]
ds_read_b128 v[40:43], v10 offset:47104
v_mfma_f32_16x16x32_bf16 v[80:83], a[156:159], v[48:51], v[80:83]
s_waitcnt lgkmcnt(4)
v_mfma_f32_16x16x32_bf16 v[68:71], a[160:163], v[20:23], v[68:71]
ds_read_b128 v[44:47], v11 offset:45056
v_mfma_f32_16x16x32_bf16 v[72:75], a[164:167], v[20:23], v[72:75]
v_mfma_f32_16x16x32_bf16 v[76:79], a[160:163], v[24:27], v[76:79]
ds_read_b128 v[48:51], v11 offset:47104
v_mfma_f32_16x16x32_bf16 v[80:83], a[164:167], v[24:27], v[80:83]
s_waitcnt lgkmcnt(4)
v_mfma_f32_16x16x32_bf16 v[68:71], a[168:171], v[28:31], v[68:71]
ds_read_b128 v[20:23], v10 offset:49152
v_mfma_f32_16x16x32_bf16 v[72:75], a[172:175], v[28:31], v[72:75]
s_waitcnt vmcnt(16)
v_mov_b32 v17, s42
s_mov_b64 exec, 1
buffer_store_dword v17, v16, s[84:87], s49 offen sc1
s_mov_b64 exec, -1
v_mfma_f32_16x16x32_bf16 v[76:79], a[168:171], v[32:35], v[76:79]
ds_read_b128 v[24:27], v10 offset:51200
v_mfma_f32_16x16x32_bf16 v[80:83], a[172:175], v[32:35], v[80:83]
s_waitcnt lgkmcnt(4)
v_mfma_f32_16x16x32_bf16 v[68:71], a[176:179], v[36:39], v[68:71]
ds_read_b128 v[28:31], v11 offset:49152
v_mfma_f32_16x16x32_bf16 v[72:75], a[180:183], v[36:39], v[72:75]
s_add_u32 s53, s42, 3
s_min_u32 s53, s53, 63
s_lshl_b32 s53, s53, 16
s_mov_b64 exec, 0xffff
buffer_load_dword v250, v19, s[8:11], s53 offen
s_mov_b64 exec, -1
v_mfma_f32_16x16x32_bf16 v[76:79], a[176:179], v[40:43], v[76:79]
ds_read_b128 v[32:35], v11 offset:51200
v_mfma_f32_16x16x32_bf16 v[80:83], a[180:183], v[40:43], v[80:83]
s_waitcnt lgkmcnt(4)
v_mfma_f32_16x16x32_bf16 v[68:71], a[184:187], v[44:47], v[68:71]
ds_read_b128 v[36:39], v10 offset:53248
v_mfma_f32_16x16x32_bf16 v[72:75], a[188:191], v[44:47], v[72:75]
v_mfma_f32_16x16x32_bf16 v[76:79], a[184:187], v[48:51], v[76:79]
ds_read_b128 v[40:43], v10 offset:55296
v_mfma_f32_16x16x32_bf16 v[80:83], a[188:191], v[48:51], v[80:83]
s_waitcnt lgkmcnt(4)
v_mfma_f32_16x16x32_bf16 v[68:71], a[192:195], v[20:23], v[68:71]
ds_read_b128 v[44:47], v11 offset:53248
v_mfma_f32_16x16x32_bf16 v[72:75], a[196:199], v[20:23], v[72:75]
v_mfma_f32_16x16x32_bf16 v[76:79], a[192:195], v[24:27], v[76:79]
ds_read_b128 v[48:51], v11 offset:55296
v_mfma_f32_16x16x32_bf16 v[80:83], a[196:199], v[24:27], v[80:83]
s_waitcnt lgkmcnt(4)
v_mfma_f32_16x16x32_bf16 v[68:71], a[200:203], v[28:31], v[68:71]
ds_read_b128 v[20:23], v10 offset:57344
v_mfma_f32_16x16x32_bf16 v[72:75], a[204:207], v[28:31], v[72:75]
v_mfma_f32_16x16x32_bf16 v[76:79], a[200:203], v[32:35], v[76:79]
ds_read_b128 v[24:27], v10 offset:59392
v_mfma_f32_16x16x32_bf16 v[80:83], a[204:207], v[32:35], v[80:83]
s_waitcnt lgkmcnt(4)
v_mfma_f32_16x16x32_bf16 v[68:71], a[208:211], v[36:39], v[68:71]
ds_read_b128 v[28:31], v11 offset:57344
v_mfma_f32_16x16x32_bf16 v[72:75], a[212:215], v[36:39], v[72:75]
v_mfma_f32_16x16x32_bf16 v[76:79], a[208:211], v[40:43], v[76:79]
ds_read_b128 v[32:35], v11 offset:59392
v_mfma_f32_16x16x32_bf16 v[80:83], a[212:215], v[40:43], v[80:83]
s_waitcnt lgkmcnt(4)
v_mfma_f32_16x16x32_bf16 v[68:71], a[216:219], v[44:47], v[68:71]
ds_read_b128 v[36:39], v10 offset:61440
v_mfma_f32_16x16x32_bf16 v[72:75], a[220:223], v[44:47], v[72:75]
v_mfma_f32_16x16x32_bf16 v[76:79], a[216:219], v[48:51], v[76:79]
ds_read_b128 v[40:43], v10 offset:63488
v_mfma_f32_16x16x32_bf16 v[80:83], a[220:223], v[48:51], v[80:83]
s_waitcnt lgkmcnt(4)
v_mfma_f32_16x16x32_bf16 v[68:71], a[224:227], v[20:23], v[68:71]
ds_read_b128 v[44:47], v11 offset:61440
v_mfma_f32_16x16x32_bf16 v[72:75], a[228:231], v[20:23], v[72:75]
v_mfma_f32_16x16x32_bf16 v[76:79], a[224:227], v[24:27], v[76:79]
ds_read_b128 v[48:51], v11 offset:63488
v_mfma_f32_16x16x32_bf16 v[80:83], a[228:231], v[24:27], v[80:83]
s_waitcnt lgkmcnt(5)
v_mfma_f32_16x16x32_bf16 v[68:71], a[232:235], v[28:31], v[68:71]
v_mfma_f32_16x16x32_bf16 v[72:75], a[236:239], v[28:31], v[72:75]
s_waitcnt lgkmcnt(4)
v_mfma_f32_16x16x32_bf16 v[76:79], a[232:235], v[32:35], v[76:79]
v_mfma_f32_16x16x32_bf16 v[80:83], a[236:239], v[32:35], v[80:83]
s_waitcnt lgkmcnt(3)
v_mfma_f32_16x16x32_bf16 v[68:71], a[240:243], v[36:39], v[68:71]
v_mfma_f32_16x16x32_bf16 v[72:75], a[244:247], v[36:39], v[72:75]
s_waitcnt lgkmcnt(2)
v_mfma_f32_16x16x32_bf16 v[76:79], a[240:243], v[40:43], v[76:79]
v_mfma_f32_16x16x32_bf16 v[80:83], a[244:247], v[40:43], v[80:83]
s_waitcnt lgkmcnt(1)
v_mfma_f32_16x16x32_bf16 v[68:71], a[248:251], v[44:47], v[68:71]
v_mfma_f32_16x16x32_bf16 v[72:75], a[252:255], v[44:47], v[72:75]
s_waitcnt lgkmcnt(0)
v_mfma_f32_16x16x32_bf16 v[76:79], a[248:251], v[48:51], v[76:79]
v_mfma_f32_16x16x32_bf16 v[80:83], a[252:255], v[48:51], v[80:83]
s_add_u32 s42, s42, 1
s_cmp_eq_u32 s42, 64
s_cbranch_scc1 mega_kernel_k_fin
mega_kernel_k_mid:
s_waitcnt vmcnt(2)
s_barrier
s_add_u32 s50, s42, 1
s_min_u32 s50, s50, 63
s_lshl_b32 s50, s50, 16
ds_read_b128 v[20:23], v8 offset:0
ds_read_b128 v[24:27], v8 offset:2048
ds_read_b128 v[28:31], v9 offset:0
ds_read_b128 v[32:35], v9 offset:2048
ds_read_b128 v[36:39], v8 offset:4096
ds_read_b128 v[40:43], v8 offset:6144
s_waitcnt lgkmcnt(4)
v_mfma_f32_16x16x32_bf16 v[52:55], a[0:3], v[20:23], 0
ds_read_b128 v[44:47], v9 offset:4096
v_mfma_f32_16x16x32_bf16 v[56:59], a[4:7], v[20:23], 0
v_cvt_pk_bf16_f32 v84, v68, v69
v_cvt_pk_bf16_f32 v85, v70, v71
v_cvt_pk_bf16_f32 v86, v72, v73
v_mfma_f32_16x16x32_bf16 v[60:63], a[0:3], v[24:27], 0
ds_read_b128 v[48:51], v9 offset:6144
v_mfma_f32_16x16x32_bf16 v[64:67], a[4:7], v[24:27], 0
v_cvt_pk_bf16_f32 v87, v74, v75
v_cvt_pk_bf16_f32 v88, v76, v77
v_cvt_pk_bf16_f32 v89, v78, v79
s_waitcnt lgkmcnt(4)
v_mfma_f32_16x16x32_bf16 v[52:55], a[8:11], v[28:31], v[52:55]
ds_read_b128 v[20:23], v8 offset:8192
v_mfma_f32_16x16x32_bf16 v[56:59], a[12:15], v[28:31], v[56:59]
v_cvt_pk_bf16_f32 v90, v80, v81
v_cvt_pk_bf16_f32 v91, v82, v83
v_mfma_f32_16x16x32_bf16 v[60:63], a[8:11], v[32:35], v[60:63]
ds_read_b128 v[24:27], v8 offset:10240
v_mfma_f32_16x16x32_bf16 v[64:67], a[12:15], v[32:35], v[64:67]
s_add_u32 s51, s42, s47
s_sub_u32 s51, s51, 1
s_bfe_u32 s52, s51, 0x40002
s_lshl_b32 s52, s52, 14
s_waitcnt lgkmcnt(4)
v_mfma_f32_16x16x32_bf16 v[52:55], a[16:19], v[36:39], v[52:55]
ds_read_b128 v[28:31], v9 offset:8192
v_mfma_f32_16x16x32_bf16 v[56:59], a[20:23], v[36:39], v[56:59]
s_and_b32 s51, s51, 3
s_lshl_b32 s51, s51, 11
s_add_u32 s51, s51, s52
s_add_u32 s51, s51, s48
buffer_store_dwordx4 v[84:87], v7, s[84:87], s51 offen sc1
v_mfma_f32_16x16x32_bf16 v[60:63], a[16:19], v[40:43], v[60:63]
ds_read_b128 v[32:35], v9 offset:10240
v_mfma_f32_16x16x32_bf16 v[64:67], a[20:23], v[40:43], v[64:67]
buffer_store_dwordx4 v[88:91], v7, s[84:87], s51 offen offset:1024 sc1
s_waitcnt lgkmcnt(4)
v_mfma_f32_16x16x32_bf16 v[52:55], a[24:27], v[44:47], v[52:55]
ds_read_b128 v[36:39], v8 offset:12288
v_mfma_f32_16x16x32_bf16 v[56:59], a[28:31], v[44:47], v[56:59]
s_add_u32 m0, s46, 65536
v_mfma_f32_16x16x32_bf16 v[60:63], a[24:27], v[48:51], v[60:63]
ds_read_b128 v[40:43], v8 offset:14336
v_mfma_f32_16x16x32_bf16 v[64:67], a[28:31], v[48:51], v[64:67]
buffer_load_dwordx4 v6, s[8:11], s50 offen offset:0 lds
s_waitcnt lgkmcnt(4)
v_mfma_f32_16x16x32_bf16 v[52:55], a[32:35], v[20:23], v[52:55]
ds_read_b128 v[44:47], v9 offset:12288
v_mfma_f32_16x16x32_bf16 v[56:59], a[36:39], v[20:23], v[56:59]
s_add_u32 m0, s46, 69504
v_mfma_f32_16x16x32_bf16 v[60:63], a[32:35], v[24:27], v[60:63]
ds_read_b128 v[48:51], v9 offset:14336
v_mfma_f32_16x16x32_bf16 v[64:67], a[36:39], v[24:27], v[64:67]
buffer_load_dwordx4 v6, s[8:11], s50 offen offset:128 lds
s_waitcnt lgkmcnt(4)
v_mfma_f32_16x16x32_bf16 v[52:55], a[40:43], v[28:31], v[52:55]
ds_read_b128 v[20:23], v8 offset:16384
v_mfma_f32_16x16x32_bf16 v[56:59], a[44:47], v[28:31], v[56:59]
s_add_u32 m0, s46, 73472
v_mfma_f32_16x16x32_bf16 v[60:63], a[40:43], v[32:35], v[60:63]
ds_read_b128 v[24:27], v8 offset:18432
v_mfma_f32_16x16x32_bf16 v[64:67], a[44:47], v[32:35], v[64:67]
buffer_load_dwordx4 v6, s[8:11], s50 offen offset:256 lds
s_waitcnt lgkmcnt(4)
v_mfma_f32_16x16x32_bf16 v[52:55], a[48:51], v[36:39], v[52:55]
ds_read_b128 v[28:31], v9 offset:16384
v_mfma_f32_16x16x32_bf16 v[56:59], a[52:55], v[36:39], v[56:59]
s_add_u32 m0, s46, 77440
v_mfma_f32_16x16x32_bf16 v[60:63], a[48:51], v[40:43], v[60:63]
ds_read_b128 v[32:35], v9 offset:18432
v_mfma_f32_16x16x32_bf16 v[64:67], a[52:55], v[40:43], v[64:67]
buffer_load_dwordx4 v6, s[8:11], s50 offen offset:384 lds
s_waitcnt lgkmcnt(4)
v_mfma_f32_16x16x32_bf16 v[52:55], a[56:59], v[44:47], v[52:55]
ds_read_b128 v[36:39], v8 offset:20480
v_mfma_f32_16x16x32_bf16 v[56:59], a[60:63], v[44:47], v[56:59]
s_add_u32 m0, s46, 81408
v_mfma_f32_16x16x32_bf16 v[60:63], a[56:59], v[48:51], v[60:63]
ds_read_b128 v[40:43], v8 offset:22528
v_mfma_f32_16x16x32_bf16 v[64:67], a[60:63], v[48:51], v[64:67]
buffer_load_dwordx4 v6, s[8:11], s50 offen offset:512 lds
s_waitcnt lgkmcnt(4)
v_mfma_f32_16x16x32_bf16 v[52:55], a[64:67], v[20:23], v[52:55]
ds_read_b128 v[44:47], v9 offset:20480
v_mfma_f32_16x16x32_bf16 v[56:59], a[68:71], v[20:23], v[56:59]
s_add_u32 m0, s46, 85376
v_mfma_f32_16x16x32_bf16 v[60:63], a[64:67], v[24:27], v[60:63]
ds_read_b128 v[48:51], v9 offset:22528
v_mfma_f32_16x16x32_bf16 v[64:67], a[68:71], v[24:27], v[64:67]
buffer_load_dwordx4 v6, s[8:11], s50 offen offset:640 lds
s_waitcnt lgkmcnt(4)
v_mfma_f32_16x16x32_bf16 v[52:55], a[72:75], v[28:31], v[52:55]
ds_read_b128 v[20:23], v8 offset:24576
v_mfma_f32_16x16x32_bf16 v[56:59], a[76:79], v[28:31], v[56:59]
s_add_u32 m0, s46, 89344
v_mfma_f32_16x16x32_bf16 v[60:63], a[72:75], v[32:35], v[60:63]
ds_read_b128 v[24:27], v8 offset:26624
v_mfma_f32_16x16x32_bf16 v[64:67], a[76:79], v[32:35], v[64:67]
buffer_load_dwordx4 v6, s[8:11], s50 offen offset:768 lds
s_waitcnt lgkmcnt(4)
v_mfma_f32_16x16x32_bf16 v[52:55], a[80:83], v[36:39], v[52:55]
ds_read_b128 v[28:31], v9 offset:24576
v_mfma_f32_16x16x32_bf16 v[56:59], a[84:87], v[36:39], v[56:59]
s_add_u32 m0, s46, 93312
v_mfma_f32_16x16x32_bf16 v[60:63], a[80:83], v[40:43], v[60:63]
ds_read_b128 v[32:35], v9 offset:26624
v_mfma_f32_16x16x32_bf16 v[64:67], a[84:87], v[40:43], v[64:67]
buffer_load_dwordx4 v6, s[8:11], s50 offen offset:896 lds
s_waitcnt lgkmcnt(4)
v_mfma_f32_16x16x32_bf16 v[52:55], a[88:91], v[44:47], v[52:55]
ds_read_b128 v[36:39], v8 offset:28672
v_mfma_f32_16x16x32_bf16 v[56:59], a[92:95], v[44:47], v[56:59]
s_add_u32 m0, s46, 97280
v_mfma_f32_16x16x32_bf16 v[60:63], a[88:91], v[48:51], v[60:63]
ds_read_b128 v[40:43], v8 offset:30720
v_mfma_f32_16x16x32_bf16 v[64:67], a[92:95], v[48:51], v[64:67]
buffer_load_dwordx4 v6, s[8:11], s50 offen offset:1024 lds
s_waitcnt lgkmcnt(4)
v_mfma_f32_16x16x32_bf16 v[52:55], a[96:99], v[20:23], v[52:55]
ds_read_b128 v[44:47], v9 offset:28672
v_mfma_f32_16x16x32_bf16 v[56:59], a[100:103], v[20:23], v[56:59]
s_add_u32 m0, s46, 101248
v_mfma_f32_16x16x32_bf16 v[60:63], a[96:99], v[24:27], v[60:63]
ds_read_b128 v[48:51], v9 offset:30720
v_mfma_f32_16x16x32_bf16 v[64:67], a[100:103], v[24:27], v[64:67]
buffer_load_dwordx4 v6, s[8:11], s50 offen offset:1152 lds
s_waitcnt lgkmcnt(4)
v_mfma_f32_16x16x32_bf16 v[52:55], a[104:107], v[28:31], v[52:55]
ds_read_b128 v[20:23], v8 offset:32768
v_mfma_f32_16x16x32_bf16 v[56:59], a[108:111], v[28:31], v[56:59]
s_add_u32 m0, s46, 105216
v_mfma_f32_16x16x32_bf16 v[60:63], a[104:107], v[32:35], v[60:63]
ds_read_b128 v[24:27], v8 offset:34816
v_mfma_f32_16x16x32_bf16 v[64:67], a[108:111], v[32:35], v[64:67]
buffer_load_dwordx4 v6, s[8:11], s50 offen offset:1280 lds
s_waitcnt lgkmcnt(4)
v_mfma_f32_16x16x32_bf16 v[52:55], a[112:115], v[36:39], v[52:55]
ds_read_b128 v[28:31], v9 offset:32768
v_mfma_f32_16x16x32_bf16 v[56:59], a[116:119], v[36:39], v[56:59]
s_add_u32 m0, s46, 109184
v_mfma_f32_16x16x32_bf16 v[60:63], a[112:115], v[40:43], v[60:63]
ds_read_b128 v[32:35], v9 offset:34816
v_mfma_f32_16x16x32_bf16 v[64:67], a[116:119], v[40:43], v[64:67]
buffer_load_dwordx4 v6, s[8:11], s50 offen offset:1408 lds
s_waitcnt lgkmcnt(4)
v_mfma_f32_16x16x32_bf16 v[52:55], a[120:123], v[44:47], v[52:55]
ds_read_b128 v[36:39], v8 offset:36864
v_mfma_f32_16x16x32_bf16 v[56:59], a[124:127], v[44:47], v[56:59]
s_add_u32 m0, s46, 113152
v_mfma_f32_16x16x32_bf16 v[60:63], a[120:123], v[48:51], v[60:63]
ds_read_b128 v[40:43], v8 offset:38912
v_mfma_f32_16x16x32_bf16 v[64:67], a[124:127], v[48:51], v[64:67]
buffer_load_dwordx4 v6, s[8:11], s50 offen offset:1536 lds
s_waitcnt lgkmcnt(4)
v_mfma_f32_16x16x32_bf16 v[52:55], a[128:131], v[20:23], v[52:55]
ds_read_b128 v[44:47], v9 offset:36864
v_mfma_f32_16x16x32_bf16 v[56:59], a[132:135], v[20:23], v[56:59]
s_add_u32 m0, s46, 117120
v_mfma_f32_16x16x32_bf16 v[60:63], a[128:131], v[24:27], v[60:63]
ds_read_b128 v[48:51], v9 offset:38912
v_mfma_f32_16x16x32_bf16 v[64:67], a[132:135], v[24:27], v[64:67]
buffer_load_dwordx4 v6, s[8:11], s50 offen offset:1664 lds
s_waitcnt lgkmcnt(4)
v_mfma_f32_16x16x32_bf16 v[52:55], a[136:139], v[28:31], v[52:55]
ds_read_b128 v[20:23], v8 offset:40960
v_mfma_f32_16x16x32_bf16 v[56:59], a[140:143], v[28:31], v[56:59]
s_add_u32 m0, s46, 121088
v_mfma_f32_16x16x32_bf16 v[60:63], a[136:139], v[32:35], v[60:63]
ds_read_b128 v[24:27], v8 offset:43008
v_mfma_f32_16x16x32_bf16 v[64:67], a[140:143], v[32:35], v[64:67]
buffer_load_dwordx4 v6, s[8:11], s50 offen offset:1792 lds
s_waitcnt lgkmcnt(4)
v_mfma_f32_16x16x32_bf16 v[52:55], a[144:147], v[36:39], v[52:55]
ds_read_b128 v[28:31], v9 offset:40960
v_mfma_f32_16x16x32_bf16 v[56:59], a[148:151], v[36:39], v[56:59]
s_add_u32 m0, s46, 125056
v_mfma_f32_16x16x32_bf16 v[60:63], a[144:147], v[40:43], v[60:63]
ds_read_b128 v[32:35], v9 offset:43008
v_mfma_f32_16x16x32_bf16 v[64:67], a[148:151], v[40:43], v[64:67]
buffer_load_dwordx4 v6, s[8:11], s50 offen offset:1920 lds
s_waitcnt lgkmcnt(4)
v_mfma_f32_16x16x32_bf16 v[52:55], a[152:155], v[44:47], v[52:55]
ds_read_b128 v[36:39], v8 offset:45056
v_mfma_f32_16x16x32_bf16 v[56:59], a[156:159], v[44:47], v[56:59]
v_mfma_f32_16x16x32_bf16 v[60:63], a[152:155], v[48:51], v[60:63]
ds_read_b128 v[40:43], v8 offset:47104
v_mfma_f32_16x16x32_bf16 v[64:67], a[156:159], v[48:51], v[64:67]
s_waitcnt lgkmcnt(4)
v_mfma_f32_16x16x32_bf16 v[52:55], a[160:163], v[20:23], v[52:55]
ds_read_b128 v[44:47], v9 offset:45056
v_mfma_f32_16x16x32_bf16 v[56:59], a[164:167], v[20:23], v[56:59]
v_mfma_f32_16x16x32_bf16 v[60:63], a[160:163], v[24:27], v[60:63]
ds_read_b128 v[48:51], v9 offset:47104
v_mfma_f32_16x16x32_bf16 v[64:67], a[164:167], v[24:27], v[64:67]
s_waitcnt lgkmcnt(4)
v_mfma_f32_16x16x32_bf16 v[52:55], a[168:171], v[28:31], v[52:55]
ds_read_b128 v[20:23], v8 offset:49152
v_mfma_f32_16x16x32_bf16 v[56:59], a[172:175], v[28:31], v[56:59]
s_waitcnt vmcnt(16)
v_mov_b32 v17, s42
s_mov_b64 exec, 1
buffer_store_dword v17, v16, s[84:87], s49 offen sc1
s_mov_b64 exec, -1
v_mfma_f32_16x16x32_bf16 v[60:63], a[168:171], v[32:35], v[60:63]
ds_read_b128 v[24:27], v8 offset:51200
v_mfma_f32_16x16x32_bf16 v[64:67], a[172:175], v[32:35], v[64:67]
s_waitcnt lgkmcnt(4)
v_mfma_f32_16x16x32_bf16 v[52:55], a[176:179], v[36:39], v[52:55]
ds_read_b128 v[28:31], v9 offset:49152
v_mfma_f32_16x16x32_bf16 v[56:59], a[180:183], v[36:39], v[56:59]
s_add_u32 s53, s42, 3
s_min_u32 s53, s53, 63
s_lshl_b32 s53, s53, 16
s_mov_b64 exec, 0xffff
buffer_load_dword v250, v19, s[8:11], s53 offen
s_mov_b64 exec, -1
v_mfma_f32_16x16x32_bf16 v[60:63], a[176:179], v[40:43], v[60:63]
ds_read_b128 v[32:35], v9 offset:51200
v_mfma_f32_16x16x32_bf16 v[64:67], a[180:183], v[40:43], v[64:67]
s_waitcnt lgkmcnt(4)
v_mfma_f32_16x16x32_bf16 v[52:55], a[184:187], v[44:47], v[52:55]
ds_read_b128 v[36:39], v8 offset:53248
v_mfma_f32_16x16x32_bf16 v[56:59], a[188:191], v[44:47], v[56:59]
v_mfma_f32_16x16x32_bf16 v[60:63], a[184:187], v[48:51], v[60:63]
ds_read_b128 v[40:43], v8 offset:55296
v_mfma_f32_16x16x32_bf16 v[64:67], a[188:191], v[48:51], v[64:67]
s_waitcnt lgkmcnt(4)
v_mfma_f32_16x16x32_bf16 v[52:55], a[192:195], v[20:23], v[52:55]
ds_read_b128 v[44:47], v9 offset:53248
v_mfma_f32_16x16x32_bf16 v[56:59], a[196:199], v[20:23], v[56:59]
v_mfma_f32_16x16x32_bf16 v[60:63], a[192:195], v[24:27], v[60:63]
ds_read_b128 v[48:51], v9 offset:55296
v_mfma_f32_16x16x32_bf16 v[64:67], a[196:199], v[24:27], v[64:67]
s_waitcnt lgkmcnt(4)
v_mfma_f32_16x16x32_bf16 v[52:55], a[200:203], v[28:31], v[52:55]
ds_read_b128 v[20:23], v8 offset:57344
v_mfma_f32_16x16x32_bf16 v[56:59], a[204:207], v[28:31], v[56:59]
v_mfma_f32_16x16x32_bf16 v[60:63], a[200:203], v[32:35], v[60:63]
ds_read_b128 v[24:27], v8 offset:59392
v_mfma_f32_16x16x32_bf16 v[64:67], a[204:207], v[32:35], v[64:67]
s_waitcnt lgkmcnt(4)
v_mfma_f32_16x16x32_bf16 v[52:55], a[208:211], v[36:39], v[52:55]
ds_read_b128 v[28:31], v9 offset:57344
v_mfma_f32_16x16x32_bf16 v[56:59], a[212:215], v[36:39], v[56:59]
v_mfma_f32_16x16x32_bf16 v[60:63], a[208:211], v[40:43], v[60:63]
ds_read_b128 v[32:35], v9 offset:59392
v_mfma_f32_16x16x32_bf16 v[64:67], a[212:215], v[40:43], v[64:67]
s_waitcnt lgkmcnt(4)
v_mfma_f32_16x16x32_bf16 v[52:55], a[216:219], v[44:47], v[52:55]
ds_read_b128 v[36:39], v8 offset:61440
v_mfma_f32_16x16x32_bf16 v[56:59], a[220:223], v[44:47], v[56:59]
v_mfma_f32_16x16x32_bf16 v[60:63], a[216:219], v[48:51], v[60:63]
ds_read_b128 v[40:43], v8 offset:63488
v_mfma_f32_16x16x32_bf16 v[64:67], a[220:223], v[48:51], v[64:67]
s_waitcnt lgkmcnt(4)
v_mfma_f32_16x16x32_bf16 v[52:55], a[224:227], v[20:23], v[52:55]
ds_read_b128 v[44:47], v9 offset:61440
v_mfma_f32_16x16x32_bf16 v[56:59], a[228:231], v[20:23], v[56:59]
v_mfma_f32_16x16x32_bf16 v[60:63], a[224:227], v[24:27], v[60:63]
ds_read_b128 v[48:51], v9 offset:63488
v_mfma_f32_16x16x32_bf16 v[64:67], a[228:231], v[24:27], v[64:67]
s_waitcnt lgkmcnt(5)
v_mfma_f32_16x16x32_bf16 v[52:55], a[232:235], v[28:31], v[52:55]
v_mfma_f32_16x16x32_bf16 v[56:59], a[236:239], v[28:31], v[56:59]
s_waitcnt lgkmcnt(4)
v_mfma_f32_16x16x32_bf16 v[60:63], a[232:235], v[32:35], v[60:63]
v_mfma_f32_16x16x32_bf16 v[64:67], a[236:239], v[32:35], v[64:67]
s_waitcnt lgkmcnt(3)
v_mfma_f32_16x16x32_bf16 v[52:55], a[240:243], v[36:39], v[52:55]
v_mfma_f32_16x16x32_bf16 v[56:59], a[244:247], v[36:39], v[56:59]
s_waitcnt lgkmcnt(2)
v_mfma_f32_16x16x32_bf16 v[60:63], a[240:243], v[40:43], v[60:63]
v_mfma_f32_16x16x32_bf16 v[64:67], a[244:247], v[40:43], v[64:67]
s_waitcnt lgkmcnt(1)
v_mfma_f32_16x16x32_bf16 v[52:55], a[248:251], v[44:47], v[52:55]
v_mfma_f32_16x16x32_bf16 v[56:59], a[252:255], v[44:47], v[56:59]
s_waitcnt lgkmcnt(0)
v_mfma_f32_16x16x32_bf16 v[60:63], a[248:251], v[48:51], v[60:63]
v_mfma_f32_16x16x32_bf16 v[64:67], a[252:255], v[48:51], v[64:67]
s_add_u32 s42, s42, 1
s_branch mega_kernel_k_loop
mega_kernel_k_fin:
s_nop 11
v_cvt_pk_bf16_f32 v84, v68, v69
v_cvt_pk_bf16_f32 v85, v70, v71
v_cvt_pk_bf16_f32 v86, v72, v73
v_cvt_pk_bf16_f32 v87, v74, v75
v_cvt_pk_bf16_f32 v88, v76, v77
v_cvt_pk_bf16_f32 v89, v78, v79
v_cvt_pk_bf16_f32 v90, v80, v81
v_cvt_pk_bf16_f32 v91, v82, v83
s_add_u32 s51, s42, s47
s_sub_u32 s51, s51, 1
s_bfe_u32 s52, s51, 0x40002
s_lshl_b32 s52, s52, 14
s_and_b32 s51, s51, 3
s_lshl_b32 s51, s51, 11
s_add_u32 s51, s51, s52
s_add_u32 s51, s51, s48
buffer_store_dwordx4 v[84:87], v7, s[84:87], s51 offen sc1
buffer_store_dwordx4 v[88:91], v7, s[84:87], s51 offen offset:1024 sc1
s_waitcnt vmcnt(0)
v_mov_b32 v17, s42
s_mov_b64 exec, 1
buffer_store_dword v17, v16, s[84:87], s49 offen sc1
s_mov_b64 exec, -1
s_waitcnt vmcnt(0)
s_barrier
s_branch mega_kernel_fft
mega_kernel_rv:
s_load_dwordx2 s[4:5], s[0:1], 32
s_load_dwordx2 s[8:9], s[0:1], 0
v_lshrrev_b32 v2, 6, v0
v_and_b32 v1, 63, v0
v_readfirstlane_b32 s41, v2
v_lshlrev_b32 v5, 4, v1
s_waitcnt lgkmcnt(0)
s_mov_b32 s6, 8388608
s_mov_b32 s7, 0x00020000
s_mov_b32 s10, 4194304
s_mov_b32 s11, 0x00020000
s_lshl_b32 s43, s40, 8
s_lshl_b32 s44, s41, 6
s_add_u32 s48, s43, s44
s_and_b32 s43, s48, 0x7ff
v_add_u32 v19, s43, v1
v_lshlrev_b32 v19, 7, v19
s_mov_b32 s43, 0
buffer_load_dword v250, v19, s[8:11], s43 offen
s_nop 0
v_lshrrev_b32 v2, 3, v1
s_lshl_b32 s43, s41, 3
v_add_u32 v2, s43, v2
v_bfe_u32 v3, v2, 1, 3
v_and_b32 v4, 7, v1
v_xor_b32 v3, v3, v4
v_lshlrev_b32 v6, 11, v2
v_lshl_add_u32 v6, v3, 4, v6
s_lshl_b32 s46, s41, 10
v_and_b32 v2, 15, v1
v_bfe_u32 v3, v2, 1, 3
v_lshrrev_b32 v4, 4, v1
v_xor_b32 v3, v3, v4
v_lshlrev_b32 v8, 7, v2
v_lshl_add_u32 v8, v3, 4, v8
v_xor_b32 v9, 64, v8
v_add_u32 v10, 0x10000, v8
v_add_u32 v11, 0x10000, v9
v_mov_b32 v7, v5
s_lshl_b32 s47, s40, 2
s_add_u32 s47, s47, s41
s_mov_b32 s42, 0
s_mov_b32 s50, 0
s_add_u32 m0, s46, 0
s_nop 0
buffer_load_dwordx4 v6, s[8:11], s50 offen offset:0 lds
s_add_u32 m0, s46, 3968
s_nop 0
buffer_load_dwordx4 v6, s[8:11], s50 offen offset:128 lds
s_add_u32 m0, s46, 7936
s_nop 0
buffer_load_dwordx4 v6, s[8:11], s50 offen offset:256 lds
s_add_u32 m0, s46, 11904
s_nop 0
buffer_load_dwordx4 v6, s[8:11], s50 offen offset:384 lds
s_add_u32 m0, s46, 15872
s_nop 0
buffer_load_dwordx4 v6, s[8:11], s50 offen offset:512 lds
s_add_u32 m0, s46, 19840
s_nop 0
buffer_load_dwordx4 v6, s[8:11], s50 offen offset:640 lds
s_add_u32 m0, s46, 23808
s_nop 0
buffer_load_dwordx4 v6, s[8:11], s50 offen offset:768 lds
s_add_u32 m0, s46, 27776
s_nop 0
buffer_load_dwordx4 v6, s[8:11], s50 offen offset:896 lds
s_add_u32 m0, s46, 31744
s_nop 0
buffer_load_dwordx4 v6, s[8:11], s50 offen offset:1024 lds
s_add_u32 m0, s46, 35712
s_nop 0
buffer_load_dwordx4 v6, s[8:11], s50 offen offset:1152 lds
s_add_u32 m0, s46, 39680
s_nop 0
buffer_load_dwordx4 v6, s[8:11], s50 offen offset:1280 lds
s_add_u32 m0, s46, 43648
s_nop 0
buffer_load_dwordx4 v6, s[8:11], s50 offen offset:1408 lds
s_add_u32 m0, s46, 47616
s_nop 0
buffer_load_dwordx4 v6, s[8:11], s50 offen offset:1536 lds
s_add_u32 m0, s46, 51584
s_nop 0
buffer_load_dwordx4 v6, s[8:11], s50 offen offset:1664 lds
s_add_u32 m0, s46, 55552
s_nop 0
buffer_load_dwordx4 v6, s[8:11], s50 offen offset:1792 lds
s_add_u32 m0, s46, 59520
s_nop 0
buffer_load_dwordx4 v6, s[8:11], s50 offen offset:1920 lds
v_lshrrev_b32 v2, 2, v1
v_and_b32 v3, 3, v1
v_lshlrev_b32 v16, 13, v2
v_lshl_add_u32 v16, v3, 4, v16
v_add_u32 v16, s48, v16
s_mul_i32 s45, s41, 24576
s_add_u32 s45, s45, 65536
v_bfe_u32 v17, v1, 2, 2
v_lshrrev_b32 v18, 4, v1
v_lshl_add_u32 v17, v18, 3, v17
v_lshlrev_b32 v17, 6, v17
v_lshl_add_u32 v17, v3, 3, v17
v_add_u32 v17, s45, v17
s_and_b32 s43, s40, 3
s_lshl_b32 s43, s43, 2
s_add_u32 s43, s43, s41
s_lshl_b32 s43, s43, 3
v_and_b32 v12, 7, v1
v_add_u32 v12, s43, v12
s_lshr_b32 s43, s40, 2
s_lshl_b32 s43, s43, 10
s_add_u32 s44, s43, 896
s_add_u32 s43, s43, 384
s_cmp_ge_u32 s40, 28
s_cselect_b32 s44, s44, s43
v_mov_b32 v13, s43
v_mov_b32 v14, s44
v_cmp_gt_u32 vcc, 32, v1
s_nop 1
v_cndmask_b32 v13, v14, v13, vcc
v_lshl_add_u32 v12, v12, 13, v13
s_mov_b32 s44, 0
buffer_load_dword v250, v12, s[4:7], s44 offen
s_add_u32 m0, s45, 0
s_mov_b32 s44, 0
buffer_load_dwordx4 v16, s[4:7], s44 offen lds
s_add_u32 m0, s45, 1024
s_mov_b32 s44, 131072
buffer_load_dwordx4 v16, s[4:7], s44 offen lds
s_add_u32 m0, s45, 2048
s_mov_b32 s44, 262144
buffer_load_dwordx4 v16, s[4:7], s44 offen lds
s_add_u32 m0, s45, 3072
s_mov_b32 s44, 393216
buffer_load_dwordx4 v16, s[4:7], s44 offen lds
s_add_u32 m0, s45, 4096
s_mov_b32 s44, 524288
buffer_load_dwordx4 v16, s[4:7], s44 offen lds
s_add_u32 m0, s45, 5120
s_mov_b32 s44, 655360
buffer_load_dwordx4 v16, s[4:7], s44 offen lds
s_add_u32 m0, s45, 6144
s_mov_b32 s44, 786432
buffer_load_dwordx4 v16, s[4:7], s44 offen lds
s_add_u32 m0, s45, 7168
s_mov_b32 s44, 917504
buffer_load_dwordx4 v16, s[4:7], s44 offen lds
s_mov_b32 s44, 1048576
buffer_load_dword v250, v12, s[4:7], s44 offen
s_add_u32 m0, s45, 8192
s_mov_b32 s44, 1048576
buffer_load_dwordx4 v16, s[4:7], s44 offen lds
s_add_u32 m0, s45, 9216
s_mov_b32 s44, 1179648
buffer_load_dwordx4 v16, s[4:7], s44 offen lds
s_add_u32 m0, s45, 10240
s_mov_b32 s44, 1310720
buffer_load_dwordx4 v16, s[4:7], s44 offen lds
s_add_u32 m0, s45, 11264
s_mov_b32 s44, 1441792
buffer_load_dwordx4 v16, s[4:7], s44 offen lds
s_add_u32 m0, s45, 12288
s_mov_b32 s44, 1572864
buffer_load_dwordx4 v16, s[4:7], s44 offen lds
s_add_u32 m0, s45, 13312
s_mov_b32 s44, 1703936
buffer_load_dwordx4 v16, s[4:7], s44 offen lds
s_add_u32 m0, s45, 14336
s_mov_b32 s44, 1835008
buffer_load_dwordx4 v16, s[4:7], s44 offen lds
s_add_u32 m0, s45, 15360
s_mov_b32 s44, 1966080
buffer_load_dwordx4 v16, s[4:7], s44 offen lds
s_mov_b32 s44, 2097152
buffer_load_dword v250, v12, s[4:7], s44 offen
s_add_u32 m0, s45, 16384
s_mov_b32 s44, 2097152
buffer_load_dwordx4 v16, s[4:7], s44 offen lds
s_add_u32 m0, s45, 17408
s_mov_b32 s44, 2228224
buffer_load_dwordx4 v16, s[4:7], s44 offen lds
s_add_u32 m0, s45, 18432
s_mov_b32 s44, 2359296
buffer_load_dwordx4 v16, s[4:7], s44 offen lds
s_add_u32 m0, s45, 19456
s_mov_b32 s44, 2490368
buffer_load_dwordx4 v16, s[4:7], s44 offen lds
s_add_u32 m0, s45, 20480
s_mov_b32 s44, 2621440
buffer_load_dwordx4 v16, s[4:7], s44 offen lds
s_add_u32 m0, s45, 21504
s_mov_b32 s44, 2752512
buffer_load_dwordx4 v16, s[4:7], s44 offen lds
s_add_u32 m0, s45, 22528
s_mov_b32 s44, 2883584
buffer_load_dwordx4 v16, s[4:7], s44 offen lds
s_add_u32 m0, s45, 23552
s_mov_b32 s44, 3014656
buffer_load_dwordx4 v16, s[4:7], s44 offen lds
s_waitcnt vmcnt(18)
s_barrier
ds_read_b64_tr_b16 a[0:1], v17 offset:0
ds_read_b64_tr_b16 a[2:3], v17 offset:256
ds_read_b64_tr_b16 a[4:5], v17 offset:32
ds_read_b64_tr_b16 a[6:7], v17 offset:288
ds_read_b64_tr_b16 a[8:9], v17 offset:2048
ds_read_b64_tr_b16 a[10:11], v17 offset:2304
ds_read_b64_tr_b16 a[12:13], v17 offset:2080
ds_read_b64_tr_b16 a[14:15], v17 offset:2336
s_waitcnt lgkmcnt(0)
ds_read_b64_tr_b16 a[16:17], v17 offset:4096
ds_read_b64_tr_b16 a[18:19], v17 offset:4352
ds_read_b64_tr_b16 a[20:21], v17 offset:4128
ds_read_b64_tr_b16 a[22:23], v17 offset:4384
ds_read_b64_tr_b16 a[24:25], v17 offset:6144
ds_read_b64_tr_b16 a[26:27], v17 offset:6400
ds_read_b64_tr_b16 a[28:29], v17 offset:6176
ds_read_b64_tr_b16 a[30:31], v17 offset:6432
s_waitcnt lgkmcnt(0)
s_mov_b32 s44, 3145728
buffer_load_dword v250, v12, s[4:7], s44 offen
s_add_u32 m0, s45, 0
s_mov_b32 s44, 3145728
buffer_load_dwordx4 v16, s[4:7], s44 offen lds
s_add_u32 m0, s45, 1024
s_mov_b32 s44, 3276800
buffer_load_dwordx4 v16, s[4:7], s44 offen lds
s_add_u32 m0, s45, 2048
s_mov_b32 s44, 3407872
buffer_load_dwordx4 v16, s[4:7], s44 offen lds
s_add_u32 m0, s45, 3072
s_mov_b32 s44, 3538944
buffer_load_dwordx4 v16, s[4:7], s44 offen lds
s_add_u32 m0, s45, 4096
s_mov_b32 s44, 3670016
buffer_load_dwordx4 v16, s[4:7], s44 offen lds
s_add_u32 m0, s45, 5120
s_mov_b32 s44, 3801088
buffer_load_dwordx4 v16, s[4:7], s44 offen lds
s_add_u32 m0, s45, 6144
s_mov_b32 s44, 3932160
buffer_load_dwordx4 v16, s[4:7], s44 offen lds
s_add_u32 m0, s45, 7168
s_mov_b32 s44, 4063232
buffer_load_dwordx4 v16, s[4:7], s44 offen lds
ds_read_b128 v[20:23], v8 offset:0
ds_read_b128 v[24:27], v8 offset:2048
ds_read_b128 v[28:31], v9 offset:0
ds_read_b128 v[32:35], v9 offset:2048
ds_read_b128 v[36:39], v8 offset:4096
ds_read_b128 v[40:43], v8 offset:6144
ds_read_b128 v[44:47], v9 offset:4096
ds_read_b128 v[48:51], v9 offset:6144
s_waitcnt lgkmcnt(0)
v_mfma_f32_16x16x32_bf16 v[52:55], v[20:23], a[0:3], 0
v_mfma_f32_16x16x32_bf16 v[56:59], v[20:23], a[4:7], 0
v_mfma_f32_16x16x32_bf16 v[60:63], v[24:27], a[0:3], 0
v_mfma_f32_16x16x32_bf16 v[64:67], v[24:27], a[4:7], 0
v_mfma_f32_16x16x32_bf16 v[52:55], v[28:31], a[8:11], v[52:55]
v_mfma_f32_16x16x32_bf16 v[56:59], v[28:31], a[12:15], v[56:59]
v_mfma_f32_16x16x32_bf16 v[60:63], v[32:35], a[8:11], v[60:63]
v_mfma_f32_16x16x32_bf16 v[64:67], v[32:35], a[12:15], v[64:67]
v_mfma_f32_16x16x32_bf16 v[52:55], v[36:39], a[16:19], v[52:55]
v_mfma_f32_16x16x32_bf16 v[56:59], v[36:39], a[20:23], v[56:59]
v_mfma_f32_16x16x32_bf16 v[60:63], v[40:43], a[16:19], v[60:63]
v_mfma_f32_16x16x32_bf16 v[64:67], v[40:43], a[20:23], v[64:67]
v_mfma_f32_16x16x32_bf16 v[52:55], v[44:47], a[24:27], v[52:55]
v_mfma_f32_16x16x32_bf16 v[56:59], v[44:47], a[28:31], v[56:59]
v_mfma_f32_16x16x32_bf16 v[60:63], v[48:51], a[24:27], v[60:63]
v_mfma_f32_16x16x32_bf16 v[64:67], v[48:51], a[28:31], v[64:67]
s_waitcnt vmcnt(18)
ds_read_b64_tr_b16 a[32:33], v17 offset:8192
ds_read_b64_tr_b16 a[34:35], v17 offset:8448
ds_read_b64_tr_b16 a[36:37], v17 offset:8224
ds_read_b64_tr_b16 a[38:39], v17 offset:8480
ds_read_b64_tr_b16 a[40:41], v17 offset:10240
ds_read_b64_tr_b16 a[42:43], v17 offset:10496
ds_read_b64_tr_b16 a[44:45], v17 offset:10272
ds_read_b64_tr_b16 a[46:47], v17 offset:10528
s_waitcnt lgkmcnt(0)
ds_read_b64_tr_b16 a[48:49], v17 offset:12288
ds_read_b64_tr_b16 a[50:51], v17 offset:12544
ds_read_b64_tr_b16 a[52:53], v17 offset:12320
ds_read_b64_tr_b16 a[54:55], v17 offset:12576
ds_read_b64_tr_b16 a[56:57], v17 offset:14336
ds_read_b64_tr_b16 a[58:59], v17 offset:14592
ds_read_b64_tr_b16 a[60:61], v17 offset:14368
ds_read_b64_tr_b16 a[62:63], v17 offset:14624
s_waitcnt lgkmcnt(0)
s_mov_b32 s44, 4194304
buffer_load_dword v250, v12, s[4:7], s44 offen
s_add_u32 m0, s45, 8192
s_mov_b32 s44, 4194304
buffer_load_dwordx4 v16, s[4:7], s44 offen lds
s_add_u32 m0, s45, 9216
s_mov_b32 s44, 4325376
buffer_load_dwordx4 v16, s[4:7], s44 offen lds
s_add_u32 m0, s45, 10240
s_mov_b32 s44, 4456448
buffer_load_dwordx4 v16, s[4:7], s44 offen lds
s_add_u32 m0, s45, 11264
s_mov_b32 s44, 4587520
buffer_load_dwordx4 v16, s[4:7], s44 offen lds
s_add_u32 m0, s45, 12288
s_mov_b32 s44, 4718592
buffer_load_dwordx4 v16, s[4:7], s44 offen lds
s_add_u32 m0, s45, 13312
s_mov_b32 s44, 4849664
buffer_load_dwordx4 v16, s[4:7], s44 offen lds
s_add_u32 m0, s45, 14336
s_mov_b32 s44, 4980736
buffer_load_dwordx4 v16, s[4:7], s44 offen lds
s_add_u32 m0, s45, 15360
s_mov_b32 s44, 5111808
buffer_load_dwordx4 v16, s[4:7], s44 offen lds
ds_read_b128 v[20:23], v8 offset:8192
ds_read_b128 v[24:27], v8 offset:10240
ds_read_b128 v[28:31], v9 offset:8192
ds_read_b128 v[32:35], v9 offset:10240
ds_read_b128 v[36:39], v8 offset:12288
ds_read_b128 v[40:43], v8 offset:14336
ds_read_b128 v[44:47], v9 offset:12288
ds_read_b128 v[48:51], v9 offset:14336
s_waitcnt lgkmcnt(0)
v_mfma_f32_16x16x32_bf16 v[52:55], v[20:23], a[32:35], v[52:55]
v_mfma_f32_16x16x32_bf16 v[56:59], v[20:23], a[36:39], v[56:59]
v_mfma_f32_16x16x32_bf16 v[60:63], v[24:27], a[32:35], v[60:63]
v_mfma_f32_16x16x32_bf16 v[64:67], v[24:27], a[36:39], v[64:67]
v_mfma_f32_16x16x32_bf16 v[52:55], v[28:31], a[40:43], v[52:55]
v_mfma_f32_16x16x32_bf16 v[56:59], v[28:31], a[44:47], v[56:59]
v_mfma_f32_16x16x32_bf16 v[60:63], v[32:35], a[40:43], v[60:63]
v_mfma_f32_16x16x32_bf16 v[64:67], v[32:35], a[44:47], v[64:67]
v_mfma_f32_16x16x32_bf16 v[52:55], v[36:39], a[48:51], v[52:55]
v_mfma_f32_16x16x32_bf16 v[56:59], v[36:39], a[52:55], v[56:59]
v_mfma_f32_16x16x32_bf16 v[60:63], v[40:43], a[48:51], v[60:63]
v_mfma_f32_16x16x32_bf16 v[64:67], v[40:43], a[52:55], v[64:67]
v_mfma_f32_16x16x32_bf16 v[52:55], v[44:47], a[56:59], v[52:55]
v_mfma_f32_16x16x32_bf16 v[56:59], v[44:47], a[60:63], v[56:59]
v_mfma_f32_16x16x32_bf16 v[60:63], v[48:51], a[56:59], v[60:63]
v_mfma_f32_16x16x32_bf16 v[64:67], v[48:51], a[60:63], v[64:67]
s_waitcnt vmcnt(18)
ds_read_b64_tr_b16 a[64:65], v17 offset:16384
ds_read_b64_tr_b16 a[66:67], v17 offset:16640
ds_read_b64_tr_b16 a[68:69], v17 offset:16416
ds_read_b64_tr_b16 a[70:71], v17 offset:16672
ds_read_b64_tr_b16 a[72:73], v17 offset:18432
ds_read_b64_tr_b16 a[74:75], v17 offset:18688
ds_read_b64_tr_b16 a[76:77], v17 offset:18464
ds_read_b64_tr_b16 a[78:79], v17 offset:18720
s_waitcnt lgkmcnt(0)
ds_read_b64_tr_b16 a[80:81], v17 offset:20480
ds_read_b64_tr_b16 a[82:83], v17 offset:20736
ds_read_b64_tr_b16 a[84:85], v17 offset:20512
ds_read_b64_tr_b16 a[86:87], v17 offset:20768
ds_read_b64_tr_b16 a[88:89], v17 offset:22528
ds_read_b64_tr_b16 a[90:91], v17 offset:22784
ds_read_b64_tr_b16 a[92:93], v17 offset:22560
ds_read_b64_tr_b16 a[94:95], v17 offset:22816
s_waitcnt lgkmcnt(0)
s_mov_b32 s44, 5242880
buffer_load_dword v250, v12, s[4:7], s44 offen
s_add_u32 m0, s45, 16384
s_mov_b32 s44, 5242880
buffer_load_dwordx4 v16, s[4:7], s44 offen lds
s_add_u32 m0, s45, 17408
s_mov_b32 s44, 5373952
buffer_load_dwordx4 v16, s[4:7], s44 offen lds
s_add_u32 m0, s45, 18432
s_mov_b32 s44, 5505024
buffer_load_dwordx4 v16, s[4:7], s44 offen lds
s_add_u32 m0, s45, 19456
s_mov_b32 s44, 5636096
buffer_load_dwordx4 v16, s[4:7], s44 offen lds
s_add_u32 m0, s45, 20480
s_mov_b32 s44, 5767168
buffer_load_dwordx4 v16, s[4:7], s44 offen lds
s_add_u32 m0, s45, 21504
s_mov_b32 s44, 5898240
buffer_load_dwordx4 v16, s[4:7], s44 offen lds
s_add_u32 m0, s45, 22528
s_mov_b32 s44, 6029312
buffer_load_dwordx4 v16, s[4:7], s44 offen lds
s_add_u32 m0, s45, 23552
s_mov_b32 s44, 6160384
buffer_load_dwordx4 v16, s[4:7], s44 offen lds
ds_read_b128 v[20:23], v8 offset:16384
ds_read_b128 v[24:27], v8 offset:18432
ds_read_b128 v[28:31], v9 offset:16384
ds_read_b128 v[32:35], v9 offset:18432
ds_read_b128 v[36:39], v8 offset:20480
ds_read_b128 v[40:43], v8 offset:22528
ds_read_b128 v[44:47], v9 offset:20480
ds_read_b128 v[48:51], v9 offset:22528
s_waitcnt lgkmcnt(0)
v_mfma_f32_16x16x32_bf16 v[52:55], v[20:23], a[64:67], v[52:55]
v_mfma_f32_16x16x32_bf16 v[56:59], v[20:23], a[68:71], v[56:59]
v_mfma_f32_16x16x32_bf16 v[60:63], v[24:27], a[64:67], v[60:63]
v_mfma_f32_16x16x32_bf16 v[64:67], v[24:27], a[68:71], v[64:67]
v_mfma_f32_16x16x32_bf16 v[52:55], v[28:31], a[72:75], v[52:55]
v_mfma_f32_16x16x32_bf16 v[56:59], v[28:31], a[76:79], v[56:59]
v_mfma_f32_16x16x32_bf16 v[60:63], v[32:35], a[72:75], v[60:63]
v_mfma_f32_16x16x32_bf16 v[64:67], v[32:35], a[76:79], v[64:67]
v_mfma_f32_16x16x32_bf16 v[52:55], v[36:39], a[80:83], v[52:55]
v_mfma_f32_16x16x32_bf16 v[56:59], v[36:39], a[84:87], v[56:59]
v_mfma_f32_16x16x32_bf16 v[60:63], v[40:43], a[80:83], v[60:63]
v_mfma_f32_16x16x32_bf16 v[64:67], v[40:43], a[84:87], v[64:67]
v_mfma_f32_16x16x32_bf16 v[52:55], v[44:47], a[88:91], v[52:55]
v_mfma_f32_16x16x32_bf16 v[56:59], v[44:47], a[92:95], v[56:59]
v_mfma_f32_16x16x32_bf16 v[60:63], v[48:51], a[88:91], v[60:63]
v_mfma_f32_16x16x32_bf16 v[64:67], v[48:51], a[92:95], v[64:67]
s_waitcnt vmcnt(18)
ds_read_b64_tr_b16 a[96:97], v17 offset:0
ds_read_b64_tr_b16 a[98:99], v17 offset:256
ds_read_b64_tr_b16 a[100:101], v17 offset:32
ds_read_b64_tr_b16 a[102:103], v17 offset:288
ds_read_b64_tr_b16 a[104:105], v17 offset:2048
ds_read_b64_tr_b16 a[106:107], v17 offset:2304
ds_read_b64_tr_b16 a[108:109], v17 offset:2080
ds_read_b64_tr_b16 a[110:111], v17 offset:2336
s_waitcnt lgkmcnt(0)
ds_read_b64_tr_b16 a[112:113], v17 offset:4096
ds_read_b64_tr_b16 a[114:115], v17 offset:4352
ds_read_b64_tr_b16 a[116:117], v17 offset:4128
ds_read_b64_tr_b16 a[118:119], v17 offset:4384
ds_read_b64_tr_b16 a[120:121], v17 offset:6144
ds_read_b64_tr_b16 a[122:123], v17 offset:6400
ds_read_b64_tr_b16 a[124:125], v17 offset:6176
ds_read_b64_tr_b16 a[126:127], v17 offset:6432
s_waitcnt lgkmcnt(0)
s_mov_b32 s44, 6291456
buffer_load_dword v250, v12, s[4:7], s44 offen
s_add_u32 m0, s45, 0
s_mov_b32 s44, 6291456
buffer_load_dwordx4 v16, s[4:7], s44 offen lds
s_add_u32 m0, s45, 1024
s_mov_b32 s44, 6422528
buffer_load_dwordx4 v16, s[4:7], s44 offen lds
s_add_u32 m0, s45, 2048
s_mov_b32 s44, 6553600
buffer_load_dwordx4 v16, s[4:7], s44 offen lds
s_add_u32 m0, s45, 3072
s_mov_b32 s44, 6684672
buffer_load_dwordx4 v16, s[4:7], s44 offen lds
s_add_u32 m0, s45, 4096
s_mov_b32 s44, 6815744
buffer_load_dwordx4 v16, s[4:7], s44 offen lds
s_add_u32 m0, s45, 5120
s_mov_b32 s44, 6946816
buffer_load_dwordx4 v16, s[4:7], s44 offen lds
s_add_u32 m0, s45, 6144
s_mov_b32 s44, 7077888
buffer_load_dwordx4 v16, s[4:7], s44 offen lds
s_add_u32 m0, s45, 7168
s_mov_b32 s44, 7208960
buffer_load_dwordx4 v16, s[4:7], s44 offen lds
ds_read_b128 v[20:23], v8 offset:24576
ds_read_b128 v[24:27], v8 offset:26624
ds_read_b128 v[28:31], v9 offset:24576
ds_read_b128 v[32:35], v9 offset:26624
ds_read_b128 v[36:39], v8 offset:28672
ds_read_b128 v[40:43], v8 offset:30720
ds_read_b128 v[44:47], v9 offset:28672
ds_read_b128 v[48:51], v9 offset:30720
s_waitcnt lgkmcnt(0)
v_mfma_f32_16x16x32_bf16 v[52:55], v[20:23], a[96:99], v[52:55]
v_mfma_f32_16x16x32_bf16 v[56:59], v[20:23], a[100:103], v[56:59]
v_mfma_f32_16x16x32_bf16 v[60:63], v[24:27], a[96:99], v[60:63]
v_mfma_f32_16x16x32_bf16 v[64:67], v[24:27], a[100:103], v[64:67]
v_mfma_f32_16x16x32_bf16 v[52:55], v[28:31], a[104:107], v[52:55]
v_mfma_f32_16x16x32_bf16 v[56:59], v[28:31], a[108:111], v[56:59]
v_mfma_f32_16x16x32_bf16 v[60:63], v[32:35], a[104:107], v[60:63]
v_mfma_f32_16x16x32_bf16 v[64:67], v[32:35], a[108:111], v[64:67]
v_mfma_f32_16x16x32_bf16 v[52:55], v[36:39], a[112:115], v[52:55]
v_mfma_f32_16x16x32_bf16 v[56:59], v[36:39], a[116:119], v[56:59]
v_mfma_f32_16x16x32_bf16 v[60:63], v[40:43], a[112:115], v[60:63]
v_mfma_f32_16x16x32_bf16 v[64:67], v[40:43], a[116:119], v[64:67]
v_mfma_f32_16x16x32_bf16 v[52:55], v[44:47], a[120:123], v[52:55]
v_mfma_f32_16x16x32_bf16 v[56:59], v[44:47], a[124:127], v[56:59]
v_mfma_f32_16x16x32_bf16 v[60:63], v[48:51], a[120:123], v[60:63]
v_mfma_f32_16x16x32_bf16 v[64:67], v[48:51], a[124:127], v[64:67]
s_waitcnt vmcnt(18)
ds_read_b64_tr_b16 a[128:129], v17 offset:8192
ds_read_b64_tr_b16 a[130:131], v17 offset:8448
ds_read_b64_tr_b16 a[132:133], v17 offset:8224
ds_read_b64_tr_b16 a[134:135], v17 offset:8480
ds_read_b64_tr_b16 a[136:137], v17 offset:10240
ds_read_b64_tr_b16 a[138:139], v17 offset:10496
ds_read_b64_tr_b16 a[140:141], v17 offset:10272
ds_read_b64_tr_b16 a[142:143], v17 offset:10528
s_waitcnt lgkmcnt(0)
ds_read_b64_tr_b16 a[144:145], v17 offset:12288
ds_read_b64_tr_b16 a[146:147], v17 offset:12544
ds_read_b64_tr_b16 a[148:149], v17 offset:12320
ds_read_b64_tr_b16 a[150:151], v17 offset:12576
ds_read_b64_tr_b16 a[152:153], v17 offset:14336
ds_read_b64_tr_b16 a[154:155], v17 offset:14592
ds_read_b64_tr_b16 a[156:157], v17 offset:14368
ds_read_b64_tr_b16 a[158:159], v17 offset:14624
s_waitcnt lgkmcnt(0)
s_mov_b32 s44, 7340032
buffer_load_dword v250, v12, s[4:7], s44 offen
s_add_u32 m0, s45, 8192
s_mov_b32 s44, 7340032
buffer_load_dwordx4 v16, s[4:7], s44 offen lds
s_add_u32 m0, s45, 9216
s_mov_b32 s44, 7471104
buffer_load_dwordx4 v16, s[4:7], s44 offen lds
s_add_u32 m0, s45, 10240
s_mov_b32 s44, 7602176
buffer_load_dwordx4 v16, s[4:7], s44 offen lds
s_add_u32 m0, s45, 11264
s_mov_b32 s44, 7733248
buffer_load_dwordx4 v16, s[4:7], s44 offen lds
s_add_u32 m0, s45, 12288
s_mov_b32 s44, 7864320
buffer_load_dwordx4 v16, s[4:7], s44 offen lds
s_add_u32 m0, s45, 13312
s_mov_b32 s44, 7995392
buffer_load_dwordx4 v16, s[4:7], s44 offen lds
s_add_u32 m0, s45, 14336
s_mov_b32 s44, 8126464
buffer_load_dwordx4 v16, s[4:7], s44 offen lds
s_add_u32 m0, s45, 15360
s_mov_b32 s44, 8257536
buffer_load_dwordx4 v16, s[4:7], s44 offen lds
ds_read_b128 v[20:23], v8 offset:32768
ds_read_b128 v[24:27], v8 offset:34816
ds_read_b128 v[28:31], v9 offset:32768
ds_read_b128 v[32:35], v9 offset:34816
ds_read_b128 v[36:39], v8 offset:36864
ds_read_b128 v[40:43], v8 offset:38912
ds_read_b128 v[44:47], v9 offset:36864
ds_read_b128 v[48:51], v9 offset:38912
s_waitcnt lgkmcnt(0)
v_mfma_f32_16x16x32_bf16 v[52:55], v[20:23], a[128:131], v[52:55]
v_mfma_f32_16x16x32_bf16 v[56:59], v[20:23], a[132:135], v[56:59]
v_mfma_f32_16x16x32_bf16 v[60:63], v[24:27], a[128:131], v[60:63]
v_mfma_f32_16x16x32_bf16 v[64:67], v[24:27], a[132:135], v[64:67]
v_mfma_f32_16x16x32_bf16 v[52:55], v[28:31], a[136:139], v[52:55]
v_mfma_f32_16x16x32_bf16 v[56:59], v[28:31], a[140:143], v[56:59]
v_mfma_f32_16x16x32_bf16 v[60:63], v[32:35], a[136:139], v[60:63]
v_mfma_f32_16x16x32_bf16 v[64:67], v[32:35], a[140:143], v[64:67]
v_mfma_f32_16x16x32_bf16 v[52:55], v[36:39], a[144:147], v[52:55]
v_mfma_f32_16x16x32_bf16 v[56:59], v[36:39], a[148:151], v[56:59]
v_mfma_f32_16x16x32_bf16 v[60:63], v[40:43], a[144:147], v[60:63]
v_mfma_f32_16x16x32_bf16 v[64:67], v[40:43], a[148:151], v[64:67]
v_mfma_f32_16x16x32_bf16 v[52:55], v[44:47], a[152:155], v[52:55]
v_mfma_f32_16x16x32_bf16 v[56:59], v[44:47], a[156:159], v[56:59]
v_mfma_f32_16x16x32_bf16 v[60:63], v[48:51], a[152:155], v[60:63]
v_mfma_f32_16x16x32_bf16 v[64:67], v[48:51], a[156:159], v[64:67]
s_waitcnt vmcnt(18)
ds_read_b64_tr_b16 a[160:161], v17 offset:16384
ds_read_b64_tr_b16 a[162:163], v17 offset:16640
ds_read_b64_tr_b16 a[164:165], v17 offset:16416
ds_read_b64_tr_b16 a[166:167], v17 offset:16672
ds_read_b64_tr_b16 a[168:169], v17 offset:18432
ds_read_b64_tr_b16 a[170:171], v17 offset:18688
ds_read_b64_tr_b16 a[172:173], v17 offset:18464
ds_read_b64_tr_b16 a[174:175], v17 offset:18720
s_waitcnt lgkmcnt(0)
ds_read_b64_tr_b16 a[176:177], v17 offset:20480
ds_read_b64_tr_b16 a[178:179], v17 offset:20736
ds_read_b64_tr_b16 a[180:181], v17 offset:20512
ds_read_b64_tr_b16 a[182:183], v17 offset:20768
ds_read_b64_tr_b16 a[184:185], v17 offset:22528
ds_read_b64_tr_b16 a[186:187], v17 offset:22784
ds_read_b64_tr_b16 a[188:189], v17 offset:22560
ds_read_b64_tr_b16 a[190:191], v17 offset:22816
s_waitcnt lgkmcnt(0)
ds_read_b128 v[20:23], v8 offset:40960
ds_read_b128 v[24:27], v8 offset:43008
ds_read_b128 v[28:31], v9 offset:40960
ds_read_b128 v[32:35], v9 offset:43008
ds_read_b128 v[36:39], v8 offset:45056
ds_read_b128 v[40:43], v8 offset:47104
ds_read_b128 v[44:47], v9 offset:45056
ds_read_b128 v[48:51], v9 offset:47104
s_waitcnt lgkmcnt(0)
v_mfma_f32_16x16x32_bf16 v[52:55], v[20:23], a[160:163], v[52:55]
v_mfma_f32_16x16x32_bf16 v[56:59], v[20:23], a[164:167], v[56:59]
v_mfma_f32_16x16x32_bf16 v[60:63], v[24:27], a[160:163], v[60:63]
v_mfma_f32_16x16x32_bf16 v[64:67], v[24:27], a[164:167], v[64:67]
v_mfma_f32_16x16x32_bf16 v[52:55], v[28:31], a[168:171], v[52:55]
v_mfma_f32_16x16x32_bf16 v[56:59], v[28:31], a[172:175], v[56:59]
v_mfma_f32_16x16x32_bf16 v[60:63], v[32:35], a[168:171], v[60:63]
v_mfma_f32_16x16x32_bf16 v[64:67], v[32:35], a[172:175], v[64:67]
v_mfma_f32_16x16x32_bf16 v[52:55], v[36:39], a[176:179], v[52:55]
v_mfma_f32_16x16x32_bf16 v[56:59], v[36:39], a[180:183], v[56:59]
v_mfma_f32_16x16x32_bf16 v[60:63], v[40:43], a[176:179], v[60:63]
v_mfma_f32_16x16x32_bf16 v[64:67], v[40:43], a[180:183], v[64:67]
v_mfma_f32_16x16x32_bf16 v[52:55], v[44:47], a[184:187], v[52:55]
v_mfma_f32_16x16x32_bf16 v[56:59], v[44:47], a[188:191], v[56:59]
v_mfma_f32_16x16x32_bf16 v[60:63], v[48:51], a[184:187], v[60:63]
v_mfma_f32_16x16x32_bf16 v[64:67], v[48:51], a[188:191], v[64:67]
s_waitcnt vmcnt(9)
ds_read_b64_tr_b16 a[192:193], v17 offset:0
ds_read_b64_tr_b16 a[194:195], v17 offset:256
ds_read_b64_tr_b16 a[196:197], v17 offset:32
ds_read_b64_tr_b16 a[198:199], v17 offset:288
ds_read_b64_tr_b16 a[200:201], v17 offset:2048
ds_read_b64_tr_b16 a[202:203], v17 offset:2304
ds_read_b64_tr_b16 a[204:205], v17 offset:2080
ds_read_b64_tr_b16 a[206:207], v17 offset:2336
s_waitcnt lgkmcnt(0)
ds_read_b64_tr_b16 a[208:209], v17 offset:4096
ds_read_b64_tr_b16 a[210:211], v17 offset:4352
ds_read_b64_tr_b16 a[212:213], v17 offset:4128
ds_read_b64_tr_b16 a[214:215], v17 offset:4384
ds_read_b64_tr_b16 a[216:217], v17 offset:6144
ds_read_b64_tr_b16 a[218:219], v17 offset:6400
ds_read_b64_tr_b16 a[220:221], v17 offset:6176
ds_read_b64_tr_b16 a[222:223], v17 offset:6432
s_waitcnt lgkmcnt(0)
ds_read_b128 v[20:23], v8 offset:49152
ds_read_b128 v[24:27], v8 offset:51200
ds_read_b128 v[28:31], v9 offset:49152
ds_read_b128 v[32:35], v9 offset:51200
ds_read_b128 v[36:39], v8 offset:53248
ds_read_b128 v[40:43], v8 offset:55296
ds_read_b128 v[44:47], v9 offset:53248
ds_read_b128 v[48:51], v9 offset:55296
s_waitcnt lgkmcnt(0)
v_mfma_f32_16x16x32_bf16 v[52:55], v[20:23], a[192:195], v[52:55]
v_mfma_f32_16x16x32_bf16 v[56:59], v[20:23], a[196:199], v[56:59]
v_mfma_f32_16x16x32_bf16 v[60:63], v[24:27], a[192:195], v[60:63]
v_mfma_f32_16x16x32_bf16 v[64:67], v[24:27], a[196:199], v[64:67]
v_mfma_f32_16x16x32_bf16 v[52:55], v[28:31], a[200:203], v[52:55]
v_mfma_f32_16x16x32_bf16 v[56:59], v[28:31], a[204:207], v[56:59]
v_mfma_f32_16x16x32_bf16 v[60:63], v[32:35], a[200:203], v[60:63]
v_mfma_f32_16x16x32_bf16 v[64:67], v[32:35], a[204:207], v[64:67]
v_mfma_f32_16x16x32_bf16 v[52:55], v[36:39], a[208:211], v[52:55]
v_mfma_f32_16x16x32_bf16 v[56:59], v[36:39], a[212:215], v[56:59]
v_mfma_f32_16x16x32_bf16 v[60:63], v[40:43], a[208:211], v[60:63]
v_mfma_f32_16x16x32_bf16 v[64:67], v[40:43], a[212:215], v[64:67]
v_mfma_f32_16x16x32_bf16 v[52:55], v[44:47], a[216:219], v[52:55]
v_mfma_f32_16x16x32_bf16 v[56:59], v[44:47], a[220:223], v[56:59]
v_mfma_f32_16x16x32_bf16 v[60:63], v[48:51], a[216:219], v[60:63]
v_mfma_f32_16x16x32_bf16 v[64:67], v[48:51], a[220:223], v[64:67]
s_waitcnt vmcnt(0)
ds_read_b64_tr_b16 a[224:225], v17 offset:8192
ds_read_b64_tr_b16 a[226:227], v17 offset:8448
ds_read_b64_tr_b16 a[228:229], v17 offset:8224
ds_read_b64_tr_b16 a[230:231], v17 offset:8480
ds_read_b64_tr_b16 a[232:233], v17 offset:10240
ds_read_b64_tr_b16 a[234:235], v17 offset:10496
ds_read_b64_tr_b16 a[236:237], v17 offset:10272
ds_read_b64_tr_b16 a[238:239], v17 offset:10528
s_waitcnt lgkmcnt(0)
ds_read_b64_tr_b16 a[240:241], v17 offset:12288
ds_read_b64_tr_b16 a[242:243], v17 offset:12544
ds_read_b64_tr_b16 a[244:245], v17 offset:12320
ds_read_b64_tr_b16 a[246:247], v17 offset:12576
ds_read_b64_tr_b16 a[248:249], v17 offset:14336
ds_read_b64_tr_b16 a[250:251], v17 offset:14592
ds_read_b64_tr_b16 a[252:253], v17 offset:14368
ds_read_b64_tr_b16 a[254:255], v17 offset:14624
s_waitcnt lgkmcnt(0)
ds_read_b128 v[20:23], v8 offset:57344
ds_read_b128 v[24:27], v8 offset:59392
ds_read_b128 v[28:31], v9 offset:57344
ds_read_b128 v[32:35], v9 offset:59392
ds_read_b128 v[36:39], v8 offset:61440
ds_read_b128 v[40:43], v8 offset:63488
ds_read_b128 v[44:47], v9 offset:61440
ds_read_b128 v[48:51], v9 offset:63488
s_waitcnt lgkmcnt(0)
v_mfma_f32_16x16x32_bf16 v[52:55], v[20:23], a[224:227], v[52:55]
v_mfma_f32_16x16x32_bf16 v[56:59], v[20:23], a[228:231], v[56:59]
v_mfma_f32_16x16x32_bf16 v[60:63], v[24:27], a[224:227], v[60:63]
v_mfma_f32_16x16x32_bf16 v[64:67], v[24:27], a[228:231], v[64:67]
v_mfma_f32_16x16x32_bf16 v[52:55], v[28:31], a[232:235], v[52:55]
v_mfma_f32_16x16x32_bf16 v[56:59], v[28:31], a[236:239], v[56:59]
v_mfma_f32_16x16x32_bf16 v[60:63], v[32:35], a[232:235], v[60:63]
v_mfma_f32_16x16x32_bf16 v[64:67], v[32:35], a[236:239], v[64:67]
v_mfma_f32_16x16x32_bf16 v[52:55], v[36:39], a[240:243], v[52:55]
v_mfma_f32_16x16x32_bf16 v[56:59], v[36:39], a[244:247], v[56:59]
v_mfma_f32_16x16x32_bf16 v[60:63], v[40:43], a[240:243], v[60:63]
v_mfma_f32_16x16x32_bf16 v[64:67], v[40:43], a[244:247], v[64:67]
v_mfma_f32_16x16x32_bf16 v[52:55], v[44:47], a[248:251], v[52:55]
v_mfma_f32_16x16x32_bf16 v[56:59], v[44:47], a[252:255], v[56:59]
v_mfma_f32_16x16x32_bf16 v[60:63], v[48:51], a[248:251], v[60:63]
v_mfma_f32_16x16x32_bf16 v[64:67], v[48:51], a[252:255], v[64:67]
s_barrier
s_mov_b32 s50, 0x10000
s_add_u32 m0, s46, 65536
s_nop 0
buffer_load_dwordx4 v6, s[8:11], s50 offen offset:0 lds
s_add_u32 m0, s46, 69504
s_nop 0
buffer_load_dwordx4 v6, s[8:11], s50 offen offset:128 lds
s_add_u32 m0, s46, 73472
s_nop 0
buffer_load_dwordx4 v6, s[8:11], s50 offen offset:256 lds
s_add_u32 m0, s46, 77440
s_nop 0
buffer_load_dwordx4 v6, s[8:11], s50 offen offset:384 lds
s_add_u32 m0, s46, 81408
s_nop 0
buffer_load_dwordx4 v6, s[8:11], s50 offen offset:512 lds
s_add_u32 m0, s46, 85376
s_nop 0
buffer_load_dwordx4 v6, s[8:11], s50 offen offset:640 lds
s_add_u32 m0, s46, 89344
s_nop 0
buffer_load_dwordx4 v6, s[8:11], s50 offen offset:768 lds
s_add_u32 m0, s46, 93312
s_nop 0
buffer_load_dwordx4 v6, s[8:11], s50 offen offset:896 lds
s_add_u32 m0, s46, 97280
s_nop 0
buffer_load_dwordx4 v6, s[8:11], s50 offen offset:1024 lds
s_add_u32 m0, s46, 101248
s_nop 0
buffer_load_dwordx4 v6, s[8:11], s50 offen offset:1152 lds
s_add_u32 m0, s46, 105216
s_nop 0
buffer_load_dwordx4 v6, s[8:11], s50 offen offset:1280 lds
s_add_u32 m0, s46, 109184
s_nop 0
buffer_load_dwordx4 v6, s[8:11], s50 offen offset:1408 lds
s_add_u32 m0, s46, 113152
s_nop 0
buffer_load_dwordx4 v6, s[8:11], s50 offen offset:1536 lds
s_add_u32 m0, s46, 117120
s_nop 0
buffer_load_dwordx4 v6, s[8:11], s50 offen offset:1664 lds
s_add_u32 m0, s46, 121088
s_nop 0
buffer_load_dwordx4 v6, s[8:11], s50 offen offset:1792 lds
s_add_u32 m0, s46, 125056
s_nop 0
buffer_load_dwordx4 v6, s[8:11], s50 offen offset:1920 lds
s_and_b32 s53, s47, 31
s_lshl_b32 s53, s53, 4
v_add_u32 v19, s53, v1
v_lshlrev_b32 v19, 7, v19
s_mov_b32 s42, 1
v_and_b32 v3, 15, v0
v_lshlrev_b32 v3, 4, v3
s_branch mega_kernel_syv
mega_kernel_syvw:
s_sleep 4
mega_kernel_syv:
buffer_load_dword v2, v3, s[72:75], 0 offen sc1
s_waitcnt vmcnt(0)
mega_kernel_syvp:
s_cmp_eq_u32 s95, 1
s_cbranch_scc0 mega_kernel_syvf
v_readlane_b32 s76, v2, 14
s_mov_b32 s98, 0
s_cmp_eq_u32 s76, 32
s_cbranch_scc0 mega_kernel_syvw
s_branch mega_kernel_syvd
mega_kernel_syvf:
s_mov_b32 s77, 0
s_mov_b32 s78, 0
v_readlane_b32 s76, v2, 0
s_add_u32 s77, s77, s76
s_xor_b32 s76, s76, 32
s_or_b32 s78, s78, s76
v_readlane_b32 s76, v2, 1
s_add_u32 s77, s77, s76
s_xor_b32 s76, s76, 32
s_or_b32 s78, s78, s76
v_readlane_b32 s76, v2, 2
s_add_u32 s77, s77, s76
s_xor_b32 s76, s76, 32
s_or_b32 s78, s78, s76
v_readlane_b32 s76, v2, 3
s_add_u32 s77, s77, s76
s_xor_b32 s76, s76, 32
s_or_b32 s78, s78, s76
v_readlane_b32 s76, v2, 4
s_add_u32 s77, s77, s76
s_xor_b32 s76, s76, 32
s_or_b32 s78, s78, s76
v_readlane_b32 s76, v2, 5
s_add_u32 s77, s77, s76
s_xor_b32 s76, s76, 32
s_or_b32 s78, s78, s76
v_readlane_b32 s76, v2, 6
s_add_u32 s77, s77, s76
s_xor_b32 s76, s76, 32
s_or_b32 s78, s78, s76
v_readlane_b32 s76, v2, 7
s_add_u32 s77, s77, s76
s_xor_b32 s76, s76, 32
s_or_b32 s78, s78, s76
s_cmp_eq_u32 s77, 256
s_cbranch_scc0 mega_kernel_syvw
v_mov_b32 v252, v2
s_cmp_eq_u32 s78, 0
s_cbranch_scc0 mega_kernel_slowent
v_readlane_b32 s76, v2, 10
v_readlane_b32 s77, v2, 8
s_cmp_eq_u32 s76, 32
s_cbranch_scc0 mega_kernel_syvw
s_cmp_gt_u32 s77, 16
s_cselect_b32 s98, 1, 0
mega_kernel_syvd:
s_lshr_b32 s44, s47, 3
s_xor_b32 s44, s44, s98
s_and_b32 s44, s44, 1
s_lshl_b32 s44, s44, 13
s_lshl_b32 s48, s47, 18
s_add_u32 s48, s48, s44
s_add_u32 s48, s48, 33554432
s_xor_b32 s44, s98, 1
s_lshl_b32 s44, s44, 13
s_lshl_b32 s49, s40, 7
s_add_u32 s49, s49, s44
s_lshl_b32 s44, s41, 2
s_add_u32 s49, s49, s44
s_add_u32 s49, s49, 69210112
v_mov_b32 v16, 0
v_cvt_pk_bf16_f32 v84, v52, v53
v_cvt_pk_bf16_f32 v85, v54, v55
v_cvt_pk_bf16_f32 v86, v60, v61
v_cvt_pk_bf16_f32 v87, v62, v63
v_cvt_pk_bf16_f32 v88, v56, v57
v_cvt_pk_bf16_f32 v89, v58, v59
v_cvt_pk_bf16_f32 v90, v64, v65
v_cvt_pk_bf16_f32 v91, v66, v67
s_add_u32 s51, s42, s47
s_sub_u32 s51, s51, 1
s_bfe_u32 s52, s51, 0x40002
s_lshl_b32 s52, s52, 14
s_and_b32 s51, s51, 3
s_lshl_b32 s51, s51, 11
s_add_u32 s51, s51, s52
s_add_u32 s51, s51, s48
buffer_store_dwordx4 v[84:87], v7, s[84:87], s51 offen sc1
buffer_store_dwordx4 v[88:91], v7, s[84:87], s51 offen offset:1024 sc1
s_waitcnt vmcnt(0)
v_mov_b32 v17, s42
s_mov_b64 exec, 1
buffer_store_dword v17, v16, s[84:87], s49 offen sc1
s_mov_b64 exec, -1
mega_kernel_v_loop:
s_waitcnt vmcnt(2)
s_barrier
s_add_u32 s50, s42, 1
s_min_u32 s50, s50, 63
s_lshl_b32 s50, s50, 16
ds_read_b128 v[20:23], v10 offset:0
ds_read_b128 v[24:27], v10 offset:2048
ds_read_b128 v[28:31], v11 offset:0
ds_read_b128 v[32:35], v11 offset:2048
ds_read_b128 v[36:39], v10 offset:4096
ds_read_b128 v[40:43], v10 offset:6144
s_waitcnt lgkmcnt(4)
v_mfma_f32_16x16x32_bf16 v[68:71], v[20:23], a[0:3], 0
ds_read_b128 v[44:47], v11 offset:4096
v_mfma_f32_16x16x32_bf16 v[72:75], v[20:23], a[4:7], 0
v_cvt_pk_bf16_f32 v84, v52, v53
v_cvt_pk_bf16_f32 v85, v54, v55
v_cvt_pk_bf16_f32 v86, v60, v61
v_mfma_f32_16x16x32_bf16 v[76:79], v[24:27], a[0:3], 0
ds_read_b128 v[48:51], v11 offset:6144
v_mfma_f32_16x16x32_bf16 v[80:83], v[24:27], a[4:7], 0
v_cvt_pk_bf16_f32 v87, v62, v63
v_cvt_pk_bf16_f32 v88, v56, v57
v_cvt_pk_bf16_f32 v89, v58, v59
s_waitcnt lgkmcnt(4)
v_mfma_f32_16x16x32_bf16 v[68:71], v[28:31], a[8:11], v[68:71]
ds_read_b128 v[20:23], v10 offset:8192
v_mfma_f32_16x16x32_bf16 v[72:75], v[28:31], a[12:15], v[72:75]
v_cvt_pk_bf16_f32 v90, v64, v65
v_cvt_pk_bf16_f32 v91, v66, v67
v_mfma_f32_16x16x32_bf16 v[76:79], v[32:35], a[8:11], v[76:79]
ds_read_b128 v[24:27], v10 offset:10240
v_mfma_f32_16x16x32_bf16 v[80:83], v[32:35], a[12:15], v[80:83]
s_add_u32 s51, s42, s47
s_sub_u32 s51, s51, 1
s_bfe_u32 s52, s51, 0x40002
s_lshl_b32 s52, s52, 14
s_waitcnt lgkmcnt(4)
v_mfma_f32_16x16x32_bf16 v[68:71], v[36:39], a[16:19], v[68:71]
ds_read_b128 v[28:31], v11 offset:8192
v_mfma_f32_16x16x32_bf16 v[72:75], v[36:39], a[20:23], v[72:75]
s_and_b32 s51, s51, 3
s_lshl_b32 s51, s51, 11
s_add_u32 s51, s51, s52
s_add_u32 s51, s51, s48
buffer_store_dwordx4 v[84:87], v7, s[84:87], s51 offen sc1
v_mfma_f32_16x16x32_bf16 v[76:79], v[40:43], a[16:19], v[76:79]
ds_read_b128 v[32:35], v11 offset:10240
v_mfma_f32_16x16x32_bf16 v[80:83], v[40:43], a[20:23], v[80:83]
buffer_store_dwordx4 v[88:91], v7, s[84:87], s51 offen offset:1024 sc1
s_waitcnt lgkmcnt(4)
v_mfma_f32_16x16x32_bf16 v[68:71], v[44:47], a[24:27], v[68:71]
ds_read_b128 v[36:39], v10 offset:12288
v_mfma_f32_16x16x32_bf16 v[72:75], v[44:47], a[28:31], v[72:75]
s_add_u32 m0, s46, 0
v_mfma_f32_16x16x32_bf16 v[76:79], v[48:51], a[24:27], v[76:79]
ds_read_b128 v[40:43], v10 offset:14336
v_mfma_f32_16x16x32_bf16 v[80:83], v[48:51], a[28:31], v[80:83]
buffer_load_dwordx4 v6, s[8:11], s50 offen offset:0 lds
s_waitcnt lgkmcnt(4)
v_mfma_f32_16x16x32_bf16 v[68:71], v[20:23], a[32:35], v[68:71]
ds_read_b128 v[44:47], v11 offset:12288
v_mfma_f32_16x16x32_bf16 v[72:75], v[20:23], a[36:39], v[72:75]
s_add_u32 m0, s46, 3968
v_mfma_f32_16x16x32_bf16 v[76:79], v[24:27], a[32:35], v[76:79]
ds_read_b128 v[48:51], v11 offset:14336
v_mfma_f32_16x16x32_bf16 v[80:83], v[24:27], a[36:39], v[80:83]
buffer_load_dwordx4 v6, s[8:11], s50 offen offset:128 lds
s_waitcnt lgkmcnt(4)
v_mfma_f32_16x16x32_bf16 v[68:71], v[28:31], a[40:43], v[68:71]
ds_read_b128 v[20:23], v10 offset:16384
v_mfma_f32_16x16x32_bf16 v[72:75], v[28:31], a[44:47], v[72:75]
s_add_u32 m0, s46, 7936
v_mfma_f32_16x16x32_bf16 v[76:79], v[32:35], a[40:43], v[76:79]
ds_read_b128 v[24:27], v10 offset:18432
v_mfma_f32_16x16x32_bf16 v[80:83], v[32:35], a[44:47], v[80:83]
buffer_load_dwordx4 v6, s[8:11], s50 offen offset:256 lds
s_waitcnt lgkmcnt(4)
v_mfma_f32_16x16x32_bf16 v[68:71], v[36:39], a[48:51], v[68:71]
ds_read_b128 v[28:31], v11 offset:16384
v_mfma_f32_16x16x32_bf16 v[72:75], v[36:39], a[52:55], v[72:75]
s_add_u32 m0, s46, 11904
v_mfma_f32_16x16x32_bf16 v[76:79], v[40:43], a[48:51], v[76:79]
ds_read_b128 v[32:35], v11 offset:18432
v_mfma_f32_16x16x32_bf16 v[80:83], v[40:43], a[52:55], v[80:83]
buffer_load_dwordx4 v6, s[8:11], s50 offen offset:384 lds
s_waitcnt lgkmcnt(4)
v_mfma_f32_16x16x32_bf16 v[68:71], v[44:47], a[56:59], v[68:71]
ds_read_b128 v[36:39], v10 offset:20480
v_mfma_f32_16x16x32_bf16 v[72:75], v[44:47], a[60:63], v[72:75]
s_add_u32 m0, s46, 15872
v_mfma_f32_16x16x32_bf16 v[76:79], v[48:51], a[56:59], v[76:79]
ds_read_b128 v[40:43], v10 offset:22528
v_mfma_f32_16x16x32_bf16 v[80:83], v[48:51], a[60:63], v[80:83]
buffer_load_dwordx4 v6, s[8:11], s50 offen offset:512 lds
s_waitcnt lgkmcnt(4)
v_mfma_f32_16x16x32_bf16 v[68:71], v[20:23], a[64:67], v[68:71]
ds_read_b128 v[44:47], v11 offset:20480
v_mfma_f32_16x16x32_bf16 v[72:75], v[20:23], a[68:71], v[72:75]
s_add_u32 m0, s46, 19840
v_mfma_f32_16x16x32_bf16 v[76:79], v[24:27], a[64:67], v[76:79]
ds_read_b128 v[48:51], v11 offset:22528
v_mfma_f32_16x16x32_bf16 v[80:83], v[24:27], a[68:71], v[80:83]
buffer_load_dwordx4 v6, s[8:11], s50 offen offset:640 lds
s_waitcnt lgkmcnt(4)
v_mfma_f32_16x16x32_bf16 v[68:71], v[28:31], a[72:75], v[68:71]
ds_read_b128 v[20:23], v10 offset:24576
v_mfma_f32_16x16x32_bf16 v[72:75], v[28:31], a[76:79], v[72:75]
s_add_u32 m0, s46, 23808
v_mfma_f32_16x16x32_bf16 v[76:79], v[32:35], a[72:75], v[76:79]
ds_read_b128 v[24:27], v10 offset:26624
v_mfma_f32_16x16x32_bf16 v[80:83], v[32:35], a[76:79], v[80:83]
buffer_load_dwordx4 v6, s[8:11], s50 offen offset:768 lds
s_waitcnt lgkmcnt(4)
v_mfma_f32_16x16x32_bf16 v[68:71], v[36:39], a[80:83], v[68:71]
ds_read_b128 v[28:31], v11 offset:24576
v_mfma_f32_16x16x32_bf16 v[72:75], v[36:39], a[84:87], v[72:75]
s_add_u32 m0, s46, 27776
v_mfma_f32_16x16x32_bf16 v[76:79], v[40:43], a[80:83], v[76:79]
ds_read_b128 v[32:35], v11 offset:26624
v_mfma_f32_16x16x32_bf16 v[80:83], v[40:43], a[84:87], v[80:83]
buffer_load_dwordx4 v6, s[8:11], s50 offen offset:896 lds
s_waitcnt lgkmcnt(4)
v_mfma_f32_16x16x32_bf16 v[68:71], v[44:47], a[88:91], v[68:71]
ds_read_b128 v[36:39], v10 offset:28672
v_mfma_f32_16x16x32_bf16 v[72:75], v[44:47], a[92:95], v[72:75]
s_add_u32 m0, s46, 31744
v_mfma_f32_16x16x32_bf16 v[76:79], v[48:51], a[88:91], v[76:79]
ds_read_b128 v[40:43], v10 offset:30720
v_mfma_f32_16x16x32_bf16 v[80:83], v[48:51], a[92:95], v[80:83]
buffer_load_dwordx4 v6, s[8:11], s50 offen offset:1024 lds
s_waitcnt lgkmcnt(4)
v_mfma_f32_16x16x32_bf16 v[68:71], v[20:23], a[96:99], v[68:71]
ds_read_b128 v[44:47], v11 offset:28672
v_mfma_f32_16x16x32_bf16 v[72:75], v[20:23], a[100:103], v[72:75]
s_add_u32 m0, s46, 35712
v_mfma_f32_16x16x32_bf16 v[76:79], v[24:27], a[96:99], v[76:79]
ds_read_b128 v[48:51], v11 offset:30720
v_mfma_f32_16x16x32_bf16 v[80:83], v[24:27], a[100:103], v[80:83]
buffer_load_dwordx4 v6, s[8:11], s50 offen offset:1152 lds
s_waitcnt lgkmcnt(4)
v_mfma_f32_16x16x32_bf16 v[68:71], v[28:31], a[104:107], v[68:71]
ds_read_b128 v[20:23], v10 offset:32768
v_mfma_f32_16x16x32_bf16 v[72:75], v[28:31], a[108:111], v[72:75]
s_add_u32 m0, s46, 39680
v_mfma_f32_16x16x32_bf16 v[76:79], v[32:35], a[104:107], v[76:79]
ds_read_b128 v[24:27], v10 offset:34816
v_mfma_f32_16x16x32_bf16 v[80:83], v[32:35], a[108:111], v[80:83]
buffer_load_dwordx4 v6, s[8:11], s50 offen offset:1280 lds
s_waitcnt lgkmcnt(4)
v_mfma_f32_16x16x32_bf16 v[68:71], v[36:39], a[112:115], v[68:71]
ds_read_b128 v[28:31], v11 offset:32768
v_mfma_f32_16x16x32_bf16 v[72:75], v[36:39], a[116:119], v[72:75]
s_add_u32 m0, s46, 43648
v_mfma_f32_16x16x32_bf16 v[76:79], v[40:43], a[112:115], v[76:79]
ds_read_b128 v[32:35], v11 offset:34816
v_mfma_f32_16x16x32_bf16 v[80:83], v[40:43], a[116:119], v[80:83]
buffer_load_dwordx4 v6, s[8:11], s50 offen offset:1408 lds
s_waitcnt lgkmcnt(4)
v_mfma_f32_16x16x32_bf16 v[68:71], v[44:47], a[120:123], v[68:71]
ds_read_b128 v[36:39], v10 offset:36864
v_mfma_f32_16x16x32_bf16 v[72:75], v[44:47], a[124:127], v[72:75]
s_add_u32 m0, s46, 47616
v_mfma_f32_16x16x32_bf16 v[76:79], v[48:51], a[120:123], v[76:79]
ds_read_b128 v[40:43], v10 offset:38912
v_mfma_f32_16x16x32_bf16 v[80:83], v[48:51], a[124:127], v[80:83]
buffer_load_dwordx4 v6, s[8:11], s50 offen offset:1536 lds
s_waitcnt lgkmcnt(4)
v_mfma_f32_16x16x32_bf16 v[68:71], v[20:23], a[128:131], v[68:71]
ds_read_b128 v[44:47], v11 offset:36864
v_mfma_f32_16x16x32_bf16 v[72:75], v[20:23], a[132:135], v[72:75]
s_add_u32 m0, s46, 51584
v_mfma_f32_16x16x32_bf16 v[76:79], v[24:27], a[128:131], v[76:79]
ds_read_b128 v[48:51], v11 offset:38912
v_mfma_f32_16x16x32_bf16 v[80:83], v[24:27], a[132:135], v[80:83]
buffer_load_dwordx4 v6, s[8:11], s50 offen offset:1664 lds
s_waitcnt lgkmcnt(4)
v_mfma_f32_16x16x32_bf16 v[68:71], v[28:31], a[136:139], v[68:71]
ds_read_b128 v[20:23], v10 offset:40960
v_mfma_f32_16x16x32_bf16 v[72:75], v[28:31], a[140:143], v[72:75]
s_add_u32 m0, s46, 55552
v_mfma_f32_16x16x32_bf16 v[76:79], v[32:35], a[136:139], v[76:79]
ds_read_b128 v[24:27], v10 offset:43008
v_mfma_f32_16x16x32_bf16 v[80:83], v[32:35], a[140:143], v[80:83]
buffer_load_dwordx4 v6, s[8:11], s50 offen offset:1792 lds
s_waitcnt lgkmcnt(4)
v_mfma_f32_16x16x32_bf16 v[68:71], v[36:39], a[144:147], v[68:71]
ds_read_b128 v[28:31], v11 offset:40960
v_mfma_f32_16x16x32_bf16 v[72:75], v[36:39], a[148:151], v[72:75]
s_add_u32 m0, s46, 59520
v_mfma_f32_16x16x32_bf16 v[76:79], v[40:43], a[144:147], v[76:79]
ds_read_b128 v[32:35], v11 offset:43008
v_mfma_f32_16x16x32_bf16 v[80:83], v[40:43], a[148:151], v[80:83]
buffer_load_dwordx4 v6, s[8:11], s50 offen offset:1920 lds
s_waitcnt lgkmcnt(4)
v_mfma_f32_16x16x32_bf16 v[68:71], v[44:47], a[152:155], v[68:71]
ds_read_b128 v[36:39], v10 offset:45056
v_mfma_f32_16x16x32_bf16 v[72:75], v[44:47], a[156:159], v[72:75]
v_mfma_f32_16x16x32_bf16 v[76:79], v[48:51], a[152:155], v[76:79]
ds_read_b128 v[40:43], v10 offset:47104
v_mfma_f32_16x16x32_bf16 v[80:83], v[48:51], a[156:159], v[80:83]
s_waitcnt lgkmcnt(4)
v_mfma_f32_16x16x32_bf16 v[68:71], v[20:23], a[160:163], v[68:71]
ds_read_b128 v[44:47], v11 offset:45056
v_mfma_f32_16x16x32_bf16 v[72:75], v[20:23], a[164:167], v[72:75]
v_mfma_f32_16x16x32_bf16 v[76:79], v[24:27], a[160:163], v[76:79]
ds_read_b128 v[48:51], v11 offset:47104
v_mfma_f32_16x16x32_bf16 v[80:83], v[24:27], a[164:167], v[80:83]
s_waitcnt lgkmcnt(4)
v_mfma_f32_16x16x32_bf16 v[68:71], v[28:31], a[168:171], v[68:71]
ds_read_b128 v[20:23], v10 offset:49152
v_mfma_f32_16x16x32_bf16 v[72:75], v[28:31], a[172:175], v[72:75]
s_waitcnt vmcnt(16)
v_mov_b32 v17, s42
s_mov_b64 exec, 1
buffer_store_dword v17, v16, s[84:87], s49 offen sc1
s_mov_b64 exec, -1
v_mfma_f32_16x16x32_bf16 v[76:79], v[32:35], a[168:171], v[76:79]
ds_read_b128 v[24:27], v10 offset:51200
v_mfma_f32_16x16x32_bf16 v[80:83], v[32:35], a[172:175], v[80:83]
s_waitcnt lgkmcnt(4)
v_mfma_f32_16x16x32_bf16 v[68:71], v[36:39], a[176:179], v[68:71]
ds_read_b128 v[28:31], v11 offset:49152
v_mfma_f32_16x16x32_bf16 v[72:75], v[36:39], a[180:183], v[72:75]
s_add_u32 s53, s42, 3
s_min_u32 s53, s53, 63
s_lshl_b32 s53, s53, 16
s_mov_b64 exec, 0xffff
buffer_load_dword v250, v19, s[8:11], s53 offen
s_mov_b64 exec, -1
v_mfma_f32_16x16x32_bf16 v[76:79], v[40:43], a[176:179], v[76:79]
ds_read_b128 v[32:35], v11 offset:51200
v_mfma_f32_16x16x32_bf16 v[80:83], v[40:43], a[180:183], v[80:83]
s_waitcnt lgkmcnt(4)
v_mfma_f32_16x16x32_bf16 v[68:71], v[44:47], a[184:187], v[68:71]
ds_read_b128 v[36:39], v10 offset:53248
v_mfma_f32_16x16x32_bf16 v[72:75], v[44:47], a[188:191], v[72:75]
v_mfma_f32_16x16x32_bf16 v[76:79], v[48:51], a[184:187], v[76:79]
ds_read_b128 v[40:43], v10 offset:55296
v_mfma_f32_16x16x32_bf16 v[80:83], v[48:51], a[188:191], v[80:83]
s_waitcnt lgkmcnt(4)
v_mfma_f32_16x16x32_bf16 v[68:71], v[20:23], a[192:195], v[68:71]
ds_read_b128 v[44:47], v11 offset:53248
v_mfma_f32_16x16x32_bf16 v[72:75], v[20:23], a[196:199], v[72:75]
v_mfma_f32_16x16x32_bf16 v[76:79], v[24:27], a[192:195], v[76:79]
ds_read_b128 v[48:51], v11 offset:55296
v_mfma_f32_16x16x32_bf16 v[80:83], v[24:27], a[196:199], v[80:83]
s_waitcnt lgkmcnt(4)
v_mfma_f32_16x16x32_bf16 v[68:71], v[28:31], a[200:203], v[68:71]
ds_read_b128 v[20:23], v10 offset:57344
v_mfma_f32_16x16x32_bf16 v[72:75], v[28:31], a[204:207], v[72:75]
v_mfma_f32_16x16x32_bf16 v[76:79], v[32:35], a[200:203], v[76:79]
ds_read_b128 v[24:27], v10 offset:59392
v_mfma_f32_16x16x32_bf16 v[80:83], v[32:35], a[204:207], v[80:83]
s_waitcnt lgkmcnt(4)
v_mfma_f32_16x16x32_bf16 v[68:71], v[36:39], a[208:211], v[68:71]
ds_read_b128 v[28:31], v11 offset:57344
v_mfma_f32_16x16x32_bf16 v[72:75], v[36:39], a[212:215], v[72:75]
v_mfma_f32_16x16x32_bf16 v[76:79], v[40:43], a[208:211], v[76:79]
ds_read_b128 v[32:35], v11 offset:59392
v_mfma_f32_16x16x32_bf16 v[80:83], v[40:43], a[212:215], v[80:83]
s_waitcnt lgkmcnt(4)
v_mfma_f32_16x16x32_bf16 v[68:71], v[44:47], a[216:219], v[68:71]
ds_read_b128 v[36:39], v10 offset:61440
v_mfma_f32_16x16x32_bf16 v[72:75], v[44:47], a[220:223], v[72:75]
v_mfma_f32_16x16x32_bf16 v[76:79], v[48:51], a[216:219], v[76:79]
ds_read_b128 v[40:43], v10 offset:63488
v_mfma_f32_16x16x32_bf16 v[80:83], v[48:51], a[220:223], v[80:83]
s_waitcnt lgkmcnt(4)
v_mfma_f32_16x16x32_bf16 v[68:71], v[20:23], a[224:227], v[68:71]
ds_read_b128 v[44:47], v11 offset:61440
v_mfma_f32_16x16x32_bf16 v[72:75], v[20:23], a[228:231], v[72:75]
v_mfma_f32_16x16x32_bf16 v[76:79], v[24:27], a[224:227], v[76:79]
ds_read_b128 v[48:51], v11 offset:63488
v_mfma_f32_16x16x32_bf16 v[80:83], v[24:27], a[228:231], v[80:83]
s_waitcnt lgkmcnt(5)
v_mfma_f32_16x16x32_bf16 v[68:71], v[28:31], a[232:235], v[68:71]
v_mfma_f32_16x16x32_bf16 v[72:75], v[28:31], a[236:239], v[72:75]
s_waitcnt lgkmcnt(4)
v_mfma_f32_16x16x32_bf16 v[76:79], v[32:35], a[232:235], v[76:79]
v_mfma_f32_16x16x32_bf16 v[80:83], v[32:35], a[236:239], v[80:83]
s_waitcnt lgkmcnt(3)
v_mfma_f32_16x16x32_bf16 v[68:71], v[36:39], a[240:243], v[68:71]
v_mfma_f32_16x16x32_bf16 v[72:75], v[36:39], a[244:247], v[72:75]
s_waitcnt lgkmcnt(2)
v_mfma_f32_16x16x32_bf16 v[76:79], v[40:43], a[240:243], v[76:79]
v_mfma_f32_16x16x32_bf16 v[80:83], v[40:43], a[244:247], v[80:83]
s_waitcnt lgkmcnt(1)
v_mfma_f32_16x16x32_bf16 v[68:71], v[44:47], a[248:251], v[68:71]
v_mfma_f32_16x16x32_bf16 v[72:75], v[44:47], a[252:255], v[72:75]
s_waitcnt lgkmcnt(0)
v_mfma_f32_16x16x32_bf16 v[76:79], v[48:51], a[248:251], v[76:79]
v_mfma_f32_16x16x32_bf16 v[80:83], v[48:51], a[252:255], v[80:83]
s_add_u32 s42, s42, 1
s_cmp_eq_u32 s42, 64
s_cbranch_scc1 mega_kernel_v_fin
mega_kernel_v_mid:
s_waitcnt vmcnt(2)
s_barrier
s_add_u32 s50, s42, 1
s_min_u32 s50, s50, 63
s_lshl_b32 s50, s50, 16
ds_read_b128 v[20:23], v8 offset:0
ds_read_b128 v[24:27], v8 offset:2048
ds_read_b128 v[28:31], v9 offset:0
ds_read_b128 v[32:35], v9 offset:2048
ds_read_b128 v[36:39], v8 offset:4096
ds_read_b128 v[40:43], v8 offset:6144
s_waitcnt lgkmcnt(4)
v_mfma_f32_16x16x32_bf16 v[52:55], v[20:23], a[0:3], 0
ds_read_b128 v[44:47], v9 offset:4096
v_mfma_f32_16x16x32_bf16 v[56:59], v[20:23], a[4:7], 0
v_cvt_pk_bf16_f32 v84, v68, v69
v_cvt_pk_bf16_f32 v85, v70, v71
v_cvt_pk_bf16_f32 v86, v76, v77
v_mfma_f32_16x16x32_bf16 v[60:63], v[24:27], a[0:3], 0
ds_read_b128 v[48:51], v9 offset:6144
v_mfma_f32_16x16x32_bf16 v[64:67], v[24:27], a[4:7], 0
v_cvt_pk_bf16_f32 v87, v78, v79
v_cvt_pk_bf16_f32 v88, v72, v73
v_cvt_pk_bf16_f32 v89, v74, v75
s_waitcnt lgkmcnt(4)
v_mfma_f32_16x16x32_bf16 v[52:55], v[28:31], a[8:11], v[52:55]
ds_read_b128 v[20:23], v8 offset:8192
v_mfma_f32_16x16x32_bf16 v[56:59], v[28:31], a[12:15], v[56:59]
v_cvt_pk_bf16_f32 v90, v80, v81
v_cvt_pk_bf16_f32 v91, v82, v83
v_mfma_f32_16x16x32_bf16 v[60:63], v[32:35], a[8:11], v[60:63]
ds_read_b128 v[24:27], v8 offset:10240
v_mfma_f32_16x16x32_bf16 v[64:67], v[32:35], a[12:15], v[64:67]
s_add_u32 s51, s42, s47
s_sub_u32 s51, s51, 1
s_bfe_u32 s52, s51, 0x40002
s_lshl_b32 s52, s52, 14
s_waitcnt lgkmcnt(4)
v_mfma_f32_16x16x32_bf16 v[52:55], v[36:39], a[16:19], v[52:55]
ds_read_b128 v[28:31], v9 offset:8192
v_mfma_f32_16x16x32_bf16 v[56:59], v[36:39], a[20:23], v[56:59]
s_and_b32 s51, s51, 3
s_lshl_b32 s51, s51, 11
s_add_u32 s51, s51, s52
s_add_u32 s51, s51, s48
buffer_store_dwordx4 v[84:87], v7, s[84:87], s51 offen sc1
v_mfma_f32_16x16x32_bf16 v[60:63], v[40:43], a[16:19], v[60:63]
ds_read_b128 v[32:35], v9 offset:10240
v_mfma_f32_16x16x32_bf16 v[64:67], v[40:43], a[20:23], v[64:67]
buffer_store_dwordx4 v[88:91], v7, s[84:87], s51 offen offset:1024 sc1
s_waitcnt lgkmcnt(4)
v_mfma_f32_16x16x32_bf16 v[52:55], v[44:47], a[24:27], v[52:55]
ds_read_b128 v[36:39], v8 offset:12288
v_mfma_f32_16x16x32_bf16 v[56:59], v[44:47], a[28:31], v[56:59]
s_add_u32 m0, s46, 65536
v_mfma_f32_16x16x32_bf16 v[60:63], v[48:51], a[24:27], v[60:63]
ds_read_b128 v[40:43], v8 offset:14336
v_mfma_f32_16x16x32_bf16 v[64:67], v[48:51], a[28:31], v[64:67]
buffer_load_dwordx4 v6, s[8:11], s50 offen offset:0 lds
s_waitcnt lgkmcnt(4)
v_mfma_f32_16x16x32_bf16 v[52:55], v[20:23], a[32:35], v[52:55]
ds_read_b128 v[44:47], v9 offset:12288
v_mfma_f32_16x16x32_bf16 v[56:59], v[20:23], a[36:39], v[56:59]
s_add_u32 m0, s46, 69504
v_mfma_f32_16x16x32_bf16 v[60:63], v[24:27], a[32:35], v[60:63]
ds_read_b128 v[48:51], v9 offset:14336
v_mfma_f32_16x16x32_bf16 v[64:67], v[24:27], a[36:39], v[64:67]
buffer_load_dwordx4 v6, s[8:11], s50 offen offset:128 lds
s_waitcnt lgkmcnt(4)
v_mfma_f32_16x16x32_bf16 v[52:55], v[28:31], a[40:43], v[52:55]
ds_read_b128 v[20:23], v8 offset:16384
v_mfma_f32_16x16x32_bf16 v[56:59], v[28:31], a[44:47], v[56:59]
s_add_u32 m0, s46, 73472
v_mfma_f32_16x16x32_bf16 v[60:63], v[32:35], a[40:43], v[60:63]
ds_read_b128 v[24:27], v8 offset:18432
v_mfma_f32_16x16x32_bf16 v[64:67], v[32:35], a[44:47], v[64:67]
buffer_load_dwordx4 v6, s[8:11], s50 offen offset:256 lds
s_waitcnt lgkmcnt(4)
v_mfma_f32_16x16x32_bf16 v[52:55], v[36:39], a[48:51], v[52:55]
ds_read_b128 v[28:31], v9 offset:16384
v_mfma_f32_16x16x32_bf16 v[56:59], v[36:39], a[52:55], v[56:59]
s_add_u32 m0, s46, 77440
v_mfma_f32_16x16x32_bf16 v[60:63], v[40:43], a[48:51], v[60:63]
ds_read_b128 v[32:35], v9 offset:18432
v_mfma_f32_16x16x32_bf16 v[64:67], v[40:43], a[52:55], v[64:67]
buffer_load_dwordx4 v6, s[8:11], s50 offen offset:384 lds
s_waitcnt lgkmcnt(4)
v_mfma_f32_16x16x32_bf16 v[52:55], v[44:47], a[56:59], v[52:55]
ds_read_b128 v[36:39], v8 offset:20480
v_mfma_f32_16x16x32_bf16 v[56:59], v[44:47], a[60:63], v[56:59]
s_add_u32 m0, s46, 81408
v_mfma_f32_16x16x32_bf16 v[60:63], v[48:51], a[56:59], v[60:63]
ds_read_b128 v[40:43], v8 offset:22528
v_mfma_f32_16x16x32_bf16 v[64:67], v[48:51], a[60:63], v[64:67]
buffer_load_dwordx4 v6, s[8:11], s50 offen offset:512 lds
s_waitcnt lgkmcnt(4)
v_mfma_f32_16x16x32_bf16 v[52:55], v[20:23], a[64:67], v[52:55]
ds_read_b128 v[44:47], v9 offset:20480
v_mfma_f32_16x16x32_bf16 v[56:59], v[20:23], a[68:71], v[56:59]
s_add_u32 m0, s46, 85376
v_mfma_f32_16x16x32_bf16 v[60:63], v[24:27], a[64:67], v[60:63]
ds_read_b128 v[48:51], v9 offset:22528
v_mfma_f32_16x16x32_bf16 v[64:67], v[24:27], a[68:71], v[64:67]
buffer_load_dwordx4 v6, s[8:11], s50 offen offset:640 lds
s_waitcnt lgkmcnt(4)
v_mfma_f32_16x16x32_bf16 v[52:55], v[28:31], a[72:75], v[52:55]
ds_read_b128 v[20:23], v8 offset:24576
v_mfma_f32_16x16x32_bf16 v[56:59], v[28:31], a[76:79], v[56:59]
s_add_u32 m0, s46, 89344
v_mfma_f32_16x16x32_bf16 v[60:63], v[32:35], a[72:75], v[60:63]
ds_read_b128 v[24:27], v8 offset:26624
v_mfma_f32_16x16x32_bf16 v[64:67], v[32:35], a[76:79], v[64:67]
buffer_load_dwordx4 v6, s[8:11], s50 offen offset:768 lds
s_waitcnt lgkmcnt(4)
v_mfma_f32_16x16x32_bf16 v[52:55], v[36:39], a[80:83], v[52:55]
ds_read_b128 v[28:31], v9 offset:24576
v_mfma_f32_16x16x32_bf16 v[56:59], v[36:39], a[84:87], v[56:59]
s_add_u32 m0, s46, 93312
v_mfma_f32_16x16x32_bf16 v[60:63], v[40:43], a[80:83], v[60:63]
ds_read_b128 v[32:35], v9 offset:26624
v_mfma_f32_16x16x32_bf16 v[64:67], v[40:43], a[84:87], v[64:67]
buffer_load_dwordx4 v6, s[8:11], s50 offen offset:896 lds
s_waitcnt lgkmcnt(4)
v_mfma_f32_16x16x32_bf16 v[52:55], v[44:47], a[88:91], v[52:55]
ds_read_b128 v[36:39], v8 offset:28672
v_mfma_f32_16x16x32_bf16 v[56:59], v[44:47], a[92:95], v[56:59]
s_add_u32 m0, s46, 97280
v_mfma_f32_16x16x32_bf16 v[60:63], v[48:51], a[88:91], v[60:63]
ds_read_b128 v[40:43], v8 offset:30720
v_mfma_f32_16x16x32_bf16 v[64:67], v[48:51], a[92:95], v[64:67]
buffer_load_dwordx4 v6, s[8:11], s50 offen offset:1024 lds
s_waitcnt lgkmcnt(4)
v_mfma_f32_16x16x32_bf16 v[52:55], v[20:23], a[96:99], v[52:55]
ds_read_b128 v[44:47], v9 offset:28672
v_mfma_f32_16x16x32_bf16 v[56:59], v[20:23], a[100:103], v[56:59]
s_add_u32 m0, s46, 101248
v_mfma_f32_16x16x32_bf16 v[60:63], v[24:27], a[96:99], v[60:63]
ds_read_b128 v[48:51], v9 offset:30720
v_mfma_f32_16x16x32_bf16 v[64:67], v[24:27], a[100:103], v[64:67]
buffer_load_dwordx4 v6, s[8:11], s50 offen offset:1152 lds
s_waitcnt lgkmcnt(4)
v_mfma_f32_16x16x32_bf16 v[52:55], v[28:31], a[104:107], v[52:55]
ds_read_b128 v[20:23], v8 offset:32768
v_mfma_f32_16x16x32_bf16 v[56:59], v[28:31], a[108:111], v[56:59]
s_add_u32 m0, s46, 105216
v_mfma_f32_16x16x32_bf16 v[60:63], v[32:35], a[104:107], v[60:63]
ds_read_b128 v[24:27], v8 offset:34816
v_mfma_f32_16x16x32_bf16 v[64:67], v[32:35], a[108:111], v[64:67]
buffer_load_dwordx4 v6, s[8:11], s50 offen offset:1280 lds
s_waitcnt lgkmcnt(4)
v_mfma_f32_16x16x32_bf16 v[52:55], v[36:39], a[112:115], v[52:55]
ds_read_b128 v[28:31], v9 offset:32768
v_mfma_f32_16x16x32_bf16 v[56:59], v[36:39], a[116:119], v[56:59]
s_add_u32 m0, s46, 109184
v_mfma_f32_16x16x32_bf16 v[60:63], v[40:43], a[112:115], v[60:63]
ds_read_b128 v[32:35], v9 offset:34816
v_mfma_f32_16x16x32_bf16 v[64:67], v[40:43], a[116:119], v[64:67]
buffer_load_dwordx4 v6, s[8:11], s50 offen offset:1408 lds
s_waitcnt lgkmcnt(4)
v_mfma_f32_16x16x32_bf16 v[52:55], v[44:47], a[120:123], v[52:55]
ds_read_b128 v[36:39], v8 offset:36864
v_mfma_f32_16x16x32_bf16 v[56:59], v[44:47], a[124:127], v[56:59]
s_add_u32 m0, s46, 113152
v_mfma_f32_16x16x32_bf16 v[60:63], v[48:51], a[120:123], v[60:63]
ds_read_b128 v[40:43], v8 offset:38912
v_mfma_f32_16x16x32_bf16 v[64:67], v[48:51], a[124:127], v[64:67]
buffer_load_dwordx4 v6, s[8:11], s50 offen offset:1536 lds
s_waitcnt lgkmcnt(4)
v_mfma_f32_16x16x32_bf16 v[52:55], v[20:23], a[128:131], v[52:55]
ds_read_b128 v[44:47], v9 offset:36864
v_mfma_f32_16x16x32_bf16 v[56:59], v[20:23], a[132:135], v[56:59]
s_add_u32 m0, s46, 117120
v_mfma_f32_16x16x32_bf16 v[60:63], v[24:27], a[128:131], v[60:63]
ds_read_b128 v[48:51], v9 offset:38912
v_mfma_f32_16x16x32_bf16 v[64:67], v[24:27], a[132:135], v[64:67]
buffer_load_dwordx4 v6, s[8:11], s50 offen offset:1664 lds
s_waitcnt lgkmcnt(4)
v_mfma_f32_16x16x32_bf16 v[52:55], v[28:31], a[136:139], v[52:55]
ds_read_b128 v[20:23], v8 offset:40960
v_mfma_f32_16x16x32_bf16 v[56:59], v[28:31], a[140:143], v[56:59]
s_add_u32 m0, s46, 121088
v_mfma_f32_16x16x32_bf16 v[60:63], v[32:35], a[136:139], v[60:63]
ds_read_b128 v[24:27], v8 offset:43008
v_mfma_f32_16x16x32_bf16 v[64:67], v[32:35], a[140:143], v[64:67]
buffer_load_dwordx4 v6, s[8:11], s50 offen offset:1792 lds
s_waitcnt lgkmcnt(4)
v_mfma_f32_16x16x32_bf16 v[52:55], v[36:39], a[144:147], v[52:55]
ds_read_b128 v[28:31], v9 offset:40960
v_mfma_f32_16x16x32_bf16 v[56:59], v[36:39], a[148:151], v[56:59]
s_add_u32 m0, s46, 125056
v_mfma_f32_16x16x32_bf16 v[60:63], v[40:43], a[144:147], v[60:63]
ds_read_b128 v[32:35], v9 offset:43008
v_mfma_f32_16x16x32_bf16 v[64:67], v[40:43], a[148:151], v[64:67]
buffer_load_dwordx4 v6, s[8:11], s50 offen offset:1920 lds
s_waitcnt lgkmcnt(4)
v_mfma_f32_16x16x32_bf16 v[52:55], v[44:47], a[152:155], v[52:55]
ds_read_b128 v[36:39], v8 offset:45056
v_mfma_f32_16x16x32_bf16 v[56:59], v[44:47], a[156:159], v[56:59]
v_mfma_f32_16x16x32_bf16 v[60:63], v[48:51], a[152:155], v[60:63]
ds_read_b128 v[40:43], v8 offset:47104
v_mfma_f32_16x16x32_bf16 v[64:67], v[48:51], a[156:159], v[64:67]
s_waitcnt lgkmcnt(4)
v_mfma_f32_16x16x32_bf16 v[52:55], v[20:23], a[160:163], v[52:55]
ds_read_b128 v[44:47], v9 offset:45056
v_mfma_f32_16x16x32_bf16 v[56:59], v[20:23], a[164:167], v[56:59]
v_mfma_f32_16x16x32_bf16 v[60:63], v[24:27], a[160:163], v[60:63]
ds_read_b128 v[48:51], v9 offset:47104
v_mfma_f32_16x16x32_bf16 v[64:67], v[24:27], a[164:167], v[64:67]
s_waitcnt lgkmcnt(4)
v_mfma_f32_16x16x32_bf16 v[52:55], v[28:31], a[168:171], v[52:55]
ds_read_b128 v[20:23], v8 offset:49152
v_mfma_f32_16x16x32_bf16 v[56:59], v[28:31], a[172:175], v[56:59]
s_waitcnt vmcnt(16)
v_mov_b32 v17, s42
s_mov_b64 exec, 1
buffer_store_dword v17, v16, s[84:87], s49 offen sc1
s_mov_b64 exec, -1
v_mfma_f32_16x16x32_bf16 v[60:63], v[32:35], a[168:171], v[60:63]
ds_read_b128 v[24:27], v8 offset:51200
v_mfma_f32_16x16x32_bf16 v[64:67], v[32:35], a[172:175], v[64:67]
s_waitcnt lgkmcnt(4)
v_mfma_f32_16x16x32_bf16 v[52:55], v[36:39], a[176:179], v[52:55]
ds_read_b128 v[28:31], v9 offset:49152
v_mfma_f32_16x16x32_bf16 v[56:59], v[36:39], a[180:183], v[56:59]
s_add_u32 s53, s42, 3
s_min_u32 s53, s53, 63
s_lshl_b32 s53, s53, 16
s_mov_b64 exec, 0xffff
buffer_load_dword v250, v19, s[8:11], s53 offen
s_mov_b64 exec, -1
v_mfma_f32_16x16x32_bf16 v[60:63], v[40:43], a[176:179], v[60:63]
ds_read_b128 v[32:35], v9 offset:51200
v_mfma_f32_16x16x32_bf16 v[64:67], v[40:43], a[180:183], v[64:67]
s_waitcnt lgkmcnt(4)
v_mfma_f32_16x16x32_bf16 v[52:55], v[44:47], a[184:187], v[52:55]
ds_read_b128 v[36:39], v8 offset:53248
v_mfma_f32_16x16x32_bf16 v[56:59], v[44:47], a[188:191], v[56:59]
v_mfma_f32_16x16x32_bf16 v[60:63], v[48:51], a[184:187], v[60:63]
ds_read_b128 v[40:43], v8 offset:55296
v_mfma_f32_16x16x32_bf16 v[64:67], v[48:51], a[188:191], v[64:67]
s_waitcnt lgkmcnt(4)
v_mfma_f32_16x16x32_bf16 v[52:55], v[20:23], a[192:195], v[52:55]
ds_read_b128 v[44:47], v9 offset:53248
v_mfma_f32_16x16x32_bf16 v[56:59], v[20:23], a[196:199], v[56:59]
v_mfma_f32_16x16x32_bf16 v[60:63], v[24:27], a[192:195], v[60:63]
ds_read_b128 v[48:51], v9 offset:55296
v_mfma_f32_16x16x32_bf16 v[64:67], v[24:27], a[196:199], v[64:67]
s_waitcnt lgkmcnt(4)
v_mfma_f32_16x16x32_bf16 v[52:55], v[28:31], a[200:203], v[52:55]
ds_read_b128 v[20:23], v8 offset:57344
v_mfma_f32_16x16x32_bf16 v[56:59], v[28:31], a[204:207], v[56:59]
v_mfma_f32_16x16x32_bf16 v[60:63], v[32:35], a[200:203], v[60:63]
ds_read_b128 v[24:27], v8 offset:59392
v_mfma_f32_16x16x32_bf16 v[64:67], v[32:35], a[204:207], v[64:67]
s_waitcnt lgkmcnt(4)
v_mfma_f32_16x16x32_bf16 v[52:55], v[36:39], a[208:211], v[52:55]
ds_read_b128 v[28:31], v9 offset:57344
v_mfma_f32_16x16x32_bf16 v[56:59], v[36:39], a[212:215], v[56:59]
v_mfma_f32_16x16x32_bf16 v[60:63], v[40:43], a[208:211], v[60:63]
ds_read_b128 v[32:35], v9 offset:59392
v_mfma_f32_16x16x32_bf16 v[64:67], v[40:43], a[212:215], v[64:67]
s_waitcnt lgkmcnt(4)
v_mfma_f32_16x16x32_bf16 v[52:55], v[44:47], a[216:219], v[52:55]
ds_read_b128 v[36:39], v8 offset:61440
v_mfma_f32_16x16x32_bf16 v[56:59], v[44:47], a[220:223], v[56:59]
v_mfma_f32_16x16x32_bf16 v[60:63], v[48:51], a[216:219], v[60:63]
ds_read_b128 v[40:43], v8 offset:63488
v_mfma_f32_16x16x32_bf16 v[64:67], v[48:51], a[220:223], v[64:67]
s_waitcnt lgkmcnt(4)
v_mfma_f32_16x16x32_bf16 v[52:55], v[20:23], a[224:227], v[52:55]
ds_read_b128 v[44:47], v9 offset:61440
v_mfma_f32_16x16x32_bf16 v[56:59], v[20:23], a[228:231], v[56:59]
v_mfma_f32_16x16x32_bf16 v[60:63], v[24:27], a[224:227], v[60:63]
ds_read_b128 v[48:51], v9 offset:63488
v_mfma_f32_16x16x32_bf16 v[64:67], v[24:27], a[228:231], v[64:67]
s_waitcnt lgkmcnt(5)
v_mfma_f32_16x16x32_bf16 v[52:55], v[28:31], a[232:235], v[52:55]
v_mfma_f32_16x16x32_bf16 v[56:59], v[28:31], a[236:239], v[56:59]
s_waitcnt lgkmcnt(4)
v_mfma_f32_16x16x32_bf16 v[60:63], v[32:35], a[232:235], v[60:63]
v_mfma_f32_16x16x32_bf16 v[64:67], v[32:35], a[236:239], v[64:67]
s_waitcnt lgkmcnt(3)
v_mfma_f32_16x16x32_bf16 v[52:55], v[36:39], a[240:243], v[52:55]
v_mfma_f32_16x16x32_bf16 v[56:59], v[36:39], a[244:247], v[56:59]
s_waitcnt lgkmcnt(2)
v_mfma_f32_16x16x32_bf16 v[60:63], v[40:43], a[240:243], v[60:63]
v_mfma_f32_16x16x32_bf16 v[64:67], v[40:43], a[244:247], v[64:67]
s_waitcnt lgkmcnt(1)
v_mfma_f32_16x16x32_bf16 v[52:55], v[44:47], a[248:251], v[52:55]
v_mfma_f32_16x16x32_bf16 v[56:59], v[44:47], a[252:255], v[56:59]
s_waitcnt lgkmcnt(0)
v_mfma_f32_16x16x32_bf16 v[60:63], v[48:51], a[248:251], v[60:63]
v_mfma_f32_16x16x32_bf16 v[64:67], v[48:51], a[252:255], v[64:67]
s_add_u32 s42, s42, 1
s_branch mega_kernel_v_loop
mega_kernel_v_fin:
s_nop 11
v_cvt_pk_bf16_f32 v84, v68, v69
v_cvt_pk_bf16_f32 v85, v70, v71
v_cvt_pk_bf16_f32 v86, v76, v77
v_cvt_pk_bf16_f32 v87, v78, v79
v_cvt_pk_bf16_f32 v88, v72, v73
v_cvt_pk_bf16_f32 v89, v74, v75
v_cvt_pk_bf16_f32 v90, v80, v81
v_cvt_pk_bf16_f32 v91, v82, v83
s_add_u32 s51, s42, s47
s_sub_u32 s51, s51, 1
s_bfe_u32 s52, s51, 0x40002
s_lshl_b32 s52, s52, 14
s_and_b32 s51, s51, 3
s_lshl_b32 s51, s51, 11
s_add_u32 s51, s51, s52
s_add_u32 s51, s51, s48
buffer_store_dwordx4 v[84:87], v7, s[84:87], s51 offen sc1
buffer_store_dwordx4 v[88:91], v7, s[84:87], s51 offen offset:1024 sc1
s_waitcnt vmcnt(0)
v_mov_b32 v17, s42
s_mov_b64 exec, 1
buffer_store_dword v17, v16, s[84:87], s49 offen sc1
s_mov_b64 exec, -1
s_waitcnt vmcnt(0)
s_barrier
mega_kernel_fft:
s_mov_b32 s38, s92
s_mov_b32 s39, 64
s_mov_b32 s37, 129
mega_kernel_f2s:
v_mov_b32 v1, 0
s_mov_b32 s82, 69259264
mega_kernel_w0:
s_sleep 8
buffer_load_dword v2, v1, s[84:87], s82 offen sc1
s_waitcnt vmcnt(0)
v_cmp_ne_u32 vcc, 31, v2
s_cbranch_vccnz mega_kernel_w0
s_mov_b32 s48, 0x3f7ec46d
s_mov_b32 s49, 0x3dc8bd36
s_mov_b32 s50, 0x3f7b14be
s_mov_b32 s51, 0x3e47c5c2
s_mov_b32 s52, 0x3f74fa0b
s_mov_b32 s53, 0x3e94a031
s_mov_b32 s54, 0x3f6c835e
s_mov_b32 s55, 0x3ec3ef15
s_mov_b32 s56, 0x3f61c598
s_mov_b32 s57, 0x3ef15aea
s_mov_b32 s58, 0x3f54db31
s_mov_b32 s59, 0x3f0e39da
s_mov_b32 s60, 0x3f45e403
s_mov_b32 s61, 0x3f226799
s_mov_b32 s62, 0x3f3504f3
s_mov_b32 s63, 0x3f3504f3
v_lshrrev_b32 v10, 6, v0
v_and_b32 v1, 63, v0
v_readfirstlane_b32 s16, v10
v_cvt_f32_u32 v2, v1
v_lshlrev_b32 v5, 3, v1
s_mul_i32 s17, s16, 16896
v_add_u32 v3, s17, v5
v_and_b32 v7, 1, v1
v_lshrrev_b32 v6, 1, v1
v_cvt_f32_u32 v8, v6
v_cvt_f32_u32 v10, v7
v_mul_u32_u24 v4, 528, v6
v_lshl_add_u32 v4, v7, 3, v4
v_add_u32 v4, s17, v4
v_lshlrev_b32 v11, 12, v7
v_lshl_add_u32 v11, v6, 2, v11
v_fma_f32 v9, v10, 2.0, -1.0
v_sub_f32 v7, 0, v9
v_mul_f32 v13, v10, v8
v_mul_f32 v13, 0x3a000000, v13
s_mov_b32 s18, 0xaaaaaaaa
s_mov_b32 s19, 0xaaaaaaaa
v_mul_f32 v12, 0xba000000, v2
v_cos_f32 v82, v12
v_sin_f32 v83, v12
v_mul_f32 v12, 0xba800000, v2
v_cos_f32 v84, v12
v_sin_f32 v85, v12
v_mul_f32 v12, 0xbac00000, v2
v_cos_f32 v86, v12
v_sin_f32 v87, v12
v_mul_f32 v12, 0xbb000000, v2
v_cos_f32 v88, v12
v_sin_f32 v89, v12
v_mul_f32 v12, 0xbb200000, v2
v_cos_f32 v90, v12
v_sin_f32 v91, v12
v_mul_f32 v12, 0xbb400000, v2
v_cos_f32 v92, v12
v_sin_f32 v93, v12
v_mul_f32 v12, 0xbb600000, v2
v_cos_f32 v94, v12
v_sin_f32 v95, v12
v_mul_f32 v12, 0xbb800000, v2
v_cos_f32 v96, v12
v_sin_f32 v97, v12
v_mul_f32 v12, 0xbb900000, v2
v_cos_f32 v98, v12
v_sin_f32 v99, v12
v_mul_f32 v12, 0xbba00000, v2
v_cos_f32 v100, v12
v_sin_f32 v101, v12
v_mul_f32 v12, 0xbbb00000, v2
v_cos_f32 v102, v12
v_sin_f32 v103, v12
v_mul_f32 v12, 0xbbc00000, v2
v_cos_f32 v104, v12
v_sin_f32 v105, v12
v_mul_f32 v12, 0xbbd00000, v2
v_cos_f32 v106, v12
v_sin_f32 v107, v12
v_mul_f32 v12, 0xbbe00000, v2
v_cos_f32 v108, v12
v_sin_f32 v109, v12
v_mul_f32 v12, 0xbbf00000, v2
v_cos_f32 v110, v12
v_sin_f32 v111, v12
v_mul_f32 v12, 0xbc000000, v2
v_cos_f32 v112, v12
v_sin_f32 v113, v12
v_mul_f32 v12, 0xbc080000, v2
v_cos_f32 v114, v12
v_sin_f32 v115, v12
v_mul_f32 v12, 0xbc100000, v2
v_cos_f32 v116, v12
v_sin_f32 v117, v12
v_mul_f32 v12, 0xbc180000, v2
v_cos_f32 v118, v12
v_sin_f32 v119, v12
v_mul_f32 v12, 0xbc200000, v2
v_cos_f32 v120, v12
v_sin_f32 v121, v12
v_mul_f32 v12, 0xbc280000, v2
v_cos_f32 v122, v12
v_sin_f32 v123, v12
v_mul_f32 v12, 0xbc300000, v2
v_cos_f32 v124, v12
v_sin_f32 v125, v12
v_mul_f32 v12, 0xbc380000, v2
v_cos_f32 v126, v12
v_sin_f32 v127, v12
v_mul_f32 v12, 0xbc400000, v2
v_cos_f32 v128, v12
v_sin_f32 v129, v12
v_mul_f32 v12, 0xbc480000, v2
v_cos_f32 v130, v12
v_sin_f32 v131, v12
v_mul_f32 v12, 0xbc500000, v2
v_cos_f32 v132, v12
v_sin_f32 v133, v12
v_mul_f32 v12, 0xbc580000, v2
v_cos_f32 v134, v12
v_sin_f32 v135, v12
v_mul_f32 v12, 0xbc600000, v2
v_cos_f32 v136, v12
v_sin_f32 v137, v12
v_mul_f32 v12, 0xbc680000, v2
v_cos_f32 v138, v12
v_sin_f32 v139, v12
v_mul_f32 v12, 0xbc700000, v2
v_cos_f32 v140, v12
v_sin_f32 v141, v12
v_mul_f32 v12, 0xbc780000, v2
v_cos_f32 v142, v12
v_sin_f32 v143, v12
v_mov_b32 v12, v13
v_fmac_f32 v12, 0x00000000, v8
v_cos_f32 v144, v12
v_sin_f32 v145, v12
v_mov_b32 v12, v13
v_fmac_f32 v12, 0x3a800000, v8
v_cos_f32 v146, v12
v_sin_f32 v147, v12
v_mov_b32 v12, v13
v_fmac_f32 v12, 0x3b000000, v8
v_cos_f32 v148, v12
v_sin_f32 v149, v12
v_mov_b32 v12, v13
v_fmac_f32 v12, 0x3b400000, v8
v_cos_f32 v150, v12
v_sin_f32 v151, v12
v_mov_b32 v12, v13
v_fmac_f32 v12, 0x3b800000, v8
v_cos_f32 v152, v12
v_sin_f32 v153, v12
v_mov_b32 v12, v13
v_fmac_f32 v12, 0x3ba00000, v8
v_cos_f32 v154, v12
v_sin_f32 v155, v12
v_mov_b32 v12, v13
v_fmac_f32 v12, 0x3bc00000, v8
v_cos_f32 v156, v12
v_sin_f32 v157, v12
v_mov_b32 v12, v13
v_fmac_f32 v12, 0x3be00000, v8
v_cos_f32 v158, v12
v_sin_f32 v159, v12
v_mov_b32 v12, v13
v_fmac_f32 v12, 0x3c000000, v8
v_cos_f32 v160, v12
v_sin_f32 v161, v12
v_mov_b32 v12, v13
v_fmac_f32 v12, 0x3c100000, v8
v_cos_f32 v162, v12
v_sin_f32 v163, v12
v_mov_b32 v12, v13
v_fmac_f32 v12, 0x3c200000, v8
v_cos_f32 v164, v12
v_sin_f32 v165, v12
v_mov_b32 v12, v13
v_fmac_f32 v12, 0x3c300000, v8
v_cos_f32 v166, v12
v_sin_f32 v167, v12
v_mov_b32 v12, v13
v_fmac_f32 v12, 0x3c400000, v8
v_cos_f32 v168, v12
v_sin_f32 v169, v12
v_mov_b32 v12, v13
v_fmac_f32 v12, 0x3c500000, v8
v_cos_f32 v170, v12
v_sin_f32 v171, v12
v_mov_b32 v12, v13
v_fmac_f32 v12, 0x3c600000, v8
v_cos_f32 v172, v12
v_sin_f32 v173, v12
v_mov_b32 v12, v13
v_fmac_f32 v12, 0x3c700000, v8
v_cos_f32 v174, v12
v_sin_f32 v175, v12
v_mov_b32 v12, v13
v_fmac_f32 v12, 0x3c800000, v8
v_cos_f32 v176, v12
v_sin_f32 v177, v12
v_mov_b32 v12, v13
v_fmac_f32 v12, 0x3c880000, v8
v_cos_f32 v178, v12
v_sin_f32 v179, v12
v_mov_b32 v12, v13
v_fmac_f32 v12, 0x3c900000, v8
v_cos_f32 v180, v12
v_sin_f32 v181, v12
v_mov_b32 v12, v13
v_fmac_f32 v12, 0x3c980000, v8
v_cos_f32 v182, v12
v_sin_f32 v183, v12
v_mov_b32 v12, v13
v_fmac_f32 v12, 0x3ca00000, v8
v_cos_f32 v184, v12
v_sin_f32 v185, v12
v_mov_b32 v12, v13
v_fmac_f32 v12, 0x3ca80000, v8
v_cos_f32 v186, v12
v_sin_f32 v187, v12
v_mov_b32 v12, v13
v_fmac_f32 v12, 0x3cb00000, v8
v_cos_f32 v188, v12
v_sin_f32 v189, v12
v_mov_b32 v12, v13
v_fmac_f32 v12, 0x3cb80000, v8
v_cos_f32 v190, v12
v_sin_f32 v191, v12
v_mov_b32 v12, v13
v_fmac_f32 v12, 0x3cc00000, v8
v_cos_f32 v192, v12
v_sin_f32 v193, v12
v_mov_b32 v12, v13
v_fmac_f32 v12, 0x3cc80000, v8
v_cos_f32 v194, v12
v_sin_f32 v195, v12
v_mov_b32 v12, v13
v_fmac_f32 v12, 0x3cd00000, v8
v_cos_f32 v196, v12
v_sin_f32 v197, v12
v_mov_b32 v12, v13
v_fmac_f32 v12, 0x3cd80000, v8
v_cos_f32 v198, v12
v_sin_f32 v199, v12
v_mov_b32 v12, v13
v_fmac_f32 v12, 0x3ce00000, v8
v_cos_f32 v200, v12
v_sin_f32 v201, v12
v_mov_b32 v12, v13
v_fmac_f32 v12, 0x3ce80000, v8
v_cos_f32 v202, v12
v_sin_f32 v203, v12
v_mov_b32 v12, v13
v_fmac_f32 v12, 0x3cf00000, v8
v_cos_f32 v204, v12
v_sin_f32 v205, v12
v_mov_b32 v12, v13
v_fmac_f32 v12, 0x3cf80000, v8
v_cos_f32 v206, v12
v_sin_f32 v207, v12
s_nop 0
v_mul_f32 v144, 0x34800000, v144
v_mul_f32 v145, 0x34800000, v145
v_mul_f32 v146, 0x34800000, v146
v_mul_f32 v147, 0x34800000, v147
v_mul_f32 v148, 0x34800000, v148
v_mul_f32 v149, 0x34800000, v149
v_mul_f32 v150, 0x34800000, v150
v_mul_f32 v151, 0x34800000, v151
v_mul_f32 v152, 0x34800000, v152
v_mul_f32 v153, 0x34800000, v153
v_mul_f32 v154, 0x34800000, v154
v_mul_f32 v155, 0x34800000, v155
v_mul_f32 v156, 0x34800000, v156
v_mul_f32 v157, 0x34800000, v157
v_mul_f32 v158, 0x34800000, v158
v_mul_f32 v159, 0x34800000, v159
v_mul_f32 v160, 0x34800000, v160
v_mul_f32 v161, 0x34800000, v161
v_mul_f32 v162, 0x34800000, v162
v_mul_f32 v163, 0x34800000, v163
v_mul_f32 v164, 0x34800000, v164
v_mul_f32 v165, 0x34800000, v165
v_mul_f32 v166, 0x34800000, v166
v_mul_f32 v167, 0x34800000, v167
v_mul_f32 v168, 0x34800000, v168
v_mul_f32 v169, 0x34800000, v169
v_mul_f32 v170, 0x34800000, v170
v_mul_f32 v171, 0x34800000, v171
v_mul_f32 v172, 0x34800000, v172
v_mul_f32 v173, 0x34800000, v173
v_mul_f32 v174, 0x34800000, v174
v_mul_f32 v175, 0x34800000, v175
v_mul_f32 v176, 0x34800000, v176
v_mul_f32 v177, 0x34800000, v177
v_mul_f32 v178, 0x34800000, v178
v_mul_f32 v179, 0x34800000, v179
v_mul_f32 v180, 0x34800000, v180
v_mul_f32 v181, 0x34800000, v181
v_mul_f32 v182, 0x34800000, v182
v_mul_f32 v183, 0x34800000, v183
v_mul_f32 v184, 0x34800000, v184
v_mul_f32 v185, 0x34800000, v185
v_mul_f32 v186, 0x34800000, v186
v_mul_f32 v187, 0x34800000, v187
v_mul_f32 v188, 0x34800000, v188
v_mul_f32 v189, 0x34800000, v189
v_mul_f32 v190, 0x34800000, v190
v_mul_f32 v191, 0x34800000, v191
v_mul_f32 v192, 0x34800000, v192
v_mul_f32 v193, 0x34800000, v193
v_mul_f32 v194, 0x34800000, v194
v_mul_f32 v195, 0x34800000, v195
v_mul_f32 v196, 0x34800000, v196
v_mul_f32 v197, 0x34800000, v197
v_mul_f32 v198, 0x34800000, v198
v_mul_f32 v199, 0x34800000, v199
v_mul_f32 v200, 0x34800000, v200
v_mul_f32 v201, 0x34800000, v201
v_mul_f32 v202, 0x34800000, v202
v_mul_f32 v203, 0x34800000, v203
v_mul_f32 v204, 0x34800000, v204
v_mul_f32 v205, 0x34800000, v205
v_mul_f32 v206, 0x34800000, v206
v_mul_f32 v207, 0x34800000, v207
s_cmp_lt_u32 s38, s37
s_cbranch_scc0 mega_kernel_f2_e
s_lshl_b32 s12, s38, 2
s_add_u32 s12, s12, s16
s_min_u32 s12, s12, 512
s_mul_i32 s13, s12, 8192
s_mul_i32 s12, s12, 16384
s_add_u32 s12, s12, 96468992
s_add_u32 s13, s13, 121634816
buffer_load_dwordx2 a[0:1], v5, s[84:87], s12 offen offset:0 sc1
buffer_load_dwordx2 a[2:3], v5, s[84:87], s12 offen offset:512 sc1
buffer_load_dwordx2 a[4:5], v5, s[84:87], s12 offen offset:1024 sc1
buffer_load_dwordx2 a[6:7], v5, s[84:87], s12 offen offset:1536 sc1
buffer_load_dwordx2 a[8:9], v5, s[84:87], s12 offen offset:2048 sc1
buffer_load_dwordx2 a[10:11], v5, s[84:87], s12 offen offset:2560 sc1
buffer_load_dwordx2 a[12:13], v5, s[84:87], s12 offen offset:3072 sc1
buffer_load_dwordx2 a[14:15], v5, s[84:87], s12 offen offset:3584 sc1
s_add_u32 s12, s12, 4096
buffer_load_dwordx2 a[16:17], v5, s[84:87], s12 offen offset:0 sc1
buffer_load_dwordx2 a[18:19], v5, s[84:87], s12 offen offset:512 sc1
buffer_load_dwordx2 a[20:21], v5, s[84:87], s12 offen offset:1024 sc1
buffer_load_dwordx2 a[22:23], v5, s[84:87], s12 offen offset:1536 sc1
buffer_load_dwordx2 a[24:25], v5, s[84:87], s12 offen offset:2048 sc1
buffer_load_dwordx2 a[26:27], v5, s[84:87], s12 offen offset:2560 sc1
buffer_load_dwordx2 a[28:29], v5, s[84:87], s12 offen offset:3072 sc1
buffer_load_dwordx2 a[30:31], v5, s[84:87], s12 offen offset:3584 sc1
s_add_u32 s12, s12, 4096
buffer_load_dwordx2 a[32:33], v5, s[84:87], s12 offen offset:0 sc1
buffer_load_dwordx2 a[34:35], v5, s[84:87], s12 offen offset:512 sc1
buffer_load_dwordx2 a[36:37], v5, s[84:87], s12 offen offset:1024 sc1
buffer_load_dwordx2 a[38:39], v5, s[84:87], s12 offen offset:1536 sc1
buffer_load_dwordx2 a[40:41], v5, s[84:87], s12 offen offset:2048 sc1
buffer_load_dwordx2 a[42:43], v5, s[84:87], s12 offen offset:2560 sc1
buffer_load_dwordx2 a[44:45], v5, s[84:87], s12 offen offset:3072 sc1
buffer_load_dwordx2 a[46:47], v5, s[84:87], s12 offen offset:3584 sc1
s_add_u32 s12, s12, 4096
buffer_load_dwordx2 a[48:49], v5, s[84:87], s12 offen offset:0 sc1
buffer_load_dwordx2 a[50:51], v5, s[84:87], s12 offen offset:512 sc1
buffer_load_dwordx2 a[52:53], v5, s[84:87], s12 offen offset:1024 sc1
buffer_load_dwordx2 a[54:55], v5, s[84:87], s12 offen offset:1536 sc1
buffer_load_dwordx2 a[56:57], v5, s[84:87], s12 offen offset:2048 sc1
buffer_load_dwordx2 a[58:59], v5, s[84:87], s12 offen offset:2560 sc1
buffer_load_dwordx2 a[60:61], v5, s[84:87], s12 offen offset:3072 sc1
buffer_load_dwordx2 a[62:63], v5, s[84:87], s12 offen offset:3584 sc1
s_add_u32 s12, s12, 4096
buffer_load_dword a64, v11, s[84:87], s13 offen offset:0 sc1
buffer_load_dword a65, v11, s[84:87], s13 offen offset:128 sc1
buffer_load_dword a66, v11, s[84:87], s13 offen offset:256 sc1
buffer_load_dword a67, v11, s[84:87], s13 offen offset:384 sc1
buffer_load_dword a68, v11, s[84:87], s13 offen offset:512 sc1
buffer_load_dword a69, v11, s[84:87], s13 offen offset:640 sc1
buffer_load_dword a70, v11, s[84:87], s13 offen offset:768 sc1
buffer_load_dword a71, v11, s[84:87], s13 offen offset:896 sc1
buffer_load_dword a72, v11, s[84:87], s13 offen offset:1024 sc1
buffer_load_dword a73, v11, s[84:87], s13 offen offset:1152 sc1
buffer_load_dword a74, v11, s[84:87], s13 offen offset:1280 sc1
buffer_load_dword a75, v11, s[84:87], s13 offen offset:1408 sc1
buffer_load_dword a76, v11, s[84:87], s13 offen offset:1536 sc1
buffer_load_dword a77, v11, s[84:87], s13 offen offset:1664 sc1
buffer_load_dword a78, v11, s[84:87], s13 offen offset:1792 sc1
buffer_load_dword a79, v11, s[84:87], s13 offen offset:1920 sc1
buffer_load_dword a80, v11, s[84:87], s13 offen offset:2048 sc1
buffer_load_dword a81, v11, s[84:87], s13 offen offset:2176 sc1
buffer_load_dword a82, v11, s[84:87], s13 offen offset:2304 sc1
buffer_load_dword a83, v11, s[84:87], s13 offen offset:2432 sc1
buffer_load_dword a84, v11, s[84:87], s13 offen offset:2560 sc1
buffer_load_dword a85, v11, s[84:87], s13 offen offset:2688 sc1
buffer_load_dword a86, v11, s[84:87], s13 offen offset:2816 sc1
buffer_load_dword a87, v11, s[84:87], s13 offen offset:2944 sc1
buffer_load_dword a88, v11, s[84:87], s13 offen offset:3072 sc1
buffer_load_dword a89, v11, s[84:87], s13 offen offset:3200 sc1
buffer_load_dword a90, v11, s[84:87], s13 offen offset:3328 sc1
buffer_load_dword a91, v11, s[84:87], s13 offen offset:3456 sc1
buffer_load_dword a92, v11, s[84:87], s13 offen offset:3584 sc1
buffer_load_dword a93, v11, s[84:87], s13 offen offset:3712 sc1
buffer_load_dword a94, v11, s[84:87], s13 offen offset:3840 sc1
buffer_load_dword a95, v11, s[84:87], s13 offen offset:3968 sc1
s_waitcnt vmcnt(0)
mega_kernel_f2_l:
s_add_u32 s21, s38, s39
s_cmp_lt_u32 s21, s37
s_cselect_b32 s22, s21, s38
s_waitcnt vmcnt(32)
v_accvgpr_read_b32 v16, a0
v_accvgpr_read_b32 v17, a1
v_accvgpr_read_b32 v18, a2
v_accvgpr_read_b32 v19, a3
v_accvgpr_read_b32 v20, a4
v_accvgpr_read_b32 v21, a5
v_accvgpr_read_b32 v22, a6
v_accvgpr_read_b32 v23, a7
v_accvgpr_read_b32 v24, a8
v_accvgpr_read_b32 v25, a9
v_accvgpr_read_b32 v26, a10
v_accvgpr_read_b32 v27, a11
v_accvgpr_read_b32 v28, a12
v_accvgpr_read_b32 v29, a13
v_accvgpr_read_b32 v30, a14
v_accvgpr_read_b32 v31, a15
v_accvgpr_read_b32 v32, a16
v_accvgpr_read_b32 v33, a17
v_accvgpr_read_b32 v34, a18
v_accvgpr_read_b32 v35, a19
v_accvgpr_read_b32 v36, a20
v_accvgpr_read_b32 v37, a21
v_accvgpr_read_b32 v38, a22
v_accvgpr_read_b32 v39, a23
v_accvgpr_read_b32 v40, a24
v_accvgpr_read_b32 v41, a25
v_accvgpr_read_b32 v42, a26
v_accvgpr_read_b32 v43, a27
v_accvgpr_read_b32 v44, a28
v_accvgpr_read_b32 v45, a29
v_accvgpr_read_b32 v46, a30
v_accvgpr_read_b32 v47, a31
v_accvgpr_read_b32 v48, a32
v_accvgpr_read_b32 v49, a33
v_accvgpr_read_b32 v50, a34
v_accvgpr_read_b32 v51, a35
v_accvgpr_read_b32 v52, a36
v_accvgpr_read_b32 v53, a37
v_accvgpr_read_b32 v54, a38
v_accvgpr_read_b32 v55, a39
v_accvgpr_read_b32 v56, a40
v_accvgpr_read_b32 v57, a41
v_accvgpr_read_b32 v58, a42
v_accvgpr_read_b32 v59, a43
v_accvgpr_read_b32 v60, a44
v_accvgpr_read_b32 v61, a45
v_accvgpr_read_b32 v62, a46
v_accvgpr_read_b32 v63, a47
v_accvgpr_read_b32 v64, a48
v_accvgpr_read_b32 v65, a49
v_accvgpr_read_b32 v66, a50
v_accvgpr_read_b32 v67, a51
v_accvgpr_read_b32 v68, a52
v_accvgpr_read_b32 v69, a53
v_accvgpr_read_b32 v70, a54
v_accvgpr_read_b32 v71, a55
v_accvgpr_read_b32 v72, a56
v_accvgpr_read_b32 v73, a57
v_accvgpr_read_b32 v74, a58
v_accvgpr_read_b32 v75, a59
v_accvgpr_read_b32 v76, a60
v_accvgpr_read_b32 v77, a61
v_accvgpr_read_b32 v78, a62
v_accvgpr_read_b32 v79, a63
v_accvgpr_read_b32 v208, a64
v_accvgpr_read_b32 v209, a65
v_accvgpr_read_b32 v210, a66
v_accvgpr_read_b32 v211, a67
v_accvgpr_read_b32 v212, a68
v_accvgpr_read_b32 v213, a69
v_accvgpr_read_b32 v214, a70
v_accvgpr_read_b32 v215, a71
v_accvgpr_read_b32 v216, a72
v_accvgpr_read_b32 v217, a73
v_accvgpr_read_b32 v218, a74
v_accvgpr_read_b32 v219, a75
v_accvgpr_read_b32 v220, a76
v_accvgpr_read_b32 v221, a77
v_accvgpr_read_b32 v222, a78
v_accvgpr_read_b32 v223, a79
v_accvgpr_read_b32 v224, a80
v_accvgpr_read_b32 v225, a81
v_accvgpr_read_b32 v226, a82
v_accvgpr_read_b32 v227, a83
v_accvgpr_read_b32 v228, a84
v_accvgpr_read_b32 v229, a85
v_accvgpr_read_b32 v230, a86
v_accvgpr_read_b32 v231, a87
v_accvgpr_read_b32 v232, a88
v_accvgpr_read_b32 v233, a89
v_accvgpr_read_b32 v234, a90
v_accvgpr_read_b32 v235, a91
v_accvgpr_read_b32 v236, a92
v_accvgpr_read_b32 v237, a93
v_accvgpr_read_b32 v238, a94
v_accvgpr_read_b32 v239, a95
s_lshl_b32 s12, s22, 2
s_add_u32 s12, s12, s16
s_min_u32 s12, s12, 512
s_mul_i32 s13, s12, 8192
s_mul_i32 s12, s12, 16384
s_add_u32 s12, s12, 96468992
s_add_u32 s13, s13, 121634816
buffer_load_dwordx2 a[0:1], v5, s[84:87], s12 offen offset:0 sc1
buffer_load_dwordx2 a[2:3], v5, s[84:87], s12 offen offset:512 sc1
buffer_load_dwordx2 a[4:5], v5, s[84:87], s12 offen offset:1024 sc1
buffer_load_dwordx2 a[6:7], v5, s[84:87], s12 offen offset:1536 sc1
buffer_load_dwordx2 a[8:9], v5, s[84:87], s12 offen offset:2048 sc1
buffer_load_dwordx2 a[10:11], v5, s[84:87], s12 offen offset:2560 sc1
buffer_load_dwordx2 a[12:13], v5, s[84:87], s12 offen offset:3072 sc1
buffer_load_dwordx2 a[14:15], v5, s[84:87], s12 offen offset:3584 sc1
s_add_u32 s12, s12, 4096
buffer_load_dwordx2 a[16:17], v5, s[84:87], s12 offen offset:0 sc1
buffer_load_dwordx2 a[18:19], v5, s[84:87], s12 offen offset:512 sc1
buffer_load_dwordx2 a[20:21], v5, s[84:87], s12 offen offset:1024 sc1
buffer_load_dwordx2 a[22:23], v5, s[84:87], s12 offen offset:1536 sc1
buffer_load_dwordx2 a[24:25], v5, s[84:87], s12 offen offset:2048 sc1
buffer_load_dwordx2 a[26:27], v5, s[84:87], s12 offen offset:2560 sc1
buffer_load_dwordx2 a[28:29], v5, s[84:87], s12 offen offset:3072 sc1
buffer_load_dwordx2 a[30:31], v5, s[84:87], s12 offen offset:3584 sc1
s_add_u32 s12, s12, 4096
buffer_load_dwordx2 a[32:33], v5, s[84:87], s12 offen offset:0 sc1
buffer_load_dwordx2 a[34:35], v5, s[84:87], s12 offen offset:512 sc1
buffer_load_dwordx2 a[36:37], v5, s[84:87], s12 offen offset:1024 sc1
buffer_load_dwordx2 a[38:39], v5, s[84:87], s12 offen offset:1536 sc1
buffer_load_dwordx2 a[40:41], v5, s[84:87], s12 offen offset:2048 sc1
buffer_load_dwordx2 a[42:43], v5, s[84:87], s12 offen offset:2560 sc1
buffer_load_dwordx2 a[44:45], v5, s[84:87], s12 offen offset:3072 sc1
buffer_load_dwordx2 a[46:47], v5, s[84:87], s12 offen offset:3584 sc1
s_add_u32 s12, s12, 4096
buffer_load_dwordx2 a[48:49], v5, s[84:87], s12 offen offset:0 sc1
buffer_load_dwordx2 a[50:51], v5, s[84:87], s12 offen offset:512 sc1
buffer_load_dwordx2 a[52:53], v5, s[84:87], s12 offen offset:1024 sc1
buffer_load_dwordx2 a[54:55], v5, s[84:87], s12 offen offset:1536 sc1
buffer_load_dwordx2 a[56:57], v5, s[84:87], s12 offen offset:2048 sc1
buffer_load_dwordx2 a[58:59], v5, s[84:87], s12 offen offset:2560 sc1
buffer_load_dwordx2 a[60:61], v5, s[84:87], s12 offen offset:3072 sc1
buffer_load_dwordx2 a[62:63], v5, s[84:87], s12 offen offset:3584 sc1
s_add_u32 s12, s12, 4096
buffer_load_dword a64, v11, s[84:87], s13 offen offset:0 sc1
buffer_load_dword a65, v11, s[84:87], s13 offen offset:128 sc1
buffer_load_dword a66, v11, s[84:87], s13 offen offset:256 sc1
buffer_load_dword a67, v11, s[84:87], s13 offen offset:384 sc1
buffer_load_dword a68, v11, s[84:87], s13 offen offset:512 sc1
buffer_load_dword a69, v11, s[84:87], s13 offen offset:640 sc1
buffer_load_dword a70, v11, s[84:87], s13 offen offset:768 sc1
buffer_load_dword a71, v11, s[84:87], s13 offen offset:896 sc1
buffer_load_dword a72, v11, s[84:87], s13 offen offset:1024 sc1
buffer_load_dword a73, v11, s[84:87], s13 offen offset:1152 sc1
buffer_load_dword a74, v11, s[84:87], s13 offen offset:1280 sc1
buffer_load_dword a75, v11, s[84:87], s13 offen offset:1408 sc1
buffer_load_dword a76, v11, s[84:87], s13 offen offset:1536 sc1
buffer_load_dword a77, v11, s[84:87], s13 offen offset:1664 sc1
buffer_load_dword a78, v11, s[84:87], s13 offen offset:1792 sc1
buffer_load_dword a79, v11, s[84:87], s13 offen offset:1920 sc1
buffer_load_dword a80, v11, s[84:87], s13 offen offset:2048 sc1
buffer_load_dword a81, v11, s[84:87], s13 offen offset:2176 sc1
buffer_load_dword a82, v11, s[84:87], s13 offen offset:2304 sc1
buffer_load_dword a83, v11, s[84:87], s13 offen offset:2432 sc1
buffer_load_dword a84, v11, s[84:87], s13 offen offset:2560 sc1
buffer_load_dword a85, v11, s[84:87], s13 offen offset:2688 sc1
buffer_load_dword a86, v11, s[84:87], s13 offen offset:2816 sc1
buffer_load_dword a87, v11, s[84:87], s13 offen offset:2944 sc1
buffer_load_dword a88, v11, s[84:87], s13 offen offset:3072 sc1
buffer_load_dword a89, v11, s[84:87], s13 offen offset:3200 sc1
buffer_load_dword a90, v11, s[84:87], s13 offen offset:3328 sc1
buffer_load_dword a91, v11, s[84:87], s13 offen offset:3456 sc1
buffer_load_dword a92, v11, s[84:87], s13 offen offset:3584 sc1
buffer_load_dword a93, v11, s[84:87], s13 offen offset:3712 sc1
buffer_load_dword a94, v11, s[84:87], s13 offen offset:3840 sc1
buffer_load_dword a95, v11, s[84:87], s13 offen offset:3968 sc1
v_pk_add_f32 v[14:15], v[16:17], v[48:49] neg_lo:[0,1] neg_hi:[0,1]
v_pk_add_f32 v[16:17], v[16:17], v[48:49]
v_pk_add_f32 v[48:49], v[18:19], v[50:51] neg_lo:[0,1] neg_hi:[0,1]
v_pk_add_f32 v[18:19], v[18:19], v[50:51]
v_pk_mul_f32 v[50:51], v[48:49], s[50:51] op_sel:[0,0] op_sel_hi:[0,1] neg_lo:[0,0] neg_hi:[0,1]
v_pk_fma_f32 v[50:51], v[48:49], s[50:51], v[50:51] op_sel:[1,1,0] op_sel_hi:[1,0,1] neg_lo:[0,0,0] neg_hi:[0,0,0]
v_pk_add_f32 v[48:49], v[20:21], v[52:53] neg_lo:[0,1] neg_hi:[0,1]
v_pk_add_f32 v[20:21], v[20:21], v[52:53]
v_pk_mul_f32 v[52:53], v[48:49], s[54:55] op_sel:[0,0] op_sel_hi:[0,1] neg_lo:[0,0] neg_hi:[0,1]
v_pk_fma_f32 v[52:53], v[48:49], s[54:55], v[52:53] op_sel:[1,1,0] op_sel_hi:[1,0,1] neg_lo:[0,0,0] neg_hi:[0,0,0]
v_pk_add_f32 v[48:49], v[22:23], v[54:55] neg_lo:[0,1] neg_hi:[0,1]
v_pk_add_f32 v[22:23], v[22:23], v[54:55]
v_pk_mul_f32 v[54:55], v[48:49], s[58:59] op_sel:[0,0] op_sel_hi:[0,1] neg_lo:[0,0] neg_hi:[0,1]
v_pk_fma_f32 v[54:55], v[48:49], s[58:59], v[54:55] op_sel:[1,1,0] op_sel_hi:[1,0,1] neg_lo:[0,0,0] neg_hi:[0,0,0]
v_pk_add_f32 v[48:49], v[24:25], v[56:57] neg_lo:[0,1] neg_hi:[0,1]
v_pk_add_f32 v[24:25], v[24:25], v[56:57]
v_pk_mul_f32 v[56:57], v[48:49], s[62:63] op_sel:[0,0] op_sel_hi:[0,1] neg_lo:[0,0] neg_hi:[0,1]
v_pk_fma_f32 v[56:57], v[48:49], s[62:63], v[56:57] op_sel:[1,1,0] op_sel_hi:[1,0,1] neg_lo:[0,0,0] neg_hi:[0,0,0]
v_pk_add_f32 v[48:49], v[26:27], v[58:59] neg_lo:[0,1] neg_hi:[0,1]
v_pk_add_f32 v[26:27], v[26:27], v[58:59]
v_pk_mul_f32 v[58:59], v[48:49], s[58:59] op_sel:[0,1] op_sel_hi:[0,0] neg_lo:[0,0] neg_hi:[0,1]
v_pk_fma_f32 v[58:59], v[48:49], s[58:59], v[58:59] op_sel:[1,0,0] op_sel_hi:[1,1,1] neg_lo:[0,0,0] neg_hi:[0,0,0]
v_pk_add_f32 v[48:49], v[28:29], v[60:61] neg_lo:[0,1] neg_hi:[0,1]
v_pk_add_f32 v[28:29], v[28:29], v[60:61]
v_pk_mul_f32 v[60:61], v[48:49], s[54:55] op_sel:[0,1] op_sel_hi:[0,0] neg_lo:[0,0] neg_hi:[0,1]
v_pk_fma_f32 v[60:61], v[48:49], s[54:55], v[60:61] op_sel:[1,0,0] op_sel_hi:[1,1,1] neg_lo:[0,0,0] neg_hi:[0,0,0]
v_pk_add_f32 v[48:49], v[30:31], v[62:63] neg_lo:[0,1] neg_hi:[0,1]
v_pk_add_f32 v[30:31], v[30:31], v[62:63]
v_pk_mul_f32 v[62:63], v[48:49], s[50:51] op_sel:[0,1] op_sel_hi:[0,0] neg_lo:[0,0] neg_hi:[0,1]
v_pk_fma_f32 v[62:63], v[48:49], s[50:51], v[62:63] op_sel:[1,0,0] op_sel_hi:[1,1,1] neg_lo:[0,0,0] neg_hi:[0,0,0]
v_pk_add_f32 v[48:49], v[32:33], v[64:65] op_sel:[1,1] op_sel_hi:[0,0] neg_lo:[0,1] neg_hi:[1,0]
v_pk_add_f32 v[32:33], v[32:33], v[64:65]
v_pk_add_f32 v[64:65], v[34:35], v[66:67] neg_lo:[0,1] neg_hi:[0,1]
v_pk_add_f32 v[34:35], v[34:35], v[66:67]
v_pk_mul_f32 v[66:67], v[64:65], s[50:51] op_sel:[0,1] op_sel_hi:[0,0] neg_lo:[0,1] neg_hi:[0,1]
v_pk_fma_f32 v[66:67], v[64:65], s[50:51], v[66:67] op_sel:[1,0,0] op_sel_hi:[1,1,1] neg_lo:[0,0,0] neg_hi:[0,1,0]
v_pk_add_f32 v[64:65], v[36:37], v[68:69] neg_lo:[0,1] neg_hi:[0,1]
v_pk_add_f32 v[36:37], v[36:37], v[68:69]
v_pk_mul_f32 v[68:69], v[64:65], s[54:55] op_sel:[0,1] op_sel_hi:[0,0] neg_lo:[0,1] neg_hi:[0,1]
v_pk_fma_f32 v[68:69], v[64:65], s[54:55], v[68:69] op_sel:[1,0,0] op_sel_hi:[1,1,1] neg_lo:[0,0,0] neg_hi:[0,1,0]
v_pk_add_f32 v[64:65], v[38:39], v[70:71] neg_lo:[0,1] neg_hi:[0,1]
v_pk_add_f32 v[38:39], v[38:39], v[70:71]
v_pk_mul_f32 v[70:71], v[64:65], s[58:59] op_sel:[0,1] op_sel_hi:[0,0] neg_lo:[0,1] neg_hi:[0,1]
v_pk_fma_f32 v[70:71], v[64:65], s[58:59], v[70:71] op_sel:[1,0,0] op_sel_hi:[1,1,1] neg_lo:[0,0,0] neg_hi:[0,1,0]
v_pk_add_f32 v[64:65], v[40:41], v[72:73] neg_lo:[0,1] neg_hi:[0,1]
v_pk_add_f32 v[40:41], v[40:41], v[72:73]
v_pk_mul_f32 v[72:73], v[64:65], s[62:63] op_sel:[0,0] op_sel_hi:[0,1] neg_lo:[0,1] neg_hi:[0,1]
v_pk_fma_f32 v[72:73], v[64:65], s[62:63], v[72:73] op_sel:[1,1,0] op_sel_hi:[1,0,1] neg_lo:[0,0,0] neg_hi:[0,1,0]
v_pk_add_f32 v[64:65], v[42:43], v[74:75] neg_lo:[0,1] neg_hi:[0,1]
v_pk_add_f32 v[42:43], v[42:43], v[74:75]
v_pk_mul_f32 v[74:75], v[64:65], s[58:59] op_sel:[0,0] op_sel_hi:[0,1] neg_lo:[0,1] neg_hi:[0,1]
v_pk_fma_f32 v[74:75], v[64:65], s[58:59], v[74:75] op_sel:[1,1,0] op_sel_hi:[1,0,1] neg_lo:[0,0,0] neg_hi:[0,1,0]
v_pk_add_f32 v[64:65], v[44:45], v[76:77] neg_lo:[0,1] neg_hi:[0,1]
v_pk_add_f32 v[44:45], v[44:45], v[76:77]
v_pk_mul_f32 v[76:77], v[64:65], s[54:55] op_sel:[0,0] op_sel_hi:[0,1] neg_lo:[0,1] neg_hi:[0,1]
v_pk_fma_f32 v[76:77], v[64:65], s[54:55], v[76:77] op_sel:[1,1,0] op_sel_hi:[1,0,1] neg_lo:[0,0,0] neg_hi:[0,1,0]
v_pk_add_f32 v[64:65], v[46:47], v[78:79] neg_lo:[0,1] neg_hi:[0,1]
v_pk_add_f32 v[46:47], v[46:47], v[78:79]
v_pk_mul_f32 v[78:79], v[64:65], s[50:51] op_sel:[0,0] op_sel_hi:[0,1] neg_lo:[0,1] neg_hi:[0,1]
v_pk_fma_f32 v[78:79], v[64:65], s[50:51], v[78:79] op_sel:[1,1,0] op_sel_hi:[1,0,1] neg_lo:[0,0,0] neg_hi:[0,1,0]
v_pk_add_f32 v[64:65], v[16:17], v[32:33] neg_lo:[0,1] neg_hi:[0,1]
v_pk_add_f32 v[16:17], v[16:17], v[32:33]
v_pk_add_f32 v[32:33], v[18:19], v[34:35] neg_lo:[0,1] neg_hi:[0,1]
v_pk_add_f32 v[18:19], v[18:19], v[34:35]
v_pk_mul_f32 v[34:35], v[32:33], s[54:55] op_sel:[0,0] op_sel_hi:[0,1] neg_lo:[0,0] neg_hi:[0,1]
v_pk_fma_f32 v[34:35], v[32:33], s[54:55], v[34:35] op_sel:[1,1,0] op_sel_hi:[1,0,1] neg_lo:[0,0,0] neg_hi:[0,0,0]
v_pk_add_f32 v[32:33], v[20:21], v[36:37] neg_lo:[0,1] neg_hi:[0,1]
v_pk_add_f32 v[20:21], v[20:21], v[36:37]
v_pk_mul_f32 v[36:37], v[32:33], s[62:63] op_sel:[0,0] op_sel_hi:[0,1] neg_lo:[0,0] neg_hi:[0,1]
v_pk_fma_f32 v[36:37], v[32:33], s[62:63], v[36:37] op_sel:[1,1,0] op_sel_hi:[1,0,1] neg_lo:[0,0,0] neg_hi:[0,0,0]
v_pk_add_f32 v[32:33], v[22:23], v[38:39] neg_lo:[0,1] neg_hi:[0,1]
v_pk_add_f32 v[22:23], v[22:23], v[38:39]
v_pk_mul_f32 v[38:39], v[32:33], s[54:55] op_sel:[0,1] op_sel_hi:[0,0] neg_lo:[0,0] neg_hi:[0,1]
v_pk_fma_f32 v[38:39], v[32:33], s[54:55], v[38:39] op_sel:[1,0,0] op_sel_hi:[1,1,1] neg_lo:[0,0,0] neg_hi:[0,0,0]
v_pk_add_f32 v[32:33], v[24:25], v[40:41] op_sel:[1,1] op_sel_hi:[0,0] neg_lo:[0,1] neg_hi:[1,0]
v_pk_add_f32 v[24:25], v[24:25], v[40:41]
v_pk_add_f32 v[40:41], v[26:27], v[42:43] neg_lo:[0,1] neg_hi:[0,1]
v_pk_add_f32 v[26:27], v[26:27], v[42:43]
v_pk_mul_f32 v[42:43], v[40:41], s[54:55] op_sel:[0,1] op_sel_hi:[0,0] neg_lo:[0,1] neg_hi:[0,1]
v_pk_fma_f32 v[42:43], v[40:41], s[54:55], v[42:43] op_sel:[1,0,0] op_sel_hi:[1,1,1] neg_lo:[0,0,0] neg_hi:[0,1,0]
v_pk_add_f32 v[40:41], v[28:29], v[44:45] neg_lo:[0,1] neg_hi:[0,1]
v_pk_add_f32 v[28:29], v[28:29], v[44:45]
v_pk_mul_f32 v[44:45], v[40:41], s[62:63] op_sel:[0,0] op_sel_hi:[0,1] neg_lo:[0,1] neg_hi:[0,1]
v_pk_fma_f32 v[44:45], v[40:41], s[62:63], v[44:45] op_sel:[1,1,0] op_sel_hi:[1,0,1] neg_lo:[0,0,0] neg_hi:[0,1,0]
v_pk_add_f32 v[40:41], v[30:31], v[46:47] neg_lo:[0,1] neg_hi:[0,1]
v_pk_add_f32 v[30:31], v[30:31], v[46:47]
v_pk_mul_f32 v[46:47], v[40:41], s[54:55] op_sel:[0,0] op_sel_hi:[0,1] neg_lo:[0,1] neg_hi:[0,1]
v_pk_fma_f32 v[46:47], v[40:41], s[54:55], v[46:47] op_sel:[1,1,0] op_sel_hi:[1,0,1] neg_lo:[0,0,0] neg_hi:[0,1,0]
v_pk_add_f32 v[40:41], v[14:15], v[48:49] neg_lo:[0,1] neg_hi:[0,1]
v_pk_add_f32 v[14:15], v[14:15], v[48:49]
v_pk_add_f32 v[48:49], v[50:51], v[66:67] neg_lo:[0,1] neg_hi:[0,1]
v_pk_add_f32 v[50:51], v[50:51], v[66:67]
v_pk_mul_f32 v[66:67], v[48:49], s[54:55] op_sel:[0,0] op_sel_hi:[0,1] neg_lo:[0,0] neg_hi:[0,1]
v_pk_fma_f32 v[66:67], v[48:49], s[54:55], v[66:67] op_sel:[1,1,0] op_sel_hi:[1,0,1] neg_lo:[0,0,0] neg_hi:[0,0,0]
v_pk_add_f32 v[48:49], v[52:53], v[68:69] neg_lo:[0,1] neg_hi:[0,1]
v_pk_add_f32 v[52:53], v[52:53], v[68:69]
v_pk_mul_f32 v[68:69], v[48:49], s[62:63] op_sel:[0,0] op_sel_hi:[0,1] neg_lo:[0,0] neg_hi:[0,1]
v_pk_fma_f32 v[68:69], v[48:49], s[62:63], v[68:69] op_sel:[1,1,0] op_sel_hi:[1,0,1] neg_lo:[0,0,0] neg_hi:[0,0,0]
v_pk_add_f32 v[48:49], v[54:55], v[70:71] neg_lo:[0,1] neg_hi:[0,1]
v_pk_add_f32 v[54:55], v[54:55], v[70:71]
v_pk_mul_f32 v[70:71], v[48:49], s[54:55] op_sel:[0,1] op_sel_hi:[0,0] neg_lo:[0,0] neg_hi:[0,1]
v_pk_fma_f32 v[70:71], v[48:49], s[54:55], v[70:71] op_sel:[1,0,0] op_sel_hi:[1,1,1] neg_lo:[0,0,0] neg_hi:[0,0,0]
v_pk_add_f32 v[48:49], v[56:57], v[72:73] op_sel:[1,1] op_sel_hi:[0,0] neg_lo:[0,1] neg_hi:[1,0]
v_pk_add_f32 v[56:57], v[56:57], v[72:73]
v_pk_add_f32 v[72:73], v[58:59], v[74:75] neg_lo:[0,1] neg_hi:[0,1]
v_pk_add_f32 v[58:59], v[58:59], v[74:75]
v_pk_mul_f32 v[74:75], v[72:73], s[54:55] op_sel:[0,1] op_sel_hi:[0,0] neg_lo:[0,1] neg_hi:[0,1]
v_pk_fma_f32 v[74:75], v[72:73], s[54:55], v[74:75] op_sel:[1,0,0] op_sel_hi:[1,1,1] neg_lo:[0,0,0] neg_hi:[0,1,0]
v_pk_add_f32 v[72:73], v[60:61], v[76:77] neg_lo:[0,1] neg_hi:[0,1]
v_pk_add_f32 v[60:61], v[60:61], v[76:77]
v_pk_mul_f32 v[76:77], v[72:73], s[62:63] op_sel:[0,0] op_sel_hi:[0,1] neg_lo:[0,1] neg_hi:[0,1]
v_pk_fma_f32 v[76:77], v[72:73], s[62:63], v[76:77] op_sel:[1,1,0] op_sel_hi:[1,0,1] neg_lo:[0,0,0] neg_hi:[0,1,0]
v_pk_add_f32 v[72:73], v[62:63], v[78:79] neg_lo:[0,1] neg_hi:[0,1]
v_pk_add_f32 v[62:63], v[62:63], v[78:79]
v_pk_mul_f32 v[78:79], v[72:73], s[54:55] op_sel:[0,0] op_sel_hi:[0,1] neg_lo:[0,1] neg_hi:[0,1]
v_pk_fma_f32 v[78:79], v[72:73], s[54:55], v[78:79] op_sel:[1,1,0] op_sel_hi:[1,0,1] neg_lo:[0,0,0] neg_hi:[0,1,0]
v_pk_add_f32 v[72:73], v[16:17], v[24:25] neg_lo:[0,1] neg_hi:[0,1]
v_pk_add_f32 v[16:17], v[16:17], v[24:25]
v_pk_add_f32 v[24:25], v[18:19], v[26:27] neg_lo:[0,1] neg_hi:[0,1]
v_pk_add_f32 v[18:19], v[18:19], v[26:27]
v_pk_mul_f32 v[26:27], v[24:25], s[62:63] op_sel:[0,0] op_sel_hi:[0,1] neg_lo:[0,0] neg_hi:[0,1]
v_pk_fma_f32 v[26:27], v[24:25], s[62:63], v[26:27] op_sel:[1,1,0] op_sel_hi:[1,0,1] neg_lo:[0,0,0] neg_hi:[0,0,0]
v_pk_add_f32 v[24:25], v[20:21], v[28:29] op_sel:[1,1] op_sel_hi:[0,0] neg_lo:[0,1] neg_hi:[1,0]
v_pk_add_f32 v[20:21], v[20:21], v[28:29]
v_pk_add_f32 v[28:29], v[22:23], v[30:31] neg_lo:[0,1] neg_hi:[0,1]
v_pk_add_f32 v[22:23], v[22:23], v[30:31]
v_pk_mul_f32 v[30:31], v[28:29], s[62:63] op_sel:[0,0] op_sel_hi:[0,1] neg_lo:[0,1] neg_hi:[0,1]
v_pk_fma_f32 v[30:31], v[28:29], s[62:63], v[30:31] op_sel:[1,1,0] op_sel_hi:[1,0,1] neg_lo:[0,0,0] neg_hi:[0,1,0]
v_pk_add_f32 v[28:29], v[64:65], v[32:33] neg_lo:[0,1] neg_hi:[0,1]
v_pk_add_f32 v[64:65], v[64:65], v[32:33]
v_pk_add_f32 v[32:33], v[34:35], v[42:43] neg_lo:[0,1] neg_hi:[0,1]
v_pk_add_f32 v[34:35], v[34:35], v[42:43]
v_pk_mul_f32 v[42:43], v[32:33], s[62:63] op_sel:[0,0] op_sel_hi:[0,1] neg_lo:[0,0] neg_hi:[0,1]
v_pk_fma_f32 v[42:43], v[32:33], s[62:63], v[42:43] op_sel:[1,1,0] op_sel_hi:[1,0,1] neg_lo:[0,0,0] neg_hi:[0,0,0]
v_pk_add_f32 v[32:33], v[36:37], v[44:45] op_sel:[1,1] op_sel_hi:[0,0] neg_lo:[0,1] neg_hi:[1,0]
v_pk_add_f32 v[36:37], v[36:37], v[44:45]
v_pk_add_f32 v[44:45], v[38:39], v[46:47] neg_lo:[0,1] neg_hi:[0,1]
v_pk_add_f32 v[38:39], v[38:39], v[46:47]
v_pk_mul_f32 v[46:47], v[44:45], s[62:63] op_sel:[0,0] op_sel_hi:[0,1] neg_lo:[0,1] neg_hi:[0,1]
v_pk_fma_f32 v[46:47], v[44:45], s[62:63], v[46:47] op_sel:[1,1,0] op_sel_hi:[1,0,1] neg_lo:[0,0,0] neg_hi:[0,1,0]
v_pk_add_f32 v[44:45], v[14:15], v[56:57] neg_lo:[0,1] neg_hi:[0,1]
v_pk_add_f32 v[14:15], v[14:15], v[56:57]
v_pk_add_f32 v[56:57], v[50:51], v[58:59] neg_lo:[0,1] neg_hi:[0,1]
v_pk_add_f32 v[50:51], v[50:51], v[58:59]
v_pk_mul_f32 v[58:59], v[56:57], s[62:63] op_sel:[0,0] op_sel_hi:[0,1] neg_lo:[0,0] neg_hi:[0,1]
v_pk_fma_f32 v[58:59], v[56:57], s[62:63], v[58:59] op_sel:[1,1,0] op_sel_hi:[1,0,1] neg_lo:[0,0,0] neg_hi:[0,0,0]
v_pk_add_f32 v[56:57], v[52:53], v[60:61] op_sel:[1,1] op_sel_hi:[0,0] neg_lo:[0,1] neg_hi:[1,0]
v_pk_add_f32 v[52:53], v[52:53], v[60:61]
v_pk_add_f32 v[60:61], v[54:55], v[62:63] neg_lo:[0,1] neg_hi:[0,1]
v_pk_add_f32 v[54:55], v[54:55], v[62:63]
v_pk_mul_f32 v[62:63], v[60:61], s[62:63] op_sel:[0,0] op_sel_hi:[0,1] neg_lo:[0,1] neg_hi:[0,1]
v_pk_fma_f32 v[62:63], v[60:61], s[62:63], v[62:63] op_sel:[1,1,0] op_sel_hi:[1,0,1] neg_lo:[0,0,0] neg_hi:[0,1,0]
v_pk_add_f32 v[60:61], v[40:41], v[48:49] neg_lo:[0,1] neg_hi:[0,1]
v_pk_add_f32 v[40:41], v[40:41], v[48:49]
v_pk_add_f32 v[48:49], v[66:67], v[74:75] neg_lo:[0,1] neg_hi:[0,1]
v_pk_add_f32 v[66:67], v[66:67], v[74:75]
v_pk_mul_f32 v[74:75], v[48:49], s[62:63] op_sel:[0,0] op_sel_hi:[0,1] neg_lo:[0,0] neg_hi:[0,1]
v_pk_fma_f32 v[74:75], v[48:49], s[62:63], v[74:75] op_sel:[1,1,0] op_sel_hi:[1,0,1] neg_lo:[0,0,0] neg_hi:[0,0,0]
v_pk_add_f32 v[48:49], v[68:69], v[76:77] op_sel:[1,1] op_sel_hi:[0,0] neg_lo:[0,1] neg_hi:[1,0]
v_pk_add_f32 v[68:69], v[68:69], v[76:77]
v_pk_add_f32 v[76:77], v[70:71], v[78:79] neg_lo:[0,1] neg_hi:[0,1]
v_pk_add_f32 v[70:71], v[70:71], v[78:79]
v_pk_mul_f32 v[78:79], v[76:77], s[62:63] op_sel:[0,0] op_sel_hi:[0,1] neg_lo:[0,1] neg_hi:[0,1]
v_pk_fma_f32 v[78:79], v[76:77], s[62:63], v[78:79] op_sel:[1,1,0] op_sel_hi:[1,0,1] neg_lo:[0,0,0] neg_hi:[0,1,0]
v_pk_add_f32 v[76:77], v[16:17], v[20:21] neg_lo:[0,1] neg_hi:[0,1]
v_pk_add_f32 v[16:17], v[16:17], v[20:21]
v_pk_add_f32 v[20:21], v[18:19], v[22:23] op_sel:[1,1] op_sel_hi:[0,0] neg_lo:[0,1] neg_hi:[1,0]
v_pk_add_f32 v[18:19], v[18:19], v[22:23]
v_pk_add_f32 v[22:23], v[72:73], v[24:25] neg_lo:[0,1] neg_hi:[0,1]
v_pk_add_f32 v[72:73], v[72:73], v[24:25]
v_pk_add_f32 v[24:25], v[26:27], v[30:31] op_sel:[1,1] op_sel_hi:[0,0] neg_lo:[0,1] neg_hi:[1,0]
v_pk_add_f32 v[26:27], v[26:27], v[30:31]
v_pk_add_f32 v[30:31], v[64:65], v[36:37] neg_lo:[0,1] neg_hi:[0,1]
v_pk_add_f32 v[64:65], v[64:65], v[36:37]
v_pk_add_f32 v[36:37], v[34:35], v[38:39] op_sel:[1,1] op_sel_hi:[0,0] neg_lo:[0,1] neg_hi:[1,0]
v_pk_add_f32 v[34:35], v[34:35], v[38:39]
v_pk_add_f32 v[38:39], v[28:29], v[32:33] neg_lo:[0,1] neg_hi:[0,1]
v_pk_add_f32 v[28:29], v[28:29], v[32:33]
v_pk_add_f32 v[32:33], v[42:43], v[46:47] op_sel:[1,1] op_sel_hi:[0,0] neg_lo:[0,1] neg_hi:[1,0]
v_pk_add_f32 v[42:43], v[42:43], v[46:47]
v_pk_add_f32 v[46:47], v[14:15], v[52:53] neg_lo:[0,1] neg_hi:[0,1]
v_pk_add_f32 v[14:15], v[14:15], v[52:53]
v_pk_add_f32 v[52:53], v[50:51], v[54:55] op_sel:[1,1] op_sel_hi:[0,0] neg_lo:[0,1] neg_hi:[1,0]
v_pk_add_f32 v[50:51], v[50:51], v[54:55]
v_pk_add_f32 v[54:55], v[44:45], v[56:57] neg_lo:[0,1] neg_hi:[0,1]
v_pk_add_f32 v[44:45], v[44:45], v[56:57]
v_pk_add_f32 v[56:57], v[58:59], v[62:63] op_sel:[1,1] op_sel_hi:[0,0] neg_lo:[0,1] neg_hi:[1,0]
v_pk_add_f32 v[58:59], v[58:59], v[62:63]
v_pk_add_f32 v[62:63], v[40:41], v[68:69] neg_lo:[0,1] neg_hi:[0,1]
v_pk_add_f32 v[40:41], v[40:41], v[68:69]
v_pk_add_f32 v[68:69], v[66:67], v[70:71] op_sel:[1,1] op_sel_hi:[0,0] neg_lo:[0,1] neg_hi:[1,0]
v_pk_add_f32 v[66:67], v[66:67], v[70:71]
v_pk_add_f32 v[70:71], v[60:61], v[48:49] neg_lo:[0,1] neg_hi:[0,1]
v_pk_add_f32 v[60:61], v[60:61], v[48:49]
v_pk_add_f32 v[48:49], v[74:75], v[78:79] op_sel:[1,1] op_sel_hi:[0,0] neg_lo:[0,1] neg_hi:[1,0]
v_pk_add_f32 v[74:75], v[74:75], v[78:79]
v_pk_add_f32 v[78:79], v[16:17], v[18:19] neg_lo:[0,1] neg_hi:[0,1]
v_pk_add_f32 v[16:17], v[16:17], v[18:19]
v_pk_add_f32 v[18:19], v[76:77], v[20:21] neg_lo:[0,1] neg_hi:[0,1]
v_pk_add_f32 v[76:77], v[76:77], v[20:21]
v_pk_add_f32 v[20:21], v[72:73], v[26:27] neg_lo:[0,1] neg_hi:[0,1]
v_pk_add_f32 v[72:73], v[72:73], v[26:27]
v_pk_add_f32 v[26:27], v[22:23], v[24:25] neg_lo:[0,1] neg_hi:[0,1]
v_pk_add_f32 v[22:23], v[22:23], v[24:25]
v_pk_add_f32 v[24:25], v[64:65], v[34:35] neg_lo:[0,1] neg_hi:[0,1]
v_pk_add_f32 v[64:65], v[64:65], v[34:35]
v_pk_add_f32 v[34:35], v[30:31], v[36:37] neg_lo:[0,1] neg_hi:[0,1]
v_pk_add_f32 v[30:31], v[30:31], v[36:37]
v_pk_add_f32 v[36:37], v[28:29], v[42:43] neg_lo:[0,1] neg_hi:[0,1]
v_pk_add_f32 v[28:29], v[28:29], v[42:43]
v_pk_add_f32 v[42:43], v[38:39], v[32:33] neg_lo:[0,1] neg_hi:[0,1]
v_pk_add_f32 v[38:39], v[38:39], v[32:33]
v_pk_add_f32 v[32:33], v[14:15], v[50:51] neg_lo:[0,1] neg_hi:[0,1]
v_pk_add_f32 v[14:15], v[14:15], v[50:51]
v_pk_add_f32 v[50:51], v[46:47], v[52:53] neg_lo:[0,1] neg_hi:[0,1]
v_pk_add_f32 v[46:47], v[46:47], v[52:53]
v_pk_add_f32 v[52:53], v[44:45], v[58:59] neg_lo:[0,1] neg_hi:[0,1]
v_pk_add_f32 v[44:45], v[44:45], v[58:59]
v_pk_add_f32 v[58:59], v[54:55], v[56:57] neg_lo:[0,1] neg_hi:[0,1]
v_pk_add_f32 v[54:55], v[54:55], v[56:57]
v_pk_add_f32 v[56:57], v[40:41], v[66:67] neg_lo:[0,1] neg_hi:[0,1]
v_pk_add_f32 v[40:41], v[40:41], v[66:67]
v_pk_add_f32 v[66:67], v[62:63], v[68:69] neg_lo:[0,1] neg_hi:[0,1]
v_pk_add_f32 v[62:63], v[62:63], v[68:69]
v_pk_add_f32 v[68:69], v[60:61], v[74:75] neg_lo:[0,1] neg_hi:[0,1]
v_pk_add_f32 v[60:61], v[60:61], v[74:75]
v_pk_add_f32 v[74:75], v[70:71], v[48:49] neg_lo:[0,1] neg_hi:[0,1]
v_pk_add_f32 v[70:71], v[70:71], v[48:49]
v_pk_mul_f32 v[48:49], v[14:15], v[82:83] op_sel:[0,0] op_sel_hi:[0,1] neg_lo:[0,0] neg_hi:[0,0]
v_pk_fma_f32 v[14:15], v[14:15], v[82:83], v[48:49] op_sel:[1,1,0] op_sel_hi:[1,0,1] neg_lo:[0,1,0] neg_hi:[0,0,0]
v_pk_mul_f32 v[48:49], v[64:65], v[84:85] op_sel:[0,0] op_sel_hi:[0,1] neg_lo:[0,0] neg_hi:[0,0]
v_pk_fma_f32 v[64:65], v[64:65], v[84:85], v[48:49] op_sel:[1,1,0] op_sel_hi:[1,0,1] neg_lo:[0,1,0] neg_hi:[0,0,0]
v_pk_mul_f32 v[48:49], v[40:41], v[86:87] op_sel:[0,0] op_sel_hi:[0,1] neg_lo:[0,0] neg_hi:[0,0]
v_pk_fma_f32 v[40:41], v[40:41], v[86:87], v[48:49] op_sel:[1,1,0] op_sel_hi:[1,0,1] neg_lo:[0,1,0] neg_hi:[0,0,0]
v_pk_mul_f32 v[48:49], v[72:73], v[88:89] op_sel:[0,0] op_sel_hi:[0,1] neg_lo:[0,0] neg_hi:[0,0]
v_pk_fma_f32 v[72:73], v[72:73], v[88:89], v[48:49] op_sel:[1,1,0] op_sel_hi:[1,0,1] neg_lo:[0,1,0] neg_hi:[0,0,0]
v_pk_mul_f32 v[48:49], v[44:45], v[90:91] op_sel:[0,0] op_sel_hi:[0,1] neg_lo:[0,0] neg_hi:[0,0]
v_pk_fma_f32 v[44:45], v[44:45], v[90:91], v[48:49] op_sel:[1,1,0] op_sel_hi:[1,0,1] neg_lo:[0,1,0] neg_hi:[0,0,0]
v_pk_mul_f32 v[48:49], v[28:29], v[92:93] op_sel:[0,0] op_sel_hi:[0,1] neg_lo:[0,0] neg_hi:[0,0]
v_pk_fma_f32 v[28:29], v[28:29], v[92:93], v[48:49] op_sel:[1,1,0] op_sel_hi:[1,0,1] neg_lo:[0,1,0] neg_hi:[0,0,0]
v_pk_mul_f32 v[48:49], v[60:61], v[94:95] op_sel:[0,0] op_sel_hi:[0,1] neg_lo:[0,0] neg_hi:[0,0]
v_pk_fma_f32 v[60:61], v[60:61], v[94:95], v[48:49] op_sel:[1,1,0] op_sel_hi:[1,0,1] neg_lo:[0,1,0] neg_hi:[0,0,0]
v_pk_mul_f32 v[48:49], v[76:77], v[96:97] op_sel:[0,0] op_sel_hi:[0,1] neg_lo:[0,0] neg_hi:[0,0]
v_pk_fma_f32 v[76:77], v[76:77], v[96:97], v[48:49] op_sel:[1,1,0] op_sel_hi:[1,0,1] neg_lo:[0,1,0] neg_hi:[0,0,0]
v_pk_mul_f32 v[48:49], v[46:47], v[98:99] op_sel:[0,0] op_sel_hi:[0,1] neg_lo:[0,0] neg_hi:[0,0]
v_pk_fma_f32 v[46:47], v[46:47], v[98:99], v[48:49] op_sel:[1,1,0] op_sel_hi:[1,0,1] neg_lo:[0,1,0] neg_hi:[0,0,0]
v_pk_mul_f32 v[48:49], v[30:31], v[100:101] op_sel:[0,0] op_sel_hi:[0,1] neg_lo:[0,0] neg_hi:[0,0]
v_pk_fma_f32 v[30:31], v[30:31], v[100:101], v[48:49] op_sel:[1,1,0] op_sel_hi:[1,0,1] neg_lo:[0,1,0] neg_hi:[0,0,0]
v_pk_mul_f32 v[48:49], v[62:63], v[102:103] op_sel:[0,0] op_sel_hi:[0,1] neg_lo:[0,0] neg_hi:[0,0]
v_pk_fma_f32 v[62:63], v[62:63], v[102:103], v[48:49] op_sel:[1,1,0] op_sel_hi:[1,0,1] neg_lo:[0,1,0] neg_hi:[0,0,0]
v_pk_mul_f32 v[48:49], v[22:23], v[104:105] op_sel:[0,0] op_sel_hi:[0,1] neg_lo:[0,0] neg_hi:[0,0]
v_pk_fma_f32 v[22:23], v[22:23], v[104:105], v[48:49] op_sel:[1,1,0] op_sel_hi:[1,0,1] neg_lo:[0,1,0] neg_hi:[0,0,0]
v_pk_mul_f32 v[48:49], v[54:55], v[106:107] op_sel:[0,0] op_sel_hi:[0,1] neg_lo:[0,0] neg_hi:[0,0]
v_pk_fma_f32 v[54:55], v[54:55], v[106:107], v[48:49] op_sel:[1,1,0] op_sel_hi:[1,0,1] neg_lo:[0,1,0] neg_hi:[0,0,0]
v_pk_mul_f32 v[48:49], v[38:39], v[108:109] op_sel:[0,0] op_sel_hi:[0,1] neg_lo:[0,0] neg_hi:[0,0]
v_pk_fma_f32 v[38:39], v[38:39], v[108:109], v[48:49] op_sel:[1,1,0] op_sel_hi:[1,0,1] neg_lo:[0,1,0] neg_hi:[0,0,0]
v_pk_mul_f32 v[48:49], v[70:71], v[110:111] op_sel:[0,0] op_sel_hi:[0,1] neg_lo:[0,0] neg_hi:[0,0]
v_pk_fma_f32 v[70:71], v[70:71], v[110:111], v[48:49] op_sel:[1,1,0] op_sel_hi:[1,0,1] neg_lo:[0,1,0] neg_hi:[0,0,0]
v_pk_mul_f32 v[48:49], v[78:79], v[112:113] op_sel:[0,0] op_sel_hi:[0,1] neg_lo:[0,0] neg_hi:[0,0]
v_pk_fma_f32 v[78:79], v[78:79], v[112:113], v[48:49] op_sel:[1,1,0] op_sel_hi:[1,0,1] neg_lo:[0,1,0] neg_hi:[0,0,0]
v_pk_mul_f32 v[48:49], v[32:33], v[114:115] op_sel:[0,0] op_sel_hi:[0,1] neg_lo:[0,0] neg_hi:[0,0]
v_pk_fma_f32 v[32:33], v[32:33], v[114:115], v[48:49] op_sel:[1,1,0] op_sel_hi:[1,0,1] neg_lo:[0,1,0] neg_hi:[0,0,0]
v_pk_mul_f32 v[48:49], v[24:25], v[116:117] op_sel:[0,0] op_sel_hi:[0,1] neg_lo:[0,0] neg_hi:[0,0]
v_pk_fma_f32 v[24:25], v[24:25], v[116:117], v[48:49] op_sel:[1,1,0] op_sel_hi:[1,0,1] neg_lo:[0,1,0] neg_hi:[0,0,0]
v_pk_mul_f32 v[48:49], v[56:57], v[118:119] op_sel:[0,0] op_sel_hi:[0,1] neg_lo:[0,0] neg_hi:[0,0]
v_pk_fma_f32 v[56:57], v[56:57], v[118:119], v[48:49] op_sel:[1,1,0] op_sel_hi:[1,0,1] neg_lo:[0,1,0] neg_hi:[0,0,0]
v_pk_mul_f32 v[48:49], v[20:21], v[120:121] op_sel:[0,0] op_sel_hi:[0,1] neg_lo:[0,0] neg_hi:[0,0]
v_pk_fma_f32 v[20:21], v[20:21], v[120:121], v[48:49] op_sel:[1,1,0] op_sel_hi:[1,0,1] neg_lo:[0,1,0] neg_hi:[0,0,0]
v_pk_mul_f32 v[48:49], v[52:53], v[122:123] op_sel:[0,0] op_sel_hi:[0,1] neg_lo:[0,0] neg_hi:[0,0]
v_pk_fma_f32 v[52:53], v[52:53], v[122:123], v[48:49] op_sel:[1,1,0] op_sel_hi:[1,0,1] neg_lo:[0,1,0] neg_hi:[0,0,0]
v_pk_mul_f32 v[48:49], v[36:37], v[124:125] op_sel:[0,0] op_sel_hi:[0,1] neg_lo:[0,0] neg_hi:[0,0]
v_pk_fma_f32 v[36:37], v[36:37], v[124:125], v[48:49] op_sel:[1,1,0] op_sel_hi:[1,0,1] neg_lo:[0,1,0] neg_hi:[0,0,0]
v_pk_mul_f32 v[48:49], v[68:69], v[126:127] op_sel:[0,0] op_sel_hi:[0,1] neg_lo:[0,0] neg_hi:[0,0]
v_pk_fma_f32 v[68:69], v[68:69], v[126:127], v[48:49] op_sel:[1,1,0] op_sel_hi:[1,0,1] neg_lo:[0,1,0] neg_hi:[0,0,0]
v_pk_mul_f32 v[48:49], v[18:19], v[128:129] op_sel:[0,0] op_sel_hi:[0,1] neg_lo:[0,0] neg_hi:[0,0]
v_pk_fma_f32 v[18:19], v[18:19], v[128:129], v[48:49] op_sel:[1,1,0] op_sel_hi:[1,0,1] neg_lo:[0,1,0] neg_hi:[0,0,0]
v_pk_mul_f32 v[48:49], v[50:51], v[130:131] op_sel:[0,0] op_sel_hi:[0,1] neg_lo:[0,0] neg_hi:[0,0]
v_pk_fma_f32 v[50:51], v[50:51], v[130:131], v[48:49] op_sel:[1,1,0] op_sel_hi:[1,0,1] neg_lo:[0,1,0] neg_hi:[0,0,0]
v_pk_mul_f32 v[48:49], v[34:35], v[132:133] op_sel:[0,0] op_sel_hi:[0,1] neg_lo:[0,0] neg_hi:[0,0]
v_pk_fma_f32 v[34:35], v[34:35], v[132:133], v[48:49] op_sel:[1,1,0] op_sel_hi:[1,0,1] neg_lo:[0,1,0] neg_hi:[0,0,0]
v_pk_mul_f32 v[48:49], v[66:67], v[134:135] op_sel:[0,0] op_sel_hi:[0,1] neg_lo:[0,0] neg_hi:[0,0]
v_pk_fma_f32 v[66:67], v[66:67], v[134:135], v[48:49] op_sel:[1,1,0] op_sel_hi:[1,0,1] neg_lo:[0,1,0] neg_hi:[0,0,0]
v_pk_mul_f32 v[48:49], v[26:27], v[136:137] op_sel:[0,0] op_sel_hi:[0,1] neg_lo:[0,0] neg_hi:[0,0]
v_pk_fma_f32 v[26:27], v[26:27], v[136:137], v[48:49] op_sel:[1,1,0] op_sel_hi:[1,0,1] neg_lo:[0,1,0] neg_hi:[0,0,0]
v_pk_mul_f32 v[48:49], v[58:59], v[138:139] op_sel:[0,0] op_sel_hi:[0,1] neg_lo:[0,0] neg_hi:[0,0]
v_pk_fma_f32 v[58:59], v[58:59], v[138:139], v[48:49] op_sel:[1,1,0] op_sel_hi:[1,0,1] neg_lo:[0,1,0] neg_hi:[0,0,0]
v_pk_mul_f32 v[48:49], v[42:43], v[140:141] op_sel:[0,0] op_sel_hi:[0,1] neg_lo:[0,0] neg_hi:[0,0]
v_pk_fma_f32 v[42:43], v[42:43], v[140:141], v[48:49] op_sel:[1,1,0] op_sel_hi:[1,0,1] neg_lo:[0,1,0] neg_hi:[0,0,0]
v_pk_mul_f32 v[48:49], v[74:75], v[142:143] op_sel:[0,0] op_sel_hi:[0,1] neg_lo:[0,0] neg_hi:[0,0]
v_pk_fma_f32 v[74:75], v[74:75], v[142:143], v[48:49] op_sel:[1,1,0] op_sel_hi:[1,0,1] neg_lo:[0,1,0] neg_hi:[0,0,0]
ds_write_b64 v3, v[16:17] offset:0
ds_write_b64 v3, v[14:15] offset:528
ds_write_b64 v3, v[64:65] offset:1056
ds_write_b64 v3, v[40:41] offset:1584
ds_write_b64 v3, v[72:73] offset:2112
ds_write_b64 v3, v[44:45] offset:2640
ds_write_b64 v3, v[28:29] offset:3168
ds_write_b64 v3, v[60:61] offset:3696
ds_write_b64 v3, v[76:77] offset:4224
ds_write_b64 v3, v[46:47] offset:4752
ds_write_b64 v3, v[30:31] offset:5280
ds_write_b64 v3, v[62:63] offset:5808
ds_write_b64 v3, v[22:23] offset:6336
ds_write_b64 v3, v[54:55] offset:6864
ds_write_b64 v3, v[38:39] offset:7392
ds_write_b64 v3, v[70:71] offset:7920
ds_write_b64 v3, v[78:79] offset:8448
ds_write_b64 v3, v[32:33] offset:8976
ds_write_b64 v3, v[24:25] offset:9504
ds_write_b64 v3, v[56:57] offset:10032
ds_write_b64 v3, v[20:21] offset:10560
ds_write_b64 v3, v[52:53] offset:11088
ds_write_b64 v3, v[36:37] offset:11616
ds_write_b64 v3, v[68:69] offset:12144
ds_write_b64 v3, v[18:19] offset:12672
ds_write_b64 v3, v[50:51] offset:13200
ds_write_b64 v3, v[34:35] offset:13728
ds_write_b64 v3, v[66:67] offset:14256
ds_write_b64 v3, v[26:27] offset:14784
ds_write_b64 v3, v[58:59] offset:15312
ds_write_b64 v3, v[42:43] offset:15840
ds_write_b64 v3, v[74:75] offset:16368
s_waitcnt lgkmcnt(0)
ds_read_b64 v[16:17], v4 offset:0
ds_read_b64 v[48:49], v4 offset:256
ds_read_b64 v[18:19], v4 offset:16
ds_read_b64 v[50:51], v4 offset:272
ds_read_b64 v[20:21], v4 offset:32
ds_read_b64 v[52:53], v4 offset:288
ds_read_b64 v[22:23], v4 offset:48
ds_read_b64 v[54:55], v4 offset:304
ds_read_b64 v[24:25], v4 offset:64
ds_read_b64 v[56:57], v4 offset:320
ds_read_b64 v[26:27], v4 offset:80
ds_read_b64 v[58:59], v4 offset:336
ds_read_b64 v[28:29], v4 offset:96
ds_read_b64 v[60:61], v4 offset:352
ds_read_b64 v[30:31], v4 offset:112
ds_read_b64 v[62:63], v4 offset:368
ds_read_b64 v[32:33], v4 offset:128
ds_read_b64 v[64:65], v4 offset:384
ds_read_b64 v[34:35], v4 offset:144
ds_read_b64 v[66:67], v4 offset:400
ds_read_b64 v[36:37], v4 offset:160
ds_read_b64 v[68:69], v4 offset:416
ds_read_b64 v[38:39], v4 offset:176
ds_read_b64 v[70:71], v4 offset:432
ds_read_b64 v[40:41], v4 offset:192
ds_read_b64 v[72:73], v4 offset:448
ds_read_b64 v[42:43], v4 offset:208
ds_read_b64 v[74:75], v4 offset:464
ds_read_b64 v[44:45], v4 offset:224
ds_read_b64 v[76:77], v4 offset:480
ds_read_b64 v[46:47], v4 offset:240
ds_read_b64 v[78:79], v4 offset:496
s_waitcnt lgkmcnt(0)
v_pk_add_f32 v[14:15], v[16:17], v[48:49] neg_lo:[0,1] neg_hi:[0,1]
v_pk_add_f32 v[16:17], v[16:17], v[48:49]
v_pk_add_f32 v[48:49], v[18:19], v[50:51] neg_lo:[0,1] neg_hi:[0,1]
v_pk_add_f32 v[18:19], v[18:19], v[50:51]
v_pk_mul_f32 v[50:51], v[48:49], s[50:51] op_sel:[0,0] op_sel_hi:[0,1] neg_lo:[0,0] neg_hi:[0,1]
v_pk_fma_f32 v[50:51], v[48:49], s[50:51], v[50:51] op_sel:[1,1,0] op_sel_hi:[1,0,1] neg_lo:[0,0,0] neg_hi:[0,0,0]
v_pk_add_f32 v[48:49], v[20:21], v[52:53] neg_lo:[0,1] neg_hi:[0,1]
v_pk_add_f32 v[20:21], v[20:21], v[52:53]
v_pk_mul_f32 v[52:53], v[48:49], s[54:55] op_sel:[0,0] op_sel_hi:[0,1] neg_lo:[0,0] neg_hi:[0,1]
v_pk_fma_f32 v[52:53], v[48:49], s[54:55], v[52:53] op_sel:[1,1,0] op_sel_hi:[1,0,1] neg_lo:[0,0,0] neg_hi:[0,0,0]
v_pk_add_f32 v[48:49], v[22:23], v[54:55] neg_lo:[0,1] neg_hi:[0,1]
v_pk_add_f32 v[22:23], v[22:23], v[54:55]
v_pk_mul_f32 v[54:55], v[48:49], s[58:59] op_sel:[0,0] op_sel_hi:[0,1] neg_lo:[0,0] neg_hi:[0,1]
v_pk_fma_f32 v[54:55], v[48:49], s[58:59], v[54:55] op_sel:[1,1,0] op_sel_hi:[1,0,1] neg_lo:[0,0,0] neg_hi:[0,0,0]
v_pk_add_f32 v[48:49], v[24:25], v[56:57] neg_lo:[0,1] neg_hi:[0,1]
v_pk_add_f32 v[24:25], v[24:25], v[56:57]
v_pk_mul_f32 v[56:57], v[48:49], s[62:63] op_sel:[0,0] op_sel_hi:[0,1] neg_lo:[0,0] neg_hi:[0,1]
v_pk_fma_f32 v[56:57], v[48:49], s[62:63], v[56:57] op_sel:[1,1,0] op_sel_hi:[1,0,1] neg_lo:[0,0,0] neg_hi:[0,0,0]
v_pk_add_f32 v[48:49], v[26:27], v[58:59] neg_lo:[0,1] neg_hi:[0,1]
v_pk_add_f32 v[26:27], v[26:27], v[58:59]
v_pk_mul_f32 v[58:59], v[48:49], s[58:59] op_sel:[0,1] op_sel_hi:[0,0] neg_lo:[0,0] neg_hi:[0,1]
v_pk_fma_f32 v[58:59], v[48:49], s[58:59], v[58:59] op_sel:[1,0,0] op_sel_hi:[1,1,1] neg_lo:[0,0,0] neg_hi:[0,0,0]
v_pk_add_f32 v[48:49], v[28:29], v[60:61] neg_lo:[0,1] neg_hi:[0,1]
v_pk_add_f32 v[28:29], v[28:29], v[60:61]
v_pk_mul_f32 v[60:61], v[48:49], s[54:55] op_sel:[0,1] op_sel_hi:[0,0] neg_lo:[0,0] neg_hi:[0,1]
v_pk_fma_f32 v[60:61], v[48:49], s[54:55], v[60:61] op_sel:[1,0,0] op_sel_hi:[1,1,1] neg_lo:[0,0,0] neg_hi:[0,0,0]
v_pk_add_f32 v[48:49], v[30:31], v[62:63] neg_lo:[0,1] neg_hi:[0,1]
v_pk_add_f32 v[30:31], v[30:31], v[62:63]
v_pk_mul_f32 v[62:63], v[48:49], s[50:51] op_sel:[0,1] op_sel_hi:[0,0] neg_lo:[0,0] neg_hi:[0,1]
v_pk_fma_f32 v[62:63], v[48:49], s[50:51], v[62:63] op_sel:[1,0,0] op_sel_hi:[1,1,1] neg_lo:[0,0,0] neg_hi:[0,0,0]
v_pk_add_f32 v[48:49], v[32:33], v[64:65] op_sel:[1,1] op_sel_hi:[0,0] neg_lo:[0,1] neg_hi:[1,0]
v_pk_add_f32 v[32:33], v[32:33], v[64:65]
v_pk_add_f32 v[64:65], v[34:35], v[66:67] neg_lo:[0,1] neg_hi:[0,1]
v_pk_add_f32 v[34:35], v[34:35], v[66:67]
v_pk_mul_f32 v[66:67], v[64:65], s[50:51] op_sel:[0,1] op_sel_hi:[0,0] neg_lo:[0,1] neg_hi:[0,1]
v_pk_fma_f32 v[66:67], v[64:65], s[50:51], v[66:67] op_sel:[1,0,0] op_sel_hi:[1,1,1] neg_lo:[0,0,0] neg_hi:[0,1,0]
v_pk_add_f32 v[64:65], v[36:37], v[68:69] neg_lo:[0,1] neg_hi:[0,1]
v_pk_add_f32 v[36:37], v[36:37], v[68:69]
v_pk_mul_f32 v[68:69], v[64:65], s[54:55] op_sel:[0,1] op_sel_hi:[0,0] neg_lo:[0,1] neg_hi:[0,1]
v_pk_fma_f32 v[68:69], v[64:65], s[54:55], v[68:69] op_sel:[1,0,0] op_sel_hi:[1,1,1] neg_lo:[0,0,0] neg_hi:[0,1,0]
v_pk_add_f32 v[64:65], v[38:39], v[70:71] neg_lo:[0,1] neg_hi:[0,1]
v_pk_add_f32 v[38:39], v[38:39], v[70:71]
v_pk_mul_f32 v[70:71], v[64:65], s[58:59] op_sel:[0,1] op_sel_hi:[0,0] neg_lo:[0,1] neg_hi:[0,1]
v_pk_fma_f32 v[70:71], v[64:65], s[58:59], v[70:71] op_sel:[1,0,0] op_sel_hi:[1,1,1] neg_lo:[0,0,0] neg_hi:[0,1,0]
v_pk_add_f32 v[64:65], v[40:41], v[72:73] neg_lo:[0,1] neg_hi:[0,1]
v_pk_add_f32 v[40:41], v[40:41], v[72:73]
v_pk_mul_f32 v[72:73], v[64:65], s[62:63] op_sel:[0,0] op_sel_hi:[0,1] neg_lo:[0,1] neg_hi:[0,1]
v_pk_fma_f32 v[72:73], v[64:65], s[62:63], v[72:73] op_sel:[1,1,0] op_sel_hi:[1,0,1] neg_lo:[0,0,0] neg_hi:[0,1,0]
v_pk_add_f32 v[64:65], v[42:43], v[74:75] neg_lo:[0,1] neg_hi:[0,1]
v_pk_add_f32 v[42:43], v[42:43], v[74:75]
v_pk_mul_f32 v[74:75], v[64:65], s[58:59] op_sel:[0,0] op_sel_hi:[0,1] neg_lo:[0,1] neg_hi:[0,1]
v_pk_fma_f32 v[74:75], v[64:65], s[58:59], v[74:75] op_sel:[1,1,0] op_sel_hi:[1,0,1] neg_lo:[0,0,0] neg_hi:[0,1,0]
v_pk_add_f32 v[64:65], v[44:45], v[76:77] neg_lo:[0,1] neg_hi:[0,1]
v_pk_add_f32 v[44:45], v[44:45], v[76:77]
v_pk_mul_f32 v[76:77], v[64:65], s[54:55] op_sel:[0,0] op_sel_hi:[0,1] neg_lo:[0,1] neg_hi:[0,1]
v_pk_fma_f32 v[76:77], v[64:65], s[54:55], v[76:77] op_sel:[1,1,0] op_sel_hi:[1,0,1] neg_lo:[0,0,0] neg_hi:[0,1,0]
v_pk_add_f32 v[64:65], v[46:47], v[78:79] neg_lo:[0,1] neg_hi:[0,1]
v_pk_add_f32 v[46:47], v[46:47], v[78:79]
v_pk_mul_f32 v[78:79], v[64:65], s[50:51] op_sel:[0,0] op_sel_hi:[0,1] neg_lo:[0,1] neg_hi:[0,1]
v_pk_fma_f32 v[78:79], v[64:65], s[50:51], v[78:79] op_sel:[1,1,0] op_sel_hi:[1,0,1] neg_lo:[0,0,0] neg_hi:[0,1,0]
v_pk_add_f32 v[64:65], v[16:17], v[32:33] neg_lo:[0,1] neg_hi:[0,1]
v_pk_add_f32 v[16:17], v[16:17], v[32:33]
v_pk_add_f32 v[32:33], v[18:19], v[34:35] neg_lo:[0,1] neg_hi:[0,1]
v_pk_add_f32 v[18:19], v[18:19], v[34:35]
v_pk_mul_f32 v[34:35], v[32:33], s[54:55] op_sel:[0,0] op_sel_hi:[0,1] neg_lo:[0,0] neg_hi:[0,1]
v_pk_fma_f32 v[34:35], v[32:33], s[54:55], v[34:35] op_sel:[1,1,0] op_sel_hi:[1,0,1] neg_lo:[0,0,0] neg_hi:[0,0,0]
v_pk_add_f32 v[32:33], v[20:21], v[36:37] neg_lo:[0,1] neg_hi:[0,1]
v_pk_add_f32 v[20:21], v[20:21], v[36:37]
v_pk_mul_f32 v[36:37], v[32:33], s[62:63] op_sel:[0,0] op_sel_hi:[0,1] neg_lo:[0,0] neg_hi:[0,1]
v_pk_fma_f32 v[36:37], v[32:33], s[62:63], v[36:37] op_sel:[1,1,0] op_sel_hi:[1,0,1] neg_lo:[0,0,0] neg_hi:[0,0,0]
v_pk_add_f32 v[32:33], v[22:23], v[38:39] neg_lo:[0,1] neg_hi:[0,1]
v_pk_add_f32 v[22:23], v[22:23], v[38:39]
v_pk_mul_f32 v[38:39], v[32:33], s[54:55] op_sel:[0,1] op_sel_hi:[0,0] neg_lo:[0,0] neg_hi:[0,1]
v_pk_fma_f32 v[38:39], v[32:33], s[54:55], v[38:39] op_sel:[1,0,0] op_sel_hi:[1,1,1] neg_lo:[0,0,0] neg_hi:[0,0,0]
v_pk_add_f32 v[32:33], v[24:25], v[40:41] op_sel:[1,1] op_sel_hi:[0,0] neg_lo:[0,1] neg_hi:[1,0]
v_pk_add_f32 v[24:25], v[24:25], v[40:41]
v_pk_add_f32 v[40:41], v[26:27], v[42:43] neg_lo:[0,1] neg_hi:[0,1]
v_pk_add_f32 v[26:27], v[26:27], v[42:43]
v_pk_mul_f32 v[42:43], v[40:41], s[54:55] op_sel:[0,1] op_sel_hi:[0,0] neg_lo:[0,1] neg_hi:[0,1]
v_pk_fma_f32 v[42:43], v[40:41], s[54:55], v[42:43] op_sel:[1,0,0] op_sel_hi:[1,1,1] neg_lo:[0,0,0] neg_hi:[0,1,0]
v_pk_add_f32 v[40:41], v[28:29], v[44:45] neg_lo:[0,1] neg_hi:[0,1]
v_pk_add_f32 v[28:29], v[28:29], v[44:45]
v_pk_mul_f32 v[44:45], v[40:41], s[62:63] op_sel:[0,0] op_sel_hi:[0,1] neg_lo:[0,1] neg_hi:[0,1]
v_pk_fma_f32 v[44:45], v[40:41], s[62:63], v[44:45] op_sel:[1,1,0] op_sel_hi:[1,0,1] neg_lo:[0,0,0] neg_hi:[0,1,0]
v_pk_add_f32 v[40:41], v[30:31], v[46:47] neg_lo:[0,1] neg_hi:[0,1]
v_pk_add_f32 v[30:31], v[30:31], v[46:47]
v_pk_mul_f32 v[46:47], v[40:41], s[54:55] op_sel:[0,0] op_sel_hi:[0,1] neg_lo:[0,1] neg_hi:[0,1]
v_pk_fma_f32 v[46:47], v[40:41], s[54:55], v[46:47] op_sel:[1,1,0] op_sel_hi:[1,0,1] neg_lo:[0,0,0] neg_hi:[0,1,0]
v_pk_add_f32 v[40:41], v[14:15], v[48:49] neg_lo:[0,1] neg_hi:[0,1]
v_pk_add_f32 v[14:15], v[14:15], v[48:49]
v_pk_add_f32 v[48:49], v[50:51], v[66:67] neg_lo:[0,1] neg_hi:[0,1]
v_pk_add_f32 v[50:51], v[50:51], v[66:67]
v_pk_mul_f32 v[66:67], v[48:49], s[54:55] op_sel:[0,0] op_sel_hi:[0,1] neg_lo:[0,0] neg_hi:[0,1]
v_pk_fma_f32 v[66:67], v[48:49], s[54:55], v[66:67] op_sel:[1,1,0] op_sel_hi:[1,0,1] neg_lo:[0,0,0] neg_hi:[0,0,0]
v_pk_add_f32 v[48:49], v[52:53], v[68:69] neg_lo:[0,1] neg_hi:[0,1]
v_pk_add_f32 v[52:53], v[52:53], v[68:69]
v_pk_mul_f32 v[68:69], v[48:49], s[62:63] op_sel:[0,0] op_sel_hi:[0,1] neg_lo:[0,0] neg_hi:[0,1]
v_pk_fma_f32 v[68:69], v[48:49], s[62:63], v[68:69] op_sel:[1,1,0] op_sel_hi:[1,0,1] neg_lo:[0,0,0] neg_hi:[0,0,0]
v_pk_add_f32 v[48:49], v[54:55], v[70:71] neg_lo:[0,1] neg_hi:[0,1]
v_pk_add_f32 v[54:55], v[54:55], v[70:71]
v_pk_mul_f32 v[70:71], v[48:49], s[54:55] op_sel:[0,1] op_sel_hi:[0,0] neg_lo:[0,0] neg_hi:[0,1]
v_pk_fma_f32 v[70:71], v[48:49], s[54:55], v[70:71] op_sel:[1,0,0] op_sel_hi:[1,1,1] neg_lo:[0,0,0] neg_hi:[0,0,0]
v_pk_add_f32 v[48:49], v[56:57], v[72:73] op_sel:[1,1] op_sel_hi:[0,0] neg_lo:[0,1] neg_hi:[1,0]
v_pk_add_f32 v[56:57], v[56:57], v[72:73]
v_pk_add_f32 v[72:73], v[58:59], v[74:75] neg_lo:[0,1] neg_hi:[0,1]
v_pk_add_f32 v[58:59], v[58:59], v[74:75]
v_pk_mul_f32 v[74:75], v[72:73], s[54:55] op_sel:[0,1] op_sel_hi:[0,0] neg_lo:[0,1] neg_hi:[0,1]
v_pk_fma_f32 v[74:75], v[72:73], s[54:55], v[74:75] op_sel:[1,0,0] op_sel_hi:[1,1,1] neg_lo:[0,0,0] neg_hi:[0,1,0]
v_pk_add_f32 v[72:73], v[60:61], v[76:77] neg_lo:[0,1] neg_hi:[0,1]
v_pk_add_f32 v[60:61], v[60:61], v[76:77]
v_pk_mul_f32 v[76:77], v[72:73], s[62:63] op_sel:[0,0] op_sel_hi:[0,1] neg_lo:[0,1] neg_hi:[0,1]
v_pk_fma_f32 v[76:77], v[72:73], s[62:63], v[76:77] op_sel:[1,1,0] op_sel_hi:[1,0,1] neg_lo:[0,0,0] neg_hi:[0,1,0]
v_pk_add_f32 v[72:73], v[62:63], v[78:79] neg_lo:[0,1] neg_hi:[0,1]
v_pk_add_f32 v[62:63], v[62:63], v[78:79]
v_pk_mul_f32 v[78:79], v[72:73], s[54:55] op_sel:[0,0] op_sel_hi:[0,1] neg_lo:[0,1] neg_hi:[0,1]
v_pk_fma_f32 v[78:79], v[72:73], s[54:55], v[78:79] op_sel:[1,1,0] op_sel_hi:[1,0,1] neg_lo:[0,0,0] neg_hi:[0,1,0]
v_pk_add_f32 v[72:73], v[16:17], v[24:25] neg_lo:[0,1] neg_hi:[0,1]
v_pk_add_f32 v[16:17], v[16:17], v[24:25]
v_pk_add_f32 v[24:25], v[18:19], v[26:27] neg_lo:[0,1] neg_hi:[0,1]
v_pk_add_f32 v[18:19], v[18:19], v[26:27]
v_pk_mul_f32 v[26:27], v[24:25], s[62:63] op_sel:[0,0] op_sel_hi:[0,1] neg_lo:[0,0] neg_hi:[0,1]
v_pk_fma_f32 v[26:27], v[24:25], s[62:63], v[26:27] op_sel:[1,1,0] op_sel_hi:[1,0,1] neg_lo:[0,0,0] neg_hi:[0,0,0]
v_pk_add_f32 v[24:25], v[20:21], v[28:29] op_sel:[1,1] op_sel_hi:[0,0] neg_lo:[0,1] neg_hi:[1,0]
v_pk_add_f32 v[20:21], v[20:21], v[28:29]
v_pk_add_f32 v[28:29], v[22:23], v[30:31] neg_lo:[0,1] neg_hi:[0,1]
v_pk_add_f32 v[22:23], v[22:23], v[30:31]
v_pk_mul_f32 v[30:31], v[28:29], s[62:63] op_sel:[0,0] op_sel_hi:[0,1] neg_lo:[0,1] neg_hi:[0,1]
v_pk_fma_f32 v[30:31], v[28:29], s[62:63], v[30:31] op_sel:[1,1,0] op_sel_hi:[1,0,1] neg_lo:[0,0,0] neg_hi:[0,1,0]
v_pk_add_f32 v[28:29], v[64:65], v[32:33] neg_lo:[0,1] neg_hi:[0,1]
v_pk_add_f32 v[64:65], v[64:65], v[32:33]
v_pk_add_f32 v[32:33], v[34:35], v[42:43] neg_lo:[0,1] neg_hi:[0,1]
v_pk_add_f32 v[34:35], v[34:35], v[42:43]
v_pk_mul_f32 v[42:43], v[32:33], s[62:63] op_sel:[0,0] op_sel_hi:[0,1] neg_lo:[0,0] neg_hi:[0,1]
v_pk_fma_f32 v[42:43], v[32:33], s[62:63], v[42:43] op_sel:[1,1,0] op_sel_hi:[1,0,1] neg_lo:[0,0,0] neg_hi:[0,0,0]
v_pk_add_f32 v[32:33], v[36:37], v[44:45] op_sel:[1,1] op_sel_hi:[0,0] neg_lo:[0,1] neg_hi:[1,0]
v_pk_add_f32 v[36:37], v[36:37], v[44:45]
v_pk_add_f32 v[44:45], v[38:39], v[46:47] neg_lo:[0,1] neg_hi:[0,1]
v_pk_add_f32 v[38:39], v[38:39], v[46:47]
v_pk_mul_f32 v[46:47], v[44:45], s[62:63] op_sel:[0,0] op_sel_hi:[0,1] neg_lo:[0,1] neg_hi:[0,1]
v_pk_fma_f32 v[46:47], v[44:45], s[62:63], v[46:47] op_sel:[1,1,0] op_sel_hi:[1,0,1] neg_lo:[0,0,0] neg_hi:[0,1,0]
v_pk_add_f32 v[44:45], v[14:15], v[56:57] neg_lo:[0,1] neg_hi:[0,1]
v_pk_add_f32 v[14:15], v[14:15], v[56:57]
v_pk_add_f32 v[56:57], v[50:51], v[58:59] neg_lo:[0,1] neg_hi:[0,1]
v_pk_add_f32 v[50:51], v[50:51], v[58:59]
v_pk_mul_f32 v[58:59], v[56:57], s[62:63] op_sel:[0,0] op_sel_hi:[0,1] neg_lo:[0,0] neg_hi:[0,1]
v_pk_fma_f32 v[58:59], v[56:57], s[62:63], v[58:59] op_sel:[1,1,0] op_sel_hi:[1,0,1] neg_lo:[0,0,0] neg_hi:[0,0,0]
v_pk_add_f32 v[56:57], v[52:53], v[60:61] op_sel:[1,1] op_sel_hi:[0,0] neg_lo:[0,1] neg_hi:[1,0]
v_pk_add_f32 v[52:53], v[52:53], v[60:61]
v_pk_add_f32 v[60:61], v[54:55], v[62:63] neg_lo:[0,1] neg_hi:[0,1]
v_pk_add_f32 v[54:55], v[54:55], v[62:63]
v_pk_mul_f32 v[62:63], v[60:61], s[62:63] op_sel:[0,0] op_sel_hi:[0,1] neg_lo:[0,1] neg_hi:[0,1]
v_pk_fma_f32 v[62:63], v[60:61], s[62:63], v[62:63] op_sel:[1,1,0] op_sel_hi:[1,0,1] neg_lo:[0,0,0] neg_hi:[0,1,0]
v_pk_add_f32 v[60:61], v[40:41], v[48:49] neg_lo:[0,1] neg_hi:[0,1]
v_pk_add_f32 v[40:41], v[40:41], v[48:49]
v_pk_add_f32 v[48:49], v[66:67], v[74:75] neg_lo:[0,1] neg_hi:[0,1]
v_pk_add_f32 v[66:67], v[66:67], v[74:75]
v_pk_mul_f32 v[74:75], v[48:49], s[62:63] op_sel:[0,0] op_sel_hi:[0,1] neg_lo:[0,0] neg_hi:[0,1]
v_pk_fma_f32 v[74:75], v[48:49], s[62:63], v[74:75] op_sel:[1,1,0] op_sel_hi:[1,0,1] neg_lo:[0,0,0] neg_hi:[0,0,0]
v_pk_add_f32 v[48:49], v[68:69], v[76:77] op_sel:[1,1] op_sel_hi:[0,0] neg_lo:[0,1] neg_hi:[1,0]
v_pk_add_f32 v[68:69], v[68:69], v[76:77]
v_pk_add_f32 v[76:77], v[70:71], v[78:79] neg_lo:[0,1] neg_hi:[0,1]
v_pk_add_f32 v[70:71], v[70:71], v[78:79]
v_pk_mul_f32 v[78:79], v[76:77], s[62:63] op_sel:[0,0] op_sel_hi:[0,1] neg_lo:[0,1] neg_hi:[0,1]
v_pk_fma_f32 v[78:79], v[76:77], s[62:63], v[78:79] op_sel:[1,1,0] op_sel_hi:[1,0,1] neg_lo:[0,0,0] neg_hi:[0,1,0]
v_pk_add_f32 v[76:77], v[16:17], v[20:21] neg_lo:[0,1] neg_hi:[0,1]
v_pk_add_f32 v[16:17], v[16:17], v[20:21]
v_pk_add_f32 v[20:21], v[18:19], v[22:23] op_sel:[1,1] op_sel_hi:[0,0] neg_lo:[0,1] neg_hi:[1,0]
v_pk_add_f32 v[18:19], v[18:19], v[22:23]
v_pk_add_f32 v[22:23], v[72:73], v[24:25] neg_lo:[0,1] neg_hi:[0,1]
v_pk_add_f32 v[72:73], v[72:73], v[24:25]
v_pk_add_f32 v[24:25], v[26:27], v[30:31] op_sel:[1,1] op_sel_hi:[0,0] neg_lo:[0,1] neg_hi:[1,0]
v_pk_add_f32 v[26:27], v[26:27], v[30:31]
v_pk_add_f32 v[30:31], v[64:65], v[36:37] neg_lo:[0,1] neg_hi:[0,1]
v_pk_add_f32 v[64:65], v[64:65], v[36:37]
v_pk_add_f32 v[36:37], v[34:35], v[38:39] op_sel:[1,1] op_sel_hi:[0,0] neg_lo:[0,1] neg_hi:[1,0]
v_pk_add_f32 v[34:35], v[34:35], v[38:39]
v_pk_add_f32 v[38:39], v[28:29], v[32:33] neg_lo:[0,1] neg_hi:[0,1]
v_pk_add_f32 v[28:29], v[28:29], v[32:33]
v_pk_add_f32 v[32:33], v[42:43], v[46:47] op_sel:[1,1] op_sel_hi:[0,0] neg_lo:[0,1] neg_hi:[1,0]
v_pk_add_f32 v[42:43], v[42:43], v[46:47]
v_pk_add_f32 v[46:47], v[14:15], v[52:53] neg_lo:[0,1] neg_hi:[0,1]
v_pk_add_f32 v[14:15], v[14:15], v[52:53]
v_pk_add_f32 v[52:53], v[50:51], v[54:55] op_sel:[1,1] op_sel_hi:[0,0] neg_lo:[0,1] neg_hi:[1,0]
v_pk_add_f32 v[50:51], v[50:51], v[54:55]
v_pk_add_f32 v[54:55], v[44:45], v[56:57] neg_lo:[0,1] neg_hi:[0,1]
v_pk_add_f32 v[44:45], v[44:45], v[56:57]
v_pk_add_f32 v[56:57], v[58:59], v[62:63] op_sel:[1,1] op_sel_hi:[0,0] neg_lo:[0,1] neg_hi:[1,0]
v_pk_add_f32 v[58:59], v[58:59], v[62:63]
v_pk_add_f32 v[62:63], v[40:41], v[68:69] neg_lo:[0,1] neg_hi:[0,1]
v_pk_add_f32 v[40:41], v[40:41], v[68:69]
v_pk_add_f32 v[68:69], v[66:67], v[70:71] op_sel:[1,1] op_sel_hi:[0,0] neg_lo:[0,1] neg_hi:[1,0]
v_pk_add_f32 v[66:67], v[66:67], v[70:71]
v_pk_add_f32 v[70:71], v[60:61], v[48:49] neg_lo:[0,1] neg_hi:[0,1]
v_pk_add_f32 v[60:61], v[60:61], v[48:49]
v_pk_add_f32 v[48:49], v[74:75], v[78:79] op_sel:[1,1] op_sel_hi:[0,0] neg_lo:[0,1] neg_hi:[1,0]
v_pk_add_f32 v[74:75], v[74:75], v[78:79]
v_pk_add_f32 v[78:79], v[16:17], v[18:19] neg_lo:[0,1] neg_hi:[0,1]
v_pk_add_f32 v[16:17], v[16:17], v[18:19]
v_pk_add_f32 v[18:19], v[76:77], v[20:21] neg_lo:[0,1] neg_hi:[0,1]
v_pk_add_f32 v[76:77], v[76:77], v[20:21]
v_pk_add_f32 v[20:21], v[72:73], v[26:27] neg_lo:[0,1] neg_hi:[0,1]
v_pk_add_f32 v[72:73], v[72:73], v[26:27]
v_pk_add_f32 v[26:27], v[22:23], v[24:25] neg_lo:[0,1] neg_hi:[0,1]
v_pk_add_f32 v[22:23], v[22:23], v[24:25]
v_pk_add_f32 v[24:25], v[64:65], v[34:35] neg_lo:[0,1] neg_hi:[0,1]
v_pk_add_f32 v[64:65], v[64:65], v[34:35]
v_pk_add_f32 v[34:35], v[30:31], v[36:37] neg_lo:[0,1] neg_hi:[0,1]
v_pk_add_f32 v[30:31], v[30:31], v[36:37]
v_pk_add_f32 v[36:37], v[28:29], v[42:43] neg_lo:[0,1] neg_hi:[0,1]
v_pk_add_f32 v[28:29], v[28:29], v[42:43]
v_pk_add_f32 v[42:43], v[38:39], v[32:33] neg_lo:[0,1] neg_hi:[0,1]
v_pk_add_f32 v[38:39], v[38:39], v[32:33]
v_pk_add_f32 v[32:33], v[14:15], v[50:51] neg_lo:[0,1] neg_hi:[0,1]
v_pk_add_f32 v[14:15], v[14:15], v[50:51]
v_pk_add_f32 v[50:51], v[46:47], v[52:53] neg_lo:[0,1] neg_hi:[0,1]
v_pk_add_f32 v[46:47], v[46:47], v[52:53]
v_pk_add_f32 v[52:53], v[44:45], v[58:59] neg_lo:[0,1] neg_hi:[0,1]
v_pk_add_f32 v[44:45], v[44:45], v[58:59]
v_pk_add_f32 v[58:59], v[54:55], v[56:57] neg_lo:[0,1] neg_hi:[0,1]
v_pk_add_f32 v[54:55], v[54:55], v[56:57]
v_pk_add_f32 v[56:57], v[40:41], v[66:67] neg_lo:[0,1] neg_hi:[0,1]
v_pk_add_f32 v[40:41], v[40:41], v[66:67]
v_pk_add_f32 v[66:67], v[62:63], v[68:69] neg_lo:[0,1] neg_hi:[0,1]
v_pk_add_f32 v[62:63], v[62:63], v[68:69]
v_pk_add_f32 v[68:69], v[60:61], v[74:75] neg_lo:[0,1] neg_hi:[0,1]
v_pk_add_f32 v[60:61], v[60:61], v[74:75]
v_pk_add_f32 v[74:75], v[70:71], v[48:49] neg_lo:[0,1] neg_hi:[0,1]
v_pk_add_f32 v[70:71], v[70:71], v[48:49]
s_mov_b64 exec, s[18:19]
v_pk_add_f32 v[16:17], v[16:17], 0 neg_lo:[1,0] neg_hi:[1,0]
v_pk_mul_f32 v[48:49], v[14:15], s[48:49] op_sel:[0,0] op_sel_hi:[0,1] neg_lo:[0,1] neg_hi:[0,0]
v_pk_fma_f32 v[14:15], v[14:15], s[48:49], v[48:49] op_sel:[1,1,0] op_sel_hi:[1,0,1] neg_lo:[0,1,0] neg_hi:[0,1,0]
v_pk_mul_f32 v[48:49], v[64:65], s[50:51] op_sel:[0,0] op_sel_hi:[0,1] neg_lo:[0,1] neg_hi:[0,0]
v_pk_fma_f32 v[64:65], v[64:65], s[50:51], v[48:49] op_sel:[1,1,0] op_sel_hi:[1,0,1] neg_lo:[0,1,0] neg_hi:[0,1,0]
v_pk_mul_f32 v[48:49], v[40:41], s[52:53] op_sel:[0,0] op_sel_hi:[0,1] neg_lo:[0,1] neg_hi:[0,0]
v_pk_fma_f32 v[40:41], v[40:41], s[52:53], v[48:49] op_sel:[1,1,0] op_sel_hi:[1,0,1] neg_lo:[0,1,0] neg_hi:[0,1,0]
v_pk_mul_f32 v[48:49], v[72:73], s[54:55] op_sel:[0,0] op_sel_hi:[0,1] neg_lo:[0,1] neg_hi:[0,0]
v_pk_fma_f32 v[72:73], v[72:73], s[54:55], v[48:49] op_sel:[1,1,0] op_sel_hi:[1,0,1] neg_lo:[0,1,0] neg_hi:[0,1,0]
v_pk_mul_f32 v[48:49], v[44:45], s[56:57] op_sel:[0,0] op_sel_hi:[0,1] neg_lo:[0,1] neg_hi:[0,0]
v_pk_fma_f32 v[44:45], v[44:45], s[56:57], v[48:49] op_sel:[1,1,0] op_sel_hi:[1,0,1] neg_lo:[0,1,0] neg_hi:[0,1,0]
v_pk_mul_f32 v[48:49], v[28:29], s[58:59] op_sel:[0,0] op_sel_hi:[0,1] neg_lo:[0,1] neg_hi:[0,0]
v_pk_fma_f32 v[28:29], v[28:29], s[58:59], v[48:49] op_sel:[1,1,0] op_sel_hi:[1,0,1] neg_lo:[0,1,0] neg_hi:[0,1,0]
v_pk_mul_f32 v[48:49], v[60:61], s[60:61] op_sel:[0,0] op_sel_hi:[0,1] neg_lo:[0,1] neg_hi:[0,0]
v_pk_fma_f32 v[60:61], v[60:61], s[60:61], v[48:49] op_sel:[1,1,0] op_sel_hi:[1,0,1] neg_lo:[0,1,0] neg_hi:[0,1,0]
v_pk_mul_f32 v[48:49], v[76:77], s[62:63] op_sel:[0,0] op_sel_hi:[0,1] neg_lo:[0,1] neg_hi:[0,0]
v_pk_fma_f32 v[76:77], v[76:77], s[62:63], v[48:49] op_sel:[1,1,0] op_sel_hi:[1,0,1] neg_lo:[0,1,0] neg_hi:[0,1,0]
v_pk_mul_f32 v[48:49], v[46:47], s[60:61] op_sel:[0,1] op_sel_hi:[0,0] neg_lo:[0,1] neg_hi:[0,0]
v_pk_fma_f32 v[46:47], v[46:47], s[60:61], v[48:49] op_sel:[1,0,0] op_sel_hi:[1,1,1] neg_lo:[0,1,0] neg_hi:[0,1,0]
v_pk_mul_f32 v[48:49], v[30:31], s[58:59] op_sel:[0,1] op_sel_hi:[0,0] neg_lo:[0,1] neg_hi:[0,0]
v_pk_fma_f32 v[30:31], v[30:31], s[58:59], v[48:49] op_sel:[1,0,0] op_sel_hi:[1,1,1] neg_lo:[0,1,0] neg_hi:[0,1,0]
v_pk_mul_f32 v[48:49], v[62:63], s[56:57] op_sel:[0,1] op_sel_hi:[0,0] neg_lo:[0,1] neg_hi:[0,0]
v_pk_fma_f32 v[62:63], v[62:63], s[56:57], v[48:49] op_sel:[1,0,0] op_sel_hi:[1,1,1] neg_lo:[0,1,0] neg_hi:[0,1,0]
v_pk_mul_f32 v[48:49], v[22:23], s[54:55] op_sel:[0,1] op_sel_hi:[0,0] neg_lo:[0,1] neg_hi:[0,0]
v_pk_fma_f32 v[22:23], v[22:23], s[54:55], v[48:49] op_sel:[1,0,0] op_sel_hi:[1,1,1] neg_lo:[0,1,0] neg_hi:[0,1,0]
v_pk_mul_f32 v[48:49], v[54:55], s[52:53] op_sel:[0,1] op_sel_hi:[0,0] neg_lo:[0,1] neg_hi:[0,0]
v_pk_fma_f32 v[54:55], v[54:55], s[52:53], v[48:49] op_sel:[1,0,0] op_sel_hi:[1,1,1] neg_lo:[0,1,0] neg_hi:[0,1,0]
v_pk_mul_f32 v[48:49], v[38:39], s[50:51] op_sel:[0,1] op_sel_hi:[0,0] neg_lo:[0,1] neg_hi:[0,0]
v_pk_fma_f32 v[38:39], v[38:39], s[50:51], v[48:49] op_sel:[1,0,0] op_sel_hi:[1,1,1] neg_lo:[0,1,0] neg_hi:[0,1,0]
v_pk_mul_f32 v[48:49], v[70:71], s[48:49] op_sel:[0,1] op_sel_hi:[0,0] neg_lo:[0,1] neg_hi:[0,0]
v_pk_fma_f32 v[70:71], v[70:71], s[48:49], v[48:49] op_sel:[1,0,0] op_sel_hi:[1,1,1] neg_lo:[0,1,0] neg_hi:[0,1,0]
v_pk_add_f32 v[78:79], v[78:79], 0 op_sel:[1,0] op_sel_hi:[0,0] neg_lo:[1,0] neg_hi:[0,0]
v_pk_mul_f32 v[48:49], v[32:33], s[48:49] op_sel:[0,1] op_sel_hi:[0,0] neg_lo:[0,0] neg_hi:[0,0]
v_pk_fma_f32 v[32:33], v[32:33], s[48:49], v[48:49] op_sel:[1,0,0] op_sel_hi:[1,1,1] neg_lo:[0,1,0] neg_hi:[0,0,0]
v_pk_mul_f32 v[48:49], v[24:25], s[50:51] op_sel:[0,1] op_sel_hi:[0,0] neg_lo:[0,0] neg_hi:[0,0]
v_pk_fma_f32 v[24:25], v[24:25], s[50:51], v[48:49] op_sel:[1,0,0] op_sel_hi:[1,1,1] neg_lo:[0,1,0] neg_hi:[0,0,0]
v_pk_mul_f32 v[48:49], v[56:57], s[52:53] op_sel:[0,1] op_sel_hi:[0,0] neg_lo:[0,0] neg_hi:[0,0]
v_pk_fma_f32 v[56:57], v[56:57], s[52:53], v[48:49] op_sel:[1,0,0] op_sel_hi:[1,1,1] neg_lo:[0,1,0] neg_hi:[0,0,0]
v_pk_mul_f32 v[48:49], v[20:21], s[54:55] op_sel:[0,1] op_sel_hi:[0,0] neg_lo:[0,0] neg_hi:[0,0]
v_pk_fma_f32 v[20:21], v[20:21], s[54:55], v[48:49] op_sel:[1,0,0] op_sel_hi:[1,1,1] neg_lo:[0,1,0] neg_hi:[0,0,0]
v_pk_mul_f32 v[48:49], v[52:53], s[56:57] op_sel:[0,1] op_sel_hi:[0,0] neg_lo:[0,0] neg_hi:[0,0]
v_pk_fma_f32 v[52:53], v[52:53], s[56:57], v[48:49] op_sel:[1,0,0] op_sel_hi:[1,1,1] neg_lo:[0,1,0] neg_hi:[0,0,0]
v_pk_mul_f32 v[48:49], v[36:37], s[58:59] op_sel:[0,1] op_sel_hi:[0,0] neg_lo:[0,0] neg_hi:[0,0]
v_pk_fma_f32 v[36:37], v[36:37], s[58:59], v[48:49] op_sel:[1,0,0] op_sel_hi:[1,1,1] neg_lo:[0,1,0] neg_hi:[0,0,0]
v_pk_mul_f32 v[48:49], v[68:69], s[60:61] op_sel:[0,1] op_sel_hi:[0,0] neg_lo:[0,0] neg_hi:[0,0]
v_pk_fma_f32 v[68:69], v[68:69], s[60:61], v[48:49] op_sel:[1,0,0] op_sel_hi:[1,1,1] neg_lo:[0,1,0] neg_hi:[0,0,0]
v_pk_mul_f32 v[48:49], v[18:19], s[62:63] op_sel:[0,0] op_sel_hi:[0,1] neg_lo:[0,0] neg_hi:[0,0]
v_pk_fma_f32 v[18:19], v[18:19], s[62:63], v[48:49] op_sel:[1,1,0] op_sel_hi:[1,0,1] neg_lo:[0,1,0] neg_hi:[0,0,0]
v_pk_mul_f32 v[48:49], v[50:51], s[60:61] op_sel:[0,0] op_sel_hi:[0,1] neg_lo:[0,0] neg_hi:[0,0]
v_pk_fma_f32 v[50:51], v[50:51], s[60:61], v[48:49] op_sel:[1,1,0] op_sel_hi:[1,0,1] neg_lo:[0,1,0] neg_hi:[0,0,0]
v_pk_mul_f32 v[48:49], v[34:35], s[58:59] op_sel:[0,0] op_sel_hi:[0,1] neg_lo:[0,0] neg_hi:[0,0]
v_pk_fma_f32 v[34:35], v[34:35], s[58:59], v[48:49] op_sel:[1,1,0] op_sel_hi:[1,0,1] neg_lo:[0,1,0] neg_hi:[0,0,0]
v_pk_mul_f32 v[48:49], v[66:67], s[56:57] op_sel:[0,0] op_sel_hi:[0,1] neg_lo:[0,0] neg_hi:[0,0]
v_pk_fma_f32 v[66:67], v[66:67], s[56:57], v[48:49] op_sel:[1,1,0] op_sel_hi:[1,0,1] neg_lo:[0,1,0] neg_hi:[0,0,0]
v_pk_mul_f32 v[48:49], v[26:27], s[54:55] op_sel:[0,0] op_sel_hi:[0,1] neg_lo:[0,0] neg_hi:[0,0]
v_pk_fma_f32 v[26:27], v[26:27], s[54:55], v[48:49] op_sel:[1,1,0] op_sel_hi:[1,0,1] neg_lo:[0,1,0] neg_hi:[0,0,0]
v_pk_mul_f32 v[48:49], v[58:59], s[52:53] op_sel:[0,0] op_sel_hi:[0,1] neg_lo:[0,0] neg_hi:[0,0]
v_pk_fma_f32 v[58:59], v[58:59], s[52:53], v[48:49] op_sel:[1,1,0] op_sel_hi:[1,0,1] neg_lo:[0,1,0] neg_hi:[0,0,0]
v_pk_mul_f32 v[48:49], v[42:43], s[50:51] op_sel:[0,0] op_sel_hi:[0,1] neg_lo:[0,0] neg_hi:[0,0]
v_pk_fma_f32 v[42:43], v[42:43], s[50:51], v[48:49] op_sel:[1,1,0] op_sel_hi:[1,0,1] neg_lo:[0,1,0] neg_hi:[0,0,0]
v_pk_mul_f32 v[48:49], v[74:75], s[48:49] op_sel:[0,0] op_sel_hi:[0,1] neg_lo:[0,0] neg_hi:[0,0]
v_pk_fma_f32 v[74:75], v[74:75], s[48:49], v[48:49] op_sel:[1,1,0] op_sel_hi:[1,0,1] neg_lo:[0,1,0] neg_hi:[0,0,0]
s_mov_b64 exec, -1
v_fmac_f32_dpp v16, v16, v9 quad_perm:[1,0,3,2] row_mask:0xf bank_mask:0xf
v_fmac_f32_dpp v17, v17, v9 quad_perm:[1,0,3,2] row_mask:0xf bank_mask:0xf
v_fmac_f32_dpp v14, v14, v9 quad_perm:[1,0,3,2] row_mask:0xf bank_mask:0xf
v_fmac_f32_dpp v15, v15, v9 quad_perm:[1,0,3,2] row_mask:0xf bank_mask:0xf
v_fmac_f32_dpp v64, v64, v9 quad_perm:[1,0,3,2] row_mask:0xf bank_mask:0xf
v_fmac_f32_dpp v65, v65, v9 quad_perm:[1,0,3,2] row_mask:0xf bank_mask:0xf
v_fmac_f32_dpp v40, v40, v9 quad_perm:[1,0,3,2] row_mask:0xf bank_mask:0xf
v_fmac_f32_dpp v41, v41, v9 quad_perm:[1,0,3,2] row_mask:0xf bank_mask:0xf
v_fmac_f32_dpp v72, v72, v9 quad_perm:[1,0,3,2] row_mask:0xf bank_mask:0xf
v_fmac_f32_dpp v73, v73, v9 quad_perm:[1,0,3,2] row_mask:0xf bank_mask:0xf
v_fmac_f32_dpp v44, v44, v9 quad_perm:[1,0,3,2] row_mask:0xf bank_mask:0xf
v_fmac_f32_dpp v45, v45, v9 quad_perm:[1,0,3,2] row_mask:0xf bank_mask:0xf
v_fmac_f32_dpp v28, v28, v9 quad_perm:[1,0,3,2] row_mask:0xf bank_mask:0xf
v_fmac_f32_dpp v29, v29, v9 quad_perm:[1,0,3,2] row_mask:0xf bank_mask:0xf
v_fmac_f32_dpp v60, v60, v9 quad_perm:[1,0,3,2] row_mask:0xf bank_mask:0xf
v_fmac_f32_dpp v61, v61, v9 quad_perm:[1,0,3,2] row_mask:0xf bank_mask:0xf
v_fmac_f32_dpp v76, v76, v9 quad_perm:[1,0,3,2] row_mask:0xf bank_mask:0xf
v_fmac_f32_dpp v77, v77, v9 quad_perm:[1,0,3,2] row_mask:0xf bank_mask:0xf
v_fmac_f32_dpp v46, v46, v9 quad_perm:[1,0,3,2] row_mask:0xf bank_mask:0xf
v_fmac_f32_dpp v47, v47, v9 quad_perm:[1,0,3,2] row_mask:0xf bank_mask:0xf
v_fmac_f32_dpp v30, v30, v9 quad_perm:[1,0,3,2] row_mask:0xf bank_mask:0xf
v_fmac_f32_dpp v31, v31, v9 quad_perm:[1,0,3,2] row_mask:0xf bank_mask:0xf
v_fmac_f32_dpp v62, v62, v9 quad_perm:[1,0,3,2] row_mask:0xf bank_mask:0xf
v_fmac_f32_dpp v63, v63, v9 quad_perm:[1,0,3,2] row_mask:0xf bank_mask:0xf
v_fmac_f32_dpp v22, v22, v9 quad_perm:[1,0,3,2] row_mask:0xf bank_mask:0xf
v_fmac_f32_dpp v23, v23, v9 quad_perm:[1,0,3,2] row_mask:0xf bank_mask:0xf
v_fmac_f32_dpp v54, v54, v9 quad_perm:[1,0,3,2] row_mask:0xf bank_mask:0xf
v_fmac_f32_dpp v55, v55, v9 quad_perm:[1,0,3,2] row_mask:0xf bank_mask:0xf
v_fmac_f32_dpp v38, v38, v9 quad_perm:[1,0,3,2] row_mask:0xf bank_mask:0xf
v_fmac_f32_dpp v39, v39, v9 quad_perm:[1,0,3,2] row_mask:0xf bank_mask:0xf
v_fmac_f32_dpp v70, v70, v9 quad_perm:[1,0,3,2] row_mask:0xf bank_mask:0xf
v_fmac_f32_dpp v71, v71, v9 quad_perm:[1,0,3,2] row_mask:0xf bank_mask:0xf
v_fmac_f32_dpp v78, v78, v9 quad_perm:[1,0,3,2] row_mask:0xf bank_mask:0xf
v_fmac_f32_dpp v79, v79, v9 quad_perm:[1,0,3,2] row_mask:0xf bank_mask:0xf
v_fmac_f32_dpp v32, v32, v9 quad_perm:[1,0,3,2] row_mask:0xf bank_mask:0xf
v_fmac_f32_dpp v33, v33, v9 quad_perm:[1,0,3,2] row_mask:0xf bank_mask:0xf
v_fmac_f32_dpp v24, v24, v9 quad_perm:[1,0,3,2] row_mask:0xf bank_mask:0xf
v_fmac_f32_dpp v25, v25, v9 quad_perm:[1,0,3,2] row_mask:0xf bank_mask:0xf
v_fmac_f32_dpp v56, v56, v9 quad_perm:[1,0,3,2] row_mask:0xf bank_mask:0xf
v_fmac_f32_dpp v57, v57, v9 quad_perm:[1,0,3,2] row_mask:0xf bank_mask:0xf
v_fmac_f32_dpp v20, v20, v9 quad_perm:[1,0,3,2] row_mask:0xf bank_mask:0xf
v_fmac_f32_dpp v21, v21, v9 quad_perm:[1,0,3,2] row_mask:0xf bank_mask:0xf
v_fmac_f32_dpp v52, v52, v9 quad_perm:[1,0,3,2] row_mask:0xf bank_mask:0xf
v_fmac_f32_dpp v53, v53, v9 quad_perm:[1,0,3,2] row_mask:0xf bank_mask:0xf
v_fmac_f32_dpp v36, v36, v9 quad_perm:[1,0,3,2] row_mask:0xf bank_mask:0xf
v_fmac_f32_dpp v37, v37, v9 quad_perm:[1,0,3,2] row_mask:0xf bank_mask:0xf
v_fmac_f32_dpp v68, v68, v9 quad_perm:[1,0,3,2] row_mask:0xf bank_mask:0xf
v_fmac_f32_dpp v69, v69, v9 quad_perm:[1,0,3,2] row_mask:0xf bank_mask:0xf
v_fmac_f32_dpp v18, v18, v9 quad_perm:[1,0,3,2] row_mask:0xf bank_mask:0xf
v_fmac_f32_dpp v19, v19, v9 quad_perm:[1,0,3,2] row_mask:0xf bank_mask:0xf
v_fmac_f32_dpp v50, v50, v9 quad_perm:[1,0,3,2] row_mask:0xf bank_mask:0xf
v_fmac_f32_dpp v51, v51, v9 quad_perm:[1,0,3,2] row_mask:0xf bank_mask:0xf
v_fmac_f32_dpp v34, v34, v9 quad_perm:[1,0,3,2] row_mask:0xf bank_mask:0xf
v_fmac_f32_dpp v35, v35, v9 quad_perm:[1,0,3,2] row_mask:0xf bank_mask:0xf
v_fmac_f32_dpp v66, v66, v9 quad_perm:[1,0,3,2] row_mask:0xf bank_mask:0xf
v_fmac_f32_dpp v67, v67, v9 quad_perm:[1,0,3,2] row_mask:0xf bank_mask:0xf
v_fmac_f32_dpp v26, v26, v9 quad_perm:[1,0,3,2] row_mask:0xf bank_mask:0xf
v_fmac_f32_dpp v27, v27, v9 quad_perm:[1,0,3,2] row_mask:0xf bank_mask:0xf
v_fmac_f32_dpp v58, v58, v9 quad_perm:[1,0,3,2] row_mask:0xf bank_mask:0xf
v_fmac_f32_dpp v59, v59, v9 quad_perm:[1,0,3,2] row_mask:0xf bank_mask:0xf
v_fmac_f32_dpp v42, v42, v9 quad_perm:[1,0,3,2] row_mask:0xf bank_mask:0xf
v_fmac_f32_dpp v43, v43, v9 quad_perm:[1,0,3,2] row_mask:0xf bank_mask:0xf
v_fmac_f32_dpp v74, v74, v9 quad_perm:[1,0,3,2] row_mask:0xf bank_mask:0xf
v_fmac_f32_dpp v75, v75, v9 quad_perm:[1,0,3,2] row_mask:0xf bank_mask:0xf
v_lshlrev_b32 v240, 16, v208
v_and_b32 v241, 0xffff0000, v208
v_pk_mul_f32 v[48:49], v[16:17], v[240:241] op_sel:[0,0] op_sel_hi:[0,1] neg_lo:[0,0] neg_hi:[0,0]
v_pk_fma_f32 v[16:17], v[16:17], v[240:241], v[48:49] op_sel:[1,1,0] op_sel_hi:[1,0,1] neg_lo:[0,1,0] neg_hi:[0,0,0]
v_lshlrev_b32 v240, 16, v209
v_and_b32 v241, 0xffff0000, v209
v_pk_mul_f32 v[48:49], v[14:15], v[240:241] op_sel:[0,0] op_sel_hi:[0,1] neg_lo:[0,0] neg_hi:[0,0]
v_pk_fma_f32 v[14:15], v[14:15], v[240:241], v[48:49] op_sel:[1,1,0] op_sel_hi:[1,0,1] neg_lo:[0,1,0] neg_hi:[0,0,0]
v_lshlrev_b32 v240, 16, v210
v_and_b32 v241, 0xffff0000, v210
v_pk_mul_f32 v[48:49], v[64:65], v[240:241] op_sel:[0,0] op_sel_hi:[0,1] neg_lo:[0,0] neg_hi:[0,0]
v_pk_fma_f32 v[64:65], v[64:65], v[240:241], v[48:49] op_sel:[1,1,0] op_sel_hi:[1,0,1] neg_lo:[0,1,0] neg_hi:[0,0,0]
v_lshlrev_b32 v240, 16, v211
v_and_b32 v241, 0xffff0000, v211
v_pk_mul_f32 v[48:49], v[40:41], v[240:241] op_sel:[0,0] op_sel_hi:[0,1] neg_lo:[0,0] neg_hi:[0,0]
v_pk_fma_f32 v[40:41], v[40:41], v[240:241], v[48:49] op_sel:[1,1,0] op_sel_hi:[1,0,1] neg_lo:[0,1,0] neg_hi:[0,0,0]
v_lshlrev_b32 v240, 16, v212
v_and_b32 v241, 0xffff0000, v212
v_pk_mul_f32 v[48:49], v[72:73], v[240:241] op_sel:[0,0] op_sel_hi:[0,1] neg_lo:[0,0] neg_hi:[0,0]
v_pk_fma_f32 v[72:73], v[72:73], v[240:241], v[48:49] op_sel:[1,1,0] op_sel_hi:[1,0,1] neg_lo:[0,1,0] neg_hi:[0,0,0]
v_lshlrev_b32 v240, 16, v213
v_and_b32 v241, 0xffff0000, v213
v_pk_mul_f32 v[48:49], v[44:45], v[240:241] op_sel:[0,0] op_sel_hi:[0,1] neg_lo:[0,0] neg_hi:[0,0]
v_pk_fma_f32 v[44:45], v[44:45], v[240:241], v[48:49] op_sel:[1,1,0] op_sel_hi:[1,0,1] neg_lo:[0,1,0] neg_hi:[0,0,0]
v_lshlrev_b32 v240, 16, v214
v_and_b32 v241, 0xffff0000, v214
v_pk_mul_f32 v[48:49], v[28:29], v[240:241] op_sel:[0,0] op_sel_hi:[0,1] neg_lo:[0,0] neg_hi:[0,0]
v_pk_fma_f32 v[28:29], v[28:29], v[240:241], v[48:49] op_sel:[1,1,0] op_sel_hi:[1,0,1] neg_lo:[0,1,0] neg_hi:[0,0,0]
v_lshlrev_b32 v240, 16, v215
v_and_b32 v241, 0xffff0000, v215
v_pk_mul_f32 v[48:49], v[60:61], v[240:241] op_sel:[0,0] op_sel_hi:[0,1] neg_lo:[0,0] neg_hi:[0,0]
v_pk_fma_f32 v[60:61], v[60:61], v[240:241], v[48:49] op_sel:[1,1,0] op_sel_hi:[1,0,1] neg_lo:[0,1,0] neg_hi:[0,0,0]
v_lshlrev_b32 v240, 16, v216
v_and_b32 v241, 0xffff0000, v216
v_pk_mul_f32 v[48:49], v[76:77], v[240:241] op_sel:[0,0] op_sel_hi:[0,1] neg_lo:[0,0] neg_hi:[0,0]
v_pk_fma_f32 v[76:77], v[76:77], v[240:241], v[48:49] op_sel:[1,1,0] op_sel_hi:[1,0,1] neg_lo:[0,1,0] neg_hi:[0,0,0]
v_lshlrev_b32 v240, 16, v217
v_and_b32 v241, 0xffff0000, v217
v_pk_mul_f32 v[48:49], v[46:47], v[240:241] op_sel:[0,0] op_sel_hi:[0,1] neg_lo:[0,0] neg_hi:[0,0]
v_pk_fma_f32 v[46:47], v[46:47], v[240:241], v[48:49] op_sel:[1,1,0] op_sel_hi:[1,0,1] neg_lo:[0,1,0] neg_hi:[0,0,0]
v_lshlrev_b32 v240, 16, v218
v_and_b32 v241, 0xffff0000, v218
v_pk_mul_f32 v[48:49], v[30:31], v[240:241] op_sel:[0,0] op_sel_hi:[0,1] neg_lo:[0,0] neg_hi:[0,0]
v_pk_fma_f32 v[30:31], v[30:31], v[240:241], v[48:49] op_sel:[1,1,0] op_sel_hi:[1,0,1] neg_lo:[0,1,0] neg_hi:[0,0,0]
v_lshlrev_b32 v240, 16, v219
v_and_b32 v241, 0xffff0000, v219
v_pk_mul_f32 v[48:49], v[62:63], v[240:241] op_sel:[0,0] op_sel_hi:[0,1] neg_lo:[0,0] neg_hi:[0,0]
v_pk_fma_f32 v[62:63], v[62:63], v[240:241], v[48:49] op_sel:[1,1,0] op_sel_hi:[1,0,1] neg_lo:[0,1,0] neg_hi:[0,0,0]
v_lshlrev_b32 v240, 16, v220
v_and_b32 v241, 0xffff0000, v220
v_pk_mul_f32 v[48:49], v[22:23], v[240:241] op_sel:[0,0] op_sel_hi:[0,1] neg_lo:[0,0] neg_hi:[0,0]
v_pk_fma_f32 v[22:23], v[22:23], v[240:241], v[48:49] op_sel:[1,1,0] op_sel_hi:[1,0,1] neg_lo:[0,1,0] neg_hi:[0,0,0]
v_lshlrev_b32 v240, 16, v221
v_and_b32 v241, 0xffff0000, v221
v_pk_mul_f32 v[48:49], v[54:55], v[240:241] op_sel:[0,0] op_sel_hi:[0,1] neg_lo:[0,0] neg_hi:[0,0]
v_pk_fma_f32 v[54:55], v[54:55], v[240:241], v[48:49] op_sel:[1,1,0] op_sel_hi:[1,0,1] neg_lo:[0,1,0] neg_hi:[0,0,0]
v_lshlrev_b32 v240, 16, v222
v_and_b32 v241, 0xffff0000, v222
v_pk_mul_f32 v[48:49], v[38:39], v[240:241] op_sel:[0,0] op_sel_hi:[0,1] neg_lo:[0,0] neg_hi:[0,0]
v_pk_fma_f32 v[38:39], v[38:39], v[240:241], v[48:49] op_sel:[1,1,0] op_sel_hi:[1,0,1] neg_lo:[0,1,0] neg_hi:[0,0,0]
v_lshlrev_b32 v240, 16, v223
v_and_b32 v241, 0xffff0000, v223
v_pk_mul_f32 v[48:49], v[70:71], v[240:241] op_sel:[0,0] op_sel_hi:[0,1] neg_lo:[0,0] neg_hi:[0,0]
v_pk_fma_f32 v[70:71], v[70:71], v[240:241], v[48:49] op_sel:[1,1,0] op_sel_hi:[1,0,1] neg_lo:[0,1,0] neg_hi:[0,0,0]
v_lshlrev_b32 v240, 16, v224
v_and_b32 v241, 0xffff0000, v224
v_pk_mul_f32 v[48:49], v[78:79], v[240:241] op_sel:[0,0] op_sel_hi:[0,1] neg_lo:[0,0] neg_hi:[0,0]
v_pk_fma_f32 v[78:79], v[78:79], v[240:241], v[48:49] op_sel:[1,1,0] op_sel_hi:[1,0,1] neg_lo:[0,1,0] neg_hi:[0,0,0]
v_lshlrev_b32 v240, 16, v225
v_and_b32 v241, 0xffff0000, v225
v_pk_mul_f32 v[48:49], v[32:33], v[240:241] op_sel:[0,0] op_sel_hi:[0,1] neg_lo:[0,0] neg_hi:[0,0]
v_pk_fma_f32 v[32:33], v[32:33], v[240:241], v[48:49] op_sel:[1,1,0] op_sel_hi:[1,0,1] neg_lo:[0,1,0] neg_hi:[0,0,0]
v_lshlrev_b32 v240, 16, v226
v_and_b32 v241, 0xffff0000, v226
v_pk_mul_f32 v[48:49], v[24:25], v[240:241] op_sel:[0,0] op_sel_hi:[0,1] neg_lo:[0,0] neg_hi:[0,0]
v_pk_fma_f32 v[24:25], v[24:25], v[240:241], v[48:49] op_sel:[1,1,0] op_sel_hi:[1,0,1] neg_lo:[0,1,0] neg_hi:[0,0,0]
v_lshlrev_b32 v240, 16, v227
v_and_b32 v241, 0xffff0000, v227
v_pk_mul_f32 v[48:49], v[56:57], v[240:241] op_sel:[0,0] op_sel_hi:[0,1] neg_lo:[0,0] neg_hi:[0,0]
v_pk_fma_f32 v[56:57], v[56:57], v[240:241], v[48:49] op_sel:[1,1,0] op_sel_hi:[1,0,1] neg_lo:[0,1,0] neg_hi:[0,0,0]
v_lshlrev_b32 v240, 16, v228
v_and_b32 v241, 0xffff0000, v228
v_pk_mul_f32 v[48:49], v[20:21], v[240:241] op_sel:[0,0] op_sel_hi:[0,1] neg_lo:[0,0] neg_hi:[0,0]
v_pk_fma_f32 v[20:21], v[20:21], v[240:241], v[48:49] op_sel:[1,1,0] op_sel_hi:[1,0,1] neg_lo:[0,1,0] neg_hi:[0,0,0]
v_lshlrev_b32 v240, 16, v229
v_and_b32 v241, 0xffff0000, v229
v_pk_mul_f32 v[48:49], v[52:53], v[240:241] op_sel:[0,0] op_sel_hi:[0,1] neg_lo:[0,0] neg_hi:[0,0]
v_pk_fma_f32 v[52:53], v[52:53], v[240:241], v[48:49] op_sel:[1,1,0] op_sel_hi:[1,0,1] neg_lo:[0,1,0] neg_hi:[0,0,0]
v_lshlrev_b32 v240, 16, v230
v_and_b32 v241, 0xffff0000, v230
v_pk_mul_f32 v[48:49], v[36:37], v[240:241] op_sel:[0,0] op_sel_hi:[0,1] neg_lo:[0,0] neg_hi:[0,0]
v_pk_fma_f32 v[36:37], v[36:37], v[240:241], v[48:49] op_sel:[1,1,0] op_sel_hi:[1,0,1] neg_lo:[0,1,0] neg_hi:[0,0,0]
v_lshlrev_b32 v240, 16, v231
v_and_b32 v241, 0xffff0000, v231
v_pk_mul_f32 v[48:49], v[68:69], v[240:241] op_sel:[0,0] op_sel_hi:[0,1] neg_lo:[0,0] neg_hi:[0,0]
v_pk_fma_f32 v[68:69], v[68:69], v[240:241], v[48:49] op_sel:[1,1,0] op_sel_hi:[1,0,1] neg_lo:[0,1,0] neg_hi:[0,0,0]
v_lshlrev_b32 v240, 16, v232
v_and_b32 v241, 0xffff0000, v232
v_pk_mul_f32 v[48:49], v[18:19], v[240:241] op_sel:[0,0] op_sel_hi:[0,1] neg_lo:[0,0] neg_hi:[0,0]
v_pk_fma_f32 v[18:19], v[18:19], v[240:241], v[48:49] op_sel:[1,1,0] op_sel_hi:[1,0,1] neg_lo:[0,1,0] neg_hi:[0,0,0]
v_lshlrev_b32 v240, 16, v233
v_and_b32 v241, 0xffff0000, v233
v_pk_mul_f32 v[48:49], v[50:51], v[240:241] op_sel:[0,0] op_sel_hi:[0,1] neg_lo:[0,0] neg_hi:[0,0]
v_pk_fma_f32 v[50:51], v[50:51], v[240:241], v[48:49] op_sel:[1,1,0] op_sel_hi:[1,0,1] neg_lo:[0,1,0] neg_hi:[0,0,0]
v_lshlrev_b32 v240, 16, v234
v_and_b32 v241, 0xffff0000, v234
v_pk_mul_f32 v[48:49], v[34:35], v[240:241] op_sel:[0,0] op_sel_hi:[0,1] neg_lo:[0,0] neg_hi:[0,0]
v_pk_fma_f32 v[34:35], v[34:35], v[240:241], v[48:49] op_sel:[1,1,0] op_sel_hi:[1,0,1] neg_lo:[0,1,0] neg_hi:[0,0,0]
v_lshlrev_b32 v240, 16, v235
v_and_b32 v241, 0xffff0000, v235
v_pk_mul_f32 v[48:49], v[66:67], v[240:241] op_sel:[0,0] op_sel_hi:[0,1] neg_lo:[0,0] neg_hi:[0,0]
v_pk_fma_f32 v[66:67], v[66:67], v[240:241], v[48:49] op_sel:[1,1,0] op_sel_hi:[1,0,1] neg_lo:[0,1,0] neg_hi:[0,0,0]
v_lshlrev_b32 v240, 16, v236
v_and_b32 v241, 0xffff0000, v236
v_pk_mul_f32 v[48:49], v[26:27], v[240:241] op_sel:[0,0] op_sel_hi:[0,1] neg_lo:[0,0] neg_hi:[0,0]
v_pk_fma_f32 v[26:27], v[26:27], v[240:241], v[48:49] op_sel:[1,1,0] op_sel_hi:[1,0,1] neg_lo:[0,1,0] neg_hi:[0,0,0]
v_lshlrev_b32 v240, 16, v237
v_and_b32 v241, 0xffff0000, v237
v_pk_mul_f32 v[48:49], v[58:59], v[240:241] op_sel:[0,0] op_sel_hi:[0,1] neg_lo:[0,0] neg_hi:[0,0]
v_pk_fma_f32 v[58:59], v[58:59], v[240:241], v[48:49] op_sel:[1,1,0] op_sel_hi:[1,0,1] neg_lo:[0,1,0] neg_hi:[0,0,0]
v_lshlrev_b32 v240, 16, v238
v_and_b32 v241, 0xffff0000, v238
v_pk_mul_f32 v[48:49], v[42:43], v[240:241] op_sel:[0,0] op_sel_hi:[0,1] neg_lo:[0,0] neg_hi:[0,0]
v_pk_fma_f32 v[42:43], v[42:43], v[240:241], v[48:49] op_sel:[1,1,0] op_sel_hi:[1,0,1] neg_lo:[0,1,0] neg_hi:[0,0,0]
v_lshlrev_b32 v240, 16, v239
v_and_b32 v241, 0xffff0000, v239
v_pk_mul_f32 v[48:49], v[74:75], v[240:241] op_sel:[0,0] op_sel_hi:[0,1] neg_lo:[0,0] neg_hi:[0,0]
v_pk_fma_f32 v[74:75], v[74:75], v[240:241], v[48:49] op_sel:[1,1,0] op_sel_hi:[1,0,1] neg_lo:[0,1,0] neg_hi:[0,0,0]
v_fmac_f32_dpp v16, v16, v7 quad_perm:[1,0,3,2] row_mask:0xf bank_mask:0xf
v_fmac_f32_dpp v17, v17, v7 quad_perm:[1,0,3,2] row_mask:0xf bank_mask:0xf
v_fmac_f32_dpp v14, v14, v7 quad_perm:[1,0,3,2] row_mask:0xf bank_mask:0xf
v_fmac_f32_dpp v15, v15, v7 quad_perm:[1,0,3,2] row_mask:0xf bank_mask:0xf
v_fmac_f32_dpp v64, v64, v7 quad_perm:[1,0,3,2] row_mask:0xf bank_mask:0xf
v_fmac_f32_dpp v65, v65, v7 quad_perm:[1,0,3,2] row_mask:0xf bank_mask:0xf
v_fmac_f32_dpp v40, v40, v7 quad_perm:[1,0,3,2] row_mask:0xf bank_mask:0xf
v_fmac_f32_dpp v41, v41, v7 quad_perm:[1,0,3,2] row_mask:0xf bank_mask:0xf
v_fmac_f32_dpp v72, v72, v7 quad_perm:[1,0,3,2] row_mask:0xf bank_mask:0xf
v_fmac_f32_dpp v73, v73, v7 quad_perm:[1,0,3,2] row_mask:0xf bank_mask:0xf
v_fmac_f32_dpp v44, v44, v7 quad_perm:[1,0,3,2] row_mask:0xf bank_mask:0xf
v_fmac_f32_dpp v45, v45, v7 quad_perm:[1,0,3,2] row_mask:0xf bank_mask:0xf
v_fmac_f32_dpp v28, v28, v7 quad_perm:[1,0,3,2] row_mask:0xf bank_mask:0xf
v_fmac_f32_dpp v29, v29, v7 quad_perm:[1,0,3,2] row_mask:0xf bank_mask:0xf
v_fmac_f32_dpp v60, v60, v7 quad_perm:[1,0,3,2] row_mask:0xf bank_mask:0xf
v_fmac_f32_dpp v61, v61, v7 quad_perm:[1,0,3,2] row_mask:0xf bank_mask:0xf
v_fmac_f32_dpp v76, v76, v7 quad_perm:[1,0,3,2] row_mask:0xf bank_mask:0xf
v_fmac_f32_dpp v77, v77, v7 quad_perm:[1,0,3,2] row_mask:0xf bank_mask:0xf
v_fmac_f32_dpp v46, v46, v7 quad_perm:[1,0,3,2] row_mask:0xf bank_mask:0xf
v_fmac_f32_dpp v47, v47, v7 quad_perm:[1,0,3,2] row_mask:0xf bank_mask:0xf
v_fmac_f32_dpp v30, v30, v7 quad_perm:[1,0,3,2] row_mask:0xf bank_mask:0xf
v_fmac_f32_dpp v31, v31, v7 quad_perm:[1,0,3,2] row_mask:0xf bank_mask:0xf
v_fmac_f32_dpp v62, v62, v7 quad_perm:[1,0,3,2] row_mask:0xf bank_mask:0xf
v_fmac_f32_dpp v63, v63, v7 quad_perm:[1,0,3,2] row_mask:0xf bank_mask:0xf
v_fmac_f32_dpp v22, v22, v7 quad_perm:[1,0,3,2] row_mask:0xf bank_mask:0xf
v_fmac_f32_dpp v23, v23, v7 quad_perm:[1,0,3,2] row_mask:0xf bank_mask:0xf
v_fmac_f32_dpp v54, v54, v7 quad_perm:[1,0,3,2] row_mask:0xf bank_mask:0xf
v_fmac_f32_dpp v55, v55, v7 quad_perm:[1,0,3,2] row_mask:0xf bank_mask:0xf
v_fmac_f32_dpp v38, v38, v7 quad_perm:[1,0,3,2] row_mask:0xf bank_mask:0xf
v_fmac_f32_dpp v39, v39, v7 quad_perm:[1,0,3,2] row_mask:0xf bank_mask:0xf
v_fmac_f32_dpp v70, v70, v7 quad_perm:[1,0,3,2] row_mask:0xf bank_mask:0xf
v_fmac_f32_dpp v71, v71, v7 quad_perm:[1,0,3,2] row_mask:0xf bank_mask:0xf
v_fmac_f32_dpp v78, v78, v7 quad_perm:[1,0,3,2] row_mask:0xf bank_mask:0xf
v_fmac_f32_dpp v79, v79, v7 quad_perm:[1,0,3,2] row_mask:0xf bank_mask:0xf
v_fmac_f32_dpp v32, v32, v7 quad_perm:[1,0,3,2] row_mask:0xf bank_mask:0xf
v_fmac_f32_dpp v33, v33, v7 quad_perm:[1,0,3,2] row_mask:0xf bank_mask:0xf
v_fmac_f32_dpp v24, v24, v7 quad_perm:[1,0,3,2] row_mask:0xf bank_mask:0xf
v_fmac_f32_dpp v25, v25, v7 quad_perm:[1,0,3,2] row_mask:0xf bank_mask:0xf
v_fmac_f32_dpp v56, v56, v7 quad_perm:[1,0,3,2] row_mask:0xf bank_mask:0xf
v_fmac_f32_dpp v57, v57, v7 quad_perm:[1,0,3,2] row_mask:0xf bank_mask:0xf
v_fmac_f32_dpp v20, v20, v7 quad_perm:[1,0,3,2] row_mask:0xf bank_mask:0xf
v_fmac_f32_dpp v21, v21, v7 quad_perm:[1,0,3,2] row_mask:0xf bank_mask:0xf
v_fmac_f32_dpp v52, v52, v7 quad_perm:[1,0,3,2] row_mask:0xf bank_mask:0xf
v_fmac_f32_dpp v53, v53, v7 quad_perm:[1,0,3,2] row_mask:0xf bank_mask:0xf
v_fmac_f32_dpp v36, v36, v7 quad_perm:[1,0,3,2] row_mask:0xf bank_mask:0xf
v_fmac_f32_dpp v37, v37, v7 quad_perm:[1,0,3,2] row_mask:0xf bank_mask:0xf
v_fmac_f32_dpp v68, v68, v7 quad_perm:[1,0,3,2] row_mask:0xf bank_mask:0xf
v_fmac_f32_dpp v69, v69, v7 quad_perm:[1,0,3,2] row_mask:0xf bank_mask:0xf
v_fmac_f32_dpp v18, v18, v7 quad_perm:[1,0,3,2] row_mask:0xf bank_mask:0xf
v_fmac_f32_dpp v19, v19, v7 quad_perm:[1,0,3,2] row_mask:0xf bank_mask:0xf
v_fmac_f32_dpp v50, v50, v7 quad_perm:[1,0,3,2] row_mask:0xf bank_mask:0xf
v_fmac_f32_dpp v51, v51, v7 quad_perm:[1,0,3,2] row_mask:0xf bank_mask:0xf
v_fmac_f32_dpp v34, v34, v7 quad_perm:[1,0,3,2] row_mask:0xf bank_mask:0xf
v_fmac_f32_dpp v35, v35, v7 quad_perm:[1,0,3,2] row_mask:0xf bank_mask:0xf
v_fmac_f32_dpp v66, v66, v7 quad_perm:[1,0,3,2] row_mask:0xf bank_mask:0xf
v_fmac_f32_dpp v67, v67, v7 quad_perm:[1,0,3,2] row_mask:0xf bank_mask:0xf
v_fmac_f32_dpp v26, v26, v7 quad_perm:[1,0,3,2] row_mask:0xf bank_mask:0xf
v_fmac_f32_dpp v27, v27, v7 quad_perm:[1,0,3,2] row_mask:0xf bank_mask:0xf
v_fmac_f32_dpp v58, v58, v7 quad_perm:[1,0,3,2] row_mask:0xf bank_mask:0xf
v_fmac_f32_dpp v59, v59, v7 quad_perm:[1,0,3,2] row_mask:0xf bank_mask:0xf
v_fmac_f32_dpp v42, v42, v7 quad_perm:[1,0,3,2] row_mask:0xf bank_mask:0xf
v_fmac_f32_dpp v43, v43, v7 quad_perm:[1,0,3,2] row_mask:0xf bank_mask:0xf
v_fmac_f32_dpp v74, v74, v7 quad_perm:[1,0,3,2] row_mask:0xf bank_mask:0xf
v_fmac_f32_dpp v75, v75, v7 quad_perm:[1,0,3,2] row_mask:0xf bank_mask:0xf
s_mov_b64 exec, s[18:19]
v_pk_add_f32 v[16:17], v[16:17], 0 neg_lo:[1,0] neg_hi:[1,0]
v_pk_mul_f32 v[48:49], v[14:15], s[48:49] op_sel:[0,0] op_sel_hi:[0,1] neg_lo:[0,1] neg_hi:[0,1]
v_pk_fma_f32 v[14:15], v[14:15], s[48:49], v[48:49] op_sel:[1,1,0] op_sel_hi:[1,0,1] neg_lo:[0,0,0] neg_hi:[0,1,0]
v_pk_mul_f32 v[48:49], v[64:65], s[50:51] op_sel:[0,0] op_sel_hi:[0,1] neg_lo:[0,1] neg_hi:[0,1]
v_pk_fma_f32 v[64:65], v[64:65], s[50:51], v[48:49] op_sel:[1,1,0] op_sel_hi:[1,0,1] neg_lo:[0,0,0] neg_hi:[0,1,0]
v_pk_mul_f32 v[48:49], v[40:41], s[52:53] op_sel:[0,0] op_sel_hi:[0,1] neg_lo:[0,1] neg_hi:[0,1]
v_pk_fma_f32 v[40:41], v[40:41], s[52:53], v[48:49] op_sel:[1,1,0] op_sel_hi:[1,0,1] neg_lo:[0,0,0] neg_hi:[0,1,0]
v_pk_mul_f32 v[48:49], v[72:73], s[54:55] op_sel:[0,0] op_sel_hi:[0,1] neg_lo:[0,1] neg_hi:[0,1]
v_pk_fma_f32 v[72:73], v[72:73], s[54:55], v[48:49] op_sel:[1,1,0] op_sel_hi:[1,0,1] neg_lo:[0,0,0] neg_hi:[0,1,0]
v_pk_mul_f32 v[48:49], v[44:45], s[56:57] op_sel:[0,0] op_sel_hi:[0,1] neg_lo:[0,1] neg_hi:[0,1]
v_pk_fma_f32 v[44:45], v[44:45], s[56:57], v[48:49] op_sel:[1,1,0] op_sel_hi:[1,0,1] neg_lo:[0,0,0] neg_hi:[0,1,0]
v_pk_mul_f32 v[48:49], v[28:29], s[58:59] op_sel:[0,0] op_sel_hi:[0,1] neg_lo:[0,1] neg_hi:[0,1]
v_pk_fma_f32 v[28:29], v[28:29], s[58:59], v[48:49] op_sel:[1,1,0] op_sel_hi:[1,0,1] neg_lo:[0,0,0] neg_hi:[0,1,0]
v_pk_mul_f32 v[48:49], v[60:61], s[60:61] op_sel:[0,0] op_sel_hi:[0,1] neg_lo:[0,1] neg_hi:[0,1]
v_pk_fma_f32 v[60:61], v[60:61], s[60:61], v[48:49] op_sel:[1,1,0] op_sel_hi:[1,0,1] neg_lo:[0,0,0] neg_hi:[0,1,0]
v_pk_mul_f32 v[48:49], v[76:77], s[62:63] op_sel:[0,0] op_sel_hi:[0,1] neg_lo:[0,1] neg_hi:[0,1]
v_pk_fma_f32 v[76:77], v[76:77], s[62:63], v[48:49] op_sel:[1,1,0] op_sel_hi:[1,0,1] neg_lo:[0,0,0] neg_hi:[0,1,0]
v_pk_mul_f32 v[48:49], v[46:47], s[60:61] op_sel:[0,1] op_sel_hi:[0,0] neg_lo:[0,1] neg_hi:[0,1]
v_pk_fma_f32 v[46:47], v[46:47], s[60:61], v[48:49] op_sel:[1,0,0] op_sel_hi:[1,1,1] neg_lo:[0,0,0] neg_hi:[0,1,0]
v_pk_mul_f32 v[48:49], v[30:31], s[58:59] op_sel:[0,1] op_sel_hi:[0,0] neg_lo:[0,1] neg_hi:[0,1]
v_pk_fma_f32 v[30:31], v[30:31], s[58:59], v[48:49] op_sel:[1,0,0] op_sel_hi:[1,1,1] neg_lo:[0,0,0] neg_hi:[0,1,0]
v_pk_mul_f32 v[48:49], v[62:63], s[56:57] op_sel:[0,1] op_sel_hi:[0,0] neg_lo:[0,1] neg_hi:[0,1]
v_pk_fma_f32 v[62:63], v[62:63], s[56:57], v[48:49] op_sel:[1,0,0] op_sel_hi:[1,1,1] neg_lo:[0,0,0] neg_hi:[0,1,0]
v_pk_mul_f32 v[48:49], v[22:23], s[54:55] op_sel:[0,1] op_sel_hi:[0,0] neg_lo:[0,1] neg_hi:[0,1]
v_pk_fma_f32 v[22:23], v[22:23], s[54:55], v[48:49] op_sel:[1,0,0] op_sel_hi:[1,1,1] neg_lo:[0,0,0] neg_hi:[0,1,0]
v_pk_mul_f32 v[48:49], v[54:55], s[52:53] op_sel:[0,1] op_sel_hi:[0,0] neg_lo:[0,1] neg_hi:[0,1]
v_pk_fma_f32 v[54:55], v[54:55], s[52:53], v[48:49] op_sel:[1,0,0] op_sel_hi:[1,1,1] neg_lo:[0,0,0] neg_hi:[0,1,0]
v_pk_mul_f32 v[48:49], v[38:39], s[50:51] op_sel:[0,1] op_sel_hi:[0,0] neg_lo:[0,1] neg_hi:[0,1]
v_pk_fma_f32 v[38:39], v[38:39], s[50:51], v[48:49] op_sel:[1,0,0] op_sel_hi:[1,1,1] neg_lo:[0,0,0] neg_hi:[0,1,0]
v_pk_mul_f32 v[48:49], v[70:71], s[48:49] op_sel:[0,1] op_sel_hi:[0,0] neg_lo:[0,1] neg_hi:[0,1]
v_pk_fma_f32 v[70:71], v[70:71], s[48:49], v[48:49] op_sel:[1,0,0] op_sel_hi:[1,1,1] neg_lo:[0,0,0] neg_hi:[0,1,0]
v_pk_add_f32 v[78:79], v[78:79], 0 op_sel:[1,0] op_sel_hi:[0,0] neg_lo:[0,0] neg_hi:[1,0]
v_pk_mul_f32 v[48:49], v[32:33], s[48:49] op_sel:[0,1] op_sel_hi:[0,0] neg_lo:[0,0] neg_hi:[0,1]
v_pk_fma_f32 v[32:33], v[32:33], s[48:49], v[48:49] op_sel:[1,0,0] op_sel_hi:[1,1,1] neg_lo:[0,0,0] neg_hi:[0,0,0]
v_pk_mul_f32 v[48:49], v[24:25], s[50:51] op_sel:[0,1] op_sel_hi:[0,0] neg_lo:[0,0] neg_hi:[0,1]
v_pk_fma_f32 v[24:25], v[24:25], s[50:51], v[48:49] op_sel:[1,0,0] op_sel_hi:[1,1,1] neg_lo:[0,0,0] neg_hi:[0,0,0]
v_pk_mul_f32 v[48:49], v[56:57], s[52:53] op_sel:[0,1] op_sel_hi:[0,0] neg_lo:[0,0] neg_hi:[0,1]
v_pk_fma_f32 v[56:57], v[56:57], s[52:53], v[48:49] op_sel:[1,0,0] op_sel_hi:[1,1,1] neg_lo:[0,0,0] neg_hi:[0,0,0]
v_pk_mul_f32 v[48:49], v[20:21], s[54:55] op_sel:[0,1] op_sel_hi:[0,0] neg_lo:[0,0] neg_hi:[0,1]
v_pk_fma_f32 v[20:21], v[20:21], s[54:55], v[48:49] op_sel:[1,0,0] op_sel_hi:[1,1,1] neg_lo:[0,0,0] neg_hi:[0,0,0]
v_pk_mul_f32 v[48:49], v[52:53], s[56:57] op_sel:[0,1] op_sel_hi:[0,0] neg_lo:[0,0] neg_hi:[0,1]
v_pk_fma_f32 v[52:53], v[52:53], s[56:57], v[48:49] op_sel:[1,0,0] op_sel_hi:[1,1,1] neg_lo:[0,0,0] neg_hi:[0,0,0]
v_pk_mul_f32 v[48:49], v[36:37], s[58:59] op_sel:[0,1] op_sel_hi:[0,0] neg_lo:[0,0] neg_hi:[0,1]
v_pk_fma_f32 v[36:37], v[36:37], s[58:59], v[48:49] op_sel:[1,0,0] op_sel_hi:[1,1,1] neg_lo:[0,0,0] neg_hi:[0,0,0]
v_pk_mul_f32 v[48:49], v[68:69], s[60:61] op_sel:[0,1] op_sel_hi:[0,0] neg_lo:[0,0] neg_hi:[0,1]
v_pk_fma_f32 v[68:69], v[68:69], s[60:61], v[48:49] op_sel:[1,0,0] op_sel_hi:[1,1,1] neg_lo:[0,0,0] neg_hi:[0,0,0]
v_pk_mul_f32 v[48:49], v[18:19], s[62:63] op_sel:[0,0] op_sel_hi:[0,1] neg_lo:[0,0] neg_hi:[0,1]
v_pk_fma_f32 v[18:19], v[18:19], s[62:63], v[48:49] op_sel:[1,1,0] op_sel_hi:[1,0,1] neg_lo:[0,0,0] neg_hi:[0,0,0]
v_pk_mul_f32 v[48:49], v[50:51], s[60:61] op_sel:[0,0] op_sel_hi:[0,1] neg_lo:[0,0] neg_hi:[0,1]
v_pk_fma_f32 v[50:51], v[50:51], s[60:61], v[48:49] op_sel:[1,1,0] op_sel_hi:[1,0,1] neg_lo:[0,0,0] neg_hi:[0,0,0]
v_pk_mul_f32 v[48:49], v[34:35], s[58:59] op_sel:[0,0] op_sel_hi:[0,1] neg_lo:[0,0] neg_hi:[0,1]
v_pk_fma_f32 v[34:35], v[34:35], s[58:59], v[48:49] op_sel:[1,1,0] op_sel_hi:[1,0,1] neg_lo:[0,0,0] neg_hi:[0,0,0]
v_pk_mul_f32 v[48:49], v[66:67], s[56:57] op_sel:[0,0] op_sel_hi:[0,1] neg_lo:[0,0] neg_hi:[0,1]
v_pk_fma_f32 v[66:67], v[66:67], s[56:57], v[48:49] op_sel:[1,1,0] op_sel_hi:[1,0,1] neg_lo:[0,0,0] neg_hi:[0,0,0]
v_pk_mul_f32 v[48:49], v[26:27], s[54:55] op_sel:[0,0] op_sel_hi:[0,1] neg_lo:[0,0] neg_hi:[0,1]
v_pk_fma_f32 v[26:27], v[26:27], s[54:55], v[48:49] op_sel:[1,1,0] op_sel_hi:[1,0,1] neg_lo:[0,0,0] neg_hi:[0,0,0]
v_pk_mul_f32 v[48:49], v[58:59], s[52:53] op_sel:[0,0] op_sel_hi:[0,1] neg_lo:[0,0] neg_hi:[0,1]
v_pk_fma_f32 v[58:59], v[58:59], s[52:53], v[48:49] op_sel:[1,1,0] op_sel_hi:[1,0,1] neg_lo:[0,0,0] neg_hi:[0,0,0]
v_pk_mul_f32 v[48:49], v[42:43], s[50:51] op_sel:[0,0] op_sel_hi:[0,1] neg_lo:[0,0] neg_hi:[0,1]
v_pk_fma_f32 v[42:43], v[42:43], s[50:51], v[48:49] op_sel:[1,1,0] op_sel_hi:[1,0,1] neg_lo:[0,0,0] neg_hi:[0,0,0]
v_pk_mul_f32 v[48:49], v[74:75], s[48:49] op_sel:[0,0] op_sel_hi:[0,1] neg_lo:[0,0] neg_hi:[0,1]
v_pk_fma_f32 v[74:75], v[74:75], s[48:49], v[48:49] op_sel:[1,1,0] op_sel_hi:[1,0,1] neg_lo:[0,0,0] neg_hi:[0,0,0]
s_mov_b64 exec, -1
v_pk_add_f32 v[48:49], v[16:17], v[78:79] neg_lo:[0,1] neg_hi:[0,1]
v_pk_add_f32 v[16:17], v[16:17], v[78:79]
v_pk_add_f32 v[78:79], v[14:15], v[32:33] neg_lo:[0,1] neg_hi:[0,1]
v_pk_add_f32 v[14:15], v[14:15], v[32:33]
v_pk_mul_f32 v[32:33], v[78:79], s[50:51] op_sel:[0,0] op_sel_hi:[0,1] neg_lo:[0,0] neg_hi:[0,0]
v_pk_fma_f32 v[32:33], v[78:79], s[50:51], v[32:33] op_sel:[1,1,0] op_sel_hi:[1,0,1] neg_lo:[0,1,0] neg_hi:[0,0,0]
v_pk_add_f32 v[78:79], v[64:65], v[24:25] neg_lo:[0,1] neg_hi:[0,1]
v_pk_add_f32 v[64:65], v[64:65], v[24:25]
v_pk_mul_f32 v[24:25], v[78:79], s[54:55] op_sel:[0,0] op_sel_hi:[0,1] neg_lo:[0,0] neg_hi:[0,0]
v_pk_fma_f32 v[24:25], v[78:79], s[54:55], v[24:25] op_sel:[1,1,0] op_sel_hi:[1,0,1] neg_lo:[0,1,0] neg_hi:[0,0,0]
v_pk_add_f32 v[78:79], v[40:41], v[56:57] neg_lo:[0,1] neg_hi:[0,1]
v_pk_add_f32 v[40:41], v[40:41], v[56:57]
v_pk_mul_f32 v[56:57], v[78:79], s[58:59] op_sel:[0,0] op_sel_hi:[0,1] neg_lo:[0,0] neg_hi:[0,0]
v_pk_fma_f32 v[56:57], v[78:79], s[58:59], v[56:57] op_sel:[1,1,0] op_sel_hi:[1,0,1] neg_lo:[0,1,0] neg_hi:[0,0,0]
v_pk_add_f32 v[78:79], v[72:73], v[20:21] neg_lo:[0,1] neg_hi:[0,1]
v_pk_add_f32 v[72:73], v[72:73], v[20:21]
v_pk_mul_f32 v[20:21], v[78:79], s[62:63] op_sel:[0,0] op_sel_hi:[0,1] neg_lo:[0,0] neg_hi:[0,0]
v_pk_fma_f32 v[20:21], v[78:79], s[62:63], v[20:21] op_sel:[1,1,0] op_sel_hi:[1,0,1] neg_lo:[0,1,0] neg_hi:[0,0,0]
v_pk_add_f32 v[78:79], v[44:45], v[52:53] neg_lo:[0,1] neg_hi:[0,1]
v_pk_add_f32 v[44:45], v[44:45], v[52:53]
v_pk_mul_f32 v[52:53], v[78:79], s[58:59] op_sel:[0,1] op_sel_hi:[0,0] neg_lo:[0,0] neg_hi:[0,0]
v_pk_fma_f32 v[52:53], v[78:79], s[58:59], v[52:53] op_sel:[1,0,0] op_sel_hi:[1,1,1] neg_lo:[0,1,0] neg_hi:[0,0,0]
v_pk_add_f32 v[78:79], v[28:29], v[36:37] neg_lo:[0,1] neg_hi:[0,1]
v_pk_add_f32 v[28:29], v[28:29], v[36:37]
v_pk_mul_f32 v[36:37], v[78:79], s[54:55] op_sel:[0,1] op_sel_hi:[0,0] neg_lo:[0,0] neg_hi:[0,0]
v_pk_fma_f32 v[36:37], v[78:79], s[54:55], v[36:37] op_sel:[1,0,0] op_sel_hi:[1,1,1] neg_lo:[0,1,0] neg_hi:[0,0,0]
v_pk_add_f32 v[78:79], v[60:61], v[68:69] neg_lo:[0,1] neg_hi:[0,1]
v_pk_add_f32 v[60:61], v[60:61], v[68:69]
v_pk_mul_f32 v[68:69], v[78:79], s[50:51] op_sel:[0,1] op_sel_hi:[0,0] neg_lo:[0,0] neg_hi:[0,0]
v_pk_fma_f32 v[68:69], v[78:79], s[50:51], v[68:69] op_sel:[1,0,0] op_sel_hi:[1,1,1] neg_lo:[0,1,0] neg_hi:[0,0,0]
v_pk_add_f32 v[78:79], v[76:77], v[18:19] op_sel:[1,1] op_sel_hi:[0,0] neg_lo:[1,0] neg_hi:[0,1]
v_pk_add_f32 v[76:77], v[76:77], v[18:19]
v_pk_add_f32 v[18:19], v[46:47], v[50:51] neg_lo:[0,1] neg_hi:[0,1]
v_pk_add_f32 v[46:47], v[46:47], v[50:51]
v_pk_mul_f32 v[50:51], v[18:19], s[50:51] op_sel:[0,1] op_sel_hi:[0,0] neg_lo:[0,1] neg_hi:[0,0]
v_pk_fma_f32 v[50:51], v[18:19], s[50:51], v[50:51] op_sel:[1,0,0] op_sel_hi:[1,1,1] neg_lo:[0,1,0] neg_hi:[0,1,0]
v_pk_add_f32 v[18:19], v[30:31], v[34:35] neg_lo:[0,1] neg_hi:[0,1]
v_pk_add_f32 v[30:31], v[30:31], v[34:35]
v_pk_mul_f32 v[34:35], v[18:19], s[54:55] op_sel:[0,1] op_sel_hi:[0,0] neg_lo:[0,1] neg_hi:[0,0]
v_pk_fma_f32 v[34:35], v[18:19], s[54:55], v[34:35] op_sel:[1,0,0] op_sel_hi:[1,1,1] neg_lo:[0,1,0] neg_hi:[0,1,0]
v_pk_add_f32 v[18:19], v[62:63], v[66:67] neg_lo:[0,1] neg_hi:[0,1]
v_pk_add_f32 v[62:63], v[62:63], v[66:67]
v_pk_mul_f32 v[66:67], v[18:19], s[58:59] op_sel:[0,1] op_sel_hi:[0,0] neg_lo:[0,1] neg_hi:[0,0]
v_pk_fma_f32 v[66:67], v[18:19], s[58:59], v[66:67] op_sel:[1,0,0] op_sel_hi:[1,1,1] neg_lo:[0,1,0] neg_hi:[0,1,0]
v_pk_add_f32 v[18:19], v[22:23], v[26:27] neg_lo:[0,1] neg_hi:[0,1]
v_pk_add_f32 v[22:23], v[22:23], v[26:27]
v_pk_mul_f32 v[26:27], v[18:19], s[62:63] op_sel:[0,0] op_sel_hi:[0,1] neg_lo:[0,1] neg_hi:[0,0]
v_pk_fma_f32 v[26:27], v[18:19], s[62:63], v[26:27] op_sel:[1,1,0] op_sel_hi:[1,0,1] neg_lo:[0,1,0] neg_hi:[0,1,0]
v_pk_add_f32 v[18:19], v[54:55], v[58:59] neg_lo:[0,1] neg_hi:[0,1]
v_pk_add_f32 v[54:55], v[54:55], v[58:59]
v_pk_mul_f32 v[58:59], v[18:19], s[58:59] op_sel:[0,0] op_sel_hi:[0,1] neg_lo:[0,1] neg_hi:[0,0]
v_pk_fma_f32 v[58:59], v[18:19], s[58:59], v[58:59] op_sel:[1,1,0] op_sel_hi:[1,0,1] neg_lo:[0,1,0] neg_hi:[0,1,0]
v_pk_add_f32 v[18:19], v[38:39], v[42:43] neg_lo:[0,1] neg_hi:[0,1]
v_pk_add_f32 v[38:39], v[38:39], v[42:43]
v_pk_mul_f32 v[42:43], v[18:19], s[54:55] op_sel:[0,0] op_sel_hi:[0,1] neg_lo:[0,1] neg_hi:[0,0]
v_pk_fma_f32 v[42:43], v[18:19], s[54:55], v[42:43] op_sel:[1,1,0] op_sel_hi:[1,0,1] neg_lo:[0,1,0] neg_hi:[0,1,0]
v_pk_add_f32 v[18:19], v[70:71], v[74:75] neg_lo:[0,1] neg_hi:[0,1]
v_pk_add_f32 v[70:71], v[70:71], v[74:75]
v_pk_mul_f32 v[74:75], v[18:19], s[50:51] op_sel:[0,0] op_sel_hi:[0,1] neg_lo:[0,1] neg_hi:[0,0]
v_pk_fma_f32 v[74:75], v[18:19], s[50:51], v[74:75] op_sel:[1,1,0] op_sel_hi:[1,0,1] neg_lo:[0,1,0] neg_hi:[0,1,0]
v_pk_add_f32 v[18:19], v[16:17], v[76:77] neg_lo:[0,1] neg_hi:[0,1]
v_pk_add_f32 v[16:17], v[16:17], v[76:77]
v_pk_add_f32 v[76:77], v[14:15], v[46:47] neg_lo:[0,1] neg_hi:[0,1]
v_pk_add_f32 v[14:15], v[14:15], v[46:47]
v_pk_mul_f32 v[46:47], v[76:77], s[54:55] op_sel:[0,0] op_sel_hi:[0,1] neg_lo:[0,0] neg_hi:[0,0]
v_pk_fma_f32 v[46:47], v[76:77], s[54:55], v[46:47] op_sel:[1,1,0] op_sel_hi:[1,0,1] neg_lo:[0,1,0] neg_hi:[0,0,0]
v_pk_add_f32 v[76:77], v[64:65], v[30:31] neg_lo:[0,1] neg_hi:[0,1]
v_pk_add_f32 v[64:65], v[64:65], v[30:31]
v_pk_mul_f32 v[30:31], v[76:77], s[62:63] op_sel:[0,0] op_sel_hi:[0,1] neg_lo:[0,0] neg_hi:[0,0]
v_pk_fma_f32 v[30:31], v[76:77], s[62:63], v[30:31] op_sel:[1,1,0] op_sel_hi:[1,0,1] neg_lo:[0,1,0] neg_hi:[0,0,0]
v_pk_add_f32 v[76:77], v[40:41], v[62:63] neg_lo:[0,1] neg_hi:[0,1]
v_pk_add_f32 v[40:41], v[40:41], v[62:63]
v_pk_mul_f32 v[62:63], v[76:77], s[54:55] op_sel:[0,1] op_sel_hi:[0,0] neg_lo:[0,0] neg_hi:[0,0]
v_pk_fma_f32 v[62:63], v[76:77], s[54:55], v[62:63] op_sel:[1,0,0] op_sel_hi:[1,1,1] neg_lo:[0,1,0] neg_hi:[0,0,0]
v_pk_add_f32 v[76:77], v[72:73], v[22:23] op_sel:[1,1] op_sel_hi:[0,0] neg_lo:[1,0] neg_hi:[0,1]
v_pk_add_f32 v[72:73], v[72:73], v[22:23]
v_pk_add_f32 v[22:23], v[44:45], v[54:55] neg_lo:[0,1] neg_hi:[0,1]
v_pk_add_f32 v[44:45], v[44:45], v[54:55]
v_pk_mul_f32 v[54:55], v[22:23], s[54:55] op_sel:[0,1] op_sel_hi:[0,0] neg_lo:[0,1] neg_hi:[0,0]
v_pk_fma_f32 v[54:55], v[22:23], s[54:55], v[54:55] op_sel:[1,0,0] op_sel_hi:[1,1,1] neg_lo:[0,1,0] neg_hi:[0,1,0]
v_pk_add_f32 v[22:23], v[28:29], v[38:39] neg_lo:[0,1] neg_hi:[0,1]
v_pk_add_f32 v[28:29], v[28:29], v[38:39]
v_pk_mul_f32 v[38:39], v[22:23], s[62:63] op_sel:[0,0] op_sel_hi:[0,1] neg_lo:[0,1] neg_hi:[0,0]
v_pk_fma_f32 v[38:39], v[22:23], s[62:63], v[38:39] op_sel:[1,1,0] op_sel_hi:[1,0,1] neg_lo:[0,1,0] neg_hi:[0,1,0]
v_pk_add_f32 v[22:23], v[60:61], v[70:71] neg_lo:[0,1] neg_hi:[0,1]
v_pk_add_f32 v[60:61], v[60:61], v[70:71]
v_pk_mul_f32 v[70:71], v[22:23], s[54:55] op_sel:[0,0] op_sel_hi:[0,1] neg_lo:[0,1] neg_hi:[0,0]
v_pk_fma_f32 v[70:71], v[22:23], s[54:55], v[70:71] op_sel:[1,1,0] op_sel_hi:[1,0,1] neg_lo:[0,1,0] neg_hi:[0,1,0]
v_pk_add_f32 v[22:23], v[48:49], v[78:79] neg_lo:[0,1] neg_hi:[0,1]
v_pk_add_f32 v[48:49], v[48:49], v[78:79]
v_pk_add_f32 v[78:79], v[32:33], v[50:51] neg_lo:[0,1] neg_hi:[0,1]
v_pk_add_f32 v[32:33], v[32:33], v[50:51]
v_pk_mul_f32 v[50:51], v[78:79], s[54:55] op_sel:[0,0] op_sel_hi:[0,1] neg_lo:[0,0] neg_hi:[0,0]
v_pk_fma_f32 v[50:51], v[78:79], s[54:55], v[50:51] op_sel:[1,1,0] op_sel_hi:[1,0,1] neg_lo:[0,1,0] neg_hi:[0,0,0]
v_pk_add_f32 v[78:79], v[24:25], v[34:35] neg_lo:[0,1] neg_hi:[0,1]
v_pk_add_f32 v[24:25], v[24:25], v[34:35]
v_pk_mul_f32 v[34:35], v[78:79], s[62:63] op_sel:[0,0] op_sel_hi:[0,1] neg_lo:[0,0] neg_hi:[0,0]
v_pk_fma_f32 v[34:35], v[78:79], s[62:63], v[34:35] op_sel:[1,1,0] op_sel_hi:[1,0,1] neg_lo:[0,1,0] neg_hi:[0,0,0]
v_pk_add_f32 v[78:79], v[56:57], v[66:67] neg_lo:[0,1] neg_hi:[0,1]
v_pk_add_f32 v[56:57], v[56:57], v[66:67]
v_pk_mul_f32 v[66:67], v[78:79], s[54:55] op_sel:[0,1] op_sel_hi:[0,0] neg_lo:[0,0] neg_hi:[0,0]
v_pk_fma_f32 v[66:67], v[78:79], s[54:55], v[66:67] op_sel:[1,0,0] op_sel_hi:[1,1,1] neg_lo:[0,1,0] neg_hi:[0,0,0]
v_pk_add_f32 v[78:79], v[20:21], v[26:27] op_sel:[1,1] op_sel_hi:[0,0] neg_lo:[1,0] neg_hi:[0,1]
v_pk_add_f32 v[20:21], v[20:21], v[26:27]
v_pk_add_f32 v[26:27], v[52:53], v[58:59] neg_lo:[0,1] neg_hi:[0,1]
v_pk_add_f32 v[52:53], v[52:53], v[58:59]
v_pk_mul_f32 v[58:59], v[26:27], s[54:55] op_sel:[0,1] op_sel_hi:[0,0] neg_lo:[0,1] neg_hi:[0,0]
v_pk_fma_f32 v[58:59], v[26:27], s[54:55], v[58:59] op_sel:[1,0,0] op_sel_hi:[1,1,1] neg_lo:[0,1,0] neg_hi:[0,1,0]
v_pk_add_f32 v[26:27], v[36:37], v[42:43] neg_lo:[0,1] neg_hi:[0,1]
v_pk_add_f32 v[36:37], v[36:37], v[42:43]
v_pk_mul_f32 v[42:43], v[26:27], s[62:63] op_sel:[0,0] op_sel_hi:[0,1] neg_lo:[0,1] neg_hi:[0,0]
v_pk_fma_f32 v[42:43], v[26:27], s[62:63], v[42:43] op_sel:[1,1,0] op_sel_hi:[1,0,1] neg_lo:[0,1,0] neg_hi:[0,1,0]
v_pk_add_f32 v[26:27], v[68:69], v[74:75] neg_lo:[0,1] neg_hi:[0,1]
v_pk_add_f32 v[68:69], v[68:69], v[74:75]
v_pk_mul_f32 v[74:75], v[26:27], s[54:55] op_sel:[0,0] op_sel_hi:[0,1] neg_lo:[0,1] neg_hi:[0,0]
v_pk_fma_f32 v[74:75], v[26:27], s[54:55], v[74:75] op_sel:[1,1,0] op_sel_hi:[1,0,1] neg_lo:[0,1,0] neg_hi:[0,1,0]
v_pk_add_f32 v[26:27], v[16:17], v[72:73] neg_lo:[0,1] neg_hi:[0,1]
v_pk_add_f32 v[16:17], v[16:17], v[72:73]
v_pk_add_f32 v[72:73], v[14:15], v[44:45] neg_lo:[0,1] neg_hi:[0,1]
v_pk_add_f32 v[14:15], v[14:15], v[44:45]
v_pk_mul_f32 v[44:45], v[72:73], s[62:63] op_sel:[0,0] op_sel_hi:[0,1] neg_lo:[0,0] neg_hi:[0,0]
v_pk_fma_f32 v[44:45], v[72:73], s[62:63], v[44:45] op_sel:[1,1,0] op_sel_hi:[1,0,1] neg_lo:[0,1,0] neg_hi:[0,0,0]
v_pk_add_f32 v[72:73], v[64:65], v[28:29] op_sel:[1,1] op_sel_hi:[0,0] neg_lo:[1,0] neg_hi:[0,1]
v_pk_add_f32 v[64:65], v[64:65], v[28:29]
v_pk_add_f32 v[28:29], v[40:41], v[60:61] neg_lo:[0,1] neg_hi:[0,1]
v_pk_add_f32 v[40:41], v[40:41], v[60:61]
v_pk_mul_f32 v[60:61], v[28:29], s[62:63] op_sel:[0,0] op_sel_hi:[0,1] neg_lo:[0,1] neg_hi:[0,0]
v_pk_fma_f32 v[60:61], v[28:29], s[62:63], v[60:61] op_sel:[1,1,0] op_sel_hi:[1,0,1] neg_lo:[0,1,0] neg_hi:[0,1,0]
v_pk_add_f32 v[28:29], v[18:19], v[76:77] neg_lo:[0,1] neg_hi:[0,1]
v_pk_add_f32 v[18:19], v[18:19], v[76:77]
v_pk_add_f32 v[76:77], v[46:47], v[54:55] neg_lo:[0,1] neg_hi:[0,1]
v_pk_add_f32 v[46:47], v[46:47], v[54:55]
v_pk_mul_f32 v[54:55], v[76:77], s[62:63] op_sel:[0,0] op_sel_hi:[0,1] neg_lo:[0,0] neg_hi:[0,0]
v_pk_fma_f32 v[54:55], v[76:77], s[62:63], v[54:55] op_sel:[1,1,0] op_sel_hi:[1,0,1] neg_lo:[0,1,0] neg_hi:[0,0,0]
v_pk_add_f32 v[76:77], v[30:31], v[38:39] op_sel:[1,1] op_sel_hi:[0,0] neg_lo:[1,0] neg_hi:[0,1]
v_pk_add_f32 v[30:31], v[30:31], v[38:39]
v_pk_add_f32 v[38:39], v[62:63], v[70:71] neg_lo:[0,1] neg_hi:[0,1]
v_pk_add_f32 v[62:63], v[62:63], v[70:71]
v_pk_mul_f32 v[70:71], v[38:39], s[62:63] op_sel:[0,0] op_sel_hi:[0,1] neg_lo:[0,1] neg_hi:[0,0]
v_pk_fma_f32 v[70:71], v[38:39], s[62:63], v[70:71] op_sel:[1,1,0] op_sel_hi:[1,0,1] neg_lo:[0,1,0] neg_hi:[0,1,0]
v_pk_add_f32 v[38:39], v[48:49], v[20:21] neg_lo:[0,1] neg_hi:[0,1]
v_pk_add_f32 v[48:49], v[48:49], v[20:21]
v_pk_add_f32 v[20:21], v[32:33], v[52:53] neg_lo:[0,1] neg_hi:[0,1]
v_pk_add_f32 v[32:33], v[32:33], v[52:53]
v_pk_mul_f32 v[52:53], v[20:21], s[62:63] op_sel:[0,0] op_sel_hi:[0,1] neg_lo:[0,0] neg_hi:[0,0]
v_pk_fma_f32 v[52:53], v[20:21], s[62:63], v[52:53] op_sel:[1,1,0] op_sel_hi:[1,0,1] neg_lo:[0,1,0] neg_hi:[0,0,0]
v_pk_add_f32 v[20:21], v[24:25], v[36:37] op_sel:[1,1] op_sel_hi:[0,0] neg_lo:[1,0] neg_hi:[0,1]
v_pk_add_f32 v[24:25], v[24:25], v[36:37]
v_pk_add_f32 v[36:37], v[56:57], v[68:69] neg_lo:[0,1] neg_hi:[0,1]
v_pk_add_f32 v[56:57], v[56:57], v[68:69]
v_pk_mul_f32 v[68:69], v[36:37], s[62:63] op_sel:[0,0] op_sel_hi:[0,1] neg_lo:[0,1] neg_hi:[0,0]
v_pk_fma_f32 v[68:69], v[36:37], s[62:63], v[68:69] op_sel:[1,1,0] op_sel_hi:[1,0,1] neg_lo:[0,1,0] neg_hi:[0,1,0]
v_pk_add_f32 v[36:37], v[22:23], v[78:79] neg_lo:[0,1] neg_hi:[0,1]
v_pk_add_f32 v[22:23], v[22:23], v[78:79]
v_pk_add_f32 v[78:79], v[50:51], v[58:59] neg_lo:[0,1] neg_hi:[0,1]
v_pk_add_f32 v[50:51], v[50:51], v[58:59]
v_pk_mul_f32 v[58:59], v[78:79], s[62:63] op_sel:[0,0] op_sel_hi:[0,1] neg_lo:[0,0] neg_hi:[0,0]
v_pk_fma_f32 v[58:59], v[78:79], s[62:63], v[58:59] op_sel:[1,1,0] op_sel_hi:[1,0,1] neg_lo:[0,1,0] neg_hi:[0,0,0]
v_pk_add_f32 v[78:79], v[34:35], v[42:43] op_sel:[1,1] op_sel_hi:[0,0] neg_lo:[1,0] neg_hi:[0,1]
v_pk_add_f32 v[34:35], v[34:35], v[42:43]
v_pk_add_f32 v[42:43], v[66:67], v[74:75] neg_lo:[0,1] neg_hi:[0,1]
v_pk_add_f32 v[66:67], v[66:67], v[74:75]
v_pk_mul_f32 v[74:75], v[42:43], s[62:63] op_sel:[0,0] op_sel_hi:[0,1] neg_lo:[0,1] neg_hi:[0,0]
v_pk_fma_f32 v[74:75], v[42:43], s[62:63], v[74:75] op_sel:[1,1,0] op_sel_hi:[1,0,1] neg_lo:[0,1,0] neg_hi:[0,1,0]
v_pk_add_f32 v[42:43], v[16:17], v[64:65] neg_lo:[0,1] neg_hi:[0,1]
v_pk_add_f32 v[16:17], v[16:17], v[64:65]
v_pk_add_f32 v[64:65], v[14:15], v[40:41] op_sel:[1,1] op_sel_hi:[0,0] neg_lo:[1,0] neg_hi:[0,1]
v_pk_add_f32 v[14:15], v[14:15], v[40:41]
v_pk_add_f32 v[40:41], v[26:27], v[72:73] neg_lo:[0,1] neg_hi:[0,1]
v_pk_add_f32 v[26:27], v[26:27], v[72:73]
v_pk_add_f32 v[72:73], v[44:45], v[60:61] op_sel:[1,1] op_sel_hi:[0,0] neg_lo:[1,0] neg_hi:[0,1]
v_pk_add_f32 v[44:45], v[44:45], v[60:61]
v_pk_add_f32 v[60:61], v[18:19], v[30:31] neg_lo:[0,1] neg_hi:[0,1]
v_pk_add_f32 v[18:19], v[18:19], v[30:31]
v_pk_add_f32 v[30:31], v[46:47], v[62:63] op_sel:[1,1] op_sel_hi:[0,0] neg_lo:[1,0] neg_hi:[0,1]
v_pk_add_f32 v[46:47], v[46:47], v[62:63]
v_pk_add_f32 v[62:63], v[28:29], v[76:77] neg_lo:[0,1] neg_hi:[0,1]
v_pk_add_f32 v[28:29], v[28:29], v[76:77]
v_pk_add_f32 v[76:77], v[54:55], v[70:71] op_sel:[1,1] op_sel_hi:[0,0] neg_lo:[1,0] neg_hi:[0,1]
v_pk_add_f32 v[54:55], v[54:55], v[70:71]
v_pk_add_f32 v[70:71], v[48:49], v[24:25] neg_lo:[0,1] neg_hi:[0,1]
v_pk_add_f32 v[48:49], v[48:49], v[24:25]
v_pk_add_f32 v[24:25], v[32:33], v[56:57] op_sel:[1,1] op_sel_hi:[0,0] neg_lo:[1,0] neg_hi:[0,1]
v_pk_add_f32 v[32:33], v[32:33], v[56:57]
v_pk_add_f32 v[56:57], v[38:39], v[20:21] neg_lo:[0,1] neg_hi:[0,1]
v_pk_add_f32 v[38:39], v[38:39], v[20:21]
v_pk_add_f32 v[20:21], v[52:53], v[68:69] op_sel:[1,1] op_sel_hi:[0,0] neg_lo:[1,0] neg_hi:[0,1]
v_pk_add_f32 v[52:53], v[52:53], v[68:69]
v_pk_add_f32 v[68:69], v[22:23], v[34:35] neg_lo:[0,1] neg_hi:[0,1]
v_pk_add_f32 v[22:23], v[22:23], v[34:35]
v_pk_add_f32 v[34:35], v[50:51], v[66:67] op_sel:[1,1] op_sel_hi:[0,0] neg_lo:[1,0] neg_hi:[0,1]
v_pk_add_f32 v[50:51], v[50:51], v[66:67]
v_pk_add_f32 v[66:67], v[36:37], v[78:79] neg_lo:[0,1] neg_hi:[0,1]
v_pk_add_f32 v[36:37], v[36:37], v[78:79]
v_pk_add_f32 v[78:79], v[58:59], v[74:75] op_sel:[1,1] op_sel_hi:[0,0] neg_lo:[1,0] neg_hi:[0,1]
v_pk_add_f32 v[58:59], v[58:59], v[74:75]
v_pk_add_f32 v[74:75], v[16:17], v[14:15] neg_lo:[0,1] neg_hi:[0,1]
v_pk_add_f32 v[16:17], v[16:17], v[14:15]
v_pk_add_f32 v[14:15], v[42:43], v[64:65] neg_lo:[0,1] neg_hi:[0,1]
v_pk_add_f32 v[42:43], v[42:43], v[64:65]
v_pk_add_f32 v[64:65], v[26:27], v[44:45] neg_lo:[0,1] neg_hi:[0,1]
v_pk_add_f32 v[26:27], v[26:27], v[44:45]
v_pk_add_f32 v[44:45], v[40:41], v[72:73] neg_lo:[0,1] neg_hi:[0,1]
v_pk_add_f32 v[40:41], v[40:41], v[72:73]
v_pk_add_f32 v[72:73], v[18:19], v[46:47] neg_lo:[0,1] neg_hi:[0,1]
v_pk_add_f32 v[18:19], v[18:19], v[46:47]
v_pk_add_f32 v[46:47], v[60:61], v[30:31] neg_lo:[0,1] neg_hi:[0,1]
v_pk_add_f32 v[60:61], v[60:61], v[30:31]
v_pk_add_f32 v[30:31], v[28:29], v[54:55] neg_lo:[0,1] neg_hi:[0,1]
v_pk_add_f32 v[28:29], v[28:29], v[54:55]
v_pk_add_f32 v[54:55], v[62:63], v[76:77] neg_lo:[0,1] neg_hi:[0,1]
v_pk_add_f32 v[62:63], v[62:63], v[76:77]
v_pk_add_f32 v[76:77], v[48:49], v[32:33] neg_lo:[0,1] neg_hi:[0,1]
v_pk_add_f32 v[48:49], v[48:49], v[32:33]
v_pk_add_f32 v[32:33], v[70:71], v[24:25] neg_lo:[0,1] neg_hi:[0,1]
v_pk_add_f32 v[70:71], v[70:71], v[24:25]
v_pk_add_f32 v[24:25], v[38:39], v[52:53] neg_lo:[0,1] neg_hi:[0,1]
v_pk_add_f32 v[38:39], v[38:39], v[52:53]
v_pk_add_f32 v[52:53], v[56:57], v[20:21] neg_lo:[0,1] neg_hi:[0,1]
v_pk_add_f32 v[56:57], v[56:57], v[20:21]
v_pk_add_f32 v[20:21], v[22:23], v[50:51] neg_lo:[0,1] neg_hi:[0,1]
v_pk_add_f32 v[22:23], v[22:23], v[50:51]
v_pk_add_f32 v[50:51], v[68:69], v[34:35] neg_lo:[0,1] neg_hi:[0,1]
v_pk_add_f32 v[68:69], v[68:69], v[34:35]
v_pk_add_f32 v[34:35], v[36:37], v[58:59] neg_lo:[0,1] neg_hi:[0,1]
v_pk_add_f32 v[36:37], v[36:37], v[58:59]
v_pk_add_f32 v[58:59], v[66:67], v[78:79] neg_lo:[0,1] neg_hi:[0,1]
v_pk_add_f32 v[66:67], v[66:67], v[78:79]
v_pk_mul_f32 v[78:79], v[16:17], v[144:145] op_sel:[0,0] op_sel_hi:[0,1] neg_lo:[0,0] neg_hi:[0,0]
v_pk_fma_f32 v[16:17], v[16:17], v[144:145], v[78:79] op_sel:[1,1,0] op_sel_hi:[1,0,1] neg_lo:[0,1,0] neg_hi:[0,0,0]
v_pk_mul_f32 v[78:79], v[48:49], v[146:147] op_sel:[0,0] op_sel_hi:[0,1] neg_lo:[0,0] neg_hi:[0,0]
v_pk_fma_f32 v[48:49], v[48:49], v[146:147], v[78:79] op_sel:[1,1,0] op_sel_hi:[1,0,1] neg_lo:[0,1,0] neg_hi:[0,0,0]
v_pk_mul_f32 v[78:79], v[18:19], v[148:149] op_sel:[0,0] op_sel_hi:[0,1] neg_lo:[0,0] neg_hi:[0,0]
v_pk_fma_f32 v[18:19], v[18:19], v[148:149], v[78:79] op_sel:[1,1,0] op_sel_hi:[1,0,1] neg_lo:[0,1,0] neg_hi:[0,0,0]
v_pk_mul_f32 v[78:79], v[22:23], v[150:151] op_sel:[0,0] op_sel_hi:[0,1] neg_lo:[0,0] neg_hi:[0,0]
v_pk_fma_f32 v[22:23], v[22:23], v[150:151], v[78:79] op_sel:[1,1,0] op_sel_hi:[1,0,1] neg_lo:[0,1,0] neg_hi:[0,0,0]
v_pk_mul_f32 v[78:79], v[26:27], v[152:153] op_sel:[0,0] op_sel_hi:[0,1] neg_lo:[0,0] neg_hi:[0,0]
v_pk_fma_f32 v[26:27], v[26:27], v[152:153], v[78:79] op_sel:[1,1,0] op_sel_hi:[1,0,1] neg_lo:[0,1,0] neg_hi:[0,0,0]
v_pk_mul_f32 v[78:79], v[38:39], v[154:155] op_sel:[0,0] op_sel_hi:[0,1] neg_lo:[0,0] neg_hi:[0,0]
v_pk_fma_f32 v[38:39], v[38:39], v[154:155], v[78:79] op_sel:[1,1,0] op_sel_hi:[1,0,1] neg_lo:[0,1,0] neg_hi:[0,0,0]
v_pk_mul_f32 v[78:79], v[28:29], v[156:157] op_sel:[0,0] op_sel_hi:[0,1] neg_lo:[0,0] neg_hi:[0,0]
v_pk_fma_f32 v[28:29], v[28:29], v[156:157], v[78:79] op_sel:[1,1,0] op_sel_hi:[1,0,1] neg_lo:[0,1,0] neg_hi:[0,0,0]
v_pk_mul_f32 v[78:79], v[36:37], v[158:159] op_sel:[0,0] op_sel_hi:[0,1] neg_lo:[0,0] neg_hi:[0,0]
v_pk_fma_f32 v[36:37], v[36:37], v[158:159], v[78:79] op_sel:[1,1,0] op_sel_hi:[1,0,1] neg_lo:[0,1,0] neg_hi:[0,0,0]
v_pk_mul_f32 v[78:79], v[42:43], v[160:161] op_sel:[0,0] op_sel_hi:[0,1] neg_lo:[0,0] neg_hi:[0,0]
v_pk_fma_f32 v[42:43], v[42:43], v[160:161], v[78:79] op_sel:[1,1,0] op_sel_hi:[1,0,1] neg_lo:[0,1,0] neg_hi:[0,0,0]
v_pk_mul_f32 v[78:79], v[70:71], v[162:163] op_sel:[0,0] op_sel_hi:[0,1] neg_lo:[0,0] neg_hi:[0,0]
v_pk_fma_f32 v[70:71], v[70:71], v[162:163], v[78:79] op_sel:[1,1,0] op_sel_hi:[1,0,1] neg_lo:[0,1,0] neg_hi:[0,0,0]
v_pk_mul_f32 v[78:79], v[60:61], v[164:165] op_sel:[0,0] op_sel_hi:[0,1] neg_lo:[0,0] neg_hi:[0,0]
v_pk_fma_f32 v[60:61], v[60:61], v[164:165], v[78:79] op_sel:[1,1,0] op_sel_hi:[1,0,1] neg_lo:[0,1,0] neg_hi:[0,0,0]
v_pk_mul_f32 v[78:79], v[68:69], v[166:167] op_sel:[0,0] op_sel_hi:[0,1] neg_lo:[0,0] neg_hi:[0,0]
v_pk_fma_f32 v[68:69], v[68:69], v[166:167], v[78:79] op_sel:[1,1,0] op_sel_hi:[1,0,1] neg_lo:[0,1,0] neg_hi:[0,0,0]
v_pk_mul_f32 v[78:79], v[40:41], v[168:169] op_sel:[0,0] op_sel_hi:[0,1] neg_lo:[0,0] neg_hi:[0,0]
v_pk_fma_f32 v[40:41], v[40:41], v[168:169], v[78:79] op_sel:[1,1,0] op_sel_hi:[1,0,1] neg_lo:[0,1,0] neg_hi:[0,0,0]
v_pk_mul_f32 v[78:79], v[56:57], v[170:171] op_sel:[0,0] op_sel_hi:[0,1] neg_lo:[0,0] neg_hi:[0,0]
v_pk_fma_f32 v[56:57], v[56:57], v[170:171], v[78:79] op_sel:[1,1,0] op_sel_hi:[1,0,1] neg_lo:[0,1,0] neg_hi:[0,0,0]
v_pk_mul_f32 v[78:79], v[62:63], v[172:173] op_sel:[0,0] op_sel_hi:[0,1] neg_lo:[0,0] neg_hi:[0,0]
v_pk_fma_f32 v[62:63], v[62:63], v[172:173], v[78:79] op_sel:[1,1,0] op_sel_hi:[1,0,1] neg_lo:[0,1,0] neg_hi:[0,0,0]
v_pk_mul_f32 v[78:79], v[66:67], v[174:175] op_sel:[0,0] op_sel_hi:[0,1] neg_lo:[0,0] neg_hi:[0,0]
v_pk_fma_f32 v[66:67], v[66:67], v[174:175], v[78:79] op_sel:[1,1,0] op_sel_hi:[1,0,1] neg_lo:[0,1,0] neg_hi:[0,0,0]
v_pk_mul_f32 v[78:79], v[74:75], v[176:177] op_sel:[0,0] op_sel_hi:[0,1] neg_lo:[0,0] neg_hi:[0,0]
v_pk_fma_f32 v[74:75], v[74:75], v[176:177], v[78:79] op_sel:[1,1,0] op_sel_hi:[1,0,1] neg_lo:[0,1,0] neg_hi:[0,0,0]
v_pk_mul_f32 v[78:79], v[76:77], v[178:179] op_sel:[0,0] op_sel_hi:[0,1] neg_lo:[0,0] neg_hi:[0,0]
v_pk_fma_f32 v[76:77], v[76:77], v[178:179], v[78:79] op_sel:[1,1,0] op_sel_hi:[1,0,1] neg_lo:[0,1,0] neg_hi:[0,0,0]
v_pk_mul_f32 v[78:79], v[72:73], v[180:181] op_sel:[0,0] op_sel_hi:[0,1] neg_lo:[0,0] neg_hi:[0,0]
v_pk_fma_f32 v[72:73], v[72:73], v[180:181], v[78:79] op_sel:[1,1,0] op_sel_hi:[1,0,1] neg_lo:[0,1,0] neg_hi:[0,0,0]
v_pk_mul_f32 v[78:79], v[20:21], v[182:183] op_sel:[0,0] op_sel_hi:[0,1] neg_lo:[0,0] neg_hi:[0,0]
v_pk_fma_f32 v[20:21], v[20:21], v[182:183], v[78:79] op_sel:[1,1,0] op_sel_hi:[1,0,1] neg_lo:[0,1,0] neg_hi:[0,0,0]
v_pk_mul_f32 v[78:79], v[64:65], v[184:185] op_sel:[0,0] op_sel_hi:[0,1] neg_lo:[0,0] neg_hi:[0,0]
v_pk_fma_f32 v[64:65], v[64:65], v[184:185], v[78:79] op_sel:[1,1,0] op_sel_hi:[1,0,1] neg_lo:[0,1,0] neg_hi:[0,0,0]
v_pk_mul_f32 v[78:79], v[24:25], v[186:187] op_sel:[0,0] op_sel_hi:[0,1] neg_lo:[0,0] neg_hi:[0,0]
v_pk_fma_f32 v[24:25], v[24:25], v[186:187], v[78:79] op_sel:[1,1,0] op_sel_hi:[1,0,1] neg_lo:[0,1,0] neg_hi:[0,0,0]
v_pk_mul_f32 v[78:79], v[30:31], v[188:189] op_sel:[0,0] op_sel_hi:[0,1] neg_lo:[0,0] neg_hi:[0,0]
v_pk_fma_f32 v[30:31], v[30:31], v[188:189], v[78:79] op_sel:[1,1,0] op_sel_hi:[1,0,1] neg_lo:[0,1,0] neg_hi:[0,0,0]
v_pk_mul_f32 v[78:79], v[34:35], v[190:191] op_sel:[0,0] op_sel_hi:[0,1] neg_lo:[0,0] neg_hi:[0,0]
v_pk_fma_f32 v[34:35], v[34:35], v[190:191], v[78:79] op_sel:[1,1,0] op_sel_hi:[1,0,1] neg_lo:[0,1,0] neg_hi:[0,0,0]
v_pk_mul_f32 v[78:79], v[14:15], v[192:193] op_sel:[0,0] op_sel_hi:[0,1] neg_lo:[0,0] neg_hi:[0,0]
v_pk_fma_f32 v[14:15], v[14:15], v[192:193], v[78:79] op_sel:[1,1,0] op_sel_hi:[1,0,1] neg_lo:[0,1,0] neg_hi:[0,0,0]
v_pk_mul_f32 v[78:79], v[32:33], v[194:195] op_sel:[0,0] op_sel_hi:[0,1] neg_lo:[0,0] neg_hi:[0,0]
v_pk_fma_f32 v[32:33], v[32:33], v[194:195], v[78:79] op_sel:[1,1,0] op_sel_hi:[1,0,1] neg_lo:[0,1,0] neg_hi:[0,0,0]
v_pk_mul_f32 v[78:79], v[46:47], v[196:197] op_sel:[0,0] op_sel_hi:[0,1] neg_lo:[0,0] neg_hi:[0,0]
v_pk_fma_f32 v[46:47], v[46:47], v[196:197], v[78:79] op_sel:[1,1,0] op_sel_hi:[1,0,1] neg_lo:[0,1,0] neg_hi:[0,0,0]
v_pk_mul_f32 v[78:79], v[50:51], v[198:199] op_sel:[0,0] op_sel_hi:[0,1] neg_lo:[0,0] neg_hi:[0,0]
v_pk_fma_f32 v[50:51], v[50:51], v[198:199], v[78:79] op_sel:[1,1,0] op_sel_hi:[1,0,1] neg_lo:[0,1,0] neg_hi:[0,0,0]
v_pk_mul_f32 v[78:79], v[44:45], v[200:201] op_sel:[0,0] op_sel_hi:[0,1] neg_lo:[0,0] neg_hi:[0,0]
v_pk_fma_f32 v[44:45], v[44:45], v[200:201], v[78:79] op_sel:[1,1,0] op_sel_hi:[1,0,1] neg_lo:[0,1,0] neg_hi:[0,0,0]
v_pk_mul_f32 v[78:79], v[52:53], v[202:203] op_sel:[0,0] op_sel_hi:[0,1] neg_lo:[0,0] neg_hi:[0,0]
v_pk_fma_f32 v[52:53], v[52:53], v[202:203], v[78:79] op_sel:[1,1,0] op_sel_hi:[1,0,1] neg_lo:[0,1,0] neg_hi:[0,0,0]
v_pk_mul_f32 v[78:79], v[54:55], v[204:205] op_sel:[0,0] op_sel_hi:[0,1] neg_lo:[0,0] neg_hi:[0,0]
v_pk_fma_f32 v[54:55], v[54:55], v[204:205], v[78:79] op_sel:[1,1,0] op_sel_hi:[1,0,1] neg_lo:[0,1,0] neg_hi:[0,0,0]
v_pk_mul_f32 v[78:79], v[58:59], v[206:207] op_sel:[0,0] op_sel_hi:[0,1] neg_lo:[0,0] neg_hi:[0,0]
v_pk_fma_f32 v[58:59], v[58:59], v[206:207], v[78:79] op_sel:[1,1,0] op_sel_hi:[1,0,1] neg_lo:[0,1,0] neg_hi:[0,0,0]
ds_write_b64 v4, v[16:17] offset:0
ds_write_b64 v4, v[48:49] offset:16
ds_write_b64 v4, v[18:19] offset:32
ds_write_b64 v4, v[22:23] offset:48
ds_write_b64 v4, v[26:27] offset:64
ds_write_b64 v4, v[38:39] offset:80
ds_write_b64 v4, v[28:29] offset:96
ds_write_b64 v4, v[36:37] offset:112
ds_write_b64 v4, v[42:43] offset:128
ds_write_b64 v4, v[70:71] offset:144
ds_write_b64 v4, v[60:61] offset:160
ds_write_b64 v4, v[68:69] offset:176
ds_write_b64 v4, v[40:41] offset:192
ds_write_b64 v4, v[56:57] offset:208
ds_write_b64 v4, v[62:63] offset:224
ds_write_b64 v4, v[66:67] offset:240
ds_write_b64 v4, v[74:75] offset:256
ds_write_b64 v4, v[76:77] offset:272
ds_write_b64 v4, v[72:73] offset:288
ds_write_b64 v4, v[20:21] offset:304
ds_write_b64 v4, v[64:65] offset:320
ds_write_b64 v4, v[24:25] offset:336
ds_write_b64 v4, v[30:31] offset:352
ds_write_b64 v4, v[34:35] offset:368
ds_write_b64 v4, v[14:15] offset:384
ds_write_b64 v4, v[32:33] offset:400
ds_write_b64 v4, v[46:47] offset:416
ds_write_b64 v4, v[50:51] offset:432
ds_write_b64 v4, v[44:45] offset:448
ds_write_b64 v4, v[52:53] offset:464
ds_write_b64 v4, v[54:55] offset:480
ds_write_b64 v4, v[58:59] offset:496
s_waitcnt lgkmcnt(0)
ds_read_b64 v[16:17], v3 offset:0
ds_read_b64 v[48:49], v3 offset:8448
ds_read_b64 v[18:19], v3 offset:528
ds_read_b64 v[50:51], v3 offset:8976
ds_read_b64 v[20:21], v3 offset:1056
ds_read_b64 v[52:53], v3 offset:9504
ds_read_b64 v[22:23], v3 offset:1584
ds_read_b64 v[54:55], v3 offset:10032
ds_read_b64 v[24:25], v3 offset:2112
ds_read_b64 v[56:57], v3 offset:10560
ds_read_b64 v[26:27], v3 offset:2640
ds_read_b64 v[58:59], v3 offset:11088
ds_read_b64 v[28:29], v3 offset:3168
ds_read_b64 v[60:61], v3 offset:11616
ds_read_b64 v[30:31], v3 offset:3696
ds_read_b64 v[62:63], v3 offset:12144
ds_read_b64 v[32:33], v3 offset:4224
ds_read_b64 v[64:65], v3 offset:12672
ds_read_b64 v[34:35], v3 offset:4752
ds_read_b64 v[66:67], v3 offset:13200
ds_read_b64 v[36:37], v3 offset:5280
ds_read_b64 v[68:69], v3 offset:13728
ds_read_b64 v[38:39], v3 offset:5808
ds_read_b64 v[70:71], v3 offset:14256
ds_read_b64 v[40:41], v3 offset:6336
ds_read_b64 v[72:73], v3 offset:14784
ds_read_b64 v[42:43], v3 offset:6864
ds_read_b64 v[74:75], v3 offset:15312
ds_read_b64 v[44:45], v3 offset:7392
ds_read_b64 v[76:77], v3 offset:15840
ds_read_b64 v[46:47], v3 offset:7920
ds_read_b64 v[78:79], v3 offset:16368
s_waitcnt lgkmcnt(0)
v_pk_add_f32 v[14:15], v[16:17], v[48:49] neg_lo:[0,1] neg_hi:[0,1]
v_pk_add_f32 v[16:17], v[16:17], v[48:49]
v_pk_add_f32 v[48:49], v[18:19], v[50:51] neg_lo:[0,1] neg_hi:[0,1]
v_pk_add_f32 v[18:19], v[18:19], v[50:51]
v_pk_mul_f32 v[50:51], v[48:49], s[50:51] op_sel:[0,0] op_sel_hi:[0,1] neg_lo:[0,0] neg_hi:[0,0]
v_pk_fma_f32 v[50:51], v[48:49], s[50:51], v[50:51] op_sel:[1,1,0] op_sel_hi:[1,0,1] neg_lo:[0,1,0] neg_hi:[0,0,0]
v_pk_add_f32 v[48:49], v[20:21], v[52:53] neg_lo:[0,1] neg_hi:[0,1]
v_pk_add_f32 v[20:21], v[20:21], v[52:53]
v_pk_mul_f32 v[52:53], v[48:49], s[54:55] op_sel:[0,0] op_sel_hi:[0,1] neg_lo:[0,0] neg_hi:[0,0]
v_pk_fma_f32 v[52:53], v[48:49], s[54:55], v[52:53] op_sel:[1,1,0] op_sel_hi:[1,0,1] neg_lo:[0,1,0] neg_hi:[0,0,0]
v_pk_add_f32 v[48:49], v[22:23], v[54:55] neg_lo:[0,1] neg_hi:[0,1]
v_pk_add_f32 v[22:23], v[22:23], v[54:55]
v_pk_mul_f32 v[54:55], v[48:49], s[58:59] op_sel:[0,0] op_sel_hi:[0,1] neg_lo:[0,0] neg_hi:[0,0]
v_pk_fma_f32 v[54:55], v[48:49], s[58:59], v[54:55] op_sel:[1,1,0] op_sel_hi:[1,0,1] neg_lo:[0,1,0] neg_hi:[0,0,0]
v_pk_add_f32 v[48:49], v[24:25], v[56:57] neg_lo:[0,1] neg_hi:[0,1]
v_pk_add_f32 v[24:25], v[24:25], v[56:57]
v_pk_mul_f32 v[56:57], v[48:49], s[62:63] op_sel:[0,0] op_sel_hi:[0,1] neg_lo:[0,0] neg_hi:[0,0]
v_pk_fma_f32 v[56:57], v[48:49], s[62:63], v[56:57] op_sel:[1,1,0] op_sel_hi:[1,0,1] neg_lo:[0,1,0] neg_hi:[0,0,0]
v_pk_add_f32 v[48:49], v[26:27], v[58:59] neg_lo:[0,1] neg_hi:[0,1]
v_pk_add_f32 v[26:27], v[26:27], v[58:59]
v_pk_mul_f32 v[58:59], v[48:49], s[58:59] op_sel:[0,1] op_sel_hi:[0,0] neg_lo:[0,0] neg_hi:[0,0]
v_pk_fma_f32 v[58:59], v[48:49], s[58:59], v[58:59] op_sel:[1,0,0] op_sel_hi:[1,1,1] neg_lo:[0,1,0] neg_hi:[0,0,0]
v_pk_add_f32 v[48:49], v[28:29], v[60:61] neg_lo:[0,1] neg_hi:[0,1]
v_pk_add_f32 v[28:29], v[28:29], v[60:61]
v_pk_mul_f32 v[60:61], v[48:49], s[54:55] op_sel:[0,1] op_sel_hi:[0,0] neg_lo:[0,0] neg_hi:[0,0]
v_pk_fma_f32 v[60:61], v[48:49], s[54:55], v[60:61] op_sel:[1,0,0] op_sel_hi:[1,1,1] neg_lo:[0,1,0] neg_hi:[0,0,0]
v_pk_add_f32 v[48:49], v[30:31], v[62:63] neg_lo:[0,1] neg_hi:[0,1]
v_pk_add_f32 v[30:31], v[30:31], v[62:63]
v_pk_mul_f32 v[62:63], v[48:49], s[50:51] op_sel:[0,1] op_sel_hi:[0,0] neg_lo:[0,0] neg_hi:[0,0]
v_pk_fma_f32 v[62:63], v[48:49], s[50:51], v[62:63] op_sel:[1,0,0] op_sel_hi:[1,1,1] neg_lo:[0,1,0] neg_hi:[0,0,0]
v_pk_add_f32 v[48:49], v[32:33], v[64:65] op_sel:[1,1] op_sel_hi:[0,0] neg_lo:[1,0] neg_hi:[0,1]
v_pk_add_f32 v[32:33], v[32:33], v[64:65]
v_pk_add_f32 v[64:65], v[34:35], v[66:67] neg_lo:[0,1] neg_hi:[0,1]
v_pk_add_f32 v[34:35], v[34:35], v[66:67]
v_pk_mul_f32 v[66:67], v[64:65], s[50:51] op_sel:[0,1] op_sel_hi:[0,0] neg_lo:[0,1] neg_hi:[0,0]
v_pk_fma_f32 v[66:67], v[64:65], s[50:51], v[66:67] op_sel:[1,0,0] op_sel_hi:[1,1,1] neg_lo:[0,1,0] neg_hi:[0,1,0]
v_pk_add_f32 v[64:65], v[36:37], v[68:69] neg_lo:[0,1] neg_hi:[0,1]
v_pk_add_f32 v[36:37], v[36:37], v[68:69]
v_pk_mul_f32 v[68:69], v[64:65], s[54:55] op_sel:[0,1] op_sel_hi:[0,0] neg_lo:[0,1] neg_hi:[0,0]
v_pk_fma_f32 v[68:69], v[64:65], s[54:55], v[68:69] op_sel:[1,0,0] op_sel_hi:[1,1,1] neg_lo:[0,1,0] neg_hi:[0,1,0]
v_pk_add_f32 v[64:65], v[38:39], v[70:71] neg_lo:[0,1] neg_hi:[0,1]
v_pk_add_f32 v[38:39], v[38:39], v[70:71]
v_pk_mul_f32 v[70:71], v[64:65], s[58:59] op_sel:[0,1] op_sel_hi:[0,0] neg_lo:[0,1] neg_hi:[0,0]
v_pk_fma_f32 v[70:71], v[64:65], s[58:59], v[70:71] op_sel:[1,0,0] op_sel_hi:[1,1,1] neg_lo:[0,1,0] neg_hi:[0,1,0]
v_pk_add_f32 v[64:65], v[40:41], v[72:73] neg_lo:[0,1] neg_hi:[0,1]
v_pk_add_f32 v[40:41], v[40:41], v[72:73]
v_pk_mul_f32 v[72:73], v[64:65], s[62:63] op_sel:[0,0] op_sel_hi:[0,1] neg_lo:[0,1] neg_hi:[0,0]
v_pk_fma_f32 v[72:73], v[64:65], s[62:63], v[72:73] op_sel:[1,1,0] op_sel_hi:[1,0,1] neg_lo:[0,1,0] neg_hi:[0,1,0]
v_pk_add_f32 v[64:65], v[42:43], v[74:75] neg_lo:[0,1] neg_hi:[0,1]
v_pk_add_f32 v[42:43], v[42:43], v[74:75]
v_pk_mul_f32 v[74:75], v[64:65], s[58:59] op_sel:[0,0] op_sel_hi:[0,1] neg_lo:[0,1] neg_hi:[0,0]
v_pk_fma_f32 v[74:75], v[64:65], s[58:59], v[74:75] op_sel:[1,1,0] op_sel_hi:[1,0,1] neg_lo:[0,1,0] neg_hi:[0,1,0]
v_pk_add_f32 v[64:65], v[44:45], v[76:77] neg_lo:[0,1] neg_hi:[0,1]
v_pk_add_f32 v[44:45], v[44:45], v[76:77]
v_pk_mul_f32 v[76:77], v[64:65], s[54:55] op_sel:[0,0] op_sel_hi:[0,1] neg_lo:[0,1] neg_hi:[0,0]
v_pk_fma_f32 v[76:77], v[64:65], s[54:55], v[76:77] op_sel:[1,1,0] op_sel_hi:[1,0,1] neg_lo:[0,1,0] neg_hi:[0,1,0]
v_pk_add_f32 v[64:65], v[46:47], v[78:79] neg_lo:[0,1] neg_hi:[0,1]
v_pk_add_f32 v[46:47], v[46:47], v[78:79]
v_pk_mul_f32 v[78:79], v[64:65], s[50:51] op_sel:[0,0] op_sel_hi:[0,1] neg_lo:[0,1] neg_hi:[0,0]
v_pk_fma_f32 v[78:79], v[64:65], s[50:51], v[78:79] op_sel:[1,1,0] op_sel_hi:[1,0,1] neg_lo:[0,1,0] neg_hi:[0,1,0]
v_pk_add_f32 v[64:65], v[16:17], v[32:33] neg_lo:[0,1] neg_hi:[0,1]
v_pk_add_f32 v[16:17], v[16:17], v[32:33]
v_pk_add_f32 v[32:33], v[18:19], v[34:35] neg_lo:[0,1] neg_hi:[0,1]
v_pk_add_f32 v[18:19], v[18:19], v[34:35]
v_pk_mul_f32 v[34:35], v[32:33], s[54:55] op_sel:[0,0] op_sel_hi:[0,1] neg_lo:[0,0] neg_hi:[0,0]
v_pk_fma_f32 v[34:35], v[32:33], s[54:55], v[34:35] op_sel:[1,1,0] op_sel_hi:[1,0,1] neg_lo:[0,1,0] neg_hi:[0,0,0]
v_pk_add_f32 v[32:33], v[20:21], v[36:37] neg_lo:[0,1] neg_hi:[0,1]
v_pk_add_f32 v[20:21], v[20:21], v[36:37]
v_pk_mul_f32 v[36:37], v[32:33], s[62:63] op_sel:[0,0] op_sel_hi:[0,1] neg_lo:[0,0] neg_hi:[0,0]
v_pk_fma_f32 v[36:37], v[32:33], s[62:63], v[36:37] op_sel:[1,1,0] op_sel_hi:[1,0,1] neg_lo:[0,1,0] neg_hi:[0,0,0]
v_pk_add_f32 v[32:33], v[22:23], v[38:39] neg_lo:[0,1] neg_hi:[0,1]
v_pk_add_f32 v[22:23], v[22:23], v[38:39]
v_pk_mul_f32 v[38:39], v[32:33], s[54:55] op_sel:[0,1] op_sel_hi:[0,0] neg_lo:[0,0] neg_hi:[0,0]
v_pk_fma_f32 v[38:39], v[32:33], s[54:55], v[38:39] op_sel:[1,0,0] op_sel_hi:[1,1,1] neg_lo:[0,1,0] neg_hi:[0,0,0]
v_pk_add_f32 v[32:33], v[24:25], v[40:41] op_sel:[1,1] op_sel_hi:[0,0] neg_lo:[1,0] neg_hi:[0,1]
v_pk_add_f32 v[24:25], v[24:25], v[40:41]
v_pk_add_f32 v[40:41], v[26:27], v[42:43] neg_lo:[0,1] neg_hi:[0,1]
v_pk_add_f32 v[26:27], v[26:27], v[42:43]
v_pk_mul_f32 v[42:43], v[40:41], s[54:55] op_sel:[0,1] op_sel_hi:[0,0] neg_lo:[0,1] neg_hi:[0,0]
v_pk_fma_f32 v[42:43], v[40:41], s[54:55], v[42:43] op_sel:[1,0,0] op_sel_hi:[1,1,1] neg_lo:[0,1,0] neg_hi:[0,1,0]
v_pk_add_f32 v[40:41], v[28:29], v[44:45] neg_lo:[0,1] neg_hi:[0,1]
v_pk_add_f32 v[28:29], v[28:29], v[44:45]
v_pk_mul_f32 v[44:45], v[40:41], s[62:63] op_sel:[0,0] op_sel_hi:[0,1] neg_lo:[0,1] neg_hi:[0,0]
v_pk_fma_f32 v[44:45], v[40:41], s[62:63], v[44:45] op_sel:[1,1,0] op_sel_hi:[1,0,1] neg_lo:[0,1,0] neg_hi:[0,1,0]
v_pk_add_f32 v[40:41], v[30:31], v[46:47] neg_lo:[0,1] neg_hi:[0,1]
v_pk_add_f32 v[30:31], v[30:31], v[46:47]
v_pk_mul_f32 v[46:47], v[40:41], s[54:55] op_sel:[0,0] op_sel_hi:[0,1] neg_lo:[0,1] neg_hi:[0,0]
v_pk_fma_f32 v[46:47], v[40:41], s[54:55], v[46:47] op_sel:[1,1,0] op_sel_hi:[1,0,1] neg_lo:[0,1,0] neg_hi:[0,1,0]
v_pk_add_f32 v[40:41], v[14:15], v[48:49] neg_lo:[0,1] neg_hi:[0,1]
v_pk_add_f32 v[14:15], v[14:15], v[48:49]
v_pk_add_f32 v[48:49], v[50:51], v[66:67] neg_lo:[0,1] neg_hi:[0,1]
v_pk_add_f32 v[50:51], v[50:51], v[66:67]
v_pk_mul_f32 v[66:67], v[48:49], s[54:55] op_sel:[0,0] op_sel_hi:[0,1] neg_lo:[0,0] neg_hi:[0,0]
v_pk_fma_f32 v[66:67], v[48:49], s[54:55], v[66:67] op_sel:[1,1,0] op_sel_hi:[1,0,1] neg_lo:[0,1,0] neg_hi:[0,0,0]
v_pk_add_f32 v[48:49], v[52:53], v[68:69] neg_lo:[0,1] neg_hi:[0,1]
v_pk_add_f32 v[52:53], v[52:53], v[68:69]
v_pk_mul_f32 v[68:69], v[48:49], s[62:63] op_sel:[0,0] op_sel_hi:[0,1] neg_lo:[0,0] neg_hi:[0,0]
v_pk_fma_f32 v[68:69], v[48:49], s[62:63], v[68:69] op_sel:[1,1,0] op_sel_hi:[1,0,1] neg_lo:[0,1,0] neg_hi:[0,0,0]
v_pk_add_f32 v[48:49], v[54:55], v[70:71] neg_lo:[0,1] neg_hi:[0,1]
v_pk_add_f32 v[54:55], v[54:55], v[70:71]
v_pk_mul_f32 v[70:71], v[48:49], s[54:55] op_sel:[0,1] op_sel_hi:[0,0] neg_lo:[0,0] neg_hi:[0,0]
v_pk_fma_f32 v[70:71], v[48:49], s[54:55], v[70:71] op_sel:[1,0,0] op_sel_hi:[1,1,1] neg_lo:[0,1,0] neg_hi:[0,0,0]
v_pk_add_f32 v[48:49], v[56:57], v[72:73] op_sel:[1,1] op_sel_hi:[0,0] neg_lo:[1,0] neg_hi:[0,1]
v_pk_add_f32 v[56:57], v[56:57], v[72:73]
v_pk_add_f32 v[72:73], v[58:59], v[74:75] neg_lo:[0,1] neg_hi:[0,1]
v_pk_add_f32 v[58:59], v[58:59], v[74:75]
v_pk_mul_f32 v[74:75], v[72:73], s[54:55] op_sel:[0,1] op_sel_hi:[0,0] neg_lo:[0,1] neg_hi:[0,0]
v_pk_fma_f32 v[74:75], v[72:73], s[54:55], v[74:75] op_sel:[1,0,0] op_sel_hi:[1,1,1] neg_lo:[0,1,0] neg_hi:[0,1,0]
v_pk_add_f32 v[72:73], v[60:61], v[76:77] neg_lo:[0,1] neg_hi:[0,1]
v_pk_add_f32 v[60:61], v[60:61], v[76:77]
v_pk_mul_f32 v[76:77], v[72:73], s[62:63] op_sel:[0,0] op_sel_hi:[0,1] neg_lo:[0,1] neg_hi:[0,0]
v_pk_fma_f32 v[76:77], v[72:73], s[62:63], v[76:77] op_sel:[1,1,0] op_sel_hi:[1,0,1] neg_lo:[0,1,0] neg_hi:[0,1,0]
v_pk_add_f32 v[72:73], v[62:63], v[78:79] neg_lo:[0,1] neg_hi:[0,1]
v_pk_add_f32 v[62:63], v[62:63], v[78:79]
v_pk_mul_f32 v[78:79], v[72:73], s[54:55] op_sel:[0,0] op_sel_hi:[0,1] neg_lo:[0,1] neg_hi:[0,0]
v_pk_fma_f32 v[78:79], v[72:73], s[54:55], v[78:79] op_sel:[1,1,0] op_sel_hi:[1,0,1] neg_lo:[0,1,0] neg_hi:[0,1,0]
v_pk_add_f32 v[72:73], v[16:17], v[24:25] neg_lo:[0,1] neg_hi:[0,1]
v_pk_add_f32 v[16:17], v[16:17], v[24:25]
v_pk_add_f32 v[24:25], v[18:19], v[26:27] neg_lo:[0,1] neg_hi:[0,1]
v_pk_add_f32 v[18:19], v[18:19], v[26:27]
v_pk_mul_f32 v[26:27], v[24:25], s[62:63] op_sel:[0,0] op_sel_hi:[0,1] neg_lo:[0,0] neg_hi:[0,0]
v_pk_fma_f32 v[26:27], v[24:25], s[62:63], v[26:27] op_sel:[1,1,0] op_sel_hi:[1,0,1] neg_lo:[0,1,0] neg_hi:[0,0,0]
v_pk_add_f32 v[24:25], v[20:21], v[28:29] op_sel:[1,1] op_sel_hi:[0,0] neg_lo:[1,0] neg_hi:[0,1]
v_pk_add_f32 v[20:21], v[20:21], v[28:29]
v_pk_add_f32 v[28:29], v[22:23], v[30:31] neg_lo:[0,1] neg_hi:[0,1]
v_pk_add_f32 v[22:23], v[22:23], v[30:31]
v_pk_mul_f32 v[30:31], v[28:29], s[62:63] op_sel:[0,0] op_sel_hi:[0,1] neg_lo:[0,1] neg_hi:[0,0]
v_pk_fma_f32 v[30:31], v[28:29], s[62:63], v[30:31] op_sel:[1,1,0] op_sel_hi:[1,0,1] neg_lo:[0,1,0] neg_hi:[0,1,0]
v_pk_add_f32 v[28:29], v[64:65], v[32:33] neg_lo:[0,1] neg_hi:[0,1]
v_pk_add_f32 v[64:65], v[64:65], v[32:33]
v_pk_add_f32 v[32:33], v[34:35], v[42:43] neg_lo:[0,1] neg_hi:[0,1]
v_pk_add_f32 v[34:35], v[34:35], v[42:43]
v_pk_mul_f32 v[42:43], v[32:33], s[62:63] op_sel:[0,0] op_sel_hi:[0,1] neg_lo:[0,0] neg_hi:[0,0]
v_pk_fma_f32 v[42:43], v[32:33], s[62:63], v[42:43] op_sel:[1,1,0] op_sel_hi:[1,0,1] neg_lo:[0,1,0] neg_hi:[0,0,0]
v_pk_add_f32 v[32:33], v[36:37], v[44:45] op_sel:[1,1] op_sel_hi:[0,0] neg_lo:[1,0] neg_hi:[0,1]
v_pk_add_f32 v[36:37], v[36:37], v[44:45]
v_pk_add_f32 v[44:45], v[38:39], v[46:47] neg_lo:[0,1] neg_hi:[0,1]
v_pk_add_f32 v[38:39], v[38:39], v[46:47]
v_pk_mul_f32 v[46:47], v[44:45], s[62:63] op_sel:[0,0] op_sel_hi:[0,1] neg_lo:[0,1] neg_hi:[0,0]
v_pk_fma_f32 v[46:47], v[44:45], s[62:63], v[46:47] op_sel:[1,1,0] op_sel_hi:[1,0,1] neg_lo:[0,1,0] neg_hi:[0,1,0]
v_pk_add_f32 v[44:45], v[14:15], v[56:57] neg_lo:[0,1] neg_hi:[0,1]
v_pk_add_f32 v[14:15], v[14:15], v[56:57]
v_pk_add_f32 v[56:57], v[50:51], v[58:59] neg_lo:[0,1] neg_hi:[0,1]
v_pk_add_f32 v[50:51], v[50:51], v[58:59]
v_pk_mul_f32 v[58:59], v[56:57], s[62:63] op_sel:[0,0] op_sel_hi:[0,1] neg_lo:[0,0] neg_hi:[0,0]
v_pk_fma_f32 v[58:59], v[56:57], s[62:63], v[58:59] op_sel:[1,1,0] op_sel_hi:[1,0,1] neg_lo:[0,1,0] neg_hi:[0,0,0]
v_pk_add_f32 v[56:57], v[52:53], v[60:61] op_sel:[1,1] op_sel_hi:[0,0] neg_lo:[1,0] neg_hi:[0,1]
v_pk_add_f32 v[52:53], v[52:53], v[60:61]
v_pk_add_f32 v[60:61], v[54:55], v[62:63] neg_lo:[0,1] neg_hi:[0,1]
v_pk_add_f32 v[54:55], v[54:55], v[62:63]
v_pk_mul_f32 v[62:63], v[60:61], s[62:63] op_sel:[0,0] op_sel_hi:[0,1] neg_lo:[0,1] neg_hi:[0,0]
v_pk_fma_f32 v[62:63], v[60:61], s[62:63], v[62:63] op_sel:[1,1,0] op_sel_hi:[1,0,1] neg_lo:[0,1,0] neg_hi:[0,1,0]
v_pk_add_f32 v[60:61], v[40:41], v[48:49] neg_lo:[0,1] neg_hi:[0,1]
v_pk_add_f32 v[40:41], v[40:41], v[48:49]
v_pk_add_f32 v[48:49], v[66:67], v[74:75] neg_lo:[0,1] neg_hi:[0,1]
v_pk_add_f32 v[66:67], v[66:67], v[74:75]
v_pk_mul_f32 v[74:75], v[48:49], s[62:63] op_sel:[0,0] op_sel_hi:[0,1] neg_lo:[0,0] neg_hi:[0,0]
v_pk_fma_f32 v[74:75], v[48:49], s[62:63], v[74:75] op_sel:[1,1,0] op_sel_hi:[1,0,1] neg_lo:[0,1,0] neg_hi:[0,0,0]
v_pk_add_f32 v[48:49], v[68:69], v[76:77] op_sel:[1,1] op_sel_hi:[0,0] neg_lo:[1,0] neg_hi:[0,1]
v_pk_add_f32 v[68:69], v[68:69], v[76:77]
v_pk_add_f32 v[76:77], v[70:71], v[78:79] neg_lo:[0,1] neg_hi:[0,1]
v_pk_add_f32 v[70:71], v[70:71], v[78:79]
v_pk_mul_f32 v[78:79], v[76:77], s[62:63] op_sel:[0,0] op_sel_hi:[0,1] neg_lo:[0,1] neg_hi:[0,0]
v_pk_fma_f32 v[78:79], v[76:77], s[62:63], v[78:79] op_sel:[1,1,0] op_sel_hi:[1,0,1] neg_lo:[0,1,0] neg_hi:[0,1,0]
v_pk_add_f32 v[76:77], v[16:17], v[20:21] neg_lo:[0,1] neg_hi:[0,1]
v_pk_add_f32 v[16:17], v[16:17], v[20:21]
v_pk_add_f32 v[20:21], v[18:19], v[22:23] op_sel:[1,1] op_sel_hi:[0,0] neg_lo:[1,0] neg_hi:[0,1]
v_pk_add_f32 v[18:19], v[18:19], v[22:23]
v_pk_add_f32 v[22:23], v[72:73], v[24:25] neg_lo:[0,1] neg_hi:[0,1]
v_pk_add_f32 v[72:73], v[72:73], v[24:25]
v_pk_add_f32 v[24:25], v[26:27], v[30:31] op_sel:[1,1] op_sel_hi:[0,0] neg_lo:[1,0] neg_hi:[0,1]
v_pk_add_f32 v[26:27], v[26:27], v[30:31]
v_pk_add_f32 v[30:31], v[64:65], v[36:37] neg_lo:[0,1] neg_hi:[0,1]
v_pk_add_f32 v[64:65], v[64:65], v[36:37]
v_pk_add_f32 v[36:37], v[34:35], v[38:39] op_sel:[1,1] op_sel_hi:[0,0] neg_lo:[1,0] neg_hi:[0,1]
v_pk_add_f32 v[34:35], v[34:35], v[38:39]
v_pk_add_f32 v[38:39], v[28:29], v[32:33] neg_lo:[0,1] neg_hi:[0,1]
v_pk_add_f32 v[28:29], v[28:29], v[32:33]
v_pk_add_f32 v[32:33], v[42:43], v[46:47] op_sel:[1,1] op_sel_hi:[0,0] neg_lo:[1,0] neg_hi:[0,1]
v_pk_add_f32 v[42:43], v[42:43], v[46:47]
v_pk_add_f32 v[46:47], v[14:15], v[52:53] neg_lo:[0,1] neg_hi:[0,1]
v_pk_add_f32 v[14:15], v[14:15], v[52:53]
v_pk_add_f32 v[52:53], v[50:51], v[54:55] op_sel:[1,1] op_sel_hi:[0,0] neg_lo:[1,0] neg_hi:[0,1]
v_pk_add_f32 v[50:51], v[50:51], v[54:55]
v_pk_add_f32 v[54:55], v[44:45], v[56:57] neg_lo:[0,1] neg_hi:[0,1]
v_pk_add_f32 v[44:45], v[44:45], v[56:57]
v_pk_add_f32 v[56:57], v[58:59], v[62:63] op_sel:[1,1] op_sel_hi:[0,0] neg_lo:[1,0] neg_hi:[0,1]
v_pk_add_f32 v[58:59], v[58:59], v[62:63]
v_pk_add_f32 v[62:63], v[40:41], v[68:69] neg_lo:[0,1] neg_hi:[0,1]
v_pk_add_f32 v[40:41], v[40:41], v[68:69]
v_pk_add_f32 v[68:69], v[66:67], v[70:71] op_sel:[1,1] op_sel_hi:[0,0] neg_lo:[1,0] neg_hi:[0,1]
v_pk_add_f32 v[66:67], v[66:67], v[70:71]
v_pk_add_f32 v[70:71], v[60:61], v[48:49] neg_lo:[0,1] neg_hi:[0,1]
v_pk_add_f32 v[60:61], v[60:61], v[48:49]
v_pk_add_f32 v[48:49], v[74:75], v[78:79] op_sel:[1,1] op_sel_hi:[0,0] neg_lo:[1,0] neg_hi:[0,1]
v_pk_add_f32 v[74:75], v[74:75], v[78:79]
v_pk_add_f32 v[78:79], v[16:17], v[18:19] neg_lo:[0,1] neg_hi:[0,1]
v_pk_add_f32 v[16:17], v[16:17], v[18:19]
v_pk_add_f32 v[18:19], v[76:77], v[20:21] neg_lo:[0,1] neg_hi:[0,1]
v_pk_add_f32 v[76:77], v[76:77], v[20:21]
v_pk_add_f32 v[20:21], v[72:73], v[26:27] neg_lo:[0,1] neg_hi:[0,1]
v_pk_add_f32 v[72:73], v[72:73], v[26:27]
v_pk_add_f32 v[26:27], v[22:23], v[24:25] neg_lo:[0,1] neg_hi:[0,1]
v_pk_add_f32 v[22:23], v[22:23], v[24:25]
v_pk_add_f32 v[24:25], v[64:65], v[34:35] neg_lo:[0,1] neg_hi:[0,1]
v_pk_add_f32 v[64:65], v[64:65], v[34:35]
v_pk_add_f32 v[34:35], v[30:31], v[36:37] neg_lo:[0,1] neg_hi:[0,1]
v_pk_add_f32 v[30:31], v[30:31], v[36:37]
v_pk_add_f32 v[36:37], v[28:29], v[42:43] neg_lo:[0,1] neg_hi:[0,1]
v_pk_add_f32 v[28:29], v[28:29], v[42:43]
v_pk_add_f32 v[42:43], v[38:39], v[32:33] neg_lo:[0,1] neg_hi:[0,1]
v_pk_add_f32 v[38:39], v[38:39], v[32:33]
v_pk_add_f32 v[32:33], v[14:15], v[50:51] neg_lo:[0,1] neg_hi:[0,1]
v_pk_add_f32 v[14:15], v[14:15], v[50:51]
v_pk_add_f32 v[50:51], v[46:47], v[52:53] neg_lo:[0,1] neg_hi:[0,1]
v_pk_add_f32 v[46:47], v[46:47], v[52:53]
v_pk_add_f32 v[52:53], v[44:45], v[58:59] neg_lo:[0,1] neg_hi:[0,1]
v_pk_add_f32 v[44:45], v[44:45], v[58:59]
v_pk_add_f32 v[58:59], v[54:55], v[56:57] neg_lo:[0,1] neg_hi:[0,1]
v_pk_add_f32 v[54:55], v[54:55], v[56:57]
v_pk_add_f32 v[56:57], v[40:41], v[66:67] neg_lo:[0,1] neg_hi:[0,1]
v_pk_add_f32 v[40:41], v[40:41], v[66:67]
v_pk_add_f32 v[66:67], v[62:63], v[68:69] neg_lo:[0,1] neg_hi:[0,1]
v_pk_add_f32 v[62:63], v[62:63], v[68:69]
v_pk_add_f32 v[68:69], v[60:61], v[74:75] neg_lo:[0,1] neg_hi:[0,1]
v_pk_add_f32 v[60:61], v[60:61], v[74:75]
v_pk_add_f32 v[74:75], v[70:71], v[48:49] neg_lo:[0,1] neg_hi:[0,1]
v_pk_add_f32 v[70:71], v[70:71], v[48:49]
s_lshl_b32 s12, s38, 2
s_add_u32 s12, s12, s16
s_min_u32 s12, s12, 512
s_mul_i32 s12, s12, 16384
s_add_u32 s12, s12, 109051904
buffer_store_dwordx2 v[16:17], v5, s[84:87], s12 offen offset:0 sc1
buffer_store_dwordx2 v[14:15], v5, s[84:87], s12 offen offset:512 sc1
buffer_store_dwordx2 v[64:65], v5, s[84:87], s12 offen offset:1024 sc1
buffer_store_dwordx2 v[40:41], v5, s[84:87], s12 offen offset:1536 sc1
buffer_store_dwordx2 v[72:73], v5, s[84:87], s12 offen offset:2048 sc1
buffer_store_dwordx2 v[44:45], v5, s[84:87], s12 offen offset:2560 sc1
buffer_store_dwordx2 v[28:29], v5, s[84:87], s12 offen offset:3072 sc1
buffer_store_dwordx2 v[60:61], v5, s[84:87], s12 offen offset:3584 sc1
s_add_u32 s12, s12, 4096
buffer_store_dwordx2 v[76:77], v5, s[84:87], s12 offen offset:0 sc1
buffer_store_dwordx2 v[46:47], v5, s[84:87], s12 offen offset:512 sc1
buffer_store_dwordx2 v[30:31], v5, s[84:87], s12 offen offset:1024 sc1
buffer_store_dwordx2 v[62:63], v5, s[84:87], s12 offen offset:1536 sc1
buffer_store_dwordx2 v[22:23], v5, s[84:87], s12 offen offset:2048 sc1
buffer_store_dwordx2 v[54:55], v5, s[84:87], s12 offen offset:2560 sc1
buffer_store_dwordx2 v[38:39], v5, s[84:87], s12 offen offset:3072 sc1
buffer_store_dwordx2 v[70:71], v5, s[84:87], s12 offen offset:3584 sc1
s_add_u32 s12, s12, 4096
buffer_store_dwordx2 v[78:79], v5, s[84:87], s12 offen offset:0 sc1
buffer_store_dwordx2 v[32:33], v5, s[84:87], s12 offen offset:512 sc1
buffer_store_dwordx2 v[24:25], v5, s[84:87], s12 offen offset:1024 sc1
buffer_store_dwordx2 v[56:57], v5, s[84:87], s12 offen offset:1536 sc1
buffer_store_dwordx2 v[20:21], v5, s[84:87], s12 offen offset:2048 sc1
buffer_store_dwordx2 v[52:53], v5, s[84:87], s12 offen offset:2560 sc1
buffer_store_dwordx2 v[36:37], v5, s[84:87], s12 offen offset:3072 sc1
buffer_store_dwordx2 v[68:69], v5, s[84:87], s12 offen offset:3584 sc1
s_add_u32 s12, s12, 4096
buffer_store_dwordx2 v[18:19], v5, s[84:87], s12 offen offset:0 sc1
buffer_store_dwordx2 v[50:51], v5, s[84:87], s12 offen offset:512 sc1
buffer_store_dwordx2 v[34:35], v5, s[84:87], s12 offen offset:1024 sc1
buffer_store_dwordx2 v[66:67], v5, s[84:87], s12 offen offset:1536 sc1
buffer_store_dwordx2 v[26:27], v5, s[84:87], s12 offen offset:2048 sc1
buffer_store_dwordx2 v[58:59], v5, s[84:87], s12 offen offset:2560 sc1
buffer_store_dwordx2 v[42:43], v5, s[84:87], s12 offen offset:3072 sc1
buffer_store_dwordx2 v[74:75], v5, s[84:87], s12 offen offset:3584 sc1
s_add_u32 s12, s12, 4096
s_mov_b32 s38, s21
s_cmp_lt_u32 s38, s37
s_cbranch_scc1 mega_kernel_f2_l
mega_kernel_f2_e:
mega_kernel_f2e:
s_waitcnt vmcnt(0)
s_barrier
v_mov_b32 v1, 0
v_mov_b32 v2, 1
s_mov_b32 s82, 69259392
v_cmp_eq_u32 vcc, 0, v0
s_and_saveexec_b64 s[80:81], vcc
s_cbranch_execz mega_kernel_sg1
buffer_atomic_add v2, v1, s[84:87], s82 offen sc1
mega_kernel_sg1:
s_mov_b64 exec, s[80:81]
s_mov_b32 s64, 0
s_mov_b32 s65, 58
s_lshl_b32 s66, s40, 13
s_add_u32 s66, s66, 67633152
s_mov_b32 s67, 0
s_mov_b32 s68, 0
s_cmp_eq_u32 s91, 3
s_cbranch_scc1 mega_kernel_out
s_cmp_lt_u32 s92, 1
s_cbranch_scc1 mega_kernel_back
s_mov_b32 s68, 1
s_branch mega_kernel_out
mega_kernel_back:
s_lshl_b32 s68, s68, 1
s_mov_b32 s93, s92
s_load_dwordx2 s[4:5], s[0:1], 80
s_mov_b32 s48, 0x3f7ec46d
s_mov_b32 s49, 0x3dc8bd36
s_mov_b32 s50, 0x3f7b14be
s_mov_b32 s51, 0x3e47c5c2
s_mov_b32 s52, 0x3f74fa0b
s_mov_b32 s53, 0x3e94a031
s_mov_b32 s54, 0x3f6c835e
s_mov_b32 s55, 0x3ec3ef15
s_mov_b32 s56, 0x3f61c598
s_mov_b32 s57, 0x3ef15aea
s_mov_b32 s58, 0x3f54db31
s_mov_b32 s59, 0x3f0e39da
s_mov_b32 s60, 0x3f45e403
s_mov_b32 s61, 0x3f226799
s_mov_b32 s62, 0x3f3504f3
s_mov_b32 s63, 0x3f3504f3
v_and_b32 v1, 31, v0
v_lshrrev_b32 v2, 5, v0
v_cvt_f32_u32 v3, v1
v_mul_u32_u24 v10, 8448, v2
v_lshl_add_u32 v4, v1, 3, v10
v_mul_u32_u24 v5, 264, v1
v_add_u32 v5, v5, v10
v_and_b32 v11, 7, v0
v_lshrrev_b32 v9, 3, v0
v_mul_u32_u24 v10, 8448, v11
v_lshl_add_u32 v6, v9, 3, v10
v_lshlrev_b32 v7, 3, v9
v_sub_u32 v7, v10, v7
v_add_u32 v7, 4096, v7
v_mul_u32_u24 v8, 16384, v9
v_lshl_add_u32 v8, v11, 4, v8
v_mul_f32 v12, 0x3a800000, v3
v_cos_f32 v82, v12
v_sin_f32 v83, v12
v_mul_f32 v12, 0x3b000000, v3
v_cos_f32 v84, v12
v_sin_f32 v85, v12
v_mul_f32 v12, 0x3b400000, v3
v_cos_f32 v86, v12
v_sin_f32 v87, v12
v_mul_f32 v12, 0x3b800000, v3
v_cos_f32 v88, v12
v_sin_f32 v89, v12
v_mul_f32 v12, 0x3ba00000, v3
v_cos_f32 v90, v12
v_sin_f32 v91, v12
v_mul_f32 v12, 0x3bc00000, v3
v_cos_f32 v92, v12
v_sin_f32 v93, v12
v_mul_f32 v12, 0x3be00000, v3
v_cos_f32 v94, v12
v_sin_f32 v95, v12
v_mul_f32 v12, 0x3c000000, v3
v_cos_f32 v96, v12
v_sin_f32 v97, v12
v_mul_f32 v12, 0x3c100000, v3
v_cos_f32 v98, v12
v_sin_f32 v99, v12
v_mul_f32 v12, 0x3c200000, v3
v_cos_f32 v100, v12
v_sin_f32 v101, v12
v_mul_f32 v12, 0x3c300000, v3
v_cos_f32 v102, v12
v_sin_f32 v103, v12
v_mul_f32 v12, 0x3c400000, v3
v_cos_f32 v104, v12
v_sin_f32 v105, v12
v_mul_f32 v12, 0x3c500000, v3
v_cos_f32 v106, v12
v_sin_f32 v107, v12
v_mul_f32 v12, 0x3c600000, v3
v_cos_f32 v108, v12
v_sin_f32 v109, v12
v_mul_f32 v12, 0x3c700000, v3
v_cos_f32 v110, v12
v_sin_f32 v111, v12
v_mul_f32 v12, 0x3c800000, v3
v_cos_f32 v112, v12
v_sin_f32 v113, v12
v_mul_f32 v12, 0x3c880000, v3
v_cos_f32 v114, v12
v_sin_f32 v115, v12
v_mul_f32 v12, 0x3c900000, v3
v_cos_f32 v116, v12
v_sin_f32 v117, v12
v_mul_f32 v12, 0x3c980000, v3
v_cos_f32 v118, v12
v_sin_f32 v119, v12
v_mul_f32 v12, 0x3ca00000, v3
v_cos_f32 v120, v12
v_sin_f32 v121, v12
v_mul_f32 v12, 0x3ca80000, v3
v_cos_f32 v122, v12
v_sin_f32 v123, v12
v_mul_f32 v12, 0x3cb00000, v3
v_cos_f32 v124, v12
v_sin_f32 v125, v12
v_mul_f32 v12, 0x3cb80000, v3
v_cos_f32 v126, v12
v_sin_f32 v127, v12
v_mul_f32 v12, 0x3cc00000, v3
v_cos_f32 v128, v12
v_sin_f32 v129, v12
v_mul_f32 v12, 0x3cc80000, v3
v_cos_f32 v130, v12
v_sin_f32 v131, v12
v_mul_f32 v12, 0x3cd00000, v3
v_cos_f32 v132, v12
v_sin_f32 v133, v12
v_mul_f32 v12, 0x3cd80000, v3
v_cos_f32 v134, v12
v_sin_f32 v135, v12
v_mul_f32 v12, 0x3ce00000, v3
v_cos_f32 v136, v12
v_sin_f32 v137, v12
v_mul_f32 v12, 0x3ce80000, v3
v_cos_f32 v138, v12
v_sin_f32 v139, v12
v_mul_f32 v12, 0x3cf00000, v3
v_cos_f32 v140, v12
v_sin_f32 v141, v12
v_mul_f32 v12, 0x3cf80000, v3
v_cos_f32 v142, v12
v_sin_f32 v143, v12
v_lshlrev_b32 v12, 2, v1
v_sub_u32 v12, v4, v12
v_and_b32 v10, 127, v0
v_lshrrev_b32 v11, 7, v0
v_lshlrev_b32 v2, 5, v10
v_lshl_add_u32 v2, v11, 12, v2
v_lshlrev_b32 v3, 4, v10
v_lshl_add_u32 v3, v11, 12, v3
v_add_u32 v3, 2048, v3
v_cmp_eq_u32 s[14:15], 0, v9
s_waitcnt lgkmcnt(0)
s_mov_b32 s6, 8388608
s_mov_b32 s7, 0x00020000
v_mov_b32 v250, 0
s_mov_b32 s82, 69259392
mega_kernel_w1:
s_sleep 8
buffer_load_dword v251, v250, s[84:87], s82 offen sc1
s_waitcnt vmcnt(0)
v_cmp_ne_u32 vcc, 95, v251
s_cbranch_vccnz mega_kernel_w1
s_cmp_lt_u32 s93, 128
s_cbranch_scc0 mega_kernel_f3_e
s_lshl_b32 s12, s93, 7
s_add_u32 s12, s12, 109051904
buffer_load_dwordx4 v[144:147], v8, s[84:87], s12 offen sc1
s_add_u32 s12, s12, 524288
buffer_load_dwordx4 v[148:151], v8, s[84:87], s12 offen sc1
s_add_u32 s12, s12, 524288
buffer_load_dwordx4 v[152:155], v8, s[84:87], s12 offen sc1
s_add_u32 s12, s12, 524288
buffer_load_dwordx4 v[156:159], v8, s[84:87], s12 offen sc1
s_add_u32 s12, s12, 524288
buffer_load_dwordx4 v[160:163], v8, s[84:87], s12 offen sc1
s_add_u32 s12, s12, 524288
buffer_load_dwordx4 v[164:167], v8, s[84:87], s12 offen sc1
s_add_u32 s12, s12, 524288
buffer_load_dwordx4 v[168:171], v8, s[84:87], s12 offen sc1
s_add_u32 s12, s12, 524288
buffer_load_dwordx4 v[172:175], v8, s[84:87], s12 offen sc1
s_add_u32 s12, s12, 524288
buffer_load_dwordx4 v[176:179], v8, s[84:87], s12 offen sc1
s_add_u32 s12, s12, 524288
buffer_load_dwordx4 v[180:183], v8, s[84:87], s12 offen sc1
s_add_u32 s12, s12, 524288
buffer_load_dwordx4 v[184:187], v8, s[84:87], s12 offen sc1
s_add_u32 s12, s12, 524288
buffer_load_dwordx4 v[188:191], v8, s[84:87], s12 offen sc1
s_add_u32 s12, s12, 524288
buffer_load_dwordx4 v[192:195], v8, s[84:87], s12 offen sc1
s_add_u32 s12, s12, 524288
buffer_load_dwordx4 v[196:199], v8, s[84:87], s12 offen sc1
s_add_u32 s12, s12, 524288
buffer_load_dwordx4 v[200:203], v8, s[84:87], s12 offen sc1
s_add_u32 s12, s12, 524288
buffer_load_dwordx4 v[204:207], v8, s[84:87], s12 offen sc1
s_add_u32 s12, s12, 524288
buffer_load_dwordx4 v[208:211], v8, s[84:87], s12 offen sc1
s_add_u32 s12, s12, 524288
s_waitcnt vmcnt(0)
mega_kernel_f3_l:
s_add_u32 s21, s93, 64
s_cmp_lt_u32 s21, 128
s_cselect_b32 s22, s21, s93
s_waitcnt vmcnt(8)
s_barrier
v_cndmask_b32 v145, v145, 0, s[14:15]
v_cndmask_b32 v147, v147, 0, s[14:15]
v_cndmask_b32 v209, v209, 0, s[14:15]
v_cndmask_b32 v211, v211, 0, s[14:15]
v_pk_add_f32 v[16:17], v[144:145], v[146:147] op_sel:[0,1] op_sel_hi:[1,0] neg_lo:[0,1]
v_pk_add_f32 v[18:19], v[144:145], v[146:147] op_sel:[0,1] op_sel_hi:[1,0] neg_hi:[1,0]
ds_write_b64 v6, v[16:17] offset:0
ds_write_b64 v7, v[18:19] offset:4096
v_pk_add_f32 v[20:21], v[148:149], v[150:151] op_sel:[0,1] op_sel_hi:[1,0] neg_lo:[0,1]
v_pk_add_f32 v[22:23], v[148:149], v[150:151] op_sel:[0,1] op_sel_hi:[1,0] neg_hi:[1,0]
ds_write_b64 v6, v[20:21] offset:256
ds_write_b64 v7, v[22:23] offset:3840
v_pk_add_f32 v[24:25], v[152:153], v[154:155] op_sel:[0,1] op_sel_hi:[1,0] neg_lo:[0,1]
v_pk_add_f32 v[26:27], v[152:153], v[154:155] op_sel:[0,1] op_sel_hi:[1,0] neg_hi:[1,0]
ds_write_b64 v6, v[24:25] offset:512
ds_write_b64 v7, v[26:27] offset:3584
v_pk_add_f32 v[28:29], v[156:157], v[158:159] op_sel:[0,1] op_sel_hi:[1,0] neg_lo:[0,1]
v_pk_add_f32 v[30:31], v[156:157], v[158:159] op_sel:[0,1] op_sel_hi:[1,0] neg_hi:[1,0]
ds_write_b64 v6, v[28:29] offset:768
ds_write_b64 v7, v[30:31] offset:3328
v_pk_add_f32 v[32:33], v[160:161], v[162:163] op_sel:[0,1] op_sel_hi:[1,0] neg_lo:[0,1]
v_pk_add_f32 v[34:35], v[160:161], v[162:163] op_sel:[0,1] op_sel_hi:[1,0] neg_hi:[1,0]
ds_write_b64 v6, v[32:33] offset:1024
ds_write_b64 v7, v[34:35] offset:3072
v_pk_add_f32 v[36:37], v[164:165], v[166:167] op_sel:[0,1] op_sel_hi:[1,0] neg_lo:[0,1]
v_pk_add_f32 v[38:39], v[164:165], v[166:167] op_sel:[0,1] op_sel_hi:[1,0] neg_hi:[1,0]
ds_write_b64 v6, v[36:37] offset:1280
ds_write_b64 v7, v[38:39] offset:2816
v_pk_add_f32 v[40:41], v[168:169], v[170:171] op_sel:[0,1] op_sel_hi:[1,0] neg_lo:[0,1]
v_pk_add_f32 v[42:43], v[168:169], v[170:171] op_sel:[0,1] op_sel_hi:[1,0] neg_hi:[1,0]
ds_write_b64 v6, v[40:41] offset:1536
ds_write_b64 v7, v[42:43] offset:2560
v_pk_add_f32 v[44:45], v[172:173], v[174:175] op_sel:[0,1] op_sel_hi:[1,0] neg_lo:[0,1]
v_pk_add_f32 v[46:47], v[172:173], v[174:175] op_sel:[0,1] op_sel_hi:[1,0] neg_hi:[1,0]
ds_write_b64 v6, v[44:45] offset:1792
ds_write_b64 v7, v[46:47] offset:2304
v_pk_add_f32 v[48:49], v[176:177], v[178:179] op_sel:[0,1] op_sel_hi:[1,0] neg_lo:[0,1]
v_pk_add_f32 v[50:51], v[176:177], v[178:179] op_sel:[0,1] op_sel_hi:[1,0] neg_hi:[1,0]
ds_write_b64 v6, v[48:49] offset:2048
ds_write_b64 v7, v[50:51] offset:2048
v_pk_add_f32 v[52:53], v[180:181], v[182:183] op_sel:[0,1] op_sel_hi:[1,0] neg_lo:[0,1]
v_pk_add_f32 v[54:55], v[180:181], v[182:183] op_sel:[0,1] op_sel_hi:[1,0] neg_hi:[1,0]
ds_write_b64 v6, v[52:53] offset:2304
ds_write_b64 v7, v[54:55] offset:1792
v_pk_add_f32 v[56:57], v[184:185], v[186:187] op_sel:[0,1] op_sel_hi:[1,0] neg_lo:[0,1]
v_pk_add_f32 v[58:59], v[184:185], v[186:187] op_sel:[0,1] op_sel_hi:[1,0] neg_hi:[1,0]
ds_write_b64 v6, v[56:57] offset:2560
ds_write_b64 v7, v[58:59] offset:1536
v_pk_add_f32 v[60:61], v[188:189], v[190:191] op_sel:[0,1] op_sel_hi:[1,0] neg_lo:[0,1]
v_pk_add_f32 v[62:63], v[188:189], v[190:191] op_sel:[0,1] op_sel_hi:[1,0] neg_hi:[1,0]
ds_write_b64 v6, v[60:61] offset:2816
ds_write_b64 v7, v[62:63] offset:1280
v_pk_add_f32 v[64:65], v[192:193], v[194:195] op_sel:[0,1] op_sel_hi:[1,0] neg_lo:[0,1]
v_pk_add_f32 v[66:67], v[192:193], v[194:195] op_sel:[0,1] op_sel_hi:[1,0] neg_hi:[1,0]
ds_write_b64 v6, v[64:65] offset:3072
ds_write_b64 v7, v[66:67] offset:1024
v_pk_add_f32 v[68:69], v[196:197], v[198:199] op_sel:[0,1] op_sel_hi:[1,0] neg_lo:[0,1]
v_pk_add_f32 v[70:71], v[196:197], v[198:199] op_sel:[0,1] op_sel_hi:[1,0] neg_hi:[1,0]
ds_write_b64 v6, v[68:69] offset:3328
ds_write_b64 v7, v[70:71] offset:768
v_pk_add_f32 v[72:73], v[200:201], v[202:203] op_sel:[0,1] op_sel_hi:[1,0] neg_lo:[0,1]
v_pk_add_f32 v[74:75], v[200:201], v[202:203] op_sel:[0,1] op_sel_hi:[1,0] neg_hi:[1,0]
ds_write_b64 v6, v[72:73] offset:3584
ds_write_b64 v7, v[74:75] offset:512
s_waitcnt lgkmcnt(8)
v_pk_add_f32 v[76:77], v[204:205], v[206:207] op_sel:[0,1] op_sel_hi:[1,0] neg_lo:[0,1]
v_pk_add_f32 v[78:79], v[204:205], v[206:207] op_sel:[0,1] op_sel_hi:[1,0] neg_hi:[1,0]
ds_write_b64 v6, v[76:77] offset:3840
ds_write_b64 v7, v[78:79] offset:256
v_pk_add_f32 v[16:17], v[208:209], v[210:211] op_sel:[0,1] op_sel_hi:[1,0] neg_lo:[0,1]
v_pk_add_f32 v[18:19], v[208:209], v[210:211] op_sel:[0,1] op_sel_hi:[1,0] neg_hi:[1,0]
s_mov_b64 exec, s[14:15]
ds_write_b64 v6, v[16:17] offset:4096
s_mov_b64 exec, -1
s_lshl_b32 s12, s22, 7
s_add_u32 s12, s12, 109051904
buffer_load_dwordx4 v[144:147], v8, s[84:87], s12 offen sc1
s_add_u32 s12, s12, 524288
buffer_load_dwordx4 v[148:151], v8, s[84:87], s12 offen sc1
s_add_u32 s12, s12, 524288
buffer_load_dwordx4 v[152:155], v8, s[84:87], s12 offen sc1
s_add_u32 s12, s12, 524288
buffer_load_dwordx4 v[156:159], v8, s[84:87], s12 offen sc1
s_add_u32 s12, s12, 524288
buffer_load_dwordx4 v[160:163], v8, s[84:87], s12 offen sc1
s_add_u32 s12, s12, 524288
buffer_load_dwordx4 v[164:167], v8, s[84:87], s12 offen sc1
s_add_u32 s12, s12, 524288
buffer_load_dwordx4 v[168:171], v8, s[84:87], s12 offen sc1
s_add_u32 s12, s12, 524288
buffer_load_dwordx4 v[172:175], v8, s[84:87], s12 offen sc1
s_add_u32 s12, s12, 524288
buffer_load_dwordx4 v[176:179], v8, s[84:87], s12 offen sc1
s_add_u32 s12, s12, 524288
buffer_load_dwordx4 v[180:183], v8, s[84:87], s12 offen sc1
s_add_u32 s12, s12, 524288
buffer_load_dwordx4 v[184:187], v8, s[84:87], s12 offen sc1
s_add_u32 s12, s12, 524288
buffer_load_dwordx4 v[188:191], v8, s[84:87], s12 offen sc1
s_add_u32 s12, s12, 524288
buffer_load_dwordx4 v[192:195], v8, s[84:87], s12 offen sc1
s_add_u32 s12, s12, 524288
buffer_load_dwordx4 v[196:199], v8, s[84:87], s12 offen sc1
s_add_u32 s12, s12, 524288
buffer_load_dwordx4 v[200:203], v8, s[84:87], s12 offen sc1
s_add_u32 s12, s12, 524288
buffer_load_dwordx4 v[204:207], v8, s[84:87], s12 offen sc1
s_add_u32 s12, s12, 524288
buffer_load_dwordx4 v[208:211], v8, s[84:87], s12 offen sc1
s_add_u32 s12, s12, 524288
s_waitcnt lgkmcnt(0)
s_barrier
ds_read_b64 v[16:17], v4 offset:0
ds_read_b64 v[48:49], v4 offset:4096
ds_read_b64 v[18:19], v4 offset:256
ds_read_b64 v[50:51], v4 offset:4352
ds_read_b64 v[20:21], v4 offset:512
ds_read_b64 v[52:53], v4 offset:4608
ds_read_b64 v[22:23], v4 offset:768
ds_read_b64 v[54:55], v4 offset:4864
ds_read_b64 v[24:25], v4 offset:1024
ds_read_b64 v[56:57], v4 offset:5120
ds_read_b64 v[26:27], v4 offset:1280
ds_read_b64 v[58:59], v4 offset:5376
ds_read_b64 v[28:29], v4 offset:1536
ds_read_b64 v[60:61], v4 offset:5632
ds_read_b64 v[30:31], v4 offset:1792
ds_read_b64 v[62:63], v4 offset:5888
ds_read_b64 v[32:33], v4 offset:2048
ds_read_b64 v[64:65], v4 offset:6144
ds_read_b64 v[34:35], v4 offset:2304
ds_read_b64 v[66:67], v4 offset:6400
ds_read_b64 v[36:37], v4 offset:2560
ds_read_b64 v[68:69], v4 offset:6656
ds_read_b64 v[38:39], v4 offset:2816
ds_read_b64 v[70:71], v4 offset:6912
ds_read_b64 v[40:41], v4 offset:3072
ds_read_b64 v[72:73], v4 offset:7168
ds_read_b64 v[42:43], v4 offset:3328
ds_read_b64 v[74:75], v4 offset:7424
ds_read_b64 v[44:45], v4 offset:3584
ds_read_b64 v[76:77], v4 offset:7680
ds_read_b64 v[46:47], v4 offset:3840
ds_read_b64 v[78:79], v4 offset:7936
s_waitcnt lgkmcnt(0)
v_pk_add_f32 v[14:15], v[16:17], v[48:49] neg_lo:[0,1] neg_hi:[0,1]
v_pk_add_f32 v[16:17], v[16:17], v[48:49]
v_pk_add_f32 v[48:49], v[18:19], v[50:51] neg_lo:[0,1] neg_hi:[0,1]
v_pk_add_f32 v[18:19], v[18:19], v[50:51]
v_pk_mul_f32 v[50:51], v[48:49], s[50:51] op_sel:[0,0] op_sel_hi:[0,1] neg_lo:[0,0] neg_hi:[0,0]
v_pk_fma_f32 v[50:51], v[48:49], s[50:51], v[50:51] op_sel:[1,1,0] op_sel_hi:[1,0,1] neg_lo:[0,1,0] neg_hi:[0,0,0]
v_pk_add_f32 v[48:49], v[20:21], v[52:53] neg_lo:[0,1] neg_hi:[0,1]
v_pk_add_f32 v[20:21], v[20:21], v[52:53]
v_pk_mul_f32 v[52:53], v[48:49], s[54:55] op_sel:[0,0] op_sel_hi:[0,1] neg_lo:[0,0] neg_hi:[0,0]
v_pk_fma_f32 v[52:53], v[48:49], s[54:55], v[52:53] op_sel:[1,1,0] op_sel_hi:[1,0,1] neg_lo:[0,1,0] neg_hi:[0,0,0]
v_pk_add_f32 v[48:49], v[22:23], v[54:55] neg_lo:[0,1] neg_hi:[0,1]
v_pk_add_f32 v[22:23], v[22:23], v[54:55]
v_pk_mul_f32 v[54:55], v[48:49], s[58:59] op_sel:[0,0] op_sel_hi:[0,1] neg_lo:[0,0] neg_hi:[0,0]
v_pk_fma_f32 v[54:55], v[48:49], s[58:59], v[54:55] op_sel:[1,1,0] op_sel_hi:[1,0,1] neg_lo:[0,1,0] neg_hi:[0,0,0]
v_pk_add_f32 v[48:49], v[24:25], v[56:57] neg_lo:[0,1] neg_hi:[0,1]
v_pk_add_f32 v[24:25], v[24:25], v[56:57]
v_pk_mul_f32 v[56:57], v[48:49], s[62:63] op_sel:[0,0] op_sel_hi:[0,1] neg_lo:[0,0] neg_hi:[0,0]
v_pk_fma_f32 v[56:57], v[48:49], s[62:63], v[56:57] op_sel:[1,1,0] op_sel_hi:[1,0,1] neg_lo:[0,1,0] neg_hi:[0,0,0]
v_pk_add_f32 v[48:49], v[26:27], v[58:59] neg_lo:[0,1] neg_hi:[0,1]
v_pk_add_f32 v[26:27], v[26:27], v[58:59]
v_pk_mul_f32 v[58:59], v[48:49], s[58:59] op_sel:[0,1] op_sel_hi:[0,0] neg_lo:[0,0] neg_hi:[0,0]
v_pk_fma_f32 v[58:59], v[48:49], s[58:59], v[58:59] op_sel:[1,0,0] op_sel_hi:[1,1,1] neg_lo:[0,1,0] neg_hi:[0,0,0]
v_pk_add_f32 v[48:49], v[28:29], v[60:61] neg_lo:[0,1] neg_hi:[0,1]
v_pk_add_f32 v[28:29], v[28:29], v[60:61]
v_pk_mul_f32 v[60:61], v[48:49], s[54:55] op_sel:[0,1] op_sel_hi:[0,0] neg_lo:[0,0] neg_hi:[0,0]
v_pk_fma_f32 v[60:61], v[48:49], s[54:55], v[60:61] op_sel:[1,0,0] op_sel_hi:[1,1,1] neg_lo:[0,1,0] neg_hi:[0,0,0]
v_pk_add_f32 v[48:49], v[30:31], v[62:63] neg_lo:[0,1] neg_hi:[0,1]
v_pk_add_f32 v[30:31], v[30:31], v[62:63]
v_pk_mul_f32 v[62:63], v[48:49], s[50:51] op_sel:[0,1] op_sel_hi:[0,0] neg_lo:[0,0] neg_hi:[0,0]
v_pk_fma_f32 v[62:63], v[48:49], s[50:51], v[62:63] op_sel:[1,0,0] op_sel_hi:[1,1,1] neg_lo:[0,1,0] neg_hi:[0,0,0]
v_pk_add_f32 v[48:49], v[32:33], v[64:65] op_sel:[1,1] op_sel_hi:[0,0] neg_lo:[1,0] neg_hi:[0,1]
v_pk_add_f32 v[32:33], v[32:33], v[64:65]
v_pk_add_f32 v[64:65], v[34:35], v[66:67] neg_lo:[0,1] neg_hi:[0,1]
v_pk_add_f32 v[34:35], v[34:35], v[66:67]
v_pk_mul_f32 v[66:67], v[64:65], s[50:51] op_sel:[0,1] op_sel_hi:[0,0] neg_lo:[0,1] neg_hi:[0,0]
v_pk_fma_f32 v[66:67], v[64:65], s[50:51], v[66:67] op_sel:[1,0,0] op_sel_hi:[1,1,1] neg_lo:[0,1,0] neg_hi:[0,1,0]
v_pk_add_f32 v[64:65], v[36:37], v[68:69] neg_lo:[0,1] neg_hi:[0,1]
v_pk_add_f32 v[36:37], v[36:37], v[68:69]
v_pk_mul_f32 v[68:69], v[64:65], s[54:55] op_sel:[0,1] op_sel_hi:[0,0] neg_lo:[0,1] neg_hi:[0,0]
v_pk_fma_f32 v[68:69], v[64:65], s[54:55], v[68:69] op_sel:[1,0,0] op_sel_hi:[1,1,1] neg_lo:[0,1,0] neg_hi:[0,1,0]
v_pk_add_f32 v[64:65], v[38:39], v[70:71] neg_lo:[0,1] neg_hi:[0,1]
v_pk_add_f32 v[38:39], v[38:39], v[70:71]
v_pk_mul_f32 v[70:71], v[64:65], s[58:59] op_sel:[0,1] op_sel_hi:[0,0] neg_lo:[0,1] neg_hi:[0,0]
v_pk_fma_f32 v[70:71], v[64:65], s[58:59], v[70:71] op_sel:[1,0,0] op_sel_hi:[1,1,1] neg_lo:[0,1,0] neg_hi:[0,1,0]
v_pk_add_f32 v[64:65], v[40:41], v[72:73] neg_lo:[0,1] neg_hi:[0,1]
v_pk_add_f32 v[40:41], v[40:41], v[72:73]
v_pk_mul_f32 v[72:73], v[64:65], s[62:63] op_sel:[0,0] op_sel_hi:[0,1] neg_lo:[0,1] neg_hi:[0,0]
v_pk_fma_f32 v[72:73], v[64:65], s[62:63], v[72:73] op_sel:[1,1,0] op_sel_hi:[1,0,1] neg_lo:[0,1,0] neg_hi:[0,1,0]
v_pk_add_f32 v[64:65], v[42:43], v[74:75] neg_lo:[0,1] neg_hi:[0,1]
v_pk_add_f32 v[42:43], v[42:43], v[74:75]
v_pk_mul_f32 v[74:75], v[64:65], s[58:59] op_sel:[0,0] op_sel_hi:[0,1] neg_lo:[0,1] neg_hi:[0,0]
v_pk_fma_f32 v[74:75], v[64:65], s[58:59], v[74:75] op_sel:[1,1,0] op_sel_hi:[1,0,1] neg_lo:[0,1,0] neg_hi:[0,1,0]
v_pk_add_f32 v[64:65], v[44:45], v[76:77] neg_lo:[0,1] neg_hi:[0,1]
v_pk_add_f32 v[44:45], v[44:45], v[76:77]
v_pk_mul_f32 v[76:77], v[64:65], s[54:55] op_sel:[0,0] op_sel_hi:[0,1] neg_lo:[0,1] neg_hi:[0,0]
v_pk_fma_f32 v[76:77], v[64:65], s[54:55], v[76:77] op_sel:[1,1,0] op_sel_hi:[1,0,1] neg_lo:[0,1,0] neg_hi:[0,1,0]
v_pk_add_f32 v[64:65], v[46:47], v[78:79] neg_lo:[0,1] neg_hi:[0,1]
v_pk_add_f32 v[46:47], v[46:47], v[78:79]
v_pk_mul_f32 v[78:79], v[64:65], s[50:51] op_sel:[0,0] op_sel_hi:[0,1] neg_lo:[0,1] neg_hi:[0,0]
v_pk_fma_f32 v[78:79], v[64:65], s[50:51], v[78:79] op_sel:[1,1,0] op_sel_hi:[1,0,1] neg_lo:[0,1,0] neg_hi:[0,1,0]
v_pk_add_f32 v[64:65], v[16:17], v[32:33] neg_lo:[0,1] neg_hi:[0,1]
v_pk_add_f32 v[16:17], v[16:17], v[32:33]
v_pk_add_f32 v[32:33], v[18:19], v[34:35] neg_lo:[0,1] neg_hi:[0,1]
v_pk_add_f32 v[18:19], v[18:19], v[34:35]
v_pk_mul_f32 v[34:35], v[32:33], s[54:55] op_sel:[0,0] op_sel_hi:[0,1] neg_lo:[0,0] neg_hi:[0,0]
v_pk_fma_f32 v[34:35], v[32:33], s[54:55], v[34:35] op_sel:[1,1,0] op_sel_hi:[1,0,1] neg_lo:[0,1,0] neg_hi:[0,0,0]
v_pk_add_f32 v[32:33], v[20:21], v[36:37] neg_lo:[0,1] neg_hi:[0,1]
v_pk_add_f32 v[20:21], v[20:21], v[36:37]
v_pk_mul_f32 v[36:37], v[32:33], s[62:63] op_sel:[0,0] op_sel_hi:[0,1] neg_lo:[0,0] neg_hi:[0,0]
v_pk_fma_f32 v[36:37], v[32:33], s[62:63], v[36:37] op_sel:[1,1,0] op_sel_hi:[1,0,1] neg_lo:[0,1,0] neg_hi:[0,0,0]
v_pk_add_f32 v[32:33], v[22:23], v[38:39] neg_lo:[0,1] neg_hi:[0,1]
v_pk_add_f32 v[22:23], v[22:23], v[38:39]
v_pk_mul_f32 v[38:39], v[32:33], s[54:55] op_sel:[0,1] op_sel_hi:[0,0] neg_lo:[0,0] neg_hi:[0,0]
v_pk_fma_f32 v[38:39], v[32:33], s[54:55], v[38:39] op_sel:[1,0,0] op_sel_hi:[1,1,1] neg_lo:[0,1,0] neg_hi:[0,0,0]
v_pk_add_f32 v[32:33], v[24:25], v[40:41] op_sel:[1,1] op_sel_hi:[0,0] neg_lo:[1,0] neg_hi:[0,1]
v_pk_add_f32 v[24:25], v[24:25], v[40:41]
v_pk_add_f32 v[40:41], v[26:27], v[42:43] neg_lo:[0,1] neg_hi:[0,1]
v_pk_add_f32 v[26:27], v[26:27], v[42:43]
v_pk_mul_f32 v[42:43], v[40:41], s[54:55] op_sel:[0,1] op_sel_hi:[0,0] neg_lo:[0,1] neg_hi:[0,0]
v_pk_fma_f32 v[42:43], v[40:41], s[54:55], v[42:43] op_sel:[1,0,0] op_sel_hi:[1,1,1] neg_lo:[0,1,0] neg_hi:[0,1,0]
v_pk_add_f32 v[40:41], v[28:29], v[44:45] neg_lo:[0,1] neg_hi:[0,1]
v_pk_add_f32 v[28:29], v[28:29], v[44:45]
v_pk_mul_f32 v[44:45], v[40:41], s[62:63] op_sel:[0,0] op_sel_hi:[0,1] neg_lo:[0,1] neg_hi:[0,0]
v_pk_fma_f32 v[44:45], v[40:41], s[62:63], v[44:45] op_sel:[1,1,0] op_sel_hi:[1,0,1] neg_lo:[0,1,0] neg_hi:[0,1,0]
v_pk_add_f32 v[40:41], v[30:31], v[46:47] neg_lo:[0,1] neg_hi:[0,1]
v_pk_add_f32 v[30:31], v[30:31], v[46:47]
v_pk_mul_f32 v[46:47], v[40:41], s[54:55] op_sel:[0,0] op_sel_hi:[0,1] neg_lo:[0,1] neg_hi:[0,0]
v_pk_fma_f32 v[46:47], v[40:41], s[54:55], v[46:47] op_sel:[1,1,0] op_sel_hi:[1,0,1] neg_lo:[0,1,0] neg_hi:[0,1,0]
v_pk_add_f32 v[40:41], v[14:15], v[48:49] neg_lo:[0,1] neg_hi:[0,1]
v_pk_add_f32 v[14:15], v[14:15], v[48:49]
v_pk_add_f32 v[48:49], v[50:51], v[66:67] neg_lo:[0,1] neg_hi:[0,1]
v_pk_add_f32 v[50:51], v[50:51], v[66:67]
v_pk_mul_f32 v[66:67], v[48:49], s[54:55] op_sel:[0,0] op_sel_hi:[0,1] neg_lo:[0,0] neg_hi:[0,0]
v_pk_fma_f32 v[66:67], v[48:49], s[54:55], v[66:67] op_sel:[1,1,0] op_sel_hi:[1,0,1] neg_lo:[0,1,0] neg_hi:[0,0,0]
v_pk_add_f32 v[48:49], v[52:53], v[68:69] neg_lo:[0,1] neg_hi:[0,1]
v_pk_add_f32 v[52:53], v[52:53], v[68:69]
v_pk_mul_f32 v[68:69], v[48:49], s[62:63] op_sel:[0,0] op_sel_hi:[0,1] neg_lo:[0,0] neg_hi:[0,0]
v_pk_fma_f32 v[68:69], v[48:49], s[62:63], v[68:69] op_sel:[1,1,0] op_sel_hi:[1,0,1] neg_lo:[0,1,0] neg_hi:[0,0,0]
v_pk_add_f32 v[48:49], v[54:55], v[70:71] neg_lo:[0,1] neg_hi:[0,1]
v_pk_add_f32 v[54:55], v[54:55], v[70:71]
v_pk_mul_f32 v[70:71], v[48:49], s[54:55] op_sel:[0,1] op_sel_hi:[0,0] neg_lo:[0,0] neg_hi:[0,0]
v_pk_fma_f32 v[70:71], v[48:49], s[54:55], v[70:71] op_sel:[1,0,0] op_sel_hi:[1,1,1] neg_lo:[0,1,0] neg_hi:[0,0,0]
v_pk_add_f32 v[48:49], v[56:57], v[72:73] op_sel:[1,1] op_sel_hi:[0,0] neg_lo:[1,0] neg_hi:[0,1]
v_pk_add_f32 v[56:57], v[56:57], v[72:73]
v_pk_add_f32 v[72:73], v[58:59], v[74:75] neg_lo:[0,1] neg_hi:[0,1]
v_pk_add_f32 v[58:59], v[58:59], v[74:75]
v_pk_mul_f32 v[74:75], v[72:73], s[54:55] op_sel:[0,1] op_sel_hi:[0,0] neg_lo:[0,1] neg_hi:[0,0]
v_pk_fma_f32 v[74:75], v[72:73], s[54:55], v[74:75] op_sel:[1,0,0] op_sel_hi:[1,1,1] neg_lo:[0,1,0] neg_hi:[0,1,0]
v_pk_add_f32 v[72:73], v[60:61], v[76:77] neg_lo:[0,1] neg_hi:[0,1]
v_pk_add_f32 v[60:61], v[60:61], v[76:77]
v_pk_mul_f32 v[76:77], v[72:73], s[62:63] op_sel:[0,0] op_sel_hi:[0,1] neg_lo:[0,1] neg_hi:[0,0]
v_pk_fma_f32 v[76:77], v[72:73], s[62:63], v[76:77] op_sel:[1,1,0] op_sel_hi:[1,0,1] neg_lo:[0,1,0] neg_hi:[0,1,0]
v_pk_add_f32 v[72:73], v[62:63], v[78:79] neg_lo:[0,1] neg_hi:[0,1]
v_pk_add_f32 v[62:63], v[62:63], v[78:79]
v_pk_mul_f32 v[78:79], v[72:73], s[54:55] op_sel:[0,0] op_sel_hi:[0,1] neg_lo:[0,1] neg_hi:[0,0]
v_pk_fma_f32 v[78:79], v[72:73], s[54:55], v[78:79] op_sel:[1,1,0] op_sel_hi:[1,0,1] neg_lo:[0,1,0] neg_hi:[0,1,0]
v_pk_add_f32 v[72:73], v[16:17], v[24:25] neg_lo:[0,1] neg_hi:[0,1]
v_pk_add_f32 v[16:17], v[16:17], v[24:25]
v_pk_add_f32 v[24:25], v[18:19], v[26:27] neg_lo:[0,1] neg_hi:[0,1]
v_pk_add_f32 v[18:19], v[18:19], v[26:27]
v_pk_mul_f32 v[26:27], v[24:25], s[62:63] op_sel:[0,0] op_sel_hi:[0,1] neg_lo:[0,0] neg_hi:[0,0]
v_pk_fma_f32 v[26:27], v[24:25], s[62:63], v[26:27] op_sel:[1,1,0] op_sel_hi:[1,0,1] neg_lo:[0,1,0] neg_hi:[0,0,0]
v_pk_add_f32 v[24:25], v[20:21], v[28:29] op_sel:[1,1] op_sel_hi:[0,0] neg_lo:[1,0] neg_hi:[0,1]
v_pk_add_f32 v[20:21], v[20:21], v[28:29]
v_pk_add_f32 v[28:29], v[22:23], v[30:31] neg_lo:[0,1] neg_hi:[0,1]
v_pk_add_f32 v[22:23], v[22:23], v[30:31]
v_pk_mul_f32 v[30:31], v[28:29], s[62:63] op_sel:[0,0] op_sel_hi:[0,1] neg_lo:[0,1] neg_hi:[0,0]
v_pk_fma_f32 v[30:31], v[28:29], s[62:63], v[30:31] op_sel:[1,1,0] op_sel_hi:[1,0,1] neg_lo:[0,1,0] neg_hi:[0,1,0]
v_pk_add_f32 v[28:29], v[64:65], v[32:33] neg_lo:[0,1] neg_hi:[0,1]
v_pk_add_f32 v[64:65], v[64:65], v[32:33]
v_pk_add_f32 v[32:33], v[34:35], v[42:43] neg_lo:[0,1] neg_hi:[0,1]
v_pk_add_f32 v[34:35], v[34:35], v[42:43]
v_pk_mul_f32 v[42:43], v[32:33], s[62:63] op_sel:[0,0] op_sel_hi:[0,1] neg_lo:[0,0] neg_hi:[0,0]
v_pk_fma_f32 v[42:43], v[32:33], s[62:63], v[42:43] op_sel:[1,1,0] op_sel_hi:[1,0,1] neg_lo:[0,1,0] neg_hi:[0,0,0]
v_pk_add_f32 v[32:33], v[36:37], v[44:45] op_sel:[1,1] op_sel_hi:[0,0] neg_lo:[1,0] neg_hi:[0,1]
v_pk_add_f32 v[36:37], v[36:37], v[44:45]
v_pk_add_f32 v[44:45], v[38:39], v[46:47] neg_lo:[0,1] neg_hi:[0,1]
v_pk_add_f32 v[38:39], v[38:39], v[46:47]
v_pk_mul_f32 v[46:47], v[44:45], s[62:63] op_sel:[0,0] op_sel_hi:[0,1] neg_lo:[0,1] neg_hi:[0,0]
v_pk_fma_f32 v[46:47], v[44:45], s[62:63], v[46:47] op_sel:[1,1,0] op_sel_hi:[1,0,1] neg_lo:[0,1,0] neg_hi:[0,1,0]
v_pk_add_f32 v[44:45], v[14:15], v[56:57] neg_lo:[0,1] neg_hi:[0,1]
v_pk_add_f32 v[14:15], v[14:15], v[56:57]
v_pk_add_f32 v[56:57], v[50:51], v[58:59] neg_lo:[0,1] neg_hi:[0,1]
v_pk_add_f32 v[50:51], v[50:51], v[58:59]
v_pk_mul_f32 v[58:59], v[56:57], s[62:63] op_sel:[0,0] op_sel_hi:[0,1] neg_lo:[0,0] neg_hi:[0,0]
v_pk_fma_f32 v[58:59], v[56:57], s[62:63], v[58:59] op_sel:[1,1,0] op_sel_hi:[1,0,1] neg_lo:[0,1,0] neg_hi:[0,0,0]
v_pk_add_f32 v[56:57], v[52:53], v[60:61] op_sel:[1,1] op_sel_hi:[0,0] neg_lo:[1,0] neg_hi:[0,1]
v_pk_add_f32 v[52:53], v[52:53], v[60:61]
v_pk_add_f32 v[60:61], v[54:55], v[62:63] neg_lo:[0,1] neg_hi:[0,1]
v_pk_add_f32 v[54:55], v[54:55], v[62:63]
v_pk_mul_f32 v[62:63], v[60:61], s[62:63] op_sel:[0,0] op_sel_hi:[0,1] neg_lo:[0,1] neg_hi:[0,0]
v_pk_fma_f32 v[62:63], v[60:61], s[62:63], v[62:63] op_sel:[1,1,0] op_sel_hi:[1,0,1] neg_lo:[0,1,0] neg_hi:[0,1,0]
v_pk_add_f32 v[60:61], v[40:41], v[48:49] neg_lo:[0,1] neg_hi:[0,1]
v_pk_add_f32 v[40:41], v[40:41], v[48:49]
v_pk_add_f32 v[48:49], v[66:67], v[74:75] neg_lo:[0,1] neg_hi:[0,1]
v_pk_add_f32 v[66:67], v[66:67], v[74:75]
v_pk_mul_f32 v[74:75], v[48:49], s[62:63] op_sel:[0,0] op_sel_hi:[0,1] neg_lo:[0,0] neg_hi:[0,0]
v_pk_fma_f32 v[74:75], v[48:49], s[62:63], v[74:75] op_sel:[1,1,0] op_sel_hi:[1,0,1] neg_lo:[0,1,0] neg_hi:[0,0,0]
v_pk_add_f32 v[48:49], v[68:69], v[76:77] op_sel:[1,1] op_sel_hi:[0,0] neg_lo:[1,0] neg_hi:[0,1]
v_pk_add_f32 v[68:69], v[68:69], v[76:77]
v_pk_add_f32 v[76:77], v[70:71], v[78:79] neg_lo:[0,1] neg_hi:[0,1]
v_pk_add_f32 v[70:71], v[70:71], v[78:79]
v_pk_mul_f32 v[78:79], v[76:77], s[62:63] op_sel:[0,0] op_sel_hi:[0,1] neg_lo:[0,1] neg_hi:[0,0]
v_pk_fma_f32 v[78:79], v[76:77], s[62:63], v[78:79] op_sel:[1,1,0] op_sel_hi:[1,0,1] neg_lo:[0,1,0] neg_hi:[0,1,0]
v_pk_add_f32 v[76:77], v[16:17], v[20:21] neg_lo:[0,1] neg_hi:[0,1]
v_pk_add_f32 v[16:17], v[16:17], v[20:21]
v_pk_add_f32 v[20:21], v[18:19], v[22:23] op_sel:[1,1] op_sel_hi:[0,0] neg_lo:[1,0] neg_hi:[0,1]
v_pk_add_f32 v[18:19], v[18:19], v[22:23]
v_pk_add_f32 v[22:23], v[72:73], v[24:25] neg_lo:[0,1] neg_hi:[0,1]
v_pk_add_f32 v[72:73], v[72:73], v[24:25]
v_pk_add_f32 v[24:25], v[26:27], v[30:31] op_sel:[1,1] op_sel_hi:[0,0] neg_lo:[1,0] neg_hi:[0,1]
v_pk_add_f32 v[26:27], v[26:27], v[30:31]
v_pk_add_f32 v[30:31], v[64:65], v[36:37] neg_lo:[0,1] neg_hi:[0,1]
v_pk_add_f32 v[64:65], v[64:65], v[36:37]
v_pk_add_f32 v[36:37], v[34:35], v[38:39] op_sel:[1,1] op_sel_hi:[0,0] neg_lo:[1,0] neg_hi:[0,1]
v_pk_add_f32 v[34:35], v[34:35], v[38:39]
v_pk_add_f32 v[38:39], v[28:29], v[32:33] neg_lo:[0,1] neg_hi:[0,1]
v_pk_add_f32 v[28:29], v[28:29], v[32:33]
v_pk_add_f32 v[32:33], v[42:43], v[46:47] op_sel:[1,1] op_sel_hi:[0,0] neg_lo:[1,0] neg_hi:[0,1]
v_pk_add_f32 v[42:43], v[42:43], v[46:47]
v_pk_add_f32 v[46:47], v[14:15], v[52:53] neg_lo:[0,1] neg_hi:[0,1]
v_pk_add_f32 v[14:15], v[14:15], v[52:53]
v_pk_add_f32 v[52:53], v[50:51], v[54:55] op_sel:[1,1] op_sel_hi:[0,0] neg_lo:[1,0] neg_hi:[0,1]
v_pk_add_f32 v[50:51], v[50:51], v[54:55]
v_pk_add_f32 v[54:55], v[44:45], v[56:57] neg_lo:[0,1] neg_hi:[0,1]
v_pk_add_f32 v[44:45], v[44:45], v[56:57]
v_pk_add_f32 v[56:57], v[58:59], v[62:63] op_sel:[1,1] op_sel_hi:[0,0] neg_lo:[1,0] neg_hi:[0,1]
v_pk_add_f32 v[58:59], v[58:59], v[62:63]
v_pk_add_f32 v[62:63], v[40:41], v[68:69] neg_lo:[0,1] neg_hi:[0,1]
v_pk_add_f32 v[40:41], v[40:41], v[68:69]
v_pk_add_f32 v[68:69], v[66:67], v[70:71] op_sel:[1,1] op_sel_hi:[0,0] neg_lo:[1,0] neg_hi:[0,1]
v_pk_add_f32 v[66:67], v[66:67], v[70:71]
v_pk_add_f32 v[70:71], v[60:61], v[48:49] neg_lo:[0,1] neg_hi:[0,1]
v_pk_add_f32 v[60:61], v[60:61], v[48:49]
v_pk_add_f32 v[48:49], v[74:75], v[78:79] op_sel:[1,1] op_sel_hi:[0,0] neg_lo:[1,0] neg_hi:[0,1]
v_pk_add_f32 v[74:75], v[74:75], v[78:79]
v_pk_add_f32 v[78:79], v[16:17], v[18:19] neg_lo:[0,1] neg_hi:[0,1]
v_pk_add_f32 v[16:17], v[16:17], v[18:19]
v_pk_add_f32 v[18:19], v[76:77], v[20:21] neg_lo:[0,1] neg_hi:[0,1]
v_pk_add_f32 v[76:77], v[76:77], v[20:21]
v_pk_add_f32 v[20:21], v[72:73], v[26:27] neg_lo:[0,1] neg_hi:[0,1]
v_pk_add_f32 v[72:73], v[72:73], v[26:27]
v_pk_add_f32 v[26:27], v[22:23], v[24:25] neg_lo:[0,1] neg_hi:[0,1]
v_pk_add_f32 v[22:23], v[22:23], v[24:25]
v_pk_add_f32 v[24:25], v[64:65], v[34:35] neg_lo:[0,1] neg_hi:[0,1]
v_pk_add_f32 v[64:65], v[64:65], v[34:35]
v_pk_add_f32 v[34:35], v[30:31], v[36:37] neg_lo:[0,1] neg_hi:[0,1]
v_pk_add_f32 v[30:31], v[30:31], v[36:37]
v_pk_add_f32 v[36:37], v[28:29], v[42:43] neg_lo:[0,1] neg_hi:[0,1]
v_pk_add_f32 v[28:29], v[28:29], v[42:43]
v_pk_add_f32 v[42:43], v[38:39], v[32:33] neg_lo:[0,1] neg_hi:[0,1]
v_pk_add_f32 v[38:39], v[38:39], v[32:33]
v_pk_add_f32 v[32:33], v[14:15], v[50:51] neg_lo:[0,1] neg_hi:[0,1]
v_pk_add_f32 v[14:15], v[14:15], v[50:51]
v_pk_add_f32 v[50:51], v[46:47], v[52:53] neg_lo:[0,1] neg_hi:[0,1]
v_pk_add_f32 v[46:47], v[46:47], v[52:53]
v_pk_add_f32 v[52:53], v[44:45], v[58:59] neg_lo:[0,1] neg_hi:[0,1]
v_pk_add_f32 v[44:45], v[44:45], v[58:59]
v_pk_add_f32 v[58:59], v[54:55], v[56:57] neg_lo:[0,1] neg_hi:[0,1]
v_pk_add_f32 v[54:55], v[54:55], v[56:57]
v_pk_add_f32 v[56:57], v[40:41], v[66:67] neg_lo:[0,1] neg_hi:[0,1]
v_pk_add_f32 v[40:41], v[40:41], v[66:67]
v_pk_add_f32 v[66:67], v[62:63], v[68:69] neg_lo:[0,1] neg_hi:[0,1]
v_pk_add_f32 v[62:63], v[62:63], v[68:69]
v_pk_add_f32 v[68:69], v[60:61], v[74:75] neg_lo:[0,1] neg_hi:[0,1]
v_pk_add_f32 v[60:61], v[60:61], v[74:75]
v_pk_add_f32 v[74:75], v[70:71], v[48:49] neg_lo:[0,1] neg_hi:[0,1]
v_pk_add_f32 v[70:71], v[70:71], v[48:49]
v_pk_mul_f32 v[48:49], v[14:15], v[82:83] op_sel:[0,0] op_sel_hi:[0,1] neg_lo:[0,0] neg_hi:[0,0]
v_pk_fma_f32 v[14:15], v[14:15], v[82:83], v[48:49] op_sel:[1,1,0] op_sel_hi:[1,0,1] neg_lo:[0,1,0] neg_hi:[0,0,0]
v_pk_mul_f32 v[48:49], v[64:65], v[84:85] op_sel:[0,0] op_sel_hi:[0,1] neg_lo:[0,0] neg_hi:[0,0]
v_pk_fma_f32 v[64:65], v[64:65], v[84:85], v[48:49] op_sel:[1,1,0] op_sel_hi:[1,0,1] neg_lo:[0,1,0] neg_hi:[0,0,0]
v_pk_mul_f32 v[48:49], v[40:41], v[86:87] op_sel:[0,0] op_sel_hi:[0,1] neg_lo:[0,0] neg_hi:[0,0]
v_pk_fma_f32 v[40:41], v[40:41], v[86:87], v[48:49] op_sel:[1,1,0] op_sel_hi:[1,0,1] neg_lo:[0,1,0] neg_hi:[0,0,0]
v_pk_mul_f32 v[48:49], v[72:73], v[88:89] op_sel:[0,0] op_sel_hi:[0,1] neg_lo:[0,0] neg_hi:[0,0]
v_pk_fma_f32 v[72:73], v[72:73], v[88:89], v[48:49] op_sel:[1,1,0] op_sel_hi:[1,0,1] neg_lo:[0,1,0] neg_hi:[0,0,0]
v_pk_mul_f32 v[48:49], v[44:45], v[90:91] op_sel:[0,0] op_sel_hi:[0,1] neg_lo:[0,0] neg_hi:[0,0]
v_pk_fma_f32 v[44:45], v[44:45], v[90:91], v[48:49] op_sel:[1,1,0] op_sel_hi:[1,0,1] neg_lo:[0,1,0] neg_hi:[0,0,0]
v_pk_mul_f32 v[48:49], v[28:29], v[92:93] op_sel:[0,0] op_sel_hi:[0,1] neg_lo:[0,0] neg_hi:[0,0]
v_pk_fma_f32 v[28:29], v[28:29], v[92:93], v[48:49] op_sel:[1,1,0] op_sel_hi:[1,0,1] neg_lo:[0,1,0] neg_hi:[0,0,0]
v_pk_mul_f32 v[48:49], v[60:61], v[94:95] op_sel:[0,0] op_sel_hi:[0,1] neg_lo:[0,0] neg_hi:[0,0]
v_pk_fma_f32 v[60:61], v[60:61], v[94:95], v[48:49] op_sel:[1,1,0] op_sel_hi:[1,0,1] neg_lo:[0,1,0] neg_hi:[0,0,0]
v_pk_mul_f32 v[48:49], v[76:77], v[96:97] op_sel:[0,0] op_sel_hi:[0,1] neg_lo:[0,0] neg_hi:[0,0]
v_pk_fma_f32 v[76:77], v[76:77], v[96:97], v[48:49] op_sel:[1,1,0] op_sel_hi:[1,0,1] neg_lo:[0,1,0] neg_hi:[0,0,0]
v_pk_mul_f32 v[48:49], v[46:47], v[98:99] op_sel:[0,0] op_sel_hi:[0,1] neg_lo:[0,0] neg_hi:[0,0]
v_pk_fma_f32 v[46:47], v[46:47], v[98:99], v[48:49] op_sel:[1,1,0] op_sel_hi:[1,0,1] neg_lo:[0,1,0] neg_hi:[0,0,0]
v_pk_mul_f32 v[48:49], v[30:31], v[100:101] op_sel:[0,0] op_sel_hi:[0,1] neg_lo:[0,0] neg_hi:[0,0]
v_pk_fma_f32 v[30:31], v[30:31], v[100:101], v[48:49] op_sel:[1,1,0] op_sel_hi:[1,0,1] neg_lo:[0,1,0] neg_hi:[0,0,0]
v_pk_mul_f32 v[48:49], v[62:63], v[102:103] op_sel:[0,0] op_sel_hi:[0,1] neg_lo:[0,0] neg_hi:[0,0]
v_pk_fma_f32 v[62:63], v[62:63], v[102:103], v[48:49] op_sel:[1,1,0] op_sel_hi:[1,0,1] neg_lo:[0,1,0] neg_hi:[0,0,0]
v_pk_mul_f32 v[48:49], v[22:23], v[104:105] op_sel:[0,0] op_sel_hi:[0,1] neg_lo:[0,0] neg_hi:[0,0]
v_pk_fma_f32 v[22:23], v[22:23], v[104:105], v[48:49] op_sel:[1,1,0] op_sel_hi:[1,0,1] neg_lo:[0,1,0] neg_hi:[0,0,0]
v_pk_mul_f32 v[48:49], v[54:55], v[106:107] op_sel:[0,0] op_sel_hi:[0,1] neg_lo:[0,0] neg_hi:[0,0]
v_pk_fma_f32 v[54:55], v[54:55], v[106:107], v[48:49] op_sel:[1,1,0] op_sel_hi:[1,0,1] neg_lo:[0,1,0] neg_hi:[0,0,0]
v_pk_mul_f32 v[48:49], v[38:39], v[108:109] op_sel:[0,0] op_sel_hi:[0,1] neg_lo:[0,0] neg_hi:[0,0]
v_pk_fma_f32 v[38:39], v[38:39], v[108:109], v[48:49] op_sel:[1,1,0] op_sel_hi:[1,0,1] neg_lo:[0,1,0] neg_hi:[0,0,0]
v_pk_mul_f32 v[48:49], v[70:71], v[110:111] op_sel:[0,0] op_sel_hi:[0,1] neg_lo:[0,0] neg_hi:[0,0]
v_pk_fma_f32 v[70:71], v[70:71], v[110:111], v[48:49] op_sel:[1,1,0] op_sel_hi:[1,0,1] neg_lo:[0,1,0] neg_hi:[0,0,0]
v_pk_mul_f32 v[48:49], v[78:79], v[112:113] op_sel:[0,0] op_sel_hi:[0,1] neg_lo:[0,0] neg_hi:[0,0]
v_pk_fma_f32 v[78:79], v[78:79], v[112:113], v[48:49] op_sel:[1,1,0] op_sel_hi:[1,0,1] neg_lo:[0,1,0] neg_hi:[0,0,0]
v_pk_mul_f32 v[48:49], v[32:33], v[114:115] op_sel:[0,0] op_sel_hi:[0,1] neg_lo:[0,0] neg_hi:[0,0]
v_pk_fma_f32 v[32:33], v[32:33], v[114:115], v[48:49] op_sel:[1,1,0] op_sel_hi:[1,0,1] neg_lo:[0,1,0] neg_hi:[0,0,0]
v_pk_mul_f32 v[48:49], v[24:25], v[116:117] op_sel:[0,0] op_sel_hi:[0,1] neg_lo:[0,0] neg_hi:[0,0]
v_pk_fma_f32 v[24:25], v[24:25], v[116:117], v[48:49] op_sel:[1,1,0] op_sel_hi:[1,0,1] neg_lo:[0,1,0] neg_hi:[0,0,0]
v_pk_mul_f32 v[48:49], v[56:57], v[118:119] op_sel:[0,0] op_sel_hi:[0,1] neg_lo:[0,0] neg_hi:[0,0]
v_pk_fma_f32 v[56:57], v[56:57], v[118:119], v[48:49] op_sel:[1,1,0] op_sel_hi:[1,0,1] neg_lo:[0,1,0] neg_hi:[0,0,0]
v_pk_mul_f32 v[48:49], v[20:21], v[120:121] op_sel:[0,0] op_sel_hi:[0,1] neg_lo:[0,0] neg_hi:[0,0]
v_pk_fma_f32 v[20:21], v[20:21], v[120:121], v[48:49] op_sel:[1,1,0] op_sel_hi:[1,0,1] neg_lo:[0,1,0] neg_hi:[0,0,0]
v_pk_mul_f32 v[48:49], v[52:53], v[122:123] op_sel:[0,0] op_sel_hi:[0,1] neg_lo:[0,0] neg_hi:[0,0]
v_pk_fma_f32 v[52:53], v[52:53], v[122:123], v[48:49] op_sel:[1,1,0] op_sel_hi:[1,0,1] neg_lo:[0,1,0] neg_hi:[0,0,0]
v_pk_mul_f32 v[48:49], v[36:37], v[124:125] op_sel:[0,0] op_sel_hi:[0,1] neg_lo:[0,0] neg_hi:[0,0]
v_pk_fma_f32 v[36:37], v[36:37], v[124:125], v[48:49] op_sel:[1,1,0] op_sel_hi:[1,0,1] neg_lo:[0,1,0] neg_hi:[0,0,0]
v_pk_mul_f32 v[48:49], v[68:69], v[126:127] op_sel:[0,0] op_sel_hi:[0,1] neg_lo:[0,0] neg_hi:[0,0]
v_pk_fma_f32 v[68:69], v[68:69], v[126:127], v[48:49] op_sel:[1,1,0] op_sel_hi:[1,0,1] neg_lo:[0,1,0] neg_hi:[0,0,0]
v_pk_mul_f32 v[48:49], v[18:19], v[128:129] op_sel:[0,0] op_sel_hi:[0,1] neg_lo:[0,0] neg_hi:[0,0]
v_pk_fma_f32 v[18:19], v[18:19], v[128:129], v[48:49] op_sel:[1,1,0] op_sel_hi:[1,0,1] neg_lo:[0,1,0] neg_hi:[0,0,0]
v_pk_mul_f32 v[48:49], v[50:51], v[130:131] op_sel:[0,0] op_sel_hi:[0,1] neg_lo:[0,0] neg_hi:[0,0]
v_pk_fma_f32 v[50:51], v[50:51], v[130:131], v[48:49] op_sel:[1,1,0] op_sel_hi:[1,0,1] neg_lo:[0,1,0] neg_hi:[0,0,0]
v_pk_mul_f32 v[48:49], v[34:35], v[132:133] op_sel:[0,0] op_sel_hi:[0,1] neg_lo:[0,0] neg_hi:[0,0]
v_pk_fma_f32 v[34:35], v[34:35], v[132:133], v[48:49] op_sel:[1,1,0] op_sel_hi:[1,0,1] neg_lo:[0,1,0] neg_hi:[0,0,0]
v_pk_mul_f32 v[48:49], v[66:67], v[134:135] op_sel:[0,0] op_sel_hi:[0,1] neg_lo:[0,0] neg_hi:[0,0]
v_pk_fma_f32 v[66:67], v[66:67], v[134:135], v[48:49] op_sel:[1,1,0] op_sel_hi:[1,0,1] neg_lo:[0,1,0] neg_hi:[0,0,0]
v_pk_mul_f32 v[48:49], v[26:27], v[136:137] op_sel:[0,0] op_sel_hi:[0,1] neg_lo:[0,0] neg_hi:[0,0]
v_pk_fma_f32 v[26:27], v[26:27], v[136:137], v[48:49] op_sel:[1,1,0] op_sel_hi:[1,0,1] neg_lo:[0,1,0] neg_hi:[0,0,0]
v_pk_mul_f32 v[48:49], v[58:59], v[138:139] op_sel:[0,0] op_sel_hi:[0,1] neg_lo:[0,0] neg_hi:[0,0]
v_pk_fma_f32 v[58:59], v[58:59], v[138:139], v[48:49] op_sel:[1,1,0] op_sel_hi:[1,0,1] neg_lo:[0,1,0] neg_hi:[0,0,0]
v_pk_mul_f32 v[48:49], v[42:43], v[140:141] op_sel:[0,0] op_sel_hi:[0,1] neg_lo:[0,0] neg_hi:[0,0]
v_pk_fma_f32 v[42:43], v[42:43], v[140:141], v[48:49] op_sel:[1,1,0] op_sel_hi:[1,0,1] neg_lo:[0,1,0] neg_hi:[0,0,0]
v_pk_mul_f32 v[48:49], v[74:75], v[142:143] op_sel:[0,0] op_sel_hi:[0,1] neg_lo:[0,0] neg_hi:[0,0]
v_pk_fma_f32 v[74:75], v[74:75], v[142:143], v[48:49] op_sel:[1,1,0] op_sel_hi:[1,0,1] neg_lo:[0,1,0] neg_hi:[0,0,0]
ds_write_b64 v4, v[16:17] offset:0
ds_write_b64 v4, v[14:15] offset:264
ds_write_b64 v4, v[64:65] offset:528
ds_write_b64 v4, v[40:41] offset:792
ds_write_b64 v4, v[72:73] offset:1056
ds_write_b64 v4, v[44:45] offset:1320
ds_write_b64 v4, v[28:29] offset:1584
ds_write_b64 v4, v[60:61] offset:1848
ds_write_b64 v4, v[76:77] offset:2112
ds_write_b64 v4, v[46:47] offset:2376
ds_write_b64 v4, v[30:31] offset:2640
ds_write_b64 v4, v[62:63] offset:2904
ds_write_b64 v4, v[22:23] offset:3168
ds_write_b64 v4, v[54:55] offset:3432
ds_write_b64 v4, v[38:39] offset:3696
ds_write_b64 v4, v[70:71] offset:3960
ds_write_b64 v4, v[78:79] offset:4224
ds_write_b64 v4, v[32:33] offset:4488
ds_write_b64 v4, v[24:25] offset:4752
ds_write_b64 v4, v[56:57] offset:5016
ds_write_b64 v4, v[20:21] offset:5280
ds_write_b64 v4, v[52:53] offset:5544
ds_write_b64 v4, v[36:37] offset:5808
ds_write_b64 v4, v[68:69] offset:6072
ds_write_b64 v4, v[18:19] offset:6336
ds_write_b64 v4, v[50:51] offset:6600
ds_write_b64 v4, v[34:35] offset:6864
ds_write_b64 v4, v[66:67] offset:7128
ds_write_b64 v4, v[26:27] offset:7392
ds_write_b64 v4, v[58:59] offset:7656
ds_write_b64 v4, v[42:43] offset:7920
ds_write_b64 v4, v[74:75] offset:8184
s_waitcnt lgkmcnt(0)
ds_read_b64 v[16:17], v5 offset:0
ds_read_b64 v[48:49], v5 offset:128
ds_read_b64 v[18:19], v5 offset:8
ds_read_b64 v[50:51], v5 offset:136
ds_read_b64 v[20:21], v5 offset:16
ds_read_b64 v[52:53], v5 offset:144
ds_read_b64 v[22:23], v5 offset:24
ds_read_b64 v[54:55], v5 offset:152
ds_read_b64 v[24:25], v5 offset:32
ds_read_b64 v[56:57], v5 offset:160
ds_read_b64 v[26:27], v5 offset:40
ds_read_b64 v[58:59], v5 offset:168
ds_read_b64 v[28:29], v5 offset:48
ds_read_b64 v[60:61], v5 offset:176
ds_read_b64 v[30:31], v5 offset:56
ds_read_b64 v[62:63], v5 offset:184
ds_read_b64 v[32:33], v5 offset:64
ds_read_b64 v[64:65], v5 offset:192
ds_read_b64 v[34:35], v5 offset:72
ds_read_b64 v[66:67], v5 offset:200
ds_read_b64 v[36:37], v5 offset:80
ds_read_b64 v[68:69], v5 offset:208
ds_read_b64 v[38:39], v5 offset:88
ds_read_b64 v[70:71], v5 offset:216
ds_read_b64 v[40:41], v5 offset:96
ds_read_b64 v[72:73], v5 offset:224
ds_read_b64 v[42:43], v5 offset:104
ds_read_b64 v[74:75], v5 offset:232
ds_read_b64 v[44:45], v5 offset:112
ds_read_b64 v[76:77], v5 offset:240
ds_read_b64 v[46:47], v5 offset:120
ds_read_b64 v[78:79], v5 offset:248
s_waitcnt lgkmcnt(0)
v_pk_add_f32 v[14:15], v[16:17], v[48:49] neg_lo:[0,1] neg_hi:[0,1]
v_pk_add_f32 v[16:17], v[16:17], v[48:49]
v_pk_add_f32 v[48:49], v[18:19], v[50:51] neg_lo:[0,1] neg_hi:[0,1]
v_pk_add_f32 v[18:19], v[18:19], v[50:51]
v_pk_mul_f32 v[50:51], v[48:49], s[50:51] op_sel:[0,0] op_sel_hi:[0,1] neg_lo:[0,0] neg_hi:[0,0]
v_pk_fma_f32 v[50:51], v[48:49], s[50:51], v[50:51] op_sel:[1,1,0] op_sel_hi:[1,0,1] neg_lo:[0,1,0] neg_hi:[0,0,0]
v_pk_add_f32 v[48:49], v[20:21], v[52:53] neg_lo:[0,1] neg_hi:[0,1]
v_pk_add_f32 v[20:21], v[20:21], v[52:53]
v_pk_mul_f32 v[52:53], v[48:49], s[54:55] op_sel:[0,0] op_sel_hi:[0,1] neg_lo:[0,0] neg_hi:[0,0]
v_pk_fma_f32 v[52:53], v[48:49], s[54:55], v[52:53] op_sel:[1,1,0] op_sel_hi:[1,0,1] neg_lo:[0,1,0] neg_hi:[0,0,0]
v_pk_add_f32 v[48:49], v[22:23], v[54:55] neg_lo:[0,1] neg_hi:[0,1]
v_pk_add_f32 v[22:23], v[22:23], v[54:55]
v_pk_mul_f32 v[54:55], v[48:49], s[58:59] op_sel:[0,0] op_sel_hi:[0,1] neg_lo:[0,0] neg_hi:[0,0]
v_pk_fma_f32 v[54:55], v[48:49], s[58:59], v[54:55] op_sel:[1,1,0] op_sel_hi:[1,0,1] neg_lo:[0,1,0] neg_hi:[0,0,0]
v_pk_add_f32 v[48:49], v[24:25], v[56:57] neg_lo:[0,1] neg_hi:[0,1]
v_pk_add_f32 v[24:25], v[24:25], v[56:57]
v_pk_mul_f32 v[56:57], v[48:49], s[62:63] op_sel:[0,0] op_sel_hi:[0,1] neg_lo:[0,0] neg_hi:[0,0]
v_pk_fma_f32 v[56:57], v[48:49], s[62:63], v[56:57] op_sel:[1,1,0] op_sel_hi:[1,0,1] neg_lo:[0,1,0] neg_hi:[0,0,0]
v_pk_add_f32 v[48:49], v[26:27], v[58:59] neg_lo:[0,1] neg_hi:[0,1]
v_pk_add_f32 v[26:27], v[26:27], v[58:59]
v_pk_mul_f32 v[58:59], v[48:49], s[58:59] op_sel:[0,1] op_sel_hi:[0,0] neg_lo:[0,0] neg_hi:[0,0]
v_pk_fma_f32 v[58:59], v[48:49], s[58:59], v[58:59] op_sel:[1,0,0] op_sel_hi:[1,1,1] neg_lo:[0,1,0] neg_hi:[0,0,0]
v_pk_add_f32 v[48:49], v[28:29], v[60:61] neg_lo:[0,1] neg_hi:[0,1]
v_pk_add_f32 v[28:29], v[28:29], v[60:61]
v_pk_mul_f32 v[60:61], v[48:49], s[54:55] op_sel:[0,1] op_sel_hi:[0,0] neg_lo:[0,0] neg_hi:[0,0]
v_pk_fma_f32 v[60:61], v[48:49], s[54:55], v[60:61] op_sel:[1,0,0] op_sel_hi:[1,1,1] neg_lo:[0,1,0] neg_hi:[0,0,0]
v_pk_add_f32 v[48:49], v[30:31], v[62:63] neg_lo:[0,1] neg_hi:[0,1]
v_pk_add_f32 v[30:31], v[30:31], v[62:63]
v_pk_mul_f32 v[62:63], v[48:49], s[50:51] op_sel:[0,1] op_sel_hi:[0,0] neg_lo:[0,0] neg_hi:[0,0]
v_pk_fma_f32 v[62:63], v[48:49], s[50:51], v[62:63] op_sel:[1,0,0] op_sel_hi:[1,1,1] neg_lo:[0,1,0] neg_hi:[0,0,0]
v_pk_add_f32 v[48:49], v[32:33], v[64:65] op_sel:[1,1] op_sel_hi:[0,0] neg_lo:[1,0] neg_hi:[0,1]
v_pk_add_f32 v[32:33], v[32:33], v[64:65]
v_pk_add_f32 v[64:65], v[34:35], v[66:67] neg_lo:[0,1] neg_hi:[0,1]
v_pk_add_f32 v[34:35], v[34:35], v[66:67]
v_pk_mul_f32 v[66:67], v[64:65], s[50:51] op_sel:[0,1] op_sel_hi:[0,0] neg_lo:[0,1] neg_hi:[0,0]
v_pk_fma_f32 v[66:67], v[64:65], s[50:51], v[66:67] op_sel:[1,0,0] op_sel_hi:[1,1,1] neg_lo:[0,1,0] neg_hi:[0,1,0]
v_pk_add_f32 v[64:65], v[36:37], v[68:69] neg_lo:[0,1] neg_hi:[0,1]
v_pk_add_f32 v[36:37], v[36:37], v[68:69]
v_pk_mul_f32 v[68:69], v[64:65], s[54:55] op_sel:[0,1] op_sel_hi:[0,0] neg_lo:[0,1] neg_hi:[0,0]
v_pk_fma_f32 v[68:69], v[64:65], s[54:55], v[68:69] op_sel:[1,0,0] op_sel_hi:[1,1,1] neg_lo:[0,1,0] neg_hi:[0,1,0]
v_pk_add_f32 v[64:65], v[38:39], v[70:71] neg_lo:[0,1] neg_hi:[0,1]
v_pk_add_f32 v[38:39], v[38:39], v[70:71]
v_pk_mul_f32 v[70:71], v[64:65], s[58:59] op_sel:[0,1] op_sel_hi:[0,0] neg_lo:[0,1] neg_hi:[0,0]
v_pk_fma_f32 v[70:71], v[64:65], s[58:59], v[70:71] op_sel:[1,0,0] op_sel_hi:[1,1,1] neg_lo:[0,1,0] neg_hi:[0,1,0]
v_pk_add_f32 v[64:65], v[40:41], v[72:73] neg_lo:[0,1] neg_hi:[0,1]
v_pk_add_f32 v[40:41], v[40:41], v[72:73]
v_pk_mul_f32 v[72:73], v[64:65], s[62:63] op_sel:[0,0] op_sel_hi:[0,1] neg_lo:[0,1] neg_hi:[0,0]
v_pk_fma_f32 v[72:73], v[64:65], s[62:63], v[72:73] op_sel:[1,1,0] op_sel_hi:[1,0,1] neg_lo:[0,1,0] neg_hi:[0,1,0]
v_pk_add_f32 v[64:65], v[42:43], v[74:75] neg_lo:[0,1] neg_hi:[0,1]
v_pk_add_f32 v[42:43], v[42:43], v[74:75]
v_pk_mul_f32 v[74:75], v[64:65], s[58:59] op_sel:[0,0] op_sel_hi:[0,1] neg_lo:[0,1] neg_hi:[0,0]
v_pk_fma_f32 v[74:75], v[64:65], s[58:59], v[74:75] op_sel:[1,1,0] op_sel_hi:[1,0,1] neg_lo:[0,1,0] neg_hi:[0,1,0]
v_pk_add_f32 v[64:65], v[44:45], v[76:77] neg_lo:[0,1] neg_hi:[0,1]
v_pk_add_f32 v[44:45], v[44:45], v[76:77]
v_pk_mul_f32 v[76:77], v[64:65], s[54:55] op_sel:[0,0] op_sel_hi:[0,1] neg_lo:[0,1] neg_hi:[0,0]
v_pk_fma_f32 v[76:77], v[64:65], s[54:55], v[76:77] op_sel:[1,1,0] op_sel_hi:[1,0,1] neg_lo:[0,1,0] neg_hi:[0,1,0]
v_pk_add_f32 v[64:65], v[46:47], v[78:79] neg_lo:[0,1] neg_hi:[0,1]
v_pk_add_f32 v[46:47], v[46:47], v[78:79]
v_pk_mul_f32 v[78:79], v[64:65], s[50:51] op_sel:[0,0] op_sel_hi:[0,1] neg_lo:[0,1] neg_hi:[0,0]
v_pk_fma_f32 v[78:79], v[64:65], s[50:51], v[78:79] op_sel:[1,1,0] op_sel_hi:[1,0,1] neg_lo:[0,1,0] neg_hi:[0,1,0]
v_pk_add_f32 v[64:65], v[16:17], v[32:33] neg_lo:[0,1] neg_hi:[0,1]
v_pk_add_f32 v[16:17], v[16:17], v[32:33]
v_pk_add_f32 v[32:33], v[18:19], v[34:35] neg_lo:[0,1] neg_hi:[0,1]
v_pk_add_f32 v[18:19], v[18:19], v[34:35]
v_pk_mul_f32 v[34:35], v[32:33], s[54:55] op_sel:[0,0] op_sel_hi:[0,1] neg_lo:[0,0] neg_hi:[0,0]
v_pk_fma_f32 v[34:35], v[32:33], s[54:55], v[34:35] op_sel:[1,1,0] op_sel_hi:[1,0,1] neg_lo:[0,1,0] neg_hi:[0,0,0]
v_pk_add_f32 v[32:33], v[20:21], v[36:37] neg_lo:[0,1] neg_hi:[0,1]
v_pk_add_f32 v[20:21], v[20:21], v[36:37]
v_pk_mul_f32 v[36:37], v[32:33], s[62:63] op_sel:[0,0] op_sel_hi:[0,1] neg_lo:[0,0] neg_hi:[0,0]
v_pk_fma_f32 v[36:37], v[32:33], s[62:63], v[36:37] op_sel:[1,1,0] op_sel_hi:[1,0,1] neg_lo:[0,1,0] neg_hi:[0,0,0]
v_pk_add_f32 v[32:33], v[22:23], v[38:39] neg_lo:[0,1] neg_hi:[0,1]
v_pk_add_f32 v[22:23], v[22:23], v[38:39]
v_pk_mul_f32 v[38:39], v[32:33], s[54:55] op_sel:[0,1] op_sel_hi:[0,0] neg_lo:[0,0] neg_hi:[0,0]
v_pk_fma_f32 v[38:39], v[32:33], s[54:55], v[38:39] op_sel:[1,0,0] op_sel_hi:[1,1,1] neg_lo:[0,1,0] neg_hi:[0,0,0]
v_pk_add_f32 v[32:33], v[24:25], v[40:41] op_sel:[1,1] op_sel_hi:[0,0] neg_lo:[1,0] neg_hi:[0,1]
v_pk_add_f32 v[24:25], v[24:25], v[40:41]
v_pk_add_f32 v[40:41], v[26:27], v[42:43] neg_lo:[0,1] neg_hi:[0,1]
v_pk_add_f32 v[26:27], v[26:27], v[42:43]
v_pk_mul_f32 v[42:43], v[40:41], s[54:55] op_sel:[0,1] op_sel_hi:[0,0] neg_lo:[0,1] neg_hi:[0,0]
v_pk_fma_f32 v[42:43], v[40:41], s[54:55], v[42:43] op_sel:[1,0,0] op_sel_hi:[1,1,1] neg_lo:[0,1,0] neg_hi:[0,1,0]
v_pk_add_f32 v[40:41], v[28:29], v[44:45] neg_lo:[0,1] neg_hi:[0,1]
v_pk_add_f32 v[28:29], v[28:29], v[44:45]
v_pk_mul_f32 v[44:45], v[40:41], s[62:63] op_sel:[0,0] op_sel_hi:[0,1] neg_lo:[0,1] neg_hi:[0,0]
v_pk_fma_f32 v[44:45], v[40:41], s[62:63], v[44:45] op_sel:[1,1,0] op_sel_hi:[1,0,1] neg_lo:[0,1,0] neg_hi:[0,1,0]
v_pk_add_f32 v[40:41], v[30:31], v[46:47] neg_lo:[0,1] neg_hi:[0,1]
v_pk_add_f32 v[30:31], v[30:31], v[46:47]
v_pk_mul_f32 v[46:47], v[40:41], s[54:55] op_sel:[0,0] op_sel_hi:[0,1] neg_lo:[0,1] neg_hi:[0,0]
v_pk_fma_f32 v[46:47], v[40:41], s[54:55], v[46:47] op_sel:[1,1,0] op_sel_hi:[1,0,1] neg_lo:[0,1,0] neg_hi:[0,1,0]
v_pk_add_f32 v[40:41], v[14:15], v[48:49] neg_lo:[0,1] neg_hi:[0,1]
v_pk_add_f32 v[14:15], v[14:15], v[48:49]
v_pk_add_f32 v[48:49], v[50:51], v[66:67] neg_lo:[0,1] neg_hi:[0,1]
v_pk_add_f32 v[50:51], v[50:51], v[66:67]
v_pk_mul_f32 v[66:67], v[48:49], s[54:55] op_sel:[0,0] op_sel_hi:[0,1] neg_lo:[0,0] neg_hi:[0,0]
v_pk_fma_f32 v[66:67], v[48:49], s[54:55], v[66:67] op_sel:[1,1,0] op_sel_hi:[1,0,1] neg_lo:[0,1,0] neg_hi:[0,0,0]
v_pk_add_f32 v[48:49], v[52:53], v[68:69] neg_lo:[0,1] neg_hi:[0,1]
v_pk_add_f32 v[52:53], v[52:53], v[68:69]
v_pk_mul_f32 v[68:69], v[48:49], s[62:63] op_sel:[0,0] op_sel_hi:[0,1] neg_lo:[0,0] neg_hi:[0,0]
v_pk_fma_f32 v[68:69], v[48:49], s[62:63], v[68:69] op_sel:[1,1,0] op_sel_hi:[1,0,1] neg_lo:[0,1,0] neg_hi:[0,0,0]
v_pk_add_f32 v[48:49], v[54:55], v[70:71] neg_lo:[0,1] neg_hi:[0,1]
v_pk_add_f32 v[54:55], v[54:55], v[70:71]
v_pk_mul_f32 v[70:71], v[48:49], s[54:55] op_sel:[0,1] op_sel_hi:[0,0] neg_lo:[0,0] neg_hi:[0,0]
v_pk_fma_f32 v[70:71], v[48:49], s[54:55], v[70:71] op_sel:[1,0,0] op_sel_hi:[1,1,1] neg_lo:[0,1,0] neg_hi:[0,0,0]
v_pk_add_f32 v[48:49], v[56:57], v[72:73] op_sel:[1,1] op_sel_hi:[0,0] neg_lo:[1,0] neg_hi:[0,1]
v_pk_add_f32 v[56:57], v[56:57], v[72:73]
v_pk_add_f32 v[72:73], v[58:59], v[74:75] neg_lo:[0,1] neg_hi:[0,1]
v_pk_add_f32 v[58:59], v[58:59], v[74:75]
v_pk_mul_f32 v[74:75], v[72:73], s[54:55] op_sel:[0,1] op_sel_hi:[0,0] neg_lo:[0,1] neg_hi:[0,0]
v_pk_fma_f32 v[74:75], v[72:73], s[54:55], v[74:75] op_sel:[1,0,0] op_sel_hi:[1,1,1] neg_lo:[0,1,0] neg_hi:[0,1,0]
v_pk_add_f32 v[72:73], v[60:61], v[76:77] neg_lo:[0,1] neg_hi:[0,1]
v_pk_add_f32 v[60:61], v[60:61], v[76:77]
v_pk_mul_f32 v[76:77], v[72:73], s[62:63] op_sel:[0,0] op_sel_hi:[0,1] neg_lo:[0,1] neg_hi:[0,0]
v_pk_fma_f32 v[76:77], v[72:73], s[62:63], v[76:77] op_sel:[1,1,0] op_sel_hi:[1,0,1] neg_lo:[0,1,0] neg_hi:[0,1,0]
v_pk_add_f32 v[72:73], v[62:63], v[78:79] neg_lo:[0,1] neg_hi:[0,1]
v_pk_add_f32 v[62:63], v[62:63], v[78:79]
v_pk_mul_f32 v[78:79], v[72:73], s[54:55] op_sel:[0,0] op_sel_hi:[0,1] neg_lo:[0,1] neg_hi:[0,0]
v_pk_fma_f32 v[78:79], v[72:73], s[54:55], v[78:79] op_sel:[1,1,0] op_sel_hi:[1,0,1] neg_lo:[0,1,0] neg_hi:[0,1,0]
v_pk_add_f32 v[72:73], v[16:17], v[24:25] neg_lo:[0,1] neg_hi:[0,1]
v_pk_add_f32 v[16:17], v[16:17], v[24:25]
v_pk_add_f32 v[24:25], v[18:19], v[26:27] neg_lo:[0,1] neg_hi:[0,1]
v_pk_add_f32 v[18:19], v[18:19], v[26:27]
v_pk_mul_f32 v[26:27], v[24:25], s[62:63] op_sel:[0,0] op_sel_hi:[0,1] neg_lo:[0,0] neg_hi:[0,0]
v_pk_fma_f32 v[26:27], v[24:25], s[62:63], v[26:27] op_sel:[1,1,0] op_sel_hi:[1,0,1] neg_lo:[0,1,0] neg_hi:[0,0,0]
v_pk_add_f32 v[24:25], v[20:21], v[28:29] op_sel:[1,1] op_sel_hi:[0,0] neg_lo:[1,0] neg_hi:[0,1]
v_pk_add_f32 v[20:21], v[20:21], v[28:29]
v_pk_add_f32 v[28:29], v[22:23], v[30:31] neg_lo:[0,1] neg_hi:[0,1]
v_pk_add_f32 v[22:23], v[22:23], v[30:31]
v_pk_mul_f32 v[30:31], v[28:29], s[62:63] op_sel:[0,0] op_sel_hi:[0,1] neg_lo:[0,1] neg_hi:[0,0]
v_pk_fma_f32 v[30:31], v[28:29], s[62:63], v[30:31] op_sel:[1,1,0] op_sel_hi:[1,0,1] neg_lo:[0,1,0] neg_hi:[0,1,0]
v_pk_add_f32 v[28:29], v[64:65], v[32:33] neg_lo:[0,1] neg_hi:[0,1]
v_pk_add_f32 v[64:65], v[64:65], v[32:33]
v_pk_add_f32 v[32:33], v[34:35], v[42:43] neg_lo:[0,1] neg_hi:[0,1]
v_pk_add_f32 v[34:35], v[34:35], v[42:43]
v_pk_mul_f32 v[42:43], v[32:33], s[62:63] op_sel:[0,0] op_sel_hi:[0,1] neg_lo:[0,0] neg_hi:[0,0]
v_pk_fma_f32 v[42:43], v[32:33], s[62:63], v[42:43] op_sel:[1,1,0] op_sel_hi:[1,0,1] neg_lo:[0,1,0] neg_hi:[0,0,0]
v_pk_add_f32 v[32:33], v[36:37], v[44:45] op_sel:[1,1] op_sel_hi:[0,0] neg_lo:[1,0] neg_hi:[0,1]
v_pk_add_f32 v[36:37], v[36:37], v[44:45]
v_pk_add_f32 v[44:45], v[38:39], v[46:47] neg_lo:[0,1] neg_hi:[0,1]
v_pk_add_f32 v[38:39], v[38:39], v[46:47]
v_pk_mul_f32 v[46:47], v[44:45], s[62:63] op_sel:[0,0] op_sel_hi:[0,1] neg_lo:[0,1] neg_hi:[0,0]
v_pk_fma_f32 v[46:47], v[44:45], s[62:63], v[46:47] op_sel:[1,1,0] op_sel_hi:[1,0,1] neg_lo:[0,1,0] neg_hi:[0,1,0]
v_pk_add_f32 v[44:45], v[14:15], v[56:57] neg_lo:[0,1] neg_hi:[0,1]
v_pk_add_f32 v[14:15], v[14:15], v[56:57]
v_pk_add_f32 v[56:57], v[50:51], v[58:59] neg_lo:[0,1] neg_hi:[0,1]
v_pk_add_f32 v[50:51], v[50:51], v[58:59]
v_pk_mul_f32 v[58:59], v[56:57], s[62:63] op_sel:[0,0] op_sel_hi:[0,1] neg_lo:[0,0] neg_hi:[0,0]
v_pk_fma_f32 v[58:59], v[56:57], s[62:63], v[58:59] op_sel:[1,1,0] op_sel_hi:[1,0,1] neg_lo:[0,1,0] neg_hi:[0,0,0]
v_pk_add_f32 v[56:57], v[52:53], v[60:61] op_sel:[1,1] op_sel_hi:[0,0] neg_lo:[1,0] neg_hi:[0,1]
v_pk_add_f32 v[52:53], v[52:53], v[60:61]
v_pk_add_f32 v[60:61], v[54:55], v[62:63] neg_lo:[0,1] neg_hi:[0,1]
v_pk_add_f32 v[54:55], v[54:55], v[62:63]
v_pk_mul_f32 v[62:63], v[60:61], s[62:63] op_sel:[0,0] op_sel_hi:[0,1] neg_lo:[0,1] neg_hi:[0,0]
v_pk_fma_f32 v[62:63], v[60:61], s[62:63], v[62:63] op_sel:[1,1,0] op_sel_hi:[1,0,1] neg_lo:[0,1,0] neg_hi:[0,1,0]
v_pk_add_f32 v[60:61], v[40:41], v[48:49] neg_lo:[0,1] neg_hi:[0,1]
v_pk_add_f32 v[40:41], v[40:41], v[48:49]
v_pk_add_f32 v[48:49], v[66:67], v[74:75] neg_lo:[0,1] neg_hi:[0,1]
v_pk_add_f32 v[66:67], v[66:67], v[74:75]
v_pk_mul_f32 v[74:75], v[48:49], s[62:63] op_sel:[0,0] op_sel_hi:[0,1] neg_lo:[0,0] neg_hi:[0,0]
v_pk_fma_f32 v[74:75], v[48:49], s[62:63], v[74:75] op_sel:[1,1,0] op_sel_hi:[1,0,1] neg_lo:[0,1,0] neg_hi:[0,0,0]
v_pk_add_f32 v[48:49], v[68:69], v[76:77] op_sel:[1,1] op_sel_hi:[0,0] neg_lo:[1,0] neg_hi:[0,1]
v_pk_add_f32 v[68:69], v[68:69], v[76:77]
v_pk_add_f32 v[76:77], v[70:71], v[78:79] neg_lo:[0,1] neg_hi:[0,1]
v_pk_add_f32 v[70:71], v[70:71], v[78:79]
v_pk_mul_f32 v[78:79], v[76:77], s[62:63] op_sel:[0,0] op_sel_hi:[0,1] neg_lo:[0,1] neg_hi:[0,0]
v_pk_fma_f32 v[78:79], v[76:77], s[62:63], v[78:79] op_sel:[1,1,0] op_sel_hi:[1,0,1] neg_lo:[0,1,0] neg_hi:[0,1,0]
v_pk_add_f32 v[76:77], v[16:17], v[20:21] neg_lo:[0,1] neg_hi:[0,1]
v_pk_add_f32 v[16:17], v[16:17], v[20:21]
v_pk_add_f32 v[20:21], v[18:19], v[22:23] op_sel:[1,1] op_sel_hi:[0,0] neg_lo:[1,0] neg_hi:[0,1]
v_pk_add_f32 v[18:19], v[18:19], v[22:23]
v_pk_add_f32 v[22:23], v[72:73], v[24:25] neg_lo:[0,1] neg_hi:[0,1]
v_pk_add_f32 v[72:73], v[72:73], v[24:25]
v_pk_add_f32 v[24:25], v[26:27], v[30:31] op_sel:[1,1] op_sel_hi:[0,0] neg_lo:[1,0] neg_hi:[0,1]
v_pk_add_f32 v[26:27], v[26:27], v[30:31]
v_pk_add_f32 v[30:31], v[64:65], v[36:37] neg_lo:[0,1] neg_hi:[0,1]
v_pk_add_f32 v[64:65], v[64:65], v[36:37]
v_pk_add_f32 v[36:37], v[34:35], v[38:39] op_sel:[1,1] op_sel_hi:[0,0] neg_lo:[1,0] neg_hi:[0,1]
v_pk_add_f32 v[34:35], v[34:35], v[38:39]
v_pk_add_f32 v[38:39], v[28:29], v[32:33] neg_lo:[0,1] neg_hi:[0,1]
v_pk_add_f32 v[28:29], v[28:29], v[32:33]
v_pk_add_f32 v[32:33], v[42:43], v[46:47] op_sel:[1,1] op_sel_hi:[0,0] neg_lo:[1,0] neg_hi:[0,1]
v_pk_add_f32 v[42:43], v[42:43], v[46:47]
v_pk_add_f32 v[46:47], v[14:15], v[52:53] neg_lo:[0,1] neg_hi:[0,1]
v_pk_add_f32 v[14:15], v[14:15], v[52:53]
v_pk_add_f32 v[52:53], v[50:51], v[54:55] op_sel:[1,1] op_sel_hi:[0,0] neg_lo:[1,0] neg_hi:[0,1]
v_pk_add_f32 v[50:51], v[50:51], v[54:55]
v_pk_add_f32 v[54:55], v[44:45], v[56:57] neg_lo:[0,1] neg_hi:[0,1]
v_pk_add_f32 v[44:45], v[44:45], v[56:57]
v_pk_add_f32 v[56:57], v[58:59], v[62:63] op_sel:[1,1] op_sel_hi:[0,0] neg_lo:[1,0] neg_hi:[0,1]
v_pk_add_f32 v[58:59], v[58:59], v[62:63]
v_pk_add_f32 v[62:63], v[40:41], v[68:69] neg_lo:[0,1] neg_hi:[0,1]
v_pk_add_f32 v[40:41], v[40:41], v[68:69]
v_pk_add_f32 v[68:69], v[66:67], v[70:71] op_sel:[1,1] op_sel_hi:[0,0] neg_lo:[1,0] neg_hi:[0,1]
v_pk_add_f32 v[66:67], v[66:67], v[70:71]
v_pk_add_f32 v[70:71], v[60:61], v[48:49] neg_lo:[0,1] neg_hi:[0,1]
v_pk_add_f32 v[60:61], v[60:61], v[48:49]
v_pk_add_f32 v[48:49], v[74:75], v[78:79] op_sel:[1,1] op_sel_hi:[0,0] neg_lo:[1,0] neg_hi:[0,1]
v_pk_add_f32 v[74:75], v[74:75], v[78:79]
v_pk_add_f32 v[78:79], v[16:17], v[18:19] neg_lo:[0,1] neg_hi:[0,1]
v_pk_add_f32 v[16:17], v[16:17], v[18:19]
v_pk_add_f32 v[18:19], v[76:77], v[20:21] neg_lo:[0,1] neg_hi:[0,1]
v_pk_add_f32 v[76:77], v[76:77], v[20:21]
v_pk_add_f32 v[20:21], v[72:73], v[26:27] neg_lo:[0,1] neg_hi:[0,1]
v_pk_add_f32 v[72:73], v[72:73], v[26:27]
v_pk_add_f32 v[26:27], v[22:23], v[24:25] neg_lo:[0,1] neg_hi:[0,1]
v_pk_add_f32 v[22:23], v[22:23], v[24:25]
v_pk_add_f32 v[24:25], v[64:65], v[34:35] neg_lo:[0,1] neg_hi:[0,1]
v_pk_add_f32 v[64:65], v[64:65], v[34:35]
v_pk_add_f32 v[34:35], v[30:31], v[36:37] neg_lo:[0,1] neg_hi:[0,1]
v_pk_add_f32 v[30:31], v[30:31], v[36:37]
v_pk_add_f32 v[36:37], v[28:29], v[42:43] neg_lo:[0,1] neg_hi:[0,1]
v_pk_add_f32 v[28:29], v[28:29], v[42:43]
v_pk_add_f32 v[42:43], v[38:39], v[32:33] neg_lo:[0,1] neg_hi:[0,1]
v_pk_add_f32 v[38:39], v[38:39], v[32:33]
v_pk_add_f32 v[32:33], v[14:15], v[50:51] neg_lo:[0,1] neg_hi:[0,1]
v_pk_add_f32 v[14:15], v[14:15], v[50:51]
v_pk_add_f32 v[50:51], v[46:47], v[52:53] neg_lo:[0,1] neg_hi:[0,1]
v_pk_add_f32 v[46:47], v[46:47], v[52:53]
v_pk_add_f32 v[52:53], v[44:45], v[58:59] neg_lo:[0,1] neg_hi:[0,1]
v_pk_add_f32 v[44:45], v[44:45], v[58:59]
v_pk_add_f32 v[58:59], v[54:55], v[56:57] neg_lo:[0,1] neg_hi:[0,1]
v_pk_add_f32 v[54:55], v[54:55], v[56:57]
v_pk_add_f32 v[56:57], v[40:41], v[66:67] neg_lo:[0,1] neg_hi:[0,1]
v_pk_add_f32 v[40:41], v[40:41], v[66:67]
v_pk_add_f32 v[66:67], v[62:63], v[68:69] neg_lo:[0,1] neg_hi:[0,1]
v_pk_add_f32 v[62:63], v[62:63], v[68:69]
v_pk_add_f32 v[68:69], v[60:61], v[74:75] neg_lo:[0,1] neg_hi:[0,1]
v_pk_add_f32 v[60:61], v[60:61], v[74:75]
v_pk_add_f32 v[74:75], v[70:71], v[48:49] neg_lo:[0,1] neg_hi:[0,1]
v_pk_add_f32 v[70:71], v[70:71], v[48:49]
ds_write2st64_b32 v12, v16, v17 offset0:0 offset1:16
ds_write_b32 v12, v14 offset:128
ds_write_b32 v12, v15 offset:4224
ds_write_b32 v12, v64 offset:256
ds_write_b32 v12, v65 offset:4352
ds_write_b32 v12, v40 offset:384
ds_write_b32 v12, v41 offset:4480
ds_write_b32 v12, v72 offset:512
ds_write_b32 v12, v73 offset:4608
ds_write_b32 v12, v44 offset:640
ds_write_b32 v12, v45 offset:4736
ds_write_b32 v12, v28 offset:768
ds_write_b32 v12, v29 offset:4864
ds_write_b32 v12, v60 offset:896
ds_write_b32 v12, v61 offset:4992
ds_write_b32 v12, v76 offset:1024
ds_write_b32 v12, v77 offset:5120
ds_write_b32 v12, v46 offset:1152
ds_write_b32 v12, v47 offset:5248
ds_write_b32 v12, v30 offset:1280
ds_write_b32 v12, v31 offset:5376
ds_write_b32 v12, v62 offset:1408
ds_write_b32 v12, v63 offset:5504
ds_write_b32 v12, v22 offset:1536
ds_write_b32 v12, v23 offset:5632
ds_write_b32 v12, v54 offset:1664
ds_write_b32 v12, v55 offset:5760
ds_write_b32 v12, v38 offset:1792
ds_write_b32 v12, v39 offset:5888
ds_write_b32 v12, v70 offset:1920
ds_write_b32 v12, v71 offset:6016
ds_write_b32 v12, v78 offset:2048
ds_write_b32 v12, v79 offset:6144
ds_write_b32 v12, v32 offset:2176
ds_write_b32 v12, v33 offset:6272
ds_write_b32 v12, v24 offset:2304
ds_write_b32 v12, v25 offset:6400
ds_write_b32 v12, v56 offset:2432
ds_write_b32 v12, v57 offset:6528
ds_write_b32 v12, v20 offset:2560
ds_write_b32 v12, v21 offset:6656
ds_write_b32 v12, v52 offset:2688
ds_write_b32 v12, v53 offset:6784
ds_write_b32 v12, v36 offset:2816
ds_write_b32 v12, v37 offset:6912
ds_write_b32 v12, v68 offset:2944
ds_write_b32 v12, v69 offset:7040
ds_write_b32 v12, v18 offset:3072
ds_write_b32 v12, v19 offset:7168
ds_write_b32 v12, v50 offset:3200
ds_write_b32 v12, v51 offset:7296
ds_write_b32 v12, v34 offset:3328
ds_write_b32 v12, v35 offset:7424
ds_write_b32 v12, v66 offset:3456
ds_write_b32 v12, v67 offset:7552
ds_write_b32 v12, v26 offset:3584
ds_write_b32 v12, v27 offset:7680
ds_write_b32 v12, v58 offset:3712
ds_write_b32 v12, v59 offset:7808
ds_write_b32 v12, v42 offset:3840
ds_write_b32 v12, v43 offset:7936
ds_write_b32 v12, v74 offset:3968
ds_write_b32 v12, v75 offset:8064
s_waitcnt lgkmcnt(0)
s_barrier
s_lshl_b32 s13, s93, 16
ds_read_b128 v[16:19], v2 offset:0
ds_read_b128 v[20:23], v2 offset:16
ds_read_b128 v[24:27], v2 offset:8448
ds_read_b128 v[28:31], v2 offset:8464
ds_read_b128 v[32:35], v2 offset:16896
ds_read_b128 v[36:39], v2 offset:16912
ds_read_b128 v[40:43], v2 offset:25344
ds_read_b128 v[44:47], v2 offset:25360
ds_read_b128 v[48:51], v2 offset:33792
ds_read_b128 v[52:55], v2 offset:33808
ds_read_b128 v[56:59], v2 offset:42240
ds_read_b128 v[60:63], v2 offset:42256
ds_read_b128 v[64:67], v2 offset:50688
ds_read_b128 v[68:71], v2 offset:50704
s_waitcnt lgkmcnt(12)
ds_read_b128 v[72:75], v2 offset:59136
ds_read_b128 v[76:79], v2 offset:59152
s_waitcnt lgkmcnt(14)
v_cvt_pk_bf16_f32 v216, v16, v17
v_cvt_pk_bf16_f32 v217, v18, v19
v_cvt_pk_bf16_f32 v218, v20, v21
v_cvt_pk_bf16_f32 v219, v22, v23
buffer_store_dwordx4 v[216:219], v3, s[4:7], s13 offen sc1
s_add_u32 s13, s13, 8192
s_waitcnt lgkmcnt(12)
v_cvt_pk_bf16_f32 v220, v24, v25
v_cvt_pk_bf16_f32 v221, v26, v27
v_cvt_pk_bf16_f32 v222, v28, v29
v_cvt_pk_bf16_f32 v223, v30, v31
buffer_store_dwordx4 v[220:223], v3, s[4:7], s13 offen sc1
s_add_u32 s13, s13, 8192
s_waitcnt lgkmcnt(10)
v_cvt_pk_bf16_f32 v224, v32, v33
v_cvt_pk_bf16_f32 v225, v34, v35
v_cvt_pk_bf16_f32 v226, v36, v37
v_cvt_pk_bf16_f32 v227, v38, v39
buffer_store_dwordx4 v[224:227], v3, s[4:7], s13 offen sc1
s_add_u32 s13, s13, 8192
s_waitcnt lgkmcnt(8)
v_cvt_pk_bf16_f32 v228, v40, v41
v_cvt_pk_bf16_f32 v229, v42, v43
v_cvt_pk_bf16_f32 v230, v44, v45
v_cvt_pk_bf16_f32 v231, v46, v47
buffer_store_dwordx4 v[228:231], v3, s[4:7], s13 offen sc1
s_add_u32 s13, s13, 8192
s_waitcnt lgkmcnt(6)
v_cvt_pk_bf16_f32 v232, v48, v49
v_cvt_pk_bf16_f32 v233, v50, v51
v_cvt_pk_bf16_f32 v234, v52, v53
v_cvt_pk_bf16_f32 v235, v54, v55
buffer_store_dwordx4 v[232:235], v3, s[4:7], s13 offen sc1
s_add_u32 s13, s13, 8192
s_waitcnt lgkmcnt(4)
v_cvt_pk_bf16_f32 v236, v56, v57
v_cvt_pk_bf16_f32 v237, v58, v59
v_cvt_pk_bf16_f32 v238, v60, v61
v_cvt_pk_bf16_f32 v239, v62, v63
buffer_store_dwordx4 v[236:239], v3, s[4:7], s13 offen sc1
s_add_u32 s13, s13, 8192
s_waitcnt lgkmcnt(2)
v_cvt_pk_bf16_f32 v240, v64, v65
v_cvt_pk_bf16_f32 v241, v66, v67
v_cvt_pk_bf16_f32 v242, v68, v69
v_cvt_pk_bf16_f32 v243, v70, v71
buffer_store_dwordx4 v[240:243], v3, s[4:7], s13 offen sc1
s_add_u32 s13, s13, 8192
s_waitcnt lgkmcnt(0)
v_cvt_pk_bf16_f32 v244, v72, v73
v_cvt_pk_bf16_f32 v245, v74, v75
v_cvt_pk_bf16_f32 v246, v76, v77
v_cvt_pk_bf16_f32 v247, v78, v79
buffer_store_dwordx4 v[244:247], v3, s[4:7], s13 offen sc1
s_add_u32 s13, s13, 8192
s_mov_b32 s93, s21
s_cmp_lt_u32 s93, 128
s_cbranch_scc1 mega_kernel_f3_l
mega_kernel_f3_e:
s_waitcnt vmcnt(0)
s_barrier
s_add_u32 s64, s91, 58
s_mov_b32 s65, 64
s_mov_b32 s67, 1
s_add_u32 s66, s66, 262144
s_cmp_eq_u32 s91, 0
s_cbranch_scc1 mega_kernel_out
s_lshr_b32 s66, s40, 2
s_lshl_b32 s66, s66, 16
s_and_b32 s76, s40, 3
s_lshl_b32 s76, s76, 13
s_add_u32 s66, s66, s76
s_add_u32 s66, s66, 67141632
mega_kernel_out:
s_load_dwordx2 s[4:5], s[0:1], 40
s_load_dwordx2 s[8:9], s[0:1], 80
v_lshrrev_b32 v2, 6, v0
v_and_b32 v1, 63, v0
v_readfirstlane_b32 s41, v2
v_lshlrev_b32 v5, 4, v1
s_waitcnt lgkmcnt(0)
s_mov_b32 s6, 8388608
s_mov_b32 s7, 0x00020000
s_mov_b32 s10, 8388608
s_mov_b32 s11, 0x00020000
s_and_b32 s58, s40, 1
s_lshr_b32 s59, s40, 1
s_lshl_b32 s43, s58, 22
s_lshl_b32 s44, s41, 20
s_add_u32 s43, s43, s44
s_lshl_b32 s44, s59, 7
s_add_u32 s48, s43, s44
s_and_b32 s56, s59, 7
s_lshl_b32 s56, s56, 6
s_cmp_eq_u32 s68, 2
s_cbranch_scc1 mega_kernel_o_hw
v_lshrrev_b32 v2, 3, v1
v_and_b32 v3, 7, v1
v_lshlrev_b32 v16, 11, v2
v_lshl_add_u32 v16, v3, 4, v16
v_add_u32 v16, s48, v16
v_and_b32 v3, 3, v1
s_lshl_b32 s45, s41, 15
v_bfe_u32 v17, v1, 2, 2
v_lshrrev_b32 v18, 5, v1
v_mul_u32_u24 v18, 4, v18
v_add_u32 v17, v17, v18
v_lshlrev_b32 v17, 7, v17
v_bfe_u32 v18, v1, 4, 1
v_lshl_add_u32 v17, v18, 5, v17
v_lshl_add_u32 v17, v3, 3, v17
v_add_u32 v17, s45, v17
s_add_u32 m0, s45, 0
s_add_u32 s44, s56, 0
s_and_b32 s44, s44, 511
s_lshl_b32 s44, s44, 11
buffer_load_dwordx4 v16, s[4:7], s44 offen lds
s_add_u32 m0, s45, 1024
s_add_u32 s44, s56, 8
s_and_b32 s44, s44, 511
s_lshl_b32 s44, s44, 11
buffer_load_dwordx4 v16, s[4:7], s44 offen lds
s_add_u32 m0, s45, 2048
s_add_u32 s44, s56, 16
s_and_b32 s44, s44, 511
s_lshl_b32 s44, s44, 11
buffer_load_dwordx4 v16, s[4:7], s44 offen lds
s_add_u32 m0, s45, 3072
s_add_u32 s44, s56, 24
s_and_b32 s44, s44, 511
s_lshl_b32 s44, s44, 11
buffer_load_dwordx4 v16, s[4:7], s44 offen lds
s_add_u32 m0, s45, 4096
s_add_u32 s44, s56, 32
s_and_b32 s44, s44, 511
s_lshl_b32 s44, s44, 11
buffer_load_dwordx4 v16, s[4:7], s44 offen lds
s_add_u32 m0, s45, 5120
s_add_u32 s44, s56, 40
s_and_b32 s44, s44, 511
s_lshl_b32 s44, s44, 11
buffer_load_dwordx4 v16, s[4:7], s44 offen lds
s_add_u32 m0, s45, 6144
s_add_u32 s44, s56, 48
s_and_b32 s44, s44, 511
s_lshl_b32 s44, s44, 11
buffer_load_dwordx4 v16, s[4:7], s44 offen lds
s_add_u32 m0, s45, 7168
s_add_u32 s44, s56, 56
s_and_b32 s44, s44, 511
s_lshl_b32 s44, s44, 11
buffer_load_dwordx4 v16, s[4:7], s44 offen lds
s_add_u32 m0, s45, 8192
s_add_u32 s44, s56, 64
s_and_b32 s44, s44, 511
s_lshl_b32 s44, s44, 11
buffer_load_dwordx4 v16, s[4:7], s44 offen lds
s_add_u32 m0, s45, 9216
s_add_u32 s44, s56, 72
s_and_b32 s44, s44, 511
s_lshl_b32 s44, s44, 11
buffer_load_dwordx4 v16, s[4:7], s44 offen lds
s_add_u32 m0, s45, 10240
s_add_u32 s44, s56, 80
s_and_b32 s44, s44, 511
s_lshl_b32 s44, s44, 11
buffer_load_dwordx4 v16, s[4:7], s44 offen lds
s_add_u32 m0, s45, 11264
s_add_u32 s44, s56, 88
s_and_b32 s44, s44, 511
s_lshl_b32 s44, s44, 11
buffer_load_dwordx4 v16, s[4:7], s44 offen lds
s_add_u32 m0, s45, 12288
s_add_u32 s44, s56, 96
s_and_b32 s44, s44, 511
s_lshl_b32 s44, s44, 11
buffer_load_dwordx4 v16, s[4:7], s44 offen lds
s_add_u32 m0, s45, 13312
s_add_u32 s44, s56, 104
s_and_b32 s44, s44, 511
s_lshl_b32 s44, s44, 11
buffer_load_dwordx4 v16, s[4:7], s44 offen lds
s_add_u32 m0, s45, 14336
s_add_u32 s44, s56, 112
s_and_b32 s44, s44, 511
s_lshl_b32 s44, s44, 11
buffer_load_dwordx4 v16, s[4:7], s44 offen lds
s_add_u32 m0, s45, 15360
s_add_u32 s44, s56, 120
s_and_b32 s44, s44, 511
s_lshl_b32 s44, s44, 11
buffer_load_dwordx4 v16, s[4:7], s44 offen lds
s_add_u32 m0, s45, 16384
s_add_u32 s44, s56, 128
s_and_b32 s44, s44, 511
s_lshl_b32 s44, s44, 11
buffer_load_dwordx4 v16, s[4:7], s44 offen lds
s_add_u32 m0, s45, 17408
s_add_u32 s44, s56, 136
s_and_b32 s44, s44, 511
s_lshl_b32 s44, s44, 11
buffer_load_dwordx4 v16, s[4:7], s44 offen lds
s_add_u32 m0, s45, 18432
s_add_u32 s44, s56, 144
s_and_b32 s44, s44, 511
s_lshl_b32 s44, s44, 11
buffer_load_dwordx4 v16, s[4:7], s44 offen lds
s_add_u32 m0, s45, 19456
s_add_u32 s44, s56, 152
s_and_b32 s44, s44, 511
s_lshl_b32 s44, s44, 11
buffer_load_dwordx4 v16, s[4:7], s44 offen lds
s_add_u32 m0, s45, 20480
s_add_u32 s44, s56, 160
s_and_b32 s44, s44, 511
s_lshl_b32 s44, s44, 11
buffer_load_dwordx4 v16, s[4:7], s44 offen lds
s_add_u32 m0, s45, 21504
s_add_u32 s44, s56, 168
s_and_b32 s44, s44, 511
s_lshl_b32 s44, s44, 11
buffer_load_dwordx4 v16, s[4:7], s44 offen lds
s_add_u32 m0, s45, 22528
s_add_u32 s44, s56, 176
s_and_b32 s44, s44, 511
s_lshl_b32 s44, s44, 11
buffer_load_dwordx4 v16, s[4:7], s44 offen lds
s_add_u32 m0, s45, 23552
s_add_u32 s44, s56, 184
s_and_b32 s44, s44, 511
s_lshl_b32 s44, s44, 11
buffer_load_dwordx4 v16, s[4:7], s44 offen lds
s_add_u32 m0, s45, 24576
s_add_u32 s44, s56, 192
s_and_b32 s44, s44, 511
s_lshl_b32 s44, s44, 11
buffer_load_dwordx4 v16, s[4:7], s44 offen lds
s_add_u32 m0, s45, 25600
s_add_u32 s44, s56, 200
s_and_b32 s44, s44, 511
s_lshl_b32 s44, s44, 11
buffer_load_dwordx4 v16, s[4:7], s44 offen lds
s_add_u32 m0, s45, 26624
s_add_u32 s44, s56, 208
s_and_b32 s44, s44, 511
s_lshl_b32 s44, s44, 11
buffer_load_dwordx4 v16, s[4:7], s44 offen lds
s_add_u32 m0, s45, 27648
s_add_u32 s44, s56, 216
s_and_b32 s44, s44, 511
s_lshl_b32 s44, s44, 11
buffer_load_dwordx4 v16, s[4:7], s44 offen lds
s_add_u32 m0, s45, 28672
s_add_u32 s44, s56, 224
s_and_b32 s44, s44, 511
s_lshl_b32 s44, s44, 11
buffer_load_dwordx4 v16, s[4:7], s44 offen lds
s_add_u32 m0, s45, 29696
s_add_u32 s44, s56, 232
s_and_b32 s44, s44, 511
s_lshl_b32 s44, s44, 11
buffer_load_dwordx4 v16, s[4:7], s44 offen lds
s_add_u32 m0, s45, 30720
s_add_u32 s44, s56, 240
s_and_b32 s44, s44, 511
s_lshl_b32 s44, s44, 11
buffer_load_dwordx4 v16, s[4:7], s44 offen lds
s_add_u32 m0, s45, 31744
s_add_u32 s44, s56, 248
s_and_b32 s44, s44, 511
s_lshl_b32 s44, s44, 11
buffer_load_dwordx4 v16, s[4:7], s44 offen lds
s_waitcnt vmcnt(16)
ds_read_b64_tr_b16 a[0:1], v17 offset:0
ds_read_b64_tr_b16 a[2:3], v17 offset:2048
ds_read_b64_tr_b16 a[4:5], v17 offset:64
ds_read_b64_tr_b16 a[6:7], v17 offset:2112
ds_read_b64_tr_b16 a[8:9], v17 offset:1024
ds_read_b64_tr_b16 a[10:11], v17 offset:3072
ds_read_b64_tr_b16 a[12:13], v17 offset:1088
ds_read_b64_tr_b16 a[14:15], v17 offset:3136
s_waitcnt lgkmcnt(0)
ds_read_b64_tr_b16 a[16:17], v17 offset:4096
ds_read_b64_tr_b16 a[18:19], v17 offset:6144
ds_read_b64_tr_b16 a[20:21], v17 offset:4160
ds_read_b64_tr_b16 a[22:23], v17 offset:6208
ds_read_b64_tr_b16 a[24:25], v17 offset:5120
ds_read_b64_tr_b16 a[26:27], v17 offset:7168
ds_read_b64_tr_b16 a[28:29], v17 offset:5184
ds_read_b64_tr_b16 a[30:31], v17 offset:7232
s_waitcnt lgkmcnt(0)
ds_read_b64_tr_b16 a[32:33], v17 offset:8192
ds_read_b64_tr_b16 a[34:35], v17 offset:10240
ds_read_b64_tr_b16 a[36:37], v17 offset:8256
ds_read_b64_tr_b16 a[38:39], v17 offset:10304
ds_read_b64_tr_b16 a[40:41], v17 offset:9216
ds_read_b64_tr_b16 a[42:43], v17 offset:11264
ds_read_b64_tr_b16 a[44:45], v17 offset:9280
ds_read_b64_tr_b16 a[46:47], v17 offset:11328
s_waitcnt lgkmcnt(0)
ds_read_b64_tr_b16 a[48:49], v17 offset:12288
ds_read_b64_tr_b16 a[50:51], v17 offset:14336
ds_read_b64_tr_b16 a[52:53], v17 offset:12352
ds_read_b64_tr_b16 a[54:55], v17 offset:14400
ds_read_b64_tr_b16 a[56:57], v17 offset:13312
ds_read_b64_tr_b16 a[58:59], v17 offset:15360
ds_read_b64_tr_b16 a[60:61], v17 offset:13376
ds_read_b64_tr_b16 a[62:63], v17 offset:15424
s_waitcnt lgkmcnt(0)
s_add_u32 m0, s45, 0
s_add_u32 s44, s56, 256
s_and_b32 s44, s44, 511
s_lshl_b32 s44, s44, 11
buffer_load_dwordx4 v16, s[4:7], s44 offen lds
s_add_u32 m0, s45, 1024
s_add_u32 s44, s56, 264
s_and_b32 s44, s44, 511
s_lshl_b32 s44, s44, 11
buffer_load_dwordx4 v16, s[4:7], s44 offen lds
s_add_u32 m0, s45, 2048
s_add_u32 s44, s56, 272
s_and_b32 s44, s44, 511
s_lshl_b32 s44, s44, 11
buffer_load_dwordx4 v16, s[4:7], s44 offen lds
s_add_u32 m0, s45, 3072
s_add_u32 s44, s56, 280
s_and_b32 s44, s44, 511
s_lshl_b32 s44, s44, 11
buffer_load_dwordx4 v16, s[4:7], s44 offen lds
s_add_u32 m0, s45, 4096
s_add_u32 s44, s56, 288
s_and_b32 s44, s44, 511
s_lshl_b32 s44, s44, 11
buffer_load_dwordx4 v16, s[4:7], s44 offen lds
s_add_u32 m0, s45, 5120
s_add_u32 s44, s56, 296
s_and_b32 s44, s44, 511
s_lshl_b32 s44, s44, 11
buffer_load_dwordx4 v16, s[4:7], s44 offen lds
s_add_u32 m0, s45, 6144
s_add_u32 s44, s56, 304
s_and_b32 s44, s44, 511
s_lshl_b32 s44, s44, 11
buffer_load_dwordx4 v16, s[4:7], s44 offen lds
s_add_u32 m0, s45, 7168
s_add_u32 s44, s56, 312
s_and_b32 s44, s44, 511
s_lshl_b32 s44, s44, 11
buffer_load_dwordx4 v16, s[4:7], s44 offen lds
s_add_u32 m0, s45, 8192
s_add_u32 s44, s56, 320
s_and_b32 s44, s44, 511
s_lshl_b32 s44, s44, 11
buffer_load_dwordx4 v16, s[4:7], s44 offen lds
s_add_u32 m0, s45, 9216
s_add_u32 s44, s56, 328
s_and_b32 s44, s44, 511
s_lshl_b32 s44, s44, 11
buffer_load_dwordx4 v16, s[4:7], s44 offen lds
s_add_u32 m0, s45, 10240
s_add_u32 s44, s56, 336
s_and_b32 s44, s44, 511
s_lshl_b32 s44, s44, 11
buffer_load_dwordx4 v16, s[4:7], s44 offen lds
s_add_u32 m0, s45, 11264
s_add_u32 s44, s56, 344
s_and_b32 s44, s44, 511
s_lshl_b32 s44, s44, 11
buffer_load_dwordx4 v16, s[4:7], s44 offen lds
s_add_u32 m0, s45, 12288
s_add_u32 s44, s56, 352
s_and_b32 s44, s44, 511
s_lshl_b32 s44, s44, 11
buffer_load_dwordx4 v16, s[4:7], s44 offen lds
s_add_u32 m0, s45, 13312
s_add_u32 s44, s56, 360
s_and_b32 s44, s44, 511
s_lshl_b32 s44, s44, 11
buffer_load_dwordx4 v16, s[4:7], s44 offen lds
s_add_u32 m0, s45, 14336
s_add_u32 s44, s56, 368
s_and_b32 s44, s44, 511
s_lshl_b32 s44, s44, 11
buffer_load_dwordx4 v16, s[4:7], s44 offen lds
s_add_u32 m0, s45, 15360
s_add_u32 s44, s56, 376
s_and_b32 s44, s44, 511
s_lshl_b32 s44, s44, 11
buffer_load_dwordx4 v16, s[4:7], s44 offen lds
s_waitcnt vmcnt(16)
ds_read_b64_tr_b16 a[64:65], v17 offset:16384
ds_read_b64_tr_b16 a[66:67], v17 offset:18432
ds_read_b64_tr_b16 a[68:69], v17 offset:16448
ds_read_b64_tr_b16 a[70:71], v17 offset:18496
ds_read_b64_tr_b16 a[72:73], v17 offset:17408
ds_read_b64_tr_b16 a[74:75], v17 offset:19456
ds_read_b64_tr_b16 a[76:77], v17 offset:17472
ds_read_b64_tr_b16 a[78:79], v17 offset:19520
s_waitcnt lgkmcnt(0)
ds_read_b64_tr_b16 a[80:81], v17 offset:20480
ds_read_b64_tr_b16 a[82:83], v17 offset:22528
ds_read_b64_tr_b16 a[84:85], v17 offset:20544
ds_read_b64_tr_b16 a[86:87], v17 offset:22592
ds_read_b64_tr_b16 a[88:89], v17 offset:21504
ds_read_b64_tr_b16 a[90:91], v17 offset:23552
ds_read_b64_tr_b16 a[92:93], v17 offset:21568
ds_read_b64_tr_b16 a[94:95], v17 offset:23616
s_waitcnt lgkmcnt(0)
ds_read_b64_tr_b16 a[96:97], v17 offset:24576
ds_read_b64_tr_b16 a[98:99], v17 offset:26624
ds_read_b64_tr_b16 a[100:101], v17 offset:24640
ds_read_b64_tr_b16 a[102:103], v17 offset:26688
ds_read_b64_tr_b16 a[104:105], v17 offset:25600
ds_read_b64_tr_b16 a[106:107], v17 offset:27648
ds_read_b64_tr_b16 a[108:109], v17 offset:25664
ds_read_b64_tr_b16 a[110:111], v17 offset:27712
s_waitcnt lgkmcnt(0)
ds_read_b64_tr_b16 a[112:113], v17 offset:28672
ds_read_b64_tr_b16 a[114:115], v17 offset:30720
ds_read_b64_tr_b16 a[116:117], v17 offset:28736
ds_read_b64_tr_b16 a[118:119], v17 offset:30784
ds_read_b64_tr_b16 a[120:121], v17 offset:29696
ds_read_b64_tr_b16 a[122:123], v17 offset:31744
ds_read_b64_tr_b16 a[124:125], v17 offset:29760
ds_read_b64_tr_b16 a[126:127], v17 offset:31808
s_waitcnt lgkmcnt(0)
s_add_u32 m0, s45, 16384
s_add_u32 s44, s56, 384
s_and_b32 s44, s44, 511
s_lshl_b32 s44, s44, 11
buffer_load_dwordx4 v16, s[4:7], s44 offen lds
s_add_u32 m0, s45, 17408
s_add_u32 s44, s56, 392
s_and_b32 s44, s44, 511
s_lshl_b32 s44, s44, 11
buffer_load_dwordx4 v16, s[4:7], s44 offen lds
s_add_u32 m0, s45, 18432
s_add_u32 s44, s56, 400
s_and_b32 s44, s44, 511
s_lshl_b32 s44, s44, 11
buffer_load_dwordx4 v16, s[4:7], s44 offen lds
s_add_u32 m0, s45, 19456
s_add_u32 s44, s56, 408
s_and_b32 s44, s44, 511
s_lshl_b32 s44, s44, 11
buffer_load_dwordx4 v16, s[4:7], s44 offen lds
s_add_u32 m0, s45, 20480
s_add_u32 s44, s56, 416
s_and_b32 s44, s44, 511
s_lshl_b32 s44, s44, 11
buffer_load_dwordx4 v16, s[4:7], s44 offen lds
s_add_u32 m0, s45, 21504
s_add_u32 s44, s56, 424
s_and_b32 s44, s44, 511
s_lshl_b32 s44, s44, 11
buffer_load_dwordx4 v16, s[4:7], s44 offen lds
s_add_u32 m0, s45, 22528
s_add_u32 s44, s56, 432
s_and_b32 s44, s44, 511
s_lshl_b32 s44, s44, 11
buffer_load_dwordx4 v16, s[4:7], s44 offen lds
s_add_u32 m0, s45, 23552
s_add_u32 s44, s56, 440
s_and_b32 s44, s44, 511
s_lshl_b32 s44, s44, 11
buffer_load_dwordx4 v16, s[4:7], s44 offen lds
s_add_u32 m0, s45, 24576
s_add_u32 s44, s56, 448
s_and_b32 s44, s44, 511
s_lshl_b32 s44, s44, 11
buffer_load_dwordx4 v16, s[4:7], s44 offen lds
s_add_u32 m0, s45, 25600
s_add_u32 s44, s56, 456
s_and_b32 s44, s44, 511
s_lshl_b32 s44, s44, 11
buffer_load_dwordx4 v16, s[4:7], s44 offen lds
s_add_u32 m0, s45, 26624
s_add_u32 s44, s56, 464
s_and_b32 s44, s44, 511
s_lshl_b32 s44, s44, 11
buffer_load_dwordx4 v16, s[4:7], s44 offen lds
s_add_u32 m0, s45, 27648
s_add_u32 s44, s56, 472
s_and_b32 s44, s44, 511
s_lshl_b32 s44, s44, 11
buffer_load_dwordx4 v16, s[4:7], s44 offen lds
s_add_u32 m0, s45, 28672
s_add_u32 s44, s56, 480
s_and_b32 s44, s44, 511
s_lshl_b32 s44, s44, 11
buffer_load_dwordx4 v16, s[4:7], s44 offen lds
s_add_u32 m0, s45, 29696
s_add_u32 s44, s56, 488
s_and_b32 s44, s44, 511
s_lshl_b32 s44, s44, 11
buffer_load_dwordx4 v16, s[4:7], s44 offen lds
s_add_u32 m0, s45, 30720
s_add_u32 s44, s56, 496
s_and_b32 s44, s44, 511
s_lshl_b32 s44, s44, 11
buffer_load_dwordx4 v16, s[4:7], s44 offen lds
s_add_u32 m0, s45, 31744
s_add_u32 s44, s56, 504
s_and_b32 s44, s44, 511
s_lshl_b32 s44, s44, 11
buffer_load_dwordx4 v16, s[4:7], s44 offen lds
s_waitcnt vmcnt(16)
ds_read_b64_tr_b16 a[128:129], v17 offset:0
ds_read_b64_tr_b16 a[130:131], v17 offset:2048
ds_read_b64_tr_b16 a[132:133], v17 offset:64
ds_read_b64_tr_b16 a[134:135], v17 offset:2112
ds_read_b64_tr_b16 a[136:137], v17 offset:1024
ds_read_b64_tr_b16 a[138:139], v17 offset:3072
ds_read_b64_tr_b16 a[140:141], v17 offset:1088
ds_read_b64_tr_b16 a[142:143], v17 offset:3136
s_waitcnt lgkmcnt(0)
ds_read_b64_tr_b16 a[144:145], v17 offset:4096
ds_read_b64_tr_b16 a[146:147], v17 offset:6144
ds_read_b64_tr_b16 a[148:149], v17 offset:4160
ds_read_b64_tr_b16 a[150:151], v17 offset:6208
ds_read_b64_tr_b16 a[152:153], v17 offset:5120
ds_read_b64_tr_b16 a[154:155], v17 offset:7168
ds_read_b64_tr_b16 a[156:157], v17 offset:5184
ds_read_b64_tr_b16 a[158:159], v17 offset:7232
s_waitcnt lgkmcnt(0)
ds_read_b64_tr_b16 a[160:161], v17 offset:8192
ds_read_b64_tr_b16 a[162:163], v17 offset:10240
ds_read_b64_tr_b16 a[164:165], v17 offset:8256
ds_read_b64_tr_b16 a[166:167], v17 offset:10304
ds_read_b64_tr_b16 a[168:169], v17 offset:9216
ds_read_b64_tr_b16 a[170:171], v17 offset:11264
ds_read_b64_tr_b16 a[172:173], v17 offset:9280
ds_read_b64_tr_b16 a[174:175], v17 offset:11328
s_waitcnt lgkmcnt(0)
ds_read_b64_tr_b16 a[176:177], v17 offset:12288
ds_read_b64_tr_b16 a[178:179], v17 offset:14336
ds_read_b64_tr_b16 a[180:181], v17 offset:12352
ds_read_b64_tr_b16 a[182:183], v17 offset:14400
ds_read_b64_tr_b16 a[184:185], v17 offset:13312
ds_read_b64_tr_b16 a[186:187], v17 offset:15360
ds_read_b64_tr_b16 a[188:189], v17 offset:13376
ds_read_b64_tr_b16 a[190:191], v17 offset:15424
s_waitcnt lgkmcnt(0)
s_waitcnt vmcnt(0)
ds_read_b64_tr_b16 a[192:193], v17 offset:16384
ds_read_b64_tr_b16 a[194:195], v17 offset:18432
ds_read_b64_tr_b16 a[196:197], v17 offset:16448
ds_read_b64_tr_b16 a[198:199], v17 offset:18496
ds_read_b64_tr_b16 a[200:201], v17 offset:17408
ds_read_b64_tr_b16 a[202:203], v17 offset:19456
ds_read_b64_tr_b16 a[204:205], v17 offset:17472
ds_read_b64_tr_b16 a[206:207], v17 offset:19520
s_waitcnt lgkmcnt(0)
ds_read_b64_tr_b16 a[208:209], v17 offset:20480
ds_read_b64_tr_b16 a[210:211], v17 offset:22528
ds_read_b64_tr_b16 a[212:213], v17 offset:20544
ds_read_b64_tr_b16 a[214:215], v17 offset:22592
ds_read_b64_tr_b16 a[216:217], v17 offset:21504
ds_read_b64_tr_b16 a[218:219], v17 offset:23552
ds_read_b64_tr_b16 a[220:221], v17 offset:21568
ds_read_b64_tr_b16 a[222:223], v17 offset:23616
s_waitcnt lgkmcnt(0)
ds_read_b64_tr_b16 a[224:225], v17 offset:24576
ds_read_b64_tr_b16 a[226:227], v17 offset:26624
ds_read_b64_tr_b16 a[228:229], v17 offset:24640
ds_read_b64_tr_b16 a[230:231], v17 offset:26688
ds_read_b64_tr_b16 a[232:233], v17 offset:25600
ds_read_b64_tr_b16 a[234:235], v17 offset:27648
ds_read_b64_tr_b16 a[236:237], v17 offset:25664
ds_read_b64_tr_b16 a[238:239], v17 offset:27712
s_waitcnt lgkmcnt(0)
ds_read_b64_tr_b16 a[240:241], v17 offset:28672
ds_read_b64_tr_b16 a[242:243], v17 offset:30720
ds_read_b64_tr_b16 a[244:245], v17 offset:28736
ds_read_b64_tr_b16 a[246:247], v17 offset:30784
ds_read_b64_tr_b16 a[248:249], v17 offset:29696
ds_read_b64_tr_b16 a[250:251], v17 offset:31744
ds_read_b64_tr_b16 a[252:253], v17 offset:29760
ds_read_b64_tr_b16 a[254:255], v17 offset:31808
s_waitcnt lgkmcnt(0)
s_barrier
s_cmp_eq_u32 s68, 1
s_cbranch_scc1 mega_kernel_back
mega_kernel_o_hw:
s_lshl_b32 s56, s56, 6
s_lshl_b32 s43, s58, 17
s_lshl_b32 s44, s41, 15
s_add_u32 s43, s43, s44
s_add_u32 s43, s43, 134217728
v_add_u32 v6, s43, v5
v_and_b32 v2, 3, v1
v_lshlrev_b32 v7, 2, v2
v_bfe_u32 v2, v1, 2, 2
v_lshl_add_u32 v7, v2, 7, v7
s_lshl_b32 s43, s58, 11
s_lshl_b32 s44, s41, 9
s_add_u32 s43, s43, s44
s_lshl_b32 s44, s98, 13
s_add_u32 s43, s43, s44
s_add_u32 s43, s43, 69255168
v_add_u32 v7, s43, v7
s_mul_i32 s43, s41, 8704
v_lshrrev_b32 v2, 5, v1
v_lshl_add_u32 v8, v2, 5, v5
v_add_u32 v8, s43, v8
v_and_b32 v2, 7, v1
v_mul_u32_u24 v9, 544, v2
v_lshrrev_b32 v3, 3, v1
v_lshl_add_u32 v9, v3, 4, v9
s_lshl_b32 s43, s41, 7
v_add_u32 v9, s43, v9
s_mul_i32 s43, s58, 4352
s_sub_u32 s44, 4352, s43
v_add_u32 v10, s44, v9
v_add_u32 v9, s43, v9
s_lshl_b32 s43, s41, 15
s_lshl_b32 s44, s40, 6
s_add_u32 s43, s43, s44
v_lshlrev_b32 v11, 12, v3
v_and_b32 v2, 7, v1
v_lshl_add_u32 v11, v2, 3, v11
v_add_u32 v11, s43, v11
s_lshl_b32 s44, s41, 10
s_add_u32 s43, s66, s44
v_add_u32 v13, s43, v5
v_xor_b32 v12, 8192, v13
s_lshl_b32 s71, 1, s67
s_mov_b32 s42, s64
s_mov_b32 s52, 0
s_mov_b32 s53, 0
s_mov_b32 s57, 0
mega_kernel_o_cold:
s_cmp_gt_i32 s52, s42
s_cbranch_scc1 mega_kernel_o_fk
mega_kernel_o_fw:
buffer_load_dword v2, v7, s[84:87], 0 offen sc1
s_waitcnt vmcnt(0)
v_min_i32_dpp v2, v2, v2 quad_perm:[1,0,3,2] row_mask:0xf bank_mask:0xf
s_nop 1
v_min_i32_dpp v2, v2, v2 quad_perm:[2,3,0,1] row_mask:0xf bank_mask:0xf
s_nop 1
v_min_i32_dpp v2, v2, v2 row_ror:4 row_mask:0xf bank_mask:0xf
s_nop 1
v_min_i32_dpp v2, v2, v2 row_ror:8 row_mask:0xf bank_mask:0xf
s_nop 0
v_readfirstlane_b32 s52, v2
s_min_i32 s52, s52, s65
s_cmp_gt_i32 s52, s42
s_cbranch_scc1 mega_kernel_o_fk
s_sleep 2
s_add_u32 s43, s52, 2
s_cmp_gt_i32 s43, s42
s_cbranch_scc1 mega_kernel_o_fw
s_sleep 48
s_branch mega_kernel_o_fw
mega_kernel_o_fk:
s_add_u32 s54, s42, s71
s_cmp_gt_i32 s52, s54
s_cbranch_scc0 mega_kernel_o_c0
s_lshl_b32 s50, s42, 18
s_add_u32 s51, s56, 0
s_and_b32 s51, s51, 0x7fff
s_add_u32 s51, s51, s50
buffer_load_dwordx4 v[96:99], v6, s[84:87], s51 offen offset:0 sc1
buffer_load_dwordx4 v[100:103], v6, s[84:87], s51 offen offset:1024 sc1
buffer_load_dwordx4 v[104:107], v6, s[84:87], s51 offen offset:2048 sc1
buffer_load_dwordx4 v[108:111], v6, s[84:87], s51 offen offset:3072 sc1
s_add_u32 s51, s56, 4096
s_and_b32 s51, s51, 0x7fff
s_add_u32 s51, s51, s50
buffer_load_dwordx4 v[112:115], v6, s[84:87], s51 offen offset:0 sc1
buffer_load_dwordx4 v[116:119], v6, s[84:87], s51 offen offset:1024 sc1
buffer_load_dwordx4 v[120:123], v6, s[84:87], s51 offen offset:2048 sc1
buffer_load_dwordx4 v[124:127], v6, s[84:87], s51 offen offset:3072 sc1
s_add_u32 s51, s56, 8192
s_and_b32 s51, s51, 0x7fff
s_add_u32 s51, s51, s50
buffer_load_dwordx4 v[128:131], v6, s[84:87], s51 offen offset:0 sc1
buffer_load_dwordx4 v[132:135], v6, s[84:87], s51 offen offset:1024 sc1
buffer_load_dwordx4 v[136:139], v6, s[84:87], s51 offen offset:2048 sc1
buffer_load_dwordx4 v[140:143], v6, s[84:87], s51 offen offset:3072 sc1
s_add_u32 s51, s56, 12288
s_and_b32 s51, s51, 0x7fff
s_add_u32 s51, s51, s50
buffer_load_dwordx4 v[144:147], v6, s[84:87], s51 offen offset:0 sc1
buffer_load_dwordx4 v[148:151], v6, s[84:87], s51 offen offset:1024 sc1
buffer_load_dwordx4 v[152:155], v6, s[84:87], s51 offen offset:2048 sc1
buffer_load_dwordx4 v[156:159], v6, s[84:87], s51 offen offset:3072 sc1
s_add_u32 s51, s56, 16384
s_and_b32 s51, s51, 0x7fff
s_add_u32 s51, s51, s50
buffer_load_dwordx4 v[160:163], v6, s[84:87], s51 offen offset:0 sc1
buffer_load_dwordx4 v[164:167], v6, s[84:87], s51 offen offset:1024 sc1
buffer_load_dwordx4 v[168:171], v6, s[84:87], s51 offen offset:2048 sc1
buffer_load_dwordx4 v[172:175], v6, s[84:87], s51 offen offset:3072 sc1
s_add_u32 s51, s56, 20480
s_and_b32 s51, s51, 0x7fff
s_add_u32 s51, s51, s50
buffer_load_dwordx4 v[176:179], v6, s[84:87], s51 offen offset:0 sc1
buffer_load_dwordx4 v[180:183], v6, s[84:87], s51 offen offset:1024 sc1
buffer_load_dwordx4 v[184:187], v6, s[84:87], s51 offen offset:2048 sc1
buffer_load_dwordx4 v[188:191], v6, s[84:87], s51 offen offset:3072 sc1
s_add_u32 s51, s56, 24576
s_and_b32 s51, s51, 0x7fff
s_add_u32 s51, s51, s50
buffer_load_dwordx4 v[192:195], v6, s[84:87], s51 offen offset:0 sc1
buffer_load_dwordx4 v[196:199], v6, s[84:87], s51 offen offset:1024 sc1
buffer_load_dwordx4 v[200:203], v6, s[84:87], s51 offen offset:2048 sc1
buffer_load_dwordx4 v[204:207], v6, s[84:87], s51 offen offset:3072 sc1
s_add_u32 s51, s56, 28672
s_and_b32 s51, s51, 0x7fff
s_add_u32 s51, s51, s50
buffer_load_dwordx4 v[208:211], v6, s[84:87], s51 offen offset:0 sc1
buffer_load_dwordx4 v[212:215], v6, s[84:87], s51 offen offset:1024 sc1
buffer_load_dwordx4 v[216:219], v6, s[84:87], s51 offen offset:2048 sc1
buffer_load_dwordx4 v[220:223], v6, s[84:87], s51 offen offset:3072 sc1
mega_kernel_o_w0:
s_add_u32 s54, s42, s71
s_sub_u32 s62, s42, s71
s_lshl_b32 s50, s54, 18
s_cmp_gt_i32 s52, s54
s_cbranch_scc0 mega_kernel_o_n0
s_waitcnt vmcnt(31)
v_mfma_f32_32x32x16_bf16 v[20:35], a[0:3], v[96:99], 0
v_mfma_f32_32x32x16_bf16 v[36:51], a[4:7], v[96:99], 0
s_add_u32 s51, s56, 0
s_and_b32 s51, s51, 0x7fff
s_add_u32 s51, s51, s50
buffer_load_dwordx4 v[96:99], v6, s[84:87], s51 offen offset:0 sc1
s_waitcnt vmcnt(31)
v_mfma_f32_32x32x16_bf16 v[20:35], a[8:11], v[100:103], v[20:35]
v_mfma_f32_32x32x16_bf16 v[36:51], a[12:15], v[100:103], v[36:51]
buffer_load_dwordx4 v[100:103], v6, s[84:87], s51 offen offset:1024 sc1
s_waitcnt vmcnt(31)
v_mfma_f32_32x32x16_bf16 v[20:35], a[16:19], v[104:107], v[20:35]
v_mfma_f32_32x32x16_bf16 v[36:51], a[20:23], v[104:107], v[36:51]
buffer_load_dwordx4 v[104:107], v6, s[84:87], s51 offen offset:2048 sc1
s_waitcnt vmcnt(31)
v_mfma_f32_32x32x16_bf16 v[20:35], a[24:27], v[108:111], v[20:35]
v_mfma_f32_32x32x16_bf16 v[36:51], a[28:31], v[108:111], v[36:51]
buffer_load_dwordx4 v[108:111], v6, s[84:87], s51 offen offset:3072 sc1
s_waitcnt vmcnt(31)
v_mfma_f32_32x32x16_bf16 v[20:35], a[32:35], v[112:115], v[20:35]
v_mfma_f32_32x32x16_bf16 v[36:51], a[36:39], v[112:115], v[36:51]
s_add_u32 s51, s56, 4096
s_and_b32 s51, s51, 0x7fff
s_add_u32 s51, s51, s50
buffer_load_dwordx4 v[112:115], v6, s[84:87], s51 offen offset:0 sc1
s_waitcnt vmcnt(31)
v_mfma_f32_32x32x16_bf16 v[20:35], a[40:43], v[116:119], v[20:35]
v_mfma_f32_32x32x16_bf16 v[36:51], a[44:47], v[116:119], v[36:51]
buffer_load_dwordx4 v[116:119], v6, s[84:87], s51 offen offset:1024 sc1
s_waitcnt vmcnt(31)
v_mfma_f32_32x32x16_bf16 v[20:35], a[48:51], v[120:123], v[20:35]
v_mfma_f32_32x32x16_bf16 v[36:51], a[52:55], v[120:123], v[36:51]
buffer_load_dwordx4 v[120:123], v6, s[84:87], s51 offen offset:2048 sc1
s_waitcnt vmcnt(31)
v_mfma_f32_32x32x16_bf16 v[20:35], a[56:59], v[124:127], v[20:35]
v_mfma_f32_32x32x16_bf16 v[36:51], a[60:63], v[124:127], v[36:51]
buffer_load_dwordx4 v[124:127], v6, s[84:87], s51 offen offset:3072 sc1
s_waitcnt vmcnt(31)
v_mfma_f32_32x32x16_bf16 v[20:35], a[64:67], v[128:131], v[20:35]
v_mfma_f32_32x32x16_bf16 v[36:51], a[68:71], v[128:131], v[36:51]
s_add_u32 s51, s56, 8192
s_and_b32 s51, s51, 0x7fff
s_add_u32 s51, s51, s50
buffer_load_dwordx4 v[128:131], v6, s[84:87], s51 offen offset:0 sc1
s_waitcnt vmcnt(31)
v_mfma_f32_32x32x16_bf16 v[20:35], a[72:75], v[132:135], v[20:35]
v_mfma_f32_32x32x16_bf16 v[36:51], a[76:79], v[132:135], v[36:51]
buffer_load_dwordx4 v[132:135], v6, s[84:87], s51 offen offset:1024 sc1
s_waitcnt vmcnt(31)
v_mfma_f32_32x32x16_bf16 v[20:35], a[80:83], v[136:139], v[20:35]
v_mfma_f32_32x32x16_bf16 v[36:51], a[84:87], v[136:139], v[36:51]
buffer_load_dwordx4 v[136:139], v6, s[84:87], s51 offen offset:2048 sc1
s_waitcnt vmcnt(31)
v_mfma_f32_32x32x16_bf16 v[20:35], a[88:91], v[140:143], v[20:35]
v_mfma_f32_32x32x16_bf16 v[36:51], a[92:95], v[140:143], v[36:51]
buffer_load_dwordx4 v[140:143], v6, s[84:87], s51 offen offset:3072 sc1
s_waitcnt vmcnt(31)
v_mfma_f32_32x32x16_bf16 v[20:35], a[96:99], v[144:147], v[20:35]
v_mfma_f32_32x32x16_bf16 v[36:51], a[100:103], v[144:147], v[36:51]
s_add_u32 s51, s56, 12288
s_and_b32 s51, s51, 0x7fff
s_add_u32 s51, s51, s50
buffer_load_dwordx4 v[144:147], v6, s[84:87], s51 offen offset:0 sc1
s_waitcnt vmcnt(31)
v_mfma_f32_32x32x16_bf16 v[20:35], a[104:107], v[148:151], v[20:35]
v_mfma_f32_32x32x16_bf16 v[36:51], a[108:111], v[148:151], v[36:51]
buffer_load_dwordx4 v[148:151], v6, s[84:87], s51 offen offset:1024 sc1
s_waitcnt vmcnt(31)
v_mfma_f32_32x32x16_bf16 v[20:35], a[112:115], v[152:155], v[20:35]
v_mfma_f32_32x32x16_bf16 v[36:51], a[116:119], v[152:155], v[36:51]
buffer_load_dwordx4 v[152:155], v6, s[84:87], s51 offen offset:2048 sc1
s_waitcnt vmcnt(31)
v_mfma_f32_32x32x16_bf16 v[20:35], a[120:123], v[156:159], v[20:35]
v_mfma_f32_32x32x16_bf16 v[36:51], a[124:127], v[156:159], v[36:51]
buffer_load_dwordx4 v[156:159], v6, s[84:87], s51 offen offset:3072 sc1
s_waitcnt vmcnt(31)
v_mfma_f32_32x32x16_bf16 v[20:35], a[128:131], v[160:163], v[20:35]
v_mfma_f32_32x32x16_bf16 v[36:51], a[132:135], v[160:163], v[36:51]
s_add_u32 s51, s56, 16384
s_and_b32 s51, s51, 0x7fff
s_add_u32 s51, s51, s50
buffer_load_dwordx4 v[160:163], v6, s[84:87], s51 offen offset:0 sc1
s_waitcnt vmcnt(31)
v_mfma_f32_32x32x16_bf16 v[20:35], a[136:139], v[164:167], v[20:35]
v_mfma_f32_32x32x16_bf16 v[36:51], a[140:143], v[164:167], v[36:51]
buffer_load_dwordx4 v[164:167], v6, s[84:87], s51 offen offset:1024 sc1
s_waitcnt vmcnt(31)
v_mfma_f32_32x32x16_bf16 v[20:35], a[144:147], v[168:171], v[20:35]
v_mfma_f32_32x32x16_bf16 v[36:51], a[148:151], v[168:171], v[36:51]
buffer_load_dwordx4 v[168:171], v6, s[84:87], s51 offen offset:2048 sc1
s_waitcnt vmcnt(31)
v_mfma_f32_32x32x16_bf16 v[20:35], a[152:155], v[172:175], v[20:35]
v_mfma_f32_32x32x16_bf16 v[36:51], a[156:159], v[172:175], v[36:51]
buffer_load_dwordx4 v[172:175], v6, s[84:87], s51 offen offset:3072 sc1
s_waitcnt vmcnt(31)
v_mfma_f32_32x32x16_bf16 v[20:35], a[160:163], v[176:179], v[20:35]
v_mfma_f32_32x32x16_bf16 v[36:51], a[164:167], v[176:179], v[36:51]
s_add_u32 s51, s56, 20480
s_and_b32 s51, s51, 0x7fff
s_add_u32 s51, s51, s50
buffer_load_dwordx4 v[176:179], v6, s[84:87], s51 offen offset:0 sc1
s_waitcnt vmcnt(31)
v_mfma_f32_32x32x16_bf16 v[20:35], a[168:171], v[180:183], v[20:35]
v_mfma_f32_32x32x16_bf16 v[36:51], a[172:175], v[180:183], v[36:51]
buffer_load_dwordx4 v[180:183], v6, s[84:87], s51 offen offset:1024 sc1
s_waitcnt vmcnt(31)
v_mfma_f32_32x32x16_bf16 v[20:35], a[176:179], v[184:187], v[20:35]
v_mfma_f32_32x32x16_bf16 v[36:51], a[180:183], v[184:187], v[36:51]
buffer_load_dwordx4 v[184:187], v6, s[84:87], s51 offen offset:2048 sc1
s_waitcnt vmcnt(31)
v_mfma_f32_32x32x16_bf16 v[20:35], a[184:187], v[188:191], v[20:35]
v_mfma_f32_32x32x16_bf16 v[36:51], a[188:191], v[188:191], v[36:51]
buffer_load_dwordx4 v[188:191], v6, s[84:87], s51 offen offset:3072 sc1
s_waitcnt vmcnt(31)
v_mfma_f32_32x32x16_bf16 v[20:35], a[192:195], v[192:195], v[20:35]
v_mfma_f32_32x32x16_bf16 v[36:51], a[196:199], v[192:195], v[36:51]
s_add_u32 s51, s56, 24576
s_and_b32 s51, s51, 0x7fff
s_add_u32 s51, s51, s50
buffer_load_dwordx4 v[192:195], v6, s[84:87], s51 offen offset:0 sc1
s_waitcnt vmcnt(31)
v_mfma_f32_32x32x16_bf16 v[20:35], a[200:203], v[196:199], v[20:35]
v_mfma_f32_32x32x16_bf16 v[36:51], a[204:207], v[196:199], v[36:51]
buffer_load_dwordx4 v[196:199], v6, s[84:87], s51 offen offset:1024 sc1
s_waitcnt vmcnt(31)
v_mfma_f32_32x32x16_bf16 v[20:35], a[208:211], v[200:203], v[20:35]
v_mfma_f32_32x32x16_bf16 v[36:51], a[212:215], v[200:203], v[36:51]
buffer_load_dwordx4 v[200:203], v6, s[84:87], s51 offen offset:2048 sc1
s_waitcnt vmcnt(31)
v_mfma_f32_32x32x16_bf16 v[20:35], a[216:219], v[204:207], v[20:35]
v_mfma_f32_32x32x16_bf16 v[36:51], a[220:223], v[204:207], v[36:51]
buffer_load_dwordx4 v[204:207], v6, s[84:87], s51 offen offset:3072 sc1
s_waitcnt vmcnt(31)
v_mfma_f32_32x32x16_bf16 v[20:35], a[224:227], v[208:211], v[20:35]
v_mfma_f32_32x32x16_bf16 v[36:51], a[228:231], v[208:211], v[36:51]
s_add_u32 s51, s56, 28672
s_and_b32 s51, s51, 0x7fff
s_add_u32 s51, s51, s50
buffer_load_dwordx4 v[208:211], v6, s[84:87], s51 offen offset:0 sc1
s_waitcnt vmcnt(31)
v_mfma_f32_32x32x16_bf16 v[20:35], a[232:235], v[212:215], v[20:35]
v_mfma_f32_32x32x16_bf16 v[36:51], a[236:239], v[212:215], v[36:51]
buffer_load_dwordx4 v[212:215], v6, s[84:87], s51 offen offset:1024 sc1
s_waitcnt vmcnt(31)
v_mfma_f32_32x32x16_bf16 v[20:35], a[240:243], v[216:219], v[20:35]
v_mfma_f32_32x32x16_bf16 v[36:51], a[244:247], v[216:219], v[36:51]
buffer_load_dwordx4 v[216:219], v6, s[84:87], s51 offen offset:2048 sc1
s_waitcnt vmcnt(31)
v_mfma_f32_32x32x16_bf16 v[224:239], a[248:251], v[220:223], v[20:35]
v_mfma_f32_32x32x16_bf16 v[240:255], a[252:255], v[220:223], v[36:51]
buffer_load_dwordx4 v[220:223], v6, s[84:87], s51 offen offset:3072 sc1
s_add_u32 s42, s42, s71
s_branch mega_kernel_o_w1
mega_kernel_o_n0:
s_waitcnt vmcnt(31)
v_mfma_f32_32x32x16_bf16 v[20:35], a[0:3], v[96:99], 0
v_mfma_f32_32x32x16_bf16 v[36:51], a[4:7], v[96:99], 0
s_waitcnt vmcnt(30)
v_mfma_f32_32x32x16_bf16 v[20:35], a[8:11], v[100:103], v[20:35]
v_mfma_f32_32x32x16_bf16 v[36:51], a[12:15], v[100:103], v[36:51]
s_waitcnt vmcnt(29)
v_mfma_f32_32x32x16_bf16 v[20:35], a[16:19], v[104:107], v[20:35]
v_mfma_f32_32x32x16_bf16 v[36:51], a[20:23], v[104:107], v[36:51]
s_waitcnt vmcnt(28)
v_mfma_f32_32x32x16_bf16 v[20:35], a[24:27], v[108:111], v[20:35]
v_mfma_f32_32x32x16_bf16 v[36:51], a[28:31], v[108:111], v[36:51]
s_waitcnt vmcnt(27)
v_mfma_f32_32x32x16_bf16 v[20:35], a[32:35], v[112:115], v[20:35]
v_mfma_f32_32x32x16_bf16 v[36:51], a[36:39], v[112:115], v[36:51]
s_waitcnt vmcnt(26)
v_mfma_f32_32x32x16_bf16 v[20:35], a[40:43], v[116:119], v[20:35]
v_mfma_f32_32x32x16_bf16 v[36:51], a[44:47], v[116:119], v[36:51]
s_waitcnt vmcnt(25)
v_mfma_f32_32x32x16_bf16 v[20:35], a[48:51], v[120:123], v[20:35]
v_mfma_f32_32x32x16_bf16 v[36:51], a[52:55], v[120:123], v[36:51]
s_waitcnt vmcnt(24)
v_mfma_f32_32x32x16_bf16 v[20:35], a[56:59], v[124:127], v[20:35]
v_mfma_f32_32x32x16_bf16 v[36:51], a[60:63], v[124:127], v[36:51]
s_waitcnt vmcnt(23)
v_mfma_f32_32x32x16_bf16 v[20:35], a[64:67], v[128:131], v[20:35]
v_mfma_f32_32x32x16_bf16 v[36:51], a[68:71], v[128:131], v[36:51]
s_waitcnt vmcnt(22)
v_mfma_f32_32x32x16_bf16 v[20:35], a[72:75], v[132:135], v[20:35]
v_mfma_f32_32x32x16_bf16 v[36:51], a[76:79], v[132:135], v[36:51]
s_waitcnt vmcnt(21)
v_mfma_f32_32x32x16_bf16 v[20:35], a[80:83], v[136:139], v[20:35]
v_mfma_f32_32x32x16_bf16 v[36:51], a[84:87], v[136:139], v[36:51]
s_waitcnt vmcnt(20)
v_mfma_f32_32x32x16_bf16 v[20:35], a[88:91], v[140:143], v[20:35]
v_mfma_f32_32x32x16_bf16 v[36:51], a[92:95], v[140:143], v[36:51]
s_waitcnt vmcnt(19)
v_mfma_f32_32x32x16_bf16 v[20:35], a[96:99], v[144:147], v[20:35]
v_mfma_f32_32x32x16_bf16 v[36:51], a[100:103], v[144:147], v[36:51]
s_waitcnt vmcnt(18)
v_mfma_f32_32x32x16_bf16 v[20:35], a[104:107], v[148:151], v[20:35]
v_mfma_f32_32x32x16_bf16 v[36:51], a[108:111], v[148:151], v[36:51]
s_waitcnt vmcnt(17)
v_mfma_f32_32x32x16_bf16 v[20:35], a[112:115], v[152:155], v[20:35]
v_mfma_f32_32x32x16_bf16 v[36:51], a[116:119], v[152:155], v[36:51]
s_waitcnt vmcnt(16)
v_mfma_f32_32x32x16_bf16 v[20:35], a[120:123], v[156:159], v[20:35]
v_mfma_f32_32x32x16_bf16 v[36:51], a[124:127], v[156:159], v[36:51]
s_waitcnt vmcnt(15)
v_mfma_f32_32x32x16_bf16 v[20:35], a[128:131], v[160:163], v[20:35]
v_mfma_f32_32x32x16_bf16 v[36:51], a[132:135], v[160:163], v[36:51]
s_waitcnt vmcnt(14)
v_mfma_f32_32x32x16_bf16 v[20:35], a[136:139], v[164:167], v[20:35]
v_mfma_f32_32x32x16_bf16 v[36:51], a[140:143], v[164:167], v[36:51]
s_waitcnt vmcnt(13)
v_mfma_f32_32x32x16_bf16 v[20:35], a[144:147], v[168:171], v[20:35]
v_mfma_f32_32x32x16_bf16 v[36:51], a[148:151], v[168:171], v[36:51]
s_waitcnt vmcnt(12)
v_mfma_f32_32x32x16_bf16 v[20:35], a[152:155], v[172:175], v[20:35]
v_mfma_f32_32x32x16_bf16 v[36:51], a[156:159], v[172:175], v[36:51]
s_waitcnt vmcnt(11)
v_mfma_f32_32x32x16_bf16 v[20:35], a[160:163], v[176:179], v[20:35]
v_mfma_f32_32x32x16_bf16 v[36:51], a[164:167], v[176:179], v[36:51]
buffer_load_dword v15, v7, s[84:87], 0 offen sc1
s_waitcnt vmcnt(10)
v_mfma_f32_32x32x16_bf16 v[20:35], a[168:171], v[180:183], v[20:35]
v_mfma_f32_32x32x16_bf16 v[36:51], a[172:175], v[180:183], v[36:51]
s_waitcnt vmcnt(9)
v_mfma_f32_32x32x16_bf16 v[20:35], a[176:179], v[184:187], v[20:35]
v_mfma_f32_32x32x16_bf16 v[36:51], a[180:183], v[184:187], v[36:51]
s_waitcnt vmcnt(8)
v_mfma_f32_32x32x16_bf16 v[20:35], a[184:187], v[188:191], v[20:35]
v_mfma_f32_32x32x16_bf16 v[36:51], a[188:191], v[188:191], v[36:51]
s_waitcnt vmcnt(7)
v_mfma_f32_32x32x16_bf16 v[20:35], a[192:195], v[192:195], v[20:35]
v_mfma_f32_32x32x16_bf16 v[36:51], a[196:199], v[192:195], v[36:51]
s_waitcnt vmcnt(6)
v_mfma_f32_32x32x16_bf16 v[20:35], a[200:203], v[196:199], v[20:35]
v_mfma_f32_32x32x16_bf16 v[36:51], a[204:207], v[196:199], v[36:51]
s_waitcnt vmcnt(5)
v_mfma_f32_32x32x16_bf16 v[20:35], a[208:211], v[200:203], v[20:35]
v_mfma_f32_32x32x16_bf16 v[36:51], a[212:215], v[200:203], v[36:51]
s_waitcnt vmcnt(4)
v_mfma_f32_32x32x16_bf16 v[20:35], a[216:219], v[204:207], v[20:35]
v_mfma_f32_32x32x16_bf16 v[36:51], a[220:223], v[204:207], v[36:51]
s_waitcnt vmcnt(3)
v_mfma_f32_32x32x16_bf16 v[20:35], a[224:227], v[208:211], v[20:35]
v_mfma_f32_32x32x16_bf16 v[36:51], a[228:231], v[208:211], v[36:51]
s_waitcnt vmcnt(2)
v_mfma_f32_32x32x16_bf16 v[20:35], a[232:235], v[212:215], v[20:35]
v_mfma_f32_32x32x16_bf16 v[36:51], a[236:239], v[212:215], v[36:51]
s_waitcnt vmcnt(1)
v_mfma_f32_32x32x16_bf16 v[20:35], a[240:243], v[216:219], v[20:35]
v_mfma_f32_32x32x16_bf16 v[36:51], a[244:247], v[216:219], v[36:51]
s_waitcnt vmcnt(0)
v_mfma_f32_32x32x16_bf16 v[224:239], a[248:251], v[220:223], v[20:35]
v_mfma_f32_32x32x16_bf16 v[240:255], a[252:255], v[220:223], v[36:51]
s_branch mega_kernel_o_imm
mega_kernel_o_w1:
s_add_u32 s54, s42, s71
s_sub_u32 s62, s42, s71
s_lshl_b32 s50, s54, 18
s_cmp_gt_i32 s52, s54
s_cbranch_scc0 mega_kernel_o_n1
s_waitcnt vmcnt(31)
v_mfma_f32_32x32x16_bf16 v[20:35], a[0:3], v[96:99], 0
v_mfma_f32_32x32x16_bf16 v[36:51], a[4:7], v[96:99], 0
s_add_u32 s51, s56, 0
s_and_b32 s51, s51, 0x7fff
s_add_u32 s51, s51, s50
buffer_load_dwordx4 v[96:99], v6, s[84:87], s51 offen offset:0 sc1
s_waitcnt vmcnt(31)
v_mfma_f32_32x32x16_bf16 v[20:35], a[8:11], v[100:103], v[20:35]
v_mfma_f32_32x32x16_bf16 v[36:51], a[12:15], v[100:103], v[36:51]
buffer_load_dwordx4 v[100:103], v6, s[84:87], s51 offen offset:1024 sc1
v_add_u32 v2, s53, v8
v_add_u32 v3, s53, v9
v_add_u32 v4, s53, v10
s_waitcnt vmcnt(31)
v_mfma_f32_32x32x16_bf16 v[20:35], a[16:19], v[104:107], v[20:35]
v_mfma_f32_32x32x16_bf16 v[36:51], a[20:23], v[104:107], v[36:51]
buffer_load_dwordx4 v[104:107], v6, s[84:87], s51 offen offset:2048 sc1
ds_write_b128 v2, v[224:227] offset:0
ds_write_b128 v2, v[228:231] offset:1088
s_waitcnt vmcnt(31)
v_mfma_f32_32x32x16_bf16 v[20:35], a[24:27], v[108:111], v[20:35]
v_mfma_f32_32x32x16_bf16 v[36:51], a[28:31], v[108:111], v[36:51]
buffer_load_dwordx4 v[108:111], v6, s[84:87], s51 offen offset:3072 sc1
ds_write_b128 v2, v[232:235] offset:2176
ds_write_b128 v2, v[236:239] offset:3264
s_waitcnt vmcnt(31)
v_mfma_f32_32x32x16_bf16 v[20:35], a[32:35], v[112:115], v[20:35]
v_mfma_f32_32x32x16_bf16 v[36:51], a[36:39], v[112:115], v[36:51]
s_add_u32 s51, s56, 4096
s_and_b32 s51, s51, 0x7fff
s_add_u32 s51, s51, s50
buffer_load_dwordx4 v[112:115], v6, s[84:87], s51 offen offset:0 sc1
ds_write_b128 v2, v[240:243] offset:4352
ds_write_b128 v2, v[244:247] offset:5440
s_waitcnt vmcnt(31)
v_mfma_f32_32x32x16_bf16 v[20:35], a[40:43], v[116:119], v[20:35]
v_mfma_f32_32x32x16_bf16 v[36:51], a[44:47], v[116:119], v[36:51]
buffer_load_dwordx4 v[116:119], v6, s[84:87], s51 offen offset:1024 sc1
ds_write_b128 v2, v[248:251] offset:6528
ds_write_b128 v2, v[252:255] offset:7616
s_waitcnt vmcnt(31)
v_mfma_f32_32x32x16_bf16 v[20:35], a[48:51], v[120:123], v[20:35]
v_mfma_f32_32x32x16_bf16 v[36:51], a[52:55], v[120:123], v[36:51]
buffer_load_dwordx4 v[120:123], v6, s[84:87], s51 offen offset:2048 sc1
s_waitcnt vmcnt(31)
v_mfma_f32_32x32x16_bf16 v[20:35], a[56:59], v[124:127], v[20:35]
v_mfma_f32_32x32x16_bf16 v[36:51], a[60:63], v[124:127], v[36:51]
buffer_load_dwordx4 v[124:127], v6, s[84:87], s51 offen offset:3072 sc1
s_waitcnt lgkmcnt(0)
s_barrier
ds_read_b128 v[52:55], v4 offset:0
ds_read_b128 v[56:59], v4 offset:8704
ds_read_b128 v[60:63], v4 offset:17408
ds_read_b128 v[64:67], v4 offset:26112
s_waitcnt vmcnt(31)
v_mfma_f32_32x32x16_bf16 v[20:35], a[64:67], v[128:131], v[20:35]
v_mfma_f32_32x32x16_bf16 v[36:51], a[68:71], v[128:131], v[36:51]
s_add_u32 s51, s56, 8192
s_and_b32 s51, s51, 0x7fff
s_add_u32 s51, s51, s50
buffer_load_dwordx4 v[128:131], v6, s[84:87], s51 offen offset:0 sc1
ds_read_b128 v[68:71], v3 offset:0
ds_read_b128 v[72:75], v3 offset:8704
ds_read_b128 v[76:79], v3 offset:17408
ds_read_b128 v[80:83], v3 offset:26112
s_sub_u32 s53, 34816, s53
s_sub_u32 s60, s62, s64
s_lshr_b32 s60, s60, s67
s_bfe_u32 s61, s60, 0x10001
s_and_b32 s60, s60, 1
s_lshl_b32 s60, s60, 12
s_waitcnt vmcnt(31)
v_mfma_f32_32x32x16_bf16 v[20:35], a[72:75], v[132:135], v[20:35]
v_mfma_f32_32x32x16_bf16 v[36:51], a[76:79], v[132:135], v[36:51]
buffer_load_dwordx4 v[132:135], v6, s[84:87], s51 offen offset:1024 sc1
s_waitcnt vmcnt(31)
v_mfma_f32_32x32x16_bf16 v[20:35], a[80:83], v[136:139], v[20:35]
v_mfma_f32_32x32x16_bf16 v[36:51], a[84:87], v[136:139], v[36:51]
buffer_load_dwordx4 v[136:139], v6, s[84:87], s51 offen offset:2048 sc1
s_waitcnt lgkmcnt(4)
v_add_f32 v52, v52, v56
v_add_f32 v60, v60, v64
v_add_f32 v53, v53, v57
v_add_f32 v61, v61, v65
v_add_f32 v54, v54, v58
v_add_f32 v62, v62, v66
v_add_f32 v55, v55, v59
v_add_f32 v63, v63, v67
s_waitcnt vmcnt(31)
v_mfma_f32_32x32x16_bf16 v[20:35], a[88:91], v[140:143], v[20:35]
v_mfma_f32_32x32x16_bf16 v[36:51], a[92:95], v[140:143], v[36:51]
buffer_load_dwordx4 v[140:143], v6, s[84:87], s51 offen offset:3072 sc1
v_add_f32 v52, v52, v60
v_add_f32 v53, v53, v61
v_add_f32 v54, v54, v62
v_add_f32 v55, v55, v63
v_and_or_b32 v52, v52, -2, s61
s_cmp_eq_u32 s95, 0
s_cbranch_scc1 mega_kernel_o_sa1
buffer_store_dwordx4 v[52:55], v12, s[84:87], s60 offen sc1
s_branch mega_kernel_o_sb1
mega_kernel_o_sa1:
buffer_store_dwordx4 v[52:55], v12, s[84:87], s60 offen
mega_kernel_o_sb1:
s_waitcnt vmcnt(31)
v_mfma_f32_32x32x16_bf16 v[20:35], a[96:99], v[144:147], v[20:35]
v_mfma_f32_32x32x16_bf16 v[36:51], a[100:103], v[144:147], v[36:51]
s_add_u32 s51, s56, 12288
s_and_b32 s51, s51, 0x7fff
s_add_u32 s51, s51, s50
buffer_load_dwordx4 v[144:147], v6, s[84:87], s51 offen offset:0 sc1
s_waitcnt lgkmcnt(0)
v_add_f32 v68, v68, v72
v_add_f32 v76, v76, v80
v_add_f32 v69, v69, v73
v_add_f32 v77, v77, v81
v_add_f32 v70, v70, v74
v_add_f32 v78, v78, v82
v_add_f32 v71, v71, v75
v_add_f32 v79, v79, v83
s_waitcnt vmcnt(31)
v_mfma_f32_32x32x16_bf16 v[20:35], a[104:107], v[148:151], v[20:35]
v_mfma_f32_32x32x16_bf16 v[36:51], a[108:111], v[148:151], v[36:51]
buffer_load_dwordx4 v[148:151], v6, s[84:87], s51 offen offset:1024 sc1
v_add_f32 v84, v68, v76
v_add_f32 v85, v69, v77
v_add_f32 v86, v70, v78
v_add_f32 v87, v71, v79
s_waitcnt vmcnt(31)
v_mfma_f32_32x32x16_bf16 v[20:35], a[112:115], v[152:155], v[20:35]
v_mfma_f32_32x32x16_bf16 v[36:51], a[116:119], v[152:155], v[36:51]
buffer_load_dwordx4 v[152:155], v6, s[84:87], s51 offen offset:2048 sc1
s_waitcnt vmcnt(31)
v_mfma_f32_32x32x16_bf16 v[20:35], a[120:123], v[156:159], v[20:35]
v_mfma_f32_32x32x16_bf16 v[36:51], a[124:127], v[156:159], v[36:51]
buffer_load_dwordx4 v[156:159], v6, s[84:87], s51 offen offset:3072 sc1
s_waitcnt vmcnt(31)
v_mfma_f32_32x32x16_bf16 v[20:35], a[128:131], v[160:163], v[20:35]
v_mfma_f32_32x32x16_bf16 v[36:51], a[132:135], v[160:163], v[36:51]
s_add_u32 s51, s56, 16384
s_and_b32 s51, s51, 0x7fff
s_add_u32 s51, s51, s50
buffer_load_dwordx4 v[160:163], v6, s[84:87], s51 offen offset:0 sc1
s_waitcnt vmcnt(31)
v_mfma_f32_32x32x16_bf16 v[20:35], a[136:139], v[164:167], v[20:35]
v_mfma_f32_32x32x16_bf16 v[36:51], a[140:143], v[164:167], v[36:51]
buffer_load_dwordx4 v[164:167], v6, s[84:87], s51 offen offset:1024 sc1
s_waitcnt vmcnt(31)
v_mfma_f32_32x32x16_bf16 v[20:35], a[144:147], v[168:171], v[20:35]
v_mfma_f32_32x32x16_bf16 v[36:51], a[148:151], v[168:171], v[36:51]
buffer_load_dwordx4 v[168:171], v6, s[84:87], s51 offen offset:2048 sc1
s_waitcnt vmcnt(31)
v_mfma_f32_32x32x16_bf16 v[20:35], a[152:155], v[172:175], v[20:35]
v_mfma_f32_32x32x16_bf16 v[36:51], a[156:159], v[172:175], v[36:51]
buffer_load_dwordx4 v[172:175], v6, s[84:87], s51 offen offset:3072 sc1
s_waitcnt vmcnt(31)
v_mfma_f32_32x32x16_bf16 v[20:35], a[160:163], v[176:179], v[20:35]
v_mfma_f32_32x32x16_bf16 v[36:51], a[164:167], v[176:179], v[36:51]
s_add_u32 s51, s56, 20480
s_and_b32 s51, s51, 0x7fff
s_add_u32 s51, s51, s50
buffer_load_dwordx4 v[176:179], v6, s[84:87], s51 offen offset:0 sc1
s_waitcnt vmcnt(31)
v_mfma_f32_32x32x16_bf16 v[20:35], a[168:171], v[180:183], v[20:35]
v_mfma_f32_32x32x16_bf16 v[36:51], a[172:175], v[180:183], v[36:51]
buffer_load_dwordx4 v[180:183], v6, s[84:87], s51 offen offset:1024 sc1
s_waitcnt vmcnt(31)
v_mfma_f32_32x32x16_bf16 v[20:35], a[176:179], v[184:187], v[20:35]
v_mfma_f32_32x32x16_bf16 v[36:51], a[180:183], v[184:187], v[36:51]
buffer_load_dwordx4 v[184:187], v6, s[84:87], s51 offen offset:2048 sc1
s_waitcnt vmcnt(31)
v_mfma_f32_32x32x16_bf16 v[20:35], a[184:187], v[188:191], v[20:35]
v_mfma_f32_32x32x16_bf16 v[36:51], a[188:191], v[188:191], v[36:51]
buffer_load_dwordx4 v[188:191], v6, s[84:87], s51 offen offset:3072 sc1
s_waitcnt vmcnt(31)
v_mfma_f32_32x32x16_bf16 v[20:35], a[192:195], v[192:195], v[20:35]
v_mfma_f32_32x32x16_bf16 v[36:51], a[196:199], v[192:195], v[36:51]
s_add_u32 s51, s56, 24576
s_and_b32 s51, s51, 0x7fff
s_add_u32 s51, s51, s50
buffer_load_dwordx4 v[192:195], v6, s[84:87], s51 offen offset:0 sc1
s_waitcnt vmcnt(31)
v_mfma_f32_32x32x16_bf16 v[20:35], a[200:203], v[196:199], v[20:35]
v_mfma_f32_32x32x16_bf16 v[36:51], a[204:207], v[196:199], v[36:51]
buffer_load_dwordx4 v[196:199], v6, s[84:87], s51 offen offset:1024 sc1
s_waitcnt vmcnt(31)
v_mfma_f32_32x32x16_bf16 v[20:35], a[208:211], v[200:203], v[20:35]
v_mfma_f32_32x32x16_bf16 v[36:51], a[212:215], v[200:203], v[36:51]
buffer_load_dwordx4 v[200:203], v6, s[84:87], s51 offen offset:2048 sc1
s_waitcnt vmcnt(31)
v_mfma_f32_32x32x16_bf16 v[20:35], a[216:219], v[204:207], v[20:35]
v_mfma_f32_32x32x16_bf16 v[36:51], a[220:223], v[204:207], v[36:51]
buffer_load_dwordx4 v[204:207], v6, s[84:87], s51 offen offset:3072 sc1
s_sub_u32 s60, s62, s64
s_lshr_b32 s60, s60, s67
s_bfe_u32 s61, s60, 0x10001
s_and_b32 s60, s60, 1
s_lshl_b32 s60, s60, 12
buffer_load_dwordx4 v[88:91], v13, s[84:87], s60 offen sc1
s_waitcnt vmcnt(31)
v_mfma_f32_32x32x16_bf16 v[20:35], a[224:227], v[208:211], v[20:35]
v_mfma_f32_32x32x16_bf16 v[36:51], a[228:231], v[208:211], v[36:51]
s_add_u32 s51, s56, 28672
s_and_b32 s51, s51, 0x7fff
s_add_u32 s51, s51, s50
buffer_load_dwordx4 v[208:211], v6, s[84:87], s51 offen offset:0 sc1
s_waitcnt vmcnt(31)
v_mfma_f32_32x32x16_bf16 v[20:35], a[232:235], v[212:215], v[20:35]
v_mfma_f32_32x32x16_bf16 v[36:51], a[236:239], v[212:215], v[36:51]
buffer_load_dwordx4 v[212:215], v6, s[84:87], s51 offen offset:1024 sc1
s_waitcnt vmcnt(31)
v_mfma_f32_32x32x16_bf16 v[20:35], a[240:243], v[216:219], v[20:35]
v_mfma_f32_32x32x16_bf16 v[36:51], a[244:247], v[216:219], v[36:51]
buffer_load_dwordx4 v[216:219], v6, s[84:87], s51 offen offset:2048 sc1
s_waitcnt vmcnt(31)
v_mfma_f32_32x32x16_bf16 v[224:239], a[248:251], v[220:223], v[20:35]
v_mfma_f32_32x32x16_bf16 v[240:255], a[252:255], v[220:223], v[36:51]
buffer_load_dwordx4 v[220:223], v6, s[84:87], s51 offen offset:3072 sc1
s_waitcnt vmcnt(4)
mega_kernel_o_f1c:
v_and_b32 v14, 1, v88
v_cmp_ne_u32 vcc, s61, v14
s_cbranch_vccz mega_kernel_o_f1k
s_sub_u32 s60, s62, s64
s_lshr_b32 s60, s60, s67
s_bfe_u32 s61, s60, 0x10001
s_and_b32 s60, s60, 1
s_lshl_b32 s60, s60, 12
buffer_load_dwordx4 v[88:91], v13, s[84:87], s60 offen sc1
s_waitcnt vmcnt(0)
s_branch mega_kernel_o_f1c
mega_kernel_o_f1k:
v_pk_add_f32 v[88:89], v[88:89], v[84:85]
v_pk_add_f32 v[90:91], v[90:91], v[86:87]
s_lshl_b32 s60, s62, 17
v_cvt_pk_bf16_f32 v92, v88, v89
v_cvt_pk_bf16_f32 v93, v90, v91
buffer_store_dwordx2 v[92:93], v11, s[8:11], s60 offen sc1
s_add_u32 s42, s42, s71
s_branch mega_kernel_o_w1
mega_kernel_o_n1:
s_waitcnt vmcnt(31)
v_mfma_f32_32x32x16_bf16 v[20:35], a[0:3], v[96:99], 0
v_mfma_f32_32x32x16_bf16 v[36:51], a[4:7], v[96:99], 0
s_waitcnt vmcnt(30)
v_mfma_f32_32x32x16_bf16 v[20:35], a[8:11], v[100:103], v[20:35]
v_mfma_f32_32x32x16_bf16 v[36:51], a[12:15], v[100:103], v[36:51]
v_add_u32 v2, s53, v8
v_add_u32 v3, s53, v9
v_add_u32 v4, s53, v10
s_waitcnt vmcnt(29)
v_mfma_f32_32x32x16_bf16 v[20:35], a[16:19], v[104:107], v[20:35]
v_mfma_f32_32x32x16_bf16 v[36:51], a[20:23], v[104:107], v[36:51]
ds_write_b128 v2, v[224:227] offset:0
ds_write_b128 v2, v[228:231] offset:1088
s_waitcnt vmcnt(28)
v_mfma_f32_32x32x16_bf16 v[20:35], a[24:27], v[108:111], v[20:35]
v_mfma_f32_32x32x16_bf16 v[36:51], a[28:31], v[108:111], v[36:51]
ds_write_b128 v2, v[232:235] offset:2176
ds_write_b128 v2, v[236:239] offset:3264
s_waitcnt vmcnt(27)
v_mfma_f32_32x32x16_bf16 v[20:35], a[32:35], v[112:115], v[20:35]
v_mfma_f32_32x32x16_bf16 v[36:51], a[36:39], v[112:115], v[36:51]
ds_write_b128 v2, v[240:243] offset:4352
ds_write_b128 v2, v[244:247] offset:5440
s_waitcnt vmcnt(26)
v_mfma_f32_32x32x16_bf16 v[20:35], a[40:43], v[116:119], v[20:35]
v_mfma_f32_32x32x16_bf16 v[36:51], a[44:47], v[116:119], v[36:51]
ds_write_b128 v2, v[248:251] offset:6528
ds_write_b128 v2, v[252:255] offset:7616
s_waitcnt vmcnt(25)
v_mfma_f32_32x32x16_bf16 v[20:35], a[48:51], v[120:123], v[20:35]
v_mfma_f32_32x32x16_bf16 v[36:51], a[52:55], v[120:123], v[36:51]
s_waitcnt vmcnt(24)
v_mfma_f32_32x32x16_bf16 v[20:35], a[56:59], v[124:127], v[20:35]
v_mfma_f32_32x32x16_bf16 v[36:51], a[60:63], v[124:127], v[36:51]
s_waitcnt lgkmcnt(0)
s_barrier
ds_read_b128 v[52:55], v4 offset:0
ds_read_b128 v[56:59], v4 offset:8704
ds_read_b128 v[60:63], v4 offset:17408
ds_read_b128 v[64:67], v4 offset:26112
s_waitcnt vmcnt(23)
v_mfma_f32_32x32x16_bf16 v[20:35], a[64:67], v[128:131], v[20:35]
v_mfma_f32_32x32x16_bf16 v[36:51], a[68:71], v[128:131], v[36:51]
ds_read_b128 v[68:71], v3 offset:0
ds_read_b128 v[72:75], v3 offset:8704
ds_read_b128 v[76:79], v3 offset:17408
ds_read_b128 v[80:83], v3 offset:26112
s_sub_u32 s53, 34816, s53
s_sub_u32 s60, s62, s64
s_lshr_b32 s60, s60, s67
s_bfe_u32 s61, s60, 0x10001
s_and_b32 s60, s60, 1
s_lshl_b32 s60, s60, 12
s_waitcnt vmcnt(22)
v_mfma_f32_32x32x16_bf16 v[20:35], a[72:75], v[132:135], v[20:35]
v_mfma_f32_32x32x16_bf16 v[36:51], a[76:79], v[132:135], v[36:51]
s_waitcnt vmcnt(21)
v_mfma_f32_32x32x16_bf16 v[20:35], a[80:83], v[136:139], v[20:35]
v_mfma_f32_32x32x16_bf16 v[36:51], a[84:87], v[136:139], v[36:51]
s_waitcnt lgkmcnt(4)
v_add_f32 v52, v52, v56
v_add_f32 v60, v60, v64
v_add_f32 v53, v53, v57
v_add_f32 v61, v61, v65
v_add_f32 v54, v54, v58
v_add_f32 v62, v62, v66
v_add_f32 v55, v55, v59
v_add_f32 v63, v63, v67
s_waitcnt vmcnt(20)
v_mfma_f32_32x32x16_bf16 v[20:35], a[88:91], v[140:143], v[20:35]
v_mfma_f32_32x32x16_bf16 v[36:51], a[92:95], v[140:143], v[36:51]
v_add_f32 v52, v52, v60
v_add_f32 v53, v53, v61
v_add_f32 v54, v54, v62
v_add_f32 v55, v55, v63
v_and_or_b32 v52, v52, -2, s61
s_cmp_eq_u32 s95, 0
s_cbranch_scc1 mega_kernel_o_sa2
buffer_store_dwordx4 v[52:55], v12, s[84:87], s60 offen sc1
s_branch mega_kernel_o_sb2
mega_kernel_o_sa2:
buffer_store_dwordx4 v[52:55], v12, s[84:87], s60 offen
mega_kernel_o_sb2:
s_waitcnt vmcnt(19)
v_mfma_f32_32x32x16_bf16 v[20:35], a[96:99], v[144:147], v[20:35]
v_mfma_f32_32x32x16_bf16 v[36:51], a[100:103], v[144:147], v[36:51]
s_waitcnt lgkmcnt(0)
v_add_f32 v68, v68, v72
v_add_f32 v76, v76, v80
v_add_f32 v69, v69, v73
v_add_f32 v77, v77, v81
v_add_f32 v70, v70, v74
v_add_f32 v78, v78, v82
v_add_f32 v71, v71, v75
v_add_f32 v79, v79, v83
s_waitcnt vmcnt(18)
v_mfma_f32_32x32x16_bf16 v[20:35], a[104:107], v[148:151], v[20:35]
v_mfma_f32_32x32x16_bf16 v[36:51], a[108:111], v[148:151], v[36:51]
v_add_f32 v84, v68, v76
v_add_f32 v85, v69, v77
v_add_f32 v86, v70, v78
v_add_f32 v87, v71, v79
s_waitcnt vmcnt(17)
v_mfma_f32_32x32x16_bf16 v[20:35], a[112:115], v[152:155], v[20:35]
v_mfma_f32_32x32x16_bf16 v[36:51], a[116:119], v[152:155], v[36:51]
s_waitcnt vmcnt(16)
v_mfma_f32_32x32x16_bf16 v[20:35], a[120:123], v[156:159], v[20:35]
v_mfma_f32_32x32x16_bf16 v[36:51], a[124:127], v[156:159], v[36:51]
s_waitcnt vmcnt(15)
v_mfma_f32_32x32x16_bf16 v[20:35], a[128:131], v[160:163], v[20:35]
v_mfma_f32_32x32x16_bf16 v[36:51], a[132:135], v[160:163], v[36:51]
s_waitcnt vmcnt(14)
v_mfma_f32_32x32x16_bf16 v[20:35], a[136:139], v[164:167], v[20:35]
v_mfma_f32_32x32x16_bf16 v[36:51], a[140:143], v[164:167], v[36:51]
s_waitcnt vmcnt(13)
v_mfma_f32_32x32x16_bf16 v[20:35], a[144:147], v[168:171], v[20:35]
v_mfma_f32_32x32x16_bf16 v[36:51], a[148:151], v[168:171], v[36:51]
s_waitcnt vmcnt(12)
v_mfma_f32_32x32x16_bf16 v[20:35], a[152:155], v[172:175], v[20:35]
v_mfma_f32_32x32x16_bf16 v[36:51], a[156:159], v[172:175], v[36:51]
s_waitcnt vmcnt(11)
v_mfma_f32_32x32x16_bf16 v[20:35], a[160:163], v[176:179], v[20:35]
v_mfma_f32_32x32x16_bf16 v[36:51], a[164:167], v[176:179], v[36:51]
buffer_load_dword v15, v7, s[84:87], 0 offen sc1
s_waitcnt vmcnt(10)
v_mfma_f32_32x32x16_bf16 v[20:35], a[168:171], v[180:183], v[20:35]
v_mfma_f32_32x32x16_bf16 v[36:51], a[172:175], v[180:183], v[36:51]
s_waitcnt vmcnt(9)
v_mfma_f32_32x32x16_bf16 v[20:35], a[176:179], v[184:187], v[20:35]
v_mfma_f32_32x32x16_bf16 v[36:51], a[180:183], v[184:187], v[36:51]
s_waitcnt vmcnt(8)
v_mfma_f32_32x32x16_bf16 v[20:35], a[184:187], v[188:191], v[20:35]
v_mfma_f32_32x32x16_bf16 v[36:51], a[188:191], v[188:191], v[36:51]
s_waitcnt vmcnt(7)
v_mfma_f32_32x32x16_bf16 v[20:35], a[192:195], v[192:195], v[20:35]
v_mfma_f32_32x32x16_bf16 v[36:51], a[196:199], v[192:195], v[36:51]
s_waitcnt vmcnt(6)
v_mfma_f32_32x32x16_bf16 v[20:35], a[200:203], v[196:199], v[20:35]
v_mfma_f32_32x32x16_bf16 v[36:51], a[204:207], v[196:199], v[36:51]
s_waitcnt vmcnt(5)
v_mfma_f32_32x32x16_bf16 v[20:35], a[208:211], v[200:203], v[20:35]
v_mfma_f32_32x32x16_bf16 v[36:51], a[212:215], v[200:203], v[36:51]
s_waitcnt vmcnt(4)
v_mfma_f32_32x32x16_bf16 v[20:35], a[216:219], v[204:207], v[20:35]
v_mfma_f32_32x32x16_bf16 v[36:51], a[220:223], v[204:207], v[36:51]
s_sub_u32 s60, s62, s64
s_lshr_b32 s60, s60, s67
s_bfe_u32 s61, s60, 0x10001
s_and_b32 s60, s60, 1
s_lshl_b32 s60, s60, 12
buffer_load_dwordx4 v[88:91], v13, s[84:87], s60 offen sc1
s_waitcnt vmcnt(3)
v_mfma_f32_32x32x16_bf16 v[20:35], a[224:227], v[208:211], v[20:35]
v_mfma_f32_32x32x16_bf16 v[36:51], a[228:231], v[208:211], v[36:51]
s_waitcnt vmcnt(2)
v_mfma_f32_32x32x16_bf16 v[20:35], a[232:235], v[212:215], v[20:35]
v_mfma_f32_32x32x16_bf16 v[36:51], a[236:239], v[212:215], v[36:51]
s_waitcnt vmcnt(1)
v_mfma_f32_32x32x16_bf16 v[20:35], a[240:243], v[216:219], v[20:35]
v_mfma_f32_32x32x16_bf16 v[36:51], a[244:247], v[216:219], v[36:51]
s_waitcnt vmcnt(0)
v_mfma_f32_32x32x16_bf16 v[224:239], a[248:251], v[220:223], v[20:35]
v_mfma_f32_32x32x16_bf16 v[240:255], a[252:255], v[220:223], v[36:51]
s_waitcnt vmcnt(0)
mega_kernel_o_f0c:
v_and_b32 v14, 1, v88
v_cmp_ne_u32 vcc, s61, v14
s_cbranch_vccz mega_kernel_o_f0k
s_sub_u32 s60, s62, s64
s_lshr_b32 s60, s60, s67
s_bfe_u32 s61, s60, 0x10001
s_and_b32 s60, s60, 1
s_lshl_b32 s60, s60, 12
buffer_load_dwordx4 v[88:91], v13, s[84:87], s60 offen sc1
s_waitcnt vmcnt(0)
s_branch mega_kernel_o_f0c
mega_kernel_o_f0k:
v_pk_add_f32 v[88:89], v[88:89], v[84:85]
v_pk_add_f32 v[90:91], v[90:91], v[86:87]
s_lshl_b32 s60, s62, 17
v_cvt_pk_bf16_f32 v92, v88, v89
v_cvt_pk_bf16_f32 v93, v90, v91
buffer_store_dwordx2 v[92:93], v11, s[8:11], s60 offen sc1
mega_kernel_o_imm:
s_waitcnt vmcnt(1)
v_min_i32_dpp v15, v15, v15 quad_perm:[1,0,3,2] row_mask:0xf bank_mask:0xf
s_nop 1
v_min_i32_dpp v15, v15, v15 quad_perm:[2,3,0,1] row_mask:0xf bank_mask:0xf
s_nop 1
v_min_i32_dpp v15, v15, v15 row_ror:4 row_mask:0xf bank_mask:0xf
s_nop 1
v_min_i32_dpp v15, v15, v15 row_ror:8 row_mask:0xf bank_mask:0xf
s_nop 0
v_readfirstlane_b32 s52, v15
s_min_i32 s52, s52, s65
s_cmp_gt_i32 s52, s54
s_cbranch_scc0 mega_kernel_o_im2
s_add_u32 s42, s42, s71
s_add_u32 s54, s54, s71
s_cmp_gt_i32 s52, s54
s_cbranch_scc0 mega_kernel_o_c1
s_add_u32 s51, s56, 0
s_and_b32 s51, s51, 0x7fff
s_add_u32 s51, s51, s50
buffer_load_dwordx4 v[96:99], v6, s[84:87], s51 offen offset:0 sc1
buffer_load_dwordx4 v[100:103], v6, s[84:87], s51 offen offset:1024 sc1
buffer_load_dwordx4 v[104:107], v6, s[84:87], s51 offen offset:2048 sc1
buffer_load_dwordx4 v[108:111], v6, s[84:87], s51 offen offset:3072 sc1
s_add_u32 s51, s56, 4096
s_and_b32 s51, s51, 0x7fff
s_add_u32 s51, s51, s50
buffer_load_dwordx4 v[112:115], v6, s[84:87], s51 offen offset:0 sc1
buffer_load_dwordx4 v[116:119], v6, s[84:87], s51 offen offset:1024 sc1
buffer_load_dwordx4 v[120:123], v6, s[84:87], s51 offen offset:2048 sc1
buffer_load_dwordx4 v[124:127], v6, s[84:87], s51 offen offset:3072 sc1
s_add_u32 s51, s56, 8192
s_and_b32 s51, s51, 0x7fff
s_add_u32 s51, s51, s50
buffer_load_dwordx4 v[128:131], v6, s[84:87], s51 offen offset:0 sc1
buffer_load_dwordx4 v[132:135], v6, s[84:87], s51 offen offset:1024 sc1
buffer_load_dwordx4 v[136:139], v6, s[84:87], s51 offen offset:2048 sc1
buffer_load_dwordx4 v[140:143], v6, s[84:87], s51 offen offset:3072 sc1
s_add_u32 s51, s56, 12288
s_and_b32 s51, s51, 0x7fff
s_add_u32 s51, s51, s50
buffer_load_dwordx4 v[144:147], v6, s[84:87], s51 offen offset:0 sc1
buffer_load_dwordx4 v[148:151], v6, s[84:87], s51 offen offset:1024 sc1
buffer_load_dwordx4 v[152:155], v6, s[84:87], s51 offen offset:2048 sc1
buffer_load_dwordx4 v[156:159], v6, s[84:87], s51 offen offset:3072 sc1
s_add_u32 s51, s56, 16384
s_and_b32 s51, s51, 0x7fff
s_add_u32 s51, s51, s50
buffer_load_dwordx4 v[160:163], v6, s[84:87], s51 offen offset:0 sc1
buffer_load_dwordx4 v[164:167], v6, s[84:87], s51 offen offset:1024 sc1
buffer_load_dwordx4 v[168:171], v6, s[84:87], s51 offen offset:2048 sc1
buffer_load_dwordx4 v[172:175], v6, s[84:87], s51 offen offset:3072 sc1
s_add_u32 s51, s56, 20480
s_and_b32 s51, s51, 0x7fff
s_add_u32 s51, s51, s50
buffer_load_dwordx4 v[176:179], v6, s[84:87], s51 offen offset:0 sc1
buffer_load_dwordx4 v[180:183], v6, s[84:87], s51 offen offset:1024 sc1
buffer_load_dwordx4 v[184:187], v6, s[84:87], s51 offen offset:2048 sc1
buffer_load_dwordx4 v[188:191], v6, s[84:87], s51 offen offset:3072 sc1
s_add_u32 s51, s56, 24576
s_and_b32 s51, s51, 0x7fff
s_add_u32 s51, s51, s50
buffer_load_dwordx4 v[192:195], v6, s[84:87], s51 offen offset:0 sc1
buffer_load_dwordx4 v[196:199], v6, s[84:87], s51 offen offset:1024 sc1
buffer_load_dwordx4 v[200:203], v6, s[84:87], s51 offen offset:2048 sc1
buffer_load_dwordx4 v[204:207], v6, s[84:87], s51 offen offset:3072 sc1
s_add_u32 s51, s56, 28672
s_and_b32 s51, s51, 0x7fff
s_add_u32 s51, s51, s50
buffer_load_dwordx4 v[208:211], v6, s[84:87], s51 offen offset:0 sc1
buffer_load_dwordx4 v[212:215], v6, s[84:87], s51 offen offset:1024 sc1
buffer_load_dwordx4 v[216:219], v6, s[84:87], s51 offen offset:2048 sc1
buffer_load_dwordx4 v[220:223], v6, s[84:87], s51 offen offset:3072 sc1
s_branch mega_kernel_o_w1
mega_kernel_o_c0:
s_add_u32 s54, s42, s71
s_sub_u32 s62, s42, s71
s_lshl_b32 s50, s42, 18
s_add_u32 s51, s56, 0
s_and_b32 s51, s51, 0x7fff
s_add_u32 s51, s51, s50
buffer_load_dwordx4 v[96:99], v6, s[84:87], s51 offen offset:0 sc1
buffer_load_dwordx4 v[100:103], v6, s[84:87], s51 offen offset:1024 sc1
buffer_load_dwordx4 v[104:107], v6, s[84:87], s51 offen offset:2048 sc1
buffer_load_dwordx4 v[108:111], v6, s[84:87], s51 offen offset:3072 sc1
s_add_u32 s51, s56, 4096
s_and_b32 s51, s51, 0x7fff
s_add_u32 s51, s51, s50
buffer_load_dwordx4 v[112:115], v6, s[84:87], s51 offen offset:0 sc1
buffer_load_dwordx4 v[116:119], v6, s[84:87], s51 offen offset:1024 sc1
buffer_load_dwordx4 v[120:123], v6, s[84:87], s51 offen offset:2048 sc1
buffer_load_dwordx4 v[124:127], v6, s[84:87], s51 offen offset:3072 sc1
s_waitcnt vmcnt(7)
v_mfma_f32_32x32x16_bf16 v[20:35], a[0:3], v[96:99], 0
v_mfma_f32_32x32x16_bf16 v[36:51], a[4:7], v[96:99], 0
s_add_u32 s51, s56, 8192
s_and_b32 s51, s51, 0x7fff
s_add_u32 s51, s51, s50
buffer_load_dwordx4 v[128:131], v6, s[84:87], s51 offen offset:0 sc1
s_waitcnt vmcnt(7)
v_mfma_f32_32x32x16_bf16 v[20:35], a[8:11], v[100:103], v[20:35]
v_mfma_f32_32x32x16_bf16 v[36:51], a[12:15], v[100:103], v[36:51]
buffer_load_dwordx4 v[132:135], v6, s[84:87], s51 offen offset:1024 sc1
s_waitcnt vmcnt(7)
v_mfma_f32_32x32x16_bf16 v[20:35], a[16:19], v[104:107], v[20:35]
v_mfma_f32_32x32x16_bf16 v[36:51], a[20:23], v[104:107], v[36:51]
buffer_load_dwordx4 v[136:139], v6, s[84:87], s51 offen offset:2048 sc1
s_waitcnt vmcnt(7)
v_mfma_f32_32x32x16_bf16 v[20:35], a[24:27], v[108:111], v[20:35]
v_mfma_f32_32x32x16_bf16 v[36:51], a[28:31], v[108:111], v[36:51]
buffer_load_dwordx4 v[140:143], v6, s[84:87], s51 offen offset:3072 sc1
s_waitcnt vmcnt(7)
v_mfma_f32_32x32x16_bf16 v[20:35], a[32:35], v[112:115], v[20:35]
v_mfma_f32_32x32x16_bf16 v[36:51], a[36:39], v[112:115], v[36:51]
s_add_u32 s51, s56, 12288
s_and_b32 s51, s51, 0x7fff
s_add_u32 s51, s51, s50
buffer_load_dwordx4 v[144:147], v6, s[84:87], s51 offen offset:0 sc1
s_waitcnt vmcnt(7)
v_mfma_f32_32x32x16_bf16 v[20:35], a[40:43], v[116:119], v[20:35]
v_mfma_f32_32x32x16_bf16 v[36:51], a[44:47], v[116:119], v[36:51]
buffer_load_dwordx4 v[148:151], v6, s[84:87], s51 offen offset:1024 sc1
s_waitcnt vmcnt(7)
v_mfma_f32_32x32x16_bf16 v[20:35], a[48:51], v[120:123], v[20:35]
v_mfma_f32_32x32x16_bf16 v[36:51], a[52:55], v[120:123], v[36:51]
buffer_load_dwordx4 v[152:155], v6, s[84:87], s51 offen offset:2048 sc1
s_waitcnt vmcnt(7)
v_mfma_f32_32x32x16_bf16 v[20:35], a[56:59], v[124:127], v[20:35]
v_mfma_f32_32x32x16_bf16 v[36:51], a[60:63], v[124:127], v[36:51]
buffer_load_dwordx4 v[156:159], v6, s[84:87], s51 offen offset:3072 sc1
s_waitcnt vmcnt(7)
v_mfma_f32_32x32x16_bf16 v[20:35], a[64:67], v[128:131], v[20:35]
v_mfma_f32_32x32x16_bf16 v[36:51], a[68:71], v[128:131], v[36:51]
s_add_u32 s51, s56, 16384
s_and_b32 s51, s51, 0x7fff
s_add_u32 s51, s51, s50
buffer_load_dwordx4 v[160:163], v6, s[84:87], s51 offen offset:0 sc1
s_waitcnt vmcnt(7)
v_mfma_f32_32x32x16_bf16 v[20:35], a[72:75], v[132:135], v[20:35]
v_mfma_f32_32x32x16_bf16 v[36:51], a[76:79], v[132:135], v[36:51]
buffer_load_dwordx4 v[164:167], v6, s[84:87], s51 offen offset:1024 sc1
s_waitcnt vmcnt(7)
v_mfma_f32_32x32x16_bf16 v[20:35], a[80:83], v[136:139], v[20:35]
v_mfma_f32_32x32x16_bf16 v[36:51], a[84:87], v[136:139], v[36:51]
buffer_load_dwordx4 v[168:171], v6, s[84:87], s51 offen offset:2048 sc1
s_waitcnt vmcnt(7)
v_mfma_f32_32x32x16_bf16 v[20:35], a[88:91], v[140:143], v[20:35]
v_mfma_f32_32x32x16_bf16 v[36:51], a[92:95], v[140:143], v[36:51]
buffer_load_dwordx4 v[172:175], v6, s[84:87], s51 offen offset:3072 sc1
s_waitcnt vmcnt(7)
v_mfma_f32_32x32x16_bf16 v[20:35], a[96:99], v[144:147], v[20:35]
v_mfma_f32_32x32x16_bf16 v[36:51], a[100:103], v[144:147], v[36:51]
s_add_u32 s51, s56, 20480
s_and_b32 s51, s51, 0x7fff
s_add_u32 s51, s51, s50
buffer_load_dwordx4 v[176:179], v6, s[84:87], s51 offen offset:0 sc1
s_waitcnt vmcnt(7)
v_mfma_f32_32x32x16_bf16 v[20:35], a[104:107], v[148:151], v[20:35]
v_mfma_f32_32x32x16_bf16 v[36:51], a[108:111], v[148:151], v[36:51]
buffer_load_dwordx4 v[180:183], v6, s[84:87], s51 offen offset:1024 sc1
s_waitcnt vmcnt(7)
v_mfma_f32_32x32x16_bf16 v[20:35], a[112:115], v[152:155], v[20:35]
v_mfma_f32_32x32x16_bf16 v[36:51], a[116:119], v[152:155], v[36:51]
buffer_load_dwordx4 v[184:187], v6, s[84:87], s51 offen offset:2048 sc1
s_waitcnt vmcnt(7)
v_mfma_f32_32x32x16_bf16 v[20:35], a[120:123], v[156:159], v[20:35]
v_mfma_f32_32x32x16_bf16 v[36:51], a[124:127], v[156:159], v[36:51]
buffer_load_dwordx4 v[188:191], v6, s[84:87], s51 offen offset:3072 sc1
s_waitcnt vmcnt(7)
v_mfma_f32_32x32x16_bf16 v[20:35], a[128:131], v[160:163], v[20:35]
v_mfma_f32_32x32x16_bf16 v[36:51], a[132:135], v[160:163], v[36:51]
s_add_u32 s51, s56, 24576
s_and_b32 s51, s51, 0x7fff
s_add_u32 s51, s51, s50
buffer_load_dwordx4 v[192:195], v6, s[84:87], s51 offen offset:0 sc1
s_waitcnt vmcnt(7)
v_mfma_f32_32x32x16_bf16 v[20:35], a[136:139], v[164:167], v[20:35]
v_mfma_f32_32x32x16_bf16 v[36:51], a[140:143], v[164:167], v[36:51]
buffer_load_dwordx4 v[196:199], v6, s[84:87], s51 offen offset:1024 sc1
s_waitcnt vmcnt(7)
v_mfma_f32_32x32x16_bf16 v[20:35], a[144:147], v[168:171], v[20:35]
v_mfma_f32_32x32x16_bf16 v[36:51], a[148:151], v[168:171], v[36:51]
buffer_load_dwordx4 v[200:203], v6, s[84:87], s51 offen offset:2048 sc1
s_waitcnt vmcnt(7)
v_mfma_f32_32x32x16_bf16 v[20:35], a[152:155], v[172:175], v[20:35]
v_mfma_f32_32x32x16_bf16 v[36:51], a[156:159], v[172:175], v[36:51]
buffer_load_dwordx4 v[204:207], v6, s[84:87], s51 offen offset:3072 sc1
s_waitcnt vmcnt(7)
v_mfma_f32_32x32x16_bf16 v[20:35], a[160:163], v[176:179], v[20:35]
v_mfma_f32_32x32x16_bf16 v[36:51], a[164:167], v[176:179], v[36:51]
s_add_u32 s51, s56, 28672
s_and_b32 s51, s51, 0x7fff
s_add_u32 s51, s51, s50
buffer_load_dwordx4 v[208:211], v6, s[84:87], s51 offen offset:0 sc1
s_waitcnt vmcnt(7)
v_mfma_f32_32x32x16_bf16 v[20:35], a[168:171], v[180:183], v[20:35]
v_mfma_f32_32x32x16_bf16 v[36:51], a[172:175], v[180:183], v[36:51]
buffer_load_dwordx4 v[212:215], v6, s[84:87], s51 offen offset:1024 sc1
s_waitcnt vmcnt(7)
v_mfma_f32_32x32x16_bf16 v[20:35], a[176:179], v[184:187], v[20:35]
v_mfma_f32_32x32x16_bf16 v[36:51], a[180:183], v[184:187], v[36:51]
buffer_load_dwordx4 v[216:219], v6, s[84:87], s51 offen offset:2048 sc1
s_waitcnt vmcnt(7)
v_mfma_f32_32x32x16_bf16 v[20:35], a[184:187], v[188:191], v[20:35]
v_mfma_f32_32x32x16_bf16 v[36:51], a[188:191], v[188:191], v[36:51]
buffer_load_dwordx4 v[220:223], v6, s[84:87], s51 offen offset:3072 sc1
s_waitcnt vmcnt(7)
v_mfma_f32_32x32x16_bf16 v[20:35], a[192:195], v[192:195], v[20:35]
v_mfma_f32_32x32x16_bf16 v[36:51], a[196:199], v[192:195], v[36:51]
buffer_load_dword v15, v7, s[84:87], 0 offen sc1
s_waitcnt vmcnt(6)
v_mfma_f32_32x32x16_bf16 v[20:35], a[200:203], v[196:199], v[20:35]
v_mfma_f32_32x32x16_bf16 v[36:51], a[204:207], v[196:199], v[36:51]
s_waitcnt vmcnt(5)
v_mfma_f32_32x32x16_bf16 v[20:35], a[208:211], v[200:203], v[20:35]
v_mfma_f32_32x32x16_bf16 v[36:51], a[212:215], v[200:203], v[36:51]
s_waitcnt vmcnt(4)
v_mfma_f32_32x32x16_bf16 v[20:35], a[216:219], v[204:207], v[20:35]
v_mfma_f32_32x32x16_bf16 v[36:51], a[220:223], v[204:207], v[36:51]
s_waitcnt vmcnt(3)
v_mfma_f32_32x32x16_bf16 v[20:35], a[224:227], v[208:211], v[20:35]
v_mfma_f32_32x32x16_bf16 v[36:51], a[228:231], v[208:211], v[36:51]
s_waitcnt vmcnt(2)
v_mfma_f32_32x32x16_bf16 v[20:35], a[232:235], v[212:215], v[20:35]
v_mfma_f32_32x32x16_bf16 v[36:51], a[236:239], v[212:215], v[36:51]
s_waitcnt vmcnt(1)
v_mfma_f32_32x32x16_bf16 v[20:35], a[240:243], v[216:219], v[20:35]
v_mfma_f32_32x32x16_bf16 v[36:51], a[244:247], v[216:219], v[36:51]
s_waitcnt vmcnt(0)
v_mfma_f32_32x32x16_bf16 v[224:239], a[248:251], v[220:223], v[20:35]
v_mfma_f32_32x32x16_bf16 v[240:255], a[252:255], v[220:223], v[36:51]
s_lshl_b32 s50, s54, 18
s_branch mega_kernel_o_imm
mega_kernel_o_c1:
s_add_u32 s54, s42, s71
s_sub_u32 s62, s42, s71
s_lshl_b32 s50, s42, 18
s_add_u32 s51, s56, 0
s_and_b32 s51, s51, 0x7fff
s_add_u32 s51, s51, s50
buffer_load_dwordx4 v[96:99], v6, s[84:87], s51 offen offset:0 sc1
buffer_load_dwordx4 v[100:103], v6, s[84:87], s51 offen offset:1024 sc1
buffer_load_dwordx4 v[104:107], v6, s[84:87], s51 offen offset:2048 sc1
buffer_load_dwordx4 v[108:111], v6, s[84:87], s51 offen offset:3072 sc1
s_add_u32 s51, s56, 4096
s_and_b32 s51, s51, 0x7fff
s_add_u32 s51, s51, s50
buffer_load_dwordx4 v[112:115], v6, s[84:87], s51 offen offset:0 sc1
buffer_load_dwordx4 v[116:119], v6, s[84:87], s51 offen offset:1024 sc1
buffer_load_dwordx4 v[120:123], v6, s[84:87], s51 offen offset:2048 sc1
buffer_load_dwordx4 v[124:127], v6, s[84:87], s51 offen offset:3072 sc1
v_add_u32 v2, s53, v8
v_add_u32 v3, s53, v9
v_add_u32 v4, s53, v10
ds_write_b128 v2, v[224:227] offset:0
ds_write_b128 v2, v[228:231] offset:1088
ds_write_b128 v2, v[232:235] offset:2176
ds_write_b128 v2, v[236:239] offset:3264
ds_write_b128 v2, v[240:243] offset:4352
ds_write_b128 v2, v[244:247] offset:5440
ds_write_b128 v2, v[248:251] offset:6528
ds_write_b128 v2, v[252:255] offset:7616
s_waitcnt lgkmcnt(0)
s_barrier
ds_read_b128 v[52:55], v4 offset:0
ds_read_b128 v[56:59], v4 offset:8704
ds_read_b128 v[60:63], v4 offset:17408
ds_read_b128 v[64:67], v4 offset:26112
ds_read_b128 v[68:71], v3 offset:0
ds_read_b128 v[72:75], v3 offset:8704
ds_read_b128 v[76:79], v3 offset:17408
ds_read_b128 v[80:83], v3 offset:26112
s_sub_u32 s53, 34816, s53
s_sub_u32 s60, s62, s64
s_lshr_b32 s60, s60, s67
s_bfe_u32 s61, s60, 0x10001
s_and_b32 s60, s60, 1
s_lshl_b32 s60, s60, 12
s_waitcnt lgkmcnt(4)
v_add_f32 v52, v52, v56
v_add_f32 v60, v60, v64
v_add_f32 v53, v53, v57
v_add_f32 v61, v61, v65
v_add_f32 v54, v54, v58
v_add_f32 v62, v62, v66
v_add_f32 v55, v55, v59
v_add_f32 v63, v63, v67
v_add_f32 v52, v52, v60
v_add_f32 v53, v53, v61
v_add_f32 v54, v54, v62
v_add_f32 v55, v55, v63
v_and_or_b32 v52, v52, -2, s61
s_cmp_eq_u32 s95, 0
s_cbranch_scc1 mega_kernel_o_sa3
buffer_store_dwordx4 v[52:55], v12, s[84:87], s60 offen sc1
s_branch mega_kernel_o_sb3
mega_kernel_o_sa3:
buffer_store_dwordx4 v[52:55], v12, s[84:87], s60 offen
mega_kernel_o_sb3:
s_waitcnt lgkmcnt(0)
v_add_f32 v68, v68, v72
v_add_f32 v76, v76, v80
v_add_f32 v69, v69, v73
v_add_f32 v77, v77, v81
v_add_f32 v70, v70, v74
v_add_f32 v78, v78, v82
v_add_f32 v71, v71, v75
v_add_f32 v79, v79, v83
v_add_f32 v84, v68, v76
v_add_f32 v85, v69, v77
v_add_f32 v86, v70, v78
v_add_f32 v87, v71, v79
s_waitcnt vmcnt(7)
v_mfma_f32_32x32x16_bf16 v[20:35], a[0:3], v[96:99], 0
v_mfma_f32_32x32x16_bf16 v[36:51], a[4:7], v[96:99], 0
s_add_u32 s51, s56, 8192
s_and_b32 s51, s51, 0x7fff
s_add_u32 s51, s51, s50
buffer_load_dwordx4 v[128:131], v6, s[84:87], s51 offen offset:0 sc1
s_waitcnt vmcnt(7)
v_mfma_f32_32x32x16_bf16 v[20:35], a[8:11], v[100:103], v[20:35]
v_mfma_f32_32x32x16_bf16 v[36:51], a[12:15], v[100:103], v[36:51]
buffer_load_dwordx4 v[132:135], v6, s[84:87], s51 offen offset:1024 sc1
s_waitcnt vmcnt(7)
v_mfma_f32_32x32x16_bf16 v[20:35], a[16:19], v[104:107], v[20:35]
v_mfma_f32_32x32x16_bf16 v[36:51], a[20:23], v[104:107], v[36:51]
buffer_load_dwordx4 v[136:139], v6, s[84:87], s51 offen offset:2048 sc1
s_waitcnt vmcnt(7)
v_mfma_f32_32x32x16_bf16 v[20:35], a[24:27], v[108:111], v[20:35]
v_mfma_f32_32x32x16_bf16 v[36:51], a[28:31], v[108:111], v[36:51]
buffer_load_dwordx4 v[140:143], v6, s[84:87], s51 offen offset:3072 sc1
s_waitcnt vmcnt(7)
v_mfma_f32_32x32x16_bf16 v[20:35], a[32:35], v[112:115], v[20:35]
v_mfma_f32_32x32x16_bf16 v[36:51], a[36:39], v[112:115], v[36:51]
s_add_u32 s51, s56, 12288
s_and_b32 s51, s51, 0x7fff
s_add_u32 s51, s51, s50
buffer_load_dwordx4 v[144:147], v6, s[84:87], s51 offen offset:0 sc1
s_waitcnt vmcnt(7)
v_mfma_f32_32x32x16_bf16 v[20:35], a[40:43], v[116:119], v[20:35]
v_mfma_f32_32x32x16_bf16 v[36:51], a[44:47], v[116:119], v[36:51]
buffer_load_dwordx4 v[148:151], v6, s[84:87], s51 offen offset:1024 sc1
s_waitcnt vmcnt(7)
v_mfma_f32_32x32x16_bf16 v[20:35], a[48:51], v[120:123], v[20:35]
v_mfma_f32_32x32x16_bf16 v[36:51], a[52:55], v[120:123], v[36:51]
buffer_load_dwordx4 v[152:155], v6, s[84:87], s51 offen offset:2048 sc1
s_waitcnt vmcnt(7)
v_mfma_f32_32x32x16_bf16 v[20:35], a[56:59], v[124:127], v[20:35]
v_mfma_f32_32x32x16_bf16 v[36:51], a[60:63], v[124:127], v[36:51]
buffer_load_dwordx4 v[156:159], v6, s[84:87], s51 offen offset:3072 sc1
s_waitcnt vmcnt(7)
v_mfma_f32_32x32x16_bf16 v[20:35], a[64:67], v[128:131], v[20:35]
v_mfma_f32_32x32x16_bf16 v[36:51], a[68:71], v[128:131], v[36:51]
s_add_u32 s51, s56, 16384
s_and_b32 s51, s51, 0x7fff
s_add_u32 s51, s51, s50
buffer_load_dwordx4 v[160:163], v6, s[84:87], s51 offen offset:0 sc1
s_waitcnt vmcnt(7)
v_mfma_f32_32x32x16_bf16 v[20:35], a[72:75], v[132:135], v[20:35]
v_mfma_f32_32x32x16_bf16 v[36:51], a[76:79], v[132:135], v[36:51]
buffer_load_dwordx4 v[164:167], v6, s[84:87], s51 offen offset:1024 sc1
s_waitcnt vmcnt(7)
v_mfma_f32_32x32x16_bf16 v[20:35], a[80:83], v[136:139], v[20:35]
v_mfma_f32_32x32x16_bf16 v[36:51], a[84:87], v[136:139], v[36:51]
buffer_load_dwordx4 v[168:171], v6, s[84:87], s51 offen offset:2048 sc1
s_waitcnt vmcnt(7)
v_mfma_f32_32x32x16_bf16 v[20:35], a[88:91], v[140:143], v[20:35]
v_mfma_f32_32x32x16_bf16 v[36:51], a[92:95], v[140:143], v[36:51]
buffer_load_dwordx4 v[172:175], v6, s[84:87], s51 offen offset:3072 sc1
s_waitcnt vmcnt(7)
v_mfma_f32_32x32x16_bf16 v[20:35], a[96:99], v[144:147], v[20:35]
v_mfma_f32_32x32x16_bf16 v[36:51], a[100:103], v[144:147], v[36:51]
s_add_u32 s51, s56, 20480
s_and_b32 s51, s51, 0x7fff
s_add_u32 s51, s51, s50
buffer_load_dwordx4 v[176:179], v6, s[84:87], s51 offen offset:0 sc1
s_waitcnt vmcnt(7)
v_mfma_f32_32x32x16_bf16 v[20:35], a[104:107], v[148:151], v[20:35]
v_mfma_f32_32x32x16_bf16 v[36:51], a[108:111], v[148:151], v[36:51]
buffer_load_dwordx4 v[180:183], v6, s[84:87], s51 offen offset:1024 sc1
s_waitcnt vmcnt(7)
v_mfma_f32_32x32x16_bf16 v[20:35], a[112:115], v[152:155], v[20:35]
v_mfma_f32_32x32x16_bf16 v[36:51], a[116:119], v[152:155], v[36:51]
buffer_load_dwordx4 v[184:187], v6, s[84:87], s51 offen offset:2048 sc1
s_waitcnt vmcnt(7)
v_mfma_f32_32x32x16_bf16 v[20:35], a[120:123], v[156:159], v[20:35]
v_mfma_f32_32x32x16_bf16 v[36:51], a[124:127], v[156:159], v[36:51]
buffer_load_dwordx4 v[188:191], v6, s[84:87], s51 offen offset:3072 sc1
s_waitcnt vmcnt(7)
v_mfma_f32_32x32x16_bf16 v[20:35], a[128:131], v[160:163], v[20:35]
v_mfma_f32_32x32x16_bf16 v[36:51], a[132:135], v[160:163], v[36:51]
s_add_u32 s51, s56, 24576
s_and_b32 s51, s51, 0x7fff
s_add_u32 s51, s51, s50
buffer_load_dwordx4 v[192:195], v6, s[84:87], s51 offen offset:0 sc1
s_waitcnt vmcnt(7)
v_mfma_f32_32x32x16_bf16 v[20:35], a[136:139], v[164:167], v[20:35]
v_mfma_f32_32x32x16_bf16 v[36:51], a[140:143], v[164:167], v[36:51]
buffer_load_dwordx4 v[196:199], v6, s[84:87], s51 offen offset:1024 sc1
s_waitcnt vmcnt(7)
v_mfma_f32_32x32x16_bf16 v[20:35], a[144:147], v[168:171], v[20:35]
v_mfma_f32_32x32x16_bf16 v[36:51], a[148:151], v[168:171], v[36:51]
buffer_load_dwordx4 v[200:203], v6, s[84:87], s51 offen offset:2048 sc1
s_waitcnt vmcnt(7)
v_mfma_f32_32x32x16_bf16 v[20:35], a[152:155], v[172:175], v[20:35]
v_mfma_f32_32x32x16_bf16 v[36:51], a[156:159], v[172:175], v[36:51]
buffer_load_dwordx4 v[204:207], v6, s[84:87], s51 offen offset:3072 sc1
s_waitcnt vmcnt(7)
v_mfma_f32_32x32x16_bf16 v[20:35], a[160:163], v[176:179], v[20:35]
v_mfma_f32_32x32x16_bf16 v[36:51], a[164:167], v[176:179], v[36:51]
s_add_u32 s51, s56, 28672
s_and_b32 s51, s51, 0x7fff
s_add_u32 s51, s51, s50
buffer_load_dwordx4 v[208:211], v6, s[84:87], s51 offen offset:0 sc1
s_waitcnt vmcnt(7)
v_mfma_f32_32x32x16_bf16 v[20:35], a[168:171], v[180:183], v[20:35]
v_mfma_f32_32x32x16_bf16 v[36:51], a[172:175], v[180:183], v[36:51]
buffer_load_dwordx4 v[212:215], v6, s[84:87], s51 offen offset:1024 sc1
s_waitcnt vmcnt(7)
v_mfma_f32_32x32x16_bf16 v[20:35], a[176:179], v[184:187], v[20:35]
v_mfma_f32_32x32x16_bf16 v[36:51], a[180:183], v[184:187], v[36:51]
buffer_load_dwordx4 v[216:219], v6, s[84:87], s51 offen offset:2048 sc1
s_waitcnt vmcnt(7)
v_mfma_f32_32x32x16_bf16 v[20:35], a[184:187], v[188:191], v[20:35]
v_mfma_f32_32x32x16_bf16 v[36:51], a[188:191], v[188:191], v[36:51]
buffer_load_dwordx4 v[220:223], v6, s[84:87], s51 offen offset:3072 sc1
s_waitcnt vmcnt(7)
v_mfma_f32_32x32x16_bf16 v[20:35], a[192:195], v[192:195], v[20:35]
v_mfma_f32_32x32x16_bf16 v[36:51], a[196:199], v[192:195], v[36:51]
s_sub_u32 s60, s62, s64
s_lshr_b32 s60, s60, s67
s_bfe_u32 s61, s60, 0x10001
s_and_b32 s60, s60, 1
s_lshl_b32 s60, s60, 12
buffer_load_dwordx4 v[88:91], v13, s[84:87], s60 offen sc1
buffer_load_dword v15, v7, s[84:87], 0 offen sc1
s_waitcnt vmcnt(6)
v_mfma_f32_32x32x16_bf16 v[20:35], a[200:203], v[196:199], v[20:35]
v_mfma_f32_32x32x16_bf16 v[36:51], a[204:207], v[196:199], v[36:51]
s_waitcnt vmcnt(5)
v_mfma_f32_32x32x16_bf16 v[20:35], a[208:211], v[200:203], v[20:35]
v_mfma_f32_32x32x16_bf16 v[36:51], a[212:215], v[200:203], v[36:51]
s_waitcnt vmcnt(4)
v_mfma_f32_32x32x16_bf16 v[20:35], a[216:219], v[204:207], v[20:35]
v_mfma_f32_32x32x16_bf16 v[36:51], a[220:223], v[204:207], v[36:51]
s_waitcnt vmcnt(3)
v_mfma_f32_32x32x16_bf16 v[20:35], a[224:227], v[208:211], v[20:35]
v_mfma_f32_32x32x16_bf16 v[36:51], a[228:231], v[208:211], v[36:51]
s_waitcnt vmcnt(2)
v_mfma_f32_32x32x16_bf16 v[20:35], a[232:235], v[212:215], v[20:35]
v_mfma_f32_32x32x16_bf16 v[36:51], a[236:239], v[212:215], v[36:51]
s_waitcnt vmcnt(1)
v_mfma_f32_32x32x16_bf16 v[20:35], a[240:243], v[216:219], v[20:35]
v_mfma_f32_32x32x16_bf16 v[36:51], a[244:247], v[216:219], v[36:51]
s_waitcnt vmcnt(0)
v_mfma_f32_32x32x16_bf16 v[224:239], a[248:251], v[220:223], v[20:35]
v_mfma_f32_32x32x16_bf16 v[240:255], a[252:255], v[220:223], v[36:51]
s_waitcnt vmcnt(0)
mega_kernel_o_fcc:
v_and_b32 v14, 1, v88
v_cmp_ne_u32 vcc, s61, v14
s_cbranch_vccz mega_kernel_o_fck
s_sub_u32 s60, s62, s64
s_lshr_b32 s60, s60, s67
s_bfe_u32 s61, s60, 0x10001
s_and_b32 s60, s60, 1
s_lshl_b32 s60, s60, 12
buffer_load_dwordx4 v[88:91], v13, s[84:87], s60 offen sc1
s_waitcnt vmcnt(0)
s_branch mega_kernel_o_fcc
mega_kernel_o_fck:
v_pk_add_f32 v[88:89], v[88:89], v[84:85]
v_pk_add_f32 v[90:91], v[90:91], v[86:87]
s_lshl_b32 s60, s62, 17
v_cvt_pk_bf16_f32 v92, v88, v89
v_cvt_pk_bf16_f32 v93, v90, v91
buffer_store_dwordx2 v[92:93], v11, s[8:11], s60 offen sc1
s_lshl_b32 s50, s54, 18
s_branch mega_kernel_o_imm
mega_kernel_o_im2:
v_add_u32 v2, s53, v8
v_add_u32 v3, s53, v9
v_add_u32 v4, s53, v10
ds_write_b128 v2, v[224:227] offset:0
ds_write_b128 v2, v[228:231] offset:1088
ds_write_b128 v2, v[232:235] offset:2176
ds_write_b128 v2, v[236:239] offset:3264
ds_write_b128 v2, v[240:243] offset:4352
ds_write_b128 v2, v[244:247] offset:5440
ds_write_b128 v2, v[248:251] offset:6528
ds_write_b128 v2, v[252:255] offset:7616
s_waitcnt lgkmcnt(0)
s_barrier
ds_read_b128 v[52:55], v4 offset:0
ds_read_b128 v[56:59], v4 offset:8704
ds_read_b128 v[60:63], v4 offset:17408
ds_read_b128 v[64:67], v4 offset:26112
ds_read_b128 v[68:71], v3 offset:0
ds_read_b128 v[72:75], v3 offset:8704
ds_read_b128 v[76:79], v3 offset:17408
ds_read_b128 v[80:83], v3 offset:26112
s_sub_u32 s53, 34816, s53
s_sub_u32 s60, s42, s64
s_lshr_b32 s60, s60, s67
s_bfe_u32 s61, s60, 0x10001
s_and_b32 s60, s60, 1
s_lshl_b32 s60, s60, 12
s_waitcnt lgkmcnt(4)
v_add_f32 v52, v52, v56
v_add_f32 v60, v60, v64
v_add_f32 v53, v53, v57
v_add_f32 v61, v61, v65
v_add_f32 v54, v54, v58
v_add_f32 v62, v62, v66
v_add_f32 v55, v55, v59
v_add_f32 v63, v63, v67
v_add_f32 v52, v52, v60
v_add_f32 v53, v53, v61
v_add_f32 v54, v54, v62
v_add_f32 v55, v55, v63
v_and_or_b32 v52, v52, -2, s61
s_cmp_eq_u32 s95, 0
s_cbranch_scc1 mega_kernel_o_sa4
buffer_store_dwordx4 v[52:55], v12, s[84:87], s60 offen sc1
s_branch mega_kernel_o_sb4
mega_kernel_o_sa4:
buffer_store_dwordx4 v[52:55], v12, s[84:87], s60 offen
mega_kernel_o_sb4:
s_waitcnt lgkmcnt(0)
v_add_f32 v68, v68, v72
v_add_f32 v76, v76, v80
v_add_f32 v69, v69, v73
v_add_f32 v77, v77, v81
v_add_f32 v70, v70, v74
v_add_f32 v78, v78, v82
v_add_f32 v71, v71, v75
v_add_f32 v79, v79, v83
v_add_f32 v84, v68, v76
v_add_f32 v85, v69, v77
v_add_f32 v86, v70, v78
v_add_f32 v87, v71, v79
s_sub_u32 s60, s42, s64
s_lshr_b32 s60, s60, s67
s_bfe_u32 s61, s60, 0x10001
s_and_b32 s60, s60, 1
s_lshl_b32 s60, s60, 12
buffer_load_dwordx4 v[88:91], v13, s[84:87], s60 offen sc1
s_waitcnt vmcnt(0)
mega_kernel_o_f2c:
v_and_b32 v14, 1, v88
v_cmp_ne_u32 vcc, s61, v14
s_cbranch_vccz mega_kernel_o_f2k
s_sub_u32 s60, s42, s64
s_lshr_b32 s60, s60, s67
s_bfe_u32 s61, s60, 0x10001
s_and_b32 s60, s60, 1
s_lshl_b32 s60, s60, 12
buffer_load_dwordx4 v[88:91], v13, s[84:87], s60 offen sc1
s_waitcnt vmcnt(0)
s_branch mega_kernel_o_f2c
mega_kernel_o_f2k:
v_pk_add_f32 v[88:89], v[88:89], v[84:85]
v_pk_add_f32 v[90:91], v[90:91], v[86:87]
s_lshl_b32 s60, s42, 17
v_cvt_pk_bf16_f32 v92, v88, v89
v_cvt_pk_bf16_f32 v93, v90, v91
buffer_store_dwordx2 v[92:93], v11, s[8:11], s60 offen sc1
s_add_u32 s42, s42, s71
s_cmp_lt_u32 s42, s65
s_cbranch_scc1 mega_kernel_o_cold
mega_kernel_o_quit:
s_endpgm
mega_kernel_exit:
s_endpgm
mega_kernel_recf:
s_load_dwordx2 s[20:21], s[0:1], 8
s_load_dwordx2 s[16:17], s[0:1], 40
s_load_dwordx2 s[4:5], s[0:1], 16
s_load_dwordx2 s[8:9], s[0:1], 24
s_load_dwordx2 s[12:13], s[0:1], 32
v_lshrrev_b32 v4, 6, v0
v_and_b32 v1, 63, v0
v_readfirstlane_b32 s24, v4
v_lshrrev_b32 v2, 4, v1
v_and_b32 v3, 15, v1
v_lshlrev_b32 v17, 4, v1
s_lshr_b32 s28, s31, 2
s_lshl_b32 s25, s30, 3
s_add_u32 s25, s25, s28
s_and_b32 s26, s31, 3
s_waitcnt lgkmcnt(0)
s_mov_b32 s22, 16384
s_mov_b32 s23, 0x00020000
s_mov_b32 s18, 8388608
s_mov_b32 s19, 0x00020000
s_mov_b32 s6, 8388608
s_mov_b32 s7, 0x00020000
s_mov_b32 s10, 8388608
s_mov_b32 s11, 0x00020000
s_mov_b32 s14, 8388608
s_mov_b32 s15, 0x00020000
s_lshl_b32 s28, s25, 8
s_lshr_b32 s29, s26, 0
s_lshl_b32 s29, s29, 6
s_add_u32 s28, s28, s29
s_lshl_b32 s29, s24, 21
s_add_u32 s28, s28, s29
v_lshrrev_b32 v4, 2, v1
v_and_b32 v5, 3, v1
v_lshlrev_b32 v40, 13, v4
v_lshl_add_u32 v40, v5, 4, v40
v_add_u32 v40, s28, v40
s_lshl_b32 s28, s30, 21
s_lshl_b32 s29, s24, 19
s_add_u32 s28, s28, s29
s_lshr_b32 s29, s31, 0
s_lshl_b32 s29, s29, 6
s_add_u32 s28, s28, s29
v_lshlrev_b32 v41, 11, v4
v_lshl_add_u32 v41, v5, 4, v41
v_add_u32 v41, s28, v41
s_lshl_b32 s47, s24, 15
s_add_u32 s47, s47, 32768
s_lshl_b32 s28, s31, 18
s_lshl_b32 s29, s24, 16
s_add_u32 s28, s28, s29
s_lshl_b32 s29, s30, 11
s_add_u32 s28, s28, s29
v_lshlrev_b32 v48, 13, v2
v_lshl_add_u32 v48, v3, 7, v48
v_add_u32 v48, s28, v48
s_lshl_b32 s28, s30, 21
s_lshl_b32 s29, s31, 16
s_add_u32 s28, s28, s29
s_lshl_b32 s29, s24, 14
s_add_u32 s28, s28, s29
v_lshlrev_b32 v49, 7, v1
v_add_u32 v49, s28, v49
s_and_b32 s76, s31, 1
s_mul_i32 s76, s76, 8
s_and_b32 s28, s31, 15
s_lshl_b32 s28, s28, 4
s_lshl_b32 s29, s24, 8
s_add_u32 s28, s28, s29
v_add_u32 v53, s28, v3
s_lshr_b32 s28, s31, 4
s_lshl_b32 s28, s28, 10
s_add_u32 s28, s28, 384
v_mov_b32 v54, s28
v_mov_b32 v55, 1920
v_cmp_gt_u32 vcc, 32, v1
s_nop 1
v_cndmask_b32 v54, v55, v54, vcc
s_lshl_b32 s29, s30, 11
v_lshl_add_u32 v51, v53, 13, v54
v_add_u32 v51, s29, v51
s_lshl_b32 s29, s30, 21
v_lshl_add_u32 v52, v53, 11, v54
v_add_u32 v52, s29, v52
buffer_load_dword v50, v51, s[8:11], 0 offen
s_xor_b32 s29, s76, 0
s_lshl_b32 s28, s29, 10
s_add_u32 s28, s28, s47
s_add_u32 m0, s28, 0
s_lshl_b32 s29, s29, 17
buffer_load_dwordx4 v40, s[8:11], s29 offen lds
s_xor_b32 s29, s76, 1
s_lshl_b32 s28, s29, 10
s_add_u32 s28, s28, s47
s_add_u32 m0, s28, 0
s_lshl_b32 s29, s29, 17
buffer_load_dwordx4 v40, s[8:11], s29 offen lds
s_xor_b32 s29, s76, 2
s_lshl_b32 s28, s29, 10
s_add_u32 s28, s28, s47
s_add_u32 m0, s28, 0
s_lshl_b32 s29, s29, 17
buffer_load_dwordx4 v40, s[8:11], s29 offen lds
s_xor_b32 s29, s76, 3
s_lshl_b32 s28, s29, 10
s_add_u32 s28, s28, s47
s_add_u32 m0, s28, 0
s_lshl_b32 s29, s29, 17
buffer_load_dwordx4 v40, s[8:11], s29 offen lds
s_xor_b32 s29, s76, 4
s_lshl_b32 s28, s29, 10
s_add_u32 s28, s28, s47
s_add_u32 m0, s28, 0
s_lshl_b32 s29, s29, 17
buffer_load_dwordx4 v40, s[8:11], s29 offen lds
s_xor_b32 s29, s76, 5
s_lshl_b32 s28, s29, 10
s_add_u32 s28, s28, s47
s_add_u32 m0, s28, 0
s_lshl_b32 s29, s29, 17
buffer_load_dwordx4 v40, s[8:11], s29 offen lds
s_xor_b32 s29, s76, 6
s_lshl_b32 s28, s29, 10
s_add_u32 s28, s28, s47
s_add_u32 m0, s28, 0
s_lshl_b32 s29, s29, 17
buffer_load_dwordx4 v40, s[8:11], s29 offen lds
s_xor_b32 s29, s76, 7
s_lshl_b32 s28, s29, 10
s_add_u32 s28, s28, s47
s_add_u32 m0, s28, 0
s_lshl_b32 s29, s29, 17
buffer_load_dwordx4 v40, s[8:11], s29 offen lds
s_xor_b32 s29, s76, 8
s_lshl_b32 s28, s29, 10
s_add_u32 s28, s28, s47
s_add_u32 m0, s28, 0
s_lshl_b32 s29, s29, 17
buffer_load_dwordx4 v40, s[8:11], s29 offen lds
s_xor_b32 s29, s76, 9
s_lshl_b32 s28, s29, 10
s_add_u32 s28, s28, s47
s_add_u32 m0, s28, 0
s_lshl_b32 s29, s29, 17
buffer_load_dwordx4 v40, s[8:11], s29 offen lds
s_xor_b32 s29, s76, 10
s_lshl_b32 s28, s29, 10
s_add_u32 s28, s28, s47
s_add_u32 m0, s28, 0
s_lshl_b32 s29, s29, 17
buffer_load_dwordx4 v40, s[8:11], s29 offen lds
s_xor_b32 s29, s76, 11
s_lshl_b32 s28, s29, 10
s_add_u32 s28, s28, s47
s_add_u32 m0, s28, 0
s_lshl_b32 s29, s29, 17
buffer_load_dwordx4 v40, s[8:11], s29 offen lds
s_xor_b32 s29, s76, 12
s_lshl_b32 s28, s29, 10
s_add_u32 s28, s28, s47
s_add_u32 m0, s28, 0
s_lshl_b32 s29, s29, 17
buffer_load_dwordx4 v40, s[8:11], s29 offen lds
s_xor_b32 s29, s76, 13
s_lshl_b32 s28, s29, 10
s_add_u32 s28, s28, s47
s_add_u32 m0, s28, 0
s_lshl_b32 s29, s29, 17
buffer_load_dwordx4 v40, s[8:11], s29 offen lds
s_xor_b32 s29, s76, 14
s_lshl_b32 s28, s29, 10
s_add_u32 s28, s28, s47
s_add_u32 m0, s28, 0
s_lshl_b32 s29, s29, 17
buffer_load_dwordx4 v40, s[8:11], s29 offen lds
s_xor_b32 s29, s76, 15
s_lshl_b32 s28, s29, 10
s_add_u32 s28, s28, s47
s_add_u32 m0, s28, 0
s_lshl_b32 s29, s29, 17
buffer_load_dwordx4 v40, s[8:11], s29 offen lds
buffer_load_dword v50, v51, s[12:15], 0 offen
s_xor_b32 s29, s76, 0
s_lshl_b32 s28, s29, 10
s_add_u32 s28, s28, s47
s_add_u32 m0, s28, 16384
s_lshl_b32 s29, s29, 17
buffer_load_dwordx4 v40, s[12:15], s29 offen lds
s_xor_b32 s29, s76, 1
s_lshl_b32 s28, s29, 10
s_add_u32 s28, s28, s47
s_add_u32 m0, s28, 16384
s_lshl_b32 s29, s29, 17
buffer_load_dwordx4 v40, s[12:15], s29 offen lds
s_xor_b32 s29, s76, 2
s_lshl_b32 s28, s29, 10
s_add_u32 s28, s28, s47
s_add_u32 m0, s28, 16384
s_lshl_b32 s29, s29, 17
buffer_load_dwordx4 v40, s[12:15], s29 offen lds
s_xor_b32 s29, s76, 3
s_lshl_b32 s28, s29, 10
s_add_u32 s28, s28, s47
s_add_u32 m0, s28, 16384
s_lshl_b32 s29, s29, 17
buffer_load_dwordx4 v40, s[12:15], s29 offen lds
s_xor_b32 s29, s76, 4
s_lshl_b32 s28, s29, 10
s_add_u32 s28, s28, s47
s_add_u32 m0, s28, 16384
s_lshl_b32 s29, s29, 17
buffer_load_dwordx4 v40, s[12:15], s29 offen lds
s_xor_b32 s29, s76, 5
s_lshl_b32 s28, s29, 10
s_add_u32 s28, s28, s47
s_add_u32 m0, s28, 16384
s_lshl_b32 s29, s29, 17
buffer_load_dwordx4 v40, s[12:15], s29 offen lds
s_xor_b32 s29, s76, 6
s_lshl_b32 s28, s29, 10
s_add_u32 s28, s28, s47
s_add_u32 m0, s28, 16384
s_lshl_b32 s29, s29, 17
buffer_load_dwordx4 v40, s[12:15], s29 offen lds
s_xor_b32 s29, s76, 7
s_lshl_b32 s28, s29, 10
s_add_u32 s28, s28, s47
s_add_u32 m0, s28, 16384
s_lshl_b32 s29, s29, 17
buffer_load_dwordx4 v40, s[12:15], s29 offen lds
s_xor_b32 s29, s76, 8
s_lshl_b32 s28, s29, 10
s_add_u32 s28, s28, s47
s_add_u32 m0, s28, 16384
s_lshl_b32 s29, s29, 17
buffer_load_dwordx4 v40, s[12:15], s29 offen lds
s_xor_b32 s29, s76, 9
s_lshl_b32 s28, s29, 10
s_add_u32 s28, s28, s47
s_add_u32 m0, s28, 16384
s_lshl_b32 s29, s29, 17
buffer_load_dwordx4 v40, s[12:15], s29 offen lds
s_xor_b32 s29, s76, 10
s_lshl_b32 s28, s29, 10
s_add_u32 s28, s28, s47
s_add_u32 m0, s28, 16384
s_lshl_b32 s29, s29, 17
buffer_load_dwordx4 v40, s[12:15], s29 offen lds
s_xor_b32 s29, s76, 11
s_lshl_b32 s28, s29, 10
s_add_u32 s28, s28, s47
s_add_u32 m0, s28, 16384
s_lshl_b32 s29, s29, 17
buffer_load_dwordx4 v40, s[12:15], s29 offen lds
s_xor_b32 s29, s76, 12
s_lshl_b32 s28, s29, 10
s_add_u32 s28, s28, s47
s_add_u32 m0, s28, 16384
s_lshl_b32 s29, s29, 17
buffer_load_dwordx4 v40, s[12:15], s29 offen lds
s_xor_b32 s29, s76, 13
s_lshl_b32 s28, s29, 10
s_add_u32 s28, s28, s47
s_add_u32 m0, s28, 16384
s_lshl_b32 s29, s29, 17
buffer_load_dwordx4 v40, s[12:15], s29 offen lds
s_xor_b32 s29, s76, 14
s_lshl_b32 s28, s29, 10
s_add_u32 s28, s28, s47
s_add_u32 m0, s28, 16384
s_lshl_b32 s29, s29, 17
buffer_load_dwordx4 v40, s[12:15], s29 offen lds
s_xor_b32 s29, s76, 15
s_lshl_b32 s28, s29, 10
s_add_u32 s28, s28, s47
s_add_u32 m0, s28, 16384
s_lshl_b32 s29, s29, 17
buffer_load_dwordx4 v40, s[12:15], s29 offen lds
s_mov_b32 s40, 0x00ff00ff
s_mov_b32 s41, 0x00ff00ff
s_mov_b32 s48, 0xff00ff00
s_mov_b32 s49, 0xff00ff00
s_mov_b32 s42, 0
s_mov_b32 s43, 0x00ff00ff
s_mov_b32 s32, 0x3e0293ee
v_mov_b32 v23, 0xff800000
v_mov_b32 v6, 0x4444
v_mov_b32 v4, 0xeeee
v_cndmask_b32 v6, v6, v4, s[48:49]
v_mov_b32 v28, -1
v_mov_b32 v29, -1
v_mov_b32 v30, -1
v_mov_b32 v31, -1
s_mul_i32 s28, s24, 4096
v_add_u32 v7, s28, v17
v_and_b32 v4, 7, v1
v_lshlrev_b32 v8, 11, v4
v_lshrrev_b32 v5, 3, v1
v_lshl_add_u32 v8, v5, 4, v8
s_lshl_b32 s28, s24, 9
v_add_u32 v8, s28, v8
s_lshl_b32 s28, s31, 9
s_lshr_b32 s29, s31, 3
s_mul_i32 s29, s29, 0
s_add_u32 s28, s28, s29
v_lshlrev_b32 v9, 3, v1
v_add_u32 v9, s28, v9
v_and_b32 v4, 7, v3
v_lshlrev_b32 v11, 7, v2
v_lshl_add_u32 v11, v4, 4, v11
v_add_u32 v22, 0, v11
s_add_u32 s28, s28, 24576
v_add_u32 v11, s28, v11
v_and_b32 v5, 1, v2
v_lshlrev_b32 v10, 7, v5
v_lshl_add_u32 v10, v4, 4, v10
v_add_u32 v10, 1024, v10
s_xor_b32 s37, s31, 1
s_mul_i32 s37, s37, 2048
s_add_u32 s37, s37, 49152
s_xor_b32 s38, s31, 2
s_mul_i32 s38, s38, 2048
s_add_u32 s38, s38, 49152
s_xor_b32 s39, s31, 3
s_mul_i32 s39, s39, 2048
s_add_u32 s39, s39, 49152
v_and_b32 v4, 1, v2
v_mul_u32_u24 v14, 576, v4
v_lshrrev_b32 v5, 1, v2
v_lshl_add_u32 v5, v5, 4, v3
v_lshl_add_u32 v14, v5, 2, v14
s_mul_i32 s28, s24, 1152
s_add_u32 s28, s28, 13312
v_add_u32 v18, s28, v14
s_mul_i32 s28, s24, 2304
v_add_u32 v14, s28, v14
v_add_u32 v15, 1152, v14
v_mul_u32_u24 v16, 144, v3
v_lshl_add_u32 v16, v2, 5, v16
v_bfe_u32 v4, v1, 1, 3
v_mul_u32_u24 v19, 144, v4
v_lshl_add_u32 v19, v2, 5, v19
v_and_b32 v4, 1, v1
v_lshl_add_u32 v19, v4, 4, v19
v_add_u32 v19, 13312, v19
s_lshl_b32 s28, s24, 10
s_add_u32 s28, s28, 9216
v_add_u32 v20, s28, v17
v_and_b32 v4, 31, v1
v_lshlrev_b32 v21, 3, v4
v_add_u32 v21, 17920, v21
v_lshrrev_b32 v4, 2, v3
v_and_b32 v42, 1, v4
v_lshrrev_b32 v43, 1, v4
v_lshrrev_b32 v44, 1, v2
v_and_b32 v45, 1, v2
v_lshl_add_u32 v46, v44, 4, v42
v_lshl_add_u32 v46, v45, 2, v46
v_lshl_add_u32 v46, v43, 3, v46
v_lshl_add_u32 v47, v44, 3, v42
v_lshl_add_u32 v47, v45, 4, v47
v_lshl_add_u32 v47, v43, 2, v47
v_and_b32 v5, 3, v3
v_lshlrev_b32 v5, 3, v5
v_lshl_add_u32 v46, v46, 6, v5
v_lshl_add_u32 v47, v47, 6, v5
s_and_b32 s28, s31, 0
s_lshl_b32 s28, s28, 6
s_add_u32 s28, s28, s47
v_add_u32 v46, s28, v46
v_add_u32 v47, s28, v47
s_waitcnt vmcnt(17)
ds_read_b64_tr_b16 a[64:65], v46 offset:0
ds_read_b64_tr_b16 a[66:67], v46 offset:128
ds_read_b64_tr_b16 a[68:69], v46 offset:2048
ds_read_b64_tr_b16 a[70:71], v46 offset:2176
ds_read_b64_tr_b16 a[72:73], v46 offset:4096
ds_read_b64_tr_b16 a[74:75], v46 offset:4224
ds_read_b64_tr_b16 a[76:77], v46 offset:6144
ds_read_b64_tr_b16 a[78:79], v46 offset:6272
s_waitcnt lgkmcnt(0)
ds_read_b64_tr_b16 a[80:81], v46 offset:8192
ds_read_b64_tr_b16 a[82:83], v46 offset:8320
ds_read_b64_tr_b16 a[84:85], v46 offset:10240
ds_read_b64_tr_b16 a[86:87], v46 offset:10368
ds_read_b64_tr_b16 a[88:89], v46 offset:12288
ds_read_b64_tr_b16 a[90:91], v46 offset:12416
ds_read_b64_tr_b16 a[92:93], v46 offset:14336
ds_read_b64_tr_b16 a[94:95], v46 offset:14464
s_waitcnt lgkmcnt(0)
ds_read_b64_tr_b16 a[96:97], v46 offset:32
ds_read_b64_tr_b16 a[98:99], v46 offset:160
ds_read_b64_tr_b16 a[100:101], v46 offset:2080
ds_read_b64_tr_b16 a[102:103], v46 offset:2208
ds_read_b64_tr_b16 a[104:105], v46 offset:4128
ds_read_b64_tr_b16 a[106:107], v46 offset:4256
ds_read_b64_tr_b16 a[108:109], v46 offset:6176
ds_read_b64_tr_b16 a[110:111], v46 offset:6304
s_waitcnt lgkmcnt(0)
ds_read_b64_tr_b16 a[112:113], v46 offset:8224
ds_read_b64_tr_b16 a[114:115], v46 offset:8352
ds_read_b64_tr_b16 a[116:117], v46 offset:10272
ds_read_b64_tr_b16 a[118:119], v46 offset:10400
ds_read_b64_tr_b16 a[120:121], v46 offset:12320
ds_read_b64_tr_b16 a[122:123], v46 offset:12448
ds_read_b64_tr_b16 a[124:125], v46 offset:14368
ds_read_b64_tr_b16 a[126:127], v46 offset:14496
s_waitcnt lgkmcnt(0)
buffer_load_dword v50, v51, s[4:7], 0 offen
s_xor_b32 s29, s76, 0
s_lshl_b32 s28, s29, 10
s_add_u32 s28, s28, s47
s_add_u32 m0, s28, 0
s_lshl_b32 s29, s29, 17
buffer_load_dwordx4 v40, s[4:7], s29 offen lds
s_xor_b32 s29, s76, 1
s_lshl_b32 s28, s29, 10
s_add_u32 s28, s28, s47
s_add_u32 m0, s28, 0
s_lshl_b32 s29, s29, 17
buffer_load_dwordx4 v40, s[4:7], s29 offen lds
s_xor_b32 s29, s76, 2
s_lshl_b32 s28, s29, 10
s_add_u32 s28, s28, s47
s_add_u32 m0, s28, 0
s_lshl_b32 s29, s29, 17
buffer_load_dwordx4 v40, s[4:7], s29 offen lds
s_xor_b32 s29, s76, 3
s_lshl_b32 s28, s29, 10
s_add_u32 s28, s28, s47
s_add_u32 m0, s28, 0
s_lshl_b32 s29, s29, 17
buffer_load_dwordx4 v40, s[4:7], s29 offen lds
s_xor_b32 s29, s76, 4
s_lshl_b32 s28, s29, 10
s_add_u32 s28, s28, s47
s_add_u32 m0, s28, 0
s_lshl_b32 s29, s29, 17
buffer_load_dwordx4 v40, s[4:7], s29 offen lds
s_xor_b32 s29, s76, 5
s_lshl_b32 s28, s29, 10
s_add_u32 s28, s28, s47
s_add_u32 m0, s28, 0
s_lshl_b32 s29, s29, 17
buffer_load_dwordx4 v40, s[4:7], s29 offen lds
s_xor_b32 s29, s76, 6
s_lshl_b32 s28, s29, 10
s_add_u32 s28, s28, s47
s_add_u32 m0, s28, 0
s_lshl_b32 s29, s29, 17
buffer_load_dwordx4 v40, s[4:7], s29 offen lds
s_xor_b32 s29, s76, 7
s_lshl_b32 s28, s29, 10
s_add_u32 s28, s28, s47
s_add_u32 m0, s28, 0
s_lshl_b32 s29, s29, 17
buffer_load_dwordx4 v40, s[4:7], s29 offen lds
s_xor_b32 s29, s76, 8
s_lshl_b32 s28, s29, 10
s_add_u32 s28, s28, s47
s_add_u32 m0, s28, 0
s_lshl_b32 s29, s29, 17
buffer_load_dwordx4 v40, s[4:7], s29 offen lds
s_xor_b32 s29, s76, 9
s_lshl_b32 s28, s29, 10
s_add_u32 s28, s28, s47
s_add_u32 m0, s28, 0
s_lshl_b32 s29, s29, 17
buffer_load_dwordx4 v40, s[4:7], s29 offen lds
s_xor_b32 s29, s76, 10
s_lshl_b32 s28, s29, 10
s_add_u32 s28, s28, s47
s_add_u32 m0, s28, 0
s_lshl_b32 s29, s29, 17
buffer_load_dwordx4 v40, s[4:7], s29 offen lds
s_xor_b32 s29, s76, 11
s_lshl_b32 s28, s29, 10
s_add_u32 s28, s28, s47
s_add_u32 m0, s28, 0
s_lshl_b32 s29, s29, 17
buffer_load_dwordx4 v40, s[4:7], s29 offen lds
s_xor_b32 s29, s76, 12
s_lshl_b32 s28, s29, 10
s_add_u32 s28, s28, s47
s_add_u32 m0, s28, 0
s_lshl_b32 s29, s29, 17
buffer_load_dwordx4 v40, s[4:7], s29 offen lds
s_xor_b32 s29, s76, 13
s_lshl_b32 s28, s29, 10
s_add_u32 s28, s28, s47
s_add_u32 m0, s28, 0
s_lshl_b32 s29, s29, 17
buffer_load_dwordx4 v40, s[4:7], s29 offen lds
s_xor_b32 s29, s76, 14
s_lshl_b32 s28, s29, 10
s_add_u32 s28, s28, s47
s_add_u32 m0, s28, 0
s_lshl_b32 s29, s29, 17
buffer_load_dwordx4 v40, s[4:7], s29 offen lds
s_xor_b32 s29, s76, 15
s_lshl_b32 s28, s29, 10
s_add_u32 s28, s28, s47
s_add_u32 m0, s28, 0
s_lshl_b32 s29, s29, 17
buffer_load_dwordx4 v40, s[4:7], s29 offen lds
s_waitcnt vmcnt(17)
ds_read_b64_tr_b16 a[128:129], v46 offset:16384
ds_read_b64_tr_b16 a[130:131], v46 offset:16512
ds_read_b64_tr_b16 a[132:133], v46 offset:18432
ds_read_b64_tr_b16 a[134:135], v46 offset:18560
ds_read_b64_tr_b16 a[136:137], v46 offset:20480
ds_read_b64_tr_b16 a[138:139], v46 offset:20608
ds_read_b64_tr_b16 a[140:141], v46 offset:22528
ds_read_b64_tr_b16 a[142:143], v46 offset:22656
s_waitcnt lgkmcnt(0)
ds_read_b64_tr_b16 a[144:145], v46 offset:24576
ds_read_b64_tr_b16 a[146:147], v46 offset:24704
ds_read_b64_tr_b16 a[148:149], v46 offset:26624
ds_read_b64_tr_b16 a[150:151], v46 offset:26752
ds_read_b64_tr_b16 a[152:153], v46 offset:28672
ds_read_b64_tr_b16 a[154:155], v46 offset:28800
ds_read_b64_tr_b16 a[156:157], v46 offset:30720
ds_read_b64_tr_b16 a[158:159], v46 offset:30848
s_waitcnt lgkmcnt(0)
ds_read_b64_tr_b16 a[160:161], v46 offset:16416
ds_read_b64_tr_b16 a[162:163], v46 offset:16544
ds_read_b64_tr_b16 a[164:165], v46 offset:18464
ds_read_b64_tr_b16 a[166:167], v46 offset:18592
ds_read_b64_tr_b16 a[168:169], v46 offset:20512
ds_read_b64_tr_b16 a[170:171], v46 offset:20640
ds_read_b64_tr_b16 a[172:173], v46 offset:22560
ds_read_b64_tr_b16 a[174:175], v46 offset:22688
s_waitcnt lgkmcnt(0)
ds_read_b64_tr_b16 a[176:177], v46 offset:24608
ds_read_b64_tr_b16 a[178:179], v46 offset:24736
ds_read_b64_tr_b16 a[180:181], v46 offset:26656
ds_read_b64_tr_b16 a[182:183], v46 offset:26784
ds_read_b64_tr_b16 a[184:185], v46 offset:28704
ds_read_b64_tr_b16 a[186:187], v46 offset:28832
ds_read_b64_tr_b16 a[188:189], v46 offset:30752
ds_read_b64_tr_b16 a[190:191], v46 offset:30880
s_waitcnt lgkmcnt(0)
buffer_load_dword v50, v52, s[16:19], 0 offen
s_xor_b32 s29, s76, 0
s_lshl_b32 s28, s29, 10
s_add_u32 s28, s28, s47
s_add_u32 m0, s28, 16384
s_lshl_b32 s29, s29, 15
buffer_load_dwordx4 v41, s[16:19], s29 offen lds
s_xor_b32 s29, s76, 1
s_lshl_b32 s28, s29, 10
s_add_u32 s28, s28, s47
s_add_u32 m0, s28, 16384
s_lshl_b32 s29, s29, 15
buffer_load_dwordx4 v41, s[16:19], s29 offen lds
s_xor_b32 s29, s76, 2
s_lshl_b32 s28, s29, 10
s_add_u32 s28, s28, s47
s_add_u32 m0, s28, 16384
s_lshl_b32 s29, s29, 15
buffer_load_dwordx4 v41, s[16:19], s29 offen lds
s_xor_b32 s29, s76, 3
s_lshl_b32 s28, s29, 10
s_add_u32 s28, s28, s47
s_add_u32 m0, s28, 16384
s_lshl_b32 s29, s29, 15
buffer_load_dwordx4 v41, s[16:19], s29 offen lds
s_xor_b32 s29, s76, 4
s_lshl_b32 s28, s29, 10
s_add_u32 s28, s28, s47
s_add_u32 m0, s28, 16384
s_lshl_b32 s29, s29, 15
buffer_load_dwordx4 v41, s[16:19], s29 offen lds
s_xor_b32 s29, s76, 5
s_lshl_b32 s28, s29, 10
s_add_u32 s28, s28, s47
s_add_u32 m0, s28, 16384
s_lshl_b32 s29, s29, 15
buffer_load_dwordx4 v41, s[16:19], s29 offen lds
s_xor_b32 s29, s76, 6
s_lshl_b32 s28, s29, 10
s_add_u32 s28, s28, s47
s_add_u32 m0, s28, 16384
s_lshl_b32 s29, s29, 15
buffer_load_dwordx4 v41, s[16:19], s29 offen lds
s_xor_b32 s29, s76, 7
s_lshl_b32 s28, s29, 10
s_add_u32 s28, s28, s47
s_add_u32 m0, s28, 16384
s_lshl_b32 s29, s29, 15
buffer_load_dwordx4 v41, s[16:19], s29 offen lds
s_xor_b32 s29, s76, 8
s_lshl_b32 s28, s29, 10
s_add_u32 s28, s28, s47
s_add_u32 m0, s28, 16384
s_lshl_b32 s29, s29, 15
buffer_load_dwordx4 v41, s[16:19], s29 offen lds
s_xor_b32 s29, s76, 9
s_lshl_b32 s28, s29, 10
s_add_u32 s28, s28, s47
s_add_u32 m0, s28, 16384
s_lshl_b32 s29, s29, 15
buffer_load_dwordx4 v41, s[16:19], s29 offen lds
s_xor_b32 s29, s76, 10
s_lshl_b32 s28, s29, 10
s_add_u32 s28, s28, s47
s_add_u32 m0, s28, 16384
s_lshl_b32 s29, s29, 15
buffer_load_dwordx4 v41, s[16:19], s29 offen lds
s_xor_b32 s29, s76, 11
s_lshl_b32 s28, s29, 10
s_add_u32 s28, s28, s47
s_add_u32 m0, s28, 16384
s_lshl_b32 s29, s29, 15
buffer_load_dwordx4 v41, s[16:19], s29 offen lds
s_xor_b32 s29, s76, 12
s_lshl_b32 s28, s29, 10
s_add_u32 s28, s28, s47
s_add_u32 m0, s28, 16384
s_lshl_b32 s29, s29, 15
buffer_load_dwordx4 v41, s[16:19], s29 offen lds
s_xor_b32 s29, s76, 13
s_lshl_b32 s28, s29, 10
s_add_u32 s28, s28, s47
s_add_u32 m0, s28, 16384
s_lshl_b32 s29, s29, 15
buffer_load_dwordx4 v41, s[16:19], s29 offen lds
s_xor_b32 s29, s76, 14
s_lshl_b32 s28, s29, 10
s_add_u32 s28, s28, s47
s_add_u32 m0, s28, 16384
s_lshl_b32 s29, s29, 15
buffer_load_dwordx4 v41, s[16:19], s29 offen lds
s_xor_b32 s29, s76, 15
s_lshl_b32 s28, s29, 10
s_add_u32 s28, s28, s47
s_add_u32 m0, s28, 16384
s_lshl_b32 s29, s29, 15
buffer_load_dwordx4 v41, s[16:19], s29 offen lds
s_mov_b64 exec, 0
s_cmp_eq_u32 s24, 0
s_cbranch_scc1 mega_kernel_rf_iw0
s_cmp_eq_u32 s24, 1
s_cbranch_scc1 mega_kernel_rf_iw1
s_cmp_eq_u32 s24, 2
s_cbranch_scc1 mega_kernel_rf_iw2
s_branch mega_kernel_rf_iw3
mega_kernel_rf_iwd:
s_mov_b64 exec, -1
s_waitcnt vmcnt(17)
ds_read_b64_tr_b16 a[0:1], v46 offset:0
ds_read_b64_tr_b16 a[2:3], v46 offset:128
ds_read_b64_tr_b16 a[4:5], v46 offset:2048
ds_read_b64_tr_b16 a[6:7], v46 offset:2176
ds_read_b64_tr_b16 a[8:9], v46 offset:4096
ds_read_b64_tr_b16 a[10:11], v46 offset:4224
ds_read_b64_tr_b16 a[12:13], v46 offset:6144
ds_read_b64_tr_b16 a[14:15], v46 offset:6272
s_waitcnt lgkmcnt(0)
ds_read_b64_tr_b16 a[16:17], v46 offset:8192
ds_read_b64_tr_b16 a[18:19], v46 offset:8320
ds_read_b64_tr_b16 a[20:21], v46 offset:10240
ds_read_b64_tr_b16 a[22:23], v46 offset:10368
ds_read_b64_tr_b16 a[24:25], v46 offset:12288
ds_read_b64_tr_b16 a[26:27], v46 offset:12416
ds_read_b64_tr_b16 a[28:29], v46 offset:14336
ds_read_b64_tr_b16 a[30:31], v46 offset:14464
s_waitcnt lgkmcnt(0)
ds_read_b64_tr_b16 a[32:33], v46 offset:32
ds_read_b64_tr_b16 a[34:35], v46 offset:160
ds_read_b64_tr_b16 a[36:37], v46 offset:2080
ds_read_b64_tr_b16 a[38:39], v46 offset:2208
ds_read_b64_tr_b16 a[40:41], v46 offset:4128
ds_read_b64_tr_b16 a[42:43], v46 offset:4256
ds_read_b64_tr_b16 a[44:45], v46 offset:6176
ds_read_b64_tr_b16 a[46:47], v46 offset:6304
s_waitcnt lgkmcnt(0)
ds_read_b64_tr_b16 a[48:49], v46 offset:8224
ds_read_b64_tr_b16 a[50:51], v46 offset:8352
ds_read_b64_tr_b16 a[52:53], v46 offset:10272
ds_read_b64_tr_b16 a[54:55], v46 offset:10400
ds_read_b64_tr_b16 a[56:57], v46 offset:12320
ds_read_b64_tr_b16 a[58:59], v46 offset:12448
ds_read_b64_tr_b16 a[60:61], v46 offset:14368
ds_read_b64_tr_b16 a[62:63], v46 offset:14496
s_waitcnt lgkmcnt(0)
v_and_b32 v247, 15, v0
v_lshlrev_b32 v247, 4, v247
buffer_load_dword v246, v247, s[72:75], 0 offen sc1
buffer_load_dwordx4 v[64:67], v8, s[20:23], 0 offen offset:0
buffer_load_dwordx4 v[68:71], v8, s[20:23], 0 offen offset:128
buffer_load_dwordx4 v[72:75], v8, s[20:23], 0 offen offset:256
buffer_load_dwordx4 v[76:79], v8, s[20:23], 0 offen offset:384
s_waitcnt vmcnt(0)
ds_read_b64_tr_b16 a[192:193], v47 offset:16384
ds_read_b64_tr_b16 a[194:195], v47 offset:16512
ds_read_b64_tr_b16 a[196:197], v47 offset:18432
ds_read_b64_tr_b16 a[198:199], v47 offset:18560
ds_read_b64_tr_b16 a[200:201], v47 offset:20480
ds_read_b64_tr_b16 a[202:203], v47 offset:20608
ds_read_b64_tr_b16 a[204:205], v47 offset:22528
ds_read_b64_tr_b16 a[206:207], v47 offset:22656
s_waitcnt lgkmcnt(0)
ds_read_b64_tr_b16 a[208:209], v47 offset:24576
ds_read_b64_tr_b16 a[210:211], v47 offset:24704
ds_read_b64_tr_b16 a[212:213], v47 offset:26624
ds_read_b64_tr_b16 a[214:215], v47 offset:26752
ds_read_b64_tr_b16 a[216:217], v47 offset:28672
ds_read_b64_tr_b16 a[218:219], v47 offset:28800
ds_read_b64_tr_b16 a[220:221], v47 offset:30720
ds_read_b64_tr_b16 a[222:223], v47 offset:30848
s_waitcnt lgkmcnt(0)
ds_read_b64_tr_b16 a[224:225], v47 offset:16416
ds_read_b64_tr_b16 a[226:227], v47 offset:16544
ds_read_b64_tr_b16 a[228:229], v47 offset:18464
ds_read_b64_tr_b16 a[230:231], v47 offset:18592
ds_read_b64_tr_b16 a[232:233], v47 offset:20512
ds_read_b64_tr_b16 a[234:235], v47 offset:20640
ds_read_b64_tr_b16 a[236:237], v47 offset:22560
ds_read_b64_tr_b16 a[238:239], v47 offset:22688
s_waitcnt lgkmcnt(0)
ds_read_b64_tr_b16 a[240:241], v47 offset:24608
ds_read_b64_tr_b16 a[242:243], v47 offset:24736
ds_read_b64_tr_b16 a[244:245], v47 offset:26656
ds_read_b64_tr_b16 a[246:247], v47 offset:26784
ds_read_b64_tr_b16 a[248:249], v47 offset:28704
ds_read_b64_tr_b16 a[250:251], v47 offset:28832
ds_read_b64_tr_b16 a[252:253], v47 offset:30752
ds_read_b64_tr_b16 a[254:255], v47 offset:30880
s_waitcnt lgkmcnt(0)
v_mov_b32 v32, v64
v_mov_b32 v33, v65
v_mov_b32 v34, v66
v_mov_b32 v35, v67
v_mov_b32 v36, v68
v_mov_b32 v37, v69
v_mov_b32 v38, v70
v_mov_b32 v39, v71
v_mov_b32 v40, v72
v_mov_b32 v41, v73
v_mov_b32 v42, v74
v_mov_b32 v43, v75
v_mov_b32 v44, v76
v_mov_b32 v45, v77
v_mov_b32 v46, v78
v_mov_b32 v47, v79
v_mov_b32 v96, 0
v_mov_b32 v97, 0
v_mov_b32 v98, 0
v_mov_b32 v99, 0
v_mov_b32 v100, 0
v_mov_b32 v101, 0
v_mov_b32 v102, 0
v_mov_b32 v103, 0
v_mov_b32 v104, 0
v_mov_b32 v105, 0
v_mov_b32 v106, 0
v_mov_b32 v107, 0
v_mov_b32 v108, 0
v_mov_b32 v109, 0
v_mov_b32 v110, 0
v_mov_b32 v111, 0
v_mov_b32 v112, 0
v_mov_b32 v113, 0
v_mov_b32 v114, 0
v_mov_b32 v115, 0
v_mov_b32 v116, 0
v_mov_b32 v117, 0
v_mov_b32 v118, 0
v_mov_b32 v119, 0
s_nop 1
v_smfmac_f32_16x16x64_bf16 v[96:99], v[32:35], a[0:7], v6
v_smfmac_f32_16x16x64_bf16 v[100:103], v[32:35], a[32:39], v6
v_smfmac_f32_16x16x64_bf16 v[104:107], v[32:35], a[64:71], v6
v_smfmac_f32_16x16x64_bf16 v[108:111], v[32:35], a[96:103], v6
v_smfmac_f32_16x16x64_bf16 v[96:99], v[36:39], a[8:15], v6
v_smfmac_f32_16x16x64_bf16 v[100:103], v[36:39], a[40:47], v6
v_smfmac_f32_16x16x64_bf16 v[104:107], v[36:39], a[72:79], v6
v_smfmac_f32_16x16x64_bf16 v[108:111], v[36:39], a[104:111], v6
v_smfmac_f32_16x16x64_bf16 v[96:99], v[40:43], a[16:23], v6
v_smfmac_f32_16x16x64_bf16 v[100:103], v[40:43], a[48:55], v6
v_smfmac_f32_16x16x64_bf16 v[104:107], v[40:43], a[80:87], v6
v_smfmac_f32_16x16x64_bf16 v[108:111], v[40:43], a[112:119], v6
v_smfmac_f32_16x16x64_bf16 v[96:99], v[44:47], a[24:31], v6
v_smfmac_f32_16x16x64_bf16 v[100:103], v[44:47], a[56:63], v6
v_smfmac_f32_16x16x64_bf16 v[104:107], v[44:47], a[88:95], v6
v_smfmac_f32_16x16x64_bf16 v[108:111], v[44:47], a[120:127], v6
v_and_b32 v247, 15, v0
v_lshlrev_b32 v247, 4, v247
s_branch mega_kernel_syrp
mega_kernel_syrw:
s_sleep 4
mega_kernel_syr:
buffer_load_dword v246, v247, s[72:75], 0 offen sc1
s_waitcnt vmcnt(0)
mega_kernel_syrp:
s_cmp_eq_u32 s95, 1
s_cbranch_scc0 mega_kernel_syrf
v_readlane_b32 s76, v246, 14
s_mov_b32 s98, 0
s_cmp_eq_u32 s76, 32
s_cbranch_scc0 mega_kernel_syrw
s_branch mega_kernel_syrd
mega_kernel_syrf:
s_mov_b32 s77, 0
s_mov_b32 s78, 0
v_readlane_b32 s76, v246, 0
s_add_u32 s77, s77, s76
s_xor_b32 s76, s76, 32
s_or_b32 s78, s78, s76
v_readlane_b32 s76, v246, 1
s_add_u32 s77, s77, s76
s_xor_b32 s76, s76, 32
s_or_b32 s78, s78, s76
v_readlane_b32 s76, v246, 2
s_add_u32 s77, s77, s76
s_xor_b32 s76, s76, 32
s_or_b32 s78, s78, s76
v_readlane_b32 s76, v246, 3
s_add_u32 s77, s77, s76
s_xor_b32 s76, s76, 32
s_or_b32 s78, s78, s76
v_readlane_b32 s76, v246, 4
s_add_u32 s77, s77, s76
s_xor_b32 s76, s76, 32
s_or_b32 s78, s78, s76
v_readlane_b32 s76, v246, 5
s_add_u32 s77, s77, s76
s_xor_b32 s76, s76, 32
s_or_b32 s78, s78, s76
v_readlane_b32 s76, v246, 6
s_add_u32 s77, s77, s76
s_xor_b32 s76, s76, 32
s_or_b32 s78, s78, s76
v_readlane_b32 s76, v246, 7
s_add_u32 s77, s77, s76
s_xor_b32 s76, s76, 32
s_or_b32 s78, s78, s76
s_cmp_eq_u32 s77, 256
s_cbranch_scc0 mega_kernel_syrw
v_mov_b32 v252, v246
s_cmp_eq_u32 s78, 0
s_cbranch_scc0 mega_kernel_slowent
v_readlane_b32 s76, v246, 10
v_readlane_b32 s77, v246, 8
s_cmp_eq_u32 s76, 32
s_cbranch_scc0 mega_kernel_syrw
s_cmp_gt_u32 s77, 16
s_cselect_b32 s98, 1, 0
mega_kernel_syrd:
s_lshr_b32 s28, s31, 4
s_lshl_b32 s28, s28, 14
s_lshl_b32 s29, s98, 13
s_add_u32 s28, s28, s29
s_and_b32 s29, s31, 15
s_lshl_b32 s29, s29, 9
s_add_u32 s28, s28, s29
s_lshl_b32 s29, s30, 16
s_add_u32 s28, s28, s29
s_add_u32 s28, s28, 67108864
v_lshrrev_b32 v12, 1, v17
v_add_u32 v12, s28, v12
v_xor_b32 v25, 0x10000, v12
v_xor_b32 v26, 0x20000, v12
v_xor_b32 v27, 0x30000, v12
v_add_u32 v25, 0, v25
v_add_u32 v26, 0, v26
v_add_u32 v27, 0, v27
s_lshl_b32 s28, s25, 2
s_add_u32 s28, s28, s26
s_mov_b32 s82, s28
s_lshr_b32 s29, s28, 3
s_xor_b32 s29, s29, s98
s_and_b32 s29, s29, 1
s_lshl_b32 s29, s29, 13
s_lshl_b32 s76, s28, 18
s_add_u32 s76, s76, s29
s_mov_b32 s83, s76
v_add_u32 v240, s76, v17
v_add_u32 v241, 33554432, v240
s_lshr_b32 s29, s28, 4
s_xor_b32 s29, s29, s98
s_and_b32 s29, s29, 1
s_lshl_b32 s29, s29, 13
s_lshl_b32 s79, s28, 17
s_add_u32 s79, s79, s29
s_add_u32 s79, s79, 71303168
s_xor_b32 s29, s98, 1
s_lshl_b32 s29, s29, 13
s_lshl_b32 s28, s25, 7
s_add_u32 s28, s28, s29
s_add_u32 s28, s28, 69206016
v_and_b32 v4, 1, v1
v_lshlrev_b32 v24, 12, v4
v_add_u32 v24, s28, v24
s_lshl_b32 s29, s26, 2
v_add_u32 v24, s29, v24
s_xor_b32 s81, s98, 1
s_lshl_b32 s81, s81, 13
s_lshr_b32 s29, s82, 6
s_lshl_b32 s29, s29, 14
s_add_u32 s81, s81, s29
s_and_b32 s29, s82, 63
s_lshl_b32 s29, s29, 7
s_add_u32 s81, s81, s29
s_add_u32 s81, s81, 69222400
v_mov_b32 v220, 0x3f803f80
v_mov_b32 v221, 0x3f803f80
v_mov_b32 v222, 0x3f803f80
v_mov_b32 v223, 0x3f803f80
v_mov_b32 v228, 0
s_mov_b32 s27, 0
s_mov_b32 s46, 0
s_mov_b32 s89, 0
s_mov_b32 s88, 0
s_mov_b32 s44, 18432
s_mov_b32 s45, 18432
s_cmp_eq_u32 s24, 3
s_cbranch_scc0 mega_kernel_rf_pfi
s_mov_b32 s76, 0
s_cmp_gt_i32 s46, s76
s_cbranch_scc1 mega_kernel_rf_pf0ok
mega_kernel_rf_pf0w:
v_mov_b32 v4, 0
s_mov_b64 exec, 3
buffer_atomic_add v4, v24, s[84:87], 0 offen sc0 sc1
s_mov_b64 exec, -1
s_waitcnt vmcnt(0)
v_readlane_b32 s46, v4, 0
v_readlane_b32 s28, v4, 1
s_nop 1
s_min_i32 s46, s46, s28
s_cmp_gt_i32 s46, s76
s_cbranch_scc0 mega_kernel_rf_pf0w
mega_kernel_rf_pf0ok:
s_add_u32 s77, s76, s82
s_bfe_u32 s28, s77, 0x40002
s_lshl_b32 s28, s28, 14
s_and_b32 s77, s77, 3
s_lshl_b32 s77, s77, 11
s_add_u32 s28, s28, s77
s_add_u32 m0, s45, 0
s_nop 0
buffer_load_dwordx4 v240, s[84:87], s28 offen offset:0 sc1 lds
s_add_u32 m0, s45, 0
s_nop 0
buffer_load_dwordx4 v240, s[84:87], s28 offen offset:1024 sc1 lds
s_add_u32 m0, s45, 2048
s_nop 0
buffer_load_dwordx4 v241, s[84:87], s28 offen offset:0 sc1 lds
s_add_u32 m0, s45, 2048
s_nop 0
buffer_load_dwordx4 v241, s[84:87], s28 offen offset:1024 sc1 lds
s_add_u32 s45, s45, 4096
s_cmp_eq_u32 s45, 30720
s_cselect_b32 s45, 18432, s45
s_waitcnt vmcnt(0) lgkmcnt(0)
mega_kernel_rf_pfi:
v_mov_b32 v184, 0
v_mov_b32 v185, 0
v_mov_b32 v186, 0
v_mov_b32 v187, 0
v_mov_b32 v188, 0
v_mov_b32 v189, 0
v_mov_b32 v190, 0
v_mov_b32 v191, 0
v_mov_b32 v192, 0
v_mov_b32 v193, 0
v_mov_b32 v194, 0
v_mov_b32 v195, 0
v_mov_b32 v196, 0
v_mov_b32 v197, 0
v_mov_b32 v198, 0
v_mov_b32 v199, 0
v_mov_b32 v200, 0
v_mov_b32 v201, 0
v_mov_b32 v202, 0
v_mov_b32 v203, 0
v_mov_b32 v204, 0
v_mov_b32 v205, 0
v_mov_b32 v206, 0
v_mov_b32 v207, 0
v_mov_b32 v249, 0
s_barrier
s_and_b32 s29, s27, 1
s_lshl_b32 s33, s29, 17
s_lshl_b32 s28, s30, 18
s_add_u32 s33, s33, s28
s_add_u32 s33, s33, 68157440
s_xor_b32 s34, s33, 131072
s_lshl_b32 s35, s29, 18
s_bfe_u32 s47, s27, 0x10001
s_branch mega_kernel_rf_first
.p2align 6
s_nop 0
s_nop 0
mega_kernel_rf_loop:
buffer_load_dwordx4 v[32:35], v7, s[84:87], s33 offen offset:0 sc1
v_add_u32 v5, s44, v17
ds_read_b128 v[156:159], v5 offset:0
ds_read_b128 v[160:163], v5 offset:1024
ds_read_b128 v[164:167], v5 offset:2048
ds_read_b128 v[168:171], v5 offset:3072
s_nop 4
buffer_load_dwordx4 v[36:39], v7, s[84:87], s33 offen offset:1024 sc1
s_nop 9
buffer_load_dwordx4 v[40:43], v7, s[84:87], s33 offen offset:2048 sc1
s_nop 9
buffer_load_dwordx4 v[44:47], v7, s[84:87], s33 offen offset:3072 sc1
s_waitcnt vmcnt(3)
v_max_u32 v4, v32, v34
v_cmp_eq_u32 vcc, -1, v4
s_cbranch_vccnz mega_kernel_rf_pa_15_0f
v_smfmac_f32_16x16x64_bf16 v[96:99], v[32:35], a[0:7], v6
v_smfmac_f32_16x16x64_bf16 v[100:103], v[32:35], a[32:39], v6
v_smfmac_f32_16x16x64_bf16 v[104:107], v[32:35], a[64:71], v6
s_waitcnt vmcnt(2)
v_max_u32 v4, v36, v38
v_cmp_eq_u32 vcc, -1, v4
v_smfmac_f32_16x16x64_bf16 v[108:111], v[32:35], a[96:103], v6
s_cbranch_vccnz mega_kernel_rf_pa_14_1f
v_smfmac_f32_16x16x64_bf16 v[96:99], v[36:39], a[8:15], v6
v_smfmac_f32_16x16x64_bf16 v[100:103], v[36:39], a[40:47], v6
v_smfmac_f32_16x16x64_bf16 v[104:107], v[36:39], a[72:79], v6
s_waitcnt vmcnt(1)
v_max_u32 v4, v40, v42
v_cmp_eq_u32 vcc, -1, v4
v_smfmac_f32_16x16x64_bf16 v[108:111], v[36:39], a[104:111], v6
s_cbranch_vccnz mega_kernel_rf_pa_12_2f
v_smfmac_f32_16x16x64_bf16 v[96:99], v[40:43], a[16:23], v6
v_smfmac_f32_16x16x64_bf16 v[100:103], v[40:43], a[48:55], v6
v_smfmac_f32_16x16x64_bf16 v[104:107], v[40:43], a[80:87], v6
s_waitcnt vmcnt(0)
v_max_u32 v4, v44, v46
v_cmp_eq_u32 vcc, -1, v4
v_smfmac_f32_16x16x64_bf16 v[108:111], v[40:43], a[112:119], v6
s_cbranch_vccnz mega_kernel_rf_pa_8_3f
v_smfmac_f32_16x16x64_bf16 v[96:99], v[44:47], a[24:31], v6
v_smfmac_f32_16x16x64_bf16 v[100:103], v[44:47], a[56:63], v6
v_smfmac_f32_16x16x64_bf16 v[104:107], v[44:47], a[88:95], v6
v_smfmac_f32_16x16x64_bf16 v[108:111], v[44:47], a[120:127], v6
mega_kernel_rf_pa_d:
mega_kernel_rf_adone:
s_nop 5
v_permlane32_swap_b32 v96, v100
v_permlane32_swap_b32 v97, v101
v_permlane32_swap_b32 v98, v102
v_permlane32_swap_b32 v99, v103
v_pk_add_f32 v[96:97], v[96:97], v[100:101]
v_pk_add_f32 v[98:99], v[98:99], v[102:103]
ds_write2_b32 v14, v96, v97 offset0:0 offset1:36
ds_write2_b32 v14, v98, v99 offset0:72 offset1:108
v_permlane32_swap_b32 v104, v108
v_permlane32_swap_b32 v105, v109
v_permlane32_swap_b32 v106, v110
v_permlane32_swap_b32 v107, v111
v_pk_add_f32 v[104:105], v[104:105], v[108:109]
v_pk_add_f32 v[106:107], v[106:107], v[110:111]
ds_write2_b32 v15, v104, v105 offset0:0 offset1:36
ds_write2_b32 v15, v106, v107 offset0:72 offset1:108
v_smfmac_f32_16x16x64_bf16 v[112:115], v[32:35], a[128:135], v6
v_smfmac_f32_16x16x64_bf16 v[116:119], v[32:35], a[160:167], v6
v_smfmac_f32_16x16x64_bf16 v[112:115], v[36:39], a[136:143], v6
v_smfmac_f32_16x16x64_bf16 v[116:119], v[36:39], a[168:175], v6
s_waitcnt lgkmcnt(0)
s_barrier
s_cmp_lg_u32 s24, 0
s_cbranch_scc1 mega_kernel_rf_side
ds_read_b128 v[120:123], v16 offset:0
ds_read_b128 v[124:127], v16 offset:16
ds_read_b128 v[128:131], v16 offset:2304
ds_read_b128 v[132:135], v16 offset:2320
ds_read_b128 v[136:139], v16 offset:4608
ds_read_b128 v[140:143], v16 offset:4624
ds_read_b128 v[144:147], v16 offset:6912
ds_read_b128 v[148:151], v16 offset:6928
v_smfmac_f32_16x16x64_bf16 v[112:115], v[40:43], a[144:151], v6
v_smfmac_f32_16x16x64_bf16 v[116:119], v[40:43], a[176:183], v6
v_smfmac_f32_16x16x64_bf16 v[112:115], v[44:47], a[152:159], v6
v_smfmac_f32_16x16x64_bf16 v[116:119], v[44:47], a[184:191], v6
s_mul_i32 s28, s31, 2048
s_add_u32 s28, s28, s33
s_add_u32 s28, s28, 49152
s_add_u32 s76, s37, s33
s_add_u32 s77, s38, s33
s_add_u32 s78, s39, s33
s_waitcnt lgkmcnt(4)
v_pk_add_f32 v[120:121], v[120:121], v[128:129]
v_pk_add_f32 v[122:123], v[122:123], v[130:131]
v_pk_add_f32 v[124:125], v[124:125], v[132:133]
v_pk_add_f32 v[126:127], v[126:127], v[134:135]
s_waitcnt lgkmcnt(0)
v_pk_add_f32 v[136:137], v[136:137], v[144:145]
v_pk_add_f32 v[138:139], v[138:139], v[146:147]
v_pk_add_f32 v[140:141], v[140:141], v[148:149]
v_pk_add_f32 v[142:143], v[142:143], v[150:151]
v_pk_add_f32 v[120:121], v[120:121], v[136:137]
v_pk_add_f32 v[122:123], v[122:123], v[138:139]
v_pk_add_f32 v[124:125], v[124:125], v[140:141]
v_pk_add_f32 v[126:127], v[126:127], v[142:143]
v_cvt_pk_bf16_f32 v152, v120, v121
v_cvt_pk_bf16_f32 v153, v122, v123
v_cvt_pk_bf16_f32 v154, v124, v125
v_cvt_pk_bf16_f32 v155, v126, v127
s_nop 1
v_mfma_f32_16x16x32_bf16 v[176:179], v[160:163], v[152:155], 0
v_mfma_f32_16x16x32_bf16 v[172:175], v[156:159], v[152:155], 0
v_mfma_f32_16x16x32_bf16 v[180:183], v[152:155], v[152:155], 0
s_cmp_eq_u32 s27, 63
s_cbranch_scc1 mega_kernel_rf_w0last
s_nop 4
v_mov_b32_dpp v172, v176 row_shr:8 row_mask:0xf bank_mask:0xc
v_mov_b32_dpp v173, v177 row_shr:8 row_mask:0xf bank_mask:0xc
v_mov_b32_dpp v174, v178 row_shr:8 row_mask:0xf bank_mask:0xc
v_mov_b32_dpp v175, v179 row_shr:8 row_mask:0xf bank_mask:0xc
v_min_u32 v180, -2, v180
v_min_u32 v172, -2, v172
s_mov_b64 exec, s[42:43]
buffer_store_dwordx4 v[180:183], v10, s[84:87], s28 offen
s_mov_b64 exec, -1
buffer_store_dwordx4 v[172:175], v17, s[84:87], s28 offen
v_permlane32_swap_b32 v112, v116
v_permlane32_swap_b32 v113, v117
v_permlane32_swap_b32 v114, v118
v_permlane32_swap_b32 v115, v119
v_pk_add_f32 v[112:113], v[112:113], v[116:117]
v_pk_add_f32 v[114:115], v[114:115], v[118:119]
ds_write_b128 v20, v[112:115]
s_waitcnt lgkmcnt(0)
s_barrier
v_mov_b32 v96, 0
v_mov_b32 v97, 0
v_mov_b32 v98, 0
v_mov_b32 v99, 0
v_mov_b32 v100, 0
v_mov_b32 v101, 0
v_mov_b32 v102, 0
v_mov_b32 v103, 0
v_cndmask_b32 v176, v23, v180, s[42:43]
v_cndmask_b32 v177, v23, v181, s[42:43]
v_cndmask_b32 v178, v23, v182, s[42:43]
v_cndmask_b32 v179, v23, v183, s[42:43]
s_mov_b64 exec, s[42:43]
buffer_load_dwordx4 v[188:191], v10, s[84:87], s76 offen sc1
buffer_load_dwordx4 v[196:199], v10, s[84:87], s77 offen sc1
buffer_load_dwordx4 v[204:207], v10, s[84:87], s78 offen sc1
s_mov_b64 exec, -1
buffer_load_dwordx4 v[184:187], v17, s[84:87], s76 offen sc1
buffer_load_dwordx4 v[192:195], v17, s[84:87], s77 offen sc1
buffer_load_dwordx4 v[200:203], v17, s[84:87], s78 offen sc1
v_pk_mul_f32 v[172:173], v[172:173], s[32:33] op_sel_hi:[1,0]
v_pk_mul_f32 v[174:175], v[174:175], s[32:33] op_sel_hi:[1,0]
v_pk_mul_f32 v[176:177], v[176:177], s[32:33] op_sel_hi:[1,0]
v_pk_mul_f32 v[178:179], v[178:179], s[32:33] op_sel_hi:[1,0]
s_lshl_b32 s89, s47, 31
s_or_b32 s89, s89, 0x3b39999a
s_nop 15
s_nop 1
s_mov_b64 exec, s[42:43]
buffer_load_dwordx4 v[188:191], v10, s[84:87], s76 offen sc1
buffer_load_dwordx4 v[196:199], v10, s[84:87], s77 offen sc1
buffer_load_dwordx4 v[204:207], v10, s[84:87], s78 offen sc1
s_mov_b64 exec, -1
buffer_load_dwordx4 v[184:187], v17, s[84:87], s76 offen sc1
buffer_load_dwordx4 v[192:195], v17, s[84:87], s77 offen sc1
buffer_load_dwordx4 v[200:203], v17, s[84:87], s78 offen sc1
mega_kernel_rf_p2:
s_waitcnt vmcnt(6)
v_max3_u32 v4, v184, v188, v192
v_max3_u32 v5, v196, v200, v204
v_max_u32 v4, v4, v5
v_cmp_eq_u32 vcc, -1, v4
s_cbranch_vccnz mega_kernel_rf_p2r
v_pk_add_f32 v[124:125], v[196:197], v[204:205]
v_pk_add_f32 v[126:127], v[198:199], v[206:207]
v_pk_add_f32 v[120:121], v[192:193], v[200:201]
v_pk_add_f32 v[122:123], v[194:195], v[202:203]
v_pk_add_f32 v[124:125], v[124:125], v[188:189]
v_pk_add_f32 v[126:127], v[126:127], v[190:191]
v_pk_add_f32 v[120:121], v[120:121], v[184:185]
v_pk_add_f32 v[122:123], v[122:123], v[186:187]
v_pk_fma_f32 v[176:177], v[124:125], s[32:33], v[176:177] op_sel_hi:[1,0,1]
v_pk_fma_f32 v[178:179], v[126:127], s[32:33], v[178:179] op_sel_hi:[1,0,1]
v_pk_fma_f32 v[172:173], v[120:121], s[32:33], v[172:173] op_sel_hi:[1,0,1]
v_pk_fma_f32 v[174:175], v[122:123], s[32:33], v[174:175] op_sel_hi:[1,0,1]
v_max3_f32 v232, v172, v173, v174
v_max3_f32 v233, v176, v177, v178
v_max3_f32 v232, v232, v175, v179
v_max_f32 v234, v232, v233
s_barrier
ds_read2_b64 v[208:211], v21 offset0:0 offset1:32
v_max_f32_dpp v232, v234, v234 row_ror:8 row_mask:0xf bank_mask:0xf
v_max_f32_dpp v233, v234, v234 row_ror:8 row_mask:0xf bank_mask:0xf
s_nop 1
v_permlane16_swap_b32 v232, v233
s_nop 0
v_max_f32 v234, v232, v233
v_max_f32 v235, v232, v233
s_nop 1
v_permlane32_swap_b32 v234, v235
s_nop 0
v_max_f32 v232, v234, v235
v_pk_add_f32 v[176:177], v[176:177], v[232:233] op_sel_hi:[1,0] neg_lo:[0,1] neg_hi:[0,1]
v_pk_add_f32 v[178:179], v[178:179], v[232:233] op_sel_hi:[1,0] neg_lo:[0,1] neg_hi:[0,1]
v_pk_add_f32 v[172:173], v[172:173], v[232:233] op_sel_hi:[1,0] neg_lo:[0,1] neg_hi:[0,1]
v_pk_add_f32 v[174:175], v[174:175], v[232:233] op_sel_hi:[1,0] neg_lo:[0,1] neg_hi:[0,1]
v_exp_f32 v176, v176
v_exp_f32 v177, v177
v_exp_f32 v178, v178
v_exp_f32 v179, v179
v_exp_f32 v172, v172
v_cvt_pk_bf16_f32 v216, v176, v177
v_cvt_pk_bf16_f32 v217, v178, v179
v_exp_f32 v173, v173
v_exp_f32 v174, v174
v_mfma_f32_16x16x16_bf16 v[224:227], v[220:221], v[216:217], 0
v_exp_f32 v175, v175
v_cvt_pk_bf16_f32 v212, v172, v173
s_waitcnt lgkmcnt(0)
v_mfma_f32_16x16x16_bf16 v[120:123], v[208:209], v[216:217], 0
v_cvt_pk_bf16_f32 v213, v174, v175
v_mfma_f32_16x16x16_bf16 v[124:127], v[210:211], v[216:217], 0
v_mov_b32_dpp v214, v212 row_ror:8 row_mask:0xf bank_mask:0xf
v_mov_b32_dpp v215, v213 row_ror:8 row_mask:0xf bank_mask:0xf
s_nop 1
v_mfma_f32_16x16x32_bf16 v[224:227], v[220:223], v[212:215], v[224:227]
v_mfma_f32_16x16x32_bf16 v[120:123], v[164:167], v[212:215], v[120:123]
v_mfma_f32_16x16x32_bf16 v[124:127], v[168:171], v[212:215], v[124:127]
s_add_u32 s29, s33, 24576
s_nop 4
v_rcp_f32 v234, v224
s_nop 0
v_pk_mul_f32 v[120:121], v[120:121], v[234:235] op_sel_hi:[1,0]
v_pk_mul_f32 v[122:123], v[122:123], v[234:235] op_sel_hi:[1,0]
v_pk_mul_f32 v[124:125], v[124:125], v[234:235] op_sel_hi:[1,0]
v_pk_mul_f32 v[126:127], v[126:127], v[234:235] op_sel_hi:[1,0]
v_cvt_pk_bf16_f32 v212, v120, v121
v_cvt_pk_bf16_f32 v213, v122, v123
v_cvt_pk_bf16_f32 v214, v124, v125
v_cvt_pk_bf16_f32 v215, v126, v127
v_min_u32 v212, -2, v212
s_mov_b64 exec, s[40:41]
buffer_store_dwordx4 v[212:215], v11, s[84:87], s33 offen
s_mov_b64 exec, -1
mega_kernel_rf_b3:
s_barrier
s_nop 15
buffer_load_dwordx4 v[32:35], v7, s[84:87], s29 offen offset:0 sc1
s_nop 9
buffer_load_dwordx4 v[36:39], v7, s[84:87], s29 offen offset:1024 sc1
s_nop 9
buffer_load_dwordx4 v[40:43], v7, s[84:87], s29 offen offset:2048 sc1
s_nop 9
buffer_load_dwordx4 v[44:47], v7, s[84:87], s29 offen offset:3072 sc1
mega_kernel_rf_pc_15_0:
s_waitcnt vmcnt(3)
v_cmp_eq_u32 vcc, -1, v32
s_cbranch_vccnz mega_kernel_rf_pc_15_0f
v_smfmac_f32_16x16x64_bf16 v[96:99], v[32:35], a[192:199], v6
v_smfmac_f32_16x16x64_bf16 v[100:103], v[32:35], a[224:231], v6
mega_kernel_rf_pc_14_1:
s_waitcnt vmcnt(2)
v_cmp_eq_u32 vcc, -1, v36
s_cbranch_vccnz mega_kernel_rf_pc_14_1f
v_smfmac_f32_16x16x64_bf16 v[96:99], v[36:39], a[200:207], v6
v_smfmac_f32_16x16x64_bf16 v[100:103], v[36:39], a[232:239], v6
mega_kernel_rf_pc_12_2:
s_waitcnt vmcnt(1)
v_cmp_eq_u32 vcc, -1, v40
s_cbranch_vccnz mega_kernel_rf_pc_12_2f
v_smfmac_f32_16x16x64_bf16 v[96:99], v[40:43], a[208:215], v6
v_smfmac_f32_16x16x64_bf16 v[100:103], v[40:43], a[240:247], v6
mega_kernel_rf_pc_8_3:
s_waitcnt vmcnt(0)
v_cmp_eq_u32 vcc, -1, v44
s_cbranch_vccnz mega_kernel_rf_pc_8_3f
v_smfmac_f32_16x16x64_bf16 v[96:99], v[44:47], a[216:223], v6
v_smfmac_f32_16x16x64_bf16 v[100:103], v[44:47], a[248:255], v6
mega_kernel_rf_pc_d:
s_nop 7
v_permlane32_swap_b32 v96, v100
v_permlane32_swap_b32 v97, v101
v_permlane32_swap_b32 v98, v102
v_permlane32_swap_b32 v99, v103
v_pk_add_f32 v[96:97], v[96:97], v[100:101]
v_pk_add_f32 v[98:99], v[98:99], v[102:103]
ds_write2_b32 v18, v96, v97 offset0:0 offset1:36
ds_write2_b32 v18, v98, v99 offset0:72 offset1:108
s_waitcnt lgkmcnt(0)
s_barrier
s_cmp_lg_u32 s24, 0
s_cbranch_scc1 mega_kernel_rf_x1
ds_read_b128 v[120:123], v19 offset:0
ds_read_b128 v[124:127], v19 offset:1152
ds_read_b128 v[128:131], v19 offset:2304
ds_read_b128 v[132:135], v19 offset:3456
s_waitcnt lgkmcnt(2)
v_pk_add_f32 v[120:121], v[120:121], v[124:125]
v_pk_add_f32 v[122:123], v[122:123], v[126:127]
s_waitcnt lgkmcnt(0)
v_pk_add_f32 v[128:129], v[128:129], v[132:133]
v_pk_add_f32 v[130:131], v[130:131], v[134:135]
v_pk_add_f32 v[120:121], v[120:121], v[128:129]
v_pk_add_f32 v[122:123], v[122:123], v[130:131]
v_fma_f32 v212, v120, s89, v120
v_cvt_pk_bf16_f32 v213, v122, v123
v_cvt_pk_bf16_f32 v212, v212, v121
v_and_or_b32 v212, v212, -2, s47
buffer_store_dwordx2 v[212:213], v12, s[84:87], s35 offen sc1
s_mov_b32 s77, 0x3f80
s_mov_b32 s78, 0x3f800000
s_xor_b32 s76, s47, 1
v_mov_b32 v48, s76
v_mov_b32 v50, s76
v_mov_b32 v52, s76
s_nop 8
v_mov_b32 v96, 0
v_mov_b32 v97, 0
v_mov_b32 v98, 0
v_mov_b32 v99, 0
v_mov_b32 v100, 0
v_mov_b32 v101, 0
v_mov_b32 v102, 0
v_mov_b32 v103, 0
v_mov_b32 v104, 0
v_mov_b32 v105, 0
v_mov_b32 v106, 0
v_mov_b32 v107, 0
v_mov_b32 v108, 0
v_mov_b32 v109, 0
v_mov_b32 v110, 0
v_mov_b32 v111, 0
v_mov_b32 v112, 0
v_mov_b32 v113, 0
v_mov_b32 v114, 0
v_mov_b32 v115, 0
v_mov_b32 v116, 0
v_mov_b32 v117, 0
v_mov_b32 v118, 0
v_mov_b32 v119, 0
s_nop 15
s_nop 7
s_cmp_eq_u32 s47, 1
s_cbranch_scc1 mega_kernel_rf_p4_1
.p2align 6
mega_kernel_rf_p4_0:
buffer_load_dwordx2 v[48:49], v25, s[84:87], s35 offen sc1
buffer_load_dwordx2 v[50:51], v26, s[84:87], s35 offen sc1
buffer_load_dwordx2 v[52:53], v27, s[84:87], s35 offen sc1
s_waitcnt vmcnt(12)
mega_kernel_rf_p4c_0:
v_bitop3_b32 v4, v48, v50, v52 bitop3:0xfe
v_and_b32 v4, 1, v4
v_cmp_ne_u32 vcc, 0, v4
s_cbranch_vccnz mega_kernel_rf_p4_0
v_dot2_f32_bf16 v120, v48, s77, v120
v_dot2_f32_bf16 v121, v48, s78, v121
v_dot2_f32_bf16 v122, v49, s77, v122
v_dot2_f32_bf16 v123, v49, s78, v123
v_dot2_f32_bf16 v120, v50, s77, v120
v_dot2_f32_bf16 v121, v50, s78, v121
v_dot2_f32_bf16 v122, v51, s77, v122
v_dot2_f32_bf16 v123, v51, s78, v123
v_dot2_f32_bf16 v120, v52, s77, v120
v_dot2_f32_bf16 v121, v52, s78, v121
v_dot2_f32_bf16 v122, v53, s77, v122
v_dot2_f32_bf16 v123, v53, s78, v123
s_nop 0
v_cvt_pk_bf16_f32 v212, v120, v121
v_min_u32 v212, -2, v212
v_cvt_pk_bf16_f32 v213, v122, v123
buffer_store_dwordx2 v[212:213], v9, s[84:87], s34 offen
s_branch mega_kernel_rf_p4d
mega_kernel_rf_iw0:
mega_kernel_rf_il0:
s_cbranch_execz mega_kernel_rf_il1
.p2align 6
mega_kernel_rf_p4_1:
buffer_load_dwordx2 v[48:49], v25, s[84:87], s35 offen sc1
buffer_load_dwordx2 v[50:51], v26, s[84:87], s35 offen sc1
buffer_load_dwordx2 v[52:53], v27, s[84:87], s35 offen sc1
s_waitcnt vmcnt(12)
mega_kernel_rf_p4c_1:
v_bitop3_b32 v4, v48, v50, v52 bitop3:0x80
v_and_b32 v4, 1, v4
v_cmp_ne_u32 vcc, 1, v4
s_cbranch_vccnz mega_kernel_rf_p4_1
v_dot2_f32_bf16 v120, v48, s77, v120
v_dot2_f32_bf16 v121, v48, s78, v121
v_dot2_f32_bf16 v122, v49, s77, v122
v_dot2_f32_bf16 v123, v49, s78, v123
v_dot2_f32_bf16 v120, v50, s77, v120
v_dot2_f32_bf16 v121, v50, s78, v121
v_dot2_f32_bf16 v122, v51, s77, v122
v_dot2_f32_bf16 v123, v51, s78, v123
v_dot2_f32_bf16 v120, v52, s77, v120
v_dot2_f32_bf16 v121, v52, s78, v121
v_dot2_f32_bf16 v122, v53, s77, v122
v_dot2_f32_bf16 v123, v53, s78, v123
s_nop 0
v_cvt_pk_bf16_f32 v212, v120, v121
v_min_u32 v212, -2, v212
v_cvt_pk_bf16_f32 v213, v122, v123
buffer_store_dwordx2 v[212:213], v9, s[84:87], s34 offen
mega_kernel_rf_p4d:
mega_kernel_rf_b5:
s_add_u32 s27, s27, 1
s_add_u32 s44, s44, 4096
s_cmp_eq_u32 s44, 30720
s_cselect_b32 s44, 18432, s44
s_mov_b32 s28, s33
s_mov_b32 s33, s34
s_mov_b32 s34, s28
s_xor_b32 s35, s35, 262144
s_bfe_u32 s47, s27, 0x10001
s_barrier
s_nop 15
s_branch mega_kernel_rf_loop
mega_kernel_rf_il1:
s_cbranch_execz mega_kernel_rf_il2
mega_kernel_rf_x1:
s_cmp_eq_u32 s24, 1
s_cbranch_scc0 mega_kernel_rf_x2
s_add_u32 s76, s27, 1
v_mov_b32 v5, s76
s_mov_b64 exec, 1
buffer_store_dword v5, v228, s[84:87], s81 offen sc1
s_mov_b64 exec, -1
mega_kernel_rf_x2:
s_cmp_eq_u32 s24, 3
s_cbranch_scc0 mega_kernel_rf_x4
s_cmp_eq_u32 s36, 1
s_cbranch_scc0 mega_kernel_rf_x5
s_add_u32 s76, s27, 1
s_cmp_gt_i32 s46, s76
s_cbranch_scc1 mega_kernel_rf_pf1ok
mega_kernel_rf_pf1w:
v_mov_b32 v4, 0
s_mov_b64 exec, 3
buffer_atomic_add v4, v24, s[84:87], 0 offen sc0 sc1
s_mov_b64 exec, -1
s_waitcnt vmcnt(0)
v_readlane_b32 s46, v4, 0
v_readlane_b32 s28, v4, 1
s_nop 1
s_min_i32 s46, s46, s28
s_cmp_gt_i32 s46, s76
s_cbranch_scc0 mega_kernel_rf_pf1w
mega_kernel_rf_pf1ok:
s_add_u32 s77, s76, s82
s_bfe_u32 s28, s77, 0x40002
s_lshl_b32 s28, s28, 14
s_and_b32 s77, s77, 3
s_lshl_b32 s77, s77, 11
s_add_u32 s28, s28, s77
s_add_u32 m0, s45, 0
s_nop 0
buffer_load_dwordx4 v240, s[84:87], s28 offen offset:0 sc1 lds
s_add_u32 m0, s45, 0
s_nop 0
buffer_load_dwordx4 v240, s[84:87], s28 offen offset:1024 sc1 lds
s_add_u32 m0, s45, 2048
s_nop 0
buffer_load_dwordx4 v241, s[84:87], s28 offen offset:0 sc1 lds
s_add_u32 m0, s45, 2048
s_nop 0
buffer_load_dwordx4 v241, s[84:87], s28 offen offset:1024 sc1 lds
s_add_u32 s45, s45, 4096
s_cmp_eq_u32 s45, 30720
s_cselect_b32 s45, 18432, s45
s_waitcnt vmcnt(0)
mega_kernel_rf_x5:
s_add_u32 s76, s27, 4
s_min_u32 s76, s76, 63
s_cmp_gt_i32 s46, s76
s_cbranch_scc1 mega_kernel_rf_x6
v_mov_b32 v249, 0
s_mov_b64 exec, 3
buffer_atomic_add v249, v24, s[84:87], 0 offen sc0 sc1
s_mov_b64 exec, -1
mega_kernel_rf_x6:
s_add_u32 s76, s27, 2
s_cmp_lt_u32 s76, 63
s_cbranch_scc0 mega_kernel_rf_x4
s_cmp_gt_i32 s46, s76
s_cbranch_scc0 mega_kernel_rf_x4
s_add_u32 s77, s76, s82
s_bfe_u32 s28, s77, 0x40002
s_lshl_b32 s28, s28, 14
s_and_b32 s77, s77, 3
s_lshl_b32 s77, s77, 11
s_add_u32 s28, s28, s77
s_add_u32 s28, s28, s83
s_add_u32 s28, s28, 33554432
s_buffer_load_dword s78, s[84:87], s28 offset:0
s_buffer_load_dword s78, s[84:87], s28 offset:128
s_buffer_load_dword s78, s[84:87], s28 offset:256
s_buffer_load_dword s78, s[84:87], s28 offset:384
s_buffer_load_dword s78, s[84:87], s28 offset:512
s_buffer_load_dword s78, s[84:87], s28 offset:640
s_buffer_load_dword s78, s[84:87], s28 offset:768
s_buffer_load_dword s78, s[84:87], s28 offset:896
s_buffer_load_dword s78, s[84:87], s28 offset:1024
s_buffer_load_dword s78, s[84:87], s28 offset:1152
s_buffer_load_dword s78, s[84:87], s28 offset:1280
s_buffer_load_dword s78, s[84:87], s28 offset:1408
s_buffer_load_dword s78, s[84:87], s28 offset:1536
s_buffer_load_dword s78, s[84:87], s28 offset:1664
s_buffer_load_dword s78, s[84:87], s28 offset:1792
s_buffer_load_dword s78, s[84:87], s28 offset:1920
s_mov_b32 s89, s76
mega_kernel_rf_x4:
v_mov_b32 v96, 0
v_mov_b32 v97, 0
v_mov_b32 v98, 0
v_mov_b32 v99, 0
v_mov_b32 v100, 0
v_mov_b32 v101, 0
v_mov_b32 v102, 0
v_mov_b32 v103, 0
v_mov_b32 v104, 0
v_mov_b32 v105, 0
v_mov_b32 v106, 0
v_mov_b32 v107, 0
v_mov_b32 v108, 0
v_mov_b32 v109, 0
v_mov_b32 v110, 0
v_mov_b32 v111, 0
v_mov_b32 v112, 0
v_mov_b32 v113, 0
v_mov_b32 v114, 0
v_mov_b32 v115, 0
v_mov_b32 v116, 0
v_mov_b32 v117, 0
v_mov_b32 v118, 0
v_mov_b32 v119, 0
s_branch mega_kernel_rf_b5
mega_kernel_rf_il2:
s_cbranch_execz mega_kernel_rf_il3
mega_kernel_rf_p2r:
s_mov_b64 exec, s[42:43]
buffer_load_dwordx4 v[188:191], v10, s[84:87], s76 offen sc1
buffer_load_dwordx4 v[196:199], v10, s[84:87], s77 offen sc1
buffer_load_dwordx4 v[204:207], v10, s[84:87], s78 offen sc1
s_mov_b64 exec, -1
buffer_load_dwordx4 v[184:187], v17, s[84:87], s76 offen sc1
buffer_load_dwordx4 v[192:195], v17, s[84:87], s77 offen sc1
buffer_load_dwordx4 v[200:203], v17, s[84:87], s78 offen sc1
s_branch mega_kernel_rf_p2
mega_kernel_rf_il3:
s_cbranch_execz mega_kernel_rf_il4
.p2align 5
mega_kernel_rf_pa_1_0f:
s_mov_b64 exec, vcc
buffer_load_dwordx4 v[32:35], v7, s[84:87], s33 offen offset:0 sc1
s_mov_b64 exec, -1
s_branch mega_kernel_rf_pa_1_0
.p2align 5
mega_kernel_rf_pa_1_0:
s_waitcnt vmcnt(0)
v_max_u32 v4, v32, v34
v_cmp_eq_u32 vcc, -1, v4
s_cbranch_vccnz mega_kernel_rf_pa_1_0f
v_smfmac_f32_16x16x64_bf16 v[96:99], v[32:35], a[0:7], v6
v_smfmac_f32_16x16x64_bf16 v[100:103], v[32:35], a[32:39], v6
v_smfmac_f32_16x16x64_bf16 v[104:107], v[32:35], a[64:71], v6
v_smfmac_f32_16x16x64_bf16 v[108:111], v[32:35], a[96:103], v6
s_branch mega_kernel_rf_pa_d
mega_kernel_rf_il4:
s_cbranch_execz mega_kernel_rf_il5
.p2align 5
mega_kernel_rf_pa_2_1f:
s_mov_b64 exec, vcc
buffer_load_dwordx4 v[36:39], v7, s[84:87], s33 offen offset:1024 sc1
s_mov_b64 exec, -1
s_branch mega_kernel_rf_pa_2_1
.p2align 5
mega_kernel_rf_pa_2_1:
s_waitcnt vmcnt(0)
v_max_u32 v4, v36, v38
v_cmp_eq_u32 vcc, -1, v4
s_cbranch_vccnz mega_kernel_rf_pa_2_1f
v_smfmac_f32_16x16x64_bf16 v[96:99], v[36:39], a[8:15], v6
v_smfmac_f32_16x16x64_bf16 v[100:103], v[36:39], a[40:47], v6
v_smfmac_f32_16x16x64_bf16 v[104:107], v[36:39], a[72:79], v6
v_smfmac_f32_16x16x64_bf16 v[108:111], v[36:39], a[104:111], v6
s_branch mega_kernel_rf_pa_d
mega_kernel_rf_il5:
s_cbranch_execz mega_kernel_rf_il6
.p2align 5
mega_kernel_rf_pa_3_0f:
s_mov_b64 exec, vcc
buffer_load_dwordx4 v[32:35], v7, s[84:87], s33 offen offset:0 sc1
s_mov_b64 exec, -1
s_branch mega_kernel_rf_pa_3_1
.p2align 5
mega_kernel_rf_pa_3_0:
s_waitcnt vmcnt(1)
v_max_u32 v4, v32, v34
v_cmp_eq_u32 vcc, -1, v4
s_cbranch_vccnz mega_kernel_rf_pa_3_0f
v_smfmac_f32_16x16x64_bf16 v[96:99], v[32:35], a[0:7], v6
v_smfmac_f32_16x16x64_bf16 v[100:103], v[32:35], a[32:39], v6
v_smfmac_f32_16x16x64_bf16 v[104:107], v[32:35], a[64:71], v6
v_smfmac_f32_16x16x64_bf16 v[108:111], v[32:35], a[96:103], v6
s_branch mega_kernel_rf_pa_2_1
mega_kernel_rf_il6:
s_cbranch_execz mega_kernel_rf_il7
.p2align 5
mega_kernel_rf_pa_3_1f:
s_mov_b64 exec, vcc
buffer_load_dwordx4 v[36:39], v7, s[84:87], s33 offen offset:1024 sc1
s_mov_b64 exec, -1
s_branch mega_kernel_rf_pa_3_0
.p2align 5
mega_kernel_rf_pa_3_1:
s_waitcnt vmcnt(1)
v_max_u32 v4, v36, v38
v_cmp_eq_u32 vcc, -1, v4
s_cbranch_vccnz mega_kernel_rf_pa_3_1f
v_smfmac_f32_16x16x64_bf16 v[96:99], v[36:39], a[8:15], v6
v_smfmac_f32_16x16x64_bf16 v[100:103], v[36:39], a[40:47], v6
v_smfmac_f32_16x16x64_bf16 v[104:107], v[36:39], a[72:79], v6
v_smfmac_f32_16x16x64_bf16 v[108:111], v[36:39], a[104:111], v6
s_branch mega_kernel_rf_pa_1_0
mega_kernel_rf_il7:
s_cbranch_execz mega_kernel_rf_il8
.p2align 5
mega_kernel_rf_pa_4_2f:
s_mov_b64 exec, vcc
buffer_load_dwordx4 v[40:43], v7, s[84:87], s33 offen offset:2048 sc1
s_mov_b64 exec, -1
s_branch mega_kernel_rf_pa_4_2
.p2align 5
mega_kernel_rf_pa_4_2:
s_waitcnt vmcnt(0)
v_max_u32 v4, v40, v42
v_cmp_eq_u32 vcc, -1, v4
s_cbranch_vccnz mega_kernel_rf_pa_4_2f
v_smfmac_f32_16x16x64_bf16 v[96:99], v[40:43], a[16:23], v6
v_smfmac_f32_16x16x64_bf16 v[100:103], v[40:43], a[48:55], v6
v_smfmac_f32_16x16x64_bf16 v[104:107], v[40:43], a[80:87], v6
v_smfmac_f32_16x16x64_bf16 v[108:111], v[40:43], a[112:119], v6
s_branch mega_kernel_rf_pa_d
mega_kernel_rf_il8:
s_cbranch_execz mega_kernel_rf_il9
.p2align 5
mega_kernel_rf_pa_5_0f:
s_mov_b64 exec, vcc
buffer_load_dwordx4 v[32:35], v7, s[84:87], s33 offen offset:0 sc1
s_mov_b64 exec, -1
s_branch mega_kernel_rf_pa_5_2
.p2align 5
mega_kernel_rf_pa_5_0:
s_waitcnt vmcnt(1)
v_max_u32 v4, v32, v34
v_cmp_eq_u32 vcc, -1, v4
s_cbranch_vccnz mega_kernel_rf_pa_5_0f
v_smfmac_f32_16x16x64_bf16 v[96:99], v[32:35], a[0:7], v6
v_smfmac_f32_16x16x64_bf16 v[100:103], v[32:35], a[32:39], v6
v_smfmac_f32_16x16x64_bf16 v[104:107], v[32:35], a[64:71], v6
v_smfmac_f32_16x16x64_bf16 v[108:111], v[32:35], a[96:103], v6
s_branch mega_kernel_rf_pa_4_2
mega_kernel_rf_il9:
s_cbranch_execz mega_kernel_rf_il10
.p2align 5
mega_kernel_rf_pa_5_2f:
s_mov_b64 exec, vcc
buffer_load_dwordx4 v[40:43], v7, s[84:87], s33 offen offset:2048 sc1
s_mov_b64 exec, -1
s_branch mega_kernel_rf_pa_5_0
.p2align 5
mega_kernel_rf_pa_5_2:
s_waitcnt vmcnt(1)
v_max_u32 v4, v40, v42
v_cmp_eq_u32 vcc, -1, v4
s_cbranch_vccnz mega_kernel_rf_pa_5_2f
v_smfmac_f32_16x16x64_bf16 v[96:99], v[40:43], a[16:23], v6
v_smfmac_f32_16x16x64_bf16 v[100:103], v[40:43], a[48:55], v6
v_smfmac_f32_16x16x64_bf16 v[104:107], v[40:43], a[80:87], v6
v_smfmac_f32_16x16x64_bf16 v[108:111], v[40:43], a[112:119], v6
s_branch mega_kernel_rf_pa_1_0
mega_kernel_rf_il10:
s_cbranch_execz mega_kernel_rf_il11
.p2align 5
mega_kernel_rf_pa_6_1f:
s_mov_b64 exec, vcc
buffer_load_dwordx4 v[36:39], v7, s[84:87], s33 offen offset:1024 sc1
s_mov_b64 exec, -1
s_branch mega_kernel_rf_pa_6_2
.p2align 5
mega_kernel_rf_pa_6_1:
s_waitcnt vmcnt(1)
v_max_u32 v4, v36, v38
v_cmp_eq_u32 vcc, -1, v4
s_cbranch_vccnz mega_kernel_rf_pa_6_1f
v_smfmac_f32_16x16x64_bf16 v[96:99], v[36:39], a[8:15], v6
v_smfmac_f32_16x16x64_bf16 v[100:103], v[36:39], a[40:47], v6
v_smfmac_f32_16x16x64_bf16 v[104:107], v[36:39], a[72:79], v6
v_smfmac_f32_16x16x64_bf16 v[108:111], v[36:39], a[104:111], v6
s_branch mega_kernel_rf_pa_4_2
mega_kernel_rf_il11:
s_cbranch_execz mega_kernel_rf_il12
.p2align 5
mega_kernel_rf_pa_6_2f:
s_mov_b64 exec, vcc
buffer_load_dwordx4 v[40:43], v7, s[84:87], s33 offen offset:2048 sc1
s_mov_b64 exec, -1
s_branch mega_kernel_rf_pa_6_1
.p2align 5
mega_kernel_rf_pa_6_2:
s_waitcnt vmcnt(1)
v_max_u32 v4, v40, v42
v_cmp_eq_u32 vcc, -1, v4
s_cbranch_vccnz mega_kernel_rf_pa_6_2f
v_smfmac_f32_16x16x64_bf16 v[96:99], v[40:43], a[16:23], v6
v_smfmac_f32_16x16x64_bf16 v[100:103], v[40:43], a[48:55], v6
v_smfmac_f32_16x16x64_bf16 v[104:107], v[40:43], a[80:87], v6
v_smfmac_f32_16x16x64_bf16 v[108:111], v[40:43], a[112:119], v6
s_branch mega_kernel_rf_pa_2_1
mega_kernel_rf_il12:
s_cbranch_execz mega_kernel_rf_il13
.p2align 5
mega_kernel_rf_pa_7_0f:
s_mov_b64 exec, vcc
buffer_load_dwordx4 v[32:35], v7, s[84:87], s33 offen offset:0 sc1
s_mov_b64 exec, -1
s_branch mega_kernel_rf_pa_7_1
.p2align 5
mega_kernel_rf_pa_7_0:
s_waitcnt vmcnt(2)
v_max_u32 v4, v32, v34
v_cmp_eq_u32 vcc, -1, v4
s_cbranch_vccnz mega_kernel_rf_pa_7_0f
v_smfmac_f32_16x16x64_bf16 v[96:99], v[32:35], a[0:7], v6
v_smfmac_f32_16x16x64_bf16 v[100:103], v[32:35], a[32:39], v6
v_smfmac_f32_16x16x64_bf16 v[104:107], v[32:35], a[64:71], v6
v_smfmac_f32_16x16x64_bf16 v[108:111], v[32:35], a[96:103], v6
s_branch mega_kernel_rf_pa_6_1
mega_kernel_rf_il13:
s_cbranch_execz mega_kernel_rf_il14
.p2align 5
mega_kernel_rf_pa_7_1f:
s_mov_b64 exec, vcc
buffer_load_dwordx4 v[36:39], v7, s[84:87], s33 offen offset:1024 sc1
s_mov_b64 exec, -1
s_branch mega_kernel_rf_pa_7_2
.p2align 5
mega_kernel_rf_pa_7_1:
s_waitcnt vmcnt(2)
v_max_u32 v4, v36, v38
v_cmp_eq_u32 vcc, -1, v4
s_cbranch_vccnz mega_kernel_rf_pa_7_1f
v_smfmac_f32_16x16x64_bf16 v[96:99], v[36:39], a[8:15], v6
v_smfmac_f32_16x16x64_bf16 v[100:103], v[36:39], a[40:47], v6
v_smfmac_f32_16x16x64_bf16 v[104:107], v[36:39], a[72:79], v6
v_smfmac_f32_16x16x64_bf16 v[108:111], v[36:39], a[104:111], v6
s_branch mega_kernel_rf_pa_5_2
mega_kernel_rf_il14:
s_cbranch_execz mega_kernel_rf_il15
.p2align 5
mega_kernel_rf_pa_7_2f:
s_mov_b64 exec, vcc
buffer_load_dwordx4 v[40:43], v7, s[84:87], s33 offen offset:2048 sc1
s_mov_b64 exec, -1
s_branch mega_kernel_rf_pa_7_0
.p2align 5
mega_kernel_rf_pa_7_2:
s_waitcnt vmcnt(2)
v_max_u32 v4, v40, v42
v_cmp_eq_u32 vcc, -1, v4
s_cbranch_vccnz mega_kernel_rf_pa_7_2f
v_smfmac_f32_16x16x64_bf16 v[96:99], v[40:43], a[16:23], v6
v_smfmac_f32_16x16x64_bf16 v[100:103], v[40:43], a[48:55], v6
v_smfmac_f32_16x16x64_bf16 v[104:107], v[40:43], a[80:87], v6
v_smfmac_f32_16x16x64_bf16 v[108:111], v[40:43], a[112:119], v6
s_branch mega_kernel_rf_pa_3_0
mega_kernel_rf_il15:
s_cbranch_execz mega_kernel_rf_il16
.p2align 5
mega_kernel_rf_pa_8_3f:
s_mov_b64 exec, vcc
buffer_load_dwordx4 v[44:47], v7, s[84:87], s33 offen offset:3072 sc1
s_mov_b64 exec, -1
s_branch mega_kernel_rf_pa_8_3
.p2align 5
mega_kernel_rf_pa_8_3:
s_waitcnt vmcnt(0)
v_max_u32 v4, v44, v46
v_cmp_eq_u32 vcc, -1, v4
s_cbranch_vccnz mega_kernel_rf_pa_8_3f
v_smfmac_f32_16x16x64_bf16 v[96:99], v[44:47], a[24:31], v6
v_smfmac_f32_16x16x64_bf16 v[100:103], v[44:47], a[56:63], v6
v_smfmac_f32_16x16x64_bf16 v[104:107], v[44:47], a[88:95], v6
v_smfmac_f32_16x16x64_bf16 v[108:111], v[44:47], a[120:127], v6
s_branch mega_kernel_rf_pa_d
mega_kernel_rf_il16:
s_cbranch_execz mega_kernel_rf_il17
.p2align 5
mega_kernel_rf_pa_9_0f:
s_mov_b64 exec, vcc
buffer_load_dwordx4 v[32:35], v7, s[84:87], s33 offen offset:0 sc1
s_mov_b64 exec, -1
s_branch mega_kernel_rf_pa_9_3
.p2align 5
mega_kernel_rf_pa_9_0:
s_waitcnt vmcnt(1)
v_max_u32 v4, v32, v34
v_cmp_eq_u32 vcc, -1, v4
s_cbranch_vccnz mega_kernel_rf_pa_9_0f
v_smfmac_f32_16x16x64_bf16 v[96:99], v[32:35], a[0:7], v6
v_smfmac_f32_16x16x64_bf16 v[100:103], v[32:35], a[32:39], v6
v_smfmac_f32_16x16x64_bf16 v[104:107], v[32:35], a[64:71], v6
v_smfmac_f32_16x16x64_bf16 v[108:111], v[32:35], a[96:103], v6
s_branch mega_kernel_rf_pa_8_3
mega_kernel_rf_il17:
s_cbranch_execz mega_kernel_rf_il18
.p2align 5
mega_kernel_rf_pa_9_3f:
s_mov_b64 exec, vcc
buffer_load_dwordx4 v[44:47], v7, s[84:87], s33 offen offset:3072 sc1
s_mov_b64 exec, -1
s_branch mega_kernel_rf_pa_9_0
.p2align 5
mega_kernel_rf_pa_9_3:
s_waitcnt vmcnt(1)
v_max_u32 v4, v44, v46
v_cmp_eq_u32 vcc, -1, v4
s_cbranch_vccnz mega_kernel_rf_pa_9_3f
v_smfmac_f32_16x16x64_bf16 v[96:99], v[44:47], a[24:31], v6
v_smfmac_f32_16x16x64_bf16 v[100:103], v[44:47], a[56:63], v6
v_smfmac_f32_16x16x64_bf16 v[104:107], v[44:47], a[88:95], v6
v_smfmac_f32_16x16x64_bf16 v[108:111], v[44:47], a[120:127], v6
s_branch mega_kernel_rf_pa_1_0
mega_kernel_rf_il18:
s_cbranch_execz mega_kernel_rf_iwd
.p2align 5
mega_kernel_rf_pa_10_1f:
s_mov_b64 exec, vcc
buffer_load_dwordx4 v[36:39], v7, s[84:87], s33 offen offset:1024 sc1
s_mov_b64 exec, -1
s_branch mega_kernel_rf_pa_10_3
.p2align 5
mega_kernel_rf_pa_10_1:
s_waitcnt vmcnt(1)
v_max_u32 v4, v36, v38
v_cmp_eq_u32 vcc, -1, v4
s_cbranch_vccnz mega_kernel_rf_pa_10_1f
v_smfmac_f32_16x16x64_bf16 v[96:99], v[36:39], a[8:15], v6
v_smfmac_f32_16x16x64_bf16 v[100:103], v[36:39], a[40:47], v6
v_smfmac_f32_16x16x64_bf16 v[104:107], v[36:39], a[72:79], v6
v_smfmac_f32_16x16x64_bf16 v[108:111], v[36:39], a[104:111], v6
s_branch mega_kernel_rf_pa_8_3
mega_kernel_rf_iw1:
mega_kernel_rf_il19:
s_cbranch_execz mega_kernel_rf_il20
.p2align 5
mega_kernel_rf_pa_10_3f:
s_mov_b64 exec, vcc
buffer_load_dwordx4 v[44:47], v7, s[84:87], s33 offen offset:3072 sc1
s_mov_b64 exec, -1
s_branch mega_kernel_rf_pa_10_1
.p2align 5
mega_kernel_rf_pa_10_3:
s_waitcnt vmcnt(1)
v_max_u32 v4, v44, v46
v_cmp_eq_u32 vcc, -1, v4
s_cbranch_vccnz mega_kernel_rf_pa_10_3f
v_smfmac_f32_16x16x64_bf16 v[96:99], v[44:47], a[24:31], v6
v_smfmac_f32_16x16x64_bf16 v[100:103], v[44:47], a[56:63], v6
v_smfmac_f32_16x16x64_bf16 v[104:107], v[44:47], a[88:95], v6
v_smfmac_f32_16x16x64_bf16 v[108:111], v[44:47], a[120:127], v6
s_branch mega_kernel_rf_pa_2_1
mega_kernel_rf_il20:
s_cbranch_execz mega_kernel_rf_il21
.p2align 5
mega_kernel_rf_pa_11_0f:
s_mov_b64 exec, vcc
buffer_load_dwordx4 v[32:35], v7, s[84:87], s33 offen offset:0 sc1
s_mov_b64 exec, -1
s_branch mega_kernel_rf_pa_11_1
.p2align 5
mega_kernel_rf_pa_11_0:
s_waitcnt vmcnt(2)
v_max_u32 v4, v32, v34
v_cmp_eq_u32 vcc, -1, v4
s_cbranch_vccnz mega_kernel_rf_pa_11_0f
v_smfmac_f32_16x16x64_bf16 v[96:99], v[32:35], a[0:7], v6
v_smfmac_f32_16x16x64_bf16 v[100:103], v[32:35], a[32:39], v6
v_smfmac_f32_16x16x64_bf16 v[104:107], v[32:35], a[64:71], v6
v_smfmac_f32_16x16x64_bf16 v[108:111], v[32:35], a[96:103], v6
s_branch mega_kernel_rf_pa_10_1
mega_kernel_rf_il21:
s_cbranch_execz mega_kernel_rf_il22
.p2align 5
mega_kernel_rf_pa_11_1f:
s_mov_b64 exec, vcc
buffer_load_dwordx4 v[36:39], v7, s[84:87], s33 offen offset:1024 sc1
s_mov_b64 exec, -1
s_branch mega_kernel_rf_pa_11_3
.p2align 5
mega_kernel_rf_pa_11_1:
s_waitcnt vmcnt(2)
v_max_u32 v4, v36, v38
v_cmp_eq_u32 vcc, -1, v4
s_cbranch_vccnz mega_kernel_rf_pa_11_1f
v_smfmac_f32_16x16x64_bf16 v[96:99], v[36:39], a[8:15], v6
v_smfmac_f32_16x16x64_bf16 v[100:103], v[36:39], a[40:47], v6
v_smfmac_f32_16x16x64_bf16 v[104:107], v[36:39], a[72:79], v6
v_smfmac_f32_16x16x64_bf16 v[108:111], v[36:39], a[104:111], v6
s_branch mega_kernel_rf_pa_9_3
mega_kernel_rf_il22:
s_cbranch_execz mega_kernel_rf_il23
.p2align 5
mega_kernel_rf_pa_11_3f:
s_mov_b64 exec, vcc
buffer_load_dwordx4 v[44:47], v7, s[84:87], s33 offen offset:3072 sc1
s_mov_b64 exec, -1
s_branch mega_kernel_rf_pa_11_0
.p2align 5
mega_kernel_rf_pa_11_3:
s_waitcnt vmcnt(2)
v_max_u32 v4, v44, v46
v_cmp_eq_u32 vcc, -1, v4
s_cbranch_vccnz mega_kernel_rf_pa_11_3f
v_smfmac_f32_16x16x64_bf16 v[96:99], v[44:47], a[24:31], v6
v_smfmac_f32_16x16x64_bf16 v[100:103], v[44:47], a[56:63], v6
v_smfmac_f32_16x16x64_bf16 v[104:107], v[44:47], a[88:95], v6
v_smfmac_f32_16x16x64_bf16 v[108:111], v[44:47], a[120:127], v6
s_branch mega_kernel_rf_pa_3_0
mega_kernel_rf_il23:
s_cbranch_execz mega_kernel_rf_il24
.p2align 5
mega_kernel_rf_pa_12_2f:
s_mov_b64 exec, vcc
buffer_load_dwordx4 v[40:43], v7, s[84:87], s33 offen offset:2048 sc1
s_mov_b64 exec, -1
s_branch mega_kernel_rf_pa_12_3
.p2align 5
mega_kernel_rf_pa_12_2:
s_waitcnt vmcnt(1)
v_max_u32 v4, v40, v42
v_cmp_eq_u32 vcc, -1, v4
s_cbranch_vccnz mega_kernel_rf_pa_12_2f
v_smfmac_f32_16x16x64_bf16 v[96:99], v[40:43], a[16:23], v6
v_smfmac_f32_16x16x64_bf16 v[100:103], v[40:43], a[48:55], v6
v_smfmac_f32_16x16x64_bf16 v[104:107], v[40:43], a[80:87], v6
v_smfmac_f32_16x16x64_bf16 v[108:111], v[40:43], a[112:119], v6
s_branch mega_kernel_rf_pa_8_3
mega_kernel_rf_il24:
s_cbranch_execz mega_kernel_rf_il25
.p2align 5
mega_kernel_rf_pa_12_3f:
s_mov_b64 exec, vcc
buffer_load_dwordx4 v[44:47], v7, s[84:87], s33 offen offset:3072 sc1
s_mov_b64 exec, -1
s_branch mega_kernel_rf_pa_12_2
.p2align 5
mega_kernel_rf_pa_12_3:
s_waitcnt vmcnt(1)
v_max_u32 v4, v44, v46
v_cmp_eq_u32 vcc, -1, v4
s_cbranch_vccnz mega_kernel_rf_pa_12_3f
v_smfmac_f32_16x16x64_bf16 v[96:99], v[44:47], a[24:31], v6
v_smfmac_f32_16x16x64_bf16 v[100:103], v[44:47], a[56:63], v6
v_smfmac_f32_16x16x64_bf16 v[104:107], v[44:47], a[88:95], v6
v_smfmac_f32_16x16x64_bf16 v[108:111], v[44:47], a[120:127], v6
s_branch mega_kernel_rf_pa_4_2
mega_kernel_rf_il25:
s_cbranch_execz mega_kernel_rf_il26
.p2align 5
mega_kernel_rf_pa_13_0f:
s_mov_b64 exec, vcc
buffer_load_dwordx4 v[32:35], v7, s[84:87], s33 offen offset:0 sc1
s_mov_b64 exec, -1
s_branch mega_kernel_rf_pa_13_2
.p2align 5
mega_kernel_rf_pa_13_0:
s_waitcnt vmcnt(2)
v_max_u32 v4, v32, v34
v_cmp_eq_u32 vcc, -1, v4
s_cbranch_vccnz mega_kernel_rf_pa_13_0f
v_smfmac_f32_16x16x64_bf16 v[96:99], v[32:35], a[0:7], v6
v_smfmac_f32_16x16x64_bf16 v[100:103], v[32:35], a[32:39], v6
v_smfmac_f32_16x16x64_bf16 v[104:107], v[32:35], a[64:71], v6
v_smfmac_f32_16x16x64_bf16 v[108:111], v[32:35], a[96:103], v6
s_branch mega_kernel_rf_pa_12_2
mega_kernel_rf_il26:
s_cbranch_execz mega_kernel_rf_il27
.p2align 5
mega_kernel_rf_pa_13_2f:
s_mov_b64 exec, vcc
buffer_load_dwordx4 v[40:43], v7, s[84:87], s33 offen offset:2048 sc1
s_mov_b64 exec, -1
s_branch mega_kernel_rf_pa_13_3
.p2align 5
mega_kernel_rf_pa_13_2:
s_waitcnt vmcnt(2)
v_max_u32 v4, v40, v42
v_cmp_eq_u32 vcc, -1, v4
s_cbranch_vccnz mega_kernel_rf_pa_13_2f
v_smfmac_f32_16x16x64_bf16 v[96:99], v[40:43], a[16:23], v6
v_smfmac_f32_16x16x64_bf16 v[100:103], v[40:43], a[48:55], v6
v_smfmac_f32_16x16x64_bf16 v[104:107], v[40:43], a[80:87], v6
v_smfmac_f32_16x16x64_bf16 v[108:111], v[40:43], a[112:119], v6
s_branch mega_kernel_rf_pa_9_3
mega_kernel_rf_il27:
s_cbranch_execz mega_kernel_rf_il28
.p2align 5
mega_kernel_rf_pa_13_3f:
s_mov_b64 exec, vcc
buffer_load_dwordx4 v[44:47], v7, s[84:87], s33 offen offset:3072 sc1
s_mov_b64 exec, -1
s_branch mega_kernel_rf_pa_13_0
.p2align 5
mega_kernel_rf_pa_13_3:
s_waitcnt vmcnt(2)
v_max_u32 v4, v44, v46
v_cmp_eq_u32 vcc, -1, v4
s_cbranch_vccnz mega_kernel_rf_pa_13_3f
v_smfmac_f32_16x16x64_bf16 v[96:99], v[44:47], a[24:31], v6
v_smfmac_f32_16x16x64_bf16 v[100:103], v[44:47], a[56:63], v6
v_smfmac_f32_16x16x64_bf16 v[104:107], v[44:47], a[88:95], v6
v_smfmac_f32_16x16x64_bf16 v[108:111], v[44:47], a[120:127], v6
s_branch mega_kernel_rf_pa_5_0
mega_kernel_rf_il28:
s_cbranch_execz mega_kernel_rf_il29
.p2align 5
mega_kernel_rf_pa_14_1f:
s_mov_b64 exec, vcc
buffer_load_dwordx4 v[36:39], v7, s[84:87], s33 offen offset:1024 sc1
s_mov_b64 exec, -1
s_branch mega_kernel_rf_pa_14_2
.p2align 5
mega_kernel_rf_pa_14_1:
s_waitcnt vmcnt(2)
v_max_u32 v4, v36, v38
v_cmp_eq_u32 vcc, -1, v4
s_cbranch_vccnz mega_kernel_rf_pa_14_1f
v_smfmac_f32_16x16x64_bf16 v[96:99], v[36:39], a[8:15], v6
v_smfmac_f32_16x16x64_bf16 v[100:103], v[36:39], a[40:47], v6
v_smfmac_f32_16x16x64_bf16 v[104:107], v[36:39], a[72:79], v6
v_smfmac_f32_16x16x64_bf16 v[108:111], v[36:39], a[104:111], v6
s_branch mega_kernel_rf_pa_12_2
mega_kernel_rf_il29:
s_cbranch_execz mega_kernel_rf_il30
.p2align 5
mega_kernel_rf_pa_14_2f:
s_mov_b64 exec, vcc
buffer_load_dwordx4 v[40:43], v7, s[84:87], s33 offen offset:2048 sc1
s_mov_b64 exec, -1
s_branch mega_kernel_rf_pa_14_3
.p2align 5
mega_kernel_rf_pa_14_2:
s_waitcnt vmcnt(2)
v_max_u32 v4, v40, v42
v_cmp_eq_u32 vcc, -1, v4
s_cbranch_vccnz mega_kernel_rf_pa_14_2f
v_smfmac_f32_16x16x64_bf16 v[96:99], v[40:43], a[16:23], v6
v_smfmac_f32_16x16x64_bf16 v[100:103], v[40:43], a[48:55], v6
v_smfmac_f32_16x16x64_bf16 v[104:107], v[40:43], a[80:87], v6
v_smfmac_f32_16x16x64_bf16 v[108:111], v[40:43], a[112:119], v6
s_branch mega_kernel_rf_pa_10_3
mega_kernel_rf_il30:
s_cbranch_execz mega_kernel_rf_il31
.p2align 5
mega_kernel_rf_pa_14_3f:
s_mov_b64 exec, vcc
buffer_load_dwordx4 v[44:47], v7, s[84:87], s33 offen offset:3072 sc1
s_mov_b64 exec, -1
s_branch mega_kernel_rf_pa_14_1
.p2align 5
mega_kernel_rf_pa_14_3:
s_waitcnt vmcnt(2)
v_max_u32 v4, v44, v46
v_cmp_eq_u32 vcc, -1, v4
s_cbranch_vccnz mega_kernel_rf_pa_14_3f
v_smfmac_f32_16x16x64_bf16 v[96:99], v[44:47], a[24:31], v6
v_smfmac_f32_16x16x64_bf16 v[100:103], v[44:47], a[56:63], v6
v_smfmac_f32_16x16x64_bf16 v[104:107], v[44:47], a[88:95], v6
v_smfmac_f32_16x16x64_bf16 v[108:111], v[44:47], a[120:127], v6
s_branch mega_kernel_rf_pa_6_1
mega_kernel_rf_il31:
s_cbranch_execz mega_kernel_rf_il32
.p2align 5
mega_kernel_rf_pa_15_0f:
s_mov_b64 exec, vcc
buffer_load_dwordx4 v[32:35], v7, s[84:87], s33 offen offset:0 sc1
s_mov_b64 exec, -1
s_branch mega_kernel_rf_pa_15_1
.p2align 5
mega_kernel_rf_pa_15_0:
s_waitcnt vmcnt(3)
v_max_u32 v4, v32, v34
v_cmp_eq_u32 vcc, -1, v4
s_cbranch_vccnz mega_kernel_rf_pa_15_0f
v_smfmac_f32_16x16x64_bf16 v[96:99], v[32:35], a[0:7], v6
v_smfmac_f32_16x16x64_bf16 v[100:103], v[32:35], a[32:39], v6
v_smfmac_f32_16x16x64_bf16 v[104:107], v[32:35], a[64:71], v6
v_smfmac_f32_16x16x64_bf16 v[108:111], v[32:35], a[96:103], v6
s_branch mega_kernel_rf_pa_14_1
mega_kernel_rf_il32:
s_cbranch_execz mega_kernel_rf_il33
.p2align 5
mega_kernel_rf_pa_15_1f:
s_mov_b64 exec, vcc
buffer_load_dwordx4 v[36:39], v7, s[84:87], s33 offen offset:1024 sc1
s_mov_b64 exec, -1
s_branch mega_kernel_rf_pa_15_2
.p2align 5
mega_kernel_rf_pa_15_1:
s_waitcnt vmcnt(3)
v_max_u32 v4, v36, v38
v_cmp_eq_u32 vcc, -1, v4
s_cbranch_vccnz mega_kernel_rf_pa_15_1f
v_smfmac_f32_16x16x64_bf16 v[96:99], v[36:39], a[8:15], v6
v_smfmac_f32_16x16x64_bf16 v[100:103], v[36:39], a[40:47], v6
v_smfmac_f32_16x16x64_bf16 v[104:107], v[36:39], a[72:79], v6
v_smfmac_f32_16x16x64_bf16 v[108:111], v[36:39], a[104:111], v6
s_branch mega_kernel_rf_pa_13_2
mega_kernel_rf_il33:
s_cbranch_execz mega_kernel_rf_il34
.p2align 5
mega_kernel_rf_pa_15_2f:
s_mov_b64 exec, vcc
buffer_load_dwordx4 v[40:43], v7, s[84:87], s33 offen offset:2048 sc1
s_mov_b64 exec, -1
s_branch mega_kernel_rf_pa_15_3
.p2align 5
mega_kernel_rf_pa_15_2:
s_waitcnt vmcnt(3)
v_max_u32 v4, v40, v42
v_cmp_eq_u32 vcc, -1, v4
s_cbranch_vccnz mega_kernel_rf_pa_15_2f
v_smfmac_f32_16x16x64_bf16 v[96:99], v[40:43], a[16:23], v6
v_smfmac_f32_16x16x64_bf16 v[100:103], v[40:43], a[48:55], v6
v_smfmac_f32_16x16x64_bf16 v[104:107], v[40:43], a[80:87], v6
v_smfmac_f32_16x16x64_bf16 v[108:111], v[40:43], a[112:119], v6
s_branch mega_kernel_rf_pa_11_3
mega_kernel_rf_il34:
s_cbranch_execz mega_kernel_rf_il35
.p2align 5
mega_kernel_rf_pa_15_3f:
s_mov_b64 exec, vcc
buffer_load_dwordx4 v[44:47], v7, s[84:87], s33 offen offset:3072 sc1
s_mov_b64 exec, -1
s_branch mega_kernel_rf_pa_15_0
.p2align 5
mega_kernel_rf_pa_15_3:
s_waitcnt vmcnt(3)
v_max_u32 v4, v44, v46
v_cmp_eq_u32 vcc, -1, v4
s_cbranch_vccnz mega_kernel_rf_pa_15_3f
v_smfmac_f32_16x16x64_bf16 v[96:99], v[44:47], a[24:31], v6
v_smfmac_f32_16x16x64_bf16 v[100:103], v[44:47], a[56:63], v6
v_smfmac_f32_16x16x64_bf16 v[104:107], v[44:47], a[88:95], v6
v_smfmac_f32_16x16x64_bf16 v[108:111], v[44:47], a[120:127], v6
s_branch mega_kernel_rf_pa_7_0
mega_kernel_rf_il35:
s_cbranch_execz mega_kernel_rf_il36
.p2align 5
mega_kernel_rf_pc_1_0f:
s_mov_b64 exec, vcc
buffer_load_dwordx4 v[32:35], v7, s[84:87], s29 offen offset:0 sc1
s_mov_b64 exec, -1
s_branch mega_kernel_rf_pc_1_0
.p2align 5
mega_kernel_rf_pc_1_0:
s_waitcnt vmcnt(0)
v_cmp_eq_u32 vcc, -1, v32
s_cbranch_vccnz mega_kernel_rf_pc_1_0f
v_smfmac_f32_16x16x64_bf16 v[96:99], v[32:35], a[192:199], v6
v_smfmac_f32_16x16x64_bf16 v[100:103], v[32:35], a[224:231], v6
s_branch mega_kernel_rf_pc_d
mega_kernel_rf_il36:
s_cbranch_execz mega_kernel_rf_il37
.p2align 5
mega_kernel_rf_pc_2_1f:
s_mov_b64 exec, vcc
buffer_load_dwordx4 v[36:39], v7, s[84:87], s29 offen offset:1024 sc1
s_mov_b64 exec, -1
s_branch mega_kernel_rf_pc_2_1
mega_kernel_rf_il37:
s_cbranch_execz mega_kernel_rf_iwd
.p2align 5
mega_kernel_rf_pc_2_1:
s_waitcnt vmcnt(0)
v_cmp_eq_u32 vcc, -1, v36
s_cbranch_vccnz mega_kernel_rf_pc_2_1f
v_smfmac_f32_16x16x64_bf16 v[96:99], v[36:39], a[200:207], v6
v_smfmac_f32_16x16x64_bf16 v[100:103], v[36:39], a[232:239], v6
s_branch mega_kernel_rf_pc_d
.p2align 5
mega_kernel_rf_pc_3_0f:
s_mov_b64 exec, vcc
buffer_load_dwordx4 v[32:35], v7, s[84:87], s29 offen offset:0 sc1
s_mov_b64 exec, -1
s_branch mega_kernel_rf_pc_3_1
mega_kernel_rf_iw2:
mega_kernel_rf_il38:
s_cbranch_execz mega_kernel_rf_il39
.p2align 5
mega_kernel_rf_pc_3_0:
s_waitcnt vmcnt(1)
v_cmp_eq_u32 vcc, -1, v32
s_cbranch_vccnz mega_kernel_rf_pc_3_0f
v_smfmac_f32_16x16x64_bf16 v[96:99], v[32:35], a[192:199], v6
v_smfmac_f32_16x16x64_bf16 v[100:103], v[32:35], a[224:231], v6
s_branch mega_kernel_rf_pc_2_1
.p2align 5
mega_kernel_rf_pc_3_1f:
s_mov_b64 exec, vcc
buffer_load_dwordx4 v[36:39], v7, s[84:87], s29 offen offset:1024 sc1
s_mov_b64 exec, -1
s_branch mega_kernel_rf_pc_3_0
mega_kernel_rf_il39:
s_cbranch_execz mega_kernel_rf_il40
.p2align 5
mega_kernel_rf_pc_3_1:
s_waitcnt vmcnt(1)
v_cmp_eq_u32 vcc, -1, v36
s_cbranch_vccnz mega_kernel_rf_pc_3_1f
v_smfmac_f32_16x16x64_bf16 v[96:99], v[36:39], a[200:207], v6
v_smfmac_f32_16x16x64_bf16 v[100:103], v[36:39], a[232:239], v6
s_branch mega_kernel_rf_pc_1_0
.p2align 5
mega_kernel_rf_pc_4_2f:
s_mov_b64 exec, vcc
buffer_load_dwordx4 v[40:43], v7, s[84:87], s29 offen offset:2048 sc1
s_mov_b64 exec, -1
s_branch mega_kernel_rf_pc_4_2
mega_kernel_rf_il40:
s_cbranch_execz mega_kernel_rf_il41
.p2align 5
mega_kernel_rf_pc_4_2:
s_waitcnt vmcnt(0)
v_cmp_eq_u32 vcc, -1, v40
s_cbranch_vccnz mega_kernel_rf_pc_4_2f
v_smfmac_f32_16x16x64_bf16 v[96:99], v[40:43], a[208:215], v6
v_smfmac_f32_16x16x64_bf16 v[100:103], v[40:43], a[240:247], v6
s_branch mega_kernel_rf_pc_d
.p2align 5
mega_kernel_rf_pc_5_0f:
s_mov_b64 exec, vcc
buffer_load_dwordx4 v[32:35], v7, s[84:87], s29 offen offset:0 sc1
s_mov_b64 exec, -1
s_branch mega_kernel_rf_pc_5_2
mega_kernel_rf_il41:
s_cbranch_execz mega_kernel_rf_il42
.p2align 5
mega_kernel_rf_pc_5_0:
s_waitcnt vmcnt(1)
v_cmp_eq_u32 vcc, -1, v32
s_cbranch_vccnz mega_kernel_rf_pc_5_0f
v_smfmac_f32_16x16x64_bf16 v[96:99], v[32:35], a[192:199], v6
v_smfmac_f32_16x16x64_bf16 v[100:103], v[32:35], a[224:231], v6
s_branch mega_kernel_rf_pc_4_2
.p2align 5
mega_kernel_rf_pc_5_2f:
s_mov_b64 exec, vcc
buffer_load_dwordx4 v[40:43], v7, s[84:87], s29 offen offset:2048 sc1
s_mov_b64 exec, -1
s_branch mega_kernel_rf_pc_5_0
mega_kernel_rf_il42:
s_cbranch_execz mega_kernel_rf_il43
.p2align 5
mega_kernel_rf_pc_5_2:
s_waitcnt vmcnt(1)
v_cmp_eq_u32 vcc, -1, v40
s_cbranch_vccnz mega_kernel_rf_pc_5_2f
v_smfmac_f32_16x16x64_bf16 v[96:99], v[40:43], a[208:215], v6
v_smfmac_f32_16x16x64_bf16 v[100:103], v[40:43], a[240:247], v6
s_branch mega_kernel_rf_pc_1_0
.p2align 5
mega_kernel_rf_pc_6_1f:
s_mov_b64 exec, vcc
buffer_load_dwordx4 v[36:39], v7, s[84:87], s29 offen offset:1024 sc1
s_mov_b64 exec, -1
s_branch mega_kernel_rf_pc_6_2
mega_kernel_rf_il43:
s_cbranch_execz mega_kernel_rf_il44
.p2align 5
mega_kernel_rf_pc_6_1:
s_waitcnt vmcnt(1)
v_cmp_eq_u32 vcc, -1, v36
s_cbranch_vccnz mega_kernel_rf_pc_6_1f
v_smfmac_f32_16x16x64_bf16 v[96:99], v[36:39], a[200:207], v6
v_smfmac_f32_16x16x64_bf16 v[100:103], v[36:39], a[232:239], v6
s_branch mega_kernel_rf_pc_4_2
.p2align 5
mega_kernel_rf_pc_6_2f:
s_mov_b64 exec, vcc
buffer_load_dwordx4 v[40:43], v7, s[84:87], s29 offen offset:2048 sc1
s_mov_b64 exec, -1
s_branch mega_kernel_rf_pc_6_1
mega_kernel_rf_il44:
s_cbranch_execz mega_kernel_rf_il45
.p2align 5
mega_kernel_rf_pc_6_2:
s_waitcnt vmcnt(1)
v_cmp_eq_u32 vcc, -1, v40
s_cbranch_vccnz mega_kernel_rf_pc_6_2f
v_smfmac_f32_16x16x64_bf16 v[96:99], v[40:43], a[208:215], v6
v_smfmac_f32_16x16x64_bf16 v[100:103], v[40:43], a[240:247], v6
s_branch mega_kernel_rf_pc_2_1
.p2align 5
mega_kernel_rf_pc_7_0f:
s_mov_b64 exec, vcc
buffer_load_dwordx4 v[32:35], v7, s[84:87], s29 offen offset:0 sc1
s_mov_b64 exec, -1
s_branch mega_kernel_rf_pc_7_1
mega_kernel_rf_il45:
s_cbranch_execz mega_kernel_rf_il46
.p2align 5
mega_kernel_rf_pc_7_0:
s_waitcnt vmcnt(2)
v_cmp_eq_u32 vcc, -1, v32
s_cbranch_vccnz mega_kernel_rf_pc_7_0f
v_smfmac_f32_16x16x64_bf16 v[96:99], v[32:35], a[192:199], v6
v_smfmac_f32_16x16x64_bf16 v[100:103], v[32:35], a[224:231], v6
s_branch mega_kernel_rf_pc_6_1
.p2align 5
mega_kernel_rf_pc_7_1f:
s_mov_b64 exec, vcc
buffer_load_dwordx4 v[36:39], v7, s[84:87], s29 offen offset:1024 sc1
s_mov_b64 exec, -1
s_branch mega_kernel_rf_pc_7_2
mega_kernel_rf_il46:
s_cbranch_execz mega_kernel_rf_il47
.p2align 5
mega_kernel_rf_pc_7_1:
s_waitcnt vmcnt(2)
v_cmp_eq_u32 vcc, -1, v36
s_cbranch_vccnz mega_kernel_rf_pc_7_1f
v_smfmac_f32_16x16x64_bf16 v[96:99], v[36:39], a[200:207], v6
v_smfmac_f32_16x16x64_bf16 v[100:103], v[36:39], a[232:239], v6
s_branch mega_kernel_rf_pc_5_2
.p2align 5
mega_kernel_rf_pc_7_2f:
s_mov_b64 exec, vcc
buffer_load_dwordx4 v[40:43], v7, s[84:87], s29 offen offset:2048 sc1
s_mov_b64 exec, -1
s_branch mega_kernel_rf_pc_7_0
mega_kernel_rf_il47:
s_cbranch_execz mega_kernel_rf_il48
.p2align 5
mega_kernel_rf_pc_7_2:
s_waitcnt vmcnt(2)
v_cmp_eq_u32 vcc, -1, v40
s_cbranch_vccnz mega_kernel_rf_pc_7_2f
v_smfmac_f32_16x16x64_bf16 v[96:99], v[40:43], a[208:215], v6
v_smfmac_f32_16x16x64_bf16 v[100:103], v[40:43], a[240:247], v6
s_branch mega_kernel_rf_pc_3_0
.p2align 5
mega_kernel_rf_pc_8_3f:
s_mov_b64 exec, vcc
buffer_load_dwordx4 v[44:47], v7, s[84:87], s29 offen offset:3072 sc1
s_mov_b64 exec, -1
s_branch mega_kernel_rf_pc_8_3
mega_kernel_rf_il48:
s_cbranch_execz mega_kernel_rf_il49
.p2align 5
mega_kernel_rf_pc_9_0f:
s_mov_b64 exec, vcc
buffer_load_dwordx4 v[32:35], v7, s[84:87], s29 offen offset:0 sc1
s_mov_b64 exec, -1
s_branch mega_kernel_rf_pc_9_3
.p2align 5
mega_kernel_rf_pc_9_0:
s_waitcnt vmcnt(1)
v_cmp_eq_u32 vcc, -1, v32
s_cbranch_vccnz mega_kernel_rf_pc_9_0f
v_smfmac_f32_16x16x64_bf16 v[96:99], v[32:35], a[192:199], v6
v_smfmac_f32_16x16x64_bf16 v[100:103], v[32:35], a[224:231], v6
s_branch mega_kernel_rf_pc_8_3
mega_kernel_rf_il49:
s_cbranch_execz mega_kernel_rf_il50
.p2align 5
mega_kernel_rf_pc_9_3f:
s_mov_b64 exec, vcc
buffer_load_dwordx4 v[44:47], v7, s[84:87], s29 offen offset:3072 sc1
s_mov_b64 exec, -1
s_branch mega_kernel_rf_pc_9_0
mega_kernel_rf_il50:
s_cbranch_execz mega_kernel_rf_il51
.p2align 5
mega_kernel_rf_pc_9_3:
s_waitcnt vmcnt(1)
v_cmp_eq_u32 vcc, -1, v44
s_cbranch_vccnz mega_kernel_rf_pc_9_3f
v_smfmac_f32_16x16x64_bf16 v[96:99], v[44:47], a[216:223], v6
v_smfmac_f32_16x16x64_bf16 v[100:103], v[44:47], a[248:255], v6
s_branch mega_kernel_rf_pc_1_0
.p2align 5
mega_kernel_rf_pc_10_1f:
s_mov_b64 exec, vcc
buffer_load_dwordx4 v[36:39], v7, s[84:87], s29 offen offset:1024 sc1
s_mov_b64 exec, -1
s_branch mega_kernel_rf_pc_10_3
mega_kernel_rf_il51:
s_cbranch_execz mega_kernel_rf_il52
.p2align 5
mega_kernel_rf_pc_10_1:
s_waitcnt vmcnt(1)
v_cmp_eq_u32 vcc, -1, v36
s_cbranch_vccnz mega_kernel_rf_pc_10_1f
v_smfmac_f32_16x16x64_bf16 v[96:99], v[36:39], a[200:207], v6
v_smfmac_f32_16x16x64_bf16 v[100:103], v[36:39], a[232:239], v6
s_branch mega_kernel_rf_pc_8_3
.p2align 5
mega_kernel_rf_pc_10_3f:
s_mov_b64 exec, vcc
buffer_load_dwordx4 v[44:47], v7, s[84:87], s29 offen offset:3072 sc1
s_mov_b64 exec, -1
s_branch mega_kernel_rf_pc_10_1
mega_kernel_rf_il52:
s_cbranch_execz mega_kernel_rf_il53
.p2align 5
mega_kernel_rf_pc_10_3:
s_waitcnt vmcnt(1)
v_cmp_eq_u32 vcc, -1, v44
s_cbranch_vccnz mega_kernel_rf_pc_10_3f
v_smfmac_f32_16x16x64_bf16 v[96:99], v[44:47], a[216:223], v6
v_smfmac_f32_16x16x64_bf16 v[100:103], v[44:47], a[248:255], v6
s_branch mega_kernel_rf_pc_2_1
.p2align 5
mega_kernel_rf_pc_11_0f:
s_mov_b64 exec, vcc
buffer_load_dwordx4 v[32:35], v7, s[84:87], s29 offen offset:0 sc1
s_mov_b64 exec, -1
s_branch mega_kernel_rf_pc_11_1
mega_kernel_rf_il53:
s_cbranch_execz mega_kernel_rf_il54
.p2align 5
mega_kernel_rf_pc_11_0:
s_waitcnt vmcnt(2)
v_cmp_eq_u32 vcc, -1, v32
s_cbranch_vccnz mega_kernel_rf_pc_11_0f
v_smfmac_f32_16x16x64_bf16 v[96:99], v[32:35], a[192:199], v6
v_smfmac_f32_16x16x64_bf16 v[100:103], v[32:35], a[224:231], v6
s_branch mega_kernel_rf_pc_10_1
.p2align 5
mega_kernel_rf_pc_11_1f:
s_mov_b64 exec, vcc
buffer_load_dwordx4 v[36:39], v7, s[84:87], s29 offen offset:1024 sc1
s_mov_b64 exec, -1
s_branch mega_kernel_rf_pc_11_3
mega_kernel_rf_il54:
s_cbranch_execz mega_kernel_rf_il55
.p2align 5
mega_kernel_rf_pc_11_1:
s_waitcnt vmcnt(2)
v_cmp_eq_u32 vcc, -1, v36
s_cbranch_vccnz mega_kernel_rf_pc_11_1f
v_smfmac_f32_16x16x64_bf16 v[96:99], v[36:39], a[200:207], v6
v_smfmac_f32_16x16x64_bf16 v[100:103], v[36:39], a[232:239], v6
s_branch mega_kernel_rf_pc_9_3
.p2align 5
mega_kernel_rf_pc_11_3f:
s_mov_b64 exec, vcc
buffer_load_dwordx4 v[44:47], v7, s[84:87], s29 offen offset:3072 sc1
s_mov_b64 exec, -1
s_branch mega_kernel_rf_pc_11_0
mega_kernel_rf_il55:
s_cbranch_execz mega_kernel_rf_il56
.p2align 5
mega_kernel_rf_pc_11_3:
s_waitcnt vmcnt(2)
v_cmp_eq_u32 vcc, -1, v44
s_cbranch_vccnz mega_kernel_rf_pc_11_3f
v_smfmac_f32_16x16x64_bf16 v[96:99], v[44:47], a[216:223], v6
v_smfmac_f32_16x16x64_bf16 v[100:103], v[44:47], a[248:255], v6
s_branch mega_kernel_rf_pc_3_0
.p2align 5
mega_kernel_rf_pc_12_2f:
s_mov_b64 exec, vcc
buffer_load_dwordx4 v[40:43], v7, s[84:87], s29 offen offset:2048 sc1
s_mov_b64 exec, -1
s_branch mega_kernel_rf_pc_12_3
mega_kernel_rf_il56:
s_cbranch_execz mega_kernel_rf_iwd
.p2align 5
mega_kernel_rf_pc_12_3f:
s_mov_b64 exec, vcc
buffer_load_dwordx4 v[44:47], v7, s[84:87], s29 offen offset:3072 sc1
s_mov_b64 exec, -1
s_branch mega_kernel_rf_pc_12_2
.p2align 5
mega_kernel_rf_pc_12_3:
s_waitcnt vmcnt(1)
v_cmp_eq_u32 vcc, -1, v44
s_cbranch_vccnz mega_kernel_rf_pc_12_3f
v_smfmac_f32_16x16x64_bf16 v[96:99], v[44:47], a[216:223], v6
v_smfmac_f32_16x16x64_bf16 v[100:103], v[44:47], a[248:255], v6
s_branch mega_kernel_rf_pc_4_2
mega_kernel_rf_iw3:
mega_kernel_rf_il57:
s_cbranch_execz mega_kernel_rf_il58
.p2align 5
mega_kernel_rf_pc_13_0f:
s_mov_b64 exec, vcc
buffer_load_dwordx4 v[32:35], v7, s[84:87], s29 offen offset:0 sc1
s_mov_b64 exec, -1
s_branch mega_kernel_rf_pc_13_2
mega_kernel_rf_il58:
s_cbranch_execz mega_kernel_rf_il59
.p2align 5
mega_kernel_rf_pc_13_0:
s_waitcnt vmcnt(2)
v_cmp_eq_u32 vcc, -1, v32
s_cbranch_vccnz mega_kernel_rf_pc_13_0f
v_smfmac_f32_16x16x64_bf16 v[96:99], v[32:35], a[192:199], v6
v_smfmac_f32_16x16x64_bf16 v[100:103], v[32:35], a[224:231], v6
s_branch mega_kernel_rf_pc_12_2
.p2align 5
mega_kernel_rf_pc_13_2f:
s_mov_b64 exec, vcc
buffer_load_dwordx4 v[40:43], v7, s[84:87], s29 offen offset:2048 sc1
s_mov_b64 exec, -1
s_branch mega_kernel_rf_pc_13_3
mega_kernel_rf_il59:
s_cbranch_execz mega_kernel_rf_il60
.p2align 5
mega_kernel_rf_pc_13_2:
s_waitcnt vmcnt(2)
v_cmp_eq_u32 vcc, -1, v40
s_cbranch_vccnz mega_kernel_rf_pc_13_2f
v_smfmac_f32_16x16x64_bf16 v[96:99], v[40:43], a[208:215], v6
v_smfmac_f32_16x16x64_bf16 v[100:103], v[40:43], a[240:247], v6
s_branch mega_kernel_rf_pc_9_3
.p2align 5
mega_kernel_rf_pc_13_3f:
s_mov_b64 exec, vcc
buffer_load_dwordx4 v[44:47], v7, s[84:87], s29 offen offset:3072 sc1
s_mov_b64 exec, -1
s_branch mega_kernel_rf_pc_13_0
mega_kernel_rf_il60:
s_cbranch_execz mega_kernel_rf_il61
.p2align 5
mega_kernel_rf_pc_13_3:
s_waitcnt vmcnt(2)
v_cmp_eq_u32 vcc, -1, v44
s_cbranch_vccnz mega_kernel_rf_pc_13_3f
v_smfmac_f32_16x16x64_bf16 v[96:99], v[44:47], a[216:223], v6
v_smfmac_f32_16x16x64_bf16 v[100:103], v[44:47], a[248:255], v6
s_branch mega_kernel_rf_pc_5_0
.p2align 5
mega_kernel_rf_pc_14_1f:
s_mov_b64 exec, vcc
buffer_load_dwordx4 v[36:39], v7, s[84:87], s29 offen offset:1024 sc1
s_mov_b64 exec, -1
s_branch mega_kernel_rf_pc_14_2
mega_kernel_rf_il61:
s_cbranch_execz mega_kernel_rf_il62
.p2align 5
mega_kernel_rf_pc_14_2f:
s_mov_b64 exec, vcc
buffer_load_dwordx4 v[40:43], v7, s[84:87], s29 offen offset:2048 sc1
s_mov_b64 exec, -1
s_branch mega_kernel_rf_pc_14_3
.p2align 5
mega_kernel_rf_pc_14_2:
s_waitcnt vmcnt(2)
v_cmp_eq_u32 vcc, -1, v40
s_cbranch_vccnz mega_kernel_rf_pc_14_2f
v_smfmac_f32_16x16x64_bf16 v[96:99], v[40:43], a[208:215], v6
v_smfmac_f32_16x16x64_bf16 v[100:103], v[40:43], a[240:247], v6
s_branch mega_kernel_rf_pc_10_3
mega_kernel_rf_il62:
s_cbranch_execz mega_kernel_rf_il63
.p2align 5
mega_kernel_rf_pc_14_3f:
s_mov_b64 exec, vcc
buffer_load_dwordx4 v[44:47], v7, s[84:87], s29 offen offset:3072 sc1
s_mov_b64 exec, -1
s_branch mega_kernel_rf_pc_14_1
mega_kernel_rf_il63:
s_cbranch_execz mega_kernel_rf_il64
.p2align 5
mega_kernel_rf_pc_14_3:
s_waitcnt vmcnt(2)
v_cmp_eq_u32 vcc, -1, v44
s_cbranch_vccnz mega_kernel_rf_pc_14_3f
v_smfmac_f32_16x16x64_bf16 v[96:99], v[44:47], a[216:223], v6
v_smfmac_f32_16x16x64_bf16 v[100:103], v[44:47], a[248:255], v6
s_branch mega_kernel_rf_pc_6_1
.p2align 5
mega_kernel_rf_pc_15_0f:
s_mov_b64 exec, vcc
buffer_load_dwordx4 v[32:35], v7, s[84:87], s29 offen offset:0 sc1
s_mov_b64 exec, -1
s_branch mega_kernel_rf_pc_15_1
mega_kernel_rf_il64:
s_cbranch_execz mega_kernel_rf_il65
.p2align 5
mega_kernel_rf_pc_15_1f:
s_mov_b64 exec, vcc
buffer_load_dwordx4 v[36:39], v7, s[84:87], s29 offen offset:1024 sc1
s_mov_b64 exec, -1
s_branch mega_kernel_rf_pc_15_2
.p2align 5
mega_kernel_rf_pc_15_1:
s_waitcnt vmcnt(3)
v_cmp_eq_u32 vcc, -1, v36
s_cbranch_vccnz mega_kernel_rf_pc_15_1f
v_smfmac_f32_16x16x64_bf16 v[96:99], v[36:39], a[200:207], v6
v_smfmac_f32_16x16x64_bf16 v[100:103], v[36:39], a[232:239], v6
s_branch mega_kernel_rf_pc_13_2
mega_kernel_rf_il65:
s_cbranch_execz mega_kernel_rf_il66
.p2align 5
mega_kernel_rf_pc_15_2f:
s_mov_b64 exec, vcc
buffer_load_dwordx4 v[40:43], v7, s[84:87], s29 offen offset:2048 sc1
s_mov_b64 exec, -1
s_branch mega_kernel_rf_pc_15_3
mega_kernel_rf_il66:
s_cbranch_execz mega_kernel_rf_il67
.p2align 5
mega_kernel_rf_pc_15_2:
s_waitcnt vmcnt(3)
v_cmp_eq_u32 vcc, -1, v40
s_cbranch_vccnz mega_kernel_rf_pc_15_2f
v_smfmac_f32_16x16x64_bf16 v[96:99], v[40:43], a[208:215], v6
v_smfmac_f32_16x16x64_bf16 v[100:103], v[40:43], a[240:247], v6
s_branch mega_kernel_rf_pc_11_3
.p2align 5
mega_kernel_rf_pc_15_3f:
s_mov_b64 exec, vcc
buffer_load_dwordx4 v[44:47], v7, s[84:87], s29 offen offset:3072 sc1
s_mov_b64 exec, -1
s_branch mega_kernel_rf_pc_15_0
mega_kernel_rf_il67:
s_cbranch_execz mega_kernel_rf_il68
.p2align 5
mega_kernel_rf_pc_15_3:
s_waitcnt vmcnt(3)
v_cmp_eq_u32 vcc, -1, v44
s_cbranch_vccnz mega_kernel_rf_pc_15_3f
v_smfmac_f32_16x16x64_bf16 v[96:99], v[44:47], a[216:223], v6
v_smfmac_f32_16x16x64_bf16 v[100:103], v[44:47], a[248:255], v6
s_branch mega_kernel_rf_pc_7_0
mega_kernel_rf_w0last:
s_nop 7
v_permlane32_swap_b32 v112, v116
v_permlane32_swap_b32 v113, v117
v_permlane32_swap_b32 v114, v118
v_permlane32_swap_b32 v115, v119
v_pk_add_f32 v[112:113], v[112:113], v[116:117]
v_pk_add_f32 v[114:115], v[114:115], v[118:119]
ds_write_b128 v20, v[112:115]
s_waitcnt lgkmcnt(0)
s_barrier
s_branch mega_kernel_rf_end
mega_kernel_rf_il68:
s_cbranch_execz mega_kernel_rf_il69
mega_kernel_rf_side:
s_cmp_eq_u32 s24, 3
s_cbranch_scc1 mega_kernel_rf_sd3
s_cmp_eq_u32 s24, 2
s_cbranch_scc0 mega_kernel_rf_sd4
s_mov_b64 exec, s[40:41]
buffer_store_dwordx4 v[28:31], v11, s[84:87], s34 offen
s_mov_b64 exec, -1
buffer_store_dwordx2 v[28:29], v9, s[84:87], s34 offen
s_mul_i32 s28, s31, 2048
s_add_u32 s28, s28, s34
s_add_u32 s28, s28, 49152
buffer_store_dwordx4 v[28:31], v17, s[84:87], s28 offen
buffer_store_dwordx4 v[28:31], v10, s[84:87], s28 offen
s_branch mega_kernel_rf_sd4
mega_kernel_rf_il69:
s_cbranch_execz mega_kernel_rf_il70
mega_kernel_rf_sd3:
v_readlane_b32 s76, v249, 0
v_readlane_b32 s77, v249, 1
s_min_i32 s76, s76, s77
s_max_i32 s46, s46, s76
s_mov_b32 s36, 0
s_add_u32 s76, s27, 1
s_cmp_lt_u32 s76, 63
s_cbranch_scc0 mega_kernel_rf_sd4
s_cmp_ge_u32 s76, 0
s_cbranch_scc0 mega_kernel_rf_sd4
s_cmp_gt_i32 s46, s76
s_cselect_b32 s36, 0, 1
s_cbranch_scc0 mega_kernel_rf_sd4
s_add_u32 s77, s76, s82
s_bfe_u32 s28, s77, 0x40002
s_lshl_b32 s28, s28, 14
s_and_b32 s77, s77, 3
s_lshl_b32 s77, s77, 11
s_add_u32 s28, s28, s77
s_add_u32 m0, s45, 0
s_nop 0
buffer_load_dwordx4 v240, s[84:87], s28 offen offset:0 sc1 lds
s_add_u32 m0, s45, 0
s_nop 0
buffer_load_dwordx4 v240, s[84:87], s28 offen offset:1024 sc1 lds
s_add_u32 m0, s45, 2048
s_nop 0
buffer_load_dwordx4 v241, s[84:87], s28 offen offset:0 sc1 lds
s_add_u32 m0, s45, 2048
s_nop 0
buffer_load_dwordx4 v241, s[84:87], s28 offen offset:1024 sc1 lds
s_add_u32 s45, s45, 4096
s_cmp_eq_u32 s45, 30720
s_cselect_b32 s45, 18432, s45
mega_kernel_rf_sd4:
v_smfmac_f32_16x16x64_bf16 v[112:115], v[40:43], a[144:151], v6
v_smfmac_f32_16x16x64_bf16 v[116:119], v[40:43], a[176:183], v6
v_smfmac_f32_16x16x64_bf16 v[112:115], v[44:47], a[152:159], v6
v_smfmac_f32_16x16x64_bf16 v[116:119], v[44:47], a[184:191], v6
s_nop 7
v_permlane32_swap_b32 v112, v116
v_permlane32_swap_b32 v113, v117
v_permlane32_swap_b32 v114, v118
v_permlane32_swap_b32 v115, v119
v_pk_add_f32 v[112:113], v[112:113], v[116:117]
v_pk_add_f32 v[114:115], v[114:115], v[118:119]
ds_write_b128 v20, v[112:115]
v_mov_b32 v96, 0
v_mov_b32 v97, 0
v_mov_b32 v98, 0
v_mov_b32 v99, 0
v_mov_b32 v100, 0
v_mov_b32 v101, 0
v_mov_b32 v102, 0
v_mov_b32 v103, 0
s_cmp_eq_u32 s24, 1
s_cbranch_scc0 mega_kernel_rf_s1
s_waitcnt lgkmcnt(0)
ds_read_b128 v[120:123], v16 offset:0
ds_read_b128 v[124:127], v16 offset:16
ds_read_b128 v[128:131], v16 offset:2304
ds_read_b128 v[132:135], v16 offset:2320
ds_read_b128 v[136:139], v16 offset:4608
ds_read_b128 v[140:143], v16 offset:4624
ds_read_b128 v[144:147], v16 offset:6912
ds_read_b128 v[148:151], v16 offset:6928
s_waitcnt lgkmcnt(4)
v_pk_add_f32 v[120:121], v[120:121], v[128:129]
v_pk_add_f32 v[122:123], v[122:123], v[130:131]
v_pk_add_f32 v[124:125], v[124:125], v[132:133]
v_pk_add_f32 v[126:127], v[126:127], v[134:135]
s_waitcnt lgkmcnt(0)
v_pk_add_f32 v[136:137], v[136:137], v[144:145]
v_pk_add_f32 v[138:139], v[138:139], v[146:147]
v_pk_add_f32 v[140:141], v[140:141], v[148:149]
v_pk_add_f32 v[142:143], v[142:143], v[150:151]
v_pk_add_f32 v[120:121], v[120:121], v[136:137]
v_pk_add_f32 v[122:123], v[122:123], v[138:139]
v_pk_add_f32 v[124:125], v[124:125], v[140:141]
v_pk_add_f32 v[126:127], v[126:127], v[142:143]
v_cvt_pk_bf16_f32 v244, v120, v121
v_cvt_pk_bf16_f32 v245, v122, v123
v_cvt_pk_bf16_f32 v246, v124, v125
v_cvt_pk_bf16_f32 v247, v126, v127
mega_kernel_rf_s1:
v_add_u32 v5, 9216, v17
s_waitcnt lgkmcnt(0)
s_barrier
s_cmp_eq_u32 s24, 2
s_cbranch_scc1 mega_kernel_rf_s2
s_cmp_eq_u32 s24, 3
s_cbranch_scc0 mega_kernel_rf_s3
s_add_u32 s76, s27, 2
s_cmp_lt_u32 s76, 63
s_cbranch_scc0 mega_kernel_rf_s3
s_cmp_gt_i32 s46, s76
s_cbranch_scc0 mega_kernel_rf_s3
s_add_u32 s77, s76, s82
s_bfe_u32 s28, s77, 0x40002
s_lshl_b32 s28, s28, 14
s_and_b32 s77, s77, 3
s_lshl_b32 s77, s77, 11
s_add_u32 s28, s28, s77
s_add_u32 s28, s28, s83
s_buffer_load_dword s78, s[84:87], s28 offset:0
s_buffer_load_dword s78, s[84:87], s28 offset:128
s_buffer_load_dword s78, s[84:87], s28 offset:256
s_buffer_load_dword s78, s[84:87], s28 offset:384
s_buffer_load_dword s78, s[84:87], s28 offset:512
s_buffer_load_dword s78, s[84:87], s28 offset:640
s_buffer_load_dword s78, s[84:87], s28 offset:768
s_buffer_load_dword s78, s[84:87], s28 offset:896
s_buffer_load_dword s78, s[84:87], s28 offset:1024
s_buffer_load_dword s78, s[84:87], s28 offset:1152
s_buffer_load_dword s78, s[84:87], s28 offset:1280
s_buffer_load_dword s78, s[84:87], s28 offset:1408
s_buffer_load_dword s78, s[84:87], s28 offset:1536
s_buffer_load_dword s78, s[84:87], s28 offset:1664
s_buffer_load_dword s78, s[84:87], s28 offset:1792
s_buffer_load_dword s78, s[84:87], s28 offset:1920
s_mov_b32 s88, s76
s_branch mega_kernel_rf_s3
mega_kernel_rf_il70:
s_cbranch_execz mega_kernel_rf_il71
mega_kernel_rf_s2:
ds_read_b128 v[120:123], v5 offset:0
ds_read_b128 v[124:127], v5 offset:1024
ds_read_b128 v[128:131], v5 offset:2048
ds_read_b128 v[132:135], v5 offset:3072
v_lshrrev_b32 v5, 1, v17
s_waitcnt lgkmcnt(2)
v_pk_add_f32 v[120:121], v[120:121], v[124:125]
v_pk_add_f32 v[122:123], v[122:123], v[126:127]
s_waitcnt lgkmcnt(0)
v_pk_add_f32 v[128:129], v[128:129], v[132:133]
v_pk_add_f32 v[130:131], v[130:131], v[134:135]
v_pk_add_f32 v[120:121], v[120:121], v[128:129]
v_pk_add_f32 v[122:123], v[122:123], v[130:131]
v_cvt_pk_bf16_f32 v244, v120, v121
v_cvt_pk_bf16_f32 v245, v122, v123
ds_write_b64 v5, v[244:245] offset:17920
s_waitcnt lgkmcnt(0) vmcnt(0)
mega_kernel_rf_s3:
s_cmp_eq_u32 s27, 63
s_cbranch_scc1 mega_kernel_rf_slast
s_add_u32 s29, s33, 24576
s_barrier
s_cmp_eq_u32 s24, 3
s_cbranch_scc1 mega_kernel_rf_y3
s_add_u32 s77, s27, s82
s_bfe_u32 s28, s77, 0x30003
s_lshl_b32 s28, s28, 14
s_and_b32 s77, s77, 7
s_lshl_b32 s77, s77, 10
s_add_u32 s28, s28, s77
s_add_u32 s28, s28, s79
s_cmp_eq_u32 s24, 2
s_cbranch_scc1 mega_kernel_rf_kv2a
s_mov_b64 exec, s[48:49]
buffer_store_dwordx4 v[244:247], v22, s[84:87], s28 offen sc1
s_mov_b64 exec, -1
s_branch mega_kernel_rf_kvda
mega_kernel_rf_il71:
s_cbranch_execz mega_kernel_rf_il72
mega_kernel_rf_kv2a:
v_lshlrev_b32 v4, 3, v1
buffer_store_dwordx2 v[244:245], v4, s[84:87], s28 offen offset:512 sc1
mega_kernel_rf_kvda:
s_branch mega_kernel_rf_y4
mega_kernel_rf_y3:
s_add_u32 s76, s27, 2
s_cmp_lt_u32 s76, 63
s_cbranch_scc0 mega_kernel_rf_y4
mega_kernel_rf_y4:
s_branch mega_kernel_rf_b3
mega_kernel_rf_first:
v_add_u32 v5, s44, v17
ds_read_b128 v[156:159], v5 offset:0
ds_read_b128 v[160:163], v5 offset:1024
ds_read_b128 v[164:167], v5 offset:2048
ds_read_b128 v[168:171], v5 offset:3072
s_branch mega_kernel_rf_adone
mega_kernel_rf_il72:
s_cbranch_execz mega_kernel_rf_il73
mega_kernel_rf_slast:
s_cmp_eq_u32 s24, 3
s_cbranch_scc1 mega_kernel_rf_end
s_add_u32 s77, s27, s82
s_bfe_u32 s28, s77, 0x30003
s_lshl_b32 s28, s28, 14
s_and_b32 s77, s77, 7
s_lshl_b32 s77, s77, 10
s_add_u32 s28, s28, s77
s_add_u32 s28, s28, s79
s_cmp_eq_u32 s24, 2
s_cbranch_scc1 mega_kernel_rf_kv2b
s_mov_b64 exec, s[48:49]
buffer_store_dwordx4 v[244:247], v22, s[84:87], s28 offen sc1
s_mov_b64 exec, -1
s_branch mega_kernel_rf_kvdb
mega_kernel_rf_il73:
s_cbranch_execz mega_kernel_rf_iwd
mega_kernel_rf_kv2b:
v_lshlrev_b32 v4, 3, v1
buffer_store_dwordx2 v[244:245], v4, s[84:87], s28 offen offset:512 sc1
mega_kernel_rf_kvdb:
s_waitcnt vmcnt(0)
s_barrier
s_mov_b32 s76, 64
s_cmp_eq_u32 s24, 1
s_cbranch_scc0 mega_kernel_rf_end
v_mov_b32 v5, s76
s_mov_b64 exec, 1
buffer_store_dword v5, v228, s[84:87], s81 offen sc1
s_mov_b64 exec, -1
mega_kernel_rf_end:
s_endpgm
mega_kernel_recs:
s_load_dwordx2 s[20:21], s[0:1], 8
s_load_dwordx2 s[16:17], s[0:1], 40
s_load_dwordx2 s[4:5], s[0:1], 16
s_load_dwordx2 s[8:9], s[0:1], 24
s_load_dwordx2 s[12:13], s[0:1], 32
v_lshrrev_b32 v4, 6, v0
v_and_b32 v1, 63, v0
v_readfirstlane_b32 s24, v4
v_lshrrev_b32 v2, 4, v1
v_and_b32 v3, 15, v1
v_lshlrev_b32 v17, 4, v1
s_lshr_b32 s28, s31, 2
s_lshl_b32 s25, s30, 3
s_add_u32 s25, s25, s28
s_and_b32 s26, s31, 3
s_waitcnt lgkmcnt(0)
s_mov_b32 s22, 16384
s_mov_b32 s23, 0x00020000
s_mov_b32 s18, 8388608
s_mov_b32 s19, 0x00020000
s_mov_b32 s6, 8388608
s_mov_b32 s7, 0x00020000
s_mov_b32 s10, 8388608
s_mov_b32 s11, 0x00020000
s_mov_b32 s14, 8388608
s_mov_b32 s15, 0x00020000
s_lshl_b32 s28, s25, 8
s_lshr_b32 s29, s26, 0
s_lshl_b32 s29, s29, 6
s_add_u32 s28, s28, s29
s_lshl_b32 s29, s24, 21
s_add_u32 s28, s28, s29
v_lshrrev_b32 v4, 2, v1
v_and_b32 v5, 3, v1
v_lshlrev_b32 v40, 13, v4
v_lshl_add_u32 v40, v5, 4, v40
v_add_u32 v40, s28, v40
s_lshl_b32 s28, s30, 21
s_lshl_b32 s29, s24, 19
s_add_u32 s28, s28, s29
s_lshr_b32 s29, s31, 0
s_lshl_b32 s29, s29, 6
s_add_u32 s28, s28, s29
v_lshlrev_b32 v41, 11, v4
v_lshl_add_u32 v41, v5, 4, v41
v_add_u32 v41, s28, v41
s_lshl_b32 s47, s24, 15
s_add_u32 s47, s47, 32768
s_lshl_b32 s28, s31, 18
s_lshl_b32 s29, s24, 16
s_add_u32 s28, s28, s29
s_lshl_b32 s29, s30, 11
s_add_u32 s28, s28, s29
v_lshlrev_b32 v48, 13, v2
v_lshl_add_u32 v48, v3, 7, v48
v_add_u32 v48, s28, v48
s_lshl_b32 s28, s30, 21
s_lshl_b32 s29, s31, 16
s_add_u32 s28, s28, s29
s_lshl_b32 s29, s24, 14
s_add_u32 s28, s28, s29
v_lshlrev_b32 v49, 7, v1
v_add_u32 v49, s28, v49
s_and_b32 s76, s31, 1
s_mul_i32 s76, s76, 8
s_and_b32 s28, s31, 15
s_lshl_b32 s28, s28, 4
s_lshl_b32 s29, s24, 8
s_add_u32 s28, s28, s29
v_add_u32 v53, s28, v3
s_lshr_b32 s28, s31, 4
s_lshl_b32 s28, s28, 10
s_add_u32 s28, s28, 384
v_mov_b32 v54, s28
v_mov_b32 v55, 1920
v_cmp_gt_u32 vcc, 32, v1
s_nop 1
v_cndmask_b32 v54, v55, v54, vcc
s_lshl_b32 s29, s30, 11
v_lshl_add_u32 v51, v53, 13, v54
v_add_u32 v51, s29, v51
s_lshl_b32 s29, s30, 21
v_lshl_add_u32 v52, v53, 11, v54
v_add_u32 v52, s29, v52
buffer_load_dword v50, v51, s[8:11], 0 offen
s_xor_b32 s29, s76, 0
s_lshl_b32 s28, s29, 10
s_add_u32 s28, s28, s47
s_add_u32 m0, s28, 0
s_lshl_b32 s29, s29, 17
buffer_load_dwordx4 v40, s[8:11], s29 offen lds
s_xor_b32 s29, s76, 1
s_lshl_b32 s28, s29, 10
s_add_u32 s28, s28, s47
s_add_u32 m0, s28, 0
s_lshl_b32 s29, s29, 17
buffer_load_dwordx4 v40, s[8:11], s29 offen lds
s_xor_b32 s29, s76, 2
s_lshl_b32 s28, s29, 10
s_add_u32 s28, s28, s47
s_add_u32 m0, s28, 0
s_lshl_b32 s29, s29, 17
buffer_load_dwordx4 v40, s[8:11], s29 offen lds
s_xor_b32 s29, s76, 3
s_lshl_b32 s28, s29, 10
s_add_u32 s28, s28, s47
s_add_u32 m0, s28, 0
s_lshl_b32 s29, s29, 17
buffer_load_dwordx4 v40, s[8:11], s29 offen lds
s_xor_b32 s29, s76, 4
s_lshl_b32 s28, s29, 10
s_add_u32 s28, s28, s47
s_add_u32 m0, s28, 0
s_lshl_b32 s29, s29, 17
buffer_load_dwordx4 v40, s[8:11], s29 offen lds
s_xor_b32 s29, s76, 5
s_lshl_b32 s28, s29, 10
s_add_u32 s28, s28, s47
s_add_u32 m0, s28, 0
s_lshl_b32 s29, s29, 17
buffer_load_dwordx4 v40, s[8:11], s29 offen lds
s_xor_b32 s29, s76, 6
s_lshl_b32 s28, s29, 10
s_add_u32 s28, s28, s47
s_add_u32 m0, s28, 0
s_lshl_b32 s29, s29, 17
buffer_load_dwordx4 v40, s[8:11], s29 offen lds
s_xor_b32 s29, s76, 7
s_lshl_b32 s28, s29, 10
s_add_u32 s28, s28, s47
s_add_u32 m0, s28, 0
s_lshl_b32 s29, s29, 17
buffer_load_dwordx4 v40, s[8:11], s29 offen lds
s_xor_b32 s29, s76, 8
s_lshl_b32 s28, s29, 10
s_add_u32 s28, s28, s47
s_add_u32 m0, s28, 0
s_lshl_b32 s29, s29, 17
buffer_load_dwordx4 v40, s[8:11], s29 offen lds
s_xor_b32 s29, s76, 9
s_lshl_b32 s28, s29, 10
s_add_u32 s28, s28, s47
s_add_u32 m0, s28, 0
s_lshl_b32 s29, s29, 17
buffer_load_dwordx4 v40, s[8:11], s29 offen lds
s_xor_b32 s29, s76, 10
s_lshl_b32 s28, s29, 10
s_add_u32 s28, s28, s47
s_add_u32 m0, s28, 0
s_lshl_b32 s29, s29, 17
buffer_load_dwordx4 v40, s[8:11], s29 offen lds
s_xor_b32 s29, s76, 11
s_lshl_b32 s28, s29, 10
s_add_u32 s28, s28, s47
s_add_u32 m0, s28, 0
s_lshl_b32 s29, s29, 17
buffer_load_dwordx4 v40, s[8:11], s29 offen lds
s_xor_b32 s29, s76, 12
s_lshl_b32 s28, s29, 10
s_add_u32 s28, s28, s47
s_add_u32 m0, s28, 0
s_lshl_b32 s29, s29, 17
buffer_load_dwordx4 v40, s[8:11], s29 offen lds
s_xor_b32 s29, s76, 13
s_lshl_b32 s28, s29, 10
s_add_u32 s28, s28, s47
s_add_u32 m0, s28, 0
s_lshl_b32 s29, s29, 17
buffer_load_dwordx4 v40, s[8:11], s29 offen lds
s_xor_b32 s29, s76, 14
s_lshl_b32 s28, s29, 10
s_add_u32 s28, s28, s47
s_add_u32 m0, s28, 0
s_lshl_b32 s29, s29, 17
buffer_load_dwordx4 v40, s[8:11], s29 offen lds
s_xor_b32 s29, s76, 15
s_lshl_b32 s28, s29, 10
s_add_u32 s28, s28, s47
s_add_u32 m0, s28, 0
s_lshl_b32 s29, s29, 17
buffer_load_dwordx4 v40, s[8:11], s29 offen lds
buffer_load_dword v50, v51, s[12:15], 0 offen
s_xor_b32 s29, s76, 0
s_lshl_b32 s28, s29, 10
s_add_u32 s28, s28, s47
s_add_u32 m0, s28, 16384
s_lshl_b32 s29, s29, 17
buffer_load_dwordx4 v40, s[12:15], s29 offen lds
s_xor_b32 s29, s76, 1
s_lshl_b32 s28, s29, 10
s_add_u32 s28, s28, s47
s_add_u32 m0, s28, 16384
s_lshl_b32 s29, s29, 17
buffer_load_dwordx4 v40, s[12:15], s29 offen lds
s_xor_b32 s29, s76, 2
s_lshl_b32 s28, s29, 10
s_add_u32 s28, s28, s47
s_add_u32 m0, s28, 16384
s_lshl_b32 s29, s29, 17
buffer_load_dwordx4 v40, s[12:15], s29 offen lds
s_xor_b32 s29, s76, 3
s_lshl_b32 s28, s29, 10
s_add_u32 s28, s28, s47
s_add_u32 m0, s28, 16384
s_lshl_b32 s29, s29, 17
buffer_load_dwordx4 v40, s[12:15], s29 offen lds
s_xor_b32 s29, s76, 4
s_lshl_b32 s28, s29, 10
s_add_u32 s28, s28, s47
s_add_u32 m0, s28, 16384
s_lshl_b32 s29, s29, 17
buffer_load_dwordx4 v40, s[12:15], s29 offen lds
s_xor_b32 s29, s76, 5
s_lshl_b32 s28, s29, 10
s_add_u32 s28, s28, s47
s_add_u32 m0, s28, 16384
s_lshl_b32 s29, s29, 17
buffer_load_dwordx4 v40, s[12:15], s29 offen lds
s_xor_b32 s29, s76, 6
s_lshl_b32 s28, s29, 10
s_add_u32 s28, s28, s47
s_add_u32 m0, s28, 16384
s_lshl_b32 s29, s29, 17
buffer_load_dwordx4 v40, s[12:15], s29 offen lds
s_xor_b32 s29, s76, 7
s_lshl_b32 s28, s29, 10
s_add_u32 s28, s28, s47
s_add_u32 m0, s28, 16384
s_lshl_b32 s29, s29, 17
buffer_load_dwordx4 v40, s[12:15], s29 offen lds
s_xor_b32 s29, s76, 8
s_lshl_b32 s28, s29, 10
s_add_u32 s28, s28, s47
s_add_u32 m0, s28, 16384
s_lshl_b32 s29, s29, 17
buffer_load_dwordx4 v40, s[12:15], s29 offen lds
s_xor_b32 s29, s76, 9
s_lshl_b32 s28, s29, 10
s_add_u32 s28, s28, s47
s_add_u32 m0, s28, 16384
s_lshl_b32 s29, s29, 17
buffer_load_dwordx4 v40, s[12:15], s29 offen lds
s_xor_b32 s29, s76, 10
s_lshl_b32 s28, s29, 10
s_add_u32 s28, s28, s47
s_add_u32 m0, s28, 16384
s_lshl_b32 s29, s29, 17
buffer_load_dwordx4 v40, s[12:15], s29 offen lds
s_xor_b32 s29, s76, 11
s_lshl_b32 s28, s29, 10
s_add_u32 s28, s28, s47
s_add_u32 m0, s28, 16384
s_lshl_b32 s29, s29, 17
buffer_load_dwordx4 v40, s[12:15], s29 offen lds
s_xor_b32 s29, s76, 12
s_lshl_b32 s28, s29, 10
s_add_u32 s28, s28, s47
s_add_u32 m0, s28, 16384
s_lshl_b32 s29, s29, 17
buffer_load_dwordx4 v40, s[12:15], s29 offen lds
s_xor_b32 s29, s76, 13
s_lshl_b32 s28, s29, 10
s_add_u32 s28, s28, s47
s_add_u32 m0, s28, 16384
s_lshl_b32 s29, s29, 17
buffer_load_dwordx4 v40, s[12:15], s29 offen lds
s_xor_b32 s29, s76, 14
s_lshl_b32 s28, s29, 10
s_add_u32 s28, s28, s47
s_add_u32 m0, s28, 16384
s_lshl_b32 s29, s29, 17
buffer_load_dwordx4 v40, s[12:15], s29 offen lds
s_xor_b32 s29, s76, 15
s_lshl_b32 s28, s29, 10
s_add_u32 s28, s28, s47
s_add_u32 m0, s28, 16384
s_lshl_b32 s29, s29, 17
buffer_load_dwordx4 v40, s[12:15], s29 offen lds
s_mov_b32 s40, 0x00ff00ff
s_mov_b32 s41, 0x00ff00ff
s_mov_b32 s48, 0xff00ff00
s_mov_b32 s49, 0xff00ff00
s_mov_b32 s42, 0
s_mov_b32 s43, 0x00ff00ff
s_mov_b32 s32, 0x3e0293ee
v_mov_b32 v23, 0xff800000
v_mov_b32 v6, 0x4444
v_mov_b32 v4, 0xeeee
v_cndmask_b32 v6, v6, v4, s[48:49]
v_mov_b32 v28, -1
v_mov_b32 v29, -1
v_mov_b32 v30, -1
v_mov_b32 v31, -1
s_mul_i32 s28, s24, 4096
v_add_u32 v7, s28, v17
v_and_b32 v4, 7, v1
v_lshlrev_b32 v8, 11, v4
v_lshrrev_b32 v5, 3, v1
v_lshl_add_u32 v8, v5, 4, v8
s_lshl_b32 s28, s24, 9
v_add_u32 v8, s28, v8
s_lshl_b32 s28, s31, 9
s_lshr_b32 s29, s31, 3
s_mul_i32 s29, s29, 0
s_add_u32 s28, s28, s29
v_lshlrev_b32 v9, 3, v1
v_add_u32 v9, s28, v9
v_and_b32 v4, 7, v3
v_lshlrev_b32 v11, 7, v2
v_lshl_add_u32 v11, v4, 4, v11
v_add_u32 v22, 0, v11
s_add_u32 s28, s28, 24576
v_add_u32 v11, s28, v11
v_and_b32 v5, 1, v2
v_lshlrev_b32 v10, 7, v5
v_lshl_add_u32 v10, v4, 4, v10
v_add_u32 v10, 1024, v10
s_xor_b32 s37, s31, 1
s_mul_i32 s37, s37, 2048
s_add_u32 s37, s37, 49152
s_xor_b32 s38, s31, 2
s_mul_i32 s38, s38, 2048
s_add_u32 s38, s38, 49152
s_xor_b32 s39, s31, 3
s_mul_i32 s39, s39, 2048
s_add_u32 s39, s39, 49152
v_and_b32 v4, 1, v2
v_mul_u32_u24 v14, 576, v4
v_lshrrev_b32 v5, 1, v2
v_lshl_add_u32 v5, v5, 4, v3
v_lshl_add_u32 v14, v5, 2, v14
s_mul_i32 s28, s24, 1152
s_add_u32 s28, s28, 13312
v_add_u32 v18, s28, v14
s_mul_i32 s28, s24, 2304
v_add_u32 v14, s28, v14
v_add_u32 v15, 1152, v14
v_mul_u32_u24 v16, 144, v3
v_lshl_add_u32 v16, v2, 5, v16
v_bfe_u32 v4, v1, 1, 3
v_mul_u32_u24 v19, 144, v4
v_lshl_add_u32 v19, v2, 5, v19
v_and_b32 v4, 1, v1
v_lshl_add_u32 v19, v4, 4, v19
v_add_u32 v19, 13312, v19
s_lshl_b32 s28, s24, 10
s_add_u32 s28, s28, 9216
v_add_u32 v20, s28, v17
v_and_b32 v4, 31, v1
v_lshlrev_b32 v21, 3, v4
v_add_u32 v21, 17920, v21
v_lshrrev_b32 v4, 2, v3
v_and_b32 v42, 1, v4
v_lshrrev_b32 v43, 1, v4
v_lshrrev_b32 v44, 1, v2
v_and_b32 v45, 1, v2
v_lshl_add_u32 v46, v44, 4, v42
v_lshl_add_u32 v46, v45, 2, v46
v_lshl_add_u32 v46, v43, 3, v46
v_lshl_add_u32 v47, v44, 3, v42
v_lshl_add_u32 v47, v45, 4, v47
v_lshl_add_u32 v47, v43, 2, v47
v_and_b32 v5, 3, v3
v_lshlrev_b32 v5, 3, v5
v_lshl_add_u32 v46, v46, 6, v5
v_lshl_add_u32 v47, v47, 6, v5
s_and_b32 s28, s31, 0
s_lshl_b32 s28, s28, 6
s_add_u32 s28, s28, s47
v_add_u32 v46, s28, v46
v_add_u32 v47, s28, v47
s_waitcnt vmcnt(17)
ds_read_b64_tr_b16 a[64:65], v46 offset:0
ds_read_b64_tr_b16 a[66:67], v46 offset:128
ds_read_b64_tr_b16 a[68:69], v46 offset:2048
ds_read_b64_tr_b16 a[70:71], v46 offset:2176
ds_read_b64_tr_b16 a[72:73], v46 offset:4096
ds_read_b64_tr_b16 a[74:75], v46 offset:4224
ds_read_b64_tr_b16 a[76:77], v46 offset:6144
ds_read_b64_tr_b16 a[78:79], v46 offset:6272
s_waitcnt lgkmcnt(0)
ds_read_b64_tr_b16 a[80:81], v46 offset:8192
ds_read_b64_tr_b16 a[82:83], v46 offset:8320
ds_read_b64_tr_b16 a[84:85], v46 offset:10240
ds_read_b64_tr_b16 a[86:87], v46 offset:10368
ds_read_b64_tr_b16 a[88:89], v46 offset:12288
ds_read_b64_tr_b16 a[90:91], v46 offset:12416
ds_read_b64_tr_b16 a[92:93], v46 offset:14336
ds_read_b64_tr_b16 a[94:95], v46 offset:14464
s_waitcnt lgkmcnt(0)
ds_read_b64_tr_b16 a[96:97], v46 offset:32
ds_read_b64_tr_b16 a[98:99], v46 offset:160
ds_read_b64_tr_b16 a[100:101], v46 offset:2080
ds_read_b64_tr_b16 a[102:103], v46 offset:2208
ds_read_b64_tr_b16 a[104:105], v46 offset:4128
ds_read_b64_tr_b16 a[106:107], v46 offset:4256
ds_read_b64_tr_b16 a[108:109], v46 offset:6176
ds_read_b64_tr_b16 a[110:111], v46 offset:6304
s_waitcnt lgkmcnt(0)
ds_read_b64_tr_b16 a[112:113], v46 offset:8224
ds_read_b64_tr_b16 a[114:115], v46 offset:8352
ds_read_b64_tr_b16 a[116:117], v46 offset:10272
ds_read_b64_tr_b16 a[118:119], v46 offset:10400
ds_read_b64_tr_b16 a[120:121], v46 offset:12320
ds_read_b64_tr_b16 a[122:123], v46 offset:12448
ds_read_b64_tr_b16 a[124:125], v46 offset:14368
ds_read_b64_tr_b16 a[126:127], v46 offset:14496
s_waitcnt lgkmcnt(0)
buffer_load_dword v50, v51, s[4:7], 0 offen
s_xor_b32 s29, s76, 0
s_lshl_b32 s28, s29, 10
s_add_u32 s28, s28, s47
s_add_u32 m0, s28, 0
s_lshl_b32 s29, s29, 17
buffer_load_dwordx4 v40, s[4:7], s29 offen lds
s_xor_b32 s29, s76, 1
s_lshl_b32 s28, s29, 10
s_add_u32 s28, s28, s47
s_add_u32 m0, s28, 0
s_lshl_b32 s29, s29, 17
buffer_load_dwordx4 v40, s[4:7], s29 offen lds
s_xor_b32 s29, s76, 2
s_lshl_b32 s28, s29, 10
s_add_u32 s28, s28, s47
s_add_u32 m0, s28, 0
s_lshl_b32 s29, s29, 17
buffer_load_dwordx4 v40, s[4:7], s29 offen lds
s_xor_b32 s29, s76, 3
s_lshl_b32 s28, s29, 10
s_add_u32 s28, s28, s47
s_add_u32 m0, s28, 0
s_lshl_b32 s29, s29, 17
buffer_load_dwordx4 v40, s[4:7], s29 offen lds
s_xor_b32 s29, s76, 4
s_lshl_b32 s28, s29, 10
s_add_u32 s28, s28, s47
s_add_u32 m0, s28, 0
s_lshl_b32 s29, s29, 17
buffer_load_dwordx4 v40, s[4:7], s29 offen lds
s_xor_b32 s29, s76, 5
s_lshl_b32 s28, s29, 10
s_add_u32 s28, s28, s47
s_add_u32 m0, s28, 0
s_lshl_b32 s29, s29, 17
buffer_load_dwordx4 v40, s[4:7], s29 offen lds
s_xor_b32 s29, s76, 6
s_lshl_b32 s28, s29, 10
s_add_u32 s28, s28, s47
s_add_u32 m0, s28, 0
s_lshl_b32 s29, s29, 17
buffer_load_dwordx4 v40, s[4:7], s29 offen lds
s_xor_b32 s29, s76, 7
s_lshl_b32 s28, s29, 10
s_add_u32 s28, s28, s47
s_add_u32 m0, s28, 0
s_lshl_b32 s29, s29, 17
buffer_load_dwordx4 v40, s[4:7], s29 offen lds
s_xor_b32 s29, s76, 8
s_lshl_b32 s28, s29, 10
s_add_u32 s28, s28, s47
s_add_u32 m0, s28, 0
s_lshl_b32 s29, s29, 17
buffer_load_dwordx4 v40, s[4:7], s29 offen lds
s_xor_b32 s29, s76, 9
s_lshl_b32 s28, s29, 10
s_add_u32 s28, s28, s47
s_add_u32 m0, s28, 0
s_lshl_b32 s29, s29, 17
buffer_load_dwordx4 v40, s[4:7], s29 offen lds
s_xor_b32 s29, s76, 10
s_lshl_b32 s28, s29, 10
s_add_u32 s28, s28, s47
s_add_u32 m0, s28, 0
s_lshl_b32 s29, s29, 17
buffer_load_dwordx4 v40, s[4:7], s29 offen lds
s_xor_b32 s29, s76, 11
s_lshl_b32 s28, s29, 10
s_add_u32 s28, s28, s47
s_add_u32 m0, s28, 0
s_lshl_b32 s29, s29, 17
buffer_load_dwordx4 v40, s[4:7], s29 offen lds
s_xor_b32 s29, s76, 12
s_lshl_b32 s28, s29, 10
s_add_u32 s28, s28, s47
s_add_u32 m0, s28, 0
s_lshl_b32 s29, s29, 17
buffer_load_dwordx4 v40, s[4:7], s29 offen lds
s_xor_b32 s29, s76, 13
s_lshl_b32 s28, s29, 10
s_add_u32 s28, s28, s47
s_add_u32 m0, s28, 0
s_lshl_b32 s29, s29, 17
buffer_load_dwordx4 v40, s[4:7], s29 offen lds
s_xor_b32 s29, s76, 14
s_lshl_b32 s28, s29, 10
s_add_u32 s28, s28, s47
s_add_u32 m0, s28, 0
s_lshl_b32 s29, s29, 17
buffer_load_dwordx4 v40, s[4:7], s29 offen lds
s_xor_b32 s29, s76, 15
s_lshl_b32 s28, s29, 10
s_add_u32 s28, s28, s47
s_add_u32 m0, s28, 0
s_lshl_b32 s29, s29, 17
buffer_load_dwordx4 v40, s[4:7], s29 offen lds
s_waitcnt vmcnt(17)
ds_read_b64_tr_b16 a[128:129], v46 offset:16384
ds_read_b64_tr_b16 a[130:131], v46 offset:16512
ds_read_b64_tr_b16 a[132:133], v46 offset:18432
ds_read_b64_tr_b16 a[134:135], v46 offset:18560
ds_read_b64_tr_b16 a[136:137], v46 offset:20480
ds_read_b64_tr_b16 a[138:139], v46 offset:20608
ds_read_b64_tr_b16 a[140:141], v46 offset:22528
ds_read_b64_tr_b16 a[142:143], v46 offset:22656
s_waitcnt lgkmcnt(0)
ds_read_b64_tr_b16 a[144:145], v46 offset:24576
ds_read_b64_tr_b16 a[146:147], v46 offset:24704
ds_read_b64_tr_b16 a[148:149], v46 offset:26624
ds_read_b64_tr_b16 a[150:151], v46 offset:26752
ds_read_b64_tr_b16 a[152:153], v46 offset:28672
ds_read_b64_tr_b16 a[154:155], v46 offset:28800
ds_read_b64_tr_b16 a[156:157], v46 offset:30720
ds_read_b64_tr_b16 a[158:159], v46 offset:30848
s_waitcnt lgkmcnt(0)
ds_read_b64_tr_b16 a[160:161], v46 offset:16416
ds_read_b64_tr_b16 a[162:163], v46 offset:16544
ds_read_b64_tr_b16 a[164:165], v46 offset:18464
ds_read_b64_tr_b16 a[166:167], v46 offset:18592
ds_read_b64_tr_b16 a[168:169], v46 offset:20512
ds_read_b64_tr_b16 a[170:171], v46 offset:20640
ds_read_b64_tr_b16 a[172:173], v46 offset:22560
ds_read_b64_tr_b16 a[174:175], v46 offset:22688
s_waitcnt lgkmcnt(0)
ds_read_b64_tr_b16 a[176:177], v46 offset:24608
ds_read_b64_tr_b16 a[178:179], v46 offset:24736
ds_read_b64_tr_b16 a[180:181], v46 offset:26656
ds_read_b64_tr_b16 a[182:183], v46 offset:26784
ds_read_b64_tr_b16 a[184:185], v46 offset:28704
ds_read_b64_tr_b16 a[186:187], v46 offset:28832
ds_read_b64_tr_b16 a[188:189], v46 offset:30752
ds_read_b64_tr_b16 a[190:191], v46 offset:30880
s_waitcnt lgkmcnt(0)
buffer_load_dword v50, v52, s[16:19], 0 offen
s_xor_b32 s29, s76, 0
s_lshl_b32 s28, s29, 10
s_add_u32 s28, s28, s47
s_add_u32 m0, s28, 16384
s_lshl_b32 s29, s29, 15
buffer_load_dwordx4 v41, s[16:19], s29 offen lds
s_xor_b32 s29, s76, 1
s_lshl_b32 s28, s29, 10
s_add_u32 s28, s28, s47
s_add_u32 m0, s28, 16384
s_lshl_b32 s29, s29, 15
buffer_load_dwordx4 v41, s[16:19], s29 offen lds
s_xor_b32 s29, s76, 2
s_lshl_b32 s28, s29, 10
s_add_u32 s28, s28, s47
s_add_u32 m0, s28, 16384
s_lshl_b32 s29, s29, 15
buffer_load_dwordx4 v41, s[16:19], s29 offen lds
s_xor_b32 s29, s76, 3
s_lshl_b32 s28, s29, 10
s_add_u32 s28, s28, s47
s_add_u32 m0, s28, 16384
s_lshl_b32 s29, s29, 15
buffer_load_dwordx4 v41, s[16:19], s29 offen lds
s_xor_b32 s29, s76, 4
s_lshl_b32 s28, s29, 10
s_add_u32 s28, s28, s47
s_add_u32 m0, s28, 16384
s_lshl_b32 s29, s29, 15
buffer_load_dwordx4 v41, s[16:19], s29 offen lds
s_xor_b32 s29, s76, 5
s_lshl_b32 s28, s29, 10
s_add_u32 s28, s28, s47
s_add_u32 m0, s28, 16384
s_lshl_b32 s29, s29, 15
buffer_load_dwordx4 v41, s[16:19], s29 offen lds
s_xor_b32 s29, s76, 6
s_lshl_b32 s28, s29, 10
s_add_u32 s28, s28, s47
s_add_u32 m0, s28, 16384
s_lshl_b32 s29, s29, 15
buffer_load_dwordx4 v41, s[16:19], s29 offen lds
s_xor_b32 s29, s76, 7
s_lshl_b32 s28, s29, 10
s_add_u32 s28, s28, s47
s_add_u32 m0, s28, 16384
s_lshl_b32 s29, s29, 15
buffer_load_dwordx4 v41, s[16:19], s29 offen lds
s_xor_b32 s29, s76, 8
s_lshl_b32 s28, s29, 10
s_add_u32 s28, s28, s47
s_add_u32 m0, s28, 16384
s_lshl_b32 s29, s29, 15
buffer_load_dwordx4 v41, s[16:19], s29 offen lds
s_xor_b32 s29, s76, 9
s_lshl_b32 s28, s29, 10
s_add_u32 s28, s28, s47
s_add_u32 m0, s28, 16384
s_lshl_b32 s29, s29, 15
buffer_load_dwordx4 v41, s[16:19], s29 offen lds
s_xor_b32 s29, s76, 10
s_lshl_b32 s28, s29, 10
s_add_u32 s28, s28, s47
s_add_u32 m0, s28, 16384
s_lshl_b32 s29, s29, 15
buffer_load_dwordx4 v41, s[16:19], s29 offen lds
s_xor_b32 s29, s76, 11
s_lshl_b32 s28, s29, 10
s_add_u32 s28, s28, s47
s_add_u32 m0, s28, 16384
s_lshl_b32 s29, s29, 15
buffer_load_dwordx4 v41, s[16:19], s29 offen lds
s_xor_b32 s29, s76, 12
s_lshl_b32 s28, s29, 10
s_add_u32 s28, s28, s47
s_add_u32 m0, s28, 16384
s_lshl_b32 s29, s29, 15
buffer_load_dwordx4 v41, s[16:19], s29 offen lds
s_xor_b32 s29, s76, 13
s_lshl_b32 s28, s29, 10
s_add_u32 s28, s28, s47
s_add_u32 m0, s28, 16384
s_lshl_b32 s29, s29, 15
buffer_load_dwordx4 v41, s[16:19], s29 offen lds
s_xor_b32 s29, s76, 14
s_lshl_b32 s28, s29, 10
s_add_u32 s28, s28, s47
s_add_u32 m0, s28, 16384
s_lshl_b32 s29, s29, 15
buffer_load_dwordx4 v41, s[16:19], s29 offen lds
s_xor_b32 s29, s76, 15
s_lshl_b32 s28, s29, 10
s_add_u32 s28, s28, s47
s_add_u32 m0, s28, 16384
s_lshl_b32 s29, s29, 15
buffer_load_dwordx4 v41, s[16:19], s29 offen lds
s_mov_b64 exec, 0
s_cmp_eq_u32 s24, 0
s_cbranch_scc1 mega_kernel_rs_iw0
s_cmp_eq_u32 s24, 1
s_cbranch_scc1 mega_kernel_rs_iw1
s_cmp_eq_u32 s24, 2
s_cbranch_scc1 mega_kernel_rs_iw2
s_branch mega_kernel_rs_iw3
mega_kernel_rs_iwd:
s_mov_b64 exec, -1
s_waitcnt vmcnt(17)
ds_read_b64_tr_b16 a[0:1], v46 offset:0
ds_read_b64_tr_b16 a[2:3], v46 offset:128
ds_read_b64_tr_b16 a[4:5], v46 offset:2048
ds_read_b64_tr_b16 a[6:7], v46 offset:2176
ds_read_b64_tr_b16 a[8:9], v46 offset:4096
ds_read_b64_tr_b16 a[10:11], v46 offset:4224
ds_read_b64_tr_b16 a[12:13], v46 offset:6144
ds_read_b64_tr_b16 a[14:15], v46 offset:6272
s_waitcnt lgkmcnt(0)
ds_read_b64_tr_b16 a[16:17], v46 offset:8192
ds_read_b64_tr_b16 a[18:19], v46 offset:8320
ds_read_b64_tr_b16 a[20:21], v46 offset:10240
ds_read_b64_tr_b16 a[22:23], v46 offset:10368
ds_read_b64_tr_b16 a[24:25], v46 offset:12288
ds_read_b64_tr_b16 a[26:27], v46 offset:12416
ds_read_b64_tr_b16 a[28:29], v46 offset:14336
ds_read_b64_tr_b16 a[30:31], v46 offset:14464
s_waitcnt lgkmcnt(0)
ds_read_b64_tr_b16 a[32:33], v46 offset:32
ds_read_b64_tr_b16 a[34:35], v46 offset:160
ds_read_b64_tr_b16 a[36:37], v46 offset:2080
ds_read_b64_tr_b16 a[38:39], v46 offset:2208
ds_read_b64_tr_b16 a[40:41], v46 offset:4128
ds_read_b64_tr_b16 a[42:43], v46 offset:4256
ds_read_b64_tr_b16 a[44:45], v46 offset:6176
ds_read_b64_tr_b16 a[46:47], v46 offset:6304
s_waitcnt lgkmcnt(0)
ds_read_b64_tr_b16 a[48:49], v46 offset:8224
ds_read_b64_tr_b16 a[50:51], v46 offset:8352
ds_read_b64_tr_b16 a[52:53], v46 offset:10272
ds_read_b64_tr_b16 a[54:55], v46 offset:10400
ds_read_b64_tr_b16 a[56:57], v46 offset:12320
ds_read_b64_tr_b16 a[58:59], v46 offset:12448
ds_read_b64_tr_b16 a[60:61], v46 offset:14368
ds_read_b64_tr_b16 a[62:63], v46 offset:14496
s_waitcnt lgkmcnt(0)
v_and_b32 v247, 15, v0
v_lshlrev_b32 v247, 4, v247
buffer_load_dword v246, v247, s[72:75], 0 offen sc1
buffer_load_dwordx4 v[64:67], v8, s[20:23], 0 offen offset:0
buffer_load_dwordx4 v[68:71], v8, s[20:23], 0 offen offset:128
buffer_load_dwordx4 v[72:75], v8, s[20:23], 0 offen offset:256
buffer_load_dwordx4 v[76:79], v8, s[20:23], 0 offen offset:384
s_waitcnt vmcnt(0)
ds_read_b64_tr_b16 a[192:193], v47 offset:16384
ds_read_b64_tr_b16 a[194:195], v47 offset:16512
ds_read_b64_tr_b16 a[196:197], v47 offset:18432
ds_read_b64_tr_b16 a[198:199], v47 offset:18560
ds_read_b64_tr_b16 a[200:201], v47 offset:20480
ds_read_b64_tr_b16 a[202:203], v47 offset:20608
ds_read_b64_tr_b16 a[204:205], v47 offset:22528
ds_read_b64_tr_b16 a[206:207], v47 offset:22656
s_waitcnt lgkmcnt(0)
ds_read_b64_tr_b16 a[208:209], v47 offset:24576
ds_read_b64_tr_b16 a[210:211], v47 offset:24704
ds_read_b64_tr_b16 a[212:213], v47 offset:26624
ds_read_b64_tr_b16 a[214:215], v47 offset:26752
ds_read_b64_tr_b16 a[216:217], v47 offset:28672
ds_read_b64_tr_b16 a[218:219], v47 offset:28800
ds_read_b64_tr_b16 a[220:221], v47 offset:30720
ds_read_b64_tr_b16 a[222:223], v47 offset:30848
s_waitcnt lgkmcnt(0)
ds_read_b64_tr_b16 a[224:225], v47 offset:16416
ds_read_b64_tr_b16 a[226:227], v47 offset:16544
ds_read_b64_tr_b16 a[228:229], v47 offset:18464
ds_read_b64_tr_b16 a[230:231], v47 offset:18592
ds_read_b64_tr_b16 a[232:233], v47 offset:20512
ds_read_b64_tr_b16 a[234:235], v47 offset:20640
ds_read_b64_tr_b16 a[236:237], v47 offset:22560
ds_read_b64_tr_b16 a[238:239], v47 offset:22688
s_waitcnt lgkmcnt(0)
ds_read_b64_tr_b16 a[240:241], v47 offset:24608
ds_read_b64_tr_b16 a[242:243], v47 offset:24736
ds_read_b64_tr_b16 a[244:245], v47 offset:26656
ds_read_b64_tr_b16 a[246:247], v47 offset:26784
ds_read_b64_tr_b16 a[248:249], v47 offset:28704
ds_read_b64_tr_b16 a[250:251], v47 offset:28832
ds_read_b64_tr_b16 a[252:253], v47 offset:30752
ds_read_b64_tr_b16 a[254:255], v47 offset:30880
s_waitcnt lgkmcnt(0)
v_mov_b32 v32, v64
v_mov_b32 v33, v65
v_mov_b32 v34, v66
v_mov_b32 v35, v67
v_mov_b32 v36, v68
v_mov_b32 v37, v69
v_mov_b32 v38, v70
v_mov_b32 v39, v71
v_mov_b32 v40, v72
v_mov_b32 v41, v73
v_mov_b32 v42, v74
v_mov_b32 v43, v75
v_mov_b32 v44, v76
v_mov_b32 v45, v77
v_mov_b32 v46, v78
v_mov_b32 v47, v79
v_mov_b32 v96, 0
v_mov_b32 v97, 0
v_mov_b32 v98, 0
v_mov_b32 v99, 0
v_mov_b32 v100, 0
v_mov_b32 v101, 0
v_mov_b32 v102, 0
v_mov_b32 v103, 0
v_mov_b32 v104, 0
v_mov_b32 v105, 0
v_mov_b32 v106, 0
v_mov_b32 v107, 0
v_mov_b32 v108, 0
v_mov_b32 v109, 0
v_mov_b32 v110, 0
v_mov_b32 v111, 0
v_mov_b32 v112, 0
v_mov_b32 v113, 0
v_mov_b32 v114, 0
v_mov_b32 v115, 0
v_mov_b32 v116, 0
v_mov_b32 v117, 0
v_mov_b32 v118, 0
v_mov_b32 v119, 0
s_nop 1
v_smfmac_f32_16x16x64_bf16 v[96:99], v[32:35], a[0:7], v6
v_smfmac_f32_16x16x64_bf16 v[100:103], v[32:35], a[32:39], v6
v_smfmac_f32_16x16x64_bf16 v[104:107], v[32:35], a[64:71], v6
v_smfmac_f32_16x16x64_bf16 v[108:111], v[32:35], a[96:103], v6
v_smfmac_f32_16x16x64_bf16 v[96:99], v[36:39], a[8:15], v6
v_smfmac_f32_16x16x64_bf16 v[100:103], v[36:39], a[40:47], v6
v_smfmac_f32_16x16x64_bf16 v[104:107], v[36:39], a[72:79], v6
v_smfmac_f32_16x16x64_bf16 v[108:111], v[36:39], a[104:111], v6
v_smfmac_f32_16x16x64_bf16 v[96:99], v[40:43], a[16:23], v6
v_smfmac_f32_16x16x64_bf16 v[100:103], v[40:43], a[48:55], v6
v_smfmac_f32_16x16x64_bf16 v[104:107], v[40:43], a[80:87], v6
v_smfmac_f32_16x16x64_bf16 v[108:111], v[40:43], a[112:119], v6
v_smfmac_f32_16x16x64_bf16 v[96:99], v[44:47], a[24:31], v6
v_smfmac_f32_16x16x64_bf16 v[100:103], v[44:47], a[56:63], v6
v_smfmac_f32_16x16x64_bf16 v[104:107], v[44:47], a[88:95], v6
v_smfmac_f32_16x16x64_bf16 v[108:111], v[44:47], a[120:127], v6
v_and_b32 v247, 15, v0
v_lshlrev_b32 v247, 4, v247
s_branch mega_kernel_sysp
mega_kernel_sysw:
s_sleep 4
mega_kernel_sys:
buffer_load_dword v246, v247, s[72:75], 0 offen sc1
s_waitcnt vmcnt(0)
mega_kernel_sysp:
s_cmp_eq_u32 s95, 1
s_cbranch_scc0 mega_kernel_sysf
v_readlane_b32 s76, v246, 14
s_mov_b32 s98, 0
s_cmp_eq_u32 s76, 32
s_cbranch_scc0 mega_kernel_sysw
s_branch mega_kernel_sysd
mega_kernel_sysf:
s_mov_b32 s77, 0
s_mov_b32 s78, 0
v_readlane_b32 s76, v246, 0
s_add_u32 s77, s77, s76
s_xor_b32 s76, s76, 32
s_or_b32 s78, s78, s76
v_readlane_b32 s76, v246, 1
s_add_u32 s77, s77, s76
s_xor_b32 s76, s76, 32
s_or_b32 s78, s78, s76
v_readlane_b32 s76, v246, 2
s_add_u32 s77, s77, s76
s_xor_b32 s76, s76, 32
s_or_b32 s78, s78, s76
v_readlane_b32 s76, v246, 3
s_add_u32 s77, s77, s76
s_xor_b32 s76, s76, 32
s_or_b32 s78, s78, s76
v_readlane_b32 s76, v246, 4
s_add_u32 s77, s77, s76
s_xor_b32 s76, s76, 32
s_or_b32 s78, s78, s76
v_readlane_b32 s76, v246, 5
s_add_u32 s77, s77, s76
s_xor_b32 s76, s76, 32
s_or_b32 s78, s78, s76
v_readlane_b32 s76, v246, 6
s_add_u32 s77, s77, s76
s_xor_b32 s76, s76, 32
s_or_b32 s78, s78, s76
v_readlane_b32 s76, v246, 7
s_add_u32 s77, s77, s76
s_xor_b32 s76, s76, 32
s_or_b32 s78, s78, s76
s_cmp_eq_u32 s77, 256
s_cbranch_scc0 mega_kernel_sysw
v_mov_b32 v252, v246
s_cmp_eq_u32 s78, 0
s_cbranch_scc0 mega_kernel_slowent
v_readlane_b32 s76, v246, 10
v_readlane_b32 s77, v246, 8
s_cmp_eq_u32 s76, 32
s_cbranch_scc0 mega_kernel_sysw
s_cmp_gt_u32 s77, 16
s_cselect_b32 s98, 1, 0
mega_kernel_sysd:
s_lshr_b32 s28, s31, 4
s_lshl_b32 s28, s28, 14
s_lshl_b32 s29, s98, 13
s_add_u32 s28, s28, s29
s_and_b32 s29, s31, 15
s_lshl_b32 s29, s29, 9
s_add_u32 s28, s28, s29
s_lshl_b32 s29, s30, 16
s_add_u32 s28, s28, s29
s_add_u32 s28, s28, 67108864
v_lshrrev_b32 v12, 1, v17
v_add_u32 v12, s28, v12
v_xor_b32 v25, 0x10000, v12
v_xor_b32 v26, 0x20000, v12
v_xor_b32 v27, 0x30000, v12
v_add_u32 v25, 0, v25
v_add_u32 v26, 0, v26
v_add_u32 v27, 0, v27
s_lshl_b32 s28, s25, 2
s_add_u32 s28, s28, s26
s_mov_b32 s82, s28
s_lshr_b32 s29, s28, 3
s_xor_b32 s29, s29, s98
s_and_b32 s29, s29, 1
s_lshl_b32 s29, s29, 13
s_lshl_b32 s76, s28, 18
s_add_u32 s76, s76, s29
s_mov_b32 s83, s76
v_add_u32 v240, s76, v17
v_add_u32 v241, 33554432, v240
s_lshr_b32 s29, s28, 4
s_xor_b32 s29, s29, s98
s_and_b32 s29, s29, 1
s_lshl_b32 s29, s29, 13
s_lshl_b32 s79, s28, 17
s_add_u32 s79, s79, s29
s_add_u32 s79, s79, 71303168
s_xor_b32 s29, s98, 1
s_lshl_b32 s29, s29, 13
s_lshl_b32 s28, s25, 7
s_add_u32 s28, s28, s29
s_add_u32 s28, s28, 69206016
v_and_b32 v4, 1, v1
v_lshlrev_b32 v24, 12, v4
v_add_u32 v24, s28, v24
s_lshl_b32 s29, s26, 2
v_add_u32 v24, s29, v24
s_xor_b32 s81, s98, 1
s_lshl_b32 s81, s81, 13
s_lshr_b32 s29, s82, 6
s_lshl_b32 s29, s29, 14
s_add_u32 s81, s81, s29
s_and_b32 s29, s82, 63
s_lshl_b32 s29, s29, 7
s_add_u32 s81, s81, s29
s_add_u32 s81, s81, 69222400
v_mov_b32 v220, 0x3f803f80
v_mov_b32 v221, 0x3f803f80
v_mov_b32 v222, 0x3f803f80
v_mov_b32 v223, 0x3f803f80
v_mov_b32 v228, 0
s_mov_b32 s27, 0
s_mov_b32 s46, 0
s_mov_b32 s89, 0
s_mov_b32 s88, 0
s_mov_b32 s44, 18432
s_mov_b32 s45, 18432
s_cmp_eq_u32 s24, 3
s_cbranch_scc0 mega_kernel_rs_pfi
s_mov_b32 s76, 0
s_cmp_gt_i32 s46, s76
s_cbranch_scc1 mega_kernel_rs_pf0ok
mega_kernel_rs_pf0w:
v_mov_b32 v4, 0
s_mov_b64 exec, 3
buffer_atomic_add v4, v24, s[84:87], 0 offen sc0 sc1
s_mov_b64 exec, -1
s_waitcnt vmcnt(0)
v_readlane_b32 s46, v4, 0
v_readlane_b32 s28, v4, 1
s_nop 1
s_min_i32 s46, s46, s28
s_cmp_gt_i32 s46, s76
s_cbranch_scc0 mega_kernel_rs_pf0w
mega_kernel_rs_pf0ok:
s_add_u32 s77, s76, s82
s_bfe_u32 s28, s77, 0x40002
s_lshl_b32 s28, s28, 14
s_and_b32 s77, s77, 3
s_lshl_b32 s77, s77, 11
s_add_u32 s28, s28, s77
s_add_u32 m0, s45, 0
s_nop 0
buffer_load_dwordx4 v240, s[84:87], s28 offen offset:0 sc1 lds
s_add_u32 m0, s45, 0
s_nop 0
buffer_load_dwordx4 v240, s[84:87], s28 offen offset:1024 sc1 lds
s_add_u32 m0, s45, 2048
s_nop 0
buffer_load_dwordx4 v241, s[84:87], s28 offen offset:0 sc1 lds
s_add_u32 m0, s45, 2048
s_nop 0
buffer_load_dwordx4 v241, s[84:87], s28 offen offset:1024 sc1 lds
s_add_u32 s45, s45, 4096
s_cmp_eq_u32 s45, 30720
s_cselect_b32 s45, 18432, s45
s_waitcnt vmcnt(0) lgkmcnt(0)
mega_kernel_rs_pfi:
v_mov_b32 v184, 0
v_mov_b32 v185, 0
v_mov_b32 v186, 0
v_mov_b32 v187, 0
v_mov_b32 v188, 0
v_mov_b32 v189, 0
v_mov_b32 v190, 0
v_mov_b32 v191, 0
v_mov_b32 v192, 0
v_mov_b32 v193, 0
v_mov_b32 v194, 0
v_mov_b32 v195, 0
v_mov_b32 v196, 0
v_mov_b32 v197, 0
v_mov_b32 v198, 0
v_mov_b32 v199, 0
v_mov_b32 v200, 0
v_mov_b32 v201, 0
v_mov_b32 v202, 0
v_mov_b32 v203, 0
v_mov_b32 v204, 0
v_mov_b32 v205, 0
v_mov_b32 v206, 0
v_mov_b32 v207, 0
v_mov_b32 v249, 0
s_barrier
s_and_b32 s29, s27, 1
s_lshl_b32 s33, s29, 17
s_lshl_b32 s28, s30, 18
s_add_u32 s33, s33, s28
s_add_u32 s33, s33, 68157440
s_xor_b32 s34, s33, 131072
s_lshl_b32 s35, s29, 18
s_bfe_u32 s47, s27, 0x10001
s_branch mega_kernel_rs_first
.p2align 6
s_nop 0
s_nop 0
mega_kernel_rs_loop:
buffer_load_dwordx4 v[32:35], v7, s[84:87], s33 offen offset:0 sc1
v_add_u32 v5, s44, v17
ds_read_b128 v[156:159], v5 offset:0
ds_read_b128 v[160:163], v5 offset:1024
ds_read_b128 v[164:167], v5 offset:2048
ds_read_b128 v[168:171], v5 offset:3072
s_nop 4
buffer_load_dwordx4 v[36:39], v7, s[84:87], s33 offen offset:1024 sc1
s_nop 9
buffer_load_dwordx4 v[40:43], v7, s[84:87], s33 offen offset:2048 sc1
s_nop 9
buffer_load_dwordx4 v[44:47], v7, s[84:87], s33 offen offset:3072 sc1
s_waitcnt vmcnt(3)
v_max_u32 v4, v32, v34
v_cmp_eq_u32 vcc, -1, v4
s_cbranch_vccnz mega_kernel_rs_pa_15_0f
v_smfmac_f32_16x16x64_bf16 v[96:99], v[32:35], a[0:7], v6
v_smfmac_f32_16x16x64_bf16 v[100:103], v[32:35], a[32:39], v6
v_smfmac_f32_16x16x64_bf16 v[104:107], v[32:35], a[64:71], v6
s_waitcnt vmcnt(2)
v_max_u32 v4, v36, v38
v_cmp_eq_u32 vcc, -1, v4
v_smfmac_f32_16x16x64_bf16 v[108:111], v[32:35], a[96:103], v6
s_cbranch_vccnz mega_kernel_rs_pa_14_1f
v_smfmac_f32_16x16x64_bf16 v[96:99], v[36:39], a[8:15], v6
v_smfmac_f32_16x16x64_bf16 v[100:103], v[36:39], a[40:47], v6
v_smfmac_f32_16x16x64_bf16 v[104:107], v[36:39], a[72:79], v6
s_waitcnt vmcnt(1)
v_max_u32 v4, v40, v42
v_cmp_eq_u32 vcc, -1, v4
v_smfmac_f32_16x16x64_bf16 v[108:111], v[36:39], a[104:111], v6
s_cbranch_vccnz mega_kernel_rs_pa_12_2f
v_smfmac_f32_16x16x64_bf16 v[96:99], v[40:43], a[16:23], v6
v_smfmac_f32_16x16x64_bf16 v[100:103], v[40:43], a[48:55], v6
v_smfmac_f32_16x16x64_bf16 v[104:107], v[40:43], a[80:87], v6
s_waitcnt vmcnt(0)
v_max_u32 v4, v44, v46
v_cmp_eq_u32 vcc, -1, v4
v_smfmac_f32_16x16x64_bf16 v[108:111], v[40:43], a[112:119], v6
s_cbranch_vccnz mega_kernel_rs_pa_8_3f
v_smfmac_f32_16x16x64_bf16 v[96:99], v[44:47], a[24:31], v6
v_smfmac_f32_16x16x64_bf16 v[100:103], v[44:47], a[56:63], v6
v_smfmac_f32_16x16x64_bf16 v[104:107], v[44:47], a[88:95], v6
v_smfmac_f32_16x16x64_bf16 v[108:111], v[44:47], a[120:127], v6
mega_kernel_rs_pa_d:
mega_kernel_rs_adone:
s_nop 5
v_permlane32_swap_b32 v96, v100
v_permlane32_swap_b32 v97, v101
v_permlane32_swap_b32 v98, v102
v_permlane32_swap_b32 v99, v103
v_pk_add_f32 v[96:97], v[96:97], v[100:101]
v_pk_add_f32 v[98:99], v[98:99], v[102:103]
ds_write2_b32 v14, v96, v97 offset0:0 offset1:36
ds_write2_b32 v14, v98, v99 offset0:72 offset1:108
v_permlane32_swap_b32 v104, v108
v_permlane32_swap_b32 v105, v109
v_permlane32_swap_b32 v106, v110
v_permlane32_swap_b32 v107, v111
v_pk_add_f32 v[104:105], v[104:105], v[108:109]
v_pk_add_f32 v[106:107], v[106:107], v[110:111]
ds_write2_b32 v15, v104, v105 offset0:0 offset1:36
ds_write2_b32 v15, v106, v107 offset0:72 offset1:108
v_smfmac_f32_16x16x64_bf16 v[112:115], v[32:35], a[128:135], v6
v_smfmac_f32_16x16x64_bf16 v[116:119], v[32:35], a[160:167], v6
v_smfmac_f32_16x16x64_bf16 v[112:115], v[36:39], a[136:143], v6
v_smfmac_f32_16x16x64_bf16 v[116:119], v[36:39], a[168:175], v6
s_waitcnt lgkmcnt(0)
s_barrier
s_cmp_lg_u32 s24, 0
s_cbranch_scc1 mega_kernel_rs_side
ds_read_b128 v[120:123], v16 offset:0
ds_read_b128 v[124:127], v16 offset:16
ds_read_b128 v[128:131], v16 offset:2304
ds_read_b128 v[132:135], v16 offset:2320
ds_read_b128 v[136:139], v16 offset:4608
ds_read_b128 v[140:143], v16 offset:4624
ds_read_b128 v[144:147], v16 offset:6912
ds_read_b128 v[148:151], v16 offset:6928
v_smfmac_f32_16x16x64_bf16 v[112:115], v[40:43], a[144:151], v6
v_smfmac_f32_16x16x64_bf16 v[116:119], v[40:43], a[176:183], v6
v_smfmac_f32_16x16x64_bf16 v[112:115], v[44:47], a[152:159], v6
v_smfmac_f32_16x16x64_bf16 v[116:119], v[44:47], a[184:191], v6
s_mul_i32 s28, s31, 2048
s_add_u32 s28, s28, s33
s_add_u32 s28, s28, 49152
s_add_u32 s76, s37, s33
s_add_u32 s77, s38, s33
s_add_u32 s78, s39, s33
s_waitcnt lgkmcnt(4)
v_pk_add_f32 v[120:121], v[120:121], v[128:129]
v_pk_add_f32 v[122:123], v[122:123], v[130:131]
v_pk_add_f32 v[124:125], v[124:125], v[132:133]
v_pk_add_f32 v[126:127], v[126:127], v[134:135]
s_waitcnt lgkmcnt(0)
v_pk_add_f32 v[136:137], v[136:137], v[144:145]
v_pk_add_f32 v[138:139], v[138:139], v[146:147]
v_pk_add_f32 v[140:141], v[140:141], v[148:149]
v_pk_add_f32 v[142:143], v[142:143], v[150:151]
v_pk_add_f32 v[120:121], v[120:121], v[136:137]
v_pk_add_f32 v[122:123], v[122:123], v[138:139]
v_pk_add_f32 v[124:125], v[124:125], v[140:141]
v_pk_add_f32 v[126:127], v[126:127], v[142:143]
v_cvt_pk_bf16_f32 v152, v120, v121
v_cvt_pk_bf16_f32 v153, v122, v123
v_cvt_pk_bf16_f32 v154, v124, v125
v_cvt_pk_bf16_f32 v155, v126, v127
s_nop 1
v_mfma_f32_16x16x32_bf16 v[176:179], v[160:163], v[152:155], 0
v_mfma_f32_16x16x32_bf16 v[172:175], v[156:159], v[152:155], 0
v_mfma_f32_16x16x32_bf16 v[180:183], v[152:155], v[152:155], 0
s_cmp_eq_u32 s27, 63
s_cbranch_scc1 mega_kernel_rs_w0last
s_nop 4
v_mov_b32_dpp v172, v176 row_shr:8 row_mask:0xf bank_mask:0xc
v_mov_b32_dpp v173, v177 row_shr:8 row_mask:0xf bank_mask:0xc
v_mov_b32_dpp v174, v178 row_shr:8 row_mask:0xf bank_mask:0xc
v_mov_b32_dpp v175, v179 row_shr:8 row_mask:0xf bank_mask:0xc
v_min_u32 v180, -2, v180
v_min_u32 v172, -2, v172
s_mov_b64 exec, s[42:43]
buffer_store_dwordx4 v[180:183], v10, s[84:87], s28 offen sc1
s_mov_b64 exec, -1
buffer_store_dwordx4 v[172:175], v17, s[84:87], s28 offen sc1
v_permlane32_swap_b32 v112, v116
v_permlane32_swap_b32 v113, v117
v_permlane32_swap_b32 v114, v118
v_permlane32_swap_b32 v115, v119
v_pk_add_f32 v[112:113], v[112:113], v[116:117]
v_pk_add_f32 v[114:115], v[114:115], v[118:119]
ds_write_b128 v20, v[112:115]
s_waitcnt lgkmcnt(0)
s_barrier
v_mov_b32 v96, 0
v_mov_b32 v97, 0
v_mov_b32 v98, 0
v_mov_b32 v99, 0
v_mov_b32 v100, 0
v_mov_b32 v101, 0
v_mov_b32 v102, 0
v_mov_b32 v103, 0
v_cndmask_b32 v176, v23, v180, s[42:43]
v_cndmask_b32 v177, v23, v181, s[42:43]
v_cndmask_b32 v178, v23, v182, s[42:43]
v_cndmask_b32 v179, v23, v183, s[42:43]
s_mov_b64 exec, s[42:43]
buffer_load_dwordx4 v[188:191], v10, s[84:87], s76 offen sc1
buffer_load_dwordx4 v[196:199], v10, s[84:87], s77 offen sc1
buffer_load_dwordx4 v[204:207], v10, s[84:87], s78 offen sc1
s_mov_b64 exec, -1
buffer_load_dwordx4 v[184:187], v17, s[84:87], s76 offen sc1
buffer_load_dwordx4 v[192:195], v17, s[84:87], s77 offen sc1
buffer_load_dwordx4 v[200:203], v17, s[84:87], s78 offen sc1
v_pk_mul_f32 v[172:173], v[172:173], s[32:33] op_sel_hi:[1,0]
v_pk_mul_f32 v[174:175], v[174:175], s[32:33] op_sel_hi:[1,0]
v_pk_mul_f32 v[176:177], v[176:177], s[32:33] op_sel_hi:[1,0]
v_pk_mul_f32 v[178:179], v[178:179], s[32:33] op_sel_hi:[1,0]
s_lshl_b32 s89, s47, 31
s_or_b32 s89, s89, 0x3b39999a
s_nop 15
s_nop 1
s_mov_b64 exec, s[42:43]
buffer_load_dwordx4 v[188:191], v10, s[84:87], s76 offen sc1
buffer_load_dwordx4 v[196:199], v10, s[84:87], s77 offen sc1
buffer_load_dwordx4 v[204:207], v10, s[84:87], s78 offen sc1
s_mov_b64 exec, -1
buffer_load_dwordx4 v[184:187], v17, s[84:87], s76 offen sc1
buffer_load_dwordx4 v[192:195], v17, s[84:87], s77 offen sc1
buffer_load_dwordx4 v[200:203], v17, s[84:87], s78 offen sc1
mega_kernel_rs_p2:
s_waitcnt vmcnt(6)
v_max3_u32 v4, v184, v188, v192
v_max3_u32 v5, v196, v200, v204
v_max_u32 v4, v4, v5
v_cmp_eq_u32 vcc, -1, v4
s_cbranch_vccnz mega_kernel_rs_p2r
v_pk_add_f32 v[124:125], v[196:197], v[204:205]
v_pk_add_f32 v[126:127], v[198:199], v[206:207]
v_pk_add_f32 v[120:121], v[192:193], v[200:201]
v_pk_add_f32 v[122:123], v[194:195], v[202:203]
v_pk_add_f32 v[124:125], v[124:125], v[188:189]
v_pk_add_f32 v[126:127], v[126:127], v[190:191]
v_pk_add_f32 v[120:121], v[120:121], v[184:185]
v_pk_add_f32 v[122:123], v[122:123], v[186:187]
v_pk_fma_f32 v[176:177], v[124:125], s[32:33], v[176:177] op_sel_hi:[1,0,1]
v_pk_fma_f32 v[178:179], v[126:127], s[32:33], v[178:179] op_sel_hi:[1,0,1]
v_pk_fma_f32 v[172:173], v[120:121], s[32:33], v[172:173] op_sel_hi:[1,0,1]
v_pk_fma_f32 v[174:175], v[122:123], s[32:33], v[174:175] op_sel_hi:[1,0,1]
v_max3_f32 v232, v172, v173, v174
v_max3_f32 v233, v176, v177, v178
v_max3_f32 v232, v232, v175, v179
v_max_f32 v234, v232, v233
s_barrier
ds_read2_b64 v[208:211], v21 offset0:0 offset1:32
v_max_f32_dpp v232, v234, v234 row_ror:8 row_mask:0xf bank_mask:0xf
v_max_f32_dpp v233, v234, v234 row_ror:8 row_mask:0xf bank_mask:0xf
s_nop 1
v_permlane16_swap_b32 v232, v233
s_nop 0
v_max_f32 v234, v232, v233
v_max_f32 v235, v232, v233
s_nop 1
v_permlane32_swap_b32 v234, v235
s_nop 0
v_max_f32 v232, v234, v235
v_pk_add_f32 v[176:177], v[176:177], v[232:233] op_sel_hi:[1,0] neg_lo:[0,1] neg_hi:[0,1]
v_pk_add_f32 v[178:179], v[178:179], v[232:233] op_sel_hi:[1,0] neg_lo:[0,1] neg_hi:[0,1]
v_pk_add_f32 v[172:173], v[172:173], v[232:233] op_sel_hi:[1,0] neg_lo:[0,1] neg_hi:[0,1]
v_pk_add_f32 v[174:175], v[174:175], v[232:233] op_sel_hi:[1,0] neg_lo:[0,1] neg_hi:[0,1]
v_exp_f32 v176, v176
v_exp_f32 v177, v177
v_exp_f32 v178, v178
v_exp_f32 v179, v179
v_exp_f32 v172, v172
v_cvt_pk_bf16_f32 v216, v176, v177
v_cvt_pk_bf16_f32 v217, v178, v179
v_exp_f32 v173, v173
v_exp_f32 v174, v174
v_mfma_f32_16x16x16_bf16 v[224:227], v[220:221], v[216:217], 0
v_exp_f32 v175, v175
v_cvt_pk_bf16_f32 v212, v172, v173
s_waitcnt lgkmcnt(0)
v_mfma_f32_16x16x16_bf16 v[120:123], v[208:209], v[216:217], 0
v_cvt_pk_bf16_f32 v213, v174, v175
v_mfma_f32_16x16x16_bf16 v[124:127], v[210:211], v[216:217], 0
v_mov_b32_dpp v214, v212 row_ror:8 row_mask:0xf bank_mask:0xf
v_mov_b32_dpp v215, v213 row_ror:8 row_mask:0xf bank_mask:0xf
s_nop 1
v_mfma_f32_16x16x32_bf16 v[224:227], v[220:223], v[212:215], v[224:227]
v_mfma_f32_16x16x32_bf16 v[120:123], v[164:167], v[212:215], v[120:123]
v_mfma_f32_16x16x32_bf16 v[124:127], v[168:171], v[212:215], v[124:127]
s_add_u32 s29, s33, 24576
s_nop 4
v_rcp_f32 v234, v224
s_nop 0
v_pk_mul_f32 v[120:121], v[120:121], v[234:235] op_sel_hi:[1,0]
v_pk_mul_f32 v[122:123], v[122:123], v[234:235] op_sel_hi:[1,0]
v_pk_mul_f32 v[124:125], v[124:125], v[234:235] op_sel_hi:[1,0]
v_pk_mul_f32 v[126:127], v[126:127], v[234:235] op_sel_hi:[1,0]
v_cvt_pk_bf16_f32 v212, v120, v121
v_cvt_pk_bf16_f32 v213, v122, v123
v_cvt_pk_bf16_f32 v214, v124, v125
v_cvt_pk_bf16_f32 v215, v126, v127
v_min_u32 v212, -2, v212
s_mov_b64 exec, s[40:41]
buffer_store_dwordx4 v[212:215], v11, s[84:87], s33 offen sc1
s_mov_b64 exec, -1
mega_kernel_rs_b3:
s_barrier
s_nop 15
buffer_load_dwordx4 v[32:35], v7, s[84:87], s29 offen offset:0 sc1
s_nop 9
buffer_load_dwordx4 v[36:39], v7, s[84:87], s29 offen offset:1024 sc1
s_nop 9
buffer_load_dwordx4 v[40:43], v7, s[84:87], s29 offen offset:2048 sc1
s_nop 9
buffer_load_dwordx4 v[44:47], v7, s[84:87], s29 offen offset:3072 sc1
mega_kernel_rs_pc_15_0:
s_waitcnt vmcnt(3)
v_cmp_eq_u32 vcc, -1, v32
s_cbranch_vccnz mega_kernel_rs_pc_15_0f
v_smfmac_f32_16x16x64_bf16 v[96:99], v[32:35], a[192:199], v6
v_smfmac_f32_16x16x64_bf16 v[100:103], v[32:35], a[224:231], v6
mega_kernel_rs_pc_14_1:
s_waitcnt vmcnt(2)
v_cmp_eq_u32 vcc, -1, v36
s_cbranch_vccnz mega_kernel_rs_pc_14_1f
v_smfmac_f32_16x16x64_bf16 v[96:99], v[36:39], a[200:207], v6
v_smfmac_f32_16x16x64_bf16 v[100:103], v[36:39], a[232:239], v6
mega_kernel_rs_pc_12_2:
s_waitcnt vmcnt(1)
v_cmp_eq_u32 vcc, -1, v40
s_cbranch_vccnz mega_kernel_rs_pc_12_2f
v_smfmac_f32_16x16x64_bf16 v[96:99], v[40:43], a[208:215], v6
v_smfmac_f32_16x16x64_bf16 v[100:103], v[40:43], a[240:247], v6
mega_kernel_rs_pc_8_3:
s_waitcnt vmcnt(0)
v_cmp_eq_u32 vcc, -1, v44
s_cbranch_vccnz mega_kernel_rs_pc_8_3f
v_smfmac_f32_16x16x64_bf16 v[96:99], v[44:47], a[216:223], v6
v_smfmac_f32_16x16x64_bf16 v[100:103], v[44:47], a[248:255], v6
mega_kernel_rs_pc_d:
s_nop 7
v_permlane32_swap_b32 v96, v100
v_permlane32_swap_b32 v97, v101
v_permlane32_swap_b32 v98, v102
v_permlane32_swap_b32 v99, v103
v_pk_add_f32 v[96:97], v[96:97], v[100:101]
v_pk_add_f32 v[98:99], v[98:99], v[102:103]
ds_write2_b32 v18, v96, v97 offset0:0 offset1:36
ds_write2_b32 v18, v98, v99 offset0:72 offset1:108
s_waitcnt lgkmcnt(0)
s_barrier
s_cmp_lg_u32 s24, 0
s_cbranch_scc1 mega_kernel_rs_x1
ds_read_b128 v[120:123], v19 offset:0
ds_read_b128 v[124:127], v19 offset:1152
ds_read_b128 v[128:131], v19 offset:2304
ds_read_b128 v[132:135], v19 offset:3456
s_waitcnt lgkmcnt(2)
v_pk_add_f32 v[120:121], v[120:121], v[124:125]
v_pk_add_f32 v[122:123], v[122:123], v[126:127]
s_waitcnt lgkmcnt(0)
v_pk_add_f32 v[128:129], v[128:129], v[132:133]
v_pk_add_f32 v[130:131], v[130:131], v[134:135]
v_pk_add_f32 v[120:121], v[120:121], v[128:129]
v_pk_add_f32 v[122:123], v[122:123], v[130:131]
v_fma_f32 v212, v120, s89, v120
v_cvt_pk_bf16_f32 v213, v122, v123
v_cvt_pk_bf16_f32 v212, v212, v121
v_and_or_b32 v212, v212, -2, s47
buffer_store_dwordx2 v[212:213], v12, s[84:87], s35 offen sc1
s_mov_b32 s77, 0x3f80
s_mov_b32 s78, 0x3f800000
s_xor_b32 s76, s47, 1
v_mov_b32 v48, s76
v_mov_b32 v50, s76
v_mov_b32 v52, s76
s_nop 8
v_mov_b32 v96, 0
v_mov_b32 v97, 0
v_mov_b32 v98, 0
v_mov_b32 v99, 0
v_mov_b32 v100, 0
v_mov_b32 v101, 0
v_mov_b32 v102, 0
v_mov_b32 v103, 0
v_mov_b32 v104, 0
v_mov_b32 v105, 0
v_mov_b32 v106, 0
v_mov_b32 v107, 0
v_mov_b32 v108, 0
v_mov_b32 v109, 0
v_mov_b32 v110, 0
v_mov_b32 v111, 0
v_mov_b32 v112, 0
v_mov_b32 v113, 0
v_mov_b32 v114, 0
v_mov_b32 v115, 0
v_mov_b32 v116, 0
v_mov_b32 v117, 0
v_mov_b32 v118, 0
v_mov_b32 v119, 0
s_nop 15
s_nop 7
s_cmp_eq_u32 s47, 1
s_cbranch_scc1 mega_kernel_rs_p4_1
.p2align 6
mega_kernel_rs_p4_0:
buffer_load_dwordx2 v[48:49], v25, s[84:87], s35 offen sc1
buffer_load_dwordx2 v[50:51], v26, s[84:87], s35 offen sc1
buffer_load_dwordx2 v[52:53], v27, s[84:87], s35 offen sc1
s_waitcnt vmcnt(12)
mega_kernel_rs_p4c_0:
v_bitop3_b32 v4, v48, v50, v52 bitop3:0xfe
v_and_b32 v4, 1, v4
v_cmp_ne_u32 vcc, 0, v4
s_cbranch_vccnz mega_kernel_rs_p4_0
v_dot2_f32_bf16 v120, v48, s77, v120
v_dot2_f32_bf16 v121, v48, s78, v121
v_dot2_f32_bf16 v122, v49, s77, v122
v_dot2_f32_bf16 v123, v49, s78, v123
v_dot2_f32_bf16 v120, v50, s77, v120
v_dot2_f32_bf16 v121, v50, s78, v121
v_dot2_f32_bf16 v122, v51, s77, v122
v_dot2_f32_bf16 v123, v51, s78, v123
v_dot2_f32_bf16 v120, v52, s77, v120
v_dot2_f32_bf16 v121, v52, s78, v121
v_dot2_f32_bf16 v122, v53, s77, v122
v_dot2_f32_bf16 v123, v53, s78, v123
s_nop 0
v_cvt_pk_bf16_f32 v212, v120, v121
v_min_u32 v212, -2, v212
v_cvt_pk_bf16_f32 v213, v122, v123
buffer_store_dwordx2 v[212:213], v9, s[84:87], s34 offen sc1
s_branch mega_kernel_rs_p4d
mega_kernel_rs_iw0:
mega_kernel_rs_il0:
s_cbranch_execz mega_kernel_rs_il1
.p2align 6
mega_kernel_rs_p4_1:
buffer_load_dwordx2 v[48:49], v25, s[84:87], s35 offen sc1
buffer_load_dwordx2 v[50:51], v26, s[84:87], s35 offen sc1
buffer_load_dwordx2 v[52:53], v27, s[84:87], s35 offen sc1
s_waitcnt vmcnt(12)
mega_kernel_rs_p4c_1:
v_bitop3_b32 v4, v48, v50, v52 bitop3:0x80
v_and_b32 v4, 1, v4
v_cmp_ne_u32 vcc, 1, v4
s_cbranch_vccnz mega_kernel_rs_p4_1
v_dot2_f32_bf16 v120, v48, s77, v120
v_dot2_f32_bf16 v121, v48, s78, v121
v_dot2_f32_bf16 v122, v49, s77, v122
v_dot2_f32_bf16 v123, v49, s78, v123
v_dot2_f32_bf16 v120, v50, s77, v120
v_dot2_f32_bf16 v121, v50, s78, v121
v_dot2_f32_bf16 v122, v51, s77, v122
v_dot2_f32_bf16 v123, v51, s78, v123
v_dot2_f32_bf16 v120, v52, s77, v120
v_dot2_f32_bf16 v121, v52, s78, v121
v_dot2_f32_bf16 v122, v53, s77, v122
v_dot2_f32_bf16 v123, v53, s78, v123
s_nop 0
v_cvt_pk_bf16_f32 v212, v120, v121
v_min_u32 v212, -2, v212
v_cvt_pk_bf16_f32 v213, v122, v123
buffer_store_dwordx2 v[212:213], v9, s[84:87], s34 offen sc1
mega_kernel_rs_p4d:
mega_kernel_rs_b5:
s_add_u32 s27, s27, 1
s_add_u32 s44, s44, 4096
s_cmp_eq_u32 s44, 30720
s_cselect_b32 s44, 18432, s44
s_mov_b32 s28, s33
s_mov_b32 s33, s34
s_mov_b32 s34, s28
s_xor_b32 s35, s35, 262144
s_bfe_u32 s47, s27, 0x10001
s_barrier
s_nop 15
s_branch mega_kernel_rs_loop
mega_kernel_rs_il1:
s_cbranch_execz mega_kernel_rs_il2
mega_kernel_rs_x1:
s_cmp_eq_u32 s24, 1
s_cbranch_scc0 mega_kernel_rs_x2
s_add_u32 s76, s27, 1
v_mov_b32 v5, s76
s_mov_b64 exec, 1
buffer_store_dword v5, v228, s[84:87], s81 offen sc1
s_mov_b64 exec, -1
mega_kernel_rs_x2:
s_cmp_eq_u32 s24, 3
s_cbranch_scc0 mega_kernel_rs_x4
s_cmp_eq_u32 s36, 1
s_cbranch_scc0 mega_kernel_rs_x5
s_add_u32 s76, s27, 1
s_cmp_gt_i32 s46, s76
s_cbranch_scc1 mega_kernel_rs_pf1ok
mega_kernel_rs_pf1w:
v_mov_b32 v4, 0
s_mov_b64 exec, 3
buffer_atomic_add v4, v24, s[84:87], 0 offen sc0 sc1
s_mov_b64 exec, -1
s_waitcnt vmcnt(0)
v_readlane_b32 s46, v4, 0
v_readlane_b32 s28, v4, 1
s_nop 1
s_min_i32 s46, s46, s28
s_cmp_gt_i32 s46, s76
s_cbranch_scc0 mega_kernel_rs_pf1w
mega_kernel_rs_pf1ok:
s_add_u32 s77, s76, s82
s_bfe_u32 s28, s77, 0x40002
s_lshl_b32 s28, s28, 14
s_and_b32 s77, s77, 3
s_lshl_b32 s77, s77, 11
s_add_u32 s28, s28, s77
s_add_u32 m0, s45, 0
s_nop 0
buffer_load_dwordx4 v240, s[84:87], s28 offen offset:0 sc1 lds
s_add_u32 m0, s45, 0
s_nop 0
buffer_load_dwordx4 v240, s[84:87], s28 offen offset:1024 sc1 lds
s_add_u32 m0, s45, 2048
s_nop 0
buffer_load_dwordx4 v241, s[84:87], s28 offen offset:0 sc1 lds
s_add_u32 m0, s45, 2048
s_nop 0
buffer_load_dwordx4 v241, s[84:87], s28 offen offset:1024 sc1 lds
s_add_u32 s45, s45, 4096
s_cmp_eq_u32 s45, 30720
s_cselect_b32 s45, 18432, s45
s_waitcnt vmcnt(0)
mega_kernel_rs_x5:
s_add_u32 s76, s27, 4
s_min_u32 s76, s76, 63
s_cmp_gt_i32 s46, s76
s_cbranch_scc1 mega_kernel_rs_x6
v_mov_b32 v249, 0
s_mov_b64 exec, 3
buffer_atomic_add v249, v24, s[84:87], 0 offen sc0 sc1
s_mov_b64 exec, -1
mega_kernel_rs_x6:
s_add_u32 s76, s27, 2
s_cmp_lt_u32 s76, 63
s_cbranch_scc0 mega_kernel_rs_x4
s_cmp_gt_i32 s46, s76
s_cbranch_scc0 mega_kernel_rs_x4
s_add_u32 s77, s76, s82
s_bfe_u32 s28, s77, 0x40002
s_lshl_b32 s28, s28, 14
s_and_b32 s77, s77, 3
s_lshl_b32 s77, s77, 11
s_add_u32 s28, s28, s77
s_add_u32 s28, s28, s83
s_add_u32 s28, s28, 33554432
s_buffer_load_dword s78, s[84:87], s28 offset:0
s_buffer_load_dword s78, s[84:87], s28 offset:128
s_buffer_load_dword s78, s[84:87], s28 offset:256
s_buffer_load_dword s78, s[84:87], s28 offset:384
s_buffer_load_dword s78, s[84:87], s28 offset:512
s_buffer_load_dword s78, s[84:87], s28 offset:640
s_buffer_load_dword s78, s[84:87], s28 offset:768
s_buffer_load_dword s78, s[84:87], s28 offset:896
s_buffer_load_dword s78, s[84:87], s28 offset:1024
s_buffer_load_dword s78, s[84:87], s28 offset:1152
s_buffer_load_dword s78, s[84:87], s28 offset:1280
s_buffer_load_dword s78, s[84:87], s28 offset:1408
s_buffer_load_dword s78, s[84:87], s28 offset:1536
s_buffer_load_dword s78, s[84:87], s28 offset:1664
s_buffer_load_dword s78, s[84:87], s28 offset:1792
s_buffer_load_dword s78, s[84:87], s28 offset:1920
s_mov_b32 s89, s76
mega_kernel_rs_x4:
v_mov_b32 v96, 0
v_mov_b32 v97, 0
v_mov_b32 v98, 0
v_mov_b32 v99, 0
v_mov_b32 v100, 0
v_mov_b32 v101, 0
v_mov_b32 v102, 0
v_mov_b32 v103, 0
v_mov_b32 v104, 0
v_mov_b32 v105, 0
v_mov_b32 v106, 0
v_mov_b32 v107, 0
v_mov_b32 v108, 0
v_mov_b32 v109, 0
v_mov_b32 v110, 0
v_mov_b32 v111, 0
v_mov_b32 v112, 0
v_mov_b32 v113, 0
v_mov_b32 v114, 0
v_mov_b32 v115, 0
v_mov_b32 v116, 0
v_mov_b32 v117, 0
v_mov_b32 v118, 0
v_mov_b32 v119, 0
s_branch mega_kernel_rs_b5
mega_kernel_rs_il2:
s_cbranch_execz mega_kernel_rs_il3
mega_kernel_rs_p2r:
s_mov_b64 exec, s[42:43]
buffer_load_dwordx4 v[188:191], v10, s[84:87], s76 offen sc1
buffer_load_dwordx4 v[196:199], v10, s[84:87], s77 offen sc1
buffer_load_dwordx4 v[204:207], v10, s[84:87], s78 offen sc1
s_mov_b64 exec, -1
buffer_load_dwordx4 v[184:187], v17, s[84:87], s76 offen sc1
buffer_load_dwordx4 v[192:195], v17, s[84:87], s77 offen sc1
buffer_load_dwordx4 v[200:203], v17, s[84:87], s78 offen sc1
s_branch mega_kernel_rs_p2
mega_kernel_rs_il3:
s_cbranch_execz mega_kernel_rs_il4
.p2align 5
mega_kernel_rs_pa_1_0f:
s_mov_b64 exec, vcc
buffer_load_dwordx4 v[32:35], v7, s[84:87], s33 offen offset:0 sc1
s_mov_b64 exec, -1
s_branch mega_kernel_rs_pa_1_0
.p2align 5
mega_kernel_rs_pa_1_0:
s_waitcnt vmcnt(0)
v_max_u32 v4, v32, v34
v_cmp_eq_u32 vcc, -1, v4
s_cbranch_vccnz mega_kernel_rs_pa_1_0f
v_smfmac_f32_16x16x64_bf16 v[96:99], v[32:35], a[0:7], v6
v_smfmac_f32_16x16x64_bf16 v[100:103], v[32:35], a[32:39], v6
v_smfmac_f32_16x16x64_bf16 v[104:107], v[32:35], a[64:71], v6
v_smfmac_f32_16x16x64_bf16 v[108:111], v[32:35], a[96:103], v6
s_branch mega_kernel_rs_pa_d
mega_kernel_rs_il4:
s_cbranch_execz mega_kernel_rs_il5
.p2align 5
mega_kernel_rs_pa_2_1f:
s_mov_b64 exec, vcc
buffer_load_dwordx4 v[36:39], v7, s[84:87], s33 offen offset:1024 sc1
s_mov_b64 exec, -1
s_branch mega_kernel_rs_pa_2_1
.p2align 5
mega_kernel_rs_pa_2_1:
s_waitcnt vmcnt(0)
v_max_u32 v4, v36, v38
v_cmp_eq_u32 vcc, -1, v4
s_cbranch_vccnz mega_kernel_rs_pa_2_1f
v_smfmac_f32_16x16x64_bf16 v[96:99], v[36:39], a[8:15], v6
v_smfmac_f32_16x16x64_bf16 v[100:103], v[36:39], a[40:47], v6
v_smfmac_f32_16x16x64_bf16 v[104:107], v[36:39], a[72:79], v6
v_smfmac_f32_16x16x64_bf16 v[108:111], v[36:39], a[104:111], v6
s_branch mega_kernel_rs_pa_d
mega_kernel_rs_il5:
s_cbranch_execz mega_kernel_rs_il6
.p2align 5
mega_kernel_rs_pa_3_0f:
s_mov_b64 exec, vcc
buffer_load_dwordx4 v[32:35], v7, s[84:87], s33 offen offset:0 sc1
s_mov_b64 exec, -1
s_branch mega_kernel_rs_pa_3_1
.p2align 5
mega_kernel_rs_pa_3_0:
s_waitcnt vmcnt(1)
v_max_u32 v4, v32, v34
v_cmp_eq_u32 vcc, -1, v4
s_cbranch_vccnz mega_kernel_rs_pa_3_0f
v_smfmac_f32_16x16x64_bf16 v[96:99], v[32:35], a[0:7], v6
v_smfmac_f32_16x16x64_bf16 v[100:103], v[32:35], a[32:39], v6
v_smfmac_f32_16x16x64_bf16 v[104:107], v[32:35], a[64:71], v6
v_smfmac_f32_16x16x64_bf16 v[108:111], v[32:35], a[96:103], v6
s_branch mega_kernel_rs_pa_2_1
mega_kernel_rs_il6:
s_cbranch_execz mega_kernel_rs_il7
.p2align 5
mega_kernel_rs_pa_3_1f:
s_mov_b64 exec, vcc
buffer_load_dwordx4 v[36:39], v7, s[84:87], s33 offen offset:1024 sc1
s_mov_b64 exec, -1
s_branch mega_kernel_rs_pa_3_0
.p2align 5
mega_kernel_rs_pa_3_1:
s_waitcnt vmcnt(1)
v_max_u32 v4, v36, v38
v_cmp_eq_u32 vcc, -1, v4
s_cbranch_vccnz mega_kernel_rs_pa_3_1f
v_smfmac_f32_16x16x64_bf16 v[96:99], v[36:39], a[8:15], v6
v_smfmac_f32_16x16x64_bf16 v[100:103], v[36:39], a[40:47], v6
v_smfmac_f32_16x16x64_bf16 v[104:107], v[36:39], a[72:79], v6
v_smfmac_f32_16x16x64_bf16 v[108:111], v[36:39], a[104:111], v6
s_branch mega_kernel_rs_pa_1_0
mega_kernel_rs_il7:
s_cbranch_execz mega_kernel_rs_il8
.p2align 5
mega_kernel_rs_pa_4_2f:
s_mov_b64 exec, vcc
buffer_load_dwordx4 v[40:43], v7, s[84:87], s33 offen offset:2048 sc1
s_mov_b64 exec, -1
s_branch mega_kernel_rs_pa_4_2
.p2align 5
mega_kernel_rs_pa_4_2:
s_waitcnt vmcnt(0)
v_max_u32 v4, v40, v42
v_cmp_eq_u32 vcc, -1, v4
s_cbranch_vccnz mega_kernel_rs_pa_4_2f
v_smfmac_f32_16x16x64_bf16 v[96:99], v[40:43], a[16:23], v6
v_smfmac_f32_16x16x64_bf16 v[100:103], v[40:43], a[48:55], v6
v_smfmac_f32_16x16x64_bf16 v[104:107], v[40:43], a[80:87], v6
v_smfmac_f32_16x16x64_bf16 v[108:111], v[40:43], a[112:119], v6
s_branch mega_kernel_rs_pa_d
mega_kernel_rs_il8:
s_cbranch_execz mega_kernel_rs_il9
.p2align 5
mega_kernel_rs_pa_5_0f:
s_mov_b64 exec, vcc
buffer_load_dwordx4 v[32:35], v7, s[84:87], s33 offen offset:0 sc1
s_mov_b64 exec, -1
s_branch mega_kernel_rs_pa_5_2
.p2align 5
mega_kernel_rs_pa_5_0:
s_waitcnt vmcnt(1)
v_max_u32 v4, v32, v34
v_cmp_eq_u32 vcc, -1, v4
s_cbranch_vccnz mega_kernel_rs_pa_5_0f
v_smfmac_f32_16x16x64_bf16 v[96:99], v[32:35], a[0:7], v6
v_smfmac_f32_16x16x64_bf16 v[100:103], v[32:35], a[32:39], v6
v_smfmac_f32_16x16x64_bf16 v[104:107], v[32:35], a[64:71], v6
v_smfmac_f32_16x16x64_bf16 v[108:111], v[32:35], a[96:103], v6
s_branch mega_kernel_rs_pa_4_2
mega_kernel_rs_il9:
s_cbranch_execz mega_kernel_rs_il10
.p2align 5
mega_kernel_rs_pa_5_2f:
s_mov_b64 exec, vcc
buffer_load_dwordx4 v[40:43], v7, s[84:87], s33 offen offset:2048 sc1
s_mov_b64 exec, -1
s_branch mega_kernel_rs_pa_5_0
.p2align 5
mega_kernel_rs_pa_5_2:
s_waitcnt vmcnt(1)
v_max_u32 v4, v40, v42
v_cmp_eq_u32 vcc, -1, v4
s_cbranch_vccnz mega_kernel_rs_pa_5_2f
v_smfmac_f32_16x16x64_bf16 v[96:99], v[40:43], a[16:23], v6
v_smfmac_f32_16x16x64_bf16 v[100:103], v[40:43], a[48:55], v6
v_smfmac_f32_16x16x64_bf16 v[104:107], v[40:43], a[80:87], v6
v_smfmac_f32_16x16x64_bf16 v[108:111], v[40:43], a[112:119], v6
s_branch mega_kernel_rs_pa_1_0
mega_kernel_rs_il10:
s_cbranch_execz mega_kernel_rs_il11
.p2align 5
mega_kernel_rs_pa_6_1f:
s_mov_b64 exec, vcc
buffer_load_dwordx4 v[36:39], v7, s[84:87], s33 offen offset:1024 sc1
s_mov_b64 exec, -1
s_branch mega_kernel_rs_pa_6_2
.p2align 5
mega_kernel_rs_pa_6_1:
s_waitcnt vmcnt(1)
v_max_u32 v4, v36, v38
v_cmp_eq_u32 vcc, -1, v4
s_cbranch_vccnz mega_kernel_rs_pa_6_1f
v_smfmac_f32_16x16x64_bf16 v[96:99], v[36:39], a[8:15], v6
v_smfmac_f32_16x16x64_bf16 v[100:103], v[36:39], a[40:47], v6
v_smfmac_f32_16x16x64_bf16 v[104:107], v[36:39], a[72:79], v6
v_smfmac_f32_16x16x64_bf16 v[108:111], v[36:39], a[104:111], v6
s_branch mega_kernel_rs_pa_4_2
mega_kernel_rs_il11:
s_cbranch_execz mega_kernel_rs_il12
.p2align 5
mega_kernel_rs_pa_6_2f:
s_mov_b64 exec, vcc
buffer_load_dwordx4 v[40:43], v7, s[84:87], s33 offen offset:2048 sc1
s_mov_b64 exec, -1
s_branch mega_kernel_rs_pa_6_1
.p2align 5
mega_kernel_rs_pa_6_2:
s_waitcnt vmcnt(1)
v_max_u32 v4, v40, v42
v_cmp_eq_u32 vcc, -1, v4
s_cbranch_vccnz mega_kernel_rs_pa_6_2f
v_smfmac_f32_16x16x64_bf16 v[96:99], v[40:43], a[16:23], v6
v_smfmac_f32_16x16x64_bf16 v[100:103], v[40:43], a[48:55], v6
v_smfmac_f32_16x16x64_bf16 v[104:107], v[40:43], a[80:87], v6
v_smfmac_f32_16x16x64_bf16 v[108:111], v[40:43], a[112:119], v6
s_branch mega_kernel_rs_pa_2_1
mega_kernel_rs_il12:
s_cbranch_execz mega_kernel_rs_il13
.p2align 5
mega_kernel_rs_pa_7_0f:
s_mov_b64 exec, vcc
buffer_load_dwordx4 v[32:35], v7, s[84:87], s33 offen offset:0 sc1
s_mov_b64 exec, -1
s_branch mega_kernel_rs_pa_7_1
.p2align 5
mega_kernel_rs_pa_7_0:
s_waitcnt vmcnt(2)
v_max_u32 v4, v32, v34
v_cmp_eq_u32 vcc, -1, v4
s_cbranch_vccnz mega_kernel_rs_pa_7_0f
v_smfmac_f32_16x16x64_bf16 v[96:99], v[32:35], a[0:7], v6
v_smfmac_f32_16x16x64_bf16 v[100:103], v[32:35], a[32:39], v6
v_smfmac_f32_16x16x64_bf16 v[104:107], v[32:35], a[64:71], v6
v_smfmac_f32_16x16x64_bf16 v[108:111], v[32:35], a[96:103], v6
s_branch mega_kernel_rs_pa_6_1
mega_kernel_rs_il13:
s_cbranch_execz mega_kernel_rs_il14
.p2align 5
mega_kernel_rs_pa_7_1f:
s_mov_b64 exec, vcc
buffer_load_dwordx4 v[36:39], v7, s[84:87], s33 offen offset:1024 sc1
s_mov_b64 exec, -1
s_branch mega_kernel_rs_pa_7_2
.p2align 5
mega_kernel_rs_pa_7_1:
s_waitcnt vmcnt(2)
v_max_u32 v4, v36, v38
v_cmp_eq_u32 vcc, -1, v4
s_cbranch_vccnz mega_kernel_rs_pa_7_1f
v_smfmac_f32_16x16x64_bf16 v[96:99], v[36:39], a[8:15], v6
v_smfmac_f32_16x16x64_bf16 v[100:103], v[36:39], a[40:47], v6
v_smfmac_f32_16x16x64_bf16 v[104:107], v[36:39], a[72:79], v6
v_smfmac_f32_16x16x64_bf16 v[108:111], v[36:39], a[104:111], v6
s_branch mega_kernel_rs_pa_5_2
mega_kernel_rs_il14:
s_cbranch_execz mega_kernel_rs_il15
.p2align 5
mega_kernel_rs_pa_7_2f:
s_mov_b64 exec, vcc
buffer_load_dwordx4 v[40:43], v7, s[84:87], s33 offen offset:2048 sc1
s_mov_b64 exec, -1
s_branch mega_kernel_rs_pa_7_0
.p2align 5
mega_kernel_rs_pa_7_2:
s_waitcnt vmcnt(2)
v_max_u32 v4, v40, v42
v_cmp_eq_u32 vcc, -1, v4
s_cbranch_vccnz mega_kernel_rs_pa_7_2f
v_smfmac_f32_16x16x64_bf16 v[96:99], v[40:43], a[16:23], v6
v_smfmac_f32_16x16x64_bf16 v[100:103], v[40:43], a[48:55], v6
v_smfmac_f32_16x16x64_bf16 v[104:107], v[40:43], a[80:87], v6
v_smfmac_f32_16x16x64_bf16 v[108:111], v[40:43], a[112:119], v6
s_branch mega_kernel_rs_pa_3_0
mega_kernel_rs_il15:
s_cbranch_execz mega_kernel_rs_il16
.p2align 5
mega_kernel_rs_pa_8_3f:
s_mov_b64 exec, vcc
buffer_load_dwordx4 v[44:47], v7, s[84:87], s33 offen offset:3072 sc1
s_mov_b64 exec, -1
s_branch mega_kernel_rs_pa_8_3
.p2align 5
mega_kernel_rs_pa_8_3:
s_waitcnt vmcnt(0)
v_max_u32 v4, v44, v46
v_cmp_eq_u32 vcc, -1, v4
s_cbranch_vccnz mega_kernel_rs_pa_8_3f
v_smfmac_f32_16x16x64_bf16 v[96:99], v[44:47], a[24:31], v6
v_smfmac_f32_16x16x64_bf16 v[100:103], v[44:47], a[56:63], v6
v_smfmac_f32_16x16x64_bf16 v[104:107], v[44:47], a[88:95], v6
v_smfmac_f32_16x16x64_bf16 v[108:111], v[44:47], a[120:127], v6
s_branch mega_kernel_rs_pa_d
mega_kernel_rs_il16:
s_cbranch_execz mega_kernel_rs_il17
.p2align 5
mega_kernel_rs_pa_9_0f:
s_mov_b64 exec, vcc
buffer_load_dwordx4 v[32:35], v7, s[84:87], s33 offen offset:0 sc1
s_mov_b64 exec, -1
s_branch mega_kernel_rs_pa_9_3
.p2align 5
mega_kernel_rs_pa_9_0:
s_waitcnt vmcnt(1)
v_max_u32 v4, v32, v34
v_cmp_eq_u32 vcc, -1, v4
s_cbranch_vccnz mega_kernel_rs_pa_9_0f
v_smfmac_f32_16x16x64_bf16 v[96:99], v[32:35], a[0:7], v6
v_smfmac_f32_16x16x64_bf16 v[100:103], v[32:35], a[32:39], v6
v_smfmac_f32_16x16x64_bf16 v[104:107], v[32:35], a[64:71], v6
v_smfmac_f32_16x16x64_bf16 v[108:111], v[32:35], a[96:103], v6
s_branch mega_kernel_rs_pa_8_3
mega_kernel_rs_il17:
s_cbranch_execz mega_kernel_rs_il18
.p2align 5
mega_kernel_rs_pa_9_3f:
s_mov_b64 exec, vcc
buffer_load_dwordx4 v[44:47], v7, s[84:87], s33 offen offset:3072 sc1
s_mov_b64 exec, -1
s_branch mega_kernel_rs_pa_9_0
.p2align 5
mega_kernel_rs_pa_9_3:
s_waitcnt vmcnt(1)
v_max_u32 v4, v44, v46
v_cmp_eq_u32 vcc, -1, v4
s_cbranch_vccnz mega_kernel_rs_pa_9_3f
v_smfmac_f32_16x16x64_bf16 v[96:99], v[44:47], a[24:31], v6
v_smfmac_f32_16x16x64_bf16 v[100:103], v[44:47], a[56:63], v6
v_smfmac_f32_16x16x64_bf16 v[104:107], v[44:47], a[88:95], v6
v_smfmac_f32_16x16x64_bf16 v[108:111], v[44:47], a[120:127], v6
s_branch mega_kernel_rs_pa_1_0
mega_kernel_rs_il18:
s_cbranch_execz mega_kernel_rs_iwd
.p2align 5
mega_kernel_rs_pa_10_1f:
s_mov_b64 exec, vcc
buffer_load_dwordx4 v[36:39], v7, s[84:87], s33 offen offset:1024 sc1
s_mov_b64 exec, -1
s_branch mega_kernel_rs_pa_10_3
.p2align 5
mega_kernel_rs_pa_10_1:
s_waitcnt vmcnt(1)
v_max_u32 v4, v36, v38
v_cmp_eq_u32 vcc, -1, v4
s_cbranch_vccnz mega_kernel_rs_pa_10_1f
v_smfmac_f32_16x16x64_bf16 v[96:99], v[36:39], a[8:15], v6
v_smfmac_f32_16x16x64_bf16 v[100:103], v[36:39], a[40:47], v6
v_smfmac_f32_16x16x64_bf16 v[104:107], v[36:39], a[72:79], v6
v_smfmac_f32_16x16x64_bf16 v[108:111], v[36:39], a[104:111], v6
s_branch mega_kernel_rs_pa_8_3
mega_kernel_rs_iw1:
mega_kernel_rs_il19:
s_cbranch_execz mega_kernel_rs_il20
.p2align 5
mega_kernel_rs_pa_10_3f:
s_mov_b64 exec, vcc
buffer_load_dwordx4 v[44:47], v7, s[84:87], s33 offen offset:3072 sc1
s_mov_b64 exec, -1
s_branch mega_kernel_rs_pa_10_1
.p2align 5
mega_kernel_rs_pa_10_3:
s_waitcnt vmcnt(1)
v_max_u32 v4, v44, v46
v_cmp_eq_u32 vcc, -1, v4
s_cbranch_vccnz mega_kernel_rs_pa_10_3f
v_smfmac_f32_16x16x64_bf16 v[96:99], v[44:47], a[24:31], v6
v_smfmac_f32_16x16x64_bf16 v[100:103], v[44:47], a[56:63], v6
v_smfmac_f32_16x16x64_bf16 v[104:107], v[44:47], a[88:95], v6
v_smfmac_f32_16x16x64_bf16 v[108:111], v[44:47], a[120:127], v6
s_branch mega_kernel_rs_pa_2_1
mega_kernel_rs_il20:
s_cbranch_execz mega_kernel_rs_il21
.p2align 5
mega_kernel_rs_pa_11_0f:
s_mov_b64 exec, vcc
buffer_load_dwordx4 v[32:35], v7, s[84:87], s33 offen offset:0 sc1
s_mov_b64 exec, -1
s_branch mega_kernel_rs_pa_11_1
.p2align 5
mega_kernel_rs_pa_11_0:
s_waitcnt vmcnt(2)
v_max_u32 v4, v32, v34
v_cmp_eq_u32 vcc, -1, v4
s_cbranch_vccnz mega_kernel_rs_pa_11_0f
v_smfmac_f32_16x16x64_bf16 v[96:99], v[32:35], a[0:7], v6
v_smfmac_f32_16x16x64_bf16 v[100:103], v[32:35], a[32:39], v6
v_smfmac_f32_16x16x64_bf16 v[104:107], v[32:35], a[64:71], v6
v_smfmac_f32_16x16x64_bf16 v[108:111], v[32:35], a[96:103], v6
s_branch mega_kernel_rs_pa_10_1
mega_kernel_rs_il21:
s_cbranch_execz mega_kernel_rs_il22
.p2align 5
mega_kernel_rs_pa_11_1f:
s_mov_b64 exec, vcc
buffer_load_dwordx4 v[36:39], v7, s[84:87], s33 offen offset:1024 sc1
s_mov_b64 exec, -1
s_branch mega_kernel_rs_pa_11_3
.p2align 5
mega_kernel_rs_pa_11_1:
s_waitcnt vmcnt(2)
v_max_u32 v4, v36, v38
v_cmp_eq_u32 vcc, -1, v4
s_cbranch_vccnz mega_kernel_rs_pa_11_1f
v_smfmac_f32_16x16x64_bf16 v[96:99], v[36:39], a[8:15], v6
v_smfmac_f32_16x16x64_bf16 v[100:103], v[36:39], a[40:47], v6
v_smfmac_f32_16x16x64_bf16 v[104:107], v[36:39], a[72:79], v6
v_smfmac_f32_16x16x64_bf16 v[108:111], v[36:39], a[104:111], v6
s_branch mega_kernel_rs_pa_9_3
mega_kernel_rs_il22:
s_cbranch_execz mega_kernel_rs_il23
.p2align 5
mega_kernel_rs_pa_11_3f:
s_mov_b64 exec, vcc
buffer_load_dwordx4 v[44:47], v7, s[84:87], s33 offen offset:3072 sc1
s_mov_b64 exec, -1
s_branch mega_kernel_rs_pa_11_0
.p2align 5
mega_kernel_rs_pa_11_3:
s_waitcnt vmcnt(2)
v_max_u32 v4, v44, v46
v_cmp_eq_u32 vcc, -1, v4
s_cbranch_vccnz mega_kernel_rs_pa_11_3f
v_smfmac_f32_16x16x64_bf16 v[96:99], v[44:47], a[24:31], v6
v_smfmac_f32_16x16x64_bf16 v[100:103], v[44:47], a[56:63], v6
v_smfmac_f32_16x16x64_bf16 v[104:107], v[44:47], a[88:95], v6
v_smfmac_f32_16x16x64_bf16 v[108:111], v[44:47], a[120:127], v6
s_branch mega_kernel_rs_pa_3_0
mega_kernel_rs_il23:
s_cbranch_execz mega_kernel_rs_il24
.p2align 5
mega_kernel_rs_pa_12_2f:
s_mov_b64 exec, vcc
buffer_load_dwordx4 v[40:43], v7, s[84:87], s33 offen offset:2048 sc1
s_mov_b64 exec, -1
s_branch mega_kernel_rs_pa_12_3
.p2align 5
mega_kernel_rs_pa_12_2:
s_waitcnt vmcnt(1)
v_max_u32 v4, v40, v42
v_cmp_eq_u32 vcc, -1, v4
s_cbranch_vccnz mega_kernel_rs_pa_12_2f
v_smfmac_f32_16x16x64_bf16 v[96:99], v[40:43], a[16:23], v6
v_smfmac_f32_16x16x64_bf16 v[100:103], v[40:43], a[48:55], v6
v_smfmac_f32_16x16x64_bf16 v[104:107], v[40:43], a[80:87], v6
v_smfmac_f32_16x16x64_bf16 v[108:111], v[40:43], a[112:119], v6
s_branch mega_kernel_rs_pa_8_3
mega_kernel_rs_il24:
s_cbranch_execz mega_kernel_rs_il25
.p2align 5
mega_kernel_rs_pa_12_3f:
s_mov_b64 exec, vcc
buffer_load_dwordx4 v[44:47], v7, s[84:87], s33 offen offset:3072 sc1
s_mov_b64 exec, -1
s_branch mega_kernel_rs_pa_12_2
.p2align 5
mega_kernel_rs_pa_12_3:
s_waitcnt vmcnt(1)
v_max_u32 v4, v44, v46
v_cmp_eq_u32 vcc, -1, v4
s_cbranch_vccnz mega_kernel_rs_pa_12_3f
v_smfmac_f32_16x16x64_bf16 v[96:99], v[44:47], a[24:31], v6
v_smfmac_f32_16x16x64_bf16 v[100:103], v[44:47], a[56:63], v6
v_smfmac_f32_16x16x64_bf16 v[104:107], v[44:47], a[88:95], v6
v_smfmac_f32_16x16x64_bf16 v[108:111], v[44:47], a[120:127], v6
s_branch mega_kernel_rs_pa_4_2
mega_kernel_rs_il25:
s_cbranch_execz mega_kernel_rs_il26
.p2align 5
mega_kernel_rs_pa_13_0f:
s_mov_b64 exec, vcc
buffer_load_dwordx4 v[32:35], v7, s[84:87], s33 offen offset:0 sc1
s_mov_b64 exec, -1
s_branch mega_kernel_rs_pa_13_2
.p2align 5
mega_kernel_rs_pa_13_0:
s_waitcnt vmcnt(2)
v_max_u32 v4, v32, v34
v_cmp_eq_u32 vcc, -1, v4
s_cbranch_vccnz mega_kernel_rs_pa_13_0f
v_smfmac_f32_16x16x64_bf16 v[96:99], v[32:35], a[0:7], v6
v_smfmac_f32_16x16x64_bf16 v[100:103], v[32:35], a[32:39], v6
v_smfmac_f32_16x16x64_bf16 v[104:107], v[32:35], a[64:71], v6
v_smfmac_f32_16x16x64_bf16 v[108:111], v[32:35], a[96:103], v6
s_branch mega_kernel_rs_pa_12_2
mega_kernel_rs_il26:
s_cbranch_execz mega_kernel_rs_il27
.p2align 5
mega_kernel_rs_pa_13_2f:
s_mov_b64 exec, vcc
buffer_load_dwordx4 v[40:43], v7, s[84:87], s33 offen offset:2048 sc1
s_mov_b64 exec, -1
s_branch mega_kernel_rs_pa_13_3
.p2align 5
mega_kernel_rs_pa_13_2:
s_waitcnt vmcnt(2)
v_max_u32 v4, v40, v42
v_cmp_eq_u32 vcc, -1, v4
s_cbranch_vccnz mega_kernel_rs_pa_13_2f
v_smfmac_f32_16x16x64_bf16 v[96:99], v[40:43], a[16:23], v6
v_smfmac_f32_16x16x64_bf16 v[100:103], v[40:43], a[48:55], v6
v_smfmac_f32_16x16x64_bf16 v[104:107], v[40:43], a[80:87], v6
v_smfmac_f32_16x16x64_bf16 v[108:111], v[40:43], a[112:119], v6
s_branch mega_kernel_rs_pa_9_3
mega_kernel_rs_il27:
s_cbranch_execz mega_kernel_rs_il28
.p2align 5
mega_kernel_rs_pa_13_3f:
s_mov_b64 exec, vcc
buffer_load_dwordx4 v[44:47], v7, s[84:87], s33 offen offset:3072 sc1
s_mov_b64 exec, -1
s_branch mega_kernel_rs_pa_13_0
.p2align 5
mega_kernel_rs_pa_13_3:
s_waitcnt vmcnt(2)
v_max_u32 v4, v44, v46
v_cmp_eq_u32 vcc, -1, v4
s_cbranch_vccnz mega_kernel_rs_pa_13_3f
v_smfmac_f32_16x16x64_bf16 v[96:99], v[44:47], a[24:31], v6
v_smfmac_f32_16x16x64_bf16 v[100:103], v[44:47], a[56:63], v6
v_smfmac_f32_16x16x64_bf16 v[104:107], v[44:47], a[88:95], v6
v_smfmac_f32_16x16x64_bf16 v[108:111], v[44:47], a[120:127], v6
s_branch mega_kernel_rs_pa_5_0
mega_kernel_rs_il28:
s_cbranch_execz mega_kernel_rs_il29
.p2align 5
mega_kernel_rs_pa_14_1f:
s_mov_b64 exec, vcc
buffer_load_dwordx4 v[36:39], v7, s[84:87], s33 offen offset:1024 sc1
s_mov_b64 exec, -1
s_branch mega_kernel_rs_pa_14_2
.p2align 5
mega_kernel_rs_pa_14_1:
s_waitcnt vmcnt(2)
v_max_u32 v4, v36, v38
v_cmp_eq_u32 vcc, -1, v4
s_cbranch_vccnz mega_kernel_rs_pa_14_1f
v_smfmac_f32_16x16x64_bf16 v[96:99], v[36:39], a[8:15], v6
v_smfmac_f32_16x16x64_bf16 v[100:103], v[36:39], a[40:47], v6
v_smfmac_f32_16x16x64_bf16 v[104:107], v[36:39], a[72:79], v6
v_smfmac_f32_16x16x64_bf16 v[108:111], v[36:39], a[104:111], v6
s_branch mega_kernel_rs_pa_12_2
mega_kernel_rs_il29:
s_cbranch_execz mega_kernel_rs_il30
.p2align 5
mega_kernel_rs_pa_14_2f:
s_mov_b64 exec, vcc
buffer_load_dwordx4 v[40:43], v7, s[84:87], s33 offen offset:2048 sc1
s_mov_b64 exec, -1
s_branch mega_kernel_rs_pa_14_3
.p2align 5
mega_kernel_rs_pa_14_2:
s_waitcnt vmcnt(2)
v_max_u32 v4, v40, v42
v_cmp_eq_u32 vcc, -1, v4
s_cbranch_vccnz mega_kernel_rs_pa_14_2f
v_smfmac_f32_16x16x64_bf16 v[96:99], v[40:43], a[16:23], v6
v_smfmac_f32_16x16x64_bf16 v[100:103], v[40:43], a[48:55], v6
v_smfmac_f32_16x16x64_bf16 v[104:107], v[40:43], a[80:87], v6
v_smfmac_f32_16x16x64_bf16 v[108:111], v[40:43], a[112:119], v6
s_branch mega_kernel_rs_pa_10_3
mega_kernel_rs_il30:
s_cbranch_execz mega_kernel_rs_il31
.p2align 5
mega_kernel_rs_pa_14_3f:
s_mov_b64 exec, vcc
buffer_load_dwordx4 v[44:47], v7, s[84:87], s33 offen offset:3072 sc1
s_mov_b64 exec, -1
s_branch mega_kernel_rs_pa_14_1
.p2align 5
mega_kernel_rs_pa_14_3:
s_waitcnt vmcnt(2)
v_max_u32 v4, v44, v46
v_cmp_eq_u32 vcc, -1, v4
s_cbranch_vccnz mega_kernel_rs_pa_14_3f
v_smfmac_f32_16x16x64_bf16 v[96:99], v[44:47], a[24:31], v6
v_smfmac_f32_16x16x64_bf16 v[100:103], v[44:47], a[56:63], v6
v_smfmac_f32_16x16x64_bf16 v[104:107], v[44:47], a[88:95], v6
v_smfmac_f32_16x16x64_bf16 v[108:111], v[44:47], a[120:127], v6
s_branch mega_kernel_rs_pa_6_1
mega_kernel_rs_il31:
s_cbranch_execz mega_kernel_rs_il32
.p2align 5
mega_kernel_rs_pa_15_0f:
s_mov_b64 exec, vcc
buffer_load_dwordx4 v[32:35], v7, s[84:87], s33 offen offset:0 sc1
s_mov_b64 exec, -1
s_branch mega_kernel_rs_pa_15_1
.p2align 5
mega_kernel_rs_pa_15_0:
s_waitcnt vmcnt(3)
v_max_u32 v4, v32, v34
v_cmp_eq_u32 vcc, -1, v4
s_cbranch_vccnz mega_kernel_rs_pa_15_0f
v_smfmac_f32_16x16x64_bf16 v[96:99], v[32:35], a[0:7], v6
v_smfmac_f32_16x16x64_bf16 v[100:103], v[32:35], a[32:39], v6
v_smfmac_f32_16x16x64_bf16 v[104:107], v[32:35], a[64:71], v6
v_smfmac_f32_16x16x64_bf16 v[108:111], v[32:35], a[96:103], v6
s_branch mega_kernel_rs_pa_14_1
mega_kernel_rs_il32:
s_cbranch_execz mega_kernel_rs_il33
.p2align 5
mega_kernel_rs_pa_15_1f:
s_mov_b64 exec, vcc
buffer_load_dwordx4 v[36:39], v7, s[84:87], s33 offen offset:1024 sc1
s_mov_b64 exec, -1
s_branch mega_kernel_rs_pa_15_2
.p2align 5
mega_kernel_rs_pa_15_1:
s_waitcnt vmcnt(3)
v_max_u32 v4, v36, v38
v_cmp_eq_u32 vcc, -1, v4
s_cbranch_vccnz mega_kernel_rs_pa_15_1f
v_smfmac_f32_16x16x64_bf16 v[96:99], v[36:39], a[8:15], v6
v_smfmac_f32_16x16x64_bf16 v[100:103], v[36:39], a[40:47], v6
v_smfmac_f32_16x16x64_bf16 v[104:107], v[36:39], a[72:79], v6
v_smfmac_f32_16x16x64_bf16 v[108:111], v[36:39], a[104:111], v6
s_branch mega_kernel_rs_pa_13_2
mega_kernel_rs_il33:
s_cbranch_execz mega_kernel_rs_il34
.p2align 5
mega_kernel_rs_pa_15_2f:
s_mov_b64 exec, vcc
buffer_load_dwordx4 v[40:43], v7, s[84:87], s33 offen offset:2048 sc1
s_mov_b64 exec, -1
s_branch mega_kernel_rs_pa_15_3
.p2align 5
mega_kernel_rs_pa_15_2:
s_waitcnt vmcnt(3)
v_max_u32 v4, v40, v42
v_cmp_eq_u32 vcc, -1, v4
s_cbranch_vccnz mega_kernel_rs_pa_15_2f
v_smfmac_f32_16x16x64_bf16 v[96:99], v[40:43], a[16:23], v6
v_smfmac_f32_16x16x64_bf16 v[100:103], v[40:43], a[48:55], v6
v_smfmac_f32_16x16x64_bf16 v[104:107], v[40:43], a[80:87], v6
v_smfmac_f32_16x16x64_bf16 v[108:111], v[40:43], a[112:119], v6
s_branch mega_kernel_rs_pa_11_3
mega_kernel_rs_il34:
s_cbranch_execz mega_kernel_rs_il35
.p2align 5
mega_kernel_rs_pa_15_3f:
s_mov_b64 exec, vcc
buffer_load_dwordx4 v[44:47], v7, s[84:87], s33 offen offset:3072 sc1
s_mov_b64 exec, -1
s_branch mega_kernel_rs_pa_15_0
.p2align 5
mega_kernel_rs_pa_15_3:
s_waitcnt vmcnt(3)
v_max_u32 v4, v44, v46
v_cmp_eq_u32 vcc, -1, v4
s_cbranch_vccnz mega_kernel_rs_pa_15_3f
v_smfmac_f32_16x16x64_bf16 v[96:99], v[44:47], a[24:31], v6
v_smfmac_f32_16x16x64_bf16 v[100:103], v[44:47], a[56:63], v6
v_smfmac_f32_16x16x64_bf16 v[104:107], v[44:47], a[88:95], v6
v_smfmac_f32_16x16x64_bf16 v[108:111], v[44:47], a[120:127], v6
s_branch mega_kernel_rs_pa_7_0
mega_kernel_rs_il35:
s_cbranch_execz mega_kernel_rs_il36
.p2align 5
mega_kernel_rs_pc_1_0f:
s_mov_b64 exec, vcc
buffer_load_dwordx4 v[32:35], v7, s[84:87], s29 offen offset:0 sc1
s_mov_b64 exec, -1
s_branch mega_kernel_rs_pc_1_0
.p2align 5
mega_kernel_rs_pc_1_0:
s_waitcnt vmcnt(0)
v_cmp_eq_u32 vcc, -1, v32
s_cbranch_vccnz mega_kernel_rs_pc_1_0f
v_smfmac_f32_16x16x64_bf16 v[96:99], v[32:35], a[192:199], v6
v_smfmac_f32_16x16x64_bf16 v[100:103], v[32:35], a[224:231], v6
s_branch mega_kernel_rs_pc_d
mega_kernel_rs_il36:
s_cbranch_execz mega_kernel_rs_il37
.p2align 5
mega_kernel_rs_pc_2_1f:
s_mov_b64 exec, vcc
buffer_load_dwordx4 v[36:39], v7, s[84:87], s29 offen offset:1024 sc1
s_mov_b64 exec, -1
s_branch mega_kernel_rs_pc_2_1
mega_kernel_rs_il37:
s_cbranch_execz mega_kernel_rs_iwd
.p2align 5
mega_kernel_rs_pc_2_1:
s_waitcnt vmcnt(0)
v_cmp_eq_u32 vcc, -1, v36
s_cbranch_vccnz mega_kernel_rs_pc_2_1f
v_smfmac_f32_16x16x64_bf16 v[96:99], v[36:39], a[200:207], v6
v_smfmac_f32_16x16x64_bf16 v[100:103], v[36:39], a[232:239], v6
s_branch mega_kernel_rs_pc_d
.p2align 5
mega_kernel_rs_pc_3_0f:
s_mov_b64 exec, vcc
buffer_load_dwordx4 v[32:35], v7, s[84:87], s29 offen offset:0 sc1
s_mov_b64 exec, -1
s_branch mega_kernel_rs_pc_3_1
mega_kernel_rs_iw2:
mega_kernel_rs_il38:
s_cbranch_execz mega_kernel_rs_il39
.p2align 5
mega_kernel_rs_pc_3_0:
s_waitcnt vmcnt(1)
v_cmp_eq_u32 vcc, -1, v32
s_cbranch_vccnz mega_kernel_rs_pc_3_0f
v_smfmac_f32_16x16x64_bf16 v[96:99], v[32:35], a[192:199], v6
v_smfmac_f32_16x16x64_bf16 v[100:103], v[32:35], a[224:231], v6
s_branch mega_kernel_rs_pc_2_1
.p2align 5
mega_kernel_rs_pc_3_1f:
s_mov_b64 exec, vcc
buffer_load_dwordx4 v[36:39], v7, s[84:87], s29 offen offset:1024 sc1
s_mov_b64 exec, -1
s_branch mega_kernel_rs_pc_3_0
mega_kernel_rs_il39:
s_cbranch_execz mega_kernel_rs_il40
.p2align 5
mega_kernel_rs_pc_3_1:
s_waitcnt vmcnt(1)
v_cmp_eq_u32 vcc, -1, v36
s_cbranch_vccnz mega_kernel_rs_pc_3_1f
v_smfmac_f32_16x16x64_bf16 v[96:99], v[36:39], a[200:207], v6
v_smfmac_f32_16x16x64_bf16 v[100:103], v[36:39], a[232:239], v6
s_branch mega_kernel_rs_pc_1_0
.p2align 5
mega_kernel_rs_pc_4_2f:
s_mov_b64 exec, vcc
buffer_load_dwordx4 v[40:43], v7, s[84:87], s29 offen offset:2048 sc1
s_mov_b64 exec, -1
s_branch mega_kernel_rs_pc_4_2
mega_kernel_rs_il40:
s_cbranch_execz mega_kernel_rs_il41
.p2align 5
mega_kernel_rs_pc_4_2:
s_waitcnt vmcnt(0)
v_cmp_eq_u32 vcc, -1, v40
s_cbranch_vccnz mega_kernel_rs_pc_4_2f
v_smfmac_f32_16x16x64_bf16 v[96:99], v[40:43], a[208:215], v6
v_smfmac_f32_16x16x64_bf16 v[100:103], v[40:43], a[240:247], v6
s_branch mega_kernel_rs_pc_d
.p2align 5
mega_kernel_rs_pc_5_0f:
s_mov_b64 exec, vcc
buffer_load_dwordx4 v[32:35], v7, s[84:87], s29 offen offset:0 sc1
s_mov_b64 exec, -1
s_branch mega_kernel_rs_pc_5_2
mega_kernel_rs_il41:
s_cbranch_execz mega_kernel_rs_il42
.p2align 5
mega_kernel_rs_pc_5_0:
s_waitcnt vmcnt(1)
v_cmp_eq_u32 vcc, -1, v32
s_cbranch_vccnz mega_kernel_rs_pc_5_0f
v_smfmac_f32_16x16x64_bf16 v[96:99], v[32:35], a[192:199], v6
v_smfmac_f32_16x16x64_bf16 v[100:103], v[32:35], a[224:231], v6
s_branch mega_kernel_rs_pc_4_2
.p2align 5
mega_kernel_rs_pc_5_2f:
s_mov_b64 exec, vcc
buffer_load_dwordx4 v[40:43], v7, s[84:87], s29 offen offset:2048 sc1
s_mov_b64 exec, -1
s_branch mega_kernel_rs_pc_5_0
mega_kernel_rs_il42:
s_cbranch_execz mega_kernel_rs_il43
.p2align 5
mega_kernel_rs_pc_5_2:
s_waitcnt vmcnt(1)
v_cmp_eq_u32 vcc, -1, v40
s_cbranch_vccnz mega_kernel_rs_pc_5_2f
v_smfmac_f32_16x16x64_bf16 v[96:99], v[40:43], a[208:215], v6
v_smfmac_f32_16x16x64_bf16 v[100:103], v[40:43], a[240:247], v6
s_branch mega_kernel_rs_pc_1_0
.p2align 5
mega_kernel_rs_pc_6_1f:
s_mov_b64 exec, vcc
buffer_load_dwordx4 v[36:39], v7, s[84:87], s29 offen offset:1024 sc1
s_mov_b64 exec, -1
s_branch mega_kernel_rs_pc_6_2
mega_kernel_rs_il43:
s_cbranch_execz mega_kernel_rs_il44
.p2align 5
mega_kernel_rs_pc_6_1:
s_waitcnt vmcnt(1)
v_cmp_eq_u32 vcc, -1, v36
s_cbranch_vccnz mega_kernel_rs_pc_6_1f
v_smfmac_f32_16x16x64_bf16 v[96:99], v[36:39], a[200:207], v6
v_smfmac_f32_16x16x64_bf16 v[100:103], v[36:39], a[232:239], v6
s_branch mega_kernel_rs_pc_4_2
.p2align 5
mega_kernel_rs_pc_6_2f:
s_mov_b64 exec, vcc
buffer_load_dwordx4 v[40:43], v7, s[84:87], s29 offen offset:2048 sc1
s_mov_b64 exec, -1
s_branch mega_kernel_rs_pc_6_1
mega_kernel_rs_il44:
s_cbranch_execz mega_kernel_rs_il45
.p2align 5
mega_kernel_rs_pc_6_2:
s_waitcnt vmcnt(1)
v_cmp_eq_u32 vcc, -1, v40
s_cbranch_vccnz mega_kernel_rs_pc_6_2f
v_smfmac_f32_16x16x64_bf16 v[96:99], v[40:43], a[208:215], v6
v_smfmac_f32_16x16x64_bf16 v[100:103], v[40:43], a[240:247], v6
s_branch mega_kernel_rs_pc_2_1
.p2align 5
mega_kernel_rs_pc_7_0f:
s_mov_b64 exec, vcc
buffer_load_dwordx4 v[32:35], v7, s[84:87], s29 offen offset:0 sc1
s_mov_b64 exec, -1
s_branch mega_kernel_rs_pc_7_1
mega_kernel_rs_il45:
s_cbranch_execz mega_kernel_rs_il46
.p2align 5
mega_kernel_rs_pc_7_0:
s_waitcnt vmcnt(2)
v_cmp_eq_u32 vcc, -1, v32
s_cbranch_vccnz mega_kernel_rs_pc_7_0f
v_smfmac_f32_16x16x64_bf16 v[96:99], v[32:35], a[192:199], v6
v_smfmac_f32_16x16x64_bf16 v[100:103], v[32:35], a[224:231], v6
s_branch mega_kernel_rs_pc_6_1
.p2align 5
mega_kernel_rs_pc_7_1f:
s_mov_b64 exec, vcc
buffer_load_dwordx4 v[36:39], v7, s[84:87], s29 offen offset:1024 sc1
s_mov_b64 exec, -1
s_branch mega_kernel_rs_pc_7_2
mega_kernel_rs_il46:
s_cbranch_execz mega_kernel_rs_il47
.p2align 5
mega_kernel_rs_pc_7_1:
s_waitcnt vmcnt(2)
v_cmp_eq_u32 vcc, -1, v36
s_cbranch_vccnz mega_kernel_rs_pc_7_1f
v_smfmac_f32_16x16x64_bf16 v[96:99], v[36:39], a[200:207], v6
v_smfmac_f32_16x16x64_bf16 v[100:103], v[36:39], a[232:239], v6
s_branch mega_kernel_rs_pc_5_2
.p2align 5
mega_kernel_rs_pc_7_2f:
s_mov_b64 exec, vcc
buffer_load_dwordx4 v[40:43], v7, s[84:87], s29 offen offset:2048 sc1
s_mov_b64 exec, -1
s_branch mega_kernel_rs_pc_7_0
mega_kernel_rs_il47:
s_cbranch_execz mega_kernel_rs_il48
.p2align 5
mega_kernel_rs_pc_7_2:
s_waitcnt vmcnt(2)
v_cmp_eq_u32 vcc, -1, v40
s_cbranch_vccnz mega_kernel_rs_pc_7_2f
v_smfmac_f32_16x16x64_bf16 v[96:99], v[40:43], a[208:215], v6
v_smfmac_f32_16x16x64_bf16 v[100:103], v[40:43], a[240:247], v6
s_branch mega_kernel_rs_pc_3_0
.p2align 5
mega_kernel_rs_pc_8_3f:
s_mov_b64 exec, vcc
buffer_load_dwordx4 v[44:47], v7, s[84:87], s29 offen offset:3072 sc1
s_mov_b64 exec, -1
s_branch mega_kernel_rs_pc_8_3
mega_kernel_rs_il48:
s_cbranch_execz mega_kernel_rs_il49
.p2align 5
mega_kernel_rs_pc_9_0f:
s_mov_b64 exec, vcc
buffer_load_dwordx4 v[32:35], v7, s[84:87], s29 offen offset:0 sc1
s_mov_b64 exec, -1
s_branch mega_kernel_rs_pc_9_3
.p2align 5
mega_kernel_rs_pc_9_0:
s_waitcnt vmcnt(1)
v_cmp_eq_u32 vcc, -1, v32
s_cbranch_vccnz mega_kernel_rs_pc_9_0f
v_smfmac_f32_16x16x64_bf16 v[96:99], v[32:35], a[192:199], v6
v_smfmac_f32_16x16x64_bf16 v[100:103], v[32:35], a[224:231], v6
s_branch mega_kernel_rs_pc_8_3
mega_kernel_rs_il49:
s_cbranch_execz mega_kernel_rs_il50
.p2align 5
mega_kernel_rs_pc_9_3f:
s_mov_b64 exec, vcc
buffer_load_dwordx4 v[44:47], v7, s[84:87], s29 offen offset:3072 sc1
s_mov_b64 exec, -1
s_branch mega_kernel_rs_pc_9_0
mega_kernel_rs_il50:
s_cbranch_execz mega_kernel_rs_il51
.p2align 5
mega_kernel_rs_pc_9_3:
s_waitcnt vmcnt(1)
v_cmp_eq_u32 vcc, -1, v44
s_cbranch_vccnz mega_kernel_rs_pc_9_3f
v_smfmac_f32_16x16x64_bf16 v[96:99], v[44:47], a[216:223], v6
v_smfmac_f32_16x16x64_bf16 v[100:103], v[44:47], a[248:255], v6
s_branch mega_kernel_rs_pc_1_0
.p2align 5
mega_kernel_rs_pc_10_1f:
s_mov_b64 exec, vcc
buffer_load_dwordx4 v[36:39], v7, s[84:87], s29 offen offset:1024 sc1
s_mov_b64 exec, -1
s_branch mega_kernel_rs_pc_10_3
mega_kernel_rs_il51:
s_cbranch_execz mega_kernel_rs_il52
.p2align 5
mega_kernel_rs_pc_10_1:
s_waitcnt vmcnt(1)
v_cmp_eq_u32 vcc, -1, v36
s_cbranch_vccnz mega_kernel_rs_pc_10_1f
v_smfmac_f32_16x16x64_bf16 v[96:99], v[36:39], a[200:207], v6
v_smfmac_f32_16x16x64_bf16 v[100:103], v[36:39], a[232:239], v6
s_branch mega_kernel_rs_pc_8_3
.p2align 5
mega_kernel_rs_pc_10_3f:
s_mov_b64 exec, vcc
buffer_load_dwordx4 v[44:47], v7, s[84:87], s29 offen offset:3072 sc1
s_mov_b64 exec, -1
s_branch mega_kernel_rs_pc_10_1
mega_kernel_rs_il52:
s_cbranch_execz mega_kernel_rs_il53
.p2align 5
mega_kernel_rs_pc_10_3:
s_waitcnt vmcnt(1)
v_cmp_eq_u32 vcc, -1, v44
s_cbranch_vccnz mega_kernel_rs_pc_10_3f
v_smfmac_f32_16x16x64_bf16 v[96:99], v[44:47], a[216:223], v6
v_smfmac_f32_16x16x64_bf16 v[100:103], v[44:47], a[248:255], v6
s_branch mega_kernel_rs_pc_2_1
.p2align 5
mega_kernel_rs_pc_11_0f:
s_mov_b64 exec, vcc
buffer_load_dwordx4 v[32:35], v7, s[84:87], s29 offen offset:0 sc1
s_mov_b64 exec, -1
s_branch mega_kernel_rs_pc_11_1
mega_kernel_rs_il53:
s_cbranch_execz mega_kernel_rs_il54
.p2align 5
mega_kernel_rs_pc_11_0:
s_waitcnt vmcnt(2)
v_cmp_eq_u32 vcc, -1, v32
s_cbranch_vccnz mega_kernel_rs_pc_11_0f
v_smfmac_f32_16x16x64_bf16 v[96:99], v[32:35], a[192:199], v6
v_smfmac_f32_16x16x64_bf16 v[100:103], v[32:35], a[224:231], v6
s_branch mega_kernel_rs_pc_10_1
.p2align 5
mega_kernel_rs_pc_11_1f:
s_mov_b64 exec, vcc
buffer_load_dwordx4 v[36:39], v7, s[84:87], s29 offen offset:1024 sc1
s_mov_b64 exec, -1
s_branch mega_kernel_rs_pc_11_3
mega_kernel_rs_il54:
s_cbranch_execz mega_kernel_rs_il55
.p2align 5
mega_kernel_rs_pc_11_1:
s_waitcnt vmcnt(2)
v_cmp_eq_u32 vcc, -1, v36
s_cbranch_vccnz mega_kernel_rs_pc_11_1f
v_smfmac_f32_16x16x64_bf16 v[96:99], v[36:39], a[200:207], v6
v_smfmac_f32_16x16x64_bf16 v[100:103], v[36:39], a[232:239], v6
s_branch mega_kernel_rs_pc_9_3
.p2align 5
mega_kernel_rs_pc_11_3f:
s_mov_b64 exec, vcc
buffer_load_dwordx4 v[44:47], v7, s[84:87], s29 offen offset:3072 sc1
s_mov_b64 exec, -1
s_branch mega_kernel_rs_pc_11_0
mega_kernel_rs_il55:
s_cbranch_execz mega_kernel_rs_il56
.p2align 5
mega_kernel_rs_pc_11_3:
s_waitcnt vmcnt(2)
v_cmp_eq_u32 vcc, -1, v44
s_cbranch_vccnz mega_kernel_rs_pc_11_3f
v_smfmac_f32_16x16x64_bf16 v[96:99], v[44:47], a[216:223], v6
v_smfmac_f32_16x16x64_bf16 v[100:103], v[44:47], a[248:255], v6
s_branch mega_kernel_rs_pc_3_0
.p2align 5
mega_kernel_rs_pc_12_2f:
s_mov_b64 exec, vcc
buffer_load_dwordx4 v[40:43], v7, s[84:87], s29 offen offset:2048 sc1
s_mov_b64 exec, -1
s_branch mega_kernel_rs_pc_12_3
mega_kernel_rs_il56:
s_cbranch_execz mega_kernel_rs_iwd
.p2align 5
mega_kernel_rs_pc_12_3f:
s_mov_b64 exec, vcc
buffer_load_dwordx4 v[44:47], v7, s[84:87], s29 offen offset:3072 sc1
s_mov_b64 exec, -1
s_branch mega_kernel_rs_pc_12_2
.p2align 5
mega_kernel_rs_pc_12_3:
s_waitcnt vmcnt(1)
v_cmp_eq_u32 vcc, -1, v44
s_cbranch_vccnz mega_kernel_rs_pc_12_3f
v_smfmac_f32_16x16x64_bf16 v[96:99], v[44:47], a[216:223], v6
v_smfmac_f32_16x16x64_bf16 v[100:103], v[44:47], a[248:255], v6
s_branch mega_kernel_rs_pc_4_2
mega_kernel_rs_iw3:
mega_kernel_rs_il57:
s_cbranch_execz mega_kernel_rs_il58
.p2align 5
mega_kernel_rs_pc_13_0f:
s_mov_b64 exec, vcc
buffer_load_dwordx4 v[32:35], v7, s[84:87], s29 offen offset:0 sc1
s_mov_b64 exec, -1
s_branch mega_kernel_rs_pc_13_2
mega_kernel_rs_il58:
s_cbranch_execz mega_kernel_rs_il59
.p2align 5
mega_kernel_rs_pc_13_0:
s_waitcnt vmcnt(2)
v_cmp_eq_u32 vcc, -1, v32
s_cbranch_vccnz mega_kernel_rs_pc_13_0f
v_smfmac_f32_16x16x64_bf16 v[96:99], v[32:35], a[192:199], v6
v_smfmac_f32_16x16x64_bf16 v[100:103], v[32:35], a[224:231], v6
s_branch mega_kernel_rs_pc_12_2
.p2align 5
mega_kernel_rs_pc_13_2f:
s_mov_b64 exec, vcc
buffer_load_dwordx4 v[40:43], v7, s[84:87], s29 offen offset:2048 sc1
s_mov_b64 exec, -1
s_branch mega_kernel_rs_pc_13_3
mega_kernel_rs_il59:
s_cbranch_execz mega_kernel_rs_il60
.p2align 5
mega_kernel_rs_pc_13_2:
s_waitcnt vmcnt(2)
v_cmp_eq_u32 vcc, -1, v40
s_cbranch_vccnz mega_kernel_rs_pc_13_2f
v_smfmac_f32_16x16x64_bf16 v[96:99], v[40:43], a[208:215], v6
v_smfmac_f32_16x16x64_bf16 v[100:103], v[40:43], a[240:247], v6
s_branch mega_kernel_rs_pc_9_3
.p2align 5
mega_kernel_rs_pc_13_3f:
s_mov_b64 exec, vcc
buffer_load_dwordx4 v[44:47], v7, s[84:87], s29 offen offset:3072 sc1
s_mov_b64 exec, -1
s_branch mega_kernel_rs_pc_13_0
mega_kernel_rs_il60:
s_cbranch_execz mega_kernel_rs_il61
.p2align 5
mega_kernel_rs_pc_13_3:
s_waitcnt vmcnt(2)
v_cmp_eq_u32 vcc, -1, v44
s_cbranch_vccnz mega_kernel_rs_pc_13_3f
v_smfmac_f32_16x16x64_bf16 v[96:99], v[44:47], a[216:223], v6
v_smfmac_f32_16x16x64_bf16 v[100:103], v[44:47], a[248:255], v6
s_branch mega_kernel_rs_pc_5_0
.p2align 5
mega_kernel_rs_pc_14_1f:
s_mov_b64 exec, vcc
buffer_load_dwordx4 v[36:39], v7, s[84:87], s29 offen offset:1024 sc1
s_mov_b64 exec, -1
s_branch mega_kernel_rs_pc_14_2
mega_kernel_rs_il61:
s_cbranch_execz mega_kernel_rs_il62
.p2align 5
mega_kernel_rs_pc_14_2f:
s_mov_b64 exec, vcc
buffer_load_dwordx4 v[40:43], v7, s[84:87], s29 offen offset:2048 sc1
s_mov_b64 exec, -1
s_branch mega_kernel_rs_pc_14_3
.p2align 5
mega_kernel_rs_pc_14_2:
s_waitcnt vmcnt(2)
v_cmp_eq_u32 vcc, -1, v40
s_cbranch_vccnz mega_kernel_rs_pc_14_2f
v_smfmac_f32_16x16x64_bf16 v[96:99], v[40:43], a[208:215], v6
v_smfmac_f32_16x16x64_bf16 v[100:103], v[40:43], a[240:247], v6
s_branch mega_kernel_rs_pc_10_3
mega_kernel_rs_il62:
s_cbranch_execz mega_kernel_rs_il63
.p2align 5
mega_kernel_rs_pc_14_3f:
s_mov_b64 exec, vcc
buffer_load_dwordx4 v[44:47], v7, s[84:87], s29 offen offset:3072 sc1
s_mov_b64 exec, -1
s_branch mega_kernel_rs_pc_14_1
mega_kernel_rs_il63:
s_cbranch_execz mega_kernel_rs_il64
.p2align 5
mega_kernel_rs_pc_14_3:
s_waitcnt vmcnt(2)
v_cmp_eq_u32 vcc, -1, v44
s_cbranch_vccnz mega_kernel_rs_pc_14_3f
v_smfmac_f32_16x16x64_bf16 v[96:99], v[44:47], a[216:223], v6
v_smfmac_f32_16x16x64_bf16 v[100:103], v[44:47], a[248:255], v6
s_branch mega_kernel_rs_pc_6_1
.p2align 5
mega_kernel_rs_pc_15_0f:
s_mov_b64 exec, vcc
buffer_load_dwordx4 v[32:35], v7, s[84:87], s29 offen offset:0 sc1
s_mov_b64 exec, -1
s_branch mega_kernel_rs_pc_15_1
mega_kernel_rs_il64:
s_cbranch_execz mega_kernel_rs_il65
.p2align 5
mega_kernel_rs_pc_15_1f:
s_mov_b64 exec, vcc
buffer_load_dwordx4 v[36:39], v7, s[84:87], s29 offen offset:1024 sc1
s_mov_b64 exec, -1
s_branch mega_kernel_rs_pc_15_2
.p2align 5
mega_kernel_rs_pc_15_1:
s_waitcnt vmcnt(3)
v_cmp_eq_u32 vcc, -1, v36
s_cbranch_vccnz mega_kernel_rs_pc_15_1f
v_smfmac_f32_16x16x64_bf16 v[96:99], v[36:39], a[200:207], v6
v_smfmac_f32_16x16x64_bf16 v[100:103], v[36:39], a[232:239], v6
s_branch mega_kernel_rs_pc_13_2
mega_kernel_rs_il65:
s_cbranch_execz mega_kernel_rs_il66
.p2align 5
mega_kernel_rs_pc_15_2f:
s_mov_b64 exec, vcc
buffer_load_dwordx4 v[40:43], v7, s[84:87], s29 offen offset:2048 sc1
s_mov_b64 exec, -1
s_branch mega_kernel_rs_pc_15_3
mega_kernel_rs_il66:
s_cbranch_execz mega_kernel_rs_il67
.p2align 5
mega_kernel_rs_pc_15_2:
s_waitcnt vmcnt(3)
v_cmp_eq_u32 vcc, -1, v40
s_cbranch_vccnz mega_kernel_rs_pc_15_2f
v_smfmac_f32_16x16x64_bf16 v[96:99], v[40:43], a[208:215], v6
v_smfmac_f32_16x16x64_bf16 v[100:103], v[40:43], a[240:247], v6
s_branch mega_kernel_rs_pc_11_3
.p2align 5
mega_kernel_rs_pc_15_3f:
s_mov_b64 exec, vcc
buffer_load_dwordx4 v[44:47], v7, s[84:87], s29 offen offset:3072 sc1
s_mov_b64 exec, -1
s_branch mega_kernel_rs_pc_15_0
mega_kernel_rs_il67:
s_cbranch_execz mega_kernel_rs_il68
.p2align 5
mega_kernel_rs_pc_15_3:
s_waitcnt vmcnt(3)
v_cmp_eq_u32 vcc, -1, v44
s_cbranch_vccnz mega_kernel_rs_pc_15_3f
v_smfmac_f32_16x16x64_bf16 v[96:99], v[44:47], a[216:223], v6
v_smfmac_f32_16x16x64_bf16 v[100:103], v[44:47], a[248:255], v6
s_branch mega_kernel_rs_pc_7_0
mega_kernel_rs_w0last:
s_nop 7
v_permlane32_swap_b32 v112, v116
v_permlane32_swap_b32 v113, v117
v_permlane32_swap_b32 v114, v118
v_permlane32_swap_b32 v115, v119
v_pk_add_f32 v[112:113], v[112:113], v[116:117]
v_pk_add_f32 v[114:115], v[114:115], v[118:119]
ds_write_b128 v20, v[112:115]
s_waitcnt lgkmcnt(0)
s_barrier
s_branch mega_kernel_rs_end
mega_kernel_rs_il68:
s_cbranch_execz mega_kernel_rs_il69
mega_kernel_rs_side:
s_cmp_eq_u32 s24, 3
s_cbranch_scc1 mega_kernel_rs_sd3
s_cmp_eq_u32 s24, 2
s_cbranch_scc0 mega_kernel_rs_sd4
s_mov_b64 exec, s[40:41]
buffer_store_dwordx4 v[28:31], v11, s[84:87], s34 offen sc1
s_mov_b64 exec, -1
buffer_store_dwordx2 v[28:29], v9, s[84:87], s34 offen sc1
s_mul_i32 s28, s31, 2048
s_add_u32 s28, s28, s34
s_add_u32 s28, s28, 49152
buffer_store_dwordx4 v[28:31], v17, s[84:87], s28 offen sc1
buffer_store_dwordx4 v[28:31], v10, s[84:87], s28 offen sc1
s_branch mega_kernel_rs_sd4
mega_kernel_rs_il69:
s_cbranch_execz mega_kernel_rs_il70
mega_kernel_rs_sd3:
v_readlane_b32 s76, v249, 0
v_readlane_b32 s77, v249, 1
s_min_i32 s76, s76, s77
s_max_i32 s46, s46, s76
s_mov_b32 s36, 0
s_add_u32 s76, s27, 1
s_cmp_lt_u32 s76, 63
s_cbranch_scc0 mega_kernel_rs_sd4
s_cmp_ge_u32 s76, 0
s_cbranch_scc0 mega_kernel_rs_sd4
s_cmp_gt_i32 s46, s76
s_cselect_b32 s36, 0, 1
s_cbranch_scc0 mega_kernel_rs_sd4
s_add_u32 s77, s76, s82
s_bfe_u32 s28, s77, 0x40002
s_lshl_b32 s28, s28, 14
s_and_b32 s77, s77, 3
s_lshl_b32 s77, s77, 11
s_add_u32 s28, s28, s77
s_add_u32 m0, s45, 0
s_nop 0
buffer_load_dwordx4 v240, s[84:87], s28 offen offset:0 sc1 lds
s_add_u32 m0, s45, 0
s_nop 0
buffer_load_dwordx4 v240, s[84:87], s28 offen offset:1024 sc1 lds
s_add_u32 m0, s45, 2048
s_nop 0
buffer_load_dwordx4 v241, s[84:87], s28 offen offset:0 sc1 lds
s_add_u32 m0, s45, 2048
s_nop 0
buffer_load_dwordx4 v241, s[84:87], s28 offen offset:1024 sc1 lds
s_add_u32 s45, s45, 4096
s_cmp_eq_u32 s45, 30720
s_cselect_b32 s45, 18432, s45
mega_kernel_rs_sd4:
v_smfmac_f32_16x16x64_bf16 v[112:115], v[40:43], a[144:151], v6
v_smfmac_f32_16x16x64_bf16 v[116:119], v[40:43], a[176:183], v6
v_smfmac_f32_16x16x64_bf16 v[112:115], v[44:47], a[152:159], v6
v_smfmac_f32_16x16x64_bf16 v[116:119], v[44:47], a[184:191], v6
s_nop 7
v_permlane32_swap_b32 v112, v116
v_permlane32_swap_b32 v113, v117
v_permlane32_swap_b32 v114, v118
v_permlane32_swap_b32 v115, v119
v_pk_add_f32 v[112:113], v[112:113], v[116:117]
v_pk_add_f32 v[114:115], v[114:115], v[118:119]
ds_write_b128 v20, v[112:115]
v_mov_b32 v96, 0
v_mov_b32 v97, 0
v_mov_b32 v98, 0
v_mov_b32 v99, 0
v_mov_b32 v100, 0
v_mov_b32 v101, 0
v_mov_b32 v102, 0
v_mov_b32 v103, 0
s_cmp_eq_u32 s24, 1
s_cbranch_scc0 mega_kernel_rs_s1
s_waitcnt lgkmcnt(0)
ds_read_b128 v[120:123], v16 offset:0
ds_read_b128 v[124:127], v16 offset:16
ds_read_b128 v[128:131], v16 offset:2304
ds_read_b128 v[132:135], v16 offset:2320
ds_read_b128 v[136:139], v16 offset:4608
ds_read_b128 v[140:143], v16 offset:4624
ds_read_b128 v[144:147], v16 offset:6912
ds_read_b128 v[148:151], v16 offset:6928
s_waitcnt lgkmcnt(4)
v_pk_add_f32 v[120:121], v[120:121], v[128:129]
v_pk_add_f32 v[122:123], v[122:123], v[130:131]
v_pk_add_f32 v[124:125], v[124:125], v[132:133]
v_pk_add_f32 v[126:127], v[126:127], v[134:135]
s_waitcnt lgkmcnt(0)
v_pk_add_f32 v[136:137], v[136:137], v[144:145]
v_pk_add_f32 v[138:139], v[138:139], v[146:147]
v_pk_add_f32 v[140:141], v[140:141], v[148:149]
v_pk_add_f32 v[142:143], v[142:143], v[150:151]
v_pk_add_f32 v[120:121], v[120:121], v[136:137]
v_pk_add_f32 v[122:123], v[122:123], v[138:139]
v_pk_add_f32 v[124:125], v[124:125], v[140:141]
v_pk_add_f32 v[126:127], v[126:127], v[142:143]
v_cvt_pk_bf16_f32 v244, v120, v121
v_cvt_pk_bf16_f32 v245, v122, v123
v_cvt_pk_bf16_f32 v246, v124, v125
v_cvt_pk_bf16_f32 v247, v126, v127
mega_kernel_rs_s1:
v_add_u32 v5, 9216, v17
s_waitcnt lgkmcnt(0)
s_barrier
s_cmp_eq_u32 s24, 2
s_cbranch_scc1 mega_kernel_rs_s2
s_cmp_eq_u32 s24, 3
s_cbranch_scc0 mega_kernel_rs_s3
s_add_u32 s76, s27, 2
s_cmp_lt_u32 s76, 63
s_cbranch_scc0 mega_kernel_rs_s3
s_cmp_gt_i32 s46, s76
s_cbranch_scc0 mega_kernel_rs_s3
s_add_u32 s77, s76, s82
s_bfe_u32 s28, s77, 0x40002
s_lshl_b32 s28, s28, 14
s_and_b32 s77, s77, 3
s_lshl_b32 s77, s77, 11
s_add_u32 s28, s28, s77
s_add_u32 s28, s28, s83
s_buffer_load_dword s78, s[84:87], s28 offset:0
s_buffer_load_dword s78, s[84:87], s28 offset:128
s_buffer_load_dword s78, s[84:87], s28 offset:256
s_buffer_load_dword s78, s[84:87], s28 offset:384
s_buffer_load_dword s78, s[84:87], s28 offset:512
s_buffer_load_dword s78, s[84:87], s28 offset:640
s_buffer_load_dword s78, s[84:87], s28 offset:768
s_buffer_load_dword s78, s[84:87], s28 offset:896
s_buffer_load_dword s78, s[84:87], s28 offset:1024
s_buffer_load_dword s78, s[84:87], s28 offset:1152
s_buffer_load_dword s78, s[84:87], s28 offset:1280
s_buffer_load_dword s78, s[84:87], s28 offset:1408
s_buffer_load_dword s78, s[84:87], s28 offset:1536
s_buffer_load_dword s78, s[84:87], s28 offset:1664
s_buffer_load_dword s78, s[84:87], s28 offset:1792
s_buffer_load_dword s78, s[84:87], s28 offset:1920
s_mov_b32 s88, s76
s_branch mega_kernel_rs_s3
mega_kernel_rs_il70:
s_cbranch_execz mega_kernel_rs_il71
mega_kernel_rs_s2:
ds_read_b128 v[120:123], v5 offset:0
ds_read_b128 v[124:127], v5 offset:1024
ds_read_b128 v[128:131], v5 offset:2048
ds_read_b128 v[132:135], v5 offset:3072
v_lshrrev_b32 v5, 1, v17
s_waitcnt lgkmcnt(2)
v_pk_add_f32 v[120:121], v[120:121], v[124:125]
v_pk_add_f32 v[122:123], v[122:123], v[126:127]
s_waitcnt lgkmcnt(0)
v_pk_add_f32 v[128:129], v[128:129], v[132:133]
v_pk_add_f32 v[130:131], v[130:131], v[134:135]
v_pk_add_f32 v[120:121], v[120:121], v[128:129]
v_pk_add_f32 v[122:123], v[122:123], v[130:131]
v_cvt_pk_bf16_f32 v244, v120, v121
v_cvt_pk_bf16_f32 v245, v122, v123
ds_write_b64 v5, v[244:245] offset:17920
s_waitcnt lgkmcnt(0) vmcnt(0)
mega_kernel_rs_s3:
s_cmp_eq_u32 s27, 63
s_cbranch_scc1 mega_kernel_rs_slast
s_add_u32 s29, s33, 24576
s_barrier
s_cmp_eq_u32 s24, 3
s_cbranch_scc1 mega_kernel_rs_y3
s_add_u32 s77, s27, s82
s_bfe_u32 s28, s77, 0x30003
s_lshl_b32 s28, s28, 14
s_and_b32 s77, s77, 7
s_lshl_b32 s77, s77, 10
s_add_u32 s28, s28, s77
s_add_u32 s28, s28, s79
s_cmp_eq_u32 s24, 2
s_cbranch_scc1 mega_kernel_rs_kv2a
s_mov_b64 exec, s[48:49]
buffer_store_dwordx4 v[244:247], v22, s[84:87], s28 offen sc1
s_mov_b64 exec, -1
s_branch mega_kernel_rs_kvda
mega_kernel_rs_il71:
s_cbranch_execz mega_kernel_rs_il72
mega_kernel_rs_kv2a:
v_lshlrev_b32 v4, 3, v1
buffer_store_dwordx2 v[244:245], v4, s[84:87], s28 offen offset:512 sc1
mega_kernel_rs_kvda:
s_branch mega_kernel_rs_y4
mega_kernel_rs_y3:
s_add_u32 s76, s27, 2
s_cmp_lt_u32 s76, 63
s_cbranch_scc0 mega_kernel_rs_y4
mega_kernel_rs_y4:
s_branch mega_kernel_rs_b3
mega_kernel_rs_first:
v_add_u32 v5, s44, v17
ds_read_b128 v[156:159], v5 offset:0
ds_read_b128 v[160:163], v5 offset:1024
ds_read_b128 v[164:167], v5 offset:2048
ds_read_b128 v[168:171], v5 offset:3072
s_branch mega_kernel_rs_adone
mega_kernel_rs_il72:
s_cbranch_execz mega_kernel_rs_il73
mega_kernel_rs_slast:
s_cmp_eq_u32 s24, 3
s_cbranch_scc1 mega_kernel_rs_end
s_add_u32 s77, s27, s82
s_bfe_u32 s28, s77, 0x30003
s_lshl_b32 s28, s28, 14
s_and_b32 s77, s77, 7
s_lshl_b32 s77, s77, 10
s_add_u32 s28, s28, s77
s_add_u32 s28, s28, s79
s_cmp_eq_u32 s24, 2
s_cbranch_scc1 mega_kernel_rs_kv2b
s_mov_b64 exec, s[48:49]
buffer_store_dwordx4 v[244:247], v22, s[84:87], s28 offen sc1
s_mov_b64 exec, -1
s_branch mega_kernel_rs_kvdb
mega_kernel_rs_il73:
s_cbranch_execz mega_kernel_rs_iwd
mega_kernel_rs_kv2b:
v_lshlrev_b32 v4, 3, v1
buffer_store_dwordx2 v[244:245], v4, s[84:87], s28 offen offset:512 sc1
mega_kernel_rs_kvdb:
s_waitcnt vmcnt(0)
s_barrier
s_mov_b32 s76, 64
s_cmp_eq_u32 s24, 1
s_cbranch_scc0 mega_kernel_rs_end
v_mov_b32 v5, s76
s_mov_b64 exec, 1
buffer_store_dword v5, v228, s[84:87], s81 offen sc1
s_mov_b64 exec, -1
mega_kernel_rs_end:
s_endpgm
.section .rodata,"a"
.p2align 6
.amdhsa_kernel mega_kernel
  .amdhsa_next_free_vgpr 512
  .amdhsa_next_free_sgpr 102
  .amdhsa_accum_offset 256
  .amdhsa_group_segment_fixed_size 0
  .amdhsa_kernarg_size 104
  .amdhsa_user_sgpr_count 2
  .amdhsa_user_sgpr_kernarg_segment_ptr 1
  .amdhsa_system_sgpr_workgroup_id_x 1
.end_amdhsa_kernel
```

```asm
; @launch kernel=mega_kernel grid=(256,1,1) block=(256,1,1) lds=163840
.amdgcn_target "amdgcn-amd-amdhsa--gfx950"
.text
.globl mega_kernel
.p2align 8
.type mega_kernel,@function
mega_kernel:
s_cmp_ge_u32 s2, 256
s_cbranch_scc1 mega_kernel_exit
s_load_dwordx2 s[84:85], s[0:1], 96
s_load_dwordx2 s[72:73], s[0:1], 88
s_getreg_b32 s90, hwreg(HW_REG_XCC_ID)
s_and_b32 s90, s90, 7
v_mov_b32 v1, 0
v_mov_b32 v2, 1
s_lshl_b32 s91, s90, 4
s_mov_b32 s95, 0
s_mov_b32 s99, 0
s_waitcnt lgkmcnt(0)
s_mov_b32 s86, 268435456
s_mov_b32 s87, 0x00020000
s_mov_b32 s74, 256
s_mov_b32 s75, 0x00020000
v_cmp_eq_u32 vcc, 0, v0
s_and_saveexec_b64 s[88:89], vcc
s_cbranch_execz mega_kernel_tkd
s_lshl_b32 s92, s2, 13
s_add_u32 s92, s92, 167772160
buffer_atomic_add v2, v1, s[72:75], s91 offen sc0
buffer_load_dword v251, v1, s[84:87], s92 offen offset:2048 sc1
s_waitcnt vmcnt(1)
ds_write_b32 v1, v2
s_waitcnt lgkmcnt(0)
mega_kernel_tkd:
s_mov_b64 exec, s[88:89]
s_barrier
ds_read_b32 v2, v1
s_waitcnt lgkmcnt(0)
v_readfirstlane_b32 s96, v2
s_barrier
s_cmp_lt_u32 s96, 32
s_cbranch_scc1 mega_kernel_spec
v_and_b32 v3, 15, v0
v_lshlrev_b32 v3, 4, v3
s_branch mega_kernel_syx
mega_kernel_syxw:
s_sleep 4
mega_kernel_syx:
buffer_load_dword v2, v3, s[72:75], 0 offen sc1
s_waitcnt vmcnt(0)
mega_kernel_syxp:
s_cmp_eq_u32 s95, 1
s_cbranch_scc0 mega_kernel_syxf
v_readlane_b32 s76, v2, 14
s_mov_b32 s98, 0
s_cmp_eq_u32 s76, 32
s_cbranch_scc0 mega_kernel_syxw
s_branch mega_kernel_syxd
mega_kernel_syxf:
s_mov_b32 s77, 0
s_mov_b32 s78, 0
v_readlane_b32 s76, v2, 0
s_add_u32 s77, s77, s76
s_xor_b32 s76, s76, 32
s_or_b32 s78, s78, s76
v_readlane_b32 s76, v2, 1
s_add_u32 s77, s77, s76
s_xor_b32 s76, s76, 32
s_or_b32 s78, s78, s76
v_readlane_b32 s76, v2, 2
s_add_u32 s77, s77, s76
s_xor_b32 s76, s76, 32
s_or_b32 s78, s78, s76
v_readlane_b32 s76, v2, 3
s_add_u32 s77, s77, s76
s_xor_b32 s76, s76, 32
s_or_b32 s78, s78, s76
v_readlane_b32 s76, v2, 4
s_add_u32 s77, s77, s76
s_xor_b32 s76, s76, 32
s_or_b32 s78, s78, s76
v_readlane_b32 s76, v2, 5
s_add_u32 s77, s77, s76
s_xor_b32 s76, s76, 32
s_or_b32 s78, s78, s76
v_readlane_b32 s76, v2, 6
s_add_u32 s77, s77, s76
s_xor_b32 s76, s76, 32
s_or_b32 s78, s78, s76
v_readlane_b32 s76, v2, 7
s_add_u32 s77, s77, s76
s_xor_b32 s76, s76, 32
s_or_b32 s78, s78, s76
s_cmp_eq_u32 s77, 256
s_cbranch_scc0 mega_kernel_syxw
v_mov_b32 v252, v2
s_cmp_eq_u32 s78, 0
s_cbranch_scc0 mega_kernel_slowent
v_readlane_b32 s76, v2, 10
v_readlane_b32 s77, v2, 8
s_cmp_eq_u32 s76, 32
s_cbranch_scc0 mega_kernel_syxw
s_cmp_gt_u32 s77, 16
s_cselect_b32 s98, 1, 0
mega_kernel_syxd:
mega_kernel_slowent:
s_mov_b64 exec, -1
s_waitcnt vmcnt(0) lgkmcnt(0)
s_barrier
s_mov_b32 s97, s96
v_readlane_b32 s76, v252, 0
s_cmp_gt_u32 s90, 0
s_cselect_b32 s76, s76, 0
s_add_u32 s97, s97, s76
v_readlane_b32 s76, v252, 1
s_cmp_gt_u32 s90, 1
s_cselect_b32 s76, s76, 0
s_add_u32 s97, s97, s76
v_readlane_b32 s76, v252, 2
s_cmp_gt_u32 s90, 2
s_cselect_b32 s76, s76, 0
s_add_u32 s97, s97, s76
v_readlane_b32 s76, v252, 3
s_cmp_gt_u32 s90, 3
s_cselect_b32 s76, s76, 0
s_add_u32 s97, s97, s76
v_readlane_b32 s76, v252, 4
s_cmp_gt_u32 s90, 4
s_cselect_b32 s76, s76, 0
s_add_u32 s97, s97, s76
v_readlane_b32 s76, v252, 5
s_cmp_gt_u32 s90, 5
s_cselect_b32 s76, s76, 0
s_add_u32 s97, s97, s76
v_readlane_b32 s76, v252, 6
s_cmp_gt_u32 s90, 6
s_cselect_b32 s76, s76, 0
s_add_u32 s97, s97, s76
v_mov_b32 v1, 0
v_mov_b32 v2, 1
v_cmp_eq_u32 vcc, 0, v0
s_and_saveexec_b64 s[88:89], vcc
s_cbranch_execz mega_kernel_sb1
buffer_atomic_add v2, v1, s[72:75], 0 offen offset:192 sc1
mega_kernel_sb1:
s_mov_b64 exec, s[88:89]
mega_kernel_sb2:
s_sleep 4
buffer_load_dword v2, v1, s[72:75], 0 offen offset:192 sc1
s_waitcnt vmcnt(0)
v_cmp_ne_u32 vcc, 256, v2
s_cbranch_vccnz mega_kernel_sb2
s_mov_b32 s95, 1
s_lshr_b32 s30, s97, 5
s_and_b32 s31, s97, 31
s_cmp_lt_u32 s97, 128
s_cbranch_scc1 mega_kernel_recs
s_sub_u32 s94, s97, 128
s_branch mega_kernel_bulk
mega_kernel_spec:
s_mov_b32 s30, s90
s_mov_b32 s31, s96
s_cmp_lt_u32 s90, 4
s_cbranch_scc1 mega_kernel_recf
s_sub_u32 s94, s90, 4
s_lshl_b32 s94, s94, 5
s_add_u32 s94, s94, s96
mega_kernel_bulk:
s_lshr_b32 s91, s94, 5
s_and_b32 s40, s94, 31
s_and_b32 s92, s91, 1
s_lshl_b32 s92, s92, 5
s_add_u32 s92, s92, s40
s_cmp_eq_u32 s91, 0
s_cbranch_scc1 mega_kernel_rk
s_cmp_eq_u32 s91, 1
s_cbranch_scc1 mega_kernel_rv
s_cmp_eq_u32 s91, 2
s_cbranch_scc1 mega_kernel_noinit
v_mov_b32 v8, -1
v_mov_b32 v9, -1
v_mov_b32 v10, -1
v_mov_b32 v11, -1
v_lshlrev_b32 v1, 4, v0
v_mov_b32 v2, 0
v_cmp_gt_u32 vcc, 64, v0
s_cbranch_vccz mega_kernel_nv
s_cmp_eq_u32 s95, 0
s_cbranch_scc0 mega_kernel_nv
s_lshr_b32 s60, s2, 1
s_lshl_b32 s60, s60, 14
s_and_b32 s61, s40, 1
s_lshl_b32 s66, s61, 13
s_add_u32 s60, s60, s66
s_and_b32 s66, s2, 1
s_lshl_b32 s66, s66, 10
s_add_u32 s60, s60, s66
s_add_u32 s60, s60, 167772160
s_mov_b32 s66, 0x7fffffff
s_mov_b32 s67, 0x7fffffff
s_mov_b64 exec, 0xff
s_waitcnt vmcnt(0)
s_memtime s[62:63]
s_waitcnt lgkmcnt(0)
buffer_store_dwordx4 v[8:11], v1, s[84:87], s60 offen offset:0 sc1
s_waitcnt vmcnt(0)
s_memtime s[64:65]
s_xor_b32 s60, s60, 8192
s_waitcnt lgkmcnt(0)
s_sub_u32 s64, s64, s62
s_min_u32 s66, s66, s64
s_memtime s[62:63]
s_waitcnt lgkmcnt(0)
buffer_store_dwordx4 v[8:11], v1, s[84:87], s60 offen offset:0 sc1
s_waitcnt vmcnt(0)
s_memtime s[64:65]
s_xor_b32 s60, s60, 8192
s_waitcnt lgkmcnt(0)
s_sub_u32 s64, s64, s62
s_min_u32 s67, s67, s64
s_memtime s[62:63]
s_waitcnt lgkmcnt(0)
buffer_store_dwordx4 v[8:11], v1, s[84:87], s60 offen offset:256 sc1
s_waitcnt vmcnt(0)
s_memtime s[64:65]
s_xor_b32 s60, s60, 8192
s_waitcnt lgkmcnt(0)
s_sub_u32 s64, s64, s62
s_min_u32 s66, s66, s64
s_memtime s[62:63]
s_waitcnt lgkmcnt(0)
buffer_store_dwordx4 v[8:11], v1, s[84:87], s60 offen offset:256 sc1
s_waitcnt vmcnt(0)
s_memtime s[64:65]
s_xor_b32 s60, s60, 8192
s_waitcnt lgkmcnt(0)
s_sub_u32 s64, s64, s62
s_min_u32 s67, s67, s64
s_cmp_lt_u32 s67, s66
s_cselect_b32 s60, 1, 0
s_xor_b32 s60, s60, s61
s_lshr_b32 s61, s90, 2
s_xor_b32 s60, s60, s61
v_mov_b32 v3, s60
s_mov_b64 exec, 1
buffer_atomic_add v3, v2, s[72:75], 0 offen offset:128 sc1
s_mov_b64 exec, -1
mega_kernel_nv:
s_barrier
s_lshl_b32 s60, s40, 12
s_add_u32 s60, s60, 67108864
buffer_store_dwordx4 v[8:11], v1, s[84:87], s60 offen sc1
s_add_u32 s60, s60, 131072
buffer_store_dwordx4 v[8:11], v1, s[84:87], s60 offen sc1
s_add_u32 s60, s60, 131072
buffer_store_dwordx4 v[8:11], v1, s[84:87], s60 offen sc1
s_add_u32 s60, s60, 131072
buffer_store_dwordx4 v[8:11], v1, s[84:87], s60 offen sc1
s_add_u32 s60, s60, 131072
buffer_store_dwordx4 v[8:11], v1, s[84:87], s60 offen sc1
s_add_u32 s60, s60, 131072
buffer_store_dwordx4 v[8:11], v1, s[84:87], s60 offen sc1
s_add_u32 s60, s60, 131072
buffer_store_dwordx4 v[8:11], v1, s[84:87], s60 offen sc1
s_add_u32 s60, s60, 131072
buffer_store_dwordx4 v[8:11], v1, s[84:87], s60 offen sc1
s_add_u32 s60, s60, 131072
buffer_store_dwordx4 v[8:11], v1, s[84:87], s60 offen sc1
s_add_u32 s60, s60, 131072
buffer_store_dwordx4 v[8:11], v1, s[84:87], s60 offen sc1
s_add_u32 s60, s60, 131072
buffer_store_dwordx4 v[8:11], v1, s[84:87], s60 offen sc1
s_add_u32 s60, s60, 131072
buffer_store_dwordx4 v[8:11], v1, s[84:87], s60 offen sc1
s_add_u32 s60, s60, 131072
buffer_store_dwordx4 v[8:11], v1, s[84:87], s60 offen sc1
s_add_u32 s60, s60, 131072
buffer_store_dwordx4 v[8:11], v1, s[84:87], s60 offen sc1
s_add_u32 s60, s60, 131072
buffer_store_dwordx4 v[8:11], v1, s[84:87], s60 offen sc1
s_add_u32 s60, s60, 131072
buffer_store_dwordx4 v[8:11], v1, s[84:87], s60 offen sc1
s_add_u32 s60, s60, 131072
s_lshr_b32 s62, s40, 1
s_and_b32 s63, s40, 1
s_add_u32 s63, s63, s62
s_lshl_b32 s62, s62, 19
s_and_b32 s64, s63, 14
s_lshl_b32 s64, s64, 13
s_add_u32 s62, s62, s64
s_and_b32 s64, s63, 1
s_lshl_b32 s64, s64, 12
s_add_u32 s62, s62, s64
s_add_u32 s62, s62, 150994944
s_add_u32 s62, s62, 8192
s_cmp_lt_u32 s40, 16
s_cbranch_scc0 mega_kernel_pz
buffer_store_dwordx4 v[8:11], v1, s[84:87], s60 offen sc1
mega_kernel_pz:
s_waitcnt vmcnt(0)
s_barrier
v_mov_b32 v3, 1
s_lshl_b32 s62, s95, 6
v_cmp_eq_u32 vcc, 0, v0
s_and_saveexec_b64 s[60:61], vcc
s_cbranch_execz mega_kernel_xps
buffer_atomic_add v3, v2, s[72:75], s62 offen offset:160 sc1
mega_kernel_xps:
s_mov_b64 exec, s[60:61]
mega_kernel_noinit:
s_cmp_eq_u32 s91, 2
s_cbranch_scc1 mega_kernel_nohold
v_and_b32 v3, 15, v0
v_lshlrev_b32 v3, 4, v3
s_branch mega_kernel_syh
mega_kernel_syhw:
s_sleep 4
mega_kernel_syh:
buffer_load_dword v2, v3, s[72:75], 0 offen sc1
s_waitcnt vmcnt(0)
mega_kernel_syhp:
s_cmp_eq_u32 s95, 1
s_cbranch_scc0 mega_kernel_syhf
v_readlane_b32 s76, v2, 14
s_mov_b32 s98, 0
s_cmp_eq_u32 s76, 32
s_cbranch_scc0 mega_kernel_syhw
s_branch mega_kernel_syhd
mega_kernel_syhf:
s_mov_b32 s77, 0
s_mov_b32 s78, 0
v_readlane_b32 s76, v2, 0
s_add_u32 s77, s77, s76
s_xor_b32 s76, s76, 32
s_or_b32 s78, s78, s76
v_readlane_b32 s76, v2, 1
s_add_u32 s77, s77, s76
s_xor_b32 s76, s76, 32
s_or_b32 s78, s78, s76
v_readlane_b32 s76, v2, 2
s_add_u32 s77, s77, s76
s_xor_b32 s76, s76, 32
s_or_b32 s78, s78, s76
v_readlane_b32 s76, v2, 3
s_add_u32 s77, s77, s76
s_xor_b32 s76, s76, 32
s_or_b32 s78, s78, s76
v_readlane_b32 s76, v2, 4
s_add_u32 s77, s77, s76
s_xor_b32 s76, s76, 32
s_or_b32 s78, s78, s76
v_readlane_b32 s76, v2, 5
s_add_u32 s77, s77, s76
s_xor_b32 s76, s76, 32
s_or_b32 s78, s78, s76
v_readlane_b32 s76, v2, 6
s_add_u32 s77, s77, s76
s_xor_b32 s76, s76, 32
s_or_b32 s78, s78, s76
v_readlane_b32 s76, v2, 7
s_add_u32 s77, s77, s76
s_xor_b32 s76, s76, 32
s_or_b32 s78, s78, s76
s_cmp_eq_u32 s77, 256
s_cbranch_scc0 mega_kernel_syhw
v_mov_b32 v252, v2
s_cmp_eq_u32 s78, 0
s_cbranch_scc0 mega_kernel_slowent
v_readlane_b32 s76, v2, 10
v_readlane_b32 s77, v2, 8
s_cmp_eq_u32 s76, 32
s_cbranch_scc0 mega_kernel_syhw
s_cmp_gt_u32 s77, 16
s_cselect_b32 s98, 1, 0
mega_kernel_syhd:
s_xor_b32 s76, s98, 1
s_lshl_b32 s76, s76, 13
s_lshl_b32 s77, s40, 7
s_add_u32 s76, s76, s77
s_add_u32 s76, s76, 69206016
v_mov_b32 v1, 0
mega_kernel_hold:
s_sleep 12
buffer_load_dword v2, v1, s[84:87], s76 offen sc1
s_waitcnt vmcnt(0)
v_cmp_gt_i32 vcc, 1, v2
s_cbranch_vccnz mega_kernel_hold
mega_kernel_nohold:
s_cmp_eq_u32 s91, 2
s_cbranch_scc0 mega_kernel_rd
s_load_dwordx2 s[4:5], s[0:1], 16
s_load_dwordx2 s[8:9], s[0:1], 0
v_lshrrev_b32 v2, 6, v0
v_and_b32 v1, 63, v0
v_readfirstlane_b32 s41, v2
v_lshlrev_b32 v5, 4, v1
s_waitcnt lgkmcnt(0)
s_mov_b32 s6, 8388608
s_mov_b32 s7, 0x00020000
s_mov_b32 s10, 4194304
s_mov_b32 s11, 0x00020000
s_lshl_b32 s43, s40, 8
s_lshl_b32 s44, s41, 6
s_add_u32 s48, s43, s44
s_and_b32 s43, s48, 0x7ff
v_add_u32 v19, s43, v1
v_lshlrev_b32 v19, 7, v19
s_mov_b32 s43, 0
buffer_load_dword v250, v19, s[8:11], s43 offen
s_nop 0
v_lshrrev_b32 v2, 3, v1
s_lshl_b32 s43, s41, 3
v_add_u32 v2, s43, v2
v_bfe_u32 v3, v2, 1, 3
v_and_b32 v4, 7, v1
v_xor_b32 v3, v3, v4
v_lshlrev_b32 v6, 11, v2
v_lshl_add_u32 v6, v3, 4, v6
s_lshl_b32 s46, s41, 10
v_and_b32 v2, 15, v1
v_bfe_u32 v3, v2, 1, 3
v_lshrrev_b32 v4, 4, v1
v_xor_b32 v3, v3, v4
v_lshlrev_b32 v8, 7, v2
v_lshl_add_u32 v8, v3, 4, v8
v_xor_b32 v9, 64, v8
v_add_u32 v10, 0x10000, v8
v_add_u32 v11, 0x10000, v9
v_mov_b32 v7, v5
s_lshl_b32 s47, s40, 2
s_add_u32 s47, s47, s41
s_mov_b32 s42, 0
s_mov_b32 s50, 0
s_add_u32 m0, s46, 0
s_nop 0
buffer_load_dwordx4 v6, s[8:11], s50 offen offset:0 lds
s_add_u32 m0, s46, 3968
s_nop 0
buffer_load_dwordx4 v6, s[8:11], s50 offen offset:128 lds
s_add_u32 m0, s46, 7936
s_nop 0
buffer_load_dwordx4 v6, s[8:11], s50 offen offset:256 lds
s_add_u32 m0, s46, 11904
s_nop 0
buffer_load_dwordx4 v6, s[8:11], s50 offen offset:384 lds
s_add_u32 m0, s46, 15872
s_nop 0
buffer_load_dwordx4 v6, s[8:11], s50 offen offset:512 lds
s_add_u32 m0, s46, 19840
s_nop 0
buffer_load_dwordx4 v6, s[8:11], s50 offen offset:640 lds
s_add_u32 m0, s46, 23808
s_nop 0
buffer_load_dwordx4 v6, s[8:11], s50 offen offset:768 lds
s_add_u32 m0, s46, 27776
s_nop 0
buffer_load_dwordx4 v6, s[8:11], s50 offen offset:896 lds
s_add_u32 m0, s46, 31744
s_nop 0
buffer_load_dwordx4 v6, s[8:11], s50 offen offset:1024 lds
s_add_u32 m0, s46, 35712
s_nop 0
buffer_load_dwordx4 v6, s[8:11], s50 offen offset:1152 lds
s_add_u32 m0, s46, 39680
s_nop 0
buffer_load_dwordx4 v6, s[8:11], s50 offen offset:1280 lds
s_add_u32 m0, s46, 43648
s_nop 0
buffer_load_dwordx4 v6, s[8:11], s50 offen offset:1408 lds
s_add_u32 m0, s46, 47616
s_nop 0
buffer_load_dwordx4 v6, s[8:11], s50 offen offset:1536 lds
s_add_u32 m0, s46, 51584
s_nop 0
buffer_load_dwordx4 v6, s[8:11], s50 offen offset:1664 lds
s_add_u32 m0, s46, 55552
s_nop 0
buffer_load_dwordx4 v6, s[8:11], s50 offen offset:1792 lds
s_add_u32 m0, s46, 59520
s_nop 0
buffer_load_dwordx4 v6, s[8:11], s50 offen offset:1920 lds
v_lshrrev_b32 v2, 2, v1
v_and_b32 v3, 3, v1
v_lshlrev_b32 v16, 13, v2
v_lshl_add_u32 v16, v3, 4, v16
v_add_u32 v16, s48, v16
s_mul_i32 s45, s41, 24576
s_add_u32 s45, s45, 65536
v_bfe_u32 v17, v1, 2, 2
v_lshrrev_b32 v18, 4, v1
v_lshl_add_u32 v17, v18, 3, v17
v_lshlrev_b32 v17, 6, v17
v_lshl_add_u32 v17, v3, 4, v17
v_add_u32 v17, s45, v17
s_and_b32 s43, s40, 3
s_lshl_b32 s43, s43, 2
s_add_u32 s43, s43, s41
s_lshl_b32 s43, s43, 3
v_and_b32 v12, 7, v1
v_add_u32 v12, s43, v12
s_lshr_b32 s43, s40, 2
s_lshl_b32 s43, s43, 10
s_add_u32 s44, s43, 896
s_add_u32 s43, s43, 384
s_cmp_ge_u32 s40, 28
s_cselect_b32 s44, s44, s43
v_mov_b32 v13, s43
v_mov_b32 v14, s44
v_cmp_gt_u32 vcc, 32, v1
s_nop 1
v_cndmask_b32 v13, v14, v13, vcc
v_lshl_add_u32 v12, v12, 13, v13
s_mov_b32 s44, 0
buffer_load_dword v250, v12, s[4:7], s44 offen
s_add_u32 m0, s45, 0
s_mov_b32 s44, 0
buffer_load_dwordx4 v16, s[4:7], s44 offen lds
s_add_u32 m0, s45, 1024
s_mov_b32 s44, 131072
buffer_load_dwordx4 v16, s[4:7], s44 offen lds
s_add_u32 m0, s45, 2048
s_mov_b32 s44, 262144
buffer_load_dwordx4 v16, s[4:7], s44 offen lds
s_add_u32 m0, s45, 3072
s_mov_b32 s44, 393216
buffer_load_dwordx4 v16, s[4:7], s44 offen lds
s_add_u32 m0, s45, 4096
s_mov_b32 s44, 524288
buffer_load_dwordx4 v16, s[4:7], s44 offen lds
s_add_u32 m0, s45, 5120
s_mov_b32 s44, 655360
buffer_load_dwordx4 v16, s[4:7], s44 offen lds
s_add_u32 m0, s45, 6144
s_mov_b32 s44, 786432
buffer_load_dwordx4 v16, s[4:7], s44 offen lds
s_add_u32 m0, s45, 7168
s_mov_b32 s44, 917504
buffer_load_dwordx4 v16, s[4:7], s44 offen lds
s_mov_b32 s44, 1048576
buffer_load_dword v250, v12, s[4:7], s44 offen
s_add_u32 m0, s45, 8192
s_mov_b32 s44, 1048576
buffer_load_dwordx4 v16, s[4:7], s44 offen lds
s_add_u32 m0, s45, 9216
s_mov_b32 s44, 1179648
buffer_load_dwordx4 v16, s[4:7], s44 offen lds
s_add_u32 m0, s45, 10240
s_mov_b32 s44, 1310720
buffer_load_dwordx4 v16, s[4:7], s44 offen lds
s_add_u32 m0, s45, 11264
s_mov_b32 s44, 1441792
buffer_load_dwordx4 v16, s[4:7], s44 offen lds
s_add_u32 m0, s45, 12288
s_mov_b32 s44, 1572864
buffer_load_dwordx4 v16, s[4:7], s44 offen lds
s_add_u32 m0, s45, 13312
s_mov_b32 s44, 1703936
buffer_load_dwordx4 v16, s[4:7], s44 offen lds
s_add_u32 m0, s45, 14336
s_mov_b32 s44, 1835008
buffer_load_dwordx4 v16, s[4:7], s44 offen lds
s_add_u32 m0, s45, 15360
s_mov_b32 s44, 1966080
buffer_load_dwordx4 v16, s[4:7], s44 offen lds
s_mov_b32 s44, 2097152
buffer_load_dword v250, v12, s[4:7], s44 offen
s_add_u32 m0, s45, 16384
s_mov_b32 s44, 2097152
buffer_load_dwordx4 v16, s[4:7], s44 offen lds
s_add_u32 m0, s45, 17408
s_mov_b32 s44, 2228224
buffer_load_dwordx4 v16, s[4:7], s44 offen lds
s_add_u32 m0, s45, 18432
s_mov_b32 s44, 2359296
buffer_load_dwordx4 v16, s[4:7], s44 offen lds
s_add_u32 m0, s45, 19456
s_mov_b32 s44, 2490368
buffer_load_dwordx4 v16, s[4:7], s44 offen lds
s_add_u32 m0, s45, 20480
s_mov_b32 s44, 2621440
buffer_load_dwordx4 v16, s[4:7], s44 offen lds
s_add_u32 m0, s45, 21504
s_mov_b32 s44, 2752512
buffer_load_dwordx4 v16, s[4:7], s44 offen lds
s_add_u32 m0, s45, 22528
s_mov_b32 s44, 2883584
buffer_load_dwordx4 v16, s[4:7], s44 offen lds
s_add_u32 m0, s45, 23552
s_mov_b32 s44, 3014656
buffer_load_dwordx4 v16, s[4:7], s44 offen lds
s_waitcnt vmcnt(18)
s_barrier
ds_read_b64_tr_b16 a[0:1], v17 offset:0
ds_read_b64_tr_b16 a[2:3], v17 offset:256
ds_read_b64_tr_b16 a[4:5], v17 offset:8
ds_read_b64_tr_b16 a[6:7], v17 offset:264
ds_read_b64_tr_b16 a[8:9], v17 offset:2048
ds_read_b64_tr_b16 a[10:11], v17 offset:2304
ds_read_b64_tr_b16 a[12:13], v17 offset:2056
ds_read_b64_tr_b16 a[14:15], v17 offset:2312
s_waitcnt lgkmcnt(0)
ds_read_b64_tr_b16 a[16:17], v17 offset:4096
ds_read_b64_tr_b16 a[18:19], v17 offset:4352
ds_read_b64_tr_b16 a[20:21], v17 offset:4104
ds_read_b64_tr_b16 a[22:23], v17 offset:4360
ds_read_b64_tr_b16 a[24:25], v17 offset:6144
ds_read_b64_tr_b16 a[26:27], v17 offset:6400
ds_read_b64_tr_b16 a[28:29], v17 offset:6152
ds_read_b64_tr_b16 a[30:31], v17 offset:6408
s_waitcnt lgkmcnt(0)
s_mov_b32 s44, 3145728
buffer_load_dword v250, v12, s[4:7], s44 offen
s_add_u32 m0, s45, 0
s_mov_b32 s44, 3145728
buffer_load_dwordx4 v16, s[4:7], s44 offen lds
s_add_u32 m0, s45, 1024
s_mov_b32 s44, 3276800
buffer_load_dwordx4 v16, s[4:7], s44 offen lds
s_add_u32 m0, s45, 2048
s_mov_b32 s44, 3407872
buffer_load_dwordx4 v16, s[4:7], s44 offen lds
s_add_u32 m0, s45, 3072
s_mov_b32 s44, 3538944
buffer_load_dwordx4 v16, s[4:7], s44 offen lds
s_add_u32 m0, s45, 4096
s_mov_b32 s44, 3670016
buffer_load_dwordx4 v16, s[4:7], s44 offen lds
s_add_u32 m0, s45, 5120
s_mov_b32 s44, 3801088
buffer_load_dwordx4 v16, s[4:7], s44 offen lds
s_add_u32 m0, s45, 6144
s_mov_b32 s44, 3932160
buffer_load_dwordx4 v16, s[4:7], s44 offen lds
s_add_u32 m0, s45, 7168
s_mov_b32 s44, 4063232
buffer_load_dwordx4 v16, s[4:7], s44 offen lds
ds_read_b128 v[20:23], v8 offset:0
ds_read_b128 v[24:27], v8 offset:2048
ds_read_b128 v[28:31], v9 offset:0
ds_read_b128 v[32:35], v9 offset:2048
ds_read_b128 v[36:39], v8 offset:4096
ds_read_b128 v[40:43], v8 offset:6144
ds_read_b128 v[44:47], v9 offset:4096
ds_read_b128 v[48:51], v9 offset:6144
s_waitcnt lgkmcnt(0)
v_mfma_f32_16x16x32_bf16 v[52:55], a[0:3], v[20:23], 0
v_mfma_f32_16x16x32_bf16 v[56:59], a[4:7], v[20:23], 0
v_mfma_f32_16x16x32_bf16 v[60:63], a[0:3], v[24:27], 0
v_mfma_f32_16x16x32_bf16 v[64:67], a[4:7], v[24:27], 0
v_mfma_f32_16x16x32_bf16 v[52:55], a[8:11], v[28:31], v[52:55]
v_mfma_f32_16x16x32_bf16 v[56:59], a[12:15], v[28:31], v[56:59]
v_mfma_f32_16x16x32_bf16 v[60:63], a[8:11], v[32:35], v[60:63]
v_mfma_f32_16x16x32_bf16 v[64:67], a[12:15], v[32:35], v[64:67]
v_mfma_f32_16x16x32_bf16 v[52:55], a[16:19], v[36:39], v[52:55]
v_mfma_f32_16x16x32_bf16 v[56:59], a[20:23], v[36:39], v[56:59]
v_mfma_f32_16x16x32_bf16 v[60:63], a[16:19], v[40:43], v[60:63]
v_mfma_f32_16x16x32_bf16 v[64:67], a[20:23], v[40:43], v[64:67]
v_mfma_f32_16x16x32_bf16 v[52:55], a[24:27], v[44:47], v[52:55]
v_mfma_f32_16x16x32_bf16 v[56:59], a[28:31], v[44:47], v[56:59]
v_mfma_f32_16x16x32_bf16 v[60:63], a[24:27], v[48:51], v[60:63]
v_mfma_f32_16x16x32_bf16 v[64:67], a[28:31], v[48:51], v[64:67]
s_waitcnt vmcnt(18)
ds_read_b64_tr_b16 a[32:33], v17 offset:8192
ds_read_b64_tr_b16 a[34:35], v17 offset:8448
ds_read_b64_tr_b16 a[36:37], v17 offset:8200
ds_read_b64_tr_b16 a[38:39], v17 offset:8456
ds_read_b64_tr_b16 a[40:41], v17 offset:10240
ds_read_b64_tr_b16 a[42:43], v17 offset:10496
ds_read_b64_tr_b16 a[44:45], v17 offset:10248
ds_read_b64_tr_b16 a[46:47], v17 offset:10504
s_waitcnt lgkmcnt(0)
ds_read_b64_tr_b16 a[48:49], v17 offset:12288
ds_read_b64_tr_b16 a[50:51], v17 offset:12544
ds_read_b64_tr_b16 a[52:53], v17 offset:12296
ds_read_b64_tr_b16 a[54:55], v17 offset:12552
ds_read_b64_tr_b16 a[56:57], v17 offset:14336
ds_read_b64_tr_b16 a[58:59], v17 offset:14592
ds_read_b64_tr_b16 a[60:61], v17 offset:14344
ds_read_b64_tr_b16 a[62:63], v17 offset:14600
s_waitcnt lgkmcnt(0)
s_mov_b32 s44, 4194304
buffer_load_dword v250, v12, s[4:7], s44 offen
s_add_u32 m0, s45, 8192
s_mov_b32 s44, 4194304
buffer_load_dwordx4 v16, s[4:7], s44 offen lds
s_add_u32 m0, s45, 9216
s_mov_b32 s44, 4325376
buffer_load_dwordx4 v16, s[4:7], s44 offen lds
s_add_u32 m0, s45, 10240
s_mov_b32 s44, 4456448
buffer_load_dwordx4 v16, s[4:7], s44 offen lds
s_add_u32 m0, s45, 11264
s_mov_b32 s44, 4587520
buffer_load_dwordx4 v16, s[4:7], s44 offen lds
s_add_u32 m0, s45, 12288
s_mov_b32 s44, 4718592
buffer_load_dwordx4 v16, s[4:7], s44 offen lds
s_add_u32 m0, s45, 13312
s_mov_b32 s44, 4849664
buffer_load_dwordx4 v16, s[4:7], s44 offen lds
s_add_u32 m0, s45, 14336
s_mov_b32 s44, 4980736
buffer_load_dwordx4 v16, s[4:7], s44 offen lds
s_add_u32 m0, s45, 15360
s_mov_b32 s44, 5111808
buffer_load_dwordx4 v16, s[4:7], s44 offen lds
ds_read_b128 v[20:23], v8 offset:8192
ds_read_b128 v[24:27], v8 offset:10240
ds_read_b128 v[28:31], v9 offset:8192
ds_read_b128 v[32:35], v9 offset:10240
ds_read_b128 v[36:39], v8 offset:12288
ds_read_b128 v[40:43], v8 offset:14336
ds_read_b128 v[44:47], v9 offset:12288
ds_read_b128 v[48:51], v9 offset:14336
s_waitcnt lgkmcnt(0)
v_mfma_f32_16x16x32_bf16 v[52:55], a[32:35], v[20:23], v[52:55]
v_mfma_f32_16x16x32_bf16 v[56:59], a[36:39], v[20:23], v[56:59]
v_mfma_f32_16x16x32_bf16 v[60:63], a[32:35], v[24:27], v[60:63]
v_mfma_f32_16x16x32_bf16 v[64:67], a[36:39], v[24:27], v[64:67]
v_mfma_f32_16x16x32_bf16 v[52:55], a[40:43], v[28:31], v[52:55]
v_mfma_f32_16x16x32_bf16 v[56:59], a[44:47], v[28:31], v[56:59]
v_mfma_f32_16x16x32_bf16 v[60:63], a[40:43], v[32:35], v[60:63]
v_mfma_f32_16x16x32_bf16 v[64:67], a[44:47], v[32:35], v[64:67]
v_mfma_f32_16x16x32_bf16 v[52:55], a[48:51], v[36:39], v[52:55]
v_mfma_f32_16x16x32_bf16 v[56:59], a[52:55], v[36:39], v[56:59]
v_mfma_f32_16x16x32_bf16 v[60:63], a[48:51], v[40:43], v[60:63]
v_mfma_f32_16x16x32_bf16 v[64:67], a[52:55], v[40:43], v[64:67]
v_mfma_f32_16x16x32_bf16 v[52:55], a[56:59], v[44:47], v[52:55]
v_mfma_f32_16x16x32_bf16 v[56:59], a[60:63], v[44:47], v[56:59]
v_mfma_f32_16x16x32_bf16 v[60:63], a[56:59], v[48:51], v[60:63]
v_mfma_f32_16x16x32_bf16 v[64:67], a[60:63], v[48:51], v[64:67]
s_waitcnt vmcnt(18)
ds_read_b64_tr_b16 a[64:65], v17 offset:16384
ds_read_b64_tr_b16 a[66:67], v17 offset:16640
ds_read_b64_tr_b16 a[68:69], v17 offset:16392
ds_read_b64_tr_b16 a[70:71], v17 offset:16648
ds_read_b64_tr_b16 a[72:73], v17 offset:18432
ds_read_b64_tr_b16 a[74:75], v17 offset:18688
ds_read_b64_tr_b16 a[76:77], v17 offset:18440
ds_read_b64_tr_b16 a[78:79], v17 offset:18696
s_waitcnt lgkmcnt(0)
ds_read_b64_tr_b16 a[80:81], v17 offset:20480
ds_read_b64_tr_b16 a[82:83], v17 offset:20736
ds_read_b64_tr_b16 a[84:85], v17 offset:20488
ds_read_b64_tr_b16 a[86:87], v17 offset:20744
ds_read_b64_tr_b16 a[88:89], v17 offset:22528
ds_read_b64_tr_b16 a[90:91], v17 offset:22784
ds_read_b64_tr_b16 a[92:93], v17 offset:22536
ds_read_b64_tr_b16 a[94:95], v17 offset:22792
s_waitcnt lgkmcnt(0)
s_mov_b32 s44, 5242880
buffer_load_dword v250, v12, s[4:7], s44 offen
s_add_u32 m0, s45, 16384
s_mov_b32 s44, 5242880
buffer_load_dwordx4 v16, s[4:7], s44 offen lds
s_add_u32 m0, s45, 17408
s_mov_b32 s44, 5373952
buffer_load_dwordx4 v16, s[4:7], s44 offen lds
s_add_u32 m0, s45, 18432
s_mov_b32 s44, 5505024
buffer_load_dwordx4 v16, s[4:7], s44 offen lds
s_add_u32 m0, s45, 19456
s_mov_b32 s44, 5636096
buffer_load_dwordx4 v16, s[4:7], s44 offen lds
s_add_u32 m0, s45, 20480
s_mov_b32 s44, 5767168
buffer_load_dwordx4 v16, s[4:7], s44 offen lds
s_add_u32 m0, s45, 21504
s_mov_b32 s44, 5898240
buffer_load_dwordx4 v16, s[4:7], s44 offen lds
s_add_u32 m0, s45, 22528
s_mov_b32 s44, 6029312
buffer_load_dwordx4 v16, s[4:7], s44 offen lds
s_add_u32 m0, s45, 23552
s_mov_b32 s44, 6160384
buffer_load_dwordx4 v16, s[4:7], s44 offen lds
ds_read_b128 v[20:23], v8 offset:16384
ds_read_b128 v[24:27], v8 offset:18432
ds_read_b128 v[28:31], v9 offset:16384
ds_read_b128 v[32:35], v9 offset:18432
ds_read_b128 v[36:39], v8 offset:20480
ds_read_b128 v[40:43], v8 offset:22528
ds_read_b128 v[44:47], v9 offset:20480
ds_read_b128 v[48:51], v9 offset:22528
s_waitcnt lgkmcnt(0)
v_mfma_f32_16x16x32_bf16 v[52:55], a[64:67], v[20:23], v[52:55]
v_mfma_f32_16x16x32_bf16 v[56:59], a[68:71], v[20:23], v[56:59]
v_mfma_f32_16x16x32_bf16 v[60:63], a[64:67], v[24:27], v[60:63]
v_mfma_f32_16x16x32_bf16 v[64:67], a[68:71], v[24:27], v[64:67]
v_mfma_f32_16x16x32_bf16 v[52:55], a[72:75], v[28:31], v[52:55]
v_mfma_f32_16x16x32_bf16 v[56:59], a[76:79], v[28:31], v[56:59]
v_mfma_f32_16x16x32_bf16 v[60:63], a[72:75], v[32:35], v[60:63]
v_mfma_f32_16x16x32_bf16 v[64:67], a[76:79], v[32:35], v[64:67]
v_mfma_f32_16x16x32_bf16 v[52:55], a[80:83], v[36:39], v[52:55]
v_mfma_f32_16x16x32_bf16 v[56:59], a[84:87], v[36:39], v[56:59]
v_mfma_f32_16x16x32_bf16 v[60:63], a[80:83], v[40:43], v[60:63]
v_mfma_f32_16x16x32_bf16 v[64:67], a[84:87], v[40:43], v[64:67]
v_mfma_f32_16x16x32_bf16 v[52:55], a[88:91], v[44:47], v[52:55]
v_mfma_f32_16x16x32_bf16 v[56:59], a[92:95], v[44:47], v[56:59]
v_mfma_f32_16x16x32_bf16 v[60:63], a[88:91], v[48:51], v[60:63]
v_mfma_f32_16x16x32_bf16 v[64:67], a[92:95], v[48:51], v[64:67]
s_waitcnt vmcnt(18)
ds_read_b64_tr_b16 a[96:97], v17 offset:0
ds_read_b64_tr_b16 a[98:99], v17 offset:256
ds_read_b64_tr_b16 a[100:101], v17 offset:8
ds_read_b64_tr_b16 a[102:103], v17 offset:264
ds_read_b64_tr_b16 a[104:105], v17 offset:2048
ds_read_b64_tr_b16 a[106:107], v17 offset:2304
ds_read_b64_tr_b16 a[108:109], v17 offset:2056
ds_read_b64_tr_b16 a[110:111], v17 offset:2312
s_waitcnt lgkmcnt(0)
ds_read_b64_tr_b16 a[112:113], v17 offset:4096
ds_read_b64_tr_b16 a[114:115], v17 offset:4352
ds_read_b64_tr_b16 a[116:117], v17 offset:4104
ds_read_b64_tr_b16 a[118:119], v17 offset:4360
ds_read_b64_tr_b16 a[120:121], v17 offset:6144
ds_read_b64_tr_b16 a[122:123], v17 offset:6400
ds_read_b64_tr_b16 a[124:125], v17 offset:6152
ds_read_b64_tr_b16 a[126:127], v17 offset:6408
s_waitcnt lgkmcnt(0)
s_mov_b32 s44, 6291456
buffer_load_dword v250, v12, s[4:7], s44 offen
s_add_u32 m0, s45, 0
s_mov_b32 s44, 6291456
buffer_load_dwordx4 v16, s[4:7], s44 offen lds
s_add_u32 m0, s45, 1024
s_mov_b32 s44, 6422528
buffer_load_dwordx4 v16, s[4:7], s44 offen lds
s_add_u32 m0, s45, 2048
s_mov_b32 s44, 6553600
buffer_load_dwordx4 v16, s[4:7], s44 offen lds
s_add_u32 m0, s45, 3072
s_mov_b32 s44, 6684672
buffer_load_dwordx4 v16, s[4:7], s44 offen lds
s_add_u32 m0, s45, 4096
s_mov_b32 s44, 6815744
buffer_load_dwordx4 v16, s[4:7], s44 offen lds
s_add_u32 m0, s45, 5120
s_mov_b32 s44, 6946816
buffer_load_dwordx4 v16, s[4:7], s44 offen lds
s_add_u32 m0, s45, 6144
s_mov_b32 s44, 7077888
buffer_load_dwordx4 v16, s[4:7], s44 offen lds
s_add_u32 m0, s45, 7168
s_mov_b32 s44, 7208960
buffer_load_dwordx4 v16, s[4:7], s44 offen lds
ds_read_b128 v[20:23], v8 offset:24576
ds_read_b128 v[24:27], v8 offset:26624
ds_read_b128 v[28:31], v9 offset:24576
ds_read_b128 v[32:35], v9 offset:26624
ds_read_b128 v[36:39], v8 offset:28672
ds_read_b128 v[40:43], v8 offset:30720
ds_read_b128 v[44:47], v9 offset:28672
ds_read_b128 v[48:51], v9 offset:30720
s_waitcnt lgkmcnt(0)
v_mfma_f32_16x16x32_bf16 v[52:55], a[96:99], v[20:23], v[52:55]
v_mfma_f32_16x16x32_bf16 v[56:59], a[100:103], v[20:23], v[56:59]
v_mfma_f32_16x16x32_bf16 v[60:63], a[96:99], v[24:27], v[60:63]
v_mfma_f32_16x16x32_bf16 v[64:67], a[100:103], v[24:27], v[64:67]
v_mfma_f32_16x16x32_bf16 v[52:55], a[104:107], v[28:31], v[52:55]
v_mfma_f32_16x16x32_bf16 v[56:59], a[108:111], v[28:31], v[56:59]
v_mfma_f32_16x16x32_bf16 v[60:63], a[104:107], v[32:35], v[60:63]
v_mfma_f32_16x16x32_bf16 v[64:67], a[108:111], v[32:35], v[64:67]
v_mfma_f32_16x16x32_bf16 v[52:55], a[112:115], v[36:39], v[52:55]
v_mfma_f32_16x16x32_bf16 v[56:59], a[116:119], v[36:39], v[56:59]
v_mfma_f32_16x16x32_bf16 v[60:63], a[112:115], v[40:43], v[60:63]
v_mfma_f32_16x16x32_bf16 v[64:67], a[116:119], v[40:43], v[64:67]
v_mfma_f32_16x16x32_bf16 v[52:55], a[120:123], v[44:47], v[52:55]
v_mfma_f32_16x16x32_bf16 v[56:59], a[124:127], v[44:47], v[56:59]
v_mfma_f32_16x16x32_bf16 v[60:63], a[120:123], v[48:51], v[60:63]
v_mfma_f32_16x16x32_bf16 v[64:67], a[124:127], v[48:51], v[64:67]
s_waitcnt vmcnt(18)
ds_read_b64_tr_b16 a[128:129], v17 offset:8192
ds_read_b64_tr_b16 a[130:131], v17 offset:8448
ds_read_b64_tr_b16 a[132:133], v17 offset:8200
ds_read_b64_tr_b16 a[134:135], v17 offset:8456
ds_read_b64_tr_b16 a[136:137], v17 offset:10240
ds_read_b64_tr_b16 a[138:139], v17 offset:10496
ds_read_b64_tr_b16 a[140:141], v17 offset:10248
ds_read_b64_tr_b16 a[142:143], v17 offset:10504
s_waitcnt lgkmcnt(0)
ds_read_b64_tr_b16 a[144:145], v17 offset:12288
ds_read_b64_tr_b16 a[146:147], v17 offset:12544
ds_read_b64_tr_b16 a[148:149], v17 offset:12296
ds_read_b64_tr_b16 a[150:151], v17 offset:12552
ds_read_b64_tr_b16 a[152:153], v17 offset:14336
ds_read_b64_tr_b16 a[154:155], v17 offset:14592
ds_read_b64_tr_b16 a[156:157], v17 offset:14344
ds_read_b64_tr_b16 a[158:159], v17 offset:14600
s_waitcnt lgkmcnt(0)
s_mov_b32 s44, 7340032
buffer_load_dword v250, v12, s[4:7], s44 offen
s_add_u32 m0, s45, 8192
s_mov_b32 s44, 7340032
buffer_load_dwordx4 v16, s[4:7], s44 offen lds
s_add_u32 m0, s45, 9216
s_mov_b32 s44, 7471104
buffer_load_dwordx4 v16, s[4:7], s44 offen lds
s_add_u32 m0, s45, 10240
s_mov_b32 s44, 7602176
buffer_load_dwordx4 v16, s[4:7], s44 offen lds
s_add_u32 m0, s45, 11264
s_mov_b32 s44, 7733248
buffer_load_dwordx4 v16, s[4:7], s44 offen lds
s_add_u32 m0, s45, 12288
s_mov_b32 s44, 7864320
buffer_load_dwordx4 v16, s[4:7], s44 offen lds
s_add_u32 m0, s45, 13312
s_mov_b32 s44, 7995392
buffer_load_dwordx4 v16, s[4:7], s44 offen lds
s_add_u32 m0, s45, 14336
s_mov_b32 s44, 8126464
buffer_load_dwordx4 v16, s[4:7], s44 offen lds
s_add_u32 m0, s45, 15360
s_mov_b32 s44, 8257536
buffer_load_dwordx4 v16, s[4:7], s44 offen lds
ds_read_b128 v[20:23], v8 offset:32768
ds_read_b128 v[24:27], v8 offset:34816
ds_read_b128 v[28:31], v9 offset:32768
ds_read_b128 v[32:35], v9 offset:34816
ds_read_b128 v[36:39], v8 offset:36864
ds_read_b128 v[40:43], v8 offset:38912
ds_read_b128 v[44:47], v9 offset:36864
ds_read_b128 v[48:51], v9 offset:38912
s_waitcnt lgkmcnt(0)
v_mfma_f32_16x16x32_bf16 v[52:55], a[128:131], v[20:23], v[52:55]
v_mfma_f32_16x16x32_bf16 v[56:59], a[132:135], v[20:23], v[56:59]
v_mfma_f32_16x16x32_bf16 v[60:63], a[128:131], v[24:27], v[60:63]
v_mfma_f32_16x16x32_bf16 v[64:67], a[132:135], v[24:27], v[64:67]
v_mfma_f32_16x16x32_bf16 v[52:55], a[136:139], v[28:31], v[52:55]
v_mfma_f32_16x16x32_bf16 v[56:59], a[140:143], v[28:31], v[56:59]
v_mfma_f32_16x16x32_bf16 v[60:63], a[136:139], v[32:35], v[60:63]
v_mfma_f32_16x16x32_bf16 v[64:67], a[140:143], v[32:35], v[64:67]
v_mfma_f32_16x16x32_bf16 v[52:55], a[144:147], v[36:39], v[52:55]
v_mfma_f32_16x16x32_bf16 v[56:59], a[148:151], v[36:39], v[56:59]
v_mfma_f32_16x16x32_bf16 v[60:63], a[144:147], v[40:43], v[60:63]
v_mfma_f32_16x16x32_bf16 v[64:67], a[148:151], v[40:43], v[64:67]
v_mfma_f32_16x16x32_bf16 v[52:55], a[152:155], v[44:47], v[52:55]
v_mfma_f32_16x16x32_bf16 v[56:59], a[156:159], v[44:47], v[56:59]
v_mfma_f32_16x16x32_bf16 v[60:63], a[152:155], v[48:51], v[60:63]
v_mfma_f32_16x16x32_bf16 v[64:67], a[156:159], v[48:51], v[64:67]
s_waitcnt vmcnt(18)
ds_read_b64_tr_b16 a[160:161], v17 offset:16384
ds_read_b64_tr_b16 a[162:163], v17 offset:16640
ds_read_b64_tr_b16 a[164:165], v17 offset:16392
ds_read_b64_tr_b16 a[166:167], v17 offset:16648
ds_read_b64_tr_b16 a[168:169], v17 offset:18432
ds_read_b64_tr_b16 a[170:171], v17 offset:18688
ds_read_b64_tr_b16 a[172:173], v17 offset:18440
ds_read_b64_tr_b16 a[174:175], v17 offset:18696
s_waitcnt lgkmcnt(0)
ds_read_b64_tr_b16 a[176:177], v17 offset:20480
ds_read_b64_tr_b16 a[178:179], v17 offset:20736
ds_read_b64_tr_b16 a[180:181], v17 offset:20488
ds_read_b64_tr_b16 a[182:183], v17 offset:20744
ds_read_b64_tr_b16 a[184:185], v17 offset:22528
ds_read_b64_tr_b16 a[186:187], v17 offset:22784
ds_read_b64_tr_b16 a[188:189], v17 offset:22536
ds_read_b64_tr_b16 a[190:191], v17 offset:22792
s_waitcnt lgkmcnt(0)
ds_read_b128 v[20:23], v8 offset:40960
ds_read_b128 v[24:27], v8 offset:43008
ds_read_b128 v[28:31], v9 offset:40960
ds_read_b128 v[32:35], v9 offset:43008
ds_read_b128 v[36:39], v8 offset:45056
ds_read_b128 v[40:43], v8 offset:47104
ds_read_b128 v[44:47], v9 offset:45056
ds_read_b128 v[48:51], v9 offset:47104
s_waitcnt lgkmcnt(0)
v_mfma_f32_16x16x32_bf16 v[52:55], a[160:163], v[20:23], v[52:55]
v_mfma_f32_16x16x32_bf16 v[56:59], a[164:167], v[20:23], v[56:59]
v_mfma_f32_16x16x32_bf16 v[60:63], a[160:163], v[24:27], v[60:63]
v_mfma_f32_16x16x32_bf16 v[64:67], a[164:167], v[24:27], v[64:67]
v_mfma_f32_16x16x32_bf16 v[52:55], a[168:171], v[28:31], v[52:55]
v_mfma_f32_16x16x32_bf16 v[56:59], a[172:175], v[28:31], v[56:59]
v_mfma_f32_16x16x32_bf16 v[60:63], a[168:171], v[32:35], v[60:63]
v_mfma_f32_16x16x32_bf16 v[64:67], a[172:175], v[32:35], v[64:67]
v_mfma_f32_16x16x32_bf16 v[52:55], a[176:179], v[36:39], v[52:55]
v_mfma_f32_16x16x32_bf16 v[56:59], a[180:183], v[36:39], v[56:59]
v_mfma_f32_16x16x32_bf16 v[60:63], a[176:179], v[40:43], v[60:63]
v_mfma_f32_16x16x32_bf16 v[64:67], a[180:183], v[40:43], v[64:67]
v_mfma_f32_16x16x32_bf16 v[52:55], a[184:187], v[44:47], v[52:55]
v_mfma_f32_16x16x32_bf16 v[56:59], a[188:191], v[44:47], v[56:59]
v_mfma_f32_16x16x32_bf16 v[60:63], a[184:187], v[48:51], v[60:63]
v_mfma_f32_16x16x32_bf16 v[64:67], a[188:191], v[48:51], v[64:67]
s_waitcnt vmcnt(9)
ds_read_b64_tr_b16 a[192:193], v17 offset:0
ds_read_b64_tr_b16 a[194:195], v17 offset:256
ds_read_b64_tr_b16 a[196:197], v17 offset:8
ds_read_b64_tr_b16 a[198:199], v17 offset:264
ds_read_b64_tr_b16 a[200:201], v17 offset:2048
ds_read_b64_tr_b16 a[202:203], v17 offset:2304
ds_read_b64_tr_b16 a[204:205], v17 offset:2056
ds_read_b64_tr_b16 a[206:207], v17 offset:2312
s_waitcnt lgkmcnt(0)
ds_read_b64_tr_b16 a[208:209], v17 offset:4096
ds_read_b64_tr_b16 a[210:211], v17 offset:4352
ds_read_b64_tr_b16 a[212:213], v17 offset:4104
ds_read_b64_tr_b16 a[214:215], v17 offset:4360
ds_read_b64_tr_b16 a[216:217], v17 offset:6144
ds_read_b64_tr_b16 a[218:219], v17 offset:6400
ds_read_b64_tr_b16 a[220:221], v17 offset:6152
ds_read_b64_tr_b16 a[222:223], v17 offset:6408
s_waitcnt lgkmcnt(0)
ds_read_b128 v[20:23], v8 offset:49152
ds_read_b128 v[24:27], v8 offset:51200
ds_read_b128 v[28:31], v9 offset:49152
ds_read_b128 v[32:35], v9 offset:51200
ds_read_b128 v[36:39], v8 offset:53248
ds_read_b128 v[40:43], v8 offset:55296
ds_read_b128 v[44:47], v9 offset:53248
ds_read_b128 v[48:51], v9 offset:55296
s_waitcnt lgkmcnt(0)
v_mfma_f32_16x16x32_bf16 v[52:55], a[192:195], v[20:23], v[52:55]
v_mfma_f32_16x16x32_bf16 v[56:59], a[196:199], v[20:23], v[56:59]
v_mfma_f32_16x16x32_bf16 v[60:63], a[192:195], v[24:27], v[60:63]
v_mfma_f32_16x16x32_bf16 v[64:67], a[196:199], v[24:27], v[64:67]
v_mfma_f32_16x16x32_bf16 v[52:55], a[200:203], v[28:31], v[52:55]
v_mfma_f32_16x16x32_bf16 v[56:59], a[204:207], v[28:31], v[56:59]
v_mfma_f32_16x16x32_bf16 v[60:63], a[200:203], v[32:35], v[60:63]
v_mfma_f32_16x16x32_bf16 v[64:67], a[204:207], v[32:35], v[64:67]
v_mfma_f32_16x16x32_bf16 v[52:55], a[208:211], v[36:39], v[52:55]
v_mfma_f32_16x16x32_bf16 v[56:59], a[212:215], v[36:39], v[56:59]
v_mfma_f32_16x16x32_bf16 v[60:63], a[208:211], v[40:43], v[60:63]
v_mfma_f32_16x16x32_bf16 v[64:67], a[212:215], v[40:43], v[64:67]
v_mfma_f32_16x16x32_bf16 v[52:55], a[216:219], v[44:47], v[52:55]
v_mfma_f32_16x16x32_bf16 v[56:59], a[220:223], v[44:47], v[56:59]
v_mfma_f32_16x16x32_bf16 v[60:63], a[216:219], v[48:51], v[60:63]
v_mfma_f32_16x16x32_bf16 v[64:67], a[220:223], v[48:51], v[64:67]
s_waitcnt vmcnt(0)
ds_read_b64_tr_b16 a[224:225], v17 offset:8192
ds_read_b64_tr_b16 a[226:227], v17 offset:8448
ds_read_b64_tr_b16 a[228:229], v17 offset:8200
ds_read_b64_tr_b16 a[230:231], v17 offset:8456
ds_read_b64_tr_b16 a[232:233], v17 offset:10240
ds_read_b64_tr_b16 a[234:235], v17 offset:10496
ds_read_b64_tr_b16 a[236:237], v17 offset:10248
ds_read_b64_tr_b16 a[238:239], v17 offset:10504
s_waitcnt lgkmcnt(0)
ds_read_b64_tr_b16 a[240:241], v17 offset:12288
ds_read_b64_tr_b16 a[242:243], v17 offset:12544
ds_read_b64_tr_b16 a[244:245], v17 offset:12296
ds_read_b64_tr_b16 a[246:247], v17 offset:12552
ds_read_b64_tr_b16 a[248:249], v17 offset:14336
ds_read_b64_tr_b16 a[250:251], v17 offset:14592
ds_read_b64_tr_b16 a[252:253], v17 offset:14344
ds_read_b64_tr_b16 a[254:255], v17 offset:14600
s_waitcnt lgkmcnt(0)
ds_read_b128 v[20:23], v8 offset:57344
ds_read_b128 v[24:27], v8 offset:59392
ds_read_b128 v[28:31], v9 offset:57344
ds_read_b128 v[32:35], v9 offset:59392
ds_read_b128 v[36:39], v8 offset:61440
ds_read_b128 v[40:43], v8 offset:63488
ds_read_b128 v[44:47], v9 offset:61440
ds_read_b128 v[48:51], v9 offset:63488
s_waitcnt lgkmcnt(0)
v_mfma_f32_16x16x32_bf16 v[52:55], a[224:227], v[20:23], v[52:55]
v_mfma_f32_16x16x32_bf16 v[56:59], a[228:231], v[20:23], v[56:59]
v_mfma_f32_16x16x32_bf16 v[60:63], a[224:227], v[24:27], v[60:63]
v_mfma_f32_16x16x32_bf16 v[64:67], a[228:231], v[24:27], v[64:67]
v_mfma_f32_16x16x32_bf16 v[52:55], a[232:235], v[28:31], v[52:55]
v_mfma_f32_16x16x32_bf16 v[56:59], a[236:239], v[28:31], v[56:59]
v_mfma_f32_16x16x32_bf16 v[60:63], a[232:235], v[32:35], v[60:63]
v_mfma_f32_16x16x32_bf16 v[64:67], a[236:239], v[32:35], v[64:67]
v_mfma_f32_16x16x32_bf16 v[52:55], a[240:243], v[36:39], v[52:55]
v_mfma_f32_16x16x32_bf16 v[56:59], a[244:247], v[36:39], v[56:59]
v_mfma_f32_16x16x32_bf16 v[60:63], a[240:243], v[40:43], v[60:63]
v_mfma_f32_16x16x32_bf16 v[64:67], a[244:247], v[40:43], v[64:67]
v_mfma_f32_16x16x32_bf16 v[52:55], a[248:251], v[44:47], v[52:55]
v_mfma_f32_16x16x32_bf16 v[56:59], a[252:255], v[44:47], v[56:59]
v_mfma_f32_16x16x32_bf16 v[60:63], a[248:251], v[48:51], v[60:63]
v_mfma_f32_16x16x32_bf16 v[64:67], a[252:255], v[48:51], v[64:67]
s_barrier
s_mov_b32 s50, 0x10000
s_add_u32 m0, s46, 65536
s_nop 0
buffer_load_dwordx4 v6, s[8:11], s50 offen offset:0 lds
s_add_u32 m0, s46, 69504
s_nop 0
buffer_load_dwordx4 v6, s[8:11], s50 offen offset:128 lds
s_add_u32 m0, s46, 73472
s_nop 0
buffer_load_dwordx4 v6, s[8:11], s50 offen offset:256 lds
s_add_u32 m0, s46, 77440
s_nop 0
buffer_load_dwordx4 v6, s[8:11], s50 offen offset:384 lds
s_add_u32 m0, s46, 81408
s_nop 0
buffer_load_dwordx4 v6, s[8:11], s50 offen offset:512 lds
s_add_u32 m0, s46, 85376
s_nop 0
buffer_load_dwordx4 v6, s[8:11], s50 offen offset:640 lds
s_add_u32 m0, s46, 89344
s_nop 0
buffer_load_dwordx4 v6, s[8:11], s50 offen offset:768 lds
s_add_u32 m0, s46, 93312
s_nop 0
buffer_load_dwordx4 v6, s[8:11], s50 offen offset:896 lds
s_add_u32 m0, s46, 97280
s_nop 0
buffer_load_dwordx4 v6, s[8:11], s50 offen offset:1024 lds
s_add_u32 m0, s46, 101248
s_nop 0
buffer_load_dwordx4 v6, s[8:11], s50 offen offset:1152 lds
s_add_u32 m0, s46, 105216
s_nop 0
buffer_load_dwordx4 v6, s[8:11], s50 offen offset:1280 lds
s_add_u32 m0, s46, 109184
s_nop 0
buffer_load_dwordx4 v6, s[8:11], s50 offen offset:1408 lds
s_add_u32 m0, s46, 113152
s_nop 0
buffer_load_dwordx4 v6, s[8:11], s50 offen offset:1536 lds
s_add_u32 m0, s46, 117120
s_nop 0
buffer_load_dwordx4 v6, s[8:11], s50 offen offset:1664 lds
s_add_u32 m0, s46, 121088
s_nop 0
buffer_load_dwordx4 v6, s[8:11], s50 offen offset:1792 lds
s_add_u32 m0, s46, 125056
s_nop 0
buffer_load_dwordx4 v6, s[8:11], s50 offen offset:1920 lds
v_and_b32 v3, 15, v0
v_lshlrev_b32 v3, 4, v3
s_branch mega_kernel_syc
mega_kernel_sycw:
s_sleep 4
mega_kernel_syc:
buffer_load_dword v2, v3, s[72:75], 0 offen sc1
s_waitcnt vmcnt(0)
mega_kernel_sycp:
s_cmp_eq_u32 s95, 1
s_cbranch_scc0 mega_kernel_sycf
v_readlane_b32 s76, v2, 14
s_mov_b32 s98, 0
s_cmp_eq_u32 s76, 32
s_cbranch_scc0 mega_kernel_sycw
s_branch mega_kernel_sycd
mega_kernel_sycf:
s_mov_b32 s77, 0
s_mov_b32 s78, 0
v_readlane_b32 s76, v2, 0
s_add_u32 s77, s77, s76
s_xor_b32 s76, s76, 32
s_or_b32 s78, s78, s76
v_readlane_b32 s76, v2, 1
s_add_u32 s77, s77, s76
s_xor_b32 s76, s76, 32
s_or_b32 s78, s78, s76
v_readlane_b32 s76, v2, 2
s_add_u32 s77, s77, s76
s_xor_b32 s76, s76, 32
s_or_b32 s78, s78, s76
v_readlane_b32 s76, v2, 3
s_add_u32 s77, s77, s76
s_xor_b32 s76, s76, 32
s_or_b32 s78, s78, s76
v_readlane_b32 s76, v2, 4
s_add_u32 s77, s77, s76
s_xor_b32 s76, s76, 32
s_or_b32 s78, s78, s76
v_readlane_b32 s76, v2, 5
s_add_u32 s77, s77, s76
s_xor_b32 s76, s76, 32
s_or_b32 s78, s78, s76
v_readlane_b32 s76, v2, 6
s_add_u32 s77, s77, s76
s_xor_b32 s76, s76, 32
s_or_b32 s78, s78, s76
v_readlane_b32 s76, v2, 7
s_add_u32 s77, s77, s76
s_xor_b32 s76, s76, 32
s_or_b32 s78, s78, s76
s_cmp_eq_u32 s77, 256
s_cbranch_scc0 mega_kernel_sycw
v_mov_b32 v252, v2
s_cmp_eq_u32 s78, 0
s_cbranch_scc0 mega_kernel_slowent
v_readlane_b32 s76, v2, 10
v_readlane_b32 s77, v2, 8
s_cmp_eq_u32 s76, 32
s_cbranch_scc0 mega_kernel_sycw
s_cmp_gt_u32 s77, 16
s_cselect_b32 s98, 1, 0
mega_kernel_sycd:
v_lshrrev_b32 v92, 4, v1
v_and_b32 v93, 15, v1
s_and_b32 s52, s41, 1
s_lshr_b32 s53, s41, 1
s_mov_b32 s54, 0x3e0293ee
s_mov_b32 s55, 0
s_mov_b32 s56, 0
v_mov_b32 v97, 0xff800000
v_mov_b32 v241, 0xceabdc6e
v_and_b32 v2, 7, v93
v_lshlrev_b32 v94, 7, v92
v_lshl_add_u32 v94, v2, 4, v94
v_and_b32 v2, 31, v1
v_lshlrev_b32 v95, 3, v2
v_lshrrev_b32 v2, 1, v92
v_lshlrev_b32 v96, 10, v2
v_and_b32 v2, 1, v92
v_lshl_add_u32 v96, v2, 9, v96
v_lshl_add_u32 v96, v93, 4, v96
s_lshl_b32 s43, s40, 14
s_lshl_b32 s44, s53, 12
s_add_u32 s43, s43, s44
s_lshl_b32 s44, s52, 8
s_add_u32 s43, s43, s44
s_add_u32 s43, s43, 134217728
v_add_u32 v96, s43, v96
s_lshl_b32 s43, s52, 4
v_add_u32 v98, s43, v93
v_lshlrev_b32 v2, 2, v92
v_sub_u32 v98, v98, v2
s_mov_b32 s28, 0
s_mov_b32 s29, -1
s_xor_b32 s44, s98, 1
s_lshl_b32 s44, s44, 13
s_lshl_b32 s43, s40, 7
s_add_u32 s43, s43, s44
s_add_u32 s43, s43, 69206016
v_and_b32 v2, 3, v1
v_bfe_u32 v3, v1, 2, 1
v_lshlrev_b32 v99, 12, v3
v_lshl_add_u32 v99, v2, 2, v99
v_add_u32 v99, s43, v99
s_xor_b32 s62, s98, 1
s_lshl_b32 s62, s62, 13
s_lshr_b32 s44, s47, 6
s_lshl_b32 s44, s44, 14
s_add_u32 s62, s62, s44
s_and_b32 s44, s47, 63
s_lshl_b32 s44, s44, 7
s_add_u32 s62, s62, s44
s_add_u32 s62, s62, 69222400
s_lshl_b32 s49, s40, 7
s_lshl_b32 s44, s41, 2
s_add_u32 s49, s49, s44
s_lshl_b32 s44, s98, 13
s_add_u32 s49, s49, s44
s_add_u32 s49, s49, 69255168
s_lshl_b32 s43, s41, 11
s_add_u32 s43, s43, 131072
v_add_u32 v101, s43, v7
s_lshl_b32 s43, s52, 10
s_add_u32 s43, s43, 131072
v_add_u32 v102, s43, v5
v_mov_b32 v16, 0
s_mov_b32 s50, 0
v_mov_b32 v104, 0x3f803f80
v_mov_b32 v105, 0x3f803f80
v_mov_b32 v106, 0x3f803f80
v_mov_b32 v107, 0x3f803f80
v_cmp_gt_i32 s[12:13], 0, v98
v_cmp_gt_i32 s[14:15], 1, v98
v_cmp_gt_i32 s[16:17], 2, v98
v_cmp_gt_i32 s[18:19], 3, v98
v_cmp_gt_i32 s[20:21], 16, v98
v_cmp_gt_i32 s[22:23], 17, v98
v_cmp_gt_i32 s[24:25], 18, v98
v_cmp_gt_i32 s[26:27], 19, v98
s_lshr_b32 s44, s47, 3
s_xor_b32 s44, s44, s98
s_and_b32 s44, s44, 1
s_lshl_b32 s44, s44, 13
s_lshl_b32 s58, s47, 18
s_add_u32 s58, s58, s44
s_add_u32 s58, s58, 0
s_lshr_b32 s44, s47, 4
s_xor_b32 s44, s44, s98
s_and_b32 s44, s44, 1
s_lshl_b32 s44, s44, 13
s_lshl_b32 s59, s47, 17
s_add_u32 s59, s59, s44
s_add_u32 s59, s59, 71303168
s_lshl_b32 s60, s41, 11
s_add_u32 s60, s60, 139264
s_lshl_b32 s61, s41, 10
s_add_u32 s61, s61, 155648
v_add_u32 v94, 155648, v94
s_lshl_b32 s43, s53, 11
s_add_u32 s43, s43, 156160
v_add_u32 v95, s43, v95
v_add_u32 v103, 139264, v5
s_lshl_b32 s43, s53, 12
s_add_u32 s43, s43, 147456
v_add_u32 v240, s43, v5
s_waitcnt vmcnt(0)
v_cvt_pk_bf16_f32 v220, v52, v53
v_cvt_pk_bf16_f32 v221, v54, v55
v_cvt_pk_bf16_f32 v222, v56, v57
v_cvt_pk_bf16_f32 v223, v58, v59
v_cvt_pk_bf16_f32 v224, v60, v61
v_cvt_pk_bf16_f32 v225, v62, v63
v_cvt_pk_bf16_f32 v226, v64, v65
v_cvt_pk_bf16_f32 v227, v66, v67
s_barrier
s_mov_b32 s50, 0x20000
ds_read_b128 v[20:23], v10 offset:0
ds_read_b128 v[24:27], v10 offset:2048
ds_read_b128 v[28:31], v11 offset:0
ds_read_b128 v[32:35], v11 offset:2048
ds_read_b128 v[36:39], v10 offset:4096
ds_read_b128 v[40:43], v10 offset:6144
s_add_u32 m0, s46, 0
s_waitcnt lgkmcnt(4)
v_mfma_f32_16x16x32_bf16 v[52:55], a[0:3], v[20:23], 0
ds_read_b128 v[44:47], v11 offset:4096
v_mfma_f32_16x16x32_bf16 v[56:59], a[4:7], v[20:23], 0
buffer_load_dwordx4 v6, s[8:11], s50 offen offset:0 lds
v_mfma_f32_16x16x32_bf16 v[60:63], a[0:3], v[24:27], 0
ds_read_b128 v[48:51], v11 offset:6144
v_mfma_f32_16x16x32_bf16 v[64:67], a[4:7], v[24:27], 0
s_add_u32 m0, s46, 3968
s_waitcnt lgkmcnt(4)
v_mfma_f32_16x16x32_bf16 v[52:55], a[8:11], v[28:31], v[52:55]
ds_read_b128 v[20:23], v10 offset:8192
v_mfma_f32_16x16x32_bf16 v[56:59], a[12:15], v[28:31], v[56:59]
buffer_load_dwordx4 v6, s[8:11], s50 offen offset:128 lds
v_mfma_f32_16x16x32_bf16 v[60:63], a[8:11], v[32:35], v[60:63]
ds_read_b128 v[24:27], v10 offset:10240
v_mfma_f32_16x16x32_bf16 v[64:67], a[12:15], v[32:35], v[64:67]
s_add_u32 m0, s46, 7936
s_waitcnt lgkmcnt(4)
v_mfma_f32_16x16x32_bf16 v[52:55], a[16:19], v[36:39], v[52:55]
ds_read_b128 v[28:31], v11 offset:8192
v_mfma_f32_16x16x32_bf16 v[56:59], a[20:23], v[36:39], v[56:59]
buffer_load_dwordx4 v6, s[8:11], s50 offen offset:256 lds
v_mfma_f32_16x16x32_bf16 v[60:63], a[16:19], v[40:43], v[60:63]
ds_read_b128 v[32:35], v11 offset:10240
v_mfma_f32_16x16x32_bf16 v[64:67], a[20:23], v[40:43], v[64:67]
s_add_u32 m0, s46, 11904
s_waitcnt lgkmcnt(4)
v_mfma_f32_16x16x32_bf16 v[52:55], a[24:27], v[44:47], v[52:55]
ds_read_b128 v[36:39], v10 offset:12288
v_mfma_f32_16x16x32_bf16 v[56:59], a[28:31], v[44:47], v[56:59]
buffer_load_dwordx4 v6, s[8:11], s50 offen offset:384 lds
v_mfma_f32_16x16x32_bf16 v[60:63], a[24:27], v[48:51], v[60:63]
ds_read_b128 v[40:43], v10 offset:14336
v_mfma_f32_16x16x32_bf16 v[64:67], a[28:31], v[48:51], v[64:67]
s_add_u32 m0, s46, 15872
s_waitcnt lgkmcnt(4)
v_mfma_f32_16x16x32_bf16 v[52:55], a[32:35], v[20:23], v[52:55]
ds_read_b128 v[44:47], v11 offset:12288
v_mfma_f32_16x16x32_bf16 v[56:59], a[36:39], v[20:23], v[56:59]
buffer_load_dwordx4 v6, s[8:11], s50 offen offset:512 lds
v_mfma_f32_16x16x32_bf16 v[60:63], a[32:35], v[24:27], v[60:63]
ds_read_b128 v[48:51], v11 offset:14336
v_mfma_f32_16x16x32_bf16 v[64:67], a[36:39], v[24:27], v[64:67]
s_add_u32 m0, s46, 19840
s_waitcnt lgkmcnt(4)
v_mfma_f32_16x16x32_bf16 v[52:55], a[40:43], v[28:31], v[52:55]
ds_read_b128 v[20:23], v10 offset:16384
v_mfma_f32_16x16x32_bf16 v[56:59], a[44:47], v[28:31], v[56:59]
buffer_load_dwordx4 v6, s[8:11], s50 offen offset:640 lds
v_mfma_f32_16x16x32_bf16 v[60:63], a[40:43], v[32:35], v[60:63]
ds_read_b128 v[24:27], v10 offset:18432
v_mfma_f32_16x16x32_bf16 v[64:67], a[44:47], v[32:35], v[64:67]
s_add_u32 m0, s46, 23808
s_waitcnt lgkmcnt(4)
v_mfma_f32_16x16x32_bf16 v[52:55], a[48:51], v[36:39], v[52:55]
ds_read_b128 v[28:31], v11 offset:16384
v_mfma_f32_16x16x32_bf16 v[56:59], a[52:55], v[36:39], v[56:59]
buffer_load_dwordx4 v6, s[8:11], s50 offen offset:768 lds
v_mfma_f32_16x16x32_bf16 v[60:63], a[48:51], v[40:43], v[60:63]
ds_read_b128 v[32:35], v11 offset:18432
v_mfma_f32_16x16x32_bf16 v[64:67], a[52:55], v[40:43], v[64:67]
s_add_u32 m0, s46, 27776
s_waitcnt lgkmcnt(4)
v_mfma_f32_16x16x32_bf16 v[52:55], a[56:59], v[44:47], v[52:55]
ds_read_b128 v[36:39], v10 offset:20480
v_mfma_f32_16x16x32_bf16 v[56:59], a[60:63], v[44:47], v[56:59]
buffer_load_dwordx4 v6, s[8:11], s50 offen offset:896 lds
v_mfma_f32_16x16x32_bf16 v[60:63], a[56:59], v[48:51], v[60:63]
ds_read_b128 v[40:43], v10 offset:22528
v_mfma_f32_16x16x32_bf16 v[64:67], a[60:63], v[48:51], v[64:67]
s_add_u32 m0, s46, 31744
s_waitcnt lgkmcnt(4)
v_mfma_f32_16x16x32_bf16 v[52:55], a[64:67], v[20:23], v[52:55]
ds_read_b128 v[44:47], v11 offset:20480
v_mfma_f32_16x16x32_bf16 v[56:59], a[68:71], v[20:23], v[56:59]
buffer_load_dwordx4 v6, s[8:11], s50 offen offset:1024 lds
v_mfma_f32_16x16x32_bf16 v[60:63], a[64:67], v[24:27], v[60:63]
ds_read_b128 v[48:51], v11 offset:22528
v_mfma_f32_16x16x32_bf16 v[64:67], a[68:71], v[24:27], v[64:67]
s_add_u32 m0, s46, 35712
s_waitcnt lgkmcnt(4)
v_mfma_f32_16x16x32_bf16 v[52:55], a[72:75], v[28:31], v[52:55]
ds_read_b128 v[20:23], v10 offset:24576
v_mfma_f32_16x16x32_bf16 v[56:59], a[76:79], v[28:31], v[56:59]
buffer_load_dwordx4 v6, s[8:11], s50 offen offset:1152 lds
v_mfma_f32_16x16x32_bf16 v[60:63], a[72:75], v[32:35], v[60:63]
ds_read_b128 v[24:27], v10 offset:26624
v_mfma_f32_16x16x32_bf16 v[64:67], a[76:79], v[32:35], v[64:67]
s_add_u32 m0, s46, 39680
s_waitcnt lgkmcnt(4)
v_mfma_f32_16x16x32_bf16 v[52:55], a[80:83], v[36:39], v[52:55]
ds_read_b128 v[28:31], v11 offset:24576
v_mfma_f32_16x16x32_bf16 v[56:59], a[84:87], v[36:39], v[56:59]
buffer_load_dwordx4 v6, s[8:11], s50 offen offset:1280 lds
v_mfma_f32_16x16x32_bf16 v[60:63], a[80:83], v[40:43], v[60:63]
ds_read_b128 v[32:35], v11 offset:26624
v_mfma_f32_16x16x32_bf16 v[64:67], a[84:87], v[40:43], v[64:67]
s_add_u32 m0, s46, 43648
s_waitcnt lgkmcnt(4)
v_mfma_f32_16x16x32_bf16 v[52:55], a[88:91], v[44:47], v[52:55]
ds_read_b128 v[36:39], v10 offset:28672
v_mfma_f32_16x16x32_bf16 v[56:59], a[92:95], v[44:47], v[56:59]
buffer_load_dwordx4 v6, s[8:11], s50 offen offset:1408 lds
v_mfma_f32_16x16x32_bf16 v[60:63], a[88:91], v[48:51], v[60:63]
ds_read_b128 v[40:43], v10 offset:30720
v_mfma_f32_16x16x32_bf16 v[64:67], a[92:95], v[48:51], v[64:67]
s_add_u32 m0, s46, 47616
s_waitcnt lgkmcnt(4)
v_mfma_f32_16x16x32_bf16 v[52:55], a[96:99], v[20:23], v[52:55]
ds_read_b128 v[44:47], v11 offset:28672
v_mfma_f32_16x16x32_bf16 v[56:59], a[100:103], v[20:23], v[56:59]
buffer_load_dwordx4 v6, s[8:11], s50 offen offset:1536 lds
v_mfma_f32_16x16x32_bf16 v[60:63], a[96:99], v[24:27], v[60:63]
ds_read_b128 v[48:51], v11 offset:30720
v_mfma_f32_16x16x32_bf16 v[64:67], a[100:103], v[24:27], v[64:67]
s_add_u32 m0, s46, 51584
s_waitcnt lgkmcnt(4)
v_mfma_f32_16x16x32_bf16 v[52:55], a[104:107], v[28:31], v[52:55]
ds_read_b128 v[20:23], v10 offset:32768
v_mfma_f32_16x16x32_bf16 v[56:59], a[108:111], v[28:31], v[56:59]
buffer_load_dwordx4 v6, s[8:11], s50 offen offset:1664 lds
v_mfma_f32_16x16x32_bf16 v[60:63], a[104:107], v[32:35], v[60:63]
ds_read_b128 v[24:27], v10 offset:34816
v_mfma_f32_16x16x32_bf16 v[64:67], a[108:111], v[32:35], v[64:67]
s_add_u32 m0, s46, 55552
s_waitcnt lgkmcnt(4)
v_mfma_f32_16x16x32_bf16 v[52:55], a[112:115], v[36:39], v[52:55]
ds_read_b128 v[28:31], v11 offset:32768
v_mfma_f32_16x16x32_bf16 v[56:59], a[116:119], v[36:39], v[56:59]
buffer_load_dwordx4 v6, s[8:11], s50 offen offset:1792 lds
v_mfma_f32_16x16x32_bf16 v[60:63], a[112:115], v[40:43], v[60:63]
ds_read_b128 v[32:35], v11 offset:34816
v_mfma_f32_16x16x32_bf16 v[64:67], a[116:119], v[40:43], v[64:67]
s_add_u32 m0, s46, 59520
s_waitcnt lgkmcnt(4)
v_mfma_f32_16x16x32_bf16 v[52:55], a[120:123], v[44:47], v[52:55]
ds_read_b128 v[36:39], v10 offset:36864
v_mfma_f32_16x16x32_bf16 v[56:59], a[124:127], v[44:47], v[56:59]
buffer_load_dwordx4 v6, s[8:11], s50 offen offset:1920 lds
v_mfma_f32_16x16x32_bf16 v[60:63], a[120:123], v[48:51], v[60:63]
ds_read_b128 v[40:43], v10 offset:38912
v_mfma_f32_16x16x32_bf16 v[64:67], a[124:127], v[48:51], v[64:67]
s_waitcnt lgkmcnt(4)
v_mfma_f32_16x16x32_bf16 v[52:55], a[128:131], v[20:23], v[52:55]
ds_read_b128 v[44:47], v11 offset:36864
v_mfma_f32_16x16x32_bf16 v[56:59], a[132:135], v[20:23], v[56:59]
v_mfma_f32_16x16x32_bf16 v[60:63], a[128:131], v[24:27], v[60:63]
ds_read_b128 v[48:51], v11 offset:38912
v_mfma_f32_16x16x32_bf16 v[64:67], a[132:135], v[24:27], v[64:67]
s_waitcnt lgkmcnt(4)
v_mfma_f32_16x16x32_bf16 v[52:55], a[136:139], v[28:31], v[52:55]
ds_read_b128 v[20:23], v10 offset:40960
v_mfma_f32_16x16x32_bf16 v[56:59], a[140:143], v[28:31], v[56:59]
v_mfma_f32_16x16x32_bf16 v[60:63], a[136:139], v[32:35], v[60:63]
ds_read_b128 v[24:27], v10 offset:43008
v_mfma_f32_16x16x32_bf16 v[64:67], a[140:143], v[32:35], v[64:67]
s_waitcnt lgkmcnt(4)
v_mfma_f32_16x16x32_bf16 v[52:55], a[144:147], v[36:39], v[52:55]
ds_read_b128 v[28:31], v11 offset:40960
v_mfma_f32_16x16x32_bf16 v[56:59], a[148:151], v[36:39], v[56:59]
v_mfma_f32_16x16x32_bf16 v[60:63], a[144:147], v[40:43], v[60:63]
ds_read_b128 v[32:35], v11 offset:43008
v_mfma_f32_16x16x32_bf16 v[64:67], a[148:151], v[40:43], v[64:67]
s_waitcnt lgkmcnt(4)
v_mfma_f32_16x16x32_bf16 v[52:55], a[152:155], v[44:47], v[52:55]
ds_read_b128 v[36:39], v10 offset:45056
v_mfma_f32_16x16x32_bf16 v[56:59], a[156:159], v[44:47], v[56:59]
v_mfma_f32_16x16x32_bf16 v[60:63], a[152:155], v[48:51], v[60:63]
ds_read_b128 v[40:43], v10 offset:47104
v_mfma_f32_16x16x32_bf16 v[64:67], a[156:159], v[48:51], v[64:67]
s_waitcnt lgkmcnt(4)
v_mfma_f32_16x16x32_bf16 v[52:55], a[160:163], v[20:23], v[52:55]
ds_read_b128 v[44:47], v11 offset:45056
v_mfma_f32_16x16x32_bf16 v[56:59], a[164:167], v[20:23], v[56:59]
v_mfma_f32_16x16x32_bf16 v[60:63], a[160:163], v[24:27], v[60:63]
ds_read_b128 v[48:51], v11 offset:47104
v_mfma_f32_16x16x32_bf16 v[64:67], a[164:167], v[24:27], v[64:67]
s_waitcnt lgkmcnt(4)
v_mfma_f32_16x16x32_bf16 v[52:55], a[168:171], v[28:31], v[52:55]
ds_read_b128 v[20:23], v10 offset:49152
v_mfma_f32_16x16x32_bf16 v[56:59], a[172:175], v[28:31], v[56:59]
v_mfma_f32_16x16x32_bf16 v[60:63], a[168:171], v[32:35], v[60:63]
ds_read_b128 v[24:27], v10 offset:51200
v_mfma_f32_16x16x32_bf16 v[64:67], a[172:175], v[32:35], v[64:67]
s_waitcnt lgkmcnt(4)
v_mfma_f32_16x16x32_bf16 v[52:55], a[176:179], v[36:39], v[52:55]
ds_read_b128 v[28:31], v11 offset:49152
v_mfma_f32_16x16x32_bf16 v[56:59], a[180:183], v[36:39], v[56:59]
v_mfma_f32_16x16x32_bf16 v[60:63], a[176:179], v[40:43], v[60:63]
ds_read_b128 v[32:35], v11 offset:51200
v_mfma_f32_16x16x32_bf16 v[64:67], a[180:183], v[40:43], v[64:67]
s_waitcnt lgkmcnt(4)
v_mfma_f32_16x16x32_bf16 v[52:55], a[184:187], v[44:47], v[52:55]
ds_read_b128 v[36:39], v10 offset:53248
v_mfma_f32_16x16x32_bf16 v[56:59], a[188:191], v[44:47], v[56:59]
v_mfma_f32_16x16x32_bf16 v[60:63], a[184:187], v[48:51], v[60:63]
ds_read_b128 v[40:43], v10 offset:55296
v_mfma_f32_16x16x32_bf16 v[64:67], a[188:191], v[48:51], v[64:67]
s_waitcnt lgkmcnt(4)
v_mfma_f32_16x16x32_bf16 v[52:55], a[192:195], v[20:23], v[52:55]
ds_read_b128 v[44:47], v11 offset:53248
v_mfma_f32_16x16x32_bf16 v[56:59], a[196:199], v[20:23], v[56:59]
v_mfma_f32_16x16x32_bf16 v[60:63], a[192:195], v[24:27], v[60:63]
ds_read_b128 v[48:51], v11 offset:55296
v_mfma_f32_16x16x32_bf16 v[64:67], a[196:199], v[24:27], v[64:67]
s_waitcnt lgkmcnt(4)
v_mfma_f32_16x16x32_bf16 v[52:55], a[200:203], v[28:31], v[52:55]
ds_read_b128 v[20:23], v10 offset:57344
v_mfma_f32_16x16x32_bf16 v[56:59], a[204:207], v[28:31], v[56:59]
v_mfma_f32_16x16x32_bf16 v[60:63], a[200:203], v[32:35], v[60:63]
ds_read_b128 v[24:27], v10 offset:59392
v_mfma_f32_16x16x32_bf16 v[64:67], a[204:207], v[32:35], v[64:67]
s_waitcnt lgkmcnt(4)
v_mfma_f32_16x16x32_bf16 v[52:55], a[208:211], v[36:39], v[52:55]
ds_read_b128 v[28:31], v11 offset:57344
v_mfma_f32_16x16x32_bf16 v[56:59], a[212:215], v[36:39], v[56:59]
v_mfma_f32_16x16x32_bf16 v[60:63], a[208:211], v[40:43], v[60:63]
ds_read_b128 v[32:35], v11 offset:59392
v_mfma_f32_16x16x32_bf16 v[64:67], a[212:215], v[40:43], v[64:67]
s_waitcnt lgkmcnt(4)
v_mfma_f32_16x16x32_bf16 v[52:55], a[216:219], v[44:47], v[52:55]
ds_read_b128 v[36:39], v10 offset:61440
v_mfma_f32_16x16x32_bf16 v[56:59], a[220:223], v[44:47], v[56:59]
v_mfma_f32_16x16x32_bf16 v[60:63], a[216:219], v[48:51], v[60:63]
ds_read_b128 v[40:43], v10 offset:63488
v_mfma_f32_16x16x32_bf16 v[64:67], a[220:223], v[48:51], v[64:67]
s_waitcnt lgkmcnt(4)
v_mfma_f32_16x16x32_bf16 v[52:55], a[224:227], v[20:23], v[52:55]
ds_read_b128 v[44:47], v11 offset:61440
v_mfma_f32_16x16x32_bf16 v[56:59], a[228:231], v[20:23], v[56:59]
v_mfma_f32_16x16x32_bf16 v[60:63], a[224:227], v[24:27], v[60:63]
ds_read_b128 v[48:51], v11 offset:63488
v_mfma_f32_16x16x32_bf16 v[64:67], a[228:231], v[24:27], v[64:67]
s_waitcnt lgkmcnt(5)
v_mfma_f32_16x16x32_bf16 v[52:55], a[232:235], v[28:31], v[52:55]
v_mfma_f32_16x16x32_bf16 v[56:59], a[236:239], v[28:31], v[56:59]
s_waitcnt lgkmcnt(4)
v_mfma_f32_16x16x32_bf16 v[60:63], a[232:235], v[32:35], v[60:63]
v_mfma_f32_16x16x32_bf16 v[64:67], a[236:239], v[32:35], v[64:67]
s_waitcnt lgkmcnt(3)
v_mfma_f32_16x16x32_bf16 v[52:55], a[240:243], v[36:39], v[52:55]
v_mfma_f32_16x16x32_bf16 v[56:59], a[244:247], v[36:39], v[56:59]
s_waitcnt lgkmcnt(2)
v_mfma_f32_16x16x32_bf16 v[60:63], a[240:243], v[40:43], v[60:63]
v_mfma_f32_16x16x32_bf16 v[64:67], a[244:247], v[40:43], v[64:67]
s_waitcnt lgkmcnt(1)
v_mfma_f32_16x16x32_bf16 v[52:55], a[248:251], v[44:47], v[52:55]
v_mfma_f32_16x16x32_bf16 v[56:59], a[252:255], v[44:47], v[56:59]
s_waitcnt lgkmcnt(0)
v_mfma_f32_16x16x32_bf16 v[60:63], a[248:251], v[48:51], v[60:63]
v_mfma_f32_16x16x32_bf16 v[64:67], a[252:255], v[48:51], v[64:67]
s_waitcnt vmcnt(0)
s_barrier
s_mov_b32 s50, 0x30000
s_nop 5
v_cvt_pk_bf16_f32 v228, v52, v53
v_cvt_pk_bf16_f32 v229, v54, v55
v_cvt_pk_bf16_f32 v230, v56, v57
v_cvt_pk_bf16_f32 v231, v58, v59
v_cvt_pk_bf16_f32 v232, v60, v61
v_cvt_pk_bf16_f32 v233, v62, v63
v_cvt_pk_bf16_f32 v234, v64, v65
v_cvt_pk_bf16_f32 v235, v66, v67
ds_read_b128 v[20:23], v8 offset:0
ds_read_b128 v[24:27], v8 offset:2048
ds_read_b128 v[28:31], v9 offset:0
ds_read_b128 v[32:35], v9 offset:2048
ds_read_b128 v[36:39], v8 offset:4096
ds_read_b128 v[40:43], v8 offset:6144
s_add_u32 m0, s46, 65536
s_waitcnt lgkmcnt(4)
v_mfma_f32_16x16x32_bf16 v[52:55], a[0:3], v[20:23], 0
ds_read_b128 v[44:47], v9 offset:4096
v_mfma_f32_16x16x32_bf16 v[56:59], a[4:7], v[20:23], 0
buffer_load_dwordx4 v6, s[8:11], s50 offen offset:0 lds
v_mfma_f32_16x16x32_bf16 v[60:63], a[0:3], v[24:27], 0
ds_read_b128 v[48:51], v9 offset:6144
v_mfma_f32_16x16x32_bf16 v[64:67], a[4:7], v[24:27], 0
s_add_u32 m0, s46, 69504
s_waitcnt lgkmcnt(4)
v_mfma_f32_16x16x32_bf16 v[52:55], a[8:11], v[28:31], v[52:55]
ds_read_b128 v[20:23], v8 offset:8192
v_mfma_f32_16x16x32_bf16 v[56:59], a[12:15], v[28:31], v[56:59]
buffer_load_dwordx4 v6, s[8:11], s50 offen offset:128 lds
v_mfma_f32_16x16x32_bf16 v[60:63], a[8:11], v[32:35], v[60:63]
ds_read_b128 v[24:27], v8 offset:10240
v_mfma_f32_16x16x32_bf16 v[64:67], a[12:15], v[32:35], v[64:67]
s_add_u32 m0, s46, 73472
s_waitcnt lgkmcnt(4)
v_mfma_f32_16x16x32_bf16 v[52:55], a[16:19], v[36:39], v[52:55]
ds_read_b128 v[28:31], v9 offset:8192
v_mfma_f32_16x16x32_bf16 v[56:59], a[20:23], v[36:39], v[56:59]
buffer_load_dwordx4 v6, s[8:11], s50 offen offset:256 lds
v_mfma_f32_16x16x32_bf16 v[60:63], a[16:19], v[40:43], v[60:63]
ds_read_b128 v[32:35], v9 offset:10240
v_mfma_f32_16x16x32_bf16 v[64:67], a[20:23], v[40:43], v[64:67]
s_add_u32 m0, s46, 77440
s_waitcnt lgkmcnt(4)
v_mfma_f32_16x16x32_bf16 v[52:55], a[24:27], v[44:47], v[52:55]
ds_read_b128 v[36:39], v8 offset:12288
v_mfma_f32_16x16x32_bf16 v[56:59], a[28:31], v[44:47], v[56:59]
buffer_load_dwordx4 v6, s[8:11], s50 offen offset:384 lds
v_mfma_f32_16x16x32_bf16 v[60:63], a[24:27], v[48:51], v[60:63]
ds_read_b128 v[40:43], v8 offset:14336
v_mfma_f32_16x16x32_bf16 v[64:67], a[28:31], v[48:51], v[64:67]
s_add_u32 m0, s46, 81408
s_waitcnt lgkmcnt(4)
v_mfma_f32_16x16x32_bf16 v[52:55], a[32:35], v[20:23], v[52:55]
ds_read_b128 v[44:47], v9 offset:12288
v_mfma_f32_16x16x32_bf16 v[56:59], a[36:39], v[20:23], v[56:59]
buffer_load_dwordx4 v6, s[8:11], s50 offen offset:512 lds
v_mfma_f32_16x16x32_bf16 v[60:63], a[32:35], v[24:27], v[60:63]
ds_read_b128 v[48:51], v9 offset:14336
v_mfma_f32_16x16x32_bf16 v[64:67], a[36:39], v[24:27], v[64:67]
s_add_u32 m0, s46, 85376
s_waitcnt lgkmcnt(4)
v_mfma_f32_16x16x32_bf16 v[52:55], a[40:43], v[28:31], v[52:55]
ds_read_b128 v[20:23], v8 offset:16384
v_mfma_f32_16x16x32_bf16 v[56:59], a[44:47], v[28:31], v[56:59]
buffer_load_dwordx4 v6, s[8:11], s50 offen offset:640 lds
v_mfma_f32_16x16x32_bf16 v[60:63], a[40:43], v[32:35], v[60:63]
ds_read_b128 v[24:27], v8 offset:18432
v_mfma_f32_16x16x32_bf16 v[64:67], a[44:47], v[32:35], v[64:67]
s_add_u32 m0, s46, 89344
s_waitcnt lgkmcnt(4)
v_mfma_f32_16x16x32_bf16 v[52:55], a[48:51], v[36:39], v[52:55]
ds_read_b128 v[28:31], v9 offset:16384
v_mfma_f32_16x16x32_bf16 v[56:59], a[52:55], v[36:39], v[56:59]
buffer_load_dwordx4 v6, s[8:11], s50 offen offset:768 lds
v_mfma_f32_16x16x32_bf16 v[60:63], a[48:51], v[40:43], v[60:63]
ds_read_b128 v[32:35], v9 offset:18432
v_mfma_f32_16x16x32_bf16 v[64:67], a[52:55], v[40:43], v[64:67]
s_add_u32 m0, s46, 93312
s_waitcnt lgkmcnt(4)
v_mfma_f32_16x16x32_bf16 v[52:55], a[56:59], v[44:47], v[52:55]
ds_read_b128 v[36:39], v8 offset:20480
v_mfma_f32_16x16x32_bf16 v[56:59], a[60:63], v[44:47], v[56:59]
buffer_load_dwordx4 v6, s[8:11], s50 offen offset:896 lds
v_mfma_f32_16x16x32_bf16 v[60:63], a[56:59], v[48:51], v[60:63]
ds_read_b128 v[40:43], v8 offset:22528
v_mfma_f32_16x16x32_bf16 v[64:67], a[60:63], v[48:51], v[64:67]
s_add_u32 m0, s46, 97280
s_waitcnt lgkmcnt(4)
v_mfma_f32_16x16x32_bf16 v[52:55], a[64:67], v[20:23], v[52:55]
ds_read_b128 v[44:47], v9 offset:20480
v_mfma_f32_16x16x32_bf16 v[56:59], a[68:71], v[20:23], v[56:59]
buffer_load_dwordx4 v6, s[8:11], s50 offen offset:1024 lds
v_mfma_f32_16x16x32_bf16 v[60:63], a[64:67], v[24:27], v[60:63]
ds_read_b128 v[48:51], v9 offset:22528
v_mfma_f32_16x16x32_bf16 v[64:67], a[68:71], v[24:27], v[64:67]
s_add_u32 m0, s46, 101248
s_waitcnt lgkmcnt(4)
v_mfma_f32_16x16x32_bf16 v[52:55], a[72:75], v[28:31], v[52:55]
ds_read_b128 v[20:23], v8 offset:24576
v_mfma_f32_16x16x32_bf16 v[56:59], a[76:79], v[28:31], v[56:59]
buffer_load_dwordx4 v6, s[8:11], s50 offen offset:1152 lds
v_mfma_f32_16x16x32_bf16 v[60:63], a[72:75], v[32:35], v[60:63]
ds_read_b128 v[24:27], v8 offset:26624
v_mfma_f32_16x16x32_bf16 v[64:67], a[76:79], v[32:35], v[64:67]
s_add_u32 m0, s46, 105216
s_waitcnt lgkmcnt(4)
v_mfma_f32_16x16x32_bf16 v[52:55], a[80:83], v[36:39], v[52:55]
ds_read_b128 v[28:31], v9 offset:24576
v_mfma_f32_16x16x32_bf16 v[56:59], a[84:87], v[36:39], v[56:59]
buffer_load_dwordx4 v6, s[8:11], s50 offen offset:1280 lds
v_mfma_f32_16x16x32_bf16 v[60:63], a[80:83], v[40:43], v[60:63]
ds_read_b128 v[32:35], v9 offset:26624
v_mfma_f32_16x16x32_bf16 v[64:67], a[84:87], v[40:43], v[64:67]
s_add_u32 m0, s46, 109184
s_waitcnt lgkmcnt(4)
v_mfma_f32_16x16x32_bf16 v[52:55], a[88:91], v[44:47], v[52:55]
ds_read_b128 v[36:39], v8 offset:28672
v_mfma_f32_16x16x32_bf16 v[56:59], a[92:95], v[44:47], v[56:59]
buffer_load_dwordx4 v6, s[8:11], s50 offen offset:1408 lds
v_mfma_f32_16x16x32_bf16 v[60:63], a[88:91], v[48:51], v[60:63]
ds_read_b128 v[40:43], v8 offset:30720
v_mfma_f32_16x16x32_bf16 v[64:67], a[92:95], v[48:51], v[64:67]
s_add_u32 m0, s46, 113152
s_waitcnt lgkmcnt(4)
v_mfma_f32_16x16x32_bf16 v[52:55], a[96:99], v[20:23], v[52:55]
ds_read_b128 v[44:47], v9 offset:28672
v_mfma_f32_16x16x32_bf16 v[56:59], a[100:103], v[20:23], v[56:59]
buffer_load_dwordx4 v6, s[8:11], s50 offen offset:1536 lds
v_mfma_f32_16x16x32_bf16 v[60:63], a[96:99], v[24:27], v[60:63]
ds_read_b128 v[48:51], v9 offset:30720
v_mfma_f32_16x16x32_bf16 v[64:67], a[100:103], v[24:27], v[64:67]
s_add_u32 m0, s46, 117120
s_waitcnt lgkmcnt(4)
v_mfma_f32_16x16x32_bf16 v[52:55], a[104:107], v[28:31], v[52:55]
ds_read_b128 v[20:23], v8 offset:32768
v_mfma_f32_16x16x32_bf16 v[56:59], a[108:111], v[28:31], v[56:59]
buffer_load_dwordx4 v6, s[8:11], s50 offen offset:1664 lds
v_mfma_f32_16x16x32_bf16 v[60:63], a[104:107], v[32:35], v[60:63]
ds_read_b128 v[24:27], v8 offset:34816
v_mfma_f32_16x16x32_bf16 v[64:67], a[108:111], v[32:35], v[64:67]
s_add_u32 m0, s46, 121088
s_waitcnt lgkmcnt(4)
v_mfma_f32_16x16x32_bf16 v[52:55], a[112:115], v[36:39], v[52:55]
ds_read_b128 v[28:31], v9 offset:32768
v_mfma_f32_16x16x32_bf16 v[56:59], a[116:119], v[36:39], v[56:59]
buffer_load_dwordx4 v6, s[8:11], s50 offen offset:1792 lds
v_mfma_f32_16x16x32_bf16 v[60:63], a[112:115], v[40:43], v[60:63]
ds_read_b128 v[32:35], v9 offset:34816
v_mfma_f32_16x16x32_bf16 v[64:67], a[116:119], v[40:43], v[64:67]
s_add_u32 m0, s46, 125056
s_waitcnt lgkmcnt(4)
v_mfma_f32_16x16x32_bf16 v[52:55], a[120:123], v[44:47], v[52:55]
ds_read_b128 v[36:39], v8 offset:36864
v_mfma_f32_16x16x32_bf16 v[56:59], a[124:127], v[44:47], v[56:59]
buffer_load_dwordx4 v6, s[8:11], s50 offen offset:1920 lds
v_mfma_f32_16x16x32_bf16 v[60:63], a[120:123], v[48:51], v[60:63]
ds_read_b128 v[40:43], v8 offset:38912
v_mfma_f32_16x16x32_bf16 v[64:67], a[124:127], v[48:51], v[64:67]
s_waitcnt lgkmcnt(4)
v_mfma_f32_16x16x32_bf16 v[52:55], a[128:131], v[20:23], v[52:55]
ds_read_b128 v[44:47], v9 offset:36864
v_mfma_f32_16x16x32_bf16 v[56:59], a[132:135], v[20:23], v[56:59]
v_mfma_f32_16x16x32_bf16 v[60:63], a[128:131], v[24:27], v[60:63]
ds_read_b128 v[48:51], v9 offset:38912
v_mfma_f32_16x16x32_bf16 v[64:67], a[132:135], v[24:27], v[64:67]
s_waitcnt lgkmcnt(4)
v_mfma_f32_16x16x32_bf16 v[52:55], a[136:139], v[28:31], v[52:55]
ds_read_b128 v[20:23], v8 offset:40960
v_mfma_f32_16x16x32_bf16 v[56:59], a[140:143], v[28:31], v[56:59]
v_mfma_f32_16x16x32_bf16 v[60:63], a[136:139], v[32:35], v[60:63]
ds_read_b128 v[24:27], v8 offset:43008
v_mfma_f32_16x16x32_bf16 v[64:67], a[140:143], v[32:35], v[64:67]
s_waitcnt lgkmcnt(4)
v_mfma_f32_16x16x32_bf16 v[52:55], a[144:147], v[36:39], v[52:55]
ds_read_b128 v[28:31], v9 offset:40960
v_mfma_f32_16x16x32_bf16 v[56:59], a[148:151], v[36:39], v[56:59]
v_mfma_f32_16x16x32_bf16 v[60:63], a[144:147], v[40:43], v[60:63]
ds_read_b128 v[32:35], v9 offset:43008
v_mfma_f32_16x16x32_bf16 v[64:67], a[148:151], v[40:43], v[64:67]
s_waitcnt lgkmcnt(4)
v_mfma_f32_16x16x32_bf16 v[52:55], a[152:155], v[44:47], v[52:55]
ds_read_b128 v[36:39], v8 offset:45056
v_mfma_f32_16x16x32_bf16 v[56:59], a[156:159], v[44:47], v[56:59]
v_mfma_f32_16x16x32_bf16 v[60:63], a[152:155], v[48:51], v[60:63]
ds_read_b128 v[40:43], v8 offset:47104
v_mfma_f32_16x16x32_bf16 v[64:67], a[156:159], v[48:51], v[64:67]
s_waitcnt lgkmcnt(4)
v_mfma_f32_16x16x32_bf16 v[52:55], a[160:163], v[20:23], v[52:55]
ds_read_b128 v[44:47], v9 offset:45056
v_mfma_f32_16x16x32_bf16 v[56:59], a[164:167], v[20:23], v[56:59]
v_mfma_f32_16x16x32_bf16 v[60:63], a[160:163], v[24:27], v[60:63]
ds_read_b128 v[48:51], v9 offset:47104
v_mfma_f32_16x16x32_bf16 v[64:67], a[164:167], v[24:27], v[64:67]
s_waitcnt lgkmcnt(4)
v_mfma_f32_16x16x32_bf16 v[52:55], a[168:171], v[28:31], v[52:55]
ds_read_b128 v[20:23], v8 offset:49152
v_mfma_f32_16x16x32_bf16 v[56:59], a[172:175], v[28:31], v[56:59]
v_mfma_f32_16x16x32_bf16 v[60:63], a[168:171], v[32:35], v[60:63]
ds_read_b128 v[24:27], v8 offset:51200
v_mfma_f32_16x16x32_bf16 v[64:67], a[172:175], v[32:35], v[64:67]
s_waitcnt lgkmcnt(4)
v_mfma_f32_16x16x32_bf16 v[52:55], a[176:179], v[36:39], v[52:55]
ds_read_b128 v[28:31], v9 offset:49152
v_mfma_f32_16x16x32_bf16 v[56:59], a[180:183], v[36:39], v[56:59]
v_mfma_f32_16x16x32_bf16 v[60:63], a[176:179], v[40:43], v[60:63]
ds_read_b128 v[32:35], v9 offset:51200
v_mfma_f32_16x16x32_bf16 v[64:67], a[180:183], v[40:43], v[64:67]
s_waitcnt lgkmcnt(4)
v_mfma_f32_16x16x32_bf16 v[52:55], a[184:187], v[44:47], v[52:55]
ds_read_b128 v[36:39], v8 offset:53248
v_mfma_f32_16x16x32_bf16 v[56:59], a[188:191], v[44:47], v[56:59]
v_mfma_f32_16x16x32_bf16 v[60:63], a[184:187], v[48:51], v[60:63]
ds_read_b128 v[40:43], v8 offset:55296
v_mfma_f32_16x16x32_bf16 v[64:67], a[188:191], v[48:51], v[64:67]
s_waitcnt lgkmcnt(4)
v_mfma_f32_16x16x32_bf16 v[52:55], a[192:195], v[20:23], v[52:55]
ds_read_b128 v[44:47], v9 offset:53248
v_mfma_f32_16x16x32_bf16 v[56:59], a[196:199], v[20:23], v[56:59]
v_mfma_f32_16x16x32_bf16 v[60:63], a[192:195], v[24:27], v[60:63]
ds_read_b128 v[48:51], v9 offset:55296
v_mfma_f32_16x16x32_bf16 v[64:67], a[196:199], v[24:27], v[64:67]
s_waitcnt lgkmcnt(4)
v_mfma_f32_16x16x32_bf16 v[52:55], a[200:203], v[28:31], v[52:55]
ds_read_b128 v[20:23], v8 offset:57344
v_mfma_f32_16x16x32_bf16 v[56:59], a[204:207], v[28:31], v[56:59]
v_mfma_f32_16x16x32_bf16 v[60:63], a[200:203], v[32:35], v[60:63]
ds_read_b128 v[24:27], v8 offset:59392
v_mfma_f32_16x16x32_bf16 v[64:67], a[204:207], v[32:35], v[64:67]
s_waitcnt lgkmcnt(4)
v_mfma_f32_16x16x32_bf16 v[52:55], a[208:211], v[36:39], v[52:55]
ds_read_b128 v[28:31], v9 offset:57344
v_mfma_f32_16x16x32_bf16 v[56:59], a[212:215], v[36:39], v[56:59]
v_mfma_f32_16x16x32_bf16 v[60:63], a[208:211], v[40:43], v[60:63]
ds_read_b128 v[32:35], v9 offset:59392
v_mfma_f32_16x16x32_bf16 v[64:67], a[212:215], v[40:43], v[64:67]
s_waitcnt lgkmcnt(4)
v_mfma_f32_16x16x32_bf16 v[52:55], a[216:219], v[44:47], v[52:55]
ds_read_b128 v[36:39], v8 offset:61440
v_mfma_f32_16x16x32_bf16 v[56:59], a[220:223], v[44:47], v[56:59]
v_mfma_f32_16x16x32_bf16 v[60:63], a[216:219], v[48:51], v[60:63]
ds_read_b128 v[40:43], v8 offset:63488
v_mfma_f32_16x16x32_bf16 v[64:67], a[220:223], v[48:51], v[64:67]
s_waitcnt lgkmcnt(4)
v_mfma_f32_16x16x32_bf16 v[52:55], a[224:227], v[20:23], v[52:55]
ds_read_b128 v[44:47], v9 offset:61440
v_mfma_f32_16x16x32_bf16 v[56:59], a[228:231], v[20:23], v[56:59]
v_mfma_f32_16x16x32_bf16 v[60:63], a[224:227], v[24:27], v[60:63]
ds_read_b128 v[48:51], v9 offset:63488
v_mfma_f32_16x16x32_bf16 v[64:67], a[228:231], v[24:27], v[64:67]
s_waitcnt lgkmcnt(5)
v_mfma_f32_16x16x32_bf16 v[52:55], a[232:235], v[28:31], v[52:55]
v_mfma_f32_16x16x32_bf16 v[56:59], a[236:239], v[28:31], v[56:59]
s_waitcnt lgkmcnt(4)
v_mfma_f32_16x16x32_bf16 v[60:63], a[232:235], v[32:35], v[60:63]
v_mfma_f32_16x16x32_bf16 v[64:67], a[236:239], v[32:35], v[64:67]
s_waitcnt lgkmcnt(3)
v_mfma_f32_16x16x32_bf16 v[52:55], a[240:243], v[36:39], v[52:55]
v_mfma_f32_16x16x32_bf16 v[56:59], a[244:247], v[36:39], v[56:59]
s_waitcnt lgkmcnt(2)
v_mfma_f32_16x16x32_bf16 v[60:63], a[240:243], v[40:43], v[60:63]
v_mfma_f32_16x16x32_bf16 v[64:67], a[244:247], v[40:43], v[64:67]
s_waitcnt lgkmcnt(1)
v_mfma_f32_16x16x32_bf16 v[68:71], a[248:251], v[44:47], v[52:55]
v_mfma_f32_16x16x32_bf16 v[72:75], a[252:255], v[44:47], v[56:59]
s_waitcnt lgkmcnt(0)
v_mfma_f32_16x16x32_bf16 v[76:79], a[248:251], v[48:51], v[60:63]
v_mfma_f32_16x16x32_bf16 v[80:83], a[252:255], v[48:51], v[64:67]
s_waitcnt vmcnt(0)
mega_kernel_q_loop:
s_barrier
s_cmp_gt_i32 s55, s42
s_cbranch_scc1 mega_kernel_q_kv1k
mega_kernel_q_kv1w:
v_mov_b32 v2, 0
s_mov_b64 exec, 0xff
buffer_atomic_add v2, v99, s[84:87], 0 offen sc0 sc1
s_mov_b64 exec, -1
s_waitcnt vmcnt(0)
v_min_i32_dpp v2, v2, v2 quad_perm:[1,0,3,2] row_mask:0xf bank_mask:0xf
s_nop 1
v_min_i32_dpp v2, v2, v2 quad_perm:[2,3,0,1] row_mask:0xf bank_mask:0xf
s_nop 1
v_min_i32_dpp v2, v2, v2 row_half_mirror row_mask:0xf bank_mask:0xf
s_nop 0
v_readfirstlane_b32 s55, v2
s_cmp_gt_i32 s55, s42
s_cbranch_scc1 mega_kernel_q_kv1k
s_sleep 4
s_branch mega_kernel_q_kv1w
mega_kernel_q_kv1k:
s_cmp_ge_u32 s42, 61
s_cbranch_scc0 mega_kernel_q_nl1
s_add_u32 s51, s47, s42
s_bfe_u32 s57, s51, 0x40002
s_lshl_b32 s57, s57, 14
s_and_b32 s66, s51, 3
s_lshl_b32 s66, s66, 11
s_add_u32 s66, s66, s57
s_add_u32 s66, s66, s58
s_add_u32 s67, s66, 33554432
s_bfe_u32 s57, s51, 0x30003
s_lshl_b32 s57, s57, 14
s_and_b32 s68, s51, 7
s_lshl_b32 s68, s68, 10
s_add_u32 s68, s68, s57
s_add_u32 s68, s68, s59
s_add_u32 s50, s42, 4
s_min_u32 s50, s50, 63
s_lshl_b32 s50, s50, 16
s_cmp_gt_i32 s56, s42
s_cselect_b32 s30, 1, 0
s_add_u32 m0, s60, 0
s_nop 0
buffer_load_dwordx4 v5, s[84:87], s66 offen offset:0 sc1 lds
s_add_u32 m0, s60, 0
s_nop 0
buffer_load_dwordx4 v5, s[84:87], s66 offen offset:1024 sc1 lds
s_add_u32 m0, s60, 8192
s_nop 0
buffer_load_dwordx4 v5, s[84:87], s67 offen offset:0 sc1 lds
s_add_u32 m0, s60, 8192
s_nop 0
buffer_load_dwordx4 v5, s[84:87], s67 offen offset:1024 sc1 lds
s_cmp_eq_u32 s30, 1
s_cbranch_scc0 mega_kernel_q_kx1
s_mov_b32 m0, s61
s_nop 0
buffer_load_dwordx4 v5, s[84:87], s68 offen sc1 lds
mega_kernel_q_kx1:
v_mov_b64 v[84:85], v[220:221]
v_mov_b64 v[86:87], v[222:223]
v_mov_b64 v[88:89], v[224:225]
v_mov_b64 v[90:91], v[226:227]
v_mov_b64 v[220:221], v[228:229]
v_mov_b64 v[222:223], v[230:231]
v_mov_b64 v[224:225], v[232:233]
v_mov_b64 v[226:227], v[234:235]
v_cvt_pk_bf16_f32 v228, v68, v69
v_cvt_pk_bf16_f32 v229, v70, v71
v_cvt_pk_bf16_f32 v230, v72, v73
v_cvt_pk_bf16_f32 v231, v74, v75
v_cvt_pk_bf16_f32 v232, v76, v77
v_cvt_pk_bf16_f32 v233, v78, v79
v_cvt_pk_bf16_f32 v234, v80, v81
v_cvt_pk_bf16_f32 v235, v82, v83
ds_write_b128 v101, v[84:87]
ds_write_b128 v101, v[88:91] offset:1024
s_waitcnt vmcnt(4)
v_mov_b32 v17, s42
s_mov_b64 exec, 1
buffer_store_dword v17, v16, s[84:87], s49 offen sc1
s_mov_b64 exec, -1
s_branch mega_kernel_q_jl1
mega_kernel_q_nl1:
ds_read_b128 v[20:23], v10 offset:0
ds_read_b128 v[24:27], v10 offset:2048
ds_read_b128 v[28:31], v11 offset:0
ds_read_b128 v[32:35], v11 offset:2048
ds_read_b128 v[36:39], v10 offset:4096
ds_read_b128 v[40:43], v10 offset:6144
s_add_u32 s51, s47, s42
s_bfe_u32 s57, s51, 0x40002
s_lshl_b32 s57, s57, 14
s_and_b32 s66, s51, 3
s_lshl_b32 s66, s66, 11
s_add_u32 s66, s66, s57
s_add_u32 s66, s66, s58
s_add_u32 s67, s66, 33554432
s_bfe_u32 s57, s51, 0x30003
s_lshl_b32 s57, s57, 14
s_and_b32 s68, s51, 7
s_lshl_b32 s68, s68, 10
s_add_u32 s68, s68, s57
s_add_u32 s68, s68, s59
s_add_u32 s50, s42, 4
s_min_u32 s50, s50, 63
s_lshl_b32 s50, s50, 16
s_cmp_gt_i32 s56, s42
s_cselect_b32 s30, 1, 0
s_add_u32 m0, s60, 0
s_waitcnt lgkmcnt(4)
v_mfma_f32_16x16x32_bf16 v[52:55], a[0:3], v[20:23], 0
ds_read_b128 v[44:47], v11 offset:4096
v_mfma_f32_16x16x32_bf16 v[56:59], a[4:7], v[20:23], 0
buffer_load_dwordx4 v5, s[84:87], s66 offen offset:0 sc1 lds
v_mfma_f32_16x16x32_bf16 v[60:63], a[0:3], v[24:27], 0
ds_read_b128 v[48:51], v11 offset:6144
v_mfma_f32_16x16x32_bf16 v[64:67], a[4:7], v[24:27], 0
s_add_u32 m0, s60, 0
s_waitcnt lgkmcnt(4)
v_mfma_f32_16x16x32_bf16 v[52:55], a[8:11], v[28:31], v[52:55]
ds_read_b128 v[20:23], v10 offset:8192
v_mfma_f32_16x16x32_bf16 v[56:59], a[12:15], v[28:31], v[56:59]
buffer_load_dwordx4 v5, s[84:87], s66 offen offset:1024 sc1 lds
v_mfma_f32_16x16x32_bf16 v[60:63], a[8:11], v[32:35], v[60:63]
ds_read_b128 v[24:27], v10 offset:10240
v_mfma_f32_16x16x32_bf16 v[64:67], a[12:15], v[32:35], v[64:67]
s_add_u32 m0, s60, 8192
s_waitcnt lgkmcnt(4)
v_mfma_f32_16x16x32_bf16 v[52:55], a[16:19], v[36:39], v[52:55]
ds_read_b128 v[28:31], v11 offset:8192
v_mfma_f32_16x16x32_bf16 v[56:59], a[20:23], v[36:39], v[56:59]
buffer_load_dwordx4 v5, s[84:87], s67 offen offset:0 sc1 lds
v_mfma_f32_16x16x32_bf16 v[60:63], a[16:19], v[40:43], v[60:63]
ds_read_b128 v[32:35], v11 offset:10240
v_mfma_f32_16x16x32_bf16 v[64:67], a[20:23], v[40:43], v[64:67]
s_add_u32 m0, s60, 8192
s_waitcnt lgkmcnt(4)
v_mfma_f32_16x16x32_bf16 v[52:55], a[24:27], v[44:47], v[52:55]
ds_read_b128 v[36:39], v10 offset:12288
v_mfma_f32_16x16x32_bf16 v[56:59], a[28:31], v[44:47], v[56:59]
buffer_load_dwordx4 v5, s[84:87], s67 offen offset:1024 sc1 lds
v_mfma_f32_16x16x32_bf16 v[60:63], a[24:27], v[48:51], v[60:63]
ds_read_b128 v[40:43], v10 offset:14336
v_mfma_f32_16x16x32_bf16 v[64:67], a[28:31], v[48:51], v[64:67]
s_waitcnt lgkmcnt(4)
v_mfma_f32_16x16x32_bf16 v[52:55], a[32:35], v[20:23], v[52:55]
ds_read_b128 v[44:47], v11 offset:12288
v_mfma_f32_16x16x32_bf16 v[56:59], a[36:39], v[20:23], v[56:59]
s_cmp_eq_u32 s30, 1
s_cbranch_scc0 mega_kernel_q_ke1
s_mov_b32 m0, s61
s_nop 0
buffer_load_dwordx4 v5, s[84:87], s68 offen sc1 lds
mega_kernel_q_ke1:
v_mfma_f32_16x16x32_bf16 v[60:63], a[32:35], v[24:27], v[60:63]
ds_read_b128 v[48:51], v11 offset:14336
v_mfma_f32_16x16x32_bf16 v[64:67], a[36:39], v[24:27], v[64:67]
s_add_u32 m0, s46, 0
s_waitcnt lgkmcnt(4)
v_mfma_f32_16x16x32_bf16 v[52:55], a[40:43], v[28:31], v[52:55]
ds_read_b128 v[20:23], v10 offset:16384
v_mfma_f32_16x16x32_bf16 v[56:59], a[44:47], v[28:31], v[56:59]
buffer_load_dwordx4 v6, s[8:11], s50 offen offset:0 lds
v_mfma_f32_16x16x32_bf16 v[60:63], a[40:43], v[32:35], v[60:63]
ds_read_b128 v[24:27], v10 offset:18432
v_mfma_f32_16x16x32_bf16 v[64:67], a[44:47], v[32:35], v[64:67]
s_add_u32 m0, s46, 3968
s_waitcnt lgkmcnt(4)
v_mfma_f32_16x16x32_bf16 v[52:55], a[48:51], v[36:39], v[52:55]
ds_read_b128 v[28:31], v11 offset:16384
v_mfma_f32_16x16x32_bf16 v[56:59], a[52:55], v[36:39], v[56:59]
buffer_load_dwordx4 v6, s[8:11], s50 offen offset:128 lds
v_mfma_f32_16x16x32_bf16 v[60:63], a[48:51], v[40:43], v[60:63]
ds_read_b128 v[32:35], v11 offset:18432
v_mfma_f32_16x16x32_bf16 v[64:67], a[52:55], v[40:43], v[64:67]
s_add_u32 m0, s46, 7936
s_waitcnt lgkmcnt(4)
v_mfma_f32_16x16x32_bf16 v[52:55], a[56:59], v[44:47], v[52:55]
ds_read_b128 v[36:39], v10 offset:20480
v_mfma_f32_16x16x32_bf16 v[56:59], a[60:63], v[44:47], v[56:59]
buffer_load_dwordx4 v6, s[8:11], s50 offen offset:256 lds
v_mfma_f32_16x16x32_bf16 v[60:63], a[56:59], v[48:51], v[60:63]
ds_read_b128 v[40:43], v10 offset:22528
v_mfma_f32_16x16x32_bf16 v[64:67], a[60:63], v[48:51], v[64:67]
s_add_u32 m0, s46, 11904
s_waitcnt lgkmcnt(4)
v_mfma_f32_16x16x32_bf16 v[52:55], a[64:67], v[20:23], v[52:55]
ds_read_b128 v[44:47], v11 offset:20480
v_mfma_f32_16x16x32_bf16 v[56:59], a[68:71], v[20:23], v[56:59]
buffer_load_dwordx4 v6, s[8:11], s50 offen offset:384 lds
v_mfma_f32_16x16x32_bf16 v[60:63], a[64:67], v[24:27], v[60:63]
ds_read_b128 v[48:51], v11 offset:22528
v_mfma_f32_16x16x32_bf16 v[64:67], a[68:71], v[24:27], v[64:67]
s_add_u32 m0, s46, 15872
s_waitcnt lgkmcnt(4)
v_mfma_f32_16x16x32_bf16 v[52:55], a[72:75], v[28:31], v[52:55]
ds_read_b128 v[20:23], v10 offset:24576
v_mfma_f32_16x16x32_bf16 v[56:59], a[76:79], v[28:31], v[56:59]
buffer_load_dwordx4 v6, s[8:11], s50 offen offset:512 lds
v_mfma_f32_16x16x32_bf16 v[60:63], a[72:75], v[32:35], v[60:63]
ds_read_b128 v[24:27], v10 offset:26624
v_mfma_f32_16x16x32_bf16 v[64:67], a[76:79], v[32:35], v[64:67]
s_add_u32 m0, s46, 19840
s_waitcnt lgkmcnt(4)
v_mfma_f32_16x16x32_bf16 v[52:55], a[80:83], v[36:39], v[52:55]
ds_read_b128 v[28:31], v11 offset:24576
v_mfma_f32_16x16x32_bf16 v[56:59], a[84:87], v[36:39], v[56:59]
buffer_load_dwordx4 v6, s[8:11], s50 offen offset:640 lds
v_mfma_f32_16x16x32_bf16 v[60:63], a[80:83], v[40:43], v[60:63]
ds_read_b128 v[32:35], v11 offset:26624
v_mfma_f32_16x16x32_bf16 v[64:67], a[84:87], v[40:43], v[64:67]
s_add_u32 m0, s46, 23808
s_waitcnt lgkmcnt(4)
v_mfma_f32_16x16x32_bf16 v[52:55], a[88:91], v[44:47], v[52:55]
ds_read_b128 v[36:39], v10 offset:28672
v_mfma_f32_16x16x32_bf16 v[56:59], a[92:95], v[44:47], v[56:59]
buffer_load_dwordx4 v6, s[8:11], s50 offen offset:768 lds
v_mfma_f32_16x16x32_bf16 v[60:63], a[88:91], v[48:51], v[60:63]
ds_read_b128 v[40:43], v10 offset:30720
v_mfma_f32_16x16x32_bf16 v[64:67], a[92:95], v[48:51], v[64:67]
s_add_u32 m0, s46, 27776
s_waitcnt lgkmcnt(4)
v_mfma_f32_16x16x32_bf16 v[52:55], a[96:99], v[20:23], v[52:55]
ds_read_b128 v[44:47], v11 offset:28672
v_mfma_f32_16x16x32_bf16 v[56:59], a[100:103], v[20:23], v[56:59]
buffer_load_dwordx4 v6, s[8:11], s50 offen offset:896 lds
v_mfma_f32_16x16x32_bf16 v[60:63], a[96:99], v[24:27], v[60:63]
ds_read_b128 v[48:51], v11 offset:30720
v_mfma_f32_16x16x32_bf16 v[64:67], a[100:103], v[24:27], v[64:67]
s_add_u32 m0, s46, 31744
s_waitcnt lgkmcnt(4)
v_mfma_f32_16x16x32_bf16 v[52:55], a[104:107], v[28:31], v[52:55]
ds_read_b128 v[20:23], v10 offset:32768
v_mfma_f32_16x16x32_bf16 v[56:59], a[108:111], v[28:31], v[56:59]
buffer_load_dwordx4 v6, s[8:11], s50 offen offset:1024 lds
v_mfma_f32_16x16x32_bf16 v[60:63], a[104:107], v[32:35], v[60:63]
ds_read_b128 v[24:27], v10 offset:34816
v_mfma_f32_16x16x32_bf16 v[64:67], a[108:111], v[32:35], v[64:67]
s_waitcnt vmcnt(13)
v_mov_b32 v17, s42
s_mov_b64 exec, 1
buffer_store_dword v17, v16, s[84:87], s49 offen sc1
s_mov_b64 exec, -1
s_add_u32 m0, s46, 35712
s_waitcnt lgkmcnt(4)
v_mfma_f32_16x16x32_bf16 v[52:55], a[112:115], v[36:39], v[52:55]
ds_read_b128 v[28:31], v11 offset:32768
v_mfma_f32_16x16x32_bf16 v[56:59], a[116:119], v[36:39], v[56:59]
buffer_load_dwordx4 v6, s[8:11], s50 offen offset:1152 lds
v_mfma_f32_16x16x32_bf16 v[60:63], a[112:115], v[40:43], v[60:63]
ds_read_b128 v[32:35], v11 offset:34816
v_mfma_f32_16x16x32_bf16 v[64:67], a[116:119], v[40:43], v[64:67]
v_mov_b32 v100, 0
s_mov_b64 exec, 1
buffer_atomic_add v100, v16, s[84:87], s62 offen sc0 sc1
s_mov_b64 exec, -1
s_add_u32 m0, s46, 39680
s_waitcnt lgkmcnt(4)
v_mfma_f32_16x16x32_bf16 v[52:55], a[120:123], v[44:47], v[52:55]
ds_read_b128 v[36:39], v10 offset:36864
v_mfma_f32_16x16x32_bf16 v[56:59], a[124:127], v[44:47], v[56:59]
buffer_load_dwordx4 v6, s[8:11], s50 offen offset:1280 lds
v_mfma_f32_16x16x32_bf16 v[60:63], a[120:123], v[48:51], v[60:63]
ds_read_b128 v[40:43], v10 offset:38912
v_mfma_f32_16x16x32_bf16 v[64:67], a[124:127], v[48:51], v[64:67]
s_add_u32 m0, s46, 43648
s_waitcnt lgkmcnt(4)
v_mfma_f32_16x16x32_bf16 v[52:55], a[128:131], v[20:23], v[52:55]
ds_read_b128 v[44:47], v11 offset:36864
v_mfma_f32_16x16x32_bf16 v[56:59], a[132:135], v[20:23], v[56:59]
buffer_load_dwordx4 v6, s[8:11], s50 offen offset:1408 lds
v_mfma_f32_16x16x32_bf16 v[60:63], a[128:131], v[24:27], v[60:63]
ds_read_b128 v[48:51], v11 offset:38912
v_mfma_f32_16x16x32_bf16 v[64:67], a[132:135], v[24:27], v[64:67]
s_add_u32 m0, s46, 47616
s_waitcnt lgkmcnt(4)
v_mfma_f32_16x16x32_bf16 v[52:55], a[136:139], v[28:31], v[52:55]
ds_read_b128 v[20:23], v10 offset:40960
v_mfma_f32_16x16x32_bf16 v[56:59], a[140:143], v[28:31], v[56:59]
buffer_load_dwordx4 v6, s[8:11], s50 offen offset:1536 lds
v_mfma_f32_16x16x32_bf16 v[60:63], a[136:139], v[32:35], v[60:63]
ds_read_b128 v[24:27], v10 offset:43008
v_mfma_f32_16x16x32_bf16 v[64:67], a[140:143], v[32:35], v[64:67]
s_add_u32 m0, s46, 51584
s_waitcnt lgkmcnt(4)
v_mfma_f32_16x16x32_bf16 v[52:55], a[144:147], v[36:39], v[52:55]
ds_read_b128 v[28:31], v11 offset:40960
v_mfma_f32_16x16x32_bf16 v[56:59], a[148:151], v[36:39], v[56:59]
buffer_load_dwordx4 v6, s[8:11], s50 offen offset:1664 lds
v_mfma_f32_16x16x32_bf16 v[60:63], a[144:147], v[40:43], v[60:63]
ds_read_b128 v[32:35], v11 offset:43008
v_mfma_f32_16x16x32_bf16 v[64:67], a[148:151], v[40:43], v[64:67]
s_add_u32 m0, s46, 55552
s_waitcnt lgkmcnt(4)
v_mfma_f32_16x16x32_bf16 v[52:55], a[152:155], v[44:47], v[52:55]
ds_read_b128 v[36:39], v10 offset:45056
v_mfma_f32_16x16x32_bf16 v[56:59], a[156:159], v[44:47], v[56:59]
buffer_load_dwordx4 v6, s[8:11], s50 offen offset:1792 lds
v_mfma_f32_16x16x32_bf16 v[60:63], a[152:155], v[48:51], v[60:63]
ds_read_b128 v[40:43], v10 offset:47104
v_mfma_f32_16x16x32_bf16 v[64:67], a[156:159], v[48:51], v[64:67]
s_add_u32 m0, s46, 59520
s_waitcnt lgkmcnt(4)
v_mfma_f32_16x16x32_bf16 v[52:55], a[160:163], v[20:23], v[52:55]
ds_read_b128 v[44:47], v11 offset:45056
v_mfma_f32_16x16x32_bf16 v[56:59], a[164:167], v[20:23], v[56:59]
buffer_load_dwordx4 v6, s[8:11], s50 offen offset:1920 lds
v_mfma_f32_16x16x32_bf16 v[60:63], a[160:163], v[24:27], v[60:63]
ds_read_b128 v[48:51], v11 offset:47104
v_mfma_f32_16x16x32_bf16 v[64:67], a[164:167], v[24:27], v[64:67]
s_waitcnt lgkmcnt(4)
v_mfma_f32_16x16x32_bf16 v[52:55], a[168:171], v[28:31], v[52:55]
ds_read_b128 v[20:23], v10 offset:49152
v_mfma_f32_16x16x32_bf16 v[56:59], a[172:175], v[28:31], v[56:59]
v_mov_b64 v[84:85], v[220:221]
v_mov_b64 v[86:87], v[222:223]
v_mfma_f32_16x16x32_bf16 v[60:63], a[168:171], v[32:35], v[60:63]
ds_read_b128 v[24:27], v10 offset:51200
v_mfma_f32_16x16x32_bf16 v[64:67], a[172:175], v[32:35], v[64:67]
v_mov_b64 v[88:89], v[224:225]
v_mov_b64 v[90:91], v[226:227]
s_waitcnt lgkmcnt(4)
v_mfma_f32_16x16x32_bf16 v[52:55], a[176:179], v[36:39], v[52:55]
ds_read_b128 v[28:31], v11 offset:49152
v_mfma_f32_16x16x32_bf16 v[56:59], a[180:183], v[36:39], v[56:59]
v_mov_b64 v[220:221], v[228:229]
v_mov_b64 v[222:223], v[230:231]
v_mfma_f32_16x16x32_bf16 v[60:63], a[176:179], v[40:43], v[60:63]
ds_read_b128 v[32:35], v11 offset:51200
v_mfma_f32_16x16x32_bf16 v[64:67], a[180:183], v[40:43], v[64:67]
v_mov_b64 v[224:225], v[232:233]
v_mov_b64 v[226:227], v[234:235]
s_waitcnt lgkmcnt(4)
v_mfma_f32_16x16x32_bf16 v[52:55], a[184:187], v[44:47], v[52:55]
ds_read_b128 v[36:39], v10 offset:53248
v_mfma_f32_16x16x32_bf16 v[56:59], a[188:191], v[44:47], v[56:59]
v_cvt_pk_bf16_f32 v228, v68, v69
v_cvt_pk_bf16_f32 v229, v70, v71
v_mfma_f32_16x16x32_bf16 v[60:63], a[184:187], v[48:51], v[60:63]
ds_read_b128 v[40:43], v10 offset:55296
v_mfma_f32_16x16x32_bf16 v[64:67], a[188:191], v[48:51], v[64:67]
v_cvt_pk_bf16_f32 v230, v72, v73
v_cvt_pk_bf16_f32 v231, v74, v75
s_waitcnt lgkmcnt(4)
v_mfma_f32_16x16x32_bf16 v[52:55], a[192:195], v[20:23], v[52:55]
ds_read_b128 v[44:47], v11 offset:53248
v_mfma_f32_16x16x32_bf16 v[56:59], a[196:199], v[20:23], v[56:59]
v_cvt_pk_bf16_f32 v232, v76, v77
v_cvt_pk_bf16_f32 v233, v78, v79
v_mfma_f32_16x16x32_bf16 v[60:63], a[192:195], v[24:27], v[60:63]
ds_read_b128 v[48:51], v11 offset:55296
v_mfma_f32_16x16x32_bf16 v[64:67], a[196:199], v[24:27], v[64:67]
v_cvt_pk_bf16_f32 v234, v80, v81
v_cvt_pk_bf16_f32 v235, v82, v83
s_waitcnt lgkmcnt(4)
v_mfma_f32_16x16x32_bf16 v[52:55], a[200:203], v[28:31], v[52:55]
ds_read_b128 v[20:23], v10 offset:57344
v_mfma_f32_16x16x32_bf16 v[56:59], a[204:207], v[28:31], v[56:59]
v_mfma_f32_16x16x32_bf16 v[60:63], a[200:203], v[32:35], v[60:63]
ds_read_b128 v[24:27], v10 offset:59392
v_mfma_f32_16x16x32_bf16 v[64:67], a[204:207], v[32:35], v[64:67]
s_waitcnt lgkmcnt(4)
v_mfma_f32_16x16x32_bf16 v[52:55], a[208:211], v[36:39], v[52:55]
ds_read_b128 v[28:31], v11 offset:57344
v_mfma_f32_16x16x32_bf16 v[56:59], a[212:215], v[36:39], v[56:59]
v_mfma_f32_16x16x32_bf16 v[60:63], a[208:211], v[40:43], v[60:63]
ds_read_b128 v[32:35], v11 offset:59392
v_mfma_f32_16x16x32_bf16 v[64:67], a[212:215], v[40:43], v[64:67]
s_waitcnt lgkmcnt(4)
v_mfma_f32_16x16x32_bf16 v[52:55], a[216:219], v[44:47], v[52:55]
ds_read_b128 v[36:39], v10 offset:61440
v_mfma_f32_16x16x32_bf16 v[56:59], a[220:223], v[44:47], v[56:59]
s_waitcnt vmcnt(6)
v_readfirstlane_b32 s56, v100
s_cmp_eq_u32 s30, 1
s_cbranch_scc1 mega_kernel_q_kf1
s_cmp_gt_i32 s56, s42
s_cbranch_scc0 mega_kernel_q_kf1
s_mov_b32 s30, 1
s_mov_b32 m0, s61
s_nop 0
buffer_load_dwordx4 v5, s[84:87], s68 offen sc1 lds
mega_kernel_q_kf1:
v_mfma_f32_16x16x32_bf16 v[60:63], a[216:219], v[48:51], v[60:63]
ds_read_b128 v[40:43], v10 offset:63488
v_mfma_f32_16x16x32_bf16 v[64:67], a[220:223], v[48:51], v[64:67]
s_waitcnt lgkmcnt(4)
v_mfma_f32_16x16x32_bf16 v[52:55], a[224:227], v[20:23], v[52:55]
ds_read_b128 v[44:47], v11 offset:61440
v_mfma_f32_16x16x32_bf16 v[56:59], a[228:231], v[20:23], v[56:59]
v_mfma_f32_16x16x32_bf16 v[60:63], a[224:227], v[24:27], v[60:63]
ds_read_b128 v[48:51], v11 offset:63488
v_mfma_f32_16x16x32_bf16 v[64:67], a[228:231], v[24:27], v[64:67]
s_waitcnt lgkmcnt(5)
v_mfma_f32_16x16x32_bf16 v[52:55], a[232:235], v[28:31], v[52:55]
v_mfma_f32_16x16x32_bf16 v[56:59], a[236:239], v[28:31], v[56:59]
s_waitcnt lgkmcnt(4)
v_mfma_f32_16x16x32_bf16 v[60:63], a[232:235], v[32:35], v[60:63]
v_mfma_f32_16x16x32_bf16 v[64:67], a[236:239], v[32:35], v[64:67]
s_waitcnt lgkmcnt(3)
v_mfma_f32_16x16x32_bf16 v[52:55], a[240:243], v[36:39], v[52:55]
v_mfma_f32_16x16x32_bf16 v[56:59], a[244:247], v[36:39], v[56:59]
s_waitcnt lgkmcnt(2)
v_mfma_f32_16x16x32_bf16 v[60:63], a[240:243], v[40:43], v[60:63]
v_mfma_f32_16x16x32_bf16 v[64:67], a[244:247], v[40:43], v[64:67]
ds_write_b128 v101, v[84:87]
ds_write_b128 v101, v[88:91] offset:1024
s_waitcnt lgkmcnt(1)
v_mfma_f32_16x16x32_bf16 v[68:71], a[248:251], v[44:47], v[52:55]
v_mfma_f32_16x16x32_bf16 v[72:75], a[252:255], v[44:47], v[56:59]
s_waitcnt lgkmcnt(0)
v_mfma_f32_16x16x32_bf16 v[76:79], a[248:251], v[48:51], v[60:63]
v_mfma_f32_16x16x32_bf16 v[80:83], a[252:255], v[48:51], v[64:67]
mega_kernel_q_jl1:
s_cmp_eq_u32 s30, 1
s_cbranch_scc1 mega_kernel_q_kl1
mega_kernel_q_kw1:
v_mov_b32 v100, 0
s_mov_b64 exec, 1
buffer_atomic_add v100, v16, s[84:87], s62 offen sc0 sc1
s_mov_b64 exec, -1
s_waitcnt vmcnt(0)
v_readfirstlane_b32 s56, v100
s_cmp_gt_i32 s56, s42
s_cbranch_scc1 mega_kernel_q_kv1
s_cmp_eq_u32 s42, 63
s_cbranch_scc1 mega_kernel_q_kw1
s_sleep 0
s_branch mega_kernel_q_kw1
mega_kernel_q_kv1:
s_mov_b32 m0, s61
s_nop 0
buffer_load_dwordx4 v5, s[84:87], s68 offen sc1 lds
mega_kernel_q_kl1:
s_waitcnt lgkmcnt(0) vmcnt(0)
s_barrier
ds_read_b128 v[184:187], v102 offset:0
ds_read_b128 v[112:115], v103 offset:0
ds_read_b128 v[128:131], v103 offset:1024
ds_read_b128 v[188:191], v102 offset:2048
ds_read_b128 v[116:119], v103 offset:2048
ds_read_b128 v[132:135], v103 offset:3072
ds_read_b128 v[192:195], v102 offset:4096
ds_read_b128 v[120:123], v103 offset:4096
ds_read_b128 v[136:139], v103 offset:5120
ds_read_b128 v[196:199], v102 offset:6144
ds_read_b128 v[124:127], v103 offset:6144
ds_read_b128 v[140:143], v103 offset:7168
s_waitcnt lgkmcnt(9)
v_mfma_f32_16x16x32_bf16 v[200:203], v[112:115], v[184:187], 0
v_mfma_f32_16x16x32_bf16 v[204:207], v[128:131], v[184:187], 0
ds_read_b128 v[160:163], v94 offset:0
s_waitcnt lgkmcnt(7)
v_mfma_f32_16x16x32_bf16 v[200:203], v[116:119], v[188:191], v[200:203]
v_mfma_f32_16x16x32_bf16 v[204:207], v[132:135], v[188:191], v[204:207]
ds_read_b128 v[164:167], v94 offset:1024
s_waitcnt lgkmcnt(5)
v_mfma_f32_16x16x32_bf16 v[200:203], v[120:123], v[192:195], v[200:203]
v_mfma_f32_16x16x32_bf16 v[204:207], v[136:139], v[192:195], v[204:207]
ds_read_b128 v[168:171], v94 offset:2048
s_waitcnt lgkmcnt(3)
v_mfma_f32_16x16x32_bf16 v[200:203], v[124:127], v[196:199], v[200:203]
v_mfma_f32_16x16x32_bf16 v[204:207], v[140:143], v[196:199], v[204:207]
ds_read_b128 v[172:175], v94 offset:3072
s_waitcnt lgkmcnt(3)
v_mfma_f32_16x16x32_bf16 v[208:211], v[160:163], v[184:187], 0
ds_read_b128 v[144:147], v240 offset:0
ds_read_b64 v[176:177], v95 offset:0
s_waitcnt lgkmcnt(4)
v_mfma_f32_16x16x32_bf16 v[208:211], v[164:167], v[188:191], v[208:211]
ds_read_b128 v[148:151], v240 offset:1024
ds_read_b64 v[178:179], v95 offset:256
s_waitcnt lgkmcnt(5)
v_mfma_f32_16x16x32_bf16 v[208:211], v[168:171], v[192:195], v[208:211]
ds_read_b128 v[152:155], v240 offset:2048
ds_read_b64 v[180:181], v95 offset:1024
s_waitcnt lgkmcnt(6)
v_mfma_f32_16x16x32_bf16 v[208:211], v[172:175], v[196:199], v[208:211]
ds_read_b128 v[156:159], v240 offset:3072
ds_read_b64 v[182:183], v95 offset:1280
v_pk_mul_f32 v[200:201], v[200:201], s[54:55] op_sel_hi:[1,0]
v_pk_mul_f32 v[202:203], v[202:203], s[54:55] op_sel_hi:[1,0]
v_pk_mul_f32 v[204:205], v[204:205], s[54:55] op_sel_hi:[1,0]
v_pk_mul_f32 v[206:207], v[206:207], s[54:55] op_sel_hi:[1,0]
v_cndmask_b32 v200, v200, v241, s[12:13]
v_cndmask_b32 v201, v201, v241, s[14:15]
v_cndmask_b32 v202, v202, v241, s[16:17]
v_cndmask_b32 v203, v203, v241, s[18:19]
v_cndmask_b32 v204, v204, v241, s[20:21]
v_cndmask_b32 v205, v205, v241, s[22:23]
v_cndmask_b32 v206, v206, v241, s[24:25]
v_cndmask_b32 v207, v207, v241, s[26:27]
v_pk_mul_f32 v[208:209], v[208:209], s[54:55] op_sel_hi:[1,0]
v_pk_mul_f32 v[210:211], v[210:211], s[54:55] op_sel_hi:[1,0]
v_cndmask_b32 v208, v208, v97, s[28:29]
v_cndmask_b32 v209, v209, v97, s[28:29]
v_cndmask_b32 v210, v210, v97, s[28:29]
v_cndmask_b32 v211, v211, v97, s[28:29]
v_max3_f32 v236, v200, v201, v202
v_max3_f32 v236, v236, v203, v204
v_max3_f32 v236, v236, v205, v206
v_max3_f32 v236, v236, v207, v208
v_max3_f32 v236, v236, v209, v210
v_max_f32 v237, v236, v211
v_max_f32 v236, v236, v211
s_nop 1
v_permlane16_swap_b32 v236, v237
s_nop 0
v_max_f32 v238, v236, v237
v_max_f32 v239, v236, v237
s_nop 1
v_permlane32_swap_b32 v238, v239
s_nop 0
v_max_f32 v236, v238, v239
v_pk_add_f32 v[200:201], v[200:201], v[236:237] op_sel_hi:[1,0] neg_lo:[0,1] neg_hi:[0,1]
v_pk_add_f32 v[202:203], v[202:203], v[236:237] op_sel_hi:[1,0] neg_lo:[0,1] neg_hi:[0,1]
v_pk_add_f32 v[204:205], v[204:205], v[236:237] op_sel_hi:[1,0] neg_lo:[0,1] neg_hi:[0,1]
v_pk_add_f32 v[206:207], v[206:207], v[236:237] op_sel_hi:[1,0] neg_lo:[0,1] neg_hi:[0,1]
v_pk_add_f32 v[208:209], v[208:209], v[236:237] op_sel_hi:[1,0] neg_lo:[0,1] neg_hi:[0,1]
v_pk_add_f32 v[210:211], v[210:211], v[236:237] op_sel_hi:[1,0] neg_lo:[0,1] neg_hi:[0,1]
v_exp_f32 v200, v200
v_exp_f32 v201, v201
v_exp_f32 v202, v202
v_exp_f32 v203, v203
v_exp_f32 v204, v204
v_exp_f32 v205, v205
v_exp_f32 v206, v206
v_exp_f32 v207, v207
v_exp_f32 v208, v208
v_exp_f32 v209, v209
v_exp_f32 v210, v210
v_exp_f32 v211, v211
s_nop 0
v_cvt_pk_bf16_f32 v212, v200, v201
v_cvt_pk_bf16_f32 v213, v202, v203
v_cvt_pk_bf16_f32 v214, v204, v205
v_cvt_pk_bf16_f32 v215, v206, v207
v_cvt_pk_bf16_f32 v216, v208, v209
v_cvt_pk_bf16_f32 v217, v210, v211
s_waitcnt lgkmcnt(0)
s_nop 0
v_mfma_f32_16x16x32_bf16 v[108:111], v[104:107], v[212:215], 0
v_mfma_f32_16x16x32_bf16 v[112:115], v[144:147], v[212:215], 0
v_mfma_f32_16x16x32_bf16 v[116:119], v[148:151], v[212:215], 0
v_mfma_f32_16x16x32_bf16 v[120:123], v[152:155], v[212:215], 0
v_mfma_f32_16x16x32_bf16 v[124:127], v[156:159], v[212:215], 0
v_mfma_f32_16x16x16_bf16 v[108:111], v[104:105], v[216:217], v[108:111]
v_mfma_f32_16x16x16_bf16 v[112:115], v[176:177], v[216:217], v[112:115]
v_mfma_f32_16x16x16_bf16 v[116:119], v[178:179], v[216:217], v[116:119]
v_mfma_f32_16x16x16_bf16 v[120:123], v[180:181], v[216:217], v[120:123]
v_mfma_f32_16x16x16_bf16 v[124:127], v[182:183], v[216:217], v[124:127]
s_lshr_b32 s63, s42, 2
s_xnor_b32 s63, s63, s98
s_and_b32 s63, s63, 1
s_lshl_b32 s63, s63, 13
s_lshl_b32 s51, s42, 19
s_add_u32 s51, s51, s63
s_nop 2
v_rcp_f32 v238, v108
v_rcp_f32 v239, v109
s_nop 1
v_pk_mul_f32 v[112:113], v[112:113], v[238:239]
v_pk_mul_f32 v[114:115], v[114:115], v[238:239]
v_pk_mul_f32 v[116:117], v[116:117], v[238:239]
v_pk_mul_f32 v[118:119], v[118:119], v[238:239]
v_pk_mul_f32 v[120:121], v[120:121], v[238:239]
v_pk_mul_f32 v[122:123], v[122:123], v[238:239]
v_pk_mul_f32 v[124:125], v[124:125], v[238:239]
v_pk_mul_f32 v[126:127], v[126:127], v[238:239]
v_cvt_pk_bf16_f32 v200, v112, v113
v_cvt_pk_bf16_f32 v201, v114, v115
v_cvt_pk_bf16_f32 v202, v116, v117
v_cvt_pk_bf16_f32 v203, v118, v119
v_cvt_pk_bf16_f32 v204, v120, v121
v_cvt_pk_bf16_f32 v205, v122, v123
v_cvt_pk_bf16_f32 v206, v124, v125
v_cvt_pk_bf16_f32 v207, v126, v127
buffer_store_dwordx4 v[200:203], v96, s[84:87], s51 offen sc1
buffer_store_dwordx4 v[204:207], v96, s[84:87], s51 offen offset:2048 sc1
s_add_u32 s42, s42, 1
s_barrier
s_cmp_gt_i32 s55, s42
s_cbranch_scc1 mega_kernel_q_kv0k
mega_kernel_q_kv0w:
v_mov_b32 v2, 0
s_mov_b64 exec, 0xff
buffer_atomic_add v2, v99, s[84:87], 0 offen sc0 sc1
s_mov_b64 exec, -1
s_waitcnt vmcnt(0)
v_min_i32_dpp v2, v2, v2 quad_perm:[1,0,3,2] row_mask:0xf bank_mask:0xf
s_nop 1
v_min_i32_dpp v2, v2, v2 quad_perm:[2,3,0,1] row_mask:0xf bank_mask:0xf
s_nop 1
v_min_i32_dpp v2, v2, v2 row_half_mirror row_mask:0xf bank_mask:0xf
s_nop 0
v_readfirstlane_b32 s55, v2
s_cmp_gt_i32 s55, s42
s_cbranch_scc1 mega_kernel_q_kv0k
s_sleep 4
s_branch mega_kernel_q_kv0w
mega_kernel_q_kv0k:
s_cmp_ge_u32 s42, 61
s_cbranch_scc0 mega_kernel_q_nl0
s_add_u32 s51, s47, s42
s_bfe_u32 s57, s51, 0x40002
s_lshl_b32 s57, s57, 14
s_and_b32 s66, s51, 3
s_lshl_b32 s66, s66, 11
s_add_u32 s66, s66, s57
s_add_u32 s66, s66, s58
s_add_u32 s67, s66, 33554432
s_bfe_u32 s57, s51, 0x30003
s_lshl_b32 s57, s57, 14
s_and_b32 s68, s51, 7
s_lshl_b32 s68, s68, 10
s_add_u32 s68, s68, s57
s_add_u32 s68, s68, s59
s_add_u32 s50, s42, 4
s_min_u32 s50, s50, 63
s_lshl_b32 s50, s50, 16
s_cmp_gt_i32 s56, s42
s_cselect_b32 s30, 1, 0
s_add_u32 m0, s60, 0
s_nop 0
buffer_load_dwordx4 v5, s[84:87], s66 offen offset:0 sc1 lds
s_add_u32 m0, s60, 0
s_nop 0
buffer_load_dwordx4 v5, s[84:87], s66 offen offset:1024 sc1 lds
s_add_u32 m0, s60, 8192
s_nop 0
buffer_load_dwordx4 v5, s[84:87], s67 offen offset:0 sc1 lds
s_add_u32 m0, s60, 8192
s_nop 0
buffer_load_dwordx4 v5, s[84:87], s67 offen offset:1024 sc1 lds
s_cmp_eq_u32 s30, 1
s_cbranch_scc0 mega_kernel_q_kx0
s_mov_b32 m0, s61
s_nop 0
buffer_load_dwordx4 v5, s[84:87], s68 offen sc1 lds
mega_kernel_q_kx0:
v_mov_b64 v[84:85], v[220:221]
v_mov_b64 v[86:87], v[222:223]
v_mov_b64 v[88:89], v[224:225]
v_mov_b64 v[90:91], v[226:227]
v_mov_b64 v[220:221], v[228:229]
v_mov_b64 v[222:223], v[230:231]
v_mov_b64 v[224:225], v[232:233]
v_mov_b64 v[226:227], v[234:235]
v_cvt_pk_bf16_f32 v228, v68, v69
v_cvt_pk_bf16_f32 v229, v70, v71
v_cvt_pk_bf16_f32 v230, v72, v73
v_cvt_pk_bf16_f32 v231, v74, v75
v_cvt_pk_bf16_f32 v232, v76, v77
v_cvt_pk_bf16_f32 v233, v78, v79
v_cvt_pk_bf16_f32 v234, v80, v81
v_cvt_pk_bf16_f32 v235, v82, v83
ds_write_b128 v101, v[84:87]
ds_write_b128 v101, v[88:91] offset:1024
s_waitcnt vmcnt(4)
v_mov_b32 v17, s42
s_mov_b64 exec, 1
buffer_store_dword v17, v16, s[84:87], s49 offen sc1
s_mov_b64 exec, -1
s_branch mega_kernel_q_jl0
mega_kernel_q_nl0:
ds_read_b128 v[20:23], v8 offset:0
ds_read_b128 v[24:27], v8 offset:2048
ds_read_b128 v[28:31], v9 offset:0
ds_read_b128 v[32:35], v9 offset:2048
ds_read_b128 v[36:39], v8 offset:4096
ds_read_b128 v[40:43], v8 offset:6144
s_add_u32 s51, s47, s42
s_bfe_u32 s57, s51, 0x40002
s_lshl_b32 s57, s57, 14
s_and_b32 s66, s51, 3
s_lshl_b32 s66, s66, 11
s_add_u32 s66, s66, s57
s_add_u32 s66, s66, s58
s_add_u32 s67, s66, 33554432
s_bfe_u32 s57, s51, 0x30003
s_lshl_b32 s57, s57, 14
s_and_b32 s68, s51, 7
s_lshl_b32 s68, s68, 10
s_add_u32 s68, s68, s57
s_add_u32 s68, s68, s59
s_add_u32 s50, s42, 4
s_min_u32 s50, s50, 63
s_lshl_b32 s50, s50, 16
s_cmp_gt_i32 s56, s42
s_cselect_b32 s30, 1, 0
s_add_u32 m0, s60, 0
s_waitcnt lgkmcnt(4)
v_mfma_f32_16x16x32_bf16 v[52:55], a[0:3], v[20:23], 0
ds_read_b128 v[44:47], v9 offset:4096
v_mfma_f32_16x16x32_bf16 v[56:59], a[4:7], v[20:23], 0
buffer_load_dwordx4 v5, s[84:87], s66 offen offset:0 sc1 lds
v_mfma_f32_16x16x32_bf16 v[60:63], a[0:3], v[24:27], 0
ds_read_b128 v[48:51], v9 offset:6144
v_mfma_f32_16x16x32_bf16 v[64:67], a[4:7], v[24:27], 0
s_add_u32 m0, s60, 0
s_waitcnt lgkmcnt(4)
v_mfma_f32_16x16x32_bf16 v[52:55], a[8:11], v[28:31], v[52:55]
ds_read_b128 v[20:23], v8 offset:8192
v_mfma_f32_16x16x32_bf16 v[56:59], a[12:15], v[28:31], v[56:59]
buffer_load_dwordx4 v5, s[84:87], s66 offen offset:1024 sc1 lds
v_mfma_f32_16x16x32_bf16 v[60:63], a[8:11], v[32:35], v[60:63]
ds_read_b128 v[24:27], v8 offset:10240
v_mfma_f32_16x16x32_bf16 v[64:67], a[12:15], v[32:35], v[64:67]
s_add_u32 m0, s60, 8192
s_waitcnt lgkmcnt(4)
v_mfma_f32_16x16x32_bf16 v[52:55], a[16:19], v[36:39], v[52:55]
ds_read_b128 v[28:31], v9 offset:8192
v_mfma_f32_16x16x32_bf16 v[56:59], a[20:23], v[36:39], v[56:59]
buffer_load_dwordx4 v5, s[84:87], s67 offen offset:0 sc1 lds
v_mfma_f32_16x16x32_bf16 v[60:63], a[16:19], v[40:43], v[60:63]
ds_read_b128 v[32:35], v9 offset:10240
v_mfma_f32_16x16x32_bf16 v[64:67], a[20:23], v[40:43], v[64:67]
s_add_u32 m0, s60, 8192
s_waitcnt lgkmcnt(4)
v_mfma_f32_16x16x32_bf16 v[52:55], a[24:27], v[44:47], v[52:55]
ds_read_b128 v[36:39], v8 offset:12288
v_mfma_f32_16x16x32_bf16 v[56:59], a[28:31], v[44:47], v[56:59]
buffer_load_dwordx4 v5, s[84:87], s67 offen offset:1024 sc1 lds
v_mfma_f32_16x16x32_bf16 v[60:63], a[24:27], v[48:51], v[60:63]
ds_read_b128 v[40:43], v8 offset:14336
v_mfma_f32_16x16x32_bf16 v[64:67], a[28:31], v[48:51], v[64:67]
s_waitcnt lgkmcnt(4)
v_mfma_f32_16x16x32_bf16 v[52:55], a[32:35], v[20:23], v[52:55]
ds_read_b128 v[44:47], v9 offset:12288
v_mfma_f32_16x16x32_bf16 v[56:59], a[36:39], v[20:23], v[56:59]
s_cmp_eq_u32 s30, 1
s_cbranch_scc0 mega_kernel_q_ke0
s_mov_b32 m0, s61
s_nop 0
buffer_load_dwordx4 v5, s[84:87], s68 offen sc1 lds
mega_kernel_q_ke0:
v_mfma_f32_16x16x32_bf16 v[60:63], a[32:35], v[24:27], v[60:63]
ds_read_b128 v[48:51], v9 offset:14336
v_mfma_f32_16x16x32_bf16 v[64:67], a[36:39], v[24:27], v[64:67]
s_add_u32 m0, s46, 65536
s_waitcnt lgkmcnt(4)
v_mfma_f32_16x16x32_bf16 v[52:55], a[40:43], v[28:31], v[52:55]
ds_read_b128 v[20:23], v8 offset:16384
v_mfma_f32_16x16x32_bf16 v[56:59], a[44:47], v[28:31], v[56:59]
buffer_load_dwordx4 v6, s[8:11], s50 offen offset:0 lds
v_mfma_f32_16x16x32_bf16 v[60:63], a[40:43], v[32:35], v[60:63]
ds_read_b128 v[24:27], v8 offset:18432
v_mfma_f32_16x16x32_bf16 v[64:67], a[44:47], v[32:35], v[64:67]
s_add_u32 m0, s46, 69504
s_waitcnt lgkmcnt(4)
v_mfma_f32_16x16x32_bf16 v[52:55], a[48:51], v[36:39], v[52:55]
ds_read_b128 v[28:31], v9 offset:16384
v_mfma_f32_16x16x32_bf16 v[56:59], a[52:55], v[36:39], v[56:59]
buffer_load_dwordx4 v6, s[8:11], s50 offen offset:128 lds
v_mfma_f32_16x16x32_bf16 v[60:63], a[48:51], v[40:43], v[60:63]
ds_read_b128 v[32:35], v9 offset:18432
v_mfma_f32_16x16x32_bf16 v[64:67], a[52:55], v[40:43], v[64:67]
s_add_u32 m0, s46, 73472
s_waitcnt lgkmcnt(4)
v_mfma_f32_16x16x32_bf16 v[52:55], a[56:59], v[44:47], v[52:55]
ds_read_b128 v[36:39], v8 offset:20480
v_mfma_f32_16x16x32_bf16 v[56:59], a[60:63], v[44:47], v[56:59]
buffer_load_dwordx4 v6, s[8:11], s50 offen offset:256 lds
v_mfma_f32_16x16x32_bf16 v[60:63], a[56:59], v[48:51], v[60:63]
ds_read_b128 v[40:43], v8 offset:22528
v_mfma_f32_16x16x32_bf16 v[64:67], a[60:63], v[48:51], v[64:67]
s_add_u32 m0, s46, 77440
s_waitcnt lgkmcnt(4)
v_mfma_f32_16x16x32_bf16 v[52:55], a[64:67], v[20:23], v[52:55]
ds_read_b128 v[44:47], v9 offset:20480
v_mfma_f32_16x16x32_bf16 v[56:59], a[68:71], v[20:23], v[56:59]
buffer_load_dwordx4 v6, s[8:11], s50 offen offset:384 lds
v_mfma_f32_16x16x32_bf16 v[60:63], a[64:67], v[24:27], v[60:63]
ds_read_b128 v[48:51], v9 offset:22528
v_mfma_f32_16x16x32_bf16 v[64:67], a[68:71], v[24:27], v[64:67]
s_add_u32 m0, s46, 81408
s_waitcnt lgkmcnt(4)
v_mfma_f32_16x16x32_bf16 v[52:55], a[72:75], v[28:31], v[52:55]
ds_read_b128 v[20:23], v8 offset:24576
v_mfma_f32_16x16x32_bf16 v[56:59], a[76:79], v[28:31], v[56:59]
buffer_load_dwordx4 v6, s[8:11], s50 offen offset:512 lds
v_mfma_f32_16x16x32_bf16 v[60:63], a[72:75], v[32:35], v[60:63]
ds_read_b128 v[24:27], v8 offset:26624
v_mfma_f32_16x16x32_bf16 v[64:67], a[76:79], v[32:35], v[64:67]
s_add_u32 m0, s46, 85376
s_waitcnt lgkmcnt(4)
v_mfma_f32_16x16x32_bf16 v[52:55], a[80:83], v[36:39], v[52:55]
ds_read_b128 v[28:31], v9 offset:24576
v_mfma_f32_16x16x32_bf16 v[56:59], a[84:87], v[36:39], v[56:59]
buffer_load_dwordx4 v6, s[8:11], s50 offen offset:640 lds
v_mfma_f32_16x16x32_bf16 v[60:63], a[80:83], v[40:43], v[60:63]
ds_read_b128 v[32:35], v9 offset:26624
v_mfma_f32_16x16x32_bf16 v[64:67], a[84:87], v[40:43], v[64:67]
s_add_u32 m0, s46, 89344
s_waitcnt lgkmcnt(4)
v_mfma_f32_16x16x32_bf16 v[52:55], a[88:91], v[44:47], v[52:55]
ds_read_b128 v[36:39], v8 offset:28672
v_mfma_f32_16x16x32_bf16 v[56:59], a[92:95], v[44:47], v[56:59]
buffer_load_dwordx4 v6, s[8:11], s50 offen offset:768 lds
v_mfma_f32_16x16x32_bf16 v[60:63], a[88:91], v[48:51], v[60:63]
ds_read_b128 v[40:43], v8 offset:30720
v_mfma_f32_16x16x32_bf16 v[64:67], a[92:95], v[48:51], v[64:67]
s_add_u32 m0, s46, 93312
s_waitcnt lgkmcnt(4)
v_mfma_f32_16x16x32_bf16 v[52:55], a[96:99], v[20:23], v[52:55]
ds_read_b128 v[44:47], v9 offset:28672
v_mfma_f32_16x16x32_bf16 v[56:59], a[100:103], v[20:23], v[56:59]
buffer_load_dwordx4 v6, s[8:11], s50 offen offset:896 lds
v_mfma_f32_16x16x32_bf16 v[60:63], a[96:99], v[24:27], v[60:63]
ds_read_b128 v[48:51], v9 offset:30720
v_mfma_f32_16x16x32_bf16 v[64:67], a[100:103], v[24:27], v[64:67]
s_add_u32 m0, s46, 97280
s_waitcnt lgkmcnt(4)
v_mfma_f32_16x16x32_bf16 v[52:55], a[104:107], v[28:31], v[52:55]
ds_read_b128 v[20:23], v8 offset:32768
v_mfma_f32_16x16x32_bf16 v[56:59], a[108:111], v[28:31], v[56:59]
buffer_load_dwordx4 v6, s[8:11], s50 offen offset:1024 lds
v_mfma_f32_16x16x32_bf16 v[60:63], a[104:107], v[32:35], v[60:63]
ds_read_b128 v[24:27], v8 offset:34816
v_mfma_f32_16x16x32_bf16 v[64:67], a[108:111], v[32:35], v[64:67]
s_waitcnt vmcnt(13)
v_mov_b32 v17, s42
s_mov_b64 exec, 1
buffer_store_dword v17, v16, s[84:87], s49 offen sc1
s_mov_b64 exec, -1
s_add_u32 m0, s46, 101248
s_waitcnt lgkmcnt(4)
v_mfma_f32_16x16x32_bf16 v[52:55], a[112:115], v[36:39], v[52:55]
ds_read_b128 v[28:31], v9 offset:32768
v_mfma_f32_16x16x32_bf16 v[56:59], a[116:119], v[36:39], v[56:59]
buffer_load_dwordx4 v6, s[8:11], s50 offen offset:1152 lds
v_mfma_f32_16x16x32_bf16 v[60:63], a[112:115], v[40:43], v[60:63]
ds_read_b128 v[32:35], v9 offset:34816
v_mfma_f32_16x16x32_bf16 v[64:67], a[116:119], v[40:43], v[64:67]
v_mov_b32 v100, 0
s_mov_b64 exec, 1
buffer_atomic_add v100, v16, s[84:87], s62 offen sc0 sc1
s_mov_b64 exec, -1
s_add_u32 m0, s46, 105216
s_waitcnt lgkmcnt(4)
v_mfma_f32_16x16x32_bf16 v[52:55], a[120:123], v[44:47], v[52:55]
ds_read_b128 v[36:39], v8 offset:36864
v_mfma_f32_16x16x32_bf16 v[56:59], a[124:127], v[44:47], v[56:59]
buffer_load_dwordx4 v6, s[8:11], s50 offen offset:1280 lds
v_mfma_f32_16x16x32_bf16 v[60:63], a[120:123], v[48:51], v[60:63]
ds_read_b128 v[40:43], v8 offset:38912
v_mfma_f32_16x16x32_bf16 v[64:67], a[124:127], v[48:51], v[64:67]
s_add_u32 m0, s46, 109184
s_waitcnt lgkmcnt(4)
v_mfma_f32_16x16x32_bf16 v[52:55], a[128:131], v[20:23], v[52:55]
ds_read_b128 v[44:47], v9 offset:36864
v_mfma_f32_16x16x32_bf16 v[56:59], a[132:135], v[20:23], v[56:59]
buffer_load_dwordx4 v6, s[8:11], s50 offen offset:1408 lds
v_mfma_f32_16x16x32_bf16 v[60:63], a[128:131], v[24:27], v[60:63]
ds_read_b128 v[48:51], v9 offset:38912
v_mfma_f32_16x16x32_bf16 v[64:67], a[132:135], v[24:27], v[64:67]
s_add_u32 m0, s46, 113152
s_waitcnt lgkmcnt(4)
v_mfma_f32_16x16x32_bf16 v[52:55], a[136:139], v[28:31], v[52:55]
ds_read_b128 v[20:23], v8 offset:40960
v_mfma_f32_16x16x32_bf16 v[56:59], a[140:143], v[28:31], v[56:59]
buffer_load_dwordx4 v6, s[8:11], s50 offen offset:1536 lds
v_mfma_f32_16x16x32_bf16 v[60:63], a[136:139], v[32:35], v[60:63]
ds_read_b128 v[24:27], v8 offset:43008
v_mfma_f32_16x16x32_bf16 v[64:67], a[140:143], v[32:35], v[64:67]
s_add_u32 m0, s46, 117120
s_waitcnt lgkmcnt(4)
v_mfma_f32_16x16x32_bf16 v[52:55], a[144:147], v[36:39], v[52:55]
ds_read_b128 v[28:31], v9 offset:40960
v_mfma_f32_16x16x32_bf16 v[56:59], a[148:151], v[36:39], v[56:59]
buffer_load_dwordx4 v6, s[8:11], s50 offen offset:1664 lds
v_mfma_f32_16x16x32_bf16 v[60:63], a[144:147], v[40:43], v[60:63]
ds_read_b128 v[32:35], v9 offset:43008
v_mfma_f32_16x16x32_bf16 v[64:67], a[148:151], v[40:43], v[64:67]
s_add_u32 m0, s46, 121088
s_waitcnt lgkmcnt(4)
v_mfma_f32_16x16x32_bf16 v[52:55], a[152:155], v[44:47], v[52:55]
ds_read_b128 v[36:39], v8 offset:45056
v_mfma_f32_16x16x32_bf16 v[56:59], a[156:159], v[44:47], v[56:59]
buffer_load_dwordx4 v6, s[8:11], s50 offen offset:1792 lds
v_mfma_f32_16x16x32_bf16 v[60:63], a[152:155], v[48:51], v[60:63]
ds_read_b128 v[40:43], v8 offset:47104
v_mfma_f32_16x16x32_bf16 v[64:67], a[156:159], v[48:51], v[64:67]
s_add_u32 m0, s46, 125056
s_waitcnt lgkmcnt(4)
v_mfma_f32_16x16x32_bf16 v[52:55], a[160:163], v[20:23], v[52:55]
ds_read_b128 v[44:47], v9 offset:45056
v_mfma_f32_16x16x32_bf16 v[56:59], a[164:167], v[20:23], v[56:59]
buffer_load_dwordx4 v6, s[8:11], s50 offen offset:1920 lds
v_mfma_f32_16x16x32_bf16 v[60:63], a[160:163], v[24:27], v[60:63]
ds_read_b128 v[48:51], v9 offset:47104
v_mfma_f32_16x16x32_bf16 v[64:67], a[164:167], v[24:27], v[64:67]
s_waitcnt lgkmcnt(4)
v_mfma_f32_16x16x32_bf16 v[52:55], a[168:171], v[28:31], v[52:55]
ds_read_b128 v[20:23], v8 offset:49152
v_mfma_f32_16x16x32_bf16 v[56:59], a[172:175], v[28:31], v[56:59]
v_mov_b64 v[84:85], v[220:221]
v_mov_b64 v[86:87], v[222:223]
v_mfma_f32_16x16x32_bf16 v[60:63], a[168:171], v[32:35], v[60:63]
ds_read_b128 v[24:27], v8 offset:51200
v_mfma_f32_16x16x32_bf16 v[64:67], a[172:175], v[32:35], v[64:67]
v_mov_b64 v[88:89], v[224:225]
v_mov_b64 v[90:91], v[226:227]
s_waitcnt lgkmcnt(4)
v_mfma_f32_16x16x32_bf16 v[52:55], a[176:179], v[36:39], v[52:55]
ds_read_b128 v[28:31], v9 offset:49152
v_mfma_f32_16x16x32_bf16 v[56:59], a[180:183], v[36:39], v[56:59]
v_mov_b64 v[220:221], v[228:229]
v_mov_b64 v[222:223], v[230:231]
v_mfma_f32_16x16x32_bf16 v[60:63], a[176:179], v[40:43], v[60:63]
ds_read_b128 v[32:35], v9 offset:51200
v_mfma_f32_16x16x32_bf16 v[64:67], a[180:183], v[40:43], v[64:67]
v_mov_b64 v[224:225], v[232:233]
v_mov_b64 v[226:227], v[234:235]
s_waitcnt lgkmcnt(4)
v_mfma_f32_16x16x32_bf16 v[52:55], a[184:187], v[44:47], v[52:55]
ds_read_b128 v[36:39], v8 offset:53248
v_mfma_f32_16x16x32_bf16 v[56:59], a[188:191], v[44:47], v[56:59]
v_cvt_pk_bf16_f32 v228, v68, v69
v_cvt_pk_bf16_f32 v229, v70, v71
v_mfma_f32_16x16x32_bf16 v[60:63], a[184:187], v[48:51], v[60:63]
ds_read_b128 v[40:43], v8 offset:55296
v_mfma_f32_16x16x32_bf16 v[64:67], a[188:191], v[48:51], v[64:67]
v_cvt_pk_bf16_f32 v230, v72, v73
v_cvt_pk_bf16_f32 v231, v74, v75
s_waitcnt lgkmcnt(4)
v_mfma_f32_16x16x32_bf16 v[52:55], a[192:195], v[20:23], v[52:55]
ds_read_b128 v[44:47], v9 offset:53248
v_mfma_f32_16x16x32_bf16 v[56:59], a[196:199], v[20:23], v[56:59]
v_cvt_pk_bf16_f32 v232, v76, v77
v_cvt_pk_bf16_f32 v233, v78, v79
v_mfma_f32_16x16x32_bf16 v[60:63], a[192:195], v[24:27], v[60:63]
ds_read_b128 v[48:51], v9 offset:55296
v_mfma_f32_16x16x32_bf16 v[64:67], a[196:199], v[24:27], v[64:67]
v_cvt_pk_bf16_f32 v234, v80, v81
v_cvt_pk_bf16_f32 v235, v82, v83
s_waitcnt lgkmcnt(4)
v_mfma_f32_16x16x32_bf16 v[52:55], a[200:203], v[28:31], v[52:55]
ds_read_b128 v[20:23], v8 offset:57344
v_mfma_f32_16x16x32_bf16 v[56:59], a[204:207], v[28:31], v[56:59]
v_mfma_f32_16x16x32_bf16 v[60:63], a[200:203], v[32:35], v[60:63]
ds_read_b128 v[24:27], v8 offset:59392
v_mfma_f32_16x16x32_bf16 v[64:67], a[204:207], v[32:35], v[64:67]
s_waitcnt lgkmcnt(4)
v_mfma_f32_16x16x32_bf16 v[52:55], a[208:211], v[36:39], v[52:55]
ds_read_b128 v[28:31], v9 offset:57344
v_mfma_f32_16x16x32_bf16 v[56:59], a[212:215], v[36:39], v[56:59]
v_mfma_f32_16x16x32_bf16 v[60:63], a[208:211], v[40:43], v[60:63]
ds_read_b128 v[32:35], v9 offset:59392
v_mfma_f32_16x16x32_bf16 v[64:67], a[212:215], v[40:43], v[64:67]
s_waitcnt lgkmcnt(4)
v_mfma_f32_16x16x32_bf16 v[52:55], a[216:219], v[44:47], v[52:55]
ds_read_b128 v[36:39], v8 offset:61440
v_mfma_f32_16x16x32_bf16 v[56:59], a[220:223], v[44:47], v[56:59]
s_waitcnt vmcnt(6)
v_readfirstlane_b32 s56, v100
s_cmp_eq_u32 s30, 1
s_cbranch_scc1 mega_kernel_q_kf0
s_cmp_gt_i32 s56, s42
s_cbranch_scc0 mega_kernel_q_kf0
s_mov_b32 s30, 1
s_mov_b32 m0, s61
s_nop 0
buffer_load_dwordx4 v5, s[84:87], s68 offen sc1 lds
mega_kernel_q_kf0:
v_mfma_f32_16x16x32_bf16 v[60:63], a[216:219], v[48:51], v[60:63]
ds_read_b128 v[40:43], v8 offset:63488
v_mfma_f32_16x16x32_bf16 v[64:67], a[220:223], v[48:51], v[64:67]
s_waitcnt lgkmcnt(4)
v_mfma_f32_16x16x32_bf16 v[52:55], a[224:227], v[20:23], v[52:55]
ds_read_b128 v[44:47], v9 offset:61440
v_mfma_f32_16x16x32_bf16 v[56:59], a[228:231], v[20:23], v[56:59]
v_mfma_f32_16x16x32_bf16 v[60:63], a[224:227], v[24:27], v[60:63]
ds_read_b128 v[48:51], v9 offset:63488
v_mfma_f32_16x16x32_bf16 v[64:67], a[228:231], v[24:27], v[64:67]
s_waitcnt lgkmcnt(5)
v_mfma_f32_16x16x32_bf16 v[52:55], a[232:235], v[28:31], v[52:55]
v_mfma_f32_16x16x32_bf16 v[56:59], a[236:239], v[28:31], v[56:59]
s_waitcnt lgkmcnt(4)
v_mfma_f32_16x16x32_bf16 v[60:63], a[232:235], v[32:35], v[60:63]
v_mfma_f32_16x16x32_bf16 v[64:67], a[236:239], v[32:35], v[64:67]
s_waitcnt lgkmcnt(3)
v_mfma_f32_16x16x32_bf16 v[52:55], a[240:243], v[36:39], v[52:55]
v_mfma_f32_16x16x32_bf16 v[56:59], a[244:247], v[36:39], v[56:59]
s_waitcnt lgkmcnt(2)
v_mfma_f32_16x16x32_bf16 v[60:63], a[240:243], v[40:43], v[60:63]
v_mfma_f32_16x16x32_bf16 v[64:67], a[244:247], v[40:43], v[64:67]
ds_write_b128 v101, v[84:87]
ds_write_b128 v101, v[88:91] offset:1024
s_waitcnt lgkmcnt(1)
v_mfma_f32_16x16x32_bf16 v[68:71], a[248:251], v[44:47], v[52:55]
v_mfma_f32_16x16x32_bf16 v[72:75], a[252:255], v[44:47], v[56:59]
s_waitcnt lgkmcnt(0)
v_mfma_f32_16x16x32_bf16 v[76:79], a[248:251], v[48:51], v[60:63]
v_mfma_f32_16x16x32_bf16 v[80:83], a[252:255], v[48:51], v[64:67]
mega_kernel_q_jl0:
s_cmp_eq_u32 s30, 1
s_cbranch_scc1 mega_kernel_q_kl0
mega_kernel_q_kw0:
v_mov_b32 v100, 0
s_mov_b64 exec, 1
buffer_atomic_add v100, v16, s[84:87], s62 offen sc0 sc1
s_mov_b64 exec, -1
s_waitcnt vmcnt(0)
v_readfirstlane_b32 s56, v100
s_cmp_gt_i32 s56, s42
s_cbranch_scc1 mega_kernel_q_kv0
s_cmp_eq_u32 s42, 63
s_cbranch_scc1 mega_kernel_q_kw0
s_sleep 0
s_branch mega_kernel_q_kw0
mega_kernel_q_kv0:
s_mov_b32 m0, s61
s_nop 0
buffer_load_dwordx4 v5, s[84:87], s68 offen sc1 lds
mega_kernel_q_kl0:
s_waitcnt lgkmcnt(0) vmcnt(0)
s_barrier
ds_read_b128 v[184:187], v102 offset:0
ds_read_b128 v[112:115], v103 offset:0
ds_read_b128 v[128:131], v103 offset:1024
ds_read_b128 v[188:191], v102 offset:2048
ds_read_b128 v[116:119], v103 offset:2048
ds_read_b128 v[132:135], v103 offset:3072
ds_read_b128 v[192:195], v102 offset:4096
ds_read_b128 v[120:123], v103 offset:4096
ds_read_b128 v[136:139], v103 offset:5120
ds_read_b128 v[196:199], v102 offset:6144
ds_read_b128 v[124:127], v103 offset:6144
ds_read_b128 v[140:143], v103 offset:7168
s_waitcnt lgkmcnt(9)
v_mfma_f32_16x16x32_bf16 v[200:203], v[112:115], v[184:187], 0
v_mfma_f32_16x16x32_bf16 v[204:207], v[128:131], v[184:187], 0
ds_read_b128 v[160:163], v94 offset:0
s_waitcnt lgkmcnt(7)
v_mfma_f32_16x16x32_bf16 v[200:203], v[116:119], v[188:191], v[200:203]
v_mfma_f32_16x16x32_bf16 v[204:207], v[132:135], v[188:191], v[204:207]
ds_read_b128 v[164:167], v94 offset:1024
s_waitcnt lgkmcnt(5)
v_mfma_f32_16x16x32_bf16 v[200:203], v[120:123], v[192:195], v[200:203]
v_mfma_f32_16x16x32_bf16 v[204:207], v[136:139], v[192:195], v[204:207]
ds_read_b128 v[168:171], v94 offset:2048
s_waitcnt lgkmcnt(3)
v_mfma_f32_16x16x32_bf16 v[200:203], v[124:127], v[196:199], v[200:203]
v_mfma_f32_16x16x32_bf16 v[204:207], v[140:143], v[196:199], v[204:207]
ds_read_b128 v[172:175], v94 offset:3072
s_waitcnt lgkmcnt(3)
v_mfma_f32_16x16x32_bf16 v[208:211], v[160:163], v[184:187], 0
ds_read_b128 v[144:147], v240 offset:0
ds_read_b64 v[176:177], v95 offset:0
s_waitcnt lgkmcnt(4)
v_mfma_f32_16x16x32_bf16 v[208:211], v[164:167], v[188:191], v[208:211]
ds_read_b128 v[148:151], v240 offset:1024
ds_read_b64 v[178:179], v95 offset:256
s_waitcnt lgkmcnt(5)
v_mfma_f32_16x16x32_bf16 v[208:211], v[168:171], v[192:195], v[208:211]
ds_read_b128 v[152:155], v240 offset:2048
ds_read_b64 v[180:181], v95 offset:1024
s_waitcnt lgkmcnt(6)
v_mfma_f32_16x16x32_bf16 v[208:211], v[172:175], v[196:199], v[208:211]
ds_read_b128 v[156:159], v240 offset:3072
ds_read_b64 v[182:183], v95 offset:1280
v_pk_mul_f32 v[200:201], v[200:201], s[54:55] op_sel_hi:[1,0]
v_pk_mul_f32 v[202:203], v[202:203], s[54:55] op_sel_hi:[1,0]
v_pk_mul_f32 v[204:205], v[204:205], s[54:55] op_sel_hi:[1,0]
v_pk_mul_f32 v[206:207], v[206:207], s[54:55] op_sel_hi:[1,0]
v_cndmask_b32 v200, v200, v241, s[12:13]
v_cndmask_b32 v201, v201, v241, s[14:15]
v_cndmask_b32 v202, v202, v241, s[16:17]
v_cndmask_b32 v203, v203, v241, s[18:19]
v_cndmask_b32 v204, v204, v241, s[20:21]
v_cndmask_b32 v205, v205, v241, s[22:23]
v_cndmask_b32 v206, v206, v241, s[24:25]
v_cndmask_b32 v207, v207, v241, s[26:27]
v_pk_mul_f32 v[208:209], v[208:209], s[54:55] op_sel_hi:[1,0]
v_pk_mul_f32 v[210:211], v[210:211], s[54:55] op_sel_hi:[1,0]
v_cndmask_b32 v208, v208, v97, s[28:29]
v_cndmask_b32 v209, v209, v97, s[28:29]
v_cndmask_b32 v210, v210, v97, s[28:29]
v_cndmask_b32 v211, v211, v97, s[28:29]
v_max3_f32 v236, v200, v201, v202
v_max3_f32 v236, v236, v203, v204
v_max3_f32 v236, v236, v205, v206
v_max3_f32 v236, v236, v207, v208
v_max3_f32 v236, v236, v209, v210
v_max_f32 v237, v236, v211
v_max_f32 v236, v236, v211
s_nop 1
v_permlane16_swap_b32 v236, v237
s_nop 0
v_max_f32 v238, v236, v237
v_max_f32 v239, v236, v237
s_nop 1
v_permlane32_swap_b32 v238, v239
s_nop 0
v_max_f32 v236, v238, v239
v_pk_add_f32 v[200:201], v[200:201], v[236:237] op_sel_hi:[1,0] neg_lo:[0,1] neg_hi:[0,1]
v_pk_add_f32 v[202:203], v[202:203], v[236:237] op_sel_hi:[1,0] neg_lo:[0,1] neg_hi:[0,1]
v_pk_add_f32 v[204:205], v[204:205], v[236:237] op_sel_hi:[1,0] neg_lo:[0,1] neg_hi:[0,1]
v_pk_add_f32 v[206:207], v[206:207], v[236:237] op_sel_hi:[1,0] neg_lo:[0,1] neg_hi:[0,1]
v_pk_add_f32 v[208:209], v[208:209], v[236:237] op_sel_hi:[1,0] neg_lo:[0,1] neg_hi:[0,1]
v_pk_add_f32 v[210:211], v[210:211], v[236:237] op_sel_hi:[1,0] neg_lo:[0,1] neg_hi:[0,1]
v_exp_f32 v200, v200
v_exp_f32 v201, v201
v_exp_f32 v202, v202
v_exp_f32 v203, v203
v_exp_f32 v204, v204
v_exp_f32 v205, v205
v_exp_f32 v206, v206
v_exp_f32 v207, v207
v_exp_f32 v208, v208
v_exp_f32 v209, v209
v_exp_f32 v210, v210
v_exp_f32 v211, v211
s_nop 0
v_cvt_pk_bf16_f32 v212, v200, v201
v_cvt_pk_bf16_f32 v213, v202, v203
v_cvt_pk_bf16_f32 v214, v204, v205
v_cvt_pk_bf16_f32 v215, v206, v207
v_cvt_pk_bf16_f32 v216, v208, v209
v_cvt_pk_bf16_f32 v217, v210, v211
s_waitcnt lgkmcnt(0)
s_nop 0
v_mfma_f32_16x16x32_bf16 v[108:111], v[104:107], v[212:215], 0
v_mfma_f32_16x16x32_bf16 v[112:115], v[144:147], v[212:215], 0
v_mfma_f32_16x16x32_bf16 v[116:119], v[148:151], v[212:215], 0
v_mfma_f32_16x16x32_bf16 v[120:123], v[152:155], v[212:215], 0
v_mfma_f32_16x16x32_bf16 v[124:127], v[156:159], v[212:215], 0
v_mfma_f32_16x16x16_bf16 v[108:111], v[104:105], v[216:217], v[108:111]
v_mfma_f32_16x16x16_bf16 v[112:115], v[176:177], v[216:217], v[112:115]
v_mfma_f32_16x16x16_bf16 v[116:119], v[178:179], v[216:217], v[116:119]
v_mfma_f32_16x16x16_bf16 v[120:123], v[180:181], v[216:217], v[120:123]
v_mfma_f32_16x16x16_bf16 v[124:127], v[182:183], v[216:217], v[124:127]
s_lshr_b32 s63, s42, 2
s_xnor_b32 s63, s63, s98
s_and_b32 s63, s63, 1
s_lshl_b32 s63, s63, 13
s_lshl_b32 s51, s42, 19
s_add_u32 s51, s51, s63
s_nop 2
v_rcp_f32 v238, v108
v_rcp_f32 v239, v109
s_nop 1
v_pk_mul_f32 v[112:113], v[112:113], v[238:239]
v_pk_mul_f32 v[114:115], v[114:115], v[238:239]
v_pk_mul_f32 v[116:117], v[116:117], v[238:239]
v_pk_mul_f32 v[118:119], v[118:119], v[238:239]
v_pk_mul_f32 v[120:121], v[120:121], v[238:239]
v_pk_mul_f32 v[122:123], v[122:123], v[238:239]
v_pk_mul_f32 v[124:125], v[124:125], v[238:239]
v_pk_mul_f32 v[126:127], v[126:127], v[238:239]
v_cvt_pk_bf16_f32 v200, v112, v113
v_cvt_pk_bf16_f32 v201, v114, v115
v_cvt_pk_bf16_f32 v202, v116, v117
v_cvt_pk_bf16_f32 v203, v118, v119
v_cvt_pk_bf16_f32 v204, v120, v121
v_cvt_pk_bf16_f32 v205, v122, v123
v_cvt_pk_bf16_f32 v206, v124, v125
v_cvt_pk_bf16_f32 v207, v126, v127
buffer_store_dwordx4 v[200:203], v96, s[84:87], s51 offen sc1
buffer_store_dwordx4 v[204:207], v96, s[84:87], s51 offen offset:2048 sc1
s_add_u32 s42, s42, 1
s_cmp_lt_u32 s42, 64
s_cbranch_scc1 mega_kernel_q_loop
s_waitcnt vmcnt(0)
v_mov_b32 v17, s42
s_mov_b64 exec, 1
buffer_store_dword v17, v16, s[84:87], s49 offen sc1
s_mov_b64 exec, -1
mega_kernel_q_quit:
s_endpgm
mega_kernel_rd:
s_mov_b32 s93, s40
s_load_dwordx2 s[4:5], s[0:1], 56
s_mov_b32 s48, 0x3f7ec46d
s_mov_b32 s49, 0x3dc8bd36
s_mov_b32 s50, 0x3f7b14be
s_mov_b32 s51, 0x3e47c5c2
s_mov_b32 s52, 0x3f74fa0b
s_mov_b32 s53, 0x3e94a031
s_mov_b32 s54, 0x3f6c835e
s_mov_b32 s55, 0x3ec3ef15
s_mov_b32 s56, 0x3f61c598
s_mov_b32 s57, 0x3ef15aea
s_mov_b32 s58, 0x3f54db31
s_mov_b32 s59, 0x3f0e39da
s_mov_b32 s60, 0x3f45e403
s_mov_b32 s61, 0x3f226799
s_mov_b32 s62, 0x3f3504f3
s_mov_b32 s63, 0x3f3504f3
v_and_b32 v1, 31, v0
v_lshrrev_b32 v2, 5, v0
v_cvt_f32_u32 v3, v1
v_mul_u32_u24 v10, 8448, v2
v_lshl_add_u32 v4, v1, 3, v10
v_mul_u32_u24 v5, 264, v1
v_add_u32 v5, v5, v10
v_and_b32 v11, 7, v0
v_lshrrev_b32 v9, 3, v0
v_mul_u32_u24 v10, 8448, v11
v_lshl_add_u32 v6, v9, 3, v10
v_lshlrev_b32 v7, 3, v9
v_sub_u32 v7, v10, v7
v_add_u32 v7, 4096, v7
v_mul_u32_u24 v8, 32768, v9
v_lshl_add_u32 v8, v11, 4, v8
v_mul_f32 v12, 0xba800000, v3
v_cos_f32 v82, v12
v_sin_f32 v83, v12
v_mul_f32 v12, 0xbb000000, v3
v_cos_f32 v84, v12
v_sin_f32 v85, v12
v_mul_f32 v12, 0xbb400000, v3
v_cos_f32 v86, v12
v_sin_f32 v87, v12
v_mul_f32 v12, 0xbb800000, v3
v_cos_f32 v88, v12
v_sin_f32 v89, v12
v_mul_f32 v12, 0xbba00000, v3
v_cos_f32 v90, v12
v_sin_f32 v91, v12
v_mul_f32 v12, 0xbbc00000, v3
v_cos_f32 v92, v12
v_sin_f32 v93, v12
v_mul_f32 v12, 0xbbe00000, v3
v_cos_f32 v94, v12
v_sin_f32 v95, v12
v_mul_f32 v12, 0xbc000000, v3
v_cos_f32 v96, v12
v_sin_f32 v97, v12
v_mul_f32 v12, 0xbc100000, v3
v_cos_f32 v98, v12
v_sin_f32 v99, v12
v_mul_f32 v12, 0xbc200000, v3
v_cos_f32 v100, v12
v_sin_f32 v101, v12
v_mul_f32 v12, 0xbc300000, v3
v_cos_f32 v102, v12
v_sin_f32 v103, v12
v_mul_f32 v12, 0xbc400000, v3
v_cos_f32 v104, v12
v_sin_f32 v105, v12
v_mul_f32 v12, 0xbc500000, v3
v_cos_f32 v106, v12
v_sin_f32 v107, v12
v_mul_f32 v12, 0xbc600000, v3
v_cos_f32 v108, v12
v_sin_f32 v109, v12
v_mul_f32 v12, 0xbc700000, v3
v_cos_f32 v110, v12
v_sin_f32 v111, v12
v_mul_f32 v12, 0xbc800000, v3
v_cos_f32 v112, v12
v_sin_f32 v113, v12
v_mul_f32 v12, 0xbc880000, v3
v_cos_f32 v114, v12
v_sin_f32 v115, v12
v_mul_f32 v12, 0xbc900000, v3
v_cos_f32 v116, v12
v_sin_f32 v117, v12
v_mul_f32 v12, 0xbc980000, v3
v_cos_f32 v118, v12
v_sin_f32 v119, v12
v_mul_f32 v12, 0xbca00000, v3
v_cos_f32 v120, v12
v_sin_f32 v121, v12
v_mul_f32 v12, 0xbca80000, v3
v_cos_f32 v122, v12
v_sin_f32 v123, v12
v_mul_f32 v12, 0xbcb00000, v3
v_cos_f32 v124, v12
v_sin_f32 v125, v12
v_mul_f32 v12, 0xbcb80000, v3
v_cos_f32 v126, v12
v_sin_f32 v127, v12
v_mul_f32 v12, 0xbcc00000, v3
v_cos_f32 v128, v12
v_sin_f32 v129, v12
v_mul_f32 v12, 0xbcc80000, v3
v_cos_f32 v130, v12
v_sin_f32 v131, v12
v_mul_f32 v12, 0xbcd00000, v3
v_cos_f32 v132, v12
v_sin_f32 v133, v12
v_mul_f32 v12, 0xbcd80000, v3
v_cos_f32 v134, v12
v_sin_f32 v135, v12
v_mul_f32 v12, 0xbce00000, v3
v_cos_f32 v136, v12
v_sin_f32 v137, v12
v_mul_f32 v12, 0xbce80000, v3
v_cos_f32 v138, v12
v_sin_f32 v139, v12
v_mul_f32 v12, 0xbcf00000, v3
v_cos_f32 v140, v12
v_sin_f32 v141, v12
v_mul_f32 v12, 0xbcf80000, v3
v_cos_f32 v142, v12
v_sin_f32 v143, v12
v_lshlrev_b32 v12, 12, v2
v_lshl_add_u32 v12, v1, 1, v12
s_waitcnt lgkmcnt(0)
s_mov_b32 s6, 4194304
s_mov_b32 s7, 0x00020000
v_mov_b32 v144, 0
v_mov_b32 v145, 0
v_mov_b32 v146, 0
v_mov_b32 v147, 0
v_mov_b32 v148, 0
v_mov_b32 v149, 0
v_mov_b32 v150, 0
v_mov_b32 v151, 0
v_mov_b32 v152, 0
v_mov_b32 v153, 0
v_mov_b32 v154, 0
v_mov_b32 v155, 0
v_mov_b32 v156, 0
v_mov_b32 v157, 0
v_mov_b32 v158, 0
v_mov_b32 v159, 0
v_mov_b32 v160, 0
v_mov_b32 v161, 0
v_mov_b32 v162, 0
v_mov_b32 v163, 0
v_mov_b32 v164, 0
v_mov_b32 v165, 0
v_mov_b32 v166, 0
v_mov_b32 v167, 0
v_mov_b32 v168, 0
v_mov_b32 v169, 0
v_mov_b32 v170, 0
v_mov_b32 v171, 0
v_mov_b32 v172, 0
v_mov_b32 v173, 0
v_mov_b32 v174, 0
v_mov_b32 v175, 0
v_mov_b32 v176, 0
v_mov_b32 v177, 0
v_mov_b32 v178, 0
v_mov_b32 v179, 0
v_mov_b32 v180, 0
v_mov_b32 v181, 0
v_mov_b32 v182, 0
v_mov_b32 v183, 0
v_mov_b32 v184, 0
v_mov_b32 v185, 0
v_mov_b32 v186, 0
v_mov_b32 v187, 0
v_mov_b32 v188, 0
v_mov_b32 v189, 0
v_mov_b32 v190, 0
v_mov_b32 v191, 0
v_mov_b32 v192, 0
v_mov_b32 v193, 0
v_mov_b32 v194, 0
v_mov_b32 v195, 0
v_mov_b32 v196, 0
v_mov_b32 v197, 0
v_mov_b32 v198, 0
v_mov_b32 v199, 0
v_mov_b32 v200, 0
v_mov_b32 v201, 0
v_mov_b32 v202, 0
v_mov_b32 v203, 0
v_mov_b32 v204, 0
v_mov_b32 v205, 0
v_mov_b32 v206, 0
v_mov_b32 v207, 0
s_cmp_lt_u32 s93, 128
s_cbranch_scc0 mega_kernel_f1_e
s_lshl_b32 s12, s93, 15
buffer_load_short_d16_hi v144, v12, s[4:7], s12 offen offset:0
buffer_load_short_d16_hi v145, v12, s[4:7], s12 offen offset:2048
buffer_load_short_d16_hi v176, v12, s[4:7], s12 offen offset:1024
buffer_load_short_d16_hi v177, v12, s[4:7], s12 offen offset:3072
buffer_load_short_d16_hi v146, v12, s[4:7], s12 offen offset:64
buffer_load_short_d16_hi v147, v12, s[4:7], s12 offen offset:2112
buffer_load_short_d16_hi v178, v12, s[4:7], s12 offen offset:1088
buffer_load_short_d16_hi v179, v12, s[4:7], s12 offen offset:3136
buffer_load_short_d16_hi v148, v12, s[4:7], s12 offen offset:128
buffer_load_short_d16_hi v149, v12, s[4:7], s12 offen offset:2176
buffer_load_short_d16_hi v180, v12, s[4:7], s12 offen offset:1152
buffer_load_short_d16_hi v181, v12, s[4:7], s12 offen offset:3200
buffer_load_short_d16_hi v150, v12, s[4:7], s12 offen offset:192
buffer_load_short_d16_hi v151, v12, s[4:7], s12 offen offset:2240
buffer_load_short_d16_hi v182, v12, s[4:7], s12 offen offset:1216
buffer_load_short_d16_hi v183, v12, s[4:7], s12 offen offset:3264
buffer_load_short_d16_hi v152, v12, s[4:7], s12 offen offset:256
buffer_load_short_d16_hi v153, v12, s[4:7], s12 offen offset:2304
buffer_load_short_d16_hi v184, v12, s[4:7], s12 offen offset:1280
buffer_load_short_d16_hi v185, v12, s[4:7], s12 offen offset:3328
buffer_load_short_d16_hi v154, v12, s[4:7], s12 offen offset:320
buffer_load_short_d16_hi v155, v12, s[4:7], s12 offen offset:2368
buffer_load_short_d16_hi v186, v12, s[4:7], s12 offen offset:1344
buffer_load_short_d16_hi v187, v12, s[4:7], s12 offen offset:3392
buffer_load_short_d16_hi v156, v12, s[4:7], s12 offen offset:384
buffer_load_short_d16_hi v157, v12, s[4:7], s12 offen offset:2432
buffer_load_short_d16_hi v188, v12, s[4:7], s12 offen offset:1408
buffer_load_short_d16_hi v189, v12, s[4:7], s12 offen offset:3456
buffer_load_short_d16_hi v158, v12, s[4:7], s12 offen offset:448
buffer_load_short_d16_hi v159, v12, s[4:7], s12 offen offset:2496
buffer_load_short_d16_hi v190, v12, s[4:7], s12 offen offset:1472
buffer_load_short_d16_hi v191, v12, s[4:7], s12 offen offset:3520
buffer_load_short_d16_hi v160, v12, s[4:7], s12 offen offset:512
buffer_load_short_d16_hi v161, v12, s[4:7], s12 offen offset:2560
buffer_load_short_d16_hi v192, v12, s[4:7], s12 offen offset:1536
buffer_load_short_d16_hi v193, v12, s[4:7], s12 offen offset:3584
buffer_load_short_d16_hi v162, v12, s[4:7], s12 offen offset:576
buffer_load_short_d16_hi v163, v12, s[4:7], s12 offen offset:2624
buffer_load_short_d16_hi v194, v12, s[4:7], s12 offen offset:1600
buffer_load_short_d16_hi v195, v12, s[4:7], s12 offen offset:3648
buffer_load_short_d16_hi v164, v12, s[4:7], s12 offen offset:640
buffer_load_short_d16_hi v165, v12, s[4:7], s12 offen offset:2688
buffer_load_short_d16_hi v196, v12, s[4:7], s12 offen offset:1664
buffer_load_short_d16_hi v197, v12, s[4:7], s12 offen offset:3712
buffer_load_short_d16_hi v166, v12, s[4:7], s12 offen offset:704
buffer_load_short_d16_hi v167, v12, s[4:7], s12 offen offset:2752
buffer_load_short_d16_hi v198, v12, s[4:7], s12 offen offset:1728
buffer_load_short_d16_hi v199, v12, s[4:7], s12 offen offset:3776
buffer_load_short_d16_hi v168, v12, s[4:7], s12 offen offset:768
buffer_load_short_d16_hi v169, v12, s[4:7], s12 offen offset:2816
buffer_load_short_d16_hi v200, v12, s[4:7], s12 offen offset:1792
buffer_load_short_d16_hi v201, v12, s[4:7], s12 offen offset:3840
buffer_load_short_d16_hi v170, v12, s[4:7], s12 offen offset:832
buffer_load_short_d16_hi v171, v12, s[4:7], s12 offen offset:2880
buffer_load_short_d16_hi v202, v12, s[4:7], s12 offen offset:1856
buffer_load_short_d16_hi v203, v12, s[4:7], s12 offen offset:3904
buffer_load_short_d16_hi v172, v12, s[4:7], s12 offen offset:896
buffer_load_short_d16_hi v173, v12, s[4:7], s12 offen offset:2944
buffer_load_short_d16_hi v204, v12, s[4:7], s12 offen offset:1920
buffer_load_short_d16_hi v205, v12, s[4:7], s12 offen offset:3968
buffer_load_short_d16_hi v174, v12, s[4:7], s12 offen offset:960
buffer_load_short_d16_hi v175, v12, s[4:7], s12 offen offset:3008
buffer_load_short_d16_hi v206, v12, s[4:7], s12 offen offset:1984
buffer_load_short_d16_hi v207, v12, s[4:7], s12 offen offset:4032
s_waitcnt vmcnt(0)
mega_kernel_f1_l:
s_add_u32 s21, s93, 32
s_cmp_lt_u32 s21, 128
s_cselect_b32 s22, s21, s93
s_waitcnt vmcnt(17)
v_pk_add_f32 v[48:49], v[144:145], v[176:177] neg_lo:[0,1] neg_hi:[0,1]
v_pk_add_f32 v[16:17], v[144:145], v[176:177]
v_pk_add_f32 v[14:15], v[146:147], v[178:179] neg_lo:[0,1] neg_hi:[0,1]
v_pk_add_f32 v[18:19], v[146:147], v[178:179]
v_pk_mul_f32 v[50:51], v[14:15], s[50:51] op_sel:[0,0] op_sel_hi:[0,1] neg_lo:[0,0] neg_hi:[0,1]
v_pk_fma_f32 v[50:51], v[14:15], s[50:51], v[50:51] op_sel:[1,1,0] op_sel_hi:[1,0,1] neg_lo:[0,0,0] neg_hi:[0,0,0]
v_pk_add_f32 v[14:15], v[148:149], v[180:181] neg_lo:[0,1] neg_hi:[0,1]
v_pk_add_f32 v[20:21], v[148:149], v[180:181]
v_pk_mul_f32 v[52:53], v[14:15], s[54:55] op_sel:[0,0] op_sel_hi:[0,1] neg_lo:[0,0] neg_hi:[0,1]
v_pk_fma_f32 v[52:53], v[14:15], s[54:55], v[52:53] op_sel:[1,1,0] op_sel_hi:[1,0,1] neg_lo:[0,0,0] neg_hi:[0,0,0]
v_pk_add_f32 v[14:15], v[150:151], v[182:183] neg_lo:[0,1] neg_hi:[0,1]
v_pk_add_f32 v[22:23], v[150:151], v[182:183]
v_pk_mul_f32 v[54:55], v[14:15], s[58:59] op_sel:[0,0] op_sel_hi:[0,1] neg_lo:[0,0] neg_hi:[0,1]
v_pk_fma_f32 v[54:55], v[14:15], s[58:59], v[54:55] op_sel:[1,1,0] op_sel_hi:[1,0,1] neg_lo:[0,0,0] neg_hi:[0,0,0]
v_pk_add_f32 v[14:15], v[152:153], v[184:185] neg_lo:[0,1] neg_hi:[0,1]
v_pk_add_f32 v[24:25], v[152:153], v[184:185]
v_pk_mul_f32 v[56:57], v[14:15], s[62:63] op_sel:[0,0] op_sel_hi:[0,1] neg_lo:[0,0] neg_hi:[0,1]
v_pk_fma_f32 v[56:57], v[14:15], s[62:63], v[56:57] op_sel:[1,1,0] op_sel_hi:[1,0,1] neg_lo:[0,0,0] neg_hi:[0,0,0]
v_pk_add_f32 v[14:15], v[154:155], v[186:187] neg_lo:[0,1] neg_hi:[0,1]
v_pk_add_f32 v[26:27], v[154:155], v[186:187]
v_pk_mul_f32 v[58:59], v[14:15], s[58:59] op_sel:[0,1] op_sel_hi:[0,0] neg_lo:[0,0] neg_hi:[0,1]
v_pk_fma_f32 v[58:59], v[14:15], s[58:59], v[58:59] op_sel:[1,0,0] op_sel_hi:[1,1,1] neg_lo:[0,0,0] neg_hi:[0,0,0]
v_pk_add_f32 v[14:15], v[156:157], v[188:189] neg_lo:[0,1] neg_hi:[0,1]
v_pk_add_f32 v[28:29], v[156:157], v[188:189]
v_pk_mul_f32 v[60:61], v[14:15], s[54:55] op_sel:[0,1] op_sel_hi:[0,0] neg_lo:[0,0] neg_hi:[0,1]
v_pk_fma_f32 v[60:61], v[14:15], s[54:55], v[60:61] op_sel:[1,0,0] op_sel_hi:[1,1,1] neg_lo:[0,0,0] neg_hi:[0,0,0]
v_pk_add_f32 v[14:15], v[158:159], v[190:191] neg_lo:[0,1] neg_hi:[0,1]
v_pk_add_f32 v[30:31], v[158:159], v[190:191]
v_pk_mul_f32 v[62:63], v[14:15], s[50:51] op_sel:[0,1] op_sel_hi:[0,0] neg_lo:[0,0] neg_hi:[0,1]
v_pk_fma_f32 v[62:63], v[14:15], s[50:51], v[62:63] op_sel:[1,0,0] op_sel_hi:[1,1,1] neg_lo:[0,0,0] neg_hi:[0,0,0]
v_pk_add_f32 v[64:65], v[160:161], v[192:193] op_sel:[1,1] op_sel_hi:[0,0] neg_lo:[0,1] neg_hi:[1,0]
v_pk_add_f32 v[32:33], v[160:161], v[192:193]
v_pk_add_f32 v[14:15], v[162:163], v[194:195] neg_lo:[0,1] neg_hi:[0,1]
v_pk_add_f32 v[34:35], v[162:163], v[194:195]
v_pk_mul_f32 v[66:67], v[14:15], s[50:51] op_sel:[0,1] op_sel_hi:[0,0] neg_lo:[0,1] neg_hi:[0,1]
v_pk_fma_f32 v[66:67], v[14:15], s[50:51], v[66:67] op_sel:[1,0,0] op_sel_hi:[1,1,1] neg_lo:[0,0,0] neg_hi:[0,1,0]
v_pk_add_f32 v[14:15], v[164:165], v[196:197] neg_lo:[0,1] neg_hi:[0,1]
v_pk_add_f32 v[36:37], v[164:165], v[196:197]
v_pk_mul_f32 v[68:69], v[14:15], s[54:55] op_sel:[0,1] op_sel_hi:[0,0] neg_lo:[0,1] neg_hi:[0,1]
v_pk_fma_f32 v[68:69], v[14:15], s[54:55], v[68:69] op_sel:[1,0,0] op_sel_hi:[1,1,1] neg_lo:[0,0,0] neg_hi:[0,1,0]
v_pk_add_f32 v[14:15], v[166:167], v[198:199] neg_lo:[0,1] neg_hi:[0,1]
v_pk_add_f32 v[38:39], v[166:167], v[198:199]
v_pk_mul_f32 v[70:71], v[14:15], s[58:59] op_sel:[0,1] op_sel_hi:[0,0] neg_lo:[0,1] neg_hi:[0,1]
v_pk_fma_f32 v[70:71], v[14:15], s[58:59], v[70:71] op_sel:[1,0,0] op_sel_hi:[1,1,1] neg_lo:[0,0,0] neg_hi:[0,1,0]
v_pk_add_f32 v[14:15], v[168:169], v[200:201] neg_lo:[0,1] neg_hi:[0,1]
v_pk_add_f32 v[40:41], v[168:169], v[200:201]
v_pk_mul_f32 v[72:73], v[14:15], s[62:63] op_sel:[0,0] op_sel_hi:[0,1] neg_lo:[0,1] neg_hi:[0,1]
v_pk_fma_f32 v[72:73], v[14:15], s[62:63], v[72:73] op_sel:[1,1,0] op_sel_hi:[1,0,1] neg_lo:[0,0,0] neg_hi:[0,1,0]
v_pk_add_f32 v[14:15], v[170:171], v[202:203] neg_lo:[0,1] neg_hi:[0,1]
v_pk_add_f32 v[42:43], v[170:171], v[202:203]
v_pk_mul_f32 v[74:75], v[14:15], s[58:59] op_sel:[0,0] op_sel_hi:[0,1] neg_lo:[0,1] neg_hi:[0,1]
v_pk_fma_f32 v[74:75], v[14:15], s[58:59], v[74:75] op_sel:[1,1,0] op_sel_hi:[1,0,1] neg_lo:[0,0,0] neg_hi:[0,1,0]
v_pk_add_f32 v[14:15], v[172:173], v[204:205] neg_lo:[0,1] neg_hi:[0,1]
v_pk_add_f32 v[44:45], v[172:173], v[204:205]
v_pk_mul_f32 v[76:77], v[14:15], s[54:55] op_sel:[0,0] op_sel_hi:[0,1] neg_lo:[0,1] neg_hi:[0,1]
v_pk_fma_f32 v[76:77], v[14:15], s[54:55], v[76:77] op_sel:[1,1,0] op_sel_hi:[1,0,1] neg_lo:[0,0,0] neg_hi:[0,1,0]
v_pk_add_f32 v[14:15], v[174:175], v[206:207] neg_lo:[0,1] neg_hi:[0,1]
v_pk_add_f32 v[46:47], v[174:175], v[206:207]
v_pk_mul_f32 v[78:79], v[14:15], s[50:51] op_sel:[0,0] op_sel_hi:[0,1] neg_lo:[0,1] neg_hi:[0,1]
v_pk_fma_f32 v[78:79], v[14:15], s[50:51], v[78:79] op_sel:[1,1,0] op_sel_hi:[1,0,1] neg_lo:[0,0,0] neg_hi:[0,1,0]
s_lshl_b32 s12, s22, 15
buffer_load_short_d16_hi v144, v12, s[4:7], s12 offen offset:0
buffer_load_short_d16_hi v145, v12, s[4:7], s12 offen offset:2048
buffer_load_short_d16_hi v176, v12, s[4:7], s12 offen offset:1024
buffer_load_short_d16_hi v177, v12, s[4:7], s12 offen offset:3072
buffer_load_short_d16_hi v146, v12, s[4:7], s12 offen offset:64
buffer_load_short_d16_hi v147, v12, s[4:7], s12 offen offset:2112
buffer_load_short_d16_hi v178, v12, s[4:7], s12 offen offset:1088
buffer_load_short_d16_hi v179, v12, s[4:7], s12 offen offset:3136
buffer_load_short_d16_hi v148, v12, s[4:7], s12 offen offset:128
buffer_load_short_d16_hi v149, v12, s[4:7], s12 offen offset:2176
buffer_load_short_d16_hi v180, v12, s[4:7], s12 offen offset:1152
buffer_load_short_d16_hi v181, v12, s[4:7], s12 offen offset:3200
buffer_load_short_d16_hi v150, v12, s[4:7], s12 offen offset:192
buffer_load_short_d16_hi v151, v12, s[4:7], s12 offen offset:2240
buffer_load_short_d16_hi v182, v12, s[4:7], s12 offen offset:1216
buffer_load_short_d16_hi v183, v12, s[4:7], s12 offen offset:3264
buffer_load_short_d16_hi v152, v12, s[4:7], s12 offen offset:256
buffer_load_short_d16_hi v153, v12, s[4:7], s12 offen offset:2304
buffer_load_short_d16_hi v184, v12, s[4:7], s12 offen offset:1280
buffer_load_short_d16_hi v185, v12, s[4:7], s12 offen offset:3328
buffer_load_short_d16_hi v154, v12, s[4:7], s12 offen offset:320
buffer_load_short_d16_hi v155, v12, s[4:7], s12 offen offset:2368
buffer_load_short_d16_hi v186, v12, s[4:7], s12 offen offset:1344
buffer_load_short_d16_hi v187, v12, s[4:7], s12 offen offset:3392
buffer_load_short_d16_hi v156, v12, s[4:7], s12 offen offset:384
buffer_load_short_d16_hi v157, v12, s[4:7], s12 offen offset:2432
buffer_load_short_d16_hi v188, v12, s[4:7], s12 offen offset:1408
buffer_load_short_d16_hi v189, v12, s[4:7], s12 offen offset:3456
buffer_load_short_d16_hi v158, v12, s[4:7], s12 offen offset:448
buffer_load_short_d16_hi v159, v12, s[4:7], s12 offen offset:2496
buffer_load_short_d16_hi v190, v12, s[4:7], s12 offen offset:1472
buffer_load_short_d16_hi v191, v12, s[4:7], s12 offen offset:3520
buffer_load_short_d16_hi v160, v12, s[4:7], s12 offen offset:512
buffer_load_short_d16_hi v161, v12, s[4:7], s12 offen offset:2560
buffer_load_short_d16_hi v192, v12, s[4:7], s12 offen offset:1536
buffer_load_short_d16_hi v193, v12, s[4:7], s12 offen offset:3584
buffer_load_short_d16_hi v162, v12, s[4:7], s12 offen offset:576
buffer_load_short_d16_hi v163, v12, s[4:7], s12 offen offset:2624
buffer_load_short_d16_hi v194, v12, s[4:7], s12 offen offset:1600
buffer_load_short_d16_hi v195, v12, s[4:7], s12 offen offset:3648
buffer_load_short_d16_hi v164, v12, s[4:7], s12 offen offset:640
buffer_load_short_d16_hi v165, v12, s[4:7], s12 offen offset:2688
buffer_load_short_d16_hi v196, v12, s[4:7], s12 offen offset:1664
buffer_load_short_d16_hi v197, v12, s[4:7], s12 offen offset:3712
buffer_load_short_d16_hi v166, v12, s[4:7], s12 offen offset:704
buffer_load_short_d16_hi v167, v12, s[4:7], s12 offen offset:2752
buffer_load_short_d16_hi v198, v12, s[4:7], s12 offen offset:1728
buffer_load_short_d16_hi v199, v12, s[4:7], s12 offen offset:3776
buffer_load_short_d16_hi v168, v12, s[4:7], s12 offen offset:768
buffer_load_short_d16_hi v169, v12, s[4:7], s12 offen offset:2816
buffer_load_short_d16_hi v200, v12, s[4:7], s12 offen offset:1792
buffer_load_short_d16_hi v201, v12, s[4:7], s12 offen offset:3840
buffer_load_short_d16_hi v170, v12, s[4:7], s12 offen offset:832
buffer_load_short_d16_hi v171, v12, s[4:7], s12 offen offset:2880
buffer_load_short_d16_hi v202, v12, s[4:7], s12 offen offset:1856
buffer_load_short_d16_hi v203, v12, s[4:7], s12 offen offset:3904
buffer_load_short_d16_hi v172, v12, s[4:7], s12 offen offset:896
buffer_load_short_d16_hi v173, v12, s[4:7], s12 offen offset:2944
buffer_load_short_d16_hi v204, v12, s[4:7], s12 offen offset:1920
buffer_load_short_d16_hi v205, v12, s[4:7], s12 offen offset:3968
buffer_load_short_d16_hi v174, v12, s[4:7], s12 offen offset:960
buffer_load_short_d16_hi v175, v12, s[4:7], s12 offen offset:3008
buffer_load_short_d16_hi v206, v12, s[4:7], s12 offen offset:1984
buffer_load_short_d16_hi v207, v12, s[4:7], s12 offen offset:4032
v_pk_add_f32 v[14:15], v[16:17], v[32:33] neg_lo:[0,1] neg_hi:[0,1]
v_pk_add_f32 v[16:17], v[16:17], v[32:33]
v_pk_add_f32 v[32:33], v[18:19], v[34:35] neg_lo:[0,1] neg_hi:[0,1]
v_pk_add_f32 v[18:19], v[18:19], v[34:35]
v_pk_mul_f32 v[34:35], v[32:33], s[54:55] op_sel:[0,0] op_sel_hi:[0,1] neg_lo:[0,0] neg_hi:[0,1]
v_pk_fma_f32 v[34:35], v[32:33], s[54:55], v[34:35] op_sel:[1,1,0] op_sel_hi:[1,0,1] neg_lo:[0,0,0] neg_hi:[0,0,0]
v_pk_add_f32 v[32:33], v[20:21], v[36:37] neg_lo:[0,1] neg_hi:[0,1]
v_pk_add_f32 v[20:21], v[20:21], v[36:37]
v_pk_mul_f32 v[36:37], v[32:33], s[62:63] op_sel:[0,0] op_sel_hi:[0,1] neg_lo:[0,0] neg_hi:[0,1]
v_pk_fma_f32 v[36:37], v[32:33], s[62:63], v[36:37] op_sel:[1,1,0] op_sel_hi:[1,0,1] neg_lo:[0,0,0] neg_hi:[0,0,0]
v_pk_add_f32 v[32:33], v[22:23], v[38:39] neg_lo:[0,1] neg_hi:[0,1]
v_pk_add_f32 v[22:23], v[22:23], v[38:39]
v_pk_mul_f32 v[38:39], v[32:33], s[54:55] op_sel:[0,1] op_sel_hi:[0,0] neg_lo:[0,0] neg_hi:[0,1]
v_pk_fma_f32 v[38:39], v[32:33], s[54:55], v[38:39] op_sel:[1,0,0] op_sel_hi:[1,1,1] neg_lo:[0,0,0] neg_hi:[0,0,0]
v_pk_add_f32 v[32:33], v[24:25], v[40:41] op_sel:[1,1] op_sel_hi:[0,0] neg_lo:[0,1] neg_hi:[1,0]
v_pk_add_f32 v[24:25], v[24:25], v[40:41]
v_pk_add_f32 v[40:41], v[26:27], v[42:43] neg_lo:[0,1] neg_hi:[0,1]
v_pk_add_f32 v[26:27], v[26:27], v[42:43]
v_pk_mul_f32 v[42:43], v[40:41], s[54:55] op_sel:[0,1] op_sel_hi:[0,0] neg_lo:[0,1] neg_hi:[0,1]
v_pk_fma_f32 v[42:43], v[40:41], s[54:55], v[42:43] op_sel:[1,0,0] op_sel_hi:[1,1,1] neg_lo:[0,0,0] neg_hi:[0,1,0]
v_pk_add_f32 v[40:41], v[28:29], v[44:45] neg_lo:[0,1] neg_hi:[0,1]
v_pk_add_f32 v[28:29], v[28:29], v[44:45]
v_pk_mul_f32 v[44:45], v[40:41], s[62:63] op_sel:[0,0] op_sel_hi:[0,1] neg_lo:[0,1] neg_hi:[0,1]
v_pk_fma_f32 v[44:45], v[40:41], s[62:63], v[44:45] op_sel:[1,1,0] op_sel_hi:[1,0,1] neg_lo:[0,0,0] neg_hi:[0,1,0]
v_pk_add_f32 v[40:41], v[30:31], v[46:47] neg_lo:[0,1] neg_hi:[0,1]
v_pk_add_f32 v[30:31], v[30:31], v[46:47]
v_pk_mul_f32 v[46:47], v[40:41], s[54:55] op_sel:[0,0] op_sel_hi:[0,1] neg_lo:[0,1] neg_hi:[0,1]
v_pk_fma_f32 v[46:47], v[40:41], s[54:55], v[46:47] op_sel:[1,1,0] op_sel_hi:[1,0,1] neg_lo:[0,0,0] neg_hi:[0,1,0]
v_pk_add_f32 v[40:41], v[48:49], v[64:65] neg_lo:[0,1] neg_hi:[0,1]
v_pk_add_f32 v[48:49], v[48:49], v[64:65]
v_pk_add_f32 v[64:65], v[50:51], v[66:67] neg_lo:[0,1] neg_hi:[0,1]
v_pk_add_f32 v[50:51], v[50:51], v[66:67]
v_pk_mul_f32 v[66:67], v[64:65], s[54:55] op_sel:[0,0] op_sel_hi:[0,1] neg_lo:[0,0] neg_hi:[0,1]
v_pk_fma_f32 v[66:67], v[64:65], s[54:55], v[66:67] op_sel:[1,1,0] op_sel_hi:[1,0,1] neg_lo:[0,0,0] neg_hi:[0,0,0]
v_pk_add_f32 v[64:65], v[52:53], v[68:69] neg_lo:[0,1] neg_hi:[0,1]
v_pk_add_f32 v[52:53], v[52:53], v[68:69]
v_pk_mul_f32 v[68:69], v[64:65], s[62:63] op_sel:[0,0] op_sel_hi:[0,1] neg_lo:[0,0] neg_hi:[0,1]
v_pk_fma_f32 v[68:69], v[64:65], s[62:63], v[68:69] op_sel:[1,1,0] op_sel_hi:[1,0,1] neg_lo:[0,0,0] neg_hi:[0,0,0]
v_pk_add_f32 v[64:65], v[54:55], v[70:71] neg_lo:[0,1] neg_hi:[0,1]
v_pk_add_f32 v[54:55], v[54:55], v[70:71]
v_pk_mul_f32 v[70:71], v[64:65], s[54:55] op_sel:[0,1] op_sel_hi:[0,0] neg_lo:[0,0] neg_hi:[0,1]
v_pk_fma_f32 v[70:71], v[64:65], s[54:55], v[70:71] op_sel:[1,0,0] op_sel_hi:[1,1,1] neg_lo:[0,0,0] neg_hi:[0,0,0]
v_pk_add_f32 v[64:65], v[56:57], v[72:73] op_sel:[1,1] op_sel_hi:[0,0] neg_lo:[0,1] neg_hi:[1,0]
v_pk_add_f32 v[56:57], v[56:57], v[72:73]
v_pk_add_f32 v[72:73], v[58:59], v[74:75] neg_lo:[0,1] neg_hi:[0,1]
v_pk_add_f32 v[58:59], v[58:59], v[74:75]
v_pk_mul_f32 v[74:75], v[72:73], s[54:55] op_sel:[0,1] op_sel_hi:[0,0] neg_lo:[0,1] neg_hi:[0,1]
v_pk_fma_f32 v[74:75], v[72:73], s[54:55], v[74:75] op_sel:[1,0,0] op_sel_hi:[1,1,1] neg_lo:[0,0,0] neg_hi:[0,1,0]
v_pk_add_f32 v[72:73], v[60:61], v[76:77] neg_lo:[0,1] neg_hi:[0,1]
v_pk_add_f32 v[60:61], v[60:61], v[76:77]
v_pk_mul_f32 v[76:77], v[72:73], s[62:63] op_sel:[0,0] op_sel_hi:[0,1] neg_lo:[0,1] neg_hi:[0,1]
v_pk_fma_f32 v[76:77], v[72:73], s[62:63], v[76:77] op_sel:[1,1,0] op_sel_hi:[1,0,1] neg_lo:[0,0,0] neg_hi:[0,1,0]
v_pk_add_f32 v[72:73], v[62:63], v[78:79] neg_lo:[0,1] neg_hi:[0,1]
v_pk_add_f32 v[62:63], v[62:63], v[78:79]
v_pk_mul_f32 v[78:79], v[72:73], s[54:55] op_sel:[0,0] op_sel_hi:[0,1] neg_lo:[0,1] neg_hi:[0,1]
v_pk_fma_f32 v[78:79], v[72:73], s[54:55], v[78:79] op_sel:[1,1,0] op_sel_hi:[1,0,1] neg_lo:[0,0,0] neg_hi:[0,1,0]
v_pk_add_f32 v[72:73], v[16:17], v[24:25] neg_lo:[0,1] neg_hi:[0,1]
v_pk_add_f32 v[16:17], v[16:17], v[24:25]
v_pk_add_f32 v[24:25], v[18:19], v[26:27] neg_lo:[0,1] neg_hi:[0,1]
v_pk_add_f32 v[18:19], v[18:19], v[26:27]
v_pk_mul_f32 v[26:27], v[24:25], s[62:63] op_sel:[0,0] op_sel_hi:[0,1] neg_lo:[0,0] neg_hi:[0,1]
v_pk_fma_f32 v[26:27], v[24:25], s[62:63], v[26:27] op_sel:[1,1,0] op_sel_hi:[1,0,1] neg_lo:[0,0,0] neg_hi:[0,0,0]
v_pk_add_f32 v[24:25], v[20:21], v[28:29] op_sel:[1,1] op_sel_hi:[0,0] neg_lo:[0,1] neg_hi:[1,0]
v_pk_add_f32 v[20:21], v[20:21], v[28:29]
v_pk_add_f32 v[28:29], v[22:23], v[30:31] neg_lo:[0,1] neg_hi:[0,1]
v_pk_add_f32 v[22:23], v[22:23], v[30:31]
v_pk_mul_f32 v[30:31], v[28:29], s[62:63] op_sel:[0,0] op_sel_hi:[0,1] neg_lo:[0,1] neg_hi:[0,1]
v_pk_fma_f32 v[30:31], v[28:29], s[62:63], v[30:31] op_sel:[1,1,0] op_sel_hi:[1,0,1] neg_lo:[0,0,0] neg_hi:[0,1,0]
v_pk_add_f32 v[28:29], v[14:15], v[32:33] neg_lo:[0,1] neg_hi:[0,1]
v_pk_add_f32 v[14:15], v[14:15], v[32:33]
v_pk_add_f32 v[32:33], v[34:35], v[42:43] neg_lo:[0,1] neg_hi:[0,1]
v_pk_add_f32 v[34:35], v[34:35], v[42:43]
v_pk_mul_f32 v[42:43], v[32:33], s[62:63] op_sel:[0,0] op_sel_hi:[0,1] neg_lo:[0,0] neg_hi:[0,1]
v_pk_fma_f32 v[42:43], v[32:33], s[62:63], v[42:43] op_sel:[1,1,0] op_sel_hi:[1,0,1] neg_lo:[0,0,0] neg_hi:[0,0,0]
v_pk_add_f32 v[32:33], v[36:37], v[44:45] op_sel:[1,1] op_sel_hi:[0,0] neg_lo:[0,1] neg_hi:[1,0]
v_pk_add_f32 v[36:37], v[36:37], v[44:45]
v_pk_add_f32 v[44:45], v[38:39], v[46:47] neg_lo:[0,1] neg_hi:[0,1]
v_pk_add_f32 v[38:39], v[38:39], v[46:47]
v_pk_mul_f32 v[46:47], v[44:45], s[62:63] op_sel:[0,0] op_sel_hi:[0,1] neg_lo:[0,1] neg_hi:[0,1]
v_pk_fma_f32 v[46:47], v[44:45], s[62:63], v[46:47] op_sel:[1,1,0] op_sel_hi:[1,0,1] neg_lo:[0,0,0] neg_hi:[0,1,0]
v_pk_add_f32 v[44:45], v[48:49], v[56:57] neg_lo:[0,1] neg_hi:[0,1]
v_pk_add_f32 v[48:49], v[48:49], v[56:57]
v_pk_add_f32 v[56:57], v[50:51], v[58:59] neg_lo:[0,1] neg_hi:[0,1]
v_pk_add_f32 v[50:51], v[50:51], v[58:59]
v_pk_mul_f32 v[58:59], v[56:57], s[62:63] op_sel:[0,0] op_sel_hi:[0,1] neg_lo:[0,0] neg_hi:[0,1]
v_pk_fma_f32 v[58:59], v[56:57], s[62:63], v[58:59] op_sel:[1,1,0] op_sel_hi:[1,0,1] neg_lo:[0,0,0] neg_hi:[0,0,0]
v_pk_add_f32 v[56:57], v[52:53], v[60:61] op_sel:[1,1] op_sel_hi:[0,0] neg_lo:[0,1] neg_hi:[1,0]
v_pk_add_f32 v[52:53], v[52:53], v[60:61]
v_pk_add_f32 v[60:61], v[54:55], v[62:63] neg_lo:[0,1] neg_hi:[0,1]
v_pk_add_f32 v[54:55], v[54:55], v[62:63]
v_pk_mul_f32 v[62:63], v[60:61], s[62:63] op_sel:[0,0] op_sel_hi:[0,1] neg_lo:[0,1] neg_hi:[0,1]
v_pk_fma_f32 v[62:63], v[60:61], s[62:63], v[62:63] op_sel:[1,1,0] op_sel_hi:[1,0,1] neg_lo:[0,0,0] neg_hi:[0,1,0]
v_pk_add_f32 v[60:61], v[40:41], v[64:65] neg_lo:[0,1] neg_hi:[0,1]
v_pk_add_f32 v[40:41], v[40:41], v[64:65]
v_pk_add_f32 v[64:65], v[66:67], v[74:75] neg_lo:[0,1] neg_hi:[0,1]
v_pk_add_f32 v[66:67], v[66:67], v[74:75]
v_pk_mul_f32 v[74:75], v[64:65], s[62:63] op_sel:[0,0] op_sel_hi:[0,1] neg_lo:[0,0] neg_hi:[0,1]
v_pk_fma_f32 v[74:75], v[64:65], s[62:63], v[74:75] op_sel:[1,1,0] op_sel_hi:[1,0,1] neg_lo:[0,0,0] neg_hi:[0,0,0]
v_pk_add_f32 v[64:65], v[68:69], v[76:77] op_sel:[1,1] op_sel_hi:[0,0] neg_lo:[0,1] neg_hi:[1,0]
v_pk_add_f32 v[68:69], v[68:69], v[76:77]
v_pk_add_f32 v[76:77], v[70:71], v[78:79] neg_lo:[0,1] neg_hi:[0,1]
v_pk_add_f32 v[70:71], v[70:71], v[78:79]
v_pk_mul_f32 v[78:79], v[76:77], s[62:63] op_sel:[0,0] op_sel_hi:[0,1] neg_lo:[0,1] neg_hi:[0,1]
v_pk_fma_f32 v[78:79], v[76:77], s[62:63], v[78:79] op_sel:[1,1,0] op_sel_hi:[1,0,1] neg_lo:[0,0,0] neg_hi:[0,1,0]
v_pk_add_f32 v[76:77], v[16:17], v[20:21] neg_lo:[0,1] neg_hi:[0,1]
v_pk_add_f32 v[16:17], v[16:17], v[20:21]
v_pk_add_f32 v[20:21], v[18:19], v[22:23] op_sel:[1,1] op_sel_hi:[0,0] neg_lo:[0,1] neg_hi:[1,0]
v_pk_add_f32 v[18:19], v[18:19], v[22:23]
v_pk_add_f32 v[22:23], v[72:73], v[24:25] neg_lo:[0,1] neg_hi:[0,1]
v_pk_add_f32 v[72:73], v[72:73], v[24:25]
v_pk_add_f32 v[24:25], v[26:27], v[30:31] op_sel:[1,1] op_sel_hi:[0,0] neg_lo:[0,1] neg_hi:[1,0]
v_pk_add_f32 v[26:27], v[26:27], v[30:31]
v_pk_add_f32 v[30:31], v[14:15], v[36:37] neg_lo:[0,1] neg_hi:[0,1]
v_pk_add_f32 v[14:15], v[14:15], v[36:37]
v_pk_add_f32 v[36:37], v[34:35], v[38:39] op_sel:[1,1] op_sel_hi:[0,0] neg_lo:[0,1] neg_hi:[1,0]
v_pk_add_f32 v[34:35], v[34:35], v[38:39]
v_pk_add_f32 v[38:39], v[28:29], v[32:33] neg_lo:[0,1] neg_hi:[0,1]
v_pk_add_f32 v[28:29], v[28:29], v[32:33]
v_pk_add_f32 v[32:33], v[42:43], v[46:47] op_sel:[1,1] op_sel_hi:[0,0] neg_lo:[0,1] neg_hi:[1,0]
v_pk_add_f32 v[42:43], v[42:43], v[46:47]
v_pk_add_f32 v[46:47], v[48:49], v[52:53] neg_lo:[0,1] neg_hi:[0,1]
v_pk_add_f32 v[48:49], v[48:49], v[52:53]
v_pk_add_f32 v[52:53], v[50:51], v[54:55] op_sel:[1,1] op_sel_hi:[0,0] neg_lo:[0,1] neg_hi:[1,0]
v_pk_add_f32 v[50:51], v[50:51], v[54:55]
v_pk_add_f32 v[54:55], v[44:45], v[56:57] neg_lo:[0,1] neg_hi:[0,1]
v_pk_add_f32 v[44:45], v[44:45], v[56:57]
v_pk_add_f32 v[56:57], v[58:59], v[62:63] op_sel:[1,1] op_sel_hi:[0,0] neg_lo:[0,1] neg_hi:[1,0]
v_pk_add_f32 v[58:59], v[58:59], v[62:63]
v_pk_add_f32 v[62:63], v[40:41], v[68:69] neg_lo:[0,1] neg_hi:[0,1]
v_pk_add_f32 v[40:41], v[40:41], v[68:69]
v_pk_add_f32 v[68:69], v[66:67], v[70:71] op_sel:[1,1] op_sel_hi:[0,0] neg_lo:[0,1] neg_hi:[1,0]
v_pk_add_f32 v[66:67], v[66:67], v[70:71]
v_pk_add_f32 v[70:71], v[60:61], v[64:65] neg_lo:[0,1] neg_hi:[0,1]
v_pk_add_f32 v[60:61], v[60:61], v[64:65]
v_pk_add_f32 v[64:65], v[74:75], v[78:79] op_sel:[1,1] op_sel_hi:[0,0] neg_lo:[0,1] neg_hi:[1,0]
v_pk_add_f32 v[74:75], v[74:75], v[78:79]
v_pk_add_f32 v[78:79], v[16:17], v[18:19] neg_lo:[0,1] neg_hi:[0,1]
v_pk_add_f32 v[16:17], v[16:17], v[18:19]
v_pk_add_f32 v[18:19], v[76:77], v[20:21] neg_lo:[0,1] neg_hi:[0,1]
v_pk_add_f32 v[76:77], v[76:77], v[20:21]
v_pk_add_f32 v[20:21], v[72:73], v[26:27] neg_lo:[0,1] neg_hi:[0,1]
v_pk_add_f32 v[72:73], v[72:73], v[26:27]
v_pk_add_f32 v[26:27], v[22:23], v[24:25] neg_lo:[0,1] neg_hi:[0,1]
v_pk_add_f32 v[22:23], v[22:23], v[24:25]
v_pk_add_f32 v[24:25], v[14:15], v[34:35] neg_lo:[0,1] neg_hi:[0,1]
v_pk_add_f32 v[14:15], v[14:15], v[34:35]
v_pk_add_f32 v[34:35], v[30:31], v[36:37] neg_lo:[0,1] neg_hi:[0,1]
v_pk_add_f32 v[30:31], v[30:31], v[36:37]
v_pk_add_f32 v[36:37], v[28:29], v[42:43] neg_lo:[0,1] neg_hi:[0,1]
v_pk_add_f32 v[28:29], v[28:29], v[42:43]
v_pk_add_f32 v[42:43], v[38:39], v[32:33] neg_lo:[0,1] neg_hi:[0,1]
v_pk_add_f32 v[38:39], v[38:39], v[32:33]
v_pk_add_f32 v[32:33], v[48:49], v[50:51] neg_lo:[0,1] neg_hi:[0,1]
v_pk_add_f32 v[48:49], v[48:49], v[50:51]
v_pk_add_f32 v[50:51], v[46:47], v[52:53] neg_lo:[0,1] neg_hi:[0,1]
v_pk_add_f32 v[46:47], v[46:47], v[52:53]
v_pk_add_f32 v[52:53], v[44:45], v[58:59] neg_lo:[0,1] neg_hi:[0,1]
v_pk_add_f32 v[44:45], v[44:45], v[58:59]
v_pk_add_f32 v[58:59], v[54:55], v[56:57] neg_lo:[0,1] neg_hi:[0,1]
v_pk_add_f32 v[54:55], v[54:55], v[56:57]
v_pk_add_f32 v[56:57], v[40:41], v[66:67] neg_lo:[0,1] neg_hi:[0,1]
v_pk_add_f32 v[40:41], v[40:41], v[66:67]
v_pk_add_f32 v[66:67], v[62:63], v[68:69] neg_lo:[0,1] neg_hi:[0,1]
v_pk_add_f32 v[62:63], v[62:63], v[68:69]
v_pk_add_f32 v[68:69], v[60:61], v[74:75] neg_lo:[0,1] neg_hi:[0,1]
v_pk_add_f32 v[60:61], v[60:61], v[74:75]
v_pk_add_f32 v[74:75], v[70:71], v[64:65] neg_lo:[0,1] neg_hi:[0,1]
v_pk_add_f32 v[70:71], v[70:71], v[64:65]
v_pk_mul_f32 v[64:65], v[48:49], v[82:83] op_sel:[0,0] op_sel_hi:[0,1] neg_lo:[0,0] neg_hi:[0,0]
v_pk_fma_f32 v[48:49], v[48:49], v[82:83], v[64:65] op_sel:[1,1,0] op_sel_hi:[1,0,1] neg_lo:[0,1,0] neg_hi:[0,0,0]
v_pk_mul_f32 v[64:65], v[14:15], v[84:85] op_sel:[0,0] op_sel_hi:[0,1] neg_lo:[0,0] neg_hi:[0,0]
v_pk_fma_f32 v[14:15], v[14:15], v[84:85], v[64:65] op_sel:[1,1,0] op_sel_hi:[1,0,1] neg_lo:[0,1,0] neg_hi:[0,0,0]
v_pk_mul_f32 v[64:65], v[40:41], v[86:87] op_sel:[0,0] op_sel_hi:[0,1] neg_lo:[0,0] neg_hi:[0,0]
v_pk_fma_f32 v[40:41], v[40:41], v[86:87], v[64:65] op_sel:[1,1,0] op_sel_hi:[1,0,1] neg_lo:[0,1,0] neg_hi:[0,0,0]
v_pk_mul_f32 v[64:65], v[72:73], v[88:89] op_sel:[0,0] op_sel_hi:[0,1] neg_lo:[0,0] neg_hi:[0,0]
v_pk_fma_f32 v[72:73], v[72:73], v[88:89], v[64:65] op_sel:[1,1,0] op_sel_hi:[1,0,1] neg_lo:[0,1,0] neg_hi:[0,0,0]
v_pk_mul_f32 v[64:65], v[44:45], v[90:91] op_sel:[0,0] op_sel_hi:[0,1] neg_lo:[0,0] neg_hi:[0,0]
v_pk_fma_f32 v[44:45], v[44:45], v[90:91], v[64:65] op_sel:[1,1,0] op_sel_hi:[1,0,1] neg_lo:[0,1,0] neg_hi:[0,0,0]
v_pk_mul_f32 v[64:65], v[28:29], v[92:93] op_sel:[0,0] op_sel_hi:[0,1] neg_lo:[0,0] neg_hi:[0,0]
v_pk_fma_f32 v[28:29], v[28:29], v[92:93], v[64:65] op_sel:[1,1,0] op_sel_hi:[1,0,1] neg_lo:[0,1,0] neg_hi:[0,0,0]
v_pk_mul_f32 v[64:65], v[60:61], v[94:95] op_sel:[0,0] op_sel_hi:[0,1] neg_lo:[0,0] neg_hi:[0,0]
v_pk_fma_f32 v[60:61], v[60:61], v[94:95], v[64:65] op_sel:[1,1,0] op_sel_hi:[1,0,1] neg_lo:[0,1,0] neg_hi:[0,0,0]
v_pk_mul_f32 v[64:65], v[76:77], v[96:97] op_sel:[0,0] op_sel_hi:[0,1] neg_lo:[0,0] neg_hi:[0,0]
v_pk_fma_f32 v[76:77], v[76:77], v[96:97], v[64:65] op_sel:[1,1,0] op_sel_hi:[1,0,1] neg_lo:[0,1,0] neg_hi:[0,0,0]
v_pk_mul_f32 v[64:65], v[46:47], v[98:99] op_sel:[0,0] op_sel_hi:[0,1] neg_lo:[0,0] neg_hi:[0,0]
v_pk_fma_f32 v[46:47], v[46:47], v[98:99], v[64:65] op_sel:[1,1,0] op_sel_hi:[1,0,1] neg_lo:[0,1,0] neg_hi:[0,0,0]
v_pk_mul_f32 v[64:65], v[30:31], v[100:101] op_sel:[0,0] op_sel_hi:[0,1] neg_lo:[0,0] neg_hi:[0,0]
v_pk_fma_f32 v[30:31], v[30:31], v[100:101], v[64:65] op_sel:[1,1,0] op_sel_hi:[1,0,1] neg_lo:[0,1,0] neg_hi:[0,0,0]
v_pk_mul_f32 v[64:65], v[62:63], v[102:103] op_sel:[0,0] op_sel_hi:[0,1] neg_lo:[0,0] neg_hi:[0,0]
v_pk_fma_f32 v[62:63], v[62:63], v[102:103], v[64:65] op_sel:[1,1,0] op_sel_hi:[1,0,1] neg_lo:[0,1,0] neg_hi:[0,0,0]
v_pk_mul_f32 v[64:65], v[22:23], v[104:105] op_sel:[0,0] op_sel_hi:[0,1] neg_lo:[0,0] neg_hi:[0,0]
v_pk_fma_f32 v[22:23], v[22:23], v[104:105], v[64:65] op_sel:[1,1,0] op_sel_hi:[1,0,1] neg_lo:[0,1,0] neg_hi:[0,0,0]
v_pk_mul_f32 v[64:65], v[54:55], v[106:107] op_sel:[0,0] op_sel_hi:[0,1] neg_lo:[0,0] neg_hi:[0,0]
v_pk_fma_f32 v[54:55], v[54:55], v[106:107], v[64:65] op_sel:[1,1,0] op_sel_hi:[1,0,1] neg_lo:[0,1,0] neg_hi:[0,0,0]
v_pk_mul_f32 v[64:65], v[38:39], v[108:109] op_sel:[0,0] op_sel_hi:[0,1] neg_lo:[0,0] neg_hi:[0,0]
v_pk_fma_f32 v[38:39], v[38:39], v[108:109], v[64:65] op_sel:[1,1,0] op_sel_hi:[1,0,1] neg_lo:[0,1,0] neg_hi:[0,0,0]
v_pk_mul_f32 v[64:65], v[70:71], v[110:111] op_sel:[0,0] op_sel_hi:[0,1] neg_lo:[0,0] neg_hi:[0,0]
v_pk_fma_f32 v[70:71], v[70:71], v[110:111], v[64:65] op_sel:[1,1,0] op_sel_hi:[1,0,1] neg_lo:[0,1,0] neg_hi:[0,0,0]
v_pk_mul_f32 v[64:65], v[78:79], v[112:113] op_sel:[0,0] op_sel_hi:[0,1] neg_lo:[0,0] neg_hi:[0,0]
v_pk_fma_f32 v[78:79], v[78:79], v[112:113], v[64:65] op_sel:[1,1,0] op_sel_hi:[1,0,1] neg_lo:[0,1,0] neg_hi:[0,0,0]
v_pk_mul_f32 v[64:65], v[32:33], v[114:115] op_sel:[0,0] op_sel_hi:[0,1] neg_lo:[0,0] neg_hi:[0,0]
v_pk_fma_f32 v[32:33], v[32:33], v[114:115], v[64:65] op_sel:[1,1,0] op_sel_hi:[1,0,1] neg_lo:[0,1,0] neg_hi:[0,0,0]
v_pk_mul_f32 v[64:65], v[24:25], v[116:117] op_sel:[0,0] op_sel_hi:[0,1] neg_lo:[0,0] neg_hi:[0,0]
v_pk_fma_f32 v[24:25], v[24:25], v[116:117], v[64:65] op_sel:[1,1,0] op_sel_hi:[1,0,1] neg_lo:[0,1,0] neg_hi:[0,0,0]
v_pk_mul_f32 v[64:65], v[56:57], v[118:119] op_sel:[0,0] op_sel_hi:[0,1] neg_lo:[0,0] neg_hi:[0,0]
v_pk_fma_f32 v[56:57], v[56:57], v[118:119], v[64:65] op_sel:[1,1,0] op_sel_hi:[1,0,1] neg_lo:[0,1,0] neg_hi:[0,0,0]
v_pk_mul_f32 v[64:65], v[20:21], v[120:121] op_sel:[0,0] op_sel_hi:[0,1] neg_lo:[0,0] neg_hi:[0,0]
v_pk_fma_f32 v[20:21], v[20:21], v[120:121], v[64:65] op_sel:[1,1,0] op_sel_hi:[1,0,1] neg_lo:[0,1,0] neg_hi:[0,0,0]
v_pk_mul_f32 v[64:65], v[52:53], v[122:123] op_sel:[0,0] op_sel_hi:[0,1] neg_lo:[0,0] neg_hi:[0,0]
v_pk_fma_f32 v[52:53], v[52:53], v[122:123], v[64:65] op_sel:[1,1,0] op_sel_hi:[1,0,1] neg_lo:[0,1,0] neg_hi:[0,0,0]
v_pk_mul_f32 v[64:65], v[36:37], v[124:125] op_sel:[0,0] op_sel_hi:[0,1] neg_lo:[0,0] neg_hi:[0,0]
v_pk_fma_f32 v[36:37], v[36:37], v[124:125], v[64:65] op_sel:[1,1,0] op_sel_hi:[1,0,1] neg_lo:[0,1,0] neg_hi:[0,0,0]
v_pk_mul_f32 v[64:65], v[68:69], v[126:127] op_sel:[0,0] op_sel_hi:[0,1] neg_lo:[0,0] neg_hi:[0,0]
v_pk_fma_f32 v[68:69], v[68:69], v[126:127], v[64:65] op_sel:[1,1,0] op_sel_hi:[1,0,1] neg_lo:[0,1,0] neg_hi:[0,0,0]
v_pk_mul_f32 v[64:65], v[18:19], v[128:129] op_sel:[0,0] op_sel_hi:[0,1] neg_lo:[0,0] neg_hi:[0,0]
v_pk_fma_f32 v[18:19], v[18:19], v[128:129], v[64:65] op_sel:[1,1,0] op_sel_hi:[1,0,1] neg_lo:[0,1,0] neg_hi:[0,0,0]
v_pk_mul_f32 v[64:65], v[50:51], v[130:131] op_sel:[0,0] op_sel_hi:[0,1] neg_lo:[0,0] neg_hi:[0,0]
v_pk_fma_f32 v[50:51], v[50:51], v[130:131], v[64:65] op_sel:[1,1,0] op_sel_hi:[1,0,1] neg_lo:[0,1,0] neg_hi:[0,0,0]
v_pk_mul_f32 v[64:65], v[34:35], v[132:133] op_sel:[0,0] op_sel_hi:[0,1] neg_lo:[0,0] neg_hi:[0,0]
v_pk_fma_f32 v[34:35], v[34:35], v[132:133], v[64:65] op_sel:[1,1,0] op_sel_hi:[1,0,1] neg_lo:[0,1,0] neg_hi:[0,0,0]
v_pk_mul_f32 v[64:65], v[66:67], v[134:135] op_sel:[0,0] op_sel_hi:[0,1] neg_lo:[0,0] neg_hi:[0,0]
v_pk_fma_f32 v[66:67], v[66:67], v[134:135], v[64:65] op_sel:[1,1,0] op_sel_hi:[1,0,1] neg_lo:[0,1,0] neg_hi:[0,0,0]
v_pk_mul_f32 v[64:65], v[26:27], v[136:137] op_sel:[0,0] op_sel_hi:[0,1] neg_lo:[0,0] neg_hi:[0,0]
v_pk_fma_f32 v[26:27], v[26:27], v[136:137], v[64:65] op_sel:[1,1,0] op_sel_hi:[1,0,1] neg_lo:[0,1,0] neg_hi:[0,0,0]
v_pk_mul_f32 v[64:65], v[58:59], v[138:139] op_sel:[0,0] op_sel_hi:[0,1] neg_lo:[0,0] neg_hi:[0,0]
v_pk_fma_f32 v[58:59], v[58:59], v[138:139], v[64:65] op_sel:[1,1,0] op_sel_hi:[1,0,1] neg_lo:[0,1,0] neg_hi:[0,0,0]
v_pk_mul_f32 v[64:65], v[42:43], v[140:141] op_sel:[0,0] op_sel_hi:[0,1] neg_lo:[0,0] neg_hi:[0,0]
v_pk_fma_f32 v[42:43], v[42:43], v[140:141], v[64:65] op_sel:[1,1,0] op_sel_hi:[1,0,1] neg_lo:[0,1,0] neg_hi:[0,0,0]
v_pk_mul_f32 v[64:65], v[74:75], v[142:143] op_sel:[0,0] op_sel_hi:[0,1] neg_lo:[0,0] neg_hi:[0,0]
v_pk_fma_f32 v[74:75], v[74:75], v[142:143], v[64:65] op_sel:[1,1,0] op_sel_hi:[1,0,1] neg_lo:[0,1,0] neg_hi:[0,0,0]
s_barrier
ds_write_b64 v4, v[16:17] offset:0
ds_write_b64 v4, v[48:49] offset:264
ds_write_b64 v4, v[14:15] offset:528
ds_write_b64 v4, v[40:41] offset:792
ds_write_b64 v4, v[72:73] offset:1056
ds_write_b64 v4, v[44:45] offset:1320
ds_write_b64 v4, v[28:29] offset:1584
ds_write_b64 v4, v[60:61] offset:1848
ds_write_b64 v4, v[76:77] offset:2112
ds_write_b64 v4, v[46:47] offset:2376
ds_write_b64 v4, v[30:31] offset:2640
ds_write_b64 v4, v[62:63] offset:2904
ds_write_b64 v4, v[22:23] offset:3168
ds_write_b64 v4, v[54:55] offset:3432
ds_write_b64 v4, v[38:39] offset:3696
ds_write_b64 v4, v[70:71] offset:3960
ds_write_b64 v4, v[78:79] offset:4224
ds_write_b64 v4, v[32:33] offset:4488
ds_write_b64 v4, v[24:25] offset:4752
ds_write_b64 v4, v[56:57] offset:5016
ds_write_b64 v4, v[20:21] offset:5280
ds_write_b64 v4, v[52:53] offset:5544
ds_write_b64 v4, v[36:37] offset:5808
ds_write_b64 v4, v[68:69] offset:6072
ds_write_b64 v4, v[18:19] offset:6336
ds_write_b64 v4, v[50:51] offset:6600
ds_write_b64 v4, v[34:35] offset:6864
ds_write_b64 v4, v[66:67] offset:7128
ds_write_b64 v4, v[26:27] offset:7392
ds_write_b64 v4, v[58:59] offset:7656
ds_write_b64 v4, v[42:43] offset:7920
ds_write_b64 v4, v[74:75] offset:8184
s_waitcnt lgkmcnt(0)
ds_read_b64 v[16:17], v5 offset:0
ds_read_b64 v[48:49], v5 offset:128
ds_read_b64 v[18:19], v5 offset:8
ds_read_b64 v[50:51], v5 offset:136
ds_read_b64 v[20:21], v5 offset:16
ds_read_b64 v[52:53], v5 offset:144
ds_read_b64 v[22:23], v5 offset:24
ds_read_b64 v[54:55], v5 offset:152
ds_read_b64 v[24:25], v5 offset:32
ds_read_b64 v[56:57], v5 offset:160
ds_read_b64 v[26:27], v5 offset:40
ds_read_b64 v[58:59], v5 offset:168
ds_read_b64 v[28:29], v5 offset:48
ds_read_b64 v[60:61], v5 offset:176
ds_read_b64 v[30:31], v5 offset:56
ds_read_b64 v[62:63], v5 offset:184
ds_read_b64 v[32:33], v5 offset:64
ds_read_b64 v[64:65], v5 offset:192
ds_read_b64 v[34:35], v5 offset:72
ds_read_b64 v[66:67], v5 offset:200
ds_read_b64 v[36:37], v5 offset:80
ds_read_b64 v[68:69], v5 offset:208
ds_read_b64 v[38:39], v5 offset:88
ds_read_b64 v[70:71], v5 offset:216
ds_read_b64 v[40:41], v5 offset:96
ds_read_b64 v[72:73], v5 offset:224
ds_read_b64 v[42:43], v5 offset:104
ds_read_b64 v[74:75], v5 offset:232
ds_read_b64 v[44:45], v5 offset:112
ds_read_b64 v[76:77], v5 offset:240
ds_read_b64 v[46:47], v5 offset:120
ds_read_b64 v[78:79], v5 offset:248
s_waitcnt lgkmcnt(0)
v_pk_add_f32 v[14:15], v[16:17], v[48:49] neg_lo:[0,1] neg_hi:[0,1]
v_pk_add_f32 v[16:17], v[16:17], v[48:49]
v_pk_add_f32 v[48:49], v[18:19], v[50:51] neg_lo:[0,1] neg_hi:[0,1]
v_pk_add_f32 v[18:19], v[18:19], v[50:51]
v_pk_mul_f32 v[50:51], v[48:49], s[50:51] op_sel:[0,0] op_sel_hi:[0,1] neg_lo:[0,0] neg_hi:[0,1]
v_pk_fma_f32 v[50:51], v[48:49], s[50:51], v[50:51] op_sel:[1,1,0] op_sel_hi:[1,0,1] neg_lo:[0,0,0] neg_hi:[0,0,0]
v_pk_add_f32 v[48:49], v[20:21], v[52:53] neg_lo:[0,1] neg_hi:[0,1]
v_pk_add_f32 v[20:21], v[20:21], v[52:53]
v_pk_mul_f32 v[52:53], v[48:49], s[54:55] op_sel:[0,0] op_sel_hi:[0,1] neg_lo:[0,0] neg_hi:[0,1]
v_pk_fma_f32 v[52:53], v[48:49], s[54:55], v[52:53] op_sel:[1,1,0] op_sel_hi:[1,0,1] neg_lo:[0,0,0] neg_hi:[0,0,0]
v_pk_add_f32 v[48:49], v[22:23], v[54:55] neg_lo:[0,1] neg_hi:[0,1]
v_pk_add_f32 v[22:23], v[22:23], v[54:55]
v_pk_mul_f32 v[54:55], v[48:49], s[58:59] op_sel:[0,0] op_sel_hi:[0,1] neg_lo:[0,0] neg_hi:[0,1]
v_pk_fma_f32 v[54:55], v[48:49], s[58:59], v[54:55] op_sel:[1,1,0] op_sel_hi:[1,0,1] neg_lo:[0,0,0] neg_hi:[0,0,0]
v_pk_add_f32 v[48:49], v[24:25], v[56:57] neg_lo:[0,1] neg_hi:[0,1]
v_pk_add_f32 v[24:25], v[24:25], v[56:57]
v_pk_mul_f32 v[56:57], v[48:49], s[62:63] op_sel:[0,0] op_sel_hi:[0,1] neg_lo:[0,0] neg_hi:[0,1]
v_pk_fma_f32 v[56:57], v[48:49], s[62:63], v[56:57] op_sel:[1,1,0] op_sel_hi:[1,0,1] neg_lo:[0,0,0] neg_hi:[0,0,0]
v_pk_add_f32 v[48:49], v[26:27], v[58:59] neg_lo:[0,1] neg_hi:[0,1]
v_pk_add_f32 v[26:27], v[26:27], v[58:59]
v_pk_mul_f32 v[58:59], v[48:49], s[58:59] op_sel:[0,1] op_sel_hi:[0,0] neg_lo:[0,0] neg_hi:[0,1]
v_pk_fma_f32 v[58:59], v[48:49], s[58:59], v[58:59] op_sel:[1,0,0] op_sel_hi:[1,1,1] neg_lo:[0,0,0] neg_hi:[0,0,0]
v_pk_add_f32 v[48:49], v[28:29], v[60:61] neg_lo:[0,1] neg_hi:[0,1]
v_pk_add_f32 v[28:29], v[28:29], v[60:61]
v_pk_mul_f32 v[60:61], v[48:49], s[54:55] op_sel:[0,1] op_sel_hi:[0,0] neg_lo:[0,0] neg_hi:[0,1]
v_pk_fma_f32 v[60:61], v[48:49], s[54:55], v[60:61] op_sel:[1,0,0] op_sel_hi:[1,1,1] neg_lo:[0,0,0] neg_hi:[0,0,0]
v_pk_add_f32 v[48:49], v[30:31], v[62:63] neg_lo:[0,1] neg_hi:[0,1]
v_pk_add_f32 v[30:31], v[30:31], v[62:63]
v_pk_mul_f32 v[62:63], v[48:49], s[50:51] op_sel:[0,1] op_sel_hi:[0,0] neg_lo:[0,0] neg_hi:[0,1]
v_pk_fma_f32 v[62:63], v[48:49], s[50:51], v[62:63] op_sel:[1,0,0] op_sel_hi:[1,1,1] neg_lo:[0,0,0] neg_hi:[0,0,0]
v_pk_add_f32 v[48:49], v[32:33], v[64:65] op_sel:[1,1] op_sel_hi:[0,0] neg_lo:[0,1] neg_hi:[1,0]
v_pk_add_f32 v[32:33], v[32:33], v[64:65]
v_pk_add_f32 v[64:65], v[34:35], v[66:67] neg_lo:[0,1] neg_hi:[0,1]
v_pk_add_f32 v[34:35], v[34:35], v[66:67]
v_pk_mul_f32 v[66:67], v[64:65], s[50:51] op_sel:[0,1] op_sel_hi:[0,0] neg_lo:[0,1] neg_hi:[0,1]
v_pk_fma_f32 v[66:67], v[64:65], s[50:51], v[66:67] op_sel:[1,0,0] op_sel_hi:[1,1,1] neg_lo:[0,0,0] neg_hi:[0,1,0]
v_pk_add_f32 v[64:65], v[36:37], v[68:69] neg_lo:[0,1] neg_hi:[0,1]
v_pk_add_f32 v[36:37], v[36:37], v[68:69]
v_pk_mul_f32 v[68:69], v[64:65], s[54:55] op_sel:[0,1] op_sel_hi:[0,0] neg_lo:[0,1] neg_hi:[0,1]
v_pk_fma_f32 v[68:69], v[64:65], s[54:55], v[68:69] op_sel:[1,0,0] op_sel_hi:[1,1,1] neg_lo:[0,0,0] neg_hi:[0,1,0]
v_pk_add_f32 v[64:65], v[38:39], v[70:71] neg_lo:[0,1] neg_hi:[0,1]
v_pk_add_f32 v[38:39], v[38:39], v[70:71]
v_pk_mul_f32 v[70:71], v[64:65], s[58:59] op_sel:[0,1] op_sel_hi:[0,0] neg_lo:[0,1] neg_hi:[0,1]
v_pk_fma_f32 v[70:71], v[64:65], s[58:59], v[70:71] op_sel:[1,0,0] op_sel_hi:[1,1,1] neg_lo:[0,0,0] neg_hi:[0,1,0]
v_pk_add_f32 v[64:65], v[40:41], v[72:73] neg_lo:[0,1] neg_hi:[0,1]
v_pk_add_f32 v[40:41], v[40:41], v[72:73]
v_pk_mul_f32 v[72:73], v[64:65], s[62:63] op_sel:[0,0] op_sel_hi:[0,1] neg_lo:[0,1] neg_hi:[0,1]
v_pk_fma_f32 v[72:73], v[64:65], s[62:63], v[72:73] op_sel:[1,1,0] op_sel_hi:[1,0,1] neg_lo:[0,0,0] neg_hi:[0,1,0]
v_pk_add_f32 v[64:65], v[42:43], v[74:75] neg_lo:[0,1] neg_hi:[0,1]
v_pk_add_f32 v[42:43], v[42:43], v[74:75]
v_pk_mul_f32 v[74:75], v[64:65], s[58:59] op_sel:[0,0] op_sel_hi:[0,1] neg_lo:[0,1] neg_hi:[0,1]
v_pk_fma_f32 v[74:75], v[64:65], s[58:59], v[74:75] op_sel:[1,1,0] op_sel_hi:[1,0,1] neg_lo:[0,0,0] neg_hi:[0,1,0]
v_pk_add_f32 v[64:65], v[44:45], v[76:77] neg_lo:[0,1] neg_hi:[0,1]
v_pk_add_f32 v[44:45], v[44:45], v[76:77]
v_pk_mul_f32 v[76:77], v[64:65], s[54:55] op_sel:[0,0] op_sel_hi:[0,1] neg_lo:[0,1] neg_hi:[0,1]
v_pk_fma_f32 v[76:77], v[64:65], s[54:55], v[76:77] op_sel:[1,1,0] op_sel_hi:[1,0,1] neg_lo:[0,0,0] neg_hi:[0,1,0]
v_pk_add_f32 v[64:65], v[46:47], v[78:79] neg_lo:[0,1] neg_hi:[0,1]
v_pk_add_f32 v[46:47], v[46:47], v[78:79]
v_pk_mul_f32 v[78:79], v[64:65], s[50:51] op_sel:[0,0] op_sel_hi:[0,1] neg_lo:[0,1] neg_hi:[0,1]
v_pk_fma_f32 v[78:79], v[64:65], s[50:51], v[78:79] op_sel:[1,1,0] op_sel_hi:[1,0,1] neg_lo:[0,0,0] neg_hi:[0,1,0]
v_pk_add_f32 v[64:65], v[16:17], v[32:33] neg_lo:[0,1] neg_hi:[0,1]
v_pk_add_f32 v[16:17], v[16:17], v[32:33]
v_pk_add_f32 v[32:33], v[18:19], v[34:35] neg_lo:[0,1] neg_hi:[0,1]
v_pk_add_f32 v[18:19], v[18:19], v[34:35]
v_pk_mul_f32 v[34:35], v[32:33], s[54:55] op_sel:[0,0] op_sel_hi:[0,1] neg_lo:[0,0] neg_hi:[0,1]
v_pk_fma_f32 v[34:35], v[32:33], s[54:55], v[34:35] op_sel:[1,1,0] op_sel_hi:[1,0,1] neg_lo:[0,0,0] neg_hi:[0,0,0]
v_pk_add_f32 v[32:33], v[20:21], v[36:37] neg_lo:[0,1] neg_hi:[0,1]
v_pk_add_f32 v[20:21], v[20:21], v[36:37]
v_pk_mul_f32 v[36:37], v[32:33], s[62:63] op_sel:[0,0] op_sel_hi:[0,1] neg_lo:[0,0] neg_hi:[0,1]
v_pk_fma_f32 v[36:37], v[32:33], s[62:63], v[36:37] op_sel:[1,1,0] op_sel_hi:[1,0,1] neg_lo:[0,0,0] neg_hi:[0,0,0]
v_pk_add_f32 v[32:33], v[22:23], v[38:39] neg_lo:[0,1] neg_hi:[0,1]
v_pk_add_f32 v[22:23], v[22:23], v[38:39]
v_pk_mul_f32 v[38:39], v[32:33], s[54:55] op_sel:[0,1] op_sel_hi:[0,0] neg_lo:[0,0] neg_hi:[0,1]
v_pk_fma_f32 v[38:39], v[32:33], s[54:55], v[38:39] op_sel:[1,0,0] op_sel_hi:[1,1,1] neg_lo:[0,0,0] neg_hi:[0,0,0]
v_pk_add_f32 v[32:33], v[24:25], v[40:41] op_sel:[1,1] op_sel_hi:[0,0] neg_lo:[0,1] neg_hi:[1,0]
v_pk_add_f32 v[24:25], v[24:25], v[40:41]
v_pk_add_f32 v[40:41], v[26:27], v[42:43] neg_lo:[0,1] neg_hi:[0,1]
v_pk_add_f32 v[26:27], v[26:27], v[42:43]
v_pk_mul_f32 v[42:43], v[40:41], s[54:55] op_sel:[0,1] op_sel_hi:[0,0] neg_lo:[0,1] neg_hi:[0,1]
v_pk_fma_f32 v[42:43], v[40:41], s[54:55], v[42:43] op_sel:[1,0,0] op_sel_hi:[1,1,1] neg_lo:[0,0,0] neg_hi:[0,1,0]
v_pk_add_f32 v[40:41], v[28:29], v[44:45] neg_lo:[0,1] neg_hi:[0,1]
v_pk_add_f32 v[28:29], v[28:29], v[44:45]
v_pk_mul_f32 v[44:45], v[40:41], s[62:63] op_sel:[0,0] op_sel_hi:[0,1] neg_lo:[0,1] neg_hi:[0,1]
v_pk_fma_f32 v[44:45], v[40:41], s[62:63], v[44:45] op_sel:[1,1,0] op_sel_hi:[1,0,1] neg_lo:[0,0,0] neg_hi:[0,1,0]
v_pk_add_f32 v[40:41], v[30:31], v[46:47] neg_lo:[0,1] neg_hi:[0,1]
v_pk_add_f32 v[30:31], v[30:31], v[46:47]
v_pk_mul_f32 v[46:47], v[40:41], s[54:55] op_sel:[0,0] op_sel_hi:[0,1] neg_lo:[0,1] neg_hi:[0,1]
v_pk_fma_f32 v[46:47], v[40:41], s[54:55], v[46:47] op_sel:[1,1,0] op_sel_hi:[1,0,1] neg_lo:[0,0,0] neg_hi:[0,1,0]
v_pk_add_f32 v[40:41], v[14:15], v[48:49] neg_lo:[0,1] neg_hi:[0,1]
v_pk_add_f32 v[14:15], v[14:15], v[48:49]
v_pk_add_f32 v[48:49], v[50:51], v[66:67] neg_lo:[0,1] neg_hi:[0,1]
v_pk_add_f32 v[50:51], v[50:51], v[66:67]
v_pk_mul_f32 v[66:67], v[48:49], s[54:55] op_sel:[0,0] op_sel_hi:[0,1] neg_lo:[0,0] neg_hi:[0,1]
v_pk_fma_f32 v[66:67], v[48:49], s[54:55], v[66:67] op_sel:[1,1,0] op_sel_hi:[1,0,1] neg_lo:[0,0,0] neg_hi:[0,0,0]
v_pk_add_f32 v[48:49], v[52:53], v[68:69] neg_lo:[0,1] neg_hi:[0,1]
v_pk_add_f32 v[52:53], v[52:53], v[68:69]
v_pk_mul_f32 v[68:69], v[48:49], s[62:63] op_sel:[0,0] op_sel_hi:[0,1] neg_lo:[0,0] neg_hi:[0,1]
v_pk_fma_f32 v[68:69], v[48:49], s[62:63], v[68:69] op_sel:[1,1,0] op_sel_hi:[1,0,1] neg_lo:[0,0,0] neg_hi:[0,0,0]
v_pk_add_f32 v[48:49], v[54:55], v[70:71] neg_lo:[0,1] neg_hi:[0,1]
v_pk_add_f32 v[54:55], v[54:55], v[70:71]
v_pk_mul_f32 v[70:71], v[48:49], s[54:55] op_sel:[0,1] op_sel_hi:[0,0] neg_lo:[0,0] neg_hi:[0,1]
v_pk_fma_f32 v[70:71], v[48:49], s[54:55], v[70:71] op_sel:[1,0,0] op_sel_hi:[1,1,1] neg_lo:[0,0,0] neg_hi:[0,0,0]
v_pk_add_f32 v[48:49], v[56:57], v[72:73] op_sel:[1,1] op_sel_hi:[0,0] neg_lo:[0,1] neg_hi:[1,0]
v_pk_add_f32 v[56:57], v[56:57], v[72:73]
v_pk_add_f32 v[72:73], v[58:59], v[74:75] neg_lo:[0,1] neg_hi:[0,1]
v_pk_add_f32 v[58:59], v[58:59], v[74:75]
v_pk_mul_f32 v[74:75], v[72:73], s[54:55] op_sel:[0,1] op_sel_hi:[0,0] neg_lo:[0,1] neg_hi:[0,1]
v_pk_fma_f32 v[74:75], v[72:73], s[54:55], v[74:75] op_sel:[1,0,0] op_sel_hi:[1,1,1] neg_lo:[0,0,0] neg_hi:[0,1,0]
v_pk_add_f32 v[72:73], v[60:61], v[76:77] neg_lo:[0,1] neg_hi:[0,1]
v_pk_add_f32 v[60:61], v[60:61], v[76:77]
v_pk_mul_f32 v[76:77], v[72:73], s[62:63] op_sel:[0,0] op_sel_hi:[0,1] neg_lo:[0,1] neg_hi:[0,1]
v_pk_fma_f32 v[76:77], v[72:73], s[62:63], v[76:77] op_sel:[1,1,0] op_sel_hi:[1,0,1] neg_lo:[0,0,0] neg_hi:[0,1,0]
v_pk_add_f32 v[72:73], v[62:63], v[78:79] neg_lo:[0,1] neg_hi:[0,1]
v_pk_add_f32 v[62:63], v[62:63], v[78:79]
v_pk_mul_f32 v[78:79], v[72:73], s[54:55] op_sel:[0,0] op_sel_hi:[0,1] neg_lo:[0,1] neg_hi:[0,1]
v_pk_fma_f32 v[78:79], v[72:73], s[54:55], v[78:79] op_sel:[1,1,0] op_sel_hi:[1,0,1] neg_lo:[0,0,0] neg_hi:[0,1,0]
v_pk_add_f32 v[72:73], v[16:17], v[24:25] neg_lo:[0,1] neg_hi:[0,1]
v_pk_add_f32 v[16:17], v[16:17], v[24:25]
v_pk_add_f32 v[24:25], v[18:19], v[26:27] neg_lo:[0,1] neg_hi:[0,1]
v_pk_add_f32 v[18:19], v[18:19], v[26:27]
v_pk_mul_f32 v[26:27], v[24:25], s[62:63] op_sel:[0,0] op_sel_hi:[0,1] neg_lo:[0,0] neg_hi:[0,1]
v_pk_fma_f32 v[26:27], v[24:25], s[62:63], v[26:27] op_sel:[1,1,0] op_sel_hi:[1,0,1] neg_lo:[0,0,0] neg_hi:[0,0,0]
v_pk_add_f32 v[24:25], v[20:21], v[28:29] op_sel:[1,1] op_sel_hi:[0,0] neg_lo:[0,1] neg_hi:[1,0]
v_pk_add_f32 v[20:21], v[20:21], v[28:29]
v_pk_add_f32 v[28:29], v[22:23], v[30:31] neg_lo:[0,1] neg_hi:[0,1]
v_pk_add_f32 v[22:23], v[22:23], v[30:31]
v_pk_mul_f32 v[30:31], v[28:29], s[62:63] op_sel:[0,0] op_sel_hi:[0,1] neg_lo:[0,1] neg_hi:[0,1]
v_pk_fma_f32 v[30:31], v[28:29], s[62:63], v[30:31] op_sel:[1,1,0] op_sel_hi:[1,0,1] neg_lo:[0,0,0] neg_hi:[0,1,0]
v_pk_add_f32 v[28:29], v[64:65], v[32:33] neg_lo:[0,1] neg_hi:[0,1]
v_pk_add_f32 v[64:65], v[64:65], v[32:33]
v_pk_add_f32 v[32:33], v[34:35], v[42:43] neg_lo:[0,1] neg_hi:[0,1]
v_pk_add_f32 v[34:35], v[34:35], v[42:43]
v_pk_mul_f32 v[42:43], v[32:33], s[62:63] op_sel:[0,0] op_sel_hi:[0,1] neg_lo:[0,0] neg_hi:[0,1]
v_pk_fma_f32 v[42:43], v[32:33], s[62:63], v[42:43] op_sel:[1,1,0] op_sel_hi:[1,0,1] neg_lo:[0,0,0] neg_hi:[0,0,0]
v_pk_add_f32 v[32:33], v[36:37], v[44:45] op_sel:[1,1] op_sel_hi:[0,0] neg_lo:[0,1] neg_hi:[1,0]
v_pk_add_f32 v[36:37], v[36:37], v[44:45]
v_pk_add_f32 v[44:45], v[38:39], v[46:47] neg_lo:[0,1] neg_hi:[0,1]
v_pk_add_f32 v[38:39], v[38:39], v[46:47]
v_pk_mul_f32 v[46:47], v[44:45], s[62:63] op_sel:[0,0] op_sel_hi:[0,1] neg_lo:[0,1] neg_hi:[0,1]
v_pk_fma_f32 v[46:47], v[44:45], s[62:63], v[46:47] op_sel:[1,1,0] op_sel_hi:[1,0,1] neg_lo:[0,0,0] neg_hi:[0,1,0]
v_pk_add_f32 v[44:45], v[14:15], v[56:57] neg_lo:[0,1] neg_hi:[0,1]
v_pk_add_f32 v[14:15], v[14:15], v[56:57]
v_pk_add_f32 v[56:57], v[50:51], v[58:59] neg_lo:[0,1] neg_hi:[0,1]
v_pk_add_f32 v[50:51], v[50:51], v[58:59]
v_pk_mul_f32 v[58:59], v[56:57], s[62:63] op_sel:[0,0] op_sel_hi:[0,1] neg_lo:[0,0] neg_hi:[0,1]
v_pk_fma_f32 v[58:59], v[56:57], s[62:63], v[58:59] op_sel:[1,1,0] op_sel_hi:[1,0,1] neg_lo:[0,0,0] neg_hi:[0,0,0]
v_pk_add_f32 v[56:57], v[52:53], v[60:61] op_sel:[1,1] op_sel_hi:[0,0] neg_lo:[0,1] neg_hi:[1,0]
v_pk_add_f32 v[52:53], v[52:53], v[60:61]
v_pk_add_f32 v[60:61], v[54:55], v[62:63] neg_lo:[0,1] neg_hi:[0,1]
v_pk_add_f32 v[54:55], v[54:55], v[62:63]
v_pk_mul_f32 v[62:63], v[60:61], s[62:63] op_sel:[0,0] op_sel_hi:[0,1] neg_lo:[0,1] neg_hi:[0,1]
v_pk_fma_f32 v[62:63], v[60:61], s[62:63], v[62:63] op_sel:[1,1,0] op_sel_hi:[1,0,1] neg_lo:[0,0,0] neg_hi:[0,1,0]
v_pk_add_f32 v[60:61], v[40:41], v[48:49] neg_lo:[0,1] neg_hi:[0,1]
v_pk_add_f32 v[40:41], v[40:41], v[48:49]
v_pk_add_f32 v[48:49], v[66:67], v[74:75] neg_lo:[0,1] neg_hi:[0,1]
v_pk_add_f32 v[66:67], v[66:67], v[74:75]
v_pk_mul_f32 v[74:75], v[48:49], s[62:63] op_sel:[0,0] op_sel_hi:[0,1] neg_lo:[0,0] neg_hi:[0,1]
v_pk_fma_f32 v[74:75], v[48:49], s[62:63], v[74:75] op_sel:[1,1,0] op_sel_hi:[1,0,1] neg_lo:[0,0,0] neg_hi:[0,0,0]
v_pk_add_f32 v[48:49], v[68:69], v[76:77] op_sel:[1,1] op_sel_hi:[0,0] neg_lo:[0,1] neg_hi:[1,0]
v_pk_add_f32 v[68:69], v[68:69], v[76:77]
v_pk_add_f32 v[76:77], v[70:71], v[78:79] neg_lo:[0,1] neg_hi:[0,1]
v_pk_add_f32 v[70:71], v[70:71], v[78:79]
v_pk_mul_f32 v[78:79], v[76:77], s[62:63] op_sel:[0,0] op_sel_hi:[0,1] neg_lo:[0,1] neg_hi:[0,1]
v_pk_fma_f32 v[78:79], v[76:77], s[62:63], v[78:79] op_sel:[1,1,0] op_sel_hi:[1,0,1] neg_lo:[0,0,0] neg_hi:[0,1,0]
v_pk_add_f32 v[76:77], v[16:17], v[20:21] neg_lo:[0,1] neg_hi:[0,1]
v_pk_add_f32 v[16:17], v[16:17], v[20:21]
v_pk_add_f32 v[20:21], v[18:19], v[22:23] op_sel:[1,1] op_sel_hi:[0,0] neg_lo:[0,1] neg_hi:[1,0]
v_pk_add_f32 v[18:19], v[18:19], v[22:23]
v_pk_add_f32 v[22:23], v[72:73], v[24:25] neg_lo:[0,1] neg_hi:[0,1]
v_pk_add_f32 v[72:73], v[72:73], v[24:25]
v_pk_add_f32 v[24:25], v[26:27], v[30:31] op_sel:[1,1] op_sel_hi:[0,0] neg_lo:[0,1] neg_hi:[1,0]
v_pk_add_f32 v[26:27], v[26:27], v[30:31]
v_pk_add_f32 v[30:31], v[64:65], v[36:37] neg_lo:[0,1] neg_hi:[0,1]
v_pk_add_f32 v[64:65], v[64:65], v[36:37]
v_pk_add_f32 v[36:37], v[34:35], v[38:39] op_sel:[1,1] op_sel_hi:[0,0] neg_lo:[0,1] neg_hi:[1,0]
v_pk_add_f32 v[34:35], v[34:35], v[38:39]
v_pk_add_f32 v[38:39], v[28:29], v[32:33] neg_lo:[0,1] neg_hi:[0,1]
v_pk_add_f32 v[28:29], v[28:29], v[32:33]
v_pk_add_f32 v[32:33], v[42:43], v[46:47] op_sel:[1,1] op_sel_hi:[0,0] neg_lo:[0,1] neg_hi:[1,0]
v_pk_add_f32 v[42:43], v[42:43], v[46:47]
v_pk_add_f32 v[46:47], v[14:15], v[52:53] neg_lo:[0,1] neg_hi:[0,1]
v_pk_add_f32 v[14:15], v[14:15], v[52:53]
v_pk_add_f32 v[52:53], v[50:51], v[54:55] op_sel:[1,1] op_sel_hi:[0,0] neg_lo:[0,1] neg_hi:[1,0]
v_pk_add_f32 v[50:51], v[50:51], v[54:55]
v_pk_add_f32 v[54:55], v[44:45], v[56:57] neg_lo:[0,1] neg_hi:[0,1]
v_pk_add_f32 v[44:45], v[44:45], v[56:57]
v_pk_add_f32 v[56:57], v[58:59], v[62:63] op_sel:[1,1] op_sel_hi:[0,0] neg_lo:[0,1] neg_hi:[1,0]
v_pk_add_f32 v[58:59], v[58:59], v[62:63]
v_pk_add_f32 v[62:63], v[40:41], v[68:69] neg_lo:[0,1] neg_hi:[0,1]
v_pk_add_f32 v[40:41], v[40:41], v[68:69]
v_pk_add_f32 v[68:69], v[66:67], v[70:71] op_sel:[1,1] op_sel_hi:[0,0] neg_lo:[0,1] neg_hi:[1,0]
v_pk_add_f32 v[66:67], v[66:67], v[70:71]
v_pk_add_f32 v[70:71], v[60:61], v[48:49] neg_lo:[0,1] neg_hi:[0,1]
v_pk_add_f32 v[60:61], v[60:61], v[48:49]
v_pk_add_f32 v[48:49], v[74:75], v[78:79] op_sel:[1,1] op_sel_hi:[0,0] neg_lo:[0,1] neg_hi:[1,0]
v_pk_add_f32 v[74:75], v[74:75], v[78:79]
v_pk_add_f32 v[78:79], v[16:17], v[18:19] neg_lo:[0,1] neg_hi:[0,1]
v_pk_add_f32 v[16:17], v[16:17], v[18:19]
v_pk_add_f32 v[18:19], v[76:77], v[20:21] neg_lo:[0,1] neg_hi:[0,1]
v_pk_add_f32 v[76:77], v[76:77], v[20:21]
v_pk_add_f32 v[20:21], v[72:73], v[26:27] neg_lo:[0,1] neg_hi:[0,1]
v_pk_add_f32 v[72:73], v[72:73], v[26:27]
v_pk_add_f32 v[26:27], v[22:23], v[24:25] neg_lo:[0,1] neg_hi:[0,1]
v_pk_add_f32 v[22:23], v[22:23], v[24:25]
v_pk_add_f32 v[24:25], v[64:65], v[34:35] neg_lo:[0,1] neg_hi:[0,1]
v_pk_add_f32 v[64:65], v[64:65], v[34:35]
v_pk_add_f32 v[34:35], v[30:31], v[36:37] neg_lo:[0,1] neg_hi:[0,1]
v_pk_add_f32 v[30:31], v[30:31], v[36:37]
v_pk_add_f32 v[36:37], v[28:29], v[42:43] neg_lo:[0,1] neg_hi:[0,1]
v_pk_add_f32 v[28:29], v[28:29], v[42:43]
v_pk_add_f32 v[42:43], v[38:39], v[32:33] neg_lo:[0,1] neg_hi:[0,1]
v_pk_add_f32 v[38:39], v[38:39], v[32:33]
v_pk_add_f32 v[32:33], v[14:15], v[50:51] neg_lo:[0,1] neg_hi:[0,1]
v_pk_add_f32 v[14:15], v[14:15], v[50:51]
v_pk_add_f32 v[50:51], v[46:47], v[52:53] neg_lo:[0,1] neg_hi:[0,1]
v_pk_add_f32 v[46:47], v[46:47], v[52:53]
v_pk_add_f32 v[52:53], v[44:45], v[58:59] neg_lo:[0,1] neg_hi:[0,1]
v_pk_add_f32 v[44:45], v[44:45], v[58:59]
v_pk_add_f32 v[58:59], v[54:55], v[56:57] neg_lo:[0,1] neg_hi:[0,1]
v_pk_add_f32 v[54:55], v[54:55], v[56:57]
v_pk_add_f32 v[56:57], v[40:41], v[66:67] neg_lo:[0,1] neg_hi:[0,1]
v_pk_add_f32 v[40:41], v[40:41], v[66:67]
v_pk_add_f32 v[66:67], v[62:63], v[68:69] neg_lo:[0,1] neg_hi:[0,1]
v_pk_add_f32 v[62:63], v[62:63], v[68:69]
v_pk_add_f32 v[68:69], v[60:61], v[74:75] neg_lo:[0,1] neg_hi:[0,1]
v_pk_add_f32 v[60:61], v[60:61], v[74:75]
v_pk_add_f32 v[74:75], v[70:71], v[48:49] neg_lo:[0,1] neg_hi:[0,1]
v_pk_add_f32 v[70:71], v[70:71], v[48:49]
ds_write_b64 v4, v[16:17] offset:0
ds_write_b64 v4, v[14:15] offset:256
ds_write_b64 v4, v[64:65] offset:512
ds_write_b64 v4, v[40:41] offset:768
ds_write_b64 v4, v[72:73] offset:1024
ds_write_b64 v4, v[44:45] offset:1280
ds_write_b64 v4, v[28:29] offset:1536
ds_write_b64 v4, v[60:61] offset:1792
ds_write_b64 v4, v[76:77] offset:2048
ds_write_b64 v4, v[46:47] offset:2304
ds_write_b64 v4, v[30:31] offset:2560
ds_write_b64 v4, v[62:63] offset:2816
ds_write_b64 v4, v[22:23] offset:3072
ds_write_b64 v4, v[54:55] offset:3328
ds_write_b64 v4, v[38:39] offset:3584
ds_write_b64 v4, v[70:71] offset:3840
ds_write_b64 v4, v[78:79] offset:4096
ds_write_b64 v4, v[32:33] offset:4352
ds_write_b64 v4, v[24:25] offset:4608
ds_write_b64 v4, v[56:57] offset:4864
ds_write_b64 v4, v[20:21] offset:5120
ds_write_b64 v4, v[52:53] offset:5376
ds_write_b64 v4, v[36:37] offset:5632
ds_write_b64 v4, v[68:69] offset:5888
ds_write_b64 v4, v[18:19] offset:6144
ds_write_b64 v4, v[50:51] offset:6400
ds_write_b64 v4, v[34:35] offset:6656
ds_write_b64 v4, v[66:67] offset:6912
ds_write_b64 v4, v[26:27] offset:7168
ds_write_b64 v4, v[58:59] offset:7424
ds_write_b64 v4, v[42:43] offset:7680
ds_write_b64 v4, v[74:75] offset:7936
ds_write_b64 v4, v[16:17] offset:8192
s_waitcnt lgkmcnt(0)
s_barrier
s_lshl_b32 s13, s93, 7
s_and_b32 s23, s13, 0x2000
s_add_u32 s13, s13, s23
s_xor_b32 s23, s98, 1
s_lshl_b32 s23, s23, 13
s_add_u32 s13, s13, s23
s_add_u32 s13, s13, 92274688
ds_read_b64 v[16:17], v6 offset:0
ds_read_b64 v[18:19], v7 offset:4096
ds_read_b64 v[20:21], v6 offset:256
ds_read_b64 v[22:23], v7 offset:3840
ds_read_b64 v[24:25], v6 offset:512
ds_read_b64 v[26:27], v7 offset:3584
ds_read_b64 v[28:29], v6 offset:768
ds_read_b64 v[30:31], v7 offset:3328
ds_read_b64 v[32:33], v6 offset:1024
ds_read_b64 v[34:35], v7 offset:3072
ds_read_b64 v[36:37], v6 offset:1280
ds_read_b64 v[38:39], v7 offset:2816
s_waitcnt lgkmcnt(10)
v_pk_add_f32 v[208:209], v[16:17], v[18:19] neg_hi:[0,1]
v_pk_add_f32 v[210:211], v[16:17], v[18:19] op_sel:[1,1] op_sel_hi:[0,0] neg_hi:[1,0]
ds_read_b64 v[40:41], v6 offset:1536
ds_read_b64 v[42:43], v7 offset:2560
buffer_store_dwordx4 v[208:211], v8, s[84:87], s13 offen sc1
s_add_u32 s13, s13, 1048576
s_waitcnt lgkmcnt(10)
v_pk_add_f32 v[212:213], v[20:21], v[22:23] neg_hi:[0,1]
v_pk_add_f32 v[214:215], v[20:21], v[22:23] op_sel:[1,1] op_sel_hi:[0,0] neg_hi:[1,0]
ds_read_b64 v[44:45], v6 offset:1792
ds_read_b64 v[46:47], v7 offset:2304
buffer_store_dwordx4 v[212:215], v8, s[84:87], s13 offen sc1
s_add_u32 s13, s13, 1048576
s_xor_b32 s13, s13, 0x2000
s_waitcnt lgkmcnt(10)
v_pk_add_f32 v[216:217], v[24:25], v[26:27] neg_hi:[0,1]
v_pk_add_f32 v[218:219], v[24:25], v[26:27] op_sel:[1,1] op_sel_hi:[0,0] neg_hi:[1,0]
ds_read_b64 v[16:17], v6 offset:2048
ds_read_b64 v[18:19], v7 offset:2048
buffer_store_dwordx4 v[216:219], v8, s[84:87], s13 offen sc1
s_add_u32 s13, s13, 1048576
s_waitcnt lgkmcnt(10)
v_pk_add_f32 v[220:221], v[28:29], v[30:31] neg_hi:[0,1]
v_pk_add_f32 v[222:223], v[28:29], v[30:31] op_sel:[1,1] op_sel_hi:[0,0] neg_hi:[1,0]
ds_read_b64 v[20:21], v6 offset:2304
ds_read_b64 v[22:23], v7 offset:1792
buffer_store_dwordx4 v[220:223], v8, s[84:87], s13 offen sc1
s_add_u32 s13, s13, 1048576
s_xor_b32 s13, s13, 0x2000
s_waitcnt lgkmcnt(10)
v_pk_add_f32 v[224:225], v[32:33], v[34:35] neg_hi:[0,1]
v_pk_add_f32 v[226:227], v[32:33], v[34:35] op_sel:[1,1] op_sel_hi:[0,0] neg_hi:[1,0]
ds_read_b64 v[24:25], v6 offset:2560
ds_read_b64 v[26:27], v7 offset:1536
buffer_store_dwordx4 v[224:227], v8, s[84:87], s13 offen sc1
s_add_u32 s13, s13, 1048576
s_waitcnt lgkmcnt(10)
v_pk_add_f32 v[228:229], v[36:37], v[38:39] neg_hi:[0,1]
v_pk_add_f32 v[230:231], v[36:37], v[38:39] op_sel:[1,1] op_sel_hi:[0,0] neg_hi:[1,0]
ds_read_b64 v[28:29], v6 offset:2816
ds_read_b64 v[30:31], v7 offset:1280
buffer_store_dwordx4 v[228:231], v8, s[84:87], s13 offen sc1
s_add_u32 s13, s13, 1048576
s_xor_b32 s13, s13, 0x2000
s_waitcnt lgkmcnt(10)
v_pk_add_f32 v[232:233], v[40:41], v[42:43] neg_hi:[0,1]
v_pk_add_f32 v[234:235], v[40:41], v[42:43] op_sel:[1,1] op_sel_hi:[0,0] neg_hi:[1,0]
ds_read_b64 v[32:33], v6 offset:3072
ds_read_b64 v[34:35], v7 offset:1024
buffer_store_dwordx4 v[232:235], v8, s[84:87], s13 offen sc1
s_add_u32 s13, s13, 1048576
s_waitcnt lgkmcnt(10)
v_pk_add_f32 v[236:237], v[44:45], v[46:47] neg_hi:[0,1]
v_pk_add_f32 v[238:239], v[44:45], v[46:47] op_sel:[1,1] op_sel_hi:[0,0] neg_hi:[1,0]
ds_read_b64 v[36:37], v6 offset:3328
ds_read_b64 v[38:39], v7 offset:768
buffer_store_dwordx4 v[236:239], v8, s[84:87], s13 offen sc1
s_add_u32 s13, s13, 1048576
s_xor_b32 s13, s13, 0x2000
s_waitcnt lgkmcnt(10)
v_pk_add_f32 v[208:209], v[16:17], v[18:19] neg_hi:[0,1]
v_pk_add_f32 v[210:211], v[16:17], v[18:19] op_sel:[1,1] op_sel_hi:[0,0] neg_hi:[1,0]
ds_read_b64 v[40:41], v6 offset:3584
ds_read_b64 v[42:43], v7 offset:512
buffer_store_dwordx4 v[208:211], v8, s[84:87], s13 offen sc1
s_add_u32 s13, s13, 1048576
s_waitcnt lgkmcnt(10)
v_pk_add_f32 v[212:213], v[20:21], v[22:23] neg_hi:[0,1]
v_pk_add_f32 v[214:215], v[20:21], v[22:23] op_sel:[1,1] op_sel_hi:[0,0] neg_hi:[1,0]
ds_read_b64 v[44:45], v6 offset:3840
ds_read_b64 v[46:47], v7 offset:256
buffer_store_dwordx4 v[212:215], v8, s[84:87], s13 offen sc1
s_add_u32 s13, s13, 1048576
s_xor_b32 s13, s13, 0x2000
s_waitcnt lgkmcnt(10)
v_pk_add_f32 v[216:217], v[24:25], v[26:27] neg_hi:[0,1]
v_pk_add_f32 v[218:219], v[24:25], v[26:27] op_sel:[1,1] op_sel_hi:[0,0] neg_hi:[1,0]
ds_read_b64 v[16:17], v6 offset:4096
ds_read_b64 v[18:19], v7 offset:0
buffer_store_dwordx4 v[216:219], v8, s[84:87], s13 offen sc1
s_add_u32 s13, s13, 1048576
s_waitcnt lgkmcnt(10)
v_pk_add_f32 v[220:221], v[28:29], v[30:31] neg_hi:[0,1]
v_pk_add_f32 v[222:223], v[28:29], v[30:31] op_sel:[1,1] op_sel_hi:[0,0] neg_hi:[1,0]
buffer_store_dwordx4 v[220:223], v8, s[84:87], s13 offen sc1
s_add_u32 s13, s13, 1048576
s_xor_b32 s13, s13, 0x2000
s_waitcnt lgkmcnt(8)
v_pk_add_f32 v[224:225], v[32:33], v[34:35] neg_hi:[0,1]
v_pk_add_f32 v[226:227], v[32:33], v[34:35] op_sel:[1,1] op_sel_hi:[0,0] neg_hi:[1,0]
buffer_store_dwordx4 v[224:227], v8, s[84:87], s13 offen sc1
s_add_u32 s13, s13, 1048576
s_waitcnt lgkmcnt(6)
v_pk_add_f32 v[228:229], v[36:37], v[38:39] neg_hi:[0,1]
v_pk_add_f32 v[230:231], v[36:37], v[38:39] op_sel:[1,1] op_sel_hi:[0,0] neg_hi:[1,0]
buffer_store_dwordx4 v[228:231], v8, s[84:87], s13 offen sc1
s_add_u32 s13, s13, 1048576
s_xor_b32 s13, s13, 0x2000
s_waitcnt lgkmcnt(4)
v_pk_add_f32 v[232:233], v[40:41], v[42:43] neg_hi:[0,1]
v_pk_add_f32 v[234:235], v[40:41], v[42:43] op_sel:[1,1] op_sel_hi:[0,0] neg_hi:[1,0]
buffer_store_dwordx4 v[232:235], v8, s[84:87], s13 offen sc1
s_add_u32 s13, s13, 1048576
s_waitcnt lgkmcnt(2)
v_pk_add_f32 v[236:237], v[44:45], v[46:47] neg_hi:[0,1]
v_pk_add_f32 v[238:239], v[44:45], v[46:47] op_sel:[1,1] op_sel_hi:[0,0] neg_hi:[1,0]
buffer_store_dwordx4 v[236:239], v8, s[84:87], s13 offen sc1
s_add_u32 s13, s13, 1048576
s_xor_b32 s13, s13, 0x2000
s_waitcnt lgkmcnt(0)
v_pk_add_f32 v[208:209], v[16:17], v[18:19] neg_hi:[0,1]
v_pk_add_f32 v[210:211], v[16:17], v[18:19] op_sel:[1,1] op_sel_hi:[0,0] neg_hi:[1,0]
v_cmp_eq_u32 vcc, 0, v9
s_nop 1
v_cndmask_b32 v13, -16, v8, vcc
buffer_store_dwordx4 v[208:211], v13, s[84:87], s13 offen sc1
s_add_u32 s13, s13, 1048576
s_mov_b32 s93, s21
s_cmp_lt_u32 s93, 128
s_cbranch_scc1 mega_kernel_f1_l
mega_kernel_f1_e:
s_mov_b32 s93, s40
s_waitcnt vmcnt(0)
s_load_dwordx2 s[4:5], s[0:1], 64
s_load_dwordx2 s[8:9], s[0:1], 72
v_and_b32 v1, 63, v0
v_lshrrev_b32 v2, 6, v0
v_mul_u32_u24 v3, 1026, v2
v_lshl_add_u32 v3, v1, 1, v3
v_mul_u32_u24 v4, 65, v1
v_add_u32 v4, v4, v2
v_lshlrev_b32 v4, 2, v4
v_lshrrev_b32 v7, 4, v0
v_and_b32 v8, 15, v0
v_mul_u32_u24 v5, 65, v7
v_lshl_add_u32 v5, v8, 2, v5
v_lshlrev_b32 v5, 2, v5
v_mul_u32_u24 v6, 16384, v7
v_lshl_add_u32 v6, v8, 4, v6
s_add_u32 s24, s84, 171966464
s_addc_u32 s25, s85, 0
s_mov_b32 s26, 8404992
s_mov_b32 s27, 0x00020000
s_waitcnt lgkmcnt(0)
s_mov_b32 s6, 2101248
s_mov_b32 s7, 0x00020000
s_mov_b32 s10, 2101248
s_mov_b32 s11, 0x00020000
v_lshlrev_b32 v9, 7, v0
s_and_b32 s12, s93, 31
s_mul_i32 s12, s12, 65664
buffer_load_dword v250, v9, s[4:7], s12 offen
buffer_load_dword v250, v9, s[8:11], s12 offen
s_add_u32 s12, s12, 32768
buffer_load_dword v250, v9, s[4:7], s12 offen
buffer_load_dword v250, v9, s[8:11], s12 offen
s_add_u32 s12, s12, 32768
s_cmp_lt_u32 s93, 288
s_cbranch_scc0 mega_kernel_f0_e
s_and_b32 s12, s93, 31
s_mul_i32 s12, s12, 65664
s_lshr_b32 s13, s93, 5
s_lshl_b32 s13, s13, 7
s_add_u32 s12, s12, s13
buffer_load_ushort v16, v3, s[4:7], s12 offen
buffer_load_ushort v32, v3, s[8:11], s12 offen
s_add_u32 s12, s12, 4104
buffer_load_ushort v17, v3, s[4:7], s12 offen
buffer_load_ushort v33, v3, s[8:11], s12 offen
s_add_u32 s12, s12, 4104
buffer_load_ushort v18, v3, s[4:7], s12 offen
buffer_load_ushort v34, v3, s[8:11], s12 offen
s_add_u32 s12, s12, 4104
buffer_load_ushort v19, v3, s[4:7], s12 offen
buffer_load_ushort v35, v3, s[8:11], s12 offen
s_add_u32 s12, s12, 4104
buffer_load_ushort v20, v3, s[4:7], s12 offen
buffer_load_ushort v36, v3, s[8:11], s12 offen
s_add_u32 s12, s12, 4104
buffer_load_ushort v21, v3, s[4:7], s12 offen
buffer_load_ushort v37, v3, s[8:11], s12 offen
s_add_u32 s12, s12, 4104
buffer_load_ushort v22, v3, s[4:7], s12 offen
buffer_load_ushort v38, v3, s[8:11], s12 offen
s_add_u32 s12, s12, 4104
buffer_load_ushort v23, v3, s[4:7], s12 offen
buffer_load_ushort v39, v3, s[8:11], s12 offen
s_add_u32 s12, s12, 4104
buffer_load_ushort v24, v3, s[4:7], s12 offen
buffer_load_ushort v40, v3, s[8:11], s12 offen
s_add_u32 s12, s12, 4104
buffer_load_ushort v25, v3, s[4:7], s12 offen
buffer_load_ushort v41, v3, s[8:11], s12 offen
s_add_u32 s12, s12, 4104
buffer_load_ushort v26, v3, s[4:7], s12 offen
buffer_load_ushort v42, v3, s[8:11], s12 offen
s_add_u32 s12, s12, 4104
buffer_load_ushort v27, v3, s[4:7], s12 offen
buffer_load_ushort v43, v3, s[8:11], s12 offen
s_add_u32 s12, s12, 4104
buffer_load_ushort v28, v3, s[4:7], s12 offen
buffer_load_ushort v44, v3, s[8:11], s12 offen
s_add_u32 s12, s12, 4104
buffer_load_ushort v29, v3, s[4:7], s12 offen
buffer_load_ushort v45, v3, s[8:11], s12 offen
s_add_u32 s12, s12, 4104
buffer_load_ushort v30, v3, s[4:7], s12 offen
buffer_load_ushort v46, v3, s[8:11], s12 offen
s_add_u32 s12, s12, 4104
buffer_load_ushort v31, v3, s[4:7], s12 offen
buffer_load_ushort v47, v3, s[8:11], s12 offen
s_add_u32 s12, s12, 4104
s_waitcnt vmcnt(0)
mega_kernel_f0_l:
s_add_u32 s21, s93, 32
s_cmp_lt_u32 s21, 288
s_cselect_b32 s22, s21, s93
s_waitcnt vmcnt(4)
v_lshl_or_b32 v48, v32, 16, v16
v_lshl_or_b32 v49, v33, 16, v17
v_lshl_or_b32 v50, v34, 16, v18
v_lshl_or_b32 v51, v35, 16, v19
v_lshl_or_b32 v52, v36, 16, v20
v_lshl_or_b32 v53, v37, 16, v21
v_lshl_or_b32 v54, v38, 16, v22
v_lshl_or_b32 v55, v39, 16, v23
v_lshl_or_b32 v56, v40, 16, v24
v_lshl_or_b32 v57, v41, 16, v25
v_lshl_or_b32 v58, v42, 16, v26
v_lshl_or_b32 v59, v43, 16, v27
v_lshl_or_b32 v60, v44, 16, v28
v_lshl_or_b32 v61, v45, 16, v29
v_lshl_or_b32 v62, v46, 16, v30
v_lshl_or_b32 v63, v47, 16, v31
s_and_b32 s12, s22, 31
s_mul_i32 s12, s12, 65664
s_lshr_b32 s13, s22, 5
s_lshl_b32 s13, s13, 7
s_add_u32 s12, s12, s13
buffer_load_ushort v16, v3, s[4:7], s12 offen
buffer_load_ushort v32, v3, s[8:11], s12 offen
s_add_u32 s12, s12, 4104
buffer_load_ushort v17, v3, s[4:7], s12 offen
buffer_load_ushort v33, v3, s[8:11], s12 offen
s_add_u32 s12, s12, 4104
buffer_load_ushort v18, v3, s[4:7], s12 offen
buffer_load_ushort v34, v3, s[8:11], s12 offen
s_add_u32 s12, s12, 4104
buffer_load_ushort v19, v3, s[4:7], s12 offen
buffer_load_ushort v35, v3, s[8:11], s12 offen
s_add_u32 s12, s12, 4104
buffer_load_ushort v20, v3, s[4:7], s12 offen
buffer_load_ushort v36, v3, s[8:11], s12 offen
s_add_u32 s12, s12, 4104
buffer_load_ushort v21, v3, s[4:7], s12 offen
buffer_load_ushort v37, v3, s[8:11], s12 offen
s_add_u32 s12, s12, 4104
buffer_load_ushort v22, v3, s[4:7], s12 offen
buffer_load_ushort v38, v3, s[8:11], s12 offen
s_add_u32 s12, s12, 4104
buffer_load_ushort v23, v3, s[4:7], s12 offen
buffer_load_ushort v39, v3, s[8:11], s12 offen
s_add_u32 s12, s12, 4104
buffer_load_ushort v24, v3, s[4:7], s12 offen
buffer_load_ushort v40, v3, s[8:11], s12 offen
s_add_u32 s12, s12, 4104
buffer_load_ushort v25, v3, s[4:7], s12 offen
buffer_load_ushort v41, v3, s[8:11], s12 offen
s_add_u32 s12, s12, 4104
buffer_load_ushort v26, v3, s[4:7], s12 offen
buffer_load_ushort v42, v3, s[8:11], s12 offen
s_add_u32 s12, s12, 4104
buffer_load_ushort v27, v3, s[4:7], s12 offen
buffer_load_ushort v43, v3, s[8:11], s12 offen
s_add_u32 s12, s12, 4104
buffer_load_ushort v28, v3, s[4:7], s12 offen
buffer_load_ushort v44, v3, s[8:11], s12 offen
s_add_u32 s12, s12, 4104
buffer_load_ushort v29, v3, s[4:7], s12 offen
buffer_load_ushort v45, v3, s[8:11], s12 offen
s_add_u32 s12, s12, 4104
buffer_load_ushort v30, v3, s[4:7], s12 offen
buffer_load_ushort v46, v3, s[8:11], s12 offen
s_add_u32 s12, s12, 4104
buffer_load_ushort v31, v3, s[4:7], s12 offen
buffer_load_ushort v47, v3, s[8:11], s12 offen
s_add_u32 s12, s12, 4104
s_barrier
ds_write_b32 v4, v48 offset:0
ds_write_b32 v4, v49 offset:16
ds_write_b32 v4, v50 offset:32
ds_write_b32 v4, v51 offset:48
ds_write_b32 v4, v52 offset:64
ds_write_b32 v4, v53 offset:80
ds_write_b32 v4, v54 offset:96
ds_write_b32 v4, v55 offset:112
ds_write_b32 v4, v56 offset:128
ds_write_b32 v4, v57 offset:144
ds_write_b32 v4, v58 offset:160
ds_write_b32 v4, v59 offset:176
s_waitcnt lgkmcnt(4)
ds_write_b32 v4, v60 offset:192
ds_write_b32 v4, v61 offset:208
ds_write_b32 v4, v62 offset:224
ds_write_b32 v4, v63 offset:240
s_waitcnt lgkmcnt(0)
s_barrier
ds_read2_b32 v[64:65], v5 offset0:0 offset1:1
ds_read_b32 v66, v5 offset:8
ds_read_b32 v67, v5 offset:12
ds_read_b32 v68, v5 offset:4160
ds_read_b32 v69, v5 offset:4164
ds_read_b32 v70, v5 offset:4168
ds_read_b32 v71, v5 offset:4172
ds_read_b32 v72, v5 offset:8320
ds_read_b32 v73, v5 offset:8324
ds_read_b32 v74, v5 offset:8328
ds_read_b32 v75, v5 offset:8332
ds_read_b32 v76, v5 offset:12480
ds_read_b32 v77, v5 offset:12484
ds_read_b32 v78, v5 offset:12488
ds_read_b32 v79, v5 offset:12492
s_and_b32 s14, s93, 31
s_lshl_b32 s14, s14, 8
s_lshr_b32 s15, s93, 5
s_lshr_b32 s23, s15, 1
s_xnor_b32 s23, s23, s98
s_and_b32 s23, s23, 1
s_lshl_b32 s23, s23, 13
s_mul_i32 s15, s15, 1048576
s_add_u32 s15, s15, 0
s_add_u32 s15, s15, s23
s_add_u32 s14, s14, s15
s_waitcnt lgkmcnt(0)
buffer_store_dwordx4 v[64:67], v6, s[24:27], s14 offen sc1
s_add_u32 s14, s14, 262144
buffer_store_dwordx4 v[68:71], v6, s[24:27], s14 offen sc1
s_add_u32 s14, s14, 262144
buffer_store_dwordx4 v[72:75], v6, s[24:27], s14 offen sc1
s_add_u32 s14, s14, 262144
buffer_store_dwordx4 v[76:79], v6, s[24:27], s14 offen sc1
s_add_u32 s14, s14, 262144
s_mov_b32 s93, s21
s_cmp_lt_u32 s93, 288
s_cbranch_scc1 mega_kernel_f0_l
mega_kernel_f0_e:
v_and_b32 v3, 15, v0
v_lshlrev_b32 v3, 4, v3
s_branch mega_kernel_syd
mega_kernel_sydw:
s_sleep 4
mega_kernel_syd:
buffer_load_dword v2, v3, s[72:75], 0 offen sc1
s_waitcnt vmcnt(0)
mega_kernel_sydp:
s_cmp_eq_u32 s95, 1
s_cbranch_scc0 mega_kernel_sydf
v_readlane_b32 s76, v2, 14
s_mov_b32 s98, 0
s_cmp_eq_u32 s76, 32
s_cbranch_scc0 mega_kernel_sydw
s_branch mega_kernel_sydd
mega_kernel_sydf:
s_mov_b32 s77, 0
s_mov_b32 s78, 0
v_readlane_b32 s76, v2, 0
s_add_u32 s77, s77, s76
s_xor_b32 s76, s76, 32
s_or_b32 s78, s78, s76
v_readlane_b32 s76, v2, 1
s_add_u32 s77, s77, s76
s_xor_b32 s76, s76, 32
s_or_b32 s78, s78, s76
v_readlane_b32 s76, v2, 2
s_add_u32 s77, s77, s76
s_xor_b32 s76, s76, 32
s_or_b32 s78, s78, s76
v_readlane_b32 s76, v2, 3
s_add_u32 s77, s77, s76
s_xor_b32 s76, s76, 32
s_or_b32 s78, s78, s76
v_readlane_b32 s76, v2, 4
s_add_u32 s77, s77, s76
s_xor_b32 s76, s76, 32
s_or_b32 s78, s78, s76
v_readlane_b32 s76, v2, 5
s_add_u32 s77, s77, s76
s_xor_b32 s76, s76, 32
s_or_b32 s78, s78, s76
v_readlane_b32 s76, v2, 6
s_add_u32 s77, s77, s76
s_xor_b32 s76, s76, 32
s_or_b32 s78, s78, s76
v_readlane_b32 s76, v2, 7
s_add_u32 s77, s77, s76
s_xor_b32 s76, s76, 32
s_or_b32 s78, s78, s76
s_cmp_eq_u32 s77, 256
s_cbranch_scc0 mega_kernel_sydw
v_mov_b32 v252, v2
s_cmp_eq_u32 s78, 0
s_cbranch_scc0 mega_kernel_slowent
v_readlane_b32 s76, v2, 10
v_readlane_b32 s77, v2, 8
s_cmp_eq_u32 s76, 32
s_cbranch_scc0 mega_kernel_sydw
s_cmp_gt_u32 s77, 16
s_cselect_b32 s98, 1, 0
mega_kernel_sydd:
s_waitcnt vmcnt(0)
s_barrier
v_mov_b32 v1, 0
v_mov_b32 v2, 1
s_mov_b32 s82, 69259264
v_cmp_eq_u32 vcc, 0, v0
s_and_saveexec_b64 s[80:81], vcc
s_cbranch_execz mega_kernel_sg0
buffer_atomic_add v2, v1, s[84:87], s82 offen sc1
mega_kernel_sg0:
s_mov_b64 exec, s[80:81]
s_add_u32 s38, s40, 129
s_mov_b32 s39, 32
s_mov_b32 s37, 129
s_cmp_lt_u32 s38, 129
s_cbranch_scc1 mega_kernel_f2s
s_branch mega_kernel_f2e
mega_kernel_rk:
s_load_dwordx2 s[4:5], s[0:1], 24
s_load_dwordx2 s[8:9], s[0:1], 0
v_lshrrev_b32 v2, 6, v0
v_and_b32 v1, 63, v0
v_readfirstlane_b32 s41, v2
v_lshlrev_b32 v5, 4, v1
s_waitcnt lgkmcnt(0)
s_mov_b32 s6, 8388608
s_mov_b32 s7, 0x00020000
s_mov_b32 s10, 4194304
s_mov_b32 s11, 0x00020000
s_lshl_b32 s43, s40, 8
s_lshl_b32 s44, s41, 6
s_add_u32 s48, s43, s44
s_and_b32 s43, s48, 0x7ff
v_add_u32 v19, s43, v1
v_lshlrev_b32 v19, 7, v19
s_mov_b32 s43, 0
buffer_load_dword v250, v19, s[8:11], s43 offen
s_nop 0
v_lshrrev_b32 v2, 3, v1
s_lshl_b32 s43, s41, 3
v_add_u32 v2, s43, v2
v_bfe_u32 v3, v2, 1, 3
v_and_b32 v4, 7, v1
v_xor_b32 v3, v3, v4
v_lshlrev_b32 v6, 11, v2
v_lshl_add_u32 v6, v3, 4, v6
s_lshl_b32 s46, s41, 10
v_and_b32 v2, 15, v1
v_bfe_u32 v3, v2, 1, 3
v_lshrrev_b32 v4, 4, v1
v_xor_b32 v3, v3, v4
v_lshlrev_b32 v8, 7, v2
v_lshl_add_u32 v8, v3, 4, v8
v_xor_b32 v9, 64, v8
v_add_u32 v10, 0x10000, v8
v_add_u32 v11, 0x10000, v9
v_mov_b32 v7, v5
s_lshl_b32 s47, s40, 2
s_add_u32 s47, s47, s41
s_mov_b32 s42, 0
s_mov_b32 s50, 0
s_add_u32 m0, s46, 0
s_nop 0
buffer_load_dwordx4 v6, s[8:11], s50 offen offset:0 lds
s_add_u32 m0, s46, 3968
s_nop 0
buffer_load_dwordx4 v6, s[8:11], s50 offen offset:128 lds
s_add_u32 m0, s46, 7936
s_nop 0
buffer_load_dwordx4 v6, s[8:11], s50 offen offset:256 lds
s_add_u32 m0, s46, 11904
s_nop 0
buffer_load_dwordx4 v6, s[8:11], s50 offen offset:384 lds
s_add_u32 m0, s46, 15872
s_nop 0
buffer_load_dwordx4 v6, s[8:11], s50 offen offset:512 lds
s_add_u32 m0, s46, 19840
s_nop 0
buffer_load_dwordx4 v6, s[8:11], s50 offen offset:640 lds
s_add_u32 m0, s46, 23808
s_nop 0
buffer_load_dwordx4 v6, s[8:11], s50 offen offset:768 lds
s_add_u32 m0, s46, 27776
s_nop 0
buffer_load_dwordx4 v6, s[8:11], s50 offen offset:896 lds
s_add_u32 m0, s46, 31744
s_nop 0
buffer_load_dwordx4 v6, s[8:11], s50 offen offset:1024 lds
s_add_u32 m0, s46, 35712
s_nop 0
buffer_load_dwordx4 v6, s[8:11], s50 offen offset:1152 lds
s_add_u32 m0, s46, 39680
s_nop 0
buffer_load_dwordx4 v6, s[8:11], s50 offen offset:1280 lds
s_add_u32 m0, s46, 43648
s_nop 0
buffer_load_dwordx4 v6, s[8:11], s50 offen offset:1408 lds
s_add_u32 m0, s46, 47616
s_nop 0
buffer_load_dwordx4 v6, s[8:11], s50 offen offset:1536 lds
s_add_u32 m0, s46, 51584
s_nop 0
buffer_load_dwordx4 v6, s[8:11], s50 offen offset:1664 lds
s_add_u32 m0, s46, 55552
s_nop 0
buffer_load_dwordx4 v6, s[8:11], s50 offen offset:1792 lds
s_add_u32 m0, s46, 59520
s_nop 0
buffer_load_dwordx4 v6, s[8:11], s50 offen offset:1920 lds
v_lshrrev_b32 v2, 2, v1
v_and_b32 v3, 3, v1
v_lshlrev_b32 v16, 13, v2
v_lshl_add_u32 v16, v3, 4, v16
v_add_u32 v16, s48, v16
s_mul_i32 s45, s41, 24576
s_add_u32 s45, s45, 65536
v_bfe_u32 v17, v1, 2, 2
v_lshrrev_b32 v18, 4, v1
v_lshl_add_u32 v17, v18, 3, v17
v_lshlrev_b32 v17, 6, v17
v_lshl_add_u32 v17, v3, 4, v17
v_add_u32 v17, s45, v17
s_and_b32 s43, s40, 3
s_lshl_b32 s43, s43, 2
s_add_u32 s43, s43, s41
s_lshl_b32 s43, s43, 3
v_and_b32 v12, 7, v1
v_add_u32 v12, s43, v12
s_lshr_b32 s43, s40, 2
s_lshl_b32 s43, s43, 10
s_add_u32 s44, s43, 896
s_add_u32 s43, s43, 384
s_cmp_ge_u32 s40, 28
s_cselect_b32 s44, s44, s43
v_mov_b32 v13, s43
v_mov_b32 v14, s44
v_cmp_gt_u32 vcc, 32, v1
s_nop 1
v_cndmask_b32 v13, v14, v13, vcc
v_lshl_add_u32 v12, v12, 13, v13
s_mov_b32 s44, 0
buffer_load_dword v250, v12, s[4:7], s44 offen
s_add_u32 m0, s45, 0
s_mov_b32 s44, 0
buffer_load_dwordx4 v16, s[4:7], s44 offen lds
s_add_u32 m0, s45, 1024
s_mov_b32 s44, 131072
buffer_load_dwordx4 v16, s[4:7], s44 offen lds
s_add_u32 m0, s45, 2048
s_mov_b32 s44, 262144
buffer_load_dwordx4 v16, s[4:7], s44 offen lds
s_add_u32 m0, s45, 3072
s_mov_b32 s44, 393216
buffer_load_dwordx4 v16, s[4:7], s44 offen lds
s_add_u32 m0, s45, 4096
s_mov_b32 s44, 524288
buffer_load_dwordx4 v16, s[4:7], s44 offen lds
s_add_u32 m0, s45, 5120
s_mov_b32 s44, 655360
buffer_load_dwordx4 v16, s[4:7], s44 offen lds
s_add_u32 m0, s45, 6144
s_mov_b32 s44, 786432
buffer_load_dwordx4 v16, s[4:7], s44 offen lds
s_add_u32 m0, s45, 7168
s_mov_b32 s44, 917504
buffer_load_dwordx4 v16, s[4:7], s44 offen lds
s_mov_b32 s44, 1048576
buffer_load_dword v250, v12, s[4:7], s44 offen
s_add_u32 m0, s45, 8192
s_mov_b32 s44, 1048576
buffer_load_dwordx4 v16, s[4:7], s44 offen lds
s_add_u32 m0, s45, 9216
s_mov_b32 s44, 1179648
buffer_load_dwordx4 v16, s[4:7], s44 offen lds
s_add_u32 m0, s45, 10240
s_mov_b32 s44, 1310720
buffer_load_dwordx4 v16, s[4:7], s44 offen lds
s_add_u32 m0, s45, 11264
s_mov_b32 s44, 1441792
buffer_load_dwordx4 v16, s[4:7], s44 offen lds
s_add_u32 m0, s45, 12288
s_mov_b32 s44, 1572864
buffer_load_dwordx4 v16, s[4:7], s44 offen lds
s_add_u32 m0, s45, 13312
s_mov_b32 s44, 1703936
buffer_load_dwordx4 v16, s[4:7], s44 offen lds
s_add_u32 m0, s45, 14336
s_mov_b32 s44, 1835008
buffer_load_dwordx4 v16, s[4:7], s44 offen lds
s_add_u32 m0, s45, 15360
s_mov_b32 s44, 1966080
buffer_load_dwordx4 v16, s[4:7], s44 offen lds
s_mov_b32 s44, 2097152
buffer_load_dword v250, v12, s[4:7], s44 offen
s_add_u32 m0, s45, 16384
s_mov_b32 s44, 2097152
buffer_load_dwordx4 v16, s[4:7], s44 offen lds
s_add_u32 m0, s45, 17408
s_mov_b32 s44, 2228224
buffer_load_dwordx4 v16, s[4:7], s44 offen lds
s_add_u32 m0, s45, 18432
s_mov_b32 s44, 2359296
buffer_load_dwordx4 v16, s[4:7], s44 offen lds
s_add_u32 m0, s45, 19456
s_mov_b32 s44, 2490368
buffer_load_dwordx4 v16, s[4:7], s44 offen lds
s_add_u32 m0, s45, 20480
s_mov_b32 s44, 2621440
buffer_load_dwordx4 v16, s[4:7], s44 offen lds
s_add_u32 m0, s45, 21504
s_mov_b32 s44, 2752512
buffer_load_dwordx4 v16, s[4:7], s44 offen lds
s_add_u32 m0, s45, 22528
s_mov_b32 s44, 2883584
buffer_load_dwordx4 v16, s[4:7], s44 offen lds
s_add_u32 m0, s45, 23552
s_mov_b32 s44, 3014656
buffer_load_dwordx4 v16, s[4:7], s44 offen lds
s_waitcnt vmcnt(18)
s_barrier
ds_read_b64_tr_b16 a[0:1], v17 offset:0
ds_read_b64_tr_b16 a[2:3], v17 offset:256
ds_read_b64_tr_b16 a[4:5], v17 offset:8
ds_read_b64_tr_b16 a[6:7], v17 offset:264
ds_read_b64_tr_b16 a[8:9], v17 offset:2048
ds_read_b64_tr_b16 a[10:11], v17 offset:2304
ds_read_b64_tr_b16 a[12:13], v17 offset:2056
ds_read_b64_tr_b16 a[14:15], v17 offset:2312
s_waitcnt lgkmcnt(0)
ds_read_b64_tr_b16 a[16:17], v17 offset:4096
ds_read_b64_tr_b16 a[18:19], v17 offset:4352
ds_read_b64_tr_b16 a[20:21], v17 offset:4104
ds_read_b64_tr_b16 a[22:23], v17 offset:4360
ds_read_b64_tr_b16 a[24:25], v17 offset:6144
ds_read_b64_tr_b16 a[26:27], v17 offset:6400
ds_read_b64_tr_b16 a[28:29], v17 offset:6152
ds_read_b64_tr_b16 a[30:31], v17 offset:6408
s_waitcnt lgkmcnt(0)
s_mov_b32 s44, 3145728
buffer_load_dword v250, v12, s[4:7], s44 offen
s_add_u32 m0, s45, 0
s_mov_b32 s44, 3145728
buffer_load_dwordx4 v16, s[4:7], s44 offen lds
s_add_u32 m0, s45, 1024
s_mov_b32 s44, 3276800
buffer_load_dwordx4 v16, s[4:7], s44 offen lds
s_add_u32 m0, s45, 2048
s_mov_b32 s44, 3407872
buffer_load_dwordx4 v16, s[4:7], s44 offen lds
s_add_u32 m0, s45, 3072
s_mov_b32 s44, 3538944
buffer_load_dwordx4 v16, s[4:7], s44 offen lds
s_add_u32 m0, s45, 4096
s_mov_b32 s44, 3670016
buffer_load_dwordx4 v16, s[4:7], s44 offen lds
s_add_u32 m0, s45, 5120
s_mov_b32 s44, 3801088
buffer_load_dwordx4 v16, s[4:7], s44 offen lds
s_add_u32 m0, s45, 6144
s_mov_b32 s44, 3932160
buffer_load_dwordx4 v16, s[4:7], s44 offen lds
s_add_u32 m0, s45, 7168
s_mov_b32 s44, 4063232
buffer_load_dwordx4 v16, s[4:7], s44 offen lds
ds_read_b128 v[20:23], v8 offset:0
ds_read_b128 v[24:27], v8 offset:2048
ds_read_b128 v[28:31], v9 offset:0
ds_read_b128 v[32:35], v9 offset:2048
ds_read_b128 v[36:39], v8 offset:4096
ds_read_b128 v[40:43], v8 offset:6144
ds_read_b128 v[44:47], v9 offset:4096
ds_read_b128 v[48:51], v9 offset:6144
s_waitcnt lgkmcnt(0)
v_mfma_f32_16x16x32_bf16 v[52:55], a[0:3], v[20:23], 0
v_mfma_f32_16x16x32_bf16 v[56:59], a[4:7], v[20:23], 0
v_mfma_f32_16x16x32_bf16 v[60:63], a[0:3], v[24:27], 0
v_mfma_f32_16x16x32_bf16 v[64:67], a[4:7], v[24:27], 0
v_mfma_f32_16x16x32_bf16 v[52:55], a[8:11], v[28:31], v[52:55]
v_mfma_f32_16x16x32_bf16 v[56:59], a[12:15], v[28:31], v[56:59]
v_mfma_f32_16x16x32_bf16 v[60:63], a[8:11], v[32:35], v[60:63]
v_mfma_f32_16x16x32_bf16 v[64:67], a[12:15], v[32:35], v[64:67]
v_mfma_f32_16x16x32_bf16 v[52:55], a[16:19], v[36:39], v[52:55]
v_mfma_f32_16x16x32_bf16 v[56:59], a[20:23], v[36:39], v[56:59]
v_mfma_f32_16x16x32_bf16 v[60:63], a[16:19], v[40:43], v[60:63]
v_mfma_f32_16x16x32_bf16 v[64:67], a[20:23], v[40:43], v[64:67]
v_mfma_f32_16x16x32_bf16 v[52:55], a[24:27], v[44:47], v[52:55]
v_mfma_f32_16x16x32_bf16 v[56:59], a[28:31], v[44:47], v[56:59]
v_mfma_f32_16x16x32_bf16 v[60:63], a[24:27], v[48:51], v[60:63]
v_mfma_f32_16x16x32_bf16 v[64:67], a[28:31], v[48:51], v[64:67]
s_waitcnt vmcnt(18)
ds_read_b64_tr_b16 a[32:33], v17 offset:8192
ds_read_b64_tr_b16 a[34:35], v17 offset:8448
ds_read_b64_tr_b16 a[36:37], v17 offset:8200
ds_read_b64_tr_b16 a[38:39], v17 offset:8456
ds_read_b64_tr_b16 a[40:41], v17 offset:10240
ds_read_b64_tr_b16 a[42:43], v17 offset:10496
ds_read_b64_tr_b16 a[44:45], v17 offset:10248
ds_read_b64_tr_b16 a[46:47], v17 offset:10504
s_waitcnt lgkmcnt(0)
ds_read_b64_tr_b16 a[48:49], v17 offset:12288
ds_read_b64_tr_b16 a[50:51], v17 offset:12544
ds_read_b64_tr_b16 a[52:53], v17 offset:12296
ds_read_b64_tr_b16 a[54:55], v17 offset:12552
ds_read_b64_tr_b16 a[56:57], v17 offset:14336
ds_read_b64_tr_b16 a[58:59], v17 offset:14592
ds_read_b64_tr_b16 a[60:61], v17 offset:14344
ds_read_b64_tr_b16 a[62:63], v17 offset:14600
s_waitcnt lgkmcnt(0)
s_mov_b32 s44, 4194304
buffer_load_dword v250, v12, s[4:7], s44 offen
s_add_u32 m0, s45, 8192
s_mov_b32 s44, 4194304
buffer_load_dwordx4 v16, s[4:7], s44 offen lds
s_add_u32 m0, s45, 9216
s_mov_b32 s44, 4325376
buffer_load_dwordx4 v16, s[4:7], s44 offen lds
s_add_u32 m0, s45, 10240
s_mov_b32 s44, 4456448
buffer_load_dwordx4 v16, s[4:7], s44 offen lds
s_add_u32 m0, s45, 11264
s_mov_b32 s44, 4587520
buffer_load_dwordx4 v16, s[4:7], s44 offen lds
s_add_u32 m0, s45, 12288
s_mov_b32 s44, 4718592
buffer_load_dwordx4 v16, s[4:7], s44 offen lds
s_add_u32 m0, s45, 13312
s_mov_b32 s44, 4849664
buffer_load_dwordx4 v16, s[4:7], s44 offen lds
s_add_u32 m0, s45, 14336
s_mov_b32 s44, 4980736
buffer_load_dwordx4 v16, s[4:7], s44 offen lds
s_add_u32 m0, s45, 15360
s_mov_b32 s44, 5111808
buffer_load_dwordx4 v16, s[4:7], s44 offen lds
ds_read_b128 v[20:23], v8 offset:8192
ds_read_b128 v[24:27], v8 offset:10240
ds_read_b128 v[28:31], v9 offset:8192
ds_read_b128 v[32:35], v9 offset:10240
ds_read_b128 v[36:39], v8 offset:12288
ds_read_b128 v[40:43], v8 offset:14336
ds_read_b128 v[44:47], v9 offset:12288
ds_read_b128 v[48:51], v9 offset:14336
s_waitcnt lgkmcnt(0)
v_mfma_f32_16x16x32_bf16 v[52:55], a[32:35], v[20:23], v[52:55]
v_mfma_f32_16x16x32_bf16 v[56:59], a[36:39], v[20:23], v[56:59]
v_mfma_f32_16x16x32_bf16 v[60:63], a[32:35], v[24:27], v[60:63]
v_mfma_f32_16x16x32_bf16 v[64:67], a[36:39], v[24:27], v[64:67]
v_mfma_f32_16x16x32_bf16 v[52:55], a[40:43], v[28:31], v[52:55]
v_mfma_f32_16x16x32_bf16 v[56:59], a[44:47], v[28:31], v[56:59]
v_mfma_f32_16x16x32_bf16 v[60:63], a[40:43], v[32:35], v[60:63]
v_mfma_f32_16x16x32_bf16 v[64:67], a[44:47], v[32:35], v[64:67]
v_mfma_f32_16x16x32_bf16 v[52:55], a[48:51], v[36:39], v[52:55]
v_mfma_f32_16x16x32_bf16 v[56:59], a[52:55], v[36:39], v[56:59]
v_mfma_f32_16x16x32_bf16 v[60:63], a[48:51], v[40:43], v[60:63]
v_mfma_f32_16x16x32_bf16 v[64:67], a[52:55], v[40:43], v[64:67]
v_mfma_f32_16x16x32_bf16 v[52:55], a[56:59], v[44:47], v[52:55]
v_mfma_f32_16x16x32_bf16 v[56:59], a[60:63], v[44:47], v[56:59]
v_mfma_f32_16x16x32_bf16 v[60:63], a[56:59], v[48:51], v[60:63]
v_mfma_f32_16x16x32_bf16 v[64:67], a[60:63], v[48:51], v[64:67]
s_waitcnt vmcnt(18)
ds_read_b64_tr_b16 a[64:65], v17 offset:16384
ds_read_b64_tr_b16 a[66:67], v17 offset:16640
ds_read_b64_tr_b16 a[68:69], v17 offset:16392
ds_read_b64_tr_b16 a[70:71], v17 offset:16648
ds_read_b64_tr_b16 a[72:73], v17 offset:18432
ds_read_b64_tr_b16 a[74:75], v17 offset:18688
ds_read_b64_tr_b16 a[76:77], v17 offset:18440
ds_read_b64_tr_b16 a[78:79], v17 offset:18696
s_waitcnt lgkmcnt(0)
ds_read_b64_tr_b16 a[80:81], v17 offset:20480
ds_read_b64_tr_b16 a[82:83], v17 offset:20736
ds_read_b64_tr_b16 a[84:85], v17 offset:20488
ds_read_b64_tr_b16 a[86:87], v17 offset:20744
ds_read_b64_tr_b16 a[88:89], v17 offset:22528
ds_read_b64_tr_b16 a[90:91], v17 offset:22784
ds_read_b64_tr_b16 a[92:93], v17 offset:22536
ds_read_b64_tr_b16 a[94:95], v17 offset:22792
s_waitcnt lgkmcnt(0)
s_mov_b32 s44, 5242880
buffer_load_dword v250, v12, s[4:7], s44 offen
s_add_u32 m0, s45, 16384
s_mov_b32 s44, 5242880
buffer_load_dwordx4 v16, s[4:7], s44 offen lds
s_add_u32 m0, s45, 17408
s_mov_b32 s44, 5373952
buffer_load_dwordx4 v16, s[4:7], s44 offen lds
s_add_u32 m0, s45, 18432
s_mov_b32 s44, 5505024
buffer_load_dwordx4 v16, s[4:7], s44 offen lds
s_add_u32 m0, s45, 19456
s_mov_b32 s44, 5636096
buffer_load_dwordx4 v16, s[4:7], s44 offen lds
s_add_u32 m0, s45, 20480
s_mov_b32 s44, 5767168
buffer_load_dwordx4 v16, s[4:7], s44 offen lds
s_add_u32 m0, s45, 21504
s_mov_b32 s44, 5898240
buffer_load_dwordx4 v16, s[4:7], s44 offen lds
s_add_u32 m0, s45, 22528
s_mov_b32 s44, 6029312
buffer_load_dwordx4 v16, s[4:7], s44 offen lds
s_add_u32 m0, s45, 23552
s_mov_b32 s44, 6160384
buffer_load_dwordx4 v16, s[4:7], s44 offen lds
ds_read_b128 v[20:23], v8 offset:16384
ds_read_b128 v[24:27], v8 offset:18432
ds_read_b128 v[28:31], v9 offset:16384
ds_read_b128 v[32:35], v9 offset:18432
ds_read_b128 v[36:39], v8 offset:20480
ds_read_b128 v[40:43], v8 offset:22528
ds_read_b128 v[44:47], v9 offset:20480
ds_read_b128 v[48:51], v9 offset:22528
s_waitcnt lgkmcnt(0)
v_mfma_f32_16x16x32_bf16 v[52:55], a[64:67], v[20:23], v[52:55]
v_mfma_f32_16x16x32_bf16 v[56:59], a[68:71], v[20:23], v[56:59]
v_mfma_f32_16x16x32_bf16 v[60:63], a[64:67], v[24:27], v[60:63]
v_mfma_f32_16x16x32_bf16 v[64:67], a[68:71], v[24:27], v[64:67]
v_mfma_f32_16x16x32_bf16 v[52:55], a[72:75], v[28:31], v[52:55]
v_mfma_f32_16x16x32_bf16 v[56:59], a[76:79], v[28:31], v[56:59]
v_mfma_f32_16x16x32_bf16 v[60:63], a[72:75], v[32:35], v[60:63]
v_mfma_f32_16x16x32_bf16 v[64:67], a[76:79], v[32:35], v[64:67]
v_mfma_f32_16x16x32_bf16 v[52:55], a[80:83], v[36:39], v[52:55]
v_mfma_f32_16x16x32_bf16 v[56:59], a[84:87], v[36:39], v[56:59]
v_mfma_f32_16x16x32_bf16 v[60:63], a[80:83], v[40:43], v[60:63]
v_mfma_f32_16x16x32_bf16 v[64:67], a[84:87], v[40:43], v[64:67]
v_mfma_f32_16x16x32_bf16 v[52:55], a[88:91], v[44:47], v[52:55]
v_mfma_f32_16x16x32_bf16 v[56:59], a[92:95], v[44:47], v[56:59]
v_mfma_f32_16x16x32_bf16 v[60:63], a[88:91], v[48:51], v[60:63]
v_mfma_f32_16x16x32_bf16 v[64:67], a[92:95], v[48:51], v[64:67]
s_waitcnt vmcnt(18)
ds_read_b64_tr_b16 a[96:97], v17 offset:0
ds_read_b64_tr_b16 a[98:99], v17 offset:256
ds_read_b64_tr_b16 a[100:101], v17 offset:8
ds_read_b64_tr_b16 a[102:103], v17 offset:264
ds_read_b64_tr_b16 a[104:105], v17 offset:2048
ds_read_b64_tr_b16 a[106:107], v17 offset:2304
ds_read_b64_tr_b16 a[108:109], v17 offset:2056
ds_read_b64_tr_b16 a[110:111], v17 offset:2312
s_waitcnt lgkmcnt(0)
ds_read_b64_tr_b16 a[112:113], v17 offset:4096
ds_read_b64_tr_b16 a[114:115], v17 offset:4352
ds_read_b64_tr_b16 a[116:117], v17 offset:4104
ds_read_b64_tr_b16 a[118:119], v17 offset:4360
ds_read_b64_tr_b16 a[120:121], v17 offset:6144
ds_read_b64_tr_b16 a[122:123], v17 offset:6400
ds_read_b64_tr_b16 a[124:125], v17 offset:6152
ds_read_b64_tr_b16 a[126:127], v17 offset:6408
s_waitcnt lgkmcnt(0)
s_mov_b32 s44, 6291456
buffer_load_dword v250, v12, s[4:7], s44 offen
s_add_u32 m0, s45, 0
s_mov_b32 s44, 6291456
buffer_load_dwordx4 v16, s[4:7], s44 offen lds
s_add_u32 m0, s45, 1024
s_mov_b32 s44, 6422528
buffer_load_dwordx4 v16, s[4:7], s44 offen lds
s_add_u32 m0, s45, 2048
s_mov_b32 s44, 6553600
buffer_load_dwordx4 v16, s[4:7], s44 offen lds
s_add_u32 m0, s45, 3072
s_mov_b32 s44, 6684672
buffer_load_dwordx4 v16, s[4:7], s44 offen lds
s_add_u32 m0, s45, 4096
s_mov_b32 s44, 6815744
buffer_load_dwordx4 v16, s[4:7], s44 offen lds
s_add_u32 m0, s45, 5120
s_mov_b32 s44, 6946816
buffer_load_dwordx4 v16, s[4:7], s44 offen lds
s_add_u32 m0, s45, 6144
s_mov_b32 s44, 7077888
buffer_load_dwordx4 v16, s[4:7], s44 offen lds
s_add_u32 m0, s45, 7168
s_mov_b32 s44, 7208960
buffer_load_dwordx4 v16, s[4:7], s44 offen lds
ds_read_b128 v[20:23], v8 offset:24576
ds_read_b128 v[24:27], v8 offset:26624
ds_read_b128 v[28:31], v9 offset:24576
ds_read_b128 v[32:35], v9 offset:26624
ds_read_b128 v[36:39], v8 offset:28672
ds_read_b128 v[40:43], v8 offset:30720
ds_read_b128 v[44:47], v9 offset:28672
ds_read_b128 v[48:51], v9 offset:30720
s_waitcnt lgkmcnt(0)
v_mfma_f32_16x16x32_bf16 v[52:55], a[96:99], v[20:23], v[52:55]
v_mfma_f32_16x16x32_bf16 v[56:59], a[100:103], v[20:23], v[56:59]
v_mfma_f32_16x16x32_bf16 v[60:63], a[96:99], v[24:27], v[60:63]
v_mfma_f32_16x16x32_bf16 v[64:67], a[100:103], v[24:27], v[64:67]
v_mfma_f32_16x16x32_bf16 v[52:55], a[104:107], v[28:31], v[52:55]
v_mfma_f32_16x16x32_bf16 v[56:59], a[108:111], v[28:31], v[56:59]
v_mfma_f32_16x16x32_bf16 v[60:63], a[104:107], v[32:35], v[60:63]
v_mfma_f32_16x16x32_bf16 v[64:67], a[108:111], v[32:35], v[64:67]
v_mfma_f32_16x16x32_bf16 v[52:55], a[112:115], v[36:39], v[52:55]
v_mfma_f32_16x16x32_bf16 v[56:59], a[116:119], v[36:39], v[56:59]
v_mfma_f32_16x16x32_bf16 v[60:63], a[112:115], v[40:43], v[60:63]
v_mfma_f32_16x16x32_bf16 v[64:67], a[116:119], v[40:43], v[64:67]
v_mfma_f32_16x16x32_bf16 v[52:55], a[120:123], v[44:47], v[52:55]
v_mfma_f32_16x16x32_bf16 v[56:59], a[124:127], v[44:47], v[56:59]
v_mfma_f32_16x16x32_bf16 v[60:63], a[120:123], v[48:51], v[60:63]
v_mfma_f32_16x16x32_bf16 v[64:67], a[124:127], v[48:51], v[64:67]
s_waitcnt vmcnt(18)
ds_read_b64_tr_b16 a[128:129], v17 offset:8192
ds_read_b64_tr_b16 a[130:131], v17 offset:8448
ds_read_b64_tr_b16 a[132:133], v17 offset:8200
ds_read_b64_tr_b16 a[134:135], v17 offset:8456
ds_read_b64_tr_b16 a[136:137], v17 offset:10240
ds_read_b64_tr_b16 a[138:139], v17 offset:10496
ds_read_b64_tr_b16 a[140:141], v17 offset:10248
ds_read_b64_tr_b16 a[142:143], v17 offset:10504
s_waitcnt lgkmcnt(0)
ds_read_b64_tr_b16 a[144:145], v17 offset:12288
ds_read_b64_tr_b16 a[146:147], v17 offset:12544
ds_read_b64_tr_b16 a[148:149], v17 offset:12296
ds_read_b64_tr_b16 a[150:151], v17 offset:12552
ds_read_b64_tr_b16 a[152:153], v17 offset:14336
ds_read_b64_tr_b16 a[154:155], v17 offset:14592
ds_read_b64_tr_b16 a[156:157], v17 offset:14344
ds_read_b64_tr_b16 a[158:159], v17 offset:14600
s_waitcnt lgkmcnt(0)
s_mov_b32 s44, 7340032
buffer_load_dword v250, v12, s[4:7], s44 offen
s_add_u32 m0, s45, 8192
s_mov_b32 s44, 7340032
buffer_load_dwordx4 v16, s[4:7], s44 offen lds
s_add_u32 m0, s45, 9216
s_mov_b32 s44, 7471104
buffer_load_dwordx4 v16, s[4:7], s44 offen lds
s_add_u32 m0, s45, 10240
s_mov_b32 s44, 7602176
buffer_load_dwordx4 v16, s[4:7], s44 offen lds
s_add_u32 m0, s45, 11264
s_mov_b32 s44, 7733248
buffer_load_dwordx4 v16, s[4:7], s44 offen lds
s_add_u32 m0, s45, 12288
s_mov_b32 s44, 7864320
buffer_load_dwordx4 v16, s[4:7], s44 offen lds
s_add_u32 m0, s45, 13312
s_mov_b32 s44, 7995392
buffer_load_dwordx4 v16, s[4:7], s44 offen lds
s_add_u32 m0, s45, 14336
s_mov_b32 s44, 8126464
buffer_load_dwordx4 v16, s[4:7], s44 offen lds
s_add_u32 m0, s45, 15360
s_mov_b32 s44, 8257536
buffer_load_dwordx4 v16, s[4:7], s44 offen lds
ds_read_b128 v[20:23], v8 offset:32768
ds_read_b128 v[24:27], v8 offset:34816
ds_read_b128 v[28:31], v9 offset:32768
ds_read_b128 v[32:35], v9 offset:34816
ds_read_b128 v[36:39], v8 offset:36864
ds_read_b128 v[40:43], v8 offset:38912
ds_read_b128 v[44:47], v9 offset:36864
ds_read_b128 v[48:51], v9 offset:38912
s_waitcnt lgkmcnt(0)
v_mfma_f32_16x16x32_bf16 v[52:55], a[128:131], v[20:23], v[52:55]
v_mfma_f32_16x16x32_bf16 v[56:59], a[132:135], v[20:23], v[56:59]
v_mfma_f32_16x16x32_bf16 v[60:63], a[128:131], v[24:27], v[60:63]
v_mfma_f32_16x16x32_bf16 v[64:67], a[132:135], v[24:27], v[64:67]
v_mfma_f32_16x16x32_bf16 v[52:55], a[136:139], v[28:31], v[52:55]
v_mfma_f32_16x16x32_bf16 v[56:59], a[140:143], v[28:31], v[56:59]
v_mfma_f32_16x16x32_bf16 v[60:63], a[136:139], v[32:35], v[60:63]
v_mfma_f32_16x16x32_bf16 v[64:67], a[140:143], v[32:35], v[64:67]
v_mfma_f32_16x16x32_bf16 v[52:55], a[144:147], v[36:39], v[52:55]
v_mfma_f32_16x16x32_bf16 v[56:59], a[148:151], v[36:39], v[56:59]
v_mfma_f32_16x16x32_bf16 v[60:63], a[144:147], v[40:43], v[60:63]
v_mfma_f32_16x16x32_bf16 v[64:67], a[148:151], v[40:43], v[64:67]
v_mfma_f32_16x16x32_bf16 v[52:55], a[152:155], v[44:47], v[52:55]
v_mfma_f32_16x16x32_bf16 v[56:59], a[156:159], v[44:47], v[56:59]
v_mfma_f32_16x16x32_bf16 v[60:63], a[152:155], v[48:51], v[60:63]
v_mfma_f32_16x16x32_bf16 v[64:67], a[156:159], v[48:51], v[64:67]
s_waitcnt vmcnt(18)
ds_read_b64_tr_b16 a[160:161], v17 offset:16384
ds_read_b64_tr_b16 a[162:163], v17 offset:16640
ds_read_b64_tr_b16 a[164:165], v17 offset:16392
ds_read_b64_tr_b16 a[166:167], v17 offset:16648
ds_read_b64_tr_b16 a[168:169], v17 offset:18432
ds_read_b64_tr_b16 a[170:171], v17 offset:18688
ds_read_b64_tr_b16 a[172:173], v17 offset:18440
ds_read_b64_tr_b16 a[174:175], v17 offset:18696
s_waitcnt lgkmcnt(0)
ds_read_b64_tr_b16 a[176:177], v17 offset:20480
ds_read_b64_tr_b16 a[178:179], v17 offset:20736
ds_read_b64_tr_b16 a[180:181], v17 offset:20488
ds_read_b64_tr_b16 a[182:183], v17 offset:20744
ds_read_b64_tr_b16 a[184:185], v17 offset:22528
ds_read_b64_tr_b16 a[186:187], v17 offset:22784
ds_read_b64_tr_b16 a[188:189], v17 offset:22536
ds_read_b64_tr_b16 a[190:191], v17 offset:22792
s_waitcnt lgkmcnt(0)
ds_read_b128 v[20:23], v8 offset:40960
ds_read_b128 v[24:27], v8 offset:43008
ds_read_b128 v[28:31], v9 offset:40960
ds_read_b128 v[32:35], v9 offset:43008
ds_read_b128 v[36:39], v8 offset:45056
ds_read_b128 v[40:43], v8 offset:47104
ds_read_b128 v[44:47], v9 offset:45056
ds_read_b128 v[48:51], v9 offset:47104
s_waitcnt lgkmcnt(0)
v_mfma_f32_16x16x32_bf16 v[52:55], a[160:163], v[20:23], v[52:55]
v_mfma_f32_16x16x32_bf16 v[56:59], a[164:167], v[20:23], v[56:59]
v_mfma_f32_16x16x32_bf16 v[60:63], a[160:163], v[24:27], v[60:63]
v_mfma_f32_16x16x32_bf16 v[64:67], a[164:167], v[24:27], v[64:67]
v_mfma_f32_16x16x32_bf16 v[52:55], a[168:171], v[28:31], v[52:55]
v_mfma_f32_16x16x32_bf16 v[56:59], a[172:175], v[28:31], v[56:59]
v_mfma_f32_16x16x32_bf16 v[60:63], a[168:171], v[32:35], v[60:63]
v_mfma_f32_16x16x32_bf16 v[64:67], a[172:175], v[32:35], v[64:67]
v_mfma_f32_16x16x32_bf16 v[52:55], a[176:179], v[36:39], v[52:55]
v_mfma_f32_16x16x32_bf16 v[56:59], a[180:183], v[36:39], v[56:59]
v_mfma_f32_16x16x32_bf16 v[60:63], a[176:179], v[40:43], v[60:63]
v_mfma_f32_16x16x32_bf16 v[64:67], a[180:183], v[40:43], v[64:67]
v_mfma_f32_16x16x32_bf16 v[52:55], a[184:187], v[44:47], v[52:55]
v_mfma_f32_16x16x32_bf16 v[56:59], a[188:191], v[44:47], v[56:59]
v_mfma_f32_16x16x32_bf16 v[60:63], a[184:187], v[48:51], v[60:63]
v_mfma_f32_16x16x32_bf16 v[64:67], a[188:191], v[48:51], v[64:67]
s_waitcnt vmcnt(9)
ds_read_b64_tr_b16 a[192:193], v17 offset:0
ds_read_b64_tr_b16 a[194:195], v17 offset:256
ds_read_b64_tr_b16 a[196:197], v17 offset:8
ds_read_b64_tr_b16 a[198:199], v17 offset:264
ds_read_b64_tr_b16 a[200:201], v17 offset:2048
ds_read_b64_tr_b16 a[202:203], v17 offset:2304
ds_read_b64_tr_b16 a[204:205], v17 offset:2056
ds_read_b64_tr_b16 a[206:207], v17 offset:2312
s_waitcnt lgkmcnt(0)
ds_read_b64_tr_b16 a[208:209], v17 offset:4096
ds_read_b64_tr_b16 a[210:211], v17 offset:4352
ds_read_b64_tr_b16 a[212:213], v17 offset:4104
ds_read_b64_tr_b16 a[214:215], v17 offset:4360
ds_read_b64_tr_b16 a[216:217], v17 offset:6144
ds_read_b64_tr_b16 a[218:219], v17 offset:6400
ds_read_b64_tr_b16 a[220:221], v17 offset:6152
ds_read_b64_tr_b16 a[222:223], v17 offset:6408
s_waitcnt lgkmcnt(0)
ds_read_b128 v[20:23], v8 offset:49152
ds_read_b128 v[24:27], v8 offset:51200
ds_read_b128 v[28:31], v9 offset:49152
ds_read_b128 v[32:35], v9 offset:51200
ds_read_b128 v[36:39], v8 offset:53248
ds_read_b128 v[40:43], v8 offset:55296
ds_read_b128 v[44:47], v9 offset:53248
ds_read_b128 v[48:51], v9 offset:55296
s_waitcnt lgkmcnt(0)
v_mfma_f32_16x16x32_bf16 v[52:55], a[192:195], v[20:23], v[52:55]
v_mfma_f32_16x16x32_bf16 v[56:59], a[196:199], v[20:23], v[56:59]
v_mfma_f32_16x16x32_bf16 v[60:63], a[192:195], v[24:27], v[60:63]
v_mfma_f32_16x16x32_bf16 v[64:67], a[196:199], v[24:27], v[64:67]
v_mfma_f32_16x16x32_bf16 v[52:55], a[200:203], v[28:31], v[52:55]
v_mfma_f32_16x16x32_bf16 v[56:59], a[204:207], v[28:31], v[56:59]
v_mfma_f32_16x16x32_bf16 v[60:63], a[200:203], v[32:35], v[60:63]
v_mfma_f32_16x16x32_bf16 v[64:67], a[204:207], v[32:35], v[64:67]
v_mfma_f32_16x16x32_bf16 v[52:55], a[208:211], v[36:39], v[52:55]
v_mfma_f32_16x16x32_bf16 v[56:59], a[212:215], v[36:39], v[56:59]
v_mfma_f32_16x16x32_bf16 v[60:63], a[208:211], v[40:43], v[60:63]
v_mfma_f32_16x16x32_bf16 v[64:67], a[212:215], v[40:43], v[64:67]
v_mfma_f32_16x16x32_bf16 v[52:55], a[216:219], v[44:47], v[52:55]
v_mfma_f32_16x16x32_bf16 v[56:59], a[220:223], v[44:47], v[56:59]
v_mfma_f32_16x16x32_bf16 v[60:63], a[216:219], v[48:51], v[60:63]
v_mfma_f32_16x16x32_bf16 v[64:67], a[220:223], v[48:51], v[64:67]
s_waitcnt vmcnt(0)
ds_read_b64_tr_b16 a[224:225], v17 offset:8192
ds_read_b64_tr_b16 a[226:227], v17 offset:8448
ds_read_b64_tr_b16 a[228:229], v17 offset:8200
ds_read_b64_tr_b16 a[230:231], v17 offset:8456
ds_read_b64_tr_b16 a[232:233], v17 offset:10240
ds_read_b64_tr_b16 a[234:235], v17 offset:10496
ds_read_b64_tr_b16 a[236:237], v17 offset:10248
ds_read_b64_tr_b16 a[238:239], v17 offset:10504
s_waitcnt lgkmcnt(0)
ds_read_b64_tr_b16 a[240:241], v17 offset:12288
ds_read_b64_tr_b16 a[242:243], v17 offset:12544
ds_read_b64_tr_b16 a[244:245], v17 offset:12296
ds_read_b64_tr_b16 a[246:247], v17 offset:12552
ds_read_b64_tr_b16 a[248:249], v17 offset:14336
ds_read_b64_tr_b16 a[250:251], v17 offset:14592
ds_read_b64_tr_b16 a[252:253], v17 offset:14344
ds_read_b64_tr_b16 a[254:255], v17 offset:14600
s_waitcnt lgkmcnt(0)
ds_read_b128 v[20:23], v8 offset:57344
ds_read_b128 v[24:27], v8 offset:59392
ds_read_b128 v[28:31], v9 offset:57344
ds_read_b128 v[32:35], v9 offset:59392
ds_read_b128 v[36:39], v8 offset:61440
ds_read_b128 v[40:43], v8 offset:63488
ds_read_b128 v[44:47], v9 offset:61440
ds_read_b128 v[48:51], v9 offset:63488
s_waitcnt lgkmcnt(0)
v_mfma_f32_16x16x32_bf16 v[52:55], a[224:227], v[20:23], v[52:55]
v_mfma_f32_16x16x32_bf16 v[56:59], a[228:231], v[20:23], v[56:59]
v_mfma_f32_16x16x32_bf16 v[60:63], a[224:227], v[24:27], v[60:63]
v_mfma_f32_16x16x32_bf16 v[64:67], a[228:231], v[24:27], v[64:67]
v_mfma_f32_16x16x32_bf16 v[52:55], a[232:235], v[28:31], v[52:55]
v_mfma_f32_16x16x32_bf16 v[56:59], a[236:239], v[28:31], v[56:59]
v_mfma_f32_16x16x32_bf16 v[60:63], a[232:235], v[32:35], v[60:63]
v_mfma_f32_16x16x32_bf16 v[64:67], a[236:239], v[32:35], v[64:67]
v_mfma_f32_16x16x32_bf16 v[52:55], a[240:243], v[36:39], v[52:55]
v_mfma_f32_16x16x32_bf16 v[56:59], a[244:247], v[36:39], v[56:59]
v_mfma_f32_16x16x32_bf16 v[60:63], a[240:243], v[40:43], v[60:63]
v_mfma_f32_16x16x32_bf16 v[64:67], a[244:247], v[40:43], v[64:67]
v_mfma_f32_16x16x32_bf16 v[52:55], a[248:251], v[44:47], v[52:55]
v_mfma_f32_16x16x32_bf16 v[56:59], a[252:255], v[44:47], v[56:59]
v_mfma_f32_16x16x32_bf16 v[60:63], a[248:251], v[48:51], v[60:63]
v_mfma_f32_16x16x32_bf16 v[64:67], a[252:255], v[48:51], v[64:67]
s_barrier
s_mov_b32 s50, 0x10000
s_add_u32 m0, s46, 65536
s_nop 0
buffer_load_dwordx4 v6, s[8:11], s50 offen offset:0 lds
s_add_u32 m0, s46, 69504
s_nop 0
buffer_load_dwordx4 v6, s[8:11], s50 offen offset:128 lds
s_add_u32 m0, s46, 73472
s_nop 0
buffer_load_dwordx4 v6, s[8:11], s50 offen offset:256 lds
s_add_u32 m0, s46, 77440
s_nop 0
buffer_load_dwordx4 v6, s[8:11], s50 offen offset:384 lds
s_add_u32 m0, s46, 81408
s_nop 0
buffer_load_dwordx4 v6, s[8:11], s50 offen offset:512 lds
s_add_u32 m0, s46, 85376
s_nop 0
buffer_load_dwordx4 v6, s[8:11], s50 offen offset:640 lds
s_add_u32 m0, s46, 89344
s_nop 0
buffer_load_dwordx4 v6, s[8:11], s50 offen offset:768 lds
s_add_u32 m0, s46, 93312
s_nop 0
buffer_load_dwordx4 v6, s[8:11], s50 offen offset:896 lds
s_add_u32 m0, s46, 97280
s_nop 0
buffer_load_dwordx4 v6, s[8:11], s50 offen offset:1024 lds
s_add_u32 m0, s46, 101248
s_nop 0
buffer_load_dwordx4 v6, s[8:11], s50 offen offset:1152 lds
s_add_u32 m0, s46, 105216
s_nop 0
buffer_load_dwordx4 v6, s[8:11], s50 offen offset:1280 lds
s_add_u32 m0, s46, 109184
s_nop 0
buffer_load_dwordx4 v6, s[8:11], s50 offen offset:1408 lds
s_add_u32 m0, s46, 113152
s_nop 0
buffer_load_dwordx4 v6, s[8:11], s50 offen offset:1536 lds
s_add_u32 m0, s46, 117120
s_nop 0
buffer_load_dwordx4 v6, s[8:11], s50 offen offset:1664 lds
s_add_u32 m0, s46, 121088
s_nop 0
buffer_load_dwordx4 v6, s[8:11], s50 offen offset:1792 lds
s_add_u32 m0, s46, 125056
s_nop 0
buffer_load_dwordx4 v6, s[8:11], s50 offen offset:1920 lds
s_and_b32 s53, s47, 31
s_lshl_b32 s53, s53, 4
v_add_u32 v19, s53, v1
v_lshlrev_b32 v19, 7, v19
s_mov_b32 s42, 1
v_and_b32 v3, 15, v0
v_lshlrev_b32 v3, 4, v3
s_branch mega_kernel_syk
mega_kernel_sykw:
s_sleep 4
mega_kernel_syk:
buffer_load_dword v2, v3, s[72:75], 0 offen sc1
s_waitcnt vmcnt(0)
mega_kernel_sykp:
s_cmp_eq_u32 s95, 1
s_cbranch_scc0 mega_kernel_sykf
v_readlane_b32 s76, v2, 14
s_mov_b32 s98, 0
s_cmp_eq_u32 s76, 32
s_cbranch_scc0 mega_kernel_sykw
s_branch mega_kernel_sykd
mega_kernel_sykf:
s_mov_b32 s77, 0
s_mov_b32 s78, 0
v_readlane_b32 s76, v2, 0
s_add_u32 s77, s77, s76
s_xor_b32 s76, s76, 32
s_or_b32 s78, s78, s76
v_readlane_b32 s76, v2, 1
s_add_u32 s77, s77, s76
s_xor_b32 s76, s76, 32
s_or_b32 s78, s78, s76
v_readlane_b32 s76, v2, 2
s_add_u32 s77, s77, s76
s_xor_b32 s76, s76, 32
s_or_b32 s78, s78, s76
v_readlane_b32 s76, v2, 3
s_add_u32 s77, s77, s76
s_xor_b32 s76, s76, 32
s_or_b32 s78, s78, s76
v_readlane_b32 s76, v2, 4
s_add_u32 s77, s77, s76
s_xor_b32 s76, s76, 32
s_or_b32 s78, s78, s76
v_readlane_b32 s76, v2, 5
s_add_u32 s77, s77, s76
s_xor_b32 s76, s76, 32
s_or_b32 s78, s78, s76
v_readlane_b32 s76, v2, 6
s_add_u32 s77, s77, s76
s_xor_b32 s76, s76, 32
s_or_b32 s78, s78, s76
v_readlane_b32 s76, v2, 7
s_add_u32 s77, s77, s76
s_xor_b32 s76, s76, 32
s_or_b32 s78, s78, s76
s_cmp_eq_u32 s77, 256
s_cbranch_scc0 mega_kernel_sykw
v_mov_b32 v252, v2
s_cmp_eq_u32 s78, 0
s_cbranch_scc0 mega_kernel_slowent
v_readlane_b32 s76, v2, 10
v_readlane_b32 s77, v2, 8
s_cmp_eq_u32 s76, 32
s_cbranch_scc0 mega_kernel_sykw
s_cmp_gt_u32 s77, 16
s_cselect_b32 s98, 1, 0
mega_kernel_sykd:
s_lshr_b32 s44, s47, 3
s_xor_b32 s44, s44, s98
s_and_b32 s44, s44, 1
s_lshl_b32 s44, s44, 13
s_lshl_b32 s48, s47, 18
s_add_u32 s48, s48, s44
s_add_u32 s48, s48, 0
s_xor_b32 s44, s98, 1
s_lshl_b32 s44, s44, 13
s_lshl_b32 s49, s40, 7
s_add_u32 s49, s49, s44
s_lshl_b32 s44, s41, 2
s_add_u32 s49, s49, s44
s_add_u32 s49, s49, 69206016
v_mov_b32 v16, 0
v_cvt_pk_bf16_f32 v84, v52, v53
v_cvt_pk_bf16_f32 v85, v54, v55
v_cvt_pk_bf16_f32 v86, v56, v57
v_cvt_pk_bf16_f32 v87, v58, v59
v_cvt_pk_bf16_f32 v88, v60, v61
v_cvt_pk_bf16_f32 v89, v62, v63
v_cvt_pk_bf16_f32 v90, v64, v65
v_cvt_pk_bf16_f32 v91, v66, v67
s_add_u32 s51, s42, s47
s_sub_u32 s51, s51, 1
s_bfe_u32 s52, s51, 0x40002
s_lshl_b32 s52, s52, 14
s_and_b32 s51, s51, 3
s_lshl_b32 s51, s51, 11
s_add_u32 s51, s51, s52
s_add_u32 s51, s51, s48
buffer_store_dwordx4 v[84:87], v7, s[84:87], s51 offen sc1
buffer_store_dwordx4 v[88:91], v7, s[84:87], s51 offen offset:1024 sc1
s_waitcnt vmcnt(0)
v_mov_b32 v17, s42
s_mov_b64 exec, 1
buffer_store_dword v17, v16, s[84:87], s49 offen sc1
s_mov_b64 exec, -1
mega_kernel_k_loop:
s_waitcnt vmcnt(2)
s_barrier
s_add_u32 s50, s42, 1
s_min_u32 s50, s50, 63
s_lshl_b32 s50, s50, 16
ds_read_b128 v[20:23], v10 offset:0
ds_read_b128 v[24:27], v10 offset:2048
ds_read_b128 v[28:31], v11 offset:0
ds_read_b128 v[32:35], v11 offset:2048
ds_read_b128 v[36:39], v10 offset:4096
ds_read_b128 v[40:43], v10 offset:6144
s_waitcnt lgkmcnt(4)
v_mfma_f32_16x16x32_bf16 v[68:71], a[0:3], v[20:23], 0
ds_read_b128 v[44:47], v11 offset:4096
v_mfma_f32_16x16x32_bf16 v[72:75], a[4:7], v[20:23], 0
v_cvt_pk_bf16_f32 v84, v52, v53
v_cvt_pk_bf16_f32 v85, v54, v55
v_cvt_pk_bf16_f32 v86, v56, v57
v_mfma_f32_16x16x32_bf16 v[76:79], a[0:3], v[24:27], 0
ds_read_b128 v[48:51], v11 offset:6144
v_mfma_f32_16x16x32_bf16 v[80:83], a[4:7], v[24:27], 0
v_cvt_pk_bf16_f32 v87, v58, v59
v_cvt_pk_bf16_f32 v88, v60, v61
v_cvt_pk_bf16_f32 v89, v62, v63
s_waitcnt lgkmcnt(4)
v_mfma_f32_16x16x32_bf16 v[68:71], a[8:11], v[28:31], v[68:71]
ds_read_b128 v[20:23], v10 offset:8192
v_mfma_f32_16x16x32_bf16 v[72:75], a[12:15], v[28:31], v[72:75]
v_cvt_pk_bf16_f32 v90, v64, v65
v_cvt_pk_bf16_f32 v91, v66, v67
v_mfma_f32_16x16x32_bf16 v[76:79], a[8:11], v[32:35], v[76:79]
ds_read_b128 v[24:27], v10 offset:10240
v_mfma_f32_16x16x32_bf16 v[80:83], a[12:15], v[32:35], v[80:83]
s_add_u32 s51, s42, s47
s_sub_u32 s51, s51, 1
s_bfe_u32 s52, s51, 0x40002
s_lshl_b32 s52, s52, 14
s_waitcnt lgkmcnt(4)
v_mfma_f32_16x16x32_bf16 v[68:71], a[16:19], v[36:39], v[68:71]
ds_read_b128 v[28:31], v11 offset:8192
v_mfma_f32_16x16x32_bf16 v[72:75], a[20:23], v[36:39], v[72:75]
s_and_b32 s51, s51, 3
s_lshl_b32 s51, s51, 11
s_add_u32 s51, s51, s52
s_add_u32 s51, s51, s48
buffer_store_dwordx4 v[84:87], v7, s[84:87], s51 offen sc1
v_mfma_f32_16x16x32_bf16 v[76:79], a[16:19], v[40:43], v[76:79]
ds_read_b128 v[32:35], v11 offset:10240
v_mfma_f32_16x16x32_bf16 v[80:83], a[20:23], v[40:43], v[80:83]
buffer_store_dwordx4 v[88:91], v7, s[84:87], s51 offen offset:1024 sc1
s_waitcnt lgkmcnt(4)
v_mfma_f32_16x16x32_bf16 v[68:71], a[24:27], v[44:47], v[68:71]
ds_read_b128 v[36:39], v10 offset:12288
v_mfma_f32_16x16x32_bf16 v[72:75], a[28:31], v[44:47], v[72:75]
s_add_u32 m0, s46, 0
v_mfma_f32_16x16x32_bf16 v[76:79], a[24:27], v[48:51], v[76:79]
ds_read_b128 v[40:43], v10 offset:14336
v_mfma_f32_16x16x32_bf16 v[80:83], a[28:31], v[48:51], v[80:83]
buffer_load_dwordx4 v6, s[8:11], s50 offen offset:0 lds
s_waitcnt lgkmcnt(4)
v_mfma_f32_16x16x32_bf16 v[68:71], a[32:35], v[20:23], v[68:71]
ds_read_b128 v[44:47], v11 offset:12288
v_mfma_f32_16x16x32_bf16 v[72:75], a[36:39], v[20:23], v[72:75]
s_add_u32 m0, s46, 3968
v_mfma_f32_16x16x32_bf16 v[76:79], a[32:35], v[24:27], v[76:79]
ds_read_b128 v[48:51], v11 offset:14336
v_mfma_f32_16x16x32_bf16 v[80:83], a[36:39], v[24:27], v[80:83]
buffer_load_dwordx4 v6, s[8:11], s50 offen offset:128 lds
s_waitcnt lgkmcnt(4)
v_mfma_f32_16x16x32_bf16 v[68:71], a[40:43], v[28:31], v[68:71]
ds_read_b128 v[20:23], v10 offset:16384
v_mfma_f32_16x16x32_bf16 v[72:75], a[44:47], v[28:31], v[72:75]
s_add_u32 m0, s46, 7936
v_mfma_f32_16x16x32_bf16 v[76:79], a[40:43], v[32:35], v[76:79]
ds_read_b128 v[24:27], v10 offset:18432
v_mfma_f32_16x16x32_bf16 v[80:83], a[44:47], v[32:35], v[80:83]
buffer_load_dwordx4 v6, s[8:11], s50 offen offset:256 lds
s_waitcnt lgkmcnt(4)
v_mfma_f32_16x16x32_bf16 v[68:71], a[48:51], v[36:39], v[68:71]
ds_read_b128 v[28:31], v11 offset:16384
v_mfma_f32_16x16x32_bf16 v[72:75], a[52:55], v[36:39], v[72:75]
s_add_u32 m0, s46, 11904
v_mfma_f32_16x16x32_bf16 v[76:79], a[48:51], v[40:43], v[76:79]
ds_read_b128 v[32:35], v11 offset:18432
v_mfma_f32_16x16x32_bf16 v[80:83], a[52:55], v[40:43], v[80:83]
buffer_load_dwordx4 v6, s[8:11], s50 offen offset:384 lds
s_waitcnt lgkmcnt(4)
v_mfma_f32_16x16x32_bf16 v[68:71], a[56:59], v[44:47], v[68:71]
ds_read_b128 v[36:39], v10 offset:20480
v_mfma_f32_16x16x32_bf16 v[72:75], a[60:63], v[44:47], v[72:75]
s_add_u32 m0, s46, 15872
v_mfma_f32_16x16x32_bf16 v[76:79], a[56:59], v[48:51], v[76:79]
ds_read_b128 v[40:43], v10 offset:22528
v_mfma_f32_16x16x32_bf16 v[80:83], a[60:63], v[48:51], v[80:83]
buffer_load_dwordx4 v6, s[8:11], s50 offen offset:512 lds
s_waitcnt lgkmcnt(4)
v_mfma_f32_16x16x32_bf16 v[68:71], a[64:67], v[20:23], v[68:71]
ds_read_b128 v[44:47], v11 offset:20480
v_mfma_f32_16x16x32_bf16 v[72:75], a[68:71], v[20:23], v[72:75]
s_add_u32 m0, s46, 19840
v_mfma_f32_16x16x32_bf16 v[76:79], a[64:67], v[24:27], v[76:79]
ds_read_b128 v[48:51], v11 offset:22528
v_mfma_f32_16x16x32_bf16 v[80:83], a[68:71], v[24:27], v[80:83]
buffer_load_dwordx4 v6, s[8:11], s50 offen offset:640 lds
s_waitcnt lgkmcnt(4)
v_mfma_f32_16x16x32_bf16 v[68:71], a[72:75], v[28:31], v[68:71]
ds_read_b128 v[20:23], v10 offset:24576
v_mfma_f32_16x16x32_bf16 v[72:75], a[76:79], v[28:31], v[72:75]
s_add_u32 m0, s46, 23808
v_mfma_f32_16x16x32_bf16 v[76:79], a[72:75], v[32:35], v[76:79]
ds_read_b128 v[24:27], v10 offset:26624
v_mfma_f32_16x16x32_bf16 v[80:83], a[76:79], v[32:35], v[80:83]
buffer_load_dwordx4 v6, s[8:11], s50 offen offset:768 lds
s_waitcnt lgkmcnt(4)
v_mfma_f32_16x16x32_bf16 v[68:71], a[80:83], v[36:39], v[68:71]
ds_read_b128 v[28:31], v11 offset:24576
v_mfma_f32_16x16x32_bf16 v[72:75], a[84:87], v[36:39], v[72:75]
s_add_u32 m0, s46, 27776
v_mfma_f32_16x16x32_bf16 v[76:79], a[80:83], v[40:43], v[76:79]
ds_read_b128 v[32:35], v11 offset:26624
v_mfma_f32_16x16x32_bf16 v[80:83], a[84:87], v[40:43], v[80:83]
buffer_load_dwordx4 v6, s[8:11], s50 offen offset:896 lds
s_waitcnt lgkmcnt(4)
v_mfma_f32_16x16x32_bf16 v[68:71], a[88:91], v[44:47], v[68:71]
ds_read_b128 v[36:39], v10 offset:28672
v_mfma_f32_16x16x32_bf16 v[72:75], a[92:95], v[44:47], v[72:75]
s_add_u32 m0, s46, 31744
v_mfma_f32_16x16x32_bf16 v[76:79], a[88:91], v[48:51], v[76:79]
ds_read_b128 v[40:43], v10 offset:30720
v_mfma_f32_16x16x32_bf16 v[80:83], a[92:95], v[48:51], v[80:83]
buffer_load_dwordx4 v6, s[8:11], s50 offen offset:1024 lds
s_waitcnt lgkmcnt(4)
v_mfma_f32_16x16x32_bf16 v[68:71], a[96:99], v[20:23], v[68:71]
ds_read_b128 v[44:47], v11 offset:28672
v_mfma_f32_16x16x32_bf16 v[72:75], a[100:103], v[20:23], v[72:75]
s_add_u32 m0, s46, 35712
v_mfma_f32_16x16x32_bf16 v[76:79], a[96:99], v[24:27], v[76:79]
ds_read_b128 v[48:51], v11 offset:30720
v_mfma_f32_16x16x32_bf16 v[80:83], a[100:103], v[24:27], v[80:83]
buffer_load_dwordx4 v6, s[8:11], s50 offen offset:1152 lds
s_waitcnt lgkmcnt(4)
v_mfma_f32_16x16x32_bf16 v[68:71], a[104:107], v[28:31], v[68:71]
ds_read_b128 v[20:23], v10 offset:32768
v_mfma_f32_16x16x32_bf16 v[72:75], a[108:111], v[28:31], v[72:75]
s_add_u32 m0, s46, 39680
v_mfma_f32_16x16x32_bf16 v[76:79], a[104:107], v[32:35], v[76:79]
ds_read_b128 v[24:27], v10 offset:34816
v_mfma_f32_16x16x32_bf16 v[80:83], a[108:111], v[32:35], v[80:83]
buffer_load_dwordx4 v6, s[8:11], s50 offen offset:1280 lds
s_waitcnt lgkmcnt(4)
v_mfma_f32_16x16x32_bf16 v[68:71], a[112:115], v[36:39], v[68:71]
ds_read_b128 v[28:31], v11 offset:32768
v_mfma_f32_16x16x32_bf16 v[72:75], a[116:119], v[36:39], v[72:75]
s_add_u32 m0, s46, 43648
v_mfma_f32_16x16x32_bf16 v[76:79], a[112:115], v[40:43], v[76:79]
ds_read_b128 v[32:35], v11 offset:34816
v_mfma_f32_16x16x32_bf16 v[80:83], a[116:119], v[40:43], v[80:83]
buffer_load_dwordx4 v6, s[8:11], s50 offen offset:1408 lds
s_waitcnt lgkmcnt(4)
v_mfma_f32_16x16x32_bf16 v[68:71], a[120:123], v[44:47], v[68:71]
ds_read_b128 v[36:39], v10 offset:36864
v_mfma_f32_16x16x32_bf16 v[72:75], a[124:127], v[44:47], v[72:75]
s_add_u32 m0, s46, 47616
v_mfma_f32_16x16x32_bf16 v[76:79], a[120:123], v[48:51], v[76:79]
ds_read_b128 v[40:43], v10 offset:38912
v_mfma_f32_16x16x32_bf16 v[80:83], a[124:127], v[48:51], v[80:83]
buffer_load_dwordx4 v6, s[8:11], s50 offen offset:1536 lds
s_waitcnt lgkmcnt(4)
v_mfma_f32_16x16x32_bf16 v[68:71], a[128:131], v[20:23], v[68:71]
ds_read_b128 v[44:47], v11 offset:36864
v_mfma_f32_16x16x32_bf16 v[72:75], a[132:135], v[20:23], v[72:75]
s_add_u32 m0, s46, 51584
v_mfma_f32_16x16x32_bf16 v[76:79], a[128:131], v[24:27], v[76:79]
ds_read_b128 v[48:51], v11 offset:38912
v_mfma_f32_16x16x32_bf16 v[80:83], a[132:135], v[24:27], v[80:83]
buffer_load_dwordx4 v6, s[8:11], s50 offen offset:1664 lds
s_waitcnt lgkmcnt(4)
v_mfma_f32_16x16x32_bf16 v[68:71], a[136:139], v[28:31], v[68:71]
ds_read_b128 v[20:23], v10 offset:40960
v_mfma_f32_16x16x32_bf16 v[72:75], a[140:143], v[28:31], v[72:75]
s_add_u32 m0, s46, 55552
v_mfma_f32_16x16x32_bf16 v[76:79], a[136:139], v[32:35], v[76:79]
ds_read_b128 v[24:27], v10 offset:43008
v_mfma_f32_16x16x32_bf16 v[80:83], a[140:143], v[32:35], v[80:83]
buffer_load_dwordx4 v6, s[8:11], s50 offen offset:1792 lds
s_waitcnt lgkmcnt(4)
v_mfma_f32_16x16x32_bf16 v[68:71], a[144:147], v[36:39], v[68:71]
ds_read_b128 v[28:31], v11 offset:40960
v_mfma_f32_16x16x32_bf16 v[72:75], a[148:151], v[36:39], v[72:75]
s_add_u32 m0, s46, 59520
v_mfma_f32_16x16x32_bf16 v[76:79], a[144:147], v[40:43], v[76:79]
ds_read_b128 v[32:35], v11 offset:43008
v_mfma_f32_16x16x32_bf16 v[80:83], a[148:151], v[40:43], v[80:83]
buffer_load_dwordx4 v6, s[8:11], s50 offen offset:1920 lds
s_waitcnt lgkmcnt(4)
v_mfma_f32_16x16x32_bf16 v[68:71], a[152:155], v[44:47], v[68:71]
ds_read_b128 v[36:39], v10 offset:45056
v_mfma_f32_16x16x32_bf16 v[72:75], a[156:159], v[44:47], v[72:75]
v_mfma_f32_16x16x32_bf16 v[76:79], a[152:155], v[48:51], v[76:79]
ds_read_b128 v[40:43], v10 offset:47104
v_mfma_f32_16x16x32_bf16 v[80:83], a[156:159], v[48:51], v[80:83]
s_waitcnt lgkmcnt(4)
v_mfma_f32_16x16x32_bf16 v[68:71], a[160:163], v[20:23], v[68:71]
ds_read_b128 v[44:47], v11 offset:45056
v_mfma_f32_16x16x32_bf16 v[72:75], a[164:167], v[20:23], v[72:75]
v_mfma_f32_16x16x32_bf16 v[76:79], a[160:163], v[24:27], v[76:79]
ds_read_b128 v[48:51], v11 offset:47104
v_mfma_f32_16x16x32_bf16 v[80:83], a[164:167], v[24:27], v[80:83]
s_waitcnt lgkmcnt(4)
v_mfma_f32_16x16x32_bf16 v[68:71], a[168:171], v[28:31], v[68:71]
ds_read_b128 v[20:23], v10 offset:49152
v_mfma_f32_16x16x32_bf16 v[72:75], a[172:175], v[28:31], v[72:75]
s_waitcnt vmcnt(16)
v_mov_b32 v17, s42
s_mov_b64 exec, 1
buffer_store_dword v17, v16, s[84:87], s49 offen sc1
s_mov_b64 exec, -1
v_mfma_f32_16x16x32_bf16 v[76:79], a[168:171], v[32:35], v[76:79]
ds_read_b128 v[24:27], v10 offset:51200
v_mfma_f32_16x16x32_bf16 v[80:83], a[172:175], v[32:35], v[80:83]
s_waitcnt lgkmcnt(4)
v_mfma_f32_16x16x32_bf16 v[68:71], a[176:179], v[36:39], v[68:71]
ds_read_b128 v[28:31], v11 offset:49152
v_mfma_f32_16x16x32_bf16 v[72:75], a[180:183], v[36:39], v[72:75]
s_add_u32 s53, s42, 3
s_min_u32 s53, s53, 63
s_lshl_b32 s53, s53, 16
s_mov_b64 exec, 0xffff
buffer_load_dword v250, v19, s[8:11], s53 offen
s_mov_b64 exec, -1
v_mfma_f32_16x16x32_bf16 v[76:79], a[176:179], v[40:43], v[76:79]
ds_read_b128 v[32:35], v11 offset:51200
v_mfma_f32_16x16x32_bf16 v[80:83], a[180:183], v[40:43], v[80:83]
s_waitcnt lgkmcnt(4)
v_mfma_f32_16x16x32_bf16 v[68:71], a[184:187], v[44:47], v[68:71]
ds_read_b128 v[36:39], v10 offset:53248
v_mfma_f32_16x16x32_bf16 v[72:75], a[188:191], v[44:47], v[72:75]
v_mfma_f32_16x16x32_bf16 v[76:79], a[184:187], v[48:51], v[76:79]
ds_read_b128 v[40:43], v10 offset:55296
v_mfma_f32_16x16x32_bf16 v[80:83], a[188:191], v[48:51], v[80:83]
s_waitcnt lgkmcnt(4)
v_mfma_f32_16x16x32_bf16 v[68:71], a[192:195], v[20:23], v[68:71]
ds_read_b128 v[44:47], v11 offset:53248
v_mfma_f32_16x16x32_bf16 v[72:75], a[196:199], v[20:23], v[72:75]
v_mfma_f32_16x16x32_bf16 v[76:79], a[192:195], v[24:27], v[76:79]
ds_read_b128 v[48:51], v11 offset:55296
v_mfma_f32_16x16x32_bf16 v[80:83], a[196:199], v[24:27], v[80:83]
s_waitcnt lgkmcnt(4)
v_mfma_f32_16x16x32_bf16 v[68:71], a[200:203], v[28:31], v[68:71]
ds_read_b128 v[20:23], v10 offset:57344
v_mfma_f32_16x16x32_bf16 v[72:75], a[204:207], v[28:31], v[72:75]
v_mfma_f32_16x16x32_bf16 v[76:79], a[200:203], v[32:35], v[76:79]
ds_read_b128 v[24:27], v10 offset:59392
v_mfma_f32_16x16x32_bf16 v[80:83], a[204:207], v[32:35], v[80:83]
s_waitcnt lgkmcnt(4)
v_mfma_f32_16x16x32_bf16 v[68:71], a[208:211], v[36:39], v[68:71]
ds_read_b128 v[28:31], v11 offset:57344
v_mfma_f32_16x16x32_bf16 v[72:75], a[212:215], v[36:39], v[72:75]
v_mfma_f32_16x16x32_bf16 v[76:79], a[208:211], v[40:43], v[76:79]
ds_read_b128 v[32:35], v11 offset:59392
v_mfma_f32_16x16x32_bf16 v[80:83], a[212:215], v[40:43], v[80:83]
s_waitcnt lgkmcnt(4)
v_mfma_f32_16x16x32_bf16 v[68:71], a[216:219], v[44:47], v[68:71]
ds_read_b128 v[36:39], v10 offset:61440
v_mfma_f32_16x16x32_bf16 v[72:75], a[220:223], v[44:47], v[72:75]
v_mfma_f32_16x16x32_bf16 v[76:79], a[216:219], v[48:51], v[76:79]
ds_read_b128 v[40:43], v10 offset:63488
v_mfma_f32_16x16x32_bf16 v[80:83], a[220:223], v[48:51], v[80:83]
s_waitcnt lgkmcnt(4)
v_mfma_f32_16x16x32_bf16 v[68:71], a[224:227], v[20:23], v[68:71]
ds_read_b128 v[44:47], v11 offset:61440
v_mfma_f32_16x16x32_bf16 v[72:75], a[228:231], v[20:23], v[72:75]
v_mfma_f32_16x16x32_bf16 v[76:79], a[224:227], v[24:27], v[76:79]
ds_read_b128 v[48:51], v11 offset:63488
v_mfma_f32_16x16x32_bf16 v[80:83], a[228:231], v[24:27], v[80:83]
s_waitcnt lgkmcnt(5)
v_mfma_f32_16x16x32_bf16 v[68:71], a[232:235], v[28:31], v[68:71]
v_mfma_f32_16x16x32_bf16 v[72:75], a[236:239], v[28:31], v[72:75]
s_waitcnt lgkmcnt(4)
v_mfma_f32_16x16x32_bf16 v[76:79], a[232:235], v[32:35], v[76:79]
v_mfma_f32_16x16x32_bf16 v[80:83], a[236:239], v[32:35], v[80:83]
s_waitcnt lgkmcnt(3)
v_mfma_f32_16x16x32_bf16 v[68:71], a[240:243], v[36:39], v[68:71]
v_mfma_f32_16x16x32_bf16 v[72:75], a[244:247], v[36:39], v[72:75]
s_waitcnt lgkmcnt(2)
v_mfma_f32_16x16x32_bf16 v[76:79], a[240:243], v[40:43], v[76:79]
v_mfma_f32_16x16x32_bf16 v[80:83], a[244:247], v[40:43], v[80:83]
s_waitcnt lgkmcnt(1)
v_mfma_f32_16x16x32_bf16 v[68:71], a[248:251], v[44:47], v[68:71]
v_mfma_f32_16x16x32_bf16 v[72:75], a[252:255], v[44:47], v[72:75]
s_waitcnt lgkmcnt(0)
v_mfma_f32_16x16x32_bf16 v[76:79], a[248:251], v[48:51], v[76:79]
v_mfma_f32_16x16x32_bf16 v[80:83], a[252:255], v[48:51], v[80:83]
s_add_u32 s42, s42, 1
s_cmp_eq_u32 s42, 64
s_cbranch_scc1 mega_kernel_k_fin
mega_kernel_k_mid:
s_waitcnt vmcnt(2)
s_barrier
s_add_u32 s50, s42, 1
s_min_u32 s50, s50, 63
s_lshl_b32 s50, s50, 16
ds_read_b128 v[20:23], v8 offset:0
ds_read_b128 v[24:27], v8 offset:2048
ds_read_b128 v[28:31], v9 offset:0
ds_read_b128 v[32:35], v9 offset:2048
ds_read_b128 v[36:39], v8 offset:4096
ds_read_b128 v[40:43], v8 offset:6144
s_waitcnt lgkmcnt(4)
v_mfma_f32_16x16x32_bf16 v[52:55], a[0:3], v[20:23], 0
ds_read_b128 v[44:47], v9 offset:4096
v_mfma_f32_16x16x32_bf16 v[56:59], a[4:7], v[20:23], 0
v_cvt_pk_bf16_f32 v84, v68, v69
v_cvt_pk_bf16_f32 v85, v70, v71
v_cvt_pk_bf16_f32 v86, v72, v73
v_mfma_f32_16x16x32_bf16 v[60:63], a[0:3], v[24:27], 0
ds_read_b128 v[48:51], v9 offset:6144
v_mfma_f32_16x16x32_bf16 v[64:67], a[4:7], v[24:27], 0
v_cvt_pk_bf16_f32 v87, v74, v75
v_cvt_pk_bf16_f32 v88, v76, v77
v_cvt_pk_bf16_f32 v89, v78, v79
s_waitcnt lgkmcnt(4)
v_mfma_f32_16x16x32_bf16 v[52:55], a[8:11], v[28:31], v[52:55]
ds_read_b128 v[20:23], v8 offset:8192
v_mfma_f32_16x16x32_bf16 v[56:59], a[12:15], v[28:31], v[56:59]
v_cvt_pk_bf16_f32 v90, v80, v81
v_cvt_pk_bf16_f32 v91, v82, v83
v_mfma_f32_16x16x32_bf16 v[60:63], a[8:11], v[32:35], v[60:63]
ds_read_b128 v[24:27], v8 offset:10240
v_mfma_f32_16x16x32_bf16 v[64:67], a[12:15], v[32:35], v[64:67]
s_add_u32 s51, s42, s47
s_sub_u32 s51, s51, 1
s_bfe_u32 s52, s51, 0x40002
s_lshl_b32 s52, s52, 14
s_waitcnt lgkmcnt(4)
v_mfma_f32_16x16x32_bf16 v[52:55], a[16:19], v[36:39], v[52:55]
ds_read_b128 v[28:31], v9 offset:8192
v_mfma_f32_16x16x32_bf16 v[56:59], a[20:23], v[36:39], v[56:59]
s_and_b32 s51, s51, 3
s_lshl_b32 s51, s51, 11
s_add_u32 s51, s51, s52
s_add_u32 s51, s51, s48
buffer_store_dwordx4 v[84:87], v7, s[84:87], s51 offen sc1
v_mfma_f32_16x16x32_bf16 v[60:63], a[16:19], v[40:43], v[60:63]
ds_read_b128 v[32:35], v9 offset:10240
v_mfma_f32_16x16x32_bf16 v[64:67], a[20:23], v[40:43], v[64:67]
buffer_store_dwordx4 v[88:91], v7, s[84:87], s51 offen offset:1024 sc1
s_waitcnt lgkmcnt(4)
v_mfma_f32_16x16x32_bf16 v[52:55], a[24:27], v[44:47], v[52:55]
ds_read_b128 v[36:39], v8 offset:12288
v_mfma_f32_16x16x32_bf16 v[56:59], a[28:31], v[44:47], v[56:59]
s_add_u32 m0, s46, 65536
v_mfma_f32_16x16x32_bf16 v[60:63], a[24:27], v[48:51], v[60:63]
ds_read_b128 v[40:43], v8 offset:14336
v_mfma_f32_16x16x32_bf16 v[64:67], a[28:31], v[48:51], v[64:67]
buffer_load_dwordx4 v6, s[8:11], s50 offen offset:0 lds
s_waitcnt lgkmcnt(4)
v_mfma_f32_16x16x32_bf16 v[52:55], a[32:35], v[20:23], v[52:55]
ds_read_b128 v[44:47], v9 offset:12288
v_mfma_f32_16x16x32_bf16 v[56:59], a[36:39], v[20:23], v[56:59]
s_add_u32 m0, s46, 69504
v_mfma_f32_16x16x32_bf16 v[60:63], a[32:35], v[24:27], v[60:63]
ds_read_b128 v[48:51], v9 offset:14336
v_mfma_f32_16x16x32_bf16 v[64:67], a[36:39], v[24:27], v[64:67]
buffer_load_dwordx4 v6, s[8:11], s50 offen offset:128 lds
s_waitcnt lgkmcnt(4)
v_mfma_f32_16x16x32_bf16 v[52:55], a[40:43], v[28:31], v[52:55]
ds_read_b128 v[20:23], v8 offset:16384
v_mfma_f32_16x16x32_bf16 v[56:59], a[44:47], v[28:31], v[56:59]
s_add_u32 m0, s46, 73472
v_mfma_f32_16x16x32_bf16 v[60:63], a[40:43], v[32:35], v[60:63]
ds_read_b128 v[24:27], v8 offset:18432
v_mfma_f32_16x16x32_bf16 v[64:67], a[44:47], v[32:35], v[64:67]
buffer_load_dwordx4 v6, s[8:11], s50 offen offset:256 lds
s_waitcnt lgkmcnt(4)
v_mfma_f32_16x16x32_bf16 v[52:55], a[48:51], v[36:39], v[52:55]
ds_read_b128 v[28:31], v9 offset:16384
v_mfma_f32_16x16x32_bf16 v[56:59], a[52:55], v[36:39], v[56:59]
s_add_u32 m0, s46, 77440
v_mfma_f32_16x16x32_bf16 v[60:63], a[48:51], v[40:43], v[60:63]
ds_read_b128 v[32:35], v9 offset:18432
v_mfma_f32_16x16x32_bf16 v[64:67], a[52:55], v[40:43], v[64:67]
buffer_load_dwordx4 v6, s[8:11], s50 offen offset:384 lds
s_waitcnt lgkmcnt(4)
v_mfma_f32_16x16x32_bf16 v[52:55], a[56:59], v[44:47], v[52:55]
ds_read_b128 v[36:39], v8 offset:20480
v_mfma_f32_16x16x32_bf16 v[56:59], a[60:63], v[44:47], v[56:59]
s_add_u32 m0, s46, 81408
v_mfma_f32_16x16x32_bf16 v[60:63], a[56:59], v[48:51], v[60:63]
ds_read_b128 v[40:43], v8 offset:22528
v_mfma_f32_16x16x32_bf16 v[64:67], a[60:63], v[48:51], v[64:67]
buffer_load_dwordx4 v6, s[8:11], s50 offen offset:512 lds
s_waitcnt lgkmcnt(4)
v_mfma_f32_16x16x32_bf16 v[52:55], a[64:67], v[20:23], v[52:55]
ds_read_b128 v[44:47], v9 offset:20480
v_mfma_f32_16x16x32_bf16 v[56:59], a[68:71], v[20:23], v[56:59]
s_add_u32 m0, s46, 85376
v_mfma_f32_16x16x32_bf16 v[60:63], a[64:67], v[24:27], v[60:63]
ds_read_b128 v[48:51], v9 offset:22528
v_mfma_f32_16x16x32_bf16 v[64:67], a[68:71], v[24:27], v[64:67]
buffer_load_dwordx4 v6, s[8:11], s50 offen offset:640 lds
s_waitcnt lgkmcnt(4)
v_mfma_f32_16x16x32_bf16 v[52:55], a[72:75], v[28:31], v[52:55]
ds_read_b128 v[20:23], v8 offset:24576
v_mfma_f32_16x16x32_bf16 v[56:59], a[76:79], v[28:31], v[56:59]
s_add_u32 m0, s46, 89344
v_mfma_f32_16x16x32_bf16 v[60:63], a[72:75], v[32:35], v[60:63]
ds_read_b128 v[24:27], v8 offset:26624
v_mfma_f32_16x16x32_bf16 v[64:67], a[76:79], v[32:35], v[64:67]
buffer_load_dwordx4 v6, s[8:11], s50 offen offset:768 lds
s_waitcnt lgkmcnt(4)
v_mfma_f32_16x16x32_bf16 v[52:55], a[80:83], v[36:39], v[52:55]
ds_read_b128 v[28:31], v9 offset:24576
v_mfma_f32_16x16x32_bf16 v[56:59], a[84:87], v[36:39], v[56:59]
s_add_u32 m0, s46, 93312
v_mfma_f32_16x16x32_bf16 v[60:63], a[80:83], v[40:43], v[60:63]
ds_read_b128 v[32:35], v9 offset:26624
v_mfma_f32_16x16x32_bf16 v[64:67], a[84:87], v[40:43], v[64:67]
buffer_load_dwordx4 v6, s[8:11], s50 offen offset:896 lds
s_waitcnt lgkmcnt(4)
v_mfma_f32_16x16x32_bf16 v[52:55], a[88:91], v[44:47], v[52:55]
ds_read_b128 v[36:39], v8 offset:28672
v_mfma_f32_16x16x32_bf16 v[56:59], a[92:95], v[44:47], v[56:59]
s_add_u32 m0, s46, 97280
v_mfma_f32_16x16x32_bf16 v[60:63], a[88:91], v[48:51], v[60:63]
ds_read_b128 v[40:43], v8 offset:30720
v_mfma_f32_16x16x32_bf16 v[64:67], a[92:95], v[48:51], v[64:67]
buffer_load_dwordx4 v6, s[8:11], s50 offen offset:1024 lds
s_waitcnt lgkmcnt(4)
v_mfma_f32_16x16x32_bf16 v[52:55], a[96:99], v[20:23], v[52:55]
ds_read_b128 v[44:47], v9 offset:28672
v_mfma_f32_16x16x32_bf16 v[56:59], a[100:103], v[20:23], v[56:59]
s_add_u32 m0, s46, 101248
v_mfma_f32_16x16x32_bf16 v[60:63], a[96:99], v[24:27], v[60:63]
ds_read_b128 v[48:51], v9 offset:30720
v_mfma_f32_16x16x32_bf16 v[64:67], a[100:103], v[24:27], v[64:67]
buffer_load_dwordx4 v6, s[8:11], s50 offen offset:1152 lds
s_waitcnt lgkmcnt(4)
v_mfma_f32_16x16x32_bf16 v[52:55], a[104:107], v[28:31], v[52:55]
ds_read_b128 v[20:23], v8 offset:32768
v_mfma_f32_16x16x32_bf16 v[56:59], a[108:111], v[28:31], v[56:59]
s_add_u32 m0, s46, 105216
v_mfma_f32_16x16x32_bf16 v[60:63], a[104:107], v[32:35], v[60:63]
ds_read_b128 v[24:27], v8 offset:34816
v_mfma_f32_16x16x32_bf16 v[64:67], a[108:111], v[32:35], v[64:67]
buffer_load_dwordx4 v6, s[8:11], s50 offen offset:1280 lds
s_waitcnt lgkmcnt(4)
v_mfma_f32_16x16x32_bf16 v[52:55], a[112:115], v[36:39], v[52:55]
ds_read_b128 v[28:31], v9 offset:32768
v_mfma_f32_16x16x32_bf16 v[56:59], a[116:119], v[36:39], v[56:59]
s_add_u32 m0, s46, 109184
v_mfma_f32_16x16x32_bf16 v[60:63], a[112:115], v[40:43], v[60:63]
ds_read_b128 v[32:35], v9 offset:34816
v_mfma_f32_16x16x32_bf16 v[64:67], a[116:119], v[40:43], v[64:67]
buffer_load_dwordx4 v6, s[8:11], s50 offen offset:1408 lds
s_waitcnt lgkmcnt(4)
v_mfma_f32_16x16x32_bf16 v[52:55], a[120:123], v[44:47], v[52:55]
ds_read_b128 v[36:39], v8 offset:36864
v_mfma_f32_16x16x32_bf16 v[56:59], a[124:127], v[44:47], v[56:59]
s_add_u32 m0, s46, 113152
v_mfma_f32_16x16x32_bf16 v[60:63], a[120:123], v[48:51], v[60:63]
ds_read_b128 v[40:43], v8 offset:38912
v_mfma_f32_16x16x32_bf16 v[64:67], a[124:127], v[48:51], v[64:67]
buffer_load_dwordx4 v6, s[8:11], s50 offen offset:1536 lds
s_waitcnt lgkmcnt(4)
v_mfma_f32_16x16x32_bf16 v[52:55], a[128:131], v[20:23], v[52:55]
ds_read_b128 v[44:47], v9 offset:36864
v_mfma_f32_16x16x32_bf16 v[56:59], a[132:135], v[20:23], v[56:59]
s_add_u32 m0, s46, 117120
v_mfma_f32_16x16x32_bf16 v[60:63], a[128:131], v[24:27], v[60:63]
ds_read_b128 v[48:51], v9 offset:38912
v_mfma_f32_16x16x32_bf16 v[64:67], a[132:135], v[24:27], v[64:67]
buffer_load_dwordx4 v6, s[8:11], s50 offen offset:1664 lds
s_waitcnt lgkmcnt(4)
v_mfma_f32_16x16x32_bf16 v[52:55], a[136:139], v[28:31], v[52:55]
ds_read_b128 v[20:23], v8 offset:40960
v_mfma_f32_16x16x32_bf16 v[56:59], a[140:143], v[28:31], v[56:59]
s_add_u32 m0, s46, 121088
v_mfma_f32_16x16x32_bf16 v[60:63], a[136:139], v[32:35], v[60:63]
ds_read_b128 v[24:27], v8 offset:43008
v_mfma_f32_16x16x32_bf16 v[64:67], a[140:143], v[32:35], v[64:67]
buffer_load_dwordx4 v6, s[8:11], s50 offen offset:1792 lds
s_waitcnt lgkmcnt(4)
v_mfma_f32_16x16x32_bf16 v[52:55], a[144:147], v[36:39], v[52:55]
ds_read_b128 v[28:31], v9 offset:40960
v_mfma_f32_16x16x32_bf16 v[56:59], a[148:151], v[36:39], v[56:59]
s_add_u32 m0, s46, 125056
v_mfma_f32_16x16x32_bf16 v[60:63], a[144:147], v[40:43], v[60:63]
ds_read_b128 v[32:35], v9 offset:43008
v_mfma_f32_16x16x32_bf16 v[64:67], a[148:151], v[40:43], v[64:67]
buffer_load_dwordx4 v6, s[8:11], s50 offen offset:1920 lds
s_waitcnt lgkmcnt(4)
v_mfma_f32_16x16x32_bf16 v[52:55], a[152:155], v[44:47], v[52:55]
ds_read_b128 v[36:39], v8 offset:45056
v_mfma_f32_16x16x32_bf16 v[56:59], a[156:159], v[44:47], v[56:59]
v_mfma_f32_16x16x32_bf16 v[60:63], a[152:155], v[48:51], v[60:63]
ds_read_b128 v[40:43], v8 offset:47104
v_mfma_f32_16x16x32_bf16 v[64:67], a[156:159], v[48:51], v[64:67]
s_waitcnt lgkmcnt(4)
v_mfma_f32_16x16x32_bf16 v[52:55], a[160:163], v[20:23], v[52:55]
ds_read_b128 v[44:47], v9 offset:45056
v_mfma_f32_16x16x32_bf16 v[56:59], a[164:167], v[20:23], v[56:59]
v_mfma_f32_16x16x32_bf16 v[60:63], a[160:163], v[24:27], v[60:63]
ds_read_b128 v[48:51], v9 offset:47104
v_mfma_f32_16x16x32_bf16 v[64:67], a[164:167], v[24:27], v[64:67]
s_waitcnt lgkmcnt(4)
v_mfma_f32_16x16x32_bf16 v[52:55], a[168:171], v[28:31], v[52:55]
ds_read_b128 v[20:23], v8 offset:49152
v_mfma_f32_16x16x32_bf16 v[56:59], a[172:175], v[28:31], v[56:59]
s_waitcnt vmcnt(16)
v_mov_b32 v17, s42
s_mov_b64 exec, 1
buffer_store_dword v17, v16, s[84:87], s49 offen sc1
s_mov_b64 exec, -1
v_mfma_f32_16x16x32_bf16 v[60:63], a[168:171], v[32:35], v[60:63]
ds_read_b128 v[24:27], v8 offset:51200
v_mfma_f32_16x16x32_bf16 v[64:67], a[172:175], v[32:35], v[64:67]
s_waitcnt lgkmcnt(4)
v_mfma_f32_16x16x32_bf16 v[52:55], a[176:179], v[36:39], v[52:55]
ds_read_b128 v[28:31], v9 offset:49152
v_mfma_f32_16x16x32_bf16 v[56:59], a[180:183], v[36:39], v[56:59]
s_add_u32 s53, s42, 3
s_min_u32 s53, s53, 63
s_lshl_b32 s53, s53, 16
s_mov_b64 exec, 0xffff
buffer_load_dword v250, v19, s[8:11], s53 offen
s_mov_b64 exec, -1
v_mfma_f32_16x16x32_bf16 v[60:63], a[176:179], v[40:43], v[60:63]
ds_read_b128 v[32:35], v9 offset:51200
v_mfma_f32_16x16x32_bf16 v[64:67], a[180:183], v[40:43], v[64:67]
s_waitcnt lgkmcnt(4)
v_mfma_f32_16x16x32_bf16 v[52:55], a[184:187], v[44:47], v[52:55]
ds_read_b128 v[36:39], v8 offset:53248
v_mfma_f32_16x16x32_bf16 v[56:59], a[188:191], v[44:47], v[56:59]
v_mfma_f32_16x16x32_bf16 v[60:63], a[184:187], v[48:51], v[60:63]
ds_read_b128 v[40:43], v8 offset:55296
v_mfma_f32_16x16x32_bf16 v[64:67], a[188:191], v[48:51], v[64:67]
s_waitcnt lgkmcnt(4)
v_mfma_f32_16x16x32_bf16 v[52:55], a[192:195], v[20:23], v[52:55]
ds_read_b128 v[44:47], v9 offset:53248
v_mfma_f32_16x16x32_bf16 v[56:59], a[196:199], v[20:23], v[56:59]
v_mfma_f32_16x16x32_bf16 v[60:63], a[192:195], v[24:27], v[60:63]
ds_read_b128 v[48:51], v9 offset:55296
v_mfma_f32_16x16x32_bf16 v[64:67], a[196:199], v[24:27], v[64:67]
s_waitcnt lgkmcnt(4)
v_mfma_f32_16x16x32_bf16 v[52:55], a[200:203], v[28:31], v[52:55]
ds_read_b128 v[20:23], v8 offset:57344
v_mfma_f32_16x16x32_bf16 v[56:59], a[204:207], v[28:31], v[56:59]
v_mfma_f32_16x16x32_bf16 v[60:63], a[200:203], v[32:35], v[60:63]
ds_read_b128 v[24:27], v8 offset:59392
v_mfma_f32_16x16x32_bf16 v[64:67], a[204:207], v[32:35], v[64:67]
s_waitcnt lgkmcnt(4)
v_mfma_f32_16x16x32_bf16 v[52:55], a[208:211], v[36:39], v[52:55]
ds_read_b128 v[28:31], v9 offset:57344
v_mfma_f32_16x16x32_bf16 v[56:59], a[212:215], v[36:39], v[56:59]
v_mfma_f32_16x16x32_bf16 v[60:63], a[208:211], v[40:43], v[60:63]
ds_read_b128 v[32:35], v9 offset:59392
v_mfma_f32_16x16x32_bf16 v[64:67], a[212:215], v[40:43], v[64:67]
s_waitcnt lgkmcnt(4)
v_mfma_f32_16x16x32_bf16 v[52:55], a[216:219], v[44:47], v[52:55]
ds_read_b128 v[36:39], v8 offset:61440
v_mfma_f32_16x16x32_bf16 v[56:59], a[220:223], v[44:47], v[56:59]
v_mfma_f32_16x16x32_bf16 v[60:63], a[216:219], v[48:51], v[60:63]
ds_read_b128 v[40:43], v8 offset:63488
v_mfma_f32_16x16x32_bf16 v[64:67], a[220:223], v[48:51], v[64:67]
s_waitcnt lgkmcnt(4)
v_mfma_f32_16x16x32_bf16 v[52:55], a[224:227], v[20:23], v[52:55]
ds_read_b128 v[44:47], v9 offset:61440
v_mfma_f32_16x16x32_bf16 v[56:59], a[228:231], v[20:23], v[56:59]
v_mfma_f32_16x16x32_bf16 v[60:63], a[224:227], v[24:27], v[60:63]
ds_read_b128 v[48:51], v9 offset:63488
v_mfma_f32_16x16x32_bf16 v[64:67], a[228:231], v[24:27], v[64:67]
s_waitcnt lgkmcnt(5)
v_mfma_f32_16x16x32_bf16 v[52:55], a[232:235], v[28:31], v[52:55]
v_mfma_f32_16x16x32_bf16 v[56:59], a[236:239], v[28:31], v[56:59]
s_waitcnt lgkmcnt(4)
v_mfma_f32_16x16x32_bf16 v[60:63], a[232:235], v[32:35], v[60:63]
v_mfma_f32_16x16x32_bf16 v[64:67], a[236:239], v[32:35], v[64:67]
s_waitcnt lgkmcnt(3)
v_mfma_f32_16x16x32_bf16 v[52:55], a[240:243], v[36:39], v[52:55]
v_mfma_f32_16x16x32_bf16 v[56:59], a[244:247], v[36:39], v[56:59]
s_waitcnt lgkmcnt(2)
v_mfma_f32_16x16x32_bf16 v[60:63], a[240:243], v[40:43], v[60:63]
v_mfma_f32_16x16x32_bf16 v[64:67], a[244:247], v[40:43], v[64:67]
s_waitcnt lgkmcnt(1)
v_mfma_f32_16x16x32_bf16 v[52:55], a[248:251], v[44:47], v[52:55]
v_mfma_f32_16x16x32_bf16 v[56:59], a[252:255], v[44:47], v[56:59]
s_waitcnt lgkmcnt(0)
v_mfma_f32_16x16x32_bf16 v[60:63], a[248:251], v[48:51], v[60:63]
v_mfma_f32_16x16x32_bf16 v[64:67], a[252:255], v[48:51], v[64:67]
s_add_u32 s42, s42, 1
s_branch mega_kernel_k_loop
mega_kernel_k_fin:
s_nop 11
v_cvt_pk_bf16_f32 v84, v68, v69
v_cvt_pk_bf16_f32 v85, v70, v71
v_cvt_pk_bf16_f32 v86, v72, v73
v_cvt_pk_bf16_f32 v87, v74, v75
v_cvt_pk_bf16_f32 v88, v76, v77
v_cvt_pk_bf16_f32 v89, v78, v79
v_cvt_pk_bf16_f32 v90, v80, v81
v_cvt_pk_bf16_f32 v91, v82, v83
s_add_u32 s51, s42, s47
s_sub_u32 s51, s51, 1
s_bfe_u32 s52, s51, 0x40002
s_lshl_b32 s52, s52, 14
s_and_b32 s51, s51, 3
s_lshl_b32 s51, s51, 11
s_add_u32 s51, s51, s52
s_add_u32 s51, s51, s48
buffer_store_dwordx4 v[84:87], v7, s[84:87], s51 offen sc1
buffer_store_dwordx4 v[88:91], v7, s[84:87], s51 offen offset:1024 sc1
s_waitcnt vmcnt(0)
v_mov_b32 v17, s42
s_mov_b64 exec, 1
buffer_store_dword v17, v16, s[84:87], s49 offen sc1
s_mov_b64 exec, -1
s_waitcnt vmcnt(0)
s_barrier
s_branch mega_kernel_fft
mega_kernel_rv:
s_load_dwordx2 s[4:5], s[0:1], 32
s_load_dwordx2 s[8:9], s[0:1], 0
v_lshrrev_b32 v2, 6, v0
v_and_b32 v1, 63, v0
v_readfirstlane_b32 s41, v2
v_lshlrev_b32 v5, 4, v1
s_waitcnt lgkmcnt(0)
s_mov_b32 s6, 8388608
s_mov_b32 s7, 0x00020000
s_mov_b32 s10, 4194304
s_mov_b32 s11, 0x00020000
s_lshl_b32 s43, s40, 8
s_lshl_b32 s44, s41, 6
s_add_u32 s48, s43, s44
s_and_b32 s43, s48, 0x7ff
v_add_u32 v19, s43, v1
v_lshlrev_b32 v19, 7, v19
s_mov_b32 s43, 0
buffer_load_dword v250, v19, s[8:11], s43 offen
s_nop 0
v_lshrrev_b32 v2, 3, v1
s_lshl_b32 s43, s41, 3
v_add_u32 v2, s43, v2
v_bfe_u32 v3, v2, 1, 3
v_and_b32 v4, 7, v1
v_xor_b32 v3, v3, v4
v_lshlrev_b32 v6, 11, v2
v_lshl_add_u32 v6, v3, 4, v6
s_lshl_b32 s46, s41, 10
v_and_b32 v2, 15, v1
v_bfe_u32 v3, v2, 1, 3
v_lshrrev_b32 v4, 4, v1
v_xor_b32 v3, v3, v4
v_lshlrev_b32 v8, 7, v2
v_lshl_add_u32 v8, v3, 4, v8
v_xor_b32 v9, 64, v8
v_add_u32 v10, 0x10000, v8
v_add_u32 v11, 0x10000, v9
v_mov_b32 v7, v5
s_lshl_b32 s47, s40, 2
s_add_u32 s47, s47, s41
s_mov_b32 s42, 0
s_mov_b32 s50, 0
s_add_u32 m0, s46, 0
s_nop 0
buffer_load_dwordx4 v6, s[8:11], s50 offen offset:0 lds
s_add_u32 m0, s46, 3968
s_nop 0
buffer_load_dwordx4 v6, s[8:11], s50 offen offset:128 lds
s_add_u32 m0, s46, 7936
s_nop 0
buffer_load_dwordx4 v6, s[8:11], s50 offen offset:256 lds
s_add_u32 m0, s46, 11904
s_nop 0
buffer_load_dwordx4 v6, s[8:11], s50 offen offset:384 lds
s_add_u32 m0, s46, 15872
s_nop 0
buffer_load_dwordx4 v6, s[8:11], s50 offen offset:512 lds
s_add_u32 m0, s46, 19840
s_nop 0
buffer_load_dwordx4 v6, s[8:11], s50 offen offset:640 lds
s_add_u32 m0, s46, 23808
s_nop 0
buffer_load_dwordx4 v6, s[8:11], s50 offen offset:768 lds
s_add_u32 m0, s46, 27776
s_nop 0
buffer_load_dwordx4 v6, s[8:11], s50 offen offset:896 lds
s_add_u32 m0, s46, 31744
s_nop 0
buffer_load_dwordx4 v6, s[8:11], s50 offen offset:1024 lds
s_add_u32 m0, s46, 35712
s_nop 0
buffer_load_dwordx4 v6, s[8:11], s50 offen offset:1152 lds
s_add_u32 m0, s46, 39680
s_nop 0
buffer_load_dwordx4 v6, s[8:11], s50 offen offset:1280 lds
s_add_u32 m0, s46, 43648
s_nop 0
buffer_load_dwordx4 v6, s[8:11], s50 offen offset:1408 lds
s_add_u32 m0, s46, 47616
s_nop 0
buffer_load_dwordx4 v6, s[8:11], s50 offen offset:1536 lds
s_add_u32 m0, s46, 51584
s_nop 0
buffer_load_dwordx4 v6, s[8:11], s50 offen offset:1664 lds
s_add_u32 m0, s46, 55552
s_nop 0
buffer_load_dwordx4 v6, s[8:11], s50 offen offset:1792 lds
s_add_u32 m0, s46, 59520
s_nop 0
buffer_load_dwordx4 v6, s[8:11], s50 offen offset:1920 lds
v_lshrrev_b32 v2, 2, v1
v_and_b32 v3, 3, v1
v_lshlrev_b32 v16, 13, v2
v_lshl_add_u32 v16, v3, 4, v16
v_add_u32 v16, s48, v16
s_mul_i32 s45, s41, 24576
s_add_u32 s45, s45, 65536
v_bfe_u32 v17, v1, 2, 2
v_lshrrev_b32 v18, 4, v1
v_lshl_add_u32 v17, v18, 3, v17
v_lshlrev_b32 v17, 6, v17
v_lshl_add_u32 v17, v3, 3, v17
v_add_u32 v17, s45, v17
s_and_b32 s43, s40, 3
s_lshl_b32 s43, s43, 2
s_add_u32 s43, s43, s41
s_lshl_b32 s43, s43, 3
v_and_b32 v12, 7, v1
v_add_u32 v12, s43, v12
s_lshr_b32 s43, s40, 2
s_lshl_b32 s43, s43, 10
s_add_u32 s44, s43, 896
s_add_u32 s43, s43, 384
s_cmp_ge_u32 s40, 28
s_cselect_b32 s44, s44, s43
v_mov_b32 v13, s43
v_mov_b32 v14, s44
v_cmp_gt_u32 vcc, 32, v1
s_nop 1
v_cndmask_b32 v13, v14, v13, vcc
v_lshl_add_u32 v12, v12, 13, v13
s_mov_b32 s44, 0
buffer_load_dword v250, v12, s[4:7], s44 offen
s_add_u32 m0, s45, 0
s_mov_b32 s44, 0
buffer_load_dwordx4 v16, s[4:7], s44 offen lds
s_add_u32 m0, s45, 1024
s_mov_b32 s44, 131072
buffer_load_dwordx4 v16, s[4:7], s44 offen lds
s_add_u32 m0, s45, 2048
s_mov_b32 s44, 262144
buffer_load_dwordx4 v16, s[4:7], s44 offen lds
s_add_u32 m0, s45, 3072
s_mov_b32 s44, 393216
buffer_load_dwordx4 v16, s[4:7], s44 offen lds
s_add_u32 m0, s45, 4096
s_mov_b32 s44, 524288
buffer_load_dwordx4 v16, s[4:7], s44 offen lds
s_add_u32 m0, s45, 5120
s_mov_b32 s44, 655360
buffer_load_dwordx4 v16, s[4:7], s44 offen lds
s_add_u32 m0, s45, 6144
s_mov_b32 s44, 786432
buffer_load_dwordx4 v16, s[4:7], s44 offen lds
s_add_u32 m0, s45, 7168
s_mov_b32 s44, 917504
buffer_load_dwordx4 v16, s[4:7], s44 offen lds
s_mov_b32 s44, 1048576
buffer_load_dword v250, v12, s[4:7], s44 offen
s_add_u32 m0, s45, 8192
s_mov_b32 s44, 1048576
buffer_load_dwordx4 v16, s[4:7], s44 offen lds
s_add_u32 m0, s45, 9216
s_mov_b32 s44, 1179648
buffer_load_dwordx4 v16, s[4:7], s44 offen lds
s_add_u32 m0, s45, 10240
s_mov_b32 s44, 1310720
buffer_load_dwordx4 v16, s[4:7], s44 offen lds
s_add_u32 m0, s45, 11264
s_mov_b32 s44, 1441792
buffer_load_dwordx4 v16, s[4:7], s44 offen lds
s_add_u32 m0, s45, 12288
s_mov_b32 s44, 1572864
buffer_load_dwordx4 v16, s[4:7], s44 offen lds
s_add_u32 m0, s45, 13312
s_mov_b32 s44, 1703936
buffer_load_dwordx4 v16, s[4:7], s44 offen lds
s_add_u32 m0, s45, 14336
s_mov_b32 s44, 1835008
buffer_load_dwordx4 v16, s[4:7], s44 offen lds
s_add_u32 m0, s45, 15360
s_mov_b32 s44, 1966080
buffer_load_dwordx4 v16, s[4:7], s44 offen lds
s_mov_b32 s44, 2097152
buffer_load_dword v250, v12, s[4:7], s44 offen
s_add_u32 m0, s45, 16384
s_mov_b32 s44, 2097152
buffer_load_dwordx4 v16, s[4:7], s44 offen lds
s_add_u32 m0, s45, 17408
s_mov_b32 s44, 2228224
buffer_load_dwordx4 v16, s[4:7], s44 offen lds
s_add_u32 m0, s45, 18432
s_mov_b32 s44, 2359296
buffer_load_dwordx4 v16, s[4:7], s44 offen lds
s_add_u32 m0, s45, 19456
s_mov_b32 s44, 2490368
buffer_load_dwordx4 v16, s[4:7], s44 offen lds
s_add_u32 m0, s45, 20480
s_mov_b32 s44, 2621440
buffer_load_dwordx4 v16, s[4:7], s44 offen lds
s_add_u32 m0, s45, 21504
s_mov_b32 s44, 2752512
buffer_load_dwordx4 v16, s[4:7], s44 offen lds
s_add_u32 m0, s45, 22528
s_mov_b32 s44, 2883584
buffer_load_dwordx4 v16, s[4:7], s44 offen lds
s_add_u32 m0, s45, 23552
s_mov_b32 s44, 3014656
buffer_load_dwordx4 v16, s[4:7], s44 offen lds
s_waitcnt vmcnt(18)
s_barrier
ds_read_b64_tr_b16 a[0:1], v17 offset:0
ds_read_b64_tr_b16 a[2:3], v17 offset:256
ds_read_b64_tr_b16 a[4:5], v17 offset:32
ds_read_b64_tr_b16 a[6:7], v17 offset:288
ds_read_b64_tr_b16 a[8:9], v17 offset:2048
ds_read_b64_tr_b16 a[10:11], v17 offset:2304
ds_read_b64_tr_b16 a[12:13], v17 offset:2080
ds_read_b64_tr_b16 a[14:15], v17 offset:2336
s_waitcnt lgkmcnt(0)
ds_read_b64_tr_b16 a[16:17], v17 offset:4096
ds_read_b64_tr_b16 a[18:19], v17 offset:4352
ds_read_b64_tr_b16 a[20:21], v17 offset:4128
ds_read_b64_tr_b16 a[22:23], v17 offset:4384
ds_read_b64_tr_b16 a[24:25], v17 offset:6144
ds_read_b64_tr_b16 a[26:27], v17 offset:6400
ds_read_b64_tr_b16 a[28:29], v17 offset:6176
ds_read_b64_tr_b16 a[30:31], v17 offset:6432
s_waitcnt lgkmcnt(0)
s_mov_b32 s44, 3145728
buffer_load_dword v250, v12, s[4:7], s44 offen
s_add_u32 m0, s45, 0
s_mov_b32 s44, 3145728
buffer_load_dwordx4 v16, s[4:7], s44 offen lds
s_add_u32 m0, s45, 1024
s_mov_b32 s44, 3276800
buffer_load_dwordx4 v16, s[4:7], s44 offen lds
s_add_u32 m0, s45, 2048
s_mov_b32 s44, 3407872
buffer_load_dwordx4 v16, s[4:7], s44 offen lds
s_add_u32 m0, s45, 3072
s_mov_b32 s44, 3538944
buffer_load_dwordx4 v16, s[4:7], s44 offen lds
s_add_u32 m0, s45, 4096
s_mov_b32 s44, 3670016
buffer_load_dwordx4 v16, s[4:7], s44 offen lds
s_add_u32 m0, s45, 5120
s_mov_b32 s44, 3801088
buffer_load_dwordx4 v16, s[4:7], s44 offen lds
s_add_u32 m0, s45, 6144
s_mov_b32 s44, 3932160
buffer_load_dwordx4 v16, s[4:7], s44 offen lds
s_add_u32 m0, s45, 7168
s_mov_b32 s44, 4063232
buffer_load_dwordx4 v16, s[4:7], s44 offen lds
ds_read_b128 v[20:23], v8 offset:0
ds_read_b128 v[24:27], v8 offset:2048
ds_read_b128 v[28:31], v9 offset:0
ds_read_b128 v[32:35], v9 offset:2048
ds_read_b128 v[36:39], v8 offset:4096
ds_read_b128 v[40:43], v8 offset:6144
ds_read_b128 v[44:47], v9 offset:4096
ds_read_b128 v[48:51], v9 offset:6144
s_waitcnt lgkmcnt(0)
v_mfma_f32_16x16x32_bf16 v[52:55], v[20:23], a[0:3], 0
v_mfma_f32_16x16x32_bf16 v[56:59], v[20:23], a[4:7], 0
v_mfma_f32_16x16x32_bf16 v[60:63], v[24:27], a[0:3], 0
v_mfma_f32_16x16x32_bf16 v[64:67], v[24:27], a[4:7], 0
v_mfma_f32_16x16x32_bf16 v[52:55], v[28:31], a[8:11], v[52:55]
v_mfma_f32_16x16x32_bf16 v[56:59], v[28:31], a[12:15], v[56:59]
v_mfma_f32_16x16x32_bf16 v[60:63], v[32:35], a[8:11], v[60:63]
v_mfma_f32_16x16x32_bf16 v[64:67], v[32:35], a[12:15], v[64:67]
v_mfma_f32_16x16x32_bf16 v[52:55], v[36:39], a[16:19], v[52:55]
v_mfma_f32_16x16x32_bf16 v[56:59], v[36:39], a[20:23], v[56:59]
v_mfma_f32_16x16x32_bf16 v[60:63], v[40:43], a[16:19], v[60:63]
v_mfma_f32_16x16x32_bf16 v[64:67], v[40:43], a[20:23], v[64:67]
v_mfma_f32_16x16x32_bf16 v[52:55], v[44:47], a[24:27], v[52:55]
v_mfma_f32_16x16x32_bf16 v[56:59], v[44:47], a[28:31], v[56:59]
v_mfma_f32_16x16x32_bf16 v[60:63], v[48:51], a[24:27], v[60:63]
v_mfma_f32_16x16x32_bf16 v[64:67], v[48:51], a[28:31], v[64:67]
s_waitcnt vmcnt(18)
ds_read_b64_tr_b16 a[32:33], v17 offset:8192
ds_read_b64_tr_b16 a[34:35], v17 offset:8448
ds_read_b64_tr_b16 a[36:37], v17 offset:8224
ds_read_b64_tr_b16 a[38:39], v17 offset:8480
ds_read_b64_tr_b16 a[40:41], v17 offset:10240
ds_read_b64_tr_b16 a[42:43], v17 offset:10496
ds_read_b64_tr_b16 a[44:45], v17 offset:10272
ds_read_b64_tr_b16 a[46:47], v17 offset:10528
s_waitcnt lgkmcnt(0)
ds_read_b64_tr_b16 a[48:49], v17 offset:12288
ds_read_b64_tr_b16 a[50:51], v17 offset:12544
ds_read_b64_tr_b16 a[52:53], v17 offset:12320
ds_read_b64_tr_b16 a[54:55], v17 offset:12576
ds_read_b64_tr_b16 a[56:57], v17 offset:14336
ds_read_b64_tr_b16 a[58:59], v17 offset:14592
ds_read_b64_tr_b16 a[60:61], v17 offset:14368
ds_read_b64_tr_b16 a[62:63], v17 offset:14624
s_waitcnt lgkmcnt(0)
s_mov_b32 s44, 4194304
buffer_load_dword v250, v12, s[4:7], s44 offen
s_add_u32 m0, s45, 8192
s_mov_b32 s44, 4194304
buffer_load_dwordx4 v16, s[4:7], s44 offen lds
s_add_u32 m0, s45, 9216
s_mov_b32 s44, 4325376
buffer_load_dwordx4 v16, s[4:7], s44 offen lds
s_add_u32 m0, s45, 10240
s_mov_b32 s44, 4456448
buffer_load_dwordx4 v16, s[4:7], s44 offen lds
s_add_u32 m0, s45, 11264
s_mov_b32 s44, 4587520
buffer_load_dwordx4 v16, s[4:7], s44 offen lds
s_add_u32 m0, s45, 12288
s_mov_b32 s44, 4718592
buffer_load_dwordx4 v16, s[4:7], s44 offen lds
s_add_u32 m0, s45, 13312
s_mov_b32 s44, 4849664
buffer_load_dwordx4 v16, s[4:7], s44 offen lds
s_add_u32 m0, s45, 14336
s_mov_b32 s44, 4980736
buffer_load_dwordx4 v16, s[4:7], s44 offen lds
s_add_u32 m0, s45, 15360
s_mov_b32 s44, 5111808
buffer_load_dwordx4 v16, s[4:7], s44 offen lds
ds_read_b128 v[20:23], v8 offset:8192
ds_read_b128 v[24:27], v8 offset:10240
ds_read_b128 v[28:31], v9 offset:8192
ds_read_b128 v[32:35], v9 offset:10240
ds_read_b128 v[36:39], v8 offset:12288
ds_read_b128 v[40:43], v8 offset:14336
ds_read_b128 v[44:47], v9 offset:12288
ds_read_b128 v[48:51], v9 offset:14336
s_waitcnt lgkmcnt(0)
v_mfma_f32_16x16x32_bf16 v[52:55], v[20:23], a[32:35], v[52:55]
v_mfma_f32_16x16x32_bf16 v[56:59], v[20:23], a[36:39], v[56:59]
v_mfma_f32_16x16x32_bf16 v[60:63], v[24:27], a[32:35], v[60:63]
v_mfma_f32_16x16x32_bf16 v[64:67], v[24:27], a[36:39], v[64:67]
v_mfma_f32_16x16x32_bf16 v[52:55], v[28:31], a[40:43], v[52:55]
v_mfma_f32_16x16x32_bf16 v[56:59], v[28:31], a[44:47], v[56:59]
v_mfma_f32_16x16x32_bf16 v[60:63], v[32:35], a[40:43], v[60:63]
v_mfma_f32_16x16x32_bf16 v[64:67], v[32:35], a[44:47], v[64:67]
v_mfma_f32_16x16x32_bf16 v[52:55], v[36:39], a[48:51], v[52:55]
v_mfma_f32_16x16x32_bf16 v[56:59], v[36:39], a[52:55], v[56:59]
v_mfma_f32_16x16x32_bf16 v[60:63], v[40:43], a[48:51], v[60:63]
v_mfma_f32_16x16x32_bf16 v[64:67], v[40:43], a[52:55], v[64:67]
v_mfma_f32_16x16x32_bf16 v[52:55], v[44:47], a[56:59], v[52:55]
v_mfma_f32_16x16x32_bf16 v[56:59], v[44:47], a[60:63], v[56:59]
v_mfma_f32_16x16x32_bf16 v[60:63], v[48:51], a[56:59], v[60:63]
v_mfma_f32_16x16x32_bf16 v[64:67], v[48:51], a[60:63], v[64:67]
s_waitcnt vmcnt(18)
ds_read_b64_tr_b16 a[64:65], v17 offset:16384
ds_read_b64_tr_b16 a[66:67], v17 offset:16640
ds_read_b64_tr_b16 a[68:69], v17 offset:16416
ds_read_b64_tr_b16 a[70:71], v17 offset:16672
ds_read_b64_tr_b16 a[72:73], v17 offset:18432
ds_read_b64_tr_b16 a[74:75], v17 offset:18688
ds_read_b64_tr_b16 a[76:77], v17 offset:18464
ds_read_b64_tr_b16 a[78:79], v17 offset:18720
s_waitcnt lgkmcnt(0)
ds_read_b64_tr_b16 a[80:81], v17 offset:20480
ds_read_b64_tr_b16 a[82:83], v17 offset:20736
ds_read_b64_tr_b16 a[84:85], v17 offset:20512
ds_read_b64_tr_b16 a[86:87], v17 offset:20768
ds_read_b64_tr_b16 a[88:89], v17 offset:22528
ds_read_b64_tr_b16 a[90:91], v17 offset:22784
ds_read_b64_tr_b16 a[92:93], v17 offset:22560
ds_read_b64_tr_b16 a[94:95], v17 offset:22816
s_waitcnt lgkmcnt(0)
s_mov_b32 s44, 5242880
buffer_load_dword v250, v12, s[4:7], s44 offen
s_add_u32 m0, s45, 16384
s_mov_b32 s44, 5242880
buffer_load_dwordx4 v16, s[4:7], s44 offen lds
s_add_u32 m0, s45, 17408
s_mov_b32 s44, 5373952
buffer_load_dwordx4 v16, s[4:7], s44 offen lds
s_add_u32 m0, s45, 18432
s_mov_b32 s44, 5505024
buffer_load_dwordx4 v16, s[4:7], s44 offen lds
s_add_u32 m0, s45, 19456
s_mov_b32 s44, 5636096
buffer_load_dwordx4 v16, s[4:7], s44 offen lds
s_add_u32 m0, s45, 20480
s_mov_b32 s44, 5767168
buffer_load_dwordx4 v16, s[4:7], s44 offen lds
s_add_u32 m0, s45, 21504
s_mov_b32 s44, 5898240
buffer_load_dwordx4 v16, s[4:7], s44 offen lds
s_add_u32 m0, s45, 22528
s_mov_b32 s44, 6029312
buffer_load_dwordx4 v16, s[4:7], s44 offen lds
s_add_u32 m0, s45, 23552
s_mov_b32 s44, 6160384
buffer_load_dwordx4 v16, s[4:7], s44 offen lds
ds_read_b128 v[20:23], v8 offset:16384
ds_read_b128 v[24:27], v8 offset:18432
ds_read_b128 v[28:31], v9 offset:16384
ds_read_b128 v[32:35], v9 offset:18432
ds_read_b128 v[36:39], v8 offset:20480
ds_read_b128 v[40:43], v8 offset:22528
ds_read_b128 v[44:47], v9 offset:20480
ds_read_b128 v[48:51], v9 offset:22528
s_waitcnt lgkmcnt(0)
v_mfma_f32_16x16x32_bf16 v[52:55], v[20:23], a[64:67], v[52:55]
v_mfma_f32_16x16x32_bf16 v[56:59], v[20:23], a[68:71], v[56:59]
v_mfma_f32_16x16x32_bf16 v[60:63], v[24:27], a[64:67], v[60:63]
v_mfma_f32_16x16x32_bf16 v[64:67], v[24:27], a[68:71], v[64:67]
v_mfma_f32_16x16x32_bf16 v[52:55], v[28:31], a[72:75], v[52:55]
v_mfma_f32_16x16x32_bf16 v[56:59], v[28:31], a[76:79], v[56:59]
v_mfma_f32_16x16x32_bf16 v[60:63], v[32:35], a[72:75], v[60:63]
v_mfma_f32_16x16x32_bf16 v[64:67], v[32:35], a[76:79], v[64:67]
v_mfma_f32_16x16x32_bf16 v[52:55], v[36:39], a[80:83], v[52:55]
v_mfma_f32_16x16x32_bf16 v[56:59], v[36:39], a[84:87], v[56:59]
v_mfma_f32_16x16x32_bf16 v[60:63], v[40:43], a[80:83], v[60:63]
v_mfma_f32_16x16x32_bf16 v[64:67], v[40:43], a[84:87], v[64:67]
v_mfma_f32_16x16x32_bf16 v[52:55], v[44:47], a[88:91], v[52:55]
v_mfma_f32_16x16x32_bf16 v[56:59], v[44:47], a[92:95], v[56:59]
v_mfma_f32_16x16x32_bf16 v[60:63], v[48:51], a[88:91], v[60:63]
v_mfma_f32_16x16x32_bf16 v[64:67], v[48:51], a[92:95], v[64:67]
s_waitcnt vmcnt(18)
ds_read_b64_tr_b16 a[96:97], v17 offset:0
ds_read_b64_tr_b16 a[98:99], v17 offset:256
ds_read_b64_tr_b16 a[100:101], v17 offset:32
ds_read_b64_tr_b16 a[102:103], v17 offset:288
ds_read_b64_tr_b16 a[104:105], v17 offset:2048
ds_read_b64_tr_b16 a[106:107], v17 offset:2304
ds_read_b64_tr_b16 a[108:109], v17 offset:2080
ds_read_b64_tr_b16 a[110:111], v17 offset:2336
s_waitcnt lgkmcnt(0)
ds_read_b64_tr_b16 a[112:113], v17 offset:4096
ds_read_b64_tr_b16 a[114:115], v17 offset:4352
ds_read_b64_tr_b16 a[116:117], v17 offset:4128
ds_read_b64_tr_b16 a[118:119], v17 offset:4384
ds_read_b64_tr_b16 a[120:121], v17 offset:6144
ds_read_b64_tr_b16 a[122:123], v17 offset:6400
ds_read_b64_tr_b16 a[124:125], v17 offset:6176
ds_read_b64_tr_b16 a[126:127], v17 offset:6432
s_waitcnt lgkmcnt(0)
s_mov_b32 s44, 6291456
buffer_load_dword v250, v12, s[4:7], s44 offen
s_add_u32 m0, s45, 0
s_mov_b32 s44, 6291456
buffer_load_dwordx4 v16, s[4:7], s44 offen lds
s_add_u32 m0, s45, 1024
s_mov_b32 s44, 6422528
buffer_load_dwordx4 v16, s[4:7], s44 offen lds
s_add_u32 m0, s45, 2048
s_mov_b32 s44, 6553600
buffer_load_dwordx4 v16, s[4:7], s44 offen lds
s_add_u32 m0, s45, 3072
s_mov_b32 s44, 6684672
buffer_load_dwordx4 v16, s[4:7], s44 offen lds
s_add_u32 m0, s45, 4096
s_mov_b32 s44, 6815744
buffer_load_dwordx4 v16, s[4:7], s44 offen lds
s_add_u32 m0, s45, 5120
s_mov_b32 s44, 6946816
buffer_load_dwordx4 v16, s[4:7], s44 offen lds
s_add_u32 m0, s45, 6144
s_mov_b32 s44, 7077888
buffer_load_dwordx4 v16, s[4:7], s44 offen lds
s_add_u32 m0, s45, 7168
s_mov_b32 s44, 7208960
buffer_load_dwordx4 v16, s[4:7], s44 offen lds
ds_read_b128 v[20:23], v8 offset:24576
ds_read_b128 v[24:27], v8 offset:26624
ds_read_b128 v[28:31], v9 offset:24576
ds_read_b128 v[32:35], v9 offset:26624
ds_read_b128 v[36:39], v8 offset:28672
ds_read_b128 v[40:43], v8 offset:30720
ds_read_b128 v[44:47], v9 offset:28672
ds_read_b128 v[48:51], v9 offset:30720
s_waitcnt lgkmcnt(0)
v_mfma_f32_16x16x32_bf16 v[52:55], v[20:23], a[96:99], v[52:55]
v_mfma_f32_16x16x32_bf16 v[56:59], v[20:23], a[100:103], v[56:59]
v_mfma_f32_16x16x32_bf16 v[60:63], v[24:27], a[96:99], v[60:63]
v_mfma_f32_16x16x32_bf16 v[64:67], v[24:27], a[100:103], v[64:67]
v_mfma_f32_16x16x32_bf16 v[52:55], v[28:31], a[104:107], v[52:55]
v_mfma_f32_16x16x32_bf16 v[56:59], v[28:31], a[108:111], v[56:59]
v_mfma_f32_16x16x32_bf16 v[60:63], v[32:35], a[104:107], v[60:63]
v_mfma_f32_16x16x32_bf16 v[64:67], v[32:35], a[108:111], v[64:67]
v_mfma_f32_16x16x32_bf16 v[52:55], v[36:39], a[112:115], v[52:55]
v_mfma_f32_16x16x32_bf16 v[56:59], v[36:39], a[116:119], v[56:59]
v_mfma_f32_16x16x32_bf16 v[60:63], v[40:43], a[112:115], v[60:63]
v_mfma_f32_16x16x32_bf16 v[64:67], v[40:43], a[116:119], v[64:67]
v_mfma_f32_16x16x32_bf16 v[52:55], v[44:47], a[120:123], v[52:55]
v_mfma_f32_16x16x32_bf16 v[56:59], v[44:47], a[124:127], v[56:59]
v_mfma_f32_16x16x32_bf16 v[60:63], v[48:51], a[120:123], v[60:63]
v_mfma_f32_16x16x32_bf16 v[64:67], v[48:51], a[124:127], v[64:67]
s_waitcnt vmcnt(18)
ds_read_b64_tr_b16 a[128:129], v17 offset:8192
ds_read_b64_tr_b16 a[130:131], v17 offset:8448
ds_read_b64_tr_b16 a[132:133], v17 offset:8224
ds_read_b64_tr_b16 a[134:135], v17 offset:8480
ds_read_b64_tr_b16 a[136:137], v17 offset:10240
ds_read_b64_tr_b16 a[138:139], v17 offset:10496
ds_read_b64_tr_b16 a[140:141], v17 offset:10272
ds_read_b64_tr_b16 a[142:143], v17 offset:10528
s_waitcnt lgkmcnt(0)
ds_read_b64_tr_b16 a[144:145], v17 offset:12288
ds_read_b64_tr_b16 a[146:147], v17 offset:12544
ds_read_b64_tr_b16 a[148:149], v17 offset:12320
ds_read_b64_tr_b16 a[150:151], v17 offset:12576
ds_read_b64_tr_b16 a[152:153], v17 offset:14336
ds_read_b64_tr_b16 a[154:155], v17 offset:14592
ds_read_b64_tr_b16 a[156:157], v17 offset:14368
ds_read_b64_tr_b16 a[158:159], v17 offset:14624
s_waitcnt lgkmcnt(0)
s_mov_b32 s44, 7340032
buffer_load_dword v250, v12, s[4:7], s44 offen
s_add_u32 m0, s45, 8192
s_mov_b32 s44, 7340032
buffer_load_dwordx4 v16, s[4:7], s44 offen lds
s_add_u32 m0, s45, 9216
s_mov_b32 s44, 7471104
buffer_load_dwordx4 v16, s[4:7], s44 offen lds
s_add_u32 m0, s45, 10240
s_mov_b32 s44, 7602176
buffer_load_dwordx4 v16, s[4:7], s44 offen lds
s_add_u32 m0, s45, 11264
s_mov_b32 s44, 7733248
buffer_load_dwordx4 v16, s[4:7], s44 offen lds
s_add_u32 m0, s45, 12288
s_mov_b32 s44, 7864320
buffer_load_dwordx4 v16, s[4:7], s44 offen lds
s_add_u32 m0, s45, 13312
s_mov_b32 s44, 7995392
buffer_load_dwordx4 v16, s[4:7], s44 offen lds
s_add_u32 m0, s45, 14336
s_mov_b32 s44, 8126464
buffer_load_dwordx4 v16, s[4:7], s44 offen lds
s_add_u32 m0, s45, 15360
s_mov_b32 s44, 8257536
buffer_load_dwordx4 v16, s[4:7], s44 offen lds
ds_read_b128 v[20:23], v8 offset:32768
ds_read_b128 v[24:27], v8 offset:34816
ds_read_b128 v[28:31], v9 offset:32768
ds_read_b128 v[32:35], v9 offset:34816
ds_read_b128 v[36:39], v8 offset:36864
ds_read_b128 v[40:43], v8 offset:38912
ds_read_b128 v[44:47], v9 offset:36864
ds_read_b128 v[48:51], v9 offset:38912
s_waitcnt lgkmcnt(0)
v_mfma_f32_16x16x32_bf16 v[52:55], v[20:23], a[128:131], v[52:55]
v_mfma_f32_16x16x32_bf16 v[56:59], v[20:23], a[132:135], v[56:59]
v_mfma_f32_16x16x32_bf16 v[60:63], v[24:27], a[128:131], v[60:63]
v_mfma_f32_16x16x32_bf16 v[64:67], v[24:27], a[132:135], v[64:67]
v_mfma_f32_16x16x32_bf16 v[52:55], v[28:31], a[136:139], v[52:55]
v_mfma_f32_16x16x32_bf16 v[56:59], v[28:31], a[140:143], v[56:59]
v_mfma_f32_16x16x32_bf16 v[60:63], v[32:35], a[136:139], v[60:63]
v_mfma_f32_16x16x32_bf16 v[64:67], v[32:35], a[140:143], v[64:67]
v_mfma_f32_16x16x32_bf16 v[52:55], v[36:39], a[144:147], v[52:55]
v_mfma_f32_16x16x32_bf16 v[56:59], v[36:39], a[148:151], v[56:59]
v_mfma_f32_16x16x32_bf16 v[60:63], v[40:43], a[144:147], v[60:63]
v_mfma_f32_16x16x32_bf16 v[64:67], v[40:43], a[148:151], v[64:67]
v_mfma_f32_16x16x32_bf16 v[52:55], v[44:47], a[152:155], v[52:55]
v_mfma_f32_16x16x32_bf16 v[56:59], v[44:47], a[156:159], v[56:59]
v_mfma_f32_16x16x32_bf16 v[60:63], v[48:51], a[152:155], v[60:63]
v_mfma_f32_16x16x32_bf16 v[64:67], v[48:51], a[156:159], v[64:67]
s_waitcnt vmcnt(18)
ds_read_b64_tr_b16 a[160:161], v17 offset:16384
ds_read_b64_tr_b16 a[162:163], v17 offset:16640
ds_read_b64_tr_b16 a[164:165], v17 offset:16416
ds_read_b64_tr_b16 a[166:167], v17 offset:16672
ds_read_b64_tr_b16 a[168:169], v17 offset:18432
ds_read_b64_tr_b16 a[170:171], v17 offset:18688
ds_read_b64_tr_b16 a[172:173], v17 offset:18464
ds_read_b64_tr_b16 a[174:175], v17 offset:18720
s_waitcnt lgkmcnt(0)
ds_read_b64_tr_b16 a[176:177], v17 offset:20480
ds_read_b64_tr_b16 a[178:179], v17 offset:20736
ds_read_b64_tr_b16 a[180:181], v17 offset:20512
ds_read_b64_tr_b16 a[182:183], v17 offset:20768
ds_read_b64_tr_b16 a[184:185], v17 offset:22528
ds_read_b64_tr_b16 a[186:187], v17 offset:22784
ds_read_b64_tr_b16 a[188:189], v17 offset:22560
ds_read_b64_tr_b16 a[190:191], v17 offset:22816
s_waitcnt lgkmcnt(0)
ds_read_b128 v[20:23], v8 offset:40960
ds_read_b128 v[24:27], v8 offset:43008
ds_read_b128 v[28:31], v9 offset:40960
ds_read_b128 v[32:35], v9 offset:43008
ds_read_b128 v[36:39], v8 offset:45056
ds_read_b128 v[40:43], v8 offset:47104
ds_read_b128 v[44:47], v9 offset:45056
ds_read_b128 v[48:51], v9 offset:47104
s_waitcnt lgkmcnt(0)
v_mfma_f32_16x16x32_bf16 v[52:55], v[20:23], a[160:163], v[52:55]
v_mfma_f32_16x16x32_bf16 v[56:59], v[20:23], a[164:167], v[56:59]
v_mfma_f32_16x16x32_bf16 v[60:63], v[24:27], a[160:163], v[60:63]
v_mfma_f32_16x16x32_bf16 v[64:67], v[24:27], a[164:167], v[64:67]
v_mfma_f32_16x16x32_bf16 v[52:55], v[28:31], a[168:171], v[52:55]
v_mfma_f32_16x16x32_bf16 v[56:59], v[28:31], a[172:175], v[56:59]
v_mfma_f32_16x16x32_bf16 v[60:63], v[32:35], a[168:171], v[60:63]
v_mfma_f32_16x16x32_bf16 v[64:67], v[32:35], a[172:175], v[64:67]
v_mfma_f32_16x16x32_bf16 v[52:55], v[36:39], a[176:179], v[52:55]
v_mfma_f32_16x16x32_bf16 v[56:59], v[36:39], a[180:183], v[56:59]
v_mfma_f32_16x16x32_bf16 v[60:63], v[40:43], a[176:179], v[60:63]
v_mfma_f32_16x16x32_bf16 v[64:67], v[40:43], a[180:183], v[64:67]
v_mfma_f32_16x16x32_bf16 v[52:55], v[44:47], a[184:187], v[52:55]
v_mfma_f32_16x16x32_bf16 v[56:59], v[44:47], a[188:191], v[56:59]
v_mfma_f32_16x16x32_bf16 v[60:63], v[48:51], a[184:187], v[60:63]
v_mfma_f32_16x16x32_bf16 v[64:67], v[48:51], a[188:191], v[64:67]
s_waitcnt vmcnt(9)
ds_read_b64_tr_b16 a[192:193], v17 offset:0
ds_read_b64_tr_b16 a[194:195], v17 offset:256
ds_read_b64_tr_b16 a[196:197], v17 offset:32
ds_read_b64_tr_b16 a[198:199], v17 offset:288
ds_read_b64_tr_b16 a[200:201], v17 offset:2048
ds_read_b64_tr_b16 a[202:203], v17 offset:2304
ds_read_b64_tr_b16 a[204:205], v17 offset:2080
ds_read_b64_tr_b16 a[206:207], v17 offset:2336
s_waitcnt lgkmcnt(0)
ds_read_b64_tr_b16 a[208:209], v17 offset:4096
ds_read_b64_tr_b16 a[210:211], v17 offset:4352
ds_read_b64_tr_b16 a[212:213], v17 offset:4128
ds_read_b64_tr_b16 a[214:215], v17 offset:4384
ds_read_b64_tr_b16 a[216:217], v17 offset:6144
ds_read_b64_tr_b16 a[218:219], v17 offset:6400
ds_read_b64_tr_b16 a[220:221], v17 offset:6176
ds_read_b64_tr_b16 a[222:223], v17 offset:6432
s_waitcnt lgkmcnt(0)
ds_read_b128 v[20:23], v8 offset:49152
ds_read_b128 v[24:27], v8 offset:51200
ds_read_b128 v[28:31], v9 offset:49152
ds_read_b128 v[32:35], v9 offset:51200
ds_read_b128 v[36:39], v8 offset:53248
ds_read_b128 v[40:43], v8 offset:55296
ds_read_b128 v[44:47], v9 offset:53248
ds_read_b128 v[48:51], v9 offset:55296
s_waitcnt lgkmcnt(0)
v_mfma_f32_16x16x32_bf16 v[52:55], v[20:23], a[192:195], v[52:55]
v_mfma_f32_16x16x32_bf16 v[56:59], v[20:23], a[196:199], v[56:59]
v_mfma_f32_16x16x32_bf16 v[60:63], v[24:27], a[192:195], v[60:63]
v_mfma_f32_16x16x32_bf16 v[64:67], v[24:27], a[196:199], v[64:67]
v_mfma_f32_16x16x32_bf16 v[52:55], v[28:31], a[200:203], v[52:55]
v_mfma_f32_16x16x32_bf16 v[56:59], v[28:31], a[204:207], v[56:59]
v_mfma_f32_16x16x32_bf16 v[60:63], v[32:35], a[200:203], v[60:63]
v_mfma_f32_16x16x32_bf16 v[64:67], v[32:35], a[204:207], v[64:67]
v_mfma_f32_16x16x32_bf16 v[52:55], v[36:39], a[208:211], v[52:55]
v_mfma_f32_16x16x32_bf16 v[56:59], v[36:39], a[212:215], v[56:59]
v_mfma_f32_16x16x32_bf16 v[60:63], v[40:43], a[208:211], v[60:63]
v_mfma_f32_16x16x32_bf16 v[64:67], v[40:43], a[212:215], v[64:67]
v_mfma_f32_16x16x32_bf16 v[52:55], v[44:47], a[216:219], v[52:55]
v_mfma_f32_16x16x32_bf16 v[56:59], v[44:47], a[220:223], v[56:59]
v_mfma_f32_16x16x32_bf16 v[60:63], v[48:51], a[216:219], v[60:63]
v_mfma_f32_16x16x32_bf16 v[64:67], v[48:51], a[220:223], v[64:67]
s_waitcnt vmcnt(0)
ds_read_b64_tr_b16 a[224:225], v17 offset:8192
ds_read_b64_tr_b16 a[226:227], v17 offset:8448
ds_read_b64_tr_b16 a[228:229], v17 offset:8224
ds_read_b64_tr_b16 a[230:231], v17 offset:8480
ds_read_b64_tr_b16 a[232:233], v17 offset:10240
ds_read_b64_tr_b16 a[234:235], v17 offset:10496
ds_read_b64_tr_b16 a[236:237], v17 offset:10272
ds_read_b64_tr_b16 a[238:239], v17 offset:10528
s_waitcnt lgkmcnt(0)
ds_read_b64_tr_b16 a[240:241], v17 offset:12288
ds_read_b64_tr_b16 a[242:243], v17 offset:12544
ds_read_b64_tr_b16 a[244:245], v17 offset:12320
ds_read_b64_tr_b16 a[246:247], v17 offset:12576
ds_read_b64_tr_b16 a[248:249], v17 offset:14336
ds_read_b64_tr_b16 a[250:251], v17 offset:14592
ds_read_b64_tr_b16 a[252:253], v17 offset:14368
ds_read_b64_tr_b16 a[254:255], v17 offset:14624
s_waitcnt lgkmcnt(0)
ds_read_b128 v[20:23], v8 offset:57344
ds_read_b128 v[24:27], v8 offset:59392
ds_read_b128 v[28:31], v9 offset:57344
ds_read_b128 v[32:35], v9 offset:59392
ds_read_b128 v[36:39], v8 offset:61440
ds_read_b128 v[40:43], v8 offset:63488
ds_read_b128 v[44:47], v9 offset:61440
ds_read_b128 v[48:51], v9 offset:63488
s_waitcnt lgkmcnt(0)
v_mfma_f32_16x16x32_bf16 v[52:55], v[20:23], a[224:227], v[52:55]
v_mfma_f32_16x16x32_bf16 v[56:59], v[20:23], a[228:231], v[56:59]
v_mfma_f32_16x16x32_bf16 v[60:63], v[24:27], a[224:227], v[60:63]
v_mfma_f32_16x16x32_bf16 v[64:67], v[24:27], a[228:231], v[64:67]
v_mfma_f32_16x16x32_bf16 v[52:55], v[28:31], a[232:235], v[52:55]
v_mfma_f32_16x16x32_bf16 v[56:59], v[28:31], a[236:239], v[56:59]
v_mfma_f32_16x16x32_bf16 v[60:63], v[32:35], a[232:235], v[60:63]
v_mfma_f32_16x16x32_bf16 v[64:67], v[32:35], a[236:239], v[64:67]
v_mfma_f32_16x16x32_bf16 v[52:55], v[36:39], a[240:243], v[52:55]
v_mfma_f32_16x16x32_bf16 v[56:59], v[36:39], a[244:247], v[56:59]
v_mfma_f32_16x16x32_bf16 v[60:63], v[40:43], a[240:243], v[60:63]
v_mfma_f32_16x16x32_bf16 v[64:67], v[40:43], a[244:247], v[64:67]
v_mfma_f32_16x16x32_bf16 v[52:55], v[44:47], a[248:251], v[52:55]
v_mfma_f32_16x16x32_bf16 v[56:59], v[44:47], a[252:255], v[56:59]
v_mfma_f32_16x16x32_bf16 v[60:63], v[48:51], a[248:251], v[60:63]
v_mfma_f32_16x16x32_bf16 v[64:67], v[48:51], a[252:255], v[64:67]
s_barrier
s_mov_b32 s50, 0x10000
s_add_u32 m0, s46, 65536
s_nop 0
buffer_load_dwordx4 v6, s[8:11], s50 offen offset:0 lds
s_add_u32 m0, s46, 69504
s_nop 0
buffer_load_dwordx4 v6, s[8:11], s50 offen offset:128 lds
s_add_u32 m0, s46, 73472
s_nop 0
buffer_load_dwordx4 v6, s[8:11], s50 offen offset:256 lds
s_add_u32 m0, s46, 77440
s_nop 0
buffer_load_dwordx4 v6, s[8:11], s50 offen offset:384 lds
s_add_u32 m0, s46, 81408
s_nop 0
buffer_load_dwordx4 v6, s[8:11], s50 offen offset:512 lds
s_add_u32 m0, s46, 85376
s_nop 0
buffer_load_dwordx4 v6, s[8:11], s50 offen offset:640 lds
s_add_u32 m0, s46, 89344
s_nop 0
buffer_load_dwordx4 v6, s[8:11], s50 offen offset:768 lds
s_add_u32 m0, s46, 93312
s_nop 0
buffer_load_dwordx4 v6, s[8:11], s50 offen offset:896 lds
s_add_u32 m0, s46, 97280
s_nop 0
buffer_load_dwordx4 v6, s[8:11], s50 offen offset:1024 lds
s_add_u32 m0, s46, 101248
s_nop 0
buffer_load_dwordx4 v6, s[8:11], s50 offen offset:1152 lds
s_add_u32 m0, s46, 105216
s_nop 0
buffer_load_dwordx4 v6, s[8:11], s50 offen offset:1280 lds
s_add_u32 m0, s46, 109184
s_nop 0
buffer_load_dwordx4 v6, s[8:11], s50 offen offset:1408 lds
s_add_u32 m0, s46, 113152
s_nop 0
buffer_load_dwordx4 v6, s[8:11], s50 offen offset:1536 lds
s_add_u32 m0, s46, 117120
s_nop 0
buffer_load_dwordx4 v6, s[8:11], s50 offen offset:1664 lds
s_add_u32 m0, s46, 121088
s_nop 0
buffer_load_dwordx4 v6, s[8:11], s50 offen offset:1792 lds
s_add_u32 m0, s46, 125056
s_nop 0
buffer_load_dwordx4 v6, s[8:11], s50 offen offset:1920 lds
s_and_b32 s53, s47, 31
s_lshl_b32 s53, s53, 4
v_add_u32 v19, s53, v1
v_lshlrev_b32 v19, 7, v19
s_mov_b32 s42, 1
v_and_b32 v3, 15, v0
v_lshlrev_b32 v3, 4, v3
s_branch mega_kernel_syv
mega_kernel_syvw:
s_sleep 4
mega_kernel_syv:
buffer_load_dword v2, v3, s[72:75], 0 offen sc1
s_waitcnt vmcnt(0)
mega_kernel_syvp:
s_cmp_eq_u32 s95, 1
s_cbranch_scc0 mega_kernel_syvf
v_readlane_b32 s76, v2, 14
s_mov_b32 s98, 0
s_cmp_eq_u32 s76, 32
s_cbranch_scc0 mega_kernel_syvw
s_branch mega_kernel_syvd
mega_kernel_syvf:
s_mov_b32 s77, 0
s_mov_b32 s78, 0
v_readlane_b32 s76, v2, 0
s_add_u32 s77, s77, s76
s_xor_b32 s76, s76, 32
s_or_b32 s78, s78, s76
v_readlane_b32 s76, v2, 1
s_add_u32 s77, s77, s76
s_xor_b32 s76, s76, 32
s_or_b32 s78, s78, s76
v_readlane_b32 s76, v2, 2
s_add_u32 s77, s77, s76
s_xor_b32 s76, s76, 32
s_or_b32 s78, s78, s76
v_readlane_b32 s76, v2, 3
s_add_u32 s77, s77, s76
s_xor_b32 s76, s76, 32
s_or_b32 s78, s78, s76
v_readlane_b32 s76, v2, 4
s_add_u32 s77, s77, s76
s_xor_b32 s76, s76, 32
s_or_b32 s78, s78, s76
v_readlane_b32 s76, v2, 5
s_add_u32 s77, s77, s76
s_xor_b32 s76, s76, 32
s_or_b32 s78, s78, s76
v_readlane_b32 s76, v2, 6
s_add_u32 s77, s77, s76
s_xor_b32 s76, s76, 32
s_or_b32 s78, s78, s76
v_readlane_b32 s76, v2, 7
s_add_u32 s77, s77, s76
s_xor_b32 s76, s76, 32
s_or_b32 s78, s78, s76
s_cmp_eq_u32 s77, 256
s_cbranch_scc0 mega_kernel_syvw
v_mov_b32 v252, v2
s_cmp_eq_u32 s78, 0
s_cbranch_scc0 mega_kernel_slowent
v_readlane_b32 s76, v2, 10
v_readlane_b32 s77, v2, 8
s_cmp_eq_u32 s76, 32
s_cbranch_scc0 mega_kernel_syvw
s_cmp_gt_u32 s77, 16
s_cselect_b32 s98, 1, 0
mega_kernel_syvd:
s_lshr_b32 s44, s47, 3
s_xor_b32 s44, s44, s98
s_and_b32 s44, s44, 1
s_lshl_b32 s44, s44, 13
s_lshl_b32 s48, s47, 18
s_add_u32 s48, s48, s44
s_add_u32 s48, s48, 33554432
s_xor_b32 s44, s98, 1
s_lshl_b32 s44, s44, 13
s_lshl_b32 s49, s40, 7
s_add_u32 s49, s49, s44
s_lshl_b32 s44, s41, 2
s_add_u32 s49, s49, s44
s_add_u32 s49, s49, 69210112
v_mov_b32 v16, 0
v_cvt_pk_bf16_f32 v84, v52, v53
v_cvt_pk_bf16_f32 v85, v54, v55
v_cvt_pk_bf16_f32 v86, v60, v61
v_cvt_pk_bf16_f32 v87, v62, v63
v_cvt_pk_bf16_f32 v88, v56, v57
v_cvt_pk_bf16_f32 v89, v58, v59
v_cvt_pk_bf16_f32 v90, v64, v65
v_cvt_pk_bf16_f32 v91, v66, v67
s_add_u32 s51, s42, s47
s_sub_u32 s51, s51, 1
s_bfe_u32 s52, s51, 0x40002
s_lshl_b32 s52, s52, 14
s_and_b32 s51, s51, 3
s_lshl_b32 s51, s51, 11
s_add_u32 s51, s51, s52
s_add_u32 s51, s51, s48
buffer_store_dwordx4 v[84:87], v7, s[84:87], s51 offen sc1
buffer_store_dwordx4 v[88:91], v7, s[84:87], s51 offen offset:1024 sc1
s_waitcnt vmcnt(0)
v_mov_b32 v17, s42
s_mov_b64 exec, 1
buffer_store_dword v17, v16, s[84:87], s49 offen sc1
s_mov_b64 exec, -1
mega_kernel_v_loop:
s_waitcnt vmcnt(2)
s_barrier
s_add_u32 s50, s42, 1
s_min_u32 s50, s50, 63
s_lshl_b32 s50, s50, 16
ds_read_b128 v[20:23], v10 offset:0
ds_read_b128 v[24:27], v10 offset:2048
ds_read_b128 v[28:31], v11 offset:0
ds_read_b128 v[32:35], v11 offset:2048
ds_read_b128 v[36:39], v10 offset:4096
ds_read_b128 v[40:43], v10 offset:6144
s_waitcnt lgkmcnt(4)
v_mfma_f32_16x16x32_bf16 v[68:71], v[20:23], a[0:3], 0
ds_read_b128 v[44:47], v11 offset:4096
v_mfma_f32_16x16x32_bf16 v[72:75], v[20:23], a[4:7], 0
v_cvt_pk_bf16_f32 v84, v52, v53
v_cvt_pk_bf16_f32 v85, v54, v55
v_cvt_pk_bf16_f32 v86, v60, v61
v_mfma_f32_16x16x32_bf16 v[76:79], v[24:27], a[0:3], 0
ds_read_b128 v[48:51], v11 offset:6144
v_mfma_f32_16x16x32_bf16 v[80:83], v[24:27], a[4:7], 0
v_cvt_pk_bf16_f32 v87, v62, v63
v_cvt_pk_bf16_f32 v88, v56, v57
v_cvt_pk_bf16_f32 v89, v58, v59
s_waitcnt lgkmcnt(4)
v_mfma_f32_16x16x32_bf16 v[68:71], v[28:31], a[8:11], v[68:71]
ds_read_b128 v[20:23], v10 offset:8192
v_mfma_f32_16x16x32_bf16 v[72:75], v[28:31], a[12:15], v[72:75]
v_cvt_pk_bf16_f32 v90, v64, v65
v_cvt_pk_bf16_f32 v91, v66, v67
v_mfma_f32_16x16x32_bf16 v[76:79], v[32:35], a[8:11], v[76:79]
ds_read_b128 v[24:27], v10 offset:10240
v_mfma_f32_16x16x32_bf16 v[80:83], v[32:35], a[12:15], v[80:83]
s_add_u32 s51, s42, s47
s_sub_u32 s51, s51, 1
s_bfe_u32 s52, s51, 0x40002
s_lshl_b32 s52, s52, 14
s_waitcnt lgkmcnt(4)
v_mfma_f32_16x16x32_bf16 v[68:71], v[36:39], a[16:19], v[68:71]
ds_read_b128 v[28:31], v11 offset:8192
v_mfma_f32_16x16x32_bf16 v[72:75], v[36:39], a[20:23], v[72:75]
s_and_b32 s51, s51, 3
s_lshl_b32 s51, s51, 11
s_add_u32 s51, s51, s52
s_add_u32 s51, s51, s48
buffer_store_dwordx4 v[84:87], v7, s[84:87], s51 offen sc1
v_mfma_f32_16x16x32_bf16 v[76:79], v[40:43], a[16:19], v[76:79]
ds_read_b128 v[32:35], v11 offset:10240
v_mfma_f32_16x16x32_bf16 v[80:83], v[40:43], a[20:23], v[80:83]
buffer_store_dwordx4 v[88:91], v7, s[84:87], s51 offen offset:1024 sc1
s_waitcnt lgkmcnt(4)
v_mfma_f32_16x16x32_bf16 v[68:71], v[44:47], a[24:27], v[68:71]
ds_read_b128 v[36:39], v10 offset:12288
v_mfma_f32_16x16x32_bf16 v[72:75], v[44:47], a[28:31], v[72:75]
s_add_u32 m0, s46, 0
v_mfma_f32_16x16x32_bf16 v[76:79], v[48:51], a[24:27], v[76:79]
ds_read_b128 v[40:43], v10 offset:14336
v_mfma_f32_16x16x32_bf16 v[80:83], v[48:51], a[28:31], v[80:83]
buffer_load_dwordx4 v6, s[8:11], s50 offen offset:0 lds
s_waitcnt lgkmcnt(4)
v_mfma_f32_16x16x32_bf16 v[68:71], v[20:23], a[32:35], v[68:71]
ds_read_b128 v[44:47], v11 offset:12288
v_mfma_f32_16x16x32_bf16 v[72:75], v[20:23], a[36:39], v[72:75]
s_add_u32 m0, s46, 3968
v_mfma_f32_16x16x32_bf16 v[76:79], v[24:27], a[32:35], v[76:79]
ds_read_b128 v[48:51], v11 offset:14336
v_mfma_f32_16x16x32_bf16 v[80:83], v[24:27], a[36:39], v[80:83]
buffer_load_dwordx4 v6, s[8:11], s50 offen offset:128 lds
s_waitcnt lgkmcnt(4)
v_mfma_f32_16x16x32_bf16 v[68:71], v[28:31], a[40:43], v[68:71]
ds_read_b128 v[20:23], v10 offset:16384
v_mfma_f32_16x16x32_bf16 v[72:75], v[28:31], a[44:47], v[72:75]
s_add_u32 m0, s46, 7936
v_mfma_f32_16x16x32_bf16 v[76:79], v[32:35], a[40:43], v[76:79]
ds_read_b128 v[24:27], v10 offset:18432
v_mfma_f32_16x16x32_bf16 v[80:83], v[32:35], a[44:47], v[80:83]
buffer_load_dwordx4 v6, s[8:11], s50 offen offset:256 lds
s_waitcnt lgkmcnt(4)
v_mfma_f32_16x16x32_bf16 v[68:71], v[36:39], a[48:51], v[68:71]
ds_read_b128 v[28:31], v11 offset:16384
v_mfma_f32_16x16x32_bf16 v[72:75], v[36:39], a[52:55], v[72:75]
s_add_u32 m0, s46, 11904
v_mfma_f32_16x16x32_bf16 v[76:79], v[40:43], a[48:51], v[76:79]
ds_read_b128 v[32:35], v11 offset:18432
v_mfma_f32_16x16x32_bf16 v[80:83], v[40:43], a[52:55], v[80:83]
buffer_load_dwordx4 v6, s[8:11], s50 offen offset:384 lds
s_waitcnt lgkmcnt(4)
v_mfma_f32_16x16x32_bf16 v[68:71], v[44:47], a[56:59], v[68:71]
ds_read_b128 v[36:39], v10 offset:20480
v_mfma_f32_16x16x32_bf16 v[72:75], v[44:47], a[60:63], v[72:75]
s_add_u32 m0, s46, 15872
v_mfma_f32_16x16x32_bf16 v[76:79], v[48:51], a[56:59], v[76:79]
ds_read_b128 v[40:43], v10 offset:22528
v_mfma_f32_16x16x32_bf16 v[80:83], v[48:51], a[60:63], v[80:83]
buffer_load_dwordx4 v6, s[8:11], s50 offen offset:512 lds
s_waitcnt lgkmcnt(4)
v_mfma_f32_16x16x32_bf16 v[68:71], v[20:23], a[64:67], v[68:71]
ds_read_b128 v[44:47], v11 offset:20480
v_mfma_f32_16x16x32_bf16 v[72:75], v[20:23], a[68:71], v[72:75]
s_add_u32 m0, s46, 19840
v_mfma_f32_16x16x32_bf16 v[76:79], v[24:27], a[64:67], v[76:79]
ds_read_b128 v[48:51], v11 offset:22528
v_mfma_f32_16x16x32_bf16 v[80:83], v[24:27], a[68:71], v[80:83]
buffer_load_dwordx4 v6, s[8:11], s50 offen offset:640 lds
s_waitcnt lgkmcnt(4)
v_mfma_f32_16x16x32_bf16 v[68:71], v[28:31], a[72:75], v[68:71]
ds_read_b128 v[20:23], v10 offset:24576
v_mfma_f32_16x16x32_bf16 v[72:75], v[28:31], a[76:79], v[72:75]
s_add_u32 m0, s46, 23808
v_mfma_f32_16x16x32_bf16 v[76:79], v[32:35], a[72:75], v[76:79]
ds_read_b128 v[24:27], v10 offset:26624
v_mfma_f32_16x16x32_bf16 v[80:83], v[32:35], a[76:79], v[80:83]
buffer_load_dwordx4 v6, s[8:11], s50 offen offset:768 lds
s_waitcnt lgkmcnt(4)
v_mfma_f32_16x16x32_bf16 v[68:71], v[36:39], a[80:83], v[68:71]
ds_read_b128 v[28:31], v11 offset:24576
v_mfma_f32_16x16x32_bf16 v[72:75], v[36:39], a[84:87], v[72:75]
s_add_u32 m0, s46, 27776
v_mfma_f32_16x16x32_bf16 v[76:79], v[40:43], a[80:83], v[76:79]
ds_read_b128 v[32:35], v11 offset:26624
v_mfma_f32_16x16x32_bf16 v[80:83], v[40:43], a[84:87], v[80:83]
buffer_load_dwordx4 v6, s[8:11], s50 offen offset:896 lds
s_waitcnt lgkmcnt(4)
v_mfma_f32_16x16x32_bf16 v[68:71], v[44:47], a[88:91], v[68:71]
ds_read_b128 v[36:39], v10 offset:28672
v_mfma_f32_16x16x32_bf16 v[72:75], v[44:47], a[92:95], v[72:75]
s_add_u32 m0, s46, 31744
v_mfma_f32_16x16x32_bf16 v[76:79], v[48:51], a[88:91], v[76:79]
ds_read_b128 v[40:43], v10 offset:30720
v_mfma_f32_16x16x32_bf16 v[80:83], v[48:51], a[92:95], v[80:83]
buffer_load_dwordx4 v6, s[8:11], s50 offen offset:1024 lds
s_waitcnt lgkmcnt(4)
v_mfma_f32_16x16x32_bf16 v[68:71], v[20:23], a[96:99], v[68:71]
ds_read_b128 v[44:47], v11 offset:28672
v_mfma_f32_16x16x32_bf16 v[72:75], v[20:23], a[100:103], v[72:75]
s_add_u32 m0, s46, 35712
v_mfma_f32_16x16x32_bf16 v[76:79], v[24:27], a[96:99], v[76:79]
ds_read_b128 v[48:51], v11 offset:30720
v_mfma_f32_16x16x32_bf16 v[80:83], v[24:27], a[100:103], v[80:83]
buffer_load_dwordx4 v6, s[8:11], s50 offen offset:1152 lds
s_waitcnt lgkmcnt(4)
v_mfma_f32_16x16x32_bf16 v[68:71], v[28:31], a[104:107], v[68:71]
ds_read_b128 v[20:23], v10 offset:32768
v_mfma_f32_16x16x32_bf16 v[72:75], v[28:31], a[108:111], v[72:75]
s_add_u32 m0, s46, 39680
v_mfma_f32_16x16x32_bf16 v[76:79], v[32:35], a[104:107], v[76:79]
ds_read_b128 v[24:27], v10 offset:34816
v_mfma_f32_16x16x32_bf16 v[80:83], v[32:35], a[108:111], v[80:83]
buffer_load_dwordx4 v6, s[8:11], s50 offen offset:1280 lds
s_waitcnt lgkmcnt(4)
v_mfma_f32_16x16x32_bf16 v[68:71], v[36:39], a[112:115], v[68:71]
ds_read_b128 v[28:31], v11 offset:32768
v_mfma_f32_16x16x32_bf16 v[72:75], v[36:39], a[116:119], v[72:75]
s_add_u32 m0, s46, 43648
v_mfma_f32_16x16x32_bf16 v[76:79], v[40:43], a[112:115], v[76:79]
ds_read_b128 v[32:35], v11 offset:34816
v_mfma_f32_16x16x32_bf16 v[80:83], v[40:43], a[116:119], v[80:83]
buffer_load_dwordx4 v6, s[8:11], s50 offen offset:1408 lds
s_waitcnt lgkmcnt(4)
v_mfma_f32_16x16x32_bf16 v[68:71], v[44:47], a[120:123], v[68:71]
ds_read_b128 v[36:39], v10 offset:36864
v_mfma_f32_16x16x32_bf16 v[72:75], v[44:47], a[124:127], v[72:75]
s_add_u32 m0, s46, 47616
v_mfma_f32_16x16x32_bf16 v[76:79], v[48:51], a[120:123], v[76:79]
ds_read_b128 v[40:43], v10 offset:38912
v_mfma_f32_16x16x32_bf16 v[80:83], v[48:51], a[124:127], v[80:83]
buffer_load_dwordx4 v6, s[8:11], s50 offen offset:1536 lds
s_waitcnt lgkmcnt(4)
v_mfma_f32_16x16x32_bf16 v[68:71], v[20:23], a[128:131], v[68:71]
ds_read_b128 v[44:47], v11 offset:36864
v_mfma_f32_16x16x32_bf16 v[72:75], v[20:23], a[132:135], v[72:75]
s_add_u32 m0, s46, 51584
v_mfma_f32_16x16x32_bf16 v[76:79], v[24:27], a[128:131], v[76:79]
ds_read_b128 v[48:51], v11 offset:38912
v_mfma_f32_16x16x32_bf16 v[80:83], v[24:27], a[132:135], v[80:83]
buffer_load_dwordx4 v6, s[8:11], s50 offen offset:1664 lds
s_waitcnt lgkmcnt(4)
v_mfma_f32_16x16x32_bf16 v[68:71], v[28:31], a[136:139], v[68:71]
ds_read_b128 v[20:23], v10 offset:40960
v_mfma_f32_16x16x32_bf16 v[72:75], v[28:31], a[140:143], v[72:75]
s_add_u32 m0, s46, 55552
v_mfma_f32_16x16x32_bf16 v[76:79], v[32:35], a[136:139], v[76:79]
ds_read_b128 v[24:27], v10 offset:43008
v_mfma_f32_16x16x32_bf16 v[80:83], v[32:35], a[140:143], v[80:83]
buffer_load_dwordx4 v6, s[8:11], s50 offen offset:1792 lds
s_waitcnt lgkmcnt(4)
v_mfma_f32_16x16x32_bf16 v[68:71], v[36:39], a[144:147], v[68:71]
ds_read_b128 v[28:31], v11 offset:40960
v_mfma_f32_16x16x32_bf16 v[72:75], v[36:39], a[148:151], v[72:75]
s_add_u32 m0, s46, 59520
v_mfma_f32_16x16x32_bf16 v[76:79], v[40:43], a[144:147], v[76:79]
ds_read_b128 v[32:35], v11 offset:43008
v_mfma_f32_16x16x32_bf16 v[80:83], v[40:43], a[148:151], v[80:83]
buffer_load_dwordx4 v6, s[8:11], s50 offen offset:1920 lds
s_waitcnt lgkmcnt(4)
v_mfma_f32_16x16x32_bf16 v[68:71], v[44:47], a[152:155], v[68:71]
ds_read_b128 v[36:39], v10 offset:45056
v_mfma_f32_16x16x32_bf16 v[72:75], v[44:47], a[156:159], v[72:75]
v_mfma_f32_16x16x32_bf16 v[76:79], v[48:51], a[152:155], v[76:79]
ds_read_b128 v[40:43], v10 offset:47104
v_mfma_f32_16x16x32_bf16 v[80:83], v[48:51], a[156:159], v[80:83]
s_waitcnt lgkmcnt(4)
v_mfma_f32_16x16x32_bf16 v[68:71], v[20:23], a[160:163], v[68:71]
ds_read_b128 v[44:47], v11 offset:45056
v_mfma_f32_16x16x32_bf16 v[72:75], v[20:23], a[164:167], v[72:75]
v_mfma_f32_16x16x32_bf16 v[76:79], v[24:27], a[160:163], v[76:79]
ds_read_b128 v[48:51], v11 offset:47104
v_mfma_f32_16x16x32_bf16 v[80:83], v[24:27], a[164:167], v[80:83]
s_waitcnt lgkmcnt(4)
v_mfma_f32_16x16x32_bf16 v[68:71], v[28:31], a[168:171], v[68:71]
ds_read_b128 v[20:23], v10 offset:49152
v_mfma_f32_16x16x32_bf16 v[72:75], v[28:31], a[172:175], v[72:75]
s_waitcnt vmcnt(16)
v_mov_b32 v17, s42
s_mov_b64 exec, 1
buffer_store_dword v17, v16, s[84:87], s49 offen sc1
s_mov_b64 exec, -1
v_mfma_f32_16x16x32_bf16 v[76:79], v[32:35], a[168:171], v[76:79]
ds_read_b128 v[24:27], v10 offset:51200
v_mfma_f32_16x16x32_bf16 v[80:83], v[32:35], a[172:175], v[80:83]
s_waitcnt lgkmcnt(4)
v_mfma_f32_16x16x32_bf16 v[68:71], v[36:39], a[176:179], v[68:71]
ds_read_b128 v[28:31], v11 offset:49152
v_mfma_f32_16x16x32_bf16 v[72:75], v[36:39], a[180:183], v[72:75]
s_add_u32 s53, s42, 3
s_min_u32 s53, s53, 63
s_lshl_b32 s53, s53, 16
s_mov_b64 exec, 0xffff
buffer_load_dword v250, v19, s[8:11], s53 offen
s_mov_b64 exec, -1
v_mfma_f32_16x16x32_bf16 v[76:79], v[40:43], a[176:179], v[76:79]
ds_read_b128 v[32:35], v11 offset:51200
v_mfma_f32_16x16x32_bf16 v[80:83], v[40:43], a[180:183], v[80:83]
s_waitcnt lgkmcnt(4)
v_mfma_f32_16x16x32_bf16 v[68:71], v[44:47], a[184:187], v[68:71]
ds_read_b128 v[36:39], v10 offset:53248
v_mfma_f32_16x16x32_bf16 v[72:75], v[44:47], a[188:191], v[72:75]
v_mfma_f32_16x16x32_bf16 v[76:79], v[48:51], a[184:187], v[76:79]
ds_read_b128 v[40:43], v10 offset:55296
v_mfma_f32_16x16x32_bf16 v[80:83], v[48:51], a[188:191], v[80:83]
s_waitcnt lgkmcnt(4)
v_mfma_f32_16x16x32_bf16 v[68:71], v[20:23], a[192:195], v[68:71]
ds_read_b128 v[44:47], v11 offset:53248
v_mfma_f32_16x16x32_bf16 v[72:75], v[20:23], a[196:199], v[72:75]
v_mfma_f32_16x16x32_bf16 v[76:79], v[24:27], a[192:195], v[76:79]
ds_read_b128 v[48:51], v11 offset:55296
v_mfma_f32_16x16x32_bf16 v[80:83], v[24:27], a[196:199], v[80:83]
s_waitcnt lgkmcnt(4)
v_mfma_f32_16x16x32_bf16 v[68:71], v[28:31], a[200:203], v[68:71]
ds_read_b128 v[20:23], v10 offset:57344
v_mfma_f32_16x16x32_bf16 v[72:75], v[28:31], a[204:207], v[72:75]
v_mfma_f32_16x16x32_bf16 v[76:79], v[32:35], a[200:203], v[76:79]
ds_read_b128 v[24:27], v10 offset:59392
v_mfma_f32_16x16x32_bf16 v[80:83], v[32:35], a[204:207], v[80:83]
s_waitcnt lgkmcnt(4)
v_mfma_f32_16x16x32_bf16 v[68:71], v[36:39], a[208:211], v[68:71]
ds_read_b128 v[28:31], v11 offset:57344
v_mfma_f32_16x16x32_bf16 v[72:75], v[36:39], a[212:215], v[72:75]
v_mfma_f32_16x16x32_bf16 v[76:79], v[40:43], a[208:211], v[76:79]
ds_read_b128 v[32:35], v11 offset:59392
v_mfma_f32_16x16x32_bf16 v[80:83], v[40:43], a[212:215], v[80:83]
s_waitcnt lgkmcnt(4)
v_mfma_f32_16x16x32_bf16 v[68:71], v[44:47], a[216:219], v[68:71]
ds_read_b128 v[36:39], v10 offset:61440
v_mfma_f32_16x16x32_bf16 v[72:75], v[44:47], a[220:223], v[72:75]
v_mfma_f32_16x16x32_bf16 v[76:79], v[48:51], a[216:219], v[76:79]
ds_read_b128 v[40:43], v10 offset:63488
v_mfma_f32_16x16x32_bf16 v[80:83], v[48:51], a[220:223], v[80:83]
s_waitcnt lgkmcnt(4)
v_mfma_f32_16x16x32_bf16 v[68:71], v[20:23], a[224:227], v[68:71]
ds_read_b128 v[44:47], v11 offset:61440
v_mfma_f32_16x16x32_bf16 v[72:75], v[20:23], a[228:231], v[72:75]
v_mfma_f32_16x16x32_bf16 v[76:79], v[24:27], a[224:227], v[76:79]
ds_read_b128 v[48:51], v11 offset:63488
v_mfma_f32_16x16x32_bf16 v[80:83], v[24:27], a[228:231], v[80:83]
s_waitcnt lgkmcnt(5)
v_mfma_f32_16x16x32_bf16 v[68:71], v[28:31], a[232:235], v[68:71]
v_mfma_f32_16x16x32_bf16 v[72:75], v[28:31], a[236:239], v[72:75]
s_waitcnt lgkmcnt(4)
v_mfma_f32_16x16x32_bf16 v[76:79], v[32:35], a[232:235], v[76:79]
v_mfma_f32_16x16x32_bf16 v[80:83], v[32:35], a[236:239], v[80:83]
s_waitcnt lgkmcnt(3)
v_mfma_f32_16x16x32_bf16 v[68:71], v[36:39], a[240:243], v[68:71]
v_mfma_f32_16x16x32_bf16 v[72:75], v[36:39], a[244:247], v[72:75]
s_waitcnt lgkmcnt(2)
v_mfma_f32_16x16x32_bf16 v[76:79], v[40:43], a[240:243], v[76:79]
v_mfma_f32_16x16x32_bf16 v[80:83], v[40:43], a[244:247], v[80:83]
s_waitcnt lgkmcnt(1)
v_mfma_f32_16x16x32_bf16 v[68:71], v[44:47], a[248:251], v[68:71]
v_mfma_f32_16x16x32_bf16 v[72:75], v[44:47], a[252:255], v[72:75]
s_waitcnt lgkmcnt(0)
v_mfma_f32_16x16x32_bf16 v[76:79], v[48:51], a[248:251], v[76:79]
v_mfma_f32_16x16x32_bf16 v[80:83], v[48:51], a[252:255], v[80:83]
s_add_u32 s42, s42, 1
s_cmp_eq_u32 s42, 64
s_cbranch_scc1 mega_kernel_v_fin
mega_kernel_v_mid:
s_waitcnt vmcnt(2)
s_barrier
s_add_u32 s50, s42, 1
s_min_u32 s50, s50, 63
s_lshl_b32 s50, s50, 16
ds_read_b128 v[20:23], v8 offset:0
ds_read_b128 v[24:27], v8 offset:2048
ds_read_b128 v[28:31], v9 offset:0
ds_read_b128 v[32:35], v9 offset:2048
ds_read_b128 v[36:39], v8 offset:4096
ds_read_b128 v[40:43], v8 offset:6144
s_waitcnt lgkmcnt(4)
v_mfma_f32_16x16x32_bf16 v[52:55], v[20:23], a[0:3], 0
ds_read_b128 v[44:47], v9 offset:4096
v_mfma_f32_16x16x32_bf16 v[56:59], v[20:23], a[4:7], 0
v_cvt_pk_bf16_f32 v84, v68, v69
v_cvt_pk_bf16_f32 v85, v70, v71
v_cvt_pk_bf16_f32 v86, v76, v77
v_mfma_f32_16x16x32_bf16 v[60:63], v[24:27], a[0:3], 0
ds_read_b128 v[48:51], v9 offset:6144
v_mfma_f32_16x16x32_bf16 v[64:67], v[24:27], a[4:7], 0
v_cvt_pk_bf16_f32 v87, v78, v79
v_cvt_pk_bf16_f32 v88, v72, v73
v_cvt_pk_bf16_f32 v89, v74, v75
s_waitcnt lgkmcnt(4)
v_mfma_f32_16x16x32_bf16 v[52:55], v[28:31], a[8:11], v[52:55]
ds_read_b128 v[20:23], v8 offset:8192
v_mfma_f32_16x16x32_bf16 v[56:59], v[28:31], a[12:15], v[56:59]
v_cvt_pk_bf16_f32 v90, v80, v81
v_cvt_pk_bf16_f32 v91, v82, v83
v_mfma_f32_16x16x32_bf16 v[60:63], v[32:35], a[8:11], v[60:63]
ds_read_b128 v[24:27], v8 offset:10240
v_mfma_f32_16x16x32_bf16 v[64:67], v[32:35], a[12:15], v[64:67]
s_add_u32 s51, s42, s47
s_sub_u32 s51, s51, 1
s_bfe_u32 s52, s51, 0x40002
s_lshl_b32 s52, s52, 14
s_waitcnt lgkmcnt(4)
v_mfma_f32_16x16x32_bf16 v[52:55], v[36:39], a[16:19], v[52:55]
ds_read_b128 v[28:31], v9 offset:8192
v_mfma_f32_16x16x32_bf16 v[56:59], v[36:39], a[20:23], v[56:59]
s_and_b32 s51, s51, 3
s_lshl_b32 s51, s51, 11
s_add_u32 s51, s51, s52
s_add_u32 s51, s51, s48
buffer_store_dwordx4 v[84:87], v7, s[84:87], s51 offen sc1
v_mfma_f32_16x16x32_bf16 v[60:63], v[40:43], a[16:19], v[60:63]
ds_read_b128 v[32:35], v9 offset:10240
v_mfma_f32_16x16x32_bf16 v[64:67], v[40:43], a[20:23], v[64:67]
buffer_store_dwordx4 v[88:91], v7, s[84:87], s51 offen offset:1024 sc1
s_waitcnt lgkmcnt(4)
v_mfma_f32_16x16x32_bf16 v[52:55], v[44:47], a[24:27], v[52:55]
ds_read_b128 v[36:39], v8 offset:12288
v_mfma_f32_16x16x32_bf16 v[56:59], v[44:47], a[28:31], v[56:59]
s_add_u32 m0, s46, 65536
v_mfma_f32_16x16x32_bf16 v[60:63], v[48:51], a[24:27], v[60:63]
ds_read_b128 v[40:43], v8 offset:14336
v_mfma_f32_16x16x32_bf16 v[64:67], v[48:51], a[28:31], v[64:67]
buffer_load_dwordx4 v6, s[8:11], s50 offen offset:0 lds
s_waitcnt lgkmcnt(4)
v_mfma_f32_16x16x32_bf16 v[52:55], v[20:23], a[32:35], v[52:55]
ds_read_b128 v[44:47], v9 offset:12288
v_mfma_f32_16x16x32_bf16 v[56:59], v[20:23], a[36:39], v[56:59]
s_add_u32 m0, s46, 69504
v_mfma_f32_16x16x32_bf16 v[60:63], v[24:27], a[32:35], v[60:63]
ds_read_b128 v[48:51], v9 offset:14336
v_mfma_f32_16x16x32_bf16 v[64:67], v[24:27], a[36:39], v[64:67]
buffer_load_dwordx4 v6, s[8:11], s50 offen offset:128 lds
s_waitcnt lgkmcnt(4)
v_mfma_f32_16x16x32_bf16 v[52:55], v[28:31], a[40:43], v[52:55]
ds_read_b128 v[20:23], v8 offset:16384
v_mfma_f32_16x16x32_bf16 v[56:59], v[28:31], a[44:47], v[56:59]
s_add_u32 m0, s46, 73472
v_mfma_f32_16x16x32_bf16 v[60:63], v[32:35], a[40:43], v[60:63]
ds_read_b128 v[24:27], v8 offset:18432
v_mfma_f32_16x16x32_bf16 v[64:67], v[32:35], a[44:47], v[64:67]
buffer_load_dwordx4 v6, s[8:11], s50 offen offset:256 lds
s_waitcnt lgkmcnt(4)
v_mfma_f32_16x16x32_bf16 v[52:55], v[36:39], a[48:51], v[52:55]
ds_read_b128 v[28:31], v9 offset:16384
v_mfma_f32_16x16x32_bf16 v[56:59], v[36:39], a[52:55], v[56:59]
s_add_u32 m0, s46, 77440
v_mfma_f32_16x16x32_bf16 v[60:63], v[40:43], a[48:51], v[60:63]
ds_read_b128 v[32:35], v9 offset:18432
v_mfma_f32_16x16x32_bf16 v[64:67], v[40:43], a[52:55], v[64:67]
buffer_load_dwordx4 v6, s[8:11], s50 offen offset:384 lds
s_waitcnt lgkmcnt(4)
v_mfma_f32_16x16x32_bf16 v[52:55], v[44:47], a[56:59], v[52:55]
ds_read_b128 v[36:39], v8 offset:20480
v_mfma_f32_16x16x32_bf16 v[56:59], v[44:47], a[60:63], v[56:59]
s_add_u32 m0, s46, 81408
v_mfma_f32_16x16x32_bf16 v[60:63], v[48:51], a[56:59], v[60:63]
ds_read_b128 v[40:43], v8 offset:22528
v_mfma_f32_16x16x32_bf16 v[64:67], v[48:51], a[60:63], v[64:67]
buffer_load_dwordx4 v6, s[8:11], s50 offen offset:512 lds
s_waitcnt lgkmcnt(4)
v_mfma_f32_16x16x32_bf16 v[52:55], v[20:23], a[64:67], v[52:55]
ds_read_b128 v[44:47], v9 offset:20480
v_mfma_f32_16x16x32_bf16 v[56:59], v[20:23], a[68:71], v[56:59]
s_add_u32 m0, s46, 85376
v_mfma_f32_16x16x32_bf16 v[60:63], v[24:27], a[64:67], v[60:63]
ds_read_b128 v[48:51], v9 offset:22528
v_mfma_f32_16x16x32_bf16 v[64:67], v[24:27], a[68:71], v[64:67]
buffer_load_dwordx4 v6, s[8:11], s50 offen offset:640 lds
s_waitcnt lgkmcnt(4)
v_mfma_f32_16x16x32_bf16 v[52:55], v[28:31], a[72:75], v[52:55]
ds_read_b128 v[20:23], v8 offset:24576
v_mfma_f32_16x16x32_bf16 v[56:59], v[28:31], a[76:79], v[56:59]
s_add_u32 m0, s46, 89344
v_mfma_f32_16x16x32_bf16 v[60:63], v[32:35], a[72:75], v[60:63]
ds_read_b128 v[24:27], v8 offset:26624
v_mfma_f32_16x16x32_bf16 v[64:67], v[32:35], a[76:79], v[64:67]
buffer_load_dwordx4 v6, s[8:11], s50 offen offset:768 lds
s_waitcnt lgkmcnt(4)
v_mfma_f32_16x16x32_bf16 v[52:55], v[36:39], a[80:83], v[52:55]
ds_read_b128 v[28:31], v9 offset:24576
v_mfma_f32_16x16x32_bf16 v[56:59], v[36:39], a[84:87], v[56:59]
s_add_u32 m0, s46, 93312
v_mfma_f32_16x16x32_bf16 v[60:63], v[40:43], a[80:83], v[60:63]
ds_read_b128 v[32:35], v9 offset:26624
v_mfma_f32_16x16x32_bf16 v[64:67], v[40:43], a[84:87], v[64:67]
buffer_load_dwordx4 v6, s[8:11], s50 offen offset:896 lds
s_waitcnt lgkmcnt(4)
v_mfma_f32_16x16x32_bf16 v[52:55], v[44:47], a[88:91], v[52:55]
ds_read_b128 v[36:39], v8 offset:28672
v_mfma_f32_16x16x32_bf16 v[56:59], v[44:47], a[92:95], v[56:59]
s_add_u32 m0, s46, 97280
v_mfma_f32_16x16x32_bf16 v[60:63], v[48:51], a[88:91], v[60:63]
ds_read_b128 v[40:43], v8 offset:30720
v_mfma_f32_16x16x32_bf16 v[64:67], v[48:51], a[92:95], v[64:67]
buffer_load_dwordx4 v6, s[8:11], s50 offen offset:1024 lds
s_waitcnt lgkmcnt(4)
v_mfma_f32_16x16x32_bf16 v[52:55], v[20:23], a[96:99], v[52:55]
ds_read_b128 v[44:47], v9 offset:28672
v_mfma_f32_16x16x32_bf16 v[56:59], v[20:23], a[100:103], v[56:59]
s_add_u32 m0, s46, 101248
v_mfma_f32_16x16x32_bf16 v[60:63], v[24:27], a[96:99], v[60:63]
ds_read_b128 v[48:51], v9 offset:30720
v_mfma_f32_16x16x32_bf16 v[64:67], v[24:27], a[100:103], v[64:67]
buffer_load_dwordx4 v6, s[8:11], s50 offen offset:1152 lds
s_waitcnt lgkmcnt(4)
v_mfma_f32_16x16x32_bf16 v[52:55], v[28:31], a[104:107], v[52:55]
ds_read_b128 v[20:23], v8 offset:32768
v_mfma_f32_16x16x32_bf16 v[56:59], v[28:31], a[108:111], v[56:59]
s_add_u32 m0, s46, 105216
v_mfma_f32_16x16x32_bf16 v[60:63], v[32:35], a[104:107], v[60:63]
ds_read_b128 v[24:27], v8 offset:34816
v_mfma_f32_16x16x32_bf16 v[64:67], v[32:35], a[108:111], v[64:67]
buffer_load_dwordx4 v6, s[8:11], s50 offen offset:1280 lds
s_waitcnt lgkmcnt(4)
v_mfma_f32_16x16x32_bf16 v[52:55], v[36:39], a[112:115], v[52:55]
ds_read_b128 v[28:31], v9 offset:32768
v_mfma_f32_16x16x32_bf16 v[56:59], v[36:39], a[116:119], v[56:59]
s_add_u32 m0, s46, 109184
v_mfma_f32_16x16x32_bf16 v[60:63], v[40:43], a[112:115], v[60:63]
ds_read_b128 v[32:35], v9 offset:34816
v_mfma_f32_16x16x32_bf16 v[64:67], v[40:43], a[116:119], v[64:67]
buffer_load_dwordx4 v6, s[8:11], s50 offen offset:1408 lds
s_waitcnt lgkmcnt(4)
v_mfma_f32_16x16x32_bf16 v[52:55], v[44:47], a[120:123], v[52:55]
ds_read_b128 v[36:39], v8 offset:36864
v_mfma_f32_16x16x32_bf16 v[56:59], v[44:47], a[124:127], v[56:59]
s_add_u32 m0, s46, 113152
v_mfma_f32_16x16x32_bf16 v[60:63], v[48:51], a[120:123], v[60:63]
ds_read_b128 v[40:43], v8 offset:38912
v_mfma_f32_16x16x32_bf16 v[64:67], v[48:51], a[124:127], v[64:67]
buffer_load_dwordx4 v6, s[8:11], s50 offen offset:1536 lds
s_waitcnt lgkmcnt(4)
v_mfma_f32_16x16x32_bf16 v[52:55], v[20:23], a[128:131], v[52:55]
ds_read_b128 v[44:47], v9 offset:36864
v_mfma_f32_16x16x32_bf16 v[56:59], v[20:23], a[132:135], v[56:59]
s_add_u32 m0, s46, 117120
v_mfma_f32_16x16x32_bf16 v[60:63], v[24:27], a[128:131], v[60:63]
ds_read_b128 v[48:51], v9 offset:38912
v_mfma_f32_16x16x32_bf16 v[64:67], v[24:27], a[132:135], v[64:67]
buffer_load_dwordx4 v6, s[8:11], s50 offen offset:1664 lds
s_waitcnt lgkmcnt(4)
v_mfma_f32_16x16x32_bf16 v[52:55], v[28:31], a[136:139], v[52:55]
ds_read_b128 v[20:23], v8 offset:40960
v_mfma_f32_16x16x32_bf16 v[56:59], v[28:31], a[140:143], v[56:59]
s_add_u32 m0, s46, 121088
v_mfma_f32_16x16x32_bf16 v[60:63], v[32:35], a[136:139], v[60:63]
ds_read_b128 v[24:27], v8 offset:43008
v_mfma_f32_16x16x32_bf16 v[64:67], v[32:35], a[140:143], v[64:67]
buffer_load_dwordx4 v6, s[8:11], s50 offen offset:1792 lds
s_waitcnt lgkmcnt(4)
v_mfma_f32_16x16x32_bf16 v[52:55], v[36:39], a[144:147], v[52:55]
ds_read_b128 v[28:31], v9 offset:40960
v_mfma_f32_16x16x32_bf16 v[56:59], v[36:39], a[148:151], v[56:59]
s_add_u32 m0, s46, 125056
v_mfma_f32_16x16x32_bf16 v[60:63], v[40:43], a[144:147], v[60:63]
ds_read_b128 v[32:35], v9 offset:43008
v_mfma_f32_16x16x32_bf16 v[64:67], v[40:43], a[148:151], v[64:67]
buffer_load_dwordx4 v6, s[8:11], s50 offen offset:1920 lds
s_waitcnt lgkmcnt(4)
v_mfma_f32_16x16x32_bf16 v[52:55], v[44:47], a[152:155], v[52:55]
ds_read_b128 v[36:39], v8 offset:45056
v_mfma_f32_16x16x32_bf16 v[56:59], v[44:47], a[156:159], v[56:59]
v_mfma_f32_16x16x32_bf16 v[60:63], v[48:51], a[152:155], v[60:63]
ds_read_b128 v[40:43], v8 offset:47104
v_mfma_f32_16x16x32_bf16 v[64:67], v[48:51], a[156:159], v[64:67]
s_waitcnt lgkmcnt(4)
v_mfma_f32_16x16x32_bf16 v[52:55], v[20:23], a[160:163], v[52:55]
ds_read_b128 v[44:47], v9 offset:45056
v_mfma_f32_16x16x32_bf16 v[56:59], v[20:23], a[164:167], v[56:59]
v_mfma_f32_16x16x32_bf16 v[60:63], v[24:27], a[160:163], v[60:63]
ds_read_b128 v[48:51], v9 offset:47104
v_mfma_f32_16x16x32_bf16 v[64:67], v[24:27], a[164:167], v[64:67]
s_waitcnt lgkmcnt(4)
v_mfma_f32_16x16x32_bf16 v[52:55], v[28:31], a[168:171], v[52:55]
ds_read_b128 v[20:23], v8 offset:49152
v_mfma_f32_16x16x32_bf16 v[56:59], v[28:31], a[172:175], v[56:59]
s_waitcnt vmcnt(16)
v_mov_b32 v17, s42
s_mov_b64 exec, 1
buffer_store_dword v17, v16, s[84:87], s49 offen sc1
s_mov_b64 exec, -1
v_mfma_f32_16x16x32_bf16 v[60:63], v[32:35], a[168:171], v[60:63]
ds_read_b128 v[24:27], v8 offset:51200
v_mfma_f32_16x16x32_bf16 v[64:67], v[32:35], a[172:175], v[64:67]
s_waitcnt lgkmcnt(4)
v_mfma_f32_16x16x32_bf16 v[52:55], v[36:39], a[176:179], v[52:55]
ds_read_b128 v[28:31], v9 offset:49152
v_mfma_f32_16x16x32_bf16 v[56:59], v[36:39], a[180:183], v[56:59]
s_add_u32 s53, s42, 3
s_min_u32 s53, s53, 63
s_lshl_b32 s53, s53, 16
s_mov_b64 exec, 0xffff
buffer_load_dword v250, v19, s[8:11], s53 offen
s_mov_b64 exec, -1
v_mfma_f32_16x16x32_bf16 v[60:63], v[40:43], a[176:179], v[60:63]
ds_read_b128 v[32:35], v9 offset:51200
v_mfma_f32_16x16x32_bf16 v[64:67], v[40:43], a[180:183], v[64:67]
s_waitcnt lgkmcnt(4)
v_mfma_f32_16x16x32_bf16 v[52:55], v[44:47], a[184:187], v[52:55]
ds_read_b128 v[36:39], v8 offset:53248
v_mfma_f32_16x16x32_bf16 v[56:59], v[44:47], a[188:191], v[56:59]
v_mfma_f32_16x16x32_bf16 v[60:63], v[48:51], a[184:187], v[60:63]
ds_read_b128 v[40:43], v8 offset:55296
v_mfma_f32_16x16x32_bf16 v[64:67], v[48:51], a[188:191], v[64:67]
s_waitcnt lgkmcnt(4)
v_mfma_f32_16x16x32_bf16 v[52:55], v[20:23], a[192:195], v[52:55]
ds_read_b128 v[44:47], v9 offset:53248
v_mfma_f32_16x16x32_bf16 v[56:59], v[20:23], a[196:199], v[56:59]
v_mfma_f32_16x16x32_bf16 v[60:63], v[24:27], a[192:195], v[60:63]
ds_read_b128 v[48:51], v9 offset:55296
v_mfma_f32_16x16x32_bf16 v[64:67], v[24:27], a[196:199], v[64:67]
s_waitcnt lgkmcnt(4)
v_mfma_f32_16x16x32_bf16 v[52:55], v[28:31], a[200:203], v[52:55]
ds_read_b128 v[20:23], v8 offset:57344
v_mfma_f32_16x16x32_bf16 v[56:59], v[28:31], a[204:207], v[56:59]
v_mfma_f32_16x16x32_bf16 v[60:63], v[32:35], a[200:203], v[60:63]
ds_read_b128 v[24:27], v8 offset:59392
v_mfma_f32_16x16x32_bf16 v[64:67], v[32:35], a[204:207], v[64:67]
s_waitcnt lgkmcnt(4)
v_mfma_f32_16x16x32_bf16 v[52:55], v[36:39], a[208:211], v[52:55]
ds_read_b128 v[28:31], v9 offset:57344
v_mfma_f32_16x16x32_bf16 v[56:59], v[36:39], a[212:215], v[56:59]
v_mfma_f32_16x16x32_bf16 v[60:63], v[40:43], a[208:211], v[60:63]
ds_read_b128 v[32:35], v9 offset:59392
v_mfma_f32_16x16x32_bf16 v[64:67], v[40:43], a[212:215], v[64:67]
s_waitcnt lgkmcnt(4)
v_mfma_f32_16x16x32_bf16 v[52:55], v[44:47], a[216:219], v[52:55]
ds_read_b128 v[36:39], v8 offset:61440
v_mfma_f32_16x16x32_bf16 v[56:59], v[44:47], a[220:223], v[56:59]
v_mfma_f32_16x16x32_bf16 v[60:63], v[48:51], a[216:219], v[60:63]
ds_read_b128 v[40:43], v8 offset:63488
v_mfma_f32_16x16x32_bf16 v[64:67], v[48:51], a[220:223], v[64:67]
s_waitcnt lgkmcnt(4)
v_mfma_f32_16x16x32_bf16 v[52:55], v[20:23], a[224:227], v[52:55]
ds_read_b128 v[44:47], v9 offset:61440
v_mfma_f32_16x16x32_bf16 v[56:59], v[20:23], a[228:231], v[56:59]
v_mfma_f32_16x16x32_bf16 v[60:63], v[24:27], a[224:227], v[60:63]
ds_read_b128 v[48:51], v9 offset:63488
v_mfma_f32_16x16x32_bf16 v[64:67], v[24:27], a[228:231], v[64:67]
s_waitcnt lgkmcnt(5)
v_mfma_f32_16x16x32_bf16 v[52:55], v[28:31], a[232:235], v[52:55]
v_mfma_f32_16x16x32_bf16 v[56:59], v[28:31], a[236:239], v[56:59]
s_waitcnt lgkmcnt(4)
v_mfma_f32_16x16x32_bf16 v[60:63], v[32:35], a[232:235], v[60:63]
v_mfma_f32_16x16x32_bf16 v[64:67], v[32:35], a[236:239], v[64:67]
s_waitcnt lgkmcnt(3)
v_mfma_f32_16x16x32_bf16 v[52:55], v[36:39], a[240:243], v[52:55]
v_mfma_f32_16x16x32_bf16 v[56:59], v[36:39], a[244:247], v[56:59]
s_waitcnt lgkmcnt(2)
v_mfma_f32_16x16x32_bf16 v[60:63], v[40:43], a[240:243], v[60:63]
v_mfma_f32_16x16x32_bf16 v[64:67], v[40:43], a[244:247], v[64:67]
s_waitcnt lgkmcnt(1)
v_mfma_f32_16x16x32_bf16 v[52:55], v[44:47], a[248:251], v[52:55]
v_mfma_f32_16x16x32_bf16 v[56:59], v[44:47], a[252:255], v[56:59]
s_waitcnt lgkmcnt(0)
v_mfma_f32_16x16x32_bf16 v[60:63], v[48:51], a[248:251], v[60:63]
v_mfma_f32_16x16x32_bf16 v[64:67], v[48:51], a[252:255], v[64:67]
s_add_u32 s42, s42, 1
s_branch mega_kernel_v_loop
mega_kernel_v_fin:
s_nop 11
v_cvt_pk_bf16_f32 v84, v68, v69
v_cvt_pk_bf16_f32 v85, v70, v71
v_cvt_pk_bf16_f32 v86, v76, v77
v_cvt_pk_bf16_f32 v87, v78, v79
v_cvt_pk_bf16_f32 v88, v72, v73
v_cvt_pk_bf16_f32 v89, v74, v75
v_cvt_pk_bf16_f32 v90, v80, v81
v_cvt_pk_bf16_f32 v91, v82, v83
s_add_u32 s51, s42, s47
s_sub_u32 s51, s51, 1
s_bfe_u32 s52, s51, 0x40002
s_lshl_b32 s52, s52, 14
s_and_b32 s51, s51, 3
s_lshl_b32 s51, s51, 11
s_add_u32 s51, s51, s52
s_add_u32 s51, s51, s48
buffer_store_dwordx4 v[84:87], v7, s[84:87], s51 offen sc1
buffer_store_dwordx4 v[88:91], v7, s[84:87], s51 offen offset:1024 sc1
s_waitcnt vmcnt(0)
v_mov_b32 v17, s42
s_mov_b64 exec, 1
buffer_store_dword v17, v16, s[84:87], s49 offen sc1
s_mov_b64 exec, -1
s_waitcnt vmcnt(0)
s_barrier
mega_kernel_fft:
s_mov_b32 s38, s92
s_mov_b32 s39, 64
s_mov_b32 s37, 129
mega_kernel_f2s:
v_mov_b32 v1, 0
s_mov_b32 s82, 69259264
mega_kernel_w0:
s_sleep 8
buffer_load_dword v2, v1, s[84:87], s82 offen sc1
s_waitcnt vmcnt(0)
v_cmp_ne_u32 vcc, 31, v2
s_cbranch_vccnz mega_kernel_w0
s_mov_b32 s48, 0x3f7ec46d
s_mov_b32 s49, 0x3dc8bd36
s_mov_b32 s50, 0x3f7b14be
s_mov_b32 s51, 0x3e47c5c2
s_mov_b32 s52, 0x3f74fa0b
s_mov_b32 s53, 0x3e94a031
s_mov_b32 s54, 0x3f6c835e
s_mov_b32 s55, 0x3ec3ef15
s_mov_b32 s56, 0x3f61c598
s_mov_b32 s57, 0x3ef15aea
s_mov_b32 s58, 0x3f54db31
s_mov_b32 s59, 0x3f0e39da
s_mov_b32 s60, 0x3f45e403
s_mov_b32 s61, 0x3f226799
s_mov_b32 s62, 0x3f3504f3
s_mov_b32 s63, 0x3f3504f3
v_lshrrev_b32 v10, 6, v0
v_and_b32 v1, 63, v0
v_readfirstlane_b32 s16, v10
v_cvt_f32_u32 v2, v1
v_lshlrev_b32 v5, 3, v1
s_mul_i32 s17, s16, 16896
v_add_u32 v3, s17, v5
v_and_b32 v7, 1, v1
v_lshrrev_b32 v6, 1, v1
v_cvt_f32_u32 v8, v6
v_cvt_f32_u32 v10, v7
v_mul_u32_u24 v4, 528, v6
v_lshl_add_u32 v4, v7, 3, v4
v_add_u32 v4, s17, v4
v_lshlrev_b32 v11, 12, v7
v_lshl_add_u32 v11, v6, 2, v11
v_fma_f32 v9, v10, 2.0, -1.0
v_sub_f32 v7, 0, v9
v_mul_f32 v13, v10, v8
v_mul_f32 v13, 0x3a000000, v13
s_mov_b32 s18, 0xaaaaaaaa
s_mov_b32 s19, 0xaaaaaaaa
v_mul_f32 v12, 0xba000000, v2
v_cos_f32 v82, v12
v_sin_f32 v83, v12
v_mul_f32 v12, 0xba800000, v2
v_cos_f32 v84, v12
v_sin_f32 v85, v12
v_mul_f32 v12, 0xbac00000, v2
v_cos_f32 v86, v12
v_sin_f32 v87, v12
v_mul_f32 v12, 0xbb000000, v2
v_cos_f32 v88, v12
v_sin_f32 v89, v12
v_mul_f32 v12, 0xbb200000, v2
v_cos_f32 v90, v12
v_sin_f32 v91, v12
v_mul_f32 v12, 0xbb400000, v2
v_cos_f32 v92, v12
v_sin_f32 v93, v12
v_mul_f32 v12, 0xbb600000, v2
v_cos_f32 v94, v12
v_sin_f32 v95, v12
v_mul_f32 v12, 0xbb800000, v2
v_cos_f32 v96, v12
v_sin_f32 v97, v12
v_mul_f32 v12, 0xbb900000, v2
v_cos_f32 v98, v12
v_sin_f32 v99, v12
v_mul_f32 v12, 0xbba00000, v2
v_cos_f32 v100, v12
v_sin_f32 v101, v12
v_mul_f32 v12, 0xbbb00000, v2
v_cos_f32 v102, v12
v_sin_f32 v103, v12
v_mul_f32 v12, 0xbbc00000, v2
v_cos_f32 v104, v12
v_sin_f32 v105, v12
v_mul_f32 v12, 0xbbd00000, v2
v_cos_f32 v106, v12
v_sin_f32 v107, v12
v_mul_f32 v12, 0xbbe00000, v2
v_cos_f32 v108, v12
v_sin_f32 v109, v12
v_mul_f32 v12, 0xbbf00000, v2
v_cos_f32 v110, v12
v_sin_f32 v111, v12
v_mul_f32 v12, 0xbc000000, v2
v_cos_f32 v112, v12
v_sin_f32 v113, v12
v_mul_f32 v12, 0xbc080000, v2
v_cos_f32 v114, v12
v_sin_f32 v115, v12
v_mul_f32 v12, 0xbc100000, v2
v_cos_f32 v116, v12
v_sin_f32 v117, v12
v_mul_f32 v12, 0xbc180000, v2
v_cos_f32 v118, v12
v_sin_f32 v119, v12
v_mul_f32 v12, 0xbc200000, v2
v_cos_f32 v120, v12
v_sin_f32 v121, v12
v_mul_f32 v12, 0xbc280000, v2
v_cos_f32 v122, v12
v_sin_f32 v123, v12
v_mul_f32 v12, 0xbc300000, v2
v_cos_f32 v124, v12
v_sin_f32 v125, v12
v_mul_f32 v12, 0xbc380000, v2
v_cos_f32 v126, v12
v_sin_f32 v127, v12
v_mul_f32 v12, 0xbc400000, v2
v_cos_f32 v128, v12
v_sin_f32 v129, v12
v_mul_f32 v12, 0xbc480000, v2
v_cos_f32 v130, v12
v_sin_f32 v131, v12
v_mul_f32 v12, 0xbc500000, v2
v_cos_f32 v132, v12
v_sin_f32 v133, v12
v_mul_f32 v12, 0xbc580000, v2
v_cos_f32 v134, v12
v_sin_f32 v135, v12
v_mul_f32 v12, 0xbc600000, v2
v_cos_f32 v136, v12
v_sin_f32 v137, v12
v_mul_f32 v12, 0xbc680000, v2
v_cos_f32 v138, v12
v_sin_f32 v139, v12
v_mul_f32 v12, 0xbc700000, v2
v_cos_f32 v140, v12
v_sin_f32 v141, v12
v_mul_f32 v12, 0xbc780000, v2
v_cos_f32 v142, v12
v_sin_f32 v143, v12
v_mov_b32 v12, v13
v_fmac_f32 v12, 0x00000000, v8
v_cos_f32 v144, v12
v_sin_f32 v145, v12
v_mov_b32 v12, v13
v_fmac_f32 v12, 0x3a800000, v8
v_cos_f32 v146, v12
v_sin_f32 v147, v12
v_mov_b32 v12, v13
v_fmac_f32 v12, 0x3b000000, v8
v_cos_f32 v148, v12
v_sin_f32 v149, v12
v_mov_b32 v12, v13
v_fmac_f32 v12, 0x3b400000, v8
v_cos_f32 v150, v12
v_sin_f32 v151, v12
v_mov_b32 v12, v13
v_fmac_f32 v12, 0x3b800000, v8
v_cos_f32 v152, v12
v_sin_f32 v153, v12
v_mov_b32 v12, v13
v_fmac_f32 v12, 0x3ba00000, v8
v_cos_f32 v154, v12
v_sin_f32 v155, v12
v_mov_b32 v12, v13
v_fmac_f32 v12, 0x3bc00000, v8
v_cos_f32 v156, v12
v_sin_f32 v157, v12
v_mov_b32 v12, v13
v_fmac_f32 v12, 0x3be00000, v8
v_cos_f32 v158, v12
v_sin_f32 v159, v12
v_mov_b32 v12, v13
v_fmac_f32 v12, 0x3c000000, v8
v_cos_f32 v160, v12
v_sin_f32 v161, v12
v_mov_b32 v12, v13
v_fmac_f32 v12, 0x3c100000, v8
v_cos_f32 v162, v12
v_sin_f32 v163, v12
v_mov_b32 v12, v13
v_fmac_f32 v12, 0x3c200000, v8
v_cos_f32 v164, v12
v_sin_f32 v165, v12
v_mov_b32 v12, v13
v_fmac_f32 v12, 0x3c300000, v8
v_cos_f32 v166, v12
v_sin_f32 v167, v12
v_mov_b32 v12, v13
v_fmac_f32 v12, 0x3c400000, v8
v_cos_f32 v168, v12
v_sin_f32 v169, v12
v_mov_b32 v12, v13
v_fmac_f32 v12, 0x3c500000, v8
v_cos_f32 v170, v12
v_sin_f32 v171, v12
v_mov_b32 v12, v13
v_fmac_f32 v12, 0x3c600000, v8
v_cos_f32 v172, v12
v_sin_f32 v173, v12
v_mov_b32 v12, v13
v_fmac_f32 v12, 0x3c700000, v8
v_cos_f32 v174, v12
v_sin_f32 v175, v12
v_mov_b32 v12, v13
v_fmac_f32 v12, 0x3c800000, v8
v_cos_f32 v176, v12
v_sin_f32 v177, v12
v_mov_b32 v12, v13
v_fmac_f32 v12, 0x3c880000, v8
v_cos_f32 v178, v12
v_sin_f32 v179, v12
v_mov_b32 v12, v13
v_fmac_f32 v12, 0x3c900000, v8
v_cos_f32 v180, v12
v_sin_f32 v181, v12
v_mov_b32 v12, v13
v_fmac_f32 v12, 0x3c980000, v8
v_cos_f32 v182, v12
v_sin_f32 v183, v12
v_mov_b32 v12, v13
v_fmac_f32 v12, 0x3ca00000, v8
v_cos_f32 v184, v12
v_sin_f32 v185, v12
v_mov_b32 v12, v13
v_fmac_f32 v12, 0x3ca80000, v8
v_cos_f32 v186, v12
v_sin_f32 v187, v12
v_mov_b32 v12, v13
v_fmac_f32 v12, 0x3cb00000, v8
v_cos_f32 v188, v12
v_sin_f32 v189, v12
v_mov_b32 v12, v13
v_fmac_f32 v12, 0x3cb80000, v8
v_cos_f32 v190, v12
v_sin_f32 v191, v12
v_mov_b32 v12, v13
v_fmac_f32 v12, 0x3cc00000, v8
v_cos_f32 v192, v12
v_sin_f32 v193, v12
v_mov_b32 v12, v13
v_fmac_f32 v12, 0x3cc80000, v8
v_cos_f32 v194, v12
v_sin_f32 v195, v12
v_mov_b32 v12, v13
v_fmac_f32 v12, 0x3cd00000, v8
v_cos_f32 v196, v12
v_sin_f32 v197, v12
v_mov_b32 v12, v13
v_fmac_f32 v12, 0x3cd80000, v8
v_cos_f32 v198, v12
v_sin_f32 v199, v12
v_mov_b32 v12, v13
v_fmac_f32 v12, 0x3ce00000, v8
v_cos_f32 v200, v12
v_sin_f32 v201, v12
v_mov_b32 v12, v13
v_fmac_f32 v12, 0x3ce80000, v8
v_cos_f32 v202, v12
v_sin_f32 v203, v12
v_mov_b32 v12, v13
v_fmac_f32 v12, 0x3cf00000, v8
v_cos_f32 v204, v12
v_sin_f32 v205, v12
v_mov_b32 v12, v13
v_fmac_f32 v12, 0x3cf80000, v8
v_cos_f32 v206, v12
v_sin_f32 v207, v12
s_nop 0
v_mul_f32 v144, 0x34800000, v144
v_mul_f32 v145, 0x34800000, v145
v_mul_f32 v146, 0x34800000, v146
v_mul_f32 v147, 0x34800000, v147
v_mul_f32 v148, 0x34800000, v148
v_mul_f32 v149, 0x34800000, v149
v_mul_f32 v150, 0x34800000, v150
v_mul_f32 v151, 0x34800000, v151
v_mul_f32 v152, 0x34800000, v152
v_mul_f32 v153, 0x34800000, v153
v_mul_f32 v154, 0x34800000, v154
v_mul_f32 v155, 0x34800000, v155
v_mul_f32 v156, 0x34800000, v156
v_mul_f32 v157, 0x34800000, v157
v_mul_f32 v158, 0x34800000, v158
v_mul_f32 v159, 0x34800000, v159
v_mul_f32 v160, 0x34800000, v160
v_mul_f32 v161, 0x34800000, v161
v_mul_f32 v162, 0x34800000, v162
v_mul_f32 v163, 0x34800000, v163
v_mul_f32 v164, 0x34800000, v164
v_mul_f32 v165, 0x34800000, v165
v_mul_f32 v166, 0x34800000, v166
v_mul_f32 v167, 0x34800000, v167
v_mul_f32 v168, 0x34800000, v168
v_mul_f32 v169, 0x34800000, v169
v_mul_f32 v170, 0x34800000, v170
v_mul_f32 v171, 0x34800000, v171
v_mul_f32 v172, 0x34800000, v172
v_mul_f32 v173, 0x34800000, v173
v_mul_f32 v174, 0x34800000, v174
v_mul_f32 v175, 0x34800000, v175
v_mul_f32 v176, 0x34800000, v176
v_mul_f32 v177, 0x34800000, v177
v_mul_f32 v178, 0x34800000, v178
v_mul_f32 v179, 0x34800000, v179
v_mul_f32 v180, 0x34800000, v180
v_mul_f32 v181, 0x34800000, v181
v_mul_f32 v182, 0x34800000, v182
v_mul_f32 v183, 0x34800000, v183
v_mul_f32 v184, 0x34800000, v184
v_mul_f32 v185, 0x34800000, v185
v_mul_f32 v186, 0x34800000, v186
v_mul_f32 v187, 0x34800000, v187
v_mul_f32 v188, 0x34800000, v188
v_mul_f32 v189, 0x34800000, v189
v_mul_f32 v190, 0x34800000, v190
v_mul_f32 v191, 0x34800000, v191
v_mul_f32 v192, 0x34800000, v192
v_mul_f32 v193, 0x34800000, v193
v_mul_f32 v194, 0x34800000, v194
v_mul_f32 v195, 0x34800000, v195
v_mul_f32 v196, 0x34800000, v196
v_mul_f32 v197, 0x34800000, v197
v_mul_f32 v198, 0x34800000, v198
v_mul_f32 v199, 0x34800000, v199
v_mul_f32 v200, 0x34800000, v200
v_mul_f32 v201, 0x34800000, v201
v_mul_f32 v202, 0x34800000, v202
v_mul_f32 v203, 0x34800000, v203
v_mul_f32 v204, 0x34800000, v204
v_mul_f32 v205, 0x34800000, v205
v_mul_f32 v206, 0x34800000, v206
v_mul_f32 v207, 0x34800000, v207
s_cmp_lt_u32 s38, s37
s_cbranch_scc0 mega_kernel_f2_e
s_lshl_b32 s12, s38, 2
s_add_u32 s12, s12, s16
s_min_u32 s12, s12, 512
s_lshr_b32 s23, s12, 7
s_xnor_b32 s23, s23, s98
s_and_b32 s23, s23, 1
s_lshl_b32 s23, s23, 13
s_mul_i32 s13, s12, 16384
s_add_u32 s13, s13, 171966464
s_add_u32 s13, s13, s23
s_lshr_b32 s23, s12, 6
s_xnor_b32 s23, s23, s98
s_and_b32 s23, s23, 1
s_lshl_b32 s23, s23, 13
s_mul_i32 s12, s12, 32768
s_add_u32 s12, s12, 92274688
s_add_u32 s12, s12, s23
buffer_load_dwordx2 a[0:1], v5, s[84:87], s12 offen offset:0 sc1
buffer_load_dwordx2 a[2:3], v5, s[84:87], s12 offen offset:512 sc1
buffer_load_dwordx2 a[4:5], v5, s[84:87], s12 offen offset:1024 sc1
buffer_load_dwordx2 a[6:7], v5, s[84:87], s12 offen offset:1536 sc1
buffer_load_dwordx2 a[8:9], v5, s[84:87], s12 offen offset:2048 sc1
buffer_load_dwordx2 a[10:11], v5, s[84:87], s12 offen offset:2560 sc1
buffer_load_dwordx2 a[12:13], v5, s[84:87], s12 offen offset:3072 sc1
buffer_load_dwordx2 a[14:15], v5, s[84:87], s12 offen offset:3584 sc1
s_add_u32 s12, s12, 4096
buffer_load_dwordx2 a[16:17], v5, s[84:87], s12 offen offset:0 sc1
buffer_load_dwordx2 a[18:19], v5, s[84:87], s12 offen offset:512 sc1
buffer_load_dwordx2 a[20:21], v5, s[84:87], s12 offen offset:1024 sc1
buffer_load_dwordx2 a[22:23], v5, s[84:87], s12 offen offset:1536 sc1
buffer_load_dwordx2 a[24:25], v5, s[84:87], s12 offen offset:2048 sc1
buffer_load_dwordx2 a[26:27], v5, s[84:87], s12 offen offset:2560 sc1
buffer_load_dwordx2 a[28:29], v5, s[84:87], s12 offen offset:3072 sc1
buffer_load_dwordx2 a[30:31], v5, s[84:87], s12 offen offset:3584 sc1
s_add_u32 s12, s12, 12288
buffer_load_dwordx2 a[32:33], v5, s[84:87], s12 offen offset:0 sc1
buffer_load_dwordx2 a[34:35], v5, s[84:87], s12 offen offset:512 sc1
buffer_load_dwordx2 a[36:37], v5, s[84:87], s12 offen offset:1024 sc1
buffer_load_dwordx2 a[38:39], v5, s[84:87], s12 offen offset:1536 sc1
buffer_load_dwordx2 a[40:41], v5, s[84:87], s12 offen offset:2048 sc1
buffer_load_dwordx2 a[42:43], v5, s[84:87], s12 offen offset:2560 sc1
buffer_load_dwordx2 a[44:45], v5, s[84:87], s12 offen offset:3072 sc1
buffer_load_dwordx2 a[46:47], v5, s[84:87], s12 offen offset:3584 sc1
s_add_u32 s12, s12, 4096
buffer_load_dwordx2 a[48:49], v5, s[84:87], s12 offen offset:0 sc1
buffer_load_dwordx2 a[50:51], v5, s[84:87], s12 offen offset:512 sc1
buffer_load_dwordx2 a[52:53], v5, s[84:87], s12 offen offset:1024 sc1
buffer_load_dwordx2 a[54:55], v5, s[84:87], s12 offen offset:1536 sc1
buffer_load_dwordx2 a[56:57], v5, s[84:87], s12 offen offset:2048 sc1
buffer_load_dwordx2 a[58:59], v5, s[84:87], s12 offen offset:2560 sc1
buffer_load_dwordx2 a[60:61], v5, s[84:87], s12 offen offset:3072 sc1
buffer_load_dwordx2 a[62:63], v5, s[84:87], s12 offen offset:3584 sc1
s_add_u32 s12, s12, 4096
buffer_load_dword a64, v11, s[84:87], s13 offen offset:0 sc1
buffer_load_dword a65, v11, s[84:87], s13 offen offset:128 sc1
buffer_load_dword a66, v11, s[84:87], s13 offen offset:256 sc1
buffer_load_dword a67, v11, s[84:87], s13 offen offset:384 sc1
buffer_load_dword a68, v11, s[84:87], s13 offen offset:512 sc1
buffer_load_dword a69, v11, s[84:87], s13 offen offset:640 sc1
buffer_load_dword a70, v11, s[84:87], s13 offen offset:768 sc1
buffer_load_dword a71, v11, s[84:87], s13 offen offset:896 sc1
buffer_load_dword a72, v11, s[84:87], s13 offen offset:1024 sc1
buffer_load_dword a73, v11, s[84:87], s13 offen offset:1152 sc1
buffer_load_dword a74, v11, s[84:87], s13 offen offset:1280 sc1
buffer_load_dword a75, v11, s[84:87], s13 offen offset:1408 sc1
buffer_load_dword a76, v11, s[84:87], s13 offen offset:1536 sc1
buffer_load_dword a77, v11, s[84:87], s13 offen offset:1664 sc1
buffer_load_dword a78, v11, s[84:87], s13 offen offset:1792 sc1
buffer_load_dword a79, v11, s[84:87], s13 offen offset:1920 sc1
buffer_load_dword a80, v11, s[84:87], s13 offen offset:2048 sc1
buffer_load_dword a81, v11, s[84:87], s13 offen offset:2176 sc1
buffer_load_dword a82, v11, s[84:87], s13 offen offset:2304 sc1
buffer_load_dword a83, v11, s[84:87], s13 offen offset:2432 sc1
buffer_load_dword a84, v11, s[84:87], s13 offen offset:2560 sc1
buffer_load_dword a85, v11, s[84:87], s13 offen offset:2688 sc1
buffer_load_dword a86, v11, s[84:87], s13 offen offset:2816 sc1
buffer_load_dword a87, v11, s[84:87], s13 offen offset:2944 sc1
buffer_load_dword a88, v11, s[84:87], s13 offen offset:3072 sc1
buffer_load_dword a89, v11, s[84:87], s13 offen offset:3200 sc1
buffer_load_dword a90, v11, s[84:87], s13 offen offset:3328 sc1
buffer_load_dword a91, v11, s[84:87], s13 offen offset:3456 sc1
buffer_load_dword a92, v11, s[84:87], s13 offen offset:3584 sc1
buffer_load_dword a93, v11, s[84:87], s13 offen offset:3712 sc1
buffer_load_dword a94, v11, s[84:87], s13 offen offset:3840 sc1
buffer_load_dword a95, v11, s[84:87], s13 offen offset:3968 sc1
s_waitcnt vmcnt(0)
mega_kernel_f2_l:
s_add_u32 s21, s38, s39
s_cmp_lt_u32 s21, s37
s_cselect_b32 s22, s21, s38
s_waitcnt vmcnt(32)
v_accvgpr_read_b32 v16, a0
v_accvgpr_read_b32 v17, a1
v_accvgpr_read_b32 v18, a2
v_accvgpr_read_b32 v19, a3
v_accvgpr_read_b32 v20, a4
v_accvgpr_read_b32 v21, a5
v_accvgpr_read_b32 v22, a6
v_accvgpr_read_b32 v23, a7
v_accvgpr_read_b32 v24, a8
v_accvgpr_read_b32 v25, a9
v_accvgpr_read_b32 v26, a10
v_accvgpr_read_b32 v27, a11
v_accvgpr_read_b32 v28, a12
v_accvgpr_read_b32 v29, a13
v_accvgpr_read_b32 v30, a14
v_accvgpr_read_b32 v31, a15
v_accvgpr_read_b32 v32, a16
v_accvgpr_read_b32 v33, a17
v_accvgpr_read_b32 v34, a18
v_accvgpr_read_b32 v35, a19
v_accvgpr_read_b32 v36, a20
v_accvgpr_read_b32 v37, a21
v_accvgpr_read_b32 v38, a22
v_accvgpr_read_b32 v39, a23
v_accvgpr_read_b32 v40, a24
v_accvgpr_read_b32 v41, a25
v_accvgpr_read_b32 v42, a26
v_accvgpr_read_b32 v43, a27
v_accvgpr_read_b32 v44, a28
v_accvgpr_read_b32 v45, a29
v_accvgpr_read_b32 v46, a30
v_accvgpr_read_b32 v47, a31
v_accvgpr_read_b32 v48, a32
v_accvgpr_read_b32 v49, a33
v_accvgpr_read_b32 v50, a34
v_accvgpr_read_b32 v51, a35
v_accvgpr_read_b32 v52, a36
v_accvgpr_read_b32 v53, a37
v_accvgpr_read_b32 v54, a38
v_accvgpr_read_b32 v55, a39
v_accvgpr_read_b32 v56, a40
v_accvgpr_read_b32 v57, a41
v_accvgpr_read_b32 v58, a42
v_accvgpr_read_b32 v59, a43
v_accvgpr_read_b32 v60, a44
v_accvgpr_read_b32 v61, a45
v_accvgpr_read_b32 v62, a46
v_accvgpr_read_b32 v63, a47
v_accvgpr_read_b32 v64, a48
v_accvgpr_read_b32 v65, a49
v_accvgpr_read_b32 v66, a50
v_accvgpr_read_b32 v67, a51
v_accvgpr_read_b32 v68, a52
v_accvgpr_read_b32 v69, a53
v_accvgpr_read_b32 v70, a54
v_accvgpr_read_b32 v71, a55
v_accvgpr_read_b32 v72, a56
v_accvgpr_read_b32 v73, a57
v_accvgpr_read_b32 v74, a58
v_accvgpr_read_b32 v75, a59
v_accvgpr_read_b32 v76, a60
v_accvgpr_read_b32 v77, a61
v_accvgpr_read_b32 v78, a62
v_accvgpr_read_b32 v79, a63
v_accvgpr_read_b32 v208, a64
v_accvgpr_read_b32 v209, a65
v_accvgpr_read_b32 v210, a66
v_accvgpr_read_b32 v211, a67
v_accvgpr_read_b32 v212, a68
v_accvgpr_read_b32 v213, a69
v_accvgpr_read_b32 v214, a70
v_accvgpr_read_b32 v215, a71
v_accvgpr_read_b32 v216, a72
v_accvgpr_read_b32 v217, a73
v_accvgpr_read_b32 v218, a74
v_accvgpr_read_b32 v219, a75
v_accvgpr_read_b32 v220, a76
v_accvgpr_read_b32 v221, a77
v_accvgpr_read_b32 v222, a78
v_accvgpr_read_b32 v223, a79
v_accvgpr_read_b32 v224, a80
v_accvgpr_read_b32 v225, a81
v_accvgpr_read_b32 v226, a82
v_accvgpr_read_b32 v227, a83
v_accvgpr_read_b32 v228, a84
v_accvgpr_read_b32 v229, a85
v_accvgpr_read_b32 v230, a86
v_accvgpr_read_b32 v231, a87
v_accvgpr_read_b32 v232, a88
v_accvgpr_read_b32 v233, a89
v_accvgpr_read_b32 v234, a90
v_accvgpr_read_b32 v235, a91
v_accvgpr_read_b32 v236, a92
v_accvgpr_read_b32 v237, a93
v_accvgpr_read_b32 v238, a94
v_accvgpr_read_b32 v239, a95
s_lshl_b32 s12, s22, 2
s_add_u32 s12, s12, s16
s_min_u32 s12, s12, 512
s_lshr_b32 s23, s12, 7
s_xnor_b32 s23, s23, s98
s_and_b32 s23, s23, 1
s_lshl_b32 s23, s23, 13
s_mul_i32 s13, s12, 16384
s_add_u32 s13, s13, 171966464
s_add_u32 s13, s13, s23
s_lshr_b32 s23, s12, 6
s_xnor_b32 s23, s23, s98
s_and_b32 s23, s23, 1
s_lshl_b32 s23, s23, 13
s_mul_i32 s12, s12, 32768
s_add_u32 s12, s12, 92274688
s_add_u32 s12, s12, s23
buffer_load_dwordx2 a[0:1], v5, s[84:87], s12 offen offset:0 sc1
buffer_load_dwordx2 a[2:3], v5, s[84:87], s12 offen offset:512 sc1
buffer_load_dwordx2 a[4:5], v5, s[84:87], s12 offen offset:1024 sc1
buffer_load_dwordx2 a[6:7], v5, s[84:87], s12 offen offset:1536 sc1
buffer_load_dwordx2 a[8:9], v5, s[84:87], s12 offen offset:2048 sc1
buffer_load_dwordx2 a[10:11], v5, s[84:87], s12 offen offset:2560 sc1
buffer_load_dwordx2 a[12:13], v5, s[84:87], s12 offen offset:3072 sc1
buffer_load_dwordx2 a[14:15], v5, s[84:87], s12 offen offset:3584 sc1
s_add_u32 s12, s12, 4096
buffer_load_dwordx2 a[16:17], v5, s[84:87], s12 offen offset:0 sc1
buffer_load_dwordx2 a[18:19], v5, s[84:87], s12 offen offset:512 sc1
buffer_load_dwordx2 a[20:21], v5, s[84:87], s12 offen offset:1024 sc1
buffer_load_dwordx2 a[22:23], v5, s[84:87], s12 offen offset:1536 sc1
buffer_load_dwordx2 a[24:25], v5, s[84:87], s12 offen offset:2048 sc1
buffer_load_dwordx2 a[26:27], v5, s[84:87], s12 offen offset:2560 sc1
buffer_load_dwordx2 a[28:29], v5, s[84:87], s12 offen offset:3072 sc1
buffer_load_dwordx2 a[30:31], v5, s[84:87], s12 offen offset:3584 sc1
s_add_u32 s12, s12, 12288
buffer_load_dwordx2 a[32:33], v5, s[84:87], s12 offen offset:0 sc1
buffer_load_dwordx2 a[34:35], v5, s[84:87], s12 offen offset:512 sc1
buffer_load_dwordx2 a[36:37], v5, s[84:87], s12 offen offset:1024 sc1
buffer_load_dwordx2 a[38:39], v5, s[84:87], s12 offen offset:1536 sc1
buffer_load_dwordx2 a[40:41], v5, s[84:87], s12 offen offset:2048 sc1
buffer_load_dwordx2 a[42:43], v5, s[84:87], s12 offen offset:2560 sc1
buffer_load_dwordx2 a[44:45], v5, s[84:87], s12 offen offset:3072 sc1
buffer_load_dwordx2 a[46:47], v5, s[84:87], s12 offen offset:3584 sc1
s_add_u32 s12, s12, 4096
buffer_load_dwordx2 a[48:49], v5, s[84:87], s12 offen offset:0 sc1
buffer_load_dwordx2 a[50:51], v5, s[84:87], s12 offen offset:512 sc1
buffer_load_dwordx2 a[52:53], v5, s[84:87], s12 offen offset:1024 sc1
buffer_load_dwordx2 a[54:55], v5, s[84:87], s12 offen offset:1536 sc1
buffer_load_dwordx2 a[56:57], v5, s[84:87], s12 offen offset:2048 sc1
buffer_load_dwordx2 a[58:59], v5, s[84:87], s12 offen offset:2560 sc1
buffer_load_dwordx2 a[60:61], v5, s[84:87], s12 offen offset:3072 sc1
buffer_load_dwordx2 a[62:63], v5, s[84:87], s12 offen offset:3584 sc1
s_add_u32 s12, s12, 4096
buffer_load_dword a64, v11, s[84:87], s13 offen offset:0 sc1
buffer_load_dword a65, v11, s[84:87], s13 offen offset:128 sc1
buffer_load_dword a66, v11, s[84:87], s13 offen offset:256 sc1
buffer_load_dword a67, v11, s[84:87], s13 offen offset:384 sc1
buffer_load_dword a68, v11, s[84:87], s13 offen offset:512 sc1
buffer_load_dword a69, v11, s[84:87], s13 offen offset:640 sc1
buffer_load_dword a70, v11, s[84:87], s13 offen offset:768 sc1
buffer_load_dword a71, v11, s[84:87], s13 offen offset:896 sc1
buffer_load_dword a72, v11, s[84:87], s13 offen offset:1024 sc1
buffer_load_dword a73, v11, s[84:87], s13 offen offset:1152 sc1
buffer_load_dword a74, v11, s[84:87], s13 offen offset:1280 sc1
buffer_load_dword a75, v11, s[84:87], s13 offen offset:1408 sc1
buffer_load_dword a76, v11, s[84:87], s13 offen offset:1536 sc1
buffer_load_dword a77, v11, s[84:87], s13 offen offset:1664 sc1
buffer_load_dword a78, v11, s[84:87], s13 offen offset:1792 sc1
buffer_load_dword a79, v11, s[84:87], s13 offen offset:1920 sc1
buffer_load_dword a80, v11, s[84:87], s13 offen offset:2048 sc1
buffer_load_dword a81, v11, s[84:87], s13 offen offset:2176 sc1
buffer_load_dword a82, v11, s[84:87], s13 offen offset:2304 sc1
buffer_load_dword a83, v11, s[84:87], s13 offen offset:2432 sc1
buffer_load_dword a84, v11, s[84:87], s13 offen offset:2560 sc1
buffer_load_dword a85, v11, s[84:87], s13 offen offset:2688 sc1
buffer_load_dword a86, v11, s[84:87], s13 offen offset:2816 sc1
buffer_load_dword a87, v11, s[84:87], s13 offen offset:2944 sc1
buffer_load_dword a88, v11, s[84:87], s13 offen offset:3072 sc1
buffer_load_dword a89, v11, s[84:87], s13 offen offset:3200 sc1
buffer_load_dword a90, v11, s[84:87], s13 offen offset:3328 sc1
buffer_load_dword a91, v11, s[84:87], s13 offen offset:3456 sc1
buffer_load_dword a92, v11, s[84:87], s13 offen offset:3584 sc1
buffer_load_dword a93, v11, s[84:87], s13 offen offset:3712 sc1
buffer_load_dword a94, v11, s[84:87], s13 offen offset:3840 sc1
buffer_load_dword a95, v11, s[84:87], s13 offen offset:3968 sc1
v_pk_add_f32 v[14:15], v[16:17], v[48:49] neg_lo:[0,1] neg_hi:[0,1]
v_pk_add_f32 v[16:17], v[16:17], v[48:49]
v_pk_add_f32 v[48:49], v[18:19], v[50:51] neg_lo:[0,1] neg_hi:[0,1]
v_pk_add_f32 v[18:19], v[18:19], v[50:51]
v_pk_mul_f32 v[50:51], v[48:49], s[50:51] op_sel:[0,0] op_sel_hi:[0,1] neg_lo:[0,0] neg_hi:[0,1]
v_pk_fma_f32 v[50:51], v[48:49], s[50:51], v[50:51] op_sel:[1,1,0] op_sel_hi:[1,0,1] neg_lo:[0,0,0] neg_hi:[0,0,0]
v_pk_add_f32 v[48:49], v[20:21], v[52:53] neg_lo:[0,1] neg_hi:[0,1]
v_pk_add_f32 v[20:21], v[20:21], v[52:53]
v_pk_mul_f32 v[52:53], v[48:49], s[54:55] op_sel:[0,0] op_sel_hi:[0,1] neg_lo:[0,0] neg_hi:[0,1]
v_pk_fma_f32 v[52:53], v[48:49], s[54:55], v[52:53] op_sel:[1,1,0] op_sel_hi:[1,0,1] neg_lo:[0,0,0] neg_hi:[0,0,0]
v_pk_add_f32 v[48:49], v[22:23], v[54:55] neg_lo:[0,1] neg_hi:[0,1]
v_pk_add_f32 v[22:23], v[22:23], v[54:55]
v_pk_mul_f32 v[54:55], v[48:49], s[58:59] op_sel:[0,0] op_sel_hi:[0,1] neg_lo:[0,0] neg_hi:[0,1]
v_pk_fma_f32 v[54:55], v[48:49], s[58:59], v[54:55] op_sel:[1,1,0] op_sel_hi:[1,0,1] neg_lo:[0,0,0] neg_hi:[0,0,0]
v_pk_add_f32 v[48:49], v[24:25], v[56:57] neg_lo:[0,1] neg_hi:[0,1]
v_pk_add_f32 v[24:25], v[24:25], v[56:57]
v_pk_mul_f32 v[56:57], v[48:49], s[62:63] op_sel:[0,0] op_sel_hi:[0,1] neg_lo:[0,0] neg_hi:[0,1]
v_pk_fma_f32 v[56:57], v[48:49], s[62:63], v[56:57] op_sel:[1,1,0] op_sel_hi:[1,0,1] neg_lo:[0,0,0] neg_hi:[0,0,0]
v_pk_add_f32 v[48:49], v[26:27], v[58:59] neg_lo:[0,1] neg_hi:[0,1]
v_pk_add_f32 v[26:27], v[26:27], v[58:59]
v_pk_mul_f32 v[58:59], v[48:49], s[58:59] op_sel:[0,1] op_sel_hi:[0,0] neg_lo:[0,0] neg_hi:[0,1]
v_pk_fma_f32 v[58:59], v[48:49], s[58:59], v[58:59] op_sel:[1,0,0] op_sel_hi:[1,1,1] neg_lo:[0,0,0] neg_hi:[0,0,0]
v_pk_add_f32 v[48:49], v[28:29], v[60:61] neg_lo:[0,1] neg_hi:[0,1]
v_pk_add_f32 v[28:29], v[28:29], v[60:61]
v_pk_mul_f32 v[60:61], v[48:49], s[54:55] op_sel:[0,1] op_sel_hi:[0,0] neg_lo:[0,0] neg_hi:[0,1]
v_pk_fma_f32 v[60:61], v[48:49], s[54:55], v[60:61] op_sel:[1,0,0] op_sel_hi:[1,1,1] neg_lo:[0,0,0] neg_hi:[0,0,0]
v_pk_add_f32 v[48:49], v[30:31], v[62:63] neg_lo:[0,1] neg_hi:[0,1]
v_pk_add_f32 v[30:31], v[30:31], v[62:63]
v_pk_mul_f32 v[62:63], v[48:49], s[50:51] op_sel:[0,1] op_sel_hi:[0,0] neg_lo:[0,0] neg_hi:[0,1]
v_pk_fma_f32 v[62:63], v[48:49], s[50:51], v[62:63] op_sel:[1,0,0] op_sel_hi:[1,1,1] neg_lo:[0,0,0] neg_hi:[0,0,0]
v_pk_add_f32 v[48:49], v[32:33], v[64:65] op_sel:[1,1] op_sel_hi:[0,0] neg_lo:[0,1] neg_hi:[1,0]
v_pk_add_f32 v[32:33], v[32:33], v[64:65]
v_pk_add_f32 v[64:65], v[34:35], v[66:67] neg_lo:[0,1] neg_hi:[0,1]
v_pk_add_f32 v[34:35], v[34:35], v[66:67]
v_pk_mul_f32 v[66:67], v[64:65], s[50:51] op_sel:[0,1] op_sel_hi:[0,0] neg_lo:[0,1] neg_hi:[0,1]
v_pk_fma_f32 v[66:67], v[64:65], s[50:51], v[66:67] op_sel:[1,0,0] op_sel_hi:[1,1,1] neg_lo:[0,0,0] neg_hi:[0,1,0]
v_pk_add_f32 v[64:65], v[36:37], v[68:69] neg_lo:[0,1] neg_hi:[0,1]
v_pk_add_f32 v[36:37], v[36:37], v[68:69]
v_pk_mul_f32 v[68:69], v[64:65], s[54:55] op_sel:[0,1] op_sel_hi:[0,0] neg_lo:[0,1] neg_hi:[0,1]
v_pk_fma_f32 v[68:69], v[64:65], s[54:55], v[68:69] op_sel:[1,0,0] op_sel_hi:[1,1,1] neg_lo:[0,0,0] neg_hi:[0,1,0]
v_pk_add_f32 v[64:65], v[38:39], v[70:71] neg_lo:[0,1] neg_hi:[0,1]
v_pk_add_f32 v[38:39], v[38:39], v[70:71]
v_pk_mul_f32 v[70:71], v[64:65], s[58:59] op_sel:[0,1] op_sel_hi:[0,0] neg_lo:[0,1] neg_hi:[0,1]
v_pk_fma_f32 v[70:71], v[64:65], s[58:59], v[70:71] op_sel:[1,0,0] op_sel_hi:[1,1,1] neg_lo:[0,0,0] neg_hi:[0,1,0]
v_pk_add_f32 v[64:65], v[40:41], v[72:73] neg_lo:[0,1] neg_hi:[0,1]
v_pk_add_f32 v[40:41], v[40:41], v[72:73]
v_pk_mul_f32 v[72:73], v[64:65], s[62:63] op_sel:[0,0] op_sel_hi:[0,1] neg_lo:[0,1] neg_hi:[0,1]
v_pk_fma_f32 v[72:73], v[64:65], s[62:63], v[72:73] op_sel:[1,1,0] op_sel_hi:[1,0,1] neg_lo:[0,0,0] neg_hi:[0,1,0]
v_pk_add_f32 v[64:65], v[42:43], v[74:75] neg_lo:[0,1] neg_hi:[0,1]
v_pk_add_f32 v[42:43], v[42:43], v[74:75]
v_pk_mul_f32 v[74:75], v[64:65], s[58:59] op_sel:[0,0] op_sel_hi:[0,1] neg_lo:[0,1] neg_hi:[0,1]
v_pk_fma_f32 v[74:75], v[64:65], s[58:59], v[74:75] op_sel:[1,1,0] op_sel_hi:[1,0,1] neg_lo:[0,0,0] neg_hi:[0,1,0]
v_pk_add_f32 v[64:65], v[44:45], v[76:77] neg_lo:[0,1] neg_hi:[0,1]
v_pk_add_f32 v[44:45], v[44:45], v[76:77]
v_pk_mul_f32 v[76:77], v[64:65], s[54:55] op_sel:[0,0] op_sel_hi:[0,1] neg_lo:[0,1] neg_hi:[0,1]
v_pk_fma_f32 v[76:77], v[64:65], s[54:55], v[76:77] op_sel:[1,1,0] op_sel_hi:[1,0,1] neg_lo:[0,0,0] neg_hi:[0,1,0]
v_pk_add_f32 v[64:65], v[46:47], v[78:79] neg_lo:[0,1] neg_hi:[0,1]
v_pk_add_f32 v[46:47], v[46:47], v[78:79]
v_pk_mul_f32 v[78:79], v[64:65], s[50:51] op_sel:[0,0] op_sel_hi:[0,1] neg_lo:[0,1] neg_hi:[0,1]
v_pk_fma_f32 v[78:79], v[64:65], s[50:51], v[78:79] op_sel:[1,1,0] op_sel_hi:[1,0,1] neg_lo:[0,0,0] neg_hi:[0,1,0]
v_pk_add_f32 v[64:65], v[16:17], v[32:33] neg_lo:[0,1] neg_hi:[0,1]
v_pk_add_f32 v[16:17], v[16:17], v[32:33]
v_pk_add_f32 v[32:33], v[18:19], v[34:35] neg_lo:[0,1] neg_hi:[0,1]
v_pk_add_f32 v[18:19], v[18:19], v[34:35]
v_pk_mul_f32 v[34:35], v[32:33], s[54:55] op_sel:[0,0] op_sel_hi:[0,1] neg_lo:[0,0] neg_hi:[0,1]
v_pk_fma_f32 v[34:35], v[32:33], s[54:55], v[34:35] op_sel:[1,1,0] op_sel_hi:[1,0,1] neg_lo:[0,0,0] neg_hi:[0,0,0]
v_pk_add_f32 v[32:33], v[20:21], v[36:37] neg_lo:[0,1] neg_hi:[0,1]
v_pk_add_f32 v[20:21], v[20:21], v[36:37]
v_pk_mul_f32 v[36:37], v[32:33], s[62:63] op_sel:[0,0] op_sel_hi:[0,1] neg_lo:[0,0] neg_hi:[0,1]
v_pk_fma_f32 v[36:37], v[32:33], s[62:63], v[36:37] op_sel:[1,1,0] op_sel_hi:[1,0,1] neg_lo:[0,0,0] neg_hi:[0,0,0]
v_pk_add_f32 v[32:33], v[22:23], v[38:39] neg_lo:[0,1] neg_hi:[0,1]
v_pk_add_f32 v[22:23], v[22:23], v[38:39]
v_pk_mul_f32 v[38:39], v[32:33], s[54:55] op_sel:[0,1] op_sel_hi:[0,0] neg_lo:[0,0] neg_hi:[0,1]
v_pk_fma_f32 v[38:39], v[32:33], s[54:55], v[38:39] op_sel:[1,0,0] op_sel_hi:[1,1,1] neg_lo:[0,0,0] neg_hi:[0,0,0]
v_pk_add_f32 v[32:33], v[24:25], v[40:41] op_sel:[1,1] op_sel_hi:[0,0] neg_lo:[0,1] neg_hi:[1,0]
v_pk_add_f32 v[24:25], v[24:25], v[40:41]
v_pk_add_f32 v[40:41], v[26:27], v[42:43] neg_lo:[0,1] neg_hi:[0,1]
v_pk_add_f32 v[26:27], v[26:27], v[42:43]
v_pk_mul_f32 v[42:43], v[40:41], s[54:55] op_sel:[0,1] op_sel_hi:[0,0] neg_lo:[0,1] neg_hi:[0,1]
v_pk_fma_f32 v[42:43], v[40:41], s[54:55], v[42:43] op_sel:[1,0,0] op_sel_hi:[1,1,1] neg_lo:[0,0,0] neg_hi:[0,1,0]
v_pk_add_f32 v[40:41], v[28:29], v[44:45] neg_lo:[0,1] neg_hi:[0,1]
v_pk_add_f32 v[28:29], v[28:29], v[44:45]
v_pk_mul_f32 v[44:45], v[40:41], s[62:63] op_sel:[0,0] op_sel_hi:[0,1] neg_lo:[0,1] neg_hi:[0,1]
v_pk_fma_f32 v[44:45], v[40:41], s[62:63], v[44:45] op_sel:[1,1,0] op_sel_hi:[1,0,1] neg_lo:[0,0,0] neg_hi:[0,1,0]
v_pk_add_f32 v[40:41], v[30:31], v[46:47] neg_lo:[0,1] neg_hi:[0,1]
v_pk_add_f32 v[30:31], v[30:31], v[46:47]
v_pk_mul_f32 v[46:47], v[40:41], s[54:55] op_sel:[0,0] op_sel_hi:[0,1] neg_lo:[0,1] neg_hi:[0,1]
v_pk_fma_f32 v[46:47], v[40:41], s[54:55], v[46:47] op_sel:[1,1,0] op_sel_hi:[1,0,1] neg_lo:[0,0,0] neg_hi:[0,1,0]
v_pk_add_f32 v[40:41], v[14:15], v[48:49] neg_lo:[0,1] neg_hi:[0,1]
v_pk_add_f32 v[14:15], v[14:15], v[48:49]
v_pk_add_f32 v[48:49], v[50:51], v[66:67] neg_lo:[0,1] neg_hi:[0,1]
v_pk_add_f32 v[50:51], v[50:51], v[66:67]
v_pk_mul_f32 v[66:67], v[48:49], s[54:55] op_sel:[0,0] op_sel_hi:[0,1] neg_lo:[0,0] neg_hi:[0,1]
v_pk_fma_f32 v[66:67], v[48:49], s[54:55], v[66:67] op_sel:[1,1,0] op_sel_hi:[1,0,1] neg_lo:[0,0,0] neg_hi:[0,0,0]
v_pk_add_f32 v[48:49], v[52:53], v[68:69] neg_lo:[0,1] neg_hi:[0,1]
v_pk_add_f32 v[52:53], v[52:53], v[68:69]
v_pk_mul_f32 v[68:69], v[48:49], s[62:63] op_sel:[0,0] op_sel_hi:[0,1] neg_lo:[0,0] neg_hi:[0,1]
v_pk_fma_f32 v[68:69], v[48:49], s[62:63], v[68:69] op_sel:[1,1,0] op_sel_hi:[1,0,1] neg_lo:[0,0,0] neg_hi:[0,0,0]
v_pk_add_f32 v[48:49], v[54:55], v[70:71] neg_lo:[0,1] neg_hi:[0,1]
v_pk_add_f32 v[54:55], v[54:55], v[70:71]
v_pk_mul_f32 v[70:71], v[48:49], s[54:55] op_sel:[0,1] op_sel_hi:[0,0] neg_lo:[0,0] neg_hi:[0,1]
v_pk_fma_f32 v[70:71], v[48:49], s[54:55], v[70:71] op_sel:[1,0,0] op_sel_hi:[1,1,1] neg_lo:[0,0,0] neg_hi:[0,0,0]
v_pk_add_f32 v[48:49], v[56:57], v[72:73] op_sel:[1,1] op_sel_hi:[0,0] neg_lo:[0,1] neg_hi:[1,0]
v_pk_add_f32 v[56:57], v[56:57], v[72:73]
v_pk_add_f32 v[72:73], v[58:59], v[74:75] neg_lo:[0,1] neg_hi:[0,1]
v_pk_add_f32 v[58:59], v[58:59], v[74:75]
v_pk_mul_f32 v[74:75], v[72:73], s[54:55] op_sel:[0,1] op_sel_hi:[0,0] neg_lo:[0,1] neg_hi:[0,1]
v_pk_fma_f32 v[74:75], v[72:73], s[54:55], v[74:75] op_sel:[1,0,0] op_sel_hi:[1,1,1] neg_lo:[0,0,0] neg_hi:[0,1,0]
v_pk_add_f32 v[72:73], v[60:61], v[76:77] neg_lo:[0,1] neg_hi:[0,1]
v_pk_add_f32 v[60:61], v[60:61], v[76:77]
v_pk_mul_f32 v[76:77], v[72:73], s[62:63] op_sel:[0,0] op_sel_hi:[0,1] neg_lo:[0,1] neg_hi:[0,1]
v_pk_fma_f32 v[76:77], v[72:73], s[62:63], v[76:77] op_sel:[1,1,0] op_sel_hi:[1,0,1] neg_lo:[0,0,0] neg_hi:[0,1,0]
v_pk_add_f32 v[72:73], v[62:63], v[78:79] neg_lo:[0,1] neg_hi:[0,1]
v_pk_add_f32 v[62:63], v[62:63], v[78:79]
v_pk_mul_f32 v[78:79], v[72:73], s[54:55] op_sel:[0,0] op_sel_hi:[0,1] neg_lo:[0,1] neg_hi:[0,1]
v_pk_fma_f32 v[78:79], v[72:73], s[54:55], v[78:79] op_sel:[1,1,0] op_sel_hi:[1,0,1] neg_lo:[0,0,0] neg_hi:[0,1,0]
v_pk_add_f32 v[72:73], v[16:17], v[24:25] neg_lo:[0,1] neg_hi:[0,1]
v_pk_add_f32 v[16:17], v[16:17], v[24:25]
v_pk_add_f32 v[24:25], v[18:19], v[26:27] neg_lo:[0,1] neg_hi:[0,1]
v_pk_add_f32 v[18:19], v[18:19], v[26:27]
v_pk_mul_f32 v[26:27], v[24:25], s[62:63] op_sel:[0,0] op_sel_hi:[0,1] neg_lo:[0,0] neg_hi:[0,1]
v_pk_fma_f32 v[26:27], v[24:25], s[62:63], v[26:27] op_sel:[1,1,0] op_sel_hi:[1,0,1] neg_lo:[0,0,0] neg_hi:[0,0,0]
v_pk_add_f32 v[24:25], v[20:21], v[28:29] op_sel:[1,1] op_sel_hi:[0,0] neg_lo:[0,1] neg_hi:[1,0]
v_pk_add_f32 v[20:21], v[20:21], v[28:29]
v_pk_add_f32 v[28:29], v[22:23], v[30:31] neg_lo:[0,1] neg_hi:[0,1]
v_pk_add_f32 v[22:23], v[22:23], v[30:31]
v_pk_mul_f32 v[30:31], v[28:29], s[62:63] op_sel:[0,0] op_sel_hi:[0,1] neg_lo:[0,1] neg_hi:[0,1]
v_pk_fma_f32 v[30:31], v[28:29], s[62:63], v[30:31] op_sel:[1,1,0] op_sel_hi:[1,0,1] neg_lo:[0,0,0] neg_hi:[0,1,0]
v_pk_add_f32 v[28:29], v[64:65], v[32:33] neg_lo:[0,1] neg_hi:[0,1]
v_pk_add_f32 v[64:65], v[64:65], v[32:33]
v_pk_add_f32 v[32:33], v[34:35], v[42:43] neg_lo:[0,1] neg_hi:[0,1]
v_pk_add_f32 v[34:35], v[34:35], v[42:43]
v_pk_mul_f32 v[42:43], v[32:33], s[62:63] op_sel:[0,0] op_sel_hi:[0,1] neg_lo:[0,0] neg_hi:[0,1]
v_pk_fma_f32 v[42:43], v[32:33], s[62:63], v[42:43] op_sel:[1,1,0] op_sel_hi:[1,0,1] neg_lo:[0,0,0] neg_hi:[0,0,0]
v_pk_add_f32 v[32:33], v[36:37], v[44:45] op_sel:[1,1] op_sel_hi:[0,0] neg_lo:[0,1] neg_hi:[1,0]
v_pk_add_f32 v[36:37], v[36:37], v[44:45]
v_pk_add_f32 v[44:45], v[38:39], v[46:47] neg_lo:[0,1] neg_hi:[0,1]
v_pk_add_f32 v[38:39], v[38:39], v[46:47]
v_pk_mul_f32 v[46:47], v[44:45], s[62:63] op_sel:[0,0] op_sel_hi:[0,1] neg_lo:[0,1] neg_hi:[0,1]
v_pk_fma_f32 v[46:47], v[44:45], s[62:63], v[46:47] op_sel:[1,1,0] op_sel_hi:[1,0,1] neg_lo:[0,0,0] neg_hi:[0,1,0]
v_pk_add_f32 v[44:45], v[14:15], v[56:57] neg_lo:[0,1] neg_hi:[0,1]
v_pk_add_f32 v[14:15], v[14:15], v[56:57]
v_pk_add_f32 v[56:57], v[50:51], v[58:59] neg_lo:[0,1] neg_hi:[0,1]
v_pk_add_f32 v[50:51], v[50:51], v[58:59]
v_pk_mul_f32 v[58:59], v[56:57], s[62:63] op_sel:[0,0] op_sel_hi:[0,1] neg_lo:[0,0] neg_hi:[0,1]
v_pk_fma_f32 v[58:59], v[56:57], s[62:63], v[58:59] op_sel:[1,1,0] op_sel_hi:[1,0,1] neg_lo:[0,0,0] neg_hi:[0,0,0]
v_pk_add_f32 v[56:57], v[52:53], v[60:61] op_sel:[1,1] op_sel_hi:[0,0] neg_lo:[0,1] neg_hi:[1,0]
v_pk_add_f32 v[52:53], v[52:53], v[60:61]
v_pk_add_f32 v[60:61], v[54:55], v[62:63] neg_lo:[0,1] neg_hi:[0,1]
v_pk_add_f32 v[54:55], v[54:55], v[62:63]
v_pk_mul_f32 v[62:63], v[60:61], s[62:63] op_sel:[0,0] op_sel_hi:[0,1] neg_lo:[0,1] neg_hi:[0,1]
v_pk_fma_f32 v[62:63], v[60:61], s[62:63], v[62:63] op_sel:[1,1,0] op_sel_hi:[1,0,1] neg_lo:[0,0,0] neg_hi:[0,1,0]
v_pk_add_f32 v[60:61], v[40:41], v[48:49] neg_lo:[0,1] neg_hi:[0,1]
v_pk_add_f32 v[40:41], v[40:41], v[48:49]
v_pk_add_f32 v[48:49], v[66:67], v[74:75] neg_lo:[0,1] neg_hi:[0,1]
v_pk_add_f32 v[66:67], v[66:67], v[74:75]
v_pk_mul_f32 v[74:75], v[48:49], s[62:63] op_sel:[0,0] op_sel_hi:[0,1] neg_lo:[0,0] neg_hi:[0,1]
v_pk_fma_f32 v[74:75], v[48:49], s[62:63], v[74:75] op_sel:[1,1,0] op_sel_hi:[1,0,1] neg_lo:[0,0,0] neg_hi:[0,0,0]
v_pk_add_f32 v[48:49], v[68:69], v[76:77] op_sel:[1,1] op_sel_hi:[0,0] neg_lo:[0,1] neg_hi:[1,0]
v_pk_add_f32 v[68:69], v[68:69], v[76:77]
v_pk_add_f32 v[76:77], v[70:71], v[78:79] neg_lo:[0,1] neg_hi:[0,1]
v_pk_add_f32 v[70:71], v[70:71], v[78:79]
v_pk_mul_f32 v[78:79], v[76:77], s[62:63] op_sel:[0,0] op_sel_hi:[0,1] neg_lo:[0,1] neg_hi:[0,1]
v_pk_fma_f32 v[78:79], v[76:77], s[62:63], v[78:79] op_sel:[1,1,0] op_sel_hi:[1,0,1] neg_lo:[0,0,0] neg_hi:[0,1,0]
v_pk_add_f32 v[76:77], v[16:17], v[20:21] neg_lo:[0,1] neg_hi:[0,1]
v_pk_add_f32 v[16:17], v[16:17], v[20:21]
v_pk_add_f32 v[20:21], v[18:19], v[22:23] op_sel:[1,1] op_sel_hi:[0,0] neg_lo:[0,1] neg_hi:[1,0]
v_pk_add_f32 v[18:19], v[18:19], v[22:23]
v_pk_add_f32 v[22:23], v[72:73], v[24:25] neg_lo:[0,1] neg_hi:[0,1]
v_pk_add_f32 v[72:73], v[72:73], v[24:25]
v_pk_add_f32 v[24:25], v[26:27], v[30:31] op_sel:[1,1] op_sel_hi:[0,0] neg_lo:[0,1] neg_hi:[1,0]
v_pk_add_f32 v[26:27], v[26:27], v[30:31]
v_pk_add_f32 v[30:31], v[64:65], v[36:37] neg_lo:[0,1] neg_hi:[0,1]
v_pk_add_f32 v[64:65], v[64:65], v[36:37]
v_pk_add_f32 v[36:37], v[34:35], v[38:39] op_sel:[1,1] op_sel_hi:[0,0] neg_lo:[0,1] neg_hi:[1,0]
v_pk_add_f32 v[34:35], v[34:35], v[38:39]
v_pk_add_f32 v[38:39], v[28:29], v[32:33] neg_lo:[0,1] neg_hi:[0,1]
v_pk_add_f32 v[28:29], v[28:29], v[32:33]
v_pk_add_f32 v[32:33], v[42:43], v[46:47] op_sel:[1,1] op_sel_hi:[0,0] neg_lo:[0,1] neg_hi:[1,0]
v_pk_add_f32 v[42:43], v[42:43], v[46:47]
v_pk_add_f32 v[46:47], v[14:15], v[52:53] neg_lo:[0,1] neg_hi:[0,1]
v_pk_add_f32 v[14:15], v[14:15], v[52:53]
v_pk_add_f32 v[52:53], v[50:51], v[54:55] op_sel:[1,1] op_sel_hi:[0,0] neg_lo:[0,1] neg_hi:[1,0]
v_pk_add_f32 v[50:51], v[50:51], v[54:55]
v_pk_add_f32 v[54:55], v[44:45], v[56:57] neg_lo:[0,1] neg_hi:[0,1]
v_pk_add_f32 v[44:45], v[44:45], v[56:57]
v_pk_add_f32 v[56:57], v[58:59], v[62:63] op_sel:[1,1] op_sel_hi:[0,0] neg_lo:[0,1] neg_hi:[1,0]
v_pk_add_f32 v[58:59], v[58:59], v[62:63]
v_pk_add_f32 v[62:63], v[40:41], v[68:69] neg_lo:[0,1] neg_hi:[0,1]
v_pk_add_f32 v[40:41], v[40:41], v[68:69]
v_pk_add_f32 v[68:69], v[66:67], v[70:71] op_sel:[1,1] op_sel_hi:[0,0] neg_lo:[0,1] neg_hi:[1,0]
v_pk_add_f32 v[66:67], v[66:67], v[70:71]
v_pk_add_f32 v[70:71], v[60:61], v[48:49] neg_lo:[0,1] neg_hi:[0,1]
v_pk_add_f32 v[60:61], v[60:61], v[48:49]
v_pk_add_f32 v[48:49], v[74:75], v[78:79] op_sel:[1,1] op_sel_hi:[0,0] neg_lo:[0,1] neg_hi:[1,0]
v_pk_add_f32 v[74:75], v[74:75], v[78:79]
v_pk_add_f32 v[78:79], v[16:17], v[18:19] neg_lo:[0,1] neg_hi:[0,1]
v_pk_add_f32 v[16:17], v[16:17], v[18:19]
v_pk_add_f32 v[18:19], v[76:77], v[20:21] neg_lo:[0,1] neg_hi:[0,1]
v_pk_add_f32 v[76:77], v[76:77], v[20:21]
v_pk_add_f32 v[20:21], v[72:73], v[26:27] neg_lo:[0,1] neg_hi:[0,1]
v_pk_add_f32 v[72:73], v[72:73], v[26:27]
v_pk_add_f32 v[26:27], v[22:23], v[24:25] neg_lo:[0,1] neg_hi:[0,1]
v_pk_add_f32 v[22:23], v[22:23], v[24:25]
v_pk_add_f32 v[24:25], v[64:65], v[34:35] neg_lo:[0,1] neg_hi:[0,1]
v_pk_add_f32 v[64:65], v[64:65], v[34:35]
v_pk_add_f32 v[34:35], v[30:31], v[36:37] neg_lo:[0,1] neg_hi:[0,1]
v_pk_add_f32 v[30:31], v[30:31], v[36:37]
v_pk_add_f32 v[36:37], v[28:29], v[42:43] neg_lo:[0,1] neg_hi:[0,1]
v_pk_add_f32 v[28:29], v[28:29], v[42:43]
v_pk_add_f32 v[42:43], v[38:39], v[32:33] neg_lo:[0,1] neg_hi:[0,1]
v_pk_add_f32 v[38:39], v[38:39], v[32:33]
v_pk_add_f32 v[32:33], v[14:15], v[50:51] neg_lo:[0,1] neg_hi:[0,1]
v_pk_add_f32 v[14:15], v[14:15], v[50:51]
v_pk_add_f32 v[50:51], v[46:47], v[52:53] neg_lo:[0,1] neg_hi:[0,1]
v_pk_add_f32 v[46:47], v[46:47], v[52:53]
v_pk_add_f32 v[52:53], v[44:45], v[58:59] neg_lo:[0,1] neg_hi:[0,1]
v_pk_add_f32 v[44:45], v[44:45], v[58:59]
v_pk_add_f32 v[58:59], v[54:55], v[56:57] neg_lo:[0,1] neg_hi:[0,1]
v_pk_add_f32 v[54:55], v[54:55], v[56:57]
v_pk_add_f32 v[56:57], v[40:41], v[66:67] neg_lo:[0,1] neg_hi:[0,1]
v_pk_add_f32 v[40:41], v[40:41], v[66:67]
v_pk_add_f32 v[66:67], v[62:63], v[68:69] neg_lo:[0,1] neg_hi:[0,1]
v_pk_add_f32 v[62:63], v[62:63], v[68:69]
v_pk_add_f32 v[68:69], v[60:61], v[74:75] neg_lo:[0,1] neg_hi:[0,1]
v_pk_add_f32 v[60:61], v[60:61], v[74:75]
v_pk_add_f32 v[74:75], v[70:71], v[48:49] neg_lo:[0,1] neg_hi:[0,1]
v_pk_add_f32 v[70:71], v[70:71], v[48:49]
v_pk_mul_f32 v[48:49], v[14:15], v[82:83] op_sel:[0,0] op_sel_hi:[0,1] neg_lo:[0,0] neg_hi:[0,0]
v_pk_fma_f32 v[14:15], v[14:15], v[82:83], v[48:49] op_sel:[1,1,0] op_sel_hi:[1,0,1] neg_lo:[0,1,0] neg_hi:[0,0,0]
v_pk_mul_f32 v[48:49], v[64:65], v[84:85] op_sel:[0,0] op_sel_hi:[0,1] neg_lo:[0,0] neg_hi:[0,0]
v_pk_fma_f32 v[64:65], v[64:65], v[84:85], v[48:49] op_sel:[1,1,0] op_sel_hi:[1,0,1] neg_lo:[0,1,0] neg_hi:[0,0,0]
v_pk_mul_f32 v[48:49], v[40:41], v[86:87] op_sel:[0,0] op_sel_hi:[0,1] neg_lo:[0,0] neg_hi:[0,0]
v_pk_fma_f32 v[40:41], v[40:41], v[86:87], v[48:49] op_sel:[1,1,0] op_sel_hi:[1,0,1] neg_lo:[0,1,0] neg_hi:[0,0,0]
v_pk_mul_f32 v[48:49], v[72:73], v[88:89] op_sel:[0,0] op_sel_hi:[0,1] neg_lo:[0,0] neg_hi:[0,0]
v_pk_fma_f32 v[72:73], v[72:73], v[88:89], v[48:49] op_sel:[1,1,0] op_sel_hi:[1,0,1] neg_lo:[0,1,0] neg_hi:[0,0,0]
v_pk_mul_f32 v[48:49], v[44:45], v[90:91] op_sel:[0,0] op_sel_hi:[0,1] neg_lo:[0,0] neg_hi:[0,0]
v_pk_fma_f32 v[44:45], v[44:45], v[90:91], v[48:49] op_sel:[1,1,0] op_sel_hi:[1,0,1] neg_lo:[0,1,0] neg_hi:[0,0,0]
v_pk_mul_f32 v[48:49], v[28:29], v[92:93] op_sel:[0,0] op_sel_hi:[0,1] neg_lo:[0,0] neg_hi:[0,0]
v_pk_fma_f32 v[28:29], v[28:29], v[92:93], v[48:49] op_sel:[1,1,0] op_sel_hi:[1,0,1] neg_lo:[0,1,0] neg_hi:[0,0,0]
v_pk_mul_f32 v[48:49], v[60:61], v[94:95] op_sel:[0,0] op_sel_hi:[0,1] neg_lo:[0,0] neg_hi:[0,0]
v_pk_fma_f32 v[60:61], v[60:61], v[94:95], v[48:49] op_sel:[1,1,0] op_sel_hi:[1,0,1] neg_lo:[0,1,0] neg_hi:[0,0,0]
v_pk_mul_f32 v[48:49], v[76:77], v[96:97] op_sel:[0,0] op_sel_hi:[0,1] neg_lo:[0,0] neg_hi:[0,0]
v_pk_fma_f32 v[76:77], v[76:77], v[96:97], v[48:49] op_sel:[1,1,0] op_sel_hi:[1,0,1] neg_lo:[0,1,0] neg_hi:[0,0,0]
v_pk_mul_f32 v[48:49], v[46:47], v[98:99] op_sel:[0,0] op_sel_hi:[0,1] neg_lo:[0,0] neg_hi:[0,0]
v_pk_fma_f32 v[46:47], v[46:47], v[98:99], v[48:49] op_sel:[1,1,0] op_sel_hi:[1,0,1] neg_lo:[0,1,0] neg_hi:[0,0,0]
v_pk_mul_f32 v[48:49], v[30:31], v[100:101] op_sel:[0,0] op_sel_hi:[0,1] neg_lo:[0,0] neg_hi:[0,0]
v_pk_fma_f32 v[30:31], v[30:31], v[100:101], v[48:49] op_sel:[1,1,0] op_sel_hi:[1,0,1] neg_lo:[0,1,0] neg_hi:[0,0,0]
v_pk_mul_f32 v[48:49], v[62:63], v[102:103] op_sel:[0,0] op_sel_hi:[0,1] neg_lo:[0,0] neg_hi:[0,0]
v_pk_fma_f32 v[62:63], v[62:63], v[102:103], v[48:49] op_sel:[1,1,0] op_sel_hi:[1,0,1] neg_lo:[0,1,0] neg_hi:[0,0,0]
v_pk_mul_f32 v[48:49], v[22:23], v[104:105] op_sel:[0,0] op_sel_hi:[0,1] neg_lo:[0,0] neg_hi:[0,0]
v_pk_fma_f32 v[22:23], v[22:23], v[104:105], v[48:49] op_sel:[1,1,0] op_sel_hi:[1,0,1] neg_lo:[0,1,0] neg_hi:[0,0,0]
v_pk_mul_f32 v[48:49], v[54:55], v[106:107] op_sel:[0,0] op_sel_hi:[0,1] neg_lo:[0,0] neg_hi:[0,0]
v_pk_fma_f32 v[54:55], v[54:55], v[106:107], v[48:49] op_sel:[1,1,0] op_sel_hi:[1,0,1] neg_lo:[0,1,0] neg_hi:[0,0,0]
v_pk_mul_f32 v[48:49], v[38:39], v[108:109] op_sel:[0,0] op_sel_hi:[0,1] neg_lo:[0,0] neg_hi:[0,0]
v_pk_fma_f32 v[38:39], v[38:39], v[108:109], v[48:49] op_sel:[1,1,0] op_sel_hi:[1,0,1] neg_lo:[0,1,0] neg_hi:[0,0,0]
v_pk_mul_f32 v[48:49], v[70:71], v[110:111] op_sel:[0,0] op_sel_hi:[0,1] neg_lo:[0,0] neg_hi:[0,0]
v_pk_fma_f32 v[70:71], v[70:71], v[110:111], v[48:49] op_sel:[1,1,0] op_sel_hi:[1,0,1] neg_lo:[0,1,0] neg_hi:[0,0,0]
v_pk_mul_f32 v[48:49], v[78:79], v[112:113] op_sel:[0,0] op_sel_hi:[0,1] neg_lo:[0,0] neg_hi:[0,0]
v_pk_fma_f32 v[78:79], v[78:79], v[112:113], v[48:49] op_sel:[1,1,0] op_sel_hi:[1,0,1] neg_lo:[0,1,0] neg_hi:[0,0,0]
v_pk_mul_f32 v[48:49], v[32:33], v[114:115] op_sel:[0,0] op_sel_hi:[0,1] neg_lo:[0,0] neg_hi:[0,0]
v_pk_fma_f32 v[32:33], v[32:33], v[114:115], v[48:49] op_sel:[1,1,0] op_sel_hi:[1,0,1] neg_lo:[0,1,0] neg_hi:[0,0,0]
v_pk_mul_f32 v[48:49], v[24:25], v[116:117] op_sel:[0,0] op_sel_hi:[0,1] neg_lo:[0,0] neg_hi:[0,0]
v_pk_fma_f32 v[24:25], v[24:25], v[116:117], v[48:49] op_sel:[1,1,0] op_sel_hi:[1,0,1] neg_lo:[0,1,0] neg_hi:[0,0,0]
v_pk_mul_f32 v[48:49], v[56:57], v[118:119] op_sel:[0,0] op_sel_hi:[0,1] neg_lo:[0,0] neg_hi:[0,0]
v_pk_fma_f32 v[56:57], v[56:57], v[118:119], v[48:49] op_sel:[1,1,0] op_sel_hi:[1,0,1] neg_lo:[0,1,0] neg_hi:[0,0,0]
v_pk_mul_f32 v[48:49], v[20:21], v[120:121] op_sel:[0,0] op_sel_hi:[0,1] neg_lo:[0,0] neg_hi:[0,0]
v_pk_fma_f32 v[20:21], v[20:21], v[120:121], v[48:49] op_sel:[1,1,0] op_sel_hi:[1,0,1] neg_lo:[0,1,0] neg_hi:[0,0,0]
v_pk_mul_f32 v[48:49], v[52:53], v[122:123] op_sel:[0,0] op_sel_hi:[0,1] neg_lo:[0,0] neg_hi:[0,0]
v_pk_fma_f32 v[52:53], v[52:53], v[122:123], v[48:49] op_sel:[1,1,0] op_sel_hi:[1,0,1] neg_lo:[0,1,0] neg_hi:[0,0,0]
v_pk_mul_f32 v[48:49], v[36:37], v[124:125] op_sel:[0,0] op_sel_hi:[0,1] neg_lo:[0,0] neg_hi:[0,0]
v_pk_fma_f32 v[36:37], v[36:37], v[124:125], v[48:49] op_sel:[1,1,0] op_sel_hi:[1,0,1] neg_lo:[0,1,0] neg_hi:[0,0,0]
v_pk_mul_f32 v[48:49], v[68:69], v[126:127] op_sel:[0,0] op_sel_hi:[0,1] neg_lo:[0,0] neg_hi:[0,0]
v_pk_fma_f32 v[68:69], v[68:69], v[126:127], v[48:49] op_sel:[1,1,0] op_sel_hi:[1,0,1] neg_lo:[0,1,0] neg_hi:[0,0,0]
v_pk_mul_f32 v[48:49], v[18:19], v[128:129] op_sel:[0,0] op_sel_hi:[0,1] neg_lo:[0,0] neg_hi:[0,0]
v_pk_fma_f32 v[18:19], v[18:19], v[128:129], v[48:49] op_sel:[1,1,0] op_sel_hi:[1,0,1] neg_lo:[0,1,0] neg_hi:[0,0,0]
v_pk_mul_f32 v[48:49], v[50:51], v[130:131] op_sel:[0,0] op_sel_hi:[0,1] neg_lo:[0,0] neg_hi:[0,0]
v_pk_fma_f32 v[50:51], v[50:51], v[130:131], v[48:49] op_sel:[1,1,0] op_sel_hi:[1,0,1] neg_lo:[0,1,0] neg_hi:[0,0,0]
v_pk_mul_f32 v[48:49], v[34:35], v[132:133] op_sel:[0,0] op_sel_hi:[0,1] neg_lo:[0,0] neg_hi:[0,0]
v_pk_fma_f32 v[34:35], v[34:35], v[132:133], v[48:49] op_sel:[1,1,0] op_sel_hi:[1,0,1] neg_lo:[0,1,0] neg_hi:[0,0,0]
v_pk_mul_f32 v[48:49], v[66:67], v[134:135] op_sel:[0,0] op_sel_hi:[0,1] neg_lo:[0,0] neg_hi:[0,0]
v_pk_fma_f32 v[66:67], v[66:67], v[134:135], v[48:49] op_sel:[1,1,0] op_sel_hi:[1,0,1] neg_lo:[0,1,0] neg_hi:[0,0,0]
v_pk_mul_f32 v[48:49], v[26:27], v[136:137] op_sel:[0,0] op_sel_hi:[0,1] neg_lo:[0,0] neg_hi:[0,0]
v_pk_fma_f32 v[26:27], v[26:27], v[136:137], v[48:49] op_sel:[1,1,0] op_sel_hi:[1,0,1] neg_lo:[0,1,0] neg_hi:[0,0,0]
v_pk_mul_f32 v[48:49], v[58:59], v[138:139] op_sel:[0,0] op_sel_hi:[0,1] neg_lo:[0,0] neg_hi:[0,0]
v_pk_fma_f32 v[58:59], v[58:59], v[138:139], v[48:49] op_sel:[1,1,0] op_sel_hi:[1,0,1] neg_lo:[0,1,0] neg_hi:[0,0,0]
v_pk_mul_f32 v[48:49], v[42:43], v[140:141] op_sel:[0,0] op_sel_hi:[0,1] neg_lo:[0,0] neg_hi:[0,0]
v_pk_fma_f32 v[42:43], v[42:43], v[140:141], v[48:49] op_sel:[1,1,0] op_sel_hi:[1,0,1] neg_lo:[0,1,0] neg_hi:[0,0,0]
v_pk_mul_f32 v[48:49], v[74:75], v[142:143] op_sel:[0,0] op_sel_hi:[0,1] neg_lo:[0,0] neg_hi:[0,0]
v_pk_fma_f32 v[74:75], v[74:75], v[142:143], v[48:49] op_sel:[1,1,0] op_sel_hi:[1,0,1] neg_lo:[0,1,0] neg_hi:[0,0,0]
ds_write_b64 v3, v[16:17] offset:0
ds_write_b64 v3, v[14:15] offset:528
ds_write_b64 v3, v[64:65] offset:1056
ds_write_b64 v3, v[40:41] offset:1584
ds_write_b64 v3, v[72:73] offset:2112
ds_write_b64 v3, v[44:45] offset:2640
ds_write_b64 v3, v[28:29] offset:3168
ds_write_b64 v3, v[60:61] offset:3696
ds_write_b64 v3, v[76:77] offset:4224
ds_write_b64 v3, v[46:47] offset:4752
ds_write_b64 v3, v[30:31] offset:5280
ds_write_b64 v3, v[62:63] offset:5808
ds_write_b64 v3, v[22:23] offset:6336
ds_write_b64 v3, v[54:55] offset:6864
ds_write_b64 v3, v[38:39] offset:7392
ds_write_b64 v3, v[70:71] offset:7920
ds_write_b64 v3, v[78:79] offset:8448
ds_write_b64 v3, v[32:33] offset:8976
ds_write_b64 v3, v[24:25] offset:9504
ds_write_b64 v3, v[56:57] offset:10032
ds_write_b64 v3, v[20:21] offset:10560
ds_write_b64 v3, v[52:53] offset:11088
ds_write_b64 v3, v[36:37] offset:11616
ds_write_b64 v3, v[68:69] offset:12144
ds_write_b64 v3, v[18:19] offset:12672
ds_write_b64 v3, v[50:51] offset:13200
ds_write_b64 v3, v[34:35] offset:13728
ds_write_b64 v3, v[66:67] offset:14256
ds_write_b64 v3, v[26:27] offset:14784
ds_write_b64 v3, v[58:59] offset:15312
ds_write_b64 v3, v[42:43] offset:15840
ds_write_b64 v3, v[74:75] offset:16368
s_waitcnt lgkmcnt(0)
ds_read_b64 v[16:17], v4 offset:0
ds_read_b64 v[48:49], v4 offset:256
ds_read_b64 v[18:19], v4 offset:16
ds_read_b64 v[50:51], v4 offset:272
ds_read_b64 v[20:21], v4 offset:32
ds_read_b64 v[52:53], v4 offset:288
ds_read_b64 v[22:23], v4 offset:48
ds_read_b64 v[54:55], v4 offset:304
ds_read_b64 v[24:25], v4 offset:64
ds_read_b64 v[56:57], v4 offset:320
ds_read_b64 v[26:27], v4 offset:80
ds_read_b64 v[58:59], v4 offset:336
ds_read_b64 v[28:29], v4 offset:96
ds_read_b64 v[60:61], v4 offset:352
ds_read_b64 v[30:31], v4 offset:112
ds_read_b64 v[62:63], v4 offset:368
ds_read_b64 v[32:33], v4 offset:128
ds_read_b64 v[64:65], v4 offset:384
ds_read_b64 v[34:35], v4 offset:144
ds_read_b64 v[66:67], v4 offset:400
ds_read_b64 v[36:37], v4 offset:160
ds_read_b64 v[68:69], v4 offset:416
ds_read_b64 v[38:39], v4 offset:176
ds_read_b64 v[70:71], v4 offset:432
ds_read_b64 v[40:41], v4 offset:192
ds_read_b64 v[72:73], v4 offset:448
ds_read_b64 v[42:43], v4 offset:208
ds_read_b64 v[74:75], v4 offset:464
ds_read_b64 v[44:45], v4 offset:224
ds_read_b64 v[76:77], v4 offset:480
ds_read_b64 v[46:47], v4 offset:240
ds_read_b64 v[78:79], v4 offset:496
s_waitcnt lgkmcnt(0)
v_pk_add_f32 v[14:15], v[16:17], v[48:49] neg_lo:[0,1] neg_hi:[0,1]
v_pk_add_f32 v[16:17], v[16:17], v[48:49]
v_pk_add_f32 v[48:49], v[18:19], v[50:51] neg_lo:[0,1] neg_hi:[0,1]
v_pk_add_f32 v[18:19], v[18:19], v[50:51]
v_pk_mul_f32 v[50:51], v[48:49], s[50:51] op_sel:[0,0] op_sel_hi:[0,1] neg_lo:[0,0] neg_hi:[0,1]
v_pk_fma_f32 v[50:51], v[48:49], s[50:51], v[50:51] op_sel:[1,1,0] op_sel_hi:[1,0,1] neg_lo:[0,0,0] neg_hi:[0,0,0]
v_pk_add_f32 v[48:49], v[20:21], v[52:53] neg_lo:[0,1] neg_hi:[0,1]
v_pk_add_f32 v[20:21], v[20:21], v[52:53]
v_pk_mul_f32 v[52:53], v[48:49], s[54:55] op_sel:[0,0] op_sel_hi:[0,1] neg_lo:[0,0] neg_hi:[0,1]
v_pk_fma_f32 v[52:53], v[48:49], s[54:55], v[52:53] op_sel:[1,1,0] op_sel_hi:[1,0,1] neg_lo:[0,0,0] neg_hi:[0,0,0]
v_pk_add_f32 v[48:49], v[22:23], v[54:55] neg_lo:[0,1] neg_hi:[0,1]
v_pk_add_f32 v[22:23], v[22:23], v[54:55]
v_pk_mul_f32 v[54:55], v[48:49], s[58:59] op_sel:[0,0] op_sel_hi:[0,1] neg_lo:[0,0] neg_hi:[0,1]
v_pk_fma_f32 v[54:55], v[48:49], s[58:59], v[54:55] op_sel:[1,1,0] op_sel_hi:[1,0,1] neg_lo:[0,0,0] neg_hi:[0,0,0]
v_pk_add_f32 v[48:49], v[24:25], v[56:57] neg_lo:[0,1] neg_hi:[0,1]
v_pk_add_f32 v[24:25], v[24:25], v[56:57]
v_pk_mul_f32 v[56:57], v[48:49], s[62:63] op_sel:[0,0] op_sel_hi:[0,1] neg_lo:[0,0] neg_hi:[0,1]
v_pk_fma_f32 v[56:57], v[48:49], s[62:63], v[56:57] op_sel:[1,1,0] op_sel_hi:[1,0,1] neg_lo:[0,0,0] neg_hi:[0,0,0]
v_pk_add_f32 v[48:49], v[26:27], v[58:59] neg_lo:[0,1] neg_hi:[0,1]
v_pk_add_f32 v[26:27], v[26:27], v[58:59]
v_pk_mul_f32 v[58:59], v[48:49], s[58:59] op_sel:[0,1] op_sel_hi:[0,0] neg_lo:[0,0] neg_hi:[0,1]
v_pk_fma_f32 v[58:59], v[48:49], s[58:59], v[58:59] op_sel:[1,0,0] op_sel_hi:[1,1,1] neg_lo:[0,0,0] neg_hi:[0,0,0]
v_pk_add_f32 v[48:49], v[28:29], v[60:61] neg_lo:[0,1] neg_hi:[0,1]
v_pk_add_f32 v[28:29], v[28:29], v[60:61]
v_pk_mul_f32 v[60:61], v[48:49], s[54:55] op_sel:[0,1] op_sel_hi:[0,0] neg_lo:[0,0] neg_hi:[0,1]
v_pk_fma_f32 v[60:61], v[48:49], s[54:55], v[60:61] op_sel:[1,0,0] op_sel_hi:[1,1,1] neg_lo:[0,0,0] neg_hi:[0,0,0]
v_pk_add_f32 v[48:49], v[30:31], v[62:63] neg_lo:[0,1] neg_hi:[0,1]
v_pk_add_f32 v[30:31], v[30:31], v[62:63]
v_pk_mul_f32 v[62:63], v[48:49], s[50:51] op_sel:[0,1] op_sel_hi:[0,0] neg_lo:[0,0] neg_hi:[0,1]
v_pk_fma_f32 v[62:63], v[48:49], s[50:51], v[62:63] op_sel:[1,0,0] op_sel_hi:[1,1,1] neg_lo:[0,0,0] neg_hi:[0,0,0]
v_pk_add_f32 v[48:49], v[32:33], v[64:65] op_sel:[1,1] op_sel_hi:[0,0] neg_lo:[0,1] neg_hi:[1,0]
v_pk_add_f32 v[32:33], v[32:33], v[64:65]
v_pk_add_f32 v[64:65], v[34:35], v[66:67] neg_lo:[0,1] neg_hi:[0,1]
v_pk_add_f32 v[34:35], v[34:35], v[66:67]
v_pk_mul_f32 v[66:67], v[64:65], s[50:51] op_sel:[0,1] op_sel_hi:[0,0] neg_lo:[0,1] neg_hi:[0,1]
v_pk_fma_f32 v[66:67], v[64:65], s[50:51], v[66:67] op_sel:[1,0,0] op_sel_hi:[1,1,1] neg_lo:[0,0,0] neg_hi:[0,1,0]
v_pk_add_f32 v[64:65], v[36:37], v[68:69] neg_lo:[0,1] neg_hi:[0,1]
v_pk_add_f32 v[36:37], v[36:37], v[68:69]
v_pk_mul_f32 v[68:69], v[64:65], s[54:55] op_sel:[0,1] op_sel_hi:[0,0] neg_lo:[0,1] neg_hi:[0,1]
v_pk_fma_f32 v[68:69], v[64:65], s[54:55], v[68:69] op_sel:[1,0,0] op_sel_hi:[1,1,1] neg_lo:[0,0,0] neg_hi:[0,1,0]
v_pk_add_f32 v[64:65], v[38:39], v[70:71] neg_lo:[0,1] neg_hi:[0,1]
v_pk_add_f32 v[38:39], v[38:39], v[70:71]
v_pk_mul_f32 v[70:71], v[64:65], s[58:59] op_sel:[0,1] op_sel_hi:[0,0] neg_lo:[0,1] neg_hi:[0,1]
v_pk_fma_f32 v[70:71], v[64:65], s[58:59], v[70:71] op_sel:[1,0,0] op_sel_hi:[1,1,1] neg_lo:[0,0,0] neg_hi:[0,1,0]
v_pk_add_f32 v[64:65], v[40:41], v[72:73] neg_lo:[0,1] neg_hi:[0,1]
v_pk_add_f32 v[40:41], v[40:41], v[72:73]
v_pk_mul_f32 v[72:73], v[64:65], s[62:63] op_sel:[0,0] op_sel_hi:[0,1] neg_lo:[0,1] neg_hi:[0,1]
v_pk_fma_f32 v[72:73], v[64:65], s[62:63], v[72:73] op_sel:[1,1,0] op_sel_hi:[1,0,1] neg_lo:[0,0,0] neg_hi:[0,1,0]
v_pk_add_f32 v[64:65], v[42:43], v[74:75] neg_lo:[0,1] neg_hi:[0,1]
v_pk_add_f32 v[42:43], v[42:43], v[74:75]
v_pk_mul_f32 v[74:75], v[64:65], s[58:59] op_sel:[0,0] op_sel_hi:[0,1] neg_lo:[0,1] neg_hi:[0,1]
v_pk_fma_f32 v[74:75], v[64:65], s[58:59], v[74:75] op_sel:[1,1,0] op_sel_hi:[1,0,1] neg_lo:[0,0,0] neg_hi:[0,1,0]
v_pk_add_f32 v[64:65], v[44:45], v[76:77] neg_lo:[0,1] neg_hi:[0,1]
v_pk_add_f32 v[44:45], v[44:45], v[76:77]
v_pk_mul_f32 v[76:77], v[64:65], s[54:55] op_sel:[0,0] op_sel_hi:[0,1] neg_lo:[0,1] neg_hi:[0,1]
v_pk_fma_f32 v[76:77], v[64:65], s[54:55], v[76:77] op_sel:[1,1,0] op_sel_hi:[1,0,1] neg_lo:[0,0,0] neg_hi:[0,1,0]
v_pk_add_f32 v[64:65], v[46:47], v[78:79] neg_lo:[0,1] neg_hi:[0,1]
v_pk_add_f32 v[46:47], v[46:47], v[78:79]
v_pk_mul_f32 v[78:79], v[64:65], s[50:51] op_sel:[0,0] op_sel_hi:[0,1] neg_lo:[0,1] neg_hi:[0,1]
v_pk_fma_f32 v[78:79], v[64:65], s[50:51], v[78:79] op_sel:[1,1,0] op_sel_hi:[1,0,1] neg_lo:[0,0,0] neg_hi:[0,1,0]
v_pk_add_f32 v[64:65], v[16:17], v[32:33] neg_lo:[0,1] neg_hi:[0,1]
v_pk_add_f32 v[16:17], v[16:17], v[32:33]
v_pk_add_f32 v[32:33], v[18:19], v[34:35] neg_lo:[0,1] neg_hi:[0,1]
v_pk_add_f32 v[18:19], v[18:19], v[34:35]
v_pk_mul_f32 v[34:35], v[32:33], s[54:55] op_sel:[0,0] op_sel_hi:[0,1] neg_lo:[0,0] neg_hi:[0,1]
v_pk_fma_f32 v[34:35], v[32:33], s[54:55], v[34:35] op_sel:[1,1,0] op_sel_hi:[1,0,1] neg_lo:[0,0,0] neg_hi:[0,0,0]
v_pk_add_f32 v[32:33], v[20:21], v[36:37] neg_lo:[0,1] neg_hi:[0,1]
v_pk_add_f32 v[20:21], v[20:21], v[36:37]
v_pk_mul_f32 v[36:37], v[32:33], s[62:63] op_sel:[0,0] op_sel_hi:[0,1] neg_lo:[0,0] neg_hi:[0,1]
v_pk_fma_f32 v[36:37], v[32:33], s[62:63], v[36:37] op_sel:[1,1,0] op_sel_hi:[1,0,1] neg_lo:[0,0,0] neg_hi:[0,0,0]
v_pk_add_f32 v[32:33], v[22:23], v[38:39] neg_lo:[0,1] neg_hi:[0,1]
v_pk_add_f32 v[22:23], v[22:23], v[38:39]
v_pk_mul_f32 v[38:39], v[32:33], s[54:55] op_sel:[0,1] op_sel_hi:[0,0] neg_lo:[0,0] neg_hi:[0,1]
v_pk_fma_f32 v[38:39], v[32:33], s[54:55], v[38:39] op_sel:[1,0,0] op_sel_hi:[1,1,1] neg_lo:[0,0,0] neg_hi:[0,0,0]
v_pk_add_f32 v[32:33], v[24:25], v[40:41] op_sel:[1,1] op_sel_hi:[0,0] neg_lo:[0,1] neg_hi:[1,0]
v_pk_add_f32 v[24:25], v[24:25], v[40:41]
v_pk_add_f32 v[40:41], v[26:27], v[42:43] neg_lo:[0,1] neg_hi:[0,1]
v_pk_add_f32 v[26:27], v[26:27], v[42:43]
v_pk_mul_f32 v[42:43], v[40:41], s[54:55] op_sel:[0,1] op_sel_hi:[0,0] neg_lo:[0,1] neg_hi:[0,1]
v_pk_fma_f32 v[42:43], v[40:41], s[54:55], v[42:43] op_sel:[1,0,0] op_sel_hi:[1,1,1] neg_lo:[0,0,0] neg_hi:[0,1,0]
v_pk_add_f32 v[40:41], v[28:29], v[44:45] neg_lo:[0,1] neg_hi:[0,1]
v_pk_add_f32 v[28:29], v[28:29], v[44:45]
v_pk_mul_f32 v[44:45], v[40:41], s[62:63] op_sel:[0,0] op_sel_hi:[0,1] neg_lo:[0,1] neg_hi:[0,1]
v_pk_fma_f32 v[44:45], v[40:41], s[62:63], v[44:45] op_sel:[1,1,0] op_sel_hi:[1,0,1] neg_lo:[0,0,0] neg_hi:[0,1,0]
v_pk_add_f32 v[40:41], v[30:31], v[46:47] neg_lo:[0,1] neg_hi:[0,1]
v_pk_add_f32 v[30:31], v[30:31], v[46:47]
v_pk_mul_f32 v[46:47], v[40:41], s[54:55] op_sel:[0,0] op_sel_hi:[0,1] neg_lo:[0,1] neg_hi:[0,1]
v_pk_fma_f32 v[46:47], v[40:41], s[54:55], v[46:47] op_sel:[1,1,0] op_sel_hi:[1,0,1] neg_lo:[0,0,0] neg_hi:[0,1,0]
v_pk_add_f32 v[40:41], v[14:15], v[48:49] neg_lo:[0,1] neg_hi:[0,1]
v_pk_add_f32 v[14:15], v[14:15], v[48:49]
v_pk_add_f32 v[48:49], v[50:51], v[66:67] neg_lo:[0,1] neg_hi:[0,1]
v_pk_add_f32 v[50:51], v[50:51], v[66:67]
v_pk_mul_f32 v[66:67], v[48:49], s[54:55] op_sel:[0,0] op_sel_hi:[0,1] neg_lo:[0,0] neg_hi:[0,1]
v_pk_fma_f32 v[66:67], v[48:49], s[54:55], v[66:67] op_sel:[1,1,0] op_sel_hi:[1,0,1] neg_lo:[0,0,0] neg_hi:[0,0,0]
v_pk_add_f32 v[48:49], v[52:53], v[68:69] neg_lo:[0,1] neg_hi:[0,1]
v_pk_add_f32 v[52:53], v[52:53], v[68:69]
v_pk_mul_f32 v[68:69], v[48:49], s[62:63] op_sel:[0,0] op_sel_hi:[0,1] neg_lo:[0,0] neg_hi:[0,1]
v_pk_fma_f32 v[68:69], v[48:49], s[62:63], v[68:69] op_sel:[1,1,0] op_sel_hi:[1,0,1] neg_lo:[0,0,0] neg_hi:[0,0,0]
v_pk_add_f32 v[48:49], v[54:55], v[70:71] neg_lo:[0,1] neg_hi:[0,1]
v_pk_add_f32 v[54:55], v[54:55], v[70:71]
v_pk_mul_f32 v[70:71], v[48:49], s[54:55] op_sel:[0,1] op_sel_hi:[0,0] neg_lo:[0,0] neg_hi:[0,1]
v_pk_fma_f32 v[70:71], v[48:49], s[54:55], v[70:71] op_sel:[1,0,0] op_sel_hi:[1,1,1] neg_lo:[0,0,0] neg_hi:[0,0,0]
v_pk_add_f32 v[48:49], v[56:57], v[72:73] op_sel:[1,1] op_sel_hi:[0,0] neg_lo:[0,1] neg_hi:[1,0]
v_pk_add_f32 v[56:57], v[56:57], v[72:73]
v_pk_add_f32 v[72:73], v[58:59], v[74:75] neg_lo:[0,1] neg_hi:[0,1]
v_pk_add_f32 v[58:59], v[58:59], v[74:75]
v_pk_mul_f32 v[74:75], v[72:73], s[54:55] op_sel:[0,1] op_sel_hi:[0,0] neg_lo:[0,1] neg_hi:[0,1]
v_pk_fma_f32 v[74:75], v[72:73], s[54:55], v[74:75] op_sel:[1,0,0] op_sel_hi:[1,1,1] neg_lo:[0,0,0] neg_hi:[0,1,0]
v_pk_add_f32 v[72:73], v[60:61], v[76:77] neg_lo:[0,1] neg_hi:[0,1]
v_pk_add_f32 v[60:61], v[60:61], v[76:77]
v_pk_mul_f32 v[76:77], v[72:73], s[62:63] op_sel:[0,0] op_sel_hi:[0,1] neg_lo:[0,1] neg_hi:[0,1]
v_pk_fma_f32 v[76:77], v[72:73], s[62:63], v[76:77] op_sel:[1,1,0] op_sel_hi:[1,0,1] neg_lo:[0,0,0] neg_hi:[0,1,0]
v_pk_add_f32 v[72:73], v[62:63], v[78:79] neg_lo:[0,1] neg_hi:[0,1]
v_pk_add_f32 v[62:63], v[62:63], v[78:79]
v_pk_mul_f32 v[78:79], v[72:73], s[54:55] op_sel:[0,0] op_sel_hi:[0,1] neg_lo:[0,1] neg_hi:[0,1]
v_pk_fma_f32 v[78:79], v[72:73], s[54:55], v[78:79] op_sel:[1,1,0] op_sel_hi:[1,0,1] neg_lo:[0,0,0] neg_hi:[0,1,0]
v_pk_add_f32 v[72:73], v[16:17], v[24:25] neg_lo:[0,1] neg_hi:[0,1]
v_pk_add_f32 v[16:17], v[16:17], v[24:25]
v_pk_add_f32 v[24:25], v[18:19], v[26:27] neg_lo:[0,1] neg_hi:[0,1]
v_pk_add_f32 v[18:19], v[18:19], v[26:27]
v_pk_mul_f32 v[26:27], v[24:25], s[62:63] op_sel:[0,0] op_sel_hi:[0,1] neg_lo:[0,0] neg_hi:[0,1]
v_pk_fma_f32 v[26:27], v[24:25], s[62:63], v[26:27] op_sel:[1,1,0] op_sel_hi:[1,0,1] neg_lo:[0,0,0] neg_hi:[0,0,0]
v_pk_add_f32 v[24:25], v[20:21], v[28:29] op_sel:[1,1] op_sel_hi:[0,0] neg_lo:[0,1] neg_hi:[1,0]
v_pk_add_f32 v[20:21], v[20:21], v[28:29]
v_pk_add_f32 v[28:29], v[22:23], v[30:31] neg_lo:[0,1] neg_hi:[0,1]
v_pk_add_f32 v[22:23], v[22:23], v[30:31]
v_pk_mul_f32 v[30:31], v[28:29], s[62:63] op_sel:[0,0] op_sel_hi:[0,1] neg_lo:[0,1] neg_hi:[0,1]
v_pk_fma_f32 v[30:31], v[28:29], s[62:63], v[30:31] op_sel:[1,1,0] op_sel_hi:[1,0,1] neg_lo:[0,0,0] neg_hi:[0,1,0]
v_pk_add_f32 v[28:29], v[64:65], v[32:33] neg_lo:[0,1] neg_hi:[0,1]
v_pk_add_f32 v[64:65], v[64:65], v[32:33]
v_pk_add_f32 v[32:33], v[34:35], v[42:43] neg_lo:[0,1] neg_hi:[0,1]
v_pk_add_f32 v[34:35], v[34:35], v[42:43]
v_pk_mul_f32 v[42:43], v[32:33], s[62:63] op_sel:[0,0] op_sel_hi:[0,1] neg_lo:[0,0] neg_hi:[0,1]
v_pk_fma_f32 v[42:43], v[32:33], s[62:63], v[42:43] op_sel:[1,1,0] op_sel_hi:[1,0,1] neg_lo:[0,0,0] neg_hi:[0,0,0]
v_pk_add_f32 v[32:33], v[36:37], v[44:45] op_sel:[1,1] op_sel_hi:[0,0] neg_lo:[0,1] neg_hi:[1,0]
v_pk_add_f32 v[36:37], v[36:37], v[44:45]
v_pk_add_f32 v[44:45], v[38:39], v[46:47] neg_lo:[0,1] neg_hi:[0,1]
v_pk_add_f32 v[38:39], v[38:39], v[46:47]
v_pk_mul_f32 v[46:47], v[44:45], s[62:63] op_sel:[0,0] op_sel_hi:[0,1] neg_lo:[0,1] neg_hi:[0,1]
v_pk_fma_f32 v[46:47], v[44:45], s[62:63], v[46:47] op_sel:[1,1,0] op_sel_hi:[1,0,1] neg_lo:[0,0,0] neg_hi:[0,1,0]
v_pk_add_f32 v[44:45], v[14:15], v[56:57] neg_lo:[0,1] neg_hi:[0,1]
v_pk_add_f32 v[14:15], v[14:15], v[56:57]
v_pk_add_f32 v[56:57], v[50:51], v[58:59] neg_lo:[0,1] neg_hi:[0,1]
v_pk_add_f32 v[50:51], v[50:51], v[58:59]
v_pk_mul_f32 v[58:59], v[56:57], s[62:63] op_sel:[0,0] op_sel_hi:[0,1] neg_lo:[0,0] neg_hi:[0,1]
v_pk_fma_f32 v[58:59], v[56:57], s[62:63], v[58:59] op_sel:[1,1,0] op_sel_hi:[1,0,1] neg_lo:[0,0,0] neg_hi:[0,0,0]
v_pk_add_f32 v[56:57], v[52:53], v[60:61] op_sel:[1,1] op_sel_hi:[0,0] neg_lo:[0,1] neg_hi:[1,0]
v_pk_add_f32 v[52:53], v[52:53], v[60:61]
v_pk_add_f32 v[60:61], v[54:55], v[62:63] neg_lo:[0,1] neg_hi:[0,1]
v_pk_add_f32 v[54:55], v[54:55], v[62:63]
v_pk_mul_f32 v[62:63], v[60:61], s[62:63] op_sel:[0,0] op_sel_hi:[0,1] neg_lo:[0,1] neg_hi:[0,1]
v_pk_fma_f32 v[62:63], v[60:61], s[62:63], v[62:63] op_sel:[1,1,0] op_sel_hi:[1,0,1] neg_lo:[0,0,0] neg_hi:[0,1,0]
v_pk_add_f32 v[60:61], v[40:41], v[48:49] neg_lo:[0,1] neg_hi:[0,1]
v_pk_add_f32 v[40:41], v[40:41], v[48:49]
v_pk_add_f32 v[48:49], v[66:67], v[74:75] neg_lo:[0,1] neg_hi:[0,1]
v_pk_add_f32 v[66:67], v[66:67], v[74:75]
v_pk_mul_f32 v[74:75], v[48:49], s[62:63] op_sel:[0,0] op_sel_hi:[0,1] neg_lo:[0,0] neg_hi:[0,1]
v_pk_fma_f32 v[74:75], v[48:49], s[62:63], v[74:75] op_sel:[1,1,0] op_sel_hi:[1,0,1] neg_lo:[0,0,0] neg_hi:[0,0,0]
v_pk_add_f32 v[48:49], v[68:69], v[76:77] op_sel:[1,1] op_sel_hi:[0,0] neg_lo:[0,1] neg_hi:[1,0]
v_pk_add_f32 v[68:69], v[68:69], v[76:77]
v_pk_add_f32 v[76:77], v[70:71], v[78:79] neg_lo:[0,1] neg_hi:[0,1]
v_pk_add_f32 v[70:71], v[70:71], v[78:79]
v_pk_mul_f32 v[78:79], v[76:77], s[62:63] op_sel:[0,0] op_sel_hi:[0,1] neg_lo:[0,1] neg_hi:[0,1]
v_pk_fma_f32 v[78:79], v[76:77], s[62:63], v[78:79] op_sel:[1,1,0] op_sel_hi:[1,0,1] neg_lo:[0,0,0] neg_hi:[0,1,0]
v_pk_add_f32 v[76:77], v[16:17], v[20:21] neg_lo:[0,1] neg_hi:[0,1]
v_pk_add_f32 v[16:17], v[16:17], v[20:21]
v_pk_add_f32 v[20:21], v[18:19], v[22:23] op_sel:[1,1] op_sel_hi:[0,0] neg_lo:[0,1] neg_hi:[1,0]
v_pk_add_f32 v[18:19], v[18:19], v[22:23]
v_pk_add_f32 v[22:23], v[72:73], v[24:25] neg_lo:[0,1] neg_hi:[0,1]
v_pk_add_f32 v[72:73], v[72:73], v[24:25]
v_pk_add_f32 v[24:25], v[26:27], v[30:31] op_sel:[1,1] op_sel_hi:[0,0] neg_lo:[0,1] neg_hi:[1,0]
v_pk_add_f32 v[26:27], v[26:27], v[30:31]
v_pk_add_f32 v[30:31], v[64:65], v[36:37] neg_lo:[0,1] neg_hi:[0,1]
v_pk_add_f32 v[64:65], v[64:65], v[36:37]
v_pk_add_f32 v[36:37], v[34:35], v[38:39] op_sel:[1,1] op_sel_hi:[0,0] neg_lo:[0,1] neg_hi:[1,0]
v_pk_add_f32 v[34:35], v[34:35], v[38:39]
v_pk_add_f32 v[38:39], v[28:29], v[32:33] neg_lo:[0,1] neg_hi:[0,1]
v_pk_add_f32 v[28:29], v[28:29], v[32:33]
v_pk_add_f32 v[32:33], v[42:43], v[46:47] op_sel:[1,1] op_sel_hi:[0,0] neg_lo:[0,1] neg_hi:[1,0]
v_pk_add_f32 v[42:43], v[42:43], v[46:47]
v_pk_add_f32 v[46:47], v[14:15], v[52:53] neg_lo:[0,1] neg_hi:[0,1]
v_pk_add_f32 v[14:15], v[14:15], v[52:53]
v_pk_add_f32 v[52:53], v[50:51], v[54:55] op_sel:[1,1] op_sel_hi:[0,0] neg_lo:[0,1] neg_hi:[1,0]
v_pk_add_f32 v[50:51], v[50:51], v[54:55]
v_pk_add_f32 v[54:55], v[44:45], v[56:57] neg_lo:[0,1] neg_hi:[0,1]
v_pk_add_f32 v[44:45], v[44:45], v[56:57]
v_pk_add_f32 v[56:57], v[58:59], v[62:63] op_sel:[1,1] op_sel_hi:[0,0] neg_lo:[0,1] neg_hi:[1,0]
v_pk_add_f32 v[58:59], v[58:59], v[62:63]
v_pk_add_f32 v[62:63], v[40:41], v[68:69] neg_lo:[0,1] neg_hi:[0,1]
v_pk_add_f32 v[40:41], v[40:41], v[68:69]
v_pk_add_f32 v[68:69], v[66:67], v[70:71] op_sel:[1,1] op_sel_hi:[0,0] neg_lo:[0,1] neg_hi:[1,0]
v_pk_add_f32 v[66:67], v[66:67], v[70:71]
v_pk_add_f32 v[70:71], v[60:61], v[48:49] neg_lo:[0,1] neg_hi:[0,1]
v_pk_add_f32 v[60:61], v[60:61], v[48:49]
v_pk_add_f32 v[48:49], v[74:75], v[78:79] op_sel:[1,1] op_sel_hi:[0,0] neg_lo:[0,1] neg_hi:[1,0]
v_pk_add_f32 v[74:75], v[74:75], v[78:79]
v_pk_add_f32 v[78:79], v[16:17], v[18:19] neg_lo:[0,1] neg_hi:[0,1]
v_pk_add_f32 v[16:17], v[16:17], v[18:19]
v_pk_add_f32 v[18:19], v[76:77], v[20:21] neg_lo:[0,1] neg_hi:[0,1]
v_pk_add_f32 v[76:77], v[76:77], v[20:21]
v_pk_add_f32 v[20:21], v[72:73], v[26:27] neg_lo:[0,1] neg_hi:[0,1]
v_pk_add_f32 v[72:73], v[72:73], v[26:27]
v_pk_add_f32 v[26:27], v[22:23], v[24:25] neg_lo:[0,1] neg_hi:[0,1]
v_pk_add_f32 v[22:23], v[22:23], v[24:25]
v_pk_add_f32 v[24:25], v[64:65], v[34:35] neg_lo:[0,1] neg_hi:[0,1]
v_pk_add_f32 v[64:65], v[64:65], v[34:35]
v_pk_add_f32 v[34:35], v[30:31], v[36:37] neg_lo:[0,1] neg_hi:[0,1]
v_pk_add_f32 v[30:31], v[30:31], v[36:37]
v_pk_add_f32 v[36:37], v[28:29], v[42:43] neg_lo:[0,1] neg_hi:[0,1]
v_pk_add_f32 v[28:29], v[28:29], v[42:43]
v_pk_add_f32 v[42:43], v[38:39], v[32:33] neg_lo:[0,1] neg_hi:[0,1]
v_pk_add_f32 v[38:39], v[38:39], v[32:33]
v_pk_add_f32 v[32:33], v[14:15], v[50:51] neg_lo:[0,1] neg_hi:[0,1]
v_pk_add_f32 v[14:15], v[14:15], v[50:51]
v_pk_add_f32 v[50:51], v[46:47], v[52:53] neg_lo:[0,1] neg_hi:[0,1]
v_pk_add_f32 v[46:47], v[46:47], v[52:53]
v_pk_add_f32 v[52:53], v[44:45], v[58:59] neg_lo:[0,1] neg_hi:[0,1]
v_pk_add_f32 v[44:45], v[44:45], v[58:59]
v_pk_add_f32 v[58:59], v[54:55], v[56:57] neg_lo:[0,1] neg_hi:[0,1]
v_pk_add_f32 v[54:55], v[54:55], v[56:57]
v_pk_add_f32 v[56:57], v[40:41], v[66:67] neg_lo:[0,1] neg_hi:[0,1]
v_pk_add_f32 v[40:41], v[40:41], v[66:67]
v_pk_add_f32 v[66:67], v[62:63], v[68:69] neg_lo:[0,1] neg_hi:[0,1]
v_pk_add_f32 v[62:63], v[62:63], v[68:69]
v_pk_add_f32 v[68:69], v[60:61], v[74:75] neg_lo:[0,1] neg_hi:[0,1]
v_pk_add_f32 v[60:61], v[60:61], v[74:75]
v_pk_add_f32 v[74:75], v[70:71], v[48:49] neg_lo:[0,1] neg_hi:[0,1]
v_pk_add_f32 v[70:71], v[70:71], v[48:49]
s_mov_b64 exec, s[18:19]
v_pk_add_f32 v[16:17], v[16:17], 0 neg_lo:[1,0] neg_hi:[1,0]
v_pk_mul_f32 v[48:49], v[14:15], s[48:49] op_sel:[0,0] op_sel_hi:[0,1] neg_lo:[0,1] neg_hi:[0,0]
v_pk_fma_f32 v[14:15], v[14:15], s[48:49], v[48:49] op_sel:[1,1,0] op_sel_hi:[1,0,1] neg_lo:[0,1,0] neg_hi:[0,1,0]
v_pk_mul_f32 v[48:49], v[64:65], s[50:51] op_sel:[0,0] op_sel_hi:[0,1] neg_lo:[0,1] neg_hi:[0,0]
v_pk_fma_f32 v[64:65], v[64:65], s[50:51], v[48:49] op_sel:[1,1,0] op_sel_hi:[1,0,1] neg_lo:[0,1,0] neg_hi:[0,1,0]
v_pk_mul_f32 v[48:49], v[40:41], s[52:53] op_sel:[0,0] op_sel_hi:[0,1] neg_lo:[0,1] neg_hi:[0,0]
v_pk_fma_f32 v[40:41], v[40:41], s[52:53], v[48:49] op_sel:[1,1,0] op_sel_hi:[1,0,1] neg_lo:[0,1,0] neg_hi:[0,1,0]
v_pk_mul_f32 v[48:49], v[72:73], s[54:55] op_sel:[0,0] op_sel_hi:[0,1] neg_lo:[0,1] neg_hi:[0,0]
v_pk_fma_f32 v[72:73], v[72:73], s[54:55], v[48:49] op_sel:[1,1,0] op_sel_hi:[1,0,1] neg_lo:[0,1,0] neg_hi:[0,1,0]
v_pk_mul_f32 v[48:49], v[44:45], s[56:57] op_sel:[0,0] op_sel_hi:[0,1] neg_lo:[0,1] neg_hi:[0,0]
v_pk_fma_f32 v[44:45], v[44:45], s[56:57], v[48:49] op_sel:[1,1,0] op_sel_hi:[1,0,1] neg_lo:[0,1,0] neg_hi:[0,1,0]
v_pk_mul_f32 v[48:49], v[28:29], s[58:59] op_sel:[0,0] op_sel_hi:[0,1] neg_lo:[0,1] neg_hi:[0,0]
v_pk_fma_f32 v[28:29], v[28:29], s[58:59], v[48:49] op_sel:[1,1,0] op_sel_hi:[1,0,1] neg_lo:[0,1,0] neg_hi:[0,1,0]
v_pk_mul_f32 v[48:49], v[60:61], s[60:61] op_sel:[0,0] op_sel_hi:[0,1] neg_lo:[0,1] neg_hi:[0,0]
v_pk_fma_f32 v[60:61], v[60:61], s[60:61], v[48:49] op_sel:[1,1,0] op_sel_hi:[1,0,1] neg_lo:[0,1,0] neg_hi:[0,1,0]
v_pk_mul_f32 v[48:49], v[76:77], s[62:63] op_sel:[0,0] op_sel_hi:[0,1] neg_lo:[0,1] neg_hi:[0,0]
v_pk_fma_f32 v[76:77], v[76:77], s[62:63], v[48:49] op_sel:[1,1,0] op_sel_hi:[1,0,1] neg_lo:[0,1,0] neg_hi:[0,1,0]
v_pk_mul_f32 v[48:49], v[46:47], s[60:61] op_sel:[0,1] op_sel_hi:[0,0] neg_lo:[0,1] neg_hi:[0,0]
v_pk_fma_f32 v[46:47], v[46:47], s[60:61], v[48:49] op_sel:[1,0,0] op_sel_hi:[1,1,1] neg_lo:[0,1,0] neg_hi:[0,1,0]
v_pk_mul_f32 v[48:49], v[30:31], s[58:59] op_sel:[0,1] op_sel_hi:[0,0] neg_lo:[0,1] neg_hi:[0,0]
v_pk_fma_f32 v[30:31], v[30:31], s[58:59], v[48:49] op_sel:[1,0,0] op_sel_hi:[1,1,1] neg_lo:[0,1,0] neg_hi:[0,1,0]
v_pk_mul_f32 v[48:49], v[62:63], s[56:57] op_sel:[0,1] op_sel_hi:[0,0] neg_lo:[0,1] neg_hi:[0,0]
v_pk_fma_f32 v[62:63], v[62:63], s[56:57], v[48:49] op_sel:[1,0,0] op_sel_hi:[1,1,1] neg_lo:[0,1,0] neg_hi:[0,1,0]
v_pk_mul_f32 v[48:49], v[22:23], s[54:55] op_sel:[0,1] op_sel_hi:[0,0] neg_lo:[0,1] neg_hi:[0,0]
v_pk_fma_f32 v[22:23], v[22:23], s[54:55], v[48:49] op_sel:[1,0,0] op_sel_hi:[1,1,1] neg_lo:[0,1,0] neg_hi:[0,1,0]
v_pk_mul_f32 v[48:49], v[54:55], s[52:53] op_sel:[0,1] op_sel_hi:[0,0] neg_lo:[0,1] neg_hi:[0,0]
v_pk_fma_f32 v[54:55], v[54:55], s[52:53], v[48:49] op_sel:[1,0,0] op_sel_hi:[1,1,1] neg_lo:[0,1,0] neg_hi:[0,1,0]
v_pk_mul_f32 v[48:49], v[38:39], s[50:51] op_sel:[0,1] op_sel_hi:[0,0] neg_lo:[0,1] neg_hi:[0,0]
v_pk_fma_f32 v[38:39], v[38:39], s[50:51], v[48:49] op_sel:[1,0,0] op_sel_hi:[1,1,1] neg_lo:[0,1,0] neg_hi:[0,1,0]
v_pk_mul_f32 v[48:49], v[70:71], s[48:49] op_sel:[0,1] op_sel_hi:[0,0] neg_lo:[0,1] neg_hi:[0,0]
v_pk_fma_f32 v[70:71], v[70:71], s[48:49], v[48:49] op_sel:[1,0,0] op_sel_hi:[1,1,1] neg_lo:[0,1,0] neg_hi:[0,1,0]
v_pk_add_f32 v[78:79], v[78:79], 0 op_sel:[1,0] op_sel_hi:[0,0] neg_lo:[1,0] neg_hi:[0,0]
v_pk_mul_f32 v[48:49], v[32:33], s[48:49] op_sel:[0,1] op_sel_hi:[0,0] neg_lo:[0,0] neg_hi:[0,0]
v_pk_fma_f32 v[32:33], v[32:33], s[48:49], v[48:49] op_sel:[1,0,0] op_sel_hi:[1,1,1] neg_lo:[0,1,0] neg_hi:[0,0,0]
v_pk_mul_f32 v[48:49], v[24:25], s[50:51] op_sel:[0,1] op_sel_hi:[0,0] neg_lo:[0,0] neg_hi:[0,0]
v_pk_fma_f32 v[24:25], v[24:25], s[50:51], v[48:49] op_sel:[1,0,0] op_sel_hi:[1,1,1] neg_lo:[0,1,0] neg_hi:[0,0,0]
v_pk_mul_f32 v[48:49], v[56:57], s[52:53] op_sel:[0,1] op_sel_hi:[0,0] neg_lo:[0,0] neg_hi:[0,0]
v_pk_fma_f32 v[56:57], v[56:57], s[52:53], v[48:49] op_sel:[1,0,0] op_sel_hi:[1,1,1] neg_lo:[0,1,0] neg_hi:[0,0,0]
v_pk_mul_f32 v[48:49], v[20:21], s[54:55] op_sel:[0,1] op_sel_hi:[0,0] neg_lo:[0,0] neg_hi:[0,0]
v_pk_fma_f32 v[20:21], v[20:21], s[54:55], v[48:49] op_sel:[1,0,0] op_sel_hi:[1,1,1] neg_lo:[0,1,0] neg_hi:[0,0,0]
v_pk_mul_f32 v[48:49], v[52:53], s[56:57] op_sel:[0,1] op_sel_hi:[0,0] neg_lo:[0,0] neg_hi:[0,0]
v_pk_fma_f32 v[52:53], v[52:53], s[56:57], v[48:49] op_sel:[1,0,0] op_sel_hi:[1,1,1] neg_lo:[0,1,0] neg_hi:[0,0,0]
v_pk_mul_f32 v[48:49], v[36:37], s[58:59] op_sel:[0,1] op_sel_hi:[0,0] neg_lo:[0,0] neg_hi:[0,0]
v_pk_fma_f32 v[36:37], v[36:37], s[58:59], v[48:49] op_sel:[1,0,0] op_sel_hi:[1,1,1] neg_lo:[0,1,0] neg_hi:[0,0,0]
v_pk_mul_f32 v[48:49], v[68:69], s[60:61] op_sel:[0,1] op_sel_hi:[0,0] neg_lo:[0,0] neg_hi:[0,0]
v_pk_fma_f32 v[68:69], v[68:69], s[60:61], v[48:49] op_sel:[1,0,0] op_sel_hi:[1,1,1] neg_lo:[0,1,0] neg_hi:[0,0,0]
v_pk_mul_f32 v[48:49], v[18:19], s[62:63] op_sel:[0,0] op_sel_hi:[0,1] neg_lo:[0,0] neg_hi:[0,0]
v_pk_fma_f32 v[18:19], v[18:19], s[62:63], v[48:49] op_sel:[1,1,0] op_sel_hi:[1,0,1] neg_lo:[0,1,0] neg_hi:[0,0,0]
v_pk_mul_f32 v[48:49], v[50:51], s[60:61] op_sel:[0,0] op_sel_hi:[0,1] neg_lo:[0,0] neg_hi:[0,0]
v_pk_fma_f32 v[50:51], v[50:51], s[60:61], v[48:49] op_sel:[1,1,0] op_sel_hi:[1,0,1] neg_lo:[0,1,0] neg_hi:[0,0,0]
v_pk_mul_f32 v[48:49], v[34:35], s[58:59] op_sel:[0,0] op_sel_hi:[0,1] neg_lo:[0,0] neg_hi:[0,0]
v_pk_fma_f32 v[34:35], v[34:35], s[58:59], v[48:49] op_sel:[1,1,0] op_sel_hi:[1,0,1] neg_lo:[0,1,0] neg_hi:[0,0,0]
v_pk_mul_f32 v[48:49], v[66:67], s[56:57] op_sel:[0,0] op_sel_hi:[0,1] neg_lo:[0,0] neg_hi:[0,0]
v_pk_fma_f32 v[66:67], v[66:67], s[56:57], v[48:49] op_sel:[1,1,0] op_sel_hi:[1,0,1] neg_lo:[0,1,0] neg_hi:[0,0,0]
v_pk_mul_f32 v[48:49], v[26:27], s[54:55] op_sel:[0,0] op_sel_hi:[0,1] neg_lo:[0,0] neg_hi:[0,0]
v_pk_fma_f32 v[26:27], v[26:27], s[54:55], v[48:49] op_sel:[1,1,0] op_sel_hi:[1,0,1] neg_lo:[0,1,0] neg_hi:[0,0,0]
v_pk_mul_f32 v[48:49], v[58:59], s[52:53] op_sel:[0,0] op_sel_hi:[0,1] neg_lo:[0,0] neg_hi:[0,0]
v_pk_fma_f32 v[58:59], v[58:59], s[52:53], v[48:49] op_sel:[1,1,0] op_sel_hi:[1,0,1] neg_lo:[0,1,0] neg_hi:[0,0,0]
v_pk_mul_f32 v[48:49], v[42:43], s[50:51] op_sel:[0,0] op_sel_hi:[0,1] neg_lo:[0,0] neg_hi:[0,0]
v_pk_fma_f32 v[42:43], v[42:43], s[50:51], v[48:49] op_sel:[1,1,0] op_sel_hi:[1,0,1] neg_lo:[0,1,0] neg_hi:[0,0,0]
v_pk_mul_f32 v[48:49], v[74:75], s[48:49] op_sel:[0,0] op_sel_hi:[0,1] neg_lo:[0,0] neg_hi:[0,0]
v_pk_fma_f32 v[74:75], v[74:75], s[48:49], v[48:49] op_sel:[1,1,0] op_sel_hi:[1,0,1] neg_lo:[0,1,0] neg_hi:[0,0,0]
s_mov_b64 exec, -1
v_fmac_f32_dpp v16, v16, v9 quad_perm:[1,0,3,2] row_mask:0xf bank_mask:0xf
v_fmac_f32_dpp v17, v17, v9 quad_perm:[1,0,3,2] row_mask:0xf bank_mask:0xf
v_fmac_f32_dpp v14, v14, v9 quad_perm:[1,0,3,2] row_mask:0xf bank_mask:0xf
v_fmac_f32_dpp v15, v15, v9 quad_perm:[1,0,3,2] row_mask:0xf bank_mask:0xf
v_fmac_f32_dpp v64, v64, v9 quad_perm:[1,0,3,2] row_mask:0xf bank_mask:0xf
v_fmac_f32_dpp v65, v65, v9 quad_perm:[1,0,3,2] row_mask:0xf bank_mask:0xf
v_fmac_f32_dpp v40, v40, v9 quad_perm:[1,0,3,2] row_mask:0xf bank_mask:0xf
v_fmac_f32_dpp v41, v41, v9 quad_perm:[1,0,3,2] row_mask:0xf bank_mask:0xf
v_fmac_f32_dpp v72, v72, v9 quad_perm:[1,0,3,2] row_mask:0xf bank_mask:0xf
v_fmac_f32_dpp v73, v73, v9 quad_perm:[1,0,3,2] row_mask:0xf bank_mask:0xf
v_fmac_f32_dpp v44, v44, v9 quad_perm:[1,0,3,2] row_mask:0xf bank_mask:0xf
v_fmac_f32_dpp v45, v45, v9 quad_perm:[1,0,3,2] row_mask:0xf bank_mask:0xf
v_fmac_f32_dpp v28, v28, v9 quad_perm:[1,0,3,2] row_mask:0xf bank_mask:0xf
v_fmac_f32_dpp v29, v29, v9 quad_perm:[1,0,3,2] row_mask:0xf bank_mask:0xf
v_fmac_f32_dpp v60, v60, v9 quad_perm:[1,0,3,2] row_mask:0xf bank_mask:0xf
v_fmac_f32_dpp v61, v61, v9 quad_perm:[1,0,3,2] row_mask:0xf bank_mask:0xf
v_fmac_f32_dpp v76, v76, v9 quad_perm:[1,0,3,2] row_mask:0xf bank_mask:0xf
v_fmac_f32_dpp v77, v77, v9 quad_perm:[1,0,3,2] row_mask:0xf bank_mask:0xf
v_fmac_f32_dpp v46, v46, v9 quad_perm:[1,0,3,2] row_mask:0xf bank_mask:0xf
v_fmac_f32_dpp v47, v47, v9 quad_perm:[1,0,3,2] row_mask:0xf bank_mask:0xf
v_fmac_f32_dpp v30, v30, v9 quad_perm:[1,0,3,2] row_mask:0xf bank_mask:0xf
v_fmac_f32_dpp v31, v31, v9 quad_perm:[1,0,3,2] row_mask:0xf bank_mask:0xf
v_fmac_f32_dpp v62, v62, v9 quad_perm:[1,0,3,2] row_mask:0xf bank_mask:0xf
v_fmac_f32_dpp v63, v63, v9 quad_perm:[1,0,3,2] row_mask:0xf bank_mask:0xf
v_fmac_f32_dpp v22, v22, v9 quad_perm:[1,0,3,2] row_mask:0xf bank_mask:0xf
v_fmac_f32_dpp v23, v23, v9 quad_perm:[1,0,3,2] row_mask:0xf bank_mask:0xf
v_fmac_f32_dpp v54, v54, v9 quad_perm:[1,0,3,2] row_mask:0xf bank_mask:0xf
v_fmac_f32_dpp v55, v55, v9 quad_perm:[1,0,3,2] row_mask:0xf bank_mask:0xf
v_fmac_f32_dpp v38, v38, v9 quad_perm:[1,0,3,2] row_mask:0xf bank_mask:0xf
v_fmac_f32_dpp v39, v39, v9 quad_perm:[1,0,3,2] row_mask:0xf bank_mask:0xf
v_fmac_f32_dpp v70, v70, v9 quad_perm:[1,0,3,2] row_mask:0xf bank_mask:0xf
v_fmac_f32_dpp v71, v71, v9 quad_perm:[1,0,3,2] row_mask:0xf bank_mask:0xf
v_fmac_f32_dpp v78, v78, v9 quad_perm:[1,0,3,2] row_mask:0xf bank_mask:0xf
v_fmac_f32_dpp v79, v79, v9 quad_perm:[1,0,3,2] row_mask:0xf bank_mask:0xf
v_fmac_f32_dpp v32, v32, v9 quad_perm:[1,0,3,2] row_mask:0xf bank_mask:0xf
v_fmac_f32_dpp v33, v33, v9 quad_perm:[1,0,3,2] row_mask:0xf bank_mask:0xf
v_fmac_f32_dpp v24, v24, v9 quad_perm:[1,0,3,2] row_mask:0xf bank_mask:0xf
v_fmac_f32_dpp v25, v25, v9 quad_perm:[1,0,3,2] row_mask:0xf bank_mask:0xf
v_fmac_f32_dpp v56, v56, v9 quad_perm:[1,0,3,2] row_mask:0xf bank_mask:0xf
v_fmac_f32_dpp v57, v57, v9 quad_perm:[1,0,3,2] row_mask:0xf bank_mask:0xf
v_fmac_f32_dpp v20, v20, v9 quad_perm:[1,0,3,2] row_mask:0xf bank_mask:0xf
v_fmac_f32_dpp v21, v21, v9 quad_perm:[1,0,3,2] row_mask:0xf bank_mask:0xf
v_fmac_f32_dpp v52, v52, v9 quad_perm:[1,0,3,2] row_mask:0xf bank_mask:0xf
v_fmac_f32_dpp v53, v53, v9 quad_perm:[1,0,3,2] row_mask:0xf bank_mask:0xf
v_fmac_f32_dpp v36, v36, v9 quad_perm:[1,0,3,2] row_mask:0xf bank_mask:0xf
v_fmac_f32_dpp v37, v37, v9 quad_perm:[1,0,3,2] row_mask:0xf bank_mask:0xf
v_fmac_f32_dpp v68, v68, v9 quad_perm:[1,0,3,2] row_mask:0xf bank_mask:0xf
v_fmac_f32_dpp v69, v69, v9 quad_perm:[1,0,3,2] row_mask:0xf bank_mask:0xf
v_fmac_f32_dpp v18, v18, v9 quad_perm:[1,0,3,2] row_mask:0xf bank_mask:0xf
v_fmac_f32_dpp v19, v19, v9 quad_perm:[1,0,3,2] row_mask:0xf bank_mask:0xf
v_fmac_f32_dpp v50, v50, v9 quad_perm:[1,0,3,2] row_mask:0xf bank_mask:0xf
v_fmac_f32_dpp v51, v51, v9 quad_perm:[1,0,3,2] row_mask:0xf bank_mask:0xf
v_fmac_f32_dpp v34, v34, v9 quad_perm:[1,0,3,2] row_mask:0xf bank_mask:0xf
v_fmac_f32_dpp v35, v35, v9 quad_perm:[1,0,3,2] row_mask:0xf bank_mask:0xf
v_fmac_f32_dpp v66, v66, v9 quad_perm:[1,0,3,2] row_mask:0xf bank_mask:0xf
v_fmac_f32_dpp v67, v67, v9 quad_perm:[1,0,3,2] row_mask:0xf bank_mask:0xf
v_fmac_f32_dpp v26, v26, v9 quad_perm:[1,0,3,2] row_mask:0xf bank_mask:0xf
v_fmac_f32_dpp v27, v27, v9 quad_perm:[1,0,3,2] row_mask:0xf bank_mask:0xf
v_fmac_f32_dpp v58, v58, v9 quad_perm:[1,0,3,2] row_mask:0xf bank_mask:0xf
v_fmac_f32_dpp v59, v59, v9 quad_perm:[1,0,3,2] row_mask:0xf bank_mask:0xf
v_fmac_f32_dpp v42, v42, v9 quad_perm:[1,0,3,2] row_mask:0xf bank_mask:0xf
v_fmac_f32_dpp v43, v43, v9 quad_perm:[1,0,3,2] row_mask:0xf bank_mask:0xf
v_fmac_f32_dpp v74, v74, v9 quad_perm:[1,0,3,2] row_mask:0xf bank_mask:0xf
v_fmac_f32_dpp v75, v75, v9 quad_perm:[1,0,3,2] row_mask:0xf bank_mask:0xf
v_lshlrev_b32 v240, 16, v208
v_and_b32 v241, 0xffff0000, v208
v_pk_mul_f32 v[48:49], v[16:17], v[240:241] op_sel:[0,0] op_sel_hi:[0,1] neg_lo:[0,0] neg_hi:[0,0]
v_pk_fma_f32 v[16:17], v[16:17], v[240:241], v[48:49] op_sel:[1,1,0] op_sel_hi:[1,0,1] neg_lo:[0,1,0] neg_hi:[0,0,0]
v_lshlrev_b32 v240, 16, v209
v_and_b32 v241, 0xffff0000, v209
v_pk_mul_f32 v[48:49], v[14:15], v[240:241] op_sel:[0,0] op_sel_hi:[0,1] neg_lo:[0,0] neg_hi:[0,0]
v_pk_fma_f32 v[14:15], v[14:15], v[240:241], v[48:49] op_sel:[1,1,0] op_sel_hi:[1,0,1] neg_lo:[0,1,0] neg_hi:[0,0,0]
v_lshlrev_b32 v240, 16, v210
v_and_b32 v241, 0xffff0000, v210
v_pk_mul_f32 v[48:49], v[64:65], v[240:241] op_sel:[0,0] op_sel_hi:[0,1] neg_lo:[0,0] neg_hi:[0,0]
v_pk_fma_f32 v[64:65], v[64:65], v[240:241], v[48:49] op_sel:[1,1,0] op_sel_hi:[1,0,1] neg_lo:[0,1,0] neg_hi:[0,0,0]
v_lshlrev_b32 v240, 16, v211
v_and_b32 v241, 0xffff0000, v211
v_pk_mul_f32 v[48:49], v[40:41], v[240:241] op_sel:[0,0] op_sel_hi:[0,1] neg_lo:[0,0] neg_hi:[0,0]
v_pk_fma_f32 v[40:41], v[40:41], v[240:241], v[48:49] op_sel:[1,1,0] op_sel_hi:[1,0,1] neg_lo:[0,1,0] neg_hi:[0,0,0]
v_lshlrev_b32 v240, 16, v212
v_and_b32 v241, 0xffff0000, v212
v_pk_mul_f32 v[48:49], v[72:73], v[240:241] op_sel:[0,0] op_sel_hi:[0,1] neg_lo:[0,0] neg_hi:[0,0]
v_pk_fma_f32 v[72:73], v[72:73], v[240:241], v[48:49] op_sel:[1,1,0] op_sel_hi:[1,0,1] neg_lo:[0,1,0] neg_hi:[0,0,0]
v_lshlrev_b32 v240, 16, v213
v_and_b32 v241, 0xffff0000, v213
v_pk_mul_f32 v[48:49], v[44:45], v[240:241] op_sel:[0,0] op_sel_hi:[0,1] neg_lo:[0,0] neg_hi:[0,0]
v_pk_fma_f32 v[44:45], v[44:45], v[240:241], v[48:49] op_sel:[1,1,0] op_sel_hi:[1,0,1] neg_lo:[0,1,0] neg_hi:[0,0,0]
v_lshlrev_b32 v240, 16, v214
v_and_b32 v241, 0xffff0000, v214
v_pk_mul_f32 v[48:49], v[28:29], v[240:241] op_sel:[0,0] op_sel_hi:[0,1] neg_lo:[0,0] neg_hi:[0,0]
v_pk_fma_f32 v[28:29], v[28:29], v[240:241], v[48:49] op_sel:[1,1,0] op_sel_hi:[1,0,1] neg_lo:[0,1,0] neg_hi:[0,0,0]
v_lshlrev_b32 v240, 16, v215
v_and_b32 v241, 0xffff0000, v215
v_pk_mul_f32 v[48:49], v[60:61], v[240:241] op_sel:[0,0] op_sel_hi:[0,1] neg_lo:[0,0] neg_hi:[0,0]
v_pk_fma_f32 v[60:61], v[60:61], v[240:241], v[48:49] op_sel:[1,1,0] op_sel_hi:[1,0,1] neg_lo:[0,1,0] neg_hi:[0,0,0]
v_lshlrev_b32 v240, 16, v216
v_and_b32 v241, 0xffff0000, v216
v_pk_mul_f32 v[48:49], v[76:77], v[240:241] op_sel:[0,0] op_sel_hi:[0,1] neg_lo:[0,0] neg_hi:[0,0]
v_pk_fma_f32 v[76:77], v[76:77], v[240:241], v[48:49] op_sel:[1,1,0] op_sel_hi:[1,0,1] neg_lo:[0,1,0] neg_hi:[0,0,0]
v_lshlrev_b32 v240, 16, v217
v_and_b32 v241, 0xffff0000, v217
v_pk_mul_f32 v[48:49], v[46:47], v[240:241] op_sel:[0,0] op_sel_hi:[0,1] neg_lo:[0,0] neg_hi:[0,0]
v_pk_fma_f32 v[46:47], v[46:47], v[240:241], v[48:49] op_sel:[1,1,0] op_sel_hi:[1,0,1] neg_lo:[0,1,0] neg_hi:[0,0,0]
v_lshlrev_b32 v240, 16, v218
v_and_b32 v241, 0xffff0000, v218
v_pk_mul_f32 v[48:49], v[30:31], v[240:241] op_sel:[0,0] op_sel_hi:[0,1] neg_lo:[0,0] neg_hi:[0,0]
v_pk_fma_f32 v[30:31], v[30:31], v[240:241], v[48:49] op_sel:[1,1,0] op_sel_hi:[1,0,1] neg_lo:[0,1,0] neg_hi:[0,0,0]
v_lshlrev_b32 v240, 16, v219
v_and_b32 v241, 0xffff0000, v219
v_pk_mul_f32 v[48:49], v[62:63], v[240:241] op_sel:[0,0] op_sel_hi:[0,1] neg_lo:[0,0] neg_hi:[0,0]
v_pk_fma_f32 v[62:63], v[62:63], v[240:241], v[48:49] op_sel:[1,1,0] op_sel_hi:[1,0,1] neg_lo:[0,1,0] neg_hi:[0,0,0]
v_lshlrev_b32 v240, 16, v220
v_and_b32 v241, 0xffff0000, v220
v_pk_mul_f32 v[48:49], v[22:23], v[240:241] op_sel:[0,0] op_sel_hi:[0,1] neg_lo:[0,0] neg_hi:[0,0]
v_pk_fma_f32 v[22:23], v[22:23], v[240:241], v[48:49] op_sel:[1,1,0] op_sel_hi:[1,0,1] neg_lo:[0,1,0] neg_hi:[0,0,0]
v_lshlrev_b32 v240, 16, v221
v_and_b32 v241, 0xffff0000, v221
v_pk_mul_f32 v[48:49], v[54:55], v[240:241] op_sel:[0,0] op_sel_hi:[0,1] neg_lo:[0,0] neg_hi:[0,0]
v_pk_fma_f32 v[54:55], v[54:55], v[240:241], v[48:49] op_sel:[1,1,0] op_sel_hi:[1,0,1] neg_lo:[0,1,0] neg_hi:[0,0,0]
v_lshlrev_b32 v240, 16, v222
v_and_b32 v241, 0xffff0000, v222
v_pk_mul_f32 v[48:49], v[38:39], v[240:241] op_sel:[0,0] op_sel_hi:[0,1] neg_lo:[0,0] neg_hi:[0,0]
v_pk_fma_f32 v[38:39], v[38:39], v[240:241], v[48:49] op_sel:[1,1,0] op_sel_hi:[1,0,1] neg_lo:[0,1,0] neg_hi:[0,0,0]
v_lshlrev_b32 v240, 16, v223
v_and_b32 v241, 0xffff0000, v223
v_pk_mul_f32 v[48:49], v[70:71], v[240:241] op_sel:[0,0] op_sel_hi:[0,1] neg_lo:[0,0] neg_hi:[0,0]
v_pk_fma_f32 v[70:71], v[70:71], v[240:241], v[48:49] op_sel:[1,1,0] op_sel_hi:[1,0,1] neg_lo:[0,1,0] neg_hi:[0,0,0]
v_lshlrev_b32 v240, 16, v224
v_and_b32 v241, 0xffff0000, v224
v_pk_mul_f32 v[48:49], v[78:79], v[240:241] op_sel:[0,0] op_sel_hi:[0,1] neg_lo:[0,0] neg_hi:[0,0]
v_pk_fma_f32 v[78:79], v[78:79], v[240:241], v[48:49] op_sel:[1,1,0] op_sel_hi:[1,0,1] neg_lo:[0,1,0] neg_hi:[0,0,0]
v_lshlrev_b32 v240, 16, v225
v_and_b32 v241, 0xffff0000, v225
v_pk_mul_f32 v[48:49], v[32:33], v[240:241] op_sel:[0,0] op_sel_hi:[0,1] neg_lo:[0,0] neg_hi:[0,0]
v_pk_fma_f32 v[32:33], v[32:33], v[240:241], v[48:49] op_sel:[1,1,0] op_sel_hi:[1,0,1] neg_lo:[0,1,0] neg_hi:[0,0,0]
v_lshlrev_b32 v240, 16, v226
v_and_b32 v241, 0xffff0000, v226
v_pk_mul_f32 v[48:49], v[24:25], v[240:241] op_sel:[0,0] op_sel_hi:[0,1] neg_lo:[0,0] neg_hi:[0,0]
v_pk_fma_f32 v[24:25], v[24:25], v[240:241], v[48:49] op_sel:[1,1,0] op_sel_hi:[1,0,1] neg_lo:[0,1,0] neg_hi:[0,0,0]
v_lshlrev_b32 v240, 16, v227
v_and_b32 v241, 0xffff0000, v227
v_pk_mul_f32 v[48:49], v[56:57], v[240:241] op_sel:[0,0] op_sel_hi:[0,1] neg_lo:[0,0] neg_hi:[0,0]
v_pk_fma_f32 v[56:57], v[56:57], v[240:241], v[48:49] op_sel:[1,1,0] op_sel_hi:[1,0,1] neg_lo:[0,1,0] neg_hi:[0,0,0]
v_lshlrev_b32 v240, 16, v228
v_and_b32 v241, 0xffff0000, v228
v_pk_mul_f32 v[48:49], v[20:21], v[240:241] op_sel:[0,0] op_sel_hi:[0,1] neg_lo:[0,0] neg_hi:[0,0]
v_pk_fma_f32 v[20:21], v[20:21], v[240:241], v[48:49] op_sel:[1,1,0] op_sel_hi:[1,0,1] neg_lo:[0,1,0] neg_hi:[0,0,0]
v_lshlrev_b32 v240, 16, v229
v_and_b32 v241, 0xffff0000, v229
v_pk_mul_f32 v[48:49], v[52:53], v[240:241] op_sel:[0,0] op_sel_hi:[0,1] neg_lo:[0,0] neg_hi:[0,0]
v_pk_fma_f32 v[52:53], v[52:53], v[240:241], v[48:49] op_sel:[1,1,0] op_sel_hi:[1,0,1] neg_lo:[0,1,0] neg_hi:[0,0,0]
v_lshlrev_b32 v240, 16, v230
v_and_b32 v241, 0xffff0000, v230
v_pk_mul_f32 v[48:49], v[36:37], v[240:241] op_sel:[0,0] op_sel_hi:[0,1] neg_lo:[0,0] neg_hi:[0,0]
v_pk_fma_f32 v[36:37], v[36:37], v[240:241], v[48:49] op_sel:[1,1,0] op_sel_hi:[1,0,1] neg_lo:[0,1,0] neg_hi:[0,0,0]
v_lshlrev_b32 v240, 16, v231
v_and_b32 v241, 0xffff0000, v231
v_pk_mul_f32 v[48:49], v[68:69], v[240:241] op_sel:[0,0] op_sel_hi:[0,1] neg_lo:[0,0] neg_hi:[0,0]
v_pk_fma_f32 v[68:69], v[68:69], v[240:241], v[48:49] op_sel:[1,1,0] op_sel_hi:[1,0,1] neg_lo:[0,1,0] neg_hi:[0,0,0]
v_lshlrev_b32 v240, 16, v232
v_and_b32 v241, 0xffff0000, v232
v_pk_mul_f32 v[48:49], v[18:19], v[240:241] op_sel:[0,0] op_sel_hi:[0,1] neg_lo:[0,0] neg_hi:[0,0]
v_pk_fma_f32 v[18:19], v[18:19], v[240:241], v[48:49] op_sel:[1,1,0] op_sel_hi:[1,0,1] neg_lo:[0,1,0] neg_hi:[0,0,0]
v_lshlrev_b32 v240, 16, v233
v_and_b32 v241, 0xffff0000, v233
v_pk_mul_f32 v[48:49], v[50:51], v[240:241] op_sel:[0,0] op_sel_hi:[0,1] neg_lo:[0,0] neg_hi:[0,0]
v_pk_fma_f32 v[50:51], v[50:51], v[240:241], v[48:49] op_sel:[1,1,0] op_sel_hi:[1,0,1] neg_lo:[0,1,0] neg_hi:[0,0,0]
v_lshlrev_b32 v240, 16, v234
v_and_b32 v241, 0xffff0000, v234
v_pk_mul_f32 v[48:49], v[34:35], v[240:241] op_sel:[0,0] op_sel_hi:[0,1] neg_lo:[0,0] neg_hi:[0,0]
v_pk_fma_f32 v[34:35], v[34:35], v[240:241], v[48:49] op_sel:[1,1,0] op_sel_hi:[1,0,1] neg_lo:[0,1,0] neg_hi:[0,0,0]
v_lshlrev_b32 v240, 16, v235
v_and_b32 v241, 0xffff0000, v235
v_pk_mul_f32 v[48:49], v[66:67], v[240:241] op_sel:[0,0] op_sel_hi:[0,1] neg_lo:[0,0] neg_hi:[0,0]
v_pk_fma_f32 v[66:67], v[66:67], v[240:241], v[48:49] op_sel:[1,1,0] op_sel_hi:[1,0,1] neg_lo:[0,1,0] neg_hi:[0,0,0]
v_lshlrev_b32 v240, 16, v236
v_and_b32 v241, 0xffff0000, v236
v_pk_mul_f32 v[48:49], v[26:27], v[240:241] op_sel:[0,0] op_sel_hi:[0,1] neg_lo:[0,0] neg_hi:[0,0]
v_pk_fma_f32 v[26:27], v[26:27], v[240:241], v[48:49] op_sel:[1,1,0] op_sel_hi:[1,0,1] neg_lo:[0,1,0] neg_hi:[0,0,0]
v_lshlrev_b32 v240, 16, v237
v_and_b32 v241, 0xffff0000, v237
v_pk_mul_f32 v[48:49], v[58:59], v[240:241] op_sel:[0,0] op_sel_hi:[0,1] neg_lo:[0,0] neg_hi:[0,0]
v_pk_fma_f32 v[58:59], v[58:59], v[240:241], v[48:49] op_sel:[1,1,0] op_sel_hi:[1,0,1] neg_lo:[0,1,0] neg_hi:[0,0,0]
v_lshlrev_b32 v240, 16, v238
v_and_b32 v241, 0xffff0000, v238
v_pk_mul_f32 v[48:49], v[42:43], v[240:241] op_sel:[0,0] op_sel_hi:[0,1] neg_lo:[0,0] neg_hi:[0,0]
v_pk_fma_f32 v[42:43], v[42:43], v[240:241], v[48:49] op_sel:[1,1,0] op_sel_hi:[1,0,1] neg_lo:[0,1,0] neg_hi:[0,0,0]
v_lshlrev_b32 v240, 16, v239
v_and_b32 v241, 0xffff0000, v239
v_pk_mul_f32 v[48:49], v[74:75], v[240:241] op_sel:[0,0] op_sel_hi:[0,1] neg_lo:[0,0] neg_hi:[0,0]
v_pk_fma_f32 v[74:75], v[74:75], v[240:241], v[48:49] op_sel:[1,1,0] op_sel_hi:[1,0,1] neg_lo:[0,1,0] neg_hi:[0,0,0]
v_fmac_f32_dpp v16, v16, v7 quad_perm:[1,0,3,2] row_mask:0xf bank_mask:0xf
v_fmac_f32_dpp v17, v17, v7 quad_perm:[1,0,3,2] row_mask:0xf bank_mask:0xf
v_fmac_f32_dpp v14, v14, v7 quad_perm:[1,0,3,2] row_mask:0xf bank_mask:0xf
v_fmac_f32_dpp v15, v15, v7 quad_perm:[1,0,3,2] row_mask:0xf bank_mask:0xf
v_fmac_f32_dpp v64, v64, v7 quad_perm:[1,0,3,2] row_mask:0xf bank_mask:0xf
v_fmac_f32_dpp v65, v65, v7 quad_perm:[1,0,3,2] row_mask:0xf bank_mask:0xf
v_fmac_f32_dpp v40, v40, v7 quad_perm:[1,0,3,2] row_mask:0xf bank_mask:0xf
v_fmac_f32_dpp v41, v41, v7 quad_perm:[1,0,3,2] row_mask:0xf bank_mask:0xf
v_fmac_f32_dpp v72, v72, v7 quad_perm:[1,0,3,2] row_mask:0xf bank_mask:0xf
v_fmac_f32_dpp v73, v73, v7 quad_perm:[1,0,3,2] row_mask:0xf bank_mask:0xf
v_fmac_f32_dpp v44, v44, v7 quad_perm:[1,0,3,2] row_mask:0xf bank_mask:0xf
v_fmac_f32_dpp v45, v45, v7 quad_perm:[1,0,3,2] row_mask:0xf bank_mask:0xf
v_fmac_f32_dpp v28, v28, v7 quad_perm:[1,0,3,2] row_mask:0xf bank_mask:0xf
v_fmac_f32_dpp v29, v29, v7 quad_perm:[1,0,3,2] row_mask:0xf bank_mask:0xf
v_fmac_f32_dpp v60, v60, v7 quad_perm:[1,0,3,2] row_mask:0xf bank_mask:0xf
v_fmac_f32_dpp v61, v61, v7 quad_perm:[1,0,3,2] row_mask:0xf bank_mask:0xf
v_fmac_f32_dpp v76, v76, v7 quad_perm:[1,0,3,2] row_mask:0xf bank_mask:0xf
v_fmac_f32_dpp v77, v77, v7 quad_perm:[1,0,3,2] row_mask:0xf bank_mask:0xf
v_fmac_f32_dpp v46, v46, v7 quad_perm:[1,0,3,2] row_mask:0xf bank_mask:0xf
v_fmac_f32_dpp v47, v47, v7 quad_perm:[1,0,3,2] row_mask:0xf bank_mask:0xf
v_fmac_f32_dpp v30, v30, v7 quad_perm:[1,0,3,2] row_mask:0xf bank_mask:0xf
v_fmac_f32_dpp v31, v31, v7 quad_perm:[1,0,3,2] row_mask:0xf bank_mask:0xf
v_fmac_f32_dpp v62, v62, v7 quad_perm:[1,0,3,2] row_mask:0xf bank_mask:0xf
v_fmac_f32_dpp v63, v63, v7 quad_perm:[1,0,3,2] row_mask:0xf bank_mask:0xf
v_fmac_f32_dpp v22, v22, v7 quad_perm:[1,0,3,2] row_mask:0xf bank_mask:0xf
v_fmac_f32_dpp v23, v23, v7 quad_perm:[1,0,3,2] row_mask:0xf bank_mask:0xf
v_fmac_f32_dpp v54, v54, v7 quad_perm:[1,0,3,2] row_mask:0xf bank_mask:0xf
v_fmac_f32_dpp v55, v55, v7 quad_perm:[1,0,3,2] row_mask:0xf bank_mask:0xf
v_fmac_f32_dpp v38, v38, v7 quad_perm:[1,0,3,2] row_mask:0xf bank_mask:0xf
v_fmac_f32_dpp v39, v39, v7 quad_perm:[1,0,3,2] row_mask:0xf bank_mask:0xf
v_fmac_f32_dpp v70, v70, v7 quad_perm:[1,0,3,2] row_mask:0xf bank_mask:0xf
v_fmac_f32_dpp v71, v71, v7 quad_perm:[1,0,3,2] row_mask:0xf bank_mask:0xf
v_fmac_f32_dpp v78, v78, v7 quad_perm:[1,0,3,2] row_mask:0xf bank_mask:0xf
v_fmac_f32_dpp v79, v79, v7 quad_perm:[1,0,3,2] row_mask:0xf bank_mask:0xf
v_fmac_f32_dpp v32, v32, v7 quad_perm:[1,0,3,2] row_mask:0xf bank_mask:0xf
v_fmac_f32_dpp v33, v33, v7 quad_perm:[1,0,3,2] row_mask:0xf bank_mask:0xf
v_fmac_f32_dpp v24, v24, v7 quad_perm:[1,0,3,2] row_mask:0xf bank_mask:0xf
v_fmac_f32_dpp v25, v25, v7 quad_perm:[1,0,3,2] row_mask:0xf bank_mask:0xf
v_fmac_f32_dpp v56, v56, v7 quad_perm:[1,0,3,2] row_mask:0xf bank_mask:0xf
v_fmac_f32_dpp v57, v57, v7 quad_perm:[1,0,3,2] row_mask:0xf bank_mask:0xf
v_fmac_f32_dpp v20, v20, v7 quad_perm:[1,0,3,2] row_mask:0xf bank_mask:0xf
v_fmac_f32_dpp v21, v21, v7 quad_perm:[1,0,3,2] row_mask:0xf bank_mask:0xf
v_fmac_f32_dpp v52, v52, v7 quad_perm:[1,0,3,2] row_mask:0xf bank_mask:0xf
v_fmac_f32_dpp v53, v53, v7 quad_perm:[1,0,3,2] row_mask:0xf bank_mask:0xf
v_fmac_f32_dpp v36, v36, v7 quad_perm:[1,0,3,2] row_mask:0xf bank_mask:0xf
v_fmac_f32_dpp v37, v37, v7 quad_perm:[1,0,3,2] row_mask:0xf bank_mask:0xf
v_fmac_f32_dpp v68, v68, v7 quad_perm:[1,0,3,2] row_mask:0xf bank_mask:0xf
v_fmac_f32_dpp v69, v69, v7 quad_perm:[1,0,3,2] row_mask:0xf bank_mask:0xf
v_fmac_f32_dpp v18, v18, v7 quad_perm:[1,0,3,2] row_mask:0xf bank_mask:0xf
v_fmac_f32_dpp v19, v19, v7 quad_perm:[1,0,3,2] row_mask:0xf bank_mask:0xf
v_fmac_f32_dpp v50, v50, v7 quad_perm:[1,0,3,2] row_mask:0xf bank_mask:0xf
v_fmac_f32_dpp v51, v51, v7 quad_perm:[1,0,3,2] row_mask:0xf bank_mask:0xf
v_fmac_f32_dpp v34, v34, v7 quad_perm:[1,0,3,2] row_mask:0xf bank_mask:0xf
v_fmac_f32_dpp v35, v35, v7 quad_perm:[1,0,3,2] row_mask:0xf bank_mask:0xf
v_fmac_f32_dpp v66, v66, v7 quad_perm:[1,0,3,2] row_mask:0xf bank_mask:0xf
v_fmac_f32_dpp v67, v67, v7 quad_perm:[1,0,3,2] row_mask:0xf bank_mask:0xf
v_fmac_f32_dpp v26, v26, v7 quad_perm:[1,0,3,2] row_mask:0xf bank_mask:0xf
v_fmac_f32_dpp v27, v27, v7 quad_perm:[1,0,3,2] row_mask:0xf bank_mask:0xf
v_fmac_f32_dpp v58, v58, v7 quad_perm:[1,0,3,2] row_mask:0xf bank_mask:0xf
v_fmac_f32_dpp v59, v59, v7 quad_perm:[1,0,3,2] row_mask:0xf bank_mask:0xf
v_fmac_f32_dpp v42, v42, v7 quad_perm:[1,0,3,2] row_mask:0xf bank_mask:0xf
v_fmac_f32_dpp v43, v43, v7 quad_perm:[1,0,3,2] row_mask:0xf bank_mask:0xf
v_fmac_f32_dpp v74, v74, v7 quad_perm:[1,0,3,2] row_mask:0xf bank_mask:0xf
v_fmac_f32_dpp v75, v75, v7 quad_perm:[1,0,3,2] row_mask:0xf bank_mask:0xf
s_mov_b64 exec, s[18:19]
v_pk_add_f32 v[16:17], v[16:17], 0 neg_lo:[1,0] neg_hi:[1,0]
v_pk_mul_f32 v[48:49], v[14:15], s[48:49] op_sel:[0,0] op_sel_hi:[0,1] neg_lo:[0,1] neg_hi:[0,1]
v_pk_fma_f32 v[14:15], v[14:15], s[48:49], v[48:49] op_sel:[1,1,0] op_sel_hi:[1,0,1] neg_lo:[0,0,0] neg_hi:[0,1,0]
v_pk_mul_f32 v[48:49], v[64:65], s[50:51] op_sel:[0,0] op_sel_hi:[0,1] neg_lo:[0,1] neg_hi:[0,1]
v_pk_fma_f32 v[64:65], v[64:65], s[50:51], v[48:49] op_sel:[1,1,0] op_sel_hi:[1,0,1] neg_lo:[0,0,0] neg_hi:[0,1,0]
v_pk_mul_f32 v[48:49], v[40:41], s[52:53] op_sel:[0,0] op_sel_hi:[0,1] neg_lo:[0,1] neg_hi:[0,1]
v_pk_fma_f32 v[40:41], v[40:41], s[52:53], v[48:49] op_sel:[1,1,0] op_sel_hi:[1,0,1] neg_lo:[0,0,0] neg_hi:[0,1,0]
v_pk_mul_f32 v[48:49], v[72:73], s[54:55] op_sel:[0,0] op_sel_hi:[0,1] neg_lo:[0,1] neg_hi:[0,1]
v_pk_fma_f32 v[72:73], v[72:73], s[54:55], v[48:49] op_sel:[1,1,0] op_sel_hi:[1,0,1] neg_lo:[0,0,0] neg_hi:[0,1,0]
v_pk_mul_f32 v[48:49], v[44:45], s[56:57] op_sel:[0,0] op_sel_hi:[0,1] neg_lo:[0,1] neg_hi:[0,1]
v_pk_fma_f32 v[44:45], v[44:45], s[56:57], v[48:49] op_sel:[1,1,0] op_sel_hi:[1,0,1] neg_lo:[0,0,0] neg_hi:[0,1,0]
v_pk_mul_f32 v[48:49], v[28:29], s[58:59] op_sel:[0,0] op_sel_hi:[0,1] neg_lo:[0,1] neg_hi:[0,1]
v_pk_fma_f32 v[28:29], v[28:29], s[58:59], v[48:49] op_sel:[1,1,0] op_sel_hi:[1,0,1] neg_lo:[0,0,0] neg_hi:[0,1,0]
v_pk_mul_f32 v[48:49], v[60:61], s[60:61] op_sel:[0,0] op_sel_hi:[0,1] neg_lo:[0,1] neg_hi:[0,1]
v_pk_fma_f32 v[60:61], v[60:61], s[60:61], v[48:49] op_sel:[1,1,0] op_sel_hi:[1,0,1] neg_lo:[0,0,0] neg_hi:[0,1,0]
v_pk_mul_f32 v[48:49], v[76:77], s[62:63] op_sel:[0,0] op_sel_hi:[0,1] neg_lo:[0,1] neg_hi:[0,1]
v_pk_fma_f32 v[76:77], v[76:77], s[62:63], v[48:49] op_sel:[1,1,0] op_sel_hi:[1,0,1] neg_lo:[0,0,0] neg_hi:[0,1,0]
v_pk_mul_f32 v[48:49], v[46:47], s[60:61] op_sel:[0,1] op_sel_hi:[0,0] neg_lo:[0,1] neg_hi:[0,1]
v_pk_fma_f32 v[46:47], v[46:47], s[60:61], v[48:49] op_sel:[1,0,0] op_sel_hi:[1,1,1] neg_lo:[0,0,0] neg_hi:[0,1,0]
v_pk_mul_f32 v[48:49], v[30:31], s[58:59] op_sel:[0,1] op_sel_hi:[0,0] neg_lo:[0,1] neg_hi:[0,1]
v_pk_fma_f32 v[30:31], v[30:31], s[58:59], v[48:49] op_sel:[1,0,0] op_sel_hi:[1,1,1] neg_lo:[0,0,0] neg_hi:[0,1,0]
v_pk_mul_f32 v[48:49], v[62:63], s[56:57] op_sel:[0,1] op_sel_hi:[0,0] neg_lo:[0,1] neg_hi:[0,1]
v_pk_fma_f32 v[62:63], v[62:63], s[56:57], v[48:49] op_sel:[1,0,0] op_sel_hi:[1,1,1] neg_lo:[0,0,0] neg_hi:[0,1,0]
v_pk_mul_f32 v[48:49], v[22:23], s[54:55] op_sel:[0,1] op_sel_hi:[0,0] neg_lo:[0,1] neg_hi:[0,1]
v_pk_fma_f32 v[22:23], v[22:23], s[54:55], v[48:49] op_sel:[1,0,0] op_sel_hi:[1,1,1] neg_lo:[0,0,0] neg_hi:[0,1,0]
v_pk_mul_f32 v[48:49], v[54:55], s[52:53] op_sel:[0,1] op_sel_hi:[0,0] neg_lo:[0,1] neg_hi:[0,1]
v_pk_fma_f32 v[54:55], v[54:55], s[52:53], v[48:49] op_sel:[1,0,0] op_sel_hi:[1,1,1] neg_lo:[0,0,0] neg_hi:[0,1,0]
v_pk_mul_f32 v[48:49], v[38:39], s[50:51] op_sel:[0,1] op_sel_hi:[0,0] neg_lo:[0,1] neg_hi:[0,1]
v_pk_fma_f32 v[38:39], v[38:39], s[50:51], v[48:49] op_sel:[1,0,0] op_sel_hi:[1,1,1] neg_lo:[0,0,0] neg_hi:[0,1,0]
v_pk_mul_f32 v[48:49], v[70:71], s[48:49] op_sel:[0,1] op_sel_hi:[0,0] neg_lo:[0,1] neg_hi:[0,1]
v_pk_fma_f32 v[70:71], v[70:71], s[48:49], v[48:49] op_sel:[1,0,0] op_sel_hi:[1,1,1] neg_lo:[0,0,0] neg_hi:[0,1,0]
v_pk_add_f32 v[78:79], v[78:79], 0 op_sel:[1,0] op_sel_hi:[0,0] neg_lo:[0,0] neg_hi:[1,0]
v_pk_mul_f32 v[48:49], v[32:33], s[48:49] op_sel:[0,1] op_sel_hi:[0,0] neg_lo:[0,0] neg_hi:[0,1]
v_pk_fma_f32 v[32:33], v[32:33], s[48:49], v[48:49] op_sel:[1,0,0] op_sel_hi:[1,1,1] neg_lo:[0,0,0] neg_hi:[0,0,0]
v_pk_mul_f32 v[48:49], v[24:25], s[50:51] op_sel:[0,1] op_sel_hi:[0,0] neg_lo:[0,0] neg_hi:[0,1]
v_pk_fma_f32 v[24:25], v[24:25], s[50:51], v[48:49] op_sel:[1,0,0] op_sel_hi:[1,1,1] neg_lo:[0,0,0] neg_hi:[0,0,0]
v_pk_mul_f32 v[48:49], v[56:57], s[52:53] op_sel:[0,1] op_sel_hi:[0,0] neg_lo:[0,0] neg_hi:[0,1]
v_pk_fma_f32 v[56:57], v[56:57], s[52:53], v[48:49] op_sel:[1,0,0] op_sel_hi:[1,1,1] neg_lo:[0,0,0] neg_hi:[0,0,0]
v_pk_mul_f32 v[48:49], v[20:21], s[54:55] op_sel:[0,1] op_sel_hi:[0,0] neg_lo:[0,0] neg_hi:[0,1]
v_pk_fma_f32 v[20:21], v[20:21], s[54:55], v[48:49] op_sel:[1,0,0] op_sel_hi:[1,1,1] neg_lo:[0,0,0] neg_hi:[0,0,0]
v_pk_mul_f32 v[48:49], v[52:53], s[56:57] op_sel:[0,1] op_sel_hi:[0,0] neg_lo:[0,0] neg_hi:[0,1]
v_pk_fma_f32 v[52:53], v[52:53], s[56:57], v[48:49] op_sel:[1,0,0] op_sel_hi:[1,1,1] neg_lo:[0,0,0] neg_hi:[0,0,0]
v_pk_mul_f32 v[48:49], v[36:37], s[58:59] op_sel:[0,1] op_sel_hi:[0,0] neg_lo:[0,0] neg_hi:[0,1]
v_pk_fma_f32 v[36:37], v[36:37], s[58:59], v[48:49] op_sel:[1,0,0] op_sel_hi:[1,1,1] neg_lo:[0,0,0] neg_hi:[0,0,0]
v_pk_mul_f32 v[48:49], v[68:69], s[60:61] op_sel:[0,1] op_sel_hi:[0,0] neg_lo:[0,0] neg_hi:[0,1]
v_pk_fma_f32 v[68:69], v[68:69], s[60:61], v[48:49] op_sel:[1,0,0] op_sel_hi:[1,1,1] neg_lo:[0,0,0] neg_hi:[0,0,0]
v_pk_mul_f32 v[48:49], v[18:19], s[62:63] op_sel:[0,0] op_sel_hi:[0,1] neg_lo:[0,0] neg_hi:[0,1]
v_pk_fma_f32 v[18:19], v[18:19], s[62:63], v[48:49] op_sel:[1,1,0] op_sel_hi:[1,0,1] neg_lo:[0,0,0] neg_hi:[0,0,0]
v_pk_mul_f32 v[48:49], v[50:51], s[60:61] op_sel:[0,0] op_sel_hi:[0,1] neg_lo:[0,0] neg_hi:[0,1]
v_pk_fma_f32 v[50:51], v[50:51], s[60:61], v[48:49] op_sel:[1,1,0] op_sel_hi:[1,0,1] neg_lo:[0,0,0] neg_hi:[0,0,0]
v_pk_mul_f32 v[48:49], v[34:35], s[58:59] op_sel:[0,0] op_sel_hi:[0,1] neg_lo:[0,0] neg_hi:[0,1]
v_pk_fma_f32 v[34:35], v[34:35], s[58:59], v[48:49] op_sel:[1,1,0] op_sel_hi:[1,0,1] neg_lo:[0,0,0] neg_hi:[0,0,0]
v_pk_mul_f32 v[48:49], v[66:67], s[56:57] op_sel:[0,0] op_sel_hi:[0,1] neg_lo:[0,0] neg_hi:[0,1]
v_pk_fma_f32 v[66:67], v[66:67], s[56:57], v[48:49] op_sel:[1,1,0] op_sel_hi:[1,0,1] neg_lo:[0,0,0] neg_hi:[0,0,0]
v_pk_mul_f32 v[48:49], v[26:27], s[54:55] op_sel:[0,0] op_sel_hi:[0,1] neg_lo:[0,0] neg_hi:[0,1]
v_pk_fma_f32 v[26:27], v[26:27], s[54:55], v[48:49] op_sel:[1,1,0] op_sel_hi:[1,0,1] neg_lo:[0,0,0] neg_hi:[0,0,0]
v_pk_mul_f32 v[48:49], v[58:59], s[52:53] op_sel:[0,0] op_sel_hi:[0,1] neg_lo:[0,0] neg_hi:[0,1]
v_pk_fma_f32 v[58:59], v[58:59], s[52:53], v[48:49] op_sel:[1,1,0] op_sel_hi:[1,0,1] neg_lo:[0,0,0] neg_hi:[0,0,0]
v_pk_mul_f32 v[48:49], v[42:43], s[50:51] op_sel:[0,0] op_sel_hi:[0,1] neg_lo:[0,0] neg_hi:[0,1]
v_pk_fma_f32 v[42:43], v[42:43], s[50:51], v[48:49] op_sel:[1,1,0] op_sel_hi:[1,0,1] neg_lo:[0,0,0] neg_hi:[0,0,0]
v_pk_mul_f32 v[48:49], v[74:75], s[48:49] op_sel:[0,0] op_sel_hi:[0,1] neg_lo:[0,0] neg_hi:[0,1]
v_pk_fma_f32 v[74:75], v[74:75], s[48:49], v[48:49] op_sel:[1,1,0] op_sel_hi:[1,0,1] neg_lo:[0,0,0] neg_hi:[0,0,0]
s_mov_b64 exec, -1
v_pk_add_f32 v[48:49], v[16:17], v[78:79] neg_lo:[0,1] neg_hi:[0,1]
v_pk_add_f32 v[16:17], v[16:17], v[78:79]
v_pk_add_f32 v[78:79], v[14:15], v[32:33] neg_lo:[0,1] neg_hi:[0,1]
v_pk_add_f32 v[14:15], v[14:15], v[32:33]
v_pk_mul_f32 v[32:33], v[78:79], s[50:51] op_sel:[0,0] op_sel_hi:[0,1] neg_lo:[0,0] neg_hi:[0,0]
v_pk_fma_f32 v[32:33], v[78:79], s[50:51], v[32:33] op_sel:[1,1,0] op_sel_hi:[1,0,1] neg_lo:[0,1,0] neg_hi:[0,0,0]
v_pk_add_f32 v[78:79], v[64:65], v[24:25] neg_lo:[0,1] neg_hi:[0,1]
v_pk_add_f32 v[64:65], v[64:65], v[24:25]
v_pk_mul_f32 v[24:25], v[78:79], s[54:55] op_sel:[0,0] op_sel_hi:[0,1] neg_lo:[0,0] neg_hi:[0,0]
v_pk_fma_f32 v[24:25], v[78:79], s[54:55], v[24:25] op_sel:[1,1,0] op_sel_hi:[1,0,1] neg_lo:[0,1,0] neg_hi:[0,0,0]
v_pk_add_f32 v[78:79], v[40:41], v[56:57] neg_lo:[0,1] neg_hi:[0,1]
v_pk_add_f32 v[40:41], v[40:41], v[56:57]
v_pk_mul_f32 v[56:57], v[78:79], s[58:59] op_sel:[0,0] op_sel_hi:[0,1] neg_lo:[0,0] neg_hi:[0,0]
v_pk_fma_f32 v[56:57], v[78:79], s[58:59], v[56:57] op_sel:[1,1,0] op_sel_hi:[1,0,1] neg_lo:[0,1,0] neg_hi:[0,0,0]
v_pk_add_f32 v[78:79], v[72:73], v[20:21] neg_lo:[0,1] neg_hi:[0,1]
v_pk_add_f32 v[72:73], v[72:73], v[20:21]
v_pk_mul_f32 v[20:21], v[78:79], s[62:63] op_sel:[0,0] op_sel_hi:[0,1] neg_lo:[0,0] neg_hi:[0,0]
v_pk_fma_f32 v[20:21], v[78:79], s[62:63], v[20:21] op_sel:[1,1,0] op_sel_hi:[1,0,1] neg_lo:[0,1,0] neg_hi:[0,0,0]
v_pk_add_f32 v[78:79], v[44:45], v[52:53] neg_lo:[0,1] neg_hi:[0,1]
v_pk_add_f32 v[44:45], v[44:45], v[52:53]
v_pk_mul_f32 v[52:53], v[78:79], s[58:59] op_sel:[0,1] op_sel_hi:[0,0] neg_lo:[0,0] neg_hi:[0,0]
v_pk_fma_f32 v[52:53], v[78:79], s[58:59], v[52:53] op_sel:[1,0,0] op_sel_hi:[1,1,1] neg_lo:[0,1,0] neg_hi:[0,0,0]
v_pk_add_f32 v[78:79], v[28:29], v[36:37] neg_lo:[0,1] neg_hi:[0,1]
v_pk_add_f32 v[28:29], v[28:29], v[36:37]
v_pk_mul_f32 v[36:37], v[78:79], s[54:55] op_sel:[0,1] op_sel_hi:[0,0] neg_lo:[0,0] neg_hi:[0,0]
v_pk_fma_f32 v[36:37], v[78:79], s[54:55], v[36:37] op_sel:[1,0,0] op_sel_hi:[1,1,1] neg_lo:[0,1,0] neg_hi:[0,0,0]
v_pk_add_f32 v[78:79], v[60:61], v[68:69] neg_lo:[0,1] neg_hi:[0,1]
v_pk_add_f32 v[60:61], v[60:61], v[68:69]
v_pk_mul_f32 v[68:69], v[78:79], s[50:51] op_sel:[0,1] op_sel_hi:[0,0] neg_lo:[0,0] neg_hi:[0,0]
v_pk_fma_f32 v[68:69], v[78:79], s[50:51], v[68:69] op_sel:[1,0,0] op_sel_hi:[1,1,1] neg_lo:[0,1,0] neg_hi:[0,0,0]
v_pk_add_f32 v[78:79], v[76:77], v[18:19] op_sel:[1,1] op_sel_hi:[0,0] neg_lo:[1,0] neg_hi:[0,1]
v_pk_add_f32 v[76:77], v[76:77], v[18:19]
v_pk_add_f32 v[18:19], v[46:47], v[50:51] neg_lo:[0,1] neg_hi:[0,1]
v_pk_add_f32 v[46:47], v[46:47], v[50:51]
v_pk_mul_f32 v[50:51], v[18:19], s[50:51] op_sel:[0,1] op_sel_hi:[0,0] neg_lo:[0,1] neg_hi:[0,0]
v_pk_fma_f32 v[50:51], v[18:19], s[50:51], v[50:51] op_sel:[1,0,0] op_sel_hi:[1,1,1] neg_lo:[0,1,0] neg_hi:[0,1,0]
v_pk_add_f32 v[18:19], v[30:31], v[34:35] neg_lo:[0,1] neg_hi:[0,1]
v_pk_add_f32 v[30:31], v[30:31], v[34:35]
v_pk_mul_f32 v[34:35], v[18:19], s[54:55] op_sel:[0,1] op_sel_hi:[0,0] neg_lo:[0,1] neg_hi:[0,0]
v_pk_fma_f32 v[34:35], v[18:19], s[54:55], v[34:35] op_sel:[1,0,0] op_sel_hi:[1,1,1] neg_lo:[0,1,0] neg_hi:[0,1,0]
v_pk_add_f32 v[18:19], v[62:63], v[66:67] neg_lo:[0,1] neg_hi:[0,1]
v_pk_add_f32 v[62:63], v[62:63], v[66:67]
v_pk_mul_f32 v[66:67], v[18:19], s[58:59] op_sel:[0,1] op_sel_hi:[0,0] neg_lo:[0,1] neg_hi:[0,0]
v_pk_fma_f32 v[66:67], v[18:19], s[58:59], v[66:67] op_sel:[1,0,0] op_sel_hi:[1,1,1] neg_lo:[0,1,0] neg_hi:[0,1,0]
v_pk_add_f32 v[18:19], v[22:23], v[26:27] neg_lo:[0,1] neg_hi:[0,1]
v_pk_add_f32 v[22:23], v[22:23], v[26:27]
v_pk_mul_f32 v[26:27], v[18:19], s[62:63] op_sel:[0,0] op_sel_hi:[0,1] neg_lo:[0,1] neg_hi:[0,0]
v_pk_fma_f32 v[26:27], v[18:19], s[62:63], v[26:27] op_sel:[1,1,0] op_sel_hi:[1,0,1] neg_lo:[0,1,0] neg_hi:[0,1,0]
v_pk_add_f32 v[18:19], v[54:55], v[58:59] neg_lo:[0,1] neg_hi:[0,1]
v_pk_add_f32 v[54:55], v[54:55], v[58:59]
v_pk_mul_f32 v[58:59], v[18:19], s[58:59] op_sel:[0,0] op_sel_hi:[0,1] neg_lo:[0,1] neg_hi:[0,0]
v_pk_fma_f32 v[58:59], v[18:19], s[58:59], v[58:59] op_sel:[1,1,0] op_sel_hi:[1,0,1] neg_lo:[0,1,0] neg_hi:[0,1,0]
v_pk_add_f32 v[18:19], v[38:39], v[42:43] neg_lo:[0,1] neg_hi:[0,1]
v_pk_add_f32 v[38:39], v[38:39], v[42:43]
v_pk_mul_f32 v[42:43], v[18:19], s[54:55] op_sel:[0,0] op_sel_hi:[0,1] neg_lo:[0,1] neg_hi:[0,0]
v_pk_fma_f32 v[42:43], v[18:19], s[54:55], v[42:43] op_sel:[1,1,0] op_sel_hi:[1,0,1] neg_lo:[0,1,0] neg_hi:[0,1,0]
v_pk_add_f32 v[18:19], v[70:71], v[74:75] neg_lo:[0,1] neg_hi:[0,1]
v_pk_add_f32 v[70:71], v[70:71], v[74:75]
v_pk_mul_f32 v[74:75], v[18:19], s[50:51] op_sel:[0,0] op_sel_hi:[0,1] neg_lo:[0,1] neg_hi:[0,0]
v_pk_fma_f32 v[74:75], v[18:19], s[50:51], v[74:75] op_sel:[1,1,0] op_sel_hi:[1,0,1] neg_lo:[0,1,0] neg_hi:[0,1,0]
v_pk_add_f32 v[18:19], v[16:17], v[76:77] neg_lo:[0,1] neg_hi:[0,1]
v_pk_add_f32 v[16:17], v[16:17], v[76:77]
v_pk_add_f32 v[76:77], v[14:15], v[46:47] neg_lo:[0,1] neg_hi:[0,1]
v_pk_add_f32 v[14:15], v[14:15], v[46:47]
v_pk_mul_f32 v[46:47], v[76:77], s[54:55] op_sel:[0,0] op_sel_hi:[0,1] neg_lo:[0,0] neg_hi:[0,0]
v_pk_fma_f32 v[46:47], v[76:77], s[54:55], v[46:47] op_sel:[1,1,0] op_sel_hi:[1,0,1] neg_lo:[0,1,0] neg_hi:[0,0,0]
v_pk_add_f32 v[76:77], v[64:65], v[30:31] neg_lo:[0,1] neg_hi:[0,1]
v_pk_add_f32 v[64:65], v[64:65], v[30:31]
v_pk_mul_f32 v[30:31], v[76:77], s[62:63] op_sel:[0,0] op_sel_hi:[0,1] neg_lo:[0,0] neg_hi:[0,0]
v_pk_fma_f32 v[30:31], v[76:77], s[62:63], v[30:31] op_sel:[1,1,0] op_sel_hi:[1,0,1] neg_lo:[0,1,0] neg_hi:[0,0,0]
v_pk_add_f32 v[76:77], v[40:41], v[62:63] neg_lo:[0,1] neg_hi:[0,1]
v_pk_add_f32 v[40:41], v[40:41], v[62:63]
v_pk_mul_f32 v[62:63], v[76:77], s[54:55] op_sel:[0,1] op_sel_hi:[0,0] neg_lo:[0,0] neg_hi:[0,0]
v_pk_fma_f32 v[62:63], v[76:77], s[54:55], v[62:63] op_sel:[1,0,0] op_sel_hi:[1,1,1] neg_lo:[0,1,0] neg_hi:[0,0,0]
v_pk_add_f32 v[76:77], v[72:73], v[22:23] op_sel:[1,1] op_sel_hi:[0,0] neg_lo:[1,0] neg_hi:[0,1]
v_pk_add_f32 v[72:73], v[72:73], v[22:23]
v_pk_add_f32 v[22:23], v[44:45], v[54:55] neg_lo:[0,1] neg_hi:[0,1]
v_pk_add_f32 v[44:45], v[44:45], v[54:55]
v_pk_mul_f32 v[54:55], v[22:23], s[54:55] op_sel:[0,1] op_sel_hi:[0,0] neg_lo:[0,1] neg_hi:[0,0]
v_pk_fma_f32 v[54:55], v[22:23], s[54:55], v[54:55] op_sel:[1,0,0] op_sel_hi:[1,1,1] neg_lo:[0,1,0] neg_hi:[0,1,0]
v_pk_add_f32 v[22:23], v[28:29], v[38:39] neg_lo:[0,1] neg_hi:[0,1]
v_pk_add_f32 v[28:29], v[28:29], v[38:39]
v_pk_mul_f32 v[38:39], v[22:23], s[62:63] op_sel:[0,0] op_sel_hi:[0,1] neg_lo:[0,1] neg_hi:[0,0]
v_pk_fma_f32 v[38:39], v[22:23], s[62:63], v[38:39] op_sel:[1,1,0] op_sel_hi:[1,0,1] neg_lo:[0,1,0] neg_hi:[0,1,0]
v_pk_add_f32 v[22:23], v[60:61], v[70:71] neg_lo:[0,1] neg_hi:[0,1]
v_pk_add_f32 v[60:61], v[60:61], v[70:71]
v_pk_mul_f32 v[70:71], v[22:23], s[54:55] op_sel:[0,0] op_sel_hi:[0,1] neg_lo:[0,1] neg_hi:[0,0]
v_pk_fma_f32 v[70:71], v[22:23], s[54:55], v[70:71] op_sel:[1,1,0] op_sel_hi:[1,0,1] neg_lo:[0,1,0] neg_hi:[0,1,0]
v_pk_add_f32 v[22:23], v[48:49], v[78:79] neg_lo:[0,1] neg_hi:[0,1]
v_pk_add_f32 v[48:49], v[48:49], v[78:79]
v_pk_add_f32 v[78:79], v[32:33], v[50:51] neg_lo:[0,1] neg_hi:[0,1]
v_pk_add_f32 v[32:33], v[32:33], v[50:51]
v_pk_mul_f32 v[50:51], v[78:79], s[54:55] op_sel:[0,0] op_sel_hi:[0,1] neg_lo:[0,0] neg_hi:[0,0]
v_pk_fma_f32 v[50:51], v[78:79], s[54:55], v[50:51] op_sel:[1,1,0] op_sel_hi:[1,0,1] neg_lo:[0,1,0] neg_hi:[0,0,0]
v_pk_add_f32 v[78:79], v[24:25], v[34:35] neg_lo:[0,1] neg_hi:[0,1]
v_pk_add_f32 v[24:25], v[24:25], v[34:35]
v_pk_mul_f32 v[34:35], v[78:79], s[62:63] op_sel:[0,0] op_sel_hi:[0,1] neg_lo:[0,0] neg_hi:[0,0]
v_pk_fma_f32 v[34:35], v[78:79], s[62:63], v[34:35] op_sel:[1,1,0] op_sel_hi:[1,0,1] neg_lo:[0,1,0] neg_hi:[0,0,0]
v_pk_add_f32 v[78:79], v[56:57], v[66:67] neg_lo:[0,1] neg_hi:[0,1]
v_pk_add_f32 v[56:57], v[56:57], v[66:67]
v_pk_mul_f32 v[66:67], v[78:79], s[54:55] op_sel:[0,1] op_sel_hi:[0,0] neg_lo:[0,0] neg_hi:[0,0]
v_pk_fma_f32 v[66:67], v[78:79], s[54:55], v[66:67] op_sel:[1,0,0] op_sel_hi:[1,1,1] neg_lo:[0,1,0] neg_hi:[0,0,0]
v_pk_add_f32 v[78:79], v[20:21], v[26:27] op_sel:[1,1] op_sel_hi:[0,0] neg_lo:[1,0] neg_hi:[0,1]
v_pk_add_f32 v[20:21], v[20:21], v[26:27]
v_pk_add_f32 v[26:27], v[52:53], v[58:59] neg_lo:[0,1] neg_hi:[0,1]
v_pk_add_f32 v[52:53], v[52:53], v[58:59]
v_pk_mul_f32 v[58:59], v[26:27], s[54:55] op_sel:[0,1] op_sel_hi:[0,0] neg_lo:[0,1] neg_hi:[0,0]
v_pk_fma_f32 v[58:59], v[26:27], s[54:55], v[58:59] op_sel:[1,0,0] op_sel_hi:[1,1,1] neg_lo:[0,1,0] neg_hi:[0,1,0]
v_pk_add_f32 v[26:27], v[36:37], v[42:43] neg_lo:[0,1] neg_hi:[0,1]
v_pk_add_f32 v[36:37], v[36:37], v[42:43]
v_pk_mul_f32 v[42:43], v[26:27], s[62:63] op_sel:[0,0] op_sel_hi:[0,1] neg_lo:[0,1] neg_hi:[0,0]
v_pk_fma_f32 v[42:43], v[26:27], s[62:63], v[42:43] op_sel:[1,1,0] op_sel_hi:[1,0,1] neg_lo:[0,1,0] neg_hi:[0,1,0]
v_pk_add_f32 v[26:27], v[68:69], v[74:75] neg_lo:[0,1] neg_hi:[0,1]
v_pk_add_f32 v[68:69], v[68:69], v[74:75]
v_pk_mul_f32 v[74:75], v[26:27], s[54:55] op_sel:[0,0] op_sel_hi:[0,1] neg_lo:[0,1] neg_hi:[0,0]
v_pk_fma_f32 v[74:75], v[26:27], s[54:55], v[74:75] op_sel:[1,1,0] op_sel_hi:[1,0,1] neg_lo:[0,1,0] neg_hi:[0,1,0]
v_pk_add_f32 v[26:27], v[16:17], v[72:73] neg_lo:[0,1] neg_hi:[0,1]
v_pk_add_f32 v[16:17], v[16:17], v[72:73]
v_pk_add_f32 v[72:73], v[14:15], v[44:45] neg_lo:[0,1] neg_hi:[0,1]
v_pk_add_f32 v[14:15], v[14:15], v[44:45]
v_pk_mul_f32 v[44:45], v[72:73], s[62:63] op_sel:[0,0] op_sel_hi:[0,1] neg_lo:[0,0] neg_hi:[0,0]
v_pk_fma_f32 v[44:45], v[72:73], s[62:63], v[44:45] op_sel:[1,1,0] op_sel_hi:[1,0,1] neg_lo:[0,1,0] neg_hi:[0,0,0]
v_pk_add_f32 v[72:73], v[64:65], v[28:29] op_sel:[1,1] op_sel_hi:[0,0] neg_lo:[1,0] neg_hi:[0,1]
v_pk_add_f32 v[64:65], v[64:65], v[28:29]
v_pk_add_f32 v[28:29], v[40:41], v[60:61] neg_lo:[0,1] neg_hi:[0,1]
v_pk_add_f32 v[40:41], v[40:41], v[60:61]
v_pk_mul_f32 v[60:61], v[28:29], s[62:63] op_sel:[0,0] op_sel_hi:[0,1] neg_lo:[0,1] neg_hi:[0,0]
v_pk_fma_f32 v[60:61], v[28:29], s[62:63], v[60:61] op_sel:[1,1,0] op_sel_hi:[1,0,1] neg_lo:[0,1,0] neg_hi:[0,1,0]
v_pk_add_f32 v[28:29], v[18:19], v[76:77] neg_lo:[0,1] neg_hi:[0,1]
v_pk_add_f32 v[18:19], v[18:19], v[76:77]
v_pk_add_f32 v[76:77], v[46:47], v[54:55] neg_lo:[0,1] neg_hi:[0,1]
v_pk_add_f32 v[46:47], v[46:47], v[54:55]
v_pk_mul_f32 v[54:55], v[76:77], s[62:63] op_sel:[0,0] op_sel_hi:[0,1] neg_lo:[0,0] neg_hi:[0,0]
v_pk_fma_f32 v[54:55], v[76:77], s[62:63], v[54:55] op_sel:[1,1,0] op_sel_hi:[1,0,1] neg_lo:[0,1,0] neg_hi:[0,0,0]
v_pk_add_f32 v[76:77], v[30:31], v[38:39] op_sel:[1,1] op_sel_hi:[0,0] neg_lo:[1,0] neg_hi:[0,1]
v_pk_add_f32 v[30:31], v[30:31], v[38:39]
v_pk_add_f32 v[38:39], v[62:63], v[70:71] neg_lo:[0,1] neg_hi:[0,1]
v_pk_add_f32 v[62:63], v[62:63], v[70:71]
v_pk_mul_f32 v[70:71], v[38:39], s[62:63] op_sel:[0,0] op_sel_hi:[0,1] neg_lo:[0,1] neg_hi:[0,0]
v_pk_fma_f32 v[70:71], v[38:39], s[62:63], v[70:71] op_sel:[1,1,0] op_sel_hi:[1,0,1] neg_lo:[0,1,0] neg_hi:[0,1,0]
v_pk_add_f32 v[38:39], v[48:49], v[20:21] neg_lo:[0,1] neg_hi:[0,1]
v_pk_add_f32 v[48:49], v[48:49], v[20:21]
v_pk_add_f32 v[20:21], v[32:33], v[52:53] neg_lo:[0,1] neg_hi:[0,1]
v_pk_add_f32 v[32:33], v[32:33], v[52:53]
v_pk_mul_f32 v[52:53], v[20:21], s[62:63] op_sel:[0,0] op_sel_hi:[0,1] neg_lo:[0,0] neg_hi:[0,0]
v_pk_fma_f32 v[52:53], v[20:21], s[62:63], v[52:53] op_sel:[1,1,0] op_sel_hi:[1,0,1] neg_lo:[0,1,0] neg_hi:[0,0,0]
v_pk_add_f32 v[20:21], v[24:25], v[36:37] op_sel:[1,1] op_sel_hi:[0,0] neg_lo:[1,0] neg_hi:[0,1]
v_pk_add_f32 v[24:25], v[24:25], v[36:37]
v_pk_add_f32 v[36:37], v[56:57], v[68:69] neg_lo:[0,1] neg_hi:[0,1]
v_pk_add_f32 v[56:57], v[56:57], v[68:69]
v_pk_mul_f32 v[68:69], v[36:37], s[62:63] op_sel:[0,0] op_sel_hi:[0,1] neg_lo:[0,1] neg_hi:[0,0]
v_pk_fma_f32 v[68:69], v[36:37], s[62:63], v[68:69] op_sel:[1,1,0] op_sel_hi:[1,0,1] neg_lo:[0,1,0] neg_hi:[0,1,0]
v_pk_add_f32 v[36:37], v[22:23], v[78:79] neg_lo:[0,1] neg_hi:[0,1]
v_pk_add_f32 v[22:23], v[22:23], v[78:79]
v_pk_add_f32 v[78:79], v[50:51], v[58:59] neg_lo:[0,1] neg_hi:[0,1]
v_pk_add_f32 v[50:51], v[50:51], v[58:59]
v_pk_mul_f32 v[58:59], v[78:79], s[62:63] op_sel:[0,0] op_sel_hi:[0,1] neg_lo:[0,0] neg_hi:[0,0]
v_pk_fma_f32 v[58:59], v[78:79], s[62:63], v[58:59] op_sel:[1,1,0] op_sel_hi:[1,0,1] neg_lo:[0,1,0] neg_hi:[0,0,0]
v_pk_add_f32 v[78:79], v[34:35], v[42:43] op_sel:[1,1] op_sel_hi:[0,0] neg_lo:[1,0] neg_hi:[0,1]
v_pk_add_f32 v[34:35], v[34:35], v[42:43]
v_pk_add_f32 v[42:43], v[66:67], v[74:75] neg_lo:[0,1] neg_hi:[0,1]
v_pk_add_f32 v[66:67], v[66:67], v[74:75]
v_pk_mul_f32 v[74:75], v[42:43], s[62:63] op_sel:[0,0] op_sel_hi:[0,1] neg_lo:[0,1] neg_hi:[0,0]
v_pk_fma_f32 v[74:75], v[42:43], s[62:63], v[74:75] op_sel:[1,1,0] op_sel_hi:[1,0,1] neg_lo:[0,1,0] neg_hi:[0,1,0]
v_pk_add_f32 v[42:43], v[16:17], v[64:65] neg_lo:[0,1] neg_hi:[0,1]
v_pk_add_f32 v[16:17], v[16:17], v[64:65]
v_pk_add_f32 v[64:65], v[14:15], v[40:41] op_sel:[1,1] op_sel_hi:[0,0] neg_lo:[1,0] neg_hi:[0,1]
v_pk_add_f32 v[14:15], v[14:15], v[40:41]
v_pk_add_f32 v[40:41], v[26:27], v[72:73] neg_lo:[0,1] neg_hi:[0,1]
v_pk_add_f32 v[26:27], v[26:27], v[72:73]
v_pk_add_f32 v[72:73], v[44:45], v[60:61] op_sel:[1,1] op_sel_hi:[0,0] neg_lo:[1,0] neg_hi:[0,1]
v_pk_add_f32 v[44:45], v[44:45], v[60:61]
v_pk_add_f32 v[60:61], v[18:19], v[30:31] neg_lo:[0,1] neg_hi:[0,1]
v_pk_add_f32 v[18:19], v[18:19], v[30:31]
v_pk_add_f32 v[30:31], v[46:47], v[62:63] op_sel:[1,1] op_sel_hi:[0,0] neg_lo:[1,0] neg_hi:[0,1]
v_pk_add_f32 v[46:47], v[46:47], v[62:63]
v_pk_add_f32 v[62:63], v[28:29], v[76:77] neg_lo:[0,1] neg_hi:[0,1]
v_pk_add_f32 v[28:29], v[28:29], v[76:77]
v_pk_add_f32 v[76:77], v[54:55], v[70:71] op_sel:[1,1] op_sel_hi:[0,0] neg_lo:[1,0] neg_hi:[0,1]
v_pk_add_f32 v[54:55], v[54:55], v[70:71]
v_pk_add_f32 v[70:71], v[48:49], v[24:25] neg_lo:[0,1] neg_hi:[0,1]
v_pk_add_f32 v[48:49], v[48:49], v[24:25]
v_pk_add_f32 v[24:25], v[32:33], v[56:57] op_sel:[1,1] op_sel_hi:[0,0] neg_lo:[1,0] neg_hi:[0,1]
v_pk_add_f32 v[32:33], v[32:33], v[56:57]
v_pk_add_f32 v[56:57], v[38:39], v[20:21] neg_lo:[0,1] neg_hi:[0,1]
v_pk_add_f32 v[38:39], v[38:39], v[20:21]
v_pk_add_f32 v[20:21], v[52:53], v[68:69] op_sel:[1,1] op_sel_hi:[0,0] neg_lo:[1,0] neg_hi:[0,1]
v_pk_add_f32 v[52:53], v[52:53], v[68:69]
v_pk_add_f32 v[68:69], v[22:23], v[34:35] neg_lo:[0,1] neg_hi:[0,1]
v_pk_add_f32 v[22:23], v[22:23], v[34:35]
v_pk_add_f32 v[34:35], v[50:51], v[66:67] op_sel:[1,1] op_sel_hi:[0,0] neg_lo:[1,0] neg_hi:[0,1]
v_pk_add_f32 v[50:51], v[50:51], v[66:67]
v_pk_add_f32 v[66:67], v[36:37], v[78:79] neg_lo:[0,1] neg_hi:[0,1]
v_pk_add_f32 v[36:37], v[36:37], v[78:79]
v_pk_add_f32 v[78:79], v[58:59], v[74:75] op_sel:[1,1] op_sel_hi:[0,0] neg_lo:[1,0] neg_hi:[0,1]
v_pk_add_f32 v[58:59], v[58:59], v[74:75]
v_pk_add_f32 v[74:75], v[16:17], v[14:15] neg_lo:[0,1] neg_hi:[0,1]
v_pk_add_f32 v[16:17], v[16:17], v[14:15]
v_pk_add_f32 v[14:15], v[42:43], v[64:65] neg_lo:[0,1] neg_hi:[0,1]
v_pk_add_f32 v[42:43], v[42:43], v[64:65]
v_pk_add_f32 v[64:65], v[26:27], v[44:45] neg_lo:[0,1] neg_hi:[0,1]
v_pk_add_f32 v[26:27], v[26:27], v[44:45]
v_pk_add_f32 v[44:45], v[40:41], v[72:73] neg_lo:[0,1] neg_hi:[0,1]
v_pk_add_f32 v[40:41], v[40:41], v[72:73]
v_pk_add_f32 v[72:73], v[18:19], v[46:47] neg_lo:[0,1] neg_hi:[0,1]
v_pk_add_f32 v[18:19], v[18:19], v[46:47]
v_pk_add_f32 v[46:47], v[60:61], v[30:31] neg_lo:[0,1] neg_hi:[0,1]
v_pk_add_f32 v[60:61], v[60:61], v[30:31]
v_pk_add_f32 v[30:31], v[28:29], v[54:55] neg_lo:[0,1] neg_hi:[0,1]
v_pk_add_f32 v[28:29], v[28:29], v[54:55]
v_pk_add_f32 v[54:55], v[62:63], v[76:77] neg_lo:[0,1] neg_hi:[0,1]
v_pk_add_f32 v[62:63], v[62:63], v[76:77]
v_pk_add_f32 v[76:77], v[48:49], v[32:33] neg_lo:[0,1] neg_hi:[0,1]
v_pk_add_f32 v[48:49], v[48:49], v[32:33]
v_pk_add_f32 v[32:33], v[70:71], v[24:25] neg_lo:[0,1] neg_hi:[0,1]
v_pk_add_f32 v[70:71], v[70:71], v[24:25]
v_pk_add_f32 v[24:25], v[38:39], v[52:53] neg_lo:[0,1] neg_hi:[0,1]
v_pk_add_f32 v[38:39], v[38:39], v[52:53]
v_pk_add_f32 v[52:53], v[56:57], v[20:21] neg_lo:[0,1] neg_hi:[0,1]
v_pk_add_f32 v[56:57], v[56:57], v[20:21]
v_pk_add_f32 v[20:21], v[22:23], v[50:51] neg_lo:[0,1] neg_hi:[0,1]
v_pk_add_f32 v[22:23], v[22:23], v[50:51]
v_pk_add_f32 v[50:51], v[68:69], v[34:35] neg_lo:[0,1] neg_hi:[0,1]
v_pk_add_f32 v[68:69], v[68:69], v[34:35]
v_pk_add_f32 v[34:35], v[36:37], v[58:59] neg_lo:[0,1] neg_hi:[0,1]
v_pk_add_f32 v[36:37], v[36:37], v[58:59]
v_pk_add_f32 v[58:59], v[66:67], v[78:79] neg_lo:[0,1] neg_hi:[0,1]
v_pk_add_f32 v[66:67], v[66:67], v[78:79]
v_pk_mul_f32 v[78:79], v[16:17], v[144:145] op_sel:[0,0] op_sel_hi:[0,1] neg_lo:[0,0] neg_hi:[0,0]
v_pk_fma_f32 v[16:17], v[16:17], v[144:145], v[78:79] op_sel:[1,1,0] op_sel_hi:[1,0,1] neg_lo:[0,1,0] neg_hi:[0,0,0]
v_pk_mul_f32 v[78:79], v[48:49], v[146:147] op_sel:[0,0] op_sel_hi:[0,1] neg_lo:[0,0] neg_hi:[0,0]
v_pk_fma_f32 v[48:49], v[48:49], v[146:147], v[78:79] op_sel:[1,1,0] op_sel_hi:[1,0,1] neg_lo:[0,1,0] neg_hi:[0,0,0]
v_pk_mul_f32 v[78:79], v[18:19], v[148:149] op_sel:[0,0] op_sel_hi:[0,1] neg_lo:[0,0] neg_hi:[0,0]
v_pk_fma_f32 v[18:19], v[18:19], v[148:149], v[78:79] op_sel:[1,1,0] op_sel_hi:[1,0,1] neg_lo:[0,1,0] neg_hi:[0,0,0]
v_pk_mul_f32 v[78:79], v[22:23], v[150:151] op_sel:[0,0] op_sel_hi:[0,1] neg_lo:[0,0] neg_hi:[0,0]
v_pk_fma_f32 v[22:23], v[22:23], v[150:151], v[78:79] op_sel:[1,1,0] op_sel_hi:[1,0,1] neg_lo:[0,1,0] neg_hi:[0,0,0]
v_pk_mul_f32 v[78:79], v[26:27], v[152:153] op_sel:[0,0] op_sel_hi:[0,1] neg_lo:[0,0] neg_hi:[0,0]
v_pk_fma_f32 v[26:27], v[26:27], v[152:153], v[78:79] op_sel:[1,1,0] op_sel_hi:[1,0,1] neg_lo:[0,1,0] neg_hi:[0,0,0]
v_pk_mul_f32 v[78:79], v[38:39], v[154:155] op_sel:[0,0] op_sel_hi:[0,1] neg_lo:[0,0] neg_hi:[0,0]
v_pk_fma_f32 v[38:39], v[38:39], v[154:155], v[78:79] op_sel:[1,1,0] op_sel_hi:[1,0,1] neg_lo:[0,1,0] neg_hi:[0,0,0]
v_pk_mul_f32 v[78:79], v[28:29], v[156:157] op_sel:[0,0] op_sel_hi:[0,1] neg_lo:[0,0] neg_hi:[0,0]
v_pk_fma_f32 v[28:29], v[28:29], v[156:157], v[78:79] op_sel:[1,1,0] op_sel_hi:[1,0,1] neg_lo:[0,1,0] neg_hi:[0,0,0]
v_pk_mul_f32 v[78:79], v[36:37], v[158:159] op_sel:[0,0] op_sel_hi:[0,1] neg_lo:[0,0] neg_hi:[0,0]
v_pk_fma_f32 v[36:37], v[36:37], v[158:159], v[78:79] op_sel:[1,1,0] op_sel_hi:[1,0,1] neg_lo:[0,1,0] neg_hi:[0,0,0]
v_pk_mul_f32 v[78:79], v[42:43], v[160:161] op_sel:[0,0] op_sel_hi:[0,1] neg_lo:[0,0] neg_hi:[0,0]
v_pk_fma_f32 v[42:43], v[42:43], v[160:161], v[78:79] op_sel:[1,1,0] op_sel_hi:[1,0,1] neg_lo:[0,1,0] neg_hi:[0,0,0]
v_pk_mul_f32 v[78:79], v[70:71], v[162:163] op_sel:[0,0] op_sel_hi:[0,1] neg_lo:[0,0] neg_hi:[0,0]
v_pk_fma_f32 v[70:71], v[70:71], v[162:163], v[78:79] op_sel:[1,1,0] op_sel_hi:[1,0,1] neg_lo:[0,1,0] neg_hi:[0,0,0]
v_pk_mul_f32 v[78:79], v[60:61], v[164:165] op_sel:[0,0] op_sel_hi:[0,1] neg_lo:[0,0] neg_hi:[0,0]
v_pk_fma_f32 v[60:61], v[60:61], v[164:165], v[78:79] op_sel:[1,1,0] op_sel_hi:[1,0,1] neg_lo:[0,1,0] neg_hi:[0,0,0]
v_pk_mul_f32 v[78:79], v[68:69], v[166:167] op_sel:[0,0] op_sel_hi:[0,1] neg_lo:[0,0] neg_hi:[0,0]
v_pk_fma_f32 v[68:69], v[68:69], v[166:167], v[78:79] op_sel:[1,1,0] op_sel_hi:[1,0,1] neg_lo:[0,1,0] neg_hi:[0,0,0]
v_pk_mul_f32 v[78:79], v[40:41], v[168:169] op_sel:[0,0] op_sel_hi:[0,1] neg_lo:[0,0] neg_hi:[0,0]
v_pk_fma_f32 v[40:41], v[40:41], v[168:169], v[78:79] op_sel:[1,1,0] op_sel_hi:[1,0,1] neg_lo:[0,1,0] neg_hi:[0,0,0]
v_pk_mul_f32 v[78:79], v[56:57], v[170:171] op_sel:[0,0] op_sel_hi:[0,1] neg_lo:[0,0] neg_hi:[0,0]
v_pk_fma_f32 v[56:57], v[56:57], v[170:171], v[78:79] op_sel:[1,1,0] op_sel_hi:[1,0,1] neg_lo:[0,1,0] neg_hi:[0,0,0]
v_pk_mul_f32 v[78:79], v[62:63], v[172:173] op_sel:[0,0] op_sel_hi:[0,1] neg_lo:[0,0] neg_hi:[0,0]
v_pk_fma_f32 v[62:63], v[62:63], v[172:173], v[78:79] op_sel:[1,1,0] op_sel_hi:[1,0,1] neg_lo:[0,1,0] neg_hi:[0,0,0]
v_pk_mul_f32 v[78:79], v[66:67], v[174:175] op_sel:[0,0] op_sel_hi:[0,1] neg_lo:[0,0] neg_hi:[0,0]
v_pk_fma_f32 v[66:67], v[66:67], v[174:175], v[78:79] op_sel:[1,1,0] op_sel_hi:[1,0,1] neg_lo:[0,1,0] neg_hi:[0,0,0]
v_pk_mul_f32 v[78:79], v[74:75], v[176:177] op_sel:[0,0] op_sel_hi:[0,1] neg_lo:[0,0] neg_hi:[0,0]
v_pk_fma_f32 v[74:75], v[74:75], v[176:177], v[78:79] op_sel:[1,1,0] op_sel_hi:[1,0,1] neg_lo:[0,1,0] neg_hi:[0,0,0]
v_pk_mul_f32 v[78:79], v[76:77], v[178:179] op_sel:[0,0] op_sel_hi:[0,1] neg_lo:[0,0] neg_hi:[0,0]
v_pk_fma_f32 v[76:77], v[76:77], v[178:179], v[78:79] op_sel:[1,1,0] op_sel_hi:[1,0,1] neg_lo:[0,1,0] neg_hi:[0,0,0]
v_pk_mul_f32 v[78:79], v[72:73], v[180:181] op_sel:[0,0] op_sel_hi:[0,1] neg_lo:[0,0] neg_hi:[0,0]
v_pk_fma_f32 v[72:73], v[72:73], v[180:181], v[78:79] op_sel:[1,1,0] op_sel_hi:[1,0,1] neg_lo:[0,1,0] neg_hi:[0,0,0]
v_pk_mul_f32 v[78:79], v[20:21], v[182:183] op_sel:[0,0] op_sel_hi:[0,1] neg_lo:[0,0] neg_hi:[0,0]
v_pk_fma_f32 v[20:21], v[20:21], v[182:183], v[78:79] op_sel:[1,1,0] op_sel_hi:[1,0,1] neg_lo:[0,1,0] neg_hi:[0,0,0]
v_pk_mul_f32 v[78:79], v[64:65], v[184:185] op_sel:[0,0] op_sel_hi:[0,1] neg_lo:[0,0] neg_hi:[0,0]
v_pk_fma_f32 v[64:65], v[64:65], v[184:185], v[78:79] op_sel:[1,1,0] op_sel_hi:[1,0,1] neg_lo:[0,1,0] neg_hi:[0,0,0]
v_pk_mul_f32 v[78:79], v[24:25], v[186:187] op_sel:[0,0] op_sel_hi:[0,1] neg_lo:[0,0] neg_hi:[0,0]
v_pk_fma_f32 v[24:25], v[24:25], v[186:187], v[78:79] op_sel:[1,1,0] op_sel_hi:[1,0,1] neg_lo:[0,1,0] neg_hi:[0,0,0]
v_pk_mul_f32 v[78:79], v[30:31], v[188:189] op_sel:[0,0] op_sel_hi:[0,1] neg_lo:[0,0] neg_hi:[0,0]
v_pk_fma_f32 v[30:31], v[30:31], v[188:189], v[78:79] op_sel:[1,1,0] op_sel_hi:[1,0,1] neg_lo:[0,1,0] neg_hi:[0,0,0]
v_pk_mul_f32 v[78:79], v[34:35], v[190:191] op_sel:[0,0] op_sel_hi:[0,1] neg_lo:[0,0] neg_hi:[0,0]
v_pk_fma_f32 v[34:35], v[34:35], v[190:191], v[78:79] op_sel:[1,1,0] op_sel_hi:[1,0,1] neg_lo:[0,1,0] neg_hi:[0,0,0]
v_pk_mul_f32 v[78:79], v[14:15], v[192:193] op_sel:[0,0] op_sel_hi:[0,1] neg_lo:[0,0] neg_hi:[0,0]
v_pk_fma_f32 v[14:15], v[14:15], v[192:193], v[78:79] op_sel:[1,1,0] op_sel_hi:[1,0,1] neg_lo:[0,1,0] neg_hi:[0,0,0]
v_pk_mul_f32 v[78:79], v[32:33], v[194:195] op_sel:[0,0] op_sel_hi:[0,1] neg_lo:[0,0] neg_hi:[0,0]
v_pk_fma_f32 v[32:33], v[32:33], v[194:195], v[78:79] op_sel:[1,1,0] op_sel_hi:[1,0,1] neg_lo:[0,1,0] neg_hi:[0,0,0]
v_pk_mul_f32 v[78:79], v[46:47], v[196:197] op_sel:[0,0] op_sel_hi:[0,1] neg_lo:[0,0] neg_hi:[0,0]
v_pk_fma_f32 v[46:47], v[46:47], v[196:197], v[78:79] op_sel:[1,1,0] op_sel_hi:[1,0,1] neg_lo:[0,1,0] neg_hi:[0,0,0]
v_pk_mul_f32 v[78:79], v[50:51], v[198:199] op_sel:[0,0] op_sel_hi:[0,1] neg_lo:[0,0] neg_hi:[0,0]
v_pk_fma_f32 v[50:51], v[50:51], v[198:199], v[78:79] op_sel:[1,1,0] op_sel_hi:[1,0,1] neg_lo:[0,1,0] neg_hi:[0,0,0]
v_pk_mul_f32 v[78:79], v[44:45], v[200:201] op_sel:[0,0] op_sel_hi:[0,1] neg_lo:[0,0] neg_hi:[0,0]
v_pk_fma_f32 v[44:45], v[44:45], v[200:201], v[78:79] op_sel:[1,1,0] op_sel_hi:[1,0,1] neg_lo:[0,1,0] neg_hi:[0,0,0]
v_pk_mul_f32 v[78:79], v[52:53], v[202:203] op_sel:[0,0] op_sel_hi:[0,1] neg_lo:[0,0] neg_hi:[0,0]
v_pk_fma_f32 v[52:53], v[52:53], v[202:203], v[78:79] op_sel:[1,1,0] op_sel_hi:[1,0,1] neg_lo:[0,1,0] neg_hi:[0,0,0]
v_pk_mul_f32 v[78:79], v[54:55], v[204:205] op_sel:[0,0] op_sel_hi:[0,1] neg_lo:[0,0] neg_hi:[0,0]
v_pk_fma_f32 v[54:55], v[54:55], v[204:205], v[78:79] op_sel:[1,1,0] op_sel_hi:[1,0,1] neg_lo:[0,1,0] neg_hi:[0,0,0]
v_pk_mul_f32 v[78:79], v[58:59], v[206:207] op_sel:[0,0] op_sel_hi:[0,1] neg_lo:[0,0] neg_hi:[0,0]
v_pk_fma_f32 v[58:59], v[58:59], v[206:207], v[78:79] op_sel:[1,1,0] op_sel_hi:[1,0,1] neg_lo:[0,1,0] neg_hi:[0,0,0]
ds_write_b64 v4, v[16:17] offset:0
ds_write_b64 v4, v[48:49] offset:16
ds_write_b64 v4, v[18:19] offset:32
ds_write_b64 v4, v[22:23] offset:48
ds_write_b64 v4, v[26:27] offset:64
ds_write_b64 v4, v[38:39] offset:80
ds_write_b64 v4, v[28:29] offset:96
ds_write_b64 v4, v[36:37] offset:112
ds_write_b64 v4, v[42:43] offset:128
ds_write_b64 v4, v[70:71] offset:144
ds_write_b64 v4, v[60:61] offset:160
ds_write_b64 v4, v[68:69] offset:176
ds_write_b64 v4, v[40:41] offset:192
ds_write_b64 v4, v[56:57] offset:208
ds_write_b64 v4, v[62:63] offset:224
ds_write_b64 v4, v[66:67] offset:240
ds_write_b64 v4, v[74:75] offset:256
ds_write_b64 v4, v[76:77] offset:272
ds_write_b64 v4, v[72:73] offset:288
ds_write_b64 v4, v[20:21] offset:304
ds_write_b64 v4, v[64:65] offset:320
ds_write_b64 v4, v[24:25] offset:336
ds_write_b64 v4, v[30:31] offset:352
ds_write_b64 v4, v[34:35] offset:368
ds_write_b64 v4, v[14:15] offset:384
ds_write_b64 v4, v[32:33] offset:400
ds_write_b64 v4, v[46:47] offset:416
ds_write_b64 v4, v[50:51] offset:432
ds_write_b64 v4, v[44:45] offset:448
ds_write_b64 v4, v[52:53] offset:464
ds_write_b64 v4, v[54:55] offset:480
ds_write_b64 v4, v[58:59] offset:496
s_waitcnt lgkmcnt(0)
ds_read_b64 v[16:17], v3 offset:0
ds_read_b64 v[48:49], v3 offset:8448
ds_read_b64 v[18:19], v3 offset:528
ds_read_b64 v[50:51], v3 offset:8976
ds_read_b64 v[20:21], v3 offset:1056
ds_read_b64 v[52:53], v3 offset:9504
ds_read_b64 v[22:23], v3 offset:1584
ds_read_b64 v[54:55], v3 offset:10032
ds_read_b64 v[24:25], v3 offset:2112
ds_read_b64 v[56:57], v3 offset:10560
ds_read_b64 v[26:27], v3 offset:2640
ds_read_b64 v[58:59], v3 offset:11088
ds_read_b64 v[28:29], v3 offset:3168
ds_read_b64 v[60:61], v3 offset:11616
ds_read_b64 v[30:31], v3 offset:3696
ds_read_b64 v[62:63], v3 offset:12144
ds_read_b64 v[32:33], v3 offset:4224
ds_read_b64 v[64:65], v3 offset:12672
ds_read_b64 v[34:35], v3 offset:4752
ds_read_b64 v[66:67], v3 offset:13200
ds_read_b64 v[36:37], v3 offset:5280
ds_read_b64 v[68:69], v3 offset:13728
ds_read_b64 v[38:39], v3 offset:5808
ds_read_b64 v[70:71], v3 offset:14256
ds_read_b64 v[40:41], v3 offset:6336
ds_read_b64 v[72:73], v3 offset:14784
ds_read_b64 v[42:43], v3 offset:6864
ds_read_b64 v[74:75], v3 offset:15312
ds_read_b64 v[44:45], v3 offset:7392
ds_read_b64 v[76:77], v3 offset:15840
ds_read_b64 v[46:47], v3 offset:7920
ds_read_b64 v[78:79], v3 offset:16368
s_waitcnt lgkmcnt(0)
v_pk_add_f32 v[14:15], v[16:17], v[48:49] neg_lo:[0,1] neg_hi:[0,1]
v_pk_add_f32 v[16:17], v[16:17], v[48:49]
v_pk_add_f32 v[48:49], v[18:19], v[50:51] neg_lo:[0,1] neg_hi:[0,1]
v_pk_add_f32 v[18:19], v[18:19], v[50:51]
v_pk_mul_f32 v[50:51], v[48:49], s[50:51] op_sel:[0,0] op_sel_hi:[0,1] neg_lo:[0,0] neg_hi:[0,0]
v_pk_fma_f32 v[50:51], v[48:49], s[50:51], v[50:51] op_sel:[1,1,0] op_sel_hi:[1,0,1] neg_lo:[0,1,0] neg_hi:[0,0,0]
v_pk_add_f32 v[48:49], v[20:21], v[52:53] neg_lo:[0,1] neg_hi:[0,1]
v_pk_add_f32 v[20:21], v[20:21], v[52:53]
v_pk_mul_f32 v[52:53], v[48:49], s[54:55] op_sel:[0,0] op_sel_hi:[0,1] neg_lo:[0,0] neg_hi:[0,0]
v_pk_fma_f32 v[52:53], v[48:49], s[54:55], v[52:53] op_sel:[1,1,0] op_sel_hi:[1,0,1] neg_lo:[0,1,0] neg_hi:[0,0,0]
v_pk_add_f32 v[48:49], v[22:23], v[54:55] neg_lo:[0,1] neg_hi:[0,1]
v_pk_add_f32 v[22:23], v[22:23], v[54:55]
v_pk_mul_f32 v[54:55], v[48:49], s[58:59] op_sel:[0,0] op_sel_hi:[0,1] neg_lo:[0,0] neg_hi:[0,0]
v_pk_fma_f32 v[54:55], v[48:49], s[58:59], v[54:55] op_sel:[1,1,0] op_sel_hi:[1,0,1] neg_lo:[0,1,0] neg_hi:[0,0,0]
v_pk_add_f32 v[48:49], v[24:25], v[56:57] neg_lo:[0,1] neg_hi:[0,1]
v_pk_add_f32 v[24:25], v[24:25], v[56:57]
v_pk_mul_f32 v[56:57], v[48:49], s[62:63] op_sel:[0,0] op_sel_hi:[0,1] neg_lo:[0,0] neg_hi:[0,0]
v_pk_fma_f32 v[56:57], v[48:49], s[62:63], v[56:57] op_sel:[1,1,0] op_sel_hi:[1,0,1] neg_lo:[0,1,0] neg_hi:[0,0,0]
v_pk_add_f32 v[48:49], v[26:27], v[58:59] neg_lo:[0,1] neg_hi:[0,1]
v_pk_add_f32 v[26:27], v[26:27], v[58:59]
v_pk_mul_f32 v[58:59], v[48:49], s[58:59] op_sel:[0,1] op_sel_hi:[0,0] neg_lo:[0,0] neg_hi:[0,0]
v_pk_fma_f32 v[58:59], v[48:49], s[58:59], v[58:59] op_sel:[1,0,0] op_sel_hi:[1,1,1] neg_lo:[0,1,0] neg_hi:[0,0,0]
v_pk_add_f32 v[48:49], v[28:29], v[60:61] neg_lo:[0,1] neg_hi:[0,1]
v_pk_add_f32 v[28:29], v[28:29], v[60:61]
v_pk_mul_f32 v[60:61], v[48:49], s[54:55] op_sel:[0,1] op_sel_hi:[0,0] neg_lo:[0,0] neg_hi:[0,0]
v_pk_fma_f32 v[60:61], v[48:49], s[54:55], v[60:61] op_sel:[1,0,0] op_sel_hi:[1,1,1] neg_lo:[0,1,0] neg_hi:[0,0,0]
v_pk_add_f32 v[48:49], v[30:31], v[62:63] neg_lo:[0,1] neg_hi:[0,1]
v_pk_add_f32 v[30:31], v[30:31], v[62:63]
v_pk_mul_f32 v[62:63], v[48:49], s[50:51] op_sel:[0,1] op_sel_hi:[0,0] neg_lo:[0,0] neg_hi:[0,0]
v_pk_fma_f32 v[62:63], v[48:49], s[50:51], v[62:63] op_sel:[1,0,0] op_sel_hi:[1,1,1] neg_lo:[0,1,0] neg_hi:[0,0,0]
v_pk_add_f32 v[48:49], v[32:33], v[64:65] op_sel:[1,1] op_sel_hi:[0,0] neg_lo:[1,0] neg_hi:[0,1]
v_pk_add_f32 v[32:33], v[32:33], v[64:65]
v_pk_add_f32 v[64:65], v[34:35], v[66:67] neg_lo:[0,1] neg_hi:[0,1]
v_pk_add_f32 v[34:35], v[34:35], v[66:67]
v_pk_mul_f32 v[66:67], v[64:65], s[50:51] op_sel:[0,1] op_sel_hi:[0,0] neg_lo:[0,1] neg_hi:[0,0]
v_pk_fma_f32 v[66:67], v[64:65], s[50:51], v[66:67] op_sel:[1,0,0] op_sel_hi:[1,1,1] neg_lo:[0,1,0] neg_hi:[0,1,0]
v_pk_add_f32 v[64:65], v[36:37], v[68:69] neg_lo:[0,1] neg_hi:[0,1]
v_pk_add_f32 v[36:37], v[36:37], v[68:69]
v_pk_mul_f32 v[68:69], v[64:65], s[54:55] op_sel:[0,1] op_sel_hi:[0,0] neg_lo:[0,1] neg_hi:[0,0]
v_pk_fma_f32 v[68:69], v[64:65], s[54:55], v[68:69] op_sel:[1,0,0] op_sel_hi:[1,1,1] neg_lo:[0,1,0] neg_hi:[0,1,0]
v_pk_add_f32 v[64:65], v[38:39], v[70:71] neg_lo:[0,1] neg_hi:[0,1]
v_pk_add_f32 v[38:39], v[38:39], v[70:71]
v_pk_mul_f32 v[70:71], v[64:65], s[58:59] op_sel:[0,1] op_sel_hi:[0,0] neg_lo:[0,1] neg_hi:[0,0]
v_pk_fma_f32 v[70:71], v[64:65], s[58:59], v[70:71] op_sel:[1,0,0] op_sel_hi:[1,1,1] neg_lo:[0,1,0] neg_hi:[0,1,0]
v_pk_add_f32 v[64:65], v[40:41], v[72:73] neg_lo:[0,1] neg_hi:[0,1]
v_pk_add_f32 v[40:41], v[40:41], v[72:73]
v_pk_mul_f32 v[72:73], v[64:65], s[62:63] op_sel:[0,0] op_sel_hi:[0,1] neg_lo:[0,1] neg_hi:[0,0]
v_pk_fma_f32 v[72:73], v[64:65], s[62:63], v[72:73] op_sel:[1,1,0] op_sel_hi:[1,0,1] neg_lo:[0,1,0] neg_hi:[0,1,0]
v_pk_add_f32 v[64:65], v[42:43], v[74:75] neg_lo:[0,1] neg_hi:[0,1]
v_pk_add_f32 v[42:43], v[42:43], v[74:75]
v_pk_mul_f32 v[74:75], v[64:65], s[58:59] op_sel:[0,0] op_sel_hi:[0,1] neg_lo:[0,1] neg_hi:[0,0]
v_pk_fma_f32 v[74:75], v[64:65], s[58:59], v[74:75] op_sel:[1,1,0] op_sel_hi:[1,0,1] neg_lo:[0,1,0] neg_hi:[0,1,0]
v_pk_add_f32 v[64:65], v[44:45], v[76:77] neg_lo:[0,1] neg_hi:[0,1]
v_pk_add_f32 v[44:45], v[44:45], v[76:77]
v_pk_mul_f32 v[76:77], v[64:65], s[54:55] op_sel:[0,0] op_sel_hi:[0,1] neg_lo:[0,1] neg_hi:[0,0]
v_pk_fma_f32 v[76:77], v[64:65], s[54:55], v[76:77] op_sel:[1,1,0] op_sel_hi:[1,0,1] neg_lo:[0,1,0] neg_hi:[0,1,0]
v_pk_add_f32 v[64:65], v[46:47], v[78:79] neg_lo:[0,1] neg_hi:[0,1]
v_pk_add_f32 v[46:47], v[46:47], v[78:79]
v_pk_mul_f32 v[78:79], v[64:65], s[50:51] op_sel:[0,0] op_sel_hi:[0,1] neg_lo:[0,1] neg_hi:[0,0]
v_pk_fma_f32 v[78:79], v[64:65], s[50:51], v[78:79] op_sel:[1,1,0] op_sel_hi:[1,0,1] neg_lo:[0,1,0] neg_hi:[0,1,0]
v_pk_add_f32 v[64:65], v[16:17], v[32:33] neg_lo:[0,1] neg_hi:[0,1]
v_pk_add_f32 v[16:17], v[16:17], v[32:33]
v_pk_add_f32 v[32:33], v[18:19], v[34:35] neg_lo:[0,1] neg_hi:[0,1]
v_pk_add_f32 v[18:19], v[18:19], v[34:35]
v_pk_mul_f32 v[34:35], v[32:33], s[54:55] op_sel:[0,0] op_sel_hi:[0,1] neg_lo:[0,0] neg_hi:[0,0]
v_pk_fma_f32 v[34:35], v[32:33], s[54:55], v[34:35] op_sel:[1,1,0] op_sel_hi:[1,0,1] neg_lo:[0,1,0] neg_hi:[0,0,0]
v_pk_add_f32 v[32:33], v[20:21], v[36:37] neg_lo:[0,1] neg_hi:[0,1]
v_pk_add_f32 v[20:21], v[20:21], v[36:37]
v_pk_mul_f32 v[36:37], v[32:33], s[62:63] op_sel:[0,0] op_sel_hi:[0,1] neg_lo:[0,0] neg_hi:[0,0]
v_pk_fma_f32 v[36:37], v[32:33], s[62:63], v[36:37] op_sel:[1,1,0] op_sel_hi:[1,0,1] neg_lo:[0,1,0] neg_hi:[0,0,0]
v_pk_add_f32 v[32:33], v[22:23], v[38:39] neg_lo:[0,1] neg_hi:[0,1]
v_pk_add_f32 v[22:23], v[22:23], v[38:39]
v_pk_mul_f32 v[38:39], v[32:33], s[54:55] op_sel:[0,1] op_sel_hi:[0,0] neg_lo:[0,0] neg_hi:[0,0]
v_pk_fma_f32 v[38:39], v[32:33], s[54:55], v[38:39] op_sel:[1,0,0] op_sel_hi:[1,1,1] neg_lo:[0,1,0] neg_hi:[0,0,0]
v_pk_add_f32 v[32:33], v[24:25], v[40:41] op_sel:[1,1] op_sel_hi:[0,0] neg_lo:[1,0] neg_hi:[0,1]
v_pk_add_f32 v[24:25], v[24:25], v[40:41]
v_pk_add_f32 v[40:41], v[26:27], v[42:43] neg_lo:[0,1] neg_hi:[0,1]
v_pk_add_f32 v[26:27], v[26:27], v[42:43]
v_pk_mul_f32 v[42:43], v[40:41], s[54:55] op_sel:[0,1] op_sel_hi:[0,0] neg_lo:[0,1] neg_hi:[0,0]
v_pk_fma_f32 v[42:43], v[40:41], s[54:55], v[42:43] op_sel:[1,0,0] op_sel_hi:[1,1,1] neg_lo:[0,1,0] neg_hi:[0,1,0]
v_pk_add_f32 v[40:41], v[28:29], v[44:45] neg_lo:[0,1] neg_hi:[0,1]
v_pk_add_f32 v[28:29], v[28:29], v[44:45]
v_pk_mul_f32 v[44:45], v[40:41], s[62:63] op_sel:[0,0] op_sel_hi:[0,1] neg_lo:[0,1] neg_hi:[0,0]
v_pk_fma_f32 v[44:45], v[40:41], s[62:63], v[44:45] op_sel:[1,1,0] op_sel_hi:[1,0,1] neg_lo:[0,1,0] neg_hi:[0,1,0]
v_pk_add_f32 v[40:41], v[30:31], v[46:47] neg_lo:[0,1] neg_hi:[0,1]
v_pk_add_f32 v[30:31], v[30:31], v[46:47]
v_pk_mul_f32 v[46:47], v[40:41], s[54:55] op_sel:[0,0] op_sel_hi:[0,1] neg_lo:[0,1] neg_hi:[0,0]
v_pk_fma_f32 v[46:47], v[40:41], s[54:55], v[46:47] op_sel:[1,1,0] op_sel_hi:[1,0,1] neg_lo:[0,1,0] neg_hi:[0,1,0]
v_pk_add_f32 v[40:41], v[14:15], v[48:49] neg_lo:[0,1] neg_hi:[0,1]
v_pk_add_f32 v[14:15], v[14:15], v[48:49]
v_pk_add_f32 v[48:49], v[50:51], v[66:67] neg_lo:[0,1] neg_hi:[0,1]
v_pk_add_f32 v[50:51], v[50:51], v[66:67]
v_pk_mul_f32 v[66:67], v[48:49], s[54:55] op_sel:[0,0] op_sel_hi:[0,1] neg_lo:[0,0] neg_hi:[0,0]
v_pk_fma_f32 v[66:67], v[48:49], s[54:55], v[66:67] op_sel:[1,1,0] op_sel_hi:[1,0,1] neg_lo:[0,1,0] neg_hi:[0,0,0]
v_pk_add_f32 v[48:49], v[52:53], v[68:69] neg_lo:[0,1] neg_hi:[0,1]
v_pk_add_f32 v[52:53], v[52:53], v[68:69]
v_pk_mul_f32 v[68:69], v[48:49], s[62:63] op_sel:[0,0] op_sel_hi:[0,1] neg_lo:[0,0] neg_hi:[0,0]
v_pk_fma_f32 v[68:69], v[48:49], s[62:63], v[68:69] op_sel:[1,1,0] op_sel_hi:[1,0,1] neg_lo:[0,1,0] neg_hi:[0,0,0]
v_pk_add_f32 v[48:49], v[54:55], v[70:71] neg_lo:[0,1] neg_hi:[0,1]
v_pk_add_f32 v[54:55], v[54:55], v[70:71]
v_pk_mul_f32 v[70:71], v[48:49], s[54:55] op_sel:[0,1] op_sel_hi:[0,0] neg_lo:[0,0] neg_hi:[0,0]
v_pk_fma_f32 v[70:71], v[48:49], s[54:55], v[70:71] op_sel:[1,0,0] op_sel_hi:[1,1,1] neg_lo:[0,1,0] neg_hi:[0,0,0]
v_pk_add_f32 v[48:49], v[56:57], v[72:73] op_sel:[1,1] op_sel_hi:[0,0] neg_lo:[1,0] neg_hi:[0,1]
v_pk_add_f32 v[56:57], v[56:57], v[72:73]
v_pk_add_f32 v[72:73], v[58:59], v[74:75] neg_lo:[0,1] neg_hi:[0,1]
v_pk_add_f32 v[58:59], v[58:59], v[74:75]
v_pk_mul_f32 v[74:75], v[72:73], s[54:55] op_sel:[0,1] op_sel_hi:[0,0] neg_lo:[0,1] neg_hi:[0,0]
v_pk_fma_f32 v[74:75], v[72:73], s[54:55], v[74:75] op_sel:[1,0,0] op_sel_hi:[1,1,1] neg_lo:[0,1,0] neg_hi:[0,1,0]
v_pk_add_f32 v[72:73], v[60:61], v[76:77] neg_lo:[0,1] neg_hi:[0,1]
v_pk_add_f32 v[60:61], v[60:61], v[76:77]
v_pk_mul_f32 v[76:77], v[72:73], s[62:63] op_sel:[0,0] op_sel_hi:[0,1] neg_lo:[0,1] neg_hi:[0,0]
v_pk_fma_f32 v[76:77], v[72:73], s[62:63], v[76:77] op_sel:[1,1,0] op_sel_hi:[1,0,1] neg_lo:[0,1,0] neg_hi:[0,1,0]
v_pk_add_f32 v[72:73], v[62:63], v[78:79] neg_lo:[0,1] neg_hi:[0,1]
v_pk_add_f32 v[62:63], v[62:63], v[78:79]
v_pk_mul_f32 v[78:79], v[72:73], s[54:55] op_sel:[0,0] op_sel_hi:[0,1] neg_lo:[0,1] neg_hi:[0,0]
v_pk_fma_f32 v[78:79], v[72:73], s[54:55], v[78:79] op_sel:[1,1,0] op_sel_hi:[1,0,1] neg_lo:[0,1,0] neg_hi:[0,1,0]
v_pk_add_f32 v[72:73], v[16:17], v[24:25] neg_lo:[0,1] neg_hi:[0,1]
v_pk_add_f32 v[16:17], v[16:17], v[24:25]
v_pk_add_f32 v[24:25], v[18:19], v[26:27] neg_lo:[0,1] neg_hi:[0,1]
v_pk_add_f32 v[18:19], v[18:19], v[26:27]
v_pk_mul_f32 v[26:27], v[24:25], s[62:63] op_sel:[0,0] op_sel_hi:[0,1] neg_lo:[0,0] neg_hi:[0,0]
v_pk_fma_f32 v[26:27], v[24:25], s[62:63], v[26:27] op_sel:[1,1,0] op_sel_hi:[1,0,1] neg_lo:[0,1,0] neg_hi:[0,0,0]
v_pk_add_f32 v[24:25], v[20:21], v[28:29] op_sel:[1,1] op_sel_hi:[0,0] neg_lo:[1,0] neg_hi:[0,1]
v_pk_add_f32 v[20:21], v[20:21], v[28:29]
v_pk_add_f32 v[28:29], v[22:23], v[30:31] neg_lo:[0,1] neg_hi:[0,1]
v_pk_add_f32 v[22:23], v[22:23], v[30:31]
v_pk_mul_f32 v[30:31], v[28:29], s[62:63] op_sel:[0,0] op_sel_hi:[0,1] neg_lo:[0,1] neg_hi:[0,0]
v_pk_fma_f32 v[30:31], v[28:29], s[62:63], v[30:31] op_sel:[1,1,0] op_sel_hi:[1,0,1] neg_lo:[0,1,0] neg_hi:[0,1,0]
v_pk_add_f32 v[28:29], v[64:65], v[32:33] neg_lo:[0,1] neg_hi:[0,1]
v_pk_add_f32 v[64:65], v[64:65], v[32:33]
v_pk_add_f32 v[32:33], v[34:35], v[42:43] neg_lo:[0,1] neg_hi:[0,1]
v_pk_add_f32 v[34:35], v[34:35], v[42:43]
v_pk_mul_f32 v[42:43], v[32:33], s[62:63] op_sel:[0,0] op_sel_hi:[0,1] neg_lo:[0,0] neg_hi:[0,0]
v_pk_fma_f32 v[42:43], v[32:33], s[62:63], v[42:43] op_sel:[1,1,0] op_sel_hi:[1,0,1] neg_lo:[0,1,0] neg_hi:[0,0,0]
v_pk_add_f32 v[32:33], v[36:37], v[44:45] op_sel:[1,1] op_sel_hi:[0,0] neg_lo:[1,0] neg_hi:[0,1]
v_pk_add_f32 v[36:37], v[36:37], v[44:45]
v_pk_add_f32 v[44:45], v[38:39], v[46:47] neg_lo:[0,1] neg_hi:[0,1]
v_pk_add_f32 v[38:39], v[38:39], v[46:47]
v_pk_mul_f32 v[46:47], v[44:45], s[62:63] op_sel:[0,0] op_sel_hi:[0,1] neg_lo:[0,1] neg_hi:[0,0]
v_pk_fma_f32 v[46:47], v[44:45], s[62:63], v[46:47] op_sel:[1,1,0] op_sel_hi:[1,0,1] neg_lo:[0,1,0] neg_hi:[0,1,0]
v_pk_add_f32 v[44:45], v[14:15], v[56:57] neg_lo:[0,1] neg_hi:[0,1]
v_pk_add_f32 v[14:15], v[14:15], v[56:57]
v_pk_add_f32 v[56:57], v[50:51], v[58:59] neg_lo:[0,1] neg_hi:[0,1]
v_pk_add_f32 v[50:51], v[50:51], v[58:59]
v_pk_mul_f32 v[58:59], v[56:57], s[62:63] op_sel:[0,0] op_sel_hi:[0,1] neg_lo:[0,0] neg_hi:[0,0]
v_pk_fma_f32 v[58:59], v[56:57], s[62:63], v[58:59] op_sel:[1,1,0] op_sel_hi:[1,0,1] neg_lo:[0,1,0] neg_hi:[0,0,0]
v_pk_add_f32 v[56:57], v[52:53], v[60:61] op_sel:[1,1] op_sel_hi:[0,0] neg_lo:[1,0] neg_hi:[0,1]
v_pk_add_f32 v[52:53], v[52:53], v[60:61]
v_pk_add_f32 v[60:61], v[54:55], v[62:63] neg_lo:[0,1] neg_hi:[0,1]
v_pk_add_f32 v[54:55], v[54:55], v[62:63]
v_pk_mul_f32 v[62:63], v[60:61], s[62:63] op_sel:[0,0] op_sel_hi:[0,1] neg_lo:[0,1] neg_hi:[0,0]
v_pk_fma_f32 v[62:63], v[60:61], s[62:63], v[62:63] op_sel:[1,1,0] op_sel_hi:[1,0,1] neg_lo:[0,1,0] neg_hi:[0,1,0]
v_pk_add_f32 v[60:61], v[40:41], v[48:49] neg_lo:[0,1] neg_hi:[0,1]
v_pk_add_f32 v[40:41], v[40:41], v[48:49]
v_pk_add_f32 v[48:49], v[66:67], v[74:75] neg_lo:[0,1] neg_hi:[0,1]
v_pk_add_f32 v[66:67], v[66:67], v[74:75]
v_pk_mul_f32 v[74:75], v[48:49], s[62:63] op_sel:[0,0] op_sel_hi:[0,1] neg_lo:[0,0] neg_hi:[0,0]
v_pk_fma_f32 v[74:75], v[48:49], s[62:63], v[74:75] op_sel:[1,1,0] op_sel_hi:[1,0,1] neg_lo:[0,1,0] neg_hi:[0,0,0]
v_pk_add_f32 v[48:49], v[68:69], v[76:77] op_sel:[1,1] op_sel_hi:[0,0] neg_lo:[1,0] neg_hi:[0,1]
v_pk_add_f32 v[68:69], v[68:69], v[76:77]
v_pk_add_f32 v[76:77], v[70:71], v[78:79] neg_lo:[0,1] neg_hi:[0,1]
v_pk_add_f32 v[70:71], v[70:71], v[78:79]
v_pk_mul_f32 v[78:79], v[76:77], s[62:63] op_sel:[0,0] op_sel_hi:[0,1] neg_lo:[0,1] neg_hi:[0,0]
v_pk_fma_f32 v[78:79], v[76:77], s[62:63], v[78:79] op_sel:[1,1,0] op_sel_hi:[1,0,1] neg_lo:[0,1,0] neg_hi:[0,1,0]
v_pk_add_f32 v[76:77], v[16:17], v[20:21] neg_lo:[0,1] neg_hi:[0,1]
v_pk_add_f32 v[16:17], v[16:17], v[20:21]
v_pk_add_f32 v[20:21], v[18:19], v[22:23] op_sel:[1,1] op_sel_hi:[0,0] neg_lo:[1,0] neg_hi:[0,1]
v_pk_add_f32 v[18:19], v[18:19], v[22:23]
v_pk_add_f32 v[22:23], v[72:73], v[24:25] neg_lo:[0,1] neg_hi:[0,1]
v_pk_add_f32 v[72:73], v[72:73], v[24:25]
v_pk_add_f32 v[24:25], v[26:27], v[30:31] op_sel:[1,1] op_sel_hi:[0,0] neg_lo:[1,0] neg_hi:[0,1]
v_pk_add_f32 v[26:27], v[26:27], v[30:31]
v_pk_add_f32 v[30:31], v[64:65], v[36:37] neg_lo:[0,1] neg_hi:[0,1]
v_pk_add_f32 v[64:65], v[64:65], v[36:37]
v_pk_add_f32 v[36:37], v[34:35], v[38:39] op_sel:[1,1] op_sel_hi:[0,0] neg_lo:[1,0] neg_hi:[0,1]
v_pk_add_f32 v[34:35], v[34:35], v[38:39]
v_pk_add_f32 v[38:39], v[28:29], v[32:33] neg_lo:[0,1] neg_hi:[0,1]
v_pk_add_f32 v[28:29], v[28:29], v[32:33]
v_pk_add_f32 v[32:33], v[42:43], v[46:47] op_sel:[1,1] op_sel_hi:[0,0] neg_lo:[1,0] neg_hi:[0,1]
v_pk_add_f32 v[42:43], v[42:43], v[46:47]
v_pk_add_f32 v[46:47], v[14:15], v[52:53] neg_lo:[0,1] neg_hi:[0,1]
v_pk_add_f32 v[14:15], v[14:15], v[52:53]
v_pk_add_f32 v[52:53], v[50:51], v[54:55] op_sel:[1,1] op_sel_hi:[0,0] neg_lo:[1,0] neg_hi:[0,1]
v_pk_add_f32 v[50:51], v[50:51], v[54:55]
v_pk_add_f32 v[54:55], v[44:45], v[56:57] neg_lo:[0,1] neg_hi:[0,1]
v_pk_add_f32 v[44:45], v[44:45], v[56:57]
v_pk_add_f32 v[56:57], v[58:59], v[62:63] op_sel:[1,1] op_sel_hi:[0,0] neg_lo:[1,0] neg_hi:[0,1]
v_pk_add_f32 v[58:59], v[58:59], v[62:63]
v_pk_add_f32 v[62:63], v[40:41], v[68:69] neg_lo:[0,1] neg_hi:[0,1]
v_pk_add_f32 v[40:41], v[40:41], v[68:69]
v_pk_add_f32 v[68:69], v[66:67], v[70:71] op_sel:[1,1] op_sel_hi:[0,0] neg_lo:[1,0] neg_hi:[0,1]
v_pk_add_f32 v[66:67], v[66:67], v[70:71]
v_pk_add_f32 v[70:71], v[60:61], v[48:49] neg_lo:[0,1] neg_hi:[0,1]
v_pk_add_f32 v[60:61], v[60:61], v[48:49]
v_pk_add_f32 v[48:49], v[74:75], v[78:79] op_sel:[1,1] op_sel_hi:[0,0] neg_lo:[1,0] neg_hi:[0,1]
v_pk_add_f32 v[74:75], v[74:75], v[78:79]
v_pk_add_f32 v[78:79], v[16:17], v[18:19] neg_lo:[0,1] neg_hi:[0,1]
v_pk_add_f32 v[16:17], v[16:17], v[18:19]
v_pk_add_f32 v[18:19], v[76:77], v[20:21] neg_lo:[0,1] neg_hi:[0,1]
v_pk_add_f32 v[76:77], v[76:77], v[20:21]
v_pk_add_f32 v[20:21], v[72:73], v[26:27] neg_lo:[0,1] neg_hi:[0,1]
v_pk_add_f32 v[72:73], v[72:73], v[26:27]
v_pk_add_f32 v[26:27], v[22:23], v[24:25] neg_lo:[0,1] neg_hi:[0,1]
v_pk_add_f32 v[22:23], v[22:23], v[24:25]
v_pk_add_f32 v[24:25], v[64:65], v[34:35] neg_lo:[0,1] neg_hi:[0,1]
v_pk_add_f32 v[64:65], v[64:65], v[34:35]
v_pk_add_f32 v[34:35], v[30:31], v[36:37] neg_lo:[0,1] neg_hi:[0,1]
v_pk_add_f32 v[30:31], v[30:31], v[36:37]
v_pk_add_f32 v[36:37], v[28:29], v[42:43] neg_lo:[0,1] neg_hi:[0,1]
v_pk_add_f32 v[28:29], v[28:29], v[42:43]
v_pk_add_f32 v[42:43], v[38:39], v[32:33] neg_lo:[0,1] neg_hi:[0,1]
v_pk_add_f32 v[38:39], v[38:39], v[32:33]
v_pk_add_f32 v[32:33], v[14:15], v[50:51] neg_lo:[0,1] neg_hi:[0,1]
v_pk_add_f32 v[14:15], v[14:15], v[50:51]
v_pk_add_f32 v[50:51], v[46:47], v[52:53] neg_lo:[0,1] neg_hi:[0,1]
v_pk_add_f32 v[46:47], v[46:47], v[52:53]
v_pk_add_f32 v[52:53], v[44:45], v[58:59] neg_lo:[0,1] neg_hi:[0,1]
v_pk_add_f32 v[44:45], v[44:45], v[58:59]
v_pk_add_f32 v[58:59], v[54:55], v[56:57] neg_lo:[0,1] neg_hi:[0,1]
v_pk_add_f32 v[54:55], v[54:55], v[56:57]
v_pk_add_f32 v[56:57], v[40:41], v[66:67] neg_lo:[0,1] neg_hi:[0,1]
v_pk_add_f32 v[40:41], v[40:41], v[66:67]
v_pk_add_f32 v[66:67], v[62:63], v[68:69] neg_lo:[0,1] neg_hi:[0,1]
v_pk_add_f32 v[62:63], v[62:63], v[68:69]
v_pk_add_f32 v[68:69], v[60:61], v[74:75] neg_lo:[0,1] neg_hi:[0,1]
v_pk_add_f32 v[60:61], v[60:61], v[74:75]
v_pk_add_f32 v[74:75], v[70:71], v[48:49] neg_lo:[0,1] neg_hi:[0,1]
v_pk_add_f32 v[70:71], v[70:71], v[48:49]
s_lshl_b32 s12, s38, 2
s_add_u32 s12, s12, s16
s_min_u32 s12, s12, 512
s_lshr_b32 s23, s12, 6
s_xnor_b32 s23, s23, s98
s_and_b32 s23, s23, 1
s_lshl_b32 s23, s23, 13
s_mul_i32 s12, s12, 32768
s_add_u32 s12, s12, 113246208
s_add_u32 s12, s12, s23
buffer_store_dwordx2 v[16:17], v5, s[84:87], s12 offen offset:0 sc1
buffer_store_dwordx2 v[14:15], v5, s[84:87], s12 offen offset:512 sc1
buffer_store_dwordx2 v[64:65], v5, s[84:87], s12 offen offset:1024 sc1
buffer_store_dwordx2 v[40:41], v5, s[84:87], s12 offen offset:1536 sc1
buffer_store_dwordx2 v[72:73], v5, s[84:87], s12 offen offset:2048 sc1
buffer_store_dwordx2 v[44:45], v5, s[84:87], s12 offen offset:2560 sc1
buffer_store_dwordx2 v[28:29], v5, s[84:87], s12 offen offset:3072 sc1
buffer_store_dwordx2 v[60:61], v5, s[84:87], s12 offen offset:3584 sc1
s_add_u32 s12, s12, 4096
buffer_store_dwordx2 v[76:77], v5, s[84:87], s12 offen offset:0 sc1
buffer_store_dwordx2 v[46:47], v5, s[84:87], s12 offen offset:512 sc1
buffer_store_dwordx2 v[30:31], v5, s[84:87], s12 offen offset:1024 sc1
buffer_store_dwordx2 v[62:63], v5, s[84:87], s12 offen offset:1536 sc1
buffer_store_dwordx2 v[22:23], v5, s[84:87], s12 offen offset:2048 sc1
buffer_store_dwordx2 v[54:55], v5, s[84:87], s12 offen offset:2560 sc1
buffer_store_dwordx2 v[38:39], v5, s[84:87], s12 offen offset:3072 sc1
buffer_store_dwordx2 v[70:71], v5, s[84:87], s12 offen offset:3584 sc1
s_add_u32 s12, s12, 12288
buffer_store_dwordx2 v[78:79], v5, s[84:87], s12 offen offset:0 sc1
buffer_store_dwordx2 v[32:33], v5, s[84:87], s12 offen offset:512 sc1
buffer_store_dwordx2 v[24:25], v5, s[84:87], s12 offen offset:1024 sc1
buffer_store_dwordx2 v[56:57], v5, s[84:87], s12 offen offset:1536 sc1
buffer_store_dwordx2 v[20:21], v5, s[84:87], s12 offen offset:2048 sc1
buffer_store_dwordx2 v[52:53], v5, s[84:87], s12 offen offset:2560 sc1
buffer_store_dwordx2 v[36:37], v5, s[84:87], s12 offen offset:3072 sc1
buffer_store_dwordx2 v[68:69], v5, s[84:87], s12 offen offset:3584 sc1
s_add_u32 s12, s12, 4096
buffer_store_dwordx2 v[18:19], v5, s[84:87], s12 offen offset:0 sc1
buffer_store_dwordx2 v[50:51], v5, s[84:87], s12 offen offset:512 sc1
buffer_store_dwordx2 v[34:35], v5, s[84:87], s12 offen offset:1024 sc1
buffer_store_dwordx2 v[66:67], v5, s[84:87], s12 offen offset:1536 sc1
buffer_store_dwordx2 v[26:27], v5, s[84:87], s12 offen offset:2048 sc1
buffer_store_dwordx2 v[58:59], v5, s[84:87], s12 offen offset:2560 sc1
buffer_store_dwordx2 v[42:43], v5, s[84:87], s12 offen offset:3072 sc1
buffer_store_dwordx2 v[74:75], v5, s[84:87], s12 offen offset:3584 sc1
s_add_u32 s12, s12, 4096
s_mov_b32 s38, s21
s_cmp_lt_u32 s38, s37
s_cbranch_scc1 mega_kernel_f2_l
mega_kernel_f2_e:
mega_kernel_f2e:
s_waitcnt vmcnt(0)
s_barrier
v_mov_b32 v1, 0
v_mov_b32 v2, 1
s_mov_b32 s82, 69259392
v_cmp_eq_u32 vcc, 0, v0
s_and_saveexec_b64 s[80:81], vcc
s_cbranch_execz mega_kernel_sg1
buffer_atomic_add v2, v1, s[84:87], s82 offen sc1
mega_kernel_sg1:
s_mov_b64 exec, s[80:81]
s_mov_b32 s64, 0
s_mov_b32 s65, 58
s_lshl_b32 s66, s40, 13
s_add_u32 s66, s66, 67633152
s_mov_b32 s67, 0
s_mov_b32 s68, 0
s_cmp_eq_u32 s91, 3
s_cbranch_scc1 mega_kernel_out
s_cmp_lt_u32 s92, 1
s_cbranch_scc1 mega_kernel_back
s_mov_b32 s68, 1
s_branch mega_kernel_out
mega_kernel_back:
s_lshl_b32 s68, s68, 1
s_mov_b32 s93, s92
s_load_dwordx2 s[4:5], s[0:1], 80
s_mov_b32 s48, 0x3f7ec46d
s_mov_b32 s49, 0x3dc8bd36
s_mov_b32 s50, 0x3f7b14be
s_mov_b32 s51, 0x3e47c5c2
s_mov_b32 s52, 0x3f74fa0b
s_mov_b32 s53, 0x3e94a031
s_mov_b32 s54, 0x3f6c835e
s_mov_b32 s55, 0x3ec3ef15
s_mov_b32 s56, 0x3f61c598
s_mov_b32 s57, 0x3ef15aea
s_mov_b32 s58, 0x3f54db31
s_mov_b32 s59, 0x3f0e39da
s_mov_b32 s60, 0x3f45e403
s_mov_b32 s61, 0x3f226799
s_mov_b32 s62, 0x3f3504f3
s_mov_b32 s63, 0x3f3504f3
v_and_b32 v1, 31, v0
v_lshrrev_b32 v2, 5, v0
v_cvt_f32_u32 v3, v1
v_mul_u32_u24 v10, 8448, v2
v_lshl_add_u32 v4, v1, 3, v10
v_mul_u32_u24 v5, 264, v1
v_add_u32 v5, v5, v10
v_and_b32 v11, 7, v0
v_lshrrev_b32 v9, 3, v0
v_mul_u32_u24 v10, 8448, v11
v_lshl_add_u32 v6, v9, 3, v10
v_lshlrev_b32 v7, 3, v9
v_sub_u32 v7, v10, v7
v_add_u32 v7, 4096, v7
v_mul_u32_u24 v8, 32768, v9
v_lshl_add_u32 v8, v11, 4, v8
v_mul_f32 v12, 0x3a800000, v3
v_cos_f32 v82, v12
v_sin_f32 v83, v12
v_mul_f32 v12, 0x3b000000, v3
v_cos_f32 v84, v12
v_sin_f32 v85, v12
v_mul_f32 v12, 0x3b400000, v3
v_cos_f32 v86, v12
v_sin_f32 v87, v12
v_mul_f32 v12, 0x3b800000, v3
v_cos_f32 v88, v12
v_sin_f32 v89, v12
v_mul_f32 v12, 0x3ba00000, v3
v_cos_f32 v90, v12
v_sin_f32 v91, v12
v_mul_f32 v12, 0x3bc00000, v3
v_cos_f32 v92, v12
v_sin_f32 v93, v12
v_mul_f32 v12, 0x3be00000, v3
v_cos_f32 v94, v12
v_sin_f32 v95, v12
v_mul_f32 v12, 0x3c000000, v3
v_cos_f32 v96, v12
v_sin_f32 v97, v12
v_mul_f32 v12, 0x3c100000, v3
v_cos_f32 v98, v12
v_sin_f32 v99, v12
v_mul_f32 v12, 0x3c200000, v3
v_cos_f32 v100, v12
v_sin_f32 v101, v12
v_mul_f32 v12, 0x3c300000, v3
v_cos_f32 v102, v12
v_sin_f32 v103, v12
v_mul_f32 v12, 0x3c400000, v3
v_cos_f32 v104, v12
v_sin_f32 v105, v12
v_mul_f32 v12, 0x3c500000, v3
v_cos_f32 v106, v12
v_sin_f32 v107, v12
v_mul_f32 v12, 0x3c600000, v3
v_cos_f32 v108, v12
v_sin_f32 v109, v12
v_mul_f32 v12, 0x3c700000, v3
v_cos_f32 v110, v12
v_sin_f32 v111, v12
v_mul_f32 v12, 0x3c800000, v3
v_cos_f32 v112, v12
v_sin_f32 v113, v12
v_mul_f32 v12, 0x3c880000, v3
v_cos_f32 v114, v12
v_sin_f32 v115, v12
v_mul_f32 v12, 0x3c900000, v3
v_cos_f32 v116, v12
v_sin_f32 v117, v12
v_mul_f32 v12, 0x3c980000, v3
v_cos_f32 v118, v12
v_sin_f32 v119, v12
v_mul_f32 v12, 0x3ca00000, v3
v_cos_f32 v120, v12
v_sin_f32 v121, v12
v_mul_f32 v12, 0x3ca80000, v3
v_cos_f32 v122, v12
v_sin_f32 v123, v12
v_mul_f32 v12, 0x3cb00000, v3
v_cos_f32 v124, v12
v_sin_f32 v125, v12
v_mul_f32 v12, 0x3cb80000, v3
v_cos_f32 v126, v12
v_sin_f32 v127, v12
v_mul_f32 v12, 0x3cc00000, v3
v_cos_f32 v128, v12
v_sin_f32 v129, v12
v_mul_f32 v12, 0x3cc80000, v3
v_cos_f32 v130, v12
v_sin_f32 v131, v12
v_mul_f32 v12, 0x3cd00000, v3
v_cos_f32 v132, v12
v_sin_f32 v133, v12
v_mul_f32 v12, 0x3cd80000, v3
v_cos_f32 v134, v12
v_sin_f32 v135, v12
v_mul_f32 v12, 0x3ce00000, v3
v_cos_f32 v136, v12
v_sin_f32 v137, v12
v_mul_f32 v12, 0x3ce80000, v3
v_cos_f32 v138, v12
v_sin_f32 v139, v12
v_mul_f32 v12, 0x3cf00000, v3
v_cos_f32 v140, v12
v_sin_f32 v141, v12
v_mul_f32 v12, 0x3cf80000, v3
v_cos_f32 v142, v12
v_sin_f32 v143, v12
v_lshlrev_b32 v12, 2, v1
v_sub_u32 v12, v4, v12
v_and_b32 v10, 127, v0
v_lshrrev_b32 v11, 7, v0
v_lshlrev_b32 v2, 5, v10
v_lshl_add_u32 v2, v11, 12, v2
v_lshlrev_b32 v3, 4, v10
v_lshl_add_u32 v3, v11, 12, v3
v_add_u32 v3, 2048, v3
v_cmp_eq_u32 s[14:15], 0, v9
s_waitcnt lgkmcnt(0)
s_mov_b32 s6, 8388608
s_mov_b32 s7, 0x00020000
v_mov_b32 v250, 0
s_mov_b32 s82, 69259392
mega_kernel_w1:
s_sleep 8
buffer_load_dword v251, v250, s[84:87], s82 offen sc1
s_waitcnt vmcnt(0)
v_cmp_ne_u32 vcc, 95, v251
s_cbranch_vccnz mega_kernel_w1
s_cmp_lt_u32 s93, 128
s_cbranch_scc0 mega_kernel_f3_e
s_lshl_b32 s12, s93, 7
s_and_b32 s23, s12, 0x2000
s_add_u32 s12, s12, s23
s_xor_b32 s23, s98, 1
s_lshl_b32 s23, s23, 13
s_add_u32 s12, s12, s23
s_add_u32 s12, s12, 113246208
buffer_load_dwordx4 v[144:147], v8, s[84:87], s12 offen sc1
s_add_u32 s12, s12, 1048576
buffer_load_dwordx4 v[148:151], v8, s[84:87], s12 offen sc1
s_add_u32 s12, s12, 1048576
s_xor_b32 s12, s12, 0x2000
buffer_load_dwordx4 v[152:155], v8, s[84:87], s12 offen sc1
s_add_u32 s12, s12, 1048576
buffer_load_dwordx4 v[156:159], v8, s[84:87], s12 offen sc1
s_add_u32 s12, s12, 1048576
s_xor_b32 s12, s12, 0x2000
buffer_load_dwordx4 v[160:163], v8, s[84:87], s12 offen sc1
s_add_u32 s12, s12, 1048576
buffer_load_dwordx4 v[164:167], v8, s[84:87], s12 offen sc1
s_add_u32 s12, s12, 1048576
s_xor_b32 s12, s12, 0x2000
buffer_load_dwordx4 v[168:171], v8, s[84:87], s12 offen sc1
s_add_u32 s12, s12, 1048576
buffer_load_dwordx4 v[172:175], v8, s[84:87], s12 offen sc1
s_add_u32 s12, s12, 1048576
s_xor_b32 s12, s12, 0x2000
buffer_load_dwordx4 v[176:179], v8, s[84:87], s12 offen sc1
s_add_u32 s12, s12, 1048576
buffer_load_dwordx4 v[180:183], v8, s[84:87], s12 offen sc1
s_add_u32 s12, s12, 1048576
s_xor_b32 s12, s12, 0x2000
buffer_load_dwordx4 v[184:187], v8, s[84:87], s12 offen sc1
s_add_u32 s12, s12, 1048576
buffer_load_dwordx4 v[188:191], v8, s[84:87], s12 offen sc1
s_add_u32 s12, s12, 1048576
s_xor_b32 s12, s12, 0x2000
buffer_load_dwordx4 v[192:195], v8, s[84:87], s12 offen sc1
s_add_u32 s12, s12, 1048576
buffer_load_dwordx4 v[196:199], v8, s[84:87], s12 offen sc1
s_add_u32 s12, s12, 1048576
s_xor_b32 s12, s12, 0x2000
buffer_load_dwordx4 v[200:203], v8, s[84:87], s12 offen sc1
s_add_u32 s12, s12, 1048576
buffer_load_dwordx4 v[204:207], v8, s[84:87], s12 offen sc1
s_add_u32 s12, s12, 1048576
s_xor_b32 s12, s12, 0x2000
buffer_load_dwordx4 v[208:211], v8, s[84:87], s12 offen sc1
s_add_u32 s12, s12, 1048576
s_waitcnt vmcnt(0)
mega_kernel_f3_l:
s_add_u32 s21, s93, 64
s_cmp_lt_u32 s21, 128
s_cselect_b32 s22, s21, s93
s_waitcnt vmcnt(8)
s_barrier
v_cndmask_b32 v145, v145, 0, s[14:15]
v_cndmask_b32 v147, v147, 0, s[14:15]
v_cndmask_b32 v209, v209, 0, s[14:15]
v_cndmask_b32 v211, v211, 0, s[14:15]
v_pk_add_f32 v[16:17], v[144:145], v[146:147] op_sel:[0,1] op_sel_hi:[1,0] neg_lo:[0,1]
v_pk_add_f32 v[18:19], v[144:145], v[146:147] op_sel:[0,1] op_sel_hi:[1,0] neg_hi:[1,0]
ds_write_b64 v6, v[16:17] offset:0
ds_write_b64 v7, v[18:19] offset:4096
v_pk_add_f32 v[20:21], v[148:149], v[150:151] op_sel:[0,1] op_sel_hi:[1,0] neg_lo:[0,1]
v_pk_add_f32 v[22:23], v[148:149], v[150:151] op_sel:[0,1] op_sel_hi:[1,0] neg_hi:[1,0]
ds_write_b64 v6, v[20:21] offset:256
ds_write_b64 v7, v[22:23] offset:3840
v_pk_add_f32 v[24:25], v[152:153], v[154:155] op_sel:[0,1] op_sel_hi:[1,0] neg_lo:[0,1]
v_pk_add_f32 v[26:27], v[152:153], v[154:155] op_sel:[0,1] op_sel_hi:[1,0] neg_hi:[1,0]
ds_write_b64 v6, v[24:25] offset:512
ds_write_b64 v7, v[26:27] offset:3584
v_pk_add_f32 v[28:29], v[156:157], v[158:159] op_sel:[0,1] op_sel_hi:[1,0] neg_lo:[0,1]
v_pk_add_f32 v[30:31], v[156:157], v[158:159] op_sel:[0,1] op_sel_hi:[1,0] neg_hi:[1,0]
ds_write_b64 v6, v[28:29] offset:768
ds_write_b64 v7, v[30:31] offset:3328
v_pk_add_f32 v[32:33], v[160:161], v[162:163] op_sel:[0,1] op_sel_hi:[1,0] neg_lo:[0,1]
v_pk_add_f32 v[34:35], v[160:161], v[162:163] op_sel:[0,1] op_sel_hi:[1,0] neg_hi:[1,0]
ds_write_b64 v6, v[32:33] offset:1024
ds_write_b64 v7, v[34:35] offset:3072
v_pk_add_f32 v[36:37], v[164:165], v[166:167] op_sel:[0,1] op_sel_hi:[1,0] neg_lo:[0,1]
v_pk_add_f32 v[38:39], v[164:165], v[166:167] op_sel:[0,1] op_sel_hi:[1,0] neg_hi:[1,0]
ds_write_b64 v6, v[36:37] offset:1280
ds_write_b64 v7, v[38:39] offset:2816
v_pk_add_f32 v[40:41], v[168:169], v[170:171] op_sel:[0,1] op_sel_hi:[1,0] neg_lo:[0,1]
v_pk_add_f32 v[42:43], v[168:169], v[170:171] op_sel:[0,1] op_sel_hi:[1,0] neg_hi:[1,0]
ds_write_b64 v6, v[40:41] offset:1536
ds_write_b64 v7, v[42:43] offset:2560
v_pk_add_f32 v[44:45], v[172:173], v[174:175] op_sel:[0,1] op_sel_hi:[1,0] neg_lo:[0,1]
v_pk_add_f32 v[46:47], v[172:173], v[174:175] op_sel:[0,1] op_sel_hi:[1,0] neg_hi:[1,0]
ds_write_b64 v6, v[44:45] offset:1792
ds_write_b64 v7, v[46:47] offset:2304
v_pk_add_f32 v[48:49], v[176:177], v[178:179] op_sel:[0,1] op_sel_hi:[1,0] neg_lo:[0,1]
v_pk_add_f32 v[50:51], v[176:177], v[178:179] op_sel:[0,1] op_sel_hi:[1,0] neg_hi:[1,0]
ds_write_b64 v6, v[48:49] offset:2048
ds_write_b64 v7, v[50:51] offset:2048
v_pk_add_f32 v[52:53], v[180:181], v[182:183] op_sel:[0,1] op_sel_hi:[1,0] neg_lo:[0,1]
v_pk_add_f32 v[54:55], v[180:181], v[182:183] op_sel:[0,1] op_sel_hi:[1,0] neg_hi:[1,0]
ds_write_b64 v6, v[52:53] offset:2304
ds_write_b64 v7, v[54:55] offset:1792
v_pk_add_f32 v[56:57], v[184:185], v[186:187] op_sel:[0,1] op_sel_hi:[1,0] neg_lo:[0,1]
v_pk_add_f32 v[58:59], v[184:185], v[186:187] op_sel:[0,1] op_sel_hi:[1,0] neg_hi:[1,0]
ds_write_b64 v6, v[56:57] offset:2560
ds_write_b64 v7, v[58:59] offset:1536
v_pk_add_f32 v[60:61], v[188:189], v[190:191] op_sel:[0,1] op_sel_hi:[1,0] neg_lo:[0,1]
v_pk_add_f32 v[62:63], v[188:189], v[190:191] op_sel:[0,1] op_sel_hi:[1,0] neg_hi:[1,0]
ds_write_b64 v6, v[60:61] offset:2816
ds_write_b64 v7, v[62:63] offset:1280
v_pk_add_f32 v[64:65], v[192:193], v[194:195] op_sel:[0,1] op_sel_hi:[1,0] neg_lo:[0,1]
v_pk_add_f32 v[66:67], v[192:193], v[194:195] op_sel:[0,1] op_sel_hi:[1,0] neg_hi:[1,0]
ds_write_b64 v6, v[64:65] offset:3072
ds_write_b64 v7, v[66:67] offset:1024
v_pk_add_f32 v[68:69], v[196:197], v[198:199] op_sel:[0,1] op_sel_hi:[1,0] neg_lo:[0,1]
v_pk_add_f32 v[70:71], v[196:197], v[198:199] op_sel:[0,1] op_sel_hi:[1,0] neg_hi:[1,0]
ds_write_b64 v6, v[68:69] offset:3328
ds_write_b64 v7, v[70:71] offset:768
v_pk_add_f32 v[72:73], v[200:201], v[202:203] op_sel:[0,1] op_sel_hi:[1,0] neg_lo:[0,1]
v_pk_add_f32 v[74:75], v[200:201], v[202:203] op_sel:[0,1] op_sel_hi:[1,0] neg_hi:[1,0]
ds_write_b64 v6, v[72:73] offset:3584
ds_write_b64 v7, v[74:75] offset:512
s_waitcnt lgkmcnt(8)
v_pk_add_f32 v[76:77], v[204:205], v[206:207] op_sel:[0,1] op_sel_hi:[1,0] neg_lo:[0,1]
v_pk_add_f32 v[78:79], v[204:205], v[206:207] op_sel:[0,1] op_sel_hi:[1,0] neg_hi:[1,0]
ds_write_b64 v6, v[76:77] offset:3840
ds_write_b64 v7, v[78:79] offset:256
v_pk_add_f32 v[16:17], v[208:209], v[210:211] op_sel:[0,1] op_sel_hi:[1,0] neg_lo:[0,1]
v_pk_add_f32 v[18:19], v[208:209], v[210:211] op_sel:[0,1] op_sel_hi:[1,0] neg_hi:[1,0]
s_mov_b64 exec, s[14:15]
ds_write_b64 v6, v[16:17] offset:4096
s_mov_b64 exec, -1
s_lshl_b32 s12, s22, 7
s_and_b32 s23, s12, 0x2000
s_add_u32 s12, s12, s23
s_xor_b32 s23, s98, 1
s_lshl_b32 s23, s23, 13
s_add_u32 s12, s12, s23
s_add_u32 s12, s12, 113246208
buffer_load_dwordx4 v[144:147], v8, s[84:87], s12 offen sc1
s_add_u32 s12, s12, 1048576
buffer_load_dwordx4 v[148:151], v8, s[84:87], s12 offen sc1
s_add_u32 s12, s12, 1048576
s_xor_b32 s12, s12, 0x2000
buffer_load_dwordx4 v[152:155], v8, s[84:87], s12 offen sc1
s_add_u32 s12, s12, 1048576
buffer_load_dwordx4 v[156:159], v8, s[84:87], s12 offen sc1
s_add_u32 s12, s12, 1048576
s_xor_b32 s12, s12, 0x2000
buffer_load_dwordx4 v[160:163], v8, s[84:87], s12 offen sc1
s_add_u32 s12, s12, 1048576
buffer_load_dwordx4 v[164:167], v8, s[84:87], s12 offen sc1
s_add_u32 s12, s12, 1048576
s_xor_b32 s12, s12, 0x2000
buffer_load_dwordx4 v[168:171], v8, s[84:87], s12 offen sc1
s_add_u32 s12, s12, 1048576
buffer_load_dwordx4 v[172:175], v8, s[84:87], s12 offen sc1
s_add_u32 s12, s12, 1048576
s_xor_b32 s12, s12, 0x2000
buffer_load_dwordx4 v[176:179], v8, s[84:87], s12 offen sc1
s_add_u32 s12, s12, 1048576
buffer_load_dwordx4 v[180:183], v8, s[84:87], s12 offen sc1
s_add_u32 s12, s12, 1048576
s_xor_b32 s12, s12, 0x2000
buffer_load_dwordx4 v[184:187], v8, s[84:87], s12 offen sc1
s_add_u32 s12, s12, 1048576
buffer_load_dwordx4 v[188:191], v8, s[84:87], s12 offen sc1
s_add_u32 s12, s12, 1048576
s_xor_b32 s12, s12, 0x2000
buffer_load_dwordx4 v[192:195], v8, s[84:87], s12 offen sc1
s_add_u32 s12, s12, 1048576
buffer_load_dwordx4 v[196:199], v8, s[84:87], s12 offen sc1
s_add_u32 s12, s12, 1048576
s_xor_b32 s12, s12, 0x2000
buffer_load_dwordx4 v[200:203], v8, s[84:87], s12 offen sc1
s_add_u32 s12, s12, 1048576
buffer_load_dwordx4 v[204:207], v8, s[84:87], s12 offen sc1
s_add_u32 s12, s12, 1048576
s_xor_b32 s12, s12, 0x2000
buffer_load_dwordx4 v[208:211], v8, s[84:87], s12 offen sc1
s_add_u32 s12, s12, 1048576
s_waitcnt lgkmcnt(0)
s_barrier
ds_read_b64 v[16:17], v4 offset:0
ds_read_b64 v[48:49], v4 offset:4096
ds_read_b64 v[18:19], v4 offset:256
ds_read_b64 v[50:51], v4 offset:4352
ds_read_b64 v[20:21], v4 offset:512
ds_read_b64 v[52:53], v4 offset:4608
ds_read_b64 v[22:23], v4 offset:768
ds_read_b64 v[54:55], v4 offset:4864
ds_read_b64 v[24:25], v4 offset:1024
ds_read_b64 v[56:57], v4 offset:5120
ds_read_b64 v[26:27], v4 offset:1280
ds_read_b64 v[58:59], v4 offset:5376
ds_read_b64 v[28:29], v4 offset:1536
ds_read_b64 v[60:61], v4 offset:5632
ds_read_b64 v[30:31], v4 offset:1792
ds_read_b64 v[62:63], v4 offset:5888
ds_read_b64 v[32:33], v4 offset:2048
ds_read_b64 v[64:65], v4 offset:6144
ds_read_b64 v[34:35], v4 offset:2304
ds_read_b64 v[66:67], v4 offset:6400
ds_read_b64 v[36:37], v4 offset:2560
ds_read_b64 v[68:69], v4 offset:6656
ds_read_b64 v[38:39], v4 offset:2816
ds_read_b64 v[70:71], v4 offset:6912
ds_read_b64 v[40:41], v4 offset:3072
ds_read_b64 v[72:73], v4 offset:7168
ds_read_b64 v[42:43], v4 offset:3328
ds_read_b64 v[74:75], v4 offset:7424
ds_read_b64 v[44:45], v4 offset:3584
ds_read_b64 v[76:77], v4 offset:7680
ds_read_b64 v[46:47], v4 offset:3840
ds_read_b64 v[78:79], v4 offset:7936
s_waitcnt lgkmcnt(0)
v_pk_add_f32 v[14:15], v[16:17], v[48:49] neg_lo:[0,1] neg_hi:[0,1]
v_pk_add_f32 v[16:17], v[16:17], v[48:49]
v_pk_add_f32 v[48:49], v[18:19], v[50:51] neg_lo:[0,1] neg_hi:[0,1]
v_pk_add_f32 v[18:19], v[18:19], v[50:51]
v_pk_mul_f32 v[50:51], v[48:49], s[50:51] op_sel:[0,0] op_sel_hi:[0,1] neg_lo:[0,0] neg_hi:[0,0]
v_pk_fma_f32 v[50:51], v[48:49], s[50:51], v[50:51] op_sel:[1,1,0] op_sel_hi:[1,0,1] neg_lo:[0,1,0] neg_hi:[0,0,0]
v_pk_add_f32 v[48:49], v[20:21], v[52:53] neg_lo:[0,1] neg_hi:[0,1]
v_pk_add_f32 v[20:21], v[20:21], v[52:53]
v_pk_mul_f32 v[52:53], v[48:49], s[54:55] op_sel:[0,0] op_sel_hi:[0,1] neg_lo:[0,0] neg_hi:[0,0]
v_pk_fma_f32 v[52:53], v[48:49], s[54:55], v[52:53] op_sel:[1,1,0] op_sel_hi:[1,0,1] neg_lo:[0,1,0] neg_hi:[0,0,0]
v_pk_add_f32 v[48:49], v[22:23], v[54:55] neg_lo:[0,1] neg_hi:[0,1]
v_pk_add_f32 v[22:23], v[22:23], v[54:55]
v_pk_mul_f32 v[54:55], v[48:49], s[58:59] op_sel:[0,0] op_sel_hi:[0,1] neg_lo:[0,0] neg_hi:[0,0]
v_pk_fma_f32 v[54:55], v[48:49], s[58:59], v[54:55] op_sel:[1,1,0] op_sel_hi:[1,0,1] neg_lo:[0,1,0] neg_hi:[0,0,0]
v_pk_add_f32 v[48:49], v[24:25], v[56:57] neg_lo:[0,1] neg_hi:[0,1]
v_pk_add_f32 v[24:25], v[24:25], v[56:57]
v_pk_mul_f32 v[56:57], v[48:49], s[62:63] op_sel:[0,0] op_sel_hi:[0,1] neg_lo:[0,0] neg_hi:[0,0]
v_pk_fma_f32 v[56:57], v[48:49], s[62:63], v[56:57] op_sel:[1,1,0] op_sel_hi:[1,0,1] neg_lo:[0,1,0] neg_hi:[0,0,0]
v_pk_add_f32 v[48:49], v[26:27], v[58:59] neg_lo:[0,1] neg_hi:[0,1]
v_pk_add_f32 v[26:27], v[26:27], v[58:59]
v_pk_mul_f32 v[58:59], v[48:49], s[58:59] op_sel:[0,1] op_sel_hi:[0,0] neg_lo:[0,0] neg_hi:[0,0]
v_pk_fma_f32 v[58:59], v[48:49], s[58:59], v[58:59] op_sel:[1,0,0] op_sel_hi:[1,1,1] neg_lo:[0,1,0] neg_hi:[0,0,0]
v_pk_add_f32 v[48:49], v[28:29], v[60:61] neg_lo:[0,1] neg_hi:[0,1]
v_pk_add_f32 v[28:29], v[28:29], v[60:61]
v_pk_mul_f32 v[60:61], v[48:49], s[54:55] op_sel:[0,1] op_sel_hi:[0,0] neg_lo:[0,0] neg_hi:[0,0]
v_pk_fma_f32 v[60:61], v[48:49], s[54:55], v[60:61] op_sel:[1,0,0] op_sel_hi:[1,1,1] neg_lo:[0,1,0] neg_hi:[0,0,0]
v_pk_add_f32 v[48:49], v[30:31], v[62:63] neg_lo:[0,1] neg_hi:[0,1]
v_pk_add_f32 v[30:31], v[30:31], v[62:63]
v_pk_mul_f32 v[62:63], v[48:49], s[50:51] op_sel:[0,1] op_sel_hi:[0,0] neg_lo:[0,0] neg_hi:[0,0]
v_pk_fma_f32 v[62:63], v[48:49], s[50:51], v[62:63] op_sel:[1,0,0] op_sel_hi:[1,1,1] neg_lo:[0,1,0] neg_hi:[0,0,0]
v_pk_add_f32 v[48:49], v[32:33], v[64:65] op_sel:[1,1] op_sel_hi:[0,0] neg_lo:[1,0] neg_hi:[0,1]
v_pk_add_f32 v[32:33], v[32:33], v[64:65]
v_pk_add_f32 v[64:65], v[34:35], v[66:67] neg_lo:[0,1] neg_hi:[0,1]
v_pk_add_f32 v[34:35], v[34:35], v[66:67]
v_pk_mul_f32 v[66:67], v[64:65], s[50:51] op_sel:[0,1] op_sel_hi:[0,0] neg_lo:[0,1] neg_hi:[0,0]
v_pk_fma_f32 v[66:67], v[64:65], s[50:51], v[66:67] op_sel:[1,0,0] op_sel_hi:[1,1,1] neg_lo:[0,1,0] neg_hi:[0,1,0]
v_pk_add_f32 v[64:65], v[36:37], v[68:69] neg_lo:[0,1] neg_hi:[0,1]
v_pk_add_f32 v[36:37], v[36:37], v[68:69]
v_pk_mul_f32 v[68:69], v[64:65], s[54:55] op_sel:[0,1] op_sel_hi:[0,0] neg_lo:[0,1] neg_hi:[0,0]
v_pk_fma_f32 v[68:69], v[64:65], s[54:55], v[68:69] op_sel:[1,0,0] op_sel_hi:[1,1,1] neg_lo:[0,1,0] neg_hi:[0,1,0]
v_pk_add_f32 v[64:65], v[38:39], v[70:71] neg_lo:[0,1] neg_hi:[0,1]
v_pk_add_f32 v[38:39], v[38:39], v[70:71]
v_pk_mul_f32 v[70:71], v[64:65], s[58:59] op_sel:[0,1] op_sel_hi:[0,0] neg_lo:[0,1] neg_hi:[0,0]
v_pk_fma_f32 v[70:71], v[64:65], s[58:59], v[70:71] op_sel:[1,0,0] op_sel_hi:[1,1,1] neg_lo:[0,1,0] neg_hi:[0,1,0]
v_pk_add_f32 v[64:65], v[40:41], v[72:73] neg_lo:[0,1] neg_hi:[0,1]
v_pk_add_f32 v[40:41], v[40:41], v[72:73]
v_pk_mul_f32 v[72:73], v[64:65], s[62:63] op_sel:[0,0] op_sel_hi:[0,1] neg_lo:[0,1] neg_hi:[0,0]
v_pk_fma_f32 v[72:73], v[64:65], s[62:63], v[72:73] op_sel:[1,1,0] op_sel_hi:[1,0,1] neg_lo:[0,1,0] neg_hi:[0,1,0]
v_pk_add_f32 v[64:65], v[42:43], v[74:75] neg_lo:[0,1] neg_hi:[0,1]
v_pk_add_f32 v[42:43], v[42:43], v[74:75]
v_pk_mul_f32 v[74:75], v[64:65], s[58:59] op_sel:[0,0] op_sel_hi:[0,1] neg_lo:[0,1] neg_hi:[0,0]
v_pk_fma_f32 v[74:75], v[64:65], s[58:59], v[74:75] op_sel:[1,1,0] op_sel_hi:[1,0,1] neg_lo:[0,1,0] neg_hi:[0,1,0]
v_pk_add_f32 v[64:65], v[44:45], v[76:77] neg_lo:[0,1] neg_hi:[0,1]
v_pk_add_f32 v[44:45], v[44:45], v[76:77]
v_pk_mul_f32 v[76:77], v[64:65], s[54:55] op_sel:[0,0] op_sel_hi:[0,1] neg_lo:[0,1] neg_hi:[0,0]
v_pk_fma_f32 v[76:77], v[64:65], s[54:55], v[76:77] op_sel:[1,1,0] op_sel_hi:[1,0,1] neg_lo:[0,1,0] neg_hi:[0,1,0]
v_pk_add_f32 v[64:65], v[46:47], v[78:79] neg_lo:[0,1] neg_hi:[0,1]
v_pk_add_f32 v[46:47], v[46:47], v[78:79]
v_pk_mul_f32 v[78:79], v[64:65], s[50:51] op_sel:[0,0] op_sel_hi:[0,1] neg_lo:[0,1] neg_hi:[0,0]
v_pk_fma_f32 v[78:79], v[64:65], s[50:51], v[78:79] op_sel:[1,1,0] op_sel_hi:[1,0,1] neg_lo:[0,1,0] neg_hi:[0,1,0]
v_pk_add_f32 v[64:65], v[16:17], v[32:33] neg_lo:[0,1] neg_hi:[0,1]
v_pk_add_f32 v[16:17], v[16:17], v[32:33]
v_pk_add_f32 v[32:33], v[18:19], v[34:35] neg_lo:[0,1] neg_hi:[0,1]
v_pk_add_f32 v[18:19], v[18:19], v[34:35]
v_pk_mul_f32 v[34:35], v[32:33], s[54:55] op_sel:[0,0] op_sel_hi:[0,1] neg_lo:[0,0] neg_hi:[0,0]
v_pk_fma_f32 v[34:35], v[32:33], s[54:55], v[34:35] op_sel:[1,1,0] op_sel_hi:[1,0,1] neg_lo:[0,1,0] neg_hi:[0,0,0]
v_pk_add_f32 v[32:33], v[20:21], v[36:37] neg_lo:[0,1] neg_hi:[0,1]
v_pk_add_f32 v[20:21], v[20:21], v[36:37]
v_pk_mul_f32 v[36:37], v[32:33], s[62:63] op_sel:[0,0] op_sel_hi:[0,1] neg_lo:[0,0] neg_hi:[0,0]
v_pk_fma_f32 v[36:37], v[32:33], s[62:63], v[36:37] op_sel:[1,1,0] op_sel_hi:[1,0,1] neg_lo:[0,1,0] neg_hi:[0,0,0]
v_pk_add_f32 v[32:33], v[22:23], v[38:39] neg_lo:[0,1] neg_hi:[0,1]
v_pk_add_f32 v[22:23], v[22:23], v[38:39]
v_pk_mul_f32 v[38:39], v[32:33], s[54:55] op_sel:[0,1] op_sel_hi:[0,0] neg_lo:[0,0] neg_hi:[0,0]
v_pk_fma_f32 v[38:39], v[32:33], s[54:55], v[38:39] op_sel:[1,0,0] op_sel_hi:[1,1,1] neg_lo:[0,1,0] neg_hi:[0,0,0]
v_pk_add_f32 v[32:33], v[24:25], v[40:41] op_sel:[1,1] op_sel_hi:[0,0] neg_lo:[1,0] neg_hi:[0,1]
v_pk_add_f32 v[24:25], v[24:25], v[40:41]
v_pk_add_f32 v[40:41], v[26:27], v[42:43] neg_lo:[0,1] neg_hi:[0,1]
v_pk_add_f32 v[26:27], v[26:27], v[42:43]
v_pk_mul_f32 v[42:43], v[40:41], s[54:55] op_sel:[0,1] op_sel_hi:[0,0] neg_lo:[0,1] neg_hi:[0,0]
v_pk_fma_f32 v[42:43], v[40:41], s[54:55], v[42:43] op_sel:[1,0,0] op_sel_hi:[1,1,1] neg_lo:[0,1,0] neg_hi:[0,1,0]
v_pk_add_f32 v[40:41], v[28:29], v[44:45] neg_lo:[0,1] neg_hi:[0,1]
v_pk_add_f32 v[28:29], v[28:29], v[44:45]
v_pk_mul_f32 v[44:45], v[40:41], s[62:63] op_sel:[0,0] op_sel_hi:[0,1] neg_lo:[0,1] neg_hi:[0,0]
v_pk_fma_f32 v[44:45], v[40:41], s[62:63], v[44:45] op_sel:[1,1,0] op_sel_hi:[1,0,1] neg_lo:[0,1,0] neg_hi:[0,1,0]
v_pk_add_f32 v[40:41], v[30:31], v[46:47] neg_lo:[0,1] neg_hi:[0,1]
v_pk_add_f32 v[30:31], v[30:31], v[46:47]
v_pk_mul_f32 v[46:47], v[40:41], s[54:55] op_sel:[0,0] op_sel_hi:[0,1] neg_lo:[0,1] neg_hi:[0,0]
v_pk_fma_f32 v[46:47], v[40:41], s[54:55], v[46:47] op_sel:[1,1,0] op_sel_hi:[1,0,1] neg_lo:[0,1,0] neg_hi:[0,1,0]
v_pk_add_f32 v[40:41], v[14:15], v[48:49] neg_lo:[0,1] neg_hi:[0,1]
v_pk_add_f32 v[14:15], v[14:15], v[48:49]
v_pk_add_f32 v[48:49], v[50:51], v[66:67] neg_lo:[0,1] neg_hi:[0,1]
v_pk_add_f32 v[50:51], v[50:51], v[66:67]
v_pk_mul_f32 v[66:67], v[48:49], s[54:55] op_sel:[0,0] op_sel_hi:[0,1] neg_lo:[0,0] neg_hi:[0,0]
v_pk_fma_f32 v[66:67], v[48:49], s[54:55], v[66:67] op_sel:[1,1,0] op_sel_hi:[1,0,1] neg_lo:[0,1,0] neg_hi:[0,0,0]
v_pk_add_f32 v[48:49], v[52:53], v[68:69] neg_lo:[0,1] neg_hi:[0,1]
v_pk_add_f32 v[52:53], v[52:53], v[68:69]
v_pk_mul_f32 v[68:69], v[48:49], s[62:63] op_sel:[0,0] op_sel_hi:[0,1] neg_lo:[0,0] neg_hi:[0,0]
v_pk_fma_f32 v[68:69], v[48:49], s[62:63], v[68:69] op_sel:[1,1,0] op_sel_hi:[1,0,1] neg_lo:[0,1,0] neg_hi:[0,0,0]
v_pk_add_f32 v[48:49], v[54:55], v[70:71] neg_lo:[0,1] neg_hi:[0,1]
v_pk_add_f32 v[54:55], v[54:55], v[70:71]
v_pk_mul_f32 v[70:71], v[48:49], s[54:55] op_sel:[0,1] op_sel_hi:[0,0] neg_lo:[0,0] neg_hi:[0,0]
v_pk_fma_f32 v[70:71], v[48:49], s[54:55], v[70:71] op_sel:[1,0,0] op_sel_hi:[1,1,1] neg_lo:[0,1,0] neg_hi:[0,0,0]
v_pk_add_f32 v[48:49], v[56:57], v[72:73] op_sel:[1,1] op_sel_hi:[0,0] neg_lo:[1,0] neg_hi:[0,1]
v_pk_add_f32 v[56:57], v[56:57], v[72:73]
v_pk_add_f32 v[72:73], v[58:59], v[74:75] neg_lo:[0,1] neg_hi:[0,1]
v_pk_add_f32 v[58:59], v[58:59], v[74:75]
v_pk_mul_f32 v[74:75], v[72:73], s[54:55] op_sel:[0,1] op_sel_hi:[0,0] neg_lo:[0,1] neg_hi:[0,0]
v_pk_fma_f32 v[74:75], v[72:73], s[54:55], v[74:75] op_sel:[1,0,0] op_sel_hi:[1,1,1] neg_lo:[0,1,0] neg_hi:[0,1,0]
v_pk_add_f32 v[72:73], v[60:61], v[76:77] neg_lo:[0,1] neg_hi:[0,1]
v_pk_add_f32 v[60:61], v[60:61], v[76:77]
v_pk_mul_f32 v[76:77], v[72:73], s[62:63] op_sel:[0,0] op_sel_hi:[0,1] neg_lo:[0,1] neg_hi:[0,0]
v_pk_fma_f32 v[76:77], v[72:73], s[62:63], v[76:77] op_sel:[1,1,0] op_sel_hi:[1,0,1] neg_lo:[0,1,0] neg_hi:[0,1,0]
v_pk_add_f32 v[72:73], v[62:63], v[78:79] neg_lo:[0,1] neg_hi:[0,1]
v_pk_add_f32 v[62:63], v[62:63], v[78:79]
v_pk_mul_f32 v[78:79], v[72:73], s[54:55] op_sel:[0,0] op_sel_hi:[0,1] neg_lo:[0,1] neg_hi:[0,0]
v_pk_fma_f32 v[78:79], v[72:73], s[54:55], v[78:79] op_sel:[1,1,0] op_sel_hi:[1,0,1] neg_lo:[0,1,0] neg_hi:[0,1,0]
v_pk_add_f32 v[72:73], v[16:17], v[24:25] neg_lo:[0,1] neg_hi:[0,1]
v_pk_add_f32 v[16:17], v[16:17], v[24:25]
v_pk_add_f32 v[24:25], v[18:19], v[26:27] neg_lo:[0,1] neg_hi:[0,1]
v_pk_add_f32 v[18:19], v[18:19], v[26:27]
v_pk_mul_f32 v[26:27], v[24:25], s[62:63] op_sel:[0,0] op_sel_hi:[0,1] neg_lo:[0,0] neg_hi:[0,0]
v_pk_fma_f32 v[26:27], v[24:25], s[62:63], v[26:27] op_sel:[1,1,0] op_sel_hi:[1,0,1] neg_lo:[0,1,0] neg_hi:[0,0,0]
v_pk_add_f32 v[24:25], v[20:21], v[28:29] op_sel:[1,1] op_sel_hi:[0,0] neg_lo:[1,0] neg_hi:[0,1]
v_pk_add_f32 v[20:21], v[20:21], v[28:29]
v_pk_add_f32 v[28:29], v[22:23], v[30:31] neg_lo:[0,1] neg_hi:[0,1]
v_pk_add_f32 v[22:23], v[22:23], v[30:31]
v_pk_mul_f32 v[30:31], v[28:29], s[62:63] op_sel:[0,0] op_sel_hi:[0,1] neg_lo:[0,1] neg_hi:[0,0]
v_pk_fma_f32 v[30:31], v[28:29], s[62:63], v[30:31] op_sel:[1,1,0] op_sel_hi:[1,0,1] neg_lo:[0,1,0] neg_hi:[0,1,0]
v_pk_add_f32 v[28:29], v[64:65], v[32:33] neg_lo:[0,1] neg_hi:[0,1]
v_pk_add_f32 v[64:65], v[64:65], v[32:33]
v_pk_add_f32 v[32:33], v[34:35], v[42:43] neg_lo:[0,1] neg_hi:[0,1]
v_pk_add_f32 v[34:35], v[34:35], v[42:43]
v_pk_mul_f32 v[42:43], v[32:33], s[62:63] op_sel:[0,0] op_sel_hi:[0,1] neg_lo:[0,0] neg_hi:[0,0]
v_pk_fma_f32 v[42:43], v[32:33], s[62:63], v[42:43] op_sel:[1,1,0] op_sel_hi:[1,0,1] neg_lo:[0,1,0] neg_hi:[0,0,0]
v_pk_add_f32 v[32:33], v[36:37], v[44:45] op_sel:[1,1] op_sel_hi:[0,0] neg_lo:[1,0] neg_hi:[0,1]
v_pk_add_f32 v[36:37], v[36:37], v[44:45]
v_pk_add_f32 v[44:45], v[38:39], v[46:47] neg_lo:[0,1] neg_hi:[0,1]
v_pk_add_f32 v[38:39], v[38:39], v[46:47]
v_pk_mul_f32 v[46:47], v[44:45], s[62:63] op_sel:[0,0] op_sel_hi:[0,1] neg_lo:[0,1] neg_hi:[0,0]
v_pk_fma_f32 v[46:47], v[44:45], s[62:63], v[46:47] op_sel:[1,1,0] op_sel_hi:[1,0,1] neg_lo:[0,1,0] neg_hi:[0,1,0]
v_pk_add_f32 v[44:45], v[14:15], v[56:57] neg_lo:[0,1] neg_hi:[0,1]
v_pk_add_f32 v[14:15], v[14:15], v[56:57]
v_pk_add_f32 v[56:57], v[50:51], v[58:59] neg_lo:[0,1] neg_hi:[0,1]
v_pk_add_f32 v[50:51], v[50:51], v[58:59]
v_pk_mul_f32 v[58:59], v[56:57], s[62:63] op_sel:[0,0] op_sel_hi:[0,1] neg_lo:[0,0] neg_hi:[0,0]
v_pk_fma_f32 v[58:59], v[56:57], s[62:63], v[58:59] op_sel:[1,1,0] op_sel_hi:[1,0,1] neg_lo:[0,1,0] neg_hi:[0,0,0]
v_pk_add_f32 v[56:57], v[52:53], v[60:61] op_sel:[1,1] op_sel_hi:[0,0] neg_lo:[1,0] neg_hi:[0,1]
v_pk_add_f32 v[52:53], v[52:53], v[60:61]
v_pk_add_f32 v[60:61], v[54:55], v[62:63] neg_lo:[0,1] neg_hi:[0,1]
v_pk_add_f32 v[54:55], v[54:55], v[62:63]
v_pk_mul_f32 v[62:63], v[60:61], s[62:63] op_sel:[0,0] op_sel_hi:[0,1] neg_lo:[0,1] neg_hi:[0,0]
v_pk_fma_f32 v[62:63], v[60:61], s[62:63], v[62:63] op_sel:[1,1,0] op_sel_hi:[1,0,1] neg_lo:[0,1,0] neg_hi:[0,1,0]
v_pk_add_f32 v[60:61], v[40:41], v[48:49] neg_lo:[0,1] neg_hi:[0,1]
v_pk_add_f32 v[40:41], v[40:41], v[48:49]
v_pk_add_f32 v[48:49], v[66:67], v[74:75] neg_lo:[0,1] neg_hi:[0,1]
v_pk_add_f32 v[66:67], v[66:67], v[74:75]
v_pk_mul_f32 v[74:75], v[48:49], s[62:63] op_sel:[0,0] op_sel_hi:[0,1] neg_lo:[0,0] neg_hi:[0,0]
v_pk_fma_f32 v[74:75], v[48:49], s[62:63], v[74:75] op_sel:[1,1,0] op_sel_hi:[1,0,1] neg_lo:[0,1,0] neg_hi:[0,0,0]
v_pk_add_f32 v[48:49], v[68:69], v[76:77] op_sel:[1,1] op_sel_hi:[0,0] neg_lo:[1,0] neg_hi:[0,1]
v_pk_add_f32 v[68:69], v[68:69], v[76:77]
v_pk_add_f32 v[76:77], v[70:71], v[78:79] neg_lo:[0,1] neg_hi:[0,1]
v_pk_add_f32 v[70:71], v[70:71], v[78:79]
v_pk_mul_f32 v[78:79], v[76:77], s[62:63] op_sel:[0,0] op_sel_hi:[0,1] neg_lo:[0,1] neg_hi:[0,0]
v_pk_fma_f32 v[78:79], v[76:77], s[62:63], v[78:79] op_sel:[1,1,0] op_sel_hi:[1,0,1] neg_lo:[0,1,0] neg_hi:[0,1,0]
v_pk_add_f32 v[76:77], v[16:17], v[20:21] neg_lo:[0,1] neg_hi:[0,1]
v_pk_add_f32 v[16:17], v[16:17], v[20:21]
v_pk_add_f32 v[20:21], v[18:19], v[22:23] op_sel:[1,1] op_sel_hi:[0,0] neg_lo:[1,0] neg_hi:[0,1]
v_pk_add_f32 v[18:19], v[18:19], v[22:23]
v_pk_add_f32 v[22:23], v[72:73], v[24:25] neg_lo:[0,1] neg_hi:[0,1]
v_pk_add_f32 v[72:73], v[72:73], v[24:25]
v_pk_add_f32 v[24:25], v[26:27], v[30:31] op_sel:[1,1] op_sel_hi:[0,0] neg_lo:[1,0] neg_hi:[0,1]
v_pk_add_f32 v[26:27], v[26:27], v[30:31]
v_pk_add_f32 v[30:31], v[64:65], v[36:37] neg_lo:[0,1] neg_hi:[0,1]
v_pk_add_f32 v[64:65], v[64:65], v[36:37]
v_pk_add_f32 v[36:37], v[34:35], v[38:39] op_sel:[1,1] op_sel_hi:[0,0] neg_lo:[1,0] neg_hi:[0,1]
v_pk_add_f32 v[34:35], v[34:35], v[38:39]
v_pk_add_f32 v[38:39], v[28:29], v[32:33] neg_lo:[0,1] neg_hi:[0,1]
v_pk_add_f32 v[28:29], v[28:29], v[32:33]
v_pk_add_f32 v[32:33], v[42:43], v[46:47] op_sel:[1,1] op_sel_hi:[0,0] neg_lo:[1,0] neg_hi:[0,1]
v_pk_add_f32 v[42:43], v[42:43], v[46:47]
v_pk_add_f32 v[46:47], v[14:15], v[52:53] neg_lo:[0,1] neg_hi:[0,1]
v_pk_add_f32 v[14:15], v[14:15], v[52:53]
v_pk_add_f32 v[52:53], v[50:51], v[54:55] op_sel:[1,1] op_sel_hi:[0,0] neg_lo:[1,0] neg_hi:[0,1]
v_pk_add_f32 v[50:51], v[50:51], v[54:55]
v_pk_add_f32 v[54:55], v[44:45], v[56:57] neg_lo:[0,1] neg_hi:[0,1]
v_pk_add_f32 v[44:45], v[44:45], v[56:57]
v_pk_add_f32 v[56:57], v[58:59], v[62:63] op_sel:[1,1] op_sel_hi:[0,0] neg_lo:[1,0] neg_hi:[0,1]
v_pk_add_f32 v[58:59], v[58:59], v[62:63]
v_pk_add_f32 v[62:63], v[40:41], v[68:69] neg_lo:[0,1] neg_hi:[0,1]
v_pk_add_f32 v[40:41], v[40:41], v[68:69]
v_pk_add_f32 v[68:69], v[66:67], v[70:71] op_sel:[1,1] op_sel_hi:[0,0] neg_lo:[1,0] neg_hi:[0,1]
v_pk_add_f32 v[66:67], v[66:67], v[70:71]
v_pk_add_f32 v[70:71], v[60:61], v[48:49] neg_lo:[0,1] neg_hi:[0,1]
v_pk_add_f32 v[60:61], v[60:61], v[48:49]
v_pk_add_f32 v[48:49], v[74:75], v[78:79] op_sel:[1,1] op_sel_hi:[0,0] neg_lo:[1,0] neg_hi:[0,1]
v_pk_add_f32 v[74:75], v[74:75], v[78:79]
v_pk_add_f32 v[78:79], v[16:17], v[18:19] neg_lo:[0,1] neg_hi:[0,1]
v_pk_add_f32 v[16:17], v[16:17], v[18:19]
v_pk_add_f32 v[18:19], v[76:77], v[20:21] neg_lo:[0,1] neg_hi:[0,1]
v_pk_add_f32 v[76:77], v[76:77], v[20:21]
v_pk_add_f32 v[20:21], v[72:73], v[26:27] neg_lo:[0,1] neg_hi:[0,1]
v_pk_add_f32 v[72:73], v[72:73], v[26:27]
v_pk_add_f32 v[26:27], v[22:23], v[24:25] neg_lo:[0,1] neg_hi:[0,1]
v_pk_add_f32 v[22:23], v[22:23], v[24:25]
v_pk_add_f32 v[24:25], v[64:65], v[34:35] neg_lo:[0,1] neg_hi:[0,1]
v_pk_add_f32 v[64:65], v[64:65], v[34:35]
v_pk_add_f32 v[34:35], v[30:31], v[36:37] neg_lo:[0,1] neg_hi:[0,1]
v_pk_add_f32 v[30:31], v[30:31], v[36:37]
v_pk_add_f32 v[36:37], v[28:29], v[42:43] neg_lo:[0,1] neg_hi:[0,1]
v_pk_add_f32 v[28:29], v[28:29], v[42:43]
v_pk_add_f32 v[42:43], v[38:39], v[32:33] neg_lo:[0,1] neg_hi:[0,1]
v_pk_add_f32 v[38:39], v[38:39], v[32:33]
v_pk_add_f32 v[32:33], v[14:15], v[50:51] neg_lo:[0,1] neg_hi:[0,1]
v_pk_add_f32 v[14:15], v[14:15], v[50:51]
v_pk_add_f32 v[50:51], v[46:47], v[52:53] neg_lo:[0,1] neg_hi:[0,1]
v_pk_add_f32 v[46:47], v[46:47], v[52:53]
v_pk_add_f32 v[52:53], v[44:45], v[58:59] neg_lo:[0,1] neg_hi:[0,1]
v_pk_add_f32 v[44:45], v[44:45], v[58:59]
v_pk_add_f32 v[58:59], v[54:55], v[56:57] neg_lo:[0,1] neg_hi:[0,1]
v_pk_add_f32 v[54:55], v[54:55], v[56:57]
v_pk_add_f32 v[56:57], v[40:41], v[66:67] neg_lo:[0,1] neg_hi:[0,1]
v_pk_add_f32 v[40:41], v[40:41], v[66:67]
v_pk_add_f32 v[66:67], v[62:63], v[68:69] neg_lo:[0,1] neg_hi:[0,1]
v_pk_add_f32 v[62:63], v[62:63], v[68:69]
v_pk_add_f32 v[68:69], v[60:61], v[74:75] neg_lo:[0,1] neg_hi:[0,1]
v_pk_add_f32 v[60:61], v[60:61], v[74:75]
v_pk_add_f32 v[74:75], v[70:71], v[48:49] neg_lo:[0,1] neg_hi:[0,1]
v_pk_add_f32 v[70:71], v[70:71], v[48:49]
v_pk_mul_f32 v[48:49], v[14:15], v[82:83] op_sel:[0,0] op_sel_hi:[0,1] neg_lo:[0,0] neg_hi:[0,0]
v_pk_fma_f32 v[14:15], v[14:15], v[82:83], v[48:49] op_sel:[1,1,0] op_sel_hi:[1,0,1] neg_lo:[0,1,0] neg_hi:[0,0,0]
v_pk_mul_f32 v[48:49], v[64:65], v[84:85] op_sel:[0,0] op_sel_hi:[0,1] neg_lo:[0,0] neg_hi:[0,0]
v_pk_fma_f32 v[64:65], v[64:65], v[84:85], v[48:49] op_sel:[1,1,0] op_sel_hi:[1,0,1] neg_lo:[0,1,0] neg_hi:[0,0,0]
v_pk_mul_f32 v[48:49], v[40:41], v[86:87] op_sel:[0,0] op_sel_hi:[0,1] neg_lo:[0,0] neg_hi:[0,0]
v_pk_fma_f32 v[40:41], v[40:41], v[86:87], v[48:49] op_sel:[1,1,0] op_sel_hi:[1,0,1] neg_lo:[0,1,0] neg_hi:[0,0,0]
v_pk_mul_f32 v[48:49], v[72:73], v[88:89] op_sel:[0,0] op_sel_hi:[0,1] neg_lo:[0,0] neg_hi:[0,0]
v_pk_fma_f32 v[72:73], v[72:73], v[88:89], v[48:49] op_sel:[1,1,0] op_sel_hi:[1,0,1] neg_lo:[0,1,0] neg_hi:[0,0,0]
v_pk_mul_f32 v[48:49], v[44:45], v[90:91] op_sel:[0,0] op_sel_hi:[0,1] neg_lo:[0,0] neg_hi:[0,0]
v_pk_fma_f32 v[44:45], v[44:45], v[90:91], v[48:49] op_sel:[1,1,0] op_sel_hi:[1,0,1] neg_lo:[0,1,0] neg_hi:[0,0,0]
v_pk_mul_f32 v[48:49], v[28:29], v[92:93] op_sel:[0,0] op_sel_hi:[0,1] neg_lo:[0,0] neg_hi:[0,0]
v_pk_fma_f32 v[28:29], v[28:29], v[92:93], v[48:49] op_sel:[1,1,0] op_sel_hi:[1,0,1] neg_lo:[0,1,0] neg_hi:[0,0,0]
v_pk_mul_f32 v[48:49], v[60:61], v[94:95] op_sel:[0,0] op_sel_hi:[0,1] neg_lo:[0,0] neg_hi:[0,0]
v_pk_fma_f32 v[60:61], v[60:61], v[94:95], v[48:49] op_sel:[1,1,0] op_sel_hi:[1,0,1] neg_lo:[0,1,0] neg_hi:[0,0,0]
v_pk_mul_f32 v[48:49], v[76:77], v[96:97] op_sel:[0,0] op_sel_hi:[0,1] neg_lo:[0,0] neg_hi:[0,0]
v_pk_fma_f32 v[76:77], v[76:77], v[96:97], v[48:49] op_sel:[1,1,0] op_sel_hi:[1,0,1] neg_lo:[0,1,0] neg_hi:[0,0,0]
v_pk_mul_f32 v[48:49], v[46:47], v[98:99] op_sel:[0,0] op_sel_hi:[0,1] neg_lo:[0,0] neg_hi:[0,0]
v_pk_fma_f32 v[46:47], v[46:47], v[98:99], v[48:49] op_sel:[1,1,0] op_sel_hi:[1,0,1] neg_lo:[0,1,0] neg_hi:[0,0,0]
v_pk_mul_f32 v[48:49], v[30:31], v[100:101] op_sel:[0,0] op_sel_hi:[0,1] neg_lo:[0,0] neg_hi:[0,0]
v_pk_fma_f32 v[30:31], v[30:31], v[100:101], v[48:49] op_sel:[1,1,0] op_sel_hi:[1,0,1] neg_lo:[0,1,0] neg_hi:[0,0,0]
v_pk_mul_f32 v[48:49], v[62:63], v[102:103] op_sel:[0,0] op_sel_hi:[0,1] neg_lo:[0,0] neg_hi:[0,0]
v_pk_fma_f32 v[62:63], v[62:63], v[102:103], v[48:49] op_sel:[1,1,0] op_sel_hi:[1,0,1] neg_lo:[0,1,0] neg_hi:[0,0,0]
v_pk_mul_f32 v[48:49], v[22:23], v[104:105] op_sel:[0,0] op_sel_hi:[0,1] neg_lo:[0,0] neg_hi:[0,0]
v_pk_fma_f32 v[22:23], v[22:23], v[104:105], v[48:49] op_sel:[1,1,0] op_sel_hi:[1,0,1] neg_lo:[0,1,0] neg_hi:[0,0,0]
v_pk_mul_f32 v[48:49], v[54:55], v[106:107] op_sel:[0,0] op_sel_hi:[0,1] neg_lo:[0,0] neg_hi:[0,0]
v_pk_fma_f32 v[54:55], v[54:55], v[106:107], v[48:49] op_sel:[1,1,0] op_sel_hi:[1,0,1] neg_lo:[0,1,0] neg_hi:[0,0,0]
v_pk_mul_f32 v[48:49], v[38:39], v[108:109] op_sel:[0,0] op_sel_hi:[0,1] neg_lo:[0,0] neg_hi:[0,0]
v_pk_fma_f32 v[38:39], v[38:39], v[108:109], v[48:49] op_sel:[1,1,0] op_sel_hi:[1,0,1] neg_lo:[0,1,0] neg_hi:[0,0,0]
v_pk_mul_f32 v[48:49], v[70:71], v[110:111] op_sel:[0,0] op_sel_hi:[0,1] neg_lo:[0,0] neg_hi:[0,0]
v_pk_fma_f32 v[70:71], v[70:71], v[110:111], v[48:49] op_sel:[1,1,0] op_sel_hi:[1,0,1] neg_lo:[0,1,0] neg_hi:[0,0,0]
v_pk_mul_f32 v[48:49], v[78:79], v[112:113] op_sel:[0,0] op_sel_hi:[0,1] neg_lo:[0,0] neg_hi:[0,0]
v_pk_fma_f32 v[78:79], v[78:79], v[112:113], v[48:49] op_sel:[1,1,0] op_sel_hi:[1,0,1] neg_lo:[0,1,0] neg_hi:[0,0,0]
v_pk_mul_f32 v[48:49], v[32:33], v[114:115] op_sel:[0,0] op_sel_hi:[0,1] neg_lo:[0,0] neg_hi:[0,0]
v_pk_fma_f32 v[32:33], v[32:33], v[114:115], v[48:49] op_sel:[1,1,0] op_sel_hi:[1,0,1] neg_lo:[0,1,0] neg_hi:[0,0,0]
v_pk_mul_f32 v[48:49], v[24:25], v[116:117] op_sel:[0,0] op_sel_hi:[0,1] neg_lo:[0,0] neg_hi:[0,0]
v_pk_fma_f32 v[24:25], v[24:25], v[116:117], v[48:49] op_sel:[1,1,0] op_sel_hi:[1,0,1] neg_lo:[0,1,0] neg_hi:[0,0,0]
v_pk_mul_f32 v[48:49], v[56:57], v[118:119] op_sel:[0,0] op_sel_hi:[0,1] neg_lo:[0,0] neg_hi:[0,0]
v_pk_fma_f32 v[56:57], v[56:57], v[118:119], v[48:49] op_sel:[1,1,0] op_sel_hi:[1,0,1] neg_lo:[0,1,0] neg_hi:[0,0,0]
v_pk_mul_f32 v[48:49], v[20:21], v[120:121] op_sel:[0,0] op_sel_hi:[0,1] neg_lo:[0,0] neg_hi:[0,0]
v_pk_fma_f32 v[20:21], v[20:21], v[120:121], v[48:49] op_sel:[1,1,0] op_sel_hi:[1,0,1] neg_lo:[0,1,0] neg_hi:[0,0,0]
v_pk_mul_f32 v[48:49], v[52:53], v[122:123] op_sel:[0,0] op_sel_hi:[0,1] neg_lo:[0,0] neg_hi:[0,0]
v_pk_fma_f32 v[52:53], v[52:53], v[122:123], v[48:49] op_sel:[1,1,0] op_sel_hi:[1,0,1] neg_lo:[0,1,0] neg_hi:[0,0,0]
v_pk_mul_f32 v[48:49], v[36:37], v[124:125] op_sel:[0,0] op_sel_hi:[0,1] neg_lo:[0,0] neg_hi:[0,0]
v_pk_fma_f32 v[36:37], v[36:37], v[124:125], v[48:49] op_sel:[1,1,0] op_sel_hi:[1,0,1] neg_lo:[0,1,0] neg_hi:[0,0,0]
v_pk_mul_f32 v[48:49], v[68:69], v[126:127] op_sel:[0,0] op_sel_hi:[0,1] neg_lo:[0,0] neg_hi:[0,0]
v_pk_fma_f32 v[68:69], v[68:69], v[126:127], v[48:49] op_sel:[1,1,0] op_sel_hi:[1,0,1] neg_lo:[0,1,0] neg_hi:[0,0,0]
v_pk_mul_f32 v[48:49], v[18:19], v[128:129] op_sel:[0,0] op_sel_hi:[0,1] neg_lo:[0,0] neg_hi:[0,0]
v_pk_fma_f32 v[18:19], v[18:19], v[128:129], v[48:49] op_sel:[1,1,0] op_sel_hi:[1,0,1] neg_lo:[0,1,0] neg_hi:[0,0,0]
v_pk_mul_f32 v[48:49], v[50:51], v[130:131] op_sel:[0,0] op_sel_hi:[0,1] neg_lo:[0,0] neg_hi:[0,0]
v_pk_fma_f32 v[50:51], v[50:51], v[130:131], v[48:49] op_sel:[1,1,0] op_sel_hi:[1,0,1] neg_lo:[0,1,0] neg_hi:[0,0,0]
v_pk_mul_f32 v[48:49], v[34:35], v[132:133] op_sel:[0,0] op_sel_hi:[0,1] neg_lo:[0,0] neg_hi:[0,0]
v_pk_fma_f32 v[34:35], v[34:35], v[132:133], v[48:49] op_sel:[1,1,0] op_sel_hi:[1,0,1] neg_lo:[0,1,0] neg_hi:[0,0,0]
v_pk_mul_f32 v[48:49], v[66:67], v[134:135] op_sel:[0,0] op_sel_hi:[0,1] neg_lo:[0,0] neg_hi:[0,0]
v_pk_fma_f32 v[66:67], v[66:67], v[134:135], v[48:49] op_sel:[1,1,0] op_sel_hi:[1,0,1] neg_lo:[0,1,0] neg_hi:[0,0,0]
v_pk_mul_f32 v[48:49], v[26:27], v[136:137] op_sel:[0,0] op_sel_hi:[0,1] neg_lo:[0,0] neg_hi:[0,0]
v_pk_fma_f32 v[26:27], v[26:27], v[136:137], v[48:49] op_sel:[1,1,0] op_sel_hi:[1,0,1] neg_lo:[0,1,0] neg_hi:[0,0,0]
v_pk_mul_f32 v[48:49], v[58:59], v[138:139] op_sel:[0,0] op_sel_hi:[0,1] neg_lo:[0,0] neg_hi:[0,0]
v_pk_fma_f32 v[58:59], v[58:59], v[138:139], v[48:49] op_sel:[1,1,0] op_sel_hi:[1,0,1] neg_lo:[0,1,0] neg_hi:[0,0,0]
v_pk_mul_f32 v[48:49], v[42:43], v[140:141] op_sel:[0,0] op_sel_hi:[0,1] neg_lo:[0,0] neg_hi:[0,0]
v_pk_fma_f32 v[42:43], v[42:43], v[140:141], v[48:49] op_sel:[1,1,0] op_sel_hi:[1,0,1] neg_lo:[0,1,0] neg_hi:[0,0,0]
v_pk_mul_f32 v[48:49], v[74:75], v[142:143] op_sel:[0,0] op_sel_hi:[0,1] neg_lo:[0,0] neg_hi:[0,0]
v_pk_fma_f32 v[74:75], v[74:75], v[142:143], v[48:49] op_sel:[1,1,0] op_sel_hi:[1,0,1] neg_lo:[0,1,0] neg_hi:[0,0,0]
ds_write_b64 v4, v[16:17] offset:0
ds_write_b64 v4, v[14:15] offset:264
ds_write_b64 v4, v[64:65] offset:528
ds_write_b64 v4, v[40:41] offset:792
ds_write_b64 v4, v[72:73] offset:1056
ds_write_b64 v4, v[44:45] offset:1320
ds_write_b64 v4, v[28:29] offset:1584
ds_write_b64 v4, v[60:61] offset:1848
ds_write_b64 v4, v[76:77] offset:2112
ds_write_b64 v4, v[46:47] offset:2376
ds_write_b64 v4, v[30:31] offset:2640
ds_write_b64 v4, v[62:63] offset:2904
ds_write_b64 v4, v[22:23] offset:3168
ds_write_b64 v4, v[54:55] offset:3432
ds_write_b64 v4, v[38:39] offset:3696
ds_write_b64 v4, v[70:71] offset:3960
ds_write_b64 v4, v[78:79] offset:4224
ds_write_b64 v4, v[32:33] offset:4488
ds_write_b64 v4, v[24:25] offset:4752
ds_write_b64 v4, v[56:57] offset:5016
ds_write_b64 v4, v[20:21] offset:5280
ds_write_b64 v4, v[52:53] offset:5544
ds_write_b64 v4, v[36:37] offset:5808
ds_write_b64 v4, v[68:69] offset:6072
ds_write_b64 v4, v[18:19] offset:6336
ds_write_b64 v4, v[50:51] offset:6600
ds_write_b64 v4, v[34:35] offset:6864
ds_write_b64 v4, v[66:67] offset:7128
ds_write_b64 v4, v[26:27] offset:7392
ds_write_b64 v4, v[58:59] offset:7656
ds_write_b64 v4, v[42:43] offset:7920
ds_write_b64 v4, v[74:75] offset:8184
s_waitcnt lgkmcnt(0)
ds_read_b64 v[16:17], v5 offset:0
ds_read_b64 v[48:49], v5 offset:128
ds_read_b64 v[18:19], v5 offset:8
ds_read_b64 v[50:51], v5 offset:136
ds_read_b64 v[20:21], v5 offset:16
ds_read_b64 v[52:53], v5 offset:144
ds_read_b64 v[22:23], v5 offset:24
ds_read_b64 v[54:55], v5 offset:152
ds_read_b64 v[24:25], v5 offset:32
ds_read_b64 v[56:57], v5 offset:160
ds_read_b64 v[26:27], v5 offset:40
ds_read_b64 v[58:59], v5 offset:168
ds_read_b64 v[28:29], v5 offset:48
ds_read_b64 v[60:61], v5 offset:176
ds_read_b64 v[30:31], v5 offset:56
ds_read_b64 v[62:63], v5 offset:184
ds_read_b64 v[32:33], v5 offset:64
ds_read_b64 v[64:65], v5 offset:192
ds_read_b64 v[34:35], v5 offset:72
ds_read_b64 v[66:67], v5 offset:200
ds_read_b64 v[36:37], v5 offset:80
ds_read_b64 v[68:69], v5 offset:208
ds_read_b64 v[38:39], v5 offset:88
ds_read_b64 v[70:71], v5 offset:216
ds_read_b64 v[40:41], v5 offset:96
ds_read_b64 v[72:73], v5 offset:224
ds_read_b64 v[42:43], v5 offset:104
ds_read_b64 v[74:75], v5 offset:232
ds_read_b64 v[44:45], v5 offset:112
ds_read_b64 v[76:77], v5 offset:240
ds_read_b64 v[46:47], v5 offset:120
ds_read_b64 v[78:79], v5 offset:248
s_waitcnt lgkmcnt(0)
v_pk_add_f32 v[14:15], v[16:17], v[48:49] neg_lo:[0,1] neg_hi:[0,1]
v_pk_add_f32 v[16:17], v[16:17], v[48:49]
v_pk_add_f32 v[48:49], v[18:19], v[50:51] neg_lo:[0,1] neg_hi:[0,1]
v_pk_add_f32 v[18:19], v[18:19], v[50:51]
v_pk_mul_f32 v[50:51], v[48:49], s[50:51] op_sel:[0,0] op_sel_hi:[0,1] neg_lo:[0,0] neg_hi:[0,0]
v_pk_fma_f32 v[50:51], v[48:49], s[50:51], v[50:51] op_sel:[1,1,0] op_sel_hi:[1,0,1] neg_lo:[0,1,0] neg_hi:[0,0,0]
v_pk_add_f32 v[48:49], v[20:21], v[52:53] neg_lo:[0,1] neg_hi:[0,1]
v_pk_add_f32 v[20:21], v[20:21], v[52:53]
v_pk_mul_f32 v[52:53], v[48:49], s[54:55] op_sel:[0,0] op_sel_hi:[0,1] neg_lo:[0,0] neg_hi:[0,0]
v_pk_fma_f32 v[52:53], v[48:49], s[54:55], v[52:53] op_sel:[1,1,0] op_sel_hi:[1,0,1] neg_lo:[0,1,0] neg_hi:[0,0,0]
v_pk_add_f32 v[48:49], v[22:23], v[54:55] neg_lo:[0,1] neg_hi:[0,1]
v_pk_add_f32 v[22:23], v[22:23], v[54:55]
v_pk_mul_f32 v[54:55], v[48:49], s[58:59] op_sel:[0,0] op_sel_hi:[0,1] neg_lo:[0,0] neg_hi:[0,0]
v_pk_fma_f32 v[54:55], v[48:49], s[58:59], v[54:55] op_sel:[1,1,0] op_sel_hi:[1,0,1] neg_lo:[0,1,0] neg_hi:[0,0,0]
v_pk_add_f32 v[48:49], v[24:25], v[56:57] neg_lo:[0,1] neg_hi:[0,1]
v_pk_add_f32 v[24:25], v[24:25], v[56:57]
v_pk_mul_f32 v[56:57], v[48:49], s[62:63] op_sel:[0,0] op_sel_hi:[0,1] neg_lo:[0,0] neg_hi:[0,0]
v_pk_fma_f32 v[56:57], v[48:49], s[62:63], v[56:57] op_sel:[1,1,0] op_sel_hi:[1,0,1] neg_lo:[0,1,0] neg_hi:[0,0,0]
v_pk_add_f32 v[48:49], v[26:27], v[58:59] neg_lo:[0,1] neg_hi:[0,1]
v_pk_add_f32 v[26:27], v[26:27], v[58:59]
v_pk_mul_f32 v[58:59], v[48:49], s[58:59] op_sel:[0,1] op_sel_hi:[0,0] neg_lo:[0,0] neg_hi:[0,0]
v_pk_fma_f32 v[58:59], v[48:49], s[58:59], v[58:59] op_sel:[1,0,0] op_sel_hi:[1,1,1] neg_lo:[0,1,0] neg_hi:[0,0,0]
v_pk_add_f32 v[48:49], v[28:29], v[60:61] neg_lo:[0,1] neg_hi:[0,1]
v_pk_add_f32 v[28:29], v[28:29], v[60:61]
v_pk_mul_f32 v[60:61], v[48:49], s[54:55] op_sel:[0,1] op_sel_hi:[0,0] neg_lo:[0,0] neg_hi:[0,0]
v_pk_fma_f32 v[60:61], v[48:49], s[54:55], v[60:61] op_sel:[1,0,0] op_sel_hi:[1,1,1] neg_lo:[0,1,0] neg_hi:[0,0,0]
v_pk_add_f32 v[48:49], v[30:31], v[62:63] neg_lo:[0,1] neg_hi:[0,1]
v_pk_add_f32 v[30:31], v[30:31], v[62:63]
v_pk_mul_f32 v[62:63], v[48:49], s[50:51] op_sel:[0,1] op_sel_hi:[0,0] neg_lo:[0,0] neg_hi:[0,0]
v_pk_fma_f32 v[62:63], v[48:49], s[50:51], v[62:63] op_sel:[1,0,0] op_sel_hi:[1,1,1] neg_lo:[0,1,0] neg_hi:[0,0,0]
v_pk_add_f32 v[48:49], v[32:33], v[64:65] op_sel:[1,1] op_sel_hi:[0,0] neg_lo:[1,0] neg_hi:[0,1]
v_pk_add_f32 v[32:33], v[32:33], v[64:65]
v_pk_add_f32 v[64:65], v[34:35], v[66:67] neg_lo:[0,1] neg_hi:[0,1]
v_pk_add_f32 v[34:35], v[34:35], v[66:67]
v_pk_mul_f32 v[66:67], v[64:65], s[50:51] op_sel:[0,1] op_sel_hi:[0,0] neg_lo:[0,1] neg_hi:[0,0]
v_pk_fma_f32 v[66:67], v[64:65], s[50:51], v[66:67] op_sel:[1,0,0] op_sel_hi:[1,1,1] neg_lo:[0,1,0] neg_hi:[0,1,0]
v_pk_add_f32 v[64:65], v[36:37], v[68:69] neg_lo:[0,1] neg_hi:[0,1]
v_pk_add_f32 v[36:37], v[36:37], v[68:69]
v_pk_mul_f32 v[68:69], v[64:65], s[54:55] op_sel:[0,1] op_sel_hi:[0,0] neg_lo:[0,1] neg_hi:[0,0]
v_pk_fma_f32 v[68:69], v[64:65], s[54:55], v[68:69] op_sel:[1,0,0] op_sel_hi:[1,1,1] neg_lo:[0,1,0] neg_hi:[0,1,0]
v_pk_add_f32 v[64:65], v[38:39], v[70:71] neg_lo:[0,1] neg_hi:[0,1]
v_pk_add_f32 v[38:39], v[38:39], v[70:71]
v_pk_mul_f32 v[70:71], v[64:65], s[58:59] op_sel:[0,1] op_sel_hi:[0,0] neg_lo:[0,1] neg_hi:[0,0]
v_pk_fma_f32 v[70:71], v[64:65], s[58:59], v[70:71] op_sel:[1,0,0] op_sel_hi:[1,1,1] neg_lo:[0,1,0] neg_hi:[0,1,0]
v_pk_add_f32 v[64:65], v[40:41], v[72:73] neg_lo:[0,1] neg_hi:[0,1]
v_pk_add_f32 v[40:41], v[40:41], v[72:73]
v_pk_mul_f32 v[72:73], v[64:65], s[62:63] op_sel:[0,0] op_sel_hi:[0,1] neg_lo:[0,1] neg_hi:[0,0]
v_pk_fma_f32 v[72:73], v[64:65], s[62:63], v[72:73] op_sel:[1,1,0] op_sel_hi:[1,0,1] neg_lo:[0,1,0] neg_hi:[0,1,0]
v_pk_add_f32 v[64:65], v[42:43], v[74:75] neg_lo:[0,1] neg_hi:[0,1]
v_pk_add_f32 v[42:43], v[42:43], v[74:75]
v_pk_mul_f32 v[74:75], v[64:65], s[58:59] op_sel:[0,0] op_sel_hi:[0,1] neg_lo:[0,1] neg_hi:[0,0]
v_pk_fma_f32 v[74:75], v[64:65], s[58:59], v[74:75] op_sel:[1,1,0] op_sel_hi:[1,0,1] neg_lo:[0,1,0] neg_hi:[0,1,0]
v_pk_add_f32 v[64:65], v[44:45], v[76:77] neg_lo:[0,1] neg_hi:[0,1]
v_pk_add_f32 v[44:45], v[44:45], v[76:77]
v_pk_mul_f32 v[76:77], v[64:65], s[54:55] op_sel:[0,0] op_sel_hi:[0,1] neg_lo:[0,1] neg_hi:[0,0]
v_pk_fma_f32 v[76:77], v[64:65], s[54:55], v[76:77] op_sel:[1,1,0] op_sel_hi:[1,0,1] neg_lo:[0,1,0] neg_hi:[0,1,0]
v_pk_add_f32 v[64:65], v[46:47], v[78:79] neg_lo:[0,1] neg_hi:[0,1]
v_pk_add_f32 v[46:47], v[46:47], v[78:79]
v_pk_mul_f32 v[78:79], v[64:65], s[50:51] op_sel:[0,0] op_sel_hi:[0,1] neg_lo:[0,1] neg_hi:[0,0]
v_pk_fma_f32 v[78:79], v[64:65], s[50:51], v[78:79] op_sel:[1,1,0] op_sel_hi:[1,0,1] neg_lo:[0,1,0] neg_hi:[0,1,0]
v_pk_add_f32 v[64:65], v[16:17], v[32:33] neg_lo:[0,1] neg_hi:[0,1]
v_pk_add_f32 v[16:17], v[16:17], v[32:33]
v_pk_add_f32 v[32:33], v[18:19], v[34:35] neg_lo:[0,1] neg_hi:[0,1]
v_pk_add_f32 v[18:19], v[18:19], v[34:35]
v_pk_mul_f32 v[34:35], v[32:33], s[54:55] op_sel:[0,0] op_sel_hi:[0,1] neg_lo:[0,0] neg_hi:[0,0]
v_pk_fma_f32 v[34:35], v[32:33], s[54:55], v[34:35] op_sel:[1,1,0] op_sel_hi:[1,0,1] neg_lo:[0,1,0] neg_hi:[0,0,0]
v_pk_add_f32 v[32:33], v[20:21], v[36:37] neg_lo:[0,1] neg_hi:[0,1]
v_pk_add_f32 v[20:21], v[20:21], v[36:37]
v_pk_mul_f32 v[36:37], v[32:33], s[62:63] op_sel:[0,0] op_sel_hi:[0,1] neg_lo:[0,0] neg_hi:[0,0]
v_pk_fma_f32 v[36:37], v[32:33], s[62:63], v[36:37] op_sel:[1,1,0] op_sel_hi:[1,0,1] neg_lo:[0,1,0] neg_hi:[0,0,0]
v_pk_add_f32 v[32:33], v[22:23], v[38:39] neg_lo:[0,1] neg_hi:[0,1]
v_pk_add_f32 v[22:23], v[22:23], v[38:39]
v_pk_mul_f32 v[38:39], v[32:33], s[54:55] op_sel:[0,1] op_sel_hi:[0,0] neg_lo:[0,0] neg_hi:[0,0]
v_pk_fma_f32 v[38:39], v[32:33], s[54:55], v[38:39] op_sel:[1,0,0] op_sel_hi:[1,1,1] neg_lo:[0,1,0] neg_hi:[0,0,0]
v_pk_add_f32 v[32:33], v[24:25], v[40:41] op_sel:[1,1] op_sel_hi:[0,0] neg_lo:[1,0] neg_hi:[0,1]
v_pk_add_f32 v[24:25], v[24:25], v[40:41]
v_pk_add_f32 v[40:41], v[26:27], v[42:43] neg_lo:[0,1] neg_hi:[0,1]
v_pk_add_f32 v[26:27], v[26:27], v[42:43]
v_pk_mul_f32 v[42:43], v[40:41], s[54:55] op_sel:[0,1] op_sel_hi:[0,0] neg_lo:[0,1] neg_hi:[0,0]
v_pk_fma_f32 v[42:43], v[40:41], s[54:55], v[42:43] op_sel:[1,0,0] op_sel_hi:[1,1,1] neg_lo:[0,1,0] neg_hi:[0,1,0]
v_pk_add_f32 v[40:41], v[28:29], v[44:45] neg_lo:[0,1] neg_hi:[0,1]
v_pk_add_f32 v[28:29], v[28:29], v[44:45]
v_pk_mul_f32 v[44:45], v[40:41], s[62:63] op_sel:[0,0] op_sel_hi:[0,1] neg_lo:[0,1] neg_hi:[0,0]
v_pk_fma_f32 v[44:45], v[40:41], s[62:63], v[44:45] op_sel:[1,1,0] op_sel_hi:[1,0,1] neg_lo:[0,1,0] neg_hi:[0,1,0]
v_pk_add_f32 v[40:41], v[30:31], v[46:47] neg_lo:[0,1] neg_hi:[0,1]
v_pk_add_f32 v[30:31], v[30:31], v[46:47]
v_pk_mul_f32 v[46:47], v[40:41], s[54:55] op_sel:[0,0] op_sel_hi:[0,1] neg_lo:[0,1] neg_hi:[0,0]
v_pk_fma_f32 v[46:47], v[40:41], s[54:55], v[46:47] op_sel:[1,1,0] op_sel_hi:[1,0,1] neg_lo:[0,1,0] neg_hi:[0,1,0]
v_pk_add_f32 v[40:41], v[14:15], v[48:49] neg_lo:[0,1] neg_hi:[0,1]
v_pk_add_f32 v[14:15], v[14:15], v[48:49]
v_pk_add_f32 v[48:49], v[50:51], v[66:67] neg_lo:[0,1] neg_hi:[0,1]
v_pk_add_f32 v[50:51], v[50:51], v[66:67]
v_pk_mul_f32 v[66:67], v[48:49], s[54:55] op_sel:[0,0] op_sel_hi:[0,1] neg_lo:[0,0] neg_hi:[0,0]
v_pk_fma_f32 v[66:67], v[48:49], s[54:55], v[66:67] op_sel:[1,1,0] op_sel_hi:[1,0,1] neg_lo:[0,1,0] neg_hi:[0,0,0]
v_pk_add_f32 v[48:49], v[52:53], v[68:69] neg_lo:[0,1] neg_hi:[0,1]
v_pk_add_f32 v[52:53], v[52:53], v[68:69]
v_pk_mul_f32 v[68:69], v[48:49], s[62:63] op_sel:[0,0] op_sel_hi:[0,1] neg_lo:[0,0] neg_hi:[0,0]
v_pk_fma_f32 v[68:69], v[48:49], s[62:63], v[68:69] op_sel:[1,1,0] op_sel_hi:[1,0,1] neg_lo:[0,1,0] neg_hi:[0,0,0]
v_pk_add_f32 v[48:49], v[54:55], v[70:71] neg_lo:[0,1] neg_hi:[0,1]
v_pk_add_f32 v[54:55], v[54:55], v[70:71]
v_pk_mul_f32 v[70:71], v[48:49], s[54:55] op_sel:[0,1] op_sel_hi:[0,0] neg_lo:[0,0] neg_hi:[0,0]
v_pk_fma_f32 v[70:71], v[48:49], s[54:55], v[70:71] op_sel:[1,0,0] op_sel_hi:[1,1,1] neg_lo:[0,1,0] neg_hi:[0,0,0]
v_pk_add_f32 v[48:49], v[56:57], v[72:73] op_sel:[1,1] op_sel_hi:[0,0] neg_lo:[1,0] neg_hi:[0,1]
v_pk_add_f32 v[56:57], v[56:57], v[72:73]
v_pk_add_f32 v[72:73], v[58:59], v[74:75] neg_lo:[0,1] neg_hi:[0,1]
v_pk_add_f32 v[58:59], v[58:59], v[74:75]
v_pk_mul_f32 v[74:75], v[72:73], s[54:55] op_sel:[0,1] op_sel_hi:[0,0] neg_lo:[0,1] neg_hi:[0,0]
v_pk_fma_f32 v[74:75], v[72:73], s[54:55], v[74:75] op_sel:[1,0,0] op_sel_hi:[1,1,1] neg_lo:[0,1,0] neg_hi:[0,1,0]
v_pk_add_f32 v[72:73], v[60:61], v[76:77] neg_lo:[0,1] neg_hi:[0,1]
v_pk_add_f32 v[60:61], v[60:61], v[76:77]
v_pk_mul_f32 v[76:77], v[72:73], s[62:63] op_sel:[0,0] op_sel_hi:[0,1] neg_lo:[0,1] neg_hi:[0,0]
v_pk_fma_f32 v[76:77], v[72:73], s[62:63], v[76:77] op_sel:[1,1,0] op_sel_hi:[1,0,1] neg_lo:[0,1,0] neg_hi:[0,1,0]
v_pk_add_f32 v[72:73], v[62:63], v[78:79] neg_lo:[0,1] neg_hi:[0,1]
v_pk_add_f32 v[62:63], v[62:63], v[78:79]
v_pk_mul_f32 v[78:79], v[72:73], s[54:55] op_sel:[0,0] op_sel_hi:[0,1] neg_lo:[0,1] neg_hi:[0,0]
v_pk_fma_f32 v[78:79], v[72:73], s[54:55], v[78:79] op_sel:[1,1,0] op_sel_hi:[1,0,1] neg_lo:[0,1,0] neg_hi:[0,1,0]
v_pk_add_f32 v[72:73], v[16:17], v[24:25] neg_lo:[0,1] neg_hi:[0,1]
v_pk_add_f32 v[16:17], v[16:17], v[24:25]
v_pk_add_f32 v[24:25], v[18:19], v[26:27] neg_lo:[0,1] neg_hi:[0,1]
v_pk_add_f32 v[18:19], v[18:19], v[26:27]
v_pk_mul_f32 v[26:27], v[24:25], s[62:63] op_sel:[0,0] op_sel_hi:[0,1] neg_lo:[0,0] neg_hi:[0,0]
v_pk_fma_f32 v[26:27], v[24:25], s[62:63], v[26:27] op_sel:[1,1,0] op_sel_hi:[1,0,1] neg_lo:[0,1,0] neg_hi:[0,0,0]
v_pk_add_f32 v[24:25], v[20:21], v[28:29] op_sel:[1,1] op_sel_hi:[0,0] neg_lo:[1,0] neg_hi:[0,1]
v_pk_add_f32 v[20:21], v[20:21], v[28:29]
v_pk_add_f32 v[28:29], v[22:23], v[30:31] neg_lo:[0,1] neg_hi:[0,1]
v_pk_add_f32 v[22:23], v[22:23], v[30:31]
v_pk_mul_f32 v[30:31], v[28:29], s[62:63] op_sel:[0,0] op_sel_hi:[0,1] neg_lo:[0,1] neg_hi:[0,0]
v_pk_fma_f32 v[30:31], v[28:29], s[62:63], v[30:31] op_sel:[1,1,0] op_sel_hi:[1,0,1] neg_lo:[0,1,0] neg_hi:[0,1,0]
v_pk_add_f32 v[28:29], v[64:65], v[32:33] neg_lo:[0,1] neg_hi:[0,1]
v_pk_add_f32 v[64:65], v[64:65], v[32:33]
v_pk_add_f32 v[32:33], v[34:35], v[42:43] neg_lo:[0,1] neg_hi:[0,1]
v_pk_add_f32 v[34:35], v[34:35], v[42:43]
v_pk_mul_f32 v[42:43], v[32:33], s[62:63] op_sel:[0,0] op_sel_hi:[0,1] neg_lo:[0,0] neg_hi:[0,0]
v_pk_fma_f32 v[42:43], v[32:33], s[62:63], v[42:43] op_sel:[1,1,0] op_sel_hi:[1,0,1] neg_lo:[0,1,0] neg_hi:[0,0,0]
v_pk_add_f32 v[32:33], v[36:37], v[44:45] op_sel:[1,1] op_sel_hi:[0,0] neg_lo:[1,0] neg_hi:[0,1]
v_pk_add_f32 v[36:37], v[36:37], v[44:45]
v_pk_add_f32 v[44:45], v[38:39], v[46:47] neg_lo:[0,1] neg_hi:[0,1]
v_pk_add_f32 v[38:39], v[38:39], v[46:47]
v_pk_mul_f32 v[46:47], v[44:45], s[62:63] op_sel:[0,0] op_sel_hi:[0,1] neg_lo:[0,1] neg_hi:[0,0]
v_pk_fma_f32 v[46:47], v[44:45], s[62:63], v[46:47] op_sel:[1,1,0] op_sel_hi:[1,0,1] neg_lo:[0,1,0] neg_hi:[0,1,0]
v_pk_add_f32 v[44:45], v[14:15], v[56:57] neg_lo:[0,1] neg_hi:[0,1]
v_pk_add_f32 v[14:15], v[14:15], v[56:57]
v_pk_add_f32 v[56:57], v[50:51], v[58:59] neg_lo:[0,1] neg_hi:[0,1]
v_pk_add_f32 v[50:51], v[50:51], v[58:59]
v_pk_mul_f32 v[58:59], v[56:57], s[62:63] op_sel:[0,0] op_sel_hi:[0,1] neg_lo:[0,0] neg_hi:[0,0]
v_pk_fma_f32 v[58:59], v[56:57], s[62:63], v[58:59] op_sel:[1,1,0] op_sel_hi:[1,0,1] neg_lo:[0,1,0] neg_hi:[0,0,0]
v_pk_add_f32 v[56:57], v[52:53], v[60:61] op_sel:[1,1] op_sel_hi:[0,0] neg_lo:[1,0] neg_hi:[0,1]
v_pk_add_f32 v[52:53], v[52:53], v[60:61]
v_pk_add_f32 v[60:61], v[54:55], v[62:63] neg_lo:[0,1] neg_hi:[0,1]
v_pk_add_f32 v[54:55], v[54:55], v[62:63]
v_pk_mul_f32 v[62:63], v[60:61], s[62:63] op_sel:[0,0] op_sel_hi:[0,1] neg_lo:[0,1] neg_hi:[0,0]
v_pk_fma_f32 v[62:63], v[60:61], s[62:63], v[62:63] op_sel:[1,1,0] op_sel_hi:[1,0,1] neg_lo:[0,1,0] neg_hi:[0,1,0]
v_pk_add_f32 v[60:61], v[40:41], v[48:49] neg_lo:[0,1] neg_hi:[0,1]
v_pk_add_f32 v[40:41], v[40:41], v[48:49]
v_pk_add_f32 v[48:49], v[66:67], v[74:75] neg_lo:[0,1] neg_hi:[0,1]
v_pk_add_f32 v[66:67], v[66:67], v[74:75]
v_pk_mul_f32 v[74:75], v[48:49], s[62:63] op_sel:[0,0] op_sel_hi:[0,1] neg_lo:[0,0] neg_hi:[0,0]
v_pk_fma_f32 v[74:75], v[48:49], s[62:63], v[74:75] op_sel:[1,1,0] op_sel_hi:[1,0,1] neg_lo:[0,1,0] neg_hi:[0,0,0]
v_pk_add_f32 v[48:49], v[68:69], v[76:77] op_sel:[1,1] op_sel_hi:[0,0] neg_lo:[1,0] neg_hi:[0,1]
v_pk_add_f32 v[68:69], v[68:69], v[76:77]
v_pk_add_f32 v[76:77], v[70:71], v[78:79] neg_lo:[0,1] neg_hi:[0,1]
v_pk_add_f32 v[70:71], v[70:71], v[78:79]
v_pk_mul_f32 v[78:79], v[76:77], s[62:63] op_sel:[0,0] op_sel_hi:[0,1] neg_lo:[0,1] neg_hi:[0,0]
v_pk_fma_f32 v[78:79], v[76:77], s[62:63], v[78:79] op_sel:[1,1,0] op_sel_hi:[1,0,1] neg_lo:[0,1,0] neg_hi:[0,1,0]
v_pk_add_f32 v[76:77], v[16:17], v[20:21] neg_lo:[0,1] neg_hi:[0,1]
v_pk_add_f32 v[16:17], v[16:17], v[20:21]
v_pk_add_f32 v[20:21], v[18:19], v[22:23] op_sel:[1,1] op_sel_hi:[0,0] neg_lo:[1,0] neg_hi:[0,1]
v_pk_add_f32 v[18:19], v[18:19], v[22:23]
v_pk_add_f32 v[22:23], v[72:73], v[24:25] neg_lo:[0,1] neg_hi:[0,1]
v_pk_add_f32 v[72:73], v[72:73], v[24:25]
v_pk_add_f32 v[24:25], v[26:27], v[30:31] op_sel:[1,1] op_sel_hi:[0,0] neg_lo:[1,0] neg_hi:[0,1]
v_pk_add_f32 v[26:27], v[26:27], v[30:31]
v_pk_add_f32 v[30:31], v[64:65], v[36:37] neg_lo:[0,1] neg_hi:[0,1]
v_pk_add_f32 v[64:65], v[64:65], v[36:37]
v_pk_add_f32 v[36:37], v[34:35], v[38:39] op_sel:[1,1] op_sel_hi:[0,0] neg_lo:[1,0] neg_hi:[0,1]
v_pk_add_f32 v[34:35], v[34:35], v[38:39]
v_pk_add_f32 v[38:39], v[28:29], v[32:33] neg_lo:[0,1] neg_hi:[0,1]
v_pk_add_f32 v[28:29], v[28:29], v[32:33]
v_pk_add_f32 v[32:33], v[42:43], v[46:47] op_sel:[1,1] op_sel_hi:[0,0] neg_lo:[1,0] neg_hi:[0,1]
v_pk_add_f32 v[42:43], v[42:43], v[46:47]
v_pk_add_f32 v[46:47], v[14:15], v[52:53] neg_lo:[0,1] neg_hi:[0,1]
v_pk_add_f32 v[14:15], v[14:15], v[52:53]
v_pk_add_f32 v[52:53], v[50:51], v[54:55] op_sel:[1,1] op_sel_hi:[0,0] neg_lo:[1,0] neg_hi:[0,1]
v_pk_add_f32 v[50:51], v[50:51], v[54:55]
v_pk_add_f32 v[54:55], v[44:45], v[56:57] neg_lo:[0,1] neg_hi:[0,1]
v_pk_add_f32 v[44:45], v[44:45], v[56:57]
v_pk_add_f32 v[56:57], v[58:59], v[62:63] op_sel:[1,1] op_sel_hi:[0,0] neg_lo:[1,0] neg_hi:[0,1]
v_pk_add_f32 v[58:59], v[58:59], v[62:63]
v_pk_add_f32 v[62:63], v[40:41], v[68:69] neg_lo:[0,1] neg_hi:[0,1]
v_pk_add_f32 v[40:41], v[40:41], v[68:69]
v_pk_add_f32 v[68:69], v[66:67], v[70:71] op_sel:[1,1] op_sel_hi:[0,0] neg_lo:[1,0] neg_hi:[0,1]
v_pk_add_f32 v[66:67], v[66:67], v[70:71]
v_pk_add_f32 v[70:71], v[60:61], v[48:49] neg_lo:[0,1] neg_hi:[0,1]
v_pk_add_f32 v[60:61], v[60:61], v[48:49]
v_pk_add_f32 v[48:49], v[74:75], v[78:79] op_sel:[1,1] op_sel_hi:[0,0] neg_lo:[1,0] neg_hi:[0,1]
v_pk_add_f32 v[74:75], v[74:75], v[78:79]
v_pk_add_f32 v[78:79], v[16:17], v[18:19] neg_lo:[0,1] neg_hi:[0,1]
v_pk_add_f32 v[16:17], v[16:17], v[18:19]
v_pk_add_f32 v[18:19], v[76:77], v[20:21] neg_lo:[0,1] neg_hi:[0,1]
v_pk_add_f32 v[76:77], v[76:77], v[20:21]
v_pk_add_f32 v[20:21], v[72:73], v[26:27] neg_lo:[0,1] neg_hi:[0,1]
v_pk_add_f32 v[72:73], v[72:73], v[26:27]
v_pk_add_f32 v[26:27], v[22:23], v[24:25] neg_lo:[0,1] neg_hi:[0,1]
v_pk_add_f32 v[22:23], v[22:23], v[24:25]
v_pk_add_f32 v[24:25], v[64:65], v[34:35] neg_lo:[0,1] neg_hi:[0,1]
v_pk_add_f32 v[64:65], v[64:65], v[34:35]
v_pk_add_f32 v[34:35], v[30:31], v[36:37] neg_lo:[0,1] neg_hi:[0,1]
v_pk_add_f32 v[30:31], v[30:31], v[36:37]
v_pk_add_f32 v[36:37], v[28:29], v[42:43] neg_lo:[0,1] neg_hi:[0,1]
v_pk_add_f32 v[28:29], v[28:29], v[42:43]
v_pk_add_f32 v[42:43], v[38:39], v[32:33] neg_lo:[0,1] neg_hi:[0,1]
v_pk_add_f32 v[38:39], v[38:39], v[32:33]
v_pk_add_f32 v[32:33], v[14:15], v[50:51] neg_lo:[0,1] neg_hi:[0,1]
v_pk_add_f32 v[14:15], v[14:15], v[50:51]
v_pk_add_f32 v[50:51], v[46:47], v[52:53] neg_lo:[0,1] neg_hi:[0,1]
v_pk_add_f32 v[46:47], v[46:47], v[52:53]
v_pk_add_f32 v[52:53], v[44:45], v[58:59] neg_lo:[0,1] neg_hi:[0,1]
v_pk_add_f32 v[44:45], v[44:45], v[58:59]
v_pk_add_f32 v[58:59], v[54:55], v[56:57] neg_lo:[0,1] neg_hi:[0,1]
v_pk_add_f32 v[54:55], v[54:55], v[56:57]
v_pk_add_f32 v[56:57], v[40:41], v[66:67] neg_lo:[0,1] neg_hi:[0,1]
v_pk_add_f32 v[40:41], v[40:41], v[66:67]
v_pk_add_f32 v[66:67], v[62:63], v[68:69] neg_lo:[0,1] neg_hi:[0,1]
v_pk_add_f32 v[62:63], v[62:63], v[68:69]
v_pk_add_f32 v[68:69], v[60:61], v[74:75] neg_lo:[0,1] neg_hi:[0,1]
v_pk_add_f32 v[60:61], v[60:61], v[74:75]
v_pk_add_f32 v[74:75], v[70:71], v[48:49] neg_lo:[0,1] neg_hi:[0,1]
v_pk_add_f32 v[70:71], v[70:71], v[48:49]
ds_write2st64_b32 v12, v16, v17 offset0:0 offset1:16
ds_write_b32 v12, v14 offset:128
ds_write_b32 v12, v15 offset:4224
ds_write_b32 v12, v64 offset:256
ds_write_b32 v12, v65 offset:4352
ds_write_b32 v12, v40 offset:384
ds_write_b32 v12, v41 offset:4480
ds_write_b32 v12, v72 offset:512
ds_write_b32 v12, v73 offset:4608
ds_write_b32 v12, v44 offset:640
ds_write_b32 v12, v45 offset:4736
ds_write_b32 v12, v28 offset:768
ds_write_b32 v12, v29 offset:4864
ds_write_b32 v12, v60 offset:896
ds_write_b32 v12, v61 offset:4992
ds_write_b32 v12, v76 offset:1024
ds_write_b32 v12, v77 offset:5120
ds_write_b32 v12, v46 offset:1152
ds_write_b32 v12, v47 offset:5248
ds_write_b32 v12, v30 offset:1280
ds_write_b32 v12, v31 offset:5376
ds_write_b32 v12, v62 offset:1408
ds_write_b32 v12, v63 offset:5504
ds_write_b32 v12, v22 offset:1536
ds_write_b32 v12, v23 offset:5632
ds_write_b32 v12, v54 offset:1664
ds_write_b32 v12, v55 offset:5760
ds_write_b32 v12, v38 offset:1792
ds_write_b32 v12, v39 offset:5888
ds_write_b32 v12, v70 offset:1920
ds_write_b32 v12, v71 offset:6016
ds_write_b32 v12, v78 offset:2048
ds_write_b32 v12, v79 offset:6144
ds_write_b32 v12, v32 offset:2176
ds_write_b32 v12, v33 offset:6272
ds_write_b32 v12, v24 offset:2304
ds_write_b32 v12, v25 offset:6400
ds_write_b32 v12, v56 offset:2432
ds_write_b32 v12, v57 offset:6528
ds_write_b32 v12, v20 offset:2560
ds_write_b32 v12, v21 offset:6656
ds_write_b32 v12, v52 offset:2688
ds_write_b32 v12, v53 offset:6784
ds_write_b32 v12, v36 offset:2816
ds_write_b32 v12, v37 offset:6912
ds_write_b32 v12, v68 offset:2944
ds_write_b32 v12, v69 offset:7040
ds_write_b32 v12, v18 offset:3072
ds_write_b32 v12, v19 offset:7168
ds_write_b32 v12, v50 offset:3200
ds_write_b32 v12, v51 offset:7296
ds_write_b32 v12, v34 offset:3328
ds_write_b32 v12, v35 offset:7424
ds_write_b32 v12, v66 offset:3456
ds_write_b32 v12, v67 offset:7552
ds_write_b32 v12, v26 offset:3584
ds_write_b32 v12, v27 offset:7680
ds_write_b32 v12, v58 offset:3712
ds_write_b32 v12, v59 offset:7808
ds_write_b32 v12, v42 offset:3840
ds_write_b32 v12, v43 offset:7936
ds_write_b32 v12, v74 offset:3968
ds_write_b32 v12, v75 offset:8064
s_waitcnt lgkmcnt(0)
s_barrier
s_lshl_b32 s13, s93, 16
ds_read_b128 v[16:19], v2 offset:0
ds_read_b128 v[20:23], v2 offset:16
ds_read_b128 v[24:27], v2 offset:8448
ds_read_b128 v[28:31], v2 offset:8464
ds_read_b128 v[32:35], v2 offset:16896
ds_read_b128 v[36:39], v2 offset:16912
ds_read_b128 v[40:43], v2 offset:25344
ds_read_b128 v[44:47], v2 offset:25360
ds_read_b128 v[48:51], v2 offset:33792
ds_read_b128 v[52:55], v2 offset:33808
ds_read_b128 v[56:59], v2 offset:42240
ds_read_b128 v[60:63], v2 offset:42256
ds_read_b128 v[64:67], v2 offset:50688
ds_read_b128 v[68:71], v2 offset:50704
s_waitcnt lgkmcnt(12)
ds_read_b128 v[72:75], v2 offset:59136
ds_read_b128 v[76:79], v2 offset:59152
s_waitcnt lgkmcnt(14)
v_cvt_pk_bf16_f32 v216, v16, v17
v_cvt_pk_bf16_f32 v217, v18, v19
v_cvt_pk_bf16_f32 v218, v20, v21
v_cvt_pk_bf16_f32 v219, v22, v23
buffer_store_dwordx4 v[216:219], v3, s[4:7], s13 offen sc1
s_add_u32 s13, s13, 8192
s_waitcnt lgkmcnt(12)
v_cvt_pk_bf16_f32 v220, v24, v25
v_cvt_pk_bf16_f32 v221, v26, v27
v_cvt_pk_bf16_f32 v222, v28, v29
v_cvt_pk_bf16_f32 v223, v30, v31
buffer_store_dwordx4 v[220:223], v3, s[4:7], s13 offen sc1
s_add_u32 s13, s13, 8192
s_waitcnt lgkmcnt(10)
v_cvt_pk_bf16_f32 v224, v32, v33
v_cvt_pk_bf16_f32 v225, v34, v35
v_cvt_pk_bf16_f32 v226, v36, v37
v_cvt_pk_bf16_f32 v227, v38, v39
buffer_store_dwordx4 v[224:227], v3, s[4:7], s13 offen sc1
s_add_u32 s13, s13, 8192
s_waitcnt lgkmcnt(8)
v_cvt_pk_bf16_f32 v228, v40, v41
v_cvt_pk_bf16_f32 v229, v42, v43
v_cvt_pk_bf16_f32 v230, v44, v45
v_cvt_pk_bf16_f32 v231, v46, v47
buffer_store_dwordx4 v[228:231], v3, s[4:7], s13 offen sc1
s_add_u32 s13, s13, 8192
s_waitcnt lgkmcnt(6)
v_cvt_pk_bf16_f32 v232, v48, v49
v_cvt_pk_bf16_f32 v233, v50, v51
v_cvt_pk_bf16_f32 v234, v52, v53
v_cvt_pk_bf16_f32 v235, v54, v55
buffer_store_dwordx4 v[232:235], v3, s[4:7], s13 offen sc1
s_add_u32 s13, s13, 8192
s_waitcnt lgkmcnt(4)
v_cvt_pk_bf16_f32 v236, v56, v57
v_cvt_pk_bf16_f32 v237, v58, v59
v_cvt_pk_bf16_f32 v238, v60, v61
v_cvt_pk_bf16_f32 v239, v62, v63
buffer_store_dwordx4 v[236:239], v3, s[4:7], s13 offen sc1
s_add_u32 s13, s13, 8192
s_waitcnt lgkmcnt(2)
v_cvt_pk_bf16_f32 v240, v64, v65
v_cvt_pk_bf16_f32 v241, v66, v67
v_cvt_pk_bf16_f32 v242, v68, v69
v_cvt_pk_bf16_f32 v243, v70, v71
buffer_store_dwordx4 v[240:243], v3, s[4:7], s13 offen sc1
s_add_u32 s13, s13, 8192
s_waitcnt lgkmcnt(0)
v_cvt_pk_bf16_f32 v244, v72, v73
v_cvt_pk_bf16_f32 v245, v74, v75
v_cvt_pk_bf16_f32 v246, v76, v77
v_cvt_pk_bf16_f32 v247, v78, v79
buffer_store_dwordx4 v[244:247], v3, s[4:7], s13 offen sc1
s_add_u32 s13, s13, 8192
s_mov_b32 s93, s21
s_cmp_lt_u32 s93, 128
s_cbranch_scc1 mega_kernel_f3_l
mega_kernel_f3_e:
s_waitcnt vmcnt(0)
s_barrier
s_add_u32 s64, s91, 58
s_mov_b32 s65, 64
s_mov_b32 s67, 1
s_add_u32 s66, s66, 262144
s_cmp_eq_u32 s91, 0
s_cbranch_scc1 mega_kernel_out
s_lshr_b32 s66, s40, 2
s_lshl_b32 s66, s66, 16
s_and_b32 s76, s40, 3
s_lshl_b32 s76, s76, 13
s_add_u32 s66, s66, s76
s_add_u32 s66, s66, 67141632
mega_kernel_out:
s_load_dwordx2 s[4:5], s[0:1], 40
s_load_dwordx2 s[8:9], s[0:1], 80
v_lshrrev_b32 v2, 6, v0
v_and_b32 v1, 63, v0
v_readfirstlane_b32 s41, v2
v_lshlrev_b32 v5, 4, v1
s_waitcnt lgkmcnt(0)
s_mov_b32 s6, 8388608
s_mov_b32 s7, 0x00020000
s_mov_b32 s10, 8388608
s_mov_b32 s11, 0x00020000
s_and_b32 s58, s40, 1
s_lshr_b32 s59, s40, 1
s_lshl_b32 s43, s58, 22
s_lshl_b32 s44, s41, 20
s_add_u32 s43, s43, s44
s_lshl_b32 s44, s59, 7
s_add_u32 s48, s43, s44
s_and_b32 s56, s59, 7
s_lshl_b32 s56, s56, 6
s_cmp_eq_u32 s68, 2
s_cbranch_scc1 mega_kernel_o_hw
v_lshrrev_b32 v2, 3, v1
v_and_b32 v3, 7, v1
v_lshlrev_b32 v16, 11, v2
v_lshl_add_u32 v16, v3, 4, v16
v_add_u32 v16, s48, v16
v_and_b32 v3, 3, v1
s_lshl_b32 s45, s41, 15
v_bfe_u32 v17, v1, 2, 2
v_lshrrev_b32 v18, 5, v1
v_mul_u32_u24 v18, 4, v18
v_add_u32 v17, v17, v18
v_lshlrev_b32 v17, 7, v17
v_bfe_u32 v18, v1, 4, 1
v_lshl_add_u32 v17, v18, 5, v17
v_lshl_add_u32 v17, v3, 3, v17
v_add_u32 v17, s45, v17
s_add_u32 m0, s45, 0
s_add_u32 s44, s56, 0
s_and_b32 s44, s44, 511
s_lshl_b32 s44, s44, 11
buffer_load_dwordx4 v16, s[4:7], s44 offen lds
s_add_u32 m0, s45, 1024
s_add_u32 s44, s56, 8
s_and_b32 s44, s44, 511
s_lshl_b32 s44, s44, 11
buffer_load_dwordx4 v16, s[4:7], s44 offen lds
s_add_u32 m0, s45, 2048
s_add_u32 s44, s56, 16
s_and_b32 s44, s44, 511
s_lshl_b32 s44, s44, 11
buffer_load_dwordx4 v16, s[4:7], s44 offen lds
s_add_u32 m0, s45, 3072
s_add_u32 s44, s56, 24
s_and_b32 s44, s44, 511
s_lshl_b32 s44, s44, 11
buffer_load_dwordx4 v16, s[4:7], s44 offen lds
s_add_u32 m0, s45, 4096
s_add_u32 s44, s56, 32
s_and_b32 s44, s44, 511
s_lshl_b32 s44, s44, 11
buffer_load_dwordx4 v16, s[4:7], s44 offen lds
s_add_u32 m0, s45, 5120
s_add_u32 s44, s56, 40
s_and_b32 s44, s44, 511
s_lshl_b32 s44, s44, 11
buffer_load_dwordx4 v16, s[4:7], s44 offen lds
s_add_u32 m0, s45, 6144
s_add_u32 s44, s56, 48
s_and_b32 s44, s44, 511
s_lshl_b32 s44, s44, 11
buffer_load_dwordx4 v16, s[4:7], s44 offen lds
s_add_u32 m0, s45, 7168
s_add_u32 s44, s56, 56
s_and_b32 s44, s44, 511
s_lshl_b32 s44, s44, 11
buffer_load_dwordx4 v16, s[4:7], s44 offen lds
s_add_u32 m0, s45, 8192
s_add_u32 s44, s56, 64
s_and_b32 s44, s44, 511
s_lshl_b32 s44, s44, 11
buffer_load_dwordx4 v16, s[4:7], s44 offen lds
s_add_u32 m0, s45, 9216
s_add_u32 s44, s56, 72
s_and_b32 s44, s44, 511
s_lshl_b32 s44, s44, 11
buffer_load_dwordx4 v16, s[4:7], s44 offen lds
s_add_u32 m0, s45, 10240
s_add_u32 s44, s56, 80
s_and_b32 s44, s44, 511
s_lshl_b32 s44, s44, 11
buffer_load_dwordx4 v16, s[4:7], s44 offen lds
s_add_u32 m0, s45, 11264
s_add_u32 s44, s56, 88
s_and_b32 s44, s44, 511
s_lshl_b32 s44, s44, 11
buffer_load_dwordx4 v16, s[4:7], s44 offen lds
s_add_u32 m0, s45, 12288
s_add_u32 s44, s56, 96
s_and_b32 s44, s44, 511
s_lshl_b32 s44, s44, 11
buffer_load_dwordx4 v16, s[4:7], s44 offen lds
s_add_u32 m0, s45, 13312
s_add_u32 s44, s56, 104
s_and_b32 s44, s44, 511
s_lshl_b32 s44, s44, 11
buffer_load_dwordx4 v16, s[4:7], s44 offen lds
s_add_u32 m0, s45, 14336
s_add_u32 s44, s56, 112
s_and_b32 s44, s44, 511
s_lshl_b32 s44, s44, 11
buffer_load_dwordx4 v16, s[4:7], s44 offen lds
s_add_u32 m0, s45, 15360
s_add_u32 s44, s56, 120
s_and_b32 s44, s44, 511
s_lshl_b32 s44, s44, 11
buffer_load_dwordx4 v16, s[4:7], s44 offen lds
s_add_u32 m0, s45, 16384
s_add_u32 s44, s56, 128
s_and_b32 s44, s44, 511
s_lshl_b32 s44, s44, 11
buffer_load_dwordx4 v16, s[4:7], s44 offen lds
s_add_u32 m0, s45, 17408
s_add_u32 s44, s56, 136
s_and_b32 s44, s44, 511
s_lshl_b32 s44, s44, 11
buffer_load_dwordx4 v16, s[4:7], s44 offen lds
s_add_u32 m0, s45, 18432
s_add_u32 s44, s56, 144
s_and_b32 s44, s44, 511
s_lshl_b32 s44, s44, 11
buffer_load_dwordx4 v16, s[4:7], s44 offen lds
s_add_u32 m0, s45, 19456
s_add_u32 s44, s56, 152
s_and_b32 s44, s44, 511
s_lshl_b32 s44, s44, 11
buffer_load_dwordx4 v16, s[4:7], s44 offen lds
s_add_u32 m0, s45, 20480
s_add_u32 s44, s56, 160
s_and_b32 s44, s44, 511
s_lshl_b32 s44, s44, 11
buffer_load_dwordx4 v16, s[4:7], s44 offen lds
s_add_u32 m0, s45, 21504
s_add_u32 s44, s56, 168
s_and_b32 s44, s44, 511
s_lshl_b32 s44, s44, 11
buffer_load_dwordx4 v16, s[4:7], s44 offen lds
s_add_u32 m0, s45, 22528
s_add_u32 s44, s56, 176
s_and_b32 s44, s44, 511
s_lshl_b32 s44, s44, 11
buffer_load_dwordx4 v16, s[4:7], s44 offen lds
s_add_u32 m0, s45, 23552
s_add_u32 s44, s56, 184
s_and_b32 s44, s44, 511
s_lshl_b32 s44, s44, 11
buffer_load_dwordx4 v16, s[4:7], s44 offen lds
s_add_u32 m0, s45, 24576
s_add_u32 s44, s56, 192
s_and_b32 s44, s44, 511
s_lshl_b32 s44, s44, 11
buffer_load_dwordx4 v16, s[4:7], s44 offen lds
s_add_u32 m0, s45, 25600
s_add_u32 s44, s56, 200
s_and_b32 s44, s44, 511
s_lshl_b32 s44, s44, 11
buffer_load_dwordx4 v16, s[4:7], s44 offen lds
s_add_u32 m0, s45, 26624
s_add_u32 s44, s56, 208
s_and_b32 s44, s44, 511
s_lshl_b32 s44, s44, 11
buffer_load_dwordx4 v16, s[4:7], s44 offen lds
s_add_u32 m0, s45, 27648
s_add_u32 s44, s56, 216
s_and_b32 s44, s44, 511
s_lshl_b32 s44, s44, 11
buffer_load_dwordx4 v16, s[4:7], s44 offen lds
s_add_u32 m0, s45, 28672
s_add_u32 s44, s56, 224
s_and_b32 s44, s44, 511
s_lshl_b32 s44, s44, 11
buffer_load_dwordx4 v16, s[4:7], s44 offen lds
s_add_u32 m0, s45, 29696
s_add_u32 s44, s56, 232
s_and_b32 s44, s44, 511
s_lshl_b32 s44, s44, 11
buffer_load_dwordx4 v16, s[4:7], s44 offen lds
s_add_u32 m0, s45, 30720
s_add_u32 s44, s56, 240
s_and_b32 s44, s44, 511
s_lshl_b32 s44, s44, 11
buffer_load_dwordx4 v16, s[4:7], s44 offen lds
s_add_u32 m0, s45, 31744
s_add_u32 s44, s56, 248
s_and_b32 s44, s44, 511
s_lshl_b32 s44, s44, 11
buffer_load_dwordx4 v16, s[4:7], s44 offen lds
s_waitcnt vmcnt(16)
ds_read_b64_tr_b16 a[0:1], v17 offset:0
ds_read_b64_tr_b16 a[2:3], v17 offset:2048
ds_read_b64_tr_b16 a[4:5], v17 offset:64
ds_read_b64_tr_b16 a[6:7], v17 offset:2112
ds_read_b64_tr_b16 a[8:9], v17 offset:1024
ds_read_b64_tr_b16 a[10:11], v17 offset:3072
ds_read_b64_tr_b16 a[12:13], v17 offset:1088
ds_read_b64_tr_b16 a[14:15], v17 offset:3136
s_waitcnt lgkmcnt(0)
ds_read_b64_tr_b16 a[16:17], v17 offset:4096
ds_read_b64_tr_b16 a[18:19], v17 offset:6144
ds_read_b64_tr_b16 a[20:21], v17 offset:4160
ds_read_b64_tr_b16 a[22:23], v17 offset:6208
ds_read_b64_tr_b16 a[24:25], v17 offset:5120
ds_read_b64_tr_b16 a[26:27], v17 offset:7168
ds_read_b64_tr_b16 a[28:29], v17 offset:5184
ds_read_b64_tr_b16 a[30:31], v17 offset:7232
s_waitcnt lgkmcnt(0)
ds_read_b64_tr_b16 a[32:33], v17 offset:8192
ds_read_b64_tr_b16 a[34:35], v17 offset:10240
ds_read_b64_tr_b16 a[36:37], v17 offset:8256
ds_read_b64_tr_b16 a[38:39], v17 offset:10304
ds_read_b64_tr_b16 a[40:41], v17 offset:9216
ds_read_b64_tr_b16 a[42:43], v17 offset:11264
ds_read_b64_tr_b16 a[44:45], v17 offset:9280
ds_read_b64_tr_b16 a[46:47], v17 offset:11328
s_waitcnt lgkmcnt(0)
ds_read_b64_tr_b16 a[48:49], v17 offset:12288
ds_read_b64_tr_b16 a[50:51], v17 offset:14336
ds_read_b64_tr_b16 a[52:53], v17 offset:12352
ds_read_b64_tr_b16 a[54:55], v17 offset:14400
ds_read_b64_tr_b16 a[56:57], v17 offset:13312
ds_read_b64_tr_b16 a[58:59], v17 offset:15360
ds_read_b64_tr_b16 a[60:61], v17 offset:13376
ds_read_b64_tr_b16 a[62:63], v17 offset:15424
s_waitcnt lgkmcnt(0)
s_add_u32 m0, s45, 0
s_add_u32 s44, s56, 256
s_and_b32 s44, s44, 511
s_lshl_b32 s44, s44, 11
buffer_load_dwordx4 v16, s[4:7], s44 offen lds
s_add_u32 m0, s45, 1024
s_add_u32 s44, s56, 264
s_and_b32 s44, s44, 511
s_lshl_b32 s44, s44, 11
buffer_load_dwordx4 v16, s[4:7], s44 offen lds
s_add_u32 m0, s45, 2048
s_add_u32 s44, s56, 272
s_and_b32 s44, s44, 511
s_lshl_b32 s44, s44, 11
buffer_load_dwordx4 v16, s[4:7], s44 offen lds
s_add_u32 m0, s45, 3072
s_add_u32 s44, s56, 280
s_and_b32 s44, s44, 511
s_lshl_b32 s44, s44, 11
buffer_load_dwordx4 v16, s[4:7], s44 offen lds
s_add_u32 m0, s45, 4096
s_add_u32 s44, s56, 288
s_and_b32 s44, s44, 511
s_lshl_b32 s44, s44, 11
buffer_load_dwordx4 v16, s[4:7], s44 offen lds
s_add_u32 m0, s45, 5120
s_add_u32 s44, s56, 296
s_and_b32 s44, s44, 511
s_lshl_b32 s44, s44, 11
buffer_load_dwordx4 v16, s[4:7], s44 offen lds
s_add_u32 m0, s45, 6144
s_add_u32 s44, s56, 304
s_and_b32 s44, s44, 511
s_lshl_b32 s44, s44, 11
buffer_load_dwordx4 v16, s[4:7], s44 offen lds
s_add_u32 m0, s45, 7168
s_add_u32 s44, s56, 312
s_and_b32 s44, s44, 511
s_lshl_b32 s44, s44, 11
buffer_load_dwordx4 v16, s[4:7], s44 offen lds
s_add_u32 m0, s45, 8192
s_add_u32 s44, s56, 320
s_and_b32 s44, s44, 511
s_lshl_b32 s44, s44, 11
buffer_load_dwordx4 v16, s[4:7], s44 offen lds
s_add_u32 m0, s45, 9216
s_add_u32 s44, s56, 328
s_and_b32 s44, s44, 511
s_lshl_b32 s44, s44, 11
buffer_load_dwordx4 v16, s[4:7], s44 offen lds
s_add_u32 m0, s45, 10240
s_add_u32 s44, s56, 336
s_and_b32 s44, s44, 511
s_lshl_b32 s44, s44, 11
buffer_load_dwordx4 v16, s[4:7], s44 offen lds
s_add_u32 m0, s45, 11264
s_add_u32 s44, s56, 344
s_and_b32 s44, s44, 511
s_lshl_b32 s44, s44, 11
buffer_load_dwordx4 v16, s[4:7], s44 offen lds
s_add_u32 m0, s45, 12288
s_add_u32 s44, s56, 352
s_and_b32 s44, s44, 511
s_lshl_b32 s44, s44, 11
buffer_load_dwordx4 v16, s[4:7], s44 offen lds
s_add_u32 m0, s45, 13312
s_add_u32 s44, s56, 360
s_and_b32 s44, s44, 511
s_lshl_b32 s44, s44, 11
buffer_load_dwordx4 v16, s[4:7], s44 offen lds
s_add_u32 m0, s45, 14336
s_add_u32 s44, s56, 368
s_and_b32 s44, s44, 511
s_lshl_b32 s44, s44, 11
buffer_load_dwordx4 v16, s[4:7], s44 offen lds
s_add_u32 m0, s45, 15360
s_add_u32 s44, s56, 376
s_and_b32 s44, s44, 511
s_lshl_b32 s44, s44, 11
buffer_load_dwordx4 v16, s[4:7], s44 offen lds
s_waitcnt vmcnt(16)
ds_read_b64_tr_b16 a[64:65], v17 offset:16384
ds_read_b64_tr_b16 a[66:67], v17 offset:18432
ds_read_b64_tr_b16 a[68:69], v17 offset:16448
ds_read_b64_tr_b16 a[70:71], v17 offset:18496
ds_read_b64_tr_b16 a[72:73], v17 offset:17408
ds_read_b64_tr_b16 a[74:75], v17 offset:19456
ds_read_b64_tr_b16 a[76:77], v17 offset:17472
ds_read_b64_tr_b16 a[78:79], v17 offset:19520
s_waitcnt lgkmcnt(0)
ds_read_b64_tr_b16 a[80:81], v17 offset:20480
ds_read_b64_tr_b16 a[82:83], v17 offset:22528
ds_read_b64_tr_b16 a[84:85], v17 offset:20544
ds_read_b64_tr_b16 a[86:87], v17 offset:22592
ds_read_b64_tr_b16 a[88:89], v17 offset:21504
ds_read_b64_tr_b16 a[90:91], v17 offset:23552
ds_read_b64_tr_b16 a[92:93], v17 offset:21568
ds_read_b64_tr_b16 a[94:95], v17 offset:23616
s_waitcnt lgkmcnt(0)
ds_read_b64_tr_b16 a[96:97], v17 offset:24576
ds_read_b64_tr_b16 a[98:99], v17 offset:26624
ds_read_b64_tr_b16 a[100:101], v17 offset:24640
ds_read_b64_tr_b16 a[102:103], v17 offset:26688
ds_read_b64_tr_b16 a[104:105], v17 offset:25600
ds_read_b64_tr_b16 a[106:107], v17 offset:27648
ds_read_b64_tr_b16 a[108:109], v17 offset:25664
ds_read_b64_tr_b16 a[110:111], v17 offset:27712
s_waitcnt lgkmcnt(0)
ds_read_b64_tr_b16 a[112:113], v17 offset:28672
ds_read_b64_tr_b16 a[114:115], v17 offset:30720
ds_read_b64_tr_b16 a[116:117], v17 offset:28736
ds_read_b64_tr_b16 a[118:119], v17 offset:30784
ds_read_b64_tr_b16 a[120:121], v17 offset:29696
ds_read_b64_tr_b16 a[122:123], v17 offset:31744
ds_read_b64_tr_b16 a[124:125], v17 offset:29760
ds_read_b64_tr_b16 a[126:127], v17 offset:31808
s_waitcnt lgkmcnt(0)
s_add_u32 m0, s45, 16384
s_add_u32 s44, s56, 384
s_and_b32 s44, s44, 511
s_lshl_b32 s44, s44, 11
buffer_load_dwordx4 v16, s[4:7], s44 offen lds
s_add_u32 m0, s45, 17408
s_add_u32 s44, s56, 392
s_and_b32 s44, s44, 511
s_lshl_b32 s44, s44, 11
buffer_load_dwordx4 v16, s[4:7], s44 offen lds
s_add_u32 m0, s45, 18432
s_add_u32 s44, s56, 400
s_and_b32 s44, s44, 511
s_lshl_b32 s44, s44, 11
buffer_load_dwordx4 v16, s[4:7], s44 offen lds
s_add_u32 m0, s45, 19456
s_add_u32 s44, s56, 408
s_and_b32 s44, s44, 511
s_lshl_b32 s44, s44, 11
buffer_load_dwordx4 v16, s[4:7], s44 offen lds
s_add_u32 m0, s45, 20480
s_add_u32 s44, s56, 416
s_and_b32 s44, s44, 511
s_lshl_b32 s44, s44, 11
buffer_load_dwordx4 v16, s[4:7], s44 offen lds
s_add_u32 m0, s45, 21504
s_add_u32 s44, s56, 424
s_and_b32 s44, s44, 511
s_lshl_b32 s44, s44, 11
buffer_load_dwordx4 v16, s[4:7], s44 offen lds
s_add_u32 m0, s45, 22528
s_add_u32 s44, s56, 432
s_and_b32 s44, s44, 511
s_lshl_b32 s44, s44, 11
buffer_load_dwordx4 v16, s[4:7], s44 offen lds
s_add_u32 m0, s45, 23552
s_add_u32 s44, s56, 440
s_and_b32 s44, s44, 511
s_lshl_b32 s44, s44, 11
buffer_load_dwordx4 v16, s[4:7], s44 offen lds
s_add_u32 m0, s45, 24576
s_add_u32 s44, s56, 448
s_and_b32 s44, s44, 511
s_lshl_b32 s44, s44, 11
buffer_load_dwordx4 v16, s[4:7], s44 offen lds
s_add_u32 m0, s45, 25600
s_add_u32 s44, s56, 456
s_and_b32 s44, s44, 511
s_lshl_b32 s44, s44, 11
buffer_load_dwordx4 v16, s[4:7], s44 offen lds
s_add_u32 m0, s45, 26624
s_add_u32 s44, s56, 464
s_and_b32 s44, s44, 511
s_lshl_b32 s44, s44, 11
buffer_load_dwordx4 v16, s[4:7], s44 offen lds
s_add_u32 m0, s45, 27648
s_add_u32 s44, s56, 472
s_and_b32 s44, s44, 511
s_lshl_b32 s44, s44, 11
buffer_load_dwordx4 v16, s[4:7], s44 offen lds
s_add_u32 m0, s45, 28672
s_add_u32 s44, s56, 480
s_and_b32 s44, s44, 511
s_lshl_b32 s44, s44, 11
buffer_load_dwordx4 v16, s[4:7], s44 offen lds
s_add_u32 m0, s45, 29696
s_add_u32 s44, s56, 488
s_and_b32 s44, s44, 511
s_lshl_b32 s44, s44, 11
buffer_load_dwordx4 v16, s[4:7], s44 offen lds
s_add_u32 m0, s45, 30720
s_add_u32 s44, s56, 496
s_and_b32 s44, s44, 511
s_lshl_b32 s44, s44, 11
buffer_load_dwordx4 v16, s[4:7], s44 offen lds
s_add_u32 m0, s45, 31744
s_add_u32 s44, s56, 504
s_and_b32 s44, s44, 511
s_lshl_b32 s44, s44, 11
buffer_load_dwordx4 v16, s[4:7], s44 offen lds
s_waitcnt vmcnt(16)
ds_read_b64_tr_b16 a[128:129], v17 offset:0
ds_read_b64_tr_b16 a[130:131], v17 offset:2048
ds_read_b64_tr_b16 a[132:133], v17 offset:64
ds_read_b64_tr_b16 a[134:135], v17 offset:2112
ds_read_b64_tr_b16 a[136:137], v17 offset:1024
ds_read_b64_tr_b16 a[138:139], v17 offset:3072
ds_read_b64_tr_b16 a[140:141], v17 offset:1088
ds_read_b64_tr_b16 a[142:143], v17 offset:3136
s_waitcnt lgkmcnt(0)
ds_read_b64_tr_b16 a[144:145], v17 offset:4096
ds_read_b64_tr_b16 a[146:147], v17 offset:6144
ds_read_b64_tr_b16 a[148:149], v17 offset:4160
ds_read_b64_tr_b16 a[150:151], v17 offset:6208
ds_read_b64_tr_b16 a[152:153], v17 offset:5120
ds_read_b64_tr_b16 a[154:155], v17 offset:7168
ds_read_b64_tr_b16 a[156:157], v17 offset:5184
ds_read_b64_tr_b16 a[158:159], v17 offset:7232
s_waitcnt lgkmcnt(0)
ds_read_b64_tr_b16 a[160:161], v17 offset:8192
ds_read_b64_tr_b16 a[162:163], v17 offset:10240
ds_read_b64_tr_b16 a[164:165], v17 offset:8256
ds_read_b64_tr_b16 a[166:167], v17 offset:10304
ds_read_b64_tr_b16 a[168:169], v17 offset:9216
ds_read_b64_tr_b16 a[170:171], v17 offset:11264
ds_read_b64_tr_b16 a[172:173], v17 offset:9280
ds_read_b64_tr_b16 a[174:175], v17 offset:11328
s_waitcnt lgkmcnt(0)
ds_read_b64_tr_b16 a[176:177], v17 offset:12288
ds_read_b64_tr_b16 a[178:179], v17 offset:14336
ds_read_b64_tr_b16 a[180:181], v17 offset:12352
ds_read_b64_tr_b16 a[182:183], v17 offset:14400
ds_read_b64_tr_b16 a[184:185], v17 offset:13312
ds_read_b64_tr_b16 a[186:187], v17 offset:15360
ds_read_b64_tr_b16 a[188:189], v17 offset:13376
ds_read_b64_tr_b16 a[190:191], v17 offset:15424
s_waitcnt lgkmcnt(0)
s_waitcnt vmcnt(0)
ds_read_b64_tr_b16 a[192:193], v17 offset:16384
ds_read_b64_tr_b16 a[194:195], v17 offset:18432
ds_read_b64_tr_b16 a[196:197], v17 offset:16448
ds_read_b64_tr_b16 a[198:199], v17 offset:18496
ds_read_b64_tr_b16 a[200:201], v17 offset:17408
ds_read_b64_tr_b16 a[202:203], v17 offset:19456
ds_read_b64_tr_b16 a[204:205], v17 offset:17472
ds_read_b64_tr_b16 a[206:207], v17 offset:19520
s_waitcnt lgkmcnt(0)
ds_read_b64_tr_b16 a[208:209], v17 offset:20480
ds_read_b64_tr_b16 a[210:211], v17 offset:22528
ds_read_b64_tr_b16 a[212:213], v17 offset:20544
ds_read_b64_tr_b16 a[214:215], v17 offset:22592
ds_read_b64_tr_b16 a[216:217], v17 offset:21504
ds_read_b64_tr_b16 a[218:219], v17 offset:23552
ds_read_b64_tr_b16 a[220:221], v17 offset:21568
ds_read_b64_tr_b16 a[222:223], v17 offset:23616
s_waitcnt lgkmcnt(0)
ds_read_b64_tr_b16 a[224:225], v17 offset:24576
ds_read_b64_tr_b16 a[226:227], v17 offset:26624
ds_read_b64_tr_b16 a[228:229], v17 offset:24640
ds_read_b64_tr_b16 a[230:231], v17 offset:26688
ds_read_b64_tr_b16 a[232:233], v17 offset:25600
ds_read_b64_tr_b16 a[234:235], v17 offset:27648
ds_read_b64_tr_b16 a[236:237], v17 offset:25664
ds_read_b64_tr_b16 a[238:239], v17 offset:27712
s_waitcnt lgkmcnt(0)
ds_read_b64_tr_b16 a[240:241], v17 offset:28672
ds_read_b64_tr_b16 a[242:243], v17 offset:30720
ds_read_b64_tr_b16 a[244:245], v17 offset:28736
ds_read_b64_tr_b16 a[246:247], v17 offset:30784
ds_read_b64_tr_b16 a[248:249], v17 offset:29696
ds_read_b64_tr_b16 a[250:251], v17 offset:31744
ds_read_b64_tr_b16 a[252:253], v17 offset:29760
ds_read_b64_tr_b16 a[254:255], v17 offset:31808
s_waitcnt lgkmcnt(0)
s_barrier
s_cmp_eq_u32 s68, 1
s_cbranch_scc1 mega_kernel_back
mega_kernel_o_hw:
s_lshl_b32 s56, s56, 6
s_lshl_b32 s43, s58, 18
s_lshl_b32 s44, s41, 16
s_add_u32 s43, s43, s44
s_add_u32 s43, s43, 134217728
v_add_u32 v6, s43, v5
v_and_b32 v2, 3, v1
v_lshlrev_b32 v7, 2, v2
v_bfe_u32 v2, v1, 2, 2
v_lshl_add_u32 v7, v2, 7, v7
s_lshl_b32 s43, s58, 11
s_lshl_b32 s44, s41, 9
s_add_u32 s43, s43, s44
s_lshl_b32 s44, s98, 13
s_add_u32 s43, s43, s44
s_add_u32 s43, s43, 69255168
v_add_u32 v7, s43, v7
s_mul_i32 s43, s41, 8704
v_lshrrev_b32 v2, 5, v1
v_lshl_add_u32 v8, v2, 5, v5
v_add_u32 v8, s43, v8
v_and_b32 v2, 7, v1
v_mul_u32_u24 v9, 544, v2
v_lshrrev_b32 v3, 3, v1
v_lshl_add_u32 v9, v3, 4, v9
s_lshl_b32 s43, s41, 7
v_add_u32 v9, s43, v9
s_mul_i32 s43, s58, 4352
s_sub_u32 s44, 4352, s43
v_add_u32 v10, s44, v9
v_add_u32 v9, s43, v9
s_lshl_b32 s43, s41, 15
s_lshl_b32 s44, s40, 6
s_add_u32 s43, s43, s44
v_lshlrev_b32 v11, 12, v3
v_and_b32 v2, 7, v1
v_lshl_add_u32 v11, v2, 3, v11
v_add_u32 v11, s43, v11
s_lshl_b32 s44, s41, 10
s_add_u32 s43, s66, s44
v_add_u32 v13, s43, v5
v_xor_b32 v12, 8192, v13
s_lshl_b32 s71, 1, s67
s_mov_b32 s42, s64
s_mov_b32 s52, 0
s_mov_b32 s53, 0
s_mov_b32 s57, 0
mega_kernel_o_cold:
s_cmp_gt_i32 s52, s42
s_cbranch_scc1 mega_kernel_o_fk
mega_kernel_o_fw:
buffer_load_dword v2, v7, s[84:87], 0 offen sc1
s_waitcnt vmcnt(0)
v_min_i32_dpp v2, v2, v2 quad_perm:[1,0,3,2] row_mask:0xf bank_mask:0xf
s_nop 1
v_min_i32_dpp v2, v2, v2 quad_perm:[2,3,0,1] row_mask:0xf bank_mask:0xf
s_nop 1
v_min_i32_dpp v2, v2, v2 row_ror:4 row_mask:0xf bank_mask:0xf
s_nop 1
v_min_i32_dpp v2, v2, v2 row_ror:8 row_mask:0xf bank_mask:0xf
s_nop 0
v_readfirstlane_b32 s52, v2
s_min_i32 s52, s52, s65
s_cmp_gt_i32 s52, s42
s_cbranch_scc1 mega_kernel_o_fk
s_sleep 2
s_add_u32 s43, s52, 2
s_cmp_gt_i32 s43, s42
s_cbranch_scc1 mega_kernel_o_fw
s_sleep 48
s_branch mega_kernel_o_fw
mega_kernel_o_fk:
s_add_u32 s54, s42, s71
s_cmp_gt_i32 s52, s54
s_cbranch_scc0 mega_kernel_o_c0
s_lshr_b32 s63, s42, 2
s_xnor_b32 s63, s63, s98
s_and_b32 s63, s63, 1
s_lshl_b32 s63, s63, 13
s_lshl_b32 s50, s42, 19
s_add_u32 s50, s50, s63
s_add_u32 s51, s56, 0
s_and_b32 s51, s51, 0x7fff
s_and_b32 s63, s51, 0x6000
s_add_u32 s51, s51, s63
s_add_u32 s51, s51, s50
buffer_load_dwordx4 v[96:99], v6, s[84:87], s51 offen offset:0 sc1
buffer_load_dwordx4 v[100:103], v6, s[84:87], s51 offen offset:1024 sc1
buffer_load_dwordx4 v[104:107], v6, s[84:87], s51 offen offset:2048 sc1
buffer_load_dwordx4 v[108:111], v6, s[84:87], s51 offen offset:3072 sc1
s_add_u32 s51, s56, 4096
s_and_b32 s51, s51, 0x7fff
s_and_b32 s63, s51, 0x6000
s_add_u32 s51, s51, s63
s_add_u32 s51, s51, s50
buffer_load_dwordx4 v[112:115], v6, s[84:87], s51 offen offset:0 sc1
buffer_load_dwordx4 v[116:119], v6, s[84:87], s51 offen offset:1024 sc1
buffer_load_dwordx4 v[120:123], v6, s[84:87], s51 offen offset:2048 sc1
buffer_load_dwordx4 v[124:127], v6, s[84:87], s51 offen offset:3072 sc1
s_add_u32 s51, s56, 8192
s_and_b32 s51, s51, 0x7fff
s_and_b32 s63, s51, 0x6000
s_add_u32 s51, s51, s63
s_add_u32 s51, s51, s50
buffer_load_dwordx4 v[128:131], v6, s[84:87], s51 offen offset:0 sc1
buffer_load_dwordx4 v[132:135], v6, s[84:87], s51 offen offset:1024 sc1
buffer_load_dwordx4 v[136:139], v6, s[84:87], s51 offen offset:2048 sc1
buffer_load_dwordx4 v[140:143], v6, s[84:87], s51 offen offset:3072 sc1
s_add_u32 s51, s56, 12288
s_and_b32 s51, s51, 0x7fff
s_and_b32 s63, s51, 0x6000
s_add_u32 s51, s51, s63
s_add_u32 s51, s51, s50
buffer_load_dwordx4 v[144:147], v6, s[84:87], s51 offen offset:0 sc1
buffer_load_dwordx4 v[148:151], v6, s[84:87], s51 offen offset:1024 sc1
buffer_load_dwordx4 v[152:155], v6, s[84:87], s51 offen offset:2048 sc1
buffer_load_dwordx4 v[156:159], v6, s[84:87], s51 offen offset:3072 sc1
s_add_u32 s51, s56, 16384
s_and_b32 s51, s51, 0x7fff
s_and_b32 s63, s51, 0x6000
s_add_u32 s51, s51, s63
s_add_u32 s51, s51, s50
buffer_load_dwordx4 v[160:163], v6, s[84:87], s51 offen offset:0 sc1
buffer_load_dwordx4 v[164:167], v6, s[84:87], s51 offen offset:1024 sc1
buffer_load_dwordx4 v[168:171], v6, s[84:87], s51 offen offset:2048 sc1
buffer_load_dwordx4 v[172:175], v6, s[84:87], s51 offen offset:3072 sc1
s_add_u32 s51, s56, 20480
s_and_b32 s51, s51, 0x7fff
s_and_b32 s63, s51, 0x6000
s_add_u32 s51, s51, s63
s_add_u32 s51, s51, s50
buffer_load_dwordx4 v[176:179], v6, s[84:87], s51 offen offset:0 sc1
buffer_load_dwordx4 v[180:183], v6, s[84:87], s51 offen offset:1024 sc1
buffer_load_dwordx4 v[184:187], v6, s[84:87], s51 offen offset:2048 sc1
buffer_load_dwordx4 v[188:191], v6, s[84:87], s51 offen offset:3072 sc1
s_add_u32 s51, s56, 24576
s_and_b32 s51, s51, 0x7fff
s_and_b32 s63, s51, 0x6000
s_add_u32 s51, s51, s63
s_add_u32 s51, s51, s50
buffer_load_dwordx4 v[192:195], v6, s[84:87], s51 offen offset:0 sc1
buffer_load_dwordx4 v[196:199], v6, s[84:87], s51 offen offset:1024 sc1
buffer_load_dwordx4 v[200:203], v6, s[84:87], s51 offen offset:2048 sc1
buffer_load_dwordx4 v[204:207], v6, s[84:87], s51 offen offset:3072 sc1
s_add_u32 s51, s56, 28672
s_and_b32 s51, s51, 0x7fff
s_and_b32 s63, s51, 0x6000
s_add_u32 s51, s51, s63
s_add_u32 s51, s51, s50
buffer_load_dwordx4 v[208:211], v6, s[84:87], s51 offen offset:0 sc1
buffer_load_dwordx4 v[212:215], v6, s[84:87], s51 offen offset:1024 sc1
buffer_load_dwordx4 v[216:219], v6, s[84:87], s51 offen offset:2048 sc1
buffer_load_dwordx4 v[220:223], v6, s[84:87], s51 offen offset:3072 sc1
mega_kernel_o_w0:
s_add_u32 s54, s42, s71
s_sub_u32 s62, s42, s71
s_lshr_b32 s63, s54, 2
s_xnor_b32 s63, s63, s98
s_and_b32 s63, s63, 1
s_lshl_b32 s63, s63, 13
s_lshl_b32 s50, s54, 19
s_add_u32 s50, s50, s63
s_cmp_gt_i32 s52, s54
s_cbranch_scc0 mega_kernel_o_n0
s_waitcnt vmcnt(31)
v_mfma_f32_32x32x16_bf16 v[20:35], a[0:3], v[96:99], 0
v_mfma_f32_32x32x16_bf16 v[36:51], a[4:7], v[96:99], 0
s_add_u32 s51, s56, 0
s_and_b32 s51, s51, 0x7fff
s_and_b32 s63, s51, 0x6000
s_add_u32 s51, s51, s63
s_add_u32 s51, s51, s50
buffer_load_dwordx4 v[96:99], v6, s[84:87], s51 offen offset:0 sc1
s_waitcnt vmcnt(31)
v_mfma_f32_32x32x16_bf16 v[20:35], a[8:11], v[100:103], v[20:35]
v_mfma_f32_32x32x16_bf16 v[36:51], a[12:15], v[100:103], v[36:51]
buffer_load_dwordx4 v[100:103], v6, s[84:87], s51 offen offset:1024 sc1
s_waitcnt vmcnt(31)
v_mfma_f32_32x32x16_bf16 v[20:35], a[16:19], v[104:107], v[20:35]
v_mfma_f32_32x32x16_bf16 v[36:51], a[20:23], v[104:107], v[36:51]
buffer_load_dwordx4 v[104:107], v6, s[84:87], s51 offen offset:2048 sc1
s_waitcnt vmcnt(31)
v_mfma_f32_32x32x16_bf16 v[20:35], a[24:27], v[108:111], v[20:35]
v_mfma_f32_32x32x16_bf16 v[36:51], a[28:31], v[108:111], v[36:51]
buffer_load_dwordx4 v[108:111], v6, s[84:87], s51 offen offset:3072 sc1
s_waitcnt vmcnt(31)
v_mfma_f32_32x32x16_bf16 v[20:35], a[32:35], v[112:115], v[20:35]
v_mfma_f32_32x32x16_bf16 v[36:51], a[36:39], v[112:115], v[36:51]
s_add_u32 s51, s56, 4096
s_and_b32 s51, s51, 0x7fff
s_and_b32 s63, s51, 0x6000
s_add_u32 s51, s51, s63
s_add_u32 s51, s51, s50
buffer_load_dwordx4 v[112:115], v6, s[84:87], s51 offen offset:0 sc1
s_waitcnt vmcnt(31)
v_mfma_f32_32x32x16_bf16 v[20:35], a[40:43], v[116:119], v[20:35]
v_mfma_f32_32x32x16_bf16 v[36:51], a[44:47], v[116:119], v[36:51]
buffer_load_dwordx4 v[116:119], v6, s[84:87], s51 offen offset:1024 sc1
s_waitcnt vmcnt(31)
v_mfma_f32_32x32x16_bf16 v[20:35], a[48:51], v[120:123], v[20:35]
v_mfma_f32_32x32x16_bf16 v[36:51], a[52:55], v[120:123], v[36:51]
buffer_load_dwordx4 v[120:123], v6, s[84:87], s51 offen offset:2048 sc1
s_waitcnt vmcnt(31)
v_mfma_f32_32x32x16_bf16 v[20:35], a[56:59], v[124:127], v[20:35]
v_mfma_f32_32x32x16_bf16 v[36:51], a[60:63], v[124:127], v[36:51]
buffer_load_dwordx4 v[124:127], v6, s[84:87], s51 offen offset:3072 sc1
s_waitcnt vmcnt(31)
v_mfma_f32_32x32x16_bf16 v[20:35], a[64:67], v[128:131], v[20:35]
v_mfma_f32_32x32x16_bf16 v[36:51], a[68:71], v[128:131], v[36:51]
s_add_u32 s51, s56, 8192
s_and_b32 s51, s51, 0x7fff
s_and_b32 s63, s51, 0x6000
s_add_u32 s51, s51, s63
s_add_u32 s51, s51, s50
buffer_load_dwordx4 v[128:131], v6, s[84:87], s51 offen offset:0 sc1
s_waitcnt vmcnt(31)
v_mfma_f32_32x32x16_bf16 v[20:35], a[72:75], v[132:135], v[20:35]
v_mfma_f32_32x32x16_bf16 v[36:51], a[76:79], v[132:135], v[36:51]
buffer_load_dwordx4 v[132:135], v6, s[84:87], s51 offen offset:1024 sc1
s_waitcnt vmcnt(31)
v_mfma_f32_32x32x16_bf16 v[20:35], a[80:83], v[136:139], v[20:35]
v_mfma_f32_32x32x16_bf16 v[36:51], a[84:87], v[136:139], v[36:51]
buffer_load_dwordx4 v[136:139], v6, s[84:87], s51 offen offset:2048 sc1
s_waitcnt vmcnt(31)
v_mfma_f32_32x32x16_bf16 v[20:35], a[88:91], v[140:143], v[20:35]
v_mfma_f32_32x32x16_bf16 v[36:51], a[92:95], v[140:143], v[36:51]
buffer_load_dwordx4 v[140:143], v6, s[84:87], s51 offen offset:3072 sc1
s_waitcnt vmcnt(31)
v_mfma_f32_32x32x16_bf16 v[20:35], a[96:99], v[144:147], v[20:35]
v_mfma_f32_32x32x16_bf16 v[36:51], a[100:103], v[144:147], v[36:51]
s_add_u32 s51, s56, 12288
s_and_b32 s51, s51, 0x7fff
s_and_b32 s63, s51, 0x6000
s_add_u32 s51, s51, s63
s_add_u32 s51, s51, s50
buffer_load_dwordx4 v[144:147], v6, s[84:87], s51 offen offset:0 sc1
s_waitcnt vmcnt(31)
v_mfma_f32_32x32x16_bf16 v[20:35], a[104:107], v[148:151], v[20:35]
v_mfma_f32_32x32x16_bf16 v[36:51], a[108:111], v[148:151], v[36:51]
buffer_load_dwordx4 v[148:151], v6, s[84:87], s51 offen offset:1024 sc1
s_waitcnt vmcnt(31)
v_mfma_f32_32x32x16_bf16 v[20:35], a[112:115], v[152:155], v[20:35]
v_mfma_f32_32x32x16_bf16 v[36:51], a[116:119], v[152:155], v[36:51]
buffer_load_dwordx4 v[152:155], v6, s[84:87], s51 offen offset:2048 sc1
s_waitcnt vmcnt(31)
v_mfma_f32_32x32x16_bf16 v[20:35], a[120:123], v[156:159], v[20:35]
v_mfma_f32_32x32x16_bf16 v[36:51], a[124:127], v[156:159], v[36:51]
buffer_load_dwordx4 v[156:159], v6, s[84:87], s51 offen offset:3072 sc1
s_waitcnt vmcnt(31)
v_mfma_f32_32x32x16_bf16 v[20:35], a[128:131], v[160:163], v[20:35]
v_mfma_f32_32x32x16_bf16 v[36:51], a[132:135], v[160:163], v[36:51]
s_add_u32 s51, s56, 16384
s_and_b32 s51, s51, 0x7fff
s_and_b32 s63, s51, 0x6000
s_add_u32 s51, s51, s63
s_add_u32 s51, s51, s50
buffer_load_dwordx4 v[160:163], v6, s[84:87], s51 offen offset:0 sc1
s_waitcnt vmcnt(31)
v_mfma_f32_32x32x16_bf16 v[20:35], a[136:139], v[164:167], v[20:35]
v_mfma_f32_32x32x16_bf16 v[36:51], a[140:143], v[164:167], v[36:51]
buffer_load_dwordx4 v[164:167], v6, s[84:87], s51 offen offset:1024 sc1
s_waitcnt vmcnt(31)
v_mfma_f32_32x32x16_bf16 v[20:35], a[144:147], v[168:171], v[20:35]
v_mfma_f32_32x32x16_bf16 v[36:51], a[148:151], v[168:171], v[36:51]
buffer_load_dwordx4 v[168:171], v6, s[84:87], s51 offen offset:2048 sc1
s_waitcnt vmcnt(31)
v_mfma_f32_32x32x16_bf16 v[20:35], a[152:155], v[172:175], v[20:35]
v_mfma_f32_32x32x16_bf16 v[36:51], a[156:159], v[172:175], v[36:51]
buffer_load_dwordx4 v[172:175], v6, s[84:87], s51 offen offset:3072 sc1
s_waitcnt vmcnt(31)
v_mfma_f32_32x32x16_bf16 v[20:35], a[160:163], v[176:179], v[20:35]
v_mfma_f32_32x32x16_bf16 v[36:51], a[164:167], v[176:179], v[36:51]
s_add_u32 s51, s56, 20480
s_and_b32 s51, s51, 0x7fff
s_and_b32 s63, s51, 0x6000
s_add_u32 s51, s51, s63
s_add_u32 s51, s51, s50
buffer_load_dwordx4 v[176:179], v6, s[84:87], s51 offen offset:0 sc1
s_waitcnt vmcnt(31)
v_mfma_f32_32x32x16_bf16 v[20:35], a[168:171], v[180:183], v[20:35]
v_mfma_f32_32x32x16_bf16 v[36:51], a[172:175], v[180:183], v[36:51]
buffer_load_dwordx4 v[180:183], v6, s[84:87], s51 offen offset:1024 sc1
s_waitcnt vmcnt(31)
v_mfma_f32_32x32x16_bf16 v[20:35], a[176:179], v[184:187], v[20:35]
v_mfma_f32_32x32x16_bf16 v[36:51], a[180:183], v[184:187], v[36:51]
buffer_load_dwordx4 v[184:187], v6, s[84:87], s51 offen offset:2048 sc1
s_waitcnt vmcnt(31)
v_mfma_f32_32x32x16_bf16 v[20:35], a[184:187], v[188:191], v[20:35]
v_mfma_f32_32x32x16_bf16 v[36:51], a[188:191], v[188:191], v[36:51]
buffer_load_dwordx4 v[188:191], v6, s[84:87], s51 offen offset:3072 sc1
s_waitcnt vmcnt(31)
v_mfma_f32_32x32x16_bf16 v[20:35], a[192:195], v[192:195], v[20:35]
v_mfma_f32_32x32x16_bf16 v[36:51], a[196:199], v[192:195], v[36:51]
s_add_u32 s51, s56, 24576
s_and_b32 s51, s51, 0x7fff
s_and_b32 s63, s51, 0x6000
s_add_u32 s51, s51, s63
s_add_u32 s51, s51, s50
buffer_load_dwordx4 v[192:195], v6, s[84:87], s51 offen offset:0 sc1
s_waitcnt vmcnt(31)
v_mfma_f32_32x32x16_bf16 v[20:35], a[200:203], v[196:199], v[20:35]
v_mfma_f32_32x32x16_bf16 v[36:51], a[204:207], v[196:199], v[36:51]
buffer_load_dwordx4 v[196:199], v6, s[84:87], s51 offen offset:1024 sc1
s_waitcnt vmcnt(31)
v_mfma_f32_32x32x16_bf16 v[20:35], a[208:211], v[200:203], v[20:35]
v_mfma_f32_32x32x16_bf16 v[36:51], a[212:215], v[200:203], v[36:51]
buffer_load_dwordx4 v[200:203], v6, s[84:87], s51 offen offset:2048 sc1
s_waitcnt vmcnt(31)
v_mfma_f32_32x32x16_bf16 v[20:35], a[216:219], v[204:207], v[20:35]
v_mfma_f32_32x32x16_bf16 v[36:51], a[220:223], v[204:207], v[36:51]
buffer_load_dwordx4 v[204:207], v6, s[84:87], s51 offen offset:3072 sc1
s_waitcnt vmcnt(31)
v_mfma_f32_32x32x16_bf16 v[20:35], a[224:227], v[208:211], v[20:35]
v_mfma_f32_32x32x16_bf16 v[36:51], a[228:231], v[208:211], v[36:51]
s_add_u32 s51, s56, 28672
s_and_b32 s51, s51, 0x7fff
s_and_b32 s63, s51, 0x6000
s_add_u32 s51, s51, s63
s_add_u32 s51, s51, s50
buffer_load_dwordx4 v[208:211], v6, s[84:87], s51 offen offset:0 sc1
s_waitcnt vmcnt(31)
v_mfma_f32_32x32x16_bf16 v[20:35], a[232:235], v[212:215], v[20:35]
v_mfma_f32_32x32x16_bf16 v[36:51], a[236:239], v[212:215], v[36:51]
buffer_load_dwordx4 v[212:215], v6, s[84:87], s51 offen offset:1024 sc1
s_waitcnt vmcnt(31)
v_mfma_f32_32x32x16_bf16 v[20:35], a[240:243], v[216:219], v[20:35]
v_mfma_f32_32x32x16_bf16 v[36:51], a[244:247], v[216:219], v[36:51]
buffer_load_dwordx4 v[216:219], v6, s[84:87], s51 offen offset:2048 sc1
s_waitcnt vmcnt(31)
v_mfma_f32_32x32x16_bf16 v[224:239], a[248:251], v[220:223], v[20:35]
v_mfma_f32_32x32x16_bf16 v[240:255], a[252:255], v[220:223], v[36:51]
buffer_load_dwordx4 v[220:223], v6, s[84:87], s51 offen offset:3072 sc1
s_add_u32 s42, s42, s71
s_branch mega_kernel_o_w1
mega_kernel_o_n0:
s_waitcnt vmcnt(31)
v_mfma_f32_32x32x16_bf16 v[20:35], a[0:3], v[96:99], 0
v_mfma_f32_32x32x16_bf16 v[36:51], a[4:7], v[96:99], 0
s_waitcnt vmcnt(30)
v_mfma_f32_32x32x16_bf16 v[20:35], a[8:11], v[100:103], v[20:35]
v_mfma_f32_32x32x16_bf16 v[36:51], a[12:15], v[100:103], v[36:51]
s_waitcnt vmcnt(29)
v_mfma_f32_32x32x16_bf16 v[20:35], a[16:19], v[104:107], v[20:35]
v_mfma_f32_32x32x16_bf16 v[36:51], a[20:23], v[104:107], v[36:51]
s_waitcnt vmcnt(28)
v_mfma_f32_32x32x16_bf16 v[20:35], a[24:27], v[108:111], v[20:35]
v_mfma_f32_32x32x16_bf16 v[36:51], a[28:31], v[108:111], v[36:51]
s_waitcnt vmcnt(27)
v_mfma_f32_32x32x16_bf16 v[20:35], a[32:35], v[112:115], v[20:35]
v_mfma_f32_32x32x16_bf16 v[36:51], a[36:39], v[112:115], v[36:51]
s_waitcnt vmcnt(26)
v_mfma_f32_32x32x16_bf16 v[20:35], a[40:43], v[116:119], v[20:35]
v_mfma_f32_32x32x16_bf16 v[36:51], a[44:47], v[116:119], v[36:51]
s_waitcnt vmcnt(25)
v_mfma_f32_32x32x16_bf16 v[20:35], a[48:51], v[120:123], v[20:35]
v_mfma_f32_32x32x16_bf16 v[36:51], a[52:55], v[120:123], v[36:51]
s_waitcnt vmcnt(24)
v_mfma_f32_32x32x16_bf16 v[20:35], a[56:59], v[124:127], v[20:35]
v_mfma_f32_32x32x16_bf16 v[36:51], a[60:63], v[124:127], v[36:51]
s_waitcnt vmcnt(23)
v_mfma_f32_32x32x16_bf16 v[20:35], a[64:67], v[128:131], v[20:35]
v_mfma_f32_32x32x16_bf16 v[36:51], a[68:71], v[128:131], v[36:51]
s_waitcnt vmcnt(22)
v_mfma_f32_32x32x16_bf16 v[20:35], a[72:75], v[132:135], v[20:35]
v_mfma_f32_32x32x16_bf16 v[36:51], a[76:79], v[132:135], v[36:51]
s_waitcnt vmcnt(21)
v_mfma_f32_32x32x16_bf16 v[20:35], a[80:83], v[136:139], v[20:35]
v_mfma_f32_32x32x16_bf16 v[36:51], a[84:87], v[136:139], v[36:51]
s_waitcnt vmcnt(20)
v_mfma_f32_32x32x16_bf16 v[20:35], a[88:91], v[140:143], v[20:35]
v_mfma_f32_32x32x16_bf16 v[36:51], a[92:95], v[140:143], v[36:51]
s_waitcnt vmcnt(19)
v_mfma_f32_32x32x16_bf16 v[20:35], a[96:99], v[144:147], v[20:35]
v_mfma_f32_32x32x16_bf16 v[36:51], a[100:103], v[144:147], v[36:51]
s_waitcnt vmcnt(18)
v_mfma_f32_32x32x16_bf16 v[20:35], a[104:107], v[148:151], v[20:35]
v_mfma_f32_32x32x16_bf16 v[36:51], a[108:111], v[148:151], v[36:51]
s_waitcnt vmcnt(17)
v_mfma_f32_32x32x16_bf16 v[20:35], a[112:115], v[152:155], v[20:35]
v_mfma_f32_32x32x16_bf16 v[36:51], a[116:119], v[152:155], v[36:51]
s_waitcnt vmcnt(16)
v_mfma_f32_32x32x16_bf16 v[20:35], a[120:123], v[156:159], v[20:35]
v_mfma_f32_32x32x16_bf16 v[36:51], a[124:127], v[156:159], v[36:51]
s_waitcnt vmcnt(15)
v_mfma_f32_32x32x16_bf16 v[20:35], a[128:131], v[160:163], v[20:35]
v_mfma_f32_32x32x16_bf16 v[36:51], a[132:135], v[160:163], v[36:51]
s_waitcnt vmcnt(14)
v_mfma_f32_32x32x16_bf16 v[20:35], a[136:139], v[164:167], v[20:35]
v_mfma_f32_32x32x16_bf16 v[36:51], a[140:143], v[164:167], v[36:51]
s_waitcnt vmcnt(13)
v_mfma_f32_32x32x16_bf16 v[20:35], a[144:147], v[168:171], v[20:35]
v_mfma_f32_32x32x16_bf16 v[36:51], a[148:151], v[168:171], v[36:51]
s_waitcnt vmcnt(12)
v_mfma_f32_32x32x16_bf16 v[20:35], a[152:155], v[172:175], v[20:35]
v_mfma_f32_32x32x16_bf16 v[36:51], a[156:159], v[172:175], v[36:51]
s_waitcnt vmcnt(11)
v_mfma_f32_32x32x16_bf16 v[20:35], a[160:163], v[176:179], v[20:35]
v_mfma_f32_32x32x16_bf16 v[36:51], a[164:167], v[176:179], v[36:51]
buffer_load_dword v15, v7, s[84:87], 0 offen sc1
s_waitcnt vmcnt(10)
v_mfma_f32_32x32x16_bf16 v[20:35], a[168:171], v[180:183], v[20:35]
v_mfma_f32_32x32x16_bf16 v[36:51], a[172:175], v[180:183], v[36:51]
s_waitcnt vmcnt(9)
v_mfma_f32_32x32x16_bf16 v[20:35], a[176:179], v[184:187], v[20:35]
v_mfma_f32_32x32x16_bf16 v[36:51], a[180:183], v[184:187], v[36:51]
s_waitcnt vmcnt(8)
v_mfma_f32_32x32x16_bf16 v[20:35], a[184:187], v[188:191], v[20:35]
v_mfma_f32_32x32x16_bf16 v[36:51], a[188:191], v[188:191], v[36:51]
s_waitcnt vmcnt(7)
v_mfma_f32_32x32x16_bf16 v[20:35], a[192:195], v[192:195], v[20:35]
v_mfma_f32_32x32x16_bf16 v[36:51], a[196:199], v[192:195], v[36:51]
s_waitcnt vmcnt(6)
v_mfma_f32_32x32x16_bf16 v[20:35], a[200:203], v[196:199], v[20:35]
v_mfma_f32_32x32x16_bf16 v[36:51], a[204:207], v[196:199], v[36:51]
s_waitcnt vmcnt(5)
v_mfma_f32_32x32x16_bf16 v[20:35], a[208:211], v[200:203], v[20:35]
v_mfma_f32_32x32x16_bf16 v[36:51], a[212:215], v[200:203], v[36:51]
s_waitcnt vmcnt(4)
v_mfma_f32_32x32x16_bf16 v[20:35], a[216:219], v[204:207], v[20:35]
v_mfma_f32_32x32x16_bf16 v[36:51], a[220:223], v[204:207], v[36:51]
s_waitcnt vmcnt(3)
v_mfma_f32_32x32x16_bf16 v[20:35], a[224:227], v[208:211], v[20:35]
v_mfma_f32_32x32x16_bf16 v[36:51], a[228:231], v[208:211], v[36:51]
s_waitcnt vmcnt(2)
v_mfma_f32_32x32x16_bf16 v[20:35], a[232:235], v[212:215], v[20:35]
v_mfma_f32_32x32x16_bf16 v[36:51], a[236:239], v[212:215], v[36:51]
s_waitcnt vmcnt(1)
v_mfma_f32_32x32x16_bf16 v[20:35], a[240:243], v[216:219], v[20:35]
v_mfma_f32_32x32x16_bf16 v[36:51], a[244:247], v[216:219], v[36:51]
s_waitcnt vmcnt(0)
v_mfma_f32_32x32x16_bf16 v[224:239], a[248:251], v[220:223], v[20:35]
v_mfma_f32_32x32x16_bf16 v[240:255], a[252:255], v[220:223], v[36:51]
s_branch mega_kernel_o_imm
mega_kernel_o_w1:
s_add_u32 s54, s42, s71
s_sub_u32 s62, s42, s71
s_lshr_b32 s63, s54, 2
s_xnor_b32 s63, s63, s98
s_and_b32 s63, s63, 1
s_lshl_b32 s63, s63, 13
s_lshl_b32 s50, s54, 19
s_add_u32 s50, s50, s63
s_cmp_gt_i32 s52, s54
s_cbranch_scc0 mega_kernel_o_n1
s_waitcnt vmcnt(31)
v_mfma_f32_32x32x16_bf16 v[20:35], a[0:3], v[96:99], 0
v_mfma_f32_32x32x16_bf16 v[36:51], a[4:7], v[96:99], 0
s_add_u32 s51, s56, 0
s_and_b32 s51, s51, 0x7fff
s_and_b32 s63, s51, 0x6000
s_add_u32 s51, s51, s63
s_add_u32 s51, s51, s50
buffer_load_dwordx4 v[96:99], v6, s[84:87], s51 offen offset:0 sc1
s_waitcnt vmcnt(31)
v_mfma_f32_32x32x16_bf16 v[20:35], a[8:11], v[100:103], v[20:35]
v_mfma_f32_32x32x16_bf16 v[36:51], a[12:15], v[100:103], v[36:51]
buffer_load_dwordx4 v[100:103], v6, s[84:87], s51 offen offset:1024 sc1
v_add_u32 v2, s53, v8
v_add_u32 v3, s53, v9
v_add_u32 v4, s53, v10
s_waitcnt vmcnt(31)
v_mfma_f32_32x32x16_bf16 v[20:35], a[16:19], v[104:107], v[20:35]
v_mfma_f32_32x32x16_bf16 v[36:51], a[20:23], v[104:107], v[36:51]
buffer_load_dwordx4 v[104:107], v6, s[84:87], s51 offen offset:2048 sc1
ds_write_b128 v2, v[224:227] offset:0
ds_write_b128 v2, v[228:231] offset:1088
s_waitcnt vmcnt(31)
v_mfma_f32_32x32x16_bf16 v[20:35], a[24:27], v[108:111], v[20:35]
v_mfma_f32_32x32x16_bf16 v[36:51], a[28:31], v[108:111], v[36:51]
buffer_load_dwordx4 v[108:111], v6, s[84:87], s51 offen offset:3072 sc1
ds_write_b128 v2, v[232:235] offset:2176
ds_write_b128 v2, v[236:239] offset:3264
s_waitcnt vmcnt(31)
v_mfma_f32_32x32x16_bf16 v[20:35], a[32:35], v[112:115], v[20:35]
v_mfma_f32_32x32x16_bf16 v[36:51], a[36:39], v[112:115], v[36:51]
s_add_u32 s51, s56, 4096
s_and_b32 s51, s51, 0x7fff
s_and_b32 s63, s51, 0x6000
s_add_u32 s51, s51, s63
s_add_u32 s51, s51, s50
buffer_load_dwordx4 v[112:115], v6, s[84:87], s51 offen offset:0 sc1
ds_write_b128 v2, v[240:243] offset:4352
ds_write_b128 v2, v[244:247] offset:5440
s_waitcnt vmcnt(31)
v_mfma_f32_32x32x16_bf16 v[20:35], a[40:43], v[116:119], v[20:35]
v_mfma_f32_32x32x16_bf16 v[36:51], a[44:47], v[116:119], v[36:51]
buffer_load_dwordx4 v[116:119], v6, s[84:87], s51 offen offset:1024 sc1
ds_write_b128 v2, v[248:251] offset:6528
ds_write_b128 v2, v[252:255] offset:7616
s_waitcnt vmcnt(31)
v_mfma_f32_32x32x16_bf16 v[20:35], a[48:51], v[120:123], v[20:35]
v_mfma_f32_32x32x16_bf16 v[36:51], a[52:55], v[120:123], v[36:51]
buffer_load_dwordx4 v[120:123], v6, s[84:87], s51 offen offset:2048 sc1
s_waitcnt vmcnt(31)
v_mfma_f32_32x32x16_bf16 v[20:35], a[56:59], v[124:127], v[20:35]
v_mfma_f32_32x32x16_bf16 v[36:51], a[60:63], v[124:127], v[36:51]
buffer_load_dwordx4 v[124:127], v6, s[84:87], s51 offen offset:3072 sc1
s_waitcnt lgkmcnt(0)
s_barrier
ds_read_b128 v[52:55], v4 offset:0
ds_read_b128 v[56:59], v4 offset:8704
ds_read_b128 v[60:63], v4 offset:17408
ds_read_b128 v[64:67], v4 offset:26112
s_waitcnt vmcnt(31)
v_mfma_f32_32x32x16_bf16 v[20:35], a[64:67], v[128:131], v[20:35]
v_mfma_f32_32x32x16_bf16 v[36:51], a[68:71], v[128:131], v[36:51]
s_add_u32 s51, s56, 8192
s_and_b32 s51, s51, 0x7fff
s_and_b32 s63, s51, 0x6000
s_add_u32 s51, s51, s63
s_add_u32 s51, s51, s50
buffer_load_dwordx4 v[128:131], v6, s[84:87], s51 offen offset:0 sc1
ds_read_b128 v[68:71], v3 offset:0
ds_read_b128 v[72:75], v3 offset:8704
ds_read_b128 v[76:79], v3 offset:17408
ds_read_b128 v[80:83], v3 offset:26112
s_sub_u32 s53, 34816, s53
s_sub_u32 s60, s62, s64
s_lshr_b32 s60, s60, s67
s_bfe_u32 s61, s60, 0x10001
s_and_b32 s60, s60, 1
s_lshl_b32 s60, s60, 12
s_waitcnt vmcnt(31)
v_mfma_f32_32x32x16_bf16 v[20:35], a[72:75], v[132:135], v[20:35]
v_mfma_f32_32x32x16_bf16 v[36:51], a[76:79], v[132:135], v[36:51]
buffer_load_dwordx4 v[132:135], v6, s[84:87], s51 offen offset:1024 sc1
s_waitcnt vmcnt(31)
v_mfma_f32_32x32x16_bf16 v[20:35], a[80:83], v[136:139], v[20:35]
v_mfma_f32_32x32x16_bf16 v[36:51], a[84:87], v[136:139], v[36:51]
buffer_load_dwordx4 v[136:139], v6, s[84:87], s51 offen offset:2048 sc1
s_waitcnt lgkmcnt(4)
v_add_f32 v52, v52, v56
v_add_f32 v60, v60, v64
v_add_f32 v53, v53, v57
v_add_f32 v61, v61, v65
v_add_f32 v54, v54, v58
v_add_f32 v62, v62, v66
v_add_f32 v55, v55, v59
v_add_f32 v63, v63, v67
s_waitcnt vmcnt(31)
v_mfma_f32_32x32x16_bf16 v[20:35], a[88:91], v[140:143], v[20:35]
v_mfma_f32_32x32x16_bf16 v[36:51], a[92:95], v[140:143], v[36:51]
buffer_load_dwordx4 v[140:143], v6, s[84:87], s51 offen offset:3072 sc1
v_add_f32 v52, v52, v60
v_add_f32 v53, v53, v61
v_add_f32 v54, v54, v62
v_add_f32 v55, v55, v63
v_and_or_b32 v52, v52, -2, s61
s_cmp_eq_u32 s95, 0
s_cbranch_scc1 mega_kernel_o_sa1
buffer_store_dwordx4 v[52:55], v12, s[84:87], s60 offen sc1
s_branch mega_kernel_o_sb1
mega_kernel_o_sa1:
buffer_store_dwordx4 v[52:55], v12, s[84:87], s60 offen
mega_kernel_o_sb1:
s_waitcnt vmcnt(31)
v_mfma_f32_32x32x16_bf16 v[20:35], a[96:99], v[144:147], v[20:35]
v_mfma_f32_32x32x16_bf16 v[36:51], a[100:103], v[144:147], v[36:51]
s_add_u32 s51, s56, 12288
s_and_b32 s51, s51, 0x7fff
s_and_b32 s63, s51, 0x6000
s_add_u32 s51, s51, s63
s_add_u32 s51, s51, s50
buffer_load_dwordx4 v[144:147], v6, s[84:87], s51 offen offset:0 sc1
s_waitcnt lgkmcnt(0)
v_add_f32 v68, v68, v72
v_add_f32 v76, v76, v80
v_add_f32 v69, v69, v73
v_add_f32 v77, v77, v81
v_add_f32 v70, v70, v74
v_add_f32 v78, v78, v82
v_add_f32 v71, v71, v75
v_add_f32 v79, v79, v83
s_waitcnt vmcnt(31)
v_mfma_f32_32x32x16_bf16 v[20:35], a[104:107], v[148:151], v[20:35]
v_mfma_f32_32x32x16_bf16 v[36:51], a[108:111], v[148:151], v[36:51]
buffer_load_dwordx4 v[148:151], v6, s[84:87], s51 offen offset:1024 sc1
v_add_f32 v84, v68, v76
v_add_f32 v85, v69, v77
v_add_f32 v86, v70, v78
v_add_f32 v87, v71, v79
s_waitcnt vmcnt(31)
v_mfma_f32_32x32x16_bf16 v[20:35], a[112:115], v[152:155], v[20:35]
v_mfma_f32_32x32x16_bf16 v[36:51], a[116:119], v[152:155], v[36:51]
buffer_load_dwordx4 v[152:155], v6, s[84:87], s51 offen offset:2048 sc1
s_waitcnt vmcnt(31)
v_mfma_f32_32x32x16_bf16 v[20:35], a[120:123], v[156:159], v[20:35]
v_mfma_f32_32x32x16_bf16 v[36:51], a[124:127], v[156:159], v[36:51]
buffer_load_dwordx4 v[156:159], v6, s[84:87], s51 offen offset:3072 sc1
s_waitcnt vmcnt(31)
v_mfma_f32_32x32x16_bf16 v[20:35], a[128:131], v[160:163], v[20:35]
v_mfma_f32_32x32x16_bf16 v[36:51], a[132:135], v[160:163], v[36:51]
s_add_u32 s51, s56, 16384
s_and_b32 s51, s51, 0x7fff
s_and_b32 s63, s51, 0x6000
s_add_u32 s51, s51, s63
s_add_u32 s51, s51, s50
buffer_load_dwordx4 v[160:163], v6, s[84:87], s51 offen offset:0 sc1
s_waitcnt vmcnt(31)
v_mfma_f32_32x32x16_bf16 v[20:35], a[136:139], v[164:167], v[20:35]
v_mfma_f32_32x32x16_bf16 v[36:51], a[140:143], v[164:167], v[36:51]
buffer_load_dwordx4 v[164:167], v6, s[84:87], s51 offen offset:1024 sc1
s_waitcnt vmcnt(31)
v_mfma_f32_32x32x16_bf16 v[20:35], a[144:147], v[168:171], v[20:35]
v_mfma_f32_32x32x16_bf16 v[36:51], a[148:151], v[168:171], v[36:51]
buffer_load_dwordx4 v[168:171], v6, s[84:87], s51 offen offset:2048 sc1
s_waitcnt vmcnt(31)
v_mfma_f32_32x32x16_bf16 v[20:35], a[152:155], v[172:175], v[20:35]
v_mfma_f32_32x32x16_bf16 v[36:51], a[156:159], v[172:175], v[36:51]
buffer_load_dwordx4 v[172:175], v6, s[84:87], s51 offen offset:3072 sc1
s_waitcnt vmcnt(31)
v_mfma_f32_32x32x16_bf16 v[20:35], a[160:163], v[176:179], v[20:35]
v_mfma_f32_32x32x16_bf16 v[36:51], a[164:167], v[176:179], v[36:51]
s_add_u32 s51, s56, 20480
s_and_b32 s51, s51, 0x7fff
s_and_b32 s63, s51, 0x6000
s_add_u32 s51, s51, s63
s_add_u32 s51, s51, s50
buffer_load_dwordx4 v[176:179], v6, s[84:87], s51 offen offset:0 sc1
s_waitcnt vmcnt(31)
v_mfma_f32_32x32x16_bf16 v[20:35], a[168:171], v[180:183], v[20:35]
v_mfma_f32_32x32x16_bf16 v[36:51], a[172:175], v[180:183], v[36:51]
buffer_load_dwordx4 v[180:183], v6, s[84:87], s51 offen offset:1024 sc1
s_waitcnt vmcnt(31)
v_mfma_f32_32x32x16_bf16 v[20:35], a[176:179], v[184:187], v[20:35]
v_mfma_f32_32x32x16_bf16 v[36:51], a[180:183], v[184:187], v[36:51]
buffer_load_dwordx4 v[184:187], v6, s[84:87], s51 offen offset:2048 sc1
s_waitcnt vmcnt(31)
v_mfma_f32_32x32x16_bf16 v[20:35], a[184:187], v[188:191], v[20:35]
v_mfma_f32_32x32x16_bf16 v[36:51], a[188:191], v[188:191], v[36:51]
buffer_load_dwordx4 v[188:191], v6, s[84:87], s51 offen offset:3072 sc1
s_waitcnt vmcnt(31)
v_mfma_f32_32x32x16_bf16 v[20:35], a[192:195], v[192:195], v[20:35]
v_mfma_f32_32x32x16_bf16 v[36:51], a[196:199], v[192:195], v[36:51]
s_add_u32 s51, s56, 24576
s_and_b32 s51, s51, 0x7fff
s_and_b32 s63, s51, 0x6000
s_add_u32 s51, s51, s63
s_add_u32 s51, s51, s50
buffer_load_dwordx4 v[192:195], v6, s[84:87], s51 offen offset:0 sc1
s_waitcnt vmcnt(31)
v_mfma_f32_32x32x16_bf16 v[20:35], a[200:203], v[196:199], v[20:35]
v_mfma_f32_32x32x16_bf16 v[36:51], a[204:207], v[196:199], v[36:51]
buffer_load_dwordx4 v[196:199], v6, s[84:87], s51 offen offset:1024 sc1
s_waitcnt vmcnt(31)
v_mfma_f32_32x32x16_bf16 v[20:35], a[208:211], v[200:203], v[20:35]
v_mfma_f32_32x32x16_bf16 v[36:51], a[212:215], v[200:203], v[36:51]
buffer_load_dwordx4 v[200:203], v6, s[84:87], s51 offen offset:2048 sc1
s_waitcnt vmcnt(31)
v_mfma_f32_32x32x16_bf16 v[20:35], a[216:219], v[204:207], v[20:35]
v_mfma_f32_32x32x16_bf16 v[36:51], a[220:223], v[204:207], v[36:51]
buffer_load_dwordx4 v[204:207], v6, s[84:87], s51 offen offset:3072 sc1
s_sub_u32 s60, s62, s64
s_lshr_b32 s60, s60, s67
s_bfe_u32 s61, s60, 0x10001
s_and_b32 s60, s60, 1
s_lshl_b32 s60, s60, 12
buffer_load_dwordx4 v[88:91], v13, s[84:87], s60 offen sc1
s_waitcnt vmcnt(31)
v_mfma_f32_32x32x16_bf16 v[20:35], a[224:227], v[208:211], v[20:35]
v_mfma_f32_32x32x16_bf16 v[36:51], a[228:231], v[208:211], v[36:51]
s_add_u32 s51, s56, 28672
s_and_b32 s51, s51, 0x7fff
s_and_b32 s63, s51, 0x6000
s_add_u32 s51, s51, s63
s_add_u32 s51, s51, s50
buffer_load_dwordx4 v[208:211], v6, s[84:87], s51 offen offset:0 sc1
s_waitcnt vmcnt(31)
v_mfma_f32_32x32x16_bf16 v[20:35], a[232:235], v[212:215], v[20:35]
v_mfma_f32_32x32x16_bf16 v[36:51], a[236:239], v[212:215], v[36:51]
buffer_load_dwordx4 v[212:215], v6, s[84:87], s51 offen offset:1024 sc1
s_waitcnt vmcnt(31)
v_mfma_f32_32x32x16_bf16 v[20:35], a[240:243], v[216:219], v[20:35]
v_mfma_f32_32x32x16_bf16 v[36:51], a[244:247], v[216:219], v[36:51]
buffer_load_dwordx4 v[216:219], v6, s[84:87], s51 offen offset:2048 sc1
s_waitcnt vmcnt(31)
v_mfma_f32_32x32x16_bf16 v[224:239], a[248:251], v[220:223], v[20:35]
v_mfma_f32_32x32x16_bf16 v[240:255], a[252:255], v[220:223], v[36:51]
buffer_load_dwordx4 v[220:223], v6, s[84:87], s51 offen offset:3072 sc1
s_waitcnt vmcnt(4)
mega_kernel_o_f1c:
v_and_b32 v14, 1, v88
v_cmp_ne_u32 vcc, s61, v14
s_cbranch_vccz mega_kernel_o_f1k
s_sub_u32 s60, s62, s64
s_lshr_b32 s60, s60, s67
s_bfe_u32 s61, s60, 0x10001
s_and_b32 s60, s60, 1
s_lshl_b32 s60, s60, 12
buffer_load_dwordx4 v[88:91], v13, s[84:87], s60 offen sc1
s_waitcnt vmcnt(0)
s_branch mega_kernel_o_f1c
mega_kernel_o_f1k:
v_pk_add_f32 v[88:89], v[88:89], v[84:85]
v_pk_add_f32 v[90:91], v[90:91], v[86:87]
s_lshl_b32 s60, s62, 17
v_cvt_pk_bf16_f32 v92, v88, v89
v_cvt_pk_bf16_f32 v93, v90, v91
buffer_store_dwordx2 v[92:93], v11, s[8:11], s60 offen sc1
s_add_u32 s42, s42, s71
s_branch mega_kernel_o_w1
mega_kernel_o_n1:
s_waitcnt vmcnt(31)
v_mfma_f32_32x32x16_bf16 v[20:35], a[0:3], v[96:99], 0
v_mfma_f32_32x32x16_bf16 v[36:51], a[4:7], v[96:99], 0
s_waitcnt vmcnt(30)
v_mfma_f32_32x32x16_bf16 v[20:35], a[8:11], v[100:103], v[20:35]
v_mfma_f32_32x32x16_bf16 v[36:51], a[12:15], v[100:103], v[36:51]
v_add_u32 v2, s53, v8
v_add_u32 v3, s53, v9
v_add_u32 v4, s53, v10
s_waitcnt vmcnt(29)
v_mfma_f32_32x32x16_bf16 v[20:35], a[16:19], v[104:107], v[20:35]
v_mfma_f32_32x32x16_bf16 v[36:51], a[20:23], v[104:107], v[36:51]
ds_write_b128 v2, v[224:227] offset:0
ds_write_b128 v2, v[228:231] offset:1088
s_waitcnt vmcnt(28)
v_mfma_f32_32x32x16_bf16 v[20:35], a[24:27], v[108:111], v[20:35]
v_mfma_f32_32x32x16_bf16 v[36:51], a[28:31], v[108:111], v[36:51]
ds_write_b128 v2, v[232:235] offset:2176
ds_write_b128 v2, v[236:239] offset:3264
s_waitcnt vmcnt(27)
v_mfma_f32_32x32x16_bf16 v[20:35], a[32:35], v[112:115], v[20:35]
v_mfma_f32_32x32x16_bf16 v[36:51], a[36:39], v[112:115], v[36:51]
ds_write_b128 v2, v[240:243] offset:4352
ds_write_b128 v2, v[244:247] offset:5440
s_waitcnt vmcnt(26)
v_mfma_f32_32x32x16_bf16 v[20:35], a[40:43], v[116:119], v[20:35]
v_mfma_f32_32x32x16_bf16 v[36:51], a[44:47], v[116:119], v[36:51]
ds_write_b128 v2, v[248:251] offset:6528
ds_write_b128 v2, v[252:255] offset:7616
s_waitcnt vmcnt(25)
v_mfma_f32_32x32x16_bf16 v[20:35], a[48:51], v[120:123], v[20:35]
v_mfma_f32_32x32x16_bf16 v[36:51], a[52:55], v[120:123], v[36:51]
s_waitcnt vmcnt(24)
v_mfma_f32_32x32x16_bf16 v[20:35], a[56:59], v[124:127], v[20:35]
v_mfma_f32_32x32x16_bf16 v[36:51], a[60:63], v[124:127], v[36:51]
s_waitcnt lgkmcnt(0)
s_barrier
ds_read_b128 v[52:55], v4 offset:0
ds_read_b128 v[56:59], v4 offset:8704
ds_read_b128 v[60:63], v4 offset:17408
ds_read_b128 v[64:67], v4 offset:26112
s_waitcnt vmcnt(23)
v_mfma_f32_32x32x16_bf16 v[20:35], a[64:67], v[128:131], v[20:35]
v_mfma_f32_32x32x16_bf16 v[36:51], a[68:71], v[128:131], v[36:51]
ds_read_b128 v[68:71], v3 offset:0
ds_read_b128 v[72:75], v3 offset:8704
ds_read_b128 v[76:79], v3 offset:17408
ds_read_b128 v[80:83], v3 offset:26112
s_sub_u32 s53, 34816, s53
s_sub_u32 s60, s62, s64
s_lshr_b32 s60, s60, s67
s_bfe_u32 s61, s60, 0x10001
s_and_b32 s60, s60, 1
s_lshl_b32 s60, s60, 12
s_waitcnt vmcnt(22)
v_mfma_f32_32x32x16_bf16 v[20:35], a[72:75], v[132:135], v[20:35]
v_mfma_f32_32x32x16_bf16 v[36:51], a[76:79], v[132:135], v[36:51]
s_waitcnt vmcnt(21)
v_mfma_f32_32x32x16_bf16 v[20:35], a[80:83], v[136:139], v[20:35]
v_mfma_f32_32x32x16_bf16 v[36:51], a[84:87], v[136:139], v[36:51]
s_waitcnt lgkmcnt(4)
v_add_f32 v52, v52, v56
v_add_f32 v60, v60, v64
v_add_f32 v53, v53, v57
v_add_f32 v61, v61, v65
v_add_f32 v54, v54, v58
v_add_f32 v62, v62, v66
v_add_f32 v55, v55, v59
v_add_f32 v63, v63, v67
s_waitcnt vmcnt(20)
v_mfma_f32_32x32x16_bf16 v[20:35], a[88:91], v[140:143], v[20:35]
v_mfma_f32_32x32x16_bf16 v[36:51], a[92:95], v[140:143], v[36:51]
v_add_f32 v52, v52, v60
v_add_f32 v53, v53, v61
v_add_f32 v54, v54, v62
v_add_f32 v55, v55, v63
v_and_or_b32 v52, v52, -2, s61
s_cmp_eq_u32 s95, 0
s_cbranch_scc1 mega_kernel_o_sa2
buffer_store_dwordx4 v[52:55], v12, s[84:87], s60 offen sc1
s_branch mega_kernel_o_sb2
mega_kernel_o_sa2:
buffer_store_dwordx4 v[52:55], v12, s[84:87], s60 offen
mega_kernel_o_sb2:
s_waitcnt vmcnt(19)
v_mfma_f32_32x32x16_bf16 v[20:35], a[96:99], v[144:147], v[20:35]
v_mfma_f32_32x32x16_bf16 v[36:51], a[100:103], v[144:147], v[36:51]
s_waitcnt lgkmcnt(0)
v_add_f32 v68, v68, v72
v_add_f32 v76, v76, v80
v_add_f32 v69, v69, v73
v_add_f32 v77, v77, v81
v_add_f32 v70, v70, v74
v_add_f32 v78, v78, v82
v_add_f32 v71, v71, v75
v_add_f32 v79, v79, v83
s_waitcnt vmcnt(18)
v_mfma_f32_32x32x16_bf16 v[20:35], a[104:107], v[148:151], v[20:35]
v_mfma_f32_32x32x16_bf16 v[36:51], a[108:111], v[148:151], v[36:51]
v_add_f32 v84, v68, v76
v_add_f32 v85, v69, v77
v_add_f32 v86, v70, v78
v_add_f32 v87, v71, v79
s_waitcnt vmcnt(17)
v_mfma_f32_32x32x16_bf16 v[20:35], a[112:115], v[152:155], v[20:35]
v_mfma_f32_32x32x16_bf16 v[36:51], a[116:119], v[152:155], v[36:51]
s_waitcnt vmcnt(16)
v_mfma_f32_32x32x16_bf16 v[20:35], a[120:123], v[156:159], v[20:35]
v_mfma_f32_32x32x16_bf16 v[36:51], a[124:127], v[156:159], v[36:51]
s_waitcnt vmcnt(15)
v_mfma_f32_32x32x16_bf16 v[20:35], a[128:131], v[160:163], v[20:35]
v_mfma_f32_32x32x16_bf16 v[36:51], a[132:135], v[160:163], v[36:51]
s_waitcnt vmcnt(14)
v_mfma_f32_32x32x16_bf16 v[20:35], a[136:139], v[164:167], v[20:35]
v_mfma_f32_32x32x16_bf16 v[36:51], a[140:143], v[164:167], v[36:51]
s_waitcnt vmcnt(13)
v_mfma_f32_32x32x16_bf16 v[20:35], a[144:147], v[168:171], v[20:35]
v_mfma_f32_32x32x16_bf16 v[36:51], a[148:151], v[168:171], v[36:51]
s_waitcnt vmcnt(12)
v_mfma_f32_32x32x16_bf16 v[20:35], a[152:155], v[172:175], v[20:35]
v_mfma_f32_32x32x16_bf16 v[36:51], a[156:159], v[172:175], v[36:51]
s_waitcnt vmcnt(11)
v_mfma_f32_32x32x16_bf16 v[20:35], a[160:163], v[176:179], v[20:35]
v_mfma_f32_32x32x16_bf16 v[36:51], a[164:167], v[176:179], v[36:51]
buffer_load_dword v15, v7, s[84:87], 0 offen sc1
s_waitcnt vmcnt(10)
v_mfma_f32_32x32x16_bf16 v[20:35], a[168:171], v[180:183], v[20:35]
v_mfma_f32_32x32x16_bf16 v[36:51], a[172:175], v[180:183], v[36:51]
s_waitcnt vmcnt(9)
v_mfma_f32_32x32x16_bf16 v[20:35], a[176:179], v[184:187], v[20:35]
v_mfma_f32_32x32x16_bf16 v[36:51], a[180:183], v[184:187], v[36:51]
s_waitcnt vmcnt(8)
v_mfma_f32_32x32x16_bf16 v[20:35], a[184:187], v[188:191], v[20:35]
v_mfma_f32_32x32x16_bf16 v[36:51], a[188:191], v[188:191], v[36:51]
s_waitcnt vmcnt(7)
v_mfma_f32_32x32x16_bf16 v[20:35], a[192:195], v[192:195], v[20:35]
v_mfma_f32_32x32x16_bf16 v[36:51], a[196:199], v[192:195], v[36:51]
s_waitcnt vmcnt(6)
v_mfma_f32_32x32x16_bf16 v[20:35], a[200:203], v[196:199], v[20:35]
v_mfma_f32_32x32x16_bf16 v[36:51], a[204:207], v[196:199], v[36:51]
s_waitcnt vmcnt(5)
v_mfma_f32_32x32x16_bf16 v[20:35], a[208:211], v[200:203], v[20:35]
v_mfma_f32_32x32x16_bf16 v[36:51], a[212:215], v[200:203], v[36:51]
s_waitcnt vmcnt(4)
v_mfma_f32_32x32x16_bf16 v[20:35], a[216:219], v[204:207], v[20:35]
v_mfma_f32_32x32x16_bf16 v[36:51], a[220:223], v[204:207], v[36:51]
s_sub_u32 s60, s62, s64
s_lshr_b32 s60, s60, s67
s_bfe_u32 s61, s60, 0x10001
s_and_b32 s60, s60, 1
s_lshl_b32 s60, s60, 12
buffer_load_dwordx4 v[88:91], v13, s[84:87], s60 offen sc1
s_waitcnt vmcnt(3)
v_mfma_f32_32x32x16_bf16 v[20:35], a[224:227], v[208:211], v[20:35]
v_mfma_f32_32x32x16_bf16 v[36:51], a[228:231], v[208:211], v[36:51]
s_waitcnt vmcnt(2)
v_mfma_f32_32x32x16_bf16 v[20:35], a[232:235], v[212:215], v[20:35]
v_mfma_f32_32x32x16_bf16 v[36:51], a[236:239], v[212:215], v[36:51]
s_waitcnt vmcnt(1)
v_mfma_f32_32x32x16_bf16 v[20:35], a[240:243], v[216:219], v[20:35]
v_mfma_f32_32x32x16_bf16 v[36:51], a[244:247], v[216:219], v[36:51]
s_waitcnt vmcnt(0)
v_mfma_f32_32x32x16_bf16 v[224:239], a[248:251], v[220:223], v[20:35]
v_mfma_f32_32x32x16_bf16 v[240:255], a[252:255], v[220:223], v[36:51]
s_waitcnt vmcnt(0)
mega_kernel_o_f0c:
v_and_b32 v14, 1, v88
v_cmp_ne_u32 vcc, s61, v14
s_cbranch_vccz mega_kernel_o_f0k
s_sub_u32 s60, s62, s64
s_lshr_b32 s60, s60, s67
s_bfe_u32 s61, s60, 0x10001
s_and_b32 s60, s60, 1
s_lshl_b32 s60, s60, 12
buffer_load_dwordx4 v[88:91], v13, s[84:87], s60 offen sc1
s_waitcnt vmcnt(0)
s_branch mega_kernel_o_f0c
mega_kernel_o_f0k:
v_pk_add_f32 v[88:89], v[88:89], v[84:85]
v_pk_add_f32 v[90:91], v[90:91], v[86:87]
s_lshl_b32 s60, s62, 17
v_cvt_pk_bf16_f32 v92, v88, v89
v_cvt_pk_bf16_f32 v93, v90, v91
buffer_store_dwordx2 v[92:93], v11, s[8:11], s60 offen sc1
mega_kernel_o_imm:
s_waitcnt vmcnt(1)
v_min_i32_dpp v15, v15, v15 quad_perm:[1,0,3,2] row_mask:0xf bank_mask:0xf
s_nop 1
v_min_i32_dpp v15, v15, v15 quad_perm:[2,3,0,1] row_mask:0xf bank_mask:0xf
s_nop 1
v_min_i32_dpp v15, v15, v15 row_ror:4 row_mask:0xf bank_mask:0xf
s_nop 1
v_min_i32_dpp v15, v15, v15 row_ror:8 row_mask:0xf bank_mask:0xf
s_nop 0
v_readfirstlane_b32 s52, v15
s_min_i32 s52, s52, s65
s_cmp_gt_i32 s52, s54
s_cbranch_scc0 mega_kernel_o_im2
s_add_u32 s42, s42, s71
s_add_u32 s54, s54, s71
s_cmp_gt_i32 s52, s54
s_cbranch_scc0 mega_kernel_o_c1
s_add_u32 s51, s56, 0
s_and_b32 s51, s51, 0x7fff
s_and_b32 s63, s51, 0x6000
s_add_u32 s51, s51, s63
s_add_u32 s51, s51, s50
buffer_load_dwordx4 v[96:99], v6, s[84:87], s51 offen offset:0 sc1
buffer_load_dwordx4 v[100:103], v6, s[84:87], s51 offen offset:1024 sc1
buffer_load_dwordx4 v[104:107], v6, s[84:87], s51 offen offset:2048 sc1
buffer_load_dwordx4 v[108:111], v6, s[84:87], s51 offen offset:3072 sc1
s_add_u32 s51, s56, 4096
s_and_b32 s51, s51, 0x7fff
s_and_b32 s63, s51, 0x6000
s_add_u32 s51, s51, s63
s_add_u32 s51, s51, s50
buffer_load_dwordx4 v[112:115], v6, s[84:87], s51 offen offset:0 sc1
buffer_load_dwordx4 v[116:119], v6, s[84:87], s51 offen offset:1024 sc1
buffer_load_dwordx4 v[120:123], v6, s[84:87], s51 offen offset:2048 sc1
buffer_load_dwordx4 v[124:127], v6, s[84:87], s51 offen offset:3072 sc1
s_add_u32 s51, s56, 8192
s_and_b32 s51, s51, 0x7fff
s_and_b32 s63, s51, 0x6000
s_add_u32 s51, s51, s63
s_add_u32 s51, s51, s50
buffer_load_dwordx4 v[128:131], v6, s[84:87], s51 offen offset:0 sc1
buffer_load_dwordx4 v[132:135], v6, s[84:87], s51 offen offset:1024 sc1
buffer_load_dwordx4 v[136:139], v6, s[84:87], s51 offen offset:2048 sc1
buffer_load_dwordx4 v[140:143], v6, s[84:87], s51 offen offset:3072 sc1
s_add_u32 s51, s56, 12288
s_and_b32 s51, s51, 0x7fff
s_and_b32 s63, s51, 0x6000
s_add_u32 s51, s51, s63
s_add_u32 s51, s51, s50
buffer_load_dwordx4 v[144:147], v6, s[84:87], s51 offen offset:0 sc1
buffer_load_dwordx4 v[148:151], v6, s[84:87], s51 offen offset:1024 sc1
buffer_load_dwordx4 v[152:155], v6, s[84:87], s51 offen offset:2048 sc1
buffer_load_dwordx4 v[156:159], v6, s[84:87], s51 offen offset:3072 sc1
s_add_u32 s51, s56, 16384
s_and_b32 s51, s51, 0x7fff
s_and_b32 s63, s51, 0x6000
s_add_u32 s51, s51, s63
s_add_u32 s51, s51, s50
buffer_load_dwordx4 v[160:163], v6, s[84:87], s51 offen offset:0 sc1
buffer_load_dwordx4 v[164:167], v6, s[84:87], s51 offen offset:1024 sc1
buffer_load_dwordx4 v[168:171], v6, s[84:87], s51 offen offset:2048 sc1
buffer_load_dwordx4 v[172:175], v6, s[84:87], s51 offen offset:3072 sc1
s_add_u32 s51, s56, 20480
s_and_b32 s51, s51, 0x7fff
s_and_b32 s63, s51, 0x6000
s_add_u32 s51, s51, s63
s_add_u32 s51, s51, s50
buffer_load_dwordx4 v[176:179], v6, s[84:87], s51 offen offset:0 sc1
buffer_load_dwordx4 v[180:183], v6, s[84:87], s51 offen offset:1024 sc1
buffer_load_dwordx4 v[184:187], v6, s[84:87], s51 offen offset:2048 sc1
buffer_load_dwordx4 v[188:191], v6, s[84:87], s51 offen offset:3072 sc1
s_add_u32 s51, s56, 24576
s_and_b32 s51, s51, 0x7fff
s_and_b32 s63, s51, 0x6000
s_add_u32 s51, s51, s63
s_add_u32 s51, s51, s50
buffer_load_dwordx4 v[192:195], v6, s[84:87], s51 offen offset:0 sc1
buffer_load_dwordx4 v[196:199], v6, s[84:87], s51 offen offset:1024 sc1
buffer_load_dwordx4 v[200:203], v6, s[84:87], s51 offen offset:2048 sc1
buffer_load_dwordx4 v[204:207], v6, s[84:87], s51 offen offset:3072 sc1
s_add_u32 s51, s56, 28672
s_and_b32 s51, s51, 0x7fff
s_and_b32 s63, s51, 0x6000
s_add_u32 s51, s51, s63
s_add_u32 s51, s51, s50
buffer_load_dwordx4 v[208:211], v6, s[84:87], s51 offen offset:0 sc1
buffer_load_dwordx4 v[212:215], v6, s[84:87], s51 offen offset:1024 sc1
buffer_load_dwordx4 v[216:219], v6, s[84:87], s51 offen offset:2048 sc1
buffer_load_dwordx4 v[220:223], v6, s[84:87], s51 offen offset:3072 sc1
s_branch mega_kernel_o_w1
mega_kernel_o_c0:
s_add_u32 s54, s42, s71
s_sub_u32 s62, s42, s71
s_lshr_b32 s63, s42, 2
s_xnor_b32 s63, s63, s98
s_and_b32 s63, s63, 1
s_lshl_b32 s63, s63, 13
s_lshl_b32 s50, s42, 19
s_add_u32 s50, s50, s63
s_add_u32 s51, s56, 0
s_and_b32 s51, s51, 0x7fff
s_and_b32 s63, s51, 0x6000
s_add_u32 s51, s51, s63
s_add_u32 s51, s51, s50
buffer_load_dwordx4 v[96:99], v6, s[84:87], s51 offen offset:0 sc1
buffer_load_dwordx4 v[100:103], v6, s[84:87], s51 offen offset:1024 sc1
buffer_load_dwordx4 v[104:107], v6, s[84:87], s51 offen offset:2048 sc1
buffer_load_dwordx4 v[108:111], v6, s[84:87], s51 offen offset:3072 sc1
s_add_u32 s51, s56, 4096
s_and_b32 s51, s51, 0x7fff
s_and_b32 s63, s51, 0x6000
s_add_u32 s51, s51, s63
s_add_u32 s51, s51, s50
buffer_load_dwordx4 v[112:115], v6, s[84:87], s51 offen offset:0 sc1
buffer_load_dwordx4 v[116:119], v6, s[84:87], s51 offen offset:1024 sc1
buffer_load_dwordx4 v[120:123], v6, s[84:87], s51 offen offset:2048 sc1
buffer_load_dwordx4 v[124:127], v6, s[84:87], s51 offen offset:3072 sc1
s_waitcnt vmcnt(7)
v_mfma_f32_32x32x16_bf16 v[20:35], a[0:3], v[96:99], 0
v_mfma_f32_32x32x16_bf16 v[36:51], a[4:7], v[96:99], 0
s_add_u32 s51, s56, 8192
s_and_b32 s51, s51, 0x7fff
s_and_b32 s63, s51, 0x6000
s_add_u32 s51, s51, s63
s_add_u32 s51, s51, s50
buffer_load_dwordx4 v[128:131], v6, s[84:87], s51 offen offset:0 sc1
s_waitcnt vmcnt(7)
v_mfma_f32_32x32x16_bf16 v[20:35], a[8:11], v[100:103], v[20:35]
v_mfma_f32_32x32x16_bf16 v[36:51], a[12:15], v[100:103], v[36:51]
buffer_load_dwordx4 v[132:135], v6, s[84:87], s51 offen offset:1024 sc1
s_waitcnt vmcnt(7)
v_mfma_f32_32x32x16_bf16 v[20:35], a[16:19], v[104:107], v[20:35]
v_mfma_f32_32x32x16_bf16 v[36:51], a[20:23], v[104:107], v[36:51]
buffer_load_dwordx4 v[136:139], v6, s[84:87], s51 offen offset:2048 sc1
s_waitcnt vmcnt(7)
v_mfma_f32_32x32x16_bf16 v[20:35], a[24:27], v[108:111], v[20:35]
v_mfma_f32_32x32x16_bf16 v[36:51], a[28:31], v[108:111], v[36:51]
buffer_load_dwordx4 v[140:143], v6, s[84:87], s51 offen offset:3072 sc1
s_waitcnt vmcnt(7)
v_mfma_f32_32x32x16_bf16 v[20:35], a[32:35], v[112:115], v[20:35]
v_mfma_f32_32x32x16_bf16 v[36:51], a[36:39], v[112:115], v[36:51]
s_add_u32 s51, s56, 12288
s_and_b32 s51, s51, 0x7fff
s_and_b32 s63, s51, 0x6000
s_add_u32 s51, s51, s63
s_add_u32 s51, s51, s50
buffer_load_dwordx4 v[144:147], v6, s[84:87], s51 offen offset:0 sc1
s_waitcnt vmcnt(7)
v_mfma_f32_32x32x16_bf16 v[20:35], a[40:43], v[116:119], v[20:35]
v_mfma_f32_32x32x16_bf16 v[36:51], a[44:47], v[116:119], v[36:51]
buffer_load_dwordx4 v[148:151], v6, s[84:87], s51 offen offset:1024 sc1
s_waitcnt vmcnt(7)
v_mfma_f32_32x32x16_bf16 v[20:35], a[48:51], v[120:123], v[20:35]
v_mfma_f32_32x32x16_bf16 v[36:51], a[52:55], v[120:123], v[36:51]
buffer_load_dwordx4 v[152:155], v6, s[84:87], s51 offen offset:2048 sc1
s_waitcnt vmcnt(7)
v_mfma_f32_32x32x16_bf16 v[20:35], a[56:59], v[124:127], v[20:35]
v_mfma_f32_32x32x16_bf16 v[36:51], a[60:63], v[124:127], v[36:51]
buffer_load_dwordx4 v[156:159], v6, s[84:87], s51 offen offset:3072 sc1
s_waitcnt vmcnt(7)
v_mfma_f32_32x32x16_bf16 v[20:35], a[64:67], v[128:131], v[20:35]
v_mfma_f32_32x32x16_bf16 v[36:51], a[68:71], v[128:131], v[36:51]
s_add_u32 s51, s56, 16384
s_and_b32 s51, s51, 0x7fff
s_and_b32 s63, s51, 0x6000
s_add_u32 s51, s51, s63
s_add_u32 s51, s51, s50
buffer_load_dwordx4 v[160:163], v6, s[84:87], s51 offen offset:0 sc1
s_waitcnt vmcnt(7)
v_mfma_f32_32x32x16_bf16 v[20:35], a[72:75], v[132:135], v[20:35]
v_mfma_f32_32x32x16_bf16 v[36:51], a[76:79], v[132:135], v[36:51]
buffer_load_dwordx4 v[164:167], v6, s[84:87], s51 offen offset:1024 sc1
s_waitcnt vmcnt(7)
v_mfma_f32_32x32x16_bf16 v[20:35], a[80:83], v[136:139], v[20:35]
v_mfma_f32_32x32x16_bf16 v[36:51], a[84:87], v[136:139], v[36:51]
buffer_load_dwordx4 v[168:171], v6, s[84:87], s51 offen offset:2048 sc1
s_waitcnt vmcnt(7)
v_mfma_f32_32x32x16_bf16 v[20:35], a[88:91], v[140:143], v[20:35]
v_mfma_f32_32x32x16_bf16 v[36:51], a[92:95], v[140:143], v[36:51]
buffer_load_dwordx4 v[172:175], v6, s[84:87], s51 offen offset:3072 sc1
s_waitcnt vmcnt(7)
v_mfma_f32_32x32x16_bf16 v[20:35], a[96:99], v[144:147], v[20:35]
v_mfma_f32_32x32x16_bf16 v[36:51], a[100:103], v[144:147], v[36:51]
s_add_u32 s51, s56, 20480
s_and_b32 s51, s51, 0x7fff
s_and_b32 s63, s51, 0x6000
s_add_u32 s51, s51, s63
s_add_u32 s51, s51, s50
buffer_load_dwordx4 v[176:179], v6, s[84:87], s51 offen offset:0 sc1
s_waitcnt vmcnt(7)
v_mfma_f32_32x32x16_bf16 v[20:35], a[104:107], v[148:151], v[20:35]
v_mfma_f32_32x32x16_bf16 v[36:51], a[108:111], v[148:151], v[36:51]
buffer_load_dwordx4 v[180:183], v6, s[84:87], s51 offen offset:1024 sc1
s_waitcnt vmcnt(7)
v_mfma_f32_32x32x16_bf16 v[20:35], a[112:115], v[152:155], v[20:35]
v_mfma_f32_32x32x16_bf16 v[36:51], a[116:119], v[152:155], v[36:51]
buffer_load_dwordx4 v[184:187], v6, s[84:87], s51 offen offset:2048 sc1
s_waitcnt vmcnt(7)
v_mfma_f32_32x32x16_bf16 v[20:35], a[120:123], v[156:159], v[20:35]
v_mfma_f32_32x32x16_bf16 v[36:51], a[124:127], v[156:159], v[36:51]
buffer_load_dwordx4 v[188:191], v6, s[84:87], s51 offen offset:3072 sc1
s_waitcnt vmcnt(7)
v_mfma_f32_32x32x16_bf16 v[20:35], a[128:131], v[160:163], v[20:35]
v_mfma_f32_32x32x16_bf16 v[36:51], a[132:135], v[160:163], v[36:51]
s_add_u32 s51, s56, 24576
s_and_b32 s51, s51, 0x7fff
s_and_b32 s63, s51, 0x6000
s_add_u32 s51, s51, s63
s_add_u32 s51, s51, s50
buffer_load_dwordx4 v[192:195], v6, s[84:87], s51 offen offset:0 sc1
s_waitcnt vmcnt(7)
v_mfma_f32_32x32x16_bf16 v[20:35], a[136:139], v[164:167], v[20:35]
v_mfma_f32_32x32x16_bf16 v[36:51], a[140:143], v[164:167], v[36:51]
buffer_load_dwordx4 v[196:199], v6, s[84:87], s51 offen offset:1024 sc1
s_waitcnt vmcnt(7)
v_mfma_f32_32x32x16_bf16 v[20:35], a[144:147], v[168:171], v[20:35]
v_mfma_f32_32x32x16_bf16 v[36:51], a[148:151], v[168:171], v[36:51]
buffer_load_dwordx4 v[200:203], v6, s[84:87], s51 offen offset:2048 sc1
s_waitcnt vmcnt(7)
v_mfma_f32_32x32x16_bf16 v[20:35], a[152:155], v[172:175], v[20:35]
v_mfma_f32_32x32x16_bf16 v[36:51], a[156:159], v[172:175], v[36:51]
buffer_load_dwordx4 v[204:207], v6, s[84:87], s51 offen offset:3072 sc1
s_waitcnt vmcnt(7)
v_mfma_f32_32x32x16_bf16 v[20:35], a[160:163], v[176:179], v[20:35]
v_mfma_f32_32x32x16_bf16 v[36:51], a[164:167], v[176:179], v[36:51]
s_add_u32 s51, s56, 28672
s_and_b32 s51, s51, 0x7fff
s_and_b32 s63, s51, 0x6000
s_add_u32 s51, s51, s63
s_add_u32 s51, s51, s50
buffer_load_dwordx4 v[208:211], v6, s[84:87], s51 offen offset:0 sc1
s_waitcnt vmcnt(7)
v_mfma_f32_32x32x16_bf16 v[20:35], a[168:171], v[180:183], v[20:35]
v_mfma_f32_32x32x16_bf16 v[36:51], a[172:175], v[180:183], v[36:51]
buffer_load_dwordx4 v[212:215], v6, s[84:87], s51 offen offset:1024 sc1
s_waitcnt vmcnt(7)
v_mfma_f32_32x32x16_bf16 v[20:35], a[176:179], v[184:187], v[20:35]
v_mfma_f32_32x32x16_bf16 v[36:51], a[180:183], v[184:187], v[36:51]
buffer_load_dwordx4 v[216:219], v6, s[84:87], s51 offen offset:2048 sc1
s_waitcnt vmcnt(7)
v_mfma_f32_32x32x16_bf16 v[20:35], a[184:187], v[188:191], v[20:35]
v_mfma_f32_32x32x16_bf16 v[36:51], a[188:191], v[188:191], v[36:51]
buffer_load_dwordx4 v[220:223], v6, s[84:87], s51 offen offset:3072 sc1
s_waitcnt vmcnt(7)
v_mfma_f32_32x32x16_bf16 v[20:35], a[192:195], v[192:195], v[20:35]
v_mfma_f32_32x32x16_bf16 v[36:51], a[196:199], v[192:195], v[36:51]
buffer_load_dword v15, v7, s[84:87], 0 offen sc1
s_waitcnt vmcnt(6)
v_mfma_f32_32x32x16_bf16 v[20:35], a[200:203], v[196:199], v[20:35]
v_mfma_f32_32x32x16_bf16 v[36:51], a[204:207], v[196:199], v[36:51]
s_waitcnt vmcnt(5)
v_mfma_f32_32x32x16_bf16 v[20:35], a[208:211], v[200:203], v[20:35]
v_mfma_f32_32x32x16_bf16 v[36:51], a[212:215], v[200:203], v[36:51]
s_waitcnt vmcnt(4)
v_mfma_f32_32x32x16_bf16 v[20:35], a[216:219], v[204:207], v[20:35]
v_mfma_f32_32x32x16_bf16 v[36:51], a[220:223], v[204:207], v[36:51]
s_waitcnt vmcnt(3)
v_mfma_f32_32x32x16_bf16 v[20:35], a[224:227], v[208:211], v[20:35]
v_mfma_f32_32x32x16_bf16 v[36:51], a[228:231], v[208:211], v[36:51]
s_waitcnt vmcnt(2)
v_mfma_f32_32x32x16_bf16 v[20:35], a[232:235], v[212:215], v[20:35]
v_mfma_f32_32x32x16_bf16 v[36:51], a[236:239], v[212:215], v[36:51]
s_waitcnt vmcnt(1)
v_mfma_f32_32x32x16_bf16 v[20:35], a[240:243], v[216:219], v[20:35]
v_mfma_f32_32x32x16_bf16 v[36:51], a[244:247], v[216:219], v[36:51]
s_waitcnt vmcnt(0)
v_mfma_f32_32x32x16_bf16 v[224:239], a[248:251], v[220:223], v[20:35]
v_mfma_f32_32x32x16_bf16 v[240:255], a[252:255], v[220:223], v[36:51]
s_lshr_b32 s63, s54, 2
s_xnor_b32 s63, s63, s98
s_and_b32 s63, s63, 1
s_lshl_b32 s63, s63, 13
s_lshl_b32 s50, s54, 19
s_add_u32 s50, s50, s63
s_branch mega_kernel_o_imm
mega_kernel_o_c1:
s_add_u32 s54, s42, s71
s_sub_u32 s62, s42, s71
s_lshr_b32 s63, s42, 2
s_xnor_b32 s63, s63, s98
s_and_b32 s63, s63, 1
s_lshl_b32 s63, s63, 13
s_lshl_b32 s50, s42, 19
s_add_u32 s50, s50, s63
s_add_u32 s51, s56, 0
s_and_b32 s51, s51, 0x7fff
s_and_b32 s63, s51, 0x6000
s_add_u32 s51, s51, s63
s_add_u32 s51, s51, s50
buffer_load_dwordx4 v[96:99], v6, s[84:87], s51 offen offset:0 sc1
buffer_load_dwordx4 v[100:103], v6, s[84:87], s51 offen offset:1024 sc1
buffer_load_dwordx4 v[104:107], v6, s[84:87], s51 offen offset:2048 sc1
buffer_load_dwordx4 v[108:111], v6, s[84:87], s51 offen offset:3072 sc1
s_add_u32 s51, s56, 4096
s_and_b32 s51, s51, 0x7fff
s_and_b32 s63, s51, 0x6000
s_add_u32 s51, s51, s63
s_add_u32 s51, s51, s50
buffer_load_dwordx4 v[112:115], v6, s[84:87], s51 offen offset:0 sc1
buffer_load_dwordx4 v[116:119], v6, s[84:87], s51 offen offset:1024 sc1
buffer_load_dwordx4 v[120:123], v6, s[84:87], s51 offen offset:2048 sc1
buffer_load_dwordx4 v[124:127], v6, s[84:87], s51 offen offset:3072 sc1
v_add_u32 v2, s53, v8
v_add_u32 v3, s53, v9
v_add_u32 v4, s53, v10
ds_write_b128 v2, v[224:227] offset:0
ds_write_b128 v2, v[228:231] offset:1088
ds_write_b128 v2, v[232:235] offset:2176
ds_write_b128 v2, v[236:239] offset:3264
ds_write_b128 v2, v[240:243] offset:4352
ds_write_b128 v2, v[244:247] offset:5440
ds_write_b128 v2, v[248:251] offset:6528
ds_write_b128 v2, v[252:255] offset:7616
s_waitcnt lgkmcnt(0)
s_barrier
ds_read_b128 v[52:55], v4 offset:0
ds_read_b128 v[56:59], v4 offset:8704
ds_read_b128 v[60:63], v4 offset:17408
ds_read_b128 v[64:67], v4 offset:26112
ds_read_b128 v[68:71], v3 offset:0
ds_read_b128 v[72:75], v3 offset:8704
ds_read_b128 v[76:79], v3 offset:17408
ds_read_b128 v[80:83], v3 offset:26112
s_sub_u32 s53, 34816, s53
s_sub_u32 s60, s62, s64
s_lshr_b32 s60, s60, s67
s_bfe_u32 s61, s60, 0x10001
s_and_b32 s60, s60, 1
s_lshl_b32 s60, s60, 12
s_waitcnt lgkmcnt(4)
v_add_f32 v52, v52, v56
v_add_f32 v60, v60, v64
v_add_f32 v53, v53, v57
v_add_f32 v61, v61, v65
v_add_f32 v54, v54, v58
v_add_f32 v62, v62, v66
v_add_f32 v55, v55, v59
v_add_f32 v63, v63, v67
v_add_f32 v52, v52, v60
v_add_f32 v53, v53, v61
v_add_f32 v54, v54, v62
v_add_f32 v55, v55, v63
v_and_or_b32 v52, v52, -2, s61
s_cmp_eq_u32 s95, 0
s_cbranch_scc1 mega_kernel_o_sa3
buffer_store_dwordx4 v[52:55], v12, s[84:87], s60 offen sc1
s_branch mega_kernel_o_sb3
mega_kernel_o_sa3:
buffer_store_dwordx4 v[52:55], v12, s[84:87], s60 offen
mega_kernel_o_sb3:
s_waitcnt lgkmcnt(0)
v_add_f32 v68, v68, v72
v_add_f32 v76, v76, v80
v_add_f32 v69, v69, v73
v_add_f32 v77, v77, v81
v_add_f32 v70, v70, v74
v_add_f32 v78, v78, v82
v_add_f32 v71, v71, v75
v_add_f32 v79, v79, v83
v_add_f32 v84, v68, v76
v_add_f32 v85, v69, v77
v_add_f32 v86, v70, v78
v_add_f32 v87, v71, v79
s_waitcnt vmcnt(7)
v_mfma_f32_32x32x16_bf16 v[20:35], a[0:3], v[96:99], 0
v_mfma_f32_32x32x16_bf16 v[36:51], a[4:7], v[96:99], 0
s_add_u32 s51, s56, 8192
s_and_b32 s51, s51, 0x7fff
s_and_b32 s63, s51, 0x6000
s_add_u32 s51, s51, s63
s_add_u32 s51, s51, s50
buffer_load_dwordx4 v[128:131], v6, s[84:87], s51 offen offset:0 sc1
s_waitcnt vmcnt(7)
v_mfma_f32_32x32x16_bf16 v[20:35], a[8:11], v[100:103], v[20:35]
v_mfma_f32_32x32x16_bf16 v[36:51], a[12:15], v[100:103], v[36:51]
buffer_load_dwordx4 v[132:135], v6, s[84:87], s51 offen offset:1024 sc1
s_waitcnt vmcnt(7)
v_mfma_f32_32x32x16_bf16 v[20:35], a[16:19], v[104:107], v[20:35]
v_mfma_f32_32x32x16_bf16 v[36:51], a[20:23], v[104:107], v[36:51]
buffer_load_dwordx4 v[136:139], v6, s[84:87], s51 offen offset:2048 sc1
s_waitcnt vmcnt(7)
v_mfma_f32_32x32x16_bf16 v[20:35], a[24:27], v[108:111], v[20:35]
v_mfma_f32_32x32x16_bf16 v[36:51], a[28:31], v[108:111], v[36:51]
buffer_load_dwordx4 v[140:143], v6, s[84:87], s51 offen offset:3072 sc1
s_waitcnt vmcnt(7)
v_mfma_f32_32x32x16_bf16 v[20:35], a[32:35], v[112:115], v[20:35]
v_mfma_f32_32x32x16_bf16 v[36:51], a[36:39], v[112:115], v[36:51]
s_add_u32 s51, s56, 12288
s_and_b32 s51, s51, 0x7fff
s_and_b32 s63, s51, 0x6000
s_add_u32 s51, s51, s63
s_add_u32 s51, s51, s50
buffer_load_dwordx4 v[144:147], v6, s[84:87], s51 offen offset:0 sc1
s_waitcnt vmcnt(7)
v_mfma_f32_32x32x16_bf16 v[20:35], a[40:43], v[116:119], v[20:35]
v_mfma_f32_32x32x16_bf16 v[36:51], a[44:47], v[116:119], v[36:51]
buffer_load_dwordx4 v[148:151], v6, s[84:87], s51 offen offset:1024 sc1
s_waitcnt vmcnt(7)
v_mfma_f32_32x32x16_bf16 v[20:35], a[48:51], v[120:123], v[20:35]
v_mfma_f32_32x32x16_bf16 v[36:51], a[52:55], v[120:123], v[36:51]
buffer_load_dwordx4 v[152:155], v6, s[84:87], s51 offen offset:2048 sc1
s_waitcnt vmcnt(7)
v_mfma_f32_32x32x16_bf16 v[20:35], a[56:59], v[124:127], v[20:35]
v_mfma_f32_32x32x16_bf16 v[36:51], a[60:63], v[124:127], v[36:51]
buffer_load_dwordx4 v[156:159], v6, s[84:87], s51 offen offset:3072 sc1
s_waitcnt vmcnt(7)
v_mfma_f32_32x32x16_bf16 v[20:35], a[64:67], v[128:131], v[20:35]
v_mfma_f32_32x32x16_bf16 v[36:51], a[68:71], v[128:131], v[36:51]
s_add_u32 s51, s56, 16384
s_and_b32 s51, s51, 0x7fff
s_and_b32 s63, s51, 0x6000
s_add_u32 s51, s51, s63
s_add_u32 s51, s51, s50
buffer_load_dwordx4 v[160:163], v6, s[84:87], s51 offen offset:0 sc1
s_waitcnt vmcnt(7)
v_mfma_f32_32x32x16_bf16 v[20:35], a[72:75], v[132:135], v[20:35]
v_mfma_f32_32x32x16_bf16 v[36:51], a[76:79], v[132:135], v[36:51]
buffer_load_dwordx4 v[164:167], v6, s[84:87], s51 offen offset:1024 sc1
s_waitcnt vmcnt(7)
v_mfma_f32_32x32x16_bf16 v[20:35], a[80:83], v[136:139], v[20:35]
v_mfma_f32_32x32x16_bf16 v[36:51], a[84:87], v[136:139], v[36:51]
buffer_load_dwordx4 v[168:171], v6, s[84:87], s51 offen offset:2048 sc1
s_waitcnt vmcnt(7)
v_mfma_f32_32x32x16_bf16 v[20:35], a[88:91], v[140:143], v[20:35]
v_mfma_f32_32x32x16_bf16 v[36:51], a[92:95], v[140:143], v[36:51]
buffer_load_dwordx4 v[172:175], v6, s[84:87], s51 offen offset:3072 sc1
s_waitcnt vmcnt(7)
v_mfma_f32_32x32x16_bf16 v[20:35], a[96:99], v[144:147], v[20:35]
v_mfma_f32_32x32x16_bf16 v[36:51], a[100:103], v[144:147], v[36:51]
s_add_u32 s51, s56, 20480
s_and_b32 s51, s51, 0x7fff
s_and_b32 s63, s51, 0x6000
s_add_u32 s51, s51, s63
s_add_u32 s51, s51, s50
buffer_load_dwordx4 v[176:179], v6, s[84:87], s51 offen offset:0 sc1
s_waitcnt vmcnt(7)
v_mfma_f32_32x32x16_bf16 v[20:35], a[104:107], v[148:151], v[20:35]
v_mfma_f32_32x32x16_bf16 v[36:51], a[108:111], v[148:151], v[36:51]
buffer_load_dwordx4 v[180:183], v6, s[84:87], s51 offen offset:1024 sc1
s_waitcnt vmcnt(7)
v_mfma_f32_32x32x16_bf16 v[20:35], a[112:115], v[152:155], v[20:35]
v_mfma_f32_32x32x16_bf16 v[36:51], a[116:119], v[152:155], v[36:51]
buffer_load_dwordx4 v[184:187], v6, s[84:87], s51 offen offset:2048 sc1
s_waitcnt vmcnt(7)
v_mfma_f32_32x32x16_bf16 v[20:35], a[120:123], v[156:159], v[20:35]
v_mfma_f32_32x32x16_bf16 v[36:51], a[124:127], v[156:159], v[36:51]
buffer_load_dwordx4 v[188:191], v6, s[84:87], s51 offen offset:3072 sc1
s_waitcnt vmcnt(7)
v_mfma_f32_32x32x16_bf16 v[20:35], a[128:131], v[160:163], v[20:35]
v_mfma_f32_32x32x16_bf16 v[36:51], a[132:135], v[160:163], v[36:51]
s_add_u32 s51, s56, 24576
s_and_b32 s51, s51, 0x7fff
s_and_b32 s63, s51, 0x6000
s_add_u32 s51, s51, s63
s_add_u32 s51, s51, s50
buffer_load_dwordx4 v[192:195], v6, s[84:87], s51 offen offset:0 sc1
s_waitcnt vmcnt(7)
v_mfma_f32_32x32x16_bf16 v[20:35], a[136:139], v[164:167], v[20:35]
v_mfma_f32_32x32x16_bf16 v[36:51], a[140:143], v[164:167], v[36:51]
buffer_load_dwordx4 v[196:199], v6, s[84:87], s51 offen offset:1024 sc1
s_waitcnt vmcnt(7)
v_mfma_f32_32x32x16_bf16 v[20:35], a[144:147], v[168:171], v[20:35]
v_mfma_f32_32x32x16_bf16 v[36:51], a[148:151], v[168:171], v[36:51]
buffer_load_dwordx4 v[200:203], v6, s[84:87], s51 offen offset:2048 sc1
s_waitcnt vmcnt(7)
v_mfma_f32_32x32x16_bf16 v[20:35], a[152:155], v[172:175], v[20:35]
v_mfma_f32_32x32x16_bf16 v[36:51], a[156:159], v[172:175], v[36:51]
buffer_load_dwordx4 v[204:207], v6, s[84:87], s51 offen offset:3072 sc1
s_waitcnt vmcnt(7)
v_mfma_f32_32x32x16_bf16 v[20:35], a[160:163], v[176:179], v[20:35]
v_mfma_f32_32x32x16_bf16 v[36:51], a[164:167], v[176:179], v[36:51]
s_add_u32 s51, s56, 28672
s_and_b32 s51, s51, 0x7fff
s_and_b32 s63, s51, 0x6000
s_add_u32 s51, s51, s63
s_add_u32 s51, s51, s50
buffer_load_dwordx4 v[208:211], v6, s[84:87], s51 offen offset:0 sc1
s_waitcnt vmcnt(7)
v_mfma_f32_32x32x16_bf16 v[20:35], a[168:171], v[180:183], v[20:35]
v_mfma_f32_32x32x16_bf16 v[36:51], a[172:175], v[180:183], v[36:51]
buffer_load_dwordx4 v[212:215], v6, s[84:87], s51 offen offset:1024 sc1
s_waitcnt vmcnt(7)
v_mfma_f32_32x32x16_bf16 v[20:35], a[176:179], v[184:187], v[20:35]
v_mfma_f32_32x32x16_bf16 v[36:51], a[180:183], v[184:187], v[36:51]
buffer_load_dwordx4 v[216:219], v6, s[84:87], s51 offen offset:2048 sc1
s_waitcnt vmcnt(7)
v_mfma_f32_32x32x16_bf16 v[20:35], a[184:187], v[188:191], v[20:35]
v_mfma_f32_32x32x16_bf16 v[36:51], a[188:191], v[188:191], v[36:51]
buffer_load_dwordx4 v[220:223], v6, s[84:87], s51 offen offset:3072 sc1
s_waitcnt vmcnt(7)
v_mfma_f32_32x32x16_bf16 v[20:35], a[192:195], v[192:195], v[20:35]
v_mfma_f32_32x32x16_bf16 v[36:51], a[196:199], v[192:195], v[36:51]
s_sub_u32 s60, s62, s64
s_lshr_b32 s60, s60, s67
s_bfe_u32 s61, s60, 0x10001
s_and_b32 s60, s60, 1
s_lshl_b32 s60, s60, 12
buffer_load_dwordx4 v[88:91], v13, s[84:87], s60 offen sc1
buffer_load_dword v15, v7, s[84:87], 0 offen sc1
s_waitcnt vmcnt(6)
v_mfma_f32_32x32x16_bf16 v[20:35], a[200:203], v[196:199], v[20:35]
v_mfma_f32_32x32x16_bf16 v[36:51], a[204:207], v[196:199], v[36:51]
s_waitcnt vmcnt(5)
v_mfma_f32_32x32x16_bf16 v[20:35], a[208:211], v[200:203], v[20:35]
v_mfma_f32_32x32x16_bf16 v[36:51], a[212:215], v[200:203], v[36:51]
s_waitcnt vmcnt(4)
v_mfma_f32_32x32x16_bf16 v[20:35], a[216:219], v[204:207], v[20:35]
v_mfma_f32_32x32x16_bf16 v[36:51], a[220:223], v[204:207], v[36:51]
s_waitcnt vmcnt(3)
v_mfma_f32_32x32x16_bf16 v[20:35], a[224:227], v[208:211], v[20:35]
v_mfma_f32_32x32x16_bf16 v[36:51], a[228:231], v[208:211], v[36:51]
s_waitcnt vmcnt(2)
v_mfma_f32_32x32x16_bf16 v[20:35], a[232:235], v[212:215], v[20:35]
v_mfma_f32_32x32x16_bf16 v[36:51], a[236:239], v[212:215], v[36:51]
s_waitcnt vmcnt(1)
v_mfma_f32_32x32x16_bf16 v[20:35], a[240:243], v[216:219], v[20:35]
v_mfma_f32_32x32x16_bf16 v[36:51], a[244:247], v[216:219], v[36:51]
s_waitcnt vmcnt(0)
v_mfma_f32_32x32x16_bf16 v[224:239], a[248:251], v[220:223], v[20:35]
v_mfma_f32_32x32x16_bf16 v[240:255], a[252:255], v[220:223], v[36:51]
s_waitcnt vmcnt(0)
mega_kernel_o_fcc:
v_and_b32 v14, 1, v88
v_cmp_ne_u32 vcc, s61, v14
s_cbranch_vccz mega_kernel_o_fck
s_sub_u32 s60, s62, s64
s_lshr_b32 s60, s60, s67
s_bfe_u32 s61, s60, 0x10001
s_and_b32 s60, s60, 1
s_lshl_b32 s60, s60, 12
buffer_load_dwordx4 v[88:91], v13, s[84:87], s60 offen sc1
s_waitcnt vmcnt(0)
s_branch mega_kernel_o_fcc
mega_kernel_o_fck:
v_pk_add_f32 v[88:89], v[88:89], v[84:85]
v_pk_add_f32 v[90:91], v[90:91], v[86:87]
s_lshl_b32 s60, s62, 17
v_cvt_pk_bf16_f32 v92, v88, v89
v_cvt_pk_bf16_f32 v93, v90, v91
buffer_store_dwordx2 v[92:93], v11, s[8:11], s60 offen sc1
s_lshr_b32 s63, s54, 2
s_xnor_b32 s63, s63, s98
s_and_b32 s63, s63, 1
s_lshl_b32 s63, s63, 13
s_lshl_b32 s50, s54, 19
s_add_u32 s50, s50, s63
s_branch mega_kernel_o_imm
mega_kernel_o_im2:
v_add_u32 v2, s53, v8
v_add_u32 v3, s53, v9
v_add_u32 v4, s53, v10
ds_write_b128 v2, v[224:227] offset:0
ds_write_b128 v2, v[228:231] offset:1088
ds_write_b128 v2, v[232:235] offset:2176
ds_write_b128 v2, v[236:239] offset:3264
ds_write_b128 v2, v[240:243] offset:4352
ds_write_b128 v2, v[244:247] offset:5440
ds_write_b128 v2, v[248:251] offset:6528
ds_write_b128 v2, v[252:255] offset:7616
s_waitcnt lgkmcnt(0)
s_barrier
ds_read_b128 v[52:55], v4 offset:0
ds_read_b128 v[56:59], v4 offset:8704
ds_read_b128 v[60:63], v4 offset:17408
ds_read_b128 v[64:67], v4 offset:26112
ds_read_b128 v[68:71], v3 offset:0
ds_read_b128 v[72:75], v3 offset:8704
ds_read_b128 v[76:79], v3 offset:17408
ds_read_b128 v[80:83], v3 offset:26112
s_sub_u32 s53, 34816, s53
s_sub_u32 s60, s42, s64
s_lshr_b32 s60, s60, s67
s_bfe_u32 s61, s60, 0x10001
s_and_b32 s60, s60, 1
s_lshl_b32 s60, s60, 12
s_waitcnt lgkmcnt(4)
v_add_f32 v52, v52, v56
v_add_f32 v60, v60, v64
v_add_f32 v53, v53, v57
v_add_f32 v61, v61, v65
v_add_f32 v54, v54, v58
v_add_f32 v62, v62, v66
v_add_f32 v55, v55, v59
v_add_f32 v63, v63, v67
v_add_f32 v52, v52, v60
v_add_f32 v53, v53, v61
v_add_f32 v54, v54, v62
v_add_f32 v55, v55, v63
v_and_or_b32 v52, v52, -2, s61
s_cmp_eq_u32 s95, 0
s_cbranch_scc1 mega_kernel_o_sa4
buffer_store_dwordx4 v[52:55], v12, s[84:87], s60 offen sc1
s_branch mega_kernel_o_sb4
mega_kernel_o_sa4:
buffer_store_dwordx4 v[52:55], v12, s[84:87], s60 offen
mega_kernel_o_sb4:
s_waitcnt lgkmcnt(0)
v_add_f32 v68, v68, v72
v_add_f32 v76, v76, v80
v_add_f32 v69, v69, v73
v_add_f32 v77, v77, v81
v_add_f32 v70, v70, v74
v_add_f32 v78, v78, v82
v_add_f32 v71, v71, v75
v_add_f32 v79, v79, v83
v_add_f32 v84, v68, v76
v_add_f32 v85, v69, v77
v_add_f32 v86, v70, v78
v_add_f32 v87, v71, v79
s_sub_u32 s60, s42, s64
s_lshr_b32 s60, s60, s67
s_bfe_u32 s61, s60, 0x10001
s_and_b32 s60, s60, 1
s_lshl_b32 s60, s60, 12
buffer_load_dwordx4 v[88:91], v13, s[84:87], s60 offen sc1
s_waitcnt vmcnt(0)
mega_kernel_o_f2c:
v_and_b32 v14, 1, v88
v_cmp_ne_u32 vcc, s61, v14
s_cbranch_vccz mega_kernel_o_f2k
s_sub_u32 s60, s42, s64
s_lshr_b32 s60, s60, s67
s_bfe_u32 s61, s60, 0x10001
s_and_b32 s60, s60, 1
s_lshl_b32 s60, s60, 12
buffer_load_dwordx4 v[88:91], v13, s[84:87], s60 offen sc1
s_waitcnt vmcnt(0)
s_branch mega_kernel_o_f2c
mega_kernel_o_f2k:
v_pk_add_f32 v[88:89], v[88:89], v[84:85]
v_pk_add_f32 v[90:91], v[90:91], v[86:87]
s_lshl_b32 s60, s42, 17
v_cvt_pk_bf16_f32 v92, v88, v89
v_cvt_pk_bf16_f32 v93, v90, v91
buffer_store_dwordx2 v[92:93], v11, s[8:11], s60 offen sc1
s_add_u32 s42, s42, s71
s_cmp_lt_u32 s42, s65
s_cbranch_scc1 mega_kernel_o_cold
mega_kernel_o_quit:
s_endpgm
mega_kernel_exit:
s_endpgm
mega_kernel_recf:
s_load_dwordx2 s[20:21], s[0:1], 8
s_load_dwordx2 s[16:17], s[0:1], 40
s_load_dwordx2 s[4:5], s[0:1], 16
s_load_dwordx2 s[8:9], s[0:1], 24
s_load_dwordx2 s[12:13], s[0:1], 32
v_lshrrev_b32 v4, 6, v0
v_and_b32 v1, 63, v0
v_readfirstlane_b32 s24, v4
v_lshrrev_b32 v2, 4, v1
v_and_b32 v3, 15, v1
v_lshlrev_b32 v17, 4, v1
s_lshr_b32 s28, s31, 2
s_lshl_b32 s25, s30, 3
s_add_u32 s25, s25, s28
s_and_b32 s26, s31, 3
s_waitcnt lgkmcnt(0)
s_mov_b32 s22, 16384
s_mov_b32 s23, 0x00020000
s_mov_b32 s18, 8388608
s_mov_b32 s19, 0x00020000
s_mov_b32 s6, 8388608
s_mov_b32 s7, 0x00020000
s_mov_b32 s10, 8388608
s_mov_b32 s11, 0x00020000
s_mov_b32 s14, 8388608
s_mov_b32 s15, 0x00020000
s_lshl_b32 s28, s25, 8
s_lshr_b32 s29, s26, 0
s_lshl_b32 s29, s29, 6
s_add_u32 s28, s28, s29
s_lshl_b32 s29, s24, 21
s_add_u32 s28, s28, s29
v_lshrrev_b32 v4, 2, v1
v_and_b32 v5, 3, v1
v_lshlrev_b32 v40, 13, v4
v_lshl_add_u32 v40, v5, 4, v40
v_add_u32 v40, s28, v40
s_lshl_b32 s28, s30, 21
s_lshl_b32 s29, s24, 19
s_add_u32 s28, s28, s29
s_lshr_b32 s29, s31, 0
s_lshl_b32 s29, s29, 6
s_add_u32 s28, s28, s29
v_lshlrev_b32 v41, 11, v4
v_lshl_add_u32 v41, v5, 4, v41
v_add_u32 v41, s28, v41
s_lshl_b32 s47, s24, 15
s_add_u32 s47, s47, 32768
s_lshl_b32 s28, s31, 18
s_lshl_b32 s29, s24, 16
s_add_u32 s28, s28, s29
s_lshl_b32 s29, s30, 11
s_add_u32 s28, s28, s29
v_lshlrev_b32 v48, 13, v2
v_lshl_add_u32 v48, v3, 7, v48
v_add_u32 v48, s28, v48
s_lshl_b32 s28, s30, 21
s_lshl_b32 s29, s31, 16
s_add_u32 s28, s28, s29
s_lshl_b32 s29, s24, 14
s_add_u32 s28, s28, s29
v_lshlrev_b32 v49, 7, v1
v_add_u32 v49, s28, v49
s_and_b32 s76, s31, 1
s_mul_i32 s76, s76, 8
s_and_b32 s28, s31, 15
s_lshl_b32 s28, s28, 4
s_lshl_b32 s29, s24, 8
s_add_u32 s28, s28, s29
v_add_u32 v53, s28, v3
s_lshr_b32 s28, s31, 4
s_lshl_b32 s28, s28, 10
s_add_u32 s28, s28, 384
v_mov_b32 v54, s28
v_mov_b32 v55, 1920
v_cmp_gt_u32 vcc, 32, v1
s_nop 1
v_cndmask_b32 v54, v55, v54, vcc
s_lshl_b32 s29, s30, 11
v_lshl_add_u32 v51, v53, 13, v54
v_add_u32 v51, s29, v51
s_lshl_b32 s29, s30, 21
v_lshl_add_u32 v52, v53, 11, v54
v_add_u32 v52, s29, v52
buffer_load_dword v50, v51, s[8:11], 0 offen
s_xor_b32 s29, s76, 0
s_lshl_b32 s28, s29, 10
s_add_u32 s28, s28, s47
s_add_u32 m0, s28, 0
s_lshl_b32 s29, s29, 17
buffer_load_dwordx4 v40, s[8:11], s29 offen lds
s_xor_b32 s29, s76, 1
s_lshl_b32 s28, s29, 10
s_add_u32 s28, s28, s47
s_add_u32 m0, s28, 0
s_lshl_b32 s29, s29, 17
buffer_load_dwordx4 v40, s[8:11], s29 offen lds
s_xor_b32 s29, s76, 2
s_lshl_b32 s28, s29, 10
s_add_u32 s28, s28, s47
s_add_u32 m0, s28, 0
s_lshl_b32 s29, s29, 17
buffer_load_dwordx4 v40, s[8:11], s29 offen lds
s_xor_b32 s29, s76, 3
s_lshl_b32 s28, s29, 10
s_add_u32 s28, s28, s47
s_add_u32 m0, s28, 0
s_lshl_b32 s29, s29, 17
buffer_load_dwordx4 v40, s[8:11], s29 offen lds
s_xor_b32 s29, s76, 4
s_lshl_b32 s28, s29, 10
s_add_u32 s28, s28, s47
s_add_u32 m0, s28, 0
s_lshl_b32 s29, s29, 17
buffer_load_dwordx4 v40, s[8:11], s29 offen lds
s_xor_b32 s29, s76, 5
s_lshl_b32 s28, s29, 10
s_add_u32 s28, s28, s47
s_add_u32 m0, s28, 0
s_lshl_b32 s29, s29, 17
buffer_load_dwordx4 v40, s[8:11], s29 offen lds
s_xor_b32 s29, s76, 6
s_lshl_b32 s28, s29, 10
s_add_u32 s28, s28, s47
s_add_u32 m0, s28, 0
s_lshl_b32 s29, s29, 17
buffer_load_dwordx4 v40, s[8:11], s29 offen lds
s_xor_b32 s29, s76, 7
s_lshl_b32 s28, s29, 10
s_add_u32 s28, s28, s47
s_add_u32 m0, s28, 0
s_lshl_b32 s29, s29, 17
buffer_load_dwordx4 v40, s[8:11], s29 offen lds
s_xor_b32 s29, s76, 8
s_lshl_b32 s28, s29, 10
s_add_u32 s28, s28, s47
s_add_u32 m0, s28, 0
s_lshl_b32 s29, s29, 17
buffer_load_dwordx4 v40, s[8:11], s29 offen lds
s_xor_b32 s29, s76, 9
s_lshl_b32 s28, s29, 10
s_add_u32 s28, s28, s47
s_add_u32 m0, s28, 0
s_lshl_b32 s29, s29, 17
buffer_load_dwordx4 v40, s[8:11], s29 offen lds
s_xor_b32 s29, s76, 10
s_lshl_b32 s28, s29, 10
s_add_u32 s28, s28, s47
s_add_u32 m0, s28, 0
s_lshl_b32 s29, s29, 17
buffer_load_dwordx4 v40, s[8:11], s29 offen lds
s_xor_b32 s29, s76, 11
s_lshl_b32 s28, s29, 10
s_add_u32 s28, s28, s47
s_add_u32 m0, s28, 0
s_lshl_b32 s29, s29, 17
buffer_load_dwordx4 v40, s[8:11], s29 offen lds
s_xor_b32 s29, s76, 12
s_lshl_b32 s28, s29, 10
s_add_u32 s28, s28, s47
s_add_u32 m0, s28, 0
s_lshl_b32 s29, s29, 17
buffer_load_dwordx4 v40, s[8:11], s29 offen lds
s_xor_b32 s29, s76, 13
s_lshl_b32 s28, s29, 10
s_add_u32 s28, s28, s47
s_add_u32 m0, s28, 0
s_lshl_b32 s29, s29, 17
buffer_load_dwordx4 v40, s[8:11], s29 offen lds
s_xor_b32 s29, s76, 14
s_lshl_b32 s28, s29, 10
s_add_u32 s28, s28, s47
s_add_u32 m0, s28, 0
s_lshl_b32 s29, s29, 17
buffer_load_dwordx4 v40, s[8:11], s29 offen lds
s_xor_b32 s29, s76, 15
s_lshl_b32 s28, s29, 10
s_add_u32 s28, s28, s47
s_add_u32 m0, s28, 0
s_lshl_b32 s29, s29, 17
buffer_load_dwordx4 v40, s[8:11], s29 offen lds
buffer_load_dword v50, v51, s[12:15], 0 offen
s_xor_b32 s29, s76, 0
s_lshl_b32 s28, s29, 10
s_add_u32 s28, s28, s47
s_add_u32 m0, s28, 16384
s_lshl_b32 s29, s29, 17
buffer_load_dwordx4 v40, s[12:15], s29 offen lds
s_xor_b32 s29, s76, 1
s_lshl_b32 s28, s29, 10
s_add_u32 s28, s28, s47
s_add_u32 m0, s28, 16384
s_lshl_b32 s29, s29, 17
buffer_load_dwordx4 v40, s[12:15], s29 offen lds
s_xor_b32 s29, s76, 2
s_lshl_b32 s28, s29, 10
s_add_u32 s28, s28, s47
s_add_u32 m0, s28, 16384
s_lshl_b32 s29, s29, 17
buffer_load_dwordx4 v40, s[12:15], s29 offen lds
s_xor_b32 s29, s76, 3
s_lshl_b32 s28, s29, 10
s_add_u32 s28, s28, s47
s_add_u32 m0, s28, 16384
s_lshl_b32 s29, s29, 17
buffer_load_dwordx4 v40, s[12:15], s29 offen lds
s_xor_b32 s29, s76, 4
s_lshl_b32 s28, s29, 10
s_add_u32 s28, s28, s47
s_add_u32 m0, s28, 16384
s_lshl_b32 s29, s29, 17
buffer_load_dwordx4 v40, s[12:15], s29 offen lds
s_xor_b32 s29, s76, 5
s_lshl_b32 s28, s29, 10
s_add_u32 s28, s28, s47
s_add_u32 m0, s28, 16384
s_lshl_b32 s29, s29, 17
buffer_load_dwordx4 v40, s[12:15], s29 offen lds
s_xor_b32 s29, s76, 6
s_lshl_b32 s28, s29, 10
s_add_u32 s28, s28, s47
s_add_u32 m0, s28, 16384
s_lshl_b32 s29, s29, 17
buffer_load_dwordx4 v40, s[12:15], s29 offen lds
s_xor_b32 s29, s76, 7
s_lshl_b32 s28, s29, 10
s_add_u32 s28, s28, s47
s_add_u32 m0, s28, 16384
s_lshl_b32 s29, s29, 17
buffer_load_dwordx4 v40, s[12:15], s29 offen lds
s_xor_b32 s29, s76, 8
s_lshl_b32 s28, s29, 10
s_add_u32 s28, s28, s47
s_add_u32 m0, s28, 16384
s_lshl_b32 s29, s29, 17
buffer_load_dwordx4 v40, s[12:15], s29 offen lds
s_xor_b32 s29, s76, 9
s_lshl_b32 s28, s29, 10
s_add_u32 s28, s28, s47
s_add_u32 m0, s28, 16384
s_lshl_b32 s29, s29, 17
buffer_load_dwordx4 v40, s[12:15], s29 offen lds
s_xor_b32 s29, s76, 10
s_lshl_b32 s28, s29, 10
s_add_u32 s28, s28, s47
s_add_u32 m0, s28, 16384
s_lshl_b32 s29, s29, 17
buffer_load_dwordx4 v40, s[12:15], s29 offen lds
s_xor_b32 s29, s76, 11
s_lshl_b32 s28, s29, 10
s_add_u32 s28, s28, s47
s_add_u32 m0, s28, 16384
s_lshl_b32 s29, s29, 17
buffer_load_dwordx4 v40, s[12:15], s29 offen lds
s_xor_b32 s29, s76, 12
s_lshl_b32 s28, s29, 10
s_add_u32 s28, s28, s47
s_add_u32 m0, s28, 16384
s_lshl_b32 s29, s29, 17
buffer_load_dwordx4 v40, s[12:15], s29 offen lds
s_xor_b32 s29, s76, 13
s_lshl_b32 s28, s29, 10
s_add_u32 s28, s28, s47
s_add_u32 m0, s28, 16384
s_lshl_b32 s29, s29, 17
buffer_load_dwordx4 v40, s[12:15], s29 offen lds
s_xor_b32 s29, s76, 14
s_lshl_b32 s28, s29, 10
s_add_u32 s28, s28, s47
s_add_u32 m0, s28, 16384
s_lshl_b32 s29, s29, 17
buffer_load_dwordx4 v40, s[12:15], s29 offen lds
s_xor_b32 s29, s76, 15
s_lshl_b32 s28, s29, 10
s_add_u32 s28, s28, s47
s_add_u32 m0, s28, 16384
s_lshl_b32 s29, s29, 17
buffer_load_dwordx4 v40, s[12:15], s29 offen lds
s_mov_b32 s40, 0x00ff00ff
s_mov_b32 s41, 0x00ff00ff
s_mov_b32 s48, 0xff00ff00
s_mov_b32 s49, 0xff00ff00
s_mov_b32 s42, 0
s_mov_b32 s43, 0x00ff00ff
s_mov_b32 s32, 0x3e0293ee
v_mov_b32 v23, 0xff800000
v_mov_b32 v6, 0x4444
v_mov_b32 v4, 0xeeee
v_cndmask_b32 v6, v6, v4, s[48:49]
v_mov_b32 v28, -1
v_mov_b32 v29, -1
v_mov_b32 v30, -1
v_mov_b32 v31, -1
s_mul_i32 s28, s24, 4096
v_add_u32 v7, s28, v17
v_and_b32 v4, 7, v1
v_lshlrev_b32 v8, 11, v4
v_lshrrev_b32 v5, 3, v1
v_lshl_add_u32 v8, v5, 4, v8
s_lshl_b32 s28, s24, 9
v_add_u32 v8, s28, v8
s_lshl_b32 s28, s31, 9
s_lshr_b32 s29, s31, 3
s_mul_i32 s29, s29, 0
s_add_u32 s28, s28, s29
v_lshlrev_b32 v9, 3, v1
v_add_u32 v9, s28, v9
v_and_b32 v4, 7, v3
v_lshlrev_b32 v11, 7, v2
v_lshl_add_u32 v11, v4, 4, v11
v_add_u32 v22, 0, v11
s_add_u32 s28, s28, 24576
v_add_u32 v11, s28, v11
v_and_b32 v5, 1, v2
v_lshlrev_b32 v10, 7, v5
v_lshl_add_u32 v10, v4, 4, v10
v_add_u32 v10, 1024, v10
s_xor_b32 s37, s31, 1
s_mul_i32 s37, s37, 2048
s_add_u32 s37, s37, 49152
s_xor_b32 s38, s31, 2
s_mul_i32 s38, s38, 2048
s_add_u32 s38, s38, 49152
s_xor_b32 s39, s31, 3
s_mul_i32 s39, s39, 2048
s_add_u32 s39, s39, 49152
v_and_b32 v4, 1, v2
v_mul_u32_u24 v14, 576, v4
v_lshrrev_b32 v5, 1, v2
v_lshl_add_u32 v5, v5, 4, v3
v_lshl_add_u32 v14, v5, 2, v14
s_mul_i32 s28, s24, 1152
s_add_u32 s28, s28, 13312
v_add_u32 v18, s28, v14
s_mul_i32 s28, s24, 2304
v_add_u32 v14, s28, v14
v_add_u32 v15, 1152, v14
v_mul_u32_u24 v16, 144, v3
v_lshl_add_u32 v16, v2, 5, v16
v_bfe_u32 v4, v1, 1, 3
v_mul_u32_u24 v19, 144, v4
v_lshl_add_u32 v19, v2, 5, v19
v_and_b32 v4, 1, v1
v_lshl_add_u32 v19, v4, 4, v19
v_add_u32 v19, 13312, v19
s_lshl_b32 s28, s24, 10
s_add_u32 s28, s28, 9216
v_add_u32 v20, s28, v17
v_and_b32 v4, 31, v1
v_lshlrev_b32 v21, 3, v4
v_add_u32 v21, 17920, v21
v_lshrrev_b32 v4, 2, v3
v_and_b32 v42, 1, v4
v_lshrrev_b32 v43, 1, v4
v_lshrrev_b32 v44, 1, v2
v_and_b32 v45, 1, v2
v_lshl_add_u32 v46, v44, 4, v42
v_lshl_add_u32 v46, v45, 2, v46
v_lshl_add_u32 v46, v43, 3, v46
v_lshl_add_u32 v47, v44, 3, v42
v_lshl_add_u32 v47, v45, 4, v47
v_lshl_add_u32 v47, v43, 2, v47
v_and_b32 v5, 3, v3
v_lshlrev_b32 v5, 3, v5
v_lshl_add_u32 v46, v46, 6, v5
v_lshl_add_u32 v47, v47, 6, v5
s_and_b32 s28, s31, 0
s_lshl_b32 s28, s28, 6
s_add_u32 s28, s28, s47
v_add_u32 v46, s28, v46
v_add_u32 v47, s28, v47
s_waitcnt vmcnt(17)
ds_read_b64_tr_b16 a[64:65], v46 offset:0
ds_read_b64_tr_b16 a[66:67], v46 offset:128
ds_read_b64_tr_b16 a[68:69], v46 offset:2048
ds_read_b64_tr_b16 a[70:71], v46 offset:2176
ds_read_b64_tr_b16 a[72:73], v46 offset:4096
ds_read_b64_tr_b16 a[74:75], v46 offset:4224
ds_read_b64_tr_b16 a[76:77], v46 offset:6144
ds_read_b64_tr_b16 a[78:79], v46 offset:6272
s_waitcnt lgkmcnt(0)
ds_read_b64_tr_b16 a[80:81], v46 offset:8192
ds_read_b64_tr_b16 a[82:83], v46 offset:8320
ds_read_b64_tr_b16 a[84:85], v46 offset:10240
ds_read_b64_tr_b16 a[86:87], v46 offset:10368
ds_read_b64_tr_b16 a[88:89], v46 offset:12288
ds_read_b64_tr_b16 a[90:91], v46 offset:12416
ds_read_b64_tr_b16 a[92:93], v46 offset:14336
ds_read_b64_tr_b16 a[94:95], v46 offset:14464
s_waitcnt lgkmcnt(0)
ds_read_b64_tr_b16 a[96:97], v46 offset:32
ds_read_b64_tr_b16 a[98:99], v46 offset:160
ds_read_b64_tr_b16 a[100:101], v46 offset:2080
ds_read_b64_tr_b16 a[102:103], v46 offset:2208
ds_read_b64_tr_b16 a[104:105], v46 offset:4128
ds_read_b64_tr_b16 a[106:107], v46 offset:4256
ds_read_b64_tr_b16 a[108:109], v46 offset:6176
ds_read_b64_tr_b16 a[110:111], v46 offset:6304
s_waitcnt lgkmcnt(0)
ds_read_b64_tr_b16 a[112:113], v46 offset:8224
ds_read_b64_tr_b16 a[114:115], v46 offset:8352
ds_read_b64_tr_b16 a[116:117], v46 offset:10272
ds_read_b64_tr_b16 a[118:119], v46 offset:10400
ds_read_b64_tr_b16 a[120:121], v46 offset:12320
ds_read_b64_tr_b16 a[122:123], v46 offset:12448
ds_read_b64_tr_b16 a[124:125], v46 offset:14368
ds_read_b64_tr_b16 a[126:127], v46 offset:14496
s_waitcnt lgkmcnt(0)
buffer_load_dword v50, v51, s[4:7], 0 offen
s_xor_b32 s29, s76, 0
s_lshl_b32 s28, s29, 10
s_add_u32 s28, s28, s47
s_add_u32 m0, s28, 0
s_lshl_b32 s29, s29, 17
buffer_load_dwordx4 v40, s[4:7], s29 offen lds
s_xor_b32 s29, s76, 1
s_lshl_b32 s28, s29, 10
s_add_u32 s28, s28, s47
s_add_u32 m0, s28, 0
s_lshl_b32 s29, s29, 17
buffer_load_dwordx4 v40, s[4:7], s29 offen lds
s_xor_b32 s29, s76, 2
s_lshl_b32 s28, s29, 10
s_add_u32 s28, s28, s47
s_add_u32 m0, s28, 0
s_lshl_b32 s29, s29, 17
buffer_load_dwordx4 v40, s[4:7], s29 offen lds
s_xor_b32 s29, s76, 3
s_lshl_b32 s28, s29, 10
s_add_u32 s28, s28, s47
s_add_u32 m0, s28, 0
s_lshl_b32 s29, s29, 17
buffer_load_dwordx4 v40, s[4:7], s29 offen lds
s_xor_b32 s29, s76, 4
s_lshl_b32 s28, s29, 10
s_add_u32 s28, s28, s47
s_add_u32 m0, s28, 0
s_lshl_b32 s29, s29, 17
buffer_load_dwordx4 v40, s[4:7], s29 offen lds
s_xor_b32 s29, s76, 5
s_lshl_b32 s28, s29, 10
s_add_u32 s28, s28, s47
s_add_u32 m0, s28, 0
s_lshl_b32 s29, s29, 17
buffer_load_dwordx4 v40, s[4:7], s29 offen lds
s_xor_b32 s29, s76, 6
s_lshl_b32 s28, s29, 10
s_add_u32 s28, s28, s47
s_add_u32 m0, s28, 0
s_lshl_b32 s29, s29, 17
buffer_load_dwordx4 v40, s[4:7], s29 offen lds
s_xor_b32 s29, s76, 7
s_lshl_b32 s28, s29, 10
s_add_u32 s28, s28, s47
s_add_u32 m0, s28, 0
s_lshl_b32 s29, s29, 17
buffer_load_dwordx4 v40, s[4:7], s29 offen lds
s_xor_b32 s29, s76, 8
s_lshl_b32 s28, s29, 10
s_add_u32 s28, s28, s47
s_add_u32 m0, s28, 0
s_lshl_b32 s29, s29, 17
buffer_load_dwordx4 v40, s[4:7], s29 offen lds
s_xor_b32 s29, s76, 9
s_lshl_b32 s28, s29, 10
s_add_u32 s28, s28, s47
s_add_u32 m0, s28, 0
s_lshl_b32 s29, s29, 17
buffer_load_dwordx4 v40, s[4:7], s29 offen lds
s_xor_b32 s29, s76, 10
s_lshl_b32 s28, s29, 10
s_add_u32 s28, s28, s47
s_add_u32 m0, s28, 0
s_lshl_b32 s29, s29, 17
buffer_load_dwordx4 v40, s[4:7], s29 offen lds
s_xor_b32 s29, s76, 11
s_lshl_b32 s28, s29, 10
s_add_u32 s28, s28, s47
s_add_u32 m0, s28, 0
s_lshl_b32 s29, s29, 17
buffer_load_dwordx4 v40, s[4:7], s29 offen lds
s_xor_b32 s29, s76, 12
s_lshl_b32 s28, s29, 10
s_add_u32 s28, s28, s47
s_add_u32 m0, s28, 0
s_lshl_b32 s29, s29, 17
buffer_load_dwordx4 v40, s[4:7], s29 offen lds
s_xor_b32 s29, s76, 13
s_lshl_b32 s28, s29, 10
s_add_u32 s28, s28, s47
s_add_u32 m0, s28, 0
s_lshl_b32 s29, s29, 17
buffer_load_dwordx4 v40, s[4:7], s29 offen lds
s_xor_b32 s29, s76, 14
s_lshl_b32 s28, s29, 10
s_add_u32 s28, s28, s47
s_add_u32 m0, s28, 0
s_lshl_b32 s29, s29, 17
buffer_load_dwordx4 v40, s[4:7], s29 offen lds
s_xor_b32 s29, s76, 15
s_lshl_b32 s28, s29, 10
s_add_u32 s28, s28, s47
s_add_u32 m0, s28, 0
s_lshl_b32 s29, s29, 17
buffer_load_dwordx4 v40, s[4:7], s29 offen lds
s_waitcnt vmcnt(17)
ds_read_b64_tr_b16 a[128:129], v46 offset:16384
ds_read_b64_tr_b16 a[130:131], v46 offset:16512
ds_read_b64_tr_b16 a[132:133], v46 offset:18432
ds_read_b64_tr_b16 a[134:135], v46 offset:18560
ds_read_b64_tr_b16 a[136:137], v46 offset:20480
ds_read_b64_tr_b16 a[138:139], v46 offset:20608
ds_read_b64_tr_b16 a[140:141], v46 offset:22528
ds_read_b64_tr_b16 a[142:143], v46 offset:22656
s_waitcnt lgkmcnt(0)
ds_read_b64_tr_b16 a[144:145], v46 offset:24576
ds_read_b64_tr_b16 a[146:147], v46 offset:24704
ds_read_b64_tr_b16 a[148:149], v46 offset:26624
ds_read_b64_tr_b16 a[150:151], v46 offset:26752
ds_read_b64_tr_b16 a[152:153], v46 offset:28672
ds_read_b64_tr_b16 a[154:155], v46 offset:28800
ds_read_b64_tr_b16 a[156:157], v46 offset:30720
ds_read_b64_tr_b16 a[158:159], v46 offset:30848
s_waitcnt lgkmcnt(0)
ds_read_b64_tr_b16 a[160:161], v46 offset:16416
ds_read_b64_tr_b16 a[162:163], v46 offset:16544
ds_read_b64_tr_b16 a[164:165], v46 offset:18464
ds_read_b64_tr_b16 a[166:167], v46 offset:18592
ds_read_b64_tr_b16 a[168:169], v46 offset:20512
ds_read_b64_tr_b16 a[170:171], v46 offset:20640
ds_read_b64_tr_b16 a[172:173], v46 offset:22560
ds_read_b64_tr_b16 a[174:175], v46 offset:22688
s_waitcnt lgkmcnt(0)
ds_read_b64_tr_b16 a[176:177], v46 offset:24608
ds_read_b64_tr_b16 a[178:179], v46 offset:24736
ds_read_b64_tr_b16 a[180:181], v46 offset:26656
ds_read_b64_tr_b16 a[182:183], v46 offset:26784
ds_read_b64_tr_b16 a[184:185], v46 offset:28704
ds_read_b64_tr_b16 a[186:187], v46 offset:28832
ds_read_b64_tr_b16 a[188:189], v46 offset:30752
ds_read_b64_tr_b16 a[190:191], v46 offset:30880
s_waitcnt lgkmcnt(0)
buffer_load_dword v50, v52, s[16:19], 0 offen
s_xor_b32 s29, s76, 0
s_lshl_b32 s28, s29, 10
s_add_u32 s28, s28, s47
s_add_u32 m0, s28, 16384
s_lshl_b32 s29, s29, 15
buffer_load_dwordx4 v41, s[16:19], s29 offen lds
s_xor_b32 s29, s76, 1
s_lshl_b32 s28, s29, 10
s_add_u32 s28, s28, s47
s_add_u32 m0, s28, 16384
s_lshl_b32 s29, s29, 15
buffer_load_dwordx4 v41, s[16:19], s29 offen lds
s_xor_b32 s29, s76, 2
s_lshl_b32 s28, s29, 10
s_add_u32 s28, s28, s47
s_add_u32 m0, s28, 16384
s_lshl_b32 s29, s29, 15
buffer_load_dwordx4 v41, s[16:19], s29 offen lds
s_xor_b32 s29, s76, 3
s_lshl_b32 s28, s29, 10
s_add_u32 s28, s28, s47
s_add_u32 m0, s28, 16384
s_lshl_b32 s29, s29, 15
buffer_load_dwordx4 v41, s[16:19], s29 offen lds
s_xor_b32 s29, s76, 4
s_lshl_b32 s28, s29, 10
s_add_u32 s28, s28, s47
s_add_u32 m0, s28, 16384
s_lshl_b32 s29, s29, 15
buffer_load_dwordx4 v41, s[16:19], s29 offen lds
s_xor_b32 s29, s76, 5
s_lshl_b32 s28, s29, 10
s_add_u32 s28, s28, s47
s_add_u32 m0, s28, 16384
s_lshl_b32 s29, s29, 15
buffer_load_dwordx4 v41, s[16:19], s29 offen lds
s_xor_b32 s29, s76, 6
s_lshl_b32 s28, s29, 10
s_add_u32 s28, s28, s47
s_add_u32 m0, s28, 16384
s_lshl_b32 s29, s29, 15
buffer_load_dwordx4 v41, s[16:19], s29 offen lds
s_xor_b32 s29, s76, 7
s_lshl_b32 s28, s29, 10
s_add_u32 s28, s28, s47
s_add_u32 m0, s28, 16384
s_lshl_b32 s29, s29, 15
buffer_load_dwordx4 v41, s[16:19], s29 offen lds
s_xor_b32 s29, s76, 8
s_lshl_b32 s28, s29, 10
s_add_u32 s28, s28, s47
s_add_u32 m0, s28, 16384
s_lshl_b32 s29, s29, 15
buffer_load_dwordx4 v41, s[16:19], s29 offen lds
s_xor_b32 s29, s76, 9
s_lshl_b32 s28, s29, 10
s_add_u32 s28, s28, s47
s_add_u32 m0, s28, 16384
s_lshl_b32 s29, s29, 15
buffer_load_dwordx4 v41, s[16:19], s29 offen lds
s_xor_b32 s29, s76, 10
s_lshl_b32 s28, s29, 10
s_add_u32 s28, s28, s47
s_add_u32 m0, s28, 16384
s_lshl_b32 s29, s29, 15
buffer_load_dwordx4 v41, s[16:19], s29 offen lds
s_xor_b32 s29, s76, 11
s_lshl_b32 s28, s29, 10
s_add_u32 s28, s28, s47
s_add_u32 m0, s28, 16384
s_lshl_b32 s29, s29, 15
buffer_load_dwordx4 v41, s[16:19], s29 offen lds
s_xor_b32 s29, s76, 12
s_lshl_b32 s28, s29, 10
s_add_u32 s28, s28, s47
s_add_u32 m0, s28, 16384
s_lshl_b32 s29, s29, 15
buffer_load_dwordx4 v41, s[16:19], s29 offen lds
s_xor_b32 s29, s76, 13
s_lshl_b32 s28, s29, 10
s_add_u32 s28, s28, s47
s_add_u32 m0, s28, 16384
s_lshl_b32 s29, s29, 15
buffer_load_dwordx4 v41, s[16:19], s29 offen lds
s_xor_b32 s29, s76, 14
s_lshl_b32 s28, s29, 10
s_add_u32 s28, s28, s47
s_add_u32 m0, s28, 16384
s_lshl_b32 s29, s29, 15
buffer_load_dwordx4 v41, s[16:19], s29 offen lds
s_xor_b32 s29, s76, 15
s_lshl_b32 s28, s29, 10
s_add_u32 s28, s28, s47
s_add_u32 m0, s28, 16384
s_lshl_b32 s29, s29, 15
buffer_load_dwordx4 v41, s[16:19], s29 offen lds
s_mov_b64 exec, 0
s_cmp_eq_u32 s24, 0
s_cbranch_scc1 mega_kernel_rf_iw0
s_cmp_eq_u32 s24, 1
s_cbranch_scc1 mega_kernel_rf_iw1
s_cmp_eq_u32 s24, 2
s_cbranch_scc1 mega_kernel_rf_iw2
s_branch mega_kernel_rf_iw3
mega_kernel_rf_iwd:
s_mov_b64 exec, -1
s_waitcnt vmcnt(17)
ds_read_b64_tr_b16 a[0:1], v46 offset:0
ds_read_b64_tr_b16 a[2:3], v46 offset:128
ds_read_b64_tr_b16 a[4:5], v46 offset:2048
ds_read_b64_tr_b16 a[6:7], v46 offset:2176
ds_read_b64_tr_b16 a[8:9], v46 offset:4096
ds_read_b64_tr_b16 a[10:11], v46 offset:4224
ds_read_b64_tr_b16 a[12:13], v46 offset:6144
ds_read_b64_tr_b16 a[14:15], v46 offset:6272
s_waitcnt lgkmcnt(0)
ds_read_b64_tr_b16 a[16:17], v46 offset:8192
ds_read_b64_tr_b16 a[18:19], v46 offset:8320
ds_read_b64_tr_b16 a[20:21], v46 offset:10240
ds_read_b64_tr_b16 a[22:23], v46 offset:10368
ds_read_b64_tr_b16 a[24:25], v46 offset:12288
ds_read_b64_tr_b16 a[26:27], v46 offset:12416
ds_read_b64_tr_b16 a[28:29], v46 offset:14336
ds_read_b64_tr_b16 a[30:31], v46 offset:14464
s_waitcnt lgkmcnt(0)
ds_read_b64_tr_b16 a[32:33], v46 offset:32
ds_read_b64_tr_b16 a[34:35], v46 offset:160
ds_read_b64_tr_b16 a[36:37], v46 offset:2080
ds_read_b64_tr_b16 a[38:39], v46 offset:2208
ds_read_b64_tr_b16 a[40:41], v46 offset:4128
ds_read_b64_tr_b16 a[42:43], v46 offset:4256
ds_read_b64_tr_b16 a[44:45], v46 offset:6176
ds_read_b64_tr_b16 a[46:47], v46 offset:6304
s_waitcnt lgkmcnt(0)
ds_read_b64_tr_b16 a[48:49], v46 offset:8224
ds_read_b64_tr_b16 a[50:51], v46 offset:8352
ds_read_b64_tr_b16 a[52:53], v46 offset:10272
ds_read_b64_tr_b16 a[54:55], v46 offset:10400
ds_read_b64_tr_b16 a[56:57], v46 offset:12320
ds_read_b64_tr_b16 a[58:59], v46 offset:12448
ds_read_b64_tr_b16 a[60:61], v46 offset:14368
ds_read_b64_tr_b16 a[62:63], v46 offset:14496
s_waitcnt lgkmcnt(0)
v_and_b32 v247, 15, v0
v_lshlrev_b32 v247, 4, v247
buffer_load_dword v246, v247, s[72:75], 0 offen sc1
buffer_load_dwordx4 v[64:67], v8, s[20:23], 0 offen offset:0
buffer_load_dwordx4 v[68:71], v8, s[20:23], 0 offen offset:128
buffer_load_dwordx4 v[72:75], v8, s[20:23], 0 offen offset:256
buffer_load_dwordx4 v[76:79], v8, s[20:23], 0 offen offset:384
s_waitcnt vmcnt(0)
ds_read_b64_tr_b16 a[192:193], v47 offset:16384
ds_read_b64_tr_b16 a[194:195], v47 offset:16512
ds_read_b64_tr_b16 a[196:197], v47 offset:18432
ds_read_b64_tr_b16 a[198:199], v47 offset:18560
ds_read_b64_tr_b16 a[200:201], v47 offset:20480
ds_read_b64_tr_b16 a[202:203], v47 offset:20608
ds_read_b64_tr_b16 a[204:205], v47 offset:22528
ds_read_b64_tr_b16 a[206:207], v47 offset:22656
s_waitcnt lgkmcnt(0)
ds_read_b64_tr_b16 a[208:209], v47 offset:24576
ds_read_b64_tr_b16 a[210:211], v47 offset:24704
ds_read_b64_tr_b16 a[212:213], v47 offset:26624
ds_read_b64_tr_b16 a[214:215], v47 offset:26752
ds_read_b64_tr_b16 a[216:217], v47 offset:28672
ds_read_b64_tr_b16 a[218:219], v47 offset:28800
ds_read_b64_tr_b16 a[220:221], v47 offset:30720
ds_read_b64_tr_b16 a[222:223], v47 offset:30848
s_waitcnt lgkmcnt(0)
ds_read_b64_tr_b16 a[224:225], v47 offset:16416
ds_read_b64_tr_b16 a[226:227], v47 offset:16544
ds_read_b64_tr_b16 a[228:229], v47 offset:18464
ds_read_b64_tr_b16 a[230:231], v47 offset:18592
ds_read_b64_tr_b16 a[232:233], v47 offset:20512
ds_read_b64_tr_b16 a[234:235], v47 offset:20640
ds_read_b64_tr_b16 a[236:237], v47 offset:22560
ds_read_b64_tr_b16 a[238:239], v47 offset:22688
s_waitcnt lgkmcnt(0)
ds_read_b64_tr_b16 a[240:241], v47 offset:24608
ds_read_b64_tr_b16 a[242:243], v47 offset:24736
ds_read_b64_tr_b16 a[244:245], v47 offset:26656
ds_read_b64_tr_b16 a[246:247], v47 offset:26784
ds_read_b64_tr_b16 a[248:249], v47 offset:28704
ds_read_b64_tr_b16 a[250:251], v47 offset:28832
ds_read_b64_tr_b16 a[252:253], v47 offset:30752
ds_read_b64_tr_b16 a[254:255], v47 offset:30880
s_waitcnt lgkmcnt(0)
v_mov_b32 v32, v64
v_mov_b32 v33, v65
v_mov_b32 v34, v66
v_mov_b32 v35, v67
v_mov_b32 v36, v68
v_mov_b32 v37, v69
v_mov_b32 v38, v70
v_mov_b32 v39, v71
v_mov_b32 v40, v72
v_mov_b32 v41, v73
v_mov_b32 v42, v74
v_mov_b32 v43, v75
v_mov_b32 v44, v76
v_mov_b32 v45, v77
v_mov_b32 v46, v78
v_mov_b32 v47, v79
v_mov_b32 v96, 0
v_mov_b32 v97, 0
v_mov_b32 v98, 0
v_mov_b32 v99, 0
v_mov_b32 v100, 0
v_mov_b32 v101, 0
v_mov_b32 v102, 0
v_mov_b32 v103, 0
v_mov_b32 v104, 0
v_mov_b32 v105, 0
v_mov_b32 v106, 0
v_mov_b32 v107, 0
v_mov_b32 v108, 0
v_mov_b32 v109, 0
v_mov_b32 v110, 0
v_mov_b32 v111, 0
v_mov_b32 v112, 0
v_mov_b32 v113, 0
v_mov_b32 v114, 0
v_mov_b32 v115, 0
v_mov_b32 v116, 0
v_mov_b32 v117, 0
v_mov_b32 v118, 0
v_mov_b32 v119, 0
s_nop 1
v_smfmac_f32_16x16x64_bf16 v[96:99], v[32:35], a[0:7], v6
v_smfmac_f32_16x16x64_bf16 v[100:103], v[32:35], a[32:39], v6
v_smfmac_f32_16x16x64_bf16 v[104:107], v[32:35], a[64:71], v6
v_smfmac_f32_16x16x64_bf16 v[108:111], v[32:35], a[96:103], v6
v_smfmac_f32_16x16x64_bf16 v[96:99], v[36:39], a[8:15], v6
v_smfmac_f32_16x16x64_bf16 v[100:103], v[36:39], a[40:47], v6
v_smfmac_f32_16x16x64_bf16 v[104:107], v[36:39], a[72:79], v6
v_smfmac_f32_16x16x64_bf16 v[108:111], v[36:39], a[104:111], v6
v_smfmac_f32_16x16x64_bf16 v[96:99], v[40:43], a[16:23], v6
v_smfmac_f32_16x16x64_bf16 v[100:103], v[40:43], a[48:55], v6
v_smfmac_f32_16x16x64_bf16 v[104:107], v[40:43], a[80:87], v6
v_smfmac_f32_16x16x64_bf16 v[108:111], v[40:43], a[112:119], v6
v_smfmac_f32_16x16x64_bf16 v[96:99], v[44:47], a[24:31], v6
v_smfmac_f32_16x16x64_bf16 v[100:103], v[44:47], a[56:63], v6
v_smfmac_f32_16x16x64_bf16 v[104:107], v[44:47], a[88:95], v6
v_smfmac_f32_16x16x64_bf16 v[108:111], v[44:47], a[120:127], v6
v_and_b32 v247, 15, v0
v_lshlrev_b32 v247, 4, v247
s_branch mega_kernel_syrp
mega_kernel_syrw:
s_sleep 4
mega_kernel_syr:
buffer_load_dword v246, v247, s[72:75], 0 offen sc1
s_waitcnt vmcnt(0)
mega_kernel_syrp:
s_cmp_eq_u32 s95, 1
s_cbranch_scc0 mega_kernel_syrf
v_readlane_b32 s76, v246, 14
s_mov_b32 s98, 0
s_cmp_eq_u32 s76, 32
s_cbranch_scc0 mega_kernel_syrw
s_branch mega_kernel_syrd
mega_kernel_syrf:
s_mov_b32 s77, 0
s_mov_b32 s78, 0
v_readlane_b32 s76, v246, 0
s_add_u32 s77, s77, s76
s_xor_b32 s76, s76, 32
s_or_b32 s78, s78, s76
v_readlane_b32 s76, v246, 1
s_add_u32 s77, s77, s76
s_xor_b32 s76, s76, 32
s_or_b32 s78, s78, s76
v_readlane_b32 s76, v246, 2
s_add_u32 s77, s77, s76
s_xor_b32 s76, s76, 32
s_or_b32 s78, s78, s76
v_readlane_b32 s76, v246, 3
s_add_u32 s77, s77, s76
s_xor_b32 s76, s76, 32
s_or_b32 s78, s78, s76
v_readlane_b32 s76, v246, 4
s_add_u32 s77, s77, s76
s_xor_b32 s76, s76, 32
s_or_b32 s78, s78, s76
v_readlane_b32 s76, v246, 5
s_add_u32 s77, s77, s76
s_xor_b32 s76, s76, 32
s_or_b32 s78, s78, s76
v_readlane_b32 s76, v246, 6
s_add_u32 s77, s77, s76
s_xor_b32 s76, s76, 32
s_or_b32 s78, s78, s76
v_readlane_b32 s76, v246, 7
s_add_u32 s77, s77, s76
s_xor_b32 s76, s76, 32
s_or_b32 s78, s78, s76
s_cmp_eq_u32 s77, 256
s_cbranch_scc0 mega_kernel_syrw
v_mov_b32 v252, v246
s_cmp_eq_u32 s78, 0
s_cbranch_scc0 mega_kernel_slowent
v_readlane_b32 s76, v246, 10
v_readlane_b32 s77, v246, 8
s_cmp_eq_u32 s76, 32
s_cbranch_scc0 mega_kernel_syrw
s_cmp_gt_u32 s77, 16
s_cselect_b32 s98, 1, 0
mega_kernel_syrd:
s_lshr_b32 s28, s31, 4
s_lshl_b32 s28, s28, 14
s_lshl_b32 s29, s98, 13
s_add_u32 s28, s28, s29
s_and_b32 s29, s31, 15
s_lshl_b32 s29, s29, 9
s_add_u32 s28, s28, s29
s_lshl_b32 s29, s30, 16
s_add_u32 s28, s28, s29
s_add_u32 s28, s28, 67108864
v_lshrrev_b32 v12, 1, v17
v_add_u32 v12, s28, v12
v_xor_b32 v25, 0x10000, v12
v_xor_b32 v26, 0x20000, v12
v_xor_b32 v27, 0x30000, v12
v_add_u32 v25, 0, v25
v_add_u32 v26, 0, v26
v_add_u32 v27, 0, v27
s_lshl_b32 s28, s25, 2
s_add_u32 s28, s28, s26
s_mov_b32 s82, s28
s_lshr_b32 s29, s28, 3
s_xor_b32 s29, s29, s98
s_and_b32 s29, s29, 1
s_lshl_b32 s29, s29, 13
s_lshl_b32 s76, s28, 18
s_add_u32 s76, s76, s29
s_mov_b32 s83, s76
v_add_u32 v240, s76, v17
v_add_u32 v241, 33554432, v240
s_lshr_b32 s29, s28, 4
s_xor_b32 s29, s29, s98
s_and_b32 s29, s29, 1
s_lshl_b32 s29, s29, 13
s_lshl_b32 s79, s28, 17
s_add_u32 s79, s79, s29
s_add_u32 s79, s79, 71303168
s_xor_b32 s29, s98, 1
s_lshl_b32 s29, s29, 13
s_lshl_b32 s28, s25, 7
s_add_u32 s28, s28, s29
s_add_u32 s28, s28, 69206016
v_and_b32 v4, 1, v1
v_lshlrev_b32 v24, 12, v4
v_add_u32 v24, s28, v24
s_lshl_b32 s29, s26, 2
v_add_u32 v24, s29, v24
s_xor_b32 s81, s98, 1
s_lshl_b32 s81, s81, 13
s_lshr_b32 s29, s82, 6
s_lshl_b32 s29, s29, 14
s_add_u32 s81, s81, s29
s_and_b32 s29, s82, 63
s_lshl_b32 s29, s29, 7
s_add_u32 s81, s81, s29
s_add_u32 s81, s81, 69222400
v_mov_b32 v220, 0x3f803f80
v_mov_b32 v221, 0x3f803f80
v_mov_b32 v222, 0x3f803f80
v_mov_b32 v223, 0x3f803f80
v_mov_b32 v228, 0
s_mov_b32 s27, 0
s_mov_b32 s46, 0
s_mov_b32 s89, 0
s_mov_b32 s88, 0
s_mov_b32 s44, 18432
s_mov_b32 s45, 18432
s_cmp_eq_u32 s24, 3
s_cbranch_scc0 mega_kernel_rf_pfi
s_mov_b32 s76, 0
s_cmp_gt_i32 s46, s76
s_cbranch_scc1 mega_kernel_rf_pf0ok
mega_kernel_rf_pf0w:
v_mov_b32 v4, 0
s_mov_b64 exec, 3
buffer_atomic_add v4, v24, s[84:87], 0 offen sc0 sc1
s_mov_b64 exec, -1
s_waitcnt vmcnt(0)
v_readlane_b32 s46, v4, 0
v_readlane_b32 s28, v4, 1
s_nop 1
s_min_i32 s46, s46, s28
s_cmp_gt_i32 s46, s76
s_cbranch_scc0 mega_kernel_rf_pf0w
mega_kernel_rf_pf0ok:
s_add_u32 s77, s76, s82
s_bfe_u32 s28, s77, 0x40002
s_lshl_b32 s28, s28, 14
s_and_b32 s77, s77, 3
s_lshl_b32 s77, s77, 11
s_add_u32 s28, s28, s77
s_add_u32 m0, s45, 0
s_nop 0
buffer_load_dwordx4 v240, s[84:87], s28 offen offset:0 sc1 lds
s_add_u32 m0, s45, 0
s_nop 0
buffer_load_dwordx4 v240, s[84:87], s28 offen offset:1024 sc1 lds
s_add_u32 m0, s45, 2048
s_nop 0
buffer_load_dwordx4 v241, s[84:87], s28 offen offset:0 sc1 lds
s_add_u32 m0, s45, 2048
s_nop 0
buffer_load_dwordx4 v241, s[84:87], s28 offen offset:1024 sc1 lds
s_add_u32 s45, s45, 4096
s_cmp_eq_u32 s45, 30720
s_cselect_b32 s45, 18432, s45
s_waitcnt vmcnt(0) lgkmcnt(0)
mega_kernel_rf_pfi:
v_mov_b32 v184, 0
v_mov_b32 v185, 0
v_mov_b32 v186, 0
v_mov_b32 v187, 0
v_mov_b32 v188, 0
v_mov_b32 v189, 0
v_mov_b32 v190, 0
v_mov_b32 v191, 0
v_mov_b32 v192, 0
v_mov_b32 v193, 0
v_mov_b32 v194, 0
v_mov_b32 v195, 0
v_mov_b32 v196, 0
v_mov_b32 v197, 0
v_mov_b32 v198, 0
v_mov_b32 v199, 0
v_mov_b32 v200, 0
v_mov_b32 v201, 0
v_mov_b32 v202, 0
v_mov_b32 v203, 0
v_mov_b32 v204, 0
v_mov_b32 v205, 0
v_mov_b32 v206, 0
v_mov_b32 v207, 0
v_mov_b32 v249, 0
s_barrier
s_and_b32 s29, s27, 1
s_lshl_b32 s33, s29, 17
s_lshl_b32 s28, s30, 18
s_add_u32 s33, s33, s28
s_add_u32 s33, s33, 68157440
s_xor_b32 s34, s33, 131072
s_lshl_b32 s35, s29, 18
s_bfe_u32 s47, s27, 0x10001
s_branch mega_kernel_rf_first
.p2align 6
s_nop 0
s_nop 0
mega_kernel_rf_loop:
buffer_load_dwordx4 v[32:35], v7, s[84:87], s33 offen offset:0 sc1
v_add_u32 v5, s44, v17
ds_read_b128 v[156:159], v5 offset:0
ds_read_b128 v[160:163], v5 offset:1024
ds_read_b128 v[164:167], v5 offset:2048
ds_read_b128 v[168:171], v5 offset:3072
s_nop 4
buffer_load_dwordx4 v[36:39], v7, s[84:87], s33 offen offset:1024 sc1
s_nop 9
buffer_load_dwordx4 v[40:43], v7, s[84:87], s33 offen offset:2048 sc1
s_nop 9
buffer_load_dwordx4 v[44:47], v7, s[84:87], s33 offen offset:3072 sc1
s_waitcnt vmcnt(3)
v_max_u32 v4, v32, v34
v_cmp_eq_u32 vcc, -1, v4
s_cbranch_vccnz mega_kernel_rf_pa_15_0f
v_smfmac_f32_16x16x64_bf16 v[96:99], v[32:35], a[0:7], v6
v_smfmac_f32_16x16x64_bf16 v[100:103], v[32:35], a[32:39], v6
v_smfmac_f32_16x16x64_bf16 v[104:107], v[32:35], a[64:71], v6
s_waitcnt vmcnt(2)
v_max_u32 v4, v36, v38
v_cmp_eq_u32 vcc, -1, v4
v_smfmac_f32_16x16x64_bf16 v[108:111], v[32:35], a[96:103], v6
s_cbranch_vccnz mega_kernel_rf_pa_14_1f
v_smfmac_f32_16x16x64_bf16 v[96:99], v[36:39], a[8:15], v6
v_smfmac_f32_16x16x64_bf16 v[100:103], v[36:39], a[40:47], v6
v_smfmac_f32_16x16x64_bf16 v[104:107], v[36:39], a[72:79], v6
s_waitcnt vmcnt(1)
v_max_u32 v4, v40, v42
v_cmp_eq_u32 vcc, -1, v4
v_smfmac_f32_16x16x64_bf16 v[108:111], v[36:39], a[104:111], v6
s_cbranch_vccnz mega_kernel_rf_pa_12_2f
v_smfmac_f32_16x16x64_bf16 v[96:99], v[40:43], a[16:23], v6
v_smfmac_f32_16x16x64_bf16 v[100:103], v[40:43], a[48:55], v6
v_smfmac_f32_16x16x64_bf16 v[104:107], v[40:43], a[80:87], v6
s_waitcnt vmcnt(0)
v_max_u32 v4, v44, v46
v_cmp_eq_u32 vcc, -1, v4
v_smfmac_f32_16x16x64_bf16 v[108:111], v[40:43], a[112:119], v6
s_cbranch_vccnz mega_kernel_rf_pa_8_3f
v_smfmac_f32_16x16x64_bf16 v[96:99], v[44:47], a[24:31], v6
v_smfmac_f32_16x16x64_bf16 v[100:103], v[44:47], a[56:63], v6
v_smfmac_f32_16x16x64_bf16 v[104:107], v[44:47], a[88:95], v6
v_smfmac_f32_16x16x64_bf16 v[108:111], v[44:47], a[120:127], v6
mega_kernel_rf_pa_d:
mega_kernel_rf_adone:
s_nop 5
v_permlane32_swap_b32 v96, v100
v_permlane32_swap_b32 v97, v101
v_permlane32_swap_b32 v98, v102
v_permlane32_swap_b32 v99, v103
v_pk_add_f32 v[96:97], v[96:97], v[100:101]
v_pk_add_f32 v[98:99], v[98:99], v[102:103]
ds_write2_b32 v14, v96, v97 offset0:0 offset1:36
ds_write2_b32 v14, v98, v99 offset0:72 offset1:108
v_permlane32_swap_b32 v104, v108
v_permlane32_swap_b32 v105, v109
v_permlane32_swap_b32 v106, v110
v_permlane32_swap_b32 v107, v111
v_pk_add_f32 v[104:105], v[104:105], v[108:109]
v_pk_add_f32 v[106:107], v[106:107], v[110:111]
ds_write2_b32 v15, v104, v105 offset0:0 offset1:36
ds_write2_b32 v15, v106, v107 offset0:72 offset1:108
v_smfmac_f32_16x16x64_bf16 v[112:115], v[32:35], a[128:135], v6
v_smfmac_f32_16x16x64_bf16 v[116:119], v[32:35], a[160:167], v6
v_smfmac_f32_16x16x64_bf16 v[112:115], v[36:39], a[136:143], v6
v_smfmac_f32_16x16x64_bf16 v[116:119], v[36:39], a[168:175], v6
s_waitcnt lgkmcnt(0)
s_barrier
s_cmp_lg_u32 s24, 0
s_cbranch_scc1 mega_kernel_rf_side
ds_read_b128 v[120:123], v16 offset:0
ds_read_b128 v[124:127], v16 offset:16
ds_read_b128 v[128:131], v16 offset:2304
ds_read_b128 v[132:135], v16 offset:2320
ds_read_b128 v[136:139], v16 offset:4608
ds_read_b128 v[140:143], v16 offset:4624
ds_read_b128 v[144:147], v16 offset:6912
ds_read_b128 v[148:151], v16 offset:6928
v_smfmac_f32_16x16x64_bf16 v[112:115], v[40:43], a[144:151], v6
v_smfmac_f32_16x16x64_bf16 v[116:119], v[40:43], a[176:183], v6
v_smfmac_f32_16x16x64_bf16 v[112:115], v[44:47], a[152:159], v6
v_smfmac_f32_16x16x64_bf16 v[116:119], v[44:47], a[184:191], v6
s_mul_i32 s28, s31, 2048
s_add_u32 s28, s28, s33
s_add_u32 s28, s28, 49152
s_add_u32 s76, s37, s33
s_add_u32 s77, s38, s33
s_add_u32 s78, s39, s33
s_waitcnt lgkmcnt(4)
v_pk_add_f32 v[120:121], v[120:121], v[128:129]
v_pk_add_f32 v[122:123], v[122:123], v[130:131]
v_pk_add_f32 v[124:125], v[124:125], v[132:133]
v_pk_add_f32 v[126:127], v[126:127], v[134:135]
s_waitcnt lgkmcnt(0)
v_pk_add_f32 v[136:137], v[136:137], v[144:145]
v_pk_add_f32 v[138:139], v[138:139], v[146:147]
v_pk_add_f32 v[140:141], v[140:141], v[148:149]
v_pk_add_f32 v[142:143], v[142:143], v[150:151]
v_pk_add_f32 v[120:121], v[120:121], v[136:137]
v_pk_add_f32 v[122:123], v[122:123], v[138:139]
v_pk_add_f32 v[124:125], v[124:125], v[140:141]
v_pk_add_f32 v[126:127], v[126:127], v[142:143]
v_cvt_pk_bf16_f32 v152, v120, v121
v_cvt_pk_bf16_f32 v153, v122, v123
v_cvt_pk_bf16_f32 v154, v124, v125
v_cvt_pk_bf16_f32 v155, v126, v127
s_nop 1
v_mfma_f32_16x16x32_bf16 v[176:179], v[160:163], v[152:155], 0
v_mfma_f32_16x16x32_bf16 v[172:175], v[156:159], v[152:155], 0
v_mfma_f32_16x16x32_bf16 v[180:183], v[152:155], v[152:155], 0
s_cmp_eq_u32 s27, 63
s_cbranch_scc1 mega_kernel_rf_w0last
s_nop 4
v_mov_b32_dpp v172, v176 row_shr:8 row_mask:0xf bank_mask:0xc
v_mov_b32_dpp v173, v177 row_shr:8 row_mask:0xf bank_mask:0xc
v_mov_b32_dpp v174, v178 row_shr:8 row_mask:0xf bank_mask:0xc
v_mov_b32_dpp v175, v179 row_shr:8 row_mask:0xf bank_mask:0xc
v_min_u32 v180, -2, v180
v_min_u32 v172, -2, v172
s_mov_b64 exec, s[42:43]
buffer_store_dwordx4 v[180:183], v10, s[84:87], s28 offen
s_mov_b64 exec, -1
buffer_store_dwordx4 v[172:175], v17, s[84:87], s28 offen
v_permlane32_swap_b32 v112, v116
v_permlane32_swap_b32 v113, v117
v_permlane32_swap_b32 v114, v118
v_permlane32_swap_b32 v115, v119
v_pk_add_f32 v[112:113], v[112:113], v[116:117]
v_pk_add_f32 v[114:115], v[114:115], v[118:119]
ds_write_b128 v20, v[112:115]
s_waitcnt lgkmcnt(0)
s_barrier
v_mov_b32 v96, 0
v_mov_b32 v97, 0
v_mov_b32 v98, 0
v_mov_b32 v99, 0
v_mov_b32 v100, 0
v_mov_b32 v101, 0
v_mov_b32 v102, 0
v_mov_b32 v103, 0
v_cndmask_b32 v176, v23, v180, s[42:43]
v_cndmask_b32 v177, v23, v181, s[42:43]
v_cndmask_b32 v178, v23, v182, s[42:43]
v_cndmask_b32 v179, v23, v183, s[42:43]
s_mov_b64 exec, s[42:43]
buffer_load_dwordx4 v[188:191], v10, s[84:87], s76 offen sc1
buffer_load_dwordx4 v[196:199], v10, s[84:87], s77 offen sc1
buffer_load_dwordx4 v[204:207], v10, s[84:87], s78 offen sc1
s_mov_b64 exec, -1
buffer_load_dwordx4 v[184:187], v17, s[84:87], s76 offen sc1
buffer_load_dwordx4 v[192:195], v17, s[84:87], s77 offen sc1
buffer_load_dwordx4 v[200:203], v17, s[84:87], s78 offen sc1
v_pk_mul_f32 v[172:173], v[172:173], s[32:33] op_sel_hi:[1,0]
v_pk_mul_f32 v[174:175], v[174:175], s[32:33] op_sel_hi:[1,0]
v_pk_mul_f32 v[176:177], v[176:177], s[32:33] op_sel_hi:[1,0]
v_pk_mul_f32 v[178:179], v[178:179], s[32:33] op_sel_hi:[1,0]
s_lshl_b32 s89, s47, 31
s_or_b32 s89, s89, 0x3b39999a
s_nop 15
s_nop 1
s_mov_b64 exec, s[42:43]
buffer_load_dwordx4 v[188:191], v10, s[84:87], s76 offen sc1
buffer_load_dwordx4 v[196:199], v10, s[84:87], s77 offen sc1
buffer_load_dwordx4 v[204:207], v10, s[84:87], s78 offen sc1
s_mov_b64 exec, -1
buffer_load_dwordx4 v[184:187], v17, s[84:87], s76 offen sc1
buffer_load_dwordx4 v[192:195], v17, s[84:87], s77 offen sc1
buffer_load_dwordx4 v[200:203], v17, s[84:87], s78 offen sc1
mega_kernel_rf_p2:
s_waitcnt vmcnt(6)
v_max3_u32 v4, v184, v188, v192
v_max3_u32 v5, v196, v200, v204
v_max_u32 v4, v4, v5
v_cmp_eq_u32 vcc, -1, v4
s_cbranch_vccnz mega_kernel_rf_p2r
v_pk_add_f32 v[124:125], v[196:197], v[204:205]
v_pk_add_f32 v[126:127], v[198:199], v[206:207]
v_pk_add_f32 v[120:121], v[192:193], v[200:201]
v_pk_add_f32 v[122:123], v[194:195], v[202:203]
v_pk_add_f32 v[124:125], v[124:125], v[188:189]
v_pk_add_f32 v[126:127], v[126:127], v[190:191]
v_pk_add_f32 v[120:121], v[120:121], v[184:185]
v_pk_add_f32 v[122:123], v[122:123], v[186:187]
v_pk_fma_f32 v[176:177], v[124:125], s[32:33], v[176:177] op_sel_hi:[1,0,1]
v_pk_fma_f32 v[178:179], v[126:127], s[32:33], v[178:179] op_sel_hi:[1,0,1]
v_pk_fma_f32 v[172:173], v[120:121], s[32:33], v[172:173] op_sel_hi:[1,0,1]
v_pk_fma_f32 v[174:175], v[122:123], s[32:33], v[174:175] op_sel_hi:[1,0,1]
v_max3_f32 v232, v172, v173, v174
v_max3_f32 v233, v176, v177, v178
v_max3_f32 v232, v232, v175, v179
v_max_f32 v234, v232, v233
s_barrier
ds_read2_b64 v[208:211], v21 offset0:0 offset1:32
v_max_f32_dpp v232, v234, v234 row_ror:8 row_mask:0xf bank_mask:0xf
v_max_f32_dpp v233, v234, v234 row_ror:8 row_mask:0xf bank_mask:0xf
s_nop 1
v_permlane16_swap_b32 v232, v233
s_nop 0
v_max_f32 v234, v232, v233
v_max_f32 v235, v232, v233
s_nop 1
v_permlane32_swap_b32 v234, v235
s_nop 0
v_max_f32 v232, v234, v235
v_pk_add_f32 v[176:177], v[176:177], v[232:233] op_sel_hi:[1,0] neg_lo:[0,1] neg_hi:[0,1]
v_pk_add_f32 v[178:179], v[178:179], v[232:233] op_sel_hi:[1,0] neg_lo:[0,1] neg_hi:[0,1]
v_pk_add_f32 v[172:173], v[172:173], v[232:233] op_sel_hi:[1,0] neg_lo:[0,1] neg_hi:[0,1]
v_pk_add_f32 v[174:175], v[174:175], v[232:233] op_sel_hi:[1,0] neg_lo:[0,1] neg_hi:[0,1]
v_exp_f32 v176, v176
v_exp_f32 v177, v177
v_exp_f32 v178, v178
v_exp_f32 v179, v179
v_exp_f32 v172, v172
v_cvt_pk_bf16_f32 v216, v176, v177
v_cvt_pk_bf16_f32 v217, v178, v179
v_exp_f32 v173, v173
v_exp_f32 v174, v174
v_mfma_f32_16x16x16_bf16 v[224:227], v[220:221], v[216:217], 0
v_exp_f32 v175, v175
v_cvt_pk_bf16_f32 v212, v172, v173
s_waitcnt lgkmcnt(0)
v_mfma_f32_16x16x16_bf16 v[120:123], v[208:209], v[216:217], 0
v_cvt_pk_bf16_f32 v213, v174, v175
v_mfma_f32_16x16x16_bf16 v[124:127], v[210:211], v[216:217], 0
v_mov_b32_dpp v214, v212 row_ror:8 row_mask:0xf bank_mask:0xf
v_mov_b32_dpp v215, v213 row_ror:8 row_mask:0xf bank_mask:0xf
s_nop 1
v_mfma_f32_16x16x32_bf16 v[224:227], v[220:223], v[212:215], v[224:227]
v_mfma_f32_16x16x32_bf16 v[120:123], v[164:167], v[212:215], v[120:123]
v_mfma_f32_16x16x32_bf16 v[124:127], v[168:171], v[212:215], v[124:127]
s_add_u32 s29, s33, 24576
s_nop 4
v_rcp_f32 v234, v224
s_nop 0
v_pk_mul_f32 v[120:121], v[120:121], v[234:235] op_sel_hi:[1,0]
v_pk_mul_f32 v[122:123], v[122:123], v[234:235] op_sel_hi:[1,0]
v_pk_mul_f32 v[124:125], v[124:125], v[234:235] op_sel_hi:[1,0]
v_pk_mul_f32 v[126:127], v[126:127], v[234:235] op_sel_hi:[1,0]
v_cvt_pk_bf16_f32 v212, v120, v121
v_cvt_pk_bf16_f32 v213, v122, v123
v_cvt_pk_bf16_f32 v214, v124, v125
v_cvt_pk_bf16_f32 v215, v126, v127
v_min_u32 v212, -2, v212
s_mov_b64 exec, s[40:41]
buffer_store_dwordx4 v[212:215], v11, s[84:87], s33 offen
s_mov_b64 exec, -1
mega_kernel_rf_b3:
s_barrier
s_nop 15
buffer_load_dwordx4 v[32:35], v7, s[84:87], s29 offen offset:0 sc1
s_nop 9
buffer_load_dwordx4 v[36:39], v7, s[84:87], s29 offen offset:1024 sc1
s_nop 9
buffer_load_dwordx4 v[40:43], v7, s[84:87], s29 offen offset:2048 sc1
s_nop 9
buffer_load_dwordx4 v[44:47], v7, s[84:87], s29 offen offset:3072 sc1
mega_kernel_rf_pc_15_0:
s_waitcnt vmcnt(3)
v_cmp_eq_u32 vcc, -1, v32
s_cbranch_vccnz mega_kernel_rf_pc_15_0f
v_smfmac_f32_16x16x64_bf16 v[96:99], v[32:35], a[192:199], v6
v_smfmac_f32_16x16x64_bf16 v[100:103], v[32:35], a[224:231], v6
mega_kernel_rf_pc_14_1:
s_waitcnt vmcnt(2)
v_cmp_eq_u32 vcc, -1, v36
s_cbranch_vccnz mega_kernel_rf_pc_14_1f
v_smfmac_f32_16x16x64_bf16 v[96:99], v[36:39], a[200:207], v6
v_smfmac_f32_16x16x64_bf16 v[100:103], v[36:39], a[232:239], v6
mega_kernel_rf_pc_12_2:
s_waitcnt vmcnt(1)
v_cmp_eq_u32 vcc, -1, v40
s_cbranch_vccnz mega_kernel_rf_pc_12_2f
v_smfmac_f32_16x16x64_bf16 v[96:99], v[40:43], a[208:215], v6
v_smfmac_f32_16x16x64_bf16 v[100:103], v[40:43], a[240:247], v6
mega_kernel_rf_pc_8_3:
s_waitcnt vmcnt(0)
v_cmp_eq_u32 vcc, -1, v44
s_cbranch_vccnz mega_kernel_rf_pc_8_3f
v_smfmac_f32_16x16x64_bf16 v[96:99], v[44:47], a[216:223], v6
v_smfmac_f32_16x16x64_bf16 v[100:103], v[44:47], a[248:255], v6
mega_kernel_rf_pc_d:
s_nop 7
v_permlane32_swap_b32 v96, v100
v_permlane32_swap_b32 v97, v101
v_permlane32_swap_b32 v98, v102
v_permlane32_swap_b32 v99, v103
v_pk_add_f32 v[96:97], v[96:97], v[100:101]
v_pk_add_f32 v[98:99], v[98:99], v[102:103]
ds_write2_b32 v18, v96, v97 offset0:0 offset1:36
ds_write2_b32 v18, v98, v99 offset0:72 offset1:108
s_waitcnt lgkmcnt(0)
s_barrier
s_cmp_lg_u32 s24, 0
s_cbranch_scc1 mega_kernel_rf_x1
ds_read_b128 v[120:123], v19 offset:0
ds_read_b128 v[124:127], v19 offset:1152
ds_read_b128 v[128:131], v19 offset:2304
ds_read_b128 v[132:135], v19 offset:3456
s_waitcnt lgkmcnt(2)
v_pk_add_f32 v[120:121], v[120:121], v[124:125]
v_pk_add_f32 v[122:123], v[122:123], v[126:127]
s_waitcnt lgkmcnt(0)
v_pk_add_f32 v[128:129], v[128:129], v[132:133]
v_pk_add_f32 v[130:131], v[130:131], v[134:135]
v_pk_add_f32 v[120:121], v[120:121], v[128:129]
v_pk_add_f32 v[122:123], v[122:123], v[130:131]
v_fma_f32 v212, v120, s89, v120
v_cvt_pk_bf16_f32 v213, v122, v123
v_cvt_pk_bf16_f32 v212, v212, v121
v_and_or_b32 v212, v212, -2, s47
buffer_store_dwordx2 v[212:213], v12, s[84:87], s35 offen sc1
s_mov_b32 s77, 0x3f80
s_mov_b32 s78, 0x3f800000
s_xor_b32 s76, s47, 1
v_mov_b32 v48, s76
v_mov_b32 v50, s76
v_mov_b32 v52, s76
s_nop 8
v_mov_b32 v96, 0
v_mov_b32 v97, 0
v_mov_b32 v98, 0
v_mov_b32 v99, 0
v_mov_b32 v100, 0
v_mov_b32 v101, 0
v_mov_b32 v102, 0
v_mov_b32 v103, 0
v_mov_b32 v104, 0
v_mov_b32 v105, 0
v_mov_b32 v106, 0
v_mov_b32 v107, 0
v_mov_b32 v108, 0
v_mov_b32 v109, 0
v_mov_b32 v110, 0
v_mov_b32 v111, 0
v_mov_b32 v112, 0
v_mov_b32 v113, 0
v_mov_b32 v114, 0
v_mov_b32 v115, 0
v_mov_b32 v116, 0
v_mov_b32 v117, 0
v_mov_b32 v118, 0
v_mov_b32 v119, 0
s_nop 15
s_nop 7
s_cmp_eq_u32 s47, 1
s_cbranch_scc1 mega_kernel_rf_p4_1
.p2align 6
mega_kernel_rf_p4_0:
buffer_load_dwordx2 v[48:49], v25, s[84:87], s35 offen sc1
buffer_load_dwordx2 v[50:51], v26, s[84:87], s35 offen sc1
buffer_load_dwordx2 v[52:53], v27, s[84:87], s35 offen sc1
s_waitcnt vmcnt(12)
mega_kernel_rf_p4c_0:
v_bitop3_b32 v4, v48, v50, v52 bitop3:0xfe
v_and_b32 v4, 1, v4
v_cmp_ne_u32 vcc, 0, v4
s_cbranch_vccnz mega_kernel_rf_p4_0
v_dot2_f32_bf16 v120, v48, s77, v120
v_dot2_f32_bf16 v121, v48, s78, v121
v_dot2_f32_bf16 v122, v49, s77, v122
v_dot2_f32_bf16 v123, v49, s78, v123
v_dot2_f32_bf16 v120, v50, s77, v120
v_dot2_f32_bf16 v121, v50, s78, v121
v_dot2_f32_bf16 v122, v51, s77, v122
v_dot2_f32_bf16 v123, v51, s78, v123
v_dot2_f32_bf16 v120, v52, s77, v120
v_dot2_f32_bf16 v121, v52, s78, v121
v_dot2_f32_bf16 v122, v53, s77, v122
v_dot2_f32_bf16 v123, v53, s78, v123
s_nop 0
v_cvt_pk_bf16_f32 v212, v120, v121
v_min_u32 v212, -2, v212
v_cvt_pk_bf16_f32 v213, v122, v123
buffer_store_dwordx2 v[212:213], v9, s[84:87], s34 offen
s_branch mega_kernel_rf_p4d
mega_kernel_rf_iw0:
mega_kernel_rf_il0:
s_cbranch_execz mega_kernel_rf_il1
.p2align 6
mega_kernel_rf_p4_1:
buffer_load_dwordx2 v[48:49], v25, s[84:87], s35 offen sc1
buffer_load_dwordx2 v[50:51], v26, s[84:87], s35 offen sc1
buffer_load_dwordx2 v[52:53], v27, s[84:87], s35 offen sc1
s_waitcnt vmcnt(12)
mega_kernel_rf_p4c_1:
v_bitop3_b32 v4, v48, v50, v52 bitop3:0x80
v_and_b32 v4, 1, v4
v_cmp_ne_u32 vcc, 1, v4
s_cbranch_vccnz mega_kernel_rf_p4_1
v_dot2_f32_bf16 v120, v48, s77, v120
v_dot2_f32_bf16 v121, v48, s78, v121
v_dot2_f32_bf16 v122, v49, s77, v122
v_dot2_f32_bf16 v123, v49, s78, v123
v_dot2_f32_bf16 v120, v50, s77, v120
v_dot2_f32_bf16 v121, v50, s78, v121
v_dot2_f32_bf16 v122, v51, s77, v122
v_dot2_f32_bf16 v123, v51, s78, v123
v_dot2_f32_bf16 v120, v52, s77, v120
v_dot2_f32_bf16 v121, v52, s78, v121
v_dot2_f32_bf16 v122, v53, s77, v122
v_dot2_f32_bf16 v123, v53, s78, v123
s_nop 0
v_cvt_pk_bf16_f32 v212, v120, v121
v_min_u32 v212, -2, v212
v_cvt_pk_bf16_f32 v213, v122, v123
buffer_store_dwordx2 v[212:213], v9, s[84:87], s34 offen
mega_kernel_rf_p4d:
mega_kernel_rf_b5:
s_add_u32 s27, s27, 1
s_add_u32 s44, s44, 4096
s_cmp_eq_u32 s44, 30720
s_cselect_b32 s44, 18432, s44
s_mov_b32 s28, s33
s_mov_b32 s33, s34
s_mov_b32 s34, s28
s_xor_b32 s35, s35, 262144
s_bfe_u32 s47, s27, 0x10001
s_barrier
s_nop 15
s_branch mega_kernel_rf_loop
mega_kernel_rf_il1:
s_cbranch_execz mega_kernel_rf_il2
mega_kernel_rf_x1:
s_cmp_eq_u32 s24, 1
s_cbranch_scc0 mega_kernel_rf_x2
s_add_u32 s76, s27, 1
s_sleep 6
v_mov_b32 v5, s76
s_mov_b64 exec, 1
buffer_store_dword v5, v228, s[84:87], s81 offen sc1
s_mov_b64 exec, -1
mega_kernel_rf_x2:
s_cmp_eq_u32 s24, 3
s_cbranch_scc0 mega_kernel_rf_x4
s_cmp_eq_u32 s36, 1
s_cbranch_scc0 mega_kernel_rf_x5
s_add_u32 s76, s27, 1
s_cmp_gt_i32 s46, s76
s_cbranch_scc1 mega_kernel_rf_pf1ok
mega_kernel_rf_pf1w:
v_mov_b32 v4, 0
s_mov_b64 exec, 3
buffer_atomic_add v4, v24, s[84:87], 0 offen sc0 sc1
s_mov_b64 exec, -1
s_waitcnt vmcnt(0)
v_readlane_b32 s46, v4, 0
v_readlane_b32 s28, v4, 1
s_nop 1
s_min_i32 s46, s46, s28
s_cmp_gt_i32 s46, s76
s_cbranch_scc0 mega_kernel_rf_pf1w
mega_kernel_rf_pf1ok:
s_add_u32 s77, s76, s82
s_bfe_u32 s28, s77, 0x40002
s_lshl_b32 s28, s28, 14
s_and_b32 s77, s77, 3
s_lshl_b32 s77, s77, 11
s_add_u32 s28, s28, s77
s_add_u32 m0, s45, 0
s_nop 0
buffer_load_dwordx4 v240, s[84:87], s28 offen offset:0 sc1 lds
s_add_u32 m0, s45, 0
s_nop 0
buffer_load_dwordx4 v240, s[84:87], s28 offen offset:1024 sc1 lds
s_add_u32 m0, s45, 2048
s_nop 0
buffer_load_dwordx4 v241, s[84:87], s28 offen offset:0 sc1 lds
s_add_u32 m0, s45, 2048
s_nop 0
buffer_load_dwordx4 v241, s[84:87], s28 offen offset:1024 sc1 lds
s_add_u32 s45, s45, 4096
s_cmp_eq_u32 s45, 30720
s_cselect_b32 s45, 18432, s45
s_waitcnt vmcnt(0)
mega_kernel_rf_x5:
s_add_u32 s76, s27, 4
s_min_u32 s76, s76, 63
s_cmp_gt_i32 s46, s76
s_cbranch_scc1 mega_kernel_rf_x6
v_mov_b32 v249, 0
s_mov_b64 exec, 3
buffer_atomic_add v249, v24, s[84:87], 0 offen sc0 sc1
s_mov_b64 exec, -1
mega_kernel_rf_x6:
s_add_u32 s76, s27, 2
s_cmp_lt_u32 s76, 63
s_cbranch_scc0 mega_kernel_rf_x4
s_cmp_gt_i32 s46, s76
s_cbranch_scc0 mega_kernel_rf_x4
s_add_u32 s77, s76, s82
s_bfe_u32 s28, s77, 0x40002
s_lshl_b32 s28, s28, 14
s_and_b32 s77, s77, 3
s_lshl_b32 s77, s77, 11
s_add_u32 s28, s28, s77
s_add_u32 s28, s28, s83
s_add_u32 s28, s28, 33554432
s_buffer_load_dword s78, s[84:87], s28 offset:0
s_buffer_load_dword s78, s[84:87], s28 offset:128
s_buffer_load_dword s78, s[84:87], s28 offset:256
s_buffer_load_dword s78, s[84:87], s28 offset:384
s_buffer_load_dword s78, s[84:87], s28 offset:512
s_buffer_load_dword s78, s[84:87], s28 offset:640
s_buffer_load_dword s78, s[84:87], s28 offset:768
s_buffer_load_dword s78, s[84:87], s28 offset:896
s_buffer_load_dword s78, s[84:87], s28 offset:1024
s_buffer_load_dword s78, s[84:87], s28 offset:1152
s_buffer_load_dword s78, s[84:87], s28 offset:1280
s_buffer_load_dword s78, s[84:87], s28 offset:1408
s_buffer_load_dword s78, s[84:87], s28 offset:1536
s_buffer_load_dword s78, s[84:87], s28 offset:1664
s_buffer_load_dword s78, s[84:87], s28 offset:1792
s_buffer_load_dword s78, s[84:87], s28 offset:1920
mega_kernel_rf_x4:
v_mov_b32 v96, 0
v_mov_b32 v97, 0
v_mov_b32 v98, 0
v_mov_b32 v99, 0
v_mov_b32 v100, 0
v_mov_b32 v101, 0
v_mov_b32 v102, 0
v_mov_b32 v103, 0
v_mov_b32 v104, 0
v_mov_b32 v105, 0
v_mov_b32 v106, 0
v_mov_b32 v107, 0
v_mov_b32 v108, 0
v_mov_b32 v109, 0
v_mov_b32 v110, 0
v_mov_b32 v111, 0
v_mov_b32 v112, 0
v_mov_b32 v113, 0
v_mov_b32 v114, 0
v_mov_b32 v115, 0
v_mov_b32 v116, 0
v_mov_b32 v117, 0
v_mov_b32 v118, 0
v_mov_b32 v119, 0
s_branch mega_kernel_rf_b5
mega_kernel_rf_il2:
s_cbranch_execz mega_kernel_rf_il3
mega_kernel_rf_p2r:
s_mov_b64 exec, s[42:43]
buffer_load_dwordx4 v[188:191], v10, s[84:87], s76 offen sc1
buffer_load_dwordx4 v[196:199], v10, s[84:87], s77 offen sc1
buffer_load_dwordx4 v[204:207], v10, s[84:87], s78 offen sc1
s_mov_b64 exec, -1
buffer_load_dwordx4 v[184:187], v17, s[84:87], s76 offen sc1
buffer_load_dwordx4 v[192:195], v17, s[84:87], s77 offen sc1
buffer_load_dwordx4 v[200:203], v17, s[84:87], s78 offen sc1
s_branch mega_kernel_rf_p2
mega_kernel_rf_il3:
s_cbranch_execz mega_kernel_rf_il4
.p2align 5
mega_kernel_rf_pa_1_0f:
s_mov_b64 exec, vcc
buffer_load_dwordx4 v[32:35], v7, s[84:87], s33 offen offset:0 sc1
s_mov_b64 exec, -1
s_branch mega_kernel_rf_pa_1_0
.p2align 5
mega_kernel_rf_pa_1_0:
s_waitcnt vmcnt(0)
v_max_u32 v4, v32, v34
v_cmp_eq_u32 vcc, -1, v4
s_cbranch_vccnz mega_kernel_rf_pa_1_0f
v_smfmac_f32_16x16x64_bf16 v[96:99], v[32:35], a[0:7], v6
v_smfmac_f32_16x16x64_bf16 v[100:103], v[32:35], a[32:39], v6
v_smfmac_f32_16x16x64_bf16 v[104:107], v[32:35], a[64:71], v6
v_smfmac_f32_16x16x64_bf16 v[108:111], v[32:35], a[96:103], v6
s_branch mega_kernel_rf_pa_d
mega_kernel_rf_il4:
s_cbranch_execz mega_kernel_rf_il5
.p2align 5
mega_kernel_rf_pa_2_1f:
s_mov_b64 exec, vcc
buffer_load_dwordx4 v[36:39], v7, s[84:87], s33 offen offset:1024 sc1
s_mov_b64 exec, -1
s_branch mega_kernel_rf_pa_2_1
.p2align 5
mega_kernel_rf_pa_2_1:
s_waitcnt vmcnt(0)
v_max_u32 v4, v36, v38
v_cmp_eq_u32 vcc, -1, v4
s_cbranch_vccnz mega_kernel_rf_pa_2_1f
v_smfmac_f32_16x16x64_bf16 v[96:99], v[36:39], a[8:15], v6
v_smfmac_f32_16x16x64_bf16 v[100:103], v[36:39], a[40:47], v6
v_smfmac_f32_16x16x64_bf16 v[104:107], v[36:39], a[72:79], v6
v_smfmac_f32_16x16x64_bf16 v[108:111], v[36:39], a[104:111], v6
s_branch mega_kernel_rf_pa_d
mega_kernel_rf_il5:
s_cbranch_execz mega_kernel_rf_il6
.p2align 5
mega_kernel_rf_pa_3_0f:
s_mov_b64 exec, vcc
buffer_load_dwordx4 v[32:35], v7, s[84:87], s33 offen offset:0 sc1
s_mov_b64 exec, -1
s_branch mega_kernel_rf_pa_3_1
.p2align 5
mega_kernel_rf_pa_3_0:
s_waitcnt vmcnt(1)
v_max_u32 v4, v32, v34
v_cmp_eq_u32 vcc, -1, v4
s_cbranch_vccnz mega_kernel_rf_pa_3_0f
v_smfmac_f32_16x16x64_bf16 v[96:99], v[32:35], a[0:7], v6
v_smfmac_f32_16x16x64_bf16 v[100:103], v[32:35], a[32:39], v6
v_smfmac_f32_16x16x64_bf16 v[104:107], v[32:35], a[64:71], v6
v_smfmac_f32_16x16x64_bf16 v[108:111], v[32:35], a[96:103], v6
s_branch mega_kernel_rf_pa_2_1
mega_kernel_rf_il6:
s_cbranch_execz mega_kernel_rf_il7
.p2align 5
mega_kernel_rf_pa_3_1f:
s_mov_b64 exec, vcc
buffer_load_dwordx4 v[36:39], v7, s[84:87], s33 offen offset:1024 sc1
s_mov_b64 exec, -1
s_branch mega_kernel_rf_pa_3_0
.p2align 5
mega_kernel_rf_pa_3_1:
s_waitcnt vmcnt(1)
v_max_u32 v4, v36, v38
v_cmp_eq_u32 vcc, -1, v4
s_cbranch_vccnz mega_kernel_rf_pa_3_1f
v_smfmac_f32_16x16x64_bf16 v[96:99], v[36:39], a[8:15], v6
v_smfmac_f32_16x16x64_bf16 v[100:103], v[36:39], a[40:47], v6
v_smfmac_f32_16x16x64_bf16 v[104:107], v[36:39], a[72:79], v6
v_smfmac_f32_16x16x64_bf16 v[108:111], v[36:39], a[104:111], v6
s_branch mega_kernel_rf_pa_1_0
mega_kernel_rf_il7:
s_cbranch_execz mega_kernel_rf_il8
.p2align 5
mega_kernel_rf_pa_4_2f:
s_mov_b64 exec, vcc
buffer_load_dwordx4 v[40:43], v7, s[84:87], s33 offen offset:2048 sc1
s_mov_b64 exec, -1
s_branch mega_kernel_rf_pa_4_2
.p2align 5
mega_kernel_rf_pa_4_2:
s_waitcnt vmcnt(0)
v_max_u32 v4, v40, v42
v_cmp_eq_u32 vcc, -1, v4
s_cbranch_vccnz mega_kernel_rf_pa_4_2f
v_smfmac_f32_16x16x64_bf16 v[96:99], v[40:43], a[16:23], v6
v_smfmac_f32_16x16x64_bf16 v[100:103], v[40:43], a[48:55], v6
v_smfmac_f32_16x16x64_bf16 v[104:107], v[40:43], a[80:87], v6
v_smfmac_f32_16x16x64_bf16 v[108:111], v[40:43], a[112:119], v6
s_branch mega_kernel_rf_pa_d
mega_kernel_rf_il8:
s_cbranch_execz mega_kernel_rf_il9
.p2align 5
mega_kernel_rf_pa_5_0f:
s_mov_b64 exec, vcc
buffer_load_dwordx4 v[32:35], v7, s[84:87], s33 offen offset:0 sc1
s_mov_b64 exec, -1
s_branch mega_kernel_rf_pa_5_2
.p2align 5
mega_kernel_rf_pa_5_0:
s_waitcnt vmcnt(1)
v_max_u32 v4, v32, v34
v_cmp_eq_u32 vcc, -1, v4
s_cbranch_vccnz mega_kernel_rf_pa_5_0f
v_smfmac_f32_16x16x64_bf16 v[96:99], v[32:35], a[0:7], v6
v_smfmac_f32_16x16x64_bf16 v[100:103], v[32:35], a[32:39], v6
v_smfmac_f32_16x16x64_bf16 v[104:107], v[32:35], a[64:71], v6
v_smfmac_f32_16x16x64_bf16 v[108:111], v[32:35], a[96:103], v6
s_branch mega_kernel_rf_pa_4_2
mega_kernel_rf_il9:
s_cbranch_execz mega_kernel_rf_il10
.p2align 5
mega_kernel_rf_pa_5_2f:
s_mov_b64 exec, vcc
buffer_load_dwordx4 v[40:43], v7, s[84:87], s33 offen offset:2048 sc1
s_mov_b64 exec, -1
s_branch mega_kernel_rf_pa_5_0
.p2align 5
mega_kernel_rf_pa_5_2:
s_waitcnt vmcnt(1)
v_max_u32 v4, v40, v42
v_cmp_eq_u32 vcc, -1, v4
s_cbranch_vccnz mega_kernel_rf_pa_5_2f
v_smfmac_f32_16x16x64_bf16 v[96:99], v[40:43], a[16:23], v6
v_smfmac_f32_16x16x64_bf16 v[100:103], v[40:43], a[48:55], v6
v_smfmac_f32_16x16x64_bf16 v[104:107], v[40:43], a[80:87], v6
v_smfmac_f32_16x16x64_bf16 v[108:111], v[40:43], a[112:119], v6
s_branch mega_kernel_rf_pa_1_0
mega_kernel_rf_il10:
s_cbranch_execz mega_kernel_rf_il11
.p2align 5
mega_kernel_rf_pa_6_1f:
s_mov_b64 exec, vcc
buffer_load_dwordx4 v[36:39], v7, s[84:87], s33 offen offset:1024 sc1
s_mov_b64 exec, -1
s_branch mega_kernel_rf_pa_6_2
.p2align 5
mega_kernel_rf_pa_6_1:
s_waitcnt vmcnt(1)
v_max_u32 v4, v36, v38
v_cmp_eq_u32 vcc, -1, v4
s_cbranch_vccnz mega_kernel_rf_pa_6_1f
v_smfmac_f32_16x16x64_bf16 v[96:99], v[36:39], a[8:15], v6
v_smfmac_f32_16x16x64_bf16 v[100:103], v[36:39], a[40:47], v6
v_smfmac_f32_16x16x64_bf16 v[104:107], v[36:39], a[72:79], v6
v_smfmac_f32_16x16x64_bf16 v[108:111], v[36:39], a[104:111], v6
s_branch mega_kernel_rf_pa_4_2
mega_kernel_rf_il11:
s_cbranch_execz mega_kernel_rf_il12
.p2align 5
mega_kernel_rf_pa_6_2f:
s_mov_b64 exec, vcc
buffer_load_dwordx4 v[40:43], v7, s[84:87], s33 offen offset:2048 sc1
s_mov_b64 exec, -1
s_branch mega_kernel_rf_pa_6_1
.p2align 5
mega_kernel_rf_pa_6_2:
s_waitcnt vmcnt(1)
v_max_u32 v4, v40, v42
v_cmp_eq_u32 vcc, -1, v4
s_cbranch_vccnz mega_kernel_rf_pa_6_2f
v_smfmac_f32_16x16x64_bf16 v[96:99], v[40:43], a[16:23], v6
v_smfmac_f32_16x16x64_bf16 v[100:103], v[40:43], a[48:55], v6
v_smfmac_f32_16x16x64_bf16 v[104:107], v[40:43], a[80:87], v6
v_smfmac_f32_16x16x64_bf16 v[108:111], v[40:43], a[112:119], v6
s_branch mega_kernel_rf_pa_2_1
mega_kernel_rf_il12:
s_cbranch_execz mega_kernel_rf_il13
.p2align 5
mega_kernel_rf_pa_7_0f:
s_mov_b64 exec, vcc
buffer_load_dwordx4 v[32:35], v7, s[84:87], s33 offen offset:0 sc1
s_mov_b64 exec, -1
s_branch mega_kernel_rf_pa_7_1
.p2align 5
mega_kernel_rf_pa_7_0:
s_waitcnt vmcnt(2)
v_max_u32 v4, v32, v34
v_cmp_eq_u32 vcc, -1, v4
s_cbranch_vccnz mega_kernel_rf_pa_7_0f
v_smfmac_f32_16x16x64_bf16 v[96:99], v[32:35], a[0:7], v6
v_smfmac_f32_16x16x64_bf16 v[100:103], v[32:35], a[32:39], v6
v_smfmac_f32_16x16x64_bf16 v[104:107], v[32:35], a[64:71], v6
v_smfmac_f32_16x16x64_bf16 v[108:111], v[32:35], a[96:103], v6
s_branch mega_kernel_rf_pa_6_1
mega_kernel_rf_il13:
s_cbranch_execz mega_kernel_rf_il14
.p2align 5
mega_kernel_rf_pa_7_1f:
s_mov_b64 exec, vcc
buffer_load_dwordx4 v[36:39], v7, s[84:87], s33 offen offset:1024 sc1
s_mov_b64 exec, -1
s_branch mega_kernel_rf_pa_7_2
.p2align 5
mega_kernel_rf_pa_7_1:
s_waitcnt vmcnt(2)
v_max_u32 v4, v36, v38
v_cmp_eq_u32 vcc, -1, v4
s_cbranch_vccnz mega_kernel_rf_pa_7_1f
v_smfmac_f32_16x16x64_bf16 v[96:99], v[36:39], a[8:15], v6
v_smfmac_f32_16x16x64_bf16 v[100:103], v[36:39], a[40:47], v6
v_smfmac_f32_16x16x64_bf16 v[104:107], v[36:39], a[72:79], v6
v_smfmac_f32_16x16x64_bf16 v[108:111], v[36:39], a[104:111], v6
s_branch mega_kernel_rf_pa_5_2
mega_kernel_rf_il14:
s_cbranch_execz mega_kernel_rf_il15
.p2align 5
mega_kernel_rf_pa_7_2f:
s_mov_b64 exec, vcc
buffer_load_dwordx4 v[40:43], v7, s[84:87], s33 offen offset:2048 sc1
s_mov_b64 exec, -1
s_branch mega_kernel_rf_pa_7_0
.p2align 5
mega_kernel_rf_pa_7_2:
s_waitcnt vmcnt(2)
v_max_u32 v4, v40, v42
v_cmp_eq_u32 vcc, -1, v4
s_cbranch_vccnz mega_kernel_rf_pa_7_2f
v_smfmac_f32_16x16x64_bf16 v[96:99], v[40:43], a[16:23], v6
v_smfmac_f32_16x16x64_bf16 v[100:103], v[40:43], a[48:55], v6
v_smfmac_f32_16x16x64_bf16 v[104:107], v[40:43], a[80:87], v6
v_smfmac_f32_16x16x64_bf16 v[108:111], v[40:43], a[112:119], v6
s_branch mega_kernel_rf_pa_3_0
mega_kernel_rf_il15:
s_cbranch_execz mega_kernel_rf_il16
.p2align 5
mega_kernel_rf_pa_8_3f:
s_mov_b64 exec, vcc
buffer_load_dwordx4 v[44:47], v7, s[84:87], s33 offen offset:3072 sc1
s_mov_b64 exec, -1
s_branch mega_kernel_rf_pa_8_3
.p2align 5
mega_kernel_rf_pa_8_3:
s_waitcnt vmcnt(0)
v_max_u32 v4, v44, v46
v_cmp_eq_u32 vcc, -1, v4
s_cbranch_vccnz mega_kernel_rf_pa_8_3f
v_smfmac_f32_16x16x64_bf16 v[96:99], v[44:47], a[24:31], v6
v_smfmac_f32_16x16x64_bf16 v[100:103], v[44:47], a[56:63], v6
v_smfmac_f32_16x16x64_bf16 v[104:107], v[44:47], a[88:95], v6
v_smfmac_f32_16x16x64_bf16 v[108:111], v[44:47], a[120:127], v6
s_branch mega_kernel_rf_pa_d
mega_kernel_rf_il16:
s_cbranch_execz mega_kernel_rf_il17
.p2align 5
mega_kernel_rf_pa_9_0f:
s_mov_b64 exec, vcc
buffer_load_dwordx4 v[32:35], v7, s[84:87], s33 offen offset:0 sc1
s_mov_b64 exec, -1
s_branch mega_kernel_rf_pa_9_3
.p2align 5
mega_kernel_rf_pa_9_0:
s_waitcnt vmcnt(1)
v_max_u32 v4, v32, v34
v_cmp_eq_u32 vcc, -1, v4
s_cbranch_vccnz mega_kernel_rf_pa_9_0f
v_smfmac_f32_16x16x64_bf16 v[96:99], v[32:35], a[0:7], v6
v_smfmac_f32_16x16x64_bf16 v[100:103], v[32:35], a[32:39], v6
v_smfmac_f32_16x16x64_bf16 v[104:107], v[32:35], a[64:71], v6
v_smfmac_f32_16x16x64_bf16 v[108:111], v[32:35], a[96:103], v6
s_branch mega_kernel_rf_pa_8_3
mega_kernel_rf_il17:
s_cbranch_execz mega_kernel_rf_il18
.p2align 5
mega_kernel_rf_pa_9_3f:
s_mov_b64 exec, vcc
buffer_load_dwordx4 v[44:47], v7, s[84:87], s33 offen offset:3072 sc1
s_mov_b64 exec, -1
s_branch mega_kernel_rf_pa_9_0
.p2align 5
mega_kernel_rf_pa_9_3:
s_waitcnt vmcnt(1)
v_max_u32 v4, v44, v46
v_cmp_eq_u32 vcc, -1, v4
s_cbranch_vccnz mega_kernel_rf_pa_9_3f
v_smfmac_f32_16x16x64_bf16 v[96:99], v[44:47], a[24:31], v6
v_smfmac_f32_16x16x64_bf16 v[100:103], v[44:47], a[56:63], v6
v_smfmac_f32_16x16x64_bf16 v[104:107], v[44:47], a[88:95], v6
v_smfmac_f32_16x16x64_bf16 v[108:111], v[44:47], a[120:127], v6
s_branch mega_kernel_rf_pa_1_0
mega_kernel_rf_il18:
s_cbranch_execz mega_kernel_rf_iwd
.p2align 5
mega_kernel_rf_pa_10_1f:
s_mov_b64 exec, vcc
buffer_load_dwordx4 v[36:39], v7, s[84:87], s33 offen offset:1024 sc1
s_mov_b64 exec, -1
s_branch mega_kernel_rf_pa_10_3
.p2align 5
mega_kernel_rf_pa_10_1:
s_waitcnt vmcnt(1)
v_max_u32 v4, v36, v38
v_cmp_eq_u32 vcc, -1, v4
s_cbranch_vccnz mega_kernel_rf_pa_10_1f
v_smfmac_f32_16x16x64_bf16 v[96:99], v[36:39], a[8:15], v6
v_smfmac_f32_16x16x64_bf16 v[100:103], v[36:39], a[40:47], v6
v_smfmac_f32_16x16x64_bf16 v[104:107], v[36:39], a[72:79], v6
v_smfmac_f32_16x16x64_bf16 v[108:111], v[36:39], a[104:111], v6
s_branch mega_kernel_rf_pa_8_3
mega_kernel_rf_iw1:
mega_kernel_rf_il19:
s_cbranch_execz mega_kernel_rf_il20
.p2align 5
mega_kernel_rf_pa_10_3f:
s_mov_b64 exec, vcc
buffer_load_dwordx4 v[44:47], v7, s[84:87], s33 offen offset:3072 sc1
s_mov_b64 exec, -1
s_branch mega_kernel_rf_pa_10_1
.p2align 5
mega_kernel_rf_pa_10_3:
s_waitcnt vmcnt(1)
v_max_u32 v4, v44, v46
v_cmp_eq_u32 vcc, -1, v4
s_cbranch_vccnz mega_kernel_rf_pa_10_3f
v_smfmac_f32_16x16x64_bf16 v[96:99], v[44:47], a[24:31], v6
v_smfmac_f32_16x16x64_bf16 v[100:103], v[44:47], a[56:63], v6
v_smfmac_f32_16x16x64_bf16 v[104:107], v[44:47], a[88:95], v6
v_smfmac_f32_16x16x64_bf16 v[108:111], v[44:47], a[120:127], v6
s_branch mega_kernel_rf_pa_2_1
mega_kernel_rf_il20:
s_cbranch_execz mega_kernel_rf_il21
.p2align 5
mega_kernel_rf_pa_11_0f:
s_mov_b64 exec, vcc
buffer_load_dwordx4 v[32:35], v7, s[84:87], s33 offen offset:0 sc1
s_mov_b64 exec, -1
s_branch mega_kernel_rf_pa_11_1
.p2align 5
mega_kernel_rf_pa_11_0:
s_waitcnt vmcnt(2)
v_max_u32 v4, v32, v34
v_cmp_eq_u32 vcc, -1, v4
s_cbranch_vccnz mega_kernel_rf_pa_11_0f
v_smfmac_f32_16x16x64_bf16 v[96:99], v[32:35], a[0:7], v6
v_smfmac_f32_16x16x64_bf16 v[100:103], v[32:35], a[32:39], v6
v_smfmac_f32_16x16x64_bf16 v[104:107], v[32:35], a[64:71], v6
v_smfmac_f32_16x16x64_bf16 v[108:111], v[32:35], a[96:103], v6
s_branch mega_kernel_rf_pa_10_1
mega_kernel_rf_il21:
s_cbranch_execz mega_kernel_rf_il22
.p2align 5
mega_kernel_rf_pa_11_1f:
s_mov_b64 exec, vcc
buffer_load_dwordx4 v[36:39], v7, s[84:87], s33 offen offset:1024 sc1
s_mov_b64 exec, -1
s_branch mega_kernel_rf_pa_11_3
.p2align 5
mega_kernel_rf_pa_11_1:
s_waitcnt vmcnt(2)
v_max_u32 v4, v36, v38
v_cmp_eq_u32 vcc, -1, v4
s_cbranch_vccnz mega_kernel_rf_pa_11_1f
v_smfmac_f32_16x16x64_bf16 v[96:99], v[36:39], a[8:15], v6
v_smfmac_f32_16x16x64_bf16 v[100:103], v[36:39], a[40:47], v6
v_smfmac_f32_16x16x64_bf16 v[104:107], v[36:39], a[72:79], v6
v_smfmac_f32_16x16x64_bf16 v[108:111], v[36:39], a[104:111], v6
s_branch mega_kernel_rf_pa_9_3
mega_kernel_rf_il22:
s_cbranch_execz mega_kernel_rf_il23
.p2align 5
mega_kernel_rf_pa_11_3f:
s_mov_b64 exec, vcc
buffer_load_dwordx4 v[44:47], v7, s[84:87], s33 offen offset:3072 sc1
s_mov_b64 exec, -1
s_branch mega_kernel_rf_pa_11_0
.p2align 5
mega_kernel_rf_pa_11_3:
s_waitcnt vmcnt(2)
v_max_u32 v4, v44, v46
v_cmp_eq_u32 vcc, -1, v4
s_cbranch_vccnz mega_kernel_rf_pa_11_3f
v_smfmac_f32_16x16x64_bf16 v[96:99], v[44:47], a[24:31], v6
v_smfmac_f32_16x16x64_bf16 v[100:103], v[44:47], a[56:63], v6
v_smfmac_f32_16x16x64_bf16 v[104:107], v[44:47], a[88:95], v6
v_smfmac_f32_16x16x64_bf16 v[108:111], v[44:47], a[120:127], v6
s_branch mega_kernel_rf_pa_3_0
mega_kernel_rf_il23:
s_cbranch_execz mega_kernel_rf_il24
.p2align 5
mega_kernel_rf_pa_12_2f:
s_mov_b64 exec, vcc
buffer_load_dwordx4 v[40:43], v7, s[84:87], s33 offen offset:2048 sc1
s_mov_b64 exec, -1
s_branch mega_kernel_rf_pa_12_3
.p2align 5
mega_kernel_rf_pa_12_2:
s_waitcnt vmcnt(1)
v_max_u32 v4, v40, v42
v_cmp_eq_u32 vcc, -1, v4
s_cbranch_vccnz mega_kernel_rf_pa_12_2f
v_smfmac_f32_16x16x64_bf16 v[96:99], v[40:43], a[16:23], v6
v_smfmac_f32_16x16x64_bf16 v[100:103], v[40:43], a[48:55], v6
v_smfmac_f32_16x16x64_bf16 v[104:107], v[40:43], a[80:87], v6
v_smfmac_f32_16x16x64_bf16 v[108:111], v[40:43], a[112:119], v6
s_branch mega_kernel_rf_pa_8_3
mega_kernel_rf_il24:
s_cbranch_execz mega_kernel_rf_il25
.p2align 5
mega_kernel_rf_pa_12_3f:
s_mov_b64 exec, vcc
buffer_load_dwordx4 v[44:47], v7, s[84:87], s33 offen offset:3072 sc1
s_mov_b64 exec, -1
s_branch mega_kernel_rf_pa_12_2
.p2align 5
mega_kernel_rf_pa_12_3:
s_waitcnt vmcnt(1)
v_max_u32 v4, v44, v46
v_cmp_eq_u32 vcc, -1, v4
s_cbranch_vccnz mega_kernel_rf_pa_12_3f
v_smfmac_f32_16x16x64_bf16 v[96:99], v[44:47], a[24:31], v6
v_smfmac_f32_16x16x64_bf16 v[100:103], v[44:47], a[56:63], v6
v_smfmac_f32_16x16x64_bf16 v[104:107], v[44:47], a[88:95], v6
v_smfmac_f32_16x16x64_bf16 v[108:111], v[44:47], a[120:127], v6
s_branch mega_kernel_rf_pa_4_2
mega_kernel_rf_il25:
s_cbranch_execz mega_kernel_rf_il26
.p2align 5
mega_kernel_rf_pa_13_0f:
s_mov_b64 exec, vcc
buffer_load_dwordx4 v[32:35], v7, s[84:87], s33 offen offset:0 sc1
s_mov_b64 exec, -1
s_branch mega_kernel_rf_pa_13_2
.p2align 5
mega_kernel_rf_pa_13_0:
s_waitcnt vmcnt(2)
v_max_u32 v4, v32, v34
v_cmp_eq_u32 vcc, -1, v4
s_cbranch_vccnz mega_kernel_rf_pa_13_0f
v_smfmac_f32_16x16x64_bf16 v[96:99], v[32:35], a[0:7], v6
v_smfmac_f32_16x16x64_bf16 v[100:103], v[32:35], a[32:39], v6
v_smfmac_f32_16x16x64_bf16 v[104:107], v[32:35], a[64:71], v6
v_smfmac_f32_16x16x64_bf16 v[108:111], v[32:35], a[96:103], v6
s_branch mega_kernel_rf_pa_12_2
mega_kernel_rf_il26:
s_cbranch_execz mega_kernel_rf_il27
.p2align 5
mega_kernel_rf_pa_13_2f:
s_mov_b64 exec, vcc
buffer_load_dwordx4 v[40:43], v7, s[84:87], s33 offen offset:2048 sc1
s_mov_b64 exec, -1
s_branch mega_kernel_rf_pa_13_3
.p2align 5
mega_kernel_rf_pa_13_2:
s_waitcnt vmcnt(2)
v_max_u32 v4, v40, v42
v_cmp_eq_u32 vcc, -1, v4
s_cbranch_vccnz mega_kernel_rf_pa_13_2f
v_smfmac_f32_16x16x64_bf16 v[96:99], v[40:43], a[16:23], v6
v_smfmac_f32_16x16x64_bf16 v[100:103], v[40:43], a[48:55], v6
v_smfmac_f32_16x16x64_bf16 v[104:107], v[40:43], a[80:87], v6
v_smfmac_f32_16x16x64_bf16 v[108:111], v[40:43], a[112:119], v6
s_branch mega_kernel_rf_pa_9_3
mega_kernel_rf_il27:
s_cbranch_execz mega_kernel_rf_il28
.p2align 5
mega_kernel_rf_pa_13_3f:
s_mov_b64 exec, vcc
buffer_load_dwordx4 v[44:47], v7, s[84:87], s33 offen offset:3072 sc1
s_mov_b64 exec, -1
s_branch mega_kernel_rf_pa_13_0
.p2align 5
mega_kernel_rf_pa_13_3:
s_waitcnt vmcnt(2)
v_max_u32 v4, v44, v46
v_cmp_eq_u32 vcc, -1, v4
s_cbranch_vccnz mega_kernel_rf_pa_13_3f
v_smfmac_f32_16x16x64_bf16 v[96:99], v[44:47], a[24:31], v6
v_smfmac_f32_16x16x64_bf16 v[100:103], v[44:47], a[56:63], v6
v_smfmac_f32_16x16x64_bf16 v[104:107], v[44:47], a[88:95], v6
v_smfmac_f32_16x16x64_bf16 v[108:111], v[44:47], a[120:127], v6
s_branch mega_kernel_rf_pa_5_0
mega_kernel_rf_il28:
s_cbranch_execz mega_kernel_rf_il29
.p2align 5
mega_kernel_rf_pa_14_1f:
s_mov_b64 exec, vcc
buffer_load_dwordx4 v[36:39], v7, s[84:87], s33 offen offset:1024 sc1
s_mov_b64 exec, -1
s_branch mega_kernel_rf_pa_14_2
.p2align 5
mega_kernel_rf_pa_14_1:
s_waitcnt vmcnt(2)
v_max_u32 v4, v36, v38
v_cmp_eq_u32 vcc, -1, v4
s_cbranch_vccnz mega_kernel_rf_pa_14_1f
v_smfmac_f32_16x16x64_bf16 v[96:99], v[36:39], a[8:15], v6
v_smfmac_f32_16x16x64_bf16 v[100:103], v[36:39], a[40:47], v6
v_smfmac_f32_16x16x64_bf16 v[104:107], v[36:39], a[72:79], v6
v_smfmac_f32_16x16x64_bf16 v[108:111], v[36:39], a[104:111], v6
s_branch mega_kernel_rf_pa_12_2
mega_kernel_rf_il29:
s_cbranch_execz mega_kernel_rf_il30
.p2align 5
mega_kernel_rf_pa_14_2f:
s_mov_b64 exec, vcc
buffer_load_dwordx4 v[40:43], v7, s[84:87], s33 offen offset:2048 sc1
s_mov_b64 exec, -1
s_branch mega_kernel_rf_pa_14_3
.p2align 5
mega_kernel_rf_pa_14_2:
s_waitcnt vmcnt(2)
v_max_u32 v4, v40, v42
v_cmp_eq_u32 vcc, -1, v4
s_cbranch_vccnz mega_kernel_rf_pa_14_2f
v_smfmac_f32_16x16x64_bf16 v[96:99], v[40:43], a[16:23], v6
v_smfmac_f32_16x16x64_bf16 v[100:103], v[40:43], a[48:55], v6
v_smfmac_f32_16x16x64_bf16 v[104:107], v[40:43], a[80:87], v6
v_smfmac_f32_16x16x64_bf16 v[108:111], v[40:43], a[112:119], v6
s_branch mega_kernel_rf_pa_10_3
mega_kernel_rf_il30:
s_cbranch_execz mega_kernel_rf_il31
.p2align 5
mega_kernel_rf_pa_14_3f:
s_mov_b64 exec, vcc
buffer_load_dwordx4 v[44:47], v7, s[84:87], s33 offen offset:3072 sc1
s_mov_b64 exec, -1
s_branch mega_kernel_rf_pa_14_1
.p2align 5
mega_kernel_rf_pa_14_3:
s_waitcnt vmcnt(2)
v_max_u32 v4, v44, v46
v_cmp_eq_u32 vcc, -1, v4
s_cbranch_vccnz mega_kernel_rf_pa_14_3f
v_smfmac_f32_16x16x64_bf16 v[96:99], v[44:47], a[24:31], v6
v_smfmac_f32_16x16x64_bf16 v[100:103], v[44:47], a[56:63], v6
v_smfmac_f32_16x16x64_bf16 v[104:107], v[44:47], a[88:95], v6
v_smfmac_f32_16x16x64_bf16 v[108:111], v[44:47], a[120:127], v6
s_branch mega_kernel_rf_pa_6_1
mega_kernel_rf_il31:
s_cbranch_execz mega_kernel_rf_il32
.p2align 5
mega_kernel_rf_pa_15_0f:
s_mov_b64 exec, vcc
buffer_load_dwordx4 v[32:35], v7, s[84:87], s33 offen offset:0 sc1
s_mov_b64 exec, -1
s_branch mega_kernel_rf_pa_15_1
.p2align 5
mega_kernel_rf_pa_15_0:
s_waitcnt vmcnt(3)
v_max_u32 v4, v32, v34
v_cmp_eq_u32 vcc, -1, v4
s_cbranch_vccnz mega_kernel_rf_pa_15_0f
v_smfmac_f32_16x16x64_bf16 v[96:99], v[32:35], a[0:7], v6
v_smfmac_f32_16x16x64_bf16 v[100:103], v[32:35], a[32:39], v6
v_smfmac_f32_16x16x64_bf16 v[104:107], v[32:35], a[64:71], v6
v_smfmac_f32_16x16x64_bf16 v[108:111], v[32:35], a[96:103], v6
s_branch mega_kernel_rf_pa_14_1
mega_kernel_rf_il32:
s_cbranch_execz mega_kernel_rf_il33
.p2align 5
mega_kernel_rf_pa_15_1f:
s_mov_b64 exec, vcc
buffer_load_dwordx4 v[36:39], v7, s[84:87], s33 offen offset:1024 sc1
s_mov_b64 exec, -1
s_branch mega_kernel_rf_pa_15_2
.p2align 5
mega_kernel_rf_pa_15_1:
s_waitcnt vmcnt(3)
v_max_u32 v4, v36, v38
v_cmp_eq_u32 vcc, -1, v4
s_cbranch_vccnz mega_kernel_rf_pa_15_1f
v_smfmac_f32_16x16x64_bf16 v[96:99], v[36:39], a[8:15], v6
v_smfmac_f32_16x16x64_bf16 v[100:103], v[36:39], a[40:47], v6
v_smfmac_f32_16x16x64_bf16 v[104:107], v[36:39], a[72:79], v6
v_smfmac_f32_16x16x64_bf16 v[108:111], v[36:39], a[104:111], v6
s_branch mega_kernel_rf_pa_13_2
mega_kernel_rf_il33:
s_cbranch_execz mega_kernel_rf_il34
.p2align 5
mega_kernel_rf_pa_15_2f:
s_mov_b64 exec, vcc
buffer_load_dwordx4 v[40:43], v7, s[84:87], s33 offen offset:2048 sc1
s_mov_b64 exec, -1
s_branch mega_kernel_rf_pa_15_3
.p2align 5
mega_kernel_rf_pa_15_2:
s_waitcnt vmcnt(3)
v_max_u32 v4, v40, v42
v_cmp_eq_u32 vcc, -1, v4
s_cbranch_vccnz mega_kernel_rf_pa_15_2f
v_smfmac_f32_16x16x64_bf16 v[96:99], v[40:43], a[16:23], v6
v_smfmac_f32_16x16x64_bf16 v[100:103], v[40:43], a[48:55], v6
v_smfmac_f32_16x16x64_bf16 v[104:107], v[40:43], a[80:87], v6
v_smfmac_f32_16x16x64_bf16 v[108:111], v[40:43], a[112:119], v6
s_branch mega_kernel_rf_pa_11_3
mega_kernel_rf_il34:
s_cbranch_execz mega_kernel_rf_il35
.p2align 5
mega_kernel_rf_pa_15_3f:
s_mov_b64 exec, vcc
buffer_load_dwordx4 v[44:47], v7, s[84:87], s33 offen offset:3072 sc1
s_mov_b64 exec, -1
s_branch mega_kernel_rf_pa_15_0
.p2align 5
mega_kernel_rf_pa_15_3:
s_waitcnt vmcnt(3)
v_max_u32 v4, v44, v46
v_cmp_eq_u32 vcc, -1, v4
s_cbranch_vccnz mega_kernel_rf_pa_15_3f
v_smfmac_f32_16x16x64_bf16 v[96:99], v[44:47], a[24:31], v6
v_smfmac_f32_16x16x64_bf16 v[100:103], v[44:47], a[56:63], v6
v_smfmac_f32_16x16x64_bf16 v[104:107], v[44:47], a[88:95], v6
v_smfmac_f32_16x16x64_bf16 v[108:111], v[44:47], a[120:127], v6
s_branch mega_kernel_rf_pa_7_0
mega_kernel_rf_il35:
s_cbranch_execz mega_kernel_rf_il36
.p2align 5
mega_kernel_rf_pc_1_0f:
s_mov_b64 exec, vcc
buffer_load_dwordx4 v[32:35], v7, s[84:87], s29 offen offset:0 sc1
s_mov_b64 exec, -1
s_branch mega_kernel_rf_pc_1_0
.p2align 5
mega_kernel_rf_pc_1_0:
s_waitcnt vmcnt(0)
v_cmp_eq_u32 vcc, -1, v32
s_cbranch_vccnz mega_kernel_rf_pc_1_0f
v_smfmac_f32_16x16x64_bf16 v[96:99], v[32:35], a[192:199], v6
v_smfmac_f32_16x16x64_bf16 v[100:103], v[32:35], a[224:231], v6
s_branch mega_kernel_rf_pc_d
mega_kernel_rf_il36:
s_cbranch_execz mega_kernel_rf_il37
.p2align 5
mega_kernel_rf_pc_2_1f:
s_mov_b64 exec, vcc
buffer_load_dwordx4 v[36:39], v7, s[84:87], s29 offen offset:1024 sc1
s_mov_b64 exec, -1
s_branch mega_kernel_rf_pc_2_1
mega_kernel_rf_il37:
s_cbranch_execz mega_kernel_rf_iwd
.p2align 5
mega_kernel_rf_pc_2_1:
s_waitcnt vmcnt(0)
v_cmp_eq_u32 vcc, -1, v36
s_cbranch_vccnz mega_kernel_rf_pc_2_1f
v_smfmac_f32_16x16x64_bf16 v[96:99], v[36:39], a[200:207], v6
v_smfmac_f32_16x16x64_bf16 v[100:103], v[36:39], a[232:239], v6
s_branch mega_kernel_rf_pc_d
.p2align 5
mega_kernel_rf_pc_3_0f:
s_mov_b64 exec, vcc
buffer_load_dwordx4 v[32:35], v7, s[84:87], s29 offen offset:0 sc1
s_mov_b64 exec, -1
s_branch mega_kernel_rf_pc_3_1
mega_kernel_rf_iw2:
mega_kernel_rf_il38:
s_cbranch_execz mega_kernel_rf_il39
.p2align 5
mega_kernel_rf_pc_3_0:
s_waitcnt vmcnt(1)
v_cmp_eq_u32 vcc, -1, v32
s_cbranch_vccnz mega_kernel_rf_pc_3_0f
v_smfmac_f32_16x16x64_bf16 v[96:99], v[32:35], a[192:199], v6
v_smfmac_f32_16x16x64_bf16 v[100:103], v[32:35], a[224:231], v6
s_branch mega_kernel_rf_pc_2_1
.p2align 5
mega_kernel_rf_pc_3_1f:
s_mov_b64 exec, vcc
buffer_load_dwordx4 v[36:39], v7, s[84:87], s29 offen offset:1024 sc1
s_mov_b64 exec, -1
s_branch mega_kernel_rf_pc_3_0
mega_kernel_rf_il39:
s_cbranch_execz mega_kernel_rf_il40
.p2align 5
mega_kernel_rf_pc_3_1:
s_waitcnt vmcnt(1)
v_cmp_eq_u32 vcc, -1, v36
s_cbranch_vccnz mega_kernel_rf_pc_3_1f
v_smfmac_f32_16x16x64_bf16 v[96:99], v[36:39], a[200:207], v6
v_smfmac_f32_16x16x64_bf16 v[100:103], v[36:39], a[232:239], v6
s_branch mega_kernel_rf_pc_1_0
.p2align 5
mega_kernel_rf_pc_4_2f:
s_mov_b64 exec, vcc
buffer_load_dwordx4 v[40:43], v7, s[84:87], s29 offen offset:2048 sc1
s_mov_b64 exec, -1
s_branch mega_kernel_rf_pc_4_2
mega_kernel_rf_il40:
s_cbranch_execz mega_kernel_rf_il41
.p2align 5
mega_kernel_rf_pc_4_2:
s_waitcnt vmcnt(0)
v_cmp_eq_u32 vcc, -1, v40
s_cbranch_vccnz mega_kernel_rf_pc_4_2f
v_smfmac_f32_16x16x64_bf16 v[96:99], v[40:43], a[208:215], v6
v_smfmac_f32_16x16x64_bf16 v[100:103], v[40:43], a[240:247], v6
s_branch mega_kernel_rf_pc_d
.p2align 5
mega_kernel_rf_pc_5_0f:
s_mov_b64 exec, vcc
buffer_load_dwordx4 v[32:35], v7, s[84:87], s29 offen offset:0 sc1
s_mov_b64 exec, -1
s_branch mega_kernel_rf_pc_5_2
mega_kernel_rf_il41:
s_cbranch_execz mega_kernel_rf_il42
.p2align 5
mega_kernel_rf_pc_5_0:
s_waitcnt vmcnt(1)
v_cmp_eq_u32 vcc, -1, v32
s_cbranch_vccnz mega_kernel_rf_pc_5_0f
v_smfmac_f32_16x16x64_bf16 v[96:99], v[32:35], a[192:199], v6
v_smfmac_f32_16x16x64_bf16 v[100:103], v[32:35], a[224:231], v6
s_branch mega_kernel_rf_pc_4_2
.p2align 5
mega_kernel_rf_pc_5_2f:
s_mov_b64 exec, vcc
buffer_load_dwordx4 v[40:43], v7, s[84:87], s29 offen offset:2048 sc1
s_mov_b64 exec, -1
s_branch mega_kernel_rf_pc_5_0
mega_kernel_rf_il42:
s_cbranch_execz mega_kernel_rf_il43
.p2align 5
mega_kernel_rf_pc_5_2:
s_waitcnt vmcnt(1)
v_cmp_eq_u32 vcc, -1, v40
s_cbranch_vccnz mega_kernel_rf_pc_5_2f
v_smfmac_f32_16x16x64_bf16 v[96:99], v[40:43], a[208:215], v6
v_smfmac_f32_16x16x64_bf16 v[100:103], v[40:43], a[240:247], v6
s_branch mega_kernel_rf_pc_1_0
.p2align 5
mega_kernel_rf_pc_6_1f:
s_mov_b64 exec, vcc
buffer_load_dwordx4 v[36:39], v7, s[84:87], s29 offen offset:1024 sc1
s_mov_b64 exec, -1
s_branch mega_kernel_rf_pc_6_2
mega_kernel_rf_il43:
s_cbranch_execz mega_kernel_rf_il44
.p2align 5
mega_kernel_rf_pc_6_1:
s_waitcnt vmcnt(1)
v_cmp_eq_u32 vcc, -1, v36
s_cbranch_vccnz mega_kernel_rf_pc_6_1f
v_smfmac_f32_16x16x64_bf16 v[96:99], v[36:39], a[200:207], v6
v_smfmac_f32_16x16x64_bf16 v[100:103], v[36:39], a[232:239], v6
s_branch mega_kernel_rf_pc_4_2
.p2align 5
mega_kernel_rf_pc_6_2f:
s_mov_b64 exec, vcc
buffer_load_dwordx4 v[40:43], v7, s[84:87], s29 offen offset:2048 sc1
s_mov_b64 exec, -1
s_branch mega_kernel_rf_pc_6_1
mega_kernel_rf_il44:
s_cbranch_execz mega_kernel_rf_il45
.p2align 5
mega_kernel_rf_pc_6_2:
s_waitcnt vmcnt(1)
v_cmp_eq_u32 vcc, -1, v40
s_cbranch_vccnz mega_kernel_rf_pc_6_2f
v_smfmac_f32_16x16x64_bf16 v[96:99], v[40:43], a[208:215], v6
v_smfmac_f32_16x16x64_bf16 v[100:103], v[40:43], a[240:247], v6
s_branch mega_kernel_rf_pc_2_1
.p2align 5
mega_kernel_rf_pc_7_0f:
s_mov_b64 exec, vcc
buffer_load_dwordx4 v[32:35], v7, s[84:87], s29 offen offset:0 sc1
s_mov_b64 exec, -1
s_branch mega_kernel_rf_pc_7_1
mega_kernel_rf_il45:
s_cbranch_execz mega_kernel_rf_il46
.p2align 5
mega_kernel_rf_pc_7_0:
s_waitcnt vmcnt(2)
v_cmp_eq_u32 vcc, -1, v32
s_cbranch_vccnz mega_kernel_rf_pc_7_0f
v_smfmac_f32_16x16x64_bf16 v[96:99], v[32:35], a[192:199], v6
v_smfmac_f32_16x16x64_bf16 v[100:103], v[32:35], a[224:231], v6
s_branch mega_kernel_rf_pc_6_1
.p2align 5
mega_kernel_rf_pc_7_1f:
s_mov_b64 exec, vcc
buffer_load_dwordx4 v[36:39], v7, s[84:87], s29 offen offset:1024 sc1
s_mov_b64 exec, -1
s_branch mega_kernel_rf_pc_7_2
mega_kernel_rf_il46:
s_cbranch_execz mega_kernel_rf_il47
.p2align 5
mega_kernel_rf_pc_7_1:
s_waitcnt vmcnt(2)
v_cmp_eq_u32 vcc, -1, v36
s_cbranch_vccnz mega_kernel_rf_pc_7_1f
v_smfmac_f32_16x16x64_bf16 v[96:99], v[36:39], a[200:207], v6
v_smfmac_f32_16x16x64_bf16 v[100:103], v[36:39], a[232:239], v6
s_branch mega_kernel_rf_pc_5_2
.p2align 5
mega_kernel_rf_pc_7_2f:
s_mov_b64 exec, vcc
buffer_load_dwordx4 v[40:43], v7, s[84:87], s29 offen offset:2048 sc1
s_mov_b64 exec, -1
s_branch mega_kernel_rf_pc_7_0
mega_kernel_rf_il47:
s_cbranch_execz mega_kernel_rf_il48
.p2align 5
mega_kernel_rf_pc_7_2:
s_waitcnt vmcnt(2)
v_cmp_eq_u32 vcc, -1, v40
s_cbranch_vccnz mega_kernel_rf_pc_7_2f
v_smfmac_f32_16x16x64_bf16 v[96:99], v[40:43], a[208:215], v6
v_smfmac_f32_16x16x64_bf16 v[100:103], v[40:43], a[240:247], v6
s_branch mega_kernel_rf_pc_3_0
.p2align 5
mega_kernel_rf_pc_8_3f:
s_mov_b64 exec, vcc
buffer_load_dwordx4 v[44:47], v7, s[84:87], s29 offen offset:3072 sc1
s_mov_b64 exec, -1
s_branch mega_kernel_rf_pc_8_3
mega_kernel_rf_il48:
s_cbranch_execz mega_kernel_rf_il49
.p2align 5
mega_kernel_rf_pc_9_0f:
s_mov_b64 exec, vcc
buffer_load_dwordx4 v[32:35], v7, s[84:87], s29 offen offset:0 sc1
s_mov_b64 exec, -1
s_branch mega_kernel_rf_pc_9_3
.p2align 5
mega_kernel_rf_pc_9_0:
s_waitcnt vmcnt(1)
v_cmp_eq_u32 vcc, -1, v32
s_cbranch_vccnz mega_kernel_rf_pc_9_0f
v_smfmac_f32_16x16x64_bf16 v[96:99], v[32:35], a[192:199], v6
v_smfmac_f32_16x16x64_bf16 v[100:103], v[32:35], a[224:231], v6
s_branch mega_kernel_rf_pc_8_3
mega_kernel_rf_il49:
s_cbranch_execz mega_kernel_rf_il50
.p2align 5
mega_kernel_rf_pc_9_3f:
s_mov_b64 exec, vcc
buffer_load_dwordx4 v[44:47], v7, s[84:87], s29 offen offset:3072 sc1
s_mov_b64 exec, -1
s_branch mega_kernel_rf_pc_9_0
mega_kernel_rf_il50:
s_cbranch_execz mega_kernel_rf_il51
.p2align 5
mega_kernel_rf_pc_9_3:
s_waitcnt vmcnt(1)
v_cmp_eq_u32 vcc, -1, v44
s_cbranch_vccnz mega_kernel_rf_pc_9_3f
v_smfmac_f32_16x16x64_bf16 v[96:99], v[44:47], a[216:223], v6
v_smfmac_f32_16x16x64_bf16 v[100:103], v[44:47], a[248:255], v6
s_branch mega_kernel_rf_pc_1_0
.p2align 5
mega_kernel_rf_pc_10_1f:
s_mov_b64 exec, vcc
buffer_load_dwordx4 v[36:39], v7, s[84:87], s29 offen offset:1024 sc1
s_mov_b64 exec, -1
s_branch mega_kernel_rf_pc_10_3
mega_kernel_rf_il51:
s_cbranch_execz mega_kernel_rf_il52
.p2align 5
mega_kernel_rf_pc_10_1:
s_waitcnt vmcnt(1)
v_cmp_eq_u32 vcc, -1, v36
s_cbranch_vccnz mega_kernel_rf_pc_10_1f
v_smfmac_f32_16x16x64_bf16 v[96:99], v[36:39], a[200:207], v6
v_smfmac_f32_16x16x64_bf16 v[100:103], v[36:39], a[232:239], v6
s_branch mega_kernel_rf_pc_8_3
.p2align 5
mega_kernel_rf_pc_10_3f:
s_mov_b64 exec, vcc
buffer_load_dwordx4 v[44:47], v7, s[84:87], s29 offen offset:3072 sc1
s_mov_b64 exec, -1
s_branch mega_kernel_rf_pc_10_1
mega_kernel_rf_il52:
s_cbranch_execz mega_kernel_rf_il53
.p2align 5
mega_kernel_rf_pc_10_3:
s_waitcnt vmcnt(1)
v_cmp_eq_u32 vcc, -1, v44
s_cbranch_vccnz mega_kernel_rf_pc_10_3f
v_smfmac_f32_16x16x64_bf16 v[96:99], v[44:47], a[216:223], v6
v_smfmac_f32_16x16x64_bf16 v[100:103], v[44:47], a[248:255], v6
s_branch mega_kernel_rf_pc_2_1
.p2align 5
mega_kernel_rf_pc_11_0f:
s_mov_b64 exec, vcc
buffer_load_dwordx4 v[32:35], v7, s[84:87], s29 offen offset:0 sc1
s_mov_b64 exec, -1
s_branch mega_kernel_rf_pc_11_1
mega_kernel_rf_il53:
s_cbranch_execz mega_kernel_rf_il54
.p2align 5
mega_kernel_rf_pc_11_0:
s_waitcnt vmcnt(2)
v_cmp_eq_u32 vcc, -1, v32
s_cbranch_vccnz mega_kernel_rf_pc_11_0f
v_smfmac_f32_16x16x64_bf16 v[96:99], v[32:35], a[192:199], v6
v_smfmac_f32_16x16x64_bf16 v[100:103], v[32:35], a[224:231], v6
s_branch mega_kernel_rf_pc_10_1
.p2align 5
mega_kernel_rf_pc_11_1f:
s_mov_b64 exec, vcc
buffer_load_dwordx4 v[36:39], v7, s[84:87], s29 offen offset:1024 sc1
s_mov_b64 exec, -1
s_branch mega_kernel_rf_pc_11_3
mega_kernel_rf_il54:
s_cbranch_execz mega_kernel_rf_il55
.p2align 5
mega_kernel_rf_pc_11_1:
s_waitcnt vmcnt(2)
v_cmp_eq_u32 vcc, -1, v36
s_cbranch_vccnz mega_kernel_rf_pc_11_1f
v_smfmac_f32_16x16x64_bf16 v[96:99], v[36:39], a[200:207], v6
v_smfmac_f32_16x16x64_bf16 v[100:103], v[36:39], a[232:239], v6
s_branch mega_kernel_rf_pc_9_3
.p2align 5
mega_kernel_rf_pc_11_3f:
s_mov_b64 exec, vcc
buffer_load_dwordx4 v[44:47], v7, s[84:87], s29 offen offset:3072 sc1
s_mov_b64 exec, -1
s_branch mega_kernel_rf_pc_11_0
mega_kernel_rf_il55:
s_cbranch_execz mega_kernel_rf_il56
.p2align 5
mega_kernel_rf_pc_11_3:
s_waitcnt vmcnt(2)
v_cmp_eq_u32 vcc, -1, v44
s_cbranch_vccnz mega_kernel_rf_pc_11_3f
v_smfmac_f32_16x16x64_bf16 v[96:99], v[44:47], a[216:223], v6
v_smfmac_f32_16x16x64_bf16 v[100:103], v[44:47], a[248:255], v6
s_branch mega_kernel_rf_pc_3_0
.p2align 5
mega_kernel_rf_pc_12_2f:
s_mov_b64 exec, vcc
buffer_load_dwordx4 v[40:43], v7, s[84:87], s29 offen offset:2048 sc1
s_mov_b64 exec, -1
s_branch mega_kernel_rf_pc_12_3
mega_kernel_rf_il56:
s_cbranch_execz mega_kernel_rf_iwd
.p2align 5
mega_kernel_rf_pc_12_3f:
s_mov_b64 exec, vcc
buffer_load_dwordx4 v[44:47], v7, s[84:87], s29 offen offset:3072 sc1
s_mov_b64 exec, -1
s_branch mega_kernel_rf_pc_12_2
.p2align 5
mega_kernel_rf_pc_12_3:
s_waitcnt vmcnt(1)
v_cmp_eq_u32 vcc, -1, v44
s_cbranch_vccnz mega_kernel_rf_pc_12_3f
v_smfmac_f32_16x16x64_bf16 v[96:99], v[44:47], a[216:223], v6
v_smfmac_f32_16x16x64_bf16 v[100:103], v[44:47], a[248:255], v6
s_branch mega_kernel_rf_pc_4_2
mega_kernel_rf_iw3:
mega_kernel_rf_il57:
s_cbranch_execz mega_kernel_rf_il58
.p2align 5
mega_kernel_rf_pc_13_0f:
s_mov_b64 exec, vcc
buffer_load_dwordx4 v[32:35], v7, s[84:87], s29 offen offset:0 sc1
s_mov_b64 exec, -1
s_branch mega_kernel_rf_pc_13_2
mega_kernel_rf_il58:
s_cbranch_execz mega_kernel_rf_il59
.p2align 5
mega_kernel_rf_pc_13_0:
s_waitcnt vmcnt(2)
v_cmp_eq_u32 vcc, -1, v32
s_cbranch_vccnz mega_kernel_rf_pc_13_0f
v_smfmac_f32_16x16x64_bf16 v[96:99], v[32:35], a[192:199], v6
v_smfmac_f32_16x16x64_bf16 v[100:103], v[32:35], a[224:231], v6
s_branch mega_kernel_rf_pc_12_2
.p2align 5
mega_kernel_rf_pc_13_2f:
s_mov_b64 exec, vcc
buffer_load_dwordx4 v[40:43], v7, s[84:87], s29 offen offset:2048 sc1
s_mov_b64 exec, -1
s_branch mega_kernel_rf_pc_13_3
mega_kernel_rf_il59:
s_cbranch_execz mega_kernel_rf_il60
.p2align 5
mega_kernel_rf_pc_13_2:
s_waitcnt vmcnt(2)
v_cmp_eq_u32 vcc, -1, v40
s_cbranch_vccnz mega_kernel_rf_pc_13_2f
v_smfmac_f32_16x16x64_bf16 v[96:99], v[40:43], a[208:215], v6
v_smfmac_f32_16x16x64_bf16 v[100:103], v[40:43], a[240:247], v6
s_branch mega_kernel_rf_pc_9_3
.p2align 5
mega_kernel_rf_pc_13_3f:
s_mov_b64 exec, vcc
buffer_load_dwordx4 v[44:47], v7, s[84:87], s29 offen offset:3072 sc1
s_mov_b64 exec, -1
s_branch mega_kernel_rf_pc_13_0
mega_kernel_rf_il60:
s_cbranch_execz mega_kernel_rf_il61
.p2align 5
mega_kernel_rf_pc_13_3:
s_waitcnt vmcnt(2)
v_cmp_eq_u32 vcc, -1, v44
s_cbranch_vccnz mega_kernel_rf_pc_13_3f
v_smfmac_f32_16x16x64_bf16 v[96:99], v[44:47], a[216:223], v6
v_smfmac_f32_16x16x64_bf16 v[100:103], v[44:47], a[248:255], v6
s_branch mega_kernel_rf_pc_5_0
.p2align 5
mega_kernel_rf_pc_14_1f:
s_mov_b64 exec, vcc
buffer_load_dwordx4 v[36:39], v7, s[84:87], s29 offen offset:1024 sc1
s_mov_b64 exec, -1
s_branch mega_kernel_rf_pc_14_2
mega_kernel_rf_il61:
s_cbranch_execz mega_kernel_rf_il62
.p2align 5
mega_kernel_rf_pc_14_2f:
s_mov_b64 exec, vcc
buffer_load_dwordx4 v[40:43], v7, s[84:87], s29 offen offset:2048 sc1
s_mov_b64 exec, -1
s_branch mega_kernel_rf_pc_14_3
.p2align 5
mega_kernel_rf_pc_14_2:
s_waitcnt vmcnt(2)
v_cmp_eq_u32 vcc, -1, v40
s_cbranch_vccnz mega_kernel_rf_pc_14_2f
v_smfmac_f32_16x16x64_bf16 v[96:99], v[40:43], a[208:215], v6
v_smfmac_f32_16x16x64_bf16 v[100:103], v[40:43], a[240:247], v6
s_branch mega_kernel_rf_pc_10_3
mega_kernel_rf_il62:
s_cbranch_execz mega_kernel_rf_il63
.p2align 5
mega_kernel_rf_pc_14_3f:
s_mov_b64 exec, vcc
buffer_load_dwordx4 v[44:47], v7, s[84:87], s29 offen offset:3072 sc1
s_mov_b64 exec, -1
s_branch mega_kernel_rf_pc_14_1
mega_kernel_rf_il63:
s_cbranch_execz mega_kernel_rf_il64
.p2align 5
mega_kernel_rf_pc_14_3:
s_waitcnt vmcnt(2)
v_cmp_eq_u32 vcc, -1, v44
s_cbranch_vccnz mega_kernel_rf_pc_14_3f
v_smfmac_f32_16x16x64_bf16 v[96:99], v[44:47], a[216:223], v6
v_smfmac_f32_16x16x64_bf16 v[100:103], v[44:47], a[248:255], v6
s_branch mega_kernel_rf_pc_6_1
.p2align 5
mega_kernel_rf_pc_15_0f:
s_mov_b64 exec, vcc
buffer_load_dwordx4 v[32:35], v7, s[84:87], s29 offen offset:0 sc1
s_mov_b64 exec, -1
s_branch mega_kernel_rf_pc_15_1
mega_kernel_rf_il64:
s_cbranch_execz mega_kernel_rf_il65
.p2align 5
mega_kernel_rf_pc_15_1f:
s_mov_b64 exec, vcc
buffer_load_dwordx4 v[36:39], v7, s[84:87], s29 offen offset:1024 sc1
s_mov_b64 exec, -1
s_branch mega_kernel_rf_pc_15_2
.p2align 5
mega_kernel_rf_pc_15_1:
s_waitcnt vmcnt(3)
v_cmp_eq_u32 vcc, -1, v36
s_cbranch_vccnz mega_kernel_rf_pc_15_1f
v_smfmac_f32_16x16x64_bf16 v[96:99], v[36:39], a[200:207], v6
v_smfmac_f32_16x16x64_bf16 v[100:103], v[36:39], a[232:239], v6
s_branch mega_kernel_rf_pc_13_2
mega_kernel_rf_il65:
s_cbranch_execz mega_kernel_rf_il66
.p2align 5
mega_kernel_rf_pc_15_2f:
s_mov_b64 exec, vcc
buffer_load_dwordx4 v[40:43], v7, s[84:87], s29 offen offset:2048 sc1
s_mov_b64 exec, -1
s_branch mega_kernel_rf_pc_15_3
mega_kernel_rf_il66:
s_cbranch_execz mega_kernel_rf_il67
.p2align 5
mega_kernel_rf_pc_15_2:
s_waitcnt vmcnt(3)
v_cmp_eq_u32 vcc, -1, v40
s_cbranch_vccnz mega_kernel_rf_pc_15_2f
v_smfmac_f32_16x16x64_bf16 v[96:99], v[40:43], a[208:215], v6
v_smfmac_f32_16x16x64_bf16 v[100:103], v[40:43], a[240:247], v6
s_branch mega_kernel_rf_pc_11_3
.p2align 5
mega_kernel_rf_pc_15_3f:
s_mov_b64 exec, vcc
buffer_load_dwordx4 v[44:47], v7, s[84:87], s29 offen offset:3072 sc1
s_mov_b64 exec, -1
s_branch mega_kernel_rf_pc_15_0
mega_kernel_rf_il67:
s_cbranch_execz mega_kernel_rf_il68
.p2align 5
mega_kernel_rf_pc_15_3:
s_waitcnt vmcnt(3)
v_cmp_eq_u32 vcc, -1, v44
s_cbranch_vccnz mega_kernel_rf_pc_15_3f
v_smfmac_f32_16x16x64_bf16 v[96:99], v[44:47], a[216:223], v6
v_smfmac_f32_16x16x64_bf16 v[100:103], v[44:47], a[248:255], v6
s_branch mega_kernel_rf_pc_7_0
mega_kernel_rf_w0last:
s_nop 7
v_permlane32_swap_b32 v112, v116
v_permlane32_swap_b32 v113, v117
v_permlane32_swap_b32 v114, v118
v_permlane32_swap_b32 v115, v119
v_pk_add_f32 v[112:113], v[112:113], v[116:117]
v_pk_add_f32 v[114:115], v[114:115], v[118:119]
ds_write_b128 v20, v[112:115]
s_waitcnt lgkmcnt(0)
s_barrier
s_branch mega_kernel_rf_end
mega_kernel_rf_il68:
s_cbranch_execz mega_kernel_rf_il69
mega_kernel_rf_side:
s_cmp_eq_u32 s24, 3
s_cbranch_scc1 mega_kernel_rf_sd3
s_cmp_eq_u32 s24, 2
s_cbranch_scc0 mega_kernel_rf_sd4
s_mov_b64 exec, s[40:41]
buffer_store_dwordx4 v[28:31], v11, s[84:87], s34 offen
s_mov_b64 exec, -1
buffer_store_dwordx2 v[28:29], v9, s[84:87], s34 offen
s_mul_i32 s28, s31, 2048
s_add_u32 s28, s28, s34
s_add_u32 s28, s28, 49152
buffer_store_dwordx4 v[28:31], v17, s[84:87], s28 offen
buffer_store_dwordx4 v[28:31], v10, s[84:87], s28 offen
s_branch mega_kernel_rf_sd4
mega_kernel_rf_il69:
s_cbranch_execz mega_kernel_rf_il70
mega_kernel_rf_sd3:
v_readlane_b32 s76, v249, 0
v_readlane_b32 s77, v249, 1
s_min_i32 s76, s76, s77
s_max_i32 s46, s46, s76
s_mov_b32 s36, 0
s_add_u32 s76, s27, 1
s_cmp_lt_u32 s76, 63
s_cbranch_scc0 mega_kernel_rf_sd4
s_cmp_ge_u32 s76, 0
s_cbranch_scc0 mega_kernel_rf_sd4
s_cmp_gt_i32 s46, s76
s_cselect_b32 s36, 0, 1
s_cbranch_scc0 mega_kernel_rf_sd4
s_add_u32 s77, s76, s82
s_bfe_u32 s28, s77, 0x40002
s_lshl_b32 s28, s28, 14
s_and_b32 s77, s77, 3
s_lshl_b32 s77, s77, 11
s_add_u32 s28, s28, s77
s_add_u32 m0, s45, 0
s_nop 0
buffer_load_dwordx4 v240, s[84:87], s28 offen offset:0 sc1 lds
s_add_u32 m0, s45, 0
s_nop 0
buffer_load_dwordx4 v240, s[84:87], s28 offen offset:1024 sc1 lds
s_add_u32 m0, s45, 2048
s_nop 0
buffer_load_dwordx4 v241, s[84:87], s28 offen offset:0 sc1 lds
s_add_u32 m0, s45, 2048
s_nop 0
buffer_load_dwordx4 v241, s[84:87], s28 offen offset:1024 sc1 lds
s_add_u32 s45, s45, 4096
s_cmp_eq_u32 s45, 30720
s_cselect_b32 s45, 18432, s45
mega_kernel_rf_sd4:
v_smfmac_f32_16x16x64_bf16 v[112:115], v[40:43], a[144:151], v6
v_smfmac_f32_16x16x64_bf16 v[116:119], v[40:43], a[176:183], v6
v_smfmac_f32_16x16x64_bf16 v[112:115], v[44:47], a[152:159], v6
v_smfmac_f32_16x16x64_bf16 v[116:119], v[44:47], a[184:191], v6
s_nop 7
v_permlane32_swap_b32 v112, v116
v_permlane32_swap_b32 v113, v117
v_permlane32_swap_b32 v114, v118
v_permlane32_swap_b32 v115, v119
v_pk_add_f32 v[112:113], v[112:113], v[116:117]
v_pk_add_f32 v[114:115], v[114:115], v[118:119]
ds_write_b128 v20, v[112:115]
v_mov_b32 v96, 0
v_mov_b32 v97, 0
v_mov_b32 v98, 0
v_mov_b32 v99, 0
v_mov_b32 v100, 0
v_mov_b32 v101, 0
v_mov_b32 v102, 0
v_mov_b32 v103, 0
s_cmp_eq_u32 s24, 1
s_cbranch_scc0 mega_kernel_rf_s1
s_waitcnt lgkmcnt(0)
ds_read_b128 v[120:123], v16 offset:0
ds_read_b128 v[124:127], v16 offset:16
ds_read_b128 v[128:131], v16 offset:2304
ds_read_b128 v[132:135], v16 offset:2320
ds_read_b128 v[136:139], v16 offset:4608
ds_read_b128 v[140:143], v16 offset:4624
ds_read_b128 v[144:147], v16 offset:6912
ds_read_b128 v[148:151], v16 offset:6928
s_waitcnt lgkmcnt(4)
v_pk_add_f32 v[120:121], v[120:121], v[128:129]
v_pk_add_f32 v[122:123], v[122:123], v[130:131]
v_pk_add_f32 v[124:125], v[124:125], v[132:133]
v_pk_add_f32 v[126:127], v[126:127], v[134:135]
s_waitcnt lgkmcnt(0)
v_pk_add_f32 v[136:137], v[136:137], v[144:145]
v_pk_add_f32 v[138:139], v[138:139], v[146:147]
v_pk_add_f32 v[140:141], v[140:141], v[148:149]
v_pk_add_f32 v[142:143], v[142:143], v[150:151]
v_pk_add_f32 v[120:121], v[120:121], v[136:137]
v_pk_add_f32 v[122:123], v[122:123], v[138:139]
v_pk_add_f32 v[124:125], v[124:125], v[140:141]
v_pk_add_f32 v[126:127], v[126:127], v[142:143]
v_cvt_pk_bf16_f32 v244, v120, v121
v_cvt_pk_bf16_f32 v245, v122, v123
v_cvt_pk_bf16_f32 v246, v124, v125
v_cvt_pk_bf16_f32 v247, v126, v127
mega_kernel_rf_s1:
v_add_u32 v5, 9216, v17
s_waitcnt lgkmcnt(0)
s_barrier
s_cmp_eq_u32 s24, 2
s_cbranch_scc1 mega_kernel_rf_s2
s_cmp_eq_u32 s24, 3
s_cbranch_scc0 mega_kernel_rf_s3
s_add_u32 s76, s27, 2
s_cmp_lt_u32 s76, 63
s_cbranch_scc0 mega_kernel_rf_s3
s_cmp_gt_i32 s46, s76
s_cbranch_scc0 mega_kernel_rf_s3
s_add_u32 s77, s76, s82
s_bfe_u32 s28, s77, 0x40002
s_lshl_b32 s28, s28, 14
s_and_b32 s77, s77, 3
s_lshl_b32 s77, s77, 11
s_add_u32 s28, s28, s77
s_add_u32 s28, s28, s83
s_buffer_load_dword s78, s[84:87], s28 offset:0
s_buffer_load_dword s78, s[84:87], s28 offset:128
s_buffer_load_dword s78, s[84:87], s28 offset:256
s_buffer_load_dword s78, s[84:87], s28 offset:384
s_buffer_load_dword s78, s[84:87], s28 offset:512
s_buffer_load_dword s78, s[84:87], s28 offset:640
s_buffer_load_dword s78, s[84:87], s28 offset:768
s_buffer_load_dword s78, s[84:87], s28 offset:896
s_buffer_load_dword s78, s[84:87], s28 offset:1024
s_buffer_load_dword s78, s[84:87], s28 offset:1152
s_buffer_load_dword s78, s[84:87], s28 offset:1280
s_buffer_load_dword s78, s[84:87], s28 offset:1408
s_buffer_load_dword s78, s[84:87], s28 offset:1536
s_buffer_load_dword s78, s[84:87], s28 offset:1664
s_buffer_load_dword s78, s[84:87], s28 offset:1792
s_buffer_load_dword s78, s[84:87], s28 offset:1920
s_mov_b32 s88, s76
s_branch mega_kernel_rf_s3
mega_kernel_rf_il70:
s_cbranch_execz mega_kernel_rf_il71
mega_kernel_rf_s2:
ds_read_b128 v[120:123], v5 offset:0
ds_read_b128 v[124:127], v5 offset:1024
ds_read_b128 v[128:131], v5 offset:2048
ds_read_b128 v[132:135], v5 offset:3072
v_lshrrev_b32 v5, 1, v17
s_waitcnt lgkmcnt(2)
v_pk_add_f32 v[120:121], v[120:121], v[124:125]
v_pk_add_f32 v[122:123], v[122:123], v[126:127]
s_waitcnt lgkmcnt(0)
v_pk_add_f32 v[128:129], v[128:129], v[132:133]
v_pk_add_f32 v[130:131], v[130:131], v[134:135]
v_pk_add_f32 v[120:121], v[120:121], v[128:129]
v_pk_add_f32 v[122:123], v[122:123], v[130:131]
v_cvt_pk_bf16_f32 v244, v120, v121
v_cvt_pk_bf16_f32 v245, v122, v123
ds_write_b64 v5, v[244:245] offset:17920
s_waitcnt lgkmcnt(0) vmcnt(0)
mega_kernel_rf_s3:
s_cmp_eq_u32 s27, 63
s_cbranch_scc1 mega_kernel_rf_slast
s_add_u32 s29, s33, 24576
s_barrier
s_cmp_eq_u32 s24, 3
s_cbranch_scc1 mega_kernel_rf_y3
s_add_u32 s77, s27, s82
s_bfe_u32 s28, s77, 0x30003
s_lshl_b32 s28, s28, 14
s_and_b32 s77, s77, 7
s_lshl_b32 s77, s77, 10
s_add_u32 s28, s28, s77
s_add_u32 s28, s28, s79
s_cmp_eq_u32 s24, 2
s_cbranch_scc1 mega_kernel_rf_kv2a
s_mov_b64 exec, s[48:49]
buffer_store_dwordx4 v[244:247], v22, s[84:87], s28 offen sc1
s_mov_b64 exec, -1
s_branch mega_kernel_rf_kvda
mega_kernel_rf_il71:
s_cbranch_execz mega_kernel_rf_il72
mega_kernel_rf_kv2a:
v_lshlrev_b32 v4, 3, v1
buffer_store_dwordx2 v[244:245], v4, s[84:87], s28 offen offset:512 sc1
mega_kernel_rf_kvda:
s_branch mega_kernel_rf_y4
mega_kernel_rf_y3:
s_add_u32 s76, s27, 2
s_cmp_lt_u32 s76, 63
s_cbranch_scc0 mega_kernel_rf_y4
mega_kernel_rf_y4:
s_branch mega_kernel_rf_b3
mega_kernel_rf_first:
v_add_u32 v5, s44, v17
ds_read_b128 v[156:159], v5 offset:0
ds_read_b128 v[160:163], v5 offset:1024
ds_read_b128 v[164:167], v5 offset:2048
ds_read_b128 v[168:171], v5 offset:3072
s_branch mega_kernel_rf_adone
mega_kernel_rf_il72:
s_cbranch_execz mega_kernel_rf_il73
mega_kernel_rf_slast:
s_cmp_eq_u32 s24, 3
s_cbranch_scc1 mega_kernel_rf_end
s_add_u32 s77, s27, s82
s_bfe_u32 s28, s77, 0x30003
s_lshl_b32 s28, s28, 14
s_and_b32 s77, s77, 7
s_lshl_b32 s77, s77, 10
s_add_u32 s28, s28, s77
s_add_u32 s28, s28, s79
s_cmp_eq_u32 s24, 2
s_cbranch_scc1 mega_kernel_rf_kv2b
s_mov_b64 exec, s[48:49]
buffer_store_dwordx4 v[244:247], v22, s[84:87], s28 offen sc1
s_mov_b64 exec, -1
s_branch mega_kernel_rf_kvdb
mega_kernel_rf_il73:
s_cbranch_execz mega_kernel_rf_iwd
mega_kernel_rf_kv2b:
v_lshlrev_b32 v4, 3, v1
buffer_store_dwordx2 v[244:245], v4, s[84:87], s28 offen offset:512 sc1
mega_kernel_rf_kvdb:
s_waitcnt vmcnt(0)
s_barrier
s_mov_b32 s76, 64
s_cmp_eq_u32 s24, 1
s_cbranch_scc0 mega_kernel_rf_end
v_mov_b32 v5, s76
s_mov_b64 exec, 1
buffer_store_dword v5, v228, s[84:87], s81 offen sc1
s_mov_b64 exec, -1
mega_kernel_rf_end:
s_endpgm
mega_kernel_recs:
s_load_dwordx2 s[20:21], s[0:1], 8
s_load_dwordx2 s[16:17], s[0:1], 40
s_load_dwordx2 s[4:5], s[0:1], 16
s_load_dwordx2 s[8:9], s[0:1], 24
s_load_dwordx2 s[12:13], s[0:1], 32
v_lshrrev_b32 v4, 6, v0
v_and_b32 v1, 63, v0
v_readfirstlane_b32 s24, v4
v_lshrrev_b32 v2, 4, v1
v_and_b32 v3, 15, v1
v_lshlrev_b32 v17, 4, v1
s_lshr_b32 s28, s31, 2
s_lshl_b32 s25, s30, 3
s_add_u32 s25, s25, s28
s_and_b32 s26, s31, 3
s_waitcnt lgkmcnt(0)
s_mov_b32 s22, 16384
s_mov_b32 s23, 0x00020000
s_mov_b32 s18, 8388608
s_mov_b32 s19, 0x00020000
s_mov_b32 s6, 8388608
s_mov_b32 s7, 0x00020000
s_mov_b32 s10, 8388608
s_mov_b32 s11, 0x00020000
s_mov_b32 s14, 8388608
s_mov_b32 s15, 0x00020000
s_lshl_b32 s28, s25, 8
s_lshr_b32 s29, s26, 0
s_lshl_b32 s29, s29, 6
s_add_u32 s28, s28, s29
s_lshl_b32 s29, s24, 21
s_add_u32 s28, s28, s29
v_lshrrev_b32 v4, 2, v1
v_and_b32 v5, 3, v1
v_lshlrev_b32 v40, 13, v4
v_lshl_add_u32 v40, v5, 4, v40
v_add_u32 v40, s28, v40
s_lshl_b32 s28, s30, 21
s_lshl_b32 s29, s24, 19
s_add_u32 s28, s28, s29
s_lshr_b32 s29, s31, 0
s_lshl_b32 s29, s29, 6
s_add_u32 s28, s28, s29
v_lshlrev_b32 v41, 11, v4
v_lshl_add_u32 v41, v5, 4, v41
v_add_u32 v41, s28, v41
s_lshl_b32 s47, s24, 15
s_add_u32 s47, s47, 32768
s_lshl_b32 s28, s31, 18
s_lshl_b32 s29, s24, 16
s_add_u32 s28, s28, s29
s_lshl_b32 s29, s30, 11
s_add_u32 s28, s28, s29
v_lshlrev_b32 v48, 13, v2
v_lshl_add_u32 v48, v3, 7, v48
v_add_u32 v48, s28, v48
s_lshl_b32 s28, s30, 21
s_lshl_b32 s29, s31, 16
s_add_u32 s28, s28, s29
s_lshl_b32 s29, s24, 14
s_add_u32 s28, s28, s29
v_lshlrev_b32 v49, 7, v1
v_add_u32 v49, s28, v49
s_and_b32 s76, s31, 1
s_mul_i32 s76, s76, 8
s_and_b32 s28, s31, 15
s_lshl_b32 s28, s28, 4
s_lshl_b32 s29, s24, 8
s_add_u32 s28, s28, s29
v_add_u32 v53, s28, v3
s_lshr_b32 s28, s31, 4
s_lshl_b32 s28, s28, 10
s_add_u32 s28, s28, 384
v_mov_b32 v54, s28
v_mov_b32 v55, 1920
v_cmp_gt_u32 vcc, 32, v1
s_nop 1
v_cndmask_b32 v54, v55, v54, vcc
s_lshl_b32 s29, s30, 11
v_lshl_add_u32 v51, v53, 13, v54
v_add_u32 v51, s29, v51
s_lshl_b32 s29, s30, 21
v_lshl_add_u32 v52, v53, 11, v54
v_add_u32 v52, s29, v52
buffer_load_dword v50, v51, s[8:11], 0 offen
s_xor_b32 s29, s76, 0
s_lshl_b32 s28, s29, 10
s_add_u32 s28, s28, s47
s_add_u32 m0, s28, 0
s_lshl_b32 s29, s29, 17
buffer_load_dwordx4 v40, s[8:11], s29 offen lds
s_xor_b32 s29, s76, 1
s_lshl_b32 s28, s29, 10
s_add_u32 s28, s28, s47
s_add_u32 m0, s28, 0
s_lshl_b32 s29, s29, 17
buffer_load_dwordx4 v40, s[8:11], s29 offen lds
s_xor_b32 s29, s76, 2
s_lshl_b32 s28, s29, 10
s_add_u32 s28, s28, s47
s_add_u32 m0, s28, 0
s_lshl_b32 s29, s29, 17
buffer_load_dwordx4 v40, s[8:11], s29 offen lds
s_xor_b32 s29, s76, 3
s_lshl_b32 s28, s29, 10
s_add_u32 s28, s28, s47
s_add_u32 m0, s28, 0
s_lshl_b32 s29, s29, 17
buffer_load_dwordx4 v40, s[8:11], s29 offen lds
s_xor_b32 s29, s76, 4
s_lshl_b32 s28, s29, 10
s_add_u32 s28, s28, s47
s_add_u32 m0, s28, 0
s_lshl_b32 s29, s29, 17
buffer_load_dwordx4 v40, s[8:11], s29 offen lds
s_xor_b32 s29, s76, 5
s_lshl_b32 s28, s29, 10
s_add_u32 s28, s28, s47
s_add_u32 m0, s28, 0
s_lshl_b32 s29, s29, 17
buffer_load_dwordx4 v40, s[8:11], s29 offen lds
s_xor_b32 s29, s76, 6
s_lshl_b32 s28, s29, 10
s_add_u32 s28, s28, s47
s_add_u32 m0, s28, 0
s_lshl_b32 s29, s29, 17
buffer_load_dwordx4 v40, s[8:11], s29 offen lds
s_xor_b32 s29, s76, 7
s_lshl_b32 s28, s29, 10
s_add_u32 s28, s28, s47
s_add_u32 m0, s28, 0
s_lshl_b32 s29, s29, 17
buffer_load_dwordx4 v40, s[8:11], s29 offen lds
s_xor_b32 s29, s76, 8
s_lshl_b32 s28, s29, 10
s_add_u32 s28, s28, s47
s_add_u32 m0, s28, 0
s_lshl_b32 s29, s29, 17
buffer_load_dwordx4 v40, s[8:11], s29 offen lds
s_xor_b32 s29, s76, 9
s_lshl_b32 s28, s29, 10
s_add_u32 s28, s28, s47
s_add_u32 m0, s28, 0
s_lshl_b32 s29, s29, 17
buffer_load_dwordx4 v40, s[8:11], s29 offen lds
s_xor_b32 s29, s76, 10
s_lshl_b32 s28, s29, 10
s_add_u32 s28, s28, s47
s_add_u32 m0, s28, 0
s_lshl_b32 s29, s29, 17
buffer_load_dwordx4 v40, s[8:11], s29 offen lds
s_xor_b32 s29, s76, 11
s_lshl_b32 s28, s29, 10
s_add_u32 s28, s28, s47
s_add_u32 m0, s28, 0
s_lshl_b32 s29, s29, 17
buffer_load_dwordx4 v40, s[8:11], s29 offen lds
s_xor_b32 s29, s76, 12
s_lshl_b32 s28, s29, 10
s_add_u32 s28, s28, s47
s_add_u32 m0, s28, 0
s_lshl_b32 s29, s29, 17
buffer_load_dwordx4 v40, s[8:11], s29 offen lds
s_xor_b32 s29, s76, 13
s_lshl_b32 s28, s29, 10
s_add_u32 s28, s28, s47
s_add_u32 m0, s28, 0
s_lshl_b32 s29, s29, 17
buffer_load_dwordx4 v40, s[8:11], s29 offen lds
s_xor_b32 s29, s76, 14
s_lshl_b32 s28, s29, 10
s_add_u32 s28, s28, s47
s_add_u32 m0, s28, 0
s_lshl_b32 s29, s29, 17
buffer_load_dwordx4 v40, s[8:11], s29 offen lds
s_xor_b32 s29, s76, 15
s_lshl_b32 s28, s29, 10
s_add_u32 s28, s28, s47
s_add_u32 m0, s28, 0
s_lshl_b32 s29, s29, 17
buffer_load_dwordx4 v40, s[8:11], s29 offen lds
buffer_load_dword v50, v51, s[12:15], 0 offen
s_xor_b32 s29, s76, 0
s_lshl_b32 s28, s29, 10
s_add_u32 s28, s28, s47
s_add_u32 m0, s28, 16384
s_lshl_b32 s29, s29, 17
buffer_load_dwordx4 v40, s[12:15], s29 offen lds
s_xor_b32 s29, s76, 1
s_lshl_b32 s28, s29, 10
s_add_u32 s28, s28, s47
s_add_u32 m0, s28, 16384
s_lshl_b32 s29, s29, 17
buffer_load_dwordx4 v40, s[12:15], s29 offen lds
s_xor_b32 s29, s76, 2
s_lshl_b32 s28, s29, 10
s_add_u32 s28, s28, s47
s_add_u32 m0, s28, 16384
s_lshl_b32 s29, s29, 17
buffer_load_dwordx4 v40, s[12:15], s29 offen lds
s_xor_b32 s29, s76, 3
s_lshl_b32 s28, s29, 10
s_add_u32 s28, s28, s47
s_add_u32 m0, s28, 16384
s_lshl_b32 s29, s29, 17
buffer_load_dwordx4 v40, s[12:15], s29 offen lds
s_xor_b32 s29, s76, 4
s_lshl_b32 s28, s29, 10
s_add_u32 s28, s28, s47
s_add_u32 m0, s28, 16384
s_lshl_b32 s29, s29, 17
buffer_load_dwordx4 v40, s[12:15], s29 offen lds
s_xor_b32 s29, s76, 5
s_lshl_b32 s28, s29, 10
s_add_u32 s28, s28, s47
s_add_u32 m0, s28, 16384
s_lshl_b32 s29, s29, 17
buffer_load_dwordx4 v40, s[12:15], s29 offen lds
s_xor_b32 s29, s76, 6
s_lshl_b32 s28, s29, 10
s_add_u32 s28, s28, s47
s_add_u32 m0, s28, 16384
s_lshl_b32 s29, s29, 17
buffer_load_dwordx4 v40, s[12:15], s29 offen lds
s_xor_b32 s29, s76, 7
s_lshl_b32 s28, s29, 10
s_add_u32 s28, s28, s47
s_add_u32 m0, s28, 16384
s_lshl_b32 s29, s29, 17
buffer_load_dwordx4 v40, s[12:15], s29 offen lds
s_xor_b32 s29, s76, 8
s_lshl_b32 s28, s29, 10
s_add_u32 s28, s28, s47
s_add_u32 m0, s28, 16384
s_lshl_b32 s29, s29, 17
buffer_load_dwordx4 v40, s[12:15], s29 offen lds
s_xor_b32 s29, s76, 9
s_lshl_b32 s28, s29, 10
s_add_u32 s28, s28, s47
s_add_u32 m0, s28, 16384
s_lshl_b32 s29, s29, 17
buffer_load_dwordx4 v40, s[12:15], s29 offen lds
s_xor_b32 s29, s76, 10
s_lshl_b32 s28, s29, 10
s_add_u32 s28, s28, s47
s_add_u32 m0, s28, 16384
s_lshl_b32 s29, s29, 17
buffer_load_dwordx4 v40, s[12:15], s29 offen lds
s_xor_b32 s29, s76, 11
s_lshl_b32 s28, s29, 10
s_add_u32 s28, s28, s47
s_add_u32 m0, s28, 16384
s_lshl_b32 s29, s29, 17
buffer_load_dwordx4 v40, s[12:15], s29 offen lds
s_xor_b32 s29, s76, 12
s_lshl_b32 s28, s29, 10
s_add_u32 s28, s28, s47
s_add_u32 m0, s28, 16384
s_lshl_b32 s29, s29, 17
buffer_load_dwordx4 v40, s[12:15], s29 offen lds
s_xor_b32 s29, s76, 13
s_lshl_b32 s28, s29, 10
s_add_u32 s28, s28, s47
s_add_u32 m0, s28, 16384
s_lshl_b32 s29, s29, 17
buffer_load_dwordx4 v40, s[12:15], s29 offen lds
s_xor_b32 s29, s76, 14
s_lshl_b32 s28, s29, 10
s_add_u32 s28, s28, s47
s_add_u32 m0, s28, 16384
s_lshl_b32 s29, s29, 17
buffer_load_dwordx4 v40, s[12:15], s29 offen lds
s_xor_b32 s29, s76, 15
s_lshl_b32 s28, s29, 10
s_add_u32 s28, s28, s47
s_add_u32 m0, s28, 16384
s_lshl_b32 s29, s29, 17
buffer_load_dwordx4 v40, s[12:15], s29 offen lds
s_mov_b32 s40, 0x00ff00ff
s_mov_b32 s41, 0x00ff00ff
s_mov_b32 s48, 0xff00ff00
s_mov_b32 s49, 0xff00ff00
s_mov_b32 s42, 0
s_mov_b32 s43, 0x00ff00ff
s_mov_b32 s32, 0x3e0293ee
v_mov_b32 v23, 0xff800000
v_mov_b32 v6, 0x4444
v_mov_b32 v4, 0xeeee
v_cndmask_b32 v6, v6, v4, s[48:49]
v_mov_b32 v28, -1
v_mov_b32 v29, -1
v_mov_b32 v30, -1
v_mov_b32 v31, -1
s_mul_i32 s28, s24, 4096
v_add_u32 v7, s28, v17
v_and_b32 v4, 7, v1
v_lshlrev_b32 v8, 11, v4
v_lshrrev_b32 v5, 3, v1
v_lshl_add_u32 v8, v5, 4, v8
s_lshl_b32 s28, s24, 9
v_add_u32 v8, s28, v8
s_lshl_b32 s28, s31, 9
s_lshr_b32 s29, s31, 3
s_mul_i32 s29, s29, 0
s_add_u32 s28, s28, s29
v_lshlrev_b32 v9, 3, v1
v_add_u32 v9, s28, v9
v_and_b32 v4, 7, v3
v_lshlrev_b32 v11, 7, v2
v_lshl_add_u32 v11, v4, 4, v11
v_add_u32 v22, 0, v11
s_add_u32 s28, s28, 24576
v_add_u32 v11, s28, v11
v_and_b32 v5, 1, v2
v_lshlrev_b32 v10, 7, v5
v_lshl_add_u32 v10, v4, 4, v10
v_add_u32 v10, 1024, v10
s_xor_b32 s37, s31, 1
s_mul_i32 s37, s37, 2048
s_add_u32 s37, s37, 49152
s_xor_b32 s38, s31, 2
s_mul_i32 s38, s38, 2048
s_add_u32 s38, s38, 49152
s_xor_b32 s39, s31, 3
s_mul_i32 s39, s39, 2048
s_add_u32 s39, s39, 49152
v_and_b32 v4, 1, v2
v_mul_u32_u24 v14, 576, v4
v_lshrrev_b32 v5, 1, v2
v_lshl_add_u32 v5, v5, 4, v3
v_lshl_add_u32 v14, v5, 2, v14
s_mul_i32 s28, s24, 1152
s_add_u32 s28, s28, 13312
v_add_u32 v18, s28, v14
s_mul_i32 s28, s24, 2304
v_add_u32 v14, s28, v14
v_add_u32 v15, 1152, v14
v_mul_u32_u24 v16, 144, v3
v_lshl_add_u32 v16, v2, 5, v16
v_bfe_u32 v4, v1, 1, 3
v_mul_u32_u24 v19, 144, v4
v_lshl_add_u32 v19, v2, 5, v19
v_and_b32 v4, 1, v1
v_lshl_add_u32 v19, v4, 4, v19
v_add_u32 v19, 13312, v19
s_lshl_b32 s28, s24, 10
s_add_u32 s28, s28, 9216
v_add_u32 v20, s28, v17
v_and_b32 v4, 31, v1
v_lshlrev_b32 v21, 3, v4
v_add_u32 v21, 17920, v21
v_lshrrev_b32 v4, 2, v3
v_and_b32 v42, 1, v4
v_lshrrev_b32 v43, 1, v4
v_lshrrev_b32 v44, 1, v2
v_and_b32 v45, 1, v2
v_lshl_add_u32 v46, v44, 4, v42
v_lshl_add_u32 v46, v45, 2, v46
v_lshl_add_u32 v46, v43, 3, v46
v_lshl_add_u32 v47, v44, 3, v42
v_lshl_add_u32 v47, v45, 4, v47
v_lshl_add_u32 v47, v43, 2, v47
v_and_b32 v5, 3, v3
v_lshlrev_b32 v5, 3, v5
v_lshl_add_u32 v46, v46, 6, v5
v_lshl_add_u32 v47, v47, 6, v5
s_and_b32 s28, s31, 0
s_lshl_b32 s28, s28, 6
s_add_u32 s28, s28, s47
v_add_u32 v46, s28, v46
v_add_u32 v47, s28, v47
s_waitcnt vmcnt(17)
ds_read_b64_tr_b16 a[64:65], v46 offset:0
ds_read_b64_tr_b16 a[66:67], v46 offset:128
ds_read_b64_tr_b16 a[68:69], v46 offset:2048
ds_read_b64_tr_b16 a[70:71], v46 offset:2176
ds_read_b64_tr_b16 a[72:73], v46 offset:4096
ds_read_b64_tr_b16 a[74:75], v46 offset:4224
ds_read_b64_tr_b16 a[76:77], v46 offset:6144
ds_read_b64_tr_b16 a[78:79], v46 offset:6272
s_waitcnt lgkmcnt(0)
ds_read_b64_tr_b16 a[80:81], v46 offset:8192
ds_read_b64_tr_b16 a[82:83], v46 offset:8320
ds_read_b64_tr_b16 a[84:85], v46 offset:10240
ds_read_b64_tr_b16 a[86:87], v46 offset:10368
ds_read_b64_tr_b16 a[88:89], v46 offset:12288
ds_read_b64_tr_b16 a[90:91], v46 offset:12416
ds_read_b64_tr_b16 a[92:93], v46 offset:14336
ds_read_b64_tr_b16 a[94:95], v46 offset:14464
s_waitcnt lgkmcnt(0)
ds_read_b64_tr_b16 a[96:97], v46 offset:32
ds_read_b64_tr_b16 a[98:99], v46 offset:160
ds_read_b64_tr_b16 a[100:101], v46 offset:2080
ds_read_b64_tr_b16 a[102:103], v46 offset:2208
ds_read_b64_tr_b16 a[104:105], v46 offset:4128
ds_read_b64_tr_b16 a[106:107], v46 offset:4256
ds_read_b64_tr_b16 a[108:109], v46 offset:6176
ds_read_b64_tr_b16 a[110:111], v46 offset:6304
s_waitcnt lgkmcnt(0)
ds_read_b64_tr_b16 a[112:113], v46 offset:8224
ds_read_b64_tr_b16 a[114:115], v46 offset:8352
ds_read_b64_tr_b16 a[116:117], v46 offset:10272
ds_read_b64_tr_b16 a[118:119], v46 offset:10400
ds_read_b64_tr_b16 a[120:121], v46 offset:12320
ds_read_b64_tr_b16 a[122:123], v46 offset:12448
ds_read_b64_tr_b16 a[124:125], v46 offset:14368
ds_read_b64_tr_b16 a[126:127], v46 offset:14496
s_waitcnt lgkmcnt(0)
buffer_load_dword v50, v51, s[4:7], 0 offen
s_xor_b32 s29, s76, 0
s_lshl_b32 s28, s29, 10
s_add_u32 s28, s28, s47
s_add_u32 m0, s28, 0
s_lshl_b32 s29, s29, 17
buffer_load_dwordx4 v40, s[4:7], s29 offen lds
s_xor_b32 s29, s76, 1
s_lshl_b32 s28, s29, 10
s_add_u32 s28, s28, s47
s_add_u32 m0, s28, 0
s_lshl_b32 s29, s29, 17
buffer_load_dwordx4 v40, s[4:7], s29 offen lds
s_xor_b32 s29, s76, 2
s_lshl_b32 s28, s29, 10
s_add_u32 s28, s28, s47
s_add_u32 m0, s28, 0
s_lshl_b32 s29, s29, 17
buffer_load_dwordx4 v40, s[4:7], s29 offen lds
s_xor_b32 s29, s76, 3
s_lshl_b32 s28, s29, 10
s_add_u32 s28, s28, s47
s_add_u32 m0, s28, 0
s_lshl_b32 s29, s29, 17
buffer_load_dwordx4 v40, s[4:7], s29 offen lds
s_xor_b32 s29, s76, 4
s_lshl_b32 s28, s29, 10
s_add_u32 s28, s28, s47
s_add_u32 m0, s28, 0
s_lshl_b32 s29, s29, 17
buffer_load_dwordx4 v40, s[4:7], s29 offen lds
s_xor_b32 s29, s76, 5
s_lshl_b32 s28, s29, 10
s_add_u32 s28, s28, s47
s_add_u32 m0, s28, 0
s_lshl_b32 s29, s29, 17
buffer_load_dwordx4 v40, s[4:7], s29 offen lds
s_xor_b32 s29, s76, 6
s_lshl_b32 s28, s29, 10
s_add_u32 s28, s28, s47
s_add_u32 m0, s28, 0
s_lshl_b32 s29, s29, 17
buffer_load_dwordx4 v40, s[4:7], s29 offen lds
s_xor_b32 s29, s76, 7
s_lshl_b32 s28, s29, 10
s_add_u32 s28, s28, s47
s_add_u32 m0, s28, 0
s_lshl_b32 s29, s29, 17
buffer_load_dwordx4 v40, s[4:7], s29 offen lds
s_xor_b32 s29, s76, 8
s_lshl_b32 s28, s29, 10
s_add_u32 s28, s28, s47
s_add_u32 m0, s28, 0
s_lshl_b32 s29, s29, 17
buffer_load_dwordx4 v40, s[4:7], s29 offen lds
s_xor_b32 s29, s76, 9
s_lshl_b32 s28, s29, 10
s_add_u32 s28, s28, s47
s_add_u32 m0, s28, 0
s_lshl_b32 s29, s29, 17
buffer_load_dwordx4 v40, s[4:7], s29 offen lds
s_xor_b32 s29, s76, 10
s_lshl_b32 s28, s29, 10
s_add_u32 s28, s28, s47
s_add_u32 m0, s28, 0
s_lshl_b32 s29, s29, 17
buffer_load_dwordx4 v40, s[4:7], s29 offen lds
s_xor_b32 s29, s76, 11
s_lshl_b32 s28, s29, 10
s_add_u32 s28, s28, s47
s_add_u32 m0, s28, 0
s_lshl_b32 s29, s29, 17
buffer_load_dwordx4 v40, s[4:7], s29 offen lds
s_xor_b32 s29, s76, 12
s_lshl_b32 s28, s29, 10
s_add_u32 s28, s28, s47
s_add_u32 m0, s28, 0
s_lshl_b32 s29, s29, 17
buffer_load_dwordx4 v40, s[4:7], s29 offen lds
s_xor_b32 s29, s76, 13
s_lshl_b32 s28, s29, 10
s_add_u32 s28, s28, s47
s_add_u32 m0, s28, 0
s_lshl_b32 s29, s29, 17
buffer_load_dwordx4 v40, s[4:7], s29 offen lds
s_xor_b32 s29, s76, 14
s_lshl_b32 s28, s29, 10
s_add_u32 s28, s28, s47
s_add_u32 m0, s28, 0
s_lshl_b32 s29, s29, 17
buffer_load_dwordx4 v40, s[4:7], s29 offen lds
s_xor_b32 s29, s76, 15
s_lshl_b32 s28, s29, 10
s_add_u32 s28, s28, s47
s_add_u32 m0, s28, 0
s_lshl_b32 s29, s29, 17
buffer_load_dwordx4 v40, s[4:7], s29 offen lds
s_waitcnt vmcnt(17)
ds_read_b64_tr_b16 a[128:129], v46 offset:16384
ds_read_b64_tr_b16 a[130:131], v46 offset:16512
ds_read_b64_tr_b16 a[132:133], v46 offset:18432
ds_read_b64_tr_b16 a[134:135], v46 offset:18560
ds_read_b64_tr_b16 a[136:137], v46 offset:20480
ds_read_b64_tr_b16 a[138:139], v46 offset:20608
ds_read_b64_tr_b16 a[140:141], v46 offset:22528
ds_read_b64_tr_b16 a[142:143], v46 offset:22656
s_waitcnt lgkmcnt(0)
ds_read_b64_tr_b16 a[144:145], v46 offset:24576
ds_read_b64_tr_b16 a[146:147], v46 offset:24704
ds_read_b64_tr_b16 a[148:149], v46 offset:26624
ds_read_b64_tr_b16 a[150:151], v46 offset:26752
ds_read_b64_tr_b16 a[152:153], v46 offset:28672
ds_read_b64_tr_b16 a[154:155], v46 offset:28800
ds_read_b64_tr_b16 a[156:157], v46 offset:30720
ds_read_b64_tr_b16 a[158:159], v46 offset:30848
s_waitcnt lgkmcnt(0)
ds_read_b64_tr_b16 a[160:161], v46 offset:16416
ds_read_b64_tr_b16 a[162:163], v46 offset:16544
ds_read_b64_tr_b16 a[164:165], v46 offset:18464
ds_read_b64_tr_b16 a[166:167], v46 offset:18592
ds_read_b64_tr_b16 a[168:169], v46 offset:20512
ds_read_b64_tr_b16 a[170:171], v46 offset:20640
ds_read_b64_tr_b16 a[172:173], v46 offset:22560
ds_read_b64_tr_b16 a[174:175], v46 offset:22688
s_waitcnt lgkmcnt(0)
ds_read_b64_tr_b16 a[176:177], v46 offset:24608
ds_read_b64_tr_b16 a[178:179], v46 offset:24736
ds_read_b64_tr_b16 a[180:181], v46 offset:26656
ds_read_b64_tr_b16 a[182:183], v46 offset:26784
ds_read_b64_tr_b16 a[184:185], v46 offset:28704
ds_read_b64_tr_b16 a[186:187], v46 offset:28832
ds_read_b64_tr_b16 a[188:189], v46 offset:30752
ds_read_b64_tr_b16 a[190:191], v46 offset:30880
s_waitcnt lgkmcnt(0)
buffer_load_dword v50, v52, s[16:19], 0 offen
s_xor_b32 s29, s76, 0
s_lshl_b32 s28, s29, 10
s_add_u32 s28, s28, s47
s_add_u32 m0, s28, 16384
s_lshl_b32 s29, s29, 15
buffer_load_dwordx4 v41, s[16:19], s29 offen lds
s_xor_b32 s29, s76, 1
s_lshl_b32 s28, s29, 10
s_add_u32 s28, s28, s47
s_add_u32 m0, s28, 16384
s_lshl_b32 s29, s29, 15
buffer_load_dwordx4 v41, s[16:19], s29 offen lds
s_xor_b32 s29, s76, 2
s_lshl_b32 s28, s29, 10
s_add_u32 s28, s28, s47
s_add_u32 m0, s28, 16384
s_lshl_b32 s29, s29, 15
buffer_load_dwordx4 v41, s[16:19], s29 offen lds
s_xor_b32 s29, s76, 3
s_lshl_b32 s28, s29, 10
s_add_u32 s28, s28, s47
s_add_u32 m0, s28, 16384
s_lshl_b32 s29, s29, 15
buffer_load_dwordx4 v41, s[16:19], s29 offen lds
s_xor_b32 s29, s76, 4
s_lshl_b32 s28, s29, 10
s_add_u32 s28, s28, s47
s_add_u32 m0, s28, 16384
s_lshl_b32 s29, s29, 15
buffer_load_dwordx4 v41, s[16:19], s29 offen lds
s_xor_b32 s29, s76, 5
s_lshl_b32 s28, s29, 10
s_add_u32 s28, s28, s47
s_add_u32 m0, s28, 16384
s_lshl_b32 s29, s29, 15
buffer_load_dwordx4 v41, s[16:19], s29 offen lds
s_xor_b32 s29, s76, 6
s_lshl_b32 s28, s29, 10
s_add_u32 s28, s28, s47
s_add_u32 m0, s28, 16384
s_lshl_b32 s29, s29, 15
buffer_load_dwordx4 v41, s[16:19], s29 offen lds
s_xor_b32 s29, s76, 7
s_lshl_b32 s28, s29, 10
s_add_u32 s28, s28, s47
s_add_u32 m0, s28, 16384
s_lshl_b32 s29, s29, 15
buffer_load_dwordx4 v41, s[16:19], s29 offen lds
s_xor_b32 s29, s76, 8
s_lshl_b32 s28, s29, 10
s_add_u32 s28, s28, s47
s_add_u32 m0, s28, 16384
s_lshl_b32 s29, s29, 15
buffer_load_dwordx4 v41, s[16:19], s29 offen lds
s_xor_b32 s29, s76, 9
s_lshl_b32 s28, s29, 10
s_add_u32 s28, s28, s47
s_add_u32 m0, s28, 16384
s_lshl_b32 s29, s29, 15
buffer_load_dwordx4 v41, s[16:19], s29 offen lds
s_xor_b32 s29, s76, 10
s_lshl_b32 s28, s29, 10
s_add_u32 s28, s28, s47
s_add_u32 m0, s28, 16384
s_lshl_b32 s29, s29, 15
buffer_load_dwordx4 v41, s[16:19], s29 offen lds
s_xor_b32 s29, s76, 11
s_lshl_b32 s28, s29, 10
s_add_u32 s28, s28, s47
s_add_u32 m0, s28, 16384
s_lshl_b32 s29, s29, 15
buffer_load_dwordx4 v41, s[16:19], s29 offen lds
s_xor_b32 s29, s76, 12
s_lshl_b32 s28, s29, 10
s_add_u32 s28, s28, s47
s_add_u32 m0, s28, 16384
s_lshl_b32 s29, s29, 15
buffer_load_dwordx4 v41, s[16:19], s29 offen lds
s_xor_b32 s29, s76, 13
s_lshl_b32 s28, s29, 10
s_add_u32 s28, s28, s47
s_add_u32 m0, s28, 16384
s_lshl_b32 s29, s29, 15
buffer_load_dwordx4 v41, s[16:19], s29 offen lds
s_xor_b32 s29, s76, 14
s_lshl_b32 s28, s29, 10
s_add_u32 s28, s28, s47
s_add_u32 m0, s28, 16384
s_lshl_b32 s29, s29, 15
buffer_load_dwordx4 v41, s[16:19], s29 offen lds
s_xor_b32 s29, s76, 15
s_lshl_b32 s28, s29, 10
s_add_u32 s28, s28, s47
s_add_u32 m0, s28, 16384
s_lshl_b32 s29, s29, 15
buffer_load_dwordx4 v41, s[16:19], s29 offen lds
s_mov_b64 exec, 0
s_cmp_eq_u32 s24, 0
s_cbranch_scc1 mega_kernel_rs_iw0
s_cmp_eq_u32 s24, 1
s_cbranch_scc1 mega_kernel_rs_iw1
s_cmp_eq_u32 s24, 2
s_cbranch_scc1 mega_kernel_rs_iw2
s_branch mega_kernel_rs_iw3
mega_kernel_rs_iwd:
s_mov_b64 exec, -1
s_waitcnt vmcnt(17)
ds_read_b64_tr_b16 a[0:1], v46 offset:0
ds_read_b64_tr_b16 a[2:3], v46 offset:128
ds_read_b64_tr_b16 a[4:5], v46 offset:2048
ds_read_b64_tr_b16 a[6:7], v46 offset:2176
ds_read_b64_tr_b16 a[8:9], v46 offset:4096
ds_read_b64_tr_b16 a[10:11], v46 offset:4224
ds_read_b64_tr_b16 a[12:13], v46 offset:6144
ds_read_b64_tr_b16 a[14:15], v46 offset:6272
s_waitcnt lgkmcnt(0)
ds_read_b64_tr_b16 a[16:17], v46 offset:8192
ds_read_b64_tr_b16 a[18:19], v46 offset:8320
ds_read_b64_tr_b16 a[20:21], v46 offset:10240
ds_read_b64_tr_b16 a[22:23], v46 offset:10368
ds_read_b64_tr_b16 a[24:25], v46 offset:12288
ds_read_b64_tr_b16 a[26:27], v46 offset:12416
ds_read_b64_tr_b16 a[28:29], v46 offset:14336
ds_read_b64_tr_b16 a[30:31], v46 offset:14464
s_waitcnt lgkmcnt(0)
ds_read_b64_tr_b16 a[32:33], v46 offset:32
ds_read_b64_tr_b16 a[34:35], v46 offset:160
ds_read_b64_tr_b16 a[36:37], v46 offset:2080
ds_read_b64_tr_b16 a[38:39], v46 offset:2208
ds_read_b64_tr_b16 a[40:41], v46 offset:4128
ds_read_b64_tr_b16 a[42:43], v46 offset:4256
ds_read_b64_tr_b16 a[44:45], v46 offset:6176
ds_read_b64_tr_b16 a[46:47], v46 offset:6304
s_waitcnt lgkmcnt(0)
ds_read_b64_tr_b16 a[48:49], v46 offset:8224
ds_read_b64_tr_b16 a[50:51], v46 offset:8352
ds_read_b64_tr_b16 a[52:53], v46 offset:10272
ds_read_b64_tr_b16 a[54:55], v46 offset:10400
ds_read_b64_tr_b16 a[56:57], v46 offset:12320
ds_read_b64_tr_b16 a[58:59], v46 offset:12448
ds_read_b64_tr_b16 a[60:61], v46 offset:14368
ds_read_b64_tr_b16 a[62:63], v46 offset:14496
s_waitcnt lgkmcnt(0)
v_and_b32 v247, 15, v0
v_lshlrev_b32 v247, 4, v247
buffer_load_dword v246, v247, s[72:75], 0 offen sc1
buffer_load_dwordx4 v[64:67], v8, s[20:23], 0 offen offset:0
buffer_load_dwordx4 v[68:71], v8, s[20:23], 0 offen offset:128
buffer_load_dwordx4 v[72:75], v8, s[20:23], 0 offen offset:256
buffer_load_dwordx4 v[76:79], v8, s[20:23], 0 offen offset:384
s_waitcnt vmcnt(0)
ds_read_b64_tr_b16 a[192:193], v47 offset:16384
ds_read_b64_tr_b16 a[194:195], v47 offset:16512
ds_read_b64_tr_b16 a[196:197], v47 offset:18432
ds_read_b64_tr_b16 a[198:199], v47 offset:18560
ds_read_b64_tr_b16 a[200:201], v47 offset:20480
ds_read_b64_tr_b16 a[202:203], v47 offset:20608
ds_read_b64_tr_b16 a[204:205], v47 offset:22528
ds_read_b64_tr_b16 a[206:207], v47 offset:22656
s_waitcnt lgkmcnt(0)
ds_read_b64_tr_b16 a[208:209], v47 offset:24576
ds_read_b64_tr_b16 a[210:211], v47 offset:24704
ds_read_b64_tr_b16 a[212:213], v47 offset:26624
ds_read_b64_tr_b16 a[214:215], v47 offset:26752
ds_read_b64_tr_b16 a[216:217], v47 offset:28672
ds_read_b64_tr_b16 a[218:219], v47 offset:28800
ds_read_b64_tr_b16 a[220:221], v47 offset:30720
ds_read_b64_tr_b16 a[222:223], v47 offset:30848
s_waitcnt lgkmcnt(0)
ds_read_b64_tr_b16 a[224:225], v47 offset:16416
ds_read_b64_tr_b16 a[226:227], v47 offset:16544
ds_read_b64_tr_b16 a[228:229], v47 offset:18464
ds_read_b64_tr_b16 a[230:231], v47 offset:18592
ds_read_b64_tr_b16 a[232:233], v47 offset:20512
ds_read_b64_tr_b16 a[234:235], v47 offset:20640
ds_read_b64_tr_b16 a[236:237], v47 offset:22560
ds_read_b64_tr_b16 a[238:239], v47 offset:22688
s_waitcnt lgkmcnt(0)
ds_read_b64_tr_b16 a[240:241], v47 offset:24608
ds_read_b64_tr_b16 a[242:243], v47 offset:24736
ds_read_b64_tr_b16 a[244:245], v47 offset:26656
ds_read_b64_tr_b16 a[246:247], v47 offset:26784
ds_read_b64_tr_b16 a[248:249], v47 offset:28704
ds_read_b64_tr_b16 a[250:251], v47 offset:28832
ds_read_b64_tr_b16 a[252:253], v47 offset:30752
ds_read_b64_tr_b16 a[254:255], v47 offset:30880
s_waitcnt lgkmcnt(0)
v_mov_b32 v32, v64
v_mov_b32 v33, v65
v_mov_b32 v34, v66
v_mov_b32 v35, v67
v_mov_b32 v36, v68
v_mov_b32 v37, v69
v_mov_b32 v38, v70
v_mov_b32 v39, v71
v_mov_b32 v40, v72
v_mov_b32 v41, v73
v_mov_b32 v42, v74
v_mov_b32 v43, v75
v_mov_b32 v44, v76
v_mov_b32 v45, v77
v_mov_b32 v46, v78
v_mov_b32 v47, v79
v_mov_b32 v96, 0
v_mov_b32 v97, 0
v_mov_b32 v98, 0
v_mov_b32 v99, 0
v_mov_b32 v100, 0
v_mov_b32 v101, 0
v_mov_b32 v102, 0
v_mov_b32 v103, 0
v_mov_b32 v104, 0
v_mov_b32 v105, 0
v_mov_b32 v106, 0
v_mov_b32 v107, 0
v_mov_b32 v108, 0
v_mov_b32 v109, 0
v_mov_b32 v110, 0
v_mov_b32 v111, 0
v_mov_b32 v112, 0
v_mov_b32 v113, 0
v_mov_b32 v114, 0
v_mov_b32 v115, 0
v_mov_b32 v116, 0
v_mov_b32 v117, 0
v_mov_b32 v118, 0
v_mov_b32 v119, 0
s_nop 1
v_smfmac_f32_16x16x64_bf16 v[96:99], v[32:35], a[0:7], v6
v_smfmac_f32_16x16x64_bf16 v[100:103], v[32:35], a[32:39], v6
v_smfmac_f32_16x16x64_bf16 v[104:107], v[32:35], a[64:71], v6
v_smfmac_f32_16x16x64_bf16 v[108:111], v[32:35], a[96:103], v6
v_smfmac_f32_16x16x64_bf16 v[96:99], v[36:39], a[8:15], v6
v_smfmac_f32_16x16x64_bf16 v[100:103], v[36:39], a[40:47], v6
v_smfmac_f32_16x16x64_bf16 v[104:107], v[36:39], a[72:79], v6
v_smfmac_f32_16x16x64_bf16 v[108:111], v[36:39], a[104:111], v6
v_smfmac_f32_16x16x64_bf16 v[96:99], v[40:43], a[16:23], v6
v_smfmac_f32_16x16x64_bf16 v[100:103], v[40:43], a[48:55], v6
v_smfmac_f32_16x16x64_bf16 v[104:107], v[40:43], a[80:87], v6
v_smfmac_f32_16x16x64_bf16 v[108:111], v[40:43], a[112:119], v6
v_smfmac_f32_16x16x64_bf16 v[96:99], v[44:47], a[24:31], v6
v_smfmac_f32_16x16x64_bf16 v[100:103], v[44:47], a[56:63], v6
v_smfmac_f32_16x16x64_bf16 v[104:107], v[44:47], a[88:95], v6
v_smfmac_f32_16x16x64_bf16 v[108:111], v[44:47], a[120:127], v6
v_and_b32 v247, 15, v0
v_lshlrev_b32 v247, 4, v247
s_branch mega_kernel_sysp
mega_kernel_sysw:
s_sleep 4
mega_kernel_sys:
buffer_load_dword v246, v247, s[72:75], 0 offen sc1
s_waitcnt vmcnt(0)
mega_kernel_sysp:
s_cmp_eq_u32 s95, 1
s_cbranch_scc0 mega_kernel_sysf
v_readlane_b32 s76, v246, 14
s_mov_b32 s98, 0
s_cmp_eq_u32 s76, 32
s_cbranch_scc0 mega_kernel_sysw
s_branch mega_kernel_sysd
mega_kernel_sysf:
s_mov_b32 s77, 0
s_mov_b32 s78, 0
v_readlane_b32 s76, v246, 0
s_add_u32 s77, s77, s76
s_xor_b32 s76, s76, 32
s_or_b32 s78, s78, s76
v_readlane_b32 s76, v246, 1
s_add_u32 s77, s77, s76
s_xor_b32 s76, s76, 32
s_or_b32 s78, s78, s76
v_readlane_b32 s76, v246, 2
s_add_u32 s77, s77, s76
s_xor_b32 s76, s76, 32
s_or_b32 s78, s78, s76
v_readlane_b32 s76, v246, 3
s_add_u32 s77, s77, s76
s_xor_b32 s76, s76, 32
s_or_b32 s78, s78, s76
v_readlane_b32 s76, v246, 4
s_add_u32 s77, s77, s76
s_xor_b32 s76, s76, 32
s_or_b32 s78, s78, s76
v_readlane_b32 s76, v246, 5
s_add_u32 s77, s77, s76
s_xor_b32 s76, s76, 32
s_or_b32 s78, s78, s76
v_readlane_b32 s76, v246, 6
s_add_u32 s77, s77, s76
s_xor_b32 s76, s76, 32
s_or_b32 s78, s78, s76
v_readlane_b32 s76, v246, 7
s_add_u32 s77, s77, s76
s_xor_b32 s76, s76, 32
s_or_b32 s78, s78, s76
s_cmp_eq_u32 s77, 256
s_cbranch_scc0 mega_kernel_sysw
v_mov_b32 v252, v246
s_cmp_eq_u32 s78, 0
s_cbranch_scc0 mega_kernel_slowent
v_readlane_b32 s76, v246, 10
v_readlane_b32 s77, v246, 8
s_cmp_eq_u32 s76, 32
s_cbranch_scc0 mega_kernel_sysw
s_cmp_gt_u32 s77, 16
s_cselect_b32 s98, 1, 0
mega_kernel_sysd:
s_lshr_b32 s28, s31, 4
s_lshl_b32 s28, s28, 14
s_lshl_b32 s29, s98, 13
s_add_u32 s28, s28, s29
s_and_b32 s29, s31, 15
s_lshl_b32 s29, s29, 9
s_add_u32 s28, s28, s29
s_lshl_b32 s29, s30, 16
s_add_u32 s28, s28, s29
s_add_u32 s28, s28, 67108864
v_lshrrev_b32 v12, 1, v17
v_add_u32 v12, s28, v12
v_xor_b32 v25, 0x10000, v12
v_xor_b32 v26, 0x20000, v12
v_xor_b32 v27, 0x30000, v12
v_add_u32 v25, 0, v25
v_add_u32 v26, 0, v26
v_add_u32 v27, 0, v27
s_lshl_b32 s28, s25, 2
s_add_u32 s28, s28, s26
s_mov_b32 s82, s28
s_lshr_b32 s29, s28, 3
s_xor_b32 s29, s29, s98
s_and_b32 s29, s29, 1
s_lshl_b32 s29, s29, 13
s_lshl_b32 s76, s28, 18
s_add_u32 s76, s76, s29
s_mov_b32 s83, s76
v_add_u32 v240, s76, v17
v_add_u32 v241, 33554432, v240
s_lshr_b32 s29, s28, 4
s_xor_b32 s29, s29, s98
s_and_b32 s29, s29, 1
s_lshl_b32 s29, s29, 13
s_lshl_b32 s79, s28, 17
s_add_u32 s79, s79, s29
s_add_u32 s79, s79, 71303168
s_xor_b32 s29, s98, 1
s_lshl_b32 s29, s29, 13
s_lshl_b32 s28, s25, 7
s_add_u32 s28, s28, s29
s_add_u32 s28, s28, 69206016
v_and_b32 v4, 1, v1
v_lshlrev_b32 v24, 12, v4
v_add_u32 v24, s28, v24
s_lshl_b32 s29, s26, 2
v_add_u32 v24, s29, v24
s_xor_b32 s81, s98, 1
s_lshl_b32 s81, s81, 13
s_lshr_b32 s29, s82, 6
s_lshl_b32 s29, s29, 14
s_add_u32 s81, s81, s29
s_and_b32 s29, s82, 63
s_lshl_b32 s29, s29, 7
s_add_u32 s81, s81, s29
s_add_u32 s81, s81, 69222400
v_mov_b32 v220, 0x3f803f80
v_mov_b32 v221, 0x3f803f80
v_mov_b32 v222, 0x3f803f80
v_mov_b32 v223, 0x3f803f80
v_mov_b32 v228, 0
s_mov_b32 s27, 0
s_mov_b32 s46, 0
s_mov_b32 s89, 0
s_mov_b32 s88, 0
s_mov_b32 s44, 18432
s_mov_b32 s45, 18432
s_cmp_eq_u32 s24, 3
s_cbranch_scc0 mega_kernel_rs_pfi
s_mov_b32 s76, 0
s_cmp_gt_i32 s46, s76
s_cbranch_scc1 mega_kernel_rs_pf0ok
mega_kernel_rs_pf0w:
v_mov_b32 v4, 0
s_mov_b64 exec, 3
buffer_atomic_add v4, v24, s[84:87], 0 offen sc0 sc1
s_mov_b64 exec, -1
s_waitcnt vmcnt(0)
v_readlane_b32 s46, v4, 0
v_readlane_b32 s28, v4, 1
s_nop 1
s_min_i32 s46, s46, s28
s_cmp_gt_i32 s46, s76
s_cbranch_scc0 mega_kernel_rs_pf0w
mega_kernel_rs_pf0ok:
s_add_u32 s77, s76, s82
s_bfe_u32 s28, s77, 0x40002
s_lshl_b32 s28, s28, 14
s_and_b32 s77, s77, 3
s_lshl_b32 s77, s77, 11
s_add_u32 s28, s28, s77
s_add_u32 m0, s45, 0
s_nop 0
buffer_load_dwordx4 v240, s[84:87], s28 offen offset:0 sc1 lds
s_add_u32 m0, s45, 0
s_nop 0
buffer_load_dwordx4 v240, s[84:87], s28 offen offset:1024 sc1 lds
s_add_u32 m0, s45, 2048
s_nop 0
buffer_load_dwordx4 v241, s[84:87], s28 offen offset:0 sc1 lds
s_add_u32 m0, s45, 2048
s_nop 0
buffer_load_dwordx4 v241, s[84:87], s28 offen offset:1024 sc1 lds
s_add_u32 s45, s45, 4096
s_cmp_eq_u32 s45, 30720
s_cselect_b32 s45, 18432, s45
s_waitcnt vmcnt(0) lgkmcnt(0)
mega_kernel_rs_pfi:
v_mov_b32 v184, 0
v_mov_b32 v185, 0
v_mov_b32 v186, 0
v_mov_b32 v187, 0
v_mov_b32 v188, 0
v_mov_b32 v189, 0
v_mov_b32 v190, 0
v_mov_b32 v191, 0
v_mov_b32 v192, 0
v_mov_b32 v193, 0
v_mov_b32 v194, 0
v_mov_b32 v195, 0
v_mov_b32 v196, 0
v_mov_b32 v197, 0
v_mov_b32 v198, 0
v_mov_b32 v199, 0
v_mov_b32 v200, 0
v_mov_b32 v201, 0
v_mov_b32 v202, 0
v_mov_b32 v203, 0
v_mov_b32 v204, 0
v_mov_b32 v205, 0
v_mov_b32 v206, 0
v_mov_b32 v207, 0
v_mov_b32 v249, 0
s_barrier
s_and_b32 s29, s27, 1
s_lshl_b32 s33, s29, 17
s_lshl_b32 s28, s30, 18
s_add_u32 s33, s33, s28
s_add_u32 s33, s33, 68157440
s_xor_b32 s34, s33, 131072
s_lshl_b32 s35, s29, 18
s_bfe_u32 s47, s27, 0x10001
s_branch mega_kernel_rs_first
.p2align 6
s_nop 0
s_nop 0
mega_kernel_rs_loop:
buffer_load_dwordx4 v[32:35], v7, s[84:87], s33 offen offset:0 sc1
v_add_u32 v5, s44, v17
ds_read_b128 v[156:159], v5 offset:0
ds_read_b128 v[160:163], v5 offset:1024
ds_read_b128 v[164:167], v5 offset:2048
ds_read_b128 v[168:171], v5 offset:3072
s_nop 4
buffer_load_dwordx4 v[36:39], v7, s[84:87], s33 offen offset:1024 sc1
s_nop 9
buffer_load_dwordx4 v[40:43], v7, s[84:87], s33 offen offset:2048 sc1
s_nop 9
buffer_load_dwordx4 v[44:47], v7, s[84:87], s33 offen offset:3072 sc1
s_waitcnt vmcnt(3)
v_max_u32 v4, v32, v34
v_cmp_eq_u32 vcc, -1, v4
s_cbranch_vccnz mega_kernel_rs_pa_15_0f
v_smfmac_f32_16x16x64_bf16 v[96:99], v[32:35], a[0:7], v6
v_smfmac_f32_16x16x64_bf16 v[100:103], v[32:35], a[32:39], v6
v_smfmac_f32_16x16x64_bf16 v[104:107], v[32:35], a[64:71], v6
s_waitcnt vmcnt(2)
v_max_u32 v4, v36, v38
v_cmp_eq_u32 vcc, -1, v4
v_smfmac_f32_16x16x64_bf16 v[108:111], v[32:35], a[96:103], v6
s_cbranch_vccnz mega_kernel_rs_pa_14_1f
v_smfmac_f32_16x16x64_bf16 v[96:99], v[36:39], a[8:15], v6
v_smfmac_f32_16x16x64_bf16 v[100:103], v[36:39], a[40:47], v6
v_smfmac_f32_16x16x64_bf16 v[104:107], v[36:39], a[72:79], v6
s_waitcnt vmcnt(1)
v_max_u32 v4, v40, v42
v_cmp_eq_u32 vcc, -1, v4
v_smfmac_f32_16x16x64_bf16 v[108:111], v[36:39], a[104:111], v6
s_cbranch_vccnz mega_kernel_rs_pa_12_2f
v_smfmac_f32_16x16x64_bf16 v[96:99], v[40:43], a[16:23], v6
v_smfmac_f32_16x16x64_bf16 v[100:103], v[40:43], a[48:55], v6
v_smfmac_f32_16x16x64_bf16 v[104:107], v[40:43], a[80:87], v6
s_waitcnt vmcnt(0)
v_max_u32 v4, v44, v46
v_cmp_eq_u32 vcc, -1, v4
v_smfmac_f32_16x16x64_bf16 v[108:111], v[40:43], a[112:119], v6
s_cbranch_vccnz mega_kernel_rs_pa_8_3f
v_smfmac_f32_16x16x64_bf16 v[96:99], v[44:47], a[24:31], v6
v_smfmac_f32_16x16x64_bf16 v[100:103], v[44:47], a[56:63], v6
v_smfmac_f32_16x16x64_bf16 v[104:107], v[44:47], a[88:95], v6
v_smfmac_f32_16x16x64_bf16 v[108:111], v[44:47], a[120:127], v6
mega_kernel_rs_pa_d:
mega_kernel_rs_adone:
s_nop 5
v_permlane32_swap_b32 v96, v100
v_permlane32_swap_b32 v97, v101
v_permlane32_swap_b32 v98, v102
v_permlane32_swap_b32 v99, v103
v_pk_add_f32 v[96:97], v[96:97], v[100:101]
v_pk_add_f32 v[98:99], v[98:99], v[102:103]
ds_write2_b32 v14, v96, v97 offset0:0 offset1:36
ds_write2_b32 v14, v98, v99 offset0:72 offset1:108
v_permlane32_swap_b32 v104, v108
v_permlane32_swap_b32 v105, v109
v_permlane32_swap_b32 v106, v110
v_permlane32_swap_b32 v107, v111
v_pk_add_f32 v[104:105], v[104:105], v[108:109]
v_pk_add_f32 v[106:107], v[106:107], v[110:111]
ds_write2_b32 v15, v104, v105 offset0:0 offset1:36
ds_write2_b32 v15, v106, v107 offset0:72 offset1:108
v_smfmac_f32_16x16x64_bf16 v[112:115], v[32:35], a[128:135], v6
v_smfmac_f32_16x16x64_bf16 v[116:119], v[32:35], a[160:167], v6
v_smfmac_f32_16x16x64_bf16 v[112:115], v[36:39], a[136:143], v6
v_smfmac_f32_16x16x64_bf16 v[116:119], v[36:39], a[168:175], v6
s_waitcnt lgkmcnt(0)
s_barrier
s_cmp_lg_u32 s24, 0
s_cbranch_scc1 mega_kernel_rs_side
ds_read_b128 v[120:123], v16 offset:0
ds_read_b128 v[124:127], v16 offset:16
ds_read_b128 v[128:131], v16 offset:2304
ds_read_b128 v[132:135], v16 offset:2320
ds_read_b128 v[136:139], v16 offset:4608
ds_read_b128 v[140:143], v16 offset:4624
ds_read_b128 v[144:147], v16 offset:6912
ds_read_b128 v[148:151], v16 offset:6928
v_smfmac_f32_16x16x64_bf16 v[112:115], v[40:43], a[144:151], v6
v_smfmac_f32_16x16x64_bf16 v[116:119], v[40:43], a[176:183], v6
v_smfmac_f32_16x16x64_bf16 v[112:115], v[44:47], a[152:159], v6
v_smfmac_f32_16x16x64_bf16 v[116:119], v[44:47], a[184:191], v6
s_mul_i32 s28, s31, 2048
s_add_u32 s28, s28, s33
s_add_u32 s28, s28, 49152
s_add_u32 s76, s37, s33
s_add_u32 s77, s38, s33
s_add_u32 s78, s39, s33
s_waitcnt lgkmcnt(4)
v_pk_add_f32 v[120:121], v[120:121], v[128:129]
v_pk_add_f32 v[122:123], v[122:123], v[130:131]
v_pk_add_f32 v[124:125], v[124:125], v[132:133]
v_pk_add_f32 v[126:127], v[126:127], v[134:135]
s_waitcnt lgkmcnt(0)
v_pk_add_f32 v[136:137], v[136:137], v[144:145]
v_pk_add_f32 v[138:139], v[138:139], v[146:147]
v_pk_add_f32 v[140:141], v[140:141], v[148:149]
v_pk_add_f32 v[142:143], v[142:143], v[150:151]
v_pk_add_f32 v[120:121], v[120:121], v[136:137]
v_pk_add_f32 v[122:123], v[122:123], v[138:139]
v_pk_add_f32 v[124:125], v[124:125], v[140:141]
v_pk_add_f32 v[126:127], v[126:127], v[142:143]
v_cvt_pk_bf16_f32 v152, v120, v121
v_cvt_pk_bf16_f32 v153, v122, v123
v_cvt_pk_bf16_f32 v154, v124, v125
v_cvt_pk_bf16_f32 v155, v126, v127
s_nop 1
v_mfma_f32_16x16x32_bf16 v[176:179], v[160:163], v[152:155], 0
v_mfma_f32_16x16x32_bf16 v[172:175], v[156:159], v[152:155], 0
v_mfma_f32_16x16x32_bf16 v[180:183], v[152:155], v[152:155], 0
s_cmp_eq_u32 s27, 63
s_cbranch_scc1 mega_kernel_rs_w0last
s_nop 4
v_mov_b32_dpp v172, v176 row_shr:8 row_mask:0xf bank_mask:0xc
v_mov_b32_dpp v173, v177 row_shr:8 row_mask:0xf bank_mask:0xc
v_mov_b32_dpp v174, v178 row_shr:8 row_mask:0xf bank_mask:0xc
v_mov_b32_dpp v175, v179 row_shr:8 row_mask:0xf bank_mask:0xc
v_min_u32 v180, -2, v180
v_min_u32 v172, -2, v172
s_mov_b64 exec, s[42:43]
buffer_store_dwordx4 v[180:183], v10, s[84:87], s28 offen sc1
s_mov_b64 exec, -1
buffer_store_dwordx4 v[172:175], v17, s[84:87], s28 offen sc1
v_permlane32_swap_b32 v112, v116
v_permlane32_swap_b32 v113, v117
v_permlane32_swap_b32 v114, v118
v_permlane32_swap_b32 v115, v119
v_pk_add_f32 v[112:113], v[112:113], v[116:117]
v_pk_add_f32 v[114:115], v[114:115], v[118:119]
ds_write_b128 v20, v[112:115]
s_waitcnt lgkmcnt(0)
s_barrier
v_mov_b32 v96, 0
v_mov_b32 v97, 0
v_mov_b32 v98, 0
v_mov_b32 v99, 0
v_mov_b32 v100, 0
v_mov_b32 v101, 0
v_mov_b32 v102, 0
v_mov_b32 v103, 0
v_cndmask_b32 v176, v23, v180, s[42:43]
v_cndmask_b32 v177, v23, v181, s[42:43]
v_cndmask_b32 v178, v23, v182, s[42:43]
v_cndmask_b32 v179, v23, v183, s[42:43]
s_mov_b64 exec, s[42:43]
buffer_load_dwordx4 v[188:191], v10, s[84:87], s76 offen sc1
buffer_load_dwordx4 v[196:199], v10, s[84:87], s77 offen sc1
buffer_load_dwordx4 v[204:207], v10, s[84:87], s78 offen sc1
s_mov_b64 exec, -1
buffer_load_dwordx4 v[184:187], v17, s[84:87], s76 offen sc1
buffer_load_dwordx4 v[192:195], v17, s[84:87], s77 offen sc1
buffer_load_dwordx4 v[200:203], v17, s[84:87], s78 offen sc1
v_pk_mul_f32 v[172:173], v[172:173], s[32:33] op_sel_hi:[1,0]
v_pk_mul_f32 v[174:175], v[174:175], s[32:33] op_sel_hi:[1,0]
v_pk_mul_f32 v[176:177], v[176:177], s[32:33] op_sel_hi:[1,0]
v_pk_mul_f32 v[178:179], v[178:179], s[32:33] op_sel_hi:[1,0]
s_lshl_b32 s89, s47, 31
s_or_b32 s89, s89, 0x3b39999a
s_nop 15
s_nop 1
s_mov_b64 exec, s[42:43]
buffer_load_dwordx4 v[188:191], v10, s[84:87], s76 offen sc1
buffer_load_dwordx4 v[196:199], v10, s[84:87], s77 offen sc1
buffer_load_dwordx4 v[204:207], v10, s[84:87], s78 offen sc1
s_mov_b64 exec, -1
buffer_load_dwordx4 v[184:187], v17, s[84:87], s76 offen sc1
buffer_load_dwordx4 v[192:195], v17, s[84:87], s77 offen sc1
buffer_load_dwordx4 v[200:203], v17, s[84:87], s78 offen sc1
mega_kernel_rs_p2:
s_waitcnt vmcnt(6)
v_max3_u32 v4, v184, v188, v192
v_max3_u32 v5, v196, v200, v204
v_max_u32 v4, v4, v5
v_cmp_eq_u32 vcc, -1, v4
s_cbranch_vccnz mega_kernel_rs_p2r
v_pk_add_f32 v[124:125], v[196:197], v[204:205]
v_pk_add_f32 v[126:127], v[198:199], v[206:207]
v_pk_add_f32 v[120:121], v[192:193], v[200:201]
v_pk_add_f32 v[122:123], v[194:195], v[202:203]
v_pk_add_f32 v[124:125], v[124:125], v[188:189]
v_pk_add_f32 v[126:127], v[126:127], v[190:191]
v_pk_add_f32 v[120:121], v[120:121], v[184:185]
v_pk_add_f32 v[122:123], v[122:123], v[186:187]
v_pk_fma_f32 v[176:177], v[124:125], s[32:33], v[176:177] op_sel_hi:[1,0,1]
v_pk_fma_f32 v[178:179], v[126:127], s[32:33], v[178:179] op_sel_hi:[1,0,1]
v_pk_fma_f32 v[172:173], v[120:121], s[32:33], v[172:173] op_sel_hi:[1,0,1]
v_pk_fma_f32 v[174:175], v[122:123], s[32:33], v[174:175] op_sel_hi:[1,0,1]
v_max3_f32 v232, v172, v173, v174
v_max3_f32 v233, v176, v177, v178
v_max3_f32 v232, v232, v175, v179
v_max_f32 v234, v232, v233
s_barrier
ds_read2_b64 v[208:211], v21 offset0:0 offset1:32
v_max_f32_dpp v232, v234, v234 row_ror:8 row_mask:0xf bank_mask:0xf
v_max_f32_dpp v233, v234, v234 row_ror:8 row_mask:0xf bank_mask:0xf
s_nop 1
v_permlane16_swap_b32 v232, v233
s_nop 0
v_max_f32 v234, v232, v233
v_max_f32 v235, v232, v233
s_nop 1
v_permlane32_swap_b32 v234, v235
s_nop 0
v_max_f32 v232, v234, v235
v_pk_add_f32 v[176:177], v[176:177], v[232:233] op_sel_hi:[1,0] neg_lo:[0,1] neg_hi:[0,1]
v_pk_add_f32 v[178:179], v[178:179], v[232:233] op_sel_hi:[1,0] neg_lo:[0,1] neg_hi:[0,1]
v_pk_add_f32 v[172:173], v[172:173], v[232:233] op_sel_hi:[1,0] neg_lo:[0,1] neg_hi:[0,1]
v_pk_add_f32 v[174:175], v[174:175], v[232:233] op_sel_hi:[1,0] neg_lo:[0,1] neg_hi:[0,1]
v_exp_f32 v176, v176
v_exp_f32 v177, v177
v_exp_f32 v178, v178
v_exp_f32 v179, v179
v_exp_f32 v172, v172
v_cvt_pk_bf16_f32 v216, v176, v177
v_cvt_pk_bf16_f32 v217, v178, v179
v_exp_f32 v173, v173
v_exp_f32 v174, v174
v_mfma_f32_16x16x16_bf16 v[224:227], v[220:221], v[216:217], 0
v_exp_f32 v175, v175
v_cvt_pk_bf16_f32 v212, v172, v173
s_waitcnt lgkmcnt(0)
v_mfma_f32_16x16x16_bf16 v[120:123], v[208:209], v[216:217], 0
v_cvt_pk_bf16_f32 v213, v174, v175
v_mfma_f32_16x16x16_bf16 v[124:127], v[210:211], v[216:217], 0
v_mov_b32_dpp v214, v212 row_ror:8 row_mask:0xf bank_mask:0xf
v_mov_b32_dpp v215, v213 row_ror:8 row_mask:0xf bank_mask:0xf
s_nop 1
v_mfma_f32_16x16x32_bf16 v[224:227], v[220:223], v[212:215], v[224:227]
v_mfma_f32_16x16x32_bf16 v[120:123], v[164:167], v[212:215], v[120:123]
v_mfma_f32_16x16x32_bf16 v[124:127], v[168:171], v[212:215], v[124:127]
s_add_u32 s29, s33, 24576
s_nop 4
v_rcp_f32 v234, v224
s_nop 0
v_pk_mul_f32 v[120:121], v[120:121], v[234:235] op_sel_hi:[1,0]
v_pk_mul_f32 v[122:123], v[122:123], v[234:235] op_sel_hi:[1,0]
v_pk_mul_f32 v[124:125], v[124:125], v[234:235] op_sel_hi:[1,0]
v_pk_mul_f32 v[126:127], v[126:127], v[234:235] op_sel_hi:[1,0]
v_cvt_pk_bf16_f32 v212, v120, v121
v_cvt_pk_bf16_f32 v213, v122, v123
v_cvt_pk_bf16_f32 v214, v124, v125
v_cvt_pk_bf16_f32 v215, v126, v127
v_min_u32 v212, -2, v212
s_mov_b64 exec, s[40:41]
buffer_store_dwordx4 v[212:215], v11, s[84:87], s33 offen sc1
s_mov_b64 exec, -1
mega_kernel_rs_b3:
s_barrier
s_nop 15
buffer_load_dwordx4 v[32:35], v7, s[84:87], s29 offen offset:0 sc1
s_nop 9
buffer_load_dwordx4 v[36:39], v7, s[84:87], s29 offen offset:1024 sc1
s_nop 9
buffer_load_dwordx4 v[40:43], v7, s[84:87], s29 offen offset:2048 sc1
s_nop 9
buffer_load_dwordx4 v[44:47], v7, s[84:87], s29 offen offset:3072 sc1
mega_kernel_rs_pc_15_0:
s_waitcnt vmcnt(3)
v_cmp_eq_u32 vcc, -1, v32
s_cbranch_vccnz mega_kernel_rs_pc_15_0f
v_smfmac_f32_16x16x64_bf16 v[96:99], v[32:35], a[192:199], v6
v_smfmac_f32_16x16x64_bf16 v[100:103], v[32:35], a[224:231], v6
mega_kernel_rs_pc_14_1:
s_waitcnt vmcnt(2)
v_cmp_eq_u32 vcc, -1, v36
s_cbranch_vccnz mega_kernel_rs_pc_14_1f
v_smfmac_f32_16x16x64_bf16 v[96:99], v[36:39], a[200:207], v6
v_smfmac_f32_16x16x64_bf16 v[100:103], v[36:39], a[232:239], v6
mega_kernel_rs_pc_12_2:
s_waitcnt vmcnt(1)
v_cmp_eq_u32 vcc, -1, v40
s_cbranch_vccnz mega_kernel_rs_pc_12_2f
v_smfmac_f32_16x16x64_bf16 v[96:99], v[40:43], a[208:215], v6
v_smfmac_f32_16x16x64_bf16 v[100:103], v[40:43], a[240:247], v6
mega_kernel_rs_pc_8_3:
s_waitcnt vmcnt(0)
v_cmp_eq_u32 vcc, -1, v44
s_cbranch_vccnz mega_kernel_rs_pc_8_3f
v_smfmac_f32_16x16x64_bf16 v[96:99], v[44:47], a[216:223], v6
v_smfmac_f32_16x16x64_bf16 v[100:103], v[44:47], a[248:255], v6
mega_kernel_rs_pc_d:
s_nop 7
v_permlane32_swap_b32 v96, v100
v_permlane32_swap_b32 v97, v101
v_permlane32_swap_b32 v98, v102
v_permlane32_swap_b32 v99, v103
v_pk_add_f32 v[96:97], v[96:97], v[100:101]
v_pk_add_f32 v[98:99], v[98:99], v[102:103]
ds_write2_b32 v18, v96, v97 offset0:0 offset1:36
ds_write2_b32 v18, v98, v99 offset0:72 offset1:108
s_waitcnt lgkmcnt(0)
s_barrier
s_cmp_lg_u32 s24, 0
s_cbranch_scc1 mega_kernel_rs_x1
ds_read_b128 v[120:123], v19 offset:0
ds_read_b128 v[124:127], v19 offset:1152
ds_read_b128 v[128:131], v19 offset:2304
ds_read_b128 v[132:135], v19 offset:3456
s_waitcnt lgkmcnt(2)
v_pk_add_f32 v[120:121], v[120:121], v[124:125]
v_pk_add_f32 v[122:123], v[122:123], v[126:127]
s_waitcnt lgkmcnt(0)
v_pk_add_f32 v[128:129], v[128:129], v[132:133]
v_pk_add_f32 v[130:131], v[130:131], v[134:135]
v_pk_add_f32 v[120:121], v[120:121], v[128:129]
v_pk_add_f32 v[122:123], v[122:123], v[130:131]
v_fma_f32 v212, v120, s89, v120
v_cvt_pk_bf16_f32 v213, v122, v123
v_cvt_pk_bf16_f32 v212, v212, v121
v_and_or_b32 v212, v212, -2, s47
buffer_store_dwordx2 v[212:213], v12, s[84:87], s35 offen sc1
s_mov_b32 s77, 0x3f80
s_mov_b32 s78, 0x3f800000
s_xor_b32 s76, s47, 1
v_mov_b32 v48, s76
v_mov_b32 v50, s76
v_mov_b32 v52, s76
s_nop 8
v_mov_b32 v96, 0
v_mov_b32 v97, 0
v_mov_b32 v98, 0
v_mov_b32 v99, 0
v_mov_b32 v100, 0
v_mov_b32 v101, 0
v_mov_b32 v102, 0
v_mov_b32 v103, 0
v_mov_b32 v104, 0
v_mov_b32 v105, 0
v_mov_b32 v106, 0
v_mov_b32 v107, 0
v_mov_b32 v108, 0
v_mov_b32 v109, 0
v_mov_b32 v110, 0
v_mov_b32 v111, 0
v_mov_b32 v112, 0
v_mov_b32 v113, 0
v_mov_b32 v114, 0
v_mov_b32 v115, 0
v_mov_b32 v116, 0
v_mov_b32 v117, 0
v_mov_b32 v118, 0
v_mov_b32 v119, 0
s_nop 15
s_nop 7
s_cmp_eq_u32 s47, 1
s_cbranch_scc1 mega_kernel_rs_p4_1
.p2align 6
mega_kernel_rs_p4_0:
buffer_load_dwordx2 v[48:49], v25, s[84:87], s35 offen sc1
buffer_load_dwordx2 v[50:51], v26, s[84:87], s35 offen sc1
buffer_load_dwordx2 v[52:53], v27, s[84:87], s35 offen sc1
s_waitcnt vmcnt(12)
mega_kernel_rs_p4c_0:
v_bitop3_b32 v4, v48, v50, v52 bitop3:0xfe
v_and_b32 v4, 1, v4
v_cmp_ne_u32 vcc, 0, v4
s_cbranch_vccnz mega_kernel_rs_p4_0
v_dot2_f32_bf16 v120, v48, s77, v120
v_dot2_f32_bf16 v121, v48, s78, v121
v_dot2_f32_bf16 v122, v49, s77, v122
v_dot2_f32_bf16 v123, v49, s78, v123
v_dot2_f32_bf16 v120, v50, s77, v120
v_dot2_f32_bf16 v121, v50, s78, v121
v_dot2_f32_bf16 v122, v51, s77, v122
v_dot2_f32_bf16 v123, v51, s78, v123
v_dot2_f32_bf16 v120, v52, s77, v120
v_dot2_f32_bf16 v121, v52, s78, v121
v_dot2_f32_bf16 v122, v53, s77, v122
v_dot2_f32_bf16 v123, v53, s78, v123
s_nop 0
v_cvt_pk_bf16_f32 v212, v120, v121
v_min_u32 v212, -2, v212
v_cvt_pk_bf16_f32 v213, v122, v123
buffer_store_dwordx2 v[212:213], v9, s[84:87], s34 offen sc1
s_branch mega_kernel_rs_p4d
mega_kernel_rs_iw0:
mega_kernel_rs_il0:
s_cbranch_execz mega_kernel_rs_il1
.p2align 6
mega_kernel_rs_p4_1:
buffer_load_dwordx2 v[48:49], v25, s[84:87], s35 offen sc1
buffer_load_dwordx2 v[50:51], v26, s[84:87], s35 offen sc1
buffer_load_dwordx2 v[52:53], v27, s[84:87], s35 offen sc1
s_waitcnt vmcnt(12)
mega_kernel_rs_p4c_1:
v_bitop3_b32 v4, v48, v50, v52 bitop3:0x80
v_and_b32 v4, 1, v4
v_cmp_ne_u32 vcc, 1, v4
s_cbranch_vccnz mega_kernel_rs_p4_1
v_dot2_f32_bf16 v120, v48, s77, v120
v_dot2_f32_bf16 v121, v48, s78, v121
v_dot2_f32_bf16 v122, v49, s77, v122
v_dot2_f32_bf16 v123, v49, s78, v123
v_dot2_f32_bf16 v120, v50, s77, v120
v_dot2_f32_bf16 v121, v50, s78, v121
v_dot2_f32_bf16 v122, v51, s77, v122
v_dot2_f32_bf16 v123, v51, s78, v123
v_dot2_f32_bf16 v120, v52, s77, v120
v_dot2_f32_bf16 v121, v52, s78, v121
v_dot2_f32_bf16 v122, v53, s77, v122
v_dot2_f32_bf16 v123, v53, s78, v123
s_nop 0
v_cvt_pk_bf16_f32 v212, v120, v121
v_min_u32 v212, -2, v212
v_cvt_pk_bf16_f32 v213, v122, v123
buffer_store_dwordx2 v[212:213], v9, s[84:87], s34 offen sc1
mega_kernel_rs_p4d:
mega_kernel_rs_b5:
s_add_u32 s27, s27, 1
s_add_u32 s44, s44, 4096
s_cmp_eq_u32 s44, 30720
s_cselect_b32 s44, 18432, s44
s_mov_b32 s28, s33
s_mov_b32 s33, s34
s_mov_b32 s34, s28
s_xor_b32 s35, s35, 262144
s_bfe_u32 s47, s27, 0x10001
s_barrier
s_nop 15
s_branch mega_kernel_rs_loop
mega_kernel_rs_il1:
s_cbranch_execz mega_kernel_rs_il2
mega_kernel_rs_x1:
s_cmp_eq_u32 s24, 1
s_cbranch_scc0 mega_kernel_rs_x2
s_add_u32 s76, s27, 1
s_sleep 6
v_mov_b32 v5, s76
s_mov_b64 exec, 1
buffer_store_dword v5, v228, s[84:87], s81 offen sc1
s_mov_b64 exec, -1
mega_kernel_rs_x2:
s_cmp_eq_u32 s24, 3
s_cbranch_scc0 mega_kernel_rs_x4
s_cmp_eq_u32 s36, 1
s_cbranch_scc0 mega_kernel_rs_x5
s_add_u32 s76, s27, 1
s_cmp_gt_i32 s46, s76
s_cbranch_scc1 mega_kernel_rs_pf1ok
mega_kernel_rs_pf1w:
v_mov_b32 v4, 0
s_mov_b64 exec, 3
buffer_atomic_add v4, v24, s[84:87], 0 offen sc0 sc1
s_mov_b64 exec, -1
s_waitcnt vmcnt(0)
v_readlane_b32 s46, v4, 0
v_readlane_b32 s28, v4, 1
s_nop 1
s_min_i32 s46, s46, s28
s_cmp_gt_i32 s46, s76
s_cbranch_scc0 mega_kernel_rs_pf1w
mega_kernel_rs_pf1ok:
s_add_u32 s77, s76, s82
s_bfe_u32 s28, s77, 0x40002
s_lshl_b32 s28, s28, 14
s_and_b32 s77, s77, 3
s_lshl_b32 s77, s77, 11
s_add_u32 s28, s28, s77
s_add_u32 m0, s45, 0
s_nop 0
buffer_load_dwordx4 v240, s[84:87], s28 offen offset:0 sc1 lds
s_add_u32 m0, s45, 0
s_nop 0
buffer_load_dwordx4 v240, s[84:87], s28 offen offset:1024 sc1 lds
s_add_u32 m0, s45, 2048
s_nop 0
buffer_load_dwordx4 v241, s[84:87], s28 offen offset:0 sc1 lds
s_add_u32 m0, s45, 2048
s_nop 0
buffer_load_dwordx4 v241, s[84:87], s28 offen offset:1024 sc1 lds
s_add_u32 s45, s45, 4096
s_cmp_eq_u32 s45, 30720
s_cselect_b32 s45, 18432, s45
s_waitcnt vmcnt(0)
mega_kernel_rs_x5:
s_add_u32 s76, s27, 4
s_min_u32 s76, s76, 63
s_cmp_gt_i32 s46, s76
s_cbranch_scc1 mega_kernel_rs_x6
v_mov_b32 v249, 0
s_mov_b64 exec, 3
buffer_atomic_add v249, v24, s[84:87], 0 offen sc0 sc1
s_mov_b64 exec, -1
mega_kernel_rs_x6:
s_add_u32 s76, s27, 2
s_cmp_lt_u32 s76, 63
s_cbranch_scc0 mega_kernel_rs_x4
s_cmp_gt_i32 s46, s76
s_cbranch_scc0 mega_kernel_rs_x4
s_add_u32 s77, s76, s82
s_bfe_u32 s28, s77, 0x40002
s_lshl_b32 s28, s28, 14
s_and_b32 s77, s77, 3
s_lshl_b32 s77, s77, 11
s_add_u32 s28, s28, s77
s_add_u32 s28, s28, s83
s_add_u32 s28, s28, 33554432
s_buffer_load_dword s78, s[84:87], s28 offset:0
s_buffer_load_dword s78, s[84:87], s28 offset:128
s_buffer_load_dword s78, s[84:87], s28 offset:256
s_buffer_load_dword s78, s[84:87], s28 offset:384
s_buffer_load_dword s78, s[84:87], s28 offset:512
s_buffer_load_dword s78, s[84:87], s28 offset:640
s_buffer_load_dword s78, s[84:87], s28 offset:768
s_buffer_load_dword s78, s[84:87], s28 offset:896
s_buffer_load_dword s78, s[84:87], s28 offset:1024
s_buffer_load_dword s78, s[84:87], s28 offset:1152
s_buffer_load_dword s78, s[84:87], s28 offset:1280
s_buffer_load_dword s78, s[84:87], s28 offset:1408
s_buffer_load_dword s78, s[84:87], s28 offset:1536
s_buffer_load_dword s78, s[84:87], s28 offset:1664
s_buffer_load_dword s78, s[84:87], s28 offset:1792
s_buffer_load_dword s78, s[84:87], s28 offset:1920
mega_kernel_rs_x4:
v_mov_b32 v96, 0
v_mov_b32 v97, 0
v_mov_b32 v98, 0
v_mov_b32 v99, 0
v_mov_b32 v100, 0
v_mov_b32 v101, 0
v_mov_b32 v102, 0
v_mov_b32 v103, 0
v_mov_b32 v104, 0
v_mov_b32 v105, 0
v_mov_b32 v106, 0
v_mov_b32 v107, 0
v_mov_b32 v108, 0
v_mov_b32 v109, 0
v_mov_b32 v110, 0
v_mov_b32 v111, 0
v_mov_b32 v112, 0
v_mov_b32 v113, 0
v_mov_b32 v114, 0
v_mov_b32 v115, 0
v_mov_b32 v116, 0
v_mov_b32 v117, 0
v_mov_b32 v118, 0
v_mov_b32 v119, 0
s_branch mega_kernel_rs_b5
mega_kernel_rs_il2:
s_cbranch_execz mega_kernel_rs_il3
mega_kernel_rs_p2r:
s_mov_b64 exec, s[42:43]
buffer_load_dwordx4 v[188:191], v10, s[84:87], s76 offen sc1
buffer_load_dwordx4 v[196:199], v10, s[84:87], s77 offen sc1
buffer_load_dwordx4 v[204:207], v10, s[84:87], s78 offen sc1
s_mov_b64 exec, -1
buffer_load_dwordx4 v[184:187], v17, s[84:87], s76 offen sc1
buffer_load_dwordx4 v[192:195], v17, s[84:87], s77 offen sc1
buffer_load_dwordx4 v[200:203], v17, s[84:87], s78 offen sc1
s_branch mega_kernel_rs_p2
mega_kernel_rs_il3:
s_cbranch_execz mega_kernel_rs_il4
.p2align 5
mega_kernel_rs_pa_1_0f:
s_mov_b64 exec, vcc
buffer_load_dwordx4 v[32:35], v7, s[84:87], s33 offen offset:0 sc1
s_mov_b64 exec, -1
s_branch mega_kernel_rs_pa_1_0
.p2align 5
mega_kernel_rs_pa_1_0:
s_waitcnt vmcnt(0)
v_max_u32 v4, v32, v34
v_cmp_eq_u32 vcc, -1, v4
s_cbranch_vccnz mega_kernel_rs_pa_1_0f
v_smfmac_f32_16x16x64_bf16 v[96:99], v[32:35], a[0:7], v6
v_smfmac_f32_16x16x64_bf16 v[100:103], v[32:35], a[32:39], v6
v_smfmac_f32_16x16x64_bf16 v[104:107], v[32:35], a[64:71], v6
v_smfmac_f32_16x16x64_bf16 v[108:111], v[32:35], a[96:103], v6
s_branch mega_kernel_rs_pa_d
mega_kernel_rs_il4:
s_cbranch_execz mega_kernel_rs_il5
.p2align 5
mega_kernel_rs_pa_2_1f:
s_mov_b64 exec, vcc
buffer_load_dwordx4 v[36:39], v7, s[84:87], s33 offen offset:1024 sc1
s_mov_b64 exec, -1
s_branch mega_kernel_rs_pa_2_1
.p2align 5
mega_kernel_rs_pa_2_1:
s_waitcnt vmcnt(0)
v_max_u32 v4, v36, v38
v_cmp_eq_u32 vcc, -1, v4
s_cbranch_vccnz mega_kernel_rs_pa_2_1f
v_smfmac_f32_16x16x64_bf16 v[96:99], v[36:39], a[8:15], v6
v_smfmac_f32_16x16x64_bf16 v[100:103], v[36:39], a[40:47], v6
v_smfmac_f32_16x16x64_bf16 v[104:107], v[36:39], a[72:79], v6
v_smfmac_f32_16x16x64_bf16 v[108:111], v[36:39], a[104:111], v6
s_branch mega_kernel_rs_pa_d
mega_kernel_rs_il5:
s_cbranch_execz mega_kernel_rs_il6
.p2align 5
mega_kernel_rs_pa_3_0f:
s_mov_b64 exec, vcc
buffer_load_dwordx4 v[32:35], v7, s[84:87], s33 offen offset:0 sc1
s_mov_b64 exec, -1
s_branch mega_kernel_rs_pa_3_1
.p2align 5
mega_kernel_rs_pa_3_0:
s_waitcnt vmcnt(1)
v_max_u32 v4, v32, v34
v_cmp_eq_u32 vcc, -1, v4
s_cbranch_vccnz mega_kernel_rs_pa_3_0f
v_smfmac_f32_16x16x64_bf16 v[96:99], v[32:35], a[0:7], v6
v_smfmac_f32_16x16x64_bf16 v[100:103], v[32:35], a[32:39], v6
v_smfmac_f32_16x16x64_bf16 v[104:107], v[32:35], a[64:71], v6
v_smfmac_f32_16x16x64_bf16 v[108:111], v[32:35], a[96:103], v6
s_branch mega_kernel_rs_pa_2_1
mega_kernel_rs_il6:
s_cbranch_execz mega_kernel_rs_il7
.p2align 5
mega_kernel_rs_pa_3_1f:
s_mov_b64 exec, vcc
buffer_load_dwordx4 v[36:39], v7, s[84:87], s33 offen offset:1024 sc1
s_mov_b64 exec, -1
s_branch mega_kernel_rs_pa_3_0
.p2align 5
mega_kernel_rs_pa_3_1:
s_waitcnt vmcnt(1)
v_max_u32 v4, v36, v38
v_cmp_eq_u32 vcc, -1, v4
s_cbranch_vccnz mega_kernel_rs_pa_3_1f
v_smfmac_f32_16x16x64_bf16 v[96:99], v[36:39], a[8:15], v6
v_smfmac_f32_16x16x64_bf16 v[100:103], v[36:39], a[40:47], v6
v_smfmac_f32_16x16x64_bf16 v[104:107], v[36:39], a[72:79], v6
v_smfmac_f32_16x16x64_bf16 v[108:111], v[36:39], a[104:111], v6
s_branch mega_kernel_rs_pa_1_0
mega_kernel_rs_il7:
s_cbranch_execz mega_kernel_rs_il8
.p2align 5
mega_kernel_rs_pa_4_2f:
s_mov_b64 exec, vcc
buffer_load_dwordx4 v[40:43], v7, s[84:87], s33 offen offset:2048 sc1
s_mov_b64 exec, -1
s_branch mega_kernel_rs_pa_4_2
.p2align 5
mega_kernel_rs_pa_4_2:
s_waitcnt vmcnt(0)
v_max_u32 v4, v40, v42
v_cmp_eq_u32 vcc, -1, v4
s_cbranch_vccnz mega_kernel_rs_pa_4_2f
v_smfmac_f32_16x16x64_bf16 v[96:99], v[40:43], a[16:23], v6
v_smfmac_f32_16x16x64_bf16 v[100:103], v[40:43], a[48:55], v6
v_smfmac_f32_16x16x64_bf16 v[104:107], v[40:43], a[80:87], v6
v_smfmac_f32_16x16x64_bf16 v[108:111], v[40:43], a[112:119], v6
s_branch mega_kernel_rs_pa_d
mega_kernel_rs_il8:
s_cbranch_execz mega_kernel_rs_il9
.p2align 5
mega_kernel_rs_pa_5_0f:
s_mov_b64 exec, vcc
buffer_load_dwordx4 v[32:35], v7, s[84:87], s33 offen offset:0 sc1
s_mov_b64 exec, -1
s_branch mega_kernel_rs_pa_5_2
.p2align 5
mega_kernel_rs_pa_5_0:
s_waitcnt vmcnt(1)
v_max_u32 v4, v32, v34
v_cmp_eq_u32 vcc, -1, v4
s_cbranch_vccnz mega_kernel_rs_pa_5_0f
v_smfmac_f32_16x16x64_bf16 v[96:99], v[32:35], a[0:7], v6
v_smfmac_f32_16x16x64_bf16 v[100:103], v[32:35], a[32:39], v6
v_smfmac_f32_16x16x64_bf16 v[104:107], v[32:35], a[64:71], v6
v_smfmac_f32_16x16x64_bf16 v[108:111], v[32:35], a[96:103], v6
s_branch mega_kernel_rs_pa_4_2
mega_kernel_rs_il9:
s_cbranch_execz mega_kernel_rs_il10
.p2align 5
mega_kernel_rs_pa_5_2f:
s_mov_b64 exec, vcc
buffer_load_dwordx4 v[40:43], v7, s[84:87], s33 offen offset:2048 sc1
s_mov_b64 exec, -1
s_branch mega_kernel_rs_pa_5_0
.p2align 5
mega_kernel_rs_pa_5_2:
s_waitcnt vmcnt(1)
v_max_u32 v4, v40, v42
v_cmp_eq_u32 vcc, -1, v4
s_cbranch_vccnz mega_kernel_rs_pa_5_2f
v_smfmac_f32_16x16x64_bf16 v[96:99], v[40:43], a[16:23], v6
v_smfmac_f32_16x16x64_bf16 v[100:103], v[40:43], a[48:55], v6
v_smfmac_f32_16x16x64_bf16 v[104:107], v[40:43], a[80:87], v6
v_smfmac_f32_16x16x64_bf16 v[108:111], v[40:43], a[112:119], v6
s_branch mega_kernel_rs_pa_1_0
mega_kernel_rs_il10:
s_cbranch_execz mega_kernel_rs_il11
.p2align 5
mega_kernel_rs_pa_6_1f:
s_mov_b64 exec, vcc
buffer_load_dwordx4 v[36:39], v7, s[84:87], s33 offen offset:1024 sc1
s_mov_b64 exec, -1
s_branch mega_kernel_rs_pa_6_2
.p2align 5
mega_kernel_rs_pa_6_1:
s_waitcnt vmcnt(1)
v_max_u32 v4, v36, v38
v_cmp_eq_u32 vcc, -1, v4
s_cbranch_vccnz mega_kernel_rs_pa_6_1f
v_smfmac_f32_16x16x64_bf16 v[96:99], v[36:39], a[8:15], v6
v_smfmac_f32_16x16x64_bf16 v[100:103], v[36:39], a[40:47], v6
v_smfmac_f32_16x16x64_bf16 v[104:107], v[36:39], a[72:79], v6
v_smfmac_f32_16x16x64_bf16 v[108:111], v[36:39], a[104:111], v6
s_branch mega_kernel_rs_pa_4_2
mega_kernel_rs_il11:
s_cbranch_execz mega_kernel_rs_il12
.p2align 5
mega_kernel_rs_pa_6_2f:
s_mov_b64 exec, vcc
buffer_load_dwordx4 v[40:43], v7, s[84:87], s33 offen offset:2048 sc1
s_mov_b64 exec, -1
s_branch mega_kernel_rs_pa_6_1
.p2align 5
mega_kernel_rs_pa_6_2:
s_waitcnt vmcnt(1)
v_max_u32 v4, v40, v42
v_cmp_eq_u32 vcc, -1, v4
s_cbranch_vccnz mega_kernel_rs_pa_6_2f
v_smfmac_f32_16x16x64_bf16 v[96:99], v[40:43], a[16:23], v6
v_smfmac_f32_16x16x64_bf16 v[100:103], v[40:43], a[48:55], v6
v_smfmac_f32_16x16x64_bf16 v[104:107], v[40:43], a[80:87], v6
v_smfmac_f32_16x16x64_bf16 v[108:111], v[40:43], a[112:119], v6
s_branch mega_kernel_rs_pa_2_1
mega_kernel_rs_il12:
s_cbranch_execz mega_kernel_rs_il13
.p2align 5
mega_kernel_rs_pa_7_0f:
s_mov_b64 exec, vcc
buffer_load_dwordx4 v[32:35], v7, s[84:87], s33 offen offset:0 sc1
s_mov_b64 exec, -1
s_branch mega_kernel_rs_pa_7_1
.p2align 5
mega_kernel_rs_pa_7_0:
s_waitcnt vmcnt(2)
v_max_u32 v4, v32, v34
v_cmp_eq_u32 vcc, -1, v4
s_cbranch_vccnz mega_kernel_rs_pa_7_0f
v_smfmac_f32_16x16x64_bf16 v[96:99], v[32:35], a[0:7], v6
v_smfmac_f32_16x16x64_bf16 v[100:103], v[32:35], a[32:39], v6
v_smfmac_f32_16x16x64_bf16 v[104:107], v[32:35], a[64:71], v6
v_smfmac_f32_16x16x64_bf16 v[108:111], v[32:35], a[96:103], v6
s_branch mega_kernel_rs_pa_6_1
mega_kernel_rs_il13:
s_cbranch_execz mega_kernel_rs_il14
.p2align 5
mega_kernel_rs_pa_7_1f:
s_mov_b64 exec, vcc
buffer_load_dwordx4 v[36:39], v7, s[84:87], s33 offen offset:1024 sc1
s_mov_b64 exec, -1
s_branch mega_kernel_rs_pa_7_2
.p2align 5
mega_kernel_rs_pa_7_1:
s_waitcnt vmcnt(2)
v_max_u32 v4, v36, v38
v_cmp_eq_u32 vcc, -1, v4
s_cbranch_vccnz mega_kernel_rs_pa_7_1f
v_smfmac_f32_16x16x64_bf16 v[96:99], v[36:39], a[8:15], v6
v_smfmac_f32_16x16x64_bf16 v[100:103], v[36:39], a[40:47], v6
v_smfmac_f32_16x16x64_bf16 v[104:107], v[36:39], a[72:79], v6
v_smfmac_f32_16x16x64_bf16 v[108:111], v[36:39], a[104:111], v6
s_branch mega_kernel_rs_pa_5_2
mega_kernel_rs_il14:
s_cbranch_execz mega_kernel_rs_il15
.p2align 5
mega_kernel_rs_pa_7_2f:
s_mov_b64 exec, vcc
buffer_load_dwordx4 v[40:43], v7, s[84:87], s33 offen offset:2048 sc1
s_mov_b64 exec, -1
s_branch mega_kernel_rs_pa_7_0
.p2align 5
mega_kernel_rs_pa_7_2:
s_waitcnt vmcnt(2)
v_max_u32 v4, v40, v42
v_cmp_eq_u32 vcc, -1, v4
s_cbranch_vccnz mega_kernel_rs_pa_7_2f
v_smfmac_f32_16x16x64_bf16 v[96:99], v[40:43], a[16:23], v6
v_smfmac_f32_16x16x64_bf16 v[100:103], v[40:43], a[48:55], v6
v_smfmac_f32_16x16x64_bf16 v[104:107], v[40:43], a[80:87], v6
v_smfmac_f32_16x16x64_bf16 v[108:111], v[40:43], a[112:119], v6
s_branch mega_kernel_rs_pa_3_0
mega_kernel_rs_il15:
s_cbranch_execz mega_kernel_rs_il16
.p2align 5
mega_kernel_rs_pa_8_3f:
s_mov_b64 exec, vcc
buffer_load_dwordx4 v[44:47], v7, s[84:87], s33 offen offset:3072 sc1
s_mov_b64 exec, -1
s_branch mega_kernel_rs_pa_8_3
.p2align 5
mega_kernel_rs_pa_8_3:
s_waitcnt vmcnt(0)
v_max_u32 v4, v44, v46
v_cmp_eq_u32 vcc, -1, v4
s_cbranch_vccnz mega_kernel_rs_pa_8_3f
v_smfmac_f32_16x16x64_bf16 v[96:99], v[44:47], a[24:31], v6
v_smfmac_f32_16x16x64_bf16 v[100:103], v[44:47], a[56:63], v6
v_smfmac_f32_16x16x64_bf16 v[104:107], v[44:47], a[88:95], v6
v_smfmac_f32_16x16x64_bf16 v[108:111], v[44:47], a[120:127], v6
s_branch mega_kernel_rs_pa_d
mega_kernel_rs_il16:
s_cbranch_execz mega_kernel_rs_il17
.p2align 5
mega_kernel_rs_pa_9_0f:
s_mov_b64 exec, vcc
buffer_load_dwordx4 v[32:35], v7, s[84:87], s33 offen offset:0 sc1
s_mov_b64 exec, -1
s_branch mega_kernel_rs_pa_9_3
.p2align 5
mega_kernel_rs_pa_9_0:
s_waitcnt vmcnt(1)
v_max_u32 v4, v32, v34
v_cmp_eq_u32 vcc, -1, v4
s_cbranch_vccnz mega_kernel_rs_pa_9_0f
v_smfmac_f32_16x16x64_bf16 v[96:99], v[32:35], a[0:7], v6
v_smfmac_f32_16x16x64_bf16 v[100:103], v[32:35], a[32:39], v6
v_smfmac_f32_16x16x64_bf16 v[104:107], v[32:35], a[64:71], v6
v_smfmac_f32_16x16x64_bf16 v[108:111], v[32:35], a[96:103], v6
s_branch mega_kernel_rs_pa_8_3
mega_kernel_rs_il17:
s_cbranch_execz mega_kernel_rs_il18
.p2align 5
mega_kernel_rs_pa_9_3f:
s_mov_b64 exec, vcc
buffer_load_dwordx4 v[44:47], v7, s[84:87], s33 offen offset:3072 sc1
s_mov_b64 exec, -1
s_branch mega_kernel_rs_pa_9_0
.p2align 5
mega_kernel_rs_pa_9_3:
s_waitcnt vmcnt(1)
v_max_u32 v4, v44, v46
v_cmp_eq_u32 vcc, -1, v4
s_cbranch_vccnz mega_kernel_rs_pa_9_3f
v_smfmac_f32_16x16x64_bf16 v[96:99], v[44:47], a[24:31], v6
v_smfmac_f32_16x16x64_bf16 v[100:103], v[44:47], a[56:63], v6
v_smfmac_f32_16x16x64_bf16 v[104:107], v[44:47], a[88:95], v6
v_smfmac_f32_16x16x64_bf16 v[108:111], v[44:47], a[120:127], v6
s_branch mega_kernel_rs_pa_1_0
mega_kernel_rs_il18:
s_cbranch_execz mega_kernel_rs_iwd
.p2align 5
mega_kernel_rs_pa_10_1f:
s_mov_b64 exec, vcc
buffer_load_dwordx4 v[36:39], v7, s[84:87], s33 offen offset:1024 sc1
s_mov_b64 exec, -1
s_branch mega_kernel_rs_pa_10_3
.p2align 5
mega_kernel_rs_pa_10_1:
s_waitcnt vmcnt(1)
v_max_u32 v4, v36, v38
v_cmp_eq_u32 vcc, -1, v4
s_cbranch_vccnz mega_kernel_rs_pa_10_1f
v_smfmac_f32_16x16x64_bf16 v[96:99], v[36:39], a[8:15], v6
v_smfmac_f32_16x16x64_bf16 v[100:103], v[36:39], a[40:47], v6
v_smfmac_f32_16x16x64_bf16 v[104:107], v[36:39], a[72:79], v6
v_smfmac_f32_16x16x64_bf16 v[108:111], v[36:39], a[104:111], v6
s_branch mega_kernel_rs_pa_8_3
mega_kernel_rs_iw1:
mega_kernel_rs_il19:
s_cbranch_execz mega_kernel_rs_il20
.p2align 5
mega_kernel_rs_pa_10_3f:
s_mov_b64 exec, vcc
buffer_load_dwordx4 v[44:47], v7, s[84:87], s33 offen offset:3072 sc1
s_mov_b64 exec, -1
s_branch mega_kernel_rs_pa_10_1
.p2align 5
mega_kernel_rs_pa_10_3:
s_waitcnt vmcnt(1)
v_max_u32 v4, v44, v46
v_cmp_eq_u32 vcc, -1, v4
s_cbranch_vccnz mega_kernel_rs_pa_10_3f
v_smfmac_f32_16x16x64_bf16 v[96:99], v[44:47], a[24:31], v6
v_smfmac_f32_16x16x64_bf16 v[100:103], v[44:47], a[56:63], v6
v_smfmac_f32_16x16x64_bf16 v[104:107], v[44:47], a[88:95], v6
v_smfmac_f32_16x16x64_bf16 v[108:111], v[44:47], a[120:127], v6
s_branch mega_kernel_rs_pa_2_1
mega_kernel_rs_il20:
s_cbranch_execz mega_kernel_rs_il21
.p2align 5
mega_kernel_rs_pa_11_0f:
s_mov_b64 exec, vcc
buffer_load_dwordx4 v[32:35], v7, s[84:87], s33 offen offset:0 sc1
s_mov_b64 exec, -1
s_branch mega_kernel_rs_pa_11_1
.p2align 5
mega_kernel_rs_pa_11_0:
s_waitcnt vmcnt(2)
v_max_u32 v4, v32, v34
v_cmp_eq_u32 vcc, -1, v4
s_cbranch_vccnz mega_kernel_rs_pa_11_0f
v_smfmac_f32_16x16x64_bf16 v[96:99], v[32:35], a[0:7], v6
v_smfmac_f32_16x16x64_bf16 v[100:103], v[32:35], a[32:39], v6
v_smfmac_f32_16x16x64_bf16 v[104:107], v[32:35], a[64:71], v6
v_smfmac_f32_16x16x64_bf16 v[108:111], v[32:35], a[96:103], v6
s_branch mega_kernel_rs_pa_10_1
mega_kernel_rs_il21:
s_cbranch_execz mega_kernel_rs_il22
.p2align 5
mega_kernel_rs_pa_11_1f:
s_mov_b64 exec, vcc
buffer_load_dwordx4 v[36:39], v7, s[84:87], s33 offen offset:1024 sc1
s_mov_b64 exec, -1
s_branch mega_kernel_rs_pa_11_3
.p2align 5
mega_kernel_rs_pa_11_1:
s_waitcnt vmcnt(2)
v_max_u32 v4, v36, v38
v_cmp_eq_u32 vcc, -1, v4
s_cbranch_vccnz mega_kernel_rs_pa_11_1f
v_smfmac_f32_16x16x64_bf16 v[96:99], v[36:39], a[8:15], v6
v_smfmac_f32_16x16x64_bf16 v[100:103], v[36:39], a[40:47], v6
v_smfmac_f32_16x16x64_bf16 v[104:107], v[36:39], a[72:79], v6
v_smfmac_f32_16x16x64_bf16 v[108:111], v[36:39], a[104:111], v6
s_branch mega_kernel_rs_pa_9_3
mega_kernel_rs_il22:
s_cbranch_execz mega_kernel_rs_il23
.p2align 5
mega_kernel_rs_pa_11_3f:
s_mov_b64 exec, vcc
buffer_load_dwordx4 v[44:47], v7, s[84:87], s33 offen offset:3072 sc1
s_mov_b64 exec, -1
s_branch mega_kernel_rs_pa_11_0
.p2align 5
mega_kernel_rs_pa_11_3:
s_waitcnt vmcnt(2)
v_max_u32 v4, v44, v46
v_cmp_eq_u32 vcc, -1, v4
s_cbranch_vccnz mega_kernel_rs_pa_11_3f
v_smfmac_f32_16x16x64_bf16 v[96:99], v[44:47], a[24:31], v6
v_smfmac_f32_16x16x64_bf16 v[100:103], v[44:47], a[56:63], v6
v_smfmac_f32_16x16x64_bf16 v[104:107], v[44:47], a[88:95], v6
v_smfmac_f32_16x16x64_bf16 v[108:111], v[44:47], a[120:127], v6
s_branch mega_kernel_rs_pa_3_0
mega_kernel_rs_il23:
s_cbranch_execz mega_kernel_rs_il24
.p2align 5
mega_kernel_rs_pa_12_2f:
s_mov_b64 exec, vcc
buffer_load_dwordx4 v[40:43], v7, s[84:87], s33 offen offset:2048 sc1
s_mov_b64 exec, -1
s_branch mega_kernel_rs_pa_12_3
.p2align 5
mega_kernel_rs_pa_12_2:
s_waitcnt vmcnt(1)
v_max_u32 v4, v40, v42
v_cmp_eq_u32 vcc, -1, v4
s_cbranch_vccnz mega_kernel_rs_pa_12_2f
v_smfmac_f32_16x16x64_bf16 v[96:99], v[40:43], a[16:23], v6
v_smfmac_f32_16x16x64_bf16 v[100:103], v[40:43], a[48:55], v6
v_smfmac_f32_16x16x64_bf16 v[104:107], v[40:43], a[80:87], v6
v_smfmac_f32_16x16x64_bf16 v[108:111], v[40:43], a[112:119], v6
s_branch mega_kernel_rs_pa_8_3
mega_kernel_rs_il24:
s_cbranch_execz mega_kernel_rs_il25
.p2align 5
mega_kernel_rs_pa_12_3f:
s_mov_b64 exec, vcc
buffer_load_dwordx4 v[44:47], v7, s[84:87], s33 offen offset:3072 sc1
s_mov_b64 exec, -1
s_branch mega_kernel_rs_pa_12_2
.p2align 5
mega_kernel_rs_pa_12_3:
s_waitcnt vmcnt(1)
v_max_u32 v4, v44, v46
v_cmp_eq_u32 vcc, -1, v4
s_cbranch_vccnz mega_kernel_rs_pa_12_3f
v_smfmac_f32_16x16x64_bf16 v[96:99], v[44:47], a[24:31], v6
v_smfmac_f32_16x16x64_bf16 v[100:103], v[44:47], a[56:63], v6
v_smfmac_f32_16x16x64_bf16 v[104:107], v[44:47], a[88:95], v6
v_smfmac_f32_16x16x64_bf16 v[108:111], v[44:47], a[120:127], v6
s_branch mega_kernel_rs_pa_4_2
mega_kernel_rs_il25:
s_cbranch_execz mega_kernel_rs_il26
.p2align 5
mega_kernel_rs_pa_13_0f:
s_mov_b64 exec, vcc
buffer_load_dwordx4 v[32:35], v7, s[84:87], s33 offen offset:0 sc1
s_mov_b64 exec, -1
s_branch mega_kernel_rs_pa_13_2
.p2align 5
mega_kernel_rs_pa_13_0:
s_waitcnt vmcnt(2)
v_max_u32 v4, v32, v34
v_cmp_eq_u32 vcc, -1, v4
s_cbranch_vccnz mega_kernel_rs_pa_13_0f
v_smfmac_f32_16x16x64_bf16 v[96:99], v[32:35], a[0:7], v6
v_smfmac_f32_16x16x64_bf16 v[100:103], v[32:35], a[32:39], v6
v_smfmac_f32_16x16x64_bf16 v[104:107], v[32:35], a[64:71], v6
v_smfmac_f32_16x16x64_bf16 v[108:111], v[32:35], a[96:103], v6
s_branch mega_kernel_rs_pa_12_2
mega_kernel_rs_il26:
s_cbranch_execz mega_kernel_rs_il27
.p2align 5
mega_kernel_rs_pa_13_2f:
s_mov_b64 exec, vcc
buffer_load_dwordx4 v[40:43], v7, s[84:87], s33 offen offset:2048 sc1
s_mov_b64 exec, -1
s_branch mega_kernel_rs_pa_13_3
.p2align 5
mega_kernel_rs_pa_13_2:
s_waitcnt vmcnt(2)
v_max_u32 v4, v40, v42
v_cmp_eq_u32 vcc, -1, v4
s_cbranch_vccnz mega_kernel_rs_pa_13_2f
v_smfmac_f32_16x16x64_bf16 v[96:99], v[40:43], a[16:23], v6
v_smfmac_f32_16x16x64_bf16 v[100:103], v[40:43], a[48:55], v6
v_smfmac_f32_16x16x64_bf16 v[104:107], v[40:43], a[80:87], v6
v_smfmac_f32_16x16x64_bf16 v[108:111], v[40:43], a[112:119], v6
s_branch mega_kernel_rs_pa_9_3
mega_kernel_rs_il27:
s_cbranch_execz mega_kernel_rs_il28
.p2align 5
mega_kernel_rs_pa_13_3f:
s_mov_b64 exec, vcc
buffer_load_dwordx4 v[44:47], v7, s[84:87], s33 offen offset:3072 sc1
s_mov_b64 exec, -1
s_branch mega_kernel_rs_pa_13_0
.p2align 5
mega_kernel_rs_pa_13_3:
s_waitcnt vmcnt(2)
v_max_u32 v4, v44, v46
v_cmp_eq_u32 vcc, -1, v4
s_cbranch_vccnz mega_kernel_rs_pa_13_3f
v_smfmac_f32_16x16x64_bf16 v[96:99], v[44:47], a[24:31], v6
v_smfmac_f32_16x16x64_bf16 v[100:103], v[44:47], a[56:63], v6
v_smfmac_f32_16x16x64_bf16 v[104:107], v[44:47], a[88:95], v6
v_smfmac_f32_16x16x64_bf16 v[108:111], v[44:47], a[120:127], v6
s_branch mega_kernel_rs_pa_5_0
mega_kernel_rs_il28:
s_cbranch_execz mega_kernel_rs_il29
.p2align 5
mega_kernel_rs_pa_14_1f:
s_mov_b64 exec, vcc
buffer_load_dwordx4 v[36:39], v7, s[84:87], s33 offen offset:1024 sc1
s_mov_b64 exec, -1
s_branch mega_kernel_rs_pa_14_2
.p2align 5
mega_kernel_rs_pa_14_1:
s_waitcnt vmcnt(2)
v_max_u32 v4, v36, v38
v_cmp_eq_u32 vcc, -1, v4
s_cbranch_vccnz mega_kernel_rs_pa_14_1f
v_smfmac_f32_16x16x64_bf16 v[96:99], v[36:39], a[8:15], v6
v_smfmac_f32_16x16x64_bf16 v[100:103], v[36:39], a[40:47], v6
v_smfmac_f32_16x16x64_bf16 v[104:107], v[36:39], a[72:79], v6
v_smfmac_f32_16x16x64_bf16 v[108:111], v[36:39], a[104:111], v6
s_branch mega_kernel_rs_pa_12_2
mega_kernel_rs_il29:
s_cbranch_execz mega_kernel_rs_il30
.p2align 5
mega_kernel_rs_pa_14_2f:
s_mov_b64 exec, vcc
buffer_load_dwordx4 v[40:43], v7, s[84:87], s33 offen offset:2048 sc1
s_mov_b64 exec, -1
s_branch mega_kernel_rs_pa_14_3
.p2align 5
mega_kernel_rs_pa_14_2:
s_waitcnt vmcnt(2)
v_max_u32 v4, v40, v42
v_cmp_eq_u32 vcc, -1, v4
s_cbranch_vccnz mega_kernel_rs_pa_14_2f
v_smfmac_f32_16x16x64_bf16 v[96:99], v[40:43], a[16:23], v6
v_smfmac_f32_16x16x64_bf16 v[100:103], v[40:43], a[48:55], v6
v_smfmac_f32_16x16x64_bf16 v[104:107], v[40:43], a[80:87], v6
v_smfmac_f32_16x16x64_bf16 v[108:111], v[40:43], a[112:119], v6
s_branch mega_kernel_rs_pa_10_3
mega_kernel_rs_il30:
s_cbranch_execz mega_kernel_rs_il31
.p2align 5
mega_kernel_rs_pa_14_3f:
s_mov_b64 exec, vcc
buffer_load_dwordx4 v[44:47], v7, s[84:87], s33 offen offset:3072 sc1
s_mov_b64 exec, -1
s_branch mega_kernel_rs_pa_14_1
.p2align 5
mega_kernel_rs_pa_14_3:
s_waitcnt vmcnt(2)
v_max_u32 v4, v44, v46
v_cmp_eq_u32 vcc, -1, v4
s_cbranch_vccnz mega_kernel_rs_pa_14_3f
v_smfmac_f32_16x16x64_bf16 v[96:99], v[44:47], a[24:31], v6
v_smfmac_f32_16x16x64_bf16 v[100:103], v[44:47], a[56:63], v6
v_smfmac_f32_16x16x64_bf16 v[104:107], v[44:47], a[88:95], v6
v_smfmac_f32_16x16x64_bf16 v[108:111], v[44:47], a[120:127], v6
s_branch mega_kernel_rs_pa_6_1
mega_kernel_rs_il31:
s_cbranch_execz mega_kernel_rs_il32
.p2align 5
mega_kernel_rs_pa_15_0f:
s_mov_b64 exec, vcc
buffer_load_dwordx4 v[32:35], v7, s[84:87], s33 offen offset:0 sc1
s_mov_b64 exec, -1
s_branch mega_kernel_rs_pa_15_1
.p2align 5
mega_kernel_rs_pa_15_0:
s_waitcnt vmcnt(3)
v_max_u32 v4, v32, v34
v_cmp_eq_u32 vcc, -1, v4
s_cbranch_vccnz mega_kernel_rs_pa_15_0f
v_smfmac_f32_16x16x64_bf16 v[96:99], v[32:35], a[0:7], v6
v_smfmac_f32_16x16x64_bf16 v[100:103], v[32:35], a[32:39], v6
v_smfmac_f32_16x16x64_bf16 v[104:107], v[32:35], a[64:71], v6
v_smfmac_f32_16x16x64_bf16 v[108:111], v[32:35], a[96:103], v6
s_branch mega_kernel_rs_pa_14_1
mega_kernel_rs_il32:
s_cbranch_execz mega_kernel_rs_il33
.p2align 5
mega_kernel_rs_pa_15_1f:
s_mov_b64 exec, vcc
buffer_load_dwordx4 v[36:39], v7, s[84:87], s33 offen offset:1024 sc1
s_mov_b64 exec, -1
s_branch mega_kernel_rs_pa_15_2
.p2align 5
mega_kernel_rs_pa_15_1:
s_waitcnt vmcnt(3)
v_max_u32 v4, v36, v38
v_cmp_eq_u32 vcc, -1, v4
s_cbranch_vccnz mega_kernel_rs_pa_15_1f
v_smfmac_f32_16x16x64_bf16 v[96:99], v[36:39], a[8:15], v6
v_smfmac_f32_16x16x64_bf16 v[100:103], v[36:39], a[40:47], v6
v_smfmac_f32_16x16x64_bf16 v[104:107], v[36:39], a[72:79], v6
v_smfmac_f32_16x16x64_bf16 v[108:111], v[36:39], a[104:111], v6
s_branch mega_kernel_rs_pa_13_2
mega_kernel_rs_il33:
s_cbranch_execz mega_kernel_rs_il34
.p2align 5
mega_kernel_rs_pa_15_2f:
s_mov_b64 exec, vcc
buffer_load_dwordx4 v[40:43], v7, s[84:87], s33 offen offset:2048 sc1
s_mov_b64 exec, -1
s_branch mega_kernel_rs_pa_15_3
.p2align 5
mega_kernel_rs_pa_15_2:
s_waitcnt vmcnt(3)
v_max_u32 v4, v40, v42
v_cmp_eq_u32 vcc, -1, v4
s_cbranch_vccnz mega_kernel_rs_pa_15_2f
v_smfmac_f32_16x16x64_bf16 v[96:99], v[40:43], a[16:23], v6
v_smfmac_f32_16x16x64_bf16 v[100:103], v[40:43], a[48:55], v6
v_smfmac_f32_16x16x64_bf16 v[104:107], v[40:43], a[80:87], v6
v_smfmac_f32_16x16x64_bf16 v[108:111], v[40:43], a[112:119], v6
s_branch mega_kernel_rs_pa_11_3
mega_kernel_rs_il34:
s_cbranch_execz mega_kernel_rs_il35
.p2align 5
mega_kernel_rs_pa_15_3f:
s_mov_b64 exec, vcc
buffer_load_dwordx4 v[44:47], v7, s[84:87], s33 offen offset:3072 sc1
s_mov_b64 exec, -1
s_branch mega_kernel_rs_pa_15_0
.p2align 5
mega_kernel_rs_pa_15_3:
s_waitcnt vmcnt(3)
v_max_u32 v4, v44, v46
v_cmp_eq_u32 vcc, -1, v4
s_cbranch_vccnz mega_kernel_rs_pa_15_3f
v_smfmac_f32_16x16x64_bf16 v[96:99], v[44:47], a[24:31], v6
v_smfmac_f32_16x16x64_bf16 v[100:103], v[44:47], a[56:63], v6
v_smfmac_f32_16x16x64_bf16 v[104:107], v[44:47], a[88:95], v6
v_smfmac_f32_16x16x64_bf16 v[108:111], v[44:47], a[120:127], v6
s_branch mega_kernel_rs_pa_7_0
mega_kernel_rs_il35:
s_cbranch_execz mega_kernel_rs_il36
.p2align 5
mega_kernel_rs_pc_1_0f:
s_mov_b64 exec, vcc
buffer_load_dwordx4 v[32:35], v7, s[84:87], s29 offen offset:0 sc1
s_mov_b64 exec, -1
s_branch mega_kernel_rs_pc_1_0
.p2align 5
mega_kernel_rs_pc_1_0:
s_waitcnt vmcnt(0)
v_cmp_eq_u32 vcc, -1, v32
s_cbranch_vccnz mega_kernel_rs_pc_1_0f
v_smfmac_f32_16x16x64_bf16 v[96:99], v[32:35], a[192:199], v6
v_smfmac_f32_16x16x64_bf16 v[100:103], v[32:35], a[224:231], v6
s_branch mega_kernel_rs_pc_d
mega_kernel_rs_il36:
s_cbranch_execz mega_kernel_rs_il37
.p2align 5
mega_kernel_rs_pc_2_1f:
s_mov_b64 exec, vcc
buffer_load_dwordx4 v[36:39], v7, s[84:87], s29 offen offset:1024 sc1
s_mov_b64 exec, -1
s_branch mega_kernel_rs_pc_2_1
mega_kernel_rs_il37:
s_cbranch_execz mega_kernel_rs_iwd
.p2align 5
mega_kernel_rs_pc_2_1:
s_waitcnt vmcnt(0)
v_cmp_eq_u32 vcc, -1, v36
s_cbranch_vccnz mega_kernel_rs_pc_2_1f
v_smfmac_f32_16x16x64_bf16 v[96:99], v[36:39], a[200:207], v6
v_smfmac_f32_16x16x64_bf16 v[100:103], v[36:39], a[232:239], v6
s_branch mega_kernel_rs_pc_d
.p2align 5
mega_kernel_rs_pc_3_0f:
s_mov_b64 exec, vcc
buffer_load_dwordx4 v[32:35], v7, s[84:87], s29 offen offset:0 sc1
s_mov_b64 exec, -1
s_branch mega_kernel_rs_pc_3_1
mega_kernel_rs_iw2:
mega_kernel_rs_il38:
s_cbranch_execz mega_kernel_rs_il39
.p2align 5
mega_kernel_rs_pc_3_0:
s_waitcnt vmcnt(1)
v_cmp_eq_u32 vcc, -1, v32
s_cbranch_vccnz mega_kernel_rs_pc_3_0f
v_smfmac_f32_16x16x64_bf16 v[96:99], v[32:35], a[192:199], v6
v_smfmac_f32_16x16x64_bf16 v[100:103], v[32:35], a[224:231], v6
s_branch mega_kernel_rs_pc_2_1
.p2align 5
mega_kernel_rs_pc_3_1f:
s_mov_b64 exec, vcc
buffer_load_dwordx4 v[36:39], v7, s[84:87], s29 offen offset:1024 sc1
s_mov_b64 exec, -1
s_branch mega_kernel_rs_pc_3_0
mega_kernel_rs_il39:
s_cbranch_execz mega_kernel_rs_il40
.p2align 5
mega_kernel_rs_pc_3_1:
s_waitcnt vmcnt(1)
v_cmp_eq_u32 vcc, -1, v36
s_cbranch_vccnz mega_kernel_rs_pc_3_1f
v_smfmac_f32_16x16x64_bf16 v[96:99], v[36:39], a[200:207], v6
v_smfmac_f32_16x16x64_bf16 v[100:103], v[36:39], a[232:239], v6
s_branch mega_kernel_rs_pc_1_0
.p2align 5
mega_kernel_rs_pc_4_2f:
s_mov_b64 exec, vcc
buffer_load_dwordx4 v[40:43], v7, s[84:87], s29 offen offset:2048 sc1
s_mov_b64 exec, -1
s_branch mega_kernel_rs_pc_4_2
mega_kernel_rs_il40:
s_cbranch_execz mega_kernel_rs_il41
.p2align 5
mega_kernel_rs_pc_4_2:
s_waitcnt vmcnt(0)
v_cmp_eq_u32 vcc, -1, v40
s_cbranch_vccnz mega_kernel_rs_pc_4_2f
v_smfmac_f32_16x16x64_bf16 v[96:99], v[40:43], a[208:215], v6
v_smfmac_f32_16x16x64_bf16 v[100:103], v[40:43], a[240:247], v6
s_branch mega_kernel_rs_pc_d
.p2align 5
mega_kernel_rs_pc_5_0f:
s_mov_b64 exec, vcc
buffer_load_dwordx4 v[32:35], v7, s[84:87], s29 offen offset:0 sc1
s_mov_b64 exec, -1
s_branch mega_kernel_rs_pc_5_2
mega_kernel_rs_il41:
s_cbranch_execz mega_kernel_rs_il42
.p2align 5
mega_kernel_rs_pc_5_0:
s_waitcnt vmcnt(1)
v_cmp_eq_u32 vcc, -1, v32
s_cbranch_vccnz mega_kernel_rs_pc_5_0f
v_smfmac_f32_16x16x64_bf16 v[96:99], v[32:35], a[192:199], v6
v_smfmac_f32_16x16x64_bf16 v[100:103], v[32:35], a[224:231], v6
s_branch mega_kernel_rs_pc_4_2
.p2align 5
mega_kernel_rs_pc_5_2f:
s_mov_b64 exec, vcc
buffer_load_dwordx4 v[40:43], v7, s[84:87], s29 offen offset:2048 sc1
s_mov_b64 exec, -1
s_branch mega_kernel_rs_pc_5_0
mega_kernel_rs_il42:
s_cbranch_execz mega_kernel_rs_il43
.p2align 5
mega_kernel_rs_pc_5_2:
s_waitcnt vmcnt(1)
v_cmp_eq_u32 vcc, -1, v40
s_cbranch_vccnz mega_kernel_rs_pc_5_2f
v_smfmac_f32_16x16x64_bf16 v[96:99], v[40:43], a[208:215], v6
v_smfmac_f32_16x16x64_bf16 v[100:103], v[40:43], a[240:247], v6
s_branch mega_kernel_rs_pc_1_0
.p2align 5
mega_kernel_rs_pc_6_1f:
s_mov_b64 exec, vcc
buffer_load_dwordx4 v[36:39], v7, s[84:87], s29 offen offset:1024 sc1
s_mov_b64 exec, -1
s_branch mega_kernel_rs_pc_6_2
mega_kernel_rs_il43:
s_cbranch_execz mega_kernel_rs_il44
.p2align 5
mega_kernel_rs_pc_6_1:
s_waitcnt vmcnt(1)
v_cmp_eq_u32 vcc, -1, v36
s_cbranch_vccnz mega_kernel_rs_pc_6_1f
v_smfmac_f32_16x16x64_bf16 v[96:99], v[36:39], a[200:207], v6
v_smfmac_f32_16x16x64_bf16 v[100:103], v[36:39], a[232:239], v6
s_branch mega_kernel_rs_pc_4_2
.p2align 5
mega_kernel_rs_pc_6_2f:
s_mov_b64 exec, vcc
buffer_load_dwordx4 v[40:43], v7, s[84:87], s29 offen offset:2048 sc1
s_mov_b64 exec, -1
s_branch mega_kernel_rs_pc_6_1
mega_kernel_rs_il44:
s_cbranch_execz mega_kernel_rs_il45
.p2align 5
mega_kernel_rs_pc_6_2:
s_waitcnt vmcnt(1)
v_cmp_eq_u32 vcc, -1, v40
s_cbranch_vccnz mega_kernel_rs_pc_6_2f
v_smfmac_f32_16x16x64_bf16 v[96:99], v[40:43], a[208:215], v6
v_smfmac_f32_16x16x64_bf16 v[100:103], v[40:43], a[240:247], v6
s_branch mega_kernel_rs_pc_2_1
.p2align 5
mega_kernel_rs_pc_7_0f:
s_mov_b64 exec, vcc
buffer_load_dwordx4 v[32:35], v7, s[84:87], s29 offen offset:0 sc1
s_mov_b64 exec, -1
s_branch mega_kernel_rs_pc_7_1
mega_kernel_rs_il45:
s_cbranch_execz mega_kernel_rs_il46
.p2align 5
mega_kernel_rs_pc_7_0:
s_waitcnt vmcnt(2)
v_cmp_eq_u32 vcc, -1, v32
s_cbranch_vccnz mega_kernel_rs_pc_7_0f
v_smfmac_f32_16x16x64_bf16 v[96:99], v[32:35], a[192:199], v6
v_smfmac_f32_16x16x64_bf16 v[100:103], v[32:35], a[224:231], v6
s_branch mega_kernel_rs_pc_6_1
.p2align 5
mega_kernel_rs_pc_7_1f:
s_mov_b64 exec, vcc
buffer_load_dwordx4 v[36:39], v7, s[84:87], s29 offen offset:1024 sc1
s_mov_b64 exec, -1
s_branch mega_kernel_rs_pc_7_2
mega_kernel_rs_il46:
s_cbranch_execz mega_kernel_rs_il47
.p2align 5
mega_kernel_rs_pc_7_1:
s_waitcnt vmcnt(2)
v_cmp_eq_u32 vcc, -1, v36
s_cbranch_vccnz mega_kernel_rs_pc_7_1f
v_smfmac_f32_16x16x64_bf16 v[96:99], v[36:39], a[200:207], v6
v_smfmac_f32_16x16x64_bf16 v[100:103], v[36:39], a[232:239], v6
s_branch mega_kernel_rs_pc_5_2
.p2align 5
mega_kernel_rs_pc_7_2f:
s_mov_b64 exec, vcc
buffer_load_dwordx4 v[40:43], v7, s[84:87], s29 offen offset:2048 sc1
s_mov_b64 exec, -1
s_branch mega_kernel_rs_pc_7_0
mega_kernel_rs_il47:
s_cbranch_execz mega_kernel_rs_il48
.p2align 5
mega_kernel_rs_pc_7_2:
s_waitcnt vmcnt(2)
v_cmp_eq_u32 vcc, -1, v40
s_cbranch_vccnz mega_kernel_rs_pc_7_2f
v_smfmac_f32_16x16x64_bf16 v[96:99], v[40:43], a[208:215], v6
v_smfmac_f32_16x16x64_bf16 v[100:103], v[40:43], a[240:247], v6
s_branch mega_kernel_rs_pc_3_0
.p2align 5
mega_kernel_rs_pc_8_3f:
s_mov_b64 exec, vcc
buffer_load_dwordx4 v[44:47], v7, s[84:87], s29 offen offset:3072 sc1
s_mov_b64 exec, -1
s_branch mega_kernel_rs_pc_8_3
mega_kernel_rs_il48:
s_cbranch_execz mega_kernel_rs_il49
.p2align 5
mega_kernel_rs_pc_9_0f:
s_mov_b64 exec, vcc
buffer_load_dwordx4 v[32:35], v7, s[84:87], s29 offen offset:0 sc1
s_mov_b64 exec, -1
s_branch mega_kernel_rs_pc_9_3
.p2align 5
mega_kernel_rs_pc_9_0:
s_waitcnt vmcnt(1)
v_cmp_eq_u32 vcc, -1, v32
s_cbranch_vccnz mega_kernel_rs_pc_9_0f
v_smfmac_f32_16x16x64_bf16 v[96:99], v[32:35], a[192:199], v6
v_smfmac_f32_16x16x64_bf16 v[100:103], v[32:35], a[224:231], v6
s_branch mega_kernel_rs_pc_8_3
mega_kernel_rs_il49:
s_cbranch_execz mega_kernel_rs_il50
.p2align 5
mega_kernel_rs_pc_9_3f:
s_mov_b64 exec, vcc
buffer_load_dwordx4 v[44:47], v7, s[84:87], s29 offen offset:3072 sc1
s_mov_b64 exec, -1
s_branch mega_kernel_rs_pc_9_0
mega_kernel_rs_il50:
s_cbranch_execz mega_kernel_rs_il51
.p2align 5
mega_kernel_rs_pc_9_3:
s_waitcnt vmcnt(1)
v_cmp_eq_u32 vcc, -1, v44
s_cbranch_vccnz mega_kernel_rs_pc_9_3f
v_smfmac_f32_16x16x64_bf16 v[96:99], v[44:47], a[216:223], v6
v_smfmac_f32_16x16x64_bf16 v[100:103], v[44:47], a[248:255], v6
s_branch mega_kernel_rs_pc_1_0
.p2align 5
mega_kernel_rs_pc_10_1f:
s_mov_b64 exec, vcc
buffer_load_dwordx4 v[36:39], v7, s[84:87], s29 offen offset:1024 sc1
s_mov_b64 exec, -1
s_branch mega_kernel_rs_pc_10_3
mega_kernel_rs_il51:
s_cbranch_execz mega_kernel_rs_il52
.p2align 5
mega_kernel_rs_pc_10_1:
s_waitcnt vmcnt(1)
v_cmp_eq_u32 vcc, -1, v36
s_cbranch_vccnz mega_kernel_rs_pc_10_1f
v_smfmac_f32_16x16x64_bf16 v[96:99], v[36:39], a[200:207], v6
v_smfmac_f32_16x16x64_bf16 v[100:103], v[36:39], a[232:239], v6
s_branch mega_kernel_rs_pc_8_3
.p2align 5
mega_kernel_rs_pc_10_3f:
s_mov_b64 exec, vcc
buffer_load_dwordx4 v[44:47], v7, s[84:87], s29 offen offset:3072 sc1
s_mov_b64 exec, -1
s_branch mega_kernel_rs_pc_10_1
mega_kernel_rs_il52:
s_cbranch_execz mega_kernel_rs_il53
.p2align 5
mega_kernel_rs_pc_10_3:
s_waitcnt vmcnt(1)
v_cmp_eq_u32 vcc, -1, v44
s_cbranch_vccnz mega_kernel_rs_pc_10_3f
v_smfmac_f32_16x16x64_bf16 v[96:99], v[44:47], a[216:223], v6
v_smfmac_f32_16x16x64_bf16 v[100:103], v[44:47], a[248:255], v6
s_branch mega_kernel_rs_pc_2_1
.p2align 5
mega_kernel_rs_pc_11_0f:
s_mov_b64 exec, vcc
buffer_load_dwordx4 v[32:35], v7, s[84:87], s29 offen offset:0 sc1
s_mov_b64 exec, -1
s_branch mega_kernel_rs_pc_11_1
mega_kernel_rs_il53:
s_cbranch_execz mega_kernel_rs_il54
.p2align 5
mega_kernel_rs_pc_11_0:
s_waitcnt vmcnt(2)
v_cmp_eq_u32 vcc, -1, v32
s_cbranch_vccnz mega_kernel_rs_pc_11_0f
v_smfmac_f32_16x16x64_bf16 v[96:99], v[32:35], a[192:199], v6
v_smfmac_f32_16x16x64_bf16 v[100:103], v[32:35], a[224:231], v6
s_branch mega_kernel_rs_pc_10_1
.p2align 5
mega_kernel_rs_pc_11_1f:
s_mov_b64 exec, vcc
buffer_load_dwordx4 v[36:39], v7, s[84:87], s29 offen offset:1024 sc1
s_mov_b64 exec, -1
s_branch mega_kernel_rs_pc_11_3
mega_kernel_rs_il54:
s_cbranch_execz mega_kernel_rs_il55
.p2align 5
mega_kernel_rs_pc_11_1:
s_waitcnt vmcnt(2)
v_cmp_eq_u32 vcc, -1, v36
s_cbranch_vccnz mega_kernel_rs_pc_11_1f
v_smfmac_f32_16x16x64_bf16 v[96:99], v[36:39], a[200:207], v6
v_smfmac_f32_16x16x64_bf16 v[100:103], v[36:39], a[232:239], v6
s_branch mega_kernel_rs_pc_9_3
.p2align 5
mega_kernel_rs_pc_11_3f:
s_mov_b64 exec, vcc
buffer_load_dwordx4 v[44:47], v7, s[84:87], s29 offen offset:3072 sc1
s_mov_b64 exec, -1
s_branch mega_kernel_rs_pc_11_0
mega_kernel_rs_il55:
s_cbranch_execz mega_kernel_rs_il56
.p2align 5
mega_kernel_rs_pc_11_3:
s_waitcnt vmcnt(2)
v_cmp_eq_u32 vcc, -1, v44
s_cbranch_vccnz mega_kernel_rs_pc_11_3f
v_smfmac_f32_16x16x64_bf16 v[96:99], v[44:47], a[216:223], v6
v_smfmac_f32_16x16x64_bf16 v[100:103], v[44:47], a[248:255], v6
s_branch mega_kernel_rs_pc_3_0
.p2align 5
mega_kernel_rs_pc_12_2f:
s_mov_b64 exec, vcc
buffer_load_dwordx4 v[40:43], v7, s[84:87], s29 offen offset:2048 sc1
s_mov_b64 exec, -1
s_branch mega_kernel_rs_pc_12_3
mega_kernel_rs_il56:
s_cbranch_execz mega_kernel_rs_iwd
.p2align 5
mega_kernel_rs_pc_12_3f:
s_mov_b64 exec, vcc
buffer_load_dwordx4 v[44:47], v7, s[84:87], s29 offen offset:3072 sc1
s_mov_b64 exec, -1
s_branch mega_kernel_rs_pc_12_2
.p2align 5
mega_kernel_rs_pc_12_3:
s_waitcnt vmcnt(1)
v_cmp_eq_u32 vcc, -1, v44
s_cbranch_vccnz mega_kernel_rs_pc_12_3f
v_smfmac_f32_16x16x64_bf16 v[96:99], v[44:47], a[216:223], v6
v_smfmac_f32_16x16x64_bf16 v[100:103], v[44:47], a[248:255], v6
s_branch mega_kernel_rs_pc_4_2
mega_kernel_rs_iw3:
mega_kernel_rs_il57:
s_cbranch_execz mega_kernel_rs_il58
.p2align 5
mega_kernel_rs_pc_13_0f:
s_mov_b64 exec, vcc
buffer_load_dwordx4 v[32:35], v7, s[84:87], s29 offen offset:0 sc1
s_mov_b64 exec, -1
s_branch mega_kernel_rs_pc_13_2
mega_kernel_rs_il58:
s_cbranch_execz mega_kernel_rs_il59
.p2align 5
mega_kernel_rs_pc_13_0:
s_waitcnt vmcnt(2)
v_cmp_eq_u32 vcc, -1, v32
s_cbranch_vccnz mega_kernel_rs_pc_13_0f
v_smfmac_f32_16x16x64_bf16 v[96:99], v[32:35], a[192:199], v6
v_smfmac_f32_16x16x64_bf16 v[100:103], v[32:35], a[224:231], v6
s_branch mega_kernel_rs_pc_12_2
.p2align 5
mega_kernel_rs_pc_13_2f:
s_mov_b64 exec, vcc
buffer_load_dwordx4 v[40:43], v7, s[84:87], s29 offen offset:2048 sc1
s_mov_b64 exec, -1
s_branch mega_kernel_rs_pc_13_3
mega_kernel_rs_il59:
s_cbranch_execz mega_kernel_rs_il60
.p2align 5
mega_kernel_rs_pc_13_2:
s_waitcnt vmcnt(2)
v_cmp_eq_u32 vcc, -1, v40
s_cbranch_vccnz mega_kernel_rs_pc_13_2f
v_smfmac_f32_16x16x64_bf16 v[96:99], v[40:43], a[208:215], v6
v_smfmac_f32_16x16x64_bf16 v[100:103], v[40:43], a[240:247], v6
s_branch mega_kernel_rs_pc_9_3
.p2align 5
mega_kernel_rs_pc_13_3f:
s_mov_b64 exec, vcc
buffer_load_dwordx4 v[44:47], v7, s[84:87], s29 offen offset:3072 sc1
s_mov_b64 exec, -1
s_branch mega_kernel_rs_pc_13_0
mega_kernel_rs_il60:
s_cbranch_execz mega_kernel_rs_il61
.p2align 5
mega_kernel_rs_pc_13_3:
s_waitcnt vmcnt(2)
v_cmp_eq_u32 vcc, -1, v44
s_cbranch_vccnz mega_kernel_rs_pc_13_3f
v_smfmac_f32_16x16x64_bf16 v[96:99], v[44:47], a[216:223], v6
v_smfmac_f32_16x16x64_bf16 v[100:103], v[44:47], a[248:255], v6
s_branch mega_kernel_rs_pc_5_0
.p2align 5
mega_kernel_rs_pc_14_1f:
s_mov_b64 exec, vcc
buffer_load_dwordx4 v[36:39], v7, s[84:87], s29 offen offset:1024 sc1
s_mov_b64 exec, -1
s_branch mega_kernel_rs_pc_14_2
mega_kernel_rs_il61:
s_cbranch_execz mega_kernel_rs_il62
.p2align 5
mega_kernel_rs_pc_14_2f:
s_mov_b64 exec, vcc
buffer_load_dwordx4 v[40:43], v7, s[84:87], s29 offen offset:2048 sc1
s_mov_b64 exec, -1
s_branch mega_kernel_rs_pc_14_3
.p2align 5
mega_kernel_rs_pc_14_2:
s_waitcnt vmcnt(2)
v_cmp_eq_u32 vcc, -1, v40
s_cbranch_vccnz mega_kernel_rs_pc_14_2f
v_smfmac_f32_16x16x64_bf16 v[96:99], v[40:43], a[208:215], v6
v_smfmac_f32_16x16x64_bf16 v[100:103], v[40:43], a[240:247], v6
s_branch mega_kernel_rs_pc_10_3
mega_kernel_rs_il62:
s_cbranch_execz mega_kernel_rs_il63
.p2align 5
mega_kernel_rs_pc_14_3f:
s_mov_b64 exec, vcc
buffer_load_dwordx4 v[44:47], v7, s[84:87], s29 offen offset:3072 sc1
s_mov_b64 exec, -1
s_branch mega_kernel_rs_pc_14_1
mega_kernel_rs_il63:
s_cbranch_execz mega_kernel_rs_il64
.p2align 5
mega_kernel_rs_pc_14_3:
s_waitcnt vmcnt(2)
v_cmp_eq_u32 vcc, -1, v44
s_cbranch_vccnz mega_kernel_rs_pc_14_3f
v_smfmac_f32_16x16x64_bf16 v[96:99], v[44:47], a[216:223], v6
v_smfmac_f32_16x16x64_bf16 v[100:103], v[44:47], a[248:255], v6
s_branch mega_kernel_rs_pc_6_1
.p2align 5
mega_kernel_rs_pc_15_0f:
s_mov_b64 exec, vcc
buffer_load_dwordx4 v[32:35], v7, s[84:87], s29 offen offset:0 sc1
s_mov_b64 exec, -1
s_branch mega_kernel_rs_pc_15_1
mega_kernel_rs_il64:
s_cbranch_execz mega_kernel_rs_il65
.p2align 5
mega_kernel_rs_pc_15_1f:
s_mov_b64 exec, vcc
buffer_load_dwordx4 v[36:39], v7, s[84:87], s29 offen offset:1024 sc1
s_mov_b64 exec, -1
s_branch mega_kernel_rs_pc_15_2
.p2align 5
mega_kernel_rs_pc_15_1:
s_waitcnt vmcnt(3)
v_cmp_eq_u32 vcc, -1, v36
s_cbranch_vccnz mega_kernel_rs_pc_15_1f
v_smfmac_f32_16x16x64_bf16 v[96:99], v[36:39], a[200:207], v6
v_smfmac_f32_16x16x64_bf16 v[100:103], v[36:39], a[232:239], v6
s_branch mega_kernel_rs_pc_13_2
mega_kernel_rs_il65:
s_cbranch_execz mega_kernel_rs_il66
.p2align 5
mega_kernel_rs_pc_15_2f:
s_mov_b64 exec, vcc
buffer_load_dwordx4 v[40:43], v7, s[84:87], s29 offen offset:2048 sc1
s_mov_b64 exec, -1
s_branch mega_kernel_rs_pc_15_3
mega_kernel_rs_il66:
s_cbranch_execz mega_kernel_rs_il67
.p2align 5
mega_kernel_rs_pc_15_2:
s_waitcnt vmcnt(3)
v_cmp_eq_u32 vcc, -1, v40
s_cbranch_vccnz mega_kernel_rs_pc_15_2f
v_smfmac_f32_16x16x64_bf16 v[96:99], v[40:43], a[208:215], v6
v_smfmac_f32_16x16x64_bf16 v[100:103], v[40:43], a[240:247], v6
s_branch mega_kernel_rs_pc_11_3
.p2align 5
mega_kernel_rs_pc_15_3f:
s_mov_b64 exec, vcc
buffer_load_dwordx4 v[44:47], v7, s[84:87], s29 offen offset:3072 sc1
s_mov_b64 exec, -1
s_branch mega_kernel_rs_pc_15_0
mega_kernel_rs_il67:
s_cbranch_execz mega_kernel_rs_il68
.p2align 5
mega_kernel_rs_pc_15_3:
s_waitcnt vmcnt(3)
v_cmp_eq_u32 vcc, -1, v44
s_cbranch_vccnz mega_kernel_rs_pc_15_3f
v_smfmac_f32_16x16x64_bf16 v[96:99], v[44:47], a[216:223], v6
v_smfmac_f32_16x16x64_bf16 v[100:103], v[44:47], a[248:255], v6
s_branch mega_kernel_rs_pc_7_0
mega_kernel_rs_w0last:
s_nop 7
v_permlane32_swap_b32 v112, v116
v_permlane32_swap_b32 v113, v117
v_permlane32_swap_b32 v114, v118
v_permlane32_swap_b32 v115, v119
v_pk_add_f32 v[112:113], v[112:113], v[116:117]
v_pk_add_f32 v[114:115], v[114:115], v[118:119]
ds_write_b128 v20, v[112:115]
s_waitcnt lgkmcnt(0)
s_barrier
s_branch mega_kernel_rs_end
mega_kernel_rs_il68:
s_cbranch_execz mega_kernel_rs_il69
mega_kernel_rs_side:
s_cmp_eq_u32 s24, 3
s_cbranch_scc1 mega_kernel_rs_sd3
s_cmp_eq_u32 s24, 2
s_cbranch_scc0 mega_kernel_rs_sd4
s_mov_b64 exec, s[40:41]
buffer_store_dwordx4 v[28:31], v11, s[84:87], s34 offen sc1
s_mov_b64 exec, -1
buffer_store_dwordx2 v[28:29], v9, s[84:87], s34 offen sc1
s_mul_i32 s28, s31, 2048
s_add_u32 s28, s28, s34
s_add_u32 s28, s28, 49152
buffer_store_dwordx4 v[28:31], v17, s[84:87], s28 offen sc1
buffer_store_dwordx4 v[28:31], v10, s[84:87], s28 offen sc1
s_branch mega_kernel_rs_sd4
mega_kernel_rs_il69:
s_cbranch_execz mega_kernel_rs_il70
mega_kernel_rs_sd3:
v_readlane_b32 s76, v249, 0
v_readlane_b32 s77, v249, 1
s_min_i32 s76, s76, s77
s_max_i32 s46, s46, s76
s_mov_b32 s36, 0
s_add_u32 s76, s27, 1
s_cmp_lt_u32 s76, 63
s_cbranch_scc0 mega_kernel_rs_sd4
s_cmp_ge_u32 s76, 0
s_cbranch_scc0 mega_kernel_rs_sd4
s_cmp_gt_i32 s46, s76
s_cselect_b32 s36, 0, 1
s_cbranch_scc0 mega_kernel_rs_sd4
s_add_u32 s77, s76, s82
s_bfe_u32 s28, s77, 0x40002
s_lshl_b32 s28, s28, 14
s_and_b32 s77, s77, 3
s_lshl_b32 s77, s77, 11
s_add_u32 s28, s28, s77
s_add_u32 m0, s45, 0
s_nop 0
buffer_load_dwordx4 v240, s[84:87], s28 offen offset:0 sc1 lds
s_add_u32 m0, s45, 0
s_nop 0
buffer_load_dwordx4 v240, s[84:87], s28 offen offset:1024 sc1 lds
s_add_u32 m0, s45, 2048
s_nop 0
buffer_load_dwordx4 v241, s[84:87], s28 offen offset:0 sc1 lds
s_add_u32 m0, s45, 2048
s_nop 0
buffer_load_dwordx4 v241, s[84:87], s28 offen offset:1024 sc1 lds
s_add_u32 s45, s45, 4096
s_cmp_eq_u32 s45, 30720
s_cselect_b32 s45, 18432, s45
mega_kernel_rs_sd4:
v_smfmac_f32_16x16x64_bf16 v[112:115], v[40:43], a[144:151], v6
v_smfmac_f32_16x16x64_bf16 v[116:119], v[40:43], a[176:183], v6
v_smfmac_f32_16x16x64_bf16 v[112:115], v[44:47], a[152:159], v6
v_smfmac_f32_16x16x64_bf16 v[116:119], v[44:47], a[184:191], v6
s_nop 7
v_permlane32_swap_b32 v112, v116
v_permlane32_swap_b32 v113, v117
v_permlane32_swap_b32 v114, v118
v_permlane32_swap_b32 v115, v119
v_pk_add_f32 v[112:113], v[112:113], v[116:117]
v_pk_add_f32 v[114:115], v[114:115], v[118:119]
ds_write_b128 v20, v[112:115]
v_mov_b32 v96, 0
v_mov_b32 v97, 0
v_mov_b32 v98, 0
v_mov_b32 v99, 0
v_mov_b32 v100, 0
v_mov_b32 v101, 0
v_mov_b32 v102, 0
v_mov_b32 v103, 0
s_cmp_eq_u32 s24, 1
s_cbranch_scc0 mega_kernel_rs_s1
s_waitcnt lgkmcnt(0)
ds_read_b128 v[120:123], v16 offset:0
ds_read_b128 v[124:127], v16 offset:16
ds_read_b128 v[128:131], v16 offset:2304
ds_read_b128 v[132:135], v16 offset:2320
ds_read_b128 v[136:139], v16 offset:4608
ds_read_b128 v[140:143], v16 offset:4624
ds_read_b128 v[144:147], v16 offset:6912
ds_read_b128 v[148:151], v16 offset:6928
s_waitcnt lgkmcnt(4)
v_pk_add_f32 v[120:121], v[120:121], v[128:129]
v_pk_add_f32 v[122:123], v[122:123], v[130:131]
v_pk_add_f32 v[124:125], v[124:125], v[132:133]
v_pk_add_f32 v[126:127], v[126:127], v[134:135]
s_waitcnt lgkmcnt(0)
v_pk_add_f32 v[136:137], v[136:137], v[144:145]
v_pk_add_f32 v[138:139], v[138:139], v[146:147]
v_pk_add_f32 v[140:141], v[140:141], v[148:149]
v_pk_add_f32 v[142:143], v[142:143], v[150:151]
v_pk_add_f32 v[120:121], v[120:121], v[136:137]
v_pk_add_f32 v[122:123], v[122:123], v[138:139]
v_pk_add_f32 v[124:125], v[124:125], v[140:141]
v_pk_add_f32 v[126:127], v[126:127], v[142:143]
v_cvt_pk_bf16_f32 v244, v120, v121
v_cvt_pk_bf16_f32 v245, v122, v123
v_cvt_pk_bf16_f32 v246, v124, v125
v_cvt_pk_bf16_f32 v247, v126, v127
mega_kernel_rs_s1:
v_add_u32 v5, 9216, v17
s_waitcnt lgkmcnt(0)
s_barrier
s_cmp_eq_u32 s24, 2
s_cbranch_scc1 mega_kernel_rs_s2
s_cmp_eq_u32 s24, 3
s_cbranch_scc0 mega_kernel_rs_s3
s_add_u32 s76, s27, 2
s_cmp_lt_u32 s76, 63
s_cbranch_scc0 mega_kernel_rs_s3
s_cmp_gt_i32 s46, s76
s_cbranch_scc0 mega_kernel_rs_s3
s_add_u32 s77, s76, s82
s_bfe_u32 s28, s77, 0x40002
s_lshl_b32 s28, s28, 14
s_and_b32 s77, s77, 3
s_lshl_b32 s77, s77, 11
s_add_u32 s28, s28, s77
s_add_u32 s28, s28, s83
s_buffer_load_dword s78, s[84:87], s28 offset:0
s_buffer_load_dword s78, s[84:87], s28 offset:128
s_buffer_load_dword s78, s[84:87], s28 offset:256
s_buffer_load_dword s78, s[84:87], s28 offset:384
s_buffer_load_dword s78, s[84:87], s28 offset:512
s_buffer_load_dword s78, s[84:87], s28 offset:640
s_buffer_load_dword s78, s[84:87], s28 offset:768
s_buffer_load_dword s78, s[84:87], s28 offset:896
s_buffer_load_dword s78, s[84:87], s28 offset:1024
s_buffer_load_dword s78, s[84:87], s28 offset:1152
s_buffer_load_dword s78, s[84:87], s28 offset:1280
s_buffer_load_dword s78, s[84:87], s28 offset:1408
s_buffer_load_dword s78, s[84:87], s28 offset:1536
s_buffer_load_dword s78, s[84:87], s28 offset:1664
s_buffer_load_dword s78, s[84:87], s28 offset:1792
s_buffer_load_dword s78, s[84:87], s28 offset:1920
s_mov_b32 s88, s76
s_branch mega_kernel_rs_s3
mega_kernel_rs_il70:
s_cbranch_execz mega_kernel_rs_il71
mega_kernel_rs_s2:
ds_read_b128 v[120:123], v5 offset:0
ds_read_b128 v[124:127], v5 offset:1024
ds_read_b128 v[128:131], v5 offset:2048
ds_read_b128 v[132:135], v5 offset:3072
v_lshrrev_b32 v5, 1, v17
s_waitcnt lgkmcnt(2)
v_pk_add_f32 v[120:121], v[120:121], v[124:125]
v_pk_add_f32 v[122:123], v[122:123], v[126:127]
s_waitcnt lgkmcnt(0)
v_pk_add_f32 v[128:129], v[128:129], v[132:133]
v_pk_add_f32 v[130:131], v[130:131], v[134:135]
v_pk_add_f32 v[120:121], v[120:121], v[128:129]
v_pk_add_f32 v[122:123], v[122:123], v[130:131]
v_cvt_pk_bf16_f32 v244, v120, v121
v_cvt_pk_bf16_f32 v245, v122, v123
ds_write_b64 v5, v[244:245] offset:17920
s_waitcnt lgkmcnt(0) vmcnt(0)
mega_kernel_rs_s3:
s_cmp_eq_u32 s27, 63
s_cbranch_scc1 mega_kernel_rs_slast
s_add_u32 s29, s33, 24576
s_barrier
s_cmp_eq_u32 s24, 3
s_cbranch_scc1 mega_kernel_rs_y3
s_add_u32 s77, s27, s82
s_bfe_u32 s28, s77, 0x30003
s_lshl_b32 s28, s28, 14
s_and_b32 s77, s77, 7
s_lshl_b32 s77, s77, 10
s_add_u32 s28, s28, s77
s_add_u32 s28, s28, s79
s_cmp_eq_u32 s24, 2
s_cbranch_scc1 mega_kernel_rs_kv2a
s_mov_b64 exec, s[48:49]
buffer_store_dwordx4 v[244:247], v22, s[84:87], s28 offen sc1
s_mov_b64 exec, -1
s_branch mega_kernel_rs_kvda
mega_kernel_rs_il71:
s_cbranch_execz mega_kernel_rs_il72
mega_kernel_rs_kv2a:
v_lshlrev_b32 v4, 3, v1
buffer_store_dwordx2 v[244:245], v4, s[84:87], s28 offen offset:512 sc1
mega_kernel_rs_kvda:
s_branch mega_kernel_rs_y4
mega_kernel_rs_y3:
s_add_u32 s76, s27, 2
s_cmp_lt_u32 s76, 63
s_cbranch_scc0 mega_kernel_rs_y4
mega_kernel_rs_y4:
s_branch mega_kernel_rs_b3
mega_kernel_rs_first:
v_add_u32 v5, s44, v17
ds_read_b128 v[156:159], v5 offset:0
ds_read_b128 v[160:163], v5 offset:1024
ds_read_b128 v[164:167], v5 offset:2048
ds_read_b128 v[168:171], v5 offset:3072
s_branch mega_kernel_rs_adone
mega_kernel_rs_il72:
s_cbranch_execz mega_kernel_rs_il73
mega_kernel_rs_slast:
s_cmp_eq_u32 s24, 3
s_cbranch_scc1 mega_kernel_rs_end
s_add_u32 s77, s27, s82
s_bfe_u32 s28, s77, 0x30003
s_lshl_b32 s28, s28, 14
s_and_b32 s77, s77, 7
s_lshl_b32 s77, s77, 10
s_add_u32 s28, s28, s77
s_add_u32 s28, s28, s79
s_cmp_eq_u32 s24, 2
s_cbranch_scc1 mega_kernel_rs_kv2b
s_mov_b64 exec, s[48:49]
buffer_store_dwordx4 v[244:247], v22, s[84:87], s28 offen sc1
s_mov_b64 exec, -1
s_branch mega_kernel_rs_kvdb
mega_kernel_rs_il73:
s_cbranch_execz mega_kernel_rs_iwd
mega_kernel_rs_kv2b:
v_lshlrev_b32 v4, 3, v1
buffer_store_dwordx2 v[244:245], v4, s[84:87], s28 offen offset:512 sc1
mega_kernel_rs_kvdb:
s_waitcnt vmcnt(0)
s_barrier
s_mov_b32 s76, 64
s_cmp_eq_u32 s24, 1
s_cbranch_scc0 mega_kernel_rs_end
v_mov_b32 v5, s76
s_mov_b64 exec, 1
buffer_store_dword v5, v228, s[84:87], s81 offen sc1
s_mov_b64 exec, -1
mega_kernel_rs_end:
s_endpgm
.section .rodata,"a"
.p2align 6
.amdhsa_kernel mega_kernel
  .amdhsa_next_free_vgpr 512
  .amdhsa_next_free_sgpr 102
  .amdhsa_accum_offset 256
  .amdhsa_group_segment_fixed_size 0
  .amdhsa_kernarg_size 104
  .amdhsa_user_sgpr_count 2
  .amdhsa_user_sgpr_kernarg_segment_ptr 1
  .amdhsa_system_sgpr_workgroup_id_x 1
.end_amdhsa_kernel
```

```asm
; @launch kernel=mega_kernel grid=(256,1,1) block=(256,1,1) lds=163840
.amdgcn_target "amdgcn-amd-amdhsa--gfx950"
.text
.globl mega_kernel
.p2align 8
.type mega_kernel,@function
mega_kernel:
s_cmp_ge_u32 s2, 256
s_cbranch_scc1 mega_kernel_exit
s_load_dwordx2 s[84:85], s[0:1], 96
s_load_dwordx2 s[72:73], s[0:1], 88
s_getreg_b32 s90, hwreg(HW_REG_XCC_ID)
s_and_b32 s90, s90, 7
v_mov_b32 v1, 0
v_mov_b32 v2, 1
s_lshl_b32 s91, s90, 4
s_mov_b32 s95, 0
s_mov_b32 s99, 0
s_waitcnt lgkmcnt(0)
s_mov_b32 s86, 268435456
s_mov_b32 s87, 0x00020000
s_mov_b32 s74, 256
s_mov_b32 s75, 0x00020000
v_cmp_eq_u32 vcc, 0, v0
s_and_saveexec_b64 s[88:89], vcc
s_cbranch_execz mega_kernel_tkd
s_lshl_b32 s92, s2, 13
s_add_u32 s92, s92, 167772160
buffer_atomic_add v2, v1, s[72:75], s91 offen sc0
buffer_load_dword v251, v1, s[84:87], s92 offen offset:2048 sc1
s_waitcnt vmcnt(1)
ds_write_b32 v1, v2
s_waitcnt lgkmcnt(0)
mega_kernel_tkd:
s_mov_b64 exec, s[88:89]
s_barrier
ds_read_b32 v2, v1
s_waitcnt lgkmcnt(0)
v_readfirstlane_b32 s96, v2
s_barrier
s_cmp_lt_u32 s96, 32
s_cbranch_scc1 mega_kernel_spec
v_and_b32 v3, 15, v0
v_lshlrev_b32 v3, 4, v3
s_branch mega_kernel_syx
mega_kernel_syxw:
s_sleep 4
mega_kernel_syx:
buffer_load_dword v2, v3, s[72:75], 0 offen sc1
s_waitcnt vmcnt(0)
mega_kernel_syxp:
s_cmp_eq_u32 s95, 1
s_cbranch_scc0 mega_kernel_syxf
v_readlane_b32 s76, v2, 14
s_mov_b32 s98, 0
s_cmp_eq_u32 s76, 32
s_cbranch_scc0 mega_kernel_syxw
s_branch mega_kernel_syxd
mega_kernel_syxf:
s_mov_b32 s77, 0
s_mov_b32 s78, 0
v_readlane_b32 s76, v2, 0
s_add_u32 s77, s77, s76
s_xor_b32 s76, s76, 32
s_or_b32 s78, s78, s76
v_readlane_b32 s76, v2, 1
s_add_u32 s77, s77, s76
s_xor_b32 s76, s76, 32
s_or_b32 s78, s78, s76
v_readlane_b32 s76, v2, 2
s_add_u32 s77, s77, s76
s_xor_b32 s76, s76, 32
s_or_b32 s78, s78, s76
v_readlane_b32 s76, v2, 3
s_add_u32 s77, s77, s76
s_xor_b32 s76, s76, 32
s_or_b32 s78, s78, s76
v_readlane_b32 s76, v2, 4
s_add_u32 s77, s77, s76
s_xor_b32 s76, s76, 32
s_or_b32 s78, s78, s76
v_readlane_b32 s76, v2, 5
s_add_u32 s77, s77, s76
s_xor_b32 s76, s76, 32
s_or_b32 s78, s78, s76
v_readlane_b32 s76, v2, 6
s_add_u32 s77, s77, s76
s_xor_b32 s76, s76, 32
s_or_b32 s78, s78, s76
v_readlane_b32 s76, v2, 7
s_add_u32 s77, s77, s76
s_xor_b32 s76, s76, 32
s_or_b32 s78, s78, s76
s_cmp_eq_u32 s77, 256
s_cbranch_scc0 mega_kernel_syxw
v_mov_b32 v252, v2
s_cmp_eq_u32 s78, 0
s_cbranch_scc0 mega_kernel_slowent
v_readlane_b32 s76, v2, 10
v_readlane_b32 s77, v2, 8
s_cmp_eq_u32 s76, 32
s_cbranch_scc0 mega_kernel_syxw
s_cmp_gt_u32 s77, 16
s_cselect_b32 s98, 1, 0
mega_kernel_syxd:
mega_kernel_slowent:
s_mov_b64 exec, -1
s_waitcnt vmcnt(0) lgkmcnt(0)
s_barrier
s_mov_b32 s97, s96
v_readlane_b32 s76, v252, 0
s_cmp_gt_u32 s90, 0
s_cselect_b32 s76, s76, 0
s_add_u32 s97, s97, s76
v_readlane_b32 s76, v252, 1
s_cmp_gt_u32 s90, 1
s_cselect_b32 s76, s76, 0
s_add_u32 s97, s97, s76
v_readlane_b32 s76, v252, 2
s_cmp_gt_u32 s90, 2
s_cselect_b32 s76, s76, 0
s_add_u32 s97, s97, s76
v_readlane_b32 s76, v252, 3
s_cmp_gt_u32 s90, 3
s_cselect_b32 s76, s76, 0
s_add_u32 s97, s97, s76
v_readlane_b32 s76, v252, 4
s_cmp_gt_u32 s90, 4
s_cselect_b32 s76, s76, 0
s_add_u32 s97, s97, s76
v_readlane_b32 s76, v252, 5
s_cmp_gt_u32 s90, 5
s_cselect_b32 s76, s76, 0
s_add_u32 s97, s97, s76
v_readlane_b32 s76, v252, 6
s_cmp_gt_u32 s90, 6
s_cselect_b32 s76, s76, 0
s_add_u32 s97, s97, s76
v_mov_b32 v1, 0
v_mov_b32 v2, 1
v_cmp_eq_u32 vcc, 0, v0
s_and_saveexec_b64 s[88:89], vcc
s_cbranch_execz mega_kernel_sb1
buffer_atomic_add v2, v1, s[72:75], 0 offen offset:192 sc1
mega_kernel_sb1:
s_mov_b64 exec, s[88:89]
mega_kernel_sb2:
s_sleep 4
buffer_load_dword v2, v1, s[72:75], 0 offen offset:192 sc1
s_waitcnt vmcnt(0)
v_cmp_ne_u32 vcc, 256, v2
s_cbranch_vccnz mega_kernel_sb2
s_mov_b32 s95, 1
s_lshr_b32 s30, s97, 5
s_and_b32 s31, s97, 31
s_cmp_lt_u32 s97, 128
s_cbranch_scc1 mega_kernel_recs
s_sub_u32 s94, s97, 128
s_branch mega_kernel_bulk
mega_kernel_spec:
s_mov_b32 s30, s90
s_mov_b32 s31, s96
s_cmp_lt_u32 s90, 4
s_cbranch_scc1 mega_kernel_recf
s_sub_u32 s94, s90, 4
s_lshl_b32 s94, s94, 5
s_add_u32 s94, s94, s96
mega_kernel_bulk:
s_lshr_b32 s91, s94, 5
s_and_b32 s40, s94, 31
s_and_b32 s92, s91, 1
s_lshl_b32 s92, s92, 5
s_add_u32 s92, s92, s40
s_cmp_eq_u32 s91, 0
s_cbranch_scc1 mega_kernel_rk
s_cmp_eq_u32 s91, 1
s_cbranch_scc1 mega_kernel_rv
s_cmp_eq_u32 s91, 2
s_cbranch_scc1 mega_kernel_noinit
v_mov_b32 v8, -1
v_mov_b32 v9, -1
v_mov_b32 v10, -1
v_mov_b32 v11, -1
v_lshlrev_b32 v1, 4, v0
v_mov_b32 v2, 0
v_cmp_gt_u32 vcc, 64, v0
s_cbranch_vccz mega_kernel_nv
s_cmp_eq_u32 s95, 0
s_cbranch_scc0 mega_kernel_nv
s_lshr_b32 s60, s2, 1
s_lshl_b32 s60, s60, 14
s_and_b32 s61, s40, 1
s_lshl_b32 s66, s61, 13
s_add_u32 s60, s60, s66
s_and_b32 s66, s2, 1
s_lshl_b32 s66, s66, 10
s_add_u32 s60, s60, s66
s_add_u32 s60, s60, 167772160
s_mov_b32 s66, 0x7fffffff
s_mov_b32 s67, 0x7fffffff
s_mov_b64 exec, 0xff
s_waitcnt vmcnt(0)
s_memtime s[62:63]
s_waitcnt lgkmcnt(0)
buffer_store_dwordx4 v[8:11], v1, s[84:87], s60 offen offset:0 sc1
s_waitcnt vmcnt(0)
s_memtime s[64:65]
s_xor_b32 s60, s60, 8192
s_waitcnt lgkmcnt(0)
s_sub_u32 s64, s64, s62
s_min_u32 s66, s66, s64
s_memtime s[62:63]
s_waitcnt lgkmcnt(0)
buffer_store_dwordx4 v[8:11], v1, s[84:87], s60 offen offset:0 sc1
s_waitcnt vmcnt(0)
s_memtime s[64:65]
s_xor_b32 s60, s60, 8192
s_waitcnt lgkmcnt(0)
s_sub_u32 s64, s64, s62
s_min_u32 s67, s67, s64
s_memtime s[62:63]
s_waitcnt lgkmcnt(0)
buffer_store_dwordx4 v[8:11], v1, s[84:87], s60 offen offset:256 sc1
s_waitcnt vmcnt(0)
s_memtime s[64:65]
s_xor_b32 s60, s60, 8192
s_waitcnt lgkmcnt(0)
s_sub_u32 s64, s64, s62
s_min_u32 s66, s66, s64
s_memtime s[62:63]
s_waitcnt lgkmcnt(0)
buffer_store_dwordx4 v[8:11], v1, s[84:87], s60 offen offset:256 sc1
s_waitcnt vmcnt(0)
s_memtime s[64:65]
s_xor_b32 s60, s60, 8192
s_waitcnt lgkmcnt(0)
s_sub_u32 s64, s64, s62
s_min_u32 s67, s67, s64
s_cmp_lt_u32 s67, s66
s_cselect_b32 s60, 1, 0
s_xor_b32 s60, s60, s61
s_lshr_b32 s61, s90, 2
s_xor_b32 s60, s60, s61
v_mov_b32 v3, s60
s_mov_b64 exec, 1
buffer_atomic_add v3, v2, s[72:75], 0 offen offset:128 sc1
s_mov_b64 exec, -1
mega_kernel_nv:
s_barrier
s_lshl_b32 s60, s40, 12
s_add_u32 s60, s60, 67108864
buffer_store_dwordx4 v[8:11], v1, s[84:87], s60 offen sc1
s_add_u32 s60, s60, 131072
buffer_store_dwordx4 v[8:11], v1, s[84:87], s60 offen sc1
s_add_u32 s60, s60, 131072
buffer_store_dwordx4 v[8:11], v1, s[84:87], s60 offen sc1
s_add_u32 s60, s60, 131072
buffer_store_dwordx4 v[8:11], v1, s[84:87], s60 offen sc1
s_add_u32 s60, s60, 131072
buffer_store_dwordx4 v[8:11], v1, s[84:87], s60 offen sc1
s_add_u32 s60, s60, 131072
buffer_store_dwordx4 v[8:11], v1, s[84:87], s60 offen sc1
s_add_u32 s60, s60, 131072
buffer_store_dwordx4 v[8:11], v1, s[84:87], s60 offen sc1
s_add_u32 s60, s60, 131072
buffer_store_dwordx4 v[8:11], v1, s[84:87], s60 offen sc1
s_add_u32 s60, s60, 131072
buffer_store_dwordx4 v[8:11], v1, s[84:87], s60 offen sc1
s_add_u32 s60, s60, 131072
buffer_store_dwordx4 v[8:11], v1, s[84:87], s60 offen sc1
s_add_u32 s60, s60, 131072
buffer_store_dwordx4 v[8:11], v1, s[84:87], s60 offen sc1
s_add_u32 s60, s60, 131072
buffer_store_dwordx4 v[8:11], v1, s[84:87], s60 offen sc1
s_add_u32 s60, s60, 131072
buffer_store_dwordx4 v[8:11], v1, s[84:87], s60 offen sc1
s_add_u32 s60, s60, 131072
buffer_store_dwordx4 v[8:11], v1, s[84:87], s60 offen sc1
s_add_u32 s60, s60, 131072
buffer_store_dwordx4 v[8:11], v1, s[84:87], s60 offen sc1
s_add_u32 s60, s60, 131072
buffer_store_dwordx4 v[8:11], v1, s[84:87], s60 offen sc1
s_add_u32 s60, s60, 131072
s_lshr_b32 s62, s40, 1
s_and_b32 s63, s40, 1
s_add_u32 s63, s63, s62
s_lshl_b32 s62, s62, 19
s_and_b32 s64, s63, 14
s_lshl_b32 s64, s64, 13
s_add_u32 s62, s62, s64
s_and_b32 s64, s63, 1
s_lshl_b32 s64, s64, 12
s_add_u32 s62, s62, s64
s_add_u32 s62, s62, 150994944
s_add_u32 s62, s62, 8192
s_cmp_lt_u32 s40, 16
s_cbranch_scc0 mega_kernel_pz
buffer_store_dwordx4 v[8:11], v1, s[84:87], s60 offen sc1
mega_kernel_pz:
s_waitcnt vmcnt(0)
s_barrier
v_mov_b32 v3, 1
s_lshl_b32 s62, s95, 6
v_cmp_eq_u32 vcc, 0, v0
s_and_saveexec_b64 s[60:61], vcc
s_cbranch_execz mega_kernel_xps
buffer_atomic_add v3, v2, s[72:75], s62 offen offset:160 sc1
mega_kernel_xps:
s_mov_b64 exec, s[60:61]
mega_kernel_noinit:
s_cmp_eq_u32 s91, 2
s_cbranch_scc1 mega_kernel_nohold
v_and_b32 v3, 15, v0
v_lshlrev_b32 v3, 4, v3
s_branch mega_kernel_syh
mega_kernel_syhw:
s_sleep 4
mega_kernel_syh:
buffer_load_dword v2, v3, s[72:75], 0 offen sc1
s_waitcnt vmcnt(0)
mega_kernel_syhp:
s_cmp_eq_u32 s95, 1
s_cbranch_scc0 mega_kernel_syhf
v_readlane_b32 s76, v2, 14
s_mov_b32 s98, 0
s_cmp_eq_u32 s76, 32
s_cbranch_scc0 mega_kernel_syhw
s_branch mega_kernel_syhd
mega_kernel_syhf:
s_mov_b32 s77, 0
s_mov_b32 s78, 0
v_readlane_b32 s76, v2, 0
s_add_u32 s77, s77, s76
s_xor_b32 s76, s76, 32
s_or_b32 s78, s78, s76
v_readlane_b32 s76, v2, 1
s_add_u32 s77, s77, s76
s_xor_b32 s76, s76, 32
s_or_b32 s78, s78, s76
v_readlane_b32 s76, v2, 2
s_add_u32 s77, s77, s76
s_xor_b32 s76, s76, 32
s_or_b32 s78, s78, s76
v_readlane_b32 s76, v2, 3
s_add_u32 s77, s77, s76
s_xor_b32 s76, s76, 32
s_or_b32 s78, s78, s76
v_readlane_b32 s76, v2, 4
s_add_u32 s77, s77, s76
s_xor_b32 s76, s76, 32
s_or_b32 s78, s78, s76
v_readlane_b32 s76, v2, 5
s_add_u32 s77, s77, s76
s_xor_b32 s76, s76, 32
s_or_b32 s78, s78, s76
v_readlane_b32 s76, v2, 6
s_add_u32 s77, s77, s76
s_xor_b32 s76, s76, 32
s_or_b32 s78, s78, s76
v_readlane_b32 s76, v2, 7
s_add_u32 s77, s77, s76
s_xor_b32 s76, s76, 32
s_or_b32 s78, s78, s76
s_cmp_eq_u32 s77, 256
s_cbranch_scc0 mega_kernel_syhw
v_mov_b32 v252, v2
s_cmp_eq_u32 s78, 0
s_cbranch_scc0 mega_kernel_slowent
v_readlane_b32 s76, v2, 10
v_readlane_b32 s77, v2, 8
s_cmp_eq_u32 s76, 32
s_cbranch_scc0 mega_kernel_syhw
s_cmp_gt_u32 s77, 16
s_cselect_b32 s98, 1, 0
mega_kernel_syhd:
s_xor_b32 s76, s98, 1
s_lshl_b32 s76, s76, 13
s_lshl_b32 s77, s40, 7
s_add_u32 s76, s76, s77
s_add_u32 s76, s76, 69206016
v_mov_b32 v1, 0
mega_kernel_hold:
s_sleep 12
buffer_load_dword v2, v1, s[84:87], s76 offen sc1
s_waitcnt vmcnt(0)
v_cmp_gt_i32 vcc, 1, v2
s_cbranch_vccnz mega_kernel_hold
mega_kernel_nohold:
s_cmp_eq_u32 s91, 2
s_cbranch_scc0 mega_kernel_rd
s_load_dwordx2 s[4:5], s[0:1], 16
s_load_dwordx2 s[8:9], s[0:1], 0
v_lshrrev_b32 v2, 6, v0
v_and_b32 v1, 63, v0
v_readfirstlane_b32 s41, v2
v_lshlrev_b32 v5, 4, v1
s_waitcnt lgkmcnt(0)
s_mov_b32 s6, 8388608
s_mov_b32 s7, 0x00020000
s_mov_b32 s10, 4194304
s_mov_b32 s11, 0x00020000
s_lshl_b32 s43, s40, 8
s_lshl_b32 s44, s41, 6
s_add_u32 s48, s43, s44
s_and_b32 s43, s48, 0x7ff
v_add_u32 v19, s43, v1
v_lshlrev_b32 v19, 7, v19
s_mov_b32 s43, 0
buffer_load_dword v250, v19, s[8:11], s43 offen
s_nop 0
v_lshrrev_b32 v2, 3, v1
s_lshl_b32 s43, s41, 3
v_add_u32 v2, s43, v2
v_bfe_u32 v3, v2, 1, 3
v_and_b32 v4, 7, v1
v_xor_b32 v3, v3, v4
v_lshlrev_b32 v6, 11, v2
v_lshl_add_u32 v6, v3, 4, v6
s_lshl_b32 s46, s41, 10
v_and_b32 v2, 15, v1
v_bfe_u32 v3, v2, 1, 3
v_lshrrev_b32 v4, 4, v1
v_xor_b32 v3, v3, v4
v_lshlrev_b32 v8, 7, v2
v_lshl_add_u32 v8, v3, 4, v8
v_xor_b32 v9, 64, v8
v_add_u32 v10, 0x10000, v8
v_add_u32 v11, 0x10000, v9
v_mov_b32 v7, v5
s_lshl_b32 s47, s40, 2
s_add_u32 s47, s47, s41
s_mov_b32 s42, 0
s_mov_b32 s50, 0
s_add_u32 m0, s46, 0
s_nop 0
buffer_load_dwordx4 v6, s[8:11], s50 offen offset:0 lds
s_add_u32 m0, s46, 3968
s_nop 0
buffer_load_dwordx4 v6, s[8:11], s50 offen offset:128 lds
s_add_u32 m0, s46, 7936
s_nop 0
buffer_load_dwordx4 v6, s[8:11], s50 offen offset:256 lds
s_add_u32 m0, s46, 11904
s_nop 0
buffer_load_dwordx4 v6, s[8:11], s50 offen offset:384 lds
s_add_u32 m0, s46, 15872
s_nop 0
buffer_load_dwordx4 v6, s[8:11], s50 offen offset:512 lds
s_add_u32 m0, s46, 19840
s_nop 0
buffer_load_dwordx4 v6, s[8:11], s50 offen offset:640 lds
s_add_u32 m0, s46, 23808
s_nop 0
buffer_load_dwordx4 v6, s[8:11], s50 offen offset:768 lds
s_add_u32 m0, s46, 27776
s_nop 0
buffer_load_dwordx4 v6, s[8:11], s50 offen offset:896 lds
s_add_u32 m0, s46, 31744
s_nop 0
buffer_load_dwordx4 v6, s[8:11], s50 offen offset:1024 lds
s_add_u32 m0, s46, 35712
s_nop 0
buffer_load_dwordx4 v6, s[8:11], s50 offen offset:1152 lds
s_add_u32 m0, s46, 39680
s_nop 0
buffer_load_dwordx4 v6, s[8:11], s50 offen offset:1280 lds
s_add_u32 m0, s46, 43648
s_nop 0
buffer_load_dwordx4 v6, s[8:11], s50 offen offset:1408 lds
s_add_u32 m0, s46, 47616
s_nop 0
buffer_load_dwordx4 v6, s[8:11], s50 offen offset:1536 lds
s_add_u32 m0, s46, 51584
s_nop 0
buffer_load_dwordx4 v6, s[8:11], s50 offen offset:1664 lds
s_add_u32 m0, s46, 55552
s_nop 0
buffer_load_dwordx4 v6, s[8:11], s50 offen offset:1792 lds
s_add_u32 m0, s46, 59520
s_nop 0
buffer_load_dwordx4 v6, s[8:11], s50 offen offset:1920 lds
v_lshrrev_b32 v2, 2, v1
v_and_b32 v3, 3, v1
v_lshlrev_b32 v16, 13, v2
v_lshl_add_u32 v16, v3, 4, v16
v_add_u32 v16, s48, v16
s_mul_i32 s45, s41, 24576
s_add_u32 s45, s45, 65536
v_bfe_u32 v17, v1, 2, 2
v_lshrrev_b32 v18, 4, v1
v_lshl_add_u32 v17, v18, 3, v17
v_lshlrev_b32 v17, 6, v17
v_lshl_add_u32 v17, v3, 4, v17
v_add_u32 v17, s45, v17
s_and_b32 s43, s40, 3
s_lshl_b32 s43, s43, 2
s_add_u32 s43, s43, s41
s_lshl_b32 s43, s43, 3
v_and_b32 v12, 7, v1
v_add_u32 v12, s43, v12
s_lshr_b32 s43, s40, 2
s_lshl_b32 s43, s43, 10
s_add_u32 s44, s43, 896
s_add_u32 s43, s43, 384
s_cmp_ge_u32 s40, 28
s_cselect_b32 s44, s44, s43
v_mov_b32 v13, s43
v_mov_b32 v14, s44
v_cmp_gt_u32 vcc, 32, v1
s_nop 1
v_cndmask_b32 v13, v14, v13, vcc
v_lshl_add_u32 v12, v12, 13, v13
s_mov_b32 s44, 0
buffer_load_dword v250, v12, s[4:7], s44 offen
s_add_u32 m0, s45, 0
s_mov_b32 s44, 0
buffer_load_dwordx4 v16, s[4:7], s44 offen lds
s_add_u32 m0, s45, 1024
s_mov_b32 s44, 131072
buffer_load_dwordx4 v16, s[4:7], s44 offen lds
s_add_u32 m0, s45, 2048
s_mov_b32 s44, 262144
buffer_load_dwordx4 v16, s[4:7], s44 offen lds
s_add_u32 m0, s45, 3072
s_mov_b32 s44, 393216
buffer_load_dwordx4 v16, s[4:7], s44 offen lds
s_add_u32 m0, s45, 4096
s_mov_b32 s44, 524288
buffer_load_dwordx4 v16, s[4:7], s44 offen lds
s_add_u32 m0, s45, 5120
s_mov_b32 s44, 655360
buffer_load_dwordx4 v16, s[4:7], s44 offen lds
s_add_u32 m0, s45, 6144
s_mov_b32 s44, 786432
buffer_load_dwordx4 v16, s[4:7], s44 offen lds
s_add_u32 m0, s45, 7168
s_mov_b32 s44, 917504
buffer_load_dwordx4 v16, s[4:7], s44 offen lds
s_mov_b32 s44, 1048576
buffer_load_dword v250, v12, s[4:7], s44 offen
s_add_u32 m0, s45, 8192
s_mov_b32 s44, 1048576
buffer_load_dwordx4 v16, s[4:7], s44 offen lds
s_add_u32 m0, s45, 9216
s_mov_b32 s44, 1179648
buffer_load_dwordx4 v16, s[4:7], s44 offen lds
s_add_u32 m0, s45, 10240
s_mov_b32 s44, 1310720
buffer_load_dwordx4 v16, s[4:7], s44 offen lds
s_add_u32 m0, s45, 11264
s_mov_b32 s44, 1441792
buffer_load_dwordx4 v16, s[4:7], s44 offen lds
s_add_u32 m0, s45, 12288
s_mov_b32 s44, 1572864
buffer_load_dwordx4 v16, s[4:7], s44 offen lds
s_add_u32 m0, s45, 13312
s_mov_b32 s44, 1703936
buffer_load_dwordx4 v16, s[4:7], s44 offen lds
s_add_u32 m0, s45, 14336
s_mov_b32 s44, 1835008
buffer_load_dwordx4 v16, s[4:7], s44 offen lds
s_add_u32 m0, s45, 15360
s_mov_b32 s44, 1966080
buffer_load_dwordx4 v16, s[4:7], s44 offen lds
s_mov_b32 s44, 2097152
buffer_load_dword v250, v12, s[4:7], s44 offen
s_add_u32 m0, s45, 16384
s_mov_b32 s44, 2097152
buffer_load_dwordx4 v16, s[4:7], s44 offen lds
s_add_u32 m0, s45, 17408
s_mov_b32 s44, 2228224
buffer_load_dwordx4 v16, s[4:7], s44 offen lds
s_add_u32 m0, s45, 18432
s_mov_b32 s44, 2359296
buffer_load_dwordx4 v16, s[4:7], s44 offen lds
s_add_u32 m0, s45, 19456
s_mov_b32 s44, 2490368
buffer_load_dwordx4 v16, s[4:7], s44 offen lds
s_add_u32 m0, s45, 20480
s_mov_b32 s44, 2621440
buffer_load_dwordx4 v16, s[4:7], s44 offen lds
s_add_u32 m0, s45, 21504
s_mov_b32 s44, 2752512
buffer_load_dwordx4 v16, s[4:7], s44 offen lds
s_add_u32 m0, s45, 22528
s_mov_b32 s44, 2883584
buffer_load_dwordx4 v16, s[4:7], s44 offen lds
s_add_u32 m0, s45, 23552
s_mov_b32 s44, 3014656
buffer_load_dwordx4 v16, s[4:7], s44 offen lds
s_waitcnt vmcnt(18)
s_barrier
ds_read_b64_tr_b16 a[0:1], v17 offset:0
ds_read_b64_tr_b16 a[2:3], v17 offset:256
ds_read_b64_tr_b16 a[4:5], v17 offset:8
ds_read_b64_tr_b16 a[6:7], v17 offset:264
ds_read_b64_tr_b16 a[8:9], v17 offset:2048
ds_read_b64_tr_b16 a[10:11], v17 offset:2304
ds_read_b64_tr_b16 a[12:13], v17 offset:2056
ds_read_b64_tr_b16 a[14:15], v17 offset:2312
s_waitcnt lgkmcnt(0)
ds_read_b64_tr_b16 a[16:17], v17 offset:4096
ds_read_b64_tr_b16 a[18:19], v17 offset:4352
ds_read_b64_tr_b16 a[20:21], v17 offset:4104
ds_read_b64_tr_b16 a[22:23], v17 offset:4360
ds_read_b64_tr_b16 a[24:25], v17 offset:6144
ds_read_b64_tr_b16 a[26:27], v17 offset:6400
ds_read_b64_tr_b16 a[28:29], v17 offset:6152
ds_read_b64_tr_b16 a[30:31], v17 offset:6408
s_waitcnt lgkmcnt(0)
s_mov_b32 s44, 3145728
buffer_load_dword v250, v12, s[4:7], s44 offen
s_add_u32 m0, s45, 0
s_mov_b32 s44, 3145728
buffer_load_dwordx4 v16, s[4:7], s44 offen lds
s_add_u32 m0, s45, 1024
s_mov_b32 s44, 3276800
buffer_load_dwordx4 v16, s[4:7], s44 offen lds
s_add_u32 m0, s45, 2048
s_mov_b32 s44, 3407872
buffer_load_dwordx4 v16, s[4:7], s44 offen lds
s_add_u32 m0, s45, 3072
s_mov_b32 s44, 3538944
buffer_load_dwordx4 v16, s[4:7], s44 offen lds
s_add_u32 m0, s45, 4096
s_mov_b32 s44, 3670016
buffer_load_dwordx4 v16, s[4:7], s44 offen lds
s_add_u32 m0, s45, 5120
s_mov_b32 s44, 3801088
buffer_load_dwordx4 v16, s[4:7], s44 offen lds
s_add_u32 m0, s45, 6144
s_mov_b32 s44, 3932160
buffer_load_dwordx4 v16, s[4:7], s44 offen lds
s_add_u32 m0, s45, 7168
s_mov_b32 s44, 4063232
buffer_load_dwordx4 v16, s[4:7], s44 offen lds
ds_read_b128 v[20:23], v8 offset:0
ds_read_b128 v[24:27], v8 offset:2048
ds_read_b128 v[28:31], v9 offset:0
ds_read_b128 v[32:35], v9 offset:2048
ds_read_b128 v[36:39], v8 offset:4096
ds_read_b128 v[40:43], v8 offset:6144
ds_read_b128 v[44:47], v9 offset:4096
ds_read_b128 v[48:51], v9 offset:6144
s_waitcnt lgkmcnt(0)
v_mfma_f32_16x16x32_bf16 v[52:55], a[0:3], v[20:23], 0
v_mfma_f32_16x16x32_bf16 v[56:59], a[4:7], v[20:23], 0
v_mfma_f32_16x16x32_bf16 v[60:63], a[0:3], v[24:27], 0
v_mfma_f32_16x16x32_bf16 v[64:67], a[4:7], v[24:27], 0
v_mfma_f32_16x16x32_bf16 v[52:55], a[8:11], v[28:31], v[52:55]
v_mfma_f32_16x16x32_bf16 v[56:59], a[12:15], v[28:31], v[56:59]
v_mfma_f32_16x16x32_bf16 v[60:63], a[8:11], v[32:35], v[60:63]
v_mfma_f32_16x16x32_bf16 v[64:67], a[12:15], v[32:35], v[64:67]
v_mfma_f32_16x16x32_bf16 v[52:55], a[16:19], v[36:39], v[52:55]
v_mfma_f32_16x16x32_bf16 v[56:59], a[20:23], v[36:39], v[56:59]
v_mfma_f32_16x16x32_bf16 v[60:63], a[16:19], v[40:43], v[60:63]
v_mfma_f32_16x16x32_bf16 v[64:67], a[20:23], v[40:43], v[64:67]
v_mfma_f32_16x16x32_bf16 v[52:55], a[24:27], v[44:47], v[52:55]
v_mfma_f32_16x16x32_bf16 v[56:59], a[28:31], v[44:47], v[56:59]
v_mfma_f32_16x16x32_bf16 v[60:63], a[24:27], v[48:51], v[60:63]
v_mfma_f32_16x16x32_bf16 v[64:67], a[28:31], v[48:51], v[64:67]
s_waitcnt vmcnt(18)
ds_read_b64_tr_b16 a[32:33], v17 offset:8192
ds_read_b64_tr_b16 a[34:35], v17 offset:8448
ds_read_b64_tr_b16 a[36:37], v17 offset:8200
ds_read_b64_tr_b16 a[38:39], v17 offset:8456
ds_read_b64_tr_b16 a[40:41], v17 offset:10240
ds_read_b64_tr_b16 a[42:43], v17 offset:10496
ds_read_b64_tr_b16 a[44:45], v17 offset:10248
ds_read_b64_tr_b16 a[46:47], v17 offset:10504
s_waitcnt lgkmcnt(0)
ds_read_b64_tr_b16 a[48:49], v17 offset:12288
ds_read_b64_tr_b16 a[50:51], v17 offset:12544
ds_read_b64_tr_b16 a[52:53], v17 offset:12296
ds_read_b64_tr_b16 a[54:55], v17 offset:12552
ds_read_b64_tr_b16 a[56:57], v17 offset:14336
ds_read_b64_tr_b16 a[58:59], v17 offset:14592
ds_read_b64_tr_b16 a[60:61], v17 offset:14344
ds_read_b64_tr_b16 a[62:63], v17 offset:14600
s_waitcnt lgkmcnt(0)
s_mov_b32 s44, 4194304
buffer_load_dword v250, v12, s[4:7], s44 offen
s_add_u32 m0, s45, 8192
s_mov_b32 s44, 4194304
buffer_load_dwordx4 v16, s[4:7], s44 offen lds
s_add_u32 m0, s45, 9216
s_mov_b32 s44, 4325376
buffer_load_dwordx4 v16, s[4:7], s44 offen lds
s_add_u32 m0, s45, 10240
s_mov_b32 s44, 4456448
buffer_load_dwordx4 v16, s[4:7], s44 offen lds
s_add_u32 m0, s45, 11264
s_mov_b32 s44, 4587520
buffer_load_dwordx4 v16, s[4:7], s44 offen lds
s_add_u32 m0, s45, 12288
s_mov_b32 s44, 4718592
buffer_load_dwordx4 v16, s[4:7], s44 offen lds
s_add_u32 m0, s45, 13312
s_mov_b32 s44, 4849664
buffer_load_dwordx4 v16, s[4:7], s44 offen lds
s_add_u32 m0, s45, 14336
s_mov_b32 s44, 4980736
buffer_load_dwordx4 v16, s[4:7], s44 offen lds
s_add_u32 m0, s45, 15360
s_mov_b32 s44, 5111808
buffer_load_dwordx4 v16, s[4:7], s44 offen lds
ds_read_b128 v[20:23], v8 offset:8192
ds_read_b128 v[24:27], v8 offset:10240
ds_read_b128 v[28:31], v9 offset:8192
ds_read_b128 v[32:35], v9 offset:10240
ds_read_b128 v[36:39], v8 offset:12288
ds_read_b128 v[40:43], v8 offset:14336
ds_read_b128 v[44:47], v9 offset:12288
ds_read_b128 v[48:51], v9 offset:14336
s_waitcnt lgkmcnt(0)
v_mfma_f32_16x16x32_bf16 v[52:55], a[32:35], v[20:23], v[52:55]
v_mfma_f32_16x16x32_bf16 v[56:59], a[36:39], v[20:23], v[56:59]
v_mfma_f32_16x16x32_bf16 v[60:63], a[32:35], v[24:27], v[60:63]
v_mfma_f32_16x16x32_bf16 v[64:67], a[36:39], v[24:27], v[64:67]
v_mfma_f32_16x16x32_bf16 v[52:55], a[40:43], v[28:31], v[52:55]
v_mfma_f32_16x16x32_bf16 v[56:59], a[44:47], v[28:31], v[56:59]
v_mfma_f32_16x16x32_bf16 v[60:63], a[40:43], v[32:35], v[60:63]
v_mfma_f32_16x16x32_bf16 v[64:67], a[44:47], v[32:35], v[64:67]
v_mfma_f32_16x16x32_bf16 v[52:55], a[48:51], v[36:39], v[52:55]
v_mfma_f32_16x16x32_bf16 v[56:59], a[52:55], v[36:39], v[56:59]
v_mfma_f32_16x16x32_bf16 v[60:63], a[48:51], v[40:43], v[60:63]
v_mfma_f32_16x16x32_bf16 v[64:67], a[52:55], v[40:43], v[64:67]
v_mfma_f32_16x16x32_bf16 v[52:55], a[56:59], v[44:47], v[52:55]
v_mfma_f32_16x16x32_bf16 v[56:59], a[60:63], v[44:47], v[56:59]
v_mfma_f32_16x16x32_bf16 v[60:63], a[56:59], v[48:51], v[60:63]
v_mfma_f32_16x16x32_bf16 v[64:67], a[60:63], v[48:51], v[64:67]
s_waitcnt vmcnt(18)
ds_read_b64_tr_b16 a[64:65], v17 offset:16384
ds_read_b64_tr_b16 a[66:67], v17 offset:16640
ds_read_b64_tr_b16 a[68:69], v17 offset:16392
ds_read_b64_tr_b16 a[70:71], v17 offset:16648
ds_read_b64_tr_b16 a[72:73], v17 offset:18432
ds_read_b64_tr_b16 a[74:75], v17 offset:18688
ds_read_b64_tr_b16 a[76:77], v17 offset:18440
ds_read_b64_tr_b16 a[78:79], v17 offset:18696
s_waitcnt lgkmcnt(0)
ds_read_b64_tr_b16 a[80:81], v17 offset:20480
ds_read_b64_tr_b16 a[82:83], v17 offset:20736
ds_read_b64_tr_b16 a[84:85], v17 offset:20488
ds_read_b64_tr_b16 a[86:87], v17 offset:20744
ds_read_b64_tr_b16 a[88:89], v17 offset:22528
ds_read_b64_tr_b16 a[90:91], v17 offset:22784
ds_read_b64_tr_b16 a[92:93], v17 offset:22536
ds_read_b64_tr_b16 a[94:95], v17 offset:22792
s_waitcnt lgkmcnt(0)
s_mov_b32 s44, 5242880
buffer_load_dword v250, v12, s[4:7], s44 offen
s_add_u32 m0, s45, 16384
s_mov_b32 s44, 5242880
buffer_load_dwordx4 v16, s[4:7], s44 offen lds
s_add_u32 m0, s45, 17408
s_mov_b32 s44, 5373952
buffer_load_dwordx4 v16, s[4:7], s44 offen lds
s_add_u32 m0, s45, 18432
s_mov_b32 s44, 5505024
buffer_load_dwordx4 v16, s[4:7], s44 offen lds
s_add_u32 m0, s45, 19456
s_mov_b32 s44, 5636096
buffer_load_dwordx4 v16, s[4:7], s44 offen lds
s_add_u32 m0, s45, 20480
s_mov_b32 s44, 5767168
buffer_load_dwordx4 v16, s[4:7], s44 offen lds
s_add_u32 m0, s45, 21504
s_mov_b32 s44, 5898240
buffer_load_dwordx4 v16, s[4:7], s44 offen lds
s_add_u32 m0, s45, 22528
s_mov_b32 s44, 6029312
buffer_load_dwordx4 v16, s[4:7], s44 offen lds
s_add_u32 m0, s45, 23552
s_mov_b32 s44, 6160384
buffer_load_dwordx4 v16, s[4:7], s44 offen lds
ds_read_b128 v[20:23], v8 offset:16384
ds_read_b128 v[24:27], v8 offset:18432
ds_read_b128 v[28:31], v9 offset:16384
ds_read_b128 v[32:35], v9 offset:18432
ds_read_b128 v[36:39], v8 offset:20480
ds_read_b128 v[40:43], v8 offset:22528
ds_read_b128 v[44:47], v9 offset:20480
ds_read_b128 v[48:51], v9 offset:22528
s_waitcnt lgkmcnt(0)
v_mfma_f32_16x16x32_bf16 v[52:55], a[64:67], v[20:23], v[52:55]
v_mfma_f32_16x16x32_bf16 v[56:59], a[68:71], v[20:23], v[56:59]
v_mfma_f32_16x16x32_bf16 v[60:63], a[64:67], v[24:27], v[60:63]
v_mfma_f32_16x16x32_bf16 v[64:67], a[68:71], v[24:27], v[64:67]
v_mfma_f32_16x16x32_bf16 v[52:55], a[72:75], v[28:31], v[52:55]
v_mfma_f32_16x16x32_bf16 v[56:59], a[76:79], v[28:31], v[56:59]
v_mfma_f32_16x16x32_bf16 v[60:63], a[72:75], v[32:35], v[60:63]
v_mfma_f32_16x16x32_bf16 v[64:67], a[76:79], v[32:35], v[64:67]
v_mfma_f32_16x16x32_bf16 v[52:55], a[80:83], v[36:39], v[52:55]
v_mfma_f32_16x16x32_bf16 v[56:59], a[84:87], v[36:39], v[56:59]
v_mfma_f32_16x16x32_bf16 v[60:63], a[80:83], v[40:43], v[60:63]
v_mfma_f32_16x16x32_bf16 v[64:67], a[84:87], v[40:43], v[64:67]
v_mfma_f32_16x16x32_bf16 v[52:55], a[88:91], v[44:47], v[52:55]
v_mfma_f32_16x16x32_bf16 v[56:59], a[92:95], v[44:47], v[56:59]
v_mfma_f32_16x16x32_bf16 v[60:63], a[88:91], v[48:51], v[60:63]
v_mfma_f32_16x16x32_bf16 v[64:67], a[92:95], v[48:51], v[64:67]
s_waitcnt vmcnt(18)
ds_read_b64_tr_b16 a[96:97], v17 offset:0
ds_read_b64_tr_b16 a[98:99], v17 offset:256
ds_read_b64_tr_b16 a[100:101], v17 offset:8
ds_read_b64_tr_b16 a[102:103], v17 offset:264
ds_read_b64_tr_b16 a[104:105], v17 offset:2048
ds_read_b64_tr_b16 a[106:107], v17 offset:2304
ds_read_b64_tr_b16 a[108:109], v17 offset:2056
ds_read_b64_tr_b16 a[110:111], v17 offset:2312
s_waitcnt lgkmcnt(0)
ds_read_b64_tr_b16 a[112:113], v17 offset:4096
ds_read_b64_tr_b16 a[114:115], v17 offset:4352
ds_read_b64_tr_b16 a[116:117], v17 offset:4104
ds_read_b64_tr_b16 a[118:119], v17 offset:4360
ds_read_b64_tr_b16 a[120:121], v17 offset:6144
ds_read_b64_tr_b16 a[122:123], v17 offset:6400
ds_read_b64_tr_b16 a[124:125], v17 offset:6152
ds_read_b64_tr_b16 a[126:127], v17 offset:6408
s_waitcnt lgkmcnt(0)
s_mov_b32 s44, 6291456
buffer_load_dword v250, v12, s[4:7], s44 offen
s_add_u32 m0, s45, 0
s_mov_b32 s44, 6291456
buffer_load_dwordx4 v16, s[4:7], s44 offen lds
s_add_u32 m0, s45, 1024
s_mov_b32 s44, 6422528
buffer_load_dwordx4 v16, s[4:7], s44 offen lds
s_add_u32 m0, s45, 2048
s_mov_b32 s44, 6553600
buffer_load_dwordx4 v16, s[4:7], s44 offen lds
s_add_u32 m0, s45, 3072
s_mov_b32 s44, 6684672
buffer_load_dwordx4 v16, s[4:7], s44 offen lds
s_add_u32 m0, s45, 4096
s_mov_b32 s44, 6815744
buffer_load_dwordx4 v16, s[4:7], s44 offen lds
s_add_u32 m0, s45, 5120
s_mov_b32 s44, 6946816
buffer_load_dwordx4 v16, s[4:7], s44 offen lds
s_add_u32 m0, s45, 6144
s_mov_b32 s44, 7077888
buffer_load_dwordx4 v16, s[4:7], s44 offen lds
s_add_u32 m0, s45, 7168
s_mov_b32 s44, 7208960
buffer_load_dwordx4 v16, s[4:7], s44 offen lds
ds_read_b128 v[20:23], v8 offset:24576
ds_read_b128 v[24:27], v8 offset:26624
ds_read_b128 v[28:31], v9 offset:24576
ds_read_b128 v[32:35], v9 offset:26624
ds_read_b128 v[36:39], v8 offset:28672
ds_read_b128 v[40:43], v8 offset:30720
ds_read_b128 v[44:47], v9 offset:28672
ds_read_b128 v[48:51], v9 offset:30720
s_waitcnt lgkmcnt(0)
v_mfma_f32_16x16x32_bf16 v[52:55], a[96:99], v[20:23], v[52:55]
v_mfma_f32_16x16x32_bf16 v[56:59], a[100:103], v[20:23], v[56:59]
v_mfma_f32_16x16x32_bf16 v[60:63], a[96:99], v[24:27], v[60:63]
v_mfma_f32_16x16x32_bf16 v[64:67], a[100:103], v[24:27], v[64:67]
v_mfma_f32_16x16x32_bf16 v[52:55], a[104:107], v[28:31], v[52:55]
v_mfma_f32_16x16x32_bf16 v[56:59], a[108:111], v[28:31], v[56:59]
v_mfma_f32_16x16x32_bf16 v[60:63], a[104:107], v[32:35], v[60:63]
v_mfma_f32_16x16x32_bf16 v[64:67], a[108:111], v[32:35], v[64:67]
v_mfma_f32_16x16x32_bf16 v[52:55], a[112:115], v[36:39], v[52:55]
v_mfma_f32_16x16x32_bf16 v[56:59], a[116:119], v[36:39], v[56:59]
v_mfma_f32_16x16x32_bf16 v[60:63], a[112:115], v[40:43], v[60:63]
v_mfma_f32_16x16x32_bf16 v[64:67], a[116:119], v[40:43], v[64:67]
v_mfma_f32_16x16x32_bf16 v[52:55], a[120:123], v[44:47], v[52:55]
v_mfma_f32_16x16x32_bf16 v[56:59], a[124:127], v[44:47], v[56:59]
v_mfma_f32_16x16x32_bf16 v[60:63], a[120:123], v[48:51], v[60:63]
v_mfma_f32_16x16x32_bf16 v[64:67], a[124:127], v[48:51], v[64:67]
s_waitcnt vmcnt(18)
ds_read_b64_tr_b16 a[128:129], v17 offset:8192
ds_read_b64_tr_b16 a[130:131], v17 offset:8448
ds_read_b64_tr_b16 a[132:133], v17 offset:8200
ds_read_b64_tr_b16 a[134:135], v17 offset:8456
ds_read_b64_tr_b16 a[136:137], v17 offset:10240
ds_read_b64_tr_b16 a[138:139], v17 offset:10496
ds_read_b64_tr_b16 a[140:141], v17 offset:10248
ds_read_b64_tr_b16 a[142:143], v17 offset:10504
s_waitcnt lgkmcnt(0)
ds_read_b64_tr_b16 a[144:145], v17 offset:12288
ds_read_b64_tr_b16 a[146:147], v17 offset:12544
ds_read_b64_tr_b16 a[148:149], v17 offset:12296
ds_read_b64_tr_b16 a[150:151], v17 offset:12552
ds_read_b64_tr_b16 a[152:153], v17 offset:14336
ds_read_b64_tr_b16 a[154:155], v17 offset:14592
ds_read_b64_tr_b16 a[156:157], v17 offset:14344
ds_read_b64_tr_b16 a[158:159], v17 offset:14600
s_waitcnt lgkmcnt(0)
s_mov_b32 s44, 7340032
buffer_load_dword v250, v12, s[4:7], s44 offen
s_add_u32 m0, s45, 8192
s_mov_b32 s44, 7340032
buffer_load_dwordx4 v16, s[4:7], s44 offen lds
s_add_u32 m0, s45, 9216
s_mov_b32 s44, 7471104
buffer_load_dwordx4 v16, s[4:7], s44 offen lds
s_add_u32 m0, s45, 10240
s_mov_b32 s44, 7602176
buffer_load_dwordx4 v16, s[4:7], s44 offen lds
s_add_u32 m0, s45, 11264
s_mov_b32 s44, 7733248
buffer_load_dwordx4 v16, s[4:7], s44 offen lds
s_add_u32 m0, s45, 12288
s_mov_b32 s44, 7864320
buffer_load_dwordx4 v16, s[4:7], s44 offen lds
s_add_u32 m0, s45, 13312
s_mov_b32 s44, 7995392
buffer_load_dwordx4 v16, s[4:7], s44 offen lds
s_add_u32 m0, s45, 14336
s_mov_b32 s44, 8126464
buffer_load_dwordx4 v16, s[4:7], s44 offen lds
s_add_u32 m0, s45, 15360
s_mov_b32 s44, 8257536
buffer_load_dwordx4 v16, s[4:7], s44 offen lds
ds_read_b128 v[20:23], v8 offset:32768
ds_read_b128 v[24:27], v8 offset:34816
ds_read_b128 v[28:31], v9 offset:32768
ds_read_b128 v[32:35], v9 offset:34816
ds_read_b128 v[36:39], v8 offset:36864
ds_read_b128 v[40:43], v8 offset:38912
ds_read_b128 v[44:47], v9 offset:36864
ds_read_b128 v[48:51], v9 offset:38912
s_waitcnt lgkmcnt(0)
v_mfma_f32_16x16x32_bf16 v[52:55], a[128:131], v[20:23], v[52:55]
v_mfma_f32_16x16x32_bf16 v[56:59], a[132:135], v[20:23], v[56:59]
v_mfma_f32_16x16x32_bf16 v[60:63], a[128:131], v[24:27], v[60:63]
v_mfma_f32_16x16x32_bf16 v[64:67], a[132:135], v[24:27], v[64:67]
v_mfma_f32_16x16x32_bf16 v[52:55], a[136:139], v[28:31], v[52:55]
v_mfma_f32_16x16x32_bf16 v[56:59], a[140:143], v[28:31], v[56:59]
v_mfma_f32_16x16x32_bf16 v[60:63], a[136:139], v[32:35], v[60:63]
v_mfma_f32_16x16x32_bf16 v[64:67], a[140:143], v[32:35], v[64:67]
v_mfma_f32_16x16x32_bf16 v[52:55], a[144:147], v[36:39], v[52:55]
v_mfma_f32_16x16x32_bf16 v[56:59], a[148:151], v[36:39], v[56:59]
v_mfma_f32_16x16x32_bf16 v[60:63], a[144:147], v[40:43], v[60:63]
v_mfma_f32_16x16x32_bf16 v[64:67], a[148:151], v[40:43], v[64:67]
v_mfma_f32_16x16x32_bf16 v[52:55], a[152:155], v[44:47], v[52:55]
v_mfma_f32_16x16x32_bf16 v[56:59], a[156:159], v[44:47], v[56:59]
v_mfma_f32_16x16x32_bf16 v[60:63], a[152:155], v[48:51], v[60:63]
v_mfma_f32_16x16x32_bf16 v[64:67], a[156:159], v[48:51], v[64:67]
s_waitcnt vmcnt(18)
ds_read_b64_tr_b16 a[160:161], v17 offset:16384
ds_read_b64_tr_b16 a[162:163], v17 offset:16640
ds_read_b64_tr_b16 a[164:165], v17 offset:16392
ds_read_b64_tr_b16 a[166:167], v17 offset:16648
ds_read_b64_tr_b16 a[168:169], v17 offset:18432
ds_read_b64_tr_b16 a[170:171], v17 offset:18688
ds_read_b64_tr_b16 a[172:173], v17 offset:18440
ds_read_b64_tr_b16 a[174:175], v17 offset:18696
s_waitcnt lgkmcnt(0)
ds_read_b64_tr_b16 a[176:177], v17 offset:20480
ds_read_b64_tr_b16 a[178:179], v17 offset:20736
ds_read_b64_tr_b16 a[180:181], v17 offset:20488
ds_read_b64_tr_b16 a[182:183], v17 offset:20744
ds_read_b64_tr_b16 a[184:185], v17 offset:22528
ds_read_b64_tr_b16 a[186:187], v17 offset:22784
ds_read_b64_tr_b16 a[188:189], v17 offset:22536
ds_read_b64_tr_b16 a[190:191], v17 offset:22792
s_waitcnt lgkmcnt(0)
ds_read_b128 v[20:23], v8 offset:40960
ds_read_b128 v[24:27], v8 offset:43008
ds_read_b128 v[28:31], v9 offset:40960
ds_read_b128 v[32:35], v9 offset:43008
ds_read_b128 v[36:39], v8 offset:45056
ds_read_b128 v[40:43], v8 offset:47104
ds_read_b128 v[44:47], v9 offset:45056
ds_read_b128 v[48:51], v9 offset:47104
s_waitcnt lgkmcnt(0)
v_mfma_f32_16x16x32_bf16 v[52:55], a[160:163], v[20:23], v[52:55]
v_mfma_f32_16x16x32_bf16 v[56:59], a[164:167], v[20:23], v[56:59]
v_mfma_f32_16x16x32_bf16 v[60:63], a[160:163], v[24:27], v[60:63]
v_mfma_f32_16x16x32_bf16 v[64:67], a[164:167], v[24:27], v[64:67]
v_mfma_f32_16x16x32_bf16 v[52:55], a[168:171], v[28:31], v[52:55]
v_mfma_f32_16x16x32_bf16 v[56:59], a[172:175], v[28:31], v[56:59]
v_mfma_f32_16x16x32_bf16 v[60:63], a[168:171], v[32:35], v[60:63]
v_mfma_f32_16x16x32_bf16 v[64:67], a[172:175], v[32:35], v[64:67]
v_mfma_f32_16x16x32_bf16 v[52:55], a[176:179], v[36:39], v[52:55]
v_mfma_f32_16x16x32_bf16 v[56:59], a[180:183], v[36:39], v[56:59]
v_mfma_f32_16x16x32_bf16 v[60:63], a[176:179], v[40:43], v[60:63]
v_mfma_f32_16x16x32_bf16 v[64:67], a[180:183], v[40:43], v[64:67]
v_mfma_f32_16x16x32_bf16 v[52:55], a[184:187], v[44:47], v[52:55]
v_mfma_f32_16x16x32_bf16 v[56:59], a[188:191], v[44:47], v[56:59]
v_mfma_f32_16x16x32_bf16 v[60:63], a[184:187], v[48:51], v[60:63]
v_mfma_f32_16x16x32_bf16 v[64:67], a[188:191], v[48:51], v[64:67]
s_waitcnt vmcnt(9)
ds_read_b64_tr_b16 a[192:193], v17 offset:0
ds_read_b64_tr_b16 a[194:195], v17 offset:256
ds_read_b64_tr_b16 a[196:197], v17 offset:8
ds_read_b64_tr_b16 a[198:199], v17 offset:264
ds_read_b64_tr_b16 a[200:201], v17 offset:2048
ds_read_b64_tr_b16 a[202:203], v17 offset:2304
ds_read_b64_tr_b16 a[204:205], v17 offset:2056
ds_read_b64_tr_b16 a[206:207], v17 offset:2312
s_waitcnt lgkmcnt(0)
ds_read_b64_tr_b16 a[208:209], v17 offset:4096
ds_read_b64_tr_b16 a[210:211], v17 offset:4352
ds_read_b64_tr_b16 a[212:213], v17 offset:4104
ds_read_b64_tr_b16 a[214:215], v17 offset:4360
ds_read_b64_tr_b16 a[216:217], v17 offset:6144
ds_read_b64_tr_b16 a[218:219], v17 offset:6400
ds_read_b64_tr_b16 a[220:221], v17 offset:6152
ds_read_b64_tr_b16 a[222:223], v17 offset:6408
s_waitcnt lgkmcnt(0)
ds_read_b128 v[20:23], v8 offset:49152
ds_read_b128 v[24:27], v8 offset:51200
ds_read_b128 v[28:31], v9 offset:49152
ds_read_b128 v[32:35], v9 offset:51200
ds_read_b128 v[36:39], v8 offset:53248
ds_read_b128 v[40:43], v8 offset:55296
ds_read_b128 v[44:47], v9 offset:53248
ds_read_b128 v[48:51], v9 offset:55296
s_waitcnt lgkmcnt(0)
v_mfma_f32_16x16x32_bf16 v[52:55], a[192:195], v[20:23], v[52:55]
v_mfma_f32_16x16x32_bf16 v[56:59], a[196:199], v[20:23], v[56:59]
v_mfma_f32_16x16x32_bf16 v[60:63], a[192:195], v[24:27], v[60:63]
v_mfma_f32_16x16x32_bf16 v[64:67], a[196:199], v[24:27], v[64:67]
v_mfma_f32_16x16x32_bf16 v[52:55], a[200:203], v[28:31], v[52:55]
v_mfma_f32_16x16x32_bf16 v[56:59], a[204:207], v[28:31], v[56:59]
v_mfma_f32_16x16x32_bf16 v[60:63], a[200:203], v[32:35], v[60:63]
v_mfma_f32_16x16x32_bf16 v[64:67], a[204:207], v[32:35], v[64:67]
v_mfma_f32_16x16x32_bf16 v[52:55], a[208:211], v[36:39], v[52:55]
v_mfma_f32_16x16x32_bf16 v[56:59], a[212:215], v[36:39], v[56:59]
v_mfma_f32_16x16x32_bf16 v[60:63], a[208:211], v[40:43], v[60:63]
v_mfma_f32_16x16x32_bf16 v[64:67], a[212:215], v[40:43], v[64:67]
v_mfma_f32_16x16x32_bf16 v[52:55], a[216:219], v[44:47], v[52:55]
v_mfma_f32_16x16x32_bf16 v[56:59], a[220:223], v[44:47], v[56:59]
v_mfma_f32_16x16x32_bf16 v[60:63], a[216:219], v[48:51], v[60:63]
v_mfma_f32_16x16x32_bf16 v[64:67], a[220:223], v[48:51], v[64:67]
s_waitcnt vmcnt(0)
ds_read_b64_tr_b16 a[224:225], v17 offset:8192
ds_read_b64_tr_b16 a[226:227], v17 offset:8448
ds_read_b64_tr_b16 a[228:229], v17 offset:8200
ds_read_b64_tr_b16 a[230:231], v17 offset:8456
ds_read_b64_tr_b16 a[232:233], v17 offset:10240
ds_read_b64_tr_b16 a[234:235], v17 offset:10496
ds_read_b64_tr_b16 a[236:237], v17 offset:10248
ds_read_b64_tr_b16 a[238:239], v17 offset:10504
s_waitcnt lgkmcnt(0)
ds_read_b64_tr_b16 a[240:241], v17 offset:12288
ds_read_b64_tr_b16 a[242:243], v17 offset:12544
ds_read_b64_tr_b16 a[244:245], v17 offset:12296
ds_read_b64_tr_b16 a[246:247], v17 offset:12552
ds_read_b64_tr_b16 a[248:249], v17 offset:14336
ds_read_b64_tr_b16 a[250:251], v17 offset:14592
ds_read_b64_tr_b16 a[252:253], v17 offset:14344
ds_read_b64_tr_b16 a[254:255], v17 offset:14600
s_waitcnt lgkmcnt(0)
ds_read_b128 v[20:23], v8 offset:57344
ds_read_b128 v[24:27], v8 offset:59392
ds_read_b128 v[28:31], v9 offset:57344
ds_read_b128 v[32:35], v9 offset:59392
ds_read_b128 v[36:39], v8 offset:61440
ds_read_b128 v[40:43], v8 offset:63488
ds_read_b128 v[44:47], v9 offset:61440
ds_read_b128 v[48:51], v9 offset:63488
s_waitcnt lgkmcnt(0)
v_mfma_f32_16x16x32_bf16 v[52:55], a[224:227], v[20:23], v[52:55]
v_mfma_f32_16x16x32_bf16 v[56:59], a[228:231], v[20:23], v[56:59]
v_mfma_f32_16x16x32_bf16 v[60:63], a[224:227], v[24:27], v[60:63]
v_mfma_f32_16x16x32_bf16 v[64:67], a[228:231], v[24:27], v[64:67]
v_mfma_f32_16x16x32_bf16 v[52:55], a[232:235], v[28:31], v[52:55]
v_mfma_f32_16x16x32_bf16 v[56:59], a[236:239], v[28:31], v[56:59]
v_mfma_f32_16x16x32_bf16 v[60:63], a[232:235], v[32:35], v[60:63]
v_mfma_f32_16x16x32_bf16 v[64:67], a[236:239], v[32:35], v[64:67]
v_mfma_f32_16x16x32_bf16 v[52:55], a[240:243], v[36:39], v[52:55]
v_mfma_f32_16x16x32_bf16 v[56:59], a[244:247], v[36:39], v[56:59]
v_mfma_f32_16x16x32_bf16 v[60:63], a[240:243], v[40:43], v[60:63]
v_mfma_f32_16x16x32_bf16 v[64:67], a[244:247], v[40:43], v[64:67]
v_mfma_f32_16x16x32_bf16 v[52:55], a[248:251], v[44:47], v[52:55]
v_mfma_f32_16x16x32_bf16 v[56:59], a[252:255], v[44:47], v[56:59]
v_mfma_f32_16x16x32_bf16 v[60:63], a[248:251], v[48:51], v[60:63]
v_mfma_f32_16x16x32_bf16 v[64:67], a[252:255], v[48:51], v[64:67]
s_barrier
s_mov_b32 s50, 0x10000
s_add_u32 m0, s46, 65536
s_nop 0
buffer_load_dwordx4 v6, s[8:11], s50 offen offset:0 lds
s_add_u32 m0, s46, 69504
s_nop 0
buffer_load_dwordx4 v6, s[8:11], s50 offen offset:128 lds
s_add_u32 m0, s46, 73472
s_nop 0
buffer_load_dwordx4 v6, s[8:11], s50 offen offset:256 lds
s_add_u32 m0, s46, 77440
s_nop 0
buffer_load_dwordx4 v6, s[8:11], s50 offen offset:384 lds
s_add_u32 m0, s46, 81408
s_nop 0
buffer_load_dwordx4 v6, s[8:11], s50 offen offset:512 lds
s_add_u32 m0, s46, 85376
s_nop 0
buffer_load_dwordx4 v6, s[8:11], s50 offen offset:640 lds
s_add_u32 m0, s46, 89344
s_nop 0
buffer_load_dwordx4 v6, s[8:11], s50 offen offset:768 lds
s_add_u32 m0, s46, 93312
s_nop 0
buffer_load_dwordx4 v6, s[8:11], s50 offen offset:896 lds
s_add_u32 m0, s46, 97280
s_nop 0
buffer_load_dwordx4 v6, s[8:11], s50 offen offset:1024 lds
s_add_u32 m0, s46, 101248
s_nop 0
buffer_load_dwordx4 v6, s[8:11], s50 offen offset:1152 lds
s_add_u32 m0, s46, 105216
s_nop 0
buffer_load_dwordx4 v6, s[8:11], s50 offen offset:1280 lds
s_add_u32 m0, s46, 109184
s_nop 0
buffer_load_dwordx4 v6, s[8:11], s50 offen offset:1408 lds
s_add_u32 m0, s46, 113152
s_nop 0
buffer_load_dwordx4 v6, s[8:11], s50 offen offset:1536 lds
s_add_u32 m0, s46, 117120
s_nop 0
buffer_load_dwordx4 v6, s[8:11], s50 offen offset:1664 lds
s_add_u32 m0, s46, 121088
s_nop 0
buffer_load_dwordx4 v6, s[8:11], s50 offen offset:1792 lds
s_add_u32 m0, s46, 125056
s_nop 0
buffer_load_dwordx4 v6, s[8:11], s50 offen offset:1920 lds
v_and_b32 v3, 15, v0
v_lshlrev_b32 v3, 4, v3
s_branch mega_kernel_syc
mega_kernel_sycw:
s_sleep 4
mega_kernel_syc:
buffer_load_dword v2, v3, s[72:75], 0 offen sc1
s_waitcnt vmcnt(0)
mega_kernel_sycp:
s_cmp_eq_u32 s95, 1
s_cbranch_scc0 mega_kernel_sycf
v_readlane_b32 s76, v2, 14
s_mov_b32 s98, 0
s_cmp_eq_u32 s76, 32
s_cbranch_scc0 mega_kernel_sycw
s_branch mega_kernel_sycd
mega_kernel_sycf:
s_mov_b32 s77, 0
s_mov_b32 s78, 0
v_readlane_b32 s76, v2, 0
s_add_u32 s77, s77, s76
s_xor_b32 s76, s76, 32
s_or_b32 s78, s78, s76
v_readlane_b32 s76, v2, 1
s_add_u32 s77, s77, s76
s_xor_b32 s76, s76, 32
s_or_b32 s78, s78, s76
v_readlane_b32 s76, v2, 2
s_add_u32 s77, s77, s76
s_xor_b32 s76, s76, 32
s_or_b32 s78, s78, s76
v_readlane_b32 s76, v2, 3
s_add_u32 s77, s77, s76
s_xor_b32 s76, s76, 32
s_or_b32 s78, s78, s76
v_readlane_b32 s76, v2, 4
s_add_u32 s77, s77, s76
s_xor_b32 s76, s76, 32
s_or_b32 s78, s78, s76
v_readlane_b32 s76, v2, 5
s_add_u32 s77, s77, s76
s_xor_b32 s76, s76, 32
s_or_b32 s78, s78, s76
v_readlane_b32 s76, v2, 6
s_add_u32 s77, s77, s76
s_xor_b32 s76, s76, 32
s_or_b32 s78, s78, s76
v_readlane_b32 s76, v2, 7
s_add_u32 s77, s77, s76
s_xor_b32 s76, s76, 32
s_or_b32 s78, s78, s76
s_cmp_eq_u32 s77, 256
s_cbranch_scc0 mega_kernel_sycw
v_mov_b32 v252, v2
s_cmp_eq_u32 s78, 0
s_cbranch_scc0 mega_kernel_slowent
v_readlane_b32 s76, v2, 10
v_readlane_b32 s77, v2, 8
s_cmp_eq_u32 s76, 32
s_cbranch_scc0 mega_kernel_sycw
s_cmp_gt_u32 s77, 16
s_cselect_b32 s98, 1, 0
mega_kernel_sycd:
v_lshrrev_b32 v92, 4, v1
v_and_b32 v93, 15, v1
s_and_b32 s52, s41, 1
s_lshr_b32 s53, s41, 1
s_mov_b32 s54, 0x3e0293ee
s_mov_b32 s55, 0
s_mov_b32 s56, 0
v_mov_b32 v97, 0xff800000
v_mov_b32 v241, 0xceabdc6e
v_and_b32 v2, 7, v93
v_lshlrev_b32 v94, 7, v92
v_lshl_add_u32 v94, v2, 4, v94
v_and_b32 v2, 31, v1
v_lshlrev_b32 v95, 3, v2
v_lshrrev_b32 v2, 1, v92
v_lshlrev_b32 v96, 10, v2
v_and_b32 v2, 1, v92
v_lshl_add_u32 v96, v2, 9, v96
v_lshl_add_u32 v96, v93, 4, v96
s_lshl_b32 s43, s40, 14
s_lshl_b32 s44, s53, 12
s_add_u32 s43, s43, s44
s_lshl_b32 s44, s52, 8
s_add_u32 s43, s43, s44
s_add_u32 s43, s43, 134217728
v_add_u32 v96, s43, v96
s_lshl_b32 s43, s52, 4
v_add_u32 v98, s43, v93
v_lshlrev_b32 v2, 2, v92
v_sub_u32 v98, v98, v2
s_mov_b32 s28, 0
s_mov_b32 s29, -1
s_xor_b32 s44, s98, 1
s_lshl_b32 s44, s44, 13
s_lshl_b32 s43, s40, 7
s_add_u32 s43, s43, s44
s_add_u32 s43, s43, 69206016
v_and_b32 v2, 3, v1
v_bfe_u32 v3, v1, 2, 1
v_lshlrev_b32 v99, 12, v3
v_lshl_add_u32 v99, v2, 2, v99
v_add_u32 v99, s43, v99
s_xor_b32 s62, s98, 1
s_lshl_b32 s62, s62, 13
s_lshr_b32 s44, s47, 6
s_lshl_b32 s44, s44, 14
s_add_u32 s62, s62, s44
s_and_b32 s44, s47, 63
s_lshl_b32 s44, s44, 7
s_add_u32 s62, s62, s44
s_add_u32 s62, s62, 69222400
s_lshl_b32 s49, s40, 7
s_lshl_b32 s44, s41, 2
s_add_u32 s49, s49, s44
s_lshl_b32 s44, s98, 13
s_add_u32 s49, s49, s44
s_add_u32 s49, s49, 69255168
s_lshl_b32 s43, s41, 11
s_add_u32 s43, s43, 131072
v_add_u32 v101, s43, v7
s_lshl_b32 s43, s52, 10
s_add_u32 s43, s43, 131072
v_add_u32 v102, s43, v5
v_mov_b32 v16, 0
s_mov_b32 s50, 0
v_mov_b32 v104, 0x3f803f80
v_mov_b32 v105, 0x3f803f80
v_mov_b32 v106, 0x3f803f80
v_mov_b32 v107, 0x3f803f80
v_cmp_gt_i32 s[12:13], 0, v98
v_cmp_gt_i32 s[14:15], 1, v98
v_cmp_gt_i32 s[16:17], 2, v98
v_cmp_gt_i32 s[18:19], 3, v98
v_cmp_gt_i32 s[20:21], 16, v98
v_cmp_gt_i32 s[22:23], 17, v98
v_cmp_gt_i32 s[24:25], 18, v98
v_cmp_gt_i32 s[26:27], 19, v98
s_lshr_b32 s44, s47, 3
s_xor_b32 s44, s44, s98
s_and_b32 s44, s44, 1
s_lshl_b32 s44, s44, 13
s_lshl_b32 s58, s47, 18
s_add_u32 s58, s58, s44
s_add_u32 s58, s58, 0
s_lshr_b32 s44, s47, 4
s_xor_b32 s44, s44, s98
s_and_b32 s44, s44, 1
s_lshl_b32 s44, s44, 13
s_lshl_b32 s59, s47, 17
s_add_u32 s59, s59, s44
s_add_u32 s59, s59, 71303168
s_lshl_b32 s60, s41, 11
s_add_u32 s60, s60, 139264
s_lshl_b32 s61, s41, 10
s_add_u32 s61, s61, 155648
v_add_u32 v94, 155648, v94
s_lshl_b32 s43, s53, 11
s_add_u32 s43, s43, 156160
v_add_u32 v95, s43, v95
v_add_u32 v103, 139264, v5
s_lshl_b32 s43, s53, 12
s_add_u32 s43, s43, 147456
v_add_u32 v240, s43, v5
s_waitcnt vmcnt(0)
v_cvt_pk_bf16_f32 v220, v52, v53
v_cvt_pk_bf16_f32 v221, v54, v55
v_cvt_pk_bf16_f32 v222, v56, v57
v_cvt_pk_bf16_f32 v223, v58, v59
v_cvt_pk_bf16_f32 v224, v60, v61
v_cvt_pk_bf16_f32 v225, v62, v63
v_cvt_pk_bf16_f32 v226, v64, v65
v_cvt_pk_bf16_f32 v227, v66, v67
s_barrier
s_mov_b32 s50, 0x20000
ds_read_b128 v[20:23], v10 offset:0
ds_read_b128 v[24:27], v10 offset:2048
ds_read_b128 v[28:31], v11 offset:0
ds_read_b128 v[32:35], v11 offset:2048
ds_read_b128 v[36:39], v10 offset:4096
ds_read_b128 v[40:43], v10 offset:6144
s_add_u32 m0, s46, 0
s_waitcnt lgkmcnt(4)
v_mfma_f32_16x16x32_bf16 v[52:55], a[0:3], v[20:23], 0
ds_read_b128 v[44:47], v11 offset:4096
v_mfma_f32_16x16x32_bf16 v[56:59], a[4:7], v[20:23], 0
buffer_load_dwordx4 v6, s[8:11], s50 offen offset:0 lds
v_mfma_f32_16x16x32_bf16 v[60:63], a[0:3], v[24:27], 0
ds_read_b128 v[48:51], v11 offset:6144
v_mfma_f32_16x16x32_bf16 v[64:67], a[4:7], v[24:27], 0
s_add_u32 m0, s46, 3968
s_waitcnt lgkmcnt(4)
v_mfma_f32_16x16x32_bf16 v[52:55], a[8:11], v[28:31], v[52:55]
ds_read_b128 v[20:23], v10 offset:8192
v_mfma_f32_16x16x32_bf16 v[56:59], a[12:15], v[28:31], v[56:59]
buffer_load_dwordx4 v6, s[8:11], s50 offen offset:128 lds
v_mfma_f32_16x16x32_bf16 v[60:63], a[8:11], v[32:35], v[60:63]
ds_read_b128 v[24:27], v10 offset:10240
v_mfma_f32_16x16x32_bf16 v[64:67], a[12:15], v[32:35], v[64:67]
s_add_u32 m0, s46, 7936
s_waitcnt lgkmcnt(4)
v_mfma_f32_16x16x32_bf16 v[52:55], a[16:19], v[36:39], v[52:55]
ds_read_b128 v[28:31], v11 offset:8192
v_mfma_f32_16x16x32_bf16 v[56:59], a[20:23], v[36:39], v[56:59]
buffer_load_dwordx4 v6, s[8:11], s50 offen offset:256 lds
v_mfma_f32_16x16x32_bf16 v[60:63], a[16:19], v[40:43], v[60:63]
ds_read_b128 v[32:35], v11 offset:10240
v_mfma_f32_16x16x32_bf16 v[64:67], a[20:23], v[40:43], v[64:67]
s_add_u32 m0, s46, 11904
s_waitcnt lgkmcnt(4)
v_mfma_f32_16x16x32_bf16 v[52:55], a[24:27], v[44:47], v[52:55]
ds_read_b128 v[36:39], v10 offset:12288
v_mfma_f32_16x16x32_bf16 v[56:59], a[28:31], v[44:47], v[56:59]
buffer_load_dwordx4 v6, s[8:11], s50 offen offset:384 lds
v_mfma_f32_16x16x32_bf16 v[60:63], a[24:27], v[48:51], v[60:63]
ds_read_b128 v[40:43], v10 offset:14336
v_mfma_f32_16x16x32_bf16 v[64:67], a[28:31], v[48:51], v[64:67]
s_add_u32 m0, s46, 15872
s_waitcnt lgkmcnt(4)
v_mfma_f32_16x16x32_bf16 v[52:55], a[32:35], v[20:23], v[52:55]
ds_read_b128 v[44:47], v11 offset:12288
v_mfma_f32_16x16x32_bf16 v[56:59], a[36:39], v[20:23], v[56:59]
buffer_load_dwordx4 v6, s[8:11], s50 offen offset:512 lds
v_mfma_f32_16x16x32_bf16 v[60:63], a[32:35], v[24:27], v[60:63]
ds_read_b128 v[48:51], v11 offset:14336
v_mfma_f32_16x16x32_bf16 v[64:67], a[36:39], v[24:27], v[64:67]
s_add_u32 m0, s46, 19840
s_waitcnt lgkmcnt(4)
v_mfma_f32_16x16x32_bf16 v[52:55], a[40:43], v[28:31], v[52:55]
ds_read_b128 v[20:23], v10 offset:16384
v_mfma_f32_16x16x32_bf16 v[56:59], a[44:47], v[28:31], v[56:59]
buffer_load_dwordx4 v6, s[8:11], s50 offen offset:640 lds
v_mfma_f32_16x16x32_bf16 v[60:63], a[40:43], v[32:35], v[60:63]
ds_read_b128 v[24:27], v10 offset:18432
v_mfma_f32_16x16x32_bf16 v[64:67], a[44:47], v[32:35], v[64:67]
s_add_u32 m0, s46, 23808
s_waitcnt lgkmcnt(4)
v_mfma_f32_16x16x32_bf16 v[52:55], a[48:51], v[36:39], v[52:55]
ds_read_b128 v[28:31], v11 offset:16384
v_mfma_f32_16x16x32_bf16 v[56:59], a[52:55], v[36:39], v[56:59]
buffer_load_dwordx4 v6, s[8:11], s50 offen offset:768 lds
v_mfma_f32_16x16x32_bf16 v[60:63], a[48:51], v[40:43], v[60:63]
ds_read_b128 v[32:35], v11 offset:18432
v_mfma_f32_16x16x32_bf16 v[64:67], a[52:55], v[40:43], v[64:67]
s_add_u32 m0, s46, 27776
s_waitcnt lgkmcnt(4)
v_mfma_f32_16x16x32_bf16 v[52:55], a[56:59], v[44:47], v[52:55]
ds_read_b128 v[36:39], v10 offset:20480
v_mfma_f32_16x16x32_bf16 v[56:59], a[60:63], v[44:47], v[56:59]
buffer_load_dwordx4 v6, s[8:11], s50 offen offset:896 lds
v_mfma_f32_16x16x32_bf16 v[60:63], a[56:59], v[48:51], v[60:63]
ds_read_b128 v[40:43], v10 offset:22528
v_mfma_f32_16x16x32_bf16 v[64:67], a[60:63], v[48:51], v[64:67]
s_add_u32 m0, s46, 31744
s_waitcnt lgkmcnt(4)
v_mfma_f32_16x16x32_bf16 v[52:55], a[64:67], v[20:23], v[52:55]
ds_read_b128 v[44:47], v11 offset:20480
v_mfma_f32_16x16x32_bf16 v[56:59], a[68:71], v[20:23], v[56:59]
buffer_load_dwordx4 v6, s[8:11], s50 offen offset:1024 lds
v_mfma_f32_16x16x32_bf16 v[60:63], a[64:67], v[24:27], v[60:63]
ds_read_b128 v[48:51], v11 offset:22528
v_mfma_f32_16x16x32_bf16 v[64:67], a[68:71], v[24:27], v[64:67]
s_add_u32 m0, s46, 35712
s_waitcnt lgkmcnt(4)
v_mfma_f32_16x16x32_bf16 v[52:55], a[72:75], v[28:31], v[52:55]
ds_read_b128 v[20:23], v10 offset:24576
v_mfma_f32_16x16x32_bf16 v[56:59], a[76:79], v[28:31], v[56:59]
buffer_load_dwordx4 v6, s[8:11], s50 offen offset:1152 lds
v_mfma_f32_16x16x32_bf16 v[60:63], a[72:75], v[32:35], v[60:63]
ds_read_b128 v[24:27], v10 offset:26624
v_mfma_f32_16x16x32_bf16 v[64:67], a[76:79], v[32:35], v[64:67]
s_add_u32 m0, s46, 39680
s_waitcnt lgkmcnt(4)
v_mfma_f32_16x16x32_bf16 v[52:55], a[80:83], v[36:39], v[52:55]
ds_read_b128 v[28:31], v11 offset:24576
v_mfma_f32_16x16x32_bf16 v[56:59], a[84:87], v[36:39], v[56:59]
buffer_load_dwordx4 v6, s[8:11], s50 offen offset:1280 lds
v_mfma_f32_16x16x32_bf16 v[60:63], a[80:83], v[40:43], v[60:63]
ds_read_b128 v[32:35], v11 offset:26624
v_mfma_f32_16x16x32_bf16 v[64:67], a[84:87], v[40:43], v[64:67]
s_add_u32 m0, s46, 43648
s_waitcnt lgkmcnt(4)
v_mfma_f32_16x16x32_bf16 v[52:55], a[88:91], v[44:47], v[52:55]
ds_read_b128 v[36:39], v10 offset:28672
v_mfma_f32_16x16x32_bf16 v[56:59], a[92:95], v[44:47], v[56:59]
buffer_load_dwordx4 v6, s[8:11], s50 offen offset:1408 lds
v_mfma_f32_16x16x32_bf16 v[60:63], a[88:91], v[48:51], v[60:63]
ds_read_b128 v[40:43], v10 offset:30720
v_mfma_f32_16x16x32_bf16 v[64:67], a[92:95], v[48:51], v[64:67]
s_add_u32 m0, s46, 47616
s_waitcnt lgkmcnt(4)
v_mfma_f32_16x16x32_bf16 v[52:55], a[96:99], v[20:23], v[52:55]
ds_read_b128 v[44:47], v11 offset:28672
v_mfma_f32_16x16x32_bf16 v[56:59], a[100:103], v[20:23], v[56:59]
buffer_load_dwordx4 v6, s[8:11], s50 offen offset:1536 lds
v_mfma_f32_16x16x32_bf16 v[60:63], a[96:99], v[24:27], v[60:63]
ds_read_b128 v[48:51], v11 offset:30720
v_mfma_f32_16x16x32_bf16 v[64:67], a[100:103], v[24:27], v[64:67]
s_add_u32 m0, s46, 51584
s_waitcnt lgkmcnt(4)
v_mfma_f32_16x16x32_bf16 v[52:55], a[104:107], v[28:31], v[52:55]
ds_read_b128 v[20:23], v10 offset:32768
v_mfma_f32_16x16x32_bf16 v[56:59], a[108:111], v[28:31], v[56:59]
buffer_load_dwordx4 v6, s[8:11], s50 offen offset:1664 lds
v_mfma_f32_16x16x32_bf16 v[60:63], a[104:107], v[32:35], v[60:63]
ds_read_b128 v[24:27], v10 offset:34816
v_mfma_f32_16x16x32_bf16 v[64:67], a[108:111], v[32:35], v[64:67]
s_add_u32 m0, s46, 55552
s_waitcnt lgkmcnt(4)
v_mfma_f32_16x16x32_bf16 v[52:55], a[112:115], v[36:39], v[52:55]
ds_read_b128 v[28:31], v11 offset:32768
v_mfma_f32_16x16x32_bf16 v[56:59], a[116:119], v[36:39], v[56:59]
buffer_load_dwordx4 v6, s[8:11], s50 offen offset:1792 lds
v_mfma_f32_16x16x32_bf16 v[60:63], a[112:115], v[40:43], v[60:63]
ds_read_b128 v[32:35], v11 offset:34816
v_mfma_f32_16x16x32_bf16 v[64:67], a[116:119], v[40:43], v[64:67]
s_add_u32 m0, s46, 59520
s_waitcnt lgkmcnt(4)
v_mfma_f32_16x16x32_bf16 v[52:55], a[120:123], v[44:47], v[52:55]
ds_read_b128 v[36:39], v10 offset:36864
v_mfma_f32_16x16x32_bf16 v[56:59], a[124:127], v[44:47], v[56:59]
buffer_load_dwordx4 v6, s[8:11], s50 offen offset:1920 lds
v_mfma_f32_16x16x32_bf16 v[60:63], a[120:123], v[48:51], v[60:63]
ds_read_b128 v[40:43], v10 offset:38912
v_mfma_f32_16x16x32_bf16 v[64:67], a[124:127], v[48:51], v[64:67]
s_waitcnt lgkmcnt(4)
v_mfma_f32_16x16x32_bf16 v[52:55], a[128:131], v[20:23], v[52:55]
ds_read_b128 v[44:47], v11 offset:36864
v_mfma_f32_16x16x32_bf16 v[56:59], a[132:135], v[20:23], v[56:59]
v_mfma_f32_16x16x32_bf16 v[60:63], a[128:131], v[24:27], v[60:63]
ds_read_b128 v[48:51], v11 offset:38912
v_mfma_f32_16x16x32_bf16 v[64:67], a[132:135], v[24:27], v[64:67]
s_waitcnt lgkmcnt(4)
v_mfma_f32_16x16x32_bf16 v[52:55], a[136:139], v[28:31], v[52:55]
ds_read_b128 v[20:23], v10 offset:40960
v_mfma_f32_16x16x32_bf16 v[56:59], a[140:143], v[28:31], v[56:59]
v_mfma_f32_16x16x32_bf16 v[60:63], a[136:139], v[32:35], v[60:63]
ds_read_b128 v[24:27], v10 offset:43008
v_mfma_f32_16x16x32_bf16 v[64:67], a[140:143], v[32:35], v[64:67]
s_waitcnt lgkmcnt(4)
v_mfma_f32_16x16x32_bf16 v[52:55], a[144:147], v[36:39], v[52:55]
ds_read_b128 v[28:31], v11 offset:40960
v_mfma_f32_16x16x32_bf16 v[56:59], a[148:151], v[36:39], v[56:59]
v_mfma_f32_16x16x32_bf16 v[60:63], a[144:147], v[40:43], v[60:63]
ds_read_b128 v[32:35], v11 offset:43008
v_mfma_f32_16x16x32_bf16 v[64:67], a[148:151], v[40:43], v[64:67]
s_waitcnt lgkmcnt(4)
v_mfma_f32_16x16x32_bf16 v[52:55], a[152:155], v[44:47], v[52:55]
ds_read_b128 v[36:39], v10 offset:45056
v_mfma_f32_16x16x32_bf16 v[56:59], a[156:159], v[44:47], v[56:59]
v_mfma_f32_16x16x32_bf16 v[60:63], a[152:155], v[48:51], v[60:63]
ds_read_b128 v[40:43], v10 offset:47104
v_mfma_f32_16x16x32_bf16 v[64:67], a[156:159], v[48:51], v[64:67]
s_waitcnt lgkmcnt(4)
v_mfma_f32_16x16x32_bf16 v[52:55], a[160:163], v[20:23], v[52:55]
ds_read_b128 v[44:47], v11 offset:45056
v_mfma_f32_16x16x32_bf16 v[56:59], a[164:167], v[20:23], v[56:59]
v_mfma_f32_16x16x32_bf16 v[60:63], a[160:163], v[24:27], v[60:63]
ds_read_b128 v[48:51], v11 offset:47104
v_mfma_f32_16x16x32_bf16 v[64:67], a[164:167], v[24:27], v[64:67]
s_waitcnt lgkmcnt(4)
v_mfma_f32_16x16x32_bf16 v[52:55], a[168:171], v[28:31], v[52:55]
ds_read_b128 v[20:23], v10 offset:49152
v_mfma_f32_16x16x32_bf16 v[56:59], a[172:175], v[28:31], v[56:59]
v_mfma_f32_16x16x32_bf16 v[60:63], a[168:171], v[32:35], v[60:63]
ds_read_b128 v[24:27], v10 offset:51200
v_mfma_f32_16x16x32_bf16 v[64:67], a[172:175], v[32:35], v[64:67]
s_waitcnt lgkmcnt(4)
v_mfma_f32_16x16x32_bf16 v[52:55], a[176:179], v[36:39], v[52:55]
ds_read_b128 v[28:31], v11 offset:49152
v_mfma_f32_16x16x32_bf16 v[56:59], a[180:183], v[36:39], v[56:59]
v_mfma_f32_16x16x32_bf16 v[60:63], a[176:179], v[40:43], v[60:63]
ds_read_b128 v[32:35], v11 offset:51200
v_mfma_f32_16x16x32_bf16 v[64:67], a[180:183], v[40:43], v[64:67]
s_waitcnt lgkmcnt(4)
v_mfma_f32_16x16x32_bf16 v[52:55], a[184:187], v[44:47], v[52:55]
ds_read_b128 v[36:39], v10 offset:53248
v_mfma_f32_16x16x32_bf16 v[56:59], a[188:191], v[44:47], v[56:59]
v_mfma_f32_16x16x32_bf16 v[60:63], a[184:187], v[48:51], v[60:63]
ds_read_b128 v[40:43], v10 offset:55296
v_mfma_f32_16x16x32_bf16 v[64:67], a[188:191], v[48:51], v[64:67]
s_waitcnt lgkmcnt(4)
v_mfma_f32_16x16x32_bf16 v[52:55], a[192:195], v[20:23], v[52:55]
ds_read_b128 v[44:47], v11 offset:53248
v_mfma_f32_16x16x32_bf16 v[56:59], a[196:199], v[20:23], v[56:59]
v_mfma_f32_16x16x32_bf16 v[60:63], a[192:195], v[24:27], v[60:63]
ds_read_b128 v[48:51], v11 offset:55296
v_mfma_f32_16x16x32_bf16 v[64:67], a[196:199], v[24:27], v[64:67]
s_waitcnt lgkmcnt(4)
v_mfma_f32_16x16x32_bf16 v[52:55], a[200:203], v[28:31], v[52:55]
ds_read_b128 v[20:23], v10 offset:57344
v_mfma_f32_16x16x32_bf16 v[56:59], a[204:207], v[28:31], v[56:59]
v_mfma_f32_16x16x32_bf16 v[60:63], a[200:203], v[32:35], v[60:63]
ds_read_b128 v[24:27], v10 offset:59392
v_mfma_f32_16x16x32_bf16 v[64:67], a[204:207], v[32:35], v[64:67]
s_waitcnt lgkmcnt(4)
v_mfma_f32_16x16x32_bf16 v[52:55], a[208:211], v[36:39], v[52:55]
ds_read_b128 v[28:31], v11 offset:57344
v_mfma_f32_16x16x32_bf16 v[56:59], a[212:215], v[36:39], v[56:59]
v_mfma_f32_16x16x32_bf16 v[60:63], a[208:211], v[40:43], v[60:63]
ds_read_b128 v[32:35], v11 offset:59392
v_mfma_f32_16x16x32_bf16 v[64:67], a[212:215], v[40:43], v[64:67]
s_waitcnt lgkmcnt(4)
v_mfma_f32_16x16x32_bf16 v[52:55], a[216:219], v[44:47], v[52:55]
ds_read_b128 v[36:39], v10 offset:61440
v_mfma_f32_16x16x32_bf16 v[56:59], a[220:223], v[44:47], v[56:59]
v_mfma_f32_16x16x32_bf16 v[60:63], a[216:219], v[48:51], v[60:63]
ds_read_b128 v[40:43], v10 offset:63488
v_mfma_f32_16x16x32_bf16 v[64:67], a[220:223], v[48:51], v[64:67]
s_waitcnt lgkmcnt(4)
v_mfma_f32_16x16x32_bf16 v[52:55], a[224:227], v[20:23], v[52:55]
ds_read_b128 v[44:47], v11 offset:61440
v_mfma_f32_16x16x32_bf16 v[56:59], a[228:231], v[20:23], v[56:59]
v_mfma_f32_16x16x32_bf16 v[60:63], a[224:227], v[24:27], v[60:63]
ds_read_b128 v[48:51], v11 offset:63488
v_mfma_f32_16x16x32_bf16 v[64:67], a[228:231], v[24:27], v[64:67]
s_waitcnt lgkmcnt(5)
v_mfma_f32_16x16x32_bf16 v[52:55], a[232:235], v[28:31], v[52:55]
v_mfma_f32_16x16x32_bf16 v[56:59], a[236:239], v[28:31], v[56:59]
s_waitcnt lgkmcnt(4)
v_mfma_f32_16x16x32_bf16 v[60:63], a[232:235], v[32:35], v[60:63]
v_mfma_f32_16x16x32_bf16 v[64:67], a[236:239], v[32:35], v[64:67]
s_waitcnt lgkmcnt(3)
v_mfma_f32_16x16x32_bf16 v[52:55], a[240:243], v[36:39], v[52:55]
v_mfma_f32_16x16x32_bf16 v[56:59], a[244:247], v[36:39], v[56:59]
s_waitcnt lgkmcnt(2)
v_mfma_f32_16x16x32_bf16 v[60:63], a[240:243], v[40:43], v[60:63]
v_mfma_f32_16x16x32_bf16 v[64:67], a[244:247], v[40:43], v[64:67]
s_waitcnt lgkmcnt(1)
v_mfma_f32_16x16x32_bf16 v[52:55], a[248:251], v[44:47], v[52:55]
v_mfma_f32_16x16x32_bf16 v[56:59], a[252:255], v[44:47], v[56:59]
s_waitcnt lgkmcnt(0)
v_mfma_f32_16x16x32_bf16 v[60:63], a[248:251], v[48:51], v[60:63]
v_mfma_f32_16x16x32_bf16 v[64:67], a[252:255], v[48:51], v[64:67]
s_waitcnt vmcnt(0)
s_barrier
s_mov_b32 s50, 0x30000
s_nop 5
v_cvt_pk_bf16_f32 v228, v52, v53
v_cvt_pk_bf16_f32 v229, v54, v55
v_cvt_pk_bf16_f32 v230, v56, v57
v_cvt_pk_bf16_f32 v231, v58, v59
v_cvt_pk_bf16_f32 v232, v60, v61
v_cvt_pk_bf16_f32 v233, v62, v63
v_cvt_pk_bf16_f32 v234, v64, v65
v_cvt_pk_bf16_f32 v235, v66, v67
ds_read_b128 v[20:23], v8 offset:0
ds_read_b128 v[24:27], v8 offset:2048
ds_read_b128 v[28:31], v9 offset:0
ds_read_b128 v[32:35], v9 offset:2048
ds_read_b128 v[36:39], v8 offset:4096
ds_read_b128 v[40:43], v8 offset:6144
s_add_u32 m0, s46, 65536
s_waitcnt lgkmcnt(4)
v_mfma_f32_16x16x32_bf16 v[52:55], a[0:3], v[20:23], 0
ds_read_b128 v[44:47], v9 offset:4096
v_mfma_f32_16x16x32_bf16 v[56:59], a[4:7], v[20:23], 0
buffer_load_dwordx4 v6, s[8:11], s50 offen offset:0 lds
v_mfma_f32_16x16x32_bf16 v[60:63], a[0:3], v[24:27], 0
ds_read_b128 v[48:51], v9 offset:6144
v_mfma_f32_16x16x32_bf16 v[64:67], a[4:7], v[24:27], 0
s_add_u32 m0, s46, 69504
s_waitcnt lgkmcnt(4)
v_mfma_f32_16x16x32_bf16 v[52:55], a[8:11], v[28:31], v[52:55]
ds_read_b128 v[20:23], v8 offset:8192
v_mfma_f32_16x16x32_bf16 v[56:59], a[12:15], v[28:31], v[56:59]
buffer_load_dwordx4 v6, s[8:11], s50 offen offset:128 lds
v_mfma_f32_16x16x32_bf16 v[60:63], a[8:11], v[32:35], v[60:63]
ds_read_b128 v[24:27], v8 offset:10240
v_mfma_f32_16x16x32_bf16 v[64:67], a[12:15], v[32:35], v[64:67]
s_add_u32 m0, s46, 73472
s_waitcnt lgkmcnt(4)
v_mfma_f32_16x16x32_bf16 v[52:55], a[16:19], v[36:39], v[52:55]
ds_read_b128 v[28:31], v9 offset:8192
v_mfma_f32_16x16x32_bf16 v[56:59], a[20:23], v[36:39], v[56:59]
buffer_load_dwordx4 v6, s[8:11], s50 offen offset:256 lds
v_mfma_f32_16x16x32_bf16 v[60:63], a[16:19], v[40:43], v[60:63]
ds_read_b128 v[32:35], v9 offset:10240
v_mfma_f32_16x16x32_bf16 v[64:67], a[20:23], v[40:43], v[64:67]
s_add_u32 m0, s46, 77440
s_waitcnt lgkmcnt(4)
v_mfma_f32_16x16x32_bf16 v[52:55], a[24:27], v[44:47], v[52:55]
ds_read_b128 v[36:39], v8 offset:12288
v_mfma_f32_16x16x32_bf16 v[56:59], a[28:31], v[44:47], v[56:59]
buffer_load_dwordx4 v6, s[8:11], s50 offen offset:384 lds
v_mfma_f32_16x16x32_bf16 v[60:63], a[24:27], v[48:51], v[60:63]
ds_read_b128 v[40:43], v8 offset:14336
v_mfma_f32_16x16x32_bf16 v[64:67], a[28:31], v[48:51], v[64:67]
s_add_u32 m0, s46, 81408
s_waitcnt lgkmcnt(4)
v_mfma_f32_16x16x32_bf16 v[52:55], a[32:35], v[20:23], v[52:55]
ds_read_b128 v[44:47], v9 offset:12288
v_mfma_f32_16x16x32_bf16 v[56:59], a[36:39], v[20:23], v[56:59]
buffer_load_dwordx4 v6, s[8:11], s50 offen offset:512 lds
v_mfma_f32_16x16x32_bf16 v[60:63], a[32:35], v[24:27], v[60:63]
ds_read_b128 v[48:51], v9 offset:14336
v_mfma_f32_16x16x32_bf16 v[64:67], a[36:39], v[24:27], v[64:67]
s_add_u32 m0, s46, 85376
s_waitcnt lgkmcnt(4)
v_mfma_f32_16x16x32_bf16 v[52:55], a[40:43], v[28:31], v[52:55]
ds_read_b128 v[20:23], v8 offset:16384
v_mfma_f32_16x16x32_bf16 v[56:59], a[44:47], v[28:31], v[56:59]
buffer_load_dwordx4 v6, s[8:11], s50 offen offset:640 lds
v_mfma_f32_16x16x32_bf16 v[60:63], a[40:43], v[32:35], v[60:63]
ds_read_b128 v[24:27], v8 offset:18432
v_mfma_f32_16x16x32_bf16 v[64:67], a[44:47], v[32:35], v[64:67]
s_add_u32 m0, s46, 89344
s_waitcnt lgkmcnt(4)
v_mfma_f32_16x16x32_bf16 v[52:55], a[48:51], v[36:39], v[52:55]
ds_read_b128 v[28:31], v9 offset:16384
v_mfma_f32_16x16x32_bf16 v[56:59], a[52:55], v[36:39], v[56:59]
buffer_load_dwordx4 v6, s[8:11], s50 offen offset:768 lds
v_mfma_f32_16x16x32_bf16 v[60:63], a[48:51], v[40:43], v[60:63]
ds_read_b128 v[32:35], v9 offset:18432
v_mfma_f32_16x16x32_bf16 v[64:67], a[52:55], v[40:43], v[64:67]
s_add_u32 m0, s46, 93312
s_waitcnt lgkmcnt(4)
v_mfma_f32_16x16x32_bf16 v[52:55], a[56:59], v[44:47], v[52:55]
ds_read_b128 v[36:39], v8 offset:20480
v_mfma_f32_16x16x32_bf16 v[56:59], a[60:63], v[44:47], v[56:59]
buffer_load_dwordx4 v6, s[8:11], s50 offen offset:896 lds
v_mfma_f32_16x16x32_bf16 v[60:63], a[56:59], v[48:51], v[60:63]
ds_read_b128 v[40:43], v8 offset:22528
v_mfma_f32_16x16x32_bf16 v[64:67], a[60:63], v[48:51], v[64:67]
s_add_u32 m0, s46, 97280
s_waitcnt lgkmcnt(4)
v_mfma_f32_16x16x32_bf16 v[52:55], a[64:67], v[20:23], v[52:55]
ds_read_b128 v[44:47], v9 offset:20480
v_mfma_f32_16x16x32_bf16 v[56:59], a[68:71], v[20:23], v[56:59]
buffer_load_dwordx4 v6, s[8:11], s50 offen offset:1024 lds
v_mfma_f32_16x16x32_bf16 v[60:63], a[64:67], v[24:27], v[60:63]
ds_read_b128 v[48:51], v9 offset:22528
v_mfma_f32_16x16x32_bf16 v[64:67], a[68:71], v[24:27], v[64:67]
s_add_u32 m0, s46, 101248
s_waitcnt lgkmcnt(4)
v_mfma_f32_16x16x32_bf16 v[52:55], a[72:75], v[28:31], v[52:55]
ds_read_b128 v[20:23], v8 offset:24576
v_mfma_f32_16x16x32_bf16 v[56:59], a[76:79], v[28:31], v[56:59]
buffer_load_dwordx4 v6, s[8:11], s50 offen offset:1152 lds
v_mfma_f32_16x16x32_bf16 v[60:63], a[72:75], v[32:35], v[60:63]
ds_read_b128 v[24:27], v8 offset:26624
v_mfma_f32_16x16x32_bf16 v[64:67], a[76:79], v[32:35], v[64:67]
s_add_u32 m0, s46, 105216
s_waitcnt lgkmcnt(4)
v_mfma_f32_16x16x32_bf16 v[52:55], a[80:83], v[36:39], v[52:55]
ds_read_b128 v[28:31], v9 offset:24576
v_mfma_f32_16x16x32_bf16 v[56:59], a[84:87], v[36:39], v[56:59]
buffer_load_dwordx4 v6, s[8:11], s50 offen offset:1280 lds
v_mfma_f32_16x16x32_bf16 v[60:63], a[80:83], v[40:43], v[60:63]
ds_read_b128 v[32:35], v9 offset:26624
v_mfma_f32_16x16x32_bf16 v[64:67], a[84:87], v[40:43], v[64:67]
s_add_u32 m0, s46, 109184
s_waitcnt lgkmcnt(4)
v_mfma_f32_16x16x32_bf16 v[52:55], a[88:91], v[44:47], v[52:55]
ds_read_b128 v[36:39], v8 offset:28672
v_mfma_f32_16x16x32_bf16 v[56:59], a[92:95], v[44:47], v[56:59]
buffer_load_dwordx4 v6, s[8:11], s50 offen offset:1408 lds
v_mfma_f32_16x16x32_bf16 v[60:63], a[88:91], v[48:51], v[60:63]
ds_read_b128 v[40:43], v8 offset:30720
v_mfma_f32_16x16x32_bf16 v[64:67], a[92:95], v[48:51], v[64:67]
s_add_u32 m0, s46, 113152
s_waitcnt lgkmcnt(4)
v_mfma_f32_16x16x32_bf16 v[52:55], a[96:99], v[20:23], v[52:55]
ds_read_b128 v[44:47], v9 offset:28672
v_mfma_f32_16x16x32_bf16 v[56:59], a[100:103], v[20:23], v[56:59]
buffer_load_dwordx4 v6, s[8:11], s50 offen offset:1536 lds
v_mfma_f32_16x16x32_bf16 v[60:63], a[96:99], v[24:27], v[60:63]
ds_read_b128 v[48:51], v9 offset:30720
v_mfma_f32_16x16x32_bf16 v[64:67], a[100:103], v[24:27], v[64:67]
s_add_u32 m0, s46, 117120
s_waitcnt lgkmcnt(4)
v_mfma_f32_16x16x32_bf16 v[52:55], a[104:107], v[28:31], v[52:55]
ds_read_b128 v[20:23], v8 offset:32768
v_mfma_f32_16x16x32_bf16 v[56:59], a[108:111], v[28:31], v[56:59]
buffer_load_dwordx4 v6, s[8:11], s50 offen offset:1664 lds
v_mfma_f32_16x16x32_bf16 v[60:63], a[104:107], v[32:35], v[60:63]
ds_read_b128 v[24:27], v8 offset:34816
v_mfma_f32_16x16x32_bf16 v[64:67], a[108:111], v[32:35], v[64:67]
s_add_u32 m0, s46, 121088
s_waitcnt lgkmcnt(4)
v_mfma_f32_16x16x32_bf16 v[52:55], a[112:115], v[36:39], v[52:55]
ds_read_b128 v[28:31], v9 offset:32768
v_mfma_f32_16x16x32_bf16 v[56:59], a[116:119], v[36:39], v[56:59]
buffer_load_dwordx4 v6, s[8:11], s50 offen offset:1792 lds
v_mfma_f32_16x16x32_bf16 v[60:63], a[112:115], v[40:43], v[60:63]
ds_read_b128 v[32:35], v9 offset:34816
v_mfma_f32_16x16x32_bf16 v[64:67], a[116:119], v[40:43], v[64:67]
s_add_u32 m0, s46, 125056
s_waitcnt lgkmcnt(4)
v_mfma_f32_16x16x32_bf16 v[52:55], a[120:123], v[44:47], v[52:55]
ds_read_b128 v[36:39], v8 offset:36864
v_mfma_f32_16x16x32_bf16 v[56:59], a[124:127], v[44:47], v[56:59]
buffer_load_dwordx4 v6, s[8:11], s50 offen offset:1920 lds
v_mfma_f32_16x16x32_bf16 v[60:63], a[120:123], v[48:51], v[60:63]
ds_read_b128 v[40:43], v8 offset:38912
v_mfma_f32_16x16x32_bf16 v[64:67], a[124:127], v[48:51], v[64:67]
s_waitcnt lgkmcnt(4)
v_mfma_f32_16x16x32_bf16 v[52:55], a[128:131], v[20:23], v[52:55]
ds_read_b128 v[44:47], v9 offset:36864
v_mfma_f32_16x16x32_bf16 v[56:59], a[132:135], v[20:23], v[56:59]
v_mfma_f32_16x16x32_bf16 v[60:63], a[128:131], v[24:27], v[60:63]
ds_read_b128 v[48:51], v9 offset:38912
v_mfma_f32_16x16x32_bf16 v[64:67], a[132:135], v[24:27], v[64:67]
s_waitcnt lgkmcnt(4)
v_mfma_f32_16x16x32_bf16 v[52:55], a[136:139], v[28:31], v[52:55]
ds_read_b128 v[20:23], v8 offset:40960
v_mfma_f32_16x16x32_bf16 v[56:59], a[140:143], v[28:31], v[56:59]
v_mfma_f32_16x16x32_bf16 v[60:63], a[136:139], v[32:35], v[60:63]
ds_read_b128 v[24:27], v8 offset:43008
v_mfma_f32_16x16x32_bf16 v[64:67], a[140:143], v[32:35], v[64:67]
s_waitcnt lgkmcnt(4)
v_mfma_f32_16x16x32_bf16 v[52:55], a[144:147], v[36:39], v[52:55]
ds_read_b128 v[28:31], v9 offset:40960
v_mfma_f32_16x16x32_bf16 v[56:59], a[148:151], v[36:39], v[56:59]
v_mfma_f32_16x16x32_bf16 v[60:63], a[144:147], v[40:43], v[60:63]
ds_read_b128 v[32:35], v9 offset:43008
v_mfma_f32_16x16x32_bf16 v[64:67], a[148:151], v[40:43], v[64:67]
s_waitcnt lgkmcnt(4)
v_mfma_f32_16x16x32_bf16 v[52:55], a[152:155], v[44:47], v[52:55]
ds_read_b128 v[36:39], v8 offset:45056
v_mfma_f32_16x16x32_bf16 v[56:59], a[156:159], v[44:47], v[56:59]
v_mfma_f32_16x16x32_bf16 v[60:63], a[152:155], v[48:51], v[60:63]
ds_read_b128 v[40:43], v8 offset:47104
v_mfma_f32_16x16x32_bf16 v[64:67], a[156:159], v[48:51], v[64:67]
s_waitcnt lgkmcnt(4)
v_mfma_f32_16x16x32_bf16 v[52:55], a[160:163], v[20:23], v[52:55]
ds_read_b128 v[44:47], v9 offset:45056
v_mfma_f32_16x16x32_bf16 v[56:59], a[164:167], v[20:23], v[56:59]
v_mfma_f32_16x16x32_bf16 v[60:63], a[160:163], v[24:27], v[60:63]
ds_read_b128 v[48:51], v9 offset:47104
v_mfma_f32_16x16x32_bf16 v[64:67], a[164:167], v[24:27], v[64:67]
s_waitcnt lgkmcnt(4)
v_mfma_f32_16x16x32_bf16 v[52:55], a[168:171], v[28:31], v[52:55]
ds_read_b128 v[20:23], v8 offset:49152
v_mfma_f32_16x16x32_bf16 v[56:59], a[172:175], v[28:31], v[56:59]
v_mfma_f32_16x16x32_bf16 v[60:63], a[168:171], v[32:35], v[60:63]
ds_read_b128 v[24:27], v8 offset:51200
v_mfma_f32_16x16x32_bf16 v[64:67], a[172:175], v[32:35], v[64:67]
s_waitcnt lgkmcnt(4)
v_mfma_f32_16x16x32_bf16 v[52:55], a[176:179], v[36:39], v[52:55]
ds_read_b128 v[28:31], v9 offset:49152
v_mfma_f32_16x16x32_bf16 v[56:59], a[180:183], v[36:39], v[56:59]
v_mfma_f32_16x16x32_bf16 v[60:63], a[176:179], v[40:43], v[60:63]
ds_read_b128 v[32:35], v9 offset:51200
v_mfma_f32_16x16x32_bf16 v[64:67], a[180:183], v[40:43], v[64:67]
s_waitcnt lgkmcnt(4)
v_mfma_f32_16x16x32_bf16 v[52:55], a[184:187], v[44:47], v[52:55]
ds_read_b128 v[36:39], v8 offset:53248
v_mfma_f32_16x16x32_bf16 v[56:59], a[188:191], v[44:47], v[56:59]
v_mfma_f32_16x16x32_bf16 v[60:63], a[184:187], v[48:51], v[60:63]
ds_read_b128 v[40:43], v8 offset:55296
v_mfma_f32_16x16x32_bf16 v[64:67], a[188:191], v[48:51], v[64:67]
s_waitcnt lgkmcnt(4)
v_mfma_f32_16x16x32_bf16 v[52:55], a[192:195], v[20:23], v[52:55]
ds_read_b128 v[44:47], v9 offset:53248
v_mfma_f32_16x16x32_bf16 v[56:59], a[196:199], v[20:23], v[56:59]
v_mfma_f32_16x16x32_bf16 v[60:63], a[192:195], v[24:27], v[60:63]
ds_read_b128 v[48:51], v9 offset:55296
v_mfma_f32_16x16x32_bf16 v[64:67], a[196:199], v[24:27], v[64:67]
s_waitcnt lgkmcnt(4)
v_mfma_f32_16x16x32_bf16 v[52:55], a[200:203], v[28:31], v[52:55]
ds_read_b128 v[20:23], v8 offset:57344
v_mfma_f32_16x16x32_bf16 v[56:59], a[204:207], v[28:31], v[56:59]
v_mfma_f32_16x16x32_bf16 v[60:63], a[200:203], v[32:35], v[60:63]
ds_read_b128 v[24:27], v8 offset:59392
v_mfma_f32_16x16x32_bf16 v[64:67], a[204:207], v[32:35], v[64:67]
s_waitcnt lgkmcnt(4)
v_mfma_f32_16x16x32_bf16 v[52:55], a[208:211], v[36:39], v[52:55]
ds_read_b128 v[28:31], v9 offset:57344
v_mfma_f32_16x16x32_bf16 v[56:59], a[212:215], v[36:39], v[56:59]
v_mfma_f32_16x16x32_bf16 v[60:63], a[208:211], v[40:43], v[60:63]
ds_read_b128 v[32:35], v9 offset:59392
v_mfma_f32_16x16x32_bf16 v[64:67], a[212:215], v[40:43], v[64:67]
s_waitcnt lgkmcnt(4)
v_mfma_f32_16x16x32_bf16 v[52:55], a[216:219], v[44:47], v[52:55]
ds_read_b128 v[36:39], v8 offset:61440
v_mfma_f32_16x16x32_bf16 v[56:59], a[220:223], v[44:47], v[56:59]
v_mfma_f32_16x16x32_bf16 v[60:63], a[216:219], v[48:51], v[60:63]
ds_read_b128 v[40:43], v8 offset:63488
v_mfma_f32_16x16x32_bf16 v[64:67], a[220:223], v[48:51], v[64:67]
s_waitcnt lgkmcnt(4)
v_mfma_f32_16x16x32_bf16 v[52:55], a[224:227], v[20:23], v[52:55]
ds_read_b128 v[44:47], v9 offset:61440
v_mfma_f32_16x16x32_bf16 v[56:59], a[228:231], v[20:23], v[56:59]
v_mfma_f32_16x16x32_bf16 v[60:63], a[224:227], v[24:27], v[60:63]
ds_read_b128 v[48:51], v9 offset:63488
v_mfma_f32_16x16x32_bf16 v[64:67], a[228:231], v[24:27], v[64:67]
s_waitcnt lgkmcnt(5)
v_mfma_f32_16x16x32_bf16 v[52:55], a[232:235], v[28:31], v[52:55]
v_mfma_f32_16x16x32_bf16 v[56:59], a[236:239], v[28:31], v[56:59]
s_waitcnt lgkmcnt(4)
v_mfma_f32_16x16x32_bf16 v[60:63], a[232:235], v[32:35], v[60:63]
v_mfma_f32_16x16x32_bf16 v[64:67], a[236:239], v[32:35], v[64:67]
s_waitcnt lgkmcnt(3)
v_mfma_f32_16x16x32_bf16 v[52:55], a[240:243], v[36:39], v[52:55]
v_mfma_f32_16x16x32_bf16 v[56:59], a[244:247], v[36:39], v[56:59]
s_waitcnt lgkmcnt(2)
v_mfma_f32_16x16x32_bf16 v[60:63], a[240:243], v[40:43], v[60:63]
v_mfma_f32_16x16x32_bf16 v[64:67], a[244:247], v[40:43], v[64:67]
s_waitcnt lgkmcnt(1)
v_mfma_f32_16x16x32_bf16 v[68:71], a[248:251], v[44:47], v[52:55]
v_mfma_f32_16x16x32_bf16 v[72:75], a[252:255], v[44:47], v[56:59]
s_waitcnt lgkmcnt(0)
v_mfma_f32_16x16x32_bf16 v[76:79], a[248:251], v[48:51], v[60:63]
v_mfma_f32_16x16x32_bf16 v[80:83], a[252:255], v[48:51], v[64:67]
s_waitcnt vmcnt(0)
mega_kernel_q_loop:
s_barrier
s_cmp_gt_i32 s55, s42
s_cbranch_scc1 mega_kernel_q_kv1k
mega_kernel_q_kv1w:
v_mov_b32 v2, 0
s_mov_b64 exec, 0xff
buffer_atomic_add v2, v99, s[84:87], 0 offen sc0 sc1
s_mov_b64 exec, -1
s_waitcnt vmcnt(0)
v_min_i32_dpp v2, v2, v2 quad_perm:[1,0,3,2] row_mask:0xf bank_mask:0xf
s_nop 1
v_min_i32_dpp v2, v2, v2 quad_perm:[2,3,0,1] row_mask:0xf bank_mask:0xf
s_nop 1
v_min_i32_dpp v2, v2, v2 row_half_mirror row_mask:0xf bank_mask:0xf
s_nop 0
v_readfirstlane_b32 s55, v2
s_cmp_gt_i32 s55, s42
s_cbranch_scc1 mega_kernel_q_kv1k
s_sleep 4
s_branch mega_kernel_q_kv1w
mega_kernel_q_kv1k:
s_cmp_ge_u32 s42, 61
s_cbranch_scc0 mega_kernel_q_nl1
s_add_u32 s51, s47, s42
s_bfe_u32 s57, s51, 0x40002
s_lshl_b32 s57, s57, 14
s_and_b32 s66, s51, 3
s_lshl_b32 s66, s66, 11
s_add_u32 s66, s66, s57
s_add_u32 s66, s66, s58
s_add_u32 s67, s66, 33554432
s_bfe_u32 s57, s51, 0x30003
s_lshl_b32 s57, s57, 14
s_and_b32 s68, s51, 7
s_lshl_b32 s68, s68, 10
s_add_u32 s68, s68, s57
s_add_u32 s68, s68, s59
s_add_u32 s50, s42, 4
s_min_u32 s50, s50, 63
s_lshl_b32 s50, s50, 16
s_cmp_gt_i32 s56, s42
s_cselect_b32 s30, 1, 0
s_add_u32 m0, s60, 0
s_nop 0
buffer_load_dwordx4 v5, s[84:87], s66 offen offset:0 sc1 lds
s_add_u32 m0, s60, 0
s_nop 0
buffer_load_dwordx4 v5, s[84:87], s66 offen offset:1024 sc1 lds
s_add_u32 m0, s60, 8192
s_nop 0
buffer_load_dwordx4 v5, s[84:87], s67 offen offset:0 sc1 lds
s_add_u32 m0, s60, 8192
s_nop 0
buffer_load_dwordx4 v5, s[84:87], s67 offen offset:1024 sc1 lds
s_cmp_eq_u32 s30, 1
s_cbranch_scc0 mega_kernel_q_kx1
s_mov_b32 m0, s61
s_nop 0
buffer_load_dwordx4 v5, s[84:87], s68 offen sc1 lds
mega_kernel_q_kx1:
v_mov_b64 v[84:85], v[220:221]
v_mov_b64 v[86:87], v[222:223]
v_mov_b64 v[88:89], v[224:225]
v_mov_b64 v[90:91], v[226:227]
v_mov_b64 v[220:221], v[228:229]
v_mov_b64 v[222:223], v[230:231]
v_mov_b64 v[224:225], v[232:233]
v_mov_b64 v[226:227], v[234:235]
v_cvt_pk_bf16_f32 v228, v68, v69
v_cvt_pk_bf16_f32 v229, v70, v71
v_cvt_pk_bf16_f32 v230, v72, v73
v_cvt_pk_bf16_f32 v231, v74, v75
v_cvt_pk_bf16_f32 v232, v76, v77
v_cvt_pk_bf16_f32 v233, v78, v79
v_cvt_pk_bf16_f32 v234, v80, v81
v_cvt_pk_bf16_f32 v235, v82, v83
ds_write_b128 v101, v[84:87]
ds_write_b128 v101, v[88:91] offset:1024
s_waitcnt vmcnt(4)
v_mov_b32 v17, s42
s_mov_b64 exec, 1
buffer_store_dword v17, v16, s[84:87], s49 offen sc1
s_mov_b64 exec, -1
s_branch mega_kernel_q_jl1
mega_kernel_q_nl1:
ds_read_b128 v[20:23], v10 offset:0
ds_read_b128 v[24:27], v10 offset:2048
ds_read_b128 v[28:31], v11 offset:0
ds_read_b128 v[32:35], v11 offset:2048
ds_read_b128 v[36:39], v10 offset:4096
ds_read_b128 v[40:43], v10 offset:6144
s_add_u32 s51, s47, s42
s_bfe_u32 s57, s51, 0x40002
s_lshl_b32 s57, s57, 14
s_and_b32 s66, s51, 3
s_lshl_b32 s66, s66, 11
s_add_u32 s66, s66, s57
s_add_u32 s66, s66, s58
s_add_u32 s67, s66, 33554432
s_bfe_u32 s57, s51, 0x30003
s_lshl_b32 s57, s57, 14
s_and_b32 s68, s51, 7
s_lshl_b32 s68, s68, 10
s_add_u32 s68, s68, s57
s_add_u32 s68, s68, s59
s_add_u32 s50, s42, 4
s_min_u32 s50, s50, 63
s_lshl_b32 s50, s50, 16
s_cmp_gt_i32 s56, s42
s_cselect_b32 s30, 1, 0
s_add_u32 m0, s60, 0
s_waitcnt lgkmcnt(4)
v_mfma_f32_16x16x32_bf16 v[52:55], a[0:3], v[20:23], 0
ds_read_b128 v[44:47], v11 offset:4096
v_mfma_f32_16x16x32_bf16 v[56:59], a[4:7], v[20:23], 0
buffer_load_dwordx4 v5, s[84:87], s66 offen offset:0 sc1 lds
v_mfma_f32_16x16x32_bf16 v[60:63], a[0:3], v[24:27], 0
ds_read_b128 v[48:51], v11 offset:6144
v_mfma_f32_16x16x32_bf16 v[64:67], a[4:7], v[24:27], 0
s_add_u32 m0, s60, 0
s_waitcnt lgkmcnt(4)
v_mfma_f32_16x16x32_bf16 v[52:55], a[8:11], v[28:31], v[52:55]
ds_read_b128 v[20:23], v10 offset:8192
v_mfma_f32_16x16x32_bf16 v[56:59], a[12:15], v[28:31], v[56:59]
buffer_load_dwordx4 v5, s[84:87], s66 offen offset:1024 sc1 lds
v_mfma_f32_16x16x32_bf16 v[60:63], a[8:11], v[32:35], v[60:63]
ds_read_b128 v[24:27], v10 offset:10240
v_mfma_f32_16x16x32_bf16 v[64:67], a[12:15], v[32:35], v[64:67]
s_add_u32 m0, s60, 8192
s_waitcnt lgkmcnt(4)
v_mfma_f32_16x16x32_bf16 v[52:55], a[16:19], v[36:39], v[52:55]
ds_read_b128 v[28:31], v11 offset:8192
v_mfma_f32_16x16x32_bf16 v[56:59], a[20:23], v[36:39], v[56:59]
buffer_load_dwordx4 v5, s[84:87], s67 offen offset:0 sc1 lds
v_mfma_f32_16x16x32_bf16 v[60:63], a[16:19], v[40:43], v[60:63]
ds_read_b128 v[32:35], v11 offset:10240
v_mfma_f32_16x16x32_bf16 v[64:67], a[20:23], v[40:43], v[64:67]
s_add_u32 m0, s60, 8192
s_waitcnt lgkmcnt(4)
v_mfma_f32_16x16x32_bf16 v[52:55], a[24:27], v[44:47], v[52:55]
ds_read_b128 v[36:39], v10 offset:12288
v_mfma_f32_16x16x32_bf16 v[56:59], a[28:31], v[44:47], v[56:59]
buffer_load_dwordx4 v5, s[84:87], s67 offen offset:1024 sc1 lds
v_mfma_f32_16x16x32_bf16 v[60:63], a[24:27], v[48:51], v[60:63]
ds_read_b128 v[40:43], v10 offset:14336
v_mfma_f32_16x16x32_bf16 v[64:67], a[28:31], v[48:51], v[64:67]
s_waitcnt lgkmcnt(4)
v_mfma_f32_16x16x32_bf16 v[52:55], a[32:35], v[20:23], v[52:55]
ds_read_b128 v[44:47], v11 offset:12288
v_mfma_f32_16x16x32_bf16 v[56:59], a[36:39], v[20:23], v[56:59]
s_cmp_eq_u32 s30, 1
s_cbranch_scc0 mega_kernel_q_ke1
s_mov_b32 m0, s61
s_nop 0
buffer_load_dwordx4 v5, s[84:87], s68 offen sc1 lds
mega_kernel_q_ke1:
v_mfma_f32_16x16x32_bf16 v[60:63], a[32:35], v[24:27], v[60:63]
ds_read_b128 v[48:51], v11 offset:14336
v_mfma_f32_16x16x32_bf16 v[64:67], a[36:39], v[24:27], v[64:67]
s_add_u32 m0, s46, 0
s_waitcnt lgkmcnt(4)
v_mfma_f32_16x16x32_bf16 v[52:55], a[40:43], v[28:31], v[52:55]
ds_read_b128 v[20:23], v10 offset:16384
v_mfma_f32_16x16x32_bf16 v[56:59], a[44:47], v[28:31], v[56:59]
buffer_load_dwordx4 v6, s[8:11], s50 offen offset:0 lds
v_mfma_f32_16x16x32_bf16 v[60:63], a[40:43], v[32:35], v[60:63]
ds_read_b128 v[24:27], v10 offset:18432
v_mfma_f32_16x16x32_bf16 v[64:67], a[44:47], v[32:35], v[64:67]
s_add_u32 m0, s46, 3968
s_waitcnt lgkmcnt(4)
v_mfma_f32_16x16x32_bf16 v[52:55], a[48:51], v[36:39], v[52:55]
ds_read_b128 v[28:31], v11 offset:16384
v_mfma_f32_16x16x32_bf16 v[56:59], a[52:55], v[36:39], v[56:59]
buffer_load_dwordx4 v6, s[8:11], s50 offen offset:128 lds
v_mfma_f32_16x16x32_bf16 v[60:63], a[48:51], v[40:43], v[60:63]
ds_read_b128 v[32:35], v11 offset:18432
v_mfma_f32_16x16x32_bf16 v[64:67], a[52:55], v[40:43], v[64:67]
s_add_u32 m0, s46, 7936
s_waitcnt lgkmcnt(4)
v_mfma_f32_16x16x32_bf16 v[52:55], a[56:59], v[44:47], v[52:55]
ds_read_b128 v[36:39], v10 offset:20480
v_mfma_f32_16x16x32_bf16 v[56:59], a[60:63], v[44:47], v[56:59]
buffer_load_dwordx4 v6, s[8:11], s50 offen offset:256 lds
v_mfma_f32_16x16x32_bf16 v[60:63], a[56:59], v[48:51], v[60:63]
ds_read_b128 v[40:43], v10 offset:22528
v_mfma_f32_16x16x32_bf16 v[64:67], a[60:63], v[48:51], v[64:67]
s_add_u32 m0, s46, 11904
s_waitcnt lgkmcnt(4)
v_mfma_f32_16x16x32_bf16 v[52:55], a[64:67], v[20:23], v[52:55]
ds_read_b128 v[44:47], v11 offset:20480
v_mfma_f32_16x16x32_bf16 v[56:59], a[68:71], v[20:23], v[56:59]
buffer_load_dwordx4 v6, s[8:11], s50 offen offset:384 lds
v_mfma_f32_16x16x32_bf16 v[60:63], a[64:67], v[24:27], v[60:63]
ds_read_b128 v[48:51], v11 offset:22528
v_mfma_f32_16x16x32_bf16 v[64:67], a[68:71], v[24:27], v[64:67]
s_add_u32 m0, s46, 15872
s_waitcnt lgkmcnt(4)
v_mfma_f32_16x16x32_bf16 v[52:55], a[72:75], v[28:31], v[52:55]
ds_read_b128 v[20:23], v10 offset:24576
v_mfma_f32_16x16x32_bf16 v[56:59], a[76:79], v[28:31], v[56:59]
buffer_load_dwordx4 v6, s[8:11], s50 offen offset:512 lds
v_mfma_f32_16x16x32_bf16 v[60:63], a[72:75], v[32:35], v[60:63]
ds_read_b128 v[24:27], v10 offset:26624
v_mfma_f32_16x16x32_bf16 v[64:67], a[76:79], v[32:35], v[64:67]
s_add_u32 m0, s46, 19840
s_waitcnt lgkmcnt(4)
v_mfma_f32_16x16x32_bf16 v[52:55], a[80:83], v[36:39], v[52:55]
ds_read_b128 v[28:31], v11 offset:24576
v_mfma_f32_16x16x32_bf16 v[56:59], a[84:87], v[36:39], v[56:59]
buffer_load_dwordx4 v6, s[8:11], s50 offen offset:640 lds
v_mfma_f32_16x16x32_bf16 v[60:63], a[80:83], v[40:43], v[60:63]
ds_read_b128 v[32:35], v11 offset:26624
v_mfma_f32_16x16x32_bf16 v[64:67], a[84:87], v[40:43], v[64:67]
s_add_u32 m0, s46, 23808
s_waitcnt lgkmcnt(4)
v_mfma_f32_16x16x32_bf16 v[52:55], a[88:91], v[44:47], v[52:55]
ds_read_b128 v[36:39], v10 offset:28672
v_mfma_f32_16x16x32_bf16 v[56:59], a[92:95], v[44:47], v[56:59]
buffer_load_dwordx4 v6, s[8:11], s50 offen offset:768 lds
v_mfma_f32_16x16x32_bf16 v[60:63], a[88:91], v[48:51], v[60:63]
ds_read_b128 v[40:43], v10 offset:30720
v_mfma_f32_16x16x32_bf16 v[64:67], a[92:95], v[48:51], v[64:67]
s_add_u32 m0, s46, 27776
s_waitcnt lgkmcnt(4)
v_mfma_f32_16x16x32_bf16 v[52:55], a[96:99], v[20:23], v[52:55]
ds_read_b128 v[44:47], v11 offset:28672
v_mfma_f32_16x16x32_bf16 v[56:59], a[100:103], v[20:23], v[56:59]
buffer_load_dwordx4 v6, s[8:11], s50 offen offset:896 lds
v_mfma_f32_16x16x32_bf16 v[60:63], a[96:99], v[24:27], v[60:63]
ds_read_b128 v[48:51], v11 offset:30720
v_mfma_f32_16x16x32_bf16 v[64:67], a[100:103], v[24:27], v[64:67]
s_add_u32 m0, s46, 31744
s_waitcnt lgkmcnt(4)
v_mfma_f32_16x16x32_bf16 v[52:55], a[104:107], v[28:31], v[52:55]
ds_read_b128 v[20:23], v10 offset:32768
v_mfma_f32_16x16x32_bf16 v[56:59], a[108:111], v[28:31], v[56:59]
buffer_load_dwordx4 v6, s[8:11], s50 offen offset:1024 lds
v_mfma_f32_16x16x32_bf16 v[60:63], a[104:107], v[32:35], v[60:63]
ds_read_b128 v[24:27], v10 offset:34816
v_mfma_f32_16x16x32_bf16 v[64:67], a[108:111], v[32:35], v[64:67]
s_waitcnt vmcnt(13)
v_mov_b32 v17, s42
s_mov_b64 exec, 1
buffer_store_dword v17, v16, s[84:87], s49 offen sc1
s_mov_b64 exec, -1
s_add_u32 m0, s46, 35712
s_waitcnt lgkmcnt(4)
v_mfma_f32_16x16x32_bf16 v[52:55], a[112:115], v[36:39], v[52:55]
ds_read_b128 v[28:31], v11 offset:32768
v_mfma_f32_16x16x32_bf16 v[56:59], a[116:119], v[36:39], v[56:59]
buffer_load_dwordx4 v6, s[8:11], s50 offen offset:1152 lds
v_mfma_f32_16x16x32_bf16 v[60:63], a[112:115], v[40:43], v[60:63]
ds_read_b128 v[32:35], v11 offset:34816
v_mfma_f32_16x16x32_bf16 v[64:67], a[116:119], v[40:43], v[64:67]
v_mov_b32 v100, 0
s_mov_b64 exec, 1
buffer_atomic_add v100, v16, s[84:87], s62 offen sc0 sc1
s_mov_b64 exec, -1
s_add_u32 m0, s46, 39680
s_waitcnt lgkmcnt(4)
v_mfma_f32_16x16x32_bf16 v[52:55], a[120:123], v[44:47], v[52:55]
ds_read_b128 v[36:39], v10 offset:36864
v_mfma_f32_16x16x32_bf16 v[56:59], a[124:127], v[44:47], v[56:59]
buffer_load_dwordx4 v6, s[8:11], s50 offen offset:1280 lds
v_mfma_f32_16x16x32_bf16 v[60:63], a[120:123], v[48:51], v[60:63]
ds_read_b128 v[40:43], v10 offset:38912
v_mfma_f32_16x16x32_bf16 v[64:67], a[124:127], v[48:51], v[64:67]
s_add_u32 m0, s46, 43648
s_waitcnt lgkmcnt(4)
v_mfma_f32_16x16x32_bf16 v[52:55], a[128:131], v[20:23], v[52:55]
ds_read_b128 v[44:47], v11 offset:36864
v_mfma_f32_16x16x32_bf16 v[56:59], a[132:135], v[20:23], v[56:59]
buffer_load_dwordx4 v6, s[8:11], s50 offen offset:1408 lds
v_mfma_f32_16x16x32_bf16 v[60:63], a[128:131], v[24:27], v[60:63]
ds_read_b128 v[48:51], v11 offset:38912
v_mfma_f32_16x16x32_bf16 v[64:67], a[132:135], v[24:27], v[64:67]
s_add_u32 m0, s46, 47616
s_waitcnt lgkmcnt(4)
v_mfma_f32_16x16x32_bf16 v[52:55], a[136:139], v[28:31], v[52:55]
ds_read_b128 v[20:23], v10 offset:40960
v_mfma_f32_16x16x32_bf16 v[56:59], a[140:143], v[28:31], v[56:59]
buffer_load_dwordx4 v6, s[8:11], s50 offen offset:1536 lds
v_mfma_f32_16x16x32_bf16 v[60:63], a[136:139], v[32:35], v[60:63]
ds_read_b128 v[24:27], v10 offset:43008
v_mfma_f32_16x16x32_bf16 v[64:67], a[140:143], v[32:35], v[64:67]
s_add_u32 m0, s46, 51584
s_waitcnt lgkmcnt(4)
v_mfma_f32_16x16x32_bf16 v[52:55], a[144:147], v[36:39], v[52:55]
ds_read_b128 v[28:31], v11 offset:40960
v_mfma_f32_16x16x32_bf16 v[56:59], a[148:151], v[36:39], v[56:59]
buffer_load_dwordx4 v6, s[8:11], s50 offen offset:1664 lds
v_mfma_f32_16x16x32_bf16 v[60:63], a[144:147], v[40:43], v[60:63]
ds_read_b128 v[32:35], v11 offset:43008
v_mfma_f32_16x16x32_bf16 v[64:67], a[148:151], v[40:43], v[64:67]
s_add_u32 m0, s46, 55552
s_waitcnt lgkmcnt(4)
v_mfma_f32_16x16x32_bf16 v[52:55], a[152:155], v[44:47], v[52:55]
ds_read_b128 v[36:39], v10 offset:45056
v_mfma_f32_16x16x32_bf16 v[56:59], a[156:159], v[44:47], v[56:59]
buffer_load_dwordx4 v6, s[8:11], s50 offen offset:1792 lds
v_mfma_f32_16x16x32_bf16 v[60:63], a[152:155], v[48:51], v[60:63]
ds_read_b128 v[40:43], v10 offset:47104
v_mfma_f32_16x16x32_bf16 v[64:67], a[156:159], v[48:51], v[64:67]
s_add_u32 m0, s46, 59520
s_waitcnt lgkmcnt(4)
v_mfma_f32_16x16x32_bf16 v[52:55], a[160:163], v[20:23], v[52:55]
ds_read_b128 v[44:47], v11 offset:45056
v_mfma_f32_16x16x32_bf16 v[56:59], a[164:167], v[20:23], v[56:59]
buffer_load_dwordx4 v6, s[8:11], s50 offen offset:1920 lds
v_mfma_f32_16x16x32_bf16 v[60:63], a[160:163], v[24:27], v[60:63]
ds_read_b128 v[48:51], v11 offset:47104
v_mfma_f32_16x16x32_bf16 v[64:67], a[164:167], v[24:27], v[64:67]
s_waitcnt lgkmcnt(4)
v_mfma_f32_16x16x32_bf16 v[52:55], a[168:171], v[28:31], v[52:55]
ds_read_b128 v[20:23], v10 offset:49152
v_mfma_f32_16x16x32_bf16 v[56:59], a[172:175], v[28:31], v[56:59]
v_mov_b64 v[84:85], v[220:221]
v_mov_b64 v[86:87], v[222:223]
v_mfma_f32_16x16x32_bf16 v[60:63], a[168:171], v[32:35], v[60:63]
ds_read_b128 v[24:27], v10 offset:51200
v_mfma_f32_16x16x32_bf16 v[64:67], a[172:175], v[32:35], v[64:67]
v_mov_b64 v[88:89], v[224:225]
v_mov_b64 v[90:91], v[226:227]
s_waitcnt lgkmcnt(4)
v_mfma_f32_16x16x32_bf16 v[52:55], a[176:179], v[36:39], v[52:55]
ds_read_b128 v[28:31], v11 offset:49152
v_mfma_f32_16x16x32_bf16 v[56:59], a[180:183], v[36:39], v[56:59]
v_mov_b64 v[220:221], v[228:229]
v_mov_b64 v[222:223], v[230:231]
v_mfma_f32_16x16x32_bf16 v[60:63], a[176:179], v[40:43], v[60:63]
ds_read_b128 v[32:35], v11 offset:51200
v_mfma_f32_16x16x32_bf16 v[64:67], a[180:183], v[40:43], v[64:67]
v_mov_b64 v[224:225], v[232:233]
v_mov_b64 v[226:227], v[234:235]
s_waitcnt lgkmcnt(4)
v_mfma_f32_16x16x32_bf16 v[52:55], a[184:187], v[44:47], v[52:55]
ds_read_b128 v[36:39], v10 offset:53248
v_mfma_f32_16x16x32_bf16 v[56:59], a[188:191], v[44:47], v[56:59]
v_cvt_pk_bf16_f32 v228, v68, v69
v_cvt_pk_bf16_f32 v229, v70, v71
v_mfma_f32_16x16x32_bf16 v[60:63], a[184:187], v[48:51], v[60:63]
ds_read_b128 v[40:43], v10 offset:55296
v_mfma_f32_16x16x32_bf16 v[64:67], a[188:191], v[48:51], v[64:67]
v_cvt_pk_bf16_f32 v230, v72, v73
v_cvt_pk_bf16_f32 v231, v74, v75
s_waitcnt lgkmcnt(4)
v_mfma_f32_16x16x32_bf16 v[52:55], a[192:195], v[20:23], v[52:55]
ds_read_b128 v[44:47], v11 offset:53248
v_mfma_f32_16x16x32_bf16 v[56:59], a[196:199], v[20:23], v[56:59]
v_cvt_pk_bf16_f32 v232, v76, v77
v_cvt_pk_bf16_f32 v233, v78, v79
v_mfma_f32_16x16x32_bf16 v[60:63], a[192:195], v[24:27], v[60:63]
ds_read_b128 v[48:51], v11 offset:55296
v_mfma_f32_16x16x32_bf16 v[64:67], a[196:199], v[24:27], v[64:67]
v_cvt_pk_bf16_f32 v234, v80, v81
v_cvt_pk_bf16_f32 v235, v82, v83
s_waitcnt lgkmcnt(4)
v_mfma_f32_16x16x32_bf16 v[52:55], a[200:203], v[28:31], v[52:55]
ds_read_b128 v[20:23], v10 offset:57344
v_mfma_f32_16x16x32_bf16 v[56:59], a[204:207], v[28:31], v[56:59]
v_mfma_f32_16x16x32_bf16 v[60:63], a[200:203], v[32:35], v[60:63]
ds_read_b128 v[24:27], v10 offset:59392
v_mfma_f32_16x16x32_bf16 v[64:67], a[204:207], v[32:35], v[64:67]
s_waitcnt lgkmcnt(4)
v_mfma_f32_16x16x32_bf16 v[52:55], a[208:211], v[36:39], v[52:55]
ds_read_b128 v[28:31], v11 offset:57344
v_mfma_f32_16x16x32_bf16 v[56:59], a[212:215], v[36:39], v[56:59]
v_mfma_f32_16x16x32_bf16 v[60:63], a[208:211], v[40:43], v[60:63]
ds_read_b128 v[32:35], v11 offset:59392
v_mfma_f32_16x16x32_bf16 v[64:67], a[212:215], v[40:43], v[64:67]
s_waitcnt lgkmcnt(4)
v_mfma_f32_16x16x32_bf16 v[52:55], a[216:219], v[44:47], v[52:55]
ds_read_b128 v[36:39], v10 offset:61440
v_mfma_f32_16x16x32_bf16 v[56:59], a[220:223], v[44:47], v[56:59]
s_waitcnt vmcnt(6)
v_readfirstlane_b32 s56, v100
s_cmp_eq_u32 s30, 1
s_cbranch_scc1 mega_kernel_q_kf1
s_cmp_gt_i32 s56, s42
s_cbranch_scc0 mega_kernel_q_kf1
s_mov_b32 s30, 1
s_mov_b32 m0, s61
s_nop 0
buffer_load_dwordx4 v5, s[84:87], s68 offen sc1 lds
mega_kernel_q_kf1:
v_mfma_f32_16x16x32_bf16 v[60:63], a[216:219], v[48:51], v[60:63]
ds_read_b128 v[40:43], v10 offset:63488
v_mfma_f32_16x16x32_bf16 v[64:67], a[220:223], v[48:51], v[64:67]
s_waitcnt lgkmcnt(4)
v_mfma_f32_16x16x32_bf16 v[52:55], a[224:227], v[20:23], v[52:55]
ds_read_b128 v[44:47], v11 offset:61440
v_mfma_f32_16x16x32_bf16 v[56:59], a[228:231], v[20:23], v[56:59]
v_mfma_f32_16x16x32_bf16 v[60:63], a[224:227], v[24:27], v[60:63]
ds_read_b128 v[48:51], v11 offset:63488
v_mfma_f32_16x16x32_bf16 v[64:67], a[228:231], v[24:27], v[64:67]
s_waitcnt lgkmcnt(5)
v_mfma_f32_16x16x32_bf16 v[52:55], a[232:235], v[28:31], v[52:55]
v_mfma_f32_16x16x32_bf16 v[56:59], a[236:239], v[28:31], v[56:59]
s_waitcnt lgkmcnt(4)
v_mfma_f32_16x16x32_bf16 v[60:63], a[232:235], v[32:35], v[60:63]
v_mfma_f32_16x16x32_bf16 v[64:67], a[236:239], v[32:35], v[64:67]
s_waitcnt lgkmcnt(3)
v_mfma_f32_16x16x32_bf16 v[52:55], a[240:243], v[36:39], v[52:55]
v_mfma_f32_16x16x32_bf16 v[56:59], a[244:247], v[36:39], v[56:59]
s_waitcnt lgkmcnt(2)
v_mfma_f32_16x16x32_bf16 v[60:63], a[240:243], v[40:43], v[60:63]
v_mfma_f32_16x16x32_bf16 v[64:67], a[244:247], v[40:43], v[64:67]
ds_write_b128 v101, v[84:87]
ds_write_b128 v101, v[88:91] offset:1024
s_waitcnt lgkmcnt(1)
v_mfma_f32_16x16x32_bf16 v[68:71], a[248:251], v[44:47], v[52:55]
v_mfma_f32_16x16x32_bf16 v[72:75], a[252:255], v[44:47], v[56:59]
s_waitcnt lgkmcnt(0)
v_mfma_f32_16x16x32_bf16 v[76:79], a[248:251], v[48:51], v[60:63]
v_mfma_f32_16x16x32_bf16 v[80:83], a[252:255], v[48:51], v[64:67]
mega_kernel_q_jl1:
s_cmp_eq_u32 s30, 1
s_cbranch_scc1 mega_kernel_q_kl1
mega_kernel_q_kw1:
v_mov_b32 v100, 0
s_mov_b64 exec, 1
buffer_atomic_add v100, v16, s[84:87], s62 offen sc0 sc1
s_mov_b64 exec, -1
s_waitcnt vmcnt(0)
v_readfirstlane_b32 s56, v100
s_cmp_gt_i32 s56, s42
s_cbranch_scc1 mega_kernel_q_kv1
s_cmp_eq_u32 s42, 63
s_cbranch_scc1 mega_kernel_q_kw1
s_branch mega_kernel_q_kw1
mega_kernel_q_kv1:
s_mov_b32 m0, s61
s_nop 0
buffer_load_dwordx4 v5, s[84:87], s68 offen sc1 lds
mega_kernel_q_kl1:
s_waitcnt lgkmcnt(0) vmcnt(0)
s_barrier
ds_read_b128 v[184:187], v102 offset:0
ds_read_b128 v[112:115], v103 offset:0
ds_read_b128 v[128:131], v103 offset:1024
ds_read_b128 v[188:191], v102 offset:2048
ds_read_b128 v[116:119], v103 offset:2048
ds_read_b128 v[132:135], v103 offset:3072
ds_read_b128 v[192:195], v102 offset:4096
ds_read_b128 v[120:123], v103 offset:4096
ds_read_b128 v[136:139], v103 offset:5120
ds_read_b128 v[196:199], v102 offset:6144
ds_read_b128 v[124:127], v103 offset:6144
ds_read_b128 v[140:143], v103 offset:7168
s_waitcnt lgkmcnt(9)
v_mfma_f32_16x16x32_bf16 v[200:203], v[112:115], v[184:187], 0
v_mfma_f32_16x16x32_bf16 v[204:207], v[128:131], v[184:187], 0
ds_read_b128 v[160:163], v94 offset:0
s_waitcnt lgkmcnt(7)
v_mfma_f32_16x16x32_bf16 v[200:203], v[116:119], v[188:191], v[200:203]
v_mfma_f32_16x16x32_bf16 v[204:207], v[132:135], v[188:191], v[204:207]
ds_read_b128 v[164:167], v94 offset:1024
s_waitcnt lgkmcnt(5)
v_mfma_f32_16x16x32_bf16 v[200:203], v[120:123], v[192:195], v[200:203]
v_mfma_f32_16x16x32_bf16 v[204:207], v[136:139], v[192:195], v[204:207]
ds_read_b128 v[168:171], v94 offset:2048
s_waitcnt lgkmcnt(3)
v_mfma_f32_16x16x32_bf16 v[200:203], v[124:127], v[196:199], v[200:203]
v_mfma_f32_16x16x32_bf16 v[204:207], v[140:143], v[196:199], v[204:207]
ds_read_b128 v[172:175], v94 offset:3072
s_waitcnt lgkmcnt(3)
v_mfma_f32_16x16x32_bf16 v[208:211], v[160:163], v[184:187], 0
ds_read_b128 v[144:147], v240 offset:0
ds_read_b64 v[176:177], v95 offset:0
s_waitcnt lgkmcnt(4)
v_mfma_f32_16x16x32_bf16 v[208:211], v[164:167], v[188:191], v[208:211]
ds_read_b128 v[148:151], v240 offset:1024
ds_read_b64 v[178:179], v95 offset:256
s_waitcnt lgkmcnt(5)
v_mfma_f32_16x16x32_bf16 v[208:211], v[168:171], v[192:195], v[208:211]
ds_read_b128 v[152:155], v240 offset:2048
ds_read_b64 v[180:181], v95 offset:1024
s_waitcnt lgkmcnt(6)
v_mfma_f32_16x16x32_bf16 v[208:211], v[172:175], v[196:199], v[208:211]
ds_read_b128 v[156:159], v240 offset:3072
ds_read_b64 v[182:183], v95 offset:1280
mega_kernel_q_sm1:
v_pk_mul_f32 v[200:201], v[200:201], s[54:55] op_sel_hi:[1,0]
v_pk_mul_f32 v[202:203], v[202:203], s[54:55] op_sel_hi:[1,0]
v_pk_mul_f32 v[204:205], v[204:205], s[54:55] op_sel_hi:[1,0]
v_pk_mul_f32 v[206:207], v[206:207], s[54:55] op_sel_hi:[1,0]
v_cndmask_b32 v200, v200, v241, s[12:13]
v_cndmask_b32 v201, v201, v241, s[14:15]
v_cndmask_b32 v202, v202, v241, s[16:17]
v_cndmask_b32 v203, v203, v241, s[18:19]
v_cndmask_b32 v204, v204, v241, s[20:21]
v_cndmask_b32 v205, v205, v241, s[22:23]
v_cndmask_b32 v206, v206, v241, s[24:25]
v_cndmask_b32 v207, v207, v241, s[26:27]
v_pk_mul_f32 v[208:209], v[208:209], s[54:55] op_sel_hi:[1,0]
v_pk_mul_f32 v[210:211], v[210:211], s[54:55] op_sel_hi:[1,0]
v_cndmask_b32 v208, v208, v97, s[28:29]
v_cndmask_b32 v209, v209, v97, s[28:29]
v_cndmask_b32 v210, v210, v97, s[28:29]
v_cndmask_b32 v211, v211, v97, s[28:29]
v_max3_f32 v236, v200, v201, v202
v_max3_f32 v236, v236, v203, v204
v_max3_f32 v236, v236, v205, v206
v_max3_f32 v236, v236, v207, v208
v_max3_f32 v236, v236, v209, v210
v_max_f32 v237, v236, v211
v_max_f32 v236, v236, v211
s_nop 1
v_permlane16_swap_b32 v236, v237
s_nop 0
v_max_f32 v238, v236, v237
v_max_f32 v239, v236, v237
s_nop 1
v_permlane32_swap_b32 v238, v239
s_nop 0
v_max_f32 v236, v238, v239
v_pk_add_f32 v[200:201], v[200:201], v[236:237] op_sel_hi:[1,0] neg_lo:[0,1] neg_hi:[0,1]
v_pk_add_f32 v[202:203], v[202:203], v[236:237] op_sel_hi:[1,0] neg_lo:[0,1] neg_hi:[0,1]
v_pk_add_f32 v[204:205], v[204:205], v[236:237] op_sel_hi:[1,0] neg_lo:[0,1] neg_hi:[0,1]
v_pk_add_f32 v[206:207], v[206:207], v[236:237] op_sel_hi:[1,0] neg_lo:[0,1] neg_hi:[0,1]
v_pk_add_f32 v[208:209], v[208:209], v[236:237] op_sel_hi:[1,0] neg_lo:[0,1] neg_hi:[0,1]
v_pk_add_f32 v[210:211], v[210:211], v[236:237] op_sel_hi:[1,0] neg_lo:[0,1] neg_hi:[0,1]
v_exp_f32 v200, v200
v_exp_f32 v201, v201
v_exp_f32 v202, v202
v_exp_f32 v203, v203
v_exp_f32 v204, v204
v_exp_f32 v205, v205
v_exp_f32 v206, v206
v_exp_f32 v207, v207
v_exp_f32 v208, v208
v_exp_f32 v209, v209
v_exp_f32 v210, v210
v_exp_f32 v211, v211
s_nop 0
v_cvt_pk_bf16_f32 v212, v200, v201
v_cvt_pk_bf16_f32 v213, v202, v203
v_cvt_pk_bf16_f32 v214, v204, v205
v_cvt_pk_bf16_f32 v215, v206, v207
v_cvt_pk_bf16_f32 v216, v208, v209
v_cvt_pk_bf16_f32 v217, v210, v211
s_waitcnt lgkmcnt(0)
s_nop 0
v_mfma_f32_16x16x32_bf16 v[108:111], v[104:107], v[212:215], 0
v_mfma_f32_16x16x32_bf16 v[112:115], v[144:147], v[212:215], 0
v_mfma_f32_16x16x32_bf16 v[116:119], v[148:151], v[212:215], 0
v_mfma_f32_16x16x32_bf16 v[120:123], v[152:155], v[212:215], 0
v_mfma_f32_16x16x32_bf16 v[124:127], v[156:159], v[212:215], 0
v_mfma_f32_16x16x16_bf16 v[108:111], v[104:105], v[216:217], v[108:111]
v_mfma_f32_16x16x16_bf16 v[112:115], v[176:177], v[216:217], v[112:115]
v_mfma_f32_16x16x16_bf16 v[116:119], v[178:179], v[216:217], v[116:119]
v_mfma_f32_16x16x16_bf16 v[120:123], v[180:181], v[216:217], v[120:123]
v_mfma_f32_16x16x16_bf16 v[124:127], v[182:183], v[216:217], v[124:127]
s_lshr_b32 s63, s42, 2
s_xnor_b32 s63, s63, s98
s_and_b32 s63, s63, 1
s_lshl_b32 s63, s63, 13
s_lshl_b32 s51, s42, 19
s_add_u32 s51, s51, s63
s_nop 2
v_rcp_f32 v238, v108
v_rcp_f32 v239, v109
s_nop 1
v_pk_mul_f32 v[112:113], v[112:113], v[238:239]
v_pk_mul_f32 v[114:115], v[114:115], v[238:239]
v_pk_mul_f32 v[116:117], v[116:117], v[238:239]
v_pk_mul_f32 v[118:119], v[118:119], v[238:239]
v_pk_mul_f32 v[120:121], v[120:121], v[238:239]
v_pk_mul_f32 v[122:123], v[122:123], v[238:239]
v_pk_mul_f32 v[124:125], v[124:125], v[238:239]
v_pk_mul_f32 v[126:127], v[126:127], v[238:239]
v_cvt_pk_bf16_f32 v200, v112, v113
v_cvt_pk_bf16_f32 v201, v114, v115
v_cvt_pk_bf16_f32 v202, v116, v117
v_cvt_pk_bf16_f32 v203, v118, v119
v_cvt_pk_bf16_f32 v204, v120, v121
v_cvt_pk_bf16_f32 v205, v122, v123
v_cvt_pk_bf16_f32 v206, v124, v125
v_cvt_pk_bf16_f32 v207, v126, v127
buffer_store_dwordx4 v[200:203], v96, s[84:87], s51 offen sc1
buffer_store_dwordx4 v[204:207], v96, s[84:87], s51 offen offset:2048 sc1
s_add_u32 s42, s42, 1
s_barrier
s_cmp_gt_i32 s55, s42
s_cbranch_scc1 mega_kernel_q_kv0k
mega_kernel_q_kv0w:
v_mov_b32 v2, 0
s_mov_b64 exec, 0xff
buffer_atomic_add v2, v99, s[84:87], 0 offen sc0 sc1
s_mov_b64 exec, -1
s_waitcnt vmcnt(0)
v_min_i32_dpp v2, v2, v2 quad_perm:[1,0,3,2] row_mask:0xf bank_mask:0xf
s_nop 1
v_min_i32_dpp v2, v2, v2 quad_perm:[2,3,0,1] row_mask:0xf bank_mask:0xf
s_nop 1
v_min_i32_dpp v2, v2, v2 row_half_mirror row_mask:0xf bank_mask:0xf
s_nop 0
v_readfirstlane_b32 s55, v2
s_cmp_gt_i32 s55, s42
s_cbranch_scc1 mega_kernel_q_kv0k
s_sleep 4
s_branch mega_kernel_q_kv0w
mega_kernel_q_kv0k:
s_cmp_ge_u32 s42, 61
s_cbranch_scc0 mega_kernel_q_nl0
s_add_u32 s51, s47, s42
s_bfe_u32 s57, s51, 0x40002
s_lshl_b32 s57, s57, 14
s_and_b32 s66, s51, 3
s_lshl_b32 s66, s66, 11
s_add_u32 s66, s66, s57
s_add_u32 s66, s66, s58
s_add_u32 s67, s66, 33554432
s_bfe_u32 s57, s51, 0x30003
s_lshl_b32 s57, s57, 14
s_and_b32 s68, s51, 7
s_lshl_b32 s68, s68, 10
s_add_u32 s68, s68, s57
s_add_u32 s68, s68, s59
s_add_u32 s50, s42, 4
s_min_u32 s50, s50, 63
s_lshl_b32 s50, s50, 16
s_cmp_gt_i32 s56, s42
s_cselect_b32 s30, 1, 0
s_add_u32 m0, s60, 0
s_nop 0
buffer_load_dwordx4 v5, s[84:87], s66 offen offset:0 sc1 lds
s_add_u32 m0, s60, 0
s_nop 0
buffer_load_dwordx4 v5, s[84:87], s66 offen offset:1024 sc1 lds
s_add_u32 m0, s60, 8192
s_nop 0
buffer_load_dwordx4 v5, s[84:87], s67 offen offset:0 sc1 lds
s_add_u32 m0, s60, 8192
s_nop 0
buffer_load_dwordx4 v5, s[84:87], s67 offen offset:1024 sc1 lds
s_cmp_eq_u32 s30, 1
s_cbranch_scc0 mega_kernel_q_kx0
s_mov_b32 m0, s61
s_nop 0
buffer_load_dwordx4 v5, s[84:87], s68 offen sc1 lds
mega_kernel_q_kx0:
v_mov_b64 v[84:85], v[220:221]
v_mov_b64 v[86:87], v[222:223]
v_mov_b64 v[88:89], v[224:225]
v_mov_b64 v[90:91], v[226:227]
v_mov_b64 v[220:221], v[228:229]
v_mov_b64 v[222:223], v[230:231]
v_mov_b64 v[224:225], v[232:233]
v_mov_b64 v[226:227], v[234:235]
v_cvt_pk_bf16_f32 v228, v68, v69
v_cvt_pk_bf16_f32 v229, v70, v71
v_cvt_pk_bf16_f32 v230, v72, v73
v_cvt_pk_bf16_f32 v231, v74, v75
v_cvt_pk_bf16_f32 v232, v76, v77
v_cvt_pk_bf16_f32 v233, v78, v79
v_cvt_pk_bf16_f32 v234, v80, v81
v_cvt_pk_bf16_f32 v235, v82, v83
ds_write_b128 v101, v[84:87]
ds_write_b128 v101, v[88:91] offset:1024
s_waitcnt vmcnt(4)
v_mov_b32 v17, s42
s_mov_b64 exec, 1
buffer_store_dword v17, v16, s[84:87], s49 offen sc1
s_mov_b64 exec, -1
s_branch mega_kernel_q_jl0
mega_kernel_q_nl0:
ds_read_b128 v[20:23], v8 offset:0
ds_read_b128 v[24:27], v8 offset:2048
ds_read_b128 v[28:31], v9 offset:0
ds_read_b128 v[32:35], v9 offset:2048
ds_read_b128 v[36:39], v8 offset:4096
ds_read_b128 v[40:43], v8 offset:6144
s_add_u32 s51, s47, s42
s_bfe_u32 s57, s51, 0x40002
s_lshl_b32 s57, s57, 14
s_and_b32 s66, s51, 3
s_lshl_b32 s66, s66, 11
s_add_u32 s66, s66, s57
s_add_u32 s66, s66, s58
s_add_u32 s67, s66, 33554432
s_bfe_u32 s57, s51, 0x30003
s_lshl_b32 s57, s57, 14
s_and_b32 s68, s51, 7
s_lshl_b32 s68, s68, 10
s_add_u32 s68, s68, s57
s_add_u32 s68, s68, s59
s_add_u32 s50, s42, 4
s_min_u32 s50, s50, 63
s_lshl_b32 s50, s50, 16
s_cmp_gt_i32 s56, s42
s_cselect_b32 s30, 1, 0
s_add_u32 m0, s60, 0
s_waitcnt lgkmcnt(4)
v_mfma_f32_16x16x32_bf16 v[52:55], a[0:3], v[20:23], 0
ds_read_b128 v[44:47], v9 offset:4096
v_mfma_f32_16x16x32_bf16 v[56:59], a[4:7], v[20:23], 0
buffer_load_dwordx4 v5, s[84:87], s66 offen offset:0 sc1 lds
v_mfma_f32_16x16x32_bf16 v[60:63], a[0:3], v[24:27], 0
ds_read_b128 v[48:51], v9 offset:6144
v_mfma_f32_16x16x32_bf16 v[64:67], a[4:7], v[24:27], 0
s_add_u32 m0, s60, 0
s_waitcnt lgkmcnt(4)
v_mfma_f32_16x16x32_bf16 v[52:55], a[8:11], v[28:31], v[52:55]
ds_read_b128 v[20:23], v8 offset:8192
v_mfma_f32_16x16x32_bf16 v[56:59], a[12:15], v[28:31], v[56:59]
buffer_load_dwordx4 v5, s[84:87], s66 offen offset:1024 sc1 lds
v_mfma_f32_16x16x32_bf16 v[60:63], a[8:11], v[32:35], v[60:63]
ds_read_b128 v[24:27], v8 offset:10240
v_mfma_f32_16x16x32_bf16 v[64:67], a[12:15], v[32:35], v[64:67]
s_add_u32 m0, s60, 8192
s_waitcnt lgkmcnt(4)
v_mfma_f32_16x16x32_bf16 v[52:55], a[16:19], v[36:39], v[52:55]
ds_read_b128 v[28:31], v9 offset:8192
v_mfma_f32_16x16x32_bf16 v[56:59], a[20:23], v[36:39], v[56:59]
buffer_load_dwordx4 v5, s[84:87], s67 offen offset:0 sc1 lds
v_mfma_f32_16x16x32_bf16 v[60:63], a[16:19], v[40:43], v[60:63]
ds_read_b128 v[32:35], v9 offset:10240
v_mfma_f32_16x16x32_bf16 v[64:67], a[20:23], v[40:43], v[64:67]
s_add_u32 m0, s60, 8192
s_waitcnt lgkmcnt(4)
v_mfma_f32_16x16x32_bf16 v[52:55], a[24:27], v[44:47], v[52:55]
ds_read_b128 v[36:39], v8 offset:12288
v_mfma_f32_16x16x32_bf16 v[56:59], a[28:31], v[44:47], v[56:59]
buffer_load_dwordx4 v5, s[84:87], s67 offen offset:1024 sc1 lds
v_mfma_f32_16x16x32_bf16 v[60:63], a[24:27], v[48:51], v[60:63]
ds_read_b128 v[40:43], v8 offset:14336
v_mfma_f32_16x16x32_bf16 v[64:67], a[28:31], v[48:51], v[64:67]
s_waitcnt lgkmcnt(4)
v_mfma_f32_16x16x32_bf16 v[52:55], a[32:35], v[20:23], v[52:55]
ds_read_b128 v[44:47], v9 offset:12288
v_mfma_f32_16x16x32_bf16 v[56:59], a[36:39], v[20:23], v[56:59]
s_cmp_eq_u32 s30, 1
s_cbranch_scc0 mega_kernel_q_ke0
s_mov_b32 m0, s61
s_nop 0
buffer_load_dwordx4 v5, s[84:87], s68 offen sc1 lds
mega_kernel_q_ke0:
v_mfma_f32_16x16x32_bf16 v[60:63], a[32:35], v[24:27], v[60:63]
ds_read_b128 v[48:51], v9 offset:14336
v_mfma_f32_16x16x32_bf16 v[64:67], a[36:39], v[24:27], v[64:67]
s_add_u32 m0, s46, 65536
s_waitcnt lgkmcnt(4)
v_mfma_f32_16x16x32_bf16 v[52:55], a[40:43], v[28:31], v[52:55]
ds_read_b128 v[20:23], v8 offset:16384
v_mfma_f32_16x16x32_bf16 v[56:59], a[44:47], v[28:31], v[56:59]
buffer_load_dwordx4 v6, s[8:11], s50 offen offset:0 lds
v_mfma_f32_16x16x32_bf16 v[60:63], a[40:43], v[32:35], v[60:63]
ds_read_b128 v[24:27], v8 offset:18432
v_mfma_f32_16x16x32_bf16 v[64:67], a[44:47], v[32:35], v[64:67]
s_add_u32 m0, s46, 69504
s_waitcnt lgkmcnt(4)
v_mfma_f32_16x16x32_bf16 v[52:55], a[48:51], v[36:39], v[52:55]
ds_read_b128 v[28:31], v9 offset:16384
v_mfma_f32_16x16x32_bf16 v[56:59], a[52:55], v[36:39], v[56:59]
buffer_load_dwordx4 v6, s[8:11], s50 offen offset:128 lds
v_mfma_f32_16x16x32_bf16 v[60:63], a[48:51], v[40:43], v[60:63]
ds_read_b128 v[32:35], v9 offset:18432
v_mfma_f32_16x16x32_bf16 v[64:67], a[52:55], v[40:43], v[64:67]
s_add_u32 m0, s46, 73472
s_waitcnt lgkmcnt(4)
v_mfma_f32_16x16x32_bf16 v[52:55], a[56:59], v[44:47], v[52:55]
ds_read_b128 v[36:39], v8 offset:20480
v_mfma_f32_16x16x32_bf16 v[56:59], a[60:63], v[44:47], v[56:59]
buffer_load_dwordx4 v6, s[8:11], s50 offen offset:256 lds
v_mfma_f32_16x16x32_bf16 v[60:63], a[56:59], v[48:51], v[60:63]
ds_read_b128 v[40:43], v8 offset:22528
v_mfma_f32_16x16x32_bf16 v[64:67], a[60:63], v[48:51], v[64:67]
s_add_u32 m0, s46, 77440
s_waitcnt lgkmcnt(4)
v_mfma_f32_16x16x32_bf16 v[52:55], a[64:67], v[20:23], v[52:55]
ds_read_b128 v[44:47], v9 offset:20480
v_mfma_f32_16x16x32_bf16 v[56:59], a[68:71], v[20:23], v[56:59]
buffer_load_dwordx4 v6, s[8:11], s50 offen offset:384 lds
v_mfma_f32_16x16x32_bf16 v[60:63], a[64:67], v[24:27], v[60:63]
ds_read_b128 v[48:51], v9 offset:22528
v_mfma_f32_16x16x32_bf16 v[64:67], a[68:71], v[24:27], v[64:67]
s_add_u32 m0, s46, 81408
s_waitcnt lgkmcnt(4)
v_mfma_f32_16x16x32_bf16 v[52:55], a[72:75], v[28:31], v[52:55]
ds_read_b128 v[20:23], v8 offset:24576
v_mfma_f32_16x16x32_bf16 v[56:59], a[76:79], v[28:31], v[56:59]
buffer_load_dwordx4 v6, s[8:11], s50 offen offset:512 lds
v_mfma_f32_16x16x32_bf16 v[60:63], a[72:75], v[32:35], v[60:63]
ds_read_b128 v[24:27], v8 offset:26624
v_mfma_f32_16x16x32_bf16 v[64:67], a[76:79], v[32:35], v[64:67]
s_add_u32 m0, s46, 85376
s_waitcnt lgkmcnt(4)
v_mfma_f32_16x16x32_bf16 v[52:55], a[80:83], v[36:39], v[52:55]
ds_read_b128 v[28:31], v9 offset:24576
v_mfma_f32_16x16x32_bf16 v[56:59], a[84:87], v[36:39], v[56:59]
buffer_load_dwordx4 v6, s[8:11], s50 offen offset:640 lds
v_mfma_f32_16x16x32_bf16 v[60:63], a[80:83], v[40:43], v[60:63]
ds_read_b128 v[32:35], v9 offset:26624
v_mfma_f32_16x16x32_bf16 v[64:67], a[84:87], v[40:43], v[64:67]
s_add_u32 m0, s46, 89344
s_waitcnt lgkmcnt(4)
v_mfma_f32_16x16x32_bf16 v[52:55], a[88:91], v[44:47], v[52:55]
ds_read_b128 v[36:39], v8 offset:28672
v_mfma_f32_16x16x32_bf16 v[56:59], a[92:95], v[44:47], v[56:59]
buffer_load_dwordx4 v6, s[8:11], s50 offen offset:768 lds
v_mfma_f32_16x16x32_bf16 v[60:63], a[88:91], v[48:51], v[60:63]
ds_read_b128 v[40:43], v8 offset:30720
v_mfma_f32_16x16x32_bf16 v[64:67], a[92:95], v[48:51], v[64:67]
s_add_u32 m0, s46, 93312
s_waitcnt lgkmcnt(4)
v_mfma_f32_16x16x32_bf16 v[52:55], a[96:99], v[20:23], v[52:55]
ds_read_b128 v[44:47], v9 offset:28672
v_mfma_f32_16x16x32_bf16 v[56:59], a[100:103], v[20:23], v[56:59]
buffer_load_dwordx4 v6, s[8:11], s50 offen offset:896 lds
v_mfma_f32_16x16x32_bf16 v[60:63], a[96:99], v[24:27], v[60:63]
ds_read_b128 v[48:51], v9 offset:30720
v_mfma_f32_16x16x32_bf16 v[64:67], a[100:103], v[24:27], v[64:67]
s_add_u32 m0, s46, 97280
s_waitcnt lgkmcnt(4)
v_mfma_f32_16x16x32_bf16 v[52:55], a[104:107], v[28:31], v[52:55]
ds_read_b128 v[20:23], v8 offset:32768
v_mfma_f32_16x16x32_bf16 v[56:59], a[108:111], v[28:31], v[56:59]
buffer_load_dwordx4 v6, s[8:11], s50 offen offset:1024 lds
v_mfma_f32_16x16x32_bf16 v[60:63], a[104:107], v[32:35], v[60:63]
ds_read_b128 v[24:27], v8 offset:34816
v_mfma_f32_16x16x32_bf16 v[64:67], a[108:111], v[32:35], v[64:67]
s_waitcnt vmcnt(13)
v_mov_b32 v17, s42
s_mov_b64 exec, 1
buffer_store_dword v17, v16, s[84:87], s49 offen sc1
s_mov_b64 exec, -1
s_add_u32 m0, s46, 101248
s_waitcnt lgkmcnt(4)
v_mfma_f32_16x16x32_bf16 v[52:55], a[112:115], v[36:39], v[52:55]
ds_read_b128 v[28:31], v9 offset:32768
v_mfma_f32_16x16x32_bf16 v[56:59], a[116:119], v[36:39], v[56:59]
buffer_load_dwordx4 v6, s[8:11], s50 offen offset:1152 lds
v_mfma_f32_16x16x32_bf16 v[60:63], a[112:115], v[40:43], v[60:63]
ds_read_b128 v[32:35], v9 offset:34816
v_mfma_f32_16x16x32_bf16 v[64:67], a[116:119], v[40:43], v[64:67]
v_mov_b32 v100, 0
s_mov_b64 exec, 1
buffer_atomic_add v100, v16, s[84:87], s62 offen sc0 sc1
s_mov_b64 exec, -1
s_add_u32 m0, s46, 105216
s_waitcnt lgkmcnt(4)
v_mfma_f32_16x16x32_bf16 v[52:55], a[120:123], v[44:47], v[52:55]
ds_read_b128 v[36:39], v8 offset:36864
v_mfma_f32_16x16x32_bf16 v[56:59], a[124:127], v[44:47], v[56:59]
buffer_load_dwordx4 v6, s[8:11], s50 offen offset:1280 lds
v_mfma_f32_16x16x32_bf16 v[60:63], a[120:123], v[48:51], v[60:63]
ds_read_b128 v[40:43], v8 offset:38912
v_mfma_f32_16x16x32_bf16 v[64:67], a[124:127], v[48:51], v[64:67]
s_add_u32 m0, s46, 109184
s_waitcnt lgkmcnt(4)
v_mfma_f32_16x16x32_bf16 v[52:55], a[128:131], v[20:23], v[52:55]
ds_read_b128 v[44:47], v9 offset:36864
v_mfma_f32_16x16x32_bf16 v[56:59], a[132:135], v[20:23], v[56:59]
buffer_load_dwordx4 v6, s[8:11], s50 offen offset:1408 lds
v_mfma_f32_16x16x32_bf16 v[60:63], a[128:131], v[24:27], v[60:63]
ds_read_b128 v[48:51], v9 offset:38912
v_mfma_f32_16x16x32_bf16 v[64:67], a[132:135], v[24:27], v[64:67]
s_add_u32 m0, s46, 113152
s_waitcnt lgkmcnt(4)
v_mfma_f32_16x16x32_bf16 v[52:55], a[136:139], v[28:31], v[52:55]
ds_read_b128 v[20:23], v8 offset:40960
v_mfma_f32_16x16x32_bf16 v[56:59], a[140:143], v[28:31], v[56:59]
buffer_load_dwordx4 v6, s[8:11], s50 offen offset:1536 lds
v_mfma_f32_16x16x32_bf16 v[60:63], a[136:139], v[32:35], v[60:63]
ds_read_b128 v[24:27], v8 offset:43008
v_mfma_f32_16x16x32_bf16 v[64:67], a[140:143], v[32:35], v[64:67]
s_add_u32 m0, s46, 117120
s_waitcnt lgkmcnt(4)
v_mfma_f32_16x16x32_bf16 v[52:55], a[144:147], v[36:39], v[52:55]
ds_read_b128 v[28:31], v9 offset:40960
v_mfma_f32_16x16x32_bf16 v[56:59], a[148:151], v[36:39], v[56:59]
buffer_load_dwordx4 v6, s[8:11], s50 offen offset:1664 lds
v_mfma_f32_16x16x32_bf16 v[60:63], a[144:147], v[40:43], v[60:63]
ds_read_b128 v[32:35], v9 offset:43008
v_mfma_f32_16x16x32_bf16 v[64:67], a[148:151], v[40:43], v[64:67]
s_add_u32 m0, s46, 121088
s_waitcnt lgkmcnt(4)
v_mfma_f32_16x16x32_bf16 v[52:55], a[152:155], v[44:47], v[52:55]
ds_read_b128 v[36:39], v8 offset:45056
v_mfma_f32_16x16x32_bf16 v[56:59], a[156:159], v[44:47], v[56:59]
buffer_load_dwordx4 v6, s[8:11], s50 offen offset:1792 lds
v_mfma_f32_16x16x32_bf16 v[60:63], a[152:155], v[48:51], v[60:63]
ds_read_b128 v[40:43], v8 offset:47104
v_mfma_f32_16x16x32_bf16 v[64:67], a[156:159], v[48:51], v[64:67]
s_add_u32 m0, s46, 125056
s_waitcnt lgkmcnt(4)
v_mfma_f32_16x16x32_bf16 v[52:55], a[160:163], v[20:23], v[52:55]
ds_read_b128 v[44:47], v9 offset:45056
v_mfma_f32_16x16x32_bf16 v[56:59], a[164:167], v[20:23], v[56:59]
buffer_load_dwordx4 v6, s[8:11], s50 offen offset:1920 lds
v_mfma_f32_16x16x32_bf16 v[60:63], a[160:163], v[24:27], v[60:63]
ds_read_b128 v[48:51], v9 offset:47104
v_mfma_f32_16x16x32_bf16 v[64:67], a[164:167], v[24:27], v[64:67]
s_waitcnt lgkmcnt(4)
v_mfma_f32_16x16x32_bf16 v[52:55], a[168:171], v[28:31], v[52:55]
ds_read_b128 v[20:23], v8 offset:49152
v_mfma_f32_16x16x32_bf16 v[56:59], a[172:175], v[28:31], v[56:59]
v_mov_b64 v[84:85], v[220:221]
v_mov_b64 v[86:87], v[222:223]
v_mfma_f32_16x16x32_bf16 v[60:63], a[168:171], v[32:35], v[60:63]
ds_read_b128 v[24:27], v8 offset:51200
v_mfma_f32_16x16x32_bf16 v[64:67], a[172:175], v[32:35], v[64:67]
v_mov_b64 v[88:89], v[224:225]
v_mov_b64 v[90:91], v[226:227]
s_waitcnt lgkmcnt(4)
v_mfma_f32_16x16x32_bf16 v[52:55], a[176:179], v[36:39], v[52:55]
ds_read_b128 v[28:31], v9 offset:49152
v_mfma_f32_16x16x32_bf16 v[56:59], a[180:183], v[36:39], v[56:59]
v_mov_b64 v[220:221], v[228:229]
v_mov_b64 v[222:223], v[230:231]
v_mfma_f32_16x16x32_bf16 v[60:63], a[176:179], v[40:43], v[60:63]
ds_read_b128 v[32:35], v9 offset:51200
v_mfma_f32_16x16x32_bf16 v[64:67], a[180:183], v[40:43], v[64:67]
v_mov_b64 v[224:225], v[232:233]
v_mov_b64 v[226:227], v[234:235]
s_waitcnt lgkmcnt(4)
v_mfma_f32_16x16x32_bf16 v[52:55], a[184:187], v[44:47], v[52:55]
ds_read_b128 v[36:39], v8 offset:53248
v_mfma_f32_16x16x32_bf16 v[56:59], a[188:191], v[44:47], v[56:59]
v_cvt_pk_bf16_f32 v228, v68, v69
v_cvt_pk_bf16_f32 v229, v70, v71
v_mfma_f32_16x16x32_bf16 v[60:63], a[184:187], v[48:51], v[60:63]
ds_read_b128 v[40:43], v8 offset:55296
v_mfma_f32_16x16x32_bf16 v[64:67], a[188:191], v[48:51], v[64:67]
v_cvt_pk_bf16_f32 v230, v72, v73
v_cvt_pk_bf16_f32 v231, v74, v75
s_waitcnt lgkmcnt(4)
v_mfma_f32_16x16x32_bf16 v[52:55], a[192:195], v[20:23], v[52:55]
ds_read_b128 v[44:47], v9 offset:53248
v_mfma_f32_16x16x32_bf16 v[56:59], a[196:199], v[20:23], v[56:59]
v_cvt_pk_bf16_f32 v232, v76, v77
v_cvt_pk_bf16_f32 v233, v78, v79
v_mfma_f32_16x16x32_bf16 v[60:63], a[192:195], v[24:27], v[60:63]
ds_read_b128 v[48:51], v9 offset:55296
v_mfma_f32_16x16x32_bf16 v[64:67], a[196:199], v[24:27], v[64:67]
v_cvt_pk_bf16_f32 v234, v80, v81
v_cvt_pk_bf16_f32 v235, v82, v83
s_waitcnt lgkmcnt(4)
v_mfma_f32_16x16x32_bf16 v[52:55], a[200:203], v[28:31], v[52:55]
ds_read_b128 v[20:23], v8 offset:57344
v_mfma_f32_16x16x32_bf16 v[56:59], a[204:207], v[28:31], v[56:59]
v_mfma_f32_16x16x32_bf16 v[60:63], a[200:203], v[32:35], v[60:63]
ds_read_b128 v[24:27], v8 offset:59392
v_mfma_f32_16x16x32_bf16 v[64:67], a[204:207], v[32:35], v[64:67]
s_waitcnt lgkmcnt(4)
v_mfma_f32_16x16x32_bf16 v[52:55], a[208:211], v[36:39], v[52:55]
ds_read_b128 v[28:31], v9 offset:57344
v_mfma_f32_16x16x32_bf16 v[56:59], a[212:215], v[36:39], v[56:59]
v_mfma_f32_16x16x32_bf16 v[60:63], a[208:211], v[40:43], v[60:63]
ds_read_b128 v[32:35], v9 offset:59392
v_mfma_f32_16x16x32_bf16 v[64:67], a[212:215], v[40:43], v[64:67]
s_waitcnt lgkmcnt(4)
v_mfma_f32_16x16x32_bf16 v[52:55], a[216:219], v[44:47], v[52:55]
ds_read_b128 v[36:39], v8 offset:61440
v_mfma_f32_16x16x32_bf16 v[56:59], a[220:223], v[44:47], v[56:59]
s_waitcnt vmcnt(6)
v_readfirstlane_b32 s56, v100
s_cmp_eq_u32 s30, 1
s_cbranch_scc1 mega_kernel_q_kf0
s_cmp_gt_i32 s56, s42
s_cbranch_scc0 mega_kernel_q_kf0
s_mov_b32 s30, 1
s_mov_b32 m0, s61
s_nop 0
buffer_load_dwordx4 v5, s[84:87], s68 offen sc1 lds
mega_kernel_q_kf0:
v_mfma_f32_16x16x32_bf16 v[60:63], a[216:219], v[48:51], v[60:63]
ds_read_b128 v[40:43], v8 offset:63488
v_mfma_f32_16x16x32_bf16 v[64:67], a[220:223], v[48:51], v[64:67]
s_waitcnt lgkmcnt(4)
v_mfma_f32_16x16x32_bf16 v[52:55], a[224:227], v[20:23], v[52:55]
ds_read_b128 v[44:47], v9 offset:61440
v_mfma_f32_16x16x32_bf16 v[56:59], a[228:231], v[20:23], v[56:59]
v_mfma_f32_16x16x32_bf16 v[60:63], a[224:227], v[24:27], v[60:63]
ds_read_b128 v[48:51], v9 offset:63488
v_mfma_f32_16x16x32_bf16 v[64:67], a[228:231], v[24:27], v[64:67]
s_waitcnt lgkmcnt(5)
v_mfma_f32_16x16x32_bf16 v[52:55], a[232:235], v[28:31], v[52:55]
v_mfma_f32_16x16x32_bf16 v[56:59], a[236:239], v[28:31], v[56:59]
s_waitcnt lgkmcnt(4)
v_mfma_f32_16x16x32_bf16 v[60:63], a[232:235], v[32:35], v[60:63]
v_mfma_f32_16x16x32_bf16 v[64:67], a[236:239], v[32:35], v[64:67]
s_waitcnt lgkmcnt(3)
v_mfma_f32_16x16x32_bf16 v[52:55], a[240:243], v[36:39], v[52:55]
v_mfma_f32_16x16x32_bf16 v[56:59], a[244:247], v[36:39], v[56:59]
s_waitcnt lgkmcnt(2)
v_mfma_f32_16x16x32_bf16 v[60:63], a[240:243], v[40:43], v[60:63]
v_mfma_f32_16x16x32_bf16 v[64:67], a[244:247], v[40:43], v[64:67]
ds_write_b128 v101, v[84:87]
ds_write_b128 v101, v[88:91] offset:1024
s_waitcnt lgkmcnt(1)
v_mfma_f32_16x16x32_bf16 v[68:71], a[248:251], v[44:47], v[52:55]
v_mfma_f32_16x16x32_bf16 v[72:75], a[252:255], v[44:47], v[56:59]
s_waitcnt lgkmcnt(0)
v_mfma_f32_16x16x32_bf16 v[76:79], a[248:251], v[48:51], v[60:63]
v_mfma_f32_16x16x32_bf16 v[80:83], a[252:255], v[48:51], v[64:67]
mega_kernel_q_jl0:
s_cmp_eq_u32 s30, 1
s_cbranch_scc1 mega_kernel_q_kl0
mega_kernel_q_kw0:
v_mov_b32 v100, 0
s_mov_b64 exec, 1
buffer_atomic_add v100, v16, s[84:87], s62 offen sc0 sc1
s_mov_b64 exec, -1
s_waitcnt vmcnt(0)
v_readfirstlane_b32 s56, v100
s_cmp_gt_i32 s56, s42
s_cbranch_scc1 mega_kernel_q_kv0
s_cmp_eq_u32 s42, 63
s_cbranch_scc1 mega_kernel_q_kw0
s_branch mega_kernel_q_kw0
mega_kernel_q_kv0:
s_mov_b32 m0, s61
s_nop 0
buffer_load_dwordx4 v5, s[84:87], s68 offen sc1 lds
mega_kernel_q_kl0:
s_waitcnt lgkmcnt(0) vmcnt(0)
s_barrier
ds_read_b128 v[184:187], v102 offset:0
ds_read_b128 v[112:115], v103 offset:0
ds_read_b128 v[128:131], v103 offset:1024
ds_read_b128 v[188:191], v102 offset:2048
ds_read_b128 v[116:119], v103 offset:2048
ds_read_b128 v[132:135], v103 offset:3072
ds_read_b128 v[192:195], v102 offset:4096
ds_read_b128 v[120:123], v103 offset:4096
ds_read_b128 v[136:139], v103 offset:5120
ds_read_b128 v[196:199], v102 offset:6144
ds_read_b128 v[124:127], v103 offset:6144
ds_read_b128 v[140:143], v103 offset:7168
s_waitcnt lgkmcnt(9)
v_mfma_f32_16x16x32_bf16 v[200:203], v[112:115], v[184:187], 0
v_mfma_f32_16x16x32_bf16 v[204:207], v[128:131], v[184:187], 0
ds_read_b128 v[160:163], v94 offset:0
s_waitcnt lgkmcnt(7)
v_mfma_f32_16x16x32_bf16 v[200:203], v[116:119], v[188:191], v[200:203]
v_mfma_f32_16x16x32_bf16 v[204:207], v[132:135], v[188:191], v[204:207]
ds_read_b128 v[164:167], v94 offset:1024
s_waitcnt lgkmcnt(5)
v_mfma_f32_16x16x32_bf16 v[200:203], v[120:123], v[192:195], v[200:203]
v_mfma_f32_16x16x32_bf16 v[204:207], v[136:139], v[192:195], v[204:207]
ds_read_b128 v[168:171], v94 offset:2048
s_waitcnt lgkmcnt(3)
v_mfma_f32_16x16x32_bf16 v[200:203], v[124:127], v[196:199], v[200:203]
v_mfma_f32_16x16x32_bf16 v[204:207], v[140:143], v[196:199], v[204:207]
ds_read_b128 v[172:175], v94 offset:3072
s_waitcnt lgkmcnt(3)
v_mfma_f32_16x16x32_bf16 v[208:211], v[160:163], v[184:187], 0
ds_read_b128 v[144:147], v240 offset:0
ds_read_b64 v[176:177], v95 offset:0
s_waitcnt lgkmcnt(4)
v_mfma_f32_16x16x32_bf16 v[208:211], v[164:167], v[188:191], v[208:211]
ds_read_b128 v[148:151], v240 offset:1024
ds_read_b64 v[178:179], v95 offset:256
s_waitcnt lgkmcnt(5)
v_mfma_f32_16x16x32_bf16 v[208:211], v[168:171], v[192:195], v[208:211]
ds_read_b128 v[152:155], v240 offset:2048
ds_read_b64 v[180:181], v95 offset:1024
s_waitcnt lgkmcnt(6)
v_mfma_f32_16x16x32_bf16 v[208:211], v[172:175], v[196:199], v[208:211]
ds_read_b128 v[156:159], v240 offset:3072
ds_read_b64 v[182:183], v95 offset:1280
mega_kernel_q_sm0:
v_pk_mul_f32 v[200:201], v[200:201], s[54:55] op_sel_hi:[1,0]
v_pk_mul_f32 v[202:203], v[202:203], s[54:55] op_sel_hi:[1,0]
v_pk_mul_f32 v[204:205], v[204:205], s[54:55] op_sel_hi:[1,0]
v_pk_mul_f32 v[206:207], v[206:207], s[54:55] op_sel_hi:[1,0]
v_cndmask_b32 v200, v200, v241, s[12:13]
v_cndmask_b32 v201, v201, v241, s[14:15]
v_cndmask_b32 v202, v202, v241, s[16:17]
v_cndmask_b32 v203, v203, v241, s[18:19]
v_cndmask_b32 v204, v204, v241, s[20:21]
v_cndmask_b32 v205, v205, v241, s[22:23]
v_cndmask_b32 v206, v206, v241, s[24:25]
v_cndmask_b32 v207, v207, v241, s[26:27]
v_pk_mul_f32 v[208:209], v[208:209], s[54:55] op_sel_hi:[1,0]
v_pk_mul_f32 v[210:211], v[210:211], s[54:55] op_sel_hi:[1,0]
v_cndmask_b32 v208, v208, v97, s[28:29]
v_cndmask_b32 v209, v209, v97, s[28:29]
v_cndmask_b32 v210, v210, v97, s[28:29]
v_cndmask_b32 v211, v211, v97, s[28:29]
v_max3_f32 v236, v200, v201, v202
v_max3_f32 v236, v236, v203, v204
v_max3_f32 v236, v236, v205, v206
v_max3_f32 v236, v236, v207, v208
v_max3_f32 v236, v236, v209, v210
v_max_f32 v237, v236, v211
v_max_f32 v236, v236, v211
s_nop 1
v_permlane16_swap_b32 v236, v237
s_nop 0
v_max_f32 v238, v236, v237
v_max_f32 v239, v236, v237
s_nop 1
v_permlane32_swap_b32 v238, v239
s_nop 0
v_max_f32 v236, v238, v239
v_pk_add_f32 v[200:201], v[200:201], v[236:237] op_sel_hi:[1,0] neg_lo:[0,1] neg_hi:[0,1]
v_pk_add_f32 v[202:203], v[202:203], v[236:237] op_sel_hi:[1,0] neg_lo:[0,1] neg_hi:[0,1]
v_pk_add_f32 v[204:205], v[204:205], v[236:237] op_sel_hi:[1,0] neg_lo:[0,1] neg_hi:[0,1]
v_pk_add_f32 v[206:207], v[206:207], v[236:237] op_sel_hi:[1,0] neg_lo:[0,1] neg_hi:[0,1]
v_pk_add_f32 v[208:209], v[208:209], v[236:237] op_sel_hi:[1,0] neg_lo:[0,1] neg_hi:[0,1]
v_pk_add_f32 v[210:211], v[210:211], v[236:237] op_sel_hi:[1,0] neg_lo:[0,1] neg_hi:[0,1]
v_exp_f32 v200, v200
v_exp_f32 v201, v201
v_exp_f32 v202, v202
v_exp_f32 v203, v203
v_exp_f32 v204, v204
v_exp_f32 v205, v205
v_exp_f32 v206, v206
v_exp_f32 v207, v207
v_exp_f32 v208, v208
v_exp_f32 v209, v209
v_exp_f32 v210, v210
v_exp_f32 v211, v211
s_nop 0
v_cvt_pk_bf16_f32 v212, v200, v201
v_cvt_pk_bf16_f32 v213, v202, v203
v_cvt_pk_bf16_f32 v214, v204, v205
v_cvt_pk_bf16_f32 v215, v206, v207
v_cvt_pk_bf16_f32 v216, v208, v209
v_cvt_pk_bf16_f32 v217, v210, v211
s_waitcnt lgkmcnt(0)
s_nop 0
v_mfma_f32_16x16x32_bf16 v[108:111], v[104:107], v[212:215], 0
v_mfma_f32_16x16x32_bf16 v[112:115], v[144:147], v[212:215], 0
v_mfma_f32_16x16x32_bf16 v[116:119], v[148:151], v[212:215], 0
v_mfma_f32_16x16x32_bf16 v[120:123], v[152:155], v[212:215], 0
v_mfma_f32_16x16x32_bf16 v[124:127], v[156:159], v[212:215], 0
v_mfma_f32_16x16x16_bf16 v[108:111], v[104:105], v[216:217], v[108:111]
v_mfma_f32_16x16x16_bf16 v[112:115], v[176:177], v[216:217], v[112:115]
v_mfma_f32_16x16x16_bf16 v[116:119], v[178:179], v[216:217], v[116:119]
v_mfma_f32_16x16x16_bf16 v[120:123], v[180:181], v[216:217], v[120:123]
v_mfma_f32_16x16x16_bf16 v[124:127], v[182:183], v[216:217], v[124:127]
s_lshr_b32 s63, s42, 2
s_xnor_b32 s63, s63, s98
s_and_b32 s63, s63, 1
s_lshl_b32 s63, s63, 13
s_lshl_b32 s51, s42, 19
s_add_u32 s51, s51, s63
s_nop 2
v_rcp_f32 v238, v108
v_rcp_f32 v239, v109
s_nop 1
v_pk_mul_f32 v[112:113], v[112:113], v[238:239]
v_pk_mul_f32 v[114:115], v[114:115], v[238:239]
v_pk_mul_f32 v[116:117], v[116:117], v[238:239]
v_pk_mul_f32 v[118:119], v[118:119], v[238:239]
v_pk_mul_f32 v[120:121], v[120:121], v[238:239]
v_pk_mul_f32 v[122:123], v[122:123], v[238:239]
v_pk_mul_f32 v[124:125], v[124:125], v[238:239]
v_pk_mul_f32 v[126:127], v[126:127], v[238:239]
v_cvt_pk_bf16_f32 v200, v112, v113
v_cvt_pk_bf16_f32 v201, v114, v115
v_cvt_pk_bf16_f32 v202, v116, v117
v_cvt_pk_bf16_f32 v203, v118, v119
v_cvt_pk_bf16_f32 v204, v120, v121
v_cvt_pk_bf16_f32 v205, v122, v123
v_cvt_pk_bf16_f32 v206, v124, v125
v_cvt_pk_bf16_f32 v207, v126, v127
buffer_store_dwordx4 v[200:203], v96, s[84:87], s51 offen sc1
buffer_store_dwordx4 v[204:207], v96, s[84:87], s51 offen offset:2048 sc1
s_add_u32 s42, s42, 1
s_cmp_lt_u32 s42, 64
s_cbranch_scc1 mega_kernel_q_loop
s_waitcnt vmcnt(0)
v_mov_b32 v17, s42
s_mov_b64 exec, 1
buffer_store_dword v17, v16, s[84:87], s49 offen sc1
s_mov_b64 exec, -1
mega_kernel_q_quit:
s_endpgm
mega_kernel_rd:
s_mov_b32 s93, s40
s_load_dwordx2 s[4:5], s[0:1], 56
s_mov_b32 s48, 0x3f7ec46d
s_mov_b32 s49, 0x3dc8bd36
s_mov_b32 s50, 0x3f7b14be
s_mov_b32 s51, 0x3e47c5c2
s_mov_b32 s52, 0x3f74fa0b
s_mov_b32 s53, 0x3e94a031
s_mov_b32 s54, 0x3f6c835e
s_mov_b32 s55, 0x3ec3ef15
s_mov_b32 s56, 0x3f61c598
s_mov_b32 s57, 0x3ef15aea
s_mov_b32 s58, 0x3f54db31
s_mov_b32 s59, 0x3f0e39da
s_mov_b32 s60, 0x3f45e403
s_mov_b32 s61, 0x3f226799
s_mov_b32 s62, 0x3f3504f3
s_mov_b32 s63, 0x3f3504f3
v_and_b32 v1, 31, v0
v_lshrrev_b32 v2, 5, v0
v_cvt_f32_u32 v3, v1
v_mul_u32_u24 v10, 8448, v2
v_lshl_add_u32 v4, v1, 3, v10
v_mul_u32_u24 v5, 264, v1
v_add_u32 v5, v5, v10
v_and_b32 v11, 7, v0
v_lshrrev_b32 v9, 3, v0
v_mul_u32_u24 v10, 8448, v11
v_lshl_add_u32 v6, v9, 3, v10
v_lshlrev_b32 v7, 3, v9
v_sub_u32 v7, v10, v7
v_add_u32 v7, 4096, v7
v_mul_u32_u24 v8, 32768, v9
v_lshl_add_u32 v8, v11, 4, v8
v_mul_f32 v12, 0xba800000, v3
v_cos_f32 v82, v12
v_sin_f32 v83, v12
v_mul_f32 v12, 0xbb000000, v3
v_cos_f32 v84, v12
v_sin_f32 v85, v12
v_mul_f32 v12, 0xbb400000, v3
v_cos_f32 v86, v12
v_sin_f32 v87, v12
v_mul_f32 v12, 0xbb800000, v3
v_cos_f32 v88, v12
v_sin_f32 v89, v12
v_mul_f32 v12, 0xbba00000, v3
v_cos_f32 v90, v12
v_sin_f32 v91, v12
v_mul_f32 v12, 0xbbc00000, v3
v_cos_f32 v92, v12
v_sin_f32 v93, v12
v_mul_f32 v12, 0xbbe00000, v3
v_cos_f32 v94, v12
v_sin_f32 v95, v12
v_mul_f32 v12, 0xbc000000, v3
v_cos_f32 v96, v12
v_sin_f32 v97, v12
v_mul_f32 v12, 0xbc100000, v3
v_cos_f32 v98, v12
v_sin_f32 v99, v12
v_mul_f32 v12, 0xbc200000, v3
v_cos_f32 v100, v12
v_sin_f32 v101, v12
v_mul_f32 v12, 0xbc300000, v3
v_cos_f32 v102, v12
v_sin_f32 v103, v12
v_mul_f32 v12, 0xbc400000, v3
v_cos_f32 v104, v12
v_sin_f32 v105, v12
v_mul_f32 v12, 0xbc500000, v3
v_cos_f32 v106, v12
v_sin_f32 v107, v12
v_mul_f32 v12, 0xbc600000, v3
v_cos_f32 v108, v12
v_sin_f32 v109, v12
v_mul_f32 v12, 0xbc700000, v3
v_cos_f32 v110, v12
v_sin_f32 v111, v12
v_mul_f32 v12, 0xbc800000, v3
v_cos_f32 v112, v12
v_sin_f32 v113, v12
v_mul_f32 v12, 0xbc880000, v3
v_cos_f32 v114, v12
v_sin_f32 v115, v12
v_mul_f32 v12, 0xbc900000, v3
v_cos_f32 v116, v12
v_sin_f32 v117, v12
v_mul_f32 v12, 0xbc980000, v3
v_cos_f32 v118, v12
v_sin_f32 v119, v12
v_mul_f32 v12, 0xbca00000, v3
v_cos_f32 v120, v12
v_sin_f32 v121, v12
v_mul_f32 v12, 0xbca80000, v3
v_cos_f32 v122, v12
v_sin_f32 v123, v12
v_mul_f32 v12, 0xbcb00000, v3
v_cos_f32 v124, v12
v_sin_f32 v125, v12
v_mul_f32 v12, 0xbcb80000, v3
v_cos_f32 v126, v12
v_sin_f32 v127, v12
v_mul_f32 v12, 0xbcc00000, v3
v_cos_f32 v128, v12
v_sin_f32 v129, v12
v_mul_f32 v12, 0xbcc80000, v3
v_cos_f32 v130, v12
v_sin_f32 v131, v12
v_mul_f32 v12, 0xbcd00000, v3
v_cos_f32 v132, v12
v_sin_f32 v133, v12
v_mul_f32 v12, 0xbcd80000, v3
v_cos_f32 v134, v12
v_sin_f32 v135, v12
v_mul_f32 v12, 0xbce00000, v3
v_cos_f32 v136, v12
v_sin_f32 v137, v12
v_mul_f32 v12, 0xbce80000, v3
v_cos_f32 v138, v12
v_sin_f32 v139, v12
v_mul_f32 v12, 0xbcf00000, v3
v_cos_f32 v140, v12
v_sin_f32 v141, v12
v_mul_f32 v12, 0xbcf80000, v3
v_cos_f32 v142, v12
v_sin_f32 v143, v12
v_lshlrev_b32 v12, 12, v2
v_lshl_add_u32 v12, v1, 1, v12
s_waitcnt lgkmcnt(0)
s_mov_b32 s6, 4194304
s_mov_b32 s7, 0x00020000
v_mov_b32 v144, 0
v_mov_b32 v145, 0
v_mov_b32 v146, 0
v_mov_b32 v147, 0
v_mov_b32 v148, 0
v_mov_b32 v149, 0
v_mov_b32 v150, 0
v_mov_b32 v151, 0
v_mov_b32 v152, 0
v_mov_b32 v153, 0
v_mov_b32 v154, 0
v_mov_b32 v155, 0
v_mov_b32 v156, 0
v_mov_b32 v157, 0
v_mov_b32 v158, 0
v_mov_b32 v159, 0
v_mov_b32 v160, 0
v_mov_b32 v161, 0
v_mov_b32 v162, 0
v_mov_b32 v163, 0
v_mov_b32 v164, 0
v_mov_b32 v165, 0
v_mov_b32 v166, 0
v_mov_b32 v167, 0
v_mov_b32 v168, 0
v_mov_b32 v169, 0
v_mov_b32 v170, 0
v_mov_b32 v171, 0
v_mov_b32 v172, 0
v_mov_b32 v173, 0
v_mov_b32 v174, 0
v_mov_b32 v175, 0
v_mov_b32 v176, 0
v_mov_b32 v177, 0
v_mov_b32 v178, 0
v_mov_b32 v179, 0
v_mov_b32 v180, 0
v_mov_b32 v181, 0
v_mov_b32 v182, 0
v_mov_b32 v183, 0
v_mov_b32 v184, 0
v_mov_b32 v185, 0
v_mov_b32 v186, 0
v_mov_b32 v187, 0
v_mov_b32 v188, 0
v_mov_b32 v189, 0
v_mov_b32 v190, 0
v_mov_b32 v191, 0
v_mov_b32 v192, 0
v_mov_b32 v193, 0
v_mov_b32 v194, 0
v_mov_b32 v195, 0
v_mov_b32 v196, 0
v_mov_b32 v197, 0
v_mov_b32 v198, 0
v_mov_b32 v199, 0
v_mov_b32 v200, 0
v_mov_b32 v201, 0
v_mov_b32 v202, 0
v_mov_b32 v203, 0
v_mov_b32 v204, 0
v_mov_b32 v205, 0
v_mov_b32 v206, 0
v_mov_b32 v207, 0
s_cmp_lt_u32 s93, 128
s_cbranch_scc0 mega_kernel_f1_e
s_lshl_b32 s12, s93, 15
buffer_load_short_d16_hi v144, v12, s[4:7], s12 offen offset:0
buffer_load_short_d16_hi v145, v12, s[4:7], s12 offen offset:2048
buffer_load_short_d16_hi v176, v12, s[4:7], s12 offen offset:1024
buffer_load_short_d16_hi v177, v12, s[4:7], s12 offen offset:3072
buffer_load_short_d16_hi v146, v12, s[4:7], s12 offen offset:64
buffer_load_short_d16_hi v147, v12, s[4:7], s12 offen offset:2112
buffer_load_short_d16_hi v178, v12, s[4:7], s12 offen offset:1088
buffer_load_short_d16_hi v179, v12, s[4:7], s12 offen offset:3136
buffer_load_short_d16_hi v148, v12, s[4:7], s12 offen offset:128
buffer_load_short_d16_hi v149, v12, s[4:7], s12 offen offset:2176
buffer_load_short_d16_hi v180, v12, s[4:7], s12 offen offset:1152
buffer_load_short_d16_hi v181, v12, s[4:7], s12 offen offset:3200
buffer_load_short_d16_hi v150, v12, s[4:7], s12 offen offset:192
buffer_load_short_d16_hi v151, v12, s[4:7], s12 offen offset:2240
buffer_load_short_d16_hi v182, v12, s[4:7], s12 offen offset:1216
buffer_load_short_d16_hi v183, v12, s[4:7], s12 offen offset:3264
buffer_load_short_d16_hi v152, v12, s[4:7], s12 offen offset:256
buffer_load_short_d16_hi v153, v12, s[4:7], s12 offen offset:2304
buffer_load_short_d16_hi v184, v12, s[4:7], s12 offen offset:1280
buffer_load_short_d16_hi v185, v12, s[4:7], s12 offen offset:3328
buffer_load_short_d16_hi v154, v12, s[4:7], s12 offen offset:320
buffer_load_short_d16_hi v155, v12, s[4:7], s12 offen offset:2368
buffer_load_short_d16_hi v186, v12, s[4:7], s12 offen offset:1344
buffer_load_short_d16_hi v187, v12, s[4:7], s12 offen offset:3392
buffer_load_short_d16_hi v156, v12, s[4:7], s12 offen offset:384
buffer_load_short_d16_hi v157, v12, s[4:7], s12 offen offset:2432
buffer_load_short_d16_hi v188, v12, s[4:7], s12 offen offset:1408
buffer_load_short_d16_hi v189, v12, s[4:7], s12 offen offset:3456
buffer_load_short_d16_hi v158, v12, s[4:7], s12 offen offset:448
buffer_load_short_d16_hi v159, v12, s[4:7], s12 offen offset:2496
buffer_load_short_d16_hi v190, v12, s[4:7], s12 offen offset:1472
buffer_load_short_d16_hi v191, v12, s[4:7], s12 offen offset:3520
buffer_load_short_d16_hi v160, v12, s[4:7], s12 offen offset:512
buffer_load_short_d16_hi v161, v12, s[4:7], s12 offen offset:2560
buffer_load_short_d16_hi v192, v12, s[4:7], s12 offen offset:1536
buffer_load_short_d16_hi v193, v12, s[4:7], s12 offen offset:3584
buffer_load_short_d16_hi v162, v12, s[4:7], s12 offen offset:576
buffer_load_short_d16_hi v163, v12, s[4:7], s12 offen offset:2624
buffer_load_short_d16_hi v194, v12, s[4:7], s12 offen offset:1600
buffer_load_short_d16_hi v195, v12, s[4:7], s12 offen offset:3648
buffer_load_short_d16_hi v164, v12, s[4:7], s12 offen offset:640
buffer_load_short_d16_hi v165, v12, s[4:7], s12 offen offset:2688
buffer_load_short_d16_hi v196, v12, s[4:7], s12 offen offset:1664
buffer_load_short_d16_hi v197, v12, s[4:7], s12 offen offset:3712
buffer_load_short_d16_hi v166, v12, s[4:7], s12 offen offset:704
buffer_load_short_d16_hi v167, v12, s[4:7], s12 offen offset:2752
buffer_load_short_d16_hi v198, v12, s[4:7], s12 offen offset:1728
buffer_load_short_d16_hi v199, v12, s[4:7], s12 offen offset:3776
buffer_load_short_d16_hi v168, v12, s[4:7], s12 offen offset:768
buffer_load_short_d16_hi v169, v12, s[4:7], s12 offen offset:2816
buffer_load_short_d16_hi v200, v12, s[4:7], s12 offen offset:1792
buffer_load_short_d16_hi v201, v12, s[4:7], s12 offen offset:3840
buffer_load_short_d16_hi v170, v12, s[4:7], s12 offen offset:832
buffer_load_short_d16_hi v171, v12, s[4:7], s12 offen offset:2880
buffer_load_short_d16_hi v202, v12, s[4:7], s12 offen offset:1856
buffer_load_short_d16_hi v203, v12, s[4:7], s12 offen offset:3904
buffer_load_short_d16_hi v172, v12, s[4:7], s12 offen offset:896
buffer_load_short_d16_hi v173, v12, s[4:7], s12 offen offset:2944
buffer_load_short_d16_hi v204, v12, s[4:7], s12 offen offset:1920
buffer_load_short_d16_hi v205, v12, s[4:7], s12 offen offset:3968
buffer_load_short_d16_hi v174, v12, s[4:7], s12 offen offset:960
buffer_load_short_d16_hi v175, v12, s[4:7], s12 offen offset:3008
buffer_load_short_d16_hi v206, v12, s[4:7], s12 offen offset:1984
buffer_load_short_d16_hi v207, v12, s[4:7], s12 offen offset:4032
s_waitcnt vmcnt(0)
mega_kernel_f1_l:
s_add_u32 s21, s93, 32
s_cmp_lt_u32 s21, 128
s_cselect_b32 s22, s21, s93
s_waitcnt vmcnt(17)
v_pk_add_f32 v[48:49], v[144:145], v[176:177] neg_lo:[0,1] neg_hi:[0,1]
v_pk_add_f32 v[16:17], v[144:145], v[176:177]
v_pk_add_f32 v[14:15], v[146:147], v[178:179] neg_lo:[0,1] neg_hi:[0,1]
v_pk_add_f32 v[18:19], v[146:147], v[178:179]
v_pk_mul_f32 v[50:51], v[14:15], s[50:51] op_sel:[0,0] op_sel_hi:[0,1] neg_lo:[0,0] neg_hi:[0,1]
v_pk_fma_f32 v[50:51], v[14:15], s[50:51], v[50:51] op_sel:[1,1,0] op_sel_hi:[1,0,1] neg_lo:[0,0,0] neg_hi:[0,0,0]
v_pk_add_f32 v[14:15], v[148:149], v[180:181] neg_lo:[0,1] neg_hi:[0,1]
v_pk_add_f32 v[20:21], v[148:149], v[180:181]
v_pk_mul_f32 v[52:53], v[14:15], s[54:55] op_sel:[0,0] op_sel_hi:[0,1] neg_lo:[0,0] neg_hi:[0,1]
v_pk_fma_f32 v[52:53], v[14:15], s[54:55], v[52:53] op_sel:[1,1,0] op_sel_hi:[1,0,1] neg_lo:[0,0,0] neg_hi:[0,0,0]
v_pk_add_f32 v[14:15], v[150:151], v[182:183] neg_lo:[0,1] neg_hi:[0,1]
v_pk_add_f32 v[22:23], v[150:151], v[182:183]
v_pk_mul_f32 v[54:55], v[14:15], s[58:59] op_sel:[0,0] op_sel_hi:[0,1] neg_lo:[0,0] neg_hi:[0,1]
v_pk_fma_f32 v[54:55], v[14:15], s[58:59], v[54:55] op_sel:[1,1,0] op_sel_hi:[1,0,1] neg_lo:[0,0,0] neg_hi:[0,0,0]
v_pk_add_f32 v[14:15], v[152:153], v[184:185] neg_lo:[0,1] neg_hi:[0,1]
v_pk_add_f32 v[24:25], v[152:153], v[184:185]
v_pk_mul_f32 v[56:57], v[14:15], s[62:63] op_sel:[0,0] op_sel_hi:[0,1] neg_lo:[0,0] neg_hi:[0,1]
v_pk_fma_f32 v[56:57], v[14:15], s[62:63], v[56:57] op_sel:[1,1,0] op_sel_hi:[1,0,1] neg_lo:[0,0,0] neg_hi:[0,0,0]
v_pk_add_f32 v[14:15], v[154:155], v[186:187] neg_lo:[0,1] neg_hi:[0,1]
v_pk_add_f32 v[26:27], v[154:155], v[186:187]
v_pk_mul_f32 v[58:59], v[14:15], s[58:59] op_sel:[0,1] op_sel_hi:[0,0] neg_lo:[0,0] neg_hi:[0,1]
v_pk_fma_f32 v[58:59], v[14:15], s[58:59], v[58:59] op_sel:[1,0,0] op_sel_hi:[1,1,1] neg_lo:[0,0,0] neg_hi:[0,0,0]
v_pk_add_f32 v[14:15], v[156:157], v[188:189] neg_lo:[0,1] neg_hi:[0,1]
v_pk_add_f32 v[28:29], v[156:157], v[188:189]
v_pk_mul_f32 v[60:61], v[14:15], s[54:55] op_sel:[0,1] op_sel_hi:[0,0] neg_lo:[0,0] neg_hi:[0,1]
v_pk_fma_f32 v[60:61], v[14:15], s[54:55], v[60:61] op_sel:[1,0,0] op_sel_hi:[1,1,1] neg_lo:[0,0,0] neg_hi:[0,0,0]
v_pk_add_f32 v[14:15], v[158:159], v[190:191] neg_lo:[0,1] neg_hi:[0,1]
v_pk_add_f32 v[30:31], v[158:159], v[190:191]
v_pk_mul_f32 v[62:63], v[14:15], s[50:51] op_sel:[0,1] op_sel_hi:[0,0] neg_lo:[0,0] neg_hi:[0,1]
v_pk_fma_f32 v[62:63], v[14:15], s[50:51], v[62:63] op_sel:[1,0,0] op_sel_hi:[1,1,1] neg_lo:[0,0,0] neg_hi:[0,0,0]
v_pk_add_f32 v[64:65], v[160:161], v[192:193] op_sel:[1,1] op_sel_hi:[0,0] neg_lo:[0,1] neg_hi:[1,0]
v_pk_add_f32 v[32:33], v[160:161], v[192:193]
v_pk_add_f32 v[14:15], v[162:163], v[194:195] neg_lo:[0,1] neg_hi:[0,1]
v_pk_add_f32 v[34:35], v[162:163], v[194:195]
v_pk_mul_f32 v[66:67], v[14:15], s[50:51] op_sel:[0,1] op_sel_hi:[0,0] neg_lo:[0,1] neg_hi:[0,1]
v_pk_fma_f32 v[66:67], v[14:15], s[50:51], v[66:67] op_sel:[1,0,0] op_sel_hi:[1,1,1] neg_lo:[0,0,0] neg_hi:[0,1,0]
v_pk_add_f32 v[14:15], v[164:165], v[196:197] neg_lo:[0,1] neg_hi:[0,1]
v_pk_add_f32 v[36:37], v[164:165], v[196:197]
v_pk_mul_f32 v[68:69], v[14:15], s[54:55] op_sel:[0,1] op_sel_hi:[0,0] neg_lo:[0,1] neg_hi:[0,1]
v_pk_fma_f32 v[68:69], v[14:15], s[54:55], v[68:69] op_sel:[1,0,0] op_sel_hi:[1,1,1] neg_lo:[0,0,0] neg_hi:[0,1,0]
v_pk_add_f32 v[14:15], v[166:167], v[198:199] neg_lo:[0,1] neg_hi:[0,1]
v_pk_add_f32 v[38:39], v[166:167], v[198:199]
v_pk_mul_f32 v[70:71], v[14:15], s[58:59] op_sel:[0,1] op_sel_hi:[0,0] neg_lo:[0,1] neg_hi:[0,1]
v_pk_fma_f32 v[70:71], v[14:15], s[58:59], v[70:71] op_sel:[1,0,0] op_sel_hi:[1,1,1] neg_lo:[0,0,0] neg_hi:[0,1,0]
v_pk_add_f32 v[14:15], v[168:169], v[200:201] neg_lo:[0,1] neg_hi:[0,1]
v_pk_add_f32 v[40:41], v[168:169], v[200:201]
v_pk_mul_f32 v[72:73], v[14:15], s[62:63] op_sel:[0,0] op_sel_hi:[0,1] neg_lo:[0,1] neg_hi:[0,1]
v_pk_fma_f32 v[72:73], v[14:15], s[62:63], v[72:73] op_sel:[1,1,0] op_sel_hi:[1,0,1] neg_lo:[0,0,0] neg_hi:[0,1,0]
v_pk_add_f32 v[14:15], v[170:171], v[202:203] neg_lo:[0,1] neg_hi:[0,1]
v_pk_add_f32 v[42:43], v[170:171], v[202:203]
v_pk_mul_f32 v[74:75], v[14:15], s[58:59] op_sel:[0,0] op_sel_hi:[0,1] neg_lo:[0,1] neg_hi:[0,1]
v_pk_fma_f32 v[74:75], v[14:15], s[58:59], v[74:75] op_sel:[1,1,0] op_sel_hi:[1,0,1] neg_lo:[0,0,0] neg_hi:[0,1,0]
v_pk_add_f32 v[14:15], v[172:173], v[204:205] neg_lo:[0,1] neg_hi:[0,1]
v_pk_add_f32 v[44:45], v[172:173], v[204:205]
v_pk_mul_f32 v[76:77], v[14:15], s[54:55] op_sel:[0,0] op_sel_hi:[0,1] neg_lo:[0,1] neg_hi:[0,1]
v_pk_fma_f32 v[76:77], v[14:15], s[54:55], v[76:77] op_sel:[1,1,0] op_sel_hi:[1,0,1] neg_lo:[0,0,0] neg_hi:[0,1,0]
v_pk_add_f32 v[14:15], v[174:175], v[206:207] neg_lo:[0,1] neg_hi:[0,1]
v_pk_add_f32 v[46:47], v[174:175], v[206:207]
v_pk_mul_f32 v[78:79], v[14:15], s[50:51] op_sel:[0,0] op_sel_hi:[0,1] neg_lo:[0,1] neg_hi:[0,1]
v_pk_fma_f32 v[78:79], v[14:15], s[50:51], v[78:79] op_sel:[1,1,0] op_sel_hi:[1,0,1] neg_lo:[0,0,0] neg_hi:[0,1,0]
s_lshl_b32 s12, s22, 15
buffer_load_short_d16_hi v144, v12, s[4:7], s12 offen offset:0
buffer_load_short_d16_hi v145, v12, s[4:7], s12 offen offset:2048
buffer_load_short_d16_hi v176, v12, s[4:7], s12 offen offset:1024
buffer_load_short_d16_hi v177, v12, s[4:7], s12 offen offset:3072
buffer_load_short_d16_hi v146, v12, s[4:7], s12 offen offset:64
buffer_load_short_d16_hi v147, v12, s[4:7], s12 offen offset:2112
buffer_load_short_d16_hi v178, v12, s[4:7], s12 offen offset:1088
buffer_load_short_d16_hi v179, v12, s[4:7], s12 offen offset:3136
buffer_load_short_d16_hi v148, v12, s[4:7], s12 offen offset:128
buffer_load_short_d16_hi v149, v12, s[4:7], s12 offen offset:2176
buffer_load_short_d16_hi v180, v12, s[4:7], s12 offen offset:1152
buffer_load_short_d16_hi v181, v12, s[4:7], s12 offen offset:3200
buffer_load_short_d16_hi v150, v12, s[4:7], s12 offen offset:192
buffer_load_short_d16_hi v151, v12, s[4:7], s12 offen offset:2240
buffer_load_short_d16_hi v182, v12, s[4:7], s12 offen offset:1216
buffer_load_short_d16_hi v183, v12, s[4:7], s12 offen offset:3264
buffer_load_short_d16_hi v152, v12, s[4:7], s12 offen offset:256
buffer_load_short_d16_hi v153, v12, s[4:7], s12 offen offset:2304
buffer_load_short_d16_hi v184, v12, s[4:7], s12 offen offset:1280
buffer_load_short_d16_hi v185, v12, s[4:7], s12 offen offset:3328
buffer_load_short_d16_hi v154, v12, s[4:7], s12 offen offset:320
buffer_load_short_d16_hi v155, v12, s[4:7], s12 offen offset:2368
buffer_load_short_d16_hi v186, v12, s[4:7], s12 offen offset:1344
buffer_load_short_d16_hi v187, v12, s[4:7], s12 offen offset:3392
buffer_load_short_d16_hi v156, v12, s[4:7], s12 offen offset:384
buffer_load_short_d16_hi v157, v12, s[4:7], s12 offen offset:2432
buffer_load_short_d16_hi v188, v12, s[4:7], s12 offen offset:1408
buffer_load_short_d16_hi v189, v12, s[4:7], s12 offen offset:3456
buffer_load_short_d16_hi v158, v12, s[4:7], s12 offen offset:448
buffer_load_short_d16_hi v159, v12, s[4:7], s12 offen offset:2496
buffer_load_short_d16_hi v190, v12, s[4:7], s12 offen offset:1472
buffer_load_short_d16_hi v191, v12, s[4:7], s12 offen offset:3520
buffer_load_short_d16_hi v160, v12, s[4:7], s12 offen offset:512
buffer_load_short_d16_hi v161, v12, s[4:7], s12 offen offset:2560
buffer_load_short_d16_hi v192, v12, s[4:7], s12 offen offset:1536
buffer_load_short_d16_hi v193, v12, s[4:7], s12 offen offset:3584
buffer_load_short_d16_hi v162, v12, s[4:7], s12 offen offset:576
buffer_load_short_d16_hi v163, v12, s[4:7], s12 offen offset:2624
buffer_load_short_d16_hi v194, v12, s[4:7], s12 offen offset:1600
buffer_load_short_d16_hi v195, v12, s[4:7], s12 offen offset:3648
buffer_load_short_d16_hi v164, v12, s[4:7], s12 offen offset:640
buffer_load_short_d16_hi v165, v12, s[4:7], s12 offen offset:2688
buffer_load_short_d16_hi v196, v12, s[4:7], s12 offen offset:1664
buffer_load_short_d16_hi v197, v12, s[4:7], s12 offen offset:3712
buffer_load_short_d16_hi v166, v12, s[4:7], s12 offen offset:704
buffer_load_short_d16_hi v167, v12, s[4:7], s12 offen offset:2752
buffer_load_short_d16_hi v198, v12, s[4:7], s12 offen offset:1728
buffer_load_short_d16_hi v199, v12, s[4:7], s12 offen offset:3776
buffer_load_short_d16_hi v168, v12, s[4:7], s12 offen offset:768
buffer_load_short_d16_hi v169, v12, s[4:7], s12 offen offset:2816
buffer_load_short_d16_hi v200, v12, s[4:7], s12 offen offset:1792
buffer_load_short_d16_hi v201, v12, s[4:7], s12 offen offset:3840
buffer_load_short_d16_hi v170, v12, s[4:7], s12 offen offset:832
buffer_load_short_d16_hi v171, v12, s[4:7], s12 offen offset:2880
buffer_load_short_d16_hi v202, v12, s[4:7], s12 offen offset:1856
buffer_load_short_d16_hi v203, v12, s[4:7], s12 offen offset:3904
buffer_load_short_d16_hi v172, v12, s[4:7], s12 offen offset:896
buffer_load_short_d16_hi v173, v12, s[4:7], s12 offen offset:2944
buffer_load_short_d16_hi v204, v12, s[4:7], s12 offen offset:1920
buffer_load_short_d16_hi v205, v12, s[4:7], s12 offen offset:3968
buffer_load_short_d16_hi v174, v12, s[4:7], s12 offen offset:960
buffer_load_short_d16_hi v175, v12, s[4:7], s12 offen offset:3008
buffer_load_short_d16_hi v206, v12, s[4:7], s12 offen offset:1984
buffer_load_short_d16_hi v207, v12, s[4:7], s12 offen offset:4032
v_pk_add_f32 v[14:15], v[16:17], v[32:33] neg_lo:[0,1] neg_hi:[0,1]
v_pk_add_f32 v[16:17], v[16:17], v[32:33]
v_pk_add_f32 v[32:33], v[18:19], v[34:35] neg_lo:[0,1] neg_hi:[0,1]
v_pk_add_f32 v[18:19], v[18:19], v[34:35]
v_pk_mul_f32 v[34:35], v[32:33], s[54:55] op_sel:[0,0] op_sel_hi:[0,1] neg_lo:[0,0] neg_hi:[0,1]
v_pk_fma_f32 v[34:35], v[32:33], s[54:55], v[34:35] op_sel:[1,1,0] op_sel_hi:[1,0,1] neg_lo:[0,0,0] neg_hi:[0,0,0]
v_pk_add_f32 v[32:33], v[20:21], v[36:37] neg_lo:[0,1] neg_hi:[0,1]
v_pk_add_f32 v[20:21], v[20:21], v[36:37]
v_pk_mul_f32 v[36:37], v[32:33], s[62:63] op_sel:[0,0] op_sel_hi:[0,1] neg_lo:[0,0] neg_hi:[0,1]
v_pk_fma_f32 v[36:37], v[32:33], s[62:63], v[36:37] op_sel:[1,1,0] op_sel_hi:[1,0,1] neg_lo:[0,0,0] neg_hi:[0,0,0]
v_pk_add_f32 v[32:33], v[22:23], v[38:39] neg_lo:[0,1] neg_hi:[0,1]
v_pk_add_f32 v[22:23], v[22:23], v[38:39]
v_pk_mul_f32 v[38:39], v[32:33], s[54:55] op_sel:[0,1] op_sel_hi:[0,0] neg_lo:[0,0] neg_hi:[0,1]
v_pk_fma_f32 v[38:39], v[32:33], s[54:55], v[38:39] op_sel:[1,0,0] op_sel_hi:[1,1,1] neg_lo:[0,0,0] neg_hi:[0,0,0]
v_pk_add_f32 v[32:33], v[24:25], v[40:41] op_sel:[1,1] op_sel_hi:[0,0] neg_lo:[0,1] neg_hi:[1,0]
v_pk_add_f32 v[24:25], v[24:25], v[40:41]
v_pk_add_f32 v[40:41], v[26:27], v[42:43] neg_lo:[0,1] neg_hi:[0,1]
v_pk_add_f32 v[26:27], v[26:27], v[42:43]
v_pk_mul_f32 v[42:43], v[40:41], s[54:55] op_sel:[0,1] op_sel_hi:[0,0] neg_lo:[0,1] neg_hi:[0,1]
v_pk_fma_f32 v[42:43], v[40:41], s[54:55], v[42:43] op_sel:[1,0,0] op_sel_hi:[1,1,1] neg_lo:[0,0,0] neg_hi:[0,1,0]
v_pk_add_f32 v[40:41], v[28:29], v[44:45] neg_lo:[0,1] neg_hi:[0,1]
v_pk_add_f32 v[28:29], v[28:29], v[44:45]
v_pk_mul_f32 v[44:45], v[40:41], s[62:63] op_sel:[0,0] op_sel_hi:[0,1] neg_lo:[0,1] neg_hi:[0,1]
v_pk_fma_f32 v[44:45], v[40:41], s[62:63], v[44:45] op_sel:[1,1,0] op_sel_hi:[1,0,1] neg_lo:[0,0,0] neg_hi:[0,1,0]
v_pk_add_f32 v[40:41], v[30:31], v[46:47] neg_lo:[0,1] neg_hi:[0,1]
v_pk_add_f32 v[30:31], v[30:31], v[46:47]
v_pk_mul_f32 v[46:47], v[40:41], s[54:55] op_sel:[0,0] op_sel_hi:[0,1] neg_lo:[0,1] neg_hi:[0,1]
v_pk_fma_f32 v[46:47], v[40:41], s[54:55], v[46:47] op_sel:[1,1,0] op_sel_hi:[1,0,1] neg_lo:[0,0,0] neg_hi:[0,1,0]
v_pk_add_f32 v[40:41], v[48:49], v[64:65] neg_lo:[0,1] neg_hi:[0,1]
v_pk_add_f32 v[48:49], v[48:49], v[64:65]
v_pk_add_f32 v[64:65], v[50:51], v[66:67] neg_lo:[0,1] neg_hi:[0,1]
v_pk_add_f32 v[50:51], v[50:51], v[66:67]
v_pk_mul_f32 v[66:67], v[64:65], s[54:55] op_sel:[0,0] op_sel_hi:[0,1] neg_lo:[0,0] neg_hi:[0,1]
v_pk_fma_f32 v[66:67], v[64:65], s[54:55], v[66:67] op_sel:[1,1,0] op_sel_hi:[1,0,1] neg_lo:[0,0,0] neg_hi:[0,0,0]
v_pk_add_f32 v[64:65], v[52:53], v[68:69] neg_lo:[0,1] neg_hi:[0,1]
v_pk_add_f32 v[52:53], v[52:53], v[68:69]
v_pk_mul_f32 v[68:69], v[64:65], s[62:63] op_sel:[0,0] op_sel_hi:[0,1] neg_lo:[0,0] neg_hi:[0,1]
v_pk_fma_f32 v[68:69], v[64:65], s[62:63], v[68:69] op_sel:[1,1,0] op_sel_hi:[1,0,1] neg_lo:[0,0,0] neg_hi:[0,0,0]
v_pk_add_f32 v[64:65], v[54:55], v[70:71] neg_lo:[0,1] neg_hi:[0,1]
v_pk_add_f32 v[54:55], v[54:55], v[70:71]
v_pk_mul_f32 v[70:71], v[64:65], s[54:55] op_sel:[0,1] op_sel_hi:[0,0] neg_lo:[0,0] neg_hi:[0,1]
v_pk_fma_f32 v[70:71], v[64:65], s[54:55], v[70:71] op_sel:[1,0,0] op_sel_hi:[1,1,1] neg_lo:[0,0,0] neg_hi:[0,0,0]
v_pk_add_f32 v[64:65], v[56:57], v[72:73] op_sel:[1,1] op_sel_hi:[0,0] neg_lo:[0,1] neg_hi:[1,0]
v_pk_add_f32 v[56:57], v[56:57], v[72:73]
v_pk_add_f32 v[72:73], v[58:59], v[74:75] neg_lo:[0,1] neg_hi:[0,1]
v_pk_add_f32 v[58:59], v[58:59], v[74:75]
v_pk_mul_f32 v[74:75], v[72:73], s[54:55] op_sel:[0,1] op_sel_hi:[0,0] neg_lo:[0,1] neg_hi:[0,1]
v_pk_fma_f32 v[74:75], v[72:73], s[54:55], v[74:75] op_sel:[1,0,0] op_sel_hi:[1,1,1] neg_lo:[0,0,0] neg_hi:[0,1,0]
v_pk_add_f32 v[72:73], v[60:61], v[76:77] neg_lo:[0,1] neg_hi:[0,1]
v_pk_add_f32 v[60:61], v[60:61], v[76:77]
v_pk_mul_f32 v[76:77], v[72:73], s[62:63] op_sel:[0,0] op_sel_hi:[0,1] neg_lo:[0,1] neg_hi:[0,1]
v_pk_fma_f32 v[76:77], v[72:73], s[62:63], v[76:77] op_sel:[1,1,0] op_sel_hi:[1,0,1] neg_lo:[0,0,0] neg_hi:[0,1,0]
v_pk_add_f32 v[72:73], v[62:63], v[78:79] neg_lo:[0,1] neg_hi:[0,1]
v_pk_add_f32 v[62:63], v[62:63], v[78:79]
v_pk_mul_f32 v[78:79], v[72:73], s[54:55] op_sel:[0,0] op_sel_hi:[0,1] neg_lo:[0,1] neg_hi:[0,1]
v_pk_fma_f32 v[78:79], v[72:73], s[54:55], v[78:79] op_sel:[1,1,0] op_sel_hi:[1,0,1] neg_lo:[0,0,0] neg_hi:[0,1,0]
v_pk_add_f32 v[72:73], v[16:17], v[24:25] neg_lo:[0,1] neg_hi:[0,1]
v_pk_add_f32 v[16:17], v[16:17], v[24:25]
v_pk_add_f32 v[24:25], v[18:19], v[26:27] neg_lo:[0,1] neg_hi:[0,1]
v_pk_add_f32 v[18:19], v[18:19], v[26:27]
v_pk_mul_f32 v[26:27], v[24:25], s[62:63] op_sel:[0,0] op_sel_hi:[0,1] neg_lo:[0,0] neg_hi:[0,1]
v_pk_fma_f32 v[26:27], v[24:25], s[62:63], v[26:27] op_sel:[1,1,0] op_sel_hi:[1,0,1] neg_lo:[0,0,0] neg_hi:[0,0,0]
v_pk_add_f32 v[24:25], v[20:21], v[28:29] op_sel:[1,1] op_sel_hi:[0,0] neg_lo:[0,1] neg_hi:[1,0]
v_pk_add_f32 v[20:21], v[20:21], v[28:29]
v_pk_add_f32 v[28:29], v[22:23], v[30:31] neg_lo:[0,1] neg_hi:[0,1]
v_pk_add_f32 v[22:23], v[22:23], v[30:31]
v_pk_mul_f32 v[30:31], v[28:29], s[62:63] op_sel:[0,0] op_sel_hi:[0,1] neg_lo:[0,1] neg_hi:[0,1]
v_pk_fma_f32 v[30:31], v[28:29], s[62:63], v[30:31] op_sel:[1,1,0] op_sel_hi:[1,0,1] neg_lo:[0,0,0] neg_hi:[0,1,0]
v_pk_add_f32 v[28:29], v[14:15], v[32:33] neg_lo:[0,1] neg_hi:[0,1]
v_pk_add_f32 v[14:15], v[14:15], v[32:33]
v_pk_add_f32 v[32:33], v[34:35], v[42:43] neg_lo:[0,1] neg_hi:[0,1]
v_pk_add_f32 v[34:35], v[34:35], v[42:43]
v_pk_mul_f32 v[42:43], v[32:33], s[62:63] op_sel:[0,0] op_sel_hi:[0,1] neg_lo:[0,0] neg_hi:[0,1]
v_pk_fma_f32 v[42:43], v[32:33], s[62:63], v[42:43] op_sel:[1,1,0] op_sel_hi:[1,0,1] neg_lo:[0,0,0] neg_hi:[0,0,0]
v_pk_add_f32 v[32:33], v[36:37], v[44:45] op_sel:[1,1] op_sel_hi:[0,0] neg_lo:[0,1] neg_hi:[1,0]
v_pk_add_f32 v[36:37], v[36:37], v[44:45]
v_pk_add_f32 v[44:45], v[38:39], v[46:47] neg_lo:[0,1] neg_hi:[0,1]
v_pk_add_f32 v[38:39], v[38:39], v[46:47]
v_pk_mul_f32 v[46:47], v[44:45], s[62:63] op_sel:[0,0] op_sel_hi:[0,1] neg_lo:[0,1] neg_hi:[0,1]
v_pk_fma_f32 v[46:47], v[44:45], s[62:63], v[46:47] op_sel:[1,1,0] op_sel_hi:[1,0,1] neg_lo:[0,0,0] neg_hi:[0,1,0]
v_pk_add_f32 v[44:45], v[48:49], v[56:57] neg_lo:[0,1] neg_hi:[0,1]
v_pk_add_f32 v[48:49], v[48:49], v[56:57]
v_pk_add_f32 v[56:57], v[50:51], v[58:59] neg_lo:[0,1] neg_hi:[0,1]
v_pk_add_f32 v[50:51], v[50:51], v[58:59]
v_pk_mul_f32 v[58:59], v[56:57], s[62:63] op_sel:[0,0] op_sel_hi:[0,1] neg_lo:[0,0] neg_hi:[0,1]
v_pk_fma_f32 v[58:59], v[56:57], s[62:63], v[58:59] op_sel:[1,1,0] op_sel_hi:[1,0,1] neg_lo:[0,0,0] neg_hi:[0,0,0]
v_pk_add_f32 v[56:57], v[52:53], v[60:61] op_sel:[1,1] op_sel_hi:[0,0] neg_lo:[0,1] neg_hi:[1,0]
v_pk_add_f32 v[52:53], v[52:53], v[60:61]
v_pk_add_f32 v[60:61], v[54:55], v[62:63] neg_lo:[0,1] neg_hi:[0,1]
v_pk_add_f32 v[54:55], v[54:55], v[62:63]
v_pk_mul_f32 v[62:63], v[60:61], s[62:63] op_sel:[0,0] op_sel_hi:[0,1] neg_lo:[0,1] neg_hi:[0,1]
v_pk_fma_f32 v[62:63], v[60:61], s[62:63], v[62:63] op_sel:[1,1,0] op_sel_hi:[1,0,1] neg_lo:[0,0,0] neg_hi:[0,1,0]
v_pk_add_f32 v[60:61], v[40:41], v[64:65] neg_lo:[0,1] neg_hi:[0,1]
v_pk_add_f32 v[40:41], v[40:41], v[64:65]
v_pk_add_f32 v[64:65], v[66:67], v[74:75] neg_lo:[0,1] neg_hi:[0,1]
v_pk_add_f32 v[66:67], v[66:67], v[74:75]
v_pk_mul_f32 v[74:75], v[64:65], s[62:63] op_sel:[0,0] op_sel_hi:[0,1] neg_lo:[0,0] neg_hi:[0,1]
v_pk_fma_f32 v[74:75], v[64:65], s[62:63], v[74:75] op_sel:[1,1,0] op_sel_hi:[1,0,1] neg_lo:[0,0,0] neg_hi:[0,0,0]
v_pk_add_f32 v[64:65], v[68:69], v[76:77] op_sel:[1,1] op_sel_hi:[0,0] neg_lo:[0,1] neg_hi:[1,0]
v_pk_add_f32 v[68:69], v[68:69], v[76:77]
v_pk_add_f32 v[76:77], v[70:71], v[78:79] neg_lo:[0,1] neg_hi:[0,1]
v_pk_add_f32 v[70:71], v[70:71], v[78:79]
v_pk_mul_f32 v[78:79], v[76:77], s[62:63] op_sel:[0,0] op_sel_hi:[0,1] neg_lo:[0,1] neg_hi:[0,1]
v_pk_fma_f32 v[78:79], v[76:77], s[62:63], v[78:79] op_sel:[1,1,0] op_sel_hi:[1,0,1] neg_lo:[0,0,0] neg_hi:[0,1,0]
v_pk_add_f32 v[76:77], v[16:17], v[20:21] neg_lo:[0,1] neg_hi:[0,1]
v_pk_add_f32 v[16:17], v[16:17], v[20:21]
v_pk_add_f32 v[20:21], v[18:19], v[22:23] op_sel:[1,1] op_sel_hi:[0,0] neg_lo:[0,1] neg_hi:[1,0]
v_pk_add_f32 v[18:19], v[18:19], v[22:23]
v_pk_add_f32 v[22:23], v[72:73], v[24:25] neg_lo:[0,1] neg_hi:[0,1]
v_pk_add_f32 v[72:73], v[72:73], v[24:25]
v_pk_add_f32 v[24:25], v[26:27], v[30:31] op_sel:[1,1] op_sel_hi:[0,0] neg_lo:[0,1] neg_hi:[1,0]
v_pk_add_f32 v[26:27], v[26:27], v[30:31]
v_pk_add_f32 v[30:31], v[14:15], v[36:37] neg_lo:[0,1] neg_hi:[0,1]
v_pk_add_f32 v[14:15], v[14:15], v[36:37]
v_pk_add_f32 v[36:37], v[34:35], v[38:39] op_sel:[1,1] op_sel_hi:[0,0] neg_lo:[0,1] neg_hi:[1,0]
v_pk_add_f32 v[34:35], v[34:35], v[38:39]
v_pk_add_f32 v[38:39], v[28:29], v[32:33] neg_lo:[0,1] neg_hi:[0,1]
v_pk_add_f32 v[28:29], v[28:29], v[32:33]
v_pk_add_f32 v[32:33], v[42:43], v[46:47] op_sel:[1,1] op_sel_hi:[0,0] neg_lo:[0,1] neg_hi:[1,0]
v_pk_add_f32 v[42:43], v[42:43], v[46:47]
v_pk_add_f32 v[46:47], v[48:49], v[52:53] neg_lo:[0,1] neg_hi:[0,1]
v_pk_add_f32 v[48:49], v[48:49], v[52:53]
v_pk_add_f32 v[52:53], v[50:51], v[54:55] op_sel:[1,1] op_sel_hi:[0,0] neg_lo:[0,1] neg_hi:[1,0]
v_pk_add_f32 v[50:51], v[50:51], v[54:55]
v_pk_add_f32 v[54:55], v[44:45], v[56:57] neg_lo:[0,1] neg_hi:[0,1]
v_pk_add_f32 v[44:45], v[44:45], v[56:57]
v_pk_add_f32 v[56:57], v[58:59], v[62:63] op_sel:[1,1] op_sel_hi:[0,0] neg_lo:[0,1] neg_hi:[1,0]
v_pk_add_f32 v[58:59], v[58:59], v[62:63]
v_pk_add_f32 v[62:63], v[40:41], v[68:69] neg_lo:[0,1] neg_hi:[0,1]
v_pk_add_f32 v[40:41], v[40:41], v[68:69]
v_pk_add_f32 v[68:69], v[66:67], v[70:71] op_sel:[1,1] op_sel_hi:[0,0] neg_lo:[0,1] neg_hi:[1,0]
v_pk_add_f32 v[66:67], v[66:67], v[70:71]
v_pk_add_f32 v[70:71], v[60:61], v[64:65] neg_lo:[0,1] neg_hi:[0,1]
v_pk_add_f32 v[60:61], v[60:61], v[64:65]
v_pk_add_f32 v[64:65], v[74:75], v[78:79] op_sel:[1,1] op_sel_hi:[0,0] neg_lo:[0,1] neg_hi:[1,0]
v_pk_add_f32 v[74:75], v[74:75], v[78:79]
v_pk_add_f32 v[78:79], v[16:17], v[18:19] neg_lo:[0,1] neg_hi:[0,1]
v_pk_add_f32 v[16:17], v[16:17], v[18:19]
v_pk_add_f32 v[18:19], v[76:77], v[20:21] neg_lo:[0,1] neg_hi:[0,1]
v_pk_add_f32 v[76:77], v[76:77], v[20:21]
v_pk_add_f32 v[20:21], v[72:73], v[26:27] neg_lo:[0,1] neg_hi:[0,1]
v_pk_add_f32 v[72:73], v[72:73], v[26:27]
v_pk_add_f32 v[26:27], v[22:23], v[24:25] neg_lo:[0,1] neg_hi:[0,1]
v_pk_add_f32 v[22:23], v[22:23], v[24:25]
v_pk_add_f32 v[24:25], v[14:15], v[34:35] neg_lo:[0,1] neg_hi:[0,1]
v_pk_add_f32 v[14:15], v[14:15], v[34:35]
v_pk_add_f32 v[34:35], v[30:31], v[36:37] neg_lo:[0,1] neg_hi:[0,1]
v_pk_add_f32 v[30:31], v[30:31], v[36:37]
v_pk_add_f32 v[36:37], v[28:29], v[42:43] neg_lo:[0,1] neg_hi:[0,1]
v_pk_add_f32 v[28:29], v[28:29], v[42:43]
v_pk_add_f32 v[42:43], v[38:39], v[32:33] neg_lo:[0,1] neg_hi:[0,1]
v_pk_add_f32 v[38:39], v[38:39], v[32:33]
v_pk_add_f32 v[32:33], v[48:49], v[50:51] neg_lo:[0,1] neg_hi:[0,1]
v_pk_add_f32 v[48:49], v[48:49], v[50:51]
v_pk_add_f32 v[50:51], v[46:47], v[52:53] neg_lo:[0,1] neg_hi:[0,1]
v_pk_add_f32 v[46:47], v[46:47], v[52:53]
v_pk_add_f32 v[52:53], v[44:45], v[58:59] neg_lo:[0,1] neg_hi:[0,1]
v_pk_add_f32 v[44:45], v[44:45], v[58:59]
v_pk_add_f32 v[58:59], v[54:55], v[56:57] neg_lo:[0,1] neg_hi:[0,1]
v_pk_add_f32 v[54:55], v[54:55], v[56:57]
v_pk_add_f32 v[56:57], v[40:41], v[66:67] neg_lo:[0,1] neg_hi:[0,1]
v_pk_add_f32 v[40:41], v[40:41], v[66:67]
v_pk_add_f32 v[66:67], v[62:63], v[68:69] neg_lo:[0,1] neg_hi:[0,1]
v_pk_add_f32 v[62:63], v[62:63], v[68:69]
v_pk_add_f32 v[68:69], v[60:61], v[74:75] neg_lo:[0,1] neg_hi:[0,1]
v_pk_add_f32 v[60:61], v[60:61], v[74:75]
v_pk_add_f32 v[74:75], v[70:71], v[64:65] neg_lo:[0,1] neg_hi:[0,1]
v_pk_add_f32 v[70:71], v[70:71], v[64:65]
v_pk_mul_f32 v[64:65], v[48:49], v[82:83] op_sel:[0,0] op_sel_hi:[0,1] neg_lo:[0,0] neg_hi:[0,0]
v_pk_fma_f32 v[48:49], v[48:49], v[82:83], v[64:65] op_sel:[1,1,0] op_sel_hi:[1,0,1] neg_lo:[0,1,0] neg_hi:[0,0,0]
v_pk_mul_f32 v[64:65], v[14:15], v[84:85] op_sel:[0,0] op_sel_hi:[0,1] neg_lo:[0,0] neg_hi:[0,0]
v_pk_fma_f32 v[14:15], v[14:15], v[84:85], v[64:65] op_sel:[1,1,0] op_sel_hi:[1,0,1] neg_lo:[0,1,0] neg_hi:[0,0,0]
v_pk_mul_f32 v[64:65], v[40:41], v[86:87] op_sel:[0,0] op_sel_hi:[0,1] neg_lo:[0,0] neg_hi:[0,0]
v_pk_fma_f32 v[40:41], v[40:41], v[86:87], v[64:65] op_sel:[1,1,0] op_sel_hi:[1,0,1] neg_lo:[0,1,0] neg_hi:[0,0,0]
v_pk_mul_f32 v[64:65], v[72:73], v[88:89] op_sel:[0,0] op_sel_hi:[0,1] neg_lo:[0,0] neg_hi:[0,0]
v_pk_fma_f32 v[72:73], v[72:73], v[88:89], v[64:65] op_sel:[1,1,0] op_sel_hi:[1,0,1] neg_lo:[0,1,0] neg_hi:[0,0,0]
v_pk_mul_f32 v[64:65], v[44:45], v[90:91] op_sel:[0,0] op_sel_hi:[0,1] neg_lo:[0,0] neg_hi:[0,0]
v_pk_fma_f32 v[44:45], v[44:45], v[90:91], v[64:65] op_sel:[1,1,0] op_sel_hi:[1,0,1] neg_lo:[0,1,0] neg_hi:[0,0,0]
v_pk_mul_f32 v[64:65], v[28:29], v[92:93] op_sel:[0,0] op_sel_hi:[0,1] neg_lo:[0,0] neg_hi:[0,0]
v_pk_fma_f32 v[28:29], v[28:29], v[92:93], v[64:65] op_sel:[1,1,0] op_sel_hi:[1,0,1] neg_lo:[0,1,0] neg_hi:[0,0,0]
v_pk_mul_f32 v[64:65], v[60:61], v[94:95] op_sel:[0,0] op_sel_hi:[0,1] neg_lo:[0,0] neg_hi:[0,0]
v_pk_fma_f32 v[60:61], v[60:61], v[94:95], v[64:65] op_sel:[1,1,0] op_sel_hi:[1,0,1] neg_lo:[0,1,0] neg_hi:[0,0,0]
v_pk_mul_f32 v[64:65], v[76:77], v[96:97] op_sel:[0,0] op_sel_hi:[0,1] neg_lo:[0,0] neg_hi:[0,0]
v_pk_fma_f32 v[76:77], v[76:77], v[96:97], v[64:65] op_sel:[1,1,0] op_sel_hi:[1,0,1] neg_lo:[0,1,0] neg_hi:[0,0,0]
v_pk_mul_f32 v[64:65], v[46:47], v[98:99] op_sel:[0,0] op_sel_hi:[0,1] neg_lo:[0,0] neg_hi:[0,0]
v_pk_fma_f32 v[46:47], v[46:47], v[98:99], v[64:65] op_sel:[1,1,0] op_sel_hi:[1,0,1] neg_lo:[0,1,0] neg_hi:[0,0,0]
v_pk_mul_f32 v[64:65], v[30:31], v[100:101] op_sel:[0,0] op_sel_hi:[0,1] neg_lo:[0,0] neg_hi:[0,0]
v_pk_fma_f32 v[30:31], v[30:31], v[100:101], v[64:65] op_sel:[1,1,0] op_sel_hi:[1,0,1] neg_lo:[0,1,0] neg_hi:[0,0,0]
v_pk_mul_f32 v[64:65], v[62:63], v[102:103] op_sel:[0,0] op_sel_hi:[0,1] neg_lo:[0,0] neg_hi:[0,0]
v_pk_fma_f32 v[62:63], v[62:63], v[102:103], v[64:65] op_sel:[1,1,0] op_sel_hi:[1,0,1] neg_lo:[0,1,0] neg_hi:[0,0,0]
v_pk_mul_f32 v[64:65], v[22:23], v[104:105] op_sel:[0,0] op_sel_hi:[0,1] neg_lo:[0,0] neg_hi:[0,0]
v_pk_fma_f32 v[22:23], v[22:23], v[104:105], v[64:65] op_sel:[1,1,0] op_sel_hi:[1,0,1] neg_lo:[0,1,0] neg_hi:[0,0,0]
v_pk_mul_f32 v[64:65], v[54:55], v[106:107] op_sel:[0,0] op_sel_hi:[0,1] neg_lo:[0,0] neg_hi:[0,0]
v_pk_fma_f32 v[54:55], v[54:55], v[106:107], v[64:65] op_sel:[1,1,0] op_sel_hi:[1,0,1] neg_lo:[0,1,0] neg_hi:[0,0,0]
v_pk_mul_f32 v[64:65], v[38:39], v[108:109] op_sel:[0,0] op_sel_hi:[0,1] neg_lo:[0,0] neg_hi:[0,0]
v_pk_fma_f32 v[38:39], v[38:39], v[108:109], v[64:65] op_sel:[1,1,0] op_sel_hi:[1,0,1] neg_lo:[0,1,0] neg_hi:[0,0,0]
v_pk_mul_f32 v[64:65], v[70:71], v[110:111] op_sel:[0,0] op_sel_hi:[0,1] neg_lo:[0,0] neg_hi:[0,0]
v_pk_fma_f32 v[70:71], v[70:71], v[110:111], v[64:65] op_sel:[1,1,0] op_sel_hi:[1,0,1] neg_lo:[0,1,0] neg_hi:[0,0,0]
v_pk_mul_f32 v[64:65], v[78:79], v[112:113] op_sel:[0,0] op_sel_hi:[0,1] neg_lo:[0,0] neg_hi:[0,0]
v_pk_fma_f32 v[78:79], v[78:79], v[112:113], v[64:65] op_sel:[1,1,0] op_sel_hi:[1,0,1] neg_lo:[0,1,0] neg_hi:[0,0,0]
v_pk_mul_f32 v[64:65], v[32:33], v[114:115] op_sel:[0,0] op_sel_hi:[0,1] neg_lo:[0,0] neg_hi:[0,0]
v_pk_fma_f32 v[32:33], v[32:33], v[114:115], v[64:65] op_sel:[1,1,0] op_sel_hi:[1,0,1] neg_lo:[0,1,0] neg_hi:[0,0,0]
v_pk_mul_f32 v[64:65], v[24:25], v[116:117] op_sel:[0,0] op_sel_hi:[0,1] neg_lo:[0,0] neg_hi:[0,0]
v_pk_fma_f32 v[24:25], v[24:25], v[116:117], v[64:65] op_sel:[1,1,0] op_sel_hi:[1,0,1] neg_lo:[0,1,0] neg_hi:[0,0,0]
v_pk_mul_f32 v[64:65], v[56:57], v[118:119] op_sel:[0,0] op_sel_hi:[0,1] neg_lo:[0,0] neg_hi:[0,0]
v_pk_fma_f32 v[56:57], v[56:57], v[118:119], v[64:65] op_sel:[1,1,0] op_sel_hi:[1,0,1] neg_lo:[0,1,0] neg_hi:[0,0,0]
v_pk_mul_f32 v[64:65], v[20:21], v[120:121] op_sel:[0,0] op_sel_hi:[0,1] neg_lo:[0,0] neg_hi:[0,0]
v_pk_fma_f32 v[20:21], v[20:21], v[120:121], v[64:65] op_sel:[1,1,0] op_sel_hi:[1,0,1] neg_lo:[0,1,0] neg_hi:[0,0,0]
v_pk_mul_f32 v[64:65], v[52:53], v[122:123] op_sel:[0,0] op_sel_hi:[0,1] neg_lo:[0,0] neg_hi:[0,0]
v_pk_fma_f32 v[52:53], v[52:53], v[122:123], v[64:65] op_sel:[1,1,0] op_sel_hi:[1,0,1] neg_lo:[0,1,0] neg_hi:[0,0,0]
v_pk_mul_f32 v[64:65], v[36:37], v[124:125] op_sel:[0,0] op_sel_hi:[0,1] neg_lo:[0,0] neg_hi:[0,0]
v_pk_fma_f32 v[36:37], v[36:37], v[124:125], v[64:65] op_sel:[1,1,0] op_sel_hi:[1,0,1] neg_lo:[0,1,0] neg_hi:[0,0,0]
v_pk_mul_f32 v[64:65], v[68:69], v[126:127] op_sel:[0,0] op_sel_hi:[0,1] neg_lo:[0,0] neg_hi:[0,0]
v_pk_fma_f32 v[68:69], v[68:69], v[126:127], v[64:65] op_sel:[1,1,0] op_sel_hi:[1,0,1] neg_lo:[0,1,0] neg_hi:[0,0,0]
v_pk_mul_f32 v[64:65], v[18:19], v[128:129] op_sel:[0,0] op_sel_hi:[0,1] neg_lo:[0,0] neg_hi:[0,0]
v_pk_fma_f32 v[18:19], v[18:19], v[128:129], v[64:65] op_sel:[1,1,0] op_sel_hi:[1,0,1] neg_lo:[0,1,0] neg_hi:[0,0,0]
v_pk_mul_f32 v[64:65], v[50:51], v[130:131] op_sel:[0,0] op_sel_hi:[0,1] neg_lo:[0,0] neg_hi:[0,0]
v_pk_fma_f32 v[50:51], v[50:51], v[130:131], v[64:65] op_sel:[1,1,0] op_sel_hi:[1,0,1] neg_lo:[0,1,0] neg_hi:[0,0,0]
v_pk_mul_f32 v[64:65], v[34:35], v[132:133] op_sel:[0,0] op_sel_hi:[0,1] neg_lo:[0,0] neg_hi:[0,0]
v_pk_fma_f32 v[34:35], v[34:35], v[132:133], v[64:65] op_sel:[1,1,0] op_sel_hi:[1,0,1] neg_lo:[0,1,0] neg_hi:[0,0,0]
v_pk_mul_f32 v[64:65], v[66:67], v[134:135] op_sel:[0,0] op_sel_hi:[0,1] neg_lo:[0,0] neg_hi:[0,0]
v_pk_fma_f32 v[66:67], v[66:67], v[134:135], v[64:65] op_sel:[1,1,0] op_sel_hi:[1,0,1] neg_lo:[0,1,0] neg_hi:[0,0,0]
v_pk_mul_f32 v[64:65], v[26:27], v[136:137] op_sel:[0,0] op_sel_hi:[0,1] neg_lo:[0,0] neg_hi:[0,0]
v_pk_fma_f32 v[26:27], v[26:27], v[136:137], v[64:65] op_sel:[1,1,0] op_sel_hi:[1,0,1] neg_lo:[0,1,0] neg_hi:[0,0,0]
v_pk_mul_f32 v[64:65], v[58:59], v[138:139] op_sel:[0,0] op_sel_hi:[0,1] neg_lo:[0,0] neg_hi:[0,0]
v_pk_fma_f32 v[58:59], v[58:59], v[138:139], v[64:65] op_sel:[1,1,0] op_sel_hi:[1,0,1] neg_lo:[0,1,0] neg_hi:[0,0,0]
v_pk_mul_f32 v[64:65], v[42:43], v[140:141] op_sel:[0,0] op_sel_hi:[0,1] neg_lo:[0,0] neg_hi:[0,0]
v_pk_fma_f32 v[42:43], v[42:43], v[140:141], v[64:65] op_sel:[1,1,0] op_sel_hi:[1,0,1] neg_lo:[0,1,0] neg_hi:[0,0,0]
v_pk_mul_f32 v[64:65], v[74:75], v[142:143] op_sel:[0,0] op_sel_hi:[0,1] neg_lo:[0,0] neg_hi:[0,0]
v_pk_fma_f32 v[74:75], v[74:75], v[142:143], v[64:65] op_sel:[1,1,0] op_sel_hi:[1,0,1] neg_lo:[0,1,0] neg_hi:[0,0,0]
s_barrier
ds_write_b64 v4, v[16:17] offset:0
ds_write_b64 v4, v[48:49] offset:264
ds_write_b64 v4, v[14:15] offset:528
ds_write_b64 v4, v[40:41] offset:792
ds_write_b64 v4, v[72:73] offset:1056
ds_write_b64 v4, v[44:45] offset:1320
ds_write_b64 v4, v[28:29] offset:1584
ds_write_b64 v4, v[60:61] offset:1848
ds_write_b64 v4, v[76:77] offset:2112
ds_write_b64 v4, v[46:47] offset:2376
ds_write_b64 v4, v[30:31] offset:2640
ds_write_b64 v4, v[62:63] offset:2904
ds_write_b64 v4, v[22:23] offset:3168
ds_write_b64 v4, v[54:55] offset:3432
ds_write_b64 v4, v[38:39] offset:3696
ds_write_b64 v4, v[70:71] offset:3960
ds_write_b64 v4, v[78:79] offset:4224
ds_write_b64 v4, v[32:33] offset:4488
ds_write_b64 v4, v[24:25] offset:4752
ds_write_b64 v4, v[56:57] offset:5016
ds_write_b64 v4, v[20:21] offset:5280
ds_write_b64 v4, v[52:53] offset:5544
ds_write_b64 v4, v[36:37] offset:5808
ds_write_b64 v4, v[68:69] offset:6072
ds_write_b64 v4, v[18:19] offset:6336
ds_write_b64 v4, v[50:51] offset:6600
ds_write_b64 v4, v[34:35] offset:6864
ds_write_b64 v4, v[66:67] offset:7128
ds_write_b64 v4, v[26:27] offset:7392
ds_write_b64 v4, v[58:59] offset:7656
ds_write_b64 v4, v[42:43] offset:7920
ds_write_b64 v4, v[74:75] offset:8184
s_waitcnt lgkmcnt(0)
ds_read_b64 v[16:17], v5 offset:0
ds_read_b64 v[48:49], v5 offset:128
ds_read_b64 v[18:19], v5 offset:8
ds_read_b64 v[50:51], v5 offset:136
ds_read_b64 v[20:21], v5 offset:16
ds_read_b64 v[52:53], v5 offset:144
ds_read_b64 v[22:23], v5 offset:24
ds_read_b64 v[54:55], v5 offset:152
ds_read_b64 v[24:25], v5 offset:32
ds_read_b64 v[56:57], v5 offset:160
ds_read_b64 v[26:27], v5 offset:40
ds_read_b64 v[58:59], v5 offset:168
ds_read_b64 v[28:29], v5 offset:48
ds_read_b64 v[60:61], v5 offset:176
ds_read_b64 v[30:31], v5 offset:56
ds_read_b64 v[62:63], v5 offset:184
ds_read_b64 v[32:33], v5 offset:64
ds_read_b64 v[64:65], v5 offset:192
ds_read_b64 v[34:35], v5 offset:72
ds_read_b64 v[66:67], v5 offset:200
ds_read_b64 v[36:37], v5 offset:80
ds_read_b64 v[68:69], v5 offset:208
ds_read_b64 v[38:39], v5 offset:88
ds_read_b64 v[70:71], v5 offset:216
ds_read_b64 v[40:41], v5 offset:96
ds_read_b64 v[72:73], v5 offset:224
ds_read_b64 v[42:43], v5 offset:104
ds_read_b64 v[74:75], v5 offset:232
ds_read_b64 v[44:45], v5 offset:112
ds_read_b64 v[76:77], v5 offset:240
ds_read_b64 v[46:47], v5 offset:120
ds_read_b64 v[78:79], v5 offset:248
s_waitcnt lgkmcnt(0)
v_pk_add_f32 v[14:15], v[16:17], v[48:49] neg_lo:[0,1] neg_hi:[0,1]
v_pk_add_f32 v[16:17], v[16:17], v[48:49]
v_pk_add_f32 v[48:49], v[18:19], v[50:51] neg_lo:[0,1] neg_hi:[0,1]
v_pk_add_f32 v[18:19], v[18:19], v[50:51]
v_pk_mul_f32 v[50:51], v[48:49], s[50:51] op_sel:[0,0] op_sel_hi:[0,1] neg_lo:[0,0] neg_hi:[0,1]
v_pk_fma_f32 v[50:51], v[48:49], s[50:51], v[50:51] op_sel:[1,1,0] op_sel_hi:[1,0,1] neg_lo:[0,0,0] neg_hi:[0,0,0]
v_pk_add_f32 v[48:49], v[20:21], v[52:53] neg_lo:[0,1] neg_hi:[0,1]
v_pk_add_f32 v[20:21], v[20:21], v[52:53]
v_pk_mul_f32 v[52:53], v[48:49], s[54:55] op_sel:[0,0] op_sel_hi:[0,1] neg_lo:[0,0] neg_hi:[0,1]
v_pk_fma_f32 v[52:53], v[48:49], s[54:55], v[52:53] op_sel:[1,1,0] op_sel_hi:[1,0,1] neg_lo:[0,0,0] neg_hi:[0,0,0]
v_pk_add_f32 v[48:49], v[22:23], v[54:55] neg_lo:[0,1] neg_hi:[0,1]
v_pk_add_f32 v[22:23], v[22:23], v[54:55]
v_pk_mul_f32 v[54:55], v[48:49], s[58:59] op_sel:[0,0] op_sel_hi:[0,1] neg_lo:[0,0] neg_hi:[0,1]
v_pk_fma_f32 v[54:55], v[48:49], s[58:59], v[54:55] op_sel:[1,1,0] op_sel_hi:[1,0,1] neg_lo:[0,0,0] neg_hi:[0,0,0]
v_pk_add_f32 v[48:49], v[24:25], v[56:57] neg_lo:[0,1] neg_hi:[0,1]
v_pk_add_f32 v[24:25], v[24:25], v[56:57]
v_pk_mul_f32 v[56:57], v[48:49], s[62:63] op_sel:[0,0] op_sel_hi:[0,1] neg_lo:[0,0] neg_hi:[0,1]
v_pk_fma_f32 v[56:57], v[48:49], s[62:63], v[56:57] op_sel:[1,1,0] op_sel_hi:[1,0,1] neg_lo:[0,0,0] neg_hi:[0,0,0]
v_pk_add_f32 v[48:49], v[26:27], v[58:59] neg_lo:[0,1] neg_hi:[0,1]
v_pk_add_f32 v[26:27], v[26:27], v[58:59]
v_pk_mul_f32 v[58:59], v[48:49], s[58:59] op_sel:[0,1] op_sel_hi:[0,0] neg_lo:[0,0] neg_hi:[0,1]
v_pk_fma_f32 v[58:59], v[48:49], s[58:59], v[58:59] op_sel:[1,0,0] op_sel_hi:[1,1,1] neg_lo:[0,0,0] neg_hi:[0,0,0]
v_pk_add_f32 v[48:49], v[28:29], v[60:61] neg_lo:[0,1] neg_hi:[0,1]
v_pk_add_f32 v[28:29], v[28:29], v[60:61]
v_pk_mul_f32 v[60:61], v[48:49], s[54:55] op_sel:[0,1] op_sel_hi:[0,0] neg_lo:[0,0] neg_hi:[0,1]
v_pk_fma_f32 v[60:61], v[48:49], s[54:55], v[60:61] op_sel:[1,0,0] op_sel_hi:[1,1,1] neg_lo:[0,0,0] neg_hi:[0,0,0]
v_pk_add_f32 v[48:49], v[30:31], v[62:63] neg_lo:[0,1] neg_hi:[0,1]
v_pk_add_f32 v[30:31], v[30:31], v[62:63]
v_pk_mul_f32 v[62:63], v[48:49], s[50:51] op_sel:[0,1] op_sel_hi:[0,0] neg_lo:[0,0] neg_hi:[0,1]
v_pk_fma_f32 v[62:63], v[48:49], s[50:51], v[62:63] op_sel:[1,0,0] op_sel_hi:[1,1,1] neg_lo:[0,0,0] neg_hi:[0,0,0]
v_pk_add_f32 v[48:49], v[32:33], v[64:65] op_sel:[1,1] op_sel_hi:[0,0] neg_lo:[0,1] neg_hi:[1,0]
v_pk_add_f32 v[32:33], v[32:33], v[64:65]
v_pk_add_f32 v[64:65], v[34:35], v[66:67] neg_lo:[0,1] neg_hi:[0,1]
v_pk_add_f32 v[34:35], v[34:35], v[66:67]
v_pk_mul_f32 v[66:67], v[64:65], s[50:51] op_sel:[0,1] op_sel_hi:[0,0] neg_lo:[0,1] neg_hi:[0,1]
v_pk_fma_f32 v[66:67], v[64:65], s[50:51], v[66:67] op_sel:[1,0,0] op_sel_hi:[1,1,1] neg_lo:[0,0,0] neg_hi:[0,1,0]
v_pk_add_f32 v[64:65], v[36:37], v[68:69] neg_lo:[0,1] neg_hi:[0,1]
v_pk_add_f32 v[36:37], v[36:37], v[68:69]
v_pk_mul_f32 v[68:69], v[64:65], s[54:55] op_sel:[0,1] op_sel_hi:[0,0] neg_lo:[0,1] neg_hi:[0,1]
v_pk_fma_f32 v[68:69], v[64:65], s[54:55], v[68:69] op_sel:[1,0,0] op_sel_hi:[1,1,1] neg_lo:[0,0,0] neg_hi:[0,1,0]
v_pk_add_f32 v[64:65], v[38:39], v[70:71] neg_lo:[0,1] neg_hi:[0,1]
v_pk_add_f32 v[38:39], v[38:39], v[70:71]
v_pk_mul_f32 v[70:71], v[64:65], s[58:59] op_sel:[0,1] op_sel_hi:[0,0] neg_lo:[0,1] neg_hi:[0,1]
v_pk_fma_f32 v[70:71], v[64:65], s[58:59], v[70:71] op_sel:[1,0,0] op_sel_hi:[1,1,1] neg_lo:[0,0,0] neg_hi:[0,1,0]
v_pk_add_f32 v[64:65], v[40:41], v[72:73] neg_lo:[0,1] neg_hi:[0,1]
v_pk_add_f32 v[40:41], v[40:41], v[72:73]
v_pk_mul_f32 v[72:73], v[64:65], s[62:63] op_sel:[0,0] op_sel_hi:[0,1] neg_lo:[0,1] neg_hi:[0,1]
v_pk_fma_f32 v[72:73], v[64:65], s[62:63], v[72:73] op_sel:[1,1,0] op_sel_hi:[1,0,1] neg_lo:[0,0,0] neg_hi:[0,1,0]
v_pk_add_f32 v[64:65], v[42:43], v[74:75] neg_lo:[0,1] neg_hi:[0,1]
v_pk_add_f32 v[42:43], v[42:43], v[74:75]
v_pk_mul_f32 v[74:75], v[64:65], s[58:59] op_sel:[0,0] op_sel_hi:[0,1] neg_lo:[0,1] neg_hi:[0,1]
v_pk_fma_f32 v[74:75], v[64:65], s[58:59], v[74:75] op_sel:[1,1,0] op_sel_hi:[1,0,1] neg_lo:[0,0,0] neg_hi:[0,1,0]
v_pk_add_f32 v[64:65], v[44:45], v[76:77] neg_lo:[0,1] neg_hi:[0,1]
v_pk_add_f32 v[44:45], v[44:45], v[76:77]
v_pk_mul_f32 v[76:77], v[64:65], s[54:55] op_sel:[0,0] op_sel_hi:[0,1] neg_lo:[0,1] neg_hi:[0,1]
v_pk_fma_f32 v[76:77], v[64:65], s[54:55], v[76:77] op_sel:[1,1,0] op_sel_hi:[1,0,1] neg_lo:[0,0,0] neg_hi:[0,1,0]
v_pk_add_f32 v[64:65], v[46:47], v[78:79] neg_lo:[0,1] neg_hi:[0,1]
v_pk_add_f32 v[46:47], v[46:47], v[78:79]
v_pk_mul_f32 v[78:79], v[64:65], s[50:51] op_sel:[0,0] op_sel_hi:[0,1] neg_lo:[0,1] neg_hi:[0,1]
v_pk_fma_f32 v[78:79], v[64:65], s[50:51], v[78:79] op_sel:[1,1,0] op_sel_hi:[1,0,1] neg_lo:[0,0,0] neg_hi:[0,1,0]
v_pk_add_f32 v[64:65], v[16:17], v[32:33] neg_lo:[0,1] neg_hi:[0,1]
v_pk_add_f32 v[16:17], v[16:17], v[32:33]
v_pk_add_f32 v[32:33], v[18:19], v[34:35] neg_lo:[0,1] neg_hi:[0,1]
v_pk_add_f32 v[18:19], v[18:19], v[34:35]
v_pk_mul_f32 v[34:35], v[32:33], s[54:55] op_sel:[0,0] op_sel_hi:[0,1] neg_lo:[0,0] neg_hi:[0,1]
v_pk_fma_f32 v[34:35], v[32:33], s[54:55], v[34:35] op_sel:[1,1,0] op_sel_hi:[1,0,1] neg_lo:[0,0,0] neg_hi:[0,0,0]
v_pk_add_f32 v[32:33], v[20:21], v[36:37] neg_lo:[0,1] neg_hi:[0,1]
v_pk_add_f32 v[20:21], v[20:21], v[36:37]
v_pk_mul_f32 v[36:37], v[32:33], s[62:63] op_sel:[0,0] op_sel_hi:[0,1] neg_lo:[0,0] neg_hi:[0,1]
v_pk_fma_f32 v[36:37], v[32:33], s[62:63], v[36:37] op_sel:[1,1,0] op_sel_hi:[1,0,1] neg_lo:[0,0,0] neg_hi:[0,0,0]
v_pk_add_f32 v[32:33], v[22:23], v[38:39] neg_lo:[0,1] neg_hi:[0,1]
v_pk_add_f32 v[22:23], v[22:23], v[38:39]
v_pk_mul_f32 v[38:39], v[32:33], s[54:55] op_sel:[0,1] op_sel_hi:[0,0] neg_lo:[0,0] neg_hi:[0,1]
v_pk_fma_f32 v[38:39], v[32:33], s[54:55], v[38:39] op_sel:[1,0,0] op_sel_hi:[1,1,1] neg_lo:[0,0,0] neg_hi:[0,0,0]
v_pk_add_f32 v[32:33], v[24:25], v[40:41] op_sel:[1,1] op_sel_hi:[0,0] neg_lo:[0,1] neg_hi:[1,0]
v_pk_add_f32 v[24:25], v[24:25], v[40:41]
v_pk_add_f32 v[40:41], v[26:27], v[42:43] neg_lo:[0,1] neg_hi:[0,1]
v_pk_add_f32 v[26:27], v[26:27], v[42:43]
v_pk_mul_f32 v[42:43], v[40:41], s[54:55] op_sel:[0,1] op_sel_hi:[0,0] neg_lo:[0,1] neg_hi:[0,1]
v_pk_fma_f32 v[42:43], v[40:41], s[54:55], v[42:43] op_sel:[1,0,0] op_sel_hi:[1,1,1] neg_lo:[0,0,0] neg_hi:[0,1,0]
v_pk_add_f32 v[40:41], v[28:29], v[44:45] neg_lo:[0,1] neg_hi:[0,1]
v_pk_add_f32 v[28:29], v[28:29], v[44:45]
v_pk_mul_f32 v[44:45], v[40:41], s[62:63] op_sel:[0,0] op_sel_hi:[0,1] neg_lo:[0,1] neg_hi:[0,1]
v_pk_fma_f32 v[44:45], v[40:41], s[62:63], v[44:45] op_sel:[1,1,0] op_sel_hi:[1,0,1] neg_lo:[0,0,0] neg_hi:[0,1,0]
v_pk_add_f32 v[40:41], v[30:31], v[46:47] neg_lo:[0,1] neg_hi:[0,1]
v_pk_add_f32 v[30:31], v[30:31], v[46:47]
v_pk_mul_f32 v[46:47], v[40:41], s[54:55] op_sel:[0,0] op_sel_hi:[0,1] neg_lo:[0,1] neg_hi:[0,1]
v_pk_fma_f32 v[46:47], v[40:41], s[54:55], v[46:47] op_sel:[1,1,0] op_sel_hi:[1,0,1] neg_lo:[0,0,0] neg_hi:[0,1,0]
v_pk_add_f32 v[40:41], v[14:15], v[48:49] neg_lo:[0,1] neg_hi:[0,1]
v_pk_add_f32 v[14:15], v[14:15], v[48:49]
v_pk_add_f32 v[48:49], v[50:51], v[66:67] neg_lo:[0,1] neg_hi:[0,1]
v_pk_add_f32 v[50:51], v[50:51], v[66:67]
v_pk_mul_f32 v[66:67], v[48:49], s[54:55] op_sel:[0,0] op_sel_hi:[0,1] neg_lo:[0,0] neg_hi:[0,1]
v_pk_fma_f32 v[66:67], v[48:49], s[54:55], v[66:67] op_sel:[1,1,0] op_sel_hi:[1,0,1] neg_lo:[0,0,0] neg_hi:[0,0,0]
v_pk_add_f32 v[48:49], v[52:53], v[68:69] neg_lo:[0,1] neg_hi:[0,1]
v_pk_add_f32 v[52:53], v[52:53], v[68:69]
v_pk_mul_f32 v[68:69], v[48:49], s[62:63] op_sel:[0,0] op_sel_hi:[0,1] neg_lo:[0,0] neg_hi:[0,1]
v_pk_fma_f32 v[68:69], v[48:49], s[62:63], v[68:69] op_sel:[1,1,0] op_sel_hi:[1,0,1] neg_lo:[0,0,0] neg_hi:[0,0,0]
v_pk_add_f32 v[48:49], v[54:55], v[70:71] neg_lo:[0,1] neg_hi:[0,1]
v_pk_add_f32 v[54:55], v[54:55], v[70:71]
v_pk_mul_f32 v[70:71], v[48:49], s[54:55] op_sel:[0,1] op_sel_hi:[0,0] neg_lo:[0,0] neg_hi:[0,1]
v_pk_fma_f32 v[70:71], v[48:49], s[54:55], v[70:71] op_sel:[1,0,0] op_sel_hi:[1,1,1] neg_lo:[0,0,0] neg_hi:[0,0,0]
v_pk_add_f32 v[48:49], v[56:57], v[72:73] op_sel:[1,1] op_sel_hi:[0,0] neg_lo:[0,1] neg_hi:[1,0]
v_pk_add_f32 v[56:57], v[56:57], v[72:73]
v_pk_add_f32 v[72:73], v[58:59], v[74:75] neg_lo:[0,1] neg_hi:[0,1]
v_pk_add_f32 v[58:59], v[58:59], v[74:75]
v_pk_mul_f32 v[74:75], v[72:73], s[54:55] op_sel:[0,1] op_sel_hi:[0,0] neg_lo:[0,1] neg_hi:[0,1]
v_pk_fma_f32 v[74:75], v[72:73], s[54:55], v[74:75] op_sel:[1,0,0] op_sel_hi:[1,1,1] neg_lo:[0,0,0] neg_hi:[0,1,0]
v_pk_add_f32 v[72:73], v[60:61], v[76:77] neg_lo:[0,1] neg_hi:[0,1]
v_pk_add_f32 v[60:61], v[60:61], v[76:77]
v_pk_mul_f32 v[76:77], v[72:73], s[62:63] op_sel:[0,0] op_sel_hi:[0,1] neg_lo:[0,1] neg_hi:[0,1]
v_pk_fma_f32 v[76:77], v[72:73], s[62:63], v[76:77] op_sel:[1,1,0] op_sel_hi:[1,0,1] neg_lo:[0,0,0] neg_hi:[0,1,0]
v_pk_add_f32 v[72:73], v[62:63], v[78:79] neg_lo:[0,1] neg_hi:[0,1]
v_pk_add_f32 v[62:63], v[62:63], v[78:79]
v_pk_mul_f32 v[78:79], v[72:73], s[54:55] op_sel:[0,0] op_sel_hi:[0,1] neg_lo:[0,1] neg_hi:[0,1]
v_pk_fma_f32 v[78:79], v[72:73], s[54:55], v[78:79] op_sel:[1,1,0] op_sel_hi:[1,0,1] neg_lo:[0,0,0] neg_hi:[0,1,0]
v_pk_add_f32 v[72:73], v[16:17], v[24:25] neg_lo:[0,1] neg_hi:[0,1]
v_pk_add_f32 v[16:17], v[16:17], v[24:25]
v_pk_add_f32 v[24:25], v[18:19], v[26:27] neg_lo:[0,1] neg_hi:[0,1]
v_pk_add_f32 v[18:19], v[18:19], v[26:27]
v_pk_mul_f32 v[26:27], v[24:25], s[62:63] op_sel:[0,0] op_sel_hi:[0,1] neg_lo:[0,0] neg_hi:[0,1]
v_pk_fma_f32 v[26:27], v[24:25], s[62:63], v[26:27] op_sel:[1,1,0] op_sel_hi:[1,0,1] neg_lo:[0,0,0] neg_hi:[0,0,0]
v_pk_add_f32 v[24:25], v[20:21], v[28:29] op_sel:[1,1] op_sel_hi:[0,0] neg_lo:[0,1] neg_hi:[1,0]
v_pk_add_f32 v[20:21], v[20:21], v[28:29]
v_pk_add_f32 v[28:29], v[22:23], v[30:31] neg_lo:[0,1] neg_hi:[0,1]
v_pk_add_f32 v[22:23], v[22:23], v[30:31]
v_pk_mul_f32 v[30:31], v[28:29], s[62:63] op_sel:[0,0] op_sel_hi:[0,1] neg_lo:[0,1] neg_hi:[0,1]
v_pk_fma_f32 v[30:31], v[28:29], s[62:63], v[30:31] op_sel:[1,1,0] op_sel_hi:[1,0,1] neg_lo:[0,0,0] neg_hi:[0,1,0]
v_pk_add_f32 v[28:29], v[64:65], v[32:33] neg_lo:[0,1] neg_hi:[0,1]
v_pk_add_f32 v[64:65], v[64:65], v[32:33]
v_pk_add_f32 v[32:33], v[34:35], v[42:43] neg_lo:[0,1] neg_hi:[0,1]
v_pk_add_f32 v[34:35], v[34:35], v[42:43]
v_pk_mul_f32 v[42:43], v[32:33], s[62:63] op_sel:[0,0] op_sel_hi:[0,1] neg_lo:[0,0] neg_hi:[0,1]
v_pk_fma_f32 v[42:43], v[32:33], s[62:63], v[42:43] op_sel:[1,1,0] op_sel_hi:[1,0,1] neg_lo:[0,0,0] neg_hi:[0,0,0]
v_pk_add_f32 v[32:33], v[36:37], v[44:45] op_sel:[1,1] op_sel_hi:[0,0] neg_lo:[0,1] neg_hi:[1,0]
v_pk_add_f32 v[36:37], v[36:37], v[44:45]
v_pk_add_f32 v[44:45], v[38:39], v[46:47] neg_lo:[0,1] neg_hi:[0,1]
v_pk_add_f32 v[38:39], v[38:39], v[46:47]
v_pk_mul_f32 v[46:47], v[44:45], s[62:63] op_sel:[0,0] op_sel_hi:[0,1] neg_lo:[0,1] neg_hi:[0,1]
v_pk_fma_f32 v[46:47], v[44:45], s[62:63], v[46:47] op_sel:[1,1,0] op_sel_hi:[1,0,1] neg_lo:[0,0,0] neg_hi:[0,1,0]
v_pk_add_f32 v[44:45], v[14:15], v[56:57] neg_lo:[0,1] neg_hi:[0,1]
v_pk_add_f32 v[14:15], v[14:15], v[56:57]
v_pk_add_f32 v[56:57], v[50:51], v[58:59] neg_lo:[0,1] neg_hi:[0,1]
v_pk_add_f32 v[50:51], v[50:51], v[58:59]
v_pk_mul_f32 v[58:59], v[56:57], s[62:63] op_sel:[0,0] op_sel_hi:[0,1] neg_lo:[0,0] neg_hi:[0,1]
v_pk_fma_f32 v[58:59], v[56:57], s[62:63], v[58:59] op_sel:[1,1,0] op_sel_hi:[1,0,1] neg_lo:[0,0,0] neg_hi:[0,0,0]
v_pk_add_f32 v[56:57], v[52:53], v[60:61] op_sel:[1,1] op_sel_hi:[0,0] neg_lo:[0,1] neg_hi:[1,0]
v_pk_add_f32 v[52:53], v[52:53], v[60:61]
v_pk_add_f32 v[60:61], v[54:55], v[62:63] neg_lo:[0,1] neg_hi:[0,1]
v_pk_add_f32 v[54:55], v[54:55], v[62:63]
v_pk_mul_f32 v[62:63], v[60:61], s[62:63] op_sel:[0,0] op_sel_hi:[0,1] neg_lo:[0,1] neg_hi:[0,1]
v_pk_fma_f32 v[62:63], v[60:61], s[62:63], v[62:63] op_sel:[1,1,0] op_sel_hi:[1,0,1] neg_lo:[0,0,0] neg_hi:[0,1,0]
v_pk_add_f32 v[60:61], v[40:41], v[48:49] neg_lo:[0,1] neg_hi:[0,1]
v_pk_add_f32 v[40:41], v[40:41], v[48:49]
v_pk_add_f32 v[48:49], v[66:67], v[74:75] neg_lo:[0,1] neg_hi:[0,1]
v_pk_add_f32 v[66:67], v[66:67], v[74:75]
v_pk_mul_f32 v[74:75], v[48:49], s[62:63] op_sel:[0,0] op_sel_hi:[0,1] neg_lo:[0,0] neg_hi:[0,1]
v_pk_fma_f32 v[74:75], v[48:49], s[62:63], v[74:75] op_sel:[1,1,0] op_sel_hi:[1,0,1] neg_lo:[0,0,0] neg_hi:[0,0,0]
v_pk_add_f32 v[48:49], v[68:69], v[76:77] op_sel:[1,1] op_sel_hi:[0,0] neg_lo:[0,1] neg_hi:[1,0]
v_pk_add_f32 v[68:69], v[68:69], v[76:77]
v_pk_add_f32 v[76:77], v[70:71], v[78:79] neg_lo:[0,1] neg_hi:[0,1]
v_pk_add_f32 v[70:71], v[70:71], v[78:79]
v_pk_mul_f32 v[78:79], v[76:77], s[62:63] op_sel:[0,0] op_sel_hi:[0,1] neg_lo:[0,1] neg_hi:[0,1]
v_pk_fma_f32 v[78:79], v[76:77], s[62:63], v[78:79] op_sel:[1,1,0] op_sel_hi:[1,0,1] neg_lo:[0,0,0] neg_hi:[0,1,0]
v_pk_add_f32 v[76:77], v[16:17], v[20:21] neg_lo:[0,1] neg_hi:[0,1]
v_pk_add_f32 v[16:17], v[16:17], v[20:21]
v_pk_add_f32 v[20:21], v[18:19], v[22:23] op_sel:[1,1] op_sel_hi:[0,0] neg_lo:[0,1] neg_hi:[1,0]
v_pk_add_f32 v[18:19], v[18:19], v[22:23]
v_pk_add_f32 v[22:23], v[72:73], v[24:25] neg_lo:[0,1] neg_hi:[0,1]
v_pk_add_f32 v[72:73], v[72:73], v[24:25]
v_pk_add_f32 v[24:25], v[26:27], v[30:31] op_sel:[1,1] op_sel_hi:[0,0] neg_lo:[0,1] neg_hi:[1,0]
v_pk_add_f32 v[26:27], v[26:27], v[30:31]
v_pk_add_f32 v[30:31], v[64:65], v[36:37] neg_lo:[0,1] neg_hi:[0,1]
v_pk_add_f32 v[64:65], v[64:65], v[36:37]
v_pk_add_f32 v[36:37], v[34:35], v[38:39] op_sel:[1,1] op_sel_hi:[0,0] neg_lo:[0,1] neg_hi:[1,0]
v_pk_add_f32 v[34:35], v[34:35], v[38:39]
v_pk_add_f32 v[38:39], v[28:29], v[32:33] neg_lo:[0,1] neg_hi:[0,1]
v_pk_add_f32 v[28:29], v[28:29], v[32:33]
v_pk_add_f32 v[32:33], v[42:43], v[46:47] op_sel:[1,1] op_sel_hi:[0,0] neg_lo:[0,1] neg_hi:[1,0]
v_pk_add_f32 v[42:43], v[42:43], v[46:47]
v_pk_add_f32 v[46:47], v[14:15], v[52:53] neg_lo:[0,1] neg_hi:[0,1]
v_pk_add_f32 v[14:15], v[14:15], v[52:53]
v_pk_add_f32 v[52:53], v[50:51], v[54:55] op_sel:[1,1] op_sel_hi:[0,0] neg_lo:[0,1] neg_hi:[1,0]
v_pk_add_f32 v[50:51], v[50:51], v[54:55]
v_pk_add_f32 v[54:55], v[44:45], v[56:57] neg_lo:[0,1] neg_hi:[0,1]
v_pk_add_f32 v[44:45], v[44:45], v[56:57]
v_pk_add_f32 v[56:57], v[58:59], v[62:63] op_sel:[1,1] op_sel_hi:[0,0] neg_lo:[0,1] neg_hi:[1,0]
v_pk_add_f32 v[58:59], v[58:59], v[62:63]
v_pk_add_f32 v[62:63], v[40:41], v[68:69] neg_lo:[0,1] neg_hi:[0,1]
v_pk_add_f32 v[40:41], v[40:41], v[68:69]
v_pk_add_f32 v[68:69], v[66:67], v[70:71] op_sel:[1,1] op_sel_hi:[0,0] neg_lo:[0,1] neg_hi:[1,0]
v_pk_add_f32 v[66:67], v[66:67], v[70:71]
v_pk_add_f32 v[70:71], v[60:61], v[48:49] neg_lo:[0,1] neg_hi:[0,1]
v_pk_add_f32 v[60:61], v[60:61], v[48:49]
v_pk_add_f32 v[48:49], v[74:75], v[78:79] op_sel:[1,1] op_sel_hi:[0,0] neg_lo:[0,1] neg_hi:[1,0]
v_pk_add_f32 v[74:75], v[74:75], v[78:79]
v_pk_add_f32 v[78:79], v[16:17], v[18:19] neg_lo:[0,1] neg_hi:[0,1]
v_pk_add_f32 v[16:17], v[16:17], v[18:19]
v_pk_add_f32 v[18:19], v[76:77], v[20:21] neg_lo:[0,1] neg_hi:[0,1]
v_pk_add_f32 v[76:77], v[76:77], v[20:21]
v_pk_add_f32 v[20:21], v[72:73], v[26:27] neg_lo:[0,1] neg_hi:[0,1]
v_pk_add_f32 v[72:73], v[72:73], v[26:27]
v_pk_add_f32 v[26:27], v[22:23], v[24:25] neg_lo:[0,1] neg_hi:[0,1]
v_pk_add_f32 v[22:23], v[22:23], v[24:25]
v_pk_add_f32 v[24:25], v[64:65], v[34:35] neg_lo:[0,1] neg_hi:[0,1]
v_pk_add_f32 v[64:65], v[64:65], v[34:35]
v_pk_add_f32 v[34:35], v[30:31], v[36:37] neg_lo:[0,1] neg_hi:[0,1]
v_pk_add_f32 v[30:31], v[30:31], v[36:37]
v_pk_add_f32 v[36:37], v[28:29], v[42:43] neg_lo:[0,1] neg_hi:[0,1]
v_pk_add_f32 v[28:29], v[28:29], v[42:43]
v_pk_add_f32 v[42:43], v[38:39], v[32:33] neg_lo:[0,1] neg_hi:[0,1]
v_pk_add_f32 v[38:39], v[38:39], v[32:33]
v_pk_add_f32 v[32:33], v[14:15], v[50:51] neg_lo:[0,1] neg_hi:[0,1]
v_pk_add_f32 v[14:15], v[14:15], v[50:51]
v_pk_add_f32 v[50:51], v[46:47], v[52:53] neg_lo:[0,1] neg_hi:[0,1]
v_pk_add_f32 v[46:47], v[46:47], v[52:53]
v_pk_add_f32 v[52:53], v[44:45], v[58:59] neg_lo:[0,1] neg_hi:[0,1]
v_pk_add_f32 v[44:45], v[44:45], v[58:59]
v_pk_add_f32 v[58:59], v[54:55], v[56:57] neg_lo:[0,1] neg_hi:[0,1]
v_pk_add_f32 v[54:55], v[54:55], v[56:57]
v_pk_add_f32 v[56:57], v[40:41], v[66:67] neg_lo:[0,1] neg_hi:[0,1]
v_pk_add_f32 v[40:41], v[40:41], v[66:67]
v_pk_add_f32 v[66:67], v[62:63], v[68:69] neg_lo:[0,1] neg_hi:[0,1]
v_pk_add_f32 v[62:63], v[62:63], v[68:69]
v_pk_add_f32 v[68:69], v[60:61], v[74:75] neg_lo:[0,1] neg_hi:[0,1]
v_pk_add_f32 v[60:61], v[60:61], v[74:75]
v_pk_add_f32 v[74:75], v[70:71], v[48:49] neg_lo:[0,1] neg_hi:[0,1]
v_pk_add_f32 v[70:71], v[70:71], v[48:49]
ds_write_b64 v4, v[16:17] offset:0
ds_write_b64 v4, v[14:15] offset:256
ds_write_b64 v4, v[64:65] offset:512
ds_write_b64 v4, v[40:41] offset:768
ds_write_b64 v4, v[72:73] offset:1024
ds_write_b64 v4, v[44:45] offset:1280
ds_write_b64 v4, v[28:29] offset:1536
ds_write_b64 v4, v[60:61] offset:1792
ds_write_b64 v4, v[76:77] offset:2048
ds_write_b64 v4, v[46:47] offset:2304
ds_write_b64 v4, v[30:31] offset:2560
ds_write_b64 v4, v[62:63] offset:2816
ds_write_b64 v4, v[22:23] offset:3072
ds_write_b64 v4, v[54:55] offset:3328
ds_write_b64 v4, v[38:39] offset:3584
ds_write_b64 v4, v[70:71] offset:3840
ds_write_b64 v4, v[78:79] offset:4096
ds_write_b64 v4, v[32:33] offset:4352
ds_write_b64 v4, v[24:25] offset:4608
ds_write_b64 v4, v[56:57] offset:4864
ds_write_b64 v4, v[20:21] offset:5120
ds_write_b64 v4, v[52:53] offset:5376
ds_write_b64 v4, v[36:37] offset:5632
ds_write_b64 v4, v[68:69] offset:5888
ds_write_b64 v4, v[18:19] offset:6144
ds_write_b64 v4, v[50:51] offset:6400
ds_write_b64 v4, v[34:35] offset:6656
ds_write_b64 v4, v[66:67] offset:6912
ds_write_b64 v4, v[26:27] offset:7168
ds_write_b64 v4, v[58:59] offset:7424
ds_write_b64 v4, v[42:43] offset:7680
ds_write_b64 v4, v[74:75] offset:7936
ds_write_b64 v4, v[16:17] offset:8192
s_waitcnt lgkmcnt(0)
s_barrier
s_lshl_b32 s13, s93, 7
s_and_b32 s23, s13, 0x2000
s_add_u32 s13, s13, s23
s_xor_b32 s23, s98, 1
s_lshl_b32 s23, s23, 13
s_add_u32 s13, s13, s23
s_add_u32 s13, s13, 92274688
ds_read_b64 v[16:17], v6 offset:0
ds_read_b64 v[18:19], v7 offset:4096
ds_read_b64 v[20:21], v6 offset:256
ds_read_b64 v[22:23], v7 offset:3840
ds_read_b64 v[24:25], v6 offset:512
ds_read_b64 v[26:27], v7 offset:3584
ds_read_b64 v[28:29], v6 offset:768
ds_read_b64 v[30:31], v7 offset:3328
ds_read_b64 v[32:33], v6 offset:1024
ds_read_b64 v[34:35], v7 offset:3072
ds_read_b64 v[36:37], v6 offset:1280
ds_read_b64 v[38:39], v7 offset:2816
s_waitcnt lgkmcnt(10)
v_pk_add_f32 v[208:209], v[16:17], v[18:19] neg_hi:[0,1]
v_pk_add_f32 v[210:211], v[16:17], v[18:19] op_sel:[1,1] op_sel_hi:[0,0] neg_hi:[1,0]
ds_read_b64 v[40:41], v6 offset:1536
ds_read_b64 v[42:43], v7 offset:2560
buffer_store_dwordx4 v[208:211], v8, s[84:87], s13 offen sc1
s_add_u32 s13, s13, 1048576
s_waitcnt lgkmcnt(10)
v_pk_add_f32 v[212:213], v[20:21], v[22:23] neg_hi:[0,1]
v_pk_add_f32 v[214:215], v[20:21], v[22:23] op_sel:[1,1] op_sel_hi:[0,0] neg_hi:[1,0]
ds_read_b64 v[44:45], v6 offset:1792
ds_read_b64 v[46:47], v7 offset:2304
buffer_store_dwordx4 v[212:215], v8, s[84:87], s13 offen sc1
s_add_u32 s13, s13, 1048576
s_xor_b32 s13, s13, 0x2000
s_waitcnt lgkmcnt(10)
v_pk_add_f32 v[216:217], v[24:25], v[26:27] neg_hi:[0,1]
v_pk_add_f32 v[218:219], v[24:25], v[26:27] op_sel:[1,1] op_sel_hi:[0,0] neg_hi:[1,0]
ds_read_b64 v[16:17], v6 offset:2048
ds_read_b64 v[18:19], v7 offset:2048
buffer_store_dwordx4 v[216:219], v8, s[84:87], s13 offen sc1
s_add_u32 s13, s13, 1048576
s_waitcnt lgkmcnt(10)
v_pk_add_f32 v[220:221], v[28:29], v[30:31] neg_hi:[0,1]
v_pk_add_f32 v[222:223], v[28:29], v[30:31] op_sel:[1,1] op_sel_hi:[0,0] neg_hi:[1,0]
ds_read_b64 v[20:21], v6 offset:2304
ds_read_b64 v[22:23], v7 offset:1792
buffer_store_dwordx4 v[220:223], v8, s[84:87], s13 offen sc1
s_add_u32 s13, s13, 1048576
s_xor_b32 s13, s13, 0x2000
s_waitcnt lgkmcnt(10)
v_pk_add_f32 v[224:225], v[32:33], v[34:35] neg_hi:[0,1]
v_pk_add_f32 v[226:227], v[32:33], v[34:35] op_sel:[1,1] op_sel_hi:[0,0] neg_hi:[1,0]
ds_read_b64 v[24:25], v6 offset:2560
ds_read_b64 v[26:27], v7 offset:1536
buffer_store_dwordx4 v[224:227], v8, s[84:87], s13 offen sc1
s_add_u32 s13, s13, 1048576
s_waitcnt lgkmcnt(10)
v_pk_add_f32 v[228:229], v[36:37], v[38:39] neg_hi:[0,1]
v_pk_add_f32 v[230:231], v[36:37], v[38:39] op_sel:[1,1] op_sel_hi:[0,0] neg_hi:[1,0]
ds_read_b64 v[28:29], v6 offset:2816
ds_read_b64 v[30:31], v7 offset:1280
buffer_store_dwordx4 v[228:231], v8, s[84:87], s13 offen sc1
s_add_u32 s13, s13, 1048576
s_xor_b32 s13, s13, 0x2000
s_waitcnt lgkmcnt(10)
v_pk_add_f32 v[232:233], v[40:41], v[42:43] neg_hi:[0,1]
v_pk_add_f32 v[234:235], v[40:41], v[42:43] op_sel:[1,1] op_sel_hi:[0,0] neg_hi:[1,0]
ds_read_b64 v[32:33], v6 offset:3072
ds_read_b64 v[34:35], v7 offset:1024
buffer_store_dwordx4 v[232:235], v8, s[84:87], s13 offen sc1
s_add_u32 s13, s13, 1048576
s_waitcnt lgkmcnt(10)
v_pk_add_f32 v[236:237], v[44:45], v[46:47] neg_hi:[0,1]
v_pk_add_f32 v[238:239], v[44:45], v[46:47] op_sel:[1,1] op_sel_hi:[0,0] neg_hi:[1,0]
ds_read_b64 v[36:37], v6 offset:3328
ds_read_b64 v[38:39], v7 offset:768
buffer_store_dwordx4 v[236:239], v8, s[84:87], s13 offen sc1
s_add_u32 s13, s13, 1048576
s_xor_b32 s13, s13, 0x2000
s_waitcnt lgkmcnt(10)
v_pk_add_f32 v[208:209], v[16:17], v[18:19] neg_hi:[0,1]
v_pk_add_f32 v[210:211], v[16:17], v[18:19] op_sel:[1,1] op_sel_hi:[0,0] neg_hi:[1,0]
ds_read_b64 v[40:41], v6 offset:3584
ds_read_b64 v[42:43], v7 offset:512
buffer_store_dwordx4 v[208:211], v8, s[84:87], s13 offen sc1
s_add_u32 s13, s13, 1048576
s_waitcnt lgkmcnt(10)
v_pk_add_f32 v[212:213], v[20:21], v[22:23] neg_hi:[0,1]
v_pk_add_f32 v[214:215], v[20:21], v[22:23] op_sel:[1,1] op_sel_hi:[0,0] neg_hi:[1,0]
ds_read_b64 v[44:45], v6 offset:3840
ds_read_b64 v[46:47], v7 offset:256
buffer_store_dwordx4 v[212:215], v8, s[84:87], s13 offen sc1
s_add_u32 s13, s13, 1048576
s_xor_b32 s13, s13, 0x2000
s_waitcnt lgkmcnt(10)
v_pk_add_f32 v[216:217], v[24:25], v[26:27] neg_hi:[0,1]
v_pk_add_f32 v[218:219], v[24:25], v[26:27] op_sel:[1,1] op_sel_hi:[0,0] neg_hi:[1,0]
ds_read_b64 v[16:17], v6 offset:4096
ds_read_b64 v[18:19], v7 offset:0
buffer_store_dwordx4 v[216:219], v8, s[84:87], s13 offen sc1
s_add_u32 s13, s13, 1048576
s_waitcnt lgkmcnt(10)
v_pk_add_f32 v[220:221], v[28:29], v[30:31] neg_hi:[0,1]
v_pk_add_f32 v[222:223], v[28:29], v[30:31] op_sel:[1,1] op_sel_hi:[0,0] neg_hi:[1,0]
buffer_store_dwordx4 v[220:223], v8, s[84:87], s13 offen sc1
s_add_u32 s13, s13, 1048576
s_xor_b32 s13, s13, 0x2000
s_waitcnt lgkmcnt(8)
v_pk_add_f32 v[224:225], v[32:33], v[34:35] neg_hi:[0,1]
v_pk_add_f32 v[226:227], v[32:33], v[34:35] op_sel:[1,1] op_sel_hi:[0,0] neg_hi:[1,0]
buffer_store_dwordx4 v[224:227], v8, s[84:87], s13 offen sc1
s_add_u32 s13, s13, 1048576
s_waitcnt lgkmcnt(6)
v_pk_add_f32 v[228:229], v[36:37], v[38:39] neg_hi:[0,1]
v_pk_add_f32 v[230:231], v[36:37], v[38:39] op_sel:[1,1] op_sel_hi:[0,0] neg_hi:[1,0]
buffer_store_dwordx4 v[228:231], v8, s[84:87], s13 offen sc1
s_add_u32 s13, s13, 1048576
s_xor_b32 s13, s13, 0x2000
s_waitcnt lgkmcnt(4)
v_pk_add_f32 v[232:233], v[40:41], v[42:43] neg_hi:[0,1]
v_pk_add_f32 v[234:235], v[40:41], v[42:43] op_sel:[1,1] op_sel_hi:[0,0] neg_hi:[1,0]
buffer_store_dwordx4 v[232:235], v8, s[84:87], s13 offen sc1
s_add_u32 s13, s13, 1048576
s_waitcnt lgkmcnt(2)
v_pk_add_f32 v[236:237], v[44:45], v[46:47] neg_hi:[0,1]
v_pk_add_f32 v[238:239], v[44:45], v[46:47] op_sel:[1,1] op_sel_hi:[0,0] neg_hi:[1,0]
buffer_store_dwordx4 v[236:239], v8, s[84:87], s13 offen sc1
s_add_u32 s13, s13, 1048576
s_xor_b32 s13, s13, 0x2000
s_waitcnt lgkmcnt(0)
v_pk_add_f32 v[208:209], v[16:17], v[18:19] neg_hi:[0,1]
v_pk_add_f32 v[210:211], v[16:17], v[18:19] op_sel:[1,1] op_sel_hi:[0,0] neg_hi:[1,0]
v_cmp_eq_u32 vcc, 0, v9
s_nop 1
v_cndmask_b32 v13, -16, v8, vcc
buffer_store_dwordx4 v[208:211], v13, s[84:87], s13 offen sc1
s_add_u32 s13, s13, 1048576
s_mov_b32 s93, s21
s_cmp_lt_u32 s93, 128
s_cbranch_scc1 mega_kernel_f1_l
mega_kernel_f1_e:
s_mov_b32 s93, s40
s_waitcnt vmcnt(0)
s_load_dwordx2 s[4:5], s[0:1], 64
s_load_dwordx2 s[8:9], s[0:1], 72
v_and_b32 v1, 63, v0
v_lshrrev_b32 v2, 6, v0
v_mul_u32_u24 v3, 1026, v2
v_lshl_add_u32 v3, v1, 1, v3
v_mul_u32_u24 v4, 65, v1
v_add_u32 v4, v4, v2
v_lshlrev_b32 v4, 2, v4
v_lshrrev_b32 v7, 4, v0
v_and_b32 v8, 15, v0
v_mul_u32_u24 v5, 65, v7
v_lshl_add_u32 v5, v8, 2, v5
v_lshlrev_b32 v5, 2, v5
v_mul_u32_u24 v6, 16384, v7
v_lshl_add_u32 v6, v8, 4, v6
s_add_u32 s24, s84, 171966464
s_addc_u32 s25, s85, 0
s_mov_b32 s26, 8404992
s_mov_b32 s27, 0x00020000
s_waitcnt lgkmcnt(0)
s_mov_b32 s6, 2101248
s_mov_b32 s7, 0x00020000
s_mov_b32 s10, 2101248
s_mov_b32 s11, 0x00020000
v_lshlrev_b32 v9, 7, v0
s_and_b32 s12, s93, 31
s_mul_i32 s12, s12, 65664
buffer_load_dword v250, v9, s[4:7], s12 offen
buffer_load_dword v250, v9, s[8:11], s12 offen
s_add_u32 s12, s12, 32768
buffer_load_dword v250, v9, s[4:7], s12 offen
buffer_load_dword v250, v9, s[8:11], s12 offen
s_add_u32 s12, s12, 32768
s_cmp_lt_u32 s93, 288
s_cbranch_scc0 mega_kernel_f0_e
s_and_b32 s12, s93, 31
s_mul_i32 s12, s12, 65664
s_lshr_b32 s13, s93, 5
s_lshl_b32 s13, s13, 7
s_add_u32 s12, s12, s13
buffer_load_ushort v16, v3, s[4:7], s12 offen
buffer_load_ushort v32, v3, s[8:11], s12 offen
s_add_u32 s12, s12, 4104
buffer_load_ushort v17, v3, s[4:7], s12 offen
buffer_load_ushort v33, v3, s[8:11], s12 offen
s_add_u32 s12, s12, 4104
buffer_load_ushort v18, v3, s[4:7], s12 offen
buffer_load_ushort v34, v3, s[8:11], s12 offen
s_add_u32 s12, s12, 4104
buffer_load_ushort v19, v3, s[4:7], s12 offen
buffer_load_ushort v35, v3, s[8:11], s12 offen
s_add_u32 s12, s12, 4104
buffer_load_ushort v20, v3, s[4:7], s12 offen
buffer_load_ushort v36, v3, s[8:11], s12 offen
s_add_u32 s12, s12, 4104
buffer_load_ushort v21, v3, s[4:7], s12 offen
buffer_load_ushort v37, v3, s[8:11], s12 offen
s_add_u32 s12, s12, 4104
buffer_load_ushort v22, v3, s[4:7], s12 offen
buffer_load_ushort v38, v3, s[8:11], s12 offen
s_add_u32 s12, s12, 4104
buffer_load_ushort v23, v3, s[4:7], s12 offen
buffer_load_ushort v39, v3, s[8:11], s12 offen
s_add_u32 s12, s12, 4104
buffer_load_ushort v24, v3, s[4:7], s12 offen
buffer_load_ushort v40, v3, s[8:11], s12 offen
s_add_u32 s12, s12, 4104
buffer_load_ushort v25, v3, s[4:7], s12 offen
buffer_load_ushort v41, v3, s[8:11], s12 offen
s_add_u32 s12, s12, 4104
buffer_load_ushort v26, v3, s[4:7], s12 offen
buffer_load_ushort v42, v3, s[8:11], s12 offen
s_add_u32 s12, s12, 4104
buffer_load_ushort v27, v3, s[4:7], s12 offen
buffer_load_ushort v43, v3, s[8:11], s12 offen
s_add_u32 s12, s12, 4104
buffer_load_ushort v28, v3, s[4:7], s12 offen
buffer_load_ushort v44, v3, s[8:11], s12 offen
s_add_u32 s12, s12, 4104
buffer_load_ushort v29, v3, s[4:7], s12 offen
buffer_load_ushort v45, v3, s[8:11], s12 offen
s_add_u32 s12, s12, 4104
buffer_load_ushort v30, v3, s[4:7], s12 offen
buffer_load_ushort v46, v3, s[8:11], s12 offen
s_add_u32 s12, s12, 4104
buffer_load_ushort v31, v3, s[4:7], s12 offen
buffer_load_ushort v47, v3, s[8:11], s12 offen
s_add_u32 s12, s12, 4104
s_waitcnt vmcnt(0)
mega_kernel_f0_l:
s_add_u32 s21, s93, 32
s_cmp_lt_u32 s21, 288
s_cselect_b32 s22, s21, s93
s_waitcnt vmcnt(4)
v_lshl_or_b32 v48, v32, 16, v16
v_lshl_or_b32 v49, v33, 16, v17
v_lshl_or_b32 v50, v34, 16, v18
v_lshl_or_b32 v51, v35, 16, v19
v_lshl_or_b32 v52, v36, 16, v20
v_lshl_or_b32 v53, v37, 16, v21
v_lshl_or_b32 v54, v38, 16, v22
v_lshl_or_b32 v55, v39, 16, v23
v_lshl_or_b32 v56, v40, 16, v24
v_lshl_or_b32 v57, v41, 16, v25
v_lshl_or_b32 v58, v42, 16, v26
v_lshl_or_b32 v59, v43, 16, v27
v_lshl_or_b32 v60, v44, 16, v28
v_lshl_or_b32 v61, v45, 16, v29
v_lshl_or_b32 v62, v46, 16, v30
v_lshl_or_b32 v63, v47, 16, v31
s_and_b32 s12, s22, 31
s_mul_i32 s12, s12, 65664
s_lshr_b32 s13, s22, 5
s_lshl_b32 s13, s13, 7
s_add_u32 s12, s12, s13
buffer_load_ushort v16, v3, s[4:7], s12 offen
buffer_load_ushort v32, v3, s[8:11], s12 offen
s_add_u32 s12, s12, 4104
buffer_load_ushort v17, v3, s[4:7], s12 offen
buffer_load_ushort v33, v3, s[8:11], s12 offen
s_add_u32 s12, s12, 4104
buffer_load_ushort v18, v3, s[4:7], s12 offen
buffer_load_ushort v34, v3, s[8:11], s12 offen
s_add_u32 s12, s12, 4104
buffer_load_ushort v19, v3, s[4:7], s12 offen
buffer_load_ushort v35, v3, s[8:11], s12 offen
s_add_u32 s12, s12, 4104
buffer_load_ushort v20, v3, s[4:7], s12 offen
buffer_load_ushort v36, v3, s[8:11], s12 offen
s_add_u32 s12, s12, 4104
buffer_load_ushort v21, v3, s[4:7], s12 offen
buffer_load_ushort v37, v3, s[8:11], s12 offen
s_add_u32 s12, s12, 4104
buffer_load_ushort v22, v3, s[4:7], s12 offen
buffer_load_ushort v38, v3, s[8:11], s12 offen
s_add_u32 s12, s12, 4104
buffer_load_ushort v23, v3, s[4:7], s12 offen
buffer_load_ushort v39, v3, s[8:11], s12 offen
s_add_u32 s12, s12, 4104
buffer_load_ushort v24, v3, s[4:7], s12 offen
buffer_load_ushort v40, v3, s[8:11], s12 offen
s_add_u32 s12, s12, 4104
buffer_load_ushort v25, v3, s[4:7], s12 offen
buffer_load_ushort v41, v3, s[8:11], s12 offen
s_add_u32 s12, s12, 4104
buffer_load_ushort v26, v3, s[4:7], s12 offen
buffer_load_ushort v42, v3, s[8:11], s12 offen
s_add_u32 s12, s12, 4104
buffer_load_ushort v27, v3, s[4:7], s12 offen
buffer_load_ushort v43, v3, s[8:11], s12 offen
s_add_u32 s12, s12, 4104
buffer_load_ushort v28, v3, s[4:7], s12 offen
buffer_load_ushort v44, v3, s[8:11], s12 offen
s_add_u32 s12, s12, 4104
buffer_load_ushort v29, v3, s[4:7], s12 offen
buffer_load_ushort v45, v3, s[8:11], s12 offen
s_add_u32 s12, s12, 4104
buffer_load_ushort v30, v3, s[4:7], s12 offen
buffer_load_ushort v46, v3, s[8:11], s12 offen
s_add_u32 s12, s12, 4104
buffer_load_ushort v31, v3, s[4:7], s12 offen
buffer_load_ushort v47, v3, s[8:11], s12 offen
s_add_u32 s12, s12, 4104
s_barrier
ds_write_b32 v4, v48 offset:0
ds_write_b32 v4, v49 offset:16
ds_write_b32 v4, v50 offset:32
ds_write_b32 v4, v51 offset:48
ds_write_b32 v4, v52 offset:64
ds_write_b32 v4, v53 offset:80
ds_write_b32 v4, v54 offset:96
ds_write_b32 v4, v55 offset:112
ds_write_b32 v4, v56 offset:128
ds_write_b32 v4, v57 offset:144
ds_write_b32 v4, v58 offset:160
ds_write_b32 v4, v59 offset:176
s_waitcnt lgkmcnt(4)
ds_write_b32 v4, v60 offset:192
ds_write_b32 v4, v61 offset:208
ds_write_b32 v4, v62 offset:224
ds_write_b32 v4, v63 offset:240
s_waitcnt lgkmcnt(0)
s_barrier
ds_read2_b32 v[64:65], v5 offset0:0 offset1:1
ds_read_b32 v66, v5 offset:8
ds_read_b32 v67, v5 offset:12
ds_read_b32 v68, v5 offset:4160
ds_read_b32 v69, v5 offset:4164
ds_read_b32 v70, v5 offset:4168
ds_read_b32 v71, v5 offset:4172
ds_read_b32 v72, v5 offset:8320
ds_read_b32 v73, v5 offset:8324
ds_read_b32 v74, v5 offset:8328
ds_read_b32 v75, v5 offset:8332
ds_read_b32 v76, v5 offset:12480
ds_read_b32 v77, v5 offset:12484
ds_read_b32 v78, v5 offset:12488
ds_read_b32 v79, v5 offset:12492
s_and_b32 s14, s93, 31
s_lshl_b32 s14, s14, 8
s_lshr_b32 s15, s93, 5
s_lshr_b32 s23, s15, 1
s_xnor_b32 s23, s23, s98
s_and_b32 s23, s23, 1
s_lshl_b32 s23, s23, 13
s_mul_i32 s15, s15, 1048576
s_add_u32 s15, s15, 0
s_add_u32 s15, s15, s23
s_add_u32 s14, s14, s15
s_waitcnt lgkmcnt(0)
buffer_store_dwordx4 v[64:67], v6, s[24:27], s14 offen sc1
s_add_u32 s14, s14, 262144
buffer_store_dwordx4 v[68:71], v6, s[24:27], s14 offen sc1
s_add_u32 s14, s14, 262144
buffer_store_dwordx4 v[72:75], v6, s[24:27], s14 offen sc1
s_add_u32 s14, s14, 262144
buffer_store_dwordx4 v[76:79], v6, s[24:27], s14 offen sc1
s_add_u32 s14, s14, 262144
s_mov_b32 s93, s21
s_cmp_lt_u32 s93, 288
s_cbranch_scc1 mega_kernel_f0_l
mega_kernel_f0_e:
v_and_b32 v3, 15, v0
v_lshlrev_b32 v3, 4, v3
s_branch mega_kernel_syd
mega_kernel_sydw:
s_sleep 4
mega_kernel_syd:
buffer_load_dword v2, v3, s[72:75], 0 offen sc1
s_waitcnt vmcnt(0)
mega_kernel_sydp:
s_cmp_eq_u32 s95, 1
s_cbranch_scc0 mega_kernel_sydf
v_readlane_b32 s76, v2, 14
s_mov_b32 s98, 0
s_cmp_eq_u32 s76, 32
s_cbranch_scc0 mega_kernel_sydw
s_branch mega_kernel_sydd
mega_kernel_sydf:
s_mov_b32 s77, 0
s_mov_b32 s78, 0
v_readlane_b32 s76, v2, 0
s_add_u32 s77, s77, s76
s_xor_b32 s76, s76, 32
s_or_b32 s78, s78, s76
v_readlane_b32 s76, v2, 1
s_add_u32 s77, s77, s76
s_xor_b32 s76, s76, 32
s_or_b32 s78, s78, s76
v_readlane_b32 s76, v2, 2
s_add_u32 s77, s77, s76
s_xor_b32 s76, s76, 32
s_or_b32 s78, s78, s76
v_readlane_b32 s76, v2, 3
s_add_u32 s77, s77, s76
s_xor_b32 s76, s76, 32
s_or_b32 s78, s78, s76
v_readlane_b32 s76, v2, 4
s_add_u32 s77, s77, s76
s_xor_b32 s76, s76, 32
s_or_b32 s78, s78, s76
v_readlane_b32 s76, v2, 5
s_add_u32 s77, s77, s76
s_xor_b32 s76, s76, 32
s_or_b32 s78, s78, s76
v_readlane_b32 s76, v2, 6
s_add_u32 s77, s77, s76
s_xor_b32 s76, s76, 32
s_or_b32 s78, s78, s76
v_readlane_b32 s76, v2, 7
s_add_u32 s77, s77, s76
s_xor_b32 s76, s76, 32
s_or_b32 s78, s78, s76
s_cmp_eq_u32 s77, 256
s_cbranch_scc0 mega_kernel_sydw
v_mov_b32 v252, v2
s_cmp_eq_u32 s78, 0
s_cbranch_scc0 mega_kernel_slowent
v_readlane_b32 s76, v2, 10
v_readlane_b32 s77, v2, 8
s_cmp_eq_u32 s76, 32
s_cbranch_scc0 mega_kernel_sydw
s_cmp_gt_u32 s77, 16
s_cselect_b32 s98, 1, 0
mega_kernel_sydd:
s_waitcnt vmcnt(0)
s_barrier
v_mov_b32 v1, 0
v_mov_b32 v2, 1
s_mov_b32 s82, 69259264
v_cmp_eq_u32 vcc, 0, v0
s_and_saveexec_b64 s[80:81], vcc
s_cbranch_execz mega_kernel_sg0
buffer_atomic_add v2, v1, s[84:87], s82 offen sc1
mega_kernel_sg0:
s_mov_b64 exec, s[80:81]
s_add_u32 s38, s40, 129
s_mov_b32 s39, 32
s_mov_b32 s37, 129
s_cmp_lt_u32 s38, 129
s_cbranch_scc1 mega_kernel_f2s
s_branch mega_kernel_f2e
mega_kernel_rk:
s_load_dwordx2 s[4:5], s[0:1], 24
s_load_dwordx2 s[8:9], s[0:1], 0
v_lshrrev_b32 v2, 6, v0
v_and_b32 v1, 63, v0
v_readfirstlane_b32 s41, v2
v_lshlrev_b32 v5, 4, v1
s_waitcnt lgkmcnt(0)
s_mov_b32 s6, 8388608
s_mov_b32 s7, 0x00020000
s_mov_b32 s10, 4194304
s_mov_b32 s11, 0x00020000
s_lshl_b32 s43, s40, 8
s_lshl_b32 s44, s41, 6
s_add_u32 s48, s43, s44
s_and_b32 s43, s48, 0x7ff
v_add_u32 v19, s43, v1
v_lshlrev_b32 v19, 7, v19
s_mov_b32 s43, 0
buffer_load_dword v250, v19, s[8:11], s43 offen
s_nop 0
v_lshrrev_b32 v2, 3, v1
s_lshl_b32 s43, s41, 3
v_add_u32 v2, s43, v2
v_bfe_u32 v3, v2, 1, 3
v_and_b32 v4, 7, v1
v_xor_b32 v3, v3, v4
v_lshlrev_b32 v6, 11, v2
v_lshl_add_u32 v6, v3, 4, v6
s_lshl_b32 s46, s41, 10
v_and_b32 v2, 15, v1
v_bfe_u32 v3, v2, 1, 3
v_lshrrev_b32 v4, 4, v1
v_xor_b32 v3, v3, v4
v_lshlrev_b32 v8, 7, v2
v_lshl_add_u32 v8, v3, 4, v8
v_xor_b32 v9, 64, v8
v_add_u32 v10, 0x10000, v8
v_add_u32 v11, 0x10000, v9
v_mov_b32 v7, v5
s_lshl_b32 s47, s40, 2
s_add_u32 s47, s47, s41
s_mov_b32 s42, 0
s_mov_b32 s50, 0
s_add_u32 m0, s46, 0
s_nop 0
buffer_load_dwordx4 v6, s[8:11], s50 offen offset:0 lds
s_add_u32 m0, s46, 3968
s_nop 0
buffer_load_dwordx4 v6, s[8:11], s50 offen offset:128 lds
s_add_u32 m0, s46, 7936
s_nop 0
buffer_load_dwordx4 v6, s[8:11], s50 offen offset:256 lds
s_add_u32 m0, s46, 11904
s_nop 0
buffer_load_dwordx4 v6, s[8:11], s50 offen offset:384 lds
s_add_u32 m0, s46, 15872
s_nop 0
buffer_load_dwordx4 v6, s[8:11], s50 offen offset:512 lds
s_add_u32 m0, s46, 19840
s_nop 0
buffer_load_dwordx4 v6, s[8:11], s50 offen offset:640 lds
s_add_u32 m0, s46, 23808
s_nop 0
buffer_load_dwordx4 v6, s[8:11], s50 offen offset:768 lds
s_add_u32 m0, s46, 27776
s_nop 0
buffer_load_dwordx4 v6, s[8:11], s50 offen offset:896 lds
s_add_u32 m0, s46, 31744
s_nop 0
buffer_load_dwordx4 v6, s[8:11], s50 offen offset:1024 lds
s_add_u32 m0, s46, 35712
s_nop 0
buffer_load_dwordx4 v6, s[8:11], s50 offen offset:1152 lds
s_add_u32 m0, s46, 39680
s_nop 0
buffer_load_dwordx4 v6, s[8:11], s50 offen offset:1280 lds
s_add_u32 m0, s46, 43648
s_nop 0
buffer_load_dwordx4 v6, s[8:11], s50 offen offset:1408 lds
s_add_u32 m0, s46, 47616
s_nop 0
buffer_load_dwordx4 v6, s[8:11], s50 offen offset:1536 lds
s_add_u32 m0, s46, 51584
s_nop 0
buffer_load_dwordx4 v6, s[8:11], s50 offen offset:1664 lds
s_add_u32 m0, s46, 55552
s_nop 0
buffer_load_dwordx4 v6, s[8:11], s50 offen offset:1792 lds
s_add_u32 m0, s46, 59520
s_nop 0
buffer_load_dwordx4 v6, s[8:11], s50 offen offset:1920 lds
v_lshrrev_b32 v2, 2, v1
v_and_b32 v3, 3, v1
v_lshlrev_b32 v16, 13, v2
v_lshl_add_u32 v16, v3, 4, v16
v_add_u32 v16, s48, v16
s_mul_i32 s45, s41, 24576
s_add_u32 s45, s45, 65536
v_bfe_u32 v17, v1, 2, 2
v_lshrrev_b32 v18, 4, v1
v_lshl_add_u32 v17, v18, 3, v17
v_lshlrev_b32 v17, 6, v17
v_lshl_add_u32 v17, v3, 4, v17
v_add_u32 v17, s45, v17
s_and_b32 s43, s40, 3
s_lshl_b32 s43, s43, 2
s_add_u32 s43, s43, s41
s_lshl_b32 s43, s43, 3
v_and_b32 v12, 7, v1
v_add_u32 v12, s43, v12
s_lshr_b32 s43, s40, 2
s_lshl_b32 s43, s43, 10
s_add_u32 s44, s43, 896
s_add_u32 s43, s43, 384
s_cmp_ge_u32 s40, 28
s_cselect_b32 s44, s44, s43
v_mov_b32 v13, s43
v_mov_b32 v14, s44
v_cmp_gt_u32 vcc, 32, v1
s_nop 1
v_cndmask_b32 v13, v14, v13, vcc
v_lshl_add_u32 v12, v12, 13, v13
s_mov_b32 s44, 0
buffer_load_dword v250, v12, s[4:7], s44 offen
s_add_u32 m0, s45, 0
s_mov_b32 s44, 0
buffer_load_dwordx4 v16, s[4:7], s44 offen lds
s_add_u32 m0, s45, 1024
s_mov_b32 s44, 131072
buffer_load_dwordx4 v16, s[4:7], s44 offen lds
s_add_u32 m0, s45, 2048
s_mov_b32 s44, 262144
buffer_load_dwordx4 v16, s[4:7], s44 offen lds
s_add_u32 m0, s45, 3072
s_mov_b32 s44, 393216
buffer_load_dwordx4 v16, s[4:7], s44 offen lds
s_add_u32 m0, s45, 4096
s_mov_b32 s44, 524288
buffer_load_dwordx4 v16, s[4:7], s44 offen lds
s_add_u32 m0, s45, 5120
s_mov_b32 s44, 655360
buffer_load_dwordx4 v16, s[4:7], s44 offen lds
s_add_u32 m0, s45, 6144
s_mov_b32 s44, 786432
buffer_load_dwordx4 v16, s[4:7], s44 offen lds
s_add_u32 m0, s45, 7168
s_mov_b32 s44, 917504
buffer_load_dwordx4 v16, s[4:7], s44 offen lds
s_mov_b32 s44, 1048576
buffer_load_dword v250, v12, s[4:7], s44 offen
s_add_u32 m0, s45, 8192
s_mov_b32 s44, 1048576
buffer_load_dwordx4 v16, s[4:7], s44 offen lds
s_add_u32 m0, s45, 9216
s_mov_b32 s44, 1179648
buffer_load_dwordx4 v16, s[4:7], s44 offen lds
s_add_u32 m0, s45, 10240
s_mov_b32 s44, 1310720
buffer_load_dwordx4 v16, s[4:7], s44 offen lds
s_add_u32 m0, s45, 11264
s_mov_b32 s44, 1441792
buffer_load_dwordx4 v16, s[4:7], s44 offen lds
s_add_u32 m0, s45, 12288
s_mov_b32 s44, 1572864
buffer_load_dwordx4 v16, s[4:7], s44 offen lds
s_add_u32 m0, s45, 13312
s_mov_b32 s44, 1703936
buffer_load_dwordx4 v16, s[4:7], s44 offen lds
s_add_u32 m0, s45, 14336
s_mov_b32 s44, 1835008
buffer_load_dwordx4 v16, s[4:7], s44 offen lds
s_add_u32 m0, s45, 15360
s_mov_b32 s44, 1966080
buffer_load_dwordx4 v16, s[4:7], s44 offen lds
s_mov_b32 s44, 2097152
buffer_load_dword v250, v12, s[4:7], s44 offen
s_add_u32 m0, s45, 16384
s_mov_b32 s44, 2097152
buffer_load_dwordx4 v16, s[4:7], s44 offen lds
s_add_u32 m0, s45, 17408
s_mov_b32 s44, 2228224
buffer_load_dwordx4 v16, s[4:7], s44 offen lds
s_add_u32 m0, s45, 18432
s_mov_b32 s44, 2359296
buffer_load_dwordx4 v16, s[4:7], s44 offen lds
s_add_u32 m0, s45, 19456
s_mov_b32 s44, 2490368
buffer_load_dwordx4 v16, s[4:7], s44 offen lds
s_add_u32 m0, s45, 20480
s_mov_b32 s44, 2621440
buffer_load_dwordx4 v16, s[4:7], s44 offen lds
s_add_u32 m0, s45, 21504
s_mov_b32 s44, 2752512
buffer_load_dwordx4 v16, s[4:7], s44 offen lds
s_add_u32 m0, s45, 22528
s_mov_b32 s44, 2883584
buffer_load_dwordx4 v16, s[4:7], s44 offen lds
s_add_u32 m0, s45, 23552
s_mov_b32 s44, 3014656
buffer_load_dwordx4 v16, s[4:7], s44 offen lds
s_waitcnt vmcnt(18)
s_barrier
ds_read_b64_tr_b16 a[0:1], v17 offset:0
ds_read_b64_tr_b16 a[2:3], v17 offset:256
ds_read_b64_tr_b16 a[4:5], v17 offset:8
ds_read_b64_tr_b16 a[6:7], v17 offset:264
ds_read_b64_tr_b16 a[8:9], v17 offset:2048
ds_read_b64_tr_b16 a[10:11], v17 offset:2304
ds_read_b64_tr_b16 a[12:13], v17 offset:2056
ds_read_b64_tr_b16 a[14:15], v17 offset:2312
s_waitcnt lgkmcnt(0)
ds_read_b64_tr_b16 a[16:17], v17 offset:4096
ds_read_b64_tr_b16 a[18:19], v17 offset:4352
ds_read_b64_tr_b16 a[20:21], v17 offset:4104
ds_read_b64_tr_b16 a[22:23], v17 offset:4360
ds_read_b64_tr_b16 a[24:25], v17 offset:6144
ds_read_b64_tr_b16 a[26:27], v17 offset:6400
ds_read_b64_tr_b16 a[28:29], v17 offset:6152
ds_read_b64_tr_b16 a[30:31], v17 offset:6408
s_waitcnt lgkmcnt(0)
s_mov_b32 s44, 3145728
buffer_load_dword v250, v12, s[4:7], s44 offen
s_add_u32 m0, s45, 0
s_mov_b32 s44, 3145728
buffer_load_dwordx4 v16, s[4:7], s44 offen lds
s_add_u32 m0, s45, 1024
s_mov_b32 s44, 3276800
buffer_load_dwordx4 v16, s[4:7], s44 offen lds
s_add_u32 m0, s45, 2048
s_mov_b32 s44, 3407872
buffer_load_dwordx4 v16, s[4:7], s44 offen lds
s_add_u32 m0, s45, 3072
s_mov_b32 s44, 3538944
buffer_load_dwordx4 v16, s[4:7], s44 offen lds
s_add_u32 m0, s45, 4096
s_mov_b32 s44, 3670016
buffer_load_dwordx4 v16, s[4:7], s44 offen lds
s_add_u32 m0, s45, 5120
s_mov_b32 s44, 3801088
buffer_load_dwordx4 v16, s[4:7], s44 offen lds
s_add_u32 m0, s45, 6144
s_mov_b32 s44, 3932160
buffer_load_dwordx4 v16, s[4:7], s44 offen lds
s_add_u32 m0, s45, 7168
s_mov_b32 s44, 4063232
buffer_load_dwordx4 v16, s[4:7], s44 offen lds
ds_read_b128 v[20:23], v8 offset:0
ds_read_b128 v[24:27], v8 offset:2048
ds_read_b128 v[28:31], v9 offset:0
ds_read_b128 v[32:35], v9 offset:2048
ds_read_b128 v[36:39], v8 offset:4096
ds_read_b128 v[40:43], v8 offset:6144
ds_read_b128 v[44:47], v9 offset:4096
ds_read_b128 v[48:51], v9 offset:6144
s_waitcnt lgkmcnt(0)
v_mfma_f32_16x16x32_bf16 v[52:55], a[0:3], v[20:23], 0
v_mfma_f32_16x16x32_bf16 v[56:59], a[4:7], v[20:23], 0
v_mfma_f32_16x16x32_bf16 v[60:63], a[0:3], v[24:27], 0
v_mfma_f32_16x16x32_bf16 v[64:67], a[4:7], v[24:27], 0
v_mfma_f32_16x16x32_bf16 v[52:55], a[8:11], v[28:31], v[52:55]
v_mfma_f32_16x16x32_bf16 v[56:59], a[12:15], v[28:31], v[56:59]
v_mfma_f32_16x16x32_bf16 v[60:63], a[8:11], v[32:35], v[60:63]
v_mfma_f32_16x16x32_bf16 v[64:67], a[12:15], v[32:35], v[64:67]
v_mfma_f32_16x16x32_bf16 v[52:55], a[16:19], v[36:39], v[52:55]
v_mfma_f32_16x16x32_bf16 v[56:59], a[20:23], v[36:39], v[56:59]
v_mfma_f32_16x16x32_bf16 v[60:63], a[16:19], v[40:43], v[60:63]
v_mfma_f32_16x16x32_bf16 v[64:67], a[20:23], v[40:43], v[64:67]
v_mfma_f32_16x16x32_bf16 v[52:55], a[24:27], v[44:47], v[52:55]
v_mfma_f32_16x16x32_bf16 v[56:59], a[28:31], v[44:47], v[56:59]
v_mfma_f32_16x16x32_bf16 v[60:63], a[24:27], v[48:51], v[60:63]
v_mfma_f32_16x16x32_bf16 v[64:67], a[28:31], v[48:51], v[64:67]
s_waitcnt vmcnt(18)
ds_read_b64_tr_b16 a[32:33], v17 offset:8192
ds_read_b64_tr_b16 a[34:35], v17 offset:8448
ds_read_b64_tr_b16 a[36:37], v17 offset:8200
ds_read_b64_tr_b16 a[38:39], v17 offset:8456
ds_read_b64_tr_b16 a[40:41], v17 offset:10240
ds_read_b64_tr_b16 a[42:43], v17 offset:10496
ds_read_b64_tr_b16 a[44:45], v17 offset:10248
ds_read_b64_tr_b16 a[46:47], v17 offset:10504
s_waitcnt lgkmcnt(0)
ds_read_b64_tr_b16 a[48:49], v17 offset:12288
ds_read_b64_tr_b16 a[50:51], v17 offset:12544
ds_read_b64_tr_b16 a[52:53], v17 offset:12296
ds_read_b64_tr_b16 a[54:55], v17 offset:12552
ds_read_b64_tr_b16 a[56:57], v17 offset:14336
ds_read_b64_tr_b16 a[58:59], v17 offset:14592
ds_read_b64_tr_b16 a[60:61], v17 offset:14344
ds_read_b64_tr_b16 a[62:63], v17 offset:14600
s_waitcnt lgkmcnt(0)
s_mov_b32 s44, 4194304
buffer_load_dword v250, v12, s[4:7], s44 offen
s_add_u32 m0, s45, 8192
s_mov_b32 s44, 4194304
buffer_load_dwordx4 v16, s[4:7], s44 offen lds
s_add_u32 m0, s45, 9216
s_mov_b32 s44, 4325376
buffer_load_dwordx4 v16, s[4:7], s44 offen lds
s_add_u32 m0, s45, 10240
s_mov_b32 s44, 4456448
buffer_load_dwordx4 v16, s[4:7], s44 offen lds
s_add_u32 m0, s45, 11264
s_mov_b32 s44, 4587520
buffer_load_dwordx4 v16, s[4:7], s44 offen lds
s_add_u32 m0, s45, 12288
s_mov_b32 s44, 4718592
buffer_load_dwordx4 v16, s[4:7], s44 offen lds
s_add_u32 m0, s45, 13312
s_mov_b32 s44, 4849664
buffer_load_dwordx4 v16, s[4:7], s44 offen lds
s_add_u32 m0, s45, 14336
s_mov_b32 s44, 4980736
buffer_load_dwordx4 v16, s[4:7], s44 offen lds
s_add_u32 m0, s45, 15360
s_mov_b32 s44, 5111808
buffer_load_dwordx4 v16, s[4:7], s44 offen lds
ds_read_b128 v[20:23], v8 offset:8192
ds_read_b128 v[24:27], v8 offset:10240
ds_read_b128 v[28:31], v9 offset:8192
ds_read_b128 v[32:35], v9 offset:10240
ds_read_b128 v[36:39], v8 offset:12288
ds_read_b128 v[40:43], v8 offset:14336
ds_read_b128 v[44:47], v9 offset:12288
ds_read_b128 v[48:51], v9 offset:14336
s_waitcnt lgkmcnt(0)
v_mfma_f32_16x16x32_bf16 v[52:55], a[32:35], v[20:23], v[52:55]
v_mfma_f32_16x16x32_bf16 v[56:59], a[36:39], v[20:23], v[56:59]
v_mfma_f32_16x16x32_bf16 v[60:63], a[32:35], v[24:27], v[60:63]
v_mfma_f32_16x16x32_bf16 v[64:67], a[36:39], v[24:27], v[64:67]
v_mfma_f32_16x16x32_bf16 v[52:55], a[40:43], v[28:31], v[52:55]
v_mfma_f32_16x16x32_bf16 v[56:59], a[44:47], v[28:31], v[56:59]
v_mfma_f32_16x16x32_bf16 v[60:63], a[40:43], v[32:35], v[60:63]
v_mfma_f32_16x16x32_bf16 v[64:67], a[44:47], v[32:35], v[64:67]
v_mfma_f32_16x16x32_bf16 v[52:55], a[48:51], v[36:39], v[52:55]
v_mfma_f32_16x16x32_bf16 v[56:59], a[52:55], v[36:39], v[56:59]
v_mfma_f32_16x16x32_bf16 v[60:63], a[48:51], v[40:43], v[60:63]
v_mfma_f32_16x16x32_bf16 v[64:67], a[52:55], v[40:43], v[64:67]
v_mfma_f32_16x16x32_bf16 v[52:55], a[56:59], v[44:47], v[52:55]
v_mfma_f32_16x16x32_bf16 v[56:59], a[60:63], v[44:47], v[56:59]
v_mfma_f32_16x16x32_bf16 v[60:63], a[56:59], v[48:51], v[60:63]
v_mfma_f32_16x16x32_bf16 v[64:67], a[60:63], v[48:51], v[64:67]
s_waitcnt vmcnt(18)
ds_read_b64_tr_b16 a[64:65], v17 offset:16384
ds_read_b64_tr_b16 a[66:67], v17 offset:16640
ds_read_b64_tr_b16 a[68:69], v17 offset:16392
ds_read_b64_tr_b16 a[70:71], v17 offset:16648
ds_read_b64_tr_b16 a[72:73], v17 offset:18432
ds_read_b64_tr_b16 a[74:75], v17 offset:18688
ds_read_b64_tr_b16 a[76:77], v17 offset:18440
ds_read_b64_tr_b16 a[78:79], v17 offset:18696
s_waitcnt lgkmcnt(0)
ds_read_b64_tr_b16 a[80:81], v17 offset:20480
ds_read_b64_tr_b16 a[82:83], v17 offset:20736
ds_read_b64_tr_b16 a[84:85], v17 offset:20488
ds_read_b64_tr_b16 a[86:87], v17 offset:20744
ds_read_b64_tr_b16 a[88:89], v17 offset:22528
ds_read_b64_tr_b16 a[90:91], v17 offset:22784
ds_read_b64_tr_b16 a[92:93], v17 offset:22536
ds_read_b64_tr_b16 a[94:95], v17 offset:22792
s_waitcnt lgkmcnt(0)
s_mov_b32 s44, 5242880
buffer_load_dword v250, v12, s[4:7], s44 offen
s_add_u32 m0, s45, 16384
s_mov_b32 s44, 5242880
buffer_load_dwordx4 v16, s[4:7], s44 offen lds
s_add_u32 m0, s45, 17408
s_mov_b32 s44, 5373952
buffer_load_dwordx4 v16, s[4:7], s44 offen lds
s_add_u32 m0, s45, 18432
s_mov_b32 s44, 5505024
buffer_load_dwordx4 v16, s[4:7], s44 offen lds
s_add_u32 m0, s45, 19456
s_mov_b32 s44, 5636096
buffer_load_dwordx4 v16, s[4:7], s44 offen lds
s_add_u32 m0, s45, 20480
s_mov_b32 s44, 5767168
buffer_load_dwordx4 v16, s[4:7], s44 offen lds
s_add_u32 m0, s45, 21504
s_mov_b32 s44, 5898240
buffer_load_dwordx4 v16, s[4:7], s44 offen lds
s_add_u32 m0, s45, 22528
s_mov_b32 s44, 6029312
buffer_load_dwordx4 v16, s[4:7], s44 offen lds
s_add_u32 m0, s45, 23552
s_mov_b32 s44, 6160384
buffer_load_dwordx4 v16, s[4:7], s44 offen lds
ds_read_b128 v[20:23], v8 offset:16384
ds_read_b128 v[24:27], v8 offset:18432
ds_read_b128 v[28:31], v9 offset:16384
ds_read_b128 v[32:35], v9 offset:18432
ds_read_b128 v[36:39], v8 offset:20480
ds_read_b128 v[40:43], v8 offset:22528
ds_read_b128 v[44:47], v9 offset:20480
ds_read_b128 v[48:51], v9 offset:22528
s_waitcnt lgkmcnt(0)
v_mfma_f32_16x16x32_bf16 v[52:55], a[64:67], v[20:23], v[52:55]
v_mfma_f32_16x16x32_bf16 v[56:59], a[68:71], v[20:23], v[56:59]
v_mfma_f32_16x16x32_bf16 v[60:63], a[64:67], v[24:27], v[60:63]
v_mfma_f32_16x16x32_bf16 v[64:67], a[68:71], v[24:27], v[64:67]
v_mfma_f32_16x16x32_bf16 v[52:55], a[72:75], v[28:31], v[52:55]
v_mfma_f32_16x16x32_bf16 v[56:59], a[76:79], v[28:31], v[56:59]
v_mfma_f32_16x16x32_bf16 v[60:63], a[72:75], v[32:35], v[60:63]
v_mfma_f32_16x16x32_bf16 v[64:67], a[76:79], v[32:35], v[64:67]
v_mfma_f32_16x16x32_bf16 v[52:55], a[80:83], v[36:39], v[52:55]
v_mfma_f32_16x16x32_bf16 v[56:59], a[84:87], v[36:39], v[56:59]
v_mfma_f32_16x16x32_bf16 v[60:63], a[80:83], v[40:43], v[60:63]
v_mfma_f32_16x16x32_bf16 v[64:67], a[84:87], v[40:43], v[64:67]
v_mfma_f32_16x16x32_bf16 v[52:55], a[88:91], v[44:47], v[52:55]
v_mfma_f32_16x16x32_bf16 v[56:59], a[92:95], v[44:47], v[56:59]
v_mfma_f32_16x16x32_bf16 v[60:63], a[88:91], v[48:51], v[60:63]
v_mfma_f32_16x16x32_bf16 v[64:67], a[92:95], v[48:51], v[64:67]
s_waitcnt vmcnt(18)
ds_read_b64_tr_b16 a[96:97], v17 offset:0
ds_read_b64_tr_b16 a[98:99], v17 offset:256
ds_read_b64_tr_b16 a[100:101], v17 offset:8
ds_read_b64_tr_b16 a[102:103], v17 offset:264
ds_read_b64_tr_b16 a[104:105], v17 offset:2048
ds_read_b64_tr_b16 a[106:107], v17 offset:2304
ds_read_b64_tr_b16 a[108:109], v17 offset:2056
ds_read_b64_tr_b16 a[110:111], v17 offset:2312
s_waitcnt lgkmcnt(0)
ds_read_b64_tr_b16 a[112:113], v17 offset:4096
ds_read_b64_tr_b16 a[114:115], v17 offset:4352
ds_read_b64_tr_b16 a[116:117], v17 offset:4104
ds_read_b64_tr_b16 a[118:119], v17 offset:4360
ds_read_b64_tr_b16 a[120:121], v17 offset:6144
ds_read_b64_tr_b16 a[122:123], v17 offset:6400
ds_read_b64_tr_b16 a[124:125], v17 offset:6152
ds_read_b64_tr_b16 a[126:127], v17 offset:6408
s_waitcnt lgkmcnt(0)
s_mov_b32 s44, 6291456
buffer_load_dword v250, v12, s[4:7], s44 offen
s_add_u32 m0, s45, 0
s_mov_b32 s44, 6291456
buffer_load_dwordx4 v16, s[4:7], s44 offen lds
s_add_u32 m0, s45, 1024
s_mov_b32 s44, 6422528
buffer_load_dwordx4 v16, s[4:7], s44 offen lds
s_add_u32 m0, s45, 2048
s_mov_b32 s44, 6553600
buffer_load_dwordx4 v16, s[4:7], s44 offen lds
s_add_u32 m0, s45, 3072
s_mov_b32 s44, 6684672
buffer_load_dwordx4 v16, s[4:7], s44 offen lds
s_add_u32 m0, s45, 4096
s_mov_b32 s44, 6815744
buffer_load_dwordx4 v16, s[4:7], s44 offen lds
s_add_u32 m0, s45, 5120
s_mov_b32 s44, 6946816
buffer_load_dwordx4 v16, s[4:7], s44 offen lds
s_add_u32 m0, s45, 6144
s_mov_b32 s44, 7077888
buffer_load_dwordx4 v16, s[4:7], s44 offen lds
s_add_u32 m0, s45, 7168
s_mov_b32 s44, 7208960
buffer_load_dwordx4 v16, s[4:7], s44 offen lds
ds_read_b128 v[20:23], v8 offset:24576
ds_read_b128 v[24:27], v8 offset:26624
ds_read_b128 v[28:31], v9 offset:24576
ds_read_b128 v[32:35], v9 offset:26624
ds_read_b128 v[36:39], v8 offset:28672
ds_read_b128 v[40:43], v8 offset:30720
ds_read_b128 v[44:47], v9 offset:28672
ds_read_b128 v[48:51], v9 offset:30720
s_waitcnt lgkmcnt(0)
v_mfma_f32_16x16x32_bf16 v[52:55], a[96:99], v[20:23], v[52:55]
v_mfma_f32_16x16x32_bf16 v[56:59], a[100:103], v[20:23], v[56:59]
v_mfma_f32_16x16x32_bf16 v[60:63], a[96:99], v[24:27], v[60:63]
v_mfma_f32_16x16x32_bf16 v[64:67], a[100:103], v[24:27], v[64:67]
v_mfma_f32_16x16x32_bf16 v[52:55], a[104:107], v[28:31], v[52:55]
v_mfma_f32_16x16x32_bf16 v[56:59], a[108:111], v[28:31], v[56:59]
v_mfma_f32_16x16x32_bf16 v[60:63], a[104:107], v[32:35], v[60:63]
v_mfma_f32_16x16x32_bf16 v[64:67], a[108:111], v[32:35], v[64:67]
v_mfma_f32_16x16x32_bf16 v[52:55], a[112:115], v[36:39], v[52:55]
v_mfma_f32_16x16x32_bf16 v[56:59], a[116:119], v[36:39], v[56:59]
v_mfma_f32_16x16x32_bf16 v[60:63], a[112:115], v[40:43], v[60:63]
v_mfma_f32_16x16x32_bf16 v[64:67], a[116:119], v[40:43], v[64:67]
v_mfma_f32_16x16x32_bf16 v[52:55], a[120:123], v[44:47], v[52:55]
v_mfma_f32_16x16x32_bf16 v[56:59], a[124:127], v[44:47], v[56:59]
v_mfma_f32_16x16x32_bf16 v[60:63], a[120:123], v[48:51], v[60:63]
v_mfma_f32_16x16x32_bf16 v[64:67], a[124:127], v[48:51], v[64:67]
s_waitcnt vmcnt(18)
ds_read_b64_tr_b16 a[128:129], v17 offset:8192
ds_read_b64_tr_b16 a[130:131], v17 offset:8448
ds_read_b64_tr_b16 a[132:133], v17 offset:8200
ds_read_b64_tr_b16 a[134:135], v17 offset:8456
ds_read_b64_tr_b16 a[136:137], v17 offset:10240
ds_read_b64_tr_b16 a[138:139], v17 offset:10496
ds_read_b64_tr_b16 a[140:141], v17 offset:10248
ds_read_b64_tr_b16 a[142:143], v17 offset:10504
s_waitcnt lgkmcnt(0)
ds_read_b64_tr_b16 a[144:145], v17 offset:12288
ds_read_b64_tr_b16 a[146:147], v17 offset:12544
ds_read_b64_tr_b16 a[148:149], v17 offset:12296
ds_read_b64_tr_b16 a[150:151], v17 offset:12552
ds_read_b64_tr_b16 a[152:153], v17 offset:14336
ds_read_b64_tr_b16 a[154:155], v17 offset:14592
ds_read_b64_tr_b16 a[156:157], v17 offset:14344
ds_read_b64_tr_b16 a[158:159], v17 offset:14600
s_waitcnt lgkmcnt(0)
s_mov_b32 s44, 7340032
buffer_load_dword v250, v12, s[4:7], s44 offen
s_add_u32 m0, s45, 8192
s_mov_b32 s44, 7340032
buffer_load_dwordx4 v16, s[4:7], s44 offen lds
s_add_u32 m0, s45, 9216
s_mov_b32 s44, 7471104
buffer_load_dwordx4 v16, s[4:7], s44 offen lds
s_add_u32 m0, s45, 10240
s_mov_b32 s44, 7602176
buffer_load_dwordx4 v16, s[4:7], s44 offen lds
s_add_u32 m0, s45, 11264
s_mov_b32 s44, 7733248
buffer_load_dwordx4 v16, s[4:7], s44 offen lds
s_add_u32 m0, s45, 12288
s_mov_b32 s44, 7864320
buffer_load_dwordx4 v16, s[4:7], s44 offen lds
s_add_u32 m0, s45, 13312
s_mov_b32 s44, 7995392
buffer_load_dwordx4 v16, s[4:7], s44 offen lds
s_add_u32 m0, s45, 14336
s_mov_b32 s44, 8126464
buffer_load_dwordx4 v16, s[4:7], s44 offen lds
s_add_u32 m0, s45, 15360
s_mov_b32 s44, 8257536
buffer_load_dwordx4 v16, s[4:7], s44 offen lds
ds_read_b128 v[20:23], v8 offset:32768
ds_read_b128 v[24:27], v8 offset:34816
ds_read_b128 v[28:31], v9 offset:32768
ds_read_b128 v[32:35], v9 offset:34816
ds_read_b128 v[36:39], v8 offset:36864
ds_read_b128 v[40:43], v8 offset:38912
ds_read_b128 v[44:47], v9 offset:36864
ds_read_b128 v[48:51], v9 offset:38912
s_waitcnt lgkmcnt(0)
v_mfma_f32_16x16x32_bf16 v[52:55], a[128:131], v[20:23], v[52:55]
v_mfma_f32_16x16x32_bf16 v[56:59], a[132:135], v[20:23], v[56:59]
v_mfma_f32_16x16x32_bf16 v[60:63], a[128:131], v[24:27], v[60:63]
v_mfma_f32_16x16x32_bf16 v[64:67], a[132:135], v[24:27], v[64:67]
v_mfma_f32_16x16x32_bf16 v[52:55], a[136:139], v[28:31], v[52:55]
v_mfma_f32_16x16x32_bf16 v[56:59], a[140:143], v[28:31], v[56:59]
v_mfma_f32_16x16x32_bf16 v[60:63], a[136:139], v[32:35], v[60:63]
v_mfma_f32_16x16x32_bf16 v[64:67], a[140:143], v[32:35], v[64:67]
v_mfma_f32_16x16x32_bf16 v[52:55], a[144:147], v[36:39], v[52:55]
v_mfma_f32_16x16x32_bf16 v[56:59], a[148:151], v[36:39], v[56:59]
v_mfma_f32_16x16x32_bf16 v[60:63], a[144:147], v[40:43], v[60:63]
v_mfma_f32_16x16x32_bf16 v[64:67], a[148:151], v[40:43], v[64:67]
v_mfma_f32_16x16x32_bf16 v[52:55], a[152:155], v[44:47], v[52:55]
v_mfma_f32_16x16x32_bf16 v[56:59], a[156:159], v[44:47], v[56:59]
v_mfma_f32_16x16x32_bf16 v[60:63], a[152:155], v[48:51], v[60:63]
v_mfma_f32_16x16x32_bf16 v[64:67], a[156:159], v[48:51], v[64:67]
s_waitcnt vmcnt(18)
ds_read_b64_tr_b16 a[160:161], v17 offset:16384
ds_read_b64_tr_b16 a[162:163], v17 offset:16640
ds_read_b64_tr_b16 a[164:165], v17 offset:16392
ds_read_b64_tr_b16 a[166:167], v17 offset:16648
ds_read_b64_tr_b16 a[168:169], v17 offset:18432
ds_read_b64_tr_b16 a[170:171], v17 offset:18688
ds_read_b64_tr_b16 a[172:173], v17 offset:18440
ds_read_b64_tr_b16 a[174:175], v17 offset:18696
s_waitcnt lgkmcnt(0)
ds_read_b64_tr_b16 a[176:177], v17 offset:20480
ds_read_b64_tr_b16 a[178:179], v17 offset:20736
ds_read_b64_tr_b16 a[180:181], v17 offset:20488
ds_read_b64_tr_b16 a[182:183], v17 offset:20744
ds_read_b64_tr_b16 a[184:185], v17 offset:22528
ds_read_b64_tr_b16 a[186:187], v17 offset:22784
ds_read_b64_tr_b16 a[188:189], v17 offset:22536
ds_read_b64_tr_b16 a[190:191], v17 offset:22792
s_waitcnt lgkmcnt(0)
ds_read_b128 v[20:23], v8 offset:40960
ds_read_b128 v[24:27], v8 offset:43008
ds_read_b128 v[28:31], v9 offset:40960
ds_read_b128 v[32:35], v9 offset:43008
ds_read_b128 v[36:39], v8 offset:45056
ds_read_b128 v[40:43], v8 offset:47104
ds_read_b128 v[44:47], v9 offset:45056
ds_read_b128 v[48:51], v9 offset:47104
s_waitcnt lgkmcnt(0)
v_mfma_f32_16x16x32_bf16 v[52:55], a[160:163], v[20:23], v[52:55]
v_mfma_f32_16x16x32_bf16 v[56:59], a[164:167], v[20:23], v[56:59]
v_mfma_f32_16x16x32_bf16 v[60:63], a[160:163], v[24:27], v[60:63]
v_mfma_f32_16x16x32_bf16 v[64:67], a[164:167], v[24:27], v[64:67]
v_mfma_f32_16x16x32_bf16 v[52:55], a[168:171], v[28:31], v[52:55]
v_mfma_f32_16x16x32_bf16 v[56:59], a[172:175], v[28:31], v[56:59]
v_mfma_f32_16x16x32_bf16 v[60:63], a[168:171], v[32:35], v[60:63]
v_mfma_f32_16x16x32_bf16 v[64:67], a[172:175], v[32:35], v[64:67]
v_mfma_f32_16x16x32_bf16 v[52:55], a[176:179], v[36:39], v[52:55]
v_mfma_f32_16x16x32_bf16 v[56:59], a[180:183], v[36:39], v[56:59]
v_mfma_f32_16x16x32_bf16 v[60:63], a[176:179], v[40:43], v[60:63]
v_mfma_f32_16x16x32_bf16 v[64:67], a[180:183], v[40:43], v[64:67]
v_mfma_f32_16x16x32_bf16 v[52:55], a[184:187], v[44:47], v[52:55]
v_mfma_f32_16x16x32_bf16 v[56:59], a[188:191], v[44:47], v[56:59]
v_mfma_f32_16x16x32_bf16 v[60:63], a[184:187], v[48:51], v[60:63]
v_mfma_f32_16x16x32_bf16 v[64:67], a[188:191], v[48:51], v[64:67]
s_waitcnt vmcnt(9)
ds_read_b64_tr_b16 a[192:193], v17 offset:0
ds_read_b64_tr_b16 a[194:195], v17 offset:256
ds_read_b64_tr_b16 a[196:197], v17 offset:8
ds_read_b64_tr_b16 a[198:199], v17 offset:264
ds_read_b64_tr_b16 a[200:201], v17 offset:2048
ds_read_b64_tr_b16 a[202:203], v17 offset:2304
ds_read_b64_tr_b16 a[204:205], v17 offset:2056
ds_read_b64_tr_b16 a[206:207], v17 offset:2312
s_waitcnt lgkmcnt(0)
ds_read_b64_tr_b16 a[208:209], v17 offset:4096
ds_read_b64_tr_b16 a[210:211], v17 offset:4352
ds_read_b64_tr_b16 a[212:213], v17 offset:4104
ds_read_b64_tr_b16 a[214:215], v17 offset:4360
ds_read_b64_tr_b16 a[216:217], v17 offset:6144
ds_read_b64_tr_b16 a[218:219], v17 offset:6400
ds_read_b64_tr_b16 a[220:221], v17 offset:6152
ds_read_b64_tr_b16 a[222:223], v17 offset:6408
s_waitcnt lgkmcnt(0)
ds_read_b128 v[20:23], v8 offset:49152
ds_read_b128 v[24:27], v8 offset:51200
ds_read_b128 v[28:31], v9 offset:49152
ds_read_b128 v[32:35], v9 offset:51200
ds_read_b128 v[36:39], v8 offset:53248
ds_read_b128 v[40:43], v8 offset:55296
ds_read_b128 v[44:47], v9 offset:53248
ds_read_b128 v[48:51], v9 offset:55296
s_waitcnt lgkmcnt(0)
v_mfma_f32_16x16x32_bf16 v[52:55], a[192:195], v[20:23], v[52:55]
v_mfma_f32_16x16x32_bf16 v[56:59], a[196:199], v[20:23], v[56:59]
v_mfma_f32_16x16x32_bf16 v[60:63], a[192:195], v[24:27], v[60:63]
v_mfma_f32_16x16x32_bf16 v[64:67], a[196:199], v[24:27], v[64:67]
v_mfma_f32_16x16x32_bf16 v[52:55], a[200:203], v[28:31], v[52:55]
v_mfma_f32_16x16x32_bf16 v[56:59], a[204:207], v[28:31], v[56:59]
v_mfma_f32_16x16x32_bf16 v[60:63], a[200:203], v[32:35], v[60:63]
v_mfma_f32_16x16x32_bf16 v[64:67], a[204:207], v[32:35], v[64:67]
v_mfma_f32_16x16x32_bf16 v[52:55], a[208:211], v[36:39], v[52:55]
v_mfma_f32_16x16x32_bf16 v[56:59], a[212:215], v[36:39], v[56:59]
v_mfma_f32_16x16x32_bf16 v[60:63], a[208:211], v[40:43], v[60:63]
v_mfma_f32_16x16x32_bf16 v[64:67], a[212:215], v[40:43], v[64:67]
v_mfma_f32_16x16x32_bf16 v[52:55], a[216:219], v[44:47], v[52:55]
v_mfma_f32_16x16x32_bf16 v[56:59], a[220:223], v[44:47], v[56:59]
v_mfma_f32_16x16x32_bf16 v[60:63], a[216:219], v[48:51], v[60:63]
v_mfma_f32_16x16x32_bf16 v[64:67], a[220:223], v[48:51], v[64:67]
s_waitcnt vmcnt(0)
ds_read_b64_tr_b16 a[224:225], v17 offset:8192
ds_read_b64_tr_b16 a[226:227], v17 offset:8448
ds_read_b64_tr_b16 a[228:229], v17 offset:8200
ds_read_b64_tr_b16 a[230:231], v17 offset:8456
ds_read_b64_tr_b16 a[232:233], v17 offset:10240
ds_read_b64_tr_b16 a[234:235], v17 offset:10496
ds_read_b64_tr_b16 a[236:237], v17 offset:10248
ds_read_b64_tr_b16 a[238:239], v17 offset:10504
s_waitcnt lgkmcnt(0)
ds_read_b64_tr_b16 a[240:241], v17 offset:12288
ds_read_b64_tr_b16 a[242:243], v17 offset:12544
ds_read_b64_tr_b16 a[244:245], v17 offset:12296
ds_read_b64_tr_b16 a[246:247], v17 offset:12552
ds_read_b64_tr_b16 a[248:249], v17 offset:14336
ds_read_b64_tr_b16 a[250:251], v17 offset:14592
ds_read_b64_tr_b16 a[252:253], v17 offset:14344
ds_read_b64_tr_b16 a[254:255], v17 offset:14600
s_waitcnt lgkmcnt(0)
ds_read_b128 v[20:23], v8 offset:57344
ds_read_b128 v[24:27], v8 offset:59392
ds_read_b128 v[28:31], v9 offset:57344
ds_read_b128 v[32:35], v9 offset:59392
ds_read_b128 v[36:39], v8 offset:61440
ds_read_b128 v[40:43], v8 offset:63488
ds_read_b128 v[44:47], v9 offset:61440
ds_read_b128 v[48:51], v9 offset:63488
s_waitcnt lgkmcnt(0)
v_mfma_f32_16x16x32_bf16 v[52:55], a[224:227], v[20:23], v[52:55]
v_mfma_f32_16x16x32_bf16 v[56:59], a[228:231], v[20:23], v[56:59]
v_mfma_f32_16x16x32_bf16 v[60:63], a[224:227], v[24:27], v[60:63]
v_mfma_f32_16x16x32_bf16 v[64:67], a[228:231], v[24:27], v[64:67]
v_mfma_f32_16x16x32_bf16 v[52:55], a[232:235], v[28:31], v[52:55]
v_mfma_f32_16x16x32_bf16 v[56:59], a[236:239], v[28:31], v[56:59]
v_mfma_f32_16x16x32_bf16 v[60:63], a[232:235], v[32:35], v[60:63]
v_mfma_f32_16x16x32_bf16 v[64:67], a[236:239], v[32:35], v[64:67]
v_mfma_f32_16x16x32_bf16 v[52:55], a[240:243], v[36:39], v[52:55]
v_mfma_f32_16x16x32_bf16 v[56:59], a[244:247], v[36:39], v[56:59]
v_mfma_f32_16x16x32_bf16 v[60:63], a[240:243], v[40:43], v[60:63]
v_mfma_f32_16x16x32_bf16 v[64:67], a[244:247], v[40:43], v[64:67]
v_mfma_f32_16x16x32_bf16 v[52:55], a[248:251], v[44:47], v[52:55]
v_mfma_f32_16x16x32_bf16 v[56:59], a[252:255], v[44:47], v[56:59]
v_mfma_f32_16x16x32_bf16 v[60:63], a[248:251], v[48:51], v[60:63]
v_mfma_f32_16x16x32_bf16 v[64:67], a[252:255], v[48:51], v[64:67]
s_barrier
s_mov_b32 s50, 0x10000
s_add_u32 m0, s46, 65536
s_nop 0
buffer_load_dwordx4 v6, s[8:11], s50 offen offset:0 lds
s_add_u32 m0, s46, 69504
s_nop 0
buffer_load_dwordx4 v6, s[8:11], s50 offen offset:128 lds
s_add_u32 m0, s46, 73472
s_nop 0
buffer_load_dwordx4 v6, s[8:11], s50 offen offset:256 lds
s_add_u32 m0, s46, 77440
s_nop 0
buffer_load_dwordx4 v6, s[8:11], s50 offen offset:384 lds
s_add_u32 m0, s46, 81408
s_nop 0
buffer_load_dwordx4 v6, s[8:11], s50 offen offset:512 lds
s_add_u32 m0, s46, 85376
s_nop 0
buffer_load_dwordx4 v6, s[8:11], s50 offen offset:640 lds
s_add_u32 m0, s46, 89344
s_nop 0
buffer_load_dwordx4 v6, s[8:11], s50 offen offset:768 lds
s_add_u32 m0, s46, 93312
s_nop 0
buffer_load_dwordx4 v6, s[8:11], s50 offen offset:896 lds
s_add_u32 m0, s46, 97280
s_nop 0
buffer_load_dwordx4 v6, s[8:11], s50 offen offset:1024 lds
s_add_u32 m0, s46, 101248
s_nop 0
buffer_load_dwordx4 v6, s[8:11], s50 offen offset:1152 lds
s_add_u32 m0, s46, 105216
s_nop 0
buffer_load_dwordx4 v6, s[8:11], s50 offen offset:1280 lds
s_add_u32 m0, s46, 109184
s_nop 0
buffer_load_dwordx4 v6, s[8:11], s50 offen offset:1408 lds
s_add_u32 m0, s46, 113152
s_nop 0
buffer_load_dwordx4 v6, s[8:11], s50 offen offset:1536 lds
s_add_u32 m0, s46, 117120
s_nop 0
buffer_load_dwordx4 v6, s[8:11], s50 offen offset:1664 lds
s_add_u32 m0, s46, 121088
s_nop 0
buffer_load_dwordx4 v6, s[8:11], s50 offen offset:1792 lds
s_add_u32 m0, s46, 125056
s_nop 0
buffer_load_dwordx4 v6, s[8:11], s50 offen offset:1920 lds
s_and_b32 s53, s47, 31
s_lshl_b32 s53, s53, 4
v_add_u32 v19, s53, v1
v_lshlrev_b32 v19, 7, v19
s_mov_b32 s42, 1
v_and_b32 v3, 15, v0
v_lshlrev_b32 v3, 4, v3
s_branch mega_kernel_syk
mega_kernel_sykw:
s_sleep 4
mega_kernel_syk:
buffer_load_dword v2, v3, s[72:75], 0 offen sc1
s_waitcnt vmcnt(0)
mega_kernel_sykp:
s_cmp_eq_u32 s95, 1
s_cbranch_scc0 mega_kernel_sykf
v_readlane_b32 s76, v2, 14
s_mov_b32 s98, 0
s_cmp_eq_u32 s76, 32
s_cbranch_scc0 mega_kernel_sykw
s_branch mega_kernel_sykd
mega_kernel_sykf:
s_mov_b32 s77, 0
s_mov_b32 s78, 0
v_readlane_b32 s76, v2, 0
s_add_u32 s77, s77, s76
s_xor_b32 s76, s76, 32
s_or_b32 s78, s78, s76
v_readlane_b32 s76, v2, 1
s_add_u32 s77, s77, s76
s_xor_b32 s76, s76, 32
s_or_b32 s78, s78, s76
v_readlane_b32 s76, v2, 2
s_add_u32 s77, s77, s76
s_xor_b32 s76, s76, 32
s_or_b32 s78, s78, s76
v_readlane_b32 s76, v2, 3
s_add_u32 s77, s77, s76
s_xor_b32 s76, s76, 32
s_or_b32 s78, s78, s76
v_readlane_b32 s76, v2, 4
s_add_u32 s77, s77, s76
s_xor_b32 s76, s76, 32
s_or_b32 s78, s78, s76
v_readlane_b32 s76, v2, 5
s_add_u32 s77, s77, s76
s_xor_b32 s76, s76, 32
s_or_b32 s78, s78, s76
v_readlane_b32 s76, v2, 6
s_add_u32 s77, s77, s76
s_xor_b32 s76, s76, 32
s_or_b32 s78, s78, s76
v_readlane_b32 s76, v2, 7
s_add_u32 s77, s77, s76
s_xor_b32 s76, s76, 32
s_or_b32 s78, s78, s76
s_cmp_eq_u32 s77, 256
s_cbranch_scc0 mega_kernel_sykw
v_mov_b32 v252, v2
s_cmp_eq_u32 s78, 0
s_cbranch_scc0 mega_kernel_slowent
v_readlane_b32 s76, v2, 10
v_readlane_b32 s77, v2, 8
s_cmp_eq_u32 s76, 32
s_cbranch_scc0 mega_kernel_sykw
s_cmp_gt_u32 s77, 16
s_cselect_b32 s98, 1, 0
mega_kernel_sykd:
s_lshr_b32 s44, s47, 3
s_xor_b32 s44, s44, s98
s_and_b32 s44, s44, 1
s_lshl_b32 s44, s44, 13
s_lshl_b32 s48, s47, 18
s_add_u32 s48, s48, s44
s_add_u32 s48, s48, 0
s_xor_b32 s44, s98, 1
s_lshl_b32 s44, s44, 13
s_lshl_b32 s49, s40, 7
s_add_u32 s49, s49, s44
s_lshl_b32 s44, s41, 2
s_add_u32 s49, s49, s44
s_add_u32 s49, s49, 69206016
v_mov_b32 v16, 0
v_cvt_pk_bf16_f32 v84, v52, v53
v_cvt_pk_bf16_f32 v85, v54, v55
v_cvt_pk_bf16_f32 v86, v56, v57
v_cvt_pk_bf16_f32 v87, v58, v59
v_cvt_pk_bf16_f32 v88, v60, v61
v_cvt_pk_bf16_f32 v89, v62, v63
v_cvt_pk_bf16_f32 v90, v64, v65
v_cvt_pk_bf16_f32 v91, v66, v67
s_add_u32 s51, s42, s47
s_sub_u32 s51, s51, 1
s_bfe_u32 s52, s51, 0x40002
s_lshl_b32 s52, s52, 14
s_and_b32 s51, s51, 3
s_lshl_b32 s51, s51, 11
s_add_u32 s51, s51, s52
s_add_u32 s51, s51, s48
buffer_store_dwordx4 v[84:87], v7, s[84:87], s51 offen sc1
buffer_store_dwordx4 v[88:91], v7, s[84:87], s51 offen offset:1024 sc1
s_waitcnt vmcnt(0)
v_mov_b32 v17, s42
s_mov_b64 exec, 1
buffer_store_dword v17, v16, s[84:87], s49 offen sc1
s_mov_b64 exec, -1
mega_kernel_k_loop:
s_waitcnt vmcnt(2)
s_barrier
s_add_u32 s50, s42, 1
s_min_u32 s50, s50, 63
s_lshl_b32 s50, s50, 16
ds_read_b128 v[20:23], v10 offset:0
ds_read_b128 v[24:27], v10 offset:2048
ds_read_b128 v[28:31], v11 offset:0
ds_read_b128 v[32:35], v11 offset:2048
ds_read_b128 v[36:39], v10 offset:4096
ds_read_b128 v[40:43], v10 offset:6144
s_waitcnt lgkmcnt(4)
v_mfma_f32_16x16x32_bf16 v[68:71], a[0:3], v[20:23], 0
ds_read_b128 v[44:47], v11 offset:4096
v_mfma_f32_16x16x32_bf16 v[72:75], a[4:7], v[20:23], 0
v_cvt_pk_bf16_f32 v84, v52, v53
v_cvt_pk_bf16_f32 v85, v54, v55
v_cvt_pk_bf16_f32 v86, v56, v57
v_mfma_f32_16x16x32_bf16 v[76:79], a[0:3], v[24:27], 0
ds_read_b128 v[48:51], v11 offset:6144
v_mfma_f32_16x16x32_bf16 v[80:83], a[4:7], v[24:27], 0
v_cvt_pk_bf16_f32 v87, v58, v59
v_cvt_pk_bf16_f32 v88, v60, v61
v_cvt_pk_bf16_f32 v89, v62, v63
s_waitcnt lgkmcnt(4)
v_mfma_f32_16x16x32_bf16 v[68:71], a[8:11], v[28:31], v[68:71]
ds_read_b128 v[20:23], v10 offset:8192
v_mfma_f32_16x16x32_bf16 v[72:75], a[12:15], v[28:31], v[72:75]
v_cvt_pk_bf16_f32 v90, v64, v65
v_cvt_pk_bf16_f32 v91, v66, v67
v_mfma_f32_16x16x32_bf16 v[76:79], a[8:11], v[32:35], v[76:79]
ds_read_b128 v[24:27], v10 offset:10240
v_mfma_f32_16x16x32_bf16 v[80:83], a[12:15], v[32:35], v[80:83]
s_add_u32 s51, s42, s47
s_sub_u32 s51, s51, 1
s_bfe_u32 s52, s51, 0x40002
s_lshl_b32 s52, s52, 14
s_waitcnt lgkmcnt(4)
v_mfma_f32_16x16x32_bf16 v[68:71], a[16:19], v[36:39], v[68:71]
ds_read_b128 v[28:31], v11 offset:8192
v_mfma_f32_16x16x32_bf16 v[72:75], a[20:23], v[36:39], v[72:75]
s_and_b32 s51, s51, 3
s_lshl_b32 s51, s51, 11
s_add_u32 s51, s51, s52
s_add_u32 s51, s51, s48
buffer_store_dwordx4 v[84:87], v7, s[84:87], s51 offen sc1
v_mfma_f32_16x16x32_bf16 v[76:79], a[16:19], v[40:43], v[76:79]
ds_read_b128 v[32:35], v11 offset:10240
v_mfma_f32_16x16x32_bf16 v[80:83], a[20:23], v[40:43], v[80:83]
buffer_store_dwordx4 v[88:91], v7, s[84:87], s51 offen offset:1024 sc1
s_waitcnt lgkmcnt(4)
v_mfma_f32_16x16x32_bf16 v[68:71], a[24:27], v[44:47], v[68:71]
ds_read_b128 v[36:39], v10 offset:12288
v_mfma_f32_16x16x32_bf16 v[72:75], a[28:31], v[44:47], v[72:75]
s_add_u32 m0, s46, 0
v_mfma_f32_16x16x32_bf16 v[76:79], a[24:27], v[48:51], v[76:79]
ds_read_b128 v[40:43], v10 offset:14336
v_mfma_f32_16x16x32_bf16 v[80:83], a[28:31], v[48:51], v[80:83]
buffer_load_dwordx4 v6, s[8:11], s50 offen offset:0 lds
s_waitcnt lgkmcnt(4)
v_mfma_f32_16x16x32_bf16 v[68:71], a[32:35], v[20:23], v[68:71]
ds_read_b128 v[44:47], v11 offset:12288
v_mfma_f32_16x16x32_bf16 v[72:75], a[36:39], v[20:23], v[72:75]
s_add_u32 m0, s46, 3968
v_mfma_f32_16x16x32_bf16 v[76:79], a[32:35], v[24:27], v[76:79]
ds_read_b128 v[48:51], v11 offset:14336
v_mfma_f32_16x16x32_bf16 v[80:83], a[36:39], v[24:27], v[80:83]
buffer_load_dwordx4 v6, s[8:11], s50 offen offset:128 lds
s_waitcnt lgkmcnt(4)
v_mfma_f32_16x16x32_bf16 v[68:71], a[40:43], v[28:31], v[68:71]
ds_read_b128 v[20:23], v10 offset:16384
v_mfma_f32_16x16x32_bf16 v[72:75], a[44:47], v[28:31], v[72:75]
s_add_u32 m0, s46, 7936
v_mfma_f32_16x16x32_bf16 v[76:79], a[40:43], v[32:35], v[76:79]
ds_read_b128 v[24:27], v10 offset:18432
v_mfma_f32_16x16x32_bf16 v[80:83], a[44:47], v[32:35], v[80:83]
buffer_load_dwordx4 v6, s[8:11], s50 offen offset:256 lds
s_waitcnt lgkmcnt(4)
v_mfma_f32_16x16x32_bf16 v[68:71], a[48:51], v[36:39], v[68:71]
ds_read_b128 v[28:31], v11 offset:16384
v_mfma_f32_16x16x32_bf16 v[72:75], a[52:55], v[36:39], v[72:75]
s_add_u32 m0, s46, 11904
v_mfma_f32_16x16x32_bf16 v[76:79], a[48:51], v[40:43], v[76:79]
ds_read_b128 v[32:35], v11 offset:18432
v_mfma_f32_16x16x32_bf16 v[80:83], a[52:55], v[40:43], v[80:83]
buffer_load_dwordx4 v6, s[8:11], s50 offen offset:384 lds
s_waitcnt lgkmcnt(4)
v_mfma_f32_16x16x32_bf16 v[68:71], a[56:59], v[44:47], v[68:71]
ds_read_b128 v[36:39], v10 offset:20480
v_mfma_f32_16x16x32_bf16 v[72:75], a[60:63], v[44:47], v[72:75]
s_add_u32 m0, s46, 15872
v_mfma_f32_16x16x32_bf16 v[76:79], a[56:59], v[48:51], v[76:79]
ds_read_b128 v[40:43], v10 offset:22528
v_mfma_f32_16x16x32_bf16 v[80:83], a[60:63], v[48:51], v[80:83]
buffer_load_dwordx4 v6, s[8:11], s50 offen offset:512 lds
s_waitcnt lgkmcnt(4)
v_mfma_f32_16x16x32_bf16 v[68:71], a[64:67], v[20:23], v[68:71]
ds_read_b128 v[44:47], v11 offset:20480
v_mfma_f32_16x16x32_bf16 v[72:75], a[68:71], v[20:23], v[72:75]
s_add_u32 m0, s46, 19840
v_mfma_f32_16x16x32_bf16 v[76:79], a[64:67], v[24:27], v[76:79]
ds_read_b128 v[48:51], v11 offset:22528
v_mfma_f32_16x16x32_bf16 v[80:83], a[68:71], v[24:27], v[80:83]
buffer_load_dwordx4 v6, s[8:11], s50 offen offset:640 lds
s_waitcnt lgkmcnt(4)
v_mfma_f32_16x16x32_bf16 v[68:71], a[72:75], v[28:31], v[68:71]
ds_read_b128 v[20:23], v10 offset:24576
v_mfma_f32_16x16x32_bf16 v[72:75], a[76:79], v[28:31], v[72:75]
s_add_u32 m0, s46, 23808
v_mfma_f32_16x16x32_bf16 v[76:79], a[72:75], v[32:35], v[76:79]
ds_read_b128 v[24:27], v10 offset:26624
v_mfma_f32_16x16x32_bf16 v[80:83], a[76:79], v[32:35], v[80:83]
buffer_load_dwordx4 v6, s[8:11], s50 offen offset:768 lds
s_waitcnt lgkmcnt(4)
v_mfma_f32_16x16x32_bf16 v[68:71], a[80:83], v[36:39], v[68:71]
ds_read_b128 v[28:31], v11 offset:24576
v_mfma_f32_16x16x32_bf16 v[72:75], a[84:87], v[36:39], v[72:75]
s_add_u32 m0, s46, 27776
v_mfma_f32_16x16x32_bf16 v[76:79], a[80:83], v[40:43], v[76:79]
ds_read_b128 v[32:35], v11 offset:26624
v_mfma_f32_16x16x32_bf16 v[80:83], a[84:87], v[40:43], v[80:83]
buffer_load_dwordx4 v6, s[8:11], s50 offen offset:896 lds
s_waitcnt lgkmcnt(4)
v_mfma_f32_16x16x32_bf16 v[68:71], a[88:91], v[44:47], v[68:71]
ds_read_b128 v[36:39], v10 offset:28672
v_mfma_f32_16x16x32_bf16 v[72:75], a[92:95], v[44:47], v[72:75]
s_add_u32 m0, s46, 31744
v_mfma_f32_16x16x32_bf16 v[76:79], a[88:91], v[48:51], v[76:79]
ds_read_b128 v[40:43], v10 offset:30720
v_mfma_f32_16x16x32_bf16 v[80:83], a[92:95], v[48:51], v[80:83]
buffer_load_dwordx4 v6, s[8:11], s50 offen offset:1024 lds
s_waitcnt lgkmcnt(4)
v_mfma_f32_16x16x32_bf16 v[68:71], a[96:99], v[20:23], v[68:71]
ds_read_b128 v[44:47], v11 offset:28672
v_mfma_f32_16x16x32_bf16 v[72:75], a[100:103], v[20:23], v[72:75]
s_add_u32 m0, s46, 35712
v_mfma_f32_16x16x32_bf16 v[76:79], a[96:99], v[24:27], v[76:79]
ds_read_b128 v[48:51], v11 offset:30720
v_mfma_f32_16x16x32_bf16 v[80:83], a[100:103], v[24:27], v[80:83]
buffer_load_dwordx4 v6, s[8:11], s50 offen offset:1152 lds
s_waitcnt lgkmcnt(4)
v_mfma_f32_16x16x32_bf16 v[68:71], a[104:107], v[28:31], v[68:71]
ds_read_b128 v[20:23], v10 offset:32768
v_mfma_f32_16x16x32_bf16 v[72:75], a[108:111], v[28:31], v[72:75]
s_add_u32 m0, s46, 39680
v_mfma_f32_16x16x32_bf16 v[76:79], a[104:107], v[32:35], v[76:79]
ds_read_b128 v[24:27], v10 offset:34816
v_mfma_f32_16x16x32_bf16 v[80:83], a[108:111], v[32:35], v[80:83]
buffer_load_dwordx4 v6, s[8:11], s50 offen offset:1280 lds
s_waitcnt lgkmcnt(4)
v_mfma_f32_16x16x32_bf16 v[68:71], a[112:115], v[36:39], v[68:71]
ds_read_b128 v[28:31], v11 offset:32768
v_mfma_f32_16x16x32_bf16 v[72:75], a[116:119], v[36:39], v[72:75]
s_add_u32 m0, s46, 43648
v_mfma_f32_16x16x32_bf16 v[76:79], a[112:115], v[40:43], v[76:79]
ds_read_b128 v[32:35], v11 offset:34816
v_mfma_f32_16x16x32_bf16 v[80:83], a[116:119], v[40:43], v[80:83]
buffer_load_dwordx4 v6, s[8:11], s50 offen offset:1408 lds
s_waitcnt lgkmcnt(4)
v_mfma_f32_16x16x32_bf16 v[68:71], a[120:123], v[44:47], v[68:71]
ds_read_b128 v[36:39], v10 offset:36864
v_mfma_f32_16x16x32_bf16 v[72:75], a[124:127], v[44:47], v[72:75]
s_add_u32 m0, s46, 47616
v_mfma_f32_16x16x32_bf16 v[76:79], a[120:123], v[48:51], v[76:79]
ds_read_b128 v[40:43], v10 offset:38912
v_mfma_f32_16x16x32_bf16 v[80:83], a[124:127], v[48:51], v[80:83]
buffer_load_dwordx4 v6, s[8:11], s50 offen offset:1536 lds
s_waitcnt lgkmcnt(4)
v_mfma_f32_16x16x32_bf16 v[68:71], a[128:131], v[20:23], v[68:71]
ds_read_b128 v[44:47], v11 offset:36864
v_mfma_f32_16x16x32_bf16 v[72:75], a[132:135], v[20:23], v[72:75]
s_add_u32 m0, s46, 51584
v_mfma_f32_16x16x32_bf16 v[76:79], a[128:131], v[24:27], v[76:79]
ds_read_b128 v[48:51], v11 offset:38912
v_mfma_f32_16x16x32_bf16 v[80:83], a[132:135], v[24:27], v[80:83]
buffer_load_dwordx4 v6, s[8:11], s50 offen offset:1664 lds
s_waitcnt lgkmcnt(4)
v_mfma_f32_16x16x32_bf16 v[68:71], a[136:139], v[28:31], v[68:71]
ds_read_b128 v[20:23], v10 offset:40960
v_mfma_f32_16x16x32_bf16 v[72:75], a[140:143], v[28:31], v[72:75]
s_add_u32 m0, s46, 55552
v_mfma_f32_16x16x32_bf16 v[76:79], a[136:139], v[32:35], v[76:79]
ds_read_b128 v[24:27], v10 offset:43008
v_mfma_f32_16x16x32_bf16 v[80:83], a[140:143], v[32:35], v[80:83]
buffer_load_dwordx4 v6, s[8:11], s50 offen offset:1792 lds
s_waitcnt lgkmcnt(4)
v_mfma_f32_16x16x32_bf16 v[68:71], a[144:147], v[36:39], v[68:71]
ds_read_b128 v[28:31], v11 offset:40960
v_mfma_f32_16x16x32_bf16 v[72:75], a[148:151], v[36:39], v[72:75]
s_add_u32 m0, s46, 59520
v_mfma_f32_16x16x32_bf16 v[76:79], a[144:147], v[40:43], v[76:79]
ds_read_b128 v[32:35], v11 offset:43008
v_mfma_f32_16x16x32_bf16 v[80:83], a[148:151], v[40:43], v[80:83]
buffer_load_dwordx4 v6, s[8:11], s50 offen offset:1920 lds
s_waitcnt lgkmcnt(4)
v_mfma_f32_16x16x32_bf16 v[68:71], a[152:155], v[44:47], v[68:71]
ds_read_b128 v[36:39], v10 offset:45056
v_mfma_f32_16x16x32_bf16 v[72:75], a[156:159], v[44:47], v[72:75]
v_mfma_f32_16x16x32_bf16 v[76:79], a[152:155], v[48:51], v[76:79]
ds_read_b128 v[40:43], v10 offset:47104
v_mfma_f32_16x16x32_bf16 v[80:83], a[156:159], v[48:51], v[80:83]
s_waitcnt lgkmcnt(4)
v_mfma_f32_16x16x32_bf16 v[68:71], a[160:163], v[20:23], v[68:71]
ds_read_b128 v[44:47], v11 offset:45056
v_mfma_f32_16x16x32_bf16 v[72:75], a[164:167], v[20:23], v[72:75]
v_mfma_f32_16x16x32_bf16 v[76:79], a[160:163], v[24:27], v[76:79]
ds_read_b128 v[48:51], v11 offset:47104
v_mfma_f32_16x16x32_bf16 v[80:83], a[164:167], v[24:27], v[80:83]
s_waitcnt lgkmcnt(4)
v_mfma_f32_16x16x32_bf16 v[68:71], a[168:171], v[28:31], v[68:71]
ds_read_b128 v[20:23], v10 offset:49152
v_mfma_f32_16x16x32_bf16 v[72:75], a[172:175], v[28:31], v[72:75]
s_waitcnt vmcnt(16)
v_mov_b32 v17, s42
s_mov_b64 exec, 1
buffer_store_dword v17, v16, s[84:87], s49 offen sc1
s_mov_b64 exec, -1
v_mfma_f32_16x16x32_bf16 v[76:79], a[168:171], v[32:35], v[76:79]
ds_read_b128 v[24:27], v10 offset:51200
v_mfma_f32_16x16x32_bf16 v[80:83], a[172:175], v[32:35], v[80:83]
s_waitcnt lgkmcnt(4)
v_mfma_f32_16x16x32_bf16 v[68:71], a[176:179], v[36:39], v[68:71]
ds_read_b128 v[28:31], v11 offset:49152
v_mfma_f32_16x16x32_bf16 v[72:75], a[180:183], v[36:39], v[72:75]
s_add_u32 s53, s42, 3
s_min_u32 s53, s53, 63
s_lshl_b32 s53, s53, 16
s_mov_b64 exec, 0xffff
buffer_load_dword v250, v19, s[8:11], s53 offen
s_mov_b64 exec, -1
v_mfma_f32_16x16x32_bf16 v[76:79], a[176:179], v[40:43], v[76:79]
ds_read_b128 v[32:35], v11 offset:51200
v_mfma_f32_16x16x32_bf16 v[80:83], a[180:183], v[40:43], v[80:83]
s_waitcnt lgkmcnt(4)
v_mfma_f32_16x16x32_bf16 v[68:71], a[184:187], v[44:47], v[68:71]
ds_read_b128 v[36:39], v10 offset:53248
v_mfma_f32_16x16x32_bf16 v[72:75], a[188:191], v[44:47], v[72:75]
v_mfma_f32_16x16x32_bf16 v[76:79], a[184:187], v[48:51], v[76:79]
ds_read_b128 v[40:43], v10 offset:55296
v_mfma_f32_16x16x32_bf16 v[80:83], a[188:191], v[48:51], v[80:83]
s_waitcnt lgkmcnt(4)
v_mfma_f32_16x16x32_bf16 v[68:71], a[192:195], v[20:23], v[68:71]
ds_read_b128 v[44:47], v11 offset:53248
v_mfma_f32_16x16x32_bf16 v[72:75], a[196:199], v[20:23], v[72:75]
v_mfma_f32_16x16x32_bf16 v[76:79], a[192:195], v[24:27], v[76:79]
ds_read_b128 v[48:51], v11 offset:55296
v_mfma_f32_16x16x32_bf16 v[80:83], a[196:199], v[24:27], v[80:83]
s_waitcnt lgkmcnt(4)
v_mfma_f32_16x16x32_bf16 v[68:71], a[200:203], v[28:31], v[68:71]
ds_read_b128 v[20:23], v10 offset:57344
v_mfma_f32_16x16x32_bf16 v[72:75], a[204:207], v[28:31], v[72:75]
v_mfma_f32_16x16x32_bf16 v[76:79], a[200:203], v[32:35], v[76:79]
ds_read_b128 v[24:27], v10 offset:59392
v_mfma_f32_16x16x32_bf16 v[80:83], a[204:207], v[32:35], v[80:83]
s_waitcnt lgkmcnt(4)
v_mfma_f32_16x16x32_bf16 v[68:71], a[208:211], v[36:39], v[68:71]
ds_read_b128 v[28:31], v11 offset:57344
v_mfma_f32_16x16x32_bf16 v[72:75], a[212:215], v[36:39], v[72:75]
v_mfma_f32_16x16x32_bf16 v[76:79], a[208:211], v[40:43], v[76:79]
ds_read_b128 v[32:35], v11 offset:59392
v_mfma_f32_16x16x32_bf16 v[80:83], a[212:215], v[40:43], v[80:83]
s_waitcnt lgkmcnt(4)
v_mfma_f32_16x16x32_bf16 v[68:71], a[216:219], v[44:47], v[68:71]
ds_read_b128 v[36:39], v10 offset:61440
v_mfma_f32_16x16x32_bf16 v[72:75], a[220:223], v[44:47], v[72:75]
v_mfma_f32_16x16x32_bf16 v[76:79], a[216:219], v[48:51], v[76:79]
ds_read_b128 v[40:43], v10 offset:63488
v_mfma_f32_16x16x32_bf16 v[80:83], a[220:223], v[48:51], v[80:83]
s_waitcnt lgkmcnt(4)
v_mfma_f32_16x16x32_bf16 v[68:71], a[224:227], v[20:23], v[68:71]
ds_read_b128 v[44:47], v11 offset:61440
v_mfma_f32_16x16x32_bf16 v[72:75], a[228:231], v[20:23], v[72:75]
v_mfma_f32_16x16x32_bf16 v[76:79], a[224:227], v[24:27], v[76:79]
ds_read_b128 v[48:51], v11 offset:63488
v_mfma_f32_16x16x32_bf16 v[80:83], a[228:231], v[24:27], v[80:83]
s_waitcnt lgkmcnt(5)
v_mfma_f32_16x16x32_bf16 v[68:71], a[232:235], v[28:31], v[68:71]
v_mfma_f32_16x16x32_bf16 v[72:75], a[236:239], v[28:31], v[72:75]
s_waitcnt lgkmcnt(4)
v_mfma_f32_16x16x32_bf16 v[76:79], a[232:235], v[32:35], v[76:79]
v_mfma_f32_16x16x32_bf16 v[80:83], a[236:239], v[32:35], v[80:83]
s_waitcnt lgkmcnt(3)
v_mfma_f32_16x16x32_bf16 v[68:71], a[240:243], v[36:39], v[68:71]
v_mfma_f32_16x16x32_bf16 v[72:75], a[244:247], v[36:39], v[72:75]
s_waitcnt lgkmcnt(2)
v_mfma_f32_16x16x32_bf16 v[76:79], a[240:243], v[40:43], v[76:79]
v_mfma_f32_16x16x32_bf16 v[80:83], a[244:247], v[40:43], v[80:83]
s_waitcnt lgkmcnt(1)
v_mfma_f32_16x16x32_bf16 v[68:71], a[248:251], v[44:47], v[68:71]
v_mfma_f32_16x16x32_bf16 v[72:75], a[252:255], v[44:47], v[72:75]
s_waitcnt lgkmcnt(0)
v_mfma_f32_16x16x32_bf16 v[76:79], a[248:251], v[48:51], v[76:79]
v_mfma_f32_16x16x32_bf16 v[80:83], a[252:255], v[48:51], v[80:83]
s_add_u32 s42, s42, 1
s_cmp_eq_u32 s42, 64
s_cbranch_scc1 mega_kernel_k_fin
mega_kernel_k_mid:
s_waitcnt vmcnt(2)
s_barrier
s_add_u32 s50, s42, 1
s_min_u32 s50, s50, 63
s_lshl_b32 s50, s50, 16
ds_read_b128 v[20:23], v8 offset:0
ds_read_b128 v[24:27], v8 offset:2048
ds_read_b128 v[28:31], v9 offset:0
ds_read_b128 v[32:35], v9 offset:2048
ds_read_b128 v[36:39], v8 offset:4096
ds_read_b128 v[40:43], v8 offset:6144
s_waitcnt lgkmcnt(4)
v_mfma_f32_16x16x32_bf16 v[52:55], a[0:3], v[20:23], 0
ds_read_b128 v[44:47], v9 offset:4096
v_mfma_f32_16x16x32_bf16 v[56:59], a[4:7], v[20:23], 0
v_cvt_pk_bf16_f32 v84, v68, v69
v_cvt_pk_bf16_f32 v85, v70, v71
v_cvt_pk_bf16_f32 v86, v72, v73
v_mfma_f32_16x16x32_bf16 v[60:63], a[0:3], v[24:27], 0
ds_read_b128 v[48:51], v9 offset:6144
v_mfma_f32_16x16x32_bf16 v[64:67], a[4:7], v[24:27], 0
v_cvt_pk_bf16_f32 v87, v74, v75
v_cvt_pk_bf16_f32 v88, v76, v77
v_cvt_pk_bf16_f32 v89, v78, v79
s_waitcnt lgkmcnt(4)
v_mfma_f32_16x16x32_bf16 v[52:55], a[8:11], v[28:31], v[52:55]
ds_read_b128 v[20:23], v8 offset:8192
v_mfma_f32_16x16x32_bf16 v[56:59], a[12:15], v[28:31], v[56:59]
v_cvt_pk_bf16_f32 v90, v80, v81
v_cvt_pk_bf16_f32 v91, v82, v83
v_mfma_f32_16x16x32_bf16 v[60:63], a[8:11], v[32:35], v[60:63]
ds_read_b128 v[24:27], v8 offset:10240
v_mfma_f32_16x16x32_bf16 v[64:67], a[12:15], v[32:35], v[64:67]
s_add_u32 s51, s42, s47
s_sub_u32 s51, s51, 1
s_bfe_u32 s52, s51, 0x40002
s_lshl_b32 s52, s52, 14
s_waitcnt lgkmcnt(4)
v_mfma_f32_16x16x32_bf16 v[52:55], a[16:19], v[36:39], v[52:55]
ds_read_b128 v[28:31], v9 offset:8192
v_mfma_f32_16x16x32_bf16 v[56:59], a[20:23], v[36:39], v[56:59]
s_and_b32 s51, s51, 3
s_lshl_b32 s51, s51, 11
s_add_u32 s51, s51, s52
s_add_u32 s51, s51, s48
buffer_store_dwordx4 v[84:87], v7, s[84:87], s51 offen sc1
v_mfma_f32_16x16x32_bf16 v[60:63], a[16:19], v[40:43], v[60:63]
ds_read_b128 v[32:35], v9 offset:10240
v_mfma_f32_16x16x32_bf16 v[64:67], a[20:23], v[40:43], v[64:67]
buffer_store_dwordx4 v[88:91], v7, s[84:87], s51 offen offset:1024 sc1
s_waitcnt lgkmcnt(4)
v_mfma_f32_16x16x32_bf16 v[52:55], a[24:27], v[44:47], v[52:55]
ds_read_b128 v[36:39], v8 offset:12288
v_mfma_f32_16x16x32_bf16 v[56:59], a[28:31], v[44:47], v[56:59]
s_add_u32 m0, s46, 65536
v_mfma_f32_16x16x32_bf16 v[60:63], a[24:27], v[48:51], v[60:63]
ds_read_b128 v[40:43], v8 offset:14336
v_mfma_f32_16x16x32_bf16 v[64:67], a[28:31], v[48:51], v[64:67]
buffer_load_dwordx4 v6, s[8:11], s50 offen offset:0 lds
s_waitcnt lgkmcnt(4)
v_mfma_f32_16x16x32_bf16 v[52:55], a[32:35], v[20:23], v[52:55]
ds_read_b128 v[44:47], v9 offset:12288
v_mfma_f32_16x16x32_bf16 v[56:59], a[36:39], v[20:23], v[56:59]
s_add_u32 m0, s46, 69504
v_mfma_f32_16x16x32_bf16 v[60:63], a[32:35], v[24:27], v[60:63]
ds_read_b128 v[48:51], v9 offset:14336
v_mfma_f32_16x16x32_bf16 v[64:67], a[36:39], v[24:27], v[64:67]
buffer_load_dwordx4 v6, s[8:11], s50 offen offset:128 lds
s_waitcnt lgkmcnt(4)
v_mfma_f32_16x16x32_bf16 v[52:55], a[40:43], v[28:31], v[52:55]
ds_read_b128 v[20:23], v8 offset:16384
v_mfma_f32_16x16x32_bf16 v[56:59], a[44:47], v[28:31], v[56:59]
s_add_u32 m0, s46, 73472
v_mfma_f32_16x16x32_bf16 v[60:63], a[40:43], v[32:35], v[60:63]
ds_read_b128 v[24:27], v8 offset:18432
v_mfma_f32_16x16x32_bf16 v[64:67], a[44:47], v[32:35], v[64:67]
buffer_load_dwordx4 v6, s[8:11], s50 offen offset:256 lds
s_waitcnt lgkmcnt(4)
v_mfma_f32_16x16x32_bf16 v[52:55], a[48:51], v[36:39], v[52:55]
ds_read_b128 v[28:31], v9 offset:16384
v_mfma_f32_16x16x32_bf16 v[56:59], a[52:55], v[36:39], v[56:59]
s_add_u32 m0, s46, 77440
v_mfma_f32_16x16x32_bf16 v[60:63], a[48:51], v[40:43], v[60:63]
ds_read_b128 v[32:35], v9 offset:18432
v_mfma_f32_16x16x32_bf16 v[64:67], a[52:55], v[40:43], v[64:67]
buffer_load_dwordx4 v6, s[8:11], s50 offen offset:384 lds
s_waitcnt lgkmcnt(4)
v_mfma_f32_16x16x32_bf16 v[52:55], a[56:59], v[44:47], v[52:55]
ds_read_b128 v[36:39], v8 offset:20480
v_mfma_f32_16x16x32_bf16 v[56:59], a[60:63], v[44:47], v[56:59]
s_add_u32 m0, s46, 81408
v_mfma_f32_16x16x32_bf16 v[60:63], a[56:59], v[48:51], v[60:63]
ds_read_b128 v[40:43], v8 offset:22528
v_mfma_f32_16x16x32_bf16 v[64:67], a[60:63], v[48:51], v[64:67]
buffer_load_dwordx4 v6, s[8:11], s50 offen offset:512 lds
s_waitcnt lgkmcnt(4)
v_mfma_f32_16x16x32_bf16 v[52:55], a[64:67], v[20:23], v[52:55]
ds_read_b128 v[44:47], v9 offset:20480
v_mfma_f32_16x16x32_bf16 v[56:59], a[68:71], v[20:23], v[56:59]
s_add_u32 m0, s46, 85376
v_mfma_f32_16x16x32_bf16 v[60:63], a[64:67], v[24:27], v[60:63]
ds_read_b128 v[48:51], v9 offset:22528
v_mfma_f32_16x16x32_bf16 v[64:67], a[68:71], v[24:27], v[64:67]
buffer_load_dwordx4 v6, s[8:11], s50 offen offset:640 lds
s_waitcnt lgkmcnt(4)
v_mfma_f32_16x16x32_bf16 v[52:55], a[72:75], v[28:31], v[52:55]
ds_read_b128 v[20:23], v8 offset:24576
v_mfma_f32_16x16x32_bf16 v[56:59], a[76:79], v[28:31], v[56:59]
s_add_u32 m0, s46, 89344
v_mfma_f32_16x16x32_bf16 v[60:63], a[72:75], v[32:35], v[60:63]
ds_read_b128 v[24:27], v8 offset:26624
v_mfma_f32_16x16x32_bf16 v[64:67], a[76:79], v[32:35], v[64:67]
buffer_load_dwordx4 v6, s[8:11], s50 offen offset:768 lds
s_waitcnt lgkmcnt(4)
v_mfma_f32_16x16x32_bf16 v[52:55], a[80:83], v[36:39], v[52:55]
ds_read_b128 v[28:31], v9 offset:24576
v_mfma_f32_16x16x32_bf16 v[56:59], a[84:87], v[36:39], v[56:59]
s_add_u32 m0, s46, 93312
v_mfma_f32_16x16x32_bf16 v[60:63], a[80:83], v[40:43], v[60:63]
ds_read_b128 v[32:35], v9 offset:26624
v_mfma_f32_16x16x32_bf16 v[64:67], a[84:87], v[40:43], v[64:67]
buffer_load_dwordx4 v6, s[8:11], s50 offen offset:896 lds
s_waitcnt lgkmcnt(4)
v_mfma_f32_16x16x32_bf16 v[52:55], a[88:91], v[44:47], v[52:55]
ds_read_b128 v[36:39], v8 offset:28672
v_mfma_f32_16x16x32_bf16 v[56:59], a[92:95], v[44:47], v[56:59]
s_add_u32 m0, s46, 97280
v_mfma_f32_16x16x32_bf16 v[60:63], a[88:91], v[48:51], v[60:63]
ds_read_b128 v[40:43], v8 offset:30720
v_mfma_f32_16x16x32_bf16 v[64:67], a[92:95], v[48:51], v[64:67]
buffer_load_dwordx4 v6, s[8:11], s50 offen offset:1024 lds
s_waitcnt lgkmcnt(4)
v_mfma_f32_16x16x32_bf16 v[52:55], a[96:99], v[20:23], v[52:55]
ds_read_b128 v[44:47], v9 offset:28672
v_mfma_f32_16x16x32_bf16 v[56:59], a[100:103], v[20:23], v[56:59]
s_add_u32 m0, s46, 101248
v_mfma_f32_16x16x32_bf16 v[60:63], a[96:99], v[24:27], v[60:63]
ds_read_b128 v[48:51], v9 offset:30720
v_mfma_f32_16x16x32_bf16 v[64:67], a[100:103], v[24:27], v[64:67]
buffer_load_dwordx4 v6, s[8:11], s50 offen offset:1152 lds
s_waitcnt lgkmcnt(4)
v_mfma_f32_16x16x32_bf16 v[52:55], a[104:107], v[28:31], v[52:55]
ds_read_b128 v[20:23], v8 offset:32768
v_mfma_f32_16x16x32_bf16 v[56:59], a[108:111], v[28:31], v[56:59]
s_add_u32 m0, s46, 105216
v_mfma_f32_16x16x32_bf16 v[60:63], a[104:107], v[32:35], v[60:63]
ds_read_b128 v[24:27], v8 offset:34816
v_mfma_f32_16x16x32_bf16 v[64:67], a[108:111], v[32:35], v[64:67]
buffer_load_dwordx4 v6, s[8:11], s50 offen offset:1280 lds
s_waitcnt lgkmcnt(4)
v_mfma_f32_16x16x32_bf16 v[52:55], a[112:115], v[36:39], v[52:55]
ds_read_b128 v[28:31], v9 offset:32768
v_mfma_f32_16x16x32_bf16 v[56:59], a[116:119], v[36:39], v[56:59]
s_add_u32 m0, s46, 109184
v_mfma_f32_16x16x32_bf16 v[60:63], a[112:115], v[40:43], v[60:63]
ds_read_b128 v[32:35], v9 offset:34816
v_mfma_f32_16x16x32_bf16 v[64:67], a[116:119], v[40:43], v[64:67]
buffer_load_dwordx4 v6, s[8:11], s50 offen offset:1408 lds
s_waitcnt lgkmcnt(4)
v_mfma_f32_16x16x32_bf16 v[52:55], a[120:123], v[44:47], v[52:55]
ds_read_b128 v[36:39], v8 offset:36864
v_mfma_f32_16x16x32_bf16 v[56:59], a[124:127], v[44:47], v[56:59]
s_add_u32 m0, s46, 113152
v_mfma_f32_16x16x32_bf16 v[60:63], a[120:123], v[48:51], v[60:63]
ds_read_b128 v[40:43], v8 offset:38912
v_mfma_f32_16x16x32_bf16 v[64:67], a[124:127], v[48:51], v[64:67]
buffer_load_dwordx4 v6, s[8:11], s50 offen offset:1536 lds
s_waitcnt lgkmcnt(4)
v_mfma_f32_16x16x32_bf16 v[52:55], a[128:131], v[20:23], v[52:55]
ds_read_b128 v[44:47], v9 offset:36864
v_mfma_f32_16x16x32_bf16 v[56:59], a[132:135], v[20:23], v[56:59]
s_add_u32 m0, s46, 117120
v_mfma_f32_16x16x32_bf16 v[60:63], a[128:131], v[24:27], v[60:63]
ds_read_b128 v[48:51], v9 offset:38912
v_mfma_f32_16x16x32_bf16 v[64:67], a[132:135], v[24:27], v[64:67]
buffer_load_dwordx4 v6, s[8:11], s50 offen offset:1664 lds
s_waitcnt lgkmcnt(4)
v_mfma_f32_16x16x32_bf16 v[52:55], a[136:139], v[28:31], v[52:55]
ds_read_b128 v[20:23], v8 offset:40960
v_mfma_f32_16x16x32_bf16 v[56:59], a[140:143], v[28:31], v[56:59]
s_add_u32 m0, s46, 121088
v_mfma_f32_16x16x32_bf16 v[60:63], a[136:139], v[32:35], v[60:63]
ds_read_b128 v[24:27], v8 offset:43008
v_mfma_f32_16x16x32_bf16 v[64:67], a[140:143], v[32:35], v[64:67]
buffer_load_dwordx4 v6, s[8:11], s50 offen offset:1792 lds
s_waitcnt lgkmcnt(4)
v_mfma_f32_16x16x32_bf16 v[52:55], a[144:147], v[36:39], v[52:55]
ds_read_b128 v[28:31], v9 offset:40960
v_mfma_f32_16x16x32_bf16 v[56:59], a[148:151], v[36:39], v[56:59]
s_add_u32 m0, s46, 125056
v_mfma_f32_16x16x32_bf16 v[60:63], a[144:147], v[40:43], v[60:63]
ds_read_b128 v[32:35], v9 offset:43008
v_mfma_f32_16x16x32_bf16 v[64:67], a[148:151], v[40:43], v[64:67]
buffer_load_dwordx4 v6, s[8:11], s50 offen offset:1920 lds
s_waitcnt lgkmcnt(4)
v_mfma_f32_16x16x32_bf16 v[52:55], a[152:155], v[44:47], v[52:55]
ds_read_b128 v[36:39], v8 offset:45056
v_mfma_f32_16x16x32_bf16 v[56:59], a[156:159], v[44:47], v[56:59]
v_mfma_f32_16x16x32_bf16 v[60:63], a[152:155], v[48:51], v[60:63]
ds_read_b128 v[40:43], v8 offset:47104
v_mfma_f32_16x16x32_bf16 v[64:67], a[156:159], v[48:51], v[64:67]
s_waitcnt lgkmcnt(4)
v_mfma_f32_16x16x32_bf16 v[52:55], a[160:163], v[20:23], v[52:55]
ds_read_b128 v[44:47], v9 offset:45056
v_mfma_f32_16x16x32_bf16 v[56:59], a[164:167], v[20:23], v[56:59]
v_mfma_f32_16x16x32_bf16 v[60:63], a[160:163], v[24:27], v[60:63]
ds_read_b128 v[48:51], v9 offset:47104
v_mfma_f32_16x16x32_bf16 v[64:67], a[164:167], v[24:27], v[64:67]
s_waitcnt lgkmcnt(4)
v_mfma_f32_16x16x32_bf16 v[52:55], a[168:171], v[28:31], v[52:55]
ds_read_b128 v[20:23], v8 offset:49152
v_mfma_f32_16x16x32_bf16 v[56:59], a[172:175], v[28:31], v[56:59]
s_waitcnt vmcnt(16)
v_mov_b32 v17, s42
s_mov_b64 exec, 1
buffer_store_dword v17, v16, s[84:87], s49 offen sc1
s_mov_b64 exec, -1
v_mfma_f32_16x16x32_bf16 v[60:63], a[168:171], v[32:35], v[60:63]
ds_read_b128 v[24:27], v8 offset:51200
v_mfma_f32_16x16x32_bf16 v[64:67], a[172:175], v[32:35], v[64:67]
s_waitcnt lgkmcnt(4)
v_mfma_f32_16x16x32_bf16 v[52:55], a[176:179], v[36:39], v[52:55]
ds_read_b128 v[28:31], v9 offset:49152
v_mfma_f32_16x16x32_bf16 v[56:59], a[180:183], v[36:39], v[56:59]
s_add_u32 s53, s42, 3
s_min_u32 s53, s53, 63
s_lshl_b32 s53, s53, 16
s_mov_b64 exec, 0xffff
buffer_load_dword v250, v19, s[8:11], s53 offen
s_mov_b64 exec, -1
v_mfma_f32_16x16x32_bf16 v[60:63], a[176:179], v[40:43], v[60:63]
ds_read_b128 v[32:35], v9 offset:51200
v_mfma_f32_16x16x32_bf16 v[64:67], a[180:183], v[40:43], v[64:67]
s_waitcnt lgkmcnt(4)
v_mfma_f32_16x16x32_bf16 v[52:55], a[184:187], v[44:47], v[52:55]
ds_read_b128 v[36:39], v8 offset:53248
v_mfma_f32_16x16x32_bf16 v[56:59], a[188:191], v[44:47], v[56:59]
v_mfma_f32_16x16x32_bf16 v[60:63], a[184:187], v[48:51], v[60:63]
ds_read_b128 v[40:43], v8 offset:55296
v_mfma_f32_16x16x32_bf16 v[64:67], a[188:191], v[48:51], v[64:67]
s_waitcnt lgkmcnt(4)
v_mfma_f32_16x16x32_bf16 v[52:55], a[192:195], v[20:23], v[52:55]
ds_read_b128 v[44:47], v9 offset:53248
v_mfma_f32_16x16x32_bf16 v[56:59], a[196:199], v[20:23], v[56:59]
v_mfma_f32_16x16x32_bf16 v[60:63], a[192:195], v[24:27], v[60:63]
ds_read_b128 v[48:51], v9 offset:55296
v_mfma_f32_16x16x32_bf16 v[64:67], a[196:199], v[24:27], v[64:67]
s_waitcnt lgkmcnt(4)
v_mfma_f32_16x16x32_bf16 v[52:55], a[200:203], v[28:31], v[52:55]
ds_read_b128 v[20:23], v8 offset:57344
v_mfma_f32_16x16x32_bf16 v[56:59], a[204:207], v[28:31], v[56:59]
v_mfma_f32_16x16x32_bf16 v[60:63], a[200:203], v[32:35], v[60:63]
ds_read_b128 v[24:27], v8 offset:59392
v_mfma_f32_16x16x32_bf16 v[64:67], a[204:207], v[32:35], v[64:67]
s_waitcnt lgkmcnt(4)
v_mfma_f32_16x16x32_bf16 v[52:55], a[208:211], v[36:39], v[52:55]
ds_read_b128 v[28:31], v9 offset:57344
v_mfma_f32_16x16x32_bf16 v[56:59], a[212:215], v[36:39], v[56:59]
v_mfma_f32_16x16x32_bf16 v[60:63], a[208:211], v[40:43], v[60:63]
ds_read_b128 v[32:35], v9 offset:59392
v_mfma_f32_16x16x32_bf16 v[64:67], a[212:215], v[40:43], v[64:67]
s_waitcnt lgkmcnt(4)
v_mfma_f32_16x16x32_bf16 v[52:55], a[216:219], v[44:47], v[52:55]
ds_read_b128 v[36:39], v8 offset:61440
v_mfma_f32_16x16x32_bf16 v[56:59], a[220:223], v[44:47], v[56:59]
v_mfma_f32_16x16x32_bf16 v[60:63], a[216:219], v[48:51], v[60:63]
ds_read_b128 v[40:43], v8 offset:63488
v_mfma_f32_16x16x32_bf16 v[64:67], a[220:223], v[48:51], v[64:67]
s_waitcnt lgkmcnt(4)
v_mfma_f32_16x16x32_bf16 v[52:55], a[224:227], v[20:23], v[52:55]
ds_read_b128 v[44:47], v9 offset:61440
v_mfma_f32_16x16x32_bf16 v[56:59], a[228:231], v[20:23], v[56:59]
v_mfma_f32_16x16x32_bf16 v[60:63], a[224:227], v[24:27], v[60:63]
ds_read_b128 v[48:51], v9 offset:63488
v_mfma_f32_16x16x32_bf16 v[64:67], a[228:231], v[24:27], v[64:67]
s_waitcnt lgkmcnt(5)
v_mfma_f32_16x16x32_bf16 v[52:55], a[232:235], v[28:31], v[52:55]
v_mfma_f32_16x16x32_bf16 v[56:59], a[236:239], v[28:31], v[56:59]
s_waitcnt lgkmcnt(4)
v_mfma_f32_16x16x32_bf16 v[60:63], a[232:235], v[32:35], v[60:63]
v_mfma_f32_16x16x32_bf16 v[64:67], a[236:239], v[32:35], v[64:67]
s_waitcnt lgkmcnt(3)
v_mfma_f32_16x16x32_bf16 v[52:55], a[240:243], v[36:39], v[52:55]
v_mfma_f32_16x16x32_bf16 v[56:59], a[244:247], v[36:39], v[56:59]
s_waitcnt lgkmcnt(2)
v_mfma_f32_16x16x32_bf16 v[60:63], a[240:243], v[40:43], v[60:63]
v_mfma_f32_16x16x32_bf16 v[64:67], a[244:247], v[40:43], v[64:67]
s_waitcnt lgkmcnt(1)
v_mfma_f32_16x16x32_bf16 v[52:55], a[248:251], v[44:47], v[52:55]
v_mfma_f32_16x16x32_bf16 v[56:59], a[252:255], v[44:47], v[56:59]
s_waitcnt lgkmcnt(0)
v_mfma_f32_16x16x32_bf16 v[60:63], a[248:251], v[48:51], v[60:63]
v_mfma_f32_16x16x32_bf16 v[64:67], a[252:255], v[48:51], v[64:67]
s_add_u32 s42, s42, 1
s_branch mega_kernel_k_loop
mega_kernel_k_fin:
s_nop 11
v_cvt_pk_bf16_f32 v84, v68, v69
v_cvt_pk_bf16_f32 v85, v70, v71
v_cvt_pk_bf16_f32 v86, v72, v73
v_cvt_pk_bf16_f32 v87, v74, v75
v_cvt_pk_bf16_f32 v88, v76, v77
v_cvt_pk_bf16_f32 v89, v78, v79
v_cvt_pk_bf16_f32 v90, v80, v81
v_cvt_pk_bf16_f32 v91, v82, v83
s_add_u32 s51, s42, s47
s_sub_u32 s51, s51, 1
s_bfe_u32 s52, s51, 0x40002
s_lshl_b32 s52, s52, 14
s_and_b32 s51, s51, 3
s_lshl_b32 s51, s51, 11
s_add_u32 s51, s51, s52
s_add_u32 s51, s51, s48
buffer_store_dwordx4 v[84:87], v7, s[84:87], s51 offen sc1
buffer_store_dwordx4 v[88:91], v7, s[84:87], s51 offen offset:1024 sc1
s_waitcnt vmcnt(0)
v_mov_b32 v17, s42
s_mov_b64 exec, 1
buffer_store_dword v17, v16, s[84:87], s49 offen sc1
s_mov_b64 exec, -1
s_waitcnt vmcnt(0)
s_barrier
s_branch mega_kernel_fft
mega_kernel_rv:
s_load_dwordx2 s[4:5], s[0:1], 32
s_load_dwordx2 s[8:9], s[0:1], 0
v_lshrrev_b32 v2, 6, v0
v_and_b32 v1, 63, v0
v_readfirstlane_b32 s41, v2
v_lshlrev_b32 v5, 4, v1
s_waitcnt lgkmcnt(0)
s_mov_b32 s6, 8388608
s_mov_b32 s7, 0x00020000
s_mov_b32 s10, 4194304
s_mov_b32 s11, 0x00020000
s_lshl_b32 s43, s40, 8
s_lshl_b32 s44, s41, 6
s_add_u32 s48, s43, s44
s_and_b32 s43, s48, 0x7ff
v_add_u32 v19, s43, v1
v_lshlrev_b32 v19, 7, v19
s_mov_b32 s43, 0
buffer_load_dword v250, v19, s[8:11], s43 offen
s_nop 0
v_lshrrev_b32 v2, 3, v1
s_lshl_b32 s43, s41, 3
v_add_u32 v2, s43, v2
v_bfe_u32 v3, v2, 1, 3
v_and_b32 v4, 7, v1
v_xor_b32 v3, v3, v4
v_lshlrev_b32 v6, 11, v2
v_lshl_add_u32 v6, v3, 4, v6
s_lshl_b32 s46, s41, 10
v_and_b32 v2, 15, v1
v_bfe_u32 v3, v2, 1, 3
v_lshrrev_b32 v4, 4, v1
v_xor_b32 v3, v3, v4
v_lshlrev_b32 v8, 7, v2
v_lshl_add_u32 v8, v3, 4, v8
v_xor_b32 v9, 64, v8
v_add_u32 v10, 0x10000, v8
v_add_u32 v11, 0x10000, v9
v_mov_b32 v7, v5
s_lshl_b32 s47, s40, 2
s_add_u32 s47, s47, s41
s_mov_b32 s42, 0
s_mov_b32 s50, 0
s_add_u32 m0, s46, 0
s_nop 0
buffer_load_dwordx4 v6, s[8:11], s50 offen offset:0 lds
s_add_u32 m0, s46, 3968
s_nop 0
buffer_load_dwordx4 v6, s[8:11], s50 offen offset:128 lds
s_add_u32 m0, s46, 7936
s_nop 0
buffer_load_dwordx4 v6, s[8:11], s50 offen offset:256 lds
s_add_u32 m0, s46, 11904
s_nop 0
buffer_load_dwordx4 v6, s[8:11], s50 offen offset:384 lds
s_add_u32 m0, s46, 15872
s_nop 0
buffer_load_dwordx4 v6, s[8:11], s50 offen offset:512 lds
s_add_u32 m0, s46, 19840
s_nop 0
buffer_load_dwordx4 v6, s[8:11], s50 offen offset:640 lds
s_add_u32 m0, s46, 23808
s_nop 0
buffer_load_dwordx4 v6, s[8:11], s50 offen offset:768 lds
s_add_u32 m0, s46, 27776
s_nop 0
buffer_load_dwordx4 v6, s[8:11], s50 offen offset:896 lds
s_add_u32 m0, s46, 31744
s_nop 0
buffer_load_dwordx4 v6, s[8:11], s50 offen offset:1024 lds
s_add_u32 m0, s46, 35712
s_nop 0
buffer_load_dwordx4 v6, s[8:11], s50 offen offset:1152 lds
s_add_u32 m0, s46, 39680
s_nop 0
buffer_load_dwordx4 v6, s[8:11], s50 offen offset:1280 lds
s_add_u32 m0, s46, 43648
s_nop 0
buffer_load_dwordx4 v6, s[8:11], s50 offen offset:1408 lds
s_add_u32 m0, s46, 47616
s_nop 0
buffer_load_dwordx4 v6, s[8:11], s50 offen offset:1536 lds
s_add_u32 m0, s46, 51584
s_nop 0
buffer_load_dwordx4 v6, s[8:11], s50 offen offset:1664 lds
s_add_u32 m0, s46, 55552
s_nop 0
buffer_load_dwordx4 v6, s[8:11], s50 offen offset:1792 lds
s_add_u32 m0, s46, 59520
s_nop 0
buffer_load_dwordx4 v6, s[8:11], s50 offen offset:1920 lds
v_lshrrev_b32 v2, 2, v1
v_and_b32 v3, 3, v1
v_lshlrev_b32 v16, 13, v2
v_lshl_add_u32 v16, v3, 4, v16
v_add_u32 v16, s48, v16
s_mul_i32 s45, s41, 24576
s_add_u32 s45, s45, 65536
v_bfe_u32 v17, v1, 2, 2
v_lshrrev_b32 v18, 4, v1
v_lshl_add_u32 v17, v18, 3, v17
v_lshlrev_b32 v17, 6, v17
v_lshl_add_u32 v17, v3, 3, v17
v_add_u32 v17, s45, v17
s_and_b32 s43, s40, 3
s_lshl_b32 s43, s43, 2
s_add_u32 s43, s43, s41
s_lshl_b32 s43, s43, 3
v_and_b32 v12, 7, v1
v_add_u32 v12, s43, v12
s_lshr_b32 s43, s40, 2
s_lshl_b32 s43, s43, 10
s_add_u32 s44, s43, 896
s_add_u32 s43, s43, 384
s_cmp_ge_u32 s40, 28
s_cselect_b32 s44, s44, s43
v_mov_b32 v13, s43
v_mov_b32 v14, s44
v_cmp_gt_u32 vcc, 32, v1
s_nop 1
v_cndmask_b32 v13, v14, v13, vcc
v_lshl_add_u32 v12, v12, 13, v13
s_mov_b32 s44, 0
buffer_load_dword v250, v12, s[4:7], s44 offen
s_add_u32 m0, s45, 0
s_mov_b32 s44, 0
buffer_load_dwordx4 v16, s[4:7], s44 offen lds
s_add_u32 m0, s45, 1024
s_mov_b32 s44, 131072
buffer_load_dwordx4 v16, s[4:7], s44 offen lds
s_add_u32 m0, s45, 2048
s_mov_b32 s44, 262144
buffer_load_dwordx4 v16, s[4:7], s44 offen lds
s_add_u32 m0, s45, 3072
s_mov_b32 s44, 393216
buffer_load_dwordx4 v16, s[4:7], s44 offen lds
s_add_u32 m0, s45, 4096
s_mov_b32 s44, 524288
buffer_load_dwordx4 v16, s[4:7], s44 offen lds
s_add_u32 m0, s45, 5120
s_mov_b32 s44, 655360
buffer_load_dwordx4 v16, s[4:7], s44 offen lds
s_add_u32 m0, s45, 6144
s_mov_b32 s44, 786432
buffer_load_dwordx4 v16, s[4:7], s44 offen lds
s_add_u32 m0, s45, 7168
s_mov_b32 s44, 917504
buffer_load_dwordx4 v16, s[4:7], s44 offen lds
s_mov_b32 s44, 1048576
buffer_load_dword v250, v12, s[4:7], s44 offen
s_add_u32 m0, s45, 8192
s_mov_b32 s44, 1048576
buffer_load_dwordx4 v16, s[4:7], s44 offen lds
s_add_u32 m0, s45, 9216
s_mov_b32 s44, 1179648
buffer_load_dwordx4 v16, s[4:7], s44 offen lds
s_add_u32 m0, s45, 10240
s_mov_b32 s44, 1310720
buffer_load_dwordx4 v16, s[4:7], s44 offen lds
s_add_u32 m0, s45, 11264
s_mov_b32 s44, 1441792
buffer_load_dwordx4 v16, s[4:7], s44 offen lds
s_add_u32 m0, s45, 12288
s_mov_b32 s44, 1572864
buffer_load_dwordx4 v16, s[4:7], s44 offen lds
s_add_u32 m0, s45, 13312
s_mov_b32 s44, 1703936
buffer_load_dwordx4 v16, s[4:7], s44 offen lds
s_add_u32 m0, s45, 14336
s_mov_b32 s44, 1835008
buffer_load_dwordx4 v16, s[4:7], s44 offen lds
s_add_u32 m0, s45, 15360
s_mov_b32 s44, 1966080
buffer_load_dwordx4 v16, s[4:7], s44 offen lds
s_mov_b32 s44, 2097152
buffer_load_dword v250, v12, s[4:7], s44 offen
s_add_u32 m0, s45, 16384
s_mov_b32 s44, 2097152
buffer_load_dwordx4 v16, s[4:7], s44 offen lds
s_add_u32 m0, s45, 17408
s_mov_b32 s44, 2228224
buffer_load_dwordx4 v16, s[4:7], s44 offen lds
s_add_u32 m0, s45, 18432
s_mov_b32 s44, 2359296
buffer_load_dwordx4 v16, s[4:7], s44 offen lds
s_add_u32 m0, s45, 19456
s_mov_b32 s44, 2490368
buffer_load_dwordx4 v16, s[4:7], s44 offen lds
s_add_u32 m0, s45, 20480
s_mov_b32 s44, 2621440
buffer_load_dwordx4 v16, s[4:7], s44 offen lds
s_add_u32 m0, s45, 21504
s_mov_b32 s44, 2752512
buffer_load_dwordx4 v16, s[4:7], s44 offen lds
s_add_u32 m0, s45, 22528
s_mov_b32 s44, 2883584
buffer_load_dwordx4 v16, s[4:7], s44 offen lds
s_add_u32 m0, s45, 23552
s_mov_b32 s44, 3014656
buffer_load_dwordx4 v16, s[4:7], s44 offen lds
s_waitcnt vmcnt(18)
s_barrier
ds_read_b64_tr_b16 a[0:1], v17 offset:0
ds_read_b64_tr_b16 a[2:3], v17 offset:256
ds_read_b64_tr_b16 a[4:5], v17 offset:32
ds_read_b64_tr_b16 a[6:7], v17 offset:288
ds_read_b64_tr_b16 a[8:9], v17 offset:2048
ds_read_b64_tr_b16 a[10:11], v17 offset:2304
ds_read_b64_tr_b16 a[12:13], v17 offset:2080
ds_read_b64_tr_b16 a[14:15], v17 offset:2336
s_waitcnt lgkmcnt(0)
ds_read_b64_tr_b16 a[16:17], v17 offset:4096
ds_read_b64_tr_b16 a[18:19], v17 offset:4352
ds_read_b64_tr_b16 a[20:21], v17 offset:4128
ds_read_b64_tr_b16 a[22:23], v17 offset:4384
ds_read_b64_tr_b16 a[24:25], v17 offset:6144
ds_read_b64_tr_b16 a[26:27], v17 offset:6400
ds_read_b64_tr_b16 a[28:29], v17 offset:6176
ds_read_b64_tr_b16 a[30:31], v17 offset:6432
s_waitcnt lgkmcnt(0)
s_mov_b32 s44, 3145728
buffer_load_dword v250, v12, s[4:7], s44 offen
s_add_u32 m0, s45, 0
s_mov_b32 s44, 3145728
buffer_load_dwordx4 v16, s[4:7], s44 offen lds
s_add_u32 m0, s45, 1024
s_mov_b32 s44, 3276800
buffer_load_dwordx4 v16, s[4:7], s44 offen lds
s_add_u32 m0, s45, 2048
s_mov_b32 s44, 3407872
buffer_load_dwordx4 v16, s[4:7], s44 offen lds
s_add_u32 m0, s45, 3072
s_mov_b32 s44, 3538944
buffer_load_dwordx4 v16, s[4:7], s44 offen lds
s_add_u32 m0, s45, 4096
s_mov_b32 s44, 3670016
buffer_load_dwordx4 v16, s[4:7], s44 offen lds
s_add_u32 m0, s45, 5120
s_mov_b32 s44, 3801088
buffer_load_dwordx4 v16, s[4:7], s44 offen lds
s_add_u32 m0, s45, 6144
s_mov_b32 s44, 3932160
buffer_load_dwordx4 v16, s[4:7], s44 offen lds
s_add_u32 m0, s45, 7168
s_mov_b32 s44, 4063232
buffer_load_dwordx4 v16, s[4:7], s44 offen lds
ds_read_b128 v[20:23], v8 offset:0
ds_read_b128 v[24:27], v8 offset:2048
ds_read_b128 v[28:31], v9 offset:0
ds_read_b128 v[32:35], v9 offset:2048
ds_read_b128 v[36:39], v8 offset:4096
ds_read_b128 v[40:43], v8 offset:6144
ds_read_b128 v[44:47], v9 offset:4096
ds_read_b128 v[48:51], v9 offset:6144
s_waitcnt lgkmcnt(0)
v_mfma_f32_16x16x32_bf16 v[52:55], v[20:23], a[0:3], 0
v_mfma_f32_16x16x32_bf16 v[56:59], v[20:23], a[4:7], 0
v_mfma_f32_16x16x32_bf16 v[60:63], v[24:27], a[0:3], 0
v_mfma_f32_16x16x32_bf16 v[64:67], v[24:27], a[4:7], 0
v_mfma_f32_16x16x32_bf16 v[52:55], v[28:31], a[8:11], v[52:55]
v_mfma_f32_16x16x32_bf16 v[56:59], v[28:31], a[12:15], v[56:59]
v_mfma_f32_16x16x32_bf16 v[60:63], v[32:35], a[8:11], v[60:63]
v_mfma_f32_16x16x32_bf16 v[64:67], v[32:35], a[12:15], v[64:67]
v_mfma_f32_16x16x32_bf16 v[52:55], v[36:39], a[16:19], v[52:55]
v_mfma_f32_16x16x32_bf16 v[56:59], v[36:39], a[20:23], v[56:59]
v_mfma_f32_16x16x32_bf16 v[60:63], v[40:43], a[16:19], v[60:63]
v_mfma_f32_16x16x32_bf16 v[64:67], v[40:43], a[20:23], v[64:67]
v_mfma_f32_16x16x32_bf16 v[52:55], v[44:47], a[24:27], v[52:55]
v_mfma_f32_16x16x32_bf16 v[56:59], v[44:47], a[28:31], v[56:59]
v_mfma_f32_16x16x32_bf16 v[60:63], v[48:51], a[24:27], v[60:63]
v_mfma_f32_16x16x32_bf16 v[64:67], v[48:51], a[28:31], v[64:67]
s_waitcnt vmcnt(18)
ds_read_b64_tr_b16 a[32:33], v17 offset:8192
ds_read_b64_tr_b16 a[34:35], v17 offset:8448
ds_read_b64_tr_b16 a[36:37], v17 offset:8224
ds_read_b64_tr_b16 a[38:39], v17 offset:8480
ds_read_b64_tr_b16 a[40:41], v17 offset:10240
ds_read_b64_tr_b16 a[42:43], v17 offset:10496
ds_read_b64_tr_b16 a[44:45], v17 offset:10272
ds_read_b64_tr_b16 a[46:47], v17 offset:10528
s_waitcnt lgkmcnt(0)
ds_read_b64_tr_b16 a[48:49], v17 offset:12288
ds_read_b64_tr_b16 a[50:51], v17 offset:12544
ds_read_b64_tr_b16 a[52:53], v17 offset:12320
ds_read_b64_tr_b16 a[54:55], v17 offset:12576
ds_read_b64_tr_b16 a[56:57], v17 offset:14336
ds_read_b64_tr_b16 a[58:59], v17 offset:14592
ds_read_b64_tr_b16 a[60:61], v17 offset:14368
ds_read_b64_tr_b16 a[62:63], v17 offset:14624
s_waitcnt lgkmcnt(0)
s_mov_b32 s44, 4194304
buffer_load_dword v250, v12, s[4:7], s44 offen
s_add_u32 m0, s45, 8192
s_mov_b32 s44, 4194304
buffer_load_dwordx4 v16, s[4:7], s44 offen lds
s_add_u32 m0, s45, 9216
s_mov_b32 s44, 4325376
buffer_load_dwordx4 v16, s[4:7], s44 offen lds
s_add_u32 m0, s45, 10240
s_mov_b32 s44, 4456448
buffer_load_dwordx4 v16, s[4:7], s44 offen lds
s_add_u32 m0, s45, 11264
s_mov_b32 s44, 4587520
buffer_load_dwordx4 v16, s[4:7], s44 offen lds
s_add_u32 m0, s45, 12288
s_mov_b32 s44, 4718592
buffer_load_dwordx4 v16, s[4:7], s44 offen lds
s_add_u32 m0, s45, 13312
s_mov_b32 s44, 4849664
buffer_load_dwordx4 v16, s[4:7], s44 offen lds
s_add_u32 m0, s45, 14336
s_mov_b32 s44, 4980736
buffer_load_dwordx4 v16, s[4:7], s44 offen lds
s_add_u32 m0, s45, 15360
s_mov_b32 s44, 5111808
buffer_load_dwordx4 v16, s[4:7], s44 offen lds
ds_read_b128 v[20:23], v8 offset:8192
ds_read_b128 v[24:27], v8 offset:10240
ds_read_b128 v[28:31], v9 offset:8192
ds_read_b128 v[32:35], v9 offset:10240
ds_read_b128 v[36:39], v8 offset:12288
ds_read_b128 v[40:43], v8 offset:14336
ds_read_b128 v[44:47], v9 offset:12288
ds_read_b128 v[48:51], v9 offset:14336
s_waitcnt lgkmcnt(0)
v_mfma_f32_16x16x32_bf16 v[52:55], v[20:23], a[32:35], v[52:55]
v_mfma_f32_16x16x32_bf16 v[56:59], v[20:23], a[36:39], v[56:59]
v_mfma_f32_16x16x32_bf16 v[60:63], v[24:27], a[32:35], v[60:63]
v_mfma_f32_16x16x32_bf16 v[64:67], v[24:27], a[36:39], v[64:67]
v_mfma_f32_16x16x32_bf16 v[52:55], v[28:31], a[40:43], v[52:55]
v_mfma_f32_16x16x32_bf16 v[56:59], v[28:31], a[44:47], v[56:59]
v_mfma_f32_16x16x32_bf16 v[60:63], v[32:35], a[40:43], v[60:63]
v_mfma_f32_16x16x32_bf16 v[64:67], v[32:35], a[44:47], v[64:67]
v_mfma_f32_16x16x32_bf16 v[52:55], v[36:39], a[48:51], v[52:55]
v_mfma_f32_16x16x32_bf16 v[56:59], v[36:39], a[52:55], v[56:59]
v_mfma_f32_16x16x32_bf16 v[60:63], v[40:43], a[48:51], v[60:63]
v_mfma_f32_16x16x32_bf16 v[64:67], v[40:43], a[52:55], v[64:67]
v_mfma_f32_16x16x32_bf16 v[52:55], v[44:47], a[56:59], v[52:55]
v_mfma_f32_16x16x32_bf16 v[56:59], v[44:47], a[60:63], v[56:59]
v_mfma_f32_16x16x32_bf16 v[60:63], v[48:51], a[56:59], v[60:63]
v_mfma_f32_16x16x32_bf16 v[64:67], v[48:51], a[60:63], v[64:67]
s_waitcnt vmcnt(18)
ds_read_b64_tr_b16 a[64:65], v17 offset:16384
ds_read_b64_tr_b16 a[66:67], v17 offset:16640
ds_read_b64_tr_b16 a[68:69], v17 offset:16416
ds_read_b64_tr_b16 a[70:71], v17 offset:16672
ds_read_b64_tr_b16 a[72:73], v17 offset:18432
ds_read_b64_tr_b16 a[74:75], v17 offset:18688
ds_read_b64_tr_b16 a[76:77], v17 offset:18464
ds_read_b64_tr_b16 a[78:79], v17 offset:18720
s_waitcnt lgkmcnt(0)
ds_read_b64_tr_b16 a[80:81], v17 offset:20480
ds_read_b64_tr_b16 a[82:83], v17 offset:20736
ds_read_b64_tr_b16 a[84:85], v17 offset:20512
ds_read_b64_tr_b16 a[86:87], v17 offset:20768
ds_read_b64_tr_b16 a[88:89], v17 offset:22528
ds_read_b64_tr_b16 a[90:91], v17 offset:22784
ds_read_b64_tr_b16 a[92:93], v17 offset:22560
ds_read_b64_tr_b16 a[94:95], v17 offset:22816
s_waitcnt lgkmcnt(0)
s_mov_b32 s44, 5242880
buffer_load_dword v250, v12, s[4:7], s44 offen
s_add_u32 m0, s45, 16384
s_mov_b32 s44, 5242880
buffer_load_dwordx4 v16, s[4:7], s44 offen lds
s_add_u32 m0, s45, 17408
s_mov_b32 s44, 5373952
buffer_load_dwordx4 v16, s[4:7], s44 offen lds
s_add_u32 m0, s45, 18432
s_mov_b32 s44, 5505024
buffer_load_dwordx4 v16, s[4:7], s44 offen lds
s_add_u32 m0, s45, 19456
s_mov_b32 s44, 5636096
buffer_load_dwordx4 v16, s[4:7], s44 offen lds
s_add_u32 m0, s45, 20480
s_mov_b32 s44, 5767168
buffer_load_dwordx4 v16, s[4:7], s44 offen lds
s_add_u32 m0, s45, 21504
s_mov_b32 s44, 5898240
buffer_load_dwordx4 v16, s[4:7], s44 offen lds
s_add_u32 m0, s45, 22528
s_mov_b32 s44, 6029312
buffer_load_dwordx4 v16, s[4:7], s44 offen lds
s_add_u32 m0, s45, 23552
s_mov_b32 s44, 6160384
buffer_load_dwordx4 v16, s[4:7], s44 offen lds
ds_read_b128 v[20:23], v8 offset:16384
ds_read_b128 v[24:27], v8 offset:18432
ds_read_b128 v[28:31], v9 offset:16384
ds_read_b128 v[32:35], v9 offset:18432
ds_read_b128 v[36:39], v8 offset:20480
ds_read_b128 v[40:43], v8 offset:22528
ds_read_b128 v[44:47], v9 offset:20480
ds_read_b128 v[48:51], v9 offset:22528
s_waitcnt lgkmcnt(0)
v_mfma_f32_16x16x32_bf16 v[52:55], v[20:23], a[64:67], v[52:55]
v_mfma_f32_16x16x32_bf16 v[56:59], v[20:23], a[68:71], v[56:59]
v_mfma_f32_16x16x32_bf16 v[60:63], v[24:27], a[64:67], v[60:63]
v_mfma_f32_16x16x32_bf16 v[64:67], v[24:27], a[68:71], v[64:67]
v_mfma_f32_16x16x32_bf16 v[52:55], v[28:31], a[72:75], v[52:55]
v_mfma_f32_16x16x32_bf16 v[56:59], v[28:31], a[76:79], v[56:59]
v_mfma_f32_16x16x32_bf16 v[60:63], v[32:35], a[72:75], v[60:63]
v_mfma_f32_16x16x32_bf16 v[64:67], v[32:35], a[76:79], v[64:67]
v_mfma_f32_16x16x32_bf16 v[52:55], v[36:39], a[80:83], v[52:55]
v_mfma_f32_16x16x32_bf16 v[56:59], v[36:39], a[84:87], v[56:59]
v_mfma_f32_16x16x32_bf16 v[60:63], v[40:43], a[80:83], v[60:63]
v_mfma_f32_16x16x32_bf16 v[64:67], v[40:43], a[84:87], v[64:67]
v_mfma_f32_16x16x32_bf16 v[52:55], v[44:47], a[88:91], v[52:55]
v_mfma_f32_16x16x32_bf16 v[56:59], v[44:47], a[92:95], v[56:59]
v_mfma_f32_16x16x32_bf16 v[60:63], v[48:51], a[88:91], v[60:63]
v_mfma_f32_16x16x32_bf16 v[64:67], v[48:51], a[92:95], v[64:67]
s_waitcnt vmcnt(18)
ds_read_b64_tr_b16 a[96:97], v17 offset:0
ds_read_b64_tr_b16 a[98:99], v17 offset:256
ds_read_b64_tr_b16 a[100:101], v17 offset:32
ds_read_b64_tr_b16 a[102:103], v17 offset:288
ds_read_b64_tr_b16 a[104:105], v17 offset:2048
ds_read_b64_tr_b16 a[106:107], v17 offset:2304
ds_read_b64_tr_b16 a[108:109], v17 offset:2080
ds_read_b64_tr_b16 a[110:111], v17 offset:2336
s_waitcnt lgkmcnt(0)
ds_read_b64_tr_b16 a[112:113], v17 offset:4096
ds_read_b64_tr_b16 a[114:115], v17 offset:4352
ds_read_b64_tr_b16 a[116:117], v17 offset:4128
ds_read_b64_tr_b16 a[118:119], v17 offset:4384
ds_read_b64_tr_b16 a[120:121], v17 offset:6144
ds_read_b64_tr_b16 a[122:123], v17 offset:6400
ds_read_b64_tr_b16 a[124:125], v17 offset:6176
ds_read_b64_tr_b16 a[126:127], v17 offset:6432
s_waitcnt lgkmcnt(0)
s_mov_b32 s44, 6291456
buffer_load_dword v250, v12, s[4:7], s44 offen
s_add_u32 m0, s45, 0
s_mov_b32 s44, 6291456
buffer_load_dwordx4 v16, s[4:7], s44 offen lds
s_add_u32 m0, s45, 1024
s_mov_b32 s44, 6422528
buffer_load_dwordx4 v16, s[4:7], s44 offen lds
s_add_u32 m0, s45, 2048
s_mov_b32 s44, 6553600
buffer_load_dwordx4 v16, s[4:7], s44 offen lds
s_add_u32 m0, s45, 3072
s_mov_b32 s44, 6684672
buffer_load_dwordx4 v16, s[4:7], s44 offen lds
s_add_u32 m0, s45, 4096
s_mov_b32 s44, 6815744
buffer_load_dwordx4 v16, s[4:7], s44 offen lds
s_add_u32 m0, s45, 5120
s_mov_b32 s44, 6946816
buffer_load_dwordx4 v16, s[4:7], s44 offen lds
s_add_u32 m0, s45, 6144
s_mov_b32 s44, 7077888
buffer_load_dwordx4 v16, s[4:7], s44 offen lds
s_add_u32 m0, s45, 7168
s_mov_b32 s44, 7208960
buffer_load_dwordx4 v16, s[4:7], s44 offen lds
ds_read_b128 v[20:23], v8 offset:24576
ds_read_b128 v[24:27], v8 offset:26624
ds_read_b128 v[28:31], v9 offset:24576
ds_read_b128 v[32:35], v9 offset:26624
ds_read_b128 v[36:39], v8 offset:28672
ds_read_b128 v[40:43], v8 offset:30720
ds_read_b128 v[44:47], v9 offset:28672
ds_read_b128 v[48:51], v9 offset:30720
s_waitcnt lgkmcnt(0)
v_mfma_f32_16x16x32_bf16 v[52:55], v[20:23], a[96:99], v[52:55]
v_mfma_f32_16x16x32_bf16 v[56:59], v[20:23], a[100:103], v[56:59]
v_mfma_f32_16x16x32_bf16 v[60:63], v[24:27], a[96:99], v[60:63]
v_mfma_f32_16x16x32_bf16 v[64:67], v[24:27], a[100:103], v[64:67]
v_mfma_f32_16x16x32_bf16 v[52:55], v[28:31], a[104:107], v[52:55]
v_mfma_f32_16x16x32_bf16 v[56:59], v[28:31], a[108:111], v[56:59]
v_mfma_f32_16x16x32_bf16 v[60:63], v[32:35], a[104:107], v[60:63]
v_mfma_f32_16x16x32_bf16 v[64:67], v[32:35], a[108:111], v[64:67]
v_mfma_f32_16x16x32_bf16 v[52:55], v[36:39], a[112:115], v[52:55]
v_mfma_f32_16x16x32_bf16 v[56:59], v[36:39], a[116:119], v[56:59]
v_mfma_f32_16x16x32_bf16 v[60:63], v[40:43], a[112:115], v[60:63]
v_mfma_f32_16x16x32_bf16 v[64:67], v[40:43], a[116:119], v[64:67]
v_mfma_f32_16x16x32_bf16 v[52:55], v[44:47], a[120:123], v[52:55]
v_mfma_f32_16x16x32_bf16 v[56:59], v[44:47], a[124:127], v[56:59]
v_mfma_f32_16x16x32_bf16 v[60:63], v[48:51], a[120:123], v[60:63]
v_mfma_f32_16x16x32_bf16 v[64:67], v[48:51], a[124:127], v[64:67]
s_waitcnt vmcnt(18)
ds_read_b64_tr_b16 a[128:129], v17 offset:8192
ds_read_b64_tr_b16 a[130:131], v17 offset:8448
ds_read_b64_tr_b16 a[132:133], v17 offset:8224
ds_read_b64_tr_b16 a[134:135], v17 offset:8480
ds_read_b64_tr_b16 a[136:137], v17 offset:10240
ds_read_b64_tr_b16 a[138:139], v17 offset:10496
ds_read_b64_tr_b16 a[140:141], v17 offset:10272
ds_read_b64_tr_b16 a[142:143], v17 offset:10528
s_waitcnt lgkmcnt(0)
ds_read_b64_tr_b16 a[144:145], v17 offset:12288
ds_read_b64_tr_b16 a[146:147], v17 offset:12544
ds_read_b64_tr_b16 a[148:149], v17 offset:12320
ds_read_b64_tr_b16 a[150:151], v17 offset:12576
ds_read_b64_tr_b16 a[152:153], v17 offset:14336
ds_read_b64_tr_b16 a[154:155], v17 offset:14592
ds_read_b64_tr_b16 a[156:157], v17 offset:14368
ds_read_b64_tr_b16 a[158:159], v17 offset:14624
s_waitcnt lgkmcnt(0)
s_mov_b32 s44, 7340032
buffer_load_dword v250, v12, s[4:7], s44 offen
s_add_u32 m0, s45, 8192
s_mov_b32 s44, 7340032
buffer_load_dwordx4 v16, s[4:7], s44 offen lds
s_add_u32 m0, s45, 9216
s_mov_b32 s44, 7471104
buffer_load_dwordx4 v16, s[4:7], s44 offen lds
s_add_u32 m0, s45, 10240
s_mov_b32 s44, 7602176
buffer_load_dwordx4 v16, s[4:7], s44 offen lds
s_add_u32 m0, s45, 11264
s_mov_b32 s44, 7733248
buffer_load_dwordx4 v16, s[4:7], s44 offen lds
s_add_u32 m0, s45, 12288
s_mov_b32 s44, 7864320
buffer_load_dwordx4 v16, s[4:7], s44 offen lds
s_add_u32 m0, s45, 13312
s_mov_b32 s44, 7995392
buffer_load_dwordx4 v16, s[4:7], s44 offen lds
s_add_u32 m0, s45, 14336
s_mov_b32 s44, 8126464
buffer_load_dwordx4 v16, s[4:7], s44 offen lds
s_add_u32 m0, s45, 15360
s_mov_b32 s44, 8257536
buffer_load_dwordx4 v16, s[4:7], s44 offen lds
ds_read_b128 v[20:23], v8 offset:32768
ds_read_b128 v[24:27], v8 offset:34816
ds_read_b128 v[28:31], v9 offset:32768
ds_read_b128 v[32:35], v9 offset:34816
ds_read_b128 v[36:39], v8 offset:36864
ds_read_b128 v[40:43], v8 offset:38912
ds_read_b128 v[44:47], v9 offset:36864
ds_read_b128 v[48:51], v9 offset:38912
s_waitcnt lgkmcnt(0)
v_mfma_f32_16x16x32_bf16 v[52:55], v[20:23], a[128:131], v[52:55]
v_mfma_f32_16x16x32_bf16 v[56:59], v[20:23], a[132:135], v[56:59]
v_mfma_f32_16x16x32_bf16 v[60:63], v[24:27], a[128:131], v[60:63]
v_mfma_f32_16x16x32_bf16 v[64:67], v[24:27], a[132:135], v[64:67]
v_mfma_f32_16x16x32_bf16 v[52:55], v[28:31], a[136:139], v[52:55]
v_mfma_f32_16x16x32_bf16 v[56:59], v[28:31], a[140:143], v[56:59]
v_mfma_f32_16x16x32_bf16 v[60:63], v[32:35], a[136:139], v[60:63]
v_mfma_f32_16x16x32_bf16 v[64:67], v[32:35], a[140:143], v[64:67]
v_mfma_f32_16x16x32_bf16 v[52:55], v[36:39], a[144:147], v[52:55]
v_mfma_f32_16x16x32_bf16 v[56:59], v[36:39], a[148:151], v[56:59]
v_mfma_f32_16x16x32_bf16 v[60:63], v[40:43], a[144:147], v[60:63]
v_mfma_f32_16x16x32_bf16 v[64:67], v[40:43], a[148:151], v[64:67]
v_mfma_f32_16x16x32_bf16 v[52:55], v[44:47], a[152:155], v[52:55]
v_mfma_f32_16x16x32_bf16 v[56:59], v[44:47], a[156:159], v[56:59]
v_mfma_f32_16x16x32_bf16 v[60:63], v[48:51], a[152:155], v[60:63]
v_mfma_f32_16x16x32_bf16 v[64:67], v[48:51], a[156:159], v[64:67]
s_waitcnt vmcnt(18)
ds_read_b64_tr_b16 a[160:161], v17 offset:16384
ds_read_b64_tr_b16 a[162:163], v17 offset:16640
ds_read_b64_tr_b16 a[164:165], v17 offset:16416
ds_read_b64_tr_b16 a[166:167], v17 offset:16672
ds_read_b64_tr_b16 a[168:169], v17 offset:18432
ds_read_b64_tr_b16 a[170:171], v17 offset:18688
ds_read_b64_tr_b16 a[172:173], v17 offset:18464
ds_read_b64_tr_b16 a[174:175], v17 offset:18720
s_waitcnt lgkmcnt(0)
ds_read_b64_tr_b16 a[176:177], v17 offset:20480
ds_read_b64_tr_b16 a[178:179], v17 offset:20736
ds_read_b64_tr_b16 a[180:181], v17 offset:20512
ds_read_b64_tr_b16 a[182:183], v17 offset:20768
ds_read_b64_tr_b16 a[184:185], v17 offset:22528
ds_read_b64_tr_b16 a[186:187], v17 offset:22784
ds_read_b64_tr_b16 a[188:189], v17 offset:22560
ds_read_b64_tr_b16 a[190:191], v17 offset:22816
s_waitcnt lgkmcnt(0)
ds_read_b128 v[20:23], v8 offset:40960
ds_read_b128 v[24:27], v8 offset:43008
ds_read_b128 v[28:31], v9 offset:40960
ds_read_b128 v[32:35], v9 offset:43008
ds_read_b128 v[36:39], v8 offset:45056
ds_read_b128 v[40:43], v8 offset:47104
ds_read_b128 v[44:47], v9 offset:45056
ds_read_b128 v[48:51], v9 offset:47104
s_waitcnt lgkmcnt(0)
v_mfma_f32_16x16x32_bf16 v[52:55], v[20:23], a[160:163], v[52:55]
v_mfma_f32_16x16x32_bf16 v[56:59], v[20:23], a[164:167], v[56:59]
v_mfma_f32_16x16x32_bf16 v[60:63], v[24:27], a[160:163], v[60:63]
v_mfma_f32_16x16x32_bf16 v[64:67], v[24:27], a[164:167], v[64:67]
v_mfma_f32_16x16x32_bf16 v[52:55], v[28:31], a[168:171], v[52:55]
v_mfma_f32_16x16x32_bf16 v[56:59], v[28:31], a[172:175], v[56:59]
v_mfma_f32_16x16x32_bf16 v[60:63], v[32:35], a[168:171], v[60:63]
v_mfma_f32_16x16x32_bf16 v[64:67], v[32:35], a[172:175], v[64:67]
v_mfma_f32_16x16x32_bf16 v[52:55], v[36:39], a[176:179], v[52:55]
v_mfma_f32_16x16x32_bf16 v[56:59], v[36:39], a[180:183], v[56:59]
v_mfma_f32_16x16x32_bf16 v[60:63], v[40:43], a[176:179], v[60:63]
v_mfma_f32_16x16x32_bf16 v[64:67], v[40:43], a[180:183], v[64:67]
v_mfma_f32_16x16x32_bf16 v[52:55], v[44:47], a[184:187], v[52:55]
v_mfma_f32_16x16x32_bf16 v[56:59], v[44:47], a[188:191], v[56:59]
v_mfma_f32_16x16x32_bf16 v[60:63], v[48:51], a[184:187], v[60:63]
v_mfma_f32_16x16x32_bf16 v[64:67], v[48:51], a[188:191], v[64:67]
s_waitcnt vmcnt(9)
ds_read_b64_tr_b16 a[192:193], v17 offset:0
ds_read_b64_tr_b16 a[194:195], v17 offset:256
ds_read_b64_tr_b16 a[196:197], v17 offset:32
ds_read_b64_tr_b16 a[198:199], v17 offset:288
ds_read_b64_tr_b16 a[200:201], v17 offset:2048
ds_read_b64_tr_b16 a[202:203], v17 offset:2304
ds_read_b64_tr_b16 a[204:205], v17 offset:2080
ds_read_b64_tr_b16 a[206:207], v17 offset:2336
s_waitcnt lgkmcnt(0)
ds_read_b64_tr_b16 a[208:209], v17 offset:4096
ds_read_b64_tr_b16 a[210:211], v17 offset:4352
ds_read_b64_tr_b16 a[212:213], v17 offset:4128
ds_read_b64_tr_b16 a[214:215], v17 offset:4384
ds_read_b64_tr_b16 a[216:217], v17 offset:6144
ds_read_b64_tr_b16 a[218:219], v17 offset:6400
ds_read_b64_tr_b16 a[220:221], v17 offset:6176
ds_read_b64_tr_b16 a[222:223], v17 offset:6432
s_waitcnt lgkmcnt(0)
ds_read_b128 v[20:23], v8 offset:49152
ds_read_b128 v[24:27], v8 offset:51200
ds_read_b128 v[28:31], v9 offset:49152
ds_read_b128 v[32:35], v9 offset:51200
ds_read_b128 v[36:39], v8 offset:53248
ds_read_b128 v[40:43], v8 offset:55296
ds_read_b128 v[44:47], v9 offset:53248
ds_read_b128 v[48:51], v9 offset:55296
s_waitcnt lgkmcnt(0)
v_mfma_f32_16x16x32_bf16 v[52:55], v[20:23], a[192:195], v[52:55]
v_mfma_f32_16x16x32_bf16 v[56:59], v[20:23], a[196:199], v[56:59]
v_mfma_f32_16x16x32_bf16 v[60:63], v[24:27], a[192:195], v[60:63]
v_mfma_f32_16x16x32_bf16 v[64:67], v[24:27], a[196:199], v[64:67]
v_mfma_f32_16x16x32_bf16 v[52:55], v[28:31], a[200:203], v[52:55]
v_mfma_f32_16x16x32_bf16 v[56:59], v[28:31], a[204:207], v[56:59]
v_mfma_f32_16x16x32_bf16 v[60:63], v[32:35], a[200:203], v[60:63]
v_mfma_f32_16x16x32_bf16 v[64:67], v[32:35], a[204:207], v[64:67]
v_mfma_f32_16x16x32_bf16 v[52:55], v[36:39], a[208:211], v[52:55]
v_mfma_f32_16x16x32_bf16 v[56:59], v[36:39], a[212:215], v[56:59]
v_mfma_f32_16x16x32_bf16 v[60:63], v[40:43], a[208:211], v[60:63]
v_mfma_f32_16x16x32_bf16 v[64:67], v[40:43], a[212:215], v[64:67]
v_mfma_f32_16x16x32_bf16 v[52:55], v[44:47], a[216:219], v[52:55]
v_mfma_f32_16x16x32_bf16 v[56:59], v[44:47], a[220:223], v[56:59]
v_mfma_f32_16x16x32_bf16 v[60:63], v[48:51], a[216:219], v[60:63]
v_mfma_f32_16x16x32_bf16 v[64:67], v[48:51], a[220:223], v[64:67]
s_waitcnt vmcnt(0)
ds_read_b64_tr_b16 a[224:225], v17 offset:8192
ds_read_b64_tr_b16 a[226:227], v17 offset:8448
ds_read_b64_tr_b16 a[228:229], v17 offset:8224
ds_read_b64_tr_b16 a[230:231], v17 offset:8480
ds_read_b64_tr_b16 a[232:233], v17 offset:10240
ds_read_b64_tr_b16 a[234:235], v17 offset:10496
ds_read_b64_tr_b16 a[236:237], v17 offset:10272
ds_read_b64_tr_b16 a[238:239], v17 offset:10528
s_waitcnt lgkmcnt(0)
ds_read_b64_tr_b16 a[240:241], v17 offset:12288
ds_read_b64_tr_b16 a[242:243], v17 offset:12544
ds_read_b64_tr_b16 a[244:245], v17 offset:12320
ds_read_b64_tr_b16 a[246:247], v17 offset:12576
ds_read_b64_tr_b16 a[248:249], v17 offset:14336
ds_read_b64_tr_b16 a[250:251], v17 offset:14592
ds_read_b64_tr_b16 a[252:253], v17 offset:14368
ds_read_b64_tr_b16 a[254:255], v17 offset:14624
s_waitcnt lgkmcnt(0)
ds_read_b128 v[20:23], v8 offset:57344
ds_read_b128 v[24:27], v8 offset:59392
ds_read_b128 v[28:31], v9 offset:57344
ds_read_b128 v[32:35], v9 offset:59392
ds_read_b128 v[36:39], v8 offset:61440
ds_read_b128 v[40:43], v8 offset:63488
ds_read_b128 v[44:47], v9 offset:61440
ds_read_b128 v[48:51], v9 offset:63488
s_waitcnt lgkmcnt(0)
v_mfma_f32_16x16x32_bf16 v[52:55], v[20:23], a[224:227], v[52:55]
v_mfma_f32_16x16x32_bf16 v[56:59], v[20:23], a[228:231], v[56:59]
v_mfma_f32_16x16x32_bf16 v[60:63], v[24:27], a[224:227], v[60:63]
v_mfma_f32_16x16x32_bf16 v[64:67], v[24:27], a[228:231], v[64:67]
v_mfma_f32_16x16x32_bf16 v[52:55], v[28:31], a[232:235], v[52:55]
v_mfma_f32_16x16x32_bf16 v[56:59], v[28:31], a[236:239], v[56:59]
v_mfma_f32_16x16x32_bf16 v[60:63], v[32:35], a[232:235], v[60:63]
v_mfma_f32_16x16x32_bf16 v[64:67], v[32:35], a[236:239], v[64:67]
v_mfma_f32_16x16x32_bf16 v[52:55], v[36:39], a[240:243], v[52:55]
v_mfma_f32_16x16x32_bf16 v[56:59], v[36:39], a[244:247], v[56:59]
v_mfma_f32_16x16x32_bf16 v[60:63], v[40:43], a[240:243], v[60:63]
v_mfma_f32_16x16x32_bf16 v[64:67], v[40:43], a[244:247], v[64:67]
v_mfma_f32_16x16x32_bf16 v[52:55], v[44:47], a[248:251], v[52:55]
v_mfma_f32_16x16x32_bf16 v[56:59], v[44:47], a[252:255], v[56:59]
v_mfma_f32_16x16x32_bf16 v[60:63], v[48:51], a[248:251], v[60:63]
v_mfma_f32_16x16x32_bf16 v[64:67], v[48:51], a[252:255], v[64:67]
s_barrier
s_mov_b32 s50, 0x10000
s_add_u32 m0, s46, 65536
s_nop 0
buffer_load_dwordx4 v6, s[8:11], s50 offen offset:0 lds
s_add_u32 m0, s46, 69504
s_nop 0
buffer_load_dwordx4 v6, s[8:11], s50 offen offset:128 lds
s_add_u32 m0, s46, 73472
s_nop 0
buffer_load_dwordx4 v6, s[8:11], s50 offen offset:256 lds
s_add_u32 m0, s46, 77440
s_nop 0
buffer_load_dwordx4 v6, s[8:11], s50 offen offset:384 lds
s_add_u32 m0, s46, 81408
s_nop 0
buffer_load_dwordx4 v6, s[8:11], s50 offen offset:512 lds
s_add_u32 m0, s46, 85376
s_nop 0
buffer_load_dwordx4 v6, s[8:11], s50 offen offset:640 lds
s_add_u32 m0, s46, 89344
s_nop 0
buffer_load_dwordx4 v6, s[8:11], s50 offen offset:768 lds
s_add_u32 m0, s46, 93312
s_nop 0
buffer_load_dwordx4 v6, s[8:11], s50 offen offset:896 lds
s_add_u32 m0, s46, 97280
s_nop 0
buffer_load_dwordx4 v6, s[8:11], s50 offen offset:1024 lds
s_add_u32 m0, s46, 101248
s_nop 0
buffer_load_dwordx4 v6, s[8:11], s50 offen offset:1152 lds
s_add_u32 m0, s46, 105216
s_nop 0
buffer_load_dwordx4 v6, s[8:11], s50 offen offset:1280 lds
s_add_u32 m0, s46, 109184
s_nop 0
buffer_load_dwordx4 v6, s[8:11], s50 offen offset:1408 lds
s_add_u32 m0, s46, 113152
s_nop 0
buffer_load_dwordx4 v6, s[8:11], s50 offen offset:1536 lds
s_add_u32 m0, s46, 117120
s_nop 0
buffer_load_dwordx4 v6, s[8:11], s50 offen offset:1664 lds
s_add_u32 m0, s46, 121088
s_nop 0
buffer_load_dwordx4 v6, s[8:11], s50 offen offset:1792 lds
s_add_u32 m0, s46, 125056
s_nop 0
buffer_load_dwordx4 v6, s[8:11], s50 offen offset:1920 lds
s_and_b32 s53, s47, 31
s_lshl_b32 s53, s53, 4
v_add_u32 v19, s53, v1
v_lshlrev_b32 v19, 7, v19
s_mov_b32 s42, 1
v_and_b32 v3, 15, v0
v_lshlrev_b32 v3, 4, v3
s_branch mega_kernel_syv
mega_kernel_syvw:
s_sleep 4
mega_kernel_syv:
buffer_load_dword v2, v3, s[72:75], 0 offen sc1
s_waitcnt vmcnt(0)
mega_kernel_syvp:
s_cmp_eq_u32 s95, 1
s_cbranch_scc0 mega_kernel_syvf
v_readlane_b32 s76, v2, 14
s_mov_b32 s98, 0
s_cmp_eq_u32 s76, 32
s_cbranch_scc0 mega_kernel_syvw
s_branch mega_kernel_syvd
mega_kernel_syvf:
s_mov_b32 s77, 0
s_mov_b32 s78, 0
v_readlane_b32 s76, v2, 0
s_add_u32 s77, s77, s76
s_xor_b32 s76, s76, 32
s_or_b32 s78, s78, s76
v_readlane_b32 s76, v2, 1
s_add_u32 s77, s77, s76
s_xor_b32 s76, s76, 32
s_or_b32 s78, s78, s76
v_readlane_b32 s76, v2, 2
s_add_u32 s77, s77, s76
s_xor_b32 s76, s76, 32
s_or_b32 s78, s78, s76
v_readlane_b32 s76, v2, 3
s_add_u32 s77, s77, s76
s_xor_b32 s76, s76, 32
s_or_b32 s78, s78, s76
v_readlane_b32 s76, v2, 4
s_add_u32 s77, s77, s76
s_xor_b32 s76, s76, 32
s_or_b32 s78, s78, s76
v_readlane_b32 s76, v2, 5
s_add_u32 s77, s77, s76
s_xor_b32 s76, s76, 32
s_or_b32 s78, s78, s76
v_readlane_b32 s76, v2, 6
s_add_u32 s77, s77, s76
s_xor_b32 s76, s76, 32
s_or_b32 s78, s78, s76
v_readlane_b32 s76, v2, 7
s_add_u32 s77, s77, s76
s_xor_b32 s76, s76, 32
s_or_b32 s78, s78, s76
s_cmp_eq_u32 s77, 256
s_cbranch_scc0 mega_kernel_syvw
v_mov_b32 v252, v2
s_cmp_eq_u32 s78, 0
s_cbranch_scc0 mega_kernel_slowent
v_readlane_b32 s76, v2, 10
v_readlane_b32 s77, v2, 8
s_cmp_eq_u32 s76, 32
s_cbranch_scc0 mega_kernel_syvw
s_cmp_gt_u32 s77, 16
s_cselect_b32 s98, 1, 0
mega_kernel_syvd:
s_lshr_b32 s44, s47, 3
s_xor_b32 s44, s44, s98
s_and_b32 s44, s44, 1
s_lshl_b32 s44, s44, 13
s_lshl_b32 s48, s47, 18
s_add_u32 s48, s48, s44
s_add_u32 s48, s48, 33554432
s_xor_b32 s44, s98, 1
s_lshl_b32 s44, s44, 13
s_lshl_b32 s49, s40, 7
s_add_u32 s49, s49, s44
s_lshl_b32 s44, s41, 2
s_add_u32 s49, s49, s44
s_add_u32 s49, s49, 69210112
v_mov_b32 v16, 0
v_cvt_pk_bf16_f32 v84, v52, v53
v_cvt_pk_bf16_f32 v85, v54, v55
v_cvt_pk_bf16_f32 v86, v60, v61
v_cvt_pk_bf16_f32 v87, v62, v63
v_cvt_pk_bf16_f32 v88, v56, v57
v_cvt_pk_bf16_f32 v89, v58, v59
v_cvt_pk_bf16_f32 v90, v64, v65
v_cvt_pk_bf16_f32 v91, v66, v67
s_add_u32 s51, s42, s47
s_sub_u32 s51, s51, 1
s_bfe_u32 s52, s51, 0x40002
s_lshl_b32 s52, s52, 14
s_and_b32 s51, s51, 3
s_lshl_b32 s51, s51, 11
s_add_u32 s51, s51, s52
s_add_u32 s51, s51, s48
buffer_store_dwordx4 v[84:87], v7, s[84:87], s51 offen sc1
buffer_store_dwordx4 v[88:91], v7, s[84:87], s51 offen offset:1024 sc1
s_waitcnt vmcnt(0)
v_mov_b32 v17, s42
s_mov_b64 exec, 1
buffer_store_dword v17, v16, s[84:87], s49 offen sc1
s_mov_b64 exec, -1
mega_kernel_v_loop:
s_waitcnt vmcnt(2)
s_barrier
s_add_u32 s50, s42, 1
s_min_u32 s50, s50, 63
s_lshl_b32 s50, s50, 16
ds_read_b128 v[20:23], v10 offset:0
ds_read_b128 v[24:27], v10 offset:2048
ds_read_b128 v[28:31], v11 offset:0
ds_read_b128 v[32:35], v11 offset:2048
ds_read_b128 v[36:39], v10 offset:4096
ds_read_b128 v[40:43], v10 offset:6144
s_waitcnt lgkmcnt(4)
v_mfma_f32_16x16x32_bf16 v[68:71], v[20:23], a[0:3], 0
ds_read_b128 v[44:47], v11 offset:4096
v_mfma_f32_16x16x32_bf16 v[72:75], v[20:23], a[4:7], 0
v_cvt_pk_bf16_f32 v84, v52, v53
v_cvt_pk_bf16_f32 v85, v54, v55
v_cvt_pk_bf16_f32 v86, v60, v61
v_mfma_f32_16x16x32_bf16 v[76:79], v[24:27], a[0:3], 0
ds_read_b128 v[48:51], v11 offset:6144
v_mfma_f32_16x16x32_bf16 v[80:83], v[24:27], a[4:7], 0
v_cvt_pk_bf16_f32 v87, v62, v63
v_cvt_pk_bf16_f32 v88, v56, v57
v_cvt_pk_bf16_f32 v89, v58, v59
s_waitcnt lgkmcnt(4)
v_mfma_f32_16x16x32_bf16 v[68:71], v[28:31], a[8:11], v[68:71]
ds_read_b128 v[20:23], v10 offset:8192
v_mfma_f32_16x16x32_bf16 v[72:75], v[28:31], a[12:15], v[72:75]
v_cvt_pk_bf16_f32 v90, v64, v65
v_cvt_pk_bf16_f32 v91, v66, v67
v_mfma_f32_16x16x32_bf16 v[76:79], v[32:35], a[8:11], v[76:79]
ds_read_b128 v[24:27], v10 offset:10240
v_mfma_f32_16x16x32_bf16 v[80:83], v[32:35], a[12:15], v[80:83]
s_add_u32 s51, s42, s47
s_sub_u32 s51, s51, 1
s_bfe_u32 s52, s51, 0x40002
s_lshl_b32 s52, s52, 14
s_waitcnt lgkmcnt(4)
v_mfma_f32_16x16x32_bf16 v[68:71], v[36:39], a[16:19], v[68:71]
ds_read_b128 v[28:31], v11 offset:8192
v_mfma_f32_16x16x32_bf16 v[72:75], v[36:39], a[20:23], v[72:75]
s_and_b32 s51, s51, 3
s_lshl_b32 s51, s51, 11
s_add_u32 s51, s51, s52
s_add_u32 s51, s51, s48
buffer_store_dwordx4 v[84:87], v7, s[84:87], s51 offen sc1
v_mfma_f32_16x16x32_bf16 v[76:79], v[40:43], a[16:19], v[76:79]
ds_read_b128 v[32:35], v11 offset:10240
v_mfma_f32_16x16x32_bf16 v[80:83], v[40:43], a[20:23], v[80:83]
buffer_store_dwordx4 v[88:91], v7, s[84:87], s51 offen offset:1024 sc1
s_waitcnt lgkmcnt(4)
v_mfma_f32_16x16x32_bf16 v[68:71], v[44:47], a[24:27], v[68:71]
ds_read_b128 v[36:39], v10 offset:12288
v_mfma_f32_16x16x32_bf16 v[72:75], v[44:47], a[28:31], v[72:75]
s_add_u32 m0, s46, 0
v_mfma_f32_16x16x32_bf16 v[76:79], v[48:51], a[24:27], v[76:79]
ds_read_b128 v[40:43], v10 offset:14336
v_mfma_f32_16x16x32_bf16 v[80:83], v[48:51], a[28:31], v[80:83]
buffer_load_dwordx4 v6, s[8:11], s50 offen offset:0 lds
s_waitcnt lgkmcnt(4)
v_mfma_f32_16x16x32_bf16 v[68:71], v[20:23], a[32:35], v[68:71]
ds_read_b128 v[44:47], v11 offset:12288
v_mfma_f32_16x16x32_bf16 v[72:75], v[20:23], a[36:39], v[72:75]
s_add_u32 m0, s46, 3968
v_mfma_f32_16x16x32_bf16 v[76:79], v[24:27], a[32:35], v[76:79]
ds_read_b128 v[48:51], v11 offset:14336
v_mfma_f32_16x16x32_bf16 v[80:83], v[24:27], a[36:39], v[80:83]
buffer_load_dwordx4 v6, s[8:11], s50 offen offset:128 lds
s_waitcnt lgkmcnt(4)
v_mfma_f32_16x16x32_bf16 v[68:71], v[28:31], a[40:43], v[68:71]
ds_read_b128 v[20:23], v10 offset:16384
v_mfma_f32_16x16x32_bf16 v[72:75], v[28:31], a[44:47], v[72:75]
s_add_u32 m0, s46, 7936
v_mfma_f32_16x16x32_bf16 v[76:79], v[32:35], a[40:43], v[76:79]
ds_read_b128 v[24:27], v10 offset:18432
v_mfma_f32_16x16x32_bf16 v[80:83], v[32:35], a[44:47], v[80:83]
buffer_load_dwordx4 v6, s[8:11], s50 offen offset:256 lds
s_waitcnt lgkmcnt(4)
v_mfma_f32_16x16x32_bf16 v[68:71], v[36:39], a[48:51], v[68:71]
ds_read_b128 v[28:31], v11 offset:16384
v_mfma_f32_16x16x32_bf16 v[72:75], v[36:39], a[52:55], v[72:75]
s_add_u32 m0, s46, 11904
v_mfma_f32_16x16x32_bf16 v[76:79], v[40:43], a[48:51], v[76:79]
ds_read_b128 v[32:35], v11 offset:18432
v_mfma_f32_16x16x32_bf16 v[80:83], v[40:43], a[52:55], v[80:83]
buffer_load_dwordx4 v6, s[8:11], s50 offen offset:384 lds
s_waitcnt lgkmcnt(4)
v_mfma_f32_16x16x32_bf16 v[68:71], v[44:47], a[56:59], v[68:71]
ds_read_b128 v[36:39], v10 offset:20480
v_mfma_f32_16x16x32_bf16 v[72:75], v[44:47], a[60:63], v[72:75]
s_add_u32 m0, s46, 15872
v_mfma_f32_16x16x32_bf16 v[76:79], v[48:51], a[56:59], v[76:79]
ds_read_b128 v[40:43], v10 offset:22528
v_mfma_f32_16x16x32_bf16 v[80:83], v[48:51], a[60:63], v[80:83]
buffer_load_dwordx4 v6, s[8:11], s50 offen offset:512 lds
s_waitcnt lgkmcnt(4)
v_mfma_f32_16x16x32_bf16 v[68:71], v[20:23], a[64:67], v[68:71]
ds_read_b128 v[44:47], v11 offset:20480
v_mfma_f32_16x16x32_bf16 v[72:75], v[20:23], a[68:71], v[72:75]
s_add_u32 m0, s46, 19840
v_mfma_f32_16x16x32_bf16 v[76:79], v[24:27], a[64:67], v[76:79]
ds_read_b128 v[48:51], v11 offset:22528
v_mfma_f32_16x16x32_bf16 v[80:83], v[24:27], a[68:71], v[80:83]
buffer_load_dwordx4 v6, s[8:11], s50 offen offset:640 lds
s_waitcnt lgkmcnt(4)
v_mfma_f32_16x16x32_bf16 v[68:71], v[28:31], a[72:75], v[68:71]
ds_read_b128 v[20:23], v10 offset:24576
v_mfma_f32_16x16x32_bf16 v[72:75], v[28:31], a[76:79], v[72:75]
s_add_u32 m0, s46, 23808
v_mfma_f32_16x16x32_bf16 v[76:79], v[32:35], a[72:75], v[76:79]
ds_read_b128 v[24:27], v10 offset:26624
v_mfma_f32_16x16x32_bf16 v[80:83], v[32:35], a[76:79], v[80:83]
buffer_load_dwordx4 v6, s[8:11], s50 offen offset:768 lds
s_waitcnt lgkmcnt(4)
v_mfma_f32_16x16x32_bf16 v[68:71], v[36:39], a[80:83], v[68:71]
ds_read_b128 v[28:31], v11 offset:24576
v_mfma_f32_16x16x32_bf16 v[72:75], v[36:39], a[84:87], v[72:75]
s_add_u32 m0, s46, 27776
v_mfma_f32_16x16x32_bf16 v[76:79], v[40:43], a[80:83], v[76:79]
ds_read_b128 v[32:35], v11 offset:26624
v_mfma_f32_16x16x32_bf16 v[80:83], v[40:43], a[84:87], v[80:83]
buffer_load_dwordx4 v6, s[8:11], s50 offen offset:896 lds
s_waitcnt lgkmcnt(4)
v_mfma_f32_16x16x32_bf16 v[68:71], v[44:47], a[88:91], v[68:71]
ds_read_b128 v[36:39], v10 offset:28672
v_mfma_f32_16x16x32_bf16 v[72:75], v[44:47], a[92:95], v[72:75]
s_add_u32 m0, s46, 31744
v_mfma_f32_16x16x32_bf16 v[76:79], v[48:51], a[88:91], v[76:79]
ds_read_b128 v[40:43], v10 offset:30720
v_mfma_f32_16x16x32_bf16 v[80:83], v[48:51], a[92:95], v[80:83]
buffer_load_dwordx4 v6, s[8:11], s50 offen offset:1024 lds
s_waitcnt lgkmcnt(4)
v_mfma_f32_16x16x32_bf16 v[68:71], v[20:23], a[96:99], v[68:71]
ds_read_b128 v[44:47], v11 offset:28672
v_mfma_f32_16x16x32_bf16 v[72:75], v[20:23], a[100:103], v[72:75]
s_add_u32 m0, s46, 35712
v_mfma_f32_16x16x32_bf16 v[76:79], v[24:27], a[96:99], v[76:79]
ds_read_b128 v[48:51], v11 offset:30720
v_mfma_f32_16x16x32_bf16 v[80:83], v[24:27], a[100:103], v[80:83]
buffer_load_dwordx4 v6, s[8:11], s50 offen offset:1152 lds
s_waitcnt lgkmcnt(4)
v_mfma_f32_16x16x32_bf16 v[68:71], v[28:31], a[104:107], v[68:71]
ds_read_b128 v[20:23], v10 offset:32768
v_mfma_f32_16x16x32_bf16 v[72:75], v[28:31], a[108:111], v[72:75]
s_add_u32 m0, s46, 39680
v_mfma_f32_16x16x32_bf16 v[76:79], v[32:35], a[104:107], v[76:79]
ds_read_b128 v[24:27], v10 offset:34816
v_mfma_f32_16x16x32_bf16 v[80:83], v[32:35], a[108:111], v[80:83]
buffer_load_dwordx4 v6, s[8:11], s50 offen offset:1280 lds
s_waitcnt lgkmcnt(4)
v_mfma_f32_16x16x32_bf16 v[68:71], v[36:39], a[112:115], v[68:71]
ds_read_b128 v[28:31], v11 offset:32768
v_mfma_f32_16x16x32_bf16 v[72:75], v[36:39], a[116:119], v[72:75]
s_add_u32 m0, s46, 43648
v_mfma_f32_16x16x32_bf16 v[76:79], v[40:43], a[112:115], v[76:79]
ds_read_b128 v[32:35], v11 offset:34816
v_mfma_f32_16x16x32_bf16 v[80:83], v[40:43], a[116:119], v[80:83]
buffer_load_dwordx4 v6, s[8:11], s50 offen offset:1408 lds
s_waitcnt lgkmcnt(4)
v_mfma_f32_16x16x32_bf16 v[68:71], v[44:47], a[120:123], v[68:71]
ds_read_b128 v[36:39], v10 offset:36864
v_mfma_f32_16x16x32_bf16 v[72:75], v[44:47], a[124:127], v[72:75]
s_add_u32 m0, s46, 47616
v_mfma_f32_16x16x32_bf16 v[76:79], v[48:51], a[120:123], v[76:79]
ds_read_b128 v[40:43], v10 offset:38912
v_mfma_f32_16x16x32_bf16 v[80:83], v[48:51], a[124:127], v[80:83]
buffer_load_dwordx4 v6, s[8:11], s50 offen offset:1536 lds
s_waitcnt lgkmcnt(4)
v_mfma_f32_16x16x32_bf16 v[68:71], v[20:23], a[128:131], v[68:71]
ds_read_b128 v[44:47], v11 offset:36864
v_mfma_f32_16x16x32_bf16 v[72:75], v[20:23], a[132:135], v[72:75]
s_add_u32 m0, s46, 51584
v_mfma_f32_16x16x32_bf16 v[76:79], v[24:27], a[128:131], v[76:79]
ds_read_b128 v[48:51], v11 offset:38912
v_mfma_f32_16x16x32_bf16 v[80:83], v[24:27], a[132:135], v[80:83]
buffer_load_dwordx4 v6, s[8:11], s50 offen offset:1664 lds
s_waitcnt lgkmcnt(4)
v_mfma_f32_16x16x32_bf16 v[68:71], v[28:31], a[136:139], v[68:71]
ds_read_b128 v[20:23], v10 offset:40960
v_mfma_f32_16x16x32_bf16 v[72:75], v[28:31], a[140:143], v[72:75]
s_add_u32 m0, s46, 55552
v_mfma_f32_16x16x32_bf16 v[76:79], v[32:35], a[136:139], v[76:79]
ds_read_b128 v[24:27], v10 offset:43008
v_mfma_f32_16x16x32_bf16 v[80:83], v[32:35], a[140:143], v[80:83]
buffer_load_dwordx4 v6, s[8:11], s50 offen offset:1792 lds
s_waitcnt lgkmcnt(4)
v_mfma_f32_16x16x32_bf16 v[68:71], v[36:39], a[144:147], v[68:71]
ds_read_b128 v[28:31], v11 offset:40960
v_mfma_f32_16x16x32_bf16 v[72:75], v[36:39], a[148:151], v[72:75]
s_add_u32 m0, s46, 59520
v_mfma_f32_16x16x32_bf16 v[76:79], v[40:43], a[144:147], v[76:79]
ds_read_b128 v[32:35], v11 offset:43008
v_mfma_f32_16x16x32_bf16 v[80:83], v[40:43], a[148:151], v[80:83]
buffer_load_dwordx4 v6, s[8:11], s50 offen offset:1920 lds
s_waitcnt lgkmcnt(4)
v_mfma_f32_16x16x32_bf16 v[68:71], v[44:47], a[152:155], v[68:71]
ds_read_b128 v[36:39], v10 offset:45056
v_mfma_f32_16x16x32_bf16 v[72:75], v[44:47], a[156:159], v[72:75]
v_mfma_f32_16x16x32_bf16 v[76:79], v[48:51], a[152:155], v[76:79]
ds_read_b128 v[40:43], v10 offset:47104
v_mfma_f32_16x16x32_bf16 v[80:83], v[48:51], a[156:159], v[80:83]
s_waitcnt lgkmcnt(4)
v_mfma_f32_16x16x32_bf16 v[68:71], v[20:23], a[160:163], v[68:71]
ds_read_b128 v[44:47], v11 offset:45056
v_mfma_f32_16x16x32_bf16 v[72:75], v[20:23], a[164:167], v[72:75]
v_mfma_f32_16x16x32_bf16 v[76:79], v[24:27], a[160:163], v[76:79]
ds_read_b128 v[48:51], v11 offset:47104
v_mfma_f32_16x16x32_bf16 v[80:83], v[24:27], a[164:167], v[80:83]
s_waitcnt lgkmcnt(4)
v_mfma_f32_16x16x32_bf16 v[68:71], v[28:31], a[168:171], v[68:71]
ds_read_b128 v[20:23], v10 offset:49152
v_mfma_f32_16x16x32_bf16 v[72:75], v[28:31], a[172:175], v[72:75]
s_waitcnt vmcnt(16)
v_mov_b32 v17, s42
s_mov_b64 exec, 1
buffer_store_dword v17, v16, s[84:87], s49 offen sc1
s_mov_b64 exec, -1
v_mfma_f32_16x16x32_bf16 v[76:79], v[32:35], a[168:171], v[76:79]
ds_read_b128 v[24:27], v10 offset:51200
v_mfma_f32_16x16x32_bf16 v[80:83], v[32:35], a[172:175], v[80:83]
s_waitcnt lgkmcnt(4)
v_mfma_f32_16x16x32_bf16 v[68:71], v[36:39], a[176:179], v[68:71]
ds_read_b128 v[28:31], v11 offset:49152
v_mfma_f32_16x16x32_bf16 v[72:75], v[36:39], a[180:183], v[72:75]
s_add_u32 s53, s42, 3
s_min_u32 s53, s53, 63
s_lshl_b32 s53, s53, 16
s_mov_b64 exec, 0xffff
buffer_load_dword v250, v19, s[8:11], s53 offen
s_mov_b64 exec, -1
v_mfma_f32_16x16x32_bf16 v[76:79], v[40:43], a[176:179], v[76:79]
ds_read_b128 v[32:35], v11 offset:51200
v_mfma_f32_16x16x32_bf16 v[80:83], v[40:43], a[180:183], v[80:83]
s_waitcnt lgkmcnt(4)
v_mfma_f32_16x16x32_bf16 v[68:71], v[44:47], a[184:187], v[68:71]
ds_read_b128 v[36:39], v10 offset:53248
v_mfma_f32_16x16x32_bf16 v[72:75], v[44:47], a[188:191], v[72:75]
v_mfma_f32_16x16x32_bf16 v[76:79], v[48:51], a[184:187], v[76:79]
ds_read_b128 v[40:43], v10 offset:55296
v_mfma_f32_16x16x32_bf16 v[80:83], v[48:51], a[188:191], v[80:83]
s_waitcnt lgkmcnt(4)
v_mfma_f32_16x16x32_bf16 v[68:71], v[20:23], a[192:195], v[68:71]
ds_read_b128 v[44:47], v11 offset:53248
v_mfma_f32_16x16x32_bf16 v[72:75], v[20:23], a[196:199], v[72:75]
v_mfma_f32_16x16x32_bf16 v[76:79], v[24:27], a[192:195], v[76:79]
ds_read_b128 v[48:51], v11 offset:55296
v_mfma_f32_16x16x32_bf16 v[80:83], v[24:27], a[196:199], v[80:83]
s_waitcnt lgkmcnt(4)
v_mfma_f32_16x16x32_bf16 v[68:71], v[28:31], a[200:203], v[68:71]
ds_read_b128 v[20:23], v10 offset:57344
v_mfma_f32_16x16x32_bf16 v[72:75], v[28:31], a[204:207], v[72:75]
v_mfma_f32_16x16x32_bf16 v[76:79], v[32:35], a[200:203], v[76:79]
ds_read_b128 v[24:27], v10 offset:59392
v_mfma_f32_16x16x32_bf16 v[80:83], v[32:35], a[204:207], v[80:83]
s_waitcnt lgkmcnt(4)
v_mfma_f32_16x16x32_bf16 v[68:71], v[36:39], a[208:211], v[68:71]
ds_read_b128 v[28:31], v11 offset:57344
v_mfma_f32_16x16x32_bf16 v[72:75], v[36:39], a[212:215], v[72:75]
v_mfma_f32_16x16x32_bf16 v[76:79], v[40:43], a[208:211], v[76:79]
ds_read_b128 v[32:35], v11 offset:59392
v_mfma_f32_16x16x32_bf16 v[80:83], v[40:43], a[212:215], v[80:83]
s_waitcnt lgkmcnt(4)
v_mfma_f32_16x16x32_bf16 v[68:71], v[44:47], a[216:219], v[68:71]
ds_read_b128 v[36:39], v10 offset:61440
v_mfma_f32_16x16x32_bf16 v[72:75], v[44:47], a[220:223], v[72:75]
v_mfma_f32_16x16x32_bf16 v[76:79], v[48:51], a[216:219], v[76:79]
ds_read_b128 v[40:43], v10 offset:63488
v_mfma_f32_16x16x32_bf16 v[80:83], v[48:51], a[220:223], v[80:83]
s_waitcnt lgkmcnt(4)
v_mfma_f32_16x16x32_bf16 v[68:71], v[20:23], a[224:227], v[68:71]
ds_read_b128 v[44:47], v11 offset:61440
v_mfma_f32_16x16x32_bf16 v[72:75], v[20:23], a[228:231], v[72:75]
v_mfma_f32_16x16x32_bf16 v[76:79], v[24:27], a[224:227], v[76:79]
ds_read_b128 v[48:51], v11 offset:63488
v_mfma_f32_16x16x32_bf16 v[80:83], v[24:27], a[228:231], v[80:83]
s_waitcnt lgkmcnt(5)
v_mfma_f32_16x16x32_bf16 v[68:71], v[28:31], a[232:235], v[68:71]
v_mfma_f32_16x16x32_bf16 v[72:75], v[28:31], a[236:239], v[72:75]
s_waitcnt lgkmcnt(4)
v_mfma_f32_16x16x32_bf16 v[76:79], v[32:35], a[232:235], v[76:79]
v_mfma_f32_16x16x32_bf16 v[80:83], v[32:35], a[236:239], v[80:83]
s_waitcnt lgkmcnt(3)
v_mfma_f32_16x16x32_bf16 v[68:71], v[36:39], a[240:243], v[68:71]
v_mfma_f32_16x16x32_bf16 v[72:75], v[36:39], a[244:247], v[72:75]
s_waitcnt lgkmcnt(2)
v_mfma_f32_16x16x32_bf16 v[76:79], v[40:43], a[240:243], v[76:79]
v_mfma_f32_16x16x32_bf16 v[80:83], v[40:43], a[244:247], v[80:83]
s_waitcnt lgkmcnt(1)
v_mfma_f32_16x16x32_bf16 v[68:71], v[44:47], a[248:251], v[68:71]
v_mfma_f32_16x16x32_bf16 v[72:75], v[44:47], a[252:255], v[72:75]
s_waitcnt lgkmcnt(0)
v_mfma_f32_16x16x32_bf16 v[76:79], v[48:51], a[248:251], v[76:79]
v_mfma_f32_16x16x32_bf16 v[80:83], v[48:51], a[252:255], v[80:83]
s_add_u32 s42, s42, 1
s_cmp_eq_u32 s42, 64
s_cbranch_scc1 mega_kernel_v_fin
mega_kernel_v_mid:
s_waitcnt vmcnt(2)
s_barrier
s_add_u32 s50, s42, 1
s_min_u32 s50, s50, 63
s_lshl_b32 s50, s50, 16
ds_read_b128 v[20:23], v8 offset:0
ds_read_b128 v[24:27], v8 offset:2048
ds_read_b128 v[28:31], v9 offset:0
ds_read_b128 v[32:35], v9 offset:2048
ds_read_b128 v[36:39], v8 offset:4096
ds_read_b128 v[40:43], v8 offset:6144
s_waitcnt lgkmcnt(4)
v_mfma_f32_16x16x32_bf16 v[52:55], v[20:23], a[0:3], 0
ds_read_b128 v[44:47], v9 offset:4096
v_mfma_f32_16x16x32_bf16 v[56:59], v[20:23], a[4:7], 0
v_cvt_pk_bf16_f32 v84, v68, v69
v_cvt_pk_bf16_f32 v85, v70, v71
v_cvt_pk_bf16_f32 v86, v76, v77
v_mfma_f32_16x16x32_bf16 v[60:63], v[24:27], a[0:3], 0
ds_read_b128 v[48:51], v9 offset:6144
v_mfma_f32_16x16x32_bf16 v[64:67], v[24:27], a[4:7], 0
v_cvt_pk_bf16_f32 v87, v78, v79
v_cvt_pk_bf16_f32 v88, v72, v73
v_cvt_pk_bf16_f32 v89, v74, v75
s_waitcnt lgkmcnt(4)
v_mfma_f32_16x16x32_bf16 v[52:55], v[28:31], a[8:11], v[52:55]
ds_read_b128 v[20:23], v8 offset:8192
v_mfma_f32_16x16x32_bf16 v[56:59], v[28:31], a[12:15], v[56:59]
v_cvt_pk_bf16_f32 v90, v80, v81
v_cvt_pk_bf16_f32 v91, v82, v83
v_mfma_f32_16x16x32_bf16 v[60:63], v[32:35], a[8:11], v[60:63]
ds_read_b128 v[24:27], v8 offset:10240
v_mfma_f32_16x16x32_bf16 v[64:67], v[32:35], a[12:15], v[64:67]
s_add_u32 s51, s42, s47
s_sub_u32 s51, s51, 1
s_bfe_u32 s52, s51, 0x40002
s_lshl_b32 s52, s52, 14
s_waitcnt lgkmcnt(4)
v_mfma_f32_16x16x32_bf16 v[52:55], v[36:39], a[16:19], v[52:55]
ds_read_b128 v[28:31], v9 offset:8192
v_mfma_f32_16x16x32_bf16 v[56:59], v[36:39], a[20:23], v[56:59]
s_and_b32 s51, s51, 3
s_lshl_b32 s51, s51, 11
s_add_u32 s51, s51, s52
s_add_u32 s51, s51, s48
buffer_store_dwordx4 v[84:87], v7, s[84:87], s51 offen sc1
v_mfma_f32_16x16x32_bf16 v[60:63], v[40:43], a[16:19], v[60:63]
ds_read_b128 v[32:35], v9 offset:10240
v_mfma_f32_16x16x32_bf16 v[64:67], v[40:43], a[20:23], v[64:67]
buffer_store_dwordx4 v[88:91], v7, s[84:87], s51 offen offset:1024 sc1
s_waitcnt lgkmcnt(4)
v_mfma_f32_16x16x32_bf16 v[52:55], v[44:47], a[24:27], v[52:55]
ds_read_b128 v[36:39], v8 offset:12288
v_mfma_f32_16x16x32_bf16 v[56:59], v[44:47], a[28:31], v[56:59]
s_add_u32 m0, s46, 65536
v_mfma_f32_16x16x32_bf16 v[60:63], v[48:51], a[24:27], v[60:63]
ds_read_b128 v[40:43], v8 offset:14336
v_mfma_f32_16x16x32_bf16 v[64:67], v[48:51], a[28:31], v[64:67]
buffer_load_dwordx4 v6, s[8:11], s50 offen offset:0 lds
s_waitcnt lgkmcnt(4)
v_mfma_f32_16x16x32_bf16 v[52:55], v[20:23], a[32:35], v[52:55]
ds_read_b128 v[44:47], v9 offset:12288
v_mfma_f32_16x16x32_bf16 v[56:59], v[20:23], a[36:39], v[56:59]
s_add_u32 m0, s46, 69504
v_mfma_f32_16x16x32_bf16 v[60:63], v[24:27], a[32:35], v[60:63]
ds_read_b128 v[48:51], v9 offset:14336
v_mfma_f32_16x16x32_bf16 v[64:67], v[24:27], a[36:39], v[64:67]
buffer_load_dwordx4 v6, s[8:11], s50 offen offset:128 lds
s_waitcnt lgkmcnt(4)
v_mfma_f32_16x16x32_bf16 v[52:55], v[28:31], a[40:43], v[52:55]
ds_read_b128 v[20:23], v8 offset:16384
v_mfma_f32_16x16x32_bf16 v[56:59], v[28:31], a[44:47], v[56:59]
s_add_u32 m0, s46, 73472
v_mfma_f32_16x16x32_bf16 v[60:63], v[32:35], a[40:43], v[60:63]
ds_read_b128 v[24:27], v8 offset:18432
v_mfma_f32_16x16x32_bf16 v[64:67], v[32:35], a[44:47], v[64:67]
buffer_load_dwordx4 v6, s[8:11], s50 offen offset:256 lds
s_waitcnt lgkmcnt(4)
v_mfma_f32_16x16x32_bf16 v[52:55], v[36:39], a[48:51], v[52:55]
ds_read_b128 v[28:31], v9 offset:16384
v_mfma_f32_16x16x32_bf16 v[56:59], v[36:39], a[52:55], v[56:59]
s_add_u32 m0, s46, 77440
v_mfma_f32_16x16x32_bf16 v[60:63], v[40:43], a[48:51], v[60:63]
ds_read_b128 v[32:35], v9 offset:18432
v_mfma_f32_16x16x32_bf16 v[64:67], v[40:43], a[52:55], v[64:67]
buffer_load_dwordx4 v6, s[8:11], s50 offen offset:384 lds
s_waitcnt lgkmcnt(4)
v_mfma_f32_16x16x32_bf16 v[52:55], v[44:47], a[56:59], v[52:55]
ds_read_b128 v[36:39], v8 offset:20480
v_mfma_f32_16x16x32_bf16 v[56:59], v[44:47], a[60:63], v[56:59]
s_add_u32 m0, s46, 81408
v_mfma_f32_16x16x32_bf16 v[60:63], v[48:51], a[56:59], v[60:63]
ds_read_b128 v[40:43], v8 offset:22528
v_mfma_f32_16x16x32_bf16 v[64:67], v[48:51], a[60:63], v[64:67]
buffer_load_dwordx4 v6, s[8:11], s50 offen offset:512 lds
s_waitcnt lgkmcnt(4)
v_mfma_f32_16x16x32_bf16 v[52:55], v[20:23], a[64:67], v[52:55]
ds_read_b128 v[44:47], v9 offset:20480
v_mfma_f32_16x16x32_bf16 v[56:59], v[20:23], a[68:71], v[56:59]
s_add_u32 m0, s46, 85376
v_mfma_f32_16x16x32_bf16 v[60:63], v[24:27], a[64:67], v[60:63]
ds_read_b128 v[48:51], v9 offset:22528
v_mfma_f32_16x16x32_bf16 v[64:67], v[24:27], a[68:71], v[64:67]
buffer_load_dwordx4 v6, s[8:11], s50 offen offset:640 lds
s_waitcnt lgkmcnt(4)
v_mfma_f32_16x16x32_bf16 v[52:55], v[28:31], a[72:75], v[52:55]
ds_read_b128 v[20:23], v8 offset:24576
v_mfma_f32_16x16x32_bf16 v[56:59], v[28:31], a[76:79], v[56:59]
s_add_u32 m0, s46, 89344
v_mfma_f32_16x16x32_bf16 v[60:63], v[32:35], a[72:75], v[60:63]
ds_read_b128 v[24:27], v8 offset:26624
v_mfma_f32_16x16x32_bf16 v[64:67], v[32:35], a[76:79], v[64:67]
buffer_load_dwordx4 v6, s[8:11], s50 offen offset:768 lds
s_waitcnt lgkmcnt(4)
v_mfma_f32_16x16x32_bf16 v[52:55], v[36:39], a[80:83], v[52:55]
ds_read_b128 v[28:31], v9 offset:24576
v_mfma_f32_16x16x32_bf16 v[56:59], v[36:39], a[84:87], v[56:59]
s_add_u32 m0, s46, 93312
v_mfma_f32_16x16x32_bf16 v[60:63], v[40:43], a[80:83], v[60:63]
ds_read_b128 v[32:35], v9 offset:26624
v_mfma_f32_16x16x32_bf16 v[64:67], v[40:43], a[84:87], v[64:67]
buffer_load_dwordx4 v6, s[8:11], s50 offen offset:896 lds
s_waitcnt lgkmcnt(4)
v_mfma_f32_16x16x32_bf16 v[52:55], v[44:47], a[88:91], v[52:55]
ds_read_b128 v[36:39], v8 offset:28672
v_mfma_f32_16x16x32_bf16 v[56:59], v[44:47], a[92:95], v[56:59]
s_add_u32 m0, s46, 97280
v_mfma_f32_16x16x32_bf16 v[60:63], v[48:51], a[88:91], v[60:63]
ds_read_b128 v[40:43], v8 offset:30720
v_mfma_f32_16x16x32_bf16 v[64:67], v[48:51], a[92:95], v[64:67]
buffer_load_dwordx4 v6, s[8:11], s50 offen offset:1024 lds
s_waitcnt lgkmcnt(4)
v_mfma_f32_16x16x32_bf16 v[52:55], v[20:23], a[96:99], v[52:55]
ds_read_b128 v[44:47], v9 offset:28672
v_mfma_f32_16x16x32_bf16 v[56:59], v[20:23], a[100:103], v[56:59]
s_add_u32 m0, s46, 101248
v_mfma_f32_16x16x32_bf16 v[60:63], v[24:27], a[96:99], v[60:63]
ds_read_b128 v[48:51], v9 offset:30720
v_mfma_f32_16x16x32_bf16 v[64:67], v[24:27], a[100:103], v[64:67]
buffer_load_dwordx4 v6, s[8:11], s50 offen offset:1152 lds
s_waitcnt lgkmcnt(4)
v_mfma_f32_16x16x32_bf16 v[52:55], v[28:31], a[104:107], v[52:55]
ds_read_b128 v[20:23], v8 offset:32768
v_mfma_f32_16x16x32_bf16 v[56:59], v[28:31], a[108:111], v[56:59]
s_add_u32 m0, s46, 105216
v_mfma_f32_16x16x32_bf16 v[60:63], v[32:35], a[104:107], v[60:63]
ds_read_b128 v[24:27], v8 offset:34816
v_mfma_f32_16x16x32_bf16 v[64:67], v[32:35], a[108:111], v[64:67]
buffer_load_dwordx4 v6, s[8:11], s50 offen offset:1280 lds
s_waitcnt lgkmcnt(4)
v_mfma_f32_16x16x32_bf16 v[52:55], v[36:39], a[112:115], v[52:55]
ds_read_b128 v[28:31], v9 offset:32768
v_mfma_f32_16x16x32_bf16 v[56:59], v[36:39], a[116:119], v[56:59]
s_add_u32 m0, s46, 109184
v_mfma_f32_16x16x32_bf16 v[60:63], v[40:43], a[112:115], v[60:63]
ds_read_b128 v[32:35], v9 offset:34816
v_mfma_f32_16x16x32_bf16 v[64:67], v[40:43], a[116:119], v[64:67]
buffer_load_dwordx4 v6, s[8:11], s50 offen offset:1408 lds
s_waitcnt lgkmcnt(4)
v_mfma_f32_16x16x32_bf16 v[52:55], v[44:47], a[120:123], v[52:55]
ds_read_b128 v[36:39], v8 offset:36864
v_mfma_f32_16x16x32_bf16 v[56:59], v[44:47], a[124:127], v[56:59]
s_add_u32 m0, s46, 113152
v_mfma_f32_16x16x32_bf16 v[60:63], v[48:51], a[120:123], v[60:63]
ds_read_b128 v[40:43], v8 offset:38912
v_mfma_f32_16x16x32_bf16 v[64:67], v[48:51], a[124:127], v[64:67]
buffer_load_dwordx4 v6, s[8:11], s50 offen offset:1536 lds
s_waitcnt lgkmcnt(4)
v_mfma_f32_16x16x32_bf16 v[52:55], v[20:23], a[128:131], v[52:55]
ds_read_b128 v[44:47], v9 offset:36864
v_mfma_f32_16x16x32_bf16 v[56:59], v[20:23], a[132:135], v[56:59]
s_add_u32 m0, s46, 117120
v_mfma_f32_16x16x32_bf16 v[60:63], v[24:27], a[128:131], v[60:63]
ds_read_b128 v[48:51], v9 offset:38912
v_mfma_f32_16x16x32_bf16 v[64:67], v[24:27], a[132:135], v[64:67]
buffer_load_dwordx4 v6, s[8:11], s50 offen offset:1664 lds
s_waitcnt lgkmcnt(4)
v_mfma_f32_16x16x32_bf16 v[52:55], v[28:31], a[136:139], v[52:55]
ds_read_b128 v[20:23], v8 offset:40960
v_mfma_f32_16x16x32_bf16 v[56:59], v[28:31], a[140:143], v[56:59]
s_add_u32 m0, s46, 121088
v_mfma_f32_16x16x32_bf16 v[60:63], v[32:35], a[136:139], v[60:63]
ds_read_b128 v[24:27], v8 offset:43008
v_mfma_f32_16x16x32_bf16 v[64:67], v[32:35], a[140:143], v[64:67]
buffer_load_dwordx4 v6, s[8:11], s50 offen offset:1792 lds
s_waitcnt lgkmcnt(4)
v_mfma_f32_16x16x32_bf16 v[52:55], v[36:39], a[144:147], v[52:55]
ds_read_b128 v[28:31], v9 offset:40960
v_mfma_f32_16x16x32_bf16 v[56:59], v[36:39], a[148:151], v[56:59]
s_add_u32 m0, s46, 125056
v_mfma_f32_16x16x32_bf16 v[60:63], v[40:43], a[144:147], v[60:63]
ds_read_b128 v[32:35], v9 offset:43008
v_mfma_f32_16x16x32_bf16 v[64:67], v[40:43], a[148:151], v[64:67]
buffer_load_dwordx4 v6, s[8:11], s50 offen offset:1920 lds
s_waitcnt lgkmcnt(4)
v_mfma_f32_16x16x32_bf16 v[52:55], v[44:47], a[152:155], v[52:55]
ds_read_b128 v[36:39], v8 offset:45056
v_mfma_f32_16x16x32_bf16 v[56:59], v[44:47], a[156:159], v[56:59]
v_mfma_f32_16x16x32_bf16 v[60:63], v[48:51], a[152:155], v[60:63]
ds_read_b128 v[40:43], v8 offset:47104
v_mfma_f32_16x16x32_bf16 v[64:67], v[48:51], a[156:159], v[64:67]
s_waitcnt lgkmcnt(4)
v_mfma_f32_16x16x32_bf16 v[52:55], v[20:23], a[160:163], v[52:55]
ds_read_b128 v[44:47], v9 offset:45056
v_mfma_f32_16x16x32_bf16 v[56:59], v[20:23], a[164:167], v[56:59]
v_mfma_f32_16x16x32_bf16 v[60:63], v[24:27], a[160:163], v[60:63]
ds_read_b128 v[48:51], v9 offset:47104
v_mfma_f32_16x16x32_bf16 v[64:67], v[24:27], a[164:167], v[64:67]
s_waitcnt lgkmcnt(4)
v_mfma_f32_16x16x32_bf16 v[52:55], v[28:31], a[168:171], v[52:55]
ds_read_b128 v[20:23], v8 offset:49152
v_mfma_f32_16x16x32_bf16 v[56:59], v[28:31], a[172:175], v[56:59]
s_waitcnt vmcnt(16)
v_mov_b32 v17, s42
s_mov_b64 exec, 1
buffer_store_dword v17, v16, s[84:87], s49 offen sc1
s_mov_b64 exec, -1
v_mfma_f32_16x16x32_bf16 v[60:63], v[32:35], a[168:171], v[60:63]
ds_read_b128 v[24:27], v8 offset:51200
v_mfma_f32_16x16x32_bf16 v[64:67], v[32:35], a[172:175], v[64:67]
s_waitcnt lgkmcnt(4)
v_mfma_f32_16x16x32_bf16 v[52:55], v[36:39], a[176:179], v[52:55]
ds_read_b128 v[28:31], v9 offset:49152
v_mfma_f32_16x16x32_bf16 v[56:59], v[36:39], a[180:183], v[56:59]
s_add_u32 s53, s42, 3
s_min_u32 s53, s53, 63
s_lshl_b32 s53, s53, 16
s_mov_b64 exec, 0xffff
buffer_load_dword v250, v19, s[8:11], s53 offen
s_mov_b64 exec, -1
v_mfma_f32_16x16x32_bf16 v[60:63], v[40:43], a[176:179], v[60:63]
ds_read_b128 v[32:35], v9 offset:51200
v_mfma_f32_16x16x32_bf16 v[64:67], v[40:43], a[180:183], v[64:67]
s_waitcnt lgkmcnt(4)
v_mfma_f32_16x16x32_bf16 v[52:55], v[44:47], a[184:187], v[52:55]
ds_read_b128 v[36:39], v8 offset:53248
v_mfma_f32_16x16x32_bf16 v[56:59], v[44:47], a[188:191], v[56:59]
v_mfma_f32_16x16x32_bf16 v[60:63], v[48:51], a[184:187], v[60:63]
ds_read_b128 v[40:43], v8 offset:55296
v_mfma_f32_16x16x32_bf16 v[64:67], v[48:51], a[188:191], v[64:67]
s_waitcnt lgkmcnt(4)
v_mfma_f32_16x16x32_bf16 v[52:55], v[20:23], a[192:195], v[52:55]
ds_read_b128 v[44:47], v9 offset:53248
v_mfma_f32_16x16x32_bf16 v[56:59], v[20:23], a[196:199], v[56:59]
v_mfma_f32_16x16x32_bf16 v[60:63], v[24:27], a[192:195], v[60:63]
ds_read_b128 v[48:51], v9 offset:55296
v_mfma_f32_16x16x32_bf16 v[64:67], v[24:27], a[196:199], v[64:67]
s_waitcnt lgkmcnt(4)
v_mfma_f32_16x16x32_bf16 v[52:55], v[28:31], a[200:203], v[52:55]
ds_read_b128 v[20:23], v8 offset:57344
v_mfma_f32_16x16x32_bf16 v[56:59], v[28:31], a[204:207], v[56:59]
v_mfma_f32_16x16x32_bf16 v[60:63], v[32:35], a[200:203], v[60:63]
ds_read_b128 v[24:27], v8 offset:59392
v_mfma_f32_16x16x32_bf16 v[64:67], v[32:35], a[204:207], v[64:67]
s_waitcnt lgkmcnt(4)
v_mfma_f32_16x16x32_bf16 v[52:55], v[36:39], a[208:211], v[52:55]
ds_read_b128 v[28:31], v9 offset:57344
v_mfma_f32_16x16x32_bf16 v[56:59], v[36:39], a[212:215], v[56:59]
v_mfma_f32_16x16x32_bf16 v[60:63], v[40:43], a[208:211], v[60:63]
ds_read_b128 v[32:35], v9 offset:59392
v_mfma_f32_16x16x32_bf16 v[64:67], v[40:43], a[212:215], v[64:67]
s_waitcnt lgkmcnt(4)
v_mfma_f32_16x16x32_bf16 v[52:55], v[44:47], a[216:219], v[52:55]
ds_read_b128 v[36:39], v8 offset:61440
v_mfma_f32_16x16x32_bf16 v[56:59], v[44:47], a[220:223], v[56:59]
v_mfma_f32_16x16x32_bf16 v[60:63], v[48:51], a[216:219], v[60:63]
ds_read_b128 v[40:43], v8 offset:63488
v_mfma_f32_16x16x32_bf16 v[64:67], v[48:51], a[220:223], v[64:67]
s_waitcnt lgkmcnt(4)
v_mfma_f32_16x16x32_bf16 v[52:55], v[20:23], a[224:227], v[52:55]
ds_read_b128 v[44:47], v9 offset:61440
v_mfma_f32_16x16x32_bf16 v[56:59], v[20:23], a[228:231], v[56:59]
v_mfma_f32_16x16x32_bf16 v[60:63], v[24:27], a[224:227], v[60:63]
ds_read_b128 v[48:51], v9 offset:63488
v_mfma_f32_16x16x32_bf16 v[64:67], v[24:27], a[228:231], v[64:67]
s_waitcnt lgkmcnt(5)
v_mfma_f32_16x16x32_bf16 v[52:55], v[28:31], a[232:235], v[52:55]
v_mfma_f32_16x16x32_bf16 v[56:59], v[28:31], a[236:239], v[56:59]
s_waitcnt lgkmcnt(4)
v_mfma_f32_16x16x32_bf16 v[60:63], v[32:35], a[232:235], v[60:63]
v_mfma_f32_16x16x32_bf16 v[64:67], v[32:35], a[236:239], v[64:67]
s_waitcnt lgkmcnt(3)
v_mfma_f32_16x16x32_bf16 v[52:55], v[36:39], a[240:243], v[52:55]
v_mfma_f32_16x16x32_bf16 v[56:59], v[36:39], a[244:247], v[56:59]
s_waitcnt lgkmcnt(2)
v_mfma_f32_16x16x32_bf16 v[60:63], v[40:43], a[240:243], v[60:63]
v_mfma_f32_16x16x32_bf16 v[64:67], v[40:43], a[244:247], v[64:67]
s_waitcnt lgkmcnt(1)
v_mfma_f32_16x16x32_bf16 v[52:55], v[44:47], a[248:251], v[52:55]
v_mfma_f32_16x16x32_bf16 v[56:59], v[44:47], a[252:255], v[56:59]
s_waitcnt lgkmcnt(0)
v_mfma_f32_16x16x32_bf16 v[60:63], v[48:51], a[248:251], v[60:63]
v_mfma_f32_16x16x32_bf16 v[64:67], v[48:51], a[252:255], v[64:67]
s_add_u32 s42, s42, 1
s_branch mega_kernel_v_loop
mega_kernel_v_fin:
s_nop 11
v_cvt_pk_bf16_f32 v84, v68, v69
v_cvt_pk_bf16_f32 v85, v70, v71
v_cvt_pk_bf16_f32 v86, v76, v77
v_cvt_pk_bf16_f32 v87, v78, v79
v_cvt_pk_bf16_f32 v88, v72, v73
v_cvt_pk_bf16_f32 v89, v74, v75
v_cvt_pk_bf16_f32 v90, v80, v81
v_cvt_pk_bf16_f32 v91, v82, v83
s_add_u32 s51, s42, s47
s_sub_u32 s51, s51, 1
s_bfe_u32 s52, s51, 0x40002
s_lshl_b32 s52, s52, 14
s_and_b32 s51, s51, 3
s_lshl_b32 s51, s51, 11
s_add_u32 s51, s51, s52
s_add_u32 s51, s51, s48
buffer_store_dwordx4 v[84:87], v7, s[84:87], s51 offen sc1
buffer_store_dwordx4 v[88:91], v7, s[84:87], s51 offen offset:1024 sc1
s_waitcnt vmcnt(0)
v_mov_b32 v17, s42
s_mov_b64 exec, 1
buffer_store_dword v17, v16, s[84:87], s49 offen sc1
s_mov_b64 exec, -1
s_waitcnt vmcnt(0)
s_barrier
mega_kernel_fft:
s_mov_b32 s38, s92
s_mov_b32 s39, 64
s_mov_b32 s37, 129
mega_kernel_f2s:
v_mov_b32 v1, 0
s_mov_b32 s82, 69259264
mega_kernel_w0:
s_sleep 8
buffer_load_dword v2, v1, s[84:87], s82 offen sc1
s_waitcnt vmcnt(0)
v_cmp_ne_u32 vcc, 31, v2
s_cbranch_vccnz mega_kernel_w0
s_mov_b32 s48, 0x3f7ec46d
s_mov_b32 s49, 0x3dc8bd36
s_mov_b32 s50, 0x3f7b14be
s_mov_b32 s51, 0x3e47c5c2
s_mov_b32 s52, 0x3f74fa0b
s_mov_b32 s53, 0x3e94a031
s_mov_b32 s54, 0x3f6c835e
s_mov_b32 s55, 0x3ec3ef15
s_mov_b32 s56, 0x3f61c598
s_mov_b32 s57, 0x3ef15aea
s_mov_b32 s58, 0x3f54db31
s_mov_b32 s59, 0x3f0e39da
s_mov_b32 s60, 0x3f45e403
s_mov_b32 s61, 0x3f226799
s_mov_b32 s62, 0x3f3504f3
s_mov_b32 s63, 0x3f3504f3
v_lshrrev_b32 v10, 6, v0
v_and_b32 v1, 63, v0
v_readfirstlane_b32 s16, v10
v_cvt_f32_u32 v2, v1
v_lshlrev_b32 v5, 3, v1
s_mul_i32 s17, s16, 16896
v_add_u32 v3, s17, v5
v_and_b32 v7, 1, v1
v_lshrrev_b32 v6, 1, v1
v_cvt_f32_u32 v8, v6
v_cvt_f32_u32 v10, v7
v_mul_u32_u24 v4, 528, v6
v_lshl_add_u32 v4, v7, 3, v4
v_add_u32 v4, s17, v4
v_lshlrev_b32 v11, 12, v7
v_lshl_add_u32 v11, v6, 2, v11
v_fma_f32 v9, v10, 2.0, -1.0
v_sub_f32 v7, 0, v9
v_mul_f32 v13, v10, v8
v_mul_f32 v13, 0x3a000000, v13
s_mov_b32 s18, 0xaaaaaaaa
s_mov_b32 s19, 0xaaaaaaaa
v_mul_f32 v12, 0xba000000, v2
v_cos_f32 v82, v12
v_sin_f32 v83, v12
v_mul_f32 v12, 0xba800000, v2
v_cos_f32 v84, v12
v_sin_f32 v85, v12
v_mul_f32 v12, 0xbac00000, v2
v_cos_f32 v86, v12
v_sin_f32 v87, v12
v_mul_f32 v12, 0xbb000000, v2
v_cos_f32 v88, v12
v_sin_f32 v89, v12
v_mul_f32 v12, 0xbb200000, v2
v_cos_f32 v90, v12
v_sin_f32 v91, v12
v_mul_f32 v12, 0xbb400000, v2
v_cos_f32 v92, v12
v_sin_f32 v93, v12
v_mul_f32 v12, 0xbb600000, v2
v_cos_f32 v94, v12
v_sin_f32 v95, v12
v_mul_f32 v12, 0xbb800000, v2
v_cos_f32 v96, v12
v_sin_f32 v97, v12
v_mul_f32 v12, 0xbb900000, v2
v_cos_f32 v98, v12
v_sin_f32 v99, v12
v_mul_f32 v12, 0xbba00000, v2
v_cos_f32 v100, v12
v_sin_f32 v101, v12
v_mul_f32 v12, 0xbbb00000, v2
v_cos_f32 v102, v12
v_sin_f32 v103, v12
v_mul_f32 v12, 0xbbc00000, v2
v_cos_f32 v104, v12
v_sin_f32 v105, v12
v_mul_f32 v12, 0xbbd00000, v2
v_cos_f32 v106, v12
v_sin_f32 v107, v12
v_mul_f32 v12, 0xbbe00000, v2
v_cos_f32 v108, v12
v_sin_f32 v109, v12
v_mul_f32 v12, 0xbbf00000, v2
v_cos_f32 v110, v12
v_sin_f32 v111, v12
v_mul_f32 v12, 0xbc000000, v2
v_cos_f32 v112, v12
v_sin_f32 v113, v12
v_mul_f32 v12, 0xbc080000, v2
v_cos_f32 v114, v12
v_sin_f32 v115, v12
v_mul_f32 v12, 0xbc100000, v2
v_cos_f32 v116, v12
v_sin_f32 v117, v12
v_mul_f32 v12, 0xbc180000, v2
v_cos_f32 v118, v12
v_sin_f32 v119, v12
v_mul_f32 v12, 0xbc200000, v2
v_cos_f32 v120, v12
v_sin_f32 v121, v12
v_mul_f32 v12, 0xbc280000, v2
v_cos_f32 v122, v12
v_sin_f32 v123, v12
v_mul_f32 v12, 0xbc300000, v2
v_cos_f32 v124, v12
v_sin_f32 v125, v12
v_mul_f32 v12, 0xbc380000, v2
v_cos_f32 v126, v12
v_sin_f32 v127, v12
v_mul_f32 v12, 0xbc400000, v2
v_cos_f32 v128, v12
v_sin_f32 v129, v12
v_mul_f32 v12, 0xbc480000, v2
v_cos_f32 v130, v12
v_sin_f32 v131, v12
v_mul_f32 v12, 0xbc500000, v2
v_cos_f32 v132, v12
v_sin_f32 v133, v12
v_mul_f32 v12, 0xbc580000, v2
v_cos_f32 v134, v12
v_sin_f32 v135, v12
v_mul_f32 v12, 0xbc600000, v2
v_cos_f32 v136, v12
v_sin_f32 v137, v12
v_mul_f32 v12, 0xbc680000, v2
v_cos_f32 v138, v12
v_sin_f32 v139, v12
v_mul_f32 v12, 0xbc700000, v2
v_cos_f32 v140, v12
v_sin_f32 v141, v12
v_mul_f32 v12, 0xbc780000, v2
v_cos_f32 v142, v12
v_sin_f32 v143, v12
v_mov_b32 v12, v13
v_fmac_f32 v12, 0x00000000, v8
v_cos_f32 v144, v12
v_sin_f32 v145, v12
v_mov_b32 v12, v13
v_fmac_f32 v12, 0x3a800000, v8
v_cos_f32 v146, v12
v_sin_f32 v147, v12
v_mov_b32 v12, v13
v_fmac_f32 v12, 0x3b000000, v8
v_cos_f32 v148, v12
v_sin_f32 v149, v12
v_mov_b32 v12, v13
v_fmac_f32 v12, 0x3b400000, v8
v_cos_f32 v150, v12
v_sin_f32 v151, v12
v_mov_b32 v12, v13
v_fmac_f32 v12, 0x3b800000, v8
v_cos_f32 v152, v12
v_sin_f32 v153, v12
v_mov_b32 v12, v13
v_fmac_f32 v12, 0x3ba00000, v8
v_cos_f32 v154, v12
v_sin_f32 v155, v12
v_mov_b32 v12, v13
v_fmac_f32 v12, 0x3bc00000, v8
v_cos_f32 v156, v12
v_sin_f32 v157, v12
v_mov_b32 v12, v13
v_fmac_f32 v12, 0x3be00000, v8
v_cos_f32 v158, v12
v_sin_f32 v159, v12
v_mov_b32 v12, v13
v_fmac_f32 v12, 0x3c000000, v8
v_cos_f32 v160, v12
v_sin_f32 v161, v12
v_mov_b32 v12, v13
v_fmac_f32 v12, 0x3c100000, v8
v_cos_f32 v162, v12
v_sin_f32 v163, v12
v_mov_b32 v12, v13
v_fmac_f32 v12, 0x3c200000, v8
v_cos_f32 v164, v12
v_sin_f32 v165, v12
v_mov_b32 v12, v13
v_fmac_f32 v12, 0x3c300000, v8
v_cos_f32 v166, v12
v_sin_f32 v167, v12
v_mov_b32 v12, v13
v_fmac_f32 v12, 0x3c400000, v8
v_cos_f32 v168, v12
v_sin_f32 v169, v12
v_mov_b32 v12, v13
v_fmac_f32 v12, 0x3c500000, v8
v_cos_f32 v170, v12
v_sin_f32 v171, v12
v_mov_b32 v12, v13
v_fmac_f32 v12, 0x3c600000, v8
v_cos_f32 v172, v12
v_sin_f32 v173, v12
v_mov_b32 v12, v13
v_fmac_f32 v12, 0x3c700000, v8
v_cos_f32 v174, v12
v_sin_f32 v175, v12
v_mov_b32 v12, v13
v_fmac_f32 v12, 0x3c800000, v8
v_cos_f32 v176, v12
v_sin_f32 v177, v12
v_mov_b32 v12, v13
v_fmac_f32 v12, 0x3c880000, v8
v_cos_f32 v178, v12
v_sin_f32 v179, v12
v_mov_b32 v12, v13
v_fmac_f32 v12, 0x3c900000, v8
v_cos_f32 v180, v12
v_sin_f32 v181, v12
v_mov_b32 v12, v13
v_fmac_f32 v12, 0x3c980000, v8
v_cos_f32 v182, v12
v_sin_f32 v183, v12
v_mov_b32 v12, v13
v_fmac_f32 v12, 0x3ca00000, v8
v_cos_f32 v184, v12
v_sin_f32 v185, v12
v_mov_b32 v12, v13
v_fmac_f32 v12, 0x3ca80000, v8
v_cos_f32 v186, v12
v_sin_f32 v187, v12
v_mov_b32 v12, v13
v_fmac_f32 v12, 0x3cb00000, v8
v_cos_f32 v188, v12
v_sin_f32 v189, v12
v_mov_b32 v12, v13
v_fmac_f32 v12, 0x3cb80000, v8
v_cos_f32 v190, v12
v_sin_f32 v191, v12
v_mov_b32 v12, v13
v_fmac_f32 v12, 0x3cc00000, v8
v_cos_f32 v192, v12
v_sin_f32 v193, v12
v_mov_b32 v12, v13
v_fmac_f32 v12, 0x3cc80000, v8
v_cos_f32 v194, v12
v_sin_f32 v195, v12
v_mov_b32 v12, v13
v_fmac_f32 v12, 0x3cd00000, v8
v_cos_f32 v196, v12
v_sin_f32 v197, v12
v_mov_b32 v12, v13
v_fmac_f32 v12, 0x3cd80000, v8
v_cos_f32 v198, v12
v_sin_f32 v199, v12
v_mov_b32 v12, v13
v_fmac_f32 v12, 0x3ce00000, v8
v_cos_f32 v200, v12
v_sin_f32 v201, v12
v_mov_b32 v12, v13
v_fmac_f32 v12, 0x3ce80000, v8
v_cos_f32 v202, v12
v_sin_f32 v203, v12
v_mov_b32 v12, v13
v_fmac_f32 v12, 0x3cf00000, v8
v_cos_f32 v204, v12
v_sin_f32 v205, v12
v_mov_b32 v12, v13
v_fmac_f32 v12, 0x3cf80000, v8
v_cos_f32 v206, v12
v_sin_f32 v207, v12
s_nop 0
v_mul_f32 v144, 0x34800000, v144
v_mul_f32 v145, 0x34800000, v145
v_mul_f32 v146, 0x34800000, v146
v_mul_f32 v147, 0x34800000, v147
v_mul_f32 v148, 0x34800000, v148
v_mul_f32 v149, 0x34800000, v149
v_mul_f32 v150, 0x34800000, v150
v_mul_f32 v151, 0x34800000, v151
v_mul_f32 v152, 0x34800000, v152
v_mul_f32 v153, 0x34800000, v153
v_mul_f32 v154, 0x34800000, v154
v_mul_f32 v155, 0x34800000, v155
v_mul_f32 v156, 0x34800000, v156
v_mul_f32 v157, 0x34800000, v157
v_mul_f32 v158, 0x34800000, v158
v_mul_f32 v159, 0x34800000, v159
v_mul_f32 v160, 0x34800000, v160
v_mul_f32 v161, 0x34800000, v161
v_mul_f32 v162, 0x34800000, v162
v_mul_f32 v163, 0x34800000, v163
v_mul_f32 v164, 0x34800000, v164
v_mul_f32 v165, 0x34800000, v165
v_mul_f32 v166, 0x34800000, v166
v_mul_f32 v167, 0x34800000, v167
v_mul_f32 v168, 0x34800000, v168
v_mul_f32 v169, 0x34800000, v169
v_mul_f32 v170, 0x34800000, v170
v_mul_f32 v171, 0x34800000, v171
v_mul_f32 v172, 0x34800000, v172
v_mul_f32 v173, 0x34800000, v173
v_mul_f32 v174, 0x34800000, v174
v_mul_f32 v175, 0x34800000, v175
v_mul_f32 v176, 0x34800000, v176
v_mul_f32 v177, 0x34800000, v177
v_mul_f32 v178, 0x34800000, v178
v_mul_f32 v179, 0x34800000, v179
v_mul_f32 v180, 0x34800000, v180
v_mul_f32 v181, 0x34800000, v181
v_mul_f32 v182, 0x34800000, v182
v_mul_f32 v183, 0x34800000, v183
v_mul_f32 v184, 0x34800000, v184
v_mul_f32 v185, 0x34800000, v185
v_mul_f32 v186, 0x34800000, v186
v_mul_f32 v187, 0x34800000, v187
v_mul_f32 v188, 0x34800000, v188
v_mul_f32 v189, 0x34800000, v189
v_mul_f32 v190, 0x34800000, v190
v_mul_f32 v191, 0x34800000, v191
v_mul_f32 v192, 0x34800000, v192
v_mul_f32 v193, 0x34800000, v193
v_mul_f32 v194, 0x34800000, v194
v_mul_f32 v195, 0x34800000, v195
v_mul_f32 v196, 0x34800000, v196
v_mul_f32 v197, 0x34800000, v197
v_mul_f32 v198, 0x34800000, v198
v_mul_f32 v199, 0x34800000, v199
v_mul_f32 v200, 0x34800000, v200
v_mul_f32 v201, 0x34800000, v201
v_mul_f32 v202, 0x34800000, v202
v_mul_f32 v203, 0x34800000, v203
v_mul_f32 v204, 0x34800000, v204
v_mul_f32 v205, 0x34800000, v205
v_mul_f32 v206, 0x34800000, v206
v_mul_f32 v207, 0x34800000, v207
s_cmp_lt_u32 s38, s37
s_cbranch_scc0 mega_kernel_f2_e
s_lshl_b32 s12, s38, 2
s_add_u32 s12, s12, s16
s_min_u32 s12, s12, 512
s_lshr_b32 s23, s12, 7
s_xnor_b32 s23, s23, s98
s_and_b32 s23, s23, 1
s_lshl_b32 s23, s23, 13
s_mul_i32 s13, s12, 16384
s_add_u32 s13, s13, 171966464
s_add_u32 s13, s13, s23
s_lshr_b32 s23, s12, 6
s_xnor_b32 s23, s23, s98
s_and_b32 s23, s23, 1
s_lshl_b32 s23, s23, 13
s_mul_i32 s12, s12, 32768
s_add_u32 s12, s12, 92274688
s_add_u32 s12, s12, s23
buffer_load_dwordx2 a[0:1], v5, s[84:87], s12 offen offset:0 sc1
buffer_load_dwordx2 a[2:3], v5, s[84:87], s12 offen offset:512 sc1
buffer_load_dwordx2 a[4:5], v5, s[84:87], s12 offen offset:1024 sc1
buffer_load_dwordx2 a[6:7], v5, s[84:87], s12 offen offset:1536 sc1
buffer_load_dwordx2 a[8:9], v5, s[84:87], s12 offen offset:2048 sc1
buffer_load_dwordx2 a[10:11], v5, s[84:87], s12 offen offset:2560 sc1
buffer_load_dwordx2 a[12:13], v5, s[84:87], s12 offen offset:3072 sc1
buffer_load_dwordx2 a[14:15], v5, s[84:87], s12 offen offset:3584 sc1
s_add_u32 s12, s12, 4096
buffer_load_dwordx2 a[16:17], v5, s[84:87], s12 offen offset:0 sc1
buffer_load_dwordx2 a[18:19], v5, s[84:87], s12 offen offset:512 sc1
buffer_load_dwordx2 a[20:21], v5, s[84:87], s12 offen offset:1024 sc1
buffer_load_dwordx2 a[22:23], v5, s[84:87], s12 offen offset:1536 sc1
buffer_load_dwordx2 a[24:25], v5, s[84:87], s12 offen offset:2048 sc1
buffer_load_dwordx2 a[26:27], v5, s[84:87], s12 offen offset:2560 sc1
buffer_load_dwordx2 a[28:29], v5, s[84:87], s12 offen offset:3072 sc1
buffer_load_dwordx2 a[30:31], v5, s[84:87], s12 offen offset:3584 sc1
s_add_u32 s12, s12, 12288
buffer_load_dwordx2 a[32:33], v5, s[84:87], s12 offen offset:0 sc1
buffer_load_dwordx2 a[34:35], v5, s[84:87], s12 offen offset:512 sc1
buffer_load_dwordx2 a[36:37], v5, s[84:87], s12 offen offset:1024 sc1
buffer_load_dwordx2 a[38:39], v5, s[84:87], s12 offen offset:1536 sc1
buffer_load_dwordx2 a[40:41], v5, s[84:87], s12 offen offset:2048 sc1
buffer_load_dwordx2 a[42:43], v5, s[84:87], s12 offen offset:2560 sc1
buffer_load_dwordx2 a[44:45], v5, s[84:87], s12 offen offset:3072 sc1
buffer_load_dwordx2 a[46:47], v5, s[84:87], s12 offen offset:3584 sc1
s_add_u32 s12, s12, 4096
buffer_load_dwordx2 a[48:49], v5, s[84:87], s12 offen offset:0 sc1
buffer_load_dwordx2 a[50:51], v5, s[84:87], s12 offen offset:512 sc1
buffer_load_dwordx2 a[52:53], v5, s[84:87], s12 offen offset:1024 sc1
buffer_load_dwordx2 a[54:55], v5, s[84:87], s12 offen offset:1536 sc1
buffer_load_dwordx2 a[56:57], v5, s[84:87], s12 offen offset:2048 sc1
buffer_load_dwordx2 a[58:59], v5, s[84:87], s12 offen offset:2560 sc1
buffer_load_dwordx2 a[60:61], v5, s[84:87], s12 offen offset:3072 sc1
buffer_load_dwordx2 a[62:63], v5, s[84:87], s12 offen offset:3584 sc1
s_add_u32 s12, s12, 4096
buffer_load_dword a64, v11, s[84:87], s13 offen offset:0 sc1
buffer_load_dword a65, v11, s[84:87], s13 offen offset:128 sc1
buffer_load_dword a66, v11, s[84:87], s13 offen offset:256 sc1
buffer_load_dword a67, v11, s[84:87], s13 offen offset:384 sc1
buffer_load_dword a68, v11, s[84:87], s13 offen offset:512 sc1
buffer_load_dword a69, v11, s[84:87], s13 offen offset:640 sc1
buffer_load_dword a70, v11, s[84:87], s13 offen offset:768 sc1
buffer_load_dword a71, v11, s[84:87], s13 offen offset:896 sc1
buffer_load_dword a72, v11, s[84:87], s13 offen offset:1024 sc1
buffer_load_dword a73, v11, s[84:87], s13 offen offset:1152 sc1
buffer_load_dword a74, v11, s[84:87], s13 offen offset:1280 sc1
buffer_load_dword a75, v11, s[84:87], s13 offen offset:1408 sc1
buffer_load_dword a76, v11, s[84:87], s13 offen offset:1536 sc1
buffer_load_dword a77, v11, s[84:87], s13 offen offset:1664 sc1
buffer_load_dword a78, v11, s[84:87], s13 offen offset:1792 sc1
buffer_load_dword a79, v11, s[84:87], s13 offen offset:1920 sc1
buffer_load_dword a80, v11, s[84:87], s13 offen offset:2048 sc1
buffer_load_dword a81, v11, s[84:87], s13 offen offset:2176 sc1
buffer_load_dword a82, v11, s[84:87], s13 offen offset:2304 sc1
buffer_load_dword a83, v11, s[84:87], s13 offen offset:2432 sc1
buffer_load_dword a84, v11, s[84:87], s13 offen offset:2560 sc1
buffer_load_dword a85, v11, s[84:87], s13 offen offset:2688 sc1
buffer_load_dword a86, v11, s[84:87], s13 offen offset:2816 sc1
buffer_load_dword a87, v11, s[84:87], s13 offen offset:2944 sc1
buffer_load_dword a88, v11, s[84:87], s13 offen offset:3072 sc1
buffer_load_dword a89, v11, s[84:87], s13 offen offset:3200 sc1
buffer_load_dword a90, v11, s[84:87], s13 offen offset:3328 sc1
buffer_load_dword a91, v11, s[84:87], s13 offen offset:3456 sc1
buffer_load_dword a92, v11, s[84:87], s13 offen offset:3584 sc1
buffer_load_dword a93, v11, s[84:87], s13 offen offset:3712 sc1
buffer_load_dword a94, v11, s[84:87], s13 offen offset:3840 sc1
buffer_load_dword a95, v11, s[84:87], s13 offen offset:3968 sc1
s_waitcnt vmcnt(0)
mega_kernel_f2_l:
s_add_u32 s21, s38, s39
s_cmp_lt_u32 s21, s37
s_cselect_b32 s22, s21, s38
s_waitcnt vmcnt(32)
v_accvgpr_read_b32 v16, a0
v_accvgpr_read_b32 v17, a1
v_accvgpr_read_b32 v18, a2
v_accvgpr_read_b32 v19, a3
v_accvgpr_read_b32 v20, a4
v_accvgpr_read_b32 v21, a5
v_accvgpr_read_b32 v22, a6
v_accvgpr_read_b32 v23, a7
v_accvgpr_read_b32 v24, a8
v_accvgpr_read_b32 v25, a9
v_accvgpr_read_b32 v26, a10
v_accvgpr_read_b32 v27, a11
v_accvgpr_read_b32 v28, a12
v_accvgpr_read_b32 v29, a13
v_accvgpr_read_b32 v30, a14
v_accvgpr_read_b32 v31, a15
v_accvgpr_read_b32 v32, a16
v_accvgpr_read_b32 v33, a17
v_accvgpr_read_b32 v34, a18
v_accvgpr_read_b32 v35, a19
v_accvgpr_read_b32 v36, a20
v_accvgpr_read_b32 v37, a21
v_accvgpr_read_b32 v38, a22
v_accvgpr_read_b32 v39, a23
v_accvgpr_read_b32 v40, a24
v_accvgpr_read_b32 v41, a25
v_accvgpr_read_b32 v42, a26
v_accvgpr_read_b32 v43, a27
v_accvgpr_read_b32 v44, a28
v_accvgpr_read_b32 v45, a29
v_accvgpr_read_b32 v46, a30
v_accvgpr_read_b32 v47, a31
v_accvgpr_read_b32 v48, a32
v_accvgpr_read_b32 v49, a33
v_accvgpr_read_b32 v50, a34
v_accvgpr_read_b32 v51, a35
v_accvgpr_read_b32 v52, a36
v_accvgpr_read_b32 v53, a37
v_accvgpr_read_b32 v54, a38
v_accvgpr_read_b32 v55, a39
v_accvgpr_read_b32 v56, a40
v_accvgpr_read_b32 v57, a41
v_accvgpr_read_b32 v58, a42
v_accvgpr_read_b32 v59, a43
v_accvgpr_read_b32 v60, a44
v_accvgpr_read_b32 v61, a45
v_accvgpr_read_b32 v62, a46
v_accvgpr_read_b32 v63, a47
v_accvgpr_read_b32 v64, a48
v_accvgpr_read_b32 v65, a49
v_accvgpr_read_b32 v66, a50
v_accvgpr_read_b32 v67, a51
v_accvgpr_read_b32 v68, a52
v_accvgpr_read_b32 v69, a53
v_accvgpr_read_b32 v70, a54
v_accvgpr_read_b32 v71, a55
v_accvgpr_read_b32 v72, a56
v_accvgpr_read_b32 v73, a57
v_accvgpr_read_b32 v74, a58
v_accvgpr_read_b32 v75, a59
v_accvgpr_read_b32 v76, a60
v_accvgpr_read_b32 v77, a61
v_accvgpr_read_b32 v78, a62
v_accvgpr_read_b32 v79, a63
v_accvgpr_read_b32 v208, a64
v_accvgpr_read_b32 v209, a65
v_accvgpr_read_b32 v210, a66
v_accvgpr_read_b32 v211, a67
v_accvgpr_read_b32 v212, a68
v_accvgpr_read_b32 v213, a69
v_accvgpr_read_b32 v214, a70
v_accvgpr_read_b32 v215, a71
v_accvgpr_read_b32 v216, a72
v_accvgpr_read_b32 v217, a73
v_accvgpr_read_b32 v218, a74
v_accvgpr_read_b32 v219, a75
v_accvgpr_read_b32 v220, a76
v_accvgpr_read_b32 v221, a77
v_accvgpr_read_b32 v222, a78
v_accvgpr_read_b32 v223, a79
v_accvgpr_read_b32 v224, a80
v_accvgpr_read_b32 v225, a81
v_accvgpr_read_b32 v226, a82
v_accvgpr_read_b32 v227, a83
v_accvgpr_read_b32 v228, a84
v_accvgpr_read_b32 v229, a85
v_accvgpr_read_b32 v230, a86
v_accvgpr_read_b32 v231, a87
v_accvgpr_read_b32 v232, a88
v_accvgpr_read_b32 v233, a89
v_accvgpr_read_b32 v234, a90
v_accvgpr_read_b32 v235, a91
v_accvgpr_read_b32 v236, a92
v_accvgpr_read_b32 v237, a93
v_accvgpr_read_b32 v238, a94
v_accvgpr_read_b32 v239, a95
s_lshl_b32 s12, s22, 2
s_add_u32 s12, s12, s16
s_min_u32 s12, s12, 512
s_lshr_b32 s23, s12, 7
s_xnor_b32 s23, s23, s98
s_and_b32 s23, s23, 1
s_lshl_b32 s23, s23, 13
s_mul_i32 s13, s12, 16384
s_add_u32 s13, s13, 171966464
s_add_u32 s13, s13, s23
s_lshr_b32 s23, s12, 6
s_xnor_b32 s23, s23, s98
s_and_b32 s23, s23, 1
s_lshl_b32 s23, s23, 13
s_mul_i32 s12, s12, 32768
s_add_u32 s12, s12, 92274688
s_add_u32 s12, s12, s23
buffer_load_dwordx2 a[0:1], v5, s[84:87], s12 offen offset:0 sc1
buffer_load_dwordx2 a[2:3], v5, s[84:87], s12 offen offset:512 sc1
buffer_load_dwordx2 a[4:5], v5, s[84:87], s12 offen offset:1024 sc1
buffer_load_dwordx2 a[6:7], v5, s[84:87], s12 offen offset:1536 sc1
buffer_load_dwordx2 a[8:9], v5, s[84:87], s12 offen offset:2048 sc1
buffer_load_dwordx2 a[10:11], v5, s[84:87], s12 offen offset:2560 sc1
buffer_load_dwordx2 a[12:13], v5, s[84:87], s12 offen offset:3072 sc1
buffer_load_dwordx2 a[14:15], v5, s[84:87], s12 offen offset:3584 sc1
s_add_u32 s12, s12, 4096
buffer_load_dwordx2 a[16:17], v5, s[84:87], s12 offen offset:0 sc1
buffer_load_dwordx2 a[18:19], v5, s[84:87], s12 offen offset:512 sc1
buffer_load_dwordx2 a[20:21], v5, s[84:87], s12 offen offset:1024 sc1
buffer_load_dwordx2 a[22:23], v5, s[84:87], s12 offen offset:1536 sc1
buffer_load_dwordx2 a[24:25], v5, s[84:87], s12 offen offset:2048 sc1
buffer_load_dwordx2 a[26:27], v5, s[84:87], s12 offen offset:2560 sc1
buffer_load_dwordx2 a[28:29], v5, s[84:87], s12 offen offset:3072 sc1
buffer_load_dwordx2 a[30:31], v5, s[84:87], s12 offen offset:3584 sc1
s_add_u32 s12, s12, 12288
buffer_load_dwordx2 a[32:33], v5, s[84:87], s12 offen offset:0 sc1
buffer_load_dwordx2 a[34:35], v5, s[84:87], s12 offen offset:512 sc1
buffer_load_dwordx2 a[36:37], v5, s[84:87], s12 offen offset:1024 sc1
buffer_load_dwordx2 a[38:39], v5, s[84:87], s12 offen offset:1536 sc1
buffer_load_dwordx2 a[40:41], v5, s[84:87], s12 offen offset:2048 sc1
buffer_load_dwordx2 a[42:43], v5, s[84:87], s12 offen offset:2560 sc1
buffer_load_dwordx2 a[44:45], v5, s[84:87], s12 offen offset:3072 sc1
buffer_load_dwordx2 a[46:47], v5, s[84:87], s12 offen offset:3584 sc1
s_add_u32 s12, s12, 4096
buffer_load_dwordx2 a[48:49], v5, s[84:87], s12 offen offset:0 sc1
buffer_load_dwordx2 a[50:51], v5, s[84:87], s12 offen offset:512 sc1
buffer_load_dwordx2 a[52:53], v5, s[84:87], s12 offen offset:1024 sc1
buffer_load_dwordx2 a[54:55], v5, s[84:87], s12 offen offset:1536 sc1
buffer_load_dwordx2 a[56:57], v5, s[84:87], s12 offen offset:2048 sc1
buffer_load_dwordx2 a[58:59], v5, s[84:87], s12 offen offset:2560 sc1
buffer_load_dwordx2 a[60:61], v5, s[84:87], s12 offen offset:3072 sc1
buffer_load_dwordx2 a[62:63], v5, s[84:87], s12 offen offset:3584 sc1
s_add_u32 s12, s12, 4096
buffer_load_dword a64, v11, s[84:87], s13 offen offset:0 sc1
buffer_load_dword a65, v11, s[84:87], s13 offen offset:128 sc1
buffer_load_dword a66, v11, s[84:87], s13 offen offset:256 sc1
buffer_load_dword a67, v11, s[84:87], s13 offen offset:384 sc1
buffer_load_dword a68, v11, s[84:87], s13 offen offset:512 sc1
buffer_load_dword a69, v11, s[84:87], s13 offen offset:640 sc1
buffer_load_dword a70, v11, s[84:87], s13 offen offset:768 sc1
buffer_load_dword a71, v11, s[84:87], s13 offen offset:896 sc1
buffer_load_dword a72, v11, s[84:87], s13 offen offset:1024 sc1
buffer_load_dword a73, v11, s[84:87], s13 offen offset:1152 sc1
buffer_load_dword a74, v11, s[84:87], s13 offen offset:1280 sc1
buffer_load_dword a75, v11, s[84:87], s13 offen offset:1408 sc1
buffer_load_dword a76, v11, s[84:87], s13 offen offset:1536 sc1
buffer_load_dword a77, v11, s[84:87], s13 offen offset:1664 sc1
buffer_load_dword a78, v11, s[84:87], s13 offen offset:1792 sc1
buffer_load_dword a79, v11, s[84:87], s13 offen offset:1920 sc1
buffer_load_dword a80, v11, s[84:87], s13 offen offset:2048 sc1
buffer_load_dword a81, v11, s[84:87], s13 offen offset:2176 sc1
buffer_load_dword a82, v11, s[84:87], s13 offen offset:2304 sc1
buffer_load_dword a83, v11, s[84:87], s13 offen offset:2432 sc1
buffer_load_dword a84, v11, s[84:87], s13 offen offset:2560 sc1
buffer_load_dword a85, v11, s[84:87], s13 offen offset:2688 sc1
buffer_load_dword a86, v11, s[84:87], s13 offen offset:2816 sc1
buffer_load_dword a87, v11, s[84:87], s13 offen offset:2944 sc1
buffer_load_dword a88, v11, s[84:87], s13 offen offset:3072 sc1
buffer_load_dword a89, v11, s[84:87], s13 offen offset:3200 sc1
buffer_load_dword a90, v11, s[84:87], s13 offen offset:3328 sc1
buffer_load_dword a91, v11, s[84:87], s13 offen offset:3456 sc1
buffer_load_dword a92, v11, s[84:87], s13 offen offset:3584 sc1
buffer_load_dword a93, v11, s[84:87], s13 offen offset:3712 sc1
buffer_load_dword a94, v11, s[84:87], s13 offen offset:3840 sc1
buffer_load_dword a95, v11, s[84:87], s13 offen offset:3968 sc1
v_pk_add_f32 v[14:15], v[16:17], v[48:49] neg_lo:[0,1] neg_hi:[0,1]
v_pk_add_f32 v[16:17], v[16:17], v[48:49]
v_pk_add_f32 v[48:49], v[18:19], v[50:51] neg_lo:[0,1] neg_hi:[0,1]
v_pk_add_f32 v[18:19], v[18:19], v[50:51]
v_pk_mul_f32 v[50:51], v[48:49], s[50:51] op_sel:[0,0] op_sel_hi:[0,1] neg_lo:[0,0] neg_hi:[0,1]
v_pk_fma_f32 v[50:51], v[48:49], s[50:51], v[50:51] op_sel:[1,1,0] op_sel_hi:[1,0,1] neg_lo:[0,0,0] neg_hi:[0,0,0]
v_pk_add_f32 v[48:49], v[20:21], v[52:53] neg_lo:[0,1] neg_hi:[0,1]
v_pk_add_f32 v[20:21], v[20:21], v[52:53]
v_pk_mul_f32 v[52:53], v[48:49], s[54:55] op_sel:[0,0] op_sel_hi:[0,1] neg_lo:[0,0] neg_hi:[0,1]
v_pk_fma_f32 v[52:53], v[48:49], s[54:55], v[52:53] op_sel:[1,1,0] op_sel_hi:[1,0,1] neg_lo:[0,0,0] neg_hi:[0,0,0]
v_pk_add_f32 v[48:49], v[22:23], v[54:55] neg_lo:[0,1] neg_hi:[0,1]
v_pk_add_f32 v[22:23], v[22:23], v[54:55]
v_pk_mul_f32 v[54:55], v[48:49], s[58:59] op_sel:[0,0] op_sel_hi:[0,1] neg_lo:[0,0] neg_hi:[0,1]
v_pk_fma_f32 v[54:55], v[48:49], s[58:59], v[54:55] op_sel:[1,1,0] op_sel_hi:[1,0,1] neg_lo:[0,0,0] neg_hi:[0,0,0]
v_pk_add_f32 v[48:49], v[24:25], v[56:57] neg_lo:[0,1] neg_hi:[0,1]
v_pk_add_f32 v[24:25], v[24:25], v[56:57]
v_pk_mul_f32 v[56:57], v[48:49], s[62:63] op_sel:[0,0] op_sel_hi:[0,1] neg_lo:[0,0] neg_hi:[0,1]
v_pk_fma_f32 v[56:57], v[48:49], s[62:63], v[56:57] op_sel:[1,1,0] op_sel_hi:[1,0,1] neg_lo:[0,0,0] neg_hi:[0,0,0]
v_pk_add_f32 v[48:49], v[26:27], v[58:59] neg_lo:[0,1] neg_hi:[0,1]
v_pk_add_f32 v[26:27], v[26:27], v[58:59]
v_pk_mul_f32 v[58:59], v[48:49], s[58:59] op_sel:[0,1] op_sel_hi:[0,0] neg_lo:[0,0] neg_hi:[0,1]
v_pk_fma_f32 v[58:59], v[48:49], s[58:59], v[58:59] op_sel:[1,0,0] op_sel_hi:[1,1,1] neg_lo:[0,0,0] neg_hi:[0,0,0]
v_pk_add_f32 v[48:49], v[28:29], v[60:61] neg_lo:[0,1] neg_hi:[0,1]
v_pk_add_f32 v[28:29], v[28:29], v[60:61]
v_pk_mul_f32 v[60:61], v[48:49], s[54:55] op_sel:[0,1] op_sel_hi:[0,0] neg_lo:[0,0] neg_hi:[0,1]
v_pk_fma_f32 v[60:61], v[48:49], s[54:55], v[60:61] op_sel:[1,0,0] op_sel_hi:[1,1,1] neg_lo:[0,0,0] neg_hi:[0,0,0]
v_pk_add_f32 v[48:49], v[30:31], v[62:63] neg_lo:[0,1] neg_hi:[0,1]
v_pk_add_f32 v[30:31], v[30:31], v[62:63]
v_pk_mul_f32 v[62:63], v[48:49], s[50:51] op_sel:[0,1] op_sel_hi:[0,0] neg_lo:[0,0] neg_hi:[0,1]
v_pk_fma_f32 v[62:63], v[48:49], s[50:51], v[62:63] op_sel:[1,0,0] op_sel_hi:[1,1,1] neg_lo:[0,0,0] neg_hi:[0,0,0]
v_pk_add_f32 v[48:49], v[32:33], v[64:65] op_sel:[1,1] op_sel_hi:[0,0] neg_lo:[0,1] neg_hi:[1,0]
v_pk_add_f32 v[32:33], v[32:33], v[64:65]
v_pk_add_f32 v[64:65], v[34:35], v[66:67] neg_lo:[0,1] neg_hi:[0,1]
v_pk_add_f32 v[34:35], v[34:35], v[66:67]
v_pk_mul_f32 v[66:67], v[64:65], s[50:51] op_sel:[0,1] op_sel_hi:[0,0] neg_lo:[0,1] neg_hi:[0,1]
v_pk_fma_f32 v[66:67], v[64:65], s[50:51], v[66:67] op_sel:[1,0,0] op_sel_hi:[1,1,1] neg_lo:[0,0,0] neg_hi:[0,1,0]
v_pk_add_f32 v[64:65], v[36:37], v[68:69] neg_lo:[0,1] neg_hi:[0,1]
v_pk_add_f32 v[36:37], v[36:37], v[68:69]
v_pk_mul_f32 v[68:69], v[64:65], s[54:55] op_sel:[0,1] op_sel_hi:[0,0] neg_lo:[0,1] neg_hi:[0,1]
v_pk_fma_f32 v[68:69], v[64:65], s[54:55], v[68:69] op_sel:[1,0,0] op_sel_hi:[1,1,1] neg_lo:[0,0,0] neg_hi:[0,1,0]
v_pk_add_f32 v[64:65], v[38:39], v[70:71] neg_lo:[0,1] neg_hi:[0,1]
v_pk_add_f32 v[38:39], v[38:39], v[70:71]
v_pk_mul_f32 v[70:71], v[64:65], s[58:59] op_sel:[0,1] op_sel_hi:[0,0] neg_lo:[0,1] neg_hi:[0,1]
v_pk_fma_f32 v[70:71], v[64:65], s[58:59], v[70:71] op_sel:[1,0,0] op_sel_hi:[1,1,1] neg_lo:[0,0,0] neg_hi:[0,1,0]
v_pk_add_f32 v[64:65], v[40:41], v[72:73] neg_lo:[0,1] neg_hi:[0,1]
v_pk_add_f32 v[40:41], v[40:41], v[72:73]
v_pk_mul_f32 v[72:73], v[64:65], s[62:63] op_sel:[0,0] op_sel_hi:[0,1] neg_lo:[0,1] neg_hi:[0,1]
v_pk_fma_f32 v[72:73], v[64:65], s[62:63], v[72:73] op_sel:[1,1,0] op_sel_hi:[1,0,1] neg_lo:[0,0,0] neg_hi:[0,1,0]
v_pk_add_f32 v[64:65], v[42:43], v[74:75] neg_lo:[0,1] neg_hi:[0,1]
v_pk_add_f32 v[42:43], v[42:43], v[74:75]
v_pk_mul_f32 v[74:75], v[64:65], s[58:59] op_sel:[0,0] op_sel_hi:[0,1] neg_lo:[0,1] neg_hi:[0,1]
v_pk_fma_f32 v[74:75], v[64:65], s[58:59], v[74:75] op_sel:[1,1,0] op_sel_hi:[1,0,1] neg_lo:[0,0,0] neg_hi:[0,1,0]
v_pk_add_f32 v[64:65], v[44:45], v[76:77] neg_lo:[0,1] neg_hi:[0,1]
v_pk_add_f32 v[44:45], v[44:45], v[76:77]
v_pk_mul_f32 v[76:77], v[64:65], s[54:55] op_sel:[0,0] op_sel_hi:[0,1] neg_lo:[0,1] neg_hi:[0,1]
v_pk_fma_f32 v[76:77], v[64:65], s[54:55], v[76:77] op_sel:[1,1,0] op_sel_hi:[1,0,1] neg_lo:[0,0,0] neg_hi:[0,1,0]
v_pk_add_f32 v[64:65], v[46:47], v[78:79] neg_lo:[0,1] neg_hi:[0,1]
v_pk_add_f32 v[46:47], v[46:47], v[78:79]
v_pk_mul_f32 v[78:79], v[64:65], s[50:51] op_sel:[0,0] op_sel_hi:[0,1] neg_lo:[0,1] neg_hi:[0,1]
v_pk_fma_f32 v[78:79], v[64:65], s[50:51], v[78:79] op_sel:[1,1,0] op_sel_hi:[1,0,1] neg_lo:[0,0,0] neg_hi:[0,1,0]
v_pk_add_f32 v[64:65], v[16:17], v[32:33] neg_lo:[0,1] neg_hi:[0,1]
v_pk_add_f32 v[16:17], v[16:17], v[32:33]
v_pk_add_f32 v[32:33], v[18:19], v[34:35] neg_lo:[0,1] neg_hi:[0,1]
v_pk_add_f32 v[18:19], v[18:19], v[34:35]
v_pk_mul_f32 v[34:35], v[32:33], s[54:55] op_sel:[0,0] op_sel_hi:[0,1] neg_lo:[0,0] neg_hi:[0,1]
v_pk_fma_f32 v[34:35], v[32:33], s[54:55], v[34:35] op_sel:[1,1,0] op_sel_hi:[1,0,1] neg_lo:[0,0,0] neg_hi:[0,0,0]
v_pk_add_f32 v[32:33], v[20:21], v[36:37] neg_lo:[0,1] neg_hi:[0,1]
v_pk_add_f32 v[20:21], v[20:21], v[36:37]
v_pk_mul_f32 v[36:37], v[32:33], s[62:63] op_sel:[0,0] op_sel_hi:[0,1] neg_lo:[0,0] neg_hi:[0,1]
v_pk_fma_f32 v[36:37], v[32:33], s[62:63], v[36:37] op_sel:[1,1,0] op_sel_hi:[1,0,1] neg_lo:[0,0,0] neg_hi:[0,0,0]
v_pk_add_f32 v[32:33], v[22:23], v[38:39] neg_lo:[0,1] neg_hi:[0,1]
v_pk_add_f32 v[22:23], v[22:23], v[38:39]
v_pk_mul_f32 v[38:39], v[32:33], s[54:55] op_sel:[0,1] op_sel_hi:[0,0] neg_lo:[0,0] neg_hi:[0,1]
v_pk_fma_f32 v[38:39], v[32:33], s[54:55], v[38:39] op_sel:[1,0,0] op_sel_hi:[1,1,1] neg_lo:[0,0,0] neg_hi:[0,0,0]
v_pk_add_f32 v[32:33], v[24:25], v[40:41] op_sel:[1,1] op_sel_hi:[0,0] neg_lo:[0,1] neg_hi:[1,0]
v_pk_add_f32 v[24:25], v[24:25], v[40:41]
v_pk_add_f32 v[40:41], v[26:27], v[42:43] neg_lo:[0,1] neg_hi:[0,1]
v_pk_add_f32 v[26:27], v[26:27], v[42:43]
v_pk_mul_f32 v[42:43], v[40:41], s[54:55] op_sel:[0,1] op_sel_hi:[0,0] neg_lo:[0,1] neg_hi:[0,1]
v_pk_fma_f32 v[42:43], v[40:41], s[54:55], v[42:43] op_sel:[1,0,0] op_sel_hi:[1,1,1] neg_lo:[0,0,0] neg_hi:[0,1,0]
v_pk_add_f32 v[40:41], v[28:29], v[44:45] neg_lo:[0,1] neg_hi:[0,1]
v_pk_add_f32 v[28:29], v[28:29], v[44:45]
v_pk_mul_f32 v[44:45], v[40:41], s[62:63] op_sel:[0,0] op_sel_hi:[0,1] neg_lo:[0,1] neg_hi:[0,1]
v_pk_fma_f32 v[44:45], v[40:41], s[62:63], v[44:45] op_sel:[1,1,0] op_sel_hi:[1,0,1] neg_lo:[0,0,0] neg_hi:[0,1,0]
v_pk_add_f32 v[40:41], v[30:31], v[46:47] neg_lo:[0,1] neg_hi:[0,1]
v_pk_add_f32 v[30:31], v[30:31], v[46:47]
v_pk_mul_f32 v[46:47], v[40:41], s[54:55] op_sel:[0,0] op_sel_hi:[0,1] neg_lo:[0,1] neg_hi:[0,1]
v_pk_fma_f32 v[46:47], v[40:41], s[54:55], v[46:47] op_sel:[1,1,0] op_sel_hi:[1,0,1] neg_lo:[0,0,0] neg_hi:[0,1,0]
v_pk_add_f32 v[40:41], v[14:15], v[48:49] neg_lo:[0,1] neg_hi:[0,1]
v_pk_add_f32 v[14:15], v[14:15], v[48:49]
v_pk_add_f32 v[48:49], v[50:51], v[66:67] neg_lo:[0,1] neg_hi:[0,1]
v_pk_add_f32 v[50:51], v[50:51], v[66:67]
v_pk_mul_f32 v[66:67], v[48:49], s[54:55] op_sel:[0,0] op_sel_hi:[0,1] neg_lo:[0,0] neg_hi:[0,1]
v_pk_fma_f32 v[66:67], v[48:49], s[54:55], v[66:67] op_sel:[1,1,0] op_sel_hi:[1,0,1] neg_lo:[0,0,0] neg_hi:[0,0,0]
v_pk_add_f32 v[48:49], v[52:53], v[68:69] neg_lo:[0,1] neg_hi:[0,1]
v_pk_add_f32 v[52:53], v[52:53], v[68:69]
v_pk_mul_f32 v[68:69], v[48:49], s[62:63] op_sel:[0,0] op_sel_hi:[0,1] neg_lo:[0,0] neg_hi:[0,1]
v_pk_fma_f32 v[68:69], v[48:49], s[62:63], v[68:69] op_sel:[1,1,0] op_sel_hi:[1,0,1] neg_lo:[0,0,0] neg_hi:[0,0,0]
v_pk_add_f32 v[48:49], v[54:55], v[70:71] neg_lo:[0,1] neg_hi:[0,1]
v_pk_add_f32 v[54:55], v[54:55], v[70:71]
v_pk_mul_f32 v[70:71], v[48:49], s[54:55] op_sel:[0,1] op_sel_hi:[0,0] neg_lo:[0,0] neg_hi:[0,1]
v_pk_fma_f32 v[70:71], v[48:49], s[54:55], v[70:71] op_sel:[1,0,0] op_sel_hi:[1,1,1] neg_lo:[0,0,0] neg_hi:[0,0,0]
v_pk_add_f32 v[48:49], v[56:57], v[72:73] op_sel:[1,1] op_sel_hi:[0,0] neg_lo:[0,1] neg_hi:[1,0]
v_pk_add_f32 v[56:57], v[56:57], v[72:73]
v_pk_add_f32 v[72:73], v[58:59], v[74:75] neg_lo:[0,1] neg_hi:[0,1]
v_pk_add_f32 v[58:59], v[58:59], v[74:75]
v_pk_mul_f32 v[74:75], v[72:73], s[54:55] op_sel:[0,1] op_sel_hi:[0,0] neg_lo:[0,1] neg_hi:[0,1]
v_pk_fma_f32 v[74:75], v[72:73], s[54:55], v[74:75] op_sel:[1,0,0] op_sel_hi:[1,1,1] neg_lo:[0,0,0] neg_hi:[0,1,0]
v_pk_add_f32 v[72:73], v[60:61], v[76:77] neg_lo:[0,1] neg_hi:[0,1]
v_pk_add_f32 v[60:61], v[60:61], v[76:77]
v_pk_mul_f32 v[76:77], v[72:73], s[62:63] op_sel:[0,0] op_sel_hi:[0,1] neg_lo:[0,1] neg_hi:[0,1]
v_pk_fma_f32 v[76:77], v[72:73], s[62:63], v[76:77] op_sel:[1,1,0] op_sel_hi:[1,0,1] neg_lo:[0,0,0] neg_hi:[0,1,0]
v_pk_add_f32 v[72:73], v[62:63], v[78:79] neg_lo:[0,1] neg_hi:[0,1]
v_pk_add_f32 v[62:63], v[62:63], v[78:79]
v_pk_mul_f32 v[78:79], v[72:73], s[54:55] op_sel:[0,0] op_sel_hi:[0,1] neg_lo:[0,1] neg_hi:[0,1]
v_pk_fma_f32 v[78:79], v[72:73], s[54:55], v[78:79] op_sel:[1,1,0] op_sel_hi:[1,0,1] neg_lo:[0,0,0] neg_hi:[0,1,0]
v_pk_add_f32 v[72:73], v[16:17], v[24:25] neg_lo:[0,1] neg_hi:[0,1]
v_pk_add_f32 v[16:17], v[16:17], v[24:25]
v_pk_add_f32 v[24:25], v[18:19], v[26:27] neg_lo:[0,1] neg_hi:[0,1]
v_pk_add_f32 v[18:19], v[18:19], v[26:27]
v_pk_mul_f32 v[26:27], v[24:25], s[62:63] op_sel:[0,0] op_sel_hi:[0,1] neg_lo:[0,0] neg_hi:[0,1]
v_pk_fma_f32 v[26:27], v[24:25], s[62:63], v[26:27] op_sel:[1,1,0] op_sel_hi:[1,0,1] neg_lo:[0,0,0] neg_hi:[0,0,0]
v_pk_add_f32 v[24:25], v[20:21], v[28:29] op_sel:[1,1] op_sel_hi:[0,0] neg_lo:[0,1] neg_hi:[1,0]
v_pk_add_f32 v[20:21], v[20:21], v[28:29]
v_pk_add_f32 v[28:29], v[22:23], v[30:31] neg_lo:[0,1] neg_hi:[0,1]
v_pk_add_f32 v[22:23], v[22:23], v[30:31]
v_pk_mul_f32 v[30:31], v[28:29], s[62:63] op_sel:[0,0] op_sel_hi:[0,1] neg_lo:[0,1] neg_hi:[0,1]
v_pk_fma_f32 v[30:31], v[28:29], s[62:63], v[30:31] op_sel:[1,1,0] op_sel_hi:[1,0,1] neg_lo:[0,0,0] neg_hi:[0,1,0]
v_pk_add_f32 v[28:29], v[64:65], v[32:33] neg_lo:[0,1] neg_hi:[0,1]
v_pk_add_f32 v[64:65], v[64:65], v[32:33]
v_pk_add_f32 v[32:33], v[34:35], v[42:43] neg_lo:[0,1] neg_hi:[0,1]
v_pk_add_f32 v[34:35], v[34:35], v[42:43]
v_pk_mul_f32 v[42:43], v[32:33], s[62:63] op_sel:[0,0] op_sel_hi:[0,1] neg_lo:[0,0] neg_hi:[0,1]
v_pk_fma_f32 v[42:43], v[32:33], s[62:63], v[42:43] op_sel:[1,1,0] op_sel_hi:[1,0,1] neg_lo:[0,0,0] neg_hi:[0,0,0]
v_pk_add_f32 v[32:33], v[36:37], v[44:45] op_sel:[1,1] op_sel_hi:[0,0] neg_lo:[0,1] neg_hi:[1,0]
v_pk_add_f32 v[36:37], v[36:37], v[44:45]
v_pk_add_f32 v[44:45], v[38:39], v[46:47] neg_lo:[0,1] neg_hi:[0,1]
v_pk_add_f32 v[38:39], v[38:39], v[46:47]
v_pk_mul_f32 v[46:47], v[44:45], s[62:63] op_sel:[0,0] op_sel_hi:[0,1] neg_lo:[0,1] neg_hi:[0,1]
v_pk_fma_f32 v[46:47], v[44:45], s[62:63], v[46:47] op_sel:[1,1,0] op_sel_hi:[1,0,1] neg_lo:[0,0,0] neg_hi:[0,1,0]
v_pk_add_f32 v[44:45], v[14:15], v[56:57] neg_lo:[0,1] neg_hi:[0,1]
v_pk_add_f32 v[14:15], v[14:15], v[56:57]
v_pk_add_f32 v[56:57], v[50:51], v[58:59] neg_lo:[0,1] neg_hi:[0,1]
v_pk_add_f32 v[50:51], v[50:51], v[58:59]
v_pk_mul_f32 v[58:59], v[56:57], s[62:63] op_sel:[0,0] op_sel_hi:[0,1] neg_lo:[0,0] neg_hi:[0,1]
v_pk_fma_f32 v[58:59], v[56:57], s[62:63], v[58:59] op_sel:[1,1,0] op_sel_hi:[1,0,1] neg_lo:[0,0,0] neg_hi:[0,0,0]
v_pk_add_f32 v[56:57], v[52:53], v[60:61] op_sel:[1,1] op_sel_hi:[0,0] neg_lo:[0,1] neg_hi:[1,0]
v_pk_add_f32 v[52:53], v[52:53], v[60:61]
v_pk_add_f32 v[60:61], v[54:55], v[62:63] neg_lo:[0,1] neg_hi:[0,1]
v_pk_add_f32 v[54:55], v[54:55], v[62:63]
v_pk_mul_f32 v[62:63], v[60:61], s[62:63] op_sel:[0,0] op_sel_hi:[0,1] neg_lo:[0,1] neg_hi:[0,1]
v_pk_fma_f32 v[62:63], v[60:61], s[62:63], v[62:63] op_sel:[1,1,0] op_sel_hi:[1,0,1] neg_lo:[0,0,0] neg_hi:[0,1,0]
v_pk_add_f32 v[60:61], v[40:41], v[48:49] neg_lo:[0,1] neg_hi:[0,1]
v_pk_add_f32 v[40:41], v[40:41], v[48:49]
v_pk_add_f32 v[48:49], v[66:67], v[74:75] neg_lo:[0,1] neg_hi:[0,1]
v_pk_add_f32 v[66:67], v[66:67], v[74:75]
v_pk_mul_f32 v[74:75], v[48:49], s[62:63] op_sel:[0,0] op_sel_hi:[0,1] neg_lo:[0,0] neg_hi:[0,1]
v_pk_fma_f32 v[74:75], v[48:49], s[62:63], v[74:75] op_sel:[1,1,0] op_sel_hi:[1,0,1] neg_lo:[0,0,0] neg_hi:[0,0,0]
v_pk_add_f32 v[48:49], v[68:69], v[76:77] op_sel:[1,1] op_sel_hi:[0,0] neg_lo:[0,1] neg_hi:[1,0]
v_pk_add_f32 v[68:69], v[68:69], v[76:77]
v_pk_add_f32 v[76:77], v[70:71], v[78:79] neg_lo:[0,1] neg_hi:[0,1]
v_pk_add_f32 v[70:71], v[70:71], v[78:79]
v_pk_mul_f32 v[78:79], v[76:77], s[62:63] op_sel:[0,0] op_sel_hi:[0,1] neg_lo:[0,1] neg_hi:[0,1]
v_pk_fma_f32 v[78:79], v[76:77], s[62:63], v[78:79] op_sel:[1,1,0] op_sel_hi:[1,0,1] neg_lo:[0,0,0] neg_hi:[0,1,0]
v_pk_add_f32 v[76:77], v[16:17], v[20:21] neg_lo:[0,1] neg_hi:[0,1]
v_pk_add_f32 v[16:17], v[16:17], v[20:21]
v_pk_add_f32 v[20:21], v[18:19], v[22:23] op_sel:[1,1] op_sel_hi:[0,0] neg_lo:[0,1] neg_hi:[1,0]
v_pk_add_f32 v[18:19], v[18:19], v[22:23]
v_pk_add_f32 v[22:23], v[72:73], v[24:25] neg_lo:[0,1] neg_hi:[0,1]
v_pk_add_f32 v[72:73], v[72:73], v[24:25]
v_pk_add_f32 v[24:25], v[26:27], v[30:31] op_sel:[1,1] op_sel_hi:[0,0] neg_lo:[0,1] neg_hi:[1,0]
v_pk_add_f32 v[26:27], v[26:27], v[30:31]
v_pk_add_f32 v[30:31], v[64:65], v[36:37] neg_lo:[0,1] neg_hi:[0,1]
v_pk_add_f32 v[64:65], v[64:65], v[36:37]
v_pk_add_f32 v[36:37], v[34:35], v[38:39] op_sel:[1,1] op_sel_hi:[0,0] neg_lo:[0,1] neg_hi:[1,0]
v_pk_add_f32 v[34:35], v[34:35], v[38:39]
v_pk_add_f32 v[38:39], v[28:29], v[32:33] neg_lo:[0,1] neg_hi:[0,1]
v_pk_add_f32 v[28:29], v[28:29], v[32:33]
v_pk_add_f32 v[32:33], v[42:43], v[46:47] op_sel:[1,1] op_sel_hi:[0,0] neg_lo:[0,1] neg_hi:[1,0]
v_pk_add_f32 v[42:43], v[42:43], v[46:47]
v_pk_add_f32 v[46:47], v[14:15], v[52:53] neg_lo:[0,1] neg_hi:[0,1]
v_pk_add_f32 v[14:15], v[14:15], v[52:53]
v_pk_add_f32 v[52:53], v[50:51], v[54:55] op_sel:[1,1] op_sel_hi:[0,0] neg_lo:[0,1] neg_hi:[1,0]
v_pk_add_f32 v[50:51], v[50:51], v[54:55]
v_pk_add_f32 v[54:55], v[44:45], v[56:57] neg_lo:[0,1] neg_hi:[0,1]
v_pk_add_f32 v[44:45], v[44:45], v[56:57]
v_pk_add_f32 v[56:57], v[58:59], v[62:63] op_sel:[1,1] op_sel_hi:[0,0] neg_lo:[0,1] neg_hi:[1,0]
v_pk_add_f32 v[58:59], v[58:59], v[62:63]
v_pk_add_f32 v[62:63], v[40:41], v[68:69] neg_lo:[0,1] neg_hi:[0,1]
v_pk_add_f32 v[40:41], v[40:41], v[68:69]
v_pk_add_f32 v[68:69], v[66:67], v[70:71] op_sel:[1,1] op_sel_hi:[0,0] neg_lo:[0,1] neg_hi:[1,0]
v_pk_add_f32 v[66:67], v[66:67], v[70:71]
v_pk_add_f32 v[70:71], v[60:61], v[48:49] neg_lo:[0,1] neg_hi:[0,1]
v_pk_add_f32 v[60:61], v[60:61], v[48:49]
v_pk_add_f32 v[48:49], v[74:75], v[78:79] op_sel:[1,1] op_sel_hi:[0,0] neg_lo:[0,1] neg_hi:[1,0]
v_pk_add_f32 v[74:75], v[74:75], v[78:79]
v_pk_add_f32 v[78:79], v[16:17], v[18:19] neg_lo:[0,1] neg_hi:[0,1]
v_pk_add_f32 v[16:17], v[16:17], v[18:19]
v_pk_add_f32 v[18:19], v[76:77], v[20:21] neg_lo:[0,1] neg_hi:[0,1]
v_pk_add_f32 v[76:77], v[76:77], v[20:21]
v_pk_add_f32 v[20:21], v[72:73], v[26:27] neg_lo:[0,1] neg_hi:[0,1]
v_pk_add_f32 v[72:73], v[72:73], v[26:27]
v_pk_add_f32 v[26:27], v[22:23], v[24:25] neg_lo:[0,1] neg_hi:[0,1]
v_pk_add_f32 v[22:23], v[22:23], v[24:25]
v_pk_add_f32 v[24:25], v[64:65], v[34:35] neg_lo:[0,1] neg_hi:[0,1]
v_pk_add_f32 v[64:65], v[64:65], v[34:35]
v_pk_add_f32 v[34:35], v[30:31], v[36:37] neg_lo:[0,1] neg_hi:[0,1]
v_pk_add_f32 v[30:31], v[30:31], v[36:37]
v_pk_add_f32 v[36:37], v[28:29], v[42:43] neg_lo:[0,1] neg_hi:[0,1]
v_pk_add_f32 v[28:29], v[28:29], v[42:43]
v_pk_add_f32 v[42:43], v[38:39], v[32:33] neg_lo:[0,1] neg_hi:[0,1]
v_pk_add_f32 v[38:39], v[38:39], v[32:33]
v_pk_add_f32 v[32:33], v[14:15], v[50:51] neg_lo:[0,1] neg_hi:[0,1]
v_pk_add_f32 v[14:15], v[14:15], v[50:51]
v_pk_add_f32 v[50:51], v[46:47], v[52:53] neg_lo:[0,1] neg_hi:[0,1]
v_pk_add_f32 v[46:47], v[46:47], v[52:53]
v_pk_add_f32 v[52:53], v[44:45], v[58:59] neg_lo:[0,1] neg_hi:[0,1]
v_pk_add_f32 v[44:45], v[44:45], v[58:59]
v_pk_add_f32 v[58:59], v[54:55], v[56:57] neg_lo:[0,1] neg_hi:[0,1]
v_pk_add_f32 v[54:55], v[54:55], v[56:57]
v_pk_add_f32 v[56:57], v[40:41], v[66:67] neg_lo:[0,1] neg_hi:[0,1]
v_pk_add_f32 v[40:41], v[40:41], v[66:67]
v_pk_add_f32 v[66:67], v[62:63], v[68:69] neg_lo:[0,1] neg_hi:[0,1]
v_pk_add_f32 v[62:63], v[62:63], v[68:69]
v_pk_add_f32 v[68:69], v[60:61], v[74:75] neg_lo:[0,1] neg_hi:[0,1]
v_pk_add_f32 v[60:61], v[60:61], v[74:75]
v_pk_add_f32 v[74:75], v[70:71], v[48:49] neg_lo:[0,1] neg_hi:[0,1]
v_pk_add_f32 v[70:71], v[70:71], v[48:49]
v_pk_mul_f32 v[48:49], v[14:15], v[82:83] op_sel:[0,0] op_sel_hi:[0,1] neg_lo:[0,0] neg_hi:[0,0]
v_pk_fma_f32 v[14:15], v[14:15], v[82:83], v[48:49] op_sel:[1,1,0] op_sel_hi:[1,0,1] neg_lo:[0,1,0] neg_hi:[0,0,0]
v_pk_mul_f32 v[48:49], v[64:65], v[84:85] op_sel:[0,0] op_sel_hi:[0,1] neg_lo:[0,0] neg_hi:[0,0]
v_pk_fma_f32 v[64:65], v[64:65], v[84:85], v[48:49] op_sel:[1,1,0] op_sel_hi:[1,0,1] neg_lo:[0,1,0] neg_hi:[0,0,0]
v_pk_mul_f32 v[48:49], v[40:41], v[86:87] op_sel:[0,0] op_sel_hi:[0,1] neg_lo:[0,0] neg_hi:[0,0]
v_pk_fma_f32 v[40:41], v[40:41], v[86:87], v[48:49] op_sel:[1,1,0] op_sel_hi:[1,0,1] neg_lo:[0,1,0] neg_hi:[0,0,0]
v_pk_mul_f32 v[48:49], v[72:73], v[88:89] op_sel:[0,0] op_sel_hi:[0,1] neg_lo:[0,0] neg_hi:[0,0]
v_pk_fma_f32 v[72:73], v[72:73], v[88:89], v[48:49] op_sel:[1,1,0] op_sel_hi:[1,0,1] neg_lo:[0,1,0] neg_hi:[0,0,0]
v_pk_mul_f32 v[48:49], v[44:45], v[90:91] op_sel:[0,0] op_sel_hi:[0,1] neg_lo:[0,0] neg_hi:[0,0]
v_pk_fma_f32 v[44:45], v[44:45], v[90:91], v[48:49] op_sel:[1,1,0] op_sel_hi:[1,0,1] neg_lo:[0,1,0] neg_hi:[0,0,0]
v_pk_mul_f32 v[48:49], v[28:29], v[92:93] op_sel:[0,0] op_sel_hi:[0,1] neg_lo:[0,0] neg_hi:[0,0]
v_pk_fma_f32 v[28:29], v[28:29], v[92:93], v[48:49] op_sel:[1,1,0] op_sel_hi:[1,0,1] neg_lo:[0,1,0] neg_hi:[0,0,0]
v_pk_mul_f32 v[48:49], v[60:61], v[94:95] op_sel:[0,0] op_sel_hi:[0,1] neg_lo:[0,0] neg_hi:[0,0]
v_pk_fma_f32 v[60:61], v[60:61], v[94:95], v[48:49] op_sel:[1,1,0] op_sel_hi:[1,0,1] neg_lo:[0,1,0] neg_hi:[0,0,0]
v_pk_mul_f32 v[48:49], v[76:77], v[96:97] op_sel:[0,0] op_sel_hi:[0,1] neg_lo:[0,0] neg_hi:[0,0]
v_pk_fma_f32 v[76:77], v[76:77], v[96:97], v[48:49] op_sel:[1,1,0] op_sel_hi:[1,0,1] neg_lo:[0,1,0] neg_hi:[0,0,0]
v_pk_mul_f32 v[48:49], v[46:47], v[98:99] op_sel:[0,0] op_sel_hi:[0,1] neg_lo:[0,0] neg_hi:[0,0]
v_pk_fma_f32 v[46:47], v[46:47], v[98:99], v[48:49] op_sel:[1,1,0] op_sel_hi:[1,0,1] neg_lo:[0,1,0] neg_hi:[0,0,0]
v_pk_mul_f32 v[48:49], v[30:31], v[100:101] op_sel:[0,0] op_sel_hi:[0,1] neg_lo:[0,0] neg_hi:[0,0]
v_pk_fma_f32 v[30:31], v[30:31], v[100:101], v[48:49] op_sel:[1,1,0] op_sel_hi:[1,0,1] neg_lo:[0,1,0] neg_hi:[0,0,0]
v_pk_mul_f32 v[48:49], v[62:63], v[102:103] op_sel:[0,0] op_sel_hi:[0,1] neg_lo:[0,0] neg_hi:[0,0]
v_pk_fma_f32 v[62:63], v[62:63], v[102:103], v[48:49] op_sel:[1,1,0] op_sel_hi:[1,0,1] neg_lo:[0,1,0] neg_hi:[0,0,0]
v_pk_mul_f32 v[48:49], v[22:23], v[104:105] op_sel:[0,0] op_sel_hi:[0,1] neg_lo:[0,0] neg_hi:[0,0]
v_pk_fma_f32 v[22:23], v[22:23], v[104:105], v[48:49] op_sel:[1,1,0] op_sel_hi:[1,0,1] neg_lo:[0,1,0] neg_hi:[0,0,0]
v_pk_mul_f32 v[48:49], v[54:55], v[106:107] op_sel:[0,0] op_sel_hi:[0,1] neg_lo:[0,0] neg_hi:[0,0]
v_pk_fma_f32 v[54:55], v[54:55], v[106:107], v[48:49] op_sel:[1,1,0] op_sel_hi:[1,0,1] neg_lo:[0,1,0] neg_hi:[0,0,0]
v_pk_mul_f32 v[48:49], v[38:39], v[108:109] op_sel:[0,0] op_sel_hi:[0,1] neg_lo:[0,0] neg_hi:[0,0]
v_pk_fma_f32 v[38:39], v[38:39], v[108:109], v[48:49] op_sel:[1,1,0] op_sel_hi:[1,0,1] neg_lo:[0,1,0] neg_hi:[0,0,0]
v_pk_mul_f32 v[48:49], v[70:71], v[110:111] op_sel:[0,0] op_sel_hi:[0,1] neg_lo:[0,0] neg_hi:[0,0]
v_pk_fma_f32 v[70:71], v[70:71], v[110:111], v[48:49] op_sel:[1,1,0] op_sel_hi:[1,0,1] neg_lo:[0,1,0] neg_hi:[0,0,0]
v_pk_mul_f32 v[48:49], v[78:79], v[112:113] op_sel:[0,0] op_sel_hi:[0,1] neg_lo:[0,0] neg_hi:[0,0]
v_pk_fma_f32 v[78:79], v[78:79], v[112:113], v[48:49] op_sel:[1,1,0] op_sel_hi:[1,0,1] neg_lo:[0,1,0] neg_hi:[0,0,0]
v_pk_mul_f32 v[48:49], v[32:33], v[114:115] op_sel:[0,0] op_sel_hi:[0,1] neg_lo:[0,0] neg_hi:[0,0]
v_pk_fma_f32 v[32:33], v[32:33], v[114:115], v[48:49] op_sel:[1,1,0] op_sel_hi:[1,0,1] neg_lo:[0,1,0] neg_hi:[0,0,0]
v_pk_mul_f32 v[48:49], v[24:25], v[116:117] op_sel:[0,0] op_sel_hi:[0,1] neg_lo:[0,0] neg_hi:[0,0]
v_pk_fma_f32 v[24:25], v[24:25], v[116:117], v[48:49] op_sel:[1,1,0] op_sel_hi:[1,0,1] neg_lo:[0,1,0] neg_hi:[0,0,0]
v_pk_mul_f32 v[48:49], v[56:57], v[118:119] op_sel:[0,0] op_sel_hi:[0,1] neg_lo:[0,0] neg_hi:[0,0]
v_pk_fma_f32 v[56:57], v[56:57], v[118:119], v[48:49] op_sel:[1,1,0] op_sel_hi:[1,0,1] neg_lo:[0,1,0] neg_hi:[0,0,0]
v_pk_mul_f32 v[48:49], v[20:21], v[120:121] op_sel:[0,0] op_sel_hi:[0,1] neg_lo:[0,0] neg_hi:[0,0]
v_pk_fma_f32 v[20:21], v[20:21], v[120:121], v[48:49] op_sel:[1,1,0] op_sel_hi:[1,0,1] neg_lo:[0,1,0] neg_hi:[0,0,0]
v_pk_mul_f32 v[48:49], v[52:53], v[122:123] op_sel:[0,0] op_sel_hi:[0,1] neg_lo:[0,0] neg_hi:[0,0]
v_pk_fma_f32 v[52:53], v[52:53], v[122:123], v[48:49] op_sel:[1,1,0] op_sel_hi:[1,0,1] neg_lo:[0,1,0] neg_hi:[0,0,0]
v_pk_mul_f32 v[48:49], v[36:37], v[124:125] op_sel:[0,0] op_sel_hi:[0,1] neg_lo:[0,0] neg_hi:[0,0]
v_pk_fma_f32 v[36:37], v[36:37], v[124:125], v[48:49] op_sel:[1,1,0] op_sel_hi:[1,0,1] neg_lo:[0,1,0] neg_hi:[0,0,0]
v_pk_mul_f32 v[48:49], v[68:69], v[126:127] op_sel:[0,0] op_sel_hi:[0,1] neg_lo:[0,0] neg_hi:[0,0]
v_pk_fma_f32 v[68:69], v[68:69], v[126:127], v[48:49] op_sel:[1,1,0] op_sel_hi:[1,0,1] neg_lo:[0,1,0] neg_hi:[0,0,0]
v_pk_mul_f32 v[48:49], v[18:19], v[128:129] op_sel:[0,0] op_sel_hi:[0,1] neg_lo:[0,0] neg_hi:[0,0]
v_pk_fma_f32 v[18:19], v[18:19], v[128:129], v[48:49] op_sel:[1,1,0] op_sel_hi:[1,0,1] neg_lo:[0,1,0] neg_hi:[0,0,0]
v_pk_mul_f32 v[48:49], v[50:51], v[130:131] op_sel:[0,0] op_sel_hi:[0,1] neg_lo:[0,0] neg_hi:[0,0]
v_pk_fma_f32 v[50:51], v[50:51], v[130:131], v[48:49] op_sel:[1,1,0] op_sel_hi:[1,0,1] neg_lo:[0,1,0] neg_hi:[0,0,0]
v_pk_mul_f32 v[48:49], v[34:35], v[132:133] op_sel:[0,0] op_sel_hi:[0,1] neg_lo:[0,0] neg_hi:[0,0]
v_pk_fma_f32 v[34:35], v[34:35], v[132:133], v[48:49] op_sel:[1,1,0] op_sel_hi:[1,0,1] neg_lo:[0,1,0] neg_hi:[0,0,0]
v_pk_mul_f32 v[48:49], v[66:67], v[134:135] op_sel:[0,0] op_sel_hi:[0,1] neg_lo:[0,0] neg_hi:[0,0]
v_pk_fma_f32 v[66:67], v[66:67], v[134:135], v[48:49] op_sel:[1,1,0] op_sel_hi:[1,0,1] neg_lo:[0,1,0] neg_hi:[0,0,0]
v_pk_mul_f32 v[48:49], v[26:27], v[136:137] op_sel:[0,0] op_sel_hi:[0,1] neg_lo:[0,0] neg_hi:[0,0]
v_pk_fma_f32 v[26:27], v[26:27], v[136:137], v[48:49] op_sel:[1,1,0] op_sel_hi:[1,0,1] neg_lo:[0,1,0] neg_hi:[0,0,0]
v_pk_mul_f32 v[48:49], v[58:59], v[138:139] op_sel:[0,0] op_sel_hi:[0,1] neg_lo:[0,0] neg_hi:[0,0]
v_pk_fma_f32 v[58:59], v[58:59], v[138:139], v[48:49] op_sel:[1,1,0] op_sel_hi:[1,0,1] neg_lo:[0,1,0] neg_hi:[0,0,0]
v_pk_mul_f32 v[48:49], v[42:43], v[140:141] op_sel:[0,0] op_sel_hi:[0,1] neg_lo:[0,0] neg_hi:[0,0]
v_pk_fma_f32 v[42:43], v[42:43], v[140:141], v[48:49] op_sel:[1,1,0] op_sel_hi:[1,0,1] neg_lo:[0,1,0] neg_hi:[0,0,0]
v_pk_mul_f32 v[48:49], v[74:75], v[142:143] op_sel:[0,0] op_sel_hi:[0,1] neg_lo:[0,0] neg_hi:[0,0]
v_pk_fma_f32 v[74:75], v[74:75], v[142:143], v[48:49] op_sel:[1,1,0] op_sel_hi:[1,0,1] neg_lo:[0,1,0] neg_hi:[0,0,0]
ds_write_b64 v3, v[16:17] offset:0
ds_write_b64 v3, v[14:15] offset:528
ds_write_b64 v3, v[64:65] offset:1056
ds_write_b64 v3, v[40:41] offset:1584
ds_write_b64 v3, v[72:73] offset:2112
ds_write_b64 v3, v[44:45] offset:2640
ds_write_b64 v3, v[28:29] offset:3168
ds_write_b64 v3, v[60:61] offset:3696
ds_write_b64 v3, v[76:77] offset:4224
ds_write_b64 v3, v[46:47] offset:4752
ds_write_b64 v3, v[30:31] offset:5280
ds_write_b64 v3, v[62:63] offset:5808
ds_write_b64 v3, v[22:23] offset:6336
ds_write_b64 v3, v[54:55] offset:6864
ds_write_b64 v3, v[38:39] offset:7392
ds_write_b64 v3, v[70:71] offset:7920
ds_write_b64 v3, v[78:79] offset:8448
ds_write_b64 v3, v[32:33] offset:8976
ds_write_b64 v3, v[24:25] offset:9504
ds_write_b64 v3, v[56:57] offset:10032
ds_write_b64 v3, v[20:21] offset:10560
ds_write_b64 v3, v[52:53] offset:11088
ds_write_b64 v3, v[36:37] offset:11616
ds_write_b64 v3, v[68:69] offset:12144
ds_write_b64 v3, v[18:19] offset:12672
ds_write_b64 v3, v[50:51] offset:13200
ds_write_b64 v3, v[34:35] offset:13728
ds_write_b64 v3, v[66:67] offset:14256
ds_write_b64 v3, v[26:27] offset:14784
ds_write_b64 v3, v[58:59] offset:15312
ds_write_b64 v3, v[42:43] offset:15840
ds_write_b64 v3, v[74:75] offset:16368
s_waitcnt lgkmcnt(0)
ds_read_b64 v[16:17], v4 offset:0
ds_read_b64 v[48:49], v4 offset:256
ds_read_b64 v[18:19], v4 offset:16
ds_read_b64 v[50:51], v4 offset:272
ds_read_b64 v[20:21], v4 offset:32
ds_read_b64 v[52:53], v4 offset:288
ds_read_b64 v[22:23], v4 offset:48
ds_read_b64 v[54:55], v4 offset:304
ds_read_b64 v[24:25], v4 offset:64
ds_read_b64 v[56:57], v4 offset:320
ds_read_b64 v[26:27], v4 offset:80
ds_read_b64 v[58:59], v4 offset:336
ds_read_b64 v[28:29], v4 offset:96
ds_read_b64 v[60:61], v4 offset:352
ds_read_b64 v[30:31], v4 offset:112
ds_read_b64 v[62:63], v4 offset:368
ds_read_b64 v[32:33], v4 offset:128
ds_read_b64 v[64:65], v4 offset:384
ds_read_b64 v[34:35], v4 offset:144
ds_read_b64 v[66:67], v4 offset:400
ds_read_b64 v[36:37], v4 offset:160
ds_read_b64 v[68:69], v4 offset:416
ds_read_b64 v[38:39], v4 offset:176
ds_read_b64 v[70:71], v4 offset:432
ds_read_b64 v[40:41], v4 offset:192
ds_read_b64 v[72:73], v4 offset:448
ds_read_b64 v[42:43], v4 offset:208
ds_read_b64 v[74:75], v4 offset:464
ds_read_b64 v[44:45], v4 offset:224
ds_read_b64 v[76:77], v4 offset:480
ds_read_b64 v[46:47], v4 offset:240
ds_read_b64 v[78:79], v4 offset:496
s_waitcnt lgkmcnt(0)
v_pk_add_f32 v[14:15], v[16:17], v[48:49] neg_lo:[0,1] neg_hi:[0,1]
v_pk_add_f32 v[16:17], v[16:17], v[48:49]
v_pk_add_f32 v[48:49], v[18:19], v[50:51] neg_lo:[0,1] neg_hi:[0,1]
v_pk_add_f32 v[18:19], v[18:19], v[50:51]
v_pk_mul_f32 v[50:51], v[48:49], s[50:51] op_sel:[0,0] op_sel_hi:[0,1] neg_lo:[0,0] neg_hi:[0,1]
v_pk_fma_f32 v[50:51], v[48:49], s[50:51], v[50:51] op_sel:[1,1,0] op_sel_hi:[1,0,1] neg_lo:[0,0,0] neg_hi:[0,0,0]
v_pk_add_f32 v[48:49], v[20:21], v[52:53] neg_lo:[0,1] neg_hi:[0,1]
v_pk_add_f32 v[20:21], v[20:21], v[52:53]
v_pk_mul_f32 v[52:53], v[48:49], s[54:55] op_sel:[0,0] op_sel_hi:[0,1] neg_lo:[0,0] neg_hi:[0,1]
v_pk_fma_f32 v[52:53], v[48:49], s[54:55], v[52:53] op_sel:[1,1,0] op_sel_hi:[1,0,1] neg_lo:[0,0,0] neg_hi:[0,0,0]
v_pk_add_f32 v[48:49], v[22:23], v[54:55] neg_lo:[0,1] neg_hi:[0,1]
v_pk_add_f32 v[22:23], v[22:23], v[54:55]
v_pk_mul_f32 v[54:55], v[48:49], s[58:59] op_sel:[0,0] op_sel_hi:[0,1] neg_lo:[0,0] neg_hi:[0,1]
v_pk_fma_f32 v[54:55], v[48:49], s[58:59], v[54:55] op_sel:[1,1,0] op_sel_hi:[1,0,1] neg_lo:[0,0,0] neg_hi:[0,0,0]
v_pk_add_f32 v[48:49], v[24:25], v[56:57] neg_lo:[0,1] neg_hi:[0,1]
v_pk_add_f32 v[24:25], v[24:25], v[56:57]
v_pk_mul_f32 v[56:57], v[48:49], s[62:63] op_sel:[0,0] op_sel_hi:[0,1] neg_lo:[0,0] neg_hi:[0,1]
v_pk_fma_f32 v[56:57], v[48:49], s[62:63], v[56:57] op_sel:[1,1,0] op_sel_hi:[1,0,1] neg_lo:[0,0,0] neg_hi:[0,0,0]
v_pk_add_f32 v[48:49], v[26:27], v[58:59] neg_lo:[0,1] neg_hi:[0,1]
v_pk_add_f32 v[26:27], v[26:27], v[58:59]
v_pk_mul_f32 v[58:59], v[48:49], s[58:59] op_sel:[0,1] op_sel_hi:[0,0] neg_lo:[0,0] neg_hi:[0,1]
v_pk_fma_f32 v[58:59], v[48:49], s[58:59], v[58:59] op_sel:[1,0,0] op_sel_hi:[1,1,1] neg_lo:[0,0,0] neg_hi:[0,0,0]
v_pk_add_f32 v[48:49], v[28:29], v[60:61] neg_lo:[0,1] neg_hi:[0,1]
v_pk_add_f32 v[28:29], v[28:29], v[60:61]
v_pk_mul_f32 v[60:61], v[48:49], s[54:55] op_sel:[0,1] op_sel_hi:[0,0] neg_lo:[0,0] neg_hi:[0,1]
v_pk_fma_f32 v[60:61], v[48:49], s[54:55], v[60:61] op_sel:[1,0,0] op_sel_hi:[1,1,1] neg_lo:[0,0,0] neg_hi:[0,0,0]
v_pk_add_f32 v[48:49], v[30:31], v[62:63] neg_lo:[0,1] neg_hi:[0,1]
v_pk_add_f32 v[30:31], v[30:31], v[62:63]
v_pk_mul_f32 v[62:63], v[48:49], s[50:51] op_sel:[0,1] op_sel_hi:[0,0] neg_lo:[0,0] neg_hi:[0,1]
v_pk_fma_f32 v[62:63], v[48:49], s[50:51], v[62:63] op_sel:[1,0,0] op_sel_hi:[1,1,1] neg_lo:[0,0,0] neg_hi:[0,0,0]
v_pk_add_f32 v[48:49], v[32:33], v[64:65] op_sel:[1,1] op_sel_hi:[0,0] neg_lo:[0,1] neg_hi:[1,0]
v_pk_add_f32 v[32:33], v[32:33], v[64:65]
v_pk_add_f32 v[64:65], v[34:35], v[66:67] neg_lo:[0,1] neg_hi:[0,1]
v_pk_add_f32 v[34:35], v[34:35], v[66:67]
v_pk_mul_f32 v[66:67], v[64:65], s[50:51] op_sel:[0,1] op_sel_hi:[0,0] neg_lo:[0,1] neg_hi:[0,1]
v_pk_fma_f32 v[66:67], v[64:65], s[50:51], v[66:67] op_sel:[1,0,0] op_sel_hi:[1,1,1] neg_lo:[0,0,0] neg_hi:[0,1,0]
v_pk_add_f32 v[64:65], v[36:37], v[68:69] neg_lo:[0,1] neg_hi:[0,1]
v_pk_add_f32 v[36:37], v[36:37], v[68:69]
v_pk_mul_f32 v[68:69], v[64:65], s[54:55] op_sel:[0,1] op_sel_hi:[0,0] neg_lo:[0,1] neg_hi:[0,1]
v_pk_fma_f32 v[68:69], v[64:65], s[54:55], v[68:69] op_sel:[1,0,0] op_sel_hi:[1,1,1] neg_lo:[0,0,0] neg_hi:[0,1,0]
v_pk_add_f32 v[64:65], v[38:39], v[70:71] neg_lo:[0,1] neg_hi:[0,1]
v_pk_add_f32 v[38:39], v[38:39], v[70:71]
v_pk_mul_f32 v[70:71], v[64:65], s[58:59] op_sel:[0,1] op_sel_hi:[0,0] neg_lo:[0,1] neg_hi:[0,1]
v_pk_fma_f32 v[70:71], v[64:65], s[58:59], v[70:71] op_sel:[1,0,0] op_sel_hi:[1,1,1] neg_lo:[0,0,0] neg_hi:[0,1,0]
v_pk_add_f32 v[64:65], v[40:41], v[72:73] neg_lo:[0,1] neg_hi:[0,1]
v_pk_add_f32 v[40:41], v[40:41], v[72:73]
v_pk_mul_f32 v[72:73], v[64:65], s[62:63] op_sel:[0,0] op_sel_hi:[0,1] neg_lo:[0,1] neg_hi:[0,1]
v_pk_fma_f32 v[72:73], v[64:65], s[62:63], v[72:73] op_sel:[1,1,0] op_sel_hi:[1,0,1] neg_lo:[0,0,0] neg_hi:[0,1,0]
v_pk_add_f32 v[64:65], v[42:43], v[74:75] neg_lo:[0,1] neg_hi:[0,1]
v_pk_add_f32 v[42:43], v[42:43], v[74:75]
v_pk_mul_f32 v[74:75], v[64:65], s[58:59] op_sel:[0,0] op_sel_hi:[0,1] neg_lo:[0,1] neg_hi:[0,1]
v_pk_fma_f32 v[74:75], v[64:65], s[58:59], v[74:75] op_sel:[1,1,0] op_sel_hi:[1,0,1] neg_lo:[0,0,0] neg_hi:[0,1,0]
v_pk_add_f32 v[64:65], v[44:45], v[76:77] neg_lo:[0,1] neg_hi:[0,1]
v_pk_add_f32 v[44:45], v[44:45], v[76:77]
v_pk_mul_f32 v[76:77], v[64:65], s[54:55] op_sel:[0,0] op_sel_hi:[0,1] neg_lo:[0,1] neg_hi:[0,1]
v_pk_fma_f32 v[76:77], v[64:65], s[54:55], v[76:77] op_sel:[1,1,0] op_sel_hi:[1,0,1] neg_lo:[0,0,0] neg_hi:[0,1,0]
v_pk_add_f32 v[64:65], v[46:47], v[78:79] neg_lo:[0,1] neg_hi:[0,1]
v_pk_add_f32 v[46:47], v[46:47], v[78:79]
v_pk_mul_f32 v[78:79], v[64:65], s[50:51] op_sel:[0,0] op_sel_hi:[0,1] neg_lo:[0,1] neg_hi:[0,1]
v_pk_fma_f32 v[78:79], v[64:65], s[50:51], v[78:79] op_sel:[1,1,0] op_sel_hi:[1,0,1] neg_lo:[0,0,0] neg_hi:[0,1,0]
v_pk_add_f32 v[64:65], v[16:17], v[32:33] neg_lo:[0,1] neg_hi:[0,1]
v_pk_add_f32 v[16:17], v[16:17], v[32:33]
v_pk_add_f32 v[32:33], v[18:19], v[34:35] neg_lo:[0,1] neg_hi:[0,1]
v_pk_add_f32 v[18:19], v[18:19], v[34:35]
v_pk_mul_f32 v[34:35], v[32:33], s[54:55] op_sel:[0,0] op_sel_hi:[0,1] neg_lo:[0,0] neg_hi:[0,1]
v_pk_fma_f32 v[34:35], v[32:33], s[54:55], v[34:35] op_sel:[1,1,0] op_sel_hi:[1,0,1] neg_lo:[0,0,0] neg_hi:[0,0,0]
v_pk_add_f32 v[32:33], v[20:21], v[36:37] neg_lo:[0,1] neg_hi:[0,1]
v_pk_add_f32 v[20:21], v[20:21], v[36:37]
v_pk_mul_f32 v[36:37], v[32:33], s[62:63] op_sel:[0,0] op_sel_hi:[0,1] neg_lo:[0,0] neg_hi:[0,1]
v_pk_fma_f32 v[36:37], v[32:33], s[62:63], v[36:37] op_sel:[1,1,0] op_sel_hi:[1,0,1] neg_lo:[0,0,0] neg_hi:[0,0,0]
v_pk_add_f32 v[32:33], v[22:23], v[38:39] neg_lo:[0,1] neg_hi:[0,1]
v_pk_add_f32 v[22:23], v[22:23], v[38:39]
v_pk_mul_f32 v[38:39], v[32:33], s[54:55] op_sel:[0,1] op_sel_hi:[0,0] neg_lo:[0,0] neg_hi:[0,1]
v_pk_fma_f32 v[38:39], v[32:33], s[54:55], v[38:39] op_sel:[1,0,0] op_sel_hi:[1,1,1] neg_lo:[0,0,0] neg_hi:[0,0,0]
v_pk_add_f32 v[32:33], v[24:25], v[40:41] op_sel:[1,1] op_sel_hi:[0,0] neg_lo:[0,1] neg_hi:[1,0]
v_pk_add_f32 v[24:25], v[24:25], v[40:41]
v_pk_add_f32 v[40:41], v[26:27], v[42:43] neg_lo:[0,1] neg_hi:[0,1]
v_pk_add_f32 v[26:27], v[26:27], v[42:43]
v_pk_mul_f32 v[42:43], v[40:41], s[54:55] op_sel:[0,1] op_sel_hi:[0,0] neg_lo:[0,1] neg_hi:[0,1]
v_pk_fma_f32 v[42:43], v[40:41], s[54:55], v[42:43] op_sel:[1,0,0] op_sel_hi:[1,1,1] neg_lo:[0,0,0] neg_hi:[0,1,0]
v_pk_add_f32 v[40:41], v[28:29], v[44:45] neg_lo:[0,1] neg_hi:[0,1]
v_pk_add_f32 v[28:29], v[28:29], v[44:45]
v_pk_mul_f32 v[44:45], v[40:41], s[62:63] op_sel:[0,0] op_sel_hi:[0,1] neg_lo:[0,1] neg_hi:[0,1]
v_pk_fma_f32 v[44:45], v[40:41], s[62:63], v[44:45] op_sel:[1,1,0] op_sel_hi:[1,0,1] neg_lo:[0,0,0] neg_hi:[0,1,0]
v_pk_add_f32 v[40:41], v[30:31], v[46:47] neg_lo:[0,1] neg_hi:[0,1]
v_pk_add_f32 v[30:31], v[30:31], v[46:47]
v_pk_mul_f32 v[46:47], v[40:41], s[54:55] op_sel:[0,0] op_sel_hi:[0,1] neg_lo:[0,1] neg_hi:[0,1]
v_pk_fma_f32 v[46:47], v[40:41], s[54:55], v[46:47] op_sel:[1,1,0] op_sel_hi:[1,0,1] neg_lo:[0,0,0] neg_hi:[0,1,0]
v_pk_add_f32 v[40:41], v[14:15], v[48:49] neg_lo:[0,1] neg_hi:[0,1]
v_pk_add_f32 v[14:15], v[14:15], v[48:49]
v_pk_add_f32 v[48:49], v[50:51], v[66:67] neg_lo:[0,1] neg_hi:[0,1]
v_pk_add_f32 v[50:51], v[50:51], v[66:67]
v_pk_mul_f32 v[66:67], v[48:49], s[54:55] op_sel:[0,0] op_sel_hi:[0,1] neg_lo:[0,0] neg_hi:[0,1]
v_pk_fma_f32 v[66:67], v[48:49], s[54:55], v[66:67] op_sel:[1,1,0] op_sel_hi:[1,0,1] neg_lo:[0,0,0] neg_hi:[0,0,0]
v_pk_add_f32 v[48:49], v[52:53], v[68:69] neg_lo:[0,1] neg_hi:[0,1]
v_pk_add_f32 v[52:53], v[52:53], v[68:69]
v_pk_mul_f32 v[68:69], v[48:49], s[62:63] op_sel:[0,0] op_sel_hi:[0,1] neg_lo:[0,0] neg_hi:[0,1]
v_pk_fma_f32 v[68:69], v[48:49], s[62:63], v[68:69] op_sel:[1,1,0] op_sel_hi:[1,0,1] neg_lo:[0,0,0] neg_hi:[0,0,0]
v_pk_add_f32 v[48:49], v[54:55], v[70:71] neg_lo:[0,1] neg_hi:[0,1]
v_pk_add_f32 v[54:55], v[54:55], v[70:71]
v_pk_mul_f32 v[70:71], v[48:49], s[54:55] op_sel:[0,1] op_sel_hi:[0,0] neg_lo:[0,0] neg_hi:[0,1]
v_pk_fma_f32 v[70:71], v[48:49], s[54:55], v[70:71] op_sel:[1,0,0] op_sel_hi:[1,1,1] neg_lo:[0,0,0] neg_hi:[0,0,0]
v_pk_add_f32 v[48:49], v[56:57], v[72:73] op_sel:[1,1] op_sel_hi:[0,0] neg_lo:[0,1] neg_hi:[1,0]
v_pk_add_f32 v[56:57], v[56:57], v[72:73]
v_pk_add_f32 v[72:73], v[58:59], v[74:75] neg_lo:[0,1] neg_hi:[0,1]
v_pk_add_f32 v[58:59], v[58:59], v[74:75]
v_pk_mul_f32 v[74:75], v[72:73], s[54:55] op_sel:[0,1] op_sel_hi:[0,0] neg_lo:[0,1] neg_hi:[0,1]
v_pk_fma_f32 v[74:75], v[72:73], s[54:55], v[74:75] op_sel:[1,0,0] op_sel_hi:[1,1,1] neg_lo:[0,0,0] neg_hi:[0,1,0]
v_pk_add_f32 v[72:73], v[60:61], v[76:77] neg_lo:[0,1] neg_hi:[0,1]
v_pk_add_f32 v[60:61], v[60:61], v[76:77]
v_pk_mul_f32 v[76:77], v[72:73], s[62:63] op_sel:[0,0] op_sel_hi:[0,1] neg_lo:[0,1] neg_hi:[0,1]
v_pk_fma_f32 v[76:77], v[72:73], s[62:63], v[76:77] op_sel:[1,1,0] op_sel_hi:[1,0,1] neg_lo:[0,0,0] neg_hi:[0,1,0]
v_pk_add_f32 v[72:73], v[62:63], v[78:79] neg_lo:[0,1] neg_hi:[0,1]
v_pk_add_f32 v[62:63], v[62:63], v[78:79]
v_pk_mul_f32 v[78:79], v[72:73], s[54:55] op_sel:[0,0] op_sel_hi:[0,1] neg_lo:[0,1] neg_hi:[0,1]
v_pk_fma_f32 v[78:79], v[72:73], s[54:55], v[78:79] op_sel:[1,1,0] op_sel_hi:[1,0,1] neg_lo:[0,0,0] neg_hi:[0,1,0]
v_pk_add_f32 v[72:73], v[16:17], v[24:25] neg_lo:[0,1] neg_hi:[0,1]
v_pk_add_f32 v[16:17], v[16:17], v[24:25]
v_pk_add_f32 v[24:25], v[18:19], v[26:27] neg_lo:[0,1] neg_hi:[0,1]
v_pk_add_f32 v[18:19], v[18:19], v[26:27]
v_pk_mul_f32 v[26:27], v[24:25], s[62:63] op_sel:[0,0] op_sel_hi:[0,1] neg_lo:[0,0] neg_hi:[0,1]
v_pk_fma_f32 v[26:27], v[24:25], s[62:63], v[26:27] op_sel:[1,1,0] op_sel_hi:[1,0,1] neg_lo:[0,0,0] neg_hi:[0,0,0]
v_pk_add_f32 v[24:25], v[20:21], v[28:29] op_sel:[1,1] op_sel_hi:[0,0] neg_lo:[0,1] neg_hi:[1,0]
v_pk_add_f32 v[20:21], v[20:21], v[28:29]
v_pk_add_f32 v[28:29], v[22:23], v[30:31] neg_lo:[0,1] neg_hi:[0,1]
v_pk_add_f32 v[22:23], v[22:23], v[30:31]
v_pk_mul_f32 v[30:31], v[28:29], s[62:63] op_sel:[0,0] op_sel_hi:[0,1] neg_lo:[0,1] neg_hi:[0,1]
v_pk_fma_f32 v[30:31], v[28:29], s[62:63], v[30:31] op_sel:[1,1,0] op_sel_hi:[1,0,1] neg_lo:[0,0,0] neg_hi:[0,1,0]
v_pk_add_f32 v[28:29], v[64:65], v[32:33] neg_lo:[0,1] neg_hi:[0,1]
v_pk_add_f32 v[64:65], v[64:65], v[32:33]
v_pk_add_f32 v[32:33], v[34:35], v[42:43] neg_lo:[0,1] neg_hi:[0,1]
v_pk_add_f32 v[34:35], v[34:35], v[42:43]
v_pk_mul_f32 v[42:43], v[32:33], s[62:63] op_sel:[0,0] op_sel_hi:[0,1] neg_lo:[0,0] neg_hi:[0,1]
v_pk_fma_f32 v[42:43], v[32:33], s[62:63], v[42:43] op_sel:[1,1,0] op_sel_hi:[1,0,1] neg_lo:[0,0,0] neg_hi:[0,0,0]
v_pk_add_f32 v[32:33], v[36:37], v[44:45] op_sel:[1,1] op_sel_hi:[0,0] neg_lo:[0,1] neg_hi:[1,0]
v_pk_add_f32 v[36:37], v[36:37], v[44:45]
v_pk_add_f32 v[44:45], v[38:39], v[46:47] neg_lo:[0,1] neg_hi:[0,1]
v_pk_add_f32 v[38:39], v[38:39], v[46:47]
v_pk_mul_f32 v[46:47], v[44:45], s[62:63] op_sel:[0,0] op_sel_hi:[0,1] neg_lo:[0,1] neg_hi:[0,1]
v_pk_fma_f32 v[46:47], v[44:45], s[62:63], v[46:47] op_sel:[1,1,0] op_sel_hi:[1,0,1] neg_lo:[0,0,0] neg_hi:[0,1,0]
v_pk_add_f32 v[44:45], v[14:15], v[56:57] neg_lo:[0,1] neg_hi:[0,1]
v_pk_add_f32 v[14:15], v[14:15], v[56:57]
v_pk_add_f32 v[56:57], v[50:51], v[58:59] neg_lo:[0,1] neg_hi:[0,1]
v_pk_add_f32 v[50:51], v[50:51], v[58:59]
v_pk_mul_f32 v[58:59], v[56:57], s[62:63] op_sel:[0,0] op_sel_hi:[0,1] neg_lo:[0,0] neg_hi:[0,1]
v_pk_fma_f32 v[58:59], v[56:57], s[62:63], v[58:59] op_sel:[1,1,0] op_sel_hi:[1,0,1] neg_lo:[0,0,0] neg_hi:[0,0,0]
v_pk_add_f32 v[56:57], v[52:53], v[60:61] op_sel:[1,1] op_sel_hi:[0,0] neg_lo:[0,1] neg_hi:[1,0]
v_pk_add_f32 v[52:53], v[52:53], v[60:61]
v_pk_add_f32 v[60:61], v[54:55], v[62:63] neg_lo:[0,1] neg_hi:[0,1]
v_pk_add_f32 v[54:55], v[54:55], v[62:63]
v_pk_mul_f32 v[62:63], v[60:61], s[62:63] op_sel:[0,0] op_sel_hi:[0,1] neg_lo:[0,1] neg_hi:[0,1]
v_pk_fma_f32 v[62:63], v[60:61], s[62:63], v[62:63] op_sel:[1,1,0] op_sel_hi:[1,0,1] neg_lo:[0,0,0] neg_hi:[0,1,0]
v_pk_add_f32 v[60:61], v[40:41], v[48:49] neg_lo:[0,1] neg_hi:[0,1]
v_pk_add_f32 v[40:41], v[40:41], v[48:49]
v_pk_add_f32 v[48:49], v[66:67], v[74:75] neg_lo:[0,1] neg_hi:[0,1]
v_pk_add_f32 v[66:67], v[66:67], v[74:75]
v_pk_mul_f32 v[74:75], v[48:49], s[62:63] op_sel:[0,0] op_sel_hi:[0,1] neg_lo:[0,0] neg_hi:[0,1]
v_pk_fma_f32 v[74:75], v[48:49], s[62:63], v[74:75] op_sel:[1,1,0] op_sel_hi:[1,0,1] neg_lo:[0,0,0] neg_hi:[0,0,0]
v_pk_add_f32 v[48:49], v[68:69], v[76:77] op_sel:[1,1] op_sel_hi:[0,0] neg_lo:[0,1] neg_hi:[1,0]
v_pk_add_f32 v[68:69], v[68:69], v[76:77]
v_pk_add_f32 v[76:77], v[70:71], v[78:79] neg_lo:[0,1] neg_hi:[0,1]
v_pk_add_f32 v[70:71], v[70:71], v[78:79]
v_pk_mul_f32 v[78:79], v[76:77], s[62:63] op_sel:[0,0] op_sel_hi:[0,1] neg_lo:[0,1] neg_hi:[0,1]
v_pk_fma_f32 v[78:79], v[76:77], s[62:63], v[78:79] op_sel:[1,1,0] op_sel_hi:[1,0,1] neg_lo:[0,0,0] neg_hi:[0,1,0]
v_pk_add_f32 v[76:77], v[16:17], v[20:21] neg_lo:[0,1] neg_hi:[0,1]
v_pk_add_f32 v[16:17], v[16:17], v[20:21]
v_pk_add_f32 v[20:21], v[18:19], v[22:23] op_sel:[1,1] op_sel_hi:[0,0] neg_lo:[0,1] neg_hi:[1,0]
v_pk_add_f32 v[18:19], v[18:19], v[22:23]
v_pk_add_f32 v[22:23], v[72:73], v[24:25] neg_lo:[0,1] neg_hi:[0,1]
v_pk_add_f32 v[72:73], v[72:73], v[24:25]
v_pk_add_f32 v[24:25], v[26:27], v[30:31] op_sel:[1,1] op_sel_hi:[0,0] neg_lo:[0,1] neg_hi:[1,0]
v_pk_add_f32 v[26:27], v[26:27], v[30:31]
v_pk_add_f32 v[30:31], v[64:65], v[36:37] neg_lo:[0,1] neg_hi:[0,1]
v_pk_add_f32 v[64:65], v[64:65], v[36:37]
v_pk_add_f32 v[36:37], v[34:35], v[38:39] op_sel:[1,1] op_sel_hi:[0,0] neg_lo:[0,1] neg_hi:[1,0]
v_pk_add_f32 v[34:35], v[34:35], v[38:39]
v_pk_add_f32 v[38:39], v[28:29], v[32:33] neg_lo:[0,1] neg_hi:[0,1]
v_pk_add_f32 v[28:29], v[28:29], v[32:33]
v_pk_add_f32 v[32:33], v[42:43], v[46:47] op_sel:[1,1] op_sel_hi:[0,0] neg_lo:[0,1] neg_hi:[1,0]
v_pk_add_f32 v[42:43], v[42:43], v[46:47]
v_pk_add_f32 v[46:47], v[14:15], v[52:53] neg_lo:[0,1] neg_hi:[0,1]
v_pk_add_f32 v[14:15], v[14:15], v[52:53]
v_pk_add_f32 v[52:53], v[50:51], v[54:55] op_sel:[1,1] op_sel_hi:[0,0] neg_lo:[0,1] neg_hi:[1,0]
v_pk_add_f32 v[50:51], v[50:51], v[54:55]
v_pk_add_f32 v[54:55], v[44:45], v[56:57] neg_lo:[0,1] neg_hi:[0,1]
v_pk_add_f32 v[44:45], v[44:45], v[56:57]
v_pk_add_f32 v[56:57], v[58:59], v[62:63] op_sel:[1,1] op_sel_hi:[0,0] neg_lo:[0,1] neg_hi:[1,0]
v_pk_add_f32 v[58:59], v[58:59], v[62:63]
v_pk_add_f32 v[62:63], v[40:41], v[68:69] neg_lo:[0,1] neg_hi:[0,1]
v_pk_add_f32 v[40:41], v[40:41], v[68:69]
v_pk_add_f32 v[68:69], v[66:67], v[70:71] op_sel:[1,1] op_sel_hi:[0,0] neg_lo:[0,1] neg_hi:[1,0]
v_pk_add_f32 v[66:67], v[66:67], v[70:71]
v_pk_add_f32 v[70:71], v[60:61], v[48:49] neg_lo:[0,1] neg_hi:[0,1]
v_pk_add_f32 v[60:61], v[60:61], v[48:49]
v_pk_add_f32 v[48:49], v[74:75], v[78:79] op_sel:[1,1] op_sel_hi:[0,0] neg_lo:[0,1] neg_hi:[1,0]
v_pk_add_f32 v[74:75], v[74:75], v[78:79]
v_pk_add_f32 v[78:79], v[16:17], v[18:19] neg_lo:[0,1] neg_hi:[0,1]
v_pk_add_f32 v[16:17], v[16:17], v[18:19]
v_pk_add_f32 v[18:19], v[76:77], v[20:21] neg_lo:[0,1] neg_hi:[0,1]
v_pk_add_f32 v[76:77], v[76:77], v[20:21]
v_pk_add_f32 v[20:21], v[72:73], v[26:27] neg_lo:[0,1] neg_hi:[0,1]
v_pk_add_f32 v[72:73], v[72:73], v[26:27]
v_pk_add_f32 v[26:27], v[22:23], v[24:25] neg_lo:[0,1] neg_hi:[0,1]
v_pk_add_f32 v[22:23], v[22:23], v[24:25]
v_pk_add_f32 v[24:25], v[64:65], v[34:35] neg_lo:[0,1] neg_hi:[0,1]
v_pk_add_f32 v[64:65], v[64:65], v[34:35]
v_pk_add_f32 v[34:35], v[30:31], v[36:37] neg_lo:[0,1] neg_hi:[0,1]
v_pk_add_f32 v[30:31], v[30:31], v[36:37]
v_pk_add_f32 v[36:37], v[28:29], v[42:43] neg_lo:[0,1] neg_hi:[0,1]
v_pk_add_f32 v[28:29], v[28:29], v[42:43]
v_pk_add_f32 v[42:43], v[38:39], v[32:33] neg_lo:[0,1] neg_hi:[0,1]
v_pk_add_f32 v[38:39], v[38:39], v[32:33]
v_pk_add_f32 v[32:33], v[14:15], v[50:51] neg_lo:[0,1] neg_hi:[0,1]
v_pk_add_f32 v[14:15], v[14:15], v[50:51]
v_pk_add_f32 v[50:51], v[46:47], v[52:53] neg_lo:[0,1] neg_hi:[0,1]
v_pk_add_f32 v[46:47], v[46:47], v[52:53]
v_pk_add_f32 v[52:53], v[44:45], v[58:59] neg_lo:[0,1] neg_hi:[0,1]
v_pk_add_f32 v[44:45], v[44:45], v[58:59]
v_pk_add_f32 v[58:59], v[54:55], v[56:57] neg_lo:[0,1] neg_hi:[0,1]
v_pk_add_f32 v[54:55], v[54:55], v[56:57]
v_pk_add_f32 v[56:57], v[40:41], v[66:67] neg_lo:[0,1] neg_hi:[0,1]
v_pk_add_f32 v[40:41], v[40:41], v[66:67]
v_pk_add_f32 v[66:67], v[62:63], v[68:69] neg_lo:[0,1] neg_hi:[0,1]
v_pk_add_f32 v[62:63], v[62:63], v[68:69]
v_pk_add_f32 v[68:69], v[60:61], v[74:75] neg_lo:[0,1] neg_hi:[0,1]
v_pk_add_f32 v[60:61], v[60:61], v[74:75]
v_pk_add_f32 v[74:75], v[70:71], v[48:49] neg_lo:[0,1] neg_hi:[0,1]
v_pk_add_f32 v[70:71], v[70:71], v[48:49]
s_mov_b64 exec, s[18:19]
v_pk_add_f32 v[16:17], v[16:17], 0 neg_lo:[1,0] neg_hi:[1,0]
v_pk_mul_f32 v[48:49], v[14:15], s[48:49] op_sel:[0,0] op_sel_hi:[0,1] neg_lo:[0,1] neg_hi:[0,0]
v_pk_fma_f32 v[14:15], v[14:15], s[48:49], v[48:49] op_sel:[1,1,0] op_sel_hi:[1,0,1] neg_lo:[0,1,0] neg_hi:[0,1,0]
v_pk_mul_f32 v[48:49], v[64:65], s[50:51] op_sel:[0,0] op_sel_hi:[0,1] neg_lo:[0,1] neg_hi:[0,0]
v_pk_fma_f32 v[64:65], v[64:65], s[50:51], v[48:49] op_sel:[1,1,0] op_sel_hi:[1,0,1] neg_lo:[0,1,0] neg_hi:[0,1,0]
v_pk_mul_f32 v[48:49], v[40:41], s[52:53] op_sel:[0,0] op_sel_hi:[0,1] neg_lo:[0,1] neg_hi:[0,0]
v_pk_fma_f32 v[40:41], v[40:41], s[52:53], v[48:49] op_sel:[1,1,0] op_sel_hi:[1,0,1] neg_lo:[0,1,0] neg_hi:[0,1,0]
v_pk_mul_f32 v[48:49], v[72:73], s[54:55] op_sel:[0,0] op_sel_hi:[0,1] neg_lo:[0,1] neg_hi:[0,0]
v_pk_fma_f32 v[72:73], v[72:73], s[54:55], v[48:49] op_sel:[1,1,0] op_sel_hi:[1,0,1] neg_lo:[0,1,0] neg_hi:[0,1,0]
v_pk_mul_f32 v[48:49], v[44:45], s[56:57] op_sel:[0,0] op_sel_hi:[0,1] neg_lo:[0,1] neg_hi:[0,0]
v_pk_fma_f32 v[44:45], v[44:45], s[56:57], v[48:49] op_sel:[1,1,0] op_sel_hi:[1,0,1] neg_lo:[0,1,0] neg_hi:[0,1,0]
v_pk_mul_f32 v[48:49], v[28:29], s[58:59] op_sel:[0,0] op_sel_hi:[0,1] neg_lo:[0,1] neg_hi:[0,0]
v_pk_fma_f32 v[28:29], v[28:29], s[58:59], v[48:49] op_sel:[1,1,0] op_sel_hi:[1,0,1] neg_lo:[0,1,0] neg_hi:[0,1,0]
v_pk_mul_f32 v[48:49], v[60:61], s[60:61] op_sel:[0,0] op_sel_hi:[0,1] neg_lo:[0,1] neg_hi:[0,0]
v_pk_fma_f32 v[60:61], v[60:61], s[60:61], v[48:49] op_sel:[1,1,0] op_sel_hi:[1,0,1] neg_lo:[0,1,0] neg_hi:[0,1,0]
v_pk_mul_f32 v[48:49], v[76:77], s[62:63] op_sel:[0,0] op_sel_hi:[0,1] neg_lo:[0,1] neg_hi:[0,0]
v_pk_fma_f32 v[76:77], v[76:77], s[62:63], v[48:49] op_sel:[1,1,0] op_sel_hi:[1,0,1] neg_lo:[0,1,0] neg_hi:[0,1,0]
v_pk_mul_f32 v[48:49], v[46:47], s[60:61] op_sel:[0,1] op_sel_hi:[0,0] neg_lo:[0,1] neg_hi:[0,0]
v_pk_fma_f32 v[46:47], v[46:47], s[60:61], v[48:49] op_sel:[1,0,0] op_sel_hi:[1,1,1] neg_lo:[0,1,0] neg_hi:[0,1,0]
v_pk_mul_f32 v[48:49], v[30:31], s[58:59] op_sel:[0,1] op_sel_hi:[0,0] neg_lo:[0,1] neg_hi:[0,0]
v_pk_fma_f32 v[30:31], v[30:31], s[58:59], v[48:49] op_sel:[1,0,0] op_sel_hi:[1,1,1] neg_lo:[0,1,0] neg_hi:[0,1,0]
v_pk_mul_f32 v[48:49], v[62:63], s[56:57] op_sel:[0,1] op_sel_hi:[0,0] neg_lo:[0,1] neg_hi:[0,0]
v_pk_fma_f32 v[62:63], v[62:63], s[56:57], v[48:49] op_sel:[1,0,0] op_sel_hi:[1,1,1] neg_lo:[0,1,0] neg_hi:[0,1,0]
v_pk_mul_f32 v[48:49], v[22:23], s[54:55] op_sel:[0,1] op_sel_hi:[0,0] neg_lo:[0,1] neg_hi:[0,0]
v_pk_fma_f32 v[22:23], v[22:23], s[54:55], v[48:49] op_sel:[1,0,0] op_sel_hi:[1,1,1] neg_lo:[0,1,0] neg_hi:[0,1,0]
v_pk_mul_f32 v[48:49], v[54:55], s[52:53] op_sel:[0,1] op_sel_hi:[0,0] neg_lo:[0,1] neg_hi:[0,0]
v_pk_fma_f32 v[54:55], v[54:55], s[52:53], v[48:49] op_sel:[1,0,0] op_sel_hi:[1,1,1] neg_lo:[0,1,0] neg_hi:[0,1,0]
v_pk_mul_f32 v[48:49], v[38:39], s[50:51] op_sel:[0,1] op_sel_hi:[0,0] neg_lo:[0,1] neg_hi:[0,0]
v_pk_fma_f32 v[38:39], v[38:39], s[50:51], v[48:49] op_sel:[1,0,0] op_sel_hi:[1,1,1] neg_lo:[0,1,0] neg_hi:[0,1,0]
v_pk_mul_f32 v[48:49], v[70:71], s[48:49] op_sel:[0,1] op_sel_hi:[0,0] neg_lo:[0,1] neg_hi:[0,0]
v_pk_fma_f32 v[70:71], v[70:71], s[48:49], v[48:49] op_sel:[1,0,0] op_sel_hi:[1,1,1] neg_lo:[0,1,0] neg_hi:[0,1,0]
v_pk_add_f32 v[78:79], v[78:79], 0 op_sel:[1,0] op_sel_hi:[0,0] neg_lo:[1,0] neg_hi:[0,0]
v_pk_mul_f32 v[48:49], v[32:33], s[48:49] op_sel:[0,1] op_sel_hi:[0,0] neg_lo:[0,0] neg_hi:[0,0]
v_pk_fma_f32 v[32:33], v[32:33], s[48:49], v[48:49] op_sel:[1,0,0] op_sel_hi:[1,1,1] neg_lo:[0,1,0] neg_hi:[0,0,0]
v_pk_mul_f32 v[48:49], v[24:25], s[50:51] op_sel:[0,1] op_sel_hi:[0,0] neg_lo:[0,0] neg_hi:[0,0]
v_pk_fma_f32 v[24:25], v[24:25], s[50:51], v[48:49] op_sel:[1,0,0] op_sel_hi:[1,1,1] neg_lo:[0,1,0] neg_hi:[0,0,0]
v_pk_mul_f32 v[48:49], v[56:57], s[52:53] op_sel:[0,1] op_sel_hi:[0,0] neg_lo:[0,0] neg_hi:[0,0]
v_pk_fma_f32 v[56:57], v[56:57], s[52:53], v[48:49] op_sel:[1,0,0] op_sel_hi:[1,1,1] neg_lo:[0,1,0] neg_hi:[0,0,0]
v_pk_mul_f32 v[48:49], v[20:21], s[54:55] op_sel:[0,1] op_sel_hi:[0,0] neg_lo:[0,0] neg_hi:[0,0]
v_pk_fma_f32 v[20:21], v[20:21], s[54:55], v[48:49] op_sel:[1,0,0] op_sel_hi:[1,1,1] neg_lo:[0,1,0] neg_hi:[0,0,0]
v_pk_mul_f32 v[48:49], v[52:53], s[56:57] op_sel:[0,1] op_sel_hi:[0,0] neg_lo:[0,0] neg_hi:[0,0]
v_pk_fma_f32 v[52:53], v[52:53], s[56:57], v[48:49] op_sel:[1,0,0] op_sel_hi:[1,1,1] neg_lo:[0,1,0] neg_hi:[0,0,0]
v_pk_mul_f32 v[48:49], v[36:37], s[58:59] op_sel:[0,1] op_sel_hi:[0,0] neg_lo:[0,0] neg_hi:[0,0]
v_pk_fma_f32 v[36:37], v[36:37], s[58:59], v[48:49] op_sel:[1,0,0] op_sel_hi:[1,1,1] neg_lo:[0,1,0] neg_hi:[0,0,0]
v_pk_mul_f32 v[48:49], v[68:69], s[60:61] op_sel:[0,1] op_sel_hi:[0,0] neg_lo:[0,0] neg_hi:[0,0]
v_pk_fma_f32 v[68:69], v[68:69], s[60:61], v[48:49] op_sel:[1,0,0] op_sel_hi:[1,1,1] neg_lo:[0,1,0] neg_hi:[0,0,0]
v_pk_mul_f32 v[48:49], v[18:19], s[62:63] op_sel:[0,0] op_sel_hi:[0,1] neg_lo:[0,0] neg_hi:[0,0]
v_pk_fma_f32 v[18:19], v[18:19], s[62:63], v[48:49] op_sel:[1,1,0] op_sel_hi:[1,0,1] neg_lo:[0,1,0] neg_hi:[0,0,0]
v_pk_mul_f32 v[48:49], v[50:51], s[60:61] op_sel:[0,0] op_sel_hi:[0,1] neg_lo:[0,0] neg_hi:[0,0]
v_pk_fma_f32 v[50:51], v[50:51], s[60:61], v[48:49] op_sel:[1,1,0] op_sel_hi:[1,0,1] neg_lo:[0,1,0] neg_hi:[0,0,0]
v_pk_mul_f32 v[48:49], v[34:35], s[58:59] op_sel:[0,0] op_sel_hi:[0,1] neg_lo:[0,0] neg_hi:[0,0]
v_pk_fma_f32 v[34:35], v[34:35], s[58:59], v[48:49] op_sel:[1,1,0] op_sel_hi:[1,0,1] neg_lo:[0,1,0] neg_hi:[0,0,0]
v_pk_mul_f32 v[48:49], v[66:67], s[56:57] op_sel:[0,0] op_sel_hi:[0,1] neg_lo:[0,0] neg_hi:[0,0]
v_pk_fma_f32 v[66:67], v[66:67], s[56:57], v[48:49] op_sel:[1,1,0] op_sel_hi:[1,0,1] neg_lo:[0,1,0] neg_hi:[0,0,0]
v_pk_mul_f32 v[48:49], v[26:27], s[54:55] op_sel:[0,0] op_sel_hi:[0,1] neg_lo:[0,0] neg_hi:[0,0]
v_pk_fma_f32 v[26:27], v[26:27], s[54:55], v[48:49] op_sel:[1,1,0] op_sel_hi:[1,0,1] neg_lo:[0,1,0] neg_hi:[0,0,0]
v_pk_mul_f32 v[48:49], v[58:59], s[52:53] op_sel:[0,0] op_sel_hi:[0,1] neg_lo:[0,0] neg_hi:[0,0]
v_pk_fma_f32 v[58:59], v[58:59], s[52:53], v[48:49] op_sel:[1,1,0] op_sel_hi:[1,0,1] neg_lo:[0,1,0] neg_hi:[0,0,0]
v_pk_mul_f32 v[48:49], v[42:43], s[50:51] op_sel:[0,0] op_sel_hi:[0,1] neg_lo:[0,0] neg_hi:[0,0]
v_pk_fma_f32 v[42:43], v[42:43], s[50:51], v[48:49] op_sel:[1,1,0] op_sel_hi:[1,0,1] neg_lo:[0,1,0] neg_hi:[0,0,0]
v_pk_mul_f32 v[48:49], v[74:75], s[48:49] op_sel:[0,0] op_sel_hi:[0,1] neg_lo:[0,0] neg_hi:[0,0]
v_pk_fma_f32 v[74:75], v[74:75], s[48:49], v[48:49] op_sel:[1,1,0] op_sel_hi:[1,0,1] neg_lo:[0,1,0] neg_hi:[0,0,0]
s_mov_b64 exec, -1
v_fmac_f32_dpp v16, v16, v9 quad_perm:[1,0,3,2] row_mask:0xf bank_mask:0xf
v_fmac_f32_dpp v17, v17, v9 quad_perm:[1,0,3,2] row_mask:0xf bank_mask:0xf
v_fmac_f32_dpp v14, v14, v9 quad_perm:[1,0,3,2] row_mask:0xf bank_mask:0xf
v_fmac_f32_dpp v15, v15, v9 quad_perm:[1,0,3,2] row_mask:0xf bank_mask:0xf
v_fmac_f32_dpp v64, v64, v9 quad_perm:[1,0,3,2] row_mask:0xf bank_mask:0xf
v_fmac_f32_dpp v65, v65, v9 quad_perm:[1,0,3,2] row_mask:0xf bank_mask:0xf
v_fmac_f32_dpp v40, v40, v9 quad_perm:[1,0,3,2] row_mask:0xf bank_mask:0xf
v_fmac_f32_dpp v41, v41, v9 quad_perm:[1,0,3,2] row_mask:0xf bank_mask:0xf
v_fmac_f32_dpp v72, v72, v9 quad_perm:[1,0,3,2] row_mask:0xf bank_mask:0xf
v_fmac_f32_dpp v73, v73, v9 quad_perm:[1,0,3,2] row_mask:0xf bank_mask:0xf
v_fmac_f32_dpp v44, v44, v9 quad_perm:[1,0,3,2] row_mask:0xf bank_mask:0xf
v_fmac_f32_dpp v45, v45, v9 quad_perm:[1,0,3,2] row_mask:0xf bank_mask:0xf
v_fmac_f32_dpp v28, v28, v9 quad_perm:[1,0,3,2] row_mask:0xf bank_mask:0xf
v_fmac_f32_dpp v29, v29, v9 quad_perm:[1,0,3,2] row_mask:0xf bank_mask:0xf
v_fmac_f32_dpp v60, v60, v9 quad_perm:[1,0,3,2] row_mask:0xf bank_mask:0xf
v_fmac_f32_dpp v61, v61, v9 quad_perm:[1,0,3,2] row_mask:0xf bank_mask:0xf
v_fmac_f32_dpp v76, v76, v9 quad_perm:[1,0,3,2] row_mask:0xf bank_mask:0xf
v_fmac_f32_dpp v77, v77, v9 quad_perm:[1,0,3,2] row_mask:0xf bank_mask:0xf
v_fmac_f32_dpp v46, v46, v9 quad_perm:[1,0,3,2] row_mask:0xf bank_mask:0xf
v_fmac_f32_dpp v47, v47, v9 quad_perm:[1,0,3,2] row_mask:0xf bank_mask:0xf
v_fmac_f32_dpp v30, v30, v9 quad_perm:[1,0,3,2] row_mask:0xf bank_mask:0xf
v_fmac_f32_dpp v31, v31, v9 quad_perm:[1,0,3,2] row_mask:0xf bank_mask:0xf
v_fmac_f32_dpp v62, v62, v9 quad_perm:[1,0,3,2] row_mask:0xf bank_mask:0xf
v_fmac_f32_dpp v63, v63, v9 quad_perm:[1,0,3,2] row_mask:0xf bank_mask:0xf
v_fmac_f32_dpp v22, v22, v9 quad_perm:[1,0,3,2] row_mask:0xf bank_mask:0xf
v_fmac_f32_dpp v23, v23, v9 quad_perm:[1,0,3,2] row_mask:0xf bank_mask:0xf
v_fmac_f32_dpp v54, v54, v9 quad_perm:[1,0,3,2] row_mask:0xf bank_mask:0xf
v_fmac_f32_dpp v55, v55, v9 quad_perm:[1,0,3,2] row_mask:0xf bank_mask:0xf
v_fmac_f32_dpp v38, v38, v9 quad_perm:[1,0,3,2] row_mask:0xf bank_mask:0xf
v_fmac_f32_dpp v39, v39, v9 quad_perm:[1,0,3,2] row_mask:0xf bank_mask:0xf
v_fmac_f32_dpp v70, v70, v9 quad_perm:[1,0,3,2] row_mask:0xf bank_mask:0xf
v_fmac_f32_dpp v71, v71, v9 quad_perm:[1,0,3,2] row_mask:0xf bank_mask:0xf
v_fmac_f32_dpp v78, v78, v9 quad_perm:[1,0,3,2] row_mask:0xf bank_mask:0xf
v_fmac_f32_dpp v79, v79, v9 quad_perm:[1,0,3,2] row_mask:0xf bank_mask:0xf
v_fmac_f32_dpp v32, v32, v9 quad_perm:[1,0,3,2] row_mask:0xf bank_mask:0xf
v_fmac_f32_dpp v33, v33, v9 quad_perm:[1,0,3,2] row_mask:0xf bank_mask:0xf
v_fmac_f32_dpp v24, v24, v9 quad_perm:[1,0,3,2] row_mask:0xf bank_mask:0xf
v_fmac_f32_dpp v25, v25, v9 quad_perm:[1,0,3,2] row_mask:0xf bank_mask:0xf
v_fmac_f32_dpp v56, v56, v9 quad_perm:[1,0,3,2] row_mask:0xf bank_mask:0xf
v_fmac_f32_dpp v57, v57, v9 quad_perm:[1,0,3,2] row_mask:0xf bank_mask:0xf
v_fmac_f32_dpp v20, v20, v9 quad_perm:[1,0,3,2] row_mask:0xf bank_mask:0xf
v_fmac_f32_dpp v21, v21, v9 quad_perm:[1,0,3,2] row_mask:0xf bank_mask:0xf
v_fmac_f32_dpp v52, v52, v9 quad_perm:[1,0,3,2] row_mask:0xf bank_mask:0xf
v_fmac_f32_dpp v53, v53, v9 quad_perm:[1,0,3,2] row_mask:0xf bank_mask:0xf
v_fmac_f32_dpp v36, v36, v9 quad_perm:[1,0,3,2] row_mask:0xf bank_mask:0xf
v_fmac_f32_dpp v37, v37, v9 quad_perm:[1,0,3,2] row_mask:0xf bank_mask:0xf
v_fmac_f32_dpp v68, v68, v9 quad_perm:[1,0,3,2] row_mask:0xf bank_mask:0xf
v_fmac_f32_dpp v69, v69, v9 quad_perm:[1,0,3,2] row_mask:0xf bank_mask:0xf
v_fmac_f32_dpp v18, v18, v9 quad_perm:[1,0,3,2] row_mask:0xf bank_mask:0xf
v_fmac_f32_dpp v19, v19, v9 quad_perm:[1,0,3,2] row_mask:0xf bank_mask:0xf
v_fmac_f32_dpp v50, v50, v9 quad_perm:[1,0,3,2] row_mask:0xf bank_mask:0xf
v_fmac_f32_dpp v51, v51, v9 quad_perm:[1,0,3,2] row_mask:0xf bank_mask:0xf
v_fmac_f32_dpp v34, v34, v9 quad_perm:[1,0,3,2] row_mask:0xf bank_mask:0xf
v_fmac_f32_dpp v35, v35, v9 quad_perm:[1,0,3,2] row_mask:0xf bank_mask:0xf
v_fmac_f32_dpp v66, v66, v9 quad_perm:[1,0,3,2] row_mask:0xf bank_mask:0xf
v_fmac_f32_dpp v67, v67, v9 quad_perm:[1,0,3,2] row_mask:0xf bank_mask:0xf
v_fmac_f32_dpp v26, v26, v9 quad_perm:[1,0,3,2] row_mask:0xf bank_mask:0xf
v_fmac_f32_dpp v27, v27, v9 quad_perm:[1,0,3,2] row_mask:0xf bank_mask:0xf
v_fmac_f32_dpp v58, v58, v9 quad_perm:[1,0,3,2] row_mask:0xf bank_mask:0xf
v_fmac_f32_dpp v59, v59, v9 quad_perm:[1,0,3,2] row_mask:0xf bank_mask:0xf
v_fmac_f32_dpp v42, v42, v9 quad_perm:[1,0,3,2] row_mask:0xf bank_mask:0xf
v_fmac_f32_dpp v43, v43, v9 quad_perm:[1,0,3,2] row_mask:0xf bank_mask:0xf
v_fmac_f32_dpp v74, v74, v9 quad_perm:[1,0,3,2] row_mask:0xf bank_mask:0xf
v_fmac_f32_dpp v75, v75, v9 quad_perm:[1,0,3,2] row_mask:0xf bank_mask:0xf
v_lshlrev_b32 v240, 16, v208
v_and_b32 v241, 0xffff0000, v208
v_pk_mul_f32 v[48:49], v[16:17], v[240:241] op_sel:[0,0] op_sel_hi:[0,1] neg_lo:[0,0] neg_hi:[0,0]
v_pk_fma_f32 v[16:17], v[16:17], v[240:241], v[48:49] op_sel:[1,1,0] op_sel_hi:[1,0,1] neg_lo:[0,1,0] neg_hi:[0,0,0]
v_lshlrev_b32 v240, 16, v209
v_and_b32 v241, 0xffff0000, v209
v_pk_mul_f32 v[48:49], v[14:15], v[240:241] op_sel:[0,0] op_sel_hi:[0,1] neg_lo:[0,0] neg_hi:[0,0]
v_pk_fma_f32 v[14:15], v[14:15], v[240:241], v[48:49] op_sel:[1,1,0] op_sel_hi:[1,0,1] neg_lo:[0,1,0] neg_hi:[0,0,0]
v_lshlrev_b32 v240, 16, v210
v_and_b32 v241, 0xffff0000, v210
v_pk_mul_f32 v[48:49], v[64:65], v[240:241] op_sel:[0,0] op_sel_hi:[0,1] neg_lo:[0,0] neg_hi:[0,0]
v_pk_fma_f32 v[64:65], v[64:65], v[240:241], v[48:49] op_sel:[1,1,0] op_sel_hi:[1,0,1] neg_lo:[0,1,0] neg_hi:[0,0,0]
v_lshlrev_b32 v240, 16, v211
v_and_b32 v241, 0xffff0000, v211
v_pk_mul_f32 v[48:49], v[40:41], v[240:241] op_sel:[0,0] op_sel_hi:[0,1] neg_lo:[0,0] neg_hi:[0,0]
v_pk_fma_f32 v[40:41], v[40:41], v[240:241], v[48:49] op_sel:[1,1,0] op_sel_hi:[1,0,1] neg_lo:[0,1,0] neg_hi:[0,0,0]
v_lshlrev_b32 v240, 16, v212
v_and_b32 v241, 0xffff0000, v212
v_pk_mul_f32 v[48:49], v[72:73], v[240:241] op_sel:[0,0] op_sel_hi:[0,1] neg_lo:[0,0] neg_hi:[0,0]
v_pk_fma_f32 v[72:73], v[72:73], v[240:241], v[48:49] op_sel:[1,1,0] op_sel_hi:[1,0,1] neg_lo:[0,1,0] neg_hi:[0,0,0]
v_lshlrev_b32 v240, 16, v213
v_and_b32 v241, 0xffff0000, v213
v_pk_mul_f32 v[48:49], v[44:45], v[240:241] op_sel:[0,0] op_sel_hi:[0,1] neg_lo:[0,0] neg_hi:[0,0]
v_pk_fma_f32 v[44:45], v[44:45], v[240:241], v[48:49] op_sel:[1,1,0] op_sel_hi:[1,0,1] neg_lo:[0,1,0] neg_hi:[0,0,0]
v_lshlrev_b32 v240, 16, v214
v_and_b32 v241, 0xffff0000, v214
v_pk_mul_f32 v[48:49], v[28:29], v[240:241] op_sel:[0,0] op_sel_hi:[0,1] neg_lo:[0,0] neg_hi:[0,0]
v_pk_fma_f32 v[28:29], v[28:29], v[240:241], v[48:49] op_sel:[1,1,0] op_sel_hi:[1,0,1] neg_lo:[0,1,0] neg_hi:[0,0,0]
v_lshlrev_b32 v240, 16, v215
v_and_b32 v241, 0xffff0000, v215
v_pk_mul_f32 v[48:49], v[60:61], v[240:241] op_sel:[0,0] op_sel_hi:[0,1] neg_lo:[0,0] neg_hi:[0,0]
v_pk_fma_f32 v[60:61], v[60:61], v[240:241], v[48:49] op_sel:[1,1,0] op_sel_hi:[1,0,1] neg_lo:[0,1,0] neg_hi:[0,0,0]
v_lshlrev_b32 v240, 16, v216
v_and_b32 v241, 0xffff0000, v216
v_pk_mul_f32 v[48:49], v[76:77], v[240:241] op_sel:[0,0] op_sel_hi:[0,1] neg_lo:[0,0] neg_hi:[0,0]
v_pk_fma_f32 v[76:77], v[76:77], v[240:241], v[48:49] op_sel:[1,1,0] op_sel_hi:[1,0,1] neg_lo:[0,1,0] neg_hi:[0,0,0]
v_lshlrev_b32 v240, 16, v217
v_and_b32 v241, 0xffff0000, v217
v_pk_mul_f32 v[48:49], v[46:47], v[240:241] op_sel:[0,0] op_sel_hi:[0,1] neg_lo:[0,0] neg_hi:[0,0]
v_pk_fma_f32 v[46:47], v[46:47], v[240:241], v[48:49] op_sel:[1,1,0] op_sel_hi:[1,0,1] neg_lo:[0,1,0] neg_hi:[0,0,0]
v_lshlrev_b32 v240, 16, v218
v_and_b32 v241, 0xffff0000, v218
v_pk_mul_f32 v[48:49], v[30:31], v[240:241] op_sel:[0,0] op_sel_hi:[0,1] neg_lo:[0,0] neg_hi:[0,0]
v_pk_fma_f32 v[30:31], v[30:31], v[240:241], v[48:49] op_sel:[1,1,0] op_sel_hi:[1,0,1] neg_lo:[0,1,0] neg_hi:[0,0,0]
v_lshlrev_b32 v240, 16, v219
v_and_b32 v241, 0xffff0000, v219
v_pk_mul_f32 v[48:49], v[62:63], v[240:241] op_sel:[0,0] op_sel_hi:[0,1] neg_lo:[0,0] neg_hi:[0,0]
v_pk_fma_f32 v[62:63], v[62:63], v[240:241], v[48:49] op_sel:[1,1,0] op_sel_hi:[1,0,1] neg_lo:[0,1,0] neg_hi:[0,0,0]
v_lshlrev_b32 v240, 16, v220
v_and_b32 v241, 0xffff0000, v220
v_pk_mul_f32 v[48:49], v[22:23], v[240:241] op_sel:[0,0] op_sel_hi:[0,1] neg_lo:[0,0] neg_hi:[0,0]
v_pk_fma_f32 v[22:23], v[22:23], v[240:241], v[48:49] op_sel:[1,1,0] op_sel_hi:[1,0,1] neg_lo:[0,1,0] neg_hi:[0,0,0]
v_lshlrev_b32 v240, 16, v221
v_and_b32 v241, 0xffff0000, v221
v_pk_mul_f32 v[48:49], v[54:55], v[240:241] op_sel:[0,0] op_sel_hi:[0,1] neg_lo:[0,0] neg_hi:[0,0]
v_pk_fma_f32 v[54:55], v[54:55], v[240:241], v[48:49] op_sel:[1,1,0] op_sel_hi:[1,0,1] neg_lo:[0,1,0] neg_hi:[0,0,0]
v_lshlrev_b32 v240, 16, v222
v_and_b32 v241, 0xffff0000, v222
v_pk_mul_f32 v[48:49], v[38:39], v[240:241] op_sel:[0,0] op_sel_hi:[0,1] neg_lo:[0,0] neg_hi:[0,0]
v_pk_fma_f32 v[38:39], v[38:39], v[240:241], v[48:49] op_sel:[1,1,0] op_sel_hi:[1,0,1] neg_lo:[0,1,0] neg_hi:[0,0,0]
v_lshlrev_b32 v240, 16, v223
v_and_b32 v241, 0xffff0000, v223
v_pk_mul_f32 v[48:49], v[70:71], v[240:241] op_sel:[0,0] op_sel_hi:[0,1] neg_lo:[0,0] neg_hi:[0,0]
v_pk_fma_f32 v[70:71], v[70:71], v[240:241], v[48:49] op_sel:[1,1,0] op_sel_hi:[1,0,1] neg_lo:[0,1,0] neg_hi:[0,0,0]
v_lshlrev_b32 v240, 16, v224
v_and_b32 v241, 0xffff0000, v224
v_pk_mul_f32 v[48:49], v[78:79], v[240:241] op_sel:[0,0] op_sel_hi:[0,1] neg_lo:[0,0] neg_hi:[0,0]
v_pk_fma_f32 v[78:79], v[78:79], v[240:241], v[48:49] op_sel:[1,1,0] op_sel_hi:[1,0,1] neg_lo:[0,1,0] neg_hi:[0,0,0]
v_lshlrev_b32 v240, 16, v225
v_and_b32 v241, 0xffff0000, v225
v_pk_mul_f32 v[48:49], v[32:33], v[240:241] op_sel:[0,0] op_sel_hi:[0,1] neg_lo:[0,0] neg_hi:[0,0]
v_pk_fma_f32 v[32:33], v[32:33], v[240:241], v[48:49] op_sel:[1,1,0] op_sel_hi:[1,0,1] neg_lo:[0,1,0] neg_hi:[0,0,0]
v_lshlrev_b32 v240, 16, v226
v_and_b32 v241, 0xffff0000, v226
v_pk_mul_f32 v[48:49], v[24:25], v[240:241] op_sel:[0,0] op_sel_hi:[0,1] neg_lo:[0,0] neg_hi:[0,0]
v_pk_fma_f32 v[24:25], v[24:25], v[240:241], v[48:49] op_sel:[1,1,0] op_sel_hi:[1,0,1] neg_lo:[0,1,0] neg_hi:[0,0,0]
v_lshlrev_b32 v240, 16, v227
v_and_b32 v241, 0xffff0000, v227
v_pk_mul_f32 v[48:49], v[56:57], v[240:241] op_sel:[0,0] op_sel_hi:[0,1] neg_lo:[0,0] neg_hi:[0,0]
v_pk_fma_f32 v[56:57], v[56:57], v[240:241], v[48:49] op_sel:[1,1,0] op_sel_hi:[1,0,1] neg_lo:[0,1,0] neg_hi:[0,0,0]
v_lshlrev_b32 v240, 16, v228
v_and_b32 v241, 0xffff0000, v228
v_pk_mul_f32 v[48:49], v[20:21], v[240:241] op_sel:[0,0] op_sel_hi:[0,1] neg_lo:[0,0] neg_hi:[0,0]
v_pk_fma_f32 v[20:21], v[20:21], v[240:241], v[48:49] op_sel:[1,1,0] op_sel_hi:[1,0,1] neg_lo:[0,1,0] neg_hi:[0,0,0]
v_lshlrev_b32 v240, 16, v229
v_and_b32 v241, 0xffff0000, v229
v_pk_mul_f32 v[48:49], v[52:53], v[240:241] op_sel:[0,0] op_sel_hi:[0,1] neg_lo:[0,0] neg_hi:[0,0]
v_pk_fma_f32 v[52:53], v[52:53], v[240:241], v[48:49] op_sel:[1,1,0] op_sel_hi:[1,0,1] neg_lo:[0,1,0] neg_hi:[0,0,0]
v_lshlrev_b32 v240, 16, v230
v_and_b32 v241, 0xffff0000, v230
v_pk_mul_f32 v[48:49], v[36:37], v[240:241] op_sel:[0,0] op_sel_hi:[0,1] neg_lo:[0,0] neg_hi:[0,0]
v_pk_fma_f32 v[36:37], v[36:37], v[240:241], v[48:49] op_sel:[1,1,0] op_sel_hi:[1,0,1] neg_lo:[0,1,0] neg_hi:[0,0,0]
v_lshlrev_b32 v240, 16, v231
v_and_b32 v241, 0xffff0000, v231
v_pk_mul_f32 v[48:49], v[68:69], v[240:241] op_sel:[0,0] op_sel_hi:[0,1] neg_lo:[0,0] neg_hi:[0,0]
v_pk_fma_f32 v[68:69], v[68:69], v[240:241], v[48:49] op_sel:[1,1,0] op_sel_hi:[1,0,1] neg_lo:[0,1,0] neg_hi:[0,0,0]
v_lshlrev_b32 v240, 16, v232
v_and_b32 v241, 0xffff0000, v232
v_pk_mul_f32 v[48:49], v[18:19], v[240:241] op_sel:[0,0] op_sel_hi:[0,1] neg_lo:[0,0] neg_hi:[0,0]
v_pk_fma_f32 v[18:19], v[18:19], v[240:241], v[48:49] op_sel:[1,1,0] op_sel_hi:[1,0,1] neg_lo:[0,1,0] neg_hi:[0,0,0]
v_lshlrev_b32 v240, 16, v233
v_and_b32 v241, 0xffff0000, v233
v_pk_mul_f32 v[48:49], v[50:51], v[240:241] op_sel:[0,0] op_sel_hi:[0,1] neg_lo:[0,0] neg_hi:[0,0]
v_pk_fma_f32 v[50:51], v[50:51], v[240:241], v[48:49] op_sel:[1,1,0] op_sel_hi:[1,0,1] neg_lo:[0,1,0] neg_hi:[0,0,0]
v_lshlrev_b32 v240, 16, v234
v_and_b32 v241, 0xffff0000, v234
v_pk_mul_f32 v[48:49], v[34:35], v[240:241] op_sel:[0,0] op_sel_hi:[0,1] neg_lo:[0,0] neg_hi:[0,0]
v_pk_fma_f32 v[34:35], v[34:35], v[240:241], v[48:49] op_sel:[1,1,0] op_sel_hi:[1,0,1] neg_lo:[0,1,0] neg_hi:[0,0,0]
v_lshlrev_b32 v240, 16, v235
v_and_b32 v241, 0xffff0000, v235
v_pk_mul_f32 v[48:49], v[66:67], v[240:241] op_sel:[0,0] op_sel_hi:[0,1] neg_lo:[0,0] neg_hi:[0,0]
v_pk_fma_f32 v[66:67], v[66:67], v[240:241], v[48:49] op_sel:[1,1,0] op_sel_hi:[1,0,1] neg_lo:[0,1,0] neg_hi:[0,0,0]
v_lshlrev_b32 v240, 16, v236
v_and_b32 v241, 0xffff0000, v236
v_pk_mul_f32 v[48:49], v[26:27], v[240:241] op_sel:[0,0] op_sel_hi:[0,1] neg_lo:[0,0] neg_hi:[0,0]
v_pk_fma_f32 v[26:27], v[26:27], v[240:241], v[48:49] op_sel:[1,1,0] op_sel_hi:[1,0,1] neg_lo:[0,1,0] neg_hi:[0,0,0]
v_lshlrev_b32 v240, 16, v237
v_and_b32 v241, 0xffff0000, v237
v_pk_mul_f32 v[48:49], v[58:59], v[240:241] op_sel:[0,0] op_sel_hi:[0,1] neg_lo:[0,0] neg_hi:[0,0]
v_pk_fma_f32 v[58:59], v[58:59], v[240:241], v[48:49] op_sel:[1,1,0] op_sel_hi:[1,0,1] neg_lo:[0,1,0] neg_hi:[0,0,0]
v_lshlrev_b32 v240, 16, v238
v_and_b32 v241, 0xffff0000, v238
v_pk_mul_f32 v[48:49], v[42:43], v[240:241] op_sel:[0,0] op_sel_hi:[0,1] neg_lo:[0,0] neg_hi:[0,0]
v_pk_fma_f32 v[42:43], v[42:43], v[240:241], v[48:49] op_sel:[1,1,0] op_sel_hi:[1,0,1] neg_lo:[0,1,0] neg_hi:[0,0,0]
v_lshlrev_b32 v240, 16, v239
v_and_b32 v241, 0xffff0000, v239
v_pk_mul_f32 v[48:49], v[74:75], v[240:241] op_sel:[0,0] op_sel_hi:[0,1] neg_lo:[0,0] neg_hi:[0,0]
v_pk_fma_f32 v[74:75], v[74:75], v[240:241], v[48:49] op_sel:[1,1,0] op_sel_hi:[1,0,1] neg_lo:[0,1,0] neg_hi:[0,0,0]
v_fmac_f32_dpp v16, v16, v7 quad_perm:[1,0,3,2] row_mask:0xf bank_mask:0xf
v_fmac_f32_dpp v17, v17, v7 quad_perm:[1,0,3,2] row_mask:0xf bank_mask:0xf
v_fmac_f32_dpp v14, v14, v7 quad_perm:[1,0,3,2] row_mask:0xf bank_mask:0xf
v_fmac_f32_dpp v15, v15, v7 quad_perm:[1,0,3,2] row_mask:0xf bank_mask:0xf
v_fmac_f32_dpp v64, v64, v7 quad_perm:[1,0,3,2] row_mask:0xf bank_mask:0xf
v_fmac_f32_dpp v65, v65, v7 quad_perm:[1,0,3,2] row_mask:0xf bank_mask:0xf
v_fmac_f32_dpp v40, v40, v7 quad_perm:[1,0,3,2] row_mask:0xf bank_mask:0xf
v_fmac_f32_dpp v41, v41, v7 quad_perm:[1,0,3,2] row_mask:0xf bank_mask:0xf
v_fmac_f32_dpp v72, v72, v7 quad_perm:[1,0,3,2] row_mask:0xf bank_mask:0xf
v_fmac_f32_dpp v73, v73, v7 quad_perm:[1,0,3,2] row_mask:0xf bank_mask:0xf
v_fmac_f32_dpp v44, v44, v7 quad_perm:[1,0,3,2] row_mask:0xf bank_mask:0xf
v_fmac_f32_dpp v45, v45, v7 quad_perm:[1,0,3,2] row_mask:0xf bank_mask:0xf
v_fmac_f32_dpp v28, v28, v7 quad_perm:[1,0,3,2] row_mask:0xf bank_mask:0xf
v_fmac_f32_dpp v29, v29, v7 quad_perm:[1,0,3,2] row_mask:0xf bank_mask:0xf
v_fmac_f32_dpp v60, v60, v7 quad_perm:[1,0,3,2] row_mask:0xf bank_mask:0xf
v_fmac_f32_dpp v61, v61, v7 quad_perm:[1,0,3,2] row_mask:0xf bank_mask:0xf
v_fmac_f32_dpp v76, v76, v7 quad_perm:[1,0,3,2] row_mask:0xf bank_mask:0xf
v_fmac_f32_dpp v77, v77, v7 quad_perm:[1,0,3,2] row_mask:0xf bank_mask:0xf
v_fmac_f32_dpp v46, v46, v7 quad_perm:[1,0,3,2] row_mask:0xf bank_mask:0xf
v_fmac_f32_dpp v47, v47, v7 quad_perm:[1,0,3,2] row_mask:0xf bank_mask:0xf
v_fmac_f32_dpp v30, v30, v7 quad_perm:[1,0,3,2] row_mask:0xf bank_mask:0xf
v_fmac_f32_dpp v31, v31, v7 quad_perm:[1,0,3,2] row_mask:0xf bank_mask:0xf
v_fmac_f32_dpp v62, v62, v7 quad_perm:[1,0,3,2] row_mask:0xf bank_mask:0xf
v_fmac_f32_dpp v63, v63, v7 quad_perm:[1,0,3,2] row_mask:0xf bank_mask:0xf
v_fmac_f32_dpp v22, v22, v7 quad_perm:[1,0,3,2] row_mask:0xf bank_mask:0xf
v_fmac_f32_dpp v23, v23, v7 quad_perm:[1,0,3,2] row_mask:0xf bank_mask:0xf
v_fmac_f32_dpp v54, v54, v7 quad_perm:[1,0,3,2] row_mask:0xf bank_mask:0xf
v_fmac_f32_dpp v55, v55, v7 quad_perm:[1,0,3,2] row_mask:0xf bank_mask:0xf
v_fmac_f32_dpp v38, v38, v7 quad_perm:[1,0,3,2] row_mask:0xf bank_mask:0xf
v_fmac_f32_dpp v39, v39, v7 quad_perm:[1,0,3,2] row_mask:0xf bank_mask:0xf
v_fmac_f32_dpp v70, v70, v7 quad_perm:[1,0,3,2] row_mask:0xf bank_mask:0xf
v_fmac_f32_dpp v71, v71, v7 quad_perm:[1,0,3,2] row_mask:0xf bank_mask:0xf
v_fmac_f32_dpp v78, v78, v7 quad_perm:[1,0,3,2] row_mask:0xf bank_mask:0xf
v_fmac_f32_dpp v79, v79, v7 quad_perm:[1,0,3,2] row_mask:0xf bank_mask:0xf
v_fmac_f32_dpp v32, v32, v7 quad_perm:[1,0,3,2] row_mask:0xf bank_mask:0xf
v_fmac_f32_dpp v33, v33, v7 quad_perm:[1,0,3,2] row_mask:0xf bank_mask:0xf
v_fmac_f32_dpp v24, v24, v7 quad_perm:[1,0,3,2] row_mask:0xf bank_mask:0xf
v_fmac_f32_dpp v25, v25, v7 quad_perm:[1,0,3,2] row_mask:0xf bank_mask:0xf
v_fmac_f32_dpp v56, v56, v7 quad_perm:[1,0,3,2] row_mask:0xf bank_mask:0xf
v_fmac_f32_dpp v57, v57, v7 quad_perm:[1,0,3,2] row_mask:0xf bank_mask:0xf
v_fmac_f32_dpp v20, v20, v7 quad_perm:[1,0,3,2] row_mask:0xf bank_mask:0xf
v_fmac_f32_dpp v21, v21, v7 quad_perm:[1,0,3,2] row_mask:0xf bank_mask:0xf
v_fmac_f32_dpp v52, v52, v7 quad_perm:[1,0,3,2] row_mask:0xf bank_mask:0xf
v_fmac_f32_dpp v53, v53, v7 quad_perm:[1,0,3,2] row_mask:0xf bank_mask:0xf
v_fmac_f32_dpp v36, v36, v7 quad_perm:[1,0,3,2] row_mask:0xf bank_mask:0xf
v_fmac_f32_dpp v37, v37, v7 quad_perm:[1,0,3,2] row_mask:0xf bank_mask:0xf
v_fmac_f32_dpp v68, v68, v7 quad_perm:[1,0,3,2] row_mask:0xf bank_mask:0xf
v_fmac_f32_dpp v69, v69, v7 quad_perm:[1,0,3,2] row_mask:0xf bank_mask:0xf
v_fmac_f32_dpp v18, v18, v7 quad_perm:[1,0,3,2] row_mask:0xf bank_mask:0xf
v_fmac_f32_dpp v19, v19, v7 quad_perm:[1,0,3,2] row_mask:0xf bank_mask:0xf
v_fmac_f32_dpp v50, v50, v7 quad_perm:[1,0,3,2] row_mask:0xf bank_mask:0xf
v_fmac_f32_dpp v51, v51, v7 quad_perm:[1,0,3,2] row_mask:0xf bank_mask:0xf
v_fmac_f32_dpp v34, v34, v7 quad_perm:[1,0,3,2] row_mask:0xf bank_mask:0xf
v_fmac_f32_dpp v35, v35, v7 quad_perm:[1,0,3,2] row_mask:0xf bank_mask:0xf
v_fmac_f32_dpp v66, v66, v7 quad_perm:[1,0,3,2] row_mask:0xf bank_mask:0xf
v_fmac_f32_dpp v67, v67, v7 quad_perm:[1,0,3,2] row_mask:0xf bank_mask:0xf
v_fmac_f32_dpp v26, v26, v7 quad_perm:[1,0,3,2] row_mask:0xf bank_mask:0xf
v_fmac_f32_dpp v27, v27, v7 quad_perm:[1,0,3,2] row_mask:0xf bank_mask:0xf
v_fmac_f32_dpp v58, v58, v7 quad_perm:[1,0,3,2] row_mask:0xf bank_mask:0xf
v_fmac_f32_dpp v59, v59, v7 quad_perm:[1,0,3,2] row_mask:0xf bank_mask:0xf
v_fmac_f32_dpp v42, v42, v7 quad_perm:[1,0,3,2] row_mask:0xf bank_mask:0xf
v_fmac_f32_dpp v43, v43, v7 quad_perm:[1,0,3,2] row_mask:0xf bank_mask:0xf
v_fmac_f32_dpp v74, v74, v7 quad_perm:[1,0,3,2] row_mask:0xf bank_mask:0xf
v_fmac_f32_dpp v75, v75, v7 quad_perm:[1,0,3,2] row_mask:0xf bank_mask:0xf
s_mov_b64 exec, s[18:19]
v_pk_add_f32 v[16:17], v[16:17], 0 neg_lo:[1,0] neg_hi:[1,0]
v_pk_mul_f32 v[48:49], v[14:15], s[48:49] op_sel:[0,0] op_sel_hi:[0,1] neg_lo:[0,1] neg_hi:[0,1]
v_pk_fma_f32 v[14:15], v[14:15], s[48:49], v[48:49] op_sel:[1,1,0] op_sel_hi:[1,0,1] neg_lo:[0,0,0] neg_hi:[0,1,0]
v_pk_mul_f32 v[48:49], v[64:65], s[50:51] op_sel:[0,0] op_sel_hi:[0,1] neg_lo:[0,1] neg_hi:[0,1]
v_pk_fma_f32 v[64:65], v[64:65], s[50:51], v[48:49] op_sel:[1,1,0] op_sel_hi:[1,0,1] neg_lo:[0,0,0] neg_hi:[0,1,0]
v_pk_mul_f32 v[48:49], v[40:41], s[52:53] op_sel:[0,0] op_sel_hi:[0,1] neg_lo:[0,1] neg_hi:[0,1]
v_pk_fma_f32 v[40:41], v[40:41], s[52:53], v[48:49] op_sel:[1,1,0] op_sel_hi:[1,0,1] neg_lo:[0,0,0] neg_hi:[0,1,0]
v_pk_mul_f32 v[48:49], v[72:73], s[54:55] op_sel:[0,0] op_sel_hi:[0,1] neg_lo:[0,1] neg_hi:[0,1]
v_pk_fma_f32 v[72:73], v[72:73], s[54:55], v[48:49] op_sel:[1,1,0] op_sel_hi:[1,0,1] neg_lo:[0,0,0] neg_hi:[0,1,0]
v_pk_mul_f32 v[48:49], v[44:45], s[56:57] op_sel:[0,0] op_sel_hi:[0,1] neg_lo:[0,1] neg_hi:[0,1]
v_pk_fma_f32 v[44:45], v[44:45], s[56:57], v[48:49] op_sel:[1,1,0] op_sel_hi:[1,0,1] neg_lo:[0,0,0] neg_hi:[0,1,0]
v_pk_mul_f32 v[48:49], v[28:29], s[58:59] op_sel:[0,0] op_sel_hi:[0,1] neg_lo:[0,1] neg_hi:[0,1]
v_pk_fma_f32 v[28:29], v[28:29], s[58:59], v[48:49] op_sel:[1,1,0] op_sel_hi:[1,0,1] neg_lo:[0,0,0] neg_hi:[0,1,0]
v_pk_mul_f32 v[48:49], v[60:61], s[60:61] op_sel:[0,0] op_sel_hi:[0,1] neg_lo:[0,1] neg_hi:[0,1]
v_pk_fma_f32 v[60:61], v[60:61], s[60:61], v[48:49] op_sel:[1,1,0] op_sel_hi:[1,0,1] neg_lo:[0,0,0] neg_hi:[0,1,0]
v_pk_mul_f32 v[48:49], v[76:77], s[62:63] op_sel:[0,0] op_sel_hi:[0,1] neg_lo:[0,1] neg_hi:[0,1]
v_pk_fma_f32 v[76:77], v[76:77], s[62:63], v[48:49] op_sel:[1,1,0] op_sel_hi:[1,0,1] neg_lo:[0,0,0] neg_hi:[0,1,0]
v_pk_mul_f32 v[48:49], v[46:47], s[60:61] op_sel:[0,1] op_sel_hi:[0,0] neg_lo:[0,1] neg_hi:[0,1]
v_pk_fma_f32 v[46:47], v[46:47], s[60:61], v[48:49] op_sel:[1,0,0] op_sel_hi:[1,1,1] neg_lo:[0,0,0] neg_hi:[0,1,0]
v_pk_mul_f32 v[48:49], v[30:31], s[58:59] op_sel:[0,1] op_sel_hi:[0,0] neg_lo:[0,1] neg_hi:[0,1]
v_pk_fma_f32 v[30:31], v[30:31], s[58:59], v[48:49] op_sel:[1,0,0] op_sel_hi:[1,1,1] neg_lo:[0,0,0] neg_hi:[0,1,0]
v_pk_mul_f32 v[48:49], v[62:63], s[56:57] op_sel:[0,1] op_sel_hi:[0,0] neg_lo:[0,1] neg_hi:[0,1]
v_pk_fma_f32 v[62:63], v[62:63], s[56:57], v[48:49] op_sel:[1,0,0] op_sel_hi:[1,1,1] neg_lo:[0,0,0] neg_hi:[0,1,0]
v_pk_mul_f32 v[48:49], v[22:23], s[54:55] op_sel:[0,1] op_sel_hi:[0,0] neg_lo:[0,1] neg_hi:[0,1]
v_pk_fma_f32 v[22:23], v[22:23], s[54:55], v[48:49] op_sel:[1,0,0] op_sel_hi:[1,1,1] neg_lo:[0,0,0] neg_hi:[0,1,0]
v_pk_mul_f32 v[48:49], v[54:55], s[52:53] op_sel:[0,1] op_sel_hi:[0,0] neg_lo:[0,1] neg_hi:[0,1]
v_pk_fma_f32 v[54:55], v[54:55], s[52:53], v[48:49] op_sel:[1,0,0] op_sel_hi:[1,1,1] neg_lo:[0,0,0] neg_hi:[0,1,0]
v_pk_mul_f32 v[48:49], v[38:39], s[50:51] op_sel:[0,1] op_sel_hi:[0,0] neg_lo:[0,1] neg_hi:[0,1]
v_pk_fma_f32 v[38:39], v[38:39], s[50:51], v[48:49] op_sel:[1,0,0] op_sel_hi:[1,1,1] neg_lo:[0,0,0] neg_hi:[0,1,0]
v_pk_mul_f32 v[48:49], v[70:71], s[48:49] op_sel:[0,1] op_sel_hi:[0,0] neg_lo:[0,1] neg_hi:[0,1]
v_pk_fma_f32 v[70:71], v[70:71], s[48:49], v[48:49] op_sel:[1,0,0] op_sel_hi:[1,1,1] neg_lo:[0,0,0] neg_hi:[0,1,0]
v_pk_add_f32 v[78:79], v[78:79], 0 op_sel:[1,0] op_sel_hi:[0,0] neg_lo:[0,0] neg_hi:[1,0]
v_pk_mul_f32 v[48:49], v[32:33], s[48:49] op_sel:[0,1] op_sel_hi:[0,0] neg_lo:[0,0] neg_hi:[0,1]
v_pk_fma_f32 v[32:33], v[32:33], s[48:49], v[48:49] op_sel:[1,0,0] op_sel_hi:[1,1,1] neg_lo:[0,0,0] neg_hi:[0,0,0]
v_pk_mul_f32 v[48:49], v[24:25], s[50:51] op_sel:[0,1] op_sel_hi:[0,0] neg_lo:[0,0] neg_hi:[0,1]
v_pk_fma_f32 v[24:25], v[24:25], s[50:51], v[48:49] op_sel:[1,0,0] op_sel_hi:[1,1,1] neg_lo:[0,0,0] neg_hi:[0,0,0]
v_pk_mul_f32 v[48:49], v[56:57], s[52:53] op_sel:[0,1] op_sel_hi:[0,0] neg_lo:[0,0] neg_hi:[0,1]
v_pk_fma_f32 v[56:57], v[56:57], s[52:53], v[48:49] op_sel:[1,0,0] op_sel_hi:[1,1,1] neg_lo:[0,0,0] neg_hi:[0,0,0]
v_pk_mul_f32 v[48:49], v[20:21], s[54:55] op_sel:[0,1] op_sel_hi:[0,0] neg_lo:[0,0] neg_hi:[0,1]
v_pk_fma_f32 v[20:21], v[20:21], s[54:55], v[48:49] op_sel:[1,0,0] op_sel_hi:[1,1,1] neg_lo:[0,0,0] neg_hi:[0,0,0]
v_pk_mul_f32 v[48:49], v[52:53], s[56:57] op_sel:[0,1] op_sel_hi:[0,0] neg_lo:[0,0] neg_hi:[0,1]
v_pk_fma_f32 v[52:53], v[52:53], s[56:57], v[48:49] op_sel:[1,0,0] op_sel_hi:[1,1,1] neg_lo:[0,0,0] neg_hi:[0,0,0]
v_pk_mul_f32 v[48:49], v[36:37], s[58:59] op_sel:[0,1] op_sel_hi:[0,0] neg_lo:[0,0] neg_hi:[0,1]
v_pk_fma_f32 v[36:37], v[36:37], s[58:59], v[48:49] op_sel:[1,0,0] op_sel_hi:[1,1,1] neg_lo:[0,0,0] neg_hi:[0,0,0]
v_pk_mul_f32 v[48:49], v[68:69], s[60:61] op_sel:[0,1] op_sel_hi:[0,0] neg_lo:[0,0] neg_hi:[0,1]
v_pk_fma_f32 v[68:69], v[68:69], s[60:61], v[48:49] op_sel:[1,0,0] op_sel_hi:[1,1,1] neg_lo:[0,0,0] neg_hi:[0,0,0]
v_pk_mul_f32 v[48:49], v[18:19], s[62:63] op_sel:[0,0] op_sel_hi:[0,1] neg_lo:[0,0] neg_hi:[0,1]
v_pk_fma_f32 v[18:19], v[18:19], s[62:63], v[48:49] op_sel:[1,1,0] op_sel_hi:[1,0,1] neg_lo:[0,0,0] neg_hi:[0,0,0]
v_pk_mul_f32 v[48:49], v[50:51], s[60:61] op_sel:[0,0] op_sel_hi:[0,1] neg_lo:[0,0] neg_hi:[0,1]
v_pk_fma_f32 v[50:51], v[50:51], s[60:61], v[48:49] op_sel:[1,1,0] op_sel_hi:[1,0,1] neg_lo:[0,0,0] neg_hi:[0,0,0]
v_pk_mul_f32 v[48:49], v[34:35], s[58:59] op_sel:[0,0] op_sel_hi:[0,1] neg_lo:[0,0] neg_hi:[0,1]
v_pk_fma_f32 v[34:35], v[34:35], s[58:59], v[48:49] op_sel:[1,1,0] op_sel_hi:[1,0,1] neg_lo:[0,0,0] neg_hi:[0,0,0]
v_pk_mul_f32 v[48:49], v[66:67], s[56:57] op_sel:[0,0] op_sel_hi:[0,1] neg_lo:[0,0] neg_hi:[0,1]
v_pk_fma_f32 v[66:67], v[66:67], s[56:57], v[48:49] op_sel:[1,1,0] op_sel_hi:[1,0,1] neg_lo:[0,0,0] neg_hi:[0,0,0]
v_pk_mul_f32 v[48:49], v[26:27], s[54:55] op_sel:[0,0] op_sel_hi:[0,1] neg_lo:[0,0] neg_hi:[0,1]
v_pk_fma_f32 v[26:27], v[26:27], s[54:55], v[48:49] op_sel:[1,1,0] op_sel_hi:[1,0,1] neg_lo:[0,0,0] neg_hi:[0,0,0]
v_pk_mul_f32 v[48:49], v[58:59], s[52:53] op_sel:[0,0] op_sel_hi:[0,1] neg_lo:[0,0] neg_hi:[0,1]
v_pk_fma_f32 v[58:59], v[58:59], s[52:53], v[48:49] op_sel:[1,1,0] op_sel_hi:[1,0,1] neg_lo:[0,0,0] neg_hi:[0,0,0]
v_pk_mul_f32 v[48:49], v[42:43], s[50:51] op_sel:[0,0] op_sel_hi:[0,1] neg_lo:[0,0] neg_hi:[0,1]
v_pk_fma_f32 v[42:43], v[42:43], s[50:51], v[48:49] op_sel:[1,1,0] op_sel_hi:[1,0,1] neg_lo:[0,0,0] neg_hi:[0,0,0]
v_pk_mul_f32 v[48:49], v[74:75], s[48:49] op_sel:[0,0] op_sel_hi:[0,1] neg_lo:[0,0] neg_hi:[0,1]
v_pk_fma_f32 v[74:75], v[74:75], s[48:49], v[48:49] op_sel:[1,1,0] op_sel_hi:[1,0,1] neg_lo:[0,0,0] neg_hi:[0,0,0]
s_mov_b64 exec, -1
v_pk_add_f32 v[48:49], v[16:17], v[78:79] neg_lo:[0,1] neg_hi:[0,1]
v_pk_add_f32 v[16:17], v[16:17], v[78:79]
v_pk_add_f32 v[78:79], v[14:15], v[32:33] neg_lo:[0,1] neg_hi:[0,1]
v_pk_add_f32 v[14:15], v[14:15], v[32:33]
v_pk_mul_f32 v[32:33], v[78:79], s[50:51] op_sel:[0,0] op_sel_hi:[0,1] neg_lo:[0,0] neg_hi:[0,0]
v_pk_fma_f32 v[32:33], v[78:79], s[50:51], v[32:33] op_sel:[1,1,0] op_sel_hi:[1,0,1] neg_lo:[0,1,0] neg_hi:[0,0,0]
v_pk_add_f32 v[78:79], v[64:65], v[24:25] neg_lo:[0,1] neg_hi:[0,1]
v_pk_add_f32 v[64:65], v[64:65], v[24:25]
v_pk_mul_f32 v[24:25], v[78:79], s[54:55] op_sel:[0,0] op_sel_hi:[0,1] neg_lo:[0,0] neg_hi:[0,0]
v_pk_fma_f32 v[24:25], v[78:79], s[54:55], v[24:25] op_sel:[1,1,0] op_sel_hi:[1,0,1] neg_lo:[0,1,0] neg_hi:[0,0,0]
v_pk_add_f32 v[78:79], v[40:41], v[56:57] neg_lo:[0,1] neg_hi:[0,1]
v_pk_add_f32 v[40:41], v[40:41], v[56:57]
v_pk_mul_f32 v[56:57], v[78:79], s[58:59] op_sel:[0,0] op_sel_hi:[0,1] neg_lo:[0,0] neg_hi:[0,0]
v_pk_fma_f32 v[56:57], v[78:79], s[58:59], v[56:57] op_sel:[1,1,0] op_sel_hi:[1,0,1] neg_lo:[0,1,0] neg_hi:[0,0,0]
v_pk_add_f32 v[78:79], v[72:73], v[20:21] neg_lo:[0,1] neg_hi:[0,1]
v_pk_add_f32 v[72:73], v[72:73], v[20:21]
v_pk_mul_f32 v[20:21], v[78:79], s[62:63] op_sel:[0,0] op_sel_hi:[0,1] neg_lo:[0,0] neg_hi:[0,0]
v_pk_fma_f32 v[20:21], v[78:79], s[62:63], v[20:21] op_sel:[1,1,0] op_sel_hi:[1,0,1] neg_lo:[0,1,0] neg_hi:[0,0,0]
v_pk_add_f32 v[78:79], v[44:45], v[52:53] neg_lo:[0,1] neg_hi:[0,1]
v_pk_add_f32 v[44:45], v[44:45], v[52:53]
v_pk_mul_f32 v[52:53], v[78:79], s[58:59] op_sel:[0,1] op_sel_hi:[0,0] neg_lo:[0,0] neg_hi:[0,0]
v_pk_fma_f32 v[52:53], v[78:79], s[58:59], v[52:53] op_sel:[1,0,0] op_sel_hi:[1,1,1] neg_lo:[0,1,0] neg_hi:[0,0,0]
v_pk_add_f32 v[78:79], v[28:29], v[36:37] neg_lo:[0,1] neg_hi:[0,1]
v_pk_add_f32 v[28:29], v[28:29], v[36:37]
v_pk_mul_f32 v[36:37], v[78:79], s[54:55] op_sel:[0,1] op_sel_hi:[0,0] neg_lo:[0,0] neg_hi:[0,0]
v_pk_fma_f32 v[36:37], v[78:79], s[54:55], v[36:37] op_sel:[1,0,0] op_sel_hi:[1,1,1] neg_lo:[0,1,0] neg_hi:[0,0,0]
v_pk_add_f32 v[78:79], v[60:61], v[68:69] neg_lo:[0,1] neg_hi:[0,1]
v_pk_add_f32 v[60:61], v[60:61], v[68:69]
v_pk_mul_f32 v[68:69], v[78:79], s[50:51] op_sel:[0,1] op_sel_hi:[0,0] neg_lo:[0,0] neg_hi:[0,0]
v_pk_fma_f32 v[68:69], v[78:79], s[50:51], v[68:69] op_sel:[1,0,0] op_sel_hi:[1,1,1] neg_lo:[0,1,0] neg_hi:[0,0,0]
v_pk_add_f32 v[78:79], v[76:77], v[18:19] op_sel:[1,1] op_sel_hi:[0,0] neg_lo:[1,0] neg_hi:[0,1]
v_pk_add_f32 v[76:77], v[76:77], v[18:19]
v_pk_add_f32 v[18:19], v[46:47], v[50:51] neg_lo:[0,1] neg_hi:[0,1]
v_pk_add_f32 v[46:47], v[46:47], v[50:51]
v_pk_mul_f32 v[50:51], v[18:19], s[50:51] op_sel:[0,1] op_sel_hi:[0,0] neg_lo:[0,1] neg_hi:[0,0]
v_pk_fma_f32 v[50:51], v[18:19], s[50:51], v[50:51] op_sel:[1,0,0] op_sel_hi:[1,1,1] neg_lo:[0,1,0] neg_hi:[0,1,0]
v_pk_add_f32 v[18:19], v[30:31], v[34:35] neg_lo:[0,1] neg_hi:[0,1]
v_pk_add_f32 v[30:31], v[30:31], v[34:35]
v_pk_mul_f32 v[34:35], v[18:19], s[54:55] op_sel:[0,1] op_sel_hi:[0,0] neg_lo:[0,1] neg_hi:[0,0]
v_pk_fma_f32 v[34:35], v[18:19], s[54:55], v[34:35] op_sel:[1,0,0] op_sel_hi:[1,1,1] neg_lo:[0,1,0] neg_hi:[0,1,0]
v_pk_add_f32 v[18:19], v[62:63], v[66:67] neg_lo:[0,1] neg_hi:[0,1]
v_pk_add_f32 v[62:63], v[62:63], v[66:67]
v_pk_mul_f32 v[66:67], v[18:19], s[58:59] op_sel:[0,1] op_sel_hi:[0,0] neg_lo:[0,1] neg_hi:[0,0]
v_pk_fma_f32 v[66:67], v[18:19], s[58:59], v[66:67] op_sel:[1,0,0] op_sel_hi:[1,1,1] neg_lo:[0,1,0] neg_hi:[0,1,0]
v_pk_add_f32 v[18:19], v[22:23], v[26:27] neg_lo:[0,1] neg_hi:[0,1]
v_pk_add_f32 v[22:23], v[22:23], v[26:27]
v_pk_mul_f32 v[26:27], v[18:19], s[62:63] op_sel:[0,0] op_sel_hi:[0,1] neg_lo:[0,1] neg_hi:[0,0]
v_pk_fma_f32 v[26:27], v[18:19], s[62:63], v[26:27] op_sel:[1,1,0] op_sel_hi:[1,0,1] neg_lo:[0,1,0] neg_hi:[0,1,0]
v_pk_add_f32 v[18:19], v[54:55], v[58:59] neg_lo:[0,1] neg_hi:[0,1]
v_pk_add_f32 v[54:55], v[54:55], v[58:59]
v_pk_mul_f32 v[58:59], v[18:19], s[58:59] op_sel:[0,0] op_sel_hi:[0,1] neg_lo:[0,1] neg_hi:[0,0]
v_pk_fma_f32 v[58:59], v[18:19], s[58:59], v[58:59] op_sel:[1,1,0] op_sel_hi:[1,0,1] neg_lo:[0,1,0] neg_hi:[0,1,0]
v_pk_add_f32 v[18:19], v[38:39], v[42:43] neg_lo:[0,1] neg_hi:[0,1]
v_pk_add_f32 v[38:39], v[38:39], v[42:43]
v_pk_mul_f32 v[42:43], v[18:19], s[54:55] op_sel:[0,0] op_sel_hi:[0,1] neg_lo:[0,1] neg_hi:[0,0]
v_pk_fma_f32 v[42:43], v[18:19], s[54:55], v[42:43] op_sel:[1,1,0] op_sel_hi:[1,0,1] neg_lo:[0,1,0] neg_hi:[0,1,0]
v_pk_add_f32 v[18:19], v[70:71], v[74:75] neg_lo:[0,1] neg_hi:[0,1]
v_pk_add_f32 v[70:71], v[70:71], v[74:75]
v_pk_mul_f32 v[74:75], v[18:19], s[50:51] op_sel:[0,0] op_sel_hi:[0,1] neg_lo:[0,1] neg_hi:[0,0]
v_pk_fma_f32 v[74:75], v[18:19], s[50:51], v[74:75] op_sel:[1,1,0] op_sel_hi:[1,0,1] neg_lo:[0,1,0] neg_hi:[0,1,0]
v_pk_add_f32 v[18:19], v[16:17], v[76:77] neg_lo:[0,1] neg_hi:[0,1]
v_pk_add_f32 v[16:17], v[16:17], v[76:77]
v_pk_add_f32 v[76:77], v[14:15], v[46:47] neg_lo:[0,1] neg_hi:[0,1]
v_pk_add_f32 v[14:15], v[14:15], v[46:47]
v_pk_mul_f32 v[46:47], v[76:77], s[54:55] op_sel:[0,0] op_sel_hi:[0,1] neg_lo:[0,0] neg_hi:[0,0]
v_pk_fma_f32 v[46:47], v[76:77], s[54:55], v[46:47] op_sel:[1,1,0] op_sel_hi:[1,0,1] neg_lo:[0,1,0] neg_hi:[0,0,0]
v_pk_add_f32 v[76:77], v[64:65], v[30:31] neg_lo:[0,1] neg_hi:[0,1]
v_pk_add_f32 v[64:65], v[64:65], v[30:31]
v_pk_mul_f32 v[30:31], v[76:77], s[62:63] op_sel:[0,0] op_sel_hi:[0,1] neg_lo:[0,0] neg_hi:[0,0]
v_pk_fma_f32 v[30:31], v[76:77], s[62:63], v[30:31] op_sel:[1,1,0] op_sel_hi:[1,0,1] neg_lo:[0,1,0] neg_hi:[0,0,0]
v_pk_add_f32 v[76:77], v[40:41], v[62:63] neg_lo:[0,1] neg_hi:[0,1]
v_pk_add_f32 v[40:41], v[40:41], v[62:63]
v_pk_mul_f32 v[62:63], v[76:77], s[54:55] op_sel:[0,1] op_sel_hi:[0,0] neg_lo:[0,0] neg_hi:[0,0]
v_pk_fma_f32 v[62:63], v[76:77], s[54:55], v[62:63] op_sel:[1,0,0] op_sel_hi:[1,1,1] neg_lo:[0,1,0] neg_hi:[0,0,0]
v_pk_add_f32 v[76:77], v[72:73], v[22:23] op_sel:[1,1] op_sel_hi:[0,0] neg_lo:[1,0] neg_hi:[0,1]
v_pk_add_f32 v[72:73], v[72:73], v[22:23]
v_pk_add_f32 v[22:23], v[44:45], v[54:55] neg_lo:[0,1] neg_hi:[0,1]
v_pk_add_f32 v[44:45], v[44:45], v[54:55]
v_pk_mul_f32 v[54:55], v[22:23], s[54:55] op_sel:[0,1] op_sel_hi:[0,0] neg_lo:[0,1] neg_hi:[0,0]
v_pk_fma_f32 v[54:55], v[22:23], s[54:55], v[54:55] op_sel:[1,0,0] op_sel_hi:[1,1,1] neg_lo:[0,1,0] neg_hi:[0,1,0]
v_pk_add_f32 v[22:23], v[28:29], v[38:39] neg_lo:[0,1] neg_hi:[0,1]
v_pk_add_f32 v[28:29], v[28:29], v[38:39]
v_pk_mul_f32 v[38:39], v[22:23], s[62:63] op_sel:[0,0] op_sel_hi:[0,1] neg_lo:[0,1] neg_hi:[0,0]
v_pk_fma_f32 v[38:39], v[22:23], s[62:63], v[38:39] op_sel:[1,1,0] op_sel_hi:[1,0,1] neg_lo:[0,1,0] neg_hi:[0,1,0]
v_pk_add_f32 v[22:23], v[60:61], v[70:71] neg_lo:[0,1] neg_hi:[0,1]
v_pk_add_f32 v[60:61], v[60:61], v[70:71]
v_pk_mul_f32 v[70:71], v[22:23], s[54:55] op_sel:[0,0] op_sel_hi:[0,1] neg_lo:[0,1] neg_hi:[0,0]
v_pk_fma_f32 v[70:71], v[22:23], s[54:55], v[70:71] op_sel:[1,1,0] op_sel_hi:[1,0,1] neg_lo:[0,1,0] neg_hi:[0,1,0]
v_pk_add_f32 v[22:23], v[48:49], v[78:79] neg_lo:[0,1] neg_hi:[0,1]
v_pk_add_f32 v[48:49], v[48:49], v[78:79]
v_pk_add_f32 v[78:79], v[32:33], v[50:51] neg_lo:[0,1] neg_hi:[0,1]
v_pk_add_f32 v[32:33], v[32:33], v[50:51]
v_pk_mul_f32 v[50:51], v[78:79], s[54:55] op_sel:[0,0] op_sel_hi:[0,1] neg_lo:[0,0] neg_hi:[0,0]
v_pk_fma_f32 v[50:51], v[78:79], s[54:55], v[50:51] op_sel:[1,1,0] op_sel_hi:[1,0,1] neg_lo:[0,1,0] neg_hi:[0,0,0]
v_pk_add_f32 v[78:79], v[24:25], v[34:35] neg_lo:[0,1] neg_hi:[0,1]
v_pk_add_f32 v[24:25], v[24:25], v[34:35]
v_pk_mul_f32 v[34:35], v[78:79], s[62:63] op_sel:[0,0] op_sel_hi:[0,1] neg_lo:[0,0] neg_hi:[0,0]
v_pk_fma_f32 v[34:35], v[78:79], s[62:63], v[34:35] op_sel:[1,1,0] op_sel_hi:[1,0,1] neg_lo:[0,1,0] neg_hi:[0,0,0]
v_pk_add_f32 v[78:79], v[56:57], v[66:67] neg_lo:[0,1] neg_hi:[0,1]
v_pk_add_f32 v[56:57], v[56:57], v[66:67]
v_pk_mul_f32 v[66:67], v[78:79], s[54:55] op_sel:[0,1] op_sel_hi:[0,0] neg_lo:[0,0] neg_hi:[0,0]
v_pk_fma_f32 v[66:67], v[78:79], s[54:55], v[66:67] op_sel:[1,0,0] op_sel_hi:[1,1,1] neg_lo:[0,1,0] neg_hi:[0,0,0]
v_pk_add_f32 v[78:79], v[20:21], v[26:27] op_sel:[1,1] op_sel_hi:[0,0] neg_lo:[1,0] neg_hi:[0,1]
v_pk_add_f32 v[20:21], v[20:21], v[26:27]
v_pk_add_f32 v[26:27], v[52:53], v[58:59] neg_lo:[0,1] neg_hi:[0,1]
v_pk_add_f32 v[52:53], v[52:53], v[58:59]
v_pk_mul_f32 v[58:59], v[26:27], s[54:55] op_sel:[0,1] op_sel_hi:[0,0] neg_lo:[0,1] neg_hi:[0,0]
v_pk_fma_f32 v[58:59], v[26:27], s[54:55], v[58:59] op_sel:[1,0,0] op_sel_hi:[1,1,1] neg_lo:[0,1,0] neg_hi:[0,1,0]
v_pk_add_f32 v[26:27], v[36:37], v[42:43] neg_lo:[0,1] neg_hi:[0,1]
v_pk_add_f32 v[36:37], v[36:37], v[42:43]
v_pk_mul_f32 v[42:43], v[26:27], s[62:63] op_sel:[0,0] op_sel_hi:[0,1] neg_lo:[0,1] neg_hi:[0,0]
v_pk_fma_f32 v[42:43], v[26:27], s[62:63], v[42:43] op_sel:[1,1,0] op_sel_hi:[1,0,1] neg_lo:[0,1,0] neg_hi:[0,1,0]
v_pk_add_f32 v[26:27], v[68:69], v[74:75] neg_lo:[0,1] neg_hi:[0,1]
v_pk_add_f32 v[68:69], v[68:69], v[74:75]
v_pk_mul_f32 v[74:75], v[26:27], s[54:55] op_sel:[0,0] op_sel_hi:[0,1] neg_lo:[0,1] neg_hi:[0,0]
v_pk_fma_f32 v[74:75], v[26:27], s[54:55], v[74:75] op_sel:[1,1,0] op_sel_hi:[1,0,1] neg_lo:[0,1,0] neg_hi:[0,1,0]
v_pk_add_f32 v[26:27], v[16:17], v[72:73] neg_lo:[0,1] neg_hi:[0,1]
v_pk_add_f32 v[16:17], v[16:17], v[72:73]
v_pk_add_f32 v[72:73], v[14:15], v[44:45] neg_lo:[0,1] neg_hi:[0,1]
v_pk_add_f32 v[14:15], v[14:15], v[44:45]
v_pk_mul_f32 v[44:45], v[72:73], s[62:63] op_sel:[0,0] op_sel_hi:[0,1] neg_lo:[0,0] neg_hi:[0,0]
v_pk_fma_f32 v[44:45], v[72:73], s[62:63], v[44:45] op_sel:[1,1,0] op_sel_hi:[1,0,1] neg_lo:[0,1,0] neg_hi:[0,0,0]
v_pk_add_f32 v[72:73], v[64:65], v[28:29] op_sel:[1,1] op_sel_hi:[0,0] neg_lo:[1,0] neg_hi:[0,1]
v_pk_add_f32 v[64:65], v[64:65], v[28:29]
v_pk_add_f32 v[28:29], v[40:41], v[60:61] neg_lo:[0,1] neg_hi:[0,1]
v_pk_add_f32 v[40:41], v[40:41], v[60:61]
v_pk_mul_f32 v[60:61], v[28:29], s[62:63] op_sel:[0,0] op_sel_hi:[0,1] neg_lo:[0,1] neg_hi:[0,0]
v_pk_fma_f32 v[60:61], v[28:29], s[62:63], v[60:61] op_sel:[1,1,0] op_sel_hi:[1,0,1] neg_lo:[0,1,0] neg_hi:[0,1,0]
v_pk_add_f32 v[28:29], v[18:19], v[76:77] neg_lo:[0,1] neg_hi:[0,1]
v_pk_add_f32 v[18:19], v[18:19], v[76:77]
v_pk_add_f32 v[76:77], v[46:47], v[54:55] neg_lo:[0,1] neg_hi:[0,1]
v_pk_add_f32 v[46:47], v[46:47], v[54:55]
v_pk_mul_f32 v[54:55], v[76:77], s[62:63] op_sel:[0,0] op_sel_hi:[0,1] neg_lo:[0,0] neg_hi:[0,0]
v_pk_fma_f32 v[54:55], v[76:77], s[62:63], v[54:55] op_sel:[1,1,0] op_sel_hi:[1,0,1] neg_lo:[0,1,0] neg_hi:[0,0,0]
v_pk_add_f32 v[76:77], v[30:31], v[38:39] op_sel:[1,1] op_sel_hi:[0,0] neg_lo:[1,0] neg_hi:[0,1]
v_pk_add_f32 v[30:31], v[30:31], v[38:39]
v_pk_add_f32 v[38:39], v[62:63], v[70:71] neg_lo:[0,1] neg_hi:[0,1]
v_pk_add_f32 v[62:63], v[62:63], v[70:71]
v_pk_mul_f32 v[70:71], v[38:39], s[62:63] op_sel:[0,0] op_sel_hi:[0,1] neg_lo:[0,1] neg_hi:[0,0]
v_pk_fma_f32 v[70:71], v[38:39], s[62:63], v[70:71] op_sel:[1,1,0] op_sel_hi:[1,0,1] neg_lo:[0,1,0] neg_hi:[0,1,0]
v_pk_add_f32 v[38:39], v[48:49], v[20:21] neg_lo:[0,1] neg_hi:[0,1]
v_pk_add_f32 v[48:49], v[48:49], v[20:21]
v_pk_add_f32 v[20:21], v[32:33], v[52:53] neg_lo:[0,1] neg_hi:[0,1]
v_pk_add_f32 v[32:33], v[32:33], v[52:53]
v_pk_mul_f32 v[52:53], v[20:21], s[62:63] op_sel:[0,0] op_sel_hi:[0,1] neg_lo:[0,0] neg_hi:[0,0]
v_pk_fma_f32 v[52:53], v[20:21], s[62:63], v[52:53] op_sel:[1,1,0] op_sel_hi:[1,0,1] neg_lo:[0,1,0] neg_hi:[0,0,0]
v_pk_add_f32 v[20:21], v[24:25], v[36:37] op_sel:[1,1] op_sel_hi:[0,0] neg_lo:[1,0] neg_hi:[0,1]
v_pk_add_f32 v[24:25], v[24:25], v[36:37]
v_pk_add_f32 v[36:37], v[56:57], v[68:69] neg_lo:[0,1] neg_hi:[0,1]
v_pk_add_f32 v[56:57], v[56:57], v[68:69]
v_pk_mul_f32 v[68:69], v[36:37], s[62:63] op_sel:[0,0] op_sel_hi:[0,1] neg_lo:[0,1] neg_hi:[0,0]
v_pk_fma_f32 v[68:69], v[36:37], s[62:63], v[68:69] op_sel:[1,1,0] op_sel_hi:[1,0,1] neg_lo:[0,1,0] neg_hi:[0,1,0]
v_pk_add_f32 v[36:37], v[22:23], v[78:79] neg_lo:[0,1] neg_hi:[0,1]
v_pk_add_f32 v[22:23], v[22:23], v[78:79]
v_pk_add_f32 v[78:79], v[50:51], v[58:59] neg_lo:[0,1] neg_hi:[0,1]
v_pk_add_f32 v[50:51], v[50:51], v[58:59]
v_pk_mul_f32 v[58:59], v[78:79], s[62:63] op_sel:[0,0] op_sel_hi:[0,1] neg_lo:[0,0] neg_hi:[0,0]
v_pk_fma_f32 v[58:59], v[78:79], s[62:63], v[58:59] op_sel:[1,1,0] op_sel_hi:[1,0,1] neg_lo:[0,1,0] neg_hi:[0,0,0]
v_pk_add_f32 v[78:79], v[34:35], v[42:43] op_sel:[1,1] op_sel_hi:[0,0] neg_lo:[1,0] neg_hi:[0,1]
v_pk_add_f32 v[34:35], v[34:35], v[42:43]
v_pk_add_f32 v[42:43], v[66:67], v[74:75] neg_lo:[0,1] neg_hi:[0,1]
v_pk_add_f32 v[66:67], v[66:67], v[74:75]
v_pk_mul_f32 v[74:75], v[42:43], s[62:63] op_sel:[0,0] op_sel_hi:[0,1] neg_lo:[0,1] neg_hi:[0,0]
v_pk_fma_f32 v[74:75], v[42:43], s[62:63], v[74:75] op_sel:[1,1,0] op_sel_hi:[1,0,1] neg_lo:[0,1,0] neg_hi:[0,1,0]
v_pk_add_f32 v[42:43], v[16:17], v[64:65] neg_lo:[0,1] neg_hi:[0,1]
v_pk_add_f32 v[16:17], v[16:17], v[64:65]
v_pk_add_f32 v[64:65], v[14:15], v[40:41] op_sel:[1,1] op_sel_hi:[0,0] neg_lo:[1,0] neg_hi:[0,1]
v_pk_add_f32 v[14:15], v[14:15], v[40:41]
v_pk_add_f32 v[40:41], v[26:27], v[72:73] neg_lo:[0,1] neg_hi:[0,1]
v_pk_add_f32 v[26:27], v[26:27], v[72:73]
v_pk_add_f32 v[72:73], v[44:45], v[60:61] op_sel:[1,1] op_sel_hi:[0,0] neg_lo:[1,0] neg_hi:[0,1]
v_pk_add_f32 v[44:45], v[44:45], v[60:61]
v_pk_add_f32 v[60:61], v[18:19], v[30:31] neg_lo:[0,1] neg_hi:[0,1]
v_pk_add_f32 v[18:19], v[18:19], v[30:31]
v_pk_add_f32 v[30:31], v[46:47], v[62:63] op_sel:[1,1] op_sel_hi:[0,0] neg_lo:[1,0] neg_hi:[0,1]
v_pk_add_f32 v[46:47], v[46:47], v[62:63]
v_pk_add_f32 v[62:63], v[28:29], v[76:77] neg_lo:[0,1] neg_hi:[0,1]
v_pk_add_f32 v[28:29], v[28:29], v[76:77]
v_pk_add_f32 v[76:77], v[54:55], v[70:71] op_sel:[1,1] op_sel_hi:[0,0] neg_lo:[1,0] neg_hi:[0,1]
v_pk_add_f32 v[54:55], v[54:55], v[70:71]
v_pk_add_f32 v[70:71], v[48:49], v[24:25] neg_lo:[0,1] neg_hi:[0,1]
v_pk_add_f32 v[48:49], v[48:49], v[24:25]
v_pk_add_f32 v[24:25], v[32:33], v[56:57] op_sel:[1,1] op_sel_hi:[0,0] neg_lo:[1,0] neg_hi:[0,1]
v_pk_add_f32 v[32:33], v[32:33], v[56:57]
v_pk_add_f32 v[56:57], v[38:39], v[20:21] neg_lo:[0,1] neg_hi:[0,1]
v_pk_add_f32 v[38:39], v[38:39], v[20:21]
v_pk_add_f32 v[20:21], v[52:53], v[68:69] op_sel:[1,1] op_sel_hi:[0,0] neg_lo:[1,0] neg_hi:[0,1]
v_pk_add_f32 v[52:53], v[52:53], v[68:69]
v_pk_add_f32 v[68:69], v[22:23], v[34:35] neg_lo:[0,1] neg_hi:[0,1]
v_pk_add_f32 v[22:23], v[22:23], v[34:35]
v_pk_add_f32 v[34:35], v[50:51], v[66:67] op_sel:[1,1] op_sel_hi:[0,0] neg_lo:[1,0] neg_hi:[0,1]
v_pk_add_f32 v[50:51], v[50:51], v[66:67]
v_pk_add_f32 v[66:67], v[36:37], v[78:79] neg_lo:[0,1] neg_hi:[0,1]
v_pk_add_f32 v[36:37], v[36:37], v[78:79]
v_pk_add_f32 v[78:79], v[58:59], v[74:75] op_sel:[1,1] op_sel_hi:[0,0] neg_lo:[1,0] neg_hi:[0,1]
v_pk_add_f32 v[58:59], v[58:59], v[74:75]
v_pk_add_f32 v[74:75], v[16:17], v[14:15] neg_lo:[0,1] neg_hi:[0,1]
v_pk_add_f32 v[16:17], v[16:17], v[14:15]
v_pk_add_f32 v[14:15], v[42:43], v[64:65] neg_lo:[0,1] neg_hi:[0,1]
v_pk_add_f32 v[42:43], v[42:43], v[64:65]
v_pk_add_f32 v[64:65], v[26:27], v[44:45] neg_lo:[0,1] neg_hi:[0,1]
v_pk_add_f32 v[26:27], v[26:27], v[44:45]
v_pk_add_f32 v[44:45], v[40:41], v[72:73] neg_lo:[0,1] neg_hi:[0,1]
v_pk_add_f32 v[40:41], v[40:41], v[72:73]
v_pk_add_f32 v[72:73], v[18:19], v[46:47] neg_lo:[0,1] neg_hi:[0,1]
v_pk_add_f32 v[18:19], v[18:19], v[46:47]
v_pk_add_f32 v[46:47], v[60:61], v[30:31] neg_lo:[0,1] neg_hi:[0,1]
v_pk_add_f32 v[60:61], v[60:61], v[30:31]
v_pk_add_f32 v[30:31], v[28:29], v[54:55] neg_lo:[0,1] neg_hi:[0,1]
v_pk_add_f32 v[28:29], v[28:29], v[54:55]
v_pk_add_f32 v[54:55], v[62:63], v[76:77] neg_lo:[0,1] neg_hi:[0,1]
v_pk_add_f32 v[62:63], v[62:63], v[76:77]
v_pk_add_f32 v[76:77], v[48:49], v[32:33] neg_lo:[0,1] neg_hi:[0,1]
v_pk_add_f32 v[48:49], v[48:49], v[32:33]
v_pk_add_f32 v[32:33], v[70:71], v[24:25] neg_lo:[0,1] neg_hi:[0,1]
v_pk_add_f32 v[70:71], v[70:71], v[24:25]
v_pk_add_f32 v[24:25], v[38:39], v[52:53] neg_lo:[0,1] neg_hi:[0,1]
v_pk_add_f32 v[38:39], v[38:39], v[52:53]
v_pk_add_f32 v[52:53], v[56:57], v[20:21] neg_lo:[0,1] neg_hi:[0,1]
v_pk_add_f32 v[56:57], v[56:57], v[20:21]
v_pk_add_f32 v[20:21], v[22:23], v[50:51] neg_lo:[0,1] neg_hi:[0,1]
v_pk_add_f32 v[22:23], v[22:23], v[50:51]
v_pk_add_f32 v[50:51], v[68:69], v[34:35] neg_lo:[0,1] neg_hi:[0,1]
v_pk_add_f32 v[68:69], v[68:69], v[34:35]
v_pk_add_f32 v[34:35], v[36:37], v[58:59] neg_lo:[0,1] neg_hi:[0,1]
v_pk_add_f32 v[36:37], v[36:37], v[58:59]
v_pk_add_f32 v[58:59], v[66:67], v[78:79] neg_lo:[0,1] neg_hi:[0,1]
v_pk_add_f32 v[66:67], v[66:67], v[78:79]
v_pk_mul_f32 v[78:79], v[16:17], v[144:145] op_sel:[0,0] op_sel_hi:[0,1] neg_lo:[0,0] neg_hi:[0,0]
v_pk_fma_f32 v[16:17], v[16:17], v[144:145], v[78:79] op_sel:[1,1,0] op_sel_hi:[1,0,1] neg_lo:[0,1,0] neg_hi:[0,0,0]
v_pk_mul_f32 v[78:79], v[48:49], v[146:147] op_sel:[0,0] op_sel_hi:[0,1] neg_lo:[0,0] neg_hi:[0,0]
v_pk_fma_f32 v[48:49], v[48:49], v[146:147], v[78:79] op_sel:[1,1,0] op_sel_hi:[1,0,1] neg_lo:[0,1,0] neg_hi:[0,0,0]
v_pk_mul_f32 v[78:79], v[18:19], v[148:149] op_sel:[0,0] op_sel_hi:[0,1] neg_lo:[0,0] neg_hi:[0,0]
v_pk_fma_f32 v[18:19], v[18:19], v[148:149], v[78:79] op_sel:[1,1,0] op_sel_hi:[1,0,1] neg_lo:[0,1,0] neg_hi:[0,0,0]
v_pk_mul_f32 v[78:79], v[22:23], v[150:151] op_sel:[0,0] op_sel_hi:[0,1] neg_lo:[0,0] neg_hi:[0,0]
v_pk_fma_f32 v[22:23], v[22:23], v[150:151], v[78:79] op_sel:[1,1,0] op_sel_hi:[1,0,1] neg_lo:[0,1,0] neg_hi:[0,0,0]
v_pk_mul_f32 v[78:79], v[26:27], v[152:153] op_sel:[0,0] op_sel_hi:[0,1] neg_lo:[0,0] neg_hi:[0,0]
v_pk_fma_f32 v[26:27], v[26:27], v[152:153], v[78:79] op_sel:[1,1,0] op_sel_hi:[1,0,1] neg_lo:[0,1,0] neg_hi:[0,0,0]
v_pk_mul_f32 v[78:79], v[38:39], v[154:155] op_sel:[0,0] op_sel_hi:[0,1] neg_lo:[0,0] neg_hi:[0,0]
v_pk_fma_f32 v[38:39], v[38:39], v[154:155], v[78:79] op_sel:[1,1,0] op_sel_hi:[1,0,1] neg_lo:[0,1,0] neg_hi:[0,0,0]
v_pk_mul_f32 v[78:79], v[28:29], v[156:157] op_sel:[0,0] op_sel_hi:[0,1] neg_lo:[0,0] neg_hi:[0,0]
v_pk_fma_f32 v[28:29], v[28:29], v[156:157], v[78:79] op_sel:[1,1,0] op_sel_hi:[1,0,1] neg_lo:[0,1,0] neg_hi:[0,0,0]
v_pk_mul_f32 v[78:79], v[36:37], v[158:159] op_sel:[0,0] op_sel_hi:[0,1] neg_lo:[0,0] neg_hi:[0,0]
v_pk_fma_f32 v[36:37], v[36:37], v[158:159], v[78:79] op_sel:[1,1,0] op_sel_hi:[1,0,1] neg_lo:[0,1,0] neg_hi:[0,0,0]
v_pk_mul_f32 v[78:79], v[42:43], v[160:161] op_sel:[0,0] op_sel_hi:[0,1] neg_lo:[0,0] neg_hi:[0,0]
v_pk_fma_f32 v[42:43], v[42:43], v[160:161], v[78:79] op_sel:[1,1,0] op_sel_hi:[1,0,1] neg_lo:[0,1,0] neg_hi:[0,0,0]
v_pk_mul_f32 v[78:79], v[70:71], v[162:163] op_sel:[0,0] op_sel_hi:[0,1] neg_lo:[0,0] neg_hi:[0,0]
v_pk_fma_f32 v[70:71], v[70:71], v[162:163], v[78:79] op_sel:[1,1,0] op_sel_hi:[1,0,1] neg_lo:[0,1,0] neg_hi:[0,0,0]
v_pk_mul_f32 v[78:79], v[60:61], v[164:165] op_sel:[0,0] op_sel_hi:[0,1] neg_lo:[0,0] neg_hi:[0,0]
v_pk_fma_f32 v[60:61], v[60:61], v[164:165], v[78:79] op_sel:[1,1,0] op_sel_hi:[1,0,1] neg_lo:[0,1,0] neg_hi:[0,0,0]
v_pk_mul_f32 v[78:79], v[68:69], v[166:167] op_sel:[0,0] op_sel_hi:[0,1] neg_lo:[0,0] neg_hi:[0,0]
v_pk_fma_f32 v[68:69], v[68:69], v[166:167], v[78:79] op_sel:[1,1,0] op_sel_hi:[1,0,1] neg_lo:[0,1,0] neg_hi:[0,0,0]
v_pk_mul_f32 v[78:79], v[40:41], v[168:169] op_sel:[0,0] op_sel_hi:[0,1] neg_lo:[0,0] neg_hi:[0,0]
v_pk_fma_f32 v[40:41], v[40:41], v[168:169], v[78:79] op_sel:[1,1,0] op_sel_hi:[1,0,1] neg_lo:[0,1,0] neg_hi:[0,0,0]
v_pk_mul_f32 v[78:79], v[56:57], v[170:171] op_sel:[0,0] op_sel_hi:[0,1] neg_lo:[0,0] neg_hi:[0,0]
v_pk_fma_f32 v[56:57], v[56:57], v[170:171], v[78:79] op_sel:[1,1,0] op_sel_hi:[1,0,1] neg_lo:[0,1,0] neg_hi:[0,0,0]
v_pk_mul_f32 v[78:79], v[62:63], v[172:173] op_sel:[0,0] op_sel_hi:[0,1] neg_lo:[0,0] neg_hi:[0,0]
v_pk_fma_f32 v[62:63], v[62:63], v[172:173], v[78:79] op_sel:[1,1,0] op_sel_hi:[1,0,1] neg_lo:[0,1,0] neg_hi:[0,0,0]
v_pk_mul_f32 v[78:79], v[66:67], v[174:175] op_sel:[0,0] op_sel_hi:[0,1] neg_lo:[0,0] neg_hi:[0,0]
v_pk_fma_f32 v[66:67], v[66:67], v[174:175], v[78:79] op_sel:[1,1,0] op_sel_hi:[1,0,1] neg_lo:[0,1,0] neg_hi:[0,0,0]
v_pk_mul_f32 v[78:79], v[74:75], v[176:177] op_sel:[0,0] op_sel_hi:[0,1] neg_lo:[0,0] neg_hi:[0,0]
v_pk_fma_f32 v[74:75], v[74:75], v[176:177], v[78:79] op_sel:[1,1,0] op_sel_hi:[1,0,1] neg_lo:[0,1,0] neg_hi:[0,0,0]
v_pk_mul_f32 v[78:79], v[76:77], v[178:179] op_sel:[0,0] op_sel_hi:[0,1] neg_lo:[0,0] neg_hi:[0,0]
v_pk_fma_f32 v[76:77], v[76:77], v[178:179], v[78:79] op_sel:[1,1,0] op_sel_hi:[1,0,1] neg_lo:[0,1,0] neg_hi:[0,0,0]
v_pk_mul_f32 v[78:79], v[72:73], v[180:181] op_sel:[0,0] op_sel_hi:[0,1] neg_lo:[0,0] neg_hi:[0,0]
v_pk_fma_f32 v[72:73], v[72:73], v[180:181], v[78:79] op_sel:[1,1,0] op_sel_hi:[1,0,1] neg_lo:[0,1,0] neg_hi:[0,0,0]
v_pk_mul_f32 v[78:79], v[20:21], v[182:183] op_sel:[0,0] op_sel_hi:[0,1] neg_lo:[0,0] neg_hi:[0,0]
v_pk_fma_f32 v[20:21], v[20:21], v[182:183], v[78:79] op_sel:[1,1,0] op_sel_hi:[1,0,1] neg_lo:[0,1,0] neg_hi:[0,0,0]
v_pk_mul_f32 v[78:79], v[64:65], v[184:185] op_sel:[0,0] op_sel_hi:[0,1] neg_lo:[0,0] neg_hi:[0,0]
v_pk_fma_f32 v[64:65], v[64:65], v[184:185], v[78:79] op_sel:[1,1,0] op_sel_hi:[1,0,1] neg_lo:[0,1,0] neg_hi:[0,0,0]
v_pk_mul_f32 v[78:79], v[24:25], v[186:187] op_sel:[0,0] op_sel_hi:[0,1] neg_lo:[0,0] neg_hi:[0,0]
v_pk_fma_f32 v[24:25], v[24:25], v[186:187], v[78:79] op_sel:[1,1,0] op_sel_hi:[1,0,1] neg_lo:[0,1,0] neg_hi:[0,0,0]
v_pk_mul_f32 v[78:79], v[30:31], v[188:189] op_sel:[0,0] op_sel_hi:[0,1] neg_lo:[0,0] neg_hi:[0,0]
v_pk_fma_f32 v[30:31], v[30:31], v[188:189], v[78:79] op_sel:[1,1,0] op_sel_hi:[1,0,1] neg_lo:[0,1,0] neg_hi:[0,0,0]
v_pk_mul_f32 v[78:79], v[34:35], v[190:191] op_sel:[0,0] op_sel_hi:[0,1] neg_lo:[0,0] neg_hi:[0,0]
v_pk_fma_f32 v[34:35], v[34:35], v[190:191], v[78:79] op_sel:[1,1,0] op_sel_hi:[1,0,1] neg_lo:[0,1,0] neg_hi:[0,0,0]
v_pk_mul_f32 v[78:79], v[14:15], v[192:193] op_sel:[0,0] op_sel_hi:[0,1] neg_lo:[0,0] neg_hi:[0,0]
v_pk_fma_f32 v[14:15], v[14:15], v[192:193], v[78:79] op_sel:[1,1,0] op_sel_hi:[1,0,1] neg_lo:[0,1,0] neg_hi:[0,0,0]
v_pk_mul_f32 v[78:79], v[32:33], v[194:195] op_sel:[0,0] op_sel_hi:[0,1] neg_lo:[0,0] neg_hi:[0,0]
v_pk_fma_f32 v[32:33], v[32:33], v[194:195], v[78:79] op_sel:[1,1,0] op_sel_hi:[1,0,1] neg_lo:[0,1,0] neg_hi:[0,0,0]
v_pk_mul_f32 v[78:79], v[46:47], v[196:197] op_sel:[0,0] op_sel_hi:[0,1] neg_lo:[0,0] neg_hi:[0,0]
v_pk_fma_f32 v[46:47], v[46:47], v[196:197], v[78:79] op_sel:[1,1,0] op_sel_hi:[1,0,1] neg_lo:[0,1,0] neg_hi:[0,0,0]
v_pk_mul_f32 v[78:79], v[50:51], v[198:199] op_sel:[0,0] op_sel_hi:[0,1] neg_lo:[0,0] neg_hi:[0,0]
v_pk_fma_f32 v[50:51], v[50:51], v[198:199], v[78:79] op_sel:[1,1,0] op_sel_hi:[1,0,1] neg_lo:[0,1,0] neg_hi:[0,0,0]
v_pk_mul_f32 v[78:79], v[44:45], v[200:201] op_sel:[0,0] op_sel_hi:[0,1] neg_lo:[0,0] neg_hi:[0,0]
v_pk_fma_f32 v[44:45], v[44:45], v[200:201], v[78:79] op_sel:[1,1,0] op_sel_hi:[1,0,1] neg_lo:[0,1,0] neg_hi:[0,0,0]
v_pk_mul_f32 v[78:79], v[52:53], v[202:203] op_sel:[0,0] op_sel_hi:[0,1] neg_lo:[0,0] neg_hi:[0,0]
v_pk_fma_f32 v[52:53], v[52:53], v[202:203], v[78:79] op_sel:[1,1,0] op_sel_hi:[1,0,1] neg_lo:[0,1,0] neg_hi:[0,0,0]
v_pk_mul_f32 v[78:79], v[54:55], v[204:205] op_sel:[0,0] op_sel_hi:[0,1] neg_lo:[0,0] neg_hi:[0,0]
v_pk_fma_f32 v[54:55], v[54:55], v[204:205], v[78:79] op_sel:[1,1,0] op_sel_hi:[1,0,1] neg_lo:[0,1,0] neg_hi:[0,0,0]
v_pk_mul_f32 v[78:79], v[58:59], v[206:207] op_sel:[0,0] op_sel_hi:[0,1] neg_lo:[0,0] neg_hi:[0,0]
v_pk_fma_f32 v[58:59], v[58:59], v[206:207], v[78:79] op_sel:[1,1,0] op_sel_hi:[1,0,1] neg_lo:[0,1,0] neg_hi:[0,0,0]
ds_write_b64 v4, v[16:17] offset:0
ds_write_b64 v4, v[48:49] offset:16
ds_write_b64 v4, v[18:19] offset:32
ds_write_b64 v4, v[22:23] offset:48
ds_write_b64 v4, v[26:27] offset:64
ds_write_b64 v4, v[38:39] offset:80
ds_write_b64 v4, v[28:29] offset:96
ds_write_b64 v4, v[36:37] offset:112
ds_write_b64 v4, v[42:43] offset:128
ds_write_b64 v4, v[70:71] offset:144
ds_write_b64 v4, v[60:61] offset:160
ds_write_b64 v4, v[68:69] offset:176
ds_write_b64 v4, v[40:41] offset:192
ds_write_b64 v4, v[56:57] offset:208
ds_write_b64 v4, v[62:63] offset:224
ds_write_b64 v4, v[66:67] offset:240
ds_write_b64 v4, v[74:75] offset:256
ds_write_b64 v4, v[76:77] offset:272
ds_write_b64 v4, v[72:73] offset:288
ds_write_b64 v4, v[20:21] offset:304
ds_write_b64 v4, v[64:65] offset:320
ds_write_b64 v4, v[24:25] offset:336
ds_write_b64 v4, v[30:31] offset:352
ds_write_b64 v4, v[34:35] offset:368
ds_write_b64 v4, v[14:15] offset:384
ds_write_b64 v4, v[32:33] offset:400
ds_write_b64 v4, v[46:47] offset:416
ds_write_b64 v4, v[50:51] offset:432
ds_write_b64 v4, v[44:45] offset:448
ds_write_b64 v4, v[52:53] offset:464
ds_write_b64 v4, v[54:55] offset:480
ds_write_b64 v4, v[58:59] offset:496
s_waitcnt lgkmcnt(0)
ds_read_b64 v[16:17], v3 offset:0
ds_read_b64 v[48:49], v3 offset:8448
ds_read_b64 v[18:19], v3 offset:528
ds_read_b64 v[50:51], v3 offset:8976
ds_read_b64 v[20:21], v3 offset:1056
ds_read_b64 v[52:53], v3 offset:9504
ds_read_b64 v[22:23], v3 offset:1584
ds_read_b64 v[54:55], v3 offset:10032
ds_read_b64 v[24:25], v3 offset:2112
ds_read_b64 v[56:57], v3 offset:10560
ds_read_b64 v[26:27], v3 offset:2640
ds_read_b64 v[58:59], v3 offset:11088
ds_read_b64 v[28:29], v3 offset:3168
ds_read_b64 v[60:61], v3 offset:11616
ds_read_b64 v[30:31], v3 offset:3696
ds_read_b64 v[62:63], v3 offset:12144
ds_read_b64 v[32:33], v3 offset:4224
ds_read_b64 v[64:65], v3 offset:12672
ds_read_b64 v[34:35], v3 offset:4752
ds_read_b64 v[66:67], v3 offset:13200
ds_read_b64 v[36:37], v3 offset:5280
ds_read_b64 v[68:69], v3 offset:13728
ds_read_b64 v[38:39], v3 offset:5808
ds_read_b64 v[70:71], v3 offset:14256
ds_read_b64 v[40:41], v3 offset:6336
ds_read_b64 v[72:73], v3 offset:14784
ds_read_b64 v[42:43], v3 offset:6864
ds_read_b64 v[74:75], v3 offset:15312
ds_read_b64 v[44:45], v3 offset:7392
ds_read_b64 v[76:77], v3 offset:15840
ds_read_b64 v[46:47], v3 offset:7920
ds_read_b64 v[78:79], v3 offset:16368
s_waitcnt lgkmcnt(0)
v_pk_add_f32 v[14:15], v[16:17], v[48:49] neg_lo:[0,1] neg_hi:[0,1]
v_pk_add_f32 v[16:17], v[16:17], v[48:49]
v_pk_add_f32 v[48:49], v[18:19], v[50:51] neg_lo:[0,1] neg_hi:[0,1]
v_pk_add_f32 v[18:19], v[18:19], v[50:51]
v_pk_mul_f32 v[50:51], v[48:49], s[50:51] op_sel:[0,0] op_sel_hi:[0,1] neg_lo:[0,0] neg_hi:[0,0]
v_pk_fma_f32 v[50:51], v[48:49], s[50:51], v[50:51] op_sel:[1,1,0] op_sel_hi:[1,0,1] neg_lo:[0,1,0] neg_hi:[0,0,0]
v_pk_add_f32 v[48:49], v[20:21], v[52:53] neg_lo:[0,1] neg_hi:[0,1]
v_pk_add_f32 v[20:21], v[20:21], v[52:53]
v_pk_mul_f32 v[52:53], v[48:49], s[54:55] op_sel:[0,0] op_sel_hi:[0,1] neg_lo:[0,0] neg_hi:[0,0]
v_pk_fma_f32 v[52:53], v[48:49], s[54:55], v[52:53] op_sel:[1,1,0] op_sel_hi:[1,0,1] neg_lo:[0,1,0] neg_hi:[0,0,0]
v_pk_add_f32 v[48:49], v[22:23], v[54:55] neg_lo:[0,1] neg_hi:[0,1]
v_pk_add_f32 v[22:23], v[22:23], v[54:55]
v_pk_mul_f32 v[54:55], v[48:49], s[58:59] op_sel:[0,0] op_sel_hi:[0,1] neg_lo:[0,0] neg_hi:[0,0]
v_pk_fma_f32 v[54:55], v[48:49], s[58:59], v[54:55] op_sel:[1,1,0] op_sel_hi:[1,0,1] neg_lo:[0,1,0] neg_hi:[0,0,0]
v_pk_add_f32 v[48:49], v[24:25], v[56:57] neg_lo:[0,1] neg_hi:[0,1]
v_pk_add_f32 v[24:25], v[24:25], v[56:57]
v_pk_mul_f32 v[56:57], v[48:49], s[62:63] op_sel:[0,0] op_sel_hi:[0,1] neg_lo:[0,0] neg_hi:[0,0]
v_pk_fma_f32 v[56:57], v[48:49], s[62:63], v[56:57] op_sel:[1,1,0] op_sel_hi:[1,0,1] neg_lo:[0,1,0] neg_hi:[0,0,0]
v_pk_add_f32 v[48:49], v[26:27], v[58:59] neg_lo:[0,1] neg_hi:[0,1]
v_pk_add_f32 v[26:27], v[26:27], v[58:59]
v_pk_mul_f32 v[58:59], v[48:49], s[58:59] op_sel:[0,1] op_sel_hi:[0,0] neg_lo:[0,0] neg_hi:[0,0]
v_pk_fma_f32 v[58:59], v[48:49], s[58:59], v[58:59] op_sel:[1,0,0] op_sel_hi:[1,1,1] neg_lo:[0,1,0] neg_hi:[0,0,0]
v_pk_add_f32 v[48:49], v[28:29], v[60:61] neg_lo:[0,1] neg_hi:[0,1]
v_pk_add_f32 v[28:29], v[28:29], v[60:61]
v_pk_mul_f32 v[60:61], v[48:49], s[54:55] op_sel:[0,1] op_sel_hi:[0,0] neg_lo:[0,0] neg_hi:[0,0]
v_pk_fma_f32 v[60:61], v[48:49], s[54:55], v[60:61] op_sel:[1,0,0] op_sel_hi:[1,1,1] neg_lo:[0,1,0] neg_hi:[0,0,0]
v_pk_add_f32 v[48:49], v[30:31], v[62:63] neg_lo:[0,1] neg_hi:[0,1]
v_pk_add_f32 v[30:31], v[30:31], v[62:63]
v_pk_mul_f32 v[62:63], v[48:49], s[50:51] op_sel:[0,1] op_sel_hi:[0,0] neg_lo:[0,0] neg_hi:[0,0]
v_pk_fma_f32 v[62:63], v[48:49], s[50:51], v[62:63] op_sel:[1,0,0] op_sel_hi:[1,1,1] neg_lo:[0,1,0] neg_hi:[0,0,0]
v_pk_add_f32 v[48:49], v[32:33], v[64:65] op_sel:[1,1] op_sel_hi:[0,0] neg_lo:[1,0] neg_hi:[0,1]
v_pk_add_f32 v[32:33], v[32:33], v[64:65]
v_pk_add_f32 v[64:65], v[34:35], v[66:67] neg_lo:[0,1] neg_hi:[0,1]
v_pk_add_f32 v[34:35], v[34:35], v[66:67]
v_pk_mul_f32 v[66:67], v[64:65], s[50:51] op_sel:[0,1] op_sel_hi:[0,0] neg_lo:[0,1] neg_hi:[0,0]
v_pk_fma_f32 v[66:67], v[64:65], s[50:51], v[66:67] op_sel:[1,0,0] op_sel_hi:[1,1,1] neg_lo:[0,1,0] neg_hi:[0,1,0]
v_pk_add_f32 v[64:65], v[36:37], v[68:69] neg_lo:[0,1] neg_hi:[0,1]
v_pk_add_f32 v[36:37], v[36:37], v[68:69]
v_pk_mul_f32 v[68:69], v[64:65], s[54:55] op_sel:[0,1] op_sel_hi:[0,0] neg_lo:[0,1] neg_hi:[0,0]
v_pk_fma_f32 v[68:69], v[64:65], s[54:55], v[68:69] op_sel:[1,0,0] op_sel_hi:[1,1,1] neg_lo:[0,1,0] neg_hi:[0,1,0]
v_pk_add_f32 v[64:65], v[38:39], v[70:71] neg_lo:[0,1] neg_hi:[0,1]
v_pk_add_f32 v[38:39], v[38:39], v[70:71]
v_pk_mul_f32 v[70:71], v[64:65], s[58:59] op_sel:[0,1] op_sel_hi:[0,0] neg_lo:[0,1] neg_hi:[0,0]
v_pk_fma_f32 v[70:71], v[64:65], s[58:59], v[70:71] op_sel:[1,0,0] op_sel_hi:[1,1,1] neg_lo:[0,1,0] neg_hi:[0,1,0]
v_pk_add_f32 v[64:65], v[40:41], v[72:73] neg_lo:[0,1] neg_hi:[0,1]
v_pk_add_f32 v[40:41], v[40:41], v[72:73]
v_pk_mul_f32 v[72:73], v[64:65], s[62:63] op_sel:[0,0] op_sel_hi:[0,1] neg_lo:[0,1] neg_hi:[0,0]
v_pk_fma_f32 v[72:73], v[64:65], s[62:63], v[72:73] op_sel:[1,1,0] op_sel_hi:[1,0,1] neg_lo:[0,1,0] neg_hi:[0,1,0]
v_pk_add_f32 v[64:65], v[42:43], v[74:75] neg_lo:[0,1] neg_hi:[0,1]
v_pk_add_f32 v[42:43], v[42:43], v[74:75]
v_pk_mul_f32 v[74:75], v[64:65], s[58:59] op_sel:[0,0] op_sel_hi:[0,1] neg_lo:[0,1] neg_hi:[0,0]
v_pk_fma_f32 v[74:75], v[64:65], s[58:59], v[74:75] op_sel:[1,1,0] op_sel_hi:[1,0,1] neg_lo:[0,1,0] neg_hi:[0,1,0]
v_pk_add_f32 v[64:65], v[44:45], v[76:77] neg_lo:[0,1] neg_hi:[0,1]
v_pk_add_f32 v[44:45], v[44:45], v[76:77]
v_pk_mul_f32 v[76:77], v[64:65], s[54:55] op_sel:[0,0] op_sel_hi:[0,1] neg_lo:[0,1] neg_hi:[0,0]
v_pk_fma_f32 v[76:77], v[64:65], s[54:55], v[76:77] op_sel:[1,1,0] op_sel_hi:[1,0,1] neg_lo:[0,1,0] neg_hi:[0,1,0]
v_pk_add_f32 v[64:65], v[46:47], v[78:79] neg_lo:[0,1] neg_hi:[0,1]
v_pk_add_f32 v[46:47], v[46:47], v[78:79]
v_pk_mul_f32 v[78:79], v[64:65], s[50:51] op_sel:[0,0] op_sel_hi:[0,1] neg_lo:[0,1] neg_hi:[0,0]
v_pk_fma_f32 v[78:79], v[64:65], s[50:51], v[78:79] op_sel:[1,1,0] op_sel_hi:[1,0,1] neg_lo:[0,1,0] neg_hi:[0,1,0]
v_pk_add_f32 v[64:65], v[16:17], v[32:33] neg_lo:[0,1] neg_hi:[0,1]
v_pk_add_f32 v[16:17], v[16:17], v[32:33]
v_pk_add_f32 v[32:33], v[18:19], v[34:35] neg_lo:[0,1] neg_hi:[0,1]
v_pk_add_f32 v[18:19], v[18:19], v[34:35]
v_pk_mul_f32 v[34:35], v[32:33], s[54:55] op_sel:[0,0] op_sel_hi:[0,1] neg_lo:[0,0] neg_hi:[0,0]
v_pk_fma_f32 v[34:35], v[32:33], s[54:55], v[34:35] op_sel:[1,1,0] op_sel_hi:[1,0,1] neg_lo:[0,1,0] neg_hi:[0,0,0]
v_pk_add_f32 v[32:33], v[20:21], v[36:37] neg_lo:[0,1] neg_hi:[0,1]
v_pk_add_f32 v[20:21], v[20:21], v[36:37]
v_pk_mul_f32 v[36:37], v[32:33], s[62:63] op_sel:[0,0] op_sel_hi:[0,1] neg_lo:[0,0] neg_hi:[0,0]
v_pk_fma_f32 v[36:37], v[32:33], s[62:63], v[36:37] op_sel:[1,1,0] op_sel_hi:[1,0,1] neg_lo:[0,1,0] neg_hi:[0,0,0]
v_pk_add_f32 v[32:33], v[22:23], v[38:39] neg_lo:[0,1] neg_hi:[0,1]
v_pk_add_f32 v[22:23], v[22:23], v[38:39]
v_pk_mul_f32 v[38:39], v[32:33], s[54:55] op_sel:[0,1] op_sel_hi:[0,0] neg_lo:[0,0] neg_hi:[0,0]
v_pk_fma_f32 v[38:39], v[32:33], s[54:55], v[38:39] op_sel:[1,0,0] op_sel_hi:[1,1,1] neg_lo:[0,1,0] neg_hi:[0,0,0]
v_pk_add_f32 v[32:33], v[24:25], v[40:41] op_sel:[1,1] op_sel_hi:[0,0] neg_lo:[1,0] neg_hi:[0,1]
v_pk_add_f32 v[24:25], v[24:25], v[40:41]
v_pk_add_f32 v[40:41], v[26:27], v[42:43] neg_lo:[0,1] neg_hi:[0,1]
v_pk_add_f32 v[26:27], v[26:27], v[42:43]
v_pk_mul_f32 v[42:43], v[40:41], s[54:55] op_sel:[0,1] op_sel_hi:[0,0] neg_lo:[0,1] neg_hi:[0,0]
v_pk_fma_f32 v[42:43], v[40:41], s[54:55], v[42:43] op_sel:[1,0,0] op_sel_hi:[1,1,1] neg_lo:[0,1,0] neg_hi:[0,1,0]
v_pk_add_f32 v[40:41], v[28:29], v[44:45] neg_lo:[0,1] neg_hi:[0,1]
v_pk_add_f32 v[28:29], v[28:29], v[44:45]
v_pk_mul_f32 v[44:45], v[40:41], s[62:63] op_sel:[0,0] op_sel_hi:[0,1] neg_lo:[0,1] neg_hi:[0,0]
v_pk_fma_f32 v[44:45], v[40:41], s[62:63], v[44:45] op_sel:[1,1,0] op_sel_hi:[1,0,1] neg_lo:[0,1,0] neg_hi:[0,1,0]
v_pk_add_f32 v[40:41], v[30:31], v[46:47] neg_lo:[0,1] neg_hi:[0,1]
v_pk_add_f32 v[30:31], v[30:31], v[46:47]
v_pk_mul_f32 v[46:47], v[40:41], s[54:55] op_sel:[0,0] op_sel_hi:[0,1] neg_lo:[0,1] neg_hi:[0,0]
v_pk_fma_f32 v[46:47], v[40:41], s[54:55], v[46:47] op_sel:[1,1,0] op_sel_hi:[1,0,1] neg_lo:[0,1,0] neg_hi:[0,1,0]
v_pk_add_f32 v[40:41], v[14:15], v[48:49] neg_lo:[0,1] neg_hi:[0,1]
v_pk_add_f32 v[14:15], v[14:15], v[48:49]
v_pk_add_f32 v[48:49], v[50:51], v[66:67] neg_lo:[0,1] neg_hi:[0,1]
v_pk_add_f32 v[50:51], v[50:51], v[66:67]
v_pk_mul_f32 v[66:67], v[48:49], s[54:55] op_sel:[0,0] op_sel_hi:[0,1] neg_lo:[0,0] neg_hi:[0,0]
v_pk_fma_f32 v[66:67], v[48:49], s[54:55], v[66:67] op_sel:[1,1,0] op_sel_hi:[1,0,1] neg_lo:[0,1,0] neg_hi:[0,0,0]
v_pk_add_f32 v[48:49], v[52:53], v[68:69] neg_lo:[0,1] neg_hi:[0,1]
v_pk_add_f32 v[52:53], v[52:53], v[68:69]
v_pk_mul_f32 v[68:69], v[48:49], s[62:63] op_sel:[0,0] op_sel_hi:[0,1] neg_lo:[0,0] neg_hi:[0,0]
v_pk_fma_f32 v[68:69], v[48:49], s[62:63], v[68:69] op_sel:[1,1,0] op_sel_hi:[1,0,1] neg_lo:[0,1,0] neg_hi:[0,0,0]
v_pk_add_f32 v[48:49], v[54:55], v[70:71] neg_lo:[0,1] neg_hi:[0,1]
v_pk_add_f32 v[54:55], v[54:55], v[70:71]
v_pk_mul_f32 v[70:71], v[48:49], s[54:55] op_sel:[0,1] op_sel_hi:[0,0] neg_lo:[0,0] neg_hi:[0,0]
v_pk_fma_f32 v[70:71], v[48:49], s[54:55], v[70:71] op_sel:[1,0,0] op_sel_hi:[1,1,1] neg_lo:[0,1,0] neg_hi:[0,0,0]
v_pk_add_f32 v[48:49], v[56:57], v[72:73] op_sel:[1,1] op_sel_hi:[0,0] neg_lo:[1,0] neg_hi:[0,1]
v_pk_add_f32 v[56:57], v[56:57], v[72:73]
v_pk_add_f32 v[72:73], v[58:59], v[74:75] neg_lo:[0,1] neg_hi:[0,1]
v_pk_add_f32 v[58:59], v[58:59], v[74:75]
v_pk_mul_f32 v[74:75], v[72:73], s[54:55] op_sel:[0,1] op_sel_hi:[0,0] neg_lo:[0,1] neg_hi:[0,0]
v_pk_fma_f32 v[74:75], v[72:73], s[54:55], v[74:75] op_sel:[1,0,0] op_sel_hi:[1,1,1] neg_lo:[0,1,0] neg_hi:[0,1,0]
v_pk_add_f32 v[72:73], v[60:61], v[76:77] neg_lo:[0,1] neg_hi:[0,1]
v_pk_add_f32 v[60:61], v[60:61], v[76:77]
v_pk_mul_f32 v[76:77], v[72:73], s[62:63] op_sel:[0,0] op_sel_hi:[0,1] neg_lo:[0,1] neg_hi:[0,0]
v_pk_fma_f32 v[76:77], v[72:73], s[62:63], v[76:77] op_sel:[1,1,0] op_sel_hi:[1,0,1] neg_lo:[0,1,0] neg_hi:[0,1,0]
v_pk_add_f32 v[72:73], v[62:63], v[78:79] neg_lo:[0,1] neg_hi:[0,1]
v_pk_add_f32 v[62:63], v[62:63], v[78:79]
v_pk_mul_f32 v[78:79], v[72:73], s[54:55] op_sel:[0,0] op_sel_hi:[0,1] neg_lo:[0,1] neg_hi:[0,0]
v_pk_fma_f32 v[78:79], v[72:73], s[54:55], v[78:79] op_sel:[1,1,0] op_sel_hi:[1,0,1] neg_lo:[0,1,0] neg_hi:[0,1,0]
v_pk_add_f32 v[72:73], v[16:17], v[24:25] neg_lo:[0,1] neg_hi:[0,1]
v_pk_add_f32 v[16:17], v[16:17], v[24:25]
v_pk_add_f32 v[24:25], v[18:19], v[26:27] neg_lo:[0,1] neg_hi:[0,1]
v_pk_add_f32 v[18:19], v[18:19], v[26:27]
v_pk_mul_f32 v[26:27], v[24:25], s[62:63] op_sel:[0,0] op_sel_hi:[0,1] neg_lo:[0,0] neg_hi:[0,0]
v_pk_fma_f32 v[26:27], v[24:25], s[62:63], v[26:27] op_sel:[1,1,0] op_sel_hi:[1,0,1] neg_lo:[0,1,0] neg_hi:[0,0,0]
v_pk_add_f32 v[24:25], v[20:21], v[28:29] op_sel:[1,1] op_sel_hi:[0,0] neg_lo:[1,0] neg_hi:[0,1]
v_pk_add_f32 v[20:21], v[20:21], v[28:29]
v_pk_add_f32 v[28:29], v[22:23], v[30:31] neg_lo:[0,1] neg_hi:[0,1]
v_pk_add_f32 v[22:23], v[22:23], v[30:31]
v_pk_mul_f32 v[30:31], v[28:29], s[62:63] op_sel:[0,0] op_sel_hi:[0,1] neg_lo:[0,1] neg_hi:[0,0]
v_pk_fma_f32 v[30:31], v[28:29], s[62:63], v[30:31] op_sel:[1,1,0] op_sel_hi:[1,0,1] neg_lo:[0,1,0] neg_hi:[0,1,0]
v_pk_add_f32 v[28:29], v[64:65], v[32:33] neg_lo:[0,1] neg_hi:[0,1]
v_pk_add_f32 v[64:65], v[64:65], v[32:33]
v_pk_add_f32 v[32:33], v[34:35], v[42:43] neg_lo:[0,1] neg_hi:[0,1]
v_pk_add_f32 v[34:35], v[34:35], v[42:43]
v_pk_mul_f32 v[42:43], v[32:33], s[62:63] op_sel:[0,0] op_sel_hi:[0,1] neg_lo:[0,0] neg_hi:[0,0]
v_pk_fma_f32 v[42:43], v[32:33], s[62:63], v[42:43] op_sel:[1,1,0] op_sel_hi:[1,0,1] neg_lo:[0,1,0] neg_hi:[0,0,0]
v_pk_add_f32 v[32:33], v[36:37], v[44:45] op_sel:[1,1] op_sel_hi:[0,0] neg_lo:[1,0] neg_hi:[0,1]
v_pk_add_f32 v[36:37], v[36:37], v[44:45]
v_pk_add_f32 v[44:45], v[38:39], v[46:47] neg_lo:[0,1] neg_hi:[0,1]
v_pk_add_f32 v[38:39], v[38:39], v[46:47]
v_pk_mul_f32 v[46:47], v[44:45], s[62:63] op_sel:[0,0] op_sel_hi:[0,1] neg_lo:[0,1] neg_hi:[0,0]
v_pk_fma_f32 v[46:47], v[44:45], s[62:63], v[46:47] op_sel:[1,1,0] op_sel_hi:[1,0,1] neg_lo:[0,1,0] neg_hi:[0,1,0]
v_pk_add_f32 v[44:45], v[14:15], v[56:57] neg_lo:[0,1] neg_hi:[0,1]
v_pk_add_f32 v[14:15], v[14:15], v[56:57]
v_pk_add_f32 v[56:57], v[50:51], v[58:59] neg_lo:[0,1] neg_hi:[0,1]
v_pk_add_f32 v[50:51], v[50:51], v[58:59]
v_pk_mul_f32 v[58:59], v[56:57], s[62:63] op_sel:[0,0] op_sel_hi:[0,1] neg_lo:[0,0] neg_hi:[0,0]
v_pk_fma_f32 v[58:59], v[56:57], s[62:63], v[58:59] op_sel:[1,1,0] op_sel_hi:[1,0,1] neg_lo:[0,1,0] neg_hi:[0,0,0]
v_pk_add_f32 v[56:57], v[52:53], v[60:61] op_sel:[1,1] op_sel_hi:[0,0] neg_lo:[1,0] neg_hi:[0,1]
v_pk_add_f32 v[52:53], v[52:53], v[60:61]
v_pk_add_f32 v[60:61], v[54:55], v[62:63] neg_lo:[0,1] neg_hi:[0,1]
v_pk_add_f32 v[54:55], v[54:55], v[62:63]
v_pk_mul_f32 v[62:63], v[60:61], s[62:63] op_sel:[0,0] op_sel_hi:[0,1] neg_lo:[0,1] neg_hi:[0,0]
v_pk_fma_f32 v[62:63], v[60:61], s[62:63], v[62:63] op_sel:[1,1,0] op_sel_hi:[1,0,1] neg_lo:[0,1,0] neg_hi:[0,1,0]
v_pk_add_f32 v[60:61], v[40:41], v[48:49] neg_lo:[0,1] neg_hi:[0,1]
v_pk_add_f32 v[40:41], v[40:41], v[48:49]
v_pk_add_f32 v[48:49], v[66:67], v[74:75] neg_lo:[0,1] neg_hi:[0,1]
v_pk_add_f32 v[66:67], v[66:67], v[74:75]
v_pk_mul_f32 v[74:75], v[48:49], s[62:63] op_sel:[0,0] op_sel_hi:[0,1] neg_lo:[0,0] neg_hi:[0,0]
v_pk_fma_f32 v[74:75], v[48:49], s[62:63], v[74:75] op_sel:[1,1,0] op_sel_hi:[1,0,1] neg_lo:[0,1,0] neg_hi:[0,0,0]
v_pk_add_f32 v[48:49], v[68:69], v[76:77] op_sel:[1,1] op_sel_hi:[0,0] neg_lo:[1,0] neg_hi:[0,1]
v_pk_add_f32 v[68:69], v[68:69], v[76:77]
v_pk_add_f32 v[76:77], v[70:71], v[78:79] neg_lo:[0,1] neg_hi:[0,1]
v_pk_add_f32 v[70:71], v[70:71], v[78:79]
v_pk_mul_f32 v[78:79], v[76:77], s[62:63] op_sel:[0,0] op_sel_hi:[0,1] neg_lo:[0,1] neg_hi:[0,0]
v_pk_fma_f32 v[78:79], v[76:77], s[62:63], v[78:79] op_sel:[1,1,0] op_sel_hi:[1,0,1] neg_lo:[0,1,0] neg_hi:[0,1,0]
v_pk_add_f32 v[76:77], v[16:17], v[20:21] neg_lo:[0,1] neg_hi:[0,1]
v_pk_add_f32 v[16:17], v[16:17], v[20:21]
v_pk_add_f32 v[20:21], v[18:19], v[22:23] op_sel:[1,1] op_sel_hi:[0,0] neg_lo:[1,0] neg_hi:[0,1]
v_pk_add_f32 v[18:19], v[18:19], v[22:23]
v_pk_add_f32 v[22:23], v[72:73], v[24:25] neg_lo:[0,1] neg_hi:[0,1]
v_pk_add_f32 v[72:73], v[72:73], v[24:25]
v_pk_add_f32 v[24:25], v[26:27], v[30:31] op_sel:[1,1] op_sel_hi:[0,0] neg_lo:[1,0] neg_hi:[0,1]
v_pk_add_f32 v[26:27], v[26:27], v[30:31]
v_pk_add_f32 v[30:31], v[64:65], v[36:37] neg_lo:[0,1] neg_hi:[0,1]
v_pk_add_f32 v[64:65], v[64:65], v[36:37]
v_pk_add_f32 v[36:37], v[34:35], v[38:39] op_sel:[1,1] op_sel_hi:[0,0] neg_lo:[1,0] neg_hi:[0,1]
v_pk_add_f32 v[34:35], v[34:35], v[38:39]
v_pk_add_f32 v[38:39], v[28:29], v[32:33] neg_lo:[0,1] neg_hi:[0,1]
v_pk_add_f32 v[28:29], v[28:29], v[32:33]
v_pk_add_f32 v[32:33], v[42:43], v[46:47] op_sel:[1,1] op_sel_hi:[0,0] neg_lo:[1,0] neg_hi:[0,1]
v_pk_add_f32 v[42:43], v[42:43], v[46:47]
v_pk_add_f32 v[46:47], v[14:15], v[52:53] neg_lo:[0,1] neg_hi:[0,1]
v_pk_add_f32 v[14:15], v[14:15], v[52:53]
v_pk_add_f32 v[52:53], v[50:51], v[54:55] op_sel:[1,1] op_sel_hi:[0,0] neg_lo:[1,0] neg_hi:[0,1]
v_pk_add_f32 v[50:51], v[50:51], v[54:55]
v_pk_add_f32 v[54:55], v[44:45], v[56:57] neg_lo:[0,1] neg_hi:[0,1]
v_pk_add_f32 v[44:45], v[44:45], v[56:57]
v_pk_add_f32 v[56:57], v[58:59], v[62:63] op_sel:[1,1] op_sel_hi:[0,0] neg_lo:[1,0] neg_hi:[0,1]
v_pk_add_f32 v[58:59], v[58:59], v[62:63]
v_pk_add_f32 v[62:63], v[40:41], v[68:69] neg_lo:[0,1] neg_hi:[0,1]
v_pk_add_f32 v[40:41], v[40:41], v[68:69]
v_pk_add_f32 v[68:69], v[66:67], v[70:71] op_sel:[1,1] op_sel_hi:[0,0] neg_lo:[1,0] neg_hi:[0,1]
v_pk_add_f32 v[66:67], v[66:67], v[70:71]
v_pk_add_f32 v[70:71], v[60:61], v[48:49] neg_lo:[0,1] neg_hi:[0,1]
v_pk_add_f32 v[60:61], v[60:61], v[48:49]
v_pk_add_f32 v[48:49], v[74:75], v[78:79] op_sel:[1,1] op_sel_hi:[0,0] neg_lo:[1,0] neg_hi:[0,1]
v_pk_add_f32 v[74:75], v[74:75], v[78:79]
v_pk_add_f32 v[78:79], v[16:17], v[18:19] neg_lo:[0,1] neg_hi:[0,1]
v_pk_add_f32 v[16:17], v[16:17], v[18:19]
v_pk_add_f32 v[18:19], v[76:77], v[20:21] neg_lo:[0,1] neg_hi:[0,1]
v_pk_add_f32 v[76:77], v[76:77], v[20:21]
v_pk_add_f32 v[20:21], v[72:73], v[26:27] neg_lo:[0,1] neg_hi:[0,1]
v_pk_add_f32 v[72:73], v[72:73], v[26:27]
v_pk_add_f32 v[26:27], v[22:23], v[24:25] neg_lo:[0,1] neg_hi:[0,1]
v_pk_add_f32 v[22:23], v[22:23], v[24:25]
v_pk_add_f32 v[24:25], v[64:65], v[34:35] neg_lo:[0,1] neg_hi:[0,1]
v_pk_add_f32 v[64:65], v[64:65], v[34:35]
v_pk_add_f32 v[34:35], v[30:31], v[36:37] neg_lo:[0,1] neg_hi:[0,1]
v_pk_add_f32 v[30:31], v[30:31], v[36:37]
v_pk_add_f32 v[36:37], v[28:29], v[42:43] neg_lo:[0,1] neg_hi:[0,1]
v_pk_add_f32 v[28:29], v[28:29], v[42:43]
v_pk_add_f32 v[42:43], v[38:39], v[32:33] neg_lo:[0,1] neg_hi:[0,1]
v_pk_add_f32 v[38:39], v[38:39], v[32:33]
v_pk_add_f32 v[32:33], v[14:15], v[50:51] neg_lo:[0,1] neg_hi:[0,1]
v_pk_add_f32 v[14:15], v[14:15], v[50:51]
v_pk_add_f32 v[50:51], v[46:47], v[52:53] neg_lo:[0,1] neg_hi:[0,1]
v_pk_add_f32 v[46:47], v[46:47], v[52:53]
v_pk_add_f32 v[52:53], v[44:45], v[58:59] neg_lo:[0,1] neg_hi:[0,1]
v_pk_add_f32 v[44:45], v[44:45], v[58:59]
v_pk_add_f32 v[58:59], v[54:55], v[56:57] neg_lo:[0,1] neg_hi:[0,1]
v_pk_add_f32 v[54:55], v[54:55], v[56:57]
v_pk_add_f32 v[56:57], v[40:41], v[66:67] neg_lo:[0,1] neg_hi:[0,1]
v_pk_add_f32 v[40:41], v[40:41], v[66:67]
v_pk_add_f32 v[66:67], v[62:63], v[68:69] neg_lo:[0,1] neg_hi:[0,1]
v_pk_add_f32 v[62:63], v[62:63], v[68:69]
v_pk_add_f32 v[68:69], v[60:61], v[74:75] neg_lo:[0,1] neg_hi:[0,1]
v_pk_add_f32 v[60:61], v[60:61], v[74:75]
v_pk_add_f32 v[74:75], v[70:71], v[48:49] neg_lo:[0,1] neg_hi:[0,1]
v_pk_add_f32 v[70:71], v[70:71], v[48:49]
s_lshl_b32 s12, s38, 2
s_add_u32 s12, s12, s16
s_min_u32 s12, s12, 512
s_lshr_b32 s23, s12, 6
s_xnor_b32 s23, s23, s98
s_and_b32 s23, s23, 1
s_lshl_b32 s23, s23, 13
s_mul_i32 s12, s12, 32768
s_add_u32 s12, s12, 113246208
s_add_u32 s12, s12, s23
buffer_store_dwordx2 v[16:17], v5, s[84:87], s12 offen offset:0 sc1
buffer_store_dwordx2 v[14:15], v5, s[84:87], s12 offen offset:512 sc1
buffer_store_dwordx2 v[64:65], v5, s[84:87], s12 offen offset:1024 sc1
buffer_store_dwordx2 v[40:41], v5, s[84:87], s12 offen offset:1536 sc1
buffer_store_dwordx2 v[72:73], v5, s[84:87], s12 offen offset:2048 sc1
buffer_store_dwordx2 v[44:45], v5, s[84:87], s12 offen offset:2560 sc1
buffer_store_dwordx2 v[28:29], v5, s[84:87], s12 offen offset:3072 sc1
buffer_store_dwordx2 v[60:61], v5, s[84:87], s12 offen offset:3584 sc1
s_add_u32 s12, s12, 4096
buffer_store_dwordx2 v[76:77], v5, s[84:87], s12 offen offset:0 sc1
buffer_store_dwordx2 v[46:47], v5, s[84:87], s12 offen offset:512 sc1
buffer_store_dwordx2 v[30:31], v5, s[84:87], s12 offen offset:1024 sc1
buffer_store_dwordx2 v[62:63], v5, s[84:87], s12 offen offset:1536 sc1
buffer_store_dwordx2 v[22:23], v5, s[84:87], s12 offen offset:2048 sc1
buffer_store_dwordx2 v[54:55], v5, s[84:87], s12 offen offset:2560 sc1
buffer_store_dwordx2 v[38:39], v5, s[84:87], s12 offen offset:3072 sc1
buffer_store_dwordx2 v[70:71], v5, s[84:87], s12 offen offset:3584 sc1
s_add_u32 s12, s12, 12288
buffer_store_dwordx2 v[78:79], v5, s[84:87], s12 offen offset:0 sc1
buffer_store_dwordx2 v[32:33], v5, s[84:87], s12 offen offset:512 sc1
buffer_store_dwordx2 v[24:25], v5, s[84:87], s12 offen offset:1024 sc1
buffer_store_dwordx2 v[56:57], v5, s[84:87], s12 offen offset:1536 sc1
buffer_store_dwordx2 v[20:21], v5, s[84:87], s12 offen offset:2048 sc1
buffer_store_dwordx2 v[52:53], v5, s[84:87], s12 offen offset:2560 sc1
buffer_store_dwordx2 v[36:37], v5, s[84:87], s12 offen offset:3072 sc1
buffer_store_dwordx2 v[68:69], v5, s[84:87], s12 offen offset:3584 sc1
s_add_u32 s12, s12, 4096
buffer_store_dwordx2 v[18:19], v5, s[84:87], s12 offen offset:0 sc1
buffer_store_dwordx2 v[50:51], v5, s[84:87], s12 offen offset:512 sc1
buffer_store_dwordx2 v[34:35], v5, s[84:87], s12 offen offset:1024 sc1
buffer_store_dwordx2 v[66:67], v5, s[84:87], s12 offen offset:1536 sc1
buffer_store_dwordx2 v[26:27], v5, s[84:87], s12 offen offset:2048 sc1
buffer_store_dwordx2 v[58:59], v5, s[84:87], s12 offen offset:2560 sc1
buffer_store_dwordx2 v[42:43], v5, s[84:87], s12 offen offset:3072 sc1
buffer_store_dwordx2 v[74:75], v5, s[84:87], s12 offen offset:3584 sc1
s_add_u32 s12, s12, 4096
s_mov_b32 s38, s21
s_cmp_lt_u32 s38, s37
s_cbranch_scc1 mega_kernel_f2_l
mega_kernel_f2_e:
mega_kernel_f2e:
s_waitcnt vmcnt(0)
s_barrier
v_mov_b32 v1, 0
v_mov_b32 v2, 1
s_mov_b32 s82, 69259392
v_cmp_eq_u32 vcc, 0, v0
s_and_saveexec_b64 s[80:81], vcc
s_cbranch_execz mega_kernel_sg1
buffer_atomic_add v2, v1, s[84:87], s82 offen sc1
mega_kernel_sg1:
s_mov_b64 exec, s[80:81]
s_mov_b32 s64, 0
s_mov_b32 s65, 58
s_lshl_b32 s66, s40, 13
s_add_u32 s66, s66, 67633152
s_mov_b32 s67, 0
s_mov_b32 s68, 0
s_cmp_eq_u32 s91, 3
s_cbranch_scc1 mega_kernel_out
s_cmp_lt_u32 s92, 1
s_cbranch_scc1 mega_kernel_back
s_mov_b32 s68, 1
s_branch mega_kernel_out
mega_kernel_back:
s_lshl_b32 s68, s68, 1
s_mov_b32 s93, s92
s_load_dwordx2 s[4:5], s[0:1], 80
s_mov_b32 s48, 0x3f7ec46d
s_mov_b32 s49, 0x3dc8bd36
s_mov_b32 s50, 0x3f7b14be
s_mov_b32 s51, 0x3e47c5c2
s_mov_b32 s52, 0x3f74fa0b
s_mov_b32 s53, 0x3e94a031
s_mov_b32 s54, 0x3f6c835e
s_mov_b32 s55, 0x3ec3ef15
s_mov_b32 s56, 0x3f61c598
s_mov_b32 s57, 0x3ef15aea
s_mov_b32 s58, 0x3f54db31
s_mov_b32 s59, 0x3f0e39da
s_mov_b32 s60, 0x3f45e403
s_mov_b32 s61, 0x3f226799
s_mov_b32 s62, 0x3f3504f3
s_mov_b32 s63, 0x3f3504f3
v_and_b32 v1, 31, v0
v_lshrrev_b32 v2, 5, v0
v_cvt_f32_u32 v3, v1
v_mul_u32_u24 v10, 8448, v2
v_lshl_add_u32 v4, v1, 3, v10
v_mul_u32_u24 v5, 264, v1
v_add_u32 v5, v5, v10
v_and_b32 v11, 7, v0
v_lshrrev_b32 v9, 3, v0
v_mul_u32_u24 v10, 8448, v11
v_lshl_add_u32 v6, v9, 3, v10
v_lshlrev_b32 v7, 3, v9
v_sub_u32 v7, v10, v7
v_add_u32 v7, 4096, v7
v_mul_u32_u24 v8, 32768, v9
v_lshl_add_u32 v8, v11, 4, v8
v_mul_f32 v12, 0x3a800000, v3
v_cos_f32 v82, v12
v_sin_f32 v83, v12
v_mul_f32 v12, 0x3b000000, v3
v_cos_f32 v84, v12
v_sin_f32 v85, v12
v_mul_f32 v12, 0x3b400000, v3
v_cos_f32 v86, v12
v_sin_f32 v87, v12
v_mul_f32 v12, 0x3b800000, v3
v_cos_f32 v88, v12
v_sin_f32 v89, v12
v_mul_f32 v12, 0x3ba00000, v3
v_cos_f32 v90, v12
v_sin_f32 v91, v12
v_mul_f32 v12, 0x3bc00000, v3
v_cos_f32 v92, v12
v_sin_f32 v93, v12
v_mul_f32 v12, 0x3be00000, v3
v_cos_f32 v94, v12
v_sin_f32 v95, v12
v_mul_f32 v12, 0x3c000000, v3
v_cos_f32 v96, v12
v_sin_f32 v97, v12
v_mul_f32 v12, 0x3c100000, v3
v_cos_f32 v98, v12
v_sin_f32 v99, v12
v_mul_f32 v12, 0x3c200000, v3
v_cos_f32 v100, v12
v_sin_f32 v101, v12
v_mul_f32 v12, 0x3c300000, v3
v_cos_f32 v102, v12
v_sin_f32 v103, v12
v_mul_f32 v12, 0x3c400000, v3
v_cos_f32 v104, v12
v_sin_f32 v105, v12
v_mul_f32 v12, 0x3c500000, v3
v_cos_f32 v106, v12
v_sin_f32 v107, v12
v_mul_f32 v12, 0x3c600000, v3
v_cos_f32 v108, v12
v_sin_f32 v109, v12
v_mul_f32 v12, 0x3c700000, v3
v_cos_f32 v110, v12
v_sin_f32 v111, v12
v_mul_f32 v12, 0x3c800000, v3
v_cos_f32 v112, v12
v_sin_f32 v113, v12
v_mul_f32 v12, 0x3c880000, v3
v_cos_f32 v114, v12
v_sin_f32 v115, v12
v_mul_f32 v12, 0x3c900000, v3
v_cos_f32 v116, v12
v_sin_f32 v117, v12
v_mul_f32 v12, 0x3c980000, v3
v_cos_f32 v118, v12
v_sin_f32 v119, v12
v_mul_f32 v12, 0x3ca00000, v3
v_cos_f32 v120, v12
v_sin_f32 v121, v12
v_mul_f32 v12, 0x3ca80000, v3
v_cos_f32 v122, v12
v_sin_f32 v123, v12
v_mul_f32 v12, 0x3cb00000, v3
v_cos_f32 v124, v12
v_sin_f32 v125, v12
v_mul_f32 v12, 0x3cb80000, v3
v_cos_f32 v126, v12
v_sin_f32 v127, v12
v_mul_f32 v12, 0x3cc00000, v3
v_cos_f32 v128, v12
v_sin_f32 v129, v12
v_mul_f32 v12, 0x3cc80000, v3
v_cos_f32 v130, v12
v_sin_f32 v131, v12
v_mul_f32 v12, 0x3cd00000, v3
v_cos_f32 v132, v12
v_sin_f32 v133, v12
v_mul_f32 v12, 0x3cd80000, v3
v_cos_f32 v134, v12
v_sin_f32 v135, v12
v_mul_f32 v12, 0x3ce00000, v3
v_cos_f32 v136, v12
v_sin_f32 v137, v12
v_mul_f32 v12, 0x3ce80000, v3
v_cos_f32 v138, v12
v_sin_f32 v139, v12
v_mul_f32 v12, 0x3cf00000, v3
v_cos_f32 v140, v12
v_sin_f32 v141, v12
v_mul_f32 v12, 0x3cf80000, v3
v_cos_f32 v142, v12
v_sin_f32 v143, v12
v_lshlrev_b32 v12, 2, v1
v_sub_u32 v12, v4, v12
v_and_b32 v10, 127, v0
v_lshrrev_b32 v11, 7, v0
v_lshlrev_b32 v2, 5, v10
v_lshl_add_u32 v2, v11, 12, v2
v_lshlrev_b32 v3, 4, v10
v_lshl_add_u32 v3, v11, 12, v3
v_add_u32 v3, 2048, v3
v_cmp_eq_u32 s[14:15], 0, v9
s_waitcnt lgkmcnt(0)
s_mov_b32 s6, 8388608
s_mov_b32 s7, 0x00020000
v_mov_b32 v250, 0
s_mov_b32 s82, 69259392
mega_kernel_w1:
s_sleep 8
buffer_load_dword v251, v250, s[84:87], s82 offen sc1
s_waitcnt vmcnt(0)
v_cmp_ne_u32 vcc, 95, v251
s_cbranch_vccnz mega_kernel_w1
s_cmp_lt_u32 s93, 128
s_cbranch_scc0 mega_kernel_f3_e
s_lshl_b32 s12, s93, 7
s_and_b32 s23, s12, 0x2000
s_add_u32 s12, s12, s23
s_xor_b32 s23, s98, 1
s_lshl_b32 s23, s23, 13
s_add_u32 s12, s12, s23
s_add_u32 s12, s12, 113246208
buffer_load_dwordx4 v[144:147], v8, s[84:87], s12 offen sc1
s_add_u32 s12, s12, 1048576
buffer_load_dwordx4 v[148:151], v8, s[84:87], s12 offen sc1
s_add_u32 s12, s12, 1048576
s_xor_b32 s12, s12, 0x2000
buffer_load_dwordx4 v[152:155], v8, s[84:87], s12 offen sc1
s_add_u32 s12, s12, 1048576
buffer_load_dwordx4 v[156:159], v8, s[84:87], s12 offen sc1
s_add_u32 s12, s12, 1048576
s_xor_b32 s12, s12, 0x2000
buffer_load_dwordx4 v[160:163], v8, s[84:87], s12 offen sc1
s_add_u32 s12, s12, 1048576
buffer_load_dwordx4 v[164:167], v8, s[84:87], s12 offen sc1
s_add_u32 s12, s12, 1048576
s_xor_b32 s12, s12, 0x2000
buffer_load_dwordx4 v[168:171], v8, s[84:87], s12 offen sc1
s_add_u32 s12, s12, 1048576
buffer_load_dwordx4 v[172:175], v8, s[84:87], s12 offen sc1
s_add_u32 s12, s12, 1048576
s_xor_b32 s12, s12, 0x2000
buffer_load_dwordx4 v[176:179], v8, s[84:87], s12 offen sc1
s_add_u32 s12, s12, 1048576
buffer_load_dwordx4 v[180:183], v8, s[84:87], s12 offen sc1
s_add_u32 s12, s12, 1048576
s_xor_b32 s12, s12, 0x2000
buffer_load_dwordx4 v[184:187], v8, s[84:87], s12 offen sc1
s_add_u32 s12, s12, 1048576
buffer_load_dwordx4 v[188:191], v8, s[84:87], s12 offen sc1
s_add_u32 s12, s12, 1048576
s_xor_b32 s12, s12, 0x2000
buffer_load_dwordx4 v[192:195], v8, s[84:87], s12 offen sc1
s_add_u32 s12, s12, 1048576
buffer_load_dwordx4 v[196:199], v8, s[84:87], s12 offen sc1
s_add_u32 s12, s12, 1048576
s_xor_b32 s12, s12, 0x2000
buffer_load_dwordx4 v[200:203], v8, s[84:87], s12 offen sc1
s_add_u32 s12, s12, 1048576
buffer_load_dwordx4 v[204:207], v8, s[84:87], s12 offen sc1
s_add_u32 s12, s12, 1048576
s_xor_b32 s12, s12, 0x2000
buffer_load_dwordx4 v[208:211], v8, s[84:87], s12 offen sc1
s_add_u32 s12, s12, 1048576
s_waitcnt vmcnt(0)
mega_kernel_f3_l:
s_add_u32 s21, s93, 64
s_cmp_lt_u32 s21, 128
s_cselect_b32 s22, s21, s93
s_waitcnt vmcnt(8)
s_barrier
v_cndmask_b32 v145, v145, 0, s[14:15]
v_cndmask_b32 v147, v147, 0, s[14:15]
v_cndmask_b32 v209, v209, 0, s[14:15]
v_cndmask_b32 v211, v211, 0, s[14:15]
v_pk_add_f32 v[16:17], v[144:145], v[146:147] op_sel:[0,1] op_sel_hi:[1,0] neg_lo:[0,1]
v_pk_add_f32 v[18:19], v[144:145], v[146:147] op_sel:[0,1] op_sel_hi:[1,0] neg_hi:[1,0]
ds_write_b64 v6, v[16:17] offset:0
ds_write_b64 v7, v[18:19] offset:4096
v_pk_add_f32 v[20:21], v[148:149], v[150:151] op_sel:[0,1] op_sel_hi:[1,0] neg_lo:[0,1]
v_pk_add_f32 v[22:23], v[148:149], v[150:151] op_sel:[0,1] op_sel_hi:[1,0] neg_hi:[1,0]
ds_write_b64 v6, v[20:21] offset:256
ds_write_b64 v7, v[22:23] offset:3840
v_pk_add_f32 v[24:25], v[152:153], v[154:155] op_sel:[0,1] op_sel_hi:[1,0] neg_lo:[0,1]
v_pk_add_f32 v[26:27], v[152:153], v[154:155] op_sel:[0,1] op_sel_hi:[1,0] neg_hi:[1,0]
ds_write_b64 v6, v[24:25] offset:512
ds_write_b64 v7, v[26:27] offset:3584
v_pk_add_f32 v[28:29], v[156:157], v[158:159] op_sel:[0,1] op_sel_hi:[1,0] neg_lo:[0,1]
v_pk_add_f32 v[30:31], v[156:157], v[158:159] op_sel:[0,1] op_sel_hi:[1,0] neg_hi:[1,0]
ds_write_b64 v6, v[28:29] offset:768
ds_write_b64 v7, v[30:31] offset:3328
v_pk_add_f32 v[32:33], v[160:161], v[162:163] op_sel:[0,1] op_sel_hi:[1,0] neg_lo:[0,1]
v_pk_add_f32 v[34:35], v[160:161], v[162:163] op_sel:[0,1] op_sel_hi:[1,0] neg_hi:[1,0]
ds_write_b64 v6, v[32:33] offset:1024
ds_write_b64 v7, v[34:35] offset:3072
v_pk_add_f32 v[36:37], v[164:165], v[166:167] op_sel:[0,1] op_sel_hi:[1,0] neg_lo:[0,1]
v_pk_add_f32 v[38:39], v[164:165], v[166:167] op_sel:[0,1] op_sel_hi:[1,0] neg_hi:[1,0]
ds_write_b64 v6, v[36:37] offset:1280
ds_write_b64 v7, v[38:39] offset:2816
v_pk_add_f32 v[40:41], v[168:169], v[170:171] op_sel:[0,1] op_sel_hi:[1,0] neg_lo:[0,1]
v_pk_add_f32 v[42:43], v[168:169], v[170:171] op_sel:[0,1] op_sel_hi:[1,0] neg_hi:[1,0]
ds_write_b64 v6, v[40:41] offset:1536
ds_write_b64 v7, v[42:43] offset:2560
v_pk_add_f32 v[44:45], v[172:173], v[174:175] op_sel:[0,1] op_sel_hi:[1,0] neg_lo:[0,1]
v_pk_add_f32 v[46:47], v[172:173], v[174:175] op_sel:[0,1] op_sel_hi:[1,0] neg_hi:[1,0]
ds_write_b64 v6, v[44:45] offset:1792
ds_write_b64 v7, v[46:47] offset:2304
v_pk_add_f32 v[48:49], v[176:177], v[178:179] op_sel:[0,1] op_sel_hi:[1,0] neg_lo:[0,1]
v_pk_add_f32 v[50:51], v[176:177], v[178:179] op_sel:[0,1] op_sel_hi:[1,0] neg_hi:[1,0]
ds_write_b64 v6, v[48:49] offset:2048
ds_write_b64 v7, v[50:51] offset:2048
v_pk_add_f32 v[52:53], v[180:181], v[182:183] op_sel:[0,1] op_sel_hi:[1,0] neg_lo:[0,1]
v_pk_add_f32 v[54:55], v[180:181], v[182:183] op_sel:[0,1] op_sel_hi:[1,0] neg_hi:[1,0]
ds_write_b64 v6, v[52:53] offset:2304
ds_write_b64 v7, v[54:55] offset:1792
v_pk_add_f32 v[56:57], v[184:185], v[186:187] op_sel:[0,1] op_sel_hi:[1,0] neg_lo:[0,1]
v_pk_add_f32 v[58:59], v[184:185], v[186:187] op_sel:[0,1] op_sel_hi:[1,0] neg_hi:[1,0]
ds_write_b64 v6, v[56:57] offset:2560
ds_write_b64 v7, v[58:59] offset:1536
v_pk_add_f32 v[60:61], v[188:189], v[190:191] op_sel:[0,1] op_sel_hi:[1,0] neg_lo:[0,1]
v_pk_add_f32 v[62:63], v[188:189], v[190:191] op_sel:[0,1] op_sel_hi:[1,0] neg_hi:[1,0]
ds_write_b64 v6, v[60:61] offset:2816
ds_write_b64 v7, v[62:63] offset:1280
v_pk_add_f32 v[64:65], v[192:193], v[194:195] op_sel:[0,1] op_sel_hi:[1,0] neg_lo:[0,1]
v_pk_add_f32 v[66:67], v[192:193], v[194:195] op_sel:[0,1] op_sel_hi:[1,0] neg_hi:[1,0]
ds_write_b64 v6, v[64:65] offset:3072
ds_write_b64 v7, v[66:67] offset:1024
v_pk_add_f32 v[68:69], v[196:197], v[198:199] op_sel:[0,1] op_sel_hi:[1,0] neg_lo:[0,1]
v_pk_add_f32 v[70:71], v[196:197], v[198:199] op_sel:[0,1] op_sel_hi:[1,0] neg_hi:[1,0]
ds_write_b64 v6, v[68:69] offset:3328
ds_write_b64 v7, v[70:71] offset:768
v_pk_add_f32 v[72:73], v[200:201], v[202:203] op_sel:[0,1] op_sel_hi:[1,0] neg_lo:[0,1]
v_pk_add_f32 v[74:75], v[200:201], v[202:203] op_sel:[0,1] op_sel_hi:[1,0] neg_hi:[1,0]
ds_write_b64 v6, v[72:73] offset:3584
ds_write_b64 v7, v[74:75] offset:512
s_waitcnt lgkmcnt(8)
v_pk_add_f32 v[76:77], v[204:205], v[206:207] op_sel:[0,1] op_sel_hi:[1,0] neg_lo:[0,1]
v_pk_add_f32 v[78:79], v[204:205], v[206:207] op_sel:[0,1] op_sel_hi:[1,0] neg_hi:[1,0]
ds_write_b64 v6, v[76:77] offset:3840
ds_write_b64 v7, v[78:79] offset:256
v_pk_add_f32 v[16:17], v[208:209], v[210:211] op_sel:[0,1] op_sel_hi:[1,0] neg_lo:[0,1]
v_pk_add_f32 v[18:19], v[208:209], v[210:211] op_sel:[0,1] op_sel_hi:[1,0] neg_hi:[1,0]
s_mov_b64 exec, s[14:15]
ds_write_b64 v6, v[16:17] offset:4096
s_mov_b64 exec, -1
s_lshl_b32 s12, s22, 7
s_and_b32 s23, s12, 0x2000
s_add_u32 s12, s12, s23
s_xor_b32 s23, s98, 1
s_lshl_b32 s23, s23, 13
s_add_u32 s12, s12, s23
s_add_u32 s12, s12, 113246208
buffer_load_dwordx4 v[144:147], v8, s[84:87], s12 offen sc1
s_add_u32 s12, s12, 1048576
buffer_load_dwordx4 v[148:151], v8, s[84:87], s12 offen sc1
s_add_u32 s12, s12, 1048576
s_xor_b32 s12, s12, 0x2000
buffer_load_dwordx4 v[152:155], v8, s[84:87], s12 offen sc1
s_add_u32 s12, s12, 1048576
buffer_load_dwordx4 v[156:159], v8, s[84:87], s12 offen sc1
s_add_u32 s12, s12, 1048576
s_xor_b32 s12, s12, 0x2000
buffer_load_dwordx4 v[160:163], v8, s[84:87], s12 offen sc1
s_add_u32 s12, s12, 1048576
buffer_load_dwordx4 v[164:167], v8, s[84:87], s12 offen sc1
s_add_u32 s12, s12, 1048576
s_xor_b32 s12, s12, 0x2000
buffer_load_dwordx4 v[168:171], v8, s[84:87], s12 offen sc1
s_add_u32 s12, s12, 1048576
buffer_load_dwordx4 v[172:175], v8, s[84:87], s12 offen sc1
s_add_u32 s12, s12, 1048576
s_xor_b32 s12, s12, 0x2000
buffer_load_dwordx4 v[176:179], v8, s[84:87], s12 offen sc1
s_add_u32 s12, s12, 1048576
buffer_load_dwordx4 v[180:183], v8, s[84:87], s12 offen sc1
s_add_u32 s12, s12, 1048576
s_xor_b32 s12, s12, 0x2000
buffer_load_dwordx4 v[184:187], v8, s[84:87], s12 offen sc1
s_add_u32 s12, s12, 1048576
buffer_load_dwordx4 v[188:191], v8, s[84:87], s12 offen sc1
s_add_u32 s12, s12, 1048576
s_xor_b32 s12, s12, 0x2000
buffer_load_dwordx4 v[192:195], v8, s[84:87], s12 offen sc1
s_add_u32 s12, s12, 1048576
buffer_load_dwordx4 v[196:199], v8, s[84:87], s12 offen sc1
s_add_u32 s12, s12, 1048576
s_xor_b32 s12, s12, 0x2000
buffer_load_dwordx4 v[200:203], v8, s[84:87], s12 offen sc1
s_add_u32 s12, s12, 1048576
buffer_load_dwordx4 v[204:207], v8, s[84:87], s12 offen sc1
s_add_u32 s12, s12, 1048576
s_xor_b32 s12, s12, 0x2000
buffer_load_dwordx4 v[208:211], v8, s[84:87], s12 offen sc1
s_add_u32 s12, s12, 1048576
s_waitcnt lgkmcnt(0)
s_barrier
ds_read_b64 v[16:17], v4 offset:0
ds_read_b64 v[48:49], v4 offset:4096
ds_read_b64 v[18:19], v4 offset:256
ds_read_b64 v[50:51], v4 offset:4352
ds_read_b64 v[20:21], v4 offset:512
ds_read_b64 v[52:53], v4 offset:4608
ds_read_b64 v[22:23], v4 offset:768
ds_read_b64 v[54:55], v4 offset:4864
ds_read_b64 v[24:25], v4 offset:1024
ds_read_b64 v[56:57], v4 offset:5120
ds_read_b64 v[26:27], v4 offset:1280
ds_read_b64 v[58:59], v4 offset:5376
ds_read_b64 v[28:29], v4 offset:1536
ds_read_b64 v[60:61], v4 offset:5632
ds_read_b64 v[30:31], v4 offset:1792
ds_read_b64 v[62:63], v4 offset:5888
ds_read_b64 v[32:33], v4 offset:2048
ds_read_b64 v[64:65], v4 offset:6144
ds_read_b64 v[34:35], v4 offset:2304
ds_read_b64 v[66:67], v4 offset:6400
ds_read_b64 v[36:37], v4 offset:2560
ds_read_b64 v[68:69], v4 offset:6656
ds_read_b64 v[38:39], v4 offset:2816
ds_read_b64 v[70:71], v4 offset:6912
ds_read_b64 v[40:41], v4 offset:3072
ds_read_b64 v[72:73], v4 offset:7168
ds_read_b64 v[42:43], v4 offset:3328
ds_read_b64 v[74:75], v4 offset:7424
ds_read_b64 v[44:45], v4 offset:3584
ds_read_b64 v[76:77], v4 offset:7680
ds_read_b64 v[46:47], v4 offset:3840
ds_read_b64 v[78:79], v4 offset:7936
s_waitcnt lgkmcnt(0)
v_pk_add_f32 v[14:15], v[16:17], v[48:49] neg_lo:[0,1] neg_hi:[0,1]
v_pk_add_f32 v[16:17], v[16:17], v[48:49]
v_pk_add_f32 v[48:49], v[18:19], v[50:51] neg_lo:[0,1] neg_hi:[0,1]
v_pk_add_f32 v[18:19], v[18:19], v[50:51]
v_pk_mul_f32 v[50:51], v[48:49], s[50:51] op_sel:[0,0] op_sel_hi:[0,1] neg_lo:[0,0] neg_hi:[0,0]
v_pk_fma_f32 v[50:51], v[48:49], s[50:51], v[50:51] op_sel:[1,1,0] op_sel_hi:[1,0,1] neg_lo:[0,1,0] neg_hi:[0,0,0]
v_pk_add_f32 v[48:49], v[20:21], v[52:53] neg_lo:[0,1] neg_hi:[0,1]
v_pk_add_f32 v[20:21], v[20:21], v[52:53]
v_pk_mul_f32 v[52:53], v[48:49], s[54:55] op_sel:[0,0] op_sel_hi:[0,1] neg_lo:[0,0] neg_hi:[0,0]
v_pk_fma_f32 v[52:53], v[48:49], s[54:55], v[52:53] op_sel:[1,1,0] op_sel_hi:[1,0,1] neg_lo:[0,1,0] neg_hi:[0,0,0]
v_pk_add_f32 v[48:49], v[22:23], v[54:55] neg_lo:[0,1] neg_hi:[0,1]
v_pk_add_f32 v[22:23], v[22:23], v[54:55]
v_pk_mul_f32 v[54:55], v[48:49], s[58:59] op_sel:[0,0] op_sel_hi:[0,1] neg_lo:[0,0] neg_hi:[0,0]
v_pk_fma_f32 v[54:55], v[48:49], s[58:59], v[54:55] op_sel:[1,1,0] op_sel_hi:[1,0,1] neg_lo:[0,1,0] neg_hi:[0,0,0]
v_pk_add_f32 v[48:49], v[24:25], v[56:57] neg_lo:[0,1] neg_hi:[0,1]
v_pk_add_f32 v[24:25], v[24:25], v[56:57]
v_pk_mul_f32 v[56:57], v[48:49], s[62:63] op_sel:[0,0] op_sel_hi:[0,1] neg_lo:[0,0] neg_hi:[0,0]
v_pk_fma_f32 v[56:57], v[48:49], s[62:63], v[56:57] op_sel:[1,1,0] op_sel_hi:[1,0,1] neg_lo:[0,1,0] neg_hi:[0,0,0]
v_pk_add_f32 v[48:49], v[26:27], v[58:59] neg_lo:[0,1] neg_hi:[0,1]
v_pk_add_f32 v[26:27], v[26:27], v[58:59]
v_pk_mul_f32 v[58:59], v[48:49], s[58:59] op_sel:[0,1] op_sel_hi:[0,0] neg_lo:[0,0] neg_hi:[0,0]
v_pk_fma_f32 v[58:59], v[48:49], s[58:59], v[58:59] op_sel:[1,0,0] op_sel_hi:[1,1,1] neg_lo:[0,1,0] neg_hi:[0,0,0]
v_pk_add_f32 v[48:49], v[28:29], v[60:61] neg_lo:[0,1] neg_hi:[0,1]
v_pk_add_f32 v[28:29], v[28:29], v[60:61]
v_pk_mul_f32 v[60:61], v[48:49], s[54:55] op_sel:[0,1] op_sel_hi:[0,0] neg_lo:[0,0] neg_hi:[0,0]
v_pk_fma_f32 v[60:61], v[48:49], s[54:55], v[60:61] op_sel:[1,0,0] op_sel_hi:[1,1,1] neg_lo:[0,1,0] neg_hi:[0,0,0]
v_pk_add_f32 v[48:49], v[30:31], v[62:63] neg_lo:[0,1] neg_hi:[0,1]
v_pk_add_f32 v[30:31], v[30:31], v[62:63]
v_pk_mul_f32 v[62:63], v[48:49], s[50:51] op_sel:[0,1] op_sel_hi:[0,0] neg_lo:[0,0] neg_hi:[0,0]
v_pk_fma_f32 v[62:63], v[48:49], s[50:51], v[62:63] op_sel:[1,0,0] op_sel_hi:[1,1,1] neg_lo:[0,1,0] neg_hi:[0,0,0]
v_pk_add_f32 v[48:49], v[32:33], v[64:65] op_sel:[1,1] op_sel_hi:[0,0] neg_lo:[1,0] neg_hi:[0,1]
v_pk_add_f32 v[32:33], v[32:33], v[64:65]
v_pk_add_f32 v[64:65], v[34:35], v[66:67] neg_lo:[0,1] neg_hi:[0,1]
v_pk_add_f32 v[34:35], v[34:35], v[66:67]
v_pk_mul_f32 v[66:67], v[64:65], s[50:51] op_sel:[0,1] op_sel_hi:[0,0] neg_lo:[0,1] neg_hi:[0,0]
v_pk_fma_f32 v[66:67], v[64:65], s[50:51], v[66:67] op_sel:[1,0,0] op_sel_hi:[1,1,1] neg_lo:[0,1,0] neg_hi:[0,1,0]
v_pk_add_f32 v[64:65], v[36:37], v[68:69] neg_lo:[0,1] neg_hi:[0,1]
v_pk_add_f32 v[36:37], v[36:37], v[68:69]
v_pk_mul_f32 v[68:69], v[64:65], s[54:55] op_sel:[0,1] op_sel_hi:[0,0] neg_lo:[0,1] neg_hi:[0,0]
v_pk_fma_f32 v[68:69], v[64:65], s[54:55], v[68:69] op_sel:[1,0,0] op_sel_hi:[1,1,1] neg_lo:[0,1,0] neg_hi:[0,1,0]
v_pk_add_f32 v[64:65], v[38:39], v[70:71] neg_lo:[0,1] neg_hi:[0,1]
v_pk_add_f32 v[38:39], v[38:39], v[70:71]
v_pk_mul_f32 v[70:71], v[64:65], s[58:59] op_sel:[0,1] op_sel_hi:[0,0] neg_lo:[0,1] neg_hi:[0,0]
v_pk_fma_f32 v[70:71], v[64:65], s[58:59], v[70:71] op_sel:[1,0,0] op_sel_hi:[1,1,1] neg_lo:[0,1,0] neg_hi:[0,1,0]
v_pk_add_f32 v[64:65], v[40:41], v[72:73] neg_lo:[0,1] neg_hi:[0,1]
v_pk_add_f32 v[40:41], v[40:41], v[72:73]
v_pk_mul_f32 v[72:73], v[64:65], s[62:63] op_sel:[0,0] op_sel_hi:[0,1] neg_lo:[0,1] neg_hi:[0,0]
v_pk_fma_f32 v[72:73], v[64:65], s[62:63], v[72:73] op_sel:[1,1,0] op_sel_hi:[1,0,1] neg_lo:[0,1,0] neg_hi:[0,1,0]
v_pk_add_f32 v[64:65], v[42:43], v[74:75] neg_lo:[0,1] neg_hi:[0,1]
v_pk_add_f32 v[42:43], v[42:43], v[74:75]
v_pk_mul_f32 v[74:75], v[64:65], s[58:59] op_sel:[0,0] op_sel_hi:[0,1] neg_lo:[0,1] neg_hi:[0,0]
v_pk_fma_f32 v[74:75], v[64:65], s[58:59], v[74:75] op_sel:[1,1,0] op_sel_hi:[1,0,1] neg_lo:[0,1,0] neg_hi:[0,1,0]
v_pk_add_f32 v[64:65], v[44:45], v[76:77] neg_lo:[0,1] neg_hi:[0,1]
v_pk_add_f32 v[44:45], v[44:45], v[76:77]
v_pk_mul_f32 v[76:77], v[64:65], s[54:55] op_sel:[0,0] op_sel_hi:[0,1] neg_lo:[0,1] neg_hi:[0,0]
v_pk_fma_f32 v[76:77], v[64:65], s[54:55], v[76:77] op_sel:[1,1,0] op_sel_hi:[1,0,1] neg_lo:[0,1,0] neg_hi:[0,1,0]
v_pk_add_f32 v[64:65], v[46:47], v[78:79] neg_lo:[0,1] neg_hi:[0,1]
v_pk_add_f32 v[46:47], v[46:47], v[78:79]
v_pk_mul_f32 v[78:79], v[64:65], s[50:51] op_sel:[0,0] op_sel_hi:[0,1] neg_lo:[0,1] neg_hi:[0,0]
v_pk_fma_f32 v[78:79], v[64:65], s[50:51], v[78:79] op_sel:[1,1,0] op_sel_hi:[1,0,1] neg_lo:[0,1,0] neg_hi:[0,1,0]
v_pk_add_f32 v[64:65], v[16:17], v[32:33] neg_lo:[0,1] neg_hi:[0,1]
v_pk_add_f32 v[16:17], v[16:17], v[32:33]
v_pk_add_f32 v[32:33], v[18:19], v[34:35] neg_lo:[0,1] neg_hi:[0,1]
v_pk_add_f32 v[18:19], v[18:19], v[34:35]
v_pk_mul_f32 v[34:35], v[32:33], s[54:55] op_sel:[0,0] op_sel_hi:[0,1] neg_lo:[0,0] neg_hi:[0,0]
v_pk_fma_f32 v[34:35], v[32:33], s[54:55], v[34:35] op_sel:[1,1,0] op_sel_hi:[1,0,1] neg_lo:[0,1,0] neg_hi:[0,0,0]
v_pk_add_f32 v[32:33], v[20:21], v[36:37] neg_lo:[0,1] neg_hi:[0,1]
v_pk_add_f32 v[20:21], v[20:21], v[36:37]
v_pk_mul_f32 v[36:37], v[32:33], s[62:63] op_sel:[0,0] op_sel_hi:[0,1] neg_lo:[0,0] neg_hi:[0,0]
v_pk_fma_f32 v[36:37], v[32:33], s[62:63], v[36:37] op_sel:[1,1,0] op_sel_hi:[1,0,1] neg_lo:[0,1,0] neg_hi:[0,0,0]
v_pk_add_f32 v[32:33], v[22:23], v[38:39] neg_lo:[0,1] neg_hi:[0,1]
v_pk_add_f32 v[22:23], v[22:23], v[38:39]
v_pk_mul_f32 v[38:39], v[32:33], s[54:55] op_sel:[0,1] op_sel_hi:[0,0] neg_lo:[0,0] neg_hi:[0,0]
v_pk_fma_f32 v[38:39], v[32:33], s[54:55], v[38:39] op_sel:[1,0,0] op_sel_hi:[1,1,1] neg_lo:[0,1,0] neg_hi:[0,0,0]
v_pk_add_f32 v[32:33], v[24:25], v[40:41] op_sel:[1,1] op_sel_hi:[0,0] neg_lo:[1,0] neg_hi:[0,1]
v_pk_add_f32 v[24:25], v[24:25], v[40:41]
v_pk_add_f32 v[40:41], v[26:27], v[42:43] neg_lo:[0,1] neg_hi:[0,1]
v_pk_add_f32 v[26:27], v[26:27], v[42:43]
v_pk_mul_f32 v[42:43], v[40:41], s[54:55] op_sel:[0,1] op_sel_hi:[0,0] neg_lo:[0,1] neg_hi:[0,0]
v_pk_fma_f32 v[42:43], v[40:41], s[54:55], v[42:43] op_sel:[1,0,0] op_sel_hi:[1,1,1] neg_lo:[0,1,0] neg_hi:[0,1,0]
v_pk_add_f32 v[40:41], v[28:29], v[44:45] neg_lo:[0,1] neg_hi:[0,1]
v_pk_add_f32 v[28:29], v[28:29], v[44:45]
v_pk_mul_f32 v[44:45], v[40:41], s[62:63] op_sel:[0,0] op_sel_hi:[0,1] neg_lo:[0,1] neg_hi:[0,0]
v_pk_fma_f32 v[44:45], v[40:41], s[62:63], v[44:45] op_sel:[1,1,0] op_sel_hi:[1,0,1] neg_lo:[0,1,0] neg_hi:[0,1,0]
v_pk_add_f32 v[40:41], v[30:31], v[46:47] neg_lo:[0,1] neg_hi:[0,1]
v_pk_add_f32 v[30:31], v[30:31], v[46:47]
v_pk_mul_f32 v[46:47], v[40:41], s[54:55] op_sel:[0,0] op_sel_hi:[0,1] neg_lo:[0,1] neg_hi:[0,0]
v_pk_fma_f32 v[46:47], v[40:41], s[54:55], v[46:47] op_sel:[1,1,0] op_sel_hi:[1,0,1] neg_lo:[0,1,0] neg_hi:[0,1,0]
v_pk_add_f32 v[40:41], v[14:15], v[48:49] neg_lo:[0,1] neg_hi:[0,1]
v_pk_add_f32 v[14:15], v[14:15], v[48:49]
v_pk_add_f32 v[48:49], v[50:51], v[66:67] neg_lo:[0,1] neg_hi:[0,1]
v_pk_add_f32 v[50:51], v[50:51], v[66:67]
v_pk_mul_f32 v[66:67], v[48:49], s[54:55] op_sel:[0,0] op_sel_hi:[0,1] neg_lo:[0,0] neg_hi:[0,0]
v_pk_fma_f32 v[66:67], v[48:49], s[54:55], v[66:67] op_sel:[1,1,0] op_sel_hi:[1,0,1] neg_lo:[0,1,0] neg_hi:[0,0,0]
v_pk_add_f32 v[48:49], v[52:53], v[68:69] neg_lo:[0,1] neg_hi:[0,1]
v_pk_add_f32 v[52:53], v[52:53], v[68:69]
v_pk_mul_f32 v[68:69], v[48:49], s[62:63] op_sel:[0,0] op_sel_hi:[0,1] neg_lo:[0,0] neg_hi:[0,0]
v_pk_fma_f32 v[68:69], v[48:49], s[62:63], v[68:69] op_sel:[1,1,0] op_sel_hi:[1,0,1] neg_lo:[0,1,0] neg_hi:[0,0,0]
v_pk_add_f32 v[48:49], v[54:55], v[70:71] neg_lo:[0,1] neg_hi:[0,1]
v_pk_add_f32 v[54:55], v[54:55], v[70:71]
v_pk_mul_f32 v[70:71], v[48:49], s[54:55] op_sel:[0,1] op_sel_hi:[0,0] neg_lo:[0,0] neg_hi:[0,0]
v_pk_fma_f32 v[70:71], v[48:49], s[54:55], v[70:71] op_sel:[1,0,0] op_sel_hi:[1,1,1] neg_lo:[0,1,0] neg_hi:[0,0,0]
v_pk_add_f32 v[48:49], v[56:57], v[72:73] op_sel:[1,1] op_sel_hi:[0,0] neg_lo:[1,0] neg_hi:[0,1]
v_pk_add_f32 v[56:57], v[56:57], v[72:73]
v_pk_add_f32 v[72:73], v[58:59], v[74:75] neg_lo:[0,1] neg_hi:[0,1]
v_pk_add_f32 v[58:59], v[58:59], v[74:75]
v_pk_mul_f32 v[74:75], v[72:73], s[54:55] op_sel:[0,1] op_sel_hi:[0,0] neg_lo:[0,1] neg_hi:[0,0]
v_pk_fma_f32 v[74:75], v[72:73], s[54:55], v[74:75] op_sel:[1,0,0] op_sel_hi:[1,1,1] neg_lo:[0,1,0] neg_hi:[0,1,0]
v_pk_add_f32 v[72:73], v[60:61], v[76:77] neg_lo:[0,1] neg_hi:[0,1]
v_pk_add_f32 v[60:61], v[60:61], v[76:77]
v_pk_mul_f32 v[76:77], v[72:73], s[62:63] op_sel:[0,0] op_sel_hi:[0,1] neg_lo:[0,1] neg_hi:[0,0]
v_pk_fma_f32 v[76:77], v[72:73], s[62:63], v[76:77] op_sel:[1,1,0] op_sel_hi:[1,0,1] neg_lo:[0,1,0] neg_hi:[0,1,0]
v_pk_add_f32 v[72:73], v[62:63], v[78:79] neg_lo:[0,1] neg_hi:[0,1]
v_pk_add_f32 v[62:63], v[62:63], v[78:79]
v_pk_mul_f32 v[78:79], v[72:73], s[54:55] op_sel:[0,0] op_sel_hi:[0,1] neg_lo:[0,1] neg_hi:[0,0]
v_pk_fma_f32 v[78:79], v[72:73], s[54:55], v[78:79] op_sel:[1,1,0] op_sel_hi:[1,0,1] neg_lo:[0,1,0] neg_hi:[0,1,0]
v_pk_add_f32 v[72:73], v[16:17], v[24:25] neg_lo:[0,1] neg_hi:[0,1]
v_pk_add_f32 v[16:17], v[16:17], v[24:25]
v_pk_add_f32 v[24:25], v[18:19], v[26:27] neg_lo:[0,1] neg_hi:[0,1]
v_pk_add_f32 v[18:19], v[18:19], v[26:27]
v_pk_mul_f32 v[26:27], v[24:25], s[62:63] op_sel:[0,0] op_sel_hi:[0,1] neg_lo:[0,0] neg_hi:[0,0]
v_pk_fma_f32 v[26:27], v[24:25], s[62:63], v[26:27] op_sel:[1,1,0] op_sel_hi:[1,0,1] neg_lo:[0,1,0] neg_hi:[0,0,0]
v_pk_add_f32 v[24:25], v[20:21], v[28:29] op_sel:[1,1] op_sel_hi:[0,0] neg_lo:[1,0] neg_hi:[0,1]
v_pk_add_f32 v[20:21], v[20:21], v[28:29]
v_pk_add_f32 v[28:29], v[22:23], v[30:31] neg_lo:[0,1] neg_hi:[0,1]
v_pk_add_f32 v[22:23], v[22:23], v[30:31]
v_pk_mul_f32 v[30:31], v[28:29], s[62:63] op_sel:[0,0] op_sel_hi:[0,1] neg_lo:[0,1] neg_hi:[0,0]
v_pk_fma_f32 v[30:31], v[28:29], s[62:63], v[30:31] op_sel:[1,1,0] op_sel_hi:[1,0,1] neg_lo:[0,1,0] neg_hi:[0,1,0]
v_pk_add_f32 v[28:29], v[64:65], v[32:33] neg_lo:[0,1] neg_hi:[0,1]
v_pk_add_f32 v[64:65], v[64:65], v[32:33]
v_pk_add_f32 v[32:33], v[34:35], v[42:43] neg_lo:[0,1] neg_hi:[0,1]
v_pk_add_f32 v[34:35], v[34:35], v[42:43]
v_pk_mul_f32 v[42:43], v[32:33], s[62:63] op_sel:[0,0] op_sel_hi:[0,1] neg_lo:[0,0] neg_hi:[0,0]
v_pk_fma_f32 v[42:43], v[32:33], s[62:63], v[42:43] op_sel:[1,1,0] op_sel_hi:[1,0,1] neg_lo:[0,1,0] neg_hi:[0,0,0]
v_pk_add_f32 v[32:33], v[36:37], v[44:45] op_sel:[1,1] op_sel_hi:[0,0] neg_lo:[1,0] neg_hi:[0,1]
v_pk_add_f32 v[36:37], v[36:37], v[44:45]
v_pk_add_f32 v[44:45], v[38:39], v[46:47] neg_lo:[0,1] neg_hi:[0,1]
v_pk_add_f32 v[38:39], v[38:39], v[46:47]
v_pk_mul_f32 v[46:47], v[44:45], s[62:63] op_sel:[0,0] op_sel_hi:[0,1] neg_lo:[0,1] neg_hi:[0,0]
v_pk_fma_f32 v[46:47], v[44:45], s[62:63], v[46:47] op_sel:[1,1,0] op_sel_hi:[1,0,1] neg_lo:[0,1,0] neg_hi:[0,1,0]
v_pk_add_f32 v[44:45], v[14:15], v[56:57] neg_lo:[0,1] neg_hi:[0,1]
v_pk_add_f32 v[14:15], v[14:15], v[56:57]
v_pk_add_f32 v[56:57], v[50:51], v[58:59] neg_lo:[0,1] neg_hi:[0,1]
v_pk_add_f32 v[50:51], v[50:51], v[58:59]
v_pk_mul_f32 v[58:59], v[56:57], s[62:63] op_sel:[0,0] op_sel_hi:[0,1] neg_lo:[0,0] neg_hi:[0,0]
v_pk_fma_f32 v[58:59], v[56:57], s[62:63], v[58:59] op_sel:[1,1,0] op_sel_hi:[1,0,1] neg_lo:[0,1,0] neg_hi:[0,0,0]
v_pk_add_f32 v[56:57], v[52:53], v[60:61] op_sel:[1,1] op_sel_hi:[0,0] neg_lo:[1,0] neg_hi:[0,1]
v_pk_add_f32 v[52:53], v[52:53], v[60:61]
v_pk_add_f32 v[60:61], v[54:55], v[62:63] neg_lo:[0,1] neg_hi:[0,1]
v_pk_add_f32 v[54:55], v[54:55], v[62:63]
v_pk_mul_f32 v[62:63], v[60:61], s[62:63] op_sel:[0,0] op_sel_hi:[0,1] neg_lo:[0,1] neg_hi:[0,0]
v_pk_fma_f32 v[62:63], v[60:61], s[62:63], v[62:63] op_sel:[1,1,0] op_sel_hi:[1,0,1] neg_lo:[0,1,0] neg_hi:[0,1,0]
v_pk_add_f32 v[60:61], v[40:41], v[48:49] neg_lo:[0,1] neg_hi:[0,1]
v_pk_add_f32 v[40:41], v[40:41], v[48:49]
v_pk_add_f32 v[48:49], v[66:67], v[74:75] neg_lo:[0,1] neg_hi:[0,1]
v_pk_add_f32 v[66:67], v[66:67], v[74:75]
v_pk_mul_f32 v[74:75], v[48:49], s[62:63] op_sel:[0,0] op_sel_hi:[0,1] neg_lo:[0,0] neg_hi:[0,0]
v_pk_fma_f32 v[74:75], v[48:49], s[62:63], v[74:75] op_sel:[1,1,0] op_sel_hi:[1,0,1] neg_lo:[0,1,0] neg_hi:[0,0,0]
v_pk_add_f32 v[48:49], v[68:69], v[76:77] op_sel:[1,1] op_sel_hi:[0,0] neg_lo:[1,0] neg_hi:[0,1]
v_pk_add_f32 v[68:69], v[68:69], v[76:77]
v_pk_add_f32 v[76:77], v[70:71], v[78:79] neg_lo:[0,1] neg_hi:[0,1]
v_pk_add_f32 v[70:71], v[70:71], v[78:79]
v_pk_mul_f32 v[78:79], v[76:77], s[62:63] op_sel:[0,0] op_sel_hi:[0,1] neg_lo:[0,1] neg_hi:[0,0]
v_pk_fma_f32 v[78:79], v[76:77], s[62:63], v[78:79] op_sel:[1,1,0] op_sel_hi:[1,0,1] neg_lo:[0,1,0] neg_hi:[0,1,0]
v_pk_add_f32 v[76:77], v[16:17], v[20:21] neg_lo:[0,1] neg_hi:[0,1]
v_pk_add_f32 v[16:17], v[16:17], v[20:21]
v_pk_add_f32 v[20:21], v[18:19], v[22:23] op_sel:[1,1] op_sel_hi:[0,0] neg_lo:[1,0] neg_hi:[0,1]
v_pk_add_f32 v[18:19], v[18:19], v[22:23]
v_pk_add_f32 v[22:23], v[72:73], v[24:25] neg_lo:[0,1] neg_hi:[0,1]
v_pk_add_f32 v[72:73], v[72:73], v[24:25]
v_pk_add_f32 v[24:25], v[26:27], v[30:31] op_sel:[1,1] op_sel_hi:[0,0] neg_lo:[1,0] neg_hi:[0,1]
v_pk_add_f32 v[26:27], v[26:27], v[30:31]
v_pk_add_f32 v[30:31], v[64:65], v[36:37] neg_lo:[0,1] neg_hi:[0,1]
v_pk_add_f32 v[64:65], v[64:65], v[36:37]
v_pk_add_f32 v[36:37], v[34:35], v[38:39] op_sel:[1,1] op_sel_hi:[0,0] neg_lo:[1,0] neg_hi:[0,1]
v_pk_add_f32 v[34:35], v[34:35], v[38:39]
v_pk_add_f32 v[38:39], v[28:29], v[32:33] neg_lo:[0,1] neg_hi:[0,1]
v_pk_add_f32 v[28:29], v[28:29], v[32:33]
v_pk_add_f32 v[32:33], v[42:43], v[46:47] op_sel:[1,1] op_sel_hi:[0,0] neg_lo:[1,0] neg_hi:[0,1]
v_pk_add_f32 v[42:43], v[42:43], v[46:47]
v_pk_add_f32 v[46:47], v[14:15], v[52:53] neg_lo:[0,1] neg_hi:[0,1]
v_pk_add_f32 v[14:15], v[14:15], v[52:53]
v_pk_add_f32 v[52:53], v[50:51], v[54:55] op_sel:[1,1] op_sel_hi:[0,0] neg_lo:[1,0] neg_hi:[0,1]
v_pk_add_f32 v[50:51], v[50:51], v[54:55]
v_pk_add_f32 v[54:55], v[44:45], v[56:57] neg_lo:[0,1] neg_hi:[0,1]
v_pk_add_f32 v[44:45], v[44:45], v[56:57]
v_pk_add_f32 v[56:57], v[58:59], v[62:63] op_sel:[1,1] op_sel_hi:[0,0] neg_lo:[1,0] neg_hi:[0,1]
v_pk_add_f32 v[58:59], v[58:59], v[62:63]
v_pk_add_f32 v[62:63], v[40:41], v[68:69] neg_lo:[0,1] neg_hi:[0,1]
v_pk_add_f32 v[40:41], v[40:41], v[68:69]
v_pk_add_f32 v[68:69], v[66:67], v[70:71] op_sel:[1,1] op_sel_hi:[0,0] neg_lo:[1,0] neg_hi:[0,1]
v_pk_add_f32 v[66:67], v[66:67], v[70:71]
v_pk_add_f32 v[70:71], v[60:61], v[48:49] neg_lo:[0,1] neg_hi:[0,1]
v_pk_add_f32 v[60:61], v[60:61], v[48:49]
v_pk_add_f32 v[48:49], v[74:75], v[78:79] op_sel:[1,1] op_sel_hi:[0,0] neg_lo:[1,0] neg_hi:[0,1]
v_pk_add_f32 v[74:75], v[74:75], v[78:79]
v_pk_add_f32 v[78:79], v[16:17], v[18:19] neg_lo:[0,1] neg_hi:[0,1]
v_pk_add_f32 v[16:17], v[16:17], v[18:19]
v_pk_add_f32 v[18:19], v[76:77], v[20:21] neg_lo:[0,1] neg_hi:[0,1]
v_pk_add_f32 v[76:77], v[76:77], v[20:21]
v_pk_add_f32 v[20:21], v[72:73], v[26:27] neg_lo:[0,1] neg_hi:[0,1]
v_pk_add_f32 v[72:73], v[72:73], v[26:27]
v_pk_add_f32 v[26:27], v[22:23], v[24:25] neg_lo:[0,1] neg_hi:[0,1]
v_pk_add_f32 v[22:23], v[22:23], v[24:25]
v_pk_add_f32 v[24:25], v[64:65], v[34:35] neg_lo:[0,1] neg_hi:[0,1]
v_pk_add_f32 v[64:65], v[64:65], v[34:35]
v_pk_add_f32 v[34:35], v[30:31], v[36:37] neg_lo:[0,1] neg_hi:[0,1]
v_pk_add_f32 v[30:31], v[30:31], v[36:37]
v_pk_add_f32 v[36:37], v[28:29], v[42:43] neg_lo:[0,1] neg_hi:[0,1]
v_pk_add_f32 v[28:29], v[28:29], v[42:43]
v_pk_add_f32 v[42:43], v[38:39], v[32:33] neg_lo:[0,1] neg_hi:[0,1]
v_pk_add_f32 v[38:39], v[38:39], v[32:33]
v_pk_add_f32 v[32:33], v[14:15], v[50:51] neg_lo:[0,1] neg_hi:[0,1]
v_pk_add_f32 v[14:15], v[14:15], v[50:51]
v_pk_add_f32 v[50:51], v[46:47], v[52:53] neg_lo:[0,1] neg_hi:[0,1]
v_pk_add_f32 v[46:47], v[46:47], v[52:53]
v_pk_add_f32 v[52:53], v[44:45], v[58:59] neg_lo:[0,1] neg_hi:[0,1]
v_pk_add_f32 v[44:45], v[44:45], v[58:59]
v_pk_add_f32 v[58:59], v[54:55], v[56:57] neg_lo:[0,1] neg_hi:[0,1]
v_pk_add_f32 v[54:55], v[54:55], v[56:57]
v_pk_add_f32 v[56:57], v[40:41], v[66:67] neg_lo:[0,1] neg_hi:[0,1]
v_pk_add_f32 v[40:41], v[40:41], v[66:67]
v_pk_add_f32 v[66:67], v[62:63], v[68:69] neg_lo:[0,1] neg_hi:[0,1]
v_pk_add_f32 v[62:63], v[62:63], v[68:69]
v_pk_add_f32 v[68:69], v[60:61], v[74:75] neg_lo:[0,1] neg_hi:[0,1]
v_pk_add_f32 v[60:61], v[60:61], v[74:75]
v_pk_add_f32 v[74:75], v[70:71], v[48:49] neg_lo:[0,1] neg_hi:[0,1]
v_pk_add_f32 v[70:71], v[70:71], v[48:49]
v_pk_mul_f32 v[48:49], v[14:15], v[82:83] op_sel:[0,0] op_sel_hi:[0,1] neg_lo:[0,0] neg_hi:[0,0]
v_pk_fma_f32 v[14:15], v[14:15], v[82:83], v[48:49] op_sel:[1,1,0] op_sel_hi:[1,0,1] neg_lo:[0,1,0] neg_hi:[0,0,0]
v_pk_mul_f32 v[48:49], v[64:65], v[84:85] op_sel:[0,0] op_sel_hi:[0,1] neg_lo:[0,0] neg_hi:[0,0]
v_pk_fma_f32 v[64:65], v[64:65], v[84:85], v[48:49] op_sel:[1,1,0] op_sel_hi:[1,0,1] neg_lo:[0,1,0] neg_hi:[0,0,0]
v_pk_mul_f32 v[48:49], v[40:41], v[86:87] op_sel:[0,0] op_sel_hi:[0,1] neg_lo:[0,0] neg_hi:[0,0]
v_pk_fma_f32 v[40:41], v[40:41], v[86:87], v[48:49] op_sel:[1,1,0] op_sel_hi:[1,0,1] neg_lo:[0,1,0] neg_hi:[0,0,0]
v_pk_mul_f32 v[48:49], v[72:73], v[88:89] op_sel:[0,0] op_sel_hi:[0,1] neg_lo:[0,0] neg_hi:[0,0]
v_pk_fma_f32 v[72:73], v[72:73], v[88:89], v[48:49] op_sel:[1,1,0] op_sel_hi:[1,0,1] neg_lo:[0,1,0] neg_hi:[0,0,0]
v_pk_mul_f32 v[48:49], v[44:45], v[90:91] op_sel:[0,0] op_sel_hi:[0,1] neg_lo:[0,0] neg_hi:[0,0]
v_pk_fma_f32 v[44:45], v[44:45], v[90:91], v[48:49] op_sel:[1,1,0] op_sel_hi:[1,0,1] neg_lo:[0,1,0] neg_hi:[0,0,0]
v_pk_mul_f32 v[48:49], v[28:29], v[92:93] op_sel:[0,0] op_sel_hi:[0,1] neg_lo:[0,0] neg_hi:[0,0]
v_pk_fma_f32 v[28:29], v[28:29], v[92:93], v[48:49] op_sel:[1,1,0] op_sel_hi:[1,0,1] neg_lo:[0,1,0] neg_hi:[0,0,0]
v_pk_mul_f32 v[48:49], v[60:61], v[94:95] op_sel:[0,0] op_sel_hi:[0,1] neg_lo:[0,0] neg_hi:[0,0]
v_pk_fma_f32 v[60:61], v[60:61], v[94:95], v[48:49] op_sel:[1,1,0] op_sel_hi:[1,0,1] neg_lo:[0,1,0] neg_hi:[0,0,0]
v_pk_mul_f32 v[48:49], v[76:77], v[96:97] op_sel:[0,0] op_sel_hi:[0,1] neg_lo:[0,0] neg_hi:[0,0]
v_pk_fma_f32 v[76:77], v[76:77], v[96:97], v[48:49] op_sel:[1,1,0] op_sel_hi:[1,0,1] neg_lo:[0,1,0] neg_hi:[0,0,0]
v_pk_mul_f32 v[48:49], v[46:47], v[98:99] op_sel:[0,0] op_sel_hi:[0,1] neg_lo:[0,0] neg_hi:[0,0]
v_pk_fma_f32 v[46:47], v[46:47], v[98:99], v[48:49] op_sel:[1,1,0] op_sel_hi:[1,0,1] neg_lo:[0,1,0] neg_hi:[0,0,0]
v_pk_mul_f32 v[48:49], v[30:31], v[100:101] op_sel:[0,0] op_sel_hi:[0,1] neg_lo:[0,0] neg_hi:[0,0]
v_pk_fma_f32 v[30:31], v[30:31], v[100:101], v[48:49] op_sel:[1,1,0] op_sel_hi:[1,0,1] neg_lo:[0,1,0] neg_hi:[0,0,0]
v_pk_mul_f32 v[48:49], v[62:63], v[102:103] op_sel:[0,0] op_sel_hi:[0,1] neg_lo:[0,0] neg_hi:[0,0]
v_pk_fma_f32 v[62:63], v[62:63], v[102:103], v[48:49] op_sel:[1,1,0] op_sel_hi:[1,0,1] neg_lo:[0,1,0] neg_hi:[0,0,0]
v_pk_mul_f32 v[48:49], v[22:23], v[104:105] op_sel:[0,0] op_sel_hi:[0,1] neg_lo:[0,0] neg_hi:[0,0]
v_pk_fma_f32 v[22:23], v[22:23], v[104:105], v[48:49] op_sel:[1,1,0] op_sel_hi:[1,0,1] neg_lo:[0,1,0] neg_hi:[0,0,0]
v_pk_mul_f32 v[48:49], v[54:55], v[106:107] op_sel:[0,0] op_sel_hi:[0,1] neg_lo:[0,0] neg_hi:[0,0]
v_pk_fma_f32 v[54:55], v[54:55], v[106:107], v[48:49] op_sel:[1,1,0] op_sel_hi:[1,0,1] neg_lo:[0,1,0] neg_hi:[0,0,0]
v_pk_mul_f32 v[48:49], v[38:39], v[108:109] op_sel:[0,0] op_sel_hi:[0,1] neg_lo:[0,0] neg_hi:[0,0]
v_pk_fma_f32 v[38:39], v[38:39], v[108:109], v[48:49] op_sel:[1,1,0] op_sel_hi:[1,0,1] neg_lo:[0,1,0] neg_hi:[0,0,0]
v_pk_mul_f32 v[48:49], v[70:71], v[110:111] op_sel:[0,0] op_sel_hi:[0,1] neg_lo:[0,0] neg_hi:[0,0]
v_pk_fma_f32 v[70:71], v[70:71], v[110:111], v[48:49] op_sel:[1,1,0] op_sel_hi:[1,0,1] neg_lo:[0,1,0] neg_hi:[0,0,0]
v_pk_mul_f32 v[48:49], v[78:79], v[112:113] op_sel:[0,0] op_sel_hi:[0,1] neg_lo:[0,0] neg_hi:[0,0]
v_pk_fma_f32 v[78:79], v[78:79], v[112:113], v[48:49] op_sel:[1,1,0] op_sel_hi:[1,0,1] neg_lo:[0,1,0] neg_hi:[0,0,0]
v_pk_mul_f32 v[48:49], v[32:33], v[114:115] op_sel:[0,0] op_sel_hi:[0,1] neg_lo:[0,0] neg_hi:[0,0]
v_pk_fma_f32 v[32:33], v[32:33], v[114:115], v[48:49] op_sel:[1,1,0] op_sel_hi:[1,0,1] neg_lo:[0,1,0] neg_hi:[0,0,0]
v_pk_mul_f32 v[48:49], v[24:25], v[116:117] op_sel:[0,0] op_sel_hi:[0,1] neg_lo:[0,0] neg_hi:[0,0]
v_pk_fma_f32 v[24:25], v[24:25], v[116:117], v[48:49] op_sel:[1,1,0] op_sel_hi:[1,0,1] neg_lo:[0,1,0] neg_hi:[0,0,0]
v_pk_mul_f32 v[48:49], v[56:57], v[118:119] op_sel:[0,0] op_sel_hi:[0,1] neg_lo:[0,0] neg_hi:[0,0]
v_pk_fma_f32 v[56:57], v[56:57], v[118:119], v[48:49] op_sel:[1,1,0] op_sel_hi:[1,0,1] neg_lo:[0,1,0] neg_hi:[0,0,0]
v_pk_mul_f32 v[48:49], v[20:21], v[120:121] op_sel:[0,0] op_sel_hi:[0,1] neg_lo:[0,0] neg_hi:[0,0]
v_pk_fma_f32 v[20:21], v[20:21], v[120:121], v[48:49] op_sel:[1,1,0] op_sel_hi:[1,0,1] neg_lo:[0,1,0] neg_hi:[0,0,0]
v_pk_mul_f32 v[48:49], v[52:53], v[122:123] op_sel:[0,0] op_sel_hi:[0,1] neg_lo:[0,0] neg_hi:[0,0]
v_pk_fma_f32 v[52:53], v[52:53], v[122:123], v[48:49] op_sel:[1,1,0] op_sel_hi:[1,0,1] neg_lo:[0,1,0] neg_hi:[0,0,0]
v_pk_mul_f32 v[48:49], v[36:37], v[124:125] op_sel:[0,0] op_sel_hi:[0,1] neg_lo:[0,0] neg_hi:[0,0]
v_pk_fma_f32 v[36:37], v[36:37], v[124:125], v[48:49] op_sel:[1,1,0] op_sel_hi:[1,0,1] neg_lo:[0,1,0] neg_hi:[0,0,0]
v_pk_mul_f32 v[48:49], v[68:69], v[126:127] op_sel:[0,0] op_sel_hi:[0,1] neg_lo:[0,0] neg_hi:[0,0]
v_pk_fma_f32 v[68:69], v[68:69], v[126:127], v[48:49] op_sel:[1,1,0] op_sel_hi:[1,0,1] neg_lo:[0,1,0] neg_hi:[0,0,0]
v_pk_mul_f32 v[48:49], v[18:19], v[128:129] op_sel:[0,0] op_sel_hi:[0,1] neg_lo:[0,0] neg_hi:[0,0]
v_pk_fma_f32 v[18:19], v[18:19], v[128:129], v[48:49] op_sel:[1,1,0] op_sel_hi:[1,0,1] neg_lo:[0,1,0] neg_hi:[0,0,0]
v_pk_mul_f32 v[48:49], v[50:51], v[130:131] op_sel:[0,0] op_sel_hi:[0,1] neg_lo:[0,0] neg_hi:[0,0]
v_pk_fma_f32 v[50:51], v[50:51], v[130:131], v[48:49] op_sel:[1,1,0] op_sel_hi:[1,0,1] neg_lo:[0,1,0] neg_hi:[0,0,0]
v_pk_mul_f32 v[48:49], v[34:35], v[132:133] op_sel:[0,0] op_sel_hi:[0,1] neg_lo:[0,0] neg_hi:[0,0]
v_pk_fma_f32 v[34:35], v[34:35], v[132:133], v[48:49] op_sel:[1,1,0] op_sel_hi:[1,0,1] neg_lo:[0,1,0] neg_hi:[0,0,0]
v_pk_mul_f32 v[48:49], v[66:67], v[134:135] op_sel:[0,0] op_sel_hi:[0,1] neg_lo:[0,0] neg_hi:[0,0]
v_pk_fma_f32 v[66:67], v[66:67], v[134:135], v[48:49] op_sel:[1,1,0] op_sel_hi:[1,0,1] neg_lo:[0,1,0] neg_hi:[0,0,0]
v_pk_mul_f32 v[48:49], v[26:27], v[136:137] op_sel:[0,0] op_sel_hi:[0,1] neg_lo:[0,0] neg_hi:[0,0]
v_pk_fma_f32 v[26:27], v[26:27], v[136:137], v[48:49] op_sel:[1,1,0] op_sel_hi:[1,0,1] neg_lo:[0,1,0] neg_hi:[0,0,0]
v_pk_mul_f32 v[48:49], v[58:59], v[138:139] op_sel:[0,0] op_sel_hi:[0,1] neg_lo:[0,0] neg_hi:[0,0]
v_pk_fma_f32 v[58:59], v[58:59], v[138:139], v[48:49] op_sel:[1,1,0] op_sel_hi:[1,0,1] neg_lo:[0,1,0] neg_hi:[0,0,0]
v_pk_mul_f32 v[48:49], v[42:43], v[140:141] op_sel:[0,0] op_sel_hi:[0,1] neg_lo:[0,0] neg_hi:[0,0]
v_pk_fma_f32 v[42:43], v[42:43], v[140:141], v[48:49] op_sel:[1,1,0] op_sel_hi:[1,0,1] neg_lo:[0,1,0] neg_hi:[0,0,0]
v_pk_mul_f32 v[48:49], v[74:75], v[142:143] op_sel:[0,0] op_sel_hi:[0,1] neg_lo:[0,0] neg_hi:[0,0]
v_pk_fma_f32 v[74:75], v[74:75], v[142:143], v[48:49] op_sel:[1,1,0] op_sel_hi:[1,0,1] neg_lo:[0,1,0] neg_hi:[0,0,0]
ds_write_b64 v4, v[16:17] offset:0
ds_write_b64 v4, v[14:15] offset:264
ds_write_b64 v4, v[64:65] offset:528
ds_write_b64 v4, v[40:41] offset:792
ds_write_b64 v4, v[72:73] offset:1056
ds_write_b64 v4, v[44:45] offset:1320
ds_write_b64 v4, v[28:29] offset:1584
ds_write_b64 v4, v[60:61] offset:1848
ds_write_b64 v4, v[76:77] offset:2112
ds_write_b64 v4, v[46:47] offset:2376
ds_write_b64 v4, v[30:31] offset:2640
ds_write_b64 v4, v[62:63] offset:2904
ds_write_b64 v4, v[22:23] offset:3168
ds_write_b64 v4, v[54:55] offset:3432
ds_write_b64 v4, v[38:39] offset:3696
ds_write_b64 v4, v[70:71] offset:3960
ds_write_b64 v4, v[78:79] offset:4224
ds_write_b64 v4, v[32:33] offset:4488
ds_write_b64 v4, v[24:25] offset:4752
ds_write_b64 v4, v[56:57] offset:5016
ds_write_b64 v4, v[20:21] offset:5280
ds_write_b64 v4, v[52:53] offset:5544
ds_write_b64 v4, v[36:37] offset:5808
ds_write_b64 v4, v[68:69] offset:6072
ds_write_b64 v4, v[18:19] offset:6336
ds_write_b64 v4, v[50:51] offset:6600
ds_write_b64 v4, v[34:35] offset:6864
ds_write_b64 v4, v[66:67] offset:7128
ds_write_b64 v4, v[26:27] offset:7392
ds_write_b64 v4, v[58:59] offset:7656
ds_write_b64 v4, v[42:43] offset:7920
ds_write_b64 v4, v[74:75] offset:8184
s_waitcnt lgkmcnt(0)
ds_read_b64 v[16:17], v5 offset:0
ds_read_b64 v[48:49], v5 offset:128
ds_read_b64 v[18:19], v5 offset:8
ds_read_b64 v[50:51], v5 offset:136
ds_read_b64 v[20:21], v5 offset:16
ds_read_b64 v[52:53], v5 offset:144
ds_read_b64 v[22:23], v5 offset:24
ds_read_b64 v[54:55], v5 offset:152
ds_read_b64 v[24:25], v5 offset:32
ds_read_b64 v[56:57], v5 offset:160
ds_read_b64 v[26:27], v5 offset:40
ds_read_b64 v[58:59], v5 offset:168
ds_read_b64 v[28:29], v5 offset:48
ds_read_b64 v[60:61], v5 offset:176
ds_read_b64 v[30:31], v5 offset:56
ds_read_b64 v[62:63], v5 offset:184
ds_read_b64 v[32:33], v5 offset:64
ds_read_b64 v[64:65], v5 offset:192
ds_read_b64 v[34:35], v5 offset:72
ds_read_b64 v[66:67], v5 offset:200
ds_read_b64 v[36:37], v5 offset:80
ds_read_b64 v[68:69], v5 offset:208
ds_read_b64 v[38:39], v5 offset:88
ds_read_b64 v[70:71], v5 offset:216
ds_read_b64 v[40:41], v5 offset:96
ds_read_b64 v[72:73], v5 offset:224
ds_read_b64 v[42:43], v5 offset:104
ds_read_b64 v[74:75], v5 offset:232
ds_read_b64 v[44:45], v5 offset:112
ds_read_b64 v[76:77], v5 offset:240
ds_read_b64 v[46:47], v5 offset:120
ds_read_b64 v[78:79], v5 offset:248
s_waitcnt lgkmcnt(0)
v_pk_add_f32 v[14:15], v[16:17], v[48:49] neg_lo:[0,1] neg_hi:[0,1]
v_pk_add_f32 v[16:17], v[16:17], v[48:49]
v_pk_add_f32 v[48:49], v[18:19], v[50:51] neg_lo:[0,1] neg_hi:[0,1]
v_pk_add_f32 v[18:19], v[18:19], v[50:51]
v_pk_mul_f32 v[50:51], v[48:49], s[50:51] op_sel:[0,0] op_sel_hi:[0,1] neg_lo:[0,0] neg_hi:[0,0]
v_pk_fma_f32 v[50:51], v[48:49], s[50:51], v[50:51] op_sel:[1,1,0] op_sel_hi:[1,0,1] neg_lo:[0,1,0] neg_hi:[0,0,0]
v_pk_add_f32 v[48:49], v[20:21], v[52:53] neg_lo:[0,1] neg_hi:[0,1]
v_pk_add_f32 v[20:21], v[20:21], v[52:53]
v_pk_mul_f32 v[52:53], v[48:49], s[54:55] op_sel:[0,0] op_sel_hi:[0,1] neg_lo:[0,0] neg_hi:[0,0]
v_pk_fma_f32 v[52:53], v[48:49], s[54:55], v[52:53] op_sel:[1,1,0] op_sel_hi:[1,0,1] neg_lo:[0,1,0] neg_hi:[0,0,0]
v_pk_add_f32 v[48:49], v[22:23], v[54:55] neg_lo:[0,1] neg_hi:[0,1]
v_pk_add_f32 v[22:23], v[22:23], v[54:55]
v_pk_mul_f32 v[54:55], v[48:49], s[58:59] op_sel:[0,0] op_sel_hi:[0,1] neg_lo:[0,0] neg_hi:[0,0]
v_pk_fma_f32 v[54:55], v[48:49], s[58:59], v[54:55] op_sel:[1,1,0] op_sel_hi:[1,0,1] neg_lo:[0,1,0] neg_hi:[0,0,0]
v_pk_add_f32 v[48:49], v[24:25], v[56:57] neg_lo:[0,1] neg_hi:[0,1]
v_pk_add_f32 v[24:25], v[24:25], v[56:57]
v_pk_mul_f32 v[56:57], v[48:49], s[62:63] op_sel:[0,0] op_sel_hi:[0,1] neg_lo:[0,0] neg_hi:[0,0]
v_pk_fma_f32 v[56:57], v[48:49], s[62:63], v[56:57] op_sel:[1,1,0] op_sel_hi:[1,0,1] neg_lo:[0,1,0] neg_hi:[0,0,0]
v_pk_add_f32 v[48:49], v[26:27], v[58:59] neg_lo:[0,1] neg_hi:[0,1]
v_pk_add_f32 v[26:27], v[26:27], v[58:59]
v_pk_mul_f32 v[58:59], v[48:49], s[58:59] op_sel:[0,1] op_sel_hi:[0,0] neg_lo:[0,0] neg_hi:[0,0]
v_pk_fma_f32 v[58:59], v[48:49], s[58:59], v[58:59] op_sel:[1,0,0] op_sel_hi:[1,1,1] neg_lo:[0,1,0] neg_hi:[0,0,0]
v_pk_add_f32 v[48:49], v[28:29], v[60:61] neg_lo:[0,1] neg_hi:[0,1]
v_pk_add_f32 v[28:29], v[28:29], v[60:61]
v_pk_mul_f32 v[60:61], v[48:49], s[54:55] op_sel:[0,1] op_sel_hi:[0,0] neg_lo:[0,0] neg_hi:[0,0]
v_pk_fma_f32 v[60:61], v[48:49], s[54:55], v[60:61] op_sel:[1,0,0] op_sel_hi:[1,1,1] neg_lo:[0,1,0] neg_hi:[0,0,0]
v_pk_add_f32 v[48:49], v[30:31], v[62:63] neg_lo:[0,1] neg_hi:[0,1]
v_pk_add_f32 v[30:31], v[30:31], v[62:63]
v_pk_mul_f32 v[62:63], v[48:49], s[50:51] op_sel:[0,1] op_sel_hi:[0,0] neg_lo:[0,0] neg_hi:[0,0]
v_pk_fma_f32 v[62:63], v[48:49], s[50:51], v[62:63] op_sel:[1,0,0] op_sel_hi:[1,1,1] neg_lo:[0,1,0] neg_hi:[0,0,0]
v_pk_add_f32 v[48:49], v[32:33], v[64:65] op_sel:[1,1] op_sel_hi:[0,0] neg_lo:[1,0] neg_hi:[0,1]
v_pk_add_f32 v[32:33], v[32:33], v[64:65]
v_pk_add_f32 v[64:65], v[34:35], v[66:67] neg_lo:[0,1] neg_hi:[0,1]
v_pk_add_f32 v[34:35], v[34:35], v[66:67]
v_pk_mul_f32 v[66:67], v[64:65], s[50:51] op_sel:[0,1] op_sel_hi:[0,0] neg_lo:[0,1] neg_hi:[0,0]
v_pk_fma_f32 v[66:67], v[64:65], s[50:51], v[66:67] op_sel:[1,0,0] op_sel_hi:[1,1,1] neg_lo:[0,1,0] neg_hi:[0,1,0]
v_pk_add_f32 v[64:65], v[36:37], v[68:69] neg_lo:[0,1] neg_hi:[0,1]
v_pk_add_f32 v[36:37], v[36:37], v[68:69]
v_pk_mul_f32 v[68:69], v[64:65], s[54:55] op_sel:[0,1] op_sel_hi:[0,0] neg_lo:[0,1] neg_hi:[0,0]
v_pk_fma_f32 v[68:69], v[64:65], s[54:55], v[68:69] op_sel:[1,0,0] op_sel_hi:[1,1,1] neg_lo:[0,1,0] neg_hi:[0,1,0]
v_pk_add_f32 v[64:65], v[38:39], v[70:71] neg_lo:[0,1] neg_hi:[0,1]
v_pk_add_f32 v[38:39], v[38:39], v[70:71]
v_pk_mul_f32 v[70:71], v[64:65], s[58:59] op_sel:[0,1] op_sel_hi:[0,0] neg_lo:[0,1] neg_hi:[0,0]
v_pk_fma_f32 v[70:71], v[64:65], s[58:59], v[70:71] op_sel:[1,0,0] op_sel_hi:[1,1,1] neg_lo:[0,1,0] neg_hi:[0,1,0]
v_pk_add_f32 v[64:65], v[40:41], v[72:73] neg_lo:[0,1] neg_hi:[0,1]
v_pk_add_f32 v[40:41], v[40:41], v[72:73]
v_pk_mul_f32 v[72:73], v[64:65], s[62:63] op_sel:[0,0] op_sel_hi:[0,1] neg_lo:[0,1] neg_hi:[0,0]
v_pk_fma_f32 v[72:73], v[64:65], s[62:63], v[72:73] op_sel:[1,1,0] op_sel_hi:[1,0,1] neg_lo:[0,1,0] neg_hi:[0,1,0]
v_pk_add_f32 v[64:65], v[42:43], v[74:75] neg_lo:[0,1] neg_hi:[0,1]
v_pk_add_f32 v[42:43], v[42:43], v[74:75]
v_pk_mul_f32 v[74:75], v[64:65], s[58:59] op_sel:[0,0] op_sel_hi:[0,1] neg_lo:[0,1] neg_hi:[0,0]
v_pk_fma_f32 v[74:75], v[64:65], s[58:59], v[74:75] op_sel:[1,1,0] op_sel_hi:[1,0,1] neg_lo:[0,1,0] neg_hi:[0,1,0]
v_pk_add_f32 v[64:65], v[44:45], v[76:77] neg_lo:[0,1] neg_hi:[0,1]
v_pk_add_f32 v[44:45], v[44:45], v[76:77]
v_pk_mul_f32 v[76:77], v[64:65], s[54:55] op_sel:[0,0] op_sel_hi:[0,1] neg_lo:[0,1] neg_hi:[0,0]
v_pk_fma_f32 v[76:77], v[64:65], s[54:55], v[76:77] op_sel:[1,1,0] op_sel_hi:[1,0,1] neg_lo:[0,1,0] neg_hi:[0,1,0]
v_pk_add_f32 v[64:65], v[46:47], v[78:79] neg_lo:[0,1] neg_hi:[0,1]
v_pk_add_f32 v[46:47], v[46:47], v[78:79]
v_pk_mul_f32 v[78:79], v[64:65], s[50:51] op_sel:[0,0] op_sel_hi:[0,1] neg_lo:[0,1] neg_hi:[0,0]
v_pk_fma_f32 v[78:79], v[64:65], s[50:51], v[78:79] op_sel:[1,1,0] op_sel_hi:[1,0,1] neg_lo:[0,1,0] neg_hi:[0,1,0]
v_pk_add_f32 v[64:65], v[16:17], v[32:33] neg_lo:[0,1] neg_hi:[0,1]
v_pk_add_f32 v[16:17], v[16:17], v[32:33]
v_pk_add_f32 v[32:33], v[18:19], v[34:35] neg_lo:[0,1] neg_hi:[0,1]
v_pk_add_f32 v[18:19], v[18:19], v[34:35]
v_pk_mul_f32 v[34:35], v[32:33], s[54:55] op_sel:[0,0] op_sel_hi:[0,1] neg_lo:[0,0] neg_hi:[0,0]
v_pk_fma_f32 v[34:35], v[32:33], s[54:55], v[34:35] op_sel:[1,1,0] op_sel_hi:[1,0,1] neg_lo:[0,1,0] neg_hi:[0,0,0]
v_pk_add_f32 v[32:33], v[20:21], v[36:37] neg_lo:[0,1] neg_hi:[0,1]
v_pk_add_f32 v[20:21], v[20:21], v[36:37]
v_pk_mul_f32 v[36:37], v[32:33], s[62:63] op_sel:[0,0] op_sel_hi:[0,1] neg_lo:[0,0] neg_hi:[0,0]
v_pk_fma_f32 v[36:37], v[32:33], s[62:63], v[36:37] op_sel:[1,1,0] op_sel_hi:[1,0,1] neg_lo:[0,1,0] neg_hi:[0,0,0]
v_pk_add_f32 v[32:33], v[22:23], v[38:39] neg_lo:[0,1] neg_hi:[0,1]
v_pk_add_f32 v[22:23], v[22:23], v[38:39]
v_pk_mul_f32 v[38:39], v[32:33], s[54:55] op_sel:[0,1] op_sel_hi:[0,0] neg_lo:[0,0] neg_hi:[0,0]
v_pk_fma_f32 v[38:39], v[32:33], s[54:55], v[38:39] op_sel:[1,0,0] op_sel_hi:[1,1,1] neg_lo:[0,1,0] neg_hi:[0,0,0]
v_pk_add_f32 v[32:33], v[24:25], v[40:41] op_sel:[1,1] op_sel_hi:[0,0] neg_lo:[1,0] neg_hi:[0,1]
v_pk_add_f32 v[24:25], v[24:25], v[40:41]
v_pk_add_f32 v[40:41], v[26:27], v[42:43] neg_lo:[0,1] neg_hi:[0,1]
v_pk_add_f32 v[26:27], v[26:27], v[42:43]
v_pk_mul_f32 v[42:43], v[40:41], s[54:55] op_sel:[0,1] op_sel_hi:[0,0] neg_lo:[0,1] neg_hi:[0,0]
v_pk_fma_f32 v[42:43], v[40:41], s[54:55], v[42:43] op_sel:[1,0,0] op_sel_hi:[1,1,1] neg_lo:[0,1,0] neg_hi:[0,1,0]
v_pk_add_f32 v[40:41], v[28:29], v[44:45] neg_lo:[0,1] neg_hi:[0,1]
v_pk_add_f32 v[28:29], v[28:29], v[44:45]
v_pk_mul_f32 v[44:45], v[40:41], s[62:63] op_sel:[0,0] op_sel_hi:[0,1] neg_lo:[0,1] neg_hi:[0,0]
v_pk_fma_f32 v[44:45], v[40:41], s[62:63], v[44:45] op_sel:[1,1,0] op_sel_hi:[1,0,1] neg_lo:[0,1,0] neg_hi:[0,1,0]
v_pk_add_f32 v[40:41], v[30:31], v[46:47] neg_lo:[0,1] neg_hi:[0,1]
v_pk_add_f32 v[30:31], v[30:31], v[46:47]
v_pk_mul_f32 v[46:47], v[40:41], s[54:55] op_sel:[0,0] op_sel_hi:[0,1] neg_lo:[0,1] neg_hi:[0,0]
v_pk_fma_f32 v[46:47], v[40:41], s[54:55], v[46:47] op_sel:[1,1,0] op_sel_hi:[1,0,1] neg_lo:[0,1,0] neg_hi:[0,1,0]
v_pk_add_f32 v[40:41], v[14:15], v[48:49] neg_lo:[0,1] neg_hi:[0,1]
v_pk_add_f32 v[14:15], v[14:15], v[48:49]
v_pk_add_f32 v[48:49], v[50:51], v[66:67] neg_lo:[0,1] neg_hi:[0,1]
v_pk_add_f32 v[50:51], v[50:51], v[66:67]
v_pk_mul_f32 v[66:67], v[48:49], s[54:55] op_sel:[0,0] op_sel_hi:[0,1] neg_lo:[0,0] neg_hi:[0,0]
v_pk_fma_f32 v[66:67], v[48:49], s[54:55], v[66:67] op_sel:[1,1,0] op_sel_hi:[1,0,1] neg_lo:[0,1,0] neg_hi:[0,0,0]
v_pk_add_f32 v[48:49], v[52:53], v[68:69] neg_lo:[0,1] neg_hi:[0,1]
v_pk_add_f32 v[52:53], v[52:53], v[68:69]
v_pk_mul_f32 v[68:69], v[48:49], s[62:63] op_sel:[0,0] op_sel_hi:[0,1] neg_lo:[0,0] neg_hi:[0,0]
v_pk_fma_f32 v[68:69], v[48:49], s[62:63], v[68:69] op_sel:[1,1,0] op_sel_hi:[1,0,1] neg_lo:[0,1,0] neg_hi:[0,0,0]
v_pk_add_f32 v[48:49], v[54:55], v[70:71] neg_lo:[0,1] neg_hi:[0,1]
v_pk_add_f32 v[54:55], v[54:55], v[70:71]
v_pk_mul_f32 v[70:71], v[48:49], s[54:55] op_sel:[0,1] op_sel_hi:[0,0] neg_lo:[0,0] neg_hi:[0,0]
v_pk_fma_f32 v[70:71], v[48:49], s[54:55], v[70:71] op_sel:[1,0,0] op_sel_hi:[1,1,1] neg_lo:[0,1,0] neg_hi:[0,0,0]
v_pk_add_f32 v[48:49], v[56:57], v[72:73] op_sel:[1,1] op_sel_hi:[0,0] neg_lo:[1,0] neg_hi:[0,1]
v_pk_add_f32 v[56:57], v[56:57], v[72:73]
v_pk_add_f32 v[72:73], v[58:59], v[74:75] neg_lo:[0,1] neg_hi:[0,1]
v_pk_add_f32 v[58:59], v[58:59], v[74:75]
v_pk_mul_f32 v[74:75], v[72:73], s[54:55] op_sel:[0,1] op_sel_hi:[0,0] neg_lo:[0,1] neg_hi:[0,0]
v_pk_fma_f32 v[74:75], v[72:73], s[54:55], v[74:75] op_sel:[1,0,0] op_sel_hi:[1,1,1] neg_lo:[0,1,0] neg_hi:[0,1,0]
v_pk_add_f32 v[72:73], v[60:61], v[76:77] neg_lo:[0,1] neg_hi:[0,1]
v_pk_add_f32 v[60:61], v[60:61], v[76:77]
v_pk_mul_f32 v[76:77], v[72:73], s[62:63] op_sel:[0,0] op_sel_hi:[0,1] neg_lo:[0,1] neg_hi:[0,0]
v_pk_fma_f32 v[76:77], v[72:73], s[62:63], v[76:77] op_sel:[1,1,0] op_sel_hi:[1,0,1] neg_lo:[0,1,0] neg_hi:[0,1,0]
v_pk_add_f32 v[72:73], v[62:63], v[78:79] neg_lo:[0,1] neg_hi:[0,1]
v_pk_add_f32 v[62:63], v[62:63], v[78:79]
v_pk_mul_f32 v[78:79], v[72:73], s[54:55] op_sel:[0,0] op_sel_hi:[0,1] neg_lo:[0,1] neg_hi:[0,0]
v_pk_fma_f32 v[78:79], v[72:73], s[54:55], v[78:79] op_sel:[1,1,0] op_sel_hi:[1,0,1] neg_lo:[0,1,0] neg_hi:[0,1,0]
v_pk_add_f32 v[72:73], v[16:17], v[24:25] neg_lo:[0,1] neg_hi:[0,1]
v_pk_add_f32 v[16:17], v[16:17], v[24:25]
v_pk_add_f32 v[24:25], v[18:19], v[26:27] neg_lo:[0,1] neg_hi:[0,1]
v_pk_add_f32 v[18:19], v[18:19], v[26:27]
v_pk_mul_f32 v[26:27], v[24:25], s[62:63] op_sel:[0,0] op_sel_hi:[0,1] neg_lo:[0,0] neg_hi:[0,0]
v_pk_fma_f32 v[26:27], v[24:25], s[62:63], v[26:27] op_sel:[1,1,0] op_sel_hi:[1,0,1] neg_lo:[0,1,0] neg_hi:[0,0,0]
v_pk_add_f32 v[24:25], v[20:21], v[28:29] op_sel:[1,1] op_sel_hi:[0,0] neg_lo:[1,0] neg_hi:[0,1]
v_pk_add_f32 v[20:21], v[20:21], v[28:29]
v_pk_add_f32 v[28:29], v[22:23], v[30:31] neg_lo:[0,1] neg_hi:[0,1]
v_pk_add_f32 v[22:23], v[22:23], v[30:31]
v_pk_mul_f32 v[30:31], v[28:29], s[62:63] op_sel:[0,0] op_sel_hi:[0,1] neg_lo:[0,1] neg_hi:[0,0]
v_pk_fma_f32 v[30:31], v[28:29], s[62:63], v[30:31] op_sel:[1,1,0] op_sel_hi:[1,0,1] neg_lo:[0,1,0] neg_hi:[0,1,0]
v_pk_add_f32 v[28:29], v[64:65], v[32:33] neg_lo:[0,1] neg_hi:[0,1]
v_pk_add_f32 v[64:65], v[64:65], v[32:33]
v_pk_add_f32 v[32:33], v[34:35], v[42:43] neg_lo:[0,1] neg_hi:[0,1]
v_pk_add_f32 v[34:35], v[34:35], v[42:43]
v_pk_mul_f32 v[42:43], v[32:33], s[62:63] op_sel:[0,0] op_sel_hi:[0,1] neg_lo:[0,0] neg_hi:[0,0]
v_pk_fma_f32 v[42:43], v[32:33], s[62:63], v[42:43] op_sel:[1,1,0] op_sel_hi:[1,0,1] neg_lo:[0,1,0] neg_hi:[0,0,0]
v_pk_add_f32 v[32:33], v[36:37], v[44:45] op_sel:[1,1] op_sel_hi:[0,0] neg_lo:[1,0] neg_hi:[0,1]
v_pk_add_f32 v[36:37], v[36:37], v[44:45]
v_pk_add_f32 v[44:45], v[38:39], v[46:47] neg_lo:[0,1] neg_hi:[0,1]
v_pk_add_f32 v[38:39], v[38:39], v[46:47]
v_pk_mul_f32 v[46:47], v[44:45], s[62:63] op_sel:[0,0] op_sel_hi:[0,1] neg_lo:[0,1] neg_hi:[0,0]
v_pk_fma_f32 v[46:47], v[44:45], s[62:63], v[46:47] op_sel:[1,1,0] op_sel_hi:[1,0,1] neg_lo:[0,1,0] neg_hi:[0,1,0]
v_pk_add_f32 v[44:45], v[14:15], v[56:57] neg_lo:[0,1] neg_hi:[0,1]
v_pk_add_f32 v[14:15], v[14:15], v[56:57]
v_pk_add_f32 v[56:57], v[50:51], v[58:59] neg_lo:[0,1] neg_hi:[0,1]
v_pk_add_f32 v[50:51], v[50:51], v[58:59]
v_pk_mul_f32 v[58:59], v[56:57], s[62:63] op_sel:[0,0] op_sel_hi:[0,1] neg_lo:[0,0] neg_hi:[0,0]
v_pk_fma_f32 v[58:59], v[56:57], s[62:63], v[58:59] op_sel:[1,1,0] op_sel_hi:[1,0,1] neg_lo:[0,1,0] neg_hi:[0,0,0]
v_pk_add_f32 v[56:57], v[52:53], v[60:61] op_sel:[1,1] op_sel_hi:[0,0] neg_lo:[1,0] neg_hi:[0,1]
v_pk_add_f32 v[52:53], v[52:53], v[60:61]
v_pk_add_f32 v[60:61], v[54:55], v[62:63] neg_lo:[0,1] neg_hi:[0,1]
v_pk_add_f32 v[54:55], v[54:55], v[62:63]
v_pk_mul_f32 v[62:63], v[60:61], s[62:63] op_sel:[0,0] op_sel_hi:[0,1] neg_lo:[0,1] neg_hi:[0,0]
v_pk_fma_f32 v[62:63], v[60:61], s[62:63], v[62:63] op_sel:[1,1,0] op_sel_hi:[1,0,1] neg_lo:[0,1,0] neg_hi:[0,1,0]
v_pk_add_f32 v[60:61], v[40:41], v[48:49] neg_lo:[0,1] neg_hi:[0,1]
v_pk_add_f32 v[40:41], v[40:41], v[48:49]
v_pk_add_f32 v[48:49], v[66:67], v[74:75] neg_lo:[0,1] neg_hi:[0,1]
v_pk_add_f32 v[66:67], v[66:67], v[74:75]
v_pk_mul_f32 v[74:75], v[48:49], s[62:63] op_sel:[0,0] op_sel_hi:[0,1] neg_lo:[0,0] neg_hi:[0,0]
v_pk_fma_f32 v[74:75], v[48:49], s[62:63], v[74:75] op_sel:[1,1,0] op_sel_hi:[1,0,1] neg_lo:[0,1,0] neg_hi:[0,0,0]
v_pk_add_f32 v[48:49], v[68:69], v[76:77] op_sel:[1,1] op_sel_hi:[0,0] neg_lo:[1,0] neg_hi:[0,1]
v_pk_add_f32 v[68:69], v[68:69], v[76:77]
v_pk_add_f32 v[76:77], v[70:71], v[78:79] neg_lo:[0,1] neg_hi:[0,1]
v_pk_add_f32 v[70:71], v[70:71], v[78:79]
v_pk_mul_f32 v[78:79], v[76:77], s[62:63] op_sel:[0,0] op_sel_hi:[0,1] neg_lo:[0,1] neg_hi:[0,0]
v_pk_fma_f32 v[78:79], v[76:77], s[62:63], v[78:79] op_sel:[1,1,0] op_sel_hi:[1,0,1] neg_lo:[0,1,0] neg_hi:[0,1,0]
v_pk_add_f32 v[76:77], v[16:17], v[20:21] neg_lo:[0,1] neg_hi:[0,1]
v_pk_add_f32 v[16:17], v[16:17], v[20:21]
v_pk_add_f32 v[20:21], v[18:19], v[22:23] op_sel:[1,1] op_sel_hi:[0,0] neg_lo:[1,0] neg_hi:[0,1]
v_pk_add_f32 v[18:19], v[18:19], v[22:23]
v_pk_add_f32 v[22:23], v[72:73], v[24:25] neg_lo:[0,1] neg_hi:[0,1]
v_pk_add_f32 v[72:73], v[72:73], v[24:25]
v_pk_add_f32 v[24:25], v[26:27], v[30:31] op_sel:[1,1] op_sel_hi:[0,0] neg_lo:[1,0] neg_hi:[0,1]
v_pk_add_f32 v[26:27], v[26:27], v[30:31]
v_pk_add_f32 v[30:31], v[64:65], v[36:37] neg_lo:[0,1] neg_hi:[0,1]
v_pk_add_f32 v[64:65], v[64:65], v[36:37]
v_pk_add_f32 v[36:37], v[34:35], v[38:39] op_sel:[1,1] op_sel_hi:[0,0] neg_lo:[1,0] neg_hi:[0,1]
v_pk_add_f32 v[34:35], v[34:35], v[38:39]
v_pk_add_f32 v[38:39], v[28:29], v[32:33] neg_lo:[0,1] neg_hi:[0,1]
v_pk_add_f32 v[28:29], v[28:29], v[32:33]
v_pk_add_f32 v[32:33], v[42:43], v[46:47] op_sel:[1,1] op_sel_hi:[0,0] neg_lo:[1,0] neg_hi:[0,1]
v_pk_add_f32 v[42:43], v[42:43], v[46:47]
v_pk_add_f32 v[46:47], v[14:15], v[52:53] neg_lo:[0,1] neg_hi:[0,1]
v_pk_add_f32 v[14:15], v[14:15], v[52:53]
v_pk_add_f32 v[52:53], v[50:51], v[54:55] op_sel:[1,1] op_sel_hi:[0,0] neg_lo:[1,0] neg_hi:[0,1]
v_pk_add_f32 v[50:51], v[50:51], v[54:55]
v_pk_add_f32 v[54:55], v[44:45], v[56:57] neg_lo:[0,1] neg_hi:[0,1]
v_pk_add_f32 v[44:45], v[44:45], v[56:57]
v_pk_add_f32 v[56:57], v[58:59], v[62:63] op_sel:[1,1] op_sel_hi:[0,0] neg_lo:[1,0] neg_hi:[0,1]
v_pk_add_f32 v[58:59], v[58:59], v[62:63]
v_pk_add_f32 v[62:63], v[40:41], v[68:69] neg_lo:[0,1] neg_hi:[0,1]
v_pk_add_f32 v[40:41], v[40:41], v[68:69]
v_pk_add_f32 v[68:69], v[66:67], v[70:71] op_sel:[1,1] op_sel_hi:[0,0] neg_lo:[1,0] neg_hi:[0,1]
v_pk_add_f32 v[66:67], v[66:67], v[70:71]
v_pk_add_f32 v[70:71], v[60:61], v[48:49] neg_lo:[0,1] neg_hi:[0,1]
v_pk_add_f32 v[60:61], v[60:61], v[48:49]
v_pk_add_f32 v[48:49], v[74:75], v[78:79] op_sel:[1,1] op_sel_hi:[0,0] neg_lo:[1,0] neg_hi:[0,1]
v_pk_add_f32 v[74:75], v[74:75], v[78:79]
v_pk_add_f32 v[78:79], v[16:17], v[18:19] neg_lo:[0,1] neg_hi:[0,1]
v_pk_add_f32 v[16:17], v[16:17], v[18:19]
v_pk_add_f32 v[18:19], v[76:77], v[20:21] neg_lo:[0,1] neg_hi:[0,1]
v_pk_add_f32 v[76:77], v[76:77], v[20:21]
v_pk_add_f32 v[20:21], v[72:73], v[26:27] neg_lo:[0,1] neg_hi:[0,1]
v_pk_add_f32 v[72:73], v[72:73], v[26:27]
v_pk_add_f32 v[26:27], v[22:23], v[24:25] neg_lo:[0,1] neg_hi:[0,1]
v_pk_add_f32 v[22:23], v[22:23], v[24:25]
v_pk_add_f32 v[24:25], v[64:65], v[34:35] neg_lo:[0,1] neg_hi:[0,1]
v_pk_add_f32 v[64:65], v[64:65], v[34:35]
v_pk_add_f32 v[34:35], v[30:31], v[36:37] neg_lo:[0,1] neg_hi:[0,1]
v_pk_add_f32 v[30:31], v[30:31], v[36:37]
v_pk_add_f32 v[36:37], v[28:29], v[42:43] neg_lo:[0,1] neg_hi:[0,1]
v_pk_add_f32 v[28:29], v[28:29], v[42:43]
v_pk_add_f32 v[42:43], v[38:39], v[32:33] neg_lo:[0,1] neg_hi:[0,1]
v_pk_add_f32 v[38:39], v[38:39], v[32:33]
v_pk_add_f32 v[32:33], v[14:15], v[50:51] neg_lo:[0,1] neg_hi:[0,1]
v_pk_add_f32 v[14:15], v[14:15], v[50:51]
v_pk_add_f32 v[50:51], v[46:47], v[52:53] neg_lo:[0,1] neg_hi:[0,1]
v_pk_add_f32 v[46:47], v[46:47], v[52:53]
v_pk_add_f32 v[52:53], v[44:45], v[58:59] neg_lo:[0,1] neg_hi:[0,1]
v_pk_add_f32 v[44:45], v[44:45], v[58:59]
v_pk_add_f32 v[58:59], v[54:55], v[56:57] neg_lo:[0,1] neg_hi:[0,1]
v_pk_add_f32 v[54:55], v[54:55], v[56:57]
v_pk_add_f32 v[56:57], v[40:41], v[66:67] neg_lo:[0,1] neg_hi:[0,1]
v_pk_add_f32 v[40:41], v[40:41], v[66:67]
v_pk_add_f32 v[66:67], v[62:63], v[68:69] neg_lo:[0,1] neg_hi:[0,1]
v_pk_add_f32 v[62:63], v[62:63], v[68:69]
v_pk_add_f32 v[68:69], v[60:61], v[74:75] neg_lo:[0,1] neg_hi:[0,1]
v_pk_add_f32 v[60:61], v[60:61], v[74:75]
v_pk_add_f32 v[74:75], v[70:71], v[48:49] neg_lo:[0,1] neg_hi:[0,1]
v_pk_add_f32 v[70:71], v[70:71], v[48:49]
ds_write2st64_b32 v12, v16, v17 offset0:0 offset1:16
ds_write_b32 v12, v14 offset:128
ds_write_b32 v12, v15 offset:4224
ds_write_b32 v12, v64 offset:256
ds_write_b32 v12, v65 offset:4352
ds_write_b32 v12, v40 offset:384
ds_write_b32 v12, v41 offset:4480
ds_write_b32 v12, v72 offset:512
ds_write_b32 v12, v73 offset:4608
ds_write_b32 v12, v44 offset:640
ds_write_b32 v12, v45 offset:4736
ds_write_b32 v12, v28 offset:768
ds_write_b32 v12, v29 offset:4864
ds_write_b32 v12, v60 offset:896
ds_write_b32 v12, v61 offset:4992
ds_write_b32 v12, v76 offset:1024
ds_write_b32 v12, v77 offset:5120
ds_write_b32 v12, v46 offset:1152
ds_write_b32 v12, v47 offset:5248
ds_write_b32 v12, v30 offset:1280
ds_write_b32 v12, v31 offset:5376
ds_write_b32 v12, v62 offset:1408
ds_write_b32 v12, v63 offset:5504
ds_write_b32 v12, v22 offset:1536
ds_write_b32 v12, v23 offset:5632
ds_write_b32 v12, v54 offset:1664
ds_write_b32 v12, v55 offset:5760
ds_write_b32 v12, v38 offset:1792
ds_write_b32 v12, v39 offset:5888
ds_write_b32 v12, v70 offset:1920
ds_write_b32 v12, v71 offset:6016
ds_write_b32 v12, v78 offset:2048
ds_write_b32 v12, v79 offset:6144
ds_write_b32 v12, v32 offset:2176
ds_write_b32 v12, v33 offset:6272
ds_write_b32 v12, v24 offset:2304
ds_write_b32 v12, v25 offset:6400
ds_write_b32 v12, v56 offset:2432
ds_write_b32 v12, v57 offset:6528
ds_write_b32 v12, v20 offset:2560
ds_write_b32 v12, v21 offset:6656
ds_write_b32 v12, v52 offset:2688
ds_write_b32 v12, v53 offset:6784
ds_write_b32 v12, v36 offset:2816
ds_write_b32 v12, v37 offset:6912
ds_write_b32 v12, v68 offset:2944
ds_write_b32 v12, v69 offset:7040
ds_write_b32 v12, v18 offset:3072
ds_write_b32 v12, v19 offset:7168
ds_write_b32 v12, v50 offset:3200
ds_write_b32 v12, v51 offset:7296
ds_write_b32 v12, v34 offset:3328
ds_write_b32 v12, v35 offset:7424
ds_write_b32 v12, v66 offset:3456
ds_write_b32 v12, v67 offset:7552
ds_write_b32 v12, v26 offset:3584
ds_write_b32 v12, v27 offset:7680
ds_write_b32 v12, v58 offset:3712
ds_write_b32 v12, v59 offset:7808
ds_write_b32 v12, v42 offset:3840
ds_write_b32 v12, v43 offset:7936
ds_write_b32 v12, v74 offset:3968
ds_write_b32 v12, v75 offset:8064
s_waitcnt lgkmcnt(0)
s_barrier
s_lshl_b32 s13, s93, 16
ds_read_b128 v[16:19], v2 offset:0
ds_read_b128 v[20:23], v2 offset:16
ds_read_b128 v[24:27], v2 offset:8448
ds_read_b128 v[28:31], v2 offset:8464
ds_read_b128 v[32:35], v2 offset:16896
ds_read_b128 v[36:39], v2 offset:16912
ds_read_b128 v[40:43], v2 offset:25344
ds_read_b128 v[44:47], v2 offset:25360
ds_read_b128 v[48:51], v2 offset:33792
ds_read_b128 v[52:55], v2 offset:33808
ds_read_b128 v[56:59], v2 offset:42240
ds_read_b128 v[60:63], v2 offset:42256
ds_read_b128 v[64:67], v2 offset:50688
ds_read_b128 v[68:71], v2 offset:50704
s_waitcnt lgkmcnt(12)
ds_read_b128 v[72:75], v2 offset:59136
ds_read_b128 v[76:79], v2 offset:59152
s_waitcnt lgkmcnt(14)
v_cvt_pk_bf16_f32 v216, v16, v17
v_cvt_pk_bf16_f32 v217, v18, v19
v_cvt_pk_bf16_f32 v218, v20, v21
v_cvt_pk_bf16_f32 v219, v22, v23
buffer_store_dwordx4 v[216:219], v3, s[4:7], s13 offen sc1
s_add_u32 s13, s13, 8192
s_waitcnt lgkmcnt(12)
v_cvt_pk_bf16_f32 v220, v24, v25
v_cvt_pk_bf16_f32 v221, v26, v27
v_cvt_pk_bf16_f32 v222, v28, v29
v_cvt_pk_bf16_f32 v223, v30, v31
buffer_store_dwordx4 v[220:223], v3, s[4:7], s13 offen sc1
s_add_u32 s13, s13, 8192
s_waitcnt lgkmcnt(10)
v_cvt_pk_bf16_f32 v224, v32, v33
v_cvt_pk_bf16_f32 v225, v34, v35
v_cvt_pk_bf16_f32 v226, v36, v37
v_cvt_pk_bf16_f32 v227, v38, v39
buffer_store_dwordx4 v[224:227], v3, s[4:7], s13 offen sc1
s_add_u32 s13, s13, 8192
s_waitcnt lgkmcnt(8)
v_cvt_pk_bf16_f32 v228, v40, v41
v_cvt_pk_bf16_f32 v229, v42, v43
v_cvt_pk_bf16_f32 v230, v44, v45
v_cvt_pk_bf16_f32 v231, v46, v47
buffer_store_dwordx4 v[228:231], v3, s[4:7], s13 offen sc1
s_add_u32 s13, s13, 8192
s_waitcnt lgkmcnt(6)
v_cvt_pk_bf16_f32 v232, v48, v49
v_cvt_pk_bf16_f32 v233, v50, v51
v_cvt_pk_bf16_f32 v234, v52, v53
v_cvt_pk_bf16_f32 v235, v54, v55
buffer_store_dwordx4 v[232:235], v3, s[4:7], s13 offen sc1
s_add_u32 s13, s13, 8192
s_waitcnt lgkmcnt(4)
v_cvt_pk_bf16_f32 v236, v56, v57
v_cvt_pk_bf16_f32 v237, v58, v59
v_cvt_pk_bf16_f32 v238, v60, v61
v_cvt_pk_bf16_f32 v239, v62, v63
buffer_store_dwordx4 v[236:239], v3, s[4:7], s13 offen sc1
s_add_u32 s13, s13, 8192
s_waitcnt lgkmcnt(2)
v_cvt_pk_bf16_f32 v240, v64, v65
v_cvt_pk_bf16_f32 v241, v66, v67
v_cvt_pk_bf16_f32 v242, v68, v69
v_cvt_pk_bf16_f32 v243, v70, v71
buffer_store_dwordx4 v[240:243], v3, s[4:7], s13 offen sc1
s_add_u32 s13, s13, 8192
s_waitcnt lgkmcnt(0)
v_cvt_pk_bf16_f32 v244, v72, v73
v_cvt_pk_bf16_f32 v245, v74, v75
v_cvt_pk_bf16_f32 v246, v76, v77
v_cvt_pk_bf16_f32 v247, v78, v79
buffer_store_dwordx4 v[244:247], v3, s[4:7], s13 offen sc1
s_add_u32 s13, s13, 8192
s_mov_b32 s93, s21
s_cmp_lt_u32 s93, 128
s_cbranch_scc1 mega_kernel_f3_l
mega_kernel_f3_e:
s_waitcnt vmcnt(0)
s_barrier
s_add_u32 s64, s91, 58
s_mov_b32 s65, 64
s_mov_b32 s67, 1
s_add_u32 s66, s66, 262144
s_cmp_eq_u32 s91, 0
s_cbranch_scc1 mega_kernel_out
s_lshr_b32 s66, s40, 2
s_lshl_b32 s66, s66, 16
s_and_b32 s76, s40, 3
s_lshl_b32 s76, s76, 13
s_add_u32 s66, s66, s76
s_add_u32 s66, s66, 67141632
mega_kernel_out:
s_load_dwordx2 s[4:5], s[0:1], 40
s_load_dwordx2 s[8:9], s[0:1], 80
v_lshrrev_b32 v2, 6, v0
v_and_b32 v1, 63, v0
v_readfirstlane_b32 s41, v2
v_lshlrev_b32 v5, 4, v1
s_waitcnt lgkmcnt(0)
s_mov_b32 s6, 8388608
s_mov_b32 s7, 0x00020000
s_mov_b32 s10, 8388608
s_mov_b32 s11, 0x00020000
s_and_b32 s58, s40, 1
s_lshr_b32 s59, s40, 1
s_lshl_b32 s43, s58, 22
s_lshl_b32 s44, s41, 20
s_add_u32 s43, s43, s44
s_lshl_b32 s44, s59, 7
s_add_u32 s48, s43, s44
s_and_b32 s56, s59, 7
s_lshl_b32 s56, s56, 6
s_cmp_eq_u32 s68, 2
s_cbranch_scc1 mega_kernel_o_hw
v_lshrrev_b32 v2, 3, v1
v_and_b32 v3, 7, v1
v_lshlrev_b32 v16, 11, v2
v_lshl_add_u32 v16, v3, 4, v16
v_add_u32 v16, s48, v16
v_and_b32 v3, 3, v1
s_lshl_b32 s45, s41, 15
v_bfe_u32 v17, v1, 2, 2
v_lshrrev_b32 v18, 5, v1
v_mul_u32_u24 v18, 4, v18
v_add_u32 v17, v17, v18
v_lshlrev_b32 v17, 7, v17
v_bfe_u32 v18, v1, 4, 1
v_lshl_add_u32 v17, v18, 5, v17
v_lshl_add_u32 v17, v3, 3, v17
v_add_u32 v17, s45, v17
s_add_u32 m0, s45, 0
s_add_u32 s44, s56, 0
s_and_b32 s44, s44, 511
s_lshl_b32 s44, s44, 11
buffer_load_dwordx4 v16, s[4:7], s44 offen lds
s_add_u32 m0, s45, 1024
s_add_u32 s44, s56, 8
s_and_b32 s44, s44, 511
s_lshl_b32 s44, s44, 11
buffer_load_dwordx4 v16, s[4:7], s44 offen lds
s_add_u32 m0, s45, 2048
s_add_u32 s44, s56, 16
s_and_b32 s44, s44, 511
s_lshl_b32 s44, s44, 11
buffer_load_dwordx4 v16, s[4:7], s44 offen lds
s_add_u32 m0, s45, 3072
s_add_u32 s44, s56, 24
s_and_b32 s44, s44, 511
s_lshl_b32 s44, s44, 11
buffer_load_dwordx4 v16, s[4:7], s44 offen lds
s_add_u32 m0, s45, 4096
s_add_u32 s44, s56, 32
s_and_b32 s44, s44, 511
s_lshl_b32 s44, s44, 11
buffer_load_dwordx4 v16, s[4:7], s44 offen lds
s_add_u32 m0, s45, 5120
s_add_u32 s44, s56, 40
s_and_b32 s44, s44, 511
s_lshl_b32 s44, s44, 11
buffer_load_dwordx4 v16, s[4:7], s44 offen lds
s_add_u32 m0, s45, 6144
s_add_u32 s44, s56, 48
s_and_b32 s44, s44, 511
s_lshl_b32 s44, s44, 11
buffer_load_dwordx4 v16, s[4:7], s44 offen lds
s_add_u32 m0, s45, 7168
s_add_u32 s44, s56, 56
s_and_b32 s44, s44, 511
s_lshl_b32 s44, s44, 11
buffer_load_dwordx4 v16, s[4:7], s44 offen lds
s_add_u32 m0, s45, 8192
s_add_u32 s44, s56, 64
s_and_b32 s44, s44, 511
s_lshl_b32 s44, s44, 11
buffer_load_dwordx4 v16, s[4:7], s44 offen lds
s_add_u32 m0, s45, 9216
s_add_u32 s44, s56, 72
s_and_b32 s44, s44, 511
s_lshl_b32 s44, s44, 11
buffer_load_dwordx4 v16, s[4:7], s44 offen lds
s_add_u32 m0, s45, 10240
s_add_u32 s44, s56, 80
s_and_b32 s44, s44, 511
s_lshl_b32 s44, s44, 11
buffer_load_dwordx4 v16, s[4:7], s44 offen lds
s_add_u32 m0, s45, 11264
s_add_u32 s44, s56, 88
s_and_b32 s44, s44, 511
s_lshl_b32 s44, s44, 11
buffer_load_dwordx4 v16, s[4:7], s44 offen lds
s_add_u32 m0, s45, 12288
s_add_u32 s44, s56, 96
s_and_b32 s44, s44, 511
s_lshl_b32 s44, s44, 11
buffer_load_dwordx4 v16, s[4:7], s44 offen lds
s_add_u32 m0, s45, 13312
s_add_u32 s44, s56, 104
s_and_b32 s44, s44, 511
s_lshl_b32 s44, s44, 11
buffer_load_dwordx4 v16, s[4:7], s44 offen lds
s_add_u32 m0, s45, 14336
s_add_u32 s44, s56, 112
s_and_b32 s44, s44, 511
s_lshl_b32 s44, s44, 11
buffer_load_dwordx4 v16, s[4:7], s44 offen lds
s_add_u32 m0, s45, 15360
s_add_u32 s44, s56, 120
s_and_b32 s44, s44, 511
s_lshl_b32 s44, s44, 11
buffer_load_dwordx4 v16, s[4:7], s44 offen lds
s_add_u32 m0, s45, 16384
s_add_u32 s44, s56, 128
s_and_b32 s44, s44, 511
s_lshl_b32 s44, s44, 11
buffer_load_dwordx4 v16, s[4:7], s44 offen lds
s_add_u32 m0, s45, 17408
s_add_u32 s44, s56, 136
s_and_b32 s44, s44, 511
s_lshl_b32 s44, s44, 11
buffer_load_dwordx4 v16, s[4:7], s44 offen lds
s_add_u32 m0, s45, 18432
s_add_u32 s44, s56, 144
s_and_b32 s44, s44, 511
s_lshl_b32 s44, s44, 11
buffer_load_dwordx4 v16, s[4:7], s44 offen lds
s_add_u32 m0, s45, 19456
s_add_u32 s44, s56, 152
s_and_b32 s44, s44, 511
s_lshl_b32 s44, s44, 11
buffer_load_dwordx4 v16, s[4:7], s44 offen lds
s_add_u32 m0, s45, 20480
s_add_u32 s44, s56, 160
s_and_b32 s44, s44, 511
s_lshl_b32 s44, s44, 11
buffer_load_dwordx4 v16, s[4:7], s44 offen lds
s_add_u32 m0, s45, 21504
s_add_u32 s44, s56, 168
s_and_b32 s44, s44, 511
s_lshl_b32 s44, s44, 11
buffer_load_dwordx4 v16, s[4:7], s44 offen lds
s_add_u32 m0, s45, 22528
s_add_u32 s44, s56, 176
s_and_b32 s44, s44, 511
s_lshl_b32 s44, s44, 11
buffer_load_dwordx4 v16, s[4:7], s44 offen lds
s_add_u32 m0, s45, 23552
s_add_u32 s44, s56, 184
s_and_b32 s44, s44, 511
s_lshl_b32 s44, s44, 11
buffer_load_dwordx4 v16, s[4:7], s44 offen lds
s_add_u32 m0, s45, 24576
s_add_u32 s44, s56, 192
s_and_b32 s44, s44, 511
s_lshl_b32 s44, s44, 11
buffer_load_dwordx4 v16, s[4:7], s44 offen lds
s_add_u32 m0, s45, 25600
s_add_u32 s44, s56, 200
s_and_b32 s44, s44, 511
s_lshl_b32 s44, s44, 11
buffer_load_dwordx4 v16, s[4:7], s44 offen lds
s_add_u32 m0, s45, 26624
s_add_u32 s44, s56, 208
s_and_b32 s44, s44, 511
s_lshl_b32 s44, s44, 11
buffer_load_dwordx4 v16, s[4:7], s44 offen lds
s_add_u32 m0, s45, 27648
s_add_u32 s44, s56, 216
s_and_b32 s44, s44, 511
s_lshl_b32 s44, s44, 11
buffer_load_dwordx4 v16, s[4:7], s44 offen lds
s_add_u32 m0, s45, 28672
s_add_u32 s44, s56, 224
s_and_b32 s44, s44, 511
s_lshl_b32 s44, s44, 11
buffer_load_dwordx4 v16, s[4:7], s44 offen lds
s_add_u32 m0, s45, 29696
s_add_u32 s44, s56, 232
s_and_b32 s44, s44, 511
s_lshl_b32 s44, s44, 11
buffer_load_dwordx4 v16, s[4:7], s44 offen lds
s_add_u32 m0, s45, 30720
s_add_u32 s44, s56, 240
s_and_b32 s44, s44, 511
s_lshl_b32 s44, s44, 11
buffer_load_dwordx4 v16, s[4:7], s44 offen lds
s_add_u32 m0, s45, 31744
s_add_u32 s44, s56, 248
s_and_b32 s44, s44, 511
s_lshl_b32 s44, s44, 11
buffer_load_dwordx4 v16, s[4:7], s44 offen lds
s_waitcnt vmcnt(16)
ds_read_b64_tr_b16 a[0:1], v17 offset:0
ds_read_b64_tr_b16 a[2:3], v17 offset:2048
ds_read_b64_tr_b16 a[4:5], v17 offset:64
ds_read_b64_tr_b16 a[6:7], v17 offset:2112
ds_read_b64_tr_b16 a[8:9], v17 offset:1024
ds_read_b64_tr_b16 a[10:11], v17 offset:3072
ds_read_b64_tr_b16 a[12:13], v17 offset:1088
ds_read_b64_tr_b16 a[14:15], v17 offset:3136
s_waitcnt lgkmcnt(0)
ds_read_b64_tr_b16 a[16:17], v17 offset:4096
ds_read_b64_tr_b16 a[18:19], v17 offset:6144
ds_read_b64_tr_b16 a[20:21], v17 offset:4160
ds_read_b64_tr_b16 a[22:23], v17 offset:6208
ds_read_b64_tr_b16 a[24:25], v17 offset:5120
ds_read_b64_tr_b16 a[26:27], v17 offset:7168
ds_read_b64_tr_b16 a[28:29], v17 offset:5184
ds_read_b64_tr_b16 a[30:31], v17 offset:7232
s_waitcnt lgkmcnt(0)
ds_read_b64_tr_b16 a[32:33], v17 offset:8192
ds_read_b64_tr_b16 a[34:35], v17 offset:10240
ds_read_b64_tr_b16 a[36:37], v17 offset:8256
ds_read_b64_tr_b16 a[38:39], v17 offset:10304
ds_read_b64_tr_b16 a[40:41], v17 offset:9216
ds_read_b64_tr_b16 a[42:43], v17 offset:11264
ds_read_b64_tr_b16 a[44:45], v17 offset:9280
ds_read_b64_tr_b16 a[46:47], v17 offset:11328
s_waitcnt lgkmcnt(0)
ds_read_b64_tr_b16 a[48:49], v17 offset:12288
ds_read_b64_tr_b16 a[50:51], v17 offset:14336
ds_read_b64_tr_b16 a[52:53], v17 offset:12352
ds_read_b64_tr_b16 a[54:55], v17 offset:14400
ds_read_b64_tr_b16 a[56:57], v17 offset:13312
ds_read_b64_tr_b16 a[58:59], v17 offset:15360
ds_read_b64_tr_b16 a[60:61], v17 offset:13376
ds_read_b64_tr_b16 a[62:63], v17 offset:15424
s_waitcnt lgkmcnt(0)
s_add_u32 m0, s45, 0
s_add_u32 s44, s56, 256
s_and_b32 s44, s44, 511
s_lshl_b32 s44, s44, 11
buffer_load_dwordx4 v16, s[4:7], s44 offen lds
s_add_u32 m0, s45, 1024
s_add_u32 s44, s56, 264
s_and_b32 s44, s44, 511
s_lshl_b32 s44, s44, 11
buffer_load_dwordx4 v16, s[4:7], s44 offen lds
s_add_u32 m0, s45, 2048
s_add_u32 s44, s56, 272
s_and_b32 s44, s44, 511
s_lshl_b32 s44, s44, 11
buffer_load_dwordx4 v16, s[4:7], s44 offen lds
s_add_u32 m0, s45, 3072
s_add_u32 s44, s56, 280
s_and_b32 s44, s44, 511
s_lshl_b32 s44, s44, 11
buffer_load_dwordx4 v16, s[4:7], s44 offen lds
s_add_u32 m0, s45, 4096
s_add_u32 s44, s56, 288
s_and_b32 s44, s44, 511
s_lshl_b32 s44, s44, 11
buffer_load_dwordx4 v16, s[4:7], s44 offen lds
s_add_u32 m0, s45, 5120
s_add_u32 s44, s56, 296
s_and_b32 s44, s44, 511
s_lshl_b32 s44, s44, 11
buffer_load_dwordx4 v16, s[4:7], s44 offen lds
s_add_u32 m0, s45, 6144
s_add_u32 s44, s56, 304
s_and_b32 s44, s44, 511
s_lshl_b32 s44, s44, 11
buffer_load_dwordx4 v16, s[4:7], s44 offen lds
s_add_u32 m0, s45, 7168
s_add_u32 s44, s56, 312
s_and_b32 s44, s44, 511
s_lshl_b32 s44, s44, 11
buffer_load_dwordx4 v16, s[4:7], s44 offen lds
s_add_u32 m0, s45, 8192
s_add_u32 s44, s56, 320
s_and_b32 s44, s44, 511
s_lshl_b32 s44, s44, 11
buffer_load_dwordx4 v16, s[4:7], s44 offen lds
s_add_u32 m0, s45, 9216
s_add_u32 s44, s56, 328
s_and_b32 s44, s44, 511
s_lshl_b32 s44, s44, 11
buffer_load_dwordx4 v16, s[4:7], s44 offen lds
s_add_u32 m0, s45, 10240
s_add_u32 s44, s56, 336
s_and_b32 s44, s44, 511
s_lshl_b32 s44, s44, 11
buffer_load_dwordx4 v16, s[4:7], s44 offen lds
s_add_u32 m0, s45, 11264
s_add_u32 s44, s56, 344
s_and_b32 s44, s44, 511
s_lshl_b32 s44, s44, 11
buffer_load_dwordx4 v16, s[4:7], s44 offen lds
s_add_u32 m0, s45, 12288
s_add_u32 s44, s56, 352
s_and_b32 s44, s44, 511
s_lshl_b32 s44, s44, 11
buffer_load_dwordx4 v16, s[4:7], s44 offen lds
s_add_u32 m0, s45, 13312
s_add_u32 s44, s56, 360
s_and_b32 s44, s44, 511
s_lshl_b32 s44, s44, 11
buffer_load_dwordx4 v16, s[4:7], s44 offen lds
s_add_u32 m0, s45, 14336
s_add_u32 s44, s56, 368
s_and_b32 s44, s44, 511
s_lshl_b32 s44, s44, 11
buffer_load_dwordx4 v16, s[4:7], s44 offen lds
s_add_u32 m0, s45, 15360
s_add_u32 s44, s56, 376
s_and_b32 s44, s44, 511
s_lshl_b32 s44, s44, 11
buffer_load_dwordx4 v16, s[4:7], s44 offen lds
s_waitcnt vmcnt(16)
ds_read_b64_tr_b16 a[64:65], v17 offset:16384
ds_read_b64_tr_b16 a[66:67], v17 offset:18432
ds_read_b64_tr_b16 a[68:69], v17 offset:16448
ds_read_b64_tr_b16 a[70:71], v17 offset:18496
ds_read_b64_tr_b16 a[72:73], v17 offset:17408
ds_read_b64_tr_b16 a[74:75], v17 offset:19456
ds_read_b64_tr_b16 a[76:77], v17 offset:17472
ds_read_b64_tr_b16 a[78:79], v17 offset:19520
s_waitcnt lgkmcnt(0)
ds_read_b64_tr_b16 a[80:81], v17 offset:20480
ds_read_b64_tr_b16 a[82:83], v17 offset:22528
ds_read_b64_tr_b16 a[84:85], v17 offset:20544
ds_read_b64_tr_b16 a[86:87], v17 offset:22592
ds_read_b64_tr_b16 a[88:89], v17 offset:21504
ds_read_b64_tr_b16 a[90:91], v17 offset:23552
ds_read_b64_tr_b16 a[92:93], v17 offset:21568
ds_read_b64_tr_b16 a[94:95], v17 offset:23616
s_waitcnt lgkmcnt(0)
ds_read_b64_tr_b16 a[96:97], v17 offset:24576
ds_read_b64_tr_b16 a[98:99], v17 offset:26624
ds_read_b64_tr_b16 a[100:101], v17 offset:24640
ds_read_b64_tr_b16 a[102:103], v17 offset:26688
ds_read_b64_tr_b16 a[104:105], v17 offset:25600
ds_read_b64_tr_b16 a[106:107], v17 offset:27648
ds_read_b64_tr_b16 a[108:109], v17 offset:25664
ds_read_b64_tr_b16 a[110:111], v17 offset:27712
s_waitcnt lgkmcnt(0)
ds_read_b64_tr_b16 a[112:113], v17 offset:28672
ds_read_b64_tr_b16 a[114:115], v17 offset:30720
ds_read_b64_tr_b16 a[116:117], v17 offset:28736
ds_read_b64_tr_b16 a[118:119], v17 offset:30784
ds_read_b64_tr_b16 a[120:121], v17 offset:29696
ds_read_b64_tr_b16 a[122:123], v17 offset:31744
ds_read_b64_tr_b16 a[124:125], v17 offset:29760
ds_read_b64_tr_b16 a[126:127], v17 offset:31808
s_waitcnt lgkmcnt(0)
s_add_u32 m0, s45, 16384
s_add_u32 s44, s56, 384
s_and_b32 s44, s44, 511
s_lshl_b32 s44, s44, 11
buffer_load_dwordx4 v16, s[4:7], s44 offen lds
s_add_u32 m0, s45, 17408
s_add_u32 s44, s56, 392
s_and_b32 s44, s44, 511
s_lshl_b32 s44, s44, 11
buffer_load_dwordx4 v16, s[4:7], s44 offen lds
s_add_u32 m0, s45, 18432
s_add_u32 s44, s56, 400
s_and_b32 s44, s44, 511
s_lshl_b32 s44, s44, 11
buffer_load_dwordx4 v16, s[4:7], s44 offen lds
s_add_u32 m0, s45, 19456
s_add_u32 s44, s56, 408
s_and_b32 s44, s44, 511
s_lshl_b32 s44, s44, 11
buffer_load_dwordx4 v16, s[4:7], s44 offen lds
s_add_u32 m0, s45, 20480
s_add_u32 s44, s56, 416
s_and_b32 s44, s44, 511
s_lshl_b32 s44, s44, 11
buffer_load_dwordx4 v16, s[4:7], s44 offen lds
s_add_u32 m0, s45, 21504
s_add_u32 s44, s56, 424
s_and_b32 s44, s44, 511
s_lshl_b32 s44, s44, 11
buffer_load_dwordx4 v16, s[4:7], s44 offen lds
s_add_u32 m0, s45, 22528
s_add_u32 s44, s56, 432
s_and_b32 s44, s44, 511
s_lshl_b32 s44, s44, 11
buffer_load_dwordx4 v16, s[4:7], s44 offen lds
s_add_u32 m0, s45, 23552
s_add_u32 s44, s56, 440
s_and_b32 s44, s44, 511
s_lshl_b32 s44, s44, 11
buffer_load_dwordx4 v16, s[4:7], s44 offen lds
s_add_u32 m0, s45, 24576
s_add_u32 s44, s56, 448
s_and_b32 s44, s44, 511
s_lshl_b32 s44, s44, 11
buffer_load_dwordx4 v16, s[4:7], s44 offen lds
s_add_u32 m0, s45, 25600
s_add_u32 s44, s56, 456
s_and_b32 s44, s44, 511
s_lshl_b32 s44, s44, 11
buffer_load_dwordx4 v16, s[4:7], s44 offen lds
s_add_u32 m0, s45, 26624
s_add_u32 s44, s56, 464
s_and_b32 s44, s44, 511
s_lshl_b32 s44, s44, 11
buffer_load_dwordx4 v16, s[4:7], s44 offen lds
s_add_u32 m0, s45, 27648
s_add_u32 s44, s56, 472
s_and_b32 s44, s44, 511
s_lshl_b32 s44, s44, 11
buffer_load_dwordx4 v16, s[4:7], s44 offen lds
s_add_u32 m0, s45, 28672
s_add_u32 s44, s56, 480
s_and_b32 s44, s44, 511
s_lshl_b32 s44, s44, 11
buffer_load_dwordx4 v16, s[4:7], s44 offen lds
s_add_u32 m0, s45, 29696
s_add_u32 s44, s56, 488
s_and_b32 s44, s44, 511
s_lshl_b32 s44, s44, 11
buffer_load_dwordx4 v16, s[4:7], s44 offen lds
s_add_u32 m0, s45, 30720
s_add_u32 s44, s56, 496
s_and_b32 s44, s44, 511
s_lshl_b32 s44, s44, 11
buffer_load_dwordx4 v16, s[4:7], s44 offen lds
s_add_u32 m0, s45, 31744
s_add_u32 s44, s56, 504
s_and_b32 s44, s44, 511
s_lshl_b32 s44, s44, 11
buffer_load_dwordx4 v16, s[4:7], s44 offen lds
s_waitcnt vmcnt(16)
ds_read_b64_tr_b16 a[128:129], v17 offset:0
ds_read_b64_tr_b16 a[130:131], v17 offset:2048
ds_read_b64_tr_b16 a[132:133], v17 offset:64
ds_read_b64_tr_b16 a[134:135], v17 offset:2112
ds_read_b64_tr_b16 a[136:137], v17 offset:1024
ds_read_b64_tr_b16 a[138:139], v17 offset:3072
ds_read_b64_tr_b16 a[140:141], v17 offset:1088
ds_read_b64_tr_b16 a[142:143], v17 offset:3136
s_waitcnt lgkmcnt(0)
ds_read_b64_tr_b16 a[144:145], v17 offset:4096
ds_read_b64_tr_b16 a[146:147], v17 offset:6144
ds_read_b64_tr_b16 a[148:149], v17 offset:4160
ds_read_b64_tr_b16 a[150:151], v17 offset:6208
ds_read_b64_tr_b16 a[152:153], v17 offset:5120
ds_read_b64_tr_b16 a[154:155], v17 offset:7168
ds_read_b64_tr_b16 a[156:157], v17 offset:5184
ds_read_b64_tr_b16 a[158:159], v17 offset:7232
s_waitcnt lgkmcnt(0)
ds_read_b64_tr_b16 a[160:161], v17 offset:8192
ds_read_b64_tr_b16 a[162:163], v17 offset:10240
ds_read_b64_tr_b16 a[164:165], v17 offset:8256
ds_read_b64_tr_b16 a[166:167], v17 offset:10304
ds_read_b64_tr_b16 a[168:169], v17 offset:9216
ds_read_b64_tr_b16 a[170:171], v17 offset:11264
ds_read_b64_tr_b16 a[172:173], v17 offset:9280
ds_read_b64_tr_b16 a[174:175], v17 offset:11328
s_waitcnt lgkmcnt(0)
ds_read_b64_tr_b16 a[176:177], v17 offset:12288
ds_read_b64_tr_b16 a[178:179], v17 offset:14336
ds_read_b64_tr_b16 a[180:181], v17 offset:12352
ds_read_b64_tr_b16 a[182:183], v17 offset:14400
ds_read_b64_tr_b16 a[184:185], v17 offset:13312
ds_read_b64_tr_b16 a[186:187], v17 offset:15360
ds_read_b64_tr_b16 a[188:189], v17 offset:13376
ds_read_b64_tr_b16 a[190:191], v17 offset:15424
s_waitcnt lgkmcnt(0)
s_waitcnt vmcnt(0)
ds_read_b64_tr_b16 a[192:193], v17 offset:16384
ds_read_b64_tr_b16 a[194:195], v17 offset:18432
ds_read_b64_tr_b16 a[196:197], v17 offset:16448
ds_read_b64_tr_b16 a[198:199], v17 offset:18496
ds_read_b64_tr_b16 a[200:201], v17 offset:17408
ds_read_b64_tr_b16 a[202:203], v17 offset:19456
ds_read_b64_tr_b16 a[204:205], v17 offset:17472
ds_read_b64_tr_b16 a[206:207], v17 offset:19520
s_waitcnt lgkmcnt(0)
ds_read_b64_tr_b16 a[208:209], v17 offset:20480
ds_read_b64_tr_b16 a[210:211], v17 offset:22528
ds_read_b64_tr_b16 a[212:213], v17 offset:20544
ds_read_b64_tr_b16 a[214:215], v17 offset:22592
ds_read_b64_tr_b16 a[216:217], v17 offset:21504
ds_read_b64_tr_b16 a[218:219], v17 offset:23552
ds_read_b64_tr_b16 a[220:221], v17 offset:21568
ds_read_b64_tr_b16 a[222:223], v17 offset:23616
s_waitcnt lgkmcnt(0)
ds_read_b64_tr_b16 a[224:225], v17 offset:24576
ds_read_b64_tr_b16 a[226:227], v17 offset:26624
ds_read_b64_tr_b16 a[228:229], v17 offset:24640
ds_read_b64_tr_b16 a[230:231], v17 offset:26688
ds_read_b64_tr_b16 a[232:233], v17 offset:25600
ds_read_b64_tr_b16 a[234:235], v17 offset:27648
ds_read_b64_tr_b16 a[236:237], v17 offset:25664
ds_read_b64_tr_b16 a[238:239], v17 offset:27712
s_waitcnt lgkmcnt(0)
ds_read_b64_tr_b16 a[240:241], v17 offset:28672
ds_read_b64_tr_b16 a[242:243], v17 offset:30720
ds_read_b64_tr_b16 a[244:245], v17 offset:28736
ds_read_b64_tr_b16 a[246:247], v17 offset:30784
ds_read_b64_tr_b16 a[248:249], v17 offset:29696
ds_read_b64_tr_b16 a[250:251], v17 offset:31744
ds_read_b64_tr_b16 a[252:253], v17 offset:29760
ds_read_b64_tr_b16 a[254:255], v17 offset:31808
s_waitcnt lgkmcnt(0)
s_barrier
s_cmp_eq_u32 s68, 1
s_cbranch_scc1 mega_kernel_back
mega_kernel_o_hw:
s_lshl_b32 s56, s56, 6
s_lshl_b32 s43, s58, 18
s_lshl_b32 s44, s41, 16
s_add_u32 s43, s43, s44
s_add_u32 s43, s43, 134217728
v_add_u32 v6, s43, v5
v_and_b32 v2, 3, v1
v_lshlrev_b32 v7, 2, v2
v_bfe_u32 v2, v1, 2, 2
v_lshl_add_u32 v7, v2, 7, v7
s_lshl_b32 s43, s58, 11
s_lshl_b32 s44, s41, 9
s_add_u32 s43, s43, s44
s_lshl_b32 s44, s98, 13
s_add_u32 s43, s43, s44
s_add_u32 s43, s43, 69255168
v_add_u32 v7, s43, v7
s_mul_i32 s43, s41, 8704
v_lshrrev_b32 v2, 5, v1
v_lshl_add_u32 v8, v2, 5, v5
v_add_u32 v8, s43, v8
v_and_b32 v2, 7, v1
v_mul_u32_u24 v9, 544, v2
v_lshrrev_b32 v3, 3, v1
v_lshl_add_u32 v9, v3, 4, v9
s_lshl_b32 s43, s41, 7
v_add_u32 v9, s43, v9
s_mul_i32 s43, s58, 4352
s_sub_u32 s44, 4352, s43
v_add_u32 v10, s44, v9
v_add_u32 v9, s43, v9
s_lshl_b32 s43, s41, 15
s_lshl_b32 s44, s40, 6
s_add_u32 s43, s43, s44
v_lshlrev_b32 v11, 12, v3
v_and_b32 v2, 7, v1
v_lshl_add_u32 v11, v2, 3, v11
v_add_u32 v11, s43, v11
s_lshl_b32 s44, s41, 10
s_add_u32 s43, s66, s44
v_add_u32 v13, s43, v5
v_xor_b32 v12, 8192, v13
s_lshl_b32 s71, 1, s67
s_mov_b32 s42, s64
s_mov_b32 s52, 0
s_mov_b32 s53, 0
s_mov_b32 s57, 0
mega_kernel_o_cold:
s_cmp_gt_i32 s52, s42
s_cbranch_scc1 mega_kernel_o_fk
mega_kernel_o_fw:
buffer_load_dword v2, v7, s[84:87], 0 offen sc1
s_waitcnt vmcnt(0)
v_min_i32_dpp v2, v2, v2 quad_perm:[1,0,3,2] row_mask:0xf bank_mask:0xf
s_nop 1
v_min_i32_dpp v2, v2, v2 quad_perm:[2,3,0,1] row_mask:0xf bank_mask:0xf
s_nop 1
v_min_i32_dpp v2, v2, v2 row_ror:4 row_mask:0xf bank_mask:0xf
s_nop 1
v_min_i32_dpp v2, v2, v2 row_ror:8 row_mask:0xf bank_mask:0xf
s_nop 0
v_readfirstlane_b32 s52, v2
s_min_i32 s52, s52, s65
s_cmp_gt_i32 s52, s42
s_cbranch_scc1 mega_kernel_o_fk
s_sleep 2
s_add_u32 s43, s52, 2
s_cmp_gt_i32 s43, s42
s_cbranch_scc1 mega_kernel_o_fw
s_sleep 48
s_branch mega_kernel_o_fw
mega_kernel_o_fk:
s_add_u32 s54, s42, s71
s_cmp_gt_i32 s52, s54
s_cbranch_scc0 mega_kernel_o_c0
s_lshr_b32 s63, s42, 2
s_xnor_b32 s63, s63, s98
s_and_b32 s63, s63, 1
s_lshl_b32 s63, s63, 13
s_lshl_b32 s50, s42, 19
s_add_u32 s50, s50, s63
s_add_u32 s51, s56, 0
s_and_b32 s51, s51, 0x7fff
s_and_b32 s63, s51, 0x6000
s_add_u32 s51, s51, s63
s_add_u32 s51, s51, s50
buffer_load_dwordx4 v[96:99], v6, s[84:87], s51 offen offset:0 sc1
buffer_load_dwordx4 v[100:103], v6, s[84:87], s51 offen offset:1024 sc1
buffer_load_dwordx4 v[104:107], v6, s[84:87], s51 offen offset:2048 sc1
buffer_load_dwordx4 v[108:111], v6, s[84:87], s51 offen offset:3072 sc1
s_add_u32 s51, s56, 4096
s_and_b32 s51, s51, 0x7fff
s_and_b32 s63, s51, 0x6000
s_add_u32 s51, s51, s63
s_add_u32 s51, s51, s50
buffer_load_dwordx4 v[112:115], v6, s[84:87], s51 offen offset:0 sc1
buffer_load_dwordx4 v[116:119], v6, s[84:87], s51 offen offset:1024 sc1
buffer_load_dwordx4 v[120:123], v6, s[84:87], s51 offen offset:2048 sc1
buffer_load_dwordx4 v[124:127], v6, s[84:87], s51 offen offset:3072 sc1
s_add_u32 s51, s56, 8192
s_and_b32 s51, s51, 0x7fff
s_and_b32 s63, s51, 0x6000
s_add_u32 s51, s51, s63
s_add_u32 s51, s51, s50
buffer_load_dwordx4 v[128:131], v6, s[84:87], s51 offen offset:0 sc1
buffer_load_dwordx4 v[132:135], v6, s[84:87], s51 offen offset:1024 sc1
buffer_load_dwordx4 v[136:139], v6, s[84:87], s51 offen offset:2048 sc1
buffer_load_dwordx4 v[140:143], v6, s[84:87], s51 offen offset:3072 sc1
s_add_u32 s51, s56, 12288
s_and_b32 s51, s51, 0x7fff
s_and_b32 s63, s51, 0x6000
s_add_u32 s51, s51, s63
s_add_u32 s51, s51, s50
buffer_load_dwordx4 v[144:147], v6, s[84:87], s51 offen offset:0 sc1
buffer_load_dwordx4 v[148:151], v6, s[84:87], s51 offen offset:1024 sc1
buffer_load_dwordx4 v[152:155], v6, s[84:87], s51 offen offset:2048 sc1
buffer_load_dwordx4 v[156:159], v6, s[84:87], s51 offen offset:3072 sc1
s_add_u32 s51, s56, 16384
s_and_b32 s51, s51, 0x7fff
s_and_b32 s63, s51, 0x6000
s_add_u32 s51, s51, s63
s_add_u32 s51, s51, s50
buffer_load_dwordx4 v[160:163], v6, s[84:87], s51 offen offset:0 sc1
buffer_load_dwordx4 v[164:167], v6, s[84:87], s51 offen offset:1024 sc1
buffer_load_dwordx4 v[168:171], v6, s[84:87], s51 offen offset:2048 sc1
buffer_load_dwordx4 v[172:175], v6, s[84:87], s51 offen offset:3072 sc1
s_add_u32 s51, s56, 20480
s_and_b32 s51, s51, 0x7fff
s_and_b32 s63, s51, 0x6000
s_add_u32 s51, s51, s63
s_add_u32 s51, s51, s50
buffer_load_dwordx4 v[176:179], v6, s[84:87], s51 offen offset:0 sc1
buffer_load_dwordx4 v[180:183], v6, s[84:87], s51 offen offset:1024 sc1
buffer_load_dwordx4 v[184:187], v6, s[84:87], s51 offen offset:2048 sc1
buffer_load_dwordx4 v[188:191], v6, s[84:87], s51 offen offset:3072 sc1
s_add_u32 s51, s56, 24576
s_and_b32 s51, s51, 0x7fff
s_and_b32 s63, s51, 0x6000
s_add_u32 s51, s51, s63
s_add_u32 s51, s51, s50
buffer_load_dwordx4 v[192:195], v6, s[84:87], s51 offen offset:0 sc1
buffer_load_dwordx4 v[196:199], v6, s[84:87], s51 offen offset:1024 sc1
buffer_load_dwordx4 v[200:203], v6, s[84:87], s51 offen offset:2048 sc1
buffer_load_dwordx4 v[204:207], v6, s[84:87], s51 offen offset:3072 sc1
s_add_u32 s51, s56, 28672
s_and_b32 s51, s51, 0x7fff
s_and_b32 s63, s51, 0x6000
s_add_u32 s51, s51, s63
s_add_u32 s51, s51, s50
buffer_load_dwordx4 v[208:211], v6, s[84:87], s51 offen offset:0 sc1
buffer_load_dwordx4 v[212:215], v6, s[84:87], s51 offen offset:1024 sc1
buffer_load_dwordx4 v[216:219], v6, s[84:87], s51 offen offset:2048 sc1
buffer_load_dwordx4 v[220:223], v6, s[84:87], s51 offen offset:3072 sc1
mega_kernel_o_w0:
s_add_u32 s54, s42, s71
s_sub_u32 s62, s42, s71
s_lshr_b32 s63, s54, 2
s_xnor_b32 s63, s63, s98
s_and_b32 s63, s63, 1
s_lshl_b32 s63, s63, 13
s_lshl_b32 s50, s54, 19
s_add_u32 s50, s50, s63
s_cmp_gt_i32 s52, s54
s_cbranch_scc0 mega_kernel_o_n0
s_waitcnt vmcnt(31)
v_mfma_f32_32x32x16_bf16 v[20:35], a[0:3], v[96:99], 0
v_mfma_f32_32x32x16_bf16 v[36:51], a[4:7], v[96:99], 0
s_add_u32 s51, s56, 0
s_and_b32 s51, s51, 0x7fff
s_and_b32 s63, s51, 0x6000
s_add_u32 s51, s51, s63
s_add_u32 s51, s51, s50
buffer_load_dwordx4 v[96:99], v6, s[84:87], s51 offen offset:0 sc1
s_waitcnt vmcnt(31)
v_mfma_f32_32x32x16_bf16 v[20:35], a[8:11], v[100:103], v[20:35]
v_mfma_f32_32x32x16_bf16 v[36:51], a[12:15], v[100:103], v[36:51]
buffer_load_dwordx4 v[100:103], v6, s[84:87], s51 offen offset:1024 sc1
s_waitcnt vmcnt(31)
v_mfma_f32_32x32x16_bf16 v[20:35], a[16:19], v[104:107], v[20:35]
v_mfma_f32_32x32x16_bf16 v[36:51], a[20:23], v[104:107], v[36:51]
buffer_load_dwordx4 v[104:107], v6, s[84:87], s51 offen offset:2048 sc1
s_waitcnt vmcnt(31)
v_mfma_f32_32x32x16_bf16 v[20:35], a[24:27], v[108:111], v[20:35]
v_mfma_f32_32x32x16_bf16 v[36:51], a[28:31], v[108:111], v[36:51]
buffer_load_dwordx4 v[108:111], v6, s[84:87], s51 offen offset:3072 sc1
s_waitcnt vmcnt(31)
v_mfma_f32_32x32x16_bf16 v[20:35], a[32:35], v[112:115], v[20:35]
v_mfma_f32_32x32x16_bf16 v[36:51], a[36:39], v[112:115], v[36:51]
s_add_u32 s51, s56, 4096
s_and_b32 s51, s51, 0x7fff
s_and_b32 s63, s51, 0x6000
s_add_u32 s51, s51, s63
s_add_u32 s51, s51, s50
buffer_load_dwordx4 v[112:115], v6, s[84:87], s51 offen offset:0 sc1
s_waitcnt vmcnt(31)
v_mfma_f32_32x32x16_bf16 v[20:35], a[40:43], v[116:119], v[20:35]
v_mfma_f32_32x32x16_bf16 v[36:51], a[44:47], v[116:119], v[36:51]
buffer_load_dwordx4 v[116:119], v6, s[84:87], s51 offen offset:1024 sc1
s_waitcnt vmcnt(31)
v_mfma_f32_32x32x16_bf16 v[20:35], a[48:51], v[120:123], v[20:35]
v_mfma_f32_32x32x16_bf16 v[36:51], a[52:55], v[120:123], v[36:51]
buffer_load_dwordx4 v[120:123], v6, s[84:87], s51 offen offset:2048 sc1
s_waitcnt vmcnt(31)
v_mfma_f32_32x32x16_bf16 v[20:35], a[56:59], v[124:127], v[20:35]
v_mfma_f32_32x32x16_bf16 v[36:51], a[60:63], v[124:127], v[36:51]
buffer_load_dwordx4 v[124:127], v6, s[84:87], s51 offen offset:3072 sc1
s_waitcnt vmcnt(31)
v_mfma_f32_32x32x16_bf16 v[20:35], a[64:67], v[128:131], v[20:35]
v_mfma_f32_32x32x16_bf16 v[36:51], a[68:71], v[128:131], v[36:51]
s_add_u32 s51, s56, 8192
s_and_b32 s51, s51, 0x7fff
s_and_b32 s63, s51, 0x6000
s_add_u32 s51, s51, s63
s_add_u32 s51, s51, s50
buffer_load_dwordx4 v[128:131], v6, s[84:87], s51 offen offset:0 sc1
s_waitcnt vmcnt(31)
v_mfma_f32_32x32x16_bf16 v[20:35], a[72:75], v[132:135], v[20:35]
v_mfma_f32_32x32x16_bf16 v[36:51], a[76:79], v[132:135], v[36:51]
buffer_load_dwordx4 v[132:135], v6, s[84:87], s51 offen offset:1024 sc1
s_waitcnt vmcnt(31)
v_mfma_f32_32x32x16_bf16 v[20:35], a[80:83], v[136:139], v[20:35]
v_mfma_f32_32x32x16_bf16 v[36:51], a[84:87], v[136:139], v[36:51]
buffer_load_dwordx4 v[136:139], v6, s[84:87], s51 offen offset:2048 sc1
s_waitcnt vmcnt(31)
v_mfma_f32_32x32x16_bf16 v[20:35], a[88:91], v[140:143], v[20:35]
v_mfma_f32_32x32x16_bf16 v[36:51], a[92:95], v[140:143], v[36:51]
buffer_load_dwordx4 v[140:143], v6, s[84:87], s51 offen offset:3072 sc1
s_waitcnt vmcnt(31)
v_mfma_f32_32x32x16_bf16 v[20:35], a[96:99], v[144:147], v[20:35]
v_mfma_f32_32x32x16_bf16 v[36:51], a[100:103], v[144:147], v[36:51]
s_add_u32 s51, s56, 12288
s_and_b32 s51, s51, 0x7fff
s_and_b32 s63, s51, 0x6000
s_add_u32 s51, s51, s63
s_add_u32 s51, s51, s50
buffer_load_dwordx4 v[144:147], v6, s[84:87], s51 offen offset:0 sc1
s_waitcnt vmcnt(31)
v_mfma_f32_32x32x16_bf16 v[20:35], a[104:107], v[148:151], v[20:35]
v_mfma_f32_32x32x16_bf16 v[36:51], a[108:111], v[148:151], v[36:51]
buffer_load_dwordx4 v[148:151], v6, s[84:87], s51 offen offset:1024 sc1
s_waitcnt vmcnt(31)
v_mfma_f32_32x32x16_bf16 v[20:35], a[112:115], v[152:155], v[20:35]
v_mfma_f32_32x32x16_bf16 v[36:51], a[116:119], v[152:155], v[36:51]
buffer_load_dwordx4 v[152:155], v6, s[84:87], s51 offen offset:2048 sc1
s_waitcnt vmcnt(31)
v_mfma_f32_32x32x16_bf16 v[20:35], a[120:123], v[156:159], v[20:35]
v_mfma_f32_32x32x16_bf16 v[36:51], a[124:127], v[156:159], v[36:51]
buffer_load_dwordx4 v[156:159], v6, s[84:87], s51 offen offset:3072 sc1
s_waitcnt vmcnt(31)
v_mfma_f32_32x32x16_bf16 v[20:35], a[128:131], v[160:163], v[20:35]
v_mfma_f32_32x32x16_bf16 v[36:51], a[132:135], v[160:163], v[36:51]
s_add_u32 s51, s56, 16384
s_and_b32 s51, s51, 0x7fff
s_and_b32 s63, s51, 0x6000
s_add_u32 s51, s51, s63
s_add_u32 s51, s51, s50
buffer_load_dwordx4 v[160:163], v6, s[84:87], s51 offen offset:0 sc1
s_waitcnt vmcnt(31)
v_mfma_f32_32x32x16_bf16 v[20:35], a[136:139], v[164:167], v[20:35]
v_mfma_f32_32x32x16_bf16 v[36:51], a[140:143], v[164:167], v[36:51]
buffer_load_dwordx4 v[164:167], v6, s[84:87], s51 offen offset:1024 sc1
s_waitcnt vmcnt(31)
v_mfma_f32_32x32x16_bf16 v[20:35], a[144:147], v[168:171], v[20:35]
v_mfma_f32_32x32x16_bf16 v[36:51], a[148:151], v[168:171], v[36:51]
buffer_load_dwordx4 v[168:171], v6, s[84:87], s51 offen offset:2048 sc1
s_waitcnt vmcnt(31)
v_mfma_f32_32x32x16_bf16 v[20:35], a[152:155], v[172:175], v[20:35]
v_mfma_f32_32x32x16_bf16 v[36:51], a[156:159], v[172:175], v[36:51]
buffer_load_dwordx4 v[172:175], v6, s[84:87], s51 offen offset:3072 sc1
s_waitcnt vmcnt(31)
v_mfma_f32_32x32x16_bf16 v[20:35], a[160:163], v[176:179], v[20:35]
v_mfma_f32_32x32x16_bf16 v[36:51], a[164:167], v[176:179], v[36:51]
s_add_u32 s51, s56, 20480
s_and_b32 s51, s51, 0x7fff
s_and_b32 s63, s51, 0x6000
s_add_u32 s51, s51, s63
s_add_u32 s51, s51, s50
buffer_load_dwordx4 v[176:179], v6, s[84:87], s51 offen offset:0 sc1
s_waitcnt vmcnt(31)
v_mfma_f32_32x32x16_bf16 v[20:35], a[168:171], v[180:183], v[20:35]
v_mfma_f32_32x32x16_bf16 v[36:51], a[172:175], v[180:183], v[36:51]
buffer_load_dwordx4 v[180:183], v6, s[84:87], s51 offen offset:1024 sc1
s_waitcnt vmcnt(31)
v_mfma_f32_32x32x16_bf16 v[20:35], a[176:179], v[184:187], v[20:35]
v_mfma_f32_32x32x16_bf16 v[36:51], a[180:183], v[184:187], v[36:51]
buffer_load_dwordx4 v[184:187], v6, s[84:87], s51 offen offset:2048 sc1
s_waitcnt vmcnt(31)
v_mfma_f32_32x32x16_bf16 v[20:35], a[184:187], v[188:191], v[20:35]
v_mfma_f32_32x32x16_bf16 v[36:51], a[188:191], v[188:191], v[36:51]
buffer_load_dwordx4 v[188:191], v6, s[84:87], s51 offen offset:3072 sc1
s_waitcnt vmcnt(31)
v_mfma_f32_32x32x16_bf16 v[20:35], a[192:195], v[192:195], v[20:35]
v_mfma_f32_32x32x16_bf16 v[36:51], a[196:199], v[192:195], v[36:51]
s_add_u32 s51, s56, 24576
s_and_b32 s51, s51, 0x7fff
s_and_b32 s63, s51, 0x6000
s_add_u32 s51, s51, s63
s_add_u32 s51, s51, s50
buffer_load_dwordx4 v[192:195], v6, s[84:87], s51 offen offset:0 sc1
s_waitcnt vmcnt(31)
v_mfma_f32_32x32x16_bf16 v[20:35], a[200:203], v[196:199], v[20:35]
v_mfma_f32_32x32x16_bf16 v[36:51], a[204:207], v[196:199], v[36:51]
buffer_load_dwordx4 v[196:199], v6, s[84:87], s51 offen offset:1024 sc1
s_waitcnt vmcnt(31)
v_mfma_f32_32x32x16_bf16 v[20:35], a[208:211], v[200:203], v[20:35]
v_mfma_f32_32x32x16_bf16 v[36:51], a[212:215], v[200:203], v[36:51]
buffer_load_dwordx4 v[200:203], v6, s[84:87], s51 offen offset:2048 sc1
s_waitcnt vmcnt(31)
v_mfma_f32_32x32x16_bf16 v[20:35], a[216:219], v[204:207], v[20:35]
v_mfma_f32_32x32x16_bf16 v[36:51], a[220:223], v[204:207], v[36:51]
buffer_load_dwordx4 v[204:207], v6, s[84:87], s51 offen offset:3072 sc1
s_waitcnt vmcnt(31)
v_mfma_f32_32x32x16_bf16 v[20:35], a[224:227], v[208:211], v[20:35]
v_mfma_f32_32x32x16_bf16 v[36:51], a[228:231], v[208:211], v[36:51]
s_add_u32 s51, s56, 28672
s_and_b32 s51, s51, 0x7fff
s_and_b32 s63, s51, 0x6000
s_add_u32 s51, s51, s63
s_add_u32 s51, s51, s50
buffer_load_dwordx4 v[208:211], v6, s[84:87], s51 offen offset:0 sc1
s_waitcnt vmcnt(31)
v_mfma_f32_32x32x16_bf16 v[20:35], a[232:235], v[212:215], v[20:35]
v_mfma_f32_32x32x16_bf16 v[36:51], a[236:239], v[212:215], v[36:51]
buffer_load_dwordx4 v[212:215], v6, s[84:87], s51 offen offset:1024 sc1
s_waitcnt vmcnt(31)
v_mfma_f32_32x32x16_bf16 v[20:35], a[240:243], v[216:219], v[20:35]
v_mfma_f32_32x32x16_bf16 v[36:51], a[244:247], v[216:219], v[36:51]
buffer_load_dwordx4 v[216:219], v6, s[84:87], s51 offen offset:2048 sc1
s_waitcnt vmcnt(31)
v_mfma_f32_32x32x16_bf16 v[224:239], a[248:251], v[220:223], v[20:35]
v_mfma_f32_32x32x16_bf16 v[240:255], a[252:255], v[220:223], v[36:51]
buffer_load_dwordx4 v[220:223], v6, s[84:87], s51 offen offset:3072 sc1
s_add_u32 s42, s42, s71
s_branch mega_kernel_o_w1
mega_kernel_o_n0:
s_waitcnt vmcnt(31)
v_mfma_f32_32x32x16_bf16 v[20:35], a[0:3], v[96:99], 0
v_mfma_f32_32x32x16_bf16 v[36:51], a[4:7], v[96:99], 0
s_waitcnt vmcnt(30)
v_mfma_f32_32x32x16_bf16 v[20:35], a[8:11], v[100:103], v[20:35]
v_mfma_f32_32x32x16_bf16 v[36:51], a[12:15], v[100:103], v[36:51]
s_waitcnt vmcnt(29)
v_mfma_f32_32x32x16_bf16 v[20:35], a[16:19], v[104:107], v[20:35]
v_mfma_f32_32x32x16_bf16 v[36:51], a[20:23], v[104:107], v[36:51]
s_waitcnt vmcnt(28)
v_mfma_f32_32x32x16_bf16 v[20:35], a[24:27], v[108:111], v[20:35]
v_mfma_f32_32x32x16_bf16 v[36:51], a[28:31], v[108:111], v[36:51]
s_waitcnt vmcnt(27)
v_mfma_f32_32x32x16_bf16 v[20:35], a[32:35], v[112:115], v[20:35]
v_mfma_f32_32x32x16_bf16 v[36:51], a[36:39], v[112:115], v[36:51]
s_waitcnt vmcnt(26)
v_mfma_f32_32x32x16_bf16 v[20:35], a[40:43], v[116:119], v[20:35]
v_mfma_f32_32x32x16_bf16 v[36:51], a[44:47], v[116:119], v[36:51]
s_waitcnt vmcnt(25)
v_mfma_f32_32x32x16_bf16 v[20:35], a[48:51], v[120:123], v[20:35]
v_mfma_f32_32x32x16_bf16 v[36:51], a[52:55], v[120:123], v[36:51]
s_waitcnt vmcnt(24)
v_mfma_f32_32x32x16_bf16 v[20:35], a[56:59], v[124:127], v[20:35]
v_mfma_f32_32x32x16_bf16 v[36:51], a[60:63], v[124:127], v[36:51]
s_waitcnt vmcnt(23)
v_mfma_f32_32x32x16_bf16 v[20:35], a[64:67], v[128:131], v[20:35]
v_mfma_f32_32x32x16_bf16 v[36:51], a[68:71], v[128:131], v[36:51]
s_waitcnt vmcnt(22)
v_mfma_f32_32x32x16_bf16 v[20:35], a[72:75], v[132:135], v[20:35]
v_mfma_f32_32x32x16_bf16 v[36:51], a[76:79], v[132:135], v[36:51]
s_waitcnt vmcnt(21)
v_mfma_f32_32x32x16_bf16 v[20:35], a[80:83], v[136:139], v[20:35]
v_mfma_f32_32x32x16_bf16 v[36:51], a[84:87], v[136:139], v[36:51]
s_waitcnt vmcnt(20)
v_mfma_f32_32x32x16_bf16 v[20:35], a[88:91], v[140:143], v[20:35]
v_mfma_f32_32x32x16_bf16 v[36:51], a[92:95], v[140:143], v[36:51]
s_waitcnt vmcnt(19)
v_mfma_f32_32x32x16_bf16 v[20:35], a[96:99], v[144:147], v[20:35]
v_mfma_f32_32x32x16_bf16 v[36:51], a[100:103], v[144:147], v[36:51]
s_waitcnt vmcnt(18)
v_mfma_f32_32x32x16_bf16 v[20:35], a[104:107], v[148:151], v[20:35]
v_mfma_f32_32x32x16_bf16 v[36:51], a[108:111], v[148:151], v[36:51]
s_waitcnt vmcnt(17)
v_mfma_f32_32x32x16_bf16 v[20:35], a[112:115], v[152:155], v[20:35]
v_mfma_f32_32x32x16_bf16 v[36:51], a[116:119], v[152:155], v[36:51]
s_waitcnt vmcnt(16)
v_mfma_f32_32x32x16_bf16 v[20:35], a[120:123], v[156:159], v[20:35]
v_mfma_f32_32x32x16_bf16 v[36:51], a[124:127], v[156:159], v[36:51]
s_waitcnt vmcnt(15)
v_mfma_f32_32x32x16_bf16 v[20:35], a[128:131], v[160:163], v[20:35]
v_mfma_f32_32x32x16_bf16 v[36:51], a[132:135], v[160:163], v[36:51]
s_waitcnt vmcnt(14)
v_mfma_f32_32x32x16_bf16 v[20:35], a[136:139], v[164:167], v[20:35]
v_mfma_f32_32x32x16_bf16 v[36:51], a[140:143], v[164:167], v[36:51]
s_waitcnt vmcnt(13)
v_mfma_f32_32x32x16_bf16 v[20:35], a[144:147], v[168:171], v[20:35]
v_mfma_f32_32x32x16_bf16 v[36:51], a[148:151], v[168:171], v[36:51]
s_waitcnt vmcnt(12)
v_mfma_f32_32x32x16_bf16 v[20:35], a[152:155], v[172:175], v[20:35]
v_mfma_f32_32x32x16_bf16 v[36:51], a[156:159], v[172:175], v[36:51]
s_waitcnt vmcnt(11)
v_mfma_f32_32x32x16_bf16 v[20:35], a[160:163], v[176:179], v[20:35]
v_mfma_f32_32x32x16_bf16 v[36:51], a[164:167], v[176:179], v[36:51]
buffer_load_dword v15, v7, s[84:87], 0 offen sc1
s_waitcnt vmcnt(10)
v_mfma_f32_32x32x16_bf16 v[20:35], a[168:171], v[180:183], v[20:35]
v_mfma_f32_32x32x16_bf16 v[36:51], a[172:175], v[180:183], v[36:51]
s_waitcnt vmcnt(9)
v_mfma_f32_32x32x16_bf16 v[20:35], a[176:179], v[184:187], v[20:35]
v_mfma_f32_32x32x16_bf16 v[36:51], a[180:183], v[184:187], v[36:51]
s_waitcnt vmcnt(8)
v_mfma_f32_32x32x16_bf16 v[20:35], a[184:187], v[188:191], v[20:35]
v_mfma_f32_32x32x16_bf16 v[36:51], a[188:191], v[188:191], v[36:51]
s_waitcnt vmcnt(7)
v_mfma_f32_32x32x16_bf16 v[20:35], a[192:195], v[192:195], v[20:35]
v_mfma_f32_32x32x16_bf16 v[36:51], a[196:199], v[192:195], v[36:51]
s_waitcnt vmcnt(6)
v_mfma_f32_32x32x16_bf16 v[20:35], a[200:203], v[196:199], v[20:35]
v_mfma_f32_32x32x16_bf16 v[36:51], a[204:207], v[196:199], v[36:51]
s_waitcnt vmcnt(5)
v_mfma_f32_32x32x16_bf16 v[20:35], a[208:211], v[200:203], v[20:35]
v_mfma_f32_32x32x16_bf16 v[36:51], a[212:215], v[200:203], v[36:51]
s_waitcnt vmcnt(4)
v_mfma_f32_32x32x16_bf16 v[20:35], a[216:219], v[204:207], v[20:35]
v_mfma_f32_32x32x16_bf16 v[36:51], a[220:223], v[204:207], v[36:51]
s_waitcnt vmcnt(3)
v_mfma_f32_32x32x16_bf16 v[20:35], a[224:227], v[208:211], v[20:35]
v_mfma_f32_32x32x16_bf16 v[36:51], a[228:231], v[208:211], v[36:51]
s_waitcnt vmcnt(2)
v_mfma_f32_32x32x16_bf16 v[20:35], a[232:235], v[212:215], v[20:35]
v_mfma_f32_32x32x16_bf16 v[36:51], a[236:239], v[212:215], v[36:51]
s_waitcnt vmcnt(1)
v_mfma_f32_32x32x16_bf16 v[20:35], a[240:243], v[216:219], v[20:35]
v_mfma_f32_32x32x16_bf16 v[36:51], a[244:247], v[216:219], v[36:51]
s_waitcnt vmcnt(0)
v_mfma_f32_32x32x16_bf16 v[224:239], a[248:251], v[220:223], v[20:35]
v_mfma_f32_32x32x16_bf16 v[240:255], a[252:255], v[220:223], v[36:51]
s_branch mega_kernel_o_imm
mega_kernel_o_w1:
s_add_u32 s54, s42, s71
s_sub_u32 s62, s42, s71
s_lshr_b32 s63, s54, 2
s_xnor_b32 s63, s63, s98
s_and_b32 s63, s63, 1
s_lshl_b32 s63, s63, 13
s_lshl_b32 s50, s54, 19
s_add_u32 s50, s50, s63
s_cmp_gt_i32 s52, s54
s_cbranch_scc0 mega_kernel_o_n1
s_waitcnt vmcnt(31)
v_mfma_f32_32x32x16_bf16 v[20:35], a[0:3], v[96:99], 0
v_mfma_f32_32x32x16_bf16 v[36:51], a[4:7], v[96:99], 0
s_add_u32 s51, s56, 0
s_and_b32 s51, s51, 0x7fff
s_and_b32 s63, s51, 0x6000
s_add_u32 s51, s51, s63
s_add_u32 s51, s51, s50
buffer_load_dwordx4 v[96:99], v6, s[84:87], s51 offen offset:0 sc1
s_waitcnt vmcnt(31)
v_mfma_f32_32x32x16_bf16 v[20:35], a[8:11], v[100:103], v[20:35]
v_mfma_f32_32x32x16_bf16 v[36:51], a[12:15], v[100:103], v[36:51]
buffer_load_dwordx4 v[100:103], v6, s[84:87], s51 offen offset:1024 sc1
v_add_u32 v2, s53, v8
v_add_u32 v3, s53, v9
v_add_u32 v4, s53, v10
s_waitcnt vmcnt(31)
v_mfma_f32_32x32x16_bf16 v[20:35], a[16:19], v[104:107], v[20:35]
v_mfma_f32_32x32x16_bf16 v[36:51], a[20:23], v[104:107], v[36:51]
buffer_load_dwordx4 v[104:107], v6, s[84:87], s51 offen offset:2048 sc1
ds_write_b128 v2, v[224:227] offset:0
ds_write_b128 v2, v[228:231] offset:1088
s_waitcnt vmcnt(31)
v_mfma_f32_32x32x16_bf16 v[20:35], a[24:27], v[108:111], v[20:35]
v_mfma_f32_32x32x16_bf16 v[36:51], a[28:31], v[108:111], v[36:51]
buffer_load_dwordx4 v[108:111], v6, s[84:87], s51 offen offset:3072 sc1
ds_write_b128 v2, v[232:235] offset:2176
ds_write_b128 v2, v[236:239] offset:3264
s_waitcnt vmcnt(31)
v_mfma_f32_32x32x16_bf16 v[20:35], a[32:35], v[112:115], v[20:35]
v_mfma_f32_32x32x16_bf16 v[36:51], a[36:39], v[112:115], v[36:51]
s_add_u32 s51, s56, 4096
s_and_b32 s51, s51, 0x7fff
s_and_b32 s63, s51, 0x6000
s_add_u32 s51, s51, s63
s_add_u32 s51, s51, s50
buffer_load_dwordx4 v[112:115], v6, s[84:87], s51 offen offset:0 sc1
ds_write_b128 v2, v[240:243] offset:4352
ds_write_b128 v2, v[244:247] offset:5440
s_waitcnt vmcnt(31)
v_mfma_f32_32x32x16_bf16 v[20:35], a[40:43], v[116:119], v[20:35]
v_mfma_f32_32x32x16_bf16 v[36:51], a[44:47], v[116:119], v[36:51]
buffer_load_dwordx4 v[116:119], v6, s[84:87], s51 offen offset:1024 sc1
ds_write_b128 v2, v[248:251] offset:6528
ds_write_b128 v2, v[252:255] offset:7616
s_waitcnt vmcnt(31)
v_mfma_f32_32x32x16_bf16 v[20:35], a[48:51], v[120:123], v[20:35]
v_mfma_f32_32x32x16_bf16 v[36:51], a[52:55], v[120:123], v[36:51]
buffer_load_dwordx4 v[120:123], v6, s[84:87], s51 offen offset:2048 sc1
s_waitcnt vmcnt(31)
v_mfma_f32_32x32x16_bf16 v[20:35], a[56:59], v[124:127], v[20:35]
v_mfma_f32_32x32x16_bf16 v[36:51], a[60:63], v[124:127], v[36:51]
buffer_load_dwordx4 v[124:127], v6, s[84:87], s51 offen offset:3072 sc1
s_waitcnt lgkmcnt(0)
s_barrier
ds_read_b128 v[52:55], v4 offset:0
ds_read_b128 v[56:59], v4 offset:8704
ds_read_b128 v[60:63], v4 offset:17408
ds_read_b128 v[64:67], v4 offset:26112
s_waitcnt vmcnt(31)
v_mfma_f32_32x32x16_bf16 v[20:35], a[64:67], v[128:131], v[20:35]
v_mfma_f32_32x32x16_bf16 v[36:51], a[68:71], v[128:131], v[36:51]
s_add_u32 s51, s56, 8192
s_and_b32 s51, s51, 0x7fff
s_and_b32 s63, s51, 0x6000
s_add_u32 s51, s51, s63
s_add_u32 s51, s51, s50
buffer_load_dwordx4 v[128:131], v6, s[84:87], s51 offen offset:0 sc1
ds_read_b128 v[68:71], v3 offset:0
ds_read_b128 v[72:75], v3 offset:8704
ds_read_b128 v[76:79], v3 offset:17408
ds_read_b128 v[80:83], v3 offset:26112
s_sub_u32 s53, 34816, s53
s_sub_u32 s60, s62, s64
s_lshr_b32 s60, s60, s67
s_bfe_u32 s61, s60, 0x10001
s_and_b32 s60, s60, 1
s_lshl_b32 s60, s60, 12
s_waitcnt vmcnt(31)
v_mfma_f32_32x32x16_bf16 v[20:35], a[72:75], v[132:135], v[20:35]
v_mfma_f32_32x32x16_bf16 v[36:51], a[76:79], v[132:135], v[36:51]
buffer_load_dwordx4 v[132:135], v6, s[84:87], s51 offen offset:1024 sc1
s_waitcnt vmcnt(31)
v_mfma_f32_32x32x16_bf16 v[20:35], a[80:83], v[136:139], v[20:35]
v_mfma_f32_32x32x16_bf16 v[36:51], a[84:87], v[136:139], v[36:51]
buffer_load_dwordx4 v[136:139], v6, s[84:87], s51 offen offset:2048 sc1
s_waitcnt lgkmcnt(4)
v_add_f32 v52, v52, v56
v_add_f32 v60, v60, v64
v_add_f32 v53, v53, v57
v_add_f32 v61, v61, v65
v_add_f32 v54, v54, v58
v_add_f32 v62, v62, v66
v_add_f32 v55, v55, v59
v_add_f32 v63, v63, v67
s_waitcnt vmcnt(31)
v_mfma_f32_32x32x16_bf16 v[20:35], a[88:91], v[140:143], v[20:35]
v_mfma_f32_32x32x16_bf16 v[36:51], a[92:95], v[140:143], v[36:51]
buffer_load_dwordx4 v[140:143], v6, s[84:87], s51 offen offset:3072 sc1
v_add_f32 v52, v52, v60
v_add_f32 v53, v53, v61
v_add_f32 v54, v54, v62
v_add_f32 v55, v55, v63
v_and_or_b32 v52, v52, -2, s61
s_cmp_eq_u32 s95, 0
s_cbranch_scc1 mega_kernel_o_sa1
buffer_store_dwordx4 v[52:55], v12, s[84:87], s60 offen sc1
s_branch mega_kernel_o_sb1
mega_kernel_o_sa1:
buffer_store_dwordx4 v[52:55], v12, s[84:87], s60 offen
mega_kernel_o_sb1:
s_waitcnt vmcnt(31)
v_mfma_f32_32x32x16_bf16 v[20:35], a[96:99], v[144:147], v[20:35]
v_mfma_f32_32x32x16_bf16 v[36:51], a[100:103], v[144:147], v[36:51]
s_add_u32 s51, s56, 12288
s_and_b32 s51, s51, 0x7fff
s_and_b32 s63, s51, 0x6000
s_add_u32 s51, s51, s63
s_add_u32 s51, s51, s50
buffer_load_dwordx4 v[144:147], v6, s[84:87], s51 offen offset:0 sc1
s_waitcnt lgkmcnt(0)
v_add_f32 v68, v68, v72
v_add_f32 v76, v76, v80
v_add_f32 v69, v69, v73
v_add_f32 v77, v77, v81
v_add_f32 v70, v70, v74
v_add_f32 v78, v78, v82
v_add_f32 v71, v71, v75
v_add_f32 v79, v79, v83
s_waitcnt vmcnt(31)
v_mfma_f32_32x32x16_bf16 v[20:35], a[104:107], v[148:151], v[20:35]
v_mfma_f32_32x32x16_bf16 v[36:51], a[108:111], v[148:151], v[36:51]
buffer_load_dwordx4 v[148:151], v6, s[84:87], s51 offen offset:1024 sc1
v_add_f32 v84, v68, v76
v_add_f32 v85, v69, v77
v_add_f32 v86, v70, v78
v_add_f32 v87, v71, v79
s_waitcnt vmcnt(31)
v_mfma_f32_32x32x16_bf16 v[20:35], a[112:115], v[152:155], v[20:35]
v_mfma_f32_32x32x16_bf16 v[36:51], a[116:119], v[152:155], v[36:51]
buffer_load_dwordx4 v[152:155], v6, s[84:87], s51 offen offset:2048 sc1
s_waitcnt vmcnt(31)
v_mfma_f32_32x32x16_bf16 v[20:35], a[120:123], v[156:159], v[20:35]
v_mfma_f32_32x32x16_bf16 v[36:51], a[124:127], v[156:159], v[36:51]
buffer_load_dwordx4 v[156:159], v6, s[84:87], s51 offen offset:3072 sc1
s_waitcnt vmcnt(31)
v_mfma_f32_32x32x16_bf16 v[20:35], a[128:131], v[160:163], v[20:35]
v_mfma_f32_32x32x16_bf16 v[36:51], a[132:135], v[160:163], v[36:51]
s_add_u32 s51, s56, 16384
s_and_b32 s51, s51, 0x7fff
s_and_b32 s63, s51, 0x6000
s_add_u32 s51, s51, s63
s_add_u32 s51, s51, s50
buffer_load_dwordx4 v[160:163], v6, s[84:87], s51 offen offset:0 sc1
s_waitcnt vmcnt(31)
v_mfma_f32_32x32x16_bf16 v[20:35], a[136:139], v[164:167], v[20:35]
v_mfma_f32_32x32x16_bf16 v[36:51], a[140:143], v[164:167], v[36:51]
buffer_load_dwordx4 v[164:167], v6, s[84:87], s51 offen offset:1024 sc1
s_waitcnt vmcnt(31)
v_mfma_f32_32x32x16_bf16 v[20:35], a[144:147], v[168:171], v[20:35]
v_mfma_f32_32x32x16_bf16 v[36:51], a[148:151], v[168:171], v[36:51]
buffer_load_dwordx4 v[168:171], v6, s[84:87], s51 offen offset:2048 sc1
s_waitcnt vmcnt(31)
v_mfma_f32_32x32x16_bf16 v[20:35], a[152:155], v[172:175], v[20:35]
v_mfma_f32_32x32x16_bf16 v[36:51], a[156:159], v[172:175], v[36:51]
buffer_load_dwordx4 v[172:175], v6, s[84:87], s51 offen offset:3072 sc1
s_waitcnt vmcnt(31)
v_mfma_f32_32x32x16_bf16 v[20:35], a[160:163], v[176:179], v[20:35]
v_mfma_f32_32x32x16_bf16 v[36:51], a[164:167], v[176:179], v[36:51]
s_add_u32 s51, s56, 20480
s_and_b32 s51, s51, 0x7fff
s_and_b32 s63, s51, 0x6000
s_add_u32 s51, s51, s63
s_add_u32 s51, s51, s50
buffer_load_dwordx4 v[176:179], v6, s[84:87], s51 offen offset:0 sc1
s_waitcnt vmcnt(31)
v_mfma_f32_32x32x16_bf16 v[20:35], a[168:171], v[180:183], v[20:35]
v_mfma_f32_32x32x16_bf16 v[36:51], a[172:175], v[180:183], v[36:51]
buffer_load_dwordx4 v[180:183], v6, s[84:87], s51 offen offset:1024 sc1
s_waitcnt vmcnt(31)
v_mfma_f32_32x32x16_bf16 v[20:35], a[176:179], v[184:187], v[20:35]
v_mfma_f32_32x32x16_bf16 v[36:51], a[180:183], v[184:187], v[36:51]
buffer_load_dwordx4 v[184:187], v6, s[84:87], s51 offen offset:2048 sc1
s_waitcnt vmcnt(31)
v_mfma_f32_32x32x16_bf16 v[20:35], a[184:187], v[188:191], v[20:35]
v_mfma_f32_32x32x16_bf16 v[36:51], a[188:191], v[188:191], v[36:51]
buffer_load_dwordx4 v[188:191], v6, s[84:87], s51 offen offset:3072 sc1
s_waitcnt vmcnt(31)
v_mfma_f32_32x32x16_bf16 v[20:35], a[192:195], v[192:195], v[20:35]
v_mfma_f32_32x32x16_bf16 v[36:51], a[196:199], v[192:195], v[36:51]
s_add_u32 s51, s56, 24576
s_and_b32 s51, s51, 0x7fff
s_and_b32 s63, s51, 0x6000
s_add_u32 s51, s51, s63
s_add_u32 s51, s51, s50
buffer_load_dwordx4 v[192:195], v6, s[84:87], s51 offen offset:0 sc1
s_waitcnt vmcnt(31)
v_mfma_f32_32x32x16_bf16 v[20:35], a[200:203], v[196:199], v[20:35]
v_mfma_f32_32x32x16_bf16 v[36:51], a[204:207], v[196:199], v[36:51]
buffer_load_dwordx4 v[196:199], v6, s[84:87], s51 offen offset:1024 sc1
s_waitcnt vmcnt(31)
v_mfma_f32_32x32x16_bf16 v[20:35], a[208:211], v[200:203], v[20:35]
v_mfma_f32_32x32x16_bf16 v[36:51], a[212:215], v[200:203], v[36:51]
buffer_load_dwordx4 v[200:203], v6, s[84:87], s51 offen offset:2048 sc1
s_waitcnt vmcnt(31)
v_mfma_f32_32x32x16_bf16 v[20:35], a[216:219], v[204:207], v[20:35]
v_mfma_f32_32x32x16_bf16 v[36:51], a[220:223], v[204:207], v[36:51]
buffer_load_dwordx4 v[204:207], v6, s[84:87], s51 offen offset:3072 sc1
s_sub_u32 s60, s62, s64
s_lshr_b32 s60, s60, s67
s_bfe_u32 s61, s60, 0x10001
s_and_b32 s60, s60, 1
s_lshl_b32 s60, s60, 12
buffer_load_dwordx4 v[88:91], v13, s[84:87], s60 offen sc1
s_waitcnt vmcnt(31)
v_mfma_f32_32x32x16_bf16 v[20:35], a[224:227], v[208:211], v[20:35]
v_mfma_f32_32x32x16_bf16 v[36:51], a[228:231], v[208:211], v[36:51]
s_add_u32 s51, s56, 28672
s_and_b32 s51, s51, 0x7fff
s_and_b32 s63, s51, 0x6000
s_add_u32 s51, s51, s63
s_add_u32 s51, s51, s50
buffer_load_dwordx4 v[208:211], v6, s[84:87], s51 offen offset:0 sc1
s_waitcnt vmcnt(31)
v_mfma_f32_32x32x16_bf16 v[20:35], a[232:235], v[212:215], v[20:35]
v_mfma_f32_32x32x16_bf16 v[36:51], a[236:239], v[212:215], v[36:51]
buffer_load_dwordx4 v[212:215], v6, s[84:87], s51 offen offset:1024 sc1
s_waitcnt vmcnt(31)
v_mfma_f32_32x32x16_bf16 v[20:35], a[240:243], v[216:219], v[20:35]
v_mfma_f32_32x32x16_bf16 v[36:51], a[244:247], v[216:219], v[36:51]
buffer_load_dwordx4 v[216:219], v6, s[84:87], s51 offen offset:2048 sc1
s_waitcnt vmcnt(31)
v_mfma_f32_32x32x16_bf16 v[224:239], a[248:251], v[220:223], v[20:35]
v_mfma_f32_32x32x16_bf16 v[240:255], a[252:255], v[220:223], v[36:51]
buffer_load_dwordx4 v[220:223], v6, s[84:87], s51 offen offset:3072 sc1
s_waitcnt vmcnt(4)
mega_kernel_o_f1c:
v_and_b32 v14, 1, v88
v_cmp_ne_u32 vcc, s61, v14
s_cbranch_vccz mega_kernel_o_f1k
s_sub_u32 s60, s62, s64
s_lshr_b32 s60, s60, s67
s_bfe_u32 s61, s60, 0x10001
s_and_b32 s60, s60, 1
s_lshl_b32 s60, s60, 12
buffer_load_dwordx4 v[88:91], v13, s[84:87], s60 offen sc1
s_waitcnt vmcnt(0)
s_branch mega_kernel_o_f1c
mega_kernel_o_f1k:
v_pk_add_f32 v[88:89], v[88:89], v[84:85]
v_pk_add_f32 v[90:91], v[90:91], v[86:87]
s_lshl_b32 s60, s62, 17
v_cvt_pk_bf16_f32 v92, v88, v89
v_cvt_pk_bf16_f32 v93, v90, v91
buffer_store_dwordx2 v[92:93], v11, s[8:11], s60 offen sc1
s_add_u32 s42, s42, s71
s_branch mega_kernel_o_w1
mega_kernel_o_n1:
s_waitcnt vmcnt(31)
v_mfma_f32_32x32x16_bf16 v[20:35], a[0:3], v[96:99], 0
v_mfma_f32_32x32x16_bf16 v[36:51], a[4:7], v[96:99], 0
s_waitcnt vmcnt(30)
v_mfma_f32_32x32x16_bf16 v[20:35], a[8:11], v[100:103], v[20:35]
v_mfma_f32_32x32x16_bf16 v[36:51], a[12:15], v[100:103], v[36:51]
v_add_u32 v2, s53, v8
v_add_u32 v3, s53, v9
v_add_u32 v4, s53, v10
s_waitcnt vmcnt(29)
v_mfma_f32_32x32x16_bf16 v[20:35], a[16:19], v[104:107], v[20:35]
v_mfma_f32_32x32x16_bf16 v[36:51], a[20:23], v[104:107], v[36:51]
ds_write_b128 v2, v[224:227] offset:0
ds_write_b128 v2, v[228:231] offset:1088
s_waitcnt vmcnt(28)
v_mfma_f32_32x32x16_bf16 v[20:35], a[24:27], v[108:111], v[20:35]
v_mfma_f32_32x32x16_bf16 v[36:51], a[28:31], v[108:111], v[36:51]
ds_write_b128 v2, v[232:235] offset:2176
ds_write_b128 v2, v[236:239] offset:3264
s_waitcnt vmcnt(27)
v_mfma_f32_32x32x16_bf16 v[20:35], a[32:35], v[112:115], v[20:35]
v_mfma_f32_32x32x16_bf16 v[36:51], a[36:39], v[112:115], v[36:51]
ds_write_b128 v2, v[240:243] offset:4352
ds_write_b128 v2, v[244:247] offset:5440
s_waitcnt vmcnt(26)
v_mfma_f32_32x32x16_bf16 v[20:35], a[40:43], v[116:119], v[20:35]
v_mfma_f32_32x32x16_bf16 v[36:51], a[44:47], v[116:119], v[36:51]
ds_write_b128 v2, v[248:251] offset:6528
ds_write_b128 v2, v[252:255] offset:7616
s_waitcnt vmcnt(25)
v_mfma_f32_32x32x16_bf16 v[20:35], a[48:51], v[120:123], v[20:35]
v_mfma_f32_32x32x16_bf16 v[36:51], a[52:55], v[120:123], v[36:51]
s_waitcnt vmcnt(24)
v_mfma_f32_32x32x16_bf16 v[20:35], a[56:59], v[124:127], v[20:35]
v_mfma_f32_32x32x16_bf16 v[36:51], a[60:63], v[124:127], v[36:51]
s_waitcnt lgkmcnt(0)
s_barrier
ds_read_b128 v[52:55], v4 offset:0
ds_read_b128 v[56:59], v4 offset:8704
ds_read_b128 v[60:63], v4 offset:17408
ds_read_b128 v[64:67], v4 offset:26112
s_waitcnt vmcnt(23)
v_mfma_f32_32x32x16_bf16 v[20:35], a[64:67], v[128:131], v[20:35]
v_mfma_f32_32x32x16_bf16 v[36:51], a[68:71], v[128:131], v[36:51]
ds_read_b128 v[68:71], v3 offset:0
ds_read_b128 v[72:75], v3 offset:8704
ds_read_b128 v[76:79], v3 offset:17408
ds_read_b128 v[80:83], v3 offset:26112
s_sub_u32 s53, 34816, s53
s_sub_u32 s60, s62, s64
s_lshr_b32 s60, s60, s67
s_bfe_u32 s61, s60, 0x10001
s_and_b32 s60, s60, 1
s_lshl_b32 s60, s60, 12
s_waitcnt vmcnt(22)
v_mfma_f32_32x32x16_bf16 v[20:35], a[72:75], v[132:135], v[20:35]
v_mfma_f32_32x32x16_bf16 v[36:51], a[76:79], v[132:135], v[36:51]
s_waitcnt vmcnt(21)
v_mfma_f32_32x32x16_bf16 v[20:35], a[80:83], v[136:139], v[20:35]
v_mfma_f32_32x32x16_bf16 v[36:51], a[84:87], v[136:139], v[36:51]
s_waitcnt lgkmcnt(4)
v_add_f32 v52, v52, v56
v_add_f32 v60, v60, v64
v_add_f32 v53, v53, v57
v_add_f32 v61, v61, v65
v_add_f32 v54, v54, v58
v_add_f32 v62, v62, v66
v_add_f32 v55, v55, v59
v_add_f32 v63, v63, v67
s_waitcnt vmcnt(20)
v_mfma_f32_32x32x16_bf16 v[20:35], a[88:91], v[140:143], v[20:35]
v_mfma_f32_32x32x16_bf16 v[36:51], a[92:95], v[140:143], v[36:51]
v_add_f32 v52, v52, v60
v_add_f32 v53, v53, v61
v_add_f32 v54, v54, v62
v_add_f32 v55, v55, v63
v_and_or_b32 v52, v52, -2, s61
s_cmp_eq_u32 s95, 0
s_cbranch_scc1 mega_kernel_o_sa2
buffer_store_dwordx4 v[52:55], v12, s[84:87], s60 offen sc1
s_branch mega_kernel_o_sb2
mega_kernel_o_sa2:
buffer_store_dwordx4 v[52:55], v12, s[84:87], s60 offen
mega_kernel_o_sb2:
s_waitcnt vmcnt(19)
v_mfma_f32_32x32x16_bf16 v[20:35], a[96:99], v[144:147], v[20:35]
v_mfma_f32_32x32x16_bf16 v[36:51], a[100:103], v[144:147], v[36:51]
s_waitcnt lgkmcnt(0)
v_add_f32 v68, v68, v72
v_add_f32 v76, v76, v80
v_add_f32 v69, v69, v73
v_add_f32 v77, v77, v81
v_add_f32 v70, v70, v74
v_add_f32 v78, v78, v82
v_add_f32 v71, v71, v75
v_add_f32 v79, v79, v83
s_waitcnt vmcnt(18)
v_mfma_f32_32x32x16_bf16 v[20:35], a[104:107], v[148:151], v[20:35]
v_mfma_f32_32x32x16_bf16 v[36:51], a[108:111], v[148:151], v[36:51]
v_add_f32 v84, v68, v76
v_add_f32 v85, v69, v77
v_add_f32 v86, v70, v78
v_add_f32 v87, v71, v79
s_waitcnt vmcnt(17)
v_mfma_f32_32x32x16_bf16 v[20:35], a[112:115], v[152:155], v[20:35]
v_mfma_f32_32x32x16_bf16 v[36:51], a[116:119], v[152:155], v[36:51]
s_waitcnt vmcnt(16)
v_mfma_f32_32x32x16_bf16 v[20:35], a[120:123], v[156:159], v[20:35]
v_mfma_f32_32x32x16_bf16 v[36:51], a[124:127], v[156:159], v[36:51]
s_waitcnt vmcnt(15)
v_mfma_f32_32x32x16_bf16 v[20:35], a[128:131], v[160:163], v[20:35]
v_mfma_f32_32x32x16_bf16 v[36:51], a[132:135], v[160:163], v[36:51]
s_waitcnt vmcnt(14)
v_mfma_f32_32x32x16_bf16 v[20:35], a[136:139], v[164:167], v[20:35]
v_mfma_f32_32x32x16_bf16 v[36:51], a[140:143], v[164:167], v[36:51]
s_waitcnt vmcnt(13)
v_mfma_f32_32x32x16_bf16 v[20:35], a[144:147], v[168:171], v[20:35]
v_mfma_f32_32x32x16_bf16 v[36:51], a[148:151], v[168:171], v[36:51]
s_waitcnt vmcnt(12)
v_mfma_f32_32x32x16_bf16 v[20:35], a[152:155], v[172:175], v[20:35]
v_mfma_f32_32x32x16_bf16 v[36:51], a[156:159], v[172:175], v[36:51]
s_waitcnt vmcnt(11)
v_mfma_f32_32x32x16_bf16 v[20:35], a[160:163], v[176:179], v[20:35]
v_mfma_f32_32x32x16_bf16 v[36:51], a[164:167], v[176:179], v[36:51]
buffer_load_dword v15, v7, s[84:87], 0 offen sc1
s_waitcnt vmcnt(10)
v_mfma_f32_32x32x16_bf16 v[20:35], a[168:171], v[180:183], v[20:35]
v_mfma_f32_32x32x16_bf16 v[36:51], a[172:175], v[180:183], v[36:51]
s_waitcnt vmcnt(9)
v_mfma_f32_32x32x16_bf16 v[20:35], a[176:179], v[184:187], v[20:35]
v_mfma_f32_32x32x16_bf16 v[36:51], a[180:183], v[184:187], v[36:51]
s_waitcnt vmcnt(8)
v_mfma_f32_32x32x16_bf16 v[20:35], a[184:187], v[188:191], v[20:35]
v_mfma_f32_32x32x16_bf16 v[36:51], a[188:191], v[188:191], v[36:51]
s_waitcnt vmcnt(7)
v_mfma_f32_32x32x16_bf16 v[20:35], a[192:195], v[192:195], v[20:35]
v_mfma_f32_32x32x16_bf16 v[36:51], a[196:199], v[192:195], v[36:51]
s_waitcnt vmcnt(6)
v_mfma_f32_32x32x16_bf16 v[20:35], a[200:203], v[196:199], v[20:35]
v_mfma_f32_32x32x16_bf16 v[36:51], a[204:207], v[196:199], v[36:51]
s_waitcnt vmcnt(5)
v_mfma_f32_32x32x16_bf16 v[20:35], a[208:211], v[200:203], v[20:35]
v_mfma_f32_32x32x16_bf16 v[36:51], a[212:215], v[200:203], v[36:51]
s_waitcnt vmcnt(4)
v_mfma_f32_32x32x16_bf16 v[20:35], a[216:219], v[204:207], v[20:35]
v_mfma_f32_32x32x16_bf16 v[36:51], a[220:223], v[204:207], v[36:51]
s_sub_u32 s60, s62, s64
s_lshr_b32 s60, s60, s67
s_bfe_u32 s61, s60, 0x10001
s_and_b32 s60, s60, 1
s_lshl_b32 s60, s60, 12
buffer_load_dwordx4 v[88:91], v13, s[84:87], s60 offen sc1
s_waitcnt vmcnt(3)
v_mfma_f32_32x32x16_bf16 v[20:35], a[224:227], v[208:211], v[20:35]
v_mfma_f32_32x32x16_bf16 v[36:51], a[228:231], v[208:211], v[36:51]
s_waitcnt vmcnt(2)
v_mfma_f32_32x32x16_bf16 v[20:35], a[232:235], v[212:215], v[20:35]
v_mfma_f32_32x32x16_bf16 v[36:51], a[236:239], v[212:215], v[36:51]
s_waitcnt vmcnt(1)
v_mfma_f32_32x32x16_bf16 v[20:35], a[240:243], v[216:219], v[20:35]
v_mfma_f32_32x32x16_bf16 v[36:51], a[244:247], v[216:219], v[36:51]
s_waitcnt vmcnt(0)
v_mfma_f32_32x32x16_bf16 v[224:239], a[248:251], v[220:223], v[20:35]
v_mfma_f32_32x32x16_bf16 v[240:255], a[252:255], v[220:223], v[36:51]
s_waitcnt vmcnt(0)
mega_kernel_o_f0c:
v_and_b32 v14, 1, v88
v_cmp_ne_u32 vcc, s61, v14
s_cbranch_vccz mega_kernel_o_f0k
s_sub_u32 s60, s62, s64
s_lshr_b32 s60, s60, s67
s_bfe_u32 s61, s60, 0x10001
s_and_b32 s60, s60, 1
s_lshl_b32 s60, s60, 12
buffer_load_dwordx4 v[88:91], v13, s[84:87], s60 offen sc1
s_waitcnt vmcnt(0)
s_branch mega_kernel_o_f0c
mega_kernel_o_f0k:
v_pk_add_f32 v[88:89], v[88:89], v[84:85]
v_pk_add_f32 v[90:91], v[90:91], v[86:87]
s_lshl_b32 s60, s62, 17
v_cvt_pk_bf16_f32 v92, v88, v89
v_cvt_pk_bf16_f32 v93, v90, v91
buffer_store_dwordx2 v[92:93], v11, s[8:11], s60 offen sc1
mega_kernel_o_imm:
s_waitcnt vmcnt(1)
v_min_i32_dpp v15, v15, v15 quad_perm:[1,0,3,2] row_mask:0xf bank_mask:0xf
s_nop 1
v_min_i32_dpp v15, v15, v15 quad_perm:[2,3,0,1] row_mask:0xf bank_mask:0xf
s_nop 1
v_min_i32_dpp v15, v15, v15 row_ror:4 row_mask:0xf bank_mask:0xf
s_nop 1
v_min_i32_dpp v15, v15, v15 row_ror:8 row_mask:0xf bank_mask:0xf
s_nop 0
v_readfirstlane_b32 s52, v15
s_min_i32 s52, s52, s65
s_cmp_gt_i32 s52, s54
s_cbranch_scc0 mega_kernel_o_im2
s_add_u32 s42, s42, s71
s_add_u32 s54, s54, s71
s_cmp_gt_i32 s52, s54
s_cbranch_scc0 mega_kernel_o_c1
s_add_u32 s51, s56, 0
s_and_b32 s51, s51, 0x7fff
s_and_b32 s63, s51, 0x6000
s_add_u32 s51, s51, s63
s_add_u32 s51, s51, s50
buffer_load_dwordx4 v[96:99], v6, s[84:87], s51 offen offset:0 sc1
buffer_load_dwordx4 v[100:103], v6, s[84:87], s51 offen offset:1024 sc1
buffer_load_dwordx4 v[104:107], v6, s[84:87], s51 offen offset:2048 sc1
buffer_load_dwordx4 v[108:111], v6, s[84:87], s51 offen offset:3072 sc1
s_add_u32 s51, s56, 4096
s_and_b32 s51, s51, 0x7fff
s_and_b32 s63, s51, 0x6000
s_add_u32 s51, s51, s63
s_add_u32 s51, s51, s50
buffer_load_dwordx4 v[112:115], v6, s[84:87], s51 offen offset:0 sc1
buffer_load_dwordx4 v[116:119], v6, s[84:87], s51 offen offset:1024 sc1
buffer_load_dwordx4 v[120:123], v6, s[84:87], s51 offen offset:2048 sc1
buffer_load_dwordx4 v[124:127], v6, s[84:87], s51 offen offset:3072 sc1
s_add_u32 s51, s56, 8192
s_and_b32 s51, s51, 0x7fff
s_and_b32 s63, s51, 0x6000
s_add_u32 s51, s51, s63
s_add_u32 s51, s51, s50
buffer_load_dwordx4 v[128:131], v6, s[84:87], s51 offen offset:0 sc1
buffer_load_dwordx4 v[132:135], v6, s[84:87], s51 offen offset:1024 sc1
buffer_load_dwordx4 v[136:139], v6, s[84:87], s51 offen offset:2048 sc1
buffer_load_dwordx4 v[140:143], v6, s[84:87], s51 offen offset:3072 sc1
s_add_u32 s51, s56, 12288
s_and_b32 s51, s51, 0x7fff
s_and_b32 s63, s51, 0x6000
s_add_u32 s51, s51, s63
s_add_u32 s51, s51, s50
buffer_load_dwordx4 v[144:147], v6, s[84:87], s51 offen offset:0 sc1
buffer_load_dwordx4 v[148:151], v6, s[84:87], s51 offen offset:1024 sc1
buffer_load_dwordx4 v[152:155], v6, s[84:87], s51 offen offset:2048 sc1
buffer_load_dwordx4 v[156:159], v6, s[84:87], s51 offen offset:3072 sc1
s_add_u32 s51, s56, 16384
s_and_b32 s51, s51, 0x7fff
s_and_b32 s63, s51, 0x6000
s_add_u32 s51, s51, s63
s_add_u32 s51, s51, s50
buffer_load_dwordx4 v[160:163], v6, s[84:87], s51 offen offset:0 sc1
buffer_load_dwordx4 v[164:167], v6, s[84:87], s51 offen offset:1024 sc1
buffer_load_dwordx4 v[168:171], v6, s[84:87], s51 offen offset:2048 sc1
buffer_load_dwordx4 v[172:175], v6, s[84:87], s51 offen offset:3072 sc1
s_add_u32 s51, s56, 20480
s_and_b32 s51, s51, 0x7fff
s_and_b32 s63, s51, 0x6000
s_add_u32 s51, s51, s63
s_add_u32 s51, s51, s50
buffer_load_dwordx4 v[176:179], v6, s[84:87], s51 offen offset:0 sc1
buffer_load_dwordx4 v[180:183], v6, s[84:87], s51 offen offset:1024 sc1
buffer_load_dwordx4 v[184:187], v6, s[84:87], s51 offen offset:2048 sc1
buffer_load_dwordx4 v[188:191], v6, s[84:87], s51 offen offset:3072 sc1
s_add_u32 s51, s56, 24576
s_and_b32 s51, s51, 0x7fff
s_and_b32 s63, s51, 0x6000
s_add_u32 s51, s51, s63
s_add_u32 s51, s51, s50
buffer_load_dwordx4 v[192:195], v6, s[84:87], s51 offen offset:0 sc1
buffer_load_dwordx4 v[196:199], v6, s[84:87], s51 offen offset:1024 sc1
buffer_load_dwordx4 v[200:203], v6, s[84:87], s51 offen offset:2048 sc1
buffer_load_dwordx4 v[204:207], v6, s[84:87], s51 offen offset:3072 sc1
s_add_u32 s51, s56, 28672
s_and_b32 s51, s51, 0x7fff
s_and_b32 s63, s51, 0x6000
s_add_u32 s51, s51, s63
s_add_u32 s51, s51, s50
buffer_load_dwordx4 v[208:211], v6, s[84:87], s51 offen offset:0 sc1
buffer_load_dwordx4 v[212:215], v6, s[84:87], s51 offen offset:1024 sc1
buffer_load_dwordx4 v[216:219], v6, s[84:87], s51 offen offset:2048 sc1
buffer_load_dwordx4 v[220:223], v6, s[84:87], s51 offen offset:3072 sc1
s_branch mega_kernel_o_w1
mega_kernel_o_c0:
s_add_u32 s54, s42, s71
s_sub_u32 s62, s42, s71
s_lshr_b32 s63, s42, 2
s_xnor_b32 s63, s63, s98
s_and_b32 s63, s63, 1
s_lshl_b32 s63, s63, 13
s_lshl_b32 s50, s42, 19
s_add_u32 s50, s50, s63
s_add_u32 s51, s56, 0
s_and_b32 s51, s51, 0x7fff
s_and_b32 s63, s51, 0x6000
s_add_u32 s51, s51, s63
s_add_u32 s51, s51, s50
buffer_load_dwordx4 v[96:99], v6, s[84:87], s51 offen offset:0 sc1
buffer_load_dwordx4 v[100:103], v6, s[84:87], s51 offen offset:1024 sc1
buffer_load_dwordx4 v[104:107], v6, s[84:87], s51 offen offset:2048 sc1
buffer_load_dwordx4 v[108:111], v6, s[84:87], s51 offen offset:3072 sc1
s_add_u32 s51, s56, 4096
s_and_b32 s51, s51, 0x7fff
s_and_b32 s63, s51, 0x6000
s_add_u32 s51, s51, s63
s_add_u32 s51, s51, s50
buffer_load_dwordx4 v[112:115], v6, s[84:87], s51 offen offset:0 sc1
buffer_load_dwordx4 v[116:119], v6, s[84:87], s51 offen offset:1024 sc1
buffer_load_dwordx4 v[120:123], v6, s[84:87], s51 offen offset:2048 sc1
buffer_load_dwordx4 v[124:127], v6, s[84:87], s51 offen offset:3072 sc1
s_waitcnt vmcnt(7)
v_mfma_f32_32x32x16_bf16 v[20:35], a[0:3], v[96:99], 0
v_mfma_f32_32x32x16_bf16 v[36:51], a[4:7], v[96:99], 0
s_add_u32 s51, s56, 8192
s_and_b32 s51, s51, 0x7fff
s_and_b32 s63, s51, 0x6000
s_add_u32 s51, s51, s63
s_add_u32 s51, s51, s50
buffer_load_dwordx4 v[128:131], v6, s[84:87], s51 offen offset:0 sc1
s_waitcnt vmcnt(7)
v_mfma_f32_32x32x16_bf16 v[20:35], a[8:11], v[100:103], v[20:35]
v_mfma_f32_32x32x16_bf16 v[36:51], a[12:15], v[100:103], v[36:51]
buffer_load_dwordx4 v[132:135], v6, s[84:87], s51 offen offset:1024 sc1
s_waitcnt vmcnt(7)
v_mfma_f32_32x32x16_bf16 v[20:35], a[16:19], v[104:107], v[20:35]
v_mfma_f32_32x32x16_bf16 v[36:51], a[20:23], v[104:107], v[36:51]
buffer_load_dwordx4 v[136:139], v6, s[84:87], s51 offen offset:2048 sc1
s_waitcnt vmcnt(7)
v_mfma_f32_32x32x16_bf16 v[20:35], a[24:27], v[108:111], v[20:35]
v_mfma_f32_32x32x16_bf16 v[36:51], a[28:31], v[108:111], v[36:51]
buffer_load_dwordx4 v[140:143], v6, s[84:87], s51 offen offset:3072 sc1
s_waitcnt vmcnt(7)
v_mfma_f32_32x32x16_bf16 v[20:35], a[32:35], v[112:115], v[20:35]
v_mfma_f32_32x32x16_bf16 v[36:51], a[36:39], v[112:115], v[36:51]
s_add_u32 s51, s56, 12288
s_and_b32 s51, s51, 0x7fff
s_and_b32 s63, s51, 0x6000
s_add_u32 s51, s51, s63
s_add_u32 s51, s51, s50
buffer_load_dwordx4 v[144:147], v6, s[84:87], s51 offen offset:0 sc1
s_waitcnt vmcnt(7)
v_mfma_f32_32x32x16_bf16 v[20:35], a[40:43], v[116:119], v[20:35]
v_mfma_f32_32x32x16_bf16 v[36:51], a[44:47], v[116:119], v[36:51]
buffer_load_dwordx4 v[148:151], v6, s[84:87], s51 offen offset:1024 sc1
s_waitcnt vmcnt(7)
v_mfma_f32_32x32x16_bf16 v[20:35], a[48:51], v[120:123], v[20:35]
v_mfma_f32_32x32x16_bf16 v[36:51], a[52:55], v[120:123], v[36:51]
buffer_load_dwordx4 v[152:155], v6, s[84:87], s51 offen offset:2048 sc1
s_waitcnt vmcnt(7)
v_mfma_f32_32x32x16_bf16 v[20:35], a[56:59], v[124:127], v[20:35]
v_mfma_f32_32x32x16_bf16 v[36:51], a[60:63], v[124:127], v[36:51]
buffer_load_dwordx4 v[156:159], v6, s[84:87], s51 offen offset:3072 sc1
s_waitcnt vmcnt(7)
v_mfma_f32_32x32x16_bf16 v[20:35], a[64:67], v[128:131], v[20:35]
v_mfma_f32_32x32x16_bf16 v[36:51], a[68:71], v[128:131], v[36:51]
s_add_u32 s51, s56, 16384
s_and_b32 s51, s51, 0x7fff
s_and_b32 s63, s51, 0x6000
s_add_u32 s51, s51, s63
s_add_u32 s51, s51, s50
buffer_load_dwordx4 v[160:163], v6, s[84:87], s51 offen offset:0 sc1
s_waitcnt vmcnt(7)
v_mfma_f32_32x32x16_bf16 v[20:35], a[72:75], v[132:135], v[20:35]
v_mfma_f32_32x32x16_bf16 v[36:51], a[76:79], v[132:135], v[36:51]
buffer_load_dwordx4 v[164:167], v6, s[84:87], s51 offen offset:1024 sc1
s_waitcnt vmcnt(7)
v_mfma_f32_32x32x16_bf16 v[20:35], a[80:83], v[136:139], v[20:35]
v_mfma_f32_32x32x16_bf16 v[36:51], a[84:87], v[136:139], v[36:51]
buffer_load_dwordx4 v[168:171], v6, s[84:87], s51 offen offset:2048 sc1
s_waitcnt vmcnt(7)
v_mfma_f32_32x32x16_bf16 v[20:35], a[88:91], v[140:143], v[20:35]
v_mfma_f32_32x32x16_bf16 v[36:51], a[92:95], v[140:143], v[36:51]
buffer_load_dwordx4 v[172:175], v6, s[84:87], s51 offen offset:3072 sc1
s_waitcnt vmcnt(7)
v_mfma_f32_32x32x16_bf16 v[20:35], a[96:99], v[144:147], v[20:35]
v_mfma_f32_32x32x16_bf16 v[36:51], a[100:103], v[144:147], v[36:51]
s_add_u32 s51, s56, 20480
s_and_b32 s51, s51, 0x7fff
s_and_b32 s63, s51, 0x6000
s_add_u32 s51, s51, s63
s_add_u32 s51, s51, s50
buffer_load_dwordx4 v[176:179], v6, s[84:87], s51 offen offset:0 sc1
s_waitcnt vmcnt(7)
v_mfma_f32_32x32x16_bf16 v[20:35], a[104:107], v[148:151], v[20:35]
v_mfma_f32_32x32x16_bf16 v[36:51], a[108:111], v[148:151], v[36:51]
buffer_load_dwordx4 v[180:183], v6, s[84:87], s51 offen offset:1024 sc1
s_waitcnt vmcnt(7)
v_mfma_f32_32x32x16_bf16 v[20:35], a[112:115], v[152:155], v[20:35]
v_mfma_f32_32x32x16_bf16 v[36:51], a[116:119], v[152:155], v[36:51]
buffer_load_dwordx4 v[184:187], v6, s[84:87], s51 offen offset:2048 sc1
s_waitcnt vmcnt(7)
v_mfma_f32_32x32x16_bf16 v[20:35], a[120:123], v[156:159], v[20:35]
v_mfma_f32_32x32x16_bf16 v[36:51], a[124:127], v[156:159], v[36:51]
buffer_load_dwordx4 v[188:191], v6, s[84:87], s51 offen offset:3072 sc1
s_waitcnt vmcnt(7)
v_mfma_f32_32x32x16_bf16 v[20:35], a[128:131], v[160:163], v[20:35]
v_mfma_f32_32x32x16_bf16 v[36:51], a[132:135], v[160:163], v[36:51]
s_add_u32 s51, s56, 24576
s_and_b32 s51, s51, 0x7fff
s_and_b32 s63, s51, 0x6000
s_add_u32 s51, s51, s63
s_add_u32 s51, s51, s50
buffer_load_dwordx4 v[192:195], v6, s[84:87], s51 offen offset:0 sc1
s_waitcnt vmcnt(7)
v_mfma_f32_32x32x16_bf16 v[20:35], a[136:139], v[164:167], v[20:35]
v_mfma_f32_32x32x16_bf16 v[36:51], a[140:143], v[164:167], v[36:51]
buffer_load_dwordx4 v[196:199], v6, s[84:87], s51 offen offset:1024 sc1
s_waitcnt vmcnt(7)
v_mfma_f32_32x32x16_bf16 v[20:35], a[144:147], v[168:171], v[20:35]
v_mfma_f32_32x32x16_bf16 v[36:51], a[148:151], v[168:171], v[36:51]
buffer_load_dwordx4 v[200:203], v6, s[84:87], s51 offen offset:2048 sc1
s_waitcnt vmcnt(7)
v_mfma_f32_32x32x16_bf16 v[20:35], a[152:155], v[172:175], v[20:35]
v_mfma_f32_32x32x16_bf16 v[36:51], a[156:159], v[172:175], v[36:51]
buffer_load_dwordx4 v[204:207], v6, s[84:87], s51 offen offset:3072 sc1
s_waitcnt vmcnt(7)
v_mfma_f32_32x32x16_bf16 v[20:35], a[160:163], v[176:179], v[20:35]
v_mfma_f32_32x32x16_bf16 v[36:51], a[164:167], v[176:179], v[36:51]
s_add_u32 s51, s56, 28672
s_and_b32 s51, s51, 0x7fff
s_and_b32 s63, s51, 0x6000
s_add_u32 s51, s51, s63
s_add_u32 s51, s51, s50
buffer_load_dwordx4 v[208:211], v6, s[84:87], s51 offen offset:0 sc1
s_waitcnt vmcnt(7)
v_mfma_f32_32x32x16_bf16 v[20:35], a[168:171], v[180:183], v[20:35]
v_mfma_f32_32x32x16_bf16 v[36:51], a[172:175], v[180:183], v[36:51]
buffer_load_dwordx4 v[212:215], v6, s[84:87], s51 offen offset:1024 sc1
s_waitcnt vmcnt(7)
v_mfma_f32_32x32x16_bf16 v[20:35], a[176:179], v[184:187], v[20:35]
v_mfma_f32_32x32x16_bf16 v[36:51], a[180:183], v[184:187], v[36:51]
buffer_load_dwordx4 v[216:219], v6, s[84:87], s51 offen offset:2048 sc1
s_waitcnt vmcnt(7)
v_mfma_f32_32x32x16_bf16 v[20:35], a[184:187], v[188:191], v[20:35]
v_mfma_f32_32x32x16_bf16 v[36:51], a[188:191], v[188:191], v[36:51]
buffer_load_dwordx4 v[220:223], v6, s[84:87], s51 offen offset:3072 sc1
s_waitcnt vmcnt(7)
v_mfma_f32_32x32x16_bf16 v[20:35], a[192:195], v[192:195], v[20:35]
v_mfma_f32_32x32x16_bf16 v[36:51], a[196:199], v[192:195], v[36:51]
buffer_load_dword v15, v7, s[84:87], 0 offen sc1
s_waitcnt vmcnt(6)
v_mfma_f32_32x32x16_bf16 v[20:35], a[200:203], v[196:199], v[20:35]
v_mfma_f32_32x32x16_bf16 v[36:51], a[204:207], v[196:199], v[36:51]
s_waitcnt vmcnt(5)
v_mfma_f32_32x32x16_bf16 v[20:35], a[208:211], v[200:203], v[20:35]
v_mfma_f32_32x32x16_bf16 v[36:51], a[212:215], v[200:203], v[36:51]
s_waitcnt vmcnt(4)
v_mfma_f32_32x32x16_bf16 v[20:35], a[216:219], v[204:207], v[20:35]
v_mfma_f32_32x32x16_bf16 v[36:51], a[220:223], v[204:207], v[36:51]
s_waitcnt vmcnt(3)
v_mfma_f32_32x32x16_bf16 v[20:35], a[224:227], v[208:211], v[20:35]
v_mfma_f32_32x32x16_bf16 v[36:51], a[228:231], v[208:211], v[36:51]
s_waitcnt vmcnt(2)
v_mfma_f32_32x32x16_bf16 v[20:35], a[232:235], v[212:215], v[20:35]
v_mfma_f32_32x32x16_bf16 v[36:51], a[236:239], v[212:215], v[36:51]
s_waitcnt vmcnt(1)
v_mfma_f32_32x32x16_bf16 v[20:35], a[240:243], v[216:219], v[20:35]
v_mfma_f32_32x32x16_bf16 v[36:51], a[244:247], v[216:219], v[36:51]
s_waitcnt vmcnt(0)
v_mfma_f32_32x32x16_bf16 v[224:239], a[248:251], v[220:223], v[20:35]
v_mfma_f32_32x32x16_bf16 v[240:255], a[252:255], v[220:223], v[36:51]
s_lshr_b32 s63, s54, 2
s_xnor_b32 s63, s63, s98
s_and_b32 s63, s63, 1
s_lshl_b32 s63, s63, 13
s_lshl_b32 s50, s54, 19
s_add_u32 s50, s50, s63
s_branch mega_kernel_o_imm
mega_kernel_o_c1:
s_add_u32 s54, s42, s71
s_sub_u32 s62, s42, s71
s_lshr_b32 s63, s42, 2
s_xnor_b32 s63, s63, s98
s_and_b32 s63, s63, 1
s_lshl_b32 s63, s63, 13
s_lshl_b32 s50, s42, 19
s_add_u32 s50, s50, s63
s_add_u32 s51, s56, 0
s_and_b32 s51, s51, 0x7fff
s_and_b32 s63, s51, 0x6000
s_add_u32 s51, s51, s63
s_add_u32 s51, s51, s50
buffer_load_dwordx4 v[96:99], v6, s[84:87], s51 offen offset:0 sc1
buffer_load_dwordx4 v[100:103], v6, s[84:87], s51 offen offset:1024 sc1
buffer_load_dwordx4 v[104:107], v6, s[84:87], s51 offen offset:2048 sc1
buffer_load_dwordx4 v[108:111], v6, s[84:87], s51 offen offset:3072 sc1
s_add_u32 s51, s56, 4096
s_and_b32 s51, s51, 0x7fff
s_and_b32 s63, s51, 0x6000
s_add_u32 s51, s51, s63
s_add_u32 s51, s51, s50
buffer_load_dwordx4 v[112:115], v6, s[84:87], s51 offen offset:0 sc1
buffer_load_dwordx4 v[116:119], v6, s[84:87], s51 offen offset:1024 sc1
buffer_load_dwordx4 v[120:123], v6, s[84:87], s51 offen offset:2048 sc1
buffer_load_dwordx4 v[124:127], v6, s[84:87], s51 offen offset:3072 sc1
v_add_u32 v2, s53, v8
v_add_u32 v3, s53, v9
v_add_u32 v4, s53, v10
ds_write_b128 v2, v[224:227] offset:0
ds_write_b128 v2, v[228:231] offset:1088
ds_write_b128 v2, v[232:235] offset:2176
ds_write_b128 v2, v[236:239] offset:3264
ds_write_b128 v2, v[240:243] offset:4352
ds_write_b128 v2, v[244:247] offset:5440
ds_write_b128 v2, v[248:251] offset:6528
ds_write_b128 v2, v[252:255] offset:7616
s_waitcnt lgkmcnt(0)
s_barrier
ds_read_b128 v[52:55], v4 offset:0
ds_read_b128 v[56:59], v4 offset:8704
ds_read_b128 v[60:63], v4 offset:17408
ds_read_b128 v[64:67], v4 offset:26112
ds_read_b128 v[68:71], v3 offset:0
ds_read_b128 v[72:75], v3 offset:8704
ds_read_b128 v[76:79], v3 offset:17408
ds_read_b128 v[80:83], v3 offset:26112
s_sub_u32 s53, 34816, s53
s_sub_u32 s60, s62, s64
s_lshr_b32 s60, s60, s67
s_bfe_u32 s61, s60, 0x10001
s_and_b32 s60, s60, 1
s_lshl_b32 s60, s60, 12
s_waitcnt lgkmcnt(4)
v_add_f32 v52, v52, v56
v_add_f32 v60, v60, v64
v_add_f32 v53, v53, v57
v_add_f32 v61, v61, v65
v_add_f32 v54, v54, v58
v_add_f32 v62, v62, v66
v_add_f32 v55, v55, v59
v_add_f32 v63, v63, v67
v_add_f32 v52, v52, v60
v_add_f32 v53, v53, v61
v_add_f32 v54, v54, v62
v_add_f32 v55, v55, v63
v_and_or_b32 v52, v52, -2, s61
s_cmp_eq_u32 s95, 0
s_cbranch_scc1 mega_kernel_o_sa3
buffer_store_dwordx4 v[52:55], v12, s[84:87], s60 offen sc1
s_branch mega_kernel_o_sb3
mega_kernel_o_sa3:
buffer_store_dwordx4 v[52:55], v12, s[84:87], s60 offen
mega_kernel_o_sb3:
s_waitcnt lgkmcnt(0)
v_add_f32 v68, v68, v72
v_add_f32 v76, v76, v80
v_add_f32 v69, v69, v73
v_add_f32 v77, v77, v81
v_add_f32 v70, v70, v74
v_add_f32 v78, v78, v82
v_add_f32 v71, v71, v75
v_add_f32 v79, v79, v83
v_add_f32 v84, v68, v76
v_add_f32 v85, v69, v77
v_add_f32 v86, v70, v78
v_add_f32 v87, v71, v79
s_waitcnt vmcnt(7)
v_mfma_f32_32x32x16_bf16 v[20:35], a[0:3], v[96:99], 0
v_mfma_f32_32x32x16_bf16 v[36:51], a[4:7], v[96:99], 0
s_add_u32 s51, s56, 8192
s_and_b32 s51, s51, 0x7fff
s_and_b32 s63, s51, 0x6000
s_add_u32 s51, s51, s63
s_add_u32 s51, s51, s50
buffer_load_dwordx4 v[128:131], v6, s[84:87], s51 offen offset:0 sc1
s_waitcnt vmcnt(7)
v_mfma_f32_32x32x16_bf16 v[20:35], a[8:11], v[100:103], v[20:35]
v_mfma_f32_32x32x16_bf16 v[36:51], a[12:15], v[100:103], v[36:51]
buffer_load_dwordx4 v[132:135], v6, s[84:87], s51 offen offset:1024 sc1
s_waitcnt vmcnt(7)
v_mfma_f32_32x32x16_bf16 v[20:35], a[16:19], v[104:107], v[20:35]
v_mfma_f32_32x32x16_bf16 v[36:51], a[20:23], v[104:107], v[36:51]
buffer_load_dwordx4 v[136:139], v6, s[84:87], s51 offen offset:2048 sc1
s_waitcnt vmcnt(7)
v_mfma_f32_32x32x16_bf16 v[20:35], a[24:27], v[108:111], v[20:35]
v_mfma_f32_32x32x16_bf16 v[36:51], a[28:31], v[108:111], v[36:51]
buffer_load_dwordx4 v[140:143], v6, s[84:87], s51 offen offset:3072 sc1
s_waitcnt vmcnt(7)
v_mfma_f32_32x32x16_bf16 v[20:35], a[32:35], v[112:115], v[20:35]
v_mfma_f32_32x32x16_bf16 v[36:51], a[36:39], v[112:115], v[36:51]
s_add_u32 s51, s56, 12288
s_and_b32 s51, s51, 0x7fff
s_and_b32 s63, s51, 0x6000
s_add_u32 s51, s51, s63
s_add_u32 s51, s51, s50
buffer_load_dwordx4 v[144:147], v6, s[84:87], s51 offen offset:0 sc1
s_waitcnt vmcnt(7)
v_mfma_f32_32x32x16_bf16 v[20:35], a[40:43], v[116:119], v[20:35]
v_mfma_f32_32x32x16_bf16 v[36:51], a[44:47], v[116:119], v[36:51]
buffer_load_dwordx4 v[148:151], v6, s[84:87], s51 offen offset:1024 sc1
s_waitcnt vmcnt(7)
v_mfma_f32_32x32x16_bf16 v[20:35], a[48:51], v[120:123], v[20:35]
v_mfma_f32_32x32x16_bf16 v[36:51], a[52:55], v[120:123], v[36:51]
buffer_load_dwordx4 v[152:155], v6, s[84:87], s51 offen offset:2048 sc1
s_waitcnt vmcnt(7)
v_mfma_f32_32x32x16_bf16 v[20:35], a[56:59], v[124:127], v[20:35]
v_mfma_f32_32x32x16_bf16 v[36:51], a[60:63], v[124:127], v[36:51]
buffer_load_dwordx4 v[156:159], v6, s[84:87], s51 offen offset:3072 sc1
s_waitcnt vmcnt(7)
v_mfma_f32_32x32x16_bf16 v[20:35], a[64:67], v[128:131], v[20:35]
v_mfma_f32_32x32x16_bf16 v[36:51], a[68:71], v[128:131], v[36:51]
s_add_u32 s51, s56, 16384
s_and_b32 s51, s51, 0x7fff
s_and_b32 s63, s51, 0x6000
s_add_u32 s51, s51, s63
s_add_u32 s51, s51, s50
buffer_load_dwordx4 v[160:163], v6, s[84:87], s51 offen offset:0 sc1
s_waitcnt vmcnt(7)
v_mfma_f32_32x32x16_bf16 v[20:35], a[72:75], v[132:135], v[20:35]
v_mfma_f32_32x32x16_bf16 v[36:51], a[76:79], v[132:135], v[36:51]
buffer_load_dwordx4 v[164:167], v6, s[84:87], s51 offen offset:1024 sc1
s_waitcnt vmcnt(7)
v_mfma_f32_32x32x16_bf16 v[20:35], a[80:83], v[136:139], v[20:35]
v_mfma_f32_32x32x16_bf16 v[36:51], a[84:87], v[136:139], v[36:51]
buffer_load_dwordx4 v[168:171], v6, s[84:87], s51 offen offset:2048 sc1
s_waitcnt vmcnt(7)
v_mfma_f32_32x32x16_bf16 v[20:35], a[88:91], v[140:143], v[20:35]
v_mfma_f32_32x32x16_bf16 v[36:51], a[92:95], v[140:143], v[36:51]
buffer_load_dwordx4 v[172:175], v6, s[84:87], s51 offen offset:3072 sc1
s_waitcnt vmcnt(7)
v_mfma_f32_32x32x16_bf16 v[20:35], a[96:99], v[144:147], v[20:35]
v_mfma_f32_32x32x16_bf16 v[36:51], a[100:103], v[144:147], v[36:51]
s_add_u32 s51, s56, 20480
s_and_b32 s51, s51, 0x7fff
s_and_b32 s63, s51, 0x6000
s_add_u32 s51, s51, s63
s_add_u32 s51, s51, s50
buffer_load_dwordx4 v[176:179], v6, s[84:87], s51 offen offset:0 sc1
s_waitcnt vmcnt(7)
v_mfma_f32_32x32x16_bf16 v[20:35], a[104:107], v[148:151], v[20:35]
v_mfma_f32_32x32x16_bf16 v[36:51], a[108:111], v[148:151], v[36:51]
buffer_load_dwordx4 v[180:183], v6, s[84:87], s51 offen offset:1024 sc1
s_waitcnt vmcnt(7)
v_mfma_f32_32x32x16_bf16 v[20:35], a[112:115], v[152:155], v[20:35]
v_mfma_f32_32x32x16_bf16 v[36:51], a[116:119], v[152:155], v[36:51]
buffer_load_dwordx4 v[184:187], v6, s[84:87], s51 offen offset:2048 sc1
s_waitcnt vmcnt(7)
v_mfma_f32_32x32x16_bf16 v[20:35], a[120:123], v[156:159], v[20:35]
v_mfma_f32_32x32x16_bf16 v[36:51], a[124:127], v[156:159], v[36:51]
buffer_load_dwordx4 v[188:191], v6, s[84:87], s51 offen offset:3072 sc1
s_waitcnt vmcnt(7)
v_mfma_f32_32x32x16_bf16 v[20:35], a[128:131], v[160:163], v[20:35]
v_mfma_f32_32x32x16_bf16 v[36:51], a[132:135], v[160:163], v[36:51]
s_add_u32 s51, s56, 24576
s_and_b32 s51, s51, 0x7fff
s_and_b32 s63, s51, 0x6000
s_add_u32 s51, s51, s63
s_add_u32 s51, s51, s50
buffer_load_dwordx4 v[192:195], v6, s[84:87], s51 offen offset:0 sc1
s_waitcnt vmcnt(7)
v_mfma_f32_32x32x16_bf16 v[20:35], a[136:139], v[164:167], v[20:35]
v_mfma_f32_32x32x16_bf16 v[36:51], a[140:143], v[164:167], v[36:51]
buffer_load_dwordx4 v[196:199], v6, s[84:87], s51 offen offset:1024 sc1
s_waitcnt vmcnt(7)
v_mfma_f32_32x32x16_bf16 v[20:35], a[144:147], v[168:171], v[20:35]
v_mfma_f32_32x32x16_bf16 v[36:51], a[148:151], v[168:171], v[36:51]
buffer_load_dwordx4 v[200:203], v6, s[84:87], s51 offen offset:2048 sc1
s_waitcnt vmcnt(7)
v_mfma_f32_32x32x16_bf16 v[20:35], a[152:155], v[172:175], v[20:35]
v_mfma_f32_32x32x16_bf16 v[36:51], a[156:159], v[172:175], v[36:51]
buffer_load_dwordx4 v[204:207], v6, s[84:87], s51 offen offset:3072 sc1
s_waitcnt vmcnt(7)
v_mfma_f32_32x32x16_bf16 v[20:35], a[160:163], v[176:179], v[20:35]
v_mfma_f32_32x32x16_bf16 v[36:51], a[164:167], v[176:179], v[36:51]
s_add_u32 s51, s56, 28672
s_and_b32 s51, s51, 0x7fff
s_and_b32 s63, s51, 0x6000
s_add_u32 s51, s51, s63
s_add_u32 s51, s51, s50
buffer_load_dwordx4 v[208:211], v6, s[84:87], s51 offen offset:0 sc1
s_waitcnt vmcnt(7)
v_mfma_f32_32x32x16_bf16 v[20:35], a[168:171], v[180:183], v[20:35]
v_mfma_f32_32x32x16_bf16 v[36:51], a[172:175], v[180:183], v[36:51]
buffer_load_dwordx4 v[212:215], v6, s[84:87], s51 offen offset:1024 sc1
s_waitcnt vmcnt(7)
v_mfma_f32_32x32x16_bf16 v[20:35], a[176:179], v[184:187], v[20:35]
v_mfma_f32_32x32x16_bf16 v[36:51], a[180:183], v[184:187], v[36:51]
buffer_load_dwordx4 v[216:219], v6, s[84:87], s51 offen offset:2048 sc1
s_waitcnt vmcnt(7)
v_mfma_f32_32x32x16_bf16 v[20:35], a[184:187], v[188:191], v[20:35]
v_mfma_f32_32x32x16_bf16 v[36:51], a[188:191], v[188:191], v[36:51]
buffer_load_dwordx4 v[220:223], v6, s[84:87], s51 offen offset:3072 sc1
s_waitcnt vmcnt(7)
v_mfma_f32_32x32x16_bf16 v[20:35], a[192:195], v[192:195], v[20:35]
v_mfma_f32_32x32x16_bf16 v[36:51], a[196:199], v[192:195], v[36:51]
s_sub_u32 s60, s62, s64
s_lshr_b32 s60, s60, s67
s_bfe_u32 s61, s60, 0x10001
s_and_b32 s60, s60, 1
s_lshl_b32 s60, s60, 12
buffer_load_dwordx4 v[88:91], v13, s[84:87], s60 offen sc1
buffer_load_dword v15, v7, s[84:87], 0 offen sc1
s_waitcnt vmcnt(6)
v_mfma_f32_32x32x16_bf16 v[20:35], a[200:203], v[196:199], v[20:35]
v_mfma_f32_32x32x16_bf16 v[36:51], a[204:207], v[196:199], v[36:51]
s_waitcnt vmcnt(5)
v_mfma_f32_32x32x16_bf16 v[20:35], a[208:211], v[200:203], v[20:35]
v_mfma_f32_32x32x16_bf16 v[36:51], a[212:215], v[200:203], v[36:51]
s_waitcnt vmcnt(4)
v_mfma_f32_32x32x16_bf16 v[20:35], a[216:219], v[204:207], v[20:35]
v_mfma_f32_32x32x16_bf16 v[36:51], a[220:223], v[204:207], v[36:51]
s_waitcnt vmcnt(3)
v_mfma_f32_32x32x16_bf16 v[20:35], a[224:227], v[208:211], v[20:35]
v_mfma_f32_32x32x16_bf16 v[36:51], a[228:231], v[208:211], v[36:51]
s_waitcnt vmcnt(2)
v_mfma_f32_32x32x16_bf16 v[20:35], a[232:235], v[212:215], v[20:35]
v_mfma_f32_32x32x16_bf16 v[36:51], a[236:239], v[212:215], v[36:51]
s_waitcnt vmcnt(1)
v_mfma_f32_32x32x16_bf16 v[20:35], a[240:243], v[216:219], v[20:35]
v_mfma_f32_32x32x16_bf16 v[36:51], a[244:247], v[216:219], v[36:51]
s_waitcnt vmcnt(0)
v_mfma_f32_32x32x16_bf16 v[224:239], a[248:251], v[220:223], v[20:35]
v_mfma_f32_32x32x16_bf16 v[240:255], a[252:255], v[220:223], v[36:51]
s_waitcnt vmcnt(0)
mega_kernel_o_fcc:
v_and_b32 v14, 1, v88
v_cmp_ne_u32 vcc, s61, v14
s_cbranch_vccz mega_kernel_o_fck
s_sub_u32 s60, s62, s64
s_lshr_b32 s60, s60, s67
s_bfe_u32 s61, s60, 0x10001
s_and_b32 s60, s60, 1
s_lshl_b32 s60, s60, 12
buffer_load_dwordx4 v[88:91], v13, s[84:87], s60 offen sc1
s_waitcnt vmcnt(0)
s_branch mega_kernel_o_fcc
mega_kernel_o_fck:
v_pk_add_f32 v[88:89], v[88:89], v[84:85]
v_pk_add_f32 v[90:91], v[90:91], v[86:87]
s_lshl_b32 s60, s62, 17
v_cvt_pk_bf16_f32 v92, v88, v89
v_cvt_pk_bf16_f32 v93, v90, v91
buffer_store_dwordx2 v[92:93], v11, s[8:11], s60 offen sc1
s_lshr_b32 s63, s54, 2
s_xnor_b32 s63, s63, s98
s_and_b32 s63, s63, 1
s_lshl_b32 s63, s63, 13
s_lshl_b32 s50, s54, 19
s_add_u32 s50, s50, s63
s_branch mega_kernel_o_imm
mega_kernel_o_im2:
v_add_u32 v2, s53, v8
v_add_u32 v3, s53, v9
v_add_u32 v4, s53, v10
ds_write_b128 v2, v[224:227] offset:0
ds_write_b128 v2, v[228:231] offset:1088
ds_write_b128 v2, v[232:235] offset:2176
ds_write_b128 v2, v[236:239] offset:3264
ds_write_b128 v2, v[240:243] offset:4352
ds_write_b128 v2, v[244:247] offset:5440
ds_write_b128 v2, v[248:251] offset:6528
ds_write_b128 v2, v[252:255] offset:7616
s_waitcnt lgkmcnt(0)
s_barrier
ds_read_b128 v[52:55], v4 offset:0
ds_read_b128 v[56:59], v4 offset:8704
ds_read_b128 v[60:63], v4 offset:17408
ds_read_b128 v[64:67], v4 offset:26112
ds_read_b128 v[68:71], v3 offset:0
ds_read_b128 v[72:75], v3 offset:8704
ds_read_b128 v[76:79], v3 offset:17408
ds_read_b128 v[80:83], v3 offset:26112
s_sub_u32 s53, 34816, s53
s_sub_u32 s60, s42, s64
s_lshr_b32 s60, s60, s67
s_bfe_u32 s61, s60, 0x10001
s_and_b32 s60, s60, 1
s_lshl_b32 s60, s60, 12
s_waitcnt lgkmcnt(4)
v_add_f32 v52, v52, v56
v_add_f32 v60, v60, v64
v_add_f32 v53, v53, v57
v_add_f32 v61, v61, v65
v_add_f32 v54, v54, v58
v_add_f32 v62, v62, v66
v_add_f32 v55, v55, v59
v_add_f32 v63, v63, v67
v_add_f32 v52, v52, v60
v_add_f32 v53, v53, v61
v_add_f32 v54, v54, v62
v_add_f32 v55, v55, v63
v_and_or_b32 v52, v52, -2, s61
s_cmp_eq_u32 s95, 0
s_cbranch_scc1 mega_kernel_o_sa4
buffer_store_dwordx4 v[52:55], v12, s[84:87], s60 offen sc1
s_branch mega_kernel_o_sb4
mega_kernel_o_sa4:
buffer_store_dwordx4 v[52:55], v12, s[84:87], s60 offen
mega_kernel_o_sb4:
s_waitcnt lgkmcnt(0)
v_add_f32 v68, v68, v72
v_add_f32 v76, v76, v80
v_add_f32 v69, v69, v73
v_add_f32 v77, v77, v81
v_add_f32 v70, v70, v74
v_add_f32 v78, v78, v82
v_add_f32 v71, v71, v75
v_add_f32 v79, v79, v83
v_add_f32 v84, v68, v76
v_add_f32 v85, v69, v77
v_add_f32 v86, v70, v78
v_add_f32 v87, v71, v79
s_sub_u32 s60, s42, s64
s_lshr_b32 s60, s60, s67
s_bfe_u32 s61, s60, 0x10001
s_and_b32 s60, s60, 1
s_lshl_b32 s60, s60, 12
buffer_load_dwordx4 v[88:91], v13, s[84:87], s60 offen sc1
s_waitcnt vmcnt(0)
mega_kernel_o_f2c:
v_and_b32 v14, 1, v88
v_cmp_ne_u32 vcc, s61, v14
s_cbranch_vccz mega_kernel_o_f2k
s_sub_u32 s60, s42, s64
s_lshr_b32 s60, s60, s67
s_bfe_u32 s61, s60, 0x10001
s_and_b32 s60, s60, 1
s_lshl_b32 s60, s60, 12
buffer_load_dwordx4 v[88:91], v13, s[84:87], s60 offen sc1
s_waitcnt vmcnt(0)
s_branch mega_kernel_o_f2c
mega_kernel_o_f2k:
v_pk_add_f32 v[88:89], v[88:89], v[84:85]
v_pk_add_f32 v[90:91], v[90:91], v[86:87]
s_lshl_b32 s60, s42, 17
v_cvt_pk_bf16_f32 v92, v88, v89
v_cvt_pk_bf16_f32 v93, v90, v91
buffer_store_dwordx2 v[92:93], v11, s[8:11], s60 offen sc1
s_add_u32 s42, s42, s71
s_cmp_lt_u32 s42, s65
s_cbranch_scc1 mega_kernel_o_cold
mega_kernel_o_quit:
s_endpgm
mega_kernel_exit:
s_endpgm
mega_kernel_recf:
s_load_dwordx2 s[20:21], s[0:1], 8
s_load_dwordx2 s[16:17], s[0:1], 40
s_load_dwordx2 s[4:5], s[0:1], 16
s_load_dwordx2 s[8:9], s[0:1], 24
s_load_dwordx2 s[12:13], s[0:1], 32
v_lshrrev_b32 v4, 6, v0
v_and_b32 v1, 63, v0
v_readfirstlane_b32 s24, v4
v_lshrrev_b32 v2, 4, v1
v_and_b32 v3, 15, v1
v_lshlrev_b32 v17, 4, v1
s_lshr_b32 s28, s31, 2
s_lshl_b32 s25, s30, 3
s_add_u32 s25, s25, s28
s_and_b32 s26, s31, 3
s_waitcnt lgkmcnt(0)
s_mov_b32 s22, 16384
s_mov_b32 s23, 0x00020000
s_mov_b32 s18, 8388608
s_mov_b32 s19, 0x00020000
s_mov_b32 s6, 8388608
s_mov_b32 s7, 0x00020000
s_mov_b32 s10, 8388608
s_mov_b32 s11, 0x00020000
s_mov_b32 s14, 8388608
s_mov_b32 s15, 0x00020000
s_lshl_b32 s28, s25, 8
s_lshr_b32 s29, s26, 0
s_lshl_b32 s29, s29, 6
s_add_u32 s28, s28, s29
s_lshl_b32 s29, s24, 21
s_add_u32 s28, s28, s29
v_lshrrev_b32 v4, 2, v1
v_and_b32 v5, 3, v1
v_lshlrev_b32 v40, 13, v4
v_lshl_add_u32 v40, v5, 4, v40
v_add_u32 v40, s28, v40
s_lshl_b32 s28, s30, 21
s_lshl_b32 s29, s24, 19
s_add_u32 s28, s28, s29
s_lshr_b32 s29, s31, 0
s_lshl_b32 s29, s29, 6
s_add_u32 s28, s28, s29
v_lshlrev_b32 v41, 11, v4
v_lshl_add_u32 v41, v5, 4, v41
v_add_u32 v41, s28, v41
s_lshl_b32 s47, s24, 15
s_add_u32 s47, s47, 32768
s_lshl_b32 s28, s31, 18
s_lshl_b32 s29, s24, 16
s_add_u32 s28, s28, s29
s_lshl_b32 s29, s30, 11
s_add_u32 s28, s28, s29
v_lshlrev_b32 v48, 13, v2
v_lshl_add_u32 v48, v3, 7, v48
v_add_u32 v48, s28, v48
s_lshl_b32 s28, s30, 21
s_lshl_b32 s29, s31, 16
s_add_u32 s28, s28, s29
s_lshl_b32 s29, s24, 14
s_add_u32 s28, s28, s29
v_lshlrev_b32 v49, 7, v1
v_add_u32 v49, s28, v49
s_and_b32 s76, s31, 1
s_mul_i32 s76, s76, 8
s_and_b32 s28, s31, 15
s_lshl_b32 s28, s28, 4
s_lshl_b32 s29, s24, 8
s_add_u32 s28, s28, s29
v_add_u32 v53, s28, v3
s_lshr_b32 s28, s31, 4
s_lshl_b32 s28, s28, 10
s_add_u32 s28, s28, 384
v_mov_b32 v54, s28
v_mov_b32 v55, 1920
v_cmp_gt_u32 vcc, 32, v1
s_nop 1
v_cndmask_b32 v54, v55, v54, vcc
s_lshl_b32 s29, s30, 11
v_lshl_add_u32 v51, v53, 13, v54
v_add_u32 v51, s29, v51
s_lshl_b32 s29, s30, 21
v_lshl_add_u32 v52, v53, 11, v54
v_add_u32 v52, s29, v52
buffer_load_dword v50, v51, s[8:11], 0 offen
s_xor_b32 s29, s76, 0
s_lshl_b32 s28, s29, 10
s_add_u32 s28, s28, s47
s_add_u32 m0, s28, 0
s_lshl_b32 s29, s29, 17
buffer_load_dwordx4 v40, s[8:11], s29 offen lds
s_xor_b32 s29, s76, 1
s_lshl_b32 s28, s29, 10
s_add_u32 s28, s28, s47
s_add_u32 m0, s28, 0
s_lshl_b32 s29, s29, 17
buffer_load_dwordx4 v40, s[8:11], s29 offen lds
s_xor_b32 s29, s76, 2
s_lshl_b32 s28, s29, 10
s_add_u32 s28, s28, s47
s_add_u32 m0, s28, 0
s_lshl_b32 s29, s29, 17
buffer_load_dwordx4 v40, s[8:11], s29 offen lds
s_xor_b32 s29, s76, 3
s_lshl_b32 s28, s29, 10
s_add_u32 s28, s28, s47
s_add_u32 m0, s28, 0
s_lshl_b32 s29, s29, 17
buffer_load_dwordx4 v40, s[8:11], s29 offen lds
s_xor_b32 s29, s76, 4
s_lshl_b32 s28, s29, 10
s_add_u32 s28, s28, s47
s_add_u32 m0, s28, 0
s_lshl_b32 s29, s29, 17
buffer_load_dwordx4 v40, s[8:11], s29 offen lds
s_xor_b32 s29, s76, 5
s_lshl_b32 s28, s29, 10
s_add_u32 s28, s28, s47
s_add_u32 m0, s28, 0
s_lshl_b32 s29, s29, 17
buffer_load_dwordx4 v40, s[8:11], s29 offen lds
s_xor_b32 s29, s76, 6
s_lshl_b32 s28, s29, 10
s_add_u32 s28, s28, s47
s_add_u32 m0, s28, 0
s_lshl_b32 s29, s29, 17
buffer_load_dwordx4 v40, s[8:11], s29 offen lds
s_xor_b32 s29, s76, 7
s_lshl_b32 s28, s29, 10
s_add_u32 s28, s28, s47
s_add_u32 m0, s28, 0
s_lshl_b32 s29, s29, 17
buffer_load_dwordx4 v40, s[8:11], s29 offen lds
s_xor_b32 s29, s76, 8
s_lshl_b32 s28, s29, 10
s_add_u32 s28, s28, s47
s_add_u32 m0, s28, 0
s_lshl_b32 s29, s29, 17
buffer_load_dwordx4 v40, s[8:11], s29 offen lds
s_xor_b32 s29, s76, 9
s_lshl_b32 s28, s29, 10
s_add_u32 s28, s28, s47
s_add_u32 m0, s28, 0
s_lshl_b32 s29, s29, 17
buffer_load_dwordx4 v40, s[8:11], s29 offen lds
s_xor_b32 s29, s76, 10
s_lshl_b32 s28, s29, 10
s_add_u32 s28, s28, s47
s_add_u32 m0, s28, 0
s_lshl_b32 s29, s29, 17
buffer_load_dwordx4 v40, s[8:11], s29 offen lds
s_xor_b32 s29, s76, 11
s_lshl_b32 s28, s29, 10
s_add_u32 s28, s28, s47
s_add_u32 m0, s28, 0
s_lshl_b32 s29, s29, 17
buffer_load_dwordx4 v40, s[8:11], s29 offen lds
s_xor_b32 s29, s76, 12
s_lshl_b32 s28, s29, 10
s_add_u32 s28, s28, s47
s_add_u32 m0, s28, 0
s_lshl_b32 s29, s29, 17
buffer_load_dwordx4 v40, s[8:11], s29 offen lds
s_xor_b32 s29, s76, 13
s_lshl_b32 s28, s29, 10
s_add_u32 s28, s28, s47
s_add_u32 m0, s28, 0
s_lshl_b32 s29, s29, 17
buffer_load_dwordx4 v40, s[8:11], s29 offen lds
s_xor_b32 s29, s76, 14
s_lshl_b32 s28, s29, 10
s_add_u32 s28, s28, s47
s_add_u32 m0, s28, 0
s_lshl_b32 s29, s29, 17
buffer_load_dwordx4 v40, s[8:11], s29 offen lds
s_xor_b32 s29, s76, 15
s_lshl_b32 s28, s29, 10
s_add_u32 s28, s28, s47
s_add_u32 m0, s28, 0
s_lshl_b32 s29, s29, 17
buffer_load_dwordx4 v40, s[8:11], s29 offen lds
buffer_load_dword v50, v51, s[12:15], 0 offen
s_xor_b32 s29, s76, 0
s_lshl_b32 s28, s29, 10
s_add_u32 s28, s28, s47
s_add_u32 m0, s28, 16384
s_lshl_b32 s29, s29, 17
buffer_load_dwordx4 v40, s[12:15], s29 offen lds
s_xor_b32 s29, s76, 1
s_lshl_b32 s28, s29, 10
s_add_u32 s28, s28, s47
s_add_u32 m0, s28, 16384
s_lshl_b32 s29, s29, 17
buffer_load_dwordx4 v40, s[12:15], s29 offen lds
s_xor_b32 s29, s76, 2
s_lshl_b32 s28, s29, 10
s_add_u32 s28, s28, s47
s_add_u32 m0, s28, 16384
s_lshl_b32 s29, s29, 17
buffer_load_dwordx4 v40, s[12:15], s29 offen lds
s_xor_b32 s29, s76, 3
s_lshl_b32 s28, s29, 10
s_add_u32 s28, s28, s47
s_add_u32 m0, s28, 16384
s_lshl_b32 s29, s29, 17
buffer_load_dwordx4 v40, s[12:15], s29 offen lds
s_xor_b32 s29, s76, 4
s_lshl_b32 s28, s29, 10
s_add_u32 s28, s28, s47
s_add_u32 m0, s28, 16384
s_lshl_b32 s29, s29, 17
buffer_load_dwordx4 v40, s[12:15], s29 offen lds
s_xor_b32 s29, s76, 5
s_lshl_b32 s28, s29, 10
s_add_u32 s28, s28, s47
s_add_u32 m0, s28, 16384
s_lshl_b32 s29, s29, 17
buffer_load_dwordx4 v40, s[12:15], s29 offen lds
s_xor_b32 s29, s76, 6
s_lshl_b32 s28, s29, 10
s_add_u32 s28, s28, s47
s_add_u32 m0, s28, 16384
s_lshl_b32 s29, s29, 17
buffer_load_dwordx4 v40, s[12:15], s29 offen lds
s_xor_b32 s29, s76, 7
s_lshl_b32 s28, s29, 10
s_add_u32 s28, s28, s47
s_add_u32 m0, s28, 16384
s_lshl_b32 s29, s29, 17
buffer_load_dwordx4 v40, s[12:15], s29 offen lds
s_xor_b32 s29, s76, 8
s_lshl_b32 s28, s29, 10
s_add_u32 s28, s28, s47
s_add_u32 m0, s28, 16384
s_lshl_b32 s29, s29, 17
buffer_load_dwordx4 v40, s[12:15], s29 offen lds
s_xor_b32 s29, s76, 9
s_lshl_b32 s28, s29, 10
s_add_u32 s28, s28, s47
s_add_u32 m0, s28, 16384
s_lshl_b32 s29, s29, 17
buffer_load_dwordx4 v40, s[12:15], s29 offen lds
s_xor_b32 s29, s76, 10
s_lshl_b32 s28, s29, 10
s_add_u32 s28, s28, s47
s_add_u32 m0, s28, 16384
s_lshl_b32 s29, s29, 17
buffer_load_dwordx4 v40, s[12:15], s29 offen lds
s_xor_b32 s29, s76, 11
s_lshl_b32 s28, s29, 10
s_add_u32 s28, s28, s47
s_add_u32 m0, s28, 16384
s_lshl_b32 s29, s29, 17
buffer_load_dwordx4 v40, s[12:15], s29 offen lds
s_xor_b32 s29, s76, 12
s_lshl_b32 s28, s29, 10
s_add_u32 s28, s28, s47
s_add_u32 m0, s28, 16384
s_lshl_b32 s29, s29, 17
buffer_load_dwordx4 v40, s[12:15], s29 offen lds
s_xor_b32 s29, s76, 13
s_lshl_b32 s28, s29, 10
s_add_u32 s28, s28, s47
s_add_u32 m0, s28, 16384
s_lshl_b32 s29, s29, 17
buffer_load_dwordx4 v40, s[12:15], s29 offen lds
s_xor_b32 s29, s76, 14
s_lshl_b32 s28, s29, 10
s_add_u32 s28, s28, s47
s_add_u32 m0, s28, 16384
s_lshl_b32 s29, s29, 17
buffer_load_dwordx4 v40, s[12:15], s29 offen lds
s_xor_b32 s29, s76, 15
s_lshl_b32 s28, s29, 10
s_add_u32 s28, s28, s47
s_add_u32 m0, s28, 16384
s_lshl_b32 s29, s29, 17
buffer_load_dwordx4 v40, s[12:15], s29 offen lds
s_mov_b32 s40, 0x00ff00ff
s_mov_b32 s41, 0x00ff00ff
s_mov_b32 s48, 0xff00ff00
s_mov_b32 s49, 0xff00ff00
s_mov_b32 s42, 0
s_mov_b32 s43, 0x00ff00ff
s_mov_b32 s32, 0x3e0293ee
v_mov_b32 v23, 0xff800000
v_mov_b32 v6, 0x4444
v_mov_b32 v4, 0xeeee
v_cndmask_b32 v6, v6, v4, s[48:49]
v_mov_b32 v28, -1
v_mov_b32 v29, -1
v_mov_b32 v30, -1
v_mov_b32 v31, -1
s_mul_i32 s28, s24, 4096
v_add_u32 v7, s28, v17
v_and_b32 v4, 7, v1
v_lshlrev_b32 v8, 11, v4
v_lshrrev_b32 v5, 3, v1
v_lshl_add_u32 v8, v5, 4, v8
s_lshl_b32 s28, s24, 9
v_add_u32 v8, s28, v8
s_lshl_b32 s28, s31, 9
s_lshr_b32 s29, s31, 3
s_mul_i32 s29, s29, 0
s_add_u32 s28, s28, s29
v_lshlrev_b32 v9, 3, v1
v_add_u32 v9, s28, v9
v_and_b32 v4, 7, v3
v_lshlrev_b32 v11, 7, v2
v_lshl_add_u32 v11, v4, 4, v11
v_add_u32 v22, 0, v11
s_add_u32 s28, s28, 24576
v_add_u32 v11, s28, v11
v_and_b32 v5, 1, v2
v_lshlrev_b32 v10, 7, v5
v_lshl_add_u32 v10, v4, 4, v10
v_add_u32 v10, 1024, v10
s_xor_b32 s37, s31, 1
s_mul_i32 s37, s37, 1280
s_add_u32 s37, s37, 49152
s_xor_b32 s38, s31, 2
s_mul_i32 s38, s38, 1280
s_add_u32 s38, s38, 49152
s_xor_b32 s39, s31, 3
s_mul_i32 s39, s39, 1280
s_add_u32 s39, s39, 49152
v_and_b32 v4, 1, v2
v_mul_u32_u24 v14, 576, v4
v_lshrrev_b32 v5, 1, v2
v_lshl_add_u32 v5, v5, 4, v3
v_lshl_add_u32 v14, v5, 2, v14
s_mul_i32 s28, s24, 1152
s_add_u32 s28, s28, 13312
v_add_u32 v18, s28, v14
s_mul_i32 s28, s24, 2304
v_add_u32 v14, s28, v14
v_add_u32 v15, 1152, v14
v_mul_u32_u24 v16, 144, v3
v_lshl_add_u32 v16, v2, 5, v16
v_bfe_u32 v4, v1, 1, 3
v_mul_u32_u24 v19, 144, v4
v_lshl_add_u32 v19, v2, 5, v19
v_and_b32 v4, 1, v1
v_lshl_add_u32 v19, v4, 4, v19
v_add_u32 v19, 13312, v19
s_lshl_b32 s28, s24, 10
s_add_u32 s28, s28, 9216
v_add_u32 v20, s28, v17
v_and_b32 v4, 31, v1
v_lshlrev_b32 v21, 3, v4
v_add_u32 v21, 17920, v21
v_lshrrev_b32 v4, 2, v3
v_and_b32 v42, 1, v4
v_lshrrev_b32 v43, 1, v4
v_lshrrev_b32 v44, 1, v2
v_and_b32 v45, 1, v2
v_lshl_add_u32 v46, v44, 4, v42
v_lshl_add_u32 v46, v45, 2, v46
v_lshl_add_u32 v46, v43, 3, v46
v_lshl_add_u32 v47, v44, 3, v42
v_lshl_add_u32 v47, v45, 4, v47
v_lshl_add_u32 v47, v43, 2, v47
v_and_b32 v5, 3, v3
v_lshlrev_b32 v5, 3, v5
v_lshl_add_u32 v46, v46, 6, v5
v_lshl_add_u32 v47, v47, 6, v5
s_and_b32 s28, s31, 0
s_lshl_b32 s28, s28, 6
s_add_u32 s28, s28, s47
v_add_u32 v46, s28, v46
v_add_u32 v47, s28, v47
s_waitcnt vmcnt(17)
ds_read_b64_tr_b16 a[64:65], v46 offset:0
ds_read_b64_tr_b16 a[66:67], v46 offset:128
ds_read_b64_tr_b16 a[68:69], v46 offset:2048
ds_read_b64_tr_b16 a[70:71], v46 offset:2176
ds_read_b64_tr_b16 a[72:73], v46 offset:4096
ds_read_b64_tr_b16 a[74:75], v46 offset:4224
ds_read_b64_tr_b16 a[76:77], v46 offset:6144
ds_read_b64_tr_b16 a[78:79], v46 offset:6272
s_waitcnt lgkmcnt(0)
ds_read_b64_tr_b16 a[80:81], v46 offset:8192
ds_read_b64_tr_b16 a[82:83], v46 offset:8320
ds_read_b64_tr_b16 a[84:85], v46 offset:10240
ds_read_b64_tr_b16 a[86:87], v46 offset:10368
ds_read_b64_tr_b16 a[88:89], v46 offset:12288
ds_read_b64_tr_b16 a[90:91], v46 offset:12416
ds_read_b64_tr_b16 a[92:93], v46 offset:14336
ds_read_b64_tr_b16 a[94:95], v46 offset:14464
s_waitcnt lgkmcnt(0)
ds_read_b64_tr_b16 a[96:97], v46 offset:32
ds_read_b64_tr_b16 a[98:99], v46 offset:160
ds_read_b64_tr_b16 a[100:101], v46 offset:2080
ds_read_b64_tr_b16 a[102:103], v46 offset:2208
ds_read_b64_tr_b16 a[104:105], v46 offset:4128
ds_read_b64_tr_b16 a[106:107], v46 offset:4256
ds_read_b64_tr_b16 a[108:109], v46 offset:6176
ds_read_b64_tr_b16 a[110:111], v46 offset:6304
s_waitcnt lgkmcnt(0)
ds_read_b64_tr_b16 a[112:113], v46 offset:8224
ds_read_b64_tr_b16 a[114:115], v46 offset:8352
ds_read_b64_tr_b16 a[116:117], v46 offset:10272
ds_read_b64_tr_b16 a[118:119], v46 offset:10400
ds_read_b64_tr_b16 a[120:121], v46 offset:12320
ds_read_b64_tr_b16 a[122:123], v46 offset:12448
ds_read_b64_tr_b16 a[124:125], v46 offset:14368
ds_read_b64_tr_b16 a[126:127], v46 offset:14496
s_waitcnt lgkmcnt(0)
buffer_load_dword v50, v51, s[4:7], 0 offen
s_xor_b32 s29, s76, 0
s_lshl_b32 s28, s29, 10
s_add_u32 s28, s28, s47
s_add_u32 m0, s28, 0
s_lshl_b32 s29, s29, 17
buffer_load_dwordx4 v40, s[4:7], s29 offen lds
s_xor_b32 s29, s76, 1
s_lshl_b32 s28, s29, 10
s_add_u32 s28, s28, s47
s_add_u32 m0, s28, 0
s_lshl_b32 s29, s29, 17
buffer_load_dwordx4 v40, s[4:7], s29 offen lds
s_xor_b32 s29, s76, 2
s_lshl_b32 s28, s29, 10
s_add_u32 s28, s28, s47
s_add_u32 m0, s28, 0
s_lshl_b32 s29, s29, 17
buffer_load_dwordx4 v40, s[4:7], s29 offen lds
s_xor_b32 s29, s76, 3
s_lshl_b32 s28, s29, 10
s_add_u32 s28, s28, s47
s_add_u32 m0, s28, 0
s_lshl_b32 s29, s29, 17
buffer_load_dwordx4 v40, s[4:7], s29 offen lds
s_xor_b32 s29, s76, 4
s_lshl_b32 s28, s29, 10
s_add_u32 s28, s28, s47
s_add_u32 m0, s28, 0
s_lshl_b32 s29, s29, 17
buffer_load_dwordx4 v40, s[4:7], s29 offen lds
s_xor_b32 s29, s76, 5
s_lshl_b32 s28, s29, 10
s_add_u32 s28, s28, s47
s_add_u32 m0, s28, 0
s_lshl_b32 s29, s29, 17
buffer_load_dwordx4 v40, s[4:7], s29 offen lds
s_xor_b32 s29, s76, 6
s_lshl_b32 s28, s29, 10
s_add_u32 s28, s28, s47
s_add_u32 m0, s28, 0
s_lshl_b32 s29, s29, 17
buffer_load_dwordx4 v40, s[4:7], s29 offen lds
s_xor_b32 s29, s76, 7
s_lshl_b32 s28, s29, 10
s_add_u32 s28, s28, s47
s_add_u32 m0, s28, 0
s_lshl_b32 s29, s29, 17
buffer_load_dwordx4 v40, s[4:7], s29 offen lds
s_xor_b32 s29, s76, 8
s_lshl_b32 s28, s29, 10
s_add_u32 s28, s28, s47
s_add_u32 m0, s28, 0
s_lshl_b32 s29, s29, 17
buffer_load_dwordx4 v40, s[4:7], s29 offen lds
s_xor_b32 s29, s76, 9
s_lshl_b32 s28, s29, 10
s_add_u32 s28, s28, s47
s_add_u32 m0, s28, 0
s_lshl_b32 s29, s29, 17
buffer_load_dwordx4 v40, s[4:7], s29 offen lds
s_xor_b32 s29, s76, 10
s_lshl_b32 s28, s29, 10
s_add_u32 s28, s28, s47
s_add_u32 m0, s28, 0
s_lshl_b32 s29, s29, 17
buffer_load_dwordx4 v40, s[4:7], s29 offen lds
s_xor_b32 s29, s76, 11
s_lshl_b32 s28, s29, 10
s_add_u32 s28, s28, s47
s_add_u32 m0, s28, 0
s_lshl_b32 s29, s29, 17
buffer_load_dwordx4 v40, s[4:7], s29 offen lds
s_xor_b32 s29, s76, 12
s_lshl_b32 s28, s29, 10
s_add_u32 s28, s28, s47
s_add_u32 m0, s28, 0
s_lshl_b32 s29, s29, 17
buffer_load_dwordx4 v40, s[4:7], s29 offen lds
s_xor_b32 s29, s76, 13
s_lshl_b32 s28, s29, 10
s_add_u32 s28, s28, s47
s_add_u32 m0, s28, 0
s_lshl_b32 s29, s29, 17
buffer_load_dwordx4 v40, s[4:7], s29 offen lds
s_xor_b32 s29, s76, 14
s_lshl_b32 s28, s29, 10
s_add_u32 s28, s28, s47
s_add_u32 m0, s28, 0
s_lshl_b32 s29, s29, 17
buffer_load_dwordx4 v40, s[4:7], s29 offen lds
s_xor_b32 s29, s76, 15
s_lshl_b32 s28, s29, 10
s_add_u32 s28, s28, s47
s_add_u32 m0, s28, 0
s_lshl_b32 s29, s29, 17
buffer_load_dwordx4 v40, s[4:7], s29 offen lds
s_waitcnt vmcnt(17)
ds_read_b64_tr_b16 a[128:129], v46 offset:16384
ds_read_b64_tr_b16 a[130:131], v46 offset:16512
ds_read_b64_tr_b16 a[132:133], v46 offset:18432
ds_read_b64_tr_b16 a[134:135], v46 offset:18560
ds_read_b64_tr_b16 a[136:137], v46 offset:20480
ds_read_b64_tr_b16 a[138:139], v46 offset:20608
ds_read_b64_tr_b16 a[140:141], v46 offset:22528
ds_read_b64_tr_b16 a[142:143], v46 offset:22656
s_waitcnt lgkmcnt(0)
ds_read_b64_tr_b16 a[144:145], v46 offset:24576
ds_read_b64_tr_b16 a[146:147], v46 offset:24704
ds_read_b64_tr_b16 a[148:149], v46 offset:26624
ds_read_b64_tr_b16 a[150:151], v46 offset:26752
ds_read_b64_tr_b16 a[152:153], v46 offset:28672
ds_read_b64_tr_b16 a[154:155], v46 offset:28800
ds_read_b64_tr_b16 a[156:157], v46 offset:30720
ds_read_b64_tr_b16 a[158:159], v46 offset:30848
s_waitcnt lgkmcnt(0)
ds_read_b64_tr_b16 a[160:161], v46 offset:16416
ds_read_b64_tr_b16 a[162:163], v46 offset:16544
ds_read_b64_tr_b16 a[164:165], v46 offset:18464
ds_read_b64_tr_b16 a[166:167], v46 offset:18592
ds_read_b64_tr_b16 a[168:169], v46 offset:20512
ds_read_b64_tr_b16 a[170:171], v46 offset:20640
ds_read_b64_tr_b16 a[172:173], v46 offset:22560
ds_read_b64_tr_b16 a[174:175], v46 offset:22688
s_waitcnt lgkmcnt(0)
ds_read_b64_tr_b16 a[176:177], v46 offset:24608
ds_read_b64_tr_b16 a[178:179], v46 offset:24736
ds_read_b64_tr_b16 a[180:181], v46 offset:26656
ds_read_b64_tr_b16 a[182:183], v46 offset:26784
ds_read_b64_tr_b16 a[184:185], v46 offset:28704
ds_read_b64_tr_b16 a[186:187], v46 offset:28832
ds_read_b64_tr_b16 a[188:189], v46 offset:30752
ds_read_b64_tr_b16 a[190:191], v46 offset:30880
s_waitcnt lgkmcnt(0)
buffer_load_dword v50, v52, s[16:19], 0 offen
s_xor_b32 s29, s76, 0
s_lshl_b32 s28, s29, 10
s_add_u32 s28, s28, s47
s_add_u32 m0, s28, 16384
s_lshl_b32 s29, s29, 15
buffer_load_dwordx4 v41, s[16:19], s29 offen lds
s_xor_b32 s29, s76, 1
s_lshl_b32 s28, s29, 10
s_add_u32 s28, s28, s47
s_add_u32 m0, s28, 16384
s_lshl_b32 s29, s29, 15
buffer_load_dwordx4 v41, s[16:19], s29 offen lds
s_xor_b32 s29, s76, 2
s_lshl_b32 s28, s29, 10
s_add_u32 s28, s28, s47
s_add_u32 m0, s28, 16384
s_lshl_b32 s29, s29, 15
buffer_load_dwordx4 v41, s[16:19], s29 offen lds
s_xor_b32 s29, s76, 3
s_lshl_b32 s28, s29, 10
s_add_u32 s28, s28, s47
s_add_u32 m0, s28, 16384
s_lshl_b32 s29, s29, 15
buffer_load_dwordx4 v41, s[16:19], s29 offen lds
s_xor_b32 s29, s76, 4
s_lshl_b32 s28, s29, 10
s_add_u32 s28, s28, s47
s_add_u32 m0, s28, 16384
s_lshl_b32 s29, s29, 15
buffer_load_dwordx4 v41, s[16:19], s29 offen lds
s_xor_b32 s29, s76, 5
s_lshl_b32 s28, s29, 10
s_add_u32 s28, s28, s47
s_add_u32 m0, s28, 16384
s_lshl_b32 s29, s29, 15
buffer_load_dwordx4 v41, s[16:19], s29 offen lds
s_xor_b32 s29, s76, 6
s_lshl_b32 s28, s29, 10
s_add_u32 s28, s28, s47
s_add_u32 m0, s28, 16384
s_lshl_b32 s29, s29, 15
buffer_load_dwordx4 v41, s[16:19], s29 offen lds
s_xor_b32 s29, s76, 7
s_lshl_b32 s28, s29, 10
s_add_u32 s28, s28, s47
s_add_u32 m0, s28, 16384
s_lshl_b32 s29, s29, 15
buffer_load_dwordx4 v41, s[16:19], s29 offen lds
s_xor_b32 s29, s76, 8
s_lshl_b32 s28, s29, 10
s_add_u32 s28, s28, s47
s_add_u32 m0, s28, 16384
s_lshl_b32 s29, s29, 15
buffer_load_dwordx4 v41, s[16:19], s29 offen lds
s_xor_b32 s29, s76, 9
s_lshl_b32 s28, s29, 10
s_add_u32 s28, s28, s47
s_add_u32 m0, s28, 16384
s_lshl_b32 s29, s29, 15
buffer_load_dwordx4 v41, s[16:19], s29 offen lds
s_xor_b32 s29, s76, 10
s_lshl_b32 s28, s29, 10
s_add_u32 s28, s28, s47
s_add_u32 m0, s28, 16384
s_lshl_b32 s29, s29, 15
buffer_load_dwordx4 v41, s[16:19], s29 offen lds
s_xor_b32 s29, s76, 11
s_lshl_b32 s28, s29, 10
s_add_u32 s28, s28, s47
s_add_u32 m0, s28, 16384
s_lshl_b32 s29, s29, 15
buffer_load_dwordx4 v41, s[16:19], s29 offen lds
s_xor_b32 s29, s76, 12
s_lshl_b32 s28, s29, 10
s_add_u32 s28, s28, s47
s_add_u32 m0, s28, 16384
s_lshl_b32 s29, s29, 15
buffer_load_dwordx4 v41, s[16:19], s29 offen lds
s_xor_b32 s29, s76, 13
s_lshl_b32 s28, s29, 10
s_add_u32 s28, s28, s47
s_add_u32 m0, s28, 16384
s_lshl_b32 s29, s29, 15
buffer_load_dwordx4 v41, s[16:19], s29 offen lds
s_xor_b32 s29, s76, 14
s_lshl_b32 s28, s29, 10
s_add_u32 s28, s28, s47
s_add_u32 m0, s28, 16384
s_lshl_b32 s29, s29, 15
buffer_load_dwordx4 v41, s[16:19], s29 offen lds
s_xor_b32 s29, s76, 15
s_lshl_b32 s28, s29, 10
s_add_u32 s28, s28, s47
s_add_u32 m0, s28, 16384
s_lshl_b32 s29, s29, 15
buffer_load_dwordx4 v41, s[16:19], s29 offen lds
s_mov_b64 exec, 0
s_cmp_eq_u32 s24, 0
s_cbranch_scc1 mega_kernel_rf_iw0
s_cmp_eq_u32 s24, 1
s_cbranch_scc1 mega_kernel_rf_iw1
s_cmp_eq_u32 s24, 2
s_cbranch_scc1 mega_kernel_rf_iw2
s_branch mega_kernel_rf_iw3
mega_kernel_rf_iwd:
s_mov_b64 exec, -1
s_waitcnt vmcnt(17)
ds_read_b64_tr_b16 a[0:1], v46 offset:0
ds_read_b64_tr_b16 a[2:3], v46 offset:128
ds_read_b64_tr_b16 a[4:5], v46 offset:2048
ds_read_b64_tr_b16 a[6:7], v46 offset:2176
ds_read_b64_tr_b16 a[8:9], v46 offset:4096
ds_read_b64_tr_b16 a[10:11], v46 offset:4224
ds_read_b64_tr_b16 a[12:13], v46 offset:6144
ds_read_b64_tr_b16 a[14:15], v46 offset:6272
s_waitcnt lgkmcnt(0)
ds_read_b64_tr_b16 a[16:17], v46 offset:8192
ds_read_b64_tr_b16 a[18:19], v46 offset:8320
ds_read_b64_tr_b16 a[20:21], v46 offset:10240
ds_read_b64_tr_b16 a[22:23], v46 offset:10368
ds_read_b64_tr_b16 a[24:25], v46 offset:12288
ds_read_b64_tr_b16 a[26:27], v46 offset:12416
ds_read_b64_tr_b16 a[28:29], v46 offset:14336
ds_read_b64_tr_b16 a[30:31], v46 offset:14464
s_waitcnt lgkmcnt(0)
ds_read_b64_tr_b16 a[32:33], v46 offset:32
ds_read_b64_tr_b16 a[34:35], v46 offset:160
ds_read_b64_tr_b16 a[36:37], v46 offset:2080
ds_read_b64_tr_b16 a[38:39], v46 offset:2208
ds_read_b64_tr_b16 a[40:41], v46 offset:4128
ds_read_b64_tr_b16 a[42:43], v46 offset:4256
ds_read_b64_tr_b16 a[44:45], v46 offset:6176
ds_read_b64_tr_b16 a[46:47], v46 offset:6304
s_waitcnt lgkmcnt(0)
ds_read_b64_tr_b16 a[48:49], v46 offset:8224
ds_read_b64_tr_b16 a[50:51], v46 offset:8352
ds_read_b64_tr_b16 a[52:53], v46 offset:10272
ds_read_b64_tr_b16 a[54:55], v46 offset:10400
ds_read_b64_tr_b16 a[56:57], v46 offset:12320
ds_read_b64_tr_b16 a[58:59], v46 offset:12448
ds_read_b64_tr_b16 a[60:61], v46 offset:14368
ds_read_b64_tr_b16 a[62:63], v46 offset:14496
s_waitcnt lgkmcnt(0)
v_and_b32 v247, 15, v0
v_lshlrev_b32 v247, 4, v247
buffer_load_dword v246, v247, s[72:75], 0 offen sc1
buffer_load_dwordx4 v[64:67], v8, s[20:23], 0 offen offset:0
buffer_load_dwordx4 v[68:71], v8, s[20:23], 0 offen offset:128
buffer_load_dwordx4 v[72:75], v8, s[20:23], 0 offen offset:256
buffer_load_dwordx4 v[76:79], v8, s[20:23], 0 offen offset:384
s_waitcnt vmcnt(0)
ds_read_b64_tr_b16 a[192:193], v47 offset:16384
ds_read_b64_tr_b16 a[194:195], v47 offset:16512
ds_read_b64_tr_b16 a[196:197], v47 offset:18432
ds_read_b64_tr_b16 a[198:199], v47 offset:18560
ds_read_b64_tr_b16 a[200:201], v47 offset:20480
ds_read_b64_tr_b16 a[202:203], v47 offset:20608
ds_read_b64_tr_b16 a[204:205], v47 offset:22528
ds_read_b64_tr_b16 a[206:207], v47 offset:22656
s_waitcnt lgkmcnt(0)
ds_read_b64_tr_b16 a[208:209], v47 offset:24576
ds_read_b64_tr_b16 a[210:211], v47 offset:24704
ds_read_b64_tr_b16 a[212:213], v47 offset:26624
ds_read_b64_tr_b16 a[214:215], v47 offset:26752
ds_read_b64_tr_b16 a[216:217], v47 offset:28672
ds_read_b64_tr_b16 a[218:219], v47 offset:28800
ds_read_b64_tr_b16 a[220:221], v47 offset:30720
ds_read_b64_tr_b16 a[222:223], v47 offset:30848
s_waitcnt lgkmcnt(0)
ds_read_b64_tr_b16 a[224:225], v47 offset:16416
ds_read_b64_tr_b16 a[226:227], v47 offset:16544
ds_read_b64_tr_b16 a[228:229], v47 offset:18464
ds_read_b64_tr_b16 a[230:231], v47 offset:18592
ds_read_b64_tr_b16 a[232:233], v47 offset:20512
ds_read_b64_tr_b16 a[234:235], v47 offset:20640
ds_read_b64_tr_b16 a[236:237], v47 offset:22560
ds_read_b64_tr_b16 a[238:239], v47 offset:22688
s_waitcnt lgkmcnt(0)
ds_read_b64_tr_b16 a[240:241], v47 offset:24608
ds_read_b64_tr_b16 a[242:243], v47 offset:24736
ds_read_b64_tr_b16 a[244:245], v47 offset:26656
ds_read_b64_tr_b16 a[246:247], v47 offset:26784
ds_read_b64_tr_b16 a[248:249], v47 offset:28704
ds_read_b64_tr_b16 a[250:251], v47 offset:28832
ds_read_b64_tr_b16 a[252:253], v47 offset:30752
ds_read_b64_tr_b16 a[254:255], v47 offset:30880
s_waitcnt lgkmcnt(0)
v_mov_b32 v32, v64
v_mov_b32 v33, v65
v_mov_b32 v34, v66
v_mov_b32 v35, v67
v_mov_b32 v36, v68
v_mov_b32 v37, v69
v_mov_b32 v38, v70
v_mov_b32 v39, v71
v_mov_b32 v40, v72
v_mov_b32 v41, v73
v_mov_b32 v42, v74
v_mov_b32 v43, v75
v_mov_b32 v44, v76
v_mov_b32 v45, v77
v_mov_b32 v46, v78
v_mov_b32 v47, v79
v_mov_b32 v96, 0
v_mov_b32 v97, 0
v_mov_b32 v98, 0
v_mov_b32 v99, 0
v_mov_b32 v100, 0
v_mov_b32 v101, 0
v_mov_b32 v102, 0
v_mov_b32 v103, 0
v_mov_b32 v104, 0
v_mov_b32 v105, 0
v_mov_b32 v106, 0
v_mov_b32 v107, 0
v_mov_b32 v108, 0
v_mov_b32 v109, 0
v_mov_b32 v110, 0
v_mov_b32 v111, 0
v_mov_b32 v112, 0
v_mov_b32 v113, 0
v_mov_b32 v114, 0
v_mov_b32 v115, 0
v_mov_b32 v116, 0
v_mov_b32 v117, 0
v_mov_b32 v118, 0
v_mov_b32 v119, 0
s_nop 1
v_smfmac_f32_16x16x64_bf16 v[96:99], v[32:35], a[0:7], v6
v_smfmac_f32_16x16x64_bf16 v[100:103], v[32:35], a[32:39], v6
v_smfmac_f32_16x16x64_bf16 v[104:107], v[32:35], a[64:71], v6
v_smfmac_f32_16x16x64_bf16 v[108:111], v[32:35], a[96:103], v6
v_smfmac_f32_16x16x64_bf16 v[96:99], v[36:39], a[8:15], v6
v_smfmac_f32_16x16x64_bf16 v[100:103], v[36:39], a[40:47], v6
v_smfmac_f32_16x16x64_bf16 v[104:107], v[36:39], a[72:79], v6
v_smfmac_f32_16x16x64_bf16 v[108:111], v[36:39], a[104:111], v6
v_smfmac_f32_16x16x64_bf16 v[96:99], v[40:43], a[16:23], v6
v_smfmac_f32_16x16x64_bf16 v[100:103], v[40:43], a[48:55], v6
v_smfmac_f32_16x16x64_bf16 v[104:107], v[40:43], a[80:87], v6
v_smfmac_f32_16x16x64_bf16 v[108:111], v[40:43], a[112:119], v6
v_smfmac_f32_16x16x64_bf16 v[96:99], v[44:47], a[24:31], v6
v_smfmac_f32_16x16x64_bf16 v[100:103], v[44:47], a[56:63], v6
v_smfmac_f32_16x16x64_bf16 v[104:107], v[44:47], a[88:95], v6
v_smfmac_f32_16x16x64_bf16 v[108:111], v[44:47], a[120:127], v6
v_and_b32 v247, 15, v0
v_lshlrev_b32 v247, 4, v247
s_branch mega_kernel_syrp
mega_kernel_syrw:
s_sleep 4
mega_kernel_syr:
buffer_load_dword v246, v247, s[72:75], 0 offen sc1
s_waitcnt vmcnt(0)
mega_kernel_syrp:
s_cmp_eq_u32 s95, 1
s_cbranch_scc0 mega_kernel_syrf
v_readlane_b32 s76, v246, 14
s_mov_b32 s98, 0
s_cmp_eq_u32 s76, 32
s_cbranch_scc0 mega_kernel_syrw
s_branch mega_kernel_syrd
mega_kernel_syrf:
s_mov_b32 s77, 0
s_mov_b32 s78, 0
v_readlane_b32 s76, v246, 0
s_add_u32 s77, s77, s76
s_xor_b32 s76, s76, 32
s_or_b32 s78, s78, s76
v_readlane_b32 s76, v246, 1
s_add_u32 s77, s77, s76
s_xor_b32 s76, s76, 32
s_or_b32 s78, s78, s76
v_readlane_b32 s76, v246, 2
s_add_u32 s77, s77, s76
s_xor_b32 s76, s76, 32
s_or_b32 s78, s78, s76
v_readlane_b32 s76, v246, 3
s_add_u32 s77, s77, s76
s_xor_b32 s76, s76, 32
s_or_b32 s78, s78, s76
v_readlane_b32 s76, v246, 4
s_add_u32 s77, s77, s76
s_xor_b32 s76, s76, 32
s_or_b32 s78, s78, s76
v_readlane_b32 s76, v246, 5
s_add_u32 s77, s77, s76
s_xor_b32 s76, s76, 32
s_or_b32 s78, s78, s76
v_readlane_b32 s76, v246, 6
s_add_u32 s77, s77, s76
s_xor_b32 s76, s76, 32
s_or_b32 s78, s78, s76
v_readlane_b32 s76, v246, 7
s_add_u32 s77, s77, s76
s_xor_b32 s76, s76, 32
s_or_b32 s78, s78, s76
s_cmp_eq_u32 s77, 256
s_cbranch_scc0 mega_kernel_syrw
v_mov_b32 v252, v246
s_cmp_eq_u32 s78, 0
s_cbranch_scc0 mega_kernel_slowent
v_readlane_b32 s76, v246, 10
v_readlane_b32 s77, v246, 8
s_cmp_eq_u32 s76, 32
s_cbranch_scc0 mega_kernel_syrw
s_cmp_gt_u32 s77, 16
s_cselect_b32 s98, 1, 0
mega_kernel_syrd:
s_lshr_b32 s28, s31, 4
s_lshl_b32 s28, s28, 14
s_lshl_b32 s29, s98, 13
s_add_u32 s28, s28, s29
s_and_b32 s29, s31, 15
s_lshl_b32 s29, s29, 9
s_add_u32 s28, s28, s29
s_lshl_b32 s29, s30, 16
s_add_u32 s28, s28, s29
s_add_u32 s28, s28, 67108864
v_lshrrev_b32 v12, 1, v17
v_add_u32 v12, s28, v12
v_xor_b32 v25, 0x10000, v12
v_xor_b32 v26, 0x20000, v12
v_xor_b32 v27, 0x30000, v12
v_add_u32 v25, 0, v25
v_add_u32 v26, 0, v26
v_add_u32 v27, 0, v27
s_lshl_b32 s28, s25, 2
s_add_u32 s28, s28, s26
s_mov_b32 s82, s28
s_lshr_b32 s29, s28, 3
s_xor_b32 s29, s29, s98
s_and_b32 s29, s29, 1
s_lshl_b32 s29, s29, 13
s_lshl_b32 s76, s28, 18
s_add_u32 s76, s76, s29
s_mov_b32 s83, s76
v_add_u32 v240, s76, v17
v_add_u32 v241, 33554432, v240
s_lshr_b32 s29, s28, 4
s_xor_b32 s29, s29, s98
s_and_b32 s29, s29, 1
s_lshl_b32 s29, s29, 13
s_lshl_b32 s79, s28, 17
s_add_u32 s79, s79, s29
s_add_u32 s79, s79, 71303168
s_xor_b32 s29, s98, 1
s_lshl_b32 s29, s29, 13
s_lshl_b32 s28, s25, 7
s_add_u32 s28, s28, s29
s_add_u32 s28, s28, 69206016
v_and_b32 v4, 1, v1
v_lshlrev_b32 v24, 12, v4
v_add_u32 v24, s28, v24
s_lshl_b32 s29, s26, 2
v_add_u32 v24, s29, v24
s_xor_b32 s81, s98, 1
s_lshl_b32 s81, s81, 13
s_lshr_b32 s29, s82, 6
s_lshl_b32 s29, s29, 14
s_add_u32 s81, s81, s29
s_and_b32 s29, s82, 63
s_lshl_b32 s29, s29, 7
s_add_u32 s81, s81, s29
s_add_u32 s81, s81, 69222400
v_mov_b32 v220, 0x3f803f80
v_mov_b32 v221, 0x3f803f80
v_mov_b32 v222, 0x3f803f80
v_mov_b32 v223, 0x3f803f80
v_mov_b32 v228, 0
s_mov_b32 s27, 0
s_mov_b32 s46, 0
s_mov_b32 s89, 0
s_mov_b32 s88, 0
s_mov_b32 s44, 18432
s_mov_b32 s45, 18432
s_cmp_eq_u32 s24, 3
s_cbranch_scc0 mega_kernel_rf_pfi
s_mov_b32 s76, 0
s_cmp_gt_i32 s46, s76
s_cbranch_scc1 mega_kernel_rf_pf0ok
mega_kernel_rf_pf0w:
v_mov_b32 v4, 0
s_mov_b64 exec, 3
buffer_atomic_add v4, v24, s[84:87], 0 offen sc0 sc1
s_mov_b64 exec, -1
s_waitcnt vmcnt(0)
v_readlane_b32 s46, v4, 0
v_readlane_b32 s28, v4, 1
s_nop 1
s_min_i32 s46, s46, s28
s_cmp_gt_i32 s46, s76
s_cbranch_scc0 mega_kernel_rf_pf0w
mega_kernel_rf_pf0ok:
s_add_u32 s77, s76, s82
s_bfe_u32 s28, s77, 0x40002
s_lshl_b32 s28, s28, 14
s_and_b32 s77, s77, 3
s_lshl_b32 s77, s77, 11
s_add_u32 s28, s28, s77
s_add_u32 m0, s45, 0
s_nop 0
buffer_load_dwordx4 v240, s[84:87], s28 offen offset:0 sc1 lds
s_add_u32 m0, s45, 0
s_nop 0
buffer_load_dwordx4 v240, s[84:87], s28 offen offset:1024 sc1 lds
s_add_u32 m0, s45, 2048
s_nop 0
buffer_load_dwordx4 v241, s[84:87], s28 offen offset:0 sc1 lds
s_add_u32 m0, s45, 2048
s_nop 0
buffer_load_dwordx4 v241, s[84:87], s28 offen offset:1024 sc1 lds
s_add_u32 s45, s45, 4096
s_cmp_eq_u32 s45, 30720
s_cselect_b32 s45, 18432, s45
s_waitcnt vmcnt(0) lgkmcnt(0)
s_branch mega_kernel_rf_pfj
mega_kernel_rf_pfi:
s_lshr_b32 s88, s25, 2
s_lshl_b32 s88, s88, 17
s_and_b32 s77, s25, 2
s_lshl_b32 s77, s77, 13
s_add_u32 s88, s88, s77
s_and_b32 s77, s25, 1
s_lshl_b32 s77, s77, 12
s_add_u32 s88, s88, s77
s_xor_b32 s77, s98, 0
s_lshl_b32 s77, s77, 13
s_add_u32 s88, s88, s77
s_add_u32 s88, s88, 68255744
s_lshl_b32 s77, s26, 10
s_add_u32 s88, s88, s77
mega_kernel_rf_pfj:
v_mov_b32 v184, 0
v_mov_b32 v185, 0
v_mov_b32 v186, 0
v_mov_b32 v187, 0
v_mov_b32 v188, 0
v_mov_b32 v189, 0
v_mov_b32 v190, 0
v_mov_b32 v191, 0
v_mov_b32 v192, 0
v_mov_b32 v193, 0
v_mov_b32 v194, 0
v_mov_b32 v195, 0
v_mov_b32 v196, 0
v_mov_b32 v197, 0
v_mov_b32 v198, 0
v_mov_b32 v199, 0
v_mov_b32 v200, 0
v_mov_b32 v201, 0
v_mov_b32 v202, 0
v_mov_b32 v203, 0
v_mov_b32 v204, 0
v_mov_b32 v205, 0
v_mov_b32 v206, 0
v_mov_b32 v207, 0
v_mov_b32 v249, 0
s_barrier
s_and_b32 s29, s27, 1
s_lshl_b32 s33, s29, 17
s_lshl_b32 s28, s30, 18
s_add_u32 s33, s33, s28
s_add_u32 s33, s33, 68157440
s_xor_b32 s34, s33, 131072
s_lshl_b32 s35, s29, 18
s_bfe_u32 s47, s27, 0x10001
s_branch mega_kernel_rf_first
.p2align 6
s_nop 0
s_nop 0
mega_kernel_rf_loop:
buffer_load_dwordx4 v[32:35], v7, s[84:87], s33 offen offset:0 sc1
v_add_u32 v5, s44, v17
ds_read_b128 v[156:159], v5 offset:0
ds_read_b128 v[160:163], v5 offset:1024
ds_read_b128 v[164:167], v5 offset:2048
ds_read_b128 v[168:171], v5 offset:3072
s_nop 4
buffer_load_dwordx4 v[36:39], v7, s[84:87], s33 offen offset:1024 sc1
s_nop 9
buffer_load_dwordx4 v[40:43], v7, s[84:87], s33 offen offset:2048 sc1
s_nop 9
buffer_load_dwordx4 v[44:47], v7, s[84:87], s33 offen offset:3072 sc1
s_waitcnt vmcnt(3)
v_max_u32 v4, v32, v34
v_cmp_eq_u32 vcc, -1, v4
s_cbranch_vccnz mega_kernel_rf_pa_15_0f
v_smfmac_f32_16x16x64_bf16 v[96:99], v[32:35], a[0:7], v6
v_smfmac_f32_16x16x64_bf16 v[100:103], v[32:35], a[32:39], v6
v_smfmac_f32_16x16x64_bf16 v[104:107], v[32:35], a[64:71], v6
s_waitcnt vmcnt(2)
v_max_u32 v4, v36, v38
v_cmp_eq_u32 vcc, -1, v4
v_smfmac_f32_16x16x64_bf16 v[108:111], v[32:35], a[96:103], v6
s_cbranch_vccnz mega_kernel_rf_pa_14_1f
v_smfmac_f32_16x16x64_bf16 v[96:99], v[36:39], a[8:15], v6
v_smfmac_f32_16x16x64_bf16 v[100:103], v[36:39], a[40:47], v6
v_smfmac_f32_16x16x64_bf16 v[104:107], v[36:39], a[72:79], v6
s_waitcnt vmcnt(1)
v_max_u32 v4, v40, v42
v_cmp_eq_u32 vcc, -1, v4
v_smfmac_f32_16x16x64_bf16 v[108:111], v[36:39], a[104:111], v6
s_cbranch_vccnz mega_kernel_rf_pa_12_2f
v_smfmac_f32_16x16x64_bf16 v[96:99], v[40:43], a[16:23], v6
v_smfmac_f32_16x16x64_bf16 v[100:103], v[40:43], a[48:55], v6
v_smfmac_f32_16x16x64_bf16 v[104:107], v[40:43], a[80:87], v6
s_waitcnt vmcnt(0)
v_max_u32 v4, v44, v46
v_cmp_eq_u32 vcc, -1, v4
v_smfmac_f32_16x16x64_bf16 v[108:111], v[40:43], a[112:119], v6
s_cbranch_vccnz mega_kernel_rf_pa_8_3f
v_smfmac_f32_16x16x64_bf16 v[96:99], v[44:47], a[24:31], v6
v_smfmac_f32_16x16x64_bf16 v[100:103], v[44:47], a[56:63], v6
v_smfmac_f32_16x16x64_bf16 v[104:107], v[44:47], a[88:95], v6
v_smfmac_f32_16x16x64_bf16 v[108:111], v[44:47], a[120:127], v6
mega_kernel_rf_pa_d:
mega_kernel_rf_adone:
s_nop 5
v_permlane32_swap_b32 v96, v100
v_permlane32_swap_b32 v97, v101
v_permlane32_swap_b32 v98, v102
v_permlane32_swap_b32 v99, v103
v_pk_add_f32 v[96:97], v[96:97], v[100:101]
v_pk_add_f32 v[98:99], v[98:99], v[102:103]
ds_write2_b32 v14, v96, v97 offset0:0 offset1:36
ds_write2_b32 v14, v98, v99 offset0:72 offset1:108
v_permlane32_swap_b32 v104, v108
v_permlane32_swap_b32 v105, v109
v_permlane32_swap_b32 v106, v110
v_permlane32_swap_b32 v107, v111
v_pk_add_f32 v[104:105], v[104:105], v[108:109]
v_pk_add_f32 v[106:107], v[106:107], v[110:111]
ds_write2_b32 v15, v104, v105 offset0:0 offset1:36
ds_write2_b32 v15, v106, v107 offset0:72 offset1:108
v_smfmac_f32_16x16x64_bf16 v[112:115], v[32:35], a[128:135], v6
v_smfmac_f32_16x16x64_bf16 v[116:119], v[32:35], a[160:167], v6
v_smfmac_f32_16x16x64_bf16 v[112:115], v[36:39], a[136:143], v6
v_smfmac_f32_16x16x64_bf16 v[116:119], v[36:39], a[168:175], v6
s_waitcnt lgkmcnt(0)
s_barrier
s_cmp_lg_u32 s24, 0
s_cbranch_scc1 mega_kernel_rf_side
ds_read_b128 v[120:123], v16 offset:0
ds_read_b128 v[124:127], v16 offset:16
ds_read_b128 v[128:131], v16 offset:2304
ds_read_b128 v[132:135], v16 offset:2320
ds_read_b128 v[136:139], v16 offset:4608
ds_read_b128 v[140:143], v16 offset:4624
ds_read_b128 v[144:147], v16 offset:6912
ds_read_b128 v[148:151], v16 offset:6928
v_smfmac_f32_16x16x64_bf16 v[112:115], v[40:43], a[144:151], v6
v_smfmac_f32_16x16x64_bf16 v[116:119], v[40:43], a[176:183], v6
v_smfmac_f32_16x16x64_bf16 v[112:115], v[44:47], a[152:159], v6
v_smfmac_f32_16x16x64_bf16 v[116:119], v[44:47], a[184:191], v6
s_mul_i32 s28, s31, 1280
s_add_u32 s28, s28, s33
s_add_u32 s28, s28, 49152
s_add_u32 s76, s37, s33
s_add_u32 s77, s38, s33
s_add_u32 s78, s39, s33
s_waitcnt lgkmcnt(4)
v_pk_add_f32 v[120:121], v[120:121], v[128:129]
v_pk_add_f32 v[122:123], v[122:123], v[130:131]
v_pk_add_f32 v[124:125], v[124:125], v[132:133]
v_pk_add_f32 v[126:127], v[126:127], v[134:135]
s_waitcnt lgkmcnt(0)
v_pk_add_f32 v[136:137], v[136:137], v[144:145]
v_pk_add_f32 v[138:139], v[138:139], v[146:147]
v_pk_add_f32 v[140:141], v[140:141], v[148:149]
v_pk_add_f32 v[142:143], v[142:143], v[150:151]
v_pk_add_f32 v[120:121], v[120:121], v[136:137]
v_pk_add_f32 v[122:123], v[122:123], v[138:139]
v_pk_add_f32 v[124:125], v[124:125], v[140:141]
v_pk_add_f32 v[126:127], v[126:127], v[142:143]
v_cvt_pk_bf16_f32 v152, v120, v121
v_cvt_pk_bf16_f32 v153, v122, v123
v_cvt_pk_bf16_f32 v154, v124, v125
v_cvt_pk_bf16_f32 v155, v126, v127
s_nop 1
v_mfma_f32_16x16x32_bf16 v[176:179], v[160:163], v[152:155], 0
v_mfma_f32_16x16x32_bf16 v[172:175], v[156:159], v[152:155], 0
v_mfma_f32_16x16x32_bf16 v[180:183], v[152:155], v[152:155], 0
s_cmp_eq_u32 s27, 63
s_cbranch_scc1 mega_kernel_rf_w0last
s_nop 4
v_mov_b32_dpp v172, v176 row_shr:8 row_mask:0xf bank_mask:0xc
v_mov_b32_dpp v173, v177 row_shr:8 row_mask:0xf bank_mask:0xc
v_mov_b32_dpp v174, v178 row_shr:8 row_mask:0xf bank_mask:0xc
v_mov_b32_dpp v175, v179 row_shr:8 row_mask:0xf bank_mask:0xc
v_min_u32 v180, -2, v180
v_min_u32 v172, -2, v172
s_mov_b64 exec, s[42:43]
buffer_store_dwordx4 v[180:183], v10, s[84:87], s28 offen
s_mov_b64 exec, -1
buffer_store_dwordx4 v[172:175], v17, s[84:87], s28 offen
v_permlane32_swap_b32 v112, v116
v_permlane32_swap_b32 v113, v117
v_permlane32_swap_b32 v114, v118
v_permlane32_swap_b32 v115, v119
v_pk_add_f32 v[112:113], v[112:113], v[116:117]
v_pk_add_f32 v[114:115], v[114:115], v[118:119]
ds_write_b128 v20, v[112:115]
s_waitcnt lgkmcnt(0)
s_barrier
v_mov_b32 v96, 0
v_mov_b32 v97, 0
v_mov_b32 v98, 0
v_mov_b32 v99, 0
v_mov_b32 v100, 0
v_mov_b32 v101, 0
v_mov_b32 v102, 0
v_mov_b32 v103, 0
v_cndmask_b32 v176, v23, v180, s[42:43]
v_cndmask_b32 v177, v23, v181, s[42:43]
v_cndmask_b32 v178, v23, v182, s[42:43]
v_cndmask_b32 v179, v23, v183, s[42:43]
s_mov_b64 exec, s[42:43]
buffer_load_dwordx4 v[188:191], v10, s[84:87], s76 offen sc1
buffer_load_dwordx4 v[196:199], v10, s[84:87], s77 offen sc1
buffer_load_dwordx4 v[204:207], v10, s[84:87], s78 offen sc1
s_mov_b64 exec, -1
buffer_load_dwordx4 v[184:187], v17, s[84:87], s76 offen sc1
buffer_load_dwordx4 v[192:195], v17, s[84:87], s77 offen sc1
buffer_load_dwordx4 v[200:203], v17, s[84:87], s78 offen sc1
v_pk_mul_f32 v[172:173], v[172:173], s[32:33] op_sel_hi:[1,0]
v_pk_mul_f32 v[174:175], v[174:175], s[32:33] op_sel_hi:[1,0]
v_pk_mul_f32 v[176:177], v[176:177], s[32:33] op_sel_hi:[1,0]
v_pk_mul_f32 v[178:179], v[178:179], s[32:33] op_sel_hi:[1,0]
s_lshl_b32 s89, s47, 31
s_or_b32 s89, s89, 0x3b39999a
s_nop 15
s_nop 1
s_mov_b64 exec, s[42:43]
buffer_load_dwordx4 v[188:191], v10, s[84:87], s76 offen sc1
buffer_load_dwordx4 v[196:199], v10, s[84:87], s77 offen sc1
buffer_load_dwordx4 v[204:207], v10, s[84:87], s78 offen sc1
s_mov_b64 exec, -1
buffer_load_dwordx4 v[184:187], v17, s[84:87], s76 offen sc1
buffer_load_dwordx4 v[192:195], v17, s[84:87], s77 offen sc1
buffer_load_dwordx4 v[200:203], v17, s[84:87], s78 offen sc1
mega_kernel_rf_p2:
s_waitcnt vmcnt(6)
v_max3_u32 v4, v184, v188, v192
v_max3_u32 v5, v196, v200, v204
v_max_u32 v4, v4, v5
v_cmp_eq_u32 vcc, -1, v4
s_cbranch_vccnz mega_kernel_rf_p2r
v_pk_add_f32 v[124:125], v[196:197], v[204:205]
v_pk_add_f32 v[126:127], v[198:199], v[206:207]
v_pk_add_f32 v[120:121], v[192:193], v[200:201]
v_pk_add_f32 v[122:123], v[194:195], v[202:203]
v_pk_add_f32 v[124:125], v[124:125], v[188:189]
v_pk_add_f32 v[126:127], v[126:127], v[190:191]
v_pk_add_f32 v[120:121], v[120:121], v[184:185]
v_pk_add_f32 v[122:123], v[122:123], v[186:187]
v_pk_fma_f32 v[176:177], v[124:125], s[32:33], v[176:177] op_sel_hi:[1,0,1]
v_pk_fma_f32 v[178:179], v[126:127], s[32:33], v[178:179] op_sel_hi:[1,0,1]
v_pk_fma_f32 v[172:173], v[120:121], s[32:33], v[172:173] op_sel_hi:[1,0,1]
v_pk_fma_f32 v[174:175], v[122:123], s[32:33], v[174:175] op_sel_hi:[1,0,1]
v_max3_f32 v232, v172, v173, v174
v_max3_f32 v233, v176, v177, v178
v_max3_f32 v232, v232, v175, v179
v_max_f32 v234, v232, v233
s_barrier
ds_read2_b64 v[208:211], v21 offset0:0 offset1:32
v_max_f32_dpp v232, v234, v234 row_ror:8 row_mask:0xf bank_mask:0xf
v_max_f32_dpp v233, v234, v234 row_ror:8 row_mask:0xf bank_mask:0xf
s_nop 1
v_permlane16_swap_b32 v232, v233
s_nop 0
v_max_f32 v234, v232, v233
v_max_f32 v235, v232, v233
s_nop 1
v_permlane32_swap_b32 v234, v235
s_nop 0
v_max_f32 v232, v234, v235
v_pk_add_f32 v[176:177], v[176:177], v[232:233] op_sel_hi:[1,0] neg_lo:[0,1] neg_hi:[0,1]
v_pk_add_f32 v[178:179], v[178:179], v[232:233] op_sel_hi:[1,0] neg_lo:[0,1] neg_hi:[0,1]
v_pk_add_f32 v[172:173], v[172:173], v[232:233] op_sel_hi:[1,0] neg_lo:[0,1] neg_hi:[0,1]
v_pk_add_f32 v[174:175], v[174:175], v[232:233] op_sel_hi:[1,0] neg_lo:[0,1] neg_hi:[0,1]
v_exp_f32 v176, v176
v_exp_f32 v177, v177
v_exp_f32 v178, v178
v_exp_f32 v179, v179
v_exp_f32 v172, v172
v_cvt_pk_bf16_f32 v216, v176, v177
v_cvt_pk_bf16_f32 v217, v178, v179
v_exp_f32 v173, v173
v_exp_f32 v174, v174
v_mfma_f32_16x16x16_bf16 v[224:227], v[220:221], v[216:217], 0
v_exp_f32 v175, v175
v_cvt_pk_bf16_f32 v212, v172, v173
s_waitcnt lgkmcnt(0)
v_mfma_f32_16x16x16_bf16 v[120:123], v[208:209], v[216:217], 0
v_cvt_pk_bf16_f32 v213, v174, v175
v_mfma_f32_16x16x16_bf16 v[124:127], v[210:211], v[216:217], 0
v_mov_b32_dpp v214, v212 row_ror:8 row_mask:0xf bank_mask:0xf
v_mov_b32_dpp v215, v213 row_ror:8 row_mask:0xf bank_mask:0xf
s_nop 1
v_mfma_f32_16x16x32_bf16 v[224:227], v[220:223], v[212:215], v[224:227]
v_mfma_f32_16x16x32_bf16 v[120:123], v[164:167], v[212:215], v[120:123]
v_mfma_f32_16x16x32_bf16 v[124:127], v[168:171], v[212:215], v[124:127]
s_add_u32 s29, s33, 24576
s_nop 4
v_rcp_f32 v234, v224
s_nop 0
v_pk_mul_f32 v[120:121], v[120:121], v[234:235] op_sel_hi:[1,0]
v_pk_mul_f32 v[122:123], v[122:123], v[234:235] op_sel_hi:[1,0]
v_pk_mul_f32 v[124:125], v[124:125], v[234:235] op_sel_hi:[1,0]
v_pk_mul_f32 v[126:127], v[126:127], v[234:235] op_sel_hi:[1,0]
v_cvt_pk_bf16_f32 v212, v120, v121
v_cvt_pk_bf16_f32 v213, v122, v123
v_cvt_pk_bf16_f32 v214, v124, v125
v_cvt_pk_bf16_f32 v215, v126, v127
v_min_u32 v212, -2, v212
s_mov_b64 exec, s[40:41]
buffer_store_dwordx4 v[212:215], v11, s[84:87], s33 offen
s_mov_b64 exec, -1
mega_kernel_rf_b3:
s_barrier
s_nop 15
buffer_load_dwordx4 v[32:35], v7, s[84:87], s29 offen offset:0 sc1
s_nop 9
buffer_load_dwordx4 v[36:39], v7, s[84:87], s29 offen offset:1024 sc1
s_nop 9
buffer_load_dwordx4 v[40:43], v7, s[84:87], s29 offen offset:2048 sc1
s_nop 9
buffer_load_dwordx4 v[44:47], v7, s[84:87], s29 offen offset:3072 sc1
mega_kernel_rf_pc_15_0:
s_waitcnt vmcnt(3)
v_cmp_eq_u32 vcc, -1, v32
s_cbranch_vccnz mega_kernel_rf_pc_15_0f
v_smfmac_f32_16x16x64_bf16 v[96:99], v[32:35], a[192:199], v6
v_smfmac_f32_16x16x64_bf16 v[100:103], v[32:35], a[224:231], v6
mega_kernel_rf_pc_14_1:
s_waitcnt vmcnt(2)
v_cmp_eq_u32 vcc, -1, v36
s_cbranch_vccnz mega_kernel_rf_pc_14_1f
v_smfmac_f32_16x16x64_bf16 v[96:99], v[36:39], a[200:207], v6
v_smfmac_f32_16x16x64_bf16 v[100:103], v[36:39], a[232:239], v6
mega_kernel_rf_pc_12_2:
s_waitcnt vmcnt(1)
v_cmp_eq_u32 vcc, -1, v40
s_cbranch_vccnz mega_kernel_rf_pc_12_2f
v_smfmac_f32_16x16x64_bf16 v[96:99], v[40:43], a[208:215], v6
v_smfmac_f32_16x16x64_bf16 v[100:103], v[40:43], a[240:247], v6
mega_kernel_rf_pc_8_3:
s_waitcnt vmcnt(0)
v_cmp_eq_u32 vcc, -1, v44
s_cbranch_vccnz mega_kernel_rf_pc_8_3f
v_smfmac_f32_16x16x64_bf16 v[96:99], v[44:47], a[216:223], v6
v_smfmac_f32_16x16x64_bf16 v[100:103], v[44:47], a[248:255], v6
mega_kernel_rf_pc_d:
s_nop 7
v_permlane32_swap_b32 v96, v100
v_permlane32_swap_b32 v97, v101
v_permlane32_swap_b32 v98, v102
v_permlane32_swap_b32 v99, v103
v_pk_add_f32 v[96:97], v[96:97], v[100:101]
v_pk_add_f32 v[98:99], v[98:99], v[102:103]
ds_write2_b32 v18, v96, v97 offset0:0 offset1:36
ds_write2_b32 v18, v98, v99 offset0:72 offset1:108
s_waitcnt lgkmcnt(0)
s_barrier
s_cmp_lg_u32 s24, 0
s_cbranch_scc1 mega_kernel_rf_x1
ds_read_b128 v[120:123], v19 offset:0
ds_read_b128 v[124:127], v19 offset:1152
ds_read_b128 v[128:131], v19 offset:2304
ds_read_b128 v[132:135], v19 offset:3456
s_waitcnt lgkmcnt(2)
v_pk_add_f32 v[120:121], v[120:121], v[124:125]
v_pk_add_f32 v[122:123], v[122:123], v[126:127]
s_waitcnt lgkmcnt(0)
v_pk_add_f32 v[128:129], v[128:129], v[132:133]
v_pk_add_f32 v[130:131], v[130:131], v[134:135]
v_pk_add_f32 v[120:121], v[120:121], v[128:129]
v_pk_add_f32 v[122:123], v[122:123], v[130:131]
v_fma_f32 v212, v120, s89, v120
v_cvt_pk_bf16_f32 v213, v122, v123
v_cvt_pk_bf16_f32 v212, v212, v121
v_and_or_b32 v212, v212, -2, s47
buffer_store_dwordx2 v[212:213], v12, s[84:87], s35 offen sc1
s_mov_b32 s77, 0x3f80
s_mov_b32 s78, 0x3f800000
s_xor_b32 s76, s47, 1
v_mov_b32 v48, s76
v_mov_b32 v50, s76
v_mov_b32 v52, s76
s_nop 8
v_mov_b32 v96, 0
v_mov_b32 v97, 0
v_mov_b32 v98, 0
v_mov_b32 v99, 0
v_mov_b32 v100, 0
v_mov_b32 v101, 0
v_mov_b32 v102, 0
v_mov_b32 v103, 0
v_mov_b32 v104, 0
v_mov_b32 v105, 0
v_mov_b32 v106, 0
v_mov_b32 v107, 0
v_mov_b32 v108, 0
v_mov_b32 v109, 0
v_mov_b32 v110, 0
v_mov_b32 v111, 0
v_mov_b32 v112, 0
v_mov_b32 v113, 0
v_mov_b32 v114, 0
v_mov_b32 v115, 0
v_mov_b32 v116, 0
v_mov_b32 v117, 0
v_mov_b32 v118, 0
v_mov_b32 v119, 0
s_nop 15
s_nop 7
s_cmp_eq_u32 s47, 1
s_cbranch_scc1 mega_kernel_rf_p4_1
.p2align 6
mega_kernel_rf_p4_0:
buffer_load_dwordx2 v[48:49], v25, s[84:87], s35 offen sc1
buffer_load_dwordx2 v[50:51], v26, s[84:87], s35 offen sc1
buffer_load_dwordx2 v[52:53], v27, s[84:87], s35 offen sc1
s_waitcnt vmcnt(12)
mega_kernel_rf_p4c_0:
v_bitop3_b32 v4, v48, v50, v52 bitop3:0xfe
v_and_b32 v4, 1, v4
v_cmp_ne_u32 vcc, 0, v4
s_cbranch_vccnz mega_kernel_rf_p4_0
v_dot2_f32_bf16 v120, v48, s77, v120
v_dot2_f32_bf16 v121, v48, s78, v121
v_dot2_f32_bf16 v122, v49, s77, v122
v_dot2_f32_bf16 v123, v49, s78, v123
v_dot2_f32_bf16 v120, v50, s77, v120
v_dot2_f32_bf16 v121, v50, s78, v121
v_dot2_f32_bf16 v122, v51, s77, v122
v_dot2_f32_bf16 v123, v51, s78, v123
v_dot2_f32_bf16 v120, v52, s77, v120
v_dot2_f32_bf16 v121, v52, s78, v121
v_dot2_f32_bf16 v122, v53, s77, v122
v_dot2_f32_bf16 v123, v53, s78, v123
s_nop 0
v_cvt_pk_bf16_f32 v212, v120, v121
v_min_u32 v212, -2, v212
v_cvt_pk_bf16_f32 v213, v122, v123
buffer_store_dwordx2 v[212:213], v9, s[84:87], s34 offen
s_branch mega_kernel_rf_p4d
mega_kernel_rf_iw0:
mega_kernel_rf_il0:
s_cbranch_execz mega_kernel_rf_il1
.p2align 6
mega_kernel_rf_p4_1:
buffer_load_dwordx2 v[48:49], v25, s[84:87], s35 offen sc1
buffer_load_dwordx2 v[50:51], v26, s[84:87], s35 offen sc1
buffer_load_dwordx2 v[52:53], v27, s[84:87], s35 offen sc1
s_waitcnt vmcnt(12)
mega_kernel_rf_p4c_1:
v_bitop3_b32 v4, v48, v50, v52 bitop3:0x80
v_and_b32 v4, 1, v4
v_cmp_ne_u32 vcc, 1, v4
s_cbranch_vccnz mega_kernel_rf_p4_1
v_dot2_f32_bf16 v120, v48, s77, v120
v_dot2_f32_bf16 v121, v48, s78, v121
v_dot2_f32_bf16 v122, v49, s77, v122
v_dot2_f32_bf16 v123, v49, s78, v123
v_dot2_f32_bf16 v120, v50, s77, v120
v_dot2_f32_bf16 v121, v50, s78, v121
v_dot2_f32_bf16 v122, v51, s77, v122
v_dot2_f32_bf16 v123, v51, s78, v123
v_dot2_f32_bf16 v120, v52, s77, v120
v_dot2_f32_bf16 v121, v52, s78, v121
v_dot2_f32_bf16 v122, v53, s77, v122
v_dot2_f32_bf16 v123, v53, s78, v123
s_nop 0
v_cvt_pk_bf16_f32 v212, v120, v121
v_min_u32 v212, -2, v212
v_cvt_pk_bf16_f32 v213, v122, v123
buffer_store_dwordx2 v[212:213], v9, s[84:87], s34 offen
mega_kernel_rf_p4d:
mega_kernel_rf_b5:
s_add_u32 s27, s27, 1
s_add_u32 s44, s44, 4096
s_cmp_eq_u32 s44, 30720
s_cselect_b32 s44, 18432, s44
s_mov_b32 s28, s33
s_mov_b32 s33, s34
s_mov_b32 s34, s28
s_xor_b32 s35, s35, 262144
s_bfe_u32 s47, s27, 0x10001
s_barrier
s_nop 15
s_branch mega_kernel_rf_loop
mega_kernel_rf_il1:
s_cbranch_execz mega_kernel_rf_il2
mega_kernel_rf_x1:
s_cmp_eq_u32 s24, 1
s_cbranch_scc0 mega_kernel_rf_x2
s_add_u32 s76, s27, 1
s_sleep 6
v_mov_b32 v5, s76
s_mov_b64 exec, 1
buffer_store_dword v5, v228, s[84:87], s81 offen sc1
s_mov_b64 exec, -1
mega_kernel_rf_x2:
s_cmp_eq_u32 s24, 3
s_cbranch_scc0 mega_kernel_rf_x4
s_cmp_eq_u32 s36, 1
s_cbranch_scc0 mega_kernel_rf_x5
s_add_u32 s76, s27, 1
s_cmp_gt_i32 s46, s76
s_cbranch_scc1 mega_kernel_rf_pf1ok
mega_kernel_rf_pf1w:
v_mov_b32 v4, 0
s_mov_b64 exec, 3
buffer_atomic_add v4, v24, s[84:87], 0 offen sc0 sc1
s_mov_b64 exec, -1
s_waitcnt vmcnt(0)
v_readlane_b32 s46, v4, 0
v_readlane_b32 s28, v4, 1
s_nop 1
s_min_i32 s46, s46, s28
s_cmp_gt_i32 s46, s76
s_cbranch_scc0 mega_kernel_rf_pf1w
mega_kernel_rf_pf1ok:
s_add_u32 s77, s76, s82
s_bfe_u32 s28, s77, 0x40002
s_lshl_b32 s28, s28, 14
s_and_b32 s77, s77, 3
s_lshl_b32 s77, s77, 11
s_add_u32 s28, s28, s77
s_add_u32 m0, s45, 0
s_nop 0
buffer_load_dwordx4 v240, s[84:87], s28 offen offset:0 sc1 lds
s_add_u32 m0, s45, 0
s_nop 0
buffer_load_dwordx4 v240, s[84:87], s28 offen offset:1024 sc1 lds
s_add_u32 m0, s45, 2048
s_nop 0
buffer_load_dwordx4 v241, s[84:87], s28 offen offset:0 sc1 lds
s_add_u32 m0, s45, 2048
s_nop 0
buffer_load_dwordx4 v241, s[84:87], s28 offen offset:1024 sc1 lds
s_add_u32 s45, s45, 4096
s_cmp_eq_u32 s45, 30720
s_cselect_b32 s45, 18432, s45
s_waitcnt vmcnt(0)
mega_kernel_rf_x5:
s_add_u32 s76, s27, 4
s_min_u32 s76, s76, 63
s_cmp_gt_i32 s46, s76
s_cbranch_scc1 mega_kernel_rf_x6
v_mov_b32 v249, 0
s_mov_b64 exec, 3
buffer_atomic_add v249, v24, s[84:87], 0 offen sc0 sc1
s_mov_b64 exec, -1
mega_kernel_rf_x6:
s_add_u32 s76, s27, 2
s_cmp_lt_u32 s76, 63
s_cbranch_scc0 mega_kernel_rf_x4
s_cmp_gt_i32 s46, s76
s_cbranch_scc0 mega_kernel_rf_x4
s_add_u32 s77, s76, s82
s_bfe_u32 s28, s77, 0x40002
s_lshl_b32 s28, s28, 14
s_and_b32 s77, s77, 3
s_lshl_b32 s77, s77, 11
s_add_u32 s28, s28, s77
s_add_u32 s28, s28, s83
s_add_u32 s28, s28, 33554432
s_buffer_load_dword s78, s[84:87], s28 offset:0
s_buffer_load_dword s78, s[84:87], s28 offset:128
s_buffer_load_dword s78, s[84:87], s28 offset:256
s_buffer_load_dword s78, s[84:87], s28 offset:384
s_buffer_load_dword s78, s[84:87], s28 offset:512
s_buffer_load_dword s78, s[84:87], s28 offset:640
s_buffer_load_dword s78, s[84:87], s28 offset:768
s_buffer_load_dword s78, s[84:87], s28 offset:896
s_buffer_load_dword s78, s[84:87], s28 offset:1024
s_buffer_load_dword s78, s[84:87], s28 offset:1152
s_buffer_load_dword s78, s[84:87], s28 offset:1280
s_buffer_load_dword s78, s[84:87], s28 offset:1408
s_buffer_load_dword s78, s[84:87], s28 offset:1536
s_buffer_load_dword s78, s[84:87], s28 offset:1664
s_buffer_load_dword s78, s[84:87], s28 offset:1792
s_buffer_load_dword s78, s[84:87], s28 offset:1920
mega_kernel_rf_x4:
v_mov_b32 v96, 0
v_mov_b32 v97, 0
v_mov_b32 v98, 0
v_mov_b32 v99, 0
v_mov_b32 v100, 0
v_mov_b32 v101, 0
v_mov_b32 v102, 0
v_mov_b32 v103, 0
v_mov_b32 v104, 0
v_mov_b32 v105, 0
v_mov_b32 v106, 0
v_mov_b32 v107, 0
v_mov_b32 v108, 0
v_mov_b32 v109, 0
v_mov_b32 v110, 0
v_mov_b32 v111, 0
v_mov_b32 v112, 0
v_mov_b32 v113, 0
v_mov_b32 v114, 0
v_mov_b32 v115, 0
v_mov_b32 v116, 0
v_mov_b32 v117, 0
v_mov_b32 v118, 0
v_mov_b32 v119, 0
s_branch mega_kernel_rf_b5
mega_kernel_rf_il2:
s_cbranch_execz mega_kernel_rf_il3
mega_kernel_rf_p2r:
s_mov_b64 exec, s[42:43]
buffer_load_dwordx4 v[188:191], v10, s[84:87], s76 offen sc1
buffer_load_dwordx4 v[196:199], v10, s[84:87], s77 offen sc1
buffer_load_dwordx4 v[204:207], v10, s[84:87], s78 offen sc1
s_mov_b64 exec, -1
buffer_load_dwordx4 v[184:187], v17, s[84:87], s76 offen sc1
buffer_load_dwordx4 v[192:195], v17, s[84:87], s77 offen sc1
buffer_load_dwordx4 v[200:203], v17, s[84:87], s78 offen sc1
s_branch mega_kernel_rf_p2
mega_kernel_rf_il3:
s_cbranch_execz mega_kernel_rf_il4
.p2align 5
mega_kernel_rf_pa_1_0f:
s_mov_b64 exec, vcc
buffer_load_dwordx4 v[32:35], v7, s[84:87], s33 offen offset:0 sc1
s_mov_b64 exec, -1
s_branch mega_kernel_rf_pa_1_0
.p2align 5
mega_kernel_rf_pa_1_0:
s_waitcnt vmcnt(0)
v_max_u32 v4, v32, v34
v_cmp_eq_u32 vcc, -1, v4
s_cbranch_vccnz mega_kernel_rf_pa_1_0f
v_smfmac_f32_16x16x64_bf16 v[96:99], v[32:35], a[0:7], v6
v_smfmac_f32_16x16x64_bf16 v[100:103], v[32:35], a[32:39], v6
v_smfmac_f32_16x16x64_bf16 v[104:107], v[32:35], a[64:71], v6
v_smfmac_f32_16x16x64_bf16 v[108:111], v[32:35], a[96:103], v6
s_branch mega_kernel_rf_pa_d
mega_kernel_rf_il4:
s_cbranch_execz mega_kernel_rf_il5
.p2align 5
mega_kernel_rf_pa_2_1f:
s_mov_b64 exec, vcc
buffer_load_dwordx4 v[36:39], v7, s[84:87], s33 offen offset:1024 sc1
s_mov_b64 exec, -1
s_branch mega_kernel_rf_pa_2_1
.p2align 5
mega_kernel_rf_pa_2_1:
s_waitcnt vmcnt(0)
v_max_u32 v4, v36, v38
v_cmp_eq_u32 vcc, -1, v4
s_cbranch_vccnz mega_kernel_rf_pa_2_1f
v_smfmac_f32_16x16x64_bf16 v[96:99], v[36:39], a[8:15], v6
v_smfmac_f32_16x16x64_bf16 v[100:103], v[36:39], a[40:47], v6
v_smfmac_f32_16x16x64_bf16 v[104:107], v[36:39], a[72:79], v6
v_smfmac_f32_16x16x64_bf16 v[108:111], v[36:39], a[104:111], v6
s_branch mega_kernel_rf_pa_d
mega_kernel_rf_il5:
s_cbranch_execz mega_kernel_rf_il6
.p2align 5
mega_kernel_rf_pa_3_0f:
s_mov_b64 exec, vcc
buffer_load_dwordx4 v[32:35], v7, s[84:87], s33 offen offset:0 sc1
s_mov_b64 exec, -1
s_branch mega_kernel_rf_pa_3_1
.p2align 5
mega_kernel_rf_pa_3_0:
s_waitcnt vmcnt(1)
v_max_u32 v4, v32, v34
v_cmp_eq_u32 vcc, -1, v4
s_cbranch_vccnz mega_kernel_rf_pa_3_0f
v_smfmac_f32_16x16x64_bf16 v[96:99], v[32:35], a[0:7], v6
v_smfmac_f32_16x16x64_bf16 v[100:103], v[32:35], a[32:39], v6
v_smfmac_f32_16x16x64_bf16 v[104:107], v[32:35], a[64:71], v6
v_smfmac_f32_16x16x64_bf16 v[108:111], v[32:35], a[96:103], v6
s_branch mega_kernel_rf_pa_2_1
mega_kernel_rf_il6:
s_cbranch_execz mega_kernel_rf_il7
.p2align 5
mega_kernel_rf_pa_3_1f:
s_mov_b64 exec, vcc
buffer_load_dwordx4 v[36:39], v7, s[84:87], s33 offen offset:1024 sc1
s_mov_b64 exec, -1
s_branch mega_kernel_rf_pa_3_0
.p2align 5
mega_kernel_rf_pa_3_1:
s_waitcnt vmcnt(1)
v_max_u32 v4, v36, v38
v_cmp_eq_u32 vcc, -1, v4
s_cbranch_vccnz mega_kernel_rf_pa_3_1f
v_smfmac_f32_16x16x64_bf16 v[96:99], v[36:39], a[8:15], v6
v_smfmac_f32_16x16x64_bf16 v[100:103], v[36:39], a[40:47], v6
v_smfmac_f32_16x16x64_bf16 v[104:107], v[36:39], a[72:79], v6
v_smfmac_f32_16x16x64_bf16 v[108:111], v[36:39], a[104:111], v6
s_branch mega_kernel_rf_pa_1_0
mega_kernel_rf_il7:
s_cbranch_execz mega_kernel_rf_il8
.p2align 5
mega_kernel_rf_pa_4_2f:
s_mov_b64 exec, vcc
buffer_load_dwordx4 v[40:43], v7, s[84:87], s33 offen offset:2048 sc1
s_mov_b64 exec, -1
s_branch mega_kernel_rf_pa_4_2
.p2align 5
mega_kernel_rf_pa_4_2:
s_waitcnt vmcnt(0)
v_max_u32 v4, v40, v42
v_cmp_eq_u32 vcc, -1, v4
s_cbranch_vccnz mega_kernel_rf_pa_4_2f
v_smfmac_f32_16x16x64_bf16 v[96:99], v[40:43], a[16:23], v6
v_smfmac_f32_16x16x64_bf16 v[100:103], v[40:43], a[48:55], v6
v_smfmac_f32_16x16x64_bf16 v[104:107], v[40:43], a[80:87], v6
v_smfmac_f32_16x16x64_bf16 v[108:111], v[40:43], a[112:119], v6
s_branch mega_kernel_rf_pa_d
mega_kernel_rf_il8:
s_cbranch_execz mega_kernel_rf_il9
.p2align 5
mega_kernel_rf_pa_5_0f:
s_mov_b64 exec, vcc
buffer_load_dwordx4 v[32:35], v7, s[84:87], s33 offen offset:0 sc1
s_mov_b64 exec, -1
s_branch mega_kernel_rf_pa_5_2
.p2align 5
mega_kernel_rf_pa_5_0:
s_waitcnt vmcnt(1)
v_max_u32 v4, v32, v34
v_cmp_eq_u32 vcc, -1, v4
s_cbranch_vccnz mega_kernel_rf_pa_5_0f
v_smfmac_f32_16x16x64_bf16 v[96:99], v[32:35], a[0:7], v6
v_smfmac_f32_16x16x64_bf16 v[100:103], v[32:35], a[32:39], v6
v_smfmac_f32_16x16x64_bf16 v[104:107], v[32:35], a[64:71], v6
v_smfmac_f32_16x16x64_bf16 v[108:111], v[32:35], a[96:103], v6
s_branch mega_kernel_rf_pa_4_2
mega_kernel_rf_il9:
s_cbranch_execz mega_kernel_rf_il10
.p2align 5
mega_kernel_rf_pa_5_2f:
s_mov_b64 exec, vcc
buffer_load_dwordx4 v[40:43], v7, s[84:87], s33 offen offset:2048 sc1
s_mov_b64 exec, -1
s_branch mega_kernel_rf_pa_5_0
.p2align 5
mega_kernel_rf_pa_5_2:
s_waitcnt vmcnt(1)
v_max_u32 v4, v40, v42
v_cmp_eq_u32 vcc, -1, v4
s_cbranch_vccnz mega_kernel_rf_pa_5_2f
v_smfmac_f32_16x16x64_bf16 v[96:99], v[40:43], a[16:23], v6
v_smfmac_f32_16x16x64_bf16 v[100:103], v[40:43], a[48:55], v6
v_smfmac_f32_16x16x64_bf16 v[104:107], v[40:43], a[80:87], v6
v_smfmac_f32_16x16x64_bf16 v[108:111], v[40:43], a[112:119], v6
s_branch mega_kernel_rf_pa_1_0
mega_kernel_rf_il10:
s_cbranch_execz mega_kernel_rf_il11
.p2align 5
mega_kernel_rf_pa_6_1f:
s_mov_b64 exec, vcc
buffer_load_dwordx4 v[36:39], v7, s[84:87], s33 offen offset:1024 sc1
s_mov_b64 exec, -1
s_branch mega_kernel_rf_pa_6_2
.p2align 5
mega_kernel_rf_pa_6_1:
s_waitcnt vmcnt(1)
v_max_u32 v4, v36, v38
v_cmp_eq_u32 vcc, -1, v4
s_cbranch_vccnz mega_kernel_rf_pa_6_1f
v_smfmac_f32_16x16x64_bf16 v[96:99], v[36:39], a[8:15], v6
v_smfmac_f32_16x16x64_bf16 v[100:103], v[36:39], a[40:47], v6
v_smfmac_f32_16x16x64_bf16 v[104:107], v[36:39], a[72:79], v6
v_smfmac_f32_16x16x64_bf16 v[108:111], v[36:39], a[104:111], v6
s_branch mega_kernel_rf_pa_4_2
mega_kernel_rf_il11:
s_cbranch_execz mega_kernel_rf_il12
.p2align 5
mega_kernel_rf_pa_6_2f:
s_mov_b64 exec, vcc
buffer_load_dwordx4 v[40:43], v7, s[84:87], s33 offen offset:2048 sc1
s_mov_b64 exec, -1
s_branch mega_kernel_rf_pa_6_1
.p2align 5
mega_kernel_rf_pa_6_2:
s_waitcnt vmcnt(1)
v_max_u32 v4, v40, v42
v_cmp_eq_u32 vcc, -1, v4
s_cbranch_vccnz mega_kernel_rf_pa_6_2f
v_smfmac_f32_16x16x64_bf16 v[96:99], v[40:43], a[16:23], v6
v_smfmac_f32_16x16x64_bf16 v[100:103], v[40:43], a[48:55], v6
v_smfmac_f32_16x16x64_bf16 v[104:107], v[40:43], a[80:87], v6
v_smfmac_f32_16x16x64_bf16 v[108:111], v[40:43], a[112:119], v6
s_branch mega_kernel_rf_pa_2_1
mega_kernel_rf_il12:
s_cbranch_execz mega_kernel_rf_il13
.p2align 5
mega_kernel_rf_pa_7_0f:
s_mov_b64 exec, vcc
buffer_load_dwordx4 v[32:35], v7, s[84:87], s33 offen offset:0 sc1
s_mov_b64 exec, -1
s_branch mega_kernel_rf_pa_7_1
.p2align 5
mega_kernel_rf_pa_7_0:
s_waitcnt vmcnt(2)
v_max_u32 v4, v32, v34
v_cmp_eq_u32 vcc, -1, v4
s_cbranch_vccnz mega_kernel_rf_pa_7_0f
v_smfmac_f32_16x16x64_bf16 v[96:99], v[32:35], a[0:7], v6
v_smfmac_f32_16x16x64_bf16 v[100:103], v[32:35], a[32:39], v6
v_smfmac_f32_16x16x64_bf16 v[104:107], v[32:35], a[64:71], v6
v_smfmac_f32_16x16x64_bf16 v[108:111], v[32:35], a[96:103], v6
s_branch mega_kernel_rf_pa_6_1
mega_kernel_rf_il13:
s_cbranch_execz mega_kernel_rf_il14
.p2align 5
mega_kernel_rf_pa_7_1f:
s_mov_b64 exec, vcc
buffer_load_dwordx4 v[36:39], v7, s[84:87], s33 offen offset:1024 sc1
s_mov_b64 exec, -1
s_branch mega_kernel_rf_pa_7_2
.p2align 5
mega_kernel_rf_pa_7_1:
s_waitcnt vmcnt(2)
v_max_u32 v4, v36, v38
v_cmp_eq_u32 vcc, -1, v4
s_cbranch_vccnz mega_kernel_rf_pa_7_1f
v_smfmac_f32_16x16x64_bf16 v[96:99], v[36:39], a[8:15], v6
v_smfmac_f32_16x16x64_bf16 v[100:103], v[36:39], a[40:47], v6
v_smfmac_f32_16x16x64_bf16 v[104:107], v[36:39], a[72:79], v6
v_smfmac_f32_16x16x64_bf16 v[108:111], v[36:39], a[104:111], v6
s_branch mega_kernel_rf_pa_5_2
mega_kernel_rf_il14:
s_cbranch_execz mega_kernel_rf_il15
.p2align 5
mega_kernel_rf_pa_7_2f:
s_mov_b64 exec, vcc
buffer_load_dwordx4 v[40:43], v7, s[84:87], s33 offen offset:2048 sc1
s_mov_b64 exec, -1
s_branch mega_kernel_rf_pa_7_0
.p2align 5
mega_kernel_rf_pa_7_2:
s_waitcnt vmcnt(2)
v_max_u32 v4, v40, v42
v_cmp_eq_u32 vcc, -1, v4
s_cbranch_vccnz mega_kernel_rf_pa_7_2f
v_smfmac_f32_16x16x64_bf16 v[96:99], v[40:43], a[16:23], v6
v_smfmac_f32_16x16x64_bf16 v[100:103], v[40:43], a[48:55], v6
v_smfmac_f32_16x16x64_bf16 v[104:107], v[40:43], a[80:87], v6
v_smfmac_f32_16x16x64_bf16 v[108:111], v[40:43], a[112:119], v6
s_branch mega_kernel_rf_pa_3_0
mega_kernel_rf_il15:
s_cbranch_execz mega_kernel_rf_il16
.p2align 5
mega_kernel_rf_pa_8_3f:
s_mov_b64 exec, vcc
buffer_load_dwordx4 v[44:47], v7, s[84:87], s33 offen offset:3072 sc1
s_mov_b64 exec, -1
s_branch mega_kernel_rf_pa_8_3
.p2align 5
mega_kernel_rf_pa_8_3:
s_waitcnt vmcnt(0)
v_max_u32 v4, v44, v46
v_cmp_eq_u32 vcc, -1, v4
s_cbranch_vccnz mega_kernel_rf_pa_8_3f
v_smfmac_f32_16x16x64_bf16 v[96:99], v[44:47], a[24:31], v6
v_smfmac_f32_16x16x64_bf16 v[100:103], v[44:47], a[56:63], v6
v_smfmac_f32_16x16x64_bf16 v[104:107], v[44:47], a[88:95], v6
v_smfmac_f32_16x16x64_bf16 v[108:111], v[44:47], a[120:127], v6
s_branch mega_kernel_rf_pa_d
mega_kernel_rf_il16:
s_cbranch_execz mega_kernel_rf_il17
.p2align 5
mega_kernel_rf_pa_9_0f:
s_mov_b64 exec, vcc
buffer_load_dwordx4 v[32:35], v7, s[84:87], s33 offen offset:0 sc1
s_mov_b64 exec, -1
s_branch mega_kernel_rf_pa_9_3
.p2align 5
mega_kernel_rf_pa_9_0:
s_waitcnt vmcnt(1)
v_max_u32 v4, v32, v34
v_cmp_eq_u32 vcc, -1, v4
s_cbranch_vccnz mega_kernel_rf_pa_9_0f
v_smfmac_f32_16x16x64_bf16 v[96:99], v[32:35], a[0:7], v6
v_smfmac_f32_16x16x64_bf16 v[100:103], v[32:35], a[32:39], v6
v_smfmac_f32_16x16x64_bf16 v[104:107], v[32:35], a[64:71], v6
v_smfmac_f32_16x16x64_bf16 v[108:111], v[32:35], a[96:103], v6
s_branch mega_kernel_rf_pa_8_3
mega_kernel_rf_il17:
s_cbranch_execz mega_kernel_rf_il18
.p2align 5
mega_kernel_rf_pa_9_3f:
s_mov_b64 exec, vcc
buffer_load_dwordx4 v[44:47], v7, s[84:87], s33 offen offset:3072 sc1
s_mov_b64 exec, -1
s_branch mega_kernel_rf_pa_9_0
.p2align 5
mega_kernel_rf_pa_9_3:
s_waitcnt vmcnt(1)
v_max_u32 v4, v44, v46
v_cmp_eq_u32 vcc, -1, v4
s_cbranch_vccnz mega_kernel_rf_pa_9_3f
v_smfmac_f32_16x16x64_bf16 v[96:99], v[44:47], a[24:31], v6
v_smfmac_f32_16x16x64_bf16 v[100:103], v[44:47], a[56:63], v6
v_smfmac_f32_16x16x64_bf16 v[104:107], v[44:47], a[88:95], v6
v_smfmac_f32_16x16x64_bf16 v[108:111], v[44:47], a[120:127], v6
s_branch mega_kernel_rf_pa_1_0
mega_kernel_rf_il18:
s_cbranch_execz mega_kernel_rf_iwd
.p2align 5
mega_kernel_rf_pa_10_1f:
s_mov_b64 exec, vcc
buffer_load_dwordx4 v[36:39], v7, s[84:87], s33 offen offset:1024 sc1
s_mov_b64 exec, -1
s_branch mega_kernel_rf_pa_10_3
.p2align 5
mega_kernel_rf_pa_10_1:
s_waitcnt vmcnt(1)
v_max_u32 v4, v36, v38
v_cmp_eq_u32 vcc, -1, v4
s_cbranch_vccnz mega_kernel_rf_pa_10_1f
v_smfmac_f32_16x16x64_bf16 v[96:99], v[36:39], a[8:15], v6
v_smfmac_f32_16x16x64_bf16 v[100:103], v[36:39], a[40:47], v6
v_smfmac_f32_16x16x64_bf16 v[104:107], v[36:39], a[72:79], v6
v_smfmac_f32_16x16x64_bf16 v[108:111], v[36:39], a[104:111], v6
s_branch mega_kernel_rf_pa_8_3
mega_kernel_rf_iw1:
mega_kernel_rf_il19:
s_cbranch_execz mega_kernel_rf_il20
.p2align 5
mega_kernel_rf_pa_10_3f:
s_mov_b64 exec, vcc
buffer_load_dwordx4 v[44:47], v7, s[84:87], s33 offen offset:3072 sc1
s_mov_b64 exec, -1
s_branch mega_kernel_rf_pa_10_1
.p2align 5
mega_kernel_rf_pa_10_3:
s_waitcnt vmcnt(1)
v_max_u32 v4, v44, v46
v_cmp_eq_u32 vcc, -1, v4
s_cbranch_vccnz mega_kernel_rf_pa_10_3f
v_smfmac_f32_16x16x64_bf16 v[96:99], v[44:47], a[24:31], v6
v_smfmac_f32_16x16x64_bf16 v[100:103], v[44:47], a[56:63], v6
v_smfmac_f32_16x16x64_bf16 v[104:107], v[44:47], a[88:95], v6
v_smfmac_f32_16x16x64_bf16 v[108:111], v[44:47], a[120:127], v6
s_branch mega_kernel_rf_pa_2_1
mega_kernel_rf_il20:
s_cbranch_execz mega_kernel_rf_il21
.p2align 5
mega_kernel_rf_pa_11_0f:
s_mov_b64 exec, vcc
buffer_load_dwordx4 v[32:35], v7, s[84:87], s33 offen offset:0 sc1
s_mov_b64 exec, -1
s_branch mega_kernel_rf_pa_11_1
.p2align 5
mega_kernel_rf_pa_11_0:
s_waitcnt vmcnt(2)
v_max_u32 v4, v32, v34
v_cmp_eq_u32 vcc, -1, v4
s_cbranch_vccnz mega_kernel_rf_pa_11_0f
v_smfmac_f32_16x16x64_bf16 v[96:99], v[32:35], a[0:7], v6
v_smfmac_f32_16x16x64_bf16 v[100:103], v[32:35], a[32:39], v6
v_smfmac_f32_16x16x64_bf16 v[104:107], v[32:35], a[64:71], v6
v_smfmac_f32_16x16x64_bf16 v[108:111], v[32:35], a[96:103], v6
s_branch mega_kernel_rf_pa_10_1
mega_kernel_rf_il21:
s_cbranch_execz mega_kernel_rf_il22
.p2align 5
mega_kernel_rf_pa_11_1f:
s_mov_b64 exec, vcc
buffer_load_dwordx4 v[36:39], v7, s[84:87], s33 offen offset:1024 sc1
s_mov_b64 exec, -1
s_branch mega_kernel_rf_pa_11_3
.p2align 5
mega_kernel_rf_pa_11_1:
s_waitcnt vmcnt(2)
v_max_u32 v4, v36, v38
v_cmp_eq_u32 vcc, -1, v4
s_cbranch_vccnz mega_kernel_rf_pa_11_1f
v_smfmac_f32_16x16x64_bf16 v[96:99], v[36:39], a[8:15], v6
v_smfmac_f32_16x16x64_bf16 v[100:103], v[36:39], a[40:47], v6
v_smfmac_f32_16x16x64_bf16 v[104:107], v[36:39], a[72:79], v6
v_smfmac_f32_16x16x64_bf16 v[108:111], v[36:39], a[104:111], v6
s_branch mega_kernel_rf_pa_9_3
mega_kernel_rf_il22:
s_cbranch_execz mega_kernel_rf_il23
.p2align 5
mega_kernel_rf_pa_11_3f:
s_mov_b64 exec, vcc
buffer_load_dwordx4 v[44:47], v7, s[84:87], s33 offen offset:3072 sc1
s_mov_b64 exec, -1
s_branch mega_kernel_rf_pa_11_0
.p2align 5
mega_kernel_rf_pa_11_3:
s_waitcnt vmcnt(2)
v_max_u32 v4, v44, v46
v_cmp_eq_u32 vcc, -1, v4
s_cbranch_vccnz mega_kernel_rf_pa_11_3f
v_smfmac_f32_16x16x64_bf16 v[96:99], v[44:47], a[24:31], v6
v_smfmac_f32_16x16x64_bf16 v[100:103], v[44:47], a[56:63], v6
v_smfmac_f32_16x16x64_bf16 v[104:107], v[44:47], a[88:95], v6
v_smfmac_f32_16x16x64_bf16 v[108:111], v[44:47], a[120:127], v6
s_branch mega_kernel_rf_pa_3_0
mega_kernel_rf_il23:
s_cbranch_execz mega_kernel_rf_il24
.p2align 5
mega_kernel_rf_pa_12_2f:
s_mov_b64 exec, vcc
buffer_load_dwordx4 v[40:43], v7, s[84:87], s33 offen offset:2048 sc1
s_mov_b64 exec, -1
s_branch mega_kernel_rf_pa_12_3
.p2align 5
mega_kernel_rf_pa_12_2:
s_waitcnt vmcnt(1)
v_max_u32 v4, v40, v42
v_cmp_eq_u32 vcc, -1, v4
s_cbranch_vccnz mega_kernel_rf_pa_12_2f
v_smfmac_f32_16x16x64_bf16 v[96:99], v[40:43], a[16:23], v6
v_smfmac_f32_16x16x64_bf16 v[100:103], v[40:43], a[48:55], v6
v_smfmac_f32_16x16x64_bf16 v[104:107], v[40:43], a[80:87], v6
v_smfmac_f32_16x16x64_bf16 v[108:111], v[40:43], a[112:119], v6
s_branch mega_kernel_rf_pa_8_3
mega_kernel_rf_il24:
s_cbranch_execz mega_kernel_rf_il25
.p2align 5
mega_kernel_rf_pa_12_3f:
s_mov_b64 exec, vcc
buffer_load_dwordx4 v[44:47], v7, s[84:87], s33 offen offset:3072 sc1
s_mov_b64 exec, -1
s_branch mega_kernel_rf_pa_12_2
.p2align 5
mega_kernel_rf_pa_12_3:
s_waitcnt vmcnt(1)
v_max_u32 v4, v44, v46
v_cmp_eq_u32 vcc, -1, v4
s_cbranch_vccnz mega_kernel_rf_pa_12_3f
v_smfmac_f32_16x16x64_bf16 v[96:99], v[44:47], a[24:31], v6
v_smfmac_f32_16x16x64_bf16 v[100:103], v[44:47], a[56:63], v6
v_smfmac_f32_16x16x64_bf16 v[104:107], v[44:47], a[88:95], v6
v_smfmac_f32_16x16x64_bf16 v[108:111], v[44:47], a[120:127], v6
s_branch mega_kernel_rf_pa_4_2
mega_kernel_rf_il25:
s_cbranch_execz mega_kernel_rf_il26
.p2align 5
mega_kernel_rf_pa_13_0f:
s_mov_b64 exec, vcc
buffer_load_dwordx4 v[32:35], v7, s[84:87], s33 offen offset:0 sc1
s_mov_b64 exec, -1
s_branch mega_kernel_rf_pa_13_2
.p2align 5
mega_kernel_rf_pa_13_0:
s_waitcnt vmcnt(2)
v_max_u32 v4, v32, v34
v_cmp_eq_u32 vcc, -1, v4
s_cbranch_vccnz mega_kernel_rf_pa_13_0f
v_smfmac_f32_16x16x64_bf16 v[96:99], v[32:35], a[0:7], v6
v_smfmac_f32_16x16x64_bf16 v[100:103], v[32:35], a[32:39], v6
v_smfmac_f32_16x16x64_bf16 v[104:107], v[32:35], a[64:71], v6
v_smfmac_f32_16x16x64_bf16 v[108:111], v[32:35], a[96:103], v6
s_branch mega_kernel_rf_pa_12_2
mega_kernel_rf_il26:
s_cbranch_execz mega_kernel_rf_il27
.p2align 5
mega_kernel_rf_pa_13_2f:
s_mov_b64 exec, vcc
buffer_load_dwordx4 v[40:43], v7, s[84:87], s33 offen offset:2048 sc1
s_mov_b64 exec, -1
s_branch mega_kernel_rf_pa_13_3
.p2align 5
mega_kernel_rf_pa_13_2:
s_waitcnt vmcnt(2)
v_max_u32 v4, v40, v42
v_cmp_eq_u32 vcc, -1, v4
s_cbranch_vccnz mega_kernel_rf_pa_13_2f
v_smfmac_f32_16x16x64_bf16 v[96:99], v[40:43], a[16:23], v6
v_smfmac_f32_16x16x64_bf16 v[100:103], v[40:43], a[48:55], v6
v_smfmac_f32_16x16x64_bf16 v[104:107], v[40:43], a[80:87], v6
v_smfmac_f32_16x16x64_bf16 v[108:111], v[40:43], a[112:119], v6
s_branch mega_kernel_rf_pa_9_3
mega_kernel_rf_il27:
s_cbranch_execz mega_kernel_rf_il28
.p2align 5
mega_kernel_rf_pa_13_3f:
s_mov_b64 exec, vcc
buffer_load_dwordx4 v[44:47], v7, s[84:87], s33 offen offset:3072 sc1
s_mov_b64 exec, -1
s_branch mega_kernel_rf_pa_13_0
.p2align 5
mega_kernel_rf_pa_13_3:
s_waitcnt vmcnt(2)
v_max_u32 v4, v44, v46
v_cmp_eq_u32 vcc, -1, v4
s_cbranch_vccnz mega_kernel_rf_pa_13_3f
v_smfmac_f32_16x16x64_bf16 v[96:99], v[44:47], a[24:31], v6
v_smfmac_f32_16x16x64_bf16 v[100:103], v[44:47], a[56:63], v6
v_smfmac_f32_16x16x64_bf16 v[104:107], v[44:47], a[88:95], v6
v_smfmac_f32_16x16x64_bf16 v[108:111], v[44:47], a[120:127], v6
s_branch mega_kernel_rf_pa_5_0
mega_kernel_rf_il28:
s_cbranch_execz mega_kernel_rf_il29
.p2align 5
mega_kernel_rf_pa_14_1f:
s_mov_b64 exec, vcc
buffer_load_dwordx4 v[36:39], v7, s[84:87], s33 offen offset:1024 sc1
s_mov_b64 exec, -1
s_branch mega_kernel_rf_pa_14_2
.p2align 5
mega_kernel_rf_pa_14_1:
s_waitcnt vmcnt(2)
v_max_u32 v4, v36, v38
v_cmp_eq_u32 vcc, -1, v4
s_cbranch_vccnz mega_kernel_rf_pa_14_1f
v_smfmac_f32_16x16x64_bf16 v[96:99], v[36:39], a[8:15], v6
v_smfmac_f32_16x16x64_bf16 v[100:103], v[36:39], a[40:47], v6
v_smfmac_f32_16x16x64_bf16 v[104:107], v[36:39], a[72:79], v6
v_smfmac_f32_16x16x64_bf16 v[108:111], v[36:39], a[104:111], v6
s_branch mega_kernel_rf_pa_12_2
mega_kernel_rf_il29:
s_cbranch_execz mega_kernel_rf_il30
.p2align 5
mega_kernel_rf_pa_14_2f:
s_mov_b64 exec, vcc
buffer_load_dwordx4 v[40:43], v7, s[84:87], s33 offen offset:2048 sc1
s_mov_b64 exec, -1
s_branch mega_kernel_rf_pa_14_3
.p2align 5
mega_kernel_rf_pa_14_2:
s_waitcnt vmcnt(2)
v_max_u32 v4, v40, v42
v_cmp_eq_u32 vcc, -1, v4
s_cbranch_vccnz mega_kernel_rf_pa_14_2f
v_smfmac_f32_16x16x64_bf16 v[96:99], v[40:43], a[16:23], v6
v_smfmac_f32_16x16x64_bf16 v[100:103], v[40:43], a[48:55], v6
v_smfmac_f32_16x16x64_bf16 v[104:107], v[40:43], a[80:87], v6
v_smfmac_f32_16x16x64_bf16 v[108:111], v[40:43], a[112:119], v6
s_branch mega_kernel_rf_pa_10_3
mega_kernel_rf_il30:
s_cbranch_execz mega_kernel_rf_il31
.p2align 5
mega_kernel_rf_pa_14_3f:
s_mov_b64 exec, vcc
buffer_load_dwordx4 v[44:47], v7, s[84:87], s33 offen offset:3072 sc1
s_mov_b64 exec, -1
s_branch mega_kernel_rf_pa_14_1
.p2align 5
mega_kernel_rf_pa_14_3:
s_waitcnt vmcnt(2)
v_max_u32 v4, v44, v46
v_cmp_eq_u32 vcc, -1, v4
s_cbranch_vccnz mega_kernel_rf_pa_14_3f
v_smfmac_f32_16x16x64_bf16 v[96:99], v[44:47], a[24:31], v6
v_smfmac_f32_16x16x64_bf16 v[100:103], v[44:47], a[56:63], v6
v_smfmac_f32_16x16x64_bf16 v[104:107], v[44:47], a[88:95], v6
v_smfmac_f32_16x16x64_bf16 v[108:111], v[44:47], a[120:127], v6
s_branch mega_kernel_rf_pa_6_1
mega_kernel_rf_il31:
s_cbranch_execz mega_kernel_rf_il32
.p2align 5
mega_kernel_rf_pa_15_0f:
s_mov_b64 exec, vcc
buffer_load_dwordx4 v[32:35], v7, s[84:87], s33 offen offset:0 sc1
s_mov_b64 exec, -1
s_branch mega_kernel_rf_pa_15_1
.p2align 5
mega_kernel_rf_pa_15_0:
s_waitcnt vmcnt(3)
v_max_u32 v4, v32, v34
v_cmp_eq_u32 vcc, -1, v4
s_cbranch_vccnz mega_kernel_rf_pa_15_0f
v_smfmac_f32_16x16x64_bf16 v[96:99], v[32:35], a[0:7], v6
v_smfmac_f32_16x16x64_bf16 v[100:103], v[32:35], a[32:39], v6
v_smfmac_f32_16x16x64_bf16 v[104:107], v[32:35], a[64:71], v6
v_smfmac_f32_16x16x64_bf16 v[108:111], v[32:35], a[96:103], v6
s_branch mega_kernel_rf_pa_14_1
mega_kernel_rf_il32:
s_cbranch_execz mega_kernel_rf_il33
.p2align 5
mega_kernel_rf_pa_15_1f:
s_mov_b64 exec, vcc
buffer_load_dwordx4 v[36:39], v7, s[84:87], s33 offen offset:1024 sc1
s_mov_b64 exec, -1
s_branch mega_kernel_rf_pa_15_2
.p2align 5
mega_kernel_rf_pa_15_1:
s_waitcnt vmcnt(3)
v_max_u32 v4, v36, v38
v_cmp_eq_u32 vcc, -1, v4
s_cbranch_vccnz mega_kernel_rf_pa_15_1f
v_smfmac_f32_16x16x64_bf16 v[96:99], v[36:39], a[8:15], v6
v_smfmac_f32_16x16x64_bf16 v[100:103], v[36:39], a[40:47], v6
v_smfmac_f32_16x16x64_bf16 v[104:107], v[36:39], a[72:79], v6
v_smfmac_f32_16x16x64_bf16 v[108:111], v[36:39], a[104:111], v6
s_branch mega_kernel_rf_pa_13_2
mega_kernel_rf_il33:
s_cbranch_execz mega_kernel_rf_il34
.p2align 5
mega_kernel_rf_pa_15_2f:
s_mov_b64 exec, vcc
buffer_load_dwordx4 v[40:43], v7, s[84:87], s33 offen offset:2048 sc1
s_mov_b64 exec, -1
s_branch mega_kernel_rf_pa_15_3
.p2align 5
mega_kernel_rf_pa_15_2:
s_waitcnt vmcnt(3)
v_max_u32 v4, v40, v42
v_cmp_eq_u32 vcc, -1, v4
s_cbranch_vccnz mega_kernel_rf_pa_15_2f
v_smfmac_f32_16x16x64_bf16 v[96:99], v[40:43], a[16:23], v6
v_smfmac_f32_16x16x64_bf16 v[100:103], v[40:43], a[48:55], v6
v_smfmac_f32_16x16x64_bf16 v[104:107], v[40:43], a[80:87], v6
v_smfmac_f32_16x16x64_bf16 v[108:111], v[40:43], a[112:119], v6
s_branch mega_kernel_rf_pa_11_3
mega_kernel_rf_il34:
s_cbranch_execz mega_kernel_rf_il35
.p2align 5
mega_kernel_rf_pa_15_3f:
s_mov_b64 exec, vcc
buffer_load_dwordx4 v[44:47], v7, s[84:87], s33 offen offset:3072 sc1
s_mov_b64 exec, -1
s_branch mega_kernel_rf_pa_15_0
.p2align 5
mega_kernel_rf_pa_15_3:
s_waitcnt vmcnt(3)
v_max_u32 v4, v44, v46
v_cmp_eq_u32 vcc, -1, v4
s_cbranch_vccnz mega_kernel_rf_pa_15_3f
v_smfmac_f32_16x16x64_bf16 v[96:99], v[44:47], a[24:31], v6
v_smfmac_f32_16x16x64_bf16 v[100:103], v[44:47], a[56:63], v6
v_smfmac_f32_16x16x64_bf16 v[104:107], v[44:47], a[88:95], v6
v_smfmac_f32_16x16x64_bf16 v[108:111], v[44:47], a[120:127], v6
s_branch mega_kernel_rf_pa_7_0
mega_kernel_rf_il35:
s_cbranch_execz mega_kernel_rf_il36
.p2align 5
mega_kernel_rf_pc_1_0f:
s_mov_b64 exec, vcc
buffer_load_dwordx4 v[32:35], v7, s[84:87], s29 offen offset:0 sc1
s_mov_b64 exec, -1
s_branch mega_kernel_rf_pc_1_0
.p2align 5
mega_kernel_rf_pc_1_0:
s_waitcnt vmcnt(0)
v_cmp_eq_u32 vcc, -1, v32
s_cbranch_vccnz mega_kernel_rf_pc_1_0f
v_smfmac_f32_16x16x64_bf16 v[96:99], v[32:35], a[192:199], v6
v_smfmac_f32_16x16x64_bf16 v[100:103], v[32:35], a[224:231], v6
s_branch mega_kernel_rf_pc_d
mega_kernel_rf_il36:
s_cbranch_execz mega_kernel_rf_il37
.p2align 5
mega_kernel_rf_pc_2_1f:
s_mov_b64 exec, vcc
buffer_load_dwordx4 v[36:39], v7, s[84:87], s29 offen offset:1024 sc1
s_mov_b64 exec, -1
s_branch mega_kernel_rf_pc_2_1
mega_kernel_rf_il37:
s_cbranch_execz mega_kernel_rf_iwd
.p2align 5
mega_kernel_rf_pc_2_1:
s_waitcnt vmcnt(0)
v_cmp_eq_u32 vcc, -1, v36
s_cbranch_vccnz mega_kernel_rf_pc_2_1f
v_smfmac_f32_16x16x64_bf16 v[96:99], v[36:39], a[200:207], v6
v_smfmac_f32_16x16x64_bf16 v[100:103], v[36:39], a[232:239], v6
s_branch mega_kernel_rf_pc_d
.p2align 5
mega_kernel_rf_pc_3_0f:
s_mov_b64 exec, vcc
buffer_load_dwordx4 v[32:35], v7, s[84:87], s29 offen offset:0 sc1
s_mov_b64 exec, -1
s_branch mega_kernel_rf_pc_3_1
mega_kernel_rf_iw2:
mega_kernel_rf_il38:
s_cbranch_execz mega_kernel_rf_il39
.p2align 5
mega_kernel_rf_pc_3_0:
s_waitcnt vmcnt(1)
v_cmp_eq_u32 vcc, -1, v32
s_cbranch_vccnz mega_kernel_rf_pc_3_0f
v_smfmac_f32_16x16x64_bf16 v[96:99], v[32:35], a[192:199], v6
v_smfmac_f32_16x16x64_bf16 v[100:103], v[32:35], a[224:231], v6
s_branch mega_kernel_rf_pc_2_1
.p2align 5
mega_kernel_rf_pc_3_1f:
s_mov_b64 exec, vcc
buffer_load_dwordx4 v[36:39], v7, s[84:87], s29 offen offset:1024 sc1
s_mov_b64 exec, -1
s_branch mega_kernel_rf_pc_3_0
mega_kernel_rf_il39:
s_cbranch_execz mega_kernel_rf_il40
.p2align 5
mega_kernel_rf_pc_3_1:
s_waitcnt vmcnt(1)
v_cmp_eq_u32 vcc, -1, v36
s_cbranch_vccnz mega_kernel_rf_pc_3_1f
v_smfmac_f32_16x16x64_bf16 v[96:99], v[36:39], a[200:207], v6
v_smfmac_f32_16x16x64_bf16 v[100:103], v[36:39], a[232:239], v6
s_branch mega_kernel_rf_pc_1_0
.p2align 5
mega_kernel_rf_pc_4_2f:
s_mov_b64 exec, vcc
buffer_load_dwordx4 v[40:43], v7, s[84:87], s29 offen offset:2048 sc1
s_mov_b64 exec, -1
s_branch mega_kernel_rf_pc_4_2
mega_kernel_rf_il40:
s_cbranch_execz mega_kernel_rf_il41
.p2align 5
mega_kernel_rf_pc_4_2:
s_waitcnt vmcnt(0)
v_cmp_eq_u32 vcc, -1, v40
s_cbranch_vccnz mega_kernel_rf_pc_4_2f
v_smfmac_f32_16x16x64_bf16 v[96:99], v[40:43], a[208:215], v6
v_smfmac_f32_16x16x64_bf16 v[100:103], v[40:43], a[240:247], v6
s_branch mega_kernel_rf_pc_d
.p2align 5
mega_kernel_rf_pc_5_0f:
s_mov_b64 exec, vcc
buffer_load_dwordx4 v[32:35], v7, s[84:87], s29 offen offset:0 sc1
s_mov_b64 exec, -1
s_branch mega_kernel_rf_pc_5_2
mega_kernel_rf_il41:
s_cbranch_execz mega_kernel_rf_il42
.p2align 5
mega_kernel_rf_pc_5_0:
s_waitcnt vmcnt(1)
v_cmp_eq_u32 vcc, -1, v32
s_cbranch_vccnz mega_kernel_rf_pc_5_0f
v_smfmac_f32_16x16x64_bf16 v[96:99], v[32:35], a[192:199], v6
v_smfmac_f32_16x16x64_bf16 v[100:103], v[32:35], a[224:231], v6
s_branch mega_kernel_rf_pc_4_2
.p2align 5
mega_kernel_rf_pc_5_2f:
s_mov_b64 exec, vcc
buffer_load_dwordx4 v[40:43], v7, s[84:87], s29 offen offset:2048 sc1
s_mov_b64 exec, -1
s_branch mega_kernel_rf_pc_5_0
mega_kernel_rf_il42:
s_cbranch_execz mega_kernel_rf_il43
.p2align 5
mega_kernel_rf_pc_5_2:
s_waitcnt vmcnt(1)
v_cmp_eq_u32 vcc, -1, v40
s_cbranch_vccnz mega_kernel_rf_pc_5_2f
v_smfmac_f32_16x16x64_bf16 v[96:99], v[40:43], a[208:215], v6
v_smfmac_f32_16x16x64_bf16 v[100:103], v[40:43], a[240:247], v6
s_branch mega_kernel_rf_pc_1_0
.p2align 5
mega_kernel_rf_pc_6_1f:
s_mov_b64 exec, vcc
buffer_load_dwordx4 v[36:39], v7, s[84:87], s29 offen offset:1024 sc1
s_mov_b64 exec, -1
s_branch mega_kernel_rf_pc_6_2
mega_kernel_rf_il43:
s_cbranch_execz mega_kernel_rf_il44
.p2align 5
mega_kernel_rf_pc_6_1:
s_waitcnt vmcnt(1)
v_cmp_eq_u32 vcc, -1, v36
s_cbranch_vccnz mega_kernel_rf_pc_6_1f
v_smfmac_f32_16x16x64_bf16 v[96:99], v[36:39], a[200:207], v6
v_smfmac_f32_16x16x64_bf16 v[100:103], v[36:39], a[232:239], v6
s_branch mega_kernel_rf_pc_4_2
.p2align 5
mega_kernel_rf_pc_6_2f:
s_mov_b64 exec, vcc
buffer_load_dwordx4 v[40:43], v7, s[84:87], s29 offen offset:2048 sc1
s_mov_b64 exec, -1
s_branch mega_kernel_rf_pc_6_1
mega_kernel_rf_il44:
s_cbranch_execz mega_kernel_rf_il45
.p2align 5
mega_kernel_rf_pc_6_2:
s_waitcnt vmcnt(1)
v_cmp_eq_u32 vcc, -1, v40
s_cbranch_vccnz mega_kernel_rf_pc_6_2f
v_smfmac_f32_16x16x64_bf16 v[96:99], v[40:43], a[208:215], v6
v_smfmac_f32_16x16x64_bf16 v[100:103], v[40:43], a[240:247], v6
s_branch mega_kernel_rf_pc_2_1
.p2align 5
mega_kernel_rf_pc_7_0f:
s_mov_b64 exec, vcc
buffer_load_dwordx4 v[32:35], v7, s[84:87], s29 offen offset:0 sc1
s_mov_b64 exec, -1
s_branch mega_kernel_rf_pc_7_1
mega_kernel_rf_il45:
s_cbranch_execz mega_kernel_rf_il46
.p2align 5
mega_kernel_rf_pc_7_0:
s_waitcnt vmcnt(2)
v_cmp_eq_u32 vcc, -1, v32
s_cbranch_vccnz mega_kernel_rf_pc_7_0f
v_smfmac_f32_16x16x64_bf16 v[96:99], v[32:35], a[192:199], v6
v_smfmac_f32_16x16x64_bf16 v[100:103], v[32:35], a[224:231], v6
s_branch mega_kernel_rf_pc_6_1
.p2align 5
mega_kernel_rf_pc_7_1f:
s_mov_b64 exec, vcc
buffer_load_dwordx4 v[36:39], v7, s[84:87], s29 offen offset:1024 sc1
s_mov_b64 exec, -1
s_branch mega_kernel_rf_pc_7_2
mega_kernel_rf_il46:
s_cbranch_execz mega_kernel_rf_il47
.p2align 5
mega_kernel_rf_pc_7_1:
s_waitcnt vmcnt(2)
v_cmp_eq_u32 vcc, -1, v36
s_cbranch_vccnz mega_kernel_rf_pc_7_1f
v_smfmac_f32_16x16x64_bf16 v[96:99], v[36:39], a[200:207], v6
v_smfmac_f32_16x16x64_bf16 v[100:103], v[36:39], a[232:239], v6
s_branch mega_kernel_rf_pc_5_2
.p2align 5
mega_kernel_rf_pc_7_2f:
s_mov_b64 exec, vcc
buffer_load_dwordx4 v[40:43], v7, s[84:87], s29 offen offset:2048 sc1
s_mov_b64 exec, -1
s_branch mega_kernel_rf_pc_7_0
mega_kernel_rf_il47:
s_cbranch_execz mega_kernel_rf_il48
.p2align 5
mega_kernel_rf_pc_7_2:
s_waitcnt vmcnt(2)
v_cmp_eq_u32 vcc, -1, v40
s_cbranch_vccnz mega_kernel_rf_pc_7_2f
v_smfmac_f32_16x16x64_bf16 v[96:99], v[40:43], a[208:215], v6
v_smfmac_f32_16x16x64_bf16 v[100:103], v[40:43], a[240:247], v6
s_branch mega_kernel_rf_pc_3_0
.p2align 5
mega_kernel_rf_pc_8_3f:
s_mov_b64 exec, vcc
buffer_load_dwordx4 v[44:47], v7, s[84:87], s29 offen offset:3072 sc1
s_mov_b64 exec, -1
s_branch mega_kernel_rf_pc_8_3
mega_kernel_rf_il48:
s_cbranch_execz mega_kernel_rf_il49
.p2align 5
mega_kernel_rf_pc_9_0f:
s_mov_b64 exec, vcc
buffer_load_dwordx4 v[32:35], v7, s[84:87], s29 offen offset:0 sc1
s_mov_b64 exec, -1
s_branch mega_kernel_rf_pc_9_3
.p2align 5
mega_kernel_rf_pc_9_0:
s_waitcnt vmcnt(1)
v_cmp_eq_u32 vcc, -1, v32
s_cbranch_vccnz mega_kernel_rf_pc_9_0f
v_smfmac_f32_16x16x64_bf16 v[96:99], v[32:35], a[192:199], v6
v_smfmac_f32_16x16x64_bf16 v[100:103], v[32:35], a[224:231], v6
s_branch mega_kernel_rf_pc_8_3
mega_kernel_rf_il49:
s_cbranch_execz mega_kernel_rf_il50
.p2align 5
mega_kernel_rf_pc_9_3f:
s_mov_b64 exec, vcc
buffer_load_dwordx4 v[44:47], v7, s[84:87], s29 offen offset:3072 sc1
s_mov_b64 exec, -1
s_branch mega_kernel_rf_pc_9_0
mega_kernel_rf_il50:
s_cbranch_execz mega_kernel_rf_il51
.p2align 5
mega_kernel_rf_pc_9_3:
s_waitcnt vmcnt(1)
v_cmp_eq_u32 vcc, -1, v44
s_cbranch_vccnz mega_kernel_rf_pc_9_3f
v_smfmac_f32_16x16x64_bf16 v[96:99], v[44:47], a[216:223], v6
v_smfmac_f32_16x16x64_bf16 v[100:103], v[44:47], a[248:255], v6
s_branch mega_kernel_rf_pc_1_0
.p2align 5
mega_kernel_rf_pc_10_1f:
s_mov_b64 exec, vcc
buffer_load_dwordx4 v[36:39], v7, s[84:87], s29 offen offset:1024 sc1
s_mov_b64 exec, -1
s_branch mega_kernel_rf_pc_10_3
mega_kernel_rf_il51:
s_cbranch_execz mega_kernel_rf_il52
.p2align 5
mega_kernel_rf_pc_10_1:
s_waitcnt vmcnt(1)
v_cmp_eq_u32 vcc, -1, v36
s_cbranch_vccnz mega_kernel_rf_pc_10_1f
v_smfmac_f32_16x16x64_bf16 v[96:99], v[36:39], a[200:207], v6
v_smfmac_f32_16x16x64_bf16 v[100:103], v[36:39], a[232:239], v6
s_branch mega_kernel_rf_pc_8_3
.p2align 5
mega_kernel_rf_pc_10_3f:
s_mov_b64 exec, vcc
buffer_load_dwordx4 v[44:47], v7, s[84:87], s29 offen offset:3072 sc1
s_mov_b64 exec, -1
s_branch mega_kernel_rf_pc_10_1
mega_kernel_rf_il52:
s_cbranch_execz mega_kernel_rf_il53
.p2align 5
mega_kernel_rf_pc_10_3:
s_waitcnt vmcnt(1)
v_cmp_eq_u32 vcc, -1, v44
s_cbranch_vccnz mega_kernel_rf_pc_10_3f
v_smfmac_f32_16x16x64_bf16 v[96:99], v[44:47], a[216:223], v6
v_smfmac_f32_16x16x64_bf16 v[100:103], v[44:47], a[248:255], v6
s_branch mega_kernel_rf_pc_2_1
.p2align 5
mega_kernel_rf_pc_11_0f:
s_mov_b64 exec, vcc
buffer_load_dwordx4 v[32:35], v7, s[84:87], s29 offen offset:0 sc1
s_mov_b64 exec, -1
s_branch mega_kernel_rf_pc_11_1
mega_kernel_rf_il53:
s_cbranch_execz mega_kernel_rf_il54
.p2align 5
mega_kernel_rf_pc_11_0:
s_waitcnt vmcnt(2)
v_cmp_eq_u32 vcc, -1, v32
s_cbranch_vccnz mega_kernel_rf_pc_11_0f
v_smfmac_f32_16x16x64_bf16 v[96:99], v[32:35], a[192:199], v6
v_smfmac_f32_16x16x64_bf16 v[100:103], v[32:35], a[224:231], v6
s_branch mega_kernel_rf_pc_10_1
.p2align 5
mega_kernel_rf_pc_11_1f:
s_mov_b64 exec, vcc
buffer_load_dwordx4 v[36:39], v7, s[84:87], s29 offen offset:1024 sc1
s_mov_b64 exec, -1
s_branch mega_kernel_rf_pc_11_3
mega_kernel_rf_il54:
s_cbranch_execz mega_kernel_rf_il55
.p2align 5
mega_kernel_rf_pc_11_1:
s_waitcnt vmcnt(2)
v_cmp_eq_u32 vcc, -1, v36
s_cbranch_vccnz mega_kernel_rf_pc_11_1f
v_smfmac_f32_16x16x64_bf16 v[96:99], v[36:39], a[200:207], v6
v_smfmac_f32_16x16x64_bf16 v[100:103], v[36:39], a[232:239], v6
s_branch mega_kernel_rf_pc_9_3
.p2align 5
mega_kernel_rf_pc_11_3f:
s_mov_b64 exec, vcc
buffer_load_dwordx4 v[44:47], v7, s[84:87], s29 offen offset:3072 sc1
s_mov_b64 exec, -1
s_branch mega_kernel_rf_pc_11_0
mega_kernel_rf_il55:
s_cbranch_execz mega_kernel_rf_il56
.p2align 5
mega_kernel_rf_pc_11_3:
s_waitcnt vmcnt(2)
v_cmp_eq_u32 vcc, -1, v44
s_cbranch_vccnz mega_kernel_rf_pc_11_3f
v_smfmac_f32_16x16x64_bf16 v[96:99], v[44:47], a[216:223], v6
v_smfmac_f32_16x16x64_bf16 v[100:103], v[44:47], a[248:255], v6
s_branch mega_kernel_rf_pc_3_0
.p2align 5
mega_kernel_rf_pc_12_2f:
s_mov_b64 exec, vcc
buffer_load_dwordx4 v[40:43], v7, s[84:87], s29 offen offset:2048 sc1
s_mov_b64 exec, -1
s_branch mega_kernel_rf_pc_12_3
mega_kernel_rf_il56:
s_cbranch_execz mega_kernel_rf_iwd
.p2align 5
mega_kernel_rf_pc_12_3f:
s_mov_b64 exec, vcc
buffer_load_dwordx4 v[44:47], v7, s[84:87], s29 offen offset:3072 sc1
s_mov_b64 exec, -1
s_branch mega_kernel_rf_pc_12_2
.p2align 5
mega_kernel_rf_pc_12_3:
s_waitcnt vmcnt(1)
v_cmp_eq_u32 vcc, -1, v44
s_cbranch_vccnz mega_kernel_rf_pc_12_3f
v_smfmac_f32_16x16x64_bf16 v[96:99], v[44:47], a[216:223], v6
v_smfmac_f32_16x16x64_bf16 v[100:103], v[44:47], a[248:255], v6
s_branch mega_kernel_rf_pc_4_2
mega_kernel_rf_iw3:
mega_kernel_rf_il57:
s_cbranch_execz mega_kernel_rf_il58
.p2align 5
mega_kernel_rf_pc_13_0f:
s_mov_b64 exec, vcc
buffer_load_dwordx4 v[32:35], v7, s[84:87], s29 offen offset:0 sc1
s_mov_b64 exec, -1
s_branch mega_kernel_rf_pc_13_2
mega_kernel_rf_il58:
s_cbranch_execz mega_kernel_rf_il59
.p2align 5
mega_kernel_rf_pc_13_0:
s_waitcnt vmcnt(2)
v_cmp_eq_u32 vcc, -1, v32
s_cbranch_vccnz mega_kernel_rf_pc_13_0f
v_smfmac_f32_16x16x64_bf16 v[96:99], v[32:35], a[192:199], v6
v_smfmac_f32_16x16x64_bf16 v[100:103], v[32:35], a[224:231], v6
s_branch mega_kernel_rf_pc_12_2
.p2align 5
mega_kernel_rf_pc_13_2f:
s_mov_b64 exec, vcc
buffer_load_dwordx4 v[40:43], v7, s[84:87], s29 offen offset:2048 sc1
s_mov_b64 exec, -1
s_branch mega_kernel_rf_pc_13_3
mega_kernel_rf_il59:
s_cbranch_execz mega_kernel_rf_il60
.p2align 5
mega_kernel_rf_pc_13_2:
s_waitcnt vmcnt(2)
v_cmp_eq_u32 vcc, -1, v40
s_cbranch_vccnz mega_kernel_rf_pc_13_2f
v_smfmac_f32_16x16x64_bf16 v[96:99], v[40:43], a[208:215], v6
v_smfmac_f32_16x16x64_bf16 v[100:103], v[40:43], a[240:247], v6
s_branch mega_kernel_rf_pc_9_3
.p2align 5
mega_kernel_rf_pc_13_3f:
s_mov_b64 exec, vcc
buffer_load_dwordx4 v[44:47], v7, s[84:87], s29 offen offset:3072 sc1
s_mov_b64 exec, -1
s_branch mega_kernel_rf_pc_13_0
mega_kernel_rf_il60:
s_cbranch_execz mega_kernel_rf_il61
.p2align 5
mega_kernel_rf_pc_13_3:
s_waitcnt vmcnt(2)
v_cmp_eq_u32 vcc, -1, v44
s_cbranch_vccnz mega_kernel_rf_pc_13_3f
v_smfmac_f32_16x16x64_bf16 v[96:99], v[44:47], a[216:223], v6
v_smfmac_f32_16x16x64_bf16 v[100:103], v[44:47], a[248:255], v6
s_branch mega_kernel_rf_pc_5_0
.p2align 5
mega_kernel_rf_pc_14_1f:
s_mov_b64 exec, vcc
buffer_load_dwordx4 v[36:39], v7, s[84:87], s29 offen offset:1024 sc1
s_mov_b64 exec, -1
s_branch mega_kernel_rf_pc_14_2
mega_kernel_rf_il61:
s_cbranch_execz mega_kernel_rf_il62
.p2align 5
mega_kernel_rf_pc_14_2f:
s_mov_b64 exec, vcc
buffer_load_dwordx4 v[40:43], v7, s[84:87], s29 offen offset:2048 sc1
s_mov_b64 exec, -1
s_branch mega_kernel_rf_pc_14_3
.p2align 5
mega_kernel_rf_pc_14_2:
s_waitcnt vmcnt(2)
v_cmp_eq_u32 vcc, -1, v40
s_cbranch_vccnz mega_kernel_rf_pc_14_2f
v_smfmac_f32_16x16x64_bf16 v[96:99], v[40:43], a[208:215], v6
v_smfmac_f32_16x16x64_bf16 v[100:103], v[40:43], a[240:247], v6
s_branch mega_kernel_rf_pc_10_3
mega_kernel_rf_il62:
s_cbranch_execz mega_kernel_rf_il63
.p2align 5
mega_kernel_rf_pc_14_3f:
s_mov_b64 exec, vcc
buffer_load_dwordx4 v[44:47], v7, s[84:87], s29 offen offset:3072 sc1
s_mov_b64 exec, -1
s_branch mega_kernel_rf_pc_14_1
mega_kernel_rf_il63:
s_cbranch_execz mega_kernel_rf_il64
.p2align 5
mega_kernel_rf_pc_14_3:
s_waitcnt vmcnt(2)
v_cmp_eq_u32 vcc, -1, v44
s_cbranch_vccnz mega_kernel_rf_pc_14_3f
v_smfmac_f32_16x16x64_bf16 v[96:99], v[44:47], a[216:223], v6
v_smfmac_f32_16x16x64_bf16 v[100:103], v[44:47], a[248:255], v6
s_branch mega_kernel_rf_pc_6_1
.p2align 5
mega_kernel_rf_pc_15_0f:
s_mov_b64 exec, vcc
buffer_load_dwordx4 v[32:35], v7, s[84:87], s29 offen offset:0 sc1
s_mov_b64 exec, -1
s_branch mega_kernel_rf_pc_15_1
mega_kernel_rf_il64:
s_cbranch_execz mega_kernel_rf_il65
.p2align 5
mega_kernel_rf_pc_15_1f:
s_mov_b64 exec, vcc
buffer_load_dwordx4 v[36:39], v7, s[84:87], s29 offen offset:1024 sc1
s_mov_b64 exec, -1
s_branch mega_kernel_rf_pc_15_2
.p2align 5
mega_kernel_rf_pc_15_1:
s_waitcnt vmcnt(3)
v_cmp_eq_u32 vcc, -1, v36
s_cbranch_vccnz mega_kernel_rf_pc_15_1f
v_smfmac_f32_16x16x64_bf16 v[96:99], v[36:39], a[200:207], v6
v_smfmac_f32_16x16x64_bf16 v[100:103], v[36:39], a[232:239], v6
s_branch mega_kernel_rf_pc_13_2
mega_kernel_rf_il65:
s_cbranch_execz mega_kernel_rf_il66
.p2align 5
mega_kernel_rf_pc_15_2f:
s_mov_b64 exec, vcc
buffer_load_dwordx4 v[40:43], v7, s[84:87], s29 offen offset:2048 sc1
s_mov_b64 exec, -1
s_branch mega_kernel_rf_pc_15_3
mega_kernel_rf_il66:
s_cbranch_execz mega_kernel_rf_il67
.p2align 5
mega_kernel_rf_pc_15_2:
s_waitcnt vmcnt(3)
v_cmp_eq_u32 vcc, -1, v40
s_cbranch_vccnz mega_kernel_rf_pc_15_2f
v_smfmac_f32_16x16x64_bf16 v[96:99], v[40:43], a[208:215], v6
v_smfmac_f32_16x16x64_bf16 v[100:103], v[40:43], a[240:247], v6
s_branch mega_kernel_rf_pc_11_3
.p2align 5
mega_kernel_rf_pc_15_3f:
s_mov_b64 exec, vcc
buffer_load_dwordx4 v[44:47], v7, s[84:87], s29 offen offset:3072 sc1
s_mov_b64 exec, -1
s_branch mega_kernel_rf_pc_15_0
mega_kernel_rf_il67:
s_cbranch_execz mega_kernel_rf_il68
.p2align 5
mega_kernel_rf_pc_15_3:
s_waitcnt vmcnt(3)
v_cmp_eq_u32 vcc, -1, v44
s_cbranch_vccnz mega_kernel_rf_pc_15_3f
v_smfmac_f32_16x16x64_bf16 v[96:99], v[44:47], a[216:223], v6
v_smfmac_f32_16x16x64_bf16 v[100:103], v[44:47], a[248:255], v6
s_branch mega_kernel_rf_pc_7_0
mega_kernel_rf_w0last:
s_nop 7
v_permlane32_swap_b32 v112, v116
v_permlane32_swap_b32 v113, v117
v_permlane32_swap_b32 v114, v118
v_permlane32_swap_b32 v115, v119
v_pk_add_f32 v[112:113], v[112:113], v[116:117]
v_pk_add_f32 v[114:115], v[114:115], v[118:119]
ds_write_b128 v20, v[112:115]
s_waitcnt lgkmcnt(0)
s_barrier
s_branch mega_kernel_rf_end
mega_kernel_rf_il68:
s_cbranch_execz mega_kernel_rf_il69
mega_kernel_rf_side:
s_cmp_eq_u32 s24, 3
s_cbranch_scc1 mega_kernel_rf_sd3
s_cmp_eq_u32 s24, 2
s_cbranch_scc0 mega_kernel_rf_sd4
s_mov_b64 exec, s[40:41]
buffer_store_dwordx4 v[28:31], v11, s[84:87], s34 offen
s_mov_b64 exec, -1
buffer_store_dwordx2 v[28:29], v9, s[84:87], s34 offen
s_mul_i32 s28, s31, 1280
s_add_u32 s28, s28, s34
s_add_u32 s28, s28, 49152
buffer_store_dwordx4 v[28:31], v17, s[84:87], s28 offen
buffer_store_dwordx4 v[28:31], v10, s[84:87], s28 offen
s_branch mega_kernel_rf_sd4
mega_kernel_rf_il69:
s_cbranch_execz mega_kernel_rf_il70
mega_kernel_rf_sd3:
v_readlane_b32 s76, v249, 0
v_readlane_b32 s77, v249, 1
s_min_i32 s76, s76, s77
s_max_i32 s46, s46, s76
s_mov_b32 s36, 0
s_add_u32 s76, s27, 1
s_cmp_lt_u32 s76, 63
s_cbranch_scc0 mega_kernel_rf_sd4
s_cmp_ge_u32 s76, 0
s_cbranch_scc0 mega_kernel_rf_sd4
s_cmp_gt_i32 s46, s76
s_cselect_b32 s36, 0, 1
s_cbranch_scc0 mega_kernel_rf_sd4
s_add_u32 s77, s76, s82
s_bfe_u32 s28, s77, 0x40002
s_lshl_b32 s28, s28, 14
s_and_b32 s77, s77, 3
s_lshl_b32 s77, s77, 11
s_add_u32 s28, s28, s77
s_add_u32 m0, s45, 0
s_nop 0
buffer_load_dwordx4 v240, s[84:87], s28 offen offset:0 sc1 lds
s_add_u32 m0, s45, 0
s_nop 0
buffer_load_dwordx4 v240, s[84:87], s28 offen offset:1024 sc1 lds
s_add_u32 m0, s45, 2048
s_nop 0
buffer_load_dwordx4 v241, s[84:87], s28 offen offset:0 sc1 lds
s_add_u32 m0, s45, 2048
s_nop 0
buffer_load_dwordx4 v241, s[84:87], s28 offen offset:1024 sc1 lds
s_add_u32 s45, s45, 4096
s_cmp_eq_u32 s45, 30720
s_cselect_b32 s45, 18432, s45
mega_kernel_rf_sd4:
v_smfmac_f32_16x16x64_bf16 v[112:115], v[40:43], a[144:151], v6
v_smfmac_f32_16x16x64_bf16 v[116:119], v[40:43], a[176:183], v6
v_smfmac_f32_16x16x64_bf16 v[112:115], v[44:47], a[152:159], v6
v_smfmac_f32_16x16x64_bf16 v[116:119], v[44:47], a[184:191], v6
s_nop 7
v_permlane32_swap_b32 v112, v116
v_permlane32_swap_b32 v113, v117
v_permlane32_swap_b32 v114, v118
v_permlane32_swap_b32 v115, v119
v_pk_add_f32 v[112:113], v[112:113], v[116:117]
v_pk_add_f32 v[114:115], v[114:115], v[118:119]
ds_write_b128 v20, v[112:115]
v_mov_b32 v96, 0
v_mov_b32 v97, 0
v_mov_b32 v98, 0
v_mov_b32 v99, 0
v_mov_b32 v100, 0
v_mov_b32 v101, 0
v_mov_b32 v102, 0
v_mov_b32 v103, 0
s_cmp_eq_u32 s24, 1
s_cbranch_scc0 mega_kernel_rf_s1
s_waitcnt lgkmcnt(0)
ds_read_b128 v[120:123], v16 offset:0
ds_read_b128 v[124:127], v16 offset:16
ds_read_b128 v[128:131], v16 offset:2304
ds_read_b128 v[132:135], v16 offset:2320
ds_read_b128 v[136:139], v16 offset:4608
ds_read_b128 v[140:143], v16 offset:4624
ds_read_b128 v[144:147], v16 offset:6912
ds_read_b128 v[148:151], v16 offset:6928
s_waitcnt lgkmcnt(4)
v_pk_add_f32 v[120:121], v[120:121], v[128:129]
v_pk_add_f32 v[122:123], v[122:123], v[130:131]
v_pk_add_f32 v[124:125], v[124:125], v[132:133]
v_pk_add_f32 v[126:127], v[126:127], v[134:135]
s_waitcnt lgkmcnt(0)
v_pk_add_f32 v[136:137], v[136:137], v[144:145]
v_pk_add_f32 v[138:139], v[138:139], v[146:147]
v_pk_add_f32 v[140:141], v[140:141], v[148:149]
v_pk_add_f32 v[142:143], v[142:143], v[150:151]
v_pk_add_f32 v[120:121], v[120:121], v[136:137]
v_pk_add_f32 v[122:123], v[122:123], v[138:139]
v_pk_add_f32 v[124:125], v[124:125], v[140:141]
v_pk_add_f32 v[126:127], v[126:127], v[142:143]
v_cvt_pk_bf16_f32 v244, v120, v121
v_cvt_pk_bf16_f32 v245, v122, v123
v_cvt_pk_bf16_f32 v246, v124, v125
v_cvt_pk_bf16_f32 v247, v126, v127
mega_kernel_rf_s1:
v_add_u32 v5, 9216, v17
s_waitcnt lgkmcnt(0)
s_barrier
s_cmp_eq_u32 s24, 2
s_cbranch_scc1 mega_kernel_rf_s2
s_cmp_eq_u32 s24, 3
s_cbranch_scc0 mega_kernel_rf_s3
s_add_u32 s76, s27, 2
s_cmp_lt_u32 s76, 63
s_cbranch_scc0 mega_kernel_rf_s3
s_cmp_gt_i32 s46, s76
s_cbranch_scc0 mega_kernel_rf_s3
s_add_u32 s77, s76, s82
s_bfe_u32 s28, s77, 0x40002
s_lshl_b32 s28, s28, 14
s_and_b32 s77, s77, 3
s_lshl_b32 s77, s77, 11
s_add_u32 s28, s28, s77
s_add_u32 s28, s28, s83
s_buffer_load_dword s78, s[84:87], s28 offset:0
s_buffer_load_dword s78, s[84:87], s28 offset:128
s_buffer_load_dword s78, s[84:87], s28 offset:256
s_buffer_load_dword s78, s[84:87], s28 offset:384
s_buffer_load_dword s78, s[84:87], s28 offset:512
s_buffer_load_dword s78, s[84:87], s28 offset:640
s_buffer_load_dword s78, s[84:87], s28 offset:768
s_buffer_load_dword s78, s[84:87], s28 offset:896
s_buffer_load_dword s78, s[84:87], s28 offset:1024
s_buffer_load_dword s78, s[84:87], s28 offset:1152
s_buffer_load_dword s78, s[84:87], s28 offset:1280
s_buffer_load_dword s78, s[84:87], s28 offset:1408
s_buffer_load_dword s78, s[84:87], s28 offset:1536
s_buffer_load_dword s78, s[84:87], s28 offset:1664
s_buffer_load_dword s78, s[84:87], s28 offset:1792
s_buffer_load_dword s78, s[84:87], s28 offset:1920
s_mov_b32 s88, s76
s_branch mega_kernel_rf_s3
mega_kernel_rf_il70:
s_cbranch_execz mega_kernel_rf_il71
mega_kernel_rf_s2:
ds_read_b128 v[120:123], v5 offset:0
ds_read_b128 v[124:127], v5 offset:1024
ds_read_b128 v[128:131], v5 offset:2048
ds_read_b128 v[132:135], v5 offset:3072
v_lshrrev_b32 v5, 1, v17
s_waitcnt lgkmcnt(2)
v_pk_add_f32 v[120:121], v[120:121], v[124:125]
v_pk_add_f32 v[122:123], v[122:123], v[126:127]
s_waitcnt lgkmcnt(0)
v_pk_add_f32 v[128:129], v[128:129], v[132:133]
v_pk_add_f32 v[130:131], v[130:131], v[134:135]
v_pk_add_f32 v[120:121], v[120:121], v[128:129]
v_pk_add_f32 v[122:123], v[122:123], v[130:131]
v_cvt_pk_bf16_f32 v244, v120, v121
v_cvt_pk_bf16_f32 v245, v122, v123
ds_write_b64 v5, v[244:245] offset:17920
s_waitcnt lgkmcnt(0) vmcnt(0)
mega_kernel_rf_s3:
s_cmp_eq_u32 s27, 63
s_cbranch_scc1 mega_kernel_rf_slast
s_add_u32 s29, s33, 24576
s_barrier
s_cmp_eq_u32 s24, 3
s_cbranch_scc1 mega_kernel_rf_y3
s_add_u32 s77, s27, s82
s_bfe_u32 s28, s77, 0x30003
s_lshl_b32 s28, s28, 14
s_and_b32 s77, s77, 7
s_lshl_b32 s77, s77, 10
s_add_u32 s28, s28, s77
s_add_u32 s28, s28, s79
s_cmp_eq_u32 s24, 2
s_cbranch_scc1 mega_kernel_rf_kv2a
s_mov_b64 exec, s[48:49]
buffer_store_dwordx4 v[244:247], v22, s[84:87], s28 offen sc1
s_mov_b64 exec, -1
s_branch mega_kernel_rf_kvda
mega_kernel_rf_il71:
s_cbranch_execz mega_kernel_rf_il72
mega_kernel_rf_kv2a:
v_lshlrev_b32 v4, 3, v1
buffer_store_dwordx2 v[244:245], v4, s[84:87], s28 offen offset:512 sc1
mega_kernel_rf_kvda:
s_branch mega_kernel_rf_y4
mega_kernel_rf_y3:
s_add_u32 s76, s27, 2
s_cmp_lt_u32 s76, 63
s_cbranch_scc0 mega_kernel_rf_y4
mega_kernel_rf_y4:
s_branch mega_kernel_rf_b3
mega_kernel_rf_first:
v_add_u32 v5, s44, v17
ds_read_b128 v[156:159], v5 offset:0
ds_read_b128 v[160:163], v5 offset:1024
ds_read_b128 v[164:167], v5 offset:2048
ds_read_b128 v[168:171], v5 offset:3072
s_branch mega_kernel_rf_adone
mega_kernel_rf_il72:
s_cbranch_execz mega_kernel_rf_il73
mega_kernel_rf_slast:
s_cmp_eq_u32 s24, 3
s_cbranch_scc1 mega_kernel_rf_end
s_add_u32 s77, s27, s82
s_bfe_u32 s28, s77, 0x30003
s_lshl_b32 s28, s28, 14
s_and_b32 s77, s77, 7
s_lshl_b32 s77, s77, 10
s_add_u32 s28, s28, s77
s_add_u32 s28, s28, s79
s_cmp_eq_u32 s24, 2
s_cbranch_scc1 mega_kernel_rf_kv2b
s_mov_b64 exec, s[48:49]
buffer_store_dwordx4 v[244:247], v22, s[84:87], s28 offen sc1
s_mov_b64 exec, -1
s_branch mega_kernel_rf_kvdb
mega_kernel_rf_il73:
s_cbranch_execz mega_kernel_rf_iwd
mega_kernel_rf_kv2b:
v_lshlrev_b32 v4, 3, v1
buffer_store_dwordx2 v[244:245], v4, s[84:87], s28 offen offset:512 sc1
mega_kernel_rf_kvdb:
s_waitcnt vmcnt(0)
s_barrier
s_mov_b32 s76, 64
s_cmp_eq_u32 s24, 1
s_cbranch_scc0 mega_kernel_rf_end
v_mov_b32 v5, s76
s_mov_b64 exec, 1
buffer_store_dword v5, v228, s[84:87], s81 offen sc1
s_mov_b64 exec, -1
mega_kernel_rf_end:
s_endpgm
mega_kernel_recs:
s_load_dwordx2 s[20:21], s[0:1], 8
s_load_dwordx2 s[16:17], s[0:1], 40
s_load_dwordx2 s[4:5], s[0:1], 16
s_load_dwordx2 s[8:9], s[0:1], 24
s_load_dwordx2 s[12:13], s[0:1], 32
v_lshrrev_b32 v4, 6, v0
v_and_b32 v1, 63, v0
v_readfirstlane_b32 s24, v4
v_lshrrev_b32 v2, 4, v1
v_and_b32 v3, 15, v1
v_lshlrev_b32 v17, 4, v1
s_lshr_b32 s28, s31, 2
s_lshl_b32 s25, s30, 3
s_add_u32 s25, s25, s28
s_and_b32 s26, s31, 3
s_waitcnt lgkmcnt(0)
s_mov_b32 s22, 16384
s_mov_b32 s23, 0x00020000
s_mov_b32 s18, 8388608
s_mov_b32 s19, 0x00020000
s_mov_b32 s6, 8388608
s_mov_b32 s7, 0x00020000
s_mov_b32 s10, 8388608
s_mov_b32 s11, 0x00020000
s_mov_b32 s14, 8388608
s_mov_b32 s15, 0x00020000
s_lshl_b32 s28, s25, 8
s_lshr_b32 s29, s26, 0
s_lshl_b32 s29, s29, 6
s_add_u32 s28, s28, s29
s_lshl_b32 s29, s24, 21
s_add_u32 s28, s28, s29
v_lshrrev_b32 v4, 2, v1
v_and_b32 v5, 3, v1
v_lshlrev_b32 v40, 13, v4
v_lshl_add_u32 v40, v5, 4, v40
v_add_u32 v40, s28, v40
s_lshl_b32 s28, s30, 21
s_lshl_b32 s29, s24, 19
s_add_u32 s28, s28, s29
s_lshr_b32 s29, s31, 0
s_lshl_b32 s29, s29, 6
s_add_u32 s28, s28, s29
v_lshlrev_b32 v41, 11, v4
v_lshl_add_u32 v41, v5, 4, v41
v_add_u32 v41, s28, v41
s_lshl_b32 s47, s24, 15
s_add_u32 s47, s47, 32768
s_lshl_b32 s28, s31, 18
s_lshl_b32 s29, s24, 16
s_add_u32 s28, s28, s29
s_lshl_b32 s29, s30, 11
s_add_u32 s28, s28, s29
v_lshlrev_b32 v48, 13, v2
v_lshl_add_u32 v48, v3, 7, v48
v_add_u32 v48, s28, v48
s_lshl_b32 s28, s30, 21
s_lshl_b32 s29, s31, 16
s_add_u32 s28, s28, s29
s_lshl_b32 s29, s24, 14
s_add_u32 s28, s28, s29
v_lshlrev_b32 v49, 7, v1
v_add_u32 v49, s28, v49
s_and_b32 s76, s31, 1
s_mul_i32 s76, s76, 8
s_and_b32 s28, s31, 15
s_lshl_b32 s28, s28, 4
s_lshl_b32 s29, s24, 8
s_add_u32 s28, s28, s29
v_add_u32 v53, s28, v3
s_lshr_b32 s28, s31, 4
s_lshl_b32 s28, s28, 10
s_add_u32 s28, s28, 384
v_mov_b32 v54, s28
v_mov_b32 v55, 1920
v_cmp_gt_u32 vcc, 32, v1
s_nop 1
v_cndmask_b32 v54, v55, v54, vcc
s_lshl_b32 s29, s30, 11
v_lshl_add_u32 v51, v53, 13, v54
v_add_u32 v51, s29, v51
s_lshl_b32 s29, s30, 21
v_lshl_add_u32 v52, v53, 11, v54
v_add_u32 v52, s29, v52
buffer_load_dword v50, v51, s[8:11], 0 offen
s_xor_b32 s29, s76, 0
s_lshl_b32 s28, s29, 10
s_add_u32 s28, s28, s47
s_add_u32 m0, s28, 0
s_lshl_b32 s29, s29, 17
buffer_load_dwordx4 v40, s[8:11], s29 offen lds
s_xor_b32 s29, s76, 1
s_lshl_b32 s28, s29, 10
s_add_u32 s28, s28, s47
s_add_u32 m0, s28, 0
s_lshl_b32 s29, s29, 17
buffer_load_dwordx4 v40, s[8:11], s29 offen lds
s_xor_b32 s29, s76, 2
s_lshl_b32 s28, s29, 10
s_add_u32 s28, s28, s47
s_add_u32 m0, s28, 0
s_lshl_b32 s29, s29, 17
buffer_load_dwordx4 v40, s[8:11], s29 offen lds
s_xor_b32 s29, s76, 3
s_lshl_b32 s28, s29, 10
s_add_u32 s28, s28, s47
s_add_u32 m0, s28, 0
s_lshl_b32 s29, s29, 17
buffer_load_dwordx4 v40, s[8:11], s29 offen lds
s_xor_b32 s29, s76, 4
s_lshl_b32 s28, s29, 10
s_add_u32 s28, s28, s47
s_add_u32 m0, s28, 0
s_lshl_b32 s29, s29, 17
buffer_load_dwordx4 v40, s[8:11], s29 offen lds
s_xor_b32 s29, s76, 5
s_lshl_b32 s28, s29, 10
s_add_u32 s28, s28, s47
s_add_u32 m0, s28, 0
s_lshl_b32 s29, s29, 17
buffer_load_dwordx4 v40, s[8:11], s29 offen lds
s_xor_b32 s29, s76, 6
s_lshl_b32 s28, s29, 10
s_add_u32 s28, s28, s47
s_add_u32 m0, s28, 0
s_lshl_b32 s29, s29, 17
buffer_load_dwordx4 v40, s[8:11], s29 offen lds
s_xor_b32 s29, s76, 7
s_lshl_b32 s28, s29, 10
s_add_u32 s28, s28, s47
s_add_u32 m0, s28, 0
s_lshl_b32 s29, s29, 17
buffer_load_dwordx4 v40, s[8:11], s29 offen lds
s_xor_b32 s29, s76, 8
s_lshl_b32 s28, s29, 10
s_add_u32 s28, s28, s47
s_add_u32 m0, s28, 0
s_lshl_b32 s29, s29, 17
buffer_load_dwordx4 v40, s[8:11], s29 offen lds
s_xor_b32 s29, s76, 9
s_lshl_b32 s28, s29, 10
s_add_u32 s28, s28, s47
s_add_u32 m0, s28, 0
s_lshl_b32 s29, s29, 17
buffer_load_dwordx4 v40, s[8:11], s29 offen lds
s_xor_b32 s29, s76, 10
s_lshl_b32 s28, s29, 10
s_add_u32 s28, s28, s47
s_add_u32 m0, s28, 0
s_lshl_b32 s29, s29, 17
buffer_load_dwordx4 v40, s[8:11], s29 offen lds
s_xor_b32 s29, s76, 11
s_lshl_b32 s28, s29, 10
s_add_u32 s28, s28, s47
s_add_u32 m0, s28, 0
s_lshl_b32 s29, s29, 17
buffer_load_dwordx4 v40, s[8:11], s29 offen lds
s_xor_b32 s29, s76, 12
s_lshl_b32 s28, s29, 10
s_add_u32 s28, s28, s47
s_add_u32 m0, s28, 0
s_lshl_b32 s29, s29, 17
buffer_load_dwordx4 v40, s[8:11], s29 offen lds
s_xor_b32 s29, s76, 13
s_lshl_b32 s28, s29, 10
s_add_u32 s28, s28, s47
s_add_u32 m0, s28, 0
s_lshl_b32 s29, s29, 17
buffer_load_dwordx4 v40, s[8:11], s29 offen lds
s_xor_b32 s29, s76, 14
s_lshl_b32 s28, s29, 10
s_add_u32 s28, s28, s47
s_add_u32 m0, s28, 0
s_lshl_b32 s29, s29, 17
buffer_load_dwordx4 v40, s[8:11], s29 offen lds
s_xor_b32 s29, s76, 15
s_lshl_b32 s28, s29, 10
s_add_u32 s28, s28, s47
s_add_u32 m0, s28, 0
s_lshl_b32 s29, s29, 17
buffer_load_dwordx4 v40, s[8:11], s29 offen lds
buffer_load_dword v50, v51, s[12:15], 0 offen
s_xor_b32 s29, s76, 0
s_lshl_b32 s28, s29, 10
s_add_u32 s28, s28, s47
s_add_u32 m0, s28, 16384
s_lshl_b32 s29, s29, 17
buffer_load_dwordx4 v40, s[12:15], s29 offen lds
s_xor_b32 s29, s76, 1
s_lshl_b32 s28, s29, 10
s_add_u32 s28, s28, s47
s_add_u32 m0, s28, 16384
s_lshl_b32 s29, s29, 17
buffer_load_dwordx4 v40, s[12:15], s29 offen lds
s_xor_b32 s29, s76, 2
s_lshl_b32 s28, s29, 10
s_add_u32 s28, s28, s47
s_add_u32 m0, s28, 16384
s_lshl_b32 s29, s29, 17
buffer_load_dwordx4 v40, s[12:15], s29 offen lds
s_xor_b32 s29, s76, 3
s_lshl_b32 s28, s29, 10
s_add_u32 s28, s28, s47
s_add_u32 m0, s28, 16384
s_lshl_b32 s29, s29, 17
buffer_load_dwordx4 v40, s[12:15], s29 offen lds
s_xor_b32 s29, s76, 4
s_lshl_b32 s28, s29, 10
s_add_u32 s28, s28, s47
s_add_u32 m0, s28, 16384
s_lshl_b32 s29, s29, 17
buffer_load_dwordx4 v40, s[12:15], s29 offen lds
s_xor_b32 s29, s76, 5
s_lshl_b32 s28, s29, 10
s_add_u32 s28, s28, s47
s_add_u32 m0, s28, 16384
s_lshl_b32 s29, s29, 17
buffer_load_dwordx4 v40, s[12:15], s29 offen lds
s_xor_b32 s29, s76, 6
s_lshl_b32 s28, s29, 10
s_add_u32 s28, s28, s47
s_add_u32 m0, s28, 16384
s_lshl_b32 s29, s29, 17
buffer_load_dwordx4 v40, s[12:15], s29 offen lds
s_xor_b32 s29, s76, 7
s_lshl_b32 s28, s29, 10
s_add_u32 s28, s28, s47
s_add_u32 m0, s28, 16384
s_lshl_b32 s29, s29, 17
buffer_load_dwordx4 v40, s[12:15], s29 offen lds
s_xor_b32 s29, s76, 8
s_lshl_b32 s28, s29, 10
s_add_u32 s28, s28, s47
s_add_u32 m0, s28, 16384
s_lshl_b32 s29, s29, 17
buffer_load_dwordx4 v40, s[12:15], s29 offen lds
s_xor_b32 s29, s76, 9
s_lshl_b32 s28, s29, 10
s_add_u32 s28, s28, s47
s_add_u32 m0, s28, 16384
s_lshl_b32 s29, s29, 17
buffer_load_dwordx4 v40, s[12:15], s29 offen lds
s_xor_b32 s29, s76, 10
s_lshl_b32 s28, s29, 10
s_add_u32 s28, s28, s47
s_add_u32 m0, s28, 16384
s_lshl_b32 s29, s29, 17
buffer_load_dwordx4 v40, s[12:15], s29 offen lds
s_xor_b32 s29, s76, 11
s_lshl_b32 s28, s29, 10
s_add_u32 s28, s28, s47
s_add_u32 m0, s28, 16384
s_lshl_b32 s29, s29, 17
buffer_load_dwordx4 v40, s[12:15], s29 offen lds
s_xor_b32 s29, s76, 12
s_lshl_b32 s28, s29, 10
s_add_u32 s28, s28, s47
s_add_u32 m0, s28, 16384
s_lshl_b32 s29, s29, 17
buffer_load_dwordx4 v40, s[12:15], s29 offen lds
s_xor_b32 s29, s76, 13
s_lshl_b32 s28, s29, 10
s_add_u32 s28, s28, s47
s_add_u32 m0, s28, 16384
s_lshl_b32 s29, s29, 17
buffer_load_dwordx4 v40, s[12:15], s29 offen lds
s_xor_b32 s29, s76, 14
s_lshl_b32 s28, s29, 10
s_add_u32 s28, s28, s47
s_add_u32 m0, s28, 16384
s_lshl_b32 s29, s29, 17
buffer_load_dwordx4 v40, s[12:15], s29 offen lds
s_xor_b32 s29, s76, 15
s_lshl_b32 s28, s29, 10
s_add_u32 s28, s28, s47
s_add_u32 m0, s28, 16384
s_lshl_b32 s29, s29, 17
buffer_load_dwordx4 v40, s[12:15], s29 offen lds
s_mov_b32 s40, 0x00ff00ff
s_mov_b32 s41, 0x00ff00ff
s_mov_b32 s48, 0xff00ff00
s_mov_b32 s49, 0xff00ff00
s_mov_b32 s42, 0
s_mov_b32 s43, 0x00ff00ff
s_mov_b32 s32, 0x3e0293ee
v_mov_b32 v23, 0xff800000
v_mov_b32 v6, 0x4444
v_mov_b32 v4, 0xeeee
v_cndmask_b32 v6, v6, v4, s[48:49]
v_mov_b32 v28, -1
v_mov_b32 v29, -1
v_mov_b32 v30, -1
v_mov_b32 v31, -1
s_mul_i32 s28, s24, 4096
v_add_u32 v7, s28, v17
v_and_b32 v4, 7, v1
v_lshlrev_b32 v8, 11, v4
v_lshrrev_b32 v5, 3, v1
v_lshl_add_u32 v8, v5, 4, v8
s_lshl_b32 s28, s24, 9
v_add_u32 v8, s28, v8
s_lshl_b32 s28, s31, 9
s_lshr_b32 s29, s31, 3
s_mul_i32 s29, s29, 0
s_add_u32 s28, s28, s29
v_lshlrev_b32 v9, 3, v1
v_add_u32 v9, s28, v9
v_and_b32 v4, 7, v3
v_lshlrev_b32 v11, 7, v2
v_lshl_add_u32 v11, v4, 4, v11
v_add_u32 v22, 0, v11
s_add_u32 s28, s28, 24576
v_add_u32 v11, s28, v11
v_and_b32 v5, 1, v2
v_lshlrev_b32 v10, 7, v5
v_lshl_add_u32 v10, v4, 4, v10
v_add_u32 v10, 1024, v10
s_xor_b32 s37, s31, 1
s_mul_i32 s37, s37, 1280
s_add_u32 s37, s37, 49152
s_xor_b32 s38, s31, 2
s_mul_i32 s38, s38, 1280
s_add_u32 s38, s38, 49152
s_xor_b32 s39, s31, 3
s_mul_i32 s39, s39, 1280
s_add_u32 s39, s39, 49152
v_and_b32 v4, 1, v2
v_mul_u32_u24 v14, 576, v4
v_lshrrev_b32 v5, 1, v2
v_lshl_add_u32 v5, v5, 4, v3
v_lshl_add_u32 v14, v5, 2, v14
s_mul_i32 s28, s24, 1152
s_add_u32 s28, s28, 13312
v_add_u32 v18, s28, v14
s_mul_i32 s28, s24, 2304
v_add_u32 v14, s28, v14
v_add_u32 v15, 1152, v14
v_mul_u32_u24 v16, 144, v3
v_lshl_add_u32 v16, v2, 5, v16
v_bfe_u32 v4, v1, 1, 3
v_mul_u32_u24 v19, 144, v4
v_lshl_add_u32 v19, v2, 5, v19
v_and_b32 v4, 1, v1
v_lshl_add_u32 v19, v4, 4, v19
v_add_u32 v19, 13312, v19
s_lshl_b32 s28, s24, 10
s_add_u32 s28, s28, 9216
v_add_u32 v20, s28, v17
v_and_b32 v4, 31, v1
v_lshlrev_b32 v21, 3, v4
v_add_u32 v21, 17920, v21
v_lshrrev_b32 v4, 2, v3
v_and_b32 v42, 1, v4
v_lshrrev_b32 v43, 1, v4
v_lshrrev_b32 v44, 1, v2
v_and_b32 v45, 1, v2
v_lshl_add_u32 v46, v44, 4, v42
v_lshl_add_u32 v46, v45, 2, v46
v_lshl_add_u32 v46, v43, 3, v46
v_lshl_add_u32 v47, v44, 3, v42
v_lshl_add_u32 v47, v45, 4, v47
v_lshl_add_u32 v47, v43, 2, v47
v_and_b32 v5, 3, v3
v_lshlrev_b32 v5, 3, v5
v_lshl_add_u32 v46, v46, 6, v5
v_lshl_add_u32 v47, v47, 6, v5
s_and_b32 s28, s31, 0
s_lshl_b32 s28, s28, 6
s_add_u32 s28, s28, s47
v_add_u32 v46, s28, v46
v_add_u32 v47, s28, v47
s_waitcnt vmcnt(17)
ds_read_b64_tr_b16 a[64:65], v46 offset:0
ds_read_b64_tr_b16 a[66:67], v46 offset:128
ds_read_b64_tr_b16 a[68:69], v46 offset:2048
ds_read_b64_tr_b16 a[70:71], v46 offset:2176
ds_read_b64_tr_b16 a[72:73], v46 offset:4096
ds_read_b64_tr_b16 a[74:75], v46 offset:4224
ds_read_b64_tr_b16 a[76:77], v46 offset:6144
ds_read_b64_tr_b16 a[78:79], v46 offset:6272
s_waitcnt lgkmcnt(0)
ds_read_b64_tr_b16 a[80:81], v46 offset:8192
ds_read_b64_tr_b16 a[82:83], v46 offset:8320
ds_read_b64_tr_b16 a[84:85], v46 offset:10240
ds_read_b64_tr_b16 a[86:87], v46 offset:10368
ds_read_b64_tr_b16 a[88:89], v46 offset:12288
ds_read_b64_tr_b16 a[90:91], v46 offset:12416
ds_read_b64_tr_b16 a[92:93], v46 offset:14336
ds_read_b64_tr_b16 a[94:95], v46 offset:14464
s_waitcnt lgkmcnt(0)
ds_read_b64_tr_b16 a[96:97], v46 offset:32
ds_read_b64_tr_b16 a[98:99], v46 offset:160
ds_read_b64_tr_b16 a[100:101], v46 offset:2080
ds_read_b64_tr_b16 a[102:103], v46 offset:2208
ds_read_b64_tr_b16 a[104:105], v46 offset:4128
ds_read_b64_tr_b16 a[106:107], v46 offset:4256
ds_read_b64_tr_b16 a[108:109], v46 offset:6176
ds_read_b64_tr_b16 a[110:111], v46 offset:6304
s_waitcnt lgkmcnt(0)
ds_read_b64_tr_b16 a[112:113], v46 offset:8224
ds_read_b64_tr_b16 a[114:115], v46 offset:8352
ds_read_b64_tr_b16 a[116:117], v46 offset:10272
ds_read_b64_tr_b16 a[118:119], v46 offset:10400
ds_read_b64_tr_b16 a[120:121], v46 offset:12320
ds_read_b64_tr_b16 a[122:123], v46 offset:12448
ds_read_b64_tr_b16 a[124:125], v46 offset:14368
ds_read_b64_tr_b16 a[126:127], v46 offset:14496
s_waitcnt lgkmcnt(0)
buffer_load_dword v50, v51, s[4:7], 0 offen
s_xor_b32 s29, s76, 0
s_lshl_b32 s28, s29, 10
s_add_u32 s28, s28, s47
s_add_u32 m0, s28, 0
s_lshl_b32 s29, s29, 17
buffer_load_dwordx4 v40, s[4:7], s29 offen lds
s_xor_b32 s29, s76, 1
s_lshl_b32 s28, s29, 10
s_add_u32 s28, s28, s47
s_add_u32 m0, s28, 0
s_lshl_b32 s29, s29, 17
buffer_load_dwordx4 v40, s[4:7], s29 offen lds
s_xor_b32 s29, s76, 2
s_lshl_b32 s28, s29, 10
s_add_u32 s28, s28, s47
s_add_u32 m0, s28, 0
s_lshl_b32 s29, s29, 17
buffer_load_dwordx4 v40, s[4:7], s29 offen lds
s_xor_b32 s29, s76, 3
s_lshl_b32 s28, s29, 10
s_add_u32 s28, s28, s47
s_add_u32 m0, s28, 0
s_lshl_b32 s29, s29, 17
buffer_load_dwordx4 v40, s[4:7], s29 offen lds
s_xor_b32 s29, s76, 4
s_lshl_b32 s28, s29, 10
s_add_u32 s28, s28, s47
s_add_u32 m0, s28, 0
s_lshl_b32 s29, s29, 17
buffer_load_dwordx4 v40, s[4:7], s29 offen lds
s_xor_b32 s29, s76, 5
s_lshl_b32 s28, s29, 10
s_add_u32 s28, s28, s47
s_add_u32 m0, s28, 0
s_lshl_b32 s29, s29, 17
buffer_load_dwordx4 v40, s[4:7], s29 offen lds
s_xor_b32 s29, s76, 6
s_lshl_b32 s28, s29, 10
s_add_u32 s28, s28, s47
s_add_u32 m0, s28, 0
s_lshl_b32 s29, s29, 17
buffer_load_dwordx4 v40, s[4:7], s29 offen lds
s_xor_b32 s29, s76, 7
s_lshl_b32 s28, s29, 10
s_add_u32 s28, s28, s47
s_add_u32 m0, s28, 0
s_lshl_b32 s29, s29, 17
buffer_load_dwordx4 v40, s[4:7], s29 offen lds
s_xor_b32 s29, s76, 8
s_lshl_b32 s28, s29, 10
s_add_u32 s28, s28, s47
s_add_u32 m0, s28, 0
s_lshl_b32 s29, s29, 17
buffer_load_dwordx4 v40, s[4:7], s29 offen lds
s_xor_b32 s29, s76, 9
s_lshl_b32 s28, s29, 10
s_add_u32 s28, s28, s47
s_add_u32 m0, s28, 0
s_lshl_b32 s29, s29, 17
buffer_load_dwordx4 v40, s[4:7], s29 offen lds
s_xor_b32 s29, s76, 10
s_lshl_b32 s28, s29, 10
s_add_u32 s28, s28, s47
s_add_u32 m0, s28, 0
s_lshl_b32 s29, s29, 17
buffer_load_dwordx4 v40, s[4:7], s29 offen lds
s_xor_b32 s29, s76, 11
s_lshl_b32 s28, s29, 10
s_add_u32 s28, s28, s47
s_add_u32 m0, s28, 0
s_lshl_b32 s29, s29, 17
buffer_load_dwordx4 v40, s[4:7], s29 offen lds
s_xor_b32 s29, s76, 12
s_lshl_b32 s28, s29, 10
s_add_u32 s28, s28, s47
s_add_u32 m0, s28, 0
s_lshl_b32 s29, s29, 17
buffer_load_dwordx4 v40, s[4:7], s29 offen lds
s_xor_b32 s29, s76, 13
s_lshl_b32 s28, s29, 10
s_add_u32 s28, s28, s47
s_add_u32 m0, s28, 0
s_lshl_b32 s29, s29, 17
buffer_load_dwordx4 v40, s[4:7], s29 offen lds
s_xor_b32 s29, s76, 14
s_lshl_b32 s28, s29, 10
s_add_u32 s28, s28, s47
s_add_u32 m0, s28, 0
s_lshl_b32 s29, s29, 17
buffer_load_dwordx4 v40, s[4:7], s29 offen lds
s_xor_b32 s29, s76, 15
s_lshl_b32 s28, s29, 10
s_add_u32 s28, s28, s47
s_add_u32 m0, s28, 0
s_lshl_b32 s29, s29, 17
buffer_load_dwordx4 v40, s[4:7], s29 offen lds
s_waitcnt vmcnt(17)
ds_read_b64_tr_b16 a[128:129], v46 offset:16384
ds_read_b64_tr_b16 a[130:131], v46 offset:16512
ds_read_b64_tr_b16 a[132:133], v46 offset:18432
ds_read_b64_tr_b16 a[134:135], v46 offset:18560
ds_read_b64_tr_b16 a[136:137], v46 offset:20480
ds_read_b64_tr_b16 a[138:139], v46 offset:20608
ds_read_b64_tr_b16 a[140:141], v46 offset:22528
ds_read_b64_tr_b16 a[142:143], v46 offset:22656
s_waitcnt lgkmcnt(0)
ds_read_b64_tr_b16 a[144:145], v46 offset:24576
ds_read_b64_tr_b16 a[146:147], v46 offset:24704
ds_read_b64_tr_b16 a[148:149], v46 offset:26624
ds_read_b64_tr_b16 a[150:151], v46 offset:26752
ds_read_b64_tr_b16 a[152:153], v46 offset:28672
ds_read_b64_tr_b16 a[154:155], v46 offset:28800
ds_read_b64_tr_b16 a[156:157], v46 offset:30720
ds_read_b64_tr_b16 a[158:159], v46 offset:30848
s_waitcnt lgkmcnt(0)
ds_read_b64_tr_b16 a[160:161], v46 offset:16416
ds_read_b64_tr_b16 a[162:163], v46 offset:16544
ds_read_b64_tr_b16 a[164:165], v46 offset:18464
ds_read_b64_tr_b16 a[166:167], v46 offset:18592
ds_read_b64_tr_b16 a[168:169], v46 offset:20512
ds_read_b64_tr_b16 a[170:171], v46 offset:20640
ds_read_b64_tr_b16 a[172:173], v46 offset:22560
ds_read_b64_tr_b16 a[174:175], v46 offset:22688
s_waitcnt lgkmcnt(0)
ds_read_b64_tr_b16 a[176:177], v46 offset:24608
ds_read_b64_tr_b16 a[178:179], v46 offset:24736
ds_read_b64_tr_b16 a[180:181], v46 offset:26656
ds_read_b64_tr_b16 a[182:183], v46 offset:26784
ds_read_b64_tr_b16 a[184:185], v46 offset:28704
ds_read_b64_tr_b16 a[186:187], v46 offset:28832
ds_read_b64_tr_b16 a[188:189], v46 offset:30752
ds_read_b64_tr_b16 a[190:191], v46 offset:30880
s_waitcnt lgkmcnt(0)
buffer_load_dword v50, v52, s[16:19], 0 offen
s_xor_b32 s29, s76, 0
s_lshl_b32 s28, s29, 10
s_add_u32 s28, s28, s47
s_add_u32 m0, s28, 16384
s_lshl_b32 s29, s29, 15
buffer_load_dwordx4 v41, s[16:19], s29 offen lds
s_xor_b32 s29, s76, 1
s_lshl_b32 s28, s29, 10
s_add_u32 s28, s28, s47
s_add_u32 m0, s28, 16384
s_lshl_b32 s29, s29, 15
buffer_load_dwordx4 v41, s[16:19], s29 offen lds
s_xor_b32 s29, s76, 2
s_lshl_b32 s28, s29, 10
s_add_u32 s28, s28, s47
s_add_u32 m0, s28, 16384
s_lshl_b32 s29, s29, 15
buffer_load_dwordx4 v41, s[16:19], s29 offen lds
s_xor_b32 s29, s76, 3
s_lshl_b32 s28, s29, 10
s_add_u32 s28, s28, s47
s_add_u32 m0, s28, 16384
s_lshl_b32 s29, s29, 15
buffer_load_dwordx4 v41, s[16:19], s29 offen lds
s_xor_b32 s29, s76, 4
s_lshl_b32 s28, s29, 10
s_add_u32 s28, s28, s47
s_add_u32 m0, s28, 16384
s_lshl_b32 s29, s29, 15
buffer_load_dwordx4 v41, s[16:19], s29 offen lds
s_xor_b32 s29, s76, 5
s_lshl_b32 s28, s29, 10
s_add_u32 s28, s28, s47
s_add_u32 m0, s28, 16384
s_lshl_b32 s29, s29, 15
buffer_load_dwordx4 v41, s[16:19], s29 offen lds
s_xor_b32 s29, s76, 6
s_lshl_b32 s28, s29, 10
s_add_u32 s28, s28, s47
s_add_u32 m0, s28, 16384
s_lshl_b32 s29, s29, 15
buffer_load_dwordx4 v41, s[16:19], s29 offen lds
s_xor_b32 s29, s76, 7
s_lshl_b32 s28, s29, 10
s_add_u32 s28, s28, s47
s_add_u32 m0, s28, 16384
s_lshl_b32 s29, s29, 15
buffer_load_dwordx4 v41, s[16:19], s29 offen lds
s_xor_b32 s29, s76, 8
s_lshl_b32 s28, s29, 10
s_add_u32 s28, s28, s47
s_add_u32 m0, s28, 16384
s_lshl_b32 s29, s29, 15
buffer_load_dwordx4 v41, s[16:19], s29 offen lds
s_xor_b32 s29, s76, 9
s_lshl_b32 s28, s29, 10
s_add_u32 s28, s28, s47
s_add_u32 m0, s28, 16384
s_lshl_b32 s29, s29, 15
buffer_load_dwordx4 v41, s[16:19], s29 offen lds
s_xor_b32 s29, s76, 10
s_lshl_b32 s28, s29, 10
s_add_u32 s28, s28, s47
s_add_u32 m0, s28, 16384
s_lshl_b32 s29, s29, 15
buffer_load_dwordx4 v41, s[16:19], s29 offen lds
s_xor_b32 s29, s76, 11
s_lshl_b32 s28, s29, 10
s_add_u32 s28, s28, s47
s_add_u32 m0, s28, 16384
s_lshl_b32 s29, s29, 15
buffer_load_dwordx4 v41, s[16:19], s29 offen lds
s_xor_b32 s29, s76, 12
s_lshl_b32 s28, s29, 10
s_add_u32 s28, s28, s47
s_add_u32 m0, s28, 16384
s_lshl_b32 s29, s29, 15
buffer_load_dwordx4 v41, s[16:19], s29 offen lds
s_xor_b32 s29, s76, 13
s_lshl_b32 s28, s29, 10
s_add_u32 s28, s28, s47
s_add_u32 m0, s28, 16384
s_lshl_b32 s29, s29, 15
buffer_load_dwordx4 v41, s[16:19], s29 offen lds
s_xor_b32 s29, s76, 14
s_lshl_b32 s28, s29, 10
s_add_u32 s28, s28, s47
s_add_u32 m0, s28, 16384
s_lshl_b32 s29, s29, 15
buffer_load_dwordx4 v41, s[16:19], s29 offen lds
s_xor_b32 s29, s76, 15
s_lshl_b32 s28, s29, 10
s_add_u32 s28, s28, s47
s_add_u32 m0, s28, 16384
s_lshl_b32 s29, s29, 15
buffer_load_dwordx4 v41, s[16:19], s29 offen lds
s_mov_b64 exec, 0
s_cmp_eq_u32 s24, 0
s_cbranch_scc1 mega_kernel_rs_iw0
s_cmp_eq_u32 s24, 1
s_cbranch_scc1 mega_kernel_rs_iw1
s_cmp_eq_u32 s24, 2
s_cbranch_scc1 mega_kernel_rs_iw2
s_branch mega_kernel_rs_iw3
mega_kernel_rs_iwd:
s_mov_b64 exec, -1
s_waitcnt vmcnt(17)
ds_read_b64_tr_b16 a[0:1], v46 offset:0
ds_read_b64_tr_b16 a[2:3], v46 offset:128
ds_read_b64_tr_b16 a[4:5], v46 offset:2048
ds_read_b64_tr_b16 a[6:7], v46 offset:2176
ds_read_b64_tr_b16 a[8:9], v46 offset:4096
ds_read_b64_tr_b16 a[10:11], v46 offset:4224
ds_read_b64_tr_b16 a[12:13], v46 offset:6144
ds_read_b64_tr_b16 a[14:15], v46 offset:6272
s_waitcnt lgkmcnt(0)
ds_read_b64_tr_b16 a[16:17], v46 offset:8192
ds_read_b64_tr_b16 a[18:19], v46 offset:8320
ds_read_b64_tr_b16 a[20:21], v46 offset:10240
ds_read_b64_tr_b16 a[22:23], v46 offset:10368
ds_read_b64_tr_b16 a[24:25], v46 offset:12288
ds_read_b64_tr_b16 a[26:27], v46 offset:12416
ds_read_b64_tr_b16 a[28:29], v46 offset:14336
ds_read_b64_tr_b16 a[30:31], v46 offset:14464
s_waitcnt lgkmcnt(0)
ds_read_b64_tr_b16 a[32:33], v46 offset:32
ds_read_b64_tr_b16 a[34:35], v46 offset:160
ds_read_b64_tr_b16 a[36:37], v46 offset:2080
ds_read_b64_tr_b16 a[38:39], v46 offset:2208
ds_read_b64_tr_b16 a[40:41], v46 offset:4128
ds_read_b64_tr_b16 a[42:43], v46 offset:4256
ds_read_b64_tr_b16 a[44:45], v46 offset:6176
ds_read_b64_tr_b16 a[46:47], v46 offset:6304
s_waitcnt lgkmcnt(0)
ds_read_b64_tr_b16 a[48:49], v46 offset:8224
ds_read_b64_tr_b16 a[50:51], v46 offset:8352
ds_read_b64_tr_b16 a[52:53], v46 offset:10272
ds_read_b64_tr_b16 a[54:55], v46 offset:10400
ds_read_b64_tr_b16 a[56:57], v46 offset:12320
ds_read_b64_tr_b16 a[58:59], v46 offset:12448
ds_read_b64_tr_b16 a[60:61], v46 offset:14368
ds_read_b64_tr_b16 a[62:63], v46 offset:14496
s_waitcnt lgkmcnt(0)
v_and_b32 v247, 15, v0
v_lshlrev_b32 v247, 4, v247
buffer_load_dword v246, v247, s[72:75], 0 offen sc1
buffer_load_dwordx4 v[64:67], v8, s[20:23], 0 offen offset:0
buffer_load_dwordx4 v[68:71], v8, s[20:23], 0 offen offset:128
buffer_load_dwordx4 v[72:75], v8, s[20:23], 0 offen offset:256
buffer_load_dwordx4 v[76:79], v8, s[20:23], 0 offen offset:384
s_waitcnt vmcnt(0)
ds_read_b64_tr_b16 a[192:193], v47 offset:16384
ds_read_b64_tr_b16 a[194:195], v47 offset:16512
ds_read_b64_tr_b16 a[196:197], v47 offset:18432
ds_read_b64_tr_b16 a[198:199], v47 offset:18560
ds_read_b64_tr_b16 a[200:201], v47 offset:20480
ds_read_b64_tr_b16 a[202:203], v47 offset:20608
ds_read_b64_tr_b16 a[204:205], v47 offset:22528
ds_read_b64_tr_b16 a[206:207], v47 offset:22656
s_waitcnt lgkmcnt(0)
ds_read_b64_tr_b16 a[208:209], v47 offset:24576
ds_read_b64_tr_b16 a[210:211], v47 offset:24704
ds_read_b64_tr_b16 a[212:213], v47 offset:26624
ds_read_b64_tr_b16 a[214:215], v47 offset:26752
ds_read_b64_tr_b16 a[216:217], v47 offset:28672
ds_read_b64_tr_b16 a[218:219], v47 offset:28800
ds_read_b64_tr_b16 a[220:221], v47 offset:30720
ds_read_b64_tr_b16 a[222:223], v47 offset:30848
s_waitcnt lgkmcnt(0)
ds_read_b64_tr_b16 a[224:225], v47 offset:16416
ds_read_b64_tr_b16 a[226:227], v47 offset:16544
ds_read_b64_tr_b16 a[228:229], v47 offset:18464
ds_read_b64_tr_b16 a[230:231], v47 offset:18592
ds_read_b64_tr_b16 a[232:233], v47 offset:20512
ds_read_b64_tr_b16 a[234:235], v47 offset:20640
ds_read_b64_tr_b16 a[236:237], v47 offset:22560
ds_read_b64_tr_b16 a[238:239], v47 offset:22688
s_waitcnt lgkmcnt(0)
ds_read_b64_tr_b16 a[240:241], v47 offset:24608
ds_read_b64_tr_b16 a[242:243], v47 offset:24736
ds_read_b64_tr_b16 a[244:245], v47 offset:26656
ds_read_b64_tr_b16 a[246:247], v47 offset:26784
ds_read_b64_tr_b16 a[248:249], v47 offset:28704
ds_read_b64_tr_b16 a[250:251], v47 offset:28832
ds_read_b64_tr_b16 a[252:253], v47 offset:30752
ds_read_b64_tr_b16 a[254:255], v47 offset:30880
s_waitcnt lgkmcnt(0)
v_mov_b32 v32, v64
v_mov_b32 v33, v65
v_mov_b32 v34, v66
v_mov_b32 v35, v67
v_mov_b32 v36, v68
v_mov_b32 v37, v69
v_mov_b32 v38, v70
v_mov_b32 v39, v71
v_mov_b32 v40, v72
v_mov_b32 v41, v73
v_mov_b32 v42, v74
v_mov_b32 v43, v75
v_mov_b32 v44, v76
v_mov_b32 v45, v77
v_mov_b32 v46, v78
v_mov_b32 v47, v79
v_mov_b32 v96, 0
v_mov_b32 v97, 0
v_mov_b32 v98, 0
v_mov_b32 v99, 0
v_mov_b32 v100, 0
v_mov_b32 v101, 0
v_mov_b32 v102, 0
v_mov_b32 v103, 0
v_mov_b32 v104, 0
v_mov_b32 v105, 0
v_mov_b32 v106, 0
v_mov_b32 v107, 0
v_mov_b32 v108, 0
v_mov_b32 v109, 0
v_mov_b32 v110, 0
v_mov_b32 v111, 0
v_mov_b32 v112, 0
v_mov_b32 v113, 0
v_mov_b32 v114, 0
v_mov_b32 v115, 0
v_mov_b32 v116, 0
v_mov_b32 v117, 0
v_mov_b32 v118, 0
v_mov_b32 v119, 0
s_nop 1
v_smfmac_f32_16x16x64_bf16 v[96:99], v[32:35], a[0:7], v6
v_smfmac_f32_16x16x64_bf16 v[100:103], v[32:35], a[32:39], v6
v_smfmac_f32_16x16x64_bf16 v[104:107], v[32:35], a[64:71], v6
v_smfmac_f32_16x16x64_bf16 v[108:111], v[32:35], a[96:103], v6
v_smfmac_f32_16x16x64_bf16 v[96:99], v[36:39], a[8:15], v6
v_smfmac_f32_16x16x64_bf16 v[100:103], v[36:39], a[40:47], v6
v_smfmac_f32_16x16x64_bf16 v[104:107], v[36:39], a[72:79], v6
v_smfmac_f32_16x16x64_bf16 v[108:111], v[36:39], a[104:111], v6
v_smfmac_f32_16x16x64_bf16 v[96:99], v[40:43], a[16:23], v6
v_smfmac_f32_16x16x64_bf16 v[100:103], v[40:43], a[48:55], v6
v_smfmac_f32_16x16x64_bf16 v[104:107], v[40:43], a[80:87], v6
v_smfmac_f32_16x16x64_bf16 v[108:111], v[40:43], a[112:119], v6
v_smfmac_f32_16x16x64_bf16 v[96:99], v[44:47], a[24:31], v6
v_smfmac_f32_16x16x64_bf16 v[100:103], v[44:47], a[56:63], v6
v_smfmac_f32_16x16x64_bf16 v[104:107], v[44:47], a[88:95], v6
v_smfmac_f32_16x16x64_bf16 v[108:111], v[44:47], a[120:127], v6
v_and_b32 v247, 15, v0
v_lshlrev_b32 v247, 4, v247
s_branch mega_kernel_sysp
mega_kernel_sysw:
s_sleep 4
mega_kernel_sys:
buffer_load_dword v246, v247, s[72:75], 0 offen sc1
s_waitcnt vmcnt(0)
mega_kernel_sysp:
s_cmp_eq_u32 s95, 1
s_cbranch_scc0 mega_kernel_sysf
v_readlane_b32 s76, v246, 14
s_mov_b32 s98, 0
s_cmp_eq_u32 s76, 32
s_cbranch_scc0 mega_kernel_sysw
s_branch mega_kernel_sysd
mega_kernel_sysf:
s_mov_b32 s77, 0
s_mov_b32 s78, 0
v_readlane_b32 s76, v246, 0
s_add_u32 s77, s77, s76
s_xor_b32 s76, s76, 32
s_or_b32 s78, s78, s76
v_readlane_b32 s76, v246, 1
s_add_u32 s77, s77, s76
s_xor_b32 s76, s76, 32
s_or_b32 s78, s78, s76
v_readlane_b32 s76, v246, 2
s_add_u32 s77, s77, s76
s_xor_b32 s76, s76, 32
s_or_b32 s78, s78, s76
v_readlane_b32 s76, v246, 3
s_add_u32 s77, s77, s76
s_xor_b32 s76, s76, 32
s_or_b32 s78, s78, s76
v_readlane_b32 s76, v246, 4
s_add_u32 s77, s77, s76
s_xor_b32 s76, s76, 32
s_or_b32 s78, s78, s76
v_readlane_b32 s76, v246, 5
s_add_u32 s77, s77, s76
s_xor_b32 s76, s76, 32
s_or_b32 s78, s78, s76
v_readlane_b32 s76, v246, 6
s_add_u32 s77, s77, s76
s_xor_b32 s76, s76, 32
s_or_b32 s78, s78, s76
v_readlane_b32 s76, v246, 7
s_add_u32 s77, s77, s76
s_xor_b32 s76, s76, 32
s_or_b32 s78, s78, s76
s_cmp_eq_u32 s77, 256
s_cbranch_scc0 mega_kernel_sysw
v_mov_b32 v252, v246
s_cmp_eq_u32 s78, 0
s_cbranch_scc0 mega_kernel_slowent
v_readlane_b32 s76, v246, 10
v_readlane_b32 s77, v246, 8
s_cmp_eq_u32 s76, 32
s_cbranch_scc0 mega_kernel_sysw
s_cmp_gt_u32 s77, 16
s_cselect_b32 s98, 1, 0
mega_kernel_sysd:
s_lshr_b32 s28, s31, 4
s_lshl_b32 s28, s28, 14
s_lshl_b32 s29, s98, 13
s_add_u32 s28, s28, s29
s_and_b32 s29, s31, 15
s_lshl_b32 s29, s29, 9
s_add_u32 s28, s28, s29
s_lshl_b32 s29, s30, 16
s_add_u32 s28, s28, s29
s_add_u32 s28, s28, 67108864
v_lshrrev_b32 v12, 1, v17
v_add_u32 v12, s28, v12
v_xor_b32 v25, 0x10000, v12
v_xor_b32 v26, 0x20000, v12
v_xor_b32 v27, 0x30000, v12
v_add_u32 v25, 0, v25
v_add_u32 v26, 0, v26
v_add_u32 v27, 0, v27
s_lshl_b32 s28, s25, 2
s_add_u32 s28, s28, s26
s_mov_b32 s82, s28
s_lshr_b32 s29, s28, 3
s_xor_b32 s29, s29, s98
s_and_b32 s29, s29, 1
s_lshl_b32 s29, s29, 13
s_lshl_b32 s76, s28, 18
s_add_u32 s76, s76, s29
s_mov_b32 s83, s76
v_add_u32 v240, s76, v17
v_add_u32 v241, 33554432, v240
s_lshr_b32 s29, s28, 4
s_xor_b32 s29, s29, s98
s_and_b32 s29, s29, 1
s_lshl_b32 s29, s29, 13
s_lshl_b32 s79, s28, 17
s_add_u32 s79, s79, s29
s_add_u32 s79, s79, 71303168
s_xor_b32 s29, s98, 1
s_lshl_b32 s29, s29, 13
s_lshl_b32 s28, s25, 7
s_add_u32 s28, s28, s29
s_add_u32 s28, s28, 69206016
v_and_b32 v4, 1, v1
v_lshlrev_b32 v24, 12, v4
v_add_u32 v24, s28, v24
s_lshl_b32 s29, s26, 2
v_add_u32 v24, s29, v24
s_xor_b32 s81, s98, 1
s_lshl_b32 s81, s81, 13
s_lshr_b32 s29, s82, 6
s_lshl_b32 s29, s29, 14
s_add_u32 s81, s81, s29
s_and_b32 s29, s82, 63
s_lshl_b32 s29, s29, 7
s_add_u32 s81, s81, s29
s_add_u32 s81, s81, 69222400
v_mov_b32 v220, 0x3f803f80
v_mov_b32 v221, 0x3f803f80
v_mov_b32 v222, 0x3f803f80
v_mov_b32 v223, 0x3f803f80
v_mov_b32 v228, 0
s_mov_b32 s27, 0
s_mov_b32 s46, 0
s_mov_b32 s89, 0
s_mov_b32 s88, 0
s_mov_b32 s44, 18432
s_mov_b32 s45, 18432
s_cmp_eq_u32 s24, 3
s_cbranch_scc0 mega_kernel_rs_pfi
s_mov_b32 s76, 0
s_cmp_gt_i32 s46, s76
s_cbranch_scc1 mega_kernel_rs_pf0ok
mega_kernel_rs_pf0w:
v_mov_b32 v4, 0
s_mov_b64 exec, 3
buffer_atomic_add v4, v24, s[84:87], 0 offen sc0 sc1
s_mov_b64 exec, -1
s_waitcnt vmcnt(0)
v_readlane_b32 s46, v4, 0
v_readlane_b32 s28, v4, 1
s_nop 1
s_min_i32 s46, s46, s28
s_cmp_gt_i32 s46, s76
s_cbranch_scc0 mega_kernel_rs_pf0w
mega_kernel_rs_pf0ok:
s_add_u32 s77, s76, s82
s_bfe_u32 s28, s77, 0x40002
s_lshl_b32 s28, s28, 14
s_and_b32 s77, s77, 3
s_lshl_b32 s77, s77, 11
s_add_u32 s28, s28, s77
s_add_u32 m0, s45, 0
s_nop 0
buffer_load_dwordx4 v240, s[84:87], s28 offen offset:0 sc1 lds
s_add_u32 m0, s45, 0
s_nop 0
buffer_load_dwordx4 v240, s[84:87], s28 offen offset:1024 sc1 lds
s_add_u32 m0, s45, 2048
s_nop 0
buffer_load_dwordx4 v241, s[84:87], s28 offen offset:0 sc1 lds
s_add_u32 m0, s45, 2048
s_nop 0
buffer_load_dwordx4 v241, s[84:87], s28 offen offset:1024 sc1 lds
s_add_u32 s45, s45, 4096
s_cmp_eq_u32 s45, 30720
s_cselect_b32 s45, 18432, s45
s_waitcnt vmcnt(0) lgkmcnt(0)
s_branch mega_kernel_rs_pfj
mega_kernel_rs_pfi:
s_lshr_b32 s88, s25, 2
s_lshl_b32 s88, s88, 17
s_and_b32 s77, s25, 2
s_lshl_b32 s77, s77, 13
s_add_u32 s88, s88, s77
s_and_b32 s77, s25, 1
s_lshl_b32 s77, s77, 12
s_add_u32 s88, s88, s77
s_xor_b32 s77, s98, 0
s_lshl_b32 s77, s77, 13
s_add_u32 s88, s88, s77
s_add_u32 s88, s88, 68255744
s_lshl_b32 s77, s26, 10
s_add_u32 s88, s88, s77
mega_kernel_rs_pfj:
v_mov_b32 v184, 0
v_mov_b32 v185, 0
v_mov_b32 v186, 0
v_mov_b32 v187, 0
v_mov_b32 v188, 0
v_mov_b32 v189, 0
v_mov_b32 v190, 0
v_mov_b32 v191, 0
v_mov_b32 v192, 0
v_mov_b32 v193, 0
v_mov_b32 v194, 0
v_mov_b32 v195, 0
v_mov_b32 v196, 0
v_mov_b32 v197, 0
v_mov_b32 v198, 0
v_mov_b32 v199, 0
v_mov_b32 v200, 0
v_mov_b32 v201, 0
v_mov_b32 v202, 0
v_mov_b32 v203, 0
v_mov_b32 v204, 0
v_mov_b32 v205, 0
v_mov_b32 v206, 0
v_mov_b32 v207, 0
v_mov_b32 v249, 0
s_barrier
s_and_b32 s29, s27, 1
s_lshl_b32 s33, s29, 17
s_lshl_b32 s28, s30, 18
s_add_u32 s33, s33, s28
s_add_u32 s33, s33, 68157440
s_xor_b32 s34, s33, 131072
s_lshl_b32 s35, s29, 18
s_bfe_u32 s47, s27, 0x10001
s_branch mega_kernel_rs_first
.p2align 6
s_nop 0
s_nop 0
mega_kernel_rs_loop:
buffer_load_dwordx4 v[32:35], v7, s[84:87], s33 offen offset:0 sc1
v_add_u32 v5, s44, v17
ds_read_b128 v[156:159], v5 offset:0
ds_read_b128 v[160:163], v5 offset:1024
ds_read_b128 v[164:167], v5 offset:2048
ds_read_b128 v[168:171], v5 offset:3072
s_nop 4
buffer_load_dwordx4 v[36:39], v7, s[84:87], s33 offen offset:1024 sc1
s_nop 9
buffer_load_dwordx4 v[40:43], v7, s[84:87], s33 offen offset:2048 sc1
s_nop 9
buffer_load_dwordx4 v[44:47], v7, s[84:87], s33 offen offset:3072 sc1
s_waitcnt vmcnt(3)
v_max_u32 v4, v32, v34
v_cmp_eq_u32 vcc, -1, v4
s_cbranch_vccnz mega_kernel_rs_pa_15_0f
v_smfmac_f32_16x16x64_bf16 v[96:99], v[32:35], a[0:7], v6
v_smfmac_f32_16x16x64_bf16 v[100:103], v[32:35], a[32:39], v6
v_smfmac_f32_16x16x64_bf16 v[104:107], v[32:35], a[64:71], v6
s_waitcnt vmcnt(2)
v_max_u32 v4, v36, v38
v_cmp_eq_u32 vcc, -1, v4
v_smfmac_f32_16x16x64_bf16 v[108:111], v[32:35], a[96:103], v6
s_cbranch_vccnz mega_kernel_rs_pa_14_1f
v_smfmac_f32_16x16x64_bf16 v[96:99], v[36:39], a[8:15], v6
v_smfmac_f32_16x16x64_bf16 v[100:103], v[36:39], a[40:47], v6
v_smfmac_f32_16x16x64_bf16 v[104:107], v[36:39], a[72:79], v6
s_waitcnt vmcnt(1)
v_max_u32 v4, v40, v42
v_cmp_eq_u32 vcc, -1, v4
v_smfmac_f32_16x16x64_bf16 v[108:111], v[36:39], a[104:111], v6
s_cbranch_vccnz mega_kernel_rs_pa_12_2f
v_smfmac_f32_16x16x64_bf16 v[96:99], v[40:43], a[16:23], v6
v_smfmac_f32_16x16x64_bf16 v[100:103], v[40:43], a[48:55], v6
v_smfmac_f32_16x16x64_bf16 v[104:107], v[40:43], a[80:87], v6
s_waitcnt vmcnt(0)
v_max_u32 v4, v44, v46
v_cmp_eq_u32 vcc, -1, v4
v_smfmac_f32_16x16x64_bf16 v[108:111], v[40:43], a[112:119], v6
s_cbranch_vccnz mega_kernel_rs_pa_8_3f
v_smfmac_f32_16x16x64_bf16 v[96:99], v[44:47], a[24:31], v6
v_smfmac_f32_16x16x64_bf16 v[100:103], v[44:47], a[56:63], v6
v_smfmac_f32_16x16x64_bf16 v[104:107], v[44:47], a[88:95], v6
v_smfmac_f32_16x16x64_bf16 v[108:111], v[44:47], a[120:127], v6
mega_kernel_rs_pa_d:
mega_kernel_rs_adone:
s_nop 5
v_permlane32_swap_b32 v96, v100
v_permlane32_swap_b32 v97, v101
v_permlane32_swap_b32 v98, v102
v_permlane32_swap_b32 v99, v103
v_pk_add_f32 v[96:97], v[96:97], v[100:101]
v_pk_add_f32 v[98:99], v[98:99], v[102:103]
ds_write2_b32 v14, v96, v97 offset0:0 offset1:36
ds_write2_b32 v14, v98, v99 offset0:72 offset1:108
v_permlane32_swap_b32 v104, v108
v_permlane32_swap_b32 v105, v109
v_permlane32_swap_b32 v106, v110
v_permlane32_swap_b32 v107, v111
v_pk_add_f32 v[104:105], v[104:105], v[108:109]
v_pk_add_f32 v[106:107], v[106:107], v[110:111]
ds_write2_b32 v15, v104, v105 offset0:0 offset1:36
ds_write2_b32 v15, v106, v107 offset0:72 offset1:108
v_smfmac_f32_16x16x64_bf16 v[112:115], v[32:35], a[128:135], v6
v_smfmac_f32_16x16x64_bf16 v[116:119], v[32:35], a[160:167], v6
v_smfmac_f32_16x16x64_bf16 v[112:115], v[36:39], a[136:143], v6
v_smfmac_f32_16x16x64_bf16 v[116:119], v[36:39], a[168:175], v6
s_waitcnt lgkmcnt(0)
s_barrier
s_cmp_lg_u32 s24, 0
s_cbranch_scc1 mega_kernel_rs_side
ds_read_b128 v[120:123], v16 offset:0
ds_read_b128 v[124:127], v16 offset:16
ds_read_b128 v[128:131], v16 offset:2304
ds_read_b128 v[132:135], v16 offset:2320
ds_read_b128 v[136:139], v16 offset:4608
ds_read_b128 v[140:143], v16 offset:4624
ds_read_b128 v[144:147], v16 offset:6912
ds_read_b128 v[148:151], v16 offset:6928
v_smfmac_f32_16x16x64_bf16 v[112:115], v[40:43], a[144:151], v6
v_smfmac_f32_16x16x64_bf16 v[116:119], v[40:43], a[176:183], v6
v_smfmac_f32_16x16x64_bf16 v[112:115], v[44:47], a[152:159], v6
v_smfmac_f32_16x16x64_bf16 v[116:119], v[44:47], a[184:191], v6
s_mul_i32 s28, s31, 1280
s_add_u32 s28, s28, s33
s_add_u32 s28, s28, 49152
s_add_u32 s76, s37, s33
s_add_u32 s77, s38, s33
s_add_u32 s78, s39, s33
s_waitcnt lgkmcnt(4)
v_pk_add_f32 v[120:121], v[120:121], v[128:129]
v_pk_add_f32 v[122:123], v[122:123], v[130:131]
v_pk_add_f32 v[124:125], v[124:125], v[132:133]
v_pk_add_f32 v[126:127], v[126:127], v[134:135]
s_waitcnt lgkmcnt(0)
v_pk_add_f32 v[136:137], v[136:137], v[144:145]
v_pk_add_f32 v[138:139], v[138:139], v[146:147]
v_pk_add_f32 v[140:141], v[140:141], v[148:149]
v_pk_add_f32 v[142:143], v[142:143], v[150:151]
v_pk_add_f32 v[120:121], v[120:121], v[136:137]
v_pk_add_f32 v[122:123], v[122:123], v[138:139]
v_pk_add_f32 v[124:125], v[124:125], v[140:141]
v_pk_add_f32 v[126:127], v[126:127], v[142:143]
v_cvt_pk_bf16_f32 v152, v120, v121
v_cvt_pk_bf16_f32 v153, v122, v123
v_cvt_pk_bf16_f32 v154, v124, v125
v_cvt_pk_bf16_f32 v155, v126, v127
s_nop 1
v_mfma_f32_16x16x32_bf16 v[176:179], v[160:163], v[152:155], 0
v_mfma_f32_16x16x32_bf16 v[172:175], v[156:159], v[152:155], 0
v_mfma_f32_16x16x32_bf16 v[180:183], v[152:155], v[152:155], 0
s_cmp_eq_u32 s27, 63
s_cbranch_scc1 mega_kernel_rs_w0last
s_nop 4
v_mov_b32_dpp v172, v176 row_shr:8 row_mask:0xf bank_mask:0xc
v_mov_b32_dpp v173, v177 row_shr:8 row_mask:0xf bank_mask:0xc
v_mov_b32_dpp v174, v178 row_shr:8 row_mask:0xf bank_mask:0xc
v_mov_b32_dpp v175, v179 row_shr:8 row_mask:0xf bank_mask:0xc
v_min_u32 v180, -2, v180
v_min_u32 v172, -2, v172
s_mov_b64 exec, s[42:43]
buffer_store_dwordx4 v[180:183], v10, s[84:87], s28 offen sc1
s_mov_b64 exec, -1
buffer_store_dwordx4 v[172:175], v17, s[84:87], s28 offen sc1
v_permlane32_swap_b32 v112, v116
v_permlane32_swap_b32 v113, v117
v_permlane32_swap_b32 v114, v118
v_permlane32_swap_b32 v115, v119
v_pk_add_f32 v[112:113], v[112:113], v[116:117]
v_pk_add_f32 v[114:115], v[114:115], v[118:119]
ds_write_b128 v20, v[112:115]
s_waitcnt lgkmcnt(0)
s_barrier
v_mov_b32 v96, 0
v_mov_b32 v97, 0
v_mov_b32 v98, 0
v_mov_b32 v99, 0
v_mov_b32 v100, 0
v_mov_b32 v101, 0
v_mov_b32 v102, 0
v_mov_b32 v103, 0
v_cndmask_b32 v176, v23, v180, s[42:43]
v_cndmask_b32 v177, v23, v181, s[42:43]
v_cndmask_b32 v178, v23, v182, s[42:43]
v_cndmask_b32 v179, v23, v183, s[42:43]
s_mov_b64 exec, s[42:43]
buffer_load_dwordx4 v[188:191], v10, s[84:87], s76 offen sc1
buffer_load_dwordx4 v[196:199], v10, s[84:87], s77 offen sc1
buffer_load_dwordx4 v[204:207], v10, s[84:87], s78 offen sc1
s_mov_b64 exec, -1
buffer_load_dwordx4 v[184:187], v17, s[84:87], s76 offen sc1
buffer_load_dwordx4 v[192:195], v17, s[84:87], s77 offen sc1
buffer_load_dwordx4 v[200:203], v17, s[84:87], s78 offen sc1
v_pk_mul_f32 v[172:173], v[172:173], s[32:33] op_sel_hi:[1,0]
v_pk_mul_f32 v[174:175], v[174:175], s[32:33] op_sel_hi:[1,0]
v_pk_mul_f32 v[176:177], v[176:177], s[32:33] op_sel_hi:[1,0]
v_pk_mul_f32 v[178:179], v[178:179], s[32:33] op_sel_hi:[1,0]
s_lshl_b32 s89, s47, 31
s_or_b32 s89, s89, 0x3b39999a
s_nop 15
s_nop 1
s_mov_b64 exec, s[42:43]
buffer_load_dwordx4 v[188:191], v10, s[84:87], s76 offen sc1
buffer_load_dwordx4 v[196:199], v10, s[84:87], s77 offen sc1
buffer_load_dwordx4 v[204:207], v10, s[84:87], s78 offen sc1
s_mov_b64 exec, -1
buffer_load_dwordx4 v[184:187], v17, s[84:87], s76 offen sc1
buffer_load_dwordx4 v[192:195], v17, s[84:87], s77 offen sc1
buffer_load_dwordx4 v[200:203], v17, s[84:87], s78 offen sc1
mega_kernel_rs_p2:
s_waitcnt vmcnt(6)
v_max3_u32 v4, v184, v188, v192
v_max3_u32 v5, v196, v200, v204
v_max_u32 v4, v4, v5
v_cmp_eq_u32 vcc, -1, v4
s_cbranch_vccnz mega_kernel_rs_p2r
v_pk_add_f32 v[124:125], v[196:197], v[204:205]
v_pk_add_f32 v[126:127], v[198:199], v[206:207]
v_pk_add_f32 v[120:121], v[192:193], v[200:201]
v_pk_add_f32 v[122:123], v[194:195], v[202:203]
v_pk_add_f32 v[124:125], v[124:125], v[188:189]
v_pk_add_f32 v[126:127], v[126:127], v[190:191]
v_pk_add_f32 v[120:121], v[120:121], v[184:185]
v_pk_add_f32 v[122:123], v[122:123], v[186:187]
v_pk_fma_f32 v[176:177], v[124:125], s[32:33], v[176:177] op_sel_hi:[1,0,1]
v_pk_fma_f32 v[178:179], v[126:127], s[32:33], v[178:179] op_sel_hi:[1,0,1]
v_pk_fma_f32 v[172:173], v[120:121], s[32:33], v[172:173] op_sel_hi:[1,0,1]
v_pk_fma_f32 v[174:175], v[122:123], s[32:33], v[174:175] op_sel_hi:[1,0,1]
v_max3_f32 v232, v172, v173, v174
v_max3_f32 v233, v176, v177, v178
v_max3_f32 v232, v232, v175, v179
v_max_f32 v234, v232, v233
s_barrier
ds_read2_b64 v[208:211], v21 offset0:0 offset1:32
v_max_f32_dpp v232, v234, v234 row_ror:8 row_mask:0xf bank_mask:0xf
v_max_f32_dpp v233, v234, v234 row_ror:8 row_mask:0xf bank_mask:0xf
s_nop 1
v_permlane16_swap_b32 v232, v233
s_nop 0
v_max_f32 v234, v232, v233
v_max_f32 v235, v232, v233
s_nop 1
v_permlane32_swap_b32 v234, v235
s_nop 0
v_max_f32 v232, v234, v235
v_pk_add_f32 v[176:177], v[176:177], v[232:233] op_sel_hi:[1,0] neg_lo:[0,1] neg_hi:[0,1]
v_pk_add_f32 v[178:179], v[178:179], v[232:233] op_sel_hi:[1,0] neg_lo:[0,1] neg_hi:[0,1]
v_pk_add_f32 v[172:173], v[172:173], v[232:233] op_sel_hi:[1,0] neg_lo:[0,1] neg_hi:[0,1]
v_pk_add_f32 v[174:175], v[174:175], v[232:233] op_sel_hi:[1,0] neg_lo:[0,1] neg_hi:[0,1]
v_exp_f32 v176, v176
v_exp_f32 v177, v177
v_exp_f32 v178, v178
v_exp_f32 v179, v179
v_exp_f32 v172, v172
v_cvt_pk_bf16_f32 v216, v176, v177
v_cvt_pk_bf16_f32 v217, v178, v179
v_exp_f32 v173, v173
v_exp_f32 v174, v174
v_mfma_f32_16x16x16_bf16 v[224:227], v[220:221], v[216:217], 0
v_exp_f32 v175, v175
v_cvt_pk_bf16_f32 v212, v172, v173
s_waitcnt lgkmcnt(0)
v_mfma_f32_16x16x16_bf16 v[120:123], v[208:209], v[216:217], 0
v_cvt_pk_bf16_f32 v213, v174, v175
v_mfma_f32_16x16x16_bf16 v[124:127], v[210:211], v[216:217], 0
v_mov_b32_dpp v214, v212 row_ror:8 row_mask:0xf bank_mask:0xf
v_mov_b32_dpp v215, v213 row_ror:8 row_mask:0xf bank_mask:0xf
s_nop 1
v_mfma_f32_16x16x32_bf16 v[224:227], v[220:223], v[212:215], v[224:227]
v_mfma_f32_16x16x32_bf16 v[120:123], v[164:167], v[212:215], v[120:123]
v_mfma_f32_16x16x32_bf16 v[124:127], v[168:171], v[212:215], v[124:127]
s_add_u32 s29, s33, 24576
s_nop 4
v_rcp_f32 v234, v224
s_nop 0
v_pk_mul_f32 v[120:121], v[120:121], v[234:235] op_sel_hi:[1,0]
v_pk_mul_f32 v[122:123], v[122:123], v[234:235] op_sel_hi:[1,0]
v_pk_mul_f32 v[124:125], v[124:125], v[234:235] op_sel_hi:[1,0]
v_pk_mul_f32 v[126:127], v[126:127], v[234:235] op_sel_hi:[1,0]
v_cvt_pk_bf16_f32 v212, v120, v121
v_cvt_pk_bf16_f32 v213, v122, v123
v_cvt_pk_bf16_f32 v214, v124, v125
v_cvt_pk_bf16_f32 v215, v126, v127
v_min_u32 v212, -2, v212
s_mov_b64 exec, s[40:41]
buffer_store_dwordx4 v[212:215], v11, s[84:87], s33 offen sc1
s_mov_b64 exec, -1
mega_kernel_rs_b3:
s_barrier
s_nop 15
buffer_load_dwordx4 v[32:35], v7, s[84:87], s29 offen offset:0 sc1
s_nop 9
buffer_load_dwordx4 v[36:39], v7, s[84:87], s29 offen offset:1024 sc1
s_nop 9
buffer_load_dwordx4 v[40:43], v7, s[84:87], s29 offen offset:2048 sc1
s_nop 9
buffer_load_dwordx4 v[44:47], v7, s[84:87], s29 offen offset:3072 sc1
mega_kernel_rs_pc_15_0:
s_waitcnt vmcnt(3)
v_cmp_eq_u32 vcc, -1, v32
s_cbranch_vccnz mega_kernel_rs_pc_15_0f
v_smfmac_f32_16x16x64_bf16 v[96:99], v[32:35], a[192:199], v6
v_smfmac_f32_16x16x64_bf16 v[100:103], v[32:35], a[224:231], v6
mega_kernel_rs_pc_14_1:
s_waitcnt vmcnt(2)
v_cmp_eq_u32 vcc, -1, v36
s_cbranch_vccnz mega_kernel_rs_pc_14_1f
v_smfmac_f32_16x16x64_bf16 v[96:99], v[36:39], a[200:207], v6
v_smfmac_f32_16x16x64_bf16 v[100:103], v[36:39], a[232:239], v6
mega_kernel_rs_pc_12_2:
s_waitcnt vmcnt(1)
v_cmp_eq_u32 vcc, -1, v40
s_cbranch_vccnz mega_kernel_rs_pc_12_2f
v_smfmac_f32_16x16x64_bf16 v[96:99], v[40:43], a[208:215], v6
v_smfmac_f32_16x16x64_bf16 v[100:103], v[40:43], a[240:247], v6
mega_kernel_rs_pc_8_3:
s_waitcnt vmcnt(0)
v_cmp_eq_u32 vcc, -1, v44
s_cbranch_vccnz mega_kernel_rs_pc_8_3f
v_smfmac_f32_16x16x64_bf16 v[96:99], v[44:47], a[216:223], v6
v_smfmac_f32_16x16x64_bf16 v[100:103], v[44:47], a[248:255], v6
mega_kernel_rs_pc_d:
s_nop 7
v_permlane32_swap_b32 v96, v100
v_permlane32_swap_b32 v97, v101
v_permlane32_swap_b32 v98, v102
v_permlane32_swap_b32 v99, v103
v_pk_add_f32 v[96:97], v[96:97], v[100:101]
v_pk_add_f32 v[98:99], v[98:99], v[102:103]
ds_write2_b32 v18, v96, v97 offset0:0 offset1:36
ds_write2_b32 v18, v98, v99 offset0:72 offset1:108
s_waitcnt lgkmcnt(0)
s_barrier
s_cmp_lg_u32 s24, 0
s_cbranch_scc1 mega_kernel_rs_x1
ds_read_b128 v[120:123], v19 offset:0
ds_read_b128 v[124:127], v19 offset:1152
ds_read_b128 v[128:131], v19 offset:2304
ds_read_b128 v[132:135], v19 offset:3456
s_waitcnt lgkmcnt(2)
v_pk_add_f32 v[120:121], v[120:121], v[124:125]
v_pk_add_f32 v[122:123], v[122:123], v[126:127]
s_waitcnt lgkmcnt(0)
v_pk_add_f32 v[128:129], v[128:129], v[132:133]
v_pk_add_f32 v[130:131], v[130:131], v[134:135]
v_pk_add_f32 v[120:121], v[120:121], v[128:129]
v_pk_add_f32 v[122:123], v[122:123], v[130:131]
v_fma_f32 v212, v120, s89, v120
v_cvt_pk_bf16_f32 v213, v122, v123
v_cvt_pk_bf16_f32 v212, v212, v121
v_and_or_b32 v212, v212, -2, s47
buffer_store_dwordx2 v[212:213], v12, s[84:87], s35 offen sc1
s_mov_b32 s77, 0x3f80
s_mov_b32 s78, 0x3f800000
s_xor_b32 s76, s47, 1
v_mov_b32 v48, s76
v_mov_b32 v50, s76
v_mov_b32 v52, s76
s_nop 8
v_mov_b32 v96, 0
v_mov_b32 v97, 0
v_mov_b32 v98, 0
v_mov_b32 v99, 0
v_mov_b32 v100, 0
v_mov_b32 v101, 0
v_mov_b32 v102, 0
v_mov_b32 v103, 0
v_mov_b32 v104, 0
v_mov_b32 v105, 0
v_mov_b32 v106, 0
v_mov_b32 v107, 0
v_mov_b32 v108, 0
v_mov_b32 v109, 0
v_mov_b32 v110, 0
v_mov_b32 v111, 0
v_mov_b32 v112, 0
v_mov_b32 v113, 0
v_mov_b32 v114, 0
v_mov_b32 v115, 0
v_mov_b32 v116, 0
v_mov_b32 v117, 0
v_mov_b32 v118, 0
v_mov_b32 v119, 0
s_nop 15
s_nop 7
s_cmp_eq_u32 s47, 1
s_cbranch_scc1 mega_kernel_rs_p4_1
.p2align 6
mega_kernel_rs_p4_0:
buffer_load_dwordx2 v[48:49], v25, s[84:87], s35 offen sc1
buffer_load_dwordx2 v[50:51], v26, s[84:87], s35 offen sc1
buffer_load_dwordx2 v[52:53], v27, s[84:87], s35 offen sc1
s_waitcnt vmcnt(12)
mega_kernel_rs_p4c_0:
v_bitop3_b32 v4, v48, v50, v52 bitop3:0xfe
v_and_b32 v4, 1, v4
v_cmp_ne_u32 vcc, 0, v4
s_cbranch_vccnz mega_kernel_rs_p4_0
v_dot2_f32_bf16 v120, v48, s77, v120
v_dot2_f32_bf16 v121, v48, s78, v121
v_dot2_f32_bf16 v122, v49, s77, v122
v_dot2_f32_bf16 v123, v49, s78, v123
v_dot2_f32_bf16 v120, v50, s77, v120
v_dot2_f32_bf16 v121, v50, s78, v121
v_dot2_f32_bf16 v122, v51, s77, v122
v_dot2_f32_bf16 v123, v51, s78, v123
v_dot2_f32_bf16 v120, v52, s77, v120
v_dot2_f32_bf16 v121, v52, s78, v121
v_dot2_f32_bf16 v122, v53, s77, v122
v_dot2_f32_bf16 v123, v53, s78, v123
s_nop 0
v_cvt_pk_bf16_f32 v212, v120, v121
v_min_u32 v212, -2, v212
v_cvt_pk_bf16_f32 v213, v122, v123
buffer_store_dwordx2 v[212:213], v9, s[84:87], s34 offen sc1
s_branch mega_kernel_rs_p4d
mega_kernel_rs_iw0:
mega_kernel_rs_il0:
s_cbranch_execz mega_kernel_rs_il1
.p2align 6
mega_kernel_rs_p4_1:
buffer_load_dwordx2 v[48:49], v25, s[84:87], s35 offen sc1
buffer_load_dwordx2 v[50:51], v26, s[84:87], s35 offen sc1
buffer_load_dwordx2 v[52:53], v27, s[84:87], s35 offen sc1
s_waitcnt vmcnt(12)
mega_kernel_rs_p4c_1:
v_bitop3_b32 v4, v48, v50, v52 bitop3:0x80
v_and_b32 v4, 1, v4
v_cmp_ne_u32 vcc, 1, v4
s_cbranch_vccnz mega_kernel_rs_p4_1
v_dot2_f32_bf16 v120, v48, s77, v120
v_dot2_f32_bf16 v121, v48, s78, v121
v_dot2_f32_bf16 v122, v49, s77, v122
v_dot2_f32_bf16 v123, v49, s78, v123
v_dot2_f32_bf16 v120, v50, s77, v120
v_dot2_f32_bf16 v121, v50, s78, v121
v_dot2_f32_bf16 v122, v51, s77, v122
v_dot2_f32_bf16 v123, v51, s78, v123
v_dot2_f32_bf16 v120, v52, s77, v120
v_dot2_f32_bf16 v121, v52, s78, v121
v_dot2_f32_bf16 v122, v53, s77, v122
v_dot2_f32_bf16 v123, v53, s78, v123
s_nop 0
v_cvt_pk_bf16_f32 v212, v120, v121
v_min_u32 v212, -2, v212
v_cvt_pk_bf16_f32 v213, v122, v123
buffer_store_dwordx2 v[212:213], v9, s[84:87], s34 offen sc1
mega_kernel_rs_p4d:
mega_kernel_rs_b5:
s_add_u32 s27, s27, 1
s_add_u32 s44, s44, 4096
s_cmp_eq_u32 s44, 30720
s_cselect_b32 s44, 18432, s44
s_mov_b32 s28, s33
s_mov_b32 s33, s34
s_mov_b32 s34, s28
s_xor_b32 s35, s35, 262144
s_bfe_u32 s47, s27, 0x10001
s_barrier
s_nop 15
s_branch mega_kernel_rs_loop
mega_kernel_rs_il1:
s_cbranch_execz mega_kernel_rs_il2
mega_kernel_rs_x1:
s_cmp_eq_u32 s24, 1
s_cbranch_scc0 mega_kernel_rs_x2
s_add_u32 s76, s27, 1
s_sleep 6
v_mov_b32 v5, s76
s_mov_b64 exec, 1
buffer_store_dword v5, v228, s[84:87], s81 offen sc1
s_mov_b64 exec, -1
mega_kernel_rs_x2:
s_cmp_eq_u32 s24, 3
s_cbranch_scc0 mega_kernel_rs_x4
s_cmp_eq_u32 s36, 1
s_cbranch_scc0 mega_kernel_rs_x5
s_add_u32 s76, s27, 1
s_cmp_gt_i32 s46, s76
s_cbranch_scc1 mega_kernel_rs_pf1ok
mega_kernel_rs_pf1w:
v_mov_b32 v4, 0
s_mov_b64 exec, 3
buffer_atomic_add v4, v24, s[84:87], 0 offen sc0 sc1
s_mov_b64 exec, -1
s_waitcnt vmcnt(0)
v_readlane_b32 s46, v4, 0
v_readlane_b32 s28, v4, 1
s_nop 1
s_min_i32 s46, s46, s28
s_cmp_gt_i32 s46, s76
s_cbranch_scc0 mega_kernel_rs_pf1w
mega_kernel_rs_pf1ok:
s_add_u32 s77, s76, s82
s_bfe_u32 s28, s77, 0x40002
s_lshl_b32 s28, s28, 14
s_and_b32 s77, s77, 3
s_lshl_b32 s77, s77, 11
s_add_u32 s28, s28, s77
s_add_u32 m0, s45, 0
s_nop 0
buffer_load_dwordx4 v240, s[84:87], s28 offen offset:0 sc1 lds
s_add_u32 m0, s45, 0
s_nop 0
buffer_load_dwordx4 v240, s[84:87], s28 offen offset:1024 sc1 lds
s_add_u32 m0, s45, 2048
s_nop 0
buffer_load_dwordx4 v241, s[84:87], s28 offen offset:0 sc1 lds
s_add_u32 m0, s45, 2048
s_nop 0
buffer_load_dwordx4 v241, s[84:87], s28 offen offset:1024 sc1 lds
s_add_u32 s45, s45, 4096
s_cmp_eq_u32 s45, 30720
s_cselect_b32 s45, 18432, s45
s_waitcnt vmcnt(0)
mega_kernel_rs_x5:
s_add_u32 s76, s27, 4
s_min_u32 s76, s76, 63
s_cmp_gt_i32 s46, s76
s_cbranch_scc1 mega_kernel_rs_x6
v_mov_b32 v249, 0
s_mov_b64 exec, 3
buffer_atomic_add v249, v24, s[84:87], 0 offen sc0 sc1
s_mov_b64 exec, -1
mega_kernel_rs_x6:
s_add_u32 s76, s27, 2
s_cmp_lt_u32 s76, 63
s_cbranch_scc0 mega_kernel_rs_x4
s_cmp_gt_i32 s46, s76
s_cbranch_scc0 mega_kernel_rs_x4
s_add_u32 s77, s76, s82
s_bfe_u32 s28, s77, 0x40002
s_lshl_b32 s28, s28, 14
s_and_b32 s77, s77, 3
s_lshl_b32 s77, s77, 11
s_add_u32 s28, s28, s77
s_add_u32 s28, s28, s83
s_add_u32 s28, s28, 33554432
s_buffer_load_dword s78, s[84:87], s28 offset:0
s_buffer_load_dword s78, s[84:87], s28 offset:128
s_buffer_load_dword s78, s[84:87], s28 offset:256
s_buffer_load_dword s78, s[84:87], s28 offset:384
s_buffer_load_dword s78, s[84:87], s28 offset:512
s_buffer_load_dword s78, s[84:87], s28 offset:640
s_buffer_load_dword s78, s[84:87], s28 offset:768
s_buffer_load_dword s78, s[84:87], s28 offset:896
s_buffer_load_dword s78, s[84:87], s28 offset:1024
s_buffer_load_dword s78, s[84:87], s28 offset:1152
s_buffer_load_dword s78, s[84:87], s28 offset:1280
s_buffer_load_dword s78, s[84:87], s28 offset:1408
s_buffer_load_dword s78, s[84:87], s28 offset:1536
s_buffer_load_dword s78, s[84:87], s28 offset:1664
s_buffer_load_dword s78, s[84:87], s28 offset:1792
s_buffer_load_dword s78, s[84:87], s28 offset:1920
mega_kernel_rs_x4:
v_mov_b32 v96, 0
v_mov_b32 v97, 0
v_mov_b32 v98, 0
v_mov_b32 v99, 0
v_mov_b32 v100, 0
v_mov_b32 v101, 0
v_mov_b32 v102, 0
v_mov_b32 v103, 0
v_mov_b32 v104, 0
v_mov_b32 v105, 0
v_mov_b32 v106, 0
v_mov_b32 v107, 0
v_mov_b32 v108, 0
v_mov_b32 v109, 0
v_mov_b32 v110, 0
v_mov_b32 v111, 0
v_mov_b32 v112, 0
v_mov_b32 v113, 0
v_mov_b32 v114, 0
v_mov_b32 v115, 0
v_mov_b32 v116, 0
v_mov_b32 v117, 0
v_mov_b32 v118, 0
v_mov_b32 v119, 0
s_branch mega_kernel_rs_b5
mega_kernel_rs_il2:
s_cbranch_execz mega_kernel_rs_il3
mega_kernel_rs_p2r:
s_mov_b64 exec, s[42:43]
buffer_load_dwordx4 v[188:191], v10, s[84:87], s76 offen sc1
buffer_load_dwordx4 v[196:199], v10, s[84:87], s77 offen sc1
buffer_load_dwordx4 v[204:207], v10, s[84:87], s78 offen sc1
s_mov_b64 exec, -1
buffer_load_dwordx4 v[184:187], v17, s[84:87], s76 offen sc1
buffer_load_dwordx4 v[192:195], v17, s[84:87], s77 offen sc1
buffer_load_dwordx4 v[200:203], v17, s[84:87], s78 offen sc1
s_branch mega_kernel_rs_p2
mega_kernel_rs_il3:
s_cbranch_execz mega_kernel_rs_il4
.p2align 5
mega_kernel_rs_pa_1_0f:
s_mov_b64 exec, vcc
buffer_load_dwordx4 v[32:35], v7, s[84:87], s33 offen offset:0 sc1
s_mov_b64 exec, -1
s_branch mega_kernel_rs_pa_1_0
.p2align 5
mega_kernel_rs_pa_1_0:
s_waitcnt vmcnt(0)
v_max_u32 v4, v32, v34
v_cmp_eq_u32 vcc, -1, v4
s_cbranch_vccnz mega_kernel_rs_pa_1_0f
v_smfmac_f32_16x16x64_bf16 v[96:99], v[32:35], a[0:7], v6
v_smfmac_f32_16x16x64_bf16 v[100:103], v[32:35], a[32:39], v6
v_smfmac_f32_16x16x64_bf16 v[104:107], v[32:35], a[64:71], v6
v_smfmac_f32_16x16x64_bf16 v[108:111], v[32:35], a[96:103], v6
s_branch mega_kernel_rs_pa_d
mega_kernel_rs_il4:
s_cbranch_execz mega_kernel_rs_il5
.p2align 5
mega_kernel_rs_pa_2_1f:
s_mov_b64 exec, vcc
buffer_load_dwordx4 v[36:39], v7, s[84:87], s33 offen offset:1024 sc1
s_mov_b64 exec, -1
s_branch mega_kernel_rs_pa_2_1
.p2align 5
mega_kernel_rs_pa_2_1:
s_waitcnt vmcnt(0)
v_max_u32 v4, v36, v38
v_cmp_eq_u32 vcc, -1, v4
s_cbranch_vccnz mega_kernel_rs_pa_2_1f
v_smfmac_f32_16x16x64_bf16 v[96:99], v[36:39], a[8:15], v6
v_smfmac_f32_16x16x64_bf16 v[100:103], v[36:39], a[40:47], v6
v_smfmac_f32_16x16x64_bf16 v[104:107], v[36:39], a[72:79], v6
v_smfmac_f32_16x16x64_bf16 v[108:111], v[36:39], a[104:111], v6
s_branch mega_kernel_rs_pa_d
mega_kernel_rs_il5:
s_cbranch_execz mega_kernel_rs_il6
.p2align 5
mega_kernel_rs_pa_3_0f:
s_mov_b64 exec, vcc
buffer_load_dwordx4 v[32:35], v7, s[84:87], s33 offen offset:0 sc1
s_mov_b64 exec, -1
s_branch mega_kernel_rs_pa_3_1
.p2align 5
mega_kernel_rs_pa_3_0:
s_waitcnt vmcnt(1)
v_max_u32 v4, v32, v34
v_cmp_eq_u32 vcc, -1, v4
s_cbranch_vccnz mega_kernel_rs_pa_3_0f
v_smfmac_f32_16x16x64_bf16 v[96:99], v[32:35], a[0:7], v6
v_smfmac_f32_16x16x64_bf16 v[100:103], v[32:35], a[32:39], v6
v_smfmac_f32_16x16x64_bf16 v[104:107], v[32:35], a[64:71], v6
v_smfmac_f32_16x16x64_bf16 v[108:111], v[32:35], a[96:103], v6
s_branch mega_kernel_rs_pa_2_1
mega_kernel_rs_il6:
s_cbranch_execz mega_kernel_rs_il7
.p2align 5
mega_kernel_rs_pa_3_1f:
s_mov_b64 exec, vcc
buffer_load_dwordx4 v[36:39], v7, s[84:87], s33 offen offset:1024 sc1
s_mov_b64 exec, -1
s_branch mega_kernel_rs_pa_3_0
.p2align 5
mega_kernel_rs_pa_3_1:
s_waitcnt vmcnt(1)
v_max_u32 v4, v36, v38
v_cmp_eq_u32 vcc, -1, v4
s_cbranch_vccnz mega_kernel_rs_pa_3_1f
v_smfmac_f32_16x16x64_bf16 v[96:99], v[36:39], a[8:15], v6
v_smfmac_f32_16x16x64_bf16 v[100:103], v[36:39], a[40:47], v6
v_smfmac_f32_16x16x64_bf16 v[104:107], v[36:39], a[72:79], v6
v_smfmac_f32_16x16x64_bf16 v[108:111], v[36:39], a[104:111], v6
s_branch mega_kernel_rs_pa_1_0
mega_kernel_rs_il7:
s_cbranch_execz mega_kernel_rs_il8
.p2align 5
mega_kernel_rs_pa_4_2f:
s_mov_b64 exec, vcc
buffer_load_dwordx4 v[40:43], v7, s[84:87], s33 offen offset:2048 sc1
s_mov_b64 exec, -1
s_branch mega_kernel_rs_pa_4_2
.p2align 5
mega_kernel_rs_pa_4_2:
s_waitcnt vmcnt(0)
v_max_u32 v4, v40, v42
v_cmp_eq_u32 vcc, -1, v4
s_cbranch_vccnz mega_kernel_rs_pa_4_2f
v_smfmac_f32_16x16x64_bf16 v[96:99], v[40:43], a[16:23], v6
v_smfmac_f32_16x16x64_bf16 v[100:103], v[40:43], a[48:55], v6
v_smfmac_f32_16x16x64_bf16 v[104:107], v[40:43], a[80:87], v6
v_smfmac_f32_16x16x64_bf16 v[108:111], v[40:43], a[112:119], v6
s_branch mega_kernel_rs_pa_d
mega_kernel_rs_il8:
s_cbranch_execz mega_kernel_rs_il9
.p2align 5
mega_kernel_rs_pa_5_0f:
s_mov_b64 exec, vcc
buffer_load_dwordx4 v[32:35], v7, s[84:87], s33 offen offset:0 sc1
s_mov_b64 exec, -1
s_branch mega_kernel_rs_pa_5_2
.p2align 5
mega_kernel_rs_pa_5_0:
s_waitcnt vmcnt(1)
v_max_u32 v4, v32, v34
v_cmp_eq_u32 vcc, -1, v4
s_cbranch_vccnz mega_kernel_rs_pa_5_0f
v_smfmac_f32_16x16x64_bf16 v[96:99], v[32:35], a[0:7], v6
v_smfmac_f32_16x16x64_bf16 v[100:103], v[32:35], a[32:39], v6
v_smfmac_f32_16x16x64_bf16 v[104:107], v[32:35], a[64:71], v6
v_smfmac_f32_16x16x64_bf16 v[108:111], v[32:35], a[96:103], v6
s_branch mega_kernel_rs_pa_4_2
mega_kernel_rs_il9:
s_cbranch_execz mega_kernel_rs_il10
.p2align 5
mega_kernel_rs_pa_5_2f:
s_mov_b64 exec, vcc
buffer_load_dwordx4 v[40:43], v7, s[84:87], s33 offen offset:2048 sc1
s_mov_b64 exec, -1
s_branch mega_kernel_rs_pa_5_0
.p2align 5
mega_kernel_rs_pa_5_2:
s_waitcnt vmcnt(1)
v_max_u32 v4, v40, v42
v_cmp_eq_u32 vcc, -1, v4
s_cbranch_vccnz mega_kernel_rs_pa_5_2f
v_smfmac_f32_16x16x64_bf16 v[96:99], v[40:43], a[16:23], v6
v_smfmac_f32_16x16x64_bf16 v[100:103], v[40:43], a[48:55], v6
v_smfmac_f32_16x16x64_bf16 v[104:107], v[40:43], a[80:87], v6
v_smfmac_f32_16x16x64_bf16 v[108:111], v[40:43], a[112:119], v6
s_branch mega_kernel_rs_pa_1_0
mega_kernel_rs_il10:
s_cbranch_execz mega_kernel_rs_il11
.p2align 5
mega_kernel_rs_pa_6_1f:
s_mov_b64 exec, vcc
buffer_load_dwordx4 v[36:39], v7, s[84:87], s33 offen offset:1024 sc1
s_mov_b64 exec, -1
s_branch mega_kernel_rs_pa_6_2
.p2align 5
mega_kernel_rs_pa_6_1:
s_waitcnt vmcnt(1)
v_max_u32 v4, v36, v38
v_cmp_eq_u32 vcc, -1, v4
s_cbranch_vccnz mega_kernel_rs_pa_6_1f
v_smfmac_f32_16x16x64_bf16 v[96:99], v[36:39], a[8:15], v6
v_smfmac_f32_16x16x64_bf16 v[100:103], v[36:39], a[40:47], v6
v_smfmac_f32_16x16x64_bf16 v[104:107], v[36:39], a[72:79], v6
v_smfmac_f32_16x16x64_bf16 v[108:111], v[36:39], a[104:111], v6
s_branch mega_kernel_rs_pa_4_2
mega_kernel_rs_il11:
s_cbranch_execz mega_kernel_rs_il12
.p2align 5
mega_kernel_rs_pa_6_2f:
s_mov_b64 exec, vcc
buffer_load_dwordx4 v[40:43], v7, s[84:87], s33 offen offset:2048 sc1
s_mov_b64 exec, -1
s_branch mega_kernel_rs_pa_6_1
.p2align 5
mega_kernel_rs_pa_6_2:
s_waitcnt vmcnt(1)
v_max_u32 v4, v40, v42
v_cmp_eq_u32 vcc, -1, v4
s_cbranch_vccnz mega_kernel_rs_pa_6_2f
v_smfmac_f32_16x16x64_bf16 v[96:99], v[40:43], a[16:23], v6
v_smfmac_f32_16x16x64_bf16 v[100:103], v[40:43], a[48:55], v6
v_smfmac_f32_16x16x64_bf16 v[104:107], v[40:43], a[80:87], v6
v_smfmac_f32_16x16x64_bf16 v[108:111], v[40:43], a[112:119], v6
s_branch mega_kernel_rs_pa_2_1
mega_kernel_rs_il12:
s_cbranch_execz mega_kernel_rs_il13
.p2align 5
mega_kernel_rs_pa_7_0f:
s_mov_b64 exec, vcc
buffer_load_dwordx4 v[32:35], v7, s[84:87], s33 offen offset:0 sc1
s_mov_b64 exec, -1
s_branch mega_kernel_rs_pa_7_1
.p2align 5
mega_kernel_rs_pa_7_0:
s_waitcnt vmcnt(2)
v_max_u32 v4, v32, v34
v_cmp_eq_u32 vcc, -1, v4
s_cbranch_vccnz mega_kernel_rs_pa_7_0f
v_smfmac_f32_16x16x64_bf16 v[96:99], v[32:35], a[0:7], v6
v_smfmac_f32_16x16x64_bf16 v[100:103], v[32:35], a[32:39], v6
v_smfmac_f32_16x16x64_bf16 v[104:107], v[32:35], a[64:71], v6
v_smfmac_f32_16x16x64_bf16 v[108:111], v[32:35], a[96:103], v6
s_branch mega_kernel_rs_pa_6_1
mega_kernel_rs_il13:
s_cbranch_execz mega_kernel_rs_il14
.p2align 5
mega_kernel_rs_pa_7_1f:
s_mov_b64 exec, vcc
buffer_load_dwordx4 v[36:39], v7, s[84:87], s33 offen offset:1024 sc1
s_mov_b64 exec, -1
s_branch mega_kernel_rs_pa_7_2
.p2align 5
mega_kernel_rs_pa_7_1:
s_waitcnt vmcnt(2)
v_max_u32 v4, v36, v38
v_cmp_eq_u32 vcc, -1, v4
s_cbranch_vccnz mega_kernel_rs_pa_7_1f
v_smfmac_f32_16x16x64_bf16 v[96:99], v[36:39], a[8:15], v6
v_smfmac_f32_16x16x64_bf16 v[100:103], v[36:39], a[40:47], v6
v_smfmac_f32_16x16x64_bf16 v[104:107], v[36:39], a[72:79], v6
v_smfmac_f32_16x16x64_bf16 v[108:111], v[36:39], a[104:111], v6
s_branch mega_kernel_rs_pa_5_2
mega_kernel_rs_il14:
s_cbranch_execz mega_kernel_rs_il15
.p2align 5
mega_kernel_rs_pa_7_2f:
s_mov_b64 exec, vcc
buffer_load_dwordx4 v[40:43], v7, s[84:87], s33 offen offset:2048 sc1
s_mov_b64 exec, -1
s_branch mega_kernel_rs_pa_7_0
.p2align 5
mega_kernel_rs_pa_7_2:
s_waitcnt vmcnt(2)
v_max_u32 v4, v40, v42
v_cmp_eq_u32 vcc, -1, v4
s_cbranch_vccnz mega_kernel_rs_pa_7_2f
v_smfmac_f32_16x16x64_bf16 v[96:99], v[40:43], a[16:23], v6
v_smfmac_f32_16x16x64_bf16 v[100:103], v[40:43], a[48:55], v6
v_smfmac_f32_16x16x64_bf16 v[104:107], v[40:43], a[80:87], v6
v_smfmac_f32_16x16x64_bf16 v[108:111], v[40:43], a[112:119], v6
s_branch mega_kernel_rs_pa_3_0
mega_kernel_rs_il15:
s_cbranch_execz mega_kernel_rs_il16
.p2align 5
mega_kernel_rs_pa_8_3f:
s_mov_b64 exec, vcc
buffer_load_dwordx4 v[44:47], v7, s[84:87], s33 offen offset:3072 sc1
s_mov_b64 exec, -1
s_branch mega_kernel_rs_pa_8_3
.p2align 5
mega_kernel_rs_pa_8_3:
s_waitcnt vmcnt(0)
v_max_u32 v4, v44, v46
v_cmp_eq_u32 vcc, -1, v4
s_cbranch_vccnz mega_kernel_rs_pa_8_3f
v_smfmac_f32_16x16x64_bf16 v[96:99], v[44:47], a[24:31], v6
v_smfmac_f32_16x16x64_bf16 v[100:103], v[44:47], a[56:63], v6
v_smfmac_f32_16x16x64_bf16 v[104:107], v[44:47], a[88:95], v6
v_smfmac_f32_16x16x64_bf16 v[108:111], v[44:47], a[120:127], v6
s_branch mega_kernel_rs_pa_d
mega_kernel_rs_il16:
s_cbranch_execz mega_kernel_rs_il17
.p2align 5
mega_kernel_rs_pa_9_0f:
s_mov_b64 exec, vcc
buffer_load_dwordx4 v[32:35], v7, s[84:87], s33 offen offset:0 sc1
s_mov_b64 exec, -1
s_branch mega_kernel_rs_pa_9_3
.p2align 5
mega_kernel_rs_pa_9_0:
s_waitcnt vmcnt(1)
v_max_u32 v4, v32, v34
v_cmp_eq_u32 vcc, -1, v4
s_cbranch_vccnz mega_kernel_rs_pa_9_0f
v_smfmac_f32_16x16x64_bf16 v[96:99], v[32:35], a[0:7], v6
v_smfmac_f32_16x16x64_bf16 v[100:103], v[32:35], a[32:39], v6
v_smfmac_f32_16x16x64_bf16 v[104:107], v[32:35], a[64:71], v6
v_smfmac_f32_16x16x64_bf16 v[108:111], v[32:35], a[96:103], v6
s_branch mega_kernel_rs_pa_8_3
mega_kernel_rs_il17:
s_cbranch_execz mega_kernel_rs_il18
.p2align 5
mega_kernel_rs_pa_9_3f:
s_mov_b64 exec, vcc
buffer_load_dwordx4 v[44:47], v7, s[84:87], s33 offen offset:3072 sc1
s_mov_b64 exec, -1
s_branch mega_kernel_rs_pa_9_0
.p2align 5
mega_kernel_rs_pa_9_3:
s_waitcnt vmcnt(1)
v_max_u32 v4, v44, v46
v_cmp_eq_u32 vcc, -1, v4
s_cbranch_vccnz mega_kernel_rs_pa_9_3f
v_smfmac_f32_16x16x64_bf16 v[96:99], v[44:47], a[24:31], v6
v_smfmac_f32_16x16x64_bf16 v[100:103], v[44:47], a[56:63], v6
v_smfmac_f32_16x16x64_bf16 v[104:107], v[44:47], a[88:95], v6
v_smfmac_f32_16x16x64_bf16 v[108:111], v[44:47], a[120:127], v6
s_branch mega_kernel_rs_pa_1_0
mega_kernel_rs_il18:
s_cbranch_execz mega_kernel_rs_iwd
.p2align 5
mega_kernel_rs_pa_10_1f:
s_mov_b64 exec, vcc
buffer_load_dwordx4 v[36:39], v7, s[84:87], s33 offen offset:1024 sc1
s_mov_b64 exec, -1
s_branch mega_kernel_rs_pa_10_3
.p2align 5
mega_kernel_rs_pa_10_1:
s_waitcnt vmcnt(1)
v_max_u32 v4, v36, v38
v_cmp_eq_u32 vcc, -1, v4
s_cbranch_vccnz mega_kernel_rs_pa_10_1f
v_smfmac_f32_16x16x64_bf16 v[96:99], v[36:39], a[8:15], v6
v_smfmac_f32_16x16x64_bf16 v[100:103], v[36:39], a[40:47], v6
v_smfmac_f32_16x16x64_bf16 v[104:107], v[36:39], a[72:79], v6
v_smfmac_f32_16x16x64_bf16 v[108:111], v[36:39], a[104:111], v6
s_branch mega_kernel_rs_pa_8_3
mega_kernel_rs_iw1:
mega_kernel_rs_il19:
s_cbranch_execz mega_kernel_rs_il20
.p2align 5
mega_kernel_rs_pa_10_3f:
s_mov_b64 exec, vcc
buffer_load_dwordx4 v[44:47], v7, s[84:87], s33 offen offset:3072 sc1
s_mov_b64 exec, -1
s_branch mega_kernel_rs_pa_10_1
.p2align 5
mega_kernel_rs_pa_10_3:
s_waitcnt vmcnt(1)
v_max_u32 v4, v44, v46
v_cmp_eq_u32 vcc, -1, v4
s_cbranch_vccnz mega_kernel_rs_pa_10_3f
v_smfmac_f32_16x16x64_bf16 v[96:99], v[44:47], a[24:31], v6
v_smfmac_f32_16x16x64_bf16 v[100:103], v[44:47], a[56:63], v6
v_smfmac_f32_16x16x64_bf16 v[104:107], v[44:47], a[88:95], v6
v_smfmac_f32_16x16x64_bf16 v[108:111], v[44:47], a[120:127], v6
s_branch mega_kernel_rs_pa_2_1
mega_kernel_rs_il20:
s_cbranch_execz mega_kernel_rs_il21
.p2align 5
mega_kernel_rs_pa_11_0f:
s_mov_b64 exec, vcc
buffer_load_dwordx4 v[32:35], v7, s[84:87], s33 offen offset:0 sc1
s_mov_b64 exec, -1
s_branch mega_kernel_rs_pa_11_1
.p2align 5
mega_kernel_rs_pa_11_0:
s_waitcnt vmcnt(2)
v_max_u32 v4, v32, v34
v_cmp_eq_u32 vcc, -1, v4
s_cbranch_vccnz mega_kernel_rs_pa_11_0f
v_smfmac_f32_16x16x64_bf16 v[96:99], v[32:35], a[0:7], v6
v_smfmac_f32_16x16x64_bf16 v[100:103], v[32:35], a[32:39], v6
v_smfmac_f32_16x16x64_bf16 v[104:107], v[32:35], a[64:71], v6
v_smfmac_f32_16x16x64_bf16 v[108:111], v[32:35], a[96:103], v6
s_branch mega_kernel_rs_pa_10_1
mega_kernel_rs_il21:
s_cbranch_execz mega_kernel_rs_il22
.p2align 5
mega_kernel_rs_pa_11_1f:
s_mov_b64 exec, vcc
buffer_load_dwordx4 v[36:39], v7, s[84:87], s33 offen offset:1024 sc1
s_mov_b64 exec, -1
s_branch mega_kernel_rs_pa_11_3
.p2align 5
mega_kernel_rs_pa_11_1:
s_waitcnt vmcnt(2)
v_max_u32 v4, v36, v38
v_cmp_eq_u32 vcc, -1, v4
s_cbranch_vccnz mega_kernel_rs_pa_11_1f
v_smfmac_f32_16x16x64_bf16 v[96:99], v[36:39], a[8:15], v6
v_smfmac_f32_16x16x64_bf16 v[100:103], v[36:39], a[40:47], v6
v_smfmac_f32_16x16x64_bf16 v[104:107], v[36:39], a[72:79], v6
v_smfmac_f32_16x16x64_bf16 v[108:111], v[36:39], a[104:111], v6
s_branch mega_kernel_rs_pa_9_3
mega_kernel_rs_il22:
s_cbranch_execz mega_kernel_rs_il23
.p2align 5
mega_kernel_rs_pa_11_3f:
s_mov_b64 exec, vcc
buffer_load_dwordx4 v[44:47], v7, s[84:87], s33 offen offset:3072 sc1
s_mov_b64 exec, -1
s_branch mega_kernel_rs_pa_11_0
.p2align 5
mega_kernel_rs_pa_11_3:
s_waitcnt vmcnt(2)
v_max_u32 v4, v44, v46
v_cmp_eq_u32 vcc, -1, v4
s_cbranch_vccnz mega_kernel_rs_pa_11_3f
v_smfmac_f32_16x16x64_bf16 v[96:99], v[44:47], a[24:31], v6
v_smfmac_f32_16x16x64_bf16 v[100:103], v[44:47], a[56:63], v6
v_smfmac_f32_16x16x64_bf16 v[104:107], v[44:47], a[88:95], v6
v_smfmac_f32_16x16x64_bf16 v[108:111], v[44:47], a[120:127], v6
s_branch mega_kernel_rs_pa_3_0
mega_kernel_rs_il23:
s_cbranch_execz mega_kernel_rs_il24
.p2align 5
mega_kernel_rs_pa_12_2f:
s_mov_b64 exec, vcc
buffer_load_dwordx4 v[40:43], v7, s[84:87], s33 offen offset:2048 sc1
s_mov_b64 exec, -1
s_branch mega_kernel_rs_pa_12_3
.p2align 5
mega_kernel_rs_pa_12_2:
s_waitcnt vmcnt(1)
v_max_u32 v4, v40, v42
v_cmp_eq_u32 vcc, -1, v4
s_cbranch_vccnz mega_kernel_rs_pa_12_2f
v_smfmac_f32_16x16x64_bf16 v[96:99], v[40:43], a[16:23], v6
v_smfmac_f32_16x16x64_bf16 v[100:103], v[40:43], a[48:55], v6
v_smfmac_f32_16x16x64_bf16 v[104:107], v[40:43], a[80:87], v6
v_smfmac_f32_16x16x64_bf16 v[108:111], v[40:43], a[112:119], v6
s_branch mega_kernel_rs_pa_8_3
mega_kernel_rs_il24:
s_cbranch_execz mega_kernel_rs_il25
.p2align 5
mega_kernel_rs_pa_12_3f:
s_mov_b64 exec, vcc
buffer_load_dwordx4 v[44:47], v7, s[84:87], s33 offen offset:3072 sc1
s_mov_b64 exec, -1
s_branch mega_kernel_rs_pa_12_2
.p2align 5
mega_kernel_rs_pa_12_3:
s_waitcnt vmcnt(1)
v_max_u32 v4, v44, v46
v_cmp_eq_u32 vcc, -1, v4
s_cbranch_vccnz mega_kernel_rs_pa_12_3f
v_smfmac_f32_16x16x64_bf16 v[96:99], v[44:47], a[24:31], v6
v_smfmac_f32_16x16x64_bf16 v[100:103], v[44:47], a[56:63], v6
v_smfmac_f32_16x16x64_bf16 v[104:107], v[44:47], a[88:95], v6
v_smfmac_f32_16x16x64_bf16 v[108:111], v[44:47], a[120:127], v6
s_branch mega_kernel_rs_pa_4_2
mega_kernel_rs_il25:
s_cbranch_execz mega_kernel_rs_il26
.p2align 5
mega_kernel_rs_pa_13_0f:
s_mov_b64 exec, vcc
buffer_load_dwordx4 v[32:35], v7, s[84:87], s33 offen offset:0 sc1
s_mov_b64 exec, -1
s_branch mega_kernel_rs_pa_13_2
.p2align 5
mega_kernel_rs_pa_13_0:
s_waitcnt vmcnt(2)
v_max_u32 v4, v32, v34
v_cmp_eq_u32 vcc, -1, v4
s_cbranch_vccnz mega_kernel_rs_pa_13_0f
v_smfmac_f32_16x16x64_bf16 v[96:99], v[32:35], a[0:7], v6
v_smfmac_f32_16x16x64_bf16 v[100:103], v[32:35], a[32:39], v6
v_smfmac_f32_16x16x64_bf16 v[104:107], v[32:35], a[64:71], v6
v_smfmac_f32_16x16x64_bf16 v[108:111], v[32:35], a[96:103], v6
s_branch mega_kernel_rs_pa_12_2
mega_kernel_rs_il26:
s_cbranch_execz mega_kernel_rs_il27
.p2align 5
mega_kernel_rs_pa_13_2f:
s_mov_b64 exec, vcc
buffer_load_dwordx4 v[40:43], v7, s[84:87], s33 offen offset:2048 sc1
s_mov_b64 exec, -1
s_branch mega_kernel_rs_pa_13_3
.p2align 5
mega_kernel_rs_pa_13_2:
s_waitcnt vmcnt(2)
v_max_u32 v4, v40, v42
v_cmp_eq_u32 vcc, -1, v4
s_cbranch_vccnz mega_kernel_rs_pa_13_2f
v_smfmac_f32_16x16x64_bf16 v[96:99], v[40:43], a[16:23], v6
v_smfmac_f32_16x16x64_bf16 v[100:103], v[40:43], a[48:55], v6
v_smfmac_f32_16x16x64_bf16 v[104:107], v[40:43], a[80:87], v6
v_smfmac_f32_16x16x64_bf16 v[108:111], v[40:43], a[112:119], v6
s_branch mega_kernel_rs_pa_9_3
mega_kernel_rs_il27:
s_cbranch_execz mega_kernel_rs_il28
.p2align 5
mega_kernel_rs_pa_13_3f:
s_mov_b64 exec, vcc
buffer_load_dwordx4 v[44:47], v7, s[84:87], s33 offen offset:3072 sc1
s_mov_b64 exec, -1
s_branch mega_kernel_rs_pa_13_0
.p2align 5
mega_kernel_rs_pa_13_3:
s_waitcnt vmcnt(2)
v_max_u32 v4, v44, v46
v_cmp_eq_u32 vcc, -1, v4
s_cbranch_vccnz mega_kernel_rs_pa_13_3f
v_smfmac_f32_16x16x64_bf16 v[96:99], v[44:47], a[24:31], v6
v_smfmac_f32_16x16x64_bf16 v[100:103], v[44:47], a[56:63], v6
v_smfmac_f32_16x16x64_bf16 v[104:107], v[44:47], a[88:95], v6
v_smfmac_f32_16x16x64_bf16 v[108:111], v[44:47], a[120:127], v6
s_branch mega_kernel_rs_pa_5_0
mega_kernel_rs_il28:
s_cbranch_execz mega_kernel_rs_il29
.p2align 5
mega_kernel_rs_pa_14_1f:
s_mov_b64 exec, vcc
buffer_load_dwordx4 v[36:39], v7, s[84:87], s33 offen offset:1024 sc1
s_mov_b64 exec, -1
s_branch mega_kernel_rs_pa_14_2
.p2align 5
mega_kernel_rs_pa_14_1:
s_waitcnt vmcnt(2)
v_max_u32 v4, v36, v38
v_cmp_eq_u32 vcc, -1, v4
s_cbranch_vccnz mega_kernel_rs_pa_14_1f
v_smfmac_f32_16x16x64_bf16 v[96:99], v[36:39], a[8:15], v6
v_smfmac_f32_16x16x64_bf16 v[100:103], v[36:39], a[40:47], v6
v_smfmac_f32_16x16x64_bf16 v[104:107], v[36:39], a[72:79], v6
v_smfmac_f32_16x16x64_bf16 v[108:111], v[36:39], a[104:111], v6
s_branch mega_kernel_rs_pa_12_2
mega_kernel_rs_il29:
s_cbranch_execz mega_kernel_rs_il30
.p2align 5
mega_kernel_rs_pa_14_2f:
s_mov_b64 exec, vcc
buffer_load_dwordx4 v[40:43], v7, s[84:87], s33 offen offset:2048 sc1
s_mov_b64 exec, -1
s_branch mega_kernel_rs_pa_14_3
.p2align 5
mega_kernel_rs_pa_14_2:
s_waitcnt vmcnt(2)
v_max_u32 v4, v40, v42
v_cmp_eq_u32 vcc, -1, v4
s_cbranch_vccnz mega_kernel_rs_pa_14_2f
v_smfmac_f32_16x16x64_bf16 v[96:99], v[40:43], a[16:23], v6
v_smfmac_f32_16x16x64_bf16 v[100:103], v[40:43], a[48:55], v6
v_smfmac_f32_16x16x64_bf16 v[104:107], v[40:43], a[80:87], v6
v_smfmac_f32_16x16x64_bf16 v[108:111], v[40:43], a[112:119], v6
s_branch mega_kernel_rs_pa_10_3
mega_kernel_rs_il30:
s_cbranch_execz mega_kernel_rs_il31
.p2align 5
mega_kernel_rs_pa_14_3f:
s_mov_b64 exec, vcc
buffer_load_dwordx4 v[44:47], v7, s[84:87], s33 offen offset:3072 sc1
s_mov_b64 exec, -1
s_branch mega_kernel_rs_pa_14_1
.p2align 5
mega_kernel_rs_pa_14_3:
s_waitcnt vmcnt(2)
v_max_u32 v4, v44, v46
v_cmp_eq_u32 vcc, -1, v4
s_cbranch_vccnz mega_kernel_rs_pa_14_3f
v_smfmac_f32_16x16x64_bf16 v[96:99], v[44:47], a[24:31], v6
v_smfmac_f32_16x16x64_bf16 v[100:103], v[44:47], a[56:63], v6
v_smfmac_f32_16x16x64_bf16 v[104:107], v[44:47], a[88:95], v6
v_smfmac_f32_16x16x64_bf16 v[108:111], v[44:47], a[120:127], v6
s_branch mega_kernel_rs_pa_6_1
mega_kernel_rs_il31:
s_cbranch_execz mega_kernel_rs_il32
.p2align 5
mega_kernel_rs_pa_15_0f:
s_mov_b64 exec, vcc
buffer_load_dwordx4 v[32:35], v7, s[84:87], s33 offen offset:0 sc1
s_mov_b64 exec, -1
s_branch mega_kernel_rs_pa_15_1
.p2align 5
mega_kernel_rs_pa_15_0:
s_waitcnt vmcnt(3)
v_max_u32 v4, v32, v34
v_cmp_eq_u32 vcc, -1, v4
s_cbranch_vccnz mega_kernel_rs_pa_15_0f
v_smfmac_f32_16x16x64_bf16 v[96:99], v[32:35], a[0:7], v6
v_smfmac_f32_16x16x64_bf16 v[100:103], v[32:35], a[32:39], v6
v_smfmac_f32_16x16x64_bf16 v[104:107], v[32:35], a[64:71], v6
v_smfmac_f32_16x16x64_bf16 v[108:111], v[32:35], a[96:103], v6
s_branch mega_kernel_rs_pa_14_1
mega_kernel_rs_il32:
s_cbranch_execz mega_kernel_rs_il33
.p2align 5
mega_kernel_rs_pa_15_1f:
s_mov_b64 exec, vcc
buffer_load_dwordx4 v[36:39], v7, s[84:87], s33 offen offset:1024 sc1
s_mov_b64 exec, -1
s_branch mega_kernel_rs_pa_15_2
.p2align 5
mega_kernel_rs_pa_15_1:
s_waitcnt vmcnt(3)
v_max_u32 v4, v36, v38
v_cmp_eq_u32 vcc, -1, v4
s_cbranch_vccnz mega_kernel_rs_pa_15_1f
v_smfmac_f32_16x16x64_bf16 v[96:99], v[36:39], a[8:15], v6
v_smfmac_f32_16x16x64_bf16 v[100:103], v[36:39], a[40:47], v6
v_smfmac_f32_16x16x64_bf16 v[104:107], v[36:39], a[72:79], v6
v_smfmac_f32_16x16x64_bf16 v[108:111], v[36:39], a[104:111], v6
s_branch mega_kernel_rs_pa_13_2
mega_kernel_rs_il33:
s_cbranch_execz mega_kernel_rs_il34
.p2align 5
mega_kernel_rs_pa_15_2f:
s_mov_b64 exec, vcc
buffer_load_dwordx4 v[40:43], v7, s[84:87], s33 offen offset:2048 sc1
s_mov_b64 exec, -1
s_branch mega_kernel_rs_pa_15_3
.p2align 5
mega_kernel_rs_pa_15_2:
s_waitcnt vmcnt(3)
v_max_u32 v4, v40, v42
v_cmp_eq_u32 vcc, -1, v4
s_cbranch_vccnz mega_kernel_rs_pa_15_2f
v_smfmac_f32_16x16x64_bf16 v[96:99], v[40:43], a[16:23], v6
v_smfmac_f32_16x16x64_bf16 v[100:103], v[40:43], a[48:55], v6
v_smfmac_f32_16x16x64_bf16 v[104:107], v[40:43], a[80:87], v6
v_smfmac_f32_16x16x64_bf16 v[108:111], v[40:43], a[112:119], v6
s_branch mega_kernel_rs_pa_11_3
mega_kernel_rs_il34:
s_cbranch_execz mega_kernel_rs_il35
.p2align 5
mega_kernel_rs_pa_15_3f:
s_mov_b64 exec, vcc
buffer_load_dwordx4 v[44:47], v7, s[84:87], s33 offen offset:3072 sc1
s_mov_b64 exec, -1
s_branch mega_kernel_rs_pa_15_0
.p2align 5
mega_kernel_rs_pa_15_3:
s_waitcnt vmcnt(3)
v_max_u32 v4, v44, v46
v_cmp_eq_u32 vcc, -1, v4
s_cbranch_vccnz mega_kernel_rs_pa_15_3f
v_smfmac_f32_16x16x64_bf16 v[96:99], v[44:47], a[24:31], v6
v_smfmac_f32_16x16x64_bf16 v[100:103], v[44:47], a[56:63], v6
v_smfmac_f32_16x16x64_bf16 v[104:107], v[44:47], a[88:95], v6
v_smfmac_f32_16x16x64_bf16 v[108:111], v[44:47], a[120:127], v6
s_branch mega_kernel_rs_pa_7_0
mega_kernel_rs_il35:
s_cbranch_execz mega_kernel_rs_il36
.p2align 5
mega_kernel_rs_pc_1_0f:
s_mov_b64 exec, vcc
buffer_load_dwordx4 v[32:35], v7, s[84:87], s29 offen offset:0 sc1
s_mov_b64 exec, -1
s_branch mega_kernel_rs_pc_1_0
.p2align 5
mega_kernel_rs_pc_1_0:
s_waitcnt vmcnt(0)
v_cmp_eq_u32 vcc, -1, v32
s_cbranch_vccnz mega_kernel_rs_pc_1_0f
v_smfmac_f32_16x16x64_bf16 v[96:99], v[32:35], a[192:199], v6
v_smfmac_f32_16x16x64_bf16 v[100:103], v[32:35], a[224:231], v6
s_branch mega_kernel_rs_pc_d
mega_kernel_rs_il36:
s_cbranch_execz mega_kernel_rs_il37
.p2align 5
mega_kernel_rs_pc_2_1f:
s_mov_b64 exec, vcc
buffer_load_dwordx4 v[36:39], v7, s[84:87], s29 offen offset:1024 sc1
s_mov_b64 exec, -1
s_branch mega_kernel_rs_pc_2_1
mega_kernel_rs_il37:
s_cbranch_execz mega_kernel_rs_iwd
.p2align 5
mega_kernel_rs_pc_2_1:
s_waitcnt vmcnt(0)
v_cmp_eq_u32 vcc, -1, v36
s_cbranch_vccnz mega_kernel_rs_pc_2_1f
v_smfmac_f32_16x16x64_bf16 v[96:99], v[36:39], a[200:207], v6
v_smfmac_f32_16x16x64_bf16 v[100:103], v[36:39], a[232:239], v6
s_branch mega_kernel_rs_pc_d
.p2align 5
mega_kernel_rs_pc_3_0f:
s_mov_b64 exec, vcc
buffer_load_dwordx4 v[32:35], v7, s[84:87], s29 offen offset:0 sc1
s_mov_b64 exec, -1
s_branch mega_kernel_rs_pc_3_1
mega_kernel_rs_iw2:
mega_kernel_rs_il38:
s_cbranch_execz mega_kernel_rs_il39
.p2align 5
mega_kernel_rs_pc_3_0:
s_waitcnt vmcnt(1)
v_cmp_eq_u32 vcc, -1, v32
s_cbranch_vccnz mega_kernel_rs_pc_3_0f
v_smfmac_f32_16x16x64_bf16 v[96:99], v[32:35], a[192:199], v6
v_smfmac_f32_16x16x64_bf16 v[100:103], v[32:35], a[224:231], v6
s_branch mega_kernel_rs_pc_2_1
.p2align 5
mega_kernel_rs_pc_3_1f:
s_mov_b64 exec, vcc
buffer_load_dwordx4 v[36:39], v7, s[84:87], s29 offen offset:1024 sc1
s_mov_b64 exec, -1
s_branch mega_kernel_rs_pc_3_0
mega_kernel_rs_il39:
s_cbranch_execz mega_kernel_rs_il40
.p2align 5
mega_kernel_rs_pc_3_1:
s_waitcnt vmcnt(1)
v_cmp_eq_u32 vcc, -1, v36
s_cbranch_vccnz mega_kernel_rs_pc_3_1f
v_smfmac_f32_16x16x64_bf16 v[96:99], v[36:39], a[200:207], v6
v_smfmac_f32_16x16x64_bf16 v[100:103], v[36:39], a[232:239], v6
s_branch mega_kernel_rs_pc_1_0
.p2align 5
mega_kernel_rs_pc_4_2f:
s_mov_b64 exec, vcc
buffer_load_dwordx4 v[40:43], v7, s[84:87], s29 offen offset:2048 sc1
s_mov_b64 exec, -1
s_branch mega_kernel_rs_pc_4_2
mega_kernel_rs_il40:
s_cbranch_execz mega_kernel_rs_il41
.p2align 5
mega_kernel_rs_pc_4_2:
s_waitcnt vmcnt(0)
v_cmp_eq_u32 vcc, -1, v40
s_cbranch_vccnz mega_kernel_rs_pc_4_2f
v_smfmac_f32_16x16x64_bf16 v[96:99], v[40:43], a[208:215], v6
v_smfmac_f32_16x16x64_bf16 v[100:103], v[40:43], a[240:247], v6
s_branch mega_kernel_rs_pc_d
.p2align 5
mega_kernel_rs_pc_5_0f:
s_mov_b64 exec, vcc
buffer_load_dwordx4 v[32:35], v7, s[84:87], s29 offen offset:0 sc1
s_mov_b64 exec, -1
s_branch mega_kernel_rs_pc_5_2
mega_kernel_rs_il41:
s_cbranch_execz mega_kernel_rs_il42
.p2align 5
mega_kernel_rs_pc_5_0:
s_waitcnt vmcnt(1)
v_cmp_eq_u32 vcc, -1, v32
s_cbranch_vccnz mega_kernel_rs_pc_5_0f
v_smfmac_f32_16x16x64_bf16 v[96:99], v[32:35], a[192:199], v6
v_smfmac_f32_16x16x64_bf16 v[100:103], v[32:35], a[224:231], v6
s_branch mega_kernel_rs_pc_4_2
.p2align 5
mega_kernel_rs_pc_5_2f:
s_mov_b64 exec, vcc
buffer_load_dwordx4 v[40:43], v7, s[84:87], s29 offen offset:2048 sc1
s_mov_b64 exec, -1
s_branch mega_kernel_rs_pc_5_0
mega_kernel_rs_il42:
s_cbranch_execz mega_kernel_rs_il43
.p2align 5
mega_kernel_rs_pc_5_2:
s_waitcnt vmcnt(1)
v_cmp_eq_u32 vcc, -1, v40
s_cbranch_vccnz mega_kernel_rs_pc_5_2f
v_smfmac_f32_16x16x64_bf16 v[96:99], v[40:43], a[208:215], v6
v_smfmac_f32_16x16x64_bf16 v[100:103], v[40:43], a[240:247], v6
s_branch mega_kernel_rs_pc_1_0
.p2align 5
mega_kernel_rs_pc_6_1f:
s_mov_b64 exec, vcc
buffer_load_dwordx4 v[36:39], v7, s[84:87], s29 offen offset:1024 sc1
s_mov_b64 exec, -1
s_branch mega_kernel_rs_pc_6_2
mega_kernel_rs_il43:
s_cbranch_execz mega_kernel_rs_il44
.p2align 5
mega_kernel_rs_pc_6_1:
s_waitcnt vmcnt(1)
v_cmp_eq_u32 vcc, -1, v36
s_cbranch_vccnz mega_kernel_rs_pc_6_1f
v_smfmac_f32_16x16x64_bf16 v[96:99], v[36:39], a[200:207], v6
v_smfmac_f32_16x16x64_bf16 v[100:103], v[36:39], a[232:239], v6
s_branch mega_kernel_rs_pc_4_2
.p2align 5
mega_kernel_rs_pc_6_2f:
s_mov_b64 exec, vcc
buffer_load_dwordx4 v[40:43], v7, s[84:87], s29 offen offset:2048 sc1
s_mov_b64 exec, -1
s_branch mega_kernel_rs_pc_6_1
mega_kernel_rs_il44:
s_cbranch_execz mega_kernel_rs_il45
.p2align 5
mega_kernel_rs_pc_6_2:
s_waitcnt vmcnt(1)
v_cmp_eq_u32 vcc, -1, v40
s_cbranch_vccnz mega_kernel_rs_pc_6_2f
v_smfmac_f32_16x16x64_bf16 v[96:99], v[40:43], a[208:215], v6
v_smfmac_f32_16x16x64_bf16 v[100:103], v[40:43], a[240:247], v6
s_branch mega_kernel_rs_pc_2_1
.p2align 5
mega_kernel_rs_pc_7_0f:
s_mov_b64 exec, vcc
buffer_load_dwordx4 v[32:35], v7, s[84:87], s29 offen offset:0 sc1
s_mov_b64 exec, -1
s_branch mega_kernel_rs_pc_7_1
mega_kernel_rs_il45:
s_cbranch_execz mega_kernel_rs_il46
.p2align 5
mega_kernel_rs_pc_7_0:
s_waitcnt vmcnt(2)
v_cmp_eq_u32 vcc, -1, v32
s_cbranch_vccnz mega_kernel_rs_pc_7_0f
v_smfmac_f32_16x16x64_bf16 v[96:99], v[32:35], a[192:199], v6
v_smfmac_f32_16x16x64_bf16 v[100:103], v[32:35], a[224:231], v6
s_branch mega_kernel_rs_pc_6_1
.p2align 5
mega_kernel_rs_pc_7_1f:
s_mov_b64 exec, vcc
buffer_load_dwordx4 v[36:39], v7, s[84:87], s29 offen offset:1024 sc1
s_mov_b64 exec, -1
s_branch mega_kernel_rs_pc_7_2
mega_kernel_rs_il46:
s_cbranch_execz mega_kernel_rs_il47
.p2align 5
mega_kernel_rs_pc_7_1:
s_waitcnt vmcnt(2)
v_cmp_eq_u32 vcc, -1, v36
s_cbranch_vccnz mega_kernel_rs_pc_7_1f
v_smfmac_f32_16x16x64_bf16 v[96:99], v[36:39], a[200:207], v6
v_smfmac_f32_16x16x64_bf16 v[100:103], v[36:39], a[232:239], v6
s_branch mega_kernel_rs_pc_5_2
.p2align 5
mega_kernel_rs_pc_7_2f:
s_mov_b64 exec, vcc
buffer_load_dwordx4 v[40:43], v7, s[84:87], s29 offen offset:2048 sc1
s_mov_b64 exec, -1
s_branch mega_kernel_rs_pc_7_0
mega_kernel_rs_il47:
s_cbranch_execz mega_kernel_rs_il48
.p2align 5
mega_kernel_rs_pc_7_2:
s_waitcnt vmcnt(2)
v_cmp_eq_u32 vcc, -1, v40
s_cbranch_vccnz mega_kernel_rs_pc_7_2f
v_smfmac_f32_16x16x64_bf16 v[96:99], v[40:43], a[208:215], v6
v_smfmac_f32_16x16x64_bf16 v[100:103], v[40:43], a[240:247], v6
s_branch mega_kernel_rs_pc_3_0
.p2align 5
mega_kernel_rs_pc_8_3f:
s_mov_b64 exec, vcc
buffer_load_dwordx4 v[44:47], v7, s[84:87], s29 offen offset:3072 sc1
s_mov_b64 exec, -1
s_branch mega_kernel_rs_pc_8_3
mega_kernel_rs_il48:
s_cbranch_execz mega_kernel_rs_il49
.p2align 5
mega_kernel_rs_pc_9_0f:
s_mov_b64 exec, vcc
buffer_load_dwordx4 v[32:35], v7, s[84:87], s29 offen offset:0 sc1
s_mov_b64 exec, -1
s_branch mega_kernel_rs_pc_9_3
.p2align 5
mega_kernel_rs_pc_9_0:
s_waitcnt vmcnt(1)
v_cmp_eq_u32 vcc, -1, v32
s_cbranch_vccnz mega_kernel_rs_pc_9_0f
v_smfmac_f32_16x16x64_bf16 v[96:99], v[32:35], a[192:199], v6
v_smfmac_f32_16x16x64_bf16 v[100:103], v[32:35], a[224:231], v6
s_branch mega_kernel_rs_pc_8_3
mega_kernel_rs_il49:
s_cbranch_execz mega_kernel_rs_il50
.p2align 5
mega_kernel_rs_pc_9_3f:
s_mov_b64 exec, vcc
buffer_load_dwordx4 v[44:47], v7, s[84:87], s29 offen offset:3072 sc1
s_mov_b64 exec, -1
s_branch mega_kernel_rs_pc_9_0
mega_kernel_rs_il50:
s_cbranch_execz mega_kernel_rs_il51
.p2align 5
mega_kernel_rs_pc_9_3:
s_waitcnt vmcnt(1)
v_cmp_eq_u32 vcc, -1, v44
s_cbranch_vccnz mega_kernel_rs_pc_9_3f
v_smfmac_f32_16x16x64_bf16 v[96:99], v[44:47], a[216:223], v6
v_smfmac_f32_16x16x64_bf16 v[100:103], v[44:47], a[248:255], v6
s_branch mega_kernel_rs_pc_1_0
.p2align 5
mega_kernel_rs_pc_10_1f:
s_mov_b64 exec, vcc
buffer_load_dwordx4 v[36:39], v7, s[84:87], s29 offen offset:1024 sc1
s_mov_b64 exec, -1
s_branch mega_kernel_rs_pc_10_3
mega_kernel_rs_il51:
s_cbranch_execz mega_kernel_rs_il52
.p2align 5
mega_kernel_rs_pc_10_1:
s_waitcnt vmcnt(1)
v_cmp_eq_u32 vcc, -1, v36
s_cbranch_vccnz mega_kernel_rs_pc_10_1f
v_smfmac_f32_16x16x64_bf16 v[96:99], v[36:39], a[200:207], v6
v_smfmac_f32_16x16x64_bf16 v[100:103], v[36:39], a[232:239], v6
s_branch mega_kernel_rs_pc_8_3
.p2align 5
mega_kernel_rs_pc_10_3f:
s_mov_b64 exec, vcc
buffer_load_dwordx4 v[44:47], v7, s[84:87], s29 offen offset:3072 sc1
s_mov_b64 exec, -1
s_branch mega_kernel_rs_pc_10_1
mega_kernel_rs_il52:
s_cbranch_execz mega_kernel_rs_il53
.p2align 5
mega_kernel_rs_pc_10_3:
s_waitcnt vmcnt(1)
v_cmp_eq_u32 vcc, -1, v44
s_cbranch_vccnz mega_kernel_rs_pc_10_3f
v_smfmac_f32_16x16x64_bf16 v[96:99], v[44:47], a[216:223], v6
v_smfmac_f32_16x16x64_bf16 v[100:103], v[44:47], a[248:255], v6
s_branch mega_kernel_rs_pc_2_1
.p2align 5
mega_kernel_rs_pc_11_0f:
s_mov_b64 exec, vcc
buffer_load_dwordx4 v[32:35], v7, s[84:87], s29 offen offset:0 sc1
s_mov_b64 exec, -1
s_branch mega_kernel_rs_pc_11_1
mega_kernel_rs_il53:
s_cbranch_execz mega_kernel_rs_il54
.p2align 5
mega_kernel_rs_pc_11_0:
s_waitcnt vmcnt(2)
v_cmp_eq_u32 vcc, -1, v32
s_cbranch_vccnz mega_kernel_rs_pc_11_0f
v_smfmac_f32_16x16x64_bf16 v[96:99], v[32:35], a[192:199], v6
v_smfmac_f32_16x16x64_bf16 v[100:103], v[32:35], a[224:231], v6
s_branch mega_kernel_rs_pc_10_1
.p2align 5
mega_kernel_rs_pc_11_1f:
s_mov_b64 exec, vcc
buffer_load_dwordx4 v[36:39], v7, s[84:87], s29 offen offset:1024 sc1
s_mov_b64 exec, -1
s_branch mega_kernel_rs_pc_11_3
mega_kernel_rs_il54:
s_cbranch_execz mega_kernel_rs_il55
.p2align 5
mega_kernel_rs_pc_11_1:
s_waitcnt vmcnt(2)
v_cmp_eq_u32 vcc, -1, v36
s_cbranch_vccnz mega_kernel_rs_pc_11_1f
v_smfmac_f32_16x16x64_bf16 v[96:99], v[36:39], a[200:207], v6
v_smfmac_f32_16x16x64_bf16 v[100:103], v[36:39], a[232:239], v6
s_branch mega_kernel_rs_pc_9_3
.p2align 5
mega_kernel_rs_pc_11_3f:
s_mov_b64 exec, vcc
buffer_load_dwordx4 v[44:47], v7, s[84:87], s29 offen offset:3072 sc1
s_mov_b64 exec, -1
s_branch mega_kernel_rs_pc_11_0
mega_kernel_rs_il55:
s_cbranch_execz mega_kernel_rs_il56
.p2align 5
mega_kernel_rs_pc_11_3:
s_waitcnt vmcnt(2)
v_cmp_eq_u32 vcc, -1, v44
s_cbranch_vccnz mega_kernel_rs_pc_11_3f
v_smfmac_f32_16x16x64_bf16 v[96:99], v[44:47], a[216:223], v6
v_smfmac_f32_16x16x64_bf16 v[100:103], v[44:47], a[248:255], v6
s_branch mega_kernel_rs_pc_3_0
.p2align 5
mega_kernel_rs_pc_12_2f:
s_mov_b64 exec, vcc
buffer_load_dwordx4 v[40:43], v7, s[84:87], s29 offen offset:2048 sc1
s_mov_b64 exec, -1
s_branch mega_kernel_rs_pc_12_3
mega_kernel_rs_il56:
s_cbranch_execz mega_kernel_rs_iwd
.p2align 5
mega_kernel_rs_pc_12_3f:
s_mov_b64 exec, vcc
buffer_load_dwordx4 v[44:47], v7, s[84:87], s29 offen offset:3072 sc1
s_mov_b64 exec, -1
s_branch mega_kernel_rs_pc_12_2
.p2align 5
mega_kernel_rs_pc_12_3:
s_waitcnt vmcnt(1)
v_cmp_eq_u32 vcc, -1, v44
s_cbranch_vccnz mega_kernel_rs_pc_12_3f
v_smfmac_f32_16x16x64_bf16 v[96:99], v[44:47], a[216:223], v6
v_smfmac_f32_16x16x64_bf16 v[100:103], v[44:47], a[248:255], v6
s_branch mega_kernel_rs_pc_4_2
mega_kernel_rs_iw3:
mega_kernel_rs_il57:
s_cbranch_execz mega_kernel_rs_il58
.p2align 5
mega_kernel_rs_pc_13_0f:
s_mov_b64 exec, vcc
buffer_load_dwordx4 v[32:35], v7, s[84:87], s29 offen offset:0 sc1
s_mov_b64 exec, -1
s_branch mega_kernel_rs_pc_13_2
mega_kernel_rs_il58:
s_cbranch_execz mega_kernel_rs_il59
.p2align 5
mega_kernel_rs_pc_13_0:
s_waitcnt vmcnt(2)
v_cmp_eq_u32 vcc, -1, v32
s_cbranch_vccnz mega_kernel_rs_pc_13_0f
v_smfmac_f32_16x16x64_bf16 v[96:99], v[32:35], a[192:199], v6
v_smfmac_f32_16x16x64_bf16 v[100:103], v[32:35], a[224:231], v6
s_branch mega_kernel_rs_pc_12_2
.p2align 5
mega_kernel_rs_pc_13_2f:
s_mov_b64 exec, vcc
buffer_load_dwordx4 v[40:43], v7, s[84:87], s29 offen offset:2048 sc1
s_mov_b64 exec, -1
s_branch mega_kernel_rs_pc_13_3
mega_kernel_rs_il59:
s_cbranch_execz mega_kernel_rs_il60
.p2align 5
mega_kernel_rs_pc_13_2:
s_waitcnt vmcnt(2)
v_cmp_eq_u32 vcc, -1, v40
s_cbranch_vccnz mega_kernel_rs_pc_13_2f
v_smfmac_f32_16x16x64_bf16 v[96:99], v[40:43], a[208:215], v6
v_smfmac_f32_16x16x64_bf16 v[100:103], v[40:43], a[240:247], v6
s_branch mega_kernel_rs_pc_9_3
.p2align 5
mega_kernel_rs_pc_13_3f:
s_mov_b64 exec, vcc
buffer_load_dwordx4 v[44:47], v7, s[84:87], s29 offen offset:3072 sc1
s_mov_b64 exec, -1
s_branch mega_kernel_rs_pc_13_0
mega_kernel_rs_il60:
s_cbranch_execz mega_kernel_rs_il61
.p2align 5
mega_kernel_rs_pc_13_3:
s_waitcnt vmcnt(2)
v_cmp_eq_u32 vcc, -1, v44
s_cbranch_vccnz mega_kernel_rs_pc_13_3f
v_smfmac_f32_16x16x64_bf16 v[96:99], v[44:47], a[216:223], v6
v_smfmac_f32_16x16x64_bf16 v[100:103], v[44:47], a[248:255], v6
s_branch mega_kernel_rs_pc_5_0
.p2align 5
mega_kernel_rs_pc_14_1f:
s_mov_b64 exec, vcc
buffer_load_dwordx4 v[36:39], v7, s[84:87], s29 offen offset:1024 sc1
s_mov_b64 exec, -1
s_branch mega_kernel_rs_pc_14_2
mega_kernel_rs_il61:
s_cbranch_execz mega_kernel_rs_il62
.p2align 5
mega_kernel_rs_pc_14_2f:
s_mov_b64 exec, vcc
buffer_load_dwordx4 v[40:43], v7, s[84:87], s29 offen offset:2048 sc1
s_mov_b64 exec, -1
s_branch mega_kernel_rs_pc_14_3
.p2align 5
mega_kernel_rs_pc_14_2:
s_waitcnt vmcnt(2)
v_cmp_eq_u32 vcc, -1, v40
s_cbranch_vccnz mega_kernel_rs_pc_14_2f
v_smfmac_f32_16x16x64_bf16 v[96:99], v[40:43], a[208:215], v6
v_smfmac_f32_16x16x64_bf16 v[100:103], v[40:43], a[240:247], v6
s_branch mega_kernel_rs_pc_10_3
mega_kernel_rs_il62:
s_cbranch_execz mega_kernel_rs_il63
.p2align 5
mega_kernel_rs_pc_14_3f:
s_mov_b64 exec, vcc
buffer_load_dwordx4 v[44:47], v7, s[84:87], s29 offen offset:3072 sc1
s_mov_b64 exec, -1
s_branch mega_kernel_rs_pc_14_1
mega_kernel_rs_il63:
s_cbranch_execz mega_kernel_rs_il64
.p2align 5
mega_kernel_rs_pc_14_3:
s_waitcnt vmcnt(2)
v_cmp_eq_u32 vcc, -1, v44
s_cbranch_vccnz mega_kernel_rs_pc_14_3f
v_smfmac_f32_16x16x64_bf16 v[96:99], v[44:47], a[216:223], v6
v_smfmac_f32_16x16x64_bf16 v[100:103], v[44:47], a[248:255], v6
s_branch mega_kernel_rs_pc_6_1
.p2align 5
mega_kernel_rs_pc_15_0f:
s_mov_b64 exec, vcc
buffer_load_dwordx4 v[32:35], v7, s[84:87], s29 offen offset:0 sc1
s_mov_b64 exec, -1
s_branch mega_kernel_rs_pc_15_1
mega_kernel_rs_il64:
s_cbranch_execz mega_kernel_rs_il65
.p2align 5
mega_kernel_rs_pc_15_1f:
s_mov_b64 exec, vcc
buffer_load_dwordx4 v[36:39], v7, s[84:87], s29 offen offset:1024 sc1
s_mov_b64 exec, -1
s_branch mega_kernel_rs_pc_15_2
.p2align 5
mega_kernel_rs_pc_15_1:
s_waitcnt vmcnt(3)
v_cmp_eq_u32 vcc, -1, v36
s_cbranch_vccnz mega_kernel_rs_pc_15_1f
v_smfmac_f32_16x16x64_bf16 v[96:99], v[36:39], a[200:207], v6
v_smfmac_f32_16x16x64_bf16 v[100:103], v[36:39], a[232:239], v6
s_branch mega_kernel_rs_pc_13_2
mega_kernel_rs_il65:
s_cbranch_execz mega_kernel_rs_il66
.p2align 5
mega_kernel_rs_pc_15_2f:
s_mov_b64 exec, vcc
buffer_load_dwordx4 v[40:43], v7, s[84:87], s29 offen offset:2048 sc1
s_mov_b64 exec, -1
s_branch mega_kernel_rs_pc_15_3
mega_kernel_rs_il66:
s_cbranch_execz mega_kernel_rs_il67
.p2align 5
mega_kernel_rs_pc_15_2:
s_waitcnt vmcnt(3)
v_cmp_eq_u32 vcc, -1, v40
s_cbranch_vccnz mega_kernel_rs_pc_15_2f
v_smfmac_f32_16x16x64_bf16 v[96:99], v[40:43], a[208:215], v6
v_smfmac_f32_16x16x64_bf16 v[100:103], v[40:43], a[240:247], v6
s_branch mega_kernel_rs_pc_11_3
.p2align 5
mega_kernel_rs_pc_15_3f:
s_mov_b64 exec, vcc
buffer_load_dwordx4 v[44:47], v7, s[84:87], s29 offen offset:3072 sc1
s_mov_b64 exec, -1
s_branch mega_kernel_rs_pc_15_0
mega_kernel_rs_il67:
s_cbranch_execz mega_kernel_rs_il68
.p2align 5
mega_kernel_rs_pc_15_3:
s_waitcnt vmcnt(3)
v_cmp_eq_u32 vcc, -1, v44
s_cbranch_vccnz mega_kernel_rs_pc_15_3f
v_smfmac_f32_16x16x64_bf16 v[96:99], v[44:47], a[216:223], v6
v_smfmac_f32_16x16x64_bf16 v[100:103], v[44:47], a[248:255], v6
s_branch mega_kernel_rs_pc_7_0
mega_kernel_rs_w0last:
s_nop 7
v_permlane32_swap_b32 v112, v116
v_permlane32_swap_b32 v113, v117
v_permlane32_swap_b32 v114, v118
v_permlane32_swap_b32 v115, v119
v_pk_add_f32 v[112:113], v[112:113], v[116:117]
v_pk_add_f32 v[114:115], v[114:115], v[118:119]
ds_write_b128 v20, v[112:115]
s_waitcnt lgkmcnt(0)
s_barrier
s_branch mega_kernel_rs_end
mega_kernel_rs_il68:
s_cbranch_execz mega_kernel_rs_il69
mega_kernel_rs_side:
s_cmp_eq_u32 s24, 3
s_cbranch_scc1 mega_kernel_rs_sd3
s_cmp_eq_u32 s24, 2
s_cbranch_scc0 mega_kernel_rs_sd4
s_mov_b64 exec, s[40:41]
buffer_store_dwordx4 v[28:31], v11, s[84:87], s34 offen sc1
s_mov_b64 exec, -1
buffer_store_dwordx2 v[28:29], v9, s[84:87], s34 offen sc1
s_mul_i32 s28, s31, 1280
s_add_u32 s28, s28, s34
s_add_u32 s28, s28, 49152
buffer_store_dwordx4 v[28:31], v17, s[84:87], s28 offen sc1
buffer_store_dwordx4 v[28:31], v10, s[84:87], s28 offen sc1
s_branch mega_kernel_rs_sd4
mega_kernel_rs_il69:
s_cbranch_execz mega_kernel_rs_il70
mega_kernel_rs_sd3:
v_readlane_b32 s76, v249, 0
v_readlane_b32 s77, v249, 1
s_min_i32 s76, s76, s77
s_max_i32 s46, s46, s76
s_mov_b32 s36, 0
s_add_u32 s76, s27, 1
s_cmp_lt_u32 s76, 63
s_cbranch_scc0 mega_kernel_rs_sd4
s_cmp_ge_u32 s76, 0
s_cbranch_scc0 mega_kernel_rs_sd4
s_cmp_gt_i32 s46, s76
s_cselect_b32 s36, 0, 1
s_cbranch_scc0 mega_kernel_rs_sd4
s_add_u32 s77, s76, s82
s_bfe_u32 s28, s77, 0x40002
s_lshl_b32 s28, s28, 14
s_and_b32 s77, s77, 3
s_lshl_b32 s77, s77, 11
s_add_u32 s28, s28, s77
s_add_u32 m0, s45, 0
s_nop 0
buffer_load_dwordx4 v240, s[84:87], s28 offen offset:0 sc1 lds
s_add_u32 m0, s45, 0
s_nop 0
buffer_load_dwordx4 v240, s[84:87], s28 offen offset:1024 sc1 lds
s_add_u32 m0, s45, 2048
s_nop 0
buffer_load_dwordx4 v241, s[84:87], s28 offen offset:0 sc1 lds
s_add_u32 m0, s45, 2048
s_nop 0
buffer_load_dwordx4 v241, s[84:87], s28 offen offset:1024 sc1 lds
s_add_u32 s45, s45, 4096
s_cmp_eq_u32 s45, 30720
s_cselect_b32 s45, 18432, s45
mega_kernel_rs_sd4:
v_smfmac_f32_16x16x64_bf16 v[112:115], v[40:43], a[144:151], v6
v_smfmac_f32_16x16x64_bf16 v[116:119], v[40:43], a[176:183], v6
v_smfmac_f32_16x16x64_bf16 v[112:115], v[44:47], a[152:159], v6
v_smfmac_f32_16x16x64_bf16 v[116:119], v[44:47], a[184:191], v6
s_nop 7
v_permlane32_swap_b32 v112, v116
v_permlane32_swap_b32 v113, v117
v_permlane32_swap_b32 v114, v118
v_permlane32_swap_b32 v115, v119
v_pk_add_f32 v[112:113], v[112:113], v[116:117]
v_pk_add_f32 v[114:115], v[114:115], v[118:119]
ds_write_b128 v20, v[112:115]
v_mov_b32 v96, 0
v_mov_b32 v97, 0
v_mov_b32 v98, 0
v_mov_b32 v99, 0
v_mov_b32 v100, 0
v_mov_b32 v101, 0
v_mov_b32 v102, 0
v_mov_b32 v103, 0
s_cmp_eq_u32 s24, 1
s_cbranch_scc0 mega_kernel_rs_s1
s_waitcnt lgkmcnt(0)
ds_read_b128 v[120:123], v16 offset:0
ds_read_b128 v[124:127], v16 offset:16
ds_read_b128 v[128:131], v16 offset:2304
ds_read_b128 v[132:135], v16 offset:2320
ds_read_b128 v[136:139], v16 offset:4608
ds_read_b128 v[140:143], v16 offset:4624
ds_read_b128 v[144:147], v16 offset:6912
ds_read_b128 v[148:151], v16 offset:6928
s_waitcnt lgkmcnt(4)
v_pk_add_f32 v[120:121], v[120:121], v[128:129]
v_pk_add_f32 v[122:123], v[122:123], v[130:131]
v_pk_add_f32 v[124:125], v[124:125], v[132:133]
v_pk_add_f32 v[126:127], v[126:127], v[134:135]
s_waitcnt lgkmcnt(0)
v_pk_add_f32 v[136:137], v[136:137], v[144:145]
v_pk_add_f32 v[138:139], v[138:139], v[146:147]
v_pk_add_f32 v[140:141], v[140:141], v[148:149]
v_pk_add_f32 v[142:143], v[142:143], v[150:151]
v_pk_add_f32 v[120:121], v[120:121], v[136:137]
v_pk_add_f32 v[122:123], v[122:123], v[138:139]
v_pk_add_f32 v[124:125], v[124:125], v[140:141]
v_pk_add_f32 v[126:127], v[126:127], v[142:143]
v_cvt_pk_bf16_f32 v244, v120, v121
v_cvt_pk_bf16_f32 v245, v122, v123
v_cvt_pk_bf16_f32 v246, v124, v125
v_cvt_pk_bf16_f32 v247, v126, v127
mega_kernel_rs_s1:
v_add_u32 v5, 9216, v17
s_waitcnt lgkmcnt(0)
s_barrier
s_cmp_eq_u32 s24, 2
s_cbranch_scc1 mega_kernel_rs_s2
s_cmp_eq_u32 s24, 3
s_cbranch_scc0 mega_kernel_rs_s3
s_add_u32 s76, s27, 2
s_cmp_lt_u32 s76, 63
s_cbranch_scc0 mega_kernel_rs_s3
s_cmp_gt_i32 s46, s76
s_cbranch_scc0 mega_kernel_rs_s3
s_add_u32 s77, s76, s82
s_bfe_u32 s28, s77, 0x40002
s_lshl_b32 s28, s28, 14
s_and_b32 s77, s77, 3
s_lshl_b32 s77, s77, 11
s_add_u32 s28, s28, s77
s_add_u32 s28, s28, s83
s_buffer_load_dword s78, s[84:87], s28 offset:0
s_buffer_load_dword s78, s[84:87], s28 offset:128
s_buffer_load_dword s78, s[84:87], s28 offset:256
s_buffer_load_dword s78, s[84:87], s28 offset:384
s_buffer_load_dword s78, s[84:87], s28 offset:512
s_buffer_load_dword s78, s[84:87], s28 offset:640
s_buffer_load_dword s78, s[84:87], s28 offset:768
s_buffer_load_dword s78, s[84:87], s28 offset:896
s_buffer_load_dword s78, s[84:87], s28 offset:1024
s_buffer_load_dword s78, s[84:87], s28 offset:1152
s_buffer_load_dword s78, s[84:87], s28 offset:1280
s_buffer_load_dword s78, s[84:87], s28 offset:1408
s_buffer_load_dword s78, s[84:87], s28 offset:1536
s_buffer_load_dword s78, s[84:87], s28 offset:1664
s_buffer_load_dword s78, s[84:87], s28 offset:1792
s_buffer_load_dword s78, s[84:87], s28 offset:1920
s_mov_b32 s88, s76
s_branch mega_kernel_rs_s3
mega_kernel_rs_il70:
s_cbranch_execz mega_kernel_rs_il71
mega_kernel_rs_s2:
ds_read_b128 v[120:123], v5 offset:0
ds_read_b128 v[124:127], v5 offset:1024
ds_read_b128 v[128:131], v5 offset:2048
ds_read_b128 v[132:135], v5 offset:3072
v_lshrrev_b32 v5, 1, v17
s_waitcnt lgkmcnt(2)
v_pk_add_f32 v[120:121], v[120:121], v[124:125]
v_pk_add_f32 v[122:123], v[122:123], v[126:127]
s_waitcnt lgkmcnt(0)
v_pk_add_f32 v[128:129], v[128:129], v[132:133]
v_pk_add_f32 v[130:131], v[130:131], v[134:135]
v_pk_add_f32 v[120:121], v[120:121], v[128:129]
v_pk_add_f32 v[122:123], v[122:123], v[130:131]
v_cvt_pk_bf16_f32 v244, v120, v121
v_cvt_pk_bf16_f32 v245, v122, v123
ds_write_b64 v5, v[244:245] offset:17920
s_waitcnt lgkmcnt(0) vmcnt(0)
mega_kernel_rs_s3:
s_cmp_eq_u32 s27, 63
s_cbranch_scc1 mega_kernel_rs_slast
s_add_u32 s29, s33, 24576
s_barrier
s_cmp_eq_u32 s24, 3
s_cbranch_scc1 mega_kernel_rs_y3
s_add_u32 s77, s27, s82
s_bfe_u32 s28, s77, 0x30003
s_lshl_b32 s28, s28, 14
s_and_b32 s77, s77, 7
s_lshl_b32 s77, s77, 10
s_add_u32 s28, s28, s77
s_add_u32 s28, s28, s79
s_cmp_eq_u32 s24, 2
s_cbranch_scc1 mega_kernel_rs_kv2a
s_mov_b64 exec, s[48:49]
buffer_store_dwordx4 v[244:247], v22, s[84:87], s28 offen sc1
s_mov_b64 exec, -1
s_branch mega_kernel_rs_kvda
mega_kernel_rs_il71:
s_cbranch_execz mega_kernel_rs_il72
mega_kernel_rs_kv2a:
v_lshlrev_b32 v4, 3, v1
buffer_store_dwordx2 v[244:245], v4, s[84:87], s28 offen offset:512 sc1
mega_kernel_rs_kvda:
s_branch mega_kernel_rs_y4
mega_kernel_rs_y3:
s_add_u32 s76, s27, 2
s_cmp_lt_u32 s76, 63
s_cbranch_scc0 mega_kernel_rs_y4
mega_kernel_rs_y4:
s_branch mega_kernel_rs_b3
mega_kernel_rs_first:
v_add_u32 v5, s44, v17
ds_read_b128 v[156:159], v5 offset:0
ds_read_b128 v[160:163], v5 offset:1024
ds_read_b128 v[164:167], v5 offset:2048
ds_read_b128 v[168:171], v5 offset:3072
s_branch mega_kernel_rs_adone
mega_kernel_rs_il72:
s_cbranch_execz mega_kernel_rs_il73
mega_kernel_rs_slast:
s_cmp_eq_u32 s24, 3
s_cbranch_scc1 mega_kernel_rs_end
s_add_u32 s77, s27, s82
s_bfe_u32 s28, s77, 0x30003
s_lshl_b32 s28, s28, 14
s_and_b32 s77, s77, 7
s_lshl_b32 s77, s77, 10
s_add_u32 s28, s28, s77
s_add_u32 s28, s28, s79
s_cmp_eq_u32 s24, 2
s_cbranch_scc1 mega_kernel_rs_kv2b
s_mov_b64 exec, s[48:49]
buffer_store_dwordx4 v[244:247], v22, s[84:87], s28 offen sc1
s_mov_b64 exec, -1
s_branch mega_kernel_rs_kvdb
mega_kernel_rs_il73:
s_cbranch_execz mega_kernel_rs_iwd
mega_kernel_rs_kv2b:
v_lshlrev_b32 v4, 3, v1
buffer_store_dwordx2 v[244:245], v4, s[84:87], s28 offen offset:512 sc1
mega_kernel_rs_kvdb:
s_waitcnt vmcnt(0)
s_barrier
s_mov_b32 s76, 64
s_cmp_eq_u32 s24, 1
s_cbranch_scc0 mega_kernel_rs_end
v_mov_b32 v5, s76
s_mov_b64 exec, 1
buffer_store_dword v5, v228, s[84:87], s81 offen sc1
s_mov_b64 exec, -1
mega_kernel_rs_end:
s_endpgm
.section .rodata,"a"
.p2align 6
.amdhsa_kernel mega_kernel
  .amdhsa_next_free_vgpr 512
  .amdhsa_next_free_sgpr 102
  .amdhsa_accum_offset 256
  .amdhsa_group_segment_fixed_size 0
  .amdhsa_kernarg_size 104
  .amdhsa_user_sgpr_count 2
  .amdhsa_user_sgpr_kernarg_segment_ptr 1
  .amdhsa_system_sgpr_workgroup_id_x 1
.end_amdhsa_kernel
```

```asm
; @launch kernel=mega_kernel grid=(256,1,1) block=(256,1,1) lds=163840
.amdgcn_target "amdgcn-amd-amdhsa--gfx950"
.text
.globl mega_kernel
.p2align 8
.type mega_kernel,@function
mega_kernel:
s_cmp_ge_u32 s2, 256
s_cbranch_scc1 mega_kernel_exit
s_load_dwordx2 s[84:85], s[0:1], 96
s_load_dwordx2 s[72:73], s[0:1], 88
s_getreg_b32 s90, hwreg(HW_REG_XCC_ID)
s_and_b32 s90, s90, 7
v_mov_b32 v1, 0
v_mov_b32 v2, 1
s_lshl_b32 s91, s90, 4
s_mov_b32 s95, 0
s_mov_b32 s99, 0
s_waitcnt lgkmcnt(0)
s_mov_b32 s86, 268435456
s_mov_b32 s87, 0x00020000
s_mov_b32 s74, 256
s_mov_b32 s75, 0x00020000
v_cmp_eq_u32 vcc, 0, v0
s_and_saveexec_b64 s[88:89], vcc
s_cbranch_execz mega_kernel_tkd
s_lshl_b32 s92, s2, 13
s_add_u32 s92, s92, 167772160
buffer_atomic_add v2, v1, s[72:75], s91 offen sc0
buffer_load_dword v251, v1, s[84:87], s92 offen offset:2048 sc1
s_waitcnt vmcnt(1)
ds_write_b32 v1, v2
s_waitcnt lgkmcnt(0)
mega_kernel_tkd:
s_mov_b64 exec, s[88:89]
s_barrier
ds_read_b32 v2, v1
s_waitcnt lgkmcnt(0)
v_readfirstlane_b32 s96, v2
s_barrier
s_cmp_lt_u32 s96, 32
s_cbranch_scc1 mega_kernel_spec
v_and_b32 v3, 15, v0
v_lshlrev_b32 v3, 4, v3
s_branch mega_kernel_syx
mega_kernel_syxw:
s_sleep 4
mega_kernel_syx:
buffer_load_dword v2, v3, s[72:75], 0 offen sc1
s_waitcnt vmcnt(0)
mega_kernel_syxp:
s_cmp_eq_u32 s95, 1
s_cbranch_scc0 mega_kernel_syxf
v_readlane_b32 s76, v2, 14
s_mov_b32 s98, 0
s_cmp_eq_u32 s76, 32
s_cbranch_scc0 mega_kernel_syxw
s_branch mega_kernel_syxd
mega_kernel_syxf:
s_mov_b32 s77, 0
s_mov_b32 s78, 0
v_readlane_b32 s76, v2, 0
s_add_u32 s77, s77, s76
s_xor_b32 s76, s76, 32
s_or_b32 s78, s78, s76
v_readlane_b32 s76, v2, 1
s_add_u32 s77, s77, s76
s_xor_b32 s76, s76, 32
s_or_b32 s78, s78, s76
v_readlane_b32 s76, v2, 2
s_add_u32 s77, s77, s76
s_xor_b32 s76, s76, 32
s_or_b32 s78, s78, s76
v_readlane_b32 s76, v2, 3
s_add_u32 s77, s77, s76
s_xor_b32 s76, s76, 32
s_or_b32 s78, s78, s76
v_readlane_b32 s76, v2, 4
s_add_u32 s77, s77, s76
s_xor_b32 s76, s76, 32
s_or_b32 s78, s78, s76
v_readlane_b32 s76, v2, 5
s_add_u32 s77, s77, s76
s_xor_b32 s76, s76, 32
s_or_b32 s78, s78, s76
v_readlane_b32 s76, v2, 6
s_add_u32 s77, s77, s76
s_xor_b32 s76, s76, 32
s_or_b32 s78, s78, s76
v_readlane_b32 s76, v2, 7
s_add_u32 s77, s77, s76
s_xor_b32 s76, s76, 32
s_or_b32 s78, s78, s76
s_cmp_eq_u32 s77, 256
s_cbranch_scc0 mega_kernel_syxw
v_mov_b32 v252, v2
s_cmp_eq_u32 s78, 0
s_cbranch_scc0 mega_kernel_slowent
v_readlane_b32 s76, v2, 10
v_readlane_b32 s77, v2, 8
s_cmp_eq_u32 s76, 32
s_cbranch_scc0 mega_kernel_syxw
s_cmp_gt_u32 s77, 16
s_cselect_b32 s98, 1, 0
mega_kernel_syxd:
mega_kernel_slowent:
s_mov_b64 exec, -1
s_waitcnt vmcnt(0) lgkmcnt(0)
s_barrier
s_mov_b32 s97, s96
v_readlane_b32 s76, v252, 0
s_cmp_gt_u32 s90, 0
s_cselect_b32 s76, s76, 0
s_add_u32 s97, s97, s76
v_readlane_b32 s76, v252, 1
s_cmp_gt_u32 s90, 1
s_cselect_b32 s76, s76, 0
s_add_u32 s97, s97, s76
v_readlane_b32 s76, v252, 2
s_cmp_gt_u32 s90, 2
s_cselect_b32 s76, s76, 0
s_add_u32 s97, s97, s76
v_readlane_b32 s76, v252, 3
s_cmp_gt_u32 s90, 3
s_cselect_b32 s76, s76, 0
s_add_u32 s97, s97, s76
v_readlane_b32 s76, v252, 4
s_cmp_gt_u32 s90, 4
s_cselect_b32 s76, s76, 0
s_add_u32 s97, s97, s76
v_readlane_b32 s76, v252, 5
s_cmp_gt_u32 s90, 5
s_cselect_b32 s76, s76, 0
s_add_u32 s97, s97, s76
v_readlane_b32 s76, v252, 6
s_cmp_gt_u32 s90, 6
s_cselect_b32 s76, s76, 0
s_add_u32 s97, s97, s76
v_mov_b32 v1, 0
v_mov_b32 v2, 1
v_cmp_eq_u32 vcc, 0, v0
s_and_saveexec_b64 s[88:89], vcc
s_cbranch_execz mega_kernel_sb1
buffer_atomic_add v2, v1, s[72:75], 0 offen offset:192 sc1
mega_kernel_sb1:
s_mov_b64 exec, s[88:89]
mega_kernel_sb2:
s_sleep 4
buffer_load_dword v2, v1, s[72:75], 0 offen offset:192 sc1
s_waitcnt vmcnt(0)
v_cmp_ne_u32 vcc, 256, v2
s_cbranch_vccnz mega_kernel_sb2
s_mov_b32 s95, 1
s_lshr_b32 s30, s97, 5
s_and_b32 s31, s97, 31
s_cmp_lt_u32 s97, 128
s_cbranch_scc1 mega_kernel_recs
s_sub_u32 s94, s97, 128
s_branch mega_kernel_bulk
mega_kernel_spec:
s_mov_b32 s30, s90
s_mov_b32 s31, s96
s_cmp_lt_u32 s90, 4
s_cbranch_scc1 mega_kernel_recf
s_sub_u32 s94, s90, 4
s_lshl_b32 s94, s94, 5
s_add_u32 s94, s94, s96
mega_kernel_bulk:
s_lshr_b32 s91, s94, 5
s_and_b32 s40, s94, 31
s_and_b32 s92, s91, 1
s_lshl_b32 s92, s92, 5
s_add_u32 s92, s92, s40
s_cmp_eq_u32 s91, 0
s_cbranch_scc1 mega_kernel_rk
s_cmp_eq_u32 s91, 1
s_cbranch_scc1 mega_kernel_rv
s_cmp_eq_u32 s91, 2
s_cbranch_scc1 mega_kernel_noinit
v_mov_b32 v8, -1
v_mov_b32 v9, -1
v_mov_b32 v10, -1
v_mov_b32 v11, -1
v_lshlrev_b32 v1, 4, v0
v_mov_b32 v2, 0
v_cmp_gt_u32 vcc, 64, v0
s_cbranch_vccz mega_kernel_nv
s_cmp_eq_u32 s95, 0
s_cbranch_scc0 mega_kernel_nv
s_lshr_b32 s60, s2, 1
s_lshl_b32 s60, s60, 14
s_and_b32 s61, s40, 1
s_lshl_b32 s66, s61, 13
s_add_u32 s60, s60, s66
s_and_b32 s66, s2, 1
s_lshl_b32 s66, s66, 10
s_add_u32 s60, s60, s66
s_add_u32 s60, s60, 167772160
s_mov_b32 s66, 0x7fffffff
s_mov_b32 s67, 0x7fffffff
s_mov_b64 exec, 0xff
s_waitcnt vmcnt(0)
s_memtime s[62:63]
s_waitcnt lgkmcnt(0)
buffer_store_dwordx4 v[8:11], v1, s[84:87], s60 offen offset:0 sc1
s_waitcnt vmcnt(0)
s_memtime s[64:65]
s_xor_b32 s60, s60, 8192
s_waitcnt lgkmcnt(0)
s_sub_u32 s64, s64, s62
s_min_u32 s66, s66, s64
s_memtime s[62:63]
s_waitcnt lgkmcnt(0)
buffer_store_dwordx4 v[8:11], v1, s[84:87], s60 offen offset:0 sc1
s_waitcnt vmcnt(0)
s_memtime s[64:65]
s_xor_b32 s60, s60, 8192
s_waitcnt lgkmcnt(0)
s_sub_u32 s64, s64, s62
s_min_u32 s67, s67, s64
s_memtime s[62:63]
s_waitcnt lgkmcnt(0)
buffer_store_dwordx4 v[8:11], v1, s[84:87], s60 offen offset:256 sc1
s_waitcnt vmcnt(0)
s_memtime s[64:65]
s_xor_b32 s60, s60, 8192
s_waitcnt lgkmcnt(0)
s_sub_u32 s64, s64, s62
s_min_u32 s66, s66, s64
s_memtime s[62:63]
s_waitcnt lgkmcnt(0)
buffer_store_dwordx4 v[8:11], v1, s[84:87], s60 offen offset:256 sc1
s_waitcnt vmcnt(0)
s_memtime s[64:65]
s_xor_b32 s60, s60, 8192
s_waitcnt lgkmcnt(0)
s_sub_u32 s64, s64, s62
s_min_u32 s67, s67, s64
s_cmp_lt_u32 s67, s66
s_cselect_b32 s60, 1, 0
s_xor_b32 s60, s60, s61
s_lshr_b32 s61, s90, 2
s_xor_b32 s60, s60, s61
v_mov_b32 v3, s60
s_mov_b64 exec, 1
buffer_atomic_add v3, v2, s[72:75], 0 offen offset:128 sc1
s_mov_b64 exec, -1
mega_kernel_nv:
s_barrier
s_lshl_b32 s60, s40, 12
s_add_u32 s60, s60, 67108864
buffer_store_dwordx4 v[8:11], v1, s[84:87], s60 offen sc1
s_add_u32 s60, s60, 131072
buffer_store_dwordx4 v[8:11], v1, s[84:87], s60 offen sc1
s_add_u32 s60, s60, 131072
buffer_store_dwordx4 v[8:11], v1, s[84:87], s60 offen sc1
s_add_u32 s60, s60, 131072
buffer_store_dwordx4 v[8:11], v1, s[84:87], s60 offen sc1
s_add_u32 s60, s60, 131072
buffer_store_dwordx4 v[8:11], v1, s[84:87], s60 offen sc1
s_add_u32 s60, s60, 131072
buffer_store_dwordx4 v[8:11], v1, s[84:87], s60 offen sc1
s_add_u32 s60, s60, 131072
buffer_store_dwordx4 v[8:11], v1, s[84:87], s60 offen sc1
s_add_u32 s60, s60, 131072
buffer_store_dwordx4 v[8:11], v1, s[84:87], s60 offen sc1
s_add_u32 s60, s60, 131072
buffer_store_dwordx4 v[8:11], v1, s[84:87], s60 offen sc1
s_add_u32 s60, s60, 131072
buffer_store_dwordx4 v[8:11], v1, s[84:87], s60 offen sc1
s_add_u32 s60, s60, 131072
buffer_store_dwordx4 v[8:11], v1, s[84:87], s60 offen sc1
s_add_u32 s60, s60, 131072
buffer_store_dwordx4 v[8:11], v1, s[84:87], s60 offen sc1
s_add_u32 s60, s60, 131072
buffer_store_dwordx4 v[8:11], v1, s[84:87], s60 offen sc1
s_add_u32 s60, s60, 131072
buffer_store_dwordx4 v[8:11], v1, s[84:87], s60 offen sc1
s_add_u32 s60, s60, 131072
buffer_store_dwordx4 v[8:11], v1, s[84:87], s60 offen sc1
s_add_u32 s60, s60, 131072
buffer_store_dwordx4 v[8:11], v1, s[84:87], s60 offen sc1
s_add_u32 s60, s60, 131072
s_lshr_b32 s62, s40, 1
s_and_b32 s63, s40, 1
s_add_u32 s63, s63, s62
s_lshl_b32 s62, s62, 19
s_and_b32 s64, s63, 14
s_lshl_b32 s64, s64, 13
s_add_u32 s62, s62, s64
s_and_b32 s64, s63, 1
s_lshl_b32 s64, s64, 12
s_add_u32 s62, s62, s64
s_add_u32 s62, s62, 150994944
s_add_u32 s62, s62, 8192
s_cmp_lt_u32 s40, 16
s_cbranch_scc0 mega_kernel_pz
buffer_store_dwordx4 v[8:11], v1, s[84:87], s60 offen sc1
mega_kernel_pz:
s_waitcnt vmcnt(0)
s_barrier
v_mov_b32 v3, 1
s_lshl_b32 s62, s95, 6
v_cmp_eq_u32 vcc, 0, v0
s_and_saveexec_b64 s[60:61], vcc
s_cbranch_execz mega_kernel_xps
buffer_atomic_add v3, v2, s[72:75], s62 offen offset:160 sc1
mega_kernel_xps:
s_mov_b64 exec, s[60:61]
mega_kernel_noinit:
s_cmp_eq_u32 s91, 2
s_cbranch_scc1 mega_kernel_nohold
v_and_b32 v3, 15, v0
v_lshlrev_b32 v3, 4, v3
s_branch mega_kernel_syh
mega_kernel_syhw:
s_sleep 4
mega_kernel_syh:
buffer_load_dword v2, v3, s[72:75], 0 offen sc1
s_waitcnt vmcnt(0)
mega_kernel_syhp:
s_cmp_eq_u32 s95, 1
s_cbranch_scc0 mega_kernel_syhf
v_readlane_b32 s76, v2, 14
s_mov_b32 s98, 0
s_cmp_eq_u32 s76, 32
s_cbranch_scc0 mega_kernel_syhw
s_branch mega_kernel_syhd
mega_kernel_syhf:
s_mov_b32 s77, 0
s_mov_b32 s78, 0
v_readlane_b32 s76, v2, 0
s_add_u32 s77, s77, s76
s_xor_b32 s76, s76, 32
s_or_b32 s78, s78, s76
v_readlane_b32 s76, v2, 1
s_add_u32 s77, s77, s76
s_xor_b32 s76, s76, 32
s_or_b32 s78, s78, s76
v_readlane_b32 s76, v2, 2
s_add_u32 s77, s77, s76
s_xor_b32 s76, s76, 32
s_or_b32 s78, s78, s76
v_readlane_b32 s76, v2, 3
s_add_u32 s77, s77, s76
s_xor_b32 s76, s76, 32
s_or_b32 s78, s78, s76
v_readlane_b32 s76, v2, 4
s_add_u32 s77, s77, s76
s_xor_b32 s76, s76, 32
s_or_b32 s78, s78, s76
v_readlane_b32 s76, v2, 5
s_add_u32 s77, s77, s76
s_xor_b32 s76, s76, 32
s_or_b32 s78, s78, s76
v_readlane_b32 s76, v2, 6
s_add_u32 s77, s77, s76
s_xor_b32 s76, s76, 32
s_or_b32 s78, s78, s76
v_readlane_b32 s76, v2, 7
s_add_u32 s77, s77, s76
s_xor_b32 s76, s76, 32
s_or_b32 s78, s78, s76
s_cmp_eq_u32 s77, 256
s_cbranch_scc0 mega_kernel_syhw
v_mov_b32 v252, v2
s_cmp_eq_u32 s78, 0
s_cbranch_scc0 mega_kernel_slowent
v_readlane_b32 s76, v2, 10
v_readlane_b32 s77, v2, 8
s_cmp_eq_u32 s76, 32
s_cbranch_scc0 mega_kernel_syhw
s_cmp_gt_u32 s77, 16
s_cselect_b32 s98, 1, 0
mega_kernel_syhd:
s_xor_b32 s76, s98, 1
s_lshl_b32 s76, s76, 13
s_lshl_b32 s77, s40, 7
s_add_u32 s76, s76, s77
s_add_u32 s76, s76, 69206016
v_mov_b32 v1, 0
mega_kernel_hold:
s_sleep 12
buffer_load_dword v2, v1, s[84:87], s76 offen sc1
s_waitcnt vmcnt(0)
v_cmp_gt_i32 vcc, 1, v2
s_cbranch_vccnz mega_kernel_hold
mega_kernel_nohold:
s_cmp_eq_u32 s91, 2
s_cbranch_scc0 mega_kernel_rd
s_load_dwordx2 s[4:5], s[0:1], 16
s_load_dwordx2 s[8:9], s[0:1], 0
v_lshrrev_b32 v2, 6, v0
v_and_b32 v1, 63, v0
v_readfirstlane_b32 s41, v2
v_lshlrev_b32 v5, 4, v1
s_waitcnt lgkmcnt(0)
s_mov_b32 s6, 8388608
s_mov_b32 s7, 0x00020000
s_mov_b32 s10, 4194304
s_mov_b32 s11, 0x00020000
s_lshl_b32 s43, s40, 8
s_lshl_b32 s44, s41, 6
s_add_u32 s48, s43, s44
s_and_b32 s43, s48, 0x7ff
v_add_u32 v19, s43, v1
v_lshlrev_b32 v19, 7, v19
s_mov_b32 s43, 0
buffer_load_dword v250, v19, s[8:11], s43 offen
s_nop 0
v_lshrrev_b32 v2, 3, v1
s_lshl_b32 s43, s41, 3
v_add_u32 v2, s43, v2
v_bfe_u32 v3, v2, 1, 3
v_and_b32 v4, 7, v1
v_xor_b32 v3, v3, v4
v_lshlrev_b32 v6, 11, v2
v_lshl_add_u32 v6, v3, 4, v6
s_lshl_b32 s46, s41, 10
v_and_b32 v2, 15, v1
v_bfe_u32 v3, v2, 1, 3
v_lshrrev_b32 v4, 4, v1
v_xor_b32 v3, v3, v4
v_lshlrev_b32 v8, 7, v2
v_lshl_add_u32 v8, v3, 4, v8
v_xor_b32 v9, 64, v8
v_add_u32 v10, 0x10000, v8
v_add_u32 v11, 0x10000, v9
v_mov_b32 v7, v5
s_lshl_b32 s47, s40, 2
s_add_u32 s47, s47, s41
s_mov_b32 s42, 0
s_mov_b32 s50, 0
s_add_u32 m0, s46, 0
s_nop 0
buffer_load_dwordx4 v6, s[8:11], s50 offen offset:0 lds
s_add_u32 m0, s46, 3968
s_nop 0
buffer_load_dwordx4 v6, s[8:11], s50 offen offset:128 lds
s_add_u32 m0, s46, 7936
s_nop 0
buffer_load_dwordx4 v6, s[8:11], s50 offen offset:256 lds
s_add_u32 m0, s46, 11904
s_nop 0
buffer_load_dwordx4 v6, s[8:11], s50 offen offset:384 lds
s_add_u32 m0, s46, 15872
s_nop 0
buffer_load_dwordx4 v6, s[8:11], s50 offen offset:512 lds
s_add_u32 m0, s46, 19840
s_nop 0
buffer_load_dwordx4 v6, s[8:11], s50 offen offset:640 lds
s_add_u32 m0, s46, 23808
s_nop 0
buffer_load_dwordx4 v6, s[8:11], s50 offen offset:768 lds
s_add_u32 m0, s46, 27776
s_nop 0
buffer_load_dwordx4 v6, s[8:11], s50 offen offset:896 lds
s_add_u32 m0, s46, 31744
s_nop 0
buffer_load_dwordx4 v6, s[8:11], s50 offen offset:1024 lds
s_add_u32 m0, s46, 35712
s_nop 0
buffer_load_dwordx4 v6, s[8:11], s50 offen offset:1152 lds
s_add_u32 m0, s46, 39680
s_nop 0
buffer_load_dwordx4 v6, s[8:11], s50 offen offset:1280 lds
s_add_u32 m0, s46, 43648
s_nop 0
buffer_load_dwordx4 v6, s[8:11], s50 offen offset:1408 lds
s_add_u32 m0, s46, 47616
s_nop 0
buffer_load_dwordx4 v6, s[8:11], s50 offen offset:1536 lds
s_add_u32 m0, s46, 51584
s_nop 0
buffer_load_dwordx4 v6, s[8:11], s50 offen offset:1664 lds
s_add_u32 m0, s46, 55552
s_nop 0
buffer_load_dwordx4 v6, s[8:11], s50 offen offset:1792 lds
s_add_u32 m0, s46, 59520
s_nop 0
buffer_load_dwordx4 v6, s[8:11], s50 offen offset:1920 lds
v_lshrrev_b32 v2, 2, v1
v_and_b32 v3, 3, v1
v_lshlrev_b32 v16, 13, v2
v_lshl_add_u32 v16, v3, 4, v16
v_add_u32 v16, s48, v16
s_mul_i32 s45, s41, 24576
s_add_u32 s45, s45, 65536
v_bfe_u32 v17, v1, 2, 2
v_lshrrev_b32 v18, 4, v1
v_lshl_add_u32 v17, v18, 3, v17
v_lshlrev_b32 v17, 6, v17
v_lshl_add_u32 v17, v3, 4, v17
v_add_u32 v17, s45, v17
s_and_b32 s43, s40, 3
s_lshl_b32 s43, s43, 2
s_add_u32 s43, s43, s41
s_lshl_b32 s43, s43, 3
v_and_b32 v12, 7, v1
v_add_u32 v12, s43, v12
s_lshr_b32 s43, s40, 2
s_lshl_b32 s43, s43, 10
s_add_u32 s44, s43, 896
s_add_u32 s43, s43, 384
s_cmp_ge_u32 s40, 28
s_cselect_b32 s44, s44, s43
v_mov_b32 v13, s43
v_mov_b32 v14, s44
v_cmp_gt_u32 vcc, 32, v1
s_nop 1
v_cndmask_b32 v13, v14, v13, vcc
v_lshl_add_u32 v12, v12, 13, v13
s_mov_b32 s44, 0
buffer_load_dword v250, v12, s[4:7], s44 offen
s_add_u32 m0, s45, 0
s_mov_b32 s44, 0
buffer_load_dwordx4 v16, s[4:7], s44 offen lds
s_add_u32 m0, s45, 1024
s_mov_b32 s44, 131072
buffer_load_dwordx4 v16, s[4:7], s44 offen lds
s_add_u32 m0, s45, 2048
s_mov_b32 s44, 262144
buffer_load_dwordx4 v16, s[4:7], s44 offen lds
s_add_u32 m0, s45, 3072
s_mov_b32 s44, 393216
buffer_load_dwordx4 v16, s[4:7], s44 offen lds
s_add_u32 m0, s45, 4096
s_mov_b32 s44, 524288
buffer_load_dwordx4 v16, s[4:7], s44 offen lds
s_add_u32 m0, s45, 5120
s_mov_b32 s44, 655360
buffer_load_dwordx4 v16, s[4:7], s44 offen lds
s_add_u32 m0, s45, 6144
s_mov_b32 s44, 786432
buffer_load_dwordx4 v16, s[4:7], s44 offen lds
s_add_u32 m0, s45, 7168
s_mov_b32 s44, 917504
buffer_load_dwordx4 v16, s[4:7], s44 offen lds
s_mov_b32 s44, 1048576
buffer_load_dword v250, v12, s[4:7], s44 offen
s_add_u32 m0, s45, 8192
s_mov_b32 s44, 1048576
buffer_load_dwordx4 v16, s[4:7], s44 offen lds
s_add_u32 m0, s45, 9216
s_mov_b32 s44, 1179648
buffer_load_dwordx4 v16, s[4:7], s44 offen lds
s_add_u32 m0, s45, 10240
s_mov_b32 s44, 1310720
buffer_load_dwordx4 v16, s[4:7], s44 offen lds
s_add_u32 m0, s45, 11264
s_mov_b32 s44, 1441792
buffer_load_dwordx4 v16, s[4:7], s44 offen lds
s_add_u32 m0, s45, 12288
s_mov_b32 s44, 1572864
buffer_load_dwordx4 v16, s[4:7], s44 offen lds
s_add_u32 m0, s45, 13312
s_mov_b32 s44, 1703936
buffer_load_dwordx4 v16, s[4:7], s44 offen lds
s_add_u32 m0, s45, 14336
s_mov_b32 s44, 1835008
buffer_load_dwordx4 v16, s[4:7], s44 offen lds
s_add_u32 m0, s45, 15360
s_mov_b32 s44, 1966080
buffer_load_dwordx4 v16, s[4:7], s44 offen lds
s_mov_b32 s44, 2097152
buffer_load_dword v250, v12, s[4:7], s44 offen
s_add_u32 m0, s45, 16384
s_mov_b32 s44, 2097152
buffer_load_dwordx4 v16, s[4:7], s44 offen lds
s_add_u32 m0, s45, 17408
s_mov_b32 s44, 2228224
buffer_load_dwordx4 v16, s[4:7], s44 offen lds
s_add_u32 m0, s45, 18432
s_mov_b32 s44, 2359296
buffer_load_dwordx4 v16, s[4:7], s44 offen lds
s_add_u32 m0, s45, 19456
s_mov_b32 s44, 2490368
buffer_load_dwordx4 v16, s[4:7], s44 offen lds
s_add_u32 m0, s45, 20480
s_mov_b32 s44, 2621440
buffer_load_dwordx4 v16, s[4:7], s44 offen lds
s_add_u32 m0, s45, 21504
s_mov_b32 s44, 2752512
buffer_load_dwordx4 v16, s[4:7], s44 offen lds
s_add_u32 m0, s45, 22528
s_mov_b32 s44, 2883584
buffer_load_dwordx4 v16, s[4:7], s44 offen lds
s_add_u32 m0, s45, 23552
s_mov_b32 s44, 3014656
buffer_load_dwordx4 v16, s[4:7], s44 offen lds
s_waitcnt vmcnt(18)
s_barrier
ds_read_b64_tr_b16 a[0:1], v17 offset:0
ds_read_b64_tr_b16 a[2:3], v17 offset:256
ds_read_b64_tr_b16 a[4:5], v17 offset:8
ds_read_b64_tr_b16 a[6:7], v17 offset:264
ds_read_b64_tr_b16 a[8:9], v17 offset:2048
ds_read_b64_tr_b16 a[10:11], v17 offset:2304
ds_read_b64_tr_b16 a[12:13], v17 offset:2056
ds_read_b64_tr_b16 a[14:15], v17 offset:2312
s_waitcnt lgkmcnt(0)
ds_read_b64_tr_b16 a[16:17], v17 offset:4096
ds_read_b64_tr_b16 a[18:19], v17 offset:4352
ds_read_b64_tr_b16 a[20:21], v17 offset:4104
ds_read_b64_tr_b16 a[22:23], v17 offset:4360
ds_read_b64_tr_b16 a[24:25], v17 offset:6144
ds_read_b64_tr_b16 a[26:27], v17 offset:6400
ds_read_b64_tr_b16 a[28:29], v17 offset:6152
ds_read_b64_tr_b16 a[30:31], v17 offset:6408
s_waitcnt lgkmcnt(0)
s_mov_b32 s44, 3145728
buffer_load_dword v250, v12, s[4:7], s44 offen
s_add_u32 m0, s45, 0
s_mov_b32 s44, 3145728
buffer_load_dwordx4 v16, s[4:7], s44 offen lds
s_add_u32 m0, s45, 1024
s_mov_b32 s44, 3276800
buffer_load_dwordx4 v16, s[4:7], s44 offen lds
s_add_u32 m0, s45, 2048
s_mov_b32 s44, 3407872
buffer_load_dwordx4 v16, s[4:7], s44 offen lds
s_add_u32 m0, s45, 3072
s_mov_b32 s44, 3538944
buffer_load_dwordx4 v16, s[4:7], s44 offen lds
s_add_u32 m0, s45, 4096
s_mov_b32 s44, 3670016
buffer_load_dwordx4 v16, s[4:7], s44 offen lds
s_add_u32 m0, s45, 5120
s_mov_b32 s44, 3801088
buffer_load_dwordx4 v16, s[4:7], s44 offen lds
s_add_u32 m0, s45, 6144
s_mov_b32 s44, 3932160
buffer_load_dwordx4 v16, s[4:7], s44 offen lds
s_add_u32 m0, s45, 7168
s_mov_b32 s44, 4063232
buffer_load_dwordx4 v16, s[4:7], s44 offen lds
ds_read_b128 v[20:23], v8 offset:0
ds_read_b128 v[24:27], v8 offset:2048
ds_read_b128 v[28:31], v9 offset:0
ds_read_b128 v[32:35], v9 offset:2048
ds_read_b128 v[36:39], v8 offset:4096
ds_read_b128 v[40:43], v8 offset:6144
ds_read_b128 v[44:47], v9 offset:4096
ds_read_b128 v[48:51], v9 offset:6144
s_waitcnt lgkmcnt(0)
v_mfma_f32_16x16x32_bf16 v[52:55], a[0:3], v[20:23], 0
v_mfma_f32_16x16x32_bf16 v[56:59], a[4:7], v[20:23], 0
v_mfma_f32_16x16x32_bf16 v[60:63], a[0:3], v[24:27], 0
v_mfma_f32_16x16x32_bf16 v[64:67], a[4:7], v[24:27], 0
v_mfma_f32_16x16x32_bf16 v[52:55], a[8:11], v[28:31], v[52:55]
v_mfma_f32_16x16x32_bf16 v[56:59], a[12:15], v[28:31], v[56:59]
v_mfma_f32_16x16x32_bf16 v[60:63], a[8:11], v[32:35], v[60:63]
v_mfma_f32_16x16x32_bf16 v[64:67], a[12:15], v[32:35], v[64:67]
v_mfma_f32_16x16x32_bf16 v[52:55], a[16:19], v[36:39], v[52:55]
v_mfma_f32_16x16x32_bf16 v[56:59], a[20:23], v[36:39], v[56:59]
v_mfma_f32_16x16x32_bf16 v[60:63], a[16:19], v[40:43], v[60:63]
v_mfma_f32_16x16x32_bf16 v[64:67], a[20:23], v[40:43], v[64:67]
v_mfma_f32_16x16x32_bf16 v[52:55], a[24:27], v[44:47], v[52:55]
v_mfma_f32_16x16x32_bf16 v[56:59], a[28:31], v[44:47], v[56:59]
v_mfma_f32_16x16x32_bf16 v[60:63], a[24:27], v[48:51], v[60:63]
v_mfma_f32_16x16x32_bf16 v[64:67], a[28:31], v[48:51], v[64:67]
s_waitcnt vmcnt(18)
ds_read_b64_tr_b16 a[32:33], v17 offset:8192
ds_read_b64_tr_b16 a[34:35], v17 offset:8448
ds_read_b64_tr_b16 a[36:37], v17 offset:8200
ds_read_b64_tr_b16 a[38:39], v17 offset:8456
ds_read_b64_tr_b16 a[40:41], v17 offset:10240
ds_read_b64_tr_b16 a[42:43], v17 offset:10496
ds_read_b64_tr_b16 a[44:45], v17 offset:10248
ds_read_b64_tr_b16 a[46:47], v17 offset:10504
s_waitcnt lgkmcnt(0)
ds_read_b64_tr_b16 a[48:49], v17 offset:12288
ds_read_b64_tr_b16 a[50:51], v17 offset:12544
ds_read_b64_tr_b16 a[52:53], v17 offset:12296
ds_read_b64_tr_b16 a[54:55], v17 offset:12552
ds_read_b64_tr_b16 a[56:57], v17 offset:14336
ds_read_b64_tr_b16 a[58:59], v17 offset:14592
ds_read_b64_tr_b16 a[60:61], v17 offset:14344
ds_read_b64_tr_b16 a[62:63], v17 offset:14600
s_waitcnt lgkmcnt(0)
s_mov_b32 s44, 4194304
buffer_load_dword v250, v12, s[4:7], s44 offen
s_add_u32 m0, s45, 8192
s_mov_b32 s44, 4194304
buffer_load_dwordx4 v16, s[4:7], s44 offen lds
s_add_u32 m0, s45, 9216
s_mov_b32 s44, 4325376
buffer_load_dwordx4 v16, s[4:7], s44 offen lds
s_add_u32 m0, s45, 10240
s_mov_b32 s44, 4456448
buffer_load_dwordx4 v16, s[4:7], s44 offen lds
s_add_u32 m0, s45, 11264
s_mov_b32 s44, 4587520
buffer_load_dwordx4 v16, s[4:7], s44 offen lds
s_add_u32 m0, s45, 12288
s_mov_b32 s44, 4718592
buffer_load_dwordx4 v16, s[4:7], s44 offen lds
s_add_u32 m0, s45, 13312
s_mov_b32 s44, 4849664
buffer_load_dwordx4 v16, s[4:7], s44 offen lds
s_add_u32 m0, s45, 14336
s_mov_b32 s44, 4980736
buffer_load_dwordx4 v16, s[4:7], s44 offen lds
s_add_u32 m0, s45, 15360
s_mov_b32 s44, 5111808
buffer_load_dwordx4 v16, s[4:7], s44 offen lds
ds_read_b128 v[20:23], v8 offset:8192
ds_read_b128 v[24:27], v8 offset:10240
ds_read_b128 v[28:31], v9 offset:8192
ds_read_b128 v[32:35], v9 offset:10240
ds_read_b128 v[36:39], v8 offset:12288
ds_read_b128 v[40:43], v8 offset:14336
ds_read_b128 v[44:47], v9 offset:12288
ds_read_b128 v[48:51], v9 offset:14336
s_waitcnt lgkmcnt(0)
v_mfma_f32_16x16x32_bf16 v[52:55], a[32:35], v[20:23], v[52:55]
v_mfma_f32_16x16x32_bf16 v[56:59], a[36:39], v[20:23], v[56:59]
v_mfma_f32_16x16x32_bf16 v[60:63], a[32:35], v[24:27], v[60:63]
v_mfma_f32_16x16x32_bf16 v[64:67], a[36:39], v[24:27], v[64:67]
v_mfma_f32_16x16x32_bf16 v[52:55], a[40:43], v[28:31], v[52:55]
v_mfma_f32_16x16x32_bf16 v[56:59], a[44:47], v[28:31], v[56:59]
v_mfma_f32_16x16x32_bf16 v[60:63], a[40:43], v[32:35], v[60:63]
v_mfma_f32_16x16x32_bf16 v[64:67], a[44:47], v[32:35], v[64:67]
v_mfma_f32_16x16x32_bf16 v[52:55], a[48:51], v[36:39], v[52:55]
v_mfma_f32_16x16x32_bf16 v[56:59], a[52:55], v[36:39], v[56:59]
v_mfma_f32_16x16x32_bf16 v[60:63], a[48:51], v[40:43], v[60:63]
v_mfma_f32_16x16x32_bf16 v[64:67], a[52:55], v[40:43], v[64:67]
v_mfma_f32_16x16x32_bf16 v[52:55], a[56:59], v[44:47], v[52:55]
v_mfma_f32_16x16x32_bf16 v[56:59], a[60:63], v[44:47], v[56:59]
v_mfma_f32_16x16x32_bf16 v[60:63], a[56:59], v[48:51], v[60:63]
v_mfma_f32_16x16x32_bf16 v[64:67], a[60:63], v[48:51], v[64:67]
s_waitcnt vmcnt(18)
ds_read_b64_tr_b16 a[64:65], v17 offset:16384
ds_read_b64_tr_b16 a[66:67], v17 offset:16640
ds_read_b64_tr_b16 a[68:69], v17 offset:16392
ds_read_b64_tr_b16 a[70:71], v17 offset:16648
ds_read_b64_tr_b16 a[72:73], v17 offset:18432
ds_read_b64_tr_b16 a[74:75], v17 offset:18688
ds_read_b64_tr_b16 a[76:77], v17 offset:18440
ds_read_b64_tr_b16 a[78:79], v17 offset:18696
s_waitcnt lgkmcnt(0)
ds_read_b64_tr_b16 a[80:81], v17 offset:20480
ds_read_b64_tr_b16 a[82:83], v17 offset:20736
ds_read_b64_tr_b16 a[84:85], v17 offset:20488
ds_read_b64_tr_b16 a[86:87], v17 offset:20744
ds_read_b64_tr_b16 a[88:89], v17 offset:22528
ds_read_b64_tr_b16 a[90:91], v17 offset:22784
ds_read_b64_tr_b16 a[92:93], v17 offset:22536
ds_read_b64_tr_b16 a[94:95], v17 offset:22792
s_waitcnt lgkmcnt(0)
s_mov_b32 s44, 5242880
buffer_load_dword v250, v12, s[4:7], s44 offen
s_add_u32 m0, s45, 16384
s_mov_b32 s44, 5242880
buffer_load_dwordx4 v16, s[4:7], s44 offen lds
s_add_u32 m0, s45, 17408
s_mov_b32 s44, 5373952
buffer_load_dwordx4 v16, s[4:7], s44 offen lds
s_add_u32 m0, s45, 18432
s_mov_b32 s44, 5505024
buffer_load_dwordx4 v16, s[4:7], s44 offen lds
s_add_u32 m0, s45, 19456
s_mov_b32 s44, 5636096
buffer_load_dwordx4 v16, s[4:7], s44 offen lds
s_add_u32 m0, s45, 20480
s_mov_b32 s44, 5767168
buffer_load_dwordx4 v16, s[4:7], s44 offen lds
s_add_u32 m0, s45, 21504
s_mov_b32 s44, 5898240
buffer_load_dwordx4 v16, s[4:7], s44 offen lds
s_add_u32 m0, s45, 22528
s_mov_b32 s44, 6029312
buffer_load_dwordx4 v16, s[4:7], s44 offen lds
s_add_u32 m0, s45, 23552
s_mov_b32 s44, 6160384
buffer_load_dwordx4 v16, s[4:7], s44 offen lds
ds_read_b128 v[20:23], v8 offset:16384
ds_read_b128 v[24:27], v8 offset:18432
ds_read_b128 v[28:31], v9 offset:16384
ds_read_b128 v[32:35], v9 offset:18432
ds_read_b128 v[36:39], v8 offset:20480
ds_read_b128 v[40:43], v8 offset:22528
ds_read_b128 v[44:47], v9 offset:20480
ds_read_b128 v[48:51], v9 offset:22528
s_waitcnt lgkmcnt(0)
v_mfma_f32_16x16x32_bf16 v[52:55], a[64:67], v[20:23], v[52:55]
v_mfma_f32_16x16x32_bf16 v[56:59], a[68:71], v[20:23], v[56:59]
v_mfma_f32_16x16x32_bf16 v[60:63], a[64:67], v[24:27], v[60:63]
v_mfma_f32_16x16x32_bf16 v[64:67], a[68:71], v[24:27], v[64:67]
v_mfma_f32_16x16x32_bf16 v[52:55], a[72:75], v[28:31], v[52:55]
v_mfma_f32_16x16x32_bf16 v[56:59], a[76:79], v[28:31], v[56:59]
v_mfma_f32_16x16x32_bf16 v[60:63], a[72:75], v[32:35], v[60:63]
v_mfma_f32_16x16x32_bf16 v[64:67], a[76:79], v[32:35], v[64:67]
v_mfma_f32_16x16x32_bf16 v[52:55], a[80:83], v[36:39], v[52:55]
v_mfma_f32_16x16x32_bf16 v[56:59], a[84:87], v[36:39], v[56:59]
v_mfma_f32_16x16x32_bf16 v[60:63], a[80:83], v[40:43], v[60:63]
v_mfma_f32_16x16x32_bf16 v[64:67], a[84:87], v[40:43], v[64:67]
v_mfma_f32_16x16x32_bf16 v[52:55], a[88:91], v[44:47], v[52:55]
v_mfma_f32_16x16x32_bf16 v[56:59], a[92:95], v[44:47], v[56:59]
v_mfma_f32_16x16x32_bf16 v[60:63], a[88:91], v[48:51], v[60:63]
v_mfma_f32_16x16x32_bf16 v[64:67], a[92:95], v[48:51], v[64:67]
s_waitcnt vmcnt(18)
ds_read_b64_tr_b16 a[96:97], v17 offset:0
ds_read_b64_tr_b16 a[98:99], v17 offset:256
ds_read_b64_tr_b16 a[100:101], v17 offset:8
ds_read_b64_tr_b16 a[102:103], v17 offset:264
ds_read_b64_tr_b16 a[104:105], v17 offset:2048
ds_read_b64_tr_b16 a[106:107], v17 offset:2304
ds_read_b64_tr_b16 a[108:109], v17 offset:2056
ds_read_b64_tr_b16 a[110:111], v17 offset:2312
s_waitcnt lgkmcnt(0)
ds_read_b64_tr_b16 a[112:113], v17 offset:4096
ds_read_b64_tr_b16 a[114:115], v17 offset:4352
ds_read_b64_tr_b16 a[116:117], v17 offset:4104
ds_read_b64_tr_b16 a[118:119], v17 offset:4360
ds_read_b64_tr_b16 a[120:121], v17 offset:6144
ds_read_b64_tr_b16 a[122:123], v17 offset:6400
ds_read_b64_tr_b16 a[124:125], v17 offset:6152
ds_read_b64_tr_b16 a[126:127], v17 offset:6408
s_waitcnt lgkmcnt(0)
s_mov_b32 s44, 6291456
buffer_load_dword v250, v12, s[4:7], s44 offen
s_add_u32 m0, s45, 0
s_mov_b32 s44, 6291456
buffer_load_dwordx4 v16, s[4:7], s44 offen lds
s_add_u32 m0, s45, 1024
s_mov_b32 s44, 6422528
buffer_load_dwordx4 v16, s[4:7], s44 offen lds
s_add_u32 m0, s45, 2048
s_mov_b32 s44, 6553600
buffer_load_dwordx4 v16, s[4:7], s44 offen lds
s_add_u32 m0, s45, 3072
s_mov_b32 s44, 6684672
buffer_load_dwordx4 v16, s[4:7], s44 offen lds
s_add_u32 m0, s45, 4096
s_mov_b32 s44, 6815744
buffer_load_dwordx4 v16, s[4:7], s44 offen lds
s_add_u32 m0, s45, 5120
s_mov_b32 s44, 6946816
buffer_load_dwordx4 v16, s[4:7], s44 offen lds
s_add_u32 m0, s45, 6144
s_mov_b32 s44, 7077888
buffer_load_dwordx4 v16, s[4:7], s44 offen lds
s_add_u32 m0, s45, 7168
s_mov_b32 s44, 7208960
buffer_load_dwordx4 v16, s[4:7], s44 offen lds
ds_read_b128 v[20:23], v8 offset:24576
ds_read_b128 v[24:27], v8 offset:26624
ds_read_b128 v[28:31], v9 offset:24576
ds_read_b128 v[32:35], v9 offset:26624
ds_read_b128 v[36:39], v8 offset:28672
ds_read_b128 v[40:43], v8 offset:30720
ds_read_b128 v[44:47], v9 offset:28672
ds_read_b128 v[48:51], v9 offset:30720
s_waitcnt lgkmcnt(0)
v_mfma_f32_16x16x32_bf16 v[52:55], a[96:99], v[20:23], v[52:55]
v_mfma_f32_16x16x32_bf16 v[56:59], a[100:103], v[20:23], v[56:59]
v_mfma_f32_16x16x32_bf16 v[60:63], a[96:99], v[24:27], v[60:63]
v_mfma_f32_16x16x32_bf16 v[64:67], a[100:103], v[24:27], v[64:67]
v_mfma_f32_16x16x32_bf16 v[52:55], a[104:107], v[28:31], v[52:55]
v_mfma_f32_16x16x32_bf16 v[56:59], a[108:111], v[28:31], v[56:59]
v_mfma_f32_16x16x32_bf16 v[60:63], a[104:107], v[32:35], v[60:63]
v_mfma_f32_16x16x32_bf16 v[64:67], a[108:111], v[32:35], v[64:67]
v_mfma_f32_16x16x32_bf16 v[52:55], a[112:115], v[36:39], v[52:55]
v_mfma_f32_16x16x32_bf16 v[56:59], a[116:119], v[36:39], v[56:59]
v_mfma_f32_16x16x32_bf16 v[60:63], a[112:115], v[40:43], v[60:63]
v_mfma_f32_16x16x32_bf16 v[64:67], a[116:119], v[40:43], v[64:67]
v_mfma_f32_16x16x32_bf16 v[52:55], a[120:123], v[44:47], v[52:55]
v_mfma_f32_16x16x32_bf16 v[56:59], a[124:127], v[44:47], v[56:59]
v_mfma_f32_16x16x32_bf16 v[60:63], a[120:123], v[48:51], v[60:63]
v_mfma_f32_16x16x32_bf16 v[64:67], a[124:127], v[48:51], v[64:67]
s_waitcnt vmcnt(18)
ds_read_b64_tr_b16 a[128:129], v17 offset:8192
ds_read_b64_tr_b16 a[130:131], v17 offset:8448
ds_read_b64_tr_b16 a[132:133], v17 offset:8200
ds_read_b64_tr_b16 a[134:135], v17 offset:8456
ds_read_b64_tr_b16 a[136:137], v17 offset:10240
ds_read_b64_tr_b16 a[138:139], v17 offset:10496
ds_read_b64_tr_b16 a[140:141], v17 offset:10248
ds_read_b64_tr_b16 a[142:143], v17 offset:10504
s_waitcnt lgkmcnt(0)
ds_read_b64_tr_b16 a[144:145], v17 offset:12288
ds_read_b64_tr_b16 a[146:147], v17 offset:12544
ds_read_b64_tr_b16 a[148:149], v17 offset:12296
ds_read_b64_tr_b16 a[150:151], v17 offset:12552
ds_read_b64_tr_b16 a[152:153], v17 offset:14336
ds_read_b64_tr_b16 a[154:155], v17 offset:14592
ds_read_b64_tr_b16 a[156:157], v17 offset:14344
ds_read_b64_tr_b16 a[158:159], v17 offset:14600
s_waitcnt lgkmcnt(0)
s_mov_b32 s44, 7340032
buffer_load_dword v250, v12, s[4:7], s44 offen
s_add_u32 m0, s45, 8192
s_mov_b32 s44, 7340032
buffer_load_dwordx4 v16, s[4:7], s44 offen lds
s_add_u32 m0, s45, 9216
s_mov_b32 s44, 7471104
buffer_load_dwordx4 v16, s[4:7], s44 offen lds
s_add_u32 m0, s45, 10240
s_mov_b32 s44, 7602176
buffer_load_dwordx4 v16, s[4:7], s44 offen lds
s_add_u32 m0, s45, 11264
s_mov_b32 s44, 7733248
buffer_load_dwordx4 v16, s[4:7], s44 offen lds
s_add_u32 m0, s45, 12288
s_mov_b32 s44, 7864320
buffer_load_dwordx4 v16, s[4:7], s44 offen lds
s_add_u32 m0, s45, 13312
s_mov_b32 s44, 7995392
buffer_load_dwordx4 v16, s[4:7], s44 offen lds
s_add_u32 m0, s45, 14336
s_mov_b32 s44, 8126464
buffer_load_dwordx4 v16, s[4:7], s44 offen lds
s_add_u32 m0, s45, 15360
s_mov_b32 s44, 8257536
buffer_load_dwordx4 v16, s[4:7], s44 offen lds
ds_read_b128 v[20:23], v8 offset:32768
ds_read_b128 v[24:27], v8 offset:34816
ds_read_b128 v[28:31], v9 offset:32768
ds_read_b128 v[32:35], v9 offset:34816
ds_read_b128 v[36:39], v8 offset:36864
ds_read_b128 v[40:43], v8 offset:38912
ds_read_b128 v[44:47], v9 offset:36864
ds_read_b128 v[48:51], v9 offset:38912
s_waitcnt lgkmcnt(0)
v_mfma_f32_16x16x32_bf16 v[52:55], a[128:131], v[20:23], v[52:55]
v_mfma_f32_16x16x32_bf16 v[56:59], a[132:135], v[20:23], v[56:59]
v_mfma_f32_16x16x32_bf16 v[60:63], a[128:131], v[24:27], v[60:63]
v_mfma_f32_16x16x32_bf16 v[64:67], a[132:135], v[24:27], v[64:67]
v_mfma_f32_16x16x32_bf16 v[52:55], a[136:139], v[28:31], v[52:55]
v_mfma_f32_16x16x32_bf16 v[56:59], a[140:143], v[28:31], v[56:59]
v_mfma_f32_16x16x32_bf16 v[60:63], a[136:139], v[32:35], v[60:63]
v_mfma_f32_16x16x32_bf16 v[64:67], a[140:143], v[32:35], v[64:67]
v_mfma_f32_16x16x32_bf16 v[52:55], a[144:147], v[36:39], v[52:55]
v_mfma_f32_16x16x32_bf16 v[56:59], a[148:151], v[36:39], v[56:59]
v_mfma_f32_16x16x32_bf16 v[60:63], a[144:147], v[40:43], v[60:63]
v_mfma_f32_16x16x32_bf16 v[64:67], a[148:151], v[40:43], v[64:67]
v_mfma_f32_16x16x32_bf16 v[52:55], a[152:155], v[44:47], v[52:55]
v_mfma_f32_16x16x32_bf16 v[56:59], a[156:159], v[44:47], v[56:59]
v_mfma_f32_16x16x32_bf16 v[60:63], a[152:155], v[48:51], v[60:63]
v_mfma_f32_16x16x32_bf16 v[64:67], a[156:159], v[48:51], v[64:67]
s_waitcnt vmcnt(18)
ds_read_b64_tr_b16 a[160:161], v17 offset:16384
ds_read_b64_tr_b16 a[162:163], v17 offset:16640
ds_read_b64_tr_b16 a[164:165], v17 offset:16392
ds_read_b64_tr_b16 a[166:167], v17 offset:16648
ds_read_b64_tr_b16 a[168:169], v17 offset:18432
ds_read_b64_tr_b16 a[170:171], v17 offset:18688
ds_read_b64_tr_b16 a[172:173], v17 offset:18440
ds_read_b64_tr_b16 a[174:175], v17 offset:18696
s_waitcnt lgkmcnt(0)
ds_read_b64_tr_b16 a[176:177], v17 offset:20480
ds_read_b64_tr_b16 a[178:179], v17 offset:20736
ds_read_b64_tr_b16 a[180:181], v17 offset:20488
ds_read_b64_tr_b16 a[182:183], v17 offset:20744
ds_read_b64_tr_b16 a[184:185], v17 offset:22528
ds_read_b64_tr_b16 a[186:187], v17 offset:22784
ds_read_b64_tr_b16 a[188:189], v17 offset:22536
ds_read_b64_tr_b16 a[190:191], v17 offset:22792
s_waitcnt lgkmcnt(0)
ds_read_b128 v[20:23], v8 offset:40960
ds_read_b128 v[24:27], v8 offset:43008
ds_read_b128 v[28:31], v9 offset:40960
ds_read_b128 v[32:35], v9 offset:43008
ds_read_b128 v[36:39], v8 offset:45056
ds_read_b128 v[40:43], v8 offset:47104
ds_read_b128 v[44:47], v9 offset:45056
ds_read_b128 v[48:51], v9 offset:47104
s_waitcnt lgkmcnt(0)
v_mfma_f32_16x16x32_bf16 v[52:55], a[160:163], v[20:23], v[52:55]
v_mfma_f32_16x16x32_bf16 v[56:59], a[164:167], v[20:23], v[56:59]
v_mfma_f32_16x16x32_bf16 v[60:63], a[160:163], v[24:27], v[60:63]
v_mfma_f32_16x16x32_bf16 v[64:67], a[164:167], v[24:27], v[64:67]
v_mfma_f32_16x16x32_bf16 v[52:55], a[168:171], v[28:31], v[52:55]
v_mfma_f32_16x16x32_bf16 v[56:59], a[172:175], v[28:31], v[56:59]
v_mfma_f32_16x16x32_bf16 v[60:63], a[168:171], v[32:35], v[60:63]
v_mfma_f32_16x16x32_bf16 v[64:67], a[172:175], v[32:35], v[64:67]
v_mfma_f32_16x16x32_bf16 v[52:55], a[176:179], v[36:39], v[52:55]
v_mfma_f32_16x16x32_bf16 v[56:59], a[180:183], v[36:39], v[56:59]
v_mfma_f32_16x16x32_bf16 v[60:63], a[176:179], v[40:43], v[60:63]
v_mfma_f32_16x16x32_bf16 v[64:67], a[180:183], v[40:43], v[64:67]
v_mfma_f32_16x16x32_bf16 v[52:55], a[184:187], v[44:47], v[52:55]
v_mfma_f32_16x16x32_bf16 v[56:59], a[188:191], v[44:47], v[56:59]
v_mfma_f32_16x16x32_bf16 v[60:63], a[184:187], v[48:51], v[60:63]
v_mfma_f32_16x16x32_bf16 v[64:67], a[188:191], v[48:51], v[64:67]
s_waitcnt vmcnt(9)
ds_read_b64_tr_b16 a[192:193], v17 offset:0
ds_read_b64_tr_b16 a[194:195], v17 offset:256
ds_read_b64_tr_b16 a[196:197], v17 offset:8
ds_read_b64_tr_b16 a[198:199], v17 offset:264
ds_read_b64_tr_b16 a[200:201], v17 offset:2048
ds_read_b64_tr_b16 a[202:203], v17 offset:2304
ds_read_b64_tr_b16 a[204:205], v17 offset:2056
ds_read_b64_tr_b16 a[206:207], v17 offset:2312
s_waitcnt lgkmcnt(0)
ds_read_b64_tr_b16 a[208:209], v17 offset:4096
ds_read_b64_tr_b16 a[210:211], v17 offset:4352
ds_read_b64_tr_b16 a[212:213], v17 offset:4104
ds_read_b64_tr_b16 a[214:215], v17 offset:4360
ds_read_b64_tr_b16 a[216:217], v17 offset:6144
ds_read_b64_tr_b16 a[218:219], v17 offset:6400
ds_read_b64_tr_b16 a[220:221], v17 offset:6152
ds_read_b64_tr_b16 a[222:223], v17 offset:6408
s_waitcnt lgkmcnt(0)
ds_read_b128 v[20:23], v8 offset:49152
ds_read_b128 v[24:27], v8 offset:51200
ds_read_b128 v[28:31], v9 offset:49152
ds_read_b128 v[32:35], v9 offset:51200
ds_read_b128 v[36:39], v8 offset:53248
ds_read_b128 v[40:43], v8 offset:55296
ds_read_b128 v[44:47], v9 offset:53248
ds_read_b128 v[48:51], v9 offset:55296
s_waitcnt lgkmcnt(0)
v_mfma_f32_16x16x32_bf16 v[52:55], a[192:195], v[20:23], v[52:55]
v_mfma_f32_16x16x32_bf16 v[56:59], a[196:199], v[20:23], v[56:59]
v_mfma_f32_16x16x32_bf16 v[60:63], a[192:195], v[24:27], v[60:63]
v_mfma_f32_16x16x32_bf16 v[64:67], a[196:199], v[24:27], v[64:67]
v_mfma_f32_16x16x32_bf16 v[52:55], a[200:203], v[28:31], v[52:55]
v_mfma_f32_16x16x32_bf16 v[56:59], a[204:207], v[28:31], v[56:59]
v_mfma_f32_16x16x32_bf16 v[60:63], a[200:203], v[32:35], v[60:63]
v_mfma_f32_16x16x32_bf16 v[64:67], a[204:207], v[32:35], v[64:67]
v_mfma_f32_16x16x32_bf16 v[52:55], a[208:211], v[36:39], v[52:55]
v_mfma_f32_16x16x32_bf16 v[56:59], a[212:215], v[36:39], v[56:59]
v_mfma_f32_16x16x32_bf16 v[60:63], a[208:211], v[40:43], v[60:63]
v_mfma_f32_16x16x32_bf16 v[64:67], a[212:215], v[40:43], v[64:67]
v_mfma_f32_16x16x32_bf16 v[52:55], a[216:219], v[44:47], v[52:55]
v_mfma_f32_16x16x32_bf16 v[56:59], a[220:223], v[44:47], v[56:59]
v_mfma_f32_16x16x32_bf16 v[60:63], a[216:219], v[48:51], v[60:63]
v_mfma_f32_16x16x32_bf16 v[64:67], a[220:223], v[48:51], v[64:67]
s_waitcnt vmcnt(0)
ds_read_b64_tr_b16 a[224:225], v17 offset:8192
ds_read_b64_tr_b16 a[226:227], v17 offset:8448
ds_read_b64_tr_b16 a[228:229], v17 offset:8200
ds_read_b64_tr_b16 a[230:231], v17 offset:8456
ds_read_b64_tr_b16 a[232:233], v17 offset:10240
ds_read_b64_tr_b16 a[234:235], v17 offset:10496
ds_read_b64_tr_b16 a[236:237], v17 offset:10248
ds_read_b64_tr_b16 a[238:239], v17 offset:10504
s_waitcnt lgkmcnt(0)
ds_read_b64_tr_b16 a[240:241], v17 offset:12288
ds_read_b64_tr_b16 a[242:243], v17 offset:12544
ds_read_b64_tr_b16 a[244:245], v17 offset:12296
ds_read_b64_tr_b16 a[246:247], v17 offset:12552
ds_read_b64_tr_b16 a[248:249], v17 offset:14336
ds_read_b64_tr_b16 a[250:251], v17 offset:14592
ds_read_b64_tr_b16 a[252:253], v17 offset:14344
ds_read_b64_tr_b16 a[254:255], v17 offset:14600
s_waitcnt lgkmcnt(0)
ds_read_b128 v[20:23], v8 offset:57344
ds_read_b128 v[24:27], v8 offset:59392
ds_read_b128 v[28:31], v9 offset:57344
ds_read_b128 v[32:35], v9 offset:59392
ds_read_b128 v[36:39], v8 offset:61440
ds_read_b128 v[40:43], v8 offset:63488
ds_read_b128 v[44:47], v9 offset:61440
ds_read_b128 v[48:51], v9 offset:63488
s_waitcnt lgkmcnt(0)
v_mfma_f32_16x16x32_bf16 v[52:55], a[224:227], v[20:23], v[52:55]
v_mfma_f32_16x16x32_bf16 v[56:59], a[228:231], v[20:23], v[56:59]
v_mfma_f32_16x16x32_bf16 v[60:63], a[224:227], v[24:27], v[60:63]
v_mfma_f32_16x16x32_bf16 v[64:67], a[228:231], v[24:27], v[64:67]
v_mfma_f32_16x16x32_bf16 v[52:55], a[232:235], v[28:31], v[52:55]
v_mfma_f32_16x16x32_bf16 v[56:59], a[236:239], v[28:31], v[56:59]
v_mfma_f32_16x16x32_bf16 v[60:63], a[232:235], v[32:35], v[60:63]
v_mfma_f32_16x16x32_bf16 v[64:67], a[236:239], v[32:35], v[64:67]
v_mfma_f32_16x16x32_bf16 v[52:55], a[240:243], v[36:39], v[52:55]
v_mfma_f32_16x16x32_bf16 v[56:59], a[244:247], v[36:39], v[56:59]
v_mfma_f32_16x16x32_bf16 v[60:63], a[240:243], v[40:43], v[60:63]
v_mfma_f32_16x16x32_bf16 v[64:67], a[244:247], v[40:43], v[64:67]
v_mfma_f32_16x16x32_bf16 v[52:55], a[248:251], v[44:47], v[52:55]
v_mfma_f32_16x16x32_bf16 v[56:59], a[252:255], v[44:47], v[56:59]
v_mfma_f32_16x16x32_bf16 v[60:63], a[248:251], v[48:51], v[60:63]
v_mfma_f32_16x16x32_bf16 v[64:67], a[252:255], v[48:51], v[64:67]
s_barrier
s_mov_b32 s50, 0x10000
s_add_u32 m0, s46, 65536
s_nop 0
buffer_load_dwordx4 v6, s[8:11], s50 offen offset:0 lds
s_add_u32 m0, s46, 69504
s_nop 0
buffer_load_dwordx4 v6, s[8:11], s50 offen offset:128 lds
s_add_u32 m0, s46, 73472
s_nop 0
buffer_load_dwordx4 v6, s[8:11], s50 offen offset:256 lds
s_add_u32 m0, s46, 77440
s_nop 0
buffer_load_dwordx4 v6, s[8:11], s50 offen offset:384 lds
s_add_u32 m0, s46, 81408
s_nop 0
buffer_load_dwordx4 v6, s[8:11], s50 offen offset:512 lds
s_add_u32 m0, s46, 85376
s_nop 0
buffer_load_dwordx4 v6, s[8:11], s50 offen offset:640 lds
s_add_u32 m0, s46, 89344
s_nop 0
buffer_load_dwordx4 v6, s[8:11], s50 offen offset:768 lds
s_add_u32 m0, s46, 93312
s_nop 0
buffer_load_dwordx4 v6, s[8:11], s50 offen offset:896 lds
s_add_u32 m0, s46, 97280
s_nop 0
buffer_load_dwordx4 v6, s[8:11], s50 offen offset:1024 lds
s_add_u32 m0, s46, 101248
s_nop 0
buffer_load_dwordx4 v6, s[8:11], s50 offen offset:1152 lds
s_add_u32 m0, s46, 105216
s_nop 0
buffer_load_dwordx4 v6, s[8:11], s50 offen offset:1280 lds
s_add_u32 m0, s46, 109184
s_nop 0
buffer_load_dwordx4 v6, s[8:11], s50 offen offset:1408 lds
s_add_u32 m0, s46, 113152
s_nop 0
buffer_load_dwordx4 v6, s[8:11], s50 offen offset:1536 lds
s_add_u32 m0, s46, 117120
s_nop 0
buffer_load_dwordx4 v6, s[8:11], s50 offen offset:1664 lds
s_add_u32 m0, s46, 121088
s_nop 0
buffer_load_dwordx4 v6, s[8:11], s50 offen offset:1792 lds
s_add_u32 m0, s46, 125056
s_nop 0
buffer_load_dwordx4 v6, s[8:11], s50 offen offset:1920 lds
v_and_b32 v3, 15, v0
v_lshlrev_b32 v3, 4, v3
s_branch mega_kernel_syc
mega_kernel_sycw:
s_sleep 4
mega_kernel_syc:
buffer_load_dword v2, v3, s[72:75], 0 offen sc1
s_waitcnt vmcnt(0)
mega_kernel_sycp:
s_cmp_eq_u32 s95, 1
s_cbranch_scc0 mega_kernel_sycf
v_readlane_b32 s76, v2, 14
s_mov_b32 s98, 0
s_cmp_eq_u32 s76, 32
s_cbranch_scc0 mega_kernel_sycw
s_branch mega_kernel_sycd
mega_kernel_sycf:
s_mov_b32 s77, 0
s_mov_b32 s78, 0
v_readlane_b32 s76, v2, 0
s_add_u32 s77, s77, s76
s_xor_b32 s76, s76, 32
s_or_b32 s78, s78, s76
v_readlane_b32 s76, v2, 1
s_add_u32 s77, s77, s76
s_xor_b32 s76, s76, 32
s_or_b32 s78, s78, s76
v_readlane_b32 s76, v2, 2
s_add_u32 s77, s77, s76
s_xor_b32 s76, s76, 32
s_or_b32 s78, s78, s76
v_readlane_b32 s76, v2, 3
s_add_u32 s77, s77, s76
s_xor_b32 s76, s76, 32
s_or_b32 s78, s78, s76
v_readlane_b32 s76, v2, 4
s_add_u32 s77, s77, s76
s_xor_b32 s76, s76, 32
s_or_b32 s78, s78, s76
v_readlane_b32 s76, v2, 5
s_add_u32 s77, s77, s76
s_xor_b32 s76, s76, 32
s_or_b32 s78, s78, s76
v_readlane_b32 s76, v2, 6
s_add_u32 s77, s77, s76
s_xor_b32 s76, s76, 32
s_or_b32 s78, s78, s76
v_readlane_b32 s76, v2, 7
s_add_u32 s77, s77, s76
s_xor_b32 s76, s76, 32
s_or_b32 s78, s78, s76
s_cmp_eq_u32 s77, 256
s_cbranch_scc0 mega_kernel_sycw
v_mov_b32 v252, v2
s_cmp_eq_u32 s78, 0
s_cbranch_scc0 mega_kernel_slowent
v_readlane_b32 s76, v2, 10
v_readlane_b32 s77, v2, 8
s_cmp_eq_u32 s76, 32
s_cbranch_scc0 mega_kernel_sycw
s_cmp_gt_u32 s77, 16
s_cselect_b32 s98, 1, 0
mega_kernel_sycd:
v_lshrrev_b32 v92, 4, v1
v_and_b32 v93, 15, v1
s_and_b32 s52, s41, 1
s_lshr_b32 s53, s41, 1
s_mov_b32 s54, 0x3e0293ee
s_mov_b32 s55, 0
s_mov_b32 s56, 0
v_mov_b32 v97, 0xff800000
v_mov_b32 v241, 0xceabdc6e
v_and_b32 v2, 7, v93
v_lshlrev_b32 v94, 7, v92
v_lshl_add_u32 v94, v2, 4, v94
v_and_b32 v2, 31, v1
v_lshlrev_b32 v95, 3, v2
v_lshrrev_b32 v2, 1, v92
v_lshlrev_b32 v96, 10, v2
v_and_b32 v2, 1, v92
v_lshl_add_u32 v96, v2, 9, v96
v_lshl_add_u32 v96, v93, 4, v96
s_lshl_b32 s43, s40, 14
s_lshl_b32 s44, s53, 12
s_add_u32 s43, s43, s44
s_lshl_b32 s44, s52, 8
s_add_u32 s43, s43, s44
s_add_u32 s43, s43, 134217728
v_add_u32 v96, s43, v96
s_lshl_b32 s43, s52, 4
v_add_u32 v98, s43, v93
v_lshlrev_b32 v2, 2, v92
v_sub_u32 v98, v98, v2
s_mov_b32 s28, 0
s_mov_b32 s29, -1
s_xor_b32 s44, s98, 1
s_lshl_b32 s44, s44, 13
s_lshl_b32 s43, s40, 7
s_add_u32 s43, s43, s44
s_add_u32 s43, s43, 69206016
v_and_b32 v2, 3, v1
v_bfe_u32 v3, v1, 2, 1
v_lshlrev_b32 v99, 12, v3
v_lshl_add_u32 v99, v2, 2, v99
v_add_u32 v99, s43, v99
s_xor_b32 s62, s98, 1
s_lshl_b32 s62, s62, 13
s_lshr_b32 s44, s47, 6
s_lshl_b32 s44, s44, 14
s_add_u32 s62, s62, s44
s_and_b32 s44, s47, 63
s_lshl_b32 s44, s44, 7
s_add_u32 s62, s62, s44
s_add_u32 s62, s62, 69222400
s_lshl_b32 s49, s40, 7
s_lshl_b32 s44, s41, 2
s_add_u32 s49, s49, s44
s_lshl_b32 s44, s98, 13
s_add_u32 s49, s49, s44
s_add_u32 s49, s49, 69255168
s_lshl_b32 s43, s41, 11
s_add_u32 s43, s43, 131072
v_add_u32 v101, s43, v7
s_lshl_b32 s43, s52, 10
s_add_u32 s43, s43, 131072
v_add_u32 v102, s43, v5
v_mov_b32 v16, 0
s_mov_b32 s50, 0
v_mov_b32 v104, 0x3f803f80
v_mov_b32 v105, 0x3f803f80
v_mov_b32 v106, 0x3f803f80
v_mov_b32 v107, 0x3f803f80
v_cmp_gt_i32 s[12:13], 0, v98
v_cmp_gt_i32 s[14:15], 1, v98
v_cmp_gt_i32 s[16:17], 2, v98
v_cmp_gt_i32 s[18:19], 3, v98
v_cmp_gt_i32 s[20:21], 16, v98
v_cmp_gt_i32 s[22:23], 17, v98
v_cmp_gt_i32 s[24:25], 18, v98
v_cmp_gt_i32 s[26:27], 19, v98
s_lshr_b32 s44, s47, 3
s_xor_b32 s44, s44, s98
s_and_b32 s44, s44, 1
s_lshl_b32 s44, s44, 13
s_lshl_b32 s58, s47, 18
s_add_u32 s58, s58, s44
s_add_u32 s58, s58, 0
s_lshr_b32 s44, s47, 4
s_xor_b32 s44, s44, s98
s_and_b32 s44, s44, 1
s_lshl_b32 s44, s44, 13
s_lshl_b32 s59, s47, 17
s_add_u32 s59, s59, s44
s_add_u32 s59, s59, 71303168
s_lshl_b32 s60, s41, 11
s_add_u32 s60, s60, 139264
s_lshl_b32 s61, s41, 10
s_add_u32 s61, s61, 155648
v_add_u32 v94, 155648, v94
s_lshl_b32 s43, s53, 11
s_add_u32 s43, s43, 156160
v_add_u32 v95, s43, v95
v_add_u32 v103, 139264, v5
s_lshl_b32 s43, s53, 12
s_add_u32 s43, s43, 147456
v_add_u32 v240, s43, v5
s_waitcnt vmcnt(0)
v_cvt_pk_bf16_f32 v220, v52, v53
v_cvt_pk_bf16_f32 v221, v54, v55
v_cvt_pk_bf16_f32 v222, v56, v57
v_cvt_pk_bf16_f32 v223, v58, v59
v_cvt_pk_bf16_f32 v224, v60, v61
v_cvt_pk_bf16_f32 v225, v62, v63
v_cvt_pk_bf16_f32 v226, v64, v65
v_cvt_pk_bf16_f32 v227, v66, v67
s_barrier
s_mov_b32 s50, 0x20000
ds_read_b128 v[20:23], v10 offset:0
ds_read_b128 v[24:27], v10 offset:2048
ds_read_b128 v[28:31], v11 offset:0
ds_read_b128 v[32:35], v11 offset:2048
ds_read_b128 v[36:39], v10 offset:4096
ds_read_b128 v[40:43], v10 offset:6144
s_add_u32 m0, s46, 0
s_waitcnt lgkmcnt(4)
v_mfma_f32_16x16x32_bf16 v[52:55], a[0:3], v[20:23], 0
ds_read_b128 v[44:47], v11 offset:4096
v_mfma_f32_16x16x32_bf16 v[56:59], a[4:7], v[20:23], 0
buffer_load_dwordx4 v6, s[8:11], s50 offen offset:0 lds
v_mfma_f32_16x16x32_bf16 v[60:63], a[0:3], v[24:27], 0
ds_read_b128 v[48:51], v11 offset:6144
v_mfma_f32_16x16x32_bf16 v[64:67], a[4:7], v[24:27], 0
s_add_u32 m0, s46, 3968
s_waitcnt lgkmcnt(4)
v_mfma_f32_16x16x32_bf16 v[52:55], a[8:11], v[28:31], v[52:55]
ds_read_b128 v[20:23], v10 offset:8192
v_mfma_f32_16x16x32_bf16 v[56:59], a[12:15], v[28:31], v[56:59]
buffer_load_dwordx4 v6, s[8:11], s50 offen offset:128 lds
v_mfma_f32_16x16x32_bf16 v[60:63], a[8:11], v[32:35], v[60:63]
ds_read_b128 v[24:27], v10 offset:10240
v_mfma_f32_16x16x32_bf16 v[64:67], a[12:15], v[32:35], v[64:67]
s_add_u32 m0, s46, 7936
s_waitcnt lgkmcnt(4)
v_mfma_f32_16x16x32_bf16 v[52:55], a[16:19], v[36:39], v[52:55]
ds_read_b128 v[28:31], v11 offset:8192
v_mfma_f32_16x16x32_bf16 v[56:59], a[20:23], v[36:39], v[56:59]
buffer_load_dwordx4 v6, s[8:11], s50 offen offset:256 lds
v_mfma_f32_16x16x32_bf16 v[60:63], a[16:19], v[40:43], v[60:63]
ds_read_b128 v[32:35], v11 offset:10240
v_mfma_f32_16x16x32_bf16 v[64:67], a[20:23], v[40:43], v[64:67]
s_add_u32 m0, s46, 11904
s_waitcnt lgkmcnt(4)
v_mfma_f32_16x16x32_bf16 v[52:55], a[24:27], v[44:47], v[52:55]
ds_read_b128 v[36:39], v10 offset:12288
v_mfma_f32_16x16x32_bf16 v[56:59], a[28:31], v[44:47], v[56:59]
buffer_load_dwordx4 v6, s[8:11], s50 offen offset:384 lds
v_mfma_f32_16x16x32_bf16 v[60:63], a[24:27], v[48:51], v[60:63]
ds_read_b128 v[40:43], v10 offset:14336
v_mfma_f32_16x16x32_bf16 v[64:67], a[28:31], v[48:51], v[64:67]
s_add_u32 m0, s46, 15872
s_waitcnt lgkmcnt(4)
v_mfma_f32_16x16x32_bf16 v[52:55], a[32:35], v[20:23], v[52:55]
ds_read_b128 v[44:47], v11 offset:12288
v_mfma_f32_16x16x32_bf16 v[56:59], a[36:39], v[20:23], v[56:59]
buffer_load_dwordx4 v6, s[8:11], s50 offen offset:512 lds
v_mfma_f32_16x16x32_bf16 v[60:63], a[32:35], v[24:27], v[60:63]
ds_read_b128 v[48:51], v11 offset:14336
v_mfma_f32_16x16x32_bf16 v[64:67], a[36:39], v[24:27], v[64:67]
s_add_u32 m0, s46, 19840
s_waitcnt lgkmcnt(4)
v_mfma_f32_16x16x32_bf16 v[52:55], a[40:43], v[28:31], v[52:55]
ds_read_b128 v[20:23], v10 offset:16384
v_mfma_f32_16x16x32_bf16 v[56:59], a[44:47], v[28:31], v[56:59]
buffer_load_dwordx4 v6, s[8:11], s50 offen offset:640 lds
v_mfma_f32_16x16x32_bf16 v[60:63], a[40:43], v[32:35], v[60:63]
ds_read_b128 v[24:27], v10 offset:18432
v_mfma_f32_16x16x32_bf16 v[64:67], a[44:47], v[32:35], v[64:67]
s_add_u32 m0, s46, 23808
s_waitcnt lgkmcnt(4)
v_mfma_f32_16x16x32_bf16 v[52:55], a[48:51], v[36:39], v[52:55]
ds_read_b128 v[28:31], v11 offset:16384
v_mfma_f32_16x16x32_bf16 v[56:59], a[52:55], v[36:39], v[56:59]
buffer_load_dwordx4 v6, s[8:11], s50 offen offset:768 lds
v_mfma_f32_16x16x32_bf16 v[60:63], a[48:51], v[40:43], v[60:63]
ds_read_b128 v[32:35], v11 offset:18432
v_mfma_f32_16x16x32_bf16 v[64:67], a[52:55], v[40:43], v[64:67]
s_add_u32 m0, s46, 27776
s_waitcnt lgkmcnt(4)
v_mfma_f32_16x16x32_bf16 v[52:55], a[56:59], v[44:47], v[52:55]
ds_read_b128 v[36:39], v10 offset:20480
v_mfma_f32_16x16x32_bf16 v[56:59], a[60:63], v[44:47], v[56:59]
buffer_load_dwordx4 v6, s[8:11], s50 offen offset:896 lds
v_mfma_f32_16x16x32_bf16 v[60:63], a[56:59], v[48:51], v[60:63]
ds_read_b128 v[40:43], v10 offset:22528
v_mfma_f32_16x16x32_bf16 v[64:67], a[60:63], v[48:51], v[64:67]
s_add_u32 m0, s46, 31744
s_waitcnt lgkmcnt(4)
v_mfma_f32_16x16x32_bf16 v[52:55], a[64:67], v[20:23], v[52:55]
ds_read_b128 v[44:47], v11 offset:20480
v_mfma_f32_16x16x32_bf16 v[56:59], a[68:71], v[20:23], v[56:59]
buffer_load_dwordx4 v6, s[8:11], s50 offen offset:1024 lds
v_mfma_f32_16x16x32_bf16 v[60:63], a[64:67], v[24:27], v[60:63]
ds_read_b128 v[48:51], v11 offset:22528
v_mfma_f32_16x16x32_bf16 v[64:67], a[68:71], v[24:27], v[64:67]
s_add_u32 m0, s46, 35712
s_waitcnt lgkmcnt(4)
v_mfma_f32_16x16x32_bf16 v[52:55], a[72:75], v[28:31], v[52:55]
ds_read_b128 v[20:23], v10 offset:24576
v_mfma_f32_16x16x32_bf16 v[56:59], a[76:79], v[28:31], v[56:59]
buffer_load_dwordx4 v6, s[8:11], s50 offen offset:1152 lds
v_mfma_f32_16x16x32_bf16 v[60:63], a[72:75], v[32:35], v[60:63]
ds_read_b128 v[24:27], v10 offset:26624
v_mfma_f32_16x16x32_bf16 v[64:67], a[76:79], v[32:35], v[64:67]
s_add_u32 m0, s46, 39680
s_waitcnt lgkmcnt(4)
v_mfma_f32_16x16x32_bf16 v[52:55], a[80:83], v[36:39], v[52:55]
ds_read_b128 v[28:31], v11 offset:24576
v_mfma_f32_16x16x32_bf16 v[56:59], a[84:87], v[36:39], v[56:59]
buffer_load_dwordx4 v6, s[8:11], s50 offen offset:1280 lds
v_mfma_f32_16x16x32_bf16 v[60:63], a[80:83], v[40:43], v[60:63]
ds_read_b128 v[32:35], v11 offset:26624
v_mfma_f32_16x16x32_bf16 v[64:67], a[84:87], v[40:43], v[64:67]
s_add_u32 m0, s46, 43648
s_waitcnt lgkmcnt(4)
v_mfma_f32_16x16x32_bf16 v[52:55], a[88:91], v[44:47], v[52:55]
ds_read_b128 v[36:39], v10 offset:28672
v_mfma_f32_16x16x32_bf16 v[56:59], a[92:95], v[44:47], v[56:59]
buffer_load_dwordx4 v6, s[8:11], s50 offen offset:1408 lds
v_mfma_f32_16x16x32_bf16 v[60:63], a[88:91], v[48:51], v[60:63]
ds_read_b128 v[40:43], v10 offset:30720
v_mfma_f32_16x16x32_bf16 v[64:67], a[92:95], v[48:51], v[64:67]
s_add_u32 m0, s46, 47616
s_waitcnt lgkmcnt(4)
v_mfma_f32_16x16x32_bf16 v[52:55], a[96:99], v[20:23], v[52:55]
ds_read_b128 v[44:47], v11 offset:28672
v_mfma_f32_16x16x32_bf16 v[56:59], a[100:103], v[20:23], v[56:59]
buffer_load_dwordx4 v6, s[8:11], s50 offen offset:1536 lds
v_mfma_f32_16x16x32_bf16 v[60:63], a[96:99], v[24:27], v[60:63]
ds_read_b128 v[48:51], v11 offset:30720
v_mfma_f32_16x16x32_bf16 v[64:67], a[100:103], v[24:27], v[64:67]
s_add_u32 m0, s46, 51584
s_waitcnt lgkmcnt(4)
v_mfma_f32_16x16x32_bf16 v[52:55], a[104:107], v[28:31], v[52:55]
ds_read_b128 v[20:23], v10 offset:32768
v_mfma_f32_16x16x32_bf16 v[56:59], a[108:111], v[28:31], v[56:59]
buffer_load_dwordx4 v6, s[8:11], s50 offen offset:1664 lds
v_mfma_f32_16x16x32_bf16 v[60:63], a[104:107], v[32:35], v[60:63]
ds_read_b128 v[24:27], v10 offset:34816
v_mfma_f32_16x16x32_bf16 v[64:67], a[108:111], v[32:35], v[64:67]
s_add_u32 m0, s46, 55552
s_waitcnt lgkmcnt(4)
v_mfma_f32_16x16x32_bf16 v[52:55], a[112:115], v[36:39], v[52:55]
ds_read_b128 v[28:31], v11 offset:32768
v_mfma_f32_16x16x32_bf16 v[56:59], a[116:119], v[36:39], v[56:59]
buffer_load_dwordx4 v6, s[8:11], s50 offen offset:1792 lds
v_mfma_f32_16x16x32_bf16 v[60:63], a[112:115], v[40:43], v[60:63]
ds_read_b128 v[32:35], v11 offset:34816
v_mfma_f32_16x16x32_bf16 v[64:67], a[116:119], v[40:43], v[64:67]
s_add_u32 m0, s46, 59520
s_waitcnt lgkmcnt(4)
v_mfma_f32_16x16x32_bf16 v[52:55], a[120:123], v[44:47], v[52:55]
ds_read_b128 v[36:39], v10 offset:36864
v_mfma_f32_16x16x32_bf16 v[56:59], a[124:127], v[44:47], v[56:59]
buffer_load_dwordx4 v6, s[8:11], s50 offen offset:1920 lds
v_mfma_f32_16x16x32_bf16 v[60:63], a[120:123], v[48:51], v[60:63]
ds_read_b128 v[40:43], v10 offset:38912
v_mfma_f32_16x16x32_bf16 v[64:67], a[124:127], v[48:51], v[64:67]
s_waitcnt lgkmcnt(4)
v_mfma_f32_16x16x32_bf16 v[52:55], a[128:131], v[20:23], v[52:55]
ds_read_b128 v[44:47], v11 offset:36864
v_mfma_f32_16x16x32_bf16 v[56:59], a[132:135], v[20:23], v[56:59]
v_mfma_f32_16x16x32_bf16 v[60:63], a[128:131], v[24:27], v[60:63]
ds_read_b128 v[48:51], v11 offset:38912
v_mfma_f32_16x16x32_bf16 v[64:67], a[132:135], v[24:27], v[64:67]
s_waitcnt lgkmcnt(4)
v_mfma_f32_16x16x32_bf16 v[52:55], a[136:139], v[28:31], v[52:55]
ds_read_b128 v[20:23], v10 offset:40960
v_mfma_f32_16x16x32_bf16 v[56:59], a[140:143], v[28:31], v[56:59]
v_mfma_f32_16x16x32_bf16 v[60:63], a[136:139], v[32:35], v[60:63]
ds_read_b128 v[24:27], v10 offset:43008
v_mfma_f32_16x16x32_bf16 v[64:67], a[140:143], v[32:35], v[64:67]
s_waitcnt lgkmcnt(4)
v_mfma_f32_16x16x32_bf16 v[52:55], a[144:147], v[36:39], v[52:55]
ds_read_b128 v[28:31], v11 offset:40960
v_mfma_f32_16x16x32_bf16 v[56:59], a[148:151], v[36:39], v[56:59]
v_mfma_f32_16x16x32_bf16 v[60:63], a[144:147], v[40:43], v[60:63]
ds_read_b128 v[32:35], v11 offset:43008
v_mfma_f32_16x16x32_bf16 v[64:67], a[148:151], v[40:43], v[64:67]
s_waitcnt lgkmcnt(4)
v_mfma_f32_16x16x32_bf16 v[52:55], a[152:155], v[44:47], v[52:55]
ds_read_b128 v[36:39], v10 offset:45056
v_mfma_f32_16x16x32_bf16 v[56:59], a[156:159], v[44:47], v[56:59]
v_mfma_f32_16x16x32_bf16 v[60:63], a[152:155], v[48:51], v[60:63]
ds_read_b128 v[40:43], v10 offset:47104
v_mfma_f32_16x16x32_bf16 v[64:67], a[156:159], v[48:51], v[64:67]
s_waitcnt lgkmcnt(4)
v_mfma_f32_16x16x32_bf16 v[52:55], a[160:163], v[20:23], v[52:55]
ds_read_b128 v[44:47], v11 offset:45056
v_mfma_f32_16x16x32_bf16 v[56:59], a[164:167], v[20:23], v[56:59]
v_mfma_f32_16x16x32_bf16 v[60:63], a[160:163], v[24:27], v[60:63]
ds_read_b128 v[48:51], v11 offset:47104
v_mfma_f32_16x16x32_bf16 v[64:67], a[164:167], v[24:27], v[64:67]
s_waitcnt lgkmcnt(4)
v_mfma_f32_16x16x32_bf16 v[52:55], a[168:171], v[28:31], v[52:55]
ds_read_b128 v[20:23], v10 offset:49152
v_mfma_f32_16x16x32_bf16 v[56:59], a[172:175], v[28:31], v[56:59]
v_mfma_f32_16x16x32_bf16 v[60:63], a[168:171], v[32:35], v[60:63]
ds_read_b128 v[24:27], v10 offset:51200
v_mfma_f32_16x16x32_bf16 v[64:67], a[172:175], v[32:35], v[64:67]
s_waitcnt lgkmcnt(4)
v_mfma_f32_16x16x32_bf16 v[52:55], a[176:179], v[36:39], v[52:55]
ds_read_b128 v[28:31], v11 offset:49152
v_mfma_f32_16x16x32_bf16 v[56:59], a[180:183], v[36:39], v[56:59]
v_mfma_f32_16x16x32_bf16 v[60:63], a[176:179], v[40:43], v[60:63]
ds_read_b128 v[32:35], v11 offset:51200
v_mfma_f32_16x16x32_bf16 v[64:67], a[180:183], v[40:43], v[64:67]
s_waitcnt lgkmcnt(4)
v_mfma_f32_16x16x32_bf16 v[52:55], a[184:187], v[44:47], v[52:55]
ds_read_b128 v[36:39], v10 offset:53248
v_mfma_f32_16x16x32_bf16 v[56:59], a[188:191], v[44:47], v[56:59]
v_mfma_f32_16x16x32_bf16 v[60:63], a[184:187], v[48:51], v[60:63]
ds_read_b128 v[40:43], v10 offset:55296
v_mfma_f32_16x16x32_bf16 v[64:67], a[188:191], v[48:51], v[64:67]
s_waitcnt lgkmcnt(4)
v_mfma_f32_16x16x32_bf16 v[52:55], a[192:195], v[20:23], v[52:55]
ds_read_b128 v[44:47], v11 offset:53248
v_mfma_f32_16x16x32_bf16 v[56:59], a[196:199], v[20:23], v[56:59]
v_mfma_f32_16x16x32_bf16 v[60:63], a[192:195], v[24:27], v[60:63]
ds_read_b128 v[48:51], v11 offset:55296
v_mfma_f32_16x16x32_bf16 v[64:67], a[196:199], v[24:27], v[64:67]
s_waitcnt lgkmcnt(4)
v_mfma_f32_16x16x32_bf16 v[52:55], a[200:203], v[28:31], v[52:55]
ds_read_b128 v[20:23], v10 offset:57344
v_mfma_f32_16x16x32_bf16 v[56:59], a[204:207], v[28:31], v[56:59]
v_mfma_f32_16x16x32_bf16 v[60:63], a[200:203], v[32:35], v[60:63]
ds_read_b128 v[24:27], v10 offset:59392
v_mfma_f32_16x16x32_bf16 v[64:67], a[204:207], v[32:35], v[64:67]
s_waitcnt lgkmcnt(4)
v_mfma_f32_16x16x32_bf16 v[52:55], a[208:211], v[36:39], v[52:55]
ds_read_b128 v[28:31], v11 offset:57344
v_mfma_f32_16x16x32_bf16 v[56:59], a[212:215], v[36:39], v[56:59]
v_mfma_f32_16x16x32_bf16 v[60:63], a[208:211], v[40:43], v[60:63]
ds_read_b128 v[32:35], v11 offset:59392
v_mfma_f32_16x16x32_bf16 v[64:67], a[212:215], v[40:43], v[64:67]
s_waitcnt lgkmcnt(4)
v_mfma_f32_16x16x32_bf16 v[52:55], a[216:219], v[44:47], v[52:55]
ds_read_b128 v[36:39], v10 offset:61440
v_mfma_f32_16x16x32_bf16 v[56:59], a[220:223], v[44:47], v[56:59]
v_mfma_f32_16x16x32_bf16 v[60:63], a[216:219], v[48:51], v[60:63]
ds_read_b128 v[40:43], v10 offset:63488
v_mfma_f32_16x16x32_bf16 v[64:67], a[220:223], v[48:51], v[64:67]
s_waitcnt lgkmcnt(4)
v_mfma_f32_16x16x32_bf16 v[52:55], a[224:227], v[20:23], v[52:55]
ds_read_b128 v[44:47], v11 offset:61440
v_mfma_f32_16x16x32_bf16 v[56:59], a[228:231], v[20:23], v[56:59]
v_mfma_f32_16x16x32_bf16 v[60:63], a[224:227], v[24:27], v[60:63]
ds_read_b128 v[48:51], v11 offset:63488
v_mfma_f32_16x16x32_bf16 v[64:67], a[228:231], v[24:27], v[64:67]
s_waitcnt lgkmcnt(5)
v_mfma_f32_16x16x32_bf16 v[52:55], a[232:235], v[28:31], v[52:55]
v_mfma_f32_16x16x32_bf16 v[56:59], a[236:239], v[28:31], v[56:59]
s_waitcnt lgkmcnt(4)
v_mfma_f32_16x16x32_bf16 v[60:63], a[232:235], v[32:35], v[60:63]
v_mfma_f32_16x16x32_bf16 v[64:67], a[236:239], v[32:35], v[64:67]
s_waitcnt lgkmcnt(3)
v_mfma_f32_16x16x32_bf16 v[52:55], a[240:243], v[36:39], v[52:55]
v_mfma_f32_16x16x32_bf16 v[56:59], a[244:247], v[36:39], v[56:59]
s_waitcnt lgkmcnt(2)
v_mfma_f32_16x16x32_bf16 v[60:63], a[240:243], v[40:43], v[60:63]
v_mfma_f32_16x16x32_bf16 v[64:67], a[244:247], v[40:43], v[64:67]
s_waitcnt lgkmcnt(1)
v_mfma_f32_16x16x32_bf16 v[52:55], a[248:251], v[44:47], v[52:55]
v_mfma_f32_16x16x32_bf16 v[56:59], a[252:255], v[44:47], v[56:59]
s_waitcnt lgkmcnt(0)
v_mfma_f32_16x16x32_bf16 v[60:63], a[248:251], v[48:51], v[60:63]
v_mfma_f32_16x16x32_bf16 v[64:67], a[252:255], v[48:51], v[64:67]
s_waitcnt vmcnt(0)
s_barrier
s_mov_b32 s50, 0x30000
s_nop 5
v_cvt_pk_bf16_f32 v228, v52, v53
v_cvt_pk_bf16_f32 v229, v54, v55
v_cvt_pk_bf16_f32 v230, v56, v57
v_cvt_pk_bf16_f32 v231, v58, v59
v_cvt_pk_bf16_f32 v232, v60, v61
v_cvt_pk_bf16_f32 v233, v62, v63
v_cvt_pk_bf16_f32 v234, v64, v65
v_cvt_pk_bf16_f32 v235, v66, v67
ds_read_b128 v[20:23], v8 offset:0
ds_read_b128 v[24:27], v8 offset:2048
ds_read_b128 v[28:31], v9 offset:0
ds_read_b128 v[32:35], v9 offset:2048
ds_read_b128 v[36:39], v8 offset:4096
ds_read_b128 v[40:43], v8 offset:6144
s_add_u32 m0, s46, 65536
s_waitcnt lgkmcnt(4)
v_mfma_f32_16x16x32_bf16 v[52:55], a[0:3], v[20:23], 0
ds_read_b128 v[44:47], v9 offset:4096
v_mfma_f32_16x16x32_bf16 v[56:59], a[4:7], v[20:23], 0
buffer_load_dwordx4 v6, s[8:11], s50 offen offset:0 lds
v_mfma_f32_16x16x32_bf16 v[60:63], a[0:3], v[24:27], 0
ds_read_b128 v[48:51], v9 offset:6144
v_mfma_f32_16x16x32_bf16 v[64:67], a[4:7], v[24:27], 0
s_add_u32 m0, s46, 69504
s_waitcnt lgkmcnt(4)
v_mfma_f32_16x16x32_bf16 v[52:55], a[8:11], v[28:31], v[52:55]
ds_read_b128 v[20:23], v8 offset:8192
v_mfma_f32_16x16x32_bf16 v[56:59], a[12:15], v[28:31], v[56:59]
buffer_load_dwordx4 v6, s[8:11], s50 offen offset:128 lds
v_mfma_f32_16x16x32_bf16 v[60:63], a[8:11], v[32:35], v[60:63]
ds_read_b128 v[24:27], v8 offset:10240
v_mfma_f32_16x16x32_bf16 v[64:67], a[12:15], v[32:35], v[64:67]
s_add_u32 m0, s46, 73472
s_waitcnt lgkmcnt(4)
v_mfma_f32_16x16x32_bf16 v[52:55], a[16:19], v[36:39], v[52:55]
ds_read_b128 v[28:31], v9 offset:8192
v_mfma_f32_16x16x32_bf16 v[56:59], a[20:23], v[36:39], v[56:59]
buffer_load_dwordx4 v6, s[8:11], s50 offen offset:256 lds
v_mfma_f32_16x16x32_bf16 v[60:63], a[16:19], v[40:43], v[60:63]
ds_read_b128 v[32:35], v9 offset:10240
v_mfma_f32_16x16x32_bf16 v[64:67], a[20:23], v[40:43], v[64:67]
s_add_u32 m0, s46, 77440
s_waitcnt lgkmcnt(4)
v_mfma_f32_16x16x32_bf16 v[52:55], a[24:27], v[44:47], v[52:55]
ds_read_b128 v[36:39], v8 offset:12288
v_mfma_f32_16x16x32_bf16 v[56:59], a[28:31], v[44:47], v[56:59]
buffer_load_dwordx4 v6, s[8:11], s50 offen offset:384 lds
v_mfma_f32_16x16x32_bf16 v[60:63], a[24:27], v[48:51], v[60:63]
ds_read_b128 v[40:43], v8 offset:14336
v_mfma_f32_16x16x32_bf16 v[64:67], a[28:31], v[48:51], v[64:67]
s_add_u32 m0, s46, 81408
s_waitcnt lgkmcnt(4)
v_mfma_f32_16x16x32_bf16 v[52:55], a[32:35], v[20:23], v[52:55]
ds_read_b128 v[44:47], v9 offset:12288
v_mfma_f32_16x16x32_bf16 v[56:59], a[36:39], v[20:23], v[56:59]
buffer_load_dwordx4 v6, s[8:11], s50 offen offset:512 lds
v_mfma_f32_16x16x32_bf16 v[60:63], a[32:35], v[24:27], v[60:63]
ds_read_b128 v[48:51], v9 offset:14336
v_mfma_f32_16x16x32_bf16 v[64:67], a[36:39], v[24:27], v[64:67]
s_add_u32 m0, s46, 85376
s_waitcnt lgkmcnt(4)
v_mfma_f32_16x16x32_bf16 v[52:55], a[40:43], v[28:31], v[52:55]
ds_read_b128 v[20:23], v8 offset:16384
v_mfma_f32_16x16x32_bf16 v[56:59], a[44:47], v[28:31], v[56:59]
buffer_load_dwordx4 v6, s[8:11], s50 offen offset:640 lds
v_mfma_f32_16x16x32_bf16 v[60:63], a[40:43], v[32:35], v[60:63]
ds_read_b128 v[24:27], v8 offset:18432
v_mfma_f32_16x16x32_bf16 v[64:67], a[44:47], v[32:35], v[64:67]
s_add_u32 m0, s46, 89344
s_waitcnt lgkmcnt(4)
v_mfma_f32_16x16x32_bf16 v[52:55], a[48:51], v[36:39], v[52:55]
ds_read_b128 v[28:31], v9 offset:16384
v_mfma_f32_16x16x32_bf16 v[56:59], a[52:55], v[36:39], v[56:59]
buffer_load_dwordx4 v6, s[8:11], s50 offen offset:768 lds
v_mfma_f32_16x16x32_bf16 v[60:63], a[48:51], v[40:43], v[60:63]
ds_read_b128 v[32:35], v9 offset:18432
v_mfma_f32_16x16x32_bf16 v[64:67], a[52:55], v[40:43], v[64:67]
s_add_u32 m0, s46, 93312
s_waitcnt lgkmcnt(4)
v_mfma_f32_16x16x32_bf16 v[52:55], a[56:59], v[44:47], v[52:55]
ds_read_b128 v[36:39], v8 offset:20480
v_mfma_f32_16x16x32_bf16 v[56:59], a[60:63], v[44:47], v[56:59]
buffer_load_dwordx4 v6, s[8:11], s50 offen offset:896 lds
v_mfma_f32_16x16x32_bf16 v[60:63], a[56:59], v[48:51], v[60:63]
ds_read_b128 v[40:43], v8 offset:22528
v_mfma_f32_16x16x32_bf16 v[64:67], a[60:63], v[48:51], v[64:67]
s_add_u32 m0, s46, 97280
s_waitcnt lgkmcnt(4)
v_mfma_f32_16x16x32_bf16 v[52:55], a[64:67], v[20:23], v[52:55]
ds_read_b128 v[44:47], v9 offset:20480
v_mfma_f32_16x16x32_bf16 v[56:59], a[68:71], v[20:23], v[56:59]
buffer_load_dwordx4 v6, s[8:11], s50 offen offset:1024 lds
v_mfma_f32_16x16x32_bf16 v[60:63], a[64:67], v[24:27], v[60:63]
ds_read_b128 v[48:51], v9 offset:22528
v_mfma_f32_16x16x32_bf16 v[64:67], a[68:71], v[24:27], v[64:67]
s_add_u32 m0, s46, 101248
s_waitcnt lgkmcnt(4)
v_mfma_f32_16x16x32_bf16 v[52:55], a[72:75], v[28:31], v[52:55]
ds_read_b128 v[20:23], v8 offset:24576
v_mfma_f32_16x16x32_bf16 v[56:59], a[76:79], v[28:31], v[56:59]
buffer_load_dwordx4 v6, s[8:11], s50 offen offset:1152 lds
v_mfma_f32_16x16x32_bf16 v[60:63], a[72:75], v[32:35], v[60:63]
ds_read_b128 v[24:27], v8 offset:26624
v_mfma_f32_16x16x32_bf16 v[64:67], a[76:79], v[32:35], v[64:67]
s_add_u32 m0, s46, 105216
s_waitcnt lgkmcnt(4)
v_mfma_f32_16x16x32_bf16 v[52:55], a[80:83], v[36:39], v[52:55]
ds_read_b128 v[28:31], v9 offset:24576
v_mfma_f32_16x16x32_bf16 v[56:59], a[84:87], v[36:39], v[56:59]
buffer_load_dwordx4 v6, s[8:11], s50 offen offset:1280 lds
v_mfma_f32_16x16x32_bf16 v[60:63], a[80:83], v[40:43], v[60:63]
ds_read_b128 v[32:35], v9 offset:26624
v_mfma_f32_16x16x32_bf16 v[64:67], a[84:87], v[40:43], v[64:67]
s_add_u32 m0, s46, 109184
s_waitcnt lgkmcnt(4)
v_mfma_f32_16x16x32_bf16 v[52:55], a[88:91], v[44:47], v[52:55]
ds_read_b128 v[36:39], v8 offset:28672
v_mfma_f32_16x16x32_bf16 v[56:59], a[92:95], v[44:47], v[56:59]
buffer_load_dwordx4 v6, s[8:11], s50 offen offset:1408 lds
v_mfma_f32_16x16x32_bf16 v[60:63], a[88:91], v[48:51], v[60:63]
ds_read_b128 v[40:43], v8 offset:30720
v_mfma_f32_16x16x32_bf16 v[64:67], a[92:95], v[48:51], v[64:67]
s_add_u32 m0, s46, 113152
s_waitcnt lgkmcnt(4)
v_mfma_f32_16x16x32_bf16 v[52:55], a[96:99], v[20:23], v[52:55]
ds_read_b128 v[44:47], v9 offset:28672
v_mfma_f32_16x16x32_bf16 v[56:59], a[100:103], v[20:23], v[56:59]
buffer_load_dwordx4 v6, s[8:11], s50 offen offset:1536 lds
v_mfma_f32_16x16x32_bf16 v[60:63], a[96:99], v[24:27], v[60:63]
ds_read_b128 v[48:51], v9 offset:30720
v_mfma_f32_16x16x32_bf16 v[64:67], a[100:103], v[24:27], v[64:67]
s_add_u32 m0, s46, 117120
s_waitcnt lgkmcnt(4)
v_mfma_f32_16x16x32_bf16 v[52:55], a[104:107], v[28:31], v[52:55]
ds_read_b128 v[20:23], v8 offset:32768
v_mfma_f32_16x16x32_bf16 v[56:59], a[108:111], v[28:31], v[56:59]
buffer_load_dwordx4 v6, s[8:11], s50 offen offset:1664 lds
v_mfma_f32_16x16x32_bf16 v[60:63], a[104:107], v[32:35], v[60:63]
ds_read_b128 v[24:27], v8 offset:34816
v_mfma_f32_16x16x32_bf16 v[64:67], a[108:111], v[32:35], v[64:67]
s_add_u32 m0, s46, 121088
s_waitcnt lgkmcnt(4)
v_mfma_f32_16x16x32_bf16 v[52:55], a[112:115], v[36:39], v[52:55]
ds_read_b128 v[28:31], v9 offset:32768
v_mfma_f32_16x16x32_bf16 v[56:59], a[116:119], v[36:39], v[56:59]
buffer_load_dwordx4 v6, s[8:11], s50 offen offset:1792 lds
v_mfma_f32_16x16x32_bf16 v[60:63], a[112:115], v[40:43], v[60:63]
ds_read_b128 v[32:35], v9 offset:34816
v_mfma_f32_16x16x32_bf16 v[64:67], a[116:119], v[40:43], v[64:67]
s_add_u32 m0, s46, 125056
s_waitcnt lgkmcnt(4)
v_mfma_f32_16x16x32_bf16 v[52:55], a[120:123], v[44:47], v[52:55]
ds_read_b128 v[36:39], v8 offset:36864
v_mfma_f32_16x16x32_bf16 v[56:59], a[124:127], v[44:47], v[56:59]
buffer_load_dwordx4 v6, s[8:11], s50 offen offset:1920 lds
v_mfma_f32_16x16x32_bf16 v[60:63], a[120:123], v[48:51], v[60:63]
ds_read_b128 v[40:43], v8 offset:38912
v_mfma_f32_16x16x32_bf16 v[64:67], a[124:127], v[48:51], v[64:67]
s_waitcnt lgkmcnt(4)
v_mfma_f32_16x16x32_bf16 v[52:55], a[128:131], v[20:23], v[52:55]
ds_read_b128 v[44:47], v9 offset:36864
v_mfma_f32_16x16x32_bf16 v[56:59], a[132:135], v[20:23], v[56:59]
v_mfma_f32_16x16x32_bf16 v[60:63], a[128:131], v[24:27], v[60:63]
ds_read_b128 v[48:51], v9 offset:38912
v_mfma_f32_16x16x32_bf16 v[64:67], a[132:135], v[24:27], v[64:67]
s_waitcnt lgkmcnt(4)
v_mfma_f32_16x16x32_bf16 v[52:55], a[136:139], v[28:31], v[52:55]
ds_read_b128 v[20:23], v8 offset:40960
v_mfma_f32_16x16x32_bf16 v[56:59], a[140:143], v[28:31], v[56:59]
v_mfma_f32_16x16x32_bf16 v[60:63], a[136:139], v[32:35], v[60:63]
ds_read_b128 v[24:27], v8 offset:43008
v_mfma_f32_16x16x32_bf16 v[64:67], a[140:143], v[32:35], v[64:67]
s_waitcnt lgkmcnt(4)
v_mfma_f32_16x16x32_bf16 v[52:55], a[144:147], v[36:39], v[52:55]
ds_read_b128 v[28:31], v9 offset:40960
v_mfma_f32_16x16x32_bf16 v[56:59], a[148:151], v[36:39], v[56:59]
v_mfma_f32_16x16x32_bf16 v[60:63], a[144:147], v[40:43], v[60:63]
ds_read_b128 v[32:35], v9 offset:43008
v_mfma_f32_16x16x32_bf16 v[64:67], a[148:151], v[40:43], v[64:67]
s_waitcnt lgkmcnt(4)
v_mfma_f32_16x16x32_bf16 v[52:55], a[152:155], v[44:47], v[52:55]
ds_read_b128 v[36:39], v8 offset:45056
v_mfma_f32_16x16x32_bf16 v[56:59], a[156:159], v[44:47], v[56:59]
v_mfma_f32_16x16x32_bf16 v[60:63], a[152:155], v[48:51], v[60:63]
ds_read_b128 v[40:43], v8 offset:47104
v_mfma_f32_16x16x32_bf16 v[64:67], a[156:159], v[48:51], v[64:67]
s_waitcnt lgkmcnt(4)
v_mfma_f32_16x16x32_bf16 v[52:55], a[160:163], v[20:23], v[52:55]
ds_read_b128 v[44:47], v9 offset:45056
v_mfma_f32_16x16x32_bf16 v[56:59], a[164:167], v[20:23], v[56:59]
v_mfma_f32_16x16x32_bf16 v[60:63], a[160:163], v[24:27], v[60:63]
ds_read_b128 v[48:51], v9 offset:47104
v_mfma_f32_16x16x32_bf16 v[64:67], a[164:167], v[24:27], v[64:67]
s_waitcnt lgkmcnt(4)
v_mfma_f32_16x16x32_bf16 v[52:55], a[168:171], v[28:31], v[52:55]
ds_read_b128 v[20:23], v8 offset:49152
v_mfma_f32_16x16x32_bf16 v[56:59], a[172:175], v[28:31], v[56:59]
v_mfma_f32_16x16x32_bf16 v[60:63], a[168:171], v[32:35], v[60:63]
ds_read_b128 v[24:27], v8 offset:51200
v_mfma_f32_16x16x32_bf16 v[64:67], a[172:175], v[32:35], v[64:67]
s_waitcnt lgkmcnt(4)
v_mfma_f32_16x16x32_bf16 v[52:55], a[176:179], v[36:39], v[52:55]
ds_read_b128 v[28:31], v9 offset:49152
v_mfma_f32_16x16x32_bf16 v[56:59], a[180:183], v[36:39], v[56:59]
v_mfma_f32_16x16x32_bf16 v[60:63], a[176:179], v[40:43], v[60:63]
ds_read_b128 v[32:35], v9 offset:51200
v_mfma_f32_16x16x32_bf16 v[64:67], a[180:183], v[40:43], v[64:67]
s_waitcnt lgkmcnt(4)
v_mfma_f32_16x16x32_bf16 v[52:55], a[184:187], v[44:47], v[52:55]
ds_read_b128 v[36:39], v8 offset:53248
v_mfma_f32_16x16x32_bf16 v[56:59], a[188:191], v[44:47], v[56:59]
v_mfma_f32_16x16x32_bf16 v[60:63], a[184:187], v[48:51], v[60:63]
ds_read_b128 v[40:43], v8 offset:55296
v_mfma_f32_16x16x32_bf16 v[64:67], a[188:191], v[48:51], v[64:67]
s_waitcnt lgkmcnt(4)
v_mfma_f32_16x16x32_bf16 v[52:55], a[192:195], v[20:23], v[52:55]
ds_read_b128 v[44:47], v9 offset:53248
v_mfma_f32_16x16x32_bf16 v[56:59], a[196:199], v[20:23], v[56:59]
v_mfma_f32_16x16x32_bf16 v[60:63], a[192:195], v[24:27], v[60:63]
ds_read_b128 v[48:51], v9 offset:55296
v_mfma_f32_16x16x32_bf16 v[64:67], a[196:199], v[24:27], v[64:67]
s_waitcnt lgkmcnt(4)
v_mfma_f32_16x16x32_bf16 v[52:55], a[200:203], v[28:31], v[52:55]
ds_read_b128 v[20:23], v8 offset:57344
v_mfma_f32_16x16x32_bf16 v[56:59], a[204:207], v[28:31], v[56:59]
v_mfma_f32_16x16x32_bf16 v[60:63], a[200:203], v[32:35], v[60:63]
ds_read_b128 v[24:27], v8 offset:59392
v_mfma_f32_16x16x32_bf16 v[64:67], a[204:207], v[32:35], v[64:67]
s_waitcnt lgkmcnt(4)
v_mfma_f32_16x16x32_bf16 v[52:55], a[208:211], v[36:39], v[52:55]
ds_read_b128 v[28:31], v9 offset:57344
v_mfma_f32_16x16x32_bf16 v[56:59], a[212:215], v[36:39], v[56:59]
v_mfma_f32_16x16x32_bf16 v[60:63], a[208:211], v[40:43], v[60:63]
ds_read_b128 v[32:35], v9 offset:59392
v_mfma_f32_16x16x32_bf16 v[64:67], a[212:215], v[40:43], v[64:67]
s_waitcnt lgkmcnt(4)
v_mfma_f32_16x16x32_bf16 v[52:55], a[216:219], v[44:47], v[52:55]
ds_read_b128 v[36:39], v8 offset:61440
v_mfma_f32_16x16x32_bf16 v[56:59], a[220:223], v[44:47], v[56:59]
v_mfma_f32_16x16x32_bf16 v[60:63], a[216:219], v[48:51], v[60:63]
ds_read_b128 v[40:43], v8 offset:63488
v_mfma_f32_16x16x32_bf16 v[64:67], a[220:223], v[48:51], v[64:67]
s_waitcnt lgkmcnt(4)
v_mfma_f32_16x16x32_bf16 v[52:55], a[224:227], v[20:23], v[52:55]
ds_read_b128 v[44:47], v9 offset:61440
v_mfma_f32_16x16x32_bf16 v[56:59], a[228:231], v[20:23], v[56:59]
v_mfma_f32_16x16x32_bf16 v[60:63], a[224:227], v[24:27], v[60:63]
ds_read_b128 v[48:51], v9 offset:63488
v_mfma_f32_16x16x32_bf16 v[64:67], a[228:231], v[24:27], v[64:67]
s_waitcnt lgkmcnt(5)
v_mfma_f32_16x16x32_bf16 v[52:55], a[232:235], v[28:31], v[52:55]
v_mfma_f32_16x16x32_bf16 v[56:59], a[236:239], v[28:31], v[56:59]
s_waitcnt lgkmcnt(4)
v_mfma_f32_16x16x32_bf16 v[60:63], a[232:235], v[32:35], v[60:63]
v_mfma_f32_16x16x32_bf16 v[64:67], a[236:239], v[32:35], v[64:67]
s_waitcnt lgkmcnt(3)
v_mfma_f32_16x16x32_bf16 v[52:55], a[240:243], v[36:39], v[52:55]
v_mfma_f32_16x16x32_bf16 v[56:59], a[244:247], v[36:39], v[56:59]
s_waitcnt lgkmcnt(2)
v_mfma_f32_16x16x32_bf16 v[60:63], a[240:243], v[40:43], v[60:63]
v_mfma_f32_16x16x32_bf16 v[64:67], a[244:247], v[40:43], v[64:67]
s_waitcnt lgkmcnt(1)
v_mfma_f32_16x16x32_bf16 v[68:71], a[248:251], v[44:47], v[52:55]
v_mfma_f32_16x16x32_bf16 v[72:75], a[252:255], v[44:47], v[56:59]
s_waitcnt lgkmcnt(0)
v_mfma_f32_16x16x32_bf16 v[76:79], a[248:251], v[48:51], v[60:63]
v_mfma_f32_16x16x32_bf16 v[80:83], a[252:255], v[48:51], v[64:67]
s_waitcnt vmcnt(0)
mega_kernel_q_loop:
s_barrier
s_cmp_gt_i32 s55, s42
s_cbranch_scc1 mega_kernel_q_kv1k
mega_kernel_q_kv1w:
v_mov_b32 v2, 0
s_mov_b64 exec, 0xff
buffer_atomic_add v2, v99, s[84:87], 0 offen sc0 sc1
s_mov_b64 exec, -1
s_waitcnt vmcnt(0)
v_min_i32_dpp v2, v2, v2 quad_perm:[1,0,3,2] row_mask:0xf bank_mask:0xf
s_nop 1
v_min_i32_dpp v2, v2, v2 quad_perm:[2,3,0,1] row_mask:0xf bank_mask:0xf
s_nop 1
v_min_i32_dpp v2, v2, v2 row_half_mirror row_mask:0xf bank_mask:0xf
s_nop 0
v_readfirstlane_b32 s55, v2
s_cmp_gt_i32 s55, s42
s_cbranch_scc1 mega_kernel_q_kv1k
s_sleep 4
s_branch mega_kernel_q_kv1w
mega_kernel_q_kv1k:
s_cmp_ge_u32 s42, 61
s_cbranch_scc0 mega_kernel_q_nl1
s_add_u32 s51, s47, s42
s_bfe_u32 s57, s51, 0x40002
s_lshl_b32 s57, s57, 14
s_and_b32 s66, s51, 3
s_lshl_b32 s66, s66, 11
s_add_u32 s66, s66, s57
s_add_u32 s66, s66, s58
s_add_u32 s67, s66, 33554432
s_bfe_u32 s57, s51, 0x30003
s_lshl_b32 s57, s57, 14
s_and_b32 s68, s51, 7
s_lshl_b32 s68, s68, 10
s_add_u32 s68, s68, s57
s_add_u32 s68, s68, s59
s_add_u32 s50, s42, 4
s_min_u32 s50, s50, 63
s_lshl_b32 s50, s50, 16
s_cmp_gt_i32 s56, s42
s_cselect_b32 s30, 1, 0
s_add_u32 m0, s60, 0
s_nop 0
buffer_load_dwordx4 v5, s[84:87], s66 offen offset:0 sc1 lds
s_add_u32 m0, s60, 0
s_nop 0
buffer_load_dwordx4 v5, s[84:87], s66 offen offset:1024 sc1 lds
s_add_u32 m0, s60, 8192
s_nop 0
buffer_load_dwordx4 v5, s[84:87], s67 offen offset:0 sc1 lds
s_add_u32 m0, s60, 8192
s_nop 0
buffer_load_dwordx4 v5, s[84:87], s67 offen offset:1024 sc1 lds
s_cmp_eq_u32 s30, 1
s_cbranch_scc0 mega_kernel_q_kx1
s_mov_b32 m0, s61
s_nop 0
buffer_load_dwordx4 v5, s[84:87], s68 offen sc1 lds
mega_kernel_q_kx1:
v_mov_b64 v[84:85], v[220:221]
v_mov_b64 v[86:87], v[222:223]
v_mov_b64 v[88:89], v[224:225]
v_mov_b64 v[90:91], v[226:227]
v_mov_b64 v[220:221], v[228:229]
v_mov_b64 v[222:223], v[230:231]
v_mov_b64 v[224:225], v[232:233]
v_mov_b64 v[226:227], v[234:235]
v_cvt_pk_bf16_f32 v228, v68, v69
v_cvt_pk_bf16_f32 v229, v70, v71
v_cvt_pk_bf16_f32 v230, v72, v73
v_cvt_pk_bf16_f32 v231, v74, v75
v_cvt_pk_bf16_f32 v232, v76, v77
v_cvt_pk_bf16_f32 v233, v78, v79
v_cvt_pk_bf16_f32 v234, v80, v81
v_cvt_pk_bf16_f32 v235, v82, v83
ds_write_b128 v101, v[84:87]
ds_write_b128 v101, v[88:91] offset:1024
s_waitcnt vmcnt(4)
v_mov_b32 v17, s42
s_mov_b64 exec, 1
buffer_store_dword v17, v16, s[84:87], s49 offen sc1
s_mov_b64 exec, -1
s_branch mega_kernel_q_jl1
mega_kernel_q_nl1:
ds_read_b128 v[20:23], v10 offset:0
ds_read_b128 v[24:27], v10 offset:2048
ds_read_b128 v[28:31], v11 offset:0
ds_read_b128 v[32:35], v11 offset:2048
ds_read_b128 v[36:39], v10 offset:4096
ds_read_b128 v[40:43], v10 offset:6144
s_add_u32 s51, s47, s42
s_bfe_u32 s57, s51, 0x40002
s_lshl_b32 s57, s57, 14
s_and_b32 s66, s51, 3
s_lshl_b32 s66, s66, 11
s_add_u32 s66, s66, s57
s_add_u32 s66, s66, s58
s_add_u32 s67, s66, 33554432
s_bfe_u32 s57, s51, 0x30003
s_lshl_b32 s57, s57, 14
s_and_b32 s68, s51, 7
s_lshl_b32 s68, s68, 10
s_add_u32 s68, s68, s57
s_add_u32 s68, s68, s59
s_add_u32 s50, s42, 4
s_min_u32 s50, s50, 63
s_lshl_b32 s50, s50, 16
s_cmp_gt_i32 s56, s42
s_cselect_b32 s30, 1, 0
s_add_u32 m0, s60, 0
s_waitcnt lgkmcnt(4)
v_mfma_f32_16x16x32_bf16 v[52:55], a[0:3], v[20:23], 0
ds_read_b128 v[44:47], v11 offset:4096
v_mfma_f32_16x16x32_bf16 v[56:59], a[4:7], v[20:23], 0
buffer_load_dwordx4 v5, s[84:87], s66 offen offset:0 sc1 lds
v_mfma_f32_16x16x32_bf16 v[60:63], a[0:3], v[24:27], 0
ds_read_b128 v[48:51], v11 offset:6144
v_mfma_f32_16x16x32_bf16 v[64:67], a[4:7], v[24:27], 0
s_add_u32 m0, s60, 0
s_waitcnt lgkmcnt(4)
v_mfma_f32_16x16x32_bf16 v[52:55], a[8:11], v[28:31], v[52:55]
ds_read_b128 v[20:23], v10 offset:8192
v_mfma_f32_16x16x32_bf16 v[56:59], a[12:15], v[28:31], v[56:59]
buffer_load_dwordx4 v5, s[84:87], s66 offen offset:1024 sc1 lds
v_mfma_f32_16x16x32_bf16 v[60:63], a[8:11], v[32:35], v[60:63]
ds_read_b128 v[24:27], v10 offset:10240
v_mfma_f32_16x16x32_bf16 v[64:67], a[12:15], v[32:35], v[64:67]
s_add_u32 m0, s60, 8192
s_waitcnt lgkmcnt(4)
v_mfma_f32_16x16x32_bf16 v[52:55], a[16:19], v[36:39], v[52:55]
ds_read_b128 v[28:31], v11 offset:8192
v_mfma_f32_16x16x32_bf16 v[56:59], a[20:23], v[36:39], v[56:59]
buffer_load_dwordx4 v5, s[84:87], s67 offen offset:0 sc1 lds
v_mfma_f32_16x16x32_bf16 v[60:63], a[16:19], v[40:43], v[60:63]
ds_read_b128 v[32:35], v11 offset:10240
v_mfma_f32_16x16x32_bf16 v[64:67], a[20:23], v[40:43], v[64:67]
s_add_u32 m0, s60, 8192
s_waitcnt lgkmcnt(4)
v_mfma_f32_16x16x32_bf16 v[52:55], a[24:27], v[44:47], v[52:55]
ds_read_b128 v[36:39], v10 offset:12288
v_mfma_f32_16x16x32_bf16 v[56:59], a[28:31], v[44:47], v[56:59]
buffer_load_dwordx4 v5, s[84:87], s67 offen offset:1024 sc1 lds
v_mfma_f32_16x16x32_bf16 v[60:63], a[24:27], v[48:51], v[60:63]
ds_read_b128 v[40:43], v10 offset:14336
v_mfma_f32_16x16x32_bf16 v[64:67], a[28:31], v[48:51], v[64:67]
s_waitcnt lgkmcnt(4)
v_mfma_f32_16x16x32_bf16 v[52:55], a[32:35], v[20:23], v[52:55]
ds_read_b128 v[44:47], v11 offset:12288
v_mfma_f32_16x16x32_bf16 v[56:59], a[36:39], v[20:23], v[56:59]
s_cmp_eq_u32 s30, 1
s_cbranch_scc0 mega_kernel_q_ke1
s_mov_b32 m0, s61
s_nop 0
buffer_load_dwordx4 v5, s[84:87], s68 offen sc1 lds
mega_kernel_q_ke1:
v_mfma_f32_16x16x32_bf16 v[60:63], a[32:35], v[24:27], v[60:63]
ds_read_b128 v[48:51], v11 offset:14336
v_mfma_f32_16x16x32_bf16 v[64:67], a[36:39], v[24:27], v[64:67]
s_add_u32 m0, s46, 0
s_waitcnt lgkmcnt(4)
v_mfma_f32_16x16x32_bf16 v[52:55], a[40:43], v[28:31], v[52:55]
ds_read_b128 v[20:23], v10 offset:16384
v_mfma_f32_16x16x32_bf16 v[56:59], a[44:47], v[28:31], v[56:59]
buffer_load_dwordx4 v6, s[8:11], s50 offen offset:0 lds
v_mfma_f32_16x16x32_bf16 v[60:63], a[40:43], v[32:35], v[60:63]
ds_read_b128 v[24:27], v10 offset:18432
v_mfma_f32_16x16x32_bf16 v[64:67], a[44:47], v[32:35], v[64:67]
s_add_u32 m0, s46, 3968
s_waitcnt lgkmcnt(4)
v_mfma_f32_16x16x32_bf16 v[52:55], a[48:51], v[36:39], v[52:55]
ds_read_b128 v[28:31], v11 offset:16384
v_mfma_f32_16x16x32_bf16 v[56:59], a[52:55], v[36:39], v[56:59]
buffer_load_dwordx4 v6, s[8:11], s50 offen offset:128 lds
v_mfma_f32_16x16x32_bf16 v[60:63], a[48:51], v[40:43], v[60:63]
ds_read_b128 v[32:35], v11 offset:18432
v_mfma_f32_16x16x32_bf16 v[64:67], a[52:55], v[40:43], v[64:67]
s_add_u32 m0, s46, 7936
s_waitcnt lgkmcnt(4)
v_mfma_f32_16x16x32_bf16 v[52:55], a[56:59], v[44:47], v[52:55]
ds_read_b128 v[36:39], v10 offset:20480
v_mfma_f32_16x16x32_bf16 v[56:59], a[60:63], v[44:47], v[56:59]
buffer_load_dwordx4 v6, s[8:11], s50 offen offset:256 lds
v_mfma_f32_16x16x32_bf16 v[60:63], a[56:59], v[48:51], v[60:63]
ds_read_b128 v[40:43], v10 offset:22528
v_mfma_f32_16x16x32_bf16 v[64:67], a[60:63], v[48:51], v[64:67]
s_add_u32 m0, s46, 11904
s_waitcnt lgkmcnt(4)
v_mfma_f32_16x16x32_bf16 v[52:55], a[64:67], v[20:23], v[52:55]
ds_read_b128 v[44:47], v11 offset:20480
v_mfma_f32_16x16x32_bf16 v[56:59], a[68:71], v[20:23], v[56:59]
buffer_load_dwordx4 v6, s[8:11], s50 offen offset:384 lds
v_mfma_f32_16x16x32_bf16 v[60:63], a[64:67], v[24:27], v[60:63]
ds_read_b128 v[48:51], v11 offset:22528
v_mfma_f32_16x16x32_bf16 v[64:67], a[68:71], v[24:27], v[64:67]
s_add_u32 m0, s46, 15872
s_waitcnt lgkmcnt(4)
v_mfma_f32_16x16x32_bf16 v[52:55], a[72:75], v[28:31], v[52:55]
ds_read_b128 v[20:23], v10 offset:24576
v_mfma_f32_16x16x32_bf16 v[56:59], a[76:79], v[28:31], v[56:59]
buffer_load_dwordx4 v6, s[8:11], s50 offen offset:512 lds
v_mfma_f32_16x16x32_bf16 v[60:63], a[72:75], v[32:35], v[60:63]
ds_read_b128 v[24:27], v10 offset:26624
v_mfma_f32_16x16x32_bf16 v[64:67], a[76:79], v[32:35], v[64:67]
s_add_u32 m0, s46, 19840
s_waitcnt lgkmcnt(4)
v_mfma_f32_16x16x32_bf16 v[52:55], a[80:83], v[36:39], v[52:55]
ds_read_b128 v[28:31], v11 offset:24576
v_mfma_f32_16x16x32_bf16 v[56:59], a[84:87], v[36:39], v[56:59]
buffer_load_dwordx4 v6, s[8:11], s50 offen offset:640 lds
v_mfma_f32_16x16x32_bf16 v[60:63], a[80:83], v[40:43], v[60:63]
ds_read_b128 v[32:35], v11 offset:26624
v_mfma_f32_16x16x32_bf16 v[64:67], a[84:87], v[40:43], v[64:67]
s_add_u32 m0, s46, 23808
s_waitcnt lgkmcnt(4)
v_mfma_f32_16x16x32_bf16 v[52:55], a[88:91], v[44:47], v[52:55]
ds_read_b128 v[36:39], v10 offset:28672
v_mfma_f32_16x16x32_bf16 v[56:59], a[92:95], v[44:47], v[56:59]
buffer_load_dwordx4 v6, s[8:11], s50 offen offset:768 lds
v_mfma_f32_16x16x32_bf16 v[60:63], a[88:91], v[48:51], v[60:63]
ds_read_b128 v[40:43], v10 offset:30720
v_mfma_f32_16x16x32_bf16 v[64:67], a[92:95], v[48:51], v[64:67]
s_add_u32 m0, s46, 27776
s_waitcnt lgkmcnt(4)
v_mfma_f32_16x16x32_bf16 v[52:55], a[96:99], v[20:23], v[52:55]
ds_read_b128 v[44:47], v11 offset:28672
v_mfma_f32_16x16x32_bf16 v[56:59], a[100:103], v[20:23], v[56:59]
buffer_load_dwordx4 v6, s[8:11], s50 offen offset:896 lds
v_mfma_f32_16x16x32_bf16 v[60:63], a[96:99], v[24:27], v[60:63]
ds_read_b128 v[48:51], v11 offset:30720
v_mfma_f32_16x16x32_bf16 v[64:67], a[100:103], v[24:27], v[64:67]
s_add_u32 m0, s46, 31744
s_waitcnt lgkmcnt(4)
v_mfma_f32_16x16x32_bf16 v[52:55], a[104:107], v[28:31], v[52:55]
ds_read_b128 v[20:23], v10 offset:32768
v_mfma_f32_16x16x32_bf16 v[56:59], a[108:111], v[28:31], v[56:59]
buffer_load_dwordx4 v6, s[8:11], s50 offen offset:1024 lds
v_mfma_f32_16x16x32_bf16 v[60:63], a[104:107], v[32:35], v[60:63]
ds_read_b128 v[24:27], v10 offset:34816
v_mfma_f32_16x16x32_bf16 v[64:67], a[108:111], v[32:35], v[64:67]
s_waitcnt vmcnt(13)
v_mov_b32 v17, s42
s_mov_b64 exec, 1
buffer_store_dword v17, v16, s[84:87], s49 offen sc1
s_mov_b64 exec, -1
s_add_u32 m0, s46, 35712
s_waitcnt lgkmcnt(4)
v_mfma_f32_16x16x32_bf16 v[52:55], a[112:115], v[36:39], v[52:55]
ds_read_b128 v[28:31], v11 offset:32768
v_mfma_f32_16x16x32_bf16 v[56:59], a[116:119], v[36:39], v[56:59]
buffer_load_dwordx4 v6, s[8:11], s50 offen offset:1152 lds
v_mfma_f32_16x16x32_bf16 v[60:63], a[112:115], v[40:43], v[60:63]
ds_read_b128 v[32:35], v11 offset:34816
v_mfma_f32_16x16x32_bf16 v[64:67], a[116:119], v[40:43], v[64:67]
v_mov_b32 v100, 0
s_mov_b64 exec, 1
buffer_atomic_add v100, v16, s[84:87], s62 offen sc0 sc1
s_mov_b64 exec, -1
s_add_u32 m0, s46, 39680
s_waitcnt lgkmcnt(4)
v_mfma_f32_16x16x32_bf16 v[52:55], a[120:123], v[44:47], v[52:55]
ds_read_b128 v[36:39], v10 offset:36864
v_mfma_f32_16x16x32_bf16 v[56:59], a[124:127], v[44:47], v[56:59]
buffer_load_dwordx4 v6, s[8:11], s50 offen offset:1280 lds
v_mfma_f32_16x16x32_bf16 v[60:63], a[120:123], v[48:51], v[60:63]
ds_read_b128 v[40:43], v10 offset:38912
v_mfma_f32_16x16x32_bf16 v[64:67], a[124:127], v[48:51], v[64:67]
s_add_u32 m0, s46, 43648
s_waitcnt lgkmcnt(4)
v_mfma_f32_16x16x32_bf16 v[52:55], a[128:131], v[20:23], v[52:55]
ds_read_b128 v[44:47], v11 offset:36864
v_mfma_f32_16x16x32_bf16 v[56:59], a[132:135], v[20:23], v[56:59]
buffer_load_dwordx4 v6, s[8:11], s50 offen offset:1408 lds
v_mfma_f32_16x16x32_bf16 v[60:63], a[128:131], v[24:27], v[60:63]
ds_read_b128 v[48:51], v11 offset:38912
v_mfma_f32_16x16x32_bf16 v[64:67], a[132:135], v[24:27], v[64:67]
s_add_u32 m0, s46, 47616
s_waitcnt lgkmcnt(4)
v_mfma_f32_16x16x32_bf16 v[52:55], a[136:139], v[28:31], v[52:55]
ds_read_b128 v[20:23], v10 offset:40960
v_mfma_f32_16x16x32_bf16 v[56:59], a[140:143], v[28:31], v[56:59]
buffer_load_dwordx4 v6, s[8:11], s50 offen offset:1536 lds
v_mfma_f32_16x16x32_bf16 v[60:63], a[136:139], v[32:35], v[60:63]
ds_read_b128 v[24:27], v10 offset:43008
v_mfma_f32_16x16x32_bf16 v[64:67], a[140:143], v[32:35], v[64:67]
s_add_u32 m0, s46, 51584
s_waitcnt lgkmcnt(4)
v_mfma_f32_16x16x32_bf16 v[52:55], a[144:147], v[36:39], v[52:55]
ds_read_b128 v[28:31], v11 offset:40960
v_mfma_f32_16x16x32_bf16 v[56:59], a[148:151], v[36:39], v[56:59]
buffer_load_dwordx4 v6, s[8:11], s50 offen offset:1664 lds
v_mfma_f32_16x16x32_bf16 v[60:63], a[144:147], v[40:43], v[60:63]
ds_read_b128 v[32:35], v11 offset:43008
v_mfma_f32_16x16x32_bf16 v[64:67], a[148:151], v[40:43], v[64:67]
s_add_u32 m0, s46, 55552
s_waitcnt lgkmcnt(4)
v_mfma_f32_16x16x32_bf16 v[52:55], a[152:155], v[44:47], v[52:55]
ds_read_b128 v[36:39], v10 offset:45056
v_mfma_f32_16x16x32_bf16 v[56:59], a[156:159], v[44:47], v[56:59]
buffer_load_dwordx4 v6, s[8:11], s50 offen offset:1792 lds
v_mfma_f32_16x16x32_bf16 v[60:63], a[152:155], v[48:51], v[60:63]
ds_read_b128 v[40:43], v10 offset:47104
v_mfma_f32_16x16x32_bf16 v[64:67], a[156:159], v[48:51], v[64:67]
s_add_u32 m0, s46, 59520
s_waitcnt lgkmcnt(4)
v_mfma_f32_16x16x32_bf16 v[52:55], a[160:163], v[20:23], v[52:55]
ds_read_b128 v[44:47], v11 offset:45056
v_mfma_f32_16x16x32_bf16 v[56:59], a[164:167], v[20:23], v[56:59]
buffer_load_dwordx4 v6, s[8:11], s50 offen offset:1920 lds
v_mfma_f32_16x16x32_bf16 v[60:63], a[160:163], v[24:27], v[60:63]
ds_read_b128 v[48:51], v11 offset:47104
v_mfma_f32_16x16x32_bf16 v[64:67], a[164:167], v[24:27], v[64:67]
s_waitcnt lgkmcnt(4)
v_mfma_f32_16x16x32_bf16 v[52:55], a[168:171], v[28:31], v[52:55]
ds_read_b128 v[20:23], v10 offset:49152
v_mfma_f32_16x16x32_bf16 v[56:59], a[172:175], v[28:31], v[56:59]
v_mov_b64 v[84:85], v[220:221]
v_mov_b64 v[86:87], v[222:223]
v_mfma_f32_16x16x32_bf16 v[60:63], a[168:171], v[32:35], v[60:63]
ds_read_b128 v[24:27], v10 offset:51200
v_mfma_f32_16x16x32_bf16 v[64:67], a[172:175], v[32:35], v[64:67]
v_mov_b64 v[88:89], v[224:225]
v_mov_b64 v[90:91], v[226:227]
s_waitcnt lgkmcnt(4)
v_mfma_f32_16x16x32_bf16 v[52:55], a[176:179], v[36:39], v[52:55]
ds_read_b128 v[28:31], v11 offset:49152
v_mfma_f32_16x16x32_bf16 v[56:59], a[180:183], v[36:39], v[56:59]
v_mov_b64 v[220:221], v[228:229]
v_mov_b64 v[222:223], v[230:231]
v_mfma_f32_16x16x32_bf16 v[60:63], a[176:179], v[40:43], v[60:63]
ds_read_b128 v[32:35], v11 offset:51200
v_mfma_f32_16x16x32_bf16 v[64:67], a[180:183], v[40:43], v[64:67]
v_mov_b64 v[224:225], v[232:233]
v_mov_b64 v[226:227], v[234:235]
s_waitcnt lgkmcnt(4)
v_mfma_f32_16x16x32_bf16 v[52:55], a[184:187], v[44:47], v[52:55]
ds_read_b128 v[36:39], v10 offset:53248
v_mfma_f32_16x16x32_bf16 v[56:59], a[188:191], v[44:47], v[56:59]
v_cvt_pk_bf16_f32 v228, v68, v69
v_cvt_pk_bf16_f32 v229, v70, v71
v_mfma_f32_16x16x32_bf16 v[60:63], a[184:187], v[48:51], v[60:63]
ds_read_b128 v[40:43], v10 offset:55296
v_mfma_f32_16x16x32_bf16 v[64:67], a[188:191], v[48:51], v[64:67]
v_cvt_pk_bf16_f32 v230, v72, v73
v_cvt_pk_bf16_f32 v231, v74, v75
s_waitcnt lgkmcnt(4)
v_mfma_f32_16x16x32_bf16 v[52:55], a[192:195], v[20:23], v[52:55]
ds_read_b128 v[44:47], v11 offset:53248
v_mfma_f32_16x16x32_bf16 v[56:59], a[196:199], v[20:23], v[56:59]
v_cvt_pk_bf16_f32 v232, v76, v77
v_cvt_pk_bf16_f32 v233, v78, v79
v_mfma_f32_16x16x32_bf16 v[60:63], a[192:195], v[24:27], v[60:63]
ds_read_b128 v[48:51], v11 offset:55296
v_mfma_f32_16x16x32_bf16 v[64:67], a[196:199], v[24:27], v[64:67]
v_cvt_pk_bf16_f32 v234, v80, v81
v_cvt_pk_bf16_f32 v235, v82, v83
s_waitcnt lgkmcnt(4)
v_mfma_f32_16x16x32_bf16 v[52:55], a[200:203], v[28:31], v[52:55]
ds_read_b128 v[20:23], v10 offset:57344
v_mfma_f32_16x16x32_bf16 v[56:59], a[204:207], v[28:31], v[56:59]
v_mfma_f32_16x16x32_bf16 v[60:63], a[200:203], v[32:35], v[60:63]
ds_read_b128 v[24:27], v10 offset:59392
v_mfma_f32_16x16x32_bf16 v[64:67], a[204:207], v[32:35], v[64:67]
s_waitcnt lgkmcnt(4)
v_mfma_f32_16x16x32_bf16 v[52:55], a[208:211], v[36:39], v[52:55]
ds_read_b128 v[28:31], v11 offset:57344
v_mfma_f32_16x16x32_bf16 v[56:59], a[212:215], v[36:39], v[56:59]
v_mfma_f32_16x16x32_bf16 v[60:63], a[208:211], v[40:43], v[60:63]
ds_read_b128 v[32:35], v11 offset:59392
v_mfma_f32_16x16x32_bf16 v[64:67], a[212:215], v[40:43], v[64:67]
s_waitcnt lgkmcnt(4)
v_mfma_f32_16x16x32_bf16 v[52:55], a[216:219], v[44:47], v[52:55]
ds_read_b128 v[36:39], v10 offset:61440
v_mfma_f32_16x16x32_bf16 v[56:59], a[220:223], v[44:47], v[56:59]
s_waitcnt vmcnt(6)
v_readfirstlane_b32 s56, v100
s_cmp_eq_u32 s30, 1
s_cbranch_scc1 mega_kernel_q_kf1
s_cmp_gt_i32 s56, s42
s_cbranch_scc0 mega_kernel_q_kf1
s_mov_b32 s30, 1
s_mov_b32 m0, s61
s_nop 0
buffer_load_dwordx4 v5, s[84:87], s68 offen sc1 lds
mega_kernel_q_kf1:
v_mfma_f32_16x16x32_bf16 v[60:63], a[216:219], v[48:51], v[60:63]
ds_read_b128 v[40:43], v10 offset:63488
v_mfma_f32_16x16x32_bf16 v[64:67], a[220:223], v[48:51], v[64:67]
s_waitcnt lgkmcnt(4)
v_mfma_f32_16x16x32_bf16 v[52:55], a[224:227], v[20:23], v[52:55]
ds_read_b128 v[44:47], v11 offset:61440
v_mfma_f32_16x16x32_bf16 v[56:59], a[228:231], v[20:23], v[56:59]
v_mfma_f32_16x16x32_bf16 v[60:63], a[224:227], v[24:27], v[60:63]
ds_read_b128 v[48:51], v11 offset:63488
v_mfma_f32_16x16x32_bf16 v[64:67], a[228:231], v[24:27], v[64:67]
s_waitcnt lgkmcnt(5)
v_mfma_f32_16x16x32_bf16 v[52:55], a[232:235], v[28:31], v[52:55]
v_mfma_f32_16x16x32_bf16 v[56:59], a[236:239], v[28:31], v[56:59]
s_waitcnt lgkmcnt(4)
v_mfma_f32_16x16x32_bf16 v[60:63], a[232:235], v[32:35], v[60:63]
v_mfma_f32_16x16x32_bf16 v[64:67], a[236:239], v[32:35], v[64:67]
s_waitcnt lgkmcnt(3)
v_mfma_f32_16x16x32_bf16 v[52:55], a[240:243], v[36:39], v[52:55]
v_mfma_f32_16x16x32_bf16 v[56:59], a[244:247], v[36:39], v[56:59]
s_waitcnt lgkmcnt(2)
v_mfma_f32_16x16x32_bf16 v[60:63], a[240:243], v[40:43], v[60:63]
v_mfma_f32_16x16x32_bf16 v[64:67], a[244:247], v[40:43], v[64:67]
ds_write_b128 v101, v[84:87]
ds_write_b128 v101, v[88:91] offset:1024
s_waitcnt lgkmcnt(1)
v_mfma_f32_16x16x32_bf16 v[68:71], a[248:251], v[44:47], v[52:55]
v_mfma_f32_16x16x32_bf16 v[72:75], a[252:255], v[44:47], v[56:59]
s_waitcnt lgkmcnt(0)
v_mfma_f32_16x16x32_bf16 v[76:79], a[248:251], v[48:51], v[60:63]
v_mfma_f32_16x16x32_bf16 v[80:83], a[252:255], v[48:51], v[64:67]
mega_kernel_q_jl1:
s_cmp_eq_u32 s30, 1
s_cbranch_scc1 mega_kernel_q_kl1
mega_kernel_q_kw1:
v_mov_b32 v100, 0
s_mov_b64 exec, 1
buffer_atomic_add v100, v16, s[84:87], s62 offen sc0 sc1
s_mov_b64 exec, -1
s_waitcnt vmcnt(0)
v_readfirstlane_b32 s56, v100
s_cmp_gt_i32 s56, s42
s_cbranch_scc1 mega_kernel_q_kv1
s_cmp_eq_u32 s42, 63
s_cbranch_scc1 mega_kernel_q_kw1
s_branch mega_kernel_q_kw1
mega_kernel_q_kv1:
s_mov_b32 m0, s61
s_nop 0
buffer_load_dwordx4 v5, s[84:87], s68 offen sc1 lds
mega_kernel_q_kl1:
s_waitcnt lgkmcnt(0) vmcnt(0)
s_barrier
ds_read_b128 v[184:187], v102 offset:0
ds_read_b128 v[112:115], v103 offset:0
ds_read_b128 v[128:131], v103 offset:1024
ds_read_b128 v[188:191], v102 offset:2048
ds_read_b128 v[116:119], v103 offset:2048
ds_read_b128 v[132:135], v103 offset:3072
ds_read_b128 v[192:195], v102 offset:4096
ds_read_b128 v[120:123], v103 offset:4096
ds_read_b128 v[136:139], v103 offset:5120
ds_read_b128 v[196:199], v102 offset:6144
ds_read_b128 v[124:127], v103 offset:6144
ds_read_b128 v[140:143], v103 offset:7168
s_waitcnt lgkmcnt(9)
v_mfma_f32_16x16x32_bf16 v[200:203], v[112:115], v[184:187], 0
v_mfma_f32_16x16x32_bf16 v[204:207], v[128:131], v[184:187], 0
ds_read_b128 v[160:163], v94 offset:0
s_waitcnt lgkmcnt(7)
v_mfma_f32_16x16x32_bf16 v[200:203], v[116:119], v[188:191], v[200:203]
v_mfma_f32_16x16x32_bf16 v[204:207], v[132:135], v[188:191], v[204:207]
ds_read_b128 v[164:167], v94 offset:1024
s_waitcnt lgkmcnt(5)
v_mfma_f32_16x16x32_bf16 v[200:203], v[120:123], v[192:195], v[200:203]
v_mfma_f32_16x16x32_bf16 v[204:207], v[136:139], v[192:195], v[204:207]
ds_read_b128 v[168:171], v94 offset:2048
s_waitcnt lgkmcnt(3)
v_mfma_f32_16x16x32_bf16 v[200:203], v[124:127], v[196:199], v[200:203]
v_mfma_f32_16x16x32_bf16 v[204:207], v[140:143], v[196:199], v[204:207]
ds_read_b128 v[172:175], v94 offset:3072
s_waitcnt lgkmcnt(3)
v_mfma_f32_16x16x32_bf16 v[208:211], v[160:163], v[184:187], 0
ds_read_b128 v[144:147], v240 offset:0
ds_read_b64 v[176:177], v95 offset:0
s_waitcnt lgkmcnt(4)
v_mfma_f32_16x16x32_bf16 v[208:211], v[164:167], v[188:191], v[208:211]
ds_read_b128 v[148:151], v240 offset:1024
ds_read_b64 v[178:179], v95 offset:256
s_waitcnt lgkmcnt(5)
v_mfma_f32_16x16x32_bf16 v[208:211], v[168:171], v[192:195], v[208:211]
ds_read_b128 v[152:155], v240 offset:2048
ds_read_b64 v[180:181], v95 offset:1024
s_waitcnt lgkmcnt(6)
v_mfma_f32_16x16x32_bf16 v[208:211], v[172:175], v[196:199], v[208:211]
ds_read_b128 v[156:159], v240 offset:3072
ds_read_b64 v[182:183], v95 offset:1280
mega_kernel_q_sm1:
v_pk_mul_f32 v[200:201], v[200:201], s[54:55] op_sel_hi:[1,0]
v_pk_mul_f32 v[202:203], v[202:203], s[54:55] op_sel_hi:[1,0]
v_pk_mul_f32 v[204:205], v[204:205], s[54:55] op_sel_hi:[1,0]
v_pk_mul_f32 v[206:207], v[206:207], s[54:55] op_sel_hi:[1,0]
v_cndmask_b32 v200, v200, v241, s[12:13]
v_cndmask_b32 v201, v201, v241, s[14:15]
v_cndmask_b32 v202, v202, v241, s[16:17]
v_cndmask_b32 v203, v203, v241, s[18:19]
v_cndmask_b32 v204, v204, v241, s[20:21]
v_cndmask_b32 v205, v205, v241, s[22:23]
v_cndmask_b32 v206, v206, v241, s[24:25]
v_cndmask_b32 v207, v207, v241, s[26:27]
v_pk_mul_f32 v[208:209], v[208:209], s[54:55] op_sel_hi:[1,0]
v_pk_mul_f32 v[210:211], v[210:211], s[54:55] op_sel_hi:[1,0]
v_cndmask_b32 v208, v208, v97, s[28:29]
v_cndmask_b32 v209, v209, v97, s[28:29]
v_cndmask_b32 v210, v210, v97, s[28:29]
v_cndmask_b32 v211, v211, v97, s[28:29]
v_max3_f32 v236, v200, v201, v202
v_max3_f32 v236, v236, v203, v204
v_max3_f32 v236, v236, v205, v206
v_max3_f32 v236, v236, v207, v208
v_max3_f32 v236, v236, v209, v210
v_max_f32 v237, v236, v211
v_max_f32 v236, v236, v211
s_nop 1
v_permlane16_swap_b32 v236, v237
s_nop 0
v_max_f32 v238, v236, v237
v_max_f32 v239, v236, v237
s_nop 1
v_permlane32_swap_b32 v238, v239
s_nop 0
v_max_f32 v236, v238, v239
v_pk_add_f32 v[200:201], v[200:201], v[236:237] op_sel_hi:[1,0] neg_lo:[0,1] neg_hi:[0,1]
v_pk_add_f32 v[202:203], v[202:203], v[236:237] op_sel_hi:[1,0] neg_lo:[0,1] neg_hi:[0,1]
v_pk_add_f32 v[204:205], v[204:205], v[236:237] op_sel_hi:[1,0] neg_lo:[0,1] neg_hi:[0,1]
v_pk_add_f32 v[206:207], v[206:207], v[236:237] op_sel_hi:[1,0] neg_lo:[0,1] neg_hi:[0,1]
v_pk_add_f32 v[208:209], v[208:209], v[236:237] op_sel_hi:[1,0] neg_lo:[0,1] neg_hi:[0,1]
v_pk_add_f32 v[210:211], v[210:211], v[236:237] op_sel_hi:[1,0] neg_lo:[0,1] neg_hi:[0,1]
v_exp_f32 v200, v200
v_exp_f32 v201, v201
v_exp_f32 v202, v202
v_exp_f32 v203, v203
v_exp_f32 v204, v204
v_exp_f32 v205, v205
v_exp_f32 v206, v206
v_exp_f32 v207, v207
v_exp_f32 v208, v208
v_exp_f32 v209, v209
v_exp_f32 v210, v210
v_exp_f32 v211, v211
s_nop 0
v_cvt_pk_bf16_f32 v212, v200, v201
v_cvt_pk_bf16_f32 v213, v202, v203
v_cvt_pk_bf16_f32 v214, v204, v205
v_cvt_pk_bf16_f32 v215, v206, v207
v_cvt_pk_bf16_f32 v216, v208, v209
v_cvt_pk_bf16_f32 v217, v210, v211
s_waitcnt lgkmcnt(0)
s_nop 0
v_mfma_f32_16x16x32_bf16 v[108:111], v[104:107], v[212:215], 0
v_mfma_f32_16x16x32_bf16 v[112:115], v[144:147], v[212:215], 0
v_mfma_f32_16x16x32_bf16 v[116:119], v[148:151], v[212:215], 0
v_mfma_f32_16x16x32_bf16 v[120:123], v[152:155], v[212:215], 0
v_mfma_f32_16x16x32_bf16 v[124:127], v[156:159], v[212:215], 0
v_mfma_f32_16x16x16_bf16 v[108:111], v[104:105], v[216:217], v[108:111]
v_mfma_f32_16x16x16_bf16 v[112:115], v[176:177], v[216:217], v[112:115]
v_mfma_f32_16x16x16_bf16 v[116:119], v[178:179], v[216:217], v[116:119]
v_mfma_f32_16x16x16_bf16 v[120:123], v[180:181], v[216:217], v[120:123]
v_mfma_f32_16x16x16_bf16 v[124:127], v[182:183], v[216:217], v[124:127]
s_lshr_b32 s63, s42, 2
s_xnor_b32 s63, s63, s98
s_and_b32 s63, s63, 1
s_lshl_b32 s63, s63, 13
s_lshl_b32 s51, s42, 19
s_add_u32 s51, s51, s63
s_nop 2
v_rcp_f32 v238, v108
v_rcp_f32 v239, v109
s_nop 1
v_pk_mul_f32 v[112:113], v[112:113], v[238:239]
v_pk_mul_f32 v[114:115], v[114:115], v[238:239]
v_pk_mul_f32 v[116:117], v[116:117], v[238:239]
v_pk_mul_f32 v[118:119], v[118:119], v[238:239]
v_pk_mul_f32 v[120:121], v[120:121], v[238:239]
v_pk_mul_f32 v[122:123], v[122:123], v[238:239]
v_pk_mul_f32 v[124:125], v[124:125], v[238:239]
v_pk_mul_f32 v[126:127], v[126:127], v[238:239]
v_cvt_pk_bf16_f32 v200, v112, v113
v_cvt_pk_bf16_f32 v201, v114, v115
v_cvt_pk_bf16_f32 v202, v116, v117
v_cvt_pk_bf16_f32 v203, v118, v119
v_cvt_pk_bf16_f32 v204, v120, v121
v_cvt_pk_bf16_f32 v205, v122, v123
v_cvt_pk_bf16_f32 v206, v124, v125
v_cvt_pk_bf16_f32 v207, v126, v127
buffer_store_dwordx4 v[200:203], v96, s[84:87], s51 offen sc1
buffer_store_dwordx4 v[204:207], v96, s[84:87], s51 offen offset:2048 sc1
s_add_u32 s42, s42, 1
s_barrier
s_cmp_gt_i32 s55, s42
s_cbranch_scc1 mega_kernel_q_kv0k
mega_kernel_q_kv0w:
v_mov_b32 v2, 0
s_mov_b64 exec, 0xff
buffer_atomic_add v2, v99, s[84:87], 0 offen sc0 sc1
s_mov_b64 exec, -1
s_waitcnt vmcnt(0)
v_min_i32_dpp v2, v2, v2 quad_perm:[1,0,3,2] row_mask:0xf bank_mask:0xf
s_nop 1
v_min_i32_dpp v2, v2, v2 quad_perm:[2,3,0,1] row_mask:0xf bank_mask:0xf
s_nop 1
v_min_i32_dpp v2, v2, v2 row_half_mirror row_mask:0xf bank_mask:0xf
s_nop 0
v_readfirstlane_b32 s55, v2
s_cmp_gt_i32 s55, s42
s_cbranch_scc1 mega_kernel_q_kv0k
s_sleep 4
s_branch mega_kernel_q_kv0w
mega_kernel_q_kv0k:
s_cmp_ge_u32 s42, 61
s_cbranch_scc0 mega_kernel_q_nl0
s_add_u32 s51, s47, s42
s_bfe_u32 s57, s51, 0x40002
s_lshl_b32 s57, s57, 14
s_and_b32 s66, s51, 3
s_lshl_b32 s66, s66, 11
s_add_u32 s66, s66, s57
s_add_u32 s66, s66, s58
s_add_u32 s67, s66, 33554432
s_bfe_u32 s57, s51, 0x30003
s_lshl_b32 s57, s57, 14
s_and_b32 s68, s51, 7
s_lshl_b32 s68, s68, 10
s_add_u32 s68, s68, s57
s_add_u32 s68, s68, s59
s_add_u32 s50, s42, 4
s_min_u32 s50, s50, 63
s_lshl_b32 s50, s50, 16
s_cmp_gt_i32 s56, s42
s_cselect_b32 s30, 1, 0
s_add_u32 m0, s60, 0
s_nop 0
buffer_load_dwordx4 v5, s[84:87], s66 offen offset:0 sc1 lds
s_add_u32 m0, s60, 0
s_nop 0
buffer_load_dwordx4 v5, s[84:87], s66 offen offset:1024 sc1 lds
s_add_u32 m0, s60, 8192
s_nop 0
buffer_load_dwordx4 v5, s[84:87], s67 offen offset:0 sc1 lds
s_add_u32 m0, s60, 8192
s_nop 0
buffer_load_dwordx4 v5, s[84:87], s67 offen offset:1024 sc1 lds
s_cmp_eq_u32 s30, 1
s_cbranch_scc0 mega_kernel_q_kx0
s_mov_b32 m0, s61
s_nop 0
buffer_load_dwordx4 v5, s[84:87], s68 offen sc1 lds
mega_kernel_q_kx0:
v_mov_b64 v[84:85], v[220:221]
v_mov_b64 v[86:87], v[222:223]
v_mov_b64 v[88:89], v[224:225]
v_mov_b64 v[90:91], v[226:227]
v_mov_b64 v[220:221], v[228:229]
v_mov_b64 v[222:223], v[230:231]
v_mov_b64 v[224:225], v[232:233]
v_mov_b64 v[226:227], v[234:235]
v_cvt_pk_bf16_f32 v228, v68, v69
v_cvt_pk_bf16_f32 v229, v70, v71
v_cvt_pk_bf16_f32 v230, v72, v73
v_cvt_pk_bf16_f32 v231, v74, v75
v_cvt_pk_bf16_f32 v232, v76, v77
v_cvt_pk_bf16_f32 v233, v78, v79
v_cvt_pk_bf16_f32 v234, v80, v81
v_cvt_pk_bf16_f32 v235, v82, v83
ds_write_b128 v101, v[84:87]
ds_write_b128 v101, v[88:91] offset:1024
s_waitcnt vmcnt(4)
v_mov_b32 v17, s42
s_mov_b64 exec, 1
buffer_store_dword v17, v16, s[84:87], s49 offen sc1
s_mov_b64 exec, -1
s_branch mega_kernel_q_jl0
mega_kernel_q_nl0:
ds_read_b128 v[20:23], v8 offset:0
ds_read_b128 v[24:27], v8 offset:2048
ds_read_b128 v[28:31], v9 offset:0
ds_read_b128 v[32:35], v9 offset:2048
ds_read_b128 v[36:39], v8 offset:4096
ds_read_b128 v[40:43], v8 offset:6144
s_add_u32 s51, s47, s42
s_bfe_u32 s57, s51, 0x40002
s_lshl_b32 s57, s57, 14
s_and_b32 s66, s51, 3
s_lshl_b32 s66, s66, 11
s_add_u32 s66, s66, s57
s_add_u32 s66, s66, s58
s_add_u32 s67, s66, 33554432
s_bfe_u32 s57, s51, 0x30003
s_lshl_b32 s57, s57, 14
s_and_b32 s68, s51, 7
s_lshl_b32 s68, s68, 10
s_add_u32 s68, s68, s57
s_add_u32 s68, s68, s59
s_add_u32 s50, s42, 4
s_min_u32 s50, s50, 63
s_lshl_b32 s50, s50, 16
s_cmp_gt_i32 s56, s42
s_cselect_b32 s30, 1, 0
s_add_u32 m0, s60, 0
s_waitcnt lgkmcnt(4)
v_mfma_f32_16x16x32_bf16 v[52:55], a[0:3], v[20:23], 0
ds_read_b128 v[44:47], v9 offset:4096
v_mfma_f32_16x16x32_bf16 v[56:59], a[4:7], v[20:23], 0
buffer_load_dwordx4 v5, s[84:87], s66 offen offset:0 sc1 lds
v_mfma_f32_16x16x32_bf16 v[60:63], a[0:3], v[24:27], 0
ds_read_b128 v[48:51], v9 offset:6144
v_mfma_f32_16x16x32_bf16 v[64:67], a[4:7], v[24:27], 0
s_add_u32 m0, s60, 0
s_waitcnt lgkmcnt(4)
v_mfma_f32_16x16x32_bf16 v[52:55], a[8:11], v[28:31], v[52:55]
ds_read_b128 v[20:23], v8 offset:8192
v_mfma_f32_16x16x32_bf16 v[56:59], a[12:15], v[28:31], v[56:59]
buffer_load_dwordx4 v5, s[84:87], s66 offen offset:1024 sc1 lds
v_mfma_f32_16x16x32_bf16 v[60:63], a[8:11], v[32:35], v[60:63]
ds_read_b128 v[24:27], v8 offset:10240
v_mfma_f32_16x16x32_bf16 v[64:67], a[12:15], v[32:35], v[64:67]
s_add_u32 m0, s60, 8192
s_waitcnt lgkmcnt(4)
v_mfma_f32_16x16x32_bf16 v[52:55], a[16:19], v[36:39], v[52:55]
ds_read_b128 v[28:31], v9 offset:8192
v_mfma_f32_16x16x32_bf16 v[56:59], a[20:23], v[36:39], v[56:59]
buffer_load_dwordx4 v5, s[84:87], s67 offen offset:0 sc1 lds
v_mfma_f32_16x16x32_bf16 v[60:63], a[16:19], v[40:43], v[60:63]
ds_read_b128 v[32:35], v9 offset:10240
v_mfma_f32_16x16x32_bf16 v[64:67], a[20:23], v[40:43], v[64:67]
s_add_u32 m0, s60, 8192
s_waitcnt lgkmcnt(4)
v_mfma_f32_16x16x32_bf16 v[52:55], a[24:27], v[44:47], v[52:55]
ds_read_b128 v[36:39], v8 offset:12288
v_mfma_f32_16x16x32_bf16 v[56:59], a[28:31], v[44:47], v[56:59]
buffer_load_dwordx4 v5, s[84:87], s67 offen offset:1024 sc1 lds
v_mfma_f32_16x16x32_bf16 v[60:63], a[24:27], v[48:51], v[60:63]
ds_read_b128 v[40:43], v8 offset:14336
v_mfma_f32_16x16x32_bf16 v[64:67], a[28:31], v[48:51], v[64:67]
s_waitcnt lgkmcnt(4)
v_mfma_f32_16x16x32_bf16 v[52:55], a[32:35], v[20:23], v[52:55]
ds_read_b128 v[44:47], v9 offset:12288
v_mfma_f32_16x16x32_bf16 v[56:59], a[36:39], v[20:23], v[56:59]
s_cmp_eq_u32 s30, 1
s_cbranch_scc0 mega_kernel_q_ke0
s_mov_b32 m0, s61
s_nop 0
buffer_load_dwordx4 v5, s[84:87], s68 offen sc1 lds
mega_kernel_q_ke0:
v_mfma_f32_16x16x32_bf16 v[60:63], a[32:35], v[24:27], v[60:63]
ds_read_b128 v[48:51], v9 offset:14336
v_mfma_f32_16x16x32_bf16 v[64:67], a[36:39], v[24:27], v[64:67]
s_add_u32 m0, s46, 65536
s_waitcnt lgkmcnt(4)
v_mfma_f32_16x16x32_bf16 v[52:55], a[40:43], v[28:31], v[52:55]
ds_read_b128 v[20:23], v8 offset:16384
v_mfma_f32_16x16x32_bf16 v[56:59], a[44:47], v[28:31], v[56:59]
buffer_load_dwordx4 v6, s[8:11], s50 offen offset:0 lds
v_mfma_f32_16x16x32_bf16 v[60:63], a[40:43], v[32:35], v[60:63]
ds_read_b128 v[24:27], v8 offset:18432
v_mfma_f32_16x16x32_bf16 v[64:67], a[44:47], v[32:35], v[64:67]
s_add_u32 m0, s46, 69504
s_waitcnt lgkmcnt(4)
v_mfma_f32_16x16x32_bf16 v[52:55], a[48:51], v[36:39], v[52:55]
ds_read_b128 v[28:31], v9 offset:16384
v_mfma_f32_16x16x32_bf16 v[56:59], a[52:55], v[36:39], v[56:59]
buffer_load_dwordx4 v6, s[8:11], s50 offen offset:128 lds
v_mfma_f32_16x16x32_bf16 v[60:63], a[48:51], v[40:43], v[60:63]
ds_read_b128 v[32:35], v9 offset:18432
v_mfma_f32_16x16x32_bf16 v[64:67], a[52:55], v[40:43], v[64:67]
s_add_u32 m0, s46, 73472
s_waitcnt lgkmcnt(4)
v_mfma_f32_16x16x32_bf16 v[52:55], a[56:59], v[44:47], v[52:55]
ds_read_b128 v[36:39], v8 offset:20480
v_mfma_f32_16x16x32_bf16 v[56:59], a[60:63], v[44:47], v[56:59]
buffer_load_dwordx4 v6, s[8:11], s50 offen offset:256 lds
v_mfma_f32_16x16x32_bf16 v[60:63], a[56:59], v[48:51], v[60:63]
ds_read_b128 v[40:43], v8 offset:22528
v_mfma_f32_16x16x32_bf16 v[64:67], a[60:63], v[48:51], v[64:67]
s_add_u32 m0, s46, 77440
s_waitcnt lgkmcnt(4)
v_mfma_f32_16x16x32_bf16 v[52:55], a[64:67], v[20:23], v[52:55]
ds_read_b128 v[44:47], v9 offset:20480
v_mfma_f32_16x16x32_bf16 v[56:59], a[68:71], v[20:23], v[56:59]
buffer_load_dwordx4 v6, s[8:11], s50 offen offset:384 lds
v_mfma_f32_16x16x32_bf16 v[60:63], a[64:67], v[24:27], v[60:63]
ds_read_b128 v[48:51], v9 offset:22528
v_mfma_f32_16x16x32_bf16 v[64:67], a[68:71], v[24:27], v[64:67]
s_add_u32 m0, s46, 81408
s_waitcnt lgkmcnt(4)
v_mfma_f32_16x16x32_bf16 v[52:55], a[72:75], v[28:31], v[52:55]
ds_read_b128 v[20:23], v8 offset:24576
v_mfma_f32_16x16x32_bf16 v[56:59], a[76:79], v[28:31], v[56:59]
buffer_load_dwordx4 v6, s[8:11], s50 offen offset:512 lds
v_mfma_f32_16x16x32_bf16 v[60:63], a[72:75], v[32:35], v[60:63]
ds_read_b128 v[24:27], v8 offset:26624
v_mfma_f32_16x16x32_bf16 v[64:67], a[76:79], v[32:35], v[64:67]
s_add_u32 m0, s46, 85376
s_waitcnt lgkmcnt(4)
v_mfma_f32_16x16x32_bf16 v[52:55], a[80:83], v[36:39], v[52:55]
ds_read_b128 v[28:31], v9 offset:24576
v_mfma_f32_16x16x32_bf16 v[56:59], a[84:87], v[36:39], v[56:59]
buffer_load_dwordx4 v6, s[8:11], s50 offen offset:640 lds
v_mfma_f32_16x16x32_bf16 v[60:63], a[80:83], v[40:43], v[60:63]
ds_read_b128 v[32:35], v9 offset:26624
v_mfma_f32_16x16x32_bf16 v[64:67], a[84:87], v[40:43], v[64:67]
s_add_u32 m0, s46, 89344
s_waitcnt lgkmcnt(4)
v_mfma_f32_16x16x32_bf16 v[52:55], a[88:91], v[44:47], v[52:55]
ds_read_b128 v[36:39], v8 offset:28672
v_mfma_f32_16x16x32_bf16 v[56:59], a[92:95], v[44:47], v[56:59]
buffer_load_dwordx4 v6, s[8:11], s50 offen offset:768 lds
v_mfma_f32_16x16x32_bf16 v[60:63], a[88:91], v[48:51], v[60:63]
ds_read_b128 v[40:43], v8 offset:30720
v_mfma_f32_16x16x32_bf16 v[64:67], a[92:95], v[48:51], v[64:67]
s_add_u32 m0, s46, 93312
s_waitcnt lgkmcnt(4)
v_mfma_f32_16x16x32_bf16 v[52:55], a[96:99], v[20:23], v[52:55]
ds_read_b128 v[44:47], v9 offset:28672
v_mfma_f32_16x16x32_bf16 v[56:59], a[100:103], v[20:23], v[56:59]
buffer_load_dwordx4 v6, s[8:11], s50 offen offset:896 lds
v_mfma_f32_16x16x32_bf16 v[60:63], a[96:99], v[24:27], v[60:63]
ds_read_b128 v[48:51], v9 offset:30720
v_mfma_f32_16x16x32_bf16 v[64:67], a[100:103], v[24:27], v[64:67]
s_add_u32 m0, s46, 97280
s_waitcnt lgkmcnt(4)
v_mfma_f32_16x16x32_bf16 v[52:55], a[104:107], v[28:31], v[52:55]
ds_read_b128 v[20:23], v8 offset:32768
v_mfma_f32_16x16x32_bf16 v[56:59], a[108:111], v[28:31], v[56:59]
buffer_load_dwordx4 v6, s[8:11], s50 offen offset:1024 lds
v_mfma_f32_16x16x32_bf16 v[60:63], a[104:107], v[32:35], v[60:63]
ds_read_b128 v[24:27], v8 offset:34816
v_mfma_f32_16x16x32_bf16 v[64:67], a[108:111], v[32:35], v[64:67]
s_waitcnt vmcnt(13)
v_mov_b32 v17, s42
s_mov_b64 exec, 1
buffer_store_dword v17, v16, s[84:87], s49 offen sc1
s_mov_b64 exec, -1
s_add_u32 m0, s46, 101248
s_waitcnt lgkmcnt(4)
v_mfma_f32_16x16x32_bf16 v[52:55], a[112:115], v[36:39], v[52:55]
ds_read_b128 v[28:31], v9 offset:32768
v_mfma_f32_16x16x32_bf16 v[56:59], a[116:119], v[36:39], v[56:59]
buffer_load_dwordx4 v6, s[8:11], s50 offen offset:1152 lds
v_mfma_f32_16x16x32_bf16 v[60:63], a[112:115], v[40:43], v[60:63]
ds_read_b128 v[32:35], v9 offset:34816
v_mfma_f32_16x16x32_bf16 v[64:67], a[116:119], v[40:43], v[64:67]
v_mov_b32 v100, 0
s_mov_b64 exec, 1
buffer_atomic_add v100, v16, s[84:87], s62 offen sc0 sc1
s_mov_b64 exec, -1
s_add_u32 m0, s46, 105216
s_waitcnt lgkmcnt(4)
v_mfma_f32_16x16x32_bf16 v[52:55], a[120:123], v[44:47], v[52:55]
ds_read_b128 v[36:39], v8 offset:36864
v_mfma_f32_16x16x32_bf16 v[56:59], a[124:127], v[44:47], v[56:59]
buffer_load_dwordx4 v6, s[8:11], s50 offen offset:1280 lds
v_mfma_f32_16x16x32_bf16 v[60:63], a[120:123], v[48:51], v[60:63]
ds_read_b128 v[40:43], v8 offset:38912
v_mfma_f32_16x16x32_bf16 v[64:67], a[124:127], v[48:51], v[64:67]
s_add_u32 m0, s46, 109184
s_waitcnt lgkmcnt(4)
v_mfma_f32_16x16x32_bf16 v[52:55], a[128:131], v[20:23], v[52:55]
ds_read_b128 v[44:47], v9 offset:36864
v_mfma_f32_16x16x32_bf16 v[56:59], a[132:135], v[20:23], v[56:59]
buffer_load_dwordx4 v6, s[8:11], s50 offen offset:1408 lds
v_mfma_f32_16x16x32_bf16 v[60:63], a[128:131], v[24:27], v[60:63]
ds_read_b128 v[48:51], v9 offset:38912
v_mfma_f32_16x16x32_bf16 v[64:67], a[132:135], v[24:27], v[64:67]
s_add_u32 m0, s46, 113152
s_waitcnt lgkmcnt(4)
v_mfma_f32_16x16x32_bf16 v[52:55], a[136:139], v[28:31], v[52:55]
ds_read_b128 v[20:23], v8 offset:40960
v_mfma_f32_16x16x32_bf16 v[56:59], a[140:143], v[28:31], v[56:59]
buffer_load_dwordx4 v6, s[8:11], s50 offen offset:1536 lds
v_mfma_f32_16x16x32_bf16 v[60:63], a[136:139], v[32:35], v[60:63]
ds_read_b128 v[24:27], v8 offset:43008
v_mfma_f32_16x16x32_bf16 v[64:67], a[140:143], v[32:35], v[64:67]
s_add_u32 m0, s46, 117120
s_waitcnt lgkmcnt(4)
v_mfma_f32_16x16x32_bf16 v[52:55], a[144:147], v[36:39], v[52:55]
ds_read_b128 v[28:31], v9 offset:40960
v_mfma_f32_16x16x32_bf16 v[56:59], a[148:151], v[36:39], v[56:59]
buffer_load_dwordx4 v6, s[8:11], s50 offen offset:1664 lds
v_mfma_f32_16x16x32_bf16 v[60:63], a[144:147], v[40:43], v[60:63]
ds_read_b128 v[32:35], v9 offset:43008
v_mfma_f32_16x16x32_bf16 v[64:67], a[148:151], v[40:43], v[64:67]
s_add_u32 m0, s46, 121088
s_waitcnt lgkmcnt(4)
v_mfma_f32_16x16x32_bf16 v[52:55], a[152:155], v[44:47], v[52:55]
ds_read_b128 v[36:39], v8 offset:45056
v_mfma_f32_16x16x32_bf16 v[56:59], a[156:159], v[44:47], v[56:59]
buffer_load_dwordx4 v6, s[8:11], s50 offen offset:1792 lds
v_mfma_f32_16x16x32_bf16 v[60:63], a[152:155], v[48:51], v[60:63]
ds_read_b128 v[40:43], v8 offset:47104
v_mfma_f32_16x16x32_bf16 v[64:67], a[156:159], v[48:51], v[64:67]
s_add_u32 m0, s46, 125056
s_waitcnt lgkmcnt(4)
v_mfma_f32_16x16x32_bf16 v[52:55], a[160:163], v[20:23], v[52:55]
ds_read_b128 v[44:47], v9 offset:45056
v_mfma_f32_16x16x32_bf16 v[56:59], a[164:167], v[20:23], v[56:59]
buffer_load_dwordx4 v6, s[8:11], s50 offen offset:1920 lds
v_mfma_f32_16x16x32_bf16 v[60:63], a[160:163], v[24:27], v[60:63]
ds_read_b128 v[48:51], v9 offset:47104
v_mfma_f32_16x16x32_bf16 v[64:67], a[164:167], v[24:27], v[64:67]
s_waitcnt lgkmcnt(4)
v_mfma_f32_16x16x32_bf16 v[52:55], a[168:171], v[28:31], v[52:55]
ds_read_b128 v[20:23], v8 offset:49152
v_mfma_f32_16x16x32_bf16 v[56:59], a[172:175], v[28:31], v[56:59]
v_mov_b64 v[84:85], v[220:221]
v_mov_b64 v[86:87], v[222:223]
v_mfma_f32_16x16x32_bf16 v[60:63], a[168:171], v[32:35], v[60:63]
ds_read_b128 v[24:27], v8 offset:51200
v_mfma_f32_16x16x32_bf16 v[64:67], a[172:175], v[32:35], v[64:67]
v_mov_b64 v[88:89], v[224:225]
v_mov_b64 v[90:91], v[226:227]
s_waitcnt lgkmcnt(4)
v_mfma_f32_16x16x32_bf16 v[52:55], a[176:179], v[36:39], v[52:55]
ds_read_b128 v[28:31], v9 offset:49152
v_mfma_f32_16x16x32_bf16 v[56:59], a[180:183], v[36:39], v[56:59]
v_mov_b64 v[220:221], v[228:229]
v_mov_b64 v[222:223], v[230:231]
v_mfma_f32_16x16x32_bf16 v[60:63], a[176:179], v[40:43], v[60:63]
ds_read_b128 v[32:35], v9 offset:51200
v_mfma_f32_16x16x32_bf16 v[64:67], a[180:183], v[40:43], v[64:67]
v_mov_b64 v[224:225], v[232:233]
v_mov_b64 v[226:227], v[234:235]
s_waitcnt lgkmcnt(4)
v_mfma_f32_16x16x32_bf16 v[52:55], a[184:187], v[44:47], v[52:55]
ds_read_b128 v[36:39], v8 offset:53248
v_mfma_f32_16x16x32_bf16 v[56:59], a[188:191], v[44:47], v[56:59]
v_cvt_pk_bf16_f32 v228, v68, v69
v_cvt_pk_bf16_f32 v229, v70, v71
v_mfma_f32_16x16x32_bf16 v[60:63], a[184:187], v[48:51], v[60:63]
ds_read_b128 v[40:43], v8 offset:55296
v_mfma_f32_16x16x32_bf16 v[64:67], a[188:191], v[48:51], v[64:67]
v_cvt_pk_bf16_f32 v230, v72, v73
v_cvt_pk_bf16_f32 v231, v74, v75
s_waitcnt lgkmcnt(4)
v_mfma_f32_16x16x32_bf16 v[52:55], a[192:195], v[20:23], v[52:55]
ds_read_b128 v[44:47], v9 offset:53248
v_mfma_f32_16x16x32_bf16 v[56:59], a[196:199], v[20:23], v[56:59]
v_cvt_pk_bf16_f32 v232, v76, v77
v_cvt_pk_bf16_f32 v233, v78, v79
v_mfma_f32_16x16x32_bf16 v[60:63], a[192:195], v[24:27], v[60:63]
ds_read_b128 v[48:51], v9 offset:55296
v_mfma_f32_16x16x32_bf16 v[64:67], a[196:199], v[24:27], v[64:67]
v_cvt_pk_bf16_f32 v234, v80, v81
v_cvt_pk_bf16_f32 v235, v82, v83
s_waitcnt lgkmcnt(4)
v_mfma_f32_16x16x32_bf16 v[52:55], a[200:203], v[28:31], v[52:55]
ds_read_b128 v[20:23], v8 offset:57344
v_mfma_f32_16x16x32_bf16 v[56:59], a[204:207], v[28:31], v[56:59]
v_mfma_f32_16x16x32_bf16 v[60:63], a[200:203], v[32:35], v[60:63]
ds_read_b128 v[24:27], v8 offset:59392
v_mfma_f32_16x16x32_bf16 v[64:67], a[204:207], v[32:35], v[64:67]
s_waitcnt lgkmcnt(4)
v_mfma_f32_16x16x32_bf16 v[52:55], a[208:211], v[36:39], v[52:55]
ds_read_b128 v[28:31], v9 offset:57344
v_mfma_f32_16x16x32_bf16 v[56:59], a[212:215], v[36:39], v[56:59]
v_mfma_f32_16x16x32_bf16 v[60:63], a[208:211], v[40:43], v[60:63]
ds_read_b128 v[32:35], v9 offset:59392
v_mfma_f32_16x16x32_bf16 v[64:67], a[212:215], v[40:43], v[64:67]
s_waitcnt lgkmcnt(4)
v_mfma_f32_16x16x32_bf16 v[52:55], a[216:219], v[44:47], v[52:55]
ds_read_b128 v[36:39], v8 offset:61440
v_mfma_f32_16x16x32_bf16 v[56:59], a[220:223], v[44:47], v[56:59]
s_waitcnt vmcnt(6)
v_readfirstlane_b32 s56, v100
s_cmp_eq_u32 s30, 1
s_cbranch_scc1 mega_kernel_q_kf0
s_cmp_gt_i32 s56, s42
s_cbranch_scc0 mega_kernel_q_kf0
s_mov_b32 s30, 1
s_mov_b32 m0, s61
s_nop 0
buffer_load_dwordx4 v5, s[84:87], s68 offen sc1 lds
mega_kernel_q_kf0:
v_mfma_f32_16x16x32_bf16 v[60:63], a[216:219], v[48:51], v[60:63]
ds_read_b128 v[40:43], v8 offset:63488
v_mfma_f32_16x16x32_bf16 v[64:67], a[220:223], v[48:51], v[64:67]
s_waitcnt lgkmcnt(4)
v_mfma_f32_16x16x32_bf16 v[52:55], a[224:227], v[20:23], v[52:55]
ds_read_b128 v[44:47], v9 offset:61440
v_mfma_f32_16x16x32_bf16 v[56:59], a[228:231], v[20:23], v[56:59]
v_mfma_f32_16x16x32_bf16 v[60:63], a[224:227], v[24:27], v[60:63]
ds_read_b128 v[48:51], v9 offset:63488
v_mfma_f32_16x16x32_bf16 v[64:67], a[228:231], v[24:27], v[64:67]
s_waitcnt lgkmcnt(5)
v_mfma_f32_16x16x32_bf16 v[52:55], a[232:235], v[28:31], v[52:55]
v_mfma_f32_16x16x32_bf16 v[56:59], a[236:239], v[28:31], v[56:59]
s_waitcnt lgkmcnt(4)
v_mfma_f32_16x16x32_bf16 v[60:63], a[232:235], v[32:35], v[60:63]
v_mfma_f32_16x16x32_bf16 v[64:67], a[236:239], v[32:35], v[64:67]
s_waitcnt lgkmcnt(3)
v_mfma_f32_16x16x32_bf16 v[52:55], a[240:243], v[36:39], v[52:55]
v_mfma_f32_16x16x32_bf16 v[56:59], a[244:247], v[36:39], v[56:59]
s_waitcnt lgkmcnt(2)
v_mfma_f32_16x16x32_bf16 v[60:63], a[240:243], v[40:43], v[60:63]
v_mfma_f32_16x16x32_bf16 v[64:67], a[244:247], v[40:43], v[64:67]
ds_write_b128 v101, v[84:87]
ds_write_b128 v101, v[88:91] offset:1024
s_waitcnt lgkmcnt(1)
v_mfma_f32_16x16x32_bf16 v[68:71], a[248:251], v[44:47], v[52:55]
v_mfma_f32_16x16x32_bf16 v[72:75], a[252:255], v[44:47], v[56:59]
s_waitcnt lgkmcnt(0)
v_mfma_f32_16x16x32_bf16 v[76:79], a[248:251], v[48:51], v[60:63]
v_mfma_f32_16x16x32_bf16 v[80:83], a[252:255], v[48:51], v[64:67]
mega_kernel_q_jl0:
s_cmp_eq_u32 s30, 1
s_cbranch_scc1 mega_kernel_q_kl0
mega_kernel_q_kw0:
v_mov_b32 v100, 0
s_mov_b64 exec, 1
buffer_atomic_add v100, v16, s[84:87], s62 offen sc0 sc1
s_mov_b64 exec, -1
s_waitcnt vmcnt(0)
v_readfirstlane_b32 s56, v100
s_cmp_gt_i32 s56, s42
s_cbranch_scc1 mega_kernel_q_kv0
s_cmp_eq_u32 s42, 63
s_cbranch_scc1 mega_kernel_q_kw0
s_branch mega_kernel_q_kw0
mega_kernel_q_kv0:
s_mov_b32 m0, s61
s_nop 0
buffer_load_dwordx4 v5, s[84:87], s68 offen sc1 lds
mega_kernel_q_kl0:
s_waitcnt lgkmcnt(0) vmcnt(0)
s_barrier
ds_read_b128 v[184:187], v102 offset:0
ds_read_b128 v[112:115], v103 offset:0
ds_read_b128 v[128:131], v103 offset:1024
ds_read_b128 v[188:191], v102 offset:2048
ds_read_b128 v[116:119], v103 offset:2048
ds_read_b128 v[132:135], v103 offset:3072
ds_read_b128 v[192:195], v102 offset:4096
ds_read_b128 v[120:123], v103 offset:4096
ds_read_b128 v[136:139], v103 offset:5120
ds_read_b128 v[196:199], v102 offset:6144
ds_read_b128 v[124:127], v103 offset:6144
ds_read_b128 v[140:143], v103 offset:7168
s_waitcnt lgkmcnt(9)
v_mfma_f32_16x16x32_bf16 v[200:203], v[112:115], v[184:187], 0
v_mfma_f32_16x16x32_bf16 v[204:207], v[128:131], v[184:187], 0
ds_read_b128 v[160:163], v94 offset:0
s_waitcnt lgkmcnt(7)
v_mfma_f32_16x16x32_bf16 v[200:203], v[116:119], v[188:191], v[200:203]
v_mfma_f32_16x16x32_bf16 v[204:207], v[132:135], v[188:191], v[204:207]
ds_read_b128 v[164:167], v94 offset:1024
s_waitcnt lgkmcnt(5)
v_mfma_f32_16x16x32_bf16 v[200:203], v[120:123], v[192:195], v[200:203]
v_mfma_f32_16x16x32_bf16 v[204:207], v[136:139], v[192:195], v[204:207]
ds_read_b128 v[168:171], v94 offset:2048
s_waitcnt lgkmcnt(3)
v_mfma_f32_16x16x32_bf16 v[200:203], v[124:127], v[196:199], v[200:203]
v_mfma_f32_16x16x32_bf16 v[204:207], v[140:143], v[196:199], v[204:207]
ds_read_b128 v[172:175], v94 offset:3072
s_waitcnt lgkmcnt(3)
v_mfma_f32_16x16x32_bf16 v[208:211], v[160:163], v[184:187], 0
ds_read_b128 v[144:147], v240 offset:0
ds_read_b64 v[176:177], v95 offset:0
s_waitcnt lgkmcnt(4)
v_mfma_f32_16x16x32_bf16 v[208:211], v[164:167], v[188:191], v[208:211]
ds_read_b128 v[148:151], v240 offset:1024
ds_read_b64 v[178:179], v95 offset:256
s_waitcnt lgkmcnt(5)
v_mfma_f32_16x16x32_bf16 v[208:211], v[168:171], v[192:195], v[208:211]
ds_read_b128 v[152:155], v240 offset:2048
ds_read_b64 v[180:181], v95 offset:1024
s_waitcnt lgkmcnt(6)
v_mfma_f32_16x16x32_bf16 v[208:211], v[172:175], v[196:199], v[208:211]
ds_read_b128 v[156:159], v240 offset:3072
ds_read_b64 v[182:183], v95 offset:1280
mega_kernel_q_sm0:
v_pk_mul_f32 v[200:201], v[200:201], s[54:55] op_sel_hi:[1,0]
v_pk_mul_f32 v[202:203], v[202:203], s[54:55] op_sel_hi:[1,0]
v_pk_mul_f32 v[204:205], v[204:205], s[54:55] op_sel_hi:[1,0]
v_pk_mul_f32 v[206:207], v[206:207], s[54:55] op_sel_hi:[1,0]
v_cndmask_b32 v200, v200, v241, s[12:13]
v_cndmask_b32 v201, v201, v241, s[14:15]
v_cndmask_b32 v202, v202, v241, s[16:17]
v_cndmask_b32 v203, v203, v241, s[18:19]
v_cndmask_b32 v204, v204, v241, s[20:21]
v_cndmask_b32 v205, v205, v241, s[22:23]
v_cndmask_b32 v206, v206, v241, s[24:25]
v_cndmask_b32 v207, v207, v241, s[26:27]
v_pk_mul_f32 v[208:209], v[208:209], s[54:55] op_sel_hi:[1,0]
v_pk_mul_f32 v[210:211], v[210:211], s[54:55] op_sel_hi:[1,0]
v_cndmask_b32 v208, v208, v97, s[28:29]
v_cndmask_b32 v209, v209, v97, s[28:29]
v_cndmask_b32 v210, v210, v97, s[28:29]
v_cndmask_b32 v211, v211, v97, s[28:29]
v_max3_f32 v236, v200, v201, v202
v_max3_f32 v236, v236, v203, v204
v_max3_f32 v236, v236, v205, v206
v_max3_f32 v236, v236, v207, v208
v_max3_f32 v236, v236, v209, v210
v_max_f32 v237, v236, v211
v_max_f32 v236, v236, v211
s_nop 1
v_permlane16_swap_b32 v236, v237
s_nop 0
v_max_f32 v238, v236, v237
v_max_f32 v239, v236, v237
s_nop 1
v_permlane32_swap_b32 v238, v239
s_nop 0
v_max_f32 v236, v238, v239
v_pk_add_f32 v[200:201], v[200:201], v[236:237] op_sel_hi:[1,0] neg_lo:[0,1] neg_hi:[0,1]
v_pk_add_f32 v[202:203], v[202:203], v[236:237] op_sel_hi:[1,0] neg_lo:[0,1] neg_hi:[0,1]
v_pk_add_f32 v[204:205], v[204:205], v[236:237] op_sel_hi:[1,0] neg_lo:[0,1] neg_hi:[0,1]
v_pk_add_f32 v[206:207], v[206:207], v[236:237] op_sel_hi:[1,0] neg_lo:[0,1] neg_hi:[0,1]
v_pk_add_f32 v[208:209], v[208:209], v[236:237] op_sel_hi:[1,0] neg_lo:[0,1] neg_hi:[0,1]
v_pk_add_f32 v[210:211], v[210:211], v[236:237] op_sel_hi:[1,0] neg_lo:[0,1] neg_hi:[0,1]
v_exp_f32 v200, v200
v_exp_f32 v201, v201
v_exp_f32 v202, v202
v_exp_f32 v203, v203
v_exp_f32 v204, v204
v_exp_f32 v205, v205
v_exp_f32 v206, v206
v_exp_f32 v207, v207
v_exp_f32 v208, v208
v_exp_f32 v209, v209
v_exp_f32 v210, v210
v_exp_f32 v211, v211
s_nop 0
v_cvt_pk_bf16_f32 v212, v200, v201
v_cvt_pk_bf16_f32 v213, v202, v203
v_cvt_pk_bf16_f32 v214, v204, v205
v_cvt_pk_bf16_f32 v215, v206, v207
v_cvt_pk_bf16_f32 v216, v208, v209
v_cvt_pk_bf16_f32 v217, v210, v211
s_waitcnt lgkmcnt(0)
s_nop 0
v_mfma_f32_16x16x32_bf16 v[108:111], v[104:107], v[212:215], 0
v_mfma_f32_16x16x32_bf16 v[112:115], v[144:147], v[212:215], 0
v_mfma_f32_16x16x32_bf16 v[116:119], v[148:151], v[212:215], 0
v_mfma_f32_16x16x32_bf16 v[120:123], v[152:155], v[212:215], 0
v_mfma_f32_16x16x32_bf16 v[124:127], v[156:159], v[212:215], 0
v_mfma_f32_16x16x16_bf16 v[108:111], v[104:105], v[216:217], v[108:111]
v_mfma_f32_16x16x16_bf16 v[112:115], v[176:177], v[216:217], v[112:115]
v_mfma_f32_16x16x16_bf16 v[116:119], v[178:179], v[216:217], v[116:119]
v_mfma_f32_16x16x16_bf16 v[120:123], v[180:181], v[216:217], v[120:123]
v_mfma_f32_16x16x16_bf16 v[124:127], v[182:183], v[216:217], v[124:127]
s_lshr_b32 s63, s42, 2
s_xnor_b32 s63, s63, s98
s_and_b32 s63, s63, 1
s_lshl_b32 s63, s63, 13
s_lshl_b32 s51, s42, 19
s_add_u32 s51, s51, s63
s_nop 2
v_rcp_f32 v238, v108
v_rcp_f32 v239, v109
s_nop 1
v_pk_mul_f32 v[112:113], v[112:113], v[238:239]
v_pk_mul_f32 v[114:115], v[114:115], v[238:239]
v_pk_mul_f32 v[116:117], v[116:117], v[238:239]
v_pk_mul_f32 v[118:119], v[118:119], v[238:239]
v_pk_mul_f32 v[120:121], v[120:121], v[238:239]
v_pk_mul_f32 v[122:123], v[122:123], v[238:239]
v_pk_mul_f32 v[124:125], v[124:125], v[238:239]
v_pk_mul_f32 v[126:127], v[126:127], v[238:239]
v_cvt_pk_bf16_f32 v200, v112, v113
v_cvt_pk_bf16_f32 v201, v114, v115
v_cvt_pk_bf16_f32 v202, v116, v117
v_cvt_pk_bf16_f32 v203, v118, v119
v_cvt_pk_bf16_f32 v204, v120, v121
v_cvt_pk_bf16_f32 v205, v122, v123
v_cvt_pk_bf16_f32 v206, v124, v125
v_cvt_pk_bf16_f32 v207, v126, v127
buffer_store_dwordx4 v[200:203], v96, s[84:87], s51 offen sc1
buffer_store_dwordx4 v[204:207], v96, s[84:87], s51 offen offset:2048 sc1
s_add_u32 s42, s42, 1
s_cmp_lt_u32 s42, 64
s_cbranch_scc1 mega_kernel_q_loop
s_waitcnt vmcnt(0)
v_mov_b32 v17, s42
s_mov_b64 exec, 1
buffer_store_dword v17, v16, s[84:87], s49 offen sc1
s_mov_b64 exec, -1
mega_kernel_q_quit:
s_endpgm
mega_kernel_rd:
s_mov_b32 s93, s40
s_load_dwordx2 s[4:5], s[0:1], 56
s_mov_b32 s48, 0x3f7ec46d
s_mov_b32 s49, 0x3dc8bd36
s_mov_b32 s50, 0x3f7b14be
s_mov_b32 s51, 0x3e47c5c2
s_mov_b32 s52, 0x3f74fa0b
s_mov_b32 s53, 0x3e94a031
s_mov_b32 s54, 0x3f6c835e
s_mov_b32 s55, 0x3ec3ef15
s_mov_b32 s56, 0x3f61c598
s_mov_b32 s57, 0x3ef15aea
s_mov_b32 s58, 0x3f54db31
s_mov_b32 s59, 0x3f0e39da
s_mov_b32 s60, 0x3f45e403
s_mov_b32 s61, 0x3f226799
s_mov_b32 s62, 0x3f3504f3
s_mov_b32 s63, 0x3f3504f3
v_and_b32 v1, 31, v0
v_lshrrev_b32 v2, 5, v0
v_cvt_f32_u32 v3, v1
v_mul_u32_u24 v10, 8448, v2
v_lshl_add_u32 v4, v1, 3, v10
v_mul_u32_u24 v5, 264, v1
v_add_u32 v5, v5, v10
v_and_b32 v11, 7, v0
v_lshrrev_b32 v9, 3, v0
v_mul_u32_u24 v10, 8448, v11
v_lshl_add_u32 v6, v9, 3, v10
v_lshlrev_b32 v7, 3, v9
v_sub_u32 v7, v10, v7
v_add_u32 v7, 4096, v7
v_mul_u32_u24 v8, 32768, v9
v_lshl_add_u32 v8, v11, 4, v8
v_mul_f32 v12, 0xba800000, v3
v_cos_f32 v82, v12
v_sin_f32 v83, v12
v_mul_f32 v12, 0xbb000000, v3
v_cos_f32 v84, v12
v_sin_f32 v85, v12
v_mul_f32 v12, 0xbb400000, v3
v_cos_f32 v86, v12
v_sin_f32 v87, v12
v_mul_f32 v12, 0xbb800000, v3
v_cos_f32 v88, v12
v_sin_f32 v89, v12
v_mul_f32 v12, 0xbba00000, v3
v_cos_f32 v90, v12
v_sin_f32 v91, v12
v_mul_f32 v12, 0xbbc00000, v3
v_cos_f32 v92, v12
v_sin_f32 v93, v12
v_mul_f32 v12, 0xbbe00000, v3
v_cos_f32 v94, v12
v_sin_f32 v95, v12
v_mul_f32 v12, 0xbc000000, v3
v_cos_f32 v96, v12
v_sin_f32 v97, v12
v_mul_f32 v12, 0xbc100000, v3
v_cos_f32 v98, v12
v_sin_f32 v99, v12
v_mul_f32 v12, 0xbc200000, v3
v_cos_f32 v100, v12
v_sin_f32 v101, v12
v_mul_f32 v12, 0xbc300000, v3
v_cos_f32 v102, v12
v_sin_f32 v103, v12
v_mul_f32 v12, 0xbc400000, v3
v_cos_f32 v104, v12
v_sin_f32 v105, v12
v_mul_f32 v12, 0xbc500000, v3
v_cos_f32 v106, v12
v_sin_f32 v107, v12
v_mul_f32 v12, 0xbc600000, v3
v_cos_f32 v108, v12
v_sin_f32 v109, v12
v_mul_f32 v12, 0xbc700000, v3
v_cos_f32 v110, v12
v_sin_f32 v111, v12
v_mul_f32 v12, 0xbc800000, v3
v_cos_f32 v112, v12
v_sin_f32 v113, v12
v_mul_f32 v12, 0xbc880000, v3
v_cos_f32 v114, v12
v_sin_f32 v115, v12
v_mul_f32 v12, 0xbc900000, v3
v_cos_f32 v116, v12
v_sin_f32 v117, v12
v_mul_f32 v12, 0xbc980000, v3
v_cos_f32 v118, v12
v_sin_f32 v119, v12
v_mul_f32 v12, 0xbca00000, v3
v_cos_f32 v120, v12
v_sin_f32 v121, v12
v_mul_f32 v12, 0xbca80000, v3
v_cos_f32 v122, v12
v_sin_f32 v123, v12
v_mul_f32 v12, 0xbcb00000, v3
v_cos_f32 v124, v12
v_sin_f32 v125, v12
v_mul_f32 v12, 0xbcb80000, v3
v_cos_f32 v126, v12
v_sin_f32 v127, v12
v_mul_f32 v12, 0xbcc00000, v3
v_cos_f32 v128, v12
v_sin_f32 v129, v12
v_mul_f32 v12, 0xbcc80000, v3
v_cos_f32 v130, v12
v_sin_f32 v131, v12
v_mul_f32 v12, 0xbcd00000, v3
v_cos_f32 v132, v12
v_sin_f32 v133, v12
v_mul_f32 v12, 0xbcd80000, v3
v_cos_f32 v134, v12
v_sin_f32 v135, v12
v_mul_f32 v12, 0xbce00000, v3
v_cos_f32 v136, v12
v_sin_f32 v137, v12
v_mul_f32 v12, 0xbce80000, v3
v_cos_f32 v138, v12
v_sin_f32 v139, v12
v_mul_f32 v12, 0xbcf00000, v3
v_cos_f32 v140, v12
v_sin_f32 v141, v12
v_mul_f32 v12, 0xbcf80000, v3
v_cos_f32 v142, v12
v_sin_f32 v143, v12
v_lshlrev_b32 v12, 12, v2
v_lshl_add_u32 v12, v1, 1, v12
s_waitcnt lgkmcnt(0)
s_mov_b32 s6, 4194304
s_mov_b32 s7, 0x00020000
v_mov_b32 v144, 0
v_mov_b32 v145, 0
v_mov_b32 v146, 0
v_mov_b32 v147, 0
v_mov_b32 v148, 0
v_mov_b32 v149, 0
v_mov_b32 v150, 0
v_mov_b32 v151, 0
v_mov_b32 v152, 0
v_mov_b32 v153, 0
v_mov_b32 v154, 0
v_mov_b32 v155, 0
v_mov_b32 v156, 0
v_mov_b32 v157, 0
v_mov_b32 v158, 0
v_mov_b32 v159, 0
v_mov_b32 v160, 0
v_mov_b32 v161, 0
v_mov_b32 v162, 0
v_mov_b32 v163, 0
v_mov_b32 v164, 0
v_mov_b32 v165, 0
v_mov_b32 v166, 0
v_mov_b32 v167, 0
v_mov_b32 v168, 0
v_mov_b32 v169, 0
v_mov_b32 v170, 0
v_mov_b32 v171, 0
v_mov_b32 v172, 0
v_mov_b32 v173, 0
v_mov_b32 v174, 0
v_mov_b32 v175, 0
v_mov_b32 v176, 0
v_mov_b32 v177, 0
v_mov_b32 v178, 0
v_mov_b32 v179, 0
v_mov_b32 v180, 0
v_mov_b32 v181, 0
v_mov_b32 v182, 0
v_mov_b32 v183, 0
v_mov_b32 v184, 0
v_mov_b32 v185, 0
v_mov_b32 v186, 0
v_mov_b32 v187, 0
v_mov_b32 v188, 0
v_mov_b32 v189, 0
v_mov_b32 v190, 0
v_mov_b32 v191, 0
v_mov_b32 v192, 0
v_mov_b32 v193, 0
v_mov_b32 v194, 0
v_mov_b32 v195, 0
v_mov_b32 v196, 0
v_mov_b32 v197, 0
v_mov_b32 v198, 0
v_mov_b32 v199, 0
v_mov_b32 v200, 0
v_mov_b32 v201, 0
v_mov_b32 v202, 0
v_mov_b32 v203, 0
v_mov_b32 v204, 0
v_mov_b32 v205, 0
v_mov_b32 v206, 0
v_mov_b32 v207, 0
s_cmp_lt_u32 s93, 128
s_cbranch_scc0 mega_kernel_f1_e
s_lshl_b32 s12, s93, 15
buffer_load_short_d16_hi v144, v12, s[4:7], s12 offen offset:0
buffer_load_short_d16_hi v145, v12, s[4:7], s12 offen offset:2048
buffer_load_short_d16_hi v176, v12, s[4:7], s12 offen offset:1024
buffer_load_short_d16_hi v177, v12, s[4:7], s12 offen offset:3072
buffer_load_short_d16_hi v146, v12, s[4:7], s12 offen offset:64
buffer_load_short_d16_hi v147, v12, s[4:7], s12 offen offset:2112
buffer_load_short_d16_hi v178, v12, s[4:7], s12 offen offset:1088
buffer_load_short_d16_hi v179, v12, s[4:7], s12 offen offset:3136
buffer_load_short_d16_hi v148, v12, s[4:7], s12 offen offset:128
buffer_load_short_d16_hi v149, v12, s[4:7], s12 offen offset:2176
buffer_load_short_d16_hi v180, v12, s[4:7], s12 offen offset:1152
buffer_load_short_d16_hi v181, v12, s[4:7], s12 offen offset:3200
buffer_load_short_d16_hi v150, v12, s[4:7], s12 offen offset:192
buffer_load_short_d16_hi v151, v12, s[4:7], s12 offen offset:2240
buffer_load_short_d16_hi v182, v12, s[4:7], s12 offen offset:1216
buffer_load_short_d16_hi v183, v12, s[4:7], s12 offen offset:3264
buffer_load_short_d16_hi v152, v12, s[4:7], s12 offen offset:256
buffer_load_short_d16_hi v153, v12, s[4:7], s12 offen offset:2304
buffer_load_short_d16_hi v184, v12, s[4:7], s12 offen offset:1280
buffer_load_short_d16_hi v185, v12, s[4:7], s12 offen offset:3328
buffer_load_short_d16_hi v154, v12, s[4:7], s12 offen offset:320
buffer_load_short_d16_hi v155, v12, s[4:7], s12 offen offset:2368
buffer_load_short_d16_hi v186, v12, s[4:7], s12 offen offset:1344
buffer_load_short_d16_hi v187, v12, s[4:7], s12 offen offset:3392
buffer_load_short_d16_hi v156, v12, s[4:7], s12 offen offset:384
buffer_load_short_d16_hi v157, v12, s[4:7], s12 offen offset:2432
buffer_load_short_d16_hi v188, v12, s[4:7], s12 offen offset:1408
buffer_load_short_d16_hi v189, v12, s[4:7], s12 offen offset:3456
buffer_load_short_d16_hi v158, v12, s[4:7], s12 offen offset:448
buffer_load_short_d16_hi v159, v12, s[4:7], s12 offen offset:2496
buffer_load_short_d16_hi v190, v12, s[4:7], s12 offen offset:1472
buffer_load_short_d16_hi v191, v12, s[4:7], s12 offen offset:3520
buffer_load_short_d16_hi v160, v12, s[4:7], s12 offen offset:512
buffer_load_short_d16_hi v161, v12, s[4:7], s12 offen offset:2560
buffer_load_short_d16_hi v192, v12, s[4:7], s12 offen offset:1536
buffer_load_short_d16_hi v193, v12, s[4:7], s12 offen offset:3584
buffer_load_short_d16_hi v162, v12, s[4:7], s12 offen offset:576
buffer_load_short_d16_hi v163, v12, s[4:7], s12 offen offset:2624
buffer_load_short_d16_hi v194, v12, s[4:7], s12 offen offset:1600
buffer_load_short_d16_hi v195, v12, s[4:7], s12 offen offset:3648
buffer_load_short_d16_hi v164, v12, s[4:7], s12 offen offset:640
buffer_load_short_d16_hi v165, v12, s[4:7], s12 offen offset:2688
buffer_load_short_d16_hi v196, v12, s[4:7], s12 offen offset:1664
buffer_load_short_d16_hi v197, v12, s[4:7], s12 offen offset:3712
buffer_load_short_d16_hi v166, v12, s[4:7], s12 offen offset:704
buffer_load_short_d16_hi v167, v12, s[4:7], s12 offen offset:2752
buffer_load_short_d16_hi v198, v12, s[4:7], s12 offen offset:1728
buffer_load_short_d16_hi v199, v12, s[4:7], s12 offen offset:3776
buffer_load_short_d16_hi v168, v12, s[4:7], s12 offen offset:768
buffer_load_short_d16_hi v169, v12, s[4:7], s12 offen offset:2816
buffer_load_short_d16_hi v200, v12, s[4:7], s12 offen offset:1792
buffer_load_short_d16_hi v201, v12, s[4:7], s12 offen offset:3840
buffer_load_short_d16_hi v170, v12, s[4:7], s12 offen offset:832
buffer_load_short_d16_hi v171, v12, s[4:7], s12 offen offset:2880
buffer_load_short_d16_hi v202, v12, s[4:7], s12 offen offset:1856
buffer_load_short_d16_hi v203, v12, s[4:7], s12 offen offset:3904
buffer_load_short_d16_hi v172, v12, s[4:7], s12 offen offset:896
buffer_load_short_d16_hi v173, v12, s[4:7], s12 offen offset:2944
buffer_load_short_d16_hi v204, v12, s[4:7], s12 offen offset:1920
buffer_load_short_d16_hi v205, v12, s[4:7], s12 offen offset:3968
buffer_load_short_d16_hi v174, v12, s[4:7], s12 offen offset:960
buffer_load_short_d16_hi v175, v12, s[4:7], s12 offen offset:3008
buffer_load_short_d16_hi v206, v12, s[4:7], s12 offen offset:1984
buffer_load_short_d16_hi v207, v12, s[4:7], s12 offen offset:4032
s_waitcnt vmcnt(0)
mega_kernel_f1_l:
s_add_u32 s21, s93, 32
s_cmp_lt_u32 s21, 128
s_cselect_b32 s22, s21, s93
s_waitcnt vmcnt(17)
v_pk_add_f32 v[48:49], v[144:145], v[176:177] neg_lo:[0,1] neg_hi:[0,1]
v_pk_add_f32 v[16:17], v[144:145], v[176:177]
v_pk_add_f32 v[14:15], v[146:147], v[178:179] neg_lo:[0,1] neg_hi:[0,1]
v_pk_add_f32 v[18:19], v[146:147], v[178:179]
v_pk_mul_f32 v[50:51], v[14:15], s[50:51] op_sel:[0,0] op_sel_hi:[0,1] neg_lo:[0,0] neg_hi:[0,1]
v_pk_fma_f32 v[50:51], v[14:15], s[50:51], v[50:51] op_sel:[1,1,0] op_sel_hi:[1,0,1] neg_lo:[0,0,0] neg_hi:[0,0,0]
v_pk_add_f32 v[14:15], v[148:149], v[180:181] neg_lo:[0,1] neg_hi:[0,1]
v_pk_add_f32 v[20:21], v[148:149], v[180:181]
v_pk_mul_f32 v[52:53], v[14:15], s[54:55] op_sel:[0,0] op_sel_hi:[0,1] neg_lo:[0,0] neg_hi:[0,1]
v_pk_fma_f32 v[52:53], v[14:15], s[54:55], v[52:53] op_sel:[1,1,0] op_sel_hi:[1,0,1] neg_lo:[0,0,0] neg_hi:[0,0,0]
v_pk_add_f32 v[14:15], v[150:151], v[182:183] neg_lo:[0,1] neg_hi:[0,1]
v_pk_add_f32 v[22:23], v[150:151], v[182:183]
v_pk_mul_f32 v[54:55], v[14:15], s[58:59] op_sel:[0,0] op_sel_hi:[0,1] neg_lo:[0,0] neg_hi:[0,1]
v_pk_fma_f32 v[54:55], v[14:15], s[58:59], v[54:55] op_sel:[1,1,0] op_sel_hi:[1,0,1] neg_lo:[0,0,0] neg_hi:[0,0,0]
v_pk_add_f32 v[14:15], v[152:153], v[184:185] neg_lo:[0,1] neg_hi:[0,1]
v_pk_add_f32 v[24:25], v[152:153], v[184:185]
v_pk_mul_f32 v[56:57], v[14:15], s[62:63] op_sel:[0,0] op_sel_hi:[0,1] neg_lo:[0,0] neg_hi:[0,1]
v_pk_fma_f32 v[56:57], v[14:15], s[62:63], v[56:57] op_sel:[1,1,0] op_sel_hi:[1,0,1] neg_lo:[0,0,0] neg_hi:[0,0,0]
v_pk_add_f32 v[14:15], v[154:155], v[186:187] neg_lo:[0,1] neg_hi:[0,1]
v_pk_add_f32 v[26:27], v[154:155], v[186:187]
v_pk_mul_f32 v[58:59], v[14:15], s[58:59] op_sel:[0,1] op_sel_hi:[0,0] neg_lo:[0,0] neg_hi:[0,1]
v_pk_fma_f32 v[58:59], v[14:15], s[58:59], v[58:59] op_sel:[1,0,0] op_sel_hi:[1,1,1] neg_lo:[0,0,0] neg_hi:[0,0,0]
v_pk_add_f32 v[14:15], v[156:157], v[188:189] neg_lo:[0,1] neg_hi:[0,1]
v_pk_add_f32 v[28:29], v[156:157], v[188:189]
v_pk_mul_f32 v[60:61], v[14:15], s[54:55] op_sel:[0,1] op_sel_hi:[0,0] neg_lo:[0,0] neg_hi:[0,1]
v_pk_fma_f32 v[60:61], v[14:15], s[54:55], v[60:61] op_sel:[1,0,0] op_sel_hi:[1,1,1] neg_lo:[0,0,0] neg_hi:[0,0,0]
v_pk_add_f32 v[14:15], v[158:159], v[190:191] neg_lo:[0,1] neg_hi:[0,1]
v_pk_add_f32 v[30:31], v[158:159], v[190:191]
v_pk_mul_f32 v[62:63], v[14:15], s[50:51] op_sel:[0,1] op_sel_hi:[0,0] neg_lo:[0,0] neg_hi:[0,1]
v_pk_fma_f32 v[62:63], v[14:15], s[50:51], v[62:63] op_sel:[1,0,0] op_sel_hi:[1,1,1] neg_lo:[0,0,0] neg_hi:[0,0,0]
v_pk_add_f32 v[64:65], v[160:161], v[192:193] op_sel:[1,1] op_sel_hi:[0,0] neg_lo:[0,1] neg_hi:[1,0]
v_pk_add_f32 v[32:33], v[160:161], v[192:193]
v_pk_add_f32 v[14:15], v[162:163], v[194:195] neg_lo:[0,1] neg_hi:[0,1]
v_pk_add_f32 v[34:35], v[162:163], v[194:195]
v_pk_mul_f32 v[66:67], v[14:15], s[50:51] op_sel:[0,1] op_sel_hi:[0,0] neg_lo:[0,1] neg_hi:[0,1]
v_pk_fma_f32 v[66:67], v[14:15], s[50:51], v[66:67] op_sel:[1,0,0] op_sel_hi:[1,1,1] neg_lo:[0,0,0] neg_hi:[0,1,0]
v_pk_add_f32 v[14:15], v[164:165], v[196:197] neg_lo:[0,1] neg_hi:[0,1]
v_pk_add_f32 v[36:37], v[164:165], v[196:197]
v_pk_mul_f32 v[68:69], v[14:15], s[54:55] op_sel:[0,1] op_sel_hi:[0,0] neg_lo:[0,1] neg_hi:[0,1]
v_pk_fma_f32 v[68:69], v[14:15], s[54:55], v[68:69] op_sel:[1,0,0] op_sel_hi:[1,1,1] neg_lo:[0,0,0] neg_hi:[0,1,0]
v_pk_add_f32 v[14:15], v[166:167], v[198:199] neg_lo:[0,1] neg_hi:[0,1]
v_pk_add_f32 v[38:39], v[166:167], v[198:199]
v_pk_mul_f32 v[70:71], v[14:15], s[58:59] op_sel:[0,1] op_sel_hi:[0,0] neg_lo:[0,1] neg_hi:[0,1]
v_pk_fma_f32 v[70:71], v[14:15], s[58:59], v[70:71] op_sel:[1,0,0] op_sel_hi:[1,1,1] neg_lo:[0,0,0] neg_hi:[0,1,0]
v_pk_add_f32 v[14:15], v[168:169], v[200:201] neg_lo:[0,1] neg_hi:[0,1]
v_pk_add_f32 v[40:41], v[168:169], v[200:201]
v_pk_mul_f32 v[72:73], v[14:15], s[62:63] op_sel:[0,0] op_sel_hi:[0,1] neg_lo:[0,1] neg_hi:[0,1]
v_pk_fma_f32 v[72:73], v[14:15], s[62:63], v[72:73] op_sel:[1,1,0] op_sel_hi:[1,0,1] neg_lo:[0,0,0] neg_hi:[0,1,0]
v_pk_add_f32 v[14:15], v[170:171], v[202:203] neg_lo:[0,1] neg_hi:[0,1]
v_pk_add_f32 v[42:43], v[170:171], v[202:203]
v_pk_mul_f32 v[74:75], v[14:15], s[58:59] op_sel:[0,0] op_sel_hi:[0,1] neg_lo:[0,1] neg_hi:[0,1]
v_pk_fma_f32 v[74:75], v[14:15], s[58:59], v[74:75] op_sel:[1,1,0] op_sel_hi:[1,0,1] neg_lo:[0,0,0] neg_hi:[0,1,0]
v_pk_add_f32 v[14:15], v[172:173], v[204:205] neg_lo:[0,1] neg_hi:[0,1]
v_pk_add_f32 v[44:45], v[172:173], v[204:205]
v_pk_mul_f32 v[76:77], v[14:15], s[54:55] op_sel:[0,0] op_sel_hi:[0,1] neg_lo:[0,1] neg_hi:[0,1]
v_pk_fma_f32 v[76:77], v[14:15], s[54:55], v[76:77] op_sel:[1,1,0] op_sel_hi:[1,0,1] neg_lo:[0,0,0] neg_hi:[0,1,0]
v_pk_add_f32 v[14:15], v[174:175], v[206:207] neg_lo:[0,1] neg_hi:[0,1]
v_pk_add_f32 v[46:47], v[174:175], v[206:207]
v_pk_mul_f32 v[78:79], v[14:15], s[50:51] op_sel:[0,0] op_sel_hi:[0,1] neg_lo:[0,1] neg_hi:[0,1]
v_pk_fma_f32 v[78:79], v[14:15], s[50:51], v[78:79] op_sel:[1,1,0] op_sel_hi:[1,0,1] neg_lo:[0,0,0] neg_hi:[0,1,0]
s_lshl_b32 s12, s22, 15
buffer_load_short_d16_hi v144, v12, s[4:7], s12 offen offset:0
buffer_load_short_d16_hi v145, v12, s[4:7], s12 offen offset:2048
buffer_load_short_d16_hi v176, v12, s[4:7], s12 offen offset:1024
buffer_load_short_d16_hi v177, v12, s[4:7], s12 offen offset:3072
buffer_load_short_d16_hi v146, v12, s[4:7], s12 offen offset:64
buffer_load_short_d16_hi v147, v12, s[4:7], s12 offen offset:2112
buffer_load_short_d16_hi v178, v12, s[4:7], s12 offen offset:1088
buffer_load_short_d16_hi v179, v12, s[4:7], s12 offen offset:3136
buffer_load_short_d16_hi v148, v12, s[4:7], s12 offen offset:128
buffer_load_short_d16_hi v149, v12, s[4:7], s12 offen offset:2176
buffer_load_short_d16_hi v180, v12, s[4:7], s12 offen offset:1152
buffer_load_short_d16_hi v181, v12, s[4:7], s12 offen offset:3200
buffer_load_short_d16_hi v150, v12, s[4:7], s12 offen offset:192
buffer_load_short_d16_hi v151, v12, s[4:7], s12 offen offset:2240
buffer_load_short_d16_hi v182, v12, s[4:7], s12 offen offset:1216
buffer_load_short_d16_hi v183, v12, s[4:7], s12 offen offset:3264
buffer_load_short_d16_hi v152, v12, s[4:7], s12 offen offset:256
buffer_load_short_d16_hi v153, v12, s[4:7], s12 offen offset:2304
buffer_load_short_d16_hi v184, v12, s[4:7], s12 offen offset:1280
buffer_load_short_d16_hi v185, v12, s[4:7], s12 offen offset:3328
buffer_load_short_d16_hi v154, v12, s[4:7], s12 offen offset:320
buffer_load_short_d16_hi v155, v12, s[4:7], s12 offen offset:2368
buffer_load_short_d16_hi v186, v12, s[4:7], s12 offen offset:1344
buffer_load_short_d16_hi v187, v12, s[4:7], s12 offen offset:3392
buffer_load_short_d16_hi v156, v12, s[4:7], s12 offen offset:384
buffer_load_short_d16_hi v157, v12, s[4:7], s12 offen offset:2432
buffer_load_short_d16_hi v188, v12, s[4:7], s12 offen offset:1408
buffer_load_short_d16_hi v189, v12, s[4:7], s12 offen offset:3456
buffer_load_short_d16_hi v158, v12, s[4:7], s12 offen offset:448
buffer_load_short_d16_hi v159, v12, s[4:7], s12 offen offset:2496
buffer_load_short_d16_hi v190, v12, s[4:7], s12 offen offset:1472
buffer_load_short_d16_hi v191, v12, s[4:7], s12 offen offset:3520
buffer_load_short_d16_hi v160, v12, s[4:7], s12 offen offset:512
buffer_load_short_d16_hi v161, v12, s[4:7], s12 offen offset:2560
buffer_load_short_d16_hi v192, v12, s[4:7], s12 offen offset:1536
buffer_load_short_d16_hi v193, v12, s[4:7], s12 offen offset:3584
buffer_load_short_d16_hi v162, v12, s[4:7], s12 offen offset:576
buffer_load_short_d16_hi v163, v12, s[4:7], s12 offen offset:2624
buffer_load_short_d16_hi v194, v12, s[4:7], s12 offen offset:1600
buffer_load_short_d16_hi v195, v12, s[4:7], s12 offen offset:3648
buffer_load_short_d16_hi v164, v12, s[4:7], s12 offen offset:640
buffer_load_short_d16_hi v165, v12, s[4:7], s12 offen offset:2688
buffer_load_short_d16_hi v196, v12, s[4:7], s12 offen offset:1664
buffer_load_short_d16_hi v197, v12, s[4:7], s12 offen offset:3712
buffer_load_short_d16_hi v166, v12, s[4:7], s12 offen offset:704
buffer_load_short_d16_hi v167, v12, s[4:7], s12 offen offset:2752
buffer_load_short_d16_hi v198, v12, s[4:7], s12 offen offset:1728
buffer_load_short_d16_hi v199, v12, s[4:7], s12 offen offset:3776
buffer_load_short_d16_hi v168, v12, s[4:7], s12 offen offset:768
buffer_load_short_d16_hi v169, v12, s[4:7], s12 offen offset:2816
buffer_load_short_d16_hi v200, v12, s[4:7], s12 offen offset:1792
buffer_load_short_d16_hi v201, v12, s[4:7], s12 offen offset:3840
buffer_load_short_d16_hi v170, v12, s[4:7], s12 offen offset:832
buffer_load_short_d16_hi v171, v12, s[4:7], s12 offen offset:2880
buffer_load_short_d16_hi v202, v12, s[4:7], s12 offen offset:1856
buffer_load_short_d16_hi v203, v12, s[4:7], s12 offen offset:3904
buffer_load_short_d16_hi v172, v12, s[4:7], s12 offen offset:896
buffer_load_short_d16_hi v173, v12, s[4:7], s12 offen offset:2944
buffer_load_short_d16_hi v204, v12, s[4:7], s12 offen offset:1920
buffer_load_short_d16_hi v205, v12, s[4:7], s12 offen offset:3968
buffer_load_short_d16_hi v174, v12, s[4:7], s12 offen offset:960
buffer_load_short_d16_hi v175, v12, s[4:7], s12 offen offset:3008
buffer_load_short_d16_hi v206, v12, s[4:7], s12 offen offset:1984
buffer_load_short_d16_hi v207, v12, s[4:7], s12 offen offset:4032
v_pk_add_f32 v[14:15], v[16:17], v[32:33] neg_lo:[0,1] neg_hi:[0,1]
v_pk_add_f32 v[16:17], v[16:17], v[32:33]
v_pk_add_f32 v[32:33], v[18:19], v[34:35] neg_lo:[0,1] neg_hi:[0,1]
v_pk_add_f32 v[18:19], v[18:19], v[34:35]
v_pk_mul_f32 v[34:35], v[32:33], s[54:55] op_sel:[0,0] op_sel_hi:[0,1] neg_lo:[0,0] neg_hi:[0,1]
v_pk_fma_f32 v[34:35], v[32:33], s[54:55], v[34:35] op_sel:[1,1,0] op_sel_hi:[1,0,1] neg_lo:[0,0,0] neg_hi:[0,0,0]
v_pk_add_f32 v[32:33], v[20:21], v[36:37] neg_lo:[0,1] neg_hi:[0,1]
v_pk_add_f32 v[20:21], v[20:21], v[36:37]
v_pk_mul_f32 v[36:37], v[32:33], s[62:63] op_sel:[0,0] op_sel_hi:[0,1] neg_lo:[0,0] neg_hi:[0,1]
v_pk_fma_f32 v[36:37], v[32:33], s[62:63], v[36:37] op_sel:[1,1,0] op_sel_hi:[1,0,1] neg_lo:[0,0,0] neg_hi:[0,0,0]
v_pk_add_f32 v[32:33], v[22:23], v[38:39] neg_lo:[0,1] neg_hi:[0,1]
v_pk_add_f32 v[22:23], v[22:23], v[38:39]
v_pk_mul_f32 v[38:39], v[32:33], s[54:55] op_sel:[0,1] op_sel_hi:[0,0] neg_lo:[0,0] neg_hi:[0,1]
v_pk_fma_f32 v[38:39], v[32:33], s[54:55], v[38:39] op_sel:[1,0,0] op_sel_hi:[1,1,1] neg_lo:[0,0,0] neg_hi:[0,0,0]
v_pk_add_f32 v[32:33], v[24:25], v[40:41] op_sel:[1,1] op_sel_hi:[0,0] neg_lo:[0,1] neg_hi:[1,0]
v_pk_add_f32 v[24:25], v[24:25], v[40:41]
v_pk_add_f32 v[40:41], v[26:27], v[42:43] neg_lo:[0,1] neg_hi:[0,1]
v_pk_add_f32 v[26:27], v[26:27], v[42:43]
v_pk_mul_f32 v[42:43], v[40:41], s[54:55] op_sel:[0,1] op_sel_hi:[0,0] neg_lo:[0,1] neg_hi:[0,1]
v_pk_fma_f32 v[42:43], v[40:41], s[54:55], v[42:43] op_sel:[1,0,0] op_sel_hi:[1,1,1] neg_lo:[0,0,0] neg_hi:[0,1,0]
v_pk_add_f32 v[40:41], v[28:29], v[44:45] neg_lo:[0,1] neg_hi:[0,1]
v_pk_add_f32 v[28:29], v[28:29], v[44:45]
v_pk_mul_f32 v[44:45], v[40:41], s[62:63] op_sel:[0,0] op_sel_hi:[0,1] neg_lo:[0,1] neg_hi:[0,1]
v_pk_fma_f32 v[44:45], v[40:41], s[62:63], v[44:45] op_sel:[1,1,0] op_sel_hi:[1,0,1] neg_lo:[0,0,0] neg_hi:[0,1,0]
v_pk_add_f32 v[40:41], v[30:31], v[46:47] neg_lo:[0,1] neg_hi:[0,1]
v_pk_add_f32 v[30:31], v[30:31], v[46:47]
v_pk_mul_f32 v[46:47], v[40:41], s[54:55] op_sel:[0,0] op_sel_hi:[0,1] neg_lo:[0,1] neg_hi:[0,1]
v_pk_fma_f32 v[46:47], v[40:41], s[54:55], v[46:47] op_sel:[1,1,0] op_sel_hi:[1,0,1] neg_lo:[0,0,0] neg_hi:[0,1,0]
v_pk_add_f32 v[40:41], v[48:49], v[64:65] neg_lo:[0,1] neg_hi:[0,1]
v_pk_add_f32 v[48:49], v[48:49], v[64:65]
v_pk_add_f32 v[64:65], v[50:51], v[66:67] neg_lo:[0,1] neg_hi:[0,1]
v_pk_add_f32 v[50:51], v[50:51], v[66:67]
v_pk_mul_f32 v[66:67], v[64:65], s[54:55] op_sel:[0,0] op_sel_hi:[0,1] neg_lo:[0,0] neg_hi:[0,1]
v_pk_fma_f32 v[66:67], v[64:65], s[54:55], v[66:67] op_sel:[1,1,0] op_sel_hi:[1,0,1] neg_lo:[0,0,0] neg_hi:[0,0,0]
v_pk_add_f32 v[64:65], v[52:53], v[68:69] neg_lo:[0,1] neg_hi:[0,1]
v_pk_add_f32 v[52:53], v[52:53], v[68:69]
v_pk_mul_f32 v[68:69], v[64:65], s[62:63] op_sel:[0,0] op_sel_hi:[0,1] neg_lo:[0,0] neg_hi:[0,1]
v_pk_fma_f32 v[68:69], v[64:65], s[62:63], v[68:69] op_sel:[1,1,0] op_sel_hi:[1,0,1] neg_lo:[0,0,0] neg_hi:[0,0,0]
v_pk_add_f32 v[64:65], v[54:55], v[70:71] neg_lo:[0,1] neg_hi:[0,1]
v_pk_add_f32 v[54:55], v[54:55], v[70:71]
v_pk_mul_f32 v[70:71], v[64:65], s[54:55] op_sel:[0,1] op_sel_hi:[0,0] neg_lo:[0,0] neg_hi:[0,1]
v_pk_fma_f32 v[70:71], v[64:65], s[54:55], v[70:71] op_sel:[1,0,0] op_sel_hi:[1,1,1] neg_lo:[0,0,0] neg_hi:[0,0,0]
v_pk_add_f32 v[64:65], v[56:57], v[72:73] op_sel:[1,1] op_sel_hi:[0,0] neg_lo:[0,1] neg_hi:[1,0]
v_pk_add_f32 v[56:57], v[56:57], v[72:73]
v_pk_add_f32 v[72:73], v[58:59], v[74:75] neg_lo:[0,1] neg_hi:[0,1]
v_pk_add_f32 v[58:59], v[58:59], v[74:75]
v_pk_mul_f32 v[74:75], v[72:73], s[54:55] op_sel:[0,1] op_sel_hi:[0,0] neg_lo:[0,1] neg_hi:[0,1]
v_pk_fma_f32 v[74:75], v[72:73], s[54:55], v[74:75] op_sel:[1,0,0] op_sel_hi:[1,1,1] neg_lo:[0,0,0] neg_hi:[0,1,0]
v_pk_add_f32 v[72:73], v[60:61], v[76:77] neg_lo:[0,1] neg_hi:[0,1]
v_pk_add_f32 v[60:61], v[60:61], v[76:77]
v_pk_mul_f32 v[76:77], v[72:73], s[62:63] op_sel:[0,0] op_sel_hi:[0,1] neg_lo:[0,1] neg_hi:[0,1]
v_pk_fma_f32 v[76:77], v[72:73], s[62:63], v[76:77] op_sel:[1,1,0] op_sel_hi:[1,0,1] neg_lo:[0,0,0] neg_hi:[0,1,0]
v_pk_add_f32 v[72:73], v[62:63], v[78:79] neg_lo:[0,1] neg_hi:[0,1]
v_pk_add_f32 v[62:63], v[62:63], v[78:79]
v_pk_mul_f32 v[78:79], v[72:73], s[54:55] op_sel:[0,0] op_sel_hi:[0,1] neg_lo:[0,1] neg_hi:[0,1]
v_pk_fma_f32 v[78:79], v[72:73], s[54:55], v[78:79] op_sel:[1,1,0] op_sel_hi:[1,0,1] neg_lo:[0,0,0] neg_hi:[0,1,0]
v_pk_add_f32 v[72:73], v[16:17], v[24:25] neg_lo:[0,1] neg_hi:[0,1]
v_pk_add_f32 v[16:17], v[16:17], v[24:25]
v_pk_add_f32 v[24:25], v[18:19], v[26:27] neg_lo:[0,1] neg_hi:[0,1]
v_pk_add_f32 v[18:19], v[18:19], v[26:27]
v_pk_mul_f32 v[26:27], v[24:25], s[62:63] op_sel:[0,0] op_sel_hi:[0,1] neg_lo:[0,0] neg_hi:[0,1]
v_pk_fma_f32 v[26:27], v[24:25], s[62:63], v[26:27] op_sel:[1,1,0] op_sel_hi:[1,0,1] neg_lo:[0,0,0] neg_hi:[0,0,0]
v_pk_add_f32 v[24:25], v[20:21], v[28:29] op_sel:[1,1] op_sel_hi:[0,0] neg_lo:[0,1] neg_hi:[1,0]
v_pk_add_f32 v[20:21], v[20:21], v[28:29]
v_pk_add_f32 v[28:29], v[22:23], v[30:31] neg_lo:[0,1] neg_hi:[0,1]
v_pk_add_f32 v[22:23], v[22:23], v[30:31]
v_pk_mul_f32 v[30:31], v[28:29], s[62:63] op_sel:[0,0] op_sel_hi:[0,1] neg_lo:[0,1] neg_hi:[0,1]
v_pk_fma_f32 v[30:31], v[28:29], s[62:63], v[30:31] op_sel:[1,1,0] op_sel_hi:[1,0,1] neg_lo:[0,0,0] neg_hi:[0,1,0]
v_pk_add_f32 v[28:29], v[14:15], v[32:33] neg_lo:[0,1] neg_hi:[0,1]
v_pk_add_f32 v[14:15], v[14:15], v[32:33]
v_pk_add_f32 v[32:33], v[34:35], v[42:43] neg_lo:[0,1] neg_hi:[0,1]
v_pk_add_f32 v[34:35], v[34:35], v[42:43]
v_pk_mul_f32 v[42:43], v[32:33], s[62:63] op_sel:[0,0] op_sel_hi:[0,1] neg_lo:[0,0] neg_hi:[0,1]
v_pk_fma_f32 v[42:43], v[32:33], s[62:63], v[42:43] op_sel:[1,1,0] op_sel_hi:[1,0,1] neg_lo:[0,0,0] neg_hi:[0,0,0]
v_pk_add_f32 v[32:33], v[36:37], v[44:45] op_sel:[1,1] op_sel_hi:[0,0] neg_lo:[0,1] neg_hi:[1,0]
v_pk_add_f32 v[36:37], v[36:37], v[44:45]
v_pk_add_f32 v[44:45], v[38:39], v[46:47] neg_lo:[0,1] neg_hi:[0,1]
v_pk_add_f32 v[38:39], v[38:39], v[46:47]
v_pk_mul_f32 v[46:47], v[44:45], s[62:63] op_sel:[0,0] op_sel_hi:[0,1] neg_lo:[0,1] neg_hi:[0,1]
v_pk_fma_f32 v[46:47], v[44:45], s[62:63], v[46:47] op_sel:[1,1,0] op_sel_hi:[1,0,1] neg_lo:[0,0,0] neg_hi:[0,1,0]
v_pk_add_f32 v[44:45], v[48:49], v[56:57] neg_lo:[0,1] neg_hi:[0,1]
v_pk_add_f32 v[48:49], v[48:49], v[56:57]
v_pk_add_f32 v[56:57], v[50:51], v[58:59] neg_lo:[0,1] neg_hi:[0,1]
v_pk_add_f32 v[50:51], v[50:51], v[58:59]
v_pk_mul_f32 v[58:59], v[56:57], s[62:63] op_sel:[0,0] op_sel_hi:[0,1] neg_lo:[0,0] neg_hi:[0,1]
v_pk_fma_f32 v[58:59], v[56:57], s[62:63], v[58:59] op_sel:[1,1,0] op_sel_hi:[1,0,1] neg_lo:[0,0,0] neg_hi:[0,0,0]
v_pk_add_f32 v[56:57], v[52:53], v[60:61] op_sel:[1,1] op_sel_hi:[0,0] neg_lo:[0,1] neg_hi:[1,0]
v_pk_add_f32 v[52:53], v[52:53], v[60:61]
v_pk_add_f32 v[60:61], v[54:55], v[62:63] neg_lo:[0,1] neg_hi:[0,1]
v_pk_add_f32 v[54:55], v[54:55], v[62:63]
v_pk_mul_f32 v[62:63], v[60:61], s[62:63] op_sel:[0,0] op_sel_hi:[0,1] neg_lo:[0,1] neg_hi:[0,1]
v_pk_fma_f32 v[62:63], v[60:61], s[62:63], v[62:63] op_sel:[1,1,0] op_sel_hi:[1,0,1] neg_lo:[0,0,0] neg_hi:[0,1,0]
v_pk_add_f32 v[60:61], v[40:41], v[64:65] neg_lo:[0,1] neg_hi:[0,1]
v_pk_add_f32 v[40:41], v[40:41], v[64:65]
v_pk_add_f32 v[64:65], v[66:67], v[74:75] neg_lo:[0,1] neg_hi:[0,1]
v_pk_add_f32 v[66:67], v[66:67], v[74:75]
v_pk_mul_f32 v[74:75], v[64:65], s[62:63] op_sel:[0,0] op_sel_hi:[0,1] neg_lo:[0,0] neg_hi:[0,1]
v_pk_fma_f32 v[74:75], v[64:65], s[62:63], v[74:75] op_sel:[1,1,0] op_sel_hi:[1,0,1] neg_lo:[0,0,0] neg_hi:[0,0,0]
v_pk_add_f32 v[64:65], v[68:69], v[76:77] op_sel:[1,1] op_sel_hi:[0,0] neg_lo:[0,1] neg_hi:[1,0]
v_pk_add_f32 v[68:69], v[68:69], v[76:77]
v_pk_add_f32 v[76:77], v[70:71], v[78:79] neg_lo:[0,1] neg_hi:[0,1]
v_pk_add_f32 v[70:71], v[70:71], v[78:79]
v_pk_mul_f32 v[78:79], v[76:77], s[62:63] op_sel:[0,0] op_sel_hi:[0,1] neg_lo:[0,1] neg_hi:[0,1]
v_pk_fma_f32 v[78:79], v[76:77], s[62:63], v[78:79] op_sel:[1,1,0] op_sel_hi:[1,0,1] neg_lo:[0,0,0] neg_hi:[0,1,0]
v_pk_add_f32 v[76:77], v[16:17], v[20:21] neg_lo:[0,1] neg_hi:[0,1]
v_pk_add_f32 v[16:17], v[16:17], v[20:21]
v_pk_add_f32 v[20:21], v[18:19], v[22:23] op_sel:[1,1] op_sel_hi:[0,0] neg_lo:[0,1] neg_hi:[1,0]
v_pk_add_f32 v[18:19], v[18:19], v[22:23]
v_pk_add_f32 v[22:23], v[72:73], v[24:25] neg_lo:[0,1] neg_hi:[0,1]
v_pk_add_f32 v[72:73], v[72:73], v[24:25]
v_pk_add_f32 v[24:25], v[26:27], v[30:31] op_sel:[1,1] op_sel_hi:[0,0] neg_lo:[0,1] neg_hi:[1,0]
v_pk_add_f32 v[26:27], v[26:27], v[30:31]
v_pk_add_f32 v[30:31], v[14:15], v[36:37] neg_lo:[0,1] neg_hi:[0,1]
v_pk_add_f32 v[14:15], v[14:15], v[36:37]
v_pk_add_f32 v[36:37], v[34:35], v[38:39] op_sel:[1,1] op_sel_hi:[0,0] neg_lo:[0,1] neg_hi:[1,0]
v_pk_add_f32 v[34:35], v[34:35], v[38:39]
v_pk_add_f32 v[38:39], v[28:29], v[32:33] neg_lo:[0,1] neg_hi:[0,1]
v_pk_add_f32 v[28:29], v[28:29], v[32:33]
v_pk_add_f32 v[32:33], v[42:43], v[46:47] op_sel:[1,1] op_sel_hi:[0,0] neg_lo:[0,1] neg_hi:[1,0]
v_pk_add_f32 v[42:43], v[42:43], v[46:47]
v_pk_add_f32 v[46:47], v[48:49], v[52:53] neg_lo:[0,1] neg_hi:[0,1]
v_pk_add_f32 v[48:49], v[48:49], v[52:53]
v_pk_add_f32 v[52:53], v[50:51], v[54:55] op_sel:[1,1] op_sel_hi:[0,0] neg_lo:[0,1] neg_hi:[1,0]
v_pk_add_f32 v[50:51], v[50:51], v[54:55]
v_pk_add_f32 v[54:55], v[44:45], v[56:57] neg_lo:[0,1] neg_hi:[0,1]
v_pk_add_f32 v[44:45], v[44:45], v[56:57]
v_pk_add_f32 v[56:57], v[58:59], v[62:63] op_sel:[1,1] op_sel_hi:[0,0] neg_lo:[0,1] neg_hi:[1,0]
v_pk_add_f32 v[58:59], v[58:59], v[62:63]
v_pk_add_f32 v[62:63], v[40:41], v[68:69] neg_lo:[0,1] neg_hi:[0,1]
v_pk_add_f32 v[40:41], v[40:41], v[68:69]
v_pk_add_f32 v[68:69], v[66:67], v[70:71] op_sel:[1,1] op_sel_hi:[0,0] neg_lo:[0,1] neg_hi:[1,0]
v_pk_add_f32 v[66:67], v[66:67], v[70:71]
v_pk_add_f32 v[70:71], v[60:61], v[64:65] neg_lo:[0,1] neg_hi:[0,1]
v_pk_add_f32 v[60:61], v[60:61], v[64:65]
v_pk_add_f32 v[64:65], v[74:75], v[78:79] op_sel:[1,1] op_sel_hi:[0,0] neg_lo:[0,1] neg_hi:[1,0]
v_pk_add_f32 v[74:75], v[74:75], v[78:79]
v_pk_add_f32 v[78:79], v[16:17], v[18:19] neg_lo:[0,1] neg_hi:[0,1]
v_pk_add_f32 v[16:17], v[16:17], v[18:19]
v_pk_add_f32 v[18:19], v[76:77], v[20:21] neg_lo:[0,1] neg_hi:[0,1]
v_pk_add_f32 v[76:77], v[76:77], v[20:21]
v_pk_add_f32 v[20:21], v[72:73], v[26:27] neg_lo:[0,1] neg_hi:[0,1]
v_pk_add_f32 v[72:73], v[72:73], v[26:27]
v_pk_add_f32 v[26:27], v[22:23], v[24:25] neg_lo:[0,1] neg_hi:[0,1]
v_pk_add_f32 v[22:23], v[22:23], v[24:25]
v_pk_add_f32 v[24:25], v[14:15], v[34:35] neg_lo:[0,1] neg_hi:[0,1]
v_pk_add_f32 v[14:15], v[14:15], v[34:35]
v_pk_add_f32 v[34:35], v[30:31], v[36:37] neg_lo:[0,1] neg_hi:[0,1]
v_pk_add_f32 v[30:31], v[30:31], v[36:37]
v_pk_add_f32 v[36:37], v[28:29], v[42:43] neg_lo:[0,1] neg_hi:[0,1]
v_pk_add_f32 v[28:29], v[28:29], v[42:43]
v_pk_add_f32 v[42:43], v[38:39], v[32:33] neg_lo:[0,1] neg_hi:[0,1]
v_pk_add_f32 v[38:39], v[38:39], v[32:33]
v_pk_add_f32 v[32:33], v[48:49], v[50:51] neg_lo:[0,1] neg_hi:[0,1]
v_pk_add_f32 v[48:49], v[48:49], v[50:51]
v_pk_add_f32 v[50:51], v[46:47], v[52:53] neg_lo:[0,1] neg_hi:[0,1]
v_pk_add_f32 v[46:47], v[46:47], v[52:53]
v_pk_add_f32 v[52:53], v[44:45], v[58:59] neg_lo:[0,1] neg_hi:[0,1]
v_pk_add_f32 v[44:45], v[44:45], v[58:59]
v_pk_add_f32 v[58:59], v[54:55], v[56:57] neg_lo:[0,1] neg_hi:[0,1]
v_pk_add_f32 v[54:55], v[54:55], v[56:57]
v_pk_add_f32 v[56:57], v[40:41], v[66:67] neg_lo:[0,1] neg_hi:[0,1]
v_pk_add_f32 v[40:41], v[40:41], v[66:67]
v_pk_add_f32 v[66:67], v[62:63], v[68:69] neg_lo:[0,1] neg_hi:[0,1]
v_pk_add_f32 v[62:63], v[62:63], v[68:69]
v_pk_add_f32 v[68:69], v[60:61], v[74:75] neg_lo:[0,1] neg_hi:[0,1]
v_pk_add_f32 v[60:61], v[60:61], v[74:75]
v_pk_add_f32 v[74:75], v[70:71], v[64:65] neg_lo:[0,1] neg_hi:[0,1]
v_pk_add_f32 v[70:71], v[70:71], v[64:65]
v_pk_mul_f32 v[64:65], v[48:49], v[82:83] op_sel:[0,0] op_sel_hi:[0,1] neg_lo:[0,0] neg_hi:[0,0]
v_pk_fma_f32 v[48:49], v[48:49], v[82:83], v[64:65] op_sel:[1,1,0] op_sel_hi:[1,0,1] neg_lo:[0,1,0] neg_hi:[0,0,0]
v_pk_mul_f32 v[64:65], v[14:15], v[84:85] op_sel:[0,0] op_sel_hi:[0,1] neg_lo:[0,0] neg_hi:[0,0]
v_pk_fma_f32 v[14:15], v[14:15], v[84:85], v[64:65] op_sel:[1,1,0] op_sel_hi:[1,0,1] neg_lo:[0,1,0] neg_hi:[0,0,0]
v_pk_mul_f32 v[64:65], v[40:41], v[86:87] op_sel:[0,0] op_sel_hi:[0,1] neg_lo:[0,0] neg_hi:[0,0]
v_pk_fma_f32 v[40:41], v[40:41], v[86:87], v[64:65] op_sel:[1,1,0] op_sel_hi:[1,0,1] neg_lo:[0,1,0] neg_hi:[0,0,0]
v_pk_mul_f32 v[64:65], v[72:73], v[88:89] op_sel:[0,0] op_sel_hi:[0,1] neg_lo:[0,0] neg_hi:[0,0]
v_pk_fma_f32 v[72:73], v[72:73], v[88:89], v[64:65] op_sel:[1,1,0] op_sel_hi:[1,0,1] neg_lo:[0,1,0] neg_hi:[0,0,0]
v_pk_mul_f32 v[64:65], v[44:45], v[90:91] op_sel:[0,0] op_sel_hi:[0,1] neg_lo:[0,0] neg_hi:[0,0]
v_pk_fma_f32 v[44:45], v[44:45], v[90:91], v[64:65] op_sel:[1,1,0] op_sel_hi:[1,0,1] neg_lo:[0,1,0] neg_hi:[0,0,0]
v_pk_mul_f32 v[64:65], v[28:29], v[92:93] op_sel:[0,0] op_sel_hi:[0,1] neg_lo:[0,0] neg_hi:[0,0]
v_pk_fma_f32 v[28:29], v[28:29], v[92:93], v[64:65] op_sel:[1,1,0] op_sel_hi:[1,0,1] neg_lo:[0,1,0] neg_hi:[0,0,0]
v_pk_mul_f32 v[64:65], v[60:61], v[94:95] op_sel:[0,0] op_sel_hi:[0,1] neg_lo:[0,0] neg_hi:[0,0]
v_pk_fma_f32 v[60:61], v[60:61], v[94:95], v[64:65] op_sel:[1,1,0] op_sel_hi:[1,0,1] neg_lo:[0,1,0] neg_hi:[0,0,0]
v_pk_mul_f32 v[64:65], v[76:77], v[96:97] op_sel:[0,0] op_sel_hi:[0,1] neg_lo:[0,0] neg_hi:[0,0]
v_pk_fma_f32 v[76:77], v[76:77], v[96:97], v[64:65] op_sel:[1,1,0] op_sel_hi:[1,0,1] neg_lo:[0,1,0] neg_hi:[0,0,0]
v_pk_mul_f32 v[64:65], v[46:47], v[98:99] op_sel:[0,0] op_sel_hi:[0,1] neg_lo:[0,0] neg_hi:[0,0]
v_pk_fma_f32 v[46:47], v[46:47], v[98:99], v[64:65] op_sel:[1,1,0] op_sel_hi:[1,0,1] neg_lo:[0,1,0] neg_hi:[0,0,0]
v_pk_mul_f32 v[64:65], v[30:31], v[100:101] op_sel:[0,0] op_sel_hi:[0,1] neg_lo:[0,0] neg_hi:[0,0]
v_pk_fma_f32 v[30:31], v[30:31], v[100:101], v[64:65] op_sel:[1,1,0] op_sel_hi:[1,0,1] neg_lo:[0,1,0] neg_hi:[0,0,0]
v_pk_mul_f32 v[64:65], v[62:63], v[102:103] op_sel:[0,0] op_sel_hi:[0,1] neg_lo:[0,0] neg_hi:[0,0]
v_pk_fma_f32 v[62:63], v[62:63], v[102:103], v[64:65] op_sel:[1,1,0] op_sel_hi:[1,0,1] neg_lo:[0,1,0] neg_hi:[0,0,0]
v_pk_mul_f32 v[64:65], v[22:23], v[104:105] op_sel:[0,0] op_sel_hi:[0,1] neg_lo:[0,0] neg_hi:[0,0]
v_pk_fma_f32 v[22:23], v[22:23], v[104:105], v[64:65] op_sel:[1,1,0] op_sel_hi:[1,0,1] neg_lo:[0,1,0] neg_hi:[0,0,0]
v_pk_mul_f32 v[64:65], v[54:55], v[106:107] op_sel:[0,0] op_sel_hi:[0,1] neg_lo:[0,0] neg_hi:[0,0]
v_pk_fma_f32 v[54:55], v[54:55], v[106:107], v[64:65] op_sel:[1,1,0] op_sel_hi:[1,0,1] neg_lo:[0,1,0] neg_hi:[0,0,0]
v_pk_mul_f32 v[64:65], v[38:39], v[108:109] op_sel:[0,0] op_sel_hi:[0,1] neg_lo:[0,0] neg_hi:[0,0]
v_pk_fma_f32 v[38:39], v[38:39], v[108:109], v[64:65] op_sel:[1,1,0] op_sel_hi:[1,0,1] neg_lo:[0,1,0] neg_hi:[0,0,0]
v_pk_mul_f32 v[64:65], v[70:71], v[110:111] op_sel:[0,0] op_sel_hi:[0,1] neg_lo:[0,0] neg_hi:[0,0]
v_pk_fma_f32 v[70:71], v[70:71], v[110:111], v[64:65] op_sel:[1,1,0] op_sel_hi:[1,0,1] neg_lo:[0,1,0] neg_hi:[0,0,0]
v_pk_mul_f32 v[64:65], v[78:79], v[112:113] op_sel:[0,0] op_sel_hi:[0,1] neg_lo:[0,0] neg_hi:[0,0]
v_pk_fma_f32 v[78:79], v[78:79], v[112:113], v[64:65] op_sel:[1,1,0] op_sel_hi:[1,0,1] neg_lo:[0,1,0] neg_hi:[0,0,0]
v_pk_mul_f32 v[64:65], v[32:33], v[114:115] op_sel:[0,0] op_sel_hi:[0,1] neg_lo:[0,0] neg_hi:[0,0]
v_pk_fma_f32 v[32:33], v[32:33], v[114:115], v[64:65] op_sel:[1,1,0] op_sel_hi:[1,0,1] neg_lo:[0,1,0] neg_hi:[0,0,0]
v_pk_mul_f32 v[64:65], v[24:25], v[116:117] op_sel:[0,0] op_sel_hi:[0,1] neg_lo:[0,0] neg_hi:[0,0]
v_pk_fma_f32 v[24:25], v[24:25], v[116:117], v[64:65] op_sel:[1,1,0] op_sel_hi:[1,0,1] neg_lo:[0,1,0] neg_hi:[0,0,0]
v_pk_mul_f32 v[64:65], v[56:57], v[118:119] op_sel:[0,0] op_sel_hi:[0,1] neg_lo:[0,0] neg_hi:[0,0]
v_pk_fma_f32 v[56:57], v[56:57], v[118:119], v[64:65] op_sel:[1,1,0] op_sel_hi:[1,0,1] neg_lo:[0,1,0] neg_hi:[0,0,0]
v_pk_mul_f32 v[64:65], v[20:21], v[120:121] op_sel:[0,0] op_sel_hi:[0,1] neg_lo:[0,0] neg_hi:[0,0]
v_pk_fma_f32 v[20:21], v[20:21], v[120:121], v[64:65] op_sel:[1,1,0] op_sel_hi:[1,0,1] neg_lo:[0,1,0] neg_hi:[0,0,0]
v_pk_mul_f32 v[64:65], v[52:53], v[122:123] op_sel:[0,0] op_sel_hi:[0,1] neg_lo:[0,0] neg_hi:[0,0]
v_pk_fma_f32 v[52:53], v[52:53], v[122:123], v[64:65] op_sel:[1,1,0] op_sel_hi:[1,0,1] neg_lo:[0,1,0] neg_hi:[0,0,0]
v_pk_mul_f32 v[64:65], v[36:37], v[124:125] op_sel:[0,0] op_sel_hi:[0,1] neg_lo:[0,0] neg_hi:[0,0]
v_pk_fma_f32 v[36:37], v[36:37], v[124:125], v[64:65] op_sel:[1,1,0] op_sel_hi:[1,0,1] neg_lo:[0,1,0] neg_hi:[0,0,0]
v_pk_mul_f32 v[64:65], v[68:69], v[126:127] op_sel:[0,0] op_sel_hi:[0,1] neg_lo:[0,0] neg_hi:[0,0]
v_pk_fma_f32 v[68:69], v[68:69], v[126:127], v[64:65] op_sel:[1,1,0] op_sel_hi:[1,0,1] neg_lo:[0,1,0] neg_hi:[0,0,0]
v_pk_mul_f32 v[64:65], v[18:19], v[128:129] op_sel:[0,0] op_sel_hi:[0,1] neg_lo:[0,0] neg_hi:[0,0]
v_pk_fma_f32 v[18:19], v[18:19], v[128:129], v[64:65] op_sel:[1,1,0] op_sel_hi:[1,0,1] neg_lo:[0,1,0] neg_hi:[0,0,0]
v_pk_mul_f32 v[64:65], v[50:51], v[130:131] op_sel:[0,0] op_sel_hi:[0,1] neg_lo:[0,0] neg_hi:[0,0]
v_pk_fma_f32 v[50:51], v[50:51], v[130:131], v[64:65] op_sel:[1,1,0] op_sel_hi:[1,0,1] neg_lo:[0,1,0] neg_hi:[0,0,0]
v_pk_mul_f32 v[64:65], v[34:35], v[132:133] op_sel:[0,0] op_sel_hi:[0,1] neg_lo:[0,0] neg_hi:[0,0]
v_pk_fma_f32 v[34:35], v[34:35], v[132:133], v[64:65] op_sel:[1,1,0] op_sel_hi:[1,0,1] neg_lo:[0,1,0] neg_hi:[0,0,0]
v_pk_mul_f32 v[64:65], v[66:67], v[134:135] op_sel:[0,0] op_sel_hi:[0,1] neg_lo:[0,0] neg_hi:[0,0]
v_pk_fma_f32 v[66:67], v[66:67], v[134:135], v[64:65] op_sel:[1,1,0] op_sel_hi:[1,0,1] neg_lo:[0,1,0] neg_hi:[0,0,0]
v_pk_mul_f32 v[64:65], v[26:27], v[136:137] op_sel:[0,0] op_sel_hi:[0,1] neg_lo:[0,0] neg_hi:[0,0]
v_pk_fma_f32 v[26:27], v[26:27], v[136:137], v[64:65] op_sel:[1,1,0] op_sel_hi:[1,0,1] neg_lo:[0,1,0] neg_hi:[0,0,0]
v_pk_mul_f32 v[64:65], v[58:59], v[138:139] op_sel:[0,0] op_sel_hi:[0,1] neg_lo:[0,0] neg_hi:[0,0]
v_pk_fma_f32 v[58:59], v[58:59], v[138:139], v[64:65] op_sel:[1,1,0] op_sel_hi:[1,0,1] neg_lo:[0,1,0] neg_hi:[0,0,0]
v_pk_mul_f32 v[64:65], v[42:43], v[140:141] op_sel:[0,0] op_sel_hi:[0,1] neg_lo:[0,0] neg_hi:[0,0]
v_pk_fma_f32 v[42:43], v[42:43], v[140:141], v[64:65] op_sel:[1,1,0] op_sel_hi:[1,0,1] neg_lo:[0,1,0] neg_hi:[0,0,0]
v_pk_mul_f32 v[64:65], v[74:75], v[142:143] op_sel:[0,0] op_sel_hi:[0,1] neg_lo:[0,0] neg_hi:[0,0]
v_pk_fma_f32 v[74:75], v[74:75], v[142:143], v[64:65] op_sel:[1,1,0] op_sel_hi:[1,0,1] neg_lo:[0,1,0] neg_hi:[0,0,0]
s_barrier
ds_write_b64 v4, v[16:17] offset:0
ds_write_b64 v4, v[48:49] offset:264
ds_write_b64 v4, v[14:15] offset:528
ds_write_b64 v4, v[40:41] offset:792
ds_write_b64 v4, v[72:73] offset:1056
ds_write_b64 v4, v[44:45] offset:1320
ds_write_b64 v4, v[28:29] offset:1584
ds_write_b64 v4, v[60:61] offset:1848
ds_write_b64 v4, v[76:77] offset:2112
ds_write_b64 v4, v[46:47] offset:2376
ds_write_b64 v4, v[30:31] offset:2640
ds_write_b64 v4, v[62:63] offset:2904
ds_write_b64 v4, v[22:23] offset:3168
ds_write_b64 v4, v[54:55] offset:3432
ds_write_b64 v4, v[38:39] offset:3696
ds_write_b64 v4, v[70:71] offset:3960
ds_write_b64 v4, v[78:79] offset:4224
ds_write_b64 v4, v[32:33] offset:4488
ds_write_b64 v4, v[24:25] offset:4752
ds_write_b64 v4, v[56:57] offset:5016
ds_write_b64 v4, v[20:21] offset:5280
ds_write_b64 v4, v[52:53] offset:5544
ds_write_b64 v4, v[36:37] offset:5808
ds_write_b64 v4, v[68:69] offset:6072
ds_write_b64 v4, v[18:19] offset:6336
ds_write_b64 v4, v[50:51] offset:6600
ds_write_b64 v4, v[34:35] offset:6864
ds_write_b64 v4, v[66:67] offset:7128
ds_write_b64 v4, v[26:27] offset:7392
ds_write_b64 v4, v[58:59] offset:7656
ds_write_b64 v4, v[42:43] offset:7920
ds_write_b64 v4, v[74:75] offset:8184
s_waitcnt lgkmcnt(0)
ds_read_b64 v[16:17], v5 offset:0
ds_read_b64 v[48:49], v5 offset:128
ds_read_b64 v[18:19], v5 offset:8
ds_read_b64 v[50:51], v5 offset:136
ds_read_b64 v[20:21], v5 offset:16
ds_read_b64 v[52:53], v5 offset:144
ds_read_b64 v[22:23], v5 offset:24
ds_read_b64 v[54:55], v5 offset:152
ds_read_b64 v[24:25], v5 offset:32
ds_read_b64 v[56:57], v5 offset:160
ds_read_b64 v[26:27], v5 offset:40
ds_read_b64 v[58:59], v5 offset:168
ds_read_b64 v[28:29], v5 offset:48
ds_read_b64 v[60:61], v5 offset:176
ds_read_b64 v[30:31], v5 offset:56
ds_read_b64 v[62:63], v5 offset:184
ds_read_b64 v[32:33], v5 offset:64
ds_read_b64 v[64:65], v5 offset:192
ds_read_b64 v[34:35], v5 offset:72
ds_read_b64 v[66:67], v5 offset:200
ds_read_b64 v[36:37], v5 offset:80
ds_read_b64 v[68:69], v5 offset:208
ds_read_b64 v[38:39], v5 offset:88
ds_read_b64 v[70:71], v5 offset:216
ds_read_b64 v[40:41], v5 offset:96
ds_read_b64 v[72:73], v5 offset:224
ds_read_b64 v[42:43], v5 offset:104
ds_read_b64 v[74:75], v5 offset:232
ds_read_b64 v[44:45], v5 offset:112
ds_read_b64 v[76:77], v5 offset:240
ds_read_b64 v[46:47], v5 offset:120
ds_read_b64 v[78:79], v5 offset:248
s_waitcnt lgkmcnt(0)
v_pk_add_f32 v[14:15], v[16:17], v[48:49] neg_lo:[0,1] neg_hi:[0,1]
v_pk_add_f32 v[16:17], v[16:17], v[48:49]
v_pk_add_f32 v[48:49], v[18:19], v[50:51] neg_lo:[0,1] neg_hi:[0,1]
v_pk_add_f32 v[18:19], v[18:19], v[50:51]
v_pk_mul_f32 v[50:51], v[48:49], s[50:51] op_sel:[0,0] op_sel_hi:[0,1] neg_lo:[0,0] neg_hi:[0,1]
v_pk_fma_f32 v[50:51], v[48:49], s[50:51], v[50:51] op_sel:[1,1,0] op_sel_hi:[1,0,1] neg_lo:[0,0,0] neg_hi:[0,0,0]
v_pk_add_f32 v[48:49], v[20:21], v[52:53] neg_lo:[0,1] neg_hi:[0,1]
v_pk_add_f32 v[20:21], v[20:21], v[52:53]
v_pk_mul_f32 v[52:53], v[48:49], s[54:55] op_sel:[0,0] op_sel_hi:[0,1] neg_lo:[0,0] neg_hi:[0,1]
v_pk_fma_f32 v[52:53], v[48:49], s[54:55], v[52:53] op_sel:[1,1,0] op_sel_hi:[1,0,1] neg_lo:[0,0,0] neg_hi:[0,0,0]
v_pk_add_f32 v[48:49], v[22:23], v[54:55] neg_lo:[0,1] neg_hi:[0,1]
v_pk_add_f32 v[22:23], v[22:23], v[54:55]
v_pk_mul_f32 v[54:55], v[48:49], s[58:59] op_sel:[0,0] op_sel_hi:[0,1] neg_lo:[0,0] neg_hi:[0,1]
v_pk_fma_f32 v[54:55], v[48:49], s[58:59], v[54:55] op_sel:[1,1,0] op_sel_hi:[1,0,1] neg_lo:[0,0,0] neg_hi:[0,0,0]
v_pk_add_f32 v[48:49], v[24:25], v[56:57] neg_lo:[0,1] neg_hi:[0,1]
v_pk_add_f32 v[24:25], v[24:25], v[56:57]
v_pk_mul_f32 v[56:57], v[48:49], s[62:63] op_sel:[0,0] op_sel_hi:[0,1] neg_lo:[0,0] neg_hi:[0,1]
v_pk_fma_f32 v[56:57], v[48:49], s[62:63], v[56:57] op_sel:[1,1,0] op_sel_hi:[1,0,1] neg_lo:[0,0,0] neg_hi:[0,0,0]
v_pk_add_f32 v[48:49], v[26:27], v[58:59] neg_lo:[0,1] neg_hi:[0,1]
v_pk_add_f32 v[26:27], v[26:27], v[58:59]
v_pk_mul_f32 v[58:59], v[48:49], s[58:59] op_sel:[0,1] op_sel_hi:[0,0] neg_lo:[0,0] neg_hi:[0,1]
v_pk_fma_f32 v[58:59], v[48:49], s[58:59], v[58:59] op_sel:[1,0,0] op_sel_hi:[1,1,1] neg_lo:[0,0,0] neg_hi:[0,0,0]
v_pk_add_f32 v[48:49], v[28:29], v[60:61] neg_lo:[0,1] neg_hi:[0,1]
v_pk_add_f32 v[28:29], v[28:29], v[60:61]
v_pk_mul_f32 v[60:61], v[48:49], s[54:55] op_sel:[0,1] op_sel_hi:[0,0] neg_lo:[0,0] neg_hi:[0,1]
v_pk_fma_f32 v[60:61], v[48:49], s[54:55], v[60:61] op_sel:[1,0,0] op_sel_hi:[1,1,1] neg_lo:[0,0,0] neg_hi:[0,0,0]
v_pk_add_f32 v[48:49], v[30:31], v[62:63] neg_lo:[0,1] neg_hi:[0,1]
v_pk_add_f32 v[30:31], v[30:31], v[62:63]
v_pk_mul_f32 v[62:63], v[48:49], s[50:51] op_sel:[0,1] op_sel_hi:[0,0] neg_lo:[0,0] neg_hi:[0,1]
v_pk_fma_f32 v[62:63], v[48:49], s[50:51], v[62:63] op_sel:[1,0,0] op_sel_hi:[1,1,1] neg_lo:[0,0,0] neg_hi:[0,0,0]
v_pk_add_f32 v[48:49], v[32:33], v[64:65] op_sel:[1,1] op_sel_hi:[0,0] neg_lo:[0,1] neg_hi:[1,0]
v_pk_add_f32 v[32:33], v[32:33], v[64:65]
v_pk_add_f32 v[64:65], v[34:35], v[66:67] neg_lo:[0,1] neg_hi:[0,1]
v_pk_add_f32 v[34:35], v[34:35], v[66:67]
v_pk_mul_f32 v[66:67], v[64:65], s[50:51] op_sel:[0,1] op_sel_hi:[0,0] neg_lo:[0,1] neg_hi:[0,1]
v_pk_fma_f32 v[66:67], v[64:65], s[50:51], v[66:67] op_sel:[1,0,0] op_sel_hi:[1,1,1] neg_lo:[0,0,0] neg_hi:[0,1,0]
v_pk_add_f32 v[64:65], v[36:37], v[68:69] neg_lo:[0,1] neg_hi:[0,1]
v_pk_add_f32 v[36:37], v[36:37], v[68:69]
v_pk_mul_f32 v[68:69], v[64:65], s[54:55] op_sel:[0,1] op_sel_hi:[0,0] neg_lo:[0,1] neg_hi:[0,1]
v_pk_fma_f32 v[68:69], v[64:65], s[54:55], v[68:69] op_sel:[1,0,0] op_sel_hi:[1,1,1] neg_lo:[0,0,0] neg_hi:[0,1,0]
v_pk_add_f32 v[64:65], v[38:39], v[70:71] neg_lo:[0,1] neg_hi:[0,1]
v_pk_add_f32 v[38:39], v[38:39], v[70:71]
v_pk_mul_f32 v[70:71], v[64:65], s[58:59] op_sel:[0,1] op_sel_hi:[0,0] neg_lo:[0,1] neg_hi:[0,1]
v_pk_fma_f32 v[70:71], v[64:65], s[58:59], v[70:71] op_sel:[1,0,0] op_sel_hi:[1,1,1] neg_lo:[0,0,0] neg_hi:[0,1,0]
v_pk_add_f32 v[64:65], v[40:41], v[72:73] neg_lo:[0,1] neg_hi:[0,1]
v_pk_add_f32 v[40:41], v[40:41], v[72:73]
v_pk_mul_f32 v[72:73], v[64:65], s[62:63] op_sel:[0,0] op_sel_hi:[0,1] neg_lo:[0,1] neg_hi:[0,1]
v_pk_fma_f32 v[72:73], v[64:65], s[62:63], v[72:73] op_sel:[1,1,0] op_sel_hi:[1,0,1] neg_lo:[0,0,0] neg_hi:[0,1,0]
v_pk_add_f32 v[64:65], v[42:43], v[74:75] neg_lo:[0,1] neg_hi:[0,1]
v_pk_add_f32 v[42:43], v[42:43], v[74:75]
v_pk_mul_f32 v[74:75], v[64:65], s[58:59] op_sel:[0,0] op_sel_hi:[0,1] neg_lo:[0,1] neg_hi:[0,1]
v_pk_fma_f32 v[74:75], v[64:65], s[58:59], v[74:75] op_sel:[1,1,0] op_sel_hi:[1,0,1] neg_lo:[0,0,0] neg_hi:[0,1,0]
v_pk_add_f32 v[64:65], v[44:45], v[76:77] neg_lo:[0,1] neg_hi:[0,1]
v_pk_add_f32 v[44:45], v[44:45], v[76:77]
v_pk_mul_f32 v[76:77], v[64:65], s[54:55] op_sel:[0,0] op_sel_hi:[0,1] neg_lo:[0,1] neg_hi:[0,1]
v_pk_fma_f32 v[76:77], v[64:65], s[54:55], v[76:77] op_sel:[1,1,0] op_sel_hi:[1,0,1] neg_lo:[0,0,0] neg_hi:[0,1,0]
v_pk_add_f32 v[64:65], v[46:47], v[78:79] neg_lo:[0,1] neg_hi:[0,1]
v_pk_add_f32 v[46:47], v[46:47], v[78:79]
v_pk_mul_f32 v[78:79], v[64:65], s[50:51] op_sel:[0,0] op_sel_hi:[0,1] neg_lo:[0,1] neg_hi:[0,1]
v_pk_fma_f32 v[78:79], v[64:65], s[50:51], v[78:79] op_sel:[1,1,0] op_sel_hi:[1,0,1] neg_lo:[0,0,0] neg_hi:[0,1,0]
v_pk_add_f32 v[64:65], v[16:17], v[32:33] neg_lo:[0,1] neg_hi:[0,1]
v_pk_add_f32 v[16:17], v[16:17], v[32:33]
v_pk_add_f32 v[32:33], v[18:19], v[34:35] neg_lo:[0,1] neg_hi:[0,1]
v_pk_add_f32 v[18:19], v[18:19], v[34:35]
v_pk_mul_f32 v[34:35], v[32:33], s[54:55] op_sel:[0,0] op_sel_hi:[0,1] neg_lo:[0,0] neg_hi:[0,1]
v_pk_fma_f32 v[34:35], v[32:33], s[54:55], v[34:35] op_sel:[1,1,0] op_sel_hi:[1,0,1] neg_lo:[0,0,0] neg_hi:[0,0,0]
v_pk_add_f32 v[32:33], v[20:21], v[36:37] neg_lo:[0,1] neg_hi:[0,1]
v_pk_add_f32 v[20:21], v[20:21], v[36:37]
v_pk_mul_f32 v[36:37], v[32:33], s[62:63] op_sel:[0,0] op_sel_hi:[0,1] neg_lo:[0,0] neg_hi:[0,1]
v_pk_fma_f32 v[36:37], v[32:33], s[62:63], v[36:37] op_sel:[1,1,0] op_sel_hi:[1,0,1] neg_lo:[0,0,0] neg_hi:[0,0,0]
v_pk_add_f32 v[32:33], v[22:23], v[38:39] neg_lo:[0,1] neg_hi:[0,1]
v_pk_add_f32 v[22:23], v[22:23], v[38:39]
v_pk_mul_f32 v[38:39], v[32:33], s[54:55] op_sel:[0,1] op_sel_hi:[0,0] neg_lo:[0,0] neg_hi:[0,1]
v_pk_fma_f32 v[38:39], v[32:33], s[54:55], v[38:39] op_sel:[1,0,0] op_sel_hi:[1,1,1] neg_lo:[0,0,0] neg_hi:[0,0,0]
v_pk_add_f32 v[32:33], v[24:25], v[40:41] op_sel:[1,1] op_sel_hi:[0,0] neg_lo:[0,1] neg_hi:[1,0]
v_pk_add_f32 v[24:25], v[24:25], v[40:41]
v_pk_add_f32 v[40:41], v[26:27], v[42:43] neg_lo:[0,1] neg_hi:[0,1]
v_pk_add_f32 v[26:27], v[26:27], v[42:43]
v_pk_mul_f32 v[42:43], v[40:41], s[54:55] op_sel:[0,1] op_sel_hi:[0,0] neg_lo:[0,1] neg_hi:[0,1]
v_pk_fma_f32 v[42:43], v[40:41], s[54:55], v[42:43] op_sel:[1,0,0] op_sel_hi:[1,1,1] neg_lo:[0,0,0] neg_hi:[0,1,0]
v_pk_add_f32 v[40:41], v[28:29], v[44:45] neg_lo:[0,1] neg_hi:[0,1]
v_pk_add_f32 v[28:29], v[28:29], v[44:45]
v_pk_mul_f32 v[44:45], v[40:41], s[62:63] op_sel:[0,0] op_sel_hi:[0,1] neg_lo:[0,1] neg_hi:[0,1]
v_pk_fma_f32 v[44:45], v[40:41], s[62:63], v[44:45] op_sel:[1,1,0] op_sel_hi:[1,0,1] neg_lo:[0,0,0] neg_hi:[0,1,0]
v_pk_add_f32 v[40:41], v[30:31], v[46:47] neg_lo:[0,1] neg_hi:[0,1]
v_pk_add_f32 v[30:31], v[30:31], v[46:47]
v_pk_mul_f32 v[46:47], v[40:41], s[54:55] op_sel:[0,0] op_sel_hi:[0,1] neg_lo:[0,1] neg_hi:[0,1]
v_pk_fma_f32 v[46:47], v[40:41], s[54:55], v[46:47] op_sel:[1,1,0] op_sel_hi:[1,0,1] neg_lo:[0,0,0] neg_hi:[0,1,0]
v_pk_add_f32 v[40:41], v[14:15], v[48:49] neg_lo:[0,1] neg_hi:[0,1]
v_pk_add_f32 v[14:15], v[14:15], v[48:49]
v_pk_add_f32 v[48:49], v[50:51], v[66:67] neg_lo:[0,1] neg_hi:[0,1]
v_pk_add_f32 v[50:51], v[50:51], v[66:67]
v_pk_mul_f32 v[66:67], v[48:49], s[54:55] op_sel:[0,0] op_sel_hi:[0,1] neg_lo:[0,0] neg_hi:[0,1]
v_pk_fma_f32 v[66:67], v[48:49], s[54:55], v[66:67] op_sel:[1,1,0] op_sel_hi:[1,0,1] neg_lo:[0,0,0] neg_hi:[0,0,0]
v_pk_add_f32 v[48:49], v[52:53], v[68:69] neg_lo:[0,1] neg_hi:[0,1]
v_pk_add_f32 v[52:53], v[52:53], v[68:69]
v_pk_mul_f32 v[68:69], v[48:49], s[62:63] op_sel:[0,0] op_sel_hi:[0,1] neg_lo:[0,0] neg_hi:[0,1]
v_pk_fma_f32 v[68:69], v[48:49], s[62:63], v[68:69] op_sel:[1,1,0] op_sel_hi:[1,0,1] neg_lo:[0,0,0] neg_hi:[0,0,0]
v_pk_add_f32 v[48:49], v[54:55], v[70:71] neg_lo:[0,1] neg_hi:[0,1]
v_pk_add_f32 v[54:55], v[54:55], v[70:71]
v_pk_mul_f32 v[70:71], v[48:49], s[54:55] op_sel:[0,1] op_sel_hi:[0,0] neg_lo:[0,0] neg_hi:[0,1]
v_pk_fma_f32 v[70:71], v[48:49], s[54:55], v[70:71] op_sel:[1,0,0] op_sel_hi:[1,1,1] neg_lo:[0,0,0] neg_hi:[0,0,0]
v_pk_add_f32 v[48:49], v[56:57], v[72:73] op_sel:[1,1] op_sel_hi:[0,0] neg_lo:[0,1] neg_hi:[1,0]
v_pk_add_f32 v[56:57], v[56:57], v[72:73]
v_pk_add_f32 v[72:73], v[58:59], v[74:75] neg_lo:[0,1] neg_hi:[0,1]
v_pk_add_f32 v[58:59], v[58:59], v[74:75]
v_pk_mul_f32 v[74:75], v[72:73], s[54:55] op_sel:[0,1] op_sel_hi:[0,0] neg_lo:[0,1] neg_hi:[0,1]
v_pk_fma_f32 v[74:75], v[72:73], s[54:55], v[74:75] op_sel:[1,0,0] op_sel_hi:[1,1,1] neg_lo:[0,0,0] neg_hi:[0,1,0]
v_pk_add_f32 v[72:73], v[60:61], v[76:77] neg_lo:[0,1] neg_hi:[0,1]
v_pk_add_f32 v[60:61], v[60:61], v[76:77]
v_pk_mul_f32 v[76:77], v[72:73], s[62:63] op_sel:[0,0] op_sel_hi:[0,1] neg_lo:[0,1] neg_hi:[0,1]
v_pk_fma_f32 v[76:77], v[72:73], s[62:63], v[76:77] op_sel:[1,1,0] op_sel_hi:[1,0,1] neg_lo:[0,0,0] neg_hi:[0,1,0]
v_pk_add_f32 v[72:73], v[62:63], v[78:79] neg_lo:[0,1] neg_hi:[0,1]
v_pk_add_f32 v[62:63], v[62:63], v[78:79]
v_pk_mul_f32 v[78:79], v[72:73], s[54:55] op_sel:[0,0] op_sel_hi:[0,1] neg_lo:[0,1] neg_hi:[0,1]
v_pk_fma_f32 v[78:79], v[72:73], s[54:55], v[78:79] op_sel:[1,1,0] op_sel_hi:[1,0,1] neg_lo:[0,0,0] neg_hi:[0,1,0]
v_pk_add_f32 v[72:73], v[16:17], v[24:25] neg_lo:[0,1] neg_hi:[0,1]
v_pk_add_f32 v[16:17], v[16:17], v[24:25]
v_pk_add_f32 v[24:25], v[18:19], v[26:27] neg_lo:[0,1] neg_hi:[0,1]
v_pk_add_f32 v[18:19], v[18:19], v[26:27]
v_pk_mul_f32 v[26:27], v[24:25], s[62:63] op_sel:[0,0] op_sel_hi:[0,1] neg_lo:[0,0] neg_hi:[0,1]
v_pk_fma_f32 v[26:27], v[24:25], s[62:63], v[26:27] op_sel:[1,1,0] op_sel_hi:[1,0,1] neg_lo:[0,0,0] neg_hi:[0,0,0]
v_pk_add_f32 v[24:25], v[20:21], v[28:29] op_sel:[1,1] op_sel_hi:[0,0] neg_lo:[0,1] neg_hi:[1,0]
v_pk_add_f32 v[20:21], v[20:21], v[28:29]
v_pk_add_f32 v[28:29], v[22:23], v[30:31] neg_lo:[0,1] neg_hi:[0,1]
v_pk_add_f32 v[22:23], v[22:23], v[30:31]
v_pk_mul_f32 v[30:31], v[28:29], s[62:63] op_sel:[0,0] op_sel_hi:[0,1] neg_lo:[0,1] neg_hi:[0,1]
v_pk_fma_f32 v[30:31], v[28:29], s[62:63], v[30:31] op_sel:[1,1,0] op_sel_hi:[1,0,1] neg_lo:[0,0,0] neg_hi:[0,1,0]
v_pk_add_f32 v[28:29], v[64:65], v[32:33] neg_lo:[0,1] neg_hi:[0,1]
v_pk_add_f32 v[64:65], v[64:65], v[32:33]
v_pk_add_f32 v[32:33], v[34:35], v[42:43] neg_lo:[0,1] neg_hi:[0,1]
v_pk_add_f32 v[34:35], v[34:35], v[42:43]
v_pk_mul_f32 v[42:43], v[32:33], s[62:63] op_sel:[0,0] op_sel_hi:[0,1] neg_lo:[0,0] neg_hi:[0,1]
v_pk_fma_f32 v[42:43], v[32:33], s[62:63], v[42:43] op_sel:[1,1,0] op_sel_hi:[1,0,1] neg_lo:[0,0,0] neg_hi:[0,0,0]
v_pk_add_f32 v[32:33], v[36:37], v[44:45] op_sel:[1,1] op_sel_hi:[0,0] neg_lo:[0,1] neg_hi:[1,0]
v_pk_add_f32 v[36:37], v[36:37], v[44:45]
v_pk_add_f32 v[44:45], v[38:39], v[46:47] neg_lo:[0,1] neg_hi:[0,1]
v_pk_add_f32 v[38:39], v[38:39], v[46:47]
v_pk_mul_f32 v[46:47], v[44:45], s[62:63] op_sel:[0,0] op_sel_hi:[0,1] neg_lo:[0,1] neg_hi:[0,1]
v_pk_fma_f32 v[46:47], v[44:45], s[62:63], v[46:47] op_sel:[1,1,0] op_sel_hi:[1,0,1] neg_lo:[0,0,0] neg_hi:[0,1,0]
v_pk_add_f32 v[44:45], v[14:15], v[56:57] neg_lo:[0,1] neg_hi:[0,1]
v_pk_add_f32 v[14:15], v[14:15], v[56:57]
v_pk_add_f32 v[56:57], v[50:51], v[58:59] neg_lo:[0,1] neg_hi:[0,1]
v_pk_add_f32 v[50:51], v[50:51], v[58:59]
v_pk_mul_f32 v[58:59], v[56:57], s[62:63] op_sel:[0,0] op_sel_hi:[0,1] neg_lo:[0,0] neg_hi:[0,1]
v_pk_fma_f32 v[58:59], v[56:57], s[62:63], v[58:59] op_sel:[1,1,0] op_sel_hi:[1,0,1] neg_lo:[0,0,0] neg_hi:[0,0,0]
v_pk_add_f32 v[56:57], v[52:53], v[60:61] op_sel:[1,1] op_sel_hi:[0,0] neg_lo:[0,1] neg_hi:[1,0]
v_pk_add_f32 v[52:53], v[52:53], v[60:61]
v_pk_add_f32 v[60:61], v[54:55], v[62:63] neg_lo:[0,1] neg_hi:[0,1]
v_pk_add_f32 v[54:55], v[54:55], v[62:63]
v_pk_mul_f32 v[62:63], v[60:61], s[62:63] op_sel:[0,0] op_sel_hi:[0,1] neg_lo:[0,1] neg_hi:[0,1]
v_pk_fma_f32 v[62:63], v[60:61], s[62:63], v[62:63] op_sel:[1,1,0] op_sel_hi:[1,0,1] neg_lo:[0,0,0] neg_hi:[0,1,0]
v_pk_add_f32 v[60:61], v[40:41], v[48:49] neg_lo:[0,1] neg_hi:[0,1]
v_pk_add_f32 v[40:41], v[40:41], v[48:49]
v_pk_add_f32 v[48:49], v[66:67], v[74:75] neg_lo:[0,1] neg_hi:[0,1]
v_pk_add_f32 v[66:67], v[66:67], v[74:75]
v_pk_mul_f32 v[74:75], v[48:49], s[62:63] op_sel:[0,0] op_sel_hi:[0,1] neg_lo:[0,0] neg_hi:[0,1]
v_pk_fma_f32 v[74:75], v[48:49], s[62:63], v[74:75] op_sel:[1,1,0] op_sel_hi:[1,0,1] neg_lo:[0,0,0] neg_hi:[0,0,0]
v_pk_add_f32 v[48:49], v[68:69], v[76:77] op_sel:[1,1] op_sel_hi:[0,0] neg_lo:[0,1] neg_hi:[1,0]
v_pk_add_f32 v[68:69], v[68:69], v[76:77]
v_pk_add_f32 v[76:77], v[70:71], v[78:79] neg_lo:[0,1] neg_hi:[0,1]
v_pk_add_f32 v[70:71], v[70:71], v[78:79]
v_pk_mul_f32 v[78:79], v[76:77], s[62:63] op_sel:[0,0] op_sel_hi:[0,1] neg_lo:[0,1] neg_hi:[0,1]
v_pk_fma_f32 v[78:79], v[76:77], s[62:63], v[78:79] op_sel:[1,1,0] op_sel_hi:[1,0,1] neg_lo:[0,0,0] neg_hi:[0,1,0]
v_pk_add_f32 v[76:77], v[16:17], v[20:21] neg_lo:[0,1] neg_hi:[0,1]
v_pk_add_f32 v[16:17], v[16:17], v[20:21]
v_pk_add_f32 v[20:21], v[18:19], v[22:23] op_sel:[1,1] op_sel_hi:[0,0] neg_lo:[0,1] neg_hi:[1,0]
v_pk_add_f32 v[18:19], v[18:19], v[22:23]
v_pk_add_f32 v[22:23], v[72:73], v[24:25] neg_lo:[0,1] neg_hi:[0,1]
v_pk_add_f32 v[72:73], v[72:73], v[24:25]
v_pk_add_f32 v[24:25], v[26:27], v[30:31] op_sel:[1,1] op_sel_hi:[0,0] neg_lo:[0,1] neg_hi:[1,0]
v_pk_add_f32 v[26:27], v[26:27], v[30:31]
v_pk_add_f32 v[30:31], v[64:65], v[36:37] neg_lo:[0,1] neg_hi:[0,1]
v_pk_add_f32 v[64:65], v[64:65], v[36:37]
v_pk_add_f32 v[36:37], v[34:35], v[38:39] op_sel:[1,1] op_sel_hi:[0,0] neg_lo:[0,1] neg_hi:[1,0]
v_pk_add_f32 v[34:35], v[34:35], v[38:39]
v_pk_add_f32 v[38:39], v[28:29], v[32:33] neg_lo:[0,1] neg_hi:[0,1]
v_pk_add_f32 v[28:29], v[28:29], v[32:33]
v_pk_add_f32 v[32:33], v[42:43], v[46:47] op_sel:[1,1] op_sel_hi:[0,0] neg_lo:[0,1] neg_hi:[1,0]
v_pk_add_f32 v[42:43], v[42:43], v[46:47]
v_pk_add_f32 v[46:47], v[14:15], v[52:53] neg_lo:[0,1] neg_hi:[0,1]
v_pk_add_f32 v[14:15], v[14:15], v[52:53]
v_pk_add_f32 v[52:53], v[50:51], v[54:55] op_sel:[1,1] op_sel_hi:[0,0] neg_lo:[0,1] neg_hi:[1,0]
v_pk_add_f32 v[50:51], v[50:51], v[54:55]
v_pk_add_f32 v[54:55], v[44:45], v[56:57] neg_lo:[0,1] neg_hi:[0,1]
v_pk_add_f32 v[44:45], v[44:45], v[56:57]
v_pk_add_f32 v[56:57], v[58:59], v[62:63] op_sel:[1,1] op_sel_hi:[0,0] neg_lo:[0,1] neg_hi:[1,0]
v_pk_add_f32 v[58:59], v[58:59], v[62:63]
v_pk_add_f32 v[62:63], v[40:41], v[68:69] neg_lo:[0,1] neg_hi:[0,1]
v_pk_add_f32 v[40:41], v[40:41], v[68:69]
v_pk_add_f32 v[68:69], v[66:67], v[70:71] op_sel:[1,1] op_sel_hi:[0,0] neg_lo:[0,1] neg_hi:[1,0]
v_pk_add_f32 v[66:67], v[66:67], v[70:71]
v_pk_add_f32 v[70:71], v[60:61], v[48:49] neg_lo:[0,1] neg_hi:[0,1]
v_pk_add_f32 v[60:61], v[60:61], v[48:49]
v_pk_add_f32 v[48:49], v[74:75], v[78:79] op_sel:[1,1] op_sel_hi:[0,0] neg_lo:[0,1] neg_hi:[1,0]
v_pk_add_f32 v[74:75], v[74:75], v[78:79]
v_pk_add_f32 v[78:79], v[16:17], v[18:19] neg_lo:[0,1] neg_hi:[0,1]
v_pk_add_f32 v[16:17], v[16:17], v[18:19]
v_pk_add_f32 v[18:19], v[76:77], v[20:21] neg_lo:[0,1] neg_hi:[0,1]
v_pk_add_f32 v[76:77], v[76:77], v[20:21]
v_pk_add_f32 v[20:21], v[72:73], v[26:27] neg_lo:[0,1] neg_hi:[0,1]
v_pk_add_f32 v[72:73], v[72:73], v[26:27]
v_pk_add_f32 v[26:27], v[22:23], v[24:25] neg_lo:[0,1] neg_hi:[0,1]
v_pk_add_f32 v[22:23], v[22:23], v[24:25]
v_pk_add_f32 v[24:25], v[64:65], v[34:35] neg_lo:[0,1] neg_hi:[0,1]
v_pk_add_f32 v[64:65], v[64:65], v[34:35]
v_pk_add_f32 v[34:35], v[30:31], v[36:37] neg_lo:[0,1] neg_hi:[0,1]
v_pk_add_f32 v[30:31], v[30:31], v[36:37]
v_pk_add_f32 v[36:37], v[28:29], v[42:43] neg_lo:[0,1] neg_hi:[0,1]
v_pk_add_f32 v[28:29], v[28:29], v[42:43]
v_pk_add_f32 v[42:43], v[38:39], v[32:33] neg_lo:[0,1] neg_hi:[0,1]
v_pk_add_f32 v[38:39], v[38:39], v[32:33]
v_pk_add_f32 v[32:33], v[14:15], v[50:51] neg_lo:[0,1] neg_hi:[0,1]
v_pk_add_f32 v[14:15], v[14:15], v[50:51]
v_pk_add_f32 v[50:51], v[46:47], v[52:53] neg_lo:[0,1] neg_hi:[0,1]
v_pk_add_f32 v[46:47], v[46:47], v[52:53]
v_pk_add_f32 v[52:53], v[44:45], v[58:59] neg_lo:[0,1] neg_hi:[0,1]
v_pk_add_f32 v[44:45], v[44:45], v[58:59]
v_pk_add_f32 v[58:59], v[54:55], v[56:57] neg_lo:[0,1] neg_hi:[0,1]
v_pk_add_f32 v[54:55], v[54:55], v[56:57]
v_pk_add_f32 v[56:57], v[40:41], v[66:67] neg_lo:[0,1] neg_hi:[0,1]
v_pk_add_f32 v[40:41], v[40:41], v[66:67]
v_pk_add_f32 v[66:67], v[62:63], v[68:69] neg_lo:[0,1] neg_hi:[0,1]
v_pk_add_f32 v[62:63], v[62:63], v[68:69]
v_pk_add_f32 v[68:69], v[60:61], v[74:75] neg_lo:[0,1] neg_hi:[0,1]
v_pk_add_f32 v[60:61], v[60:61], v[74:75]
v_pk_add_f32 v[74:75], v[70:71], v[48:49] neg_lo:[0,1] neg_hi:[0,1]
v_pk_add_f32 v[70:71], v[70:71], v[48:49]
ds_write_b64 v4, v[16:17] offset:0
ds_write_b64 v4, v[14:15] offset:256
ds_write_b64 v4, v[64:65] offset:512
ds_write_b64 v4, v[40:41] offset:768
ds_write_b64 v4, v[72:73] offset:1024
ds_write_b64 v4, v[44:45] offset:1280
ds_write_b64 v4, v[28:29] offset:1536
ds_write_b64 v4, v[60:61] offset:1792
ds_write_b64 v4, v[76:77] offset:2048
ds_write_b64 v4, v[46:47] offset:2304
ds_write_b64 v4, v[30:31] offset:2560
ds_write_b64 v4, v[62:63] offset:2816
ds_write_b64 v4, v[22:23] offset:3072
ds_write_b64 v4, v[54:55] offset:3328
ds_write_b64 v4, v[38:39] offset:3584
ds_write_b64 v4, v[70:71] offset:3840
ds_write_b64 v4, v[78:79] offset:4096
ds_write_b64 v4, v[32:33] offset:4352
ds_write_b64 v4, v[24:25] offset:4608
ds_write_b64 v4, v[56:57] offset:4864
ds_write_b64 v4, v[20:21] offset:5120
ds_write_b64 v4, v[52:53] offset:5376
ds_write_b64 v4, v[36:37] offset:5632
ds_write_b64 v4, v[68:69] offset:5888
ds_write_b64 v4, v[18:19] offset:6144
ds_write_b64 v4, v[50:51] offset:6400
ds_write_b64 v4, v[34:35] offset:6656
ds_write_b64 v4, v[66:67] offset:6912
ds_write_b64 v4, v[26:27] offset:7168
ds_write_b64 v4, v[58:59] offset:7424
ds_write_b64 v4, v[42:43] offset:7680
ds_write_b64 v4, v[74:75] offset:7936
ds_write_b64 v4, v[16:17] offset:8192
s_waitcnt lgkmcnt(0)
s_barrier
s_lshl_b32 s13, s93, 7
s_and_b32 s23, s13, 0x2000
s_add_u32 s13, s13, s23
s_xor_b32 s23, s98, 1
s_lshl_b32 s23, s23, 13
s_add_u32 s13, s13, s23
s_add_u32 s13, s13, 92274688
ds_read_b64 v[16:17], v6 offset:0
ds_read_b64 v[18:19], v7 offset:4096
ds_read_b64 v[20:21], v6 offset:256
ds_read_b64 v[22:23], v7 offset:3840
ds_read_b64 v[24:25], v6 offset:512
ds_read_b64 v[26:27], v7 offset:3584
ds_read_b64 v[28:29], v6 offset:768
ds_read_b64 v[30:31], v7 offset:3328
ds_read_b64 v[32:33], v6 offset:1024
ds_read_b64 v[34:35], v7 offset:3072
ds_read_b64 v[36:37], v6 offset:1280
ds_read_b64 v[38:39], v7 offset:2816
s_waitcnt lgkmcnt(10)
v_pk_add_f32 v[208:209], v[16:17], v[18:19] neg_hi:[0,1]
v_pk_add_f32 v[210:211], v[16:17], v[18:19] op_sel:[1,1] op_sel_hi:[0,0] neg_hi:[1,0]
ds_read_b64 v[40:41], v6 offset:1536
ds_read_b64 v[42:43], v7 offset:2560
buffer_store_dwordx4 v[208:211], v8, s[84:87], s13 offen sc1
s_add_u32 s13, s13, 1048576
s_waitcnt lgkmcnt(10)
v_pk_add_f32 v[212:213], v[20:21], v[22:23] neg_hi:[0,1]
v_pk_add_f32 v[214:215], v[20:21], v[22:23] op_sel:[1,1] op_sel_hi:[0,0] neg_hi:[1,0]
ds_read_b64 v[44:45], v6 offset:1792
ds_read_b64 v[46:47], v7 offset:2304
buffer_store_dwordx4 v[212:215], v8, s[84:87], s13 offen sc1
s_add_u32 s13, s13, 1048576
s_xor_b32 s13, s13, 0x2000
s_waitcnt lgkmcnt(10)
v_pk_add_f32 v[216:217], v[24:25], v[26:27] neg_hi:[0,1]
v_pk_add_f32 v[218:219], v[24:25], v[26:27] op_sel:[1,1] op_sel_hi:[0,0] neg_hi:[1,0]
ds_read_b64 v[16:17], v6 offset:2048
ds_read_b64 v[18:19], v7 offset:2048
buffer_store_dwordx4 v[216:219], v8, s[84:87], s13 offen sc1
s_add_u32 s13, s13, 1048576
s_waitcnt lgkmcnt(10)
v_pk_add_f32 v[220:221], v[28:29], v[30:31] neg_hi:[0,1]
v_pk_add_f32 v[222:223], v[28:29], v[30:31] op_sel:[1,1] op_sel_hi:[0,0] neg_hi:[1,0]
ds_read_b64 v[20:21], v6 offset:2304
ds_read_b64 v[22:23], v7 offset:1792
buffer_store_dwordx4 v[220:223], v8, s[84:87], s13 offen sc1
s_add_u32 s13, s13, 1048576
s_xor_b32 s13, s13, 0x2000
s_waitcnt lgkmcnt(10)
v_pk_add_f32 v[224:225], v[32:33], v[34:35] neg_hi:[0,1]
v_pk_add_f32 v[226:227], v[32:33], v[34:35] op_sel:[1,1] op_sel_hi:[0,0] neg_hi:[1,0]
ds_read_b64 v[24:25], v6 offset:2560
ds_read_b64 v[26:27], v7 offset:1536
buffer_store_dwordx4 v[224:227], v8, s[84:87], s13 offen sc1
s_add_u32 s13, s13, 1048576
s_waitcnt lgkmcnt(10)
v_pk_add_f32 v[228:229], v[36:37], v[38:39] neg_hi:[0,1]
v_pk_add_f32 v[230:231], v[36:37], v[38:39] op_sel:[1,1] op_sel_hi:[0,0] neg_hi:[1,0]
ds_read_b64 v[28:29], v6 offset:2816
ds_read_b64 v[30:31], v7 offset:1280
buffer_store_dwordx4 v[228:231], v8, s[84:87], s13 offen sc1
s_add_u32 s13, s13, 1048576
s_xor_b32 s13, s13, 0x2000
s_waitcnt lgkmcnt(10)
v_pk_add_f32 v[232:233], v[40:41], v[42:43] neg_hi:[0,1]
v_pk_add_f32 v[234:235], v[40:41], v[42:43] op_sel:[1,1] op_sel_hi:[0,0] neg_hi:[1,0]
ds_read_b64 v[32:33], v6 offset:3072
ds_read_b64 v[34:35], v7 offset:1024
buffer_store_dwordx4 v[232:235], v8, s[84:87], s13 offen sc1
s_add_u32 s13, s13, 1048576
s_waitcnt lgkmcnt(10)
v_pk_add_f32 v[236:237], v[44:45], v[46:47] neg_hi:[0,1]
v_pk_add_f32 v[238:239], v[44:45], v[46:47] op_sel:[1,1] op_sel_hi:[0,0] neg_hi:[1,0]
ds_read_b64 v[36:37], v6 offset:3328
ds_read_b64 v[38:39], v7 offset:768
buffer_store_dwordx4 v[236:239], v8, s[84:87], s13 offen sc1
s_add_u32 s13, s13, 1048576
s_xor_b32 s13, s13, 0x2000
s_waitcnt lgkmcnt(10)
v_pk_add_f32 v[208:209], v[16:17], v[18:19] neg_hi:[0,1]
v_pk_add_f32 v[210:211], v[16:17], v[18:19] op_sel:[1,1] op_sel_hi:[0,0] neg_hi:[1,0]
ds_read_b64 v[40:41], v6 offset:3584
ds_read_b64 v[42:43], v7 offset:512
buffer_store_dwordx4 v[208:211], v8, s[84:87], s13 offen sc1
s_add_u32 s13, s13, 1048576
s_waitcnt lgkmcnt(10)
v_pk_add_f32 v[212:213], v[20:21], v[22:23] neg_hi:[0,1]
v_pk_add_f32 v[214:215], v[20:21], v[22:23] op_sel:[1,1] op_sel_hi:[0,0] neg_hi:[1,0]
ds_read_b64 v[44:45], v6 offset:3840
ds_read_b64 v[46:47], v7 offset:256
buffer_store_dwordx4 v[212:215], v8, s[84:87], s13 offen sc1
s_add_u32 s13, s13, 1048576
s_xor_b32 s13, s13, 0x2000
s_waitcnt lgkmcnt(10)
v_pk_add_f32 v[216:217], v[24:25], v[26:27] neg_hi:[0,1]
v_pk_add_f32 v[218:219], v[24:25], v[26:27] op_sel:[1,1] op_sel_hi:[0,0] neg_hi:[1,0]
ds_read_b64 v[16:17], v6 offset:4096
ds_read_b64 v[18:19], v7 offset:0
buffer_store_dwordx4 v[216:219], v8, s[84:87], s13 offen sc1
s_add_u32 s13, s13, 1048576
s_waitcnt lgkmcnt(10)
v_pk_add_f32 v[220:221], v[28:29], v[30:31] neg_hi:[0,1]
v_pk_add_f32 v[222:223], v[28:29], v[30:31] op_sel:[1,1] op_sel_hi:[0,0] neg_hi:[1,0]
buffer_store_dwordx4 v[220:223], v8, s[84:87], s13 offen sc1
s_add_u32 s13, s13, 1048576
s_xor_b32 s13, s13, 0x2000
s_waitcnt lgkmcnt(8)
v_pk_add_f32 v[224:225], v[32:33], v[34:35] neg_hi:[0,1]
v_pk_add_f32 v[226:227], v[32:33], v[34:35] op_sel:[1,1] op_sel_hi:[0,0] neg_hi:[1,0]
buffer_store_dwordx4 v[224:227], v8, s[84:87], s13 offen sc1
s_add_u32 s13, s13, 1048576
s_waitcnt lgkmcnt(6)
v_pk_add_f32 v[228:229], v[36:37], v[38:39] neg_hi:[0,1]
v_pk_add_f32 v[230:231], v[36:37], v[38:39] op_sel:[1,1] op_sel_hi:[0,0] neg_hi:[1,0]
buffer_store_dwordx4 v[228:231], v8, s[84:87], s13 offen sc1
s_add_u32 s13, s13, 1048576
s_xor_b32 s13, s13, 0x2000
s_waitcnt lgkmcnt(4)
v_pk_add_f32 v[232:233], v[40:41], v[42:43] neg_hi:[0,1]
v_pk_add_f32 v[234:235], v[40:41], v[42:43] op_sel:[1,1] op_sel_hi:[0,0] neg_hi:[1,0]
buffer_store_dwordx4 v[232:235], v8, s[84:87], s13 offen sc1
s_add_u32 s13, s13, 1048576
s_waitcnt lgkmcnt(2)
v_pk_add_f32 v[236:237], v[44:45], v[46:47] neg_hi:[0,1]
v_pk_add_f32 v[238:239], v[44:45], v[46:47] op_sel:[1,1] op_sel_hi:[0,0] neg_hi:[1,0]
buffer_store_dwordx4 v[236:239], v8, s[84:87], s13 offen sc1
s_add_u32 s13, s13, 1048576
s_xor_b32 s13, s13, 0x2000
s_waitcnt lgkmcnt(0)
v_pk_add_f32 v[208:209], v[16:17], v[18:19] neg_hi:[0,1]
v_pk_add_f32 v[210:211], v[16:17], v[18:19] op_sel:[1,1] op_sel_hi:[0,0] neg_hi:[1,0]
v_cmp_eq_u32 vcc, 0, v9
s_nop 1
v_cndmask_b32 v13, -16, v8, vcc
buffer_store_dwordx4 v[208:211], v13, s[84:87], s13 offen sc1
s_add_u32 s13, s13, 1048576
s_mov_b32 s93, s21
s_cmp_lt_u32 s93, 128
s_cbranch_scc1 mega_kernel_f1_l
mega_kernel_f1_e:
s_mov_b32 s93, s40
s_waitcnt vmcnt(0)
s_load_dwordx2 s[4:5], s[0:1], 64
s_load_dwordx2 s[8:9], s[0:1], 72
v_and_b32 v1, 63, v0
v_lshrrev_b32 v2, 6, v0
v_mul_u32_u24 v3, 1026, v2
v_lshl_add_u32 v3, v1, 1, v3
v_mul_u32_u24 v4, 65, v1
v_add_u32 v4, v4, v2
v_lshlrev_b32 v4, 2, v4
v_lshrrev_b32 v7, 4, v0
v_and_b32 v8, 15, v0
v_mul_u32_u24 v5, 65, v7
v_lshl_add_u32 v5, v8, 2, v5
v_lshlrev_b32 v5, 2, v5
v_mul_u32_u24 v6, 16384, v7
v_lshl_add_u32 v6, v8, 4, v6
s_add_u32 s24, s84, 171966464
s_addc_u32 s25, s85, 0
s_mov_b32 s26, 8404992
s_mov_b32 s27, 0x00020000
s_waitcnt lgkmcnt(0)
s_mov_b32 s6, 2101248
s_mov_b32 s7, 0x00020000
s_mov_b32 s10, 2101248
s_mov_b32 s11, 0x00020000
v_lshlrev_b32 v9, 7, v0
s_and_b32 s12, s93, 31
s_mul_i32 s12, s12, 65664
buffer_load_dword v250, v9, s[4:7], s12 offen
buffer_load_dword v250, v9, s[8:11], s12 offen
s_add_u32 s12, s12, 32768
buffer_load_dword v250, v9, s[4:7], s12 offen
buffer_load_dword v250, v9, s[8:11], s12 offen
s_add_u32 s12, s12, 32768
s_cmp_lt_u32 s93, 288
s_cbranch_scc0 mega_kernel_f0_e
s_and_b32 s12, s93, 31
s_mul_i32 s12, s12, 65664
s_lshr_b32 s13, s93, 5
s_lshl_b32 s13, s13, 7
s_add_u32 s12, s12, s13
buffer_load_ushort v16, v3, s[4:7], s12 offen
buffer_load_ushort v32, v3, s[8:11], s12 offen
s_add_u32 s12, s12, 4104
buffer_load_ushort v17, v3, s[4:7], s12 offen
buffer_load_ushort v33, v3, s[8:11], s12 offen
s_add_u32 s12, s12, 4104
buffer_load_ushort v18, v3, s[4:7], s12 offen
buffer_load_ushort v34, v3, s[8:11], s12 offen
s_add_u32 s12, s12, 4104
buffer_load_ushort v19, v3, s[4:7], s12 offen
buffer_load_ushort v35, v3, s[8:11], s12 offen
s_add_u32 s12, s12, 4104
buffer_load_ushort v20, v3, s[4:7], s12 offen
buffer_load_ushort v36, v3, s[8:11], s12 offen
s_add_u32 s12, s12, 4104
buffer_load_ushort v21, v3, s[4:7], s12 offen
buffer_load_ushort v37, v3, s[8:11], s12 offen
s_add_u32 s12, s12, 4104
buffer_load_ushort v22, v3, s[4:7], s12 offen
buffer_load_ushort v38, v3, s[8:11], s12 offen
s_add_u32 s12, s12, 4104
buffer_load_ushort v23, v3, s[4:7], s12 offen
buffer_load_ushort v39, v3, s[8:11], s12 offen
s_add_u32 s12, s12, 4104
buffer_load_ushort v24, v3, s[4:7], s12 offen
buffer_load_ushort v40, v3, s[8:11], s12 offen
s_add_u32 s12, s12, 4104
buffer_load_ushort v25, v3, s[4:7], s12 offen
buffer_load_ushort v41, v3, s[8:11], s12 offen
s_add_u32 s12, s12, 4104
buffer_load_ushort v26, v3, s[4:7], s12 offen
buffer_load_ushort v42, v3, s[8:11], s12 offen
s_add_u32 s12, s12, 4104
buffer_load_ushort v27, v3, s[4:7], s12 offen
buffer_load_ushort v43, v3, s[8:11], s12 offen
s_add_u32 s12, s12, 4104
buffer_load_ushort v28, v3, s[4:7], s12 offen
buffer_load_ushort v44, v3, s[8:11], s12 offen
s_add_u32 s12, s12, 4104
buffer_load_ushort v29, v3, s[4:7], s12 offen
buffer_load_ushort v45, v3, s[8:11], s12 offen
s_add_u32 s12, s12, 4104
buffer_load_ushort v30, v3, s[4:7], s12 offen
buffer_load_ushort v46, v3, s[8:11], s12 offen
s_add_u32 s12, s12, 4104
buffer_load_ushort v31, v3, s[4:7], s12 offen
buffer_load_ushort v47, v3, s[8:11], s12 offen
s_add_u32 s12, s12, 4104
s_waitcnt vmcnt(0)
mega_kernel_f0_l:
s_add_u32 s21, s93, 32
s_cmp_lt_u32 s21, 288
s_cselect_b32 s22, s21, s93
s_waitcnt vmcnt(4)
v_lshl_or_b32 v48, v32, 16, v16
v_lshl_or_b32 v49, v33, 16, v17
v_lshl_or_b32 v50, v34, 16, v18
v_lshl_or_b32 v51, v35, 16, v19
v_lshl_or_b32 v52, v36, 16, v20
v_lshl_or_b32 v53, v37, 16, v21
v_lshl_or_b32 v54, v38, 16, v22
v_lshl_or_b32 v55, v39, 16, v23
v_lshl_or_b32 v56, v40, 16, v24
v_lshl_or_b32 v57, v41, 16, v25
v_lshl_or_b32 v58, v42, 16, v26
v_lshl_or_b32 v59, v43, 16, v27
v_lshl_or_b32 v60, v44, 16, v28
v_lshl_or_b32 v61, v45, 16, v29
v_lshl_or_b32 v62, v46, 16, v30
v_lshl_or_b32 v63, v47, 16, v31
s_and_b32 s12, s22, 31
s_mul_i32 s12, s12, 65664
s_lshr_b32 s13, s22, 5
s_lshl_b32 s13, s13, 7
s_add_u32 s12, s12, s13
buffer_load_ushort v16, v3, s[4:7], s12 offen
buffer_load_ushort v32, v3, s[8:11], s12 offen
s_add_u32 s12, s12, 4104
buffer_load_ushort v17, v3, s[4:7], s12 offen
buffer_load_ushort v33, v3, s[8:11], s12 offen
s_add_u32 s12, s12, 4104
buffer_load_ushort v18, v3, s[4:7], s12 offen
buffer_load_ushort v34, v3, s[8:11], s12 offen
s_add_u32 s12, s12, 4104
buffer_load_ushort v19, v3, s[4:7], s12 offen
buffer_load_ushort v35, v3, s[8:11], s12 offen
s_add_u32 s12, s12, 4104
buffer_load_ushort v20, v3, s[4:7], s12 offen
buffer_load_ushort v36, v3, s[8:11], s12 offen
s_add_u32 s12, s12, 4104
buffer_load_ushort v21, v3, s[4:7], s12 offen
buffer_load_ushort v37, v3, s[8:11], s12 offen
s_add_u32 s12, s12, 4104
buffer_load_ushort v22, v3, s[4:7], s12 offen
buffer_load_ushort v38, v3, s[8:11], s12 offen
s_add_u32 s12, s12, 4104
buffer_load_ushort v23, v3, s[4:7], s12 offen
buffer_load_ushort v39, v3, s[8:11], s12 offen
s_add_u32 s12, s12, 4104
buffer_load_ushort v24, v3, s[4:7], s12 offen
buffer_load_ushort v40, v3, s[8:11], s12 offen
s_add_u32 s12, s12, 4104
buffer_load_ushort v25, v3, s[4:7], s12 offen
buffer_load_ushort v41, v3, s[8:11], s12 offen
s_add_u32 s12, s12, 4104
buffer_load_ushort v26, v3, s[4:7], s12 offen
buffer_load_ushort v42, v3, s[8:11], s12 offen
s_add_u32 s12, s12, 4104
buffer_load_ushort v27, v3, s[4:7], s12 offen
buffer_load_ushort v43, v3, s[8:11], s12 offen
s_add_u32 s12, s12, 4104
buffer_load_ushort v28, v3, s[4:7], s12 offen
buffer_load_ushort v44, v3, s[8:11], s12 offen
s_add_u32 s12, s12, 4104
buffer_load_ushort v29, v3, s[4:7], s12 offen
buffer_load_ushort v45, v3, s[8:11], s12 offen
s_add_u32 s12, s12, 4104
buffer_load_ushort v30, v3, s[4:7], s12 offen
buffer_load_ushort v46, v3, s[8:11], s12 offen
s_add_u32 s12, s12, 4104
buffer_load_ushort v31, v3, s[4:7], s12 offen
buffer_load_ushort v47, v3, s[8:11], s12 offen
s_add_u32 s12, s12, 4104
s_barrier
ds_write_b32 v4, v48 offset:0
ds_write_b32 v4, v49 offset:16
ds_write_b32 v4, v50 offset:32
ds_write_b32 v4, v51 offset:48
ds_write_b32 v4, v52 offset:64
ds_write_b32 v4, v53 offset:80
ds_write_b32 v4, v54 offset:96
ds_write_b32 v4, v55 offset:112
ds_write_b32 v4, v56 offset:128
ds_write_b32 v4, v57 offset:144
ds_write_b32 v4, v58 offset:160
ds_write_b32 v4, v59 offset:176
s_waitcnt lgkmcnt(4)
ds_write_b32 v4, v60 offset:192
ds_write_b32 v4, v61 offset:208
ds_write_b32 v4, v62 offset:224
ds_write_b32 v4, v63 offset:240
s_waitcnt lgkmcnt(0)
s_barrier
ds_read2_b32 v[64:65], v5 offset0:0 offset1:1
ds_read_b32 v66, v5 offset:8
ds_read_b32 v67, v5 offset:12
ds_read_b32 v68, v5 offset:4160
ds_read_b32 v69, v5 offset:4164
ds_read_b32 v70, v5 offset:4168
ds_read_b32 v71, v5 offset:4172
ds_read_b32 v72, v5 offset:8320
ds_read_b32 v73, v5 offset:8324
ds_read_b32 v74, v5 offset:8328
ds_read_b32 v75, v5 offset:8332
ds_read_b32 v76, v5 offset:12480
ds_read_b32 v77, v5 offset:12484
ds_read_b32 v78, v5 offset:12488
ds_read_b32 v79, v5 offset:12492
s_and_b32 s14, s93, 31
s_lshl_b32 s14, s14, 8
s_lshr_b32 s15, s93, 5
s_lshr_b32 s23, s15, 1
s_xnor_b32 s23, s23, s98
s_and_b32 s23, s23, 1
s_lshl_b32 s23, s23, 13
s_mul_i32 s15, s15, 1048576
s_add_u32 s15, s15, 0
s_add_u32 s15, s15, s23
s_add_u32 s14, s14, s15
s_waitcnt lgkmcnt(0)
buffer_store_dwordx4 v[64:67], v6, s[24:27], s14 offen sc1
s_add_u32 s14, s14, 262144
buffer_store_dwordx4 v[68:71], v6, s[24:27], s14 offen sc1
s_add_u32 s14, s14, 262144
buffer_store_dwordx4 v[72:75], v6, s[24:27], s14 offen sc1
s_add_u32 s14, s14, 262144
buffer_store_dwordx4 v[76:79], v6, s[24:27], s14 offen sc1
s_add_u32 s14, s14, 262144
s_mov_b32 s93, s21
s_cmp_lt_u32 s93, 288
s_cbranch_scc1 mega_kernel_f0_l
mega_kernel_f0_e:
v_and_b32 v3, 15, v0
v_lshlrev_b32 v3, 4, v3
s_branch mega_kernel_syd
mega_kernel_sydw:
s_sleep 4
mega_kernel_syd:
buffer_load_dword v2, v3, s[72:75], 0 offen sc1
s_waitcnt vmcnt(0)
mega_kernel_sydp:
s_cmp_eq_u32 s95, 1
s_cbranch_scc0 mega_kernel_sydf
v_readlane_b32 s76, v2, 14
s_mov_b32 s98, 0
s_cmp_eq_u32 s76, 32
s_cbranch_scc0 mega_kernel_sydw
s_branch mega_kernel_sydd
mega_kernel_sydf:
s_mov_b32 s77, 0
s_mov_b32 s78, 0
v_readlane_b32 s76, v2, 0
s_add_u32 s77, s77, s76
s_xor_b32 s76, s76, 32
s_or_b32 s78, s78, s76
v_readlane_b32 s76, v2, 1
s_add_u32 s77, s77, s76
s_xor_b32 s76, s76, 32
s_or_b32 s78, s78, s76
v_readlane_b32 s76, v2, 2
s_add_u32 s77, s77, s76
s_xor_b32 s76, s76, 32
s_or_b32 s78, s78, s76
v_readlane_b32 s76, v2, 3
s_add_u32 s77, s77, s76
s_xor_b32 s76, s76, 32
s_or_b32 s78, s78, s76
v_readlane_b32 s76, v2, 4
s_add_u32 s77, s77, s76
s_xor_b32 s76, s76, 32
s_or_b32 s78, s78, s76
v_readlane_b32 s76, v2, 5
s_add_u32 s77, s77, s76
s_xor_b32 s76, s76, 32
s_or_b32 s78, s78, s76
v_readlane_b32 s76, v2, 6
s_add_u32 s77, s77, s76
s_xor_b32 s76, s76, 32
s_or_b32 s78, s78, s76
v_readlane_b32 s76, v2, 7
s_add_u32 s77, s77, s76
s_xor_b32 s76, s76, 32
s_or_b32 s78, s78, s76
s_cmp_eq_u32 s77, 256
s_cbranch_scc0 mega_kernel_sydw
v_mov_b32 v252, v2
s_cmp_eq_u32 s78, 0
s_cbranch_scc0 mega_kernel_slowent
v_readlane_b32 s76, v2, 10
v_readlane_b32 s77, v2, 8
s_cmp_eq_u32 s76, 32
s_cbranch_scc0 mega_kernel_sydw
s_cmp_gt_u32 s77, 16
s_cselect_b32 s98, 1, 0
mega_kernel_sydd:
s_waitcnt vmcnt(0)
s_barrier
v_mov_b32 v1, 0
v_mov_b32 v2, 1
s_mov_b32 s82, 69259264
v_cmp_eq_u32 vcc, 0, v0
s_and_saveexec_b64 s[80:81], vcc
s_cbranch_execz mega_kernel_sg0
buffer_atomic_add v2, v1, s[84:87], s82 offen sc1
mega_kernel_sg0:
s_mov_b64 exec, s[80:81]
s_add_u32 s38, s40, 129
s_mov_b32 s39, 32
s_mov_b32 s37, 129
s_cmp_lt_u32 s38, 129
s_cbranch_scc1 mega_kernel_f2s
s_branch mega_kernel_f2e
mega_kernel_rk:
s_load_dwordx2 s[4:5], s[0:1], 24
s_load_dwordx2 s[8:9], s[0:1], 0
v_lshrrev_b32 v2, 6, v0
v_and_b32 v1, 63, v0
v_readfirstlane_b32 s41, v2
v_lshlrev_b32 v5, 4, v1
s_waitcnt lgkmcnt(0)
s_mov_b32 s6, 8388608
s_mov_b32 s7, 0x00020000
s_mov_b32 s10, 4194304
s_mov_b32 s11, 0x00020000
s_lshl_b32 s43, s40, 8
s_lshl_b32 s44, s41, 6
s_add_u32 s48, s43, s44
s_and_b32 s43, s48, 0x7ff
v_add_u32 v19, s43, v1
v_lshlrev_b32 v19, 7, v19
s_mov_b32 s43, 0
buffer_load_dword v250, v19, s[8:11], s43 offen
s_nop 0
v_lshrrev_b32 v2, 3, v1
s_lshl_b32 s43, s41, 3
v_add_u32 v2, s43, v2
v_bfe_u32 v3, v2, 1, 3
v_and_b32 v4, 7, v1
v_xor_b32 v3, v3, v4
v_lshlrev_b32 v6, 11, v2
v_lshl_add_u32 v6, v3, 4, v6
s_lshl_b32 s46, s41, 10
v_and_b32 v2, 15, v1
v_bfe_u32 v3, v2, 1, 3
v_lshrrev_b32 v4, 4, v1
v_xor_b32 v3, v3, v4
v_lshlrev_b32 v8, 7, v2
v_lshl_add_u32 v8, v3, 4, v8
v_xor_b32 v9, 64, v8
v_add_u32 v10, 0x10000, v8
v_add_u32 v11, 0x10000, v9
v_mov_b32 v7, v5
s_lshl_b32 s47, s40, 2
s_add_u32 s47, s47, s41
s_mov_b32 s42, 0
s_mov_b32 s50, 0
s_add_u32 m0, s46, 0
s_nop 0
buffer_load_dwordx4 v6, s[8:11], s50 offen offset:0 lds
s_add_u32 m0, s46, 3968
s_nop 0
buffer_load_dwordx4 v6, s[8:11], s50 offen offset:128 lds
s_add_u32 m0, s46, 7936
s_nop 0
buffer_load_dwordx4 v6, s[8:11], s50 offen offset:256 lds
s_add_u32 m0, s46, 11904
s_nop 0
buffer_load_dwordx4 v6, s[8:11], s50 offen offset:384 lds
s_add_u32 m0, s46, 15872
s_nop 0
buffer_load_dwordx4 v6, s[8:11], s50 offen offset:512 lds
s_add_u32 m0, s46, 19840
s_nop 0
buffer_load_dwordx4 v6, s[8:11], s50 offen offset:640 lds
s_add_u32 m0, s46, 23808
s_nop 0
buffer_load_dwordx4 v6, s[8:11], s50 offen offset:768 lds
s_add_u32 m0, s46, 27776
s_nop 0
buffer_load_dwordx4 v6, s[8:11], s50 offen offset:896 lds
s_add_u32 m0, s46, 31744
s_nop 0
buffer_load_dwordx4 v6, s[8:11], s50 offen offset:1024 lds
s_add_u32 m0, s46, 35712
s_nop 0
buffer_load_dwordx4 v6, s[8:11], s50 offen offset:1152 lds
s_add_u32 m0, s46, 39680
s_nop 0
buffer_load_dwordx4 v6, s[8:11], s50 offen offset:1280 lds
s_add_u32 m0, s46, 43648
s_nop 0
buffer_load_dwordx4 v6, s[8:11], s50 offen offset:1408 lds
s_add_u32 m0, s46, 47616
s_nop 0
buffer_load_dwordx4 v6, s[8:11], s50 offen offset:1536 lds
s_add_u32 m0, s46, 51584
s_nop 0
buffer_load_dwordx4 v6, s[8:11], s50 offen offset:1664 lds
s_add_u32 m0, s46, 55552
s_nop 0
buffer_load_dwordx4 v6, s[8:11], s50 offen offset:1792 lds
s_add_u32 m0, s46, 59520
s_nop 0
buffer_load_dwordx4 v6, s[8:11], s50 offen offset:1920 lds
v_lshrrev_b32 v2, 2, v1
v_and_b32 v3, 3, v1
v_lshlrev_b32 v16, 13, v2
v_lshl_add_u32 v16, v3, 4, v16
v_add_u32 v16, s48, v16
s_mul_i32 s45, s41, 24576
s_add_u32 s45, s45, 65536
v_bfe_u32 v17, v1, 2, 2
v_lshrrev_b32 v18, 4, v1
v_lshl_add_u32 v17, v18, 3, v17
v_lshlrev_b32 v17, 6, v17
v_lshl_add_u32 v17, v3, 4, v17
v_add_u32 v17, s45, v17
s_and_b32 s43, s40, 3
s_lshl_b32 s43, s43, 2
s_add_u32 s43, s43, s41
s_lshl_b32 s43, s43, 3
v_and_b32 v12, 7, v1
v_add_u32 v12, s43, v12
s_lshr_b32 s43, s40, 2
s_lshl_b32 s43, s43, 10
s_add_u32 s44, s43, 896
s_add_u32 s43, s43, 384
s_cmp_ge_u32 s40, 28
s_cselect_b32 s44, s44, s43
v_mov_b32 v13, s43
v_mov_b32 v14, s44
v_cmp_gt_u32 vcc, 32, v1
s_nop 1
v_cndmask_b32 v13, v14, v13, vcc
v_lshl_add_u32 v12, v12, 13, v13
s_mov_b32 s44, 0
buffer_load_dword v250, v12, s[4:7], s44 offen
s_add_u32 m0, s45, 0
s_mov_b32 s44, 0
buffer_load_dwordx4 v16, s[4:7], s44 offen lds
s_add_u32 m0, s45, 1024
s_mov_b32 s44, 131072
buffer_load_dwordx4 v16, s[4:7], s44 offen lds
s_add_u32 m0, s45, 2048
s_mov_b32 s44, 262144
buffer_load_dwordx4 v16, s[4:7], s44 offen lds
s_add_u32 m0, s45, 3072
s_mov_b32 s44, 393216
buffer_load_dwordx4 v16, s[4:7], s44 offen lds
s_add_u32 m0, s45, 4096
s_mov_b32 s44, 524288
buffer_load_dwordx4 v16, s[4:7], s44 offen lds
s_add_u32 m0, s45, 5120
s_mov_b32 s44, 655360
buffer_load_dwordx4 v16, s[4:7], s44 offen lds
s_add_u32 m0, s45, 6144
s_mov_b32 s44, 786432
buffer_load_dwordx4 v16, s[4:7], s44 offen lds
s_add_u32 m0, s45, 7168
s_mov_b32 s44, 917504
buffer_load_dwordx4 v16, s[4:7], s44 offen lds
s_mov_b32 s44, 1048576
buffer_load_dword v250, v12, s[4:7], s44 offen
s_add_u32 m0, s45, 8192
s_mov_b32 s44, 1048576
buffer_load_dwordx4 v16, s[4:7], s44 offen lds
s_add_u32 m0, s45, 9216
s_mov_b32 s44, 1179648
buffer_load_dwordx4 v16, s[4:7], s44 offen lds
s_add_u32 m0, s45, 10240
s_mov_b32 s44, 1310720
buffer_load_dwordx4 v16, s[4:7], s44 offen lds
s_add_u32 m0, s45, 11264
s_mov_b32 s44, 1441792
buffer_load_dwordx4 v16, s[4:7], s44 offen lds
s_add_u32 m0, s45, 12288
s_mov_b32 s44, 1572864
buffer_load_dwordx4 v16, s[4:7], s44 offen lds
s_add_u32 m0, s45, 13312
s_mov_b32 s44, 1703936
buffer_load_dwordx4 v16, s[4:7], s44 offen lds
s_add_u32 m0, s45, 14336
s_mov_b32 s44, 1835008
buffer_load_dwordx4 v16, s[4:7], s44 offen lds
s_add_u32 m0, s45, 15360
s_mov_b32 s44, 1966080
buffer_load_dwordx4 v16, s[4:7], s44 offen lds
s_mov_b32 s44, 2097152
buffer_load_dword v250, v12, s[4:7], s44 offen
s_add_u32 m0, s45, 16384
s_mov_b32 s44, 2097152
buffer_load_dwordx4 v16, s[4:7], s44 offen lds
s_add_u32 m0, s45, 17408
s_mov_b32 s44, 2228224
buffer_load_dwordx4 v16, s[4:7], s44 offen lds
s_add_u32 m0, s45, 18432
s_mov_b32 s44, 2359296
buffer_load_dwordx4 v16, s[4:7], s44 offen lds
s_add_u32 m0, s45, 19456
s_mov_b32 s44, 2490368
buffer_load_dwordx4 v16, s[4:7], s44 offen lds
s_add_u32 m0, s45, 20480
s_mov_b32 s44, 2621440
buffer_load_dwordx4 v16, s[4:7], s44 offen lds
s_add_u32 m0, s45, 21504
s_mov_b32 s44, 2752512
buffer_load_dwordx4 v16, s[4:7], s44 offen lds
s_add_u32 m0, s45, 22528
s_mov_b32 s44, 2883584
buffer_load_dwordx4 v16, s[4:7], s44 offen lds
s_add_u32 m0, s45, 23552
s_mov_b32 s44, 3014656
buffer_load_dwordx4 v16, s[4:7], s44 offen lds
s_waitcnt vmcnt(18)
s_barrier
ds_read_b64_tr_b16 a[0:1], v17 offset:0
ds_read_b64_tr_b16 a[2:3], v17 offset:256
ds_read_b64_tr_b16 a[4:5], v17 offset:8
ds_read_b64_tr_b16 a[6:7], v17 offset:264
ds_read_b64_tr_b16 a[8:9], v17 offset:2048
ds_read_b64_tr_b16 a[10:11], v17 offset:2304
ds_read_b64_tr_b16 a[12:13], v17 offset:2056
ds_read_b64_tr_b16 a[14:15], v17 offset:2312
s_waitcnt lgkmcnt(0)
ds_read_b64_tr_b16 a[16:17], v17 offset:4096
ds_read_b64_tr_b16 a[18:19], v17 offset:4352
ds_read_b64_tr_b16 a[20:21], v17 offset:4104
ds_read_b64_tr_b16 a[22:23], v17 offset:4360
ds_read_b64_tr_b16 a[24:25], v17 offset:6144
ds_read_b64_tr_b16 a[26:27], v17 offset:6400
ds_read_b64_tr_b16 a[28:29], v17 offset:6152
ds_read_b64_tr_b16 a[30:31], v17 offset:6408
s_waitcnt lgkmcnt(0)
s_mov_b32 s44, 3145728
buffer_load_dword v250, v12, s[4:7], s44 offen
s_add_u32 m0, s45, 0
s_mov_b32 s44, 3145728
buffer_load_dwordx4 v16, s[4:7], s44 offen lds
s_add_u32 m0, s45, 1024
s_mov_b32 s44, 3276800
buffer_load_dwordx4 v16, s[4:7], s44 offen lds
s_add_u32 m0, s45, 2048
s_mov_b32 s44, 3407872
buffer_load_dwordx4 v16, s[4:7], s44 offen lds
s_add_u32 m0, s45, 3072
s_mov_b32 s44, 3538944
buffer_load_dwordx4 v16, s[4:7], s44 offen lds
s_add_u32 m0, s45, 4096
s_mov_b32 s44, 3670016
buffer_load_dwordx4 v16, s[4:7], s44 offen lds
s_add_u32 m0, s45, 5120
s_mov_b32 s44, 3801088
buffer_load_dwordx4 v16, s[4:7], s44 offen lds
s_add_u32 m0, s45, 6144
s_mov_b32 s44, 3932160
buffer_load_dwordx4 v16, s[4:7], s44 offen lds
s_add_u32 m0, s45, 7168
s_mov_b32 s44, 4063232
buffer_load_dwordx4 v16, s[4:7], s44 offen lds
ds_read_b128 v[20:23], v8 offset:0
ds_read_b128 v[24:27], v8 offset:2048
ds_read_b128 v[28:31], v9 offset:0
ds_read_b128 v[32:35], v9 offset:2048
ds_read_b128 v[36:39], v8 offset:4096
ds_read_b128 v[40:43], v8 offset:6144
ds_read_b128 v[44:47], v9 offset:4096
ds_read_b128 v[48:51], v9 offset:6144
s_waitcnt lgkmcnt(0)
v_mfma_f32_16x16x32_bf16 v[52:55], a[0:3], v[20:23], 0
v_mfma_f32_16x16x32_bf16 v[56:59], a[4:7], v[20:23], 0
v_mfma_f32_16x16x32_bf16 v[60:63], a[0:3], v[24:27], 0
v_mfma_f32_16x16x32_bf16 v[64:67], a[4:7], v[24:27], 0
v_mfma_f32_16x16x32_bf16 v[52:55], a[8:11], v[28:31], v[52:55]
v_mfma_f32_16x16x32_bf16 v[56:59], a[12:15], v[28:31], v[56:59]
v_mfma_f32_16x16x32_bf16 v[60:63], a[8:11], v[32:35], v[60:63]
v_mfma_f32_16x16x32_bf16 v[64:67], a[12:15], v[32:35], v[64:67]
v_mfma_f32_16x16x32_bf16 v[52:55], a[16:19], v[36:39], v[52:55]
v_mfma_f32_16x16x32_bf16 v[56:59], a[20:23], v[36:39], v[56:59]
v_mfma_f32_16x16x32_bf16 v[60:63], a[16:19], v[40:43], v[60:63]
v_mfma_f32_16x16x32_bf16 v[64:67], a[20:23], v[40:43], v[64:67]
v_mfma_f32_16x16x32_bf16 v[52:55], a[24:27], v[44:47], v[52:55]
v_mfma_f32_16x16x32_bf16 v[56:59], a[28:31], v[44:47], v[56:59]
v_mfma_f32_16x16x32_bf16 v[60:63], a[24:27], v[48:51], v[60:63]
v_mfma_f32_16x16x32_bf16 v[64:67], a[28:31], v[48:51], v[64:67]
s_waitcnt vmcnt(18)
ds_read_b64_tr_b16 a[32:33], v17 offset:8192
ds_read_b64_tr_b16 a[34:35], v17 offset:8448
ds_read_b64_tr_b16 a[36:37], v17 offset:8200
ds_read_b64_tr_b16 a[38:39], v17 offset:8456
ds_read_b64_tr_b16 a[40:41], v17 offset:10240
ds_read_b64_tr_b16 a[42:43], v17 offset:10496
ds_read_b64_tr_b16 a[44:45], v17 offset:10248
ds_read_b64_tr_b16 a[46:47], v17 offset:10504
s_waitcnt lgkmcnt(0)
ds_read_b64_tr_b16 a[48:49], v17 offset:12288
ds_read_b64_tr_b16 a[50:51], v17 offset:12544
ds_read_b64_tr_b16 a[52:53], v17 offset:12296
ds_read_b64_tr_b16 a[54:55], v17 offset:12552
ds_read_b64_tr_b16 a[56:57], v17 offset:14336
ds_read_b64_tr_b16 a[58:59], v17 offset:14592
ds_read_b64_tr_b16 a[60:61], v17 offset:14344
ds_read_b64_tr_b16 a[62:63], v17 offset:14600
s_waitcnt lgkmcnt(0)
s_mov_b32 s44, 4194304
buffer_load_dword v250, v12, s[4:7], s44 offen
s_add_u32 m0, s45, 8192
s_mov_b32 s44, 4194304
buffer_load_dwordx4 v16, s[4:7], s44 offen lds
s_add_u32 m0, s45, 9216
s_mov_b32 s44, 4325376
buffer_load_dwordx4 v16, s[4:7], s44 offen lds
s_add_u32 m0, s45, 10240
s_mov_b32 s44, 4456448
buffer_load_dwordx4 v16, s[4:7], s44 offen lds
s_add_u32 m0, s45, 11264
s_mov_b32 s44, 4587520
buffer_load_dwordx4 v16, s[4:7], s44 offen lds
s_add_u32 m0, s45, 12288
s_mov_b32 s44, 4718592
buffer_load_dwordx4 v16, s[4:7], s44 offen lds
s_add_u32 m0, s45, 13312
s_mov_b32 s44, 4849664
buffer_load_dwordx4 v16, s[4:7], s44 offen lds
s_add_u32 m0, s45, 14336
s_mov_b32 s44, 4980736
buffer_load_dwordx4 v16, s[4:7], s44 offen lds
s_add_u32 m0, s45, 15360
s_mov_b32 s44, 5111808
buffer_load_dwordx4 v16, s[4:7], s44 offen lds
ds_read_b128 v[20:23], v8 offset:8192
ds_read_b128 v[24:27], v8 offset:10240
ds_read_b128 v[28:31], v9 offset:8192
ds_read_b128 v[32:35], v9 offset:10240
ds_read_b128 v[36:39], v8 offset:12288
ds_read_b128 v[40:43], v8 offset:14336
ds_read_b128 v[44:47], v9 offset:12288
ds_read_b128 v[48:51], v9 offset:14336
s_waitcnt lgkmcnt(0)
v_mfma_f32_16x16x32_bf16 v[52:55], a[32:35], v[20:23], v[52:55]
v_mfma_f32_16x16x32_bf16 v[56:59], a[36:39], v[20:23], v[56:59]
v_mfma_f32_16x16x32_bf16 v[60:63], a[32:35], v[24:27], v[60:63]
v_mfma_f32_16x16x32_bf16 v[64:67], a[36:39], v[24:27], v[64:67]
v_mfma_f32_16x16x32_bf16 v[52:55], a[40:43], v[28:31], v[52:55]
v_mfma_f32_16x16x32_bf16 v[56:59], a[44:47], v[28:31], v[56:59]
v_mfma_f32_16x16x32_bf16 v[60:63], a[40:43], v[32:35], v[60:63]
v_mfma_f32_16x16x32_bf16 v[64:67], a[44:47], v[32:35], v[64:67]
v_mfma_f32_16x16x32_bf16 v[52:55], a[48:51], v[36:39], v[52:55]
v_mfma_f32_16x16x32_bf16 v[56:59], a[52:55], v[36:39], v[56:59]
v_mfma_f32_16x16x32_bf16 v[60:63], a[48:51], v[40:43], v[60:63]
v_mfma_f32_16x16x32_bf16 v[64:67], a[52:55], v[40:43], v[64:67]
v_mfma_f32_16x16x32_bf16 v[52:55], a[56:59], v[44:47], v[52:55]
v_mfma_f32_16x16x32_bf16 v[56:59], a[60:63], v[44:47], v[56:59]
v_mfma_f32_16x16x32_bf16 v[60:63], a[56:59], v[48:51], v[60:63]
v_mfma_f32_16x16x32_bf16 v[64:67], a[60:63], v[48:51], v[64:67]
s_waitcnt vmcnt(18)
ds_read_b64_tr_b16 a[64:65], v17 offset:16384
ds_read_b64_tr_b16 a[66:67], v17 offset:16640
ds_read_b64_tr_b16 a[68:69], v17 offset:16392
ds_read_b64_tr_b16 a[70:71], v17 offset:16648
ds_read_b64_tr_b16 a[72:73], v17 offset:18432
ds_read_b64_tr_b16 a[74:75], v17 offset:18688
ds_read_b64_tr_b16 a[76:77], v17 offset:18440
ds_read_b64_tr_b16 a[78:79], v17 offset:18696
s_waitcnt lgkmcnt(0)
ds_read_b64_tr_b16 a[80:81], v17 offset:20480
ds_read_b64_tr_b16 a[82:83], v17 offset:20736
ds_read_b64_tr_b16 a[84:85], v17 offset:20488
ds_read_b64_tr_b16 a[86:87], v17 offset:20744
ds_read_b64_tr_b16 a[88:89], v17 offset:22528
ds_read_b64_tr_b16 a[90:91], v17 offset:22784
ds_read_b64_tr_b16 a[92:93], v17 offset:22536
ds_read_b64_tr_b16 a[94:95], v17 offset:22792
s_waitcnt lgkmcnt(0)
s_mov_b32 s44, 5242880
buffer_load_dword v250, v12, s[4:7], s44 offen
s_add_u32 m0, s45, 16384
s_mov_b32 s44, 5242880
buffer_load_dwordx4 v16, s[4:7], s44 offen lds
s_add_u32 m0, s45, 17408
s_mov_b32 s44, 5373952
buffer_load_dwordx4 v16, s[4:7], s44 offen lds
s_add_u32 m0, s45, 18432
s_mov_b32 s44, 5505024
buffer_load_dwordx4 v16, s[4:7], s44 offen lds
s_add_u32 m0, s45, 19456
s_mov_b32 s44, 5636096
buffer_load_dwordx4 v16, s[4:7], s44 offen lds
s_add_u32 m0, s45, 20480
s_mov_b32 s44, 5767168
buffer_load_dwordx4 v16, s[4:7], s44 offen lds
s_add_u32 m0, s45, 21504
s_mov_b32 s44, 5898240
buffer_load_dwordx4 v16, s[4:7], s44 offen lds
s_add_u32 m0, s45, 22528
s_mov_b32 s44, 6029312
buffer_load_dwordx4 v16, s[4:7], s44 offen lds
s_add_u32 m0, s45, 23552
s_mov_b32 s44, 6160384
buffer_load_dwordx4 v16, s[4:7], s44 offen lds
ds_read_b128 v[20:23], v8 offset:16384
ds_read_b128 v[24:27], v8 offset:18432
ds_read_b128 v[28:31], v9 offset:16384
ds_read_b128 v[32:35], v9 offset:18432
ds_read_b128 v[36:39], v8 offset:20480
ds_read_b128 v[40:43], v8 offset:22528
ds_read_b128 v[44:47], v9 offset:20480
ds_read_b128 v[48:51], v9 offset:22528
s_waitcnt lgkmcnt(0)
v_mfma_f32_16x16x32_bf16 v[52:55], a[64:67], v[20:23], v[52:55]
v_mfma_f32_16x16x32_bf16 v[56:59], a[68:71], v[20:23], v[56:59]
v_mfma_f32_16x16x32_bf16 v[60:63], a[64:67], v[24:27], v[60:63]
v_mfma_f32_16x16x32_bf16 v[64:67], a[68:71], v[24:27], v[64:67]
v_mfma_f32_16x16x32_bf16 v[52:55], a[72:75], v[28:31], v[52:55]
v_mfma_f32_16x16x32_bf16 v[56:59], a[76:79], v[28:31], v[56:59]
v_mfma_f32_16x16x32_bf16 v[60:63], a[72:75], v[32:35], v[60:63]
v_mfma_f32_16x16x32_bf16 v[64:67], a[76:79], v[32:35], v[64:67]
v_mfma_f32_16x16x32_bf16 v[52:55], a[80:83], v[36:39], v[52:55]
v_mfma_f32_16x16x32_bf16 v[56:59], a[84:87], v[36:39], v[56:59]
v_mfma_f32_16x16x32_bf16 v[60:63], a[80:83], v[40:43], v[60:63]
v_mfma_f32_16x16x32_bf16 v[64:67], a[84:87], v[40:43], v[64:67]
v_mfma_f32_16x16x32_bf16 v[52:55], a[88:91], v[44:47], v[52:55]
v_mfma_f32_16x16x32_bf16 v[56:59], a[92:95], v[44:47], v[56:59]
v_mfma_f32_16x16x32_bf16 v[60:63], a[88:91], v[48:51], v[60:63]
v_mfma_f32_16x16x32_bf16 v[64:67], a[92:95], v[48:51], v[64:67]
s_waitcnt vmcnt(18)
ds_read_b64_tr_b16 a[96:97], v17 offset:0
ds_read_b64_tr_b16 a[98:99], v17 offset:256
ds_read_b64_tr_b16 a[100:101], v17 offset:8
ds_read_b64_tr_b16 a[102:103], v17 offset:264
ds_read_b64_tr_b16 a[104:105], v17 offset:2048
ds_read_b64_tr_b16 a[106:107], v17 offset:2304
ds_read_b64_tr_b16 a[108:109], v17 offset:2056
ds_read_b64_tr_b16 a[110:111], v17 offset:2312
s_waitcnt lgkmcnt(0)
ds_read_b64_tr_b16 a[112:113], v17 offset:4096
ds_read_b64_tr_b16 a[114:115], v17 offset:4352
ds_read_b64_tr_b16 a[116:117], v17 offset:4104
ds_read_b64_tr_b16 a[118:119], v17 offset:4360
ds_read_b64_tr_b16 a[120:121], v17 offset:6144
ds_read_b64_tr_b16 a[122:123], v17 offset:6400
ds_read_b64_tr_b16 a[124:125], v17 offset:6152
ds_read_b64_tr_b16 a[126:127], v17 offset:6408
s_waitcnt lgkmcnt(0)
s_mov_b32 s44, 6291456
buffer_load_dword v250, v12, s[4:7], s44 offen
s_add_u32 m0, s45, 0
s_mov_b32 s44, 6291456
buffer_load_dwordx4 v16, s[4:7], s44 offen lds
s_add_u32 m0, s45, 1024
s_mov_b32 s44, 6422528
buffer_load_dwordx4 v16, s[4:7], s44 offen lds
s_add_u32 m0, s45, 2048
s_mov_b32 s44, 6553600
buffer_load_dwordx4 v16, s[4:7], s44 offen lds
s_add_u32 m0, s45, 3072
s_mov_b32 s44, 6684672
buffer_load_dwordx4 v16, s[4:7], s44 offen lds
s_add_u32 m0, s45, 4096
s_mov_b32 s44, 6815744
buffer_load_dwordx4 v16, s[4:7], s44 offen lds
s_add_u32 m0, s45, 5120
s_mov_b32 s44, 6946816
buffer_load_dwordx4 v16, s[4:7], s44 offen lds
s_add_u32 m0, s45, 6144
s_mov_b32 s44, 7077888
buffer_load_dwordx4 v16, s[4:7], s44 offen lds
s_add_u32 m0, s45, 7168
s_mov_b32 s44, 7208960
buffer_load_dwordx4 v16, s[4:7], s44 offen lds
ds_read_b128 v[20:23], v8 offset:24576
ds_read_b128 v[24:27], v8 offset:26624
ds_read_b128 v[28:31], v9 offset:24576
ds_read_b128 v[32:35], v9 offset:26624
ds_read_b128 v[36:39], v8 offset:28672
ds_read_b128 v[40:43], v8 offset:30720
ds_read_b128 v[44:47], v9 offset:28672
ds_read_b128 v[48:51], v9 offset:30720
s_waitcnt lgkmcnt(0)
v_mfma_f32_16x16x32_bf16 v[52:55], a[96:99], v[20:23], v[52:55]
v_mfma_f32_16x16x32_bf16 v[56:59], a[100:103], v[20:23], v[56:59]
v_mfma_f32_16x16x32_bf16 v[60:63], a[96:99], v[24:27], v[60:63]
v_mfma_f32_16x16x32_bf16 v[64:67], a[100:103], v[24:27], v[64:67]
v_mfma_f32_16x16x32_bf16 v[52:55], a[104:107], v[28:31], v[52:55]
v_mfma_f32_16x16x32_bf16 v[56:59], a[108:111], v[28:31], v[56:59]
v_mfma_f32_16x16x32_bf16 v[60:63], a[104:107], v[32:35], v[60:63]
v_mfma_f32_16x16x32_bf16 v[64:67], a[108:111], v[32:35], v[64:67]
v_mfma_f32_16x16x32_bf16 v[52:55], a[112:115], v[36:39], v[52:55]
v_mfma_f32_16x16x32_bf16 v[56:59], a[116:119], v[36:39], v[56:59]
v_mfma_f32_16x16x32_bf16 v[60:63], a[112:115], v[40:43], v[60:63]
v_mfma_f32_16x16x32_bf16 v[64:67], a[116:119], v[40:43], v[64:67]
v_mfma_f32_16x16x32_bf16 v[52:55], a[120:123], v[44:47], v[52:55]
v_mfma_f32_16x16x32_bf16 v[56:59], a[124:127], v[44:47], v[56:59]
v_mfma_f32_16x16x32_bf16 v[60:63], a[120:123], v[48:51], v[60:63]
v_mfma_f32_16x16x32_bf16 v[64:67], a[124:127], v[48:51], v[64:67]
s_waitcnt vmcnt(18)
ds_read_b64_tr_b16 a[128:129], v17 offset:8192
ds_read_b64_tr_b16 a[130:131], v17 offset:8448
ds_read_b64_tr_b16 a[132:133], v17 offset:8200
ds_read_b64_tr_b16 a[134:135], v17 offset:8456
ds_read_b64_tr_b16 a[136:137], v17 offset:10240
ds_read_b64_tr_b16 a[138:139], v17 offset:10496
ds_read_b64_tr_b16 a[140:141], v17 offset:10248
ds_read_b64_tr_b16 a[142:143], v17 offset:10504
s_waitcnt lgkmcnt(0)
ds_read_b64_tr_b16 a[144:145], v17 offset:12288
ds_read_b64_tr_b16 a[146:147], v17 offset:12544
ds_read_b64_tr_b16 a[148:149], v17 offset:12296
ds_read_b64_tr_b16 a[150:151], v17 offset:12552
ds_read_b64_tr_b16 a[152:153], v17 offset:14336
ds_read_b64_tr_b16 a[154:155], v17 offset:14592
ds_read_b64_tr_b16 a[156:157], v17 offset:14344
ds_read_b64_tr_b16 a[158:159], v17 offset:14600
s_waitcnt lgkmcnt(0)
s_mov_b32 s44, 7340032
buffer_load_dword v250, v12, s[4:7], s44 offen
s_add_u32 m0, s45, 8192
s_mov_b32 s44, 7340032
buffer_load_dwordx4 v16, s[4:7], s44 offen lds
s_add_u32 m0, s45, 9216
s_mov_b32 s44, 7471104
buffer_load_dwordx4 v16, s[4:7], s44 offen lds
s_add_u32 m0, s45, 10240
s_mov_b32 s44, 7602176
buffer_load_dwordx4 v16, s[4:7], s44 offen lds
s_add_u32 m0, s45, 11264
s_mov_b32 s44, 7733248
buffer_load_dwordx4 v16, s[4:7], s44 offen lds
s_add_u32 m0, s45, 12288
s_mov_b32 s44, 7864320
buffer_load_dwordx4 v16, s[4:7], s44 offen lds
s_add_u32 m0, s45, 13312
s_mov_b32 s44, 7995392
buffer_load_dwordx4 v16, s[4:7], s44 offen lds
s_add_u32 m0, s45, 14336
s_mov_b32 s44, 8126464
buffer_load_dwordx4 v16, s[4:7], s44 offen lds
s_add_u32 m0, s45, 15360
s_mov_b32 s44, 8257536
buffer_load_dwordx4 v16, s[4:7], s44 offen lds
ds_read_b128 v[20:23], v8 offset:32768
ds_read_b128 v[24:27], v8 offset:34816
ds_read_b128 v[28:31], v9 offset:32768
ds_read_b128 v[32:35], v9 offset:34816
ds_read_b128 v[36:39], v8 offset:36864
ds_read_b128 v[40:43], v8 offset:38912
ds_read_b128 v[44:47], v9 offset:36864
ds_read_b128 v[48:51], v9 offset:38912
s_waitcnt lgkmcnt(0)
v_mfma_f32_16x16x32_bf16 v[52:55], a[128:131], v[20:23], v[52:55]
v_mfma_f32_16x16x32_bf16 v[56:59], a[132:135], v[20:23], v[56:59]
v_mfma_f32_16x16x32_bf16 v[60:63], a[128:131], v[24:27], v[60:63]
v_mfma_f32_16x16x32_bf16 v[64:67], a[132:135], v[24:27], v[64:67]
v_mfma_f32_16x16x32_bf16 v[52:55], a[136:139], v[28:31], v[52:55]
v_mfma_f32_16x16x32_bf16 v[56:59], a[140:143], v[28:31], v[56:59]
v_mfma_f32_16x16x32_bf16 v[60:63], a[136:139], v[32:35], v[60:63]
v_mfma_f32_16x16x32_bf16 v[64:67], a[140:143], v[32:35], v[64:67]
v_mfma_f32_16x16x32_bf16 v[52:55], a[144:147], v[36:39], v[52:55]
v_mfma_f32_16x16x32_bf16 v[56:59], a[148:151], v[36:39], v[56:59]
v_mfma_f32_16x16x32_bf16 v[60:63], a[144:147], v[40:43], v[60:63]
v_mfma_f32_16x16x32_bf16 v[64:67], a[148:151], v[40:43], v[64:67]
v_mfma_f32_16x16x32_bf16 v[52:55], a[152:155], v[44:47], v[52:55]
v_mfma_f32_16x16x32_bf16 v[56:59], a[156:159], v[44:47], v[56:59]
v_mfma_f32_16x16x32_bf16 v[60:63], a[152:155], v[48:51], v[60:63]
v_mfma_f32_16x16x32_bf16 v[64:67], a[156:159], v[48:51], v[64:67]
s_waitcnt vmcnt(18)
ds_read_b64_tr_b16 a[160:161], v17 offset:16384
ds_read_b64_tr_b16 a[162:163], v17 offset:16640
ds_read_b64_tr_b16 a[164:165], v17 offset:16392
ds_read_b64_tr_b16 a[166:167], v17 offset:16648
ds_read_b64_tr_b16 a[168:169], v17 offset:18432
ds_read_b64_tr_b16 a[170:171], v17 offset:18688
ds_read_b64_tr_b16 a[172:173], v17 offset:18440
ds_read_b64_tr_b16 a[174:175], v17 offset:18696
s_waitcnt lgkmcnt(0)
ds_read_b64_tr_b16 a[176:177], v17 offset:20480
ds_read_b64_tr_b16 a[178:179], v17 offset:20736
ds_read_b64_tr_b16 a[180:181], v17 offset:20488
ds_read_b64_tr_b16 a[182:183], v17 offset:20744
ds_read_b64_tr_b16 a[184:185], v17 offset:22528
ds_read_b64_tr_b16 a[186:187], v17 offset:22784
ds_read_b64_tr_b16 a[188:189], v17 offset:22536
ds_read_b64_tr_b16 a[190:191], v17 offset:22792
s_waitcnt lgkmcnt(0)
ds_read_b128 v[20:23], v8 offset:40960
ds_read_b128 v[24:27], v8 offset:43008
ds_read_b128 v[28:31], v9 offset:40960
ds_read_b128 v[32:35], v9 offset:43008
ds_read_b128 v[36:39], v8 offset:45056
ds_read_b128 v[40:43], v8 offset:47104
ds_read_b128 v[44:47], v9 offset:45056
ds_read_b128 v[48:51], v9 offset:47104
s_waitcnt lgkmcnt(0)
v_mfma_f32_16x16x32_bf16 v[52:55], a[160:163], v[20:23], v[52:55]
v_mfma_f32_16x16x32_bf16 v[56:59], a[164:167], v[20:23], v[56:59]
v_mfma_f32_16x16x32_bf16 v[60:63], a[160:163], v[24:27], v[60:63]
v_mfma_f32_16x16x32_bf16 v[64:67], a[164:167], v[24:27], v[64:67]
v_mfma_f32_16x16x32_bf16 v[52:55], a[168:171], v[28:31], v[52:55]
v_mfma_f32_16x16x32_bf16 v[56:59], a[172:175], v[28:31], v[56:59]
v_mfma_f32_16x16x32_bf16 v[60:63], a[168:171], v[32:35], v[60:63]
v_mfma_f32_16x16x32_bf16 v[64:67], a[172:175], v[32:35], v[64:67]
v_mfma_f32_16x16x32_bf16 v[52:55], a[176:179], v[36:39], v[52:55]
v_mfma_f32_16x16x32_bf16 v[56:59], a[180:183], v[36:39], v[56:59]
v_mfma_f32_16x16x32_bf16 v[60:63], a[176:179], v[40:43], v[60:63]
v_mfma_f32_16x16x32_bf16 v[64:67], a[180:183], v[40:43], v[64:67]
v_mfma_f32_16x16x32_bf16 v[52:55], a[184:187], v[44:47], v[52:55]
v_mfma_f32_16x16x32_bf16 v[56:59], a[188:191], v[44:47], v[56:59]
v_mfma_f32_16x16x32_bf16 v[60:63], a[184:187], v[48:51], v[60:63]
v_mfma_f32_16x16x32_bf16 v[64:67], a[188:191], v[48:51], v[64:67]
s_waitcnt vmcnt(9)
ds_read_b64_tr_b16 a[192:193], v17 offset:0
ds_read_b64_tr_b16 a[194:195], v17 offset:256
ds_read_b64_tr_b16 a[196:197], v17 offset:8
ds_read_b64_tr_b16 a[198:199], v17 offset:264
ds_read_b64_tr_b16 a[200:201], v17 offset:2048
ds_read_b64_tr_b16 a[202:203], v17 offset:2304
ds_read_b64_tr_b16 a[204:205], v17 offset:2056
ds_read_b64_tr_b16 a[206:207], v17 offset:2312
s_waitcnt lgkmcnt(0)
ds_read_b64_tr_b16 a[208:209], v17 offset:4096
ds_read_b64_tr_b16 a[210:211], v17 offset:4352
ds_read_b64_tr_b16 a[212:213], v17 offset:4104
ds_read_b64_tr_b16 a[214:215], v17 offset:4360
ds_read_b64_tr_b16 a[216:217], v17 offset:6144
ds_read_b64_tr_b16 a[218:219], v17 offset:6400
ds_read_b64_tr_b16 a[220:221], v17 offset:6152
ds_read_b64_tr_b16 a[222:223], v17 offset:6408
s_waitcnt lgkmcnt(0)
ds_read_b128 v[20:23], v8 offset:49152
ds_read_b128 v[24:27], v8 offset:51200
ds_read_b128 v[28:31], v9 offset:49152
ds_read_b128 v[32:35], v9 offset:51200
ds_read_b128 v[36:39], v8 offset:53248
ds_read_b128 v[40:43], v8 offset:55296
ds_read_b128 v[44:47], v9 offset:53248
ds_read_b128 v[48:51], v9 offset:55296
s_waitcnt lgkmcnt(0)
v_mfma_f32_16x16x32_bf16 v[52:55], a[192:195], v[20:23], v[52:55]
v_mfma_f32_16x16x32_bf16 v[56:59], a[196:199], v[20:23], v[56:59]
v_mfma_f32_16x16x32_bf16 v[60:63], a[192:195], v[24:27], v[60:63]
v_mfma_f32_16x16x32_bf16 v[64:67], a[196:199], v[24:27], v[64:67]
v_mfma_f32_16x16x32_bf16 v[52:55], a[200:203], v[28:31], v[52:55]
v_mfma_f32_16x16x32_bf16 v[56:59], a[204:207], v[28:31], v[56:59]
v_mfma_f32_16x16x32_bf16 v[60:63], a[200:203], v[32:35], v[60:63]
v_mfma_f32_16x16x32_bf16 v[64:67], a[204:207], v[32:35], v[64:67]
v_mfma_f32_16x16x32_bf16 v[52:55], a[208:211], v[36:39], v[52:55]
v_mfma_f32_16x16x32_bf16 v[56:59], a[212:215], v[36:39], v[56:59]
v_mfma_f32_16x16x32_bf16 v[60:63], a[208:211], v[40:43], v[60:63]
v_mfma_f32_16x16x32_bf16 v[64:67], a[212:215], v[40:43], v[64:67]
v_mfma_f32_16x16x32_bf16 v[52:55], a[216:219], v[44:47], v[52:55]
v_mfma_f32_16x16x32_bf16 v[56:59], a[220:223], v[44:47], v[56:59]
v_mfma_f32_16x16x32_bf16 v[60:63], a[216:219], v[48:51], v[60:63]
v_mfma_f32_16x16x32_bf16 v[64:67], a[220:223], v[48:51], v[64:67]
s_waitcnt vmcnt(0)
ds_read_b64_tr_b16 a[224:225], v17 offset:8192
ds_read_b64_tr_b16 a[226:227], v17 offset:8448
ds_read_b64_tr_b16 a[228:229], v17 offset:8200
ds_read_b64_tr_b16 a[230:231], v17 offset:8456
ds_read_b64_tr_b16 a[232:233], v17 offset:10240
ds_read_b64_tr_b16 a[234:235], v17 offset:10496
ds_read_b64_tr_b16 a[236:237], v17 offset:10248
ds_read_b64_tr_b16 a[238:239], v17 offset:10504
s_waitcnt lgkmcnt(0)
ds_read_b64_tr_b16 a[240:241], v17 offset:12288
ds_read_b64_tr_b16 a[242:243], v17 offset:12544
ds_read_b64_tr_b16 a[244:245], v17 offset:12296
ds_read_b64_tr_b16 a[246:247], v17 offset:12552
ds_read_b64_tr_b16 a[248:249], v17 offset:14336
ds_read_b64_tr_b16 a[250:251], v17 offset:14592
ds_read_b64_tr_b16 a[252:253], v17 offset:14344
ds_read_b64_tr_b16 a[254:255], v17 offset:14600
s_waitcnt lgkmcnt(0)
ds_read_b128 v[20:23], v8 offset:57344
ds_read_b128 v[24:27], v8 offset:59392
ds_read_b128 v[28:31], v9 offset:57344
ds_read_b128 v[32:35], v9 offset:59392
ds_read_b128 v[36:39], v8 offset:61440
ds_read_b128 v[40:43], v8 offset:63488
ds_read_b128 v[44:47], v9 offset:61440
ds_read_b128 v[48:51], v9 offset:63488
s_waitcnt lgkmcnt(0)
v_mfma_f32_16x16x32_bf16 v[52:55], a[224:227], v[20:23], v[52:55]
v_mfma_f32_16x16x32_bf16 v[56:59], a[228:231], v[20:23], v[56:59]
v_mfma_f32_16x16x32_bf16 v[60:63], a[224:227], v[24:27], v[60:63]
v_mfma_f32_16x16x32_bf16 v[64:67], a[228:231], v[24:27], v[64:67]
v_mfma_f32_16x16x32_bf16 v[52:55], a[232:235], v[28:31], v[52:55]
v_mfma_f32_16x16x32_bf16 v[56:59], a[236:239], v[28:31], v[56:59]
v_mfma_f32_16x16x32_bf16 v[60:63], a[232:235], v[32:35], v[60:63]
v_mfma_f32_16x16x32_bf16 v[64:67], a[236:239], v[32:35], v[64:67]
v_mfma_f32_16x16x32_bf16 v[52:55], a[240:243], v[36:39], v[52:55]
v_mfma_f32_16x16x32_bf16 v[56:59], a[244:247], v[36:39], v[56:59]
v_mfma_f32_16x16x32_bf16 v[60:63], a[240:243], v[40:43], v[60:63]
v_mfma_f32_16x16x32_bf16 v[64:67], a[244:247], v[40:43], v[64:67]
v_mfma_f32_16x16x32_bf16 v[52:55], a[248:251], v[44:47], v[52:55]
v_mfma_f32_16x16x32_bf16 v[56:59], a[252:255], v[44:47], v[56:59]
v_mfma_f32_16x16x32_bf16 v[60:63], a[248:251], v[48:51], v[60:63]
v_mfma_f32_16x16x32_bf16 v[64:67], a[252:255], v[48:51], v[64:67]
s_barrier
s_mov_b32 s50, 0x10000
s_add_u32 m0, s46, 65536
s_nop 0
buffer_load_dwordx4 v6, s[8:11], s50 offen offset:0 lds
s_add_u32 m0, s46, 69504
s_nop 0
buffer_load_dwordx4 v6, s[8:11], s50 offen offset:128 lds
s_add_u32 m0, s46, 73472
s_nop 0
buffer_load_dwordx4 v6, s[8:11], s50 offen offset:256 lds
s_add_u32 m0, s46, 77440
s_nop 0
buffer_load_dwordx4 v6, s[8:11], s50 offen offset:384 lds
s_add_u32 m0, s46, 81408
s_nop 0
buffer_load_dwordx4 v6, s[8:11], s50 offen offset:512 lds
s_add_u32 m0, s46, 85376
s_nop 0
buffer_load_dwordx4 v6, s[8:11], s50 offen offset:640 lds
s_add_u32 m0, s46, 89344
s_nop 0
buffer_load_dwordx4 v6, s[8:11], s50 offen offset:768 lds
s_add_u32 m0, s46, 93312
s_nop 0
buffer_load_dwordx4 v6, s[8:11], s50 offen offset:896 lds
s_add_u32 m0, s46, 97280
s_nop 0
buffer_load_dwordx4 v6, s[8:11], s50 offen offset:1024 lds
s_add_u32 m0, s46, 101248
s_nop 0
buffer_load_dwordx4 v6, s[8:11], s50 offen offset:1152 lds
s_add_u32 m0, s46, 105216
s_nop 0
buffer_load_dwordx4 v6, s[8:11], s50 offen offset:1280 lds
s_add_u32 m0, s46, 109184
s_nop 0
buffer_load_dwordx4 v6, s[8:11], s50 offen offset:1408 lds
s_add_u32 m0, s46, 113152
s_nop 0
buffer_load_dwordx4 v6, s[8:11], s50 offen offset:1536 lds
s_add_u32 m0, s46, 117120
s_nop 0
buffer_load_dwordx4 v6, s[8:11], s50 offen offset:1664 lds
s_add_u32 m0, s46, 121088
s_nop 0
buffer_load_dwordx4 v6, s[8:11], s50 offen offset:1792 lds
s_add_u32 m0, s46, 125056
s_nop 0
buffer_load_dwordx4 v6, s[8:11], s50 offen offset:1920 lds
s_and_b32 s53, s47, 31
s_lshl_b32 s53, s53, 4
v_add_u32 v19, s53, v1
v_lshlrev_b32 v19, 7, v19
s_mov_b32 s42, 1
v_and_b32 v3, 15, v0
v_lshlrev_b32 v3, 4, v3
s_branch mega_kernel_syk
mega_kernel_sykw:
s_sleep 4
mega_kernel_syk:
buffer_load_dword v2, v3, s[72:75], 0 offen sc1
s_waitcnt vmcnt(0)
mega_kernel_sykp:
s_cmp_eq_u32 s95, 1
s_cbranch_scc0 mega_kernel_sykf
v_readlane_b32 s76, v2, 14
s_mov_b32 s98, 0
s_cmp_eq_u32 s76, 32
s_cbranch_scc0 mega_kernel_sykw
s_branch mega_kernel_sykd
mega_kernel_sykf:
s_mov_b32 s77, 0
s_mov_b32 s78, 0
v_readlane_b32 s76, v2, 0
s_add_u32 s77, s77, s76
s_xor_b32 s76, s76, 32
s_or_b32 s78, s78, s76
v_readlane_b32 s76, v2, 1
s_add_u32 s77, s77, s76
s_xor_b32 s76, s76, 32
s_or_b32 s78, s78, s76
v_readlane_b32 s76, v2, 2
s_add_u32 s77, s77, s76
s_xor_b32 s76, s76, 32
s_or_b32 s78, s78, s76
v_readlane_b32 s76, v2, 3
s_add_u32 s77, s77, s76
s_xor_b32 s76, s76, 32
s_or_b32 s78, s78, s76
v_readlane_b32 s76, v2, 4
s_add_u32 s77, s77, s76
s_xor_b32 s76, s76, 32
s_or_b32 s78, s78, s76
v_readlane_b32 s76, v2, 5
s_add_u32 s77, s77, s76
s_xor_b32 s76, s76, 32
s_or_b32 s78, s78, s76
v_readlane_b32 s76, v2, 6
s_add_u32 s77, s77, s76
s_xor_b32 s76, s76, 32
s_or_b32 s78, s78, s76
v_readlane_b32 s76, v2, 7
s_add_u32 s77, s77, s76
s_xor_b32 s76, s76, 32
s_or_b32 s78, s78, s76
s_cmp_eq_u32 s77, 256
s_cbranch_scc0 mega_kernel_sykw
v_mov_b32 v252, v2
s_cmp_eq_u32 s78, 0
s_cbranch_scc0 mega_kernel_slowent
v_readlane_b32 s76, v2, 10
v_readlane_b32 s77, v2, 8
s_cmp_eq_u32 s76, 32
s_cbranch_scc0 mega_kernel_sykw
s_cmp_gt_u32 s77, 16
s_cselect_b32 s98, 1, 0
mega_kernel_sykd:
s_lshr_b32 s44, s47, 3
s_xor_b32 s44, s44, s98
s_and_b32 s44, s44, 1
s_lshl_b32 s44, s44, 13
s_lshl_b32 s48, s47, 18
s_add_u32 s48, s48, s44
s_add_u32 s48, s48, 0
s_xor_b32 s44, s98, 1
s_lshl_b32 s44, s44, 13
s_lshl_b32 s49, s40, 7
s_add_u32 s49, s49, s44
s_lshl_b32 s44, s41, 2
s_add_u32 s49, s49, s44
s_add_u32 s49, s49, 69206016
v_mov_b32 v16, 0
v_cvt_pk_bf16_f32 v84, v52, v53
v_cvt_pk_bf16_f32 v85, v54, v55
v_cvt_pk_bf16_f32 v86, v56, v57
v_cvt_pk_bf16_f32 v87, v58, v59
v_cvt_pk_bf16_f32 v88, v60, v61
v_cvt_pk_bf16_f32 v89, v62, v63
v_cvt_pk_bf16_f32 v90, v64, v65
v_cvt_pk_bf16_f32 v91, v66, v67
s_add_u32 s51, s42, s47
s_sub_u32 s51, s51, 1
s_bfe_u32 s52, s51, 0x40002
s_lshl_b32 s52, s52, 14
s_and_b32 s51, s51, 3
s_lshl_b32 s51, s51, 11
s_add_u32 s51, s51, s52
s_add_u32 s51, s51, s48
buffer_store_dwordx4 v[84:87], v7, s[84:87], s51 offen sc1
buffer_store_dwordx4 v[88:91], v7, s[84:87], s51 offen offset:1024 sc1
s_waitcnt vmcnt(0)
v_mov_b32 v17, s42
s_mov_b64 exec, 1
buffer_store_dword v17, v16, s[84:87], s49 offen sc1
s_mov_b64 exec, -1
mega_kernel_k_loop:
s_waitcnt vmcnt(2)
s_barrier
s_add_u32 s50, s42, 1
s_min_u32 s50, s50, 63
s_lshl_b32 s50, s50, 16
ds_read_b128 v[20:23], v10 offset:0
ds_read_b128 v[24:27], v10 offset:2048
ds_read_b128 v[28:31], v11 offset:0
ds_read_b128 v[32:35], v11 offset:2048
ds_read_b128 v[36:39], v10 offset:4096
ds_read_b128 v[40:43], v10 offset:6144
s_waitcnt lgkmcnt(4)
v_mfma_f32_16x16x32_bf16 v[68:71], a[0:3], v[20:23], 0
ds_read_b128 v[44:47], v11 offset:4096
v_mfma_f32_16x16x32_bf16 v[72:75], a[4:7], v[20:23], 0
v_cvt_pk_bf16_f32 v84, v52, v53
v_cvt_pk_bf16_f32 v85, v54, v55
v_cvt_pk_bf16_f32 v86, v56, v57
v_mfma_f32_16x16x32_bf16 v[76:79], a[0:3], v[24:27], 0
ds_read_b128 v[48:51], v11 offset:6144
v_mfma_f32_16x16x32_bf16 v[80:83], a[4:7], v[24:27], 0
v_cvt_pk_bf16_f32 v87, v58, v59
v_cvt_pk_bf16_f32 v88, v60, v61
v_cvt_pk_bf16_f32 v89, v62, v63
s_waitcnt lgkmcnt(4)
v_mfma_f32_16x16x32_bf16 v[68:71], a[8:11], v[28:31], v[68:71]
ds_read_b128 v[20:23], v10 offset:8192
v_mfma_f32_16x16x32_bf16 v[72:75], a[12:15], v[28:31], v[72:75]
v_cvt_pk_bf16_f32 v90, v64, v65
v_cvt_pk_bf16_f32 v91, v66, v67
v_mfma_f32_16x16x32_bf16 v[76:79], a[8:11], v[32:35], v[76:79]
ds_read_b128 v[24:27], v10 offset:10240
v_mfma_f32_16x16x32_bf16 v[80:83], a[12:15], v[32:35], v[80:83]
s_add_u32 s51, s42, s47
s_sub_u32 s51, s51, 1
s_bfe_u32 s52, s51, 0x40002
s_lshl_b32 s52, s52, 14
s_waitcnt lgkmcnt(4)
v_mfma_f32_16x16x32_bf16 v[68:71], a[16:19], v[36:39], v[68:71]
ds_read_b128 v[28:31], v11 offset:8192
v_mfma_f32_16x16x32_bf16 v[72:75], a[20:23], v[36:39], v[72:75]
s_and_b32 s51, s51, 3
s_lshl_b32 s51, s51, 11
s_add_u32 s51, s51, s52
s_add_u32 s51, s51, s48
buffer_store_dwordx4 v[84:87], v7, s[84:87], s51 offen sc1
v_mfma_f32_16x16x32_bf16 v[76:79], a[16:19], v[40:43], v[76:79]
ds_read_b128 v[32:35], v11 offset:10240
v_mfma_f32_16x16x32_bf16 v[80:83], a[20:23], v[40:43], v[80:83]
buffer_store_dwordx4 v[88:91], v7, s[84:87], s51 offen offset:1024 sc1
s_waitcnt lgkmcnt(4)
v_mfma_f32_16x16x32_bf16 v[68:71], a[24:27], v[44:47], v[68:71]
ds_read_b128 v[36:39], v10 offset:12288
v_mfma_f32_16x16x32_bf16 v[72:75], a[28:31], v[44:47], v[72:75]
s_add_u32 m0, s46, 0
v_mfma_f32_16x16x32_bf16 v[76:79], a[24:27], v[48:51], v[76:79]
ds_read_b128 v[40:43], v10 offset:14336
v_mfma_f32_16x16x32_bf16 v[80:83], a[28:31], v[48:51], v[80:83]
buffer_load_dwordx4 v6, s[8:11], s50 offen offset:0 lds
s_waitcnt lgkmcnt(4)
v_mfma_f32_16x16x32_bf16 v[68:71], a[32:35], v[20:23], v[68:71]
ds_read_b128 v[44:47], v11 offset:12288
v_mfma_f32_16x16x32_bf16 v[72:75], a[36:39], v[20:23], v[72:75]
s_add_u32 m0, s46, 3968
v_mfma_f32_16x16x32_bf16 v[76:79], a[32:35], v[24:27], v[76:79]
ds_read_b128 v[48:51], v11 offset:14336
v_mfma_f32_16x16x32_bf16 v[80:83], a[36:39], v[24:27], v[80:83]
buffer_load_dwordx4 v6, s[8:11], s50 offen offset:128 lds
s_waitcnt lgkmcnt(4)
v_mfma_f32_16x16x32_bf16 v[68:71], a[40:43], v[28:31], v[68:71]
ds_read_b128 v[20:23], v10 offset:16384
v_mfma_f32_16x16x32_bf16 v[72:75], a[44:47], v[28:31], v[72:75]
s_add_u32 m0, s46, 7936
v_mfma_f32_16x16x32_bf16 v[76:79], a[40:43], v[32:35], v[76:79]
ds_read_b128 v[24:27], v10 offset:18432
v_mfma_f32_16x16x32_bf16 v[80:83], a[44:47], v[32:35], v[80:83]
buffer_load_dwordx4 v6, s[8:11], s50 offen offset:256 lds
s_waitcnt lgkmcnt(4)
v_mfma_f32_16x16x32_bf16 v[68:71], a[48:51], v[36:39], v[68:71]
ds_read_b128 v[28:31], v11 offset:16384
v_mfma_f32_16x16x32_bf16 v[72:75], a[52:55], v[36:39], v[72:75]
s_add_u32 m0, s46, 11904
v_mfma_f32_16x16x32_bf16 v[76:79], a[48:51], v[40:43], v[76:79]
ds_read_b128 v[32:35], v11 offset:18432
v_mfma_f32_16x16x32_bf16 v[80:83], a[52:55], v[40:43], v[80:83]
buffer_load_dwordx4 v6, s[8:11], s50 offen offset:384 lds
s_waitcnt lgkmcnt(4)
v_mfma_f32_16x16x32_bf16 v[68:71], a[56:59], v[44:47], v[68:71]
ds_read_b128 v[36:39], v10 offset:20480
v_mfma_f32_16x16x32_bf16 v[72:75], a[60:63], v[44:47], v[72:75]
s_add_u32 m0, s46, 15872
v_mfma_f32_16x16x32_bf16 v[76:79], a[56:59], v[48:51], v[76:79]
ds_read_b128 v[40:43], v10 offset:22528
v_mfma_f32_16x16x32_bf16 v[80:83], a[60:63], v[48:51], v[80:83]
buffer_load_dwordx4 v6, s[8:11], s50 offen offset:512 lds
s_waitcnt lgkmcnt(4)
v_mfma_f32_16x16x32_bf16 v[68:71], a[64:67], v[20:23], v[68:71]
ds_read_b128 v[44:47], v11 offset:20480
v_mfma_f32_16x16x32_bf16 v[72:75], a[68:71], v[20:23], v[72:75]
s_add_u32 m0, s46, 19840
v_mfma_f32_16x16x32_bf16 v[76:79], a[64:67], v[24:27], v[76:79]
ds_read_b128 v[48:51], v11 offset:22528
v_mfma_f32_16x16x32_bf16 v[80:83], a[68:71], v[24:27], v[80:83]
buffer_load_dwordx4 v6, s[8:11], s50 offen offset:640 lds
s_waitcnt lgkmcnt(4)
v_mfma_f32_16x16x32_bf16 v[68:71], a[72:75], v[28:31], v[68:71]
ds_read_b128 v[20:23], v10 offset:24576
v_mfma_f32_16x16x32_bf16 v[72:75], a[76:79], v[28:31], v[72:75]
s_add_u32 m0, s46, 23808
v_mfma_f32_16x16x32_bf16 v[76:79], a[72:75], v[32:35], v[76:79]
ds_read_b128 v[24:27], v10 offset:26624
v_mfma_f32_16x16x32_bf16 v[80:83], a[76:79], v[32:35], v[80:83]
buffer_load_dwordx4 v6, s[8:11], s50 offen offset:768 lds
s_waitcnt lgkmcnt(4)
v_mfma_f32_16x16x32_bf16 v[68:71], a[80:83], v[36:39], v[68:71]
ds_read_b128 v[28:31], v11 offset:24576
v_mfma_f32_16x16x32_bf16 v[72:75], a[84:87], v[36:39], v[72:75]
s_add_u32 m0, s46, 27776
v_mfma_f32_16x16x32_bf16 v[76:79], a[80:83], v[40:43], v[76:79]
ds_read_b128 v[32:35], v11 offset:26624
v_mfma_f32_16x16x32_bf16 v[80:83], a[84:87], v[40:43], v[80:83]
buffer_load_dwordx4 v6, s[8:11], s50 offen offset:896 lds
s_waitcnt lgkmcnt(4)
v_mfma_f32_16x16x32_bf16 v[68:71], a[88:91], v[44:47], v[68:71]
ds_read_b128 v[36:39], v10 offset:28672
v_mfma_f32_16x16x32_bf16 v[72:75], a[92:95], v[44:47], v[72:75]
s_add_u32 m0, s46, 31744
v_mfma_f32_16x16x32_bf16 v[76:79], a[88:91], v[48:51], v[76:79]
ds_read_b128 v[40:43], v10 offset:30720
v_mfma_f32_16x16x32_bf16 v[80:83], a[92:95], v[48:51], v[80:83]
buffer_load_dwordx4 v6, s[8:11], s50 offen offset:1024 lds
s_waitcnt lgkmcnt(4)
v_mfma_f32_16x16x32_bf16 v[68:71], a[96:99], v[20:23], v[68:71]
ds_read_b128 v[44:47], v11 offset:28672
v_mfma_f32_16x16x32_bf16 v[72:75], a[100:103], v[20:23], v[72:75]
s_add_u32 m0, s46, 35712
v_mfma_f32_16x16x32_bf16 v[76:79], a[96:99], v[24:27], v[76:79]
ds_read_b128 v[48:51], v11 offset:30720
v_mfma_f32_16x16x32_bf16 v[80:83], a[100:103], v[24:27], v[80:83]
buffer_load_dwordx4 v6, s[8:11], s50 offen offset:1152 lds
s_waitcnt lgkmcnt(4)
v_mfma_f32_16x16x32_bf16 v[68:71], a[104:107], v[28:31], v[68:71]
ds_read_b128 v[20:23], v10 offset:32768
v_mfma_f32_16x16x32_bf16 v[72:75], a[108:111], v[28:31], v[72:75]
s_add_u32 m0, s46, 39680
v_mfma_f32_16x16x32_bf16 v[76:79], a[104:107], v[32:35], v[76:79]
ds_read_b128 v[24:27], v10 offset:34816
v_mfma_f32_16x16x32_bf16 v[80:83], a[108:111], v[32:35], v[80:83]
buffer_load_dwordx4 v6, s[8:11], s50 offen offset:1280 lds
s_waitcnt lgkmcnt(4)
v_mfma_f32_16x16x32_bf16 v[68:71], a[112:115], v[36:39], v[68:71]
ds_read_b128 v[28:31], v11 offset:32768
v_mfma_f32_16x16x32_bf16 v[72:75], a[116:119], v[36:39], v[72:75]
s_add_u32 m0, s46, 43648
v_mfma_f32_16x16x32_bf16 v[76:79], a[112:115], v[40:43], v[76:79]
ds_read_b128 v[32:35], v11 offset:34816
v_mfma_f32_16x16x32_bf16 v[80:83], a[116:119], v[40:43], v[80:83]
buffer_load_dwordx4 v6, s[8:11], s50 offen offset:1408 lds
s_waitcnt lgkmcnt(4)
v_mfma_f32_16x16x32_bf16 v[68:71], a[120:123], v[44:47], v[68:71]
ds_read_b128 v[36:39], v10 offset:36864
v_mfma_f32_16x16x32_bf16 v[72:75], a[124:127], v[44:47], v[72:75]
s_add_u32 m0, s46, 47616
v_mfma_f32_16x16x32_bf16 v[76:79], a[120:123], v[48:51], v[76:79]
ds_read_b128 v[40:43], v10 offset:38912
v_mfma_f32_16x16x32_bf16 v[80:83], a[124:127], v[48:51], v[80:83]
buffer_load_dwordx4 v6, s[8:11], s50 offen offset:1536 lds
s_waitcnt lgkmcnt(4)
v_mfma_f32_16x16x32_bf16 v[68:71], a[128:131], v[20:23], v[68:71]
ds_read_b128 v[44:47], v11 offset:36864
v_mfma_f32_16x16x32_bf16 v[72:75], a[132:135], v[20:23], v[72:75]
s_add_u32 m0, s46, 51584
v_mfma_f32_16x16x32_bf16 v[76:79], a[128:131], v[24:27], v[76:79]
ds_read_b128 v[48:51], v11 offset:38912
v_mfma_f32_16x16x32_bf16 v[80:83], a[132:135], v[24:27], v[80:83]
buffer_load_dwordx4 v6, s[8:11], s50 offen offset:1664 lds
s_waitcnt lgkmcnt(4)
v_mfma_f32_16x16x32_bf16 v[68:71], a[136:139], v[28:31], v[68:71]
ds_read_b128 v[20:23], v10 offset:40960
v_mfma_f32_16x16x32_bf16 v[72:75], a[140:143], v[28:31], v[72:75]
s_add_u32 m0, s46, 55552
v_mfma_f32_16x16x32_bf16 v[76:79], a[136:139], v[32:35], v[76:79]
ds_read_b128 v[24:27], v10 offset:43008
v_mfma_f32_16x16x32_bf16 v[80:83], a[140:143], v[32:35], v[80:83]
buffer_load_dwordx4 v6, s[8:11], s50 offen offset:1792 lds
s_waitcnt lgkmcnt(4)
v_mfma_f32_16x16x32_bf16 v[68:71], a[144:147], v[36:39], v[68:71]
ds_read_b128 v[28:31], v11 offset:40960
v_mfma_f32_16x16x32_bf16 v[72:75], a[148:151], v[36:39], v[72:75]
s_add_u32 m0, s46, 59520
v_mfma_f32_16x16x32_bf16 v[76:79], a[144:147], v[40:43], v[76:79]
ds_read_b128 v[32:35], v11 offset:43008
v_mfma_f32_16x16x32_bf16 v[80:83], a[148:151], v[40:43], v[80:83]
buffer_load_dwordx4 v6, s[8:11], s50 offen offset:1920 lds
s_waitcnt lgkmcnt(4)
v_mfma_f32_16x16x32_bf16 v[68:71], a[152:155], v[44:47], v[68:71]
ds_read_b128 v[36:39], v10 offset:45056
v_mfma_f32_16x16x32_bf16 v[72:75], a[156:159], v[44:47], v[72:75]
v_mfma_f32_16x16x32_bf16 v[76:79], a[152:155], v[48:51], v[76:79]
ds_read_b128 v[40:43], v10 offset:47104
v_mfma_f32_16x16x32_bf16 v[80:83], a[156:159], v[48:51], v[80:83]
s_waitcnt lgkmcnt(4)
v_mfma_f32_16x16x32_bf16 v[68:71], a[160:163], v[20:23], v[68:71]
ds_read_b128 v[44:47], v11 offset:45056
v_mfma_f32_16x16x32_bf16 v[72:75], a[164:167], v[20:23], v[72:75]
v_mfma_f32_16x16x32_bf16 v[76:79], a[160:163], v[24:27], v[76:79]
ds_read_b128 v[48:51], v11 offset:47104
v_mfma_f32_16x16x32_bf16 v[80:83], a[164:167], v[24:27], v[80:83]
s_waitcnt lgkmcnt(4)
v_mfma_f32_16x16x32_bf16 v[68:71], a[168:171], v[28:31], v[68:71]
ds_read_b128 v[20:23], v10 offset:49152
v_mfma_f32_16x16x32_bf16 v[72:75], a[172:175], v[28:31], v[72:75]
s_waitcnt vmcnt(16)
v_mov_b32 v17, s42
s_mov_b64 exec, 1
buffer_store_dword v17, v16, s[84:87], s49 offen sc1
s_mov_b64 exec, -1
v_mfma_f32_16x16x32_bf16 v[76:79], a[168:171], v[32:35], v[76:79]
ds_read_b128 v[24:27], v10 offset:51200
v_mfma_f32_16x16x32_bf16 v[80:83], a[172:175], v[32:35], v[80:83]
s_waitcnt lgkmcnt(4)
v_mfma_f32_16x16x32_bf16 v[68:71], a[176:179], v[36:39], v[68:71]
ds_read_b128 v[28:31], v11 offset:49152
v_mfma_f32_16x16x32_bf16 v[72:75], a[180:183], v[36:39], v[72:75]
s_add_u32 s53, s42, 3
s_min_u32 s53, s53, 63
s_lshl_b32 s53, s53, 16
s_mov_b64 exec, 0xffff
buffer_load_dword v250, v19, s[8:11], s53 offen
s_mov_b64 exec, -1
v_mfma_f32_16x16x32_bf16 v[76:79], a[176:179], v[40:43], v[76:79]
ds_read_b128 v[32:35], v11 offset:51200
v_mfma_f32_16x16x32_bf16 v[80:83], a[180:183], v[40:43], v[80:83]
s_waitcnt lgkmcnt(4)
v_mfma_f32_16x16x32_bf16 v[68:71], a[184:187], v[44:47], v[68:71]
ds_read_b128 v[36:39], v10 offset:53248
v_mfma_f32_16x16x32_bf16 v[72:75], a[188:191], v[44:47], v[72:75]
v_mfma_f32_16x16x32_bf16 v[76:79], a[184:187], v[48:51], v[76:79]
ds_read_b128 v[40:43], v10 offset:55296
v_mfma_f32_16x16x32_bf16 v[80:83], a[188:191], v[48:51], v[80:83]
s_waitcnt lgkmcnt(4)
v_mfma_f32_16x16x32_bf16 v[68:71], a[192:195], v[20:23], v[68:71]
ds_read_b128 v[44:47], v11 offset:53248
v_mfma_f32_16x16x32_bf16 v[72:75], a[196:199], v[20:23], v[72:75]
v_mfma_f32_16x16x32_bf16 v[76:79], a[192:195], v[24:27], v[76:79]
ds_read_b128 v[48:51], v11 offset:55296
v_mfma_f32_16x16x32_bf16 v[80:83], a[196:199], v[24:27], v[80:83]
s_waitcnt lgkmcnt(4)
v_mfma_f32_16x16x32_bf16 v[68:71], a[200:203], v[28:31], v[68:71]
ds_read_b128 v[20:23], v10 offset:57344
v_mfma_f32_16x16x32_bf16 v[72:75], a[204:207], v[28:31], v[72:75]
v_mfma_f32_16x16x32_bf16 v[76:79], a[200:203], v[32:35], v[76:79]
ds_read_b128 v[24:27], v10 offset:59392
v_mfma_f32_16x16x32_bf16 v[80:83], a[204:207], v[32:35], v[80:83]
s_waitcnt lgkmcnt(4)
v_mfma_f32_16x16x32_bf16 v[68:71], a[208:211], v[36:39], v[68:71]
ds_read_b128 v[28:31], v11 offset:57344
v_mfma_f32_16x16x32_bf16 v[72:75], a[212:215], v[36:39], v[72:75]
v_mfma_f32_16x16x32_bf16 v[76:79], a[208:211], v[40:43], v[76:79]
ds_read_b128 v[32:35], v11 offset:59392
v_mfma_f32_16x16x32_bf16 v[80:83], a[212:215], v[40:43], v[80:83]
s_waitcnt lgkmcnt(4)
v_mfma_f32_16x16x32_bf16 v[68:71], a[216:219], v[44:47], v[68:71]
ds_read_b128 v[36:39], v10 offset:61440
v_mfma_f32_16x16x32_bf16 v[72:75], a[220:223], v[44:47], v[72:75]
v_mfma_f32_16x16x32_bf16 v[76:79], a[216:219], v[48:51], v[76:79]
ds_read_b128 v[40:43], v10 offset:63488
v_mfma_f32_16x16x32_bf16 v[80:83], a[220:223], v[48:51], v[80:83]
s_waitcnt lgkmcnt(4)
v_mfma_f32_16x16x32_bf16 v[68:71], a[224:227], v[20:23], v[68:71]
ds_read_b128 v[44:47], v11 offset:61440
v_mfma_f32_16x16x32_bf16 v[72:75], a[228:231], v[20:23], v[72:75]
v_mfma_f32_16x16x32_bf16 v[76:79], a[224:227], v[24:27], v[76:79]
ds_read_b128 v[48:51], v11 offset:63488
v_mfma_f32_16x16x32_bf16 v[80:83], a[228:231], v[24:27], v[80:83]
s_waitcnt lgkmcnt(5)
v_mfma_f32_16x16x32_bf16 v[68:71], a[232:235], v[28:31], v[68:71]
v_mfma_f32_16x16x32_bf16 v[72:75], a[236:239], v[28:31], v[72:75]
s_waitcnt lgkmcnt(4)
v_mfma_f32_16x16x32_bf16 v[76:79], a[232:235], v[32:35], v[76:79]
v_mfma_f32_16x16x32_bf16 v[80:83], a[236:239], v[32:35], v[80:83]
s_waitcnt lgkmcnt(3)
v_mfma_f32_16x16x32_bf16 v[68:71], a[240:243], v[36:39], v[68:71]
v_mfma_f32_16x16x32_bf16 v[72:75], a[244:247], v[36:39], v[72:75]
s_waitcnt lgkmcnt(2)
v_mfma_f32_16x16x32_bf16 v[76:79], a[240:243], v[40:43], v[76:79]
v_mfma_f32_16x16x32_bf16 v[80:83], a[244:247], v[40:43], v[80:83]
s_waitcnt lgkmcnt(1)
v_mfma_f32_16x16x32_bf16 v[68:71], a[248:251], v[44:47], v[68:71]
v_mfma_f32_16x16x32_bf16 v[72:75], a[252:255], v[44:47], v[72:75]
s_waitcnt lgkmcnt(0)
v_mfma_f32_16x16x32_bf16 v[76:79], a[248:251], v[48:51], v[76:79]
v_mfma_f32_16x16x32_bf16 v[80:83], a[252:255], v[48:51], v[80:83]
s_add_u32 s42, s42, 1
s_cmp_eq_u32 s42, 64
s_cbranch_scc1 mega_kernel_k_fin
mega_kernel_k_mid:
s_waitcnt vmcnt(2)
s_barrier
s_add_u32 s50, s42, 1
s_min_u32 s50, s50, 63
s_lshl_b32 s50, s50, 16
ds_read_b128 v[20:23], v8 offset:0
ds_read_b128 v[24:27], v8 offset:2048
ds_read_b128 v[28:31], v9 offset:0
ds_read_b128 v[32:35], v9 offset:2048
ds_read_b128 v[36:39], v8 offset:4096
ds_read_b128 v[40:43], v8 offset:6144
s_waitcnt lgkmcnt(4)
v_mfma_f32_16x16x32_bf16 v[52:55], a[0:3], v[20:23], 0
ds_read_b128 v[44:47], v9 offset:4096
v_mfma_f32_16x16x32_bf16 v[56:59], a[4:7], v[20:23], 0
v_cvt_pk_bf16_f32 v84, v68, v69
v_cvt_pk_bf16_f32 v85, v70, v71
v_cvt_pk_bf16_f32 v86, v72, v73
v_mfma_f32_16x16x32_bf16 v[60:63], a[0:3], v[24:27], 0
ds_read_b128 v[48:51], v9 offset:6144
v_mfma_f32_16x16x32_bf16 v[64:67], a[4:7], v[24:27], 0
v_cvt_pk_bf16_f32 v87, v74, v75
v_cvt_pk_bf16_f32 v88, v76, v77
v_cvt_pk_bf16_f32 v89, v78, v79
s_waitcnt lgkmcnt(4)
v_mfma_f32_16x16x32_bf16 v[52:55], a[8:11], v[28:31], v[52:55]
ds_read_b128 v[20:23], v8 offset:8192
v_mfma_f32_16x16x32_bf16 v[56:59], a[12:15], v[28:31], v[56:59]
v_cvt_pk_bf16_f32 v90, v80, v81
v_cvt_pk_bf16_f32 v91, v82, v83
v_mfma_f32_16x16x32_bf16 v[60:63], a[8:11], v[32:35], v[60:63]
ds_read_b128 v[24:27], v8 offset:10240
v_mfma_f32_16x16x32_bf16 v[64:67], a[12:15], v[32:35], v[64:67]
s_add_u32 s51, s42, s47
s_sub_u32 s51, s51, 1
s_bfe_u32 s52, s51, 0x40002
s_lshl_b32 s52, s52, 14
s_waitcnt lgkmcnt(4)
v_mfma_f32_16x16x32_bf16 v[52:55], a[16:19], v[36:39], v[52:55]
ds_read_b128 v[28:31], v9 offset:8192
v_mfma_f32_16x16x32_bf16 v[56:59], a[20:23], v[36:39], v[56:59]
s_and_b32 s51, s51, 3
s_lshl_b32 s51, s51, 11
s_add_u32 s51, s51, s52
s_add_u32 s51, s51, s48
buffer_store_dwordx4 v[84:87], v7, s[84:87], s51 offen sc1
v_mfma_f32_16x16x32_bf16 v[60:63], a[16:19], v[40:43], v[60:63]
ds_read_b128 v[32:35], v9 offset:10240
v_mfma_f32_16x16x32_bf16 v[64:67], a[20:23], v[40:43], v[64:67]
buffer_store_dwordx4 v[88:91], v7, s[84:87], s51 offen offset:1024 sc1
s_waitcnt lgkmcnt(4)
v_mfma_f32_16x16x32_bf16 v[52:55], a[24:27], v[44:47], v[52:55]
ds_read_b128 v[36:39], v8 offset:12288
v_mfma_f32_16x16x32_bf16 v[56:59], a[28:31], v[44:47], v[56:59]
s_add_u32 m0, s46, 65536
v_mfma_f32_16x16x32_bf16 v[60:63], a[24:27], v[48:51], v[60:63]
ds_read_b128 v[40:43], v8 offset:14336
v_mfma_f32_16x16x32_bf16 v[64:67], a[28:31], v[48:51], v[64:67]
buffer_load_dwordx4 v6, s[8:11], s50 offen offset:0 lds
s_waitcnt lgkmcnt(4)
v_mfma_f32_16x16x32_bf16 v[52:55], a[32:35], v[20:23], v[52:55]
ds_read_b128 v[44:47], v9 offset:12288
v_mfma_f32_16x16x32_bf16 v[56:59], a[36:39], v[20:23], v[56:59]
s_add_u32 m0, s46, 69504
v_mfma_f32_16x16x32_bf16 v[60:63], a[32:35], v[24:27], v[60:63]
ds_read_b128 v[48:51], v9 offset:14336
v_mfma_f32_16x16x32_bf16 v[64:67], a[36:39], v[24:27], v[64:67]
buffer_load_dwordx4 v6, s[8:11], s50 offen offset:128 lds
s_waitcnt lgkmcnt(4)
v_mfma_f32_16x16x32_bf16 v[52:55], a[40:43], v[28:31], v[52:55]
ds_read_b128 v[20:23], v8 offset:16384
v_mfma_f32_16x16x32_bf16 v[56:59], a[44:47], v[28:31], v[56:59]
s_add_u32 m0, s46, 73472
v_mfma_f32_16x16x32_bf16 v[60:63], a[40:43], v[32:35], v[60:63]
ds_read_b128 v[24:27], v8 offset:18432
v_mfma_f32_16x16x32_bf16 v[64:67], a[44:47], v[32:35], v[64:67]
buffer_load_dwordx4 v6, s[8:11], s50 offen offset:256 lds
s_waitcnt lgkmcnt(4)
v_mfma_f32_16x16x32_bf16 v[52:55], a[48:51], v[36:39], v[52:55]
ds_read_b128 v[28:31], v9 offset:16384
v_mfma_f32_16x16x32_bf16 v[56:59], a[52:55], v[36:39], v[56:59]
s_add_u32 m0, s46, 77440
v_mfma_f32_16x16x32_bf16 v[60:63], a[48:51], v[40:43], v[60:63]
ds_read_b128 v[32:35], v9 offset:18432
v_mfma_f32_16x16x32_bf16 v[64:67], a[52:55], v[40:43], v[64:67]
buffer_load_dwordx4 v6, s[8:11], s50 offen offset:384 lds
s_waitcnt lgkmcnt(4)
v_mfma_f32_16x16x32_bf16 v[52:55], a[56:59], v[44:47], v[52:55]
ds_read_b128 v[36:39], v8 offset:20480
v_mfma_f32_16x16x32_bf16 v[56:59], a[60:63], v[44:47], v[56:59]
s_add_u32 m0, s46, 81408
v_mfma_f32_16x16x32_bf16 v[60:63], a[56:59], v[48:51], v[60:63]
ds_read_b128 v[40:43], v8 offset:22528
v_mfma_f32_16x16x32_bf16 v[64:67], a[60:63], v[48:51], v[64:67]
buffer_load_dwordx4 v6, s[8:11], s50 offen offset:512 lds
s_waitcnt lgkmcnt(4)
v_mfma_f32_16x16x32_bf16 v[52:55], a[64:67], v[20:23], v[52:55]
ds_read_b128 v[44:47], v9 offset:20480
v_mfma_f32_16x16x32_bf16 v[56:59], a[68:71], v[20:23], v[56:59]
s_add_u32 m0, s46, 85376
v_mfma_f32_16x16x32_bf16 v[60:63], a[64:67], v[24:27], v[60:63]
ds_read_b128 v[48:51], v9 offset:22528
v_mfma_f32_16x16x32_bf16 v[64:67], a[68:71], v[24:27], v[64:67]
buffer_load_dwordx4 v6, s[8:11], s50 offen offset:640 lds
s_waitcnt lgkmcnt(4)
v_mfma_f32_16x16x32_bf16 v[52:55], a[72:75], v[28:31], v[52:55]
ds_read_b128 v[20:23], v8 offset:24576
v_mfma_f32_16x16x32_bf16 v[56:59], a[76:79], v[28:31], v[56:59]
s_add_u32 m0, s46, 89344
v_mfma_f32_16x16x32_bf16 v[60:63], a[72:75], v[32:35], v[60:63]
ds_read_b128 v[24:27], v8 offset:26624
v_mfma_f32_16x16x32_bf16 v[64:67], a[76:79], v[32:35], v[64:67]
buffer_load_dwordx4 v6, s[8:11], s50 offen offset:768 lds
s_waitcnt lgkmcnt(4)
v_mfma_f32_16x16x32_bf16 v[52:55], a[80:83], v[36:39], v[52:55]
ds_read_b128 v[28:31], v9 offset:24576
v_mfma_f32_16x16x32_bf16 v[56:59], a[84:87], v[36:39], v[56:59]
s_add_u32 m0, s46, 93312
v_mfma_f32_16x16x32_bf16 v[60:63], a[80:83], v[40:43], v[60:63]
ds_read_b128 v[32:35], v9 offset:26624
v_mfma_f32_16x16x32_bf16 v[64:67], a[84:87], v[40:43], v[64:67]
buffer_load_dwordx4 v6, s[8:11], s50 offen offset:896 lds
s_waitcnt lgkmcnt(4)
v_mfma_f32_16x16x32_bf16 v[52:55], a[88:91], v[44:47], v[52:55]
ds_read_b128 v[36:39], v8 offset:28672
v_mfma_f32_16x16x32_bf16 v[56:59], a[92:95], v[44:47], v[56:59]
s_add_u32 m0, s46, 97280
v_mfma_f32_16x16x32_bf16 v[60:63], a[88:91], v[48:51], v[60:63]
ds_read_b128 v[40:43], v8 offset:30720
v_mfma_f32_16x16x32_bf16 v[64:67], a[92:95], v[48:51], v[64:67]
buffer_load_dwordx4 v6, s[8:11], s50 offen offset:1024 lds
s_waitcnt lgkmcnt(4)
v_mfma_f32_16x16x32_bf16 v[52:55], a[96:99], v[20:23], v[52:55]
ds_read_b128 v[44:47], v9 offset:28672
v_mfma_f32_16x16x32_bf16 v[56:59], a[100:103], v[20:23], v[56:59]
s_add_u32 m0, s46, 101248
v_mfma_f32_16x16x32_bf16 v[60:63], a[96:99], v[24:27], v[60:63]
ds_read_b128 v[48:51], v9 offset:30720
v_mfma_f32_16x16x32_bf16 v[64:67], a[100:103], v[24:27], v[64:67]
buffer_load_dwordx4 v6, s[8:11], s50 offen offset:1152 lds
s_waitcnt lgkmcnt(4)
v_mfma_f32_16x16x32_bf16 v[52:55], a[104:107], v[28:31], v[52:55]
ds_read_b128 v[20:23], v8 offset:32768
v_mfma_f32_16x16x32_bf16 v[56:59], a[108:111], v[28:31], v[56:59]
s_add_u32 m0, s46, 105216
v_mfma_f32_16x16x32_bf16 v[60:63], a[104:107], v[32:35], v[60:63]
ds_read_b128 v[24:27], v8 offset:34816
v_mfma_f32_16x16x32_bf16 v[64:67], a[108:111], v[32:35], v[64:67]
buffer_load_dwordx4 v6, s[8:11], s50 offen offset:1280 lds
s_waitcnt lgkmcnt(4)
v_mfma_f32_16x16x32_bf16 v[52:55], a[112:115], v[36:39], v[52:55]
ds_read_b128 v[28:31], v9 offset:32768
v_mfma_f32_16x16x32_bf16 v[56:59], a[116:119], v[36:39], v[56:59]
s_add_u32 m0, s46, 109184
v_mfma_f32_16x16x32_bf16 v[60:63], a[112:115], v[40:43], v[60:63]
ds_read_b128 v[32:35], v9 offset:34816
v_mfma_f32_16x16x32_bf16 v[64:67], a[116:119], v[40:43], v[64:67]
buffer_load_dwordx4 v6, s[8:11], s50 offen offset:1408 lds
s_waitcnt lgkmcnt(4)
v_mfma_f32_16x16x32_bf16 v[52:55], a[120:123], v[44:47], v[52:55]
ds_read_b128 v[36:39], v8 offset:36864
v_mfma_f32_16x16x32_bf16 v[56:59], a[124:127], v[44:47], v[56:59]
s_add_u32 m0, s46, 113152
v_mfma_f32_16x16x32_bf16 v[60:63], a[120:123], v[48:51], v[60:63]
ds_read_b128 v[40:43], v8 offset:38912
v_mfma_f32_16x16x32_bf16 v[64:67], a[124:127], v[48:51], v[64:67]
buffer_load_dwordx4 v6, s[8:11], s50 offen offset:1536 lds
s_waitcnt lgkmcnt(4)
v_mfma_f32_16x16x32_bf16 v[52:55], a[128:131], v[20:23], v[52:55]
ds_read_b128 v[44:47], v9 offset:36864
v_mfma_f32_16x16x32_bf16 v[56:59], a[132:135], v[20:23], v[56:59]
s_add_u32 m0, s46, 117120
v_mfma_f32_16x16x32_bf16 v[60:63], a[128:131], v[24:27], v[60:63]
ds_read_b128 v[48:51], v9 offset:38912
v_mfma_f32_16x16x32_bf16 v[64:67], a[132:135], v[24:27], v[64:67]
buffer_load_dwordx4 v6, s[8:11], s50 offen offset:1664 lds
s_waitcnt lgkmcnt(4)
v_mfma_f32_16x16x32_bf16 v[52:55], a[136:139], v[28:31], v[52:55]
ds_read_b128 v[20:23], v8 offset:40960
v_mfma_f32_16x16x32_bf16 v[56:59], a[140:143], v[28:31], v[56:59]
s_add_u32 m0, s46, 121088
v_mfma_f32_16x16x32_bf16 v[60:63], a[136:139], v[32:35], v[60:63]
ds_read_b128 v[24:27], v8 offset:43008
v_mfma_f32_16x16x32_bf16 v[64:67], a[140:143], v[32:35], v[64:67]
buffer_load_dwordx4 v6, s[8:11], s50 offen offset:1792 lds
s_waitcnt lgkmcnt(4)
v_mfma_f32_16x16x32_bf16 v[52:55], a[144:147], v[36:39], v[52:55]
ds_read_b128 v[28:31], v9 offset:40960
v_mfma_f32_16x16x32_bf16 v[56:59], a[148:151], v[36:39], v[56:59]
s_add_u32 m0, s46, 125056
v_mfma_f32_16x16x32_bf16 v[60:63], a[144:147], v[40:43], v[60:63]
ds_read_b128 v[32:35], v9 offset:43008
v_mfma_f32_16x16x32_bf16 v[64:67], a[148:151], v[40:43], v[64:67]
buffer_load_dwordx4 v6, s[8:11], s50 offen offset:1920 lds
s_waitcnt lgkmcnt(4)
v_mfma_f32_16x16x32_bf16 v[52:55], a[152:155], v[44:47], v[52:55]
ds_read_b128 v[36:39], v8 offset:45056
v_mfma_f32_16x16x32_bf16 v[56:59], a[156:159], v[44:47], v[56:59]
v_mfma_f32_16x16x32_bf16 v[60:63], a[152:155], v[48:51], v[60:63]
ds_read_b128 v[40:43], v8 offset:47104
v_mfma_f32_16x16x32_bf16 v[64:67], a[156:159], v[48:51], v[64:67]
s_waitcnt lgkmcnt(4)
v_mfma_f32_16x16x32_bf16 v[52:55], a[160:163], v[20:23], v[52:55]
ds_read_b128 v[44:47], v9 offset:45056
v_mfma_f32_16x16x32_bf16 v[56:59], a[164:167], v[20:23], v[56:59]
v_mfma_f32_16x16x32_bf16 v[60:63], a[160:163], v[24:27], v[60:63]
ds_read_b128 v[48:51], v9 offset:47104
v_mfma_f32_16x16x32_bf16 v[64:67], a[164:167], v[24:27], v[64:67]
s_waitcnt lgkmcnt(4)
v_mfma_f32_16x16x32_bf16 v[52:55], a[168:171], v[28:31], v[52:55]
ds_read_b128 v[20:23], v8 offset:49152
v_mfma_f32_16x16x32_bf16 v[56:59], a[172:175], v[28:31], v[56:59]
s_waitcnt vmcnt(16)
v_mov_b32 v17, s42
s_mov_b64 exec, 1
buffer_store_dword v17, v16, s[84:87], s49 offen sc1
s_mov_b64 exec, -1
v_mfma_f32_16x16x32_bf16 v[60:63], a[168:171], v[32:35], v[60:63]
ds_read_b128 v[24:27], v8 offset:51200
v_mfma_f32_16x16x32_bf16 v[64:67], a[172:175], v[32:35], v[64:67]
s_waitcnt lgkmcnt(4)
v_mfma_f32_16x16x32_bf16 v[52:55], a[176:179], v[36:39], v[52:55]
ds_read_b128 v[28:31], v9 offset:49152
v_mfma_f32_16x16x32_bf16 v[56:59], a[180:183], v[36:39], v[56:59]
s_add_u32 s53, s42, 3
s_min_u32 s53, s53, 63
s_lshl_b32 s53, s53, 16
s_mov_b64 exec, 0xffff
buffer_load_dword v250, v19, s[8:11], s53 offen
s_mov_b64 exec, -1
v_mfma_f32_16x16x32_bf16 v[60:63], a[176:179], v[40:43], v[60:63]
ds_read_b128 v[32:35], v9 offset:51200
v_mfma_f32_16x16x32_bf16 v[64:67], a[180:183], v[40:43], v[64:67]
s_waitcnt lgkmcnt(4)
v_mfma_f32_16x16x32_bf16 v[52:55], a[184:187], v[44:47], v[52:55]
ds_read_b128 v[36:39], v8 offset:53248
v_mfma_f32_16x16x32_bf16 v[56:59], a[188:191], v[44:47], v[56:59]
v_mfma_f32_16x16x32_bf16 v[60:63], a[184:187], v[48:51], v[60:63]
ds_read_b128 v[40:43], v8 offset:55296
v_mfma_f32_16x16x32_bf16 v[64:67], a[188:191], v[48:51], v[64:67]
s_waitcnt lgkmcnt(4)
v_mfma_f32_16x16x32_bf16 v[52:55], a[192:195], v[20:23], v[52:55]
ds_read_b128 v[44:47], v9 offset:53248
v_mfma_f32_16x16x32_bf16 v[56:59], a[196:199], v[20:23], v[56:59]
v_mfma_f32_16x16x32_bf16 v[60:63], a[192:195], v[24:27], v[60:63]
ds_read_b128 v[48:51], v9 offset:55296
v_mfma_f32_16x16x32_bf16 v[64:67], a[196:199], v[24:27], v[64:67]
s_waitcnt lgkmcnt(4)
v_mfma_f32_16x16x32_bf16 v[52:55], a[200:203], v[28:31], v[52:55]
ds_read_b128 v[20:23], v8 offset:57344
v_mfma_f32_16x16x32_bf16 v[56:59], a[204:207], v[28:31], v[56:59]
v_mfma_f32_16x16x32_bf16 v[60:63], a[200:203], v[32:35], v[60:63]
ds_read_b128 v[24:27], v8 offset:59392
v_mfma_f32_16x16x32_bf16 v[64:67], a[204:207], v[32:35], v[64:67]
s_waitcnt lgkmcnt(4)
v_mfma_f32_16x16x32_bf16 v[52:55], a[208:211], v[36:39], v[52:55]
ds_read_b128 v[28:31], v9 offset:57344
v_mfma_f32_16x16x32_bf16 v[56:59], a[212:215], v[36:39], v[56:59]
v_mfma_f32_16x16x32_bf16 v[60:63], a[208:211], v[40:43], v[60:63]
ds_read_b128 v[32:35], v9 offset:59392
v_mfma_f32_16x16x32_bf16 v[64:67], a[212:215], v[40:43], v[64:67]
s_waitcnt lgkmcnt(4)
v_mfma_f32_16x16x32_bf16 v[52:55], a[216:219], v[44:47], v[52:55]
ds_read_b128 v[36:39], v8 offset:61440
v_mfma_f32_16x16x32_bf16 v[56:59], a[220:223], v[44:47], v[56:59]
v_mfma_f32_16x16x32_bf16 v[60:63], a[216:219], v[48:51], v[60:63]
ds_read_b128 v[40:43], v8 offset:63488
v_mfma_f32_16x16x32_bf16 v[64:67], a[220:223], v[48:51], v[64:67]
s_waitcnt lgkmcnt(4)
v_mfma_f32_16x16x32_bf16 v[52:55], a[224:227], v[20:23], v[52:55]
ds_read_b128 v[44:47], v9 offset:61440
v_mfma_f32_16x16x32_bf16 v[56:59], a[228:231], v[20:23], v[56:59]
v_mfma_f32_16x16x32_bf16 v[60:63], a[224:227], v[24:27], v[60:63]
ds_read_b128 v[48:51], v9 offset:63488
v_mfma_f32_16x16x32_bf16 v[64:67], a[228:231], v[24:27], v[64:67]
s_waitcnt lgkmcnt(5)
v_mfma_f32_16x16x32_bf16 v[52:55], a[232:235], v[28:31], v[52:55]
v_mfma_f32_16x16x32_bf16 v[56:59], a[236:239], v[28:31], v[56:59]
s_waitcnt lgkmcnt(4)
v_mfma_f32_16x16x32_bf16 v[60:63], a[232:235], v[32:35], v[60:63]
v_mfma_f32_16x16x32_bf16 v[64:67], a[236:239], v[32:35], v[64:67]
s_waitcnt lgkmcnt(3)
v_mfma_f32_16x16x32_bf16 v[52:55], a[240:243], v[36:39], v[52:55]
v_mfma_f32_16x16x32_bf16 v[56:59], a[244:247], v[36:39], v[56:59]
s_waitcnt lgkmcnt(2)
v_mfma_f32_16x16x32_bf16 v[60:63], a[240:243], v[40:43], v[60:63]
v_mfma_f32_16x16x32_bf16 v[64:67], a[244:247], v[40:43], v[64:67]
s_waitcnt lgkmcnt(1)
v_mfma_f32_16x16x32_bf16 v[52:55], a[248:251], v[44:47], v[52:55]
v_mfma_f32_16x16x32_bf16 v[56:59], a[252:255], v[44:47], v[56:59]
s_waitcnt lgkmcnt(0)
v_mfma_f32_16x16x32_bf16 v[60:63], a[248:251], v[48:51], v[60:63]
v_mfma_f32_16x16x32_bf16 v[64:67], a[252:255], v[48:51], v[64:67]
s_add_u32 s42, s42, 1
s_branch mega_kernel_k_loop
mega_kernel_k_fin:
s_nop 11
v_cvt_pk_bf16_f32 v84, v68, v69
v_cvt_pk_bf16_f32 v85, v70, v71
v_cvt_pk_bf16_f32 v86, v72, v73
v_cvt_pk_bf16_f32 v87, v74, v75
v_cvt_pk_bf16_f32 v88, v76, v77
v_cvt_pk_bf16_f32 v89, v78, v79
v_cvt_pk_bf16_f32 v90, v80, v81
v_cvt_pk_bf16_f32 v91, v82, v83
s_add_u32 s51, s42, s47
s_sub_u32 s51, s51, 1
s_bfe_u32 s52, s51, 0x40002
s_lshl_b32 s52, s52, 14
s_and_b32 s51, s51, 3
s_lshl_b32 s51, s51, 11
s_add_u32 s51, s51, s52
s_add_u32 s51, s51, s48
buffer_store_dwordx4 v[84:87], v7, s[84:87], s51 offen sc1
buffer_store_dwordx4 v[88:91], v7, s[84:87], s51 offen offset:1024 sc1
s_waitcnt vmcnt(0)
v_mov_b32 v17, s42
s_mov_b64 exec, 1
buffer_store_dword v17, v16, s[84:87], s49 offen sc1
s_mov_b64 exec, -1
s_waitcnt vmcnt(0)
s_barrier
s_branch mega_kernel_fft
mega_kernel_rv:
s_load_dwordx2 s[4:5], s[0:1], 32
s_load_dwordx2 s[8:9], s[0:1], 0
v_lshrrev_b32 v2, 6, v0
v_and_b32 v1, 63, v0
v_readfirstlane_b32 s41, v2
v_lshlrev_b32 v5, 4, v1
s_waitcnt lgkmcnt(0)
s_mov_b32 s6, 8388608
s_mov_b32 s7, 0x00020000
s_mov_b32 s10, 4194304
s_mov_b32 s11, 0x00020000
s_lshl_b32 s43, s40, 8
s_lshl_b32 s44, s41, 6
s_add_u32 s48, s43, s44
s_and_b32 s43, s48, 0x7ff
v_add_u32 v19, s43, v1
v_lshlrev_b32 v19, 7, v19
s_mov_b32 s43, 0
buffer_load_dword v250, v19, s[8:11], s43 offen
s_nop 0
v_lshrrev_b32 v2, 3, v1
s_lshl_b32 s43, s41, 3
v_add_u32 v2, s43, v2
v_bfe_u32 v3, v2, 1, 3
v_and_b32 v4, 7, v1
v_xor_b32 v3, v3, v4
v_lshlrev_b32 v6, 11, v2
v_lshl_add_u32 v6, v3, 4, v6
s_lshl_b32 s46, s41, 10
v_and_b32 v2, 15, v1
v_bfe_u32 v3, v2, 1, 3
v_lshrrev_b32 v4, 4, v1
v_xor_b32 v3, v3, v4
v_lshlrev_b32 v8, 7, v2
v_lshl_add_u32 v8, v3, 4, v8
v_xor_b32 v9, 64, v8
v_add_u32 v10, 0x10000, v8
v_add_u32 v11, 0x10000, v9
v_mov_b32 v7, v5
s_lshl_b32 s47, s40, 2
s_add_u32 s47, s47, s41
s_mov_b32 s42, 0
s_mov_b32 s50, 0
s_add_u32 m0, s46, 0
s_nop 0
buffer_load_dwordx4 v6, s[8:11], s50 offen offset:0 lds
s_add_u32 m0, s46, 3968
s_nop 0
buffer_load_dwordx4 v6, s[8:11], s50 offen offset:128 lds
s_add_u32 m0, s46, 7936
s_nop 0
buffer_load_dwordx4 v6, s[8:11], s50 offen offset:256 lds
s_add_u32 m0, s46, 11904
s_nop 0
buffer_load_dwordx4 v6, s[8:11], s50 offen offset:384 lds
s_add_u32 m0, s46, 15872
s_nop 0
buffer_load_dwordx4 v6, s[8:11], s50 offen offset:512 lds
s_add_u32 m0, s46, 19840
s_nop 0
buffer_load_dwordx4 v6, s[8:11], s50 offen offset:640 lds
s_add_u32 m0, s46, 23808
s_nop 0
buffer_load_dwordx4 v6, s[8:11], s50 offen offset:768 lds
s_add_u32 m0, s46, 27776
s_nop 0
buffer_load_dwordx4 v6, s[8:11], s50 offen offset:896 lds
s_add_u32 m0, s46, 31744
s_nop 0
buffer_load_dwordx4 v6, s[8:11], s50 offen offset:1024 lds
s_add_u32 m0, s46, 35712
s_nop 0
buffer_load_dwordx4 v6, s[8:11], s50 offen offset:1152 lds
s_add_u32 m0, s46, 39680
s_nop 0
buffer_load_dwordx4 v6, s[8:11], s50 offen offset:1280 lds
s_add_u32 m0, s46, 43648
s_nop 0
buffer_load_dwordx4 v6, s[8:11], s50 offen offset:1408 lds
s_add_u32 m0, s46, 47616
s_nop 0
buffer_load_dwordx4 v6, s[8:11], s50 offen offset:1536 lds
s_add_u32 m0, s46, 51584
s_nop 0
buffer_load_dwordx4 v6, s[8:11], s50 offen offset:1664 lds
s_add_u32 m0, s46, 55552
s_nop 0
buffer_load_dwordx4 v6, s[8:11], s50 offen offset:1792 lds
s_add_u32 m0, s46, 59520
s_nop 0
buffer_load_dwordx4 v6, s[8:11], s50 offen offset:1920 lds
v_lshrrev_b32 v2, 2, v1
v_and_b32 v3, 3, v1
v_lshlrev_b32 v16, 13, v2
v_lshl_add_u32 v16, v3, 4, v16
v_add_u32 v16, s48, v16
s_mul_i32 s45, s41, 24576
s_add_u32 s45, s45, 65536
v_bfe_u32 v17, v1, 2, 2
v_lshrrev_b32 v18, 4, v1
v_lshl_add_u32 v17, v18, 3, v17
v_lshlrev_b32 v17, 6, v17
v_lshl_add_u32 v17, v3, 3, v17
v_add_u32 v17, s45, v17
s_and_b32 s43, s40, 3
s_lshl_b32 s43, s43, 2
s_add_u32 s43, s43, s41
s_lshl_b32 s43, s43, 3
v_and_b32 v12, 7, v1
v_add_u32 v12, s43, v12
s_lshr_b32 s43, s40, 2
s_lshl_b32 s43, s43, 10
s_add_u32 s44, s43, 896
s_add_u32 s43, s43, 384
s_cmp_ge_u32 s40, 28
s_cselect_b32 s44, s44, s43
v_mov_b32 v13, s43
v_mov_b32 v14, s44
v_cmp_gt_u32 vcc, 32, v1
s_nop 1
v_cndmask_b32 v13, v14, v13, vcc
v_lshl_add_u32 v12, v12, 13, v13
s_mov_b32 s44, 0
buffer_load_dword v250, v12, s[4:7], s44 offen
s_add_u32 m0, s45, 0
s_mov_b32 s44, 0
buffer_load_dwordx4 v16, s[4:7], s44 offen lds
s_add_u32 m0, s45, 1024
s_mov_b32 s44, 131072
buffer_load_dwordx4 v16, s[4:7], s44 offen lds
s_add_u32 m0, s45, 2048
s_mov_b32 s44, 262144
buffer_load_dwordx4 v16, s[4:7], s44 offen lds
s_add_u32 m0, s45, 3072
s_mov_b32 s44, 393216
buffer_load_dwordx4 v16, s[4:7], s44 offen lds
s_add_u32 m0, s45, 4096
s_mov_b32 s44, 524288
buffer_load_dwordx4 v16, s[4:7], s44 offen lds
s_add_u32 m0, s45, 5120
s_mov_b32 s44, 655360
buffer_load_dwordx4 v16, s[4:7], s44 offen lds
s_add_u32 m0, s45, 6144
s_mov_b32 s44, 786432
buffer_load_dwordx4 v16, s[4:7], s44 offen lds
s_add_u32 m0, s45, 7168
s_mov_b32 s44, 917504
buffer_load_dwordx4 v16, s[4:7], s44 offen lds
s_mov_b32 s44, 1048576
buffer_load_dword v250, v12, s[4:7], s44 offen
s_add_u32 m0, s45, 8192
s_mov_b32 s44, 1048576
buffer_load_dwordx4 v16, s[4:7], s44 offen lds
s_add_u32 m0, s45, 9216
s_mov_b32 s44, 1179648
buffer_load_dwordx4 v16, s[4:7], s44 offen lds
s_add_u32 m0, s45, 10240
s_mov_b32 s44, 1310720
buffer_load_dwordx4 v16, s[4:7], s44 offen lds
s_add_u32 m0, s45, 11264
s_mov_b32 s44, 1441792
buffer_load_dwordx4 v16, s[4:7], s44 offen lds
s_add_u32 m0, s45, 12288
s_mov_b32 s44, 1572864
buffer_load_dwordx4 v16, s[4:7], s44 offen lds
s_add_u32 m0, s45, 13312
s_mov_b32 s44, 1703936
buffer_load_dwordx4 v16, s[4:7], s44 offen lds
s_add_u32 m0, s45, 14336
s_mov_b32 s44, 1835008
buffer_load_dwordx4 v16, s[4:7], s44 offen lds
s_add_u32 m0, s45, 15360
s_mov_b32 s44, 1966080
buffer_load_dwordx4 v16, s[4:7], s44 offen lds
s_mov_b32 s44, 2097152
buffer_load_dword v250, v12, s[4:7], s44 offen
s_add_u32 m0, s45, 16384
s_mov_b32 s44, 2097152
buffer_load_dwordx4 v16, s[4:7], s44 offen lds
s_add_u32 m0, s45, 17408
s_mov_b32 s44, 2228224
buffer_load_dwordx4 v16, s[4:7], s44 offen lds
s_add_u32 m0, s45, 18432
s_mov_b32 s44, 2359296
buffer_load_dwordx4 v16, s[4:7], s44 offen lds
s_add_u32 m0, s45, 19456
s_mov_b32 s44, 2490368
buffer_load_dwordx4 v16, s[4:7], s44 offen lds
s_add_u32 m0, s45, 20480
s_mov_b32 s44, 2621440
buffer_load_dwordx4 v16, s[4:7], s44 offen lds
s_add_u32 m0, s45, 21504
s_mov_b32 s44, 2752512
buffer_load_dwordx4 v16, s[4:7], s44 offen lds
s_add_u32 m0, s45, 22528
s_mov_b32 s44, 2883584
buffer_load_dwordx4 v16, s[4:7], s44 offen lds
s_add_u32 m0, s45, 23552
s_mov_b32 s44, 3014656
buffer_load_dwordx4 v16, s[4:7], s44 offen lds
s_waitcnt vmcnt(18)
s_barrier
ds_read_b64_tr_b16 a[0:1], v17 offset:0
ds_read_b64_tr_b16 a[2:3], v17 offset:256
ds_read_b64_tr_b16 a[4:5], v17 offset:32
ds_read_b64_tr_b16 a[6:7], v17 offset:288
ds_read_b64_tr_b16 a[8:9], v17 offset:2048
ds_read_b64_tr_b16 a[10:11], v17 offset:2304
ds_read_b64_tr_b16 a[12:13], v17 offset:2080
ds_read_b64_tr_b16 a[14:15], v17 offset:2336
s_waitcnt lgkmcnt(0)
ds_read_b64_tr_b16 a[16:17], v17 offset:4096
ds_read_b64_tr_b16 a[18:19], v17 offset:4352
ds_read_b64_tr_b16 a[20:21], v17 offset:4128
ds_read_b64_tr_b16 a[22:23], v17 offset:4384
ds_read_b64_tr_b16 a[24:25], v17 offset:6144
ds_read_b64_tr_b16 a[26:27], v17 offset:6400
ds_read_b64_tr_b16 a[28:29], v17 offset:6176
ds_read_b64_tr_b16 a[30:31], v17 offset:6432
s_waitcnt lgkmcnt(0)
s_mov_b32 s44, 3145728
buffer_load_dword v250, v12, s[4:7], s44 offen
s_add_u32 m0, s45, 0
s_mov_b32 s44, 3145728
buffer_load_dwordx4 v16, s[4:7], s44 offen lds
s_add_u32 m0, s45, 1024
s_mov_b32 s44, 3276800
buffer_load_dwordx4 v16, s[4:7], s44 offen lds
s_add_u32 m0, s45, 2048
s_mov_b32 s44, 3407872
buffer_load_dwordx4 v16, s[4:7], s44 offen lds
s_add_u32 m0, s45, 3072
s_mov_b32 s44, 3538944
buffer_load_dwordx4 v16, s[4:7], s44 offen lds
s_add_u32 m0, s45, 4096
s_mov_b32 s44, 3670016
buffer_load_dwordx4 v16, s[4:7], s44 offen lds
s_add_u32 m0, s45, 5120
s_mov_b32 s44, 3801088
buffer_load_dwordx4 v16, s[4:7], s44 offen lds
s_add_u32 m0, s45, 6144
s_mov_b32 s44, 3932160
buffer_load_dwordx4 v16, s[4:7], s44 offen lds
s_add_u32 m0, s45, 7168
s_mov_b32 s44, 4063232
buffer_load_dwordx4 v16, s[4:7], s44 offen lds
ds_read_b128 v[20:23], v8 offset:0
ds_read_b128 v[24:27], v8 offset:2048
ds_read_b128 v[28:31], v9 offset:0
ds_read_b128 v[32:35], v9 offset:2048
ds_read_b128 v[36:39], v8 offset:4096
ds_read_b128 v[40:43], v8 offset:6144
ds_read_b128 v[44:47], v9 offset:4096
ds_read_b128 v[48:51], v9 offset:6144
s_waitcnt lgkmcnt(0)
v_mfma_f32_16x16x32_bf16 v[52:55], v[20:23], a[0:3], 0
v_mfma_f32_16x16x32_bf16 v[56:59], v[20:23], a[4:7], 0
v_mfma_f32_16x16x32_bf16 v[60:63], v[24:27], a[0:3], 0
v_mfma_f32_16x16x32_bf16 v[64:67], v[24:27], a[4:7], 0
v_mfma_f32_16x16x32_bf16 v[52:55], v[28:31], a[8:11], v[52:55]
v_mfma_f32_16x16x32_bf16 v[56:59], v[28:31], a[12:15], v[56:59]
v_mfma_f32_16x16x32_bf16 v[60:63], v[32:35], a[8:11], v[60:63]
v_mfma_f32_16x16x32_bf16 v[64:67], v[32:35], a[12:15], v[64:67]
v_mfma_f32_16x16x32_bf16 v[52:55], v[36:39], a[16:19], v[52:55]
v_mfma_f32_16x16x32_bf16 v[56:59], v[36:39], a[20:23], v[56:59]
v_mfma_f32_16x16x32_bf16 v[60:63], v[40:43], a[16:19], v[60:63]
v_mfma_f32_16x16x32_bf16 v[64:67], v[40:43], a[20:23], v[64:67]
v_mfma_f32_16x16x32_bf16 v[52:55], v[44:47], a[24:27], v[52:55]
v_mfma_f32_16x16x32_bf16 v[56:59], v[44:47], a[28:31], v[56:59]
v_mfma_f32_16x16x32_bf16 v[60:63], v[48:51], a[24:27], v[60:63]
v_mfma_f32_16x16x32_bf16 v[64:67], v[48:51], a[28:31], v[64:67]
s_waitcnt vmcnt(18)
ds_read_b64_tr_b16 a[32:33], v17 offset:8192
ds_read_b64_tr_b16 a[34:35], v17 offset:8448
ds_read_b64_tr_b16 a[36:37], v17 offset:8224
ds_read_b64_tr_b16 a[38:39], v17 offset:8480
ds_read_b64_tr_b16 a[40:41], v17 offset:10240
ds_read_b64_tr_b16 a[42:43], v17 offset:10496
ds_read_b64_tr_b16 a[44:45], v17 offset:10272
ds_read_b64_tr_b16 a[46:47], v17 offset:10528
s_waitcnt lgkmcnt(0)
ds_read_b64_tr_b16 a[48:49], v17 offset:12288
ds_read_b64_tr_b16 a[50:51], v17 offset:12544
ds_read_b64_tr_b16 a[52:53], v17 offset:12320
ds_read_b64_tr_b16 a[54:55], v17 offset:12576
ds_read_b64_tr_b16 a[56:57], v17 offset:14336
ds_read_b64_tr_b16 a[58:59], v17 offset:14592
ds_read_b64_tr_b16 a[60:61], v17 offset:14368
ds_read_b64_tr_b16 a[62:63], v17 offset:14624
s_waitcnt lgkmcnt(0)
s_mov_b32 s44, 4194304
buffer_load_dword v250, v12, s[4:7], s44 offen
s_add_u32 m0, s45, 8192
s_mov_b32 s44, 4194304
buffer_load_dwordx4 v16, s[4:7], s44 offen lds
s_add_u32 m0, s45, 9216
s_mov_b32 s44, 4325376
buffer_load_dwordx4 v16, s[4:7], s44 offen lds
s_add_u32 m0, s45, 10240
s_mov_b32 s44, 4456448
buffer_load_dwordx4 v16, s[4:7], s44 offen lds
s_add_u32 m0, s45, 11264
s_mov_b32 s44, 4587520
buffer_load_dwordx4 v16, s[4:7], s44 offen lds
s_add_u32 m0, s45, 12288
s_mov_b32 s44, 4718592
buffer_load_dwordx4 v16, s[4:7], s44 offen lds
s_add_u32 m0, s45, 13312
s_mov_b32 s44, 4849664
buffer_load_dwordx4 v16, s[4:7], s44 offen lds
s_add_u32 m0, s45, 14336
s_mov_b32 s44, 4980736
buffer_load_dwordx4 v16, s[4:7], s44 offen lds
s_add_u32 m0, s45, 15360
s_mov_b32 s44, 5111808
buffer_load_dwordx4 v16, s[4:7], s44 offen lds
ds_read_b128 v[20:23], v8 offset:8192
ds_read_b128 v[24:27], v8 offset:10240
ds_read_b128 v[28:31], v9 offset:8192
ds_read_b128 v[32:35], v9 offset:10240
ds_read_b128 v[36:39], v8 offset:12288
ds_read_b128 v[40:43], v8 offset:14336
ds_read_b128 v[44:47], v9 offset:12288
ds_read_b128 v[48:51], v9 offset:14336
s_waitcnt lgkmcnt(0)
v_mfma_f32_16x16x32_bf16 v[52:55], v[20:23], a[32:35], v[52:55]
v_mfma_f32_16x16x32_bf16 v[56:59], v[20:23], a[36:39], v[56:59]
v_mfma_f32_16x16x32_bf16 v[60:63], v[24:27], a[32:35], v[60:63]
v_mfma_f32_16x16x32_bf16 v[64:67], v[24:27], a[36:39], v[64:67]
v_mfma_f32_16x16x32_bf16 v[52:55], v[28:31], a[40:43], v[52:55]
v_mfma_f32_16x16x32_bf16 v[56:59], v[28:31], a[44:47], v[56:59]
v_mfma_f32_16x16x32_bf16 v[60:63], v[32:35], a[40:43], v[60:63]
v_mfma_f32_16x16x32_bf16 v[64:67], v[32:35], a[44:47], v[64:67]
v_mfma_f32_16x16x32_bf16 v[52:55], v[36:39], a[48:51], v[52:55]
v_mfma_f32_16x16x32_bf16 v[56:59], v[36:39], a[52:55], v[56:59]
v_mfma_f32_16x16x32_bf16 v[60:63], v[40:43], a[48:51], v[60:63]
v_mfma_f32_16x16x32_bf16 v[64:67], v[40:43], a[52:55], v[64:67]
v_mfma_f32_16x16x32_bf16 v[52:55], v[44:47], a[56:59], v[52:55]
v_mfma_f32_16x16x32_bf16 v[56:59], v[44:47], a[60:63], v[56:59]
v_mfma_f32_16x16x32_bf16 v[60:63], v[48:51], a[56:59], v[60:63]
v_mfma_f32_16x16x32_bf16 v[64:67], v[48:51], a[60:63], v[64:67]
s_waitcnt vmcnt(18)
ds_read_b64_tr_b16 a[64:65], v17 offset:16384
ds_read_b64_tr_b16 a[66:67], v17 offset:16640
ds_read_b64_tr_b16 a[68:69], v17 offset:16416
ds_read_b64_tr_b16 a[70:71], v17 offset:16672
ds_read_b64_tr_b16 a[72:73], v17 offset:18432
ds_read_b64_tr_b16 a[74:75], v17 offset:18688
ds_read_b64_tr_b16 a[76:77], v17 offset:18464
ds_read_b64_tr_b16 a[78:79], v17 offset:18720
s_waitcnt lgkmcnt(0)
ds_read_b64_tr_b16 a[80:81], v17 offset:20480
ds_read_b64_tr_b16 a[82:83], v17 offset:20736
ds_read_b64_tr_b16 a[84:85], v17 offset:20512
ds_read_b64_tr_b16 a[86:87], v17 offset:20768
ds_read_b64_tr_b16 a[88:89], v17 offset:22528
ds_read_b64_tr_b16 a[90:91], v17 offset:22784
ds_read_b64_tr_b16 a[92:93], v17 offset:22560
ds_read_b64_tr_b16 a[94:95], v17 offset:22816
s_waitcnt lgkmcnt(0)
s_mov_b32 s44, 5242880
buffer_load_dword v250, v12, s[4:7], s44 offen
s_add_u32 m0, s45, 16384
s_mov_b32 s44, 5242880
buffer_load_dwordx4 v16, s[4:7], s44 offen lds
s_add_u32 m0, s45, 17408
s_mov_b32 s44, 5373952
buffer_load_dwordx4 v16, s[4:7], s44 offen lds
s_add_u32 m0, s45, 18432
s_mov_b32 s44, 5505024
buffer_load_dwordx4 v16, s[4:7], s44 offen lds
s_add_u32 m0, s45, 19456
s_mov_b32 s44, 5636096
buffer_load_dwordx4 v16, s[4:7], s44 offen lds
s_add_u32 m0, s45, 20480
s_mov_b32 s44, 5767168
buffer_load_dwordx4 v16, s[4:7], s44 offen lds
s_add_u32 m0, s45, 21504
s_mov_b32 s44, 5898240
buffer_load_dwordx4 v16, s[4:7], s44 offen lds
s_add_u32 m0, s45, 22528
s_mov_b32 s44, 6029312
buffer_load_dwordx4 v16, s[4:7], s44 offen lds
s_add_u32 m0, s45, 23552
s_mov_b32 s44, 6160384
buffer_load_dwordx4 v16, s[4:7], s44 offen lds
ds_read_b128 v[20:23], v8 offset:16384
ds_read_b128 v[24:27], v8 offset:18432
ds_read_b128 v[28:31], v9 offset:16384
ds_read_b128 v[32:35], v9 offset:18432
ds_read_b128 v[36:39], v8 offset:20480
ds_read_b128 v[40:43], v8 offset:22528
ds_read_b128 v[44:47], v9 offset:20480
ds_read_b128 v[48:51], v9 offset:22528
s_waitcnt lgkmcnt(0)
v_mfma_f32_16x16x32_bf16 v[52:55], v[20:23], a[64:67], v[52:55]
v_mfma_f32_16x16x32_bf16 v[56:59], v[20:23], a[68:71], v[56:59]
v_mfma_f32_16x16x32_bf16 v[60:63], v[24:27], a[64:67], v[60:63]
v_mfma_f32_16x16x32_bf16 v[64:67], v[24:27], a[68:71], v[64:67]
v_mfma_f32_16x16x32_bf16 v[52:55], v[28:31], a[72:75], v[52:55]
v_mfma_f32_16x16x32_bf16 v[56:59], v[28:31], a[76:79], v[56:59]
v_mfma_f32_16x16x32_bf16 v[60:63], v[32:35], a[72:75], v[60:63]
v_mfma_f32_16x16x32_bf16 v[64:67], v[32:35], a[76:79], v[64:67]
v_mfma_f32_16x16x32_bf16 v[52:55], v[36:39], a[80:83], v[52:55]
v_mfma_f32_16x16x32_bf16 v[56:59], v[36:39], a[84:87], v[56:59]
v_mfma_f32_16x16x32_bf16 v[60:63], v[40:43], a[80:83], v[60:63]
v_mfma_f32_16x16x32_bf16 v[64:67], v[40:43], a[84:87], v[64:67]
v_mfma_f32_16x16x32_bf16 v[52:55], v[44:47], a[88:91], v[52:55]
v_mfma_f32_16x16x32_bf16 v[56:59], v[44:47], a[92:95], v[56:59]
v_mfma_f32_16x16x32_bf16 v[60:63], v[48:51], a[88:91], v[60:63]
v_mfma_f32_16x16x32_bf16 v[64:67], v[48:51], a[92:95], v[64:67]
s_waitcnt vmcnt(18)
ds_read_b64_tr_b16 a[96:97], v17 offset:0
ds_read_b64_tr_b16 a[98:99], v17 offset:256
ds_read_b64_tr_b16 a[100:101], v17 offset:32
ds_read_b64_tr_b16 a[102:103], v17 offset:288
ds_read_b64_tr_b16 a[104:105], v17 offset:2048
ds_read_b64_tr_b16 a[106:107], v17 offset:2304
ds_read_b64_tr_b16 a[108:109], v17 offset:2080
ds_read_b64_tr_b16 a[110:111], v17 offset:2336
s_waitcnt lgkmcnt(0)
ds_read_b64_tr_b16 a[112:113], v17 offset:4096
ds_read_b64_tr_b16 a[114:115], v17 offset:4352
ds_read_b64_tr_b16 a[116:117], v17 offset:4128
ds_read_b64_tr_b16 a[118:119], v17 offset:4384
ds_read_b64_tr_b16 a[120:121], v17 offset:6144
ds_read_b64_tr_b16 a[122:123], v17 offset:6400
ds_read_b64_tr_b16 a[124:125], v17 offset:6176
ds_read_b64_tr_b16 a[126:127], v17 offset:6432
s_waitcnt lgkmcnt(0)
s_mov_b32 s44, 6291456
buffer_load_dword v250, v12, s[4:7], s44 offen
s_add_u32 m0, s45, 0
s_mov_b32 s44, 6291456
buffer_load_dwordx4 v16, s[4:7], s44 offen lds
s_add_u32 m0, s45, 1024
s_mov_b32 s44, 6422528
buffer_load_dwordx4 v16, s[4:7], s44 offen lds
s_add_u32 m0, s45, 2048
s_mov_b32 s44, 6553600
buffer_load_dwordx4 v16, s[4:7], s44 offen lds
s_add_u32 m0, s45, 3072
s_mov_b32 s44, 6684672
buffer_load_dwordx4 v16, s[4:7], s44 offen lds
s_add_u32 m0, s45, 4096
s_mov_b32 s44, 6815744
buffer_load_dwordx4 v16, s[4:7], s44 offen lds
s_add_u32 m0, s45, 5120
s_mov_b32 s44, 6946816
buffer_load_dwordx4 v16, s[4:7], s44 offen lds
s_add_u32 m0, s45, 6144
s_mov_b32 s44, 7077888
buffer_load_dwordx4 v16, s[4:7], s44 offen lds
s_add_u32 m0, s45, 7168
s_mov_b32 s44, 7208960
buffer_load_dwordx4 v16, s[4:7], s44 offen lds
ds_read_b128 v[20:23], v8 offset:24576
ds_read_b128 v[24:27], v8 offset:26624
ds_read_b128 v[28:31], v9 offset:24576
ds_read_b128 v[32:35], v9 offset:26624
ds_read_b128 v[36:39], v8 offset:28672
ds_read_b128 v[40:43], v8 offset:30720
ds_read_b128 v[44:47], v9 offset:28672
ds_read_b128 v[48:51], v9 offset:30720
s_waitcnt lgkmcnt(0)
v_mfma_f32_16x16x32_bf16 v[52:55], v[20:23], a[96:99], v[52:55]
v_mfma_f32_16x16x32_bf16 v[56:59], v[20:23], a[100:103], v[56:59]
v_mfma_f32_16x16x32_bf16 v[60:63], v[24:27], a[96:99], v[60:63]
v_mfma_f32_16x16x32_bf16 v[64:67], v[24:27], a[100:103], v[64:67]
v_mfma_f32_16x16x32_bf16 v[52:55], v[28:31], a[104:107], v[52:55]
v_mfma_f32_16x16x32_bf16 v[56:59], v[28:31], a[108:111], v[56:59]
v_mfma_f32_16x16x32_bf16 v[60:63], v[32:35], a[104:107], v[60:63]
v_mfma_f32_16x16x32_bf16 v[64:67], v[32:35], a[108:111], v[64:67]
v_mfma_f32_16x16x32_bf16 v[52:55], v[36:39], a[112:115], v[52:55]
v_mfma_f32_16x16x32_bf16 v[56:59], v[36:39], a[116:119], v[56:59]
v_mfma_f32_16x16x32_bf16 v[60:63], v[40:43], a[112:115], v[60:63]
v_mfma_f32_16x16x32_bf16 v[64:67], v[40:43], a[116:119], v[64:67]
v_mfma_f32_16x16x32_bf16 v[52:55], v[44:47], a[120:123], v[52:55]
v_mfma_f32_16x16x32_bf16 v[56:59], v[44:47], a[124:127], v[56:59]
v_mfma_f32_16x16x32_bf16 v[60:63], v[48:51], a[120:123], v[60:63]
v_mfma_f32_16x16x32_bf16 v[64:67], v[48:51], a[124:127], v[64:67]
s_waitcnt vmcnt(18)
ds_read_b64_tr_b16 a[128:129], v17 offset:8192
ds_read_b64_tr_b16 a[130:131], v17 offset:8448
ds_read_b64_tr_b16 a[132:133], v17 offset:8224
ds_read_b64_tr_b16 a[134:135], v17 offset:8480
ds_read_b64_tr_b16 a[136:137], v17 offset:10240
ds_read_b64_tr_b16 a[138:139], v17 offset:10496
ds_read_b64_tr_b16 a[140:141], v17 offset:10272
ds_read_b64_tr_b16 a[142:143], v17 offset:10528
s_waitcnt lgkmcnt(0)
ds_read_b64_tr_b16 a[144:145], v17 offset:12288
ds_read_b64_tr_b16 a[146:147], v17 offset:12544
ds_read_b64_tr_b16 a[148:149], v17 offset:12320
ds_read_b64_tr_b16 a[150:151], v17 offset:12576
ds_read_b64_tr_b16 a[152:153], v17 offset:14336
ds_read_b64_tr_b16 a[154:155], v17 offset:14592
ds_read_b64_tr_b16 a[156:157], v17 offset:14368
ds_read_b64_tr_b16 a[158:159], v17 offset:14624
s_waitcnt lgkmcnt(0)
s_mov_b32 s44, 7340032
buffer_load_dword v250, v12, s[4:7], s44 offen
s_add_u32 m0, s45, 8192
s_mov_b32 s44, 7340032
buffer_load_dwordx4 v16, s[4:7], s44 offen lds
s_add_u32 m0, s45, 9216
s_mov_b32 s44, 7471104
buffer_load_dwordx4 v16, s[4:7], s44 offen lds
s_add_u32 m0, s45, 10240
s_mov_b32 s44, 7602176
buffer_load_dwordx4 v16, s[4:7], s44 offen lds
s_add_u32 m0, s45, 11264
s_mov_b32 s44, 7733248
buffer_load_dwordx4 v16, s[4:7], s44 offen lds
s_add_u32 m0, s45, 12288
s_mov_b32 s44, 7864320
buffer_load_dwordx4 v16, s[4:7], s44 offen lds
s_add_u32 m0, s45, 13312
s_mov_b32 s44, 7995392
buffer_load_dwordx4 v16, s[4:7], s44 offen lds
s_add_u32 m0, s45, 14336
s_mov_b32 s44, 8126464
buffer_load_dwordx4 v16, s[4:7], s44 offen lds
s_add_u32 m0, s45, 15360
s_mov_b32 s44, 8257536
buffer_load_dwordx4 v16, s[4:7], s44 offen lds
ds_read_b128 v[20:23], v8 offset:32768
ds_read_b128 v[24:27], v8 offset:34816
ds_read_b128 v[28:31], v9 offset:32768
ds_read_b128 v[32:35], v9 offset:34816
ds_read_b128 v[36:39], v8 offset:36864
ds_read_b128 v[40:43], v8 offset:38912
ds_read_b128 v[44:47], v9 offset:36864
ds_read_b128 v[48:51], v9 offset:38912
s_waitcnt lgkmcnt(0)
v_mfma_f32_16x16x32_bf16 v[52:55], v[20:23], a[128:131], v[52:55]
v_mfma_f32_16x16x32_bf16 v[56:59], v[20:23], a[132:135], v[56:59]
v_mfma_f32_16x16x32_bf16 v[60:63], v[24:27], a[128:131], v[60:63]
v_mfma_f32_16x16x32_bf16 v[64:67], v[24:27], a[132:135], v[64:67]
v_mfma_f32_16x16x32_bf16 v[52:55], v[28:31], a[136:139], v[52:55]
v_mfma_f32_16x16x32_bf16 v[56:59], v[28:31], a[140:143], v[56:59]
v_mfma_f32_16x16x32_bf16 v[60:63], v[32:35], a[136:139], v[60:63]
v_mfma_f32_16x16x32_bf16 v[64:67], v[32:35], a[140:143], v[64:67]
v_mfma_f32_16x16x32_bf16 v[52:55], v[36:39], a[144:147], v[52:55]
v_mfma_f32_16x16x32_bf16 v[56:59], v[36:39], a[148:151], v[56:59]
v_mfma_f32_16x16x32_bf16 v[60:63], v[40:43], a[144:147], v[60:63]
v_mfma_f32_16x16x32_bf16 v[64:67], v[40:43], a[148:151], v[64:67]
v_mfma_f32_16x16x32_bf16 v[52:55], v[44:47], a[152:155], v[52:55]
v_mfma_f32_16x16x32_bf16 v[56:59], v[44:47], a[156:159], v[56:59]
v_mfma_f32_16x16x32_bf16 v[60:63], v[48:51], a[152:155], v[60:63]
v_mfma_f32_16x16x32_bf16 v[64:67], v[48:51], a[156:159], v[64:67]
s_waitcnt vmcnt(18)
ds_read_b64_tr_b16 a[160:161], v17 offset:16384
ds_read_b64_tr_b16 a[162:163], v17 offset:16640
ds_read_b64_tr_b16 a[164:165], v17 offset:16416
ds_read_b64_tr_b16 a[166:167], v17 offset:16672
ds_read_b64_tr_b16 a[168:169], v17 offset:18432
ds_read_b64_tr_b16 a[170:171], v17 offset:18688
ds_read_b64_tr_b16 a[172:173], v17 offset:18464
ds_read_b64_tr_b16 a[174:175], v17 offset:18720
s_waitcnt lgkmcnt(0)
ds_read_b64_tr_b16 a[176:177], v17 offset:20480
ds_read_b64_tr_b16 a[178:179], v17 offset:20736
ds_read_b64_tr_b16 a[180:181], v17 offset:20512
ds_read_b64_tr_b16 a[182:183], v17 offset:20768
ds_read_b64_tr_b16 a[184:185], v17 offset:22528
ds_read_b64_tr_b16 a[186:187], v17 offset:22784
ds_read_b64_tr_b16 a[188:189], v17 offset:22560
ds_read_b64_tr_b16 a[190:191], v17 offset:22816
s_waitcnt lgkmcnt(0)
ds_read_b128 v[20:23], v8 offset:40960
ds_read_b128 v[24:27], v8 offset:43008
ds_read_b128 v[28:31], v9 offset:40960
ds_read_b128 v[32:35], v9 offset:43008
ds_read_b128 v[36:39], v8 offset:45056
ds_read_b128 v[40:43], v8 offset:47104
ds_read_b128 v[44:47], v9 offset:45056
ds_read_b128 v[48:51], v9 offset:47104
s_waitcnt lgkmcnt(0)
v_mfma_f32_16x16x32_bf16 v[52:55], v[20:23], a[160:163], v[52:55]
v_mfma_f32_16x16x32_bf16 v[56:59], v[20:23], a[164:167], v[56:59]
v_mfma_f32_16x16x32_bf16 v[60:63], v[24:27], a[160:163], v[60:63]
v_mfma_f32_16x16x32_bf16 v[64:67], v[24:27], a[164:167], v[64:67]
v_mfma_f32_16x16x32_bf16 v[52:55], v[28:31], a[168:171], v[52:55]
v_mfma_f32_16x16x32_bf16 v[56:59], v[28:31], a[172:175], v[56:59]
v_mfma_f32_16x16x32_bf16 v[60:63], v[32:35], a[168:171], v[60:63]
v_mfma_f32_16x16x32_bf16 v[64:67], v[32:35], a[172:175], v[64:67]
v_mfma_f32_16x16x32_bf16 v[52:55], v[36:39], a[176:179], v[52:55]
v_mfma_f32_16x16x32_bf16 v[56:59], v[36:39], a[180:183], v[56:59]
v_mfma_f32_16x16x32_bf16 v[60:63], v[40:43], a[176:179], v[60:63]
v_mfma_f32_16x16x32_bf16 v[64:67], v[40:43], a[180:183], v[64:67]
v_mfma_f32_16x16x32_bf16 v[52:55], v[44:47], a[184:187], v[52:55]
v_mfma_f32_16x16x32_bf16 v[56:59], v[44:47], a[188:191], v[56:59]
v_mfma_f32_16x16x32_bf16 v[60:63], v[48:51], a[184:187], v[60:63]
v_mfma_f32_16x16x32_bf16 v[64:67], v[48:51], a[188:191], v[64:67]
s_waitcnt vmcnt(9)
ds_read_b64_tr_b16 a[192:193], v17 offset:0
ds_read_b64_tr_b16 a[194:195], v17 offset:256
ds_read_b64_tr_b16 a[196:197], v17 offset:32
ds_read_b64_tr_b16 a[198:199], v17 offset:288
ds_read_b64_tr_b16 a[200:201], v17 offset:2048
ds_read_b64_tr_b16 a[202:203], v17 offset:2304
ds_read_b64_tr_b16 a[204:205], v17 offset:2080
ds_read_b64_tr_b16 a[206:207], v17 offset:2336
s_waitcnt lgkmcnt(0)
ds_read_b64_tr_b16 a[208:209], v17 offset:4096
ds_read_b64_tr_b16 a[210:211], v17 offset:4352
ds_read_b64_tr_b16 a[212:213], v17 offset:4128
ds_read_b64_tr_b16 a[214:215], v17 offset:4384
ds_read_b64_tr_b16 a[216:217], v17 offset:6144
ds_read_b64_tr_b16 a[218:219], v17 offset:6400
ds_read_b64_tr_b16 a[220:221], v17 offset:6176
ds_read_b64_tr_b16 a[222:223], v17 offset:6432
s_waitcnt lgkmcnt(0)
ds_read_b128 v[20:23], v8 offset:49152
ds_read_b128 v[24:27], v8 offset:51200
ds_read_b128 v[28:31], v9 offset:49152
ds_read_b128 v[32:35], v9 offset:51200
ds_read_b128 v[36:39], v8 offset:53248
ds_read_b128 v[40:43], v8 offset:55296
ds_read_b128 v[44:47], v9 offset:53248
ds_read_b128 v[48:51], v9 offset:55296
s_waitcnt lgkmcnt(0)
v_mfma_f32_16x16x32_bf16 v[52:55], v[20:23], a[192:195], v[52:55]
v_mfma_f32_16x16x32_bf16 v[56:59], v[20:23], a[196:199], v[56:59]
v_mfma_f32_16x16x32_bf16 v[60:63], v[24:27], a[192:195], v[60:63]
v_mfma_f32_16x16x32_bf16 v[64:67], v[24:27], a[196:199], v[64:67]
v_mfma_f32_16x16x32_bf16 v[52:55], v[28:31], a[200:203], v[52:55]
v_mfma_f32_16x16x32_bf16 v[56:59], v[28:31], a[204:207], v[56:59]
v_mfma_f32_16x16x32_bf16 v[60:63], v[32:35], a[200:203], v[60:63]
v_mfma_f32_16x16x32_bf16 v[64:67], v[32:35], a[204:207], v[64:67]
v_mfma_f32_16x16x32_bf16 v[52:55], v[36:39], a[208:211], v[52:55]
v_mfma_f32_16x16x32_bf16 v[56:59], v[36:39], a[212:215], v[56:59]
v_mfma_f32_16x16x32_bf16 v[60:63], v[40:43], a[208:211], v[60:63]
v_mfma_f32_16x16x32_bf16 v[64:67], v[40:43], a[212:215], v[64:67]
v_mfma_f32_16x16x32_bf16 v[52:55], v[44:47], a[216:219], v[52:55]
v_mfma_f32_16x16x32_bf16 v[56:59], v[44:47], a[220:223], v[56:59]
v_mfma_f32_16x16x32_bf16 v[60:63], v[48:51], a[216:219], v[60:63]
v_mfma_f32_16x16x32_bf16 v[64:67], v[48:51], a[220:223], v[64:67]
s_waitcnt vmcnt(0)
ds_read_b64_tr_b16 a[224:225], v17 offset:8192
ds_read_b64_tr_b16 a[226:227], v17 offset:8448
ds_read_b64_tr_b16 a[228:229], v17 offset:8224
ds_read_b64_tr_b16 a[230:231], v17 offset:8480
ds_read_b64_tr_b16 a[232:233], v17 offset:10240
ds_read_b64_tr_b16 a[234:235], v17 offset:10496
ds_read_b64_tr_b16 a[236:237], v17 offset:10272
ds_read_b64_tr_b16 a[238:239], v17 offset:10528
s_waitcnt lgkmcnt(0)
ds_read_b64_tr_b16 a[240:241], v17 offset:12288
ds_read_b64_tr_b16 a[242:243], v17 offset:12544
ds_read_b64_tr_b16 a[244:245], v17 offset:12320
ds_read_b64_tr_b16 a[246:247], v17 offset:12576
ds_read_b64_tr_b16 a[248:249], v17 offset:14336
ds_read_b64_tr_b16 a[250:251], v17 offset:14592
ds_read_b64_tr_b16 a[252:253], v17 offset:14368
ds_read_b64_tr_b16 a[254:255], v17 offset:14624
s_waitcnt lgkmcnt(0)
ds_read_b128 v[20:23], v8 offset:57344
ds_read_b128 v[24:27], v8 offset:59392
ds_read_b128 v[28:31], v9 offset:57344
ds_read_b128 v[32:35], v9 offset:59392
ds_read_b128 v[36:39], v8 offset:61440
ds_read_b128 v[40:43], v8 offset:63488
ds_read_b128 v[44:47], v9 offset:61440
ds_read_b128 v[48:51], v9 offset:63488
s_waitcnt lgkmcnt(0)
v_mfma_f32_16x16x32_bf16 v[52:55], v[20:23], a[224:227], v[52:55]
v_mfma_f32_16x16x32_bf16 v[56:59], v[20:23], a[228:231], v[56:59]
v_mfma_f32_16x16x32_bf16 v[60:63], v[24:27], a[224:227], v[60:63]
v_mfma_f32_16x16x32_bf16 v[64:67], v[24:27], a[228:231], v[64:67]
v_mfma_f32_16x16x32_bf16 v[52:55], v[28:31], a[232:235], v[52:55]
v_mfma_f32_16x16x32_bf16 v[56:59], v[28:31], a[236:239], v[56:59]
v_mfma_f32_16x16x32_bf16 v[60:63], v[32:35], a[232:235], v[60:63]
v_mfma_f32_16x16x32_bf16 v[64:67], v[32:35], a[236:239], v[64:67]
v_mfma_f32_16x16x32_bf16 v[52:55], v[36:39], a[240:243], v[52:55]
v_mfma_f32_16x16x32_bf16 v[56:59], v[36:39], a[244:247], v[56:59]
v_mfma_f32_16x16x32_bf16 v[60:63], v[40:43], a[240:243], v[60:63]
v_mfma_f32_16x16x32_bf16 v[64:67], v[40:43], a[244:247], v[64:67]
v_mfma_f32_16x16x32_bf16 v[52:55], v[44:47], a[248:251], v[52:55]
v_mfma_f32_16x16x32_bf16 v[56:59], v[44:47], a[252:255], v[56:59]
v_mfma_f32_16x16x32_bf16 v[60:63], v[48:51], a[248:251], v[60:63]
v_mfma_f32_16x16x32_bf16 v[64:67], v[48:51], a[252:255], v[64:67]
s_barrier
s_mov_b32 s50, 0x10000
s_add_u32 m0, s46, 65536
s_nop 0
buffer_load_dwordx4 v6, s[8:11], s50 offen offset:0 lds
s_add_u32 m0, s46, 69504
s_nop 0
buffer_load_dwordx4 v6, s[8:11], s50 offen offset:128 lds
s_add_u32 m0, s46, 73472
s_nop 0
buffer_load_dwordx4 v6, s[8:11], s50 offen offset:256 lds
s_add_u32 m0, s46, 77440
s_nop 0
buffer_load_dwordx4 v6, s[8:11], s50 offen offset:384 lds
s_add_u32 m0, s46, 81408
s_nop 0
buffer_load_dwordx4 v6, s[8:11], s50 offen offset:512 lds
s_add_u32 m0, s46, 85376
s_nop 0
buffer_load_dwordx4 v6, s[8:11], s50 offen offset:640 lds
s_add_u32 m0, s46, 89344
s_nop 0
buffer_load_dwordx4 v6, s[8:11], s50 offen offset:768 lds
s_add_u32 m0, s46, 93312
s_nop 0
buffer_load_dwordx4 v6, s[8:11], s50 offen offset:896 lds
s_add_u32 m0, s46, 97280
s_nop 0
buffer_load_dwordx4 v6, s[8:11], s50 offen offset:1024 lds
s_add_u32 m0, s46, 101248
s_nop 0
buffer_load_dwordx4 v6, s[8:11], s50 offen offset:1152 lds
s_add_u32 m0, s46, 105216
s_nop 0
buffer_load_dwordx4 v6, s[8:11], s50 offen offset:1280 lds
s_add_u32 m0, s46, 109184
s_nop 0
buffer_load_dwordx4 v6, s[8:11], s50 offen offset:1408 lds
s_add_u32 m0, s46, 113152
s_nop 0
buffer_load_dwordx4 v6, s[8:11], s50 offen offset:1536 lds
s_add_u32 m0, s46, 117120
s_nop 0
buffer_load_dwordx4 v6, s[8:11], s50 offen offset:1664 lds
s_add_u32 m0, s46, 121088
s_nop 0
buffer_load_dwordx4 v6, s[8:11], s50 offen offset:1792 lds
s_add_u32 m0, s46, 125056
s_nop 0
buffer_load_dwordx4 v6, s[8:11], s50 offen offset:1920 lds
s_and_b32 s53, s47, 31
s_lshl_b32 s53, s53, 4
v_add_u32 v19, s53, v1
v_lshlrev_b32 v19, 7, v19
s_mov_b32 s42, 1
v_and_b32 v3, 15, v0
v_lshlrev_b32 v3, 4, v3
s_branch mega_kernel_syv
mega_kernel_syvw:
s_sleep 4
mega_kernel_syv:
buffer_load_dword v2, v3, s[72:75], 0 offen sc1
s_waitcnt vmcnt(0)
mega_kernel_syvp:
s_cmp_eq_u32 s95, 1
s_cbranch_scc0 mega_kernel_syvf
v_readlane_b32 s76, v2, 14
s_mov_b32 s98, 0
s_cmp_eq_u32 s76, 32
s_cbranch_scc0 mega_kernel_syvw
s_branch mega_kernel_syvd
mega_kernel_syvf:
s_mov_b32 s77, 0
s_mov_b32 s78, 0
v_readlane_b32 s76, v2, 0
s_add_u32 s77, s77, s76
s_xor_b32 s76, s76, 32
s_or_b32 s78, s78, s76
v_readlane_b32 s76, v2, 1
s_add_u32 s77, s77, s76
s_xor_b32 s76, s76, 32
s_or_b32 s78, s78, s76
v_readlane_b32 s76, v2, 2
s_add_u32 s77, s77, s76
s_xor_b32 s76, s76, 32
s_or_b32 s78, s78, s76
v_readlane_b32 s76, v2, 3
s_add_u32 s77, s77, s76
s_xor_b32 s76, s76, 32
s_or_b32 s78, s78, s76
v_readlane_b32 s76, v2, 4
s_add_u32 s77, s77, s76
s_xor_b32 s76, s76, 32
s_or_b32 s78, s78, s76
v_readlane_b32 s76, v2, 5
s_add_u32 s77, s77, s76
s_xor_b32 s76, s76, 32
s_or_b32 s78, s78, s76
v_readlane_b32 s76, v2, 6
s_add_u32 s77, s77, s76
s_xor_b32 s76, s76, 32
s_or_b32 s78, s78, s76
v_readlane_b32 s76, v2, 7
s_add_u32 s77, s77, s76
s_xor_b32 s76, s76, 32
s_or_b32 s78, s78, s76
s_cmp_eq_u32 s77, 256
s_cbranch_scc0 mega_kernel_syvw
v_mov_b32 v252, v2
s_cmp_eq_u32 s78, 0
s_cbranch_scc0 mega_kernel_slowent
v_readlane_b32 s76, v2, 10
v_readlane_b32 s77, v2, 8
s_cmp_eq_u32 s76, 32
s_cbranch_scc0 mega_kernel_syvw
s_cmp_gt_u32 s77, 16
s_cselect_b32 s98, 1, 0
mega_kernel_syvd:
s_lshr_b32 s44, s47, 3
s_xor_b32 s44, s44, s98
s_and_b32 s44, s44, 1
s_lshl_b32 s44, s44, 13
s_lshl_b32 s48, s47, 18
s_add_u32 s48, s48, s44
s_add_u32 s48, s48, 33554432
s_xor_b32 s44, s98, 1
s_lshl_b32 s44, s44, 13
s_lshl_b32 s49, s40, 7
s_add_u32 s49, s49, s44
s_lshl_b32 s44, s41, 2
s_add_u32 s49, s49, s44
s_add_u32 s49, s49, 69210112
v_mov_b32 v16, 0
v_cvt_pk_bf16_f32 v84, v52, v53
v_cvt_pk_bf16_f32 v85, v54, v55
v_cvt_pk_bf16_f32 v86, v60, v61
v_cvt_pk_bf16_f32 v87, v62, v63
v_cvt_pk_bf16_f32 v88, v56, v57
v_cvt_pk_bf16_f32 v89, v58, v59
v_cvt_pk_bf16_f32 v90, v64, v65
v_cvt_pk_bf16_f32 v91, v66, v67
s_add_u32 s51, s42, s47
s_sub_u32 s51, s51, 1
s_bfe_u32 s52, s51, 0x40002
s_lshl_b32 s52, s52, 14
s_and_b32 s51, s51, 3
s_lshl_b32 s51, s51, 11
s_add_u32 s51, s51, s52
s_add_u32 s51, s51, s48
buffer_store_dwordx4 v[84:87], v7, s[84:87], s51 offen sc1
buffer_store_dwordx4 v[88:91], v7, s[84:87], s51 offen offset:1024 sc1
s_waitcnt vmcnt(0)
v_mov_b32 v17, s42
s_mov_b64 exec, 1
buffer_store_dword v17, v16, s[84:87], s49 offen sc1
s_mov_b64 exec, -1
mega_kernel_v_loop:
s_waitcnt vmcnt(2)
s_barrier
s_add_u32 s50, s42, 1
s_min_u32 s50, s50, 63
s_lshl_b32 s50, s50, 16
ds_read_b128 v[20:23], v10 offset:0
ds_read_b128 v[24:27], v10 offset:2048
ds_read_b128 v[28:31], v11 offset:0
ds_read_b128 v[32:35], v11 offset:2048
ds_read_b128 v[36:39], v10 offset:4096
ds_read_b128 v[40:43], v10 offset:6144
s_waitcnt lgkmcnt(4)
v_mfma_f32_16x16x32_bf16 v[68:71], v[20:23], a[0:3], 0
ds_read_b128 v[44:47], v11 offset:4096
v_mfma_f32_16x16x32_bf16 v[72:75], v[20:23], a[4:7], 0
v_cvt_pk_bf16_f32 v84, v52, v53
v_cvt_pk_bf16_f32 v85, v54, v55
v_cvt_pk_bf16_f32 v86, v60, v61
v_mfma_f32_16x16x32_bf16 v[76:79], v[24:27], a[0:3], 0
ds_read_b128 v[48:51], v11 offset:6144
v_mfma_f32_16x16x32_bf16 v[80:83], v[24:27], a[4:7], 0
v_cvt_pk_bf16_f32 v87, v62, v63
v_cvt_pk_bf16_f32 v88, v56, v57
v_cvt_pk_bf16_f32 v89, v58, v59
s_waitcnt lgkmcnt(4)
v_mfma_f32_16x16x32_bf16 v[68:71], v[28:31], a[8:11], v[68:71]
ds_read_b128 v[20:23], v10 offset:8192
v_mfma_f32_16x16x32_bf16 v[72:75], v[28:31], a[12:15], v[72:75]
v_cvt_pk_bf16_f32 v90, v64, v65
v_cvt_pk_bf16_f32 v91, v66, v67
v_mfma_f32_16x16x32_bf16 v[76:79], v[32:35], a[8:11], v[76:79]
ds_read_b128 v[24:27], v10 offset:10240
v_mfma_f32_16x16x32_bf16 v[80:83], v[32:35], a[12:15], v[80:83]
s_add_u32 s51, s42, s47
s_sub_u32 s51, s51, 1
s_bfe_u32 s52, s51, 0x40002
s_lshl_b32 s52, s52, 14
s_waitcnt lgkmcnt(4)
v_mfma_f32_16x16x32_bf16 v[68:71], v[36:39], a[16:19], v[68:71]
ds_read_b128 v[28:31], v11 offset:8192
v_mfma_f32_16x16x32_bf16 v[72:75], v[36:39], a[20:23], v[72:75]
s_and_b32 s51, s51, 3
s_lshl_b32 s51, s51, 11
s_add_u32 s51, s51, s52
s_add_u32 s51, s51, s48
buffer_store_dwordx4 v[84:87], v7, s[84:87], s51 offen sc1
v_mfma_f32_16x16x32_bf16 v[76:79], v[40:43], a[16:19], v[76:79]
ds_read_b128 v[32:35], v11 offset:10240
v_mfma_f32_16x16x32_bf16 v[80:83], v[40:43], a[20:23], v[80:83]
buffer_store_dwordx4 v[88:91], v7, s[84:87], s51 offen offset:1024 sc1
s_waitcnt lgkmcnt(4)
v_mfma_f32_16x16x32_bf16 v[68:71], v[44:47], a[24:27], v[68:71]
ds_read_b128 v[36:39], v10 offset:12288
v_mfma_f32_16x16x32_bf16 v[72:75], v[44:47], a[28:31], v[72:75]
s_add_u32 m0, s46, 0
v_mfma_f32_16x16x32_bf16 v[76:79], v[48:51], a[24:27], v[76:79]
ds_read_b128 v[40:43], v10 offset:14336
v_mfma_f32_16x16x32_bf16 v[80:83], v[48:51], a[28:31], v[80:83]
buffer_load_dwordx4 v6, s[8:11], s50 offen offset:0 lds
s_waitcnt lgkmcnt(4)
v_mfma_f32_16x16x32_bf16 v[68:71], v[20:23], a[32:35], v[68:71]
ds_read_b128 v[44:47], v11 offset:12288
v_mfma_f32_16x16x32_bf16 v[72:75], v[20:23], a[36:39], v[72:75]
s_add_u32 m0, s46, 3968
v_mfma_f32_16x16x32_bf16 v[76:79], v[24:27], a[32:35], v[76:79]
ds_read_b128 v[48:51], v11 offset:14336
v_mfma_f32_16x16x32_bf16 v[80:83], v[24:27], a[36:39], v[80:83]
buffer_load_dwordx4 v6, s[8:11], s50 offen offset:128 lds
s_waitcnt lgkmcnt(4)
v_mfma_f32_16x16x32_bf16 v[68:71], v[28:31], a[40:43], v[68:71]
ds_read_b128 v[20:23], v10 offset:16384
v_mfma_f32_16x16x32_bf16 v[72:75], v[28:31], a[44:47], v[72:75]
s_add_u32 m0, s46, 7936
v_mfma_f32_16x16x32_bf16 v[76:79], v[32:35], a[40:43], v[76:79]
ds_read_b128 v[24:27], v10 offset:18432
v_mfma_f32_16x16x32_bf16 v[80:83], v[32:35], a[44:47], v[80:83]
buffer_load_dwordx4 v6, s[8:11], s50 offen offset:256 lds
s_waitcnt lgkmcnt(4)
v_mfma_f32_16x16x32_bf16 v[68:71], v[36:39], a[48:51], v[68:71]
ds_read_b128 v[28:31], v11 offset:16384
v_mfma_f32_16x16x32_bf16 v[72:75], v[36:39], a[52:55], v[72:75]
s_add_u32 m0, s46, 11904
v_mfma_f32_16x16x32_bf16 v[76:79], v[40:43], a[48:51], v[76:79]
ds_read_b128 v[32:35], v11 offset:18432
v_mfma_f32_16x16x32_bf16 v[80:83], v[40:43], a[52:55], v[80:83]
buffer_load_dwordx4 v6, s[8:11], s50 offen offset:384 lds
s_waitcnt lgkmcnt(4)
v_mfma_f32_16x16x32_bf16 v[68:71], v[44:47], a[56:59], v[68:71]
ds_read_b128 v[36:39], v10 offset:20480
v_mfma_f32_16x16x32_bf16 v[72:75], v[44:47], a[60:63], v[72:75]
s_add_u32 m0, s46, 15872
v_mfma_f32_16x16x32_bf16 v[76:79], v[48:51], a[56:59], v[76:79]
ds_read_b128 v[40:43], v10 offset:22528
v_mfma_f32_16x16x32_bf16 v[80:83], v[48:51], a[60:63], v[80:83]
buffer_load_dwordx4 v6, s[8:11], s50 offen offset:512 lds
s_waitcnt lgkmcnt(4)
v_mfma_f32_16x16x32_bf16 v[68:71], v[20:23], a[64:67], v[68:71]
ds_read_b128 v[44:47], v11 offset:20480
v_mfma_f32_16x16x32_bf16 v[72:75], v[20:23], a[68:71], v[72:75]
s_add_u32 m0, s46, 19840
v_mfma_f32_16x16x32_bf16 v[76:79], v[24:27], a[64:67], v[76:79]
ds_read_b128 v[48:51], v11 offset:22528
v_mfma_f32_16x16x32_bf16 v[80:83], v[24:27], a[68:71], v[80:83]
buffer_load_dwordx4 v6, s[8:11], s50 offen offset:640 lds
s_waitcnt lgkmcnt(4)
v_mfma_f32_16x16x32_bf16 v[68:71], v[28:31], a[72:75], v[68:71]
ds_read_b128 v[20:23], v10 offset:24576
v_mfma_f32_16x16x32_bf16 v[72:75], v[28:31], a[76:79], v[72:75]
s_add_u32 m0, s46, 23808
v_mfma_f32_16x16x32_bf16 v[76:79], v[32:35], a[72:75], v[76:79]
ds_read_b128 v[24:27], v10 offset:26624
v_mfma_f32_16x16x32_bf16 v[80:83], v[32:35], a[76:79], v[80:83]
buffer_load_dwordx4 v6, s[8:11], s50 offen offset:768 lds
s_waitcnt lgkmcnt(4)
v_mfma_f32_16x16x32_bf16 v[68:71], v[36:39], a[80:83], v[68:71]
ds_read_b128 v[28:31], v11 offset:24576
v_mfma_f32_16x16x32_bf16 v[72:75], v[36:39], a[84:87], v[72:75]
s_add_u32 m0, s46, 27776
v_mfma_f32_16x16x32_bf16 v[76:79], v[40:43], a[80:83], v[76:79]
ds_read_b128 v[32:35], v11 offset:26624
v_mfma_f32_16x16x32_bf16 v[80:83], v[40:43], a[84:87], v[80:83]
buffer_load_dwordx4 v6, s[8:11], s50 offen offset:896 lds
s_waitcnt lgkmcnt(4)
v_mfma_f32_16x16x32_bf16 v[68:71], v[44:47], a[88:91], v[68:71]
ds_read_b128 v[36:39], v10 offset:28672
v_mfma_f32_16x16x32_bf16 v[72:75], v[44:47], a[92:95], v[72:75]
s_add_u32 m0, s46, 31744
v_mfma_f32_16x16x32_bf16 v[76:79], v[48:51], a[88:91], v[76:79]
ds_read_b128 v[40:43], v10 offset:30720
v_mfma_f32_16x16x32_bf16 v[80:83], v[48:51], a[92:95], v[80:83]
buffer_load_dwordx4 v6, s[8:11], s50 offen offset:1024 lds
s_waitcnt lgkmcnt(4)
v_mfma_f32_16x16x32_bf16 v[68:71], v[20:23], a[96:99], v[68:71]
ds_read_b128 v[44:47], v11 offset:28672
v_mfma_f32_16x16x32_bf16 v[72:75], v[20:23], a[100:103], v[72:75]
s_add_u32 m0, s46, 35712
v_mfma_f32_16x16x32_bf16 v[76:79], v[24:27], a[96:99], v[76:79]
ds_read_b128 v[48:51], v11 offset:30720
v_mfma_f32_16x16x32_bf16 v[80:83], v[24:27], a[100:103], v[80:83]
buffer_load_dwordx4 v6, s[8:11], s50 offen offset:1152 lds
s_waitcnt lgkmcnt(4)
v_mfma_f32_16x16x32_bf16 v[68:71], v[28:31], a[104:107], v[68:71]
ds_read_b128 v[20:23], v10 offset:32768
v_mfma_f32_16x16x32_bf16 v[72:75], v[28:31], a[108:111], v[72:75]
s_add_u32 m0, s46, 39680
v_mfma_f32_16x16x32_bf16 v[76:79], v[32:35], a[104:107], v[76:79]
ds_read_b128 v[24:27], v10 offset:34816
v_mfma_f32_16x16x32_bf16 v[80:83], v[32:35], a[108:111], v[80:83]
buffer_load_dwordx4 v6, s[8:11], s50 offen offset:1280 lds
s_waitcnt lgkmcnt(4)
v_mfma_f32_16x16x32_bf16 v[68:71], v[36:39], a[112:115], v[68:71]
ds_read_b128 v[28:31], v11 offset:32768
v_mfma_f32_16x16x32_bf16 v[72:75], v[36:39], a[116:119], v[72:75]
s_add_u32 m0, s46, 43648
v_mfma_f32_16x16x32_bf16 v[76:79], v[40:43], a[112:115], v[76:79]
ds_read_b128 v[32:35], v11 offset:34816
v_mfma_f32_16x16x32_bf16 v[80:83], v[40:43], a[116:119], v[80:83]
buffer_load_dwordx4 v6, s[8:11], s50 offen offset:1408 lds
s_waitcnt lgkmcnt(4)
v_mfma_f32_16x16x32_bf16 v[68:71], v[44:47], a[120:123], v[68:71]
ds_read_b128 v[36:39], v10 offset:36864
v_mfma_f32_16x16x32_bf16 v[72:75], v[44:47], a[124:127], v[72:75]
s_add_u32 m0, s46, 47616
v_mfma_f32_16x16x32_bf16 v[76:79], v[48:51], a[120:123], v[76:79]
ds_read_b128 v[40:43], v10 offset:38912
v_mfma_f32_16x16x32_bf16 v[80:83], v[48:51], a[124:127], v[80:83]
buffer_load_dwordx4 v6, s[8:11], s50 offen offset:1536 lds
s_waitcnt lgkmcnt(4)
v_mfma_f32_16x16x32_bf16 v[68:71], v[20:23], a[128:131], v[68:71]
ds_read_b128 v[44:47], v11 offset:36864
v_mfma_f32_16x16x32_bf16 v[72:75], v[20:23], a[132:135], v[72:75]
s_add_u32 m0, s46, 51584
v_mfma_f32_16x16x32_bf16 v[76:79], v[24:27], a[128:131], v[76:79]
ds_read_b128 v[48:51], v11 offset:38912
v_mfma_f32_16x16x32_bf16 v[80:83], v[24:27], a[132:135], v[80:83]
buffer_load_dwordx4 v6, s[8:11], s50 offen offset:1664 lds
s_waitcnt lgkmcnt(4)
v_mfma_f32_16x16x32_bf16 v[68:71], v[28:31], a[136:139], v[68:71]
ds_read_b128 v[20:23], v10 offset:40960
v_mfma_f32_16x16x32_bf16 v[72:75], v[28:31], a[140:143], v[72:75]
s_add_u32 m0, s46, 55552
v_mfma_f32_16x16x32_bf16 v[76:79], v[32:35], a[136:139], v[76:79]
ds_read_b128 v[24:27], v10 offset:43008
v_mfma_f32_16x16x32_bf16 v[80:83], v[32:35], a[140:143], v[80:83]
buffer_load_dwordx4 v6, s[8:11], s50 offen offset:1792 lds
s_waitcnt lgkmcnt(4)
v_mfma_f32_16x16x32_bf16 v[68:71], v[36:39], a[144:147], v[68:71]
ds_read_b128 v[28:31], v11 offset:40960
v_mfma_f32_16x16x32_bf16 v[72:75], v[36:39], a[148:151], v[72:75]
s_add_u32 m0, s46, 59520
v_mfma_f32_16x16x32_bf16 v[76:79], v[40:43], a[144:147], v[76:79]
ds_read_b128 v[32:35], v11 offset:43008
v_mfma_f32_16x16x32_bf16 v[80:83], v[40:43], a[148:151], v[80:83]
buffer_load_dwordx4 v6, s[8:11], s50 offen offset:1920 lds
s_waitcnt lgkmcnt(4)
v_mfma_f32_16x16x32_bf16 v[68:71], v[44:47], a[152:155], v[68:71]
ds_read_b128 v[36:39], v10 offset:45056
v_mfma_f32_16x16x32_bf16 v[72:75], v[44:47], a[156:159], v[72:75]
v_mfma_f32_16x16x32_bf16 v[76:79], v[48:51], a[152:155], v[76:79]
ds_read_b128 v[40:43], v10 offset:47104
v_mfma_f32_16x16x32_bf16 v[80:83], v[48:51], a[156:159], v[80:83]
s_waitcnt lgkmcnt(4)
v_mfma_f32_16x16x32_bf16 v[68:71], v[20:23], a[160:163], v[68:71]
ds_read_b128 v[44:47], v11 offset:45056
v_mfma_f32_16x16x32_bf16 v[72:75], v[20:23], a[164:167], v[72:75]
v_mfma_f32_16x16x32_bf16 v[76:79], v[24:27], a[160:163], v[76:79]
ds_read_b128 v[48:51], v11 offset:47104
v_mfma_f32_16x16x32_bf16 v[80:83], v[24:27], a[164:167], v[80:83]
s_waitcnt lgkmcnt(4)
v_mfma_f32_16x16x32_bf16 v[68:71], v[28:31], a[168:171], v[68:71]
ds_read_b128 v[20:23], v10 offset:49152
v_mfma_f32_16x16x32_bf16 v[72:75], v[28:31], a[172:175], v[72:75]
s_waitcnt vmcnt(16)
v_mov_b32 v17, s42
s_mov_b64 exec, 1
buffer_store_dword v17, v16, s[84:87], s49 offen sc1
s_mov_b64 exec, -1
v_mfma_f32_16x16x32_bf16 v[76:79], v[32:35], a[168:171], v[76:79]
ds_read_b128 v[24:27], v10 offset:51200
v_mfma_f32_16x16x32_bf16 v[80:83], v[32:35], a[172:175], v[80:83]
s_waitcnt lgkmcnt(4)
v_mfma_f32_16x16x32_bf16 v[68:71], v[36:39], a[176:179], v[68:71]
ds_read_b128 v[28:31], v11 offset:49152
v_mfma_f32_16x16x32_bf16 v[72:75], v[36:39], a[180:183], v[72:75]
s_add_u32 s53, s42, 3
s_min_u32 s53, s53, 63
s_lshl_b32 s53, s53, 16
s_mov_b64 exec, 0xffff
buffer_load_dword v250, v19, s[8:11], s53 offen
s_mov_b64 exec, -1
v_mfma_f32_16x16x32_bf16 v[76:79], v[40:43], a[176:179], v[76:79]
ds_read_b128 v[32:35], v11 offset:51200
v_mfma_f32_16x16x32_bf16 v[80:83], v[40:43], a[180:183], v[80:83]
s_waitcnt lgkmcnt(4)
v_mfma_f32_16x16x32_bf16 v[68:71], v[44:47], a[184:187], v[68:71]
ds_read_b128 v[36:39], v10 offset:53248
v_mfma_f32_16x16x32_bf16 v[72:75], v[44:47], a[188:191], v[72:75]
v_mfma_f32_16x16x32_bf16 v[76:79], v[48:51], a[184:187], v[76:79]
ds_read_b128 v[40:43], v10 offset:55296
v_mfma_f32_16x16x32_bf16 v[80:83], v[48:51], a[188:191], v[80:83]
s_waitcnt lgkmcnt(4)
v_mfma_f32_16x16x32_bf16 v[68:71], v[20:23], a[192:195], v[68:71]
ds_read_b128 v[44:47], v11 offset:53248
v_mfma_f32_16x16x32_bf16 v[72:75], v[20:23], a[196:199], v[72:75]
v_mfma_f32_16x16x32_bf16 v[76:79], v[24:27], a[192:195], v[76:79]
ds_read_b128 v[48:51], v11 offset:55296
v_mfma_f32_16x16x32_bf16 v[80:83], v[24:27], a[196:199], v[80:83]
s_waitcnt lgkmcnt(4)
v_mfma_f32_16x16x32_bf16 v[68:71], v[28:31], a[200:203], v[68:71]
ds_read_b128 v[20:23], v10 offset:57344
v_mfma_f32_16x16x32_bf16 v[72:75], v[28:31], a[204:207], v[72:75]
v_mfma_f32_16x16x32_bf16 v[76:79], v[32:35], a[200:203], v[76:79]
ds_read_b128 v[24:27], v10 offset:59392
v_mfma_f32_16x16x32_bf16 v[80:83], v[32:35], a[204:207], v[80:83]
s_waitcnt lgkmcnt(4)
v_mfma_f32_16x16x32_bf16 v[68:71], v[36:39], a[208:211], v[68:71]
ds_read_b128 v[28:31], v11 offset:57344
v_mfma_f32_16x16x32_bf16 v[72:75], v[36:39], a[212:215], v[72:75]
v_mfma_f32_16x16x32_bf16 v[76:79], v[40:43], a[208:211], v[76:79]
ds_read_b128 v[32:35], v11 offset:59392
v_mfma_f32_16x16x32_bf16 v[80:83], v[40:43], a[212:215], v[80:83]
s_waitcnt lgkmcnt(4)
v_mfma_f32_16x16x32_bf16 v[68:71], v[44:47], a[216:219], v[68:71]
ds_read_b128 v[36:39], v10 offset:61440
v_mfma_f32_16x16x32_bf16 v[72:75], v[44:47], a[220:223], v[72:75]
v_mfma_f32_16x16x32_bf16 v[76:79], v[48:51], a[216:219], v[76:79]
ds_read_b128 v[40:43], v10 offset:63488
v_mfma_f32_16x16x32_bf16 v[80:83], v[48:51], a[220:223], v[80:83]
s_waitcnt lgkmcnt(4)
v_mfma_f32_16x16x32_bf16 v[68:71], v[20:23], a[224:227], v[68:71]
ds_read_b128 v[44:47], v11 offset:61440
v_mfma_f32_16x16x32_bf16 v[72:75], v[20:23], a[228:231], v[72:75]
v_mfma_f32_16x16x32_bf16 v[76:79], v[24:27], a[224:227], v[76:79]
ds_read_b128 v[48:51], v11 offset:63488
v_mfma_f32_16x16x32_bf16 v[80:83], v[24:27], a[228:231], v[80:83]
s_waitcnt lgkmcnt(5)
v_mfma_f32_16x16x32_bf16 v[68:71], v[28:31], a[232:235], v[68:71]
v_mfma_f32_16x16x32_bf16 v[72:75], v[28:31], a[236:239], v[72:75]
s_waitcnt lgkmcnt(4)
v_mfma_f32_16x16x32_bf16 v[76:79], v[32:35], a[232:235], v[76:79]
v_mfma_f32_16x16x32_bf16 v[80:83], v[32:35], a[236:239], v[80:83]
s_waitcnt lgkmcnt(3)
v_mfma_f32_16x16x32_bf16 v[68:71], v[36:39], a[240:243], v[68:71]
v_mfma_f32_16x16x32_bf16 v[72:75], v[36:39], a[244:247], v[72:75]
s_waitcnt lgkmcnt(2)
v_mfma_f32_16x16x32_bf16 v[76:79], v[40:43], a[240:243], v[76:79]
v_mfma_f32_16x16x32_bf16 v[80:83], v[40:43], a[244:247], v[80:83]
s_waitcnt lgkmcnt(1)
v_mfma_f32_16x16x32_bf16 v[68:71], v[44:47], a[248:251], v[68:71]
v_mfma_f32_16x16x32_bf16 v[72:75], v[44:47], a[252:255], v[72:75]
s_waitcnt lgkmcnt(0)
v_mfma_f32_16x16x32_bf16 v[76:79], v[48:51], a[248:251], v[76:79]
v_mfma_f32_16x16x32_bf16 v[80:83], v[48:51], a[252:255], v[80:83]
s_add_u32 s42, s42, 1
s_cmp_eq_u32 s42, 64
s_cbranch_scc1 mega_kernel_v_fin
mega_kernel_v_mid:
s_waitcnt vmcnt(2)
s_barrier
s_add_u32 s50, s42, 1
s_min_u32 s50, s50, 63
s_lshl_b32 s50, s50, 16
ds_read_b128 v[20:23], v8 offset:0
ds_read_b128 v[24:27], v8 offset:2048
ds_read_b128 v[28:31], v9 offset:0
ds_read_b128 v[32:35], v9 offset:2048
ds_read_b128 v[36:39], v8 offset:4096
ds_read_b128 v[40:43], v8 offset:6144
s_waitcnt lgkmcnt(4)
v_mfma_f32_16x16x32_bf16 v[52:55], v[20:23], a[0:3], 0
ds_read_b128 v[44:47], v9 offset:4096
v_mfma_f32_16x16x32_bf16 v[56:59], v[20:23], a[4:7], 0
v_cvt_pk_bf16_f32 v84, v68, v69
v_cvt_pk_bf16_f32 v85, v70, v71
v_cvt_pk_bf16_f32 v86, v76, v77
v_mfma_f32_16x16x32_bf16 v[60:63], v[24:27], a[0:3], 0
ds_read_b128 v[48:51], v9 offset:6144
v_mfma_f32_16x16x32_bf16 v[64:67], v[24:27], a[4:7], 0
v_cvt_pk_bf16_f32 v87, v78, v79
v_cvt_pk_bf16_f32 v88, v72, v73
v_cvt_pk_bf16_f32 v89, v74, v75
s_waitcnt lgkmcnt(4)
v_mfma_f32_16x16x32_bf16 v[52:55], v[28:31], a[8:11], v[52:55]
ds_read_b128 v[20:23], v8 offset:8192
v_mfma_f32_16x16x32_bf16 v[56:59], v[28:31], a[12:15], v[56:59]
v_cvt_pk_bf16_f32 v90, v80, v81
v_cvt_pk_bf16_f32 v91, v82, v83
v_mfma_f32_16x16x32_bf16 v[60:63], v[32:35], a[8:11], v[60:63]
ds_read_b128 v[24:27], v8 offset:10240
v_mfma_f32_16x16x32_bf16 v[64:67], v[32:35], a[12:15], v[64:67]
s_add_u32 s51, s42, s47
s_sub_u32 s51, s51, 1
s_bfe_u32 s52, s51, 0x40002
s_lshl_b32 s52, s52, 14
s_waitcnt lgkmcnt(4)
v_mfma_f32_16x16x32_bf16 v[52:55], v[36:39], a[16:19], v[52:55]
ds_read_b128 v[28:31], v9 offset:8192
v_mfma_f32_16x16x32_bf16 v[56:59], v[36:39], a[20:23], v[56:59]
s_and_b32 s51, s51, 3
s_lshl_b32 s51, s51, 11
s_add_u32 s51, s51, s52
s_add_u32 s51, s51, s48
buffer_store_dwordx4 v[84:87], v7, s[84:87], s51 offen sc1
v_mfma_f32_16x16x32_bf16 v[60:63], v[40:43], a[16:19], v[60:63]
ds_read_b128 v[32:35], v9 offset:10240
v_mfma_f32_16x16x32_bf16 v[64:67], v[40:43], a[20:23], v[64:67]
buffer_store_dwordx4 v[88:91], v7, s[84:87], s51 offen offset:1024 sc1
s_waitcnt lgkmcnt(4)
v_mfma_f32_16x16x32_bf16 v[52:55], v[44:47], a[24:27], v[52:55]
ds_read_b128 v[36:39], v8 offset:12288
v_mfma_f32_16x16x32_bf16 v[56:59], v[44:47], a[28:31], v[56:59]
s_add_u32 m0, s46, 65536
v_mfma_f32_16x16x32_bf16 v[60:63], v[48:51], a[24:27], v[60:63]
ds_read_b128 v[40:43], v8 offset:14336
v_mfma_f32_16x16x32_bf16 v[64:67], v[48:51], a[28:31], v[64:67]
buffer_load_dwordx4 v6, s[8:11], s50 offen offset:0 lds
s_waitcnt lgkmcnt(4)
v_mfma_f32_16x16x32_bf16 v[52:55], v[20:23], a[32:35], v[52:55]
ds_read_b128 v[44:47], v9 offset:12288
v_mfma_f32_16x16x32_bf16 v[56:59], v[20:23], a[36:39], v[56:59]
s_add_u32 m0, s46, 69504
v_mfma_f32_16x16x32_bf16 v[60:63], v[24:27], a[32:35], v[60:63]
ds_read_b128 v[48:51], v9 offset:14336
v_mfma_f32_16x16x32_bf16 v[64:67], v[24:27], a[36:39], v[64:67]
buffer_load_dwordx4 v6, s[8:11], s50 offen offset:128 lds
s_waitcnt lgkmcnt(4)
v_mfma_f32_16x16x32_bf16 v[52:55], v[28:31], a[40:43], v[52:55]
ds_read_b128 v[20:23], v8 offset:16384
v_mfma_f32_16x16x32_bf16 v[56:59], v[28:31], a[44:47], v[56:59]
s_add_u32 m0, s46, 73472
v_mfma_f32_16x16x32_bf16 v[60:63], v[32:35], a[40:43], v[60:63]
ds_read_b128 v[24:27], v8 offset:18432
v_mfma_f32_16x16x32_bf16 v[64:67], v[32:35], a[44:47], v[64:67]
buffer_load_dwordx4 v6, s[8:11], s50 offen offset:256 lds
s_waitcnt lgkmcnt(4)
v_mfma_f32_16x16x32_bf16 v[52:55], v[36:39], a[48:51], v[52:55]
ds_read_b128 v[28:31], v9 offset:16384
v_mfma_f32_16x16x32_bf16 v[56:59], v[36:39], a[52:55], v[56:59]
s_add_u32 m0, s46, 77440
v_mfma_f32_16x16x32_bf16 v[60:63], v[40:43], a[48:51], v[60:63]
ds_read_b128 v[32:35], v9 offset:18432
v_mfma_f32_16x16x32_bf16 v[64:67], v[40:43], a[52:55], v[64:67]
buffer_load_dwordx4 v6, s[8:11], s50 offen offset:384 lds
s_waitcnt lgkmcnt(4)
v_mfma_f32_16x16x32_bf16 v[52:55], v[44:47], a[56:59], v[52:55]
ds_read_b128 v[36:39], v8 offset:20480
v_mfma_f32_16x16x32_bf16 v[56:59], v[44:47], a[60:63], v[56:59]
s_add_u32 m0, s46, 81408
v_mfma_f32_16x16x32_bf16 v[60:63], v[48:51], a[56:59], v[60:63]
ds_read_b128 v[40:43], v8 offset:22528
v_mfma_f32_16x16x32_bf16 v[64:67], v[48:51], a[60:63], v[64:67]
buffer_load_dwordx4 v6, s[8:11], s50 offen offset:512 lds
s_waitcnt lgkmcnt(4)
v_mfma_f32_16x16x32_bf16 v[52:55], v[20:23], a[64:67], v[52:55]
ds_read_b128 v[44:47], v9 offset:20480
v_mfma_f32_16x16x32_bf16 v[56:59], v[20:23], a[68:71], v[56:59]
s_add_u32 m0, s46, 85376
v_mfma_f32_16x16x32_bf16 v[60:63], v[24:27], a[64:67], v[60:63]
ds_read_b128 v[48:51], v9 offset:22528
v_mfma_f32_16x16x32_bf16 v[64:67], v[24:27], a[68:71], v[64:67]
buffer_load_dwordx4 v6, s[8:11], s50 offen offset:640 lds
s_waitcnt lgkmcnt(4)
v_mfma_f32_16x16x32_bf16 v[52:55], v[28:31], a[72:75], v[52:55]
ds_read_b128 v[20:23], v8 offset:24576
v_mfma_f32_16x16x32_bf16 v[56:59], v[28:31], a[76:79], v[56:59]
s_add_u32 m0, s46, 89344
v_mfma_f32_16x16x32_bf16 v[60:63], v[32:35], a[72:75], v[60:63]
ds_read_b128 v[24:27], v8 offset:26624
v_mfma_f32_16x16x32_bf16 v[64:67], v[32:35], a[76:79], v[64:67]
buffer_load_dwordx4 v6, s[8:11], s50 offen offset:768 lds
s_waitcnt lgkmcnt(4)
v_mfma_f32_16x16x32_bf16 v[52:55], v[36:39], a[80:83], v[52:55]
ds_read_b128 v[28:31], v9 offset:24576
v_mfma_f32_16x16x32_bf16 v[56:59], v[36:39], a[84:87], v[56:59]
s_add_u32 m0, s46, 93312
v_mfma_f32_16x16x32_bf16 v[60:63], v[40:43], a[80:83], v[60:63]
ds_read_b128 v[32:35], v9 offset:26624
v_mfma_f32_16x16x32_bf16 v[64:67], v[40:43], a[84:87], v[64:67]
buffer_load_dwordx4 v6, s[8:11], s50 offen offset:896 lds
s_waitcnt lgkmcnt(4)
v_mfma_f32_16x16x32_bf16 v[52:55], v[44:47], a[88:91], v[52:55]
ds_read_b128 v[36:39], v8 offset:28672
v_mfma_f32_16x16x32_bf16 v[56:59], v[44:47], a[92:95], v[56:59]
s_add_u32 m0, s46, 97280
v_mfma_f32_16x16x32_bf16 v[60:63], v[48:51], a[88:91], v[60:63]
ds_read_b128 v[40:43], v8 offset:30720
v_mfma_f32_16x16x32_bf16 v[64:67], v[48:51], a[92:95], v[64:67]
buffer_load_dwordx4 v6, s[8:11], s50 offen offset:1024 lds
s_waitcnt lgkmcnt(4)
v_mfma_f32_16x16x32_bf16 v[52:55], v[20:23], a[96:99], v[52:55]
ds_read_b128 v[44:47], v9 offset:28672
v_mfma_f32_16x16x32_bf16 v[56:59], v[20:23], a[100:103], v[56:59]
s_add_u32 m0, s46, 101248
v_mfma_f32_16x16x32_bf16 v[60:63], v[24:27], a[96:99], v[60:63]
ds_read_b128 v[48:51], v9 offset:30720
v_mfma_f32_16x16x32_bf16 v[64:67], v[24:27], a[100:103], v[64:67]
buffer_load_dwordx4 v6, s[8:11], s50 offen offset:1152 lds
s_waitcnt lgkmcnt(4)
v_mfma_f32_16x16x32_bf16 v[52:55], v[28:31], a[104:107], v[52:55]
ds_read_b128 v[20:23], v8 offset:32768
v_mfma_f32_16x16x32_bf16 v[56:59], v[28:31], a[108:111], v[56:59]
s_add_u32 m0, s46, 105216
v_mfma_f32_16x16x32_bf16 v[60:63], v[32:35], a[104:107], v[60:63]
ds_read_b128 v[24:27], v8 offset:34816
v_mfma_f32_16x16x32_bf16 v[64:67], v[32:35], a[108:111], v[64:67]
buffer_load_dwordx4 v6, s[8:11], s50 offen offset:1280 lds
s_waitcnt lgkmcnt(4)
v_mfma_f32_16x16x32_bf16 v[52:55], v[36:39], a[112:115], v[52:55]
ds_read_b128 v[28:31], v9 offset:32768
v_mfma_f32_16x16x32_bf16 v[56:59], v[36:39], a[116:119], v[56:59]
s_add_u32 m0, s46, 109184
v_mfma_f32_16x16x32_bf16 v[60:63], v[40:43], a[112:115], v[60:63]
ds_read_b128 v[32:35], v9 offset:34816
v_mfma_f32_16x16x32_bf16 v[64:67], v[40:43], a[116:119], v[64:67]
buffer_load_dwordx4 v6, s[8:11], s50 offen offset:1408 lds
s_waitcnt lgkmcnt(4)
v_mfma_f32_16x16x32_bf16 v[52:55], v[44:47], a[120:123], v[52:55]
ds_read_b128 v[36:39], v8 offset:36864
v_mfma_f32_16x16x32_bf16 v[56:59], v[44:47], a[124:127], v[56:59]
s_add_u32 m0, s46, 113152
v_mfma_f32_16x16x32_bf16 v[60:63], v[48:51], a[120:123], v[60:63]
ds_read_b128 v[40:43], v8 offset:38912
v_mfma_f32_16x16x32_bf16 v[64:67], v[48:51], a[124:127], v[64:67]
buffer_load_dwordx4 v6, s[8:11], s50 offen offset:1536 lds
s_waitcnt lgkmcnt(4)
v_mfma_f32_16x16x32_bf16 v[52:55], v[20:23], a[128:131], v[52:55]
ds_read_b128 v[44:47], v9 offset:36864
v_mfma_f32_16x16x32_bf16 v[56:59], v[20:23], a[132:135], v[56:59]
s_add_u32 m0, s46, 117120
v_mfma_f32_16x16x32_bf16 v[60:63], v[24:27], a[128:131], v[60:63]
ds_read_b128 v[48:51], v9 offset:38912
v_mfma_f32_16x16x32_bf16 v[64:67], v[24:27], a[132:135], v[64:67]
buffer_load_dwordx4 v6, s[8:11], s50 offen offset:1664 lds
s_waitcnt lgkmcnt(4)
v_mfma_f32_16x16x32_bf16 v[52:55], v[28:31], a[136:139], v[52:55]
ds_read_b128 v[20:23], v8 offset:40960
v_mfma_f32_16x16x32_bf16 v[56:59], v[28:31], a[140:143], v[56:59]
s_add_u32 m0, s46, 121088
v_mfma_f32_16x16x32_bf16 v[60:63], v[32:35], a[136:139], v[60:63]
ds_read_b128 v[24:27], v8 offset:43008
v_mfma_f32_16x16x32_bf16 v[64:67], v[32:35], a[140:143], v[64:67]
buffer_load_dwordx4 v6, s[8:11], s50 offen offset:1792 lds
s_waitcnt lgkmcnt(4)
v_mfma_f32_16x16x32_bf16 v[52:55], v[36:39], a[144:147], v[52:55]
ds_read_b128 v[28:31], v9 offset:40960
v_mfma_f32_16x16x32_bf16 v[56:59], v[36:39], a[148:151], v[56:59]
s_add_u32 m0, s46, 125056
v_mfma_f32_16x16x32_bf16 v[60:63], v[40:43], a[144:147], v[60:63]
ds_read_b128 v[32:35], v9 offset:43008
v_mfma_f32_16x16x32_bf16 v[64:67], v[40:43], a[148:151], v[64:67]
buffer_load_dwordx4 v6, s[8:11], s50 offen offset:1920 lds
s_waitcnt lgkmcnt(4)
v_mfma_f32_16x16x32_bf16 v[52:55], v[44:47], a[152:155], v[52:55]
ds_read_b128 v[36:39], v8 offset:45056
v_mfma_f32_16x16x32_bf16 v[56:59], v[44:47], a[156:159], v[56:59]
v_mfma_f32_16x16x32_bf16 v[60:63], v[48:51], a[152:155], v[60:63]
ds_read_b128 v[40:43], v8 offset:47104
v_mfma_f32_16x16x32_bf16 v[64:67], v[48:51], a[156:159], v[64:67]
s_waitcnt lgkmcnt(4)
v_mfma_f32_16x16x32_bf16 v[52:55], v[20:23], a[160:163], v[52:55]
ds_read_b128 v[44:47], v9 offset:45056
v_mfma_f32_16x16x32_bf16 v[56:59], v[20:23], a[164:167], v[56:59]
v_mfma_f32_16x16x32_bf16 v[60:63], v[24:27], a[160:163], v[60:63]
ds_read_b128 v[48:51], v9 offset:47104
v_mfma_f32_16x16x32_bf16 v[64:67], v[24:27], a[164:167], v[64:67]
s_waitcnt lgkmcnt(4)
v_mfma_f32_16x16x32_bf16 v[52:55], v[28:31], a[168:171], v[52:55]
ds_read_b128 v[20:23], v8 offset:49152
v_mfma_f32_16x16x32_bf16 v[56:59], v[28:31], a[172:175], v[56:59]
s_waitcnt vmcnt(16)
v_mov_b32 v17, s42
s_mov_b64 exec, 1
buffer_store_dword v17, v16, s[84:87], s49 offen sc1
s_mov_b64 exec, -1
v_mfma_f32_16x16x32_bf16 v[60:63], v[32:35], a[168:171], v[60:63]
ds_read_b128 v[24:27], v8 offset:51200
v_mfma_f32_16x16x32_bf16 v[64:67], v[32:35], a[172:175], v[64:67]
s_waitcnt lgkmcnt(4)
v_mfma_f32_16x16x32_bf16 v[52:55], v[36:39], a[176:179], v[52:55]
ds_read_b128 v[28:31], v9 offset:49152
v_mfma_f32_16x16x32_bf16 v[56:59], v[36:39], a[180:183], v[56:59]
s_add_u32 s53, s42, 3
s_min_u32 s53, s53, 63
s_lshl_b32 s53, s53, 16
s_mov_b64 exec, 0xffff
buffer_load_dword v250, v19, s[8:11], s53 offen
s_mov_b64 exec, -1
v_mfma_f32_16x16x32_bf16 v[60:63], v[40:43], a[176:179], v[60:63]
ds_read_b128 v[32:35], v9 offset:51200
v_mfma_f32_16x16x32_bf16 v[64:67], v[40:43], a[180:183], v[64:67]
s_waitcnt lgkmcnt(4)
v_mfma_f32_16x16x32_bf16 v[52:55], v[44:47], a[184:187], v[52:55]
ds_read_b128 v[36:39], v8 offset:53248
v_mfma_f32_16x16x32_bf16 v[56:59], v[44:47], a[188:191], v[56:59]
v_mfma_f32_16x16x32_bf16 v[60:63], v[48:51], a[184:187], v[60:63]
ds_read_b128 v[40:43], v8 offset:55296
v_mfma_f32_16x16x32_bf16 v[64:67], v[48:51], a[188:191], v[64:67]
s_waitcnt lgkmcnt(4)
v_mfma_f32_16x16x32_bf16 v[52:55], v[20:23], a[192:195], v[52:55]
ds_read_b128 v[44:47], v9 offset:53248
v_mfma_f32_16x16x32_bf16 v[56:59], v[20:23], a[196:199], v[56:59]
v_mfma_f32_16x16x32_bf16 v[60:63], v[24:27], a[192:195], v[60:63]
ds_read_b128 v[48:51], v9 offset:55296
v_mfma_f32_16x16x32_bf16 v[64:67], v[24:27], a[196:199], v[64:67]
s_waitcnt lgkmcnt(4)
v_mfma_f32_16x16x32_bf16 v[52:55], v[28:31], a[200:203], v[52:55]
ds_read_b128 v[20:23], v8 offset:57344
v_mfma_f32_16x16x32_bf16 v[56:59], v[28:31], a[204:207], v[56:59]
v_mfma_f32_16x16x32_bf16 v[60:63], v[32:35], a[200:203], v[60:63]
ds_read_b128 v[24:27], v8 offset:59392
v_mfma_f32_16x16x32_bf16 v[64:67], v[32:35], a[204:207], v[64:67]
s_waitcnt lgkmcnt(4)
v_mfma_f32_16x16x32_bf16 v[52:55], v[36:39], a[208:211], v[52:55]
ds_read_b128 v[28:31], v9 offset:57344
v_mfma_f32_16x16x32_bf16 v[56:59], v[36:39], a[212:215], v[56:59]
v_mfma_f32_16x16x32_bf16 v[60:63], v[40:43], a[208:211], v[60:63]
ds_read_b128 v[32:35], v9 offset:59392
v_mfma_f32_16x16x32_bf16 v[64:67], v[40:43], a[212:215], v[64:67]
s_waitcnt lgkmcnt(4)
v_mfma_f32_16x16x32_bf16 v[52:55], v[44:47], a[216:219], v[52:55]
ds_read_b128 v[36:39], v8 offset:61440
v_mfma_f32_16x16x32_bf16 v[56:59], v[44:47], a[220:223], v[56:59]
v_mfma_f32_16x16x32_bf16 v[60:63], v[48:51], a[216:219], v[60:63]
ds_read_b128 v[40:43], v8 offset:63488
v_mfma_f32_16x16x32_bf16 v[64:67], v[48:51], a[220:223], v[64:67]
s_waitcnt lgkmcnt(4)
v_mfma_f32_16x16x32_bf16 v[52:55], v[20:23], a[224:227], v[52:55]
ds_read_b128 v[44:47], v9 offset:61440
v_mfma_f32_16x16x32_bf16 v[56:59], v[20:23], a[228:231], v[56:59]
v_mfma_f32_16x16x32_bf16 v[60:63], v[24:27], a[224:227], v[60:63]
ds_read_b128 v[48:51], v9 offset:63488
v_mfma_f32_16x16x32_bf16 v[64:67], v[24:27], a[228:231], v[64:67]
s_waitcnt lgkmcnt(5)
v_mfma_f32_16x16x32_bf16 v[52:55], v[28:31], a[232:235], v[52:55]
v_mfma_f32_16x16x32_bf16 v[56:59], v[28:31], a[236:239], v[56:59]
s_waitcnt lgkmcnt(4)
v_mfma_f32_16x16x32_bf16 v[60:63], v[32:35], a[232:235], v[60:63]
v_mfma_f32_16x16x32_bf16 v[64:67], v[32:35], a[236:239], v[64:67]
s_waitcnt lgkmcnt(3)
v_mfma_f32_16x16x32_bf16 v[52:55], v[36:39], a[240:243], v[52:55]
v_mfma_f32_16x16x32_bf16 v[56:59], v[36:39], a[244:247], v[56:59]
s_waitcnt lgkmcnt(2)
v_mfma_f32_16x16x32_bf16 v[60:63], v[40:43], a[240:243], v[60:63]
v_mfma_f32_16x16x32_bf16 v[64:67], v[40:43], a[244:247], v[64:67]
s_waitcnt lgkmcnt(1)
v_mfma_f32_16x16x32_bf16 v[52:55], v[44:47], a[248:251], v[52:55]
v_mfma_f32_16x16x32_bf16 v[56:59], v[44:47], a[252:255], v[56:59]
s_waitcnt lgkmcnt(0)
v_mfma_f32_16x16x32_bf16 v[60:63], v[48:51], a[248:251], v[60:63]
v_mfma_f32_16x16x32_bf16 v[64:67], v[48:51], a[252:255], v[64:67]
s_add_u32 s42, s42, 1
s_branch mega_kernel_v_loop
mega_kernel_v_fin:
s_nop 11
v_cvt_pk_bf16_f32 v84, v68, v69
v_cvt_pk_bf16_f32 v85, v70, v71
v_cvt_pk_bf16_f32 v86, v76, v77
v_cvt_pk_bf16_f32 v87, v78, v79
v_cvt_pk_bf16_f32 v88, v72, v73
v_cvt_pk_bf16_f32 v89, v74, v75
v_cvt_pk_bf16_f32 v90, v80, v81
v_cvt_pk_bf16_f32 v91, v82, v83
s_add_u32 s51, s42, s47
s_sub_u32 s51, s51, 1
s_bfe_u32 s52, s51, 0x40002
s_lshl_b32 s52, s52, 14
s_and_b32 s51, s51, 3
s_lshl_b32 s51, s51, 11
s_add_u32 s51, s51, s52
s_add_u32 s51, s51, s48
buffer_store_dwordx4 v[84:87], v7, s[84:87], s51 offen sc1
buffer_store_dwordx4 v[88:91], v7, s[84:87], s51 offen offset:1024 sc1
s_waitcnt vmcnt(0)
v_mov_b32 v17, s42
s_mov_b64 exec, 1
buffer_store_dword v17, v16, s[84:87], s49 offen sc1
s_mov_b64 exec, -1
s_waitcnt vmcnt(0)
s_barrier
mega_kernel_fft:
s_mov_b32 s38, s92
s_mov_b32 s39, 64
s_mov_b32 s37, 129
mega_kernel_f2s:
v_mov_b32 v1, 0
s_mov_b32 s82, 69259264
mega_kernel_w0:
s_sleep 8
buffer_load_dword v2, v1, s[84:87], s82 offen sc1
s_waitcnt vmcnt(0)
v_cmp_ne_u32 vcc, 31, v2
s_cbranch_vccnz mega_kernel_w0
s_mov_b32 s48, 0x3f7ec46d
s_mov_b32 s49, 0x3dc8bd36
s_mov_b32 s50, 0x3f7b14be
s_mov_b32 s51, 0x3e47c5c2
s_mov_b32 s52, 0x3f74fa0b
s_mov_b32 s53, 0x3e94a031
s_mov_b32 s54, 0x3f6c835e
s_mov_b32 s55, 0x3ec3ef15
s_mov_b32 s56, 0x3f61c598
s_mov_b32 s57, 0x3ef15aea
s_mov_b32 s58, 0x3f54db31
s_mov_b32 s59, 0x3f0e39da
s_mov_b32 s60, 0x3f45e403
s_mov_b32 s61, 0x3f226799
s_mov_b32 s62, 0x3f3504f3
s_mov_b32 s63, 0x3f3504f3
v_lshrrev_b32 v10, 6, v0
v_and_b32 v1, 63, v0
v_readfirstlane_b32 s16, v10
v_cvt_f32_u32 v2, v1
v_lshlrev_b32 v5, 3, v1
s_mul_i32 s17, s16, 16896
v_add_u32 v3, s17, v5
v_and_b32 v7, 1, v1
v_lshrrev_b32 v6, 1, v1
v_cvt_f32_u32 v8, v6
v_cvt_f32_u32 v10, v7
v_mul_u32_u24 v4, 528, v6
v_lshl_add_u32 v4, v7, 3, v4
v_add_u32 v4, s17, v4
v_lshlrev_b32 v11, 12, v7
v_lshl_add_u32 v11, v6, 2, v11
v_fma_f32 v9, v10, 2.0, -1.0
v_sub_f32 v7, 0, v9
v_mul_f32 v13, v10, v8
v_mul_f32 v13, 0x3a000000, v13
s_mov_b32 s18, 0xaaaaaaaa
s_mov_b32 s19, 0xaaaaaaaa
v_mul_f32 v12, 0xba000000, v2
v_cos_f32 v82, v12
v_sin_f32 v83, v12
v_mul_f32 v12, 0xba800000, v2
v_cos_f32 v84, v12
v_sin_f32 v85, v12
v_mul_f32 v12, 0xbac00000, v2
v_cos_f32 v86, v12
v_sin_f32 v87, v12
v_mul_f32 v12, 0xbb000000, v2
v_cos_f32 v88, v12
v_sin_f32 v89, v12
v_mul_f32 v12, 0xbb200000, v2
v_cos_f32 v90, v12
v_sin_f32 v91, v12
v_mul_f32 v12, 0xbb400000, v2
v_cos_f32 v92, v12
v_sin_f32 v93, v12
v_mul_f32 v12, 0xbb600000, v2
v_cos_f32 v94, v12
v_sin_f32 v95, v12
v_mul_f32 v12, 0xbb800000, v2
v_cos_f32 v96, v12
v_sin_f32 v97, v12
v_mul_f32 v12, 0xbb900000, v2
v_cos_f32 v98, v12
v_sin_f32 v99, v12
v_mul_f32 v12, 0xbba00000, v2
v_cos_f32 v100, v12
v_sin_f32 v101, v12
v_mul_f32 v12, 0xbbb00000, v2
v_cos_f32 v102, v12
v_sin_f32 v103, v12
v_mul_f32 v12, 0xbbc00000, v2
v_cos_f32 v104, v12
v_sin_f32 v105, v12
v_mul_f32 v12, 0xbbd00000, v2
v_cos_f32 v106, v12
v_sin_f32 v107, v12
v_mul_f32 v12, 0xbbe00000, v2
v_cos_f32 v108, v12
v_sin_f32 v109, v12
v_mul_f32 v12, 0xbbf00000, v2
v_cos_f32 v110, v12
v_sin_f32 v111, v12
v_mul_f32 v12, 0xbc000000, v2
v_cos_f32 v112, v12
v_sin_f32 v113, v12
v_mul_f32 v12, 0xbc080000, v2
v_cos_f32 v114, v12
v_sin_f32 v115, v12
v_mul_f32 v12, 0xbc100000, v2
v_cos_f32 v116, v12
v_sin_f32 v117, v12
v_mul_f32 v12, 0xbc180000, v2
v_cos_f32 v118, v12
v_sin_f32 v119, v12
v_mul_f32 v12, 0xbc200000, v2
v_cos_f32 v120, v12
v_sin_f32 v121, v12
v_mul_f32 v12, 0xbc280000, v2
v_cos_f32 v122, v12
v_sin_f32 v123, v12
v_mul_f32 v12, 0xbc300000, v2
v_cos_f32 v124, v12
v_sin_f32 v125, v12
v_mul_f32 v12, 0xbc380000, v2
v_cos_f32 v126, v12
v_sin_f32 v127, v12
v_mul_f32 v12, 0xbc400000, v2
v_cos_f32 v128, v12
v_sin_f32 v129, v12
v_mul_f32 v12, 0xbc480000, v2
v_cos_f32 v130, v12
v_sin_f32 v131, v12
v_mul_f32 v12, 0xbc500000, v2
v_cos_f32 v132, v12
v_sin_f32 v133, v12
v_mul_f32 v12, 0xbc580000, v2
v_cos_f32 v134, v12
v_sin_f32 v135, v12
v_mul_f32 v12, 0xbc600000, v2
v_cos_f32 v136, v12
v_sin_f32 v137, v12
v_mul_f32 v12, 0xbc680000, v2
v_cos_f32 v138, v12
v_sin_f32 v139, v12
v_mul_f32 v12, 0xbc700000, v2
v_cos_f32 v140, v12
v_sin_f32 v141, v12
v_mul_f32 v12, 0xbc780000, v2
v_cos_f32 v142, v12
v_sin_f32 v143, v12
v_mov_b32 v12, v13
v_fmac_f32 v12, 0x00000000, v8
v_cos_f32 v144, v12
v_sin_f32 v145, v12
v_mov_b32 v12, v13
v_fmac_f32 v12, 0x3a800000, v8
v_cos_f32 v146, v12
v_sin_f32 v147, v12
v_mov_b32 v12, v13
v_fmac_f32 v12, 0x3b000000, v8
v_cos_f32 v148, v12
v_sin_f32 v149, v12
v_mov_b32 v12, v13
v_fmac_f32 v12, 0x3b400000, v8
v_cos_f32 v150, v12
v_sin_f32 v151, v12
v_mov_b32 v12, v13
v_fmac_f32 v12, 0x3b800000, v8
v_cos_f32 v152, v12
v_sin_f32 v153, v12
v_mov_b32 v12, v13
v_fmac_f32 v12, 0x3ba00000, v8
v_cos_f32 v154, v12
v_sin_f32 v155, v12
v_mov_b32 v12, v13
v_fmac_f32 v12, 0x3bc00000, v8
v_cos_f32 v156, v12
v_sin_f32 v157, v12
v_mov_b32 v12, v13
v_fmac_f32 v12, 0x3be00000, v8
v_cos_f32 v158, v12
v_sin_f32 v159, v12
v_mov_b32 v12, v13
v_fmac_f32 v12, 0x3c000000, v8
v_cos_f32 v160, v12
v_sin_f32 v161, v12
v_mov_b32 v12, v13
v_fmac_f32 v12, 0x3c100000, v8
v_cos_f32 v162, v12
v_sin_f32 v163, v12
v_mov_b32 v12, v13
v_fmac_f32 v12, 0x3c200000, v8
v_cos_f32 v164, v12
v_sin_f32 v165, v12
v_mov_b32 v12, v13
v_fmac_f32 v12, 0x3c300000, v8
v_cos_f32 v166, v12
v_sin_f32 v167, v12
v_mov_b32 v12, v13
v_fmac_f32 v12, 0x3c400000, v8
v_cos_f32 v168, v12
v_sin_f32 v169, v12
v_mov_b32 v12, v13
v_fmac_f32 v12, 0x3c500000, v8
v_cos_f32 v170, v12
v_sin_f32 v171, v12
v_mov_b32 v12, v13
v_fmac_f32 v12, 0x3c600000, v8
v_cos_f32 v172, v12
v_sin_f32 v173, v12
v_mov_b32 v12, v13
v_fmac_f32 v12, 0x3c700000, v8
v_cos_f32 v174, v12
v_sin_f32 v175, v12
v_mov_b32 v12, v13
v_fmac_f32 v12, 0x3c800000, v8
v_cos_f32 v176, v12
v_sin_f32 v177, v12
v_mov_b32 v12, v13
v_fmac_f32 v12, 0x3c880000, v8
v_cos_f32 v178, v12
v_sin_f32 v179, v12
v_mov_b32 v12, v13
v_fmac_f32 v12, 0x3c900000, v8
v_cos_f32 v180, v12
v_sin_f32 v181, v12
v_mov_b32 v12, v13
v_fmac_f32 v12, 0x3c980000, v8
v_cos_f32 v182, v12
v_sin_f32 v183, v12
v_mov_b32 v12, v13
v_fmac_f32 v12, 0x3ca00000, v8
v_cos_f32 v184, v12
v_sin_f32 v185, v12
v_mov_b32 v12, v13
v_fmac_f32 v12, 0x3ca80000, v8
v_cos_f32 v186, v12
v_sin_f32 v187, v12
v_mov_b32 v12, v13
v_fmac_f32 v12, 0x3cb00000, v8
v_cos_f32 v188, v12
v_sin_f32 v189, v12
v_mov_b32 v12, v13
v_fmac_f32 v12, 0x3cb80000, v8
v_cos_f32 v190, v12
v_sin_f32 v191, v12
v_mov_b32 v12, v13
v_fmac_f32 v12, 0x3cc00000, v8
v_cos_f32 v192, v12
v_sin_f32 v193, v12
v_mov_b32 v12, v13
v_fmac_f32 v12, 0x3cc80000, v8
v_cos_f32 v194, v12
v_sin_f32 v195, v12
v_mov_b32 v12, v13
v_fmac_f32 v12, 0x3cd00000, v8
v_cos_f32 v196, v12
v_sin_f32 v197, v12
v_mov_b32 v12, v13
v_fmac_f32 v12, 0x3cd80000, v8
v_cos_f32 v198, v12
v_sin_f32 v199, v12
v_mov_b32 v12, v13
v_fmac_f32 v12, 0x3ce00000, v8
v_cos_f32 v200, v12
v_sin_f32 v201, v12
v_mov_b32 v12, v13
v_fmac_f32 v12, 0x3ce80000, v8
v_cos_f32 v202, v12
v_sin_f32 v203, v12
v_mov_b32 v12, v13
v_fmac_f32 v12, 0x3cf00000, v8
v_cos_f32 v204, v12
v_sin_f32 v205, v12
v_mov_b32 v12, v13
v_fmac_f32 v12, 0x3cf80000, v8
v_cos_f32 v206, v12
v_sin_f32 v207, v12
s_nop 0
v_mul_f32 v144, 0x34800000, v144
v_mul_f32 v145, 0x34800000, v145
v_mul_f32 v146, 0x34800000, v146
v_mul_f32 v147, 0x34800000, v147
v_mul_f32 v148, 0x34800000, v148
v_mul_f32 v149, 0x34800000, v149
v_mul_f32 v150, 0x34800000, v150
v_mul_f32 v151, 0x34800000, v151
v_mul_f32 v152, 0x34800000, v152
v_mul_f32 v153, 0x34800000, v153
v_mul_f32 v154, 0x34800000, v154
v_mul_f32 v155, 0x34800000, v155
v_mul_f32 v156, 0x34800000, v156
v_mul_f32 v157, 0x34800000, v157
v_mul_f32 v158, 0x34800000, v158
v_mul_f32 v159, 0x34800000, v159
v_mul_f32 v160, 0x34800000, v160
v_mul_f32 v161, 0x34800000, v161
v_mul_f32 v162, 0x34800000, v162
v_mul_f32 v163, 0x34800000, v163
v_mul_f32 v164, 0x34800000, v164
v_mul_f32 v165, 0x34800000, v165
v_mul_f32 v166, 0x34800000, v166
v_mul_f32 v167, 0x34800000, v167
v_mul_f32 v168, 0x34800000, v168
v_mul_f32 v169, 0x34800000, v169
v_mul_f32 v170, 0x34800000, v170
v_mul_f32 v171, 0x34800000, v171
v_mul_f32 v172, 0x34800000, v172
v_mul_f32 v173, 0x34800000, v173
v_mul_f32 v174, 0x34800000, v174
v_mul_f32 v175, 0x34800000, v175
v_mul_f32 v176, 0x34800000, v176
v_mul_f32 v177, 0x34800000, v177
v_mul_f32 v178, 0x34800000, v178
v_mul_f32 v179, 0x34800000, v179
v_mul_f32 v180, 0x34800000, v180
v_mul_f32 v181, 0x34800000, v181
v_mul_f32 v182, 0x34800000, v182
v_mul_f32 v183, 0x34800000, v183
v_mul_f32 v184, 0x34800000, v184
v_mul_f32 v185, 0x34800000, v185
v_mul_f32 v186, 0x34800000, v186
v_mul_f32 v187, 0x34800000, v187
v_mul_f32 v188, 0x34800000, v188
v_mul_f32 v189, 0x34800000, v189
v_mul_f32 v190, 0x34800000, v190
v_mul_f32 v191, 0x34800000, v191
v_mul_f32 v192, 0x34800000, v192
v_mul_f32 v193, 0x34800000, v193
v_mul_f32 v194, 0x34800000, v194
v_mul_f32 v195, 0x34800000, v195
v_mul_f32 v196, 0x34800000, v196
v_mul_f32 v197, 0x34800000, v197
v_mul_f32 v198, 0x34800000, v198
v_mul_f32 v199, 0x34800000, v199
v_mul_f32 v200, 0x34800000, v200
v_mul_f32 v201, 0x34800000, v201
v_mul_f32 v202, 0x34800000, v202
v_mul_f32 v203, 0x34800000, v203
v_mul_f32 v204, 0x34800000, v204
v_mul_f32 v205, 0x34800000, v205
v_mul_f32 v206, 0x34800000, v206
v_mul_f32 v207, 0x34800000, v207
s_cmp_lt_u32 s38, s37
s_cbranch_scc0 mega_kernel_f2_e
s_lshl_b32 s12, s38, 2
s_add_u32 s12, s12, s16
s_min_u32 s12, s12, 512
s_lshr_b32 s23, s12, 7
s_xnor_b32 s23, s23, s98
s_and_b32 s23, s23, 1
s_lshl_b32 s23, s23, 13
s_mul_i32 s13, s12, 16384
s_add_u32 s13, s13, 171966464
s_add_u32 s13, s13, s23
s_lshr_b32 s23, s12, 6
s_xnor_b32 s23, s23, s98
s_and_b32 s23, s23, 1
s_lshl_b32 s23, s23, 13
s_mul_i32 s12, s12, 32768
s_add_u32 s12, s12, 92274688
s_add_u32 s12, s12, s23
buffer_load_dwordx2 a[0:1], v5, s[84:87], s12 offen offset:0 sc1
buffer_load_dwordx2 a[2:3], v5, s[84:87], s12 offen offset:512 sc1
buffer_load_dwordx2 a[4:5], v5, s[84:87], s12 offen offset:1024 sc1
buffer_load_dwordx2 a[6:7], v5, s[84:87], s12 offen offset:1536 sc1
buffer_load_dwordx2 a[8:9], v5, s[84:87], s12 offen offset:2048 sc1
buffer_load_dwordx2 a[10:11], v5, s[84:87], s12 offen offset:2560 sc1
buffer_load_dwordx2 a[12:13], v5, s[84:87], s12 offen offset:3072 sc1
buffer_load_dwordx2 a[14:15], v5, s[84:87], s12 offen offset:3584 sc1
s_add_u32 s12, s12, 4096
buffer_load_dwordx2 a[16:17], v5, s[84:87], s12 offen offset:0 sc1
buffer_load_dwordx2 a[18:19], v5, s[84:87], s12 offen offset:512 sc1
buffer_load_dwordx2 a[20:21], v5, s[84:87], s12 offen offset:1024 sc1
buffer_load_dwordx2 a[22:23], v5, s[84:87], s12 offen offset:1536 sc1
buffer_load_dwordx2 a[24:25], v5, s[84:87], s12 offen offset:2048 sc1
buffer_load_dwordx2 a[26:27], v5, s[84:87], s12 offen offset:2560 sc1
buffer_load_dwordx2 a[28:29], v5, s[84:87], s12 offen offset:3072 sc1
buffer_load_dwordx2 a[30:31], v5, s[84:87], s12 offen offset:3584 sc1
s_add_u32 s12, s12, 12288
buffer_load_dwordx2 a[32:33], v5, s[84:87], s12 offen offset:0 sc1
buffer_load_dwordx2 a[34:35], v5, s[84:87], s12 offen offset:512 sc1
buffer_load_dwordx2 a[36:37], v5, s[84:87], s12 offen offset:1024 sc1
buffer_load_dwordx2 a[38:39], v5, s[84:87], s12 offen offset:1536 sc1
buffer_load_dwordx2 a[40:41], v5, s[84:87], s12 offen offset:2048 sc1
buffer_load_dwordx2 a[42:43], v5, s[84:87], s12 offen offset:2560 sc1
buffer_load_dwordx2 a[44:45], v5, s[84:87], s12 offen offset:3072 sc1
buffer_load_dwordx2 a[46:47], v5, s[84:87], s12 offen offset:3584 sc1
s_add_u32 s12, s12, 4096
buffer_load_dwordx2 a[48:49], v5, s[84:87], s12 offen offset:0 sc1
buffer_load_dwordx2 a[50:51], v5, s[84:87], s12 offen offset:512 sc1
buffer_load_dwordx2 a[52:53], v5, s[84:87], s12 offen offset:1024 sc1
buffer_load_dwordx2 a[54:55], v5, s[84:87], s12 offen offset:1536 sc1
buffer_load_dwordx2 a[56:57], v5, s[84:87], s12 offen offset:2048 sc1
buffer_load_dwordx2 a[58:59], v5, s[84:87], s12 offen offset:2560 sc1
buffer_load_dwordx2 a[60:61], v5, s[84:87], s12 offen offset:3072 sc1
buffer_load_dwordx2 a[62:63], v5, s[84:87], s12 offen offset:3584 sc1
s_add_u32 s12, s12, 4096
buffer_load_dword a64, v11, s[84:87], s13 offen offset:0 sc1
buffer_load_dword a65, v11, s[84:87], s13 offen offset:128 sc1
buffer_load_dword a66, v11, s[84:87], s13 offen offset:256 sc1
buffer_load_dword a67, v11, s[84:87], s13 offen offset:384 sc1
buffer_load_dword a68, v11, s[84:87], s13 offen offset:512 sc1
buffer_load_dword a69, v11, s[84:87], s13 offen offset:640 sc1
buffer_load_dword a70, v11, s[84:87], s13 offen offset:768 sc1
buffer_load_dword a71, v11, s[84:87], s13 offen offset:896 sc1
buffer_load_dword a72, v11, s[84:87], s13 offen offset:1024 sc1
buffer_load_dword a73, v11, s[84:87], s13 offen offset:1152 sc1
buffer_load_dword a74, v11, s[84:87], s13 offen offset:1280 sc1
buffer_load_dword a75, v11, s[84:87], s13 offen offset:1408 sc1
buffer_load_dword a76, v11, s[84:87], s13 offen offset:1536 sc1
buffer_load_dword a77, v11, s[84:87], s13 offen offset:1664 sc1
buffer_load_dword a78, v11, s[84:87], s13 offen offset:1792 sc1
buffer_load_dword a79, v11, s[84:87], s13 offen offset:1920 sc1
buffer_load_dword a80, v11, s[84:87], s13 offen offset:2048 sc1
buffer_load_dword a81, v11, s[84:87], s13 offen offset:2176 sc1
buffer_load_dword a82, v11, s[84:87], s13 offen offset:2304 sc1
buffer_load_dword a83, v11, s[84:87], s13 offen offset:2432 sc1
buffer_load_dword a84, v11, s[84:87], s13 offen offset:2560 sc1
buffer_load_dword a85, v11, s[84:87], s13 offen offset:2688 sc1
buffer_load_dword a86, v11, s[84:87], s13 offen offset:2816 sc1
buffer_load_dword a87, v11, s[84:87], s13 offen offset:2944 sc1
buffer_load_dword a88, v11, s[84:87], s13 offen offset:3072 sc1
buffer_load_dword a89, v11, s[84:87], s13 offen offset:3200 sc1
buffer_load_dword a90, v11, s[84:87], s13 offen offset:3328 sc1
buffer_load_dword a91, v11, s[84:87], s13 offen offset:3456 sc1
buffer_load_dword a92, v11, s[84:87], s13 offen offset:3584 sc1
buffer_load_dword a93, v11, s[84:87], s13 offen offset:3712 sc1
buffer_load_dword a94, v11, s[84:87], s13 offen offset:3840 sc1
buffer_load_dword a95, v11, s[84:87], s13 offen offset:3968 sc1
s_waitcnt vmcnt(0)
mega_kernel_f2_l:
s_add_u32 s21, s38, s39
s_cmp_lt_u32 s21, s37
s_cselect_b32 s22, s21, s38
s_waitcnt vmcnt(32)
v_accvgpr_read_b32 v16, a0
v_accvgpr_read_b32 v17, a1
v_accvgpr_read_b32 v18, a2
v_accvgpr_read_b32 v19, a3
v_accvgpr_read_b32 v20, a4
v_accvgpr_read_b32 v21, a5
v_accvgpr_read_b32 v22, a6
v_accvgpr_read_b32 v23, a7
v_accvgpr_read_b32 v24, a8
v_accvgpr_read_b32 v25, a9
v_accvgpr_read_b32 v26, a10
v_accvgpr_read_b32 v27, a11
v_accvgpr_read_b32 v28, a12
v_accvgpr_read_b32 v29, a13
v_accvgpr_read_b32 v30, a14
v_accvgpr_read_b32 v31, a15
v_accvgpr_read_b32 v32, a16
v_accvgpr_read_b32 v33, a17
v_accvgpr_read_b32 v34, a18
v_accvgpr_read_b32 v35, a19
v_accvgpr_read_b32 v36, a20
v_accvgpr_read_b32 v37, a21
v_accvgpr_read_b32 v38, a22
v_accvgpr_read_b32 v39, a23
v_accvgpr_read_b32 v40, a24
v_accvgpr_read_b32 v41, a25
v_accvgpr_read_b32 v42, a26
v_accvgpr_read_b32 v43, a27
v_accvgpr_read_b32 v44, a28
v_accvgpr_read_b32 v45, a29
v_accvgpr_read_b32 v46, a30
v_accvgpr_read_b32 v47, a31
v_accvgpr_read_b32 v48, a32
v_accvgpr_read_b32 v49, a33
v_accvgpr_read_b32 v50, a34
v_accvgpr_read_b32 v51, a35
v_accvgpr_read_b32 v52, a36
v_accvgpr_read_b32 v53, a37
v_accvgpr_read_b32 v54, a38
v_accvgpr_read_b32 v55, a39
v_accvgpr_read_b32 v56, a40
v_accvgpr_read_b32 v57, a41
v_accvgpr_read_b32 v58, a42
v_accvgpr_read_b32 v59, a43
v_accvgpr_read_b32 v60, a44
v_accvgpr_read_b32 v61, a45
v_accvgpr_read_b32 v62, a46
v_accvgpr_read_b32 v63, a47
v_accvgpr_read_b32 v64, a48
v_accvgpr_read_b32 v65, a49
v_accvgpr_read_b32 v66, a50
v_accvgpr_read_b32 v67, a51
v_accvgpr_read_b32 v68, a52
v_accvgpr_read_b32 v69, a53
v_accvgpr_read_b32 v70, a54
v_accvgpr_read_b32 v71, a55
v_accvgpr_read_b32 v72, a56
v_accvgpr_read_b32 v73, a57
v_accvgpr_read_b32 v74, a58
v_accvgpr_read_b32 v75, a59
v_accvgpr_read_b32 v76, a60
v_accvgpr_read_b32 v77, a61
v_accvgpr_read_b32 v78, a62
v_accvgpr_read_b32 v79, a63
v_accvgpr_read_b32 v208, a64
v_accvgpr_read_b32 v209, a65
v_accvgpr_read_b32 v210, a66
v_accvgpr_read_b32 v211, a67
v_accvgpr_read_b32 v212, a68
v_accvgpr_read_b32 v213, a69
v_accvgpr_read_b32 v214, a70
v_accvgpr_read_b32 v215, a71
v_accvgpr_read_b32 v216, a72
v_accvgpr_read_b32 v217, a73
v_accvgpr_read_b32 v218, a74
v_accvgpr_read_b32 v219, a75
v_accvgpr_read_b32 v220, a76
v_accvgpr_read_b32 v221, a77
v_accvgpr_read_b32 v222, a78
v_accvgpr_read_b32 v223, a79
v_accvgpr_read_b32 v224, a80
v_accvgpr_read_b32 v225, a81
v_accvgpr_read_b32 v226, a82
v_accvgpr_read_b32 v227, a83
v_accvgpr_read_b32 v228, a84
v_accvgpr_read_b32 v229, a85
v_accvgpr_read_b32 v230, a86
v_accvgpr_read_b32 v231, a87
v_accvgpr_read_b32 v232, a88
v_accvgpr_read_b32 v233, a89
v_accvgpr_read_b32 v234, a90
v_accvgpr_read_b32 v235, a91
v_accvgpr_read_b32 v236, a92
v_accvgpr_read_b32 v237, a93
v_accvgpr_read_b32 v238, a94
v_accvgpr_read_b32 v239, a95
s_lshl_b32 s12, s22, 2
s_add_u32 s12, s12, s16
s_min_u32 s12, s12, 512
s_lshr_b32 s23, s12, 7
s_xnor_b32 s23, s23, s98
s_and_b32 s23, s23, 1
s_lshl_b32 s23, s23, 13
s_mul_i32 s13, s12, 16384
s_add_u32 s13, s13, 171966464
s_add_u32 s13, s13, s23
s_lshr_b32 s23, s12, 6
s_xnor_b32 s23, s23, s98
s_and_b32 s23, s23, 1
s_lshl_b32 s23, s23, 13
s_mul_i32 s12, s12, 32768
s_add_u32 s12, s12, 92274688
s_add_u32 s12, s12, s23
buffer_load_dwordx2 a[0:1], v5, s[84:87], s12 offen offset:0 sc1
buffer_load_dwordx2 a[2:3], v5, s[84:87], s12 offen offset:512 sc1
buffer_load_dwordx2 a[4:5], v5, s[84:87], s12 offen offset:1024 sc1
buffer_load_dwordx2 a[6:7], v5, s[84:87], s12 offen offset:1536 sc1
buffer_load_dwordx2 a[8:9], v5, s[84:87], s12 offen offset:2048 sc1
buffer_load_dwordx2 a[10:11], v5, s[84:87], s12 offen offset:2560 sc1
buffer_load_dwordx2 a[12:13], v5, s[84:87], s12 offen offset:3072 sc1
buffer_load_dwordx2 a[14:15], v5, s[84:87], s12 offen offset:3584 sc1
s_add_u32 s12, s12, 4096
buffer_load_dwordx2 a[16:17], v5, s[84:87], s12 offen offset:0 sc1
buffer_load_dwordx2 a[18:19], v5, s[84:87], s12 offen offset:512 sc1
buffer_load_dwordx2 a[20:21], v5, s[84:87], s12 offen offset:1024 sc1
buffer_load_dwordx2 a[22:23], v5, s[84:87], s12 offen offset:1536 sc1
buffer_load_dwordx2 a[24:25], v5, s[84:87], s12 offen offset:2048 sc1
buffer_load_dwordx2 a[26:27], v5, s[84:87], s12 offen offset:2560 sc1
buffer_load_dwordx2 a[28:29], v5, s[84:87], s12 offen offset:3072 sc1
buffer_load_dwordx2 a[30:31], v5, s[84:87], s12 offen offset:3584 sc1
s_add_u32 s12, s12, 12288
buffer_load_dwordx2 a[32:33], v5, s[84:87], s12 offen offset:0 sc1
buffer_load_dwordx2 a[34:35], v5, s[84:87], s12 offen offset:512 sc1
buffer_load_dwordx2 a[36:37], v5, s[84:87], s12 offen offset:1024 sc1
buffer_load_dwordx2 a[38:39], v5, s[84:87], s12 offen offset:1536 sc1
buffer_load_dwordx2 a[40:41], v5, s[84:87], s12 offen offset:2048 sc1
buffer_load_dwordx2 a[42:43], v5, s[84:87], s12 offen offset:2560 sc1
buffer_load_dwordx2 a[44:45], v5, s[84:87], s12 offen offset:3072 sc1
buffer_load_dwordx2 a[46:47], v5, s[84:87], s12 offen offset:3584 sc1
s_add_u32 s12, s12, 4096
buffer_load_dwordx2 a[48:49], v5, s[84:87], s12 offen offset:0 sc1
buffer_load_dwordx2 a[50:51], v5, s[84:87], s12 offen offset:512 sc1
buffer_load_dwordx2 a[52:53], v5, s[84:87], s12 offen offset:1024 sc1
buffer_load_dwordx2 a[54:55], v5, s[84:87], s12 offen offset:1536 sc1
buffer_load_dwordx2 a[56:57], v5, s[84:87], s12 offen offset:2048 sc1
buffer_load_dwordx2 a[58:59], v5, s[84:87], s12 offen offset:2560 sc1
buffer_load_dwordx2 a[60:61], v5, s[84:87], s12 offen offset:3072 sc1
buffer_load_dwordx2 a[62:63], v5, s[84:87], s12 offen offset:3584 sc1
s_add_u32 s12, s12, 4096
buffer_load_dword a64, v11, s[84:87], s13 offen offset:0 sc1
buffer_load_dword a65, v11, s[84:87], s13 offen offset:128 sc1
buffer_load_dword a66, v11, s[84:87], s13 offen offset:256 sc1
buffer_load_dword a67, v11, s[84:87], s13 offen offset:384 sc1
buffer_load_dword a68, v11, s[84:87], s13 offen offset:512 sc1
buffer_load_dword a69, v11, s[84:87], s13 offen offset:640 sc1
buffer_load_dword a70, v11, s[84:87], s13 offen offset:768 sc1
buffer_load_dword a71, v11, s[84:87], s13 offen offset:896 sc1
buffer_load_dword a72, v11, s[84:87], s13 offen offset:1024 sc1
buffer_load_dword a73, v11, s[84:87], s13 offen offset:1152 sc1
buffer_load_dword a74, v11, s[84:87], s13 offen offset:1280 sc1
buffer_load_dword a75, v11, s[84:87], s13 offen offset:1408 sc1
buffer_load_dword a76, v11, s[84:87], s13 offen offset:1536 sc1
buffer_load_dword a77, v11, s[84:87], s13 offen offset:1664 sc1
buffer_load_dword a78, v11, s[84:87], s13 offen offset:1792 sc1
buffer_load_dword a79, v11, s[84:87], s13 offen offset:1920 sc1
buffer_load_dword a80, v11, s[84:87], s13 offen offset:2048 sc1
buffer_load_dword a81, v11, s[84:87], s13 offen offset:2176 sc1
buffer_load_dword a82, v11, s[84:87], s13 offen offset:2304 sc1
buffer_load_dword a83, v11, s[84:87], s13 offen offset:2432 sc1
buffer_load_dword a84, v11, s[84:87], s13 offen offset:2560 sc1
buffer_load_dword a85, v11, s[84:87], s13 offen offset:2688 sc1
buffer_load_dword a86, v11, s[84:87], s13 offen offset:2816 sc1
buffer_load_dword a87, v11, s[84:87], s13 offen offset:2944 sc1
buffer_load_dword a88, v11, s[84:87], s13 offen offset:3072 sc1
buffer_load_dword a89, v11, s[84:87], s13 offen offset:3200 sc1
buffer_load_dword a90, v11, s[84:87], s13 offen offset:3328 sc1
buffer_load_dword a91, v11, s[84:87], s13 offen offset:3456 sc1
buffer_load_dword a92, v11, s[84:87], s13 offen offset:3584 sc1
buffer_load_dword a93, v11, s[84:87], s13 offen offset:3712 sc1
buffer_load_dword a94, v11, s[84:87], s13 offen offset:3840 sc1
buffer_load_dword a95, v11, s[84:87], s13 offen offset:3968 sc1
v_pk_add_f32 v[14:15], v[16:17], v[48:49] neg_lo:[0,1] neg_hi:[0,1]
v_pk_add_f32 v[16:17], v[16:17], v[48:49]
v_pk_add_f32 v[48:49], v[18:19], v[50:51] neg_lo:[0,1] neg_hi:[0,1]
v_pk_add_f32 v[18:19], v[18:19], v[50:51]
v_pk_mul_f32 v[50:51], v[48:49], s[50:51] op_sel:[0,0] op_sel_hi:[0,1] neg_lo:[0,0] neg_hi:[0,1]
v_pk_fma_f32 v[50:51], v[48:49], s[50:51], v[50:51] op_sel:[1,1,0] op_sel_hi:[1,0,1] neg_lo:[0,0,0] neg_hi:[0,0,0]
v_pk_add_f32 v[48:49], v[20:21], v[52:53] neg_lo:[0,1] neg_hi:[0,1]
v_pk_add_f32 v[20:21], v[20:21], v[52:53]
v_pk_mul_f32 v[52:53], v[48:49], s[54:55] op_sel:[0,0] op_sel_hi:[0,1] neg_lo:[0,0] neg_hi:[0,1]
v_pk_fma_f32 v[52:53], v[48:49], s[54:55], v[52:53] op_sel:[1,1,0] op_sel_hi:[1,0,1] neg_lo:[0,0,0] neg_hi:[0,0,0]
v_pk_add_f32 v[48:49], v[22:23], v[54:55] neg_lo:[0,1] neg_hi:[0,1]
v_pk_add_f32 v[22:23], v[22:23], v[54:55]
v_pk_mul_f32 v[54:55], v[48:49], s[58:59] op_sel:[0,0] op_sel_hi:[0,1] neg_lo:[0,0] neg_hi:[0,1]
v_pk_fma_f32 v[54:55], v[48:49], s[58:59], v[54:55] op_sel:[1,1,0] op_sel_hi:[1,0,1] neg_lo:[0,0,0] neg_hi:[0,0,0]
v_pk_add_f32 v[48:49], v[24:25], v[56:57] neg_lo:[0,1] neg_hi:[0,1]
v_pk_add_f32 v[24:25], v[24:25], v[56:57]
v_pk_mul_f32 v[56:57], v[48:49], s[62:63] op_sel:[0,0] op_sel_hi:[0,1] neg_lo:[0,0] neg_hi:[0,1]
v_pk_fma_f32 v[56:57], v[48:49], s[62:63], v[56:57] op_sel:[1,1,0] op_sel_hi:[1,0,1] neg_lo:[0,0,0] neg_hi:[0,0,0]
v_pk_add_f32 v[48:49], v[26:27], v[58:59] neg_lo:[0,1] neg_hi:[0,1]
v_pk_add_f32 v[26:27], v[26:27], v[58:59]
v_pk_mul_f32 v[58:59], v[48:49], s[58:59] op_sel:[0,1] op_sel_hi:[0,0] neg_lo:[0,0] neg_hi:[0,1]
v_pk_fma_f32 v[58:59], v[48:49], s[58:59], v[58:59] op_sel:[1,0,0] op_sel_hi:[1,1,1] neg_lo:[0,0,0] neg_hi:[0,0,0]
v_pk_add_f32 v[48:49], v[28:29], v[60:61] neg_lo:[0,1] neg_hi:[0,1]
v_pk_add_f32 v[28:29], v[28:29], v[60:61]
v_pk_mul_f32 v[60:61], v[48:49], s[54:55] op_sel:[0,1] op_sel_hi:[0,0] neg_lo:[0,0] neg_hi:[0,1]
v_pk_fma_f32 v[60:61], v[48:49], s[54:55], v[60:61] op_sel:[1,0,0] op_sel_hi:[1,1,1] neg_lo:[0,0,0] neg_hi:[0,0,0]
v_pk_add_f32 v[48:49], v[30:31], v[62:63] neg_lo:[0,1] neg_hi:[0,1]
v_pk_add_f32 v[30:31], v[30:31], v[62:63]
v_pk_mul_f32 v[62:63], v[48:49], s[50:51] op_sel:[0,1] op_sel_hi:[0,0] neg_lo:[0,0] neg_hi:[0,1]
v_pk_fma_f32 v[62:63], v[48:49], s[50:51], v[62:63] op_sel:[1,0,0] op_sel_hi:[1,1,1] neg_lo:[0,0,0] neg_hi:[0,0,0]
v_pk_add_f32 v[48:49], v[32:33], v[64:65] op_sel:[1,1] op_sel_hi:[0,0] neg_lo:[0,1] neg_hi:[1,0]
v_pk_add_f32 v[32:33], v[32:33], v[64:65]
v_pk_add_f32 v[64:65], v[34:35], v[66:67] neg_lo:[0,1] neg_hi:[0,1]
v_pk_add_f32 v[34:35], v[34:35], v[66:67]
v_pk_mul_f32 v[66:67], v[64:65], s[50:51] op_sel:[0,1] op_sel_hi:[0,0] neg_lo:[0,1] neg_hi:[0,1]
v_pk_fma_f32 v[66:67], v[64:65], s[50:51], v[66:67] op_sel:[1,0,0] op_sel_hi:[1,1,1] neg_lo:[0,0,0] neg_hi:[0,1,0]
v_pk_add_f32 v[64:65], v[36:37], v[68:69] neg_lo:[0,1] neg_hi:[0,1]
v_pk_add_f32 v[36:37], v[36:37], v[68:69]
v_pk_mul_f32 v[68:69], v[64:65], s[54:55] op_sel:[0,1] op_sel_hi:[0,0] neg_lo:[0,1] neg_hi:[0,1]
v_pk_fma_f32 v[68:69], v[64:65], s[54:55], v[68:69] op_sel:[1,0,0] op_sel_hi:[1,1,1] neg_lo:[0,0,0] neg_hi:[0,1,0]
v_pk_add_f32 v[64:65], v[38:39], v[70:71] neg_lo:[0,1] neg_hi:[0,1]
v_pk_add_f32 v[38:39], v[38:39], v[70:71]
v_pk_mul_f32 v[70:71], v[64:65], s[58:59] op_sel:[0,1] op_sel_hi:[0,0] neg_lo:[0,1] neg_hi:[0,1]
v_pk_fma_f32 v[70:71], v[64:65], s[58:59], v[70:71] op_sel:[1,0,0] op_sel_hi:[1,1,1] neg_lo:[0,0,0] neg_hi:[0,1,0]
v_pk_add_f32 v[64:65], v[40:41], v[72:73] neg_lo:[0,1] neg_hi:[0,1]
v_pk_add_f32 v[40:41], v[40:41], v[72:73]
v_pk_mul_f32 v[72:73], v[64:65], s[62:63] op_sel:[0,0] op_sel_hi:[0,1] neg_lo:[0,1] neg_hi:[0,1]
v_pk_fma_f32 v[72:73], v[64:65], s[62:63], v[72:73] op_sel:[1,1,0] op_sel_hi:[1,0,1] neg_lo:[0,0,0] neg_hi:[0,1,0]
v_pk_add_f32 v[64:65], v[42:43], v[74:75] neg_lo:[0,1] neg_hi:[0,1]
v_pk_add_f32 v[42:43], v[42:43], v[74:75]
v_pk_mul_f32 v[74:75], v[64:65], s[58:59] op_sel:[0,0] op_sel_hi:[0,1] neg_lo:[0,1] neg_hi:[0,1]
v_pk_fma_f32 v[74:75], v[64:65], s[58:59], v[74:75] op_sel:[1,1,0] op_sel_hi:[1,0,1] neg_lo:[0,0,0] neg_hi:[0,1,0]
v_pk_add_f32 v[64:65], v[44:45], v[76:77] neg_lo:[0,1] neg_hi:[0,1]
v_pk_add_f32 v[44:45], v[44:45], v[76:77]
v_pk_mul_f32 v[76:77], v[64:65], s[54:55] op_sel:[0,0] op_sel_hi:[0,1] neg_lo:[0,1] neg_hi:[0,1]
v_pk_fma_f32 v[76:77], v[64:65], s[54:55], v[76:77] op_sel:[1,1,0] op_sel_hi:[1,0,1] neg_lo:[0,0,0] neg_hi:[0,1,0]
v_pk_add_f32 v[64:65], v[46:47], v[78:79] neg_lo:[0,1] neg_hi:[0,1]
v_pk_add_f32 v[46:47], v[46:47], v[78:79]
v_pk_mul_f32 v[78:79], v[64:65], s[50:51] op_sel:[0,0] op_sel_hi:[0,1] neg_lo:[0,1] neg_hi:[0,1]
v_pk_fma_f32 v[78:79], v[64:65], s[50:51], v[78:79] op_sel:[1,1,0] op_sel_hi:[1,0,1] neg_lo:[0,0,0] neg_hi:[0,1,0]
v_pk_add_f32 v[64:65], v[16:17], v[32:33] neg_lo:[0,1] neg_hi:[0,1]
v_pk_add_f32 v[16:17], v[16:17], v[32:33]
v_pk_add_f32 v[32:33], v[18:19], v[34:35] neg_lo:[0,1] neg_hi:[0,1]
v_pk_add_f32 v[18:19], v[18:19], v[34:35]
v_pk_mul_f32 v[34:35], v[32:33], s[54:55] op_sel:[0,0] op_sel_hi:[0,1] neg_lo:[0,0] neg_hi:[0,1]
v_pk_fma_f32 v[34:35], v[32:33], s[54:55], v[34:35] op_sel:[1,1,0] op_sel_hi:[1,0,1] neg_lo:[0,0,0] neg_hi:[0,0,0]
v_pk_add_f32 v[32:33], v[20:21], v[36:37] neg_lo:[0,1] neg_hi:[0,1]
v_pk_add_f32 v[20:21], v[20:21], v[36:37]
v_pk_mul_f32 v[36:37], v[32:33], s[62:63] op_sel:[0,0] op_sel_hi:[0,1] neg_lo:[0,0] neg_hi:[0,1]
v_pk_fma_f32 v[36:37], v[32:33], s[62:63], v[36:37] op_sel:[1,1,0] op_sel_hi:[1,0,1] neg_lo:[0,0,0] neg_hi:[0,0,0]
v_pk_add_f32 v[32:33], v[22:23], v[38:39] neg_lo:[0,1] neg_hi:[0,1]
v_pk_add_f32 v[22:23], v[22:23], v[38:39]
v_pk_mul_f32 v[38:39], v[32:33], s[54:55] op_sel:[0,1] op_sel_hi:[0,0] neg_lo:[0,0] neg_hi:[0,1]
v_pk_fma_f32 v[38:39], v[32:33], s[54:55], v[38:39] op_sel:[1,0,0] op_sel_hi:[1,1,1] neg_lo:[0,0,0] neg_hi:[0,0,0]
v_pk_add_f32 v[32:33], v[24:25], v[40:41] op_sel:[1,1] op_sel_hi:[0,0] neg_lo:[0,1] neg_hi:[1,0]
v_pk_add_f32 v[24:25], v[24:25], v[40:41]
v_pk_add_f32 v[40:41], v[26:27], v[42:43] neg_lo:[0,1] neg_hi:[0,1]
v_pk_add_f32 v[26:27], v[26:27], v[42:43]
v_pk_mul_f32 v[42:43], v[40:41], s[54:55] op_sel:[0,1] op_sel_hi:[0,0] neg_lo:[0,1] neg_hi:[0,1]
v_pk_fma_f32 v[42:43], v[40:41], s[54:55], v[42:43] op_sel:[1,0,0] op_sel_hi:[1,1,1] neg_lo:[0,0,0] neg_hi:[0,1,0]
v_pk_add_f32 v[40:41], v[28:29], v[44:45] neg_lo:[0,1] neg_hi:[0,1]
v_pk_add_f32 v[28:29], v[28:29], v[44:45]
v_pk_mul_f32 v[44:45], v[40:41], s[62:63] op_sel:[0,0] op_sel_hi:[0,1] neg_lo:[0,1] neg_hi:[0,1]
v_pk_fma_f32 v[44:45], v[40:41], s[62:63], v[44:45] op_sel:[1,1,0] op_sel_hi:[1,0,1] neg_lo:[0,0,0] neg_hi:[0,1,0]
v_pk_add_f32 v[40:41], v[30:31], v[46:47] neg_lo:[0,1] neg_hi:[0,1]
v_pk_add_f32 v[30:31], v[30:31], v[46:47]
v_pk_mul_f32 v[46:47], v[40:41], s[54:55] op_sel:[0,0] op_sel_hi:[0,1] neg_lo:[0,1] neg_hi:[0,1]
v_pk_fma_f32 v[46:47], v[40:41], s[54:55], v[46:47] op_sel:[1,1,0] op_sel_hi:[1,0,1] neg_lo:[0,0,0] neg_hi:[0,1,0]
v_pk_add_f32 v[40:41], v[14:15], v[48:49] neg_lo:[0,1] neg_hi:[0,1]
v_pk_add_f32 v[14:15], v[14:15], v[48:49]
v_pk_add_f32 v[48:49], v[50:51], v[66:67] neg_lo:[0,1] neg_hi:[0,1]
v_pk_add_f32 v[50:51], v[50:51], v[66:67]
v_pk_mul_f32 v[66:67], v[48:49], s[54:55] op_sel:[0,0] op_sel_hi:[0,1] neg_lo:[0,0] neg_hi:[0,1]
v_pk_fma_f32 v[66:67], v[48:49], s[54:55], v[66:67] op_sel:[1,1,0] op_sel_hi:[1,0,1] neg_lo:[0,0,0] neg_hi:[0,0,0]
v_pk_add_f32 v[48:49], v[52:53], v[68:69] neg_lo:[0,1] neg_hi:[0,1]
v_pk_add_f32 v[52:53], v[52:53], v[68:69]
v_pk_mul_f32 v[68:69], v[48:49], s[62:63] op_sel:[0,0] op_sel_hi:[0,1] neg_lo:[0,0] neg_hi:[0,1]
v_pk_fma_f32 v[68:69], v[48:49], s[62:63], v[68:69] op_sel:[1,1,0] op_sel_hi:[1,0,1] neg_lo:[0,0,0] neg_hi:[0,0,0]
v_pk_add_f32 v[48:49], v[54:55], v[70:71] neg_lo:[0,1] neg_hi:[0,1]
v_pk_add_f32 v[54:55], v[54:55], v[70:71]
v_pk_mul_f32 v[70:71], v[48:49], s[54:55] op_sel:[0,1] op_sel_hi:[0,0] neg_lo:[0,0] neg_hi:[0,1]
v_pk_fma_f32 v[70:71], v[48:49], s[54:55], v[70:71] op_sel:[1,0,0] op_sel_hi:[1,1,1] neg_lo:[0,0,0] neg_hi:[0,0,0]
v_pk_add_f32 v[48:49], v[56:57], v[72:73] op_sel:[1,1] op_sel_hi:[0,0] neg_lo:[0,1] neg_hi:[1,0]
v_pk_add_f32 v[56:57], v[56:57], v[72:73]
v_pk_add_f32 v[72:73], v[58:59], v[74:75] neg_lo:[0,1] neg_hi:[0,1]
v_pk_add_f32 v[58:59], v[58:59], v[74:75]
v_pk_mul_f32 v[74:75], v[72:73], s[54:55] op_sel:[0,1] op_sel_hi:[0,0] neg_lo:[0,1] neg_hi:[0,1]
v_pk_fma_f32 v[74:75], v[72:73], s[54:55], v[74:75] op_sel:[1,0,0] op_sel_hi:[1,1,1] neg_lo:[0,0,0] neg_hi:[0,1,0]
v_pk_add_f32 v[72:73], v[60:61], v[76:77] neg_lo:[0,1] neg_hi:[0,1]
v_pk_add_f32 v[60:61], v[60:61], v[76:77]
v_pk_mul_f32 v[76:77], v[72:73], s[62:63] op_sel:[0,0] op_sel_hi:[0,1] neg_lo:[0,1] neg_hi:[0,1]
v_pk_fma_f32 v[76:77], v[72:73], s[62:63], v[76:77] op_sel:[1,1,0] op_sel_hi:[1,0,1] neg_lo:[0,0,0] neg_hi:[0,1,0]
v_pk_add_f32 v[72:73], v[62:63], v[78:79] neg_lo:[0,1] neg_hi:[0,1]
v_pk_add_f32 v[62:63], v[62:63], v[78:79]
v_pk_mul_f32 v[78:79], v[72:73], s[54:55] op_sel:[0,0] op_sel_hi:[0,1] neg_lo:[0,1] neg_hi:[0,1]
v_pk_fma_f32 v[78:79], v[72:73], s[54:55], v[78:79] op_sel:[1,1,0] op_sel_hi:[1,0,1] neg_lo:[0,0,0] neg_hi:[0,1,0]
v_pk_add_f32 v[72:73], v[16:17], v[24:25] neg_lo:[0,1] neg_hi:[0,1]
v_pk_add_f32 v[16:17], v[16:17], v[24:25]
v_pk_add_f32 v[24:25], v[18:19], v[26:27] neg_lo:[0,1] neg_hi:[0,1]
v_pk_add_f32 v[18:19], v[18:19], v[26:27]
v_pk_mul_f32 v[26:27], v[24:25], s[62:63] op_sel:[0,0] op_sel_hi:[0,1] neg_lo:[0,0] neg_hi:[0,1]
v_pk_fma_f32 v[26:27], v[24:25], s[62:63], v[26:27] op_sel:[1,1,0] op_sel_hi:[1,0,1] neg_lo:[0,0,0] neg_hi:[0,0,0]
v_pk_add_f32 v[24:25], v[20:21], v[28:29] op_sel:[1,1] op_sel_hi:[0,0] neg_lo:[0,1] neg_hi:[1,0]
v_pk_add_f32 v[20:21], v[20:21], v[28:29]
v_pk_add_f32 v[28:29], v[22:23], v[30:31] neg_lo:[0,1] neg_hi:[0,1]
v_pk_add_f32 v[22:23], v[22:23], v[30:31]
v_pk_mul_f32 v[30:31], v[28:29], s[62:63] op_sel:[0,0] op_sel_hi:[0,1] neg_lo:[0,1] neg_hi:[0,1]
v_pk_fma_f32 v[30:31], v[28:29], s[62:63], v[30:31] op_sel:[1,1,0] op_sel_hi:[1,0,1] neg_lo:[0,0,0] neg_hi:[0,1,0]
v_pk_add_f32 v[28:29], v[64:65], v[32:33] neg_lo:[0,1] neg_hi:[0,1]
v_pk_add_f32 v[64:65], v[64:65], v[32:33]
v_pk_add_f32 v[32:33], v[34:35], v[42:43] neg_lo:[0,1] neg_hi:[0,1]
v_pk_add_f32 v[34:35], v[34:35], v[42:43]
v_pk_mul_f32 v[42:43], v[32:33], s[62:63] op_sel:[0,0] op_sel_hi:[0,1] neg_lo:[0,0] neg_hi:[0,1]
v_pk_fma_f32 v[42:43], v[32:33], s[62:63], v[42:43] op_sel:[1,1,0] op_sel_hi:[1,0,1] neg_lo:[0,0,0] neg_hi:[0,0,0]
v_pk_add_f32 v[32:33], v[36:37], v[44:45] op_sel:[1,1] op_sel_hi:[0,0] neg_lo:[0,1] neg_hi:[1,0]
v_pk_add_f32 v[36:37], v[36:37], v[44:45]
v_pk_add_f32 v[44:45], v[38:39], v[46:47] neg_lo:[0,1] neg_hi:[0,1]
v_pk_add_f32 v[38:39], v[38:39], v[46:47]
v_pk_mul_f32 v[46:47], v[44:45], s[62:63] op_sel:[0,0] op_sel_hi:[0,1] neg_lo:[0,1] neg_hi:[0,1]
v_pk_fma_f32 v[46:47], v[44:45], s[62:63], v[46:47] op_sel:[1,1,0] op_sel_hi:[1,0,1] neg_lo:[0,0,0] neg_hi:[0,1,0]
v_pk_add_f32 v[44:45], v[14:15], v[56:57] neg_lo:[0,1] neg_hi:[0,1]
v_pk_add_f32 v[14:15], v[14:15], v[56:57]
v_pk_add_f32 v[56:57], v[50:51], v[58:59] neg_lo:[0,1] neg_hi:[0,1]
v_pk_add_f32 v[50:51], v[50:51], v[58:59]
v_pk_mul_f32 v[58:59], v[56:57], s[62:63] op_sel:[0,0] op_sel_hi:[0,1] neg_lo:[0,0] neg_hi:[0,1]
v_pk_fma_f32 v[58:59], v[56:57], s[62:63], v[58:59] op_sel:[1,1,0] op_sel_hi:[1,0,1] neg_lo:[0,0,0] neg_hi:[0,0,0]
v_pk_add_f32 v[56:57], v[52:53], v[60:61] op_sel:[1,1] op_sel_hi:[0,0] neg_lo:[0,1] neg_hi:[1,0]
v_pk_add_f32 v[52:53], v[52:53], v[60:61]
v_pk_add_f32 v[60:61], v[54:55], v[62:63] neg_lo:[0,1] neg_hi:[0,1]
v_pk_add_f32 v[54:55], v[54:55], v[62:63]
v_pk_mul_f32 v[62:63], v[60:61], s[62:63] op_sel:[0,0] op_sel_hi:[0,1] neg_lo:[0,1] neg_hi:[0,1]
v_pk_fma_f32 v[62:63], v[60:61], s[62:63], v[62:63] op_sel:[1,1,0] op_sel_hi:[1,0,1] neg_lo:[0,0,0] neg_hi:[0,1,0]
v_pk_add_f32 v[60:61], v[40:41], v[48:49] neg_lo:[0,1] neg_hi:[0,1]
v_pk_add_f32 v[40:41], v[40:41], v[48:49]
v_pk_add_f32 v[48:49], v[66:67], v[74:75] neg_lo:[0,1] neg_hi:[0,1]
v_pk_add_f32 v[66:67], v[66:67], v[74:75]
v_pk_mul_f32 v[74:75], v[48:49], s[62:63] op_sel:[0,0] op_sel_hi:[0,1] neg_lo:[0,0] neg_hi:[0,1]
v_pk_fma_f32 v[74:75], v[48:49], s[62:63], v[74:75] op_sel:[1,1,0] op_sel_hi:[1,0,1] neg_lo:[0,0,0] neg_hi:[0,0,0]
v_pk_add_f32 v[48:49], v[68:69], v[76:77] op_sel:[1,1] op_sel_hi:[0,0] neg_lo:[0,1] neg_hi:[1,0]
v_pk_add_f32 v[68:69], v[68:69], v[76:77]
v_pk_add_f32 v[76:77], v[70:71], v[78:79] neg_lo:[0,1] neg_hi:[0,1]
v_pk_add_f32 v[70:71], v[70:71], v[78:79]
v_pk_mul_f32 v[78:79], v[76:77], s[62:63] op_sel:[0,0] op_sel_hi:[0,1] neg_lo:[0,1] neg_hi:[0,1]
v_pk_fma_f32 v[78:79], v[76:77], s[62:63], v[78:79] op_sel:[1,1,0] op_sel_hi:[1,0,1] neg_lo:[0,0,0] neg_hi:[0,1,0]
v_pk_add_f32 v[76:77], v[16:17], v[20:21] neg_lo:[0,1] neg_hi:[0,1]
v_pk_add_f32 v[16:17], v[16:17], v[20:21]
v_pk_add_f32 v[20:21], v[18:19], v[22:23] op_sel:[1,1] op_sel_hi:[0,0] neg_lo:[0,1] neg_hi:[1,0]
v_pk_add_f32 v[18:19], v[18:19], v[22:23]
v_pk_add_f32 v[22:23], v[72:73], v[24:25] neg_lo:[0,1] neg_hi:[0,1]
v_pk_add_f32 v[72:73], v[72:73], v[24:25]
v_pk_add_f32 v[24:25], v[26:27], v[30:31] op_sel:[1,1] op_sel_hi:[0,0] neg_lo:[0,1] neg_hi:[1,0]
v_pk_add_f32 v[26:27], v[26:27], v[30:31]
v_pk_add_f32 v[30:31], v[64:65], v[36:37] neg_lo:[0,1] neg_hi:[0,1]
v_pk_add_f32 v[64:65], v[64:65], v[36:37]
v_pk_add_f32 v[36:37], v[34:35], v[38:39] op_sel:[1,1] op_sel_hi:[0,0] neg_lo:[0,1] neg_hi:[1,0]
v_pk_add_f32 v[34:35], v[34:35], v[38:39]
v_pk_add_f32 v[38:39], v[28:29], v[32:33] neg_lo:[0,1] neg_hi:[0,1]
v_pk_add_f32 v[28:29], v[28:29], v[32:33]
v_pk_add_f32 v[32:33], v[42:43], v[46:47] op_sel:[1,1] op_sel_hi:[0,0] neg_lo:[0,1] neg_hi:[1,0]
v_pk_add_f32 v[42:43], v[42:43], v[46:47]
v_pk_add_f32 v[46:47], v[14:15], v[52:53] neg_lo:[0,1] neg_hi:[0,1]
v_pk_add_f32 v[14:15], v[14:15], v[52:53]
v_pk_add_f32 v[52:53], v[50:51], v[54:55] op_sel:[1,1] op_sel_hi:[0,0] neg_lo:[0,1] neg_hi:[1,0]
v_pk_add_f32 v[50:51], v[50:51], v[54:55]
v_pk_add_f32 v[54:55], v[44:45], v[56:57] neg_lo:[0,1] neg_hi:[0,1]
v_pk_add_f32 v[44:45], v[44:45], v[56:57]
v_pk_add_f32 v[56:57], v[58:59], v[62:63] op_sel:[1,1] op_sel_hi:[0,0] neg_lo:[0,1] neg_hi:[1,0]
v_pk_add_f32 v[58:59], v[58:59], v[62:63]
v_pk_add_f32 v[62:63], v[40:41], v[68:69] neg_lo:[0,1] neg_hi:[0,1]
v_pk_add_f32 v[40:41], v[40:41], v[68:69]
v_pk_add_f32 v[68:69], v[66:67], v[70:71] op_sel:[1,1] op_sel_hi:[0,0] neg_lo:[0,1] neg_hi:[1,0]
v_pk_add_f32 v[66:67], v[66:67], v[70:71]
v_pk_add_f32 v[70:71], v[60:61], v[48:49] neg_lo:[0,1] neg_hi:[0,1]
v_pk_add_f32 v[60:61], v[60:61], v[48:49]
v_pk_add_f32 v[48:49], v[74:75], v[78:79] op_sel:[1,1] op_sel_hi:[0,0] neg_lo:[0,1] neg_hi:[1,0]
v_pk_add_f32 v[74:75], v[74:75], v[78:79]
v_pk_add_f32 v[78:79], v[16:17], v[18:19] neg_lo:[0,1] neg_hi:[0,1]
v_pk_add_f32 v[16:17], v[16:17], v[18:19]
v_pk_add_f32 v[18:19], v[76:77], v[20:21] neg_lo:[0,1] neg_hi:[0,1]
v_pk_add_f32 v[76:77], v[76:77], v[20:21]
v_pk_add_f32 v[20:21], v[72:73], v[26:27] neg_lo:[0,1] neg_hi:[0,1]
v_pk_add_f32 v[72:73], v[72:73], v[26:27]
v_pk_add_f32 v[26:27], v[22:23], v[24:25] neg_lo:[0,1] neg_hi:[0,1]
v_pk_add_f32 v[22:23], v[22:23], v[24:25]
v_pk_add_f32 v[24:25], v[64:65], v[34:35] neg_lo:[0,1] neg_hi:[0,1]
v_pk_add_f32 v[64:65], v[64:65], v[34:35]
v_pk_add_f32 v[34:35], v[30:31], v[36:37] neg_lo:[0,1] neg_hi:[0,1]
v_pk_add_f32 v[30:31], v[30:31], v[36:37]
v_pk_add_f32 v[36:37], v[28:29], v[42:43] neg_lo:[0,1] neg_hi:[0,1]
v_pk_add_f32 v[28:29], v[28:29], v[42:43]
v_pk_add_f32 v[42:43], v[38:39], v[32:33] neg_lo:[0,1] neg_hi:[0,1]
v_pk_add_f32 v[38:39], v[38:39], v[32:33]
v_pk_add_f32 v[32:33], v[14:15], v[50:51] neg_lo:[0,1] neg_hi:[0,1]
v_pk_add_f32 v[14:15], v[14:15], v[50:51]
v_pk_add_f32 v[50:51], v[46:47], v[52:53] neg_lo:[0,1] neg_hi:[0,1]
v_pk_add_f32 v[46:47], v[46:47], v[52:53]
v_pk_add_f32 v[52:53], v[44:45], v[58:59] neg_lo:[0,1] neg_hi:[0,1]
v_pk_add_f32 v[44:45], v[44:45], v[58:59]
v_pk_add_f32 v[58:59], v[54:55], v[56:57] neg_lo:[0,1] neg_hi:[0,1]
v_pk_add_f32 v[54:55], v[54:55], v[56:57]
v_pk_add_f32 v[56:57], v[40:41], v[66:67] neg_lo:[0,1] neg_hi:[0,1]
v_pk_add_f32 v[40:41], v[40:41], v[66:67]
v_pk_add_f32 v[66:67], v[62:63], v[68:69] neg_lo:[0,1] neg_hi:[0,1]
v_pk_add_f32 v[62:63], v[62:63], v[68:69]
v_pk_add_f32 v[68:69], v[60:61], v[74:75] neg_lo:[0,1] neg_hi:[0,1]
v_pk_add_f32 v[60:61], v[60:61], v[74:75]
v_pk_add_f32 v[74:75], v[70:71], v[48:49] neg_lo:[0,1] neg_hi:[0,1]
v_pk_add_f32 v[70:71], v[70:71], v[48:49]
v_pk_mul_f32 v[48:49], v[14:15], v[82:83] op_sel:[0,0] op_sel_hi:[0,1] neg_lo:[0,0] neg_hi:[0,0]
v_pk_fma_f32 v[14:15], v[14:15], v[82:83], v[48:49] op_sel:[1,1,0] op_sel_hi:[1,0,1] neg_lo:[0,1,0] neg_hi:[0,0,0]
v_pk_mul_f32 v[48:49], v[64:65], v[84:85] op_sel:[0,0] op_sel_hi:[0,1] neg_lo:[0,0] neg_hi:[0,0]
v_pk_fma_f32 v[64:65], v[64:65], v[84:85], v[48:49] op_sel:[1,1,0] op_sel_hi:[1,0,1] neg_lo:[0,1,0] neg_hi:[0,0,0]
v_pk_mul_f32 v[48:49], v[40:41], v[86:87] op_sel:[0,0] op_sel_hi:[0,1] neg_lo:[0,0] neg_hi:[0,0]
v_pk_fma_f32 v[40:41], v[40:41], v[86:87], v[48:49] op_sel:[1,1,0] op_sel_hi:[1,0,1] neg_lo:[0,1,0] neg_hi:[0,0,0]
v_pk_mul_f32 v[48:49], v[72:73], v[88:89] op_sel:[0,0] op_sel_hi:[0,1] neg_lo:[0,0] neg_hi:[0,0]
v_pk_fma_f32 v[72:73], v[72:73], v[88:89], v[48:49] op_sel:[1,1,0] op_sel_hi:[1,0,1] neg_lo:[0,1,0] neg_hi:[0,0,0]
v_pk_mul_f32 v[48:49], v[44:45], v[90:91] op_sel:[0,0] op_sel_hi:[0,1] neg_lo:[0,0] neg_hi:[0,0]
v_pk_fma_f32 v[44:45], v[44:45], v[90:91], v[48:49] op_sel:[1,1,0] op_sel_hi:[1,0,1] neg_lo:[0,1,0] neg_hi:[0,0,0]
v_pk_mul_f32 v[48:49], v[28:29], v[92:93] op_sel:[0,0] op_sel_hi:[0,1] neg_lo:[0,0] neg_hi:[0,0]
v_pk_fma_f32 v[28:29], v[28:29], v[92:93], v[48:49] op_sel:[1,1,0] op_sel_hi:[1,0,1] neg_lo:[0,1,0] neg_hi:[0,0,0]
v_pk_mul_f32 v[48:49], v[60:61], v[94:95] op_sel:[0,0] op_sel_hi:[0,1] neg_lo:[0,0] neg_hi:[0,0]
v_pk_fma_f32 v[60:61], v[60:61], v[94:95], v[48:49] op_sel:[1,1,0] op_sel_hi:[1,0,1] neg_lo:[0,1,0] neg_hi:[0,0,0]
v_pk_mul_f32 v[48:49], v[76:77], v[96:97] op_sel:[0,0] op_sel_hi:[0,1] neg_lo:[0,0] neg_hi:[0,0]
v_pk_fma_f32 v[76:77], v[76:77], v[96:97], v[48:49] op_sel:[1,1,0] op_sel_hi:[1,0,1] neg_lo:[0,1,0] neg_hi:[0,0,0]
v_pk_mul_f32 v[48:49], v[46:47], v[98:99] op_sel:[0,0] op_sel_hi:[0,1] neg_lo:[0,0] neg_hi:[0,0]
v_pk_fma_f32 v[46:47], v[46:47], v[98:99], v[48:49] op_sel:[1,1,0] op_sel_hi:[1,0,1] neg_lo:[0,1,0] neg_hi:[0,0,0]
v_pk_mul_f32 v[48:49], v[30:31], v[100:101] op_sel:[0,0] op_sel_hi:[0,1] neg_lo:[0,0] neg_hi:[0,0]
v_pk_fma_f32 v[30:31], v[30:31], v[100:101], v[48:49] op_sel:[1,1,0] op_sel_hi:[1,0,1] neg_lo:[0,1,0] neg_hi:[0,0,0]
v_pk_mul_f32 v[48:49], v[62:63], v[102:103] op_sel:[0,0] op_sel_hi:[0,1] neg_lo:[0,0] neg_hi:[0,0]
v_pk_fma_f32 v[62:63], v[62:63], v[102:103], v[48:49] op_sel:[1,1,0] op_sel_hi:[1,0,1] neg_lo:[0,1,0] neg_hi:[0,0,0]
v_pk_mul_f32 v[48:49], v[22:23], v[104:105] op_sel:[0,0] op_sel_hi:[0,1] neg_lo:[0,0] neg_hi:[0,0]
v_pk_fma_f32 v[22:23], v[22:23], v[104:105], v[48:49] op_sel:[1,1,0] op_sel_hi:[1,0,1] neg_lo:[0,1,0] neg_hi:[0,0,0]
v_pk_mul_f32 v[48:49], v[54:55], v[106:107] op_sel:[0,0] op_sel_hi:[0,1] neg_lo:[0,0] neg_hi:[0,0]
v_pk_fma_f32 v[54:55], v[54:55], v[106:107], v[48:49] op_sel:[1,1,0] op_sel_hi:[1,0,1] neg_lo:[0,1,0] neg_hi:[0,0,0]
v_pk_mul_f32 v[48:49], v[38:39], v[108:109] op_sel:[0,0] op_sel_hi:[0,1] neg_lo:[0,0] neg_hi:[0,0]
v_pk_fma_f32 v[38:39], v[38:39], v[108:109], v[48:49] op_sel:[1,1,0] op_sel_hi:[1,0,1] neg_lo:[0,1,0] neg_hi:[0,0,0]
v_pk_mul_f32 v[48:49], v[70:71], v[110:111] op_sel:[0,0] op_sel_hi:[0,1] neg_lo:[0,0] neg_hi:[0,0]
v_pk_fma_f32 v[70:71], v[70:71], v[110:111], v[48:49] op_sel:[1,1,0] op_sel_hi:[1,0,1] neg_lo:[0,1,0] neg_hi:[0,0,0]
v_pk_mul_f32 v[48:49], v[78:79], v[112:113] op_sel:[0,0] op_sel_hi:[0,1] neg_lo:[0,0] neg_hi:[0,0]
v_pk_fma_f32 v[78:79], v[78:79], v[112:113], v[48:49] op_sel:[1,1,0] op_sel_hi:[1,0,1] neg_lo:[0,1,0] neg_hi:[0,0,0]
v_pk_mul_f32 v[48:49], v[32:33], v[114:115] op_sel:[0,0] op_sel_hi:[0,1] neg_lo:[0,0] neg_hi:[0,0]
v_pk_fma_f32 v[32:33], v[32:33], v[114:115], v[48:49] op_sel:[1,1,0] op_sel_hi:[1,0,1] neg_lo:[0,1,0] neg_hi:[0,0,0]
v_pk_mul_f32 v[48:49], v[24:25], v[116:117] op_sel:[0,0] op_sel_hi:[0,1] neg_lo:[0,0] neg_hi:[0,0]
v_pk_fma_f32 v[24:25], v[24:25], v[116:117], v[48:49] op_sel:[1,1,0] op_sel_hi:[1,0,1] neg_lo:[0,1,0] neg_hi:[0,0,0]
v_pk_mul_f32 v[48:49], v[56:57], v[118:119] op_sel:[0,0] op_sel_hi:[0,1] neg_lo:[0,0] neg_hi:[0,0]
v_pk_fma_f32 v[56:57], v[56:57], v[118:119], v[48:49] op_sel:[1,1,0] op_sel_hi:[1,0,1] neg_lo:[0,1,0] neg_hi:[0,0,0]
v_pk_mul_f32 v[48:49], v[20:21], v[120:121] op_sel:[0,0] op_sel_hi:[0,1] neg_lo:[0,0] neg_hi:[0,0]
v_pk_fma_f32 v[20:21], v[20:21], v[120:121], v[48:49] op_sel:[1,1,0] op_sel_hi:[1,0,1] neg_lo:[0,1,0] neg_hi:[0,0,0]
v_pk_mul_f32 v[48:49], v[52:53], v[122:123] op_sel:[0,0] op_sel_hi:[0,1] neg_lo:[0,0] neg_hi:[0,0]
v_pk_fma_f32 v[52:53], v[52:53], v[122:123], v[48:49] op_sel:[1,1,0] op_sel_hi:[1,0,1] neg_lo:[0,1,0] neg_hi:[0,0,0]
v_pk_mul_f32 v[48:49], v[36:37], v[124:125] op_sel:[0,0] op_sel_hi:[0,1] neg_lo:[0,0] neg_hi:[0,0]
v_pk_fma_f32 v[36:37], v[36:37], v[124:125], v[48:49] op_sel:[1,1,0] op_sel_hi:[1,0,1] neg_lo:[0,1,0] neg_hi:[0,0,0]
v_pk_mul_f32 v[48:49], v[68:69], v[126:127] op_sel:[0,0] op_sel_hi:[0,1] neg_lo:[0,0] neg_hi:[0,0]
v_pk_fma_f32 v[68:69], v[68:69], v[126:127], v[48:49] op_sel:[1,1,0] op_sel_hi:[1,0,1] neg_lo:[0,1,0] neg_hi:[0,0,0]
v_pk_mul_f32 v[48:49], v[18:19], v[128:129] op_sel:[0,0] op_sel_hi:[0,1] neg_lo:[0,0] neg_hi:[0,0]
v_pk_fma_f32 v[18:19], v[18:19], v[128:129], v[48:49] op_sel:[1,1,0] op_sel_hi:[1,0,1] neg_lo:[0,1,0] neg_hi:[0,0,0]
v_pk_mul_f32 v[48:49], v[50:51], v[130:131] op_sel:[0,0] op_sel_hi:[0,1] neg_lo:[0,0] neg_hi:[0,0]
v_pk_fma_f32 v[50:51], v[50:51], v[130:131], v[48:49] op_sel:[1,1,0] op_sel_hi:[1,0,1] neg_lo:[0,1,0] neg_hi:[0,0,0]
v_pk_mul_f32 v[48:49], v[34:35], v[132:133] op_sel:[0,0] op_sel_hi:[0,1] neg_lo:[0,0] neg_hi:[0,0]
v_pk_fma_f32 v[34:35], v[34:35], v[132:133], v[48:49] op_sel:[1,1,0] op_sel_hi:[1,0,1] neg_lo:[0,1,0] neg_hi:[0,0,0]
v_pk_mul_f32 v[48:49], v[66:67], v[134:135] op_sel:[0,0] op_sel_hi:[0,1] neg_lo:[0,0] neg_hi:[0,0]
v_pk_fma_f32 v[66:67], v[66:67], v[134:135], v[48:49] op_sel:[1,1,0] op_sel_hi:[1,0,1] neg_lo:[0,1,0] neg_hi:[0,0,0]
v_pk_mul_f32 v[48:49], v[26:27], v[136:137] op_sel:[0,0] op_sel_hi:[0,1] neg_lo:[0,0] neg_hi:[0,0]
v_pk_fma_f32 v[26:27], v[26:27], v[136:137], v[48:49] op_sel:[1,1,0] op_sel_hi:[1,0,1] neg_lo:[0,1,0] neg_hi:[0,0,0]
v_pk_mul_f32 v[48:49], v[58:59], v[138:139] op_sel:[0,0] op_sel_hi:[0,1] neg_lo:[0,0] neg_hi:[0,0]
v_pk_fma_f32 v[58:59], v[58:59], v[138:139], v[48:49] op_sel:[1,1,0] op_sel_hi:[1,0,1] neg_lo:[0,1,0] neg_hi:[0,0,0]
v_pk_mul_f32 v[48:49], v[42:43], v[140:141] op_sel:[0,0] op_sel_hi:[0,1] neg_lo:[0,0] neg_hi:[0,0]
v_pk_fma_f32 v[42:43], v[42:43], v[140:141], v[48:49] op_sel:[1,1,0] op_sel_hi:[1,0,1] neg_lo:[0,1,0] neg_hi:[0,0,0]
v_pk_mul_f32 v[48:49], v[74:75], v[142:143] op_sel:[0,0] op_sel_hi:[0,1] neg_lo:[0,0] neg_hi:[0,0]
v_pk_fma_f32 v[74:75], v[74:75], v[142:143], v[48:49] op_sel:[1,1,0] op_sel_hi:[1,0,1] neg_lo:[0,1,0] neg_hi:[0,0,0]
ds_write_b64 v3, v[16:17] offset:0
ds_write_b64 v3, v[14:15] offset:528
ds_write_b64 v3, v[64:65] offset:1056
ds_write_b64 v3, v[40:41] offset:1584
ds_write_b64 v3, v[72:73] offset:2112
ds_write_b64 v3, v[44:45] offset:2640
ds_write_b64 v3, v[28:29] offset:3168
ds_write_b64 v3, v[60:61] offset:3696
ds_write_b64 v3, v[76:77] offset:4224
ds_write_b64 v3, v[46:47] offset:4752
ds_write_b64 v3, v[30:31] offset:5280
ds_write_b64 v3, v[62:63] offset:5808
ds_write_b64 v3, v[22:23] offset:6336
ds_write_b64 v3, v[54:55] offset:6864
ds_write_b64 v3, v[38:39] offset:7392
ds_write_b64 v3, v[70:71] offset:7920
ds_write_b64 v3, v[78:79] offset:8448
ds_write_b64 v3, v[32:33] offset:8976
ds_write_b64 v3, v[24:25] offset:9504
ds_write_b64 v3, v[56:57] offset:10032
ds_write_b64 v3, v[20:21] offset:10560
ds_write_b64 v3, v[52:53] offset:11088
ds_write_b64 v3, v[36:37] offset:11616
ds_write_b64 v3, v[68:69] offset:12144
ds_write_b64 v3, v[18:19] offset:12672
ds_write_b64 v3, v[50:51] offset:13200
ds_write_b64 v3, v[34:35] offset:13728
ds_write_b64 v3, v[66:67] offset:14256
ds_write_b64 v3, v[26:27] offset:14784
ds_write_b64 v3, v[58:59] offset:15312
ds_write_b64 v3, v[42:43] offset:15840
ds_write_b64 v3, v[74:75] offset:16368
s_waitcnt lgkmcnt(0)
ds_read_b64 v[16:17], v4 offset:0
ds_read_b64 v[48:49], v4 offset:256
ds_read_b64 v[18:19], v4 offset:16
ds_read_b64 v[50:51], v4 offset:272
ds_read_b64 v[20:21], v4 offset:32
ds_read_b64 v[52:53], v4 offset:288
ds_read_b64 v[22:23], v4 offset:48
ds_read_b64 v[54:55], v4 offset:304
ds_read_b64 v[24:25], v4 offset:64
ds_read_b64 v[56:57], v4 offset:320
ds_read_b64 v[26:27], v4 offset:80
ds_read_b64 v[58:59], v4 offset:336
ds_read_b64 v[28:29], v4 offset:96
ds_read_b64 v[60:61], v4 offset:352
ds_read_b64 v[30:31], v4 offset:112
ds_read_b64 v[62:63], v4 offset:368
ds_read_b64 v[32:33], v4 offset:128
ds_read_b64 v[64:65], v4 offset:384
ds_read_b64 v[34:35], v4 offset:144
ds_read_b64 v[66:67], v4 offset:400
ds_read_b64 v[36:37], v4 offset:160
ds_read_b64 v[68:69], v4 offset:416
ds_read_b64 v[38:39], v4 offset:176
ds_read_b64 v[70:71], v4 offset:432
ds_read_b64 v[40:41], v4 offset:192
ds_read_b64 v[72:73], v4 offset:448
ds_read_b64 v[42:43], v4 offset:208
ds_read_b64 v[74:75], v4 offset:464
ds_read_b64 v[44:45], v4 offset:224
ds_read_b64 v[76:77], v4 offset:480
ds_read_b64 v[46:47], v4 offset:240
ds_read_b64 v[78:79], v4 offset:496
s_waitcnt lgkmcnt(0)
v_pk_add_f32 v[14:15], v[16:17], v[48:49] neg_lo:[0,1] neg_hi:[0,1]
v_pk_add_f32 v[16:17], v[16:17], v[48:49]
v_pk_add_f32 v[48:49], v[18:19], v[50:51] neg_lo:[0,1] neg_hi:[0,1]
v_pk_add_f32 v[18:19], v[18:19], v[50:51]
v_pk_mul_f32 v[50:51], v[48:49], s[50:51] op_sel:[0,0] op_sel_hi:[0,1] neg_lo:[0,0] neg_hi:[0,1]
v_pk_fma_f32 v[50:51], v[48:49], s[50:51], v[50:51] op_sel:[1,1,0] op_sel_hi:[1,0,1] neg_lo:[0,0,0] neg_hi:[0,0,0]
v_pk_add_f32 v[48:49], v[20:21], v[52:53] neg_lo:[0,1] neg_hi:[0,1]
v_pk_add_f32 v[20:21], v[20:21], v[52:53]
v_pk_mul_f32 v[52:53], v[48:49], s[54:55] op_sel:[0,0] op_sel_hi:[0,1] neg_lo:[0,0] neg_hi:[0,1]
v_pk_fma_f32 v[52:53], v[48:49], s[54:55], v[52:53] op_sel:[1,1,0] op_sel_hi:[1,0,1] neg_lo:[0,0,0] neg_hi:[0,0,0]
v_pk_add_f32 v[48:49], v[22:23], v[54:55] neg_lo:[0,1] neg_hi:[0,1]
v_pk_add_f32 v[22:23], v[22:23], v[54:55]
v_pk_mul_f32 v[54:55], v[48:49], s[58:59] op_sel:[0,0] op_sel_hi:[0,1] neg_lo:[0,0] neg_hi:[0,1]
v_pk_fma_f32 v[54:55], v[48:49], s[58:59], v[54:55] op_sel:[1,1,0] op_sel_hi:[1,0,1] neg_lo:[0,0,0] neg_hi:[0,0,0]
v_pk_add_f32 v[48:49], v[24:25], v[56:57] neg_lo:[0,1] neg_hi:[0,1]
v_pk_add_f32 v[24:25], v[24:25], v[56:57]
v_pk_mul_f32 v[56:57], v[48:49], s[62:63] op_sel:[0,0] op_sel_hi:[0,1] neg_lo:[0,0] neg_hi:[0,1]
v_pk_fma_f32 v[56:57], v[48:49], s[62:63], v[56:57] op_sel:[1,1,0] op_sel_hi:[1,0,1] neg_lo:[0,0,0] neg_hi:[0,0,0]
v_pk_add_f32 v[48:49], v[26:27], v[58:59] neg_lo:[0,1] neg_hi:[0,1]
v_pk_add_f32 v[26:27], v[26:27], v[58:59]
v_pk_mul_f32 v[58:59], v[48:49], s[58:59] op_sel:[0,1] op_sel_hi:[0,0] neg_lo:[0,0] neg_hi:[0,1]
v_pk_fma_f32 v[58:59], v[48:49], s[58:59], v[58:59] op_sel:[1,0,0] op_sel_hi:[1,1,1] neg_lo:[0,0,0] neg_hi:[0,0,0]
v_pk_add_f32 v[48:49], v[28:29], v[60:61] neg_lo:[0,1] neg_hi:[0,1]
v_pk_add_f32 v[28:29], v[28:29], v[60:61]
v_pk_mul_f32 v[60:61], v[48:49], s[54:55] op_sel:[0,1] op_sel_hi:[0,0] neg_lo:[0,0] neg_hi:[0,1]
v_pk_fma_f32 v[60:61], v[48:49], s[54:55], v[60:61] op_sel:[1,0,0] op_sel_hi:[1,1,1] neg_lo:[0,0,0] neg_hi:[0,0,0]
v_pk_add_f32 v[48:49], v[30:31], v[62:63] neg_lo:[0,1] neg_hi:[0,1]
v_pk_add_f32 v[30:31], v[30:31], v[62:63]
v_pk_mul_f32 v[62:63], v[48:49], s[50:51] op_sel:[0,1] op_sel_hi:[0,0] neg_lo:[0,0] neg_hi:[0,1]
v_pk_fma_f32 v[62:63], v[48:49], s[50:51], v[62:63] op_sel:[1,0,0] op_sel_hi:[1,1,1] neg_lo:[0,0,0] neg_hi:[0,0,0]
v_pk_add_f32 v[48:49], v[32:33], v[64:65] op_sel:[1,1] op_sel_hi:[0,0] neg_lo:[0,1] neg_hi:[1,0]
v_pk_add_f32 v[32:33], v[32:33], v[64:65]
v_pk_add_f32 v[64:65], v[34:35], v[66:67] neg_lo:[0,1] neg_hi:[0,1]
v_pk_add_f32 v[34:35], v[34:35], v[66:67]
v_pk_mul_f32 v[66:67], v[64:65], s[50:51] op_sel:[0,1] op_sel_hi:[0,0] neg_lo:[0,1] neg_hi:[0,1]
v_pk_fma_f32 v[66:67], v[64:65], s[50:51], v[66:67] op_sel:[1,0,0] op_sel_hi:[1,1,1] neg_lo:[0,0,0] neg_hi:[0,1,0]
v_pk_add_f32 v[64:65], v[36:37], v[68:69] neg_lo:[0,1] neg_hi:[0,1]
v_pk_add_f32 v[36:37], v[36:37], v[68:69]
v_pk_mul_f32 v[68:69], v[64:65], s[54:55] op_sel:[0,1] op_sel_hi:[0,0] neg_lo:[0,1] neg_hi:[0,1]
v_pk_fma_f32 v[68:69], v[64:65], s[54:55], v[68:69] op_sel:[1,0,0] op_sel_hi:[1,1,1] neg_lo:[0,0,0] neg_hi:[0,1,0]
v_pk_add_f32 v[64:65], v[38:39], v[70:71] neg_lo:[0,1] neg_hi:[0,1]
v_pk_add_f32 v[38:39], v[38:39], v[70:71]
v_pk_mul_f32 v[70:71], v[64:65], s[58:59] op_sel:[0,1] op_sel_hi:[0,0] neg_lo:[0,1] neg_hi:[0,1]
v_pk_fma_f32 v[70:71], v[64:65], s[58:59], v[70:71] op_sel:[1,0,0] op_sel_hi:[1,1,1] neg_lo:[0,0,0] neg_hi:[0,1,0]
v_pk_add_f32 v[64:65], v[40:41], v[72:73] neg_lo:[0,1] neg_hi:[0,1]
v_pk_add_f32 v[40:41], v[40:41], v[72:73]
v_pk_mul_f32 v[72:73], v[64:65], s[62:63] op_sel:[0,0] op_sel_hi:[0,1] neg_lo:[0,1] neg_hi:[0,1]
v_pk_fma_f32 v[72:73], v[64:65], s[62:63], v[72:73] op_sel:[1,1,0] op_sel_hi:[1,0,1] neg_lo:[0,0,0] neg_hi:[0,1,0]
v_pk_add_f32 v[64:65], v[42:43], v[74:75] neg_lo:[0,1] neg_hi:[0,1]
v_pk_add_f32 v[42:43], v[42:43], v[74:75]
v_pk_mul_f32 v[74:75], v[64:65], s[58:59] op_sel:[0,0] op_sel_hi:[0,1] neg_lo:[0,1] neg_hi:[0,1]
v_pk_fma_f32 v[74:75], v[64:65], s[58:59], v[74:75] op_sel:[1,1,0] op_sel_hi:[1,0,1] neg_lo:[0,0,0] neg_hi:[0,1,0]
v_pk_add_f32 v[64:65], v[44:45], v[76:77] neg_lo:[0,1] neg_hi:[0,1]
v_pk_add_f32 v[44:45], v[44:45], v[76:77]
v_pk_mul_f32 v[76:77], v[64:65], s[54:55] op_sel:[0,0] op_sel_hi:[0,1] neg_lo:[0,1] neg_hi:[0,1]
v_pk_fma_f32 v[76:77], v[64:65], s[54:55], v[76:77] op_sel:[1,1,0] op_sel_hi:[1,0,1] neg_lo:[0,0,0] neg_hi:[0,1,0]
v_pk_add_f32 v[64:65], v[46:47], v[78:79] neg_lo:[0,1] neg_hi:[0,1]
v_pk_add_f32 v[46:47], v[46:47], v[78:79]
v_pk_mul_f32 v[78:79], v[64:65], s[50:51] op_sel:[0,0] op_sel_hi:[0,1] neg_lo:[0,1] neg_hi:[0,1]
v_pk_fma_f32 v[78:79], v[64:65], s[50:51], v[78:79] op_sel:[1,1,0] op_sel_hi:[1,0,1] neg_lo:[0,0,0] neg_hi:[0,1,0]
v_pk_add_f32 v[64:65], v[16:17], v[32:33] neg_lo:[0,1] neg_hi:[0,1]
v_pk_add_f32 v[16:17], v[16:17], v[32:33]
v_pk_add_f32 v[32:33], v[18:19], v[34:35] neg_lo:[0,1] neg_hi:[0,1]
v_pk_add_f32 v[18:19], v[18:19], v[34:35]
v_pk_mul_f32 v[34:35], v[32:33], s[54:55] op_sel:[0,0] op_sel_hi:[0,1] neg_lo:[0,0] neg_hi:[0,1]
v_pk_fma_f32 v[34:35], v[32:33], s[54:55], v[34:35] op_sel:[1,1,0] op_sel_hi:[1,0,1] neg_lo:[0,0,0] neg_hi:[0,0,0]
v_pk_add_f32 v[32:33], v[20:21], v[36:37] neg_lo:[0,1] neg_hi:[0,1]
v_pk_add_f32 v[20:21], v[20:21], v[36:37]
v_pk_mul_f32 v[36:37], v[32:33], s[62:63] op_sel:[0,0] op_sel_hi:[0,1] neg_lo:[0,0] neg_hi:[0,1]
v_pk_fma_f32 v[36:37], v[32:33], s[62:63], v[36:37] op_sel:[1,1,0] op_sel_hi:[1,0,1] neg_lo:[0,0,0] neg_hi:[0,0,0]
v_pk_add_f32 v[32:33], v[22:23], v[38:39] neg_lo:[0,1] neg_hi:[0,1]
v_pk_add_f32 v[22:23], v[22:23], v[38:39]
v_pk_mul_f32 v[38:39], v[32:33], s[54:55] op_sel:[0,1] op_sel_hi:[0,0] neg_lo:[0,0] neg_hi:[0,1]
v_pk_fma_f32 v[38:39], v[32:33], s[54:55], v[38:39] op_sel:[1,0,0] op_sel_hi:[1,1,1] neg_lo:[0,0,0] neg_hi:[0,0,0]
v_pk_add_f32 v[32:33], v[24:25], v[40:41] op_sel:[1,1] op_sel_hi:[0,0] neg_lo:[0,1] neg_hi:[1,0]
v_pk_add_f32 v[24:25], v[24:25], v[40:41]
v_pk_add_f32 v[40:41], v[26:27], v[42:43] neg_lo:[0,1] neg_hi:[0,1]
v_pk_add_f32 v[26:27], v[26:27], v[42:43]
v_pk_mul_f32 v[42:43], v[40:41], s[54:55] op_sel:[0,1] op_sel_hi:[0,0] neg_lo:[0,1] neg_hi:[0,1]
v_pk_fma_f32 v[42:43], v[40:41], s[54:55], v[42:43] op_sel:[1,0,0] op_sel_hi:[1,1,1] neg_lo:[0,0,0] neg_hi:[0,1,0]
v_pk_add_f32 v[40:41], v[28:29], v[44:45] neg_lo:[0,1] neg_hi:[0,1]
v_pk_add_f32 v[28:29], v[28:29], v[44:45]
v_pk_mul_f32 v[44:45], v[40:41], s[62:63] op_sel:[0,0] op_sel_hi:[0,1] neg_lo:[0,1] neg_hi:[0,1]
v_pk_fma_f32 v[44:45], v[40:41], s[62:63], v[44:45] op_sel:[1,1,0] op_sel_hi:[1,0,1] neg_lo:[0,0,0] neg_hi:[0,1,0]
v_pk_add_f32 v[40:41], v[30:31], v[46:47] neg_lo:[0,1] neg_hi:[0,1]
v_pk_add_f32 v[30:31], v[30:31], v[46:47]
v_pk_mul_f32 v[46:47], v[40:41], s[54:55] op_sel:[0,0] op_sel_hi:[0,1] neg_lo:[0,1] neg_hi:[0,1]
v_pk_fma_f32 v[46:47], v[40:41], s[54:55], v[46:47] op_sel:[1,1,0] op_sel_hi:[1,0,1] neg_lo:[0,0,0] neg_hi:[0,1,0]
v_pk_add_f32 v[40:41], v[14:15], v[48:49] neg_lo:[0,1] neg_hi:[0,1]
v_pk_add_f32 v[14:15], v[14:15], v[48:49]
v_pk_add_f32 v[48:49], v[50:51], v[66:67] neg_lo:[0,1] neg_hi:[0,1]
v_pk_add_f32 v[50:51], v[50:51], v[66:67]
v_pk_mul_f32 v[66:67], v[48:49], s[54:55] op_sel:[0,0] op_sel_hi:[0,1] neg_lo:[0,0] neg_hi:[0,1]
v_pk_fma_f32 v[66:67], v[48:49], s[54:55], v[66:67] op_sel:[1,1,0] op_sel_hi:[1,0,1] neg_lo:[0,0,0] neg_hi:[0,0,0]
v_pk_add_f32 v[48:49], v[52:53], v[68:69] neg_lo:[0,1] neg_hi:[0,1]
v_pk_add_f32 v[52:53], v[52:53], v[68:69]
v_pk_mul_f32 v[68:69], v[48:49], s[62:63] op_sel:[0,0] op_sel_hi:[0,1] neg_lo:[0,0] neg_hi:[0,1]
v_pk_fma_f32 v[68:69], v[48:49], s[62:63], v[68:69] op_sel:[1,1,0] op_sel_hi:[1,0,1] neg_lo:[0,0,0] neg_hi:[0,0,0]
v_pk_add_f32 v[48:49], v[54:55], v[70:71] neg_lo:[0,1] neg_hi:[0,1]
v_pk_add_f32 v[54:55], v[54:55], v[70:71]
v_pk_mul_f32 v[70:71], v[48:49], s[54:55] op_sel:[0,1] op_sel_hi:[0,0] neg_lo:[0,0] neg_hi:[0,1]
v_pk_fma_f32 v[70:71], v[48:49], s[54:55], v[70:71] op_sel:[1,0,0] op_sel_hi:[1,1,1] neg_lo:[0,0,0] neg_hi:[0,0,0]
v_pk_add_f32 v[48:49], v[56:57], v[72:73] op_sel:[1,1] op_sel_hi:[0,0] neg_lo:[0,1] neg_hi:[1,0]
v_pk_add_f32 v[56:57], v[56:57], v[72:73]
v_pk_add_f32 v[72:73], v[58:59], v[74:75] neg_lo:[0,1] neg_hi:[0,1]
v_pk_add_f32 v[58:59], v[58:59], v[74:75]
v_pk_mul_f32 v[74:75], v[72:73], s[54:55] op_sel:[0,1] op_sel_hi:[0,0] neg_lo:[0,1] neg_hi:[0,1]
v_pk_fma_f32 v[74:75], v[72:73], s[54:55], v[74:75] op_sel:[1,0,0] op_sel_hi:[1,1,1] neg_lo:[0,0,0] neg_hi:[0,1,0]
v_pk_add_f32 v[72:73], v[60:61], v[76:77] neg_lo:[0,1] neg_hi:[0,1]
v_pk_add_f32 v[60:61], v[60:61], v[76:77]
v_pk_mul_f32 v[76:77], v[72:73], s[62:63] op_sel:[0,0] op_sel_hi:[0,1] neg_lo:[0,1] neg_hi:[0,1]
v_pk_fma_f32 v[76:77], v[72:73], s[62:63], v[76:77] op_sel:[1,1,0] op_sel_hi:[1,0,1] neg_lo:[0,0,0] neg_hi:[0,1,0]
v_pk_add_f32 v[72:73], v[62:63], v[78:79] neg_lo:[0,1] neg_hi:[0,1]
v_pk_add_f32 v[62:63], v[62:63], v[78:79]
v_pk_mul_f32 v[78:79], v[72:73], s[54:55] op_sel:[0,0] op_sel_hi:[0,1] neg_lo:[0,1] neg_hi:[0,1]
v_pk_fma_f32 v[78:79], v[72:73], s[54:55], v[78:79] op_sel:[1,1,0] op_sel_hi:[1,0,1] neg_lo:[0,0,0] neg_hi:[0,1,0]
v_pk_add_f32 v[72:73], v[16:17], v[24:25] neg_lo:[0,1] neg_hi:[0,1]
v_pk_add_f32 v[16:17], v[16:17], v[24:25]
v_pk_add_f32 v[24:25], v[18:19], v[26:27] neg_lo:[0,1] neg_hi:[0,1]
v_pk_add_f32 v[18:19], v[18:19], v[26:27]
v_pk_mul_f32 v[26:27], v[24:25], s[62:63] op_sel:[0,0] op_sel_hi:[0,1] neg_lo:[0,0] neg_hi:[0,1]
v_pk_fma_f32 v[26:27], v[24:25], s[62:63], v[26:27] op_sel:[1,1,0] op_sel_hi:[1,0,1] neg_lo:[0,0,0] neg_hi:[0,0,0]
v_pk_add_f32 v[24:25], v[20:21], v[28:29] op_sel:[1,1] op_sel_hi:[0,0] neg_lo:[0,1] neg_hi:[1,0]
v_pk_add_f32 v[20:21], v[20:21], v[28:29]
v_pk_add_f32 v[28:29], v[22:23], v[30:31] neg_lo:[0,1] neg_hi:[0,1]
v_pk_add_f32 v[22:23], v[22:23], v[30:31]
v_pk_mul_f32 v[30:31], v[28:29], s[62:63] op_sel:[0,0] op_sel_hi:[0,1] neg_lo:[0,1] neg_hi:[0,1]
v_pk_fma_f32 v[30:31], v[28:29], s[62:63], v[30:31] op_sel:[1,1,0] op_sel_hi:[1,0,1] neg_lo:[0,0,0] neg_hi:[0,1,0]
v_pk_add_f32 v[28:29], v[64:65], v[32:33] neg_lo:[0,1] neg_hi:[0,1]
v_pk_add_f32 v[64:65], v[64:65], v[32:33]
v_pk_add_f32 v[32:33], v[34:35], v[42:43] neg_lo:[0,1] neg_hi:[0,1]
v_pk_add_f32 v[34:35], v[34:35], v[42:43]
v_pk_mul_f32 v[42:43], v[32:33], s[62:63] op_sel:[0,0] op_sel_hi:[0,1] neg_lo:[0,0] neg_hi:[0,1]
v_pk_fma_f32 v[42:43], v[32:33], s[62:63], v[42:43] op_sel:[1,1,0] op_sel_hi:[1,0,1] neg_lo:[0,0,0] neg_hi:[0,0,0]
v_pk_add_f32 v[32:33], v[36:37], v[44:45] op_sel:[1,1] op_sel_hi:[0,0] neg_lo:[0,1] neg_hi:[1,0]
v_pk_add_f32 v[36:37], v[36:37], v[44:45]
v_pk_add_f32 v[44:45], v[38:39], v[46:47] neg_lo:[0,1] neg_hi:[0,1]
v_pk_add_f32 v[38:39], v[38:39], v[46:47]
v_pk_mul_f32 v[46:47], v[44:45], s[62:63] op_sel:[0,0] op_sel_hi:[0,1] neg_lo:[0,1] neg_hi:[0,1]
v_pk_fma_f32 v[46:47], v[44:45], s[62:63], v[46:47] op_sel:[1,1,0] op_sel_hi:[1,0,1] neg_lo:[0,0,0] neg_hi:[0,1,0]
v_pk_add_f32 v[44:45], v[14:15], v[56:57] neg_lo:[0,1] neg_hi:[0,1]
v_pk_add_f32 v[14:15], v[14:15], v[56:57]
v_pk_add_f32 v[56:57], v[50:51], v[58:59] neg_lo:[0,1] neg_hi:[0,1]
v_pk_add_f32 v[50:51], v[50:51], v[58:59]
v_pk_mul_f32 v[58:59], v[56:57], s[62:63] op_sel:[0,0] op_sel_hi:[0,1] neg_lo:[0,0] neg_hi:[0,1]
v_pk_fma_f32 v[58:59], v[56:57], s[62:63], v[58:59] op_sel:[1,1,0] op_sel_hi:[1,0,1] neg_lo:[0,0,0] neg_hi:[0,0,0]
v_pk_add_f32 v[56:57], v[52:53], v[60:61] op_sel:[1,1] op_sel_hi:[0,0] neg_lo:[0,1] neg_hi:[1,0]
v_pk_add_f32 v[52:53], v[52:53], v[60:61]
v_pk_add_f32 v[60:61], v[54:55], v[62:63] neg_lo:[0,1] neg_hi:[0,1]
v_pk_add_f32 v[54:55], v[54:55], v[62:63]
v_pk_mul_f32 v[62:63], v[60:61], s[62:63] op_sel:[0,0] op_sel_hi:[0,1] neg_lo:[0,1] neg_hi:[0,1]
v_pk_fma_f32 v[62:63], v[60:61], s[62:63], v[62:63] op_sel:[1,1,0] op_sel_hi:[1,0,1] neg_lo:[0,0,0] neg_hi:[0,1,0]
v_pk_add_f32 v[60:61], v[40:41], v[48:49] neg_lo:[0,1] neg_hi:[0,1]
v_pk_add_f32 v[40:41], v[40:41], v[48:49]
v_pk_add_f32 v[48:49], v[66:67], v[74:75] neg_lo:[0,1] neg_hi:[0,1]
v_pk_add_f32 v[66:67], v[66:67], v[74:75]
v_pk_mul_f32 v[74:75], v[48:49], s[62:63] op_sel:[0,0] op_sel_hi:[0,1] neg_lo:[0,0] neg_hi:[0,1]
v_pk_fma_f32 v[74:75], v[48:49], s[62:63], v[74:75] op_sel:[1,1,0] op_sel_hi:[1,0,1] neg_lo:[0,0,0] neg_hi:[0,0,0]
v_pk_add_f32 v[48:49], v[68:69], v[76:77] op_sel:[1,1] op_sel_hi:[0,0] neg_lo:[0,1] neg_hi:[1,0]
v_pk_add_f32 v[68:69], v[68:69], v[76:77]
v_pk_add_f32 v[76:77], v[70:71], v[78:79] neg_lo:[0,1] neg_hi:[0,1]
v_pk_add_f32 v[70:71], v[70:71], v[78:79]
v_pk_mul_f32 v[78:79], v[76:77], s[62:63] op_sel:[0,0] op_sel_hi:[0,1] neg_lo:[0,1] neg_hi:[0,1]
v_pk_fma_f32 v[78:79], v[76:77], s[62:63], v[78:79] op_sel:[1,1,0] op_sel_hi:[1,0,1] neg_lo:[0,0,0] neg_hi:[0,1,0]
v_pk_add_f32 v[76:77], v[16:17], v[20:21] neg_lo:[0,1] neg_hi:[0,1]
v_pk_add_f32 v[16:17], v[16:17], v[20:21]
v_pk_add_f32 v[20:21], v[18:19], v[22:23] op_sel:[1,1] op_sel_hi:[0,0] neg_lo:[0,1] neg_hi:[1,0]
v_pk_add_f32 v[18:19], v[18:19], v[22:23]
v_pk_add_f32 v[22:23], v[72:73], v[24:25] neg_lo:[0,1] neg_hi:[0,1]
v_pk_add_f32 v[72:73], v[72:73], v[24:25]
v_pk_add_f32 v[24:25], v[26:27], v[30:31] op_sel:[1,1] op_sel_hi:[0,0] neg_lo:[0,1] neg_hi:[1,0]
v_pk_add_f32 v[26:27], v[26:27], v[30:31]
v_pk_add_f32 v[30:31], v[64:65], v[36:37] neg_lo:[0,1] neg_hi:[0,1]
v_pk_add_f32 v[64:65], v[64:65], v[36:37]
v_pk_add_f32 v[36:37], v[34:35], v[38:39] op_sel:[1,1] op_sel_hi:[0,0] neg_lo:[0,1] neg_hi:[1,0]
v_pk_add_f32 v[34:35], v[34:35], v[38:39]
v_pk_add_f32 v[38:39], v[28:29], v[32:33] neg_lo:[0,1] neg_hi:[0,1]
v_pk_add_f32 v[28:29], v[28:29], v[32:33]
v_pk_add_f32 v[32:33], v[42:43], v[46:47] op_sel:[1,1] op_sel_hi:[0,0] neg_lo:[0,1] neg_hi:[1,0]
v_pk_add_f32 v[42:43], v[42:43], v[46:47]
v_pk_add_f32 v[46:47], v[14:15], v[52:53] neg_lo:[0,1] neg_hi:[0,1]
v_pk_add_f32 v[14:15], v[14:15], v[52:53]
v_pk_add_f32 v[52:53], v[50:51], v[54:55] op_sel:[1,1] op_sel_hi:[0,0] neg_lo:[0,1] neg_hi:[1,0]
v_pk_add_f32 v[50:51], v[50:51], v[54:55]
v_pk_add_f32 v[54:55], v[44:45], v[56:57] neg_lo:[0,1] neg_hi:[0,1]
v_pk_add_f32 v[44:45], v[44:45], v[56:57]
v_pk_add_f32 v[56:57], v[58:59], v[62:63] op_sel:[1,1] op_sel_hi:[0,0] neg_lo:[0,1] neg_hi:[1,0]
v_pk_add_f32 v[58:59], v[58:59], v[62:63]
v_pk_add_f32 v[62:63], v[40:41], v[68:69] neg_lo:[0,1] neg_hi:[0,1]
v_pk_add_f32 v[40:41], v[40:41], v[68:69]
v_pk_add_f32 v[68:69], v[66:67], v[70:71] op_sel:[1,1] op_sel_hi:[0,0] neg_lo:[0,1] neg_hi:[1,0]
v_pk_add_f32 v[66:67], v[66:67], v[70:71]
v_pk_add_f32 v[70:71], v[60:61], v[48:49] neg_lo:[0,1] neg_hi:[0,1]
v_pk_add_f32 v[60:61], v[60:61], v[48:49]
v_pk_add_f32 v[48:49], v[74:75], v[78:79] op_sel:[1,1] op_sel_hi:[0,0] neg_lo:[0,1] neg_hi:[1,0]
v_pk_add_f32 v[74:75], v[74:75], v[78:79]
v_pk_add_f32 v[78:79], v[16:17], v[18:19] neg_lo:[0,1] neg_hi:[0,1]
v_pk_add_f32 v[16:17], v[16:17], v[18:19]
v_pk_add_f32 v[18:19], v[76:77], v[20:21] neg_lo:[0,1] neg_hi:[0,1]
v_pk_add_f32 v[76:77], v[76:77], v[20:21]
v_pk_add_f32 v[20:21], v[72:73], v[26:27] neg_lo:[0,1] neg_hi:[0,1]
v_pk_add_f32 v[72:73], v[72:73], v[26:27]
v_pk_add_f32 v[26:27], v[22:23], v[24:25] neg_lo:[0,1] neg_hi:[0,1]
v_pk_add_f32 v[22:23], v[22:23], v[24:25]
v_pk_add_f32 v[24:25], v[64:65], v[34:35] neg_lo:[0,1] neg_hi:[0,1]
v_pk_add_f32 v[64:65], v[64:65], v[34:35]
v_pk_add_f32 v[34:35], v[30:31], v[36:37] neg_lo:[0,1] neg_hi:[0,1]
v_pk_add_f32 v[30:31], v[30:31], v[36:37]
v_pk_add_f32 v[36:37], v[28:29], v[42:43] neg_lo:[0,1] neg_hi:[0,1]
v_pk_add_f32 v[28:29], v[28:29], v[42:43]
v_pk_add_f32 v[42:43], v[38:39], v[32:33] neg_lo:[0,1] neg_hi:[0,1]
v_pk_add_f32 v[38:39], v[38:39], v[32:33]
v_pk_add_f32 v[32:33], v[14:15], v[50:51] neg_lo:[0,1] neg_hi:[0,1]
v_pk_add_f32 v[14:15], v[14:15], v[50:51]
v_pk_add_f32 v[50:51], v[46:47], v[52:53] neg_lo:[0,1] neg_hi:[0,1]
v_pk_add_f32 v[46:47], v[46:47], v[52:53]
v_pk_add_f32 v[52:53], v[44:45], v[58:59] neg_lo:[0,1] neg_hi:[0,1]
v_pk_add_f32 v[44:45], v[44:45], v[58:59]
v_pk_add_f32 v[58:59], v[54:55], v[56:57] neg_lo:[0,1] neg_hi:[0,1]
v_pk_add_f32 v[54:55], v[54:55], v[56:57]
v_pk_add_f32 v[56:57], v[40:41], v[66:67] neg_lo:[0,1] neg_hi:[0,1]
v_pk_add_f32 v[40:41], v[40:41], v[66:67]
v_pk_add_f32 v[66:67], v[62:63], v[68:69] neg_lo:[0,1] neg_hi:[0,1]
v_pk_add_f32 v[62:63], v[62:63], v[68:69]
v_pk_add_f32 v[68:69], v[60:61], v[74:75] neg_lo:[0,1] neg_hi:[0,1]
v_pk_add_f32 v[60:61], v[60:61], v[74:75]
v_pk_add_f32 v[74:75], v[70:71], v[48:49] neg_lo:[0,1] neg_hi:[0,1]
v_pk_add_f32 v[70:71], v[70:71], v[48:49]
s_mov_b64 exec, s[18:19]
v_pk_add_f32 v[16:17], v[16:17], 0 neg_lo:[1,0] neg_hi:[1,0]
v_pk_mul_f32 v[48:49], v[14:15], s[48:49] op_sel:[0,0] op_sel_hi:[0,1] neg_lo:[0,1] neg_hi:[0,0]
v_pk_fma_f32 v[14:15], v[14:15], s[48:49], v[48:49] op_sel:[1,1,0] op_sel_hi:[1,0,1] neg_lo:[0,1,0] neg_hi:[0,1,0]
v_pk_mul_f32 v[48:49], v[64:65], s[50:51] op_sel:[0,0] op_sel_hi:[0,1] neg_lo:[0,1] neg_hi:[0,0]
v_pk_fma_f32 v[64:65], v[64:65], s[50:51], v[48:49] op_sel:[1,1,0] op_sel_hi:[1,0,1] neg_lo:[0,1,0] neg_hi:[0,1,0]
v_pk_mul_f32 v[48:49], v[40:41], s[52:53] op_sel:[0,0] op_sel_hi:[0,1] neg_lo:[0,1] neg_hi:[0,0]
v_pk_fma_f32 v[40:41], v[40:41], s[52:53], v[48:49] op_sel:[1,1,0] op_sel_hi:[1,0,1] neg_lo:[0,1,0] neg_hi:[0,1,0]
v_pk_mul_f32 v[48:49], v[72:73], s[54:55] op_sel:[0,0] op_sel_hi:[0,1] neg_lo:[0,1] neg_hi:[0,0]
v_pk_fma_f32 v[72:73], v[72:73], s[54:55], v[48:49] op_sel:[1,1,0] op_sel_hi:[1,0,1] neg_lo:[0,1,0] neg_hi:[0,1,0]
v_pk_mul_f32 v[48:49], v[44:45], s[56:57] op_sel:[0,0] op_sel_hi:[0,1] neg_lo:[0,1] neg_hi:[0,0]
v_pk_fma_f32 v[44:45], v[44:45], s[56:57], v[48:49] op_sel:[1,1,0] op_sel_hi:[1,0,1] neg_lo:[0,1,0] neg_hi:[0,1,0]
v_pk_mul_f32 v[48:49], v[28:29], s[58:59] op_sel:[0,0] op_sel_hi:[0,1] neg_lo:[0,1] neg_hi:[0,0]
v_pk_fma_f32 v[28:29], v[28:29], s[58:59], v[48:49] op_sel:[1,1,0] op_sel_hi:[1,0,1] neg_lo:[0,1,0] neg_hi:[0,1,0]
v_pk_mul_f32 v[48:49], v[60:61], s[60:61] op_sel:[0,0] op_sel_hi:[0,1] neg_lo:[0,1] neg_hi:[0,0]
v_pk_fma_f32 v[60:61], v[60:61], s[60:61], v[48:49] op_sel:[1,1,0] op_sel_hi:[1,0,1] neg_lo:[0,1,0] neg_hi:[0,1,0]
v_pk_mul_f32 v[48:49], v[76:77], s[62:63] op_sel:[0,0] op_sel_hi:[0,1] neg_lo:[0,1] neg_hi:[0,0]
v_pk_fma_f32 v[76:77], v[76:77], s[62:63], v[48:49] op_sel:[1,1,0] op_sel_hi:[1,0,1] neg_lo:[0,1,0] neg_hi:[0,1,0]
v_pk_mul_f32 v[48:49], v[46:47], s[60:61] op_sel:[0,1] op_sel_hi:[0,0] neg_lo:[0,1] neg_hi:[0,0]
v_pk_fma_f32 v[46:47], v[46:47], s[60:61], v[48:49] op_sel:[1,0,0] op_sel_hi:[1,1,1] neg_lo:[0,1,0] neg_hi:[0,1,0]
v_pk_mul_f32 v[48:49], v[30:31], s[58:59] op_sel:[0,1] op_sel_hi:[0,0] neg_lo:[0,1] neg_hi:[0,0]
v_pk_fma_f32 v[30:31], v[30:31], s[58:59], v[48:49] op_sel:[1,0,0] op_sel_hi:[1,1,1] neg_lo:[0,1,0] neg_hi:[0,1,0]
v_pk_mul_f32 v[48:49], v[62:63], s[56:57] op_sel:[0,1] op_sel_hi:[0,0] neg_lo:[0,1] neg_hi:[0,0]
v_pk_fma_f32 v[62:63], v[62:63], s[56:57], v[48:49] op_sel:[1,0,0] op_sel_hi:[1,1,1] neg_lo:[0,1,0] neg_hi:[0,1,0]
v_pk_mul_f32 v[48:49], v[22:23], s[54:55] op_sel:[0,1] op_sel_hi:[0,0] neg_lo:[0,1] neg_hi:[0,0]
v_pk_fma_f32 v[22:23], v[22:23], s[54:55], v[48:49] op_sel:[1,0,0] op_sel_hi:[1,1,1] neg_lo:[0,1,0] neg_hi:[0,1,0]
v_pk_mul_f32 v[48:49], v[54:55], s[52:53] op_sel:[0,1] op_sel_hi:[0,0] neg_lo:[0,1] neg_hi:[0,0]
v_pk_fma_f32 v[54:55], v[54:55], s[52:53], v[48:49] op_sel:[1,0,0] op_sel_hi:[1,1,1] neg_lo:[0,1,0] neg_hi:[0,1,0]
v_pk_mul_f32 v[48:49], v[38:39], s[50:51] op_sel:[0,1] op_sel_hi:[0,0] neg_lo:[0,1] neg_hi:[0,0]
v_pk_fma_f32 v[38:39], v[38:39], s[50:51], v[48:49] op_sel:[1,0,0] op_sel_hi:[1,1,1] neg_lo:[0,1,0] neg_hi:[0,1,0]
v_pk_mul_f32 v[48:49], v[70:71], s[48:49] op_sel:[0,1] op_sel_hi:[0,0] neg_lo:[0,1] neg_hi:[0,0]
v_pk_fma_f32 v[70:71], v[70:71], s[48:49], v[48:49] op_sel:[1,0,0] op_sel_hi:[1,1,1] neg_lo:[0,1,0] neg_hi:[0,1,0]
v_pk_add_f32 v[78:79], v[78:79], 0 op_sel:[1,0] op_sel_hi:[0,0] neg_lo:[1,0] neg_hi:[0,0]
v_pk_mul_f32 v[48:49], v[32:33], s[48:49] op_sel:[0,1] op_sel_hi:[0,0] neg_lo:[0,0] neg_hi:[0,0]
v_pk_fma_f32 v[32:33], v[32:33], s[48:49], v[48:49] op_sel:[1,0,0] op_sel_hi:[1,1,1] neg_lo:[0,1,0] neg_hi:[0,0,0]
v_pk_mul_f32 v[48:49], v[24:25], s[50:51] op_sel:[0,1] op_sel_hi:[0,0] neg_lo:[0,0] neg_hi:[0,0]
v_pk_fma_f32 v[24:25], v[24:25], s[50:51], v[48:49] op_sel:[1,0,0] op_sel_hi:[1,1,1] neg_lo:[0,1,0] neg_hi:[0,0,0]
v_pk_mul_f32 v[48:49], v[56:57], s[52:53] op_sel:[0,1] op_sel_hi:[0,0] neg_lo:[0,0] neg_hi:[0,0]
v_pk_fma_f32 v[56:57], v[56:57], s[52:53], v[48:49] op_sel:[1,0,0] op_sel_hi:[1,1,1] neg_lo:[0,1,0] neg_hi:[0,0,0]
v_pk_mul_f32 v[48:49], v[20:21], s[54:55] op_sel:[0,1] op_sel_hi:[0,0] neg_lo:[0,0] neg_hi:[0,0]
v_pk_fma_f32 v[20:21], v[20:21], s[54:55], v[48:49] op_sel:[1,0,0] op_sel_hi:[1,1,1] neg_lo:[0,1,0] neg_hi:[0,0,0]
v_pk_mul_f32 v[48:49], v[52:53], s[56:57] op_sel:[0,1] op_sel_hi:[0,0] neg_lo:[0,0] neg_hi:[0,0]
v_pk_fma_f32 v[52:53], v[52:53], s[56:57], v[48:49] op_sel:[1,0,0] op_sel_hi:[1,1,1] neg_lo:[0,1,0] neg_hi:[0,0,0]
v_pk_mul_f32 v[48:49], v[36:37], s[58:59] op_sel:[0,1] op_sel_hi:[0,0] neg_lo:[0,0] neg_hi:[0,0]
v_pk_fma_f32 v[36:37], v[36:37], s[58:59], v[48:49] op_sel:[1,0,0] op_sel_hi:[1,1,1] neg_lo:[0,1,0] neg_hi:[0,0,0]
v_pk_mul_f32 v[48:49], v[68:69], s[60:61] op_sel:[0,1] op_sel_hi:[0,0] neg_lo:[0,0] neg_hi:[0,0]
v_pk_fma_f32 v[68:69], v[68:69], s[60:61], v[48:49] op_sel:[1,0,0] op_sel_hi:[1,1,1] neg_lo:[0,1,0] neg_hi:[0,0,0]
v_pk_mul_f32 v[48:49], v[18:19], s[62:63] op_sel:[0,0] op_sel_hi:[0,1] neg_lo:[0,0] neg_hi:[0,0]
v_pk_fma_f32 v[18:19], v[18:19], s[62:63], v[48:49] op_sel:[1,1,0] op_sel_hi:[1,0,1] neg_lo:[0,1,0] neg_hi:[0,0,0]
v_pk_mul_f32 v[48:49], v[50:51], s[60:61] op_sel:[0,0] op_sel_hi:[0,1] neg_lo:[0,0] neg_hi:[0,0]
v_pk_fma_f32 v[50:51], v[50:51], s[60:61], v[48:49] op_sel:[1,1,0] op_sel_hi:[1,0,1] neg_lo:[0,1,0] neg_hi:[0,0,0]
v_pk_mul_f32 v[48:49], v[34:35], s[58:59] op_sel:[0,0] op_sel_hi:[0,1] neg_lo:[0,0] neg_hi:[0,0]
v_pk_fma_f32 v[34:35], v[34:35], s[58:59], v[48:49] op_sel:[1,1,0] op_sel_hi:[1,0,1] neg_lo:[0,1,0] neg_hi:[0,0,0]
v_pk_mul_f32 v[48:49], v[66:67], s[56:57] op_sel:[0,0] op_sel_hi:[0,1] neg_lo:[0,0] neg_hi:[0,0]
v_pk_fma_f32 v[66:67], v[66:67], s[56:57], v[48:49] op_sel:[1,1,0] op_sel_hi:[1,0,1] neg_lo:[0,1,0] neg_hi:[0,0,0]
v_pk_mul_f32 v[48:49], v[26:27], s[54:55] op_sel:[0,0] op_sel_hi:[0,1] neg_lo:[0,0] neg_hi:[0,0]
v_pk_fma_f32 v[26:27], v[26:27], s[54:55], v[48:49] op_sel:[1,1,0] op_sel_hi:[1,0,1] neg_lo:[0,1,0] neg_hi:[0,0,0]
v_pk_mul_f32 v[48:49], v[58:59], s[52:53] op_sel:[0,0] op_sel_hi:[0,1] neg_lo:[0,0] neg_hi:[0,0]
v_pk_fma_f32 v[58:59], v[58:59], s[52:53], v[48:49] op_sel:[1,1,0] op_sel_hi:[1,0,1] neg_lo:[0,1,0] neg_hi:[0,0,0]
v_pk_mul_f32 v[48:49], v[42:43], s[50:51] op_sel:[0,0] op_sel_hi:[0,1] neg_lo:[0,0] neg_hi:[0,0]
v_pk_fma_f32 v[42:43], v[42:43], s[50:51], v[48:49] op_sel:[1,1,0] op_sel_hi:[1,0,1] neg_lo:[0,1,0] neg_hi:[0,0,0]
v_pk_mul_f32 v[48:49], v[74:75], s[48:49] op_sel:[0,0] op_sel_hi:[0,1] neg_lo:[0,0] neg_hi:[0,0]
v_pk_fma_f32 v[74:75], v[74:75], s[48:49], v[48:49] op_sel:[1,1,0] op_sel_hi:[1,0,1] neg_lo:[0,1,0] neg_hi:[0,0,0]
s_mov_b64 exec, -1
v_fmac_f32_dpp v16, v16, v9 quad_perm:[1,0,3,2] row_mask:0xf bank_mask:0xf
v_fmac_f32_dpp v17, v17, v9 quad_perm:[1,0,3,2] row_mask:0xf bank_mask:0xf
v_fmac_f32_dpp v14, v14, v9 quad_perm:[1,0,3,2] row_mask:0xf bank_mask:0xf
v_fmac_f32_dpp v15, v15, v9 quad_perm:[1,0,3,2] row_mask:0xf bank_mask:0xf
v_fmac_f32_dpp v64, v64, v9 quad_perm:[1,0,3,2] row_mask:0xf bank_mask:0xf
v_fmac_f32_dpp v65, v65, v9 quad_perm:[1,0,3,2] row_mask:0xf bank_mask:0xf
v_fmac_f32_dpp v40, v40, v9 quad_perm:[1,0,3,2] row_mask:0xf bank_mask:0xf
v_fmac_f32_dpp v41, v41, v9 quad_perm:[1,0,3,2] row_mask:0xf bank_mask:0xf
v_fmac_f32_dpp v72, v72, v9 quad_perm:[1,0,3,2] row_mask:0xf bank_mask:0xf
v_fmac_f32_dpp v73, v73, v9 quad_perm:[1,0,3,2] row_mask:0xf bank_mask:0xf
v_fmac_f32_dpp v44, v44, v9 quad_perm:[1,0,3,2] row_mask:0xf bank_mask:0xf
v_fmac_f32_dpp v45, v45, v9 quad_perm:[1,0,3,2] row_mask:0xf bank_mask:0xf
v_fmac_f32_dpp v28, v28, v9 quad_perm:[1,0,3,2] row_mask:0xf bank_mask:0xf
v_fmac_f32_dpp v29, v29, v9 quad_perm:[1,0,3,2] row_mask:0xf bank_mask:0xf
v_fmac_f32_dpp v60, v60, v9 quad_perm:[1,0,3,2] row_mask:0xf bank_mask:0xf
v_fmac_f32_dpp v61, v61, v9 quad_perm:[1,0,3,2] row_mask:0xf bank_mask:0xf
v_fmac_f32_dpp v76, v76, v9 quad_perm:[1,0,3,2] row_mask:0xf bank_mask:0xf
v_fmac_f32_dpp v77, v77, v9 quad_perm:[1,0,3,2] row_mask:0xf bank_mask:0xf
v_fmac_f32_dpp v46, v46, v9 quad_perm:[1,0,3,2] row_mask:0xf bank_mask:0xf
v_fmac_f32_dpp v47, v47, v9 quad_perm:[1,0,3,2] row_mask:0xf bank_mask:0xf
v_fmac_f32_dpp v30, v30, v9 quad_perm:[1,0,3,2] row_mask:0xf bank_mask:0xf
v_fmac_f32_dpp v31, v31, v9 quad_perm:[1,0,3,2] row_mask:0xf bank_mask:0xf
v_fmac_f32_dpp v62, v62, v9 quad_perm:[1,0,3,2] row_mask:0xf bank_mask:0xf
v_fmac_f32_dpp v63, v63, v9 quad_perm:[1,0,3,2] row_mask:0xf bank_mask:0xf
v_fmac_f32_dpp v22, v22, v9 quad_perm:[1,0,3,2] row_mask:0xf bank_mask:0xf
v_fmac_f32_dpp v23, v23, v9 quad_perm:[1,0,3,2] row_mask:0xf bank_mask:0xf
v_fmac_f32_dpp v54, v54, v9 quad_perm:[1,0,3,2] row_mask:0xf bank_mask:0xf
v_fmac_f32_dpp v55, v55, v9 quad_perm:[1,0,3,2] row_mask:0xf bank_mask:0xf
v_fmac_f32_dpp v38, v38, v9 quad_perm:[1,0,3,2] row_mask:0xf bank_mask:0xf
v_fmac_f32_dpp v39, v39, v9 quad_perm:[1,0,3,2] row_mask:0xf bank_mask:0xf
v_fmac_f32_dpp v70, v70, v9 quad_perm:[1,0,3,2] row_mask:0xf bank_mask:0xf
v_fmac_f32_dpp v71, v71, v9 quad_perm:[1,0,3,2] row_mask:0xf bank_mask:0xf
v_fmac_f32_dpp v78, v78, v9 quad_perm:[1,0,3,2] row_mask:0xf bank_mask:0xf
v_fmac_f32_dpp v79, v79, v9 quad_perm:[1,0,3,2] row_mask:0xf bank_mask:0xf
v_fmac_f32_dpp v32, v32, v9 quad_perm:[1,0,3,2] row_mask:0xf bank_mask:0xf
v_fmac_f32_dpp v33, v33, v9 quad_perm:[1,0,3,2] row_mask:0xf bank_mask:0xf
v_fmac_f32_dpp v24, v24, v9 quad_perm:[1,0,3,2] row_mask:0xf bank_mask:0xf
v_fmac_f32_dpp v25, v25, v9 quad_perm:[1,0,3,2] row_mask:0xf bank_mask:0xf
v_fmac_f32_dpp v56, v56, v9 quad_perm:[1,0,3,2] row_mask:0xf bank_mask:0xf
v_fmac_f32_dpp v57, v57, v9 quad_perm:[1,0,3,2] row_mask:0xf bank_mask:0xf
v_fmac_f32_dpp v20, v20, v9 quad_perm:[1,0,3,2] row_mask:0xf bank_mask:0xf
v_fmac_f32_dpp v21, v21, v9 quad_perm:[1,0,3,2] row_mask:0xf bank_mask:0xf
v_fmac_f32_dpp v52, v52, v9 quad_perm:[1,0,3,2] row_mask:0xf bank_mask:0xf
v_fmac_f32_dpp v53, v53, v9 quad_perm:[1,0,3,2] row_mask:0xf bank_mask:0xf
v_fmac_f32_dpp v36, v36, v9 quad_perm:[1,0,3,2] row_mask:0xf bank_mask:0xf
v_fmac_f32_dpp v37, v37, v9 quad_perm:[1,0,3,2] row_mask:0xf bank_mask:0xf
v_fmac_f32_dpp v68, v68, v9 quad_perm:[1,0,3,2] row_mask:0xf bank_mask:0xf
v_fmac_f32_dpp v69, v69, v9 quad_perm:[1,0,3,2] row_mask:0xf bank_mask:0xf
v_fmac_f32_dpp v18, v18, v9 quad_perm:[1,0,3,2] row_mask:0xf bank_mask:0xf
v_fmac_f32_dpp v19, v19, v9 quad_perm:[1,0,3,2] row_mask:0xf bank_mask:0xf
v_fmac_f32_dpp v50, v50, v9 quad_perm:[1,0,3,2] row_mask:0xf bank_mask:0xf
v_fmac_f32_dpp v51, v51, v9 quad_perm:[1,0,3,2] row_mask:0xf bank_mask:0xf
v_fmac_f32_dpp v34, v34, v9 quad_perm:[1,0,3,2] row_mask:0xf bank_mask:0xf
v_fmac_f32_dpp v35, v35, v9 quad_perm:[1,0,3,2] row_mask:0xf bank_mask:0xf
v_fmac_f32_dpp v66, v66, v9 quad_perm:[1,0,3,2] row_mask:0xf bank_mask:0xf
v_fmac_f32_dpp v67, v67, v9 quad_perm:[1,0,3,2] row_mask:0xf bank_mask:0xf
v_fmac_f32_dpp v26, v26, v9 quad_perm:[1,0,3,2] row_mask:0xf bank_mask:0xf
v_fmac_f32_dpp v27, v27, v9 quad_perm:[1,0,3,2] row_mask:0xf bank_mask:0xf
v_fmac_f32_dpp v58, v58, v9 quad_perm:[1,0,3,2] row_mask:0xf bank_mask:0xf
v_fmac_f32_dpp v59, v59, v9 quad_perm:[1,0,3,2] row_mask:0xf bank_mask:0xf
v_fmac_f32_dpp v42, v42, v9 quad_perm:[1,0,3,2] row_mask:0xf bank_mask:0xf
v_fmac_f32_dpp v43, v43, v9 quad_perm:[1,0,3,2] row_mask:0xf bank_mask:0xf
v_fmac_f32_dpp v74, v74, v9 quad_perm:[1,0,3,2] row_mask:0xf bank_mask:0xf
v_fmac_f32_dpp v75, v75, v9 quad_perm:[1,0,3,2] row_mask:0xf bank_mask:0xf
v_lshlrev_b32 v240, 16, v208
v_and_b32 v241, 0xffff0000, v208
v_pk_mul_f32 v[48:49], v[16:17], v[240:241] op_sel:[0,0] op_sel_hi:[0,1] neg_lo:[0,0] neg_hi:[0,0]
v_pk_fma_f32 v[16:17], v[16:17], v[240:241], v[48:49] op_sel:[1,1,0] op_sel_hi:[1,0,1] neg_lo:[0,1,0] neg_hi:[0,0,0]
v_lshlrev_b32 v240, 16, v209
v_and_b32 v241, 0xffff0000, v209
v_pk_mul_f32 v[48:49], v[14:15], v[240:241] op_sel:[0,0] op_sel_hi:[0,1] neg_lo:[0,0] neg_hi:[0,0]
v_pk_fma_f32 v[14:15], v[14:15], v[240:241], v[48:49] op_sel:[1,1,0] op_sel_hi:[1,0,1] neg_lo:[0,1,0] neg_hi:[0,0,0]
v_lshlrev_b32 v240, 16, v210
v_and_b32 v241, 0xffff0000, v210
v_pk_mul_f32 v[48:49], v[64:65], v[240:241] op_sel:[0,0] op_sel_hi:[0,1] neg_lo:[0,0] neg_hi:[0,0]
v_pk_fma_f32 v[64:65], v[64:65], v[240:241], v[48:49] op_sel:[1,1,0] op_sel_hi:[1,0,1] neg_lo:[0,1,0] neg_hi:[0,0,0]
v_lshlrev_b32 v240, 16, v211
v_and_b32 v241, 0xffff0000, v211
v_pk_mul_f32 v[48:49], v[40:41], v[240:241] op_sel:[0,0] op_sel_hi:[0,1] neg_lo:[0,0] neg_hi:[0,0]
v_pk_fma_f32 v[40:41], v[40:41], v[240:241], v[48:49] op_sel:[1,1,0] op_sel_hi:[1,0,1] neg_lo:[0,1,0] neg_hi:[0,0,0]
v_lshlrev_b32 v240, 16, v212
v_and_b32 v241, 0xffff0000, v212
v_pk_mul_f32 v[48:49], v[72:73], v[240:241] op_sel:[0,0] op_sel_hi:[0,1] neg_lo:[0,0] neg_hi:[0,0]
v_pk_fma_f32 v[72:73], v[72:73], v[240:241], v[48:49] op_sel:[1,1,0] op_sel_hi:[1,0,1] neg_lo:[0,1,0] neg_hi:[0,0,0]
v_lshlrev_b32 v240, 16, v213
v_and_b32 v241, 0xffff0000, v213
v_pk_mul_f32 v[48:49], v[44:45], v[240:241] op_sel:[0,0] op_sel_hi:[0,1] neg_lo:[0,0] neg_hi:[0,0]
v_pk_fma_f32 v[44:45], v[44:45], v[240:241], v[48:49] op_sel:[1,1,0] op_sel_hi:[1,0,1] neg_lo:[0,1,0] neg_hi:[0,0,0]
v_lshlrev_b32 v240, 16, v214
v_and_b32 v241, 0xffff0000, v214
v_pk_mul_f32 v[48:49], v[28:29], v[240:241] op_sel:[0,0] op_sel_hi:[0,1] neg_lo:[0,0] neg_hi:[0,0]
v_pk_fma_f32 v[28:29], v[28:29], v[240:241], v[48:49] op_sel:[1,1,0] op_sel_hi:[1,0,1] neg_lo:[0,1,0] neg_hi:[0,0,0]
v_lshlrev_b32 v240, 16, v215
v_and_b32 v241, 0xffff0000, v215
v_pk_mul_f32 v[48:49], v[60:61], v[240:241] op_sel:[0,0] op_sel_hi:[0,1] neg_lo:[0,0] neg_hi:[0,0]
v_pk_fma_f32 v[60:61], v[60:61], v[240:241], v[48:49] op_sel:[1,1,0] op_sel_hi:[1,0,1] neg_lo:[0,1,0] neg_hi:[0,0,0]
v_lshlrev_b32 v240, 16, v216
v_and_b32 v241, 0xffff0000, v216
v_pk_mul_f32 v[48:49], v[76:77], v[240:241] op_sel:[0,0] op_sel_hi:[0,1] neg_lo:[0,0] neg_hi:[0,0]
v_pk_fma_f32 v[76:77], v[76:77], v[240:241], v[48:49] op_sel:[1,1,0] op_sel_hi:[1,0,1] neg_lo:[0,1,0] neg_hi:[0,0,0]
v_lshlrev_b32 v240, 16, v217
v_and_b32 v241, 0xffff0000, v217
v_pk_mul_f32 v[48:49], v[46:47], v[240:241] op_sel:[0,0] op_sel_hi:[0,1] neg_lo:[0,0] neg_hi:[0,0]
v_pk_fma_f32 v[46:47], v[46:47], v[240:241], v[48:49] op_sel:[1,1,0] op_sel_hi:[1,0,1] neg_lo:[0,1,0] neg_hi:[0,0,0]
v_lshlrev_b32 v240, 16, v218
v_and_b32 v241, 0xffff0000, v218
v_pk_mul_f32 v[48:49], v[30:31], v[240:241] op_sel:[0,0] op_sel_hi:[0,1] neg_lo:[0,0] neg_hi:[0,0]
v_pk_fma_f32 v[30:31], v[30:31], v[240:241], v[48:49] op_sel:[1,1,0] op_sel_hi:[1,0,1] neg_lo:[0,1,0] neg_hi:[0,0,0]
v_lshlrev_b32 v240, 16, v219
v_and_b32 v241, 0xffff0000, v219
v_pk_mul_f32 v[48:49], v[62:63], v[240:241] op_sel:[0,0] op_sel_hi:[0,1] neg_lo:[0,0] neg_hi:[0,0]
v_pk_fma_f32 v[62:63], v[62:63], v[240:241], v[48:49] op_sel:[1,1,0] op_sel_hi:[1,0,1] neg_lo:[0,1,0] neg_hi:[0,0,0]
v_lshlrev_b32 v240, 16, v220
v_and_b32 v241, 0xffff0000, v220
v_pk_mul_f32 v[48:49], v[22:23], v[240:241] op_sel:[0,0] op_sel_hi:[0,1] neg_lo:[0,0] neg_hi:[0,0]
v_pk_fma_f32 v[22:23], v[22:23], v[240:241], v[48:49] op_sel:[1,1,0] op_sel_hi:[1,0,1] neg_lo:[0,1,0] neg_hi:[0,0,0]
v_lshlrev_b32 v240, 16, v221
v_and_b32 v241, 0xffff0000, v221
v_pk_mul_f32 v[48:49], v[54:55], v[240:241] op_sel:[0,0] op_sel_hi:[0,1] neg_lo:[0,0] neg_hi:[0,0]
v_pk_fma_f32 v[54:55], v[54:55], v[240:241], v[48:49] op_sel:[1,1,0] op_sel_hi:[1,0,1] neg_lo:[0,1,0] neg_hi:[0,0,0]
v_lshlrev_b32 v240, 16, v222
v_and_b32 v241, 0xffff0000, v222
v_pk_mul_f32 v[48:49], v[38:39], v[240:241] op_sel:[0,0] op_sel_hi:[0,1] neg_lo:[0,0] neg_hi:[0,0]
v_pk_fma_f32 v[38:39], v[38:39], v[240:241], v[48:49] op_sel:[1,1,0] op_sel_hi:[1,0,1] neg_lo:[0,1,0] neg_hi:[0,0,0]
v_lshlrev_b32 v240, 16, v223
v_and_b32 v241, 0xffff0000, v223
v_pk_mul_f32 v[48:49], v[70:71], v[240:241] op_sel:[0,0] op_sel_hi:[0,1] neg_lo:[0,0] neg_hi:[0,0]
v_pk_fma_f32 v[70:71], v[70:71], v[240:241], v[48:49] op_sel:[1,1,0] op_sel_hi:[1,0,1] neg_lo:[0,1,0] neg_hi:[0,0,0]
v_lshlrev_b32 v240, 16, v224
v_and_b32 v241, 0xffff0000, v224
v_pk_mul_f32 v[48:49], v[78:79], v[240:241] op_sel:[0,0] op_sel_hi:[0,1] neg_lo:[0,0] neg_hi:[0,0]
v_pk_fma_f32 v[78:79], v[78:79], v[240:241], v[48:49] op_sel:[1,1,0] op_sel_hi:[1,0,1] neg_lo:[0,1,0] neg_hi:[0,0,0]
v_lshlrev_b32 v240, 16, v225
v_and_b32 v241, 0xffff0000, v225
v_pk_mul_f32 v[48:49], v[32:33], v[240:241] op_sel:[0,0] op_sel_hi:[0,1] neg_lo:[0,0] neg_hi:[0,0]
v_pk_fma_f32 v[32:33], v[32:33], v[240:241], v[48:49] op_sel:[1,1,0] op_sel_hi:[1,0,1] neg_lo:[0,1,0] neg_hi:[0,0,0]
v_lshlrev_b32 v240, 16, v226
v_and_b32 v241, 0xffff0000, v226
v_pk_mul_f32 v[48:49], v[24:25], v[240:241] op_sel:[0,0] op_sel_hi:[0,1] neg_lo:[0,0] neg_hi:[0,0]
v_pk_fma_f32 v[24:25], v[24:25], v[240:241], v[48:49] op_sel:[1,1,0] op_sel_hi:[1,0,1] neg_lo:[0,1,0] neg_hi:[0,0,0]
v_lshlrev_b32 v240, 16, v227
v_and_b32 v241, 0xffff0000, v227
v_pk_mul_f32 v[48:49], v[56:57], v[240:241] op_sel:[0,0] op_sel_hi:[0,1] neg_lo:[0,0] neg_hi:[0,0]
v_pk_fma_f32 v[56:57], v[56:57], v[240:241], v[48:49] op_sel:[1,1,0] op_sel_hi:[1,0,1] neg_lo:[0,1,0] neg_hi:[0,0,0]
v_lshlrev_b32 v240, 16, v228
v_and_b32 v241, 0xffff0000, v228
v_pk_mul_f32 v[48:49], v[20:21], v[240:241] op_sel:[0,0] op_sel_hi:[0,1] neg_lo:[0,0] neg_hi:[0,0]
v_pk_fma_f32 v[20:21], v[20:21], v[240:241], v[48:49] op_sel:[1,1,0] op_sel_hi:[1,0,1] neg_lo:[0,1,0] neg_hi:[0,0,0]
v_lshlrev_b32 v240, 16, v229
v_and_b32 v241, 0xffff0000, v229
v_pk_mul_f32 v[48:49], v[52:53], v[240:241] op_sel:[0,0] op_sel_hi:[0,1] neg_lo:[0,0] neg_hi:[0,0]
v_pk_fma_f32 v[52:53], v[52:53], v[240:241], v[48:49] op_sel:[1,1,0] op_sel_hi:[1,0,1] neg_lo:[0,1,0] neg_hi:[0,0,0]
v_lshlrev_b32 v240, 16, v230
v_and_b32 v241, 0xffff0000, v230
v_pk_mul_f32 v[48:49], v[36:37], v[240:241] op_sel:[0,0] op_sel_hi:[0,1] neg_lo:[0,0] neg_hi:[0,0]
v_pk_fma_f32 v[36:37], v[36:37], v[240:241], v[48:49] op_sel:[1,1,0] op_sel_hi:[1,0,1] neg_lo:[0,1,0] neg_hi:[0,0,0]
v_lshlrev_b32 v240, 16, v231
v_and_b32 v241, 0xffff0000, v231
v_pk_mul_f32 v[48:49], v[68:69], v[240:241] op_sel:[0,0] op_sel_hi:[0,1] neg_lo:[0,0] neg_hi:[0,0]
v_pk_fma_f32 v[68:69], v[68:69], v[240:241], v[48:49] op_sel:[1,1,0] op_sel_hi:[1,0,1] neg_lo:[0,1,0] neg_hi:[0,0,0]
v_lshlrev_b32 v240, 16, v232
v_and_b32 v241, 0xffff0000, v232
v_pk_mul_f32 v[48:49], v[18:19], v[240:241] op_sel:[0,0] op_sel_hi:[0,1] neg_lo:[0,0] neg_hi:[0,0]
v_pk_fma_f32 v[18:19], v[18:19], v[240:241], v[48:49] op_sel:[1,1,0] op_sel_hi:[1,0,1] neg_lo:[0,1,0] neg_hi:[0,0,0]
v_lshlrev_b32 v240, 16, v233
v_and_b32 v241, 0xffff0000, v233
v_pk_mul_f32 v[48:49], v[50:51], v[240:241] op_sel:[0,0] op_sel_hi:[0,1] neg_lo:[0,0] neg_hi:[0,0]
v_pk_fma_f32 v[50:51], v[50:51], v[240:241], v[48:49] op_sel:[1,1,0] op_sel_hi:[1,0,1] neg_lo:[0,1,0] neg_hi:[0,0,0]
v_lshlrev_b32 v240, 16, v234
v_and_b32 v241, 0xffff0000, v234
v_pk_mul_f32 v[48:49], v[34:35], v[240:241] op_sel:[0,0] op_sel_hi:[0,1] neg_lo:[0,0] neg_hi:[0,0]
v_pk_fma_f32 v[34:35], v[34:35], v[240:241], v[48:49] op_sel:[1,1,0] op_sel_hi:[1,0,1] neg_lo:[0,1,0] neg_hi:[0,0,0]
v_lshlrev_b32 v240, 16, v235
v_and_b32 v241, 0xffff0000, v235
v_pk_mul_f32 v[48:49], v[66:67], v[240:241] op_sel:[0,0] op_sel_hi:[0,1] neg_lo:[0,0] neg_hi:[0,0]
v_pk_fma_f32 v[66:67], v[66:67], v[240:241], v[48:49] op_sel:[1,1,0] op_sel_hi:[1,0,1] neg_lo:[0,1,0] neg_hi:[0,0,0]
v_lshlrev_b32 v240, 16, v236
v_and_b32 v241, 0xffff0000, v236
v_pk_mul_f32 v[48:49], v[26:27], v[240:241] op_sel:[0,0] op_sel_hi:[0,1] neg_lo:[0,0] neg_hi:[0,0]
v_pk_fma_f32 v[26:27], v[26:27], v[240:241], v[48:49] op_sel:[1,1,0] op_sel_hi:[1,0,1] neg_lo:[0,1,0] neg_hi:[0,0,0]
v_lshlrev_b32 v240, 16, v237
v_and_b32 v241, 0xffff0000, v237
v_pk_mul_f32 v[48:49], v[58:59], v[240:241] op_sel:[0,0] op_sel_hi:[0,1] neg_lo:[0,0] neg_hi:[0,0]
v_pk_fma_f32 v[58:59], v[58:59], v[240:241], v[48:49] op_sel:[1,1,0] op_sel_hi:[1,0,1] neg_lo:[0,1,0] neg_hi:[0,0,0]
v_lshlrev_b32 v240, 16, v238
v_and_b32 v241, 0xffff0000, v238
v_pk_mul_f32 v[48:49], v[42:43], v[240:241] op_sel:[0,0] op_sel_hi:[0,1] neg_lo:[0,0] neg_hi:[0,0]
v_pk_fma_f32 v[42:43], v[42:43], v[240:241], v[48:49] op_sel:[1,1,0] op_sel_hi:[1,0,1] neg_lo:[0,1,0] neg_hi:[0,0,0]
v_lshlrev_b32 v240, 16, v239
v_and_b32 v241, 0xffff0000, v239
v_pk_mul_f32 v[48:49], v[74:75], v[240:241] op_sel:[0,0] op_sel_hi:[0,1] neg_lo:[0,0] neg_hi:[0,0]
v_pk_fma_f32 v[74:75], v[74:75], v[240:241], v[48:49] op_sel:[1,1,0] op_sel_hi:[1,0,1] neg_lo:[0,1,0] neg_hi:[0,0,0]
v_fmac_f32_dpp v16, v16, v7 quad_perm:[1,0,3,2] row_mask:0xf bank_mask:0xf
v_fmac_f32_dpp v17, v17, v7 quad_perm:[1,0,3,2] row_mask:0xf bank_mask:0xf
v_fmac_f32_dpp v14, v14, v7 quad_perm:[1,0,3,2] row_mask:0xf bank_mask:0xf
v_fmac_f32_dpp v15, v15, v7 quad_perm:[1,0,3,2] row_mask:0xf bank_mask:0xf
v_fmac_f32_dpp v64, v64, v7 quad_perm:[1,0,3,2] row_mask:0xf bank_mask:0xf
v_fmac_f32_dpp v65, v65, v7 quad_perm:[1,0,3,2] row_mask:0xf bank_mask:0xf
v_fmac_f32_dpp v40, v40, v7 quad_perm:[1,0,3,2] row_mask:0xf bank_mask:0xf
v_fmac_f32_dpp v41, v41, v7 quad_perm:[1,0,3,2] row_mask:0xf bank_mask:0xf
v_fmac_f32_dpp v72, v72, v7 quad_perm:[1,0,3,2] row_mask:0xf bank_mask:0xf
v_fmac_f32_dpp v73, v73, v7 quad_perm:[1,0,3,2] row_mask:0xf bank_mask:0xf
v_fmac_f32_dpp v44, v44, v7 quad_perm:[1,0,3,2] row_mask:0xf bank_mask:0xf
v_fmac_f32_dpp v45, v45, v7 quad_perm:[1,0,3,2] row_mask:0xf bank_mask:0xf
v_fmac_f32_dpp v28, v28, v7 quad_perm:[1,0,3,2] row_mask:0xf bank_mask:0xf
v_fmac_f32_dpp v29, v29, v7 quad_perm:[1,0,3,2] row_mask:0xf bank_mask:0xf
v_fmac_f32_dpp v60, v60, v7 quad_perm:[1,0,3,2] row_mask:0xf bank_mask:0xf
v_fmac_f32_dpp v61, v61, v7 quad_perm:[1,0,3,2] row_mask:0xf bank_mask:0xf
v_fmac_f32_dpp v76, v76, v7 quad_perm:[1,0,3,2] row_mask:0xf bank_mask:0xf
v_fmac_f32_dpp v77, v77, v7 quad_perm:[1,0,3,2] row_mask:0xf bank_mask:0xf
v_fmac_f32_dpp v46, v46, v7 quad_perm:[1,0,3,2] row_mask:0xf bank_mask:0xf
v_fmac_f32_dpp v47, v47, v7 quad_perm:[1,0,3,2] row_mask:0xf bank_mask:0xf
v_fmac_f32_dpp v30, v30, v7 quad_perm:[1,0,3,2] row_mask:0xf bank_mask:0xf
v_fmac_f32_dpp v31, v31, v7 quad_perm:[1,0,3,2] row_mask:0xf bank_mask:0xf
v_fmac_f32_dpp v62, v62, v7 quad_perm:[1,0,3,2] row_mask:0xf bank_mask:0xf
v_fmac_f32_dpp v63, v63, v7 quad_perm:[1,0,3,2] row_mask:0xf bank_mask:0xf
v_fmac_f32_dpp v22, v22, v7 quad_perm:[1,0,3,2] row_mask:0xf bank_mask:0xf
v_fmac_f32_dpp v23, v23, v7 quad_perm:[1,0,3,2] row_mask:0xf bank_mask:0xf
v_fmac_f32_dpp v54, v54, v7 quad_perm:[1,0,3,2] row_mask:0xf bank_mask:0xf
v_fmac_f32_dpp v55, v55, v7 quad_perm:[1,0,3,2] row_mask:0xf bank_mask:0xf
v_fmac_f32_dpp v38, v38, v7 quad_perm:[1,0,3,2] row_mask:0xf bank_mask:0xf
v_fmac_f32_dpp v39, v39, v7 quad_perm:[1,0,3,2] row_mask:0xf bank_mask:0xf
v_fmac_f32_dpp v70, v70, v7 quad_perm:[1,0,3,2] row_mask:0xf bank_mask:0xf
v_fmac_f32_dpp v71, v71, v7 quad_perm:[1,0,3,2] row_mask:0xf bank_mask:0xf
v_fmac_f32_dpp v78, v78, v7 quad_perm:[1,0,3,2] row_mask:0xf bank_mask:0xf
v_fmac_f32_dpp v79, v79, v7 quad_perm:[1,0,3,2] row_mask:0xf bank_mask:0xf
v_fmac_f32_dpp v32, v32, v7 quad_perm:[1,0,3,2] row_mask:0xf bank_mask:0xf
v_fmac_f32_dpp v33, v33, v7 quad_perm:[1,0,3,2] row_mask:0xf bank_mask:0xf
v_fmac_f32_dpp v24, v24, v7 quad_perm:[1,0,3,2] row_mask:0xf bank_mask:0xf
v_fmac_f32_dpp v25, v25, v7 quad_perm:[1,0,3,2] row_mask:0xf bank_mask:0xf
v_fmac_f32_dpp v56, v56, v7 quad_perm:[1,0,3,2] row_mask:0xf bank_mask:0xf
v_fmac_f32_dpp v57, v57, v7 quad_perm:[1,0,3,2] row_mask:0xf bank_mask:0xf
v_fmac_f32_dpp v20, v20, v7 quad_perm:[1,0,3,2] row_mask:0xf bank_mask:0xf
v_fmac_f32_dpp v21, v21, v7 quad_perm:[1,0,3,2] row_mask:0xf bank_mask:0xf
v_fmac_f32_dpp v52, v52, v7 quad_perm:[1,0,3,2] row_mask:0xf bank_mask:0xf
v_fmac_f32_dpp v53, v53, v7 quad_perm:[1,0,3,2] row_mask:0xf bank_mask:0xf
v_fmac_f32_dpp v36, v36, v7 quad_perm:[1,0,3,2] row_mask:0xf bank_mask:0xf
v_fmac_f32_dpp v37, v37, v7 quad_perm:[1,0,3,2] row_mask:0xf bank_mask:0xf
v_fmac_f32_dpp v68, v68, v7 quad_perm:[1,0,3,2] row_mask:0xf bank_mask:0xf
v_fmac_f32_dpp v69, v69, v7 quad_perm:[1,0,3,2] row_mask:0xf bank_mask:0xf
v_fmac_f32_dpp v18, v18, v7 quad_perm:[1,0,3,2] row_mask:0xf bank_mask:0xf
v_fmac_f32_dpp v19, v19, v7 quad_perm:[1,0,3,2] row_mask:0xf bank_mask:0xf
v_fmac_f32_dpp v50, v50, v7 quad_perm:[1,0,3,2] row_mask:0xf bank_mask:0xf
v_fmac_f32_dpp v51, v51, v7 quad_perm:[1,0,3,2] row_mask:0xf bank_mask:0xf
v_fmac_f32_dpp v34, v34, v7 quad_perm:[1,0,3,2] row_mask:0xf bank_mask:0xf
v_fmac_f32_dpp v35, v35, v7 quad_perm:[1,0,3,2] row_mask:0xf bank_mask:0xf
v_fmac_f32_dpp v66, v66, v7 quad_perm:[1,0,3,2] row_mask:0xf bank_mask:0xf
v_fmac_f32_dpp v67, v67, v7 quad_perm:[1,0,3,2] row_mask:0xf bank_mask:0xf
v_fmac_f32_dpp v26, v26, v7 quad_perm:[1,0,3,2] row_mask:0xf bank_mask:0xf
v_fmac_f32_dpp v27, v27, v7 quad_perm:[1,0,3,2] row_mask:0xf bank_mask:0xf
v_fmac_f32_dpp v58, v58, v7 quad_perm:[1,0,3,2] row_mask:0xf bank_mask:0xf
v_fmac_f32_dpp v59, v59, v7 quad_perm:[1,0,3,2] row_mask:0xf bank_mask:0xf
v_fmac_f32_dpp v42, v42, v7 quad_perm:[1,0,3,2] row_mask:0xf bank_mask:0xf
v_fmac_f32_dpp v43, v43, v7 quad_perm:[1,0,3,2] row_mask:0xf bank_mask:0xf
v_fmac_f32_dpp v74, v74, v7 quad_perm:[1,0,3,2] row_mask:0xf bank_mask:0xf
v_fmac_f32_dpp v75, v75, v7 quad_perm:[1,0,3,2] row_mask:0xf bank_mask:0xf
s_mov_b64 exec, s[18:19]
v_pk_add_f32 v[16:17], v[16:17], 0 neg_lo:[1,0] neg_hi:[1,0]
v_pk_mul_f32 v[48:49], v[14:15], s[48:49] op_sel:[0,0] op_sel_hi:[0,1] neg_lo:[0,1] neg_hi:[0,1]
v_pk_fma_f32 v[14:15], v[14:15], s[48:49], v[48:49] op_sel:[1,1,0] op_sel_hi:[1,0,1] neg_lo:[0,0,0] neg_hi:[0,1,0]
v_pk_mul_f32 v[48:49], v[64:65], s[50:51] op_sel:[0,0] op_sel_hi:[0,1] neg_lo:[0,1] neg_hi:[0,1]
v_pk_fma_f32 v[64:65], v[64:65], s[50:51], v[48:49] op_sel:[1,1,0] op_sel_hi:[1,0,1] neg_lo:[0,0,0] neg_hi:[0,1,0]
v_pk_mul_f32 v[48:49], v[40:41], s[52:53] op_sel:[0,0] op_sel_hi:[0,1] neg_lo:[0,1] neg_hi:[0,1]
v_pk_fma_f32 v[40:41], v[40:41], s[52:53], v[48:49] op_sel:[1,1,0] op_sel_hi:[1,0,1] neg_lo:[0,0,0] neg_hi:[0,1,0]
v_pk_mul_f32 v[48:49], v[72:73], s[54:55] op_sel:[0,0] op_sel_hi:[0,1] neg_lo:[0,1] neg_hi:[0,1]
v_pk_fma_f32 v[72:73], v[72:73], s[54:55], v[48:49] op_sel:[1,1,0] op_sel_hi:[1,0,1] neg_lo:[0,0,0] neg_hi:[0,1,0]
v_pk_mul_f32 v[48:49], v[44:45], s[56:57] op_sel:[0,0] op_sel_hi:[0,1] neg_lo:[0,1] neg_hi:[0,1]
v_pk_fma_f32 v[44:45], v[44:45], s[56:57], v[48:49] op_sel:[1,1,0] op_sel_hi:[1,0,1] neg_lo:[0,0,0] neg_hi:[0,1,0]
v_pk_mul_f32 v[48:49], v[28:29], s[58:59] op_sel:[0,0] op_sel_hi:[0,1] neg_lo:[0,1] neg_hi:[0,1]
v_pk_fma_f32 v[28:29], v[28:29], s[58:59], v[48:49] op_sel:[1,1,0] op_sel_hi:[1,0,1] neg_lo:[0,0,0] neg_hi:[0,1,0]
v_pk_mul_f32 v[48:49], v[60:61], s[60:61] op_sel:[0,0] op_sel_hi:[0,1] neg_lo:[0,1] neg_hi:[0,1]
v_pk_fma_f32 v[60:61], v[60:61], s[60:61], v[48:49] op_sel:[1,1,0] op_sel_hi:[1,0,1] neg_lo:[0,0,0] neg_hi:[0,1,0]
v_pk_mul_f32 v[48:49], v[76:77], s[62:63] op_sel:[0,0] op_sel_hi:[0,1] neg_lo:[0,1] neg_hi:[0,1]
v_pk_fma_f32 v[76:77], v[76:77], s[62:63], v[48:49] op_sel:[1,1,0] op_sel_hi:[1,0,1] neg_lo:[0,0,0] neg_hi:[0,1,0]
v_pk_mul_f32 v[48:49], v[46:47], s[60:61] op_sel:[0,1] op_sel_hi:[0,0] neg_lo:[0,1] neg_hi:[0,1]
v_pk_fma_f32 v[46:47], v[46:47], s[60:61], v[48:49] op_sel:[1,0,0] op_sel_hi:[1,1,1] neg_lo:[0,0,0] neg_hi:[0,1,0]
v_pk_mul_f32 v[48:49], v[30:31], s[58:59] op_sel:[0,1] op_sel_hi:[0,0] neg_lo:[0,1] neg_hi:[0,1]
v_pk_fma_f32 v[30:31], v[30:31], s[58:59], v[48:49] op_sel:[1,0,0] op_sel_hi:[1,1,1] neg_lo:[0,0,0] neg_hi:[0,1,0]
v_pk_mul_f32 v[48:49], v[62:63], s[56:57] op_sel:[0,1] op_sel_hi:[0,0] neg_lo:[0,1] neg_hi:[0,1]
v_pk_fma_f32 v[62:63], v[62:63], s[56:57], v[48:49] op_sel:[1,0,0] op_sel_hi:[1,1,1] neg_lo:[0,0,0] neg_hi:[0,1,0]
v_pk_mul_f32 v[48:49], v[22:23], s[54:55] op_sel:[0,1] op_sel_hi:[0,0] neg_lo:[0,1] neg_hi:[0,1]
v_pk_fma_f32 v[22:23], v[22:23], s[54:55], v[48:49] op_sel:[1,0,0] op_sel_hi:[1,1,1] neg_lo:[0,0,0] neg_hi:[0,1,0]
v_pk_mul_f32 v[48:49], v[54:55], s[52:53] op_sel:[0,1] op_sel_hi:[0,0] neg_lo:[0,1] neg_hi:[0,1]
v_pk_fma_f32 v[54:55], v[54:55], s[52:53], v[48:49] op_sel:[1,0,0] op_sel_hi:[1,1,1] neg_lo:[0,0,0] neg_hi:[0,1,0]
v_pk_mul_f32 v[48:49], v[38:39], s[50:51] op_sel:[0,1] op_sel_hi:[0,0] neg_lo:[0,1] neg_hi:[0,1]
v_pk_fma_f32 v[38:39], v[38:39], s[50:51], v[48:49] op_sel:[1,0,0] op_sel_hi:[1,1,1] neg_lo:[0,0,0] neg_hi:[0,1,0]
v_pk_mul_f32 v[48:49], v[70:71], s[48:49] op_sel:[0,1] op_sel_hi:[0,0] neg_lo:[0,1] neg_hi:[0,1]
v_pk_fma_f32 v[70:71], v[70:71], s[48:49], v[48:49] op_sel:[1,0,0] op_sel_hi:[1,1,1] neg_lo:[0,0,0] neg_hi:[0,1,0]
v_pk_add_f32 v[78:79], v[78:79], 0 op_sel:[1,0] op_sel_hi:[0,0] neg_lo:[0,0] neg_hi:[1,0]
v_pk_mul_f32 v[48:49], v[32:33], s[48:49] op_sel:[0,1] op_sel_hi:[0,0] neg_lo:[0,0] neg_hi:[0,1]
v_pk_fma_f32 v[32:33], v[32:33], s[48:49], v[48:49] op_sel:[1,0,0] op_sel_hi:[1,1,1] neg_lo:[0,0,0] neg_hi:[0,0,0]
v_pk_mul_f32 v[48:49], v[24:25], s[50:51] op_sel:[0,1] op_sel_hi:[0,0] neg_lo:[0,0] neg_hi:[0,1]
v_pk_fma_f32 v[24:25], v[24:25], s[50:51], v[48:49] op_sel:[1,0,0] op_sel_hi:[1,1,1] neg_lo:[0,0,0] neg_hi:[0,0,0]
v_pk_mul_f32 v[48:49], v[56:57], s[52:53] op_sel:[0,1] op_sel_hi:[0,0] neg_lo:[0,0] neg_hi:[0,1]
v_pk_fma_f32 v[56:57], v[56:57], s[52:53], v[48:49] op_sel:[1,0,0] op_sel_hi:[1,1,1] neg_lo:[0,0,0] neg_hi:[0,0,0]
v_pk_mul_f32 v[48:49], v[20:21], s[54:55] op_sel:[0,1] op_sel_hi:[0,0] neg_lo:[0,0] neg_hi:[0,1]
v_pk_fma_f32 v[20:21], v[20:21], s[54:55], v[48:49] op_sel:[1,0,0] op_sel_hi:[1,1,1] neg_lo:[0,0,0] neg_hi:[0,0,0]
v_pk_mul_f32 v[48:49], v[52:53], s[56:57] op_sel:[0,1] op_sel_hi:[0,0] neg_lo:[0,0] neg_hi:[0,1]
v_pk_fma_f32 v[52:53], v[52:53], s[56:57], v[48:49] op_sel:[1,0,0] op_sel_hi:[1,1,1] neg_lo:[0,0,0] neg_hi:[0,0,0]
v_pk_mul_f32 v[48:49], v[36:37], s[58:59] op_sel:[0,1] op_sel_hi:[0,0] neg_lo:[0,0] neg_hi:[0,1]
v_pk_fma_f32 v[36:37], v[36:37], s[58:59], v[48:49] op_sel:[1,0,0] op_sel_hi:[1,1,1] neg_lo:[0,0,0] neg_hi:[0,0,0]
v_pk_mul_f32 v[48:49], v[68:69], s[60:61] op_sel:[0,1] op_sel_hi:[0,0] neg_lo:[0,0] neg_hi:[0,1]
v_pk_fma_f32 v[68:69], v[68:69], s[60:61], v[48:49] op_sel:[1,0,0] op_sel_hi:[1,1,1] neg_lo:[0,0,0] neg_hi:[0,0,0]
v_pk_mul_f32 v[48:49], v[18:19], s[62:63] op_sel:[0,0] op_sel_hi:[0,1] neg_lo:[0,0] neg_hi:[0,1]
v_pk_fma_f32 v[18:19], v[18:19], s[62:63], v[48:49] op_sel:[1,1,0] op_sel_hi:[1,0,1] neg_lo:[0,0,0] neg_hi:[0,0,0]
v_pk_mul_f32 v[48:49], v[50:51], s[60:61] op_sel:[0,0] op_sel_hi:[0,1] neg_lo:[0,0] neg_hi:[0,1]
v_pk_fma_f32 v[50:51], v[50:51], s[60:61], v[48:49] op_sel:[1,1,0] op_sel_hi:[1,0,1] neg_lo:[0,0,0] neg_hi:[0,0,0]
v_pk_mul_f32 v[48:49], v[34:35], s[58:59] op_sel:[0,0] op_sel_hi:[0,1] neg_lo:[0,0] neg_hi:[0,1]
v_pk_fma_f32 v[34:35], v[34:35], s[58:59], v[48:49] op_sel:[1,1,0] op_sel_hi:[1,0,1] neg_lo:[0,0,0] neg_hi:[0,0,0]
v_pk_mul_f32 v[48:49], v[66:67], s[56:57] op_sel:[0,0] op_sel_hi:[0,1] neg_lo:[0,0] neg_hi:[0,1]
v_pk_fma_f32 v[66:67], v[66:67], s[56:57], v[48:49] op_sel:[1,1,0] op_sel_hi:[1,0,1] neg_lo:[0,0,0] neg_hi:[0,0,0]
v_pk_mul_f32 v[48:49], v[26:27], s[54:55] op_sel:[0,0] op_sel_hi:[0,1] neg_lo:[0,0] neg_hi:[0,1]
v_pk_fma_f32 v[26:27], v[26:27], s[54:55], v[48:49] op_sel:[1,1,0] op_sel_hi:[1,0,1] neg_lo:[0,0,0] neg_hi:[0,0,0]
v_pk_mul_f32 v[48:49], v[58:59], s[52:53] op_sel:[0,0] op_sel_hi:[0,1] neg_lo:[0,0] neg_hi:[0,1]
v_pk_fma_f32 v[58:59], v[58:59], s[52:53], v[48:49] op_sel:[1,1,0] op_sel_hi:[1,0,1] neg_lo:[0,0,0] neg_hi:[0,0,0]
v_pk_mul_f32 v[48:49], v[42:43], s[50:51] op_sel:[0,0] op_sel_hi:[0,1] neg_lo:[0,0] neg_hi:[0,1]
v_pk_fma_f32 v[42:43], v[42:43], s[50:51], v[48:49] op_sel:[1,1,0] op_sel_hi:[1,0,1] neg_lo:[0,0,0] neg_hi:[0,0,0]
v_pk_mul_f32 v[48:49], v[74:75], s[48:49] op_sel:[0,0] op_sel_hi:[0,1] neg_lo:[0,0] neg_hi:[0,1]
v_pk_fma_f32 v[74:75], v[74:75], s[48:49], v[48:49] op_sel:[1,1,0] op_sel_hi:[1,0,1] neg_lo:[0,0,0] neg_hi:[0,0,0]
s_mov_b64 exec, -1
v_pk_add_f32 v[48:49], v[16:17], v[78:79] neg_lo:[0,1] neg_hi:[0,1]
v_pk_add_f32 v[16:17], v[16:17], v[78:79]
v_pk_add_f32 v[78:79], v[14:15], v[32:33] neg_lo:[0,1] neg_hi:[0,1]
v_pk_add_f32 v[14:15], v[14:15], v[32:33]
v_pk_mul_f32 v[32:33], v[78:79], s[50:51] op_sel:[0,0] op_sel_hi:[0,1] neg_lo:[0,0] neg_hi:[0,0]
v_pk_fma_f32 v[32:33], v[78:79], s[50:51], v[32:33] op_sel:[1,1,0] op_sel_hi:[1,0,1] neg_lo:[0,1,0] neg_hi:[0,0,0]
v_pk_add_f32 v[78:79], v[64:65], v[24:25] neg_lo:[0,1] neg_hi:[0,1]
v_pk_add_f32 v[64:65], v[64:65], v[24:25]
v_pk_mul_f32 v[24:25], v[78:79], s[54:55] op_sel:[0,0] op_sel_hi:[0,1] neg_lo:[0,0] neg_hi:[0,0]
v_pk_fma_f32 v[24:25], v[78:79], s[54:55], v[24:25] op_sel:[1,1,0] op_sel_hi:[1,0,1] neg_lo:[0,1,0] neg_hi:[0,0,0]
v_pk_add_f32 v[78:79], v[40:41], v[56:57] neg_lo:[0,1] neg_hi:[0,1]
v_pk_add_f32 v[40:41], v[40:41], v[56:57]
v_pk_mul_f32 v[56:57], v[78:79], s[58:59] op_sel:[0,0] op_sel_hi:[0,1] neg_lo:[0,0] neg_hi:[0,0]
v_pk_fma_f32 v[56:57], v[78:79], s[58:59], v[56:57] op_sel:[1,1,0] op_sel_hi:[1,0,1] neg_lo:[0,1,0] neg_hi:[0,0,0]
v_pk_add_f32 v[78:79], v[72:73], v[20:21] neg_lo:[0,1] neg_hi:[0,1]
v_pk_add_f32 v[72:73], v[72:73], v[20:21]
v_pk_mul_f32 v[20:21], v[78:79], s[62:63] op_sel:[0,0] op_sel_hi:[0,1] neg_lo:[0,0] neg_hi:[0,0]
v_pk_fma_f32 v[20:21], v[78:79], s[62:63], v[20:21] op_sel:[1,1,0] op_sel_hi:[1,0,1] neg_lo:[0,1,0] neg_hi:[0,0,0]
v_pk_add_f32 v[78:79], v[44:45], v[52:53] neg_lo:[0,1] neg_hi:[0,1]
v_pk_add_f32 v[44:45], v[44:45], v[52:53]
v_pk_mul_f32 v[52:53], v[78:79], s[58:59] op_sel:[0,1] op_sel_hi:[0,0] neg_lo:[0,0] neg_hi:[0,0]
v_pk_fma_f32 v[52:53], v[78:79], s[58:59], v[52:53] op_sel:[1,0,0] op_sel_hi:[1,1,1] neg_lo:[0,1,0] neg_hi:[0,0,0]
v_pk_add_f32 v[78:79], v[28:29], v[36:37] neg_lo:[0,1] neg_hi:[0,1]
v_pk_add_f32 v[28:29], v[28:29], v[36:37]
v_pk_mul_f32 v[36:37], v[78:79], s[54:55] op_sel:[0,1] op_sel_hi:[0,0] neg_lo:[0,0] neg_hi:[0,0]
v_pk_fma_f32 v[36:37], v[78:79], s[54:55], v[36:37] op_sel:[1,0,0] op_sel_hi:[1,1,1] neg_lo:[0,1,0] neg_hi:[0,0,0]
v_pk_add_f32 v[78:79], v[60:61], v[68:69] neg_lo:[0,1] neg_hi:[0,1]
v_pk_add_f32 v[60:61], v[60:61], v[68:69]
v_pk_mul_f32 v[68:69], v[78:79], s[50:51] op_sel:[0,1] op_sel_hi:[0,0] neg_lo:[0,0] neg_hi:[0,0]
v_pk_fma_f32 v[68:69], v[78:79], s[50:51], v[68:69] op_sel:[1,0,0] op_sel_hi:[1,1,1] neg_lo:[0,1,0] neg_hi:[0,0,0]
v_pk_add_f32 v[78:79], v[76:77], v[18:19] op_sel:[1,1] op_sel_hi:[0,0] neg_lo:[1,0] neg_hi:[0,1]
v_pk_add_f32 v[76:77], v[76:77], v[18:19]
v_pk_add_f32 v[18:19], v[46:47], v[50:51] neg_lo:[0,1] neg_hi:[0,1]
v_pk_add_f32 v[46:47], v[46:47], v[50:51]
v_pk_mul_f32 v[50:51], v[18:19], s[50:51] op_sel:[0,1] op_sel_hi:[0,0] neg_lo:[0,1] neg_hi:[0,0]
v_pk_fma_f32 v[50:51], v[18:19], s[50:51], v[50:51] op_sel:[1,0,0] op_sel_hi:[1,1,1] neg_lo:[0,1,0] neg_hi:[0,1,0]
v_pk_add_f32 v[18:19], v[30:31], v[34:35] neg_lo:[0,1] neg_hi:[0,1]
v_pk_add_f32 v[30:31], v[30:31], v[34:35]
v_pk_mul_f32 v[34:35], v[18:19], s[54:55] op_sel:[0,1] op_sel_hi:[0,0] neg_lo:[0,1] neg_hi:[0,0]
v_pk_fma_f32 v[34:35], v[18:19], s[54:55], v[34:35] op_sel:[1,0,0] op_sel_hi:[1,1,1] neg_lo:[0,1,0] neg_hi:[0,1,0]
v_pk_add_f32 v[18:19], v[62:63], v[66:67] neg_lo:[0,1] neg_hi:[0,1]
v_pk_add_f32 v[62:63], v[62:63], v[66:67]
v_pk_mul_f32 v[66:67], v[18:19], s[58:59] op_sel:[0,1] op_sel_hi:[0,0] neg_lo:[0,1] neg_hi:[0,0]
v_pk_fma_f32 v[66:67], v[18:19], s[58:59], v[66:67] op_sel:[1,0,0] op_sel_hi:[1,1,1] neg_lo:[0,1,0] neg_hi:[0,1,0]
v_pk_add_f32 v[18:19], v[22:23], v[26:27] neg_lo:[0,1] neg_hi:[0,1]
v_pk_add_f32 v[22:23], v[22:23], v[26:27]
v_pk_mul_f32 v[26:27], v[18:19], s[62:63] op_sel:[0,0] op_sel_hi:[0,1] neg_lo:[0,1] neg_hi:[0,0]
v_pk_fma_f32 v[26:27], v[18:19], s[62:63], v[26:27] op_sel:[1,1,0] op_sel_hi:[1,0,1] neg_lo:[0,1,0] neg_hi:[0,1,0]
v_pk_add_f32 v[18:19], v[54:55], v[58:59] neg_lo:[0,1] neg_hi:[0,1]
v_pk_add_f32 v[54:55], v[54:55], v[58:59]
v_pk_mul_f32 v[58:59], v[18:19], s[58:59] op_sel:[0,0] op_sel_hi:[0,1] neg_lo:[0,1] neg_hi:[0,0]
v_pk_fma_f32 v[58:59], v[18:19], s[58:59], v[58:59] op_sel:[1,1,0] op_sel_hi:[1,0,1] neg_lo:[0,1,0] neg_hi:[0,1,0]
v_pk_add_f32 v[18:19], v[38:39], v[42:43] neg_lo:[0,1] neg_hi:[0,1]
v_pk_add_f32 v[38:39], v[38:39], v[42:43]
v_pk_mul_f32 v[42:43], v[18:19], s[54:55] op_sel:[0,0] op_sel_hi:[0,1] neg_lo:[0,1] neg_hi:[0,0]
v_pk_fma_f32 v[42:43], v[18:19], s[54:55], v[42:43] op_sel:[1,1,0] op_sel_hi:[1,0,1] neg_lo:[0,1,0] neg_hi:[0,1,0]
v_pk_add_f32 v[18:19], v[70:71], v[74:75] neg_lo:[0,1] neg_hi:[0,1]
v_pk_add_f32 v[70:71], v[70:71], v[74:75]
v_pk_mul_f32 v[74:75], v[18:19], s[50:51] op_sel:[0,0] op_sel_hi:[0,1] neg_lo:[0,1] neg_hi:[0,0]
v_pk_fma_f32 v[74:75], v[18:19], s[50:51], v[74:75] op_sel:[1,1,0] op_sel_hi:[1,0,1] neg_lo:[0,1,0] neg_hi:[0,1,0]
v_pk_add_f32 v[18:19], v[16:17], v[76:77] neg_lo:[0,1] neg_hi:[0,1]
v_pk_add_f32 v[16:17], v[16:17], v[76:77]
v_pk_add_f32 v[76:77], v[14:15], v[46:47] neg_lo:[0,1] neg_hi:[0,1]
v_pk_add_f32 v[14:15], v[14:15], v[46:47]
v_pk_mul_f32 v[46:47], v[76:77], s[54:55] op_sel:[0,0] op_sel_hi:[0,1] neg_lo:[0,0] neg_hi:[0,0]
v_pk_fma_f32 v[46:47], v[76:77], s[54:55], v[46:47] op_sel:[1,1,0] op_sel_hi:[1,0,1] neg_lo:[0,1,0] neg_hi:[0,0,0]
v_pk_add_f32 v[76:77], v[64:65], v[30:31] neg_lo:[0,1] neg_hi:[0,1]
v_pk_add_f32 v[64:65], v[64:65], v[30:31]
v_pk_mul_f32 v[30:31], v[76:77], s[62:63] op_sel:[0,0] op_sel_hi:[0,1] neg_lo:[0,0] neg_hi:[0,0]
v_pk_fma_f32 v[30:31], v[76:77], s[62:63], v[30:31] op_sel:[1,1,0] op_sel_hi:[1,0,1] neg_lo:[0,1,0] neg_hi:[0,0,0]
v_pk_add_f32 v[76:77], v[40:41], v[62:63] neg_lo:[0,1] neg_hi:[0,1]
v_pk_add_f32 v[40:41], v[40:41], v[62:63]
v_pk_mul_f32 v[62:63], v[76:77], s[54:55] op_sel:[0,1] op_sel_hi:[0,0] neg_lo:[0,0] neg_hi:[0,0]
v_pk_fma_f32 v[62:63], v[76:77], s[54:55], v[62:63] op_sel:[1,0,0] op_sel_hi:[1,1,1] neg_lo:[0,1,0] neg_hi:[0,0,0]
v_pk_add_f32 v[76:77], v[72:73], v[22:23] op_sel:[1,1] op_sel_hi:[0,0] neg_lo:[1,0] neg_hi:[0,1]
v_pk_add_f32 v[72:73], v[72:73], v[22:23]
v_pk_add_f32 v[22:23], v[44:45], v[54:55] neg_lo:[0,1] neg_hi:[0,1]
v_pk_add_f32 v[44:45], v[44:45], v[54:55]
v_pk_mul_f32 v[54:55], v[22:23], s[54:55] op_sel:[0,1] op_sel_hi:[0,0] neg_lo:[0,1] neg_hi:[0,0]
v_pk_fma_f32 v[54:55], v[22:23], s[54:55], v[54:55] op_sel:[1,0,0] op_sel_hi:[1,1,1] neg_lo:[0,1,0] neg_hi:[0,1,0]
v_pk_add_f32 v[22:23], v[28:29], v[38:39] neg_lo:[0,1] neg_hi:[0,1]
v_pk_add_f32 v[28:29], v[28:29], v[38:39]
v_pk_mul_f32 v[38:39], v[22:23], s[62:63] op_sel:[0,0] op_sel_hi:[0,1] neg_lo:[0,1] neg_hi:[0,0]
v_pk_fma_f32 v[38:39], v[22:23], s[62:63], v[38:39] op_sel:[1,1,0] op_sel_hi:[1,0,1] neg_lo:[0,1,0] neg_hi:[0,1,0]
v_pk_add_f32 v[22:23], v[60:61], v[70:71] neg_lo:[0,1] neg_hi:[0,1]
v_pk_add_f32 v[60:61], v[60:61], v[70:71]
v_pk_mul_f32 v[70:71], v[22:23], s[54:55] op_sel:[0,0] op_sel_hi:[0,1] neg_lo:[0,1] neg_hi:[0,0]
v_pk_fma_f32 v[70:71], v[22:23], s[54:55], v[70:71] op_sel:[1,1,0] op_sel_hi:[1,0,1] neg_lo:[0,1,0] neg_hi:[0,1,0]
v_pk_add_f32 v[22:23], v[48:49], v[78:79] neg_lo:[0,1] neg_hi:[0,1]
v_pk_add_f32 v[48:49], v[48:49], v[78:79]
v_pk_add_f32 v[78:79], v[32:33], v[50:51] neg_lo:[0,1] neg_hi:[0,1]
v_pk_add_f32 v[32:33], v[32:33], v[50:51]
v_pk_mul_f32 v[50:51], v[78:79], s[54:55] op_sel:[0,0] op_sel_hi:[0,1] neg_lo:[0,0] neg_hi:[0,0]
v_pk_fma_f32 v[50:51], v[78:79], s[54:55], v[50:51] op_sel:[1,1,0] op_sel_hi:[1,0,1] neg_lo:[0,1,0] neg_hi:[0,0,0]
v_pk_add_f32 v[78:79], v[24:25], v[34:35] neg_lo:[0,1] neg_hi:[0,1]
v_pk_add_f32 v[24:25], v[24:25], v[34:35]
v_pk_mul_f32 v[34:35], v[78:79], s[62:63] op_sel:[0,0] op_sel_hi:[0,1] neg_lo:[0,0] neg_hi:[0,0]
v_pk_fma_f32 v[34:35], v[78:79], s[62:63], v[34:35] op_sel:[1,1,0] op_sel_hi:[1,0,1] neg_lo:[0,1,0] neg_hi:[0,0,0]
v_pk_add_f32 v[78:79], v[56:57], v[66:67] neg_lo:[0,1] neg_hi:[0,1]
v_pk_add_f32 v[56:57], v[56:57], v[66:67]
v_pk_mul_f32 v[66:67], v[78:79], s[54:55] op_sel:[0,1] op_sel_hi:[0,0] neg_lo:[0,0] neg_hi:[0,0]
v_pk_fma_f32 v[66:67], v[78:79], s[54:55], v[66:67] op_sel:[1,0,0] op_sel_hi:[1,1,1] neg_lo:[0,1,0] neg_hi:[0,0,0]
v_pk_add_f32 v[78:79], v[20:21], v[26:27] op_sel:[1,1] op_sel_hi:[0,0] neg_lo:[1,0] neg_hi:[0,1]
v_pk_add_f32 v[20:21], v[20:21], v[26:27]
v_pk_add_f32 v[26:27], v[52:53], v[58:59] neg_lo:[0,1] neg_hi:[0,1]
v_pk_add_f32 v[52:53], v[52:53], v[58:59]
v_pk_mul_f32 v[58:59], v[26:27], s[54:55] op_sel:[0,1] op_sel_hi:[0,0] neg_lo:[0,1] neg_hi:[0,0]
v_pk_fma_f32 v[58:59], v[26:27], s[54:55], v[58:59] op_sel:[1,0,0] op_sel_hi:[1,1,1] neg_lo:[0,1,0] neg_hi:[0,1,0]
v_pk_add_f32 v[26:27], v[36:37], v[42:43] neg_lo:[0,1] neg_hi:[0,1]
v_pk_add_f32 v[36:37], v[36:37], v[42:43]
v_pk_mul_f32 v[42:43], v[26:27], s[62:63] op_sel:[0,0] op_sel_hi:[0,1] neg_lo:[0,1] neg_hi:[0,0]
v_pk_fma_f32 v[42:43], v[26:27], s[62:63], v[42:43] op_sel:[1,1,0] op_sel_hi:[1,0,1] neg_lo:[0,1,0] neg_hi:[0,1,0]
v_pk_add_f32 v[26:27], v[68:69], v[74:75] neg_lo:[0,1] neg_hi:[0,1]
v_pk_add_f32 v[68:69], v[68:69], v[74:75]
v_pk_mul_f32 v[74:75], v[26:27], s[54:55] op_sel:[0,0] op_sel_hi:[0,1] neg_lo:[0,1] neg_hi:[0,0]
v_pk_fma_f32 v[74:75], v[26:27], s[54:55], v[74:75] op_sel:[1,1,0] op_sel_hi:[1,0,1] neg_lo:[0,1,0] neg_hi:[0,1,0]
v_pk_add_f32 v[26:27], v[16:17], v[72:73] neg_lo:[0,1] neg_hi:[0,1]
v_pk_add_f32 v[16:17], v[16:17], v[72:73]
v_pk_add_f32 v[72:73], v[14:15], v[44:45] neg_lo:[0,1] neg_hi:[0,1]
v_pk_add_f32 v[14:15], v[14:15], v[44:45]
v_pk_mul_f32 v[44:45], v[72:73], s[62:63] op_sel:[0,0] op_sel_hi:[0,1] neg_lo:[0,0] neg_hi:[0,0]
v_pk_fma_f32 v[44:45], v[72:73], s[62:63], v[44:45] op_sel:[1,1,0] op_sel_hi:[1,0,1] neg_lo:[0,1,0] neg_hi:[0,0,0]
v_pk_add_f32 v[72:73], v[64:65], v[28:29] op_sel:[1,1] op_sel_hi:[0,0] neg_lo:[1,0] neg_hi:[0,1]
v_pk_add_f32 v[64:65], v[64:65], v[28:29]
v_pk_add_f32 v[28:29], v[40:41], v[60:61] neg_lo:[0,1] neg_hi:[0,1]
v_pk_add_f32 v[40:41], v[40:41], v[60:61]
v_pk_mul_f32 v[60:61], v[28:29], s[62:63] op_sel:[0,0] op_sel_hi:[0,1] neg_lo:[0,1] neg_hi:[0,0]
v_pk_fma_f32 v[60:61], v[28:29], s[62:63], v[60:61] op_sel:[1,1,0] op_sel_hi:[1,0,1] neg_lo:[0,1,0] neg_hi:[0,1,0]
v_pk_add_f32 v[28:29], v[18:19], v[76:77] neg_lo:[0,1] neg_hi:[0,1]
v_pk_add_f32 v[18:19], v[18:19], v[76:77]
v_pk_add_f32 v[76:77], v[46:47], v[54:55] neg_lo:[0,1] neg_hi:[0,1]
v_pk_add_f32 v[46:47], v[46:47], v[54:55]
v_pk_mul_f32 v[54:55], v[76:77], s[62:63] op_sel:[0,0] op_sel_hi:[0,1] neg_lo:[0,0] neg_hi:[0,0]
v_pk_fma_f32 v[54:55], v[76:77], s[62:63], v[54:55] op_sel:[1,1,0] op_sel_hi:[1,0,1] neg_lo:[0,1,0] neg_hi:[0,0,0]
v_pk_add_f32 v[76:77], v[30:31], v[38:39] op_sel:[1,1] op_sel_hi:[0,0] neg_lo:[1,0] neg_hi:[0,1]
v_pk_add_f32 v[30:31], v[30:31], v[38:39]
v_pk_add_f32 v[38:39], v[62:63], v[70:71] neg_lo:[0,1] neg_hi:[0,1]
v_pk_add_f32 v[62:63], v[62:63], v[70:71]
v_pk_mul_f32 v[70:71], v[38:39], s[62:63] op_sel:[0,0] op_sel_hi:[0,1] neg_lo:[0,1] neg_hi:[0,0]
v_pk_fma_f32 v[70:71], v[38:39], s[62:63], v[70:71] op_sel:[1,1,0] op_sel_hi:[1,0,1] neg_lo:[0,1,0] neg_hi:[0,1,0]
v_pk_add_f32 v[38:39], v[48:49], v[20:21] neg_lo:[0,1] neg_hi:[0,1]
v_pk_add_f32 v[48:49], v[48:49], v[20:21]
v_pk_add_f32 v[20:21], v[32:33], v[52:53] neg_lo:[0,1] neg_hi:[0,1]
v_pk_add_f32 v[32:33], v[32:33], v[52:53]
v_pk_mul_f32 v[52:53], v[20:21], s[62:63] op_sel:[0,0] op_sel_hi:[0,1] neg_lo:[0,0] neg_hi:[0,0]
v_pk_fma_f32 v[52:53], v[20:21], s[62:63], v[52:53] op_sel:[1,1,0] op_sel_hi:[1,0,1] neg_lo:[0,1,0] neg_hi:[0,0,0]
v_pk_add_f32 v[20:21], v[24:25], v[36:37] op_sel:[1,1] op_sel_hi:[0,0] neg_lo:[1,0] neg_hi:[0,1]
v_pk_add_f32 v[24:25], v[24:25], v[36:37]
v_pk_add_f32 v[36:37], v[56:57], v[68:69] neg_lo:[0,1] neg_hi:[0,1]
v_pk_add_f32 v[56:57], v[56:57], v[68:69]
v_pk_mul_f32 v[68:69], v[36:37], s[62:63] op_sel:[0,0] op_sel_hi:[0,1] neg_lo:[0,1] neg_hi:[0,0]
v_pk_fma_f32 v[68:69], v[36:37], s[62:63], v[68:69] op_sel:[1,1,0] op_sel_hi:[1,0,1] neg_lo:[0,1,0] neg_hi:[0,1,0]
v_pk_add_f32 v[36:37], v[22:23], v[78:79] neg_lo:[0,1] neg_hi:[0,1]
v_pk_add_f32 v[22:23], v[22:23], v[78:79]
v_pk_add_f32 v[78:79], v[50:51], v[58:59] neg_lo:[0,1] neg_hi:[0,1]
v_pk_add_f32 v[50:51], v[50:51], v[58:59]
v_pk_mul_f32 v[58:59], v[78:79], s[62:63] op_sel:[0,0] op_sel_hi:[0,1] neg_lo:[0,0] neg_hi:[0,0]
v_pk_fma_f32 v[58:59], v[78:79], s[62:63], v[58:59] op_sel:[1,1,0] op_sel_hi:[1,0,1] neg_lo:[0,1,0] neg_hi:[0,0,0]
v_pk_add_f32 v[78:79], v[34:35], v[42:43] op_sel:[1,1] op_sel_hi:[0,0] neg_lo:[1,0] neg_hi:[0,1]
v_pk_add_f32 v[34:35], v[34:35], v[42:43]
v_pk_add_f32 v[42:43], v[66:67], v[74:75] neg_lo:[0,1] neg_hi:[0,1]
v_pk_add_f32 v[66:67], v[66:67], v[74:75]
v_pk_mul_f32 v[74:75], v[42:43], s[62:63] op_sel:[0,0] op_sel_hi:[0,1] neg_lo:[0,1] neg_hi:[0,0]
v_pk_fma_f32 v[74:75], v[42:43], s[62:63], v[74:75] op_sel:[1,1,0] op_sel_hi:[1,0,1] neg_lo:[0,1,0] neg_hi:[0,1,0]
v_pk_add_f32 v[42:43], v[16:17], v[64:65] neg_lo:[0,1] neg_hi:[0,1]
v_pk_add_f32 v[16:17], v[16:17], v[64:65]
v_pk_add_f32 v[64:65], v[14:15], v[40:41] op_sel:[1,1] op_sel_hi:[0,0] neg_lo:[1,0] neg_hi:[0,1]
v_pk_add_f32 v[14:15], v[14:15], v[40:41]
v_pk_add_f32 v[40:41], v[26:27], v[72:73] neg_lo:[0,1] neg_hi:[0,1]
v_pk_add_f32 v[26:27], v[26:27], v[72:73]
v_pk_add_f32 v[72:73], v[44:45], v[60:61] op_sel:[1,1] op_sel_hi:[0,0] neg_lo:[1,0] neg_hi:[0,1]
v_pk_add_f32 v[44:45], v[44:45], v[60:61]
v_pk_add_f32 v[60:61], v[18:19], v[30:31] neg_lo:[0,1] neg_hi:[0,1]
v_pk_add_f32 v[18:19], v[18:19], v[30:31]
v_pk_add_f32 v[30:31], v[46:47], v[62:63] op_sel:[1,1] op_sel_hi:[0,0] neg_lo:[1,0] neg_hi:[0,1]
v_pk_add_f32 v[46:47], v[46:47], v[62:63]
v_pk_add_f32 v[62:63], v[28:29], v[76:77] neg_lo:[0,1] neg_hi:[0,1]
v_pk_add_f32 v[28:29], v[28:29], v[76:77]
v_pk_add_f32 v[76:77], v[54:55], v[70:71] op_sel:[1,1] op_sel_hi:[0,0] neg_lo:[1,0] neg_hi:[0,1]
v_pk_add_f32 v[54:55], v[54:55], v[70:71]
v_pk_add_f32 v[70:71], v[48:49], v[24:25] neg_lo:[0,1] neg_hi:[0,1]
v_pk_add_f32 v[48:49], v[48:49], v[24:25]
v_pk_add_f32 v[24:25], v[32:33], v[56:57] op_sel:[1,1] op_sel_hi:[0,0] neg_lo:[1,0] neg_hi:[0,1]
v_pk_add_f32 v[32:33], v[32:33], v[56:57]
v_pk_add_f32 v[56:57], v[38:39], v[20:21] neg_lo:[0,1] neg_hi:[0,1]
v_pk_add_f32 v[38:39], v[38:39], v[20:21]
v_pk_add_f32 v[20:21], v[52:53], v[68:69] op_sel:[1,1] op_sel_hi:[0,0] neg_lo:[1,0] neg_hi:[0,1]
v_pk_add_f32 v[52:53], v[52:53], v[68:69]
v_pk_add_f32 v[68:69], v[22:23], v[34:35] neg_lo:[0,1] neg_hi:[0,1]
v_pk_add_f32 v[22:23], v[22:23], v[34:35]
v_pk_add_f32 v[34:35], v[50:51], v[66:67] op_sel:[1,1] op_sel_hi:[0,0] neg_lo:[1,0] neg_hi:[0,1]
v_pk_add_f32 v[50:51], v[50:51], v[66:67]
v_pk_add_f32 v[66:67], v[36:37], v[78:79] neg_lo:[0,1] neg_hi:[0,1]
v_pk_add_f32 v[36:37], v[36:37], v[78:79]
v_pk_add_f32 v[78:79], v[58:59], v[74:75] op_sel:[1,1] op_sel_hi:[0,0] neg_lo:[1,0] neg_hi:[0,1]
v_pk_add_f32 v[58:59], v[58:59], v[74:75]
v_pk_add_f32 v[74:75], v[16:17], v[14:15] neg_lo:[0,1] neg_hi:[0,1]
v_pk_add_f32 v[16:17], v[16:17], v[14:15]
v_pk_add_f32 v[14:15], v[42:43], v[64:65] neg_lo:[0,1] neg_hi:[0,1]
v_pk_add_f32 v[42:43], v[42:43], v[64:65]
v_pk_add_f32 v[64:65], v[26:27], v[44:45] neg_lo:[0,1] neg_hi:[0,1]
v_pk_add_f32 v[26:27], v[26:27], v[44:45]
v_pk_add_f32 v[44:45], v[40:41], v[72:73] neg_lo:[0,1] neg_hi:[0,1]
v_pk_add_f32 v[40:41], v[40:41], v[72:73]
v_pk_add_f32 v[72:73], v[18:19], v[46:47] neg_lo:[0,1] neg_hi:[0,1]
v_pk_add_f32 v[18:19], v[18:19], v[46:47]
v_pk_add_f32 v[46:47], v[60:61], v[30:31] neg_lo:[0,1] neg_hi:[0,1]
v_pk_add_f32 v[60:61], v[60:61], v[30:31]
v_pk_add_f32 v[30:31], v[28:29], v[54:55] neg_lo:[0,1] neg_hi:[0,1]
v_pk_add_f32 v[28:29], v[28:29], v[54:55]
v_pk_add_f32 v[54:55], v[62:63], v[76:77] neg_lo:[0,1] neg_hi:[0,1]
v_pk_add_f32 v[62:63], v[62:63], v[76:77]
v_pk_add_f32 v[76:77], v[48:49], v[32:33] neg_lo:[0,1] neg_hi:[0,1]
v_pk_add_f32 v[48:49], v[48:49], v[32:33]
v_pk_add_f32 v[32:33], v[70:71], v[24:25] neg_lo:[0,1] neg_hi:[0,1]
v_pk_add_f32 v[70:71], v[70:71], v[24:25]
v_pk_add_f32 v[24:25], v[38:39], v[52:53] neg_lo:[0,1] neg_hi:[0,1]
v_pk_add_f32 v[38:39], v[38:39], v[52:53]
v_pk_add_f32 v[52:53], v[56:57], v[20:21] neg_lo:[0,1] neg_hi:[0,1]
v_pk_add_f32 v[56:57], v[56:57], v[20:21]
v_pk_add_f32 v[20:21], v[22:23], v[50:51] neg_lo:[0,1] neg_hi:[0,1]
v_pk_add_f32 v[22:23], v[22:23], v[50:51]
v_pk_add_f32 v[50:51], v[68:69], v[34:35] neg_lo:[0,1] neg_hi:[0,1]
v_pk_add_f32 v[68:69], v[68:69], v[34:35]
v_pk_add_f32 v[34:35], v[36:37], v[58:59] neg_lo:[0,1] neg_hi:[0,1]
v_pk_add_f32 v[36:37], v[36:37], v[58:59]
v_pk_add_f32 v[58:59], v[66:67], v[78:79] neg_lo:[0,1] neg_hi:[0,1]
v_pk_add_f32 v[66:67], v[66:67], v[78:79]
v_pk_mul_f32 v[78:79], v[16:17], v[144:145] op_sel:[0,0] op_sel_hi:[0,1] neg_lo:[0,0] neg_hi:[0,0]
v_pk_fma_f32 v[16:17], v[16:17], v[144:145], v[78:79] op_sel:[1,1,0] op_sel_hi:[1,0,1] neg_lo:[0,1,0] neg_hi:[0,0,0]
v_pk_mul_f32 v[78:79], v[48:49], v[146:147] op_sel:[0,0] op_sel_hi:[0,1] neg_lo:[0,0] neg_hi:[0,0]
v_pk_fma_f32 v[48:49], v[48:49], v[146:147], v[78:79] op_sel:[1,1,0] op_sel_hi:[1,0,1] neg_lo:[0,1,0] neg_hi:[0,0,0]
v_pk_mul_f32 v[78:79], v[18:19], v[148:149] op_sel:[0,0] op_sel_hi:[0,1] neg_lo:[0,0] neg_hi:[0,0]
v_pk_fma_f32 v[18:19], v[18:19], v[148:149], v[78:79] op_sel:[1,1,0] op_sel_hi:[1,0,1] neg_lo:[0,1,0] neg_hi:[0,0,0]
v_pk_mul_f32 v[78:79], v[22:23], v[150:151] op_sel:[0,0] op_sel_hi:[0,1] neg_lo:[0,0] neg_hi:[0,0]
v_pk_fma_f32 v[22:23], v[22:23], v[150:151], v[78:79] op_sel:[1,1,0] op_sel_hi:[1,0,1] neg_lo:[0,1,0] neg_hi:[0,0,0]
v_pk_mul_f32 v[78:79], v[26:27], v[152:153] op_sel:[0,0] op_sel_hi:[0,1] neg_lo:[0,0] neg_hi:[0,0]
v_pk_fma_f32 v[26:27], v[26:27], v[152:153], v[78:79] op_sel:[1,1,0] op_sel_hi:[1,0,1] neg_lo:[0,1,0] neg_hi:[0,0,0]
v_pk_mul_f32 v[78:79], v[38:39], v[154:155] op_sel:[0,0] op_sel_hi:[0,1] neg_lo:[0,0] neg_hi:[0,0]
v_pk_fma_f32 v[38:39], v[38:39], v[154:155], v[78:79] op_sel:[1,1,0] op_sel_hi:[1,0,1] neg_lo:[0,1,0] neg_hi:[0,0,0]
v_pk_mul_f32 v[78:79], v[28:29], v[156:157] op_sel:[0,0] op_sel_hi:[0,1] neg_lo:[0,0] neg_hi:[0,0]
v_pk_fma_f32 v[28:29], v[28:29], v[156:157], v[78:79] op_sel:[1,1,0] op_sel_hi:[1,0,1] neg_lo:[0,1,0] neg_hi:[0,0,0]
v_pk_mul_f32 v[78:79], v[36:37], v[158:159] op_sel:[0,0] op_sel_hi:[0,1] neg_lo:[0,0] neg_hi:[0,0]
v_pk_fma_f32 v[36:37], v[36:37], v[158:159], v[78:79] op_sel:[1,1,0] op_sel_hi:[1,0,1] neg_lo:[0,1,0] neg_hi:[0,0,0]
v_pk_mul_f32 v[78:79], v[42:43], v[160:161] op_sel:[0,0] op_sel_hi:[0,1] neg_lo:[0,0] neg_hi:[0,0]
v_pk_fma_f32 v[42:43], v[42:43], v[160:161], v[78:79] op_sel:[1,1,0] op_sel_hi:[1,0,1] neg_lo:[0,1,0] neg_hi:[0,0,0]
v_pk_mul_f32 v[78:79], v[70:71], v[162:163] op_sel:[0,0] op_sel_hi:[0,1] neg_lo:[0,0] neg_hi:[0,0]
v_pk_fma_f32 v[70:71], v[70:71], v[162:163], v[78:79] op_sel:[1,1,0] op_sel_hi:[1,0,1] neg_lo:[0,1,0] neg_hi:[0,0,0]
v_pk_mul_f32 v[78:79], v[60:61], v[164:165] op_sel:[0,0] op_sel_hi:[0,1] neg_lo:[0,0] neg_hi:[0,0]
v_pk_fma_f32 v[60:61], v[60:61], v[164:165], v[78:79] op_sel:[1,1,0] op_sel_hi:[1,0,1] neg_lo:[0,1,0] neg_hi:[0,0,0]
v_pk_mul_f32 v[78:79], v[68:69], v[166:167] op_sel:[0,0] op_sel_hi:[0,1] neg_lo:[0,0] neg_hi:[0,0]
v_pk_fma_f32 v[68:69], v[68:69], v[166:167], v[78:79] op_sel:[1,1,0] op_sel_hi:[1,0,1] neg_lo:[0,1,0] neg_hi:[0,0,0]
v_pk_mul_f32 v[78:79], v[40:41], v[168:169] op_sel:[0,0] op_sel_hi:[0,1] neg_lo:[0,0] neg_hi:[0,0]
v_pk_fma_f32 v[40:41], v[40:41], v[168:169], v[78:79] op_sel:[1,1,0] op_sel_hi:[1,0,1] neg_lo:[0,1,0] neg_hi:[0,0,0]
v_pk_mul_f32 v[78:79], v[56:57], v[170:171] op_sel:[0,0] op_sel_hi:[0,1] neg_lo:[0,0] neg_hi:[0,0]
v_pk_fma_f32 v[56:57], v[56:57], v[170:171], v[78:79] op_sel:[1,1,0] op_sel_hi:[1,0,1] neg_lo:[0,1,0] neg_hi:[0,0,0]
v_pk_mul_f32 v[78:79], v[62:63], v[172:173] op_sel:[0,0] op_sel_hi:[0,1] neg_lo:[0,0] neg_hi:[0,0]
v_pk_fma_f32 v[62:63], v[62:63], v[172:173], v[78:79] op_sel:[1,1,0] op_sel_hi:[1,0,1] neg_lo:[0,1,0] neg_hi:[0,0,0]
v_pk_mul_f32 v[78:79], v[66:67], v[174:175] op_sel:[0,0] op_sel_hi:[0,1] neg_lo:[0,0] neg_hi:[0,0]
v_pk_fma_f32 v[66:67], v[66:67], v[174:175], v[78:79] op_sel:[1,1,0] op_sel_hi:[1,0,1] neg_lo:[0,1,0] neg_hi:[0,0,0]
v_pk_mul_f32 v[78:79], v[74:75], v[176:177] op_sel:[0,0] op_sel_hi:[0,1] neg_lo:[0,0] neg_hi:[0,0]
v_pk_fma_f32 v[74:75], v[74:75], v[176:177], v[78:79] op_sel:[1,1,0] op_sel_hi:[1,0,1] neg_lo:[0,1,0] neg_hi:[0,0,0]
v_pk_mul_f32 v[78:79], v[76:77], v[178:179] op_sel:[0,0] op_sel_hi:[0,1] neg_lo:[0,0] neg_hi:[0,0]
v_pk_fma_f32 v[76:77], v[76:77], v[178:179], v[78:79] op_sel:[1,1,0] op_sel_hi:[1,0,1] neg_lo:[0,1,0] neg_hi:[0,0,0]
v_pk_mul_f32 v[78:79], v[72:73], v[180:181] op_sel:[0,0] op_sel_hi:[0,1] neg_lo:[0,0] neg_hi:[0,0]
v_pk_fma_f32 v[72:73], v[72:73], v[180:181], v[78:79] op_sel:[1,1,0] op_sel_hi:[1,0,1] neg_lo:[0,1,0] neg_hi:[0,0,0]
v_pk_mul_f32 v[78:79], v[20:21], v[182:183] op_sel:[0,0] op_sel_hi:[0,1] neg_lo:[0,0] neg_hi:[0,0]
v_pk_fma_f32 v[20:21], v[20:21], v[182:183], v[78:79] op_sel:[1,1,0] op_sel_hi:[1,0,1] neg_lo:[0,1,0] neg_hi:[0,0,0]
v_pk_mul_f32 v[78:79], v[64:65], v[184:185] op_sel:[0,0] op_sel_hi:[0,1] neg_lo:[0,0] neg_hi:[0,0]
v_pk_fma_f32 v[64:65], v[64:65], v[184:185], v[78:79] op_sel:[1,1,0] op_sel_hi:[1,0,1] neg_lo:[0,1,0] neg_hi:[0,0,0]
v_pk_mul_f32 v[78:79], v[24:25], v[186:187] op_sel:[0,0] op_sel_hi:[0,1] neg_lo:[0,0] neg_hi:[0,0]
v_pk_fma_f32 v[24:25], v[24:25], v[186:187], v[78:79] op_sel:[1,1,0] op_sel_hi:[1,0,1] neg_lo:[0,1,0] neg_hi:[0,0,0]
v_pk_mul_f32 v[78:79], v[30:31], v[188:189] op_sel:[0,0] op_sel_hi:[0,1] neg_lo:[0,0] neg_hi:[0,0]
v_pk_fma_f32 v[30:31], v[30:31], v[188:189], v[78:79] op_sel:[1,1,0] op_sel_hi:[1,0,1] neg_lo:[0,1,0] neg_hi:[0,0,0]
v_pk_mul_f32 v[78:79], v[34:35], v[190:191] op_sel:[0,0] op_sel_hi:[0,1] neg_lo:[0,0] neg_hi:[0,0]
v_pk_fma_f32 v[34:35], v[34:35], v[190:191], v[78:79] op_sel:[1,1,0] op_sel_hi:[1,0,1] neg_lo:[0,1,0] neg_hi:[0,0,0]
v_pk_mul_f32 v[78:79], v[14:15], v[192:193] op_sel:[0,0] op_sel_hi:[0,1] neg_lo:[0,0] neg_hi:[0,0]
v_pk_fma_f32 v[14:15], v[14:15], v[192:193], v[78:79] op_sel:[1,1,0] op_sel_hi:[1,0,1] neg_lo:[0,1,0] neg_hi:[0,0,0]
v_pk_mul_f32 v[78:79], v[32:33], v[194:195] op_sel:[0,0] op_sel_hi:[0,1] neg_lo:[0,0] neg_hi:[0,0]
v_pk_fma_f32 v[32:33], v[32:33], v[194:195], v[78:79] op_sel:[1,1,0] op_sel_hi:[1,0,1] neg_lo:[0,1,0] neg_hi:[0,0,0]
v_pk_mul_f32 v[78:79], v[46:47], v[196:197] op_sel:[0,0] op_sel_hi:[0,1] neg_lo:[0,0] neg_hi:[0,0]
v_pk_fma_f32 v[46:47], v[46:47], v[196:197], v[78:79] op_sel:[1,1,0] op_sel_hi:[1,0,1] neg_lo:[0,1,0] neg_hi:[0,0,0]
v_pk_mul_f32 v[78:79], v[50:51], v[198:199] op_sel:[0,0] op_sel_hi:[0,1] neg_lo:[0,0] neg_hi:[0,0]
v_pk_fma_f32 v[50:51], v[50:51], v[198:199], v[78:79] op_sel:[1,1,0] op_sel_hi:[1,0,1] neg_lo:[0,1,0] neg_hi:[0,0,0]
v_pk_mul_f32 v[78:79], v[44:45], v[200:201] op_sel:[0,0] op_sel_hi:[0,1] neg_lo:[0,0] neg_hi:[0,0]
v_pk_fma_f32 v[44:45], v[44:45], v[200:201], v[78:79] op_sel:[1,1,0] op_sel_hi:[1,0,1] neg_lo:[0,1,0] neg_hi:[0,0,0]
v_pk_mul_f32 v[78:79], v[52:53], v[202:203] op_sel:[0,0] op_sel_hi:[0,1] neg_lo:[0,0] neg_hi:[0,0]
v_pk_fma_f32 v[52:53], v[52:53], v[202:203], v[78:79] op_sel:[1,1,0] op_sel_hi:[1,0,1] neg_lo:[0,1,0] neg_hi:[0,0,0]
v_pk_mul_f32 v[78:79], v[54:55], v[204:205] op_sel:[0,0] op_sel_hi:[0,1] neg_lo:[0,0] neg_hi:[0,0]
v_pk_fma_f32 v[54:55], v[54:55], v[204:205], v[78:79] op_sel:[1,1,0] op_sel_hi:[1,0,1] neg_lo:[0,1,0] neg_hi:[0,0,0]
v_pk_mul_f32 v[78:79], v[58:59], v[206:207] op_sel:[0,0] op_sel_hi:[0,1] neg_lo:[0,0] neg_hi:[0,0]
v_pk_fma_f32 v[58:59], v[58:59], v[206:207], v[78:79] op_sel:[1,1,0] op_sel_hi:[1,0,1] neg_lo:[0,1,0] neg_hi:[0,0,0]
ds_write_b64 v4, v[16:17] offset:0
ds_write_b64 v4, v[48:49] offset:16
ds_write_b64 v4, v[18:19] offset:32
ds_write_b64 v4, v[22:23] offset:48
ds_write_b64 v4, v[26:27] offset:64
ds_write_b64 v4, v[38:39] offset:80
ds_write_b64 v4, v[28:29] offset:96
ds_write_b64 v4, v[36:37] offset:112
ds_write_b64 v4, v[42:43] offset:128
ds_write_b64 v4, v[70:71] offset:144
ds_write_b64 v4, v[60:61] offset:160
ds_write_b64 v4, v[68:69] offset:176
ds_write_b64 v4, v[40:41] offset:192
ds_write_b64 v4, v[56:57] offset:208
ds_write_b64 v4, v[62:63] offset:224
ds_write_b64 v4, v[66:67] offset:240
ds_write_b64 v4, v[74:75] offset:256
ds_write_b64 v4, v[76:77] offset:272
ds_write_b64 v4, v[72:73] offset:288
ds_write_b64 v4, v[20:21] offset:304
ds_write_b64 v4, v[64:65] offset:320
ds_write_b64 v4, v[24:25] offset:336
ds_write_b64 v4, v[30:31] offset:352
ds_write_b64 v4, v[34:35] offset:368
ds_write_b64 v4, v[14:15] offset:384
ds_write_b64 v4, v[32:33] offset:400
ds_write_b64 v4, v[46:47] offset:416
ds_write_b64 v4, v[50:51] offset:432
ds_write_b64 v4, v[44:45] offset:448
ds_write_b64 v4, v[52:53] offset:464
ds_write_b64 v4, v[54:55] offset:480
ds_write_b64 v4, v[58:59] offset:496
s_waitcnt lgkmcnt(0)
ds_read_b64 v[16:17], v3 offset:0
ds_read_b64 v[48:49], v3 offset:8448
ds_read_b64 v[18:19], v3 offset:528
ds_read_b64 v[50:51], v3 offset:8976
ds_read_b64 v[20:21], v3 offset:1056
ds_read_b64 v[52:53], v3 offset:9504
ds_read_b64 v[22:23], v3 offset:1584
ds_read_b64 v[54:55], v3 offset:10032
ds_read_b64 v[24:25], v3 offset:2112
ds_read_b64 v[56:57], v3 offset:10560
ds_read_b64 v[26:27], v3 offset:2640
ds_read_b64 v[58:59], v3 offset:11088
ds_read_b64 v[28:29], v3 offset:3168
ds_read_b64 v[60:61], v3 offset:11616
ds_read_b64 v[30:31], v3 offset:3696
ds_read_b64 v[62:63], v3 offset:12144
ds_read_b64 v[32:33], v3 offset:4224
ds_read_b64 v[64:65], v3 offset:12672
ds_read_b64 v[34:35], v3 offset:4752
ds_read_b64 v[66:67], v3 offset:13200
ds_read_b64 v[36:37], v3 offset:5280
ds_read_b64 v[68:69], v3 offset:13728
ds_read_b64 v[38:39], v3 offset:5808
ds_read_b64 v[70:71], v3 offset:14256
ds_read_b64 v[40:41], v3 offset:6336
ds_read_b64 v[72:73], v3 offset:14784
ds_read_b64 v[42:43], v3 offset:6864
ds_read_b64 v[74:75], v3 offset:15312
ds_read_b64 v[44:45], v3 offset:7392
ds_read_b64 v[76:77], v3 offset:15840
ds_read_b64 v[46:47], v3 offset:7920
ds_read_b64 v[78:79], v3 offset:16368
s_waitcnt lgkmcnt(0)
v_pk_add_f32 v[14:15], v[16:17], v[48:49] neg_lo:[0,1] neg_hi:[0,1]
v_pk_add_f32 v[16:17], v[16:17], v[48:49]
v_pk_add_f32 v[48:49], v[18:19], v[50:51] neg_lo:[0,1] neg_hi:[0,1]
v_pk_add_f32 v[18:19], v[18:19], v[50:51]
v_pk_mul_f32 v[50:51], v[48:49], s[50:51] op_sel:[0,0] op_sel_hi:[0,1] neg_lo:[0,0] neg_hi:[0,0]
v_pk_fma_f32 v[50:51], v[48:49], s[50:51], v[50:51] op_sel:[1,1,0] op_sel_hi:[1,0,1] neg_lo:[0,1,0] neg_hi:[0,0,0]
v_pk_add_f32 v[48:49], v[20:21], v[52:53] neg_lo:[0,1] neg_hi:[0,1]
v_pk_add_f32 v[20:21], v[20:21], v[52:53]
v_pk_mul_f32 v[52:53], v[48:49], s[54:55] op_sel:[0,0] op_sel_hi:[0,1] neg_lo:[0,0] neg_hi:[0,0]
v_pk_fma_f32 v[52:53], v[48:49], s[54:55], v[52:53] op_sel:[1,1,0] op_sel_hi:[1,0,1] neg_lo:[0,1,0] neg_hi:[0,0,0]
v_pk_add_f32 v[48:49], v[22:23], v[54:55] neg_lo:[0,1] neg_hi:[0,1]
v_pk_add_f32 v[22:23], v[22:23], v[54:55]
v_pk_mul_f32 v[54:55], v[48:49], s[58:59] op_sel:[0,0] op_sel_hi:[0,1] neg_lo:[0,0] neg_hi:[0,0]
v_pk_fma_f32 v[54:55], v[48:49], s[58:59], v[54:55] op_sel:[1,1,0] op_sel_hi:[1,0,1] neg_lo:[0,1,0] neg_hi:[0,0,0]
v_pk_add_f32 v[48:49], v[24:25], v[56:57] neg_lo:[0,1] neg_hi:[0,1]
v_pk_add_f32 v[24:25], v[24:25], v[56:57]
v_pk_mul_f32 v[56:57], v[48:49], s[62:63] op_sel:[0,0] op_sel_hi:[0,1] neg_lo:[0,0] neg_hi:[0,0]
v_pk_fma_f32 v[56:57], v[48:49], s[62:63], v[56:57] op_sel:[1,1,0] op_sel_hi:[1,0,1] neg_lo:[0,1,0] neg_hi:[0,0,0]
v_pk_add_f32 v[48:49], v[26:27], v[58:59] neg_lo:[0,1] neg_hi:[0,1]
v_pk_add_f32 v[26:27], v[26:27], v[58:59]
v_pk_mul_f32 v[58:59], v[48:49], s[58:59] op_sel:[0,1] op_sel_hi:[0,0] neg_lo:[0,0] neg_hi:[0,0]
v_pk_fma_f32 v[58:59], v[48:49], s[58:59], v[58:59] op_sel:[1,0,0] op_sel_hi:[1,1,1] neg_lo:[0,1,0] neg_hi:[0,0,0]
v_pk_add_f32 v[48:49], v[28:29], v[60:61] neg_lo:[0,1] neg_hi:[0,1]
v_pk_add_f32 v[28:29], v[28:29], v[60:61]
v_pk_mul_f32 v[60:61], v[48:49], s[54:55] op_sel:[0,1] op_sel_hi:[0,0] neg_lo:[0,0] neg_hi:[0,0]
v_pk_fma_f32 v[60:61], v[48:49], s[54:55], v[60:61] op_sel:[1,0,0] op_sel_hi:[1,1,1] neg_lo:[0,1,0] neg_hi:[0,0,0]
v_pk_add_f32 v[48:49], v[30:31], v[62:63] neg_lo:[0,1] neg_hi:[0,1]
v_pk_add_f32 v[30:31], v[30:31], v[62:63]
v_pk_mul_f32 v[62:63], v[48:49], s[50:51] op_sel:[0,1] op_sel_hi:[0,0] neg_lo:[0,0] neg_hi:[0,0]
v_pk_fma_f32 v[62:63], v[48:49], s[50:51], v[62:63] op_sel:[1,0,0] op_sel_hi:[1,1,1] neg_lo:[0,1,0] neg_hi:[0,0,0]
v_pk_add_f32 v[48:49], v[32:33], v[64:65] op_sel:[1,1] op_sel_hi:[0,0] neg_lo:[1,0] neg_hi:[0,1]
v_pk_add_f32 v[32:33], v[32:33], v[64:65]
v_pk_add_f32 v[64:65], v[34:35], v[66:67] neg_lo:[0,1] neg_hi:[0,1]
v_pk_add_f32 v[34:35], v[34:35], v[66:67]
v_pk_mul_f32 v[66:67], v[64:65], s[50:51] op_sel:[0,1] op_sel_hi:[0,0] neg_lo:[0,1] neg_hi:[0,0]
v_pk_fma_f32 v[66:67], v[64:65], s[50:51], v[66:67] op_sel:[1,0,0] op_sel_hi:[1,1,1] neg_lo:[0,1,0] neg_hi:[0,1,0]
v_pk_add_f32 v[64:65], v[36:37], v[68:69] neg_lo:[0,1] neg_hi:[0,1]
v_pk_add_f32 v[36:37], v[36:37], v[68:69]
v_pk_mul_f32 v[68:69], v[64:65], s[54:55] op_sel:[0,1] op_sel_hi:[0,0] neg_lo:[0,1] neg_hi:[0,0]
v_pk_fma_f32 v[68:69], v[64:65], s[54:55], v[68:69] op_sel:[1,0,0] op_sel_hi:[1,1,1] neg_lo:[0,1,0] neg_hi:[0,1,0]
v_pk_add_f32 v[64:65], v[38:39], v[70:71] neg_lo:[0,1] neg_hi:[0,1]
v_pk_add_f32 v[38:39], v[38:39], v[70:71]
v_pk_mul_f32 v[70:71], v[64:65], s[58:59] op_sel:[0,1] op_sel_hi:[0,0] neg_lo:[0,1] neg_hi:[0,0]
v_pk_fma_f32 v[70:71], v[64:65], s[58:59], v[70:71] op_sel:[1,0,0] op_sel_hi:[1,1,1] neg_lo:[0,1,0] neg_hi:[0,1,0]
v_pk_add_f32 v[64:65], v[40:41], v[72:73] neg_lo:[0,1] neg_hi:[0,1]
v_pk_add_f32 v[40:41], v[40:41], v[72:73]
v_pk_mul_f32 v[72:73], v[64:65], s[62:63] op_sel:[0,0] op_sel_hi:[0,1] neg_lo:[0,1] neg_hi:[0,0]
v_pk_fma_f32 v[72:73], v[64:65], s[62:63], v[72:73] op_sel:[1,1,0] op_sel_hi:[1,0,1] neg_lo:[0,1,0] neg_hi:[0,1,0]
v_pk_add_f32 v[64:65], v[42:43], v[74:75] neg_lo:[0,1] neg_hi:[0,1]
v_pk_add_f32 v[42:43], v[42:43], v[74:75]
v_pk_mul_f32 v[74:75], v[64:65], s[58:59] op_sel:[0,0] op_sel_hi:[0,1] neg_lo:[0,1] neg_hi:[0,0]
v_pk_fma_f32 v[74:75], v[64:65], s[58:59], v[74:75] op_sel:[1,1,0] op_sel_hi:[1,0,1] neg_lo:[0,1,0] neg_hi:[0,1,0]
v_pk_add_f32 v[64:65], v[44:45], v[76:77] neg_lo:[0,1] neg_hi:[0,1]
v_pk_add_f32 v[44:45], v[44:45], v[76:77]
v_pk_mul_f32 v[76:77], v[64:65], s[54:55] op_sel:[0,0] op_sel_hi:[0,1] neg_lo:[0,1] neg_hi:[0,0]
v_pk_fma_f32 v[76:77], v[64:65], s[54:55], v[76:77] op_sel:[1,1,0] op_sel_hi:[1,0,1] neg_lo:[0,1,0] neg_hi:[0,1,0]
v_pk_add_f32 v[64:65], v[46:47], v[78:79] neg_lo:[0,1] neg_hi:[0,1]
v_pk_add_f32 v[46:47], v[46:47], v[78:79]
v_pk_mul_f32 v[78:79], v[64:65], s[50:51] op_sel:[0,0] op_sel_hi:[0,1] neg_lo:[0,1] neg_hi:[0,0]
v_pk_fma_f32 v[78:79], v[64:65], s[50:51], v[78:79] op_sel:[1,1,0] op_sel_hi:[1,0,1] neg_lo:[0,1,0] neg_hi:[0,1,0]
v_pk_add_f32 v[64:65], v[16:17], v[32:33] neg_lo:[0,1] neg_hi:[0,1]
v_pk_add_f32 v[16:17], v[16:17], v[32:33]
v_pk_add_f32 v[32:33], v[18:19], v[34:35] neg_lo:[0,1] neg_hi:[0,1]
v_pk_add_f32 v[18:19], v[18:19], v[34:35]
v_pk_mul_f32 v[34:35], v[32:33], s[54:55] op_sel:[0,0] op_sel_hi:[0,1] neg_lo:[0,0] neg_hi:[0,0]
v_pk_fma_f32 v[34:35], v[32:33], s[54:55], v[34:35] op_sel:[1,1,0] op_sel_hi:[1,0,1] neg_lo:[0,1,0] neg_hi:[0,0,0]
v_pk_add_f32 v[32:33], v[20:21], v[36:37] neg_lo:[0,1] neg_hi:[0,1]
v_pk_add_f32 v[20:21], v[20:21], v[36:37]
v_pk_mul_f32 v[36:37], v[32:33], s[62:63] op_sel:[0,0] op_sel_hi:[0,1] neg_lo:[0,0] neg_hi:[0,0]
v_pk_fma_f32 v[36:37], v[32:33], s[62:63], v[36:37] op_sel:[1,1,0] op_sel_hi:[1,0,1] neg_lo:[0,1,0] neg_hi:[0,0,0]
v_pk_add_f32 v[32:33], v[22:23], v[38:39] neg_lo:[0,1] neg_hi:[0,1]
v_pk_add_f32 v[22:23], v[22:23], v[38:39]
v_pk_mul_f32 v[38:39], v[32:33], s[54:55] op_sel:[0,1] op_sel_hi:[0,0] neg_lo:[0,0] neg_hi:[0,0]
v_pk_fma_f32 v[38:39], v[32:33], s[54:55], v[38:39] op_sel:[1,0,0] op_sel_hi:[1,1,1] neg_lo:[0,1,0] neg_hi:[0,0,0]
v_pk_add_f32 v[32:33], v[24:25], v[40:41] op_sel:[1,1] op_sel_hi:[0,0] neg_lo:[1,0] neg_hi:[0,1]
v_pk_add_f32 v[24:25], v[24:25], v[40:41]
v_pk_add_f32 v[40:41], v[26:27], v[42:43] neg_lo:[0,1] neg_hi:[0,1]
v_pk_add_f32 v[26:27], v[26:27], v[42:43]
v_pk_mul_f32 v[42:43], v[40:41], s[54:55] op_sel:[0,1] op_sel_hi:[0,0] neg_lo:[0,1] neg_hi:[0,0]
v_pk_fma_f32 v[42:43], v[40:41], s[54:55], v[42:43] op_sel:[1,0,0] op_sel_hi:[1,1,1] neg_lo:[0,1,0] neg_hi:[0,1,0]
v_pk_add_f32 v[40:41], v[28:29], v[44:45] neg_lo:[0,1] neg_hi:[0,1]
v_pk_add_f32 v[28:29], v[28:29], v[44:45]
v_pk_mul_f32 v[44:45], v[40:41], s[62:63] op_sel:[0,0] op_sel_hi:[0,1] neg_lo:[0,1] neg_hi:[0,0]
v_pk_fma_f32 v[44:45], v[40:41], s[62:63], v[44:45] op_sel:[1,1,0] op_sel_hi:[1,0,1] neg_lo:[0,1,0] neg_hi:[0,1,0]
v_pk_add_f32 v[40:41], v[30:31], v[46:47] neg_lo:[0,1] neg_hi:[0,1]
v_pk_add_f32 v[30:31], v[30:31], v[46:47]
v_pk_mul_f32 v[46:47], v[40:41], s[54:55] op_sel:[0,0] op_sel_hi:[0,1] neg_lo:[0,1] neg_hi:[0,0]
v_pk_fma_f32 v[46:47], v[40:41], s[54:55], v[46:47] op_sel:[1,1,0] op_sel_hi:[1,0,1] neg_lo:[0,1,0] neg_hi:[0,1,0]
v_pk_add_f32 v[40:41], v[14:15], v[48:49] neg_lo:[0,1] neg_hi:[0,1]
v_pk_add_f32 v[14:15], v[14:15], v[48:49]
v_pk_add_f32 v[48:49], v[50:51], v[66:67] neg_lo:[0,1] neg_hi:[0,1]
v_pk_add_f32 v[50:51], v[50:51], v[66:67]
v_pk_mul_f32 v[66:67], v[48:49], s[54:55] op_sel:[0,0] op_sel_hi:[0,1] neg_lo:[0,0] neg_hi:[0,0]
v_pk_fma_f32 v[66:67], v[48:49], s[54:55], v[66:67] op_sel:[1,1,0] op_sel_hi:[1,0,1] neg_lo:[0,1,0] neg_hi:[0,0,0]
v_pk_add_f32 v[48:49], v[52:53], v[68:69] neg_lo:[0,1] neg_hi:[0,1]
v_pk_add_f32 v[52:53], v[52:53], v[68:69]
v_pk_mul_f32 v[68:69], v[48:49], s[62:63] op_sel:[0,0] op_sel_hi:[0,1] neg_lo:[0,0] neg_hi:[0,0]
v_pk_fma_f32 v[68:69], v[48:49], s[62:63], v[68:69] op_sel:[1,1,0] op_sel_hi:[1,0,1] neg_lo:[0,1,0] neg_hi:[0,0,0]
v_pk_add_f32 v[48:49], v[54:55], v[70:71] neg_lo:[0,1] neg_hi:[0,1]
v_pk_add_f32 v[54:55], v[54:55], v[70:71]
v_pk_mul_f32 v[70:71], v[48:49], s[54:55] op_sel:[0,1] op_sel_hi:[0,0] neg_lo:[0,0] neg_hi:[0,0]
v_pk_fma_f32 v[70:71], v[48:49], s[54:55], v[70:71] op_sel:[1,0,0] op_sel_hi:[1,1,1] neg_lo:[0,1,0] neg_hi:[0,0,0]
v_pk_add_f32 v[48:49], v[56:57], v[72:73] op_sel:[1,1] op_sel_hi:[0,0] neg_lo:[1,0] neg_hi:[0,1]
v_pk_add_f32 v[56:57], v[56:57], v[72:73]
v_pk_add_f32 v[72:73], v[58:59], v[74:75] neg_lo:[0,1] neg_hi:[0,1]
v_pk_add_f32 v[58:59], v[58:59], v[74:75]
v_pk_mul_f32 v[74:75], v[72:73], s[54:55] op_sel:[0,1] op_sel_hi:[0,0] neg_lo:[0,1] neg_hi:[0,0]
v_pk_fma_f32 v[74:75], v[72:73], s[54:55], v[74:75] op_sel:[1,0,0] op_sel_hi:[1,1,1] neg_lo:[0,1,0] neg_hi:[0,1,0]
v_pk_add_f32 v[72:73], v[60:61], v[76:77] neg_lo:[0,1] neg_hi:[0,1]
v_pk_add_f32 v[60:61], v[60:61], v[76:77]
v_pk_mul_f32 v[76:77], v[72:73], s[62:63] op_sel:[0,0] op_sel_hi:[0,1] neg_lo:[0,1] neg_hi:[0,0]
v_pk_fma_f32 v[76:77], v[72:73], s[62:63], v[76:77] op_sel:[1,1,0] op_sel_hi:[1,0,1] neg_lo:[0,1,0] neg_hi:[0,1,0]
v_pk_add_f32 v[72:73], v[62:63], v[78:79] neg_lo:[0,1] neg_hi:[0,1]
v_pk_add_f32 v[62:63], v[62:63], v[78:79]
v_pk_mul_f32 v[78:79], v[72:73], s[54:55] op_sel:[0,0] op_sel_hi:[0,1] neg_lo:[0,1] neg_hi:[0,0]
v_pk_fma_f32 v[78:79], v[72:73], s[54:55], v[78:79] op_sel:[1,1,0] op_sel_hi:[1,0,1] neg_lo:[0,1,0] neg_hi:[0,1,0]
v_pk_add_f32 v[72:73], v[16:17], v[24:25] neg_lo:[0,1] neg_hi:[0,1]
v_pk_add_f32 v[16:17], v[16:17], v[24:25]
v_pk_add_f32 v[24:25], v[18:19], v[26:27] neg_lo:[0,1] neg_hi:[0,1]
v_pk_add_f32 v[18:19], v[18:19], v[26:27]
v_pk_mul_f32 v[26:27], v[24:25], s[62:63] op_sel:[0,0] op_sel_hi:[0,1] neg_lo:[0,0] neg_hi:[0,0]
v_pk_fma_f32 v[26:27], v[24:25], s[62:63], v[26:27] op_sel:[1,1,0] op_sel_hi:[1,0,1] neg_lo:[0,1,0] neg_hi:[0,0,0]
v_pk_add_f32 v[24:25], v[20:21], v[28:29] op_sel:[1,1] op_sel_hi:[0,0] neg_lo:[1,0] neg_hi:[0,1]
v_pk_add_f32 v[20:21], v[20:21], v[28:29]
v_pk_add_f32 v[28:29], v[22:23], v[30:31] neg_lo:[0,1] neg_hi:[0,1]
v_pk_add_f32 v[22:23], v[22:23], v[30:31]
v_pk_mul_f32 v[30:31], v[28:29], s[62:63] op_sel:[0,0] op_sel_hi:[0,1] neg_lo:[0,1] neg_hi:[0,0]
v_pk_fma_f32 v[30:31], v[28:29], s[62:63], v[30:31] op_sel:[1,1,0] op_sel_hi:[1,0,1] neg_lo:[0,1,0] neg_hi:[0,1,0]
v_pk_add_f32 v[28:29], v[64:65], v[32:33] neg_lo:[0,1] neg_hi:[0,1]
v_pk_add_f32 v[64:65], v[64:65], v[32:33]
v_pk_add_f32 v[32:33], v[34:35], v[42:43] neg_lo:[0,1] neg_hi:[0,1]
v_pk_add_f32 v[34:35], v[34:35], v[42:43]
v_pk_mul_f32 v[42:43], v[32:33], s[62:63] op_sel:[0,0] op_sel_hi:[0,1] neg_lo:[0,0] neg_hi:[0,0]
v_pk_fma_f32 v[42:43], v[32:33], s[62:63], v[42:43] op_sel:[1,1,0] op_sel_hi:[1,0,1] neg_lo:[0,1,0] neg_hi:[0,0,0]
v_pk_add_f32 v[32:33], v[36:37], v[44:45] op_sel:[1,1] op_sel_hi:[0,0] neg_lo:[1,0] neg_hi:[0,1]
v_pk_add_f32 v[36:37], v[36:37], v[44:45]
v_pk_add_f32 v[44:45], v[38:39], v[46:47] neg_lo:[0,1] neg_hi:[0,1]
v_pk_add_f32 v[38:39], v[38:39], v[46:47]
v_pk_mul_f32 v[46:47], v[44:45], s[62:63] op_sel:[0,0] op_sel_hi:[0,1] neg_lo:[0,1] neg_hi:[0,0]
v_pk_fma_f32 v[46:47], v[44:45], s[62:63], v[46:47] op_sel:[1,1,0] op_sel_hi:[1,0,1] neg_lo:[0,1,0] neg_hi:[0,1,0]
v_pk_add_f32 v[44:45], v[14:15], v[56:57] neg_lo:[0,1] neg_hi:[0,1]
v_pk_add_f32 v[14:15], v[14:15], v[56:57]
v_pk_add_f32 v[56:57], v[50:51], v[58:59] neg_lo:[0,1] neg_hi:[0,1]
v_pk_add_f32 v[50:51], v[50:51], v[58:59]
v_pk_mul_f32 v[58:59], v[56:57], s[62:63] op_sel:[0,0] op_sel_hi:[0,1] neg_lo:[0,0] neg_hi:[0,0]
v_pk_fma_f32 v[58:59], v[56:57], s[62:63], v[58:59] op_sel:[1,1,0] op_sel_hi:[1,0,1] neg_lo:[0,1,0] neg_hi:[0,0,0]
v_pk_add_f32 v[56:57], v[52:53], v[60:61] op_sel:[1,1] op_sel_hi:[0,0] neg_lo:[1,0] neg_hi:[0,1]
v_pk_add_f32 v[52:53], v[52:53], v[60:61]
v_pk_add_f32 v[60:61], v[54:55], v[62:63] neg_lo:[0,1] neg_hi:[0,1]
v_pk_add_f32 v[54:55], v[54:55], v[62:63]
v_pk_mul_f32 v[62:63], v[60:61], s[62:63] op_sel:[0,0] op_sel_hi:[0,1] neg_lo:[0,1] neg_hi:[0,0]
v_pk_fma_f32 v[62:63], v[60:61], s[62:63], v[62:63] op_sel:[1,1,0] op_sel_hi:[1,0,1] neg_lo:[0,1,0] neg_hi:[0,1,0]
v_pk_add_f32 v[60:61], v[40:41], v[48:49] neg_lo:[0,1] neg_hi:[0,1]
v_pk_add_f32 v[40:41], v[40:41], v[48:49]
v_pk_add_f32 v[48:49], v[66:67], v[74:75] neg_lo:[0,1] neg_hi:[0,1]
v_pk_add_f32 v[66:67], v[66:67], v[74:75]
v_pk_mul_f32 v[74:75], v[48:49], s[62:63] op_sel:[0,0] op_sel_hi:[0,1] neg_lo:[0,0] neg_hi:[0,0]
v_pk_fma_f32 v[74:75], v[48:49], s[62:63], v[74:75] op_sel:[1,1,0] op_sel_hi:[1,0,1] neg_lo:[0,1,0] neg_hi:[0,0,0]
v_pk_add_f32 v[48:49], v[68:69], v[76:77] op_sel:[1,1] op_sel_hi:[0,0] neg_lo:[1,0] neg_hi:[0,1]
v_pk_add_f32 v[68:69], v[68:69], v[76:77]
v_pk_add_f32 v[76:77], v[70:71], v[78:79] neg_lo:[0,1] neg_hi:[0,1]
v_pk_add_f32 v[70:71], v[70:71], v[78:79]
v_pk_mul_f32 v[78:79], v[76:77], s[62:63] op_sel:[0,0] op_sel_hi:[0,1] neg_lo:[0,1] neg_hi:[0,0]
v_pk_fma_f32 v[78:79], v[76:77], s[62:63], v[78:79] op_sel:[1,1,0] op_sel_hi:[1,0,1] neg_lo:[0,1,0] neg_hi:[0,1,0]
v_pk_add_f32 v[76:77], v[16:17], v[20:21] neg_lo:[0,1] neg_hi:[0,1]
v_pk_add_f32 v[16:17], v[16:17], v[20:21]
v_pk_add_f32 v[20:21], v[18:19], v[22:23] op_sel:[1,1] op_sel_hi:[0,0] neg_lo:[1,0] neg_hi:[0,1]
v_pk_add_f32 v[18:19], v[18:19], v[22:23]
v_pk_add_f32 v[22:23], v[72:73], v[24:25] neg_lo:[0,1] neg_hi:[0,1]
v_pk_add_f32 v[72:73], v[72:73], v[24:25]
v_pk_add_f32 v[24:25], v[26:27], v[30:31] op_sel:[1,1] op_sel_hi:[0,0] neg_lo:[1,0] neg_hi:[0,1]
v_pk_add_f32 v[26:27], v[26:27], v[30:31]
v_pk_add_f32 v[30:31], v[64:65], v[36:37] neg_lo:[0,1] neg_hi:[0,1]
v_pk_add_f32 v[64:65], v[64:65], v[36:37]
v_pk_add_f32 v[36:37], v[34:35], v[38:39] op_sel:[1,1] op_sel_hi:[0,0] neg_lo:[1,0] neg_hi:[0,1]
v_pk_add_f32 v[34:35], v[34:35], v[38:39]
v_pk_add_f32 v[38:39], v[28:29], v[32:33] neg_lo:[0,1] neg_hi:[0,1]
v_pk_add_f32 v[28:29], v[28:29], v[32:33]
v_pk_add_f32 v[32:33], v[42:43], v[46:47] op_sel:[1,1] op_sel_hi:[0,0] neg_lo:[1,0] neg_hi:[0,1]
v_pk_add_f32 v[42:43], v[42:43], v[46:47]
v_pk_add_f32 v[46:47], v[14:15], v[52:53] neg_lo:[0,1] neg_hi:[0,1]
v_pk_add_f32 v[14:15], v[14:15], v[52:53]
v_pk_add_f32 v[52:53], v[50:51], v[54:55] op_sel:[1,1] op_sel_hi:[0,0] neg_lo:[1,0] neg_hi:[0,1]
v_pk_add_f32 v[50:51], v[50:51], v[54:55]
v_pk_add_f32 v[54:55], v[44:45], v[56:57] neg_lo:[0,1] neg_hi:[0,1]
v_pk_add_f32 v[44:45], v[44:45], v[56:57]
v_pk_add_f32 v[56:57], v[58:59], v[62:63] op_sel:[1,1] op_sel_hi:[0,0] neg_lo:[1,0] neg_hi:[0,1]
v_pk_add_f32 v[58:59], v[58:59], v[62:63]
v_pk_add_f32 v[62:63], v[40:41], v[68:69] neg_lo:[0,1] neg_hi:[0,1]
v_pk_add_f32 v[40:41], v[40:41], v[68:69]
v_pk_add_f32 v[68:69], v[66:67], v[70:71] op_sel:[1,1] op_sel_hi:[0,0] neg_lo:[1,0] neg_hi:[0,1]
v_pk_add_f32 v[66:67], v[66:67], v[70:71]
v_pk_add_f32 v[70:71], v[60:61], v[48:49] neg_lo:[0,1] neg_hi:[0,1]
v_pk_add_f32 v[60:61], v[60:61], v[48:49]
v_pk_add_f32 v[48:49], v[74:75], v[78:79] op_sel:[1,1] op_sel_hi:[0,0] neg_lo:[1,0] neg_hi:[0,1]
v_pk_add_f32 v[74:75], v[74:75], v[78:79]
v_pk_add_f32 v[78:79], v[16:17], v[18:19] neg_lo:[0,1] neg_hi:[0,1]
v_pk_add_f32 v[16:17], v[16:17], v[18:19]
v_pk_add_f32 v[18:19], v[76:77], v[20:21] neg_lo:[0,1] neg_hi:[0,1]
v_pk_add_f32 v[76:77], v[76:77], v[20:21]
v_pk_add_f32 v[20:21], v[72:73], v[26:27] neg_lo:[0,1] neg_hi:[0,1]
v_pk_add_f32 v[72:73], v[72:73], v[26:27]
v_pk_add_f32 v[26:27], v[22:23], v[24:25] neg_lo:[0,1] neg_hi:[0,1]
v_pk_add_f32 v[22:23], v[22:23], v[24:25]
v_pk_add_f32 v[24:25], v[64:65], v[34:35] neg_lo:[0,1] neg_hi:[0,1]
v_pk_add_f32 v[64:65], v[64:65], v[34:35]
v_pk_add_f32 v[34:35], v[30:31], v[36:37] neg_lo:[0,1] neg_hi:[0,1]
v_pk_add_f32 v[30:31], v[30:31], v[36:37]
v_pk_add_f32 v[36:37], v[28:29], v[42:43] neg_lo:[0,1] neg_hi:[0,1]
v_pk_add_f32 v[28:29], v[28:29], v[42:43]
v_pk_add_f32 v[42:43], v[38:39], v[32:33] neg_lo:[0,1] neg_hi:[0,1]
v_pk_add_f32 v[38:39], v[38:39], v[32:33]
v_pk_add_f32 v[32:33], v[14:15], v[50:51] neg_lo:[0,1] neg_hi:[0,1]
v_pk_add_f32 v[14:15], v[14:15], v[50:51]
v_pk_add_f32 v[50:51], v[46:47], v[52:53] neg_lo:[0,1] neg_hi:[0,1]
v_pk_add_f32 v[46:47], v[46:47], v[52:53]
v_pk_add_f32 v[52:53], v[44:45], v[58:59] neg_lo:[0,1] neg_hi:[0,1]
v_pk_add_f32 v[44:45], v[44:45], v[58:59]
v_pk_add_f32 v[58:59], v[54:55], v[56:57] neg_lo:[0,1] neg_hi:[0,1]
v_pk_add_f32 v[54:55], v[54:55], v[56:57]
v_pk_add_f32 v[56:57], v[40:41], v[66:67] neg_lo:[0,1] neg_hi:[0,1]
v_pk_add_f32 v[40:41], v[40:41], v[66:67]
v_pk_add_f32 v[66:67], v[62:63], v[68:69] neg_lo:[0,1] neg_hi:[0,1]
v_pk_add_f32 v[62:63], v[62:63], v[68:69]
v_pk_add_f32 v[68:69], v[60:61], v[74:75] neg_lo:[0,1] neg_hi:[0,1]
v_pk_add_f32 v[60:61], v[60:61], v[74:75]
v_pk_add_f32 v[74:75], v[70:71], v[48:49] neg_lo:[0,1] neg_hi:[0,1]
v_pk_add_f32 v[70:71], v[70:71], v[48:49]
s_lshl_b32 s12, s38, 2
s_add_u32 s12, s12, s16
s_min_u32 s12, s12, 512
s_lshr_b32 s23, s12, 6
s_xnor_b32 s23, s23, s98
s_and_b32 s23, s23, 1
s_lshl_b32 s23, s23, 13
s_mul_i32 s12, s12, 32768
s_add_u32 s12, s12, 113246208
s_add_u32 s12, s12, s23
buffer_store_dwordx2 v[16:17], v5, s[84:87], s12 offen offset:0 sc1
buffer_store_dwordx2 v[14:15], v5, s[84:87], s12 offen offset:512 sc1
buffer_store_dwordx2 v[64:65], v5, s[84:87], s12 offen offset:1024 sc1
buffer_store_dwordx2 v[40:41], v5, s[84:87], s12 offen offset:1536 sc1
buffer_store_dwordx2 v[72:73], v5, s[84:87], s12 offen offset:2048 sc1
buffer_store_dwordx2 v[44:45], v5, s[84:87], s12 offen offset:2560 sc1
buffer_store_dwordx2 v[28:29], v5, s[84:87], s12 offen offset:3072 sc1
buffer_store_dwordx2 v[60:61], v5, s[84:87], s12 offen offset:3584 sc1
s_add_u32 s12, s12, 4096
buffer_store_dwordx2 v[76:77], v5, s[84:87], s12 offen offset:0 sc1
buffer_store_dwordx2 v[46:47], v5, s[84:87], s12 offen offset:512 sc1
buffer_store_dwordx2 v[30:31], v5, s[84:87], s12 offen offset:1024 sc1
buffer_store_dwordx2 v[62:63], v5, s[84:87], s12 offen offset:1536 sc1
buffer_store_dwordx2 v[22:23], v5, s[84:87], s12 offen offset:2048 sc1
buffer_store_dwordx2 v[54:55], v5, s[84:87], s12 offen offset:2560 sc1
buffer_store_dwordx2 v[38:39], v5, s[84:87], s12 offen offset:3072 sc1
buffer_store_dwordx2 v[70:71], v5, s[84:87], s12 offen offset:3584 sc1
s_add_u32 s12, s12, 12288
buffer_store_dwordx2 v[78:79], v5, s[84:87], s12 offen offset:0 sc1
buffer_store_dwordx2 v[32:33], v5, s[84:87], s12 offen offset:512 sc1
buffer_store_dwordx2 v[24:25], v5, s[84:87], s12 offen offset:1024 sc1
buffer_store_dwordx2 v[56:57], v5, s[84:87], s12 offen offset:1536 sc1
buffer_store_dwordx2 v[20:21], v5, s[84:87], s12 offen offset:2048 sc1
buffer_store_dwordx2 v[52:53], v5, s[84:87], s12 offen offset:2560 sc1
buffer_store_dwordx2 v[36:37], v5, s[84:87], s12 offen offset:3072 sc1
buffer_store_dwordx2 v[68:69], v5, s[84:87], s12 offen offset:3584 sc1
s_add_u32 s12, s12, 4096
buffer_store_dwordx2 v[18:19], v5, s[84:87], s12 offen offset:0 sc1
buffer_store_dwordx2 v[50:51], v5, s[84:87], s12 offen offset:512 sc1
buffer_store_dwordx2 v[34:35], v5, s[84:87], s12 offen offset:1024 sc1
buffer_store_dwordx2 v[66:67], v5, s[84:87], s12 offen offset:1536 sc1
buffer_store_dwordx2 v[26:27], v5, s[84:87], s12 offen offset:2048 sc1
buffer_store_dwordx2 v[58:59], v5, s[84:87], s12 offen offset:2560 sc1
buffer_store_dwordx2 v[42:43], v5, s[84:87], s12 offen offset:3072 sc1
buffer_store_dwordx2 v[74:75], v5, s[84:87], s12 offen offset:3584 sc1
s_add_u32 s12, s12, 4096
s_mov_b32 s38, s21
s_cmp_lt_u32 s38, s37
s_cbranch_scc1 mega_kernel_f2_l
mega_kernel_f2_e:
mega_kernel_f2e:
s_waitcnt vmcnt(0)
s_barrier
v_mov_b32 v1, 0
v_mov_b32 v2, 1
s_mov_b32 s82, 69259392
v_cmp_eq_u32 vcc, 0, v0
s_and_saveexec_b64 s[80:81], vcc
s_cbranch_execz mega_kernel_sg1
buffer_atomic_add v2, v1, s[84:87], s82 offen sc1
mega_kernel_sg1:
s_mov_b64 exec, s[80:81]
s_mov_b32 s64, 0
s_mov_b32 s65, 58
s_lshl_b32 s66, s40, 13
s_add_u32 s66, s66, 67633152
s_mov_b32 s67, 0
s_mov_b32 s68, 0
s_cmp_eq_u32 s91, 3
s_cbranch_scc1 mega_kernel_out
s_cmp_lt_u32 s92, 1
s_cbranch_scc1 mega_kernel_back
s_mov_b32 s68, 1
s_branch mega_kernel_out
mega_kernel_back:
s_lshl_b32 s68, s68, 1
s_mov_b32 s93, s92
s_load_dwordx2 s[4:5], s[0:1], 80
s_mov_b32 s48, 0x3f7ec46d
s_mov_b32 s49, 0x3dc8bd36
s_mov_b32 s50, 0x3f7b14be
s_mov_b32 s51, 0x3e47c5c2
s_mov_b32 s52, 0x3f74fa0b
s_mov_b32 s53, 0x3e94a031
s_mov_b32 s54, 0x3f6c835e
s_mov_b32 s55, 0x3ec3ef15
s_mov_b32 s56, 0x3f61c598
s_mov_b32 s57, 0x3ef15aea
s_mov_b32 s58, 0x3f54db31
s_mov_b32 s59, 0x3f0e39da
s_mov_b32 s60, 0x3f45e403
s_mov_b32 s61, 0x3f226799
s_mov_b32 s62, 0x3f3504f3
s_mov_b32 s63, 0x3f3504f3
v_and_b32 v1, 31, v0
v_lshrrev_b32 v2, 5, v0
v_cvt_f32_u32 v3, v1
v_mul_u32_u24 v10, 8448, v2
v_lshl_add_u32 v4, v1, 3, v10
v_mul_u32_u24 v5, 264, v1
v_add_u32 v5, v5, v10
v_and_b32 v11, 7, v0
v_lshrrev_b32 v9, 3, v0
v_mul_u32_u24 v10, 8448, v11
v_lshl_add_u32 v6, v9, 3, v10
v_lshlrev_b32 v7, 3, v9
v_sub_u32 v7, v10, v7
v_add_u32 v7, 4096, v7
v_mul_u32_u24 v8, 32768, v9
v_lshl_add_u32 v8, v11, 4, v8
v_mul_f32 v12, 0x3a800000, v3
v_cos_f32 v82, v12
v_sin_f32 v83, v12
v_mul_f32 v12, 0x3b000000, v3
v_cos_f32 v84, v12
v_sin_f32 v85, v12
v_mul_f32 v12, 0x3b400000, v3
v_cos_f32 v86, v12
v_sin_f32 v87, v12
v_mul_f32 v12, 0x3b800000, v3
v_cos_f32 v88, v12
v_sin_f32 v89, v12
v_mul_f32 v12, 0x3ba00000, v3
v_cos_f32 v90, v12
v_sin_f32 v91, v12
v_mul_f32 v12, 0x3bc00000, v3
v_cos_f32 v92, v12
v_sin_f32 v93, v12
v_mul_f32 v12, 0x3be00000, v3
v_cos_f32 v94, v12
v_sin_f32 v95, v12
v_mul_f32 v12, 0x3c000000, v3
v_cos_f32 v96, v12
v_sin_f32 v97, v12
v_mul_f32 v12, 0x3c100000, v3
v_cos_f32 v98, v12
v_sin_f32 v99, v12
v_mul_f32 v12, 0x3c200000, v3
v_cos_f32 v100, v12
v_sin_f32 v101, v12
v_mul_f32 v12, 0x3c300000, v3
v_cos_f32 v102, v12
v_sin_f32 v103, v12
v_mul_f32 v12, 0x3c400000, v3
v_cos_f32 v104, v12
v_sin_f32 v105, v12
v_mul_f32 v12, 0x3c500000, v3
v_cos_f32 v106, v12
v_sin_f32 v107, v12
v_mul_f32 v12, 0x3c600000, v3
v_cos_f32 v108, v12
v_sin_f32 v109, v12
v_mul_f32 v12, 0x3c700000, v3
v_cos_f32 v110, v12
v_sin_f32 v111, v12
v_mul_f32 v12, 0x3c800000, v3
v_cos_f32 v112, v12
v_sin_f32 v113, v12
v_mul_f32 v12, 0x3c880000, v3
v_cos_f32 v114, v12
v_sin_f32 v115, v12
v_mul_f32 v12, 0x3c900000, v3
v_cos_f32 v116, v12
v_sin_f32 v117, v12
v_mul_f32 v12, 0x3c980000, v3
v_cos_f32 v118, v12
v_sin_f32 v119, v12
v_mul_f32 v12, 0x3ca00000, v3
v_cos_f32 v120, v12
v_sin_f32 v121, v12
v_mul_f32 v12, 0x3ca80000, v3
v_cos_f32 v122, v12
v_sin_f32 v123, v12
v_mul_f32 v12, 0x3cb00000, v3
v_cos_f32 v124, v12
v_sin_f32 v125, v12
v_mul_f32 v12, 0x3cb80000, v3
v_cos_f32 v126, v12
v_sin_f32 v127, v12
v_mul_f32 v12, 0x3cc00000, v3
v_cos_f32 v128, v12
v_sin_f32 v129, v12
v_mul_f32 v12, 0x3cc80000, v3
v_cos_f32 v130, v12
v_sin_f32 v131, v12
v_mul_f32 v12, 0x3cd00000, v3
v_cos_f32 v132, v12
v_sin_f32 v133, v12
v_mul_f32 v12, 0x3cd80000, v3
v_cos_f32 v134, v12
v_sin_f32 v135, v12
v_mul_f32 v12, 0x3ce00000, v3
v_cos_f32 v136, v12
v_sin_f32 v137, v12
v_mul_f32 v12, 0x3ce80000, v3
v_cos_f32 v138, v12
v_sin_f32 v139, v12
v_mul_f32 v12, 0x3cf00000, v3
v_cos_f32 v140, v12
v_sin_f32 v141, v12
v_mul_f32 v12, 0x3cf80000, v3
v_cos_f32 v142, v12
v_sin_f32 v143, v12
v_lshlrev_b32 v12, 2, v1
v_sub_u32 v12, v4, v12
v_and_b32 v10, 127, v0
v_lshrrev_b32 v11, 7, v0
v_lshlrev_b32 v2, 5, v10
v_lshl_add_u32 v2, v11, 12, v2
v_lshlrev_b32 v3, 4, v10
v_lshl_add_u32 v3, v11, 12, v3
v_add_u32 v3, 2048, v3
v_cmp_eq_u32 s[14:15], 0, v9
s_waitcnt lgkmcnt(0)
s_mov_b32 s6, 8388608
s_mov_b32 s7, 0x00020000
v_mov_b32 v250, 0
s_mov_b32 s82, 69259392
mega_kernel_w1:
s_sleep 8
buffer_load_dword v251, v250, s[84:87], s82 offen sc1
s_waitcnt vmcnt(0)
v_cmp_ne_u32 vcc, 95, v251
s_cbranch_vccnz mega_kernel_w1
s_cmp_lt_u32 s93, 128
s_cbranch_scc0 mega_kernel_f3_e
s_lshl_b32 s12, s93, 7
s_and_b32 s23, s12, 0x2000
s_add_u32 s12, s12, s23
s_xor_b32 s23, s98, 1
s_lshl_b32 s23, s23, 13
s_add_u32 s12, s12, s23
s_add_u32 s12, s12, 113246208
buffer_load_dwordx4 v[144:147], v8, s[84:87], s12 offen sc1
s_add_u32 s12, s12, 1048576
buffer_load_dwordx4 v[148:151], v8, s[84:87], s12 offen sc1
s_add_u32 s12, s12, 1048576
s_xor_b32 s12, s12, 0x2000
buffer_load_dwordx4 v[152:155], v8, s[84:87], s12 offen sc1
s_add_u32 s12, s12, 1048576
buffer_load_dwordx4 v[156:159], v8, s[84:87], s12 offen sc1
s_add_u32 s12, s12, 1048576
s_xor_b32 s12, s12, 0x2000
buffer_load_dwordx4 v[160:163], v8, s[84:87], s12 offen sc1
s_add_u32 s12, s12, 1048576
buffer_load_dwordx4 v[164:167], v8, s[84:87], s12 offen sc1
s_add_u32 s12, s12, 1048576
s_xor_b32 s12, s12, 0x2000
buffer_load_dwordx4 v[168:171], v8, s[84:87], s12 offen sc1
s_add_u32 s12, s12, 1048576
buffer_load_dwordx4 v[172:175], v8, s[84:87], s12 offen sc1
s_add_u32 s12, s12, 1048576
s_xor_b32 s12, s12, 0x2000
buffer_load_dwordx4 v[176:179], v8, s[84:87], s12 offen sc1
s_add_u32 s12, s12, 1048576
buffer_load_dwordx4 v[180:183], v8, s[84:87], s12 offen sc1
s_add_u32 s12, s12, 1048576
s_xor_b32 s12, s12, 0x2000
buffer_load_dwordx4 v[184:187], v8, s[84:87], s12 offen sc1
s_add_u32 s12, s12, 1048576
buffer_load_dwordx4 v[188:191], v8, s[84:87], s12 offen sc1
s_add_u32 s12, s12, 1048576
s_xor_b32 s12, s12, 0x2000
buffer_load_dwordx4 v[192:195], v8, s[84:87], s12 offen sc1
s_add_u32 s12, s12, 1048576
buffer_load_dwordx4 v[196:199], v8, s[84:87], s12 offen sc1
s_add_u32 s12, s12, 1048576
s_xor_b32 s12, s12, 0x2000
buffer_load_dwordx4 v[200:203], v8, s[84:87], s12 offen sc1
s_add_u32 s12, s12, 1048576
buffer_load_dwordx4 v[204:207], v8, s[84:87], s12 offen sc1
s_add_u32 s12, s12, 1048576
s_xor_b32 s12, s12, 0x2000
buffer_load_dwordx4 v[208:211], v8, s[84:87], s12 offen sc1
s_add_u32 s12, s12, 1048576
s_waitcnt vmcnt(0)
mega_kernel_f3_l:
s_add_u32 s21, s93, 64
s_cmp_lt_u32 s21, 128
s_cselect_b32 s22, s21, s93
s_waitcnt vmcnt(8)
s_barrier
v_cndmask_b32 v145, v145, 0, s[14:15]
v_cndmask_b32 v147, v147, 0, s[14:15]
v_cndmask_b32 v209, v209, 0, s[14:15]
v_cndmask_b32 v211, v211, 0, s[14:15]
v_pk_add_f32 v[16:17], v[144:145], v[146:147] op_sel:[0,1] op_sel_hi:[1,0] neg_lo:[0,1]
v_pk_add_f32 v[18:19], v[144:145], v[146:147] op_sel:[0,1] op_sel_hi:[1,0] neg_hi:[1,0]
ds_write_b64 v6, v[16:17] offset:0
ds_write_b64 v7, v[18:19] offset:4096
v_pk_add_f32 v[20:21], v[148:149], v[150:151] op_sel:[0,1] op_sel_hi:[1,0] neg_lo:[0,1]
v_pk_add_f32 v[22:23], v[148:149], v[150:151] op_sel:[0,1] op_sel_hi:[1,0] neg_hi:[1,0]
ds_write_b64 v6, v[20:21] offset:256
ds_write_b64 v7, v[22:23] offset:3840
v_pk_add_f32 v[24:25], v[152:153], v[154:155] op_sel:[0,1] op_sel_hi:[1,0] neg_lo:[0,1]
v_pk_add_f32 v[26:27], v[152:153], v[154:155] op_sel:[0,1] op_sel_hi:[1,0] neg_hi:[1,0]
ds_write_b64 v6, v[24:25] offset:512
ds_write_b64 v7, v[26:27] offset:3584
v_pk_add_f32 v[28:29], v[156:157], v[158:159] op_sel:[0,1] op_sel_hi:[1,0] neg_lo:[0,1]
v_pk_add_f32 v[30:31], v[156:157], v[158:159] op_sel:[0,1] op_sel_hi:[1,0] neg_hi:[1,0]
ds_write_b64 v6, v[28:29] offset:768
ds_write_b64 v7, v[30:31] offset:3328
v_pk_add_f32 v[32:33], v[160:161], v[162:163] op_sel:[0,1] op_sel_hi:[1,0] neg_lo:[0,1]
v_pk_add_f32 v[34:35], v[160:161], v[162:163] op_sel:[0,1] op_sel_hi:[1,0] neg_hi:[1,0]
ds_write_b64 v6, v[32:33] offset:1024
ds_write_b64 v7, v[34:35] offset:3072
v_pk_add_f32 v[36:37], v[164:165], v[166:167] op_sel:[0,1] op_sel_hi:[1,0] neg_lo:[0,1]
v_pk_add_f32 v[38:39], v[164:165], v[166:167] op_sel:[0,1] op_sel_hi:[1,0] neg_hi:[1,0]
ds_write_b64 v6, v[36:37] offset:1280
ds_write_b64 v7, v[38:39] offset:2816
v_pk_add_f32 v[40:41], v[168:169], v[170:171] op_sel:[0,1] op_sel_hi:[1,0] neg_lo:[0,1]
v_pk_add_f32 v[42:43], v[168:169], v[170:171] op_sel:[0,1] op_sel_hi:[1,0] neg_hi:[1,0]
ds_write_b64 v6, v[40:41] offset:1536
ds_write_b64 v7, v[42:43] offset:2560
v_pk_add_f32 v[44:45], v[172:173], v[174:175] op_sel:[0,1] op_sel_hi:[1,0] neg_lo:[0,1]
v_pk_add_f32 v[46:47], v[172:173], v[174:175] op_sel:[0,1] op_sel_hi:[1,0] neg_hi:[1,0]
ds_write_b64 v6, v[44:45] offset:1792
ds_write_b64 v7, v[46:47] offset:2304
v_pk_add_f32 v[48:49], v[176:177], v[178:179] op_sel:[0,1] op_sel_hi:[1,0] neg_lo:[0,1]
v_pk_add_f32 v[50:51], v[176:177], v[178:179] op_sel:[0,1] op_sel_hi:[1,0] neg_hi:[1,0]
ds_write_b64 v6, v[48:49] offset:2048
ds_write_b64 v7, v[50:51] offset:2048
v_pk_add_f32 v[52:53], v[180:181], v[182:183] op_sel:[0,1] op_sel_hi:[1,0] neg_lo:[0,1]
v_pk_add_f32 v[54:55], v[180:181], v[182:183] op_sel:[0,1] op_sel_hi:[1,0] neg_hi:[1,0]
ds_write_b64 v6, v[52:53] offset:2304
ds_write_b64 v7, v[54:55] offset:1792
v_pk_add_f32 v[56:57], v[184:185], v[186:187] op_sel:[0,1] op_sel_hi:[1,0] neg_lo:[0,1]
v_pk_add_f32 v[58:59], v[184:185], v[186:187] op_sel:[0,1] op_sel_hi:[1,0] neg_hi:[1,0]
ds_write_b64 v6, v[56:57] offset:2560
ds_write_b64 v7, v[58:59] offset:1536
v_pk_add_f32 v[60:61], v[188:189], v[190:191] op_sel:[0,1] op_sel_hi:[1,0] neg_lo:[0,1]
v_pk_add_f32 v[62:63], v[188:189], v[190:191] op_sel:[0,1] op_sel_hi:[1,0] neg_hi:[1,0]
ds_write_b64 v6, v[60:61] offset:2816
ds_write_b64 v7, v[62:63] offset:1280
v_pk_add_f32 v[64:65], v[192:193], v[194:195] op_sel:[0,1] op_sel_hi:[1,0] neg_lo:[0,1]
v_pk_add_f32 v[66:67], v[192:193], v[194:195] op_sel:[0,1] op_sel_hi:[1,0] neg_hi:[1,0]
ds_write_b64 v6, v[64:65] offset:3072
ds_write_b64 v7, v[66:67] offset:1024
v_pk_add_f32 v[68:69], v[196:197], v[198:199] op_sel:[0,1] op_sel_hi:[1,0] neg_lo:[0,1]
v_pk_add_f32 v[70:71], v[196:197], v[198:199] op_sel:[0,1] op_sel_hi:[1,0] neg_hi:[1,0]
ds_write_b64 v6, v[68:69] offset:3328
ds_write_b64 v7, v[70:71] offset:768
v_pk_add_f32 v[72:73], v[200:201], v[202:203] op_sel:[0,1] op_sel_hi:[1,0] neg_lo:[0,1]
v_pk_add_f32 v[74:75], v[200:201], v[202:203] op_sel:[0,1] op_sel_hi:[1,0] neg_hi:[1,0]
ds_write_b64 v6, v[72:73] offset:3584
ds_write_b64 v7, v[74:75] offset:512
s_waitcnt lgkmcnt(8)
v_pk_add_f32 v[76:77], v[204:205], v[206:207] op_sel:[0,1] op_sel_hi:[1,0] neg_lo:[0,1]
v_pk_add_f32 v[78:79], v[204:205], v[206:207] op_sel:[0,1] op_sel_hi:[1,0] neg_hi:[1,0]
ds_write_b64 v6, v[76:77] offset:3840
ds_write_b64 v7, v[78:79] offset:256
v_pk_add_f32 v[16:17], v[208:209], v[210:211] op_sel:[0,1] op_sel_hi:[1,0] neg_lo:[0,1]
v_pk_add_f32 v[18:19], v[208:209], v[210:211] op_sel:[0,1] op_sel_hi:[1,0] neg_hi:[1,0]
s_mov_b64 exec, s[14:15]
ds_write_b64 v6, v[16:17] offset:4096
s_mov_b64 exec, -1
s_lshl_b32 s12, s22, 7
s_and_b32 s23, s12, 0x2000
s_add_u32 s12, s12, s23
s_xor_b32 s23, s98, 1
s_lshl_b32 s23, s23, 13
s_add_u32 s12, s12, s23
s_add_u32 s12, s12, 113246208
buffer_load_dwordx4 v[144:147], v8, s[84:87], s12 offen sc1
s_add_u32 s12, s12, 1048576
buffer_load_dwordx4 v[148:151], v8, s[84:87], s12 offen sc1
s_add_u32 s12, s12, 1048576
s_xor_b32 s12, s12, 0x2000
buffer_load_dwordx4 v[152:155], v8, s[84:87], s12 offen sc1
s_add_u32 s12, s12, 1048576
buffer_load_dwordx4 v[156:159], v8, s[84:87], s12 offen sc1
s_add_u32 s12, s12, 1048576
s_xor_b32 s12, s12, 0x2000
buffer_load_dwordx4 v[160:163], v8, s[84:87], s12 offen sc1
s_add_u32 s12, s12, 1048576
buffer_load_dwordx4 v[164:167], v8, s[84:87], s12 offen sc1
s_add_u32 s12, s12, 1048576
s_xor_b32 s12, s12, 0x2000
buffer_load_dwordx4 v[168:171], v8, s[84:87], s12 offen sc1
s_add_u32 s12, s12, 1048576
buffer_load_dwordx4 v[172:175], v8, s[84:87], s12 offen sc1
s_add_u32 s12, s12, 1048576
s_xor_b32 s12, s12, 0x2000
buffer_load_dwordx4 v[176:179], v8, s[84:87], s12 offen sc1
s_add_u32 s12, s12, 1048576
buffer_load_dwordx4 v[180:183], v8, s[84:87], s12 offen sc1
s_add_u32 s12, s12, 1048576
s_xor_b32 s12, s12, 0x2000
buffer_load_dwordx4 v[184:187], v8, s[84:87], s12 offen sc1
s_add_u32 s12, s12, 1048576
buffer_load_dwordx4 v[188:191], v8, s[84:87], s12 offen sc1
s_add_u32 s12, s12, 1048576
s_xor_b32 s12, s12, 0x2000
buffer_load_dwordx4 v[192:195], v8, s[84:87], s12 offen sc1
s_add_u32 s12, s12, 1048576
buffer_load_dwordx4 v[196:199], v8, s[84:87], s12 offen sc1
s_add_u32 s12, s12, 1048576
s_xor_b32 s12, s12, 0x2000
buffer_load_dwordx4 v[200:203], v8, s[84:87], s12 offen sc1
s_add_u32 s12, s12, 1048576
buffer_load_dwordx4 v[204:207], v8, s[84:87], s12 offen sc1
s_add_u32 s12, s12, 1048576
s_xor_b32 s12, s12, 0x2000
buffer_load_dwordx4 v[208:211], v8, s[84:87], s12 offen sc1
s_add_u32 s12, s12, 1048576
s_waitcnt lgkmcnt(0)
s_barrier
ds_read_b64 v[16:17], v4 offset:0
ds_read_b64 v[48:49], v4 offset:4096
ds_read_b64 v[18:19], v4 offset:256
ds_read_b64 v[50:51], v4 offset:4352
ds_read_b64 v[20:21], v4 offset:512
ds_read_b64 v[52:53], v4 offset:4608
ds_read_b64 v[22:23], v4 offset:768
ds_read_b64 v[54:55], v4 offset:4864
ds_read_b64 v[24:25], v4 offset:1024
ds_read_b64 v[56:57], v4 offset:5120
ds_read_b64 v[26:27], v4 offset:1280
ds_read_b64 v[58:59], v4 offset:5376
ds_read_b64 v[28:29], v4 offset:1536
ds_read_b64 v[60:61], v4 offset:5632
ds_read_b64 v[30:31], v4 offset:1792
ds_read_b64 v[62:63], v4 offset:5888
ds_read_b64 v[32:33], v4 offset:2048
ds_read_b64 v[64:65], v4 offset:6144
ds_read_b64 v[34:35], v4 offset:2304
ds_read_b64 v[66:67], v4 offset:6400
ds_read_b64 v[36:37], v4 offset:2560
ds_read_b64 v[68:69], v4 offset:6656
ds_read_b64 v[38:39], v4 offset:2816
ds_read_b64 v[70:71], v4 offset:6912
ds_read_b64 v[40:41], v4 offset:3072
ds_read_b64 v[72:73], v4 offset:7168
ds_read_b64 v[42:43], v4 offset:3328
ds_read_b64 v[74:75], v4 offset:7424
ds_read_b64 v[44:45], v4 offset:3584
ds_read_b64 v[76:77], v4 offset:7680
ds_read_b64 v[46:47], v4 offset:3840
ds_read_b64 v[78:79], v4 offset:7936
s_waitcnt lgkmcnt(0)
v_pk_add_f32 v[14:15], v[16:17], v[48:49] neg_lo:[0,1] neg_hi:[0,1]
v_pk_add_f32 v[16:17], v[16:17], v[48:49]
v_pk_add_f32 v[48:49], v[18:19], v[50:51] neg_lo:[0,1] neg_hi:[0,1]
v_pk_add_f32 v[18:19], v[18:19], v[50:51]
v_pk_mul_f32 v[50:51], v[48:49], s[50:51] op_sel:[0,0] op_sel_hi:[0,1] neg_lo:[0,0] neg_hi:[0,0]
v_pk_fma_f32 v[50:51], v[48:49], s[50:51], v[50:51] op_sel:[1,1,0] op_sel_hi:[1,0,1] neg_lo:[0,1,0] neg_hi:[0,0,0]
v_pk_add_f32 v[48:49], v[20:21], v[52:53] neg_lo:[0,1] neg_hi:[0,1]
v_pk_add_f32 v[20:21], v[20:21], v[52:53]
v_pk_mul_f32 v[52:53], v[48:49], s[54:55] op_sel:[0,0] op_sel_hi:[0,1] neg_lo:[0,0] neg_hi:[0,0]
v_pk_fma_f32 v[52:53], v[48:49], s[54:55], v[52:53] op_sel:[1,1,0] op_sel_hi:[1,0,1] neg_lo:[0,1,0] neg_hi:[0,0,0]
v_pk_add_f32 v[48:49], v[22:23], v[54:55] neg_lo:[0,1] neg_hi:[0,1]
v_pk_add_f32 v[22:23], v[22:23], v[54:55]
v_pk_mul_f32 v[54:55], v[48:49], s[58:59] op_sel:[0,0] op_sel_hi:[0,1] neg_lo:[0,0] neg_hi:[0,0]
v_pk_fma_f32 v[54:55], v[48:49], s[58:59], v[54:55] op_sel:[1,1,0] op_sel_hi:[1,0,1] neg_lo:[0,1,0] neg_hi:[0,0,0]
v_pk_add_f32 v[48:49], v[24:25], v[56:57] neg_lo:[0,1] neg_hi:[0,1]
v_pk_add_f32 v[24:25], v[24:25], v[56:57]
v_pk_mul_f32 v[56:57], v[48:49], s[62:63] op_sel:[0,0] op_sel_hi:[0,1] neg_lo:[0,0] neg_hi:[0,0]
v_pk_fma_f32 v[56:57], v[48:49], s[62:63], v[56:57] op_sel:[1,1,0] op_sel_hi:[1,0,1] neg_lo:[0,1,0] neg_hi:[0,0,0]
v_pk_add_f32 v[48:49], v[26:27], v[58:59] neg_lo:[0,1] neg_hi:[0,1]
v_pk_add_f32 v[26:27], v[26:27], v[58:59]
v_pk_mul_f32 v[58:59], v[48:49], s[58:59] op_sel:[0,1] op_sel_hi:[0,0] neg_lo:[0,0] neg_hi:[0,0]
v_pk_fma_f32 v[58:59], v[48:49], s[58:59], v[58:59] op_sel:[1,0,0] op_sel_hi:[1,1,1] neg_lo:[0,1,0] neg_hi:[0,0,0]
v_pk_add_f32 v[48:49], v[28:29], v[60:61] neg_lo:[0,1] neg_hi:[0,1]
v_pk_add_f32 v[28:29], v[28:29], v[60:61]
v_pk_mul_f32 v[60:61], v[48:49], s[54:55] op_sel:[0,1] op_sel_hi:[0,0] neg_lo:[0,0] neg_hi:[0,0]
v_pk_fma_f32 v[60:61], v[48:49], s[54:55], v[60:61] op_sel:[1,0,0] op_sel_hi:[1,1,1] neg_lo:[0,1,0] neg_hi:[0,0,0]
v_pk_add_f32 v[48:49], v[30:31], v[62:63] neg_lo:[0,1] neg_hi:[0,1]
v_pk_add_f32 v[30:31], v[30:31], v[62:63]
v_pk_mul_f32 v[62:63], v[48:49], s[50:51] op_sel:[0,1] op_sel_hi:[0,0] neg_lo:[0,0] neg_hi:[0,0]
v_pk_fma_f32 v[62:63], v[48:49], s[50:51], v[62:63] op_sel:[1,0,0] op_sel_hi:[1,1,1] neg_lo:[0,1,0] neg_hi:[0,0,0]
v_pk_add_f32 v[48:49], v[32:33], v[64:65] op_sel:[1,1] op_sel_hi:[0,0] neg_lo:[1,0] neg_hi:[0,1]
v_pk_add_f32 v[32:33], v[32:33], v[64:65]
v_pk_add_f32 v[64:65], v[34:35], v[66:67] neg_lo:[0,1] neg_hi:[0,1]
v_pk_add_f32 v[34:35], v[34:35], v[66:67]
v_pk_mul_f32 v[66:67], v[64:65], s[50:51] op_sel:[0,1] op_sel_hi:[0,0] neg_lo:[0,1] neg_hi:[0,0]
v_pk_fma_f32 v[66:67], v[64:65], s[50:51], v[66:67] op_sel:[1,0,0] op_sel_hi:[1,1,1] neg_lo:[0,1,0] neg_hi:[0,1,0]
v_pk_add_f32 v[64:65], v[36:37], v[68:69] neg_lo:[0,1] neg_hi:[0,1]
v_pk_add_f32 v[36:37], v[36:37], v[68:69]
v_pk_mul_f32 v[68:69], v[64:65], s[54:55] op_sel:[0,1] op_sel_hi:[0,0] neg_lo:[0,1] neg_hi:[0,0]
v_pk_fma_f32 v[68:69], v[64:65], s[54:55], v[68:69] op_sel:[1,0,0] op_sel_hi:[1,1,1] neg_lo:[0,1,0] neg_hi:[0,1,0]
v_pk_add_f32 v[64:65], v[38:39], v[70:71] neg_lo:[0,1] neg_hi:[0,1]
v_pk_add_f32 v[38:39], v[38:39], v[70:71]
v_pk_mul_f32 v[70:71], v[64:65], s[58:59] op_sel:[0,1] op_sel_hi:[0,0] neg_lo:[0,1] neg_hi:[0,0]
v_pk_fma_f32 v[70:71], v[64:65], s[58:59], v[70:71] op_sel:[1,0,0] op_sel_hi:[1,1,1] neg_lo:[0,1,0] neg_hi:[0,1,0]
v_pk_add_f32 v[64:65], v[40:41], v[72:73] neg_lo:[0,1] neg_hi:[0,1]
v_pk_add_f32 v[40:41], v[40:41], v[72:73]
v_pk_mul_f32 v[72:73], v[64:65], s[62:63] op_sel:[0,0] op_sel_hi:[0,1] neg_lo:[0,1] neg_hi:[0,0]
v_pk_fma_f32 v[72:73], v[64:65], s[62:63], v[72:73] op_sel:[1,1,0] op_sel_hi:[1,0,1] neg_lo:[0,1,0] neg_hi:[0,1,0]
v_pk_add_f32 v[64:65], v[42:43], v[74:75] neg_lo:[0,1] neg_hi:[0,1]
v_pk_add_f32 v[42:43], v[42:43], v[74:75]
v_pk_mul_f32 v[74:75], v[64:65], s[58:59] op_sel:[0,0] op_sel_hi:[0,1] neg_lo:[0,1] neg_hi:[0,0]
v_pk_fma_f32 v[74:75], v[64:65], s[58:59], v[74:75] op_sel:[1,1,0] op_sel_hi:[1,0,1] neg_lo:[0,1,0] neg_hi:[0,1,0]
v_pk_add_f32 v[64:65], v[44:45], v[76:77] neg_lo:[0,1] neg_hi:[0,1]
v_pk_add_f32 v[44:45], v[44:45], v[76:77]
v_pk_mul_f32 v[76:77], v[64:65], s[54:55] op_sel:[0,0] op_sel_hi:[0,1] neg_lo:[0,1] neg_hi:[0,0]
v_pk_fma_f32 v[76:77], v[64:65], s[54:55], v[76:77] op_sel:[1,1,0] op_sel_hi:[1,0,1] neg_lo:[0,1,0] neg_hi:[0,1,0]
v_pk_add_f32 v[64:65], v[46:47], v[78:79] neg_lo:[0,1] neg_hi:[0,1]
v_pk_add_f32 v[46:47], v[46:47], v[78:79]
v_pk_mul_f32 v[78:79], v[64:65], s[50:51] op_sel:[0,0] op_sel_hi:[0,1] neg_lo:[0,1] neg_hi:[0,0]
v_pk_fma_f32 v[78:79], v[64:65], s[50:51], v[78:79] op_sel:[1,1,0] op_sel_hi:[1,0,1] neg_lo:[0,1,0] neg_hi:[0,1,0]
v_pk_add_f32 v[64:65], v[16:17], v[32:33] neg_lo:[0,1] neg_hi:[0,1]
v_pk_add_f32 v[16:17], v[16:17], v[32:33]
v_pk_add_f32 v[32:33], v[18:19], v[34:35] neg_lo:[0,1] neg_hi:[0,1]
v_pk_add_f32 v[18:19], v[18:19], v[34:35]
v_pk_mul_f32 v[34:35], v[32:33], s[54:55] op_sel:[0,0] op_sel_hi:[0,1] neg_lo:[0,0] neg_hi:[0,0]
v_pk_fma_f32 v[34:35], v[32:33], s[54:55], v[34:35] op_sel:[1,1,0] op_sel_hi:[1,0,1] neg_lo:[0,1,0] neg_hi:[0,0,0]
v_pk_add_f32 v[32:33], v[20:21], v[36:37] neg_lo:[0,1] neg_hi:[0,1]
v_pk_add_f32 v[20:21], v[20:21], v[36:37]
v_pk_mul_f32 v[36:37], v[32:33], s[62:63] op_sel:[0,0] op_sel_hi:[0,1] neg_lo:[0,0] neg_hi:[0,0]
v_pk_fma_f32 v[36:37], v[32:33], s[62:63], v[36:37] op_sel:[1,1,0] op_sel_hi:[1,0,1] neg_lo:[0,1,0] neg_hi:[0,0,0]
v_pk_add_f32 v[32:33], v[22:23], v[38:39] neg_lo:[0,1] neg_hi:[0,1]
v_pk_add_f32 v[22:23], v[22:23], v[38:39]
v_pk_mul_f32 v[38:39], v[32:33], s[54:55] op_sel:[0,1] op_sel_hi:[0,0] neg_lo:[0,0] neg_hi:[0,0]
v_pk_fma_f32 v[38:39], v[32:33], s[54:55], v[38:39] op_sel:[1,0,0] op_sel_hi:[1,1,1] neg_lo:[0,1,0] neg_hi:[0,0,0]
v_pk_add_f32 v[32:33], v[24:25], v[40:41] op_sel:[1,1] op_sel_hi:[0,0] neg_lo:[1,0] neg_hi:[0,1]
v_pk_add_f32 v[24:25], v[24:25], v[40:41]
v_pk_add_f32 v[40:41], v[26:27], v[42:43] neg_lo:[0,1] neg_hi:[0,1]
v_pk_add_f32 v[26:27], v[26:27], v[42:43]
v_pk_mul_f32 v[42:43], v[40:41], s[54:55] op_sel:[0,1] op_sel_hi:[0,0] neg_lo:[0,1] neg_hi:[0,0]
v_pk_fma_f32 v[42:43], v[40:41], s[54:55], v[42:43] op_sel:[1,0,0] op_sel_hi:[1,1,1] neg_lo:[0,1,0] neg_hi:[0,1,0]
v_pk_add_f32 v[40:41], v[28:29], v[44:45] neg_lo:[0,1] neg_hi:[0,1]
v_pk_add_f32 v[28:29], v[28:29], v[44:45]
v_pk_mul_f32 v[44:45], v[40:41], s[62:63] op_sel:[0,0] op_sel_hi:[0,1] neg_lo:[0,1] neg_hi:[0,0]
v_pk_fma_f32 v[44:45], v[40:41], s[62:63], v[44:45] op_sel:[1,1,0] op_sel_hi:[1,0,1] neg_lo:[0,1,0] neg_hi:[0,1,0]
v_pk_add_f32 v[40:41], v[30:31], v[46:47] neg_lo:[0,1] neg_hi:[0,1]
v_pk_add_f32 v[30:31], v[30:31], v[46:47]
v_pk_mul_f32 v[46:47], v[40:41], s[54:55] op_sel:[0,0] op_sel_hi:[0,1] neg_lo:[0,1] neg_hi:[0,0]
v_pk_fma_f32 v[46:47], v[40:41], s[54:55], v[46:47] op_sel:[1,1,0] op_sel_hi:[1,0,1] neg_lo:[0,1,0] neg_hi:[0,1,0]
v_pk_add_f32 v[40:41], v[14:15], v[48:49] neg_lo:[0,1] neg_hi:[0,1]
v_pk_add_f32 v[14:15], v[14:15], v[48:49]
v_pk_add_f32 v[48:49], v[50:51], v[66:67] neg_lo:[0,1] neg_hi:[0,1]
v_pk_add_f32 v[50:51], v[50:51], v[66:67]
v_pk_mul_f32 v[66:67], v[48:49], s[54:55] op_sel:[0,0] op_sel_hi:[0,1] neg_lo:[0,0] neg_hi:[0,0]
v_pk_fma_f32 v[66:67], v[48:49], s[54:55], v[66:67] op_sel:[1,1,0] op_sel_hi:[1,0,1] neg_lo:[0,1,0] neg_hi:[0,0,0]
v_pk_add_f32 v[48:49], v[52:53], v[68:69] neg_lo:[0,1] neg_hi:[0,1]
v_pk_add_f32 v[52:53], v[52:53], v[68:69]
v_pk_mul_f32 v[68:69], v[48:49], s[62:63] op_sel:[0,0] op_sel_hi:[0,1] neg_lo:[0,0] neg_hi:[0,0]
v_pk_fma_f32 v[68:69], v[48:49], s[62:63], v[68:69] op_sel:[1,1,0] op_sel_hi:[1,0,1] neg_lo:[0,1,0] neg_hi:[0,0,0]
v_pk_add_f32 v[48:49], v[54:55], v[70:71] neg_lo:[0,1] neg_hi:[0,1]
v_pk_add_f32 v[54:55], v[54:55], v[70:71]
v_pk_mul_f32 v[70:71], v[48:49], s[54:55] op_sel:[0,1] op_sel_hi:[0,0] neg_lo:[0,0] neg_hi:[0,0]
v_pk_fma_f32 v[70:71], v[48:49], s[54:55], v[70:71] op_sel:[1,0,0] op_sel_hi:[1,1,1] neg_lo:[0,1,0] neg_hi:[0,0,0]
v_pk_add_f32 v[48:49], v[56:57], v[72:73] op_sel:[1,1] op_sel_hi:[0,0] neg_lo:[1,0] neg_hi:[0,1]
v_pk_add_f32 v[56:57], v[56:57], v[72:73]
v_pk_add_f32 v[72:73], v[58:59], v[74:75] neg_lo:[0,1] neg_hi:[0,1]
v_pk_add_f32 v[58:59], v[58:59], v[74:75]
v_pk_mul_f32 v[74:75], v[72:73], s[54:55] op_sel:[0,1] op_sel_hi:[0,0] neg_lo:[0,1] neg_hi:[0,0]
v_pk_fma_f32 v[74:75], v[72:73], s[54:55], v[74:75] op_sel:[1,0,0] op_sel_hi:[1,1,1] neg_lo:[0,1,0] neg_hi:[0,1,0]
v_pk_add_f32 v[72:73], v[60:61], v[76:77] neg_lo:[0,1] neg_hi:[0,1]
v_pk_add_f32 v[60:61], v[60:61], v[76:77]
v_pk_mul_f32 v[76:77], v[72:73], s[62:63] op_sel:[0,0] op_sel_hi:[0,1] neg_lo:[0,1] neg_hi:[0,0]
v_pk_fma_f32 v[76:77], v[72:73], s[62:63], v[76:77] op_sel:[1,1,0] op_sel_hi:[1,0,1] neg_lo:[0,1,0] neg_hi:[0,1,0]
v_pk_add_f32 v[72:73], v[62:63], v[78:79] neg_lo:[0,1] neg_hi:[0,1]
v_pk_add_f32 v[62:63], v[62:63], v[78:79]
v_pk_mul_f32 v[78:79], v[72:73], s[54:55] op_sel:[0,0] op_sel_hi:[0,1] neg_lo:[0,1] neg_hi:[0,0]
v_pk_fma_f32 v[78:79], v[72:73], s[54:55], v[78:79] op_sel:[1,1,0] op_sel_hi:[1,0,1] neg_lo:[0,1,0] neg_hi:[0,1,0]
v_pk_add_f32 v[72:73], v[16:17], v[24:25] neg_lo:[0,1] neg_hi:[0,1]
v_pk_add_f32 v[16:17], v[16:17], v[24:25]
v_pk_add_f32 v[24:25], v[18:19], v[26:27] neg_lo:[0,1] neg_hi:[0,1]
v_pk_add_f32 v[18:19], v[18:19], v[26:27]
v_pk_mul_f32 v[26:27], v[24:25], s[62:63] op_sel:[0,0] op_sel_hi:[0,1] neg_lo:[0,0] neg_hi:[0,0]
v_pk_fma_f32 v[26:27], v[24:25], s[62:63], v[26:27] op_sel:[1,1,0] op_sel_hi:[1,0,1] neg_lo:[0,1,0] neg_hi:[0,0,0]
v_pk_add_f32 v[24:25], v[20:21], v[28:29] op_sel:[1,1] op_sel_hi:[0,0] neg_lo:[1,0] neg_hi:[0,1]
v_pk_add_f32 v[20:21], v[20:21], v[28:29]
v_pk_add_f32 v[28:29], v[22:23], v[30:31] neg_lo:[0,1] neg_hi:[0,1]
v_pk_add_f32 v[22:23], v[22:23], v[30:31]
v_pk_mul_f32 v[30:31], v[28:29], s[62:63] op_sel:[0,0] op_sel_hi:[0,1] neg_lo:[0,1] neg_hi:[0,0]
v_pk_fma_f32 v[30:31], v[28:29], s[62:63], v[30:31] op_sel:[1,1,0] op_sel_hi:[1,0,1] neg_lo:[0,1,0] neg_hi:[0,1,0]
v_pk_add_f32 v[28:29], v[64:65], v[32:33] neg_lo:[0,1] neg_hi:[0,1]
v_pk_add_f32 v[64:65], v[64:65], v[32:33]
v_pk_add_f32 v[32:33], v[34:35], v[42:43] neg_lo:[0,1] neg_hi:[0,1]
v_pk_add_f32 v[34:35], v[34:35], v[42:43]
v_pk_mul_f32 v[42:43], v[32:33], s[62:63] op_sel:[0,0] op_sel_hi:[0,1] neg_lo:[0,0] neg_hi:[0,0]
v_pk_fma_f32 v[42:43], v[32:33], s[62:63], v[42:43] op_sel:[1,1,0] op_sel_hi:[1,0,1] neg_lo:[0,1,0] neg_hi:[0,0,0]
v_pk_add_f32 v[32:33], v[36:37], v[44:45] op_sel:[1,1] op_sel_hi:[0,0] neg_lo:[1,0] neg_hi:[0,1]
v_pk_add_f32 v[36:37], v[36:37], v[44:45]
v_pk_add_f32 v[44:45], v[38:39], v[46:47] neg_lo:[0,1] neg_hi:[0,1]
v_pk_add_f32 v[38:39], v[38:39], v[46:47]
v_pk_mul_f32 v[46:47], v[44:45], s[62:63] op_sel:[0,0] op_sel_hi:[0,1] neg_lo:[0,1] neg_hi:[0,0]
v_pk_fma_f32 v[46:47], v[44:45], s[62:63], v[46:47] op_sel:[1,1,0] op_sel_hi:[1,0,1] neg_lo:[0,1,0] neg_hi:[0,1,0]
v_pk_add_f32 v[44:45], v[14:15], v[56:57] neg_lo:[0,1] neg_hi:[0,1]
v_pk_add_f32 v[14:15], v[14:15], v[56:57]
v_pk_add_f32 v[56:57], v[50:51], v[58:59] neg_lo:[0,1] neg_hi:[0,1]
v_pk_add_f32 v[50:51], v[50:51], v[58:59]
v_pk_mul_f32 v[58:59], v[56:57], s[62:63] op_sel:[0,0] op_sel_hi:[0,1] neg_lo:[0,0] neg_hi:[0,0]
v_pk_fma_f32 v[58:59], v[56:57], s[62:63], v[58:59] op_sel:[1,1,0] op_sel_hi:[1,0,1] neg_lo:[0,1,0] neg_hi:[0,0,0]
v_pk_add_f32 v[56:57], v[52:53], v[60:61] op_sel:[1,1] op_sel_hi:[0,0] neg_lo:[1,0] neg_hi:[0,1]
v_pk_add_f32 v[52:53], v[52:53], v[60:61]
v_pk_add_f32 v[60:61], v[54:55], v[62:63] neg_lo:[0,1] neg_hi:[0,1]
v_pk_add_f32 v[54:55], v[54:55], v[62:63]
v_pk_mul_f32 v[62:63], v[60:61], s[62:63] op_sel:[0,0] op_sel_hi:[0,1] neg_lo:[0,1] neg_hi:[0,0]
v_pk_fma_f32 v[62:63], v[60:61], s[62:63], v[62:63] op_sel:[1,1,0] op_sel_hi:[1,0,1] neg_lo:[0,1,0] neg_hi:[0,1,0]
v_pk_add_f32 v[60:61], v[40:41], v[48:49] neg_lo:[0,1] neg_hi:[0,1]
v_pk_add_f32 v[40:41], v[40:41], v[48:49]
v_pk_add_f32 v[48:49], v[66:67], v[74:75] neg_lo:[0,1] neg_hi:[0,1]
v_pk_add_f32 v[66:67], v[66:67], v[74:75]
v_pk_mul_f32 v[74:75], v[48:49], s[62:63] op_sel:[0,0] op_sel_hi:[0,1] neg_lo:[0,0] neg_hi:[0,0]
v_pk_fma_f32 v[74:75], v[48:49], s[62:63], v[74:75] op_sel:[1,1,0] op_sel_hi:[1,0,1] neg_lo:[0,1,0] neg_hi:[0,0,0]
v_pk_add_f32 v[48:49], v[68:69], v[76:77] op_sel:[1,1] op_sel_hi:[0,0] neg_lo:[1,0] neg_hi:[0,1]
v_pk_add_f32 v[68:69], v[68:69], v[76:77]
v_pk_add_f32 v[76:77], v[70:71], v[78:79] neg_lo:[0,1] neg_hi:[0,1]
v_pk_add_f32 v[70:71], v[70:71], v[78:79]
v_pk_mul_f32 v[78:79], v[76:77], s[62:63] op_sel:[0,0] op_sel_hi:[0,1] neg_lo:[0,1] neg_hi:[0,0]
v_pk_fma_f32 v[78:79], v[76:77], s[62:63], v[78:79] op_sel:[1,1,0] op_sel_hi:[1,0,1] neg_lo:[0,1,0] neg_hi:[0,1,0]
v_pk_add_f32 v[76:77], v[16:17], v[20:21] neg_lo:[0,1] neg_hi:[0,1]
v_pk_add_f32 v[16:17], v[16:17], v[20:21]
v_pk_add_f32 v[20:21], v[18:19], v[22:23] op_sel:[1,1] op_sel_hi:[0,0] neg_lo:[1,0] neg_hi:[0,1]
v_pk_add_f32 v[18:19], v[18:19], v[22:23]
v_pk_add_f32 v[22:23], v[72:73], v[24:25] neg_lo:[0,1] neg_hi:[0,1]
v_pk_add_f32 v[72:73], v[72:73], v[24:25]
v_pk_add_f32 v[24:25], v[26:27], v[30:31] op_sel:[1,1] op_sel_hi:[0,0] neg_lo:[1,0] neg_hi:[0,1]
v_pk_add_f32 v[26:27], v[26:27], v[30:31]
v_pk_add_f32 v[30:31], v[64:65], v[36:37] neg_lo:[0,1] neg_hi:[0,1]
v_pk_add_f32 v[64:65], v[64:65], v[36:37]
v_pk_add_f32 v[36:37], v[34:35], v[38:39] op_sel:[1,1] op_sel_hi:[0,0] neg_lo:[1,0] neg_hi:[0,1]
v_pk_add_f32 v[34:35], v[34:35], v[38:39]
v_pk_add_f32 v[38:39], v[28:29], v[32:33] neg_lo:[0,1] neg_hi:[0,1]
v_pk_add_f32 v[28:29], v[28:29], v[32:33]
v_pk_add_f32 v[32:33], v[42:43], v[46:47] op_sel:[1,1] op_sel_hi:[0,0] neg_lo:[1,0] neg_hi:[0,1]
v_pk_add_f32 v[42:43], v[42:43], v[46:47]
v_pk_add_f32 v[46:47], v[14:15], v[52:53] neg_lo:[0,1] neg_hi:[0,1]
v_pk_add_f32 v[14:15], v[14:15], v[52:53]
v_pk_add_f32 v[52:53], v[50:51], v[54:55] op_sel:[1,1] op_sel_hi:[0,0] neg_lo:[1,0] neg_hi:[0,1]
v_pk_add_f32 v[50:51], v[50:51], v[54:55]
v_pk_add_f32 v[54:55], v[44:45], v[56:57] neg_lo:[0,1] neg_hi:[0,1]
v_pk_add_f32 v[44:45], v[44:45], v[56:57]
v_pk_add_f32 v[56:57], v[58:59], v[62:63] op_sel:[1,1] op_sel_hi:[0,0] neg_lo:[1,0] neg_hi:[0,1]
v_pk_add_f32 v[58:59], v[58:59], v[62:63]
v_pk_add_f32 v[62:63], v[40:41], v[68:69] neg_lo:[0,1] neg_hi:[0,1]
v_pk_add_f32 v[40:41], v[40:41], v[68:69]
v_pk_add_f32 v[68:69], v[66:67], v[70:71] op_sel:[1,1] op_sel_hi:[0,0] neg_lo:[1,0] neg_hi:[0,1]
v_pk_add_f32 v[66:67], v[66:67], v[70:71]
v_pk_add_f32 v[70:71], v[60:61], v[48:49] neg_lo:[0,1] neg_hi:[0,1]
v_pk_add_f32 v[60:61], v[60:61], v[48:49]
v_pk_add_f32 v[48:49], v[74:75], v[78:79] op_sel:[1,1] op_sel_hi:[0,0] neg_lo:[1,0] neg_hi:[0,1]
v_pk_add_f32 v[74:75], v[74:75], v[78:79]
v_pk_add_f32 v[78:79], v[16:17], v[18:19] neg_lo:[0,1] neg_hi:[0,1]
v_pk_add_f32 v[16:17], v[16:17], v[18:19]
v_pk_add_f32 v[18:19], v[76:77], v[20:21] neg_lo:[0,1] neg_hi:[0,1]
v_pk_add_f32 v[76:77], v[76:77], v[20:21]
v_pk_add_f32 v[20:21], v[72:73], v[26:27] neg_lo:[0,1] neg_hi:[0,1]
v_pk_add_f32 v[72:73], v[72:73], v[26:27]
v_pk_add_f32 v[26:27], v[22:23], v[24:25] neg_lo:[0,1] neg_hi:[0,1]
v_pk_add_f32 v[22:23], v[22:23], v[24:25]
v_pk_add_f32 v[24:25], v[64:65], v[34:35] neg_lo:[0,1] neg_hi:[0,1]
v_pk_add_f32 v[64:65], v[64:65], v[34:35]
v_pk_add_f32 v[34:35], v[30:31], v[36:37] neg_lo:[0,1] neg_hi:[0,1]
v_pk_add_f32 v[30:31], v[30:31], v[36:37]
v_pk_add_f32 v[36:37], v[28:29], v[42:43] neg_lo:[0,1] neg_hi:[0,1]
v_pk_add_f32 v[28:29], v[28:29], v[42:43]
v_pk_add_f32 v[42:43], v[38:39], v[32:33] neg_lo:[0,1] neg_hi:[0,1]
v_pk_add_f32 v[38:39], v[38:39], v[32:33]
v_pk_add_f32 v[32:33], v[14:15], v[50:51] neg_lo:[0,1] neg_hi:[0,1]
v_pk_add_f32 v[14:15], v[14:15], v[50:51]
v_pk_add_f32 v[50:51], v[46:47], v[52:53] neg_lo:[0,1] neg_hi:[0,1]
v_pk_add_f32 v[46:47], v[46:47], v[52:53]
v_pk_add_f32 v[52:53], v[44:45], v[58:59] neg_lo:[0,1] neg_hi:[0,1]
v_pk_add_f32 v[44:45], v[44:45], v[58:59]
v_pk_add_f32 v[58:59], v[54:55], v[56:57] neg_lo:[0,1] neg_hi:[0,1]
v_pk_add_f32 v[54:55], v[54:55], v[56:57]
v_pk_add_f32 v[56:57], v[40:41], v[66:67] neg_lo:[0,1] neg_hi:[0,1]
v_pk_add_f32 v[40:41], v[40:41], v[66:67]
v_pk_add_f32 v[66:67], v[62:63], v[68:69] neg_lo:[0,1] neg_hi:[0,1]
v_pk_add_f32 v[62:63], v[62:63], v[68:69]
v_pk_add_f32 v[68:69], v[60:61], v[74:75] neg_lo:[0,1] neg_hi:[0,1]
v_pk_add_f32 v[60:61], v[60:61], v[74:75]
v_pk_add_f32 v[74:75], v[70:71], v[48:49] neg_lo:[0,1] neg_hi:[0,1]
v_pk_add_f32 v[70:71], v[70:71], v[48:49]
v_pk_mul_f32 v[48:49], v[14:15], v[82:83] op_sel:[0,0] op_sel_hi:[0,1] neg_lo:[0,0] neg_hi:[0,0]
v_pk_fma_f32 v[14:15], v[14:15], v[82:83], v[48:49] op_sel:[1,1,0] op_sel_hi:[1,0,1] neg_lo:[0,1,0] neg_hi:[0,0,0]
v_pk_mul_f32 v[48:49], v[64:65], v[84:85] op_sel:[0,0] op_sel_hi:[0,1] neg_lo:[0,0] neg_hi:[0,0]
v_pk_fma_f32 v[64:65], v[64:65], v[84:85], v[48:49] op_sel:[1,1,0] op_sel_hi:[1,0,1] neg_lo:[0,1,0] neg_hi:[0,0,0]
v_pk_mul_f32 v[48:49], v[40:41], v[86:87] op_sel:[0,0] op_sel_hi:[0,1] neg_lo:[0,0] neg_hi:[0,0]
v_pk_fma_f32 v[40:41], v[40:41], v[86:87], v[48:49] op_sel:[1,1,0] op_sel_hi:[1,0,1] neg_lo:[0,1,0] neg_hi:[0,0,0]
v_pk_mul_f32 v[48:49], v[72:73], v[88:89] op_sel:[0,0] op_sel_hi:[0,1] neg_lo:[0,0] neg_hi:[0,0]
v_pk_fma_f32 v[72:73], v[72:73], v[88:89], v[48:49] op_sel:[1,1,0] op_sel_hi:[1,0,1] neg_lo:[0,1,0] neg_hi:[0,0,0]
v_pk_mul_f32 v[48:49], v[44:45], v[90:91] op_sel:[0,0] op_sel_hi:[0,1] neg_lo:[0,0] neg_hi:[0,0]
v_pk_fma_f32 v[44:45], v[44:45], v[90:91], v[48:49] op_sel:[1,1,0] op_sel_hi:[1,0,1] neg_lo:[0,1,0] neg_hi:[0,0,0]
v_pk_mul_f32 v[48:49], v[28:29], v[92:93] op_sel:[0,0] op_sel_hi:[0,1] neg_lo:[0,0] neg_hi:[0,0]
v_pk_fma_f32 v[28:29], v[28:29], v[92:93], v[48:49] op_sel:[1,1,0] op_sel_hi:[1,0,1] neg_lo:[0,1,0] neg_hi:[0,0,0]
v_pk_mul_f32 v[48:49], v[60:61], v[94:95] op_sel:[0,0] op_sel_hi:[0,1] neg_lo:[0,0] neg_hi:[0,0]
v_pk_fma_f32 v[60:61], v[60:61], v[94:95], v[48:49] op_sel:[1,1,0] op_sel_hi:[1,0,1] neg_lo:[0,1,0] neg_hi:[0,0,0]
v_pk_mul_f32 v[48:49], v[76:77], v[96:97] op_sel:[0,0] op_sel_hi:[0,1] neg_lo:[0,0] neg_hi:[0,0]
v_pk_fma_f32 v[76:77], v[76:77], v[96:97], v[48:49] op_sel:[1,1,0] op_sel_hi:[1,0,1] neg_lo:[0,1,0] neg_hi:[0,0,0]
v_pk_mul_f32 v[48:49], v[46:47], v[98:99] op_sel:[0,0] op_sel_hi:[0,1] neg_lo:[0,0] neg_hi:[0,0]
v_pk_fma_f32 v[46:47], v[46:47], v[98:99], v[48:49] op_sel:[1,1,0] op_sel_hi:[1,0,1] neg_lo:[0,1,0] neg_hi:[0,0,0]
v_pk_mul_f32 v[48:49], v[30:31], v[100:101] op_sel:[0,0] op_sel_hi:[0,1] neg_lo:[0,0] neg_hi:[0,0]
v_pk_fma_f32 v[30:31], v[30:31], v[100:101], v[48:49] op_sel:[1,1,0] op_sel_hi:[1,0,1] neg_lo:[0,1,0] neg_hi:[0,0,0]
v_pk_mul_f32 v[48:49], v[62:63], v[102:103] op_sel:[0,0] op_sel_hi:[0,1] neg_lo:[0,0] neg_hi:[0,0]
v_pk_fma_f32 v[62:63], v[62:63], v[102:103], v[48:49] op_sel:[1,1,0] op_sel_hi:[1,0,1] neg_lo:[0,1,0] neg_hi:[0,0,0]
v_pk_mul_f32 v[48:49], v[22:23], v[104:105] op_sel:[0,0] op_sel_hi:[0,1] neg_lo:[0,0] neg_hi:[0,0]
v_pk_fma_f32 v[22:23], v[22:23], v[104:105], v[48:49] op_sel:[1,1,0] op_sel_hi:[1,0,1] neg_lo:[0,1,0] neg_hi:[0,0,0]
v_pk_mul_f32 v[48:49], v[54:55], v[106:107] op_sel:[0,0] op_sel_hi:[0,1] neg_lo:[0,0] neg_hi:[0,0]
v_pk_fma_f32 v[54:55], v[54:55], v[106:107], v[48:49] op_sel:[1,1,0] op_sel_hi:[1,0,1] neg_lo:[0,1,0] neg_hi:[0,0,0]
v_pk_mul_f32 v[48:49], v[38:39], v[108:109] op_sel:[0,0] op_sel_hi:[0,1] neg_lo:[0,0] neg_hi:[0,0]
v_pk_fma_f32 v[38:39], v[38:39], v[108:109], v[48:49] op_sel:[1,1,0] op_sel_hi:[1,0,1] neg_lo:[0,1,0] neg_hi:[0,0,0]
v_pk_mul_f32 v[48:49], v[70:71], v[110:111] op_sel:[0,0] op_sel_hi:[0,1] neg_lo:[0,0] neg_hi:[0,0]
v_pk_fma_f32 v[70:71], v[70:71], v[110:111], v[48:49] op_sel:[1,1,0] op_sel_hi:[1,0,1] neg_lo:[0,1,0] neg_hi:[0,0,0]
v_pk_mul_f32 v[48:49], v[78:79], v[112:113] op_sel:[0,0] op_sel_hi:[0,1] neg_lo:[0,0] neg_hi:[0,0]
v_pk_fma_f32 v[78:79], v[78:79], v[112:113], v[48:49] op_sel:[1,1,0] op_sel_hi:[1,0,1] neg_lo:[0,1,0] neg_hi:[0,0,0]
v_pk_mul_f32 v[48:49], v[32:33], v[114:115] op_sel:[0,0] op_sel_hi:[0,1] neg_lo:[0,0] neg_hi:[0,0]
v_pk_fma_f32 v[32:33], v[32:33], v[114:115], v[48:49] op_sel:[1,1,0] op_sel_hi:[1,0,1] neg_lo:[0,1,0] neg_hi:[0,0,0]
v_pk_mul_f32 v[48:49], v[24:25], v[116:117] op_sel:[0,0] op_sel_hi:[0,1] neg_lo:[0,0] neg_hi:[0,0]
v_pk_fma_f32 v[24:25], v[24:25], v[116:117], v[48:49] op_sel:[1,1,0] op_sel_hi:[1,0,1] neg_lo:[0,1,0] neg_hi:[0,0,0]
v_pk_mul_f32 v[48:49], v[56:57], v[118:119] op_sel:[0,0] op_sel_hi:[0,1] neg_lo:[0,0] neg_hi:[0,0]
v_pk_fma_f32 v[56:57], v[56:57], v[118:119], v[48:49] op_sel:[1,1,0] op_sel_hi:[1,0,1] neg_lo:[0,1,0] neg_hi:[0,0,0]
v_pk_mul_f32 v[48:49], v[20:21], v[120:121] op_sel:[0,0] op_sel_hi:[0,1] neg_lo:[0,0] neg_hi:[0,0]
v_pk_fma_f32 v[20:21], v[20:21], v[120:121], v[48:49] op_sel:[1,1,0] op_sel_hi:[1,0,1] neg_lo:[0,1,0] neg_hi:[0,0,0]
v_pk_mul_f32 v[48:49], v[52:53], v[122:123] op_sel:[0,0] op_sel_hi:[0,1] neg_lo:[0,0] neg_hi:[0,0]
v_pk_fma_f32 v[52:53], v[52:53], v[122:123], v[48:49] op_sel:[1,1,0] op_sel_hi:[1,0,1] neg_lo:[0,1,0] neg_hi:[0,0,0]
v_pk_mul_f32 v[48:49], v[36:37], v[124:125] op_sel:[0,0] op_sel_hi:[0,1] neg_lo:[0,0] neg_hi:[0,0]
v_pk_fma_f32 v[36:37], v[36:37], v[124:125], v[48:49] op_sel:[1,1,0] op_sel_hi:[1,0,1] neg_lo:[0,1,0] neg_hi:[0,0,0]
v_pk_mul_f32 v[48:49], v[68:69], v[126:127] op_sel:[0,0] op_sel_hi:[0,1] neg_lo:[0,0] neg_hi:[0,0]
v_pk_fma_f32 v[68:69], v[68:69], v[126:127], v[48:49] op_sel:[1,1,0] op_sel_hi:[1,0,1] neg_lo:[0,1,0] neg_hi:[0,0,0]
v_pk_mul_f32 v[48:49], v[18:19], v[128:129] op_sel:[0,0] op_sel_hi:[0,1] neg_lo:[0,0] neg_hi:[0,0]
v_pk_fma_f32 v[18:19], v[18:19], v[128:129], v[48:49] op_sel:[1,1,0] op_sel_hi:[1,0,1] neg_lo:[0,1,0] neg_hi:[0,0,0]
v_pk_mul_f32 v[48:49], v[50:51], v[130:131] op_sel:[0,0] op_sel_hi:[0,1] neg_lo:[0,0] neg_hi:[0,0]
v_pk_fma_f32 v[50:51], v[50:51], v[130:131], v[48:49] op_sel:[1,1,0] op_sel_hi:[1,0,1] neg_lo:[0,1,0] neg_hi:[0,0,0]
v_pk_mul_f32 v[48:49], v[34:35], v[132:133] op_sel:[0,0] op_sel_hi:[0,1] neg_lo:[0,0] neg_hi:[0,0]
v_pk_fma_f32 v[34:35], v[34:35], v[132:133], v[48:49] op_sel:[1,1,0] op_sel_hi:[1,0,1] neg_lo:[0,1,0] neg_hi:[0,0,0]
v_pk_mul_f32 v[48:49], v[66:67], v[134:135] op_sel:[0,0] op_sel_hi:[0,1] neg_lo:[0,0] neg_hi:[0,0]
v_pk_fma_f32 v[66:67], v[66:67], v[134:135], v[48:49] op_sel:[1,1,0] op_sel_hi:[1,0,1] neg_lo:[0,1,0] neg_hi:[0,0,0]
v_pk_mul_f32 v[48:49], v[26:27], v[136:137] op_sel:[0,0] op_sel_hi:[0,1] neg_lo:[0,0] neg_hi:[0,0]
v_pk_fma_f32 v[26:27], v[26:27], v[136:137], v[48:49] op_sel:[1,1,0] op_sel_hi:[1,0,1] neg_lo:[0,1,0] neg_hi:[0,0,0]
v_pk_mul_f32 v[48:49], v[58:59], v[138:139] op_sel:[0,0] op_sel_hi:[0,1] neg_lo:[0,0] neg_hi:[0,0]
v_pk_fma_f32 v[58:59], v[58:59], v[138:139], v[48:49] op_sel:[1,1,0] op_sel_hi:[1,0,1] neg_lo:[0,1,0] neg_hi:[0,0,0]
v_pk_mul_f32 v[48:49], v[42:43], v[140:141] op_sel:[0,0] op_sel_hi:[0,1] neg_lo:[0,0] neg_hi:[0,0]
v_pk_fma_f32 v[42:43], v[42:43], v[140:141], v[48:49] op_sel:[1,1,0] op_sel_hi:[1,0,1] neg_lo:[0,1,0] neg_hi:[0,0,0]
v_pk_mul_f32 v[48:49], v[74:75], v[142:143] op_sel:[0,0] op_sel_hi:[0,1] neg_lo:[0,0] neg_hi:[0,0]
v_pk_fma_f32 v[74:75], v[74:75], v[142:143], v[48:49] op_sel:[1,1,0] op_sel_hi:[1,0,1] neg_lo:[0,1,0] neg_hi:[0,0,0]
ds_write_b64 v4, v[16:17] offset:0
ds_write_b64 v4, v[14:15] offset:264
ds_write_b64 v4, v[64:65] offset:528
ds_write_b64 v4, v[40:41] offset:792
ds_write_b64 v4, v[72:73] offset:1056
ds_write_b64 v4, v[44:45] offset:1320
ds_write_b64 v4, v[28:29] offset:1584
ds_write_b64 v4, v[60:61] offset:1848
ds_write_b64 v4, v[76:77] offset:2112
ds_write_b64 v4, v[46:47] offset:2376
ds_write_b64 v4, v[30:31] offset:2640
ds_write_b64 v4, v[62:63] offset:2904
ds_write_b64 v4, v[22:23] offset:3168
ds_write_b64 v4, v[54:55] offset:3432
ds_write_b64 v4, v[38:39] offset:3696
ds_write_b64 v4, v[70:71] offset:3960
ds_write_b64 v4, v[78:79] offset:4224
ds_write_b64 v4, v[32:33] offset:4488
ds_write_b64 v4, v[24:25] offset:4752
ds_write_b64 v4, v[56:57] offset:5016
ds_write_b64 v4, v[20:21] offset:5280
ds_write_b64 v4, v[52:53] offset:5544
ds_write_b64 v4, v[36:37] offset:5808
ds_write_b64 v4, v[68:69] offset:6072
ds_write_b64 v4, v[18:19] offset:6336
ds_write_b64 v4, v[50:51] offset:6600
ds_write_b64 v4, v[34:35] offset:6864
ds_write_b64 v4, v[66:67] offset:7128
ds_write_b64 v4, v[26:27] offset:7392
ds_write_b64 v4, v[58:59] offset:7656
ds_write_b64 v4, v[42:43] offset:7920
ds_write_b64 v4, v[74:75] offset:8184
s_waitcnt lgkmcnt(0)
ds_read_b64 v[16:17], v5 offset:0
ds_read_b64 v[48:49], v5 offset:128
ds_read_b64 v[18:19], v5 offset:8
ds_read_b64 v[50:51], v5 offset:136
ds_read_b64 v[20:21], v5 offset:16
ds_read_b64 v[52:53], v5 offset:144
ds_read_b64 v[22:23], v5 offset:24
ds_read_b64 v[54:55], v5 offset:152
ds_read_b64 v[24:25], v5 offset:32
ds_read_b64 v[56:57], v5 offset:160
ds_read_b64 v[26:27], v5 offset:40
ds_read_b64 v[58:59], v5 offset:168
ds_read_b64 v[28:29], v5 offset:48
ds_read_b64 v[60:61], v5 offset:176
ds_read_b64 v[30:31], v5 offset:56
ds_read_b64 v[62:63], v5 offset:184
ds_read_b64 v[32:33], v5 offset:64
ds_read_b64 v[64:65], v5 offset:192
ds_read_b64 v[34:35], v5 offset:72
ds_read_b64 v[66:67], v5 offset:200
ds_read_b64 v[36:37], v5 offset:80
ds_read_b64 v[68:69], v5 offset:208
ds_read_b64 v[38:39], v5 offset:88
ds_read_b64 v[70:71], v5 offset:216
ds_read_b64 v[40:41], v5 offset:96
ds_read_b64 v[72:73], v5 offset:224
ds_read_b64 v[42:43], v5 offset:104
ds_read_b64 v[74:75], v5 offset:232
ds_read_b64 v[44:45], v5 offset:112
ds_read_b64 v[76:77], v5 offset:240
ds_read_b64 v[46:47], v5 offset:120
ds_read_b64 v[78:79], v5 offset:248
s_waitcnt lgkmcnt(0)
v_pk_add_f32 v[14:15], v[16:17], v[48:49] neg_lo:[0,1] neg_hi:[0,1]
v_pk_add_f32 v[16:17], v[16:17], v[48:49]
v_pk_add_f32 v[48:49], v[18:19], v[50:51] neg_lo:[0,1] neg_hi:[0,1]
v_pk_add_f32 v[18:19], v[18:19], v[50:51]
v_pk_mul_f32 v[50:51], v[48:49], s[50:51] op_sel:[0,0] op_sel_hi:[0,1] neg_lo:[0,0] neg_hi:[0,0]
v_pk_fma_f32 v[50:51], v[48:49], s[50:51], v[50:51] op_sel:[1,1,0] op_sel_hi:[1,0,1] neg_lo:[0,1,0] neg_hi:[0,0,0]
v_pk_add_f32 v[48:49], v[20:21], v[52:53] neg_lo:[0,1] neg_hi:[0,1]
v_pk_add_f32 v[20:21], v[20:21], v[52:53]
v_pk_mul_f32 v[52:53], v[48:49], s[54:55] op_sel:[0,0] op_sel_hi:[0,1] neg_lo:[0,0] neg_hi:[0,0]
v_pk_fma_f32 v[52:53], v[48:49], s[54:55], v[52:53] op_sel:[1,1,0] op_sel_hi:[1,0,1] neg_lo:[0,1,0] neg_hi:[0,0,0]
v_pk_add_f32 v[48:49], v[22:23], v[54:55] neg_lo:[0,1] neg_hi:[0,1]
v_pk_add_f32 v[22:23], v[22:23], v[54:55]
v_pk_mul_f32 v[54:55], v[48:49], s[58:59] op_sel:[0,0] op_sel_hi:[0,1] neg_lo:[0,0] neg_hi:[0,0]
v_pk_fma_f32 v[54:55], v[48:49], s[58:59], v[54:55] op_sel:[1,1,0] op_sel_hi:[1,0,1] neg_lo:[0,1,0] neg_hi:[0,0,0]
v_pk_add_f32 v[48:49], v[24:25], v[56:57] neg_lo:[0,1] neg_hi:[0,1]
v_pk_add_f32 v[24:25], v[24:25], v[56:57]
v_pk_mul_f32 v[56:57], v[48:49], s[62:63] op_sel:[0,0] op_sel_hi:[0,1] neg_lo:[0,0] neg_hi:[0,0]
v_pk_fma_f32 v[56:57], v[48:49], s[62:63], v[56:57] op_sel:[1,1,0] op_sel_hi:[1,0,1] neg_lo:[0,1,0] neg_hi:[0,0,0]
v_pk_add_f32 v[48:49], v[26:27], v[58:59] neg_lo:[0,1] neg_hi:[0,1]
v_pk_add_f32 v[26:27], v[26:27], v[58:59]
v_pk_mul_f32 v[58:59], v[48:49], s[58:59] op_sel:[0,1] op_sel_hi:[0,0] neg_lo:[0,0] neg_hi:[0,0]
v_pk_fma_f32 v[58:59], v[48:49], s[58:59], v[58:59] op_sel:[1,0,0] op_sel_hi:[1,1,1] neg_lo:[0,1,0] neg_hi:[0,0,0]
v_pk_add_f32 v[48:49], v[28:29], v[60:61] neg_lo:[0,1] neg_hi:[0,1]
v_pk_add_f32 v[28:29], v[28:29], v[60:61]
v_pk_mul_f32 v[60:61], v[48:49], s[54:55] op_sel:[0,1] op_sel_hi:[0,0] neg_lo:[0,0] neg_hi:[0,0]
v_pk_fma_f32 v[60:61], v[48:49], s[54:55], v[60:61] op_sel:[1,0,0] op_sel_hi:[1,1,1] neg_lo:[0,1,0] neg_hi:[0,0,0]
v_pk_add_f32 v[48:49], v[30:31], v[62:63] neg_lo:[0,1] neg_hi:[0,1]
v_pk_add_f32 v[30:31], v[30:31], v[62:63]
v_pk_mul_f32 v[62:63], v[48:49], s[50:51] op_sel:[0,1] op_sel_hi:[0,0] neg_lo:[0,0] neg_hi:[0,0]
v_pk_fma_f32 v[62:63], v[48:49], s[50:51], v[62:63] op_sel:[1,0,0] op_sel_hi:[1,1,1] neg_lo:[0,1,0] neg_hi:[0,0,0]
v_pk_add_f32 v[48:49], v[32:33], v[64:65] op_sel:[1,1] op_sel_hi:[0,0] neg_lo:[1,0] neg_hi:[0,1]
v_pk_add_f32 v[32:33], v[32:33], v[64:65]
v_pk_add_f32 v[64:65], v[34:35], v[66:67] neg_lo:[0,1] neg_hi:[0,1]
v_pk_add_f32 v[34:35], v[34:35], v[66:67]
v_pk_mul_f32 v[66:67], v[64:65], s[50:51] op_sel:[0,1] op_sel_hi:[0,0] neg_lo:[0,1] neg_hi:[0,0]
v_pk_fma_f32 v[66:67], v[64:65], s[50:51], v[66:67] op_sel:[1,0,0] op_sel_hi:[1,1,1] neg_lo:[0,1,0] neg_hi:[0,1,0]
v_pk_add_f32 v[64:65], v[36:37], v[68:69] neg_lo:[0,1] neg_hi:[0,1]
v_pk_add_f32 v[36:37], v[36:37], v[68:69]
v_pk_mul_f32 v[68:69], v[64:65], s[54:55] op_sel:[0,1] op_sel_hi:[0,0] neg_lo:[0,1] neg_hi:[0,0]
v_pk_fma_f32 v[68:69], v[64:65], s[54:55], v[68:69] op_sel:[1,0,0] op_sel_hi:[1,1,1] neg_lo:[0,1,0] neg_hi:[0,1,0]
v_pk_add_f32 v[64:65], v[38:39], v[70:71] neg_lo:[0,1] neg_hi:[0,1]
v_pk_add_f32 v[38:39], v[38:39], v[70:71]
v_pk_mul_f32 v[70:71], v[64:65], s[58:59] op_sel:[0,1] op_sel_hi:[0,0] neg_lo:[0,1] neg_hi:[0,0]
v_pk_fma_f32 v[70:71], v[64:65], s[58:59], v[70:71] op_sel:[1,0,0] op_sel_hi:[1,1,1] neg_lo:[0,1,0] neg_hi:[0,1,0]
v_pk_add_f32 v[64:65], v[40:41], v[72:73] neg_lo:[0,1] neg_hi:[0,1]
v_pk_add_f32 v[40:41], v[40:41], v[72:73]
v_pk_mul_f32 v[72:73], v[64:65], s[62:63] op_sel:[0,0] op_sel_hi:[0,1] neg_lo:[0,1] neg_hi:[0,0]
v_pk_fma_f32 v[72:73], v[64:65], s[62:63], v[72:73] op_sel:[1,1,0] op_sel_hi:[1,0,1] neg_lo:[0,1,0] neg_hi:[0,1,0]
v_pk_add_f32 v[64:65], v[42:43], v[74:75] neg_lo:[0,1] neg_hi:[0,1]
v_pk_add_f32 v[42:43], v[42:43], v[74:75]
v_pk_mul_f32 v[74:75], v[64:65], s[58:59] op_sel:[0,0] op_sel_hi:[0,1] neg_lo:[0,1] neg_hi:[0,0]
v_pk_fma_f32 v[74:75], v[64:65], s[58:59], v[74:75] op_sel:[1,1,0] op_sel_hi:[1,0,1] neg_lo:[0,1,0] neg_hi:[0,1,0]
v_pk_add_f32 v[64:65], v[44:45], v[76:77] neg_lo:[0,1] neg_hi:[0,1]
v_pk_add_f32 v[44:45], v[44:45], v[76:77]
v_pk_mul_f32 v[76:77], v[64:65], s[54:55] op_sel:[0,0] op_sel_hi:[0,1] neg_lo:[0,1] neg_hi:[0,0]
v_pk_fma_f32 v[76:77], v[64:65], s[54:55], v[76:77] op_sel:[1,1,0] op_sel_hi:[1,0,1] neg_lo:[0,1,0] neg_hi:[0,1,0]
v_pk_add_f32 v[64:65], v[46:47], v[78:79] neg_lo:[0,1] neg_hi:[0,1]
v_pk_add_f32 v[46:47], v[46:47], v[78:79]
v_pk_mul_f32 v[78:79], v[64:65], s[50:51] op_sel:[0,0] op_sel_hi:[0,1] neg_lo:[0,1] neg_hi:[0,0]
v_pk_fma_f32 v[78:79], v[64:65], s[50:51], v[78:79] op_sel:[1,1,0] op_sel_hi:[1,0,1] neg_lo:[0,1,0] neg_hi:[0,1,0]
v_pk_add_f32 v[64:65], v[16:17], v[32:33] neg_lo:[0,1] neg_hi:[0,1]
v_pk_add_f32 v[16:17], v[16:17], v[32:33]
v_pk_add_f32 v[32:33], v[18:19], v[34:35] neg_lo:[0,1] neg_hi:[0,1]
v_pk_add_f32 v[18:19], v[18:19], v[34:35]
v_pk_mul_f32 v[34:35], v[32:33], s[54:55] op_sel:[0,0] op_sel_hi:[0,1] neg_lo:[0,0] neg_hi:[0,0]
v_pk_fma_f32 v[34:35], v[32:33], s[54:55], v[34:35] op_sel:[1,1,0] op_sel_hi:[1,0,1] neg_lo:[0,1,0] neg_hi:[0,0,0]
v_pk_add_f32 v[32:33], v[20:21], v[36:37] neg_lo:[0,1] neg_hi:[0,1]
v_pk_add_f32 v[20:21], v[20:21], v[36:37]
v_pk_mul_f32 v[36:37], v[32:33], s[62:63] op_sel:[0,0] op_sel_hi:[0,1] neg_lo:[0,0] neg_hi:[0,0]
v_pk_fma_f32 v[36:37], v[32:33], s[62:63], v[36:37] op_sel:[1,1,0] op_sel_hi:[1,0,1] neg_lo:[0,1,0] neg_hi:[0,0,0]
v_pk_add_f32 v[32:33], v[22:23], v[38:39] neg_lo:[0,1] neg_hi:[0,1]
v_pk_add_f32 v[22:23], v[22:23], v[38:39]
v_pk_mul_f32 v[38:39], v[32:33], s[54:55] op_sel:[0,1] op_sel_hi:[0,0] neg_lo:[0,0] neg_hi:[0,0]
v_pk_fma_f32 v[38:39], v[32:33], s[54:55], v[38:39] op_sel:[1,0,0] op_sel_hi:[1,1,1] neg_lo:[0,1,0] neg_hi:[0,0,0]
v_pk_add_f32 v[32:33], v[24:25], v[40:41] op_sel:[1,1] op_sel_hi:[0,0] neg_lo:[1,0] neg_hi:[0,1]
v_pk_add_f32 v[24:25], v[24:25], v[40:41]
v_pk_add_f32 v[40:41], v[26:27], v[42:43] neg_lo:[0,1] neg_hi:[0,1]
v_pk_add_f32 v[26:27], v[26:27], v[42:43]
v_pk_mul_f32 v[42:43], v[40:41], s[54:55] op_sel:[0,1] op_sel_hi:[0,0] neg_lo:[0,1] neg_hi:[0,0]
v_pk_fma_f32 v[42:43], v[40:41], s[54:55], v[42:43] op_sel:[1,0,0] op_sel_hi:[1,1,1] neg_lo:[0,1,0] neg_hi:[0,1,0]
v_pk_add_f32 v[40:41], v[28:29], v[44:45] neg_lo:[0,1] neg_hi:[0,1]
v_pk_add_f32 v[28:29], v[28:29], v[44:45]
v_pk_mul_f32 v[44:45], v[40:41], s[62:63] op_sel:[0,0] op_sel_hi:[0,1] neg_lo:[0,1] neg_hi:[0,0]
v_pk_fma_f32 v[44:45], v[40:41], s[62:63], v[44:45] op_sel:[1,1,0] op_sel_hi:[1,0,1] neg_lo:[0,1,0] neg_hi:[0,1,0]
v_pk_add_f32 v[40:41], v[30:31], v[46:47] neg_lo:[0,1] neg_hi:[0,1]
v_pk_add_f32 v[30:31], v[30:31], v[46:47]
v_pk_mul_f32 v[46:47], v[40:41], s[54:55] op_sel:[0,0] op_sel_hi:[0,1] neg_lo:[0,1] neg_hi:[0,0]
v_pk_fma_f32 v[46:47], v[40:41], s[54:55], v[46:47] op_sel:[1,1,0] op_sel_hi:[1,0,1] neg_lo:[0,1,0] neg_hi:[0,1,0]
v_pk_add_f32 v[40:41], v[14:15], v[48:49] neg_lo:[0,1] neg_hi:[0,1]
v_pk_add_f32 v[14:15], v[14:15], v[48:49]
v_pk_add_f32 v[48:49], v[50:51], v[66:67] neg_lo:[0,1] neg_hi:[0,1]
v_pk_add_f32 v[50:51], v[50:51], v[66:67]
v_pk_mul_f32 v[66:67], v[48:49], s[54:55] op_sel:[0,0] op_sel_hi:[0,1] neg_lo:[0,0] neg_hi:[0,0]
v_pk_fma_f32 v[66:67], v[48:49], s[54:55], v[66:67] op_sel:[1,1,0] op_sel_hi:[1,0,1] neg_lo:[0,1,0] neg_hi:[0,0,0]
v_pk_add_f32 v[48:49], v[52:53], v[68:69] neg_lo:[0,1] neg_hi:[0,1]
v_pk_add_f32 v[52:53], v[52:53], v[68:69]
v_pk_mul_f32 v[68:69], v[48:49], s[62:63] op_sel:[0,0] op_sel_hi:[0,1] neg_lo:[0,0] neg_hi:[0,0]
v_pk_fma_f32 v[68:69], v[48:49], s[62:63], v[68:69] op_sel:[1,1,0] op_sel_hi:[1,0,1] neg_lo:[0,1,0] neg_hi:[0,0,0]
v_pk_add_f32 v[48:49], v[54:55], v[70:71] neg_lo:[0,1] neg_hi:[0,1]
v_pk_add_f32 v[54:55], v[54:55], v[70:71]
v_pk_mul_f32 v[70:71], v[48:49], s[54:55] op_sel:[0,1] op_sel_hi:[0,0] neg_lo:[0,0] neg_hi:[0,0]
v_pk_fma_f32 v[70:71], v[48:49], s[54:55], v[70:71] op_sel:[1,0,0] op_sel_hi:[1,1,1] neg_lo:[0,1,0] neg_hi:[0,0,0]
v_pk_add_f32 v[48:49], v[56:57], v[72:73] op_sel:[1,1] op_sel_hi:[0,0] neg_lo:[1,0] neg_hi:[0,1]
v_pk_add_f32 v[56:57], v[56:57], v[72:73]
v_pk_add_f32 v[72:73], v[58:59], v[74:75] neg_lo:[0,1] neg_hi:[0,1]
v_pk_add_f32 v[58:59], v[58:59], v[74:75]
v_pk_mul_f32 v[74:75], v[72:73], s[54:55] op_sel:[0,1] op_sel_hi:[0,0] neg_lo:[0,1] neg_hi:[0,0]
v_pk_fma_f32 v[74:75], v[72:73], s[54:55], v[74:75] op_sel:[1,0,0] op_sel_hi:[1,1,1] neg_lo:[0,1,0] neg_hi:[0,1,0]
v_pk_add_f32 v[72:73], v[60:61], v[76:77] neg_lo:[0,1] neg_hi:[0,1]
v_pk_add_f32 v[60:61], v[60:61], v[76:77]
v_pk_mul_f32 v[76:77], v[72:73], s[62:63] op_sel:[0,0] op_sel_hi:[0,1] neg_lo:[0,1] neg_hi:[0,0]
v_pk_fma_f32 v[76:77], v[72:73], s[62:63], v[76:77] op_sel:[1,1,0] op_sel_hi:[1,0,1] neg_lo:[0,1,0] neg_hi:[0,1,0]
v_pk_add_f32 v[72:73], v[62:63], v[78:79] neg_lo:[0,1] neg_hi:[0,1]
v_pk_add_f32 v[62:63], v[62:63], v[78:79]
v_pk_mul_f32 v[78:79], v[72:73], s[54:55] op_sel:[0,0] op_sel_hi:[0,1] neg_lo:[0,1] neg_hi:[0,0]
v_pk_fma_f32 v[78:79], v[72:73], s[54:55], v[78:79] op_sel:[1,1,0] op_sel_hi:[1,0,1] neg_lo:[0,1,0] neg_hi:[0,1,0]
v_pk_add_f32 v[72:73], v[16:17], v[24:25] neg_lo:[0,1] neg_hi:[0,1]
v_pk_add_f32 v[16:17], v[16:17], v[24:25]
v_pk_add_f32 v[24:25], v[18:19], v[26:27] neg_lo:[0,1] neg_hi:[0,1]
v_pk_add_f32 v[18:19], v[18:19], v[26:27]
v_pk_mul_f32 v[26:27], v[24:25], s[62:63] op_sel:[0,0] op_sel_hi:[0,1] neg_lo:[0,0] neg_hi:[0,0]
v_pk_fma_f32 v[26:27], v[24:25], s[62:63], v[26:27] op_sel:[1,1,0] op_sel_hi:[1,0,1] neg_lo:[0,1,0] neg_hi:[0,0,0]
v_pk_add_f32 v[24:25], v[20:21], v[28:29] op_sel:[1,1] op_sel_hi:[0,0] neg_lo:[1,0] neg_hi:[0,1]
v_pk_add_f32 v[20:21], v[20:21], v[28:29]
v_pk_add_f32 v[28:29], v[22:23], v[30:31] neg_lo:[0,1] neg_hi:[0,1]
v_pk_add_f32 v[22:23], v[22:23], v[30:31]
v_pk_mul_f32 v[30:31], v[28:29], s[62:63] op_sel:[0,0] op_sel_hi:[0,1] neg_lo:[0,1] neg_hi:[0,0]
v_pk_fma_f32 v[30:31], v[28:29], s[62:63], v[30:31] op_sel:[1,1,0] op_sel_hi:[1,0,1] neg_lo:[0,1,0] neg_hi:[0,1,0]
v_pk_add_f32 v[28:29], v[64:65], v[32:33] neg_lo:[0,1] neg_hi:[0,1]
v_pk_add_f32 v[64:65], v[64:65], v[32:33]
v_pk_add_f32 v[32:33], v[34:35], v[42:43] neg_lo:[0,1] neg_hi:[0,1]
v_pk_add_f32 v[34:35], v[34:35], v[42:43]
v_pk_mul_f32 v[42:43], v[32:33], s[62:63] op_sel:[0,0] op_sel_hi:[0,1] neg_lo:[0,0] neg_hi:[0,0]
v_pk_fma_f32 v[42:43], v[32:33], s[62:63], v[42:43] op_sel:[1,1,0] op_sel_hi:[1,0,1] neg_lo:[0,1,0] neg_hi:[0,0,0]
v_pk_add_f32 v[32:33], v[36:37], v[44:45] op_sel:[1,1] op_sel_hi:[0,0] neg_lo:[1,0] neg_hi:[0,1]
v_pk_add_f32 v[36:37], v[36:37], v[44:45]
v_pk_add_f32 v[44:45], v[38:39], v[46:47] neg_lo:[0,1] neg_hi:[0,1]
v_pk_add_f32 v[38:39], v[38:39], v[46:47]
v_pk_mul_f32 v[46:47], v[44:45], s[62:63] op_sel:[0,0] op_sel_hi:[0,1] neg_lo:[0,1] neg_hi:[0,0]
v_pk_fma_f32 v[46:47], v[44:45], s[62:63], v[46:47] op_sel:[1,1,0] op_sel_hi:[1,0,1] neg_lo:[0,1,0] neg_hi:[0,1,0]
v_pk_add_f32 v[44:45], v[14:15], v[56:57] neg_lo:[0,1] neg_hi:[0,1]
v_pk_add_f32 v[14:15], v[14:15], v[56:57]
v_pk_add_f32 v[56:57], v[50:51], v[58:59] neg_lo:[0,1] neg_hi:[0,1]
v_pk_add_f32 v[50:51], v[50:51], v[58:59]
v_pk_mul_f32 v[58:59], v[56:57], s[62:63] op_sel:[0,0] op_sel_hi:[0,1] neg_lo:[0,0] neg_hi:[0,0]
v_pk_fma_f32 v[58:59], v[56:57], s[62:63], v[58:59] op_sel:[1,1,0] op_sel_hi:[1,0,1] neg_lo:[0,1,0] neg_hi:[0,0,0]
v_pk_add_f32 v[56:57], v[52:53], v[60:61] op_sel:[1,1] op_sel_hi:[0,0] neg_lo:[1,0] neg_hi:[0,1]
v_pk_add_f32 v[52:53], v[52:53], v[60:61]
v_pk_add_f32 v[60:61], v[54:55], v[62:63] neg_lo:[0,1] neg_hi:[0,1]
v_pk_add_f32 v[54:55], v[54:55], v[62:63]
v_pk_mul_f32 v[62:63], v[60:61], s[62:63] op_sel:[0,0] op_sel_hi:[0,1] neg_lo:[0,1] neg_hi:[0,0]
v_pk_fma_f32 v[62:63], v[60:61], s[62:63], v[62:63] op_sel:[1,1,0] op_sel_hi:[1,0,1] neg_lo:[0,1,0] neg_hi:[0,1,0]
v_pk_add_f32 v[60:61], v[40:41], v[48:49] neg_lo:[0,1] neg_hi:[0,1]
v_pk_add_f32 v[40:41], v[40:41], v[48:49]
v_pk_add_f32 v[48:49], v[66:67], v[74:75] neg_lo:[0,1] neg_hi:[0,1]
v_pk_add_f32 v[66:67], v[66:67], v[74:75]
v_pk_mul_f32 v[74:75], v[48:49], s[62:63] op_sel:[0,0] op_sel_hi:[0,1] neg_lo:[0,0] neg_hi:[0,0]
v_pk_fma_f32 v[74:75], v[48:49], s[62:63], v[74:75] op_sel:[1,1,0] op_sel_hi:[1,0,1] neg_lo:[0,1,0] neg_hi:[0,0,0]
v_pk_add_f32 v[48:49], v[68:69], v[76:77] op_sel:[1,1] op_sel_hi:[0,0] neg_lo:[1,0] neg_hi:[0,1]
v_pk_add_f32 v[68:69], v[68:69], v[76:77]
v_pk_add_f32 v[76:77], v[70:71], v[78:79] neg_lo:[0,1] neg_hi:[0,1]
v_pk_add_f32 v[70:71], v[70:71], v[78:79]
v_pk_mul_f32 v[78:79], v[76:77], s[62:63] op_sel:[0,0] op_sel_hi:[0,1] neg_lo:[0,1] neg_hi:[0,0]
v_pk_fma_f32 v[78:79], v[76:77], s[62:63], v[78:79] op_sel:[1,1,0] op_sel_hi:[1,0,1] neg_lo:[0,1,0] neg_hi:[0,1,0]
v_pk_add_f32 v[76:77], v[16:17], v[20:21] neg_lo:[0,1] neg_hi:[0,1]
v_pk_add_f32 v[16:17], v[16:17], v[20:21]
v_pk_add_f32 v[20:21], v[18:19], v[22:23] op_sel:[1,1] op_sel_hi:[0,0] neg_lo:[1,0] neg_hi:[0,1]
v_pk_add_f32 v[18:19], v[18:19], v[22:23]
v_pk_add_f32 v[22:23], v[72:73], v[24:25] neg_lo:[0,1] neg_hi:[0,1]
v_pk_add_f32 v[72:73], v[72:73], v[24:25]
v_pk_add_f32 v[24:25], v[26:27], v[30:31] op_sel:[1,1] op_sel_hi:[0,0] neg_lo:[1,0] neg_hi:[0,1]
v_pk_add_f32 v[26:27], v[26:27], v[30:31]
v_pk_add_f32 v[30:31], v[64:65], v[36:37] neg_lo:[0,1] neg_hi:[0,1]
v_pk_add_f32 v[64:65], v[64:65], v[36:37]
v_pk_add_f32 v[36:37], v[34:35], v[38:39] op_sel:[1,1] op_sel_hi:[0,0] neg_lo:[1,0] neg_hi:[0,1]
v_pk_add_f32 v[34:35], v[34:35], v[38:39]
v_pk_add_f32 v[38:39], v[28:29], v[32:33] neg_lo:[0,1] neg_hi:[0,1]
v_pk_add_f32 v[28:29], v[28:29], v[32:33]
v_pk_add_f32 v[32:33], v[42:43], v[46:47] op_sel:[1,1] op_sel_hi:[0,0] neg_lo:[1,0] neg_hi:[0,1]
v_pk_add_f32 v[42:43], v[42:43], v[46:47]
v_pk_add_f32 v[46:47], v[14:15], v[52:53] neg_lo:[0,1] neg_hi:[0,1]
v_pk_add_f32 v[14:15], v[14:15], v[52:53]
v_pk_add_f32 v[52:53], v[50:51], v[54:55] op_sel:[1,1] op_sel_hi:[0,0] neg_lo:[1,0] neg_hi:[0,1]
v_pk_add_f32 v[50:51], v[50:51], v[54:55]
v_pk_add_f32 v[54:55], v[44:45], v[56:57] neg_lo:[0,1] neg_hi:[0,1]
v_pk_add_f32 v[44:45], v[44:45], v[56:57]
v_pk_add_f32 v[56:57], v[58:59], v[62:63] op_sel:[1,1] op_sel_hi:[0,0] neg_lo:[1,0] neg_hi:[0,1]
v_pk_add_f32 v[58:59], v[58:59], v[62:63]
v_pk_add_f32 v[62:63], v[40:41], v[68:69] neg_lo:[0,1] neg_hi:[0,1]
v_pk_add_f32 v[40:41], v[40:41], v[68:69]
v_pk_add_f32 v[68:69], v[66:67], v[70:71] op_sel:[1,1] op_sel_hi:[0,0] neg_lo:[1,0] neg_hi:[0,1]
v_pk_add_f32 v[66:67], v[66:67], v[70:71]
v_pk_add_f32 v[70:71], v[60:61], v[48:49] neg_lo:[0,1] neg_hi:[0,1]
v_pk_add_f32 v[60:61], v[60:61], v[48:49]
v_pk_add_f32 v[48:49], v[74:75], v[78:79] op_sel:[1,1] op_sel_hi:[0,0] neg_lo:[1,0] neg_hi:[0,1]
v_pk_add_f32 v[74:75], v[74:75], v[78:79]
v_pk_add_f32 v[78:79], v[16:17], v[18:19] neg_lo:[0,1] neg_hi:[0,1]
v_pk_add_f32 v[16:17], v[16:17], v[18:19]
v_pk_add_f32 v[18:19], v[76:77], v[20:21] neg_lo:[0,1] neg_hi:[0,1]
v_pk_add_f32 v[76:77], v[76:77], v[20:21]
v_pk_add_f32 v[20:21], v[72:73], v[26:27] neg_lo:[0,1] neg_hi:[0,1]
v_pk_add_f32 v[72:73], v[72:73], v[26:27]
v_pk_add_f32 v[26:27], v[22:23], v[24:25] neg_lo:[0,1] neg_hi:[0,1]
v_pk_add_f32 v[22:23], v[22:23], v[24:25]
v_pk_add_f32 v[24:25], v[64:65], v[34:35] neg_lo:[0,1] neg_hi:[0,1]
v_pk_add_f32 v[64:65], v[64:65], v[34:35]
v_pk_add_f32 v[34:35], v[30:31], v[36:37] neg_lo:[0,1] neg_hi:[0,1]
v_pk_add_f32 v[30:31], v[30:31], v[36:37]
v_pk_add_f32 v[36:37], v[28:29], v[42:43] neg_lo:[0,1] neg_hi:[0,1]
v_pk_add_f32 v[28:29], v[28:29], v[42:43]
v_pk_add_f32 v[42:43], v[38:39], v[32:33] neg_lo:[0,1] neg_hi:[0,1]
v_pk_add_f32 v[38:39], v[38:39], v[32:33]
v_pk_add_f32 v[32:33], v[14:15], v[50:51] neg_lo:[0,1] neg_hi:[0,1]
v_pk_add_f32 v[14:15], v[14:15], v[50:51]
v_pk_add_f32 v[50:51], v[46:47], v[52:53] neg_lo:[0,1] neg_hi:[0,1]
v_pk_add_f32 v[46:47], v[46:47], v[52:53]
v_pk_add_f32 v[52:53], v[44:45], v[58:59] neg_lo:[0,1] neg_hi:[0,1]
v_pk_add_f32 v[44:45], v[44:45], v[58:59]
v_pk_add_f32 v[58:59], v[54:55], v[56:57] neg_lo:[0,1] neg_hi:[0,1]
v_pk_add_f32 v[54:55], v[54:55], v[56:57]
v_pk_add_f32 v[56:57], v[40:41], v[66:67] neg_lo:[0,1] neg_hi:[0,1]
v_pk_add_f32 v[40:41], v[40:41], v[66:67]
v_pk_add_f32 v[66:67], v[62:63], v[68:69] neg_lo:[0,1] neg_hi:[0,1]
v_pk_add_f32 v[62:63], v[62:63], v[68:69]
v_pk_add_f32 v[68:69], v[60:61], v[74:75] neg_lo:[0,1] neg_hi:[0,1]
v_pk_add_f32 v[60:61], v[60:61], v[74:75]
v_pk_add_f32 v[74:75], v[70:71], v[48:49] neg_lo:[0,1] neg_hi:[0,1]
v_pk_add_f32 v[70:71], v[70:71], v[48:49]
ds_write2st64_b32 v12, v16, v17 offset0:0 offset1:16
ds_write_b32 v12, v14 offset:128
ds_write_b32 v12, v15 offset:4224
ds_write_b32 v12, v64 offset:256
ds_write_b32 v12, v65 offset:4352
ds_write_b32 v12, v40 offset:384
ds_write_b32 v12, v41 offset:4480
ds_write_b32 v12, v72 offset:512
ds_write_b32 v12, v73 offset:4608
ds_write_b32 v12, v44 offset:640
ds_write_b32 v12, v45 offset:4736
ds_write_b32 v12, v28 offset:768
ds_write_b32 v12, v29 offset:4864
ds_write_b32 v12, v60 offset:896
ds_write_b32 v12, v61 offset:4992
ds_write_b32 v12, v76 offset:1024
ds_write_b32 v12, v77 offset:5120
ds_write_b32 v12, v46 offset:1152
ds_write_b32 v12, v47 offset:5248
ds_write_b32 v12, v30 offset:1280
ds_write_b32 v12, v31 offset:5376
ds_write_b32 v12, v62 offset:1408
ds_write_b32 v12, v63 offset:5504
ds_write_b32 v12, v22 offset:1536
ds_write_b32 v12, v23 offset:5632
ds_write_b32 v12, v54 offset:1664
ds_write_b32 v12, v55 offset:5760
ds_write_b32 v12, v38 offset:1792
ds_write_b32 v12, v39 offset:5888
ds_write_b32 v12, v70 offset:1920
ds_write_b32 v12, v71 offset:6016
ds_write_b32 v12, v78 offset:2048
ds_write_b32 v12, v79 offset:6144
ds_write_b32 v12, v32 offset:2176
ds_write_b32 v12, v33 offset:6272
ds_write_b32 v12, v24 offset:2304
ds_write_b32 v12, v25 offset:6400
ds_write_b32 v12, v56 offset:2432
ds_write_b32 v12, v57 offset:6528
ds_write_b32 v12, v20 offset:2560
ds_write_b32 v12, v21 offset:6656
ds_write_b32 v12, v52 offset:2688
ds_write_b32 v12, v53 offset:6784
ds_write_b32 v12, v36 offset:2816
ds_write_b32 v12, v37 offset:6912
ds_write_b32 v12, v68 offset:2944
ds_write_b32 v12, v69 offset:7040
ds_write_b32 v12, v18 offset:3072
ds_write_b32 v12, v19 offset:7168
ds_write_b32 v12, v50 offset:3200
ds_write_b32 v12, v51 offset:7296
ds_write_b32 v12, v34 offset:3328
ds_write_b32 v12, v35 offset:7424
ds_write_b32 v12, v66 offset:3456
ds_write_b32 v12, v67 offset:7552
ds_write_b32 v12, v26 offset:3584
ds_write_b32 v12, v27 offset:7680
ds_write_b32 v12, v58 offset:3712
ds_write_b32 v12, v59 offset:7808
ds_write_b32 v12, v42 offset:3840
ds_write_b32 v12, v43 offset:7936
ds_write_b32 v12, v74 offset:3968
ds_write_b32 v12, v75 offset:8064
s_waitcnt lgkmcnt(0)
s_barrier
s_lshl_b32 s13, s93, 16
ds_read_b128 v[16:19], v2 offset:0
ds_read_b128 v[20:23], v2 offset:16
ds_read_b128 v[24:27], v2 offset:8448
ds_read_b128 v[28:31], v2 offset:8464
ds_read_b128 v[32:35], v2 offset:16896
ds_read_b128 v[36:39], v2 offset:16912
ds_read_b128 v[40:43], v2 offset:25344
ds_read_b128 v[44:47], v2 offset:25360
ds_read_b128 v[48:51], v2 offset:33792
ds_read_b128 v[52:55], v2 offset:33808
ds_read_b128 v[56:59], v2 offset:42240
ds_read_b128 v[60:63], v2 offset:42256
ds_read_b128 v[64:67], v2 offset:50688
ds_read_b128 v[68:71], v2 offset:50704
s_waitcnt lgkmcnt(12)
ds_read_b128 v[72:75], v2 offset:59136
ds_read_b128 v[76:79], v2 offset:59152
s_waitcnt lgkmcnt(14)
v_cvt_pk_bf16_f32 v216, v16, v17
v_cvt_pk_bf16_f32 v217, v18, v19
v_cvt_pk_bf16_f32 v218, v20, v21
v_cvt_pk_bf16_f32 v219, v22, v23
buffer_store_dwordx4 v[216:219], v3, s[4:7], s13 offen sc1
s_add_u32 s13, s13, 8192
s_waitcnt lgkmcnt(12)
v_cvt_pk_bf16_f32 v220, v24, v25
v_cvt_pk_bf16_f32 v221, v26, v27
v_cvt_pk_bf16_f32 v222, v28, v29
v_cvt_pk_bf16_f32 v223, v30, v31
buffer_store_dwordx4 v[220:223], v3, s[4:7], s13 offen sc1
s_add_u32 s13, s13, 8192
s_waitcnt lgkmcnt(10)
v_cvt_pk_bf16_f32 v224, v32, v33
v_cvt_pk_bf16_f32 v225, v34, v35
v_cvt_pk_bf16_f32 v226, v36, v37
v_cvt_pk_bf16_f32 v227, v38, v39
buffer_store_dwordx4 v[224:227], v3, s[4:7], s13 offen sc1
s_add_u32 s13, s13, 8192
s_waitcnt lgkmcnt(8)
v_cvt_pk_bf16_f32 v228, v40, v41
v_cvt_pk_bf16_f32 v229, v42, v43
v_cvt_pk_bf16_f32 v230, v44, v45
v_cvt_pk_bf16_f32 v231, v46, v47
buffer_store_dwordx4 v[228:231], v3, s[4:7], s13 offen sc1
s_add_u32 s13, s13, 8192
s_waitcnt lgkmcnt(6)
v_cvt_pk_bf16_f32 v232, v48, v49
v_cvt_pk_bf16_f32 v233, v50, v51
v_cvt_pk_bf16_f32 v234, v52, v53
v_cvt_pk_bf16_f32 v235, v54, v55
buffer_store_dwordx4 v[232:235], v3, s[4:7], s13 offen sc1
s_add_u32 s13, s13, 8192
s_waitcnt lgkmcnt(4)
v_cvt_pk_bf16_f32 v236, v56, v57
v_cvt_pk_bf16_f32 v237, v58, v59
v_cvt_pk_bf16_f32 v238, v60, v61
v_cvt_pk_bf16_f32 v239, v62, v63
buffer_store_dwordx4 v[236:239], v3, s[4:7], s13 offen sc1
s_add_u32 s13, s13, 8192
s_waitcnt lgkmcnt(2)
v_cvt_pk_bf16_f32 v240, v64, v65
v_cvt_pk_bf16_f32 v241, v66, v67
v_cvt_pk_bf16_f32 v242, v68, v69
v_cvt_pk_bf16_f32 v243, v70, v71
buffer_store_dwordx4 v[240:243], v3, s[4:7], s13 offen sc1
s_add_u32 s13, s13, 8192
s_waitcnt lgkmcnt(0)
v_cvt_pk_bf16_f32 v244, v72, v73
v_cvt_pk_bf16_f32 v245, v74, v75
v_cvt_pk_bf16_f32 v246, v76, v77
v_cvt_pk_bf16_f32 v247, v78, v79
buffer_store_dwordx4 v[244:247], v3, s[4:7], s13 offen sc1
s_add_u32 s13, s13, 8192
s_mov_b32 s93, s21
s_cmp_lt_u32 s93, 128
s_cbranch_scc1 mega_kernel_f3_l
mega_kernel_f3_e:
s_waitcnt vmcnt(0)
s_barrier
s_add_u32 s64, s91, 58
s_mov_b32 s65, 64
s_mov_b32 s67, 1
s_add_u32 s66, s66, 262144
s_cmp_eq_u32 s91, 0
s_cbranch_scc1 mega_kernel_out
s_lshr_b32 s66, s40, 2
s_lshl_b32 s66, s66, 16
s_and_b32 s76, s40, 3
s_lshl_b32 s76, s76, 13
s_add_u32 s66, s66, s76
s_add_u32 s66, s66, 67141632
mega_kernel_out:
s_load_dwordx2 s[4:5], s[0:1], 40
s_load_dwordx2 s[8:9], s[0:1], 80
v_lshrrev_b32 v2, 6, v0
v_and_b32 v1, 63, v0
v_readfirstlane_b32 s41, v2
v_lshlrev_b32 v5, 4, v1
s_waitcnt lgkmcnt(0)
s_mov_b32 s6, 8388608
s_mov_b32 s7, 0x00020000
s_mov_b32 s10, 8388608
s_mov_b32 s11, 0x00020000
s_and_b32 s58, s40, 1
s_lshr_b32 s59, s40, 1
s_lshl_b32 s43, s58, 22
s_lshl_b32 s44, s41, 20
s_add_u32 s43, s43, s44
s_lshl_b32 s44, s59, 7
s_add_u32 s48, s43, s44
s_and_b32 s56, s59, 7
s_lshl_b32 s56, s56, 6
s_cmp_eq_u32 s68, 2
s_cbranch_scc1 mega_kernel_o_hw
v_lshrrev_b32 v2, 3, v1
v_and_b32 v3, 7, v1
v_lshlrev_b32 v16, 11, v2
v_lshl_add_u32 v16, v3, 4, v16
v_add_u32 v16, s48, v16
v_and_b32 v3, 3, v1
s_lshl_b32 s45, s41, 15
v_bfe_u32 v17, v1, 2, 2
v_lshrrev_b32 v18, 5, v1
v_mul_u32_u24 v18, 4, v18
v_add_u32 v17, v17, v18
v_lshlrev_b32 v17, 7, v17
v_bfe_u32 v18, v1, 4, 1
v_lshl_add_u32 v17, v18, 5, v17
v_lshl_add_u32 v17, v3, 3, v17
v_add_u32 v17, s45, v17
s_add_u32 m0, s45, 0
s_add_u32 s44, s56, 0
s_and_b32 s44, s44, 511
s_lshl_b32 s44, s44, 11
buffer_load_dwordx4 v16, s[4:7], s44 offen lds
s_add_u32 m0, s45, 1024
s_add_u32 s44, s56, 8
s_and_b32 s44, s44, 511
s_lshl_b32 s44, s44, 11
buffer_load_dwordx4 v16, s[4:7], s44 offen lds
s_add_u32 m0, s45, 2048
s_add_u32 s44, s56, 16
s_and_b32 s44, s44, 511
s_lshl_b32 s44, s44, 11
buffer_load_dwordx4 v16, s[4:7], s44 offen lds
s_add_u32 m0, s45, 3072
s_add_u32 s44, s56, 24
s_and_b32 s44, s44, 511
s_lshl_b32 s44, s44, 11
buffer_load_dwordx4 v16, s[4:7], s44 offen lds
s_add_u32 m0, s45, 4096
s_add_u32 s44, s56, 32
s_and_b32 s44, s44, 511
s_lshl_b32 s44, s44, 11
buffer_load_dwordx4 v16, s[4:7], s44 offen lds
s_add_u32 m0, s45, 5120
s_add_u32 s44, s56, 40
s_and_b32 s44, s44, 511
s_lshl_b32 s44, s44, 11
buffer_load_dwordx4 v16, s[4:7], s44 offen lds
s_add_u32 m0, s45, 6144
s_add_u32 s44, s56, 48
s_and_b32 s44, s44, 511
s_lshl_b32 s44, s44, 11
buffer_load_dwordx4 v16, s[4:7], s44 offen lds
s_add_u32 m0, s45, 7168
s_add_u32 s44, s56, 56
s_and_b32 s44, s44, 511
s_lshl_b32 s44, s44, 11
buffer_load_dwordx4 v16, s[4:7], s44 offen lds
s_add_u32 m0, s45, 8192
s_add_u32 s44, s56, 64
s_and_b32 s44, s44, 511
s_lshl_b32 s44, s44, 11
buffer_load_dwordx4 v16, s[4:7], s44 offen lds
s_add_u32 m0, s45, 9216
s_add_u32 s44, s56, 72
s_and_b32 s44, s44, 511
s_lshl_b32 s44, s44, 11
buffer_load_dwordx4 v16, s[4:7], s44 offen lds
s_add_u32 m0, s45, 10240
s_add_u32 s44, s56, 80
s_and_b32 s44, s44, 511
s_lshl_b32 s44, s44, 11
buffer_load_dwordx4 v16, s[4:7], s44 offen lds
s_add_u32 m0, s45, 11264
s_add_u32 s44, s56, 88
s_and_b32 s44, s44, 511
s_lshl_b32 s44, s44, 11
buffer_load_dwordx4 v16, s[4:7], s44 offen lds
s_add_u32 m0, s45, 12288
s_add_u32 s44, s56, 96
s_and_b32 s44, s44, 511
s_lshl_b32 s44, s44, 11
buffer_load_dwordx4 v16, s[4:7], s44 offen lds
s_add_u32 m0, s45, 13312
s_add_u32 s44, s56, 104
s_and_b32 s44, s44, 511
s_lshl_b32 s44, s44, 11
buffer_load_dwordx4 v16, s[4:7], s44 offen lds
s_add_u32 m0, s45, 14336
s_add_u32 s44, s56, 112
s_and_b32 s44, s44, 511
s_lshl_b32 s44, s44, 11
buffer_load_dwordx4 v16, s[4:7], s44 offen lds
s_add_u32 m0, s45, 15360
s_add_u32 s44, s56, 120
s_and_b32 s44, s44, 511
s_lshl_b32 s44, s44, 11
buffer_load_dwordx4 v16, s[4:7], s44 offen lds
s_add_u32 m0, s45, 16384
s_add_u32 s44, s56, 128
s_and_b32 s44, s44, 511
s_lshl_b32 s44, s44, 11
buffer_load_dwordx4 v16, s[4:7], s44 offen lds
s_add_u32 m0, s45, 17408
s_add_u32 s44, s56, 136
s_and_b32 s44, s44, 511
s_lshl_b32 s44, s44, 11
buffer_load_dwordx4 v16, s[4:7], s44 offen lds
s_add_u32 m0, s45, 18432
s_add_u32 s44, s56, 144
s_and_b32 s44, s44, 511
s_lshl_b32 s44, s44, 11
buffer_load_dwordx4 v16, s[4:7], s44 offen lds
s_add_u32 m0, s45, 19456
s_add_u32 s44, s56, 152
s_and_b32 s44, s44, 511
s_lshl_b32 s44, s44, 11
buffer_load_dwordx4 v16, s[4:7], s44 offen lds
s_add_u32 m0, s45, 20480
s_add_u32 s44, s56, 160
s_and_b32 s44, s44, 511
s_lshl_b32 s44, s44, 11
buffer_load_dwordx4 v16, s[4:7], s44 offen lds
s_add_u32 m0, s45, 21504
s_add_u32 s44, s56, 168
s_and_b32 s44, s44, 511
s_lshl_b32 s44, s44, 11
buffer_load_dwordx4 v16, s[4:7], s44 offen lds
s_add_u32 m0, s45, 22528
s_add_u32 s44, s56, 176
s_and_b32 s44, s44, 511
s_lshl_b32 s44, s44, 11
buffer_load_dwordx4 v16, s[4:7], s44 offen lds
s_add_u32 m0, s45, 23552
s_add_u32 s44, s56, 184
s_and_b32 s44, s44, 511
s_lshl_b32 s44, s44, 11
buffer_load_dwordx4 v16, s[4:7], s44 offen lds
s_add_u32 m0, s45, 24576
s_add_u32 s44, s56, 192
s_and_b32 s44, s44, 511
s_lshl_b32 s44, s44, 11
buffer_load_dwordx4 v16, s[4:7], s44 offen lds
s_add_u32 m0, s45, 25600
s_add_u32 s44, s56, 200
s_and_b32 s44, s44, 511
s_lshl_b32 s44, s44, 11
buffer_load_dwordx4 v16, s[4:7], s44 offen lds
s_add_u32 m0, s45, 26624
s_add_u32 s44, s56, 208
s_and_b32 s44, s44, 511
s_lshl_b32 s44, s44, 11
buffer_load_dwordx4 v16, s[4:7], s44 offen lds
s_add_u32 m0, s45, 27648
s_add_u32 s44, s56, 216
s_and_b32 s44, s44, 511
s_lshl_b32 s44, s44, 11
buffer_load_dwordx4 v16, s[4:7], s44 offen lds
s_add_u32 m0, s45, 28672
s_add_u32 s44, s56, 224
s_and_b32 s44, s44, 511
s_lshl_b32 s44, s44, 11
buffer_load_dwordx4 v16, s[4:7], s44 offen lds
s_add_u32 m0, s45, 29696
s_add_u32 s44, s56, 232
s_and_b32 s44, s44, 511
s_lshl_b32 s44, s44, 11
buffer_load_dwordx4 v16, s[4:7], s44 offen lds
s_add_u32 m0, s45, 30720
s_add_u32 s44, s56, 240
s_and_b32 s44, s44, 511
s_lshl_b32 s44, s44, 11
buffer_load_dwordx4 v16, s[4:7], s44 offen lds
s_add_u32 m0, s45, 31744
s_add_u32 s44, s56, 248
s_and_b32 s44, s44, 511
s_lshl_b32 s44, s44, 11
buffer_load_dwordx4 v16, s[4:7], s44 offen lds
s_waitcnt vmcnt(16)
ds_read_b64_tr_b16 a[0:1], v17 offset:0
ds_read_b64_tr_b16 a[2:3], v17 offset:2048
ds_read_b64_tr_b16 a[4:5], v17 offset:64
ds_read_b64_tr_b16 a[6:7], v17 offset:2112
ds_read_b64_tr_b16 a[8:9], v17 offset:1024
ds_read_b64_tr_b16 a[10:11], v17 offset:3072
ds_read_b64_tr_b16 a[12:13], v17 offset:1088
ds_read_b64_tr_b16 a[14:15], v17 offset:3136
s_waitcnt lgkmcnt(0)
ds_read_b64_tr_b16 a[16:17], v17 offset:4096
ds_read_b64_tr_b16 a[18:19], v17 offset:6144
ds_read_b64_tr_b16 a[20:21], v17 offset:4160
ds_read_b64_tr_b16 a[22:23], v17 offset:6208
ds_read_b64_tr_b16 a[24:25], v17 offset:5120
ds_read_b64_tr_b16 a[26:27], v17 offset:7168
ds_read_b64_tr_b16 a[28:29], v17 offset:5184
ds_read_b64_tr_b16 a[30:31], v17 offset:7232
s_waitcnt lgkmcnt(0)
ds_read_b64_tr_b16 a[32:33], v17 offset:8192
ds_read_b64_tr_b16 a[34:35], v17 offset:10240
ds_read_b64_tr_b16 a[36:37], v17 offset:8256
ds_read_b64_tr_b16 a[38:39], v17 offset:10304
ds_read_b64_tr_b16 a[40:41], v17 offset:9216
ds_read_b64_tr_b16 a[42:43], v17 offset:11264
ds_read_b64_tr_b16 a[44:45], v17 offset:9280
ds_read_b64_tr_b16 a[46:47], v17 offset:11328
s_waitcnt lgkmcnt(0)
ds_read_b64_tr_b16 a[48:49], v17 offset:12288
ds_read_b64_tr_b16 a[50:51], v17 offset:14336
ds_read_b64_tr_b16 a[52:53], v17 offset:12352
ds_read_b64_tr_b16 a[54:55], v17 offset:14400
ds_read_b64_tr_b16 a[56:57], v17 offset:13312
ds_read_b64_tr_b16 a[58:59], v17 offset:15360
ds_read_b64_tr_b16 a[60:61], v17 offset:13376
ds_read_b64_tr_b16 a[62:63], v17 offset:15424
s_waitcnt lgkmcnt(0)
s_add_u32 m0, s45, 0
s_add_u32 s44, s56, 256
s_and_b32 s44, s44, 511
s_lshl_b32 s44, s44, 11
buffer_load_dwordx4 v16, s[4:7], s44 offen lds
s_add_u32 m0, s45, 1024
s_add_u32 s44, s56, 264
s_and_b32 s44, s44, 511
s_lshl_b32 s44, s44, 11
buffer_load_dwordx4 v16, s[4:7], s44 offen lds
s_add_u32 m0, s45, 2048
s_add_u32 s44, s56, 272
s_and_b32 s44, s44, 511
s_lshl_b32 s44, s44, 11
buffer_load_dwordx4 v16, s[4:7], s44 offen lds
s_add_u32 m0, s45, 3072
s_add_u32 s44, s56, 280
s_and_b32 s44, s44, 511
s_lshl_b32 s44, s44, 11
buffer_load_dwordx4 v16, s[4:7], s44 offen lds
s_add_u32 m0, s45, 4096
s_add_u32 s44, s56, 288
s_and_b32 s44, s44, 511
s_lshl_b32 s44, s44, 11
buffer_load_dwordx4 v16, s[4:7], s44 offen lds
s_add_u32 m0, s45, 5120
s_add_u32 s44, s56, 296
s_and_b32 s44, s44, 511
s_lshl_b32 s44, s44, 11
buffer_load_dwordx4 v16, s[4:7], s44 offen lds
s_add_u32 m0, s45, 6144
s_add_u32 s44, s56, 304
s_and_b32 s44, s44, 511
s_lshl_b32 s44, s44, 11
buffer_load_dwordx4 v16, s[4:7], s44 offen lds
s_add_u32 m0, s45, 7168
s_add_u32 s44, s56, 312
s_and_b32 s44, s44, 511
s_lshl_b32 s44, s44, 11
buffer_load_dwordx4 v16, s[4:7], s44 offen lds
s_add_u32 m0, s45, 8192
s_add_u32 s44, s56, 320
s_and_b32 s44, s44, 511
s_lshl_b32 s44, s44, 11
buffer_load_dwordx4 v16, s[4:7], s44 offen lds
s_add_u32 m0, s45, 9216
s_add_u32 s44, s56, 328
s_and_b32 s44, s44, 511
s_lshl_b32 s44, s44, 11
buffer_load_dwordx4 v16, s[4:7], s44 offen lds
s_add_u32 m0, s45, 10240
s_add_u32 s44, s56, 336
s_and_b32 s44, s44, 511
s_lshl_b32 s44, s44, 11
buffer_load_dwordx4 v16, s[4:7], s44 offen lds
s_add_u32 m0, s45, 11264
s_add_u32 s44, s56, 344
s_and_b32 s44, s44, 511
s_lshl_b32 s44, s44, 11
buffer_load_dwordx4 v16, s[4:7], s44 offen lds
s_add_u32 m0, s45, 12288
s_add_u32 s44, s56, 352
s_and_b32 s44, s44, 511
s_lshl_b32 s44, s44, 11
buffer_load_dwordx4 v16, s[4:7], s44 offen lds
s_add_u32 m0, s45, 13312
s_add_u32 s44, s56, 360
s_and_b32 s44, s44, 511
s_lshl_b32 s44, s44, 11
buffer_load_dwordx4 v16, s[4:7], s44 offen lds
s_add_u32 m0, s45, 14336
s_add_u32 s44, s56, 368
s_and_b32 s44, s44, 511
s_lshl_b32 s44, s44, 11
buffer_load_dwordx4 v16, s[4:7], s44 offen lds
s_add_u32 m0, s45, 15360
s_add_u32 s44, s56, 376
s_and_b32 s44, s44, 511
s_lshl_b32 s44, s44, 11
buffer_load_dwordx4 v16, s[4:7], s44 offen lds
s_waitcnt vmcnt(16)
ds_read_b64_tr_b16 a[64:65], v17 offset:16384
ds_read_b64_tr_b16 a[66:67], v17 offset:18432
ds_read_b64_tr_b16 a[68:69], v17 offset:16448
ds_read_b64_tr_b16 a[70:71], v17 offset:18496
ds_read_b64_tr_b16 a[72:73], v17 offset:17408
ds_read_b64_tr_b16 a[74:75], v17 offset:19456
ds_read_b64_tr_b16 a[76:77], v17 offset:17472
ds_read_b64_tr_b16 a[78:79], v17 offset:19520
s_waitcnt lgkmcnt(0)
ds_read_b64_tr_b16 a[80:81], v17 offset:20480
ds_read_b64_tr_b16 a[82:83], v17 offset:22528
ds_read_b64_tr_b16 a[84:85], v17 offset:20544
ds_read_b64_tr_b16 a[86:87], v17 offset:22592
ds_read_b64_tr_b16 a[88:89], v17 offset:21504
ds_read_b64_tr_b16 a[90:91], v17 offset:23552
ds_read_b64_tr_b16 a[92:93], v17 offset:21568
ds_read_b64_tr_b16 a[94:95], v17 offset:23616
s_waitcnt lgkmcnt(0)
ds_read_b64_tr_b16 a[96:97], v17 offset:24576
ds_read_b64_tr_b16 a[98:99], v17 offset:26624
ds_read_b64_tr_b16 a[100:101], v17 offset:24640
ds_read_b64_tr_b16 a[102:103], v17 offset:26688
ds_read_b64_tr_b16 a[104:105], v17 offset:25600
ds_read_b64_tr_b16 a[106:107], v17 offset:27648
ds_read_b64_tr_b16 a[108:109], v17 offset:25664
ds_read_b64_tr_b16 a[110:111], v17 offset:27712
s_waitcnt lgkmcnt(0)
ds_read_b64_tr_b16 a[112:113], v17 offset:28672
ds_read_b64_tr_b16 a[114:115], v17 offset:30720
ds_read_b64_tr_b16 a[116:117], v17 offset:28736
ds_read_b64_tr_b16 a[118:119], v17 offset:30784
ds_read_b64_tr_b16 a[120:121], v17 offset:29696
ds_read_b64_tr_b16 a[122:123], v17 offset:31744
ds_read_b64_tr_b16 a[124:125], v17 offset:29760
ds_read_b64_tr_b16 a[126:127], v17 offset:31808
s_waitcnt lgkmcnt(0)
s_add_u32 m0, s45, 16384
s_add_u32 s44, s56, 384
s_and_b32 s44, s44, 511
s_lshl_b32 s44, s44, 11
buffer_load_dwordx4 v16, s[4:7], s44 offen lds
s_add_u32 m0, s45, 17408
s_add_u32 s44, s56, 392
s_and_b32 s44, s44, 511
s_lshl_b32 s44, s44, 11
buffer_load_dwordx4 v16, s[4:7], s44 offen lds
s_add_u32 m0, s45, 18432
s_add_u32 s44, s56, 400
s_and_b32 s44, s44, 511
s_lshl_b32 s44, s44, 11
buffer_load_dwordx4 v16, s[4:7], s44 offen lds
s_add_u32 m0, s45, 19456
s_add_u32 s44, s56, 408
s_and_b32 s44, s44, 511
s_lshl_b32 s44, s44, 11
buffer_load_dwordx4 v16, s[4:7], s44 offen lds
s_add_u32 m0, s45, 20480
s_add_u32 s44, s56, 416
s_and_b32 s44, s44, 511
s_lshl_b32 s44, s44, 11
buffer_load_dwordx4 v16, s[4:7], s44 offen lds
s_add_u32 m0, s45, 21504
s_add_u32 s44, s56, 424
s_and_b32 s44, s44, 511
s_lshl_b32 s44, s44, 11
buffer_load_dwordx4 v16, s[4:7], s44 offen lds
s_add_u32 m0, s45, 22528
s_add_u32 s44, s56, 432
s_and_b32 s44, s44, 511
s_lshl_b32 s44, s44, 11
buffer_load_dwordx4 v16, s[4:7], s44 offen lds
s_add_u32 m0, s45, 23552
s_add_u32 s44, s56, 440
s_and_b32 s44, s44, 511
s_lshl_b32 s44, s44, 11
buffer_load_dwordx4 v16, s[4:7], s44 offen lds
s_add_u32 m0, s45, 24576
s_add_u32 s44, s56, 448
s_and_b32 s44, s44, 511
s_lshl_b32 s44, s44, 11
buffer_load_dwordx4 v16, s[4:7], s44 offen lds
s_add_u32 m0, s45, 25600
s_add_u32 s44, s56, 456
s_and_b32 s44, s44, 511
s_lshl_b32 s44, s44, 11
buffer_load_dwordx4 v16, s[4:7], s44 offen lds
s_add_u32 m0, s45, 26624
s_add_u32 s44, s56, 464
s_and_b32 s44, s44, 511
s_lshl_b32 s44, s44, 11
buffer_load_dwordx4 v16, s[4:7], s44 offen lds
s_add_u32 m0, s45, 27648
s_add_u32 s44, s56, 472
s_and_b32 s44, s44, 511
s_lshl_b32 s44, s44, 11
buffer_load_dwordx4 v16, s[4:7], s44 offen lds
s_add_u32 m0, s45, 28672
s_add_u32 s44, s56, 480
s_and_b32 s44, s44, 511
s_lshl_b32 s44, s44, 11
buffer_load_dwordx4 v16, s[4:7], s44 offen lds
s_add_u32 m0, s45, 29696
s_add_u32 s44, s56, 488
s_and_b32 s44, s44, 511
s_lshl_b32 s44, s44, 11
buffer_load_dwordx4 v16, s[4:7], s44 offen lds
s_add_u32 m0, s45, 30720
s_add_u32 s44, s56, 496
s_and_b32 s44, s44, 511
s_lshl_b32 s44, s44, 11
buffer_load_dwordx4 v16, s[4:7], s44 offen lds
s_add_u32 m0, s45, 31744
s_add_u32 s44, s56, 504
s_and_b32 s44, s44, 511
s_lshl_b32 s44, s44, 11
buffer_load_dwordx4 v16, s[4:7], s44 offen lds
s_waitcnt vmcnt(16)
ds_read_b64_tr_b16 a[128:129], v17 offset:0
ds_read_b64_tr_b16 a[130:131], v17 offset:2048
ds_read_b64_tr_b16 a[132:133], v17 offset:64
ds_read_b64_tr_b16 a[134:135], v17 offset:2112
ds_read_b64_tr_b16 a[136:137], v17 offset:1024
ds_read_b64_tr_b16 a[138:139], v17 offset:3072
ds_read_b64_tr_b16 a[140:141], v17 offset:1088
ds_read_b64_tr_b16 a[142:143], v17 offset:3136
s_waitcnt lgkmcnt(0)
ds_read_b64_tr_b16 a[144:145], v17 offset:4096
ds_read_b64_tr_b16 a[146:147], v17 offset:6144
ds_read_b64_tr_b16 a[148:149], v17 offset:4160
ds_read_b64_tr_b16 a[150:151], v17 offset:6208
ds_read_b64_tr_b16 a[152:153], v17 offset:5120
ds_read_b64_tr_b16 a[154:155], v17 offset:7168
ds_read_b64_tr_b16 a[156:157], v17 offset:5184
ds_read_b64_tr_b16 a[158:159], v17 offset:7232
s_waitcnt lgkmcnt(0)
ds_read_b64_tr_b16 a[160:161], v17 offset:8192
ds_read_b64_tr_b16 a[162:163], v17 offset:10240
ds_read_b64_tr_b16 a[164:165], v17 offset:8256
ds_read_b64_tr_b16 a[166:167], v17 offset:10304
ds_read_b64_tr_b16 a[168:169], v17 offset:9216
ds_read_b64_tr_b16 a[170:171], v17 offset:11264
ds_read_b64_tr_b16 a[172:173], v17 offset:9280
ds_read_b64_tr_b16 a[174:175], v17 offset:11328
s_waitcnt lgkmcnt(0)
ds_read_b64_tr_b16 a[176:177], v17 offset:12288
ds_read_b64_tr_b16 a[178:179], v17 offset:14336
ds_read_b64_tr_b16 a[180:181], v17 offset:12352
ds_read_b64_tr_b16 a[182:183], v17 offset:14400
ds_read_b64_tr_b16 a[184:185], v17 offset:13312
ds_read_b64_tr_b16 a[186:187], v17 offset:15360
ds_read_b64_tr_b16 a[188:189], v17 offset:13376
ds_read_b64_tr_b16 a[190:191], v17 offset:15424
s_waitcnt lgkmcnt(0)
s_waitcnt vmcnt(0)
ds_read_b64_tr_b16 a[192:193], v17 offset:16384
ds_read_b64_tr_b16 a[194:195], v17 offset:18432
ds_read_b64_tr_b16 a[196:197], v17 offset:16448
ds_read_b64_tr_b16 a[198:199], v17 offset:18496
ds_read_b64_tr_b16 a[200:201], v17 offset:17408
ds_read_b64_tr_b16 a[202:203], v17 offset:19456
ds_read_b64_tr_b16 a[204:205], v17 offset:17472
ds_read_b64_tr_b16 a[206:207], v17 offset:19520
s_waitcnt lgkmcnt(0)
ds_read_b64_tr_b16 a[208:209], v17 offset:20480
ds_read_b64_tr_b16 a[210:211], v17 offset:22528
ds_read_b64_tr_b16 a[212:213], v17 offset:20544
ds_read_b64_tr_b16 a[214:215], v17 offset:22592
ds_read_b64_tr_b16 a[216:217], v17 offset:21504
ds_read_b64_tr_b16 a[218:219], v17 offset:23552
ds_read_b64_tr_b16 a[220:221], v17 offset:21568
ds_read_b64_tr_b16 a[222:223], v17 offset:23616
s_waitcnt lgkmcnt(0)
ds_read_b64_tr_b16 a[224:225], v17 offset:24576
ds_read_b64_tr_b16 a[226:227], v17 offset:26624
ds_read_b64_tr_b16 a[228:229], v17 offset:24640
ds_read_b64_tr_b16 a[230:231], v17 offset:26688
ds_read_b64_tr_b16 a[232:233], v17 offset:25600
ds_read_b64_tr_b16 a[234:235], v17 offset:27648
ds_read_b64_tr_b16 a[236:237], v17 offset:25664
ds_read_b64_tr_b16 a[238:239], v17 offset:27712
s_waitcnt lgkmcnt(0)
ds_read_b64_tr_b16 a[240:241], v17 offset:28672
ds_read_b64_tr_b16 a[242:243], v17 offset:30720
ds_read_b64_tr_b16 a[244:245], v17 offset:28736
ds_read_b64_tr_b16 a[246:247], v17 offset:30784
ds_read_b64_tr_b16 a[248:249], v17 offset:29696
ds_read_b64_tr_b16 a[250:251], v17 offset:31744
ds_read_b64_tr_b16 a[252:253], v17 offset:29760
ds_read_b64_tr_b16 a[254:255], v17 offset:31808
s_waitcnt lgkmcnt(0)
s_barrier
s_cmp_eq_u32 s68, 1
s_cbranch_scc1 mega_kernel_back
mega_kernel_o_hw:
s_lshl_b32 s56, s56, 6
s_lshl_b32 s43, s58, 18
s_lshl_b32 s44, s41, 16
s_add_u32 s43, s43, s44
s_add_u32 s43, s43, 134217728
v_add_u32 v6, s43, v5
v_and_b32 v2, 3, v1
v_lshlrev_b32 v7, 2, v2
v_bfe_u32 v2, v1, 2, 2
v_lshl_add_u32 v7, v2, 7, v7
s_lshl_b32 s43, s58, 11
s_lshl_b32 s44, s41, 9
s_add_u32 s43, s43, s44
s_lshl_b32 s44, s98, 13
s_add_u32 s43, s43, s44
s_add_u32 s43, s43, 69255168
v_add_u32 v7, s43, v7
s_mul_i32 s43, s41, 8704
v_lshrrev_b32 v2, 5, v1
v_lshl_add_u32 v8, v2, 5, v5
v_add_u32 v8, s43, v8
v_and_b32 v2, 7, v1
v_mul_u32_u24 v9, 544, v2
v_lshrrev_b32 v3, 3, v1
v_lshl_add_u32 v9, v3, 4, v9
s_lshl_b32 s43, s41, 7
v_add_u32 v9, s43, v9
s_mul_i32 s43, s58, 4352
s_sub_u32 s44, 4352, s43
v_add_u32 v10, s44, v9
v_add_u32 v9, s43, v9
s_lshl_b32 s43, s41, 15
s_lshl_b32 s44, s40, 6
s_add_u32 s43, s43, s44
v_lshlrev_b32 v11, 12, v3
v_and_b32 v2, 7, v1
v_lshl_add_u32 v11, v2, 3, v11
v_add_u32 v11, s43, v11
s_lshl_b32 s44, s41, 10
s_add_u32 s43, s66, s44
v_add_u32 v13, s43, v5
v_xor_b32 v12, 8192, v13
s_lshl_b32 s71, 1, s67
s_mov_b32 s42, s64
s_mov_b32 s52, 0
s_mov_b32 s53, 0
s_mov_b32 s57, 0
mega_kernel_o_cold:
s_cmp_gt_i32 s52, s42
s_cbranch_scc1 mega_kernel_o_fk
mega_kernel_o_fw:
buffer_load_dword v2, v7, s[84:87], 0 offen sc1
s_waitcnt vmcnt(0)
v_min_i32_dpp v2, v2, v2 quad_perm:[1,0,3,2] row_mask:0xf bank_mask:0xf
s_nop 1
v_min_i32_dpp v2, v2, v2 quad_perm:[2,3,0,1] row_mask:0xf bank_mask:0xf
s_nop 1
v_min_i32_dpp v2, v2, v2 row_ror:4 row_mask:0xf bank_mask:0xf
s_nop 1
v_min_i32_dpp v2, v2, v2 row_ror:8 row_mask:0xf bank_mask:0xf
s_nop 0
v_readfirstlane_b32 s52, v2
s_min_i32 s52, s52, s65
s_cmp_gt_i32 s52, s42
s_cbranch_scc1 mega_kernel_o_fk
s_sleep 2
s_add_u32 s43, s52, 2
s_cmp_gt_i32 s43, s42
s_cbranch_scc1 mega_kernel_o_fw
s_sleep 48
s_branch mega_kernel_o_fw
mega_kernel_o_fk:
s_add_u32 s54, s42, s71
s_cmp_gt_i32 s52, s54
s_cbranch_scc0 mega_kernel_o_c0
s_lshr_b32 s63, s42, 2
s_xnor_b32 s63, s63, s98
s_and_b32 s63, s63, 1
s_lshl_b32 s63, s63, 13
s_lshl_b32 s50, s42, 19
s_add_u32 s50, s50, s63
s_add_u32 s51, s56, 0
s_and_b32 s51, s51, 0x7fff
s_and_b32 s63, s51, 0x6000
s_add_u32 s51, s51, s63
s_add_u32 s51, s51, s50
buffer_load_dwordx4 v[96:99], v6, s[84:87], s51 offen offset:0 sc1
buffer_load_dwordx4 v[100:103], v6, s[84:87], s51 offen offset:1024 sc1
buffer_load_dwordx4 v[104:107], v6, s[84:87], s51 offen offset:2048 sc1
buffer_load_dwordx4 v[108:111], v6, s[84:87], s51 offen offset:3072 sc1
s_add_u32 s51, s56, 4096
s_and_b32 s51, s51, 0x7fff
s_and_b32 s63, s51, 0x6000
s_add_u32 s51, s51, s63
s_add_u32 s51, s51, s50
buffer_load_dwordx4 v[112:115], v6, s[84:87], s51 offen offset:0 sc1
buffer_load_dwordx4 v[116:119], v6, s[84:87], s51 offen offset:1024 sc1
buffer_load_dwordx4 v[120:123], v6, s[84:87], s51 offen offset:2048 sc1
buffer_load_dwordx4 v[124:127], v6, s[84:87], s51 offen offset:3072 sc1
s_add_u32 s51, s56, 8192
s_and_b32 s51, s51, 0x7fff
s_and_b32 s63, s51, 0x6000
s_add_u32 s51, s51, s63
s_add_u32 s51, s51, s50
buffer_load_dwordx4 v[128:131], v6, s[84:87], s51 offen offset:0 sc1
buffer_load_dwordx4 v[132:135], v6, s[84:87], s51 offen offset:1024 sc1
buffer_load_dwordx4 v[136:139], v6, s[84:87], s51 offen offset:2048 sc1
buffer_load_dwordx4 v[140:143], v6, s[84:87], s51 offen offset:3072 sc1
s_add_u32 s51, s56, 12288
s_and_b32 s51, s51, 0x7fff
s_and_b32 s63, s51, 0x6000
s_add_u32 s51, s51, s63
s_add_u32 s51, s51, s50
buffer_load_dwordx4 v[144:147], v6, s[84:87], s51 offen offset:0 sc1
buffer_load_dwordx4 v[148:151], v6, s[84:87], s51 offen offset:1024 sc1
buffer_load_dwordx4 v[152:155], v6, s[84:87], s51 offen offset:2048 sc1
buffer_load_dwordx4 v[156:159], v6, s[84:87], s51 offen offset:3072 sc1
s_add_u32 s51, s56, 16384
s_and_b32 s51, s51, 0x7fff
s_and_b32 s63, s51, 0x6000
s_add_u32 s51, s51, s63
s_add_u32 s51, s51, s50
buffer_load_dwordx4 v[160:163], v6, s[84:87], s51 offen offset:0 sc1
buffer_load_dwordx4 v[164:167], v6, s[84:87], s51 offen offset:1024 sc1
buffer_load_dwordx4 v[168:171], v6, s[84:87], s51 offen offset:2048 sc1
buffer_load_dwordx4 v[172:175], v6, s[84:87], s51 offen offset:3072 sc1
s_add_u32 s51, s56, 20480
s_and_b32 s51, s51, 0x7fff
s_and_b32 s63, s51, 0x6000
s_add_u32 s51, s51, s63
s_add_u32 s51, s51, s50
buffer_load_dwordx4 v[176:179], v6, s[84:87], s51 offen offset:0 sc1
buffer_load_dwordx4 v[180:183], v6, s[84:87], s51 offen offset:1024 sc1
buffer_load_dwordx4 v[184:187], v6, s[84:87], s51 offen offset:2048 sc1
buffer_load_dwordx4 v[188:191], v6, s[84:87], s51 offen offset:3072 sc1
s_add_u32 s51, s56, 24576
s_and_b32 s51, s51, 0x7fff
s_and_b32 s63, s51, 0x6000
s_add_u32 s51, s51, s63
s_add_u32 s51, s51, s50
buffer_load_dwordx4 v[192:195], v6, s[84:87], s51 offen offset:0 sc1
buffer_load_dwordx4 v[196:199], v6, s[84:87], s51 offen offset:1024 sc1
buffer_load_dwordx4 v[200:203], v6, s[84:87], s51 offen offset:2048 sc1
buffer_load_dwordx4 v[204:207], v6, s[84:87], s51 offen offset:3072 sc1
s_add_u32 s51, s56, 28672
s_and_b32 s51, s51, 0x7fff
s_and_b32 s63, s51, 0x6000
s_add_u32 s51, s51, s63
s_add_u32 s51, s51, s50
buffer_load_dwordx4 v[208:211], v6, s[84:87], s51 offen offset:0 sc1
buffer_load_dwordx4 v[212:215], v6, s[84:87], s51 offen offset:1024 sc1
buffer_load_dwordx4 v[216:219], v6, s[84:87], s51 offen offset:2048 sc1
buffer_load_dwordx4 v[220:223], v6, s[84:87], s51 offen offset:3072 sc1
mega_kernel_o_w0:
s_add_u32 s54, s42, s71
s_sub_u32 s62, s42, s71
s_lshr_b32 s63, s54, 2
s_xnor_b32 s63, s63, s98
s_and_b32 s63, s63, 1
s_lshl_b32 s63, s63, 13
s_lshl_b32 s50, s54, 19
s_add_u32 s50, s50, s63
s_cmp_gt_i32 s52, s54
s_cbranch_scc0 mega_kernel_o_n0
s_waitcnt vmcnt(31)
v_mfma_f32_32x32x16_bf16 v[20:35], a[0:3], v[96:99], 0
v_mfma_f32_32x32x16_bf16 v[36:51], a[4:7], v[96:99], 0
s_add_u32 s51, s56, 0
s_and_b32 s51, s51, 0x7fff
s_and_b32 s63, s51, 0x6000
s_add_u32 s51, s51, s63
s_add_u32 s51, s51, s50
buffer_load_dwordx4 v[96:99], v6, s[84:87], s51 offen offset:0 sc1
s_waitcnt vmcnt(31)
v_mfma_f32_32x32x16_bf16 v[20:35], a[8:11], v[100:103], v[20:35]
v_mfma_f32_32x32x16_bf16 v[36:51], a[12:15], v[100:103], v[36:51]
buffer_load_dwordx4 v[100:103], v6, s[84:87], s51 offen offset:1024 sc1
s_waitcnt vmcnt(31)
v_mfma_f32_32x32x16_bf16 v[20:35], a[16:19], v[104:107], v[20:35]
v_mfma_f32_32x32x16_bf16 v[36:51], a[20:23], v[104:107], v[36:51]
buffer_load_dwordx4 v[104:107], v6, s[84:87], s51 offen offset:2048 sc1
s_waitcnt vmcnt(31)
v_mfma_f32_32x32x16_bf16 v[20:35], a[24:27], v[108:111], v[20:35]
v_mfma_f32_32x32x16_bf16 v[36:51], a[28:31], v[108:111], v[36:51]
buffer_load_dwordx4 v[108:111], v6, s[84:87], s51 offen offset:3072 sc1
s_waitcnt vmcnt(31)
v_mfma_f32_32x32x16_bf16 v[20:35], a[32:35], v[112:115], v[20:35]
v_mfma_f32_32x32x16_bf16 v[36:51], a[36:39], v[112:115], v[36:51]
s_add_u32 s51, s56, 4096
s_and_b32 s51, s51, 0x7fff
s_and_b32 s63, s51, 0x6000
s_add_u32 s51, s51, s63
s_add_u32 s51, s51, s50
buffer_load_dwordx4 v[112:115], v6, s[84:87], s51 offen offset:0 sc1
s_waitcnt vmcnt(31)
v_mfma_f32_32x32x16_bf16 v[20:35], a[40:43], v[116:119], v[20:35]
v_mfma_f32_32x32x16_bf16 v[36:51], a[44:47], v[116:119], v[36:51]
buffer_load_dwordx4 v[116:119], v6, s[84:87], s51 offen offset:1024 sc1
s_waitcnt vmcnt(31)
v_mfma_f32_32x32x16_bf16 v[20:35], a[48:51], v[120:123], v[20:35]
v_mfma_f32_32x32x16_bf16 v[36:51], a[52:55], v[120:123], v[36:51]
buffer_load_dwordx4 v[120:123], v6, s[84:87], s51 offen offset:2048 sc1
s_waitcnt vmcnt(31)
v_mfma_f32_32x32x16_bf16 v[20:35], a[56:59], v[124:127], v[20:35]
v_mfma_f32_32x32x16_bf16 v[36:51], a[60:63], v[124:127], v[36:51]
buffer_load_dwordx4 v[124:127], v6, s[84:87], s51 offen offset:3072 sc1
s_waitcnt vmcnt(31)
v_mfma_f32_32x32x16_bf16 v[20:35], a[64:67], v[128:131], v[20:35]
v_mfma_f32_32x32x16_bf16 v[36:51], a[68:71], v[128:131], v[36:51]
s_add_u32 s51, s56, 8192
s_and_b32 s51, s51, 0x7fff
s_and_b32 s63, s51, 0x6000
s_add_u32 s51, s51, s63
s_add_u32 s51, s51, s50
buffer_load_dwordx4 v[128:131], v6, s[84:87], s51 offen offset:0 sc1
s_waitcnt vmcnt(31)
v_mfma_f32_32x32x16_bf16 v[20:35], a[72:75], v[132:135], v[20:35]
v_mfma_f32_32x32x16_bf16 v[36:51], a[76:79], v[132:135], v[36:51]
buffer_load_dwordx4 v[132:135], v6, s[84:87], s51 offen offset:1024 sc1
s_waitcnt vmcnt(31)
v_mfma_f32_32x32x16_bf16 v[20:35], a[80:83], v[136:139], v[20:35]
v_mfma_f32_32x32x16_bf16 v[36:51], a[84:87], v[136:139], v[36:51]
buffer_load_dwordx4 v[136:139], v6, s[84:87], s51 offen offset:2048 sc1
s_waitcnt vmcnt(31)
v_mfma_f32_32x32x16_bf16 v[20:35], a[88:91], v[140:143], v[20:35]
v_mfma_f32_32x32x16_bf16 v[36:51], a[92:95], v[140:143], v[36:51]
buffer_load_dwordx4 v[140:143], v6, s[84:87], s51 offen offset:3072 sc1
s_waitcnt vmcnt(31)
v_mfma_f32_32x32x16_bf16 v[20:35], a[96:99], v[144:147], v[20:35]
v_mfma_f32_32x32x16_bf16 v[36:51], a[100:103], v[144:147], v[36:51]
s_add_u32 s51, s56, 12288
s_and_b32 s51, s51, 0x7fff
s_and_b32 s63, s51, 0x6000
s_add_u32 s51, s51, s63
s_add_u32 s51, s51, s50
buffer_load_dwordx4 v[144:147], v6, s[84:87], s51 offen offset:0 sc1
s_waitcnt vmcnt(31)
v_mfma_f32_32x32x16_bf16 v[20:35], a[104:107], v[148:151], v[20:35]
v_mfma_f32_32x32x16_bf16 v[36:51], a[108:111], v[148:151], v[36:51]
buffer_load_dwordx4 v[148:151], v6, s[84:87], s51 offen offset:1024 sc1
s_waitcnt vmcnt(31)
v_mfma_f32_32x32x16_bf16 v[20:35], a[112:115], v[152:155], v[20:35]
v_mfma_f32_32x32x16_bf16 v[36:51], a[116:119], v[152:155], v[36:51]
buffer_load_dwordx4 v[152:155], v6, s[84:87], s51 offen offset:2048 sc1
s_waitcnt vmcnt(31)
v_mfma_f32_32x32x16_bf16 v[20:35], a[120:123], v[156:159], v[20:35]
v_mfma_f32_32x32x16_bf16 v[36:51], a[124:127], v[156:159], v[36:51]
buffer_load_dwordx4 v[156:159], v6, s[84:87], s51 offen offset:3072 sc1
s_waitcnt vmcnt(31)
v_mfma_f32_32x32x16_bf16 v[20:35], a[128:131], v[160:163], v[20:35]
v_mfma_f32_32x32x16_bf16 v[36:51], a[132:135], v[160:163], v[36:51]
s_add_u32 s51, s56, 16384
s_and_b32 s51, s51, 0x7fff
s_and_b32 s63, s51, 0x6000
s_add_u32 s51, s51, s63
s_add_u32 s51, s51, s50
buffer_load_dwordx4 v[160:163], v6, s[84:87], s51 offen offset:0 sc1
s_waitcnt vmcnt(31)
v_mfma_f32_32x32x16_bf16 v[20:35], a[136:139], v[164:167], v[20:35]
v_mfma_f32_32x32x16_bf16 v[36:51], a[140:143], v[164:167], v[36:51]
buffer_load_dwordx4 v[164:167], v6, s[84:87], s51 offen offset:1024 sc1
s_waitcnt vmcnt(31)
v_mfma_f32_32x32x16_bf16 v[20:35], a[144:147], v[168:171], v[20:35]
v_mfma_f32_32x32x16_bf16 v[36:51], a[148:151], v[168:171], v[36:51]
buffer_load_dwordx4 v[168:171], v6, s[84:87], s51 offen offset:2048 sc1
s_waitcnt vmcnt(31)
v_mfma_f32_32x32x16_bf16 v[20:35], a[152:155], v[172:175], v[20:35]
v_mfma_f32_32x32x16_bf16 v[36:51], a[156:159], v[172:175], v[36:51]
buffer_load_dwordx4 v[172:175], v6, s[84:87], s51 offen offset:3072 sc1
s_waitcnt vmcnt(31)
v_mfma_f32_32x32x16_bf16 v[20:35], a[160:163], v[176:179], v[20:35]
v_mfma_f32_32x32x16_bf16 v[36:51], a[164:167], v[176:179], v[36:51]
s_add_u32 s51, s56, 20480
s_and_b32 s51, s51, 0x7fff
s_and_b32 s63, s51, 0x6000
s_add_u32 s51, s51, s63
s_add_u32 s51, s51, s50
buffer_load_dwordx4 v[176:179], v6, s[84:87], s51 offen offset:0 sc1
s_waitcnt vmcnt(31)
v_mfma_f32_32x32x16_bf16 v[20:35], a[168:171], v[180:183], v[20:35]
v_mfma_f32_32x32x16_bf16 v[36:51], a[172:175], v[180:183], v[36:51]
buffer_load_dwordx4 v[180:183], v6, s[84:87], s51 offen offset:1024 sc1
s_waitcnt vmcnt(31)
v_mfma_f32_32x32x16_bf16 v[20:35], a[176:179], v[184:187], v[20:35]
v_mfma_f32_32x32x16_bf16 v[36:51], a[180:183], v[184:187], v[36:51]
buffer_load_dwordx4 v[184:187], v6, s[84:87], s51 offen offset:2048 sc1
s_waitcnt vmcnt(31)
v_mfma_f32_32x32x16_bf16 v[20:35], a[184:187], v[188:191], v[20:35]
v_mfma_f32_32x32x16_bf16 v[36:51], a[188:191], v[188:191], v[36:51]
buffer_load_dwordx4 v[188:191], v6, s[84:87], s51 offen offset:3072 sc1
s_waitcnt vmcnt(31)
v_mfma_f32_32x32x16_bf16 v[20:35], a[192:195], v[192:195], v[20:35]
v_mfma_f32_32x32x16_bf16 v[36:51], a[196:199], v[192:195], v[36:51]
s_add_u32 s51, s56, 24576
s_and_b32 s51, s51, 0x7fff
s_and_b32 s63, s51, 0x6000
s_add_u32 s51, s51, s63
s_add_u32 s51, s51, s50
buffer_load_dwordx4 v[192:195], v6, s[84:87], s51 offen offset:0 sc1
s_waitcnt vmcnt(31)
v_mfma_f32_32x32x16_bf16 v[20:35], a[200:203], v[196:199], v[20:35]
v_mfma_f32_32x32x16_bf16 v[36:51], a[204:207], v[196:199], v[36:51]
buffer_load_dwordx4 v[196:199], v6, s[84:87], s51 offen offset:1024 sc1
s_waitcnt vmcnt(31)
v_mfma_f32_32x32x16_bf16 v[20:35], a[208:211], v[200:203], v[20:35]
v_mfma_f32_32x32x16_bf16 v[36:51], a[212:215], v[200:203], v[36:51]
buffer_load_dwordx4 v[200:203], v6, s[84:87], s51 offen offset:2048 sc1
s_waitcnt vmcnt(31)
v_mfma_f32_32x32x16_bf16 v[20:35], a[216:219], v[204:207], v[20:35]
v_mfma_f32_32x32x16_bf16 v[36:51], a[220:223], v[204:207], v[36:51]
buffer_load_dwordx4 v[204:207], v6, s[84:87], s51 offen offset:3072 sc1
s_waitcnt vmcnt(31)
v_mfma_f32_32x32x16_bf16 v[20:35], a[224:227], v[208:211], v[20:35]
v_mfma_f32_32x32x16_bf16 v[36:51], a[228:231], v[208:211], v[36:51]
s_add_u32 s51, s56, 28672
s_and_b32 s51, s51, 0x7fff
s_and_b32 s63, s51, 0x6000
s_add_u32 s51, s51, s63
s_add_u32 s51, s51, s50
buffer_load_dwordx4 v[208:211], v6, s[84:87], s51 offen offset:0 sc1
s_waitcnt vmcnt(31)
v_mfma_f32_32x32x16_bf16 v[20:35], a[232:235], v[212:215], v[20:35]
v_mfma_f32_32x32x16_bf16 v[36:51], a[236:239], v[212:215], v[36:51]
buffer_load_dwordx4 v[212:215], v6, s[84:87], s51 offen offset:1024 sc1
s_waitcnt vmcnt(31)
v_mfma_f32_32x32x16_bf16 v[20:35], a[240:243], v[216:219], v[20:35]
v_mfma_f32_32x32x16_bf16 v[36:51], a[244:247], v[216:219], v[36:51]
buffer_load_dwordx4 v[216:219], v6, s[84:87], s51 offen offset:2048 sc1
s_waitcnt vmcnt(31)
v_mfma_f32_32x32x16_bf16 v[224:239], a[248:251], v[220:223], v[20:35]
v_mfma_f32_32x32x16_bf16 v[240:255], a[252:255], v[220:223], v[36:51]
buffer_load_dwordx4 v[220:223], v6, s[84:87], s51 offen offset:3072 sc1
s_add_u32 s42, s42, s71
s_branch mega_kernel_o_w1
mega_kernel_o_n0:
s_waitcnt vmcnt(31)
v_mfma_f32_32x32x16_bf16 v[20:35], a[0:3], v[96:99], 0
v_mfma_f32_32x32x16_bf16 v[36:51], a[4:7], v[96:99], 0
s_waitcnt vmcnt(30)
v_mfma_f32_32x32x16_bf16 v[20:35], a[8:11], v[100:103], v[20:35]
v_mfma_f32_32x32x16_bf16 v[36:51], a[12:15], v[100:103], v[36:51]
s_waitcnt vmcnt(29)
v_mfma_f32_32x32x16_bf16 v[20:35], a[16:19], v[104:107], v[20:35]
v_mfma_f32_32x32x16_bf16 v[36:51], a[20:23], v[104:107], v[36:51]
s_waitcnt vmcnt(28)
v_mfma_f32_32x32x16_bf16 v[20:35], a[24:27], v[108:111], v[20:35]
v_mfma_f32_32x32x16_bf16 v[36:51], a[28:31], v[108:111], v[36:51]
s_waitcnt vmcnt(27)
v_mfma_f32_32x32x16_bf16 v[20:35], a[32:35], v[112:115], v[20:35]
v_mfma_f32_32x32x16_bf16 v[36:51], a[36:39], v[112:115], v[36:51]
s_waitcnt vmcnt(26)
v_mfma_f32_32x32x16_bf16 v[20:35], a[40:43], v[116:119], v[20:35]
v_mfma_f32_32x32x16_bf16 v[36:51], a[44:47], v[116:119], v[36:51]
s_waitcnt vmcnt(25)
v_mfma_f32_32x32x16_bf16 v[20:35], a[48:51], v[120:123], v[20:35]
v_mfma_f32_32x32x16_bf16 v[36:51], a[52:55], v[120:123], v[36:51]
s_waitcnt vmcnt(24)
v_mfma_f32_32x32x16_bf16 v[20:35], a[56:59], v[124:127], v[20:35]
v_mfma_f32_32x32x16_bf16 v[36:51], a[60:63], v[124:127], v[36:51]
s_waitcnt vmcnt(23)
v_mfma_f32_32x32x16_bf16 v[20:35], a[64:67], v[128:131], v[20:35]
v_mfma_f32_32x32x16_bf16 v[36:51], a[68:71], v[128:131], v[36:51]
s_waitcnt vmcnt(22)
v_mfma_f32_32x32x16_bf16 v[20:35], a[72:75], v[132:135], v[20:35]
v_mfma_f32_32x32x16_bf16 v[36:51], a[76:79], v[132:135], v[36:51]
s_waitcnt vmcnt(21)
v_mfma_f32_32x32x16_bf16 v[20:35], a[80:83], v[136:139], v[20:35]
v_mfma_f32_32x32x16_bf16 v[36:51], a[84:87], v[136:139], v[36:51]
s_waitcnt vmcnt(20)
v_mfma_f32_32x32x16_bf16 v[20:35], a[88:91], v[140:143], v[20:35]
v_mfma_f32_32x32x16_bf16 v[36:51], a[92:95], v[140:143], v[36:51]
s_waitcnt vmcnt(19)
v_mfma_f32_32x32x16_bf16 v[20:35], a[96:99], v[144:147], v[20:35]
v_mfma_f32_32x32x16_bf16 v[36:51], a[100:103], v[144:147], v[36:51]
s_waitcnt vmcnt(18)
v_mfma_f32_32x32x16_bf16 v[20:35], a[104:107], v[148:151], v[20:35]
v_mfma_f32_32x32x16_bf16 v[36:51], a[108:111], v[148:151], v[36:51]
s_waitcnt vmcnt(17)
v_mfma_f32_32x32x16_bf16 v[20:35], a[112:115], v[152:155], v[20:35]
v_mfma_f32_32x32x16_bf16 v[36:51], a[116:119], v[152:155], v[36:51]
s_waitcnt vmcnt(16)
v_mfma_f32_32x32x16_bf16 v[20:35], a[120:123], v[156:159], v[20:35]
v_mfma_f32_32x32x16_bf16 v[36:51], a[124:127], v[156:159], v[36:51]
s_waitcnt vmcnt(15)
v_mfma_f32_32x32x16_bf16 v[20:35], a[128:131], v[160:163], v[20:35]
v_mfma_f32_32x32x16_bf16 v[36:51], a[132:135], v[160:163], v[36:51]
s_waitcnt vmcnt(14)
v_mfma_f32_32x32x16_bf16 v[20:35], a[136:139], v[164:167], v[20:35]
v_mfma_f32_32x32x16_bf16 v[36:51], a[140:143], v[164:167], v[36:51]
s_waitcnt vmcnt(13)
v_mfma_f32_32x32x16_bf16 v[20:35], a[144:147], v[168:171], v[20:35]
v_mfma_f32_32x32x16_bf16 v[36:51], a[148:151], v[168:171], v[36:51]
s_waitcnt vmcnt(12)
v_mfma_f32_32x32x16_bf16 v[20:35], a[152:155], v[172:175], v[20:35]
v_mfma_f32_32x32x16_bf16 v[36:51], a[156:159], v[172:175], v[36:51]
s_waitcnt vmcnt(11)
v_mfma_f32_32x32x16_bf16 v[20:35], a[160:163], v[176:179], v[20:35]
v_mfma_f32_32x32x16_bf16 v[36:51], a[164:167], v[176:179], v[36:51]
buffer_load_dword v15, v7, s[84:87], 0 offen sc1
s_waitcnt vmcnt(10)
v_mfma_f32_32x32x16_bf16 v[20:35], a[168:171], v[180:183], v[20:35]
v_mfma_f32_32x32x16_bf16 v[36:51], a[172:175], v[180:183], v[36:51]
s_waitcnt vmcnt(9)
v_mfma_f32_32x32x16_bf16 v[20:35], a[176:179], v[184:187], v[20:35]
v_mfma_f32_32x32x16_bf16 v[36:51], a[180:183], v[184:187], v[36:51]
s_waitcnt vmcnt(8)
v_mfma_f32_32x32x16_bf16 v[20:35], a[184:187], v[188:191], v[20:35]
v_mfma_f32_32x32x16_bf16 v[36:51], a[188:191], v[188:191], v[36:51]
s_waitcnt vmcnt(7)
v_mfma_f32_32x32x16_bf16 v[20:35], a[192:195], v[192:195], v[20:35]
v_mfma_f32_32x32x16_bf16 v[36:51], a[196:199], v[192:195], v[36:51]
s_waitcnt vmcnt(6)
v_mfma_f32_32x32x16_bf16 v[20:35], a[200:203], v[196:199], v[20:35]
v_mfma_f32_32x32x16_bf16 v[36:51], a[204:207], v[196:199], v[36:51]
s_waitcnt vmcnt(5)
v_mfma_f32_32x32x16_bf16 v[20:35], a[208:211], v[200:203], v[20:35]
v_mfma_f32_32x32x16_bf16 v[36:51], a[212:215], v[200:203], v[36:51]
s_waitcnt vmcnt(4)
v_mfma_f32_32x32x16_bf16 v[20:35], a[216:219], v[204:207], v[20:35]
v_mfma_f32_32x32x16_bf16 v[36:51], a[220:223], v[204:207], v[36:51]
s_waitcnt vmcnt(3)
v_mfma_f32_32x32x16_bf16 v[20:35], a[224:227], v[208:211], v[20:35]
v_mfma_f32_32x32x16_bf16 v[36:51], a[228:231], v[208:211], v[36:51]
s_waitcnt vmcnt(2)
v_mfma_f32_32x32x16_bf16 v[20:35], a[232:235], v[212:215], v[20:35]
v_mfma_f32_32x32x16_bf16 v[36:51], a[236:239], v[212:215], v[36:51]
s_waitcnt vmcnt(1)
v_mfma_f32_32x32x16_bf16 v[20:35], a[240:243], v[216:219], v[20:35]
v_mfma_f32_32x32x16_bf16 v[36:51], a[244:247], v[216:219], v[36:51]
s_waitcnt vmcnt(0)
v_mfma_f32_32x32x16_bf16 v[224:239], a[248:251], v[220:223], v[20:35]
v_mfma_f32_32x32x16_bf16 v[240:255], a[252:255], v[220:223], v[36:51]
s_branch mega_kernel_o_imm
mega_kernel_o_w1:
s_add_u32 s54, s42, s71
s_sub_u32 s62, s42, s71
s_lshr_b32 s63, s54, 2
s_xnor_b32 s63, s63, s98
s_and_b32 s63, s63, 1
s_lshl_b32 s63, s63, 13
s_lshl_b32 s50, s54, 19
s_add_u32 s50, s50, s63
s_cmp_gt_i32 s52, s54
s_cbranch_scc0 mega_kernel_o_n1
s_waitcnt vmcnt(31)
v_mfma_f32_32x32x16_bf16 v[20:35], a[0:3], v[96:99], 0
v_mfma_f32_32x32x16_bf16 v[36:51], a[4:7], v[96:99], 0
s_add_u32 s51, s56, 0
s_and_b32 s51, s51, 0x7fff
s_and_b32 s63, s51, 0x6000
s_add_u32 s51, s51, s63
s_add_u32 s51, s51, s50
buffer_load_dwordx4 v[96:99], v6, s[84:87], s51 offen offset:0 sc1
s_waitcnt vmcnt(31)
v_mfma_f32_32x32x16_bf16 v[20:35], a[8:11], v[100:103], v[20:35]
v_mfma_f32_32x32x16_bf16 v[36:51], a[12:15], v[100:103], v[36:51]
buffer_load_dwordx4 v[100:103], v6, s[84:87], s51 offen offset:1024 sc1
v_add_u32 v2, s53, v8
v_add_u32 v3, s53, v9
v_add_u32 v4, s53, v10
s_waitcnt vmcnt(31)
v_mfma_f32_32x32x16_bf16 v[20:35], a[16:19], v[104:107], v[20:35]
v_mfma_f32_32x32x16_bf16 v[36:51], a[20:23], v[104:107], v[36:51]
buffer_load_dwordx4 v[104:107], v6, s[84:87], s51 offen offset:2048 sc1
ds_write_b128 v2, v[224:227] offset:0
ds_write_b128 v2, v[228:231] offset:1088
s_waitcnt vmcnt(31)
v_mfma_f32_32x32x16_bf16 v[20:35], a[24:27], v[108:111], v[20:35]
v_mfma_f32_32x32x16_bf16 v[36:51], a[28:31], v[108:111], v[36:51]
buffer_load_dwordx4 v[108:111], v6, s[84:87], s51 offen offset:3072 sc1
ds_write_b128 v2, v[232:235] offset:2176
ds_write_b128 v2, v[236:239] offset:3264
s_waitcnt vmcnt(31)
v_mfma_f32_32x32x16_bf16 v[20:35], a[32:35], v[112:115], v[20:35]
v_mfma_f32_32x32x16_bf16 v[36:51], a[36:39], v[112:115], v[36:51]
s_add_u32 s51, s56, 4096
s_and_b32 s51, s51, 0x7fff
s_and_b32 s63, s51, 0x6000
s_add_u32 s51, s51, s63
s_add_u32 s51, s51, s50
buffer_load_dwordx4 v[112:115], v6, s[84:87], s51 offen offset:0 sc1
ds_write_b128 v2, v[240:243] offset:4352
ds_write_b128 v2, v[244:247] offset:5440
s_waitcnt vmcnt(31)
v_mfma_f32_32x32x16_bf16 v[20:35], a[40:43], v[116:119], v[20:35]
v_mfma_f32_32x32x16_bf16 v[36:51], a[44:47], v[116:119], v[36:51]
buffer_load_dwordx4 v[116:119], v6, s[84:87], s51 offen offset:1024 sc1
ds_write_b128 v2, v[248:251] offset:6528
ds_write_b128 v2, v[252:255] offset:7616
s_waitcnt vmcnt(31)
v_mfma_f32_32x32x16_bf16 v[20:35], a[48:51], v[120:123], v[20:35]
v_mfma_f32_32x32x16_bf16 v[36:51], a[52:55], v[120:123], v[36:51]
buffer_load_dwordx4 v[120:123], v6, s[84:87], s51 offen offset:2048 sc1
s_waitcnt vmcnt(31)
v_mfma_f32_32x32x16_bf16 v[20:35], a[56:59], v[124:127], v[20:35]
v_mfma_f32_32x32x16_bf16 v[36:51], a[60:63], v[124:127], v[36:51]
buffer_load_dwordx4 v[124:127], v6, s[84:87], s51 offen offset:3072 sc1
s_waitcnt lgkmcnt(0)
s_barrier
ds_read_b128 v[52:55], v4 offset:0
ds_read_b128 v[56:59], v4 offset:8704
ds_read_b128 v[60:63], v4 offset:17408
ds_read_b128 v[64:67], v4 offset:26112
s_waitcnt vmcnt(31)
v_mfma_f32_32x32x16_bf16 v[20:35], a[64:67], v[128:131], v[20:35]
v_mfma_f32_32x32x16_bf16 v[36:51], a[68:71], v[128:131], v[36:51]
s_add_u32 s51, s56, 8192
s_and_b32 s51, s51, 0x7fff
s_and_b32 s63, s51, 0x6000
s_add_u32 s51, s51, s63
s_add_u32 s51, s51, s50
buffer_load_dwordx4 v[128:131], v6, s[84:87], s51 offen offset:0 sc1
ds_read_b128 v[68:71], v3 offset:0
ds_read_b128 v[72:75], v3 offset:8704
ds_read_b128 v[76:79], v3 offset:17408
ds_read_b128 v[80:83], v3 offset:26112
s_sub_u32 s53, 34816, s53
s_sub_u32 s60, s62, s64
s_lshr_b32 s60, s60, s67
s_bfe_u32 s61, s60, 0x10001
s_and_b32 s60, s60, 1
s_lshl_b32 s60, s60, 12
s_waitcnt vmcnt(31)
v_mfma_f32_32x32x16_bf16 v[20:35], a[72:75], v[132:135], v[20:35]
v_mfma_f32_32x32x16_bf16 v[36:51], a[76:79], v[132:135], v[36:51]
buffer_load_dwordx4 v[132:135], v6, s[84:87], s51 offen offset:1024 sc1
s_waitcnt vmcnt(31)
v_mfma_f32_32x32x16_bf16 v[20:35], a[80:83], v[136:139], v[20:35]
v_mfma_f32_32x32x16_bf16 v[36:51], a[84:87], v[136:139], v[36:51]
buffer_load_dwordx4 v[136:139], v6, s[84:87], s51 offen offset:2048 sc1
s_waitcnt lgkmcnt(4)
v_add_f32 v52, v52, v56
v_add_f32 v60, v60, v64
v_add_f32 v53, v53, v57
v_add_f32 v61, v61, v65
v_add_f32 v54, v54, v58
v_add_f32 v62, v62, v66
v_add_f32 v55, v55, v59
v_add_f32 v63, v63, v67
s_waitcnt vmcnt(31)
v_mfma_f32_32x32x16_bf16 v[20:35], a[88:91], v[140:143], v[20:35]
v_mfma_f32_32x32x16_bf16 v[36:51], a[92:95], v[140:143], v[36:51]
buffer_load_dwordx4 v[140:143], v6, s[84:87], s51 offen offset:3072 sc1
v_add_f32 v52, v52, v60
v_add_f32 v53, v53, v61
v_add_f32 v54, v54, v62
v_add_f32 v55, v55, v63
v_and_or_b32 v52, v52, -2, s61
s_cmp_eq_u32 s95, 0
s_cbranch_scc1 mega_kernel_o_sa1
buffer_store_dwordx4 v[52:55], v12, s[84:87], s60 offen sc1
s_branch mega_kernel_o_sb1
mega_kernel_o_sa1:
buffer_store_dwordx4 v[52:55], v12, s[84:87], s60 offen
mega_kernel_o_sb1:
s_waitcnt vmcnt(31)
v_mfma_f32_32x32x16_bf16 v[20:35], a[96:99], v[144:147], v[20:35]
v_mfma_f32_32x32x16_bf16 v[36:51], a[100:103], v[144:147], v[36:51]
s_add_u32 s51, s56, 12288
s_and_b32 s51, s51, 0x7fff
s_and_b32 s63, s51, 0x6000
s_add_u32 s51, s51, s63
s_add_u32 s51, s51, s50
buffer_load_dwordx4 v[144:147], v6, s[84:87], s51 offen offset:0 sc1
s_waitcnt lgkmcnt(0)
v_add_f32 v68, v68, v72
v_add_f32 v76, v76, v80
v_add_f32 v69, v69, v73
v_add_f32 v77, v77, v81
v_add_f32 v70, v70, v74
v_add_f32 v78, v78, v82
v_add_f32 v71, v71, v75
v_add_f32 v79, v79, v83
s_waitcnt vmcnt(31)
v_mfma_f32_32x32x16_bf16 v[20:35], a[104:107], v[148:151], v[20:35]
v_mfma_f32_32x32x16_bf16 v[36:51], a[108:111], v[148:151], v[36:51]
buffer_load_dwordx4 v[148:151], v6, s[84:87], s51 offen offset:1024 sc1
v_add_f32 v84, v68, v76
v_add_f32 v85, v69, v77
v_add_f32 v86, v70, v78
v_add_f32 v87, v71, v79
s_waitcnt vmcnt(31)
v_mfma_f32_32x32x16_bf16 v[20:35], a[112:115], v[152:155], v[20:35]
v_mfma_f32_32x32x16_bf16 v[36:51], a[116:119], v[152:155], v[36:51]
buffer_load_dwordx4 v[152:155], v6, s[84:87], s51 offen offset:2048 sc1
s_waitcnt vmcnt(31)
v_mfma_f32_32x32x16_bf16 v[20:35], a[120:123], v[156:159], v[20:35]
v_mfma_f32_32x32x16_bf16 v[36:51], a[124:127], v[156:159], v[36:51]
buffer_load_dwordx4 v[156:159], v6, s[84:87], s51 offen offset:3072 sc1
s_waitcnt vmcnt(31)
v_mfma_f32_32x32x16_bf16 v[20:35], a[128:131], v[160:163], v[20:35]
v_mfma_f32_32x32x16_bf16 v[36:51], a[132:135], v[160:163], v[36:51]
s_add_u32 s51, s56, 16384
s_and_b32 s51, s51, 0x7fff
s_and_b32 s63, s51, 0x6000
s_add_u32 s51, s51, s63
s_add_u32 s51, s51, s50
buffer_load_dwordx4 v[160:163], v6, s[84:87], s51 offen offset:0 sc1
s_waitcnt vmcnt(31)
v_mfma_f32_32x32x16_bf16 v[20:35], a[136:139], v[164:167], v[20:35]
v_mfma_f32_32x32x16_bf16 v[36:51], a[140:143], v[164:167], v[36:51]
buffer_load_dwordx4 v[164:167], v6, s[84:87], s51 offen offset:1024 sc1
s_waitcnt vmcnt(31)
v_mfma_f32_32x32x16_bf16 v[20:35], a[144:147], v[168:171], v[20:35]
v_mfma_f32_32x32x16_bf16 v[36:51], a[148:151], v[168:171], v[36:51]
buffer_load_dwordx4 v[168:171], v6, s[84:87], s51 offen offset:2048 sc1
s_waitcnt vmcnt(31)
v_mfma_f32_32x32x16_bf16 v[20:35], a[152:155], v[172:175], v[20:35]
v_mfma_f32_32x32x16_bf16 v[36:51], a[156:159], v[172:175], v[36:51]
buffer_load_dwordx4 v[172:175], v6, s[84:87], s51 offen offset:3072 sc1
s_waitcnt vmcnt(31)
v_mfma_f32_32x32x16_bf16 v[20:35], a[160:163], v[176:179], v[20:35]
v_mfma_f32_32x32x16_bf16 v[36:51], a[164:167], v[176:179], v[36:51]
s_add_u32 s51, s56, 20480
s_and_b32 s51, s51, 0x7fff
s_and_b32 s63, s51, 0x6000
s_add_u32 s51, s51, s63
s_add_u32 s51, s51, s50
buffer_load_dwordx4 v[176:179], v6, s[84:87], s51 offen offset:0 sc1
s_waitcnt vmcnt(31)
v_mfma_f32_32x32x16_bf16 v[20:35], a[168:171], v[180:183], v[20:35]
v_mfma_f32_32x32x16_bf16 v[36:51], a[172:175], v[180:183], v[36:51]
buffer_load_dwordx4 v[180:183], v6, s[84:87], s51 offen offset:1024 sc1
s_waitcnt vmcnt(31)
v_mfma_f32_32x32x16_bf16 v[20:35], a[176:179], v[184:187], v[20:35]
v_mfma_f32_32x32x16_bf16 v[36:51], a[180:183], v[184:187], v[36:51]
buffer_load_dwordx4 v[184:187], v6, s[84:87], s51 offen offset:2048 sc1
s_waitcnt vmcnt(31)
v_mfma_f32_32x32x16_bf16 v[20:35], a[184:187], v[188:191], v[20:35]
v_mfma_f32_32x32x16_bf16 v[36:51], a[188:191], v[188:191], v[36:51]
buffer_load_dwordx4 v[188:191], v6, s[84:87], s51 offen offset:3072 sc1
s_waitcnt vmcnt(31)
v_mfma_f32_32x32x16_bf16 v[20:35], a[192:195], v[192:195], v[20:35]
v_mfma_f32_32x32x16_bf16 v[36:51], a[196:199], v[192:195], v[36:51]
s_add_u32 s51, s56, 24576
s_and_b32 s51, s51, 0x7fff
s_and_b32 s63, s51, 0x6000
s_add_u32 s51, s51, s63
s_add_u32 s51, s51, s50
buffer_load_dwordx4 v[192:195], v6, s[84:87], s51 offen offset:0 sc1
s_waitcnt vmcnt(31)
v_mfma_f32_32x32x16_bf16 v[20:35], a[200:203], v[196:199], v[20:35]
v_mfma_f32_32x32x16_bf16 v[36:51], a[204:207], v[196:199], v[36:51]
buffer_load_dwordx4 v[196:199], v6, s[84:87], s51 offen offset:1024 sc1
s_waitcnt vmcnt(31)
v_mfma_f32_32x32x16_bf16 v[20:35], a[208:211], v[200:203], v[20:35]
v_mfma_f32_32x32x16_bf16 v[36:51], a[212:215], v[200:203], v[36:51]
buffer_load_dwordx4 v[200:203], v6, s[84:87], s51 offen offset:2048 sc1
s_waitcnt vmcnt(31)
v_mfma_f32_32x32x16_bf16 v[20:35], a[216:219], v[204:207], v[20:35]
v_mfma_f32_32x32x16_bf16 v[36:51], a[220:223], v[204:207], v[36:51]
buffer_load_dwordx4 v[204:207], v6, s[84:87], s51 offen offset:3072 sc1
s_sub_u32 s60, s62, s64
s_lshr_b32 s60, s60, s67
s_bfe_u32 s61, s60, 0x10001
s_and_b32 s60, s60, 1
s_lshl_b32 s60, s60, 12
buffer_load_dwordx4 v[88:91], v13, s[84:87], s60 offen sc1
s_waitcnt vmcnt(31)
v_mfma_f32_32x32x16_bf16 v[20:35], a[224:227], v[208:211], v[20:35]
v_mfma_f32_32x32x16_bf16 v[36:51], a[228:231], v[208:211], v[36:51]
s_add_u32 s51, s56, 28672
s_and_b32 s51, s51, 0x7fff
s_and_b32 s63, s51, 0x6000
s_add_u32 s51, s51, s63
s_add_u32 s51, s51, s50
buffer_load_dwordx4 v[208:211], v6, s[84:87], s51 offen offset:0 sc1
s_waitcnt vmcnt(31)
v_mfma_f32_32x32x16_bf16 v[20:35], a[232:235], v[212:215], v[20:35]
v_mfma_f32_32x32x16_bf16 v[36:51], a[236:239], v[212:215], v[36:51]
buffer_load_dwordx4 v[212:215], v6, s[84:87], s51 offen offset:1024 sc1
s_waitcnt vmcnt(31)
v_mfma_f32_32x32x16_bf16 v[20:35], a[240:243], v[216:219], v[20:35]
v_mfma_f32_32x32x16_bf16 v[36:51], a[244:247], v[216:219], v[36:51]
buffer_load_dwordx4 v[216:219], v6, s[84:87], s51 offen offset:2048 sc1
s_waitcnt vmcnt(31)
v_mfma_f32_32x32x16_bf16 v[224:239], a[248:251], v[220:223], v[20:35]
v_mfma_f32_32x32x16_bf16 v[240:255], a[252:255], v[220:223], v[36:51]
buffer_load_dwordx4 v[220:223], v6, s[84:87], s51 offen offset:3072 sc1
s_waitcnt vmcnt(4)
mega_kernel_o_f1c:
v_and_b32 v14, 1, v88
v_cmp_ne_u32 vcc, s61, v14
s_cbranch_vccz mega_kernel_o_f1k
s_sub_u32 s60, s62, s64
s_lshr_b32 s60, s60, s67
s_bfe_u32 s61, s60, 0x10001
s_and_b32 s60, s60, 1
s_lshl_b32 s60, s60, 12
buffer_load_dwordx4 v[88:91], v13, s[84:87], s60 offen sc1
s_waitcnt vmcnt(0)
s_branch mega_kernel_o_f1c
mega_kernel_o_f1k:
v_pk_add_f32 v[88:89], v[88:89], v[84:85]
v_pk_add_f32 v[90:91], v[90:91], v[86:87]
s_lshl_b32 s60, s62, 17
v_cvt_pk_bf16_f32 v92, v88, v89
v_cvt_pk_bf16_f32 v93, v90, v91
buffer_store_dwordx2 v[92:93], v11, s[8:11], s60 offen sc1
s_add_u32 s42, s42, s71
s_branch mega_kernel_o_w1
mega_kernel_o_n1:
s_waitcnt vmcnt(31)
v_mfma_f32_32x32x16_bf16 v[20:35], a[0:3], v[96:99], 0
v_mfma_f32_32x32x16_bf16 v[36:51], a[4:7], v[96:99], 0
s_waitcnt vmcnt(30)
v_mfma_f32_32x32x16_bf16 v[20:35], a[8:11], v[100:103], v[20:35]
v_mfma_f32_32x32x16_bf16 v[36:51], a[12:15], v[100:103], v[36:51]
v_add_u32 v2, s53, v8
v_add_u32 v3, s53, v9
v_add_u32 v4, s53, v10
s_waitcnt vmcnt(29)
v_mfma_f32_32x32x16_bf16 v[20:35], a[16:19], v[104:107], v[20:35]
v_mfma_f32_32x32x16_bf16 v[36:51], a[20:23], v[104:107], v[36:51]
ds_write_b128 v2, v[224:227] offset:0
ds_write_b128 v2, v[228:231] offset:1088
s_waitcnt vmcnt(28)
v_mfma_f32_32x32x16_bf16 v[20:35], a[24:27], v[108:111], v[20:35]
v_mfma_f32_32x32x16_bf16 v[36:51], a[28:31], v[108:111], v[36:51]
ds_write_b128 v2, v[232:235] offset:2176
ds_write_b128 v2, v[236:239] offset:3264
s_waitcnt vmcnt(27)
v_mfma_f32_32x32x16_bf16 v[20:35], a[32:35], v[112:115], v[20:35]
v_mfma_f32_32x32x16_bf16 v[36:51], a[36:39], v[112:115], v[36:51]
ds_write_b128 v2, v[240:243] offset:4352
ds_write_b128 v2, v[244:247] offset:5440
s_waitcnt vmcnt(26)
v_mfma_f32_32x32x16_bf16 v[20:35], a[40:43], v[116:119], v[20:35]
v_mfma_f32_32x32x16_bf16 v[36:51], a[44:47], v[116:119], v[36:51]
ds_write_b128 v2, v[248:251] offset:6528
ds_write_b128 v2, v[252:255] offset:7616
s_waitcnt vmcnt(25)
v_mfma_f32_32x32x16_bf16 v[20:35], a[48:51], v[120:123], v[20:35]
v_mfma_f32_32x32x16_bf16 v[36:51], a[52:55], v[120:123], v[36:51]
s_waitcnt vmcnt(24)
v_mfma_f32_32x32x16_bf16 v[20:35], a[56:59], v[124:127], v[20:35]
v_mfma_f32_32x32x16_bf16 v[36:51], a[60:63], v[124:127], v[36:51]
s_waitcnt lgkmcnt(0)
s_barrier
ds_read_b128 v[52:55], v4 offset:0
ds_read_b128 v[56:59], v4 offset:8704
ds_read_b128 v[60:63], v4 offset:17408
ds_read_b128 v[64:67], v4 offset:26112
s_waitcnt vmcnt(23)
v_mfma_f32_32x32x16_bf16 v[20:35], a[64:67], v[128:131], v[20:35]
v_mfma_f32_32x32x16_bf16 v[36:51], a[68:71], v[128:131], v[36:51]
ds_read_b128 v[68:71], v3 offset:0
ds_read_b128 v[72:75], v3 offset:8704
ds_read_b128 v[76:79], v3 offset:17408
ds_read_b128 v[80:83], v3 offset:26112
s_sub_u32 s53, 34816, s53
s_sub_u32 s60, s62, s64
s_lshr_b32 s60, s60, s67
s_bfe_u32 s61, s60, 0x10001
s_and_b32 s60, s60, 1
s_lshl_b32 s60, s60, 12
s_waitcnt vmcnt(22)
v_mfma_f32_32x32x16_bf16 v[20:35], a[72:75], v[132:135], v[20:35]
v_mfma_f32_32x32x16_bf16 v[36:51], a[76:79], v[132:135], v[36:51]
s_waitcnt vmcnt(21)
v_mfma_f32_32x32x16_bf16 v[20:35], a[80:83], v[136:139], v[20:35]
v_mfma_f32_32x32x16_bf16 v[36:51], a[84:87], v[136:139], v[36:51]
s_waitcnt lgkmcnt(4)
v_add_f32 v52, v52, v56
v_add_f32 v60, v60, v64
v_add_f32 v53, v53, v57
v_add_f32 v61, v61, v65
v_add_f32 v54, v54, v58
v_add_f32 v62, v62, v66
v_add_f32 v55, v55, v59
v_add_f32 v63, v63, v67
s_waitcnt vmcnt(20)
v_mfma_f32_32x32x16_bf16 v[20:35], a[88:91], v[140:143], v[20:35]
v_mfma_f32_32x32x16_bf16 v[36:51], a[92:95], v[140:143], v[36:51]
v_add_f32 v52, v52, v60
v_add_f32 v53, v53, v61
v_add_f32 v54, v54, v62
v_add_f32 v55, v55, v63
v_and_or_b32 v52, v52, -2, s61
s_cmp_eq_u32 s95, 0
s_cbranch_scc1 mega_kernel_o_sa2
buffer_store_dwordx4 v[52:55], v12, s[84:87], s60 offen sc1
s_branch mega_kernel_o_sb2
mega_kernel_o_sa2:
buffer_store_dwordx4 v[52:55], v12, s[84:87], s60 offen
mega_kernel_o_sb2:
s_waitcnt vmcnt(19)
v_mfma_f32_32x32x16_bf16 v[20:35], a[96:99], v[144:147], v[20:35]
v_mfma_f32_32x32x16_bf16 v[36:51], a[100:103], v[144:147], v[36:51]
s_waitcnt lgkmcnt(0)
v_add_f32 v68, v68, v72
v_add_f32 v76, v76, v80
v_add_f32 v69, v69, v73
v_add_f32 v77, v77, v81
v_add_f32 v70, v70, v74
v_add_f32 v78, v78, v82
v_add_f32 v71, v71, v75
v_add_f32 v79, v79, v83
s_waitcnt vmcnt(18)
v_mfma_f32_32x32x16_bf16 v[20:35], a[104:107], v[148:151], v[20:35]
v_mfma_f32_32x32x16_bf16 v[36:51], a[108:111], v[148:151], v[36:51]
v_add_f32 v84, v68, v76
v_add_f32 v85, v69, v77
v_add_f32 v86, v70, v78
v_add_f32 v87, v71, v79
s_waitcnt vmcnt(17)
v_mfma_f32_32x32x16_bf16 v[20:35], a[112:115], v[152:155], v[20:35]
v_mfma_f32_32x32x16_bf16 v[36:51], a[116:119], v[152:155], v[36:51]
s_waitcnt vmcnt(16)
v_mfma_f32_32x32x16_bf16 v[20:35], a[120:123], v[156:159], v[20:35]
v_mfma_f32_32x32x16_bf16 v[36:51], a[124:127], v[156:159], v[36:51]
s_waitcnt vmcnt(15)
v_mfma_f32_32x32x16_bf16 v[20:35], a[128:131], v[160:163], v[20:35]
v_mfma_f32_32x32x16_bf16 v[36:51], a[132:135], v[160:163], v[36:51]
s_waitcnt vmcnt(14)
v_mfma_f32_32x32x16_bf16 v[20:35], a[136:139], v[164:167], v[20:35]
v_mfma_f32_32x32x16_bf16 v[36:51], a[140:143], v[164:167], v[36:51]
s_waitcnt vmcnt(13)
v_mfma_f32_32x32x16_bf16 v[20:35], a[144:147], v[168:171], v[20:35]
v_mfma_f32_32x32x16_bf16 v[36:51], a[148:151], v[168:171], v[36:51]
s_waitcnt vmcnt(12)
v_mfma_f32_32x32x16_bf16 v[20:35], a[152:155], v[172:175], v[20:35]
v_mfma_f32_32x32x16_bf16 v[36:51], a[156:159], v[172:175], v[36:51]
s_waitcnt vmcnt(11)
v_mfma_f32_32x32x16_bf16 v[20:35], a[160:163], v[176:179], v[20:35]
v_mfma_f32_32x32x16_bf16 v[36:51], a[164:167], v[176:179], v[36:51]
buffer_load_dword v15, v7, s[84:87], 0 offen sc1
s_waitcnt vmcnt(10)
v_mfma_f32_32x32x16_bf16 v[20:35], a[168:171], v[180:183], v[20:35]
v_mfma_f32_32x32x16_bf16 v[36:51], a[172:175], v[180:183], v[36:51]
s_waitcnt vmcnt(9)
v_mfma_f32_32x32x16_bf16 v[20:35], a[176:179], v[184:187], v[20:35]
v_mfma_f32_32x32x16_bf16 v[36:51], a[180:183], v[184:187], v[36:51]
s_waitcnt vmcnt(8)
v_mfma_f32_32x32x16_bf16 v[20:35], a[184:187], v[188:191], v[20:35]
v_mfma_f32_32x32x16_bf16 v[36:51], a[188:191], v[188:191], v[36:51]
s_waitcnt vmcnt(7)
v_mfma_f32_32x32x16_bf16 v[20:35], a[192:195], v[192:195], v[20:35]
v_mfma_f32_32x32x16_bf16 v[36:51], a[196:199], v[192:195], v[36:51]
s_waitcnt vmcnt(6)
v_mfma_f32_32x32x16_bf16 v[20:35], a[200:203], v[196:199], v[20:35]
v_mfma_f32_32x32x16_bf16 v[36:51], a[204:207], v[196:199], v[36:51]
s_waitcnt vmcnt(5)
v_mfma_f32_32x32x16_bf16 v[20:35], a[208:211], v[200:203], v[20:35]
v_mfma_f32_32x32x16_bf16 v[36:51], a[212:215], v[200:203], v[36:51]
s_waitcnt vmcnt(4)
v_mfma_f32_32x32x16_bf16 v[20:35], a[216:219], v[204:207], v[20:35]
v_mfma_f32_32x32x16_bf16 v[36:51], a[220:223], v[204:207], v[36:51]
s_sub_u32 s60, s62, s64
s_lshr_b32 s60, s60, s67
s_bfe_u32 s61, s60, 0x10001
s_and_b32 s60, s60, 1
s_lshl_b32 s60, s60, 12
buffer_load_dwordx4 v[88:91], v13, s[84:87], s60 offen sc1
s_waitcnt vmcnt(3)
v_mfma_f32_32x32x16_bf16 v[20:35], a[224:227], v[208:211], v[20:35]
v_mfma_f32_32x32x16_bf16 v[36:51], a[228:231], v[208:211], v[36:51]
s_waitcnt vmcnt(2)
v_mfma_f32_32x32x16_bf16 v[20:35], a[232:235], v[212:215], v[20:35]
v_mfma_f32_32x32x16_bf16 v[36:51], a[236:239], v[212:215], v[36:51]
s_waitcnt vmcnt(1)
v_mfma_f32_32x32x16_bf16 v[20:35], a[240:243], v[216:219], v[20:35]
v_mfma_f32_32x32x16_bf16 v[36:51], a[244:247], v[216:219], v[36:51]
s_waitcnt vmcnt(0)
v_mfma_f32_32x32x16_bf16 v[224:239], a[248:251], v[220:223], v[20:35]
v_mfma_f32_32x32x16_bf16 v[240:255], a[252:255], v[220:223], v[36:51]
s_waitcnt vmcnt(0)
mega_kernel_o_f0c:
v_and_b32 v14, 1, v88
v_cmp_ne_u32 vcc, s61, v14
s_cbranch_vccz mega_kernel_o_f0k
s_sub_u32 s60, s62, s64
s_lshr_b32 s60, s60, s67
s_bfe_u32 s61, s60, 0x10001
s_and_b32 s60, s60, 1
s_lshl_b32 s60, s60, 12
buffer_load_dwordx4 v[88:91], v13, s[84:87], s60 offen sc1
s_waitcnt vmcnt(0)
s_branch mega_kernel_o_f0c
mega_kernel_o_f0k:
v_pk_add_f32 v[88:89], v[88:89], v[84:85]
v_pk_add_f32 v[90:91], v[90:91], v[86:87]
s_lshl_b32 s60, s62, 17
v_cvt_pk_bf16_f32 v92, v88, v89
v_cvt_pk_bf16_f32 v93, v90, v91
buffer_store_dwordx2 v[92:93], v11, s[8:11], s60 offen sc1
mega_kernel_o_imm:
s_waitcnt vmcnt(1)
v_min_i32_dpp v15, v15, v15 quad_perm:[1,0,3,2] row_mask:0xf bank_mask:0xf
s_nop 1
v_min_i32_dpp v15, v15, v15 quad_perm:[2,3,0,1] row_mask:0xf bank_mask:0xf
s_nop 1
v_min_i32_dpp v15, v15, v15 row_ror:4 row_mask:0xf bank_mask:0xf
s_nop 1
v_min_i32_dpp v15, v15, v15 row_ror:8 row_mask:0xf bank_mask:0xf
s_nop 0
v_readfirstlane_b32 s52, v15
s_min_i32 s52, s52, s65
s_cmp_gt_i32 s52, s54
s_cbranch_scc0 mega_kernel_o_im2
s_add_u32 s42, s42, s71
s_add_u32 s54, s54, s71
s_cmp_gt_i32 s52, s54
s_cbranch_scc0 mega_kernel_o_c1
s_add_u32 s51, s56, 0
s_and_b32 s51, s51, 0x7fff
s_and_b32 s63, s51, 0x6000
s_add_u32 s51, s51, s63
s_add_u32 s51, s51, s50
buffer_load_dwordx4 v[96:99], v6, s[84:87], s51 offen offset:0 sc1
buffer_load_dwordx4 v[100:103], v6, s[84:87], s51 offen offset:1024 sc1
buffer_load_dwordx4 v[104:107], v6, s[84:87], s51 offen offset:2048 sc1
buffer_load_dwordx4 v[108:111], v6, s[84:87], s51 offen offset:3072 sc1
s_add_u32 s51, s56, 4096
s_and_b32 s51, s51, 0x7fff
s_and_b32 s63, s51, 0x6000
s_add_u32 s51, s51, s63
s_add_u32 s51, s51, s50
buffer_load_dwordx4 v[112:115], v6, s[84:87], s51 offen offset:0 sc1
buffer_load_dwordx4 v[116:119], v6, s[84:87], s51 offen offset:1024 sc1
buffer_load_dwordx4 v[120:123], v6, s[84:87], s51 offen offset:2048 sc1
buffer_load_dwordx4 v[124:127], v6, s[84:87], s51 offen offset:3072 sc1
s_add_u32 s51, s56, 8192
s_and_b32 s51, s51, 0x7fff
s_and_b32 s63, s51, 0x6000
s_add_u32 s51, s51, s63
s_add_u32 s51, s51, s50
buffer_load_dwordx4 v[128:131], v6, s[84:87], s51 offen offset:0 sc1
buffer_load_dwordx4 v[132:135], v6, s[84:87], s51 offen offset:1024 sc1
buffer_load_dwordx4 v[136:139], v6, s[84:87], s51 offen offset:2048 sc1
buffer_load_dwordx4 v[140:143], v6, s[84:87], s51 offen offset:3072 sc1
s_add_u32 s51, s56, 12288
s_and_b32 s51, s51, 0x7fff
s_and_b32 s63, s51, 0x6000
s_add_u32 s51, s51, s63
s_add_u32 s51, s51, s50
buffer_load_dwordx4 v[144:147], v6, s[84:87], s51 offen offset:0 sc1
buffer_load_dwordx4 v[148:151], v6, s[84:87], s51 offen offset:1024 sc1
buffer_load_dwordx4 v[152:155], v6, s[84:87], s51 offen offset:2048 sc1
buffer_load_dwordx4 v[156:159], v6, s[84:87], s51 offen offset:3072 sc1
s_add_u32 s51, s56, 16384
s_and_b32 s51, s51, 0x7fff
s_and_b32 s63, s51, 0x6000
s_add_u32 s51, s51, s63
s_add_u32 s51, s51, s50
buffer_load_dwordx4 v[160:163], v6, s[84:87], s51 offen offset:0 sc1
buffer_load_dwordx4 v[164:167], v6, s[84:87], s51 offen offset:1024 sc1
buffer_load_dwordx4 v[168:171], v6, s[84:87], s51 offen offset:2048 sc1
buffer_load_dwordx4 v[172:175], v6, s[84:87], s51 offen offset:3072 sc1
s_add_u32 s51, s56, 20480
s_and_b32 s51, s51, 0x7fff
s_and_b32 s63, s51, 0x6000
s_add_u32 s51, s51, s63
s_add_u32 s51, s51, s50
buffer_load_dwordx4 v[176:179], v6, s[84:87], s51 offen offset:0 sc1
buffer_load_dwordx4 v[180:183], v6, s[84:87], s51 offen offset:1024 sc1
buffer_load_dwordx4 v[184:187], v6, s[84:87], s51 offen offset:2048 sc1
buffer_load_dwordx4 v[188:191], v6, s[84:87], s51 offen offset:3072 sc1
s_add_u32 s51, s56, 24576
s_and_b32 s51, s51, 0x7fff
s_and_b32 s63, s51, 0x6000
s_add_u32 s51, s51, s63
s_add_u32 s51, s51, s50
buffer_load_dwordx4 v[192:195], v6, s[84:87], s51 offen offset:0 sc1
buffer_load_dwordx4 v[196:199], v6, s[84:87], s51 offen offset:1024 sc1
buffer_load_dwordx4 v[200:203], v6, s[84:87], s51 offen offset:2048 sc1
buffer_load_dwordx4 v[204:207], v6, s[84:87], s51 offen offset:3072 sc1
s_add_u32 s51, s56, 28672
s_and_b32 s51, s51, 0x7fff
s_and_b32 s63, s51, 0x6000
s_add_u32 s51, s51, s63
s_add_u32 s51, s51, s50
buffer_load_dwordx4 v[208:211], v6, s[84:87], s51 offen offset:0 sc1
buffer_load_dwordx4 v[212:215], v6, s[84:87], s51 offen offset:1024 sc1
buffer_load_dwordx4 v[216:219], v6, s[84:87], s51 offen offset:2048 sc1
buffer_load_dwordx4 v[220:223], v6, s[84:87], s51 offen offset:3072 sc1
s_branch mega_kernel_o_w1
mega_kernel_o_c0:
s_add_u32 s54, s42, s71
s_sub_u32 s62, s42, s71
s_lshr_b32 s63, s42, 2
s_xnor_b32 s63, s63, s98
s_and_b32 s63, s63, 1
s_lshl_b32 s63, s63, 13
s_lshl_b32 s50, s42, 19
s_add_u32 s50, s50, s63
s_add_u32 s51, s56, 0
s_and_b32 s51, s51, 0x7fff
s_and_b32 s63, s51, 0x6000
s_add_u32 s51, s51, s63
s_add_u32 s51, s51, s50
buffer_load_dwordx4 v[96:99], v6, s[84:87], s51 offen offset:0 sc1
buffer_load_dwordx4 v[100:103], v6, s[84:87], s51 offen offset:1024 sc1
buffer_load_dwordx4 v[104:107], v6, s[84:87], s51 offen offset:2048 sc1
buffer_load_dwordx4 v[108:111], v6, s[84:87], s51 offen offset:3072 sc1
s_add_u32 s51, s56, 4096
s_and_b32 s51, s51, 0x7fff
s_and_b32 s63, s51, 0x6000
s_add_u32 s51, s51, s63
s_add_u32 s51, s51, s50
buffer_load_dwordx4 v[112:115], v6, s[84:87], s51 offen offset:0 sc1
buffer_load_dwordx4 v[116:119], v6, s[84:87], s51 offen offset:1024 sc1
buffer_load_dwordx4 v[120:123], v6, s[84:87], s51 offen offset:2048 sc1
buffer_load_dwordx4 v[124:127], v6, s[84:87], s51 offen offset:3072 sc1
s_waitcnt vmcnt(7)
v_mfma_f32_32x32x16_bf16 v[20:35], a[0:3], v[96:99], 0
v_mfma_f32_32x32x16_bf16 v[36:51], a[4:7], v[96:99], 0
s_add_u32 s51, s56, 8192
s_and_b32 s51, s51, 0x7fff
s_and_b32 s63, s51, 0x6000
s_add_u32 s51, s51, s63
s_add_u32 s51, s51, s50
buffer_load_dwordx4 v[128:131], v6, s[84:87], s51 offen offset:0 sc1
s_waitcnt vmcnt(7)
v_mfma_f32_32x32x16_bf16 v[20:35], a[8:11], v[100:103], v[20:35]
v_mfma_f32_32x32x16_bf16 v[36:51], a[12:15], v[100:103], v[36:51]
buffer_load_dwordx4 v[132:135], v6, s[84:87], s51 offen offset:1024 sc1
s_waitcnt vmcnt(7)
v_mfma_f32_32x32x16_bf16 v[20:35], a[16:19], v[104:107], v[20:35]
v_mfma_f32_32x32x16_bf16 v[36:51], a[20:23], v[104:107], v[36:51]
buffer_load_dwordx4 v[136:139], v6, s[84:87], s51 offen offset:2048 sc1
s_waitcnt vmcnt(7)
v_mfma_f32_32x32x16_bf16 v[20:35], a[24:27], v[108:111], v[20:35]
v_mfma_f32_32x32x16_bf16 v[36:51], a[28:31], v[108:111], v[36:51]
buffer_load_dwordx4 v[140:143], v6, s[84:87], s51 offen offset:3072 sc1
s_waitcnt vmcnt(7)
v_mfma_f32_32x32x16_bf16 v[20:35], a[32:35], v[112:115], v[20:35]
v_mfma_f32_32x32x16_bf16 v[36:51], a[36:39], v[112:115], v[36:51]
s_add_u32 s51, s56, 12288
s_and_b32 s51, s51, 0x7fff
s_and_b32 s63, s51, 0x6000
s_add_u32 s51, s51, s63
s_add_u32 s51, s51, s50
buffer_load_dwordx4 v[144:147], v6, s[84:87], s51 offen offset:0 sc1
s_waitcnt vmcnt(7)
v_mfma_f32_32x32x16_bf16 v[20:35], a[40:43], v[116:119], v[20:35]
v_mfma_f32_32x32x16_bf16 v[36:51], a[44:47], v[116:119], v[36:51]
buffer_load_dwordx4 v[148:151], v6, s[84:87], s51 offen offset:1024 sc1
s_waitcnt vmcnt(7)
v_mfma_f32_32x32x16_bf16 v[20:35], a[48:51], v[120:123], v[20:35]
v_mfma_f32_32x32x16_bf16 v[36:51], a[52:55], v[120:123], v[36:51]
buffer_load_dwordx4 v[152:155], v6, s[84:87], s51 offen offset:2048 sc1
s_waitcnt vmcnt(7)
v_mfma_f32_32x32x16_bf16 v[20:35], a[56:59], v[124:127], v[20:35]
v_mfma_f32_32x32x16_bf16 v[36:51], a[60:63], v[124:127], v[36:51]
buffer_load_dwordx4 v[156:159], v6, s[84:87], s51 offen offset:3072 sc1
s_waitcnt vmcnt(7)
v_mfma_f32_32x32x16_bf16 v[20:35], a[64:67], v[128:131], v[20:35]
v_mfma_f32_32x32x16_bf16 v[36:51], a[68:71], v[128:131], v[36:51]
s_add_u32 s51, s56, 16384
s_and_b32 s51, s51, 0x7fff
s_and_b32 s63, s51, 0x6000
s_add_u32 s51, s51, s63
s_add_u32 s51, s51, s50
buffer_load_dwordx4 v[160:163], v6, s[84:87], s51 offen offset:0 sc1
s_waitcnt vmcnt(7)
v_mfma_f32_32x32x16_bf16 v[20:35], a[72:75], v[132:135], v[20:35]
v_mfma_f32_32x32x16_bf16 v[36:51], a[76:79], v[132:135], v[36:51]
buffer_load_dwordx4 v[164:167], v6, s[84:87], s51 offen offset:1024 sc1
s_waitcnt vmcnt(7)
v_mfma_f32_32x32x16_bf16 v[20:35], a[80:83], v[136:139], v[20:35]
v_mfma_f32_32x32x16_bf16 v[36:51], a[84:87], v[136:139], v[36:51]
buffer_load_dwordx4 v[168:171], v6, s[84:87], s51 offen offset:2048 sc1
s_waitcnt vmcnt(7)
v_mfma_f32_32x32x16_bf16 v[20:35], a[88:91], v[140:143], v[20:35]
v_mfma_f32_32x32x16_bf16 v[36:51], a[92:95], v[140:143], v[36:51]
buffer_load_dwordx4 v[172:175], v6, s[84:87], s51 offen offset:3072 sc1
s_waitcnt vmcnt(7)
v_mfma_f32_32x32x16_bf16 v[20:35], a[96:99], v[144:147], v[20:35]
v_mfma_f32_32x32x16_bf16 v[36:51], a[100:103], v[144:147], v[36:51]
s_add_u32 s51, s56, 20480
s_and_b32 s51, s51, 0x7fff
s_and_b32 s63, s51, 0x6000
s_add_u32 s51, s51, s63
s_add_u32 s51, s51, s50
buffer_load_dwordx4 v[176:179], v6, s[84:87], s51 offen offset:0 sc1
s_waitcnt vmcnt(7)
v_mfma_f32_32x32x16_bf16 v[20:35], a[104:107], v[148:151], v[20:35]
v_mfma_f32_32x32x16_bf16 v[36:51], a[108:111], v[148:151], v[36:51]
buffer_load_dwordx4 v[180:183], v6, s[84:87], s51 offen offset:1024 sc1
s_waitcnt vmcnt(7)
v_mfma_f32_32x32x16_bf16 v[20:35], a[112:115], v[152:155], v[20:35]
v_mfma_f32_32x32x16_bf16 v[36:51], a[116:119], v[152:155], v[36:51]
buffer_load_dwordx4 v[184:187], v6, s[84:87], s51 offen offset:2048 sc1
s_waitcnt vmcnt(7)
v_mfma_f32_32x32x16_bf16 v[20:35], a[120:123], v[156:159], v[20:35]
v_mfma_f32_32x32x16_bf16 v[36:51], a[124:127], v[156:159], v[36:51]
buffer_load_dwordx4 v[188:191], v6, s[84:87], s51 offen offset:3072 sc1
s_waitcnt vmcnt(7)
v_mfma_f32_32x32x16_bf16 v[20:35], a[128:131], v[160:163], v[20:35]
v_mfma_f32_32x32x16_bf16 v[36:51], a[132:135], v[160:163], v[36:51]
s_add_u32 s51, s56, 24576
s_and_b32 s51, s51, 0x7fff
s_and_b32 s63, s51, 0x6000
s_add_u32 s51, s51, s63
s_add_u32 s51, s51, s50
buffer_load_dwordx4 v[192:195], v6, s[84:87], s51 offen offset:0 sc1
s_waitcnt vmcnt(7)
v_mfma_f32_32x32x16_bf16 v[20:35], a[136:139], v[164:167], v[20:35]
v_mfma_f32_32x32x16_bf16 v[36:51], a[140:143], v[164:167], v[36:51]
buffer_load_dwordx4 v[196:199], v6, s[84:87], s51 offen offset:1024 sc1
s_waitcnt vmcnt(7)
v_mfma_f32_32x32x16_bf16 v[20:35], a[144:147], v[168:171], v[20:35]
v_mfma_f32_32x32x16_bf16 v[36:51], a[148:151], v[168:171], v[36:51]
buffer_load_dwordx4 v[200:203], v6, s[84:87], s51 offen offset:2048 sc1
s_waitcnt vmcnt(7)
v_mfma_f32_32x32x16_bf16 v[20:35], a[152:155], v[172:175], v[20:35]
v_mfma_f32_32x32x16_bf16 v[36:51], a[156:159], v[172:175], v[36:51]
buffer_load_dwordx4 v[204:207], v6, s[84:87], s51 offen offset:3072 sc1
s_waitcnt vmcnt(7)
v_mfma_f32_32x32x16_bf16 v[20:35], a[160:163], v[176:179], v[20:35]
v_mfma_f32_32x32x16_bf16 v[36:51], a[164:167], v[176:179], v[36:51]
s_add_u32 s51, s56, 28672
s_and_b32 s51, s51, 0x7fff
s_and_b32 s63, s51, 0x6000
s_add_u32 s51, s51, s63
s_add_u32 s51, s51, s50
buffer_load_dwordx4 v[208:211], v6, s[84:87], s51 offen offset:0 sc1
s_waitcnt vmcnt(7)
v_mfma_f32_32x32x16_bf16 v[20:35], a[168:171], v[180:183], v[20:35]
v_mfma_f32_32x32x16_bf16 v[36:51], a[172:175], v[180:183], v[36:51]
buffer_load_dwordx4 v[212:215], v6, s[84:87], s51 offen offset:1024 sc1
s_waitcnt vmcnt(7)
v_mfma_f32_32x32x16_bf16 v[20:35], a[176:179], v[184:187], v[20:35]
v_mfma_f32_32x32x16_bf16 v[36:51], a[180:183], v[184:187], v[36:51]
buffer_load_dwordx4 v[216:219], v6, s[84:87], s51 offen offset:2048 sc1
s_waitcnt vmcnt(7)
v_mfma_f32_32x32x16_bf16 v[20:35], a[184:187], v[188:191], v[20:35]
v_mfma_f32_32x32x16_bf16 v[36:51], a[188:191], v[188:191], v[36:51]
buffer_load_dwordx4 v[220:223], v6, s[84:87], s51 offen offset:3072 sc1
s_waitcnt vmcnt(7)
v_mfma_f32_32x32x16_bf16 v[20:35], a[192:195], v[192:195], v[20:35]
v_mfma_f32_32x32x16_bf16 v[36:51], a[196:199], v[192:195], v[36:51]
buffer_load_dword v15, v7, s[84:87], 0 offen sc1
s_waitcnt vmcnt(6)
v_mfma_f32_32x32x16_bf16 v[20:35], a[200:203], v[196:199], v[20:35]
v_mfma_f32_32x32x16_bf16 v[36:51], a[204:207], v[196:199], v[36:51]
s_waitcnt vmcnt(5)
v_mfma_f32_32x32x16_bf16 v[20:35], a[208:211], v[200:203], v[20:35]
v_mfma_f32_32x32x16_bf16 v[36:51], a[212:215], v[200:203], v[36:51]
s_waitcnt vmcnt(4)
v_mfma_f32_32x32x16_bf16 v[20:35], a[216:219], v[204:207], v[20:35]
v_mfma_f32_32x32x16_bf16 v[36:51], a[220:223], v[204:207], v[36:51]
s_waitcnt vmcnt(3)
v_mfma_f32_32x32x16_bf16 v[20:35], a[224:227], v[208:211], v[20:35]
v_mfma_f32_32x32x16_bf16 v[36:51], a[228:231], v[208:211], v[36:51]
s_waitcnt vmcnt(2)
v_mfma_f32_32x32x16_bf16 v[20:35], a[232:235], v[212:215], v[20:35]
v_mfma_f32_32x32x16_bf16 v[36:51], a[236:239], v[212:215], v[36:51]
s_waitcnt vmcnt(1)
v_mfma_f32_32x32x16_bf16 v[20:35], a[240:243], v[216:219], v[20:35]
v_mfma_f32_32x32x16_bf16 v[36:51], a[244:247], v[216:219], v[36:51]
s_waitcnt vmcnt(0)
v_mfma_f32_32x32x16_bf16 v[224:239], a[248:251], v[220:223], v[20:35]
v_mfma_f32_32x32x16_bf16 v[240:255], a[252:255], v[220:223], v[36:51]
s_lshr_b32 s63, s54, 2
s_xnor_b32 s63, s63, s98
s_and_b32 s63, s63, 1
s_lshl_b32 s63, s63, 13
s_lshl_b32 s50, s54, 19
s_add_u32 s50, s50, s63
s_branch mega_kernel_o_imm
mega_kernel_o_c1:
s_add_u32 s54, s42, s71
s_sub_u32 s62, s42, s71
s_lshr_b32 s63, s42, 2
s_xnor_b32 s63, s63, s98
s_and_b32 s63, s63, 1
s_lshl_b32 s63, s63, 13
s_lshl_b32 s50, s42, 19
s_add_u32 s50, s50, s63
s_add_u32 s51, s56, 0
s_and_b32 s51, s51, 0x7fff
s_and_b32 s63, s51, 0x6000
s_add_u32 s51, s51, s63
s_add_u32 s51, s51, s50
buffer_load_dwordx4 v[96:99], v6, s[84:87], s51 offen offset:0 sc1
buffer_load_dwordx4 v[100:103], v6, s[84:87], s51 offen offset:1024 sc1
buffer_load_dwordx4 v[104:107], v6, s[84:87], s51 offen offset:2048 sc1
buffer_load_dwordx4 v[108:111], v6, s[84:87], s51 offen offset:3072 sc1
s_add_u32 s51, s56, 4096
s_and_b32 s51, s51, 0x7fff
s_and_b32 s63, s51, 0x6000
s_add_u32 s51, s51, s63
s_add_u32 s51, s51, s50
buffer_load_dwordx4 v[112:115], v6, s[84:87], s51 offen offset:0 sc1
buffer_load_dwordx4 v[116:119], v6, s[84:87], s51 offen offset:1024 sc1
buffer_load_dwordx4 v[120:123], v6, s[84:87], s51 offen offset:2048 sc1
buffer_load_dwordx4 v[124:127], v6, s[84:87], s51 offen offset:3072 sc1
v_add_u32 v2, s53, v8
v_add_u32 v3, s53, v9
v_add_u32 v4, s53, v10
ds_write_b128 v2, v[224:227] offset:0
ds_write_b128 v2, v[228:231] offset:1088
ds_write_b128 v2, v[232:235] offset:2176
ds_write_b128 v2, v[236:239] offset:3264
ds_write_b128 v2, v[240:243] offset:4352
ds_write_b128 v2, v[244:247] offset:5440
ds_write_b128 v2, v[248:251] offset:6528
ds_write_b128 v2, v[252:255] offset:7616
s_waitcnt lgkmcnt(0)
s_barrier
ds_read_b128 v[52:55], v4 offset:0
ds_read_b128 v[56:59], v4 offset:8704
ds_read_b128 v[60:63], v4 offset:17408
ds_read_b128 v[64:67], v4 offset:26112
ds_read_b128 v[68:71], v3 offset:0
ds_read_b128 v[72:75], v3 offset:8704
ds_read_b128 v[76:79], v3 offset:17408
ds_read_b128 v[80:83], v3 offset:26112
s_sub_u32 s53, 34816, s53
s_sub_u32 s60, s62, s64
s_lshr_b32 s60, s60, s67
s_bfe_u32 s61, s60, 0x10001
s_and_b32 s60, s60, 1
s_lshl_b32 s60, s60, 12
s_waitcnt lgkmcnt(4)
v_add_f32 v52, v52, v56
v_add_f32 v60, v60, v64
v_add_f32 v53, v53, v57
v_add_f32 v61, v61, v65
v_add_f32 v54, v54, v58
v_add_f32 v62, v62, v66
v_add_f32 v55, v55, v59
v_add_f32 v63, v63, v67
v_add_f32 v52, v52, v60
v_add_f32 v53, v53, v61
v_add_f32 v54, v54, v62
v_add_f32 v55, v55, v63
v_and_or_b32 v52, v52, -2, s61
s_cmp_eq_u32 s95, 0
s_cbranch_scc1 mega_kernel_o_sa3
buffer_store_dwordx4 v[52:55], v12, s[84:87], s60 offen sc1
s_branch mega_kernel_o_sb3
mega_kernel_o_sa3:
buffer_store_dwordx4 v[52:55], v12, s[84:87], s60 offen
mega_kernel_o_sb3:
s_waitcnt lgkmcnt(0)
v_add_f32 v68, v68, v72
v_add_f32 v76, v76, v80
v_add_f32 v69, v69, v73
v_add_f32 v77, v77, v81
v_add_f32 v70, v70, v74
v_add_f32 v78, v78, v82
v_add_f32 v71, v71, v75
v_add_f32 v79, v79, v83
v_add_f32 v84, v68, v76
v_add_f32 v85, v69, v77
v_add_f32 v86, v70, v78
v_add_f32 v87, v71, v79
s_waitcnt vmcnt(7)
v_mfma_f32_32x32x16_bf16 v[20:35], a[0:3], v[96:99], 0
v_mfma_f32_32x32x16_bf16 v[36:51], a[4:7], v[96:99], 0
s_add_u32 s51, s56, 8192
s_and_b32 s51, s51, 0x7fff
s_and_b32 s63, s51, 0x6000
s_add_u32 s51, s51, s63
s_add_u32 s51, s51, s50
buffer_load_dwordx4 v[128:131], v6, s[84:87], s51 offen offset:0 sc1
s_waitcnt vmcnt(7)
v_mfma_f32_32x32x16_bf16 v[20:35], a[8:11], v[100:103], v[20:35]
v_mfma_f32_32x32x16_bf16 v[36:51], a[12:15], v[100:103], v[36:51]
buffer_load_dwordx4 v[132:135], v6, s[84:87], s51 offen offset:1024 sc1
s_waitcnt vmcnt(7)
v_mfma_f32_32x32x16_bf16 v[20:35], a[16:19], v[104:107], v[20:35]
v_mfma_f32_32x32x16_bf16 v[36:51], a[20:23], v[104:107], v[36:51]
buffer_load_dwordx4 v[136:139], v6, s[84:87], s51 offen offset:2048 sc1
s_waitcnt vmcnt(7)
v_mfma_f32_32x32x16_bf16 v[20:35], a[24:27], v[108:111], v[20:35]
v_mfma_f32_32x32x16_bf16 v[36:51], a[28:31], v[108:111], v[36:51]
buffer_load_dwordx4 v[140:143], v6, s[84:87], s51 offen offset:3072 sc1
s_waitcnt vmcnt(7)
v_mfma_f32_32x32x16_bf16 v[20:35], a[32:35], v[112:115], v[20:35]
v_mfma_f32_32x32x16_bf16 v[36:51], a[36:39], v[112:115], v[36:51]
s_add_u32 s51, s56, 12288
s_and_b32 s51, s51, 0x7fff
s_and_b32 s63, s51, 0x6000
s_add_u32 s51, s51, s63
s_add_u32 s51, s51, s50
buffer_load_dwordx4 v[144:147], v6, s[84:87], s51 offen offset:0 sc1
s_waitcnt vmcnt(7)
v_mfma_f32_32x32x16_bf16 v[20:35], a[40:43], v[116:119], v[20:35]
v_mfma_f32_32x32x16_bf16 v[36:51], a[44:47], v[116:119], v[36:51]
buffer_load_dwordx4 v[148:151], v6, s[84:87], s51 offen offset:1024 sc1
s_waitcnt vmcnt(7)
v_mfma_f32_32x32x16_bf16 v[20:35], a[48:51], v[120:123], v[20:35]
v_mfma_f32_32x32x16_bf16 v[36:51], a[52:55], v[120:123], v[36:51]
buffer_load_dwordx4 v[152:155], v6, s[84:87], s51 offen offset:2048 sc1
s_waitcnt vmcnt(7)
v_mfma_f32_32x32x16_bf16 v[20:35], a[56:59], v[124:127], v[20:35]
v_mfma_f32_32x32x16_bf16 v[36:51], a[60:63], v[124:127], v[36:51]
buffer_load_dwordx4 v[156:159], v6, s[84:87], s51 offen offset:3072 sc1
s_waitcnt vmcnt(7)
v_mfma_f32_32x32x16_bf16 v[20:35], a[64:67], v[128:131], v[20:35]
v_mfma_f32_32x32x16_bf16 v[36:51], a[68:71], v[128:131], v[36:51]
s_add_u32 s51, s56, 16384
s_and_b32 s51, s51, 0x7fff
s_and_b32 s63, s51, 0x6000
s_add_u32 s51, s51, s63
s_add_u32 s51, s51, s50
buffer_load_dwordx4 v[160:163], v6, s[84:87], s51 offen offset:0 sc1
s_waitcnt vmcnt(7)
v_mfma_f32_32x32x16_bf16 v[20:35], a[72:75], v[132:135], v[20:35]
v_mfma_f32_32x32x16_bf16 v[36:51], a[76:79], v[132:135], v[36:51]
buffer_load_dwordx4 v[164:167], v6, s[84:87], s51 offen offset:1024 sc1
s_waitcnt vmcnt(7)
v_mfma_f32_32x32x16_bf16 v[20:35], a[80:83], v[136:139], v[20:35]
v_mfma_f32_32x32x16_bf16 v[36:51], a[84:87], v[136:139], v[36:51]
buffer_load_dwordx4 v[168:171], v6, s[84:87], s51 offen offset:2048 sc1
s_waitcnt vmcnt(7)
v_mfma_f32_32x32x16_bf16 v[20:35], a[88:91], v[140:143], v[20:35]
v_mfma_f32_32x32x16_bf16 v[36:51], a[92:95], v[140:143], v[36:51]
buffer_load_dwordx4 v[172:175], v6, s[84:87], s51 offen offset:3072 sc1
s_waitcnt vmcnt(7)
v_mfma_f32_32x32x16_bf16 v[20:35], a[96:99], v[144:147], v[20:35]
v_mfma_f32_32x32x16_bf16 v[36:51], a[100:103], v[144:147], v[36:51]
s_add_u32 s51, s56, 20480
s_and_b32 s51, s51, 0x7fff
s_and_b32 s63, s51, 0x6000
s_add_u32 s51, s51, s63
s_add_u32 s51, s51, s50
buffer_load_dwordx4 v[176:179], v6, s[84:87], s51 offen offset:0 sc1
s_waitcnt vmcnt(7)
v_mfma_f32_32x32x16_bf16 v[20:35], a[104:107], v[148:151], v[20:35]
v_mfma_f32_32x32x16_bf16 v[36:51], a[108:111], v[148:151], v[36:51]
buffer_load_dwordx4 v[180:183], v6, s[84:87], s51 offen offset:1024 sc1
s_waitcnt vmcnt(7)
v_mfma_f32_32x32x16_bf16 v[20:35], a[112:115], v[152:155], v[20:35]
v_mfma_f32_32x32x16_bf16 v[36:51], a[116:119], v[152:155], v[36:51]
buffer_load_dwordx4 v[184:187], v6, s[84:87], s51 offen offset:2048 sc1
s_waitcnt vmcnt(7)
v_mfma_f32_32x32x16_bf16 v[20:35], a[120:123], v[156:159], v[20:35]
v_mfma_f32_32x32x16_bf16 v[36:51], a[124:127], v[156:159], v[36:51]
buffer_load_dwordx4 v[188:191], v6, s[84:87], s51 offen offset:3072 sc1
s_waitcnt vmcnt(7)
v_mfma_f32_32x32x16_bf16 v[20:35], a[128:131], v[160:163], v[20:35]
v_mfma_f32_32x32x16_bf16 v[36:51], a[132:135], v[160:163], v[36:51]
s_add_u32 s51, s56, 24576
s_and_b32 s51, s51, 0x7fff
s_and_b32 s63, s51, 0x6000
s_add_u32 s51, s51, s63
s_add_u32 s51, s51, s50
buffer_load_dwordx4 v[192:195], v6, s[84:87], s51 offen offset:0 sc1
s_waitcnt vmcnt(7)
v_mfma_f32_32x32x16_bf16 v[20:35], a[136:139], v[164:167], v[20:35]
v_mfma_f32_32x32x16_bf16 v[36:51], a[140:143], v[164:167], v[36:51]
buffer_load_dwordx4 v[196:199], v6, s[84:87], s51 offen offset:1024 sc1
s_waitcnt vmcnt(7)
v_mfma_f32_32x32x16_bf16 v[20:35], a[144:147], v[168:171], v[20:35]
v_mfma_f32_32x32x16_bf16 v[36:51], a[148:151], v[168:171], v[36:51]
buffer_load_dwordx4 v[200:203], v6, s[84:87], s51 offen offset:2048 sc1
s_waitcnt vmcnt(7)
v_mfma_f32_32x32x16_bf16 v[20:35], a[152:155], v[172:175], v[20:35]
v_mfma_f32_32x32x16_bf16 v[36:51], a[156:159], v[172:175], v[36:51]
buffer_load_dwordx4 v[204:207], v6, s[84:87], s51 offen offset:3072 sc1
s_waitcnt vmcnt(7)
v_mfma_f32_32x32x16_bf16 v[20:35], a[160:163], v[176:179], v[20:35]
v_mfma_f32_32x32x16_bf16 v[36:51], a[164:167], v[176:179], v[36:51]
s_add_u32 s51, s56, 28672
s_and_b32 s51, s51, 0x7fff
s_and_b32 s63, s51, 0x6000
s_add_u32 s51, s51, s63
s_add_u32 s51, s51, s50
buffer_load_dwordx4 v[208:211], v6, s[84:87], s51 offen offset:0 sc1
s_waitcnt vmcnt(7)
v_mfma_f32_32x32x16_bf16 v[20:35], a[168:171], v[180:183], v[20:35]
v_mfma_f32_32x32x16_bf16 v[36:51], a[172:175], v[180:183], v[36:51]
buffer_load_dwordx4 v[212:215], v6, s[84:87], s51 offen offset:1024 sc1
s_waitcnt vmcnt(7)
v_mfma_f32_32x32x16_bf16 v[20:35], a[176:179], v[184:187], v[20:35]
v_mfma_f32_32x32x16_bf16 v[36:51], a[180:183], v[184:187], v[36:51]
buffer_load_dwordx4 v[216:219], v6, s[84:87], s51 offen offset:2048 sc1
s_waitcnt vmcnt(7)
v_mfma_f32_32x32x16_bf16 v[20:35], a[184:187], v[188:191], v[20:35]
v_mfma_f32_32x32x16_bf16 v[36:51], a[188:191], v[188:191], v[36:51]
buffer_load_dwordx4 v[220:223], v6, s[84:87], s51 offen offset:3072 sc1
s_waitcnt vmcnt(7)
v_mfma_f32_32x32x16_bf16 v[20:35], a[192:195], v[192:195], v[20:35]
v_mfma_f32_32x32x16_bf16 v[36:51], a[196:199], v[192:195], v[36:51]
s_sub_u32 s60, s62, s64
s_lshr_b32 s60, s60, s67
s_bfe_u32 s61, s60, 0x10001
s_and_b32 s60, s60, 1
s_lshl_b32 s60, s60, 12
buffer_load_dwordx4 v[88:91], v13, s[84:87], s60 offen sc1
buffer_load_dword v15, v7, s[84:87], 0 offen sc1
s_waitcnt vmcnt(6)
v_mfma_f32_32x32x16_bf16 v[20:35], a[200:203], v[196:199], v[20:35]
v_mfma_f32_32x32x16_bf16 v[36:51], a[204:207], v[196:199], v[36:51]
s_waitcnt vmcnt(5)
v_mfma_f32_32x32x16_bf16 v[20:35], a[208:211], v[200:203], v[20:35]
v_mfma_f32_32x32x16_bf16 v[36:51], a[212:215], v[200:203], v[36:51]
s_waitcnt vmcnt(4)
v_mfma_f32_32x32x16_bf16 v[20:35], a[216:219], v[204:207], v[20:35]
v_mfma_f32_32x32x16_bf16 v[36:51], a[220:223], v[204:207], v[36:51]
s_waitcnt vmcnt(3)
v_mfma_f32_32x32x16_bf16 v[20:35], a[224:227], v[208:211], v[20:35]
v_mfma_f32_32x32x16_bf16 v[36:51], a[228:231], v[208:211], v[36:51]
s_waitcnt vmcnt(2)
v_mfma_f32_32x32x16_bf16 v[20:35], a[232:235], v[212:215], v[20:35]
v_mfma_f32_32x32x16_bf16 v[36:51], a[236:239], v[212:215], v[36:51]
s_waitcnt vmcnt(1)
v_mfma_f32_32x32x16_bf16 v[20:35], a[240:243], v[216:219], v[20:35]
v_mfma_f32_32x32x16_bf16 v[36:51], a[244:247], v[216:219], v[36:51]
s_waitcnt vmcnt(0)
v_mfma_f32_32x32x16_bf16 v[224:239], a[248:251], v[220:223], v[20:35]
v_mfma_f32_32x32x16_bf16 v[240:255], a[252:255], v[220:223], v[36:51]
s_waitcnt vmcnt(0)
mega_kernel_o_fcc:
v_and_b32 v14, 1, v88
v_cmp_ne_u32 vcc, s61, v14
s_cbranch_vccz mega_kernel_o_fck
s_sub_u32 s60, s62, s64
s_lshr_b32 s60, s60, s67
s_bfe_u32 s61, s60, 0x10001
s_and_b32 s60, s60, 1
s_lshl_b32 s60, s60, 12
buffer_load_dwordx4 v[88:91], v13, s[84:87], s60 offen sc1
s_waitcnt vmcnt(0)
s_branch mega_kernel_o_fcc
mega_kernel_o_fck:
v_pk_add_f32 v[88:89], v[88:89], v[84:85]
v_pk_add_f32 v[90:91], v[90:91], v[86:87]
s_lshl_b32 s60, s62, 17
v_cvt_pk_bf16_f32 v92, v88, v89
v_cvt_pk_bf16_f32 v93, v90, v91
buffer_store_dwordx2 v[92:93], v11, s[8:11], s60 offen sc1
s_lshr_b32 s63, s54, 2
s_xnor_b32 s63, s63, s98
s_and_b32 s63, s63, 1
s_lshl_b32 s63, s63, 13
s_lshl_b32 s50, s54, 19
s_add_u32 s50, s50, s63
s_branch mega_kernel_o_imm
mega_kernel_o_im2:
v_add_u32 v2, s53, v8
v_add_u32 v3, s53, v9
v_add_u32 v4, s53, v10
ds_write_b128 v2, v[224:227] offset:0
ds_write_b128 v2, v[228:231] offset:1088
ds_write_b128 v2, v[232:235] offset:2176
ds_write_b128 v2, v[236:239] offset:3264
ds_write_b128 v2, v[240:243] offset:4352
ds_write_b128 v2, v[244:247] offset:5440
ds_write_b128 v2, v[248:251] offset:6528
ds_write_b128 v2, v[252:255] offset:7616
s_waitcnt lgkmcnt(0)
s_barrier
ds_read_b128 v[52:55], v4 offset:0
ds_read_b128 v[56:59], v4 offset:8704
ds_read_b128 v[60:63], v4 offset:17408
ds_read_b128 v[64:67], v4 offset:26112
ds_read_b128 v[68:71], v3 offset:0
ds_read_b128 v[72:75], v3 offset:8704
ds_read_b128 v[76:79], v3 offset:17408
ds_read_b128 v[80:83], v3 offset:26112
s_sub_u32 s53, 34816, s53
s_sub_u32 s60, s42, s64
s_lshr_b32 s60, s60, s67
s_bfe_u32 s61, s60, 0x10001
s_and_b32 s60, s60, 1
s_lshl_b32 s60, s60, 12
s_waitcnt lgkmcnt(4)
v_add_f32 v52, v52, v56
v_add_f32 v60, v60, v64
v_add_f32 v53, v53, v57
v_add_f32 v61, v61, v65
v_add_f32 v54, v54, v58
v_add_f32 v62, v62, v66
v_add_f32 v55, v55, v59
v_add_f32 v63, v63, v67
v_add_f32 v52, v52, v60
v_add_f32 v53, v53, v61
v_add_f32 v54, v54, v62
v_add_f32 v55, v55, v63
v_and_or_b32 v52, v52, -2, s61
s_cmp_eq_u32 s95, 0
s_cbranch_scc1 mega_kernel_o_sa4
buffer_store_dwordx4 v[52:55], v12, s[84:87], s60 offen sc1
s_branch mega_kernel_o_sb4
mega_kernel_o_sa4:
buffer_store_dwordx4 v[52:55], v12, s[84:87], s60 offen
mega_kernel_o_sb4:
s_waitcnt lgkmcnt(0)
v_add_f32 v68, v68, v72
v_add_f32 v76, v76, v80
v_add_f32 v69, v69, v73
v_add_f32 v77, v77, v81
v_add_f32 v70, v70, v74
v_add_f32 v78, v78, v82
v_add_f32 v71, v71, v75
v_add_f32 v79, v79, v83
v_add_f32 v84, v68, v76
v_add_f32 v85, v69, v77
v_add_f32 v86, v70, v78
v_add_f32 v87, v71, v79
s_sub_u32 s60, s42, s64
s_lshr_b32 s60, s60, s67
s_bfe_u32 s61, s60, 0x10001
s_and_b32 s60, s60, 1
s_lshl_b32 s60, s60, 12
buffer_load_dwordx4 v[88:91], v13, s[84:87], s60 offen sc1
s_waitcnt vmcnt(0)
mega_kernel_o_f2c:
v_and_b32 v14, 1, v88
v_cmp_ne_u32 vcc, s61, v14
s_cbranch_vccz mega_kernel_o_f2k
s_sub_u32 s60, s42, s64
s_lshr_b32 s60, s60, s67
s_bfe_u32 s61, s60, 0x10001
s_and_b32 s60, s60, 1
s_lshl_b32 s60, s60, 12
buffer_load_dwordx4 v[88:91], v13, s[84:87], s60 offen sc1
s_waitcnt vmcnt(0)
s_branch mega_kernel_o_f2c
mega_kernel_o_f2k:
v_pk_add_f32 v[88:89], v[88:89], v[84:85]
v_pk_add_f32 v[90:91], v[90:91], v[86:87]
s_lshl_b32 s60, s42, 17
v_cvt_pk_bf16_f32 v92, v88, v89
v_cvt_pk_bf16_f32 v93, v90, v91
buffer_store_dwordx2 v[92:93], v11, s[8:11], s60 offen sc1
s_add_u32 s42, s42, s71
s_cmp_lt_u32 s42, s65
s_cbranch_scc1 mega_kernel_o_cold
mega_kernel_o_quit:
s_endpgm
mega_kernel_exit:
s_endpgm
mega_kernel_recf:
s_load_dwordx2 s[20:21], s[0:1], 8
s_load_dwordx2 s[16:17], s[0:1], 40
s_load_dwordx2 s[4:5], s[0:1], 16
s_load_dwordx2 s[8:9], s[0:1], 24
s_load_dwordx2 s[12:13], s[0:1], 32
v_lshrrev_b32 v4, 6, v0
v_and_b32 v1, 63, v0
v_readfirstlane_b32 s24, v4
v_lshrrev_b32 v2, 4, v1
v_and_b32 v3, 15, v1
v_lshlrev_b32 v17, 4, v1
s_lshr_b32 s28, s31, 2
s_lshl_b32 s25, s30, 3
s_add_u32 s25, s25, s28
s_and_b32 s26, s31, 3
s_waitcnt lgkmcnt(0)
s_mov_b32 s22, 16384
s_mov_b32 s23, 0x00020000
s_mov_b32 s18, 8388608
s_mov_b32 s19, 0x00020000
s_mov_b32 s6, 8388608
s_mov_b32 s7, 0x00020000
s_mov_b32 s10, 8388608
s_mov_b32 s11, 0x00020000
s_mov_b32 s14, 8388608
s_mov_b32 s15, 0x00020000
s_lshl_b32 s28, s25, 8
s_lshr_b32 s29, s26, 0
s_lshl_b32 s29, s29, 6
s_add_u32 s28, s28, s29
s_lshl_b32 s29, s24, 21
s_add_u32 s28, s28, s29
v_lshrrev_b32 v4, 2, v1
v_and_b32 v5, 3, v1
v_lshlrev_b32 v40, 13, v4
v_lshl_add_u32 v40, v5, 4, v40
v_add_u32 v40, s28, v40
s_lshl_b32 s28, s30, 21
s_lshl_b32 s29, s24, 19
s_add_u32 s28, s28, s29
s_lshr_b32 s29, s31, 0
s_lshl_b32 s29, s29, 6
s_add_u32 s28, s28, s29
v_lshlrev_b32 v41, 11, v4
v_lshl_add_u32 v41, v5, 4, v41
v_add_u32 v41, s28, v41
s_lshl_b32 s47, s24, 15
s_add_u32 s47, s47, 32768
s_lshl_b32 s28, s31, 18
s_lshl_b32 s29, s24, 16
s_add_u32 s28, s28, s29
s_lshl_b32 s29, s30, 11
s_add_u32 s28, s28, s29
v_lshlrev_b32 v48, 13, v2
v_lshl_add_u32 v48, v3, 7, v48
v_add_u32 v48, s28, v48
s_lshl_b32 s28, s30, 21
s_lshl_b32 s29, s31, 16
s_add_u32 s28, s28, s29
s_lshl_b32 s29, s24, 14
s_add_u32 s28, s28, s29
v_lshlrev_b32 v49, 7, v1
v_add_u32 v49, s28, v49
s_and_b32 s76, s31, 1
s_mul_i32 s76, s76, 8
s_and_b32 s28, s31, 15
s_lshl_b32 s28, s28, 4
s_lshl_b32 s29, s24, 8
s_add_u32 s28, s28, s29
v_add_u32 v53, s28, v3
s_lshr_b32 s28, s31, 4
s_lshl_b32 s28, s28, 10
s_add_u32 s28, s28, 384
v_mov_b32 v54, s28
v_mov_b32 v55, 1920
v_cmp_gt_u32 vcc, 32, v1
s_nop 1
v_cndmask_b32 v54, v55, v54, vcc
s_lshl_b32 s29, s30, 11
v_lshl_add_u32 v51, v53, 13, v54
v_add_u32 v51, s29, v51
s_lshl_b32 s29, s30, 21
v_lshl_add_u32 v52, v53, 11, v54
v_add_u32 v52, s29, v52
buffer_load_dword v50, v51, s[8:11], 0 offen
s_xor_b32 s29, s76, 0
s_lshl_b32 s28, s29, 10
s_add_u32 s28, s28, s47
s_add_u32 m0, s28, 0
s_lshl_b32 s29, s29, 17
buffer_load_dwordx4 v40, s[8:11], s29 offen lds
s_xor_b32 s29, s76, 1
s_lshl_b32 s28, s29, 10
s_add_u32 s28, s28, s47
s_add_u32 m0, s28, 0
s_lshl_b32 s29, s29, 17
buffer_load_dwordx4 v40, s[8:11], s29 offen lds
s_xor_b32 s29, s76, 2
s_lshl_b32 s28, s29, 10
s_add_u32 s28, s28, s47
s_add_u32 m0, s28, 0
s_lshl_b32 s29, s29, 17
buffer_load_dwordx4 v40, s[8:11], s29 offen lds
s_xor_b32 s29, s76, 3
s_lshl_b32 s28, s29, 10
s_add_u32 s28, s28, s47
s_add_u32 m0, s28, 0
s_lshl_b32 s29, s29, 17
buffer_load_dwordx4 v40, s[8:11], s29 offen lds
s_xor_b32 s29, s76, 4
s_lshl_b32 s28, s29, 10
s_add_u32 s28, s28, s47
s_add_u32 m0, s28, 0
s_lshl_b32 s29, s29, 17
buffer_load_dwordx4 v40, s[8:11], s29 offen lds
s_xor_b32 s29, s76, 5
s_lshl_b32 s28, s29, 10
s_add_u32 s28, s28, s47
s_add_u32 m0, s28, 0
s_lshl_b32 s29, s29, 17
buffer_load_dwordx4 v40, s[8:11], s29 offen lds
s_xor_b32 s29, s76, 6
s_lshl_b32 s28, s29, 10
s_add_u32 s28, s28, s47
s_add_u32 m0, s28, 0
s_lshl_b32 s29, s29, 17
buffer_load_dwordx4 v40, s[8:11], s29 offen lds
s_xor_b32 s29, s76, 7
s_lshl_b32 s28, s29, 10
s_add_u32 s28, s28, s47
s_add_u32 m0, s28, 0
s_lshl_b32 s29, s29, 17
buffer_load_dwordx4 v40, s[8:11], s29 offen lds
s_xor_b32 s29, s76, 8
s_lshl_b32 s28, s29, 10
s_add_u32 s28, s28, s47
s_add_u32 m0, s28, 0
s_lshl_b32 s29, s29, 17
buffer_load_dwordx4 v40, s[8:11], s29 offen lds
s_xor_b32 s29, s76, 9
s_lshl_b32 s28, s29, 10
s_add_u32 s28, s28, s47
s_add_u32 m0, s28, 0
s_lshl_b32 s29, s29, 17
buffer_load_dwordx4 v40, s[8:11], s29 offen lds
s_xor_b32 s29, s76, 10
s_lshl_b32 s28, s29, 10
s_add_u32 s28, s28, s47
s_add_u32 m0, s28, 0
s_lshl_b32 s29, s29, 17
buffer_load_dwordx4 v40, s[8:11], s29 offen lds
s_xor_b32 s29, s76, 11
s_lshl_b32 s28, s29, 10
s_add_u32 s28, s28, s47
s_add_u32 m0, s28, 0
s_lshl_b32 s29, s29, 17
buffer_load_dwordx4 v40, s[8:11], s29 offen lds
s_xor_b32 s29, s76, 12
s_lshl_b32 s28, s29, 10
s_add_u32 s28, s28, s47
s_add_u32 m0, s28, 0
s_lshl_b32 s29, s29, 17
buffer_load_dwordx4 v40, s[8:11], s29 offen lds
s_xor_b32 s29, s76, 13
s_lshl_b32 s28, s29, 10
s_add_u32 s28, s28, s47
s_add_u32 m0, s28, 0
s_lshl_b32 s29, s29, 17
buffer_load_dwordx4 v40, s[8:11], s29 offen lds
s_xor_b32 s29, s76, 14
s_lshl_b32 s28, s29, 10
s_add_u32 s28, s28, s47
s_add_u32 m0, s28, 0
s_lshl_b32 s29, s29, 17
buffer_load_dwordx4 v40, s[8:11], s29 offen lds
s_xor_b32 s29, s76, 15
s_lshl_b32 s28, s29, 10
s_add_u32 s28, s28, s47
s_add_u32 m0, s28, 0
s_lshl_b32 s29, s29, 17
buffer_load_dwordx4 v40, s[8:11], s29 offen lds
buffer_load_dword v50, v51, s[12:15], 0 offen
s_xor_b32 s29, s76, 0
s_lshl_b32 s28, s29, 10
s_add_u32 s28, s28, s47
s_add_u32 m0, s28, 16384
s_lshl_b32 s29, s29, 17
buffer_load_dwordx4 v40, s[12:15], s29 offen lds
s_xor_b32 s29, s76, 1
s_lshl_b32 s28, s29, 10
s_add_u32 s28, s28, s47
s_add_u32 m0, s28, 16384
s_lshl_b32 s29, s29, 17
buffer_load_dwordx4 v40, s[12:15], s29 offen lds
s_xor_b32 s29, s76, 2
s_lshl_b32 s28, s29, 10
s_add_u32 s28, s28, s47
s_add_u32 m0, s28, 16384
s_lshl_b32 s29, s29, 17
buffer_load_dwordx4 v40, s[12:15], s29 offen lds
s_xor_b32 s29, s76, 3
s_lshl_b32 s28, s29, 10
s_add_u32 s28, s28, s47
s_add_u32 m0, s28, 16384
s_lshl_b32 s29, s29, 17
buffer_load_dwordx4 v40, s[12:15], s29 offen lds
s_xor_b32 s29, s76, 4
s_lshl_b32 s28, s29, 10
s_add_u32 s28, s28, s47
s_add_u32 m0, s28, 16384
s_lshl_b32 s29, s29, 17
buffer_load_dwordx4 v40, s[12:15], s29 offen lds
s_xor_b32 s29, s76, 5
s_lshl_b32 s28, s29, 10
s_add_u32 s28, s28, s47
s_add_u32 m0, s28, 16384
s_lshl_b32 s29, s29, 17
buffer_load_dwordx4 v40, s[12:15], s29 offen lds
s_xor_b32 s29, s76, 6
s_lshl_b32 s28, s29, 10
s_add_u32 s28, s28, s47
s_add_u32 m0, s28, 16384
s_lshl_b32 s29, s29, 17
buffer_load_dwordx4 v40, s[12:15], s29 offen lds
s_xor_b32 s29, s76, 7
s_lshl_b32 s28, s29, 10
s_add_u32 s28, s28, s47
s_add_u32 m0, s28, 16384
s_lshl_b32 s29, s29, 17
buffer_load_dwordx4 v40, s[12:15], s29 offen lds
s_xor_b32 s29, s76, 8
s_lshl_b32 s28, s29, 10
s_add_u32 s28, s28, s47
s_add_u32 m0, s28, 16384
s_lshl_b32 s29, s29, 17
buffer_load_dwordx4 v40, s[12:15], s29 offen lds
s_xor_b32 s29, s76, 9
s_lshl_b32 s28, s29, 10
s_add_u32 s28, s28, s47
s_add_u32 m0, s28, 16384
s_lshl_b32 s29, s29, 17
buffer_load_dwordx4 v40, s[12:15], s29 offen lds
s_xor_b32 s29, s76, 10
s_lshl_b32 s28, s29, 10
s_add_u32 s28, s28, s47
s_add_u32 m0, s28, 16384
s_lshl_b32 s29, s29, 17
buffer_load_dwordx4 v40, s[12:15], s29 offen lds
s_xor_b32 s29, s76, 11
s_lshl_b32 s28, s29, 10
s_add_u32 s28, s28, s47
s_add_u32 m0, s28, 16384
s_lshl_b32 s29, s29, 17
buffer_load_dwordx4 v40, s[12:15], s29 offen lds
s_xor_b32 s29, s76, 12
s_lshl_b32 s28, s29, 10
s_add_u32 s28, s28, s47
s_add_u32 m0, s28, 16384
s_lshl_b32 s29, s29, 17
buffer_load_dwordx4 v40, s[12:15], s29 offen lds
s_xor_b32 s29, s76, 13
s_lshl_b32 s28, s29, 10
s_add_u32 s28, s28, s47
s_add_u32 m0, s28, 16384
s_lshl_b32 s29, s29, 17
buffer_load_dwordx4 v40, s[12:15], s29 offen lds
s_xor_b32 s29, s76, 14
s_lshl_b32 s28, s29, 10
s_add_u32 s28, s28, s47
s_add_u32 m0, s28, 16384
s_lshl_b32 s29, s29, 17
buffer_load_dwordx4 v40, s[12:15], s29 offen lds
s_xor_b32 s29, s76, 15
s_lshl_b32 s28, s29, 10
s_add_u32 s28, s28, s47
s_add_u32 m0, s28, 16384
s_lshl_b32 s29, s29, 17
buffer_load_dwordx4 v40, s[12:15], s29 offen lds
s_mov_b32 s40, 0x00ff00ff
s_mov_b32 s41, 0x00ff00ff
s_mov_b32 s48, 0xff00ff00
s_mov_b32 s49, 0xff00ff00
s_mov_b32 s42, 0
s_mov_b32 s43, 0x00ff00ff
s_mov_b32 s32, 0x3e0293ee
v_mov_b32 v23, 0xff800000
v_mov_b32 v6, 0x4444
v_mov_b32 v4, 0xeeee
v_cndmask_b32 v6, v6, v4, s[48:49]
v_mov_b32 v28, -1
v_mov_b32 v29, -1
v_mov_b32 v30, -1
v_mov_b32 v31, -1
s_mul_i32 s28, s24, 4096
v_add_u32 v7, s28, v17
v_and_b32 v4, 7, v1
v_lshlrev_b32 v8, 11, v4
v_lshrrev_b32 v5, 3, v1
v_lshl_add_u32 v8, v5, 4, v8
s_lshl_b32 s28, s24, 9
v_add_u32 v8, s28, v8
s_lshl_b32 s28, s31, 9
s_lshr_b32 s29, s31, 3
s_mul_i32 s29, s29, 0
s_add_u32 s28, s28, s29
v_lshlrev_b32 v9, 3, v1
v_add_u32 v9, s28, v9
v_and_b32 v4, 7, v3
v_lshlrev_b32 v11, 7, v2
v_lshl_add_u32 v11, v4, 4, v11
v_add_u32 v22, 0, v11
s_add_u32 s28, s28, 24576
v_add_u32 v11, s28, v11
v_and_b32 v5, 1, v2
v_lshlrev_b32 v10, 7, v5
v_lshl_add_u32 v10, v4, 4, v10
v_add_u32 v10, 1024, v10
s_xor_b32 s37, s31, 1
s_mul_i32 s37, s37, 1280
s_add_u32 s37, s37, 49152
s_xor_b32 s38, s31, 2
s_mul_i32 s38, s38, 1280
s_add_u32 s38, s38, 49152
s_xor_b32 s39, s31, 3
s_mul_i32 s39, s39, 1280
s_add_u32 s39, s39, 49152
v_and_b32 v4, 1, v2
v_mul_u32_u24 v14, 576, v4
v_lshrrev_b32 v5, 1, v2
v_lshl_add_u32 v5, v5, 4, v3
v_lshl_add_u32 v14, v5, 2, v14
s_mul_i32 s28, s24, 1152
s_add_u32 s28, s28, 13312
v_add_u32 v18, s28, v14
s_mul_i32 s28, s24, 2304
v_add_u32 v14, s28, v14
v_add_u32 v15, 1152, v14
v_mul_u32_u24 v16, 144, v3
v_lshl_add_u32 v16, v2, 5, v16
v_bfe_u32 v4, v1, 1, 3
v_mul_u32_u24 v19, 144, v4
v_lshl_add_u32 v19, v2, 5, v19
v_and_b32 v4, 1, v1
v_lshl_add_u32 v19, v4, 4, v19
v_add_u32 v19, 13312, v19
s_lshl_b32 s28, s24, 10
s_add_u32 s28, s28, 9216
v_add_u32 v20, s28, v17
v_and_b32 v4, 31, v1
v_lshlrev_b32 v21, 3, v4
v_add_u32 v21, 17920, v21
v_lshrrev_b32 v4, 2, v3
v_and_b32 v42, 1, v4
v_lshrrev_b32 v43, 1, v4
v_lshrrev_b32 v44, 1, v2
v_and_b32 v45, 1, v2
v_lshl_add_u32 v46, v44, 4, v42
v_lshl_add_u32 v46, v45, 2, v46
v_lshl_add_u32 v46, v43, 3, v46
v_lshl_add_u32 v47, v44, 3, v42
v_lshl_add_u32 v47, v45, 4, v47
v_lshl_add_u32 v47, v43, 2, v47
v_and_b32 v5, 3, v3
v_lshlrev_b32 v5, 3, v5
v_lshl_add_u32 v46, v46, 6, v5
v_lshl_add_u32 v47, v47, 6, v5
s_and_b32 s28, s31, 0
s_lshl_b32 s28, s28, 6
s_add_u32 s28, s28, s47
v_add_u32 v46, s28, v46
v_add_u32 v47, s28, v47
s_waitcnt vmcnt(17)
ds_read_b64_tr_b16 a[64:65], v46 offset:0
ds_read_b64_tr_b16 a[66:67], v46 offset:128
ds_read_b64_tr_b16 a[68:69], v46 offset:2048
ds_read_b64_tr_b16 a[70:71], v46 offset:2176
ds_read_b64_tr_b16 a[72:73], v46 offset:4096
ds_read_b64_tr_b16 a[74:75], v46 offset:4224
ds_read_b64_tr_b16 a[76:77], v46 offset:6144
ds_read_b64_tr_b16 a[78:79], v46 offset:6272
s_waitcnt lgkmcnt(0)
ds_read_b64_tr_b16 a[80:81], v46 offset:8192
ds_read_b64_tr_b16 a[82:83], v46 offset:8320
ds_read_b64_tr_b16 a[84:85], v46 offset:10240
ds_read_b64_tr_b16 a[86:87], v46 offset:10368
ds_read_b64_tr_b16 a[88:89], v46 offset:12288
ds_read_b64_tr_b16 a[90:91], v46 offset:12416
ds_read_b64_tr_b16 a[92:93], v46 offset:14336
ds_read_b64_tr_b16 a[94:95], v46 offset:14464
s_waitcnt lgkmcnt(0)
ds_read_b64_tr_b16 a[96:97], v46 offset:32
ds_read_b64_tr_b16 a[98:99], v46 offset:160
ds_read_b64_tr_b16 a[100:101], v46 offset:2080
ds_read_b64_tr_b16 a[102:103], v46 offset:2208
ds_read_b64_tr_b16 a[104:105], v46 offset:4128
ds_read_b64_tr_b16 a[106:107], v46 offset:4256
ds_read_b64_tr_b16 a[108:109], v46 offset:6176
ds_read_b64_tr_b16 a[110:111], v46 offset:6304
s_waitcnt lgkmcnt(0)
ds_read_b64_tr_b16 a[112:113], v46 offset:8224
ds_read_b64_tr_b16 a[114:115], v46 offset:8352
ds_read_b64_tr_b16 a[116:117], v46 offset:10272
ds_read_b64_tr_b16 a[118:119], v46 offset:10400
ds_read_b64_tr_b16 a[120:121], v46 offset:12320
ds_read_b64_tr_b16 a[122:123], v46 offset:12448
ds_read_b64_tr_b16 a[124:125], v46 offset:14368
ds_read_b64_tr_b16 a[126:127], v46 offset:14496
s_waitcnt lgkmcnt(0)
buffer_load_dword v50, v51, s[4:7], 0 offen
s_xor_b32 s29, s76, 0
s_lshl_b32 s28, s29, 10
s_add_u32 s28, s28, s47
s_add_u32 m0, s28, 0
s_lshl_b32 s29, s29, 17
buffer_load_dwordx4 v40, s[4:7], s29 offen lds
s_xor_b32 s29, s76, 1
s_lshl_b32 s28, s29, 10
s_add_u32 s28, s28, s47
s_add_u32 m0, s28, 0
s_lshl_b32 s29, s29, 17
buffer_load_dwordx4 v40, s[4:7], s29 offen lds
s_xor_b32 s29, s76, 2
s_lshl_b32 s28, s29, 10
s_add_u32 s28, s28, s47
s_add_u32 m0, s28, 0
s_lshl_b32 s29, s29, 17
buffer_load_dwordx4 v40, s[4:7], s29 offen lds
s_xor_b32 s29, s76, 3
s_lshl_b32 s28, s29, 10
s_add_u32 s28, s28, s47
s_add_u32 m0, s28, 0
s_lshl_b32 s29, s29, 17
buffer_load_dwordx4 v40, s[4:7], s29 offen lds
s_xor_b32 s29, s76, 4
s_lshl_b32 s28, s29, 10
s_add_u32 s28, s28, s47
s_add_u32 m0, s28, 0
s_lshl_b32 s29, s29, 17
buffer_load_dwordx4 v40, s[4:7], s29 offen lds
s_xor_b32 s29, s76, 5
s_lshl_b32 s28, s29, 10
s_add_u32 s28, s28, s47
s_add_u32 m0, s28, 0
s_lshl_b32 s29, s29, 17
buffer_load_dwordx4 v40, s[4:7], s29 offen lds
s_xor_b32 s29, s76, 6
s_lshl_b32 s28, s29, 10
s_add_u32 s28, s28, s47
s_add_u32 m0, s28, 0
s_lshl_b32 s29, s29, 17
buffer_load_dwordx4 v40, s[4:7], s29 offen lds
s_xor_b32 s29, s76, 7
s_lshl_b32 s28, s29, 10
s_add_u32 s28, s28, s47
s_add_u32 m0, s28, 0
s_lshl_b32 s29, s29, 17
buffer_load_dwordx4 v40, s[4:7], s29 offen lds
s_xor_b32 s29, s76, 8
s_lshl_b32 s28, s29, 10
s_add_u32 s28, s28, s47
s_add_u32 m0, s28, 0
s_lshl_b32 s29, s29, 17
buffer_load_dwordx4 v40, s[4:7], s29 offen lds
s_xor_b32 s29, s76, 9
s_lshl_b32 s28, s29, 10
s_add_u32 s28, s28, s47
s_add_u32 m0, s28, 0
s_lshl_b32 s29, s29, 17
buffer_load_dwordx4 v40, s[4:7], s29 offen lds
s_xor_b32 s29, s76, 10
s_lshl_b32 s28, s29, 10
s_add_u32 s28, s28, s47
s_add_u32 m0, s28, 0
s_lshl_b32 s29, s29, 17
buffer_load_dwordx4 v40, s[4:7], s29 offen lds
s_xor_b32 s29, s76, 11
s_lshl_b32 s28, s29, 10
s_add_u32 s28, s28, s47
s_add_u32 m0, s28, 0
s_lshl_b32 s29, s29, 17
buffer_load_dwordx4 v40, s[4:7], s29 offen lds
s_xor_b32 s29, s76, 12
s_lshl_b32 s28, s29, 10
s_add_u32 s28, s28, s47
s_add_u32 m0, s28, 0
s_lshl_b32 s29, s29, 17
buffer_load_dwordx4 v40, s[4:7], s29 offen lds
s_xor_b32 s29, s76, 13
s_lshl_b32 s28, s29, 10
s_add_u32 s28, s28, s47
s_add_u32 m0, s28, 0
s_lshl_b32 s29, s29, 17
buffer_load_dwordx4 v40, s[4:7], s29 offen lds
s_xor_b32 s29, s76, 14
s_lshl_b32 s28, s29, 10
s_add_u32 s28, s28, s47
s_add_u32 m0, s28, 0
s_lshl_b32 s29, s29, 17
buffer_load_dwordx4 v40, s[4:7], s29 offen lds
s_xor_b32 s29, s76, 15
s_lshl_b32 s28, s29, 10
s_add_u32 s28, s28, s47
s_add_u32 m0, s28, 0
s_lshl_b32 s29, s29, 17
buffer_load_dwordx4 v40, s[4:7], s29 offen lds
s_waitcnt vmcnt(17)
ds_read_b64_tr_b16 a[128:129], v46 offset:16384
ds_read_b64_tr_b16 a[130:131], v46 offset:16512
ds_read_b64_tr_b16 a[132:133], v46 offset:18432
ds_read_b64_tr_b16 a[134:135], v46 offset:18560
ds_read_b64_tr_b16 a[136:137], v46 offset:20480
ds_read_b64_tr_b16 a[138:139], v46 offset:20608
ds_read_b64_tr_b16 a[140:141], v46 offset:22528
ds_read_b64_tr_b16 a[142:143], v46 offset:22656
s_waitcnt lgkmcnt(0)
ds_read_b64_tr_b16 a[144:145], v46 offset:24576
ds_read_b64_tr_b16 a[146:147], v46 offset:24704
ds_read_b64_tr_b16 a[148:149], v46 offset:26624
ds_read_b64_tr_b16 a[150:151], v46 offset:26752
ds_read_b64_tr_b16 a[152:153], v46 offset:28672
ds_read_b64_tr_b16 a[154:155], v46 offset:28800
ds_read_b64_tr_b16 a[156:157], v46 offset:30720
ds_read_b64_tr_b16 a[158:159], v46 offset:30848
s_waitcnt lgkmcnt(0)
ds_read_b64_tr_b16 a[160:161], v46 offset:16416
ds_read_b64_tr_b16 a[162:163], v46 offset:16544
ds_read_b64_tr_b16 a[164:165], v46 offset:18464
ds_read_b64_tr_b16 a[166:167], v46 offset:18592
ds_read_b64_tr_b16 a[168:169], v46 offset:20512
ds_read_b64_tr_b16 a[170:171], v46 offset:20640
ds_read_b64_tr_b16 a[172:173], v46 offset:22560
ds_read_b64_tr_b16 a[174:175], v46 offset:22688
s_waitcnt lgkmcnt(0)
ds_read_b64_tr_b16 a[176:177], v46 offset:24608
ds_read_b64_tr_b16 a[178:179], v46 offset:24736
ds_read_b64_tr_b16 a[180:181], v46 offset:26656
ds_read_b64_tr_b16 a[182:183], v46 offset:26784
ds_read_b64_tr_b16 a[184:185], v46 offset:28704
ds_read_b64_tr_b16 a[186:187], v46 offset:28832
ds_read_b64_tr_b16 a[188:189], v46 offset:30752
ds_read_b64_tr_b16 a[190:191], v46 offset:30880
s_waitcnt lgkmcnt(0)
buffer_load_dword v50, v52, s[16:19], 0 offen
s_xor_b32 s29, s76, 0
s_lshl_b32 s28, s29, 10
s_add_u32 s28, s28, s47
s_add_u32 m0, s28, 16384
s_lshl_b32 s29, s29, 15
buffer_load_dwordx4 v41, s[16:19], s29 offen lds
s_xor_b32 s29, s76, 1
s_lshl_b32 s28, s29, 10
s_add_u32 s28, s28, s47
s_add_u32 m0, s28, 16384
s_lshl_b32 s29, s29, 15
buffer_load_dwordx4 v41, s[16:19], s29 offen lds
s_xor_b32 s29, s76, 2
s_lshl_b32 s28, s29, 10
s_add_u32 s28, s28, s47
s_add_u32 m0, s28, 16384
s_lshl_b32 s29, s29, 15
buffer_load_dwordx4 v41, s[16:19], s29 offen lds
s_xor_b32 s29, s76, 3
s_lshl_b32 s28, s29, 10
s_add_u32 s28, s28, s47
s_add_u32 m0, s28, 16384
s_lshl_b32 s29, s29, 15
buffer_load_dwordx4 v41, s[16:19], s29 offen lds
s_xor_b32 s29, s76, 4
s_lshl_b32 s28, s29, 10
s_add_u32 s28, s28, s47
s_add_u32 m0, s28, 16384
s_lshl_b32 s29, s29, 15
buffer_load_dwordx4 v41, s[16:19], s29 offen lds
s_xor_b32 s29, s76, 5
s_lshl_b32 s28, s29, 10
s_add_u32 s28, s28, s47
s_add_u32 m0, s28, 16384
s_lshl_b32 s29, s29, 15
buffer_load_dwordx4 v41, s[16:19], s29 offen lds
s_xor_b32 s29, s76, 6
s_lshl_b32 s28, s29, 10
s_add_u32 s28, s28, s47
s_add_u32 m0, s28, 16384
s_lshl_b32 s29, s29, 15
buffer_load_dwordx4 v41, s[16:19], s29 offen lds
s_xor_b32 s29, s76, 7
s_lshl_b32 s28, s29, 10
s_add_u32 s28, s28, s47
s_add_u32 m0, s28, 16384
s_lshl_b32 s29, s29, 15
buffer_load_dwordx4 v41, s[16:19], s29 offen lds
s_xor_b32 s29, s76, 8
s_lshl_b32 s28, s29, 10
s_add_u32 s28, s28, s47
s_add_u32 m0, s28, 16384
s_lshl_b32 s29, s29, 15
buffer_load_dwordx4 v41, s[16:19], s29 offen lds
s_xor_b32 s29, s76, 9
s_lshl_b32 s28, s29, 10
s_add_u32 s28, s28, s47
s_add_u32 m0, s28, 16384
s_lshl_b32 s29, s29, 15
buffer_load_dwordx4 v41, s[16:19], s29 offen lds
s_xor_b32 s29, s76, 10
s_lshl_b32 s28, s29, 10
s_add_u32 s28, s28, s47
s_add_u32 m0, s28, 16384
s_lshl_b32 s29, s29, 15
buffer_load_dwordx4 v41, s[16:19], s29 offen lds
s_xor_b32 s29, s76, 11
s_lshl_b32 s28, s29, 10
s_add_u32 s28, s28, s47
s_add_u32 m0, s28, 16384
s_lshl_b32 s29, s29, 15
buffer_load_dwordx4 v41, s[16:19], s29 offen lds
s_xor_b32 s29, s76, 12
s_lshl_b32 s28, s29, 10
s_add_u32 s28, s28, s47
s_add_u32 m0, s28, 16384
s_lshl_b32 s29, s29, 15
buffer_load_dwordx4 v41, s[16:19], s29 offen lds
s_xor_b32 s29, s76, 13
s_lshl_b32 s28, s29, 10
s_add_u32 s28, s28, s47
s_add_u32 m0, s28, 16384
s_lshl_b32 s29, s29, 15
buffer_load_dwordx4 v41, s[16:19], s29 offen lds
s_xor_b32 s29, s76, 14
s_lshl_b32 s28, s29, 10
s_add_u32 s28, s28, s47
s_add_u32 m0, s28, 16384
s_lshl_b32 s29, s29, 15
buffer_load_dwordx4 v41, s[16:19], s29 offen lds
s_xor_b32 s29, s76, 15
s_lshl_b32 s28, s29, 10
s_add_u32 s28, s28, s47
s_add_u32 m0, s28, 16384
s_lshl_b32 s29, s29, 15
buffer_load_dwordx4 v41, s[16:19], s29 offen lds
s_mov_b64 exec, 0
s_cmp_eq_u32 s24, 0
s_cbranch_scc1 mega_kernel_rf_iw0
s_cmp_eq_u32 s24, 1
s_cbranch_scc1 mega_kernel_rf_iw1
s_cmp_eq_u32 s24, 2
s_cbranch_scc1 mega_kernel_rf_iw2
s_branch mega_kernel_rf_iw3
mega_kernel_rf_iwd:
s_mov_b64 exec, -1
s_waitcnt vmcnt(17)
ds_read_b64_tr_b16 a[0:1], v46 offset:0
ds_read_b64_tr_b16 a[2:3], v46 offset:128
ds_read_b64_tr_b16 a[4:5], v46 offset:2048
ds_read_b64_tr_b16 a[6:7], v46 offset:2176
ds_read_b64_tr_b16 a[8:9], v46 offset:4096
ds_read_b64_tr_b16 a[10:11], v46 offset:4224
ds_read_b64_tr_b16 a[12:13], v46 offset:6144
ds_read_b64_tr_b16 a[14:15], v46 offset:6272
s_waitcnt lgkmcnt(0)
ds_read_b64_tr_b16 a[16:17], v46 offset:8192
ds_read_b64_tr_b16 a[18:19], v46 offset:8320
ds_read_b64_tr_b16 a[20:21], v46 offset:10240
ds_read_b64_tr_b16 a[22:23], v46 offset:10368
ds_read_b64_tr_b16 a[24:25], v46 offset:12288
ds_read_b64_tr_b16 a[26:27], v46 offset:12416
ds_read_b64_tr_b16 a[28:29], v46 offset:14336
ds_read_b64_tr_b16 a[30:31], v46 offset:14464
s_waitcnt lgkmcnt(0)
ds_read_b64_tr_b16 a[32:33], v46 offset:32
ds_read_b64_tr_b16 a[34:35], v46 offset:160
ds_read_b64_tr_b16 a[36:37], v46 offset:2080
ds_read_b64_tr_b16 a[38:39], v46 offset:2208
ds_read_b64_tr_b16 a[40:41], v46 offset:4128
ds_read_b64_tr_b16 a[42:43], v46 offset:4256
ds_read_b64_tr_b16 a[44:45], v46 offset:6176
ds_read_b64_tr_b16 a[46:47], v46 offset:6304
s_waitcnt lgkmcnt(0)
ds_read_b64_tr_b16 a[48:49], v46 offset:8224
ds_read_b64_tr_b16 a[50:51], v46 offset:8352
ds_read_b64_tr_b16 a[52:53], v46 offset:10272
ds_read_b64_tr_b16 a[54:55], v46 offset:10400
ds_read_b64_tr_b16 a[56:57], v46 offset:12320
ds_read_b64_tr_b16 a[58:59], v46 offset:12448
ds_read_b64_tr_b16 a[60:61], v46 offset:14368
ds_read_b64_tr_b16 a[62:63], v46 offset:14496
s_waitcnt lgkmcnt(0)
v_and_b32 v247, 15, v0
v_lshlrev_b32 v247, 4, v247
buffer_load_dword v246, v247, s[72:75], 0 offen sc1
buffer_load_dwordx4 v[64:67], v8, s[20:23], 0 offen offset:0
buffer_load_dwordx4 v[68:71], v8, s[20:23], 0 offen offset:128
buffer_load_dwordx4 v[72:75], v8, s[20:23], 0 offen offset:256
buffer_load_dwordx4 v[76:79], v8, s[20:23], 0 offen offset:384
s_waitcnt vmcnt(0)
ds_read_b64_tr_b16 a[192:193], v47 offset:16384
ds_read_b64_tr_b16 a[194:195], v47 offset:16512
ds_read_b64_tr_b16 a[196:197], v47 offset:18432
ds_read_b64_tr_b16 a[198:199], v47 offset:18560
ds_read_b64_tr_b16 a[200:201], v47 offset:20480
ds_read_b64_tr_b16 a[202:203], v47 offset:20608
ds_read_b64_tr_b16 a[204:205], v47 offset:22528
ds_read_b64_tr_b16 a[206:207], v47 offset:22656
s_waitcnt lgkmcnt(0)
ds_read_b64_tr_b16 a[208:209], v47 offset:24576
ds_read_b64_tr_b16 a[210:211], v47 offset:24704
ds_read_b64_tr_b16 a[212:213], v47 offset:26624
ds_read_b64_tr_b16 a[214:215], v47 offset:26752
ds_read_b64_tr_b16 a[216:217], v47 offset:28672
ds_read_b64_tr_b16 a[218:219], v47 offset:28800
ds_read_b64_tr_b16 a[220:221], v47 offset:30720
ds_read_b64_tr_b16 a[222:223], v47 offset:30848
s_waitcnt lgkmcnt(0)
ds_read_b64_tr_b16 a[224:225], v47 offset:16416
ds_read_b64_tr_b16 a[226:227], v47 offset:16544
ds_read_b64_tr_b16 a[228:229], v47 offset:18464
ds_read_b64_tr_b16 a[230:231], v47 offset:18592
ds_read_b64_tr_b16 a[232:233], v47 offset:20512
ds_read_b64_tr_b16 a[234:235], v47 offset:20640
ds_read_b64_tr_b16 a[236:237], v47 offset:22560
ds_read_b64_tr_b16 a[238:239], v47 offset:22688
s_waitcnt lgkmcnt(0)
ds_read_b64_tr_b16 a[240:241], v47 offset:24608
ds_read_b64_tr_b16 a[242:243], v47 offset:24736
ds_read_b64_tr_b16 a[244:245], v47 offset:26656
ds_read_b64_tr_b16 a[246:247], v47 offset:26784
ds_read_b64_tr_b16 a[248:249], v47 offset:28704
ds_read_b64_tr_b16 a[250:251], v47 offset:28832
ds_read_b64_tr_b16 a[252:253], v47 offset:30752
ds_read_b64_tr_b16 a[254:255], v47 offset:30880
s_waitcnt lgkmcnt(0)
v_mov_b32 v32, v64
v_mov_b32 v33, v65
v_mov_b32 v34, v66
v_mov_b32 v35, v67
v_mov_b32 v36, v68
v_mov_b32 v37, v69
v_mov_b32 v38, v70
v_mov_b32 v39, v71
v_mov_b32 v40, v72
v_mov_b32 v41, v73
v_mov_b32 v42, v74
v_mov_b32 v43, v75
v_mov_b32 v44, v76
v_mov_b32 v45, v77
v_mov_b32 v46, v78
v_mov_b32 v47, v79
v_mov_b32 v96, 0
v_mov_b32 v97, 0
v_mov_b32 v98, 0
v_mov_b32 v99, 0
v_mov_b32 v100, 0
v_mov_b32 v101, 0
v_mov_b32 v102, 0
v_mov_b32 v103, 0
v_mov_b32 v104, 0
v_mov_b32 v105, 0
v_mov_b32 v106, 0
v_mov_b32 v107, 0
v_mov_b32 v108, 0
v_mov_b32 v109, 0
v_mov_b32 v110, 0
v_mov_b32 v111, 0
v_mov_b32 v112, 0
v_mov_b32 v113, 0
v_mov_b32 v114, 0
v_mov_b32 v115, 0
v_mov_b32 v116, 0
v_mov_b32 v117, 0
v_mov_b32 v118, 0
v_mov_b32 v119, 0
s_nop 1
v_smfmac_f32_16x16x64_bf16 v[96:99], v[32:35], a[0:7], v6
v_smfmac_f32_16x16x64_bf16 v[100:103], v[32:35], a[32:39], v6
v_smfmac_f32_16x16x64_bf16 v[104:107], v[32:35], a[64:71], v6
v_smfmac_f32_16x16x64_bf16 v[108:111], v[32:35], a[96:103], v6
v_smfmac_f32_16x16x64_bf16 v[96:99], v[36:39], a[8:15], v6
v_smfmac_f32_16x16x64_bf16 v[100:103], v[36:39], a[40:47], v6
v_smfmac_f32_16x16x64_bf16 v[104:107], v[36:39], a[72:79], v6
v_smfmac_f32_16x16x64_bf16 v[108:111], v[36:39], a[104:111], v6
v_smfmac_f32_16x16x64_bf16 v[96:99], v[40:43], a[16:23], v6
v_smfmac_f32_16x16x64_bf16 v[100:103], v[40:43], a[48:55], v6
v_smfmac_f32_16x16x64_bf16 v[104:107], v[40:43], a[80:87], v6
v_smfmac_f32_16x16x64_bf16 v[108:111], v[40:43], a[112:119], v6
v_smfmac_f32_16x16x64_bf16 v[96:99], v[44:47], a[24:31], v6
v_smfmac_f32_16x16x64_bf16 v[100:103], v[44:47], a[56:63], v6
v_smfmac_f32_16x16x64_bf16 v[104:107], v[44:47], a[88:95], v6
v_smfmac_f32_16x16x64_bf16 v[108:111], v[44:47], a[120:127], v6
v_and_b32 v247, 15, v0
v_lshlrev_b32 v247, 4, v247
s_branch mega_kernel_syrp
mega_kernel_syrw:
s_sleep 4
mega_kernel_syr:
buffer_load_dword v246, v247, s[72:75], 0 offen sc1
s_waitcnt vmcnt(0)
mega_kernel_syrp:
s_cmp_eq_u32 s95, 1
s_cbranch_scc0 mega_kernel_syrf
v_readlane_b32 s76, v246, 14
s_mov_b32 s98, 0
s_cmp_eq_u32 s76, 32
s_cbranch_scc0 mega_kernel_syrw
s_branch mega_kernel_syrd
mega_kernel_syrf:
s_mov_b32 s77, 0
s_mov_b32 s78, 0
v_readlane_b32 s76, v246, 0
s_add_u32 s77, s77, s76
s_xor_b32 s76, s76, 32
s_or_b32 s78, s78, s76
v_readlane_b32 s76, v246, 1
s_add_u32 s77, s77, s76
s_xor_b32 s76, s76, 32
s_or_b32 s78, s78, s76
v_readlane_b32 s76, v246, 2
s_add_u32 s77, s77, s76
s_xor_b32 s76, s76, 32
s_or_b32 s78, s78, s76
v_readlane_b32 s76, v246, 3
s_add_u32 s77, s77, s76
s_xor_b32 s76, s76, 32
s_or_b32 s78, s78, s76
v_readlane_b32 s76, v246, 4
s_add_u32 s77, s77, s76
s_xor_b32 s76, s76, 32
s_or_b32 s78, s78, s76
v_readlane_b32 s76, v246, 5
s_add_u32 s77, s77, s76
s_xor_b32 s76, s76, 32
s_or_b32 s78, s78, s76
v_readlane_b32 s76, v246, 6
s_add_u32 s77, s77, s76
s_xor_b32 s76, s76, 32
s_or_b32 s78, s78, s76
v_readlane_b32 s76, v246, 7
s_add_u32 s77, s77, s76
s_xor_b32 s76, s76, 32
s_or_b32 s78, s78, s76
s_cmp_eq_u32 s77, 256
s_cbranch_scc0 mega_kernel_syrw
v_mov_b32 v252, v246
s_cmp_eq_u32 s78, 0
s_cbranch_scc0 mega_kernel_slowent
v_readlane_b32 s76, v246, 10
v_readlane_b32 s77, v246, 8
s_cmp_eq_u32 s76, 32
s_cbranch_scc0 mega_kernel_syrw
s_cmp_gt_u32 s77, 16
s_cselect_b32 s98, 1, 0
mega_kernel_syrd:
s_lshr_b32 s28, s31, 4
s_lshl_b32 s28, s28, 14
s_lshl_b32 s29, s98, 13
s_add_u32 s28, s28, s29
s_and_b32 s29, s31, 15
s_lshl_b32 s29, s29, 9
s_add_u32 s28, s28, s29
s_lshl_b32 s29, s30, 16
s_add_u32 s28, s28, s29
s_add_u32 s28, s28, 67108864
v_lshrrev_b32 v12, 1, v17
v_add_u32 v12, s28, v12
v_xor_b32 v25, 0x10000, v12
v_xor_b32 v26, 0x20000, v12
v_xor_b32 v27, 0x30000, v12
v_add_u32 v25, 0, v25
v_add_u32 v26, 0, v26
v_add_u32 v27, 0, v27
s_lshl_b32 s28, s25, 2
s_add_u32 s28, s28, s26
s_mov_b32 s82, s28
s_lshr_b32 s29, s28, 3
s_xor_b32 s29, s29, s98
s_and_b32 s29, s29, 1
s_lshl_b32 s29, s29, 13
s_lshl_b32 s76, s28, 18
s_add_u32 s76, s76, s29
s_mov_b32 s83, s76
v_add_u32 v240, s76, v17
v_add_u32 v241, 33554432, v240
s_lshr_b32 s29, s28, 4
s_xor_b32 s29, s29, s98
s_and_b32 s29, s29, 1
s_lshl_b32 s29, s29, 13
s_lshl_b32 s79, s28, 17
s_add_u32 s79, s79, s29
s_add_u32 s79, s79, 71303168
s_xor_b32 s29, s98, 1
s_lshl_b32 s29, s29, 13
s_lshl_b32 s28, s25, 7
s_add_u32 s28, s28, s29
s_add_u32 s28, s28, 69206016
v_and_b32 v4, 1, v1
v_lshlrev_b32 v24, 12, v4
v_add_u32 v24, s28, v24
s_lshl_b32 s29, s26, 2
v_add_u32 v24, s29, v24
s_xor_b32 s81, s98, 1
s_lshl_b32 s81, s81, 13
s_lshr_b32 s29, s82, 6
s_lshl_b32 s29, s29, 14
s_add_u32 s81, s81, s29
s_and_b32 s29, s82, 63
s_lshl_b32 s29, s29, 7
s_add_u32 s81, s81, s29
s_add_u32 s81, s81, 69222400
v_mov_b32 v220, 0x3f803f80
v_mov_b32 v221, 0x3f803f80
v_mov_b32 v222, 0x3f803f80
v_mov_b32 v223, 0x3f803f80
v_mov_b32 v228, 0
s_mov_b32 s27, 0
s_mov_b32 s46, 0
s_mov_b32 s89, 0
s_mov_b32 s88, 0
s_mov_b32 s44, 18432
s_mov_b32 s45, 18432
s_cmp_eq_u32 s24, 3
s_cbranch_scc0 mega_kernel_rf_pfi
s_mov_b32 s76, 0
s_cmp_gt_i32 s46, s76
s_cbranch_scc1 mega_kernel_rf_pf0ok
mega_kernel_rf_pf0w:
v_mov_b32 v4, 0
s_mov_b64 exec, 3
buffer_atomic_add v4, v24, s[84:87], 0 offen sc0 sc1
s_mov_b64 exec, -1
s_waitcnt vmcnt(0)
v_readlane_b32 s46, v4, 0
v_readlane_b32 s28, v4, 1
s_nop 1
s_min_i32 s46, s46, s28
s_cmp_gt_i32 s46, s76
s_cbranch_scc0 mega_kernel_rf_pf0w
mega_kernel_rf_pf0ok:
s_add_u32 s77, s76, s82
s_bfe_u32 s28, s77, 0x40002
s_lshl_b32 s28, s28, 14
s_and_b32 s77, s77, 3
s_lshl_b32 s77, s77, 11
s_add_u32 s28, s28, s77
s_add_u32 m0, s45, 0
s_nop 0
buffer_load_dwordx4 v240, s[84:87], s28 offen offset:0 sc1 lds
s_add_u32 m0, s45, 0
s_nop 0
buffer_load_dwordx4 v240, s[84:87], s28 offen offset:1024 sc1 lds
s_add_u32 m0, s45, 2048
s_nop 0
buffer_load_dwordx4 v241, s[84:87], s28 offen offset:0 sc1 lds
s_add_u32 m0, s45, 2048
s_nop 0
buffer_load_dwordx4 v241, s[84:87], s28 offen offset:1024 sc1 lds
s_add_u32 s45, s45, 4096
s_cmp_eq_u32 s45, 30720
s_cselect_b32 s45, 18432, s45
s_waitcnt vmcnt(0) lgkmcnt(0)
s_branch mega_kernel_rf_pfj
mega_kernel_rf_pfi:
s_lshr_b32 s88, s25, 2
s_lshl_b32 s88, s88, 17
s_and_b32 s77, s25, 2
s_lshl_b32 s77, s77, 13
s_add_u32 s88, s88, s77
s_and_b32 s77, s25, 1
s_lshl_b32 s77, s77, 12
s_add_u32 s88, s88, s77
s_xor_b32 s77, s98, 0
s_lshl_b32 s77, s77, 13
s_add_u32 s88, s88, s77
s_add_u32 s88, s88, 68255744
s_lshl_b32 s77, s26, 10
s_add_u32 s88, s88, s77
mega_kernel_rf_pfj:
v_mov_b32 v184, 0
v_mov_b32 v185, 0
v_mov_b32 v186, 0
v_mov_b32 v187, 0
v_mov_b32 v188, 0
v_mov_b32 v189, 0
v_mov_b32 v190, 0
v_mov_b32 v191, 0
v_mov_b32 v192, 0
v_mov_b32 v193, 0
v_mov_b32 v194, 0
v_mov_b32 v195, 0
v_mov_b32 v196, 0
v_mov_b32 v197, 0
v_mov_b32 v198, 0
v_mov_b32 v199, 0
v_mov_b32 v200, 0
v_mov_b32 v201, 0
v_mov_b32 v202, 0
v_mov_b32 v203, 0
v_mov_b32 v204, 0
v_mov_b32 v205, 0
v_mov_b32 v206, 0
v_mov_b32 v207, 0
v_mov_b32 v249, 0
v_mov_b32 v60, 0
v_mov_b32 v61, 0
v_mov_b32 v62, 0
v_mov_b32 v63, 0
s_waitcnt lgkmcnt(0)
s_barrier
s_and_b32 s29, s27, 1
s_lshl_b32 s33, s29, 17
s_lshl_b32 s28, s30, 18
s_add_u32 s33, s33, s28
s_add_u32 s33, s33, 68157440
s_xor_b32 s34, s33, 131072
s_lshl_b32 s35, s29, 18
s_bfe_u32 s47, s27, 0x10001
s_branch mega_kernel_rf_first
.p2align 6
s_nop 0
s_nop 0
mega_kernel_rf_loop:
buffer_load_dwordx4 v[32:35], v7, s[84:87], s33 offen offset:0 sc1
v_add_u32 v5, s44, v17
ds_read_b128 v[156:159], v5 offset:0
ds_read_b128 v[160:163], v5 offset:1024
ds_read_b128 v[164:167], v5 offset:2048
ds_read_b128 v[168:171], v5 offset:3072
s_nop 4
buffer_load_dwordx4 v[36:39], v7, s[84:87], s33 offen offset:1024 sc1
s_nop 9
buffer_load_dwordx4 v[40:43], v7, s[84:87], s33 offen offset:2048 sc1
s_nop 9
buffer_load_dwordx4 v[44:47], v7, s[84:87], s33 offen offset:3072 sc1
s_waitcnt vmcnt(3)
v_max_u32 v4, v32, v34
v_cmp_eq_u32 vcc, -1, v4
s_cbranch_vccnz mega_kernel_rf_pa_15_0f
v_smfmac_f32_16x16x64_bf16 v[96:99], v[32:35], a[0:7], v6
v_smfmac_f32_16x16x64_bf16 v[100:103], v[32:35], a[32:39], v6
v_smfmac_f32_16x16x64_bf16 v[104:107], v[32:35], a[64:71], v6
s_waitcnt vmcnt(2)
v_max_u32 v4, v36, v38
v_cmp_eq_u32 vcc, -1, v4
v_smfmac_f32_16x16x64_bf16 v[108:111], v[32:35], a[96:103], v6
s_cbranch_vccnz mega_kernel_rf_pa_14_1f
v_smfmac_f32_16x16x64_bf16 v[96:99], v[36:39], a[8:15], v6
v_smfmac_f32_16x16x64_bf16 v[100:103], v[36:39], a[40:47], v6
v_smfmac_f32_16x16x64_bf16 v[104:107], v[36:39], a[72:79], v6
s_waitcnt vmcnt(1)
v_max_u32 v4, v40, v42
v_cmp_eq_u32 vcc, -1, v4
v_smfmac_f32_16x16x64_bf16 v[108:111], v[36:39], a[104:111], v6
s_cbranch_vccnz mega_kernel_rf_pa_12_2f
v_smfmac_f32_16x16x64_bf16 v[96:99], v[40:43], a[16:23], v6
v_smfmac_f32_16x16x64_bf16 v[100:103], v[40:43], a[48:55], v6
v_smfmac_f32_16x16x64_bf16 v[104:107], v[40:43], a[80:87], v6
s_waitcnt vmcnt(0)
v_max_u32 v4, v44, v46
v_cmp_eq_u32 vcc, -1, v4
v_smfmac_f32_16x16x64_bf16 v[108:111], v[40:43], a[112:119], v6
s_cbranch_vccnz mega_kernel_rf_pa_8_3f
v_smfmac_f32_16x16x64_bf16 v[96:99], v[44:47], a[24:31], v6
v_smfmac_f32_16x16x64_bf16 v[100:103], v[44:47], a[56:63], v6
v_smfmac_f32_16x16x64_bf16 v[104:107], v[44:47], a[88:95], v6
v_smfmac_f32_16x16x64_bf16 v[108:111], v[44:47], a[120:127], v6
mega_kernel_rf_pa_d:
mega_kernel_rf_adone:
s_nop 5
v_permlane32_swap_b32 v96, v100
v_permlane32_swap_b32 v97, v101
v_permlane32_swap_b32 v98, v102
v_permlane32_swap_b32 v99, v103
v_pk_add_f32 v[96:97], v[96:97], v[100:101]
v_pk_add_f32 v[98:99], v[98:99], v[102:103]
ds_write2_b32 v14, v96, v97 offset0:0 offset1:36
ds_write2_b32 v14, v98, v99 offset0:72 offset1:108
v_permlane32_swap_b32 v104, v108
v_permlane32_swap_b32 v105, v109
v_permlane32_swap_b32 v106, v110
v_permlane32_swap_b32 v107, v111
v_pk_add_f32 v[104:105], v[104:105], v[108:109]
v_pk_add_f32 v[106:107], v[106:107], v[110:111]
ds_write2_b32 v15, v104, v105 offset0:0 offset1:36
ds_write2_b32 v15, v106, v107 offset0:72 offset1:108
v_smfmac_f32_16x16x64_bf16 v[112:115], v[32:35], a[128:135], v6
v_smfmac_f32_16x16x64_bf16 v[116:119], v[32:35], a[160:167], v6
v_smfmac_f32_16x16x64_bf16 v[112:115], v[36:39], a[136:143], v6
v_smfmac_f32_16x16x64_bf16 v[116:119], v[36:39], a[168:175], v6
s_waitcnt lgkmcnt(0)
s_barrier
s_cmp_lg_u32 s24, 0
s_cbranch_scc1 mega_kernel_rf_side
ds_read_b128 v[120:123], v16 offset:0
ds_read_b128 v[124:127], v16 offset:16
ds_read_b128 v[128:131], v16 offset:2304
ds_read_b128 v[132:135], v16 offset:2320
ds_read_b128 v[136:139], v16 offset:4608
ds_read_b128 v[140:143], v16 offset:4624
ds_read_b128 v[144:147], v16 offset:6912
ds_read_b128 v[148:151], v16 offset:6928
v_smfmac_f32_16x16x64_bf16 v[112:115], v[40:43], a[144:151], v6
v_smfmac_f32_16x16x64_bf16 v[116:119], v[40:43], a[176:183], v6
v_smfmac_f32_16x16x64_bf16 v[112:115], v[44:47], a[152:159], v6
v_smfmac_f32_16x16x64_bf16 v[116:119], v[44:47], a[184:191], v6
s_mul_i32 s28, s31, 1280
s_add_u32 s28, s28, s33
s_add_u32 s28, s28, 49152
s_add_u32 s76, s37, s33
s_add_u32 s77, s38, s33
s_add_u32 s78, s39, s33
s_waitcnt lgkmcnt(4)
v_pk_add_f32 v[120:121], v[120:121], v[128:129]
v_pk_add_f32 v[122:123], v[122:123], v[130:131]
v_pk_add_f32 v[124:125], v[124:125], v[132:133]
v_pk_add_f32 v[126:127], v[126:127], v[134:135]
s_waitcnt lgkmcnt(0)
v_pk_add_f32 v[136:137], v[136:137], v[144:145]
v_pk_add_f32 v[138:139], v[138:139], v[146:147]
v_pk_add_f32 v[140:141], v[140:141], v[148:149]
v_pk_add_f32 v[142:143], v[142:143], v[150:151]
v_pk_add_f32 v[120:121], v[120:121], v[136:137]
v_pk_add_f32 v[122:123], v[122:123], v[138:139]
v_pk_add_f32 v[124:125], v[124:125], v[140:141]
v_pk_add_f32 v[126:127], v[126:127], v[142:143]
v_cvt_pk_bf16_f32 v152, v120, v121
v_cvt_pk_bf16_f32 v153, v122, v123
v_cvt_pk_bf16_f32 v154, v124, v125
v_cvt_pk_bf16_f32 v155, v126, v127
s_nop 1
v_mfma_f32_16x16x32_bf16 v[176:179], v[160:163], v[152:155], 0
v_mfma_f32_16x16x32_bf16 v[172:175], v[156:159], v[152:155], 0
v_mfma_f32_16x16x32_bf16 v[180:183], v[152:155], v[152:155], 0
s_cmp_eq_u32 s27, 63
s_cbranch_scc1 mega_kernel_rf_w0last
s_nop 4
v_mov_b32_dpp v172, v176 row_shr:8 row_mask:0xf bank_mask:0xc
v_mov_b32_dpp v173, v177 row_shr:8 row_mask:0xf bank_mask:0xc
v_mov_b32_dpp v174, v178 row_shr:8 row_mask:0xf bank_mask:0xc
v_mov_b32_dpp v175, v179 row_shr:8 row_mask:0xf bank_mask:0xc
v_min_u32 v180, -2, v180
v_min_u32 v172, -2, v172
s_mov_b64 exec, s[42:43]
buffer_store_dwordx4 v[180:183], v10, s[84:87], s28 offen
s_mov_b64 exec, -1
buffer_store_dwordx4 v[172:175], v17, s[84:87], s28 offen
v_permlane32_swap_b32 v112, v116
v_permlane32_swap_b32 v113, v117
v_permlane32_swap_b32 v114, v118
v_permlane32_swap_b32 v115, v119
v_pk_add_f32 v[112:113], v[112:113], v[116:117]
v_pk_add_f32 v[114:115], v[114:115], v[118:119]
ds_write_b128 v20, v[112:115]
s_waitcnt lgkmcnt(0)
s_barrier
v_mov_b32 v96, 0
v_mov_b32 v97, 0
v_mov_b32 v98, 0
v_mov_b32 v99, 0
v_mov_b32 v100, 0
v_mov_b32 v101, 0
v_mov_b32 v102, 0
v_mov_b32 v103, 0
v_cndmask_b32 v176, v23, v180, s[42:43]
v_cndmask_b32 v177, v23, v181, s[42:43]
v_cndmask_b32 v178, v23, v182, s[42:43]
v_cndmask_b32 v179, v23, v183, s[42:43]
s_mov_b64 exec, s[42:43]
buffer_load_dwordx4 v[188:191], v10, s[84:87], s76 offen sc1
buffer_load_dwordx4 v[196:199], v10, s[84:87], s77 offen sc1
buffer_load_dwordx4 v[204:207], v10, s[84:87], s78 offen sc1
s_mov_b64 exec, -1
buffer_load_dwordx4 v[184:187], v17, s[84:87], s76 offen sc1
buffer_load_dwordx4 v[192:195], v17, s[84:87], s77 offen sc1
buffer_load_dwordx4 v[200:203], v17, s[84:87], s78 offen sc1
v_pk_mul_f32 v[172:173], v[172:173], s[32:33] op_sel_hi:[1,0]
v_pk_mul_f32 v[174:175], v[174:175], s[32:33] op_sel_hi:[1,0]
v_pk_mul_f32 v[176:177], v[176:177], s[32:33] op_sel_hi:[1,0]
v_pk_mul_f32 v[178:179], v[178:179], s[32:33] op_sel_hi:[1,0]
s_lshl_b32 s89, s47, 31
s_or_b32 s89, s89, 0x3b39999a
s_nop 15
s_nop 1
s_mov_b64 exec, s[42:43]
buffer_load_dwordx4 v[188:191], v10, s[84:87], s76 offen sc1
buffer_load_dwordx4 v[196:199], v10, s[84:87], s77 offen sc1
buffer_load_dwordx4 v[204:207], v10, s[84:87], s78 offen sc1
s_mov_b64 exec, -1
buffer_load_dwordx4 v[184:187], v17, s[84:87], s76 offen sc1
buffer_load_dwordx4 v[192:195], v17, s[84:87], s77 offen sc1
buffer_load_dwordx4 v[200:203], v17, s[84:87], s78 offen sc1
mega_kernel_rf_p2:
s_waitcnt vmcnt(6)
v_max3_u32 v4, v184, v188, v192
v_max3_u32 v5, v196, v200, v204
v_max_u32 v4, v4, v5
v_cmp_eq_u32 vcc, -1, v4
s_cbranch_vccnz mega_kernel_rf_p2r
v_pk_add_f32 v[124:125], v[196:197], v[204:205]
v_pk_add_f32 v[126:127], v[198:199], v[206:207]
v_pk_add_f32 v[120:121], v[192:193], v[200:201]
v_pk_add_f32 v[122:123], v[194:195], v[202:203]
v_pk_add_f32 v[124:125], v[124:125], v[188:189]
v_pk_add_f32 v[126:127], v[126:127], v[190:191]
v_pk_add_f32 v[120:121], v[120:121], v[184:185]
v_pk_add_f32 v[122:123], v[122:123], v[186:187]
v_pk_fma_f32 v[176:177], v[124:125], s[32:33], v[176:177] op_sel_hi:[1,0,1]
v_pk_fma_f32 v[178:179], v[126:127], s[32:33], v[178:179] op_sel_hi:[1,0,1]
v_pk_fma_f32 v[172:173], v[120:121], s[32:33], v[172:173] op_sel_hi:[1,0,1]
v_pk_fma_f32 v[174:175], v[122:123], s[32:33], v[174:175] op_sel_hi:[1,0,1]
v_max3_f32 v232, v172, v173, v174
v_max3_f32 v233, v176, v177, v178
v_max3_f32 v232, v232, v175, v179
v_max_f32 v234, v232, v233
s_barrier
ds_read2_b64 v[208:211], v21 offset0:0 offset1:32
v_max_f32_dpp v232, v234, v234 row_ror:8 row_mask:0xf bank_mask:0xf
v_max_f32_dpp v233, v234, v234 row_ror:8 row_mask:0xf bank_mask:0xf
s_nop 1
v_permlane16_swap_b32 v232, v233
s_nop 0
v_max_f32 v234, v232, v233
v_max_f32 v235, v232, v233
s_nop 1
v_permlane32_swap_b32 v234, v235
s_nop 0
v_max_f32 v232, v234, v235
v_pk_add_f32 v[176:177], v[176:177], v[232:233] op_sel_hi:[1,0] neg_lo:[0,1] neg_hi:[0,1]
v_pk_add_f32 v[178:179], v[178:179], v[232:233] op_sel_hi:[1,0] neg_lo:[0,1] neg_hi:[0,1]
v_pk_add_f32 v[172:173], v[172:173], v[232:233] op_sel_hi:[1,0] neg_lo:[0,1] neg_hi:[0,1]
v_pk_add_f32 v[174:175], v[174:175], v[232:233] op_sel_hi:[1,0] neg_lo:[0,1] neg_hi:[0,1]
v_exp_f32 v176, v176
v_exp_f32 v177, v177
v_exp_f32 v178, v178
v_exp_f32 v179, v179
v_exp_f32 v172, v172
v_cvt_pk_bf16_f32 v216, v176, v177
v_cvt_pk_bf16_f32 v217, v178, v179
v_exp_f32 v173, v173
v_exp_f32 v174, v174
v_mfma_f32_16x16x16_bf16 v[224:227], v[220:221], v[216:217], 0
v_exp_f32 v175, v175
v_cvt_pk_bf16_f32 v212, v172, v173
s_waitcnt lgkmcnt(0)
v_mfma_f32_16x16x16_bf16 v[120:123], v[208:209], v[216:217], 0
v_cvt_pk_bf16_f32 v213, v174, v175
v_mfma_f32_16x16x16_bf16 v[124:127], v[210:211], v[216:217], 0
v_mov_b32_dpp v214, v212 row_ror:8 row_mask:0xf bank_mask:0xf
v_mov_b32_dpp v215, v213 row_ror:8 row_mask:0xf bank_mask:0xf
s_nop 1
v_mfma_f32_16x16x32_bf16 v[224:227], v[220:223], v[212:215], v[224:227]
v_mfma_f32_16x16x32_bf16 v[120:123], v[164:167], v[212:215], v[120:123]
v_mfma_f32_16x16x32_bf16 v[124:127], v[168:171], v[212:215], v[124:127]
s_add_u32 s29, s33, 24576
s_nop 4
v_rcp_f32 v234, v224
s_nop 0
v_pk_mul_f32 v[120:121], v[120:121], v[234:235] op_sel_hi:[1,0]
v_pk_mul_f32 v[122:123], v[122:123], v[234:235] op_sel_hi:[1,0]
v_pk_mul_f32 v[124:125], v[124:125], v[234:235] op_sel_hi:[1,0]
v_pk_mul_f32 v[126:127], v[126:127], v[234:235] op_sel_hi:[1,0]
v_cvt_pk_bf16_f32 v212, v120, v121
v_cvt_pk_bf16_f32 v213, v122, v123
v_cvt_pk_bf16_f32 v214, v124, v125
v_cvt_pk_bf16_f32 v215, v126, v127
v_min_u32 v212, -2, v212
s_mov_b64 exec, s[40:41]
buffer_store_dwordx4 v[212:215], v11, s[84:87], s33 offen
s_mov_b64 exec, -1
mega_kernel_rf_b3:
s_barrier
s_nop 15
buffer_load_dwordx4 v[32:35], v7, s[84:87], s29 offen offset:0 sc1
s_nop 9
buffer_load_dwordx4 v[36:39], v7, s[84:87], s29 offen offset:1024 sc1
s_nop 9
buffer_load_dwordx4 v[40:43], v7, s[84:87], s29 offen offset:2048 sc1
s_nop 9
buffer_load_dwordx4 v[44:47], v7, s[84:87], s29 offen offset:3072 sc1
mega_kernel_rf_pc_15_0:
s_waitcnt vmcnt(3)
v_cmp_eq_u32 vcc, -1, v32
s_cbranch_vccnz mega_kernel_rf_pc_15_0f
v_smfmac_f32_16x16x64_bf16 v[96:99], v[32:35], a[192:199], v6
v_smfmac_f32_16x16x64_bf16 v[100:103], v[32:35], a[224:231], v6
mega_kernel_rf_pc_14_1:
s_waitcnt vmcnt(2)
v_cmp_eq_u32 vcc, -1, v36
s_cbranch_vccnz mega_kernel_rf_pc_14_1f
v_smfmac_f32_16x16x64_bf16 v[96:99], v[36:39], a[200:207], v6
v_smfmac_f32_16x16x64_bf16 v[100:103], v[36:39], a[232:239], v6
mega_kernel_rf_pc_12_2:
s_waitcnt vmcnt(1)
v_cmp_eq_u32 vcc, -1, v40
s_cbranch_vccnz mega_kernel_rf_pc_12_2f
v_smfmac_f32_16x16x64_bf16 v[96:99], v[40:43], a[208:215], v6
v_smfmac_f32_16x16x64_bf16 v[100:103], v[40:43], a[240:247], v6
mega_kernel_rf_pc_8_3:
s_waitcnt vmcnt(0)
v_cmp_eq_u32 vcc, -1, v44
s_cbranch_vccnz mega_kernel_rf_pc_8_3f
v_smfmac_f32_16x16x64_bf16 v[96:99], v[44:47], a[216:223], v6
v_smfmac_f32_16x16x64_bf16 v[100:103], v[44:47], a[248:255], v6
mega_kernel_rf_pc_d:
s_nop 7
v_permlane32_swap_b32 v96, v100
v_permlane32_swap_b32 v97, v101
v_permlane32_swap_b32 v98, v102
v_permlane32_swap_b32 v99, v103
v_pk_add_f32 v[96:97], v[96:97], v[100:101]
v_pk_add_f32 v[98:99], v[98:99], v[102:103]
ds_write2_b32 v18, v96, v97 offset0:0 offset1:36
ds_write2_b32 v18, v98, v99 offset0:72 offset1:108
s_waitcnt lgkmcnt(0)
s_barrier
s_cmp_lg_u32 s24, 0
s_cbranch_scc1 mega_kernel_rf_x1
ds_read_b128 v[120:123], v19 offset:0
ds_read_b128 v[124:127], v19 offset:1152
ds_read_b128 v[128:131], v19 offset:2304
ds_read_b128 v[132:135], v19 offset:3456
s_waitcnt lgkmcnt(2)
v_pk_add_f32 v[120:121], v[120:121], v[124:125]
v_pk_add_f32 v[122:123], v[122:123], v[126:127]
s_waitcnt lgkmcnt(0)
v_pk_add_f32 v[128:129], v[128:129], v[132:133]
v_pk_add_f32 v[130:131], v[130:131], v[134:135]
v_pk_add_f32 v[120:121], v[120:121], v[128:129]
v_pk_add_f32 v[122:123], v[122:123], v[130:131]
v_fma_f32 v212, v120, s89, v120
v_cvt_pk_bf16_f32 v213, v122, v123
v_cvt_pk_bf16_f32 v212, v212, v121
v_and_or_b32 v212, v212, -2, s47
buffer_store_dwordx2 v[212:213], v12, s[84:87], s35 offen sc1
s_mov_b32 s77, 0x3f80
s_mov_b32 s78, 0x3f800000
s_xor_b32 s76, s47, 1
v_mov_b32 v48, s76
v_mov_b32 v50, s76
v_mov_b32 v52, s76
s_nop 8
v_mov_b32 v96, 0
v_mov_b32 v97, 0
v_mov_b32 v98, 0
v_mov_b32 v99, 0
v_mov_b32 v100, 0
v_mov_b32 v101, 0
v_mov_b32 v102, 0
v_mov_b32 v103, 0
v_mov_b32 v104, 0
v_mov_b32 v105, 0
v_mov_b32 v106, 0
v_mov_b32 v107, 0
v_mov_b32 v108, 0
v_mov_b32 v109, 0
v_mov_b32 v110, 0
v_mov_b32 v111, 0
v_mov_b32 v112, 0
v_mov_b32 v113, 0
v_mov_b32 v114, 0
v_mov_b32 v115, 0
v_mov_b32 v116, 0
v_mov_b32 v117, 0
v_mov_b32 v118, 0
v_mov_b32 v119, 0
s_nop 15
s_nop 7
s_cmp_eq_u32 s47, 1
s_cbranch_scc1 mega_kernel_rf_p4_1
.p2align 6
mega_kernel_rf_p4_0:
buffer_load_dwordx2 v[48:49], v25, s[84:87], s35 offen sc1
buffer_load_dwordx2 v[50:51], v26, s[84:87], s35 offen sc1
buffer_load_dwordx2 v[52:53], v27, s[84:87], s35 offen sc1
s_waitcnt vmcnt(12)
mega_kernel_rf_p4c_0:
v_bitop3_b32 v4, v48, v50, v52 bitop3:0xfe
v_and_b32 v4, 1, v4
v_cmp_ne_u32 vcc, 0, v4
s_cbranch_vccnz mega_kernel_rf_p4_0
v_dot2_f32_bf16 v120, v48, s77, v120
v_dot2_f32_bf16 v121, v48, s78, v121
v_dot2_f32_bf16 v122, v49, s77, v122
v_dot2_f32_bf16 v123, v49, s78, v123
v_dot2_f32_bf16 v120, v50, s77, v120
v_dot2_f32_bf16 v121, v50, s78, v121
v_dot2_f32_bf16 v122, v51, s77, v122
v_dot2_f32_bf16 v123, v51, s78, v123
v_dot2_f32_bf16 v120, v52, s77, v120
v_dot2_f32_bf16 v121, v52, s78, v121
v_dot2_f32_bf16 v122, v53, s77, v122
v_dot2_f32_bf16 v123, v53, s78, v123
s_nop 0
v_cvt_pk_bf16_f32 v212, v120, v121
v_min_u32 v212, -2, v212
v_cvt_pk_bf16_f32 v213, v122, v123
buffer_store_dwordx2 v[212:213], v9, s[84:87], s34 offen
s_branch mega_kernel_rf_p4d
mega_kernel_rf_iw0:
mega_kernel_rf_il0:
s_cbranch_execz mega_kernel_rf_il1
.p2align 6
mega_kernel_rf_p4_1:
buffer_load_dwordx2 v[48:49], v25, s[84:87], s35 offen sc1
buffer_load_dwordx2 v[50:51], v26, s[84:87], s35 offen sc1
buffer_load_dwordx2 v[52:53], v27, s[84:87], s35 offen sc1
s_waitcnt vmcnt(12)
mega_kernel_rf_p4c_1:
v_bitop3_b32 v4, v48, v50, v52 bitop3:0x80
v_and_b32 v4, 1, v4
v_cmp_ne_u32 vcc, 1, v4
s_cbranch_vccnz mega_kernel_rf_p4_1
v_dot2_f32_bf16 v120, v48, s77, v120
v_dot2_f32_bf16 v121, v48, s78, v121
v_dot2_f32_bf16 v122, v49, s77, v122
v_dot2_f32_bf16 v123, v49, s78, v123
v_dot2_f32_bf16 v120, v50, s77, v120
v_dot2_f32_bf16 v121, v50, s78, v121
v_dot2_f32_bf16 v122, v51, s77, v122
v_dot2_f32_bf16 v123, v51, s78, v123
v_dot2_f32_bf16 v120, v52, s77, v120
v_dot2_f32_bf16 v121, v52, s78, v121
v_dot2_f32_bf16 v122, v53, s77, v122
v_dot2_f32_bf16 v123, v53, s78, v123
s_nop 0
v_cvt_pk_bf16_f32 v212, v120, v121
v_min_u32 v212, -2, v212
v_cvt_pk_bf16_f32 v213, v122, v123
buffer_store_dwordx2 v[212:213], v9, s[84:87], s34 offen
mega_kernel_rf_p4d:
mega_kernel_rf_b5:
s_add_u32 s27, s27, 1
s_add_u32 s44, s44, 4096
s_cmp_eq_u32 s44, 30720
s_cselect_b32 s44, 18432, s44
s_mov_b32 s28, s33
s_mov_b32 s33, s34
s_mov_b32 s34, s28
s_xor_b32 s35, s35, 262144
s_bfe_u32 s47, s27, 0x10001
s_barrier
s_nop 15
s_branch mega_kernel_rf_loop
mega_kernel_rf_il1:
s_cbranch_execz mega_kernel_rf_il2
mega_kernel_rf_x1:
s_cmp_eq_u32 s24, 1
s_cbranch_scc0 mega_kernel_rf_x2
s_add_u32 s76, s27, 1
s_sleep 6
v_mov_b32 v5, s76
s_mov_b64 exec, 1
buffer_store_dword v5, v228, s[84:87], s81 offen sc1
s_mov_b64 exec, -1
mega_kernel_rf_x2:
s_cmp_eq_u32 s24, 3
s_cbranch_scc0 mega_kernel_rf_x4
s_cmp_eq_u32 s36, 1
s_cbranch_scc0 mega_kernel_rf_x5
s_add_u32 s76, s27, 1
s_cmp_gt_i32 s46, s76
s_cbranch_scc1 mega_kernel_rf_pf1ok
mega_kernel_rf_pf1w:
v_mov_b32 v4, 0
s_mov_b64 exec, 3
buffer_atomic_add v4, v24, s[84:87], 0 offen sc0 sc1
s_mov_b64 exec, -1
s_waitcnt vmcnt(0)
v_readlane_b32 s46, v4, 0
v_readlane_b32 s28, v4, 1
s_nop 1
s_min_i32 s46, s46, s28
s_cmp_gt_i32 s46, s76
s_cbranch_scc0 mega_kernel_rf_pf1w
mega_kernel_rf_pf1ok:
s_add_u32 s77, s76, s82
s_bfe_u32 s28, s77, 0x40002
s_lshl_b32 s28, s28, 14
s_and_b32 s77, s77, 3
s_lshl_b32 s77, s77, 11
s_add_u32 s28, s28, s77
s_add_u32 m0, s45, 0
s_nop 0
buffer_load_dwordx4 v240, s[84:87], s28 offen offset:0 sc1 lds
s_add_u32 m0, s45, 0
s_nop 0
buffer_load_dwordx4 v240, s[84:87], s28 offen offset:1024 sc1 lds
s_add_u32 m0, s45, 2048
s_nop 0
buffer_load_dwordx4 v241, s[84:87], s28 offen offset:0 sc1 lds
s_add_u32 m0, s45, 2048
s_nop 0
buffer_load_dwordx4 v241, s[84:87], s28 offen offset:1024 sc1 lds
s_add_u32 s45, s45, 4096
s_cmp_eq_u32 s45, 30720
s_cselect_b32 s45, 18432, s45
s_waitcnt vmcnt(0)
mega_kernel_rf_x5:
s_add_u32 s76, s27, 4
s_min_u32 s76, s76, 63
s_cmp_gt_i32 s46, s76
s_cbranch_scc1 mega_kernel_rf_x6
v_mov_b32 v249, 0
s_mov_b64 exec, 3
buffer_atomic_add v249, v24, s[84:87], 0 offen sc0 sc1
s_mov_b64 exec, -1
mega_kernel_rf_x6:
s_add_u32 s76, s27, 2
s_cmp_lt_u32 s76, 63
s_cbranch_scc0 mega_kernel_rf_x4
s_cmp_gt_i32 s46, s76
s_cbranch_scc0 mega_kernel_rf_x4
s_add_u32 s77, s76, s82
s_bfe_u32 s28, s77, 0x40002
s_lshl_b32 s28, s28, 14
s_and_b32 s77, s77, 3
s_lshl_b32 s77, s77, 11
s_add_u32 s28, s28, s77
s_add_u32 s28, s28, s83
s_add_u32 s28, s28, 33554432
s_buffer_load_dword s78, s[84:87], s28 offset:0
s_buffer_load_dword s78, s[84:87], s28 offset:128
s_buffer_load_dword s78, s[84:87], s28 offset:256
s_buffer_load_dword s78, s[84:87], s28 offset:384
s_buffer_load_dword s78, s[84:87], s28 offset:512
s_buffer_load_dword s78, s[84:87], s28 offset:640
s_buffer_load_dword s78, s[84:87], s28 offset:768
s_buffer_load_dword s78, s[84:87], s28 offset:896
s_buffer_load_dword s78, s[84:87], s28 offset:1024
s_buffer_load_dword s78, s[84:87], s28 offset:1152
s_buffer_load_dword s78, s[84:87], s28 offset:1280
s_buffer_load_dword s78, s[84:87], s28 offset:1408
s_buffer_load_dword s78, s[84:87], s28 offset:1536
s_buffer_load_dword s78, s[84:87], s28 offset:1664
s_buffer_load_dword s78, s[84:87], s28 offset:1792
s_buffer_load_dword s78, s[84:87], s28 offset:1920
mega_kernel_rf_x4:
v_mov_b32 v96, 0
v_mov_b32 v97, 0
v_mov_b32 v98, 0
v_mov_b32 v99, 0
v_mov_b32 v100, 0
v_mov_b32 v101, 0
v_mov_b32 v102, 0
v_mov_b32 v103, 0
v_mov_b32 v104, 0
v_mov_b32 v105, 0
v_mov_b32 v106, 0
v_mov_b32 v107, 0
v_mov_b32 v108, 0
v_mov_b32 v109, 0
v_mov_b32 v110, 0
v_mov_b32 v111, 0
v_mov_b32 v112, 0
v_mov_b32 v113, 0
v_mov_b32 v114, 0
v_mov_b32 v115, 0
v_mov_b32 v116, 0
v_mov_b32 v117, 0
v_mov_b32 v118, 0
v_mov_b32 v119, 0
s_branch mega_kernel_rf_b5
mega_kernel_rf_il2:
s_cbranch_execz mega_kernel_rf_il3
mega_kernel_rf_p2r:
s_mov_b64 exec, s[42:43]
buffer_load_dwordx4 v[188:191], v10, s[84:87], s76 offen sc1
buffer_load_dwordx4 v[196:199], v10, s[84:87], s77 offen sc1
buffer_load_dwordx4 v[204:207], v10, s[84:87], s78 offen sc1
s_mov_b64 exec, -1
buffer_load_dwordx4 v[184:187], v17, s[84:87], s76 offen sc1
buffer_load_dwordx4 v[192:195], v17, s[84:87], s77 offen sc1
buffer_load_dwordx4 v[200:203], v17, s[84:87], s78 offen sc1
s_branch mega_kernel_rf_p2
mega_kernel_rf_il3:
s_cbranch_execz mega_kernel_rf_il4
.p2align 5
mega_kernel_rf_pa_1_0f:
s_mov_b64 exec, vcc
buffer_load_dwordx4 v[32:35], v7, s[84:87], s33 offen offset:0 sc1
s_mov_b64 exec, -1
s_branch mega_kernel_rf_pa_1_0
.p2align 5
mega_kernel_rf_pa_1_0:
s_waitcnt vmcnt(0)
v_max_u32 v4, v32, v34
v_cmp_eq_u32 vcc, -1, v4
s_cbranch_vccnz mega_kernel_rf_pa_1_0f
v_smfmac_f32_16x16x64_bf16 v[96:99], v[32:35], a[0:7], v6
v_smfmac_f32_16x16x64_bf16 v[100:103], v[32:35], a[32:39], v6
v_smfmac_f32_16x16x64_bf16 v[104:107], v[32:35], a[64:71], v6
v_smfmac_f32_16x16x64_bf16 v[108:111], v[32:35], a[96:103], v6
s_branch mega_kernel_rf_pa_d
mega_kernel_rf_il4:
s_cbranch_execz mega_kernel_rf_il5
.p2align 5
mega_kernel_rf_pa_2_1f:
s_mov_b64 exec, vcc
buffer_load_dwordx4 v[36:39], v7, s[84:87], s33 offen offset:1024 sc1
s_mov_b64 exec, -1
s_branch mega_kernel_rf_pa_2_1
.p2align 5
mega_kernel_rf_pa_2_1:
s_waitcnt vmcnt(0)
v_max_u32 v4, v36, v38
v_cmp_eq_u32 vcc, -1, v4
s_cbranch_vccnz mega_kernel_rf_pa_2_1f
v_smfmac_f32_16x16x64_bf16 v[96:99], v[36:39], a[8:15], v6
v_smfmac_f32_16x16x64_bf16 v[100:103], v[36:39], a[40:47], v6
v_smfmac_f32_16x16x64_bf16 v[104:107], v[36:39], a[72:79], v6
v_smfmac_f32_16x16x64_bf16 v[108:111], v[36:39], a[104:111], v6
s_branch mega_kernel_rf_pa_d
mega_kernel_rf_il5:
s_cbranch_execz mega_kernel_rf_il6
.p2align 5
mega_kernel_rf_pa_3_0f:
s_mov_b64 exec, vcc
buffer_load_dwordx4 v[32:35], v7, s[84:87], s33 offen offset:0 sc1
s_mov_b64 exec, -1
s_branch mega_kernel_rf_pa_3_1
.p2align 5
mega_kernel_rf_pa_3_0:
s_waitcnt vmcnt(1)
v_max_u32 v4, v32, v34
v_cmp_eq_u32 vcc, -1, v4
s_cbranch_vccnz mega_kernel_rf_pa_3_0f
v_smfmac_f32_16x16x64_bf16 v[96:99], v[32:35], a[0:7], v6
v_smfmac_f32_16x16x64_bf16 v[100:103], v[32:35], a[32:39], v6
v_smfmac_f32_16x16x64_bf16 v[104:107], v[32:35], a[64:71], v6
v_smfmac_f32_16x16x64_bf16 v[108:111], v[32:35], a[96:103], v6
s_branch mega_kernel_rf_pa_2_1
mega_kernel_rf_il6:
s_cbranch_execz mega_kernel_rf_il7
.p2align 5
mega_kernel_rf_pa_3_1f:
s_mov_b64 exec, vcc
buffer_load_dwordx4 v[36:39], v7, s[84:87], s33 offen offset:1024 sc1
s_mov_b64 exec, -1
s_branch mega_kernel_rf_pa_3_0
.p2align 5
mega_kernel_rf_pa_3_1:
s_waitcnt vmcnt(1)
v_max_u32 v4, v36, v38
v_cmp_eq_u32 vcc, -1, v4
s_cbranch_vccnz mega_kernel_rf_pa_3_1f
v_smfmac_f32_16x16x64_bf16 v[96:99], v[36:39], a[8:15], v6
v_smfmac_f32_16x16x64_bf16 v[100:103], v[36:39], a[40:47], v6
v_smfmac_f32_16x16x64_bf16 v[104:107], v[36:39], a[72:79], v6
v_smfmac_f32_16x16x64_bf16 v[108:111], v[36:39], a[104:111], v6
s_branch mega_kernel_rf_pa_1_0
mega_kernel_rf_il7:
s_cbranch_execz mega_kernel_rf_il8
.p2align 5
mega_kernel_rf_pa_4_2f:
s_mov_b64 exec, vcc
buffer_load_dwordx4 v[40:43], v7, s[84:87], s33 offen offset:2048 sc1
s_mov_b64 exec, -1
s_branch mega_kernel_rf_pa_4_2
.p2align 5
mega_kernel_rf_pa_4_2:
s_waitcnt vmcnt(0)
v_max_u32 v4, v40, v42
v_cmp_eq_u32 vcc, -1, v4
s_cbranch_vccnz mega_kernel_rf_pa_4_2f
v_smfmac_f32_16x16x64_bf16 v[96:99], v[40:43], a[16:23], v6
v_smfmac_f32_16x16x64_bf16 v[100:103], v[40:43], a[48:55], v6
v_smfmac_f32_16x16x64_bf16 v[104:107], v[40:43], a[80:87], v6
v_smfmac_f32_16x16x64_bf16 v[108:111], v[40:43], a[112:119], v6
s_branch mega_kernel_rf_pa_d
mega_kernel_rf_il8:
s_cbranch_execz mega_kernel_rf_il9
.p2align 5
mega_kernel_rf_pa_5_0f:
s_mov_b64 exec, vcc
buffer_load_dwordx4 v[32:35], v7, s[84:87], s33 offen offset:0 sc1
s_mov_b64 exec, -1
s_branch mega_kernel_rf_pa_5_2
.p2align 5
mega_kernel_rf_pa_5_0:
s_waitcnt vmcnt(1)
v_max_u32 v4, v32, v34
v_cmp_eq_u32 vcc, -1, v4
s_cbranch_vccnz mega_kernel_rf_pa_5_0f
v_smfmac_f32_16x16x64_bf16 v[96:99], v[32:35], a[0:7], v6
v_smfmac_f32_16x16x64_bf16 v[100:103], v[32:35], a[32:39], v6
v_smfmac_f32_16x16x64_bf16 v[104:107], v[32:35], a[64:71], v6
v_smfmac_f32_16x16x64_bf16 v[108:111], v[32:35], a[96:103], v6
s_branch mega_kernel_rf_pa_4_2
mega_kernel_rf_il9:
s_cbranch_execz mega_kernel_rf_il10
.p2align 5
mega_kernel_rf_pa_5_2f:
s_mov_b64 exec, vcc
buffer_load_dwordx4 v[40:43], v7, s[84:87], s33 offen offset:2048 sc1
s_mov_b64 exec, -1
s_branch mega_kernel_rf_pa_5_0
.p2align 5
mega_kernel_rf_pa_5_2:
s_waitcnt vmcnt(1)
v_max_u32 v4, v40, v42
v_cmp_eq_u32 vcc, -1, v4
s_cbranch_vccnz mega_kernel_rf_pa_5_2f
v_smfmac_f32_16x16x64_bf16 v[96:99], v[40:43], a[16:23], v6
v_smfmac_f32_16x16x64_bf16 v[100:103], v[40:43], a[48:55], v6
v_smfmac_f32_16x16x64_bf16 v[104:107], v[40:43], a[80:87], v6
v_smfmac_f32_16x16x64_bf16 v[108:111], v[40:43], a[112:119], v6
s_branch mega_kernel_rf_pa_1_0
mega_kernel_rf_il10:
s_cbranch_execz mega_kernel_rf_il11
.p2align 5
mega_kernel_rf_pa_6_1f:
s_mov_b64 exec, vcc
buffer_load_dwordx4 v[36:39], v7, s[84:87], s33 offen offset:1024 sc1
s_mov_b64 exec, -1
s_branch mega_kernel_rf_pa_6_2
.p2align 5
mega_kernel_rf_pa_6_1:
s_waitcnt vmcnt(1)
v_max_u32 v4, v36, v38
v_cmp_eq_u32 vcc, -1, v4
s_cbranch_vccnz mega_kernel_rf_pa_6_1f
v_smfmac_f32_16x16x64_bf16 v[96:99], v[36:39], a[8:15], v6
v_smfmac_f32_16x16x64_bf16 v[100:103], v[36:39], a[40:47], v6
v_smfmac_f32_16x16x64_bf16 v[104:107], v[36:39], a[72:79], v6
v_smfmac_f32_16x16x64_bf16 v[108:111], v[36:39], a[104:111], v6
s_branch mega_kernel_rf_pa_4_2
mega_kernel_rf_il11:
s_cbranch_execz mega_kernel_rf_il12
.p2align 5
mega_kernel_rf_pa_6_2f:
s_mov_b64 exec, vcc
buffer_load_dwordx4 v[40:43], v7, s[84:87], s33 offen offset:2048 sc1
s_mov_b64 exec, -1
s_branch mega_kernel_rf_pa_6_1
.p2align 5
mega_kernel_rf_pa_6_2:
s_waitcnt vmcnt(1)
v_max_u32 v4, v40, v42
v_cmp_eq_u32 vcc, -1, v4
s_cbranch_vccnz mega_kernel_rf_pa_6_2f
v_smfmac_f32_16x16x64_bf16 v[96:99], v[40:43], a[16:23], v6
v_smfmac_f32_16x16x64_bf16 v[100:103], v[40:43], a[48:55], v6
v_smfmac_f32_16x16x64_bf16 v[104:107], v[40:43], a[80:87], v6
v_smfmac_f32_16x16x64_bf16 v[108:111], v[40:43], a[112:119], v6
s_branch mega_kernel_rf_pa_2_1
mega_kernel_rf_il12:
s_cbranch_execz mega_kernel_rf_il13
.p2align 5
mega_kernel_rf_pa_7_0f:
s_mov_b64 exec, vcc
buffer_load_dwordx4 v[32:35], v7, s[84:87], s33 offen offset:0 sc1
s_mov_b64 exec, -1
s_branch mega_kernel_rf_pa_7_1
.p2align 5
mega_kernel_rf_pa_7_0:
s_waitcnt vmcnt(2)
v_max_u32 v4, v32, v34
v_cmp_eq_u32 vcc, -1, v4
s_cbranch_vccnz mega_kernel_rf_pa_7_0f
v_smfmac_f32_16x16x64_bf16 v[96:99], v[32:35], a[0:7], v6
v_smfmac_f32_16x16x64_bf16 v[100:103], v[32:35], a[32:39], v6
v_smfmac_f32_16x16x64_bf16 v[104:107], v[32:35], a[64:71], v6
v_smfmac_f32_16x16x64_bf16 v[108:111], v[32:35], a[96:103], v6
s_branch mega_kernel_rf_pa_6_1
mega_kernel_rf_il13:
s_cbranch_execz mega_kernel_rf_il14
.p2align 5
mega_kernel_rf_pa_7_1f:
s_mov_b64 exec, vcc
buffer_load_dwordx4 v[36:39], v7, s[84:87], s33 offen offset:1024 sc1
s_mov_b64 exec, -1
s_branch mega_kernel_rf_pa_7_2
.p2align 5
mega_kernel_rf_pa_7_1:
s_waitcnt vmcnt(2)
v_max_u32 v4, v36, v38
v_cmp_eq_u32 vcc, -1, v4
s_cbranch_vccnz mega_kernel_rf_pa_7_1f
v_smfmac_f32_16x16x64_bf16 v[96:99], v[36:39], a[8:15], v6
v_smfmac_f32_16x16x64_bf16 v[100:103], v[36:39], a[40:47], v6
v_smfmac_f32_16x16x64_bf16 v[104:107], v[36:39], a[72:79], v6
v_smfmac_f32_16x16x64_bf16 v[108:111], v[36:39], a[104:111], v6
s_branch mega_kernel_rf_pa_5_2
mega_kernel_rf_il14:
s_cbranch_execz mega_kernel_rf_il15
.p2align 5
mega_kernel_rf_pa_7_2f:
s_mov_b64 exec, vcc
buffer_load_dwordx4 v[40:43], v7, s[84:87], s33 offen offset:2048 sc1
s_mov_b64 exec, -1
s_branch mega_kernel_rf_pa_7_0
.p2align 5
mega_kernel_rf_pa_7_2:
s_waitcnt vmcnt(2)
v_max_u32 v4, v40, v42
v_cmp_eq_u32 vcc, -1, v4
s_cbranch_vccnz mega_kernel_rf_pa_7_2f
v_smfmac_f32_16x16x64_bf16 v[96:99], v[40:43], a[16:23], v6
v_smfmac_f32_16x16x64_bf16 v[100:103], v[40:43], a[48:55], v6
v_smfmac_f32_16x16x64_bf16 v[104:107], v[40:43], a[80:87], v6
v_smfmac_f32_16x16x64_bf16 v[108:111], v[40:43], a[112:119], v6
s_branch mega_kernel_rf_pa_3_0
mega_kernel_rf_il15:
s_cbranch_execz mega_kernel_rf_il16
.p2align 5
mega_kernel_rf_pa_8_3f:
s_mov_b64 exec, vcc
buffer_load_dwordx4 v[44:47], v7, s[84:87], s33 offen offset:3072 sc1
s_mov_b64 exec, -1
s_branch mega_kernel_rf_pa_8_3
.p2align 5
mega_kernel_rf_pa_8_3:
s_waitcnt vmcnt(0)
v_max_u32 v4, v44, v46
v_cmp_eq_u32 vcc, -1, v4
s_cbranch_vccnz mega_kernel_rf_pa_8_3f
v_smfmac_f32_16x16x64_bf16 v[96:99], v[44:47], a[24:31], v6
v_smfmac_f32_16x16x64_bf16 v[100:103], v[44:47], a[56:63], v6
v_smfmac_f32_16x16x64_bf16 v[104:107], v[44:47], a[88:95], v6
v_smfmac_f32_16x16x64_bf16 v[108:111], v[44:47], a[120:127], v6
s_branch mega_kernel_rf_pa_d
mega_kernel_rf_il16:
s_cbranch_execz mega_kernel_rf_il17
.p2align 5
mega_kernel_rf_pa_9_0f:
s_mov_b64 exec, vcc
buffer_load_dwordx4 v[32:35], v7, s[84:87], s33 offen offset:0 sc1
s_mov_b64 exec, -1
s_branch mega_kernel_rf_pa_9_3
.p2align 5
mega_kernel_rf_pa_9_0:
s_waitcnt vmcnt(1)
v_max_u32 v4, v32, v34
v_cmp_eq_u32 vcc, -1, v4
s_cbranch_vccnz mega_kernel_rf_pa_9_0f
v_smfmac_f32_16x16x64_bf16 v[96:99], v[32:35], a[0:7], v6
v_smfmac_f32_16x16x64_bf16 v[100:103], v[32:35], a[32:39], v6
v_smfmac_f32_16x16x64_bf16 v[104:107], v[32:35], a[64:71], v6
v_smfmac_f32_16x16x64_bf16 v[108:111], v[32:35], a[96:103], v6
s_branch mega_kernel_rf_pa_8_3
mega_kernel_rf_il17:
s_cbranch_execz mega_kernel_rf_il18
.p2align 5
mega_kernel_rf_pa_9_3f:
s_mov_b64 exec, vcc
buffer_load_dwordx4 v[44:47], v7, s[84:87], s33 offen offset:3072 sc1
s_mov_b64 exec, -1
s_branch mega_kernel_rf_pa_9_0
.p2align 5
mega_kernel_rf_pa_9_3:
s_waitcnt vmcnt(1)
v_max_u32 v4, v44, v46
v_cmp_eq_u32 vcc, -1, v4
s_cbranch_vccnz mega_kernel_rf_pa_9_3f
v_smfmac_f32_16x16x64_bf16 v[96:99], v[44:47], a[24:31], v6
v_smfmac_f32_16x16x64_bf16 v[100:103], v[44:47], a[56:63], v6
v_smfmac_f32_16x16x64_bf16 v[104:107], v[44:47], a[88:95], v6
v_smfmac_f32_16x16x64_bf16 v[108:111], v[44:47], a[120:127], v6
s_branch mega_kernel_rf_pa_1_0
mega_kernel_rf_il18:
s_cbranch_execz mega_kernel_rf_iwd
.p2align 5
mega_kernel_rf_pa_10_1f:
s_mov_b64 exec, vcc
buffer_load_dwordx4 v[36:39], v7, s[84:87], s33 offen offset:1024 sc1
s_mov_b64 exec, -1
s_branch mega_kernel_rf_pa_10_3
.p2align 5
mega_kernel_rf_pa_10_1:
s_waitcnt vmcnt(1)
v_max_u32 v4, v36, v38
v_cmp_eq_u32 vcc, -1, v4
s_cbranch_vccnz mega_kernel_rf_pa_10_1f
v_smfmac_f32_16x16x64_bf16 v[96:99], v[36:39], a[8:15], v6
v_smfmac_f32_16x16x64_bf16 v[100:103], v[36:39], a[40:47], v6
v_smfmac_f32_16x16x64_bf16 v[104:107], v[36:39], a[72:79], v6
v_smfmac_f32_16x16x64_bf16 v[108:111], v[36:39], a[104:111], v6
s_branch mega_kernel_rf_pa_8_3
mega_kernel_rf_iw1:
mega_kernel_rf_il19:
s_cbranch_execz mega_kernel_rf_il20
.p2align 5
mega_kernel_rf_pa_10_3f:
s_mov_b64 exec, vcc
buffer_load_dwordx4 v[44:47], v7, s[84:87], s33 offen offset:3072 sc1
s_mov_b64 exec, -1
s_branch mega_kernel_rf_pa_10_1
.p2align 5
mega_kernel_rf_pa_10_3:
s_waitcnt vmcnt(1)
v_max_u32 v4, v44, v46
v_cmp_eq_u32 vcc, -1, v4
s_cbranch_vccnz mega_kernel_rf_pa_10_3f
v_smfmac_f32_16x16x64_bf16 v[96:99], v[44:47], a[24:31], v6
v_smfmac_f32_16x16x64_bf16 v[100:103], v[44:47], a[56:63], v6
v_smfmac_f32_16x16x64_bf16 v[104:107], v[44:47], a[88:95], v6
v_smfmac_f32_16x16x64_bf16 v[108:111], v[44:47], a[120:127], v6
s_branch mega_kernel_rf_pa_2_1
mega_kernel_rf_il20:
s_cbranch_execz mega_kernel_rf_il21
.p2align 5
mega_kernel_rf_pa_11_0f:
s_mov_b64 exec, vcc
buffer_load_dwordx4 v[32:35], v7, s[84:87], s33 offen offset:0 sc1
s_mov_b64 exec, -1
s_branch mega_kernel_rf_pa_11_1
.p2align 5
mega_kernel_rf_pa_11_0:
s_waitcnt vmcnt(2)
v_max_u32 v4, v32, v34
v_cmp_eq_u32 vcc, -1, v4
s_cbranch_vccnz mega_kernel_rf_pa_11_0f
v_smfmac_f32_16x16x64_bf16 v[96:99], v[32:35], a[0:7], v6
v_smfmac_f32_16x16x64_bf16 v[100:103], v[32:35], a[32:39], v6
v_smfmac_f32_16x16x64_bf16 v[104:107], v[32:35], a[64:71], v6
v_smfmac_f32_16x16x64_bf16 v[108:111], v[32:35], a[96:103], v6
s_branch mega_kernel_rf_pa_10_1
mega_kernel_rf_il21:
s_cbranch_execz mega_kernel_rf_il22
.p2align 5
mega_kernel_rf_pa_11_1f:
s_mov_b64 exec, vcc
buffer_load_dwordx4 v[36:39], v7, s[84:87], s33 offen offset:1024 sc1
s_mov_b64 exec, -1
s_branch mega_kernel_rf_pa_11_3
.p2align 5
mega_kernel_rf_pa_11_1:
s_waitcnt vmcnt(2)
v_max_u32 v4, v36, v38
v_cmp_eq_u32 vcc, -1, v4
s_cbranch_vccnz mega_kernel_rf_pa_11_1f
v_smfmac_f32_16x16x64_bf16 v[96:99], v[36:39], a[8:15], v6
v_smfmac_f32_16x16x64_bf16 v[100:103], v[36:39], a[40:47], v6
v_smfmac_f32_16x16x64_bf16 v[104:107], v[36:39], a[72:79], v6
v_smfmac_f32_16x16x64_bf16 v[108:111], v[36:39], a[104:111], v6
s_branch mega_kernel_rf_pa_9_3
mega_kernel_rf_il22:
s_cbranch_execz mega_kernel_rf_il23
.p2align 5
mega_kernel_rf_pa_11_3f:
s_mov_b64 exec, vcc
buffer_load_dwordx4 v[44:47], v7, s[84:87], s33 offen offset:3072 sc1
s_mov_b64 exec, -1
s_branch mega_kernel_rf_pa_11_0
.p2align 5
mega_kernel_rf_pa_11_3:
s_waitcnt vmcnt(2)
v_max_u32 v4, v44, v46
v_cmp_eq_u32 vcc, -1, v4
s_cbranch_vccnz mega_kernel_rf_pa_11_3f
v_smfmac_f32_16x16x64_bf16 v[96:99], v[44:47], a[24:31], v6
v_smfmac_f32_16x16x64_bf16 v[100:103], v[44:47], a[56:63], v6
v_smfmac_f32_16x16x64_bf16 v[104:107], v[44:47], a[88:95], v6
v_smfmac_f32_16x16x64_bf16 v[108:111], v[44:47], a[120:127], v6
s_branch mega_kernel_rf_pa_3_0
mega_kernel_rf_il23:
s_cbranch_execz mega_kernel_rf_il24
.p2align 5
mega_kernel_rf_pa_12_2f:
s_mov_b64 exec, vcc
buffer_load_dwordx4 v[40:43], v7, s[84:87], s33 offen offset:2048 sc1
s_mov_b64 exec, -1
s_branch mega_kernel_rf_pa_12_3
.p2align 5
mega_kernel_rf_pa_12_2:
s_waitcnt vmcnt(1)
v_max_u32 v4, v40, v42
v_cmp_eq_u32 vcc, -1, v4
s_cbranch_vccnz mega_kernel_rf_pa_12_2f
v_smfmac_f32_16x16x64_bf16 v[96:99], v[40:43], a[16:23], v6
v_smfmac_f32_16x16x64_bf16 v[100:103], v[40:43], a[48:55], v6
v_smfmac_f32_16x16x64_bf16 v[104:107], v[40:43], a[80:87], v6
v_smfmac_f32_16x16x64_bf16 v[108:111], v[40:43], a[112:119], v6
s_branch mega_kernel_rf_pa_8_3
mega_kernel_rf_il24:
s_cbranch_execz mega_kernel_rf_il25
.p2align 5
mega_kernel_rf_pa_12_3f:
s_mov_b64 exec, vcc
buffer_load_dwordx4 v[44:47], v7, s[84:87], s33 offen offset:3072 sc1
s_mov_b64 exec, -1
s_branch mega_kernel_rf_pa_12_2
.p2align 5
mega_kernel_rf_pa_12_3:
s_waitcnt vmcnt(1)
v_max_u32 v4, v44, v46
v_cmp_eq_u32 vcc, -1, v4
s_cbranch_vccnz mega_kernel_rf_pa_12_3f
v_smfmac_f32_16x16x64_bf16 v[96:99], v[44:47], a[24:31], v6
v_smfmac_f32_16x16x64_bf16 v[100:103], v[44:47], a[56:63], v6
v_smfmac_f32_16x16x64_bf16 v[104:107], v[44:47], a[88:95], v6
v_smfmac_f32_16x16x64_bf16 v[108:111], v[44:47], a[120:127], v6
s_branch mega_kernel_rf_pa_4_2
mega_kernel_rf_il25:
s_cbranch_execz mega_kernel_rf_il26
.p2align 5
mega_kernel_rf_pa_13_0f:
s_mov_b64 exec, vcc
buffer_load_dwordx4 v[32:35], v7, s[84:87], s33 offen offset:0 sc1
s_mov_b64 exec, -1
s_branch mega_kernel_rf_pa_13_2
.p2align 5
mega_kernel_rf_pa_13_0:
s_waitcnt vmcnt(2)
v_max_u32 v4, v32, v34
v_cmp_eq_u32 vcc, -1, v4
s_cbranch_vccnz mega_kernel_rf_pa_13_0f
v_smfmac_f32_16x16x64_bf16 v[96:99], v[32:35], a[0:7], v6
v_smfmac_f32_16x16x64_bf16 v[100:103], v[32:35], a[32:39], v6
v_smfmac_f32_16x16x64_bf16 v[104:107], v[32:35], a[64:71], v6
v_smfmac_f32_16x16x64_bf16 v[108:111], v[32:35], a[96:103], v6
s_branch mega_kernel_rf_pa_12_2
mega_kernel_rf_il26:
s_cbranch_execz mega_kernel_rf_il27
.p2align 5
mega_kernel_rf_pa_13_2f:
s_mov_b64 exec, vcc
buffer_load_dwordx4 v[40:43], v7, s[84:87], s33 offen offset:2048 sc1
s_mov_b64 exec, -1
s_branch mega_kernel_rf_pa_13_3
.p2align 5
mega_kernel_rf_pa_13_2:
s_waitcnt vmcnt(2)
v_max_u32 v4, v40, v42
v_cmp_eq_u32 vcc, -1, v4
s_cbranch_vccnz mega_kernel_rf_pa_13_2f
v_smfmac_f32_16x16x64_bf16 v[96:99], v[40:43], a[16:23], v6
v_smfmac_f32_16x16x64_bf16 v[100:103], v[40:43], a[48:55], v6
v_smfmac_f32_16x16x64_bf16 v[104:107], v[40:43], a[80:87], v6
v_smfmac_f32_16x16x64_bf16 v[108:111], v[40:43], a[112:119], v6
s_branch mega_kernel_rf_pa_9_3
mega_kernel_rf_il27:
s_cbranch_execz mega_kernel_rf_il28
.p2align 5
mega_kernel_rf_pa_13_3f:
s_mov_b64 exec, vcc
buffer_load_dwordx4 v[44:47], v7, s[84:87], s33 offen offset:3072 sc1
s_mov_b64 exec, -1
s_branch mega_kernel_rf_pa_13_0
.p2align 5
mega_kernel_rf_pa_13_3:
s_waitcnt vmcnt(2)
v_max_u32 v4, v44, v46
v_cmp_eq_u32 vcc, -1, v4
s_cbranch_vccnz mega_kernel_rf_pa_13_3f
v_smfmac_f32_16x16x64_bf16 v[96:99], v[44:47], a[24:31], v6
v_smfmac_f32_16x16x64_bf16 v[100:103], v[44:47], a[56:63], v6
v_smfmac_f32_16x16x64_bf16 v[104:107], v[44:47], a[88:95], v6
v_smfmac_f32_16x16x64_bf16 v[108:111], v[44:47], a[120:127], v6
s_branch mega_kernel_rf_pa_5_0
mega_kernel_rf_il28:
s_cbranch_execz mega_kernel_rf_il29
.p2align 5
mega_kernel_rf_pa_14_1f:
s_mov_b64 exec, vcc
buffer_load_dwordx4 v[36:39], v7, s[84:87], s33 offen offset:1024 sc1
s_mov_b64 exec, -1
s_branch mega_kernel_rf_pa_14_2
.p2align 5
mega_kernel_rf_pa_14_1:
s_waitcnt vmcnt(2)
v_max_u32 v4, v36, v38
v_cmp_eq_u32 vcc, -1, v4
s_cbranch_vccnz mega_kernel_rf_pa_14_1f
v_smfmac_f32_16x16x64_bf16 v[96:99], v[36:39], a[8:15], v6
v_smfmac_f32_16x16x64_bf16 v[100:103], v[36:39], a[40:47], v6
v_smfmac_f32_16x16x64_bf16 v[104:107], v[36:39], a[72:79], v6
v_smfmac_f32_16x16x64_bf16 v[108:111], v[36:39], a[104:111], v6
s_branch mega_kernel_rf_pa_12_2
mega_kernel_rf_il29:
s_cbranch_execz mega_kernel_rf_il30
.p2align 5
mega_kernel_rf_pa_14_2f:
s_mov_b64 exec, vcc
buffer_load_dwordx4 v[40:43], v7, s[84:87], s33 offen offset:2048 sc1
s_mov_b64 exec, -1
s_branch mega_kernel_rf_pa_14_3
.p2align 5
mega_kernel_rf_pa_14_2:
s_waitcnt vmcnt(2)
v_max_u32 v4, v40, v42
v_cmp_eq_u32 vcc, -1, v4
s_cbranch_vccnz mega_kernel_rf_pa_14_2f
v_smfmac_f32_16x16x64_bf16 v[96:99], v[40:43], a[16:23], v6
v_smfmac_f32_16x16x64_bf16 v[100:103], v[40:43], a[48:55], v6
v_smfmac_f32_16x16x64_bf16 v[104:107], v[40:43], a[80:87], v6
v_smfmac_f32_16x16x64_bf16 v[108:111], v[40:43], a[112:119], v6
s_branch mega_kernel_rf_pa_10_3
mega_kernel_rf_il30:
s_cbranch_execz mega_kernel_rf_il31
.p2align 5
mega_kernel_rf_pa_14_3f:
s_mov_b64 exec, vcc
buffer_load_dwordx4 v[44:47], v7, s[84:87], s33 offen offset:3072 sc1
s_mov_b64 exec, -1
s_branch mega_kernel_rf_pa_14_1
.p2align 5
mega_kernel_rf_pa_14_3:
s_waitcnt vmcnt(2)
v_max_u32 v4, v44, v46
v_cmp_eq_u32 vcc, -1, v4
s_cbranch_vccnz mega_kernel_rf_pa_14_3f
v_smfmac_f32_16x16x64_bf16 v[96:99], v[44:47], a[24:31], v6
v_smfmac_f32_16x16x64_bf16 v[100:103], v[44:47], a[56:63], v6
v_smfmac_f32_16x16x64_bf16 v[104:107], v[44:47], a[88:95], v6
v_smfmac_f32_16x16x64_bf16 v[108:111], v[44:47], a[120:127], v6
s_branch mega_kernel_rf_pa_6_1
mega_kernel_rf_il31:
s_cbranch_execz mega_kernel_rf_il32
.p2align 5
mega_kernel_rf_pa_15_0f:
s_mov_b64 exec, vcc
buffer_load_dwordx4 v[32:35], v7, s[84:87], s33 offen offset:0 sc1
s_mov_b64 exec, -1
s_branch mega_kernel_rf_pa_15_1
.p2align 5
mega_kernel_rf_pa_15_0:
s_waitcnt vmcnt(3)
v_max_u32 v4, v32, v34
v_cmp_eq_u32 vcc, -1, v4
s_cbranch_vccnz mega_kernel_rf_pa_15_0f
v_smfmac_f32_16x16x64_bf16 v[96:99], v[32:35], a[0:7], v6
v_smfmac_f32_16x16x64_bf16 v[100:103], v[32:35], a[32:39], v6
v_smfmac_f32_16x16x64_bf16 v[104:107], v[32:35], a[64:71], v6
v_smfmac_f32_16x16x64_bf16 v[108:111], v[32:35], a[96:103], v6
s_branch mega_kernel_rf_pa_14_1
mega_kernel_rf_il32:
s_cbranch_execz mega_kernel_rf_il33
.p2align 5
mega_kernel_rf_pa_15_1f:
s_mov_b64 exec, vcc
buffer_load_dwordx4 v[36:39], v7, s[84:87], s33 offen offset:1024 sc1
s_mov_b64 exec, -1
s_branch mega_kernel_rf_pa_15_2
.p2align 5
mega_kernel_rf_pa_15_1:
s_waitcnt vmcnt(3)
v_max_u32 v4, v36, v38
v_cmp_eq_u32 vcc, -1, v4
s_cbranch_vccnz mega_kernel_rf_pa_15_1f
v_smfmac_f32_16x16x64_bf16 v[96:99], v[36:39], a[8:15], v6
v_smfmac_f32_16x16x64_bf16 v[100:103], v[36:39], a[40:47], v6
v_smfmac_f32_16x16x64_bf16 v[104:107], v[36:39], a[72:79], v6
v_smfmac_f32_16x16x64_bf16 v[108:111], v[36:39], a[104:111], v6
s_branch mega_kernel_rf_pa_13_2
mega_kernel_rf_il33:
s_cbranch_execz mega_kernel_rf_il34
.p2align 5
mega_kernel_rf_pa_15_2f:
s_mov_b64 exec, vcc
buffer_load_dwordx4 v[40:43], v7, s[84:87], s33 offen offset:2048 sc1
s_mov_b64 exec, -1
s_branch mega_kernel_rf_pa_15_3
.p2align 5
mega_kernel_rf_pa_15_2:
s_waitcnt vmcnt(3)
v_max_u32 v4, v40, v42
v_cmp_eq_u32 vcc, -1, v4
s_cbranch_vccnz mega_kernel_rf_pa_15_2f
v_smfmac_f32_16x16x64_bf16 v[96:99], v[40:43], a[16:23], v6
v_smfmac_f32_16x16x64_bf16 v[100:103], v[40:43], a[48:55], v6
v_smfmac_f32_16x16x64_bf16 v[104:107], v[40:43], a[80:87], v6
v_smfmac_f32_16x16x64_bf16 v[108:111], v[40:43], a[112:119], v6
s_branch mega_kernel_rf_pa_11_3
mega_kernel_rf_il34:
s_cbranch_execz mega_kernel_rf_il35
.p2align 5
mega_kernel_rf_pa_15_3f:
s_mov_b64 exec, vcc
buffer_load_dwordx4 v[44:47], v7, s[84:87], s33 offen offset:3072 sc1
s_mov_b64 exec, -1
s_branch mega_kernel_rf_pa_15_0
.p2align 5
mega_kernel_rf_pa_15_3:
s_waitcnt vmcnt(3)
v_max_u32 v4, v44, v46
v_cmp_eq_u32 vcc, -1, v4
s_cbranch_vccnz mega_kernel_rf_pa_15_3f
v_smfmac_f32_16x16x64_bf16 v[96:99], v[44:47], a[24:31], v6
v_smfmac_f32_16x16x64_bf16 v[100:103], v[44:47], a[56:63], v6
v_smfmac_f32_16x16x64_bf16 v[104:107], v[44:47], a[88:95], v6
v_smfmac_f32_16x16x64_bf16 v[108:111], v[44:47], a[120:127], v6
s_branch mega_kernel_rf_pa_7_0
mega_kernel_rf_il35:
s_cbranch_execz mega_kernel_rf_il36
.p2align 5
mega_kernel_rf_pc_1_0f:
s_mov_b64 exec, vcc
buffer_load_dwordx4 v[32:35], v7, s[84:87], s29 offen offset:0 sc1
s_mov_b64 exec, -1
s_branch mega_kernel_rf_pc_1_0
.p2align 5
mega_kernel_rf_pc_1_0:
s_waitcnt vmcnt(0)
v_cmp_eq_u32 vcc, -1, v32
s_cbranch_vccnz mega_kernel_rf_pc_1_0f
v_smfmac_f32_16x16x64_bf16 v[96:99], v[32:35], a[192:199], v6
v_smfmac_f32_16x16x64_bf16 v[100:103], v[32:35], a[224:231], v6
s_branch mega_kernel_rf_pc_d
mega_kernel_rf_il36:
s_cbranch_execz mega_kernel_rf_il37
.p2align 5
mega_kernel_rf_pc_2_1f:
s_mov_b64 exec, vcc
buffer_load_dwordx4 v[36:39], v7, s[84:87], s29 offen offset:1024 sc1
s_mov_b64 exec, -1
s_branch mega_kernel_rf_pc_2_1
mega_kernel_rf_il37:
s_cbranch_execz mega_kernel_rf_iwd
.p2align 5
mega_kernel_rf_pc_2_1:
s_waitcnt vmcnt(0)
v_cmp_eq_u32 vcc, -1, v36
s_cbranch_vccnz mega_kernel_rf_pc_2_1f
v_smfmac_f32_16x16x64_bf16 v[96:99], v[36:39], a[200:207], v6
v_smfmac_f32_16x16x64_bf16 v[100:103], v[36:39], a[232:239], v6
s_branch mega_kernel_rf_pc_d
.p2align 5
mega_kernel_rf_pc_3_0f:
s_mov_b64 exec, vcc
buffer_load_dwordx4 v[32:35], v7, s[84:87], s29 offen offset:0 sc1
s_mov_b64 exec, -1
s_branch mega_kernel_rf_pc_3_1
mega_kernel_rf_iw2:
mega_kernel_rf_il38:
s_cbranch_execz mega_kernel_rf_il39
.p2align 5
mega_kernel_rf_pc_3_0:
s_waitcnt vmcnt(1)
v_cmp_eq_u32 vcc, -1, v32
s_cbranch_vccnz mega_kernel_rf_pc_3_0f
v_smfmac_f32_16x16x64_bf16 v[96:99], v[32:35], a[192:199], v6
v_smfmac_f32_16x16x64_bf16 v[100:103], v[32:35], a[224:231], v6
s_branch mega_kernel_rf_pc_2_1
.p2align 5
mega_kernel_rf_pc_3_1f:
s_mov_b64 exec, vcc
buffer_load_dwordx4 v[36:39], v7, s[84:87], s29 offen offset:1024 sc1
s_mov_b64 exec, -1
s_branch mega_kernel_rf_pc_3_0
mega_kernel_rf_il39:
s_cbranch_execz mega_kernel_rf_il40
.p2align 5
mega_kernel_rf_pc_3_1:
s_waitcnt vmcnt(1)
v_cmp_eq_u32 vcc, -1, v36
s_cbranch_vccnz mega_kernel_rf_pc_3_1f
v_smfmac_f32_16x16x64_bf16 v[96:99], v[36:39], a[200:207], v6
v_smfmac_f32_16x16x64_bf16 v[100:103], v[36:39], a[232:239], v6
s_branch mega_kernel_rf_pc_1_0
.p2align 5
mega_kernel_rf_pc_4_2f:
s_mov_b64 exec, vcc
buffer_load_dwordx4 v[40:43], v7, s[84:87], s29 offen offset:2048 sc1
s_mov_b64 exec, -1
s_branch mega_kernel_rf_pc_4_2
mega_kernel_rf_il40:
s_cbranch_execz mega_kernel_rf_il41
.p2align 5
mega_kernel_rf_pc_4_2:
s_waitcnt vmcnt(0)
v_cmp_eq_u32 vcc, -1, v40
s_cbranch_vccnz mega_kernel_rf_pc_4_2f
v_smfmac_f32_16x16x64_bf16 v[96:99], v[40:43], a[208:215], v6
v_smfmac_f32_16x16x64_bf16 v[100:103], v[40:43], a[240:247], v6
s_branch mega_kernel_rf_pc_d
.p2align 5
mega_kernel_rf_pc_5_0f:
s_mov_b64 exec, vcc
buffer_load_dwordx4 v[32:35], v7, s[84:87], s29 offen offset:0 sc1
s_mov_b64 exec, -1
s_branch mega_kernel_rf_pc_5_2
mega_kernel_rf_il41:
s_cbranch_execz mega_kernel_rf_il42
.p2align 5
mega_kernel_rf_pc_5_0:
s_waitcnt vmcnt(1)
v_cmp_eq_u32 vcc, -1, v32
s_cbranch_vccnz mega_kernel_rf_pc_5_0f
v_smfmac_f32_16x16x64_bf16 v[96:99], v[32:35], a[192:199], v6
v_smfmac_f32_16x16x64_bf16 v[100:103], v[32:35], a[224:231], v6
s_branch mega_kernel_rf_pc_4_2
.p2align 5
mega_kernel_rf_pc_5_2f:
s_mov_b64 exec, vcc
buffer_load_dwordx4 v[40:43], v7, s[84:87], s29 offen offset:2048 sc1
s_mov_b64 exec, -1
s_branch mega_kernel_rf_pc_5_0
mega_kernel_rf_il42:
s_cbranch_execz mega_kernel_rf_il43
.p2align 5
mega_kernel_rf_pc_5_2:
s_waitcnt vmcnt(1)
v_cmp_eq_u32 vcc, -1, v40
s_cbranch_vccnz mega_kernel_rf_pc_5_2f
v_smfmac_f32_16x16x64_bf16 v[96:99], v[40:43], a[208:215], v6
v_smfmac_f32_16x16x64_bf16 v[100:103], v[40:43], a[240:247], v6
s_branch mega_kernel_rf_pc_1_0
.p2align 5
mega_kernel_rf_pc_6_1f:
s_mov_b64 exec, vcc
buffer_load_dwordx4 v[36:39], v7, s[84:87], s29 offen offset:1024 sc1
s_mov_b64 exec, -1
s_branch mega_kernel_rf_pc_6_2
mega_kernel_rf_il43:
s_cbranch_execz mega_kernel_rf_il44
.p2align 5
mega_kernel_rf_pc_6_1:
s_waitcnt vmcnt(1)
v_cmp_eq_u32 vcc, -1, v36
s_cbranch_vccnz mega_kernel_rf_pc_6_1f
v_smfmac_f32_16x16x64_bf16 v[96:99], v[36:39], a[200:207], v6
v_smfmac_f32_16x16x64_bf16 v[100:103], v[36:39], a[232:239], v6
s_branch mega_kernel_rf_pc_4_2
.p2align 5
mega_kernel_rf_pc_6_2f:
s_mov_b64 exec, vcc
buffer_load_dwordx4 v[40:43], v7, s[84:87], s29 offen offset:2048 sc1
s_mov_b64 exec, -1
s_branch mega_kernel_rf_pc_6_1
mega_kernel_rf_il44:
s_cbranch_execz mega_kernel_rf_il45
.p2align 5
mega_kernel_rf_pc_6_2:
s_waitcnt vmcnt(1)
v_cmp_eq_u32 vcc, -1, v40
s_cbranch_vccnz mega_kernel_rf_pc_6_2f
v_smfmac_f32_16x16x64_bf16 v[96:99], v[40:43], a[208:215], v6
v_smfmac_f32_16x16x64_bf16 v[100:103], v[40:43], a[240:247], v6
s_branch mega_kernel_rf_pc_2_1
.p2align 5
mega_kernel_rf_pc_7_0f:
s_mov_b64 exec, vcc
buffer_load_dwordx4 v[32:35], v7, s[84:87], s29 offen offset:0 sc1
s_mov_b64 exec, -1
s_branch mega_kernel_rf_pc_7_1
mega_kernel_rf_il45:
s_cbranch_execz mega_kernel_rf_il46
.p2align 5
mega_kernel_rf_pc_7_0:
s_waitcnt vmcnt(2)
v_cmp_eq_u32 vcc, -1, v32
s_cbranch_vccnz mega_kernel_rf_pc_7_0f
v_smfmac_f32_16x16x64_bf16 v[96:99], v[32:35], a[192:199], v6
v_smfmac_f32_16x16x64_bf16 v[100:103], v[32:35], a[224:231], v6
s_branch mega_kernel_rf_pc_6_1
.p2align 5
mega_kernel_rf_pc_7_1f:
s_mov_b64 exec, vcc
buffer_load_dwordx4 v[36:39], v7, s[84:87], s29 offen offset:1024 sc1
s_mov_b64 exec, -1
s_branch mega_kernel_rf_pc_7_2
mega_kernel_rf_il46:
s_cbranch_execz mega_kernel_rf_il47
.p2align 5
mega_kernel_rf_pc_7_1:
s_waitcnt vmcnt(2)
v_cmp_eq_u32 vcc, -1, v36
s_cbranch_vccnz mega_kernel_rf_pc_7_1f
v_smfmac_f32_16x16x64_bf16 v[96:99], v[36:39], a[200:207], v6
v_smfmac_f32_16x16x64_bf16 v[100:103], v[36:39], a[232:239], v6
s_branch mega_kernel_rf_pc_5_2
.p2align 5
mega_kernel_rf_pc_7_2f:
s_mov_b64 exec, vcc
buffer_load_dwordx4 v[40:43], v7, s[84:87], s29 offen offset:2048 sc1
s_mov_b64 exec, -1
s_branch mega_kernel_rf_pc_7_0
mega_kernel_rf_il47:
s_cbranch_execz mega_kernel_rf_il48
.p2align 5
mega_kernel_rf_pc_7_2:
s_waitcnt vmcnt(2)
v_cmp_eq_u32 vcc, -1, v40
s_cbranch_vccnz mega_kernel_rf_pc_7_2f
v_smfmac_f32_16x16x64_bf16 v[96:99], v[40:43], a[208:215], v6
v_smfmac_f32_16x16x64_bf16 v[100:103], v[40:43], a[240:247], v6
s_branch mega_kernel_rf_pc_3_0
.p2align 5
mega_kernel_rf_pc_8_3f:
s_mov_b64 exec, vcc
buffer_load_dwordx4 v[44:47], v7, s[84:87], s29 offen offset:3072 sc1
s_mov_b64 exec, -1
s_branch mega_kernel_rf_pc_8_3
mega_kernel_rf_il48:
s_cbranch_execz mega_kernel_rf_il49
.p2align 5
mega_kernel_rf_pc_9_0f:
s_mov_b64 exec, vcc
buffer_load_dwordx4 v[32:35], v7, s[84:87], s29 offen offset:0 sc1
s_mov_b64 exec, -1
s_branch mega_kernel_rf_pc_9_3
.p2align 5
mega_kernel_rf_pc_9_0:
s_waitcnt vmcnt(1)
v_cmp_eq_u32 vcc, -1, v32
s_cbranch_vccnz mega_kernel_rf_pc_9_0f
v_smfmac_f32_16x16x64_bf16 v[96:99], v[32:35], a[192:199], v6
v_smfmac_f32_16x16x64_bf16 v[100:103], v[32:35], a[224:231], v6
s_branch mega_kernel_rf_pc_8_3
mega_kernel_rf_il49:
s_cbranch_execz mega_kernel_rf_il50
.p2align 5
mega_kernel_rf_pc_9_3f:
s_mov_b64 exec, vcc
buffer_load_dwordx4 v[44:47], v7, s[84:87], s29 offen offset:3072 sc1
s_mov_b64 exec, -1
s_branch mega_kernel_rf_pc_9_0
mega_kernel_rf_il50:
s_cbranch_execz mega_kernel_rf_il51
.p2align 5
mega_kernel_rf_pc_9_3:
s_waitcnt vmcnt(1)
v_cmp_eq_u32 vcc, -1, v44
s_cbranch_vccnz mega_kernel_rf_pc_9_3f
v_smfmac_f32_16x16x64_bf16 v[96:99], v[44:47], a[216:223], v6
v_smfmac_f32_16x16x64_bf16 v[100:103], v[44:47], a[248:255], v6
s_branch mega_kernel_rf_pc_1_0
.p2align 5
mega_kernel_rf_pc_10_1f:
s_mov_b64 exec, vcc
buffer_load_dwordx4 v[36:39], v7, s[84:87], s29 offen offset:1024 sc1
s_mov_b64 exec, -1
s_branch mega_kernel_rf_pc_10_3
mega_kernel_rf_il51:
s_cbranch_execz mega_kernel_rf_il52
.p2align 5
mega_kernel_rf_pc_10_1:
s_waitcnt vmcnt(1)
v_cmp_eq_u32 vcc, -1, v36
s_cbranch_vccnz mega_kernel_rf_pc_10_1f
v_smfmac_f32_16x16x64_bf16 v[96:99], v[36:39], a[200:207], v6
v_smfmac_f32_16x16x64_bf16 v[100:103], v[36:39], a[232:239], v6
s_branch mega_kernel_rf_pc_8_3
.p2align 5
mega_kernel_rf_pc_10_3f:
s_mov_b64 exec, vcc
buffer_load_dwordx4 v[44:47], v7, s[84:87], s29 offen offset:3072 sc1
s_mov_b64 exec, -1
s_branch mega_kernel_rf_pc_10_1
mega_kernel_rf_il52:
s_cbranch_execz mega_kernel_rf_il53
.p2align 5
mega_kernel_rf_pc_10_3:
s_waitcnt vmcnt(1)
v_cmp_eq_u32 vcc, -1, v44
s_cbranch_vccnz mega_kernel_rf_pc_10_3f
v_smfmac_f32_16x16x64_bf16 v[96:99], v[44:47], a[216:223], v6
v_smfmac_f32_16x16x64_bf16 v[100:103], v[44:47], a[248:255], v6
s_branch mega_kernel_rf_pc_2_1
.p2align 5
mega_kernel_rf_pc_11_0f:
s_mov_b64 exec, vcc
buffer_load_dwordx4 v[32:35], v7, s[84:87], s29 offen offset:0 sc1
s_mov_b64 exec, -1
s_branch mega_kernel_rf_pc_11_1
mega_kernel_rf_il53:
s_cbranch_execz mega_kernel_rf_il54
.p2align 5
mega_kernel_rf_pc_11_0:
s_waitcnt vmcnt(2)
v_cmp_eq_u32 vcc, -1, v32
s_cbranch_vccnz mega_kernel_rf_pc_11_0f
v_smfmac_f32_16x16x64_bf16 v[96:99], v[32:35], a[192:199], v6
v_smfmac_f32_16x16x64_bf16 v[100:103], v[32:35], a[224:231], v6
s_branch mega_kernel_rf_pc_10_1
.p2align 5
mega_kernel_rf_pc_11_1f:
s_mov_b64 exec, vcc
buffer_load_dwordx4 v[36:39], v7, s[84:87], s29 offen offset:1024 sc1
s_mov_b64 exec, -1
s_branch mega_kernel_rf_pc_11_3
mega_kernel_rf_il54:
s_cbranch_execz mega_kernel_rf_il55
.p2align 5
mega_kernel_rf_pc_11_1:
s_waitcnt vmcnt(2)
v_cmp_eq_u32 vcc, -1, v36
s_cbranch_vccnz mega_kernel_rf_pc_11_1f
v_smfmac_f32_16x16x64_bf16 v[96:99], v[36:39], a[200:207], v6
v_smfmac_f32_16x16x64_bf16 v[100:103], v[36:39], a[232:239], v6
s_branch mega_kernel_rf_pc_9_3
.p2align 5
mega_kernel_rf_pc_11_3f:
s_mov_b64 exec, vcc
buffer_load_dwordx4 v[44:47], v7, s[84:87], s29 offen offset:3072 sc1
s_mov_b64 exec, -1
s_branch mega_kernel_rf_pc_11_0
mega_kernel_rf_il55:
s_cbranch_execz mega_kernel_rf_il56
.p2align 5
mega_kernel_rf_pc_11_3:
s_waitcnt vmcnt(2)
v_cmp_eq_u32 vcc, -1, v44
s_cbranch_vccnz mega_kernel_rf_pc_11_3f
v_smfmac_f32_16x16x64_bf16 v[96:99], v[44:47], a[216:223], v6
v_smfmac_f32_16x16x64_bf16 v[100:103], v[44:47], a[248:255], v6
s_branch mega_kernel_rf_pc_3_0
.p2align 5
mega_kernel_rf_pc_12_2f:
s_mov_b64 exec, vcc
buffer_load_dwordx4 v[40:43], v7, s[84:87], s29 offen offset:2048 sc1
s_mov_b64 exec, -1
s_branch mega_kernel_rf_pc_12_3
mega_kernel_rf_il56:
s_cbranch_execz mega_kernel_rf_iwd
.p2align 5
mega_kernel_rf_pc_12_3f:
s_mov_b64 exec, vcc
buffer_load_dwordx4 v[44:47], v7, s[84:87], s29 offen offset:3072 sc1
s_mov_b64 exec, -1
s_branch mega_kernel_rf_pc_12_2
.p2align 5
mega_kernel_rf_pc_12_3:
s_waitcnt vmcnt(1)
v_cmp_eq_u32 vcc, -1, v44
s_cbranch_vccnz mega_kernel_rf_pc_12_3f
v_smfmac_f32_16x16x64_bf16 v[96:99], v[44:47], a[216:223], v6
v_smfmac_f32_16x16x64_bf16 v[100:103], v[44:47], a[248:255], v6
s_branch mega_kernel_rf_pc_4_2
mega_kernel_rf_iw3:
mega_kernel_rf_il57:
s_cbranch_execz mega_kernel_rf_il58
.p2align 5
mega_kernel_rf_pc_13_0f:
s_mov_b64 exec, vcc
buffer_load_dwordx4 v[32:35], v7, s[84:87], s29 offen offset:0 sc1
s_mov_b64 exec, -1
s_branch mega_kernel_rf_pc_13_2
mega_kernel_rf_il58:
s_cbranch_execz mega_kernel_rf_il59
.p2align 5
mega_kernel_rf_pc_13_0:
s_waitcnt vmcnt(2)
v_cmp_eq_u32 vcc, -1, v32
s_cbranch_vccnz mega_kernel_rf_pc_13_0f
v_smfmac_f32_16x16x64_bf16 v[96:99], v[32:35], a[192:199], v6
v_smfmac_f32_16x16x64_bf16 v[100:103], v[32:35], a[224:231], v6
s_branch mega_kernel_rf_pc_12_2
.p2align 5
mega_kernel_rf_pc_13_2f:
s_mov_b64 exec, vcc
buffer_load_dwordx4 v[40:43], v7, s[84:87], s29 offen offset:2048 sc1
s_mov_b64 exec, -1
s_branch mega_kernel_rf_pc_13_3
mega_kernel_rf_il59:
s_cbranch_execz mega_kernel_rf_il60
.p2align 5
mega_kernel_rf_pc_13_2:
s_waitcnt vmcnt(2)
v_cmp_eq_u32 vcc, -1, v40
s_cbranch_vccnz mega_kernel_rf_pc_13_2f
v_smfmac_f32_16x16x64_bf16 v[96:99], v[40:43], a[208:215], v6
v_smfmac_f32_16x16x64_bf16 v[100:103], v[40:43], a[240:247], v6
s_branch mega_kernel_rf_pc_9_3
.p2align 5
mega_kernel_rf_pc_13_3f:
s_mov_b64 exec, vcc
buffer_load_dwordx4 v[44:47], v7, s[84:87], s29 offen offset:3072 sc1
s_mov_b64 exec, -1
s_branch mega_kernel_rf_pc_13_0
mega_kernel_rf_il60:
s_cbranch_execz mega_kernel_rf_il61
.p2align 5
mega_kernel_rf_pc_13_3:
s_waitcnt vmcnt(2)
v_cmp_eq_u32 vcc, -1, v44
s_cbranch_vccnz mega_kernel_rf_pc_13_3f
v_smfmac_f32_16x16x64_bf16 v[96:99], v[44:47], a[216:223], v6
v_smfmac_f32_16x16x64_bf16 v[100:103], v[44:47], a[248:255], v6
s_branch mega_kernel_rf_pc_5_0
.p2align 5
mega_kernel_rf_pc_14_1f:
s_mov_b64 exec, vcc
buffer_load_dwordx4 v[36:39], v7, s[84:87], s29 offen offset:1024 sc1
s_mov_b64 exec, -1
s_branch mega_kernel_rf_pc_14_2
mega_kernel_rf_il61:
s_cbranch_execz mega_kernel_rf_il62
.p2align 5
mega_kernel_rf_pc_14_2f:
s_mov_b64 exec, vcc
buffer_load_dwordx4 v[40:43], v7, s[84:87], s29 offen offset:2048 sc1
s_mov_b64 exec, -1
s_branch mega_kernel_rf_pc_14_3
.p2align 5
mega_kernel_rf_pc_14_2:
s_waitcnt vmcnt(2)
v_cmp_eq_u32 vcc, -1, v40
s_cbranch_vccnz mega_kernel_rf_pc_14_2f
v_smfmac_f32_16x16x64_bf16 v[96:99], v[40:43], a[208:215], v6
v_smfmac_f32_16x16x64_bf16 v[100:103], v[40:43], a[240:247], v6
s_branch mega_kernel_rf_pc_10_3
mega_kernel_rf_il62:
s_cbranch_execz mega_kernel_rf_il63
.p2align 5
mega_kernel_rf_pc_14_3f:
s_mov_b64 exec, vcc
buffer_load_dwordx4 v[44:47], v7, s[84:87], s29 offen offset:3072 sc1
s_mov_b64 exec, -1
s_branch mega_kernel_rf_pc_14_1
mega_kernel_rf_il63:
s_cbranch_execz mega_kernel_rf_il64
.p2align 5
mega_kernel_rf_pc_14_3:
s_waitcnt vmcnt(2)
v_cmp_eq_u32 vcc, -1, v44
s_cbranch_vccnz mega_kernel_rf_pc_14_3f
v_smfmac_f32_16x16x64_bf16 v[96:99], v[44:47], a[216:223], v6
v_smfmac_f32_16x16x64_bf16 v[100:103], v[44:47], a[248:255], v6
s_branch mega_kernel_rf_pc_6_1
.p2align 5
mega_kernel_rf_pc_15_0f:
s_mov_b64 exec, vcc
buffer_load_dwordx4 v[32:35], v7, s[84:87], s29 offen offset:0 sc1
s_mov_b64 exec, -1
s_branch mega_kernel_rf_pc_15_1
mega_kernel_rf_il64:
s_cbranch_execz mega_kernel_rf_il65
.p2align 5
mega_kernel_rf_pc_15_1f:
s_mov_b64 exec, vcc
buffer_load_dwordx4 v[36:39], v7, s[84:87], s29 offen offset:1024 sc1
s_mov_b64 exec, -1
s_branch mega_kernel_rf_pc_15_2
.p2align 5
mega_kernel_rf_pc_15_1:
s_waitcnt vmcnt(3)
v_cmp_eq_u32 vcc, -1, v36
s_cbranch_vccnz mega_kernel_rf_pc_15_1f
v_smfmac_f32_16x16x64_bf16 v[96:99], v[36:39], a[200:207], v6
v_smfmac_f32_16x16x64_bf16 v[100:103], v[36:39], a[232:239], v6
s_branch mega_kernel_rf_pc_13_2
mega_kernel_rf_il65:
s_cbranch_execz mega_kernel_rf_il66
.p2align 5
mega_kernel_rf_pc_15_2f:
s_mov_b64 exec, vcc
buffer_load_dwordx4 v[40:43], v7, s[84:87], s29 offen offset:2048 sc1
s_mov_b64 exec, -1
s_branch mega_kernel_rf_pc_15_3
mega_kernel_rf_il66:
s_cbranch_execz mega_kernel_rf_il67
.p2align 5
mega_kernel_rf_pc_15_2:
s_waitcnt vmcnt(3)
v_cmp_eq_u32 vcc, -1, v40
s_cbranch_vccnz mega_kernel_rf_pc_15_2f
v_smfmac_f32_16x16x64_bf16 v[96:99], v[40:43], a[208:215], v6
v_smfmac_f32_16x16x64_bf16 v[100:103], v[40:43], a[240:247], v6
s_branch mega_kernel_rf_pc_11_3
.p2align 5
mega_kernel_rf_pc_15_3f:
s_mov_b64 exec, vcc
buffer_load_dwordx4 v[44:47], v7, s[84:87], s29 offen offset:3072 sc1
s_mov_b64 exec, -1
s_branch mega_kernel_rf_pc_15_0
mega_kernel_rf_il67:
s_cbranch_execz mega_kernel_rf_il68
.p2align 5
mega_kernel_rf_pc_15_3:
s_waitcnt vmcnt(3)
v_cmp_eq_u32 vcc, -1, v44
s_cbranch_vccnz mega_kernel_rf_pc_15_3f
v_smfmac_f32_16x16x64_bf16 v[96:99], v[44:47], a[216:223], v6
v_smfmac_f32_16x16x64_bf16 v[100:103], v[44:47], a[248:255], v6
s_branch mega_kernel_rf_pc_7_0
mega_kernel_rf_w0last:
s_nop 7
v_permlane32_swap_b32 v112, v116
v_permlane32_swap_b32 v113, v117
v_permlane32_swap_b32 v114, v118
v_permlane32_swap_b32 v115, v119
v_pk_add_f32 v[112:113], v[112:113], v[116:117]
v_pk_add_f32 v[114:115], v[114:115], v[118:119]
ds_write_b128 v20, v[112:115]
s_waitcnt lgkmcnt(0)
s_barrier
s_branch mega_kernel_rf_end
mega_kernel_rf_il68:
s_cbranch_execz mega_kernel_rf_il69
mega_kernel_rf_side:
s_cmp_eq_u32 s24, 3
s_cbranch_scc1 mega_kernel_rf_sd3
s_cmp_eq_u32 s24, 2
s_cbranch_scc0 mega_kernel_rf_sd4
s_mov_b64 exec, s[40:41]
buffer_store_dwordx4 v[28:31], v11, s[84:87], s34 offen
s_mov_b64 exec, -1
buffer_store_dwordx2 v[28:29], v9, s[84:87], s34 offen
s_mul_i32 s28, s31, 1280
s_add_u32 s28, s28, s34
s_add_u32 s28, s28, 49152
buffer_store_dwordx4 v[28:31], v17, s[84:87], s28 offen
buffer_store_dwordx4 v[28:31], v10, s[84:87], s28 offen
s_branch mega_kernel_rf_sd4
mega_kernel_rf_il69:
s_cbranch_execz mega_kernel_rf_il70
mega_kernel_rf_sd3:
v_readlane_b32 s76, v249, 0
v_readlane_b32 s77, v249, 1
s_min_i32 s76, s76, s77
s_max_i32 s46, s46, s76
s_mov_b32 s36, 0
s_add_u32 s76, s27, 1
s_cmp_lt_u32 s76, 63
s_cbranch_scc0 mega_kernel_rf_sd4
s_cmp_ge_u32 s76, 0
s_cbranch_scc0 mega_kernel_rf_sd4
s_cmp_gt_i32 s46, s76
s_cselect_b32 s36, 0, 1
s_cbranch_scc0 mega_kernel_rf_sd4
s_add_u32 s77, s76, s82
s_bfe_u32 s28, s77, 0x40002
s_lshl_b32 s28, s28, 14
s_and_b32 s77, s77, 3
s_lshl_b32 s77, s77, 11
s_add_u32 s28, s28, s77
s_add_u32 m0, s45, 0
s_nop 0
buffer_load_dwordx4 v240, s[84:87], s28 offen offset:0 sc1 lds
s_add_u32 m0, s45, 0
s_nop 0
buffer_load_dwordx4 v240, s[84:87], s28 offen offset:1024 sc1 lds
s_add_u32 m0, s45, 2048
s_nop 0
buffer_load_dwordx4 v241, s[84:87], s28 offen offset:0 sc1 lds
s_add_u32 m0, s45, 2048
s_nop 0
buffer_load_dwordx4 v241, s[84:87], s28 offen offset:1024 sc1 lds
s_add_u32 s45, s45, 4096
s_cmp_eq_u32 s45, 30720
s_cselect_b32 s45, 18432, s45
mega_kernel_rf_sd4:
v_smfmac_f32_16x16x64_bf16 v[112:115], v[40:43], a[144:151], v6
v_smfmac_f32_16x16x64_bf16 v[116:119], v[40:43], a[176:183], v6
v_smfmac_f32_16x16x64_bf16 v[112:115], v[44:47], a[152:159], v6
v_smfmac_f32_16x16x64_bf16 v[116:119], v[44:47], a[184:191], v6
s_nop 7
v_permlane32_swap_b32 v112, v116
v_permlane32_swap_b32 v113, v117
v_permlane32_swap_b32 v114, v118
v_permlane32_swap_b32 v115, v119
v_pk_add_f32 v[112:113], v[112:113], v[116:117]
v_pk_add_f32 v[114:115], v[114:115], v[118:119]
ds_write_b128 v20, v[112:115]
v_mov_b32 v96, 0
v_mov_b32 v97, 0
v_mov_b32 v98, 0
v_mov_b32 v99, 0
v_mov_b32 v100, 0
v_mov_b32 v101, 0
v_mov_b32 v102, 0
v_mov_b32 v103, 0
s_cmp_eq_u32 s24, 1
s_cbranch_scc0 mega_kernel_rf_s1
s_waitcnt lgkmcnt(0)
ds_read_b128 v[120:123], v16 offset:0
ds_read_b128 v[124:127], v16 offset:16
ds_read_b128 v[128:131], v16 offset:2304
ds_read_b128 v[132:135], v16 offset:2320
ds_read_b128 v[136:139], v16 offset:4608
ds_read_b128 v[140:143], v16 offset:4624
ds_read_b128 v[144:147], v16 offset:6912
ds_read_b128 v[148:151], v16 offset:6928
s_waitcnt lgkmcnt(4)
v_pk_add_f32 v[120:121], v[120:121], v[128:129]
v_pk_add_f32 v[122:123], v[122:123], v[130:131]
v_pk_add_f32 v[124:125], v[124:125], v[132:133]
v_pk_add_f32 v[126:127], v[126:127], v[134:135]
s_waitcnt lgkmcnt(0)
v_pk_add_f32 v[136:137], v[136:137], v[144:145]
v_pk_add_f32 v[138:139], v[138:139], v[146:147]
v_pk_add_f32 v[140:141], v[140:141], v[148:149]
v_pk_add_f32 v[142:143], v[142:143], v[150:151]
v_pk_add_f32 v[120:121], v[120:121], v[136:137]
v_pk_add_f32 v[122:123], v[122:123], v[138:139]
v_pk_add_f32 v[124:125], v[124:125], v[140:141]
v_pk_add_f32 v[126:127], v[126:127], v[142:143]
v_cvt_pk_bf16_f32 v244, v120, v121
v_cvt_pk_bf16_f32 v245, v122, v123
v_cvt_pk_bf16_f32 v246, v124, v125
v_cvt_pk_bf16_f32 v247, v126, v127
mega_kernel_rf_s1:
v_add_u32 v5, 9216, v17
s_waitcnt lgkmcnt(0)
s_barrier
s_cmp_eq_u32 s24, 2
s_cbranch_scc1 mega_kernel_rf_s2
s_cmp_eq_u32 s24, 3
s_cbranch_scc0 mega_kernel_rf_s3
s_add_u32 s76, s27, 2
s_cmp_lt_u32 s76, 63
s_cbranch_scc0 mega_kernel_rf_s3
s_cmp_gt_i32 s46, s76
s_cbranch_scc0 mega_kernel_rf_s3
s_add_u32 s77, s76, s82
s_bfe_u32 s28, s77, 0x40002
s_lshl_b32 s28, s28, 14
s_and_b32 s77, s77, 3
s_lshl_b32 s77, s77, 11
s_add_u32 s28, s28, s77
s_add_u32 s28, s28, s83
s_buffer_load_dword s78, s[84:87], s28 offset:0
s_buffer_load_dword s78, s[84:87], s28 offset:128
s_buffer_load_dword s78, s[84:87], s28 offset:256
s_buffer_load_dword s78, s[84:87], s28 offset:384
s_buffer_load_dword s78, s[84:87], s28 offset:512
s_buffer_load_dword s78, s[84:87], s28 offset:640
s_buffer_load_dword s78, s[84:87], s28 offset:768
s_buffer_load_dword s78, s[84:87], s28 offset:896
s_buffer_load_dword s78, s[84:87], s28 offset:1024
s_buffer_load_dword s78, s[84:87], s28 offset:1152
s_buffer_load_dword s78, s[84:87], s28 offset:1280
s_buffer_load_dword s78, s[84:87], s28 offset:1408
s_buffer_load_dword s78, s[84:87], s28 offset:1536
s_buffer_load_dword s78, s[84:87], s28 offset:1664
s_buffer_load_dword s78, s[84:87], s28 offset:1792
s_buffer_load_dword s78, s[84:87], s28 offset:1920
s_mov_b32 s88, s76
s_branch mega_kernel_rf_s3
mega_kernel_rf_il70:
s_cbranch_execz mega_kernel_rf_il71
mega_kernel_rf_s2:
ds_read_b128 v[120:123], v5 offset:0
ds_read_b128 v[124:127], v5 offset:1024
ds_read_b128 v[128:131], v5 offset:2048
ds_read_b128 v[132:135], v5 offset:3072
v_lshrrev_b32 v5, 1, v17
s_waitcnt lgkmcnt(2)
v_pk_add_f32 v[120:121], v[120:121], v[124:125]
v_pk_add_f32 v[122:123], v[122:123], v[126:127]
s_waitcnt lgkmcnt(0)
v_pk_add_f32 v[128:129], v[128:129], v[132:133]
v_pk_add_f32 v[130:131], v[130:131], v[134:135]
v_pk_add_f32 v[120:121], v[120:121], v[128:129]
v_pk_add_f32 v[122:123], v[122:123], v[130:131]
v_cvt_pk_bf16_f32 v244, v120, v121
v_cvt_pk_bf16_f32 v245, v122, v123
ds_write_b64 v5, v[244:245] offset:17920
s_waitcnt lgkmcnt(0) vmcnt(0)
mega_kernel_rf_s3:
s_cmp_eq_u32 s27, 63
s_cbranch_scc1 mega_kernel_rf_slast
s_add_u32 s29, s33, 24576
s_barrier
s_cmp_eq_u32 s24, 3
s_cbranch_scc1 mega_kernel_rf_y3
s_add_u32 s77, s27, s82
s_bfe_u32 s28, s77, 0x30003
s_lshl_b32 s28, s28, 14
s_and_b32 s77, s77, 7
s_lshl_b32 s77, s77, 10
s_add_u32 s28, s28, s77
s_add_u32 s28, s28, s79
s_cmp_eq_u32 s24, 2
s_cbranch_scc1 mega_kernel_rf_kv2a
s_mov_b64 exec, s[48:49]
buffer_store_dwordx4 v[244:247], v22, s[84:87], s28 offen sc1
s_mov_b64 exec, -1
s_branch mega_kernel_rf_kvda
mega_kernel_rf_il71:
s_cbranch_execz mega_kernel_rf_il72
mega_kernel_rf_kv2a:
v_lshlrev_b32 v4, 3, v1
buffer_store_dwordx2 v[244:245], v4, s[84:87], s28 offen offset:512 sc1
mega_kernel_rf_kvda:
s_branch mega_kernel_rf_y4
mega_kernel_rf_y3:
s_add_u32 s76, s27, 2
s_cmp_lt_u32 s76, 63
s_cbranch_scc0 mega_kernel_rf_y4
mega_kernel_rf_y4:
s_branch mega_kernel_rf_b3
mega_kernel_rf_first:
v_add_u32 v5, s44, v17
ds_read_b128 v[156:159], v5 offset:0
ds_read_b128 v[160:163], v5 offset:1024
ds_read_b128 v[164:167], v5 offset:2048
ds_read_b128 v[168:171], v5 offset:3072
s_branch mega_kernel_rf_adone
mega_kernel_rf_il72:
s_cbranch_execz mega_kernel_rf_il73
mega_kernel_rf_slast:
s_cmp_eq_u32 s24, 3
s_cbranch_scc1 mega_kernel_rf_end
s_add_u32 s77, s27, s82
s_bfe_u32 s28, s77, 0x30003
s_lshl_b32 s28, s28, 14
s_and_b32 s77, s77, 7
s_lshl_b32 s77, s77, 10
s_add_u32 s28, s28, s77
s_add_u32 s28, s28, s79
s_cmp_eq_u32 s24, 2
s_cbranch_scc1 mega_kernel_rf_kv2b
s_mov_b64 exec, s[48:49]
buffer_store_dwordx4 v[244:247], v22, s[84:87], s28 offen sc1
s_mov_b64 exec, -1
s_branch mega_kernel_rf_kvdb
mega_kernel_rf_il73:
s_cbranch_execz mega_kernel_rf_iwd
mega_kernel_rf_kv2b:
v_lshlrev_b32 v4, 3, v1
buffer_store_dwordx2 v[244:245], v4, s[84:87], s28 offen offset:512 sc1
mega_kernel_rf_kvdb:
s_waitcnt vmcnt(0)
s_barrier
s_mov_b32 s76, 64
s_cmp_eq_u32 s24, 1
s_cbranch_scc0 mega_kernel_rf_end
v_mov_b32 v5, s76
s_mov_b64 exec, 1
buffer_store_dword v5, v228, s[84:87], s81 offen sc1
s_mov_b64 exec, -1
mega_kernel_rf_end:
s_endpgm
mega_kernel_recs:
s_load_dwordx2 s[20:21], s[0:1], 8
s_load_dwordx2 s[16:17], s[0:1], 40
s_load_dwordx2 s[4:5], s[0:1], 16
s_load_dwordx2 s[8:9], s[0:1], 24
s_load_dwordx2 s[12:13], s[0:1], 32
v_lshrrev_b32 v4, 6, v0
v_and_b32 v1, 63, v0
v_readfirstlane_b32 s24, v4
v_lshrrev_b32 v2, 4, v1
v_and_b32 v3, 15, v1
v_lshlrev_b32 v17, 4, v1
s_lshr_b32 s28, s31, 2
s_lshl_b32 s25, s30, 3
s_add_u32 s25, s25, s28
s_and_b32 s26, s31, 3
s_waitcnt lgkmcnt(0)
s_mov_b32 s22, 16384
s_mov_b32 s23, 0x00020000
s_mov_b32 s18, 8388608
s_mov_b32 s19, 0x00020000
s_mov_b32 s6, 8388608
s_mov_b32 s7, 0x00020000
s_mov_b32 s10, 8388608
s_mov_b32 s11, 0x00020000
s_mov_b32 s14, 8388608
s_mov_b32 s15, 0x00020000
s_lshl_b32 s28, s25, 8
s_lshr_b32 s29, s26, 0
s_lshl_b32 s29, s29, 6
s_add_u32 s28, s28, s29
s_lshl_b32 s29, s24, 21
s_add_u32 s28, s28, s29
v_lshrrev_b32 v4, 2, v1
v_and_b32 v5, 3, v1
v_lshlrev_b32 v40, 13, v4
v_lshl_add_u32 v40, v5, 4, v40
v_add_u32 v40, s28, v40
s_lshl_b32 s28, s30, 21
s_lshl_b32 s29, s24, 19
s_add_u32 s28, s28, s29
s_lshr_b32 s29, s31, 0
s_lshl_b32 s29, s29, 6
s_add_u32 s28, s28, s29
v_lshlrev_b32 v41, 11, v4
v_lshl_add_u32 v41, v5, 4, v41
v_add_u32 v41, s28, v41
s_lshl_b32 s47, s24, 15
s_add_u32 s47, s47, 32768
s_lshl_b32 s28, s31, 18
s_lshl_b32 s29, s24, 16
s_add_u32 s28, s28, s29
s_lshl_b32 s29, s30, 11
s_add_u32 s28, s28, s29
v_lshlrev_b32 v48, 13, v2
v_lshl_add_u32 v48, v3, 7, v48
v_add_u32 v48, s28, v48
s_lshl_b32 s28, s30, 21
s_lshl_b32 s29, s31, 16
s_add_u32 s28, s28, s29
s_lshl_b32 s29, s24, 14
s_add_u32 s28, s28, s29
v_lshlrev_b32 v49, 7, v1
v_add_u32 v49, s28, v49
s_and_b32 s76, s31, 1
s_mul_i32 s76, s76, 8
s_and_b32 s28, s31, 15
s_lshl_b32 s28, s28, 4
s_lshl_b32 s29, s24, 8
s_add_u32 s28, s28, s29
v_add_u32 v53, s28, v3
s_lshr_b32 s28, s31, 4
s_lshl_b32 s28, s28, 10
s_add_u32 s28, s28, 384
v_mov_b32 v54, s28
v_mov_b32 v55, 1920
v_cmp_gt_u32 vcc, 32, v1
s_nop 1
v_cndmask_b32 v54, v55, v54, vcc
s_lshl_b32 s29, s30, 11
v_lshl_add_u32 v51, v53, 13, v54
v_add_u32 v51, s29, v51
s_lshl_b32 s29, s30, 21
v_lshl_add_u32 v52, v53, 11, v54
v_add_u32 v52, s29, v52
buffer_load_dword v50, v51, s[8:11], 0 offen
s_xor_b32 s29, s76, 0
s_lshl_b32 s28, s29, 10
s_add_u32 s28, s28, s47
s_add_u32 m0, s28, 0
s_lshl_b32 s29, s29, 17
buffer_load_dwordx4 v40, s[8:11], s29 offen lds
s_xor_b32 s29, s76, 1
s_lshl_b32 s28, s29, 10
s_add_u32 s28, s28, s47
s_add_u32 m0, s28, 0
s_lshl_b32 s29, s29, 17
buffer_load_dwordx4 v40, s[8:11], s29 offen lds
s_xor_b32 s29, s76, 2
s_lshl_b32 s28, s29, 10
s_add_u32 s28, s28, s47
s_add_u32 m0, s28, 0
s_lshl_b32 s29, s29, 17
buffer_load_dwordx4 v40, s[8:11], s29 offen lds
s_xor_b32 s29, s76, 3
s_lshl_b32 s28, s29, 10
s_add_u32 s28, s28, s47
s_add_u32 m0, s28, 0
s_lshl_b32 s29, s29, 17
buffer_load_dwordx4 v40, s[8:11], s29 offen lds
s_xor_b32 s29, s76, 4
s_lshl_b32 s28, s29, 10
s_add_u32 s28, s28, s47
s_add_u32 m0, s28, 0
s_lshl_b32 s29, s29, 17
buffer_load_dwordx4 v40, s[8:11], s29 offen lds
s_xor_b32 s29, s76, 5
s_lshl_b32 s28, s29, 10
s_add_u32 s28, s28, s47
s_add_u32 m0, s28, 0
s_lshl_b32 s29, s29, 17
buffer_load_dwordx4 v40, s[8:11], s29 offen lds
s_xor_b32 s29, s76, 6
s_lshl_b32 s28, s29, 10
s_add_u32 s28, s28, s47
s_add_u32 m0, s28, 0
s_lshl_b32 s29, s29, 17
buffer_load_dwordx4 v40, s[8:11], s29 offen lds
s_xor_b32 s29, s76, 7
s_lshl_b32 s28, s29, 10
s_add_u32 s28, s28, s47
s_add_u32 m0, s28, 0
s_lshl_b32 s29, s29, 17
buffer_load_dwordx4 v40, s[8:11], s29 offen lds
s_xor_b32 s29, s76, 8
s_lshl_b32 s28, s29, 10
s_add_u32 s28, s28, s47
s_add_u32 m0, s28, 0
s_lshl_b32 s29, s29, 17
buffer_load_dwordx4 v40, s[8:11], s29 offen lds
s_xor_b32 s29, s76, 9
s_lshl_b32 s28, s29, 10
s_add_u32 s28, s28, s47
s_add_u32 m0, s28, 0
s_lshl_b32 s29, s29, 17
buffer_load_dwordx4 v40, s[8:11], s29 offen lds
s_xor_b32 s29, s76, 10
s_lshl_b32 s28, s29, 10
s_add_u32 s28, s28, s47
s_add_u32 m0, s28, 0
s_lshl_b32 s29, s29, 17
buffer_load_dwordx4 v40, s[8:11], s29 offen lds
s_xor_b32 s29, s76, 11
s_lshl_b32 s28, s29, 10
s_add_u32 s28, s28, s47
s_add_u32 m0, s28, 0
s_lshl_b32 s29, s29, 17
buffer_load_dwordx4 v40, s[8:11], s29 offen lds
s_xor_b32 s29, s76, 12
s_lshl_b32 s28, s29, 10
s_add_u32 s28, s28, s47
s_add_u32 m0, s28, 0
s_lshl_b32 s29, s29, 17
buffer_load_dwordx4 v40, s[8:11], s29 offen lds
s_xor_b32 s29, s76, 13
s_lshl_b32 s28, s29, 10
s_add_u32 s28, s28, s47
s_add_u32 m0, s28, 0
s_lshl_b32 s29, s29, 17
buffer_load_dwordx4 v40, s[8:11], s29 offen lds
s_xor_b32 s29, s76, 14
s_lshl_b32 s28, s29, 10
s_add_u32 s28, s28, s47
s_add_u32 m0, s28, 0
s_lshl_b32 s29, s29, 17
buffer_load_dwordx4 v40, s[8:11], s29 offen lds
s_xor_b32 s29, s76, 15
s_lshl_b32 s28, s29, 10
s_add_u32 s28, s28, s47
s_add_u32 m0, s28, 0
s_lshl_b32 s29, s29, 17
buffer_load_dwordx4 v40, s[8:11], s29 offen lds
buffer_load_dword v50, v51, s[12:15], 0 offen
s_xor_b32 s29, s76, 0
s_lshl_b32 s28, s29, 10
s_add_u32 s28, s28, s47
s_add_u32 m0, s28, 16384
s_lshl_b32 s29, s29, 17
buffer_load_dwordx4 v40, s[12:15], s29 offen lds
s_xor_b32 s29, s76, 1
s_lshl_b32 s28, s29, 10
s_add_u32 s28, s28, s47
s_add_u32 m0, s28, 16384
s_lshl_b32 s29, s29, 17
buffer_load_dwordx4 v40, s[12:15], s29 offen lds
s_xor_b32 s29, s76, 2
s_lshl_b32 s28, s29, 10
s_add_u32 s28, s28, s47
s_add_u32 m0, s28, 16384
s_lshl_b32 s29, s29, 17
buffer_load_dwordx4 v40, s[12:15], s29 offen lds
s_xor_b32 s29, s76, 3
s_lshl_b32 s28, s29, 10
s_add_u32 s28, s28, s47
s_add_u32 m0, s28, 16384
s_lshl_b32 s29, s29, 17
buffer_load_dwordx4 v40, s[12:15], s29 offen lds
s_xor_b32 s29, s76, 4
s_lshl_b32 s28, s29, 10
s_add_u32 s28, s28, s47
s_add_u32 m0, s28, 16384
s_lshl_b32 s29, s29, 17
buffer_load_dwordx4 v40, s[12:15], s29 offen lds
s_xor_b32 s29, s76, 5
s_lshl_b32 s28, s29, 10
s_add_u32 s28, s28, s47
s_add_u32 m0, s28, 16384
s_lshl_b32 s29, s29, 17
buffer_load_dwordx4 v40, s[12:15], s29 offen lds
s_xor_b32 s29, s76, 6
s_lshl_b32 s28, s29, 10
s_add_u32 s28, s28, s47
s_add_u32 m0, s28, 16384
s_lshl_b32 s29, s29, 17
buffer_load_dwordx4 v40, s[12:15], s29 offen lds
s_xor_b32 s29, s76, 7
s_lshl_b32 s28, s29, 10
s_add_u32 s28, s28, s47
s_add_u32 m0, s28, 16384
s_lshl_b32 s29, s29, 17
buffer_load_dwordx4 v40, s[12:15], s29 offen lds
s_xor_b32 s29, s76, 8
s_lshl_b32 s28, s29, 10
s_add_u32 s28, s28, s47
s_add_u32 m0, s28, 16384
s_lshl_b32 s29, s29, 17
buffer_load_dwordx4 v40, s[12:15], s29 offen lds
s_xor_b32 s29, s76, 9
s_lshl_b32 s28, s29, 10
s_add_u32 s28, s28, s47
s_add_u32 m0, s28, 16384
s_lshl_b32 s29, s29, 17
buffer_load_dwordx4 v40, s[12:15], s29 offen lds
s_xor_b32 s29, s76, 10
s_lshl_b32 s28, s29, 10
s_add_u32 s28, s28, s47
s_add_u32 m0, s28, 16384
s_lshl_b32 s29, s29, 17
buffer_load_dwordx4 v40, s[12:15], s29 offen lds
s_xor_b32 s29, s76, 11
s_lshl_b32 s28, s29, 10
s_add_u32 s28, s28, s47
s_add_u32 m0, s28, 16384
s_lshl_b32 s29, s29, 17
buffer_load_dwordx4 v40, s[12:15], s29 offen lds
s_xor_b32 s29, s76, 12
s_lshl_b32 s28, s29, 10
s_add_u32 s28, s28, s47
s_add_u32 m0, s28, 16384
s_lshl_b32 s29, s29, 17
buffer_load_dwordx4 v40, s[12:15], s29 offen lds
s_xor_b32 s29, s76, 13
s_lshl_b32 s28, s29, 10
s_add_u32 s28, s28, s47
s_add_u32 m0, s28, 16384
s_lshl_b32 s29, s29, 17
buffer_load_dwordx4 v40, s[12:15], s29 offen lds
s_xor_b32 s29, s76, 14
s_lshl_b32 s28, s29, 10
s_add_u32 s28, s28, s47
s_add_u32 m0, s28, 16384
s_lshl_b32 s29, s29, 17
buffer_load_dwordx4 v40, s[12:15], s29 offen lds
s_xor_b32 s29, s76, 15
s_lshl_b32 s28, s29, 10
s_add_u32 s28, s28, s47
s_add_u32 m0, s28, 16384
s_lshl_b32 s29, s29, 17
buffer_load_dwordx4 v40, s[12:15], s29 offen lds
s_mov_b32 s40, 0x00ff00ff
s_mov_b32 s41, 0x00ff00ff
s_mov_b32 s48, 0xff00ff00
s_mov_b32 s49, 0xff00ff00
s_mov_b32 s42, 0
s_mov_b32 s43, 0x00ff00ff
s_mov_b32 s32, 0x3e0293ee
v_mov_b32 v23, 0xff800000
v_mov_b32 v6, 0x4444
v_mov_b32 v4, 0xeeee
v_cndmask_b32 v6, v6, v4, s[48:49]
v_mov_b32 v28, -1
v_mov_b32 v29, -1
v_mov_b32 v30, -1
v_mov_b32 v31, -1
s_mul_i32 s28, s24, 4096
v_add_u32 v7, s28, v17
v_and_b32 v4, 7, v1
v_lshlrev_b32 v8, 11, v4
v_lshrrev_b32 v5, 3, v1
v_lshl_add_u32 v8, v5, 4, v8
s_lshl_b32 s28, s24, 9
v_add_u32 v8, s28, v8
s_lshl_b32 s28, s31, 9
s_lshr_b32 s29, s31, 3
s_mul_i32 s29, s29, 0
s_add_u32 s28, s28, s29
v_lshlrev_b32 v9, 3, v1
v_add_u32 v9, s28, v9
v_and_b32 v4, 7, v3
v_lshlrev_b32 v11, 7, v2
v_lshl_add_u32 v11, v4, 4, v11
v_add_u32 v22, 0, v11
s_add_u32 s28, s28, 24576
v_add_u32 v11, s28, v11
v_and_b32 v5, 1, v2
v_lshlrev_b32 v10, 7, v5
v_lshl_add_u32 v10, v4, 4, v10
v_add_u32 v10, 1024, v10
s_xor_b32 s37, s31, 1
s_mul_i32 s37, s37, 1280
s_add_u32 s37, s37, 49152
s_xor_b32 s38, s31, 2
s_mul_i32 s38, s38, 1280
s_add_u32 s38, s38, 49152
s_xor_b32 s39, s31, 3
s_mul_i32 s39, s39, 1280
s_add_u32 s39, s39, 49152
v_and_b32 v4, 1, v2
v_mul_u32_u24 v14, 576, v4
v_lshrrev_b32 v5, 1, v2
v_lshl_add_u32 v5, v5, 4, v3
v_lshl_add_u32 v14, v5, 2, v14
s_mul_i32 s28, s24, 1152
s_add_u32 s28, s28, 13312
v_add_u32 v18, s28, v14
s_mul_i32 s28, s24, 2304
v_add_u32 v14, s28, v14
v_add_u32 v15, 1152, v14
v_mul_u32_u24 v16, 144, v3
v_lshl_add_u32 v16, v2, 5, v16
v_bfe_u32 v4, v1, 1, 3
v_mul_u32_u24 v19, 144, v4
v_lshl_add_u32 v19, v2, 5, v19
v_and_b32 v4, 1, v1
v_lshl_add_u32 v19, v4, 4, v19
v_add_u32 v19, 13312, v19
s_lshl_b32 s28, s24, 10
s_add_u32 s28, s28, 9216
v_add_u32 v20, s28, v17
v_and_b32 v4, 31, v1
v_lshlrev_b32 v21, 3, v4
v_add_u32 v21, 17920, v21
v_lshrrev_b32 v4, 2, v3
v_and_b32 v42, 1, v4
v_lshrrev_b32 v43, 1, v4
v_lshrrev_b32 v44, 1, v2
v_and_b32 v45, 1, v2
v_lshl_add_u32 v46, v44, 4, v42
v_lshl_add_u32 v46, v45, 2, v46
v_lshl_add_u32 v46, v43, 3, v46
v_lshl_add_u32 v47, v44, 3, v42
v_lshl_add_u32 v47, v45, 4, v47
v_lshl_add_u32 v47, v43, 2, v47
v_and_b32 v5, 3, v3
v_lshlrev_b32 v5, 3, v5
v_lshl_add_u32 v46, v46, 6, v5
v_lshl_add_u32 v47, v47, 6, v5
s_and_b32 s28, s31, 0
s_lshl_b32 s28, s28, 6
s_add_u32 s28, s28, s47
v_add_u32 v46, s28, v46
v_add_u32 v47, s28, v47
s_waitcnt vmcnt(17)
ds_read_b64_tr_b16 a[64:65], v46 offset:0
ds_read_b64_tr_b16 a[66:67], v46 offset:128
ds_read_b64_tr_b16 a[68:69], v46 offset:2048
ds_read_b64_tr_b16 a[70:71], v46 offset:2176
ds_read_b64_tr_b16 a[72:73], v46 offset:4096
ds_read_b64_tr_b16 a[74:75], v46 offset:4224
ds_read_b64_tr_b16 a[76:77], v46 offset:6144
ds_read_b64_tr_b16 a[78:79], v46 offset:6272
s_waitcnt lgkmcnt(0)
ds_read_b64_tr_b16 a[80:81], v46 offset:8192
ds_read_b64_tr_b16 a[82:83], v46 offset:8320
ds_read_b64_tr_b16 a[84:85], v46 offset:10240
ds_read_b64_tr_b16 a[86:87], v46 offset:10368
ds_read_b64_tr_b16 a[88:89], v46 offset:12288
ds_read_b64_tr_b16 a[90:91], v46 offset:12416
ds_read_b64_tr_b16 a[92:93], v46 offset:14336
ds_read_b64_tr_b16 a[94:95], v46 offset:14464
s_waitcnt lgkmcnt(0)
ds_read_b64_tr_b16 a[96:97], v46 offset:32
ds_read_b64_tr_b16 a[98:99], v46 offset:160
ds_read_b64_tr_b16 a[100:101], v46 offset:2080
ds_read_b64_tr_b16 a[102:103], v46 offset:2208
ds_read_b64_tr_b16 a[104:105], v46 offset:4128
ds_read_b64_tr_b16 a[106:107], v46 offset:4256
ds_read_b64_tr_b16 a[108:109], v46 offset:6176
ds_read_b64_tr_b16 a[110:111], v46 offset:6304
s_waitcnt lgkmcnt(0)
ds_read_b64_tr_b16 a[112:113], v46 offset:8224
ds_read_b64_tr_b16 a[114:115], v46 offset:8352
ds_read_b64_tr_b16 a[116:117], v46 offset:10272
ds_read_b64_tr_b16 a[118:119], v46 offset:10400
ds_read_b64_tr_b16 a[120:121], v46 offset:12320
ds_read_b64_tr_b16 a[122:123], v46 offset:12448
ds_read_b64_tr_b16 a[124:125], v46 offset:14368
ds_read_b64_tr_b16 a[126:127], v46 offset:14496
s_waitcnt lgkmcnt(0)
buffer_load_dword v50, v51, s[4:7], 0 offen
s_xor_b32 s29, s76, 0
s_lshl_b32 s28, s29, 10
s_add_u32 s28, s28, s47
s_add_u32 m0, s28, 0
s_lshl_b32 s29, s29, 17
buffer_load_dwordx4 v40, s[4:7], s29 offen lds
s_xor_b32 s29, s76, 1
s_lshl_b32 s28, s29, 10
s_add_u32 s28, s28, s47
s_add_u32 m0, s28, 0
s_lshl_b32 s29, s29, 17
buffer_load_dwordx4 v40, s[4:7], s29 offen lds
s_xor_b32 s29, s76, 2
s_lshl_b32 s28, s29, 10
s_add_u32 s28, s28, s47
s_add_u32 m0, s28, 0
s_lshl_b32 s29, s29, 17
buffer_load_dwordx4 v40, s[4:7], s29 offen lds
s_xor_b32 s29, s76, 3
s_lshl_b32 s28, s29, 10
s_add_u32 s28, s28, s47
s_add_u32 m0, s28, 0
s_lshl_b32 s29, s29, 17
buffer_load_dwordx4 v40, s[4:7], s29 offen lds
s_xor_b32 s29, s76, 4
s_lshl_b32 s28, s29, 10
s_add_u32 s28, s28, s47
s_add_u32 m0, s28, 0
s_lshl_b32 s29, s29, 17
buffer_load_dwordx4 v40, s[4:7], s29 offen lds
s_xor_b32 s29, s76, 5
s_lshl_b32 s28, s29, 10
s_add_u32 s28, s28, s47
s_add_u32 m0, s28, 0
s_lshl_b32 s29, s29, 17
buffer_load_dwordx4 v40, s[4:7], s29 offen lds
s_xor_b32 s29, s76, 6
s_lshl_b32 s28, s29, 10
s_add_u32 s28, s28, s47
s_add_u32 m0, s28, 0
s_lshl_b32 s29, s29, 17
buffer_load_dwordx4 v40, s[4:7], s29 offen lds
s_xor_b32 s29, s76, 7
s_lshl_b32 s28, s29, 10
s_add_u32 s28, s28, s47
s_add_u32 m0, s28, 0
s_lshl_b32 s29, s29, 17
buffer_load_dwordx4 v40, s[4:7], s29 offen lds
s_xor_b32 s29, s76, 8
s_lshl_b32 s28, s29, 10
s_add_u32 s28, s28, s47
s_add_u32 m0, s28, 0
s_lshl_b32 s29, s29, 17
buffer_load_dwordx4 v40, s[4:7], s29 offen lds
s_xor_b32 s29, s76, 9
s_lshl_b32 s28, s29, 10
s_add_u32 s28, s28, s47
s_add_u32 m0, s28, 0
s_lshl_b32 s29, s29, 17
buffer_load_dwordx4 v40, s[4:7], s29 offen lds
s_xor_b32 s29, s76, 10
s_lshl_b32 s28, s29, 10
s_add_u32 s28, s28, s47
s_add_u32 m0, s28, 0
s_lshl_b32 s29, s29, 17
buffer_load_dwordx4 v40, s[4:7], s29 offen lds
s_xor_b32 s29, s76, 11
s_lshl_b32 s28, s29, 10
s_add_u32 s28, s28, s47
s_add_u32 m0, s28, 0
s_lshl_b32 s29, s29, 17
buffer_load_dwordx4 v40, s[4:7], s29 offen lds
s_xor_b32 s29, s76, 12
s_lshl_b32 s28, s29, 10
s_add_u32 s28, s28, s47
s_add_u32 m0, s28, 0
s_lshl_b32 s29, s29, 17
buffer_load_dwordx4 v40, s[4:7], s29 offen lds
s_xor_b32 s29, s76, 13
s_lshl_b32 s28, s29, 10
s_add_u32 s28, s28, s47
s_add_u32 m0, s28, 0
s_lshl_b32 s29, s29, 17
buffer_load_dwordx4 v40, s[4:7], s29 offen lds
s_xor_b32 s29, s76, 14
s_lshl_b32 s28, s29, 10
s_add_u32 s28, s28, s47
s_add_u32 m0, s28, 0
s_lshl_b32 s29, s29, 17
buffer_load_dwordx4 v40, s[4:7], s29 offen lds
s_xor_b32 s29, s76, 15
s_lshl_b32 s28, s29, 10
s_add_u32 s28, s28, s47
s_add_u32 m0, s28, 0
s_lshl_b32 s29, s29, 17
buffer_load_dwordx4 v40, s[4:7], s29 offen lds
s_waitcnt vmcnt(17)
ds_read_b64_tr_b16 a[128:129], v46 offset:16384
ds_read_b64_tr_b16 a[130:131], v46 offset:16512
ds_read_b64_tr_b16 a[132:133], v46 offset:18432
ds_read_b64_tr_b16 a[134:135], v46 offset:18560
ds_read_b64_tr_b16 a[136:137], v46 offset:20480
ds_read_b64_tr_b16 a[138:139], v46 offset:20608
ds_read_b64_tr_b16 a[140:141], v46 offset:22528
ds_read_b64_tr_b16 a[142:143], v46 offset:22656
s_waitcnt lgkmcnt(0)
ds_read_b64_tr_b16 a[144:145], v46 offset:24576
ds_read_b64_tr_b16 a[146:147], v46 offset:24704
ds_read_b64_tr_b16 a[148:149], v46 offset:26624
ds_read_b64_tr_b16 a[150:151], v46 offset:26752
ds_read_b64_tr_b16 a[152:153], v46 offset:28672
ds_read_b64_tr_b16 a[154:155], v46 offset:28800
ds_read_b64_tr_b16 a[156:157], v46 offset:30720
ds_read_b64_tr_b16 a[158:159], v46 offset:30848
s_waitcnt lgkmcnt(0)
ds_read_b64_tr_b16 a[160:161], v46 offset:16416
ds_read_b64_tr_b16 a[162:163], v46 offset:16544
ds_read_b64_tr_b16 a[164:165], v46 offset:18464
ds_read_b64_tr_b16 a[166:167], v46 offset:18592
ds_read_b64_tr_b16 a[168:169], v46 offset:20512
ds_read_b64_tr_b16 a[170:171], v46 offset:20640
ds_read_b64_tr_b16 a[172:173], v46 offset:22560
ds_read_b64_tr_b16 a[174:175], v46 offset:22688
s_waitcnt lgkmcnt(0)
ds_read_b64_tr_b16 a[176:177], v46 offset:24608
ds_read_b64_tr_b16 a[178:179], v46 offset:24736
ds_read_b64_tr_b16 a[180:181], v46 offset:26656
ds_read_b64_tr_b16 a[182:183], v46 offset:26784
ds_read_b64_tr_b16 a[184:185], v46 offset:28704
ds_read_b64_tr_b16 a[186:187], v46 offset:28832
ds_read_b64_tr_b16 a[188:189], v46 offset:30752
ds_read_b64_tr_b16 a[190:191], v46 offset:30880
s_waitcnt lgkmcnt(0)
buffer_load_dword v50, v52, s[16:19], 0 offen
s_xor_b32 s29, s76, 0
s_lshl_b32 s28, s29, 10
s_add_u32 s28, s28, s47
s_add_u32 m0, s28, 16384
s_lshl_b32 s29, s29, 15
buffer_load_dwordx4 v41, s[16:19], s29 offen lds
s_xor_b32 s29, s76, 1
s_lshl_b32 s28, s29, 10
s_add_u32 s28, s28, s47
s_add_u32 m0, s28, 16384
s_lshl_b32 s29, s29, 15
buffer_load_dwordx4 v41, s[16:19], s29 offen lds
s_xor_b32 s29, s76, 2
s_lshl_b32 s28, s29, 10
s_add_u32 s28, s28, s47
s_add_u32 m0, s28, 16384
s_lshl_b32 s29, s29, 15
buffer_load_dwordx4 v41, s[16:19], s29 offen lds
s_xor_b32 s29, s76, 3
s_lshl_b32 s28, s29, 10
s_add_u32 s28, s28, s47
s_add_u32 m0, s28, 16384
s_lshl_b32 s29, s29, 15
buffer_load_dwordx4 v41, s[16:19], s29 offen lds
s_xor_b32 s29, s76, 4
s_lshl_b32 s28, s29, 10
s_add_u32 s28, s28, s47
s_add_u32 m0, s28, 16384
s_lshl_b32 s29, s29, 15
buffer_load_dwordx4 v41, s[16:19], s29 offen lds
s_xor_b32 s29, s76, 5
s_lshl_b32 s28, s29, 10
s_add_u32 s28, s28, s47
s_add_u32 m0, s28, 16384
s_lshl_b32 s29, s29, 15
buffer_load_dwordx4 v41, s[16:19], s29 offen lds
s_xor_b32 s29, s76, 6
s_lshl_b32 s28, s29, 10
s_add_u32 s28, s28, s47
s_add_u32 m0, s28, 16384
s_lshl_b32 s29, s29, 15
buffer_load_dwordx4 v41, s[16:19], s29 offen lds
s_xor_b32 s29, s76, 7
s_lshl_b32 s28, s29, 10
s_add_u32 s28, s28, s47
s_add_u32 m0, s28, 16384
s_lshl_b32 s29, s29, 15
buffer_load_dwordx4 v41, s[16:19], s29 offen lds
s_xor_b32 s29, s76, 8
s_lshl_b32 s28, s29, 10
s_add_u32 s28, s28, s47
s_add_u32 m0, s28, 16384
s_lshl_b32 s29, s29, 15
buffer_load_dwordx4 v41, s[16:19], s29 offen lds
s_xor_b32 s29, s76, 9
s_lshl_b32 s28, s29, 10
s_add_u32 s28, s28, s47
s_add_u32 m0, s28, 16384
s_lshl_b32 s29, s29, 15
buffer_load_dwordx4 v41, s[16:19], s29 offen lds
s_xor_b32 s29, s76, 10
s_lshl_b32 s28, s29, 10
s_add_u32 s28, s28, s47
s_add_u32 m0, s28, 16384
s_lshl_b32 s29, s29, 15
buffer_load_dwordx4 v41, s[16:19], s29 offen lds
s_xor_b32 s29, s76, 11
s_lshl_b32 s28, s29, 10
s_add_u32 s28, s28, s47
s_add_u32 m0, s28, 16384
s_lshl_b32 s29, s29, 15
buffer_load_dwordx4 v41, s[16:19], s29 offen lds
s_xor_b32 s29, s76, 12
s_lshl_b32 s28, s29, 10
s_add_u32 s28, s28, s47
s_add_u32 m0, s28, 16384
s_lshl_b32 s29, s29, 15
buffer_load_dwordx4 v41, s[16:19], s29 offen lds
s_xor_b32 s29, s76, 13
s_lshl_b32 s28, s29, 10
s_add_u32 s28, s28, s47
s_add_u32 m0, s28, 16384
s_lshl_b32 s29, s29, 15
buffer_load_dwordx4 v41, s[16:19], s29 offen lds
s_xor_b32 s29, s76, 14
s_lshl_b32 s28, s29, 10
s_add_u32 s28, s28, s47
s_add_u32 m0, s28, 16384
s_lshl_b32 s29, s29, 15
buffer_load_dwordx4 v41, s[16:19], s29 offen lds
s_xor_b32 s29, s76, 15
s_lshl_b32 s28, s29, 10
s_add_u32 s28, s28, s47
s_add_u32 m0, s28, 16384
s_lshl_b32 s29, s29, 15
buffer_load_dwordx4 v41, s[16:19], s29 offen lds
s_mov_b64 exec, 0
s_cmp_eq_u32 s24, 0
s_cbranch_scc1 mega_kernel_rs_iw0
s_cmp_eq_u32 s24, 1
s_cbranch_scc1 mega_kernel_rs_iw1
s_cmp_eq_u32 s24, 2
s_cbranch_scc1 mega_kernel_rs_iw2
s_branch mega_kernel_rs_iw3
mega_kernel_rs_iwd:
s_mov_b64 exec, -1
s_waitcnt vmcnt(17)
ds_read_b64_tr_b16 a[0:1], v46 offset:0
ds_read_b64_tr_b16 a[2:3], v46 offset:128
ds_read_b64_tr_b16 a[4:5], v46 offset:2048
ds_read_b64_tr_b16 a[6:7], v46 offset:2176
ds_read_b64_tr_b16 a[8:9], v46 offset:4096
ds_read_b64_tr_b16 a[10:11], v46 offset:4224
ds_read_b64_tr_b16 a[12:13], v46 offset:6144
ds_read_b64_tr_b16 a[14:15], v46 offset:6272
s_waitcnt lgkmcnt(0)
ds_read_b64_tr_b16 a[16:17], v46 offset:8192
ds_read_b64_tr_b16 a[18:19], v46 offset:8320
ds_read_b64_tr_b16 a[20:21], v46 offset:10240
ds_read_b64_tr_b16 a[22:23], v46 offset:10368
ds_read_b64_tr_b16 a[24:25], v46 offset:12288
ds_read_b64_tr_b16 a[26:27], v46 offset:12416
ds_read_b64_tr_b16 a[28:29], v46 offset:14336
ds_read_b64_tr_b16 a[30:31], v46 offset:14464
s_waitcnt lgkmcnt(0)
ds_read_b64_tr_b16 a[32:33], v46 offset:32
ds_read_b64_tr_b16 a[34:35], v46 offset:160
ds_read_b64_tr_b16 a[36:37], v46 offset:2080
ds_read_b64_tr_b16 a[38:39], v46 offset:2208
ds_read_b64_tr_b16 a[40:41], v46 offset:4128
ds_read_b64_tr_b16 a[42:43], v46 offset:4256
ds_read_b64_tr_b16 a[44:45], v46 offset:6176
ds_read_b64_tr_b16 a[46:47], v46 offset:6304
s_waitcnt lgkmcnt(0)
ds_read_b64_tr_b16 a[48:49], v46 offset:8224
ds_read_b64_tr_b16 a[50:51], v46 offset:8352
ds_read_b64_tr_b16 a[52:53], v46 offset:10272
ds_read_b64_tr_b16 a[54:55], v46 offset:10400
ds_read_b64_tr_b16 a[56:57], v46 offset:12320
ds_read_b64_tr_b16 a[58:59], v46 offset:12448
ds_read_b64_tr_b16 a[60:61], v46 offset:14368
ds_read_b64_tr_b16 a[62:63], v46 offset:14496
s_waitcnt lgkmcnt(0)
v_and_b32 v247, 15, v0
v_lshlrev_b32 v247, 4, v247
buffer_load_dword v246, v247, s[72:75], 0 offen sc1
buffer_load_dwordx4 v[64:67], v8, s[20:23], 0 offen offset:0
buffer_load_dwordx4 v[68:71], v8, s[20:23], 0 offen offset:128
buffer_load_dwordx4 v[72:75], v8, s[20:23], 0 offen offset:256
buffer_load_dwordx4 v[76:79], v8, s[20:23], 0 offen offset:384
s_waitcnt vmcnt(0)
ds_read_b64_tr_b16 a[192:193], v47 offset:16384
ds_read_b64_tr_b16 a[194:195], v47 offset:16512
ds_read_b64_tr_b16 a[196:197], v47 offset:18432
ds_read_b64_tr_b16 a[198:199], v47 offset:18560
ds_read_b64_tr_b16 a[200:201], v47 offset:20480
ds_read_b64_tr_b16 a[202:203], v47 offset:20608
ds_read_b64_tr_b16 a[204:205], v47 offset:22528
ds_read_b64_tr_b16 a[206:207], v47 offset:22656
s_waitcnt lgkmcnt(0)
ds_read_b64_tr_b16 a[208:209], v47 offset:24576
ds_read_b64_tr_b16 a[210:211], v47 offset:24704
ds_read_b64_tr_b16 a[212:213], v47 offset:26624
ds_read_b64_tr_b16 a[214:215], v47 offset:26752
ds_read_b64_tr_b16 a[216:217], v47 offset:28672
ds_read_b64_tr_b16 a[218:219], v47 offset:28800
ds_read_b64_tr_b16 a[220:221], v47 offset:30720
ds_read_b64_tr_b16 a[222:223], v47 offset:30848
s_waitcnt lgkmcnt(0)
ds_read_b64_tr_b16 a[224:225], v47 offset:16416
ds_read_b64_tr_b16 a[226:227], v47 offset:16544
ds_read_b64_tr_b16 a[228:229], v47 offset:18464
ds_read_b64_tr_b16 a[230:231], v47 offset:18592
ds_read_b64_tr_b16 a[232:233], v47 offset:20512
ds_read_b64_tr_b16 a[234:235], v47 offset:20640
ds_read_b64_tr_b16 a[236:237], v47 offset:22560
ds_read_b64_tr_b16 a[238:239], v47 offset:22688
s_waitcnt lgkmcnt(0)
ds_read_b64_tr_b16 a[240:241], v47 offset:24608
ds_read_b64_tr_b16 a[242:243], v47 offset:24736
ds_read_b64_tr_b16 a[244:245], v47 offset:26656
ds_read_b64_tr_b16 a[246:247], v47 offset:26784
ds_read_b64_tr_b16 a[248:249], v47 offset:28704
ds_read_b64_tr_b16 a[250:251], v47 offset:28832
ds_read_b64_tr_b16 a[252:253], v47 offset:30752
ds_read_b64_tr_b16 a[254:255], v47 offset:30880
s_waitcnt lgkmcnt(0)
v_mov_b32 v32, v64
v_mov_b32 v33, v65
v_mov_b32 v34, v66
v_mov_b32 v35, v67
v_mov_b32 v36, v68
v_mov_b32 v37, v69
v_mov_b32 v38, v70
v_mov_b32 v39, v71
v_mov_b32 v40, v72
v_mov_b32 v41, v73
v_mov_b32 v42, v74
v_mov_b32 v43, v75
v_mov_b32 v44, v76
v_mov_b32 v45, v77
v_mov_b32 v46, v78
v_mov_b32 v47, v79
v_mov_b32 v96, 0
v_mov_b32 v97, 0
v_mov_b32 v98, 0
v_mov_b32 v99, 0
v_mov_b32 v100, 0
v_mov_b32 v101, 0
v_mov_b32 v102, 0
v_mov_b32 v103, 0
v_mov_b32 v104, 0
v_mov_b32 v105, 0
v_mov_b32 v106, 0
v_mov_b32 v107, 0
v_mov_b32 v108, 0
v_mov_b32 v109, 0
v_mov_b32 v110, 0
v_mov_b32 v111, 0
v_mov_b32 v112, 0
v_mov_b32 v113, 0
v_mov_b32 v114, 0
v_mov_b32 v115, 0
v_mov_b32 v116, 0
v_mov_b32 v117, 0
v_mov_b32 v118, 0
v_mov_b32 v119, 0
s_nop 1
v_smfmac_f32_16x16x64_bf16 v[96:99], v[32:35], a[0:7], v6
v_smfmac_f32_16x16x64_bf16 v[100:103], v[32:35], a[32:39], v6
v_smfmac_f32_16x16x64_bf16 v[104:107], v[32:35], a[64:71], v6
v_smfmac_f32_16x16x64_bf16 v[108:111], v[32:35], a[96:103], v6
v_smfmac_f32_16x16x64_bf16 v[96:99], v[36:39], a[8:15], v6
v_smfmac_f32_16x16x64_bf16 v[100:103], v[36:39], a[40:47], v6
v_smfmac_f32_16x16x64_bf16 v[104:107], v[36:39], a[72:79], v6
v_smfmac_f32_16x16x64_bf16 v[108:111], v[36:39], a[104:111], v6
v_smfmac_f32_16x16x64_bf16 v[96:99], v[40:43], a[16:23], v6
v_smfmac_f32_16x16x64_bf16 v[100:103], v[40:43], a[48:55], v6
v_smfmac_f32_16x16x64_bf16 v[104:107], v[40:43], a[80:87], v6
v_smfmac_f32_16x16x64_bf16 v[108:111], v[40:43], a[112:119], v6
v_smfmac_f32_16x16x64_bf16 v[96:99], v[44:47], a[24:31], v6
v_smfmac_f32_16x16x64_bf16 v[100:103], v[44:47], a[56:63], v6
v_smfmac_f32_16x16x64_bf16 v[104:107], v[44:47], a[88:95], v6
v_smfmac_f32_16x16x64_bf16 v[108:111], v[44:47], a[120:127], v6
v_and_b32 v247, 15, v0
v_lshlrev_b32 v247, 4, v247
s_branch mega_kernel_sysp
mega_kernel_sysw:
s_sleep 4
mega_kernel_sys:
buffer_load_dword v246, v247, s[72:75], 0 offen sc1
s_waitcnt vmcnt(0)
mega_kernel_sysp:
s_cmp_eq_u32 s95, 1
s_cbranch_scc0 mega_kernel_sysf
v_readlane_b32 s76, v246, 14
s_mov_b32 s98, 0
s_cmp_eq_u32 s76, 32
s_cbranch_scc0 mega_kernel_sysw
s_branch mega_kernel_sysd
mega_kernel_sysf:
s_mov_b32 s77, 0
s_mov_b32 s78, 0
v_readlane_b32 s76, v246, 0
s_add_u32 s77, s77, s76
s_xor_b32 s76, s76, 32
s_or_b32 s78, s78, s76
v_readlane_b32 s76, v246, 1
s_add_u32 s77, s77, s76
s_xor_b32 s76, s76, 32
s_or_b32 s78, s78, s76
v_readlane_b32 s76, v246, 2
s_add_u32 s77, s77, s76
s_xor_b32 s76, s76, 32
s_or_b32 s78, s78, s76
v_readlane_b32 s76, v246, 3
s_add_u32 s77, s77, s76
s_xor_b32 s76, s76, 32
s_or_b32 s78, s78, s76
v_readlane_b32 s76, v246, 4
s_add_u32 s77, s77, s76
s_xor_b32 s76, s76, 32
s_or_b32 s78, s78, s76
v_readlane_b32 s76, v246, 5
s_add_u32 s77, s77, s76
s_xor_b32 s76, s76, 32
s_or_b32 s78, s78, s76
v_readlane_b32 s76, v246, 6
s_add_u32 s77, s77, s76
s_xor_b32 s76, s76, 32
s_or_b32 s78, s78, s76
v_readlane_b32 s76, v246, 7
s_add_u32 s77, s77, s76
s_xor_b32 s76, s76, 32
s_or_b32 s78, s78, s76
s_cmp_eq_u32 s77, 256
s_cbranch_scc0 mega_kernel_sysw
v_mov_b32 v252, v246
s_cmp_eq_u32 s78, 0
s_cbranch_scc0 mega_kernel_slowent
v_readlane_b32 s76, v246, 10
v_readlane_b32 s77, v246, 8
s_cmp_eq_u32 s76, 32
s_cbranch_scc0 mega_kernel_sysw
s_cmp_gt_u32 s77, 16
s_cselect_b32 s98, 1, 0
mega_kernel_sysd:
s_lshr_b32 s28, s31, 4
s_lshl_b32 s28, s28, 14
s_lshl_b32 s29, s98, 13
s_add_u32 s28, s28, s29
s_and_b32 s29, s31, 15
s_lshl_b32 s29, s29, 9
s_add_u32 s28, s28, s29
s_lshl_b32 s29, s30, 16
s_add_u32 s28, s28, s29
s_add_u32 s28, s28, 67108864
v_lshrrev_b32 v12, 1, v17
v_add_u32 v12, s28, v12
v_xor_b32 v25, 0x10000, v12
v_xor_b32 v26, 0x20000, v12
v_xor_b32 v27, 0x30000, v12
v_add_u32 v25, 0, v25
v_add_u32 v26, 0, v26
v_add_u32 v27, 0, v27
s_lshl_b32 s28, s25, 2
s_add_u32 s28, s28, s26
s_mov_b32 s82, s28
s_lshr_b32 s29, s28, 3
s_xor_b32 s29, s29, s98
s_and_b32 s29, s29, 1
s_lshl_b32 s29, s29, 13
s_lshl_b32 s76, s28, 18
s_add_u32 s76, s76, s29
s_mov_b32 s83, s76
v_add_u32 v240, s76, v17
v_add_u32 v241, 33554432, v240
s_lshr_b32 s29, s28, 4
s_xor_b32 s29, s29, s98
s_and_b32 s29, s29, 1
s_lshl_b32 s29, s29, 13
s_lshl_b32 s79, s28, 17
s_add_u32 s79, s79, s29
s_add_u32 s79, s79, 71303168
s_xor_b32 s29, s98, 1
s_lshl_b32 s29, s29, 13
s_lshl_b32 s28, s25, 7
s_add_u32 s28, s28, s29
s_add_u32 s28, s28, 69206016
v_and_b32 v4, 1, v1
v_lshlrev_b32 v24, 12, v4
v_add_u32 v24, s28, v24
s_lshl_b32 s29, s26, 2
v_add_u32 v24, s29, v24
s_xor_b32 s81, s98, 1
s_lshl_b32 s81, s81, 13
s_lshr_b32 s29, s82, 6
s_lshl_b32 s29, s29, 14
s_add_u32 s81, s81, s29
s_and_b32 s29, s82, 63
s_lshl_b32 s29, s29, 7
s_add_u32 s81, s81, s29
s_add_u32 s81, s81, 69222400
v_mov_b32 v220, 0x3f803f80
v_mov_b32 v221, 0x3f803f80
v_mov_b32 v222, 0x3f803f80
v_mov_b32 v223, 0x3f803f80
v_mov_b32 v228, 0
s_mov_b32 s27, 0
s_mov_b32 s46, 0
s_mov_b32 s89, 0
s_mov_b32 s88, 0
s_mov_b32 s44, 18432
s_mov_b32 s45, 18432
s_cmp_eq_u32 s24, 3
s_cbranch_scc0 mega_kernel_rs_pfi
s_mov_b32 s76, 0
s_cmp_gt_i32 s46, s76
s_cbranch_scc1 mega_kernel_rs_pf0ok
mega_kernel_rs_pf0w:
v_mov_b32 v4, 0
s_mov_b64 exec, 3
buffer_atomic_add v4, v24, s[84:87], 0 offen sc0 sc1
s_mov_b64 exec, -1
s_waitcnt vmcnt(0)
v_readlane_b32 s46, v4, 0
v_readlane_b32 s28, v4, 1
s_nop 1
s_min_i32 s46, s46, s28
s_cmp_gt_i32 s46, s76
s_cbranch_scc0 mega_kernel_rs_pf0w
mega_kernel_rs_pf0ok:
s_add_u32 s77, s76, s82
s_bfe_u32 s28, s77, 0x40002
s_lshl_b32 s28, s28, 14
s_and_b32 s77, s77, 3
s_lshl_b32 s77, s77, 11
s_add_u32 s28, s28, s77
s_add_u32 m0, s45, 0
s_nop 0
buffer_load_dwordx4 v240, s[84:87], s28 offen offset:0 sc1 lds
s_add_u32 m0, s45, 0
s_nop 0
buffer_load_dwordx4 v240, s[84:87], s28 offen offset:1024 sc1 lds
s_add_u32 m0, s45, 2048
s_nop 0
buffer_load_dwordx4 v241, s[84:87], s28 offen offset:0 sc1 lds
s_add_u32 m0, s45, 2048
s_nop 0
buffer_load_dwordx4 v241, s[84:87], s28 offen offset:1024 sc1 lds
s_add_u32 s45, s45, 4096
s_cmp_eq_u32 s45, 30720
s_cselect_b32 s45, 18432, s45
s_waitcnt vmcnt(0) lgkmcnt(0)
s_branch mega_kernel_rs_pfj
mega_kernel_rs_pfi:
s_lshr_b32 s88, s25, 2
s_lshl_b32 s88, s88, 17
s_and_b32 s77, s25, 2
s_lshl_b32 s77, s77, 13
s_add_u32 s88, s88, s77
s_and_b32 s77, s25, 1
s_lshl_b32 s77, s77, 12
s_add_u32 s88, s88, s77
s_xor_b32 s77, s98, 0
s_lshl_b32 s77, s77, 13
s_add_u32 s88, s88, s77
s_add_u32 s88, s88, 68255744
s_lshl_b32 s77, s26, 10
s_add_u32 s88, s88, s77
mega_kernel_rs_pfj:
v_mov_b32 v184, 0
v_mov_b32 v185, 0
v_mov_b32 v186, 0
v_mov_b32 v187, 0
v_mov_b32 v188, 0
v_mov_b32 v189, 0
v_mov_b32 v190, 0
v_mov_b32 v191, 0
v_mov_b32 v192, 0
v_mov_b32 v193, 0
v_mov_b32 v194, 0
v_mov_b32 v195, 0
v_mov_b32 v196, 0
v_mov_b32 v197, 0
v_mov_b32 v198, 0
v_mov_b32 v199, 0
v_mov_b32 v200, 0
v_mov_b32 v201, 0
v_mov_b32 v202, 0
v_mov_b32 v203, 0
v_mov_b32 v204, 0
v_mov_b32 v205, 0
v_mov_b32 v206, 0
v_mov_b32 v207, 0
v_mov_b32 v249, 0
v_mov_b32 v60, 0
v_mov_b32 v61, 0
v_mov_b32 v62, 0
v_mov_b32 v63, 0
s_waitcnt lgkmcnt(0)
s_barrier
s_and_b32 s29, s27, 1
s_lshl_b32 s33, s29, 17
s_lshl_b32 s28, s30, 18
s_add_u32 s33, s33, s28
s_add_u32 s33, s33, 68157440
s_xor_b32 s34, s33, 131072
s_lshl_b32 s35, s29, 18
s_bfe_u32 s47, s27, 0x10001
s_branch mega_kernel_rs_first
.p2align 6
s_nop 0
s_nop 0
mega_kernel_rs_loop:
buffer_load_dwordx4 v[32:35], v7, s[84:87], s33 offen offset:0 sc1
v_add_u32 v5, s44, v17
ds_read_b128 v[156:159], v5 offset:0
ds_read_b128 v[160:163], v5 offset:1024
ds_read_b128 v[164:167], v5 offset:2048
ds_read_b128 v[168:171], v5 offset:3072
s_nop 4
buffer_load_dwordx4 v[36:39], v7, s[84:87], s33 offen offset:1024 sc1
s_nop 9
buffer_load_dwordx4 v[40:43], v7, s[84:87], s33 offen offset:2048 sc1
s_nop 9
buffer_load_dwordx4 v[44:47], v7, s[84:87], s33 offen offset:3072 sc1
s_waitcnt vmcnt(3)
v_max_u32 v4, v32, v34
v_cmp_eq_u32 vcc, -1, v4
s_cbranch_vccnz mega_kernel_rs_pa_15_0f
v_smfmac_f32_16x16x64_bf16 v[96:99], v[32:35], a[0:7], v6
v_smfmac_f32_16x16x64_bf16 v[100:103], v[32:35], a[32:39], v6
v_smfmac_f32_16x16x64_bf16 v[104:107], v[32:35], a[64:71], v6
s_waitcnt vmcnt(2)
v_max_u32 v4, v36, v38
v_cmp_eq_u32 vcc, -1, v4
v_smfmac_f32_16x16x64_bf16 v[108:111], v[32:35], a[96:103], v6
s_cbranch_vccnz mega_kernel_rs_pa_14_1f
v_smfmac_f32_16x16x64_bf16 v[96:99], v[36:39], a[8:15], v6
v_smfmac_f32_16x16x64_bf16 v[100:103], v[36:39], a[40:47], v6
v_smfmac_f32_16x16x64_bf16 v[104:107], v[36:39], a[72:79], v6
s_waitcnt vmcnt(1)
v_max_u32 v4, v40, v42
v_cmp_eq_u32 vcc, -1, v4
v_smfmac_f32_16x16x64_bf16 v[108:111], v[36:39], a[104:111], v6
s_cbranch_vccnz mega_kernel_rs_pa_12_2f
v_smfmac_f32_16x16x64_bf16 v[96:99], v[40:43], a[16:23], v6
v_smfmac_f32_16x16x64_bf16 v[100:103], v[40:43], a[48:55], v6
v_smfmac_f32_16x16x64_bf16 v[104:107], v[40:43], a[80:87], v6
s_waitcnt vmcnt(0)
v_max_u32 v4, v44, v46
v_cmp_eq_u32 vcc, -1, v4
v_smfmac_f32_16x16x64_bf16 v[108:111], v[40:43], a[112:119], v6
s_cbranch_vccnz mega_kernel_rs_pa_8_3f
v_smfmac_f32_16x16x64_bf16 v[96:99], v[44:47], a[24:31], v6
v_smfmac_f32_16x16x64_bf16 v[100:103], v[44:47], a[56:63], v6
v_smfmac_f32_16x16x64_bf16 v[104:107], v[44:47], a[88:95], v6
v_smfmac_f32_16x16x64_bf16 v[108:111], v[44:47], a[120:127], v6
mega_kernel_rs_pa_d:
mega_kernel_rs_adone:
s_nop 5
v_permlane32_swap_b32 v96, v100
v_permlane32_swap_b32 v97, v101
v_permlane32_swap_b32 v98, v102
v_permlane32_swap_b32 v99, v103
v_pk_add_f32 v[96:97], v[96:97], v[100:101]
v_pk_add_f32 v[98:99], v[98:99], v[102:103]
ds_write2_b32 v14, v96, v97 offset0:0 offset1:36
ds_write2_b32 v14, v98, v99 offset0:72 offset1:108
v_permlane32_swap_b32 v104, v108
v_permlane32_swap_b32 v105, v109
v_permlane32_swap_b32 v106, v110
v_permlane32_swap_b32 v107, v111
v_pk_add_f32 v[104:105], v[104:105], v[108:109]
v_pk_add_f32 v[106:107], v[106:107], v[110:111]
ds_write2_b32 v15, v104, v105 offset0:0 offset1:36
ds_write2_b32 v15, v106, v107 offset0:72 offset1:108
v_smfmac_f32_16x16x64_bf16 v[112:115], v[32:35], a[128:135], v6
v_smfmac_f32_16x16x64_bf16 v[116:119], v[32:35], a[160:167], v6
v_smfmac_f32_16x16x64_bf16 v[112:115], v[36:39], a[136:143], v6
v_smfmac_f32_16x16x64_bf16 v[116:119], v[36:39], a[168:175], v6
s_waitcnt lgkmcnt(0)
s_barrier
s_cmp_lg_u32 s24, 0
s_cbranch_scc1 mega_kernel_rs_side
ds_read_b128 v[120:123], v16 offset:0
ds_read_b128 v[124:127], v16 offset:16
ds_read_b128 v[128:131], v16 offset:2304
ds_read_b128 v[132:135], v16 offset:2320
ds_read_b128 v[136:139], v16 offset:4608
ds_read_b128 v[140:143], v16 offset:4624
ds_read_b128 v[144:147], v16 offset:6912
ds_read_b128 v[148:151], v16 offset:6928
v_smfmac_f32_16x16x64_bf16 v[112:115], v[40:43], a[144:151], v6
v_smfmac_f32_16x16x64_bf16 v[116:119], v[40:43], a[176:183], v6
v_smfmac_f32_16x16x64_bf16 v[112:115], v[44:47], a[152:159], v6
v_smfmac_f32_16x16x64_bf16 v[116:119], v[44:47], a[184:191], v6
s_mul_i32 s28, s31, 1280
s_add_u32 s28, s28, s33
s_add_u32 s28, s28, 49152
s_add_u32 s76, s37, s33
s_add_u32 s77, s38, s33
s_add_u32 s78, s39, s33
s_waitcnt lgkmcnt(4)
v_pk_add_f32 v[120:121], v[120:121], v[128:129]
v_pk_add_f32 v[122:123], v[122:123], v[130:131]
v_pk_add_f32 v[124:125], v[124:125], v[132:133]
v_pk_add_f32 v[126:127], v[126:127], v[134:135]
s_waitcnt lgkmcnt(0)
v_pk_add_f32 v[136:137], v[136:137], v[144:145]
v_pk_add_f32 v[138:139], v[138:139], v[146:147]
v_pk_add_f32 v[140:141], v[140:141], v[148:149]
v_pk_add_f32 v[142:143], v[142:143], v[150:151]
v_pk_add_f32 v[120:121], v[120:121], v[136:137]
v_pk_add_f32 v[122:123], v[122:123], v[138:139]
v_pk_add_f32 v[124:125], v[124:125], v[140:141]
v_pk_add_f32 v[126:127], v[126:127], v[142:143]
v_cvt_pk_bf16_f32 v152, v120, v121
v_cvt_pk_bf16_f32 v153, v122, v123
v_cvt_pk_bf16_f32 v154, v124, v125
v_cvt_pk_bf16_f32 v155, v126, v127
s_nop 1
v_mfma_f32_16x16x32_bf16 v[176:179], v[160:163], v[152:155], 0
v_mfma_f32_16x16x32_bf16 v[172:175], v[156:159], v[152:155], 0
v_mfma_f32_16x16x32_bf16 v[180:183], v[152:155], v[152:155], 0
s_cmp_eq_u32 s27, 63
s_cbranch_scc1 mega_kernel_rs_w0last
s_nop 4
v_mov_b32_dpp v172, v176 row_shr:8 row_mask:0xf bank_mask:0xc
v_mov_b32_dpp v173, v177 row_shr:8 row_mask:0xf bank_mask:0xc
v_mov_b32_dpp v174, v178 row_shr:8 row_mask:0xf bank_mask:0xc
v_mov_b32_dpp v175, v179 row_shr:8 row_mask:0xf bank_mask:0xc
v_min_u32 v180, -2, v180
v_min_u32 v172, -2, v172
s_mov_b64 exec, s[42:43]
buffer_store_dwordx4 v[180:183], v10, s[84:87], s28 offen sc1
s_mov_b64 exec, -1
buffer_store_dwordx4 v[172:175], v17, s[84:87], s28 offen sc1
v_permlane32_swap_b32 v112, v116
v_permlane32_swap_b32 v113, v117
v_permlane32_swap_b32 v114, v118
v_permlane32_swap_b32 v115, v119
v_pk_add_f32 v[112:113], v[112:113], v[116:117]
v_pk_add_f32 v[114:115], v[114:115], v[118:119]
ds_write_b128 v20, v[112:115]
s_waitcnt lgkmcnt(0)
s_barrier
v_mov_b32 v96, 0
v_mov_b32 v97, 0
v_mov_b32 v98, 0
v_mov_b32 v99, 0
v_mov_b32 v100, 0
v_mov_b32 v101, 0
v_mov_b32 v102, 0
v_mov_b32 v103, 0
v_cndmask_b32 v176, v23, v180, s[42:43]
v_cndmask_b32 v177, v23, v181, s[42:43]
v_cndmask_b32 v178, v23, v182, s[42:43]
v_cndmask_b32 v179, v23, v183, s[42:43]
s_mov_b64 exec, s[42:43]
buffer_load_dwordx4 v[188:191], v10, s[84:87], s76 offen sc1
buffer_load_dwordx4 v[196:199], v10, s[84:87], s77 offen sc1
buffer_load_dwordx4 v[204:207], v10, s[84:87], s78 offen sc1
s_mov_b64 exec, -1
buffer_load_dwordx4 v[184:187], v17, s[84:87], s76 offen sc1
buffer_load_dwordx4 v[192:195], v17, s[84:87], s77 offen sc1
buffer_load_dwordx4 v[200:203], v17, s[84:87], s78 offen sc1
v_pk_mul_f32 v[172:173], v[172:173], s[32:33] op_sel_hi:[1,0]
v_pk_mul_f32 v[174:175], v[174:175], s[32:33] op_sel_hi:[1,0]
v_pk_mul_f32 v[176:177], v[176:177], s[32:33] op_sel_hi:[1,0]
v_pk_mul_f32 v[178:179], v[178:179], s[32:33] op_sel_hi:[1,0]
s_lshl_b32 s89, s47, 31
s_or_b32 s89, s89, 0x3b39999a
s_nop 15
s_nop 1
s_mov_b64 exec, s[42:43]
buffer_load_dwordx4 v[188:191], v10, s[84:87], s76 offen sc1
buffer_load_dwordx4 v[196:199], v10, s[84:87], s77 offen sc1
buffer_load_dwordx4 v[204:207], v10, s[84:87], s78 offen sc1
s_mov_b64 exec, -1
buffer_load_dwordx4 v[184:187], v17, s[84:87], s76 offen sc1
buffer_load_dwordx4 v[192:195], v17, s[84:87], s77 offen sc1
buffer_load_dwordx4 v[200:203], v17, s[84:87], s78 offen sc1
mega_kernel_rs_p2:
s_waitcnt vmcnt(6)
v_max3_u32 v4, v184, v188, v192
v_max3_u32 v5, v196, v200, v204
v_max_u32 v4, v4, v5
v_cmp_eq_u32 vcc, -1, v4
s_cbranch_vccnz mega_kernel_rs_p2r
v_pk_add_f32 v[124:125], v[196:197], v[204:205]
v_pk_add_f32 v[126:127], v[198:199], v[206:207]
v_pk_add_f32 v[120:121], v[192:193], v[200:201]
v_pk_add_f32 v[122:123], v[194:195], v[202:203]
v_pk_add_f32 v[124:125], v[124:125], v[188:189]
v_pk_add_f32 v[126:127], v[126:127], v[190:191]
v_pk_add_f32 v[120:121], v[120:121], v[184:185]
v_pk_add_f32 v[122:123], v[122:123], v[186:187]
v_pk_fma_f32 v[176:177], v[124:125], s[32:33], v[176:177] op_sel_hi:[1,0,1]
v_pk_fma_f32 v[178:179], v[126:127], s[32:33], v[178:179] op_sel_hi:[1,0,1]
v_pk_fma_f32 v[172:173], v[120:121], s[32:33], v[172:173] op_sel_hi:[1,0,1]
v_pk_fma_f32 v[174:175], v[122:123], s[32:33], v[174:175] op_sel_hi:[1,0,1]
v_max3_f32 v232, v172, v173, v174
v_max3_f32 v233, v176, v177, v178
v_max3_f32 v232, v232, v175, v179
v_max_f32 v234, v232, v233
s_barrier
ds_read2_b64 v[208:211], v21 offset0:0 offset1:32
v_max_f32_dpp v232, v234, v234 row_ror:8 row_mask:0xf bank_mask:0xf
v_max_f32_dpp v233, v234, v234 row_ror:8 row_mask:0xf bank_mask:0xf
s_nop 1
v_permlane16_swap_b32 v232, v233
s_nop 0
v_max_f32 v234, v232, v233
v_max_f32 v235, v232, v233
s_nop 1
v_permlane32_swap_b32 v234, v235
s_nop 0
v_max_f32 v232, v234, v235
v_pk_add_f32 v[176:177], v[176:177], v[232:233] op_sel_hi:[1,0] neg_lo:[0,1] neg_hi:[0,1]
v_pk_add_f32 v[178:179], v[178:179], v[232:233] op_sel_hi:[1,0] neg_lo:[0,1] neg_hi:[0,1]
v_pk_add_f32 v[172:173], v[172:173], v[232:233] op_sel_hi:[1,0] neg_lo:[0,1] neg_hi:[0,1]
v_pk_add_f32 v[174:175], v[174:175], v[232:233] op_sel_hi:[1,0] neg_lo:[0,1] neg_hi:[0,1]
v_exp_f32 v176, v176
v_exp_f32 v177, v177
v_exp_f32 v178, v178
v_exp_f32 v179, v179
v_exp_f32 v172, v172
v_cvt_pk_bf16_f32 v216, v176, v177
v_cvt_pk_bf16_f32 v217, v178, v179
v_exp_f32 v173, v173
v_exp_f32 v174, v174
v_mfma_f32_16x16x16_bf16 v[224:227], v[220:221], v[216:217], 0
v_exp_f32 v175, v175
v_cvt_pk_bf16_f32 v212, v172, v173
s_waitcnt lgkmcnt(0)
v_mfma_f32_16x16x16_bf16 v[120:123], v[208:209], v[216:217], 0
v_cvt_pk_bf16_f32 v213, v174, v175
v_mfma_f32_16x16x16_bf16 v[124:127], v[210:211], v[216:217], 0
v_mov_b32_dpp v214, v212 row_ror:8 row_mask:0xf bank_mask:0xf
v_mov_b32_dpp v215, v213 row_ror:8 row_mask:0xf bank_mask:0xf
s_nop 1
v_mfma_f32_16x16x32_bf16 v[224:227], v[220:223], v[212:215], v[224:227]
v_mfma_f32_16x16x32_bf16 v[120:123], v[164:167], v[212:215], v[120:123]
v_mfma_f32_16x16x32_bf16 v[124:127], v[168:171], v[212:215], v[124:127]
s_add_u32 s29, s33, 24576
s_nop 4
v_rcp_f32 v234, v224
s_nop 0
v_pk_mul_f32 v[120:121], v[120:121], v[234:235] op_sel_hi:[1,0]
v_pk_mul_f32 v[122:123], v[122:123], v[234:235] op_sel_hi:[1,0]
v_pk_mul_f32 v[124:125], v[124:125], v[234:235] op_sel_hi:[1,0]
v_pk_mul_f32 v[126:127], v[126:127], v[234:235] op_sel_hi:[1,0]
v_cvt_pk_bf16_f32 v212, v120, v121
v_cvt_pk_bf16_f32 v213, v122, v123
v_cvt_pk_bf16_f32 v214, v124, v125
v_cvt_pk_bf16_f32 v215, v126, v127
v_min_u32 v212, -2, v212
s_mov_b64 exec, s[40:41]
buffer_store_dwordx4 v[212:215], v11, s[84:87], s33 offen sc1
s_mov_b64 exec, -1
mega_kernel_rs_b3:
s_barrier
s_nop 15
buffer_load_dwordx4 v[32:35], v7, s[84:87], s29 offen offset:0 sc1
s_nop 9
buffer_load_dwordx4 v[36:39], v7, s[84:87], s29 offen offset:1024 sc1
s_nop 9
buffer_load_dwordx4 v[40:43], v7, s[84:87], s29 offen offset:2048 sc1
s_nop 9
buffer_load_dwordx4 v[44:47], v7, s[84:87], s29 offen offset:3072 sc1
mega_kernel_rs_pc_15_0:
s_waitcnt vmcnt(3)
v_cmp_eq_u32 vcc, -1, v32
s_cbranch_vccnz mega_kernel_rs_pc_15_0f
v_smfmac_f32_16x16x64_bf16 v[96:99], v[32:35], a[192:199], v6
v_smfmac_f32_16x16x64_bf16 v[100:103], v[32:35], a[224:231], v6
mega_kernel_rs_pc_14_1:
s_waitcnt vmcnt(2)
v_cmp_eq_u32 vcc, -1, v36
s_cbranch_vccnz mega_kernel_rs_pc_14_1f
v_smfmac_f32_16x16x64_bf16 v[96:99], v[36:39], a[200:207], v6
v_smfmac_f32_16x16x64_bf16 v[100:103], v[36:39], a[232:239], v6
mega_kernel_rs_pc_12_2:
s_waitcnt vmcnt(1)
v_cmp_eq_u32 vcc, -1, v40
s_cbranch_vccnz mega_kernel_rs_pc_12_2f
v_smfmac_f32_16x16x64_bf16 v[96:99], v[40:43], a[208:215], v6
v_smfmac_f32_16x16x64_bf16 v[100:103], v[40:43], a[240:247], v6
mega_kernel_rs_pc_8_3:
s_waitcnt vmcnt(0)
v_cmp_eq_u32 vcc, -1, v44
s_cbranch_vccnz mega_kernel_rs_pc_8_3f
v_smfmac_f32_16x16x64_bf16 v[96:99], v[44:47], a[216:223], v6
v_smfmac_f32_16x16x64_bf16 v[100:103], v[44:47], a[248:255], v6
mega_kernel_rs_pc_d:
s_nop 7
v_permlane32_swap_b32 v96, v100
v_permlane32_swap_b32 v97, v101
v_permlane32_swap_b32 v98, v102
v_permlane32_swap_b32 v99, v103
v_pk_add_f32 v[96:97], v[96:97], v[100:101]
v_pk_add_f32 v[98:99], v[98:99], v[102:103]
ds_write2_b32 v18, v96, v97 offset0:0 offset1:36
ds_write2_b32 v18, v98, v99 offset0:72 offset1:108
s_waitcnt lgkmcnt(0)
s_barrier
s_cmp_lg_u32 s24, 0
s_cbranch_scc1 mega_kernel_rs_x1
ds_read_b128 v[120:123], v19 offset:0
ds_read_b128 v[124:127], v19 offset:1152
ds_read_b128 v[128:131], v19 offset:2304
ds_read_b128 v[132:135], v19 offset:3456
s_waitcnt lgkmcnt(2)
v_pk_add_f32 v[120:121], v[120:121], v[124:125]
v_pk_add_f32 v[122:123], v[122:123], v[126:127]
s_waitcnt lgkmcnt(0)
v_pk_add_f32 v[128:129], v[128:129], v[132:133]
v_pk_add_f32 v[130:131], v[130:131], v[134:135]
v_pk_add_f32 v[120:121], v[120:121], v[128:129]
v_pk_add_f32 v[122:123], v[122:123], v[130:131]
v_fma_f32 v212, v120, s89, v120
v_cvt_pk_bf16_f32 v213, v122, v123
v_cvt_pk_bf16_f32 v212, v212, v121
v_and_or_b32 v212, v212, -2, s47
buffer_store_dwordx2 v[212:213], v12, s[84:87], s35 offen sc1
s_mov_b32 s77, 0x3f80
s_mov_b32 s78, 0x3f800000
s_xor_b32 s76, s47, 1
v_mov_b32 v48, s76
v_mov_b32 v50, s76
v_mov_b32 v52, s76
s_nop 8
v_mov_b32 v96, 0
v_mov_b32 v97, 0
v_mov_b32 v98, 0
v_mov_b32 v99, 0
v_mov_b32 v100, 0
v_mov_b32 v101, 0
v_mov_b32 v102, 0
v_mov_b32 v103, 0
v_mov_b32 v104, 0
v_mov_b32 v105, 0
v_mov_b32 v106, 0
v_mov_b32 v107, 0
v_mov_b32 v108, 0
v_mov_b32 v109, 0
v_mov_b32 v110, 0
v_mov_b32 v111, 0
v_mov_b32 v112, 0
v_mov_b32 v113, 0
v_mov_b32 v114, 0
v_mov_b32 v115, 0
v_mov_b32 v116, 0
v_mov_b32 v117, 0
v_mov_b32 v118, 0
v_mov_b32 v119, 0
s_nop 15
s_nop 7
s_cmp_eq_u32 s47, 1
s_cbranch_scc1 mega_kernel_rs_p4_1
.p2align 6
mega_kernel_rs_p4_0:
buffer_load_dwordx2 v[48:49], v25, s[84:87], s35 offen sc1
buffer_load_dwordx2 v[50:51], v26, s[84:87], s35 offen sc1
buffer_load_dwordx2 v[52:53], v27, s[84:87], s35 offen sc1
s_waitcnt vmcnt(12)
mega_kernel_rs_p4c_0:
v_bitop3_b32 v4, v48, v50, v52 bitop3:0xfe
v_and_b32 v4, 1, v4
v_cmp_ne_u32 vcc, 0, v4
s_cbranch_vccnz mega_kernel_rs_p4_0
v_dot2_f32_bf16 v120, v48, s77, v120
v_dot2_f32_bf16 v121, v48, s78, v121
v_dot2_f32_bf16 v122, v49, s77, v122
v_dot2_f32_bf16 v123, v49, s78, v123
v_dot2_f32_bf16 v120, v50, s77, v120
v_dot2_f32_bf16 v121, v50, s78, v121
v_dot2_f32_bf16 v122, v51, s77, v122
v_dot2_f32_bf16 v123, v51, s78, v123
v_dot2_f32_bf16 v120, v52, s77, v120
v_dot2_f32_bf16 v121, v52, s78, v121
v_dot2_f32_bf16 v122, v53, s77, v122
v_dot2_f32_bf16 v123, v53, s78, v123
s_nop 0
v_cvt_pk_bf16_f32 v212, v120, v121
v_min_u32 v212, -2, v212
v_cvt_pk_bf16_f32 v213, v122, v123
buffer_store_dwordx2 v[212:213], v9, s[84:87], s34 offen sc1
s_branch mega_kernel_rs_p4d
mega_kernel_rs_iw0:
mega_kernel_rs_il0:
s_cbranch_execz mega_kernel_rs_il1
.p2align 6
mega_kernel_rs_p4_1:
buffer_load_dwordx2 v[48:49], v25, s[84:87], s35 offen sc1
buffer_load_dwordx2 v[50:51], v26, s[84:87], s35 offen sc1
buffer_load_dwordx2 v[52:53], v27, s[84:87], s35 offen sc1
s_waitcnt vmcnt(12)
mega_kernel_rs_p4c_1:
v_bitop3_b32 v4, v48, v50, v52 bitop3:0x80
v_and_b32 v4, 1, v4
v_cmp_ne_u32 vcc, 1, v4
s_cbranch_vccnz mega_kernel_rs_p4_1
v_dot2_f32_bf16 v120, v48, s77, v120
v_dot2_f32_bf16 v121, v48, s78, v121
v_dot2_f32_bf16 v122, v49, s77, v122
v_dot2_f32_bf16 v123, v49, s78, v123
v_dot2_f32_bf16 v120, v50, s77, v120
v_dot2_f32_bf16 v121, v50, s78, v121
v_dot2_f32_bf16 v122, v51, s77, v122
v_dot2_f32_bf16 v123, v51, s78, v123
v_dot2_f32_bf16 v120, v52, s77, v120
v_dot2_f32_bf16 v121, v52, s78, v121
v_dot2_f32_bf16 v122, v53, s77, v122
v_dot2_f32_bf16 v123, v53, s78, v123
s_nop 0
v_cvt_pk_bf16_f32 v212, v120, v121
v_min_u32 v212, -2, v212
v_cvt_pk_bf16_f32 v213, v122, v123
buffer_store_dwordx2 v[212:213], v9, s[84:87], s34 offen sc1
mega_kernel_rs_p4d:
mega_kernel_rs_b5:
s_add_u32 s27, s27, 1
s_add_u32 s44, s44, 4096
s_cmp_eq_u32 s44, 30720
s_cselect_b32 s44, 18432, s44
s_mov_b32 s28, s33
s_mov_b32 s33, s34
s_mov_b32 s34, s28
s_xor_b32 s35, s35, 262144
s_bfe_u32 s47, s27, 0x10001
s_barrier
s_nop 15
s_branch mega_kernel_rs_loop
mega_kernel_rs_il1:
s_cbranch_execz mega_kernel_rs_il2
mega_kernel_rs_x1:
s_cmp_eq_u32 s24, 1
s_cbranch_scc0 mega_kernel_rs_x2
s_add_u32 s76, s27, 1
s_sleep 6
v_mov_b32 v5, s76
s_mov_b64 exec, 1
buffer_store_dword v5, v228, s[84:87], s81 offen sc1
s_mov_b64 exec, -1
mega_kernel_rs_x2:
s_cmp_eq_u32 s24, 3
s_cbranch_scc0 mega_kernel_rs_x4
s_cmp_eq_u32 s36, 1
s_cbranch_scc0 mega_kernel_rs_x5
s_add_u32 s76, s27, 1
s_cmp_gt_i32 s46, s76
s_cbranch_scc1 mega_kernel_rs_pf1ok
mega_kernel_rs_pf1w:
v_mov_b32 v4, 0
s_mov_b64 exec, 3
buffer_atomic_add v4, v24, s[84:87], 0 offen sc0 sc1
s_mov_b64 exec, -1
s_waitcnt vmcnt(0)
v_readlane_b32 s46, v4, 0
v_readlane_b32 s28, v4, 1
s_nop 1
s_min_i32 s46, s46, s28
s_cmp_gt_i32 s46, s76
s_cbranch_scc0 mega_kernel_rs_pf1w
mega_kernel_rs_pf1ok:
s_add_u32 s77, s76, s82
s_bfe_u32 s28, s77, 0x40002
s_lshl_b32 s28, s28, 14
s_and_b32 s77, s77, 3
s_lshl_b32 s77, s77, 11
s_add_u32 s28, s28, s77
s_add_u32 m0, s45, 0
s_nop 0
buffer_load_dwordx4 v240, s[84:87], s28 offen offset:0 sc1 lds
s_add_u32 m0, s45, 0
s_nop 0
buffer_load_dwordx4 v240, s[84:87], s28 offen offset:1024 sc1 lds
s_add_u32 m0, s45, 2048
s_nop 0
buffer_load_dwordx4 v241, s[84:87], s28 offen offset:0 sc1 lds
s_add_u32 m0, s45, 2048
s_nop 0
buffer_load_dwordx4 v241, s[84:87], s28 offen offset:1024 sc1 lds
s_add_u32 s45, s45, 4096
s_cmp_eq_u32 s45, 30720
s_cselect_b32 s45, 18432, s45
s_waitcnt vmcnt(0)
mega_kernel_rs_x5:
s_add_u32 s76, s27, 4
s_min_u32 s76, s76, 63
s_cmp_gt_i32 s46, s76
s_cbranch_scc1 mega_kernel_rs_x6
v_mov_b32 v249, 0
s_mov_b64 exec, 3
buffer_atomic_add v249, v24, s[84:87], 0 offen sc0 sc1
s_mov_b64 exec, -1
mega_kernel_rs_x6:
s_add_u32 s76, s27, 2
s_cmp_lt_u32 s76, 63
s_cbranch_scc0 mega_kernel_rs_x4
s_cmp_gt_i32 s46, s76
s_cbranch_scc0 mega_kernel_rs_x4
s_add_u32 s77, s76, s82
s_bfe_u32 s28, s77, 0x40002
s_lshl_b32 s28, s28, 14
s_and_b32 s77, s77, 3
s_lshl_b32 s77, s77, 11
s_add_u32 s28, s28, s77
s_add_u32 s28, s28, s83
s_add_u32 s28, s28, 33554432
s_buffer_load_dword s78, s[84:87], s28 offset:0
s_buffer_load_dword s78, s[84:87], s28 offset:128
s_buffer_load_dword s78, s[84:87], s28 offset:256
s_buffer_load_dword s78, s[84:87], s28 offset:384
s_buffer_load_dword s78, s[84:87], s28 offset:512
s_buffer_load_dword s78, s[84:87], s28 offset:640
s_buffer_load_dword s78, s[84:87], s28 offset:768
s_buffer_load_dword s78, s[84:87], s28 offset:896
s_buffer_load_dword s78, s[84:87], s28 offset:1024
s_buffer_load_dword s78, s[84:87], s28 offset:1152
s_buffer_load_dword s78, s[84:87], s28 offset:1280
s_buffer_load_dword s78, s[84:87], s28 offset:1408
s_buffer_load_dword s78, s[84:87], s28 offset:1536
s_buffer_load_dword s78, s[84:87], s28 offset:1664
s_buffer_load_dword s78, s[84:87], s28 offset:1792
s_buffer_load_dword s78, s[84:87], s28 offset:1920
mega_kernel_rs_x4:
v_mov_b32 v96, 0
v_mov_b32 v97, 0
v_mov_b32 v98, 0
v_mov_b32 v99, 0
v_mov_b32 v100, 0
v_mov_b32 v101, 0
v_mov_b32 v102, 0
v_mov_b32 v103, 0
v_mov_b32 v104, 0
v_mov_b32 v105, 0
v_mov_b32 v106, 0
v_mov_b32 v107, 0
v_mov_b32 v108, 0
v_mov_b32 v109, 0
v_mov_b32 v110, 0
v_mov_b32 v111, 0
v_mov_b32 v112, 0
v_mov_b32 v113, 0
v_mov_b32 v114, 0
v_mov_b32 v115, 0
v_mov_b32 v116, 0
v_mov_b32 v117, 0
v_mov_b32 v118, 0
v_mov_b32 v119, 0
s_branch mega_kernel_rs_b5
mega_kernel_rs_il2:
s_cbranch_execz mega_kernel_rs_il3
mega_kernel_rs_p2r:
s_mov_b64 exec, s[42:43]
buffer_load_dwordx4 v[188:191], v10, s[84:87], s76 offen sc1
buffer_load_dwordx4 v[196:199], v10, s[84:87], s77 offen sc1
buffer_load_dwordx4 v[204:207], v10, s[84:87], s78 offen sc1
s_mov_b64 exec, -1
buffer_load_dwordx4 v[184:187], v17, s[84:87], s76 offen sc1
buffer_load_dwordx4 v[192:195], v17, s[84:87], s77 offen sc1
buffer_load_dwordx4 v[200:203], v17, s[84:87], s78 offen sc1
s_branch mega_kernel_rs_p2
mega_kernel_rs_il3:
s_cbranch_execz mega_kernel_rs_il4
.p2align 5
mega_kernel_rs_pa_1_0f:
s_mov_b64 exec, vcc
buffer_load_dwordx4 v[32:35], v7, s[84:87], s33 offen offset:0 sc1
s_mov_b64 exec, -1
s_branch mega_kernel_rs_pa_1_0
.p2align 5
mega_kernel_rs_pa_1_0:
s_waitcnt vmcnt(0)
v_max_u32 v4, v32, v34
v_cmp_eq_u32 vcc, -1, v4
s_cbranch_vccnz mega_kernel_rs_pa_1_0f
v_smfmac_f32_16x16x64_bf16 v[96:99], v[32:35], a[0:7], v6
v_smfmac_f32_16x16x64_bf16 v[100:103], v[32:35], a[32:39], v6
v_smfmac_f32_16x16x64_bf16 v[104:107], v[32:35], a[64:71], v6
v_smfmac_f32_16x16x64_bf16 v[108:111], v[32:35], a[96:103], v6
s_branch mega_kernel_rs_pa_d
mega_kernel_rs_il4:
s_cbranch_execz mega_kernel_rs_il5
.p2align 5
mega_kernel_rs_pa_2_1f:
s_mov_b64 exec, vcc
buffer_load_dwordx4 v[36:39], v7, s[84:87], s33 offen offset:1024 sc1
s_mov_b64 exec, -1
s_branch mega_kernel_rs_pa_2_1
.p2align 5
mega_kernel_rs_pa_2_1:
s_waitcnt vmcnt(0)
v_max_u32 v4, v36, v38
v_cmp_eq_u32 vcc, -1, v4
s_cbranch_vccnz mega_kernel_rs_pa_2_1f
v_smfmac_f32_16x16x64_bf16 v[96:99], v[36:39], a[8:15], v6
v_smfmac_f32_16x16x64_bf16 v[100:103], v[36:39], a[40:47], v6
v_smfmac_f32_16x16x64_bf16 v[104:107], v[36:39], a[72:79], v6
v_smfmac_f32_16x16x64_bf16 v[108:111], v[36:39], a[104:111], v6
s_branch mega_kernel_rs_pa_d
mega_kernel_rs_il5:
s_cbranch_execz mega_kernel_rs_il6
.p2align 5
mega_kernel_rs_pa_3_0f:
s_mov_b64 exec, vcc
buffer_load_dwordx4 v[32:35], v7, s[84:87], s33 offen offset:0 sc1
s_mov_b64 exec, -1
s_branch mega_kernel_rs_pa_3_1
.p2align 5
mega_kernel_rs_pa_3_0:
s_waitcnt vmcnt(1)
v_max_u32 v4, v32, v34
v_cmp_eq_u32 vcc, -1, v4
s_cbranch_vccnz mega_kernel_rs_pa_3_0f
v_smfmac_f32_16x16x64_bf16 v[96:99], v[32:35], a[0:7], v6
v_smfmac_f32_16x16x64_bf16 v[100:103], v[32:35], a[32:39], v6
v_smfmac_f32_16x16x64_bf16 v[104:107], v[32:35], a[64:71], v6
v_smfmac_f32_16x16x64_bf16 v[108:111], v[32:35], a[96:103], v6
s_branch mega_kernel_rs_pa_2_1
mega_kernel_rs_il6:
s_cbranch_execz mega_kernel_rs_il7
.p2align 5
mega_kernel_rs_pa_3_1f:
s_mov_b64 exec, vcc
buffer_load_dwordx4 v[36:39], v7, s[84:87], s33 offen offset:1024 sc1
s_mov_b64 exec, -1
s_branch mega_kernel_rs_pa_3_0
.p2align 5
mega_kernel_rs_pa_3_1:
s_waitcnt vmcnt(1)
v_max_u32 v4, v36, v38
v_cmp_eq_u32 vcc, -1, v4
s_cbranch_vccnz mega_kernel_rs_pa_3_1f
v_smfmac_f32_16x16x64_bf16 v[96:99], v[36:39], a[8:15], v6
v_smfmac_f32_16x16x64_bf16 v[100:103], v[36:39], a[40:47], v6
v_smfmac_f32_16x16x64_bf16 v[104:107], v[36:39], a[72:79], v6
v_smfmac_f32_16x16x64_bf16 v[108:111], v[36:39], a[104:111], v6
s_branch mega_kernel_rs_pa_1_0
mega_kernel_rs_il7:
s_cbranch_execz mega_kernel_rs_il8
.p2align 5
mega_kernel_rs_pa_4_2f:
s_mov_b64 exec, vcc
buffer_load_dwordx4 v[40:43], v7, s[84:87], s33 offen offset:2048 sc1
s_mov_b64 exec, -1
s_branch mega_kernel_rs_pa_4_2
.p2align 5
mega_kernel_rs_pa_4_2:
s_waitcnt vmcnt(0)
v_max_u32 v4, v40, v42
v_cmp_eq_u32 vcc, -1, v4
s_cbranch_vccnz mega_kernel_rs_pa_4_2f
v_smfmac_f32_16x16x64_bf16 v[96:99], v[40:43], a[16:23], v6
v_smfmac_f32_16x16x64_bf16 v[100:103], v[40:43], a[48:55], v6
v_smfmac_f32_16x16x64_bf16 v[104:107], v[40:43], a[80:87], v6
v_smfmac_f32_16x16x64_bf16 v[108:111], v[40:43], a[112:119], v6
s_branch mega_kernel_rs_pa_d
mega_kernel_rs_il8:
s_cbranch_execz mega_kernel_rs_il9
.p2align 5
mega_kernel_rs_pa_5_0f:
s_mov_b64 exec, vcc
buffer_load_dwordx4 v[32:35], v7, s[84:87], s33 offen offset:0 sc1
s_mov_b64 exec, -1
s_branch mega_kernel_rs_pa_5_2
.p2align 5
mega_kernel_rs_pa_5_0:
s_waitcnt vmcnt(1)
v_max_u32 v4, v32, v34
v_cmp_eq_u32 vcc, -1, v4
s_cbranch_vccnz mega_kernel_rs_pa_5_0f
v_smfmac_f32_16x16x64_bf16 v[96:99], v[32:35], a[0:7], v6
v_smfmac_f32_16x16x64_bf16 v[100:103], v[32:35], a[32:39], v6
v_smfmac_f32_16x16x64_bf16 v[104:107], v[32:35], a[64:71], v6
v_smfmac_f32_16x16x64_bf16 v[108:111], v[32:35], a[96:103], v6
s_branch mega_kernel_rs_pa_4_2
mega_kernel_rs_il9:
s_cbranch_execz mega_kernel_rs_il10
.p2align 5
mega_kernel_rs_pa_5_2f:
s_mov_b64 exec, vcc
buffer_load_dwordx4 v[40:43], v7, s[84:87], s33 offen offset:2048 sc1
s_mov_b64 exec, -1
s_branch mega_kernel_rs_pa_5_0
.p2align 5
mega_kernel_rs_pa_5_2:
s_waitcnt vmcnt(1)
v_max_u32 v4, v40, v42
v_cmp_eq_u32 vcc, -1, v4
s_cbranch_vccnz mega_kernel_rs_pa_5_2f
v_smfmac_f32_16x16x64_bf16 v[96:99], v[40:43], a[16:23], v6
v_smfmac_f32_16x16x64_bf16 v[100:103], v[40:43], a[48:55], v6
v_smfmac_f32_16x16x64_bf16 v[104:107], v[40:43], a[80:87], v6
v_smfmac_f32_16x16x64_bf16 v[108:111], v[40:43], a[112:119], v6
s_branch mega_kernel_rs_pa_1_0
mega_kernel_rs_il10:
s_cbranch_execz mega_kernel_rs_il11
.p2align 5
mega_kernel_rs_pa_6_1f:
s_mov_b64 exec, vcc
buffer_load_dwordx4 v[36:39], v7, s[84:87], s33 offen offset:1024 sc1
s_mov_b64 exec, -1
s_branch mega_kernel_rs_pa_6_2
.p2align 5
mega_kernel_rs_pa_6_1:
s_waitcnt vmcnt(1)
v_max_u32 v4, v36, v38
v_cmp_eq_u32 vcc, -1, v4
s_cbranch_vccnz mega_kernel_rs_pa_6_1f
v_smfmac_f32_16x16x64_bf16 v[96:99], v[36:39], a[8:15], v6
v_smfmac_f32_16x16x64_bf16 v[100:103], v[36:39], a[40:47], v6
v_smfmac_f32_16x16x64_bf16 v[104:107], v[36:39], a[72:79], v6
v_smfmac_f32_16x16x64_bf16 v[108:111], v[36:39], a[104:111], v6
s_branch mega_kernel_rs_pa_4_2
mega_kernel_rs_il11:
s_cbranch_execz mega_kernel_rs_il12
.p2align 5
mega_kernel_rs_pa_6_2f:
s_mov_b64 exec, vcc
buffer_load_dwordx4 v[40:43], v7, s[84:87], s33 offen offset:2048 sc1
s_mov_b64 exec, -1
s_branch mega_kernel_rs_pa_6_1
.p2align 5
mega_kernel_rs_pa_6_2:
s_waitcnt vmcnt(1)
v_max_u32 v4, v40, v42
v_cmp_eq_u32 vcc, -1, v4
s_cbranch_vccnz mega_kernel_rs_pa_6_2f
v_smfmac_f32_16x16x64_bf16 v[96:99], v[40:43], a[16:23], v6
v_smfmac_f32_16x16x64_bf16 v[100:103], v[40:43], a[48:55], v6
v_smfmac_f32_16x16x64_bf16 v[104:107], v[40:43], a[80:87], v6
v_smfmac_f32_16x16x64_bf16 v[108:111], v[40:43], a[112:119], v6
s_branch mega_kernel_rs_pa_2_1
mega_kernel_rs_il12:
s_cbranch_execz mega_kernel_rs_il13
.p2align 5
mega_kernel_rs_pa_7_0f:
s_mov_b64 exec, vcc
buffer_load_dwordx4 v[32:35], v7, s[84:87], s33 offen offset:0 sc1
s_mov_b64 exec, -1
s_branch mega_kernel_rs_pa_7_1
.p2align 5
mega_kernel_rs_pa_7_0:
s_waitcnt vmcnt(2)
v_max_u32 v4, v32, v34
v_cmp_eq_u32 vcc, -1, v4
s_cbranch_vccnz mega_kernel_rs_pa_7_0f
v_smfmac_f32_16x16x64_bf16 v[96:99], v[32:35], a[0:7], v6
v_smfmac_f32_16x16x64_bf16 v[100:103], v[32:35], a[32:39], v6
v_smfmac_f32_16x16x64_bf16 v[104:107], v[32:35], a[64:71], v6
v_smfmac_f32_16x16x64_bf16 v[108:111], v[32:35], a[96:103], v6
s_branch mega_kernel_rs_pa_6_1
mega_kernel_rs_il13:
s_cbranch_execz mega_kernel_rs_il14
.p2align 5
mega_kernel_rs_pa_7_1f:
s_mov_b64 exec, vcc
buffer_load_dwordx4 v[36:39], v7, s[84:87], s33 offen offset:1024 sc1
s_mov_b64 exec, -1
s_branch mega_kernel_rs_pa_7_2
.p2align 5
mega_kernel_rs_pa_7_1:
s_waitcnt vmcnt(2)
v_max_u32 v4, v36, v38
v_cmp_eq_u32 vcc, -1, v4
s_cbranch_vccnz mega_kernel_rs_pa_7_1f
v_smfmac_f32_16x16x64_bf16 v[96:99], v[36:39], a[8:15], v6
v_smfmac_f32_16x16x64_bf16 v[100:103], v[36:39], a[40:47], v6
v_smfmac_f32_16x16x64_bf16 v[104:107], v[36:39], a[72:79], v6
v_smfmac_f32_16x16x64_bf16 v[108:111], v[36:39], a[104:111], v6
s_branch mega_kernel_rs_pa_5_2
mega_kernel_rs_il14:
s_cbranch_execz mega_kernel_rs_il15
.p2align 5
mega_kernel_rs_pa_7_2f:
s_mov_b64 exec, vcc
buffer_load_dwordx4 v[40:43], v7, s[84:87], s33 offen offset:2048 sc1
s_mov_b64 exec, -1
s_branch mega_kernel_rs_pa_7_0
.p2align 5
mega_kernel_rs_pa_7_2:
s_waitcnt vmcnt(2)
v_max_u32 v4, v40, v42
v_cmp_eq_u32 vcc, -1, v4
s_cbranch_vccnz mega_kernel_rs_pa_7_2f
v_smfmac_f32_16x16x64_bf16 v[96:99], v[40:43], a[16:23], v6
v_smfmac_f32_16x16x64_bf16 v[100:103], v[40:43], a[48:55], v6
v_smfmac_f32_16x16x64_bf16 v[104:107], v[40:43], a[80:87], v6
v_smfmac_f32_16x16x64_bf16 v[108:111], v[40:43], a[112:119], v6
s_branch mega_kernel_rs_pa_3_0
mega_kernel_rs_il15:
s_cbranch_execz mega_kernel_rs_il16
.p2align 5
mega_kernel_rs_pa_8_3f:
s_mov_b64 exec, vcc
buffer_load_dwordx4 v[44:47], v7, s[84:87], s33 offen offset:3072 sc1
s_mov_b64 exec, -1
s_branch mega_kernel_rs_pa_8_3
.p2align 5
mega_kernel_rs_pa_8_3:
s_waitcnt vmcnt(0)
v_max_u32 v4, v44, v46
v_cmp_eq_u32 vcc, -1, v4
s_cbranch_vccnz mega_kernel_rs_pa_8_3f
v_smfmac_f32_16x16x64_bf16 v[96:99], v[44:47], a[24:31], v6
v_smfmac_f32_16x16x64_bf16 v[100:103], v[44:47], a[56:63], v6
v_smfmac_f32_16x16x64_bf16 v[104:107], v[44:47], a[88:95], v6
v_smfmac_f32_16x16x64_bf16 v[108:111], v[44:47], a[120:127], v6
s_branch mega_kernel_rs_pa_d
mega_kernel_rs_il16:
s_cbranch_execz mega_kernel_rs_il17
.p2align 5
mega_kernel_rs_pa_9_0f:
s_mov_b64 exec, vcc
buffer_load_dwordx4 v[32:35], v7, s[84:87], s33 offen offset:0 sc1
s_mov_b64 exec, -1
s_branch mega_kernel_rs_pa_9_3
.p2align 5
mega_kernel_rs_pa_9_0:
s_waitcnt vmcnt(1)
v_max_u32 v4, v32, v34
v_cmp_eq_u32 vcc, -1, v4
s_cbranch_vccnz mega_kernel_rs_pa_9_0f
v_smfmac_f32_16x16x64_bf16 v[96:99], v[32:35], a[0:7], v6
v_smfmac_f32_16x16x64_bf16 v[100:103], v[32:35], a[32:39], v6
v_smfmac_f32_16x16x64_bf16 v[104:107], v[32:35], a[64:71], v6
v_smfmac_f32_16x16x64_bf16 v[108:111], v[32:35], a[96:103], v6
s_branch mega_kernel_rs_pa_8_3
mega_kernel_rs_il17:
s_cbranch_execz mega_kernel_rs_il18
.p2align 5
mega_kernel_rs_pa_9_3f:
s_mov_b64 exec, vcc
buffer_load_dwordx4 v[44:47], v7, s[84:87], s33 offen offset:3072 sc1
s_mov_b64 exec, -1
s_branch mega_kernel_rs_pa_9_0
.p2align 5
mega_kernel_rs_pa_9_3:
s_waitcnt vmcnt(1)
v_max_u32 v4, v44, v46
v_cmp_eq_u32 vcc, -1, v4
s_cbranch_vccnz mega_kernel_rs_pa_9_3f
v_smfmac_f32_16x16x64_bf16 v[96:99], v[44:47], a[24:31], v6
v_smfmac_f32_16x16x64_bf16 v[100:103], v[44:47], a[56:63], v6
v_smfmac_f32_16x16x64_bf16 v[104:107], v[44:47], a[88:95], v6
v_smfmac_f32_16x16x64_bf16 v[108:111], v[44:47], a[120:127], v6
s_branch mega_kernel_rs_pa_1_0
mega_kernel_rs_il18:
s_cbranch_execz mega_kernel_rs_iwd
.p2align 5
mega_kernel_rs_pa_10_1f:
s_mov_b64 exec, vcc
buffer_load_dwordx4 v[36:39], v7, s[84:87], s33 offen offset:1024 sc1
s_mov_b64 exec, -1
s_branch mega_kernel_rs_pa_10_3
.p2align 5
mega_kernel_rs_pa_10_1:
s_waitcnt vmcnt(1)
v_max_u32 v4, v36, v38
v_cmp_eq_u32 vcc, -1, v4
s_cbranch_vccnz mega_kernel_rs_pa_10_1f
v_smfmac_f32_16x16x64_bf16 v[96:99], v[36:39], a[8:15], v6
v_smfmac_f32_16x16x64_bf16 v[100:103], v[36:39], a[40:47], v6
v_smfmac_f32_16x16x64_bf16 v[104:107], v[36:39], a[72:79], v6
v_smfmac_f32_16x16x64_bf16 v[108:111], v[36:39], a[104:111], v6
s_branch mega_kernel_rs_pa_8_3
mega_kernel_rs_iw1:
mega_kernel_rs_il19:
s_cbranch_execz mega_kernel_rs_il20
.p2align 5
mega_kernel_rs_pa_10_3f:
s_mov_b64 exec, vcc
buffer_load_dwordx4 v[44:47], v7, s[84:87], s33 offen offset:3072 sc1
s_mov_b64 exec, -1
s_branch mega_kernel_rs_pa_10_1
.p2align 5
mega_kernel_rs_pa_10_3:
s_waitcnt vmcnt(1)
v_max_u32 v4, v44, v46
v_cmp_eq_u32 vcc, -1, v4
s_cbranch_vccnz mega_kernel_rs_pa_10_3f
v_smfmac_f32_16x16x64_bf16 v[96:99], v[44:47], a[24:31], v6
v_smfmac_f32_16x16x64_bf16 v[100:103], v[44:47], a[56:63], v6
v_smfmac_f32_16x16x64_bf16 v[104:107], v[44:47], a[88:95], v6
v_smfmac_f32_16x16x64_bf16 v[108:111], v[44:47], a[120:127], v6
s_branch mega_kernel_rs_pa_2_1
mega_kernel_rs_il20:
s_cbranch_execz mega_kernel_rs_il21
.p2align 5
mega_kernel_rs_pa_11_0f:
s_mov_b64 exec, vcc
buffer_load_dwordx4 v[32:35], v7, s[84:87], s33 offen offset:0 sc1
s_mov_b64 exec, -1
s_branch mega_kernel_rs_pa_11_1
.p2align 5
mega_kernel_rs_pa_11_0:
s_waitcnt vmcnt(2)
v_max_u32 v4, v32, v34
v_cmp_eq_u32 vcc, -1, v4
s_cbranch_vccnz mega_kernel_rs_pa_11_0f
v_smfmac_f32_16x16x64_bf16 v[96:99], v[32:35], a[0:7], v6
v_smfmac_f32_16x16x64_bf16 v[100:103], v[32:35], a[32:39], v6
v_smfmac_f32_16x16x64_bf16 v[104:107], v[32:35], a[64:71], v6
v_smfmac_f32_16x16x64_bf16 v[108:111], v[32:35], a[96:103], v6
s_branch mega_kernel_rs_pa_10_1
mega_kernel_rs_il21:
s_cbranch_execz mega_kernel_rs_il22
.p2align 5
mega_kernel_rs_pa_11_1f:
s_mov_b64 exec, vcc
buffer_load_dwordx4 v[36:39], v7, s[84:87], s33 offen offset:1024 sc1
s_mov_b64 exec, -1
s_branch mega_kernel_rs_pa_11_3
.p2align 5
mega_kernel_rs_pa_11_1:
s_waitcnt vmcnt(2)
v_max_u32 v4, v36, v38
v_cmp_eq_u32 vcc, -1, v4
s_cbranch_vccnz mega_kernel_rs_pa_11_1f
v_smfmac_f32_16x16x64_bf16 v[96:99], v[36:39], a[8:15], v6
v_smfmac_f32_16x16x64_bf16 v[100:103], v[36:39], a[40:47], v6
v_smfmac_f32_16x16x64_bf16 v[104:107], v[36:39], a[72:79], v6
v_smfmac_f32_16x16x64_bf16 v[108:111], v[36:39], a[104:111], v6
s_branch mega_kernel_rs_pa_9_3
mega_kernel_rs_il22:
s_cbranch_execz mega_kernel_rs_il23
.p2align 5
mega_kernel_rs_pa_11_3f:
s_mov_b64 exec, vcc
buffer_load_dwordx4 v[44:47], v7, s[84:87], s33 offen offset:3072 sc1
s_mov_b64 exec, -1
s_branch mega_kernel_rs_pa_11_0
.p2align 5
mega_kernel_rs_pa_11_3:
s_waitcnt vmcnt(2)
v_max_u32 v4, v44, v46
v_cmp_eq_u32 vcc, -1, v4
s_cbranch_vccnz mega_kernel_rs_pa_11_3f
v_smfmac_f32_16x16x64_bf16 v[96:99], v[44:47], a[24:31], v6
v_smfmac_f32_16x16x64_bf16 v[100:103], v[44:47], a[56:63], v6
v_smfmac_f32_16x16x64_bf16 v[104:107], v[44:47], a[88:95], v6
v_smfmac_f32_16x16x64_bf16 v[108:111], v[44:47], a[120:127], v6
s_branch mega_kernel_rs_pa_3_0
mega_kernel_rs_il23:
s_cbranch_execz mega_kernel_rs_il24
.p2align 5
mega_kernel_rs_pa_12_2f:
s_mov_b64 exec, vcc
buffer_load_dwordx4 v[40:43], v7, s[84:87], s33 offen offset:2048 sc1
s_mov_b64 exec, -1
s_branch mega_kernel_rs_pa_12_3
.p2align 5
mega_kernel_rs_pa_12_2:
s_waitcnt vmcnt(1)
v_max_u32 v4, v40, v42
v_cmp_eq_u32 vcc, -1, v4
s_cbranch_vccnz mega_kernel_rs_pa_12_2f
v_smfmac_f32_16x16x64_bf16 v[96:99], v[40:43], a[16:23], v6
v_smfmac_f32_16x16x64_bf16 v[100:103], v[40:43], a[48:55], v6
v_smfmac_f32_16x16x64_bf16 v[104:107], v[40:43], a[80:87], v6
v_smfmac_f32_16x16x64_bf16 v[108:111], v[40:43], a[112:119], v6
s_branch mega_kernel_rs_pa_8_3
mega_kernel_rs_il24:
s_cbranch_execz mega_kernel_rs_il25
.p2align 5
mega_kernel_rs_pa_12_3f:
s_mov_b64 exec, vcc
buffer_load_dwordx4 v[44:47], v7, s[84:87], s33 offen offset:3072 sc1
s_mov_b64 exec, -1
s_branch mega_kernel_rs_pa_12_2
.p2align 5
mega_kernel_rs_pa_12_3:
s_waitcnt vmcnt(1)
v_max_u32 v4, v44, v46
v_cmp_eq_u32 vcc, -1, v4
s_cbranch_vccnz mega_kernel_rs_pa_12_3f
v_smfmac_f32_16x16x64_bf16 v[96:99], v[44:47], a[24:31], v6
v_smfmac_f32_16x16x64_bf16 v[100:103], v[44:47], a[56:63], v6
v_smfmac_f32_16x16x64_bf16 v[104:107], v[44:47], a[88:95], v6
v_smfmac_f32_16x16x64_bf16 v[108:111], v[44:47], a[120:127], v6
s_branch mega_kernel_rs_pa_4_2
mega_kernel_rs_il25:
s_cbranch_execz mega_kernel_rs_il26
.p2align 5
mega_kernel_rs_pa_13_0f:
s_mov_b64 exec, vcc
buffer_load_dwordx4 v[32:35], v7, s[84:87], s33 offen offset:0 sc1
s_mov_b64 exec, -1
s_branch mega_kernel_rs_pa_13_2
.p2align 5
mega_kernel_rs_pa_13_0:
s_waitcnt vmcnt(2)
v_max_u32 v4, v32, v34
v_cmp_eq_u32 vcc, -1, v4
s_cbranch_vccnz mega_kernel_rs_pa_13_0f
v_smfmac_f32_16x16x64_bf16 v[96:99], v[32:35], a[0:7], v6
v_smfmac_f32_16x16x64_bf16 v[100:103], v[32:35], a[32:39], v6
v_smfmac_f32_16x16x64_bf16 v[104:107], v[32:35], a[64:71], v6
v_smfmac_f32_16x16x64_bf16 v[108:111], v[32:35], a[96:103], v6
s_branch mega_kernel_rs_pa_12_2
mega_kernel_rs_il26:
s_cbranch_execz mega_kernel_rs_il27
.p2align 5
mega_kernel_rs_pa_13_2f:
s_mov_b64 exec, vcc
buffer_load_dwordx4 v[40:43], v7, s[84:87], s33 offen offset:2048 sc1
s_mov_b64 exec, -1
s_branch mega_kernel_rs_pa_13_3
.p2align 5
mega_kernel_rs_pa_13_2:
s_waitcnt vmcnt(2)
v_max_u32 v4, v40, v42
v_cmp_eq_u32 vcc, -1, v4
s_cbranch_vccnz mega_kernel_rs_pa_13_2f
v_smfmac_f32_16x16x64_bf16 v[96:99], v[40:43], a[16:23], v6
v_smfmac_f32_16x16x64_bf16 v[100:103], v[40:43], a[48:55], v6
v_smfmac_f32_16x16x64_bf16 v[104:107], v[40:43], a[80:87], v6
v_smfmac_f32_16x16x64_bf16 v[108:111], v[40:43], a[112:119], v6
s_branch mega_kernel_rs_pa_9_3
mega_kernel_rs_il27:
s_cbranch_execz mega_kernel_rs_il28
.p2align 5
mega_kernel_rs_pa_13_3f:
s_mov_b64 exec, vcc
buffer_load_dwordx4 v[44:47], v7, s[84:87], s33 offen offset:3072 sc1
s_mov_b64 exec, -1
s_branch mega_kernel_rs_pa_13_0
.p2align 5
mega_kernel_rs_pa_13_3:
s_waitcnt vmcnt(2)
v_max_u32 v4, v44, v46
v_cmp_eq_u32 vcc, -1, v4
s_cbranch_vccnz mega_kernel_rs_pa_13_3f
v_smfmac_f32_16x16x64_bf16 v[96:99], v[44:47], a[24:31], v6
v_smfmac_f32_16x16x64_bf16 v[100:103], v[44:47], a[56:63], v6
v_smfmac_f32_16x16x64_bf16 v[104:107], v[44:47], a[88:95], v6
v_smfmac_f32_16x16x64_bf16 v[108:111], v[44:47], a[120:127], v6
s_branch mega_kernel_rs_pa_5_0
mega_kernel_rs_il28:
s_cbranch_execz mega_kernel_rs_il29
.p2align 5
mega_kernel_rs_pa_14_1f:
s_mov_b64 exec, vcc
buffer_load_dwordx4 v[36:39], v7, s[84:87], s33 offen offset:1024 sc1
s_mov_b64 exec, -1
s_branch mega_kernel_rs_pa_14_2
.p2align 5
mega_kernel_rs_pa_14_1:
s_waitcnt vmcnt(2)
v_max_u32 v4, v36, v38
v_cmp_eq_u32 vcc, -1, v4
s_cbranch_vccnz mega_kernel_rs_pa_14_1f
v_smfmac_f32_16x16x64_bf16 v[96:99], v[36:39], a[8:15], v6
v_smfmac_f32_16x16x64_bf16 v[100:103], v[36:39], a[40:47], v6
v_smfmac_f32_16x16x64_bf16 v[104:107], v[36:39], a[72:79], v6
v_smfmac_f32_16x16x64_bf16 v[108:111], v[36:39], a[104:111], v6
s_branch mega_kernel_rs_pa_12_2
mega_kernel_rs_il29:
s_cbranch_execz mega_kernel_rs_il30
.p2align 5
mega_kernel_rs_pa_14_2f:
s_mov_b64 exec, vcc
buffer_load_dwordx4 v[40:43], v7, s[84:87], s33 offen offset:2048 sc1
s_mov_b64 exec, -1
s_branch mega_kernel_rs_pa_14_3
.p2align 5
mega_kernel_rs_pa_14_2:
s_waitcnt vmcnt(2)
v_max_u32 v4, v40, v42
v_cmp_eq_u32 vcc, -1, v4
s_cbranch_vccnz mega_kernel_rs_pa_14_2f
v_smfmac_f32_16x16x64_bf16 v[96:99], v[40:43], a[16:23], v6
v_smfmac_f32_16x16x64_bf16 v[100:103], v[40:43], a[48:55], v6
v_smfmac_f32_16x16x64_bf16 v[104:107], v[40:43], a[80:87], v6
v_smfmac_f32_16x16x64_bf16 v[108:111], v[40:43], a[112:119], v6
s_branch mega_kernel_rs_pa_10_3
mega_kernel_rs_il30:
s_cbranch_execz mega_kernel_rs_il31
.p2align 5
mega_kernel_rs_pa_14_3f:
s_mov_b64 exec, vcc
buffer_load_dwordx4 v[44:47], v7, s[84:87], s33 offen offset:3072 sc1
s_mov_b64 exec, -1
s_branch mega_kernel_rs_pa_14_1
.p2align 5
mega_kernel_rs_pa_14_3:
s_waitcnt vmcnt(2)
v_max_u32 v4, v44, v46
v_cmp_eq_u32 vcc, -1, v4
s_cbranch_vccnz mega_kernel_rs_pa_14_3f
v_smfmac_f32_16x16x64_bf16 v[96:99], v[44:47], a[24:31], v6
v_smfmac_f32_16x16x64_bf16 v[100:103], v[44:47], a[56:63], v6
v_smfmac_f32_16x16x64_bf16 v[104:107], v[44:47], a[88:95], v6
v_smfmac_f32_16x16x64_bf16 v[108:111], v[44:47], a[120:127], v6
s_branch mega_kernel_rs_pa_6_1
mega_kernel_rs_il31:
s_cbranch_execz mega_kernel_rs_il32
.p2align 5
mega_kernel_rs_pa_15_0f:
s_mov_b64 exec, vcc
buffer_load_dwordx4 v[32:35], v7, s[84:87], s33 offen offset:0 sc1
s_mov_b64 exec, -1
s_branch mega_kernel_rs_pa_15_1
.p2align 5
mega_kernel_rs_pa_15_0:
s_waitcnt vmcnt(3)
v_max_u32 v4, v32, v34
v_cmp_eq_u32 vcc, -1, v4
s_cbranch_vccnz mega_kernel_rs_pa_15_0f
v_smfmac_f32_16x16x64_bf16 v[96:99], v[32:35], a[0:7], v6
v_smfmac_f32_16x16x64_bf16 v[100:103], v[32:35], a[32:39], v6
v_smfmac_f32_16x16x64_bf16 v[104:107], v[32:35], a[64:71], v6
v_smfmac_f32_16x16x64_bf16 v[108:111], v[32:35], a[96:103], v6
s_branch mega_kernel_rs_pa_14_1
mega_kernel_rs_il32:
s_cbranch_execz mega_kernel_rs_il33
.p2align 5
mega_kernel_rs_pa_15_1f:
s_mov_b64 exec, vcc
buffer_load_dwordx4 v[36:39], v7, s[84:87], s33 offen offset:1024 sc1
s_mov_b64 exec, -1
s_branch mega_kernel_rs_pa_15_2
.p2align 5
mega_kernel_rs_pa_15_1:
s_waitcnt vmcnt(3)
v_max_u32 v4, v36, v38
v_cmp_eq_u32 vcc, -1, v4
s_cbranch_vccnz mega_kernel_rs_pa_15_1f
v_smfmac_f32_16x16x64_bf16 v[96:99], v[36:39], a[8:15], v6
v_smfmac_f32_16x16x64_bf16 v[100:103], v[36:39], a[40:47], v6
v_smfmac_f32_16x16x64_bf16 v[104:107], v[36:39], a[72:79], v6
v_smfmac_f32_16x16x64_bf16 v[108:111], v[36:39], a[104:111], v6
s_branch mega_kernel_rs_pa_13_2
mega_kernel_rs_il33:
s_cbranch_execz mega_kernel_rs_il34
.p2align 5
mega_kernel_rs_pa_15_2f:
s_mov_b64 exec, vcc
buffer_load_dwordx4 v[40:43], v7, s[84:87], s33 offen offset:2048 sc1
s_mov_b64 exec, -1
s_branch mega_kernel_rs_pa_15_3
.p2align 5
mega_kernel_rs_pa_15_2:
s_waitcnt vmcnt(3)
v_max_u32 v4, v40, v42
v_cmp_eq_u32 vcc, -1, v4
s_cbranch_vccnz mega_kernel_rs_pa_15_2f
v_smfmac_f32_16x16x64_bf16 v[96:99], v[40:43], a[16:23], v6
v_smfmac_f32_16x16x64_bf16 v[100:103], v[40:43], a[48:55], v6
v_smfmac_f32_16x16x64_bf16 v[104:107], v[40:43], a[80:87], v6
v_smfmac_f32_16x16x64_bf16 v[108:111], v[40:43], a[112:119], v6
s_branch mega_kernel_rs_pa_11_3
mega_kernel_rs_il34:
s_cbranch_execz mega_kernel_rs_il35
.p2align 5
mega_kernel_rs_pa_15_3f:
s_mov_b64 exec, vcc
buffer_load_dwordx4 v[44:47], v7, s[84:87], s33 offen offset:3072 sc1
s_mov_b64 exec, -1
s_branch mega_kernel_rs_pa_15_0
.p2align 5
mega_kernel_rs_pa_15_3:
s_waitcnt vmcnt(3)
v_max_u32 v4, v44, v46
v_cmp_eq_u32 vcc, -1, v4
s_cbranch_vccnz mega_kernel_rs_pa_15_3f
v_smfmac_f32_16x16x64_bf16 v[96:99], v[44:47], a[24:31], v6
v_smfmac_f32_16x16x64_bf16 v[100:103], v[44:47], a[56:63], v6
v_smfmac_f32_16x16x64_bf16 v[104:107], v[44:47], a[88:95], v6
v_smfmac_f32_16x16x64_bf16 v[108:111], v[44:47], a[120:127], v6
s_branch mega_kernel_rs_pa_7_0
mega_kernel_rs_il35:
s_cbranch_execz mega_kernel_rs_il36
.p2align 5
mega_kernel_rs_pc_1_0f:
s_mov_b64 exec, vcc
buffer_load_dwordx4 v[32:35], v7, s[84:87], s29 offen offset:0 sc1
s_mov_b64 exec, -1
s_branch mega_kernel_rs_pc_1_0
.p2align 5
mega_kernel_rs_pc_1_0:
s_waitcnt vmcnt(0)
v_cmp_eq_u32 vcc, -1, v32
s_cbranch_vccnz mega_kernel_rs_pc_1_0f
v_smfmac_f32_16x16x64_bf16 v[96:99], v[32:35], a[192:199], v6
v_smfmac_f32_16x16x64_bf16 v[100:103], v[32:35], a[224:231], v6
s_branch mega_kernel_rs_pc_d
mega_kernel_rs_il36:
s_cbranch_execz mega_kernel_rs_il37
.p2align 5
mega_kernel_rs_pc_2_1f:
s_mov_b64 exec, vcc
buffer_load_dwordx4 v[36:39], v7, s[84:87], s29 offen offset:1024 sc1
s_mov_b64 exec, -1
s_branch mega_kernel_rs_pc_2_1
mega_kernel_rs_il37:
s_cbranch_execz mega_kernel_rs_iwd
.p2align 5
mega_kernel_rs_pc_2_1:
s_waitcnt vmcnt(0)
v_cmp_eq_u32 vcc, -1, v36
s_cbranch_vccnz mega_kernel_rs_pc_2_1f
v_smfmac_f32_16x16x64_bf16 v[96:99], v[36:39], a[200:207], v6
v_smfmac_f32_16x16x64_bf16 v[100:103], v[36:39], a[232:239], v6
s_branch mega_kernel_rs_pc_d
.p2align 5
mega_kernel_rs_pc_3_0f:
s_mov_b64 exec, vcc
buffer_load_dwordx4 v[32:35], v7, s[84:87], s29 offen offset:0 sc1
s_mov_b64 exec, -1
s_branch mega_kernel_rs_pc_3_1
mega_kernel_rs_iw2:
mega_kernel_rs_il38:
s_cbranch_execz mega_kernel_rs_il39
.p2align 5
mega_kernel_rs_pc_3_0:
s_waitcnt vmcnt(1)
v_cmp_eq_u32 vcc, -1, v32
s_cbranch_vccnz mega_kernel_rs_pc_3_0f
v_smfmac_f32_16x16x64_bf16 v[96:99], v[32:35], a[192:199], v6
v_smfmac_f32_16x16x64_bf16 v[100:103], v[32:35], a[224:231], v6
s_branch mega_kernel_rs_pc_2_1
.p2align 5
mega_kernel_rs_pc_3_1f:
s_mov_b64 exec, vcc
buffer_load_dwordx4 v[36:39], v7, s[84:87], s29 offen offset:1024 sc1
s_mov_b64 exec, -1
s_branch mega_kernel_rs_pc_3_0
mega_kernel_rs_il39:
s_cbranch_execz mega_kernel_rs_il40
.p2align 5
mega_kernel_rs_pc_3_1:
s_waitcnt vmcnt(1)
v_cmp_eq_u32 vcc, -1, v36
s_cbranch_vccnz mega_kernel_rs_pc_3_1f
v_smfmac_f32_16x16x64_bf16 v[96:99], v[36:39], a[200:207], v6
v_smfmac_f32_16x16x64_bf16 v[100:103], v[36:39], a[232:239], v6
s_branch mega_kernel_rs_pc_1_0
.p2align 5
mega_kernel_rs_pc_4_2f:
s_mov_b64 exec, vcc
buffer_load_dwordx4 v[40:43], v7, s[84:87], s29 offen offset:2048 sc1
s_mov_b64 exec, -1
s_branch mega_kernel_rs_pc_4_2
mega_kernel_rs_il40:
s_cbranch_execz mega_kernel_rs_il41
.p2align 5
mega_kernel_rs_pc_4_2:
s_waitcnt vmcnt(0)
v_cmp_eq_u32 vcc, -1, v40
s_cbranch_vccnz mega_kernel_rs_pc_4_2f
v_smfmac_f32_16x16x64_bf16 v[96:99], v[40:43], a[208:215], v6
v_smfmac_f32_16x16x64_bf16 v[100:103], v[40:43], a[240:247], v6
s_branch mega_kernel_rs_pc_d
.p2align 5
mega_kernel_rs_pc_5_0f:
s_mov_b64 exec, vcc
buffer_load_dwordx4 v[32:35], v7, s[84:87], s29 offen offset:0 sc1
s_mov_b64 exec, -1
s_branch mega_kernel_rs_pc_5_2
mega_kernel_rs_il41:
s_cbranch_execz mega_kernel_rs_il42
.p2align 5
mega_kernel_rs_pc_5_0:
s_waitcnt vmcnt(1)
v_cmp_eq_u32 vcc, -1, v32
s_cbranch_vccnz mega_kernel_rs_pc_5_0f
v_smfmac_f32_16x16x64_bf16 v[96:99], v[32:35], a[192:199], v6
v_smfmac_f32_16x16x64_bf16 v[100:103], v[32:35], a[224:231], v6
s_branch mega_kernel_rs_pc_4_2
.p2align 5
mega_kernel_rs_pc_5_2f:
s_mov_b64 exec, vcc
buffer_load_dwordx4 v[40:43], v7, s[84:87], s29 offen offset:2048 sc1
s_mov_b64 exec, -1
s_branch mega_kernel_rs_pc_5_0
mega_kernel_rs_il42:
s_cbranch_execz mega_kernel_rs_il43
.p2align 5
mega_kernel_rs_pc_5_2:
s_waitcnt vmcnt(1)
v_cmp_eq_u32 vcc, -1, v40
s_cbranch_vccnz mega_kernel_rs_pc_5_2f
v_smfmac_f32_16x16x64_bf16 v[96:99], v[40:43], a[208:215], v6
v_smfmac_f32_16x16x64_bf16 v[100:103], v[40:43], a[240:247], v6
s_branch mega_kernel_rs_pc_1_0
.p2align 5
mega_kernel_rs_pc_6_1f:
s_mov_b64 exec, vcc
buffer_load_dwordx4 v[36:39], v7, s[84:87], s29 offen offset:1024 sc1
s_mov_b64 exec, -1
s_branch mega_kernel_rs_pc_6_2
mega_kernel_rs_il43:
s_cbranch_execz mega_kernel_rs_il44
.p2align 5
mega_kernel_rs_pc_6_1:
s_waitcnt vmcnt(1)
v_cmp_eq_u32 vcc, -1, v36
s_cbranch_vccnz mega_kernel_rs_pc_6_1f
v_smfmac_f32_16x16x64_bf16 v[96:99], v[36:39], a[200:207], v6
v_smfmac_f32_16x16x64_bf16 v[100:103], v[36:39], a[232:239], v6
s_branch mega_kernel_rs_pc_4_2
.p2align 5
mega_kernel_rs_pc_6_2f:
s_mov_b64 exec, vcc
buffer_load_dwordx4 v[40:43], v7, s[84:87], s29 offen offset:2048 sc1
s_mov_b64 exec, -1
s_branch mega_kernel_rs_pc_6_1
mega_kernel_rs_il44:
s_cbranch_execz mega_kernel_rs_il45
.p2align 5
mega_kernel_rs_pc_6_2:
s_waitcnt vmcnt(1)
v_cmp_eq_u32 vcc, -1, v40
s_cbranch_vccnz mega_kernel_rs_pc_6_2f
v_smfmac_f32_16x16x64_bf16 v[96:99], v[40:43], a[208:215], v6
v_smfmac_f32_16x16x64_bf16 v[100:103], v[40:43], a[240:247], v6
s_branch mega_kernel_rs_pc_2_1
.p2align 5
mega_kernel_rs_pc_7_0f:
s_mov_b64 exec, vcc
buffer_load_dwordx4 v[32:35], v7, s[84:87], s29 offen offset:0 sc1
s_mov_b64 exec, -1
s_branch mega_kernel_rs_pc_7_1
mega_kernel_rs_il45:
s_cbranch_execz mega_kernel_rs_il46
.p2align 5
mega_kernel_rs_pc_7_0:
s_waitcnt vmcnt(2)
v_cmp_eq_u32 vcc, -1, v32
s_cbranch_vccnz mega_kernel_rs_pc_7_0f
v_smfmac_f32_16x16x64_bf16 v[96:99], v[32:35], a[192:199], v6
v_smfmac_f32_16x16x64_bf16 v[100:103], v[32:35], a[224:231], v6
s_branch mega_kernel_rs_pc_6_1
.p2align 5
mega_kernel_rs_pc_7_1f:
s_mov_b64 exec, vcc
buffer_load_dwordx4 v[36:39], v7, s[84:87], s29 offen offset:1024 sc1
s_mov_b64 exec, -1
s_branch mega_kernel_rs_pc_7_2
mega_kernel_rs_il46:
s_cbranch_execz mega_kernel_rs_il47
.p2align 5
mega_kernel_rs_pc_7_1:
s_waitcnt vmcnt(2)
v_cmp_eq_u32 vcc, -1, v36
s_cbranch_vccnz mega_kernel_rs_pc_7_1f
v_smfmac_f32_16x16x64_bf16 v[96:99], v[36:39], a[200:207], v6
v_smfmac_f32_16x16x64_bf16 v[100:103], v[36:39], a[232:239], v6
s_branch mega_kernel_rs_pc_5_2
.p2align 5
mega_kernel_rs_pc_7_2f:
s_mov_b64 exec, vcc
buffer_load_dwordx4 v[40:43], v7, s[84:87], s29 offen offset:2048 sc1
s_mov_b64 exec, -1
s_branch mega_kernel_rs_pc_7_0
mega_kernel_rs_il47:
s_cbranch_execz mega_kernel_rs_il48
.p2align 5
mega_kernel_rs_pc_7_2:
s_waitcnt vmcnt(2)
v_cmp_eq_u32 vcc, -1, v40
s_cbranch_vccnz mega_kernel_rs_pc_7_2f
v_smfmac_f32_16x16x64_bf16 v[96:99], v[40:43], a[208:215], v6
v_smfmac_f32_16x16x64_bf16 v[100:103], v[40:43], a[240:247], v6
s_branch mega_kernel_rs_pc_3_0
.p2align 5
mega_kernel_rs_pc_8_3f:
s_mov_b64 exec, vcc
buffer_load_dwordx4 v[44:47], v7, s[84:87], s29 offen offset:3072 sc1
s_mov_b64 exec, -1
s_branch mega_kernel_rs_pc_8_3
mega_kernel_rs_il48:
s_cbranch_execz mega_kernel_rs_il49
.p2align 5
mega_kernel_rs_pc_9_0f:
s_mov_b64 exec, vcc
buffer_load_dwordx4 v[32:35], v7, s[84:87], s29 offen offset:0 sc1
s_mov_b64 exec, -1
s_branch mega_kernel_rs_pc_9_3
.p2align 5
mega_kernel_rs_pc_9_0:
s_waitcnt vmcnt(1)
v_cmp_eq_u32 vcc, -1, v32
s_cbranch_vccnz mega_kernel_rs_pc_9_0f
v_smfmac_f32_16x16x64_bf16 v[96:99], v[32:35], a[192:199], v6
v_smfmac_f32_16x16x64_bf16 v[100:103], v[32:35], a[224:231], v6
s_branch mega_kernel_rs_pc_8_3
mega_kernel_rs_il49:
s_cbranch_execz mega_kernel_rs_il50
.p2align 5
mega_kernel_rs_pc_9_3f:
s_mov_b64 exec, vcc
buffer_load_dwordx4 v[44:47], v7, s[84:87], s29 offen offset:3072 sc1
s_mov_b64 exec, -1
s_branch mega_kernel_rs_pc_9_0
mega_kernel_rs_il50:
s_cbranch_execz mega_kernel_rs_il51
.p2align 5
mega_kernel_rs_pc_9_3:
s_waitcnt vmcnt(1)
v_cmp_eq_u32 vcc, -1, v44
s_cbranch_vccnz mega_kernel_rs_pc_9_3f
v_smfmac_f32_16x16x64_bf16 v[96:99], v[44:47], a[216:223], v6
v_smfmac_f32_16x16x64_bf16 v[100:103], v[44:47], a[248:255], v6
s_branch mega_kernel_rs_pc_1_0
.p2align 5
mega_kernel_rs_pc_10_1f:
s_mov_b64 exec, vcc
buffer_load_dwordx4 v[36:39], v7, s[84:87], s29 offen offset:1024 sc1
s_mov_b64 exec, -1
s_branch mega_kernel_rs_pc_10_3
mega_kernel_rs_il51:
s_cbranch_execz mega_kernel_rs_il52
.p2align 5
mega_kernel_rs_pc_10_1:
s_waitcnt vmcnt(1)
v_cmp_eq_u32 vcc, -1, v36
s_cbranch_vccnz mega_kernel_rs_pc_10_1f
v_smfmac_f32_16x16x64_bf16 v[96:99], v[36:39], a[200:207], v6
v_smfmac_f32_16x16x64_bf16 v[100:103], v[36:39], a[232:239], v6
s_branch mega_kernel_rs_pc_8_3
.p2align 5
mega_kernel_rs_pc_10_3f:
s_mov_b64 exec, vcc
buffer_load_dwordx4 v[44:47], v7, s[84:87], s29 offen offset:3072 sc1
s_mov_b64 exec, -1
s_branch mega_kernel_rs_pc_10_1
mega_kernel_rs_il52:
s_cbranch_execz mega_kernel_rs_il53
.p2align 5
mega_kernel_rs_pc_10_3:
s_waitcnt vmcnt(1)
v_cmp_eq_u32 vcc, -1, v44
s_cbranch_vccnz mega_kernel_rs_pc_10_3f
v_smfmac_f32_16x16x64_bf16 v[96:99], v[44:47], a[216:223], v6
v_smfmac_f32_16x16x64_bf16 v[100:103], v[44:47], a[248:255], v6
s_branch mega_kernel_rs_pc_2_1
.p2align 5
mega_kernel_rs_pc_11_0f:
s_mov_b64 exec, vcc
buffer_load_dwordx4 v[32:35], v7, s[84:87], s29 offen offset:0 sc1
s_mov_b64 exec, -1
s_branch mega_kernel_rs_pc_11_1
mega_kernel_rs_il53:
s_cbranch_execz mega_kernel_rs_il54
.p2align 5
mega_kernel_rs_pc_11_0:
s_waitcnt vmcnt(2)
v_cmp_eq_u32 vcc, -1, v32
s_cbranch_vccnz mega_kernel_rs_pc_11_0f
v_smfmac_f32_16x16x64_bf16 v[96:99], v[32:35], a[192:199], v6
v_smfmac_f32_16x16x64_bf16 v[100:103], v[32:35], a[224:231], v6
s_branch mega_kernel_rs_pc_10_1
.p2align 5
mega_kernel_rs_pc_11_1f:
s_mov_b64 exec, vcc
buffer_load_dwordx4 v[36:39], v7, s[84:87], s29 offen offset:1024 sc1
s_mov_b64 exec, -1
s_branch mega_kernel_rs_pc_11_3
mega_kernel_rs_il54:
s_cbranch_execz mega_kernel_rs_il55
.p2align 5
mega_kernel_rs_pc_11_1:
s_waitcnt vmcnt(2)
v_cmp_eq_u32 vcc, -1, v36
s_cbranch_vccnz mega_kernel_rs_pc_11_1f
v_smfmac_f32_16x16x64_bf16 v[96:99], v[36:39], a[200:207], v6
v_smfmac_f32_16x16x64_bf16 v[100:103], v[36:39], a[232:239], v6
s_branch mega_kernel_rs_pc_9_3
.p2align 5
mega_kernel_rs_pc_11_3f:
s_mov_b64 exec, vcc
buffer_load_dwordx4 v[44:47], v7, s[84:87], s29 offen offset:3072 sc1
s_mov_b64 exec, -1
s_branch mega_kernel_rs_pc_11_0
mega_kernel_rs_il55:
s_cbranch_execz mega_kernel_rs_il56
.p2align 5
mega_kernel_rs_pc_11_3:
s_waitcnt vmcnt(2)
v_cmp_eq_u32 vcc, -1, v44
s_cbranch_vccnz mega_kernel_rs_pc_11_3f
v_smfmac_f32_16x16x64_bf16 v[96:99], v[44:47], a[216:223], v6
v_smfmac_f32_16x16x64_bf16 v[100:103], v[44:47], a[248:255], v6
s_branch mega_kernel_rs_pc_3_0
.p2align 5
mega_kernel_rs_pc_12_2f:
s_mov_b64 exec, vcc
buffer_load_dwordx4 v[40:43], v7, s[84:87], s29 offen offset:2048 sc1
s_mov_b64 exec, -1
s_branch mega_kernel_rs_pc_12_3
mega_kernel_rs_il56:
s_cbranch_execz mega_kernel_rs_iwd
.p2align 5
mega_kernel_rs_pc_12_3f:
s_mov_b64 exec, vcc
buffer_load_dwordx4 v[44:47], v7, s[84:87], s29 offen offset:3072 sc1
s_mov_b64 exec, -1
s_branch mega_kernel_rs_pc_12_2
.p2align 5
mega_kernel_rs_pc_12_3:
s_waitcnt vmcnt(1)
v_cmp_eq_u32 vcc, -1, v44
s_cbranch_vccnz mega_kernel_rs_pc_12_3f
v_smfmac_f32_16x16x64_bf16 v[96:99], v[44:47], a[216:223], v6
v_smfmac_f32_16x16x64_bf16 v[100:103], v[44:47], a[248:255], v6
s_branch mega_kernel_rs_pc_4_2
mega_kernel_rs_iw3:
mega_kernel_rs_il57:
s_cbranch_execz mega_kernel_rs_il58
.p2align 5
mega_kernel_rs_pc_13_0f:
s_mov_b64 exec, vcc
buffer_load_dwordx4 v[32:35], v7, s[84:87], s29 offen offset:0 sc1
s_mov_b64 exec, -1
s_branch mega_kernel_rs_pc_13_2
mega_kernel_rs_il58:
s_cbranch_execz mega_kernel_rs_il59
.p2align 5
mega_kernel_rs_pc_13_0:
s_waitcnt vmcnt(2)
v_cmp_eq_u32 vcc, -1, v32
s_cbranch_vccnz mega_kernel_rs_pc_13_0f
v_smfmac_f32_16x16x64_bf16 v[96:99], v[32:35], a[192:199], v6
v_smfmac_f32_16x16x64_bf16 v[100:103], v[32:35], a[224:231], v6
s_branch mega_kernel_rs_pc_12_2
.p2align 5
mega_kernel_rs_pc_13_2f:
s_mov_b64 exec, vcc
buffer_load_dwordx4 v[40:43], v7, s[84:87], s29 offen offset:2048 sc1
s_mov_b64 exec, -1
s_branch mega_kernel_rs_pc_13_3
mega_kernel_rs_il59:
s_cbranch_execz mega_kernel_rs_il60
.p2align 5
mega_kernel_rs_pc_13_2:
s_waitcnt vmcnt(2)
v_cmp_eq_u32 vcc, -1, v40
s_cbranch_vccnz mega_kernel_rs_pc_13_2f
v_smfmac_f32_16x16x64_bf16 v[96:99], v[40:43], a[208:215], v6
v_smfmac_f32_16x16x64_bf16 v[100:103], v[40:43], a[240:247], v6
s_branch mega_kernel_rs_pc_9_3
.p2align 5
mega_kernel_rs_pc_13_3f:
s_mov_b64 exec, vcc
buffer_load_dwordx4 v[44:47], v7, s[84:87], s29 offen offset:3072 sc1
s_mov_b64 exec, -1
s_branch mega_kernel_rs_pc_13_0
mega_kernel_rs_il60:
s_cbranch_execz mega_kernel_rs_il61
.p2align 5
mega_kernel_rs_pc_13_3:
s_waitcnt vmcnt(2)
v_cmp_eq_u32 vcc, -1, v44
s_cbranch_vccnz mega_kernel_rs_pc_13_3f
v_smfmac_f32_16x16x64_bf16 v[96:99], v[44:47], a[216:223], v6
v_smfmac_f32_16x16x64_bf16 v[100:103], v[44:47], a[248:255], v6
s_branch mega_kernel_rs_pc_5_0
.p2align 5
mega_kernel_rs_pc_14_1f:
s_mov_b64 exec, vcc
buffer_load_dwordx4 v[36:39], v7, s[84:87], s29 offen offset:1024 sc1
s_mov_b64 exec, -1
s_branch mega_kernel_rs_pc_14_2
mega_kernel_rs_il61:
s_cbranch_execz mega_kernel_rs_il62
.p2align 5
mega_kernel_rs_pc_14_2f:
s_mov_b64 exec, vcc
buffer_load_dwordx4 v[40:43], v7, s[84:87], s29 offen offset:2048 sc1
s_mov_b64 exec, -1
s_branch mega_kernel_rs_pc_14_3
.p2align 5
mega_kernel_rs_pc_14_2:
s_waitcnt vmcnt(2)
v_cmp_eq_u32 vcc, -1, v40
s_cbranch_vccnz mega_kernel_rs_pc_14_2f
v_smfmac_f32_16x16x64_bf16 v[96:99], v[40:43], a[208:215], v6
v_smfmac_f32_16x16x64_bf16 v[100:103], v[40:43], a[240:247], v6
s_branch mega_kernel_rs_pc_10_3
mega_kernel_rs_il62:
s_cbranch_execz mega_kernel_rs_il63
.p2align 5
mega_kernel_rs_pc_14_3f:
s_mov_b64 exec, vcc
buffer_load_dwordx4 v[44:47], v7, s[84:87], s29 offen offset:3072 sc1
s_mov_b64 exec, -1
s_branch mega_kernel_rs_pc_14_1
mega_kernel_rs_il63:
s_cbranch_execz mega_kernel_rs_il64
.p2align 5
mega_kernel_rs_pc_14_3:
s_waitcnt vmcnt(2)
v_cmp_eq_u32 vcc, -1, v44
s_cbranch_vccnz mega_kernel_rs_pc_14_3f
v_smfmac_f32_16x16x64_bf16 v[96:99], v[44:47], a[216:223], v6
v_smfmac_f32_16x16x64_bf16 v[100:103], v[44:47], a[248:255], v6
s_branch mega_kernel_rs_pc_6_1
.p2align 5
mega_kernel_rs_pc_15_0f:
s_mov_b64 exec, vcc
buffer_load_dwordx4 v[32:35], v7, s[84:87], s29 offen offset:0 sc1
s_mov_b64 exec, -1
s_branch mega_kernel_rs_pc_15_1
mega_kernel_rs_il64:
s_cbranch_execz mega_kernel_rs_il65
.p2align 5
mega_kernel_rs_pc_15_1f:
s_mov_b64 exec, vcc
buffer_load_dwordx4 v[36:39], v7, s[84:87], s29 offen offset:1024 sc1
s_mov_b64 exec, -1
s_branch mega_kernel_rs_pc_15_2
.p2align 5
mega_kernel_rs_pc_15_1:
s_waitcnt vmcnt(3)
v_cmp_eq_u32 vcc, -1, v36
s_cbranch_vccnz mega_kernel_rs_pc_15_1f
v_smfmac_f32_16x16x64_bf16 v[96:99], v[36:39], a[200:207], v6
v_smfmac_f32_16x16x64_bf16 v[100:103], v[36:39], a[232:239], v6
s_branch mega_kernel_rs_pc_13_2
mega_kernel_rs_il65:
s_cbranch_execz mega_kernel_rs_il66
.p2align 5
mega_kernel_rs_pc_15_2f:
s_mov_b64 exec, vcc
buffer_load_dwordx4 v[40:43], v7, s[84:87], s29 offen offset:2048 sc1
s_mov_b64 exec, -1
s_branch mega_kernel_rs_pc_15_3
mega_kernel_rs_il66:
s_cbranch_execz mega_kernel_rs_il67
.p2align 5
mega_kernel_rs_pc_15_2:
s_waitcnt vmcnt(3)
v_cmp_eq_u32 vcc, -1, v40
s_cbranch_vccnz mega_kernel_rs_pc_15_2f
v_smfmac_f32_16x16x64_bf16 v[96:99], v[40:43], a[208:215], v6
v_smfmac_f32_16x16x64_bf16 v[100:103], v[40:43], a[240:247], v6
s_branch mega_kernel_rs_pc_11_3
.p2align 5
mega_kernel_rs_pc_15_3f:
s_mov_b64 exec, vcc
buffer_load_dwordx4 v[44:47], v7, s[84:87], s29 offen offset:3072 sc1
s_mov_b64 exec, -1
s_branch mega_kernel_rs_pc_15_0
mega_kernel_rs_il67:
s_cbranch_execz mega_kernel_rs_il68
.p2align 5
mega_kernel_rs_pc_15_3:
s_waitcnt vmcnt(3)
v_cmp_eq_u32 vcc, -1, v44
s_cbranch_vccnz mega_kernel_rs_pc_15_3f
v_smfmac_f32_16x16x64_bf16 v[96:99], v[44:47], a[216:223], v6
v_smfmac_f32_16x16x64_bf16 v[100:103], v[44:47], a[248:255], v6
s_branch mega_kernel_rs_pc_7_0
mega_kernel_rs_w0last:
s_nop 7
v_permlane32_swap_b32 v112, v116
v_permlane32_swap_b32 v113, v117
v_permlane32_swap_b32 v114, v118
v_permlane32_swap_b32 v115, v119
v_pk_add_f32 v[112:113], v[112:113], v[116:117]
v_pk_add_f32 v[114:115], v[114:115], v[118:119]
ds_write_b128 v20, v[112:115]
s_waitcnt lgkmcnt(0)
s_barrier
s_branch mega_kernel_rs_end
mega_kernel_rs_il68:
s_cbranch_execz mega_kernel_rs_il69
mega_kernel_rs_side:
s_cmp_eq_u32 s24, 3
s_cbranch_scc1 mega_kernel_rs_sd3
s_cmp_eq_u32 s24, 2
s_cbranch_scc0 mega_kernel_rs_sd4
s_mov_b64 exec, s[40:41]
buffer_store_dwordx4 v[28:31], v11, s[84:87], s34 offen sc1
s_mov_b64 exec, -1
buffer_store_dwordx2 v[28:29], v9, s[84:87], s34 offen sc1
s_mul_i32 s28, s31, 1280
s_add_u32 s28, s28, s34
s_add_u32 s28, s28, 49152
buffer_store_dwordx4 v[28:31], v17, s[84:87], s28 offen sc1
buffer_store_dwordx4 v[28:31], v10, s[84:87], s28 offen sc1
s_branch mega_kernel_rs_sd4
mega_kernel_rs_il69:
s_cbranch_execz mega_kernel_rs_il70
mega_kernel_rs_sd3:
v_readlane_b32 s76, v249, 0
v_readlane_b32 s77, v249, 1
s_min_i32 s76, s76, s77
s_max_i32 s46, s46, s76
s_mov_b32 s36, 0
s_add_u32 s76, s27, 1
s_cmp_lt_u32 s76, 63
s_cbranch_scc0 mega_kernel_rs_sd4
s_cmp_ge_u32 s76, 0
s_cbranch_scc0 mega_kernel_rs_sd4
s_cmp_gt_i32 s46, s76
s_cselect_b32 s36, 0, 1
s_cbranch_scc0 mega_kernel_rs_sd4
s_add_u32 s77, s76, s82
s_bfe_u32 s28, s77, 0x40002
s_lshl_b32 s28, s28, 14
s_and_b32 s77, s77, 3
s_lshl_b32 s77, s77, 11
s_add_u32 s28, s28, s77
s_add_u32 m0, s45, 0
s_nop 0
buffer_load_dwordx4 v240, s[84:87], s28 offen offset:0 sc1 lds
s_add_u32 m0, s45, 0
s_nop 0
buffer_load_dwordx4 v240, s[84:87], s28 offen offset:1024 sc1 lds
s_add_u32 m0, s45, 2048
s_nop 0
buffer_load_dwordx4 v241, s[84:87], s28 offen offset:0 sc1 lds
s_add_u32 m0, s45, 2048
s_nop 0
buffer_load_dwordx4 v241, s[84:87], s28 offen offset:1024 sc1 lds
s_add_u32 s45, s45, 4096
s_cmp_eq_u32 s45, 30720
s_cselect_b32 s45, 18432, s45
mega_kernel_rs_sd4:
v_smfmac_f32_16x16x64_bf16 v[112:115], v[40:43], a[144:151], v6
v_smfmac_f32_16x16x64_bf16 v[116:119], v[40:43], a[176:183], v6
v_smfmac_f32_16x16x64_bf16 v[112:115], v[44:47], a[152:159], v6
v_smfmac_f32_16x16x64_bf16 v[116:119], v[44:47], a[184:191], v6
s_nop 7
v_permlane32_swap_b32 v112, v116
v_permlane32_swap_b32 v113, v117
v_permlane32_swap_b32 v114, v118
v_permlane32_swap_b32 v115, v119
v_pk_add_f32 v[112:113], v[112:113], v[116:117]
v_pk_add_f32 v[114:115], v[114:115], v[118:119]
ds_write_b128 v20, v[112:115]
v_mov_b32 v96, 0
v_mov_b32 v97, 0
v_mov_b32 v98, 0
v_mov_b32 v99, 0
v_mov_b32 v100, 0
v_mov_b32 v101, 0
v_mov_b32 v102, 0
v_mov_b32 v103, 0
s_cmp_eq_u32 s24, 1
s_cbranch_scc0 mega_kernel_rs_s1
s_waitcnt lgkmcnt(0)
ds_read_b128 v[120:123], v16 offset:0
ds_read_b128 v[124:127], v16 offset:16
ds_read_b128 v[128:131], v16 offset:2304
ds_read_b128 v[132:135], v16 offset:2320
ds_read_b128 v[136:139], v16 offset:4608
ds_read_b128 v[140:143], v16 offset:4624
ds_read_b128 v[144:147], v16 offset:6912
ds_read_b128 v[148:151], v16 offset:6928
s_waitcnt lgkmcnt(4)
v_pk_add_f32 v[120:121], v[120:121], v[128:129]
v_pk_add_f32 v[122:123], v[122:123], v[130:131]
v_pk_add_f32 v[124:125], v[124:125], v[132:133]
v_pk_add_f32 v[126:127], v[126:127], v[134:135]
s_waitcnt lgkmcnt(0)
v_pk_add_f32 v[136:137], v[136:137], v[144:145]
v_pk_add_f32 v[138:139], v[138:139], v[146:147]
v_pk_add_f32 v[140:141], v[140:141], v[148:149]
v_pk_add_f32 v[142:143], v[142:143], v[150:151]
v_pk_add_f32 v[120:121], v[120:121], v[136:137]
v_pk_add_f32 v[122:123], v[122:123], v[138:139]
v_pk_add_f32 v[124:125], v[124:125], v[140:141]
v_pk_add_f32 v[126:127], v[126:127], v[142:143]
v_cvt_pk_bf16_f32 v244, v120, v121
v_cvt_pk_bf16_f32 v245, v122, v123
v_cvt_pk_bf16_f32 v246, v124, v125
v_cvt_pk_bf16_f32 v247, v126, v127
mega_kernel_rs_s1:
v_add_u32 v5, 9216, v17
s_waitcnt lgkmcnt(0)
s_barrier
s_cmp_eq_u32 s24, 2
s_cbranch_scc1 mega_kernel_rs_s2
s_cmp_eq_u32 s24, 3
s_cbranch_scc0 mega_kernel_rs_s3
s_add_u32 s76, s27, 2
s_cmp_lt_u32 s76, 63
s_cbranch_scc0 mega_kernel_rs_s3
s_cmp_gt_i32 s46, s76
s_cbranch_scc0 mega_kernel_rs_s3
s_add_u32 s77, s76, s82
s_bfe_u32 s28, s77, 0x40002
s_lshl_b32 s28, s28, 14
s_and_b32 s77, s77, 3
s_lshl_b32 s77, s77, 11
s_add_u32 s28, s28, s77
s_add_u32 s28, s28, s83
s_buffer_load_dword s78, s[84:87], s28 offset:0
s_buffer_load_dword s78, s[84:87], s28 offset:128
s_buffer_load_dword s78, s[84:87], s28 offset:256
s_buffer_load_dword s78, s[84:87], s28 offset:384
s_buffer_load_dword s78, s[84:87], s28 offset:512
s_buffer_load_dword s78, s[84:87], s28 offset:640
s_buffer_load_dword s78, s[84:87], s28 offset:768
s_buffer_load_dword s78, s[84:87], s28 offset:896
s_buffer_load_dword s78, s[84:87], s28 offset:1024
s_buffer_load_dword s78, s[84:87], s28 offset:1152
s_buffer_load_dword s78, s[84:87], s28 offset:1280
s_buffer_load_dword s78, s[84:87], s28 offset:1408
s_buffer_load_dword s78, s[84:87], s28 offset:1536
s_buffer_load_dword s78, s[84:87], s28 offset:1664
s_buffer_load_dword s78, s[84:87], s28 offset:1792
s_buffer_load_dword s78, s[84:87], s28 offset:1920
s_mov_b32 s88, s76
s_branch mega_kernel_rs_s3
mega_kernel_rs_il70:
s_cbranch_execz mega_kernel_rs_il71
mega_kernel_rs_s2:
ds_read_b128 v[120:123], v5 offset:0
ds_read_b128 v[124:127], v5 offset:1024
ds_read_b128 v[128:131], v5 offset:2048
ds_read_b128 v[132:135], v5 offset:3072
v_lshrrev_b32 v5, 1, v17
s_waitcnt lgkmcnt(2)
v_pk_add_f32 v[120:121], v[120:121], v[124:125]
v_pk_add_f32 v[122:123], v[122:123], v[126:127]
s_waitcnt lgkmcnt(0)
v_pk_add_f32 v[128:129], v[128:129], v[132:133]
v_pk_add_f32 v[130:131], v[130:131], v[134:135]
v_pk_add_f32 v[120:121], v[120:121], v[128:129]
v_pk_add_f32 v[122:123], v[122:123], v[130:131]
v_cvt_pk_bf16_f32 v244, v120, v121
v_cvt_pk_bf16_f32 v245, v122, v123
ds_write_b64 v5, v[244:245] offset:17920
s_waitcnt lgkmcnt(0) vmcnt(0)
mega_kernel_rs_s3:
s_cmp_eq_u32 s27, 63
s_cbranch_scc1 mega_kernel_rs_slast
s_add_u32 s29, s33, 24576
s_barrier
s_cmp_eq_u32 s24, 3
s_cbranch_scc1 mega_kernel_rs_y3
s_add_u32 s77, s27, s82
s_bfe_u32 s28, s77, 0x30003
s_lshl_b32 s28, s28, 14
s_and_b32 s77, s77, 7
s_lshl_b32 s77, s77, 10
s_add_u32 s28, s28, s77
s_add_u32 s28, s28, s79
s_cmp_eq_u32 s24, 2
s_cbranch_scc1 mega_kernel_rs_kv2a
s_mov_b64 exec, s[48:49]
buffer_store_dwordx4 v[244:247], v22, s[84:87], s28 offen sc1
s_mov_b64 exec, -1
s_branch mega_kernel_rs_kvda
mega_kernel_rs_il71:
s_cbranch_execz mega_kernel_rs_il72
mega_kernel_rs_kv2a:
v_lshlrev_b32 v4, 3, v1
buffer_store_dwordx2 v[244:245], v4, s[84:87], s28 offen offset:512 sc1
mega_kernel_rs_kvda:
s_branch mega_kernel_rs_y4
mega_kernel_rs_y3:
s_add_u32 s76, s27, 2
s_cmp_lt_u32 s76, 63
s_cbranch_scc0 mega_kernel_rs_y4
mega_kernel_rs_y4:
s_branch mega_kernel_rs_b3
mega_kernel_rs_first:
v_add_u32 v5, s44, v17
ds_read_b128 v[156:159], v5 offset:0
ds_read_b128 v[160:163], v5 offset:1024
ds_read_b128 v[164:167], v5 offset:2048
ds_read_b128 v[168:171], v5 offset:3072
s_branch mega_kernel_rs_adone
mega_kernel_rs_il72:
s_cbranch_execz mega_kernel_rs_il73
mega_kernel_rs_slast:
s_cmp_eq_u32 s24, 3
s_cbranch_scc1 mega_kernel_rs_end
s_add_u32 s77, s27, s82
s_bfe_u32 s28, s77, 0x30003
s_lshl_b32 s28, s28, 14
s_and_b32 s77, s77, 7
s_lshl_b32 s77, s77, 10
s_add_u32 s28, s28, s77
s_add_u32 s28, s28, s79
s_cmp_eq_u32 s24, 2
s_cbranch_scc1 mega_kernel_rs_kv2b
s_mov_b64 exec, s[48:49]
buffer_store_dwordx4 v[244:247], v22, s[84:87], s28 offen sc1
s_mov_b64 exec, -1
s_branch mega_kernel_rs_kvdb
mega_kernel_rs_il73:
s_cbranch_execz mega_kernel_rs_iwd
mega_kernel_rs_kv2b:
v_lshlrev_b32 v4, 3, v1
buffer_store_dwordx2 v[244:245], v4, s[84:87], s28 offen offset:512 sc1
mega_kernel_rs_kvdb:
s_waitcnt vmcnt(0)
s_barrier
s_mov_b32 s76, 64
s_cmp_eq_u32 s24, 1
s_cbranch_scc0 mega_kernel_rs_end
v_mov_b32 v5, s76
s_mov_b64 exec, 1
buffer_store_dword v5, v228, s[84:87], s81 offen sc1
s_mov_b64 exec, -1
mega_kernel_rs_end:
s_endpgm
.section .rodata,"a"
.p2align 6
.amdhsa_kernel mega_kernel
  .amdhsa_next_free_vgpr 512
  .amdhsa_next_free_sgpr 102
  .amdhsa_accum_offset 256
  .amdhsa_group_segment_fixed_size 0
  .amdhsa_kernarg_size 104
  .amdhsa_user_sgpr_count 2
  .amdhsa_user_sgpr_kernarg_segment_ptr 1
  .amdhsa_system_sgpr_workgroup_id_x 1
.end_amdhsa_kernel
```

```asm
; @launch kernel=mega_kernel grid=(256,1,1) block=(256,1,1) lds=163840
.amdgcn_target "amdgcn-amd-amdhsa--gfx950"
.text
.globl mega_kernel
.p2align 8
.type mega_kernel,@function
mega_kernel:
s_cmp_ge_u32 s2, 256
s_cbranch_scc1 mega_kernel_exit
s_load_dwordx2 s[84:85], s[0:1], 96
s_load_dwordx2 s[72:73], s[0:1], 88
s_getreg_b32 s90, hwreg(HW_REG_XCC_ID)
s_and_b32 s90, s90, 7
v_mov_b32 v1, 0
v_mov_b32 v2, 1
s_lshl_b32 s91, s90, 2
s_lshr_b32 s91, 1985229328, s91
s_and_b32 s91, s91, 15
s_lshl_b32 s91, s91, 4
s_mov_b32 s95, 0
s_mov_b32 s99, 0
s_waitcnt lgkmcnt(0)
s_mov_b32 s86, 268435456
s_mov_b32 s87, 0x00020000
s_mov_b32 s74, 256
s_mov_b32 s75, 0x00020000
v_cmp_eq_u32 vcc, 0, v0
s_and_saveexec_b64 s[88:89], vcc
s_cbranch_execz mega_kernel_tkd
s_lshl_b32 s92, s2, 13
s_add_u32 s92, s92, 167772160
buffer_atomic_add v2, v1, s[72:75], s91 offen sc0
buffer_load_dword v251, v1, s[84:87], s92 offen offset:2048 sc1
s_waitcnt vmcnt(1)
ds_write_b32 v1, v2
s_waitcnt lgkmcnt(0)
mega_kernel_tkd:
s_mov_b64 exec, s[88:89]
s_barrier
ds_read_b32 v2, v1
s_waitcnt lgkmcnt(0)
v_readfirstlane_b32 s96, v2
s_barrier
s_cmp_lt_u32 s96, 32
s_cbranch_scc1 mega_kernel_spec
v_and_b32 v3, 15, v0
v_lshlrev_b32 v3, 4, v3
s_branch mega_kernel_syx
mega_kernel_syxw:
s_sleep 4
mega_kernel_syx:
buffer_load_dword v2, v3, s[72:75], 0 offen sc1
s_waitcnt vmcnt(0)
mega_kernel_syxp:
s_cmp_eq_u32 s95, 1
s_cbranch_scc0 mega_kernel_syxf
v_readlane_b32 s76, v2, 14
s_mov_b32 s98, 0
s_cmp_eq_u32 s76, 32
s_cbranch_scc0 mega_kernel_syxw
s_branch mega_kernel_syxd
mega_kernel_syxf:
s_mov_b32 s77, 0
s_mov_b32 s78, 0
v_readlane_b32 s76, v2, 0
s_add_u32 s77, s77, s76
s_xor_b32 s76, s76, 32
s_or_b32 s78, s78, s76
v_readlane_b32 s76, v2, 1
s_add_u32 s77, s77, s76
s_xor_b32 s76, s76, 32
s_or_b32 s78, s78, s76
v_readlane_b32 s76, v2, 2
s_add_u32 s77, s77, s76
s_xor_b32 s76, s76, 32
s_or_b32 s78, s78, s76
v_readlane_b32 s76, v2, 3
s_add_u32 s77, s77, s76
s_xor_b32 s76, s76, 32
s_or_b32 s78, s78, s76
v_readlane_b32 s76, v2, 4
s_add_u32 s77, s77, s76
s_xor_b32 s76, s76, 32
s_or_b32 s78, s78, s76
v_readlane_b32 s76, v2, 5
s_add_u32 s77, s77, s76
s_xor_b32 s76, s76, 32
s_or_b32 s78, s78, s76
v_readlane_b32 s76, v2, 6
s_add_u32 s77, s77, s76
s_xor_b32 s76, s76, 32
s_or_b32 s78, s78, s76
v_readlane_b32 s76, v2, 7
s_add_u32 s77, s77, s76
s_xor_b32 s76, s76, 32
s_or_b32 s78, s78, s76
s_cmp_eq_u32 s77, 256
s_cbranch_scc0 mega_kernel_syxw
v_mov_b32 v252, v2
s_cmp_eq_u32 s78, 0
s_cbranch_scc0 mega_kernel_slowent
v_readlane_b32 s76, v2, 10
v_readlane_b32 s77, v2, 8
s_cmp_eq_u32 s76, 32
s_cbranch_scc0 mega_kernel_syxw
s_cmp_gt_u32 s77, 16
s_cselect_b32 s98, 1, 0
mega_kernel_syxd:
mega_kernel_slowent:
s_mov_b64 exec, -1
s_waitcnt vmcnt(0) lgkmcnt(0)
s_barrier
s_mov_b32 s97, s96
v_readlane_b32 s76, v252, 0
s_cmp_gt_u32 s90, 0
s_cselect_b32 s76, s76, 0
s_add_u32 s97, s97, s76
v_readlane_b32 s76, v252, 1
s_cmp_gt_u32 s90, 1
s_cselect_b32 s76, s76, 0
s_add_u32 s97, s97, s76
v_readlane_b32 s76, v252, 2
s_cmp_gt_u32 s90, 2
s_cselect_b32 s76, s76, 0
s_add_u32 s97, s97, s76
v_readlane_b32 s76, v252, 3
s_cmp_gt_u32 s90, 3
s_cselect_b32 s76, s76, 0
s_add_u32 s97, s97, s76
v_readlane_b32 s76, v252, 4
s_cmp_gt_u32 s90, 4
s_cselect_b32 s76, s76, 0
s_add_u32 s97, s97, s76
v_readlane_b32 s76, v252, 5
s_cmp_gt_u32 s90, 5
s_cselect_b32 s76, s76, 0
s_add_u32 s97, s97, s76
v_readlane_b32 s76, v252, 6
s_cmp_gt_u32 s90, 6
s_cselect_b32 s76, s76, 0
s_add_u32 s97, s97, s76
v_mov_b32 v1, 0
v_mov_b32 v2, 1
v_cmp_eq_u32 vcc, 0, v0
s_and_saveexec_b64 s[88:89], vcc
s_cbranch_execz mega_kernel_sb1
buffer_atomic_add v2, v1, s[72:75], 0 offen offset:192 sc1
mega_kernel_sb1:
s_mov_b64 exec, s[88:89]
mega_kernel_sb2:
s_sleep 4
buffer_load_dword v2, v1, s[72:75], 0 offen offset:192 sc1
s_waitcnt vmcnt(0)
v_cmp_ne_u32 vcc, 256, v2
s_cbranch_vccnz mega_kernel_sb2
s_mov_b32 s95, 1
s_lshr_b32 s30, s97, 5
s_and_b32 s31, s97, 31
s_cmp_lt_u32 s97, 128
s_cbranch_scc1 mega_kernel_recs
s_sub_u32 s94, s97, 128
s_branch mega_kernel_bulk
mega_kernel_spec:
s_mov_b32 s30, s90
s_mov_b32 s31, s96
s_cmp_lt_u32 s90, 4
s_cbranch_scc1 mega_kernel_recf
s_sub_u32 s94, s90, 4
s_lshl_b32 s94, s94, 5
s_add_u32 s94, s94, s96
mega_kernel_bulk:
s_lshr_b32 s91, s94, 5
s_and_b32 s40, s94, 31
s_and_b32 s92, s91, 1
s_lshl_b32 s92, s92, 5
s_add_u32 s92, s92, s40
s_cmp_eq_u32 s91, 0
s_cbranch_scc1 mega_kernel_rk
s_cmp_eq_u32 s91, 1
s_cbranch_scc1 mega_kernel_rv
s_cmp_eq_u32 s91, 2
s_cbranch_scc1 mega_kernel_noinit
v_mov_b32 v8, -1
v_mov_b32 v9, -1
v_mov_b32 v10, -1
v_mov_b32 v11, -1
v_lshlrev_b32 v1, 4, v0
v_mov_b32 v2, 0
v_cmp_gt_u32 vcc, 64, v0
s_cbranch_vccz mega_kernel_nv
s_cmp_eq_u32 s95, 0
s_cbranch_scc0 mega_kernel_nv
s_lshr_b32 s60, s2, 1
s_lshl_b32 s60, s60, 14
s_and_b32 s61, s40, 1
s_lshl_b32 s66, s61, 13
s_add_u32 s60, s60, s66
s_and_b32 s66, s2, 1
s_lshl_b32 s66, s66, 10
s_add_u32 s60, s60, s66
s_add_u32 s60, s60, 167772160
s_mov_b32 s66, 0x7fffffff
s_mov_b32 s67, 0x7fffffff
s_mov_b64 exec, 0xff
s_waitcnt vmcnt(0)
s_memtime s[62:63]
s_waitcnt lgkmcnt(0)
buffer_store_dwordx4 v[8:11], v1, s[84:87], s60 offen offset:0 sc1
s_waitcnt vmcnt(0)
s_memtime s[64:65]
s_xor_b32 s60, s60, 8192
s_waitcnt lgkmcnt(0)
s_sub_u32 s64, s64, s62
s_min_u32 s66, s66, s64
s_memtime s[62:63]
s_waitcnt lgkmcnt(0)
buffer_store_dwordx4 v[8:11], v1, s[84:87], s60 offen offset:0 sc1
s_waitcnt vmcnt(0)
s_memtime s[64:65]
s_xor_b32 s60, s60, 8192
s_waitcnt lgkmcnt(0)
s_sub_u32 s64, s64, s62
s_min_u32 s67, s67, s64
s_memtime s[62:63]
s_waitcnt lgkmcnt(0)
buffer_store_dwordx4 v[8:11], v1, s[84:87], s60 offen offset:256 sc1
s_waitcnt vmcnt(0)
s_memtime s[64:65]
s_xor_b32 s60, s60, 8192
s_waitcnt lgkmcnt(0)
s_sub_u32 s64, s64, s62
s_min_u32 s66, s66, s64
s_memtime s[62:63]
s_waitcnt lgkmcnt(0)
buffer_store_dwordx4 v[8:11], v1, s[84:87], s60 offen offset:256 sc1
s_waitcnt vmcnt(0)
s_memtime s[64:65]
s_xor_b32 s60, s60, 8192
s_waitcnt lgkmcnt(0)
s_sub_u32 s64, s64, s62
s_min_u32 s67, s67, s64
s_cmp_lt_u32 s67, s66
s_cselect_b32 s60, 1, 0
s_xor_b32 s60, s60, s61
s_lshr_b32 s61, s90, 2
s_xor_b32 s60, s60, s61
v_mov_b32 v3, s60
s_mov_b64 exec, 1
buffer_atomic_add v3, v2, s[72:75], 0 offen offset:128 sc1
s_mov_b64 exec, -1
mega_kernel_nv:
s_barrier
s_lshl_b32 s60, s40, 12
s_add_u32 s60, s60, 67108864
buffer_store_dwordx4 v[8:11], v1, s[84:87], s60 offen sc1
s_add_u32 s60, s60, 131072
buffer_store_dwordx4 v[8:11], v1, s[84:87], s60 offen sc1
s_add_u32 s60, s60, 131072
buffer_store_dwordx4 v[8:11], v1, s[84:87], s60 offen sc1
s_add_u32 s60, s60, 131072
buffer_store_dwordx4 v[8:11], v1, s[84:87], s60 offen sc1
s_add_u32 s60, s60, 131072
buffer_store_dwordx4 v[8:11], v1, s[84:87], s60 offen sc1
s_add_u32 s60, s60, 131072
buffer_store_dwordx4 v[8:11], v1, s[84:87], s60 offen sc1
s_add_u32 s60, s60, 131072
buffer_store_dwordx4 v[8:11], v1, s[84:87], s60 offen sc1
s_add_u32 s60, s60, 131072
buffer_store_dwordx4 v[8:11], v1, s[84:87], s60 offen sc1
s_add_u32 s60, s60, 131072
buffer_store_dwordx4 v[8:11], v1, s[84:87], s60 offen sc1
s_add_u32 s60, s60, 131072
buffer_store_dwordx4 v[8:11], v1, s[84:87], s60 offen sc1
s_add_u32 s60, s60, 131072
buffer_store_dwordx4 v[8:11], v1, s[84:87], s60 offen sc1
s_add_u32 s60, s60, 131072
buffer_store_dwordx4 v[8:11], v1, s[84:87], s60 offen sc1
s_add_u32 s60, s60, 131072
buffer_store_dwordx4 v[8:11], v1, s[84:87], s60 offen sc1
s_add_u32 s60, s60, 131072
buffer_store_dwordx4 v[8:11], v1, s[84:87], s60 offen sc1
s_add_u32 s60, s60, 131072
buffer_store_dwordx4 v[8:11], v1, s[84:87], s60 offen sc1
s_add_u32 s60, s60, 131072
buffer_store_dwordx4 v[8:11], v1, s[84:87], s60 offen sc1
s_add_u32 s60, s60, 131072
s_lshr_b32 s62, s40, 1
s_and_b32 s63, s40, 1
s_add_u32 s63, s63, s62
s_lshl_b32 s62, s62, 19
s_and_b32 s64, s63, 14
s_lshl_b32 s64, s64, 13
s_add_u32 s62, s62, s64
s_and_b32 s64, s63, 1
s_lshl_b32 s64, s64, 12
s_add_u32 s62, s62, s64
s_add_u32 s62, s62, 150994944
s_add_u32 s62, s62, 8192
s_cmp_lt_u32 s40, 16
s_cbranch_scc0 mega_kernel_pz
buffer_store_dwordx4 v[8:11], v1, s[84:87], s60 offen sc1
mega_kernel_pz:
s_waitcnt vmcnt(0)
s_barrier
v_mov_b32 v3, 1
s_lshl_b32 s62, s95, 6
v_cmp_eq_u32 vcc, 0, v0
s_and_saveexec_b64 s[60:61], vcc
s_cbranch_execz mega_kernel_xps
buffer_atomic_add v3, v2, s[72:75], s62 offen offset:160 sc1
mega_kernel_xps:
s_mov_b64 exec, s[60:61]
mega_kernel_noinit:
s_cmp_eq_u32 s91, 2
s_cbranch_scc1 mega_kernel_nohold
v_and_b32 v3, 15, v0
v_lshlrev_b32 v3, 4, v3
s_branch mega_kernel_syh
mega_kernel_syhw:
s_sleep 4
mega_kernel_syh:
buffer_load_dword v2, v3, s[72:75], 0 offen sc1
s_waitcnt vmcnt(0)
mega_kernel_syhp:
s_cmp_eq_u32 s95, 1
s_cbranch_scc0 mega_kernel_syhf
v_readlane_b32 s76, v2, 14
s_mov_b32 s98, 0
s_cmp_eq_u32 s76, 32
s_cbranch_scc0 mega_kernel_syhw
s_branch mega_kernel_syhd
mega_kernel_syhf:
s_mov_b32 s77, 0
s_mov_b32 s78, 0
v_readlane_b32 s76, v2, 0
s_add_u32 s77, s77, s76
s_xor_b32 s76, s76, 32
s_or_b32 s78, s78, s76
v_readlane_b32 s76, v2, 1
s_add_u32 s77, s77, s76
s_xor_b32 s76, s76, 32
s_or_b32 s78, s78, s76
v_readlane_b32 s76, v2, 2
s_add_u32 s77, s77, s76
s_xor_b32 s76, s76, 32
s_or_b32 s78, s78, s76
v_readlane_b32 s76, v2, 3
s_add_u32 s77, s77, s76
s_xor_b32 s76, s76, 32
s_or_b32 s78, s78, s76
v_readlane_b32 s76, v2, 4
s_add_u32 s77, s77, s76
s_xor_b32 s76, s76, 32
s_or_b32 s78, s78, s76
v_readlane_b32 s76, v2, 5
s_add_u32 s77, s77, s76
s_xor_b32 s76, s76, 32
s_or_b32 s78, s78, s76
v_readlane_b32 s76, v2, 6
s_add_u32 s77, s77, s76
s_xor_b32 s76, s76, 32
s_or_b32 s78, s78, s76
v_readlane_b32 s76, v2, 7
s_add_u32 s77, s77, s76
s_xor_b32 s76, s76, 32
s_or_b32 s78, s78, s76
s_cmp_eq_u32 s77, 256
s_cbranch_scc0 mega_kernel_syhw
v_mov_b32 v252, v2
s_cmp_eq_u32 s78, 0
s_cbranch_scc0 mega_kernel_slowent
v_readlane_b32 s76, v2, 10
v_readlane_b32 s77, v2, 8
s_cmp_eq_u32 s76, 32
s_cbranch_scc0 mega_kernel_syhw
s_cmp_gt_u32 s77, 16
s_cselect_b32 s98, 1, 0
mega_kernel_syhd:
s_xor_b32 s76, s98, 1
s_lshl_b32 s76, s76, 13
s_lshl_b32 s77, s40, 7
s_add_u32 s76, s76, s77
s_add_u32 s76, s76, 69206016
v_mov_b32 v1, 0
mega_kernel_hold:
s_sleep 12
buffer_load_dword v2, v1, s[84:87], s76 offen sc1
s_waitcnt vmcnt(0)
v_cmp_gt_i32 vcc, 1, v2
s_cbranch_vccnz mega_kernel_hold
mega_kernel_nohold:
s_cmp_eq_u32 s91, 2
s_cbranch_scc0 mega_kernel_rd
s_load_dwordx2 s[4:5], s[0:1], 16
s_load_dwordx2 s[8:9], s[0:1], 0
v_lshrrev_b32 v2, 6, v0
v_and_b32 v1, 63, v0
v_readfirstlane_b32 s41, v2
v_lshlrev_b32 v5, 4, v1
s_waitcnt lgkmcnt(0)
s_mov_b32 s6, 8388608
s_mov_b32 s7, 0x00020000
s_mov_b32 s10, 4194304
s_mov_b32 s11, 0x00020000
s_lshl_b32 s43, s40, 8
s_lshl_b32 s44, s41, 6
s_add_u32 s48, s43, s44
s_and_b32 s43, s48, 0x7ff
v_add_u32 v19, s43, v1
v_lshlrev_b32 v19, 7, v19
s_mov_b32 s43, 0
buffer_load_dword v250, v19, s[8:11], s43 offen
s_nop 0
v_lshrrev_b32 v2, 3, v1
s_lshl_b32 s43, s41, 3
v_add_u32 v2, s43, v2
v_bfe_u32 v3, v2, 1, 3
v_and_b32 v4, 7, v1
v_xor_b32 v3, v3, v4
v_lshlrev_b32 v6, 11, v2
v_lshl_add_u32 v6, v3, 4, v6
s_lshl_b32 s46, s41, 10
v_and_b32 v2, 15, v1
v_bfe_u32 v3, v2, 1, 3
v_lshrrev_b32 v4, 4, v1
v_xor_b32 v3, v3, v4
v_lshlrev_b32 v8, 7, v2
v_lshl_add_u32 v8, v3, 4, v8
v_xor_b32 v9, 64, v8
v_add_u32 v10, 0x10000, v8
v_add_u32 v11, 0x10000, v9
v_mov_b32 v7, v5
s_lshl_b32 s47, s40, 2
s_add_u32 s47, s47, s41
s_mov_b32 s42, 0
s_mov_b32 s50, 0
s_add_u32 m0, s46, 0
s_nop 0
buffer_load_dwordx4 v6, s[8:11], s50 offen offset:0 lds
s_add_u32 m0, s46, 3968
s_nop 0
buffer_load_dwordx4 v6, s[8:11], s50 offen offset:128 lds
s_add_u32 m0, s46, 7936
s_nop 0
buffer_load_dwordx4 v6, s[8:11], s50 offen offset:256 lds
s_add_u32 m0, s46, 11904
s_nop 0
buffer_load_dwordx4 v6, s[8:11], s50 offen offset:384 lds
s_add_u32 m0, s46, 15872
s_nop 0
buffer_load_dwordx4 v6, s[8:11], s50 offen offset:512 lds
s_add_u32 m0, s46, 19840
s_nop 0
buffer_load_dwordx4 v6, s[8:11], s50 offen offset:640 lds
s_add_u32 m0, s46, 23808
s_nop 0
buffer_load_dwordx4 v6, s[8:11], s50 offen offset:768 lds
s_add_u32 m0, s46, 27776
s_nop 0
buffer_load_dwordx4 v6, s[8:11], s50 offen offset:896 lds
s_add_u32 m0, s46, 31744
s_nop 0
buffer_load_dwordx4 v6, s[8:11], s50 offen offset:1024 lds
s_add_u32 m0, s46, 35712
s_nop 0
buffer_load_dwordx4 v6, s[8:11], s50 offen offset:1152 lds
s_add_u32 m0, s46, 39680
s_nop 0
buffer_load_dwordx4 v6, s[8:11], s50 offen offset:1280 lds
s_add_u32 m0, s46, 43648
s_nop 0
buffer_load_dwordx4 v6, s[8:11], s50 offen offset:1408 lds
s_add_u32 m0, s46, 47616
s_nop 0
buffer_load_dwordx4 v6, s[8:11], s50 offen offset:1536 lds
s_add_u32 m0, s46, 51584
s_nop 0
buffer_load_dwordx4 v6, s[8:11], s50 offen offset:1664 lds
s_add_u32 m0, s46, 55552
s_nop 0
buffer_load_dwordx4 v6, s[8:11], s50 offen offset:1792 lds
s_add_u32 m0, s46, 59520
s_nop 0
buffer_load_dwordx4 v6, s[8:11], s50 offen offset:1920 lds
v_lshrrev_b32 v2, 2, v1
v_and_b32 v3, 3, v1
v_lshlrev_b32 v16, 13, v2
v_lshl_add_u32 v16, v3, 4, v16
v_add_u32 v16, s48, v16
s_mul_i32 s45, s41, 24576
s_add_u32 s45, s45, 65536
v_bfe_u32 v17, v1, 2, 2
v_lshrrev_b32 v18, 4, v1
v_lshl_add_u32 v17, v18, 3, v17
v_lshlrev_b32 v17, 6, v17
v_lshl_add_u32 v17, v3, 4, v17
v_add_u32 v17, s45, v17
s_and_b32 s43, s40, 3
s_lshl_b32 s43, s43, 2
s_add_u32 s43, s43, s41
s_lshl_b32 s43, s43, 3
v_and_b32 v12, 7, v1
v_add_u32 v12, s43, v12
s_lshr_b32 s43, s40, 2
s_lshl_b32 s43, s43, 10
s_add_u32 s44, s43, 896
s_add_u32 s43, s43, 384
s_cmp_ge_u32 s40, 28
s_cselect_b32 s44, s44, s43
v_mov_b32 v13, s43
v_mov_b32 v14, s44
v_cmp_gt_u32 vcc, 32, v1
s_nop 1
v_cndmask_b32 v13, v14, v13, vcc
v_lshl_add_u32 v12, v12, 13, v13
s_mov_b32 s44, 0
buffer_load_dword v250, v12, s[4:7], s44 offen
s_add_u32 m0, s45, 0
s_mov_b32 s44, 0
buffer_load_dwordx4 v16, s[4:7], s44 offen lds
s_add_u32 m0, s45, 1024
s_mov_b32 s44, 131072
buffer_load_dwordx4 v16, s[4:7], s44 offen lds
s_add_u32 m0, s45, 2048
s_mov_b32 s44, 262144
buffer_load_dwordx4 v16, s[4:7], s44 offen lds
s_add_u32 m0, s45, 3072
s_mov_b32 s44, 393216
buffer_load_dwordx4 v16, s[4:7], s44 offen lds
s_add_u32 m0, s45, 4096
s_mov_b32 s44, 524288
buffer_load_dwordx4 v16, s[4:7], s44 offen lds
s_add_u32 m0, s45, 5120
s_mov_b32 s44, 655360
buffer_load_dwordx4 v16, s[4:7], s44 offen lds
s_add_u32 m0, s45, 6144
s_mov_b32 s44, 786432
buffer_load_dwordx4 v16, s[4:7], s44 offen lds
s_add_u32 m0, s45, 7168
s_mov_b32 s44, 917504
buffer_load_dwordx4 v16, s[4:7], s44 offen lds
s_mov_b32 s44, 1048576
buffer_load_dword v250, v12, s[4:7], s44 offen
s_add_u32 m0, s45, 8192
s_mov_b32 s44, 1048576
buffer_load_dwordx4 v16, s[4:7], s44 offen lds
s_add_u32 m0, s45, 9216
s_mov_b32 s44, 1179648
buffer_load_dwordx4 v16, s[4:7], s44 offen lds
s_add_u32 m0, s45, 10240
s_mov_b32 s44, 1310720
buffer_load_dwordx4 v16, s[4:7], s44 offen lds
s_add_u32 m0, s45, 11264
s_mov_b32 s44, 1441792
buffer_load_dwordx4 v16, s[4:7], s44 offen lds
s_add_u32 m0, s45, 12288
s_mov_b32 s44, 1572864
buffer_load_dwordx4 v16, s[4:7], s44 offen lds
s_add_u32 m0, s45, 13312
s_mov_b32 s44, 1703936
buffer_load_dwordx4 v16, s[4:7], s44 offen lds
s_add_u32 m0, s45, 14336
s_mov_b32 s44, 1835008
buffer_load_dwordx4 v16, s[4:7], s44 offen lds
s_add_u32 m0, s45, 15360
s_mov_b32 s44, 1966080
buffer_load_dwordx4 v16, s[4:7], s44 offen lds
s_mov_b32 s44, 2097152
buffer_load_dword v250, v12, s[4:7], s44 offen
s_add_u32 m0, s45, 16384
s_mov_b32 s44, 2097152
buffer_load_dwordx4 v16, s[4:7], s44 offen lds
s_add_u32 m0, s45, 17408
s_mov_b32 s44, 2228224
buffer_load_dwordx4 v16, s[4:7], s44 offen lds
s_add_u32 m0, s45, 18432
s_mov_b32 s44, 2359296
buffer_load_dwordx4 v16, s[4:7], s44 offen lds
s_add_u32 m0, s45, 19456
s_mov_b32 s44, 2490368
buffer_load_dwordx4 v16, s[4:7], s44 offen lds
s_add_u32 m0, s45, 20480
s_mov_b32 s44, 2621440
buffer_load_dwordx4 v16, s[4:7], s44 offen lds
s_add_u32 m0, s45, 21504
s_mov_b32 s44, 2752512
buffer_load_dwordx4 v16, s[4:7], s44 offen lds
s_add_u32 m0, s45, 22528
s_mov_b32 s44, 2883584
buffer_load_dwordx4 v16, s[4:7], s44 offen lds
s_add_u32 m0, s45, 23552
s_mov_b32 s44, 3014656
buffer_load_dwordx4 v16, s[4:7], s44 offen lds
s_waitcnt vmcnt(18)
s_barrier
ds_read_b64_tr_b16 a[0:1], v17 offset:0
ds_read_b64_tr_b16 a[2:3], v17 offset:256
ds_read_b64_tr_b16 a[4:5], v17 offset:8
ds_read_b64_tr_b16 a[6:7], v17 offset:264
ds_read_b64_tr_b16 a[8:9], v17 offset:2048
ds_read_b64_tr_b16 a[10:11], v17 offset:2304
ds_read_b64_tr_b16 a[12:13], v17 offset:2056
ds_read_b64_tr_b16 a[14:15], v17 offset:2312
s_waitcnt lgkmcnt(0)
ds_read_b64_tr_b16 a[16:17], v17 offset:4096
ds_read_b64_tr_b16 a[18:19], v17 offset:4352
ds_read_b64_tr_b16 a[20:21], v17 offset:4104
ds_read_b64_tr_b16 a[22:23], v17 offset:4360
ds_read_b64_tr_b16 a[24:25], v17 offset:6144
ds_read_b64_tr_b16 a[26:27], v17 offset:6400
ds_read_b64_tr_b16 a[28:29], v17 offset:6152
ds_read_b64_tr_b16 a[30:31], v17 offset:6408
s_waitcnt lgkmcnt(0)
s_mov_b32 s44, 3145728
buffer_load_dword v250, v12, s[4:7], s44 offen
s_add_u32 m0, s45, 0
s_mov_b32 s44, 3145728
buffer_load_dwordx4 v16, s[4:7], s44 offen lds
s_add_u32 m0, s45, 1024
s_mov_b32 s44, 3276800
buffer_load_dwordx4 v16, s[4:7], s44 offen lds
s_add_u32 m0, s45, 2048
s_mov_b32 s44, 3407872
buffer_load_dwordx4 v16, s[4:7], s44 offen lds
s_add_u32 m0, s45, 3072
s_mov_b32 s44, 3538944
buffer_load_dwordx4 v16, s[4:7], s44 offen lds
s_add_u32 m0, s45, 4096
s_mov_b32 s44, 3670016
buffer_load_dwordx4 v16, s[4:7], s44 offen lds
s_add_u32 m0, s45, 5120
s_mov_b32 s44, 3801088
buffer_load_dwordx4 v16, s[4:7], s44 offen lds
s_add_u32 m0, s45, 6144
s_mov_b32 s44, 3932160
buffer_load_dwordx4 v16, s[4:7], s44 offen lds
s_add_u32 m0, s45, 7168
s_mov_b32 s44, 4063232
buffer_load_dwordx4 v16, s[4:7], s44 offen lds
ds_read_b128 v[20:23], v8 offset:0
ds_read_b128 v[24:27], v8 offset:2048
ds_read_b128 v[28:31], v9 offset:0
ds_read_b128 v[32:35], v9 offset:2048
ds_read_b128 v[36:39], v8 offset:4096
ds_read_b128 v[40:43], v8 offset:6144
ds_read_b128 v[44:47], v9 offset:4096
ds_read_b128 v[48:51], v9 offset:6144
s_waitcnt lgkmcnt(0)
v_mfma_f32_16x16x32_bf16 v[52:55], a[0:3], v[20:23], 0
v_mfma_f32_16x16x32_bf16 v[56:59], a[4:7], v[20:23], 0
v_mfma_f32_16x16x32_bf16 v[60:63], a[0:3], v[24:27], 0
v_mfma_f32_16x16x32_bf16 v[64:67], a[4:7], v[24:27], 0
v_mfma_f32_16x16x32_bf16 v[52:55], a[8:11], v[28:31], v[52:55]
v_mfma_f32_16x16x32_bf16 v[56:59], a[12:15], v[28:31], v[56:59]
v_mfma_f32_16x16x32_bf16 v[60:63], a[8:11], v[32:35], v[60:63]
v_mfma_f32_16x16x32_bf16 v[64:67], a[12:15], v[32:35], v[64:67]
v_mfma_f32_16x16x32_bf16 v[52:55], a[16:19], v[36:39], v[52:55]
v_mfma_f32_16x16x32_bf16 v[56:59], a[20:23], v[36:39], v[56:59]
v_mfma_f32_16x16x32_bf16 v[60:63], a[16:19], v[40:43], v[60:63]
v_mfma_f32_16x16x32_bf16 v[64:67], a[20:23], v[40:43], v[64:67]
v_mfma_f32_16x16x32_bf16 v[52:55], a[24:27], v[44:47], v[52:55]
v_mfma_f32_16x16x32_bf16 v[56:59], a[28:31], v[44:47], v[56:59]
v_mfma_f32_16x16x32_bf16 v[60:63], a[24:27], v[48:51], v[60:63]
v_mfma_f32_16x16x32_bf16 v[64:67], a[28:31], v[48:51], v[64:67]
s_waitcnt vmcnt(18)
ds_read_b64_tr_b16 a[32:33], v17 offset:8192
ds_read_b64_tr_b16 a[34:35], v17 offset:8448
ds_read_b64_tr_b16 a[36:37], v17 offset:8200
ds_read_b64_tr_b16 a[38:39], v17 offset:8456
ds_read_b64_tr_b16 a[40:41], v17 offset:10240
ds_read_b64_tr_b16 a[42:43], v17 offset:10496
ds_read_b64_tr_b16 a[44:45], v17 offset:10248
ds_read_b64_tr_b16 a[46:47], v17 offset:10504
s_waitcnt lgkmcnt(0)
ds_read_b64_tr_b16 a[48:49], v17 offset:12288
ds_read_b64_tr_b16 a[50:51], v17 offset:12544
ds_read_b64_tr_b16 a[52:53], v17 offset:12296
ds_read_b64_tr_b16 a[54:55], v17 offset:12552
ds_read_b64_tr_b16 a[56:57], v17 offset:14336
ds_read_b64_tr_b16 a[58:59], v17 offset:14592
ds_read_b64_tr_b16 a[60:61], v17 offset:14344
ds_read_b64_tr_b16 a[62:63], v17 offset:14600
s_waitcnt lgkmcnt(0)
s_mov_b32 s44, 4194304
buffer_load_dword v250, v12, s[4:7], s44 offen
s_add_u32 m0, s45, 8192
s_mov_b32 s44, 4194304
buffer_load_dwordx4 v16, s[4:7], s44 offen lds
s_add_u32 m0, s45, 9216
s_mov_b32 s44, 4325376
buffer_load_dwordx4 v16, s[4:7], s44 offen lds
s_add_u32 m0, s45, 10240
s_mov_b32 s44, 4456448
buffer_load_dwordx4 v16, s[4:7], s44 offen lds
s_add_u32 m0, s45, 11264
s_mov_b32 s44, 4587520
buffer_load_dwordx4 v16, s[4:7], s44 offen lds
s_add_u32 m0, s45, 12288
s_mov_b32 s44, 4718592
buffer_load_dwordx4 v16, s[4:7], s44 offen lds
s_add_u32 m0, s45, 13312
s_mov_b32 s44, 4849664
buffer_load_dwordx4 v16, s[4:7], s44 offen lds
s_add_u32 m0, s45, 14336
s_mov_b32 s44, 4980736
buffer_load_dwordx4 v16, s[4:7], s44 offen lds
s_add_u32 m0, s45, 15360
s_mov_b32 s44, 5111808
buffer_load_dwordx4 v16, s[4:7], s44 offen lds
ds_read_b128 v[20:23], v8 offset:8192
ds_read_b128 v[24:27], v8 offset:10240
ds_read_b128 v[28:31], v9 offset:8192
ds_read_b128 v[32:35], v9 offset:10240
ds_read_b128 v[36:39], v8 offset:12288
ds_read_b128 v[40:43], v8 offset:14336
ds_read_b128 v[44:47], v9 offset:12288
ds_read_b128 v[48:51], v9 offset:14336
s_waitcnt lgkmcnt(0)
v_mfma_f32_16x16x32_bf16 v[52:55], a[32:35], v[20:23], v[52:55]
v_mfma_f32_16x16x32_bf16 v[56:59], a[36:39], v[20:23], v[56:59]
v_mfma_f32_16x16x32_bf16 v[60:63], a[32:35], v[24:27], v[60:63]
v_mfma_f32_16x16x32_bf16 v[64:67], a[36:39], v[24:27], v[64:67]
v_mfma_f32_16x16x32_bf16 v[52:55], a[40:43], v[28:31], v[52:55]
v_mfma_f32_16x16x32_bf16 v[56:59], a[44:47], v[28:31], v[56:59]
v_mfma_f32_16x16x32_bf16 v[60:63], a[40:43], v[32:35], v[60:63]
v_mfma_f32_16x16x32_bf16 v[64:67], a[44:47], v[32:35], v[64:67]
v_mfma_f32_16x16x32_bf16 v[52:55], a[48:51], v[36:39], v[52:55]
v_mfma_f32_16x16x32_bf16 v[56:59], a[52:55], v[36:39], v[56:59]
v_mfma_f32_16x16x32_bf16 v[60:63], a[48:51], v[40:43], v[60:63]
v_mfma_f32_16x16x32_bf16 v[64:67], a[52:55], v[40:43], v[64:67]
v_mfma_f32_16x16x32_bf16 v[52:55], a[56:59], v[44:47], v[52:55]
v_mfma_f32_16x16x32_bf16 v[56:59], a[60:63], v[44:47], v[56:59]
v_mfma_f32_16x16x32_bf16 v[60:63], a[56:59], v[48:51], v[60:63]
v_mfma_f32_16x16x32_bf16 v[64:67], a[60:63], v[48:51], v[64:67]
s_waitcnt vmcnt(18)
ds_read_b64_tr_b16 a[64:65], v17 offset:16384
ds_read_b64_tr_b16 a[66:67], v17 offset:16640
ds_read_b64_tr_b16 a[68:69], v17 offset:16392
ds_read_b64_tr_b16 a[70:71], v17 offset:16648
ds_read_b64_tr_b16 a[72:73], v17 offset:18432
ds_read_b64_tr_b16 a[74:75], v17 offset:18688
ds_read_b64_tr_b16 a[76:77], v17 offset:18440
ds_read_b64_tr_b16 a[78:79], v17 offset:18696
s_waitcnt lgkmcnt(0)
ds_read_b64_tr_b16 a[80:81], v17 offset:20480
ds_read_b64_tr_b16 a[82:83], v17 offset:20736
ds_read_b64_tr_b16 a[84:85], v17 offset:20488
ds_read_b64_tr_b16 a[86:87], v17 offset:20744
ds_read_b64_tr_b16 a[88:89], v17 offset:22528
ds_read_b64_tr_b16 a[90:91], v17 offset:22784
ds_read_b64_tr_b16 a[92:93], v17 offset:22536
ds_read_b64_tr_b16 a[94:95], v17 offset:22792
s_waitcnt lgkmcnt(0)
s_mov_b32 s44, 5242880
buffer_load_dword v250, v12, s[4:7], s44 offen
s_add_u32 m0, s45, 16384
s_mov_b32 s44, 5242880
buffer_load_dwordx4 v16, s[4:7], s44 offen lds
s_add_u32 m0, s45, 17408
s_mov_b32 s44, 5373952
buffer_load_dwordx4 v16, s[4:7], s44 offen lds
s_add_u32 m0, s45, 18432
s_mov_b32 s44, 5505024
buffer_load_dwordx4 v16, s[4:7], s44 offen lds
s_add_u32 m0, s45, 19456
s_mov_b32 s44, 5636096
buffer_load_dwordx4 v16, s[4:7], s44 offen lds
s_add_u32 m0, s45, 20480
s_mov_b32 s44, 5767168
buffer_load_dwordx4 v16, s[4:7], s44 offen lds
s_add_u32 m0, s45, 21504
s_mov_b32 s44, 5898240
buffer_load_dwordx4 v16, s[4:7], s44 offen lds
s_add_u32 m0, s45, 22528
s_mov_b32 s44, 6029312
buffer_load_dwordx4 v16, s[4:7], s44 offen lds
s_add_u32 m0, s45, 23552
s_mov_b32 s44, 6160384
buffer_load_dwordx4 v16, s[4:7], s44 offen lds
ds_read_b128 v[20:23], v8 offset:16384
ds_read_b128 v[24:27], v8 offset:18432
ds_read_b128 v[28:31], v9 offset:16384
ds_read_b128 v[32:35], v9 offset:18432
ds_read_b128 v[36:39], v8 offset:20480
ds_read_b128 v[40:43], v8 offset:22528
ds_read_b128 v[44:47], v9 offset:20480
ds_read_b128 v[48:51], v9 offset:22528
s_waitcnt lgkmcnt(0)
v_mfma_f32_16x16x32_bf16 v[52:55], a[64:67], v[20:23], v[52:55]
v_mfma_f32_16x16x32_bf16 v[56:59], a[68:71], v[20:23], v[56:59]
v_mfma_f32_16x16x32_bf16 v[60:63], a[64:67], v[24:27], v[60:63]
v_mfma_f32_16x16x32_bf16 v[64:67], a[68:71], v[24:27], v[64:67]
v_mfma_f32_16x16x32_bf16 v[52:55], a[72:75], v[28:31], v[52:55]
v_mfma_f32_16x16x32_bf16 v[56:59], a[76:79], v[28:31], v[56:59]
v_mfma_f32_16x16x32_bf16 v[60:63], a[72:75], v[32:35], v[60:63]
v_mfma_f32_16x16x32_bf16 v[64:67], a[76:79], v[32:35], v[64:67]
v_mfma_f32_16x16x32_bf16 v[52:55], a[80:83], v[36:39], v[52:55]
v_mfma_f32_16x16x32_bf16 v[56:59], a[84:87], v[36:39], v[56:59]
v_mfma_f32_16x16x32_bf16 v[60:63], a[80:83], v[40:43], v[60:63]
v_mfma_f32_16x16x32_bf16 v[64:67], a[84:87], v[40:43], v[64:67]
v_mfma_f32_16x16x32_bf16 v[52:55], a[88:91], v[44:47], v[52:55]
v_mfma_f32_16x16x32_bf16 v[56:59], a[92:95], v[44:47], v[56:59]
v_mfma_f32_16x16x32_bf16 v[60:63], a[88:91], v[48:51], v[60:63]
v_mfma_f32_16x16x32_bf16 v[64:67], a[92:95], v[48:51], v[64:67]
s_waitcnt vmcnt(18)
ds_read_b64_tr_b16 a[96:97], v17 offset:0
ds_read_b64_tr_b16 a[98:99], v17 offset:256
ds_read_b64_tr_b16 a[100:101], v17 offset:8
ds_read_b64_tr_b16 a[102:103], v17 offset:264
ds_read_b64_tr_b16 a[104:105], v17 offset:2048
ds_read_b64_tr_b16 a[106:107], v17 offset:2304
ds_read_b64_tr_b16 a[108:109], v17 offset:2056
ds_read_b64_tr_b16 a[110:111], v17 offset:2312
s_waitcnt lgkmcnt(0)
ds_read_b64_tr_b16 a[112:113], v17 offset:4096
ds_read_b64_tr_b16 a[114:115], v17 offset:4352
ds_read_b64_tr_b16 a[116:117], v17 offset:4104
ds_read_b64_tr_b16 a[118:119], v17 offset:4360
ds_read_b64_tr_b16 a[120:121], v17 offset:6144
ds_read_b64_tr_b16 a[122:123], v17 offset:6400
ds_read_b64_tr_b16 a[124:125], v17 offset:6152
ds_read_b64_tr_b16 a[126:127], v17 offset:6408
s_waitcnt lgkmcnt(0)
s_mov_b32 s44, 6291456
buffer_load_dword v250, v12, s[4:7], s44 offen
s_add_u32 m0, s45, 0
s_mov_b32 s44, 6291456
buffer_load_dwordx4 v16, s[4:7], s44 offen lds
s_add_u32 m0, s45, 1024
s_mov_b32 s44, 6422528
buffer_load_dwordx4 v16, s[4:7], s44 offen lds
s_add_u32 m0, s45, 2048
s_mov_b32 s44, 6553600
buffer_load_dwordx4 v16, s[4:7], s44 offen lds
s_add_u32 m0, s45, 3072
s_mov_b32 s44, 6684672
buffer_load_dwordx4 v16, s[4:7], s44 offen lds
s_add_u32 m0, s45, 4096
s_mov_b32 s44, 6815744
buffer_load_dwordx4 v16, s[4:7], s44 offen lds
s_add_u32 m0, s45, 5120
s_mov_b32 s44, 6946816
buffer_load_dwordx4 v16, s[4:7], s44 offen lds
s_add_u32 m0, s45, 6144
s_mov_b32 s44, 7077888
buffer_load_dwordx4 v16, s[4:7], s44 offen lds
s_add_u32 m0, s45, 7168
s_mov_b32 s44, 7208960
buffer_load_dwordx4 v16, s[4:7], s44 offen lds
ds_read_b128 v[20:23], v8 offset:24576
ds_read_b128 v[24:27], v8 offset:26624
ds_read_b128 v[28:31], v9 offset:24576
ds_read_b128 v[32:35], v9 offset:26624
ds_read_b128 v[36:39], v8 offset:28672
ds_read_b128 v[40:43], v8 offset:30720
ds_read_b128 v[44:47], v9 offset:28672
ds_read_b128 v[48:51], v9 offset:30720
s_waitcnt lgkmcnt(0)
v_mfma_f32_16x16x32_bf16 v[52:55], a[96:99], v[20:23], v[52:55]
v_mfma_f32_16x16x32_bf16 v[56:59], a[100:103], v[20:23], v[56:59]
v_mfma_f32_16x16x32_bf16 v[60:63], a[96:99], v[24:27], v[60:63]
v_mfma_f32_16x16x32_bf16 v[64:67], a[100:103], v[24:27], v[64:67]
v_mfma_f32_16x16x32_bf16 v[52:55], a[104:107], v[28:31], v[52:55]
v_mfma_f32_16x16x32_bf16 v[56:59], a[108:111], v[28:31], v[56:59]
v_mfma_f32_16x16x32_bf16 v[60:63], a[104:107], v[32:35], v[60:63]
v_mfma_f32_16x16x32_bf16 v[64:67], a[108:111], v[32:35], v[64:67]
v_mfma_f32_16x16x32_bf16 v[52:55], a[112:115], v[36:39], v[52:55]
v_mfma_f32_16x16x32_bf16 v[56:59], a[116:119], v[36:39], v[56:59]
v_mfma_f32_16x16x32_bf16 v[60:63], a[112:115], v[40:43], v[60:63]
v_mfma_f32_16x16x32_bf16 v[64:67], a[116:119], v[40:43], v[64:67]
v_mfma_f32_16x16x32_bf16 v[52:55], a[120:123], v[44:47], v[52:55]
v_mfma_f32_16x16x32_bf16 v[56:59], a[124:127], v[44:47], v[56:59]
v_mfma_f32_16x16x32_bf16 v[60:63], a[120:123], v[48:51], v[60:63]
v_mfma_f32_16x16x32_bf16 v[64:67], a[124:127], v[48:51], v[64:67]
s_waitcnt vmcnt(18)
ds_read_b64_tr_b16 a[128:129], v17 offset:8192
ds_read_b64_tr_b16 a[130:131], v17 offset:8448
ds_read_b64_tr_b16 a[132:133], v17 offset:8200
ds_read_b64_tr_b16 a[134:135], v17 offset:8456
ds_read_b64_tr_b16 a[136:137], v17 offset:10240
ds_read_b64_tr_b16 a[138:139], v17 offset:10496
ds_read_b64_tr_b16 a[140:141], v17 offset:10248
ds_read_b64_tr_b16 a[142:143], v17 offset:10504
s_waitcnt lgkmcnt(0)
ds_read_b64_tr_b16 a[144:145], v17 offset:12288
ds_read_b64_tr_b16 a[146:147], v17 offset:12544
ds_read_b64_tr_b16 a[148:149], v17 offset:12296
ds_read_b64_tr_b16 a[150:151], v17 offset:12552
ds_read_b64_tr_b16 a[152:153], v17 offset:14336
ds_read_b64_tr_b16 a[154:155], v17 offset:14592
ds_read_b64_tr_b16 a[156:157], v17 offset:14344
ds_read_b64_tr_b16 a[158:159], v17 offset:14600
s_waitcnt lgkmcnt(0)
s_mov_b32 s44, 7340032
buffer_load_dword v250, v12, s[4:7], s44 offen
s_add_u32 m0, s45, 8192
s_mov_b32 s44, 7340032
buffer_load_dwordx4 v16, s[4:7], s44 offen lds
s_add_u32 m0, s45, 9216
s_mov_b32 s44, 7471104
buffer_load_dwordx4 v16, s[4:7], s44 offen lds
s_add_u32 m0, s45, 10240
s_mov_b32 s44, 7602176
buffer_load_dwordx4 v16, s[4:7], s44 offen lds
s_add_u32 m0, s45, 11264
s_mov_b32 s44, 7733248
buffer_load_dwordx4 v16, s[4:7], s44 offen lds
s_add_u32 m0, s45, 12288
s_mov_b32 s44, 7864320
buffer_load_dwordx4 v16, s[4:7], s44 offen lds
s_add_u32 m0, s45, 13312
s_mov_b32 s44, 7995392
buffer_load_dwordx4 v16, s[4:7], s44 offen lds
s_add_u32 m0, s45, 14336
s_mov_b32 s44, 8126464
buffer_load_dwordx4 v16, s[4:7], s44 offen lds
s_add_u32 m0, s45, 15360
s_mov_b32 s44, 8257536
buffer_load_dwordx4 v16, s[4:7], s44 offen lds
ds_read_b128 v[20:23], v8 offset:32768
ds_read_b128 v[24:27], v8 offset:34816
ds_read_b128 v[28:31], v9 offset:32768
ds_read_b128 v[32:35], v9 offset:34816
ds_read_b128 v[36:39], v8 offset:36864
ds_read_b128 v[40:43], v8 offset:38912
ds_read_b128 v[44:47], v9 offset:36864
ds_read_b128 v[48:51], v9 offset:38912
s_waitcnt lgkmcnt(0)
v_mfma_f32_16x16x32_bf16 v[52:55], a[128:131], v[20:23], v[52:55]
v_mfma_f32_16x16x32_bf16 v[56:59], a[132:135], v[20:23], v[56:59]
v_mfma_f32_16x16x32_bf16 v[60:63], a[128:131], v[24:27], v[60:63]
v_mfma_f32_16x16x32_bf16 v[64:67], a[132:135], v[24:27], v[64:67]
v_mfma_f32_16x16x32_bf16 v[52:55], a[136:139], v[28:31], v[52:55]
v_mfma_f32_16x16x32_bf16 v[56:59], a[140:143], v[28:31], v[56:59]
v_mfma_f32_16x16x32_bf16 v[60:63], a[136:139], v[32:35], v[60:63]
v_mfma_f32_16x16x32_bf16 v[64:67], a[140:143], v[32:35], v[64:67]
v_mfma_f32_16x16x32_bf16 v[52:55], a[144:147], v[36:39], v[52:55]
v_mfma_f32_16x16x32_bf16 v[56:59], a[148:151], v[36:39], v[56:59]
v_mfma_f32_16x16x32_bf16 v[60:63], a[144:147], v[40:43], v[60:63]
v_mfma_f32_16x16x32_bf16 v[64:67], a[148:151], v[40:43], v[64:67]
v_mfma_f32_16x16x32_bf16 v[52:55], a[152:155], v[44:47], v[52:55]
v_mfma_f32_16x16x32_bf16 v[56:59], a[156:159], v[44:47], v[56:59]
v_mfma_f32_16x16x32_bf16 v[60:63], a[152:155], v[48:51], v[60:63]
v_mfma_f32_16x16x32_bf16 v[64:67], a[156:159], v[48:51], v[64:67]
s_waitcnt vmcnt(18)
ds_read_b64_tr_b16 a[160:161], v17 offset:16384
ds_read_b64_tr_b16 a[162:163], v17 offset:16640
ds_read_b64_tr_b16 a[164:165], v17 offset:16392
ds_read_b64_tr_b16 a[166:167], v17 offset:16648
ds_read_b64_tr_b16 a[168:169], v17 offset:18432
ds_read_b64_tr_b16 a[170:171], v17 offset:18688
ds_read_b64_tr_b16 a[172:173], v17 offset:18440
ds_read_b64_tr_b16 a[174:175], v17 offset:18696
s_waitcnt lgkmcnt(0)
ds_read_b64_tr_b16 a[176:177], v17 offset:20480
ds_read_b64_tr_b16 a[178:179], v17 offset:20736
ds_read_b64_tr_b16 a[180:181], v17 offset:20488
ds_read_b64_tr_b16 a[182:183], v17 offset:20744
ds_read_b64_tr_b16 a[184:185], v17 offset:22528
ds_read_b64_tr_b16 a[186:187], v17 offset:22784
ds_read_b64_tr_b16 a[188:189], v17 offset:22536
ds_read_b64_tr_b16 a[190:191], v17 offset:22792
s_waitcnt lgkmcnt(0)
ds_read_b128 v[20:23], v8 offset:40960
ds_read_b128 v[24:27], v8 offset:43008
ds_read_b128 v[28:31], v9 offset:40960
ds_read_b128 v[32:35], v9 offset:43008
ds_read_b128 v[36:39], v8 offset:45056
ds_read_b128 v[40:43], v8 offset:47104
ds_read_b128 v[44:47], v9 offset:45056
ds_read_b128 v[48:51], v9 offset:47104
s_waitcnt lgkmcnt(0)
v_mfma_f32_16x16x32_bf16 v[52:55], a[160:163], v[20:23], v[52:55]
v_mfma_f32_16x16x32_bf16 v[56:59], a[164:167], v[20:23], v[56:59]
v_mfma_f32_16x16x32_bf16 v[60:63], a[160:163], v[24:27], v[60:63]
v_mfma_f32_16x16x32_bf16 v[64:67], a[164:167], v[24:27], v[64:67]
v_mfma_f32_16x16x32_bf16 v[52:55], a[168:171], v[28:31], v[52:55]
v_mfma_f32_16x16x32_bf16 v[56:59], a[172:175], v[28:31], v[56:59]
v_mfma_f32_16x16x32_bf16 v[60:63], a[168:171], v[32:35], v[60:63]
v_mfma_f32_16x16x32_bf16 v[64:67], a[172:175], v[32:35], v[64:67]
v_mfma_f32_16x16x32_bf16 v[52:55], a[176:179], v[36:39], v[52:55]
v_mfma_f32_16x16x32_bf16 v[56:59], a[180:183], v[36:39], v[56:59]
v_mfma_f32_16x16x32_bf16 v[60:63], a[176:179], v[40:43], v[60:63]
v_mfma_f32_16x16x32_bf16 v[64:67], a[180:183], v[40:43], v[64:67]
v_mfma_f32_16x16x32_bf16 v[52:55], a[184:187], v[44:47], v[52:55]
v_mfma_f32_16x16x32_bf16 v[56:59], a[188:191], v[44:47], v[56:59]
v_mfma_f32_16x16x32_bf16 v[60:63], a[184:187], v[48:51], v[60:63]
v_mfma_f32_16x16x32_bf16 v[64:67], a[188:191], v[48:51], v[64:67]
s_waitcnt vmcnt(9)
ds_read_b64_tr_b16 a[192:193], v17 offset:0
ds_read_b64_tr_b16 a[194:195], v17 offset:256
ds_read_b64_tr_b16 a[196:197], v17 offset:8
ds_read_b64_tr_b16 a[198:199], v17 offset:264
ds_read_b64_tr_b16 a[200:201], v17 offset:2048
ds_read_b64_tr_b16 a[202:203], v17 offset:2304
ds_read_b64_tr_b16 a[204:205], v17 offset:2056
ds_read_b64_tr_b16 a[206:207], v17 offset:2312
s_waitcnt lgkmcnt(0)
ds_read_b64_tr_b16 a[208:209], v17 offset:4096
ds_read_b64_tr_b16 a[210:211], v17 offset:4352
ds_read_b64_tr_b16 a[212:213], v17 offset:4104
ds_read_b64_tr_b16 a[214:215], v17 offset:4360
ds_read_b64_tr_b16 a[216:217], v17 offset:6144
ds_read_b64_tr_b16 a[218:219], v17 offset:6400
ds_read_b64_tr_b16 a[220:221], v17 offset:6152
ds_read_b64_tr_b16 a[222:223], v17 offset:6408
s_waitcnt lgkmcnt(0)
ds_read_b128 v[20:23], v8 offset:49152
ds_read_b128 v[24:27], v8 offset:51200
ds_read_b128 v[28:31], v9 offset:49152
ds_read_b128 v[32:35], v9 offset:51200
ds_read_b128 v[36:39], v8 offset:53248
ds_read_b128 v[40:43], v8 offset:55296
ds_read_b128 v[44:47], v9 offset:53248
ds_read_b128 v[48:51], v9 offset:55296
s_waitcnt lgkmcnt(0)
v_mfma_f32_16x16x32_bf16 v[52:55], a[192:195], v[20:23], v[52:55]
v_mfma_f32_16x16x32_bf16 v[56:59], a[196:199], v[20:23], v[56:59]
v_mfma_f32_16x16x32_bf16 v[60:63], a[192:195], v[24:27], v[60:63]
v_mfma_f32_16x16x32_bf16 v[64:67], a[196:199], v[24:27], v[64:67]
v_mfma_f32_16x16x32_bf16 v[52:55], a[200:203], v[28:31], v[52:55]
v_mfma_f32_16x16x32_bf16 v[56:59], a[204:207], v[28:31], v[56:59]
v_mfma_f32_16x16x32_bf16 v[60:63], a[200:203], v[32:35], v[60:63]
v_mfma_f32_16x16x32_bf16 v[64:67], a[204:207], v[32:35], v[64:67]
v_mfma_f32_16x16x32_bf16 v[52:55], a[208:211], v[36:39], v[52:55]
v_mfma_f32_16x16x32_bf16 v[56:59], a[212:215], v[36:39], v[56:59]
v_mfma_f32_16x16x32_bf16 v[60:63], a[208:211], v[40:43], v[60:63]
v_mfma_f32_16x16x32_bf16 v[64:67], a[212:215], v[40:43], v[64:67]
v_mfma_f32_16x16x32_bf16 v[52:55], a[216:219], v[44:47], v[52:55]
v_mfma_f32_16x16x32_bf16 v[56:59], a[220:223], v[44:47], v[56:59]
v_mfma_f32_16x16x32_bf16 v[60:63], a[216:219], v[48:51], v[60:63]
v_mfma_f32_16x16x32_bf16 v[64:67], a[220:223], v[48:51], v[64:67]
s_waitcnt vmcnt(0)
ds_read_b64_tr_b16 a[224:225], v17 offset:8192
ds_read_b64_tr_b16 a[226:227], v17 offset:8448
ds_read_b64_tr_b16 a[228:229], v17 offset:8200
ds_read_b64_tr_b16 a[230:231], v17 offset:8456
ds_read_b64_tr_b16 a[232:233], v17 offset:10240
ds_read_b64_tr_b16 a[234:235], v17 offset:10496
ds_read_b64_tr_b16 a[236:237], v17 offset:10248
ds_read_b64_tr_b16 a[238:239], v17 offset:10504
s_waitcnt lgkmcnt(0)
ds_read_b64_tr_b16 a[240:241], v17 offset:12288
ds_read_b64_tr_b16 a[242:243], v17 offset:12544
ds_read_b64_tr_b16 a[244:245], v17 offset:12296
ds_read_b64_tr_b16 a[246:247], v17 offset:12552
ds_read_b64_tr_b16 a[248:249], v17 offset:14336
ds_read_b64_tr_b16 a[250:251], v17 offset:14592
ds_read_b64_tr_b16 a[252:253], v17 offset:14344
ds_read_b64_tr_b16 a[254:255], v17 offset:14600
s_waitcnt lgkmcnt(0)
ds_read_b128 v[20:23], v8 offset:57344
ds_read_b128 v[24:27], v8 offset:59392
ds_read_b128 v[28:31], v9 offset:57344
ds_read_b128 v[32:35], v9 offset:59392
ds_read_b128 v[36:39], v8 offset:61440
ds_read_b128 v[40:43], v8 offset:63488
ds_read_b128 v[44:47], v9 offset:61440
ds_read_b128 v[48:51], v9 offset:63488
s_waitcnt lgkmcnt(0)
v_mfma_f32_16x16x32_bf16 v[52:55], a[224:227], v[20:23], v[52:55]
v_mfma_f32_16x16x32_bf16 v[56:59], a[228:231], v[20:23], v[56:59]
v_mfma_f32_16x16x32_bf16 v[60:63], a[224:227], v[24:27], v[60:63]
v_mfma_f32_16x16x32_bf16 v[64:67], a[228:231], v[24:27], v[64:67]
v_mfma_f32_16x16x32_bf16 v[52:55], a[232:235], v[28:31], v[52:55]
v_mfma_f32_16x16x32_bf16 v[56:59], a[236:239], v[28:31], v[56:59]
v_mfma_f32_16x16x32_bf16 v[60:63], a[232:235], v[32:35], v[60:63]
v_mfma_f32_16x16x32_bf16 v[64:67], a[236:239], v[32:35], v[64:67]
v_mfma_f32_16x16x32_bf16 v[52:55], a[240:243], v[36:39], v[52:55]
v_mfma_f32_16x16x32_bf16 v[56:59], a[244:247], v[36:39], v[56:59]
v_mfma_f32_16x16x32_bf16 v[60:63], a[240:243], v[40:43], v[60:63]
v_mfma_f32_16x16x32_bf16 v[64:67], a[244:247], v[40:43], v[64:67]
v_mfma_f32_16x16x32_bf16 v[52:55], a[248:251], v[44:47], v[52:55]
v_mfma_f32_16x16x32_bf16 v[56:59], a[252:255], v[44:47], v[56:59]
v_mfma_f32_16x16x32_bf16 v[60:63], a[248:251], v[48:51], v[60:63]
v_mfma_f32_16x16x32_bf16 v[64:67], a[252:255], v[48:51], v[64:67]
s_barrier
s_mov_b32 s50, 0x10000
s_add_u32 m0, s46, 65536
s_nop 0
buffer_load_dwordx4 v6, s[8:11], s50 offen offset:0 lds
s_add_u32 m0, s46, 69504
s_nop 0
buffer_load_dwordx4 v6, s[8:11], s50 offen offset:128 lds
s_add_u32 m0, s46, 73472
s_nop 0
buffer_load_dwordx4 v6, s[8:11], s50 offen offset:256 lds
s_add_u32 m0, s46, 77440
s_nop 0
buffer_load_dwordx4 v6, s[8:11], s50 offen offset:384 lds
s_add_u32 m0, s46, 81408
s_nop 0
buffer_load_dwordx4 v6, s[8:11], s50 offen offset:512 lds
s_add_u32 m0, s46, 85376
s_nop 0
buffer_load_dwordx4 v6, s[8:11], s50 offen offset:640 lds
s_add_u32 m0, s46, 89344
s_nop 0
buffer_load_dwordx4 v6, s[8:11], s50 offen offset:768 lds
s_add_u32 m0, s46, 93312
s_nop 0
buffer_load_dwordx4 v6, s[8:11], s50 offen offset:896 lds
s_add_u32 m0, s46, 97280
s_nop 0
buffer_load_dwordx4 v6, s[8:11], s50 offen offset:1024 lds
s_add_u32 m0, s46, 101248
s_nop 0
buffer_load_dwordx4 v6, s[8:11], s50 offen offset:1152 lds
s_add_u32 m0, s46, 105216
s_nop 0
buffer_load_dwordx4 v6, s[8:11], s50 offen offset:1280 lds
s_add_u32 m0, s46, 109184
s_nop 0
buffer_load_dwordx4 v6, s[8:11], s50 offen offset:1408 lds
s_add_u32 m0, s46, 113152
s_nop 0
buffer_load_dwordx4 v6, s[8:11], s50 offen offset:1536 lds
s_add_u32 m0, s46, 117120
s_nop 0
buffer_load_dwordx4 v6, s[8:11], s50 offen offset:1664 lds
s_add_u32 m0, s46, 121088
s_nop 0
buffer_load_dwordx4 v6, s[8:11], s50 offen offset:1792 lds
s_add_u32 m0, s46, 125056
s_nop 0
buffer_load_dwordx4 v6, s[8:11], s50 offen offset:1920 lds
v_and_b32 v3, 15, v0
v_lshlrev_b32 v3, 4, v3
s_branch mega_kernel_syc
mega_kernel_sycw:
s_sleep 4
mega_kernel_syc:
buffer_load_dword v2, v3, s[72:75], 0 offen sc1
s_waitcnt vmcnt(0)
mega_kernel_sycp:
s_cmp_eq_u32 s95, 1
s_cbranch_scc0 mega_kernel_sycf
v_readlane_b32 s76, v2, 14
s_mov_b32 s98, 0
s_cmp_eq_u32 s76, 32
s_cbranch_scc0 mega_kernel_sycw
s_branch mega_kernel_sycd
mega_kernel_sycf:
s_mov_b32 s77, 0
s_mov_b32 s78, 0
v_readlane_b32 s76, v2, 0
s_add_u32 s77, s77, s76
s_xor_b32 s76, s76, 32
s_or_b32 s78, s78, s76
v_readlane_b32 s76, v2, 1
s_add_u32 s77, s77, s76
s_xor_b32 s76, s76, 32
s_or_b32 s78, s78, s76
v_readlane_b32 s76, v2, 2
s_add_u32 s77, s77, s76
s_xor_b32 s76, s76, 32
s_or_b32 s78, s78, s76
v_readlane_b32 s76, v2, 3
s_add_u32 s77, s77, s76
s_xor_b32 s76, s76, 32
s_or_b32 s78, s78, s76
v_readlane_b32 s76, v2, 4
s_add_u32 s77, s77, s76
s_xor_b32 s76, s76, 32
s_or_b32 s78, s78, s76
v_readlane_b32 s76, v2, 5
s_add_u32 s77, s77, s76
s_xor_b32 s76, s76, 32
s_or_b32 s78, s78, s76
v_readlane_b32 s76, v2, 6
s_add_u32 s77, s77, s76
s_xor_b32 s76, s76, 32
s_or_b32 s78, s78, s76
v_readlane_b32 s76, v2, 7
s_add_u32 s77, s77, s76
s_xor_b32 s76, s76, 32
s_or_b32 s78, s78, s76
s_cmp_eq_u32 s77, 256
s_cbranch_scc0 mega_kernel_sycw
v_mov_b32 v252, v2
s_cmp_eq_u32 s78, 0
s_cbranch_scc0 mega_kernel_slowent
v_readlane_b32 s76, v2, 10
v_readlane_b32 s77, v2, 8
s_cmp_eq_u32 s76, 32
s_cbranch_scc0 mega_kernel_sycw
s_cmp_gt_u32 s77, 16
s_cselect_b32 s98, 1, 0
mega_kernel_sycd:
v_lshrrev_b32 v92, 4, v1
v_and_b32 v93, 15, v1
s_and_b32 s52, s41, 1
s_lshr_b32 s53, s41, 1
s_mov_b32 s54, 0x3e0293ee
s_mov_b32 s55, 0
s_mov_b32 s56, 0
v_mov_b32 v97, 0xff800000
v_mov_b32 v241, 0xceabdc6e
v_and_b32 v2, 7, v93
v_lshlrev_b32 v94, 7, v92
v_lshl_add_u32 v94, v2, 4, v94
v_and_b32 v2, 31, v1
v_lshlrev_b32 v95, 3, v2
v_lshrrev_b32 v2, 1, v92
v_lshlrev_b32 v96, 10, v2
v_and_b32 v2, 1, v92
v_lshl_add_u32 v96, v2, 9, v96
v_lshl_add_u32 v96, v93, 4, v96
s_lshl_b32 s43, s40, 14
s_lshl_b32 s44, s53, 12
s_add_u32 s43, s43, s44
s_lshl_b32 s44, s52, 8
s_add_u32 s43, s43, s44
s_add_u32 s43, s43, 134217728
v_add_u32 v96, s43, v96
s_lshl_b32 s43, s52, 4
v_add_u32 v98, s43, v93
v_lshlrev_b32 v2, 2, v92
v_sub_u32 v98, v98, v2
s_mov_b32 s28, 0
s_mov_b32 s29, -1
s_xor_b32 s44, s98, 1
s_lshl_b32 s44, s44, 13
s_lshl_b32 s43, s40, 7
s_add_u32 s43, s43, s44
s_add_u32 s43, s43, 69206016
v_and_b32 v2, 3, v1
v_bfe_u32 v3, v1, 2, 1
v_lshlrev_b32 v99, 12, v3
v_lshl_add_u32 v99, v2, 2, v99
v_add_u32 v99, s43, v99
s_xor_b32 s62, s98, 1
s_lshl_b32 s62, s62, 13
s_lshr_b32 s44, s47, 6
s_lshl_b32 s44, s44, 14
s_add_u32 s62, s62, s44
s_and_b32 s44, s47, 63
s_lshl_b32 s44, s44, 7
s_add_u32 s62, s62, s44
s_add_u32 s62, s62, 69222400
s_lshl_b32 s49, s40, 7
s_lshl_b32 s44, s41, 2
s_add_u32 s49, s49, s44
s_lshl_b32 s44, s98, 13
s_add_u32 s49, s49, s44
s_add_u32 s49, s49, 69255168
s_lshl_b32 s43, s41, 11
s_add_u32 s43, s43, 131072
v_add_u32 v101, s43, v7
s_lshl_b32 s43, s52, 10
s_add_u32 s43, s43, 131072
v_add_u32 v102, s43, v5
v_mov_b32 v16, 0
s_mov_b32 s50, 0
v_mov_b32 v104, 0x3f803f80
v_mov_b32 v105, 0x3f803f80
v_mov_b32 v106, 0x3f803f80
v_mov_b32 v107, 0x3f803f80
v_cmp_gt_i32 s[12:13], 0, v98
v_cmp_gt_i32 s[14:15], 1, v98
v_cmp_gt_i32 s[16:17], 2, v98
v_cmp_gt_i32 s[18:19], 3, v98
v_cmp_gt_i32 s[20:21], 16, v98
v_cmp_gt_i32 s[22:23], 17, v98
v_cmp_gt_i32 s[24:25], 18, v98
v_cmp_gt_i32 s[26:27], 19, v98
s_lshr_b32 s44, s47, 3
s_xor_b32 s44, s44, s98
s_and_b32 s44, s44, 1
s_lshl_b32 s44, s44, 13
s_lshl_b32 s58, s47, 18
s_add_u32 s58, s58, s44
s_add_u32 s58, s58, 0
s_lshr_b32 s44, s47, 4
s_xor_b32 s44, s44, s98
s_and_b32 s44, s44, 1
s_lshl_b32 s44, s44, 13
s_lshl_b32 s59, s47, 17
s_add_u32 s59, s59, s44
s_add_u32 s59, s59, 71303168
s_lshl_b32 s60, s41, 11
s_add_u32 s60, s60, 139264
s_lshl_b32 s61, s41, 10
s_add_u32 s61, s61, 155648
v_add_u32 v94, 155648, v94
s_lshl_b32 s43, s53, 11
s_add_u32 s43, s43, 156160
v_add_u32 v95, s43, v95
v_add_u32 v103, 139264, v5
s_lshl_b32 s43, s53, 12
s_add_u32 s43, s43, 147456
v_add_u32 v240, s43, v5
s_waitcnt vmcnt(0)
v_cvt_pk_bf16_f32 v220, v52, v53
v_cvt_pk_bf16_f32 v221, v54, v55
v_cvt_pk_bf16_f32 v222, v56, v57
v_cvt_pk_bf16_f32 v223, v58, v59
v_cvt_pk_bf16_f32 v224, v60, v61
v_cvt_pk_bf16_f32 v225, v62, v63
v_cvt_pk_bf16_f32 v226, v64, v65
v_cvt_pk_bf16_f32 v227, v66, v67
s_barrier
s_mov_b32 s50, 0x20000
ds_read_b128 v[20:23], v10 offset:0
ds_read_b128 v[24:27], v10 offset:2048
ds_read_b128 v[28:31], v11 offset:0
ds_read_b128 v[32:35], v11 offset:2048
ds_read_b128 v[36:39], v10 offset:4096
ds_read_b128 v[40:43], v10 offset:6144
s_add_u32 m0, s46, 0
s_waitcnt lgkmcnt(4)
v_mfma_f32_16x16x32_bf16 v[52:55], a[0:3], v[20:23], 0
ds_read_b128 v[44:47], v11 offset:4096
v_mfma_f32_16x16x32_bf16 v[56:59], a[4:7], v[20:23], 0
buffer_load_dwordx4 v6, s[8:11], s50 offen offset:0 lds
v_mfma_f32_16x16x32_bf16 v[60:63], a[0:3], v[24:27], 0
ds_read_b128 v[48:51], v11 offset:6144
v_mfma_f32_16x16x32_bf16 v[64:67], a[4:7], v[24:27], 0
s_add_u32 m0, s46, 3968
s_waitcnt lgkmcnt(4)
v_mfma_f32_16x16x32_bf16 v[52:55], a[8:11], v[28:31], v[52:55]
ds_read_b128 v[20:23], v10 offset:8192
v_mfma_f32_16x16x32_bf16 v[56:59], a[12:15], v[28:31], v[56:59]
buffer_load_dwordx4 v6, s[8:11], s50 offen offset:128 lds
v_mfma_f32_16x16x32_bf16 v[60:63], a[8:11], v[32:35], v[60:63]
ds_read_b128 v[24:27], v10 offset:10240
v_mfma_f32_16x16x32_bf16 v[64:67], a[12:15], v[32:35], v[64:67]
s_add_u32 m0, s46, 7936
s_waitcnt lgkmcnt(4)
v_mfma_f32_16x16x32_bf16 v[52:55], a[16:19], v[36:39], v[52:55]
ds_read_b128 v[28:31], v11 offset:8192
v_mfma_f32_16x16x32_bf16 v[56:59], a[20:23], v[36:39], v[56:59]
buffer_load_dwordx4 v6, s[8:11], s50 offen offset:256 lds
v_mfma_f32_16x16x32_bf16 v[60:63], a[16:19], v[40:43], v[60:63]
ds_read_b128 v[32:35], v11 offset:10240
v_mfma_f32_16x16x32_bf16 v[64:67], a[20:23], v[40:43], v[64:67]
s_add_u32 m0, s46, 11904
s_waitcnt lgkmcnt(4)
v_mfma_f32_16x16x32_bf16 v[52:55], a[24:27], v[44:47], v[52:55]
ds_read_b128 v[36:39], v10 offset:12288
v_mfma_f32_16x16x32_bf16 v[56:59], a[28:31], v[44:47], v[56:59]
buffer_load_dwordx4 v6, s[8:11], s50 offen offset:384 lds
v_mfma_f32_16x16x32_bf16 v[60:63], a[24:27], v[48:51], v[60:63]
ds_read_b128 v[40:43], v10 offset:14336
v_mfma_f32_16x16x32_bf16 v[64:67], a[28:31], v[48:51], v[64:67]
s_add_u32 m0, s46, 15872
s_waitcnt lgkmcnt(4)
v_mfma_f32_16x16x32_bf16 v[52:55], a[32:35], v[20:23], v[52:55]
ds_read_b128 v[44:47], v11 offset:12288
v_mfma_f32_16x16x32_bf16 v[56:59], a[36:39], v[20:23], v[56:59]
buffer_load_dwordx4 v6, s[8:11], s50 offen offset:512 lds
v_mfma_f32_16x16x32_bf16 v[60:63], a[32:35], v[24:27], v[60:63]
ds_read_b128 v[48:51], v11 offset:14336
v_mfma_f32_16x16x32_bf16 v[64:67], a[36:39], v[24:27], v[64:67]
s_add_u32 m0, s46, 19840
s_waitcnt lgkmcnt(4)
v_mfma_f32_16x16x32_bf16 v[52:55], a[40:43], v[28:31], v[52:55]
ds_read_b128 v[20:23], v10 offset:16384
v_mfma_f32_16x16x32_bf16 v[56:59], a[44:47], v[28:31], v[56:59]
buffer_load_dwordx4 v6, s[8:11], s50 offen offset:640 lds
v_mfma_f32_16x16x32_bf16 v[60:63], a[40:43], v[32:35], v[60:63]
ds_read_b128 v[24:27], v10 offset:18432
v_mfma_f32_16x16x32_bf16 v[64:67], a[44:47], v[32:35], v[64:67]
s_add_u32 m0, s46, 23808
s_waitcnt lgkmcnt(4)
v_mfma_f32_16x16x32_bf16 v[52:55], a[48:51], v[36:39], v[52:55]
ds_read_b128 v[28:31], v11 offset:16384
v_mfma_f32_16x16x32_bf16 v[56:59], a[52:55], v[36:39], v[56:59]
buffer_load_dwordx4 v6, s[8:11], s50 offen offset:768 lds
v_mfma_f32_16x16x32_bf16 v[60:63], a[48:51], v[40:43], v[60:63]
ds_read_b128 v[32:35], v11 offset:18432
v_mfma_f32_16x16x32_bf16 v[64:67], a[52:55], v[40:43], v[64:67]
s_add_u32 m0, s46, 27776
s_waitcnt lgkmcnt(4)
v_mfma_f32_16x16x32_bf16 v[52:55], a[56:59], v[44:47], v[52:55]
ds_read_b128 v[36:39], v10 offset:20480
v_mfma_f32_16x16x32_bf16 v[56:59], a[60:63], v[44:47], v[56:59]
buffer_load_dwordx4 v6, s[8:11], s50 offen offset:896 lds
v_mfma_f32_16x16x32_bf16 v[60:63], a[56:59], v[48:51], v[60:63]
ds_read_b128 v[40:43], v10 offset:22528
v_mfma_f32_16x16x32_bf16 v[64:67], a[60:63], v[48:51], v[64:67]
s_add_u32 m0, s46, 31744
s_waitcnt lgkmcnt(4)
v_mfma_f32_16x16x32_bf16 v[52:55], a[64:67], v[20:23], v[52:55]
ds_read_b128 v[44:47], v11 offset:20480
v_mfma_f32_16x16x32_bf16 v[56:59], a[68:71], v[20:23], v[56:59]
buffer_load_dwordx4 v6, s[8:11], s50 offen offset:1024 lds
v_mfma_f32_16x16x32_bf16 v[60:63], a[64:67], v[24:27], v[60:63]
ds_read_b128 v[48:51], v11 offset:22528
v_mfma_f32_16x16x32_bf16 v[64:67], a[68:71], v[24:27], v[64:67]
s_add_u32 m0, s46, 35712
s_waitcnt lgkmcnt(4)
v_mfma_f32_16x16x32_bf16 v[52:55], a[72:75], v[28:31], v[52:55]
ds_read_b128 v[20:23], v10 offset:24576
v_mfma_f32_16x16x32_bf16 v[56:59], a[76:79], v[28:31], v[56:59]
buffer_load_dwordx4 v6, s[8:11], s50 offen offset:1152 lds
v_mfma_f32_16x16x32_bf16 v[60:63], a[72:75], v[32:35], v[60:63]
ds_read_b128 v[24:27], v10 offset:26624
v_mfma_f32_16x16x32_bf16 v[64:67], a[76:79], v[32:35], v[64:67]
s_add_u32 m0, s46, 39680
s_waitcnt lgkmcnt(4)
v_mfma_f32_16x16x32_bf16 v[52:55], a[80:83], v[36:39], v[52:55]
ds_read_b128 v[28:31], v11 offset:24576
v_mfma_f32_16x16x32_bf16 v[56:59], a[84:87], v[36:39], v[56:59]
buffer_load_dwordx4 v6, s[8:11], s50 offen offset:1280 lds
v_mfma_f32_16x16x32_bf16 v[60:63], a[80:83], v[40:43], v[60:63]
ds_read_b128 v[32:35], v11 offset:26624
v_mfma_f32_16x16x32_bf16 v[64:67], a[84:87], v[40:43], v[64:67]
s_add_u32 m0, s46, 43648
s_waitcnt lgkmcnt(4)
v_mfma_f32_16x16x32_bf16 v[52:55], a[88:91], v[44:47], v[52:55]
ds_read_b128 v[36:39], v10 offset:28672
v_mfma_f32_16x16x32_bf16 v[56:59], a[92:95], v[44:47], v[56:59]
buffer_load_dwordx4 v6, s[8:11], s50 offen offset:1408 lds
v_mfma_f32_16x16x32_bf16 v[60:63], a[88:91], v[48:51], v[60:63]
ds_read_b128 v[40:43], v10 offset:30720
v_mfma_f32_16x16x32_bf16 v[64:67], a[92:95], v[48:51], v[64:67]
s_add_u32 m0, s46, 47616
s_waitcnt lgkmcnt(4)
v_mfma_f32_16x16x32_bf16 v[52:55], a[96:99], v[20:23], v[52:55]
ds_read_b128 v[44:47], v11 offset:28672
v_mfma_f32_16x16x32_bf16 v[56:59], a[100:103], v[20:23], v[56:59]
buffer_load_dwordx4 v6, s[8:11], s50 offen offset:1536 lds
v_mfma_f32_16x16x32_bf16 v[60:63], a[96:99], v[24:27], v[60:63]
ds_read_b128 v[48:51], v11 offset:30720
v_mfma_f32_16x16x32_bf16 v[64:67], a[100:103], v[24:27], v[64:67]
s_add_u32 m0, s46, 51584
s_waitcnt lgkmcnt(4)
v_mfma_f32_16x16x32_bf16 v[52:55], a[104:107], v[28:31], v[52:55]
ds_read_b128 v[20:23], v10 offset:32768
v_mfma_f32_16x16x32_bf16 v[56:59], a[108:111], v[28:31], v[56:59]
buffer_load_dwordx4 v6, s[8:11], s50 offen offset:1664 lds
v_mfma_f32_16x16x32_bf16 v[60:63], a[104:107], v[32:35], v[60:63]
ds_read_b128 v[24:27], v10 offset:34816
v_mfma_f32_16x16x32_bf16 v[64:67], a[108:111], v[32:35], v[64:67]
s_add_u32 m0, s46, 55552
s_waitcnt lgkmcnt(4)
v_mfma_f32_16x16x32_bf16 v[52:55], a[112:115], v[36:39], v[52:55]
ds_read_b128 v[28:31], v11 offset:32768
v_mfma_f32_16x16x32_bf16 v[56:59], a[116:119], v[36:39], v[56:59]
buffer_load_dwordx4 v6, s[8:11], s50 offen offset:1792 lds
v_mfma_f32_16x16x32_bf16 v[60:63], a[112:115], v[40:43], v[60:63]
ds_read_b128 v[32:35], v11 offset:34816
v_mfma_f32_16x16x32_bf16 v[64:67], a[116:119], v[40:43], v[64:67]
s_add_u32 m0, s46, 59520
s_waitcnt lgkmcnt(4)
v_mfma_f32_16x16x32_bf16 v[52:55], a[120:123], v[44:47], v[52:55]
ds_read_b128 v[36:39], v10 offset:36864
v_mfma_f32_16x16x32_bf16 v[56:59], a[124:127], v[44:47], v[56:59]
buffer_load_dwordx4 v6, s[8:11], s50 offen offset:1920 lds
v_mfma_f32_16x16x32_bf16 v[60:63], a[120:123], v[48:51], v[60:63]
ds_read_b128 v[40:43], v10 offset:38912
v_mfma_f32_16x16x32_bf16 v[64:67], a[124:127], v[48:51], v[64:67]
s_waitcnt lgkmcnt(4)
v_mfma_f32_16x16x32_bf16 v[52:55], a[128:131], v[20:23], v[52:55]
ds_read_b128 v[44:47], v11 offset:36864
v_mfma_f32_16x16x32_bf16 v[56:59], a[132:135], v[20:23], v[56:59]
v_mfma_f32_16x16x32_bf16 v[60:63], a[128:131], v[24:27], v[60:63]
ds_read_b128 v[48:51], v11 offset:38912
v_mfma_f32_16x16x32_bf16 v[64:67], a[132:135], v[24:27], v[64:67]
s_waitcnt lgkmcnt(4)
v_mfma_f32_16x16x32_bf16 v[52:55], a[136:139], v[28:31], v[52:55]
ds_read_b128 v[20:23], v10 offset:40960
v_mfma_f32_16x16x32_bf16 v[56:59], a[140:143], v[28:31], v[56:59]
v_mfma_f32_16x16x32_bf16 v[60:63], a[136:139], v[32:35], v[60:63]
ds_read_b128 v[24:27], v10 offset:43008
v_mfma_f32_16x16x32_bf16 v[64:67], a[140:143], v[32:35], v[64:67]
s_waitcnt lgkmcnt(4)
v_mfma_f32_16x16x32_bf16 v[52:55], a[144:147], v[36:39], v[52:55]
ds_read_b128 v[28:31], v11 offset:40960
v_mfma_f32_16x16x32_bf16 v[56:59], a[148:151], v[36:39], v[56:59]
v_mfma_f32_16x16x32_bf16 v[60:63], a[144:147], v[40:43], v[60:63]
ds_read_b128 v[32:35], v11 offset:43008
v_mfma_f32_16x16x32_bf16 v[64:67], a[148:151], v[40:43], v[64:67]
s_waitcnt lgkmcnt(4)
v_mfma_f32_16x16x32_bf16 v[52:55], a[152:155], v[44:47], v[52:55]
ds_read_b128 v[36:39], v10 offset:45056
v_mfma_f32_16x16x32_bf16 v[56:59], a[156:159], v[44:47], v[56:59]
v_mfma_f32_16x16x32_bf16 v[60:63], a[152:155], v[48:51], v[60:63]
ds_read_b128 v[40:43], v10 offset:47104
v_mfma_f32_16x16x32_bf16 v[64:67], a[156:159], v[48:51], v[64:67]
s_waitcnt lgkmcnt(4)
v_mfma_f32_16x16x32_bf16 v[52:55], a[160:163], v[20:23], v[52:55]
ds_read_b128 v[44:47], v11 offset:45056
v_mfma_f32_16x16x32_bf16 v[56:59], a[164:167], v[20:23], v[56:59]
v_mfma_f32_16x16x32_bf16 v[60:63], a[160:163], v[24:27], v[60:63]
ds_read_b128 v[48:51], v11 offset:47104
v_mfma_f32_16x16x32_bf16 v[64:67], a[164:167], v[24:27], v[64:67]
s_waitcnt lgkmcnt(4)
v_mfma_f32_16x16x32_bf16 v[52:55], a[168:171], v[28:31], v[52:55]
ds_read_b128 v[20:23], v10 offset:49152
v_mfma_f32_16x16x32_bf16 v[56:59], a[172:175], v[28:31], v[56:59]
v_mfma_f32_16x16x32_bf16 v[60:63], a[168:171], v[32:35], v[60:63]
ds_read_b128 v[24:27], v10 offset:51200
v_mfma_f32_16x16x32_bf16 v[64:67], a[172:175], v[32:35], v[64:67]
s_waitcnt lgkmcnt(4)
v_mfma_f32_16x16x32_bf16 v[52:55], a[176:179], v[36:39], v[52:55]
ds_read_b128 v[28:31], v11 offset:49152
v_mfma_f32_16x16x32_bf16 v[56:59], a[180:183], v[36:39], v[56:59]
v_mfma_f32_16x16x32_bf16 v[60:63], a[176:179], v[40:43], v[60:63]
ds_read_b128 v[32:35], v11 offset:51200
v_mfma_f32_16x16x32_bf16 v[64:67], a[180:183], v[40:43], v[64:67]
s_waitcnt lgkmcnt(4)
v_mfma_f32_16x16x32_bf16 v[52:55], a[184:187], v[44:47], v[52:55]
ds_read_b128 v[36:39], v10 offset:53248
v_mfma_f32_16x16x32_bf16 v[56:59], a[188:191], v[44:47], v[56:59]
v_mfma_f32_16x16x32_bf16 v[60:63], a[184:187], v[48:51], v[60:63]
ds_read_b128 v[40:43], v10 offset:55296
v_mfma_f32_16x16x32_bf16 v[64:67], a[188:191], v[48:51], v[64:67]
s_waitcnt lgkmcnt(4)
v_mfma_f32_16x16x32_bf16 v[52:55], a[192:195], v[20:23], v[52:55]
ds_read_b128 v[44:47], v11 offset:53248
v_mfma_f32_16x16x32_bf16 v[56:59], a[196:199], v[20:23], v[56:59]
v_mfma_f32_16x16x32_bf16 v[60:63], a[192:195], v[24:27], v[60:63]
ds_read_b128 v[48:51], v11 offset:55296
v_mfma_f32_16x16x32_bf16 v[64:67], a[196:199], v[24:27], v[64:67]
s_waitcnt lgkmcnt(4)
v_mfma_f32_16x16x32_bf16 v[52:55], a[200:203], v[28:31], v[52:55]
ds_read_b128 v[20:23], v10 offset:57344
v_mfma_f32_16x16x32_bf16 v[56:59], a[204:207], v[28:31], v[56:59]
v_mfma_f32_16x16x32_bf16 v[60:63], a[200:203], v[32:35], v[60:63]
ds_read_b128 v[24:27], v10 offset:59392
v_mfma_f32_16x16x32_bf16 v[64:67], a[204:207], v[32:35], v[64:67]
s_waitcnt lgkmcnt(4)
v_mfma_f32_16x16x32_bf16 v[52:55], a[208:211], v[36:39], v[52:55]
ds_read_b128 v[28:31], v11 offset:57344
v_mfma_f32_16x16x32_bf16 v[56:59], a[212:215], v[36:39], v[56:59]
v_mfma_f32_16x16x32_bf16 v[60:63], a[208:211], v[40:43], v[60:63]
ds_read_b128 v[32:35], v11 offset:59392
v_mfma_f32_16x16x32_bf16 v[64:67], a[212:215], v[40:43], v[64:67]
s_waitcnt lgkmcnt(4)
v_mfma_f32_16x16x32_bf16 v[52:55], a[216:219], v[44:47], v[52:55]
ds_read_b128 v[36:39], v10 offset:61440
v_mfma_f32_16x16x32_bf16 v[56:59], a[220:223], v[44:47], v[56:59]
v_mfma_f32_16x16x32_bf16 v[60:63], a[216:219], v[48:51], v[60:63]
ds_read_b128 v[40:43], v10 offset:63488
v_mfma_f32_16x16x32_bf16 v[64:67], a[220:223], v[48:51], v[64:67]
s_waitcnt lgkmcnt(4)
v_mfma_f32_16x16x32_bf16 v[52:55], a[224:227], v[20:23], v[52:55]
ds_read_b128 v[44:47], v11 offset:61440
v_mfma_f32_16x16x32_bf16 v[56:59], a[228:231], v[20:23], v[56:59]
v_mfma_f32_16x16x32_bf16 v[60:63], a[224:227], v[24:27], v[60:63]
ds_read_b128 v[48:51], v11 offset:63488
v_mfma_f32_16x16x32_bf16 v[64:67], a[228:231], v[24:27], v[64:67]
s_waitcnt lgkmcnt(5)
v_mfma_f32_16x16x32_bf16 v[52:55], a[232:235], v[28:31], v[52:55]
v_mfma_f32_16x16x32_bf16 v[56:59], a[236:239], v[28:31], v[56:59]
s_waitcnt lgkmcnt(4)
v_mfma_f32_16x16x32_bf16 v[60:63], a[232:235], v[32:35], v[60:63]
v_mfma_f32_16x16x32_bf16 v[64:67], a[236:239], v[32:35], v[64:67]
s_waitcnt lgkmcnt(3)
v_mfma_f32_16x16x32_bf16 v[52:55], a[240:243], v[36:39], v[52:55]
v_mfma_f32_16x16x32_bf16 v[56:59], a[244:247], v[36:39], v[56:59]
s_waitcnt lgkmcnt(2)
v_mfma_f32_16x16x32_bf16 v[60:63], a[240:243], v[40:43], v[60:63]
v_mfma_f32_16x16x32_bf16 v[64:67], a[244:247], v[40:43], v[64:67]
s_waitcnt lgkmcnt(1)
v_mfma_f32_16x16x32_bf16 v[52:55], a[248:251], v[44:47], v[52:55]
v_mfma_f32_16x16x32_bf16 v[56:59], a[252:255], v[44:47], v[56:59]
s_waitcnt lgkmcnt(0)
v_mfma_f32_16x16x32_bf16 v[60:63], a[248:251], v[48:51], v[60:63]
v_mfma_f32_16x16x32_bf16 v[64:67], a[252:255], v[48:51], v[64:67]
s_waitcnt vmcnt(0)
s_barrier
s_mov_b32 s50, 0x30000
s_nop 5
v_cvt_pk_bf16_f32 v228, v52, v53
v_cvt_pk_bf16_f32 v229, v54, v55
v_cvt_pk_bf16_f32 v230, v56, v57
v_cvt_pk_bf16_f32 v231, v58, v59
v_cvt_pk_bf16_f32 v232, v60, v61
v_cvt_pk_bf16_f32 v233, v62, v63
v_cvt_pk_bf16_f32 v234, v64, v65
v_cvt_pk_bf16_f32 v235, v66, v67
ds_read_b128 v[20:23], v8 offset:0
ds_read_b128 v[24:27], v8 offset:2048
ds_read_b128 v[28:31], v9 offset:0
ds_read_b128 v[32:35], v9 offset:2048
ds_read_b128 v[36:39], v8 offset:4096
ds_read_b128 v[40:43], v8 offset:6144
s_add_u32 m0, s46, 65536
s_waitcnt lgkmcnt(4)
v_mfma_f32_16x16x32_bf16 v[52:55], a[0:3], v[20:23], 0
ds_read_b128 v[44:47], v9 offset:4096
v_mfma_f32_16x16x32_bf16 v[56:59], a[4:7], v[20:23], 0
buffer_load_dwordx4 v6, s[8:11], s50 offen offset:0 lds
v_mfma_f32_16x16x32_bf16 v[60:63], a[0:3], v[24:27], 0
ds_read_b128 v[48:51], v9 offset:6144
v_mfma_f32_16x16x32_bf16 v[64:67], a[4:7], v[24:27], 0
s_add_u32 m0, s46, 69504
s_waitcnt lgkmcnt(4)
v_mfma_f32_16x16x32_bf16 v[52:55], a[8:11], v[28:31], v[52:55]
ds_read_b128 v[20:23], v8 offset:8192
v_mfma_f32_16x16x32_bf16 v[56:59], a[12:15], v[28:31], v[56:59]
buffer_load_dwordx4 v6, s[8:11], s50 offen offset:128 lds
v_mfma_f32_16x16x32_bf16 v[60:63], a[8:11], v[32:35], v[60:63]
ds_read_b128 v[24:27], v8 offset:10240
v_mfma_f32_16x16x32_bf16 v[64:67], a[12:15], v[32:35], v[64:67]
s_add_u32 m0, s46, 73472
s_waitcnt lgkmcnt(4)
v_mfma_f32_16x16x32_bf16 v[52:55], a[16:19], v[36:39], v[52:55]
ds_read_b128 v[28:31], v9 offset:8192
v_mfma_f32_16x16x32_bf16 v[56:59], a[20:23], v[36:39], v[56:59]
buffer_load_dwordx4 v6, s[8:11], s50 offen offset:256 lds
v_mfma_f32_16x16x32_bf16 v[60:63], a[16:19], v[40:43], v[60:63]
ds_read_b128 v[32:35], v9 offset:10240
v_mfma_f32_16x16x32_bf16 v[64:67], a[20:23], v[40:43], v[64:67]
s_add_u32 m0, s46, 77440
s_waitcnt lgkmcnt(4)
v_mfma_f32_16x16x32_bf16 v[52:55], a[24:27], v[44:47], v[52:55]
ds_read_b128 v[36:39], v8 offset:12288
v_mfma_f32_16x16x32_bf16 v[56:59], a[28:31], v[44:47], v[56:59]
buffer_load_dwordx4 v6, s[8:11], s50 offen offset:384 lds
v_mfma_f32_16x16x32_bf16 v[60:63], a[24:27], v[48:51], v[60:63]
ds_read_b128 v[40:43], v8 offset:14336
v_mfma_f32_16x16x32_bf16 v[64:67], a[28:31], v[48:51], v[64:67]
s_add_u32 m0, s46, 81408
s_waitcnt lgkmcnt(4)
v_mfma_f32_16x16x32_bf16 v[52:55], a[32:35], v[20:23], v[52:55]
ds_read_b128 v[44:47], v9 offset:12288
v_mfma_f32_16x16x32_bf16 v[56:59], a[36:39], v[20:23], v[56:59]
buffer_load_dwordx4 v6, s[8:11], s50 offen offset:512 lds
v_mfma_f32_16x16x32_bf16 v[60:63], a[32:35], v[24:27], v[60:63]
ds_read_b128 v[48:51], v9 offset:14336
v_mfma_f32_16x16x32_bf16 v[64:67], a[36:39], v[24:27], v[64:67]
s_add_u32 m0, s46, 85376
s_waitcnt lgkmcnt(4)
v_mfma_f32_16x16x32_bf16 v[52:55], a[40:43], v[28:31], v[52:55]
ds_read_b128 v[20:23], v8 offset:16384
v_mfma_f32_16x16x32_bf16 v[56:59], a[44:47], v[28:31], v[56:59]
buffer_load_dwordx4 v6, s[8:11], s50 offen offset:640 lds
v_mfma_f32_16x16x32_bf16 v[60:63], a[40:43], v[32:35], v[60:63]
ds_read_b128 v[24:27], v8 offset:18432
v_mfma_f32_16x16x32_bf16 v[64:67], a[44:47], v[32:35], v[64:67]
s_add_u32 m0, s46, 89344
s_waitcnt lgkmcnt(4)
v_mfma_f32_16x16x32_bf16 v[52:55], a[48:51], v[36:39], v[52:55]
ds_read_b128 v[28:31], v9 offset:16384
v_mfma_f32_16x16x32_bf16 v[56:59], a[52:55], v[36:39], v[56:59]
buffer_load_dwordx4 v6, s[8:11], s50 offen offset:768 lds
v_mfma_f32_16x16x32_bf16 v[60:63], a[48:51], v[40:43], v[60:63]
ds_read_b128 v[32:35], v9 offset:18432
v_mfma_f32_16x16x32_bf16 v[64:67], a[52:55], v[40:43], v[64:67]
s_add_u32 m0, s46, 93312
s_waitcnt lgkmcnt(4)
v_mfma_f32_16x16x32_bf16 v[52:55], a[56:59], v[44:47], v[52:55]
ds_read_b128 v[36:39], v8 offset:20480
v_mfma_f32_16x16x32_bf16 v[56:59], a[60:63], v[44:47], v[56:59]
buffer_load_dwordx4 v6, s[8:11], s50 offen offset:896 lds
v_mfma_f32_16x16x32_bf16 v[60:63], a[56:59], v[48:51], v[60:63]
ds_read_b128 v[40:43], v8 offset:22528
v_mfma_f32_16x16x32_bf16 v[64:67], a[60:63], v[48:51], v[64:67]
s_add_u32 m0, s46, 97280
s_waitcnt lgkmcnt(4)
v_mfma_f32_16x16x32_bf16 v[52:55], a[64:67], v[20:23], v[52:55]
ds_read_b128 v[44:47], v9 offset:20480
v_mfma_f32_16x16x32_bf16 v[56:59], a[68:71], v[20:23], v[56:59]
buffer_load_dwordx4 v6, s[8:11], s50 offen offset:1024 lds
v_mfma_f32_16x16x32_bf16 v[60:63], a[64:67], v[24:27], v[60:63]
ds_read_b128 v[48:51], v9 offset:22528
v_mfma_f32_16x16x32_bf16 v[64:67], a[68:71], v[24:27], v[64:67]
s_add_u32 m0, s46, 101248
s_waitcnt lgkmcnt(4)
v_mfma_f32_16x16x32_bf16 v[52:55], a[72:75], v[28:31], v[52:55]
ds_read_b128 v[20:23], v8 offset:24576
v_mfma_f32_16x16x32_bf16 v[56:59], a[76:79], v[28:31], v[56:59]
buffer_load_dwordx4 v6, s[8:11], s50 offen offset:1152 lds
v_mfma_f32_16x16x32_bf16 v[60:63], a[72:75], v[32:35], v[60:63]
ds_read_b128 v[24:27], v8 offset:26624
v_mfma_f32_16x16x32_bf16 v[64:67], a[76:79], v[32:35], v[64:67]
s_add_u32 m0, s46, 105216
s_waitcnt lgkmcnt(4)
v_mfma_f32_16x16x32_bf16 v[52:55], a[80:83], v[36:39], v[52:55]
ds_read_b128 v[28:31], v9 offset:24576
v_mfma_f32_16x16x32_bf16 v[56:59], a[84:87], v[36:39], v[56:59]
buffer_load_dwordx4 v6, s[8:11], s50 offen offset:1280 lds
v_mfma_f32_16x16x32_bf16 v[60:63], a[80:83], v[40:43], v[60:63]
ds_read_b128 v[32:35], v9 offset:26624
v_mfma_f32_16x16x32_bf16 v[64:67], a[84:87], v[40:43], v[64:67]
s_add_u32 m0, s46, 109184
s_waitcnt lgkmcnt(4)
v_mfma_f32_16x16x32_bf16 v[52:55], a[88:91], v[44:47], v[52:55]
ds_read_b128 v[36:39], v8 offset:28672
v_mfma_f32_16x16x32_bf16 v[56:59], a[92:95], v[44:47], v[56:59]
buffer_load_dwordx4 v6, s[8:11], s50 offen offset:1408 lds
v_mfma_f32_16x16x32_bf16 v[60:63], a[88:91], v[48:51], v[60:63]
ds_read_b128 v[40:43], v8 offset:30720
v_mfma_f32_16x16x32_bf16 v[64:67], a[92:95], v[48:51], v[64:67]
s_add_u32 m0, s46, 113152
s_waitcnt lgkmcnt(4)
v_mfma_f32_16x16x32_bf16 v[52:55], a[96:99], v[20:23], v[52:55]
ds_read_b128 v[44:47], v9 offset:28672
v_mfma_f32_16x16x32_bf16 v[56:59], a[100:103], v[20:23], v[56:59]
buffer_load_dwordx4 v6, s[8:11], s50 offen offset:1536 lds
v_mfma_f32_16x16x32_bf16 v[60:63], a[96:99], v[24:27], v[60:63]
ds_read_b128 v[48:51], v9 offset:30720
v_mfma_f32_16x16x32_bf16 v[64:67], a[100:103], v[24:27], v[64:67]
s_add_u32 m0, s46, 117120
s_waitcnt lgkmcnt(4)
v_mfma_f32_16x16x32_bf16 v[52:55], a[104:107], v[28:31], v[52:55]
ds_read_b128 v[20:23], v8 offset:32768
v_mfma_f32_16x16x32_bf16 v[56:59], a[108:111], v[28:31], v[56:59]
buffer_load_dwordx4 v6, s[8:11], s50 offen offset:1664 lds
v_mfma_f32_16x16x32_bf16 v[60:63], a[104:107], v[32:35], v[60:63]
ds_read_b128 v[24:27], v8 offset:34816
v_mfma_f32_16x16x32_bf16 v[64:67], a[108:111], v[32:35], v[64:67]
s_add_u32 m0, s46, 121088
s_waitcnt lgkmcnt(4)
v_mfma_f32_16x16x32_bf16 v[52:55], a[112:115], v[36:39], v[52:55]
ds_read_b128 v[28:31], v9 offset:32768
v_mfma_f32_16x16x32_bf16 v[56:59], a[116:119], v[36:39], v[56:59]
buffer_load_dwordx4 v6, s[8:11], s50 offen offset:1792 lds
v_mfma_f32_16x16x32_bf16 v[60:63], a[112:115], v[40:43], v[60:63]
ds_read_b128 v[32:35], v9 offset:34816
v_mfma_f32_16x16x32_bf16 v[64:67], a[116:119], v[40:43], v[64:67]
s_add_u32 m0, s46, 125056
s_waitcnt lgkmcnt(4)
v_mfma_f32_16x16x32_bf16 v[52:55], a[120:123], v[44:47], v[52:55]
ds_read_b128 v[36:39], v8 offset:36864
v_mfma_f32_16x16x32_bf16 v[56:59], a[124:127], v[44:47], v[56:59]
buffer_load_dwordx4 v6, s[8:11], s50 offen offset:1920 lds
v_mfma_f32_16x16x32_bf16 v[60:63], a[120:123], v[48:51], v[60:63]
ds_read_b128 v[40:43], v8 offset:38912
v_mfma_f32_16x16x32_bf16 v[64:67], a[124:127], v[48:51], v[64:67]
s_waitcnt lgkmcnt(4)
v_mfma_f32_16x16x32_bf16 v[52:55], a[128:131], v[20:23], v[52:55]
ds_read_b128 v[44:47], v9 offset:36864
v_mfma_f32_16x16x32_bf16 v[56:59], a[132:135], v[20:23], v[56:59]
v_mfma_f32_16x16x32_bf16 v[60:63], a[128:131], v[24:27], v[60:63]
ds_read_b128 v[48:51], v9 offset:38912
v_mfma_f32_16x16x32_bf16 v[64:67], a[132:135], v[24:27], v[64:67]
s_waitcnt lgkmcnt(4)
v_mfma_f32_16x16x32_bf16 v[52:55], a[136:139], v[28:31], v[52:55]
ds_read_b128 v[20:23], v8 offset:40960
v_mfma_f32_16x16x32_bf16 v[56:59], a[140:143], v[28:31], v[56:59]
v_mfma_f32_16x16x32_bf16 v[60:63], a[136:139], v[32:35], v[60:63]
ds_read_b128 v[24:27], v8 offset:43008
v_mfma_f32_16x16x32_bf16 v[64:67], a[140:143], v[32:35], v[64:67]
s_waitcnt lgkmcnt(4)
v_mfma_f32_16x16x32_bf16 v[52:55], a[144:147], v[36:39], v[52:55]
ds_read_b128 v[28:31], v9 offset:40960
v_mfma_f32_16x16x32_bf16 v[56:59], a[148:151], v[36:39], v[56:59]
v_mfma_f32_16x16x32_bf16 v[60:63], a[144:147], v[40:43], v[60:63]
ds_read_b128 v[32:35], v9 offset:43008
v_mfma_f32_16x16x32_bf16 v[64:67], a[148:151], v[40:43], v[64:67]
s_waitcnt lgkmcnt(4)
v_mfma_f32_16x16x32_bf16 v[52:55], a[152:155], v[44:47], v[52:55]
ds_read_b128 v[36:39], v8 offset:45056
v_mfma_f32_16x16x32_bf16 v[56:59], a[156:159], v[44:47], v[56:59]
v_mfma_f32_16x16x32_bf16 v[60:63], a[152:155], v[48:51], v[60:63]
ds_read_b128 v[40:43], v8 offset:47104
v_mfma_f32_16x16x32_bf16 v[64:67], a[156:159], v[48:51], v[64:67]
s_waitcnt lgkmcnt(4)
v_mfma_f32_16x16x32_bf16 v[52:55], a[160:163], v[20:23], v[52:55]
ds_read_b128 v[44:47], v9 offset:45056
v_mfma_f32_16x16x32_bf16 v[56:59], a[164:167], v[20:23], v[56:59]
v_mfma_f32_16x16x32_bf16 v[60:63], a[160:163], v[24:27], v[60:63]
ds_read_b128 v[48:51], v9 offset:47104
v_mfma_f32_16x16x32_bf16 v[64:67], a[164:167], v[24:27], v[64:67]
s_waitcnt lgkmcnt(4)
v_mfma_f32_16x16x32_bf16 v[52:55], a[168:171], v[28:31], v[52:55]
ds_read_b128 v[20:23], v8 offset:49152
v_mfma_f32_16x16x32_bf16 v[56:59], a[172:175], v[28:31], v[56:59]
v_mfma_f32_16x16x32_bf16 v[60:63], a[168:171], v[32:35], v[60:63]
ds_read_b128 v[24:27], v8 offset:51200
v_mfma_f32_16x16x32_bf16 v[64:67], a[172:175], v[32:35], v[64:67]
s_waitcnt lgkmcnt(4)
v_mfma_f32_16x16x32_bf16 v[52:55], a[176:179], v[36:39], v[52:55]
ds_read_b128 v[28:31], v9 offset:49152
v_mfma_f32_16x16x32_bf16 v[56:59], a[180:183], v[36:39], v[56:59]
v_mfma_f32_16x16x32_bf16 v[60:63], a[176:179], v[40:43], v[60:63]
ds_read_b128 v[32:35], v9 offset:51200
v_mfma_f32_16x16x32_bf16 v[64:67], a[180:183], v[40:43], v[64:67]
s_waitcnt lgkmcnt(4)
v_mfma_f32_16x16x32_bf16 v[52:55], a[184:187], v[44:47], v[52:55]
ds_read_b128 v[36:39], v8 offset:53248
v_mfma_f32_16x16x32_bf16 v[56:59], a[188:191], v[44:47], v[56:59]
v_mfma_f32_16x16x32_bf16 v[60:63], a[184:187], v[48:51], v[60:63]
ds_read_b128 v[40:43], v8 offset:55296
v_mfma_f32_16x16x32_bf16 v[64:67], a[188:191], v[48:51], v[64:67]
s_waitcnt lgkmcnt(4)
v_mfma_f32_16x16x32_bf16 v[52:55], a[192:195], v[20:23], v[52:55]
ds_read_b128 v[44:47], v9 offset:53248
v_mfma_f32_16x16x32_bf16 v[56:59], a[196:199], v[20:23], v[56:59]
v_mfma_f32_16x16x32_bf16 v[60:63], a[192:195], v[24:27], v[60:63]
ds_read_b128 v[48:51], v9 offset:55296
v_mfma_f32_16x16x32_bf16 v[64:67], a[196:199], v[24:27], v[64:67]
s_waitcnt lgkmcnt(4)
v_mfma_f32_16x16x32_bf16 v[52:55], a[200:203], v[28:31], v[52:55]
ds_read_b128 v[20:23], v8 offset:57344
v_mfma_f32_16x16x32_bf16 v[56:59], a[204:207], v[28:31], v[56:59]
v_mfma_f32_16x16x32_bf16 v[60:63], a[200:203], v[32:35], v[60:63]
ds_read_b128 v[24:27], v8 offset:59392
v_mfma_f32_16x16x32_bf16 v[64:67], a[204:207], v[32:35], v[64:67]
s_waitcnt lgkmcnt(4)
v_mfma_f32_16x16x32_bf16 v[52:55], a[208:211], v[36:39], v[52:55]
ds_read_b128 v[28:31], v9 offset:57344
v_mfma_f32_16x16x32_bf16 v[56:59], a[212:215], v[36:39], v[56:59]
v_mfma_f32_16x16x32_bf16 v[60:63], a[208:211], v[40:43], v[60:63]
ds_read_b128 v[32:35], v9 offset:59392
v_mfma_f32_16x16x32_bf16 v[64:67], a[212:215], v[40:43], v[64:67]
s_waitcnt lgkmcnt(4)
v_mfma_f32_16x16x32_bf16 v[52:55], a[216:219], v[44:47], v[52:55]
ds_read_b128 v[36:39], v8 offset:61440
v_mfma_f32_16x16x32_bf16 v[56:59], a[220:223], v[44:47], v[56:59]
v_mfma_f32_16x16x32_bf16 v[60:63], a[216:219], v[48:51], v[60:63]
ds_read_b128 v[40:43], v8 offset:63488
v_mfma_f32_16x16x32_bf16 v[64:67], a[220:223], v[48:51], v[64:67]
s_waitcnt lgkmcnt(4)
v_mfma_f32_16x16x32_bf16 v[52:55], a[224:227], v[20:23], v[52:55]
ds_read_b128 v[44:47], v9 offset:61440
v_mfma_f32_16x16x32_bf16 v[56:59], a[228:231], v[20:23], v[56:59]
v_mfma_f32_16x16x32_bf16 v[60:63], a[224:227], v[24:27], v[60:63]
ds_read_b128 v[48:51], v9 offset:63488
v_mfma_f32_16x16x32_bf16 v[64:67], a[228:231], v[24:27], v[64:67]
s_waitcnt lgkmcnt(5)
v_mfma_f32_16x16x32_bf16 v[52:55], a[232:235], v[28:31], v[52:55]
v_mfma_f32_16x16x32_bf16 v[56:59], a[236:239], v[28:31], v[56:59]
s_waitcnt lgkmcnt(4)
v_mfma_f32_16x16x32_bf16 v[60:63], a[232:235], v[32:35], v[60:63]
v_mfma_f32_16x16x32_bf16 v[64:67], a[236:239], v[32:35], v[64:67]
s_waitcnt lgkmcnt(3)
v_mfma_f32_16x16x32_bf16 v[52:55], a[240:243], v[36:39], v[52:55]
v_mfma_f32_16x16x32_bf16 v[56:59], a[244:247], v[36:39], v[56:59]
s_waitcnt lgkmcnt(2)
v_mfma_f32_16x16x32_bf16 v[60:63], a[240:243], v[40:43], v[60:63]
v_mfma_f32_16x16x32_bf16 v[64:67], a[244:247], v[40:43], v[64:67]
s_waitcnt lgkmcnt(1)
v_mfma_f32_16x16x32_bf16 v[68:71], a[248:251], v[44:47], v[52:55]
v_mfma_f32_16x16x32_bf16 v[72:75], a[252:255], v[44:47], v[56:59]
s_waitcnt lgkmcnt(0)
v_mfma_f32_16x16x32_bf16 v[76:79], a[248:251], v[48:51], v[60:63]
v_mfma_f32_16x16x32_bf16 v[80:83], a[252:255], v[48:51], v[64:67]
s_waitcnt vmcnt(0)
mega_kernel_q_loop:
s_barrier
s_cmp_gt_i32 s55, s42
s_cbranch_scc1 mega_kernel_q_kv1k
mega_kernel_q_kv1w:
v_mov_b32 v2, 0
s_mov_b64 exec, 0xff
buffer_atomic_add v2, v99, s[84:87], 0 offen sc0 sc1
s_mov_b64 exec, -1
s_waitcnt vmcnt(0)
v_min_i32_dpp v2, v2, v2 quad_perm:[1,0,3,2] row_mask:0xf bank_mask:0xf
s_nop 1
v_min_i32_dpp v2, v2, v2 quad_perm:[2,3,0,1] row_mask:0xf bank_mask:0xf
s_nop 1
v_min_i32_dpp v2, v2, v2 row_half_mirror row_mask:0xf bank_mask:0xf
s_nop 0
v_readfirstlane_b32 s55, v2
s_cmp_gt_i32 s55, s42
s_cbranch_scc1 mega_kernel_q_kv1k
s_sleep 4
s_branch mega_kernel_q_kv1w
mega_kernel_q_kv1k:
s_cmp_ge_u32 s42, 61
s_cbranch_scc0 mega_kernel_q_nl1
s_add_u32 s51, s47, s42
s_bfe_u32 s57, s51, 0x40002
s_lshl_b32 s57, s57, 14
s_and_b32 s66, s51, 3
s_lshl_b32 s66, s66, 11
s_add_u32 s66, s66, s57
s_add_u32 s66, s66, s58
s_add_u32 s67, s66, 33554432
s_bfe_u32 s57, s51, 0x30003
s_lshl_b32 s57, s57, 14
s_and_b32 s68, s51, 7
s_lshl_b32 s68, s68, 10
s_add_u32 s68, s68, s57
s_add_u32 s68, s68, s59
s_add_u32 s50, s42, 4
s_min_u32 s50, s50, 63
s_lshl_b32 s50, s50, 16
s_cmp_gt_i32 s56, s42
s_cselect_b32 s30, 1, 0
s_add_u32 m0, s60, 0
s_nop 0
buffer_load_dwordx4 v5, s[84:87], s66 offen offset:0 sc1 lds
s_add_u32 m0, s60, 0
s_nop 0
buffer_load_dwordx4 v5, s[84:87], s66 offen offset:1024 sc1 lds
s_add_u32 m0, s60, 8192
s_nop 0
buffer_load_dwordx4 v5, s[84:87], s67 offen offset:0 sc1 lds
s_add_u32 m0, s60, 8192
s_nop 0
buffer_load_dwordx4 v5, s[84:87], s67 offen offset:1024 sc1 lds
s_cmp_eq_u32 s30, 1
s_cbranch_scc0 mega_kernel_q_kx1
s_mov_b32 m0, s61
s_nop 0
buffer_load_dwordx4 v5, s[84:87], s68 offen sc1 lds
mega_kernel_q_kx1:
v_mov_b64 v[84:85], v[220:221]
v_mov_b64 v[86:87], v[222:223]
v_mov_b64 v[88:89], v[224:225]
v_mov_b64 v[90:91], v[226:227]
v_mov_b64 v[220:221], v[228:229]
v_mov_b64 v[222:223], v[230:231]
v_mov_b64 v[224:225], v[232:233]
v_mov_b64 v[226:227], v[234:235]
v_cvt_pk_bf16_f32 v228, v68, v69
v_cvt_pk_bf16_f32 v229, v70, v71
v_cvt_pk_bf16_f32 v230, v72, v73
v_cvt_pk_bf16_f32 v231, v74, v75
v_cvt_pk_bf16_f32 v232, v76, v77
v_cvt_pk_bf16_f32 v233, v78, v79
v_cvt_pk_bf16_f32 v234, v80, v81
v_cvt_pk_bf16_f32 v235, v82, v83
ds_write_b128 v101, v[84:87]
ds_write_b128 v101, v[88:91] offset:1024
s_waitcnt vmcnt(4)
v_mov_b32 v17, s42
s_mov_b64 exec, 1
buffer_store_dword v17, v16, s[84:87], s49 offen sc1
s_mov_b64 exec, -1
s_branch mega_kernel_q_jl1
mega_kernel_q_nl1:
ds_read_b128 v[20:23], v10 offset:0
ds_read_b128 v[24:27], v10 offset:2048
ds_read_b128 v[28:31], v11 offset:0
ds_read_b128 v[32:35], v11 offset:2048
ds_read_b128 v[36:39], v10 offset:4096
ds_read_b128 v[40:43], v10 offset:6144
s_add_u32 s51, s47, s42
s_bfe_u32 s57, s51, 0x40002
s_lshl_b32 s57, s57, 14
s_and_b32 s66, s51, 3
s_lshl_b32 s66, s66, 11
s_add_u32 s66, s66, s57
s_add_u32 s66, s66, s58
s_add_u32 s67, s66, 33554432
s_bfe_u32 s57, s51, 0x30003
s_lshl_b32 s57, s57, 14
s_and_b32 s68, s51, 7
s_lshl_b32 s68, s68, 10
s_add_u32 s68, s68, s57
s_add_u32 s68, s68, s59
s_add_u32 s50, s42, 4
s_min_u32 s50, s50, 63
s_lshl_b32 s50, s50, 16
s_cmp_gt_i32 s56, s42
s_cselect_b32 s30, 1, 0
s_add_u32 m0, s60, 0
s_waitcnt lgkmcnt(4)
v_mfma_f32_16x16x32_bf16 v[52:55], a[0:3], v[20:23], 0
ds_read_b128 v[44:47], v11 offset:4096
v_mfma_f32_16x16x32_bf16 v[56:59], a[4:7], v[20:23], 0
buffer_load_dwordx4 v5, s[84:87], s66 offen offset:0 sc1 lds
v_mfma_f32_16x16x32_bf16 v[60:63], a[0:3], v[24:27], 0
ds_read_b128 v[48:51], v11 offset:6144
v_mfma_f32_16x16x32_bf16 v[64:67], a[4:7], v[24:27], 0
s_add_u32 m0, s60, 0
s_waitcnt lgkmcnt(4)
v_mfma_f32_16x16x32_bf16 v[52:55], a[8:11], v[28:31], v[52:55]
ds_read_b128 v[20:23], v10 offset:8192
v_mfma_f32_16x16x32_bf16 v[56:59], a[12:15], v[28:31], v[56:59]
buffer_load_dwordx4 v5, s[84:87], s66 offen offset:1024 sc1 lds
v_mfma_f32_16x16x32_bf16 v[60:63], a[8:11], v[32:35], v[60:63]
ds_read_b128 v[24:27], v10 offset:10240
v_mfma_f32_16x16x32_bf16 v[64:67], a[12:15], v[32:35], v[64:67]
s_add_u32 m0, s60, 8192
s_waitcnt lgkmcnt(4)
v_mfma_f32_16x16x32_bf16 v[52:55], a[16:19], v[36:39], v[52:55]
ds_read_b128 v[28:31], v11 offset:8192
v_mfma_f32_16x16x32_bf16 v[56:59], a[20:23], v[36:39], v[56:59]
buffer_load_dwordx4 v5, s[84:87], s67 offen offset:0 sc1 lds
v_mfma_f32_16x16x32_bf16 v[60:63], a[16:19], v[40:43], v[60:63]
ds_read_b128 v[32:35], v11 offset:10240
v_mfma_f32_16x16x32_bf16 v[64:67], a[20:23], v[40:43], v[64:67]
s_add_u32 m0, s60, 8192
s_waitcnt lgkmcnt(4)
v_mfma_f32_16x16x32_bf16 v[52:55], a[24:27], v[44:47], v[52:55]
ds_read_b128 v[36:39], v10 offset:12288
v_mfma_f32_16x16x32_bf16 v[56:59], a[28:31], v[44:47], v[56:59]
buffer_load_dwordx4 v5, s[84:87], s67 offen offset:1024 sc1 lds
v_mfma_f32_16x16x32_bf16 v[60:63], a[24:27], v[48:51], v[60:63]
ds_read_b128 v[40:43], v10 offset:14336
v_mfma_f32_16x16x32_bf16 v[64:67], a[28:31], v[48:51], v[64:67]
s_waitcnt lgkmcnt(4)
v_mfma_f32_16x16x32_bf16 v[52:55], a[32:35], v[20:23], v[52:55]
ds_read_b128 v[44:47], v11 offset:12288
v_mfma_f32_16x16x32_bf16 v[56:59], a[36:39], v[20:23], v[56:59]
s_cmp_eq_u32 s30, 1
s_cbranch_scc0 mega_kernel_q_ke1
s_mov_b32 m0, s61
s_nop 0
buffer_load_dwordx4 v5, s[84:87], s68 offen sc1 lds
mega_kernel_q_ke1:
v_mfma_f32_16x16x32_bf16 v[60:63], a[32:35], v[24:27], v[60:63]
ds_read_b128 v[48:51], v11 offset:14336
v_mfma_f32_16x16x32_bf16 v[64:67], a[36:39], v[24:27], v[64:67]
s_add_u32 m0, s46, 0
s_waitcnt lgkmcnt(4)
v_mfma_f32_16x16x32_bf16 v[52:55], a[40:43], v[28:31], v[52:55]
ds_read_b128 v[20:23], v10 offset:16384
v_mfma_f32_16x16x32_bf16 v[56:59], a[44:47], v[28:31], v[56:59]
buffer_load_dwordx4 v6, s[8:11], s50 offen offset:0 lds
v_mfma_f32_16x16x32_bf16 v[60:63], a[40:43], v[32:35], v[60:63]
ds_read_b128 v[24:27], v10 offset:18432
v_mfma_f32_16x16x32_bf16 v[64:67], a[44:47], v[32:35], v[64:67]
s_add_u32 m0, s46, 3968
s_waitcnt lgkmcnt(4)
v_mfma_f32_16x16x32_bf16 v[52:55], a[48:51], v[36:39], v[52:55]
ds_read_b128 v[28:31], v11 offset:16384
v_mfma_f32_16x16x32_bf16 v[56:59], a[52:55], v[36:39], v[56:59]
buffer_load_dwordx4 v6, s[8:11], s50 offen offset:128 lds
v_mfma_f32_16x16x32_bf16 v[60:63], a[48:51], v[40:43], v[60:63]
ds_read_b128 v[32:35], v11 offset:18432
v_mfma_f32_16x16x32_bf16 v[64:67], a[52:55], v[40:43], v[64:67]
s_add_u32 m0, s46, 7936
s_waitcnt lgkmcnt(4)
v_mfma_f32_16x16x32_bf16 v[52:55], a[56:59], v[44:47], v[52:55]
ds_read_b128 v[36:39], v10 offset:20480
v_mfma_f32_16x16x32_bf16 v[56:59], a[60:63], v[44:47], v[56:59]
buffer_load_dwordx4 v6, s[8:11], s50 offen offset:256 lds
v_mfma_f32_16x16x32_bf16 v[60:63], a[56:59], v[48:51], v[60:63]
ds_read_b128 v[40:43], v10 offset:22528
v_mfma_f32_16x16x32_bf16 v[64:67], a[60:63], v[48:51], v[64:67]
s_add_u32 m0, s46, 11904
s_waitcnt lgkmcnt(4)
v_mfma_f32_16x16x32_bf16 v[52:55], a[64:67], v[20:23], v[52:55]
ds_read_b128 v[44:47], v11 offset:20480
v_mfma_f32_16x16x32_bf16 v[56:59], a[68:71], v[20:23], v[56:59]
buffer_load_dwordx4 v6, s[8:11], s50 offen offset:384 lds
v_mfma_f32_16x16x32_bf16 v[60:63], a[64:67], v[24:27], v[60:63]
ds_read_b128 v[48:51], v11 offset:22528
v_mfma_f32_16x16x32_bf16 v[64:67], a[68:71], v[24:27], v[64:67]
s_add_u32 m0, s46, 15872
s_waitcnt lgkmcnt(4)
v_mfma_f32_16x16x32_bf16 v[52:55], a[72:75], v[28:31], v[52:55]
ds_read_b128 v[20:23], v10 offset:24576
v_mfma_f32_16x16x32_bf16 v[56:59], a[76:79], v[28:31], v[56:59]
buffer_load_dwordx4 v6, s[8:11], s50 offen offset:512 lds
v_mfma_f32_16x16x32_bf16 v[60:63], a[72:75], v[32:35], v[60:63]
ds_read_b128 v[24:27], v10 offset:26624
v_mfma_f32_16x16x32_bf16 v[64:67], a[76:79], v[32:35], v[64:67]
s_add_u32 m0, s46, 19840
s_waitcnt lgkmcnt(4)
v_mfma_f32_16x16x32_bf16 v[52:55], a[80:83], v[36:39], v[52:55]
ds_read_b128 v[28:31], v11 offset:24576
v_mfma_f32_16x16x32_bf16 v[56:59], a[84:87], v[36:39], v[56:59]
buffer_load_dwordx4 v6, s[8:11], s50 offen offset:640 lds
v_mfma_f32_16x16x32_bf16 v[60:63], a[80:83], v[40:43], v[60:63]
ds_read_b128 v[32:35], v11 offset:26624
v_mfma_f32_16x16x32_bf16 v[64:67], a[84:87], v[40:43], v[64:67]
s_add_u32 m0, s46, 23808
s_waitcnt lgkmcnt(4)
v_mfma_f32_16x16x32_bf16 v[52:55], a[88:91], v[44:47], v[52:55]
ds_read_b128 v[36:39], v10 offset:28672
v_mfma_f32_16x16x32_bf16 v[56:59], a[92:95], v[44:47], v[56:59]
buffer_load_dwordx4 v6, s[8:11], s50 offen offset:768 lds
v_mfma_f32_16x16x32_bf16 v[60:63], a[88:91], v[48:51], v[60:63]
ds_read_b128 v[40:43], v10 offset:30720
v_mfma_f32_16x16x32_bf16 v[64:67], a[92:95], v[48:51], v[64:67]
s_add_u32 m0, s46, 27776
s_waitcnt lgkmcnt(4)
v_mfma_f32_16x16x32_bf16 v[52:55], a[96:99], v[20:23], v[52:55]
ds_read_b128 v[44:47], v11 offset:28672
v_mfma_f32_16x16x32_bf16 v[56:59], a[100:103], v[20:23], v[56:59]
buffer_load_dwordx4 v6, s[8:11], s50 offen offset:896 lds
v_mfma_f32_16x16x32_bf16 v[60:63], a[96:99], v[24:27], v[60:63]
ds_read_b128 v[48:51], v11 offset:30720
v_mfma_f32_16x16x32_bf16 v[64:67], a[100:103], v[24:27], v[64:67]
s_add_u32 m0, s46, 31744
s_waitcnt lgkmcnt(4)
v_mfma_f32_16x16x32_bf16 v[52:55], a[104:107], v[28:31], v[52:55]
ds_read_b128 v[20:23], v10 offset:32768
v_mfma_f32_16x16x32_bf16 v[56:59], a[108:111], v[28:31], v[56:59]
buffer_load_dwordx4 v6, s[8:11], s50 offen offset:1024 lds
v_mfma_f32_16x16x32_bf16 v[60:63], a[104:107], v[32:35], v[60:63]
ds_read_b128 v[24:27], v10 offset:34816
v_mfma_f32_16x16x32_bf16 v[64:67], a[108:111], v[32:35], v[64:67]
s_waitcnt vmcnt(13)
v_mov_b32 v17, s42
s_mov_b64 exec, 1
buffer_store_dword v17, v16, s[84:87], s49 offen sc1
s_mov_b64 exec, -1
s_add_u32 m0, s46, 35712
s_waitcnt lgkmcnt(4)
v_mfma_f32_16x16x32_bf16 v[52:55], a[112:115], v[36:39], v[52:55]
ds_read_b128 v[28:31], v11 offset:32768
v_mfma_f32_16x16x32_bf16 v[56:59], a[116:119], v[36:39], v[56:59]
buffer_load_dwordx4 v6, s[8:11], s50 offen offset:1152 lds
v_mfma_f32_16x16x32_bf16 v[60:63], a[112:115], v[40:43], v[60:63]
ds_read_b128 v[32:35], v11 offset:34816
v_mfma_f32_16x16x32_bf16 v[64:67], a[116:119], v[40:43], v[64:67]
v_mov_b32 v100, 0
s_mov_b64 exec, 1
buffer_atomic_add v100, v16, s[84:87], s62 offen sc0 sc1
s_mov_b64 exec, -1
s_add_u32 m0, s46, 39680
s_waitcnt lgkmcnt(4)
v_mfma_f32_16x16x32_bf16 v[52:55], a[120:123], v[44:47], v[52:55]
ds_read_b128 v[36:39], v10 offset:36864
v_mfma_f32_16x16x32_bf16 v[56:59], a[124:127], v[44:47], v[56:59]
buffer_load_dwordx4 v6, s[8:11], s50 offen offset:1280 lds
v_mfma_f32_16x16x32_bf16 v[60:63], a[120:123], v[48:51], v[60:63]
ds_read_b128 v[40:43], v10 offset:38912
v_mfma_f32_16x16x32_bf16 v[64:67], a[124:127], v[48:51], v[64:67]
s_add_u32 m0, s46, 43648
s_waitcnt lgkmcnt(4)
v_mfma_f32_16x16x32_bf16 v[52:55], a[128:131], v[20:23], v[52:55]
ds_read_b128 v[44:47], v11 offset:36864
v_mfma_f32_16x16x32_bf16 v[56:59], a[132:135], v[20:23], v[56:59]
buffer_load_dwordx4 v6, s[8:11], s50 offen offset:1408 lds
v_mfma_f32_16x16x32_bf16 v[60:63], a[128:131], v[24:27], v[60:63]
ds_read_b128 v[48:51], v11 offset:38912
v_mfma_f32_16x16x32_bf16 v[64:67], a[132:135], v[24:27], v[64:67]
s_add_u32 m0, s46, 47616
s_waitcnt lgkmcnt(4)
v_mfma_f32_16x16x32_bf16 v[52:55], a[136:139], v[28:31], v[52:55]
ds_read_b128 v[20:23], v10 offset:40960
v_mfma_f32_16x16x32_bf16 v[56:59], a[140:143], v[28:31], v[56:59]
buffer_load_dwordx4 v6, s[8:11], s50 offen offset:1536 lds
v_mfma_f32_16x16x32_bf16 v[60:63], a[136:139], v[32:35], v[60:63]
ds_read_b128 v[24:27], v10 offset:43008
v_mfma_f32_16x16x32_bf16 v[64:67], a[140:143], v[32:35], v[64:67]
s_add_u32 m0, s46, 51584
s_waitcnt lgkmcnt(4)
v_mfma_f32_16x16x32_bf16 v[52:55], a[144:147], v[36:39], v[52:55]
ds_read_b128 v[28:31], v11 offset:40960
v_mfma_f32_16x16x32_bf16 v[56:59], a[148:151], v[36:39], v[56:59]
buffer_load_dwordx4 v6, s[8:11], s50 offen offset:1664 lds
v_mfma_f32_16x16x32_bf16 v[60:63], a[144:147], v[40:43], v[60:63]
ds_read_b128 v[32:35], v11 offset:43008
v_mfma_f32_16x16x32_bf16 v[64:67], a[148:151], v[40:43], v[64:67]
s_add_u32 m0, s46, 55552
s_waitcnt lgkmcnt(4)
v_mfma_f32_16x16x32_bf16 v[52:55], a[152:155], v[44:47], v[52:55]
ds_read_b128 v[36:39], v10 offset:45056
v_mfma_f32_16x16x32_bf16 v[56:59], a[156:159], v[44:47], v[56:59]
buffer_load_dwordx4 v6, s[8:11], s50 offen offset:1792 lds
v_mfma_f32_16x16x32_bf16 v[60:63], a[152:155], v[48:51], v[60:63]
ds_read_b128 v[40:43], v10 offset:47104
v_mfma_f32_16x16x32_bf16 v[64:67], a[156:159], v[48:51], v[64:67]
s_add_u32 m0, s46, 59520
s_waitcnt lgkmcnt(4)
v_mfma_f32_16x16x32_bf16 v[52:55], a[160:163], v[20:23], v[52:55]
ds_read_b128 v[44:47], v11 offset:45056
v_mfma_f32_16x16x32_bf16 v[56:59], a[164:167], v[20:23], v[56:59]
buffer_load_dwordx4 v6, s[8:11], s50 offen offset:1920 lds
v_mfma_f32_16x16x32_bf16 v[60:63], a[160:163], v[24:27], v[60:63]
ds_read_b128 v[48:51], v11 offset:47104
v_mfma_f32_16x16x32_bf16 v[64:67], a[164:167], v[24:27], v[64:67]
s_waitcnt lgkmcnt(4)
v_mfma_f32_16x16x32_bf16 v[52:55], a[168:171], v[28:31], v[52:55]
ds_read_b128 v[20:23], v10 offset:49152
v_mfma_f32_16x16x32_bf16 v[56:59], a[172:175], v[28:31], v[56:59]
v_mov_b64 v[84:85], v[220:221]
v_mov_b64 v[86:87], v[222:223]
v_mfma_f32_16x16x32_bf16 v[60:63], a[168:171], v[32:35], v[60:63]
ds_read_b128 v[24:27], v10 offset:51200
v_mfma_f32_16x16x32_bf16 v[64:67], a[172:175], v[32:35], v[64:67]
v_mov_b64 v[88:89], v[224:225]
v_mov_b64 v[90:91], v[226:227]
s_waitcnt lgkmcnt(4)
v_mfma_f32_16x16x32_bf16 v[52:55], a[176:179], v[36:39], v[52:55]
ds_read_b128 v[28:31], v11 offset:49152
v_mfma_f32_16x16x32_bf16 v[56:59], a[180:183], v[36:39], v[56:59]
v_mov_b64 v[220:221], v[228:229]
v_mov_b64 v[222:223], v[230:231]
v_mfma_f32_16x16x32_bf16 v[60:63], a[176:179], v[40:43], v[60:63]
ds_read_b128 v[32:35], v11 offset:51200
v_mfma_f32_16x16x32_bf16 v[64:67], a[180:183], v[40:43], v[64:67]
v_mov_b64 v[224:225], v[232:233]
v_mov_b64 v[226:227], v[234:235]
s_waitcnt lgkmcnt(4)
v_mfma_f32_16x16x32_bf16 v[52:55], a[184:187], v[44:47], v[52:55]
ds_read_b128 v[36:39], v10 offset:53248
v_mfma_f32_16x16x32_bf16 v[56:59], a[188:191], v[44:47], v[56:59]
v_cvt_pk_bf16_f32 v228, v68, v69
v_cvt_pk_bf16_f32 v229, v70, v71
v_mfma_f32_16x16x32_bf16 v[60:63], a[184:187], v[48:51], v[60:63]
ds_read_b128 v[40:43], v10 offset:55296
v_mfma_f32_16x16x32_bf16 v[64:67], a[188:191], v[48:51], v[64:67]
v_cvt_pk_bf16_f32 v230, v72, v73
v_cvt_pk_bf16_f32 v231, v74, v75
s_waitcnt lgkmcnt(4)
v_mfma_f32_16x16x32_bf16 v[52:55], a[192:195], v[20:23], v[52:55]
ds_read_b128 v[44:47], v11 offset:53248
v_mfma_f32_16x16x32_bf16 v[56:59], a[196:199], v[20:23], v[56:59]
v_cvt_pk_bf16_f32 v232, v76, v77
v_cvt_pk_bf16_f32 v233, v78, v79
v_mfma_f32_16x16x32_bf16 v[60:63], a[192:195], v[24:27], v[60:63]
ds_read_b128 v[48:51], v11 offset:55296
v_mfma_f32_16x16x32_bf16 v[64:67], a[196:199], v[24:27], v[64:67]
v_cvt_pk_bf16_f32 v234, v80, v81
v_cvt_pk_bf16_f32 v235, v82, v83
s_waitcnt lgkmcnt(4)
v_mfma_f32_16x16x32_bf16 v[52:55], a[200:203], v[28:31], v[52:55]
ds_read_b128 v[20:23], v10 offset:57344
v_mfma_f32_16x16x32_bf16 v[56:59], a[204:207], v[28:31], v[56:59]
v_mfma_f32_16x16x32_bf16 v[60:63], a[200:203], v[32:35], v[60:63]
ds_read_b128 v[24:27], v10 offset:59392
v_mfma_f32_16x16x32_bf16 v[64:67], a[204:207], v[32:35], v[64:67]
s_waitcnt lgkmcnt(4)
v_mfma_f32_16x16x32_bf16 v[52:55], a[208:211], v[36:39], v[52:55]
ds_read_b128 v[28:31], v11 offset:57344
v_mfma_f32_16x16x32_bf16 v[56:59], a[212:215], v[36:39], v[56:59]
v_mfma_f32_16x16x32_bf16 v[60:63], a[208:211], v[40:43], v[60:63]
ds_read_b128 v[32:35], v11 offset:59392
v_mfma_f32_16x16x32_bf16 v[64:67], a[212:215], v[40:43], v[64:67]
s_waitcnt lgkmcnt(4)
v_mfma_f32_16x16x32_bf16 v[52:55], a[216:219], v[44:47], v[52:55]
ds_read_b128 v[36:39], v10 offset:61440
v_mfma_f32_16x16x32_bf16 v[56:59], a[220:223], v[44:47], v[56:59]
s_waitcnt vmcnt(6)
v_readfirstlane_b32 s56, v100
s_cmp_eq_u32 s30, 1
s_cbranch_scc1 mega_kernel_q_kf1
s_cmp_gt_i32 s56, s42
s_cbranch_scc0 mega_kernel_q_kf1
s_mov_b32 s30, 1
s_mov_b32 m0, s61
s_nop 0
buffer_load_dwordx4 v5, s[84:87], s68 offen sc1 lds
mega_kernel_q_kf1:
v_mfma_f32_16x16x32_bf16 v[60:63], a[216:219], v[48:51], v[60:63]
ds_read_b128 v[40:43], v10 offset:63488
v_mfma_f32_16x16x32_bf16 v[64:67], a[220:223], v[48:51], v[64:67]
s_waitcnt lgkmcnt(4)
v_mfma_f32_16x16x32_bf16 v[52:55], a[224:227], v[20:23], v[52:55]
ds_read_b128 v[44:47], v11 offset:61440
v_mfma_f32_16x16x32_bf16 v[56:59], a[228:231], v[20:23], v[56:59]
v_mfma_f32_16x16x32_bf16 v[60:63], a[224:227], v[24:27], v[60:63]
ds_read_b128 v[48:51], v11 offset:63488
v_mfma_f32_16x16x32_bf16 v[64:67], a[228:231], v[24:27], v[64:67]
s_waitcnt lgkmcnt(5)
v_mfma_f32_16x16x32_bf16 v[52:55], a[232:235], v[28:31], v[52:55]
v_mfma_f32_16x16x32_bf16 v[56:59], a[236:239], v[28:31], v[56:59]
s_waitcnt lgkmcnt(4)
v_mfma_f32_16x16x32_bf16 v[60:63], a[232:235], v[32:35], v[60:63]
v_mfma_f32_16x16x32_bf16 v[64:67], a[236:239], v[32:35], v[64:67]
s_waitcnt lgkmcnt(3)
v_mfma_f32_16x16x32_bf16 v[52:55], a[240:243], v[36:39], v[52:55]
v_mfma_f32_16x16x32_bf16 v[56:59], a[244:247], v[36:39], v[56:59]
s_waitcnt lgkmcnt(2)
v_mfma_f32_16x16x32_bf16 v[60:63], a[240:243], v[40:43], v[60:63]
v_mfma_f32_16x16x32_bf16 v[64:67], a[244:247], v[40:43], v[64:67]
ds_write_b128 v101, v[84:87]
ds_write_b128 v101, v[88:91] offset:1024
s_waitcnt lgkmcnt(1)
v_mfma_f32_16x16x32_bf16 v[68:71], a[248:251], v[44:47], v[52:55]
v_mfma_f32_16x16x32_bf16 v[72:75], a[252:255], v[44:47], v[56:59]
s_waitcnt lgkmcnt(0)
v_mfma_f32_16x16x32_bf16 v[76:79], a[248:251], v[48:51], v[60:63]
v_mfma_f32_16x16x32_bf16 v[80:83], a[252:255], v[48:51], v[64:67]
mega_kernel_q_jl1:
s_cmp_eq_u32 s30, 1
s_cbranch_scc1 mega_kernel_q_kl1
mega_kernel_q_kw1:
v_mov_b32 v100, 0
s_mov_b64 exec, 1
buffer_atomic_add v100, v16, s[84:87], s62 offen sc0 sc1
s_mov_b64 exec, -1
s_waitcnt vmcnt(0)
v_readfirstlane_b32 s56, v100
s_cmp_gt_i32 s56, s42
s_cbranch_scc1 mega_kernel_q_kv1
s_cmp_eq_u32 s42, 63
s_cbranch_scc1 mega_kernel_q_kw1
s_branch mega_kernel_q_kw1
mega_kernel_q_kv1:
s_mov_b32 m0, s61
s_nop 0
buffer_load_dwordx4 v5, s[84:87], s68 offen sc1 lds
mega_kernel_q_kl1:
s_waitcnt lgkmcnt(0) vmcnt(0)
s_barrier
ds_read_b128 v[184:187], v102 offset:0
ds_read_b128 v[112:115], v103 offset:0
ds_read_b128 v[128:131], v103 offset:1024
ds_read_b128 v[188:191], v102 offset:2048
ds_read_b128 v[116:119], v103 offset:2048
ds_read_b128 v[132:135], v103 offset:3072
ds_read_b128 v[192:195], v102 offset:4096
ds_read_b128 v[120:123], v103 offset:4096
ds_read_b128 v[136:139], v103 offset:5120
ds_read_b128 v[196:199], v102 offset:6144
ds_read_b128 v[124:127], v103 offset:6144
ds_read_b128 v[140:143], v103 offset:7168
s_waitcnt lgkmcnt(9)
v_mfma_f32_16x16x32_bf16 v[200:203], v[112:115], v[184:187], 0
v_mfma_f32_16x16x32_bf16 v[204:207], v[128:131], v[184:187], 0
ds_read_b128 v[160:163], v94 offset:0
s_waitcnt lgkmcnt(7)
v_mfma_f32_16x16x32_bf16 v[200:203], v[116:119], v[188:191], v[200:203]
v_mfma_f32_16x16x32_bf16 v[204:207], v[132:135], v[188:191], v[204:207]
ds_read_b128 v[164:167], v94 offset:1024
s_waitcnt lgkmcnt(5)
v_mfma_f32_16x16x32_bf16 v[200:203], v[120:123], v[192:195], v[200:203]
v_mfma_f32_16x16x32_bf16 v[204:207], v[136:139], v[192:195], v[204:207]
ds_read_b128 v[168:171], v94 offset:2048
s_waitcnt lgkmcnt(3)
v_mfma_f32_16x16x32_bf16 v[200:203], v[124:127], v[196:199], v[200:203]
v_mfma_f32_16x16x32_bf16 v[204:207], v[140:143], v[196:199], v[204:207]
ds_read_b128 v[172:175], v94 offset:3072
s_waitcnt lgkmcnt(3)
v_mfma_f32_16x16x32_bf16 v[208:211], v[160:163], v[184:187], 0
ds_read_b128 v[144:147], v240 offset:0
ds_read_b64 v[176:177], v95 offset:0
s_waitcnt lgkmcnt(4)
v_mfma_f32_16x16x32_bf16 v[208:211], v[164:167], v[188:191], v[208:211]
ds_read_b128 v[148:151], v240 offset:1024
ds_read_b64 v[178:179], v95 offset:256
s_waitcnt lgkmcnt(5)
v_mfma_f32_16x16x32_bf16 v[208:211], v[168:171], v[192:195], v[208:211]
ds_read_b128 v[152:155], v240 offset:2048
ds_read_b64 v[180:181], v95 offset:1024
s_waitcnt lgkmcnt(6)
v_mfma_f32_16x16x32_bf16 v[208:211], v[172:175], v[196:199], v[208:211]
ds_read_b128 v[156:159], v240 offset:3072
ds_read_b64 v[182:183], v95 offset:1280
mega_kernel_q_sm1:
v_pk_mul_f32 v[200:201], v[200:201], s[54:55] op_sel_hi:[1,0]
v_pk_mul_f32 v[202:203], v[202:203], s[54:55] op_sel_hi:[1,0]
v_pk_mul_f32 v[204:205], v[204:205], s[54:55] op_sel_hi:[1,0]
v_pk_mul_f32 v[206:207], v[206:207], s[54:55] op_sel_hi:[1,0]
v_cndmask_b32 v200, v200, v241, s[12:13]
v_cndmask_b32 v201, v201, v241, s[14:15]
v_cndmask_b32 v202, v202, v241, s[16:17]
v_cndmask_b32 v203, v203, v241, s[18:19]
v_cndmask_b32 v204, v204, v241, s[20:21]
v_cndmask_b32 v205, v205, v241, s[22:23]
v_cndmask_b32 v206, v206, v241, s[24:25]
v_cndmask_b32 v207, v207, v241, s[26:27]
v_pk_mul_f32 v[208:209], v[208:209], s[54:55] op_sel_hi:[1,0]
v_pk_mul_f32 v[210:211], v[210:211], s[54:55] op_sel_hi:[1,0]
v_cndmask_b32 v208, v208, v97, s[28:29]
v_cndmask_b32 v209, v209, v97, s[28:29]
v_cndmask_b32 v210, v210, v97, s[28:29]
v_cndmask_b32 v211, v211, v97, s[28:29]
v_max3_f32 v236, v200, v201, v202
v_max3_f32 v236, v236, v203, v204
v_max3_f32 v236, v236, v205, v206
v_max3_f32 v236, v236, v207, v208
v_max3_f32 v236, v236, v209, v210
v_max_f32 v237, v236, v211
v_max_f32 v236, v236, v211
s_nop 1
v_permlane16_swap_b32 v236, v237
s_nop 0
v_max_f32 v238, v236, v237
v_max_f32 v239, v236, v237
s_nop 1
v_permlane32_swap_b32 v238, v239
s_nop 0
v_max_f32 v236, v238, v239
v_pk_add_f32 v[200:201], v[200:201], v[236:237] op_sel_hi:[1,0] neg_lo:[0,1] neg_hi:[0,1]
v_pk_add_f32 v[202:203], v[202:203], v[236:237] op_sel_hi:[1,0] neg_lo:[0,1] neg_hi:[0,1]
v_pk_add_f32 v[204:205], v[204:205], v[236:237] op_sel_hi:[1,0] neg_lo:[0,1] neg_hi:[0,1]
v_pk_add_f32 v[206:207], v[206:207], v[236:237] op_sel_hi:[1,0] neg_lo:[0,1] neg_hi:[0,1]
v_pk_add_f32 v[208:209], v[208:209], v[236:237] op_sel_hi:[1,0] neg_lo:[0,1] neg_hi:[0,1]
v_pk_add_f32 v[210:211], v[210:211], v[236:237] op_sel_hi:[1,0] neg_lo:[0,1] neg_hi:[0,1]
v_exp_f32 v200, v200
v_exp_f32 v201, v201
v_exp_f32 v202, v202
v_exp_f32 v203, v203
v_exp_f32 v204, v204
v_exp_f32 v205, v205
v_exp_f32 v206, v206
v_exp_f32 v207, v207
v_exp_f32 v208, v208
v_exp_f32 v209, v209
v_exp_f32 v210, v210
v_exp_f32 v211, v211
s_nop 0
v_cvt_pk_bf16_f32 v212, v200, v201
v_cvt_pk_bf16_f32 v213, v202, v203
v_cvt_pk_bf16_f32 v214, v204, v205
v_cvt_pk_bf16_f32 v215, v206, v207
v_cvt_pk_bf16_f32 v216, v208, v209
v_cvt_pk_bf16_f32 v217, v210, v211
s_waitcnt lgkmcnt(0)
s_nop 0
v_mfma_f32_16x16x32_bf16 v[108:111], v[104:107], v[212:215], 0
v_mfma_f32_16x16x32_bf16 v[112:115], v[144:147], v[212:215], 0
v_mfma_f32_16x16x32_bf16 v[116:119], v[148:151], v[212:215], 0
v_mfma_f32_16x16x32_bf16 v[120:123], v[152:155], v[212:215], 0
v_mfma_f32_16x16x32_bf16 v[124:127], v[156:159], v[212:215], 0
v_mfma_f32_16x16x16_bf16 v[108:111], v[104:105], v[216:217], v[108:111]
v_mfma_f32_16x16x16_bf16 v[112:115], v[176:177], v[216:217], v[112:115]
v_mfma_f32_16x16x16_bf16 v[116:119], v[178:179], v[216:217], v[116:119]
v_mfma_f32_16x16x16_bf16 v[120:123], v[180:181], v[216:217], v[120:123]
v_mfma_f32_16x16x16_bf16 v[124:127], v[182:183], v[216:217], v[124:127]
s_lshr_b32 s63, s42, 2
s_xnor_b32 s63, s63, s98
s_and_b32 s63, s63, 1
s_lshl_b32 s63, s63, 13
s_lshl_b32 s51, s42, 19
s_add_u32 s51, s51, s63
s_nop 2
v_rcp_f32 v238, v108
v_rcp_f32 v239, v109
s_nop 1
v_pk_mul_f32 v[112:113], v[112:113], v[238:239]
v_pk_mul_f32 v[114:115], v[114:115], v[238:239]
v_pk_mul_f32 v[116:117], v[116:117], v[238:239]
v_pk_mul_f32 v[118:119], v[118:119], v[238:239]
v_pk_mul_f32 v[120:121], v[120:121], v[238:239]
v_pk_mul_f32 v[122:123], v[122:123], v[238:239]
v_pk_mul_f32 v[124:125], v[124:125], v[238:239]
v_pk_mul_f32 v[126:127], v[126:127], v[238:239]
v_cvt_pk_bf16_f32 v200, v112, v113
v_cvt_pk_bf16_f32 v201, v114, v115
v_cvt_pk_bf16_f32 v202, v116, v117
v_cvt_pk_bf16_f32 v203, v118, v119
v_cvt_pk_bf16_f32 v204, v120, v121
v_cvt_pk_bf16_f32 v205, v122, v123
v_cvt_pk_bf16_f32 v206, v124, v125
v_cvt_pk_bf16_f32 v207, v126, v127
buffer_store_dwordx4 v[200:203], v96, s[84:87], s51 offen sc1
buffer_store_dwordx4 v[204:207], v96, s[84:87], s51 offen offset:2048 sc1
s_add_u32 s42, s42, 1
s_barrier
s_cmp_gt_i32 s55, s42
s_cbranch_scc1 mega_kernel_q_kv0k
mega_kernel_q_kv0w:
v_mov_b32 v2, 0
s_mov_b64 exec, 0xff
buffer_atomic_add v2, v99, s[84:87], 0 offen sc0 sc1
s_mov_b64 exec, -1
s_waitcnt vmcnt(0)
v_min_i32_dpp v2, v2, v2 quad_perm:[1,0,3,2] row_mask:0xf bank_mask:0xf
s_nop 1
v_min_i32_dpp v2, v2, v2 quad_perm:[2,3,0,1] row_mask:0xf bank_mask:0xf
s_nop 1
v_min_i32_dpp v2, v2, v2 row_half_mirror row_mask:0xf bank_mask:0xf
s_nop 0
v_readfirstlane_b32 s55, v2
s_cmp_gt_i32 s55, s42
s_cbranch_scc1 mega_kernel_q_kv0k
s_sleep 4
s_branch mega_kernel_q_kv0w
mega_kernel_q_kv0k:
s_cmp_ge_u32 s42, 61
s_cbranch_scc0 mega_kernel_q_nl0
s_add_u32 s51, s47, s42
s_bfe_u32 s57, s51, 0x40002
s_lshl_b32 s57, s57, 14
s_and_b32 s66, s51, 3
s_lshl_b32 s66, s66, 11
s_add_u32 s66, s66, s57
s_add_u32 s66, s66, s58
s_add_u32 s67, s66, 33554432
s_bfe_u32 s57, s51, 0x30003
s_lshl_b32 s57, s57, 14
s_and_b32 s68, s51, 7
s_lshl_b32 s68, s68, 10
s_add_u32 s68, s68, s57
s_add_u32 s68, s68, s59
s_add_u32 s50, s42, 4
s_min_u32 s50, s50, 63
s_lshl_b32 s50, s50, 16
s_cmp_gt_i32 s56, s42
s_cselect_b32 s30, 1, 0
s_add_u32 m0, s60, 0
s_nop 0
buffer_load_dwordx4 v5, s[84:87], s66 offen offset:0 sc1 lds
s_add_u32 m0, s60, 0
s_nop 0
buffer_load_dwordx4 v5, s[84:87], s66 offen offset:1024 sc1 lds
s_add_u32 m0, s60, 8192
s_nop 0
buffer_load_dwordx4 v5, s[84:87], s67 offen offset:0 sc1 lds
s_add_u32 m0, s60, 8192
s_nop 0
buffer_load_dwordx4 v5, s[84:87], s67 offen offset:1024 sc1 lds
s_cmp_eq_u32 s30, 1
s_cbranch_scc0 mega_kernel_q_kx0
s_mov_b32 m0, s61
s_nop 0
buffer_load_dwordx4 v5, s[84:87], s68 offen sc1 lds
mega_kernel_q_kx0:
v_mov_b64 v[84:85], v[220:221]
v_mov_b64 v[86:87], v[222:223]
v_mov_b64 v[88:89], v[224:225]
v_mov_b64 v[90:91], v[226:227]
v_mov_b64 v[220:221], v[228:229]
v_mov_b64 v[222:223], v[230:231]
v_mov_b64 v[224:225], v[232:233]
v_mov_b64 v[226:227], v[234:235]
v_cvt_pk_bf16_f32 v228, v68, v69
v_cvt_pk_bf16_f32 v229, v70, v71
v_cvt_pk_bf16_f32 v230, v72, v73
v_cvt_pk_bf16_f32 v231, v74, v75
v_cvt_pk_bf16_f32 v232, v76, v77
v_cvt_pk_bf16_f32 v233, v78, v79
v_cvt_pk_bf16_f32 v234, v80, v81
v_cvt_pk_bf16_f32 v235, v82, v83
ds_write_b128 v101, v[84:87]
ds_write_b128 v101, v[88:91] offset:1024
s_waitcnt vmcnt(4)
v_mov_b32 v17, s42
s_mov_b64 exec, 1
buffer_store_dword v17, v16, s[84:87], s49 offen sc1
s_mov_b64 exec, -1
s_branch mega_kernel_q_jl0
mega_kernel_q_nl0:
ds_read_b128 v[20:23], v8 offset:0
ds_read_b128 v[24:27], v8 offset:2048
ds_read_b128 v[28:31], v9 offset:0
ds_read_b128 v[32:35], v9 offset:2048
ds_read_b128 v[36:39], v8 offset:4096
ds_read_b128 v[40:43], v8 offset:6144
s_add_u32 s51, s47, s42
s_bfe_u32 s57, s51, 0x40002
s_lshl_b32 s57, s57, 14
s_and_b32 s66, s51, 3
s_lshl_b32 s66, s66, 11
s_add_u32 s66, s66, s57
s_add_u32 s66, s66, s58
s_add_u32 s67, s66, 33554432
s_bfe_u32 s57, s51, 0x30003
s_lshl_b32 s57, s57, 14
s_and_b32 s68, s51, 7
s_lshl_b32 s68, s68, 10
s_add_u32 s68, s68, s57
s_add_u32 s68, s68, s59
s_add_u32 s50, s42, 4
s_min_u32 s50, s50, 63
s_lshl_b32 s50, s50, 16
s_cmp_gt_i32 s56, s42
s_cselect_b32 s30, 1, 0
s_add_u32 m0, s60, 0
s_waitcnt lgkmcnt(4)
v_mfma_f32_16x16x32_bf16 v[52:55], a[0:3], v[20:23], 0
ds_read_b128 v[44:47], v9 offset:4096
v_mfma_f32_16x16x32_bf16 v[56:59], a[4:7], v[20:23], 0
buffer_load_dwordx4 v5, s[84:87], s66 offen offset:0 sc1 lds
v_mfma_f32_16x16x32_bf16 v[60:63], a[0:3], v[24:27], 0
ds_read_b128 v[48:51], v9 offset:6144
v_mfma_f32_16x16x32_bf16 v[64:67], a[4:7], v[24:27], 0
s_add_u32 m0, s60, 0
s_waitcnt lgkmcnt(4)
v_mfma_f32_16x16x32_bf16 v[52:55], a[8:11], v[28:31], v[52:55]
ds_read_b128 v[20:23], v8 offset:8192
v_mfma_f32_16x16x32_bf16 v[56:59], a[12:15], v[28:31], v[56:59]
buffer_load_dwordx4 v5, s[84:87], s66 offen offset:1024 sc1 lds
v_mfma_f32_16x16x32_bf16 v[60:63], a[8:11], v[32:35], v[60:63]
ds_read_b128 v[24:27], v8 offset:10240
v_mfma_f32_16x16x32_bf16 v[64:67], a[12:15], v[32:35], v[64:67]
s_add_u32 m0, s60, 8192
s_waitcnt lgkmcnt(4)
v_mfma_f32_16x16x32_bf16 v[52:55], a[16:19], v[36:39], v[52:55]
ds_read_b128 v[28:31], v9 offset:8192
v_mfma_f32_16x16x32_bf16 v[56:59], a[20:23], v[36:39], v[56:59]
buffer_load_dwordx4 v5, s[84:87], s67 offen offset:0 sc1 lds
v_mfma_f32_16x16x32_bf16 v[60:63], a[16:19], v[40:43], v[60:63]
ds_read_b128 v[32:35], v9 offset:10240
v_mfma_f32_16x16x32_bf16 v[64:67], a[20:23], v[40:43], v[64:67]
s_add_u32 m0, s60, 8192
s_waitcnt lgkmcnt(4)
v_mfma_f32_16x16x32_bf16 v[52:55], a[24:27], v[44:47], v[52:55]
ds_read_b128 v[36:39], v8 offset:12288
v_mfma_f32_16x16x32_bf16 v[56:59], a[28:31], v[44:47], v[56:59]
buffer_load_dwordx4 v5, s[84:87], s67 offen offset:1024 sc1 lds
v_mfma_f32_16x16x32_bf16 v[60:63], a[24:27], v[48:51], v[60:63]
ds_read_b128 v[40:43], v8 offset:14336
v_mfma_f32_16x16x32_bf16 v[64:67], a[28:31], v[48:51], v[64:67]
s_waitcnt lgkmcnt(4)
v_mfma_f32_16x16x32_bf16 v[52:55], a[32:35], v[20:23], v[52:55]
ds_read_b128 v[44:47], v9 offset:12288
v_mfma_f32_16x16x32_bf16 v[56:59], a[36:39], v[20:23], v[56:59]
s_cmp_eq_u32 s30, 1
s_cbranch_scc0 mega_kernel_q_ke0
s_mov_b32 m0, s61
s_nop 0
buffer_load_dwordx4 v5, s[84:87], s68 offen sc1 lds
mega_kernel_q_ke0:
v_mfma_f32_16x16x32_bf16 v[60:63], a[32:35], v[24:27], v[60:63]
ds_read_b128 v[48:51], v9 offset:14336
v_mfma_f32_16x16x32_bf16 v[64:67], a[36:39], v[24:27], v[64:67]
s_add_u32 m0, s46, 65536
s_waitcnt lgkmcnt(4)
v_mfma_f32_16x16x32_bf16 v[52:55], a[40:43], v[28:31], v[52:55]
ds_read_b128 v[20:23], v8 offset:16384
v_mfma_f32_16x16x32_bf16 v[56:59], a[44:47], v[28:31], v[56:59]
buffer_load_dwordx4 v6, s[8:11], s50 offen offset:0 lds
v_mfma_f32_16x16x32_bf16 v[60:63], a[40:43], v[32:35], v[60:63]
ds_read_b128 v[24:27], v8 offset:18432
v_mfma_f32_16x16x32_bf16 v[64:67], a[44:47], v[32:35], v[64:67]
s_add_u32 m0, s46, 69504
s_waitcnt lgkmcnt(4)
v_mfma_f32_16x16x32_bf16 v[52:55], a[48:51], v[36:39], v[52:55]
ds_read_b128 v[28:31], v9 offset:16384
v_mfma_f32_16x16x32_bf16 v[56:59], a[52:55], v[36:39], v[56:59]
buffer_load_dwordx4 v6, s[8:11], s50 offen offset:128 lds
v_mfma_f32_16x16x32_bf16 v[60:63], a[48:51], v[40:43], v[60:63]
ds_read_b128 v[32:35], v9 offset:18432
v_mfma_f32_16x16x32_bf16 v[64:67], a[52:55], v[40:43], v[64:67]
s_add_u32 m0, s46, 73472
s_waitcnt lgkmcnt(4)
v_mfma_f32_16x16x32_bf16 v[52:55], a[56:59], v[44:47], v[52:55]
ds_read_b128 v[36:39], v8 offset:20480
v_mfma_f32_16x16x32_bf16 v[56:59], a[60:63], v[44:47], v[56:59]
buffer_load_dwordx4 v6, s[8:11], s50 offen offset:256 lds
v_mfma_f32_16x16x32_bf16 v[60:63], a[56:59], v[48:51], v[60:63]
ds_read_b128 v[40:43], v8 offset:22528
v_mfma_f32_16x16x32_bf16 v[64:67], a[60:63], v[48:51], v[64:67]
s_add_u32 m0, s46, 77440
s_waitcnt lgkmcnt(4)
v_mfma_f32_16x16x32_bf16 v[52:55], a[64:67], v[20:23], v[52:55]
ds_read_b128 v[44:47], v9 offset:20480
v_mfma_f32_16x16x32_bf16 v[56:59], a[68:71], v[20:23], v[56:59]
buffer_load_dwordx4 v6, s[8:11], s50 offen offset:384 lds
v_mfma_f32_16x16x32_bf16 v[60:63], a[64:67], v[24:27], v[60:63]
ds_read_b128 v[48:51], v9 offset:22528
v_mfma_f32_16x16x32_bf16 v[64:67], a[68:71], v[24:27], v[64:67]
s_add_u32 m0, s46, 81408
s_waitcnt lgkmcnt(4)
v_mfma_f32_16x16x32_bf16 v[52:55], a[72:75], v[28:31], v[52:55]
ds_read_b128 v[20:23], v8 offset:24576
v_mfma_f32_16x16x32_bf16 v[56:59], a[76:79], v[28:31], v[56:59]
buffer_load_dwordx4 v6, s[8:11], s50 offen offset:512 lds
v_mfma_f32_16x16x32_bf16 v[60:63], a[72:75], v[32:35], v[60:63]
ds_read_b128 v[24:27], v8 offset:26624
v_mfma_f32_16x16x32_bf16 v[64:67], a[76:79], v[32:35], v[64:67]
s_add_u32 m0, s46, 85376
s_waitcnt lgkmcnt(4)
v_mfma_f32_16x16x32_bf16 v[52:55], a[80:83], v[36:39], v[52:55]
ds_read_b128 v[28:31], v9 offset:24576
v_mfma_f32_16x16x32_bf16 v[56:59], a[84:87], v[36:39], v[56:59]
buffer_load_dwordx4 v6, s[8:11], s50 offen offset:640 lds
v_mfma_f32_16x16x32_bf16 v[60:63], a[80:83], v[40:43], v[60:63]
ds_read_b128 v[32:35], v9 offset:26624
v_mfma_f32_16x16x32_bf16 v[64:67], a[84:87], v[40:43], v[64:67]
s_add_u32 m0, s46, 89344
s_waitcnt lgkmcnt(4)
v_mfma_f32_16x16x32_bf16 v[52:55], a[88:91], v[44:47], v[52:55]
ds_read_b128 v[36:39], v8 offset:28672
v_mfma_f32_16x16x32_bf16 v[56:59], a[92:95], v[44:47], v[56:59]
buffer_load_dwordx4 v6, s[8:11], s50 offen offset:768 lds
v_mfma_f32_16x16x32_bf16 v[60:63], a[88:91], v[48:51], v[60:63]
ds_read_b128 v[40:43], v8 offset:30720
v_mfma_f32_16x16x32_bf16 v[64:67], a[92:95], v[48:51], v[64:67]
s_add_u32 m0, s46, 93312
s_waitcnt lgkmcnt(4)
v_mfma_f32_16x16x32_bf16 v[52:55], a[96:99], v[20:23], v[52:55]
ds_read_b128 v[44:47], v9 offset:28672
v_mfma_f32_16x16x32_bf16 v[56:59], a[100:103], v[20:23], v[56:59]
buffer_load_dwordx4 v6, s[8:11], s50 offen offset:896 lds
v_mfma_f32_16x16x32_bf16 v[60:63], a[96:99], v[24:27], v[60:63]
ds_read_b128 v[48:51], v9 offset:30720
v_mfma_f32_16x16x32_bf16 v[64:67], a[100:103], v[24:27], v[64:67]
s_add_u32 m0, s46, 97280
s_waitcnt lgkmcnt(4)
v_mfma_f32_16x16x32_bf16 v[52:55], a[104:107], v[28:31], v[52:55]
ds_read_b128 v[20:23], v8 offset:32768
v_mfma_f32_16x16x32_bf16 v[56:59], a[108:111], v[28:31], v[56:59]
buffer_load_dwordx4 v6, s[8:11], s50 offen offset:1024 lds
v_mfma_f32_16x16x32_bf16 v[60:63], a[104:107], v[32:35], v[60:63]
ds_read_b128 v[24:27], v8 offset:34816
v_mfma_f32_16x16x32_bf16 v[64:67], a[108:111], v[32:35], v[64:67]
s_waitcnt vmcnt(13)
v_mov_b32 v17, s42
s_mov_b64 exec, 1
buffer_store_dword v17, v16, s[84:87], s49 offen sc1
s_mov_b64 exec, -1
s_add_u32 m0, s46, 101248
s_waitcnt lgkmcnt(4)
v_mfma_f32_16x16x32_bf16 v[52:55], a[112:115], v[36:39], v[52:55]
ds_read_b128 v[28:31], v9 offset:32768
v_mfma_f32_16x16x32_bf16 v[56:59], a[116:119], v[36:39], v[56:59]
buffer_load_dwordx4 v6, s[8:11], s50 offen offset:1152 lds
v_mfma_f32_16x16x32_bf16 v[60:63], a[112:115], v[40:43], v[60:63]
ds_read_b128 v[32:35], v9 offset:34816
v_mfma_f32_16x16x32_bf16 v[64:67], a[116:119], v[40:43], v[64:67]
v_mov_b32 v100, 0
s_mov_b64 exec, 1
buffer_atomic_add v100, v16, s[84:87], s62 offen sc0 sc1
s_mov_b64 exec, -1
s_add_u32 m0, s46, 105216
s_waitcnt lgkmcnt(4)
v_mfma_f32_16x16x32_bf16 v[52:55], a[120:123], v[44:47], v[52:55]
ds_read_b128 v[36:39], v8 offset:36864
v_mfma_f32_16x16x32_bf16 v[56:59], a[124:127], v[44:47], v[56:59]
buffer_load_dwordx4 v6, s[8:11], s50 offen offset:1280 lds
v_mfma_f32_16x16x32_bf16 v[60:63], a[120:123], v[48:51], v[60:63]
ds_read_b128 v[40:43], v8 offset:38912
v_mfma_f32_16x16x32_bf16 v[64:67], a[124:127], v[48:51], v[64:67]
s_add_u32 m0, s46, 109184
s_waitcnt lgkmcnt(4)
v_mfma_f32_16x16x32_bf16 v[52:55], a[128:131], v[20:23], v[52:55]
ds_read_b128 v[44:47], v9 offset:36864
v_mfma_f32_16x16x32_bf16 v[56:59], a[132:135], v[20:23], v[56:59]
buffer_load_dwordx4 v6, s[8:11], s50 offen offset:1408 lds
v_mfma_f32_16x16x32_bf16 v[60:63], a[128:131], v[24:27], v[60:63]
ds_read_b128 v[48:51], v9 offset:38912
v_mfma_f32_16x16x32_bf16 v[64:67], a[132:135], v[24:27], v[64:67]
s_add_u32 m0, s46, 113152
s_waitcnt lgkmcnt(4)
v_mfma_f32_16x16x32_bf16 v[52:55], a[136:139], v[28:31], v[52:55]
ds_read_b128 v[20:23], v8 offset:40960
v_mfma_f32_16x16x32_bf16 v[56:59], a[140:143], v[28:31], v[56:59]
buffer_load_dwordx4 v6, s[8:11], s50 offen offset:1536 lds
v_mfma_f32_16x16x32_bf16 v[60:63], a[136:139], v[32:35], v[60:63]
ds_read_b128 v[24:27], v8 offset:43008
v_mfma_f32_16x16x32_bf16 v[64:67], a[140:143], v[32:35], v[64:67]
s_add_u32 m0, s46, 117120
s_waitcnt lgkmcnt(4)
v_mfma_f32_16x16x32_bf16 v[52:55], a[144:147], v[36:39], v[52:55]
ds_read_b128 v[28:31], v9 offset:40960
v_mfma_f32_16x16x32_bf16 v[56:59], a[148:151], v[36:39], v[56:59]
buffer_load_dwordx4 v6, s[8:11], s50 offen offset:1664 lds
v_mfma_f32_16x16x32_bf16 v[60:63], a[144:147], v[40:43], v[60:63]
ds_read_b128 v[32:35], v9 offset:43008
v_mfma_f32_16x16x32_bf16 v[64:67], a[148:151], v[40:43], v[64:67]
s_add_u32 m0, s46, 121088
s_waitcnt lgkmcnt(4)
v_mfma_f32_16x16x32_bf16 v[52:55], a[152:155], v[44:47], v[52:55]
ds_read_b128 v[36:39], v8 offset:45056
v_mfma_f32_16x16x32_bf16 v[56:59], a[156:159], v[44:47], v[56:59]
buffer_load_dwordx4 v6, s[8:11], s50 offen offset:1792 lds
v_mfma_f32_16x16x32_bf16 v[60:63], a[152:155], v[48:51], v[60:63]
ds_read_b128 v[40:43], v8 offset:47104
v_mfma_f32_16x16x32_bf16 v[64:67], a[156:159], v[48:51], v[64:67]
s_add_u32 m0, s46, 125056
s_waitcnt lgkmcnt(4)
v_mfma_f32_16x16x32_bf16 v[52:55], a[160:163], v[20:23], v[52:55]
ds_read_b128 v[44:47], v9 offset:45056
v_mfma_f32_16x16x32_bf16 v[56:59], a[164:167], v[20:23], v[56:59]
buffer_load_dwordx4 v6, s[8:11], s50 offen offset:1920 lds
v_mfma_f32_16x16x32_bf16 v[60:63], a[160:163], v[24:27], v[60:63]
ds_read_b128 v[48:51], v9 offset:47104
v_mfma_f32_16x16x32_bf16 v[64:67], a[164:167], v[24:27], v[64:67]
s_waitcnt lgkmcnt(4)
v_mfma_f32_16x16x32_bf16 v[52:55], a[168:171], v[28:31], v[52:55]
ds_read_b128 v[20:23], v8 offset:49152
v_mfma_f32_16x16x32_bf16 v[56:59], a[172:175], v[28:31], v[56:59]
v_mov_b64 v[84:85], v[220:221]
v_mov_b64 v[86:87], v[222:223]
v_mfma_f32_16x16x32_bf16 v[60:63], a[168:171], v[32:35], v[60:63]
ds_read_b128 v[24:27], v8 offset:51200
v_mfma_f32_16x16x32_bf16 v[64:67], a[172:175], v[32:35], v[64:67]
v_mov_b64 v[88:89], v[224:225]
v_mov_b64 v[90:91], v[226:227]
s_waitcnt lgkmcnt(4)
v_mfma_f32_16x16x32_bf16 v[52:55], a[176:179], v[36:39], v[52:55]
ds_read_b128 v[28:31], v9 offset:49152
v_mfma_f32_16x16x32_bf16 v[56:59], a[180:183], v[36:39], v[56:59]
v_mov_b64 v[220:221], v[228:229]
v_mov_b64 v[222:223], v[230:231]
v_mfma_f32_16x16x32_bf16 v[60:63], a[176:179], v[40:43], v[60:63]
ds_read_b128 v[32:35], v9 offset:51200
v_mfma_f32_16x16x32_bf16 v[64:67], a[180:183], v[40:43], v[64:67]
v_mov_b64 v[224:225], v[232:233]
v_mov_b64 v[226:227], v[234:235]
s_waitcnt lgkmcnt(4)
v_mfma_f32_16x16x32_bf16 v[52:55], a[184:187], v[44:47], v[52:55]
ds_read_b128 v[36:39], v8 offset:53248
v_mfma_f32_16x16x32_bf16 v[56:59], a[188:191], v[44:47], v[56:59]
v_cvt_pk_bf16_f32 v228, v68, v69
v_cvt_pk_bf16_f32 v229, v70, v71
v_mfma_f32_16x16x32_bf16 v[60:63], a[184:187], v[48:51], v[60:63]
ds_read_b128 v[40:43], v8 offset:55296
v_mfma_f32_16x16x32_bf16 v[64:67], a[188:191], v[48:51], v[64:67]
v_cvt_pk_bf16_f32 v230, v72, v73
v_cvt_pk_bf16_f32 v231, v74, v75
s_waitcnt lgkmcnt(4)
v_mfma_f32_16x16x32_bf16 v[52:55], a[192:195], v[20:23], v[52:55]
ds_read_b128 v[44:47], v9 offset:53248
v_mfma_f32_16x16x32_bf16 v[56:59], a[196:199], v[20:23], v[56:59]
v_cvt_pk_bf16_f32 v232, v76, v77
v_cvt_pk_bf16_f32 v233, v78, v79
v_mfma_f32_16x16x32_bf16 v[60:63], a[192:195], v[24:27], v[60:63]
ds_read_b128 v[48:51], v9 offset:55296
v_mfma_f32_16x16x32_bf16 v[64:67], a[196:199], v[24:27], v[64:67]
v_cvt_pk_bf16_f32 v234, v80, v81
v_cvt_pk_bf16_f32 v235, v82, v83
s_waitcnt lgkmcnt(4)
v_mfma_f32_16x16x32_bf16 v[52:55], a[200:203], v[28:31], v[52:55]
ds_read_b128 v[20:23], v8 offset:57344
v_mfma_f32_16x16x32_bf16 v[56:59], a[204:207], v[28:31], v[56:59]
v_mfma_f32_16x16x32_bf16 v[60:63], a[200:203], v[32:35], v[60:63]
ds_read_b128 v[24:27], v8 offset:59392
v_mfma_f32_16x16x32_bf16 v[64:67], a[204:207], v[32:35], v[64:67]
s_waitcnt lgkmcnt(4)
v_mfma_f32_16x16x32_bf16 v[52:55], a[208:211], v[36:39], v[52:55]
ds_read_b128 v[28:31], v9 offset:57344
v_mfma_f32_16x16x32_bf16 v[56:59], a[212:215], v[36:39], v[56:59]
v_mfma_f32_16x16x32_bf16 v[60:63], a[208:211], v[40:43], v[60:63]
ds_read_b128 v[32:35], v9 offset:59392
v_mfma_f32_16x16x32_bf16 v[64:67], a[212:215], v[40:43], v[64:67]
s_waitcnt lgkmcnt(4)
v_mfma_f32_16x16x32_bf16 v[52:55], a[216:219], v[44:47], v[52:55]
ds_read_b128 v[36:39], v8 offset:61440
v_mfma_f32_16x16x32_bf16 v[56:59], a[220:223], v[44:47], v[56:59]
s_waitcnt vmcnt(6)
v_readfirstlane_b32 s56, v100
s_cmp_eq_u32 s30, 1
s_cbranch_scc1 mega_kernel_q_kf0
s_cmp_gt_i32 s56, s42
s_cbranch_scc0 mega_kernel_q_kf0
s_mov_b32 s30, 1
s_mov_b32 m0, s61
s_nop 0
buffer_load_dwordx4 v5, s[84:87], s68 offen sc1 lds
mega_kernel_q_kf0:
v_mfma_f32_16x16x32_bf16 v[60:63], a[216:219], v[48:51], v[60:63]
ds_read_b128 v[40:43], v8 offset:63488
v_mfma_f32_16x16x32_bf16 v[64:67], a[220:223], v[48:51], v[64:67]
s_waitcnt lgkmcnt(4)
v_mfma_f32_16x16x32_bf16 v[52:55], a[224:227], v[20:23], v[52:55]
ds_read_b128 v[44:47], v9 offset:61440
v_mfma_f32_16x16x32_bf16 v[56:59], a[228:231], v[20:23], v[56:59]
v_mfma_f32_16x16x32_bf16 v[60:63], a[224:227], v[24:27], v[60:63]
ds_read_b128 v[48:51], v9 offset:63488
v_mfma_f32_16x16x32_bf16 v[64:67], a[228:231], v[24:27], v[64:67]
s_waitcnt lgkmcnt(5)
v_mfma_f32_16x16x32_bf16 v[52:55], a[232:235], v[28:31], v[52:55]
v_mfma_f32_16x16x32_bf16 v[56:59], a[236:239], v[28:31], v[56:59]
s_waitcnt lgkmcnt(4)
v_mfma_f32_16x16x32_bf16 v[60:63], a[232:235], v[32:35], v[60:63]
v_mfma_f32_16x16x32_bf16 v[64:67], a[236:239], v[32:35], v[64:67]
s_waitcnt lgkmcnt(3)
v_mfma_f32_16x16x32_bf16 v[52:55], a[240:243], v[36:39], v[52:55]
v_mfma_f32_16x16x32_bf16 v[56:59], a[244:247], v[36:39], v[56:59]
s_waitcnt lgkmcnt(2)
v_mfma_f32_16x16x32_bf16 v[60:63], a[240:243], v[40:43], v[60:63]
v_mfma_f32_16x16x32_bf16 v[64:67], a[244:247], v[40:43], v[64:67]
ds_write_b128 v101, v[84:87]
ds_write_b128 v101, v[88:91] offset:1024
s_waitcnt lgkmcnt(1)
v_mfma_f32_16x16x32_bf16 v[68:71], a[248:251], v[44:47], v[52:55]
v_mfma_f32_16x16x32_bf16 v[72:75], a[252:255], v[44:47], v[56:59]
s_waitcnt lgkmcnt(0)
v_mfma_f32_16x16x32_bf16 v[76:79], a[248:251], v[48:51], v[60:63]
v_mfma_f32_16x16x32_bf16 v[80:83], a[252:255], v[48:51], v[64:67]
mega_kernel_q_jl0:
s_cmp_eq_u32 s30, 1
s_cbranch_scc1 mega_kernel_q_kl0
mega_kernel_q_kw0:
v_mov_b32 v100, 0
s_mov_b64 exec, 1
buffer_atomic_add v100, v16, s[84:87], s62 offen sc0 sc1
s_mov_b64 exec, -1
s_waitcnt vmcnt(0)
v_readfirstlane_b32 s56, v100
s_cmp_gt_i32 s56, s42
s_cbranch_scc1 mega_kernel_q_kv0
s_cmp_eq_u32 s42, 63
s_cbranch_scc1 mega_kernel_q_kw0
s_branch mega_kernel_q_kw0
mega_kernel_q_kv0:
s_mov_b32 m0, s61
s_nop 0
buffer_load_dwordx4 v5, s[84:87], s68 offen sc1 lds
mega_kernel_q_kl0:
s_waitcnt lgkmcnt(0) vmcnt(0)
s_barrier
ds_read_b128 v[184:187], v102 offset:0
ds_read_b128 v[112:115], v103 offset:0
ds_read_b128 v[128:131], v103 offset:1024
ds_read_b128 v[188:191], v102 offset:2048
ds_read_b128 v[116:119], v103 offset:2048
ds_read_b128 v[132:135], v103 offset:3072
ds_read_b128 v[192:195], v102 offset:4096
ds_read_b128 v[120:123], v103 offset:4096
ds_read_b128 v[136:139], v103 offset:5120
ds_read_b128 v[196:199], v102 offset:6144
ds_read_b128 v[124:127], v103 offset:6144
ds_read_b128 v[140:143], v103 offset:7168
s_waitcnt lgkmcnt(9)
v_mfma_f32_16x16x32_bf16 v[200:203], v[112:115], v[184:187], 0
v_mfma_f32_16x16x32_bf16 v[204:207], v[128:131], v[184:187], 0
ds_read_b128 v[160:163], v94 offset:0
s_waitcnt lgkmcnt(7)
v_mfma_f32_16x16x32_bf16 v[200:203], v[116:119], v[188:191], v[200:203]
v_mfma_f32_16x16x32_bf16 v[204:207], v[132:135], v[188:191], v[204:207]
ds_read_b128 v[164:167], v94 offset:1024
s_waitcnt lgkmcnt(5)
v_mfma_f32_16x16x32_bf16 v[200:203], v[120:123], v[192:195], v[200:203]
v_mfma_f32_16x16x32_bf16 v[204:207], v[136:139], v[192:195], v[204:207]
ds_read_b128 v[168:171], v94 offset:2048
s_waitcnt lgkmcnt(3)
v_mfma_f32_16x16x32_bf16 v[200:203], v[124:127], v[196:199], v[200:203]
v_mfma_f32_16x16x32_bf16 v[204:207], v[140:143], v[196:199], v[204:207]
ds_read_b128 v[172:175], v94 offset:3072
s_waitcnt lgkmcnt(3)
v_mfma_f32_16x16x32_bf16 v[208:211], v[160:163], v[184:187], 0
ds_read_b128 v[144:147], v240 offset:0
ds_read_b64 v[176:177], v95 offset:0
s_waitcnt lgkmcnt(4)
v_mfma_f32_16x16x32_bf16 v[208:211], v[164:167], v[188:191], v[208:211]
ds_read_b128 v[148:151], v240 offset:1024
ds_read_b64 v[178:179], v95 offset:256
s_waitcnt lgkmcnt(5)
v_mfma_f32_16x16x32_bf16 v[208:211], v[168:171], v[192:195], v[208:211]
ds_read_b128 v[152:155], v240 offset:2048
ds_read_b64 v[180:181], v95 offset:1024
s_waitcnt lgkmcnt(6)
v_mfma_f32_16x16x32_bf16 v[208:211], v[172:175], v[196:199], v[208:211]
ds_read_b128 v[156:159], v240 offset:3072
ds_read_b64 v[182:183], v95 offset:1280
mega_kernel_q_sm0:
v_pk_mul_f32 v[200:201], v[200:201], s[54:55] op_sel_hi:[1,0]
v_pk_mul_f32 v[202:203], v[202:203], s[54:55] op_sel_hi:[1,0]
v_pk_mul_f32 v[204:205], v[204:205], s[54:55] op_sel_hi:[1,0]
v_pk_mul_f32 v[206:207], v[206:207], s[54:55] op_sel_hi:[1,0]
v_cndmask_b32 v200, v200, v241, s[12:13]
v_cndmask_b32 v201, v201, v241, s[14:15]
v_cndmask_b32 v202, v202, v241, s[16:17]
v_cndmask_b32 v203, v203, v241, s[18:19]
v_cndmask_b32 v204, v204, v241, s[20:21]
v_cndmask_b32 v205, v205, v241, s[22:23]
v_cndmask_b32 v206, v206, v241, s[24:25]
v_cndmask_b32 v207, v207, v241, s[26:27]
v_pk_mul_f32 v[208:209], v[208:209], s[54:55] op_sel_hi:[1,0]
v_pk_mul_f32 v[210:211], v[210:211], s[54:55] op_sel_hi:[1,0]
v_cndmask_b32 v208, v208, v97, s[28:29]
v_cndmask_b32 v209, v209, v97, s[28:29]
v_cndmask_b32 v210, v210, v97, s[28:29]
v_cndmask_b32 v211, v211, v97, s[28:29]
v_max3_f32 v236, v200, v201, v202
v_max3_f32 v236, v236, v203, v204
v_max3_f32 v236, v236, v205, v206
v_max3_f32 v236, v236, v207, v208
v_max3_f32 v236, v236, v209, v210
v_max_f32 v237, v236, v211
v_max_f32 v236, v236, v211
s_nop 1
v_permlane16_swap_b32 v236, v237
s_nop 0
v_max_f32 v238, v236, v237
v_max_f32 v239, v236, v237
s_nop 1
v_permlane32_swap_b32 v238, v239
s_nop 0
v_max_f32 v236, v238, v239
v_pk_add_f32 v[200:201], v[200:201], v[236:237] op_sel_hi:[1,0] neg_lo:[0,1] neg_hi:[0,1]
v_pk_add_f32 v[202:203], v[202:203], v[236:237] op_sel_hi:[1,0] neg_lo:[0,1] neg_hi:[0,1]
v_pk_add_f32 v[204:205], v[204:205], v[236:237] op_sel_hi:[1,0] neg_lo:[0,1] neg_hi:[0,1]
v_pk_add_f32 v[206:207], v[206:207], v[236:237] op_sel_hi:[1,0] neg_lo:[0,1] neg_hi:[0,1]
v_pk_add_f32 v[208:209], v[208:209], v[236:237] op_sel_hi:[1,0] neg_lo:[0,1] neg_hi:[0,1]
v_pk_add_f32 v[210:211], v[210:211], v[236:237] op_sel_hi:[1,0] neg_lo:[0,1] neg_hi:[0,1]
v_exp_f32 v200, v200
v_exp_f32 v201, v201
v_exp_f32 v202, v202
v_exp_f32 v203, v203
v_exp_f32 v204, v204
v_exp_f32 v205, v205
v_exp_f32 v206, v206
v_exp_f32 v207, v207
v_exp_f32 v208, v208
v_exp_f32 v209, v209
v_exp_f32 v210, v210
v_exp_f32 v211, v211
s_nop 0
v_cvt_pk_bf16_f32 v212, v200, v201
v_cvt_pk_bf16_f32 v213, v202, v203
v_cvt_pk_bf16_f32 v214, v204, v205
v_cvt_pk_bf16_f32 v215, v206, v207
v_cvt_pk_bf16_f32 v216, v208, v209
v_cvt_pk_bf16_f32 v217, v210, v211
s_waitcnt lgkmcnt(0)
s_nop 0
v_mfma_f32_16x16x32_bf16 v[108:111], v[104:107], v[212:215], 0
v_mfma_f32_16x16x32_bf16 v[112:115], v[144:147], v[212:215], 0
v_mfma_f32_16x16x32_bf16 v[116:119], v[148:151], v[212:215], 0
v_mfma_f32_16x16x32_bf16 v[120:123], v[152:155], v[212:215], 0
v_mfma_f32_16x16x32_bf16 v[124:127], v[156:159], v[212:215], 0
v_mfma_f32_16x16x16_bf16 v[108:111], v[104:105], v[216:217], v[108:111]
v_mfma_f32_16x16x16_bf16 v[112:115], v[176:177], v[216:217], v[112:115]
v_mfma_f32_16x16x16_bf16 v[116:119], v[178:179], v[216:217], v[116:119]
v_mfma_f32_16x16x16_bf16 v[120:123], v[180:181], v[216:217], v[120:123]
v_mfma_f32_16x16x16_bf16 v[124:127], v[182:183], v[216:217], v[124:127]
s_lshr_b32 s63, s42, 2
s_xnor_b32 s63, s63, s98
s_and_b32 s63, s63, 1
s_lshl_b32 s63, s63, 13
s_lshl_b32 s51, s42, 19
s_add_u32 s51, s51, s63
s_nop 2
v_rcp_f32 v238, v108
v_rcp_f32 v239, v109
s_nop 1
v_pk_mul_f32 v[112:113], v[112:113], v[238:239]
v_pk_mul_f32 v[114:115], v[114:115], v[238:239]
v_pk_mul_f32 v[116:117], v[116:117], v[238:239]
v_pk_mul_f32 v[118:119], v[118:119], v[238:239]
v_pk_mul_f32 v[120:121], v[120:121], v[238:239]
v_pk_mul_f32 v[122:123], v[122:123], v[238:239]
v_pk_mul_f32 v[124:125], v[124:125], v[238:239]
v_pk_mul_f32 v[126:127], v[126:127], v[238:239]
v_cvt_pk_bf16_f32 v200, v112, v113
v_cvt_pk_bf16_f32 v201, v114, v115
v_cvt_pk_bf16_f32 v202, v116, v117
v_cvt_pk_bf16_f32 v203, v118, v119
v_cvt_pk_bf16_f32 v204, v120, v121
v_cvt_pk_bf16_f32 v205, v122, v123
v_cvt_pk_bf16_f32 v206, v124, v125
v_cvt_pk_bf16_f32 v207, v126, v127
buffer_store_dwordx4 v[200:203], v96, s[84:87], s51 offen sc1
buffer_store_dwordx4 v[204:207], v96, s[84:87], s51 offen offset:2048 sc1
s_add_u32 s42, s42, 1
s_cmp_lt_u32 s42, 64
s_cbranch_scc1 mega_kernel_q_loop
s_waitcnt vmcnt(0)
v_mov_b32 v17, s42
s_mov_b64 exec, 1
buffer_store_dword v17, v16, s[84:87], s49 offen sc1
s_mov_b64 exec, -1
mega_kernel_q_quit:
s_endpgm
mega_kernel_rd:
s_mov_b32 s93, s40
s_load_dwordx2 s[4:5], s[0:1], 56
s_mov_b32 s48, 0x3f7ec46d
s_mov_b32 s49, 0x3dc8bd36
s_mov_b32 s50, 0x3f7b14be
s_mov_b32 s51, 0x3e47c5c2
s_mov_b32 s52, 0x3f74fa0b
s_mov_b32 s53, 0x3e94a031
s_mov_b32 s54, 0x3f6c835e
s_mov_b32 s55, 0x3ec3ef15
s_mov_b32 s56, 0x3f61c598
s_mov_b32 s57, 0x3ef15aea
s_mov_b32 s58, 0x3f54db31
s_mov_b32 s59, 0x3f0e39da
s_mov_b32 s60, 0x3f45e403
s_mov_b32 s61, 0x3f226799
s_mov_b32 s62, 0x3f3504f3
s_mov_b32 s63, 0x3f3504f3
v_and_b32 v1, 31, v0
v_lshrrev_b32 v2, 5, v0
v_cvt_f32_u32 v3, v1
v_mul_u32_u24 v10, 8448, v2
v_lshl_add_u32 v4, v1, 3, v10
v_mul_u32_u24 v5, 264, v1
v_add_u32 v5, v5, v10
v_and_b32 v11, 7, v0
v_lshrrev_b32 v9, 3, v0
v_mul_u32_u24 v10, 8448, v11
v_lshl_add_u32 v6, v9, 3, v10
v_lshlrev_b32 v7, 3, v9
v_sub_u32 v7, v10, v7
v_add_u32 v7, 4096, v7
v_mul_u32_u24 v8, 32768, v9
v_lshl_add_u32 v8, v11, 4, v8
v_mul_f32 v12, 0xba800000, v3
v_cos_f32 v82, v12
v_sin_f32 v83, v12
v_mul_f32 v12, 0xbb000000, v3
v_cos_f32 v84, v12
v_sin_f32 v85, v12
v_mul_f32 v12, 0xbb400000, v3
v_cos_f32 v86, v12
v_sin_f32 v87, v12
v_mul_f32 v12, 0xbb800000, v3
v_cos_f32 v88, v12
v_sin_f32 v89, v12
v_mul_f32 v12, 0xbba00000, v3
v_cos_f32 v90, v12
v_sin_f32 v91, v12
v_mul_f32 v12, 0xbbc00000, v3
v_cos_f32 v92, v12
v_sin_f32 v93, v12
v_mul_f32 v12, 0xbbe00000, v3
v_cos_f32 v94, v12
v_sin_f32 v95, v12
v_mul_f32 v12, 0xbc000000, v3
v_cos_f32 v96, v12
v_sin_f32 v97, v12
v_mul_f32 v12, 0xbc100000, v3
v_cos_f32 v98, v12
v_sin_f32 v99, v12
v_mul_f32 v12, 0xbc200000, v3
v_cos_f32 v100, v12
v_sin_f32 v101, v12
v_mul_f32 v12, 0xbc300000, v3
v_cos_f32 v102, v12
v_sin_f32 v103, v12
v_mul_f32 v12, 0xbc400000, v3
v_cos_f32 v104, v12
v_sin_f32 v105, v12
v_mul_f32 v12, 0xbc500000, v3
v_cos_f32 v106, v12
v_sin_f32 v107, v12
v_mul_f32 v12, 0xbc600000, v3
v_cos_f32 v108, v12
v_sin_f32 v109, v12
v_mul_f32 v12, 0xbc700000, v3
v_cos_f32 v110, v12
v_sin_f32 v111, v12
v_mul_f32 v12, 0xbc800000, v3
v_cos_f32 v112, v12
v_sin_f32 v113, v12
v_mul_f32 v12, 0xbc880000, v3
v_cos_f32 v114, v12
v_sin_f32 v115, v12
v_mul_f32 v12, 0xbc900000, v3
v_cos_f32 v116, v12
v_sin_f32 v117, v12
v_mul_f32 v12, 0xbc980000, v3
v_cos_f32 v118, v12
v_sin_f32 v119, v12
v_mul_f32 v12, 0xbca00000, v3
v_cos_f32 v120, v12
v_sin_f32 v121, v12
v_mul_f32 v12, 0xbca80000, v3
v_cos_f32 v122, v12
v_sin_f32 v123, v12
v_mul_f32 v12, 0xbcb00000, v3
v_cos_f32 v124, v12
v_sin_f32 v125, v12
v_mul_f32 v12, 0xbcb80000, v3
v_cos_f32 v126, v12
v_sin_f32 v127, v12
v_mul_f32 v12, 0xbcc00000, v3
v_cos_f32 v128, v12
v_sin_f32 v129, v12
v_mul_f32 v12, 0xbcc80000, v3
v_cos_f32 v130, v12
v_sin_f32 v131, v12
v_mul_f32 v12, 0xbcd00000, v3
v_cos_f32 v132, v12
v_sin_f32 v133, v12
v_mul_f32 v12, 0xbcd80000, v3
v_cos_f32 v134, v12
v_sin_f32 v135, v12
v_mul_f32 v12, 0xbce00000, v3
v_cos_f32 v136, v12
v_sin_f32 v137, v12
v_mul_f32 v12, 0xbce80000, v3
v_cos_f32 v138, v12
v_sin_f32 v139, v12
v_mul_f32 v12, 0xbcf00000, v3
v_cos_f32 v140, v12
v_sin_f32 v141, v12
v_mul_f32 v12, 0xbcf80000, v3
v_cos_f32 v142, v12
v_sin_f32 v143, v12
v_lshlrev_b32 v12, 12, v2
v_lshl_add_u32 v12, v1, 1, v12
s_waitcnt lgkmcnt(0)
s_mov_b32 s6, 4194304
s_mov_b32 s7, 0x00020000
v_mov_b32 v144, 0
v_mov_b32 v145, 0
v_mov_b32 v146, 0
v_mov_b32 v147, 0
v_mov_b32 v148, 0
v_mov_b32 v149, 0
v_mov_b32 v150, 0
v_mov_b32 v151, 0
v_mov_b32 v152, 0
v_mov_b32 v153, 0
v_mov_b32 v154, 0
v_mov_b32 v155, 0
v_mov_b32 v156, 0
v_mov_b32 v157, 0
v_mov_b32 v158, 0
v_mov_b32 v159, 0
v_mov_b32 v160, 0
v_mov_b32 v161, 0
v_mov_b32 v162, 0
v_mov_b32 v163, 0
v_mov_b32 v164, 0
v_mov_b32 v165, 0
v_mov_b32 v166, 0
v_mov_b32 v167, 0
v_mov_b32 v168, 0
v_mov_b32 v169, 0
v_mov_b32 v170, 0
v_mov_b32 v171, 0
v_mov_b32 v172, 0
v_mov_b32 v173, 0
v_mov_b32 v174, 0
v_mov_b32 v175, 0
v_mov_b32 v176, 0
v_mov_b32 v177, 0
v_mov_b32 v178, 0
v_mov_b32 v179, 0
v_mov_b32 v180, 0
v_mov_b32 v181, 0
v_mov_b32 v182, 0
v_mov_b32 v183, 0
v_mov_b32 v184, 0
v_mov_b32 v185, 0
v_mov_b32 v186, 0
v_mov_b32 v187, 0
v_mov_b32 v188, 0
v_mov_b32 v189, 0
v_mov_b32 v190, 0
v_mov_b32 v191, 0
v_mov_b32 v192, 0
v_mov_b32 v193, 0
v_mov_b32 v194, 0
v_mov_b32 v195, 0
v_mov_b32 v196, 0
v_mov_b32 v197, 0
v_mov_b32 v198, 0
v_mov_b32 v199, 0
v_mov_b32 v200, 0
v_mov_b32 v201, 0
v_mov_b32 v202, 0
v_mov_b32 v203, 0
v_mov_b32 v204, 0
v_mov_b32 v205, 0
v_mov_b32 v206, 0
v_mov_b32 v207, 0
s_cmp_lt_u32 s93, 128
s_cbranch_scc0 mega_kernel_f1_e
s_lshl_b32 s12, s93, 15
buffer_load_short_d16_hi v144, v12, s[4:7], s12 offen offset:0
buffer_load_short_d16_hi v145, v12, s[4:7], s12 offen offset:2048
buffer_load_short_d16_hi v176, v12, s[4:7], s12 offen offset:1024
buffer_load_short_d16_hi v177, v12, s[4:7], s12 offen offset:3072
buffer_load_short_d16_hi v146, v12, s[4:7], s12 offen offset:64
buffer_load_short_d16_hi v147, v12, s[4:7], s12 offen offset:2112
buffer_load_short_d16_hi v178, v12, s[4:7], s12 offen offset:1088
buffer_load_short_d16_hi v179, v12, s[4:7], s12 offen offset:3136
buffer_load_short_d16_hi v148, v12, s[4:7], s12 offen offset:128
buffer_load_short_d16_hi v149, v12, s[4:7], s12 offen offset:2176
buffer_load_short_d16_hi v180, v12, s[4:7], s12 offen offset:1152
buffer_load_short_d16_hi v181, v12, s[4:7], s12 offen offset:3200
buffer_load_short_d16_hi v150, v12, s[4:7], s12 offen offset:192
buffer_load_short_d16_hi v151, v12, s[4:7], s12 offen offset:2240
buffer_load_short_d16_hi v182, v12, s[4:7], s12 offen offset:1216
buffer_load_short_d16_hi v183, v12, s[4:7], s12 offen offset:3264
buffer_load_short_d16_hi v152, v12, s[4:7], s12 offen offset:256
buffer_load_short_d16_hi v153, v12, s[4:7], s12 offen offset:2304
buffer_load_short_d16_hi v184, v12, s[4:7], s12 offen offset:1280
buffer_load_short_d16_hi v185, v12, s[4:7], s12 offen offset:3328
buffer_load_short_d16_hi v154, v12, s[4:7], s12 offen offset:320
buffer_load_short_d16_hi v155, v12, s[4:7], s12 offen offset:2368
buffer_load_short_d16_hi v186, v12, s[4:7], s12 offen offset:1344
buffer_load_short_d16_hi v187, v12, s[4:7], s12 offen offset:3392
buffer_load_short_d16_hi v156, v12, s[4:7], s12 offen offset:384
buffer_load_short_d16_hi v157, v12, s[4:7], s12 offen offset:2432
buffer_load_short_d16_hi v188, v12, s[4:7], s12 offen offset:1408
buffer_load_short_d16_hi v189, v12, s[4:7], s12 offen offset:3456
buffer_load_short_d16_hi v158, v12, s[4:7], s12 offen offset:448
buffer_load_short_d16_hi v159, v12, s[4:7], s12 offen offset:2496
buffer_load_short_d16_hi v190, v12, s[4:7], s12 offen offset:1472
buffer_load_short_d16_hi v191, v12, s[4:7], s12 offen offset:3520
buffer_load_short_d16_hi v160, v12, s[4:7], s12 offen offset:512
buffer_load_short_d16_hi v161, v12, s[4:7], s12 offen offset:2560
buffer_load_short_d16_hi v192, v12, s[4:7], s12 offen offset:1536
buffer_load_short_d16_hi v193, v12, s[4:7], s12 offen offset:3584
buffer_load_short_d16_hi v162, v12, s[4:7], s12 offen offset:576
buffer_load_short_d16_hi v163, v12, s[4:7], s12 offen offset:2624
buffer_load_short_d16_hi v194, v12, s[4:7], s12 offen offset:1600
buffer_load_short_d16_hi v195, v12, s[4:7], s12 offen offset:3648
buffer_load_short_d16_hi v164, v12, s[4:7], s12 offen offset:640
buffer_load_short_d16_hi v165, v12, s[4:7], s12 offen offset:2688
buffer_load_short_d16_hi v196, v12, s[4:7], s12 offen offset:1664
buffer_load_short_d16_hi v197, v12, s[4:7], s12 offen offset:3712
buffer_load_short_d16_hi v166, v12, s[4:7], s12 offen offset:704
buffer_load_short_d16_hi v167, v12, s[4:7], s12 offen offset:2752
buffer_load_short_d16_hi v198, v12, s[4:7], s12 offen offset:1728
buffer_load_short_d16_hi v199, v12, s[4:7], s12 offen offset:3776
buffer_load_short_d16_hi v168, v12, s[4:7], s12 offen offset:768
buffer_load_short_d16_hi v169, v12, s[4:7], s12 offen offset:2816
buffer_load_short_d16_hi v200, v12, s[4:7], s12 offen offset:1792
buffer_load_short_d16_hi v201, v12, s[4:7], s12 offen offset:3840
buffer_load_short_d16_hi v170, v12, s[4:7], s12 offen offset:832
buffer_load_short_d16_hi v171, v12, s[4:7], s12 offen offset:2880
buffer_load_short_d16_hi v202, v12, s[4:7], s12 offen offset:1856
buffer_load_short_d16_hi v203, v12, s[4:7], s12 offen offset:3904
buffer_load_short_d16_hi v172, v12, s[4:7], s12 offen offset:896
buffer_load_short_d16_hi v173, v12, s[4:7], s12 offen offset:2944
buffer_load_short_d16_hi v204, v12, s[4:7], s12 offen offset:1920
buffer_load_short_d16_hi v205, v12, s[4:7], s12 offen offset:3968
buffer_load_short_d16_hi v174, v12, s[4:7], s12 offen offset:960
buffer_load_short_d16_hi v175, v12, s[4:7], s12 offen offset:3008
buffer_load_short_d16_hi v206, v12, s[4:7], s12 offen offset:1984
buffer_load_short_d16_hi v207, v12, s[4:7], s12 offen offset:4032
s_waitcnt vmcnt(0)
mega_kernel_f1_l:
s_add_u32 s21, s93, 32
s_cmp_lt_u32 s21, 128
s_cselect_b32 s22, s21, s93
s_waitcnt vmcnt(17)
v_pk_add_f32 v[48:49], v[144:145], v[176:177] neg_lo:[0,1] neg_hi:[0,1]
v_pk_add_f32 v[16:17], v[144:145], v[176:177]
v_pk_add_f32 v[14:15], v[146:147], v[178:179] neg_lo:[0,1] neg_hi:[0,1]
v_pk_add_f32 v[18:19], v[146:147], v[178:179]
v_pk_mul_f32 v[50:51], v[14:15], s[50:51] op_sel:[0,0] op_sel_hi:[0,1] neg_lo:[0,0] neg_hi:[0,1]
v_pk_fma_f32 v[50:51], v[14:15], s[50:51], v[50:51] op_sel:[1,1,0] op_sel_hi:[1,0,1] neg_lo:[0,0,0] neg_hi:[0,0,0]
v_pk_add_f32 v[14:15], v[148:149], v[180:181] neg_lo:[0,1] neg_hi:[0,1]
v_pk_add_f32 v[20:21], v[148:149], v[180:181]
v_pk_mul_f32 v[52:53], v[14:15], s[54:55] op_sel:[0,0] op_sel_hi:[0,1] neg_lo:[0,0] neg_hi:[0,1]
v_pk_fma_f32 v[52:53], v[14:15], s[54:55], v[52:53] op_sel:[1,1,0] op_sel_hi:[1,0,1] neg_lo:[0,0,0] neg_hi:[0,0,0]
v_pk_add_f32 v[14:15], v[150:151], v[182:183] neg_lo:[0,1] neg_hi:[0,1]
v_pk_add_f32 v[22:23], v[150:151], v[182:183]
v_pk_mul_f32 v[54:55], v[14:15], s[58:59] op_sel:[0,0] op_sel_hi:[0,1] neg_lo:[0,0] neg_hi:[0,1]
v_pk_fma_f32 v[54:55], v[14:15], s[58:59], v[54:55] op_sel:[1,1,0] op_sel_hi:[1,0,1] neg_lo:[0,0,0] neg_hi:[0,0,0]
v_pk_add_f32 v[14:15], v[152:153], v[184:185] neg_lo:[0,1] neg_hi:[0,1]
v_pk_add_f32 v[24:25], v[152:153], v[184:185]
v_pk_mul_f32 v[56:57], v[14:15], s[62:63] op_sel:[0,0] op_sel_hi:[0,1] neg_lo:[0,0] neg_hi:[0,1]
v_pk_fma_f32 v[56:57], v[14:15], s[62:63], v[56:57] op_sel:[1,1,0] op_sel_hi:[1,0,1] neg_lo:[0,0,0] neg_hi:[0,0,0]
v_pk_add_f32 v[14:15], v[154:155], v[186:187] neg_lo:[0,1] neg_hi:[0,1]
v_pk_add_f32 v[26:27], v[154:155], v[186:187]
v_pk_mul_f32 v[58:59], v[14:15], s[58:59] op_sel:[0,1] op_sel_hi:[0,0] neg_lo:[0,0] neg_hi:[0,1]
v_pk_fma_f32 v[58:59], v[14:15], s[58:59], v[58:59] op_sel:[1,0,0] op_sel_hi:[1,1,1] neg_lo:[0,0,0] neg_hi:[0,0,0]
v_pk_add_f32 v[14:15], v[156:157], v[188:189] neg_lo:[0,1] neg_hi:[0,1]
v_pk_add_f32 v[28:29], v[156:157], v[188:189]
v_pk_mul_f32 v[60:61], v[14:15], s[54:55] op_sel:[0,1] op_sel_hi:[0,0] neg_lo:[0,0] neg_hi:[0,1]
v_pk_fma_f32 v[60:61], v[14:15], s[54:55], v[60:61] op_sel:[1,0,0] op_sel_hi:[1,1,1] neg_lo:[0,0,0] neg_hi:[0,0,0]
v_pk_add_f32 v[14:15], v[158:159], v[190:191] neg_lo:[0,1] neg_hi:[0,1]
v_pk_add_f32 v[30:31], v[158:159], v[190:191]
v_pk_mul_f32 v[62:63], v[14:15], s[50:51] op_sel:[0,1] op_sel_hi:[0,0] neg_lo:[0,0] neg_hi:[0,1]
v_pk_fma_f32 v[62:63], v[14:15], s[50:51], v[62:63] op_sel:[1,0,0] op_sel_hi:[1,1,1] neg_lo:[0,0,0] neg_hi:[0,0,0]
v_pk_add_f32 v[64:65], v[160:161], v[192:193] op_sel:[1,1] op_sel_hi:[0,0] neg_lo:[0,1] neg_hi:[1,0]
v_pk_add_f32 v[32:33], v[160:161], v[192:193]
v_pk_add_f32 v[14:15], v[162:163], v[194:195] neg_lo:[0,1] neg_hi:[0,1]
v_pk_add_f32 v[34:35], v[162:163], v[194:195]
v_pk_mul_f32 v[66:67], v[14:15], s[50:51] op_sel:[0,1] op_sel_hi:[0,0] neg_lo:[0,1] neg_hi:[0,1]
v_pk_fma_f32 v[66:67], v[14:15], s[50:51], v[66:67] op_sel:[1,0,0] op_sel_hi:[1,1,1] neg_lo:[0,0,0] neg_hi:[0,1,0]
v_pk_add_f32 v[14:15], v[164:165], v[196:197] neg_lo:[0,1] neg_hi:[0,1]
v_pk_add_f32 v[36:37], v[164:165], v[196:197]
v_pk_mul_f32 v[68:69], v[14:15], s[54:55] op_sel:[0,1] op_sel_hi:[0,0] neg_lo:[0,1] neg_hi:[0,1]
v_pk_fma_f32 v[68:69], v[14:15], s[54:55], v[68:69] op_sel:[1,0,0] op_sel_hi:[1,1,1] neg_lo:[0,0,0] neg_hi:[0,1,0]
v_pk_add_f32 v[14:15], v[166:167], v[198:199] neg_lo:[0,1] neg_hi:[0,1]
v_pk_add_f32 v[38:39], v[166:167], v[198:199]
v_pk_mul_f32 v[70:71], v[14:15], s[58:59] op_sel:[0,1] op_sel_hi:[0,0] neg_lo:[0,1] neg_hi:[0,1]
v_pk_fma_f32 v[70:71], v[14:15], s[58:59], v[70:71] op_sel:[1,0,0] op_sel_hi:[1,1,1] neg_lo:[0,0,0] neg_hi:[0,1,0]
v_pk_add_f32 v[14:15], v[168:169], v[200:201] neg_lo:[0,1] neg_hi:[0,1]
v_pk_add_f32 v[40:41], v[168:169], v[200:201]
v_pk_mul_f32 v[72:73], v[14:15], s[62:63] op_sel:[0,0] op_sel_hi:[0,1] neg_lo:[0,1] neg_hi:[0,1]
v_pk_fma_f32 v[72:73], v[14:15], s[62:63], v[72:73] op_sel:[1,1,0] op_sel_hi:[1,0,1] neg_lo:[0,0,0] neg_hi:[0,1,0]
v_pk_add_f32 v[14:15], v[170:171], v[202:203] neg_lo:[0,1] neg_hi:[0,1]
v_pk_add_f32 v[42:43], v[170:171], v[202:203]
v_pk_mul_f32 v[74:75], v[14:15], s[58:59] op_sel:[0,0] op_sel_hi:[0,1] neg_lo:[0,1] neg_hi:[0,1]
v_pk_fma_f32 v[74:75], v[14:15], s[58:59], v[74:75] op_sel:[1,1,0] op_sel_hi:[1,0,1] neg_lo:[0,0,0] neg_hi:[0,1,0]
v_pk_add_f32 v[14:15], v[172:173], v[204:205] neg_lo:[0,1] neg_hi:[0,1]
v_pk_add_f32 v[44:45], v[172:173], v[204:205]
v_pk_mul_f32 v[76:77], v[14:15], s[54:55] op_sel:[0,0] op_sel_hi:[0,1] neg_lo:[0,1] neg_hi:[0,1]
v_pk_fma_f32 v[76:77], v[14:15], s[54:55], v[76:77] op_sel:[1,1,0] op_sel_hi:[1,0,1] neg_lo:[0,0,0] neg_hi:[0,1,0]
v_pk_add_f32 v[14:15], v[174:175], v[206:207] neg_lo:[0,1] neg_hi:[0,1]
v_pk_add_f32 v[46:47], v[174:175], v[206:207]
v_pk_mul_f32 v[78:79], v[14:15], s[50:51] op_sel:[0,0] op_sel_hi:[0,1] neg_lo:[0,1] neg_hi:[0,1]
v_pk_fma_f32 v[78:79], v[14:15], s[50:51], v[78:79] op_sel:[1,1,0] op_sel_hi:[1,0,1] neg_lo:[0,0,0] neg_hi:[0,1,0]
s_lshl_b32 s12, s22, 15
buffer_load_short_d16_hi v144, v12, s[4:7], s12 offen offset:0
buffer_load_short_d16_hi v145, v12, s[4:7], s12 offen offset:2048
buffer_load_short_d16_hi v176, v12, s[4:7], s12 offen offset:1024
buffer_load_short_d16_hi v177, v12, s[4:7], s12 offen offset:3072
buffer_load_short_d16_hi v146, v12, s[4:7], s12 offen offset:64
buffer_load_short_d16_hi v147, v12, s[4:7], s12 offen offset:2112
buffer_load_short_d16_hi v178, v12, s[4:7], s12 offen offset:1088
buffer_load_short_d16_hi v179, v12, s[4:7], s12 offen offset:3136
buffer_load_short_d16_hi v148, v12, s[4:7], s12 offen offset:128
buffer_load_short_d16_hi v149, v12, s[4:7], s12 offen offset:2176
buffer_load_short_d16_hi v180, v12, s[4:7], s12 offen offset:1152
buffer_load_short_d16_hi v181, v12, s[4:7], s12 offen offset:3200
buffer_load_short_d16_hi v150, v12, s[4:7], s12 offen offset:192
buffer_load_short_d16_hi v151, v12, s[4:7], s12 offen offset:2240
buffer_load_short_d16_hi v182, v12, s[4:7], s12 offen offset:1216
buffer_load_short_d16_hi v183, v12, s[4:7], s12 offen offset:3264
buffer_load_short_d16_hi v152, v12, s[4:7], s12 offen offset:256
buffer_load_short_d16_hi v153, v12, s[4:7], s12 offen offset:2304
buffer_load_short_d16_hi v184, v12, s[4:7], s12 offen offset:1280
buffer_load_short_d16_hi v185, v12, s[4:7], s12 offen offset:3328
buffer_load_short_d16_hi v154, v12, s[4:7], s12 offen offset:320
buffer_load_short_d16_hi v155, v12, s[4:7], s12 offen offset:2368
buffer_load_short_d16_hi v186, v12, s[4:7], s12 offen offset:1344
buffer_load_short_d16_hi v187, v12, s[4:7], s12 offen offset:3392
buffer_load_short_d16_hi v156, v12, s[4:7], s12 offen offset:384
buffer_load_short_d16_hi v157, v12, s[4:7], s12 offen offset:2432
buffer_load_short_d16_hi v188, v12, s[4:7], s12 offen offset:1408
buffer_load_short_d16_hi v189, v12, s[4:7], s12 offen offset:3456
buffer_load_short_d16_hi v158, v12, s[4:7], s12 offen offset:448
buffer_load_short_d16_hi v159, v12, s[4:7], s12 offen offset:2496
buffer_load_short_d16_hi v190, v12, s[4:7], s12 offen offset:1472
buffer_load_short_d16_hi v191, v12, s[4:7], s12 offen offset:3520
buffer_load_short_d16_hi v160, v12, s[4:7], s12 offen offset:512
buffer_load_short_d16_hi v161, v12, s[4:7], s12 offen offset:2560
buffer_load_short_d16_hi v192, v12, s[4:7], s12 offen offset:1536
buffer_load_short_d16_hi v193, v12, s[4:7], s12 offen offset:3584
buffer_load_short_d16_hi v162, v12, s[4:7], s12 offen offset:576
buffer_load_short_d16_hi v163, v12, s[4:7], s12 offen offset:2624
buffer_load_short_d16_hi v194, v12, s[4:7], s12 offen offset:1600
buffer_load_short_d16_hi v195, v12, s[4:7], s12 offen offset:3648
buffer_load_short_d16_hi v164, v12, s[4:7], s12 offen offset:640
buffer_load_short_d16_hi v165, v12, s[4:7], s12 offen offset:2688
buffer_load_short_d16_hi v196, v12, s[4:7], s12 offen offset:1664
buffer_load_short_d16_hi v197, v12, s[4:7], s12 offen offset:3712
buffer_load_short_d16_hi v166, v12, s[4:7], s12 offen offset:704
buffer_load_short_d16_hi v167, v12, s[4:7], s12 offen offset:2752
buffer_load_short_d16_hi v198, v12, s[4:7], s12 offen offset:1728
buffer_load_short_d16_hi v199, v12, s[4:7], s12 offen offset:3776
buffer_load_short_d16_hi v168, v12, s[4:7], s12 offen offset:768
buffer_load_short_d16_hi v169, v12, s[4:7], s12 offen offset:2816
buffer_load_short_d16_hi v200, v12, s[4:7], s12 offen offset:1792
buffer_load_short_d16_hi v201, v12, s[4:7], s12 offen offset:3840
buffer_load_short_d16_hi v170, v12, s[4:7], s12 offen offset:832
buffer_load_short_d16_hi v171, v12, s[4:7], s12 offen offset:2880
buffer_load_short_d16_hi v202, v12, s[4:7], s12 offen offset:1856
buffer_load_short_d16_hi v203, v12, s[4:7], s12 offen offset:3904
buffer_load_short_d16_hi v172, v12, s[4:7], s12 offen offset:896
buffer_load_short_d16_hi v173, v12, s[4:7], s12 offen offset:2944
buffer_load_short_d16_hi v204, v12, s[4:7], s12 offen offset:1920
buffer_load_short_d16_hi v205, v12, s[4:7], s12 offen offset:3968
buffer_load_short_d16_hi v174, v12, s[4:7], s12 offen offset:960
buffer_load_short_d16_hi v175, v12, s[4:7], s12 offen offset:3008
buffer_load_short_d16_hi v206, v12, s[4:7], s12 offen offset:1984
buffer_load_short_d16_hi v207, v12, s[4:7], s12 offen offset:4032
v_pk_add_f32 v[14:15], v[16:17], v[32:33] neg_lo:[0,1] neg_hi:[0,1]
v_pk_add_f32 v[16:17], v[16:17], v[32:33]
v_pk_add_f32 v[32:33], v[18:19], v[34:35] neg_lo:[0,1] neg_hi:[0,1]
v_pk_add_f32 v[18:19], v[18:19], v[34:35]
v_pk_mul_f32 v[34:35], v[32:33], s[54:55] op_sel:[0,0] op_sel_hi:[0,1] neg_lo:[0,0] neg_hi:[0,1]
v_pk_fma_f32 v[34:35], v[32:33], s[54:55], v[34:35] op_sel:[1,1,0] op_sel_hi:[1,0,1] neg_lo:[0,0,0] neg_hi:[0,0,0]
v_pk_add_f32 v[32:33], v[20:21], v[36:37] neg_lo:[0,1] neg_hi:[0,1]
v_pk_add_f32 v[20:21], v[20:21], v[36:37]
v_pk_mul_f32 v[36:37], v[32:33], s[62:63] op_sel:[0,0] op_sel_hi:[0,1] neg_lo:[0,0] neg_hi:[0,1]
v_pk_fma_f32 v[36:37], v[32:33], s[62:63], v[36:37] op_sel:[1,1,0] op_sel_hi:[1,0,1] neg_lo:[0,0,0] neg_hi:[0,0,0]
v_pk_add_f32 v[32:33], v[22:23], v[38:39] neg_lo:[0,1] neg_hi:[0,1]
v_pk_add_f32 v[22:23], v[22:23], v[38:39]
v_pk_mul_f32 v[38:39], v[32:33], s[54:55] op_sel:[0,1] op_sel_hi:[0,0] neg_lo:[0,0] neg_hi:[0,1]
v_pk_fma_f32 v[38:39], v[32:33], s[54:55], v[38:39] op_sel:[1,0,0] op_sel_hi:[1,1,1] neg_lo:[0,0,0] neg_hi:[0,0,0]
v_pk_add_f32 v[32:33], v[24:25], v[40:41] op_sel:[1,1] op_sel_hi:[0,0] neg_lo:[0,1] neg_hi:[1,0]
v_pk_add_f32 v[24:25], v[24:25], v[40:41]
v_pk_add_f32 v[40:41], v[26:27], v[42:43] neg_lo:[0,1] neg_hi:[0,1]
v_pk_add_f32 v[26:27], v[26:27], v[42:43]
v_pk_mul_f32 v[42:43], v[40:41], s[54:55] op_sel:[0,1] op_sel_hi:[0,0] neg_lo:[0,1] neg_hi:[0,1]
v_pk_fma_f32 v[42:43], v[40:41], s[54:55], v[42:43] op_sel:[1,0,0] op_sel_hi:[1,1,1] neg_lo:[0,0,0] neg_hi:[0,1,0]
v_pk_add_f32 v[40:41], v[28:29], v[44:45] neg_lo:[0,1] neg_hi:[0,1]
v_pk_add_f32 v[28:29], v[28:29], v[44:45]
v_pk_mul_f32 v[44:45], v[40:41], s[62:63] op_sel:[0,0] op_sel_hi:[0,1] neg_lo:[0,1] neg_hi:[0,1]
v_pk_fma_f32 v[44:45], v[40:41], s[62:63], v[44:45] op_sel:[1,1,0] op_sel_hi:[1,0,1] neg_lo:[0,0,0] neg_hi:[0,1,0]
v_pk_add_f32 v[40:41], v[30:31], v[46:47] neg_lo:[0,1] neg_hi:[0,1]
v_pk_add_f32 v[30:31], v[30:31], v[46:47]
v_pk_mul_f32 v[46:47], v[40:41], s[54:55] op_sel:[0,0] op_sel_hi:[0,1] neg_lo:[0,1] neg_hi:[0,1]
v_pk_fma_f32 v[46:47], v[40:41], s[54:55], v[46:47] op_sel:[1,1,0] op_sel_hi:[1,0,1] neg_lo:[0,0,0] neg_hi:[0,1,0]
v_pk_add_f32 v[40:41], v[48:49], v[64:65] neg_lo:[0,1] neg_hi:[0,1]
v_pk_add_f32 v[48:49], v[48:49], v[64:65]
v_pk_add_f32 v[64:65], v[50:51], v[66:67] neg_lo:[0,1] neg_hi:[0,1]
v_pk_add_f32 v[50:51], v[50:51], v[66:67]
v_pk_mul_f32 v[66:67], v[64:65], s[54:55] op_sel:[0,0] op_sel_hi:[0,1] neg_lo:[0,0] neg_hi:[0,1]
v_pk_fma_f32 v[66:67], v[64:65], s[54:55], v[66:67] op_sel:[1,1,0] op_sel_hi:[1,0,1] neg_lo:[0,0,0] neg_hi:[0,0,0]
v_pk_add_f32 v[64:65], v[52:53], v[68:69] neg_lo:[0,1] neg_hi:[0,1]
v_pk_add_f32 v[52:53], v[52:53], v[68:69]
v_pk_mul_f32 v[68:69], v[64:65], s[62:63] op_sel:[0,0] op_sel_hi:[0,1] neg_lo:[0,0] neg_hi:[0,1]
v_pk_fma_f32 v[68:69], v[64:65], s[62:63], v[68:69] op_sel:[1,1,0] op_sel_hi:[1,0,1] neg_lo:[0,0,0] neg_hi:[0,0,0]
v_pk_add_f32 v[64:65], v[54:55], v[70:71] neg_lo:[0,1] neg_hi:[0,1]
v_pk_add_f32 v[54:55], v[54:55], v[70:71]
v_pk_mul_f32 v[70:71], v[64:65], s[54:55] op_sel:[0,1] op_sel_hi:[0,0] neg_lo:[0,0] neg_hi:[0,1]
v_pk_fma_f32 v[70:71], v[64:65], s[54:55], v[70:71] op_sel:[1,0,0] op_sel_hi:[1,1,1] neg_lo:[0,0,0] neg_hi:[0,0,0]
v_pk_add_f32 v[64:65], v[56:57], v[72:73] op_sel:[1,1] op_sel_hi:[0,0] neg_lo:[0,1] neg_hi:[1,0]
v_pk_add_f32 v[56:57], v[56:57], v[72:73]
v_pk_add_f32 v[72:73], v[58:59], v[74:75] neg_lo:[0,1] neg_hi:[0,1]
v_pk_add_f32 v[58:59], v[58:59], v[74:75]
v_pk_mul_f32 v[74:75], v[72:73], s[54:55] op_sel:[0,1] op_sel_hi:[0,0] neg_lo:[0,1] neg_hi:[0,1]
v_pk_fma_f32 v[74:75], v[72:73], s[54:55], v[74:75] op_sel:[1,0,0] op_sel_hi:[1,1,1] neg_lo:[0,0,0] neg_hi:[0,1,0]
v_pk_add_f32 v[72:73], v[60:61], v[76:77] neg_lo:[0,1] neg_hi:[0,1]
v_pk_add_f32 v[60:61], v[60:61], v[76:77]
v_pk_mul_f32 v[76:77], v[72:73], s[62:63] op_sel:[0,0] op_sel_hi:[0,1] neg_lo:[0,1] neg_hi:[0,1]
v_pk_fma_f32 v[76:77], v[72:73], s[62:63], v[76:77] op_sel:[1,1,0] op_sel_hi:[1,0,1] neg_lo:[0,0,0] neg_hi:[0,1,0]
v_pk_add_f32 v[72:73], v[62:63], v[78:79] neg_lo:[0,1] neg_hi:[0,1]
v_pk_add_f32 v[62:63], v[62:63], v[78:79]
v_pk_mul_f32 v[78:79], v[72:73], s[54:55] op_sel:[0,0] op_sel_hi:[0,1] neg_lo:[0,1] neg_hi:[0,1]
v_pk_fma_f32 v[78:79], v[72:73], s[54:55], v[78:79] op_sel:[1,1,0] op_sel_hi:[1,0,1] neg_lo:[0,0,0] neg_hi:[0,1,0]
v_pk_add_f32 v[72:73], v[16:17], v[24:25] neg_lo:[0,1] neg_hi:[0,1]
v_pk_add_f32 v[16:17], v[16:17], v[24:25]
v_pk_add_f32 v[24:25], v[18:19], v[26:27] neg_lo:[0,1] neg_hi:[0,1]
v_pk_add_f32 v[18:19], v[18:19], v[26:27]
v_pk_mul_f32 v[26:27], v[24:25], s[62:63] op_sel:[0,0] op_sel_hi:[0,1] neg_lo:[0,0] neg_hi:[0,1]
v_pk_fma_f32 v[26:27], v[24:25], s[62:63], v[26:27] op_sel:[1,1,0] op_sel_hi:[1,0,1] neg_lo:[0,0,0] neg_hi:[0,0,0]
v_pk_add_f32 v[24:25], v[20:21], v[28:29] op_sel:[1,1] op_sel_hi:[0,0] neg_lo:[0,1] neg_hi:[1,0]
v_pk_add_f32 v[20:21], v[20:21], v[28:29]
v_pk_add_f32 v[28:29], v[22:23], v[30:31] neg_lo:[0,1] neg_hi:[0,1]
v_pk_add_f32 v[22:23], v[22:23], v[30:31]
v_pk_mul_f32 v[30:31], v[28:29], s[62:63] op_sel:[0,0] op_sel_hi:[0,1] neg_lo:[0,1] neg_hi:[0,1]
v_pk_fma_f32 v[30:31], v[28:29], s[62:63], v[30:31] op_sel:[1,1,0] op_sel_hi:[1,0,1] neg_lo:[0,0,0] neg_hi:[0,1,0]
v_pk_add_f32 v[28:29], v[14:15], v[32:33] neg_lo:[0,1] neg_hi:[0,1]
v_pk_add_f32 v[14:15], v[14:15], v[32:33]
v_pk_add_f32 v[32:33], v[34:35], v[42:43] neg_lo:[0,1] neg_hi:[0,1]
v_pk_add_f32 v[34:35], v[34:35], v[42:43]
v_pk_mul_f32 v[42:43], v[32:33], s[62:63] op_sel:[0,0] op_sel_hi:[0,1] neg_lo:[0,0] neg_hi:[0,1]
v_pk_fma_f32 v[42:43], v[32:33], s[62:63], v[42:43] op_sel:[1,1,0] op_sel_hi:[1,0,1] neg_lo:[0,0,0] neg_hi:[0,0,0]
v_pk_add_f32 v[32:33], v[36:37], v[44:45] op_sel:[1,1] op_sel_hi:[0,0] neg_lo:[0,1] neg_hi:[1,0]
v_pk_add_f32 v[36:37], v[36:37], v[44:45]
v_pk_add_f32 v[44:45], v[38:39], v[46:47] neg_lo:[0,1] neg_hi:[0,1]
v_pk_add_f32 v[38:39], v[38:39], v[46:47]
v_pk_mul_f32 v[46:47], v[44:45], s[62:63] op_sel:[0,0] op_sel_hi:[0,1] neg_lo:[0,1] neg_hi:[0,1]
v_pk_fma_f32 v[46:47], v[44:45], s[62:63], v[46:47] op_sel:[1,1,0] op_sel_hi:[1,0,1] neg_lo:[0,0,0] neg_hi:[0,1,0]
v_pk_add_f32 v[44:45], v[48:49], v[56:57] neg_lo:[0,1] neg_hi:[0,1]
v_pk_add_f32 v[48:49], v[48:49], v[56:57]
v_pk_add_f32 v[56:57], v[50:51], v[58:59] neg_lo:[0,1] neg_hi:[0,1]
v_pk_add_f32 v[50:51], v[50:51], v[58:59]
v_pk_mul_f32 v[58:59], v[56:57], s[62:63] op_sel:[0,0] op_sel_hi:[0,1] neg_lo:[0,0] neg_hi:[0,1]
v_pk_fma_f32 v[58:59], v[56:57], s[62:63], v[58:59] op_sel:[1,1,0] op_sel_hi:[1,0,1] neg_lo:[0,0,0] neg_hi:[0,0,0]
v_pk_add_f32 v[56:57], v[52:53], v[60:61] op_sel:[1,1] op_sel_hi:[0,0] neg_lo:[0,1] neg_hi:[1,0]
v_pk_add_f32 v[52:53], v[52:53], v[60:61]
v_pk_add_f32 v[60:61], v[54:55], v[62:63] neg_lo:[0,1] neg_hi:[0,1]
v_pk_add_f32 v[54:55], v[54:55], v[62:63]
v_pk_mul_f32 v[62:63], v[60:61], s[62:63] op_sel:[0,0] op_sel_hi:[0,1] neg_lo:[0,1] neg_hi:[0,1]
v_pk_fma_f32 v[62:63], v[60:61], s[62:63], v[62:63] op_sel:[1,1,0] op_sel_hi:[1,0,1] neg_lo:[0,0,0] neg_hi:[0,1,0]
v_pk_add_f32 v[60:61], v[40:41], v[64:65] neg_lo:[0,1] neg_hi:[0,1]
v_pk_add_f32 v[40:41], v[40:41], v[64:65]
v_pk_add_f32 v[64:65], v[66:67], v[74:75] neg_lo:[0,1] neg_hi:[0,1]
v_pk_add_f32 v[66:67], v[66:67], v[74:75]
v_pk_mul_f32 v[74:75], v[64:65], s[62:63] op_sel:[0,0] op_sel_hi:[0,1] neg_lo:[0,0] neg_hi:[0,1]
v_pk_fma_f32 v[74:75], v[64:65], s[62:63], v[74:75] op_sel:[1,1,0] op_sel_hi:[1,0,1] neg_lo:[0,0,0] neg_hi:[0,0,0]
v_pk_add_f32 v[64:65], v[68:69], v[76:77] op_sel:[1,1] op_sel_hi:[0,0] neg_lo:[0,1] neg_hi:[1,0]
v_pk_add_f32 v[68:69], v[68:69], v[76:77]
v_pk_add_f32 v[76:77], v[70:71], v[78:79] neg_lo:[0,1] neg_hi:[0,1]
v_pk_add_f32 v[70:71], v[70:71], v[78:79]
v_pk_mul_f32 v[78:79], v[76:77], s[62:63] op_sel:[0,0] op_sel_hi:[0,1] neg_lo:[0,1] neg_hi:[0,1]
v_pk_fma_f32 v[78:79], v[76:77], s[62:63], v[78:79] op_sel:[1,1,0] op_sel_hi:[1,0,1] neg_lo:[0,0,0] neg_hi:[0,1,0]
v_pk_add_f32 v[76:77], v[16:17], v[20:21] neg_lo:[0,1] neg_hi:[0,1]
v_pk_add_f32 v[16:17], v[16:17], v[20:21]
v_pk_add_f32 v[20:21], v[18:19], v[22:23] op_sel:[1,1] op_sel_hi:[0,0] neg_lo:[0,1] neg_hi:[1,0]
v_pk_add_f32 v[18:19], v[18:19], v[22:23]
v_pk_add_f32 v[22:23], v[72:73], v[24:25] neg_lo:[0,1] neg_hi:[0,1]
v_pk_add_f32 v[72:73], v[72:73], v[24:25]
v_pk_add_f32 v[24:25], v[26:27], v[30:31] op_sel:[1,1] op_sel_hi:[0,0] neg_lo:[0,1] neg_hi:[1,0]
v_pk_add_f32 v[26:27], v[26:27], v[30:31]
v_pk_add_f32 v[30:31], v[14:15], v[36:37] neg_lo:[0,1] neg_hi:[0,1]
v_pk_add_f32 v[14:15], v[14:15], v[36:37]
v_pk_add_f32 v[36:37], v[34:35], v[38:39] op_sel:[1,1] op_sel_hi:[0,0] neg_lo:[0,1] neg_hi:[1,0]
v_pk_add_f32 v[34:35], v[34:35], v[38:39]
v_pk_add_f32 v[38:39], v[28:29], v[32:33] neg_lo:[0,1] neg_hi:[0,1]
v_pk_add_f32 v[28:29], v[28:29], v[32:33]
v_pk_add_f32 v[32:33], v[42:43], v[46:47] op_sel:[1,1] op_sel_hi:[0,0] neg_lo:[0,1] neg_hi:[1,0]
v_pk_add_f32 v[42:43], v[42:43], v[46:47]
v_pk_add_f32 v[46:47], v[48:49], v[52:53] neg_lo:[0,1] neg_hi:[0,1]
v_pk_add_f32 v[48:49], v[48:49], v[52:53]
v_pk_add_f32 v[52:53], v[50:51], v[54:55] op_sel:[1,1] op_sel_hi:[0,0] neg_lo:[0,1] neg_hi:[1,0]
v_pk_add_f32 v[50:51], v[50:51], v[54:55]
v_pk_add_f32 v[54:55], v[44:45], v[56:57] neg_lo:[0,1] neg_hi:[0,1]
v_pk_add_f32 v[44:45], v[44:45], v[56:57]
v_pk_add_f32 v[56:57], v[58:59], v[62:63] op_sel:[1,1] op_sel_hi:[0,0] neg_lo:[0,1] neg_hi:[1,0]
v_pk_add_f32 v[58:59], v[58:59], v[62:63]
v_pk_add_f32 v[62:63], v[40:41], v[68:69] neg_lo:[0,1] neg_hi:[0,1]
v_pk_add_f32 v[40:41], v[40:41], v[68:69]
v_pk_add_f32 v[68:69], v[66:67], v[70:71] op_sel:[1,1] op_sel_hi:[0,0] neg_lo:[0,1] neg_hi:[1,0]
v_pk_add_f32 v[66:67], v[66:67], v[70:71]
v_pk_add_f32 v[70:71], v[60:61], v[64:65] neg_lo:[0,1] neg_hi:[0,1]
v_pk_add_f32 v[60:61], v[60:61], v[64:65]
v_pk_add_f32 v[64:65], v[74:75], v[78:79] op_sel:[1,1] op_sel_hi:[0,0] neg_lo:[0,1] neg_hi:[1,0]
v_pk_add_f32 v[74:75], v[74:75], v[78:79]
v_pk_add_f32 v[78:79], v[16:17], v[18:19] neg_lo:[0,1] neg_hi:[0,1]
v_pk_add_f32 v[16:17], v[16:17], v[18:19]
v_pk_add_f32 v[18:19], v[76:77], v[20:21] neg_lo:[0,1] neg_hi:[0,1]
v_pk_add_f32 v[76:77], v[76:77], v[20:21]
v_pk_add_f32 v[20:21], v[72:73], v[26:27] neg_lo:[0,1] neg_hi:[0,1]
v_pk_add_f32 v[72:73], v[72:73], v[26:27]
v_pk_add_f32 v[26:27], v[22:23], v[24:25] neg_lo:[0,1] neg_hi:[0,1]
v_pk_add_f32 v[22:23], v[22:23], v[24:25]
v_pk_add_f32 v[24:25], v[14:15], v[34:35] neg_lo:[0,1] neg_hi:[0,1]
v_pk_add_f32 v[14:15], v[14:15], v[34:35]
v_pk_add_f32 v[34:35], v[30:31], v[36:37] neg_lo:[0,1] neg_hi:[0,1]
v_pk_add_f32 v[30:31], v[30:31], v[36:37]
v_pk_add_f32 v[36:37], v[28:29], v[42:43] neg_lo:[0,1] neg_hi:[0,1]
v_pk_add_f32 v[28:29], v[28:29], v[42:43]
v_pk_add_f32 v[42:43], v[38:39], v[32:33] neg_lo:[0,1] neg_hi:[0,1]
v_pk_add_f32 v[38:39], v[38:39], v[32:33]
v_pk_add_f32 v[32:33], v[48:49], v[50:51] neg_lo:[0,1] neg_hi:[0,1]
v_pk_add_f32 v[48:49], v[48:49], v[50:51]
v_pk_add_f32 v[50:51], v[46:47], v[52:53] neg_lo:[0,1] neg_hi:[0,1]
v_pk_add_f32 v[46:47], v[46:47], v[52:53]
v_pk_add_f32 v[52:53], v[44:45], v[58:59] neg_lo:[0,1] neg_hi:[0,1]
v_pk_add_f32 v[44:45], v[44:45], v[58:59]
v_pk_add_f32 v[58:59], v[54:55], v[56:57] neg_lo:[0,1] neg_hi:[0,1]
v_pk_add_f32 v[54:55], v[54:55], v[56:57]
v_pk_add_f32 v[56:57], v[40:41], v[66:67] neg_lo:[0,1] neg_hi:[0,1]
v_pk_add_f32 v[40:41], v[40:41], v[66:67]
v_pk_add_f32 v[66:67], v[62:63], v[68:69] neg_lo:[0,1] neg_hi:[0,1]
v_pk_add_f32 v[62:63], v[62:63], v[68:69]
v_pk_add_f32 v[68:69], v[60:61], v[74:75] neg_lo:[0,1] neg_hi:[0,1]
v_pk_add_f32 v[60:61], v[60:61], v[74:75]
v_pk_add_f32 v[74:75], v[70:71], v[64:65] neg_lo:[0,1] neg_hi:[0,1]
v_pk_add_f32 v[70:71], v[70:71], v[64:65]
v_pk_mul_f32 v[64:65], v[48:49], v[82:83] op_sel:[0,0] op_sel_hi:[0,1] neg_lo:[0,0] neg_hi:[0,0]
v_pk_fma_f32 v[48:49], v[48:49], v[82:83], v[64:65] op_sel:[1,1,0] op_sel_hi:[1,0,1] neg_lo:[0,1,0] neg_hi:[0,0,0]
v_pk_mul_f32 v[64:65], v[14:15], v[84:85] op_sel:[0,0] op_sel_hi:[0,1] neg_lo:[0,0] neg_hi:[0,0]
v_pk_fma_f32 v[14:15], v[14:15], v[84:85], v[64:65] op_sel:[1,1,0] op_sel_hi:[1,0,1] neg_lo:[0,1,0] neg_hi:[0,0,0]
v_pk_mul_f32 v[64:65], v[40:41], v[86:87] op_sel:[0,0] op_sel_hi:[0,1] neg_lo:[0,0] neg_hi:[0,0]
v_pk_fma_f32 v[40:41], v[40:41], v[86:87], v[64:65] op_sel:[1,1,0] op_sel_hi:[1,0,1] neg_lo:[0,1,0] neg_hi:[0,0,0]
v_pk_mul_f32 v[64:65], v[72:73], v[88:89] op_sel:[0,0] op_sel_hi:[0,1] neg_lo:[0,0] neg_hi:[0,0]
v_pk_fma_f32 v[72:73], v[72:73], v[88:89], v[64:65] op_sel:[1,1,0] op_sel_hi:[1,0,1] neg_lo:[0,1,0] neg_hi:[0,0,0]
v_pk_mul_f32 v[64:65], v[44:45], v[90:91] op_sel:[0,0] op_sel_hi:[0,1] neg_lo:[0,0] neg_hi:[0,0]
v_pk_fma_f32 v[44:45], v[44:45], v[90:91], v[64:65] op_sel:[1,1,0] op_sel_hi:[1,0,1] neg_lo:[0,1,0] neg_hi:[0,0,0]
v_pk_mul_f32 v[64:65], v[28:29], v[92:93] op_sel:[0,0] op_sel_hi:[0,1] neg_lo:[0,0] neg_hi:[0,0]
v_pk_fma_f32 v[28:29], v[28:29], v[92:93], v[64:65] op_sel:[1,1,0] op_sel_hi:[1,0,1] neg_lo:[0,1,0] neg_hi:[0,0,0]
v_pk_mul_f32 v[64:65], v[60:61], v[94:95] op_sel:[0,0] op_sel_hi:[0,1] neg_lo:[0,0] neg_hi:[0,0]
v_pk_fma_f32 v[60:61], v[60:61], v[94:95], v[64:65] op_sel:[1,1,0] op_sel_hi:[1,0,1] neg_lo:[0,1,0] neg_hi:[0,0,0]
v_pk_mul_f32 v[64:65], v[76:77], v[96:97] op_sel:[0,0] op_sel_hi:[0,1] neg_lo:[0,0] neg_hi:[0,0]
v_pk_fma_f32 v[76:77], v[76:77], v[96:97], v[64:65] op_sel:[1,1,0] op_sel_hi:[1,0,1] neg_lo:[0,1,0] neg_hi:[0,0,0]
v_pk_mul_f32 v[64:65], v[46:47], v[98:99] op_sel:[0,0] op_sel_hi:[0,1] neg_lo:[0,0] neg_hi:[0,0]
v_pk_fma_f32 v[46:47], v[46:47], v[98:99], v[64:65] op_sel:[1,1,0] op_sel_hi:[1,0,1] neg_lo:[0,1,0] neg_hi:[0,0,0]
v_pk_mul_f32 v[64:65], v[30:31], v[100:101] op_sel:[0,0] op_sel_hi:[0,1] neg_lo:[0,0] neg_hi:[0,0]
v_pk_fma_f32 v[30:31], v[30:31], v[100:101], v[64:65] op_sel:[1,1,0] op_sel_hi:[1,0,1] neg_lo:[0,1,0] neg_hi:[0,0,0]
v_pk_mul_f32 v[64:65], v[62:63], v[102:103] op_sel:[0,0] op_sel_hi:[0,1] neg_lo:[0,0] neg_hi:[0,0]
v_pk_fma_f32 v[62:63], v[62:63], v[102:103], v[64:65] op_sel:[1,1,0] op_sel_hi:[1,0,1] neg_lo:[0,1,0] neg_hi:[0,0,0]
v_pk_mul_f32 v[64:65], v[22:23], v[104:105] op_sel:[0,0] op_sel_hi:[0,1] neg_lo:[0,0] neg_hi:[0,0]
v_pk_fma_f32 v[22:23], v[22:23], v[104:105], v[64:65] op_sel:[1,1,0] op_sel_hi:[1,0,1] neg_lo:[0,1,0] neg_hi:[0,0,0]
v_pk_mul_f32 v[64:65], v[54:55], v[106:107] op_sel:[0,0] op_sel_hi:[0,1] neg_lo:[0,0] neg_hi:[0,0]
v_pk_fma_f32 v[54:55], v[54:55], v[106:107], v[64:65] op_sel:[1,1,0] op_sel_hi:[1,0,1] neg_lo:[0,1,0] neg_hi:[0,0,0]
v_pk_mul_f32 v[64:65], v[38:39], v[108:109] op_sel:[0,0] op_sel_hi:[0,1] neg_lo:[0,0] neg_hi:[0,0]
v_pk_fma_f32 v[38:39], v[38:39], v[108:109], v[64:65] op_sel:[1,1,0] op_sel_hi:[1,0,1] neg_lo:[0,1,0] neg_hi:[0,0,0]
v_pk_mul_f32 v[64:65], v[70:71], v[110:111] op_sel:[0,0] op_sel_hi:[0,1] neg_lo:[0,0] neg_hi:[0,0]
v_pk_fma_f32 v[70:71], v[70:71], v[110:111], v[64:65] op_sel:[1,1,0] op_sel_hi:[1,0,1] neg_lo:[0,1,0] neg_hi:[0,0,0]
v_pk_mul_f32 v[64:65], v[78:79], v[112:113] op_sel:[0,0] op_sel_hi:[0,1] neg_lo:[0,0] neg_hi:[0,0]
v_pk_fma_f32 v[78:79], v[78:79], v[112:113], v[64:65] op_sel:[1,1,0] op_sel_hi:[1,0,1] neg_lo:[0,1,0] neg_hi:[0,0,0]
v_pk_mul_f32 v[64:65], v[32:33], v[114:115] op_sel:[0,0] op_sel_hi:[0,1] neg_lo:[0,0] neg_hi:[0,0]
v_pk_fma_f32 v[32:33], v[32:33], v[114:115], v[64:65] op_sel:[1,1,0] op_sel_hi:[1,0,1] neg_lo:[0,1,0] neg_hi:[0,0,0]
v_pk_mul_f32 v[64:65], v[24:25], v[116:117] op_sel:[0,0] op_sel_hi:[0,1] neg_lo:[0,0] neg_hi:[0,0]
v_pk_fma_f32 v[24:25], v[24:25], v[116:117], v[64:65] op_sel:[1,1,0] op_sel_hi:[1,0,1] neg_lo:[0,1,0] neg_hi:[0,0,0]
v_pk_mul_f32 v[64:65], v[56:57], v[118:119] op_sel:[0,0] op_sel_hi:[0,1] neg_lo:[0,0] neg_hi:[0,0]
v_pk_fma_f32 v[56:57], v[56:57], v[118:119], v[64:65] op_sel:[1,1,0] op_sel_hi:[1,0,1] neg_lo:[0,1,0] neg_hi:[0,0,0]
v_pk_mul_f32 v[64:65], v[20:21], v[120:121] op_sel:[0,0] op_sel_hi:[0,1] neg_lo:[0,0] neg_hi:[0,0]
v_pk_fma_f32 v[20:21], v[20:21], v[120:121], v[64:65] op_sel:[1,1,0] op_sel_hi:[1,0,1] neg_lo:[0,1,0] neg_hi:[0,0,0]
v_pk_mul_f32 v[64:65], v[52:53], v[122:123] op_sel:[0,0] op_sel_hi:[0,1] neg_lo:[0,0] neg_hi:[0,0]
v_pk_fma_f32 v[52:53], v[52:53], v[122:123], v[64:65] op_sel:[1,1,0] op_sel_hi:[1,0,1] neg_lo:[0,1,0] neg_hi:[0,0,0]
v_pk_mul_f32 v[64:65], v[36:37], v[124:125] op_sel:[0,0] op_sel_hi:[0,1] neg_lo:[0,0] neg_hi:[0,0]
v_pk_fma_f32 v[36:37], v[36:37], v[124:125], v[64:65] op_sel:[1,1,0] op_sel_hi:[1,0,1] neg_lo:[0,1,0] neg_hi:[0,0,0]
v_pk_mul_f32 v[64:65], v[68:69], v[126:127] op_sel:[0,0] op_sel_hi:[0,1] neg_lo:[0,0] neg_hi:[0,0]
v_pk_fma_f32 v[68:69], v[68:69], v[126:127], v[64:65] op_sel:[1,1,0] op_sel_hi:[1,0,1] neg_lo:[0,1,0] neg_hi:[0,0,0]
v_pk_mul_f32 v[64:65], v[18:19], v[128:129] op_sel:[0,0] op_sel_hi:[0,1] neg_lo:[0,0] neg_hi:[0,0]
v_pk_fma_f32 v[18:19], v[18:19], v[128:129], v[64:65] op_sel:[1,1,0] op_sel_hi:[1,0,1] neg_lo:[0,1,0] neg_hi:[0,0,0]
v_pk_mul_f32 v[64:65], v[50:51], v[130:131] op_sel:[0,0] op_sel_hi:[0,1] neg_lo:[0,0] neg_hi:[0,0]
v_pk_fma_f32 v[50:51], v[50:51], v[130:131], v[64:65] op_sel:[1,1,0] op_sel_hi:[1,0,1] neg_lo:[0,1,0] neg_hi:[0,0,0]
v_pk_mul_f32 v[64:65], v[34:35], v[132:133] op_sel:[0,0] op_sel_hi:[0,1] neg_lo:[0,0] neg_hi:[0,0]
v_pk_fma_f32 v[34:35], v[34:35], v[132:133], v[64:65] op_sel:[1,1,0] op_sel_hi:[1,0,1] neg_lo:[0,1,0] neg_hi:[0,0,0]
v_pk_mul_f32 v[64:65], v[66:67], v[134:135] op_sel:[0,0] op_sel_hi:[0,1] neg_lo:[0,0] neg_hi:[0,0]
v_pk_fma_f32 v[66:67], v[66:67], v[134:135], v[64:65] op_sel:[1,1,0] op_sel_hi:[1,0,1] neg_lo:[0,1,0] neg_hi:[0,0,0]
v_pk_mul_f32 v[64:65], v[26:27], v[136:137] op_sel:[0,0] op_sel_hi:[0,1] neg_lo:[0,0] neg_hi:[0,0]
v_pk_fma_f32 v[26:27], v[26:27], v[136:137], v[64:65] op_sel:[1,1,0] op_sel_hi:[1,0,1] neg_lo:[0,1,0] neg_hi:[0,0,0]
v_pk_mul_f32 v[64:65], v[58:59], v[138:139] op_sel:[0,0] op_sel_hi:[0,1] neg_lo:[0,0] neg_hi:[0,0]
v_pk_fma_f32 v[58:59], v[58:59], v[138:139], v[64:65] op_sel:[1,1,0] op_sel_hi:[1,0,1] neg_lo:[0,1,0] neg_hi:[0,0,0]
v_pk_mul_f32 v[64:65], v[42:43], v[140:141] op_sel:[0,0] op_sel_hi:[0,1] neg_lo:[0,0] neg_hi:[0,0]
v_pk_fma_f32 v[42:43], v[42:43], v[140:141], v[64:65] op_sel:[1,1,0] op_sel_hi:[1,0,1] neg_lo:[0,1,0] neg_hi:[0,0,0]
v_pk_mul_f32 v[64:65], v[74:75], v[142:143] op_sel:[0,0] op_sel_hi:[0,1] neg_lo:[0,0] neg_hi:[0,0]
v_pk_fma_f32 v[74:75], v[74:75], v[142:143], v[64:65] op_sel:[1,1,0] op_sel_hi:[1,0,1] neg_lo:[0,1,0] neg_hi:[0,0,0]
s_barrier
ds_write_b64 v4, v[16:17] offset:0
ds_write_b64 v4, v[48:49] offset:264
ds_write_b64 v4, v[14:15] offset:528
ds_write_b64 v4, v[40:41] offset:792
ds_write_b64 v4, v[72:73] offset:1056
ds_write_b64 v4, v[44:45] offset:1320
ds_write_b64 v4, v[28:29] offset:1584
ds_write_b64 v4, v[60:61] offset:1848
ds_write_b64 v4, v[76:77] offset:2112
ds_write_b64 v4, v[46:47] offset:2376
ds_write_b64 v4, v[30:31] offset:2640
ds_write_b64 v4, v[62:63] offset:2904
ds_write_b64 v4, v[22:23] offset:3168
ds_write_b64 v4, v[54:55] offset:3432
ds_write_b64 v4, v[38:39] offset:3696
ds_write_b64 v4, v[70:71] offset:3960
ds_write_b64 v4, v[78:79] offset:4224
ds_write_b64 v4, v[32:33] offset:4488
ds_write_b64 v4, v[24:25] offset:4752
ds_write_b64 v4, v[56:57] offset:5016
ds_write_b64 v4, v[20:21] offset:5280
ds_write_b64 v4, v[52:53] offset:5544
ds_write_b64 v4, v[36:37] offset:5808
ds_write_b64 v4, v[68:69] offset:6072
ds_write_b64 v4, v[18:19] offset:6336
ds_write_b64 v4, v[50:51] offset:6600
ds_write_b64 v4, v[34:35] offset:6864
ds_write_b64 v4, v[66:67] offset:7128
ds_write_b64 v4, v[26:27] offset:7392
ds_write_b64 v4, v[58:59] offset:7656
ds_write_b64 v4, v[42:43] offset:7920
ds_write_b64 v4, v[74:75] offset:8184
s_waitcnt lgkmcnt(0)
ds_read_b64 v[16:17], v5 offset:0
ds_read_b64 v[48:49], v5 offset:128
ds_read_b64 v[18:19], v5 offset:8
ds_read_b64 v[50:51], v5 offset:136
ds_read_b64 v[20:21], v5 offset:16
ds_read_b64 v[52:53], v5 offset:144
ds_read_b64 v[22:23], v5 offset:24
ds_read_b64 v[54:55], v5 offset:152
ds_read_b64 v[24:25], v5 offset:32
ds_read_b64 v[56:57], v5 offset:160
ds_read_b64 v[26:27], v5 offset:40
ds_read_b64 v[58:59], v5 offset:168
ds_read_b64 v[28:29], v5 offset:48
ds_read_b64 v[60:61], v5 offset:176
ds_read_b64 v[30:31], v5 offset:56
ds_read_b64 v[62:63], v5 offset:184
ds_read_b64 v[32:33], v5 offset:64
ds_read_b64 v[64:65], v5 offset:192
ds_read_b64 v[34:35], v5 offset:72
ds_read_b64 v[66:67], v5 offset:200
ds_read_b64 v[36:37], v5 offset:80
ds_read_b64 v[68:69], v5 offset:208
ds_read_b64 v[38:39], v5 offset:88
ds_read_b64 v[70:71], v5 offset:216
ds_read_b64 v[40:41], v5 offset:96
ds_read_b64 v[72:73], v5 offset:224
ds_read_b64 v[42:43], v5 offset:104
ds_read_b64 v[74:75], v5 offset:232
ds_read_b64 v[44:45], v5 offset:112
ds_read_b64 v[76:77], v5 offset:240
ds_read_b64 v[46:47], v5 offset:120
ds_read_b64 v[78:79], v5 offset:248
s_waitcnt lgkmcnt(0)
v_pk_add_f32 v[14:15], v[16:17], v[48:49] neg_lo:[0,1] neg_hi:[0,1]
v_pk_add_f32 v[16:17], v[16:17], v[48:49]
v_pk_add_f32 v[48:49], v[18:19], v[50:51] neg_lo:[0,1] neg_hi:[0,1]
v_pk_add_f32 v[18:19], v[18:19], v[50:51]
v_pk_mul_f32 v[50:51], v[48:49], s[50:51] op_sel:[0,0] op_sel_hi:[0,1] neg_lo:[0,0] neg_hi:[0,1]
v_pk_fma_f32 v[50:51], v[48:49], s[50:51], v[50:51] op_sel:[1,1,0] op_sel_hi:[1,0,1] neg_lo:[0,0,0] neg_hi:[0,0,0]
v_pk_add_f32 v[48:49], v[20:21], v[52:53] neg_lo:[0,1] neg_hi:[0,1]
v_pk_add_f32 v[20:21], v[20:21], v[52:53]
v_pk_mul_f32 v[52:53], v[48:49], s[54:55] op_sel:[0,0] op_sel_hi:[0,1] neg_lo:[0,0] neg_hi:[0,1]
v_pk_fma_f32 v[52:53], v[48:49], s[54:55], v[52:53] op_sel:[1,1,0] op_sel_hi:[1,0,1] neg_lo:[0,0,0] neg_hi:[0,0,0]
v_pk_add_f32 v[48:49], v[22:23], v[54:55] neg_lo:[0,1] neg_hi:[0,1]
v_pk_add_f32 v[22:23], v[22:23], v[54:55]
v_pk_mul_f32 v[54:55], v[48:49], s[58:59] op_sel:[0,0] op_sel_hi:[0,1] neg_lo:[0,0] neg_hi:[0,1]
v_pk_fma_f32 v[54:55], v[48:49], s[58:59], v[54:55] op_sel:[1,1,0] op_sel_hi:[1,0,1] neg_lo:[0,0,0] neg_hi:[0,0,0]
v_pk_add_f32 v[48:49], v[24:25], v[56:57] neg_lo:[0,1] neg_hi:[0,1]
v_pk_add_f32 v[24:25], v[24:25], v[56:57]
v_pk_mul_f32 v[56:57], v[48:49], s[62:63] op_sel:[0,0] op_sel_hi:[0,1] neg_lo:[0,0] neg_hi:[0,1]
v_pk_fma_f32 v[56:57], v[48:49], s[62:63], v[56:57] op_sel:[1,1,0] op_sel_hi:[1,0,1] neg_lo:[0,0,0] neg_hi:[0,0,0]
v_pk_add_f32 v[48:49], v[26:27], v[58:59] neg_lo:[0,1] neg_hi:[0,1]
v_pk_add_f32 v[26:27], v[26:27], v[58:59]
v_pk_mul_f32 v[58:59], v[48:49], s[58:59] op_sel:[0,1] op_sel_hi:[0,0] neg_lo:[0,0] neg_hi:[0,1]
v_pk_fma_f32 v[58:59], v[48:49], s[58:59], v[58:59] op_sel:[1,0,0] op_sel_hi:[1,1,1] neg_lo:[0,0,0] neg_hi:[0,0,0]
v_pk_add_f32 v[48:49], v[28:29], v[60:61] neg_lo:[0,1] neg_hi:[0,1]
v_pk_add_f32 v[28:29], v[28:29], v[60:61]
v_pk_mul_f32 v[60:61], v[48:49], s[54:55] op_sel:[0,1] op_sel_hi:[0,0] neg_lo:[0,0] neg_hi:[0,1]
v_pk_fma_f32 v[60:61], v[48:49], s[54:55], v[60:61] op_sel:[1,0,0] op_sel_hi:[1,1,1] neg_lo:[0,0,0] neg_hi:[0,0,0]
v_pk_add_f32 v[48:49], v[30:31], v[62:63] neg_lo:[0,1] neg_hi:[0,1]
v_pk_add_f32 v[30:31], v[30:31], v[62:63]
v_pk_mul_f32 v[62:63], v[48:49], s[50:51] op_sel:[0,1] op_sel_hi:[0,0] neg_lo:[0,0] neg_hi:[0,1]
v_pk_fma_f32 v[62:63], v[48:49], s[50:51], v[62:63] op_sel:[1,0,0] op_sel_hi:[1,1,1] neg_lo:[0,0,0] neg_hi:[0,0,0]
v_pk_add_f32 v[48:49], v[32:33], v[64:65] op_sel:[1,1] op_sel_hi:[0,0] neg_lo:[0,1] neg_hi:[1,0]
v_pk_add_f32 v[32:33], v[32:33], v[64:65]
v_pk_add_f32 v[64:65], v[34:35], v[66:67] neg_lo:[0,1] neg_hi:[0,1]
v_pk_add_f32 v[34:35], v[34:35], v[66:67]
v_pk_mul_f32 v[66:67], v[64:65], s[50:51] op_sel:[0,1] op_sel_hi:[0,0] neg_lo:[0,1] neg_hi:[0,1]
v_pk_fma_f32 v[66:67], v[64:65], s[50:51], v[66:67] op_sel:[1,0,0] op_sel_hi:[1,1,1] neg_lo:[0,0,0] neg_hi:[0,1,0]
v_pk_add_f32 v[64:65], v[36:37], v[68:69] neg_lo:[0,1] neg_hi:[0,1]
v_pk_add_f32 v[36:37], v[36:37], v[68:69]
v_pk_mul_f32 v[68:69], v[64:65], s[54:55] op_sel:[0,1] op_sel_hi:[0,0] neg_lo:[0,1] neg_hi:[0,1]
v_pk_fma_f32 v[68:69], v[64:65], s[54:55], v[68:69] op_sel:[1,0,0] op_sel_hi:[1,1,1] neg_lo:[0,0,0] neg_hi:[0,1,0]
v_pk_add_f32 v[64:65], v[38:39], v[70:71] neg_lo:[0,1] neg_hi:[0,1]
v_pk_add_f32 v[38:39], v[38:39], v[70:71]
v_pk_mul_f32 v[70:71], v[64:65], s[58:59] op_sel:[0,1] op_sel_hi:[0,0] neg_lo:[0,1] neg_hi:[0,1]
v_pk_fma_f32 v[70:71], v[64:65], s[58:59], v[70:71] op_sel:[1,0,0] op_sel_hi:[1,1,1] neg_lo:[0,0,0] neg_hi:[0,1,0]
v_pk_add_f32 v[64:65], v[40:41], v[72:73] neg_lo:[0,1] neg_hi:[0,1]
v_pk_add_f32 v[40:41], v[40:41], v[72:73]
v_pk_mul_f32 v[72:73], v[64:65], s[62:63] op_sel:[0,0] op_sel_hi:[0,1] neg_lo:[0,1] neg_hi:[0,1]
v_pk_fma_f32 v[72:73], v[64:65], s[62:63], v[72:73] op_sel:[1,1,0] op_sel_hi:[1,0,1] neg_lo:[0,0,0] neg_hi:[0,1,0]
v_pk_add_f32 v[64:65], v[42:43], v[74:75] neg_lo:[0,1] neg_hi:[0,1]
v_pk_add_f32 v[42:43], v[42:43], v[74:75]
v_pk_mul_f32 v[74:75], v[64:65], s[58:59] op_sel:[0,0] op_sel_hi:[0,1] neg_lo:[0,1] neg_hi:[0,1]
v_pk_fma_f32 v[74:75], v[64:65], s[58:59], v[74:75] op_sel:[1,1,0] op_sel_hi:[1,0,1] neg_lo:[0,0,0] neg_hi:[0,1,0]
v_pk_add_f32 v[64:65], v[44:45], v[76:77] neg_lo:[0,1] neg_hi:[0,1]
v_pk_add_f32 v[44:45], v[44:45], v[76:77]
v_pk_mul_f32 v[76:77], v[64:65], s[54:55] op_sel:[0,0] op_sel_hi:[0,1] neg_lo:[0,1] neg_hi:[0,1]
v_pk_fma_f32 v[76:77], v[64:65], s[54:55], v[76:77] op_sel:[1,1,0] op_sel_hi:[1,0,1] neg_lo:[0,0,0] neg_hi:[0,1,0]
v_pk_add_f32 v[64:65], v[46:47], v[78:79] neg_lo:[0,1] neg_hi:[0,1]
v_pk_add_f32 v[46:47], v[46:47], v[78:79]
v_pk_mul_f32 v[78:79], v[64:65], s[50:51] op_sel:[0,0] op_sel_hi:[0,1] neg_lo:[0,1] neg_hi:[0,1]
v_pk_fma_f32 v[78:79], v[64:65], s[50:51], v[78:79] op_sel:[1,1,0] op_sel_hi:[1,0,1] neg_lo:[0,0,0] neg_hi:[0,1,0]
v_pk_add_f32 v[64:65], v[16:17], v[32:33] neg_lo:[0,1] neg_hi:[0,1]
v_pk_add_f32 v[16:17], v[16:17], v[32:33]
v_pk_add_f32 v[32:33], v[18:19], v[34:35] neg_lo:[0,1] neg_hi:[0,1]
v_pk_add_f32 v[18:19], v[18:19], v[34:35]
v_pk_mul_f32 v[34:35], v[32:33], s[54:55] op_sel:[0,0] op_sel_hi:[0,1] neg_lo:[0,0] neg_hi:[0,1]
v_pk_fma_f32 v[34:35], v[32:33], s[54:55], v[34:35] op_sel:[1,1,0] op_sel_hi:[1,0,1] neg_lo:[0,0,0] neg_hi:[0,0,0]
v_pk_add_f32 v[32:33], v[20:21], v[36:37] neg_lo:[0,1] neg_hi:[0,1]
v_pk_add_f32 v[20:21], v[20:21], v[36:37]
v_pk_mul_f32 v[36:37], v[32:33], s[62:63] op_sel:[0,0] op_sel_hi:[0,1] neg_lo:[0,0] neg_hi:[0,1]
v_pk_fma_f32 v[36:37], v[32:33], s[62:63], v[36:37] op_sel:[1,1,0] op_sel_hi:[1,0,1] neg_lo:[0,0,0] neg_hi:[0,0,0]
v_pk_add_f32 v[32:33], v[22:23], v[38:39] neg_lo:[0,1] neg_hi:[0,1]
v_pk_add_f32 v[22:23], v[22:23], v[38:39]
v_pk_mul_f32 v[38:39], v[32:33], s[54:55] op_sel:[0,1] op_sel_hi:[0,0] neg_lo:[0,0] neg_hi:[0,1]
v_pk_fma_f32 v[38:39], v[32:33], s[54:55], v[38:39] op_sel:[1,0,0] op_sel_hi:[1,1,1] neg_lo:[0,0,0] neg_hi:[0,0,0]
v_pk_add_f32 v[32:33], v[24:25], v[40:41] op_sel:[1,1] op_sel_hi:[0,0] neg_lo:[0,1] neg_hi:[1,0]
v_pk_add_f32 v[24:25], v[24:25], v[40:41]
v_pk_add_f32 v[40:41], v[26:27], v[42:43] neg_lo:[0,1] neg_hi:[0,1]
v_pk_add_f32 v[26:27], v[26:27], v[42:43]
v_pk_mul_f32 v[42:43], v[40:41], s[54:55] op_sel:[0,1] op_sel_hi:[0,0] neg_lo:[0,1] neg_hi:[0,1]
v_pk_fma_f32 v[42:43], v[40:41], s[54:55], v[42:43] op_sel:[1,0,0] op_sel_hi:[1,1,1] neg_lo:[0,0,0] neg_hi:[0,1,0]
v_pk_add_f32 v[40:41], v[28:29], v[44:45] neg_lo:[0,1] neg_hi:[0,1]
v_pk_add_f32 v[28:29], v[28:29], v[44:45]
v_pk_mul_f32 v[44:45], v[40:41], s[62:63] op_sel:[0,0] op_sel_hi:[0,1] neg_lo:[0,1] neg_hi:[0,1]
v_pk_fma_f32 v[44:45], v[40:41], s[62:63], v[44:45] op_sel:[1,1,0] op_sel_hi:[1,0,1] neg_lo:[0,0,0] neg_hi:[0,1,0]
v_pk_add_f32 v[40:41], v[30:31], v[46:47] neg_lo:[0,1] neg_hi:[0,1]
v_pk_add_f32 v[30:31], v[30:31], v[46:47]
v_pk_mul_f32 v[46:47], v[40:41], s[54:55] op_sel:[0,0] op_sel_hi:[0,1] neg_lo:[0,1] neg_hi:[0,1]
v_pk_fma_f32 v[46:47], v[40:41], s[54:55], v[46:47] op_sel:[1,1,0] op_sel_hi:[1,0,1] neg_lo:[0,0,0] neg_hi:[0,1,0]
v_pk_add_f32 v[40:41], v[14:15], v[48:49] neg_lo:[0,1] neg_hi:[0,1]
v_pk_add_f32 v[14:15], v[14:15], v[48:49]
v_pk_add_f32 v[48:49], v[50:51], v[66:67] neg_lo:[0,1] neg_hi:[0,1]
v_pk_add_f32 v[50:51], v[50:51], v[66:67]
v_pk_mul_f32 v[66:67], v[48:49], s[54:55] op_sel:[0,0] op_sel_hi:[0,1] neg_lo:[0,0] neg_hi:[0,1]
v_pk_fma_f32 v[66:67], v[48:49], s[54:55], v[66:67] op_sel:[1,1,0] op_sel_hi:[1,0,1] neg_lo:[0,0,0] neg_hi:[0,0,0]
v_pk_add_f32 v[48:49], v[52:53], v[68:69] neg_lo:[0,1] neg_hi:[0,1]
v_pk_add_f32 v[52:53], v[52:53], v[68:69]
v_pk_mul_f32 v[68:69], v[48:49], s[62:63] op_sel:[0,0] op_sel_hi:[0,1] neg_lo:[0,0] neg_hi:[0,1]
v_pk_fma_f32 v[68:69], v[48:49], s[62:63], v[68:69] op_sel:[1,1,0] op_sel_hi:[1,0,1] neg_lo:[0,0,0] neg_hi:[0,0,0]
v_pk_add_f32 v[48:49], v[54:55], v[70:71] neg_lo:[0,1] neg_hi:[0,1]
v_pk_add_f32 v[54:55], v[54:55], v[70:71]
v_pk_mul_f32 v[70:71], v[48:49], s[54:55] op_sel:[0,1] op_sel_hi:[0,0] neg_lo:[0,0] neg_hi:[0,1]
v_pk_fma_f32 v[70:71], v[48:49], s[54:55], v[70:71] op_sel:[1,0,0] op_sel_hi:[1,1,1] neg_lo:[0,0,0] neg_hi:[0,0,0]
v_pk_add_f32 v[48:49], v[56:57], v[72:73] op_sel:[1,1] op_sel_hi:[0,0] neg_lo:[0,1] neg_hi:[1,0]
v_pk_add_f32 v[56:57], v[56:57], v[72:73]
v_pk_add_f32 v[72:73], v[58:59], v[74:75] neg_lo:[0,1] neg_hi:[0,1]
v_pk_add_f32 v[58:59], v[58:59], v[74:75]
v_pk_mul_f32 v[74:75], v[72:73], s[54:55] op_sel:[0,1] op_sel_hi:[0,0] neg_lo:[0,1] neg_hi:[0,1]
v_pk_fma_f32 v[74:75], v[72:73], s[54:55], v[74:75] op_sel:[1,0,0] op_sel_hi:[1,1,1] neg_lo:[0,0,0] neg_hi:[0,1,0]
v_pk_add_f32 v[72:73], v[60:61], v[76:77] neg_lo:[0,1] neg_hi:[0,1]
v_pk_add_f32 v[60:61], v[60:61], v[76:77]
v_pk_mul_f32 v[76:77], v[72:73], s[62:63] op_sel:[0,0] op_sel_hi:[0,1] neg_lo:[0,1] neg_hi:[0,1]
v_pk_fma_f32 v[76:77], v[72:73], s[62:63], v[76:77] op_sel:[1,1,0] op_sel_hi:[1,0,1] neg_lo:[0,0,0] neg_hi:[0,1,0]
v_pk_add_f32 v[72:73], v[62:63], v[78:79] neg_lo:[0,1] neg_hi:[0,1]
v_pk_add_f32 v[62:63], v[62:63], v[78:79]
v_pk_mul_f32 v[78:79], v[72:73], s[54:55] op_sel:[0,0] op_sel_hi:[0,1] neg_lo:[0,1] neg_hi:[0,1]
v_pk_fma_f32 v[78:79], v[72:73], s[54:55], v[78:79] op_sel:[1,1,0] op_sel_hi:[1,0,1] neg_lo:[0,0,0] neg_hi:[0,1,0]
v_pk_add_f32 v[72:73], v[16:17], v[24:25] neg_lo:[0,1] neg_hi:[0,1]
v_pk_add_f32 v[16:17], v[16:17], v[24:25]
v_pk_add_f32 v[24:25], v[18:19], v[26:27] neg_lo:[0,1] neg_hi:[0,1]
v_pk_add_f32 v[18:19], v[18:19], v[26:27]
v_pk_mul_f32 v[26:27], v[24:25], s[62:63] op_sel:[0,0] op_sel_hi:[0,1] neg_lo:[0,0] neg_hi:[0,1]
v_pk_fma_f32 v[26:27], v[24:25], s[62:63], v[26:27] op_sel:[1,1,0] op_sel_hi:[1,0,1] neg_lo:[0,0,0] neg_hi:[0,0,0]
v_pk_add_f32 v[24:25], v[20:21], v[28:29] op_sel:[1,1] op_sel_hi:[0,0] neg_lo:[0,1] neg_hi:[1,0]
v_pk_add_f32 v[20:21], v[20:21], v[28:29]
v_pk_add_f32 v[28:29], v[22:23], v[30:31] neg_lo:[0,1] neg_hi:[0,1]
v_pk_add_f32 v[22:23], v[22:23], v[30:31]
v_pk_mul_f32 v[30:31], v[28:29], s[62:63] op_sel:[0,0] op_sel_hi:[0,1] neg_lo:[0,1] neg_hi:[0,1]
v_pk_fma_f32 v[30:31], v[28:29], s[62:63], v[30:31] op_sel:[1,1,0] op_sel_hi:[1,0,1] neg_lo:[0,0,0] neg_hi:[0,1,0]
v_pk_add_f32 v[28:29], v[64:65], v[32:33] neg_lo:[0,1] neg_hi:[0,1]
v_pk_add_f32 v[64:65], v[64:65], v[32:33]
v_pk_add_f32 v[32:33], v[34:35], v[42:43] neg_lo:[0,1] neg_hi:[0,1]
v_pk_add_f32 v[34:35], v[34:35], v[42:43]
v_pk_mul_f32 v[42:43], v[32:33], s[62:63] op_sel:[0,0] op_sel_hi:[0,1] neg_lo:[0,0] neg_hi:[0,1]
v_pk_fma_f32 v[42:43], v[32:33], s[62:63], v[42:43] op_sel:[1,1,0] op_sel_hi:[1,0,1] neg_lo:[0,0,0] neg_hi:[0,0,0]
v_pk_add_f32 v[32:33], v[36:37], v[44:45] op_sel:[1,1] op_sel_hi:[0,0] neg_lo:[0,1] neg_hi:[1,0]
v_pk_add_f32 v[36:37], v[36:37], v[44:45]
v_pk_add_f32 v[44:45], v[38:39], v[46:47] neg_lo:[0,1] neg_hi:[0,1]
v_pk_add_f32 v[38:39], v[38:39], v[46:47]
v_pk_mul_f32 v[46:47], v[44:45], s[62:63] op_sel:[0,0] op_sel_hi:[0,1] neg_lo:[0,1] neg_hi:[0,1]
v_pk_fma_f32 v[46:47], v[44:45], s[62:63], v[46:47] op_sel:[1,1,0] op_sel_hi:[1,0,1] neg_lo:[0,0,0] neg_hi:[0,1,0]
v_pk_add_f32 v[44:45], v[14:15], v[56:57] neg_lo:[0,1] neg_hi:[0,1]
v_pk_add_f32 v[14:15], v[14:15], v[56:57]
v_pk_add_f32 v[56:57], v[50:51], v[58:59] neg_lo:[0,1] neg_hi:[0,1]
v_pk_add_f32 v[50:51], v[50:51], v[58:59]
v_pk_mul_f32 v[58:59], v[56:57], s[62:63] op_sel:[0,0] op_sel_hi:[0,1] neg_lo:[0,0] neg_hi:[0,1]
v_pk_fma_f32 v[58:59], v[56:57], s[62:63], v[58:59] op_sel:[1,1,0] op_sel_hi:[1,0,1] neg_lo:[0,0,0] neg_hi:[0,0,0]
v_pk_add_f32 v[56:57], v[52:53], v[60:61] op_sel:[1,1] op_sel_hi:[0,0] neg_lo:[0,1] neg_hi:[1,0]
v_pk_add_f32 v[52:53], v[52:53], v[60:61]
v_pk_add_f32 v[60:61], v[54:55], v[62:63] neg_lo:[0,1] neg_hi:[0,1]
v_pk_add_f32 v[54:55], v[54:55], v[62:63]
v_pk_mul_f32 v[62:63], v[60:61], s[62:63] op_sel:[0,0] op_sel_hi:[0,1] neg_lo:[0,1] neg_hi:[0,1]
v_pk_fma_f32 v[62:63], v[60:61], s[62:63], v[62:63] op_sel:[1,1,0] op_sel_hi:[1,0,1] neg_lo:[0,0,0] neg_hi:[0,1,0]
v_pk_add_f32 v[60:61], v[40:41], v[48:49] neg_lo:[0,1] neg_hi:[0,1]
v_pk_add_f32 v[40:41], v[40:41], v[48:49]
v_pk_add_f32 v[48:49], v[66:67], v[74:75] neg_lo:[0,1] neg_hi:[0,1]
v_pk_add_f32 v[66:67], v[66:67], v[74:75]
v_pk_mul_f32 v[74:75], v[48:49], s[62:63] op_sel:[0,0] op_sel_hi:[0,1] neg_lo:[0,0] neg_hi:[0,1]
v_pk_fma_f32 v[74:75], v[48:49], s[62:63], v[74:75] op_sel:[1,1,0] op_sel_hi:[1,0,1] neg_lo:[0,0,0] neg_hi:[0,0,0]
v_pk_add_f32 v[48:49], v[68:69], v[76:77] op_sel:[1,1] op_sel_hi:[0,0] neg_lo:[0,1] neg_hi:[1,0]
v_pk_add_f32 v[68:69], v[68:69], v[76:77]
v_pk_add_f32 v[76:77], v[70:71], v[78:79] neg_lo:[0,1] neg_hi:[0,1]
v_pk_add_f32 v[70:71], v[70:71], v[78:79]
v_pk_mul_f32 v[78:79], v[76:77], s[62:63] op_sel:[0,0] op_sel_hi:[0,1] neg_lo:[0,1] neg_hi:[0,1]
v_pk_fma_f32 v[78:79], v[76:77], s[62:63], v[78:79] op_sel:[1,1,0] op_sel_hi:[1,0,1] neg_lo:[0,0,0] neg_hi:[0,1,0]
v_pk_add_f32 v[76:77], v[16:17], v[20:21] neg_lo:[0,1] neg_hi:[0,1]
v_pk_add_f32 v[16:17], v[16:17], v[20:21]
v_pk_add_f32 v[20:21], v[18:19], v[22:23] op_sel:[1,1] op_sel_hi:[0,0] neg_lo:[0,1] neg_hi:[1,0]
v_pk_add_f32 v[18:19], v[18:19], v[22:23]
v_pk_add_f32 v[22:23], v[72:73], v[24:25] neg_lo:[0,1] neg_hi:[0,1]
v_pk_add_f32 v[72:73], v[72:73], v[24:25]
v_pk_add_f32 v[24:25], v[26:27], v[30:31] op_sel:[1,1] op_sel_hi:[0,0] neg_lo:[0,1] neg_hi:[1,0]
v_pk_add_f32 v[26:27], v[26:27], v[30:31]
v_pk_add_f32 v[30:31], v[64:65], v[36:37] neg_lo:[0,1] neg_hi:[0,1]
v_pk_add_f32 v[64:65], v[64:65], v[36:37]
v_pk_add_f32 v[36:37], v[34:35], v[38:39] op_sel:[1,1] op_sel_hi:[0,0] neg_lo:[0,1] neg_hi:[1,0]
v_pk_add_f32 v[34:35], v[34:35], v[38:39]
v_pk_add_f32 v[38:39], v[28:29], v[32:33] neg_lo:[0,1] neg_hi:[0,1]
v_pk_add_f32 v[28:29], v[28:29], v[32:33]
v_pk_add_f32 v[32:33], v[42:43], v[46:47] op_sel:[1,1] op_sel_hi:[0,0] neg_lo:[0,1] neg_hi:[1,0]
v_pk_add_f32 v[42:43], v[42:43], v[46:47]
v_pk_add_f32 v[46:47], v[14:15], v[52:53] neg_lo:[0,1] neg_hi:[0,1]
v_pk_add_f32 v[14:15], v[14:15], v[52:53]
v_pk_add_f32 v[52:53], v[50:51], v[54:55] op_sel:[1,1] op_sel_hi:[0,0] neg_lo:[0,1] neg_hi:[1,0]
v_pk_add_f32 v[50:51], v[50:51], v[54:55]
v_pk_add_f32 v[54:55], v[44:45], v[56:57] neg_lo:[0,1] neg_hi:[0,1]
v_pk_add_f32 v[44:45], v[44:45], v[56:57]
v_pk_add_f32 v[56:57], v[58:59], v[62:63] op_sel:[1,1] op_sel_hi:[0,0] neg_lo:[0,1] neg_hi:[1,0]
v_pk_add_f32 v[58:59], v[58:59], v[62:63]
v_pk_add_f32 v[62:63], v[40:41], v[68:69] neg_lo:[0,1] neg_hi:[0,1]
v_pk_add_f32 v[40:41], v[40:41], v[68:69]
v_pk_add_f32 v[68:69], v[66:67], v[70:71] op_sel:[1,1] op_sel_hi:[0,0] neg_lo:[0,1] neg_hi:[1,0]
v_pk_add_f32 v[66:67], v[66:67], v[70:71]
v_pk_add_f32 v[70:71], v[60:61], v[48:49] neg_lo:[0,1] neg_hi:[0,1]
v_pk_add_f32 v[60:61], v[60:61], v[48:49]
v_pk_add_f32 v[48:49], v[74:75], v[78:79] op_sel:[1,1] op_sel_hi:[0,0] neg_lo:[0,1] neg_hi:[1,0]
v_pk_add_f32 v[74:75], v[74:75], v[78:79]
v_pk_add_f32 v[78:79], v[16:17], v[18:19] neg_lo:[0,1] neg_hi:[0,1]
v_pk_add_f32 v[16:17], v[16:17], v[18:19]
v_pk_add_f32 v[18:19], v[76:77], v[20:21] neg_lo:[0,1] neg_hi:[0,1]
v_pk_add_f32 v[76:77], v[76:77], v[20:21]
v_pk_add_f32 v[20:21], v[72:73], v[26:27] neg_lo:[0,1] neg_hi:[0,1]
v_pk_add_f32 v[72:73], v[72:73], v[26:27]
v_pk_add_f32 v[26:27], v[22:23], v[24:25] neg_lo:[0,1] neg_hi:[0,1]
v_pk_add_f32 v[22:23], v[22:23], v[24:25]
v_pk_add_f32 v[24:25], v[64:65], v[34:35] neg_lo:[0,1] neg_hi:[0,1]
v_pk_add_f32 v[64:65], v[64:65], v[34:35]
v_pk_add_f32 v[34:35], v[30:31], v[36:37] neg_lo:[0,1] neg_hi:[0,1]
v_pk_add_f32 v[30:31], v[30:31], v[36:37]
v_pk_add_f32 v[36:37], v[28:29], v[42:43] neg_lo:[0,1] neg_hi:[0,1]
v_pk_add_f32 v[28:29], v[28:29], v[42:43]
v_pk_add_f32 v[42:43], v[38:39], v[32:33] neg_lo:[0,1] neg_hi:[0,1]
v_pk_add_f32 v[38:39], v[38:39], v[32:33]
v_pk_add_f32 v[32:33], v[14:15], v[50:51] neg_lo:[0,1] neg_hi:[0,1]
v_pk_add_f32 v[14:15], v[14:15], v[50:51]
v_pk_add_f32 v[50:51], v[46:47], v[52:53] neg_lo:[0,1] neg_hi:[0,1]
v_pk_add_f32 v[46:47], v[46:47], v[52:53]
v_pk_add_f32 v[52:53], v[44:45], v[58:59] neg_lo:[0,1] neg_hi:[0,1]
v_pk_add_f32 v[44:45], v[44:45], v[58:59]
v_pk_add_f32 v[58:59], v[54:55], v[56:57] neg_lo:[0,1] neg_hi:[0,1]
v_pk_add_f32 v[54:55], v[54:55], v[56:57]
v_pk_add_f32 v[56:57], v[40:41], v[66:67] neg_lo:[0,1] neg_hi:[0,1]
v_pk_add_f32 v[40:41], v[40:41], v[66:67]
v_pk_add_f32 v[66:67], v[62:63], v[68:69] neg_lo:[0,1] neg_hi:[0,1]
v_pk_add_f32 v[62:63], v[62:63], v[68:69]
v_pk_add_f32 v[68:69], v[60:61], v[74:75] neg_lo:[0,1] neg_hi:[0,1]
v_pk_add_f32 v[60:61], v[60:61], v[74:75]
v_pk_add_f32 v[74:75], v[70:71], v[48:49] neg_lo:[0,1] neg_hi:[0,1]
v_pk_add_f32 v[70:71], v[70:71], v[48:49]
ds_write_b64 v4, v[16:17] offset:0
ds_write_b64 v4, v[14:15] offset:256
ds_write_b64 v4, v[64:65] offset:512
ds_write_b64 v4, v[40:41] offset:768
ds_write_b64 v4, v[72:73] offset:1024
ds_write_b64 v4, v[44:45] offset:1280
ds_write_b64 v4, v[28:29] offset:1536
ds_write_b64 v4, v[60:61] offset:1792
ds_write_b64 v4, v[76:77] offset:2048
ds_write_b64 v4, v[46:47] offset:2304
ds_write_b64 v4, v[30:31] offset:2560
ds_write_b64 v4, v[62:63] offset:2816
ds_write_b64 v4, v[22:23] offset:3072
ds_write_b64 v4, v[54:55] offset:3328
ds_write_b64 v4, v[38:39] offset:3584
ds_write_b64 v4, v[70:71] offset:3840
ds_write_b64 v4, v[78:79] offset:4096
ds_write_b64 v4, v[32:33] offset:4352
ds_write_b64 v4, v[24:25] offset:4608
ds_write_b64 v4, v[56:57] offset:4864
ds_write_b64 v4, v[20:21] offset:5120
ds_write_b64 v4, v[52:53] offset:5376
ds_write_b64 v4, v[36:37] offset:5632
ds_write_b64 v4, v[68:69] offset:5888
ds_write_b64 v4, v[18:19] offset:6144
ds_write_b64 v4, v[50:51] offset:6400
ds_write_b64 v4, v[34:35] offset:6656
ds_write_b64 v4, v[66:67] offset:6912
ds_write_b64 v4, v[26:27] offset:7168
ds_write_b64 v4, v[58:59] offset:7424
ds_write_b64 v4, v[42:43] offset:7680
ds_write_b64 v4, v[74:75] offset:7936
ds_write_b64 v4, v[16:17] offset:8192
s_waitcnt lgkmcnt(0)
s_barrier
s_lshl_b32 s13, s93, 7
s_and_b32 s23, s13, 0x2000
s_add_u32 s13, s13, s23
s_xor_b32 s23, s98, 1
s_lshl_b32 s23, s23, 13
s_add_u32 s13, s13, s23
s_add_u32 s13, s13, 92274688
ds_read_b64 v[16:17], v6 offset:0
ds_read_b64 v[18:19], v7 offset:4096
ds_read_b64 v[20:21], v6 offset:256
ds_read_b64 v[22:23], v7 offset:3840
ds_read_b64 v[24:25], v6 offset:512
ds_read_b64 v[26:27], v7 offset:3584
ds_read_b64 v[28:29], v6 offset:768
ds_read_b64 v[30:31], v7 offset:3328
ds_read_b64 v[32:33], v6 offset:1024
ds_read_b64 v[34:35], v7 offset:3072
ds_read_b64 v[36:37], v6 offset:1280
ds_read_b64 v[38:39], v7 offset:2816
s_waitcnt lgkmcnt(10)
v_pk_add_f32 v[208:209], v[16:17], v[18:19] neg_hi:[0,1]
v_pk_add_f32 v[210:211], v[16:17], v[18:19] op_sel:[1,1] op_sel_hi:[0,0] neg_hi:[1,0]
ds_read_b64 v[40:41], v6 offset:1536
ds_read_b64 v[42:43], v7 offset:2560
buffer_store_dwordx4 v[208:211], v8, s[84:87], s13 offen sc1
s_add_u32 s13, s13, 1048576
s_waitcnt lgkmcnt(10)
v_pk_add_f32 v[212:213], v[20:21], v[22:23] neg_hi:[0,1]
v_pk_add_f32 v[214:215], v[20:21], v[22:23] op_sel:[1,1] op_sel_hi:[0,0] neg_hi:[1,0]
ds_read_b64 v[44:45], v6 offset:1792
ds_read_b64 v[46:47], v7 offset:2304
buffer_store_dwordx4 v[212:215], v8, s[84:87], s13 offen sc1
s_add_u32 s13, s13, 1048576
s_xor_b32 s13, s13, 0x2000
s_waitcnt lgkmcnt(10)
v_pk_add_f32 v[216:217], v[24:25], v[26:27] neg_hi:[0,1]
v_pk_add_f32 v[218:219], v[24:25], v[26:27] op_sel:[1,1] op_sel_hi:[0,0] neg_hi:[1,0]
ds_read_b64 v[16:17], v6 offset:2048
ds_read_b64 v[18:19], v7 offset:2048
buffer_store_dwordx4 v[216:219], v8, s[84:87], s13 offen sc1
s_add_u32 s13, s13, 1048576
s_waitcnt lgkmcnt(10)
v_pk_add_f32 v[220:221], v[28:29], v[30:31] neg_hi:[0,1]
v_pk_add_f32 v[222:223], v[28:29], v[30:31] op_sel:[1,1] op_sel_hi:[0,0] neg_hi:[1,0]
ds_read_b64 v[20:21], v6 offset:2304
ds_read_b64 v[22:23], v7 offset:1792
buffer_store_dwordx4 v[220:223], v8, s[84:87], s13 offen sc1
s_add_u32 s13, s13, 1048576
s_xor_b32 s13, s13, 0x2000
s_waitcnt lgkmcnt(10)
v_pk_add_f32 v[224:225], v[32:33], v[34:35] neg_hi:[0,1]
v_pk_add_f32 v[226:227], v[32:33], v[34:35] op_sel:[1,1] op_sel_hi:[0,0] neg_hi:[1,0]
ds_read_b64 v[24:25], v6 offset:2560
ds_read_b64 v[26:27], v7 offset:1536
buffer_store_dwordx4 v[224:227], v8, s[84:87], s13 offen sc1
s_add_u32 s13, s13, 1048576
s_waitcnt lgkmcnt(10)
v_pk_add_f32 v[228:229], v[36:37], v[38:39] neg_hi:[0,1]
v_pk_add_f32 v[230:231], v[36:37], v[38:39] op_sel:[1,1] op_sel_hi:[0,0] neg_hi:[1,0]
ds_read_b64 v[28:29], v6 offset:2816
ds_read_b64 v[30:31], v7 offset:1280
buffer_store_dwordx4 v[228:231], v8, s[84:87], s13 offen sc1
s_add_u32 s13, s13, 1048576
s_xor_b32 s13, s13, 0x2000
s_waitcnt lgkmcnt(10)
v_pk_add_f32 v[232:233], v[40:41], v[42:43] neg_hi:[0,1]
v_pk_add_f32 v[234:235], v[40:41], v[42:43] op_sel:[1,1] op_sel_hi:[0,0] neg_hi:[1,0]
ds_read_b64 v[32:33], v6 offset:3072
ds_read_b64 v[34:35], v7 offset:1024
buffer_store_dwordx4 v[232:235], v8, s[84:87], s13 offen sc1
s_add_u32 s13, s13, 1048576
s_waitcnt lgkmcnt(10)
v_pk_add_f32 v[236:237], v[44:45], v[46:47] neg_hi:[0,1]
v_pk_add_f32 v[238:239], v[44:45], v[46:47] op_sel:[1,1] op_sel_hi:[0,0] neg_hi:[1,0]
ds_read_b64 v[36:37], v6 offset:3328
ds_read_b64 v[38:39], v7 offset:768
buffer_store_dwordx4 v[236:239], v8, s[84:87], s13 offen sc1
s_add_u32 s13, s13, 1048576
s_xor_b32 s13, s13, 0x2000
s_waitcnt lgkmcnt(10)
v_pk_add_f32 v[208:209], v[16:17], v[18:19] neg_hi:[0,1]
v_pk_add_f32 v[210:211], v[16:17], v[18:19] op_sel:[1,1] op_sel_hi:[0,0] neg_hi:[1,0]
ds_read_b64 v[40:41], v6 offset:3584
ds_read_b64 v[42:43], v7 offset:512
buffer_store_dwordx4 v[208:211], v8, s[84:87], s13 offen sc1
s_add_u32 s13, s13, 1048576
s_waitcnt lgkmcnt(10)
v_pk_add_f32 v[212:213], v[20:21], v[22:23] neg_hi:[0,1]
v_pk_add_f32 v[214:215], v[20:21], v[22:23] op_sel:[1,1] op_sel_hi:[0,0] neg_hi:[1,0]
ds_read_b64 v[44:45], v6 offset:3840
ds_read_b64 v[46:47], v7 offset:256
buffer_store_dwordx4 v[212:215], v8, s[84:87], s13 offen sc1
s_add_u32 s13, s13, 1048576
s_xor_b32 s13, s13, 0x2000
s_waitcnt lgkmcnt(10)
v_pk_add_f32 v[216:217], v[24:25], v[26:27] neg_hi:[0,1]
v_pk_add_f32 v[218:219], v[24:25], v[26:27] op_sel:[1,1] op_sel_hi:[0,0] neg_hi:[1,0]
ds_read_b64 v[16:17], v6 offset:4096
ds_read_b64 v[18:19], v7 offset:0
buffer_store_dwordx4 v[216:219], v8, s[84:87], s13 offen sc1
s_add_u32 s13, s13, 1048576
s_waitcnt lgkmcnt(10)
v_pk_add_f32 v[220:221], v[28:29], v[30:31] neg_hi:[0,1]
v_pk_add_f32 v[222:223], v[28:29], v[30:31] op_sel:[1,1] op_sel_hi:[0,0] neg_hi:[1,0]
buffer_store_dwordx4 v[220:223], v8, s[84:87], s13 offen sc1
s_add_u32 s13, s13, 1048576
s_xor_b32 s13, s13, 0x2000
s_waitcnt lgkmcnt(8)
v_pk_add_f32 v[224:225], v[32:33], v[34:35] neg_hi:[0,1]
v_pk_add_f32 v[226:227], v[32:33], v[34:35] op_sel:[1,1] op_sel_hi:[0,0] neg_hi:[1,0]
buffer_store_dwordx4 v[224:227], v8, s[84:87], s13 offen sc1
s_add_u32 s13, s13, 1048576
s_waitcnt lgkmcnt(6)
v_pk_add_f32 v[228:229], v[36:37], v[38:39] neg_hi:[0,1]
v_pk_add_f32 v[230:231], v[36:37], v[38:39] op_sel:[1,1] op_sel_hi:[0,0] neg_hi:[1,0]
buffer_store_dwordx4 v[228:231], v8, s[84:87], s13 offen sc1
s_add_u32 s13, s13, 1048576
s_xor_b32 s13, s13, 0x2000
s_waitcnt lgkmcnt(4)
v_pk_add_f32 v[232:233], v[40:41], v[42:43] neg_hi:[0,1]
v_pk_add_f32 v[234:235], v[40:41], v[42:43] op_sel:[1,1] op_sel_hi:[0,0] neg_hi:[1,0]
buffer_store_dwordx4 v[232:235], v8, s[84:87], s13 offen sc1
s_add_u32 s13, s13, 1048576
s_waitcnt lgkmcnt(2)
v_pk_add_f32 v[236:237], v[44:45], v[46:47] neg_hi:[0,1]
v_pk_add_f32 v[238:239], v[44:45], v[46:47] op_sel:[1,1] op_sel_hi:[0,0] neg_hi:[1,0]
buffer_store_dwordx4 v[236:239], v8, s[84:87], s13 offen sc1
s_add_u32 s13, s13, 1048576
s_xor_b32 s13, s13, 0x2000
s_waitcnt lgkmcnt(0)
v_pk_add_f32 v[208:209], v[16:17], v[18:19] neg_hi:[0,1]
v_pk_add_f32 v[210:211], v[16:17], v[18:19] op_sel:[1,1] op_sel_hi:[0,0] neg_hi:[1,0]
v_cmp_eq_u32 vcc, 0, v9
s_nop 1
v_cndmask_b32 v13, -16, v8, vcc
buffer_store_dwordx4 v[208:211], v13, s[84:87], s13 offen sc1
s_add_u32 s13, s13, 1048576
s_mov_b32 s93, s21
s_cmp_lt_u32 s93, 128
s_cbranch_scc1 mega_kernel_f1_l
mega_kernel_f1_e:
s_mov_b32 s93, s40
s_waitcnt vmcnt(0)
s_load_dwordx2 s[4:5], s[0:1], 64
s_load_dwordx2 s[8:9], s[0:1], 72
v_and_b32 v1, 63, v0
v_lshrrev_b32 v2, 6, v0
v_mul_u32_u24 v3, 1026, v2
v_lshl_add_u32 v3, v1, 1, v3
v_mul_u32_u24 v4, 65, v1
v_add_u32 v4, v4, v2
v_lshlrev_b32 v4, 2, v4
v_lshrrev_b32 v7, 4, v0
v_and_b32 v8, 15, v0
v_mul_u32_u24 v5, 65, v7
v_lshl_add_u32 v5, v8, 2, v5
v_lshlrev_b32 v5, 2, v5
v_mul_u32_u24 v6, 16384, v7
v_lshl_add_u32 v6, v8, 4, v6
s_add_u32 s24, s84, 171966464
s_addc_u32 s25, s85, 0
s_mov_b32 s26, 8404992
s_mov_b32 s27, 0x00020000
s_waitcnt lgkmcnt(0)
s_mov_b32 s6, 2101248
s_mov_b32 s7, 0x00020000
s_mov_b32 s10, 2101248
s_mov_b32 s11, 0x00020000
v_lshlrev_b32 v9, 7, v0
s_and_b32 s12, s93, 31
s_mul_i32 s12, s12, 65664
buffer_load_dword v250, v9, s[4:7], s12 offen
buffer_load_dword v250, v9, s[8:11], s12 offen
s_add_u32 s12, s12, 32768
buffer_load_dword v250, v9, s[4:7], s12 offen
buffer_load_dword v250, v9, s[8:11], s12 offen
s_add_u32 s12, s12, 32768
s_cmp_lt_u32 s93, 288
s_cbranch_scc0 mega_kernel_f0_e
s_and_b32 s12, s93, 31
s_mul_i32 s12, s12, 65664
s_lshr_b32 s13, s93, 5
s_lshl_b32 s13, s13, 7
s_add_u32 s12, s12, s13
buffer_load_ushort v16, v3, s[4:7], s12 offen
buffer_load_ushort v32, v3, s[8:11], s12 offen
s_add_u32 s12, s12, 4104
buffer_load_ushort v17, v3, s[4:7], s12 offen
buffer_load_ushort v33, v3, s[8:11], s12 offen
s_add_u32 s12, s12, 4104
buffer_load_ushort v18, v3, s[4:7], s12 offen
buffer_load_ushort v34, v3, s[8:11], s12 offen
s_add_u32 s12, s12, 4104
buffer_load_ushort v19, v3, s[4:7], s12 offen
buffer_load_ushort v35, v3, s[8:11], s12 offen
s_add_u32 s12, s12, 4104
buffer_load_ushort v20, v3, s[4:7], s12 offen
buffer_load_ushort v36, v3, s[8:11], s12 offen
s_add_u32 s12, s12, 4104
buffer_load_ushort v21, v3, s[4:7], s12 offen
buffer_load_ushort v37, v3, s[8:11], s12 offen
s_add_u32 s12, s12, 4104
buffer_load_ushort v22, v3, s[4:7], s12 offen
buffer_load_ushort v38, v3, s[8:11], s12 offen
s_add_u32 s12, s12, 4104
buffer_load_ushort v23, v3, s[4:7], s12 offen
buffer_load_ushort v39, v3, s[8:11], s12 offen
s_add_u32 s12, s12, 4104
buffer_load_ushort v24, v3, s[4:7], s12 offen
buffer_load_ushort v40, v3, s[8:11], s12 offen
s_add_u32 s12, s12, 4104
buffer_load_ushort v25, v3, s[4:7], s12 offen
buffer_load_ushort v41, v3, s[8:11], s12 offen
s_add_u32 s12, s12, 4104
buffer_load_ushort v26, v3, s[4:7], s12 offen
buffer_load_ushort v42, v3, s[8:11], s12 offen
s_add_u32 s12, s12, 4104
buffer_load_ushort v27, v3, s[4:7], s12 offen
buffer_load_ushort v43, v3, s[8:11], s12 offen
s_add_u32 s12, s12, 4104
buffer_load_ushort v28, v3, s[4:7], s12 offen
buffer_load_ushort v44, v3, s[8:11], s12 offen
s_add_u32 s12, s12, 4104
buffer_load_ushort v29, v3, s[4:7], s12 offen
buffer_load_ushort v45, v3, s[8:11], s12 offen
s_add_u32 s12, s12, 4104
buffer_load_ushort v30, v3, s[4:7], s12 offen
buffer_load_ushort v46, v3, s[8:11], s12 offen
s_add_u32 s12, s12, 4104
buffer_load_ushort v31, v3, s[4:7], s12 offen
buffer_load_ushort v47, v3, s[8:11], s12 offen
s_add_u32 s12, s12, 4104
s_waitcnt vmcnt(0)
mega_kernel_f0_l:
s_add_u32 s21, s93, 32
s_cmp_lt_u32 s21, 288
s_cselect_b32 s22, s21, s93
s_waitcnt vmcnt(4)
v_lshl_or_b32 v48, v32, 16, v16
v_lshl_or_b32 v49, v33, 16, v17
v_lshl_or_b32 v50, v34, 16, v18
v_lshl_or_b32 v51, v35, 16, v19
v_lshl_or_b32 v52, v36, 16, v20
v_lshl_or_b32 v53, v37, 16, v21
v_lshl_or_b32 v54, v38, 16, v22
v_lshl_or_b32 v55, v39, 16, v23
v_lshl_or_b32 v56, v40, 16, v24
v_lshl_or_b32 v57, v41, 16, v25
v_lshl_or_b32 v58, v42, 16, v26
v_lshl_or_b32 v59, v43, 16, v27
v_lshl_or_b32 v60, v44, 16, v28
v_lshl_or_b32 v61, v45, 16, v29
v_lshl_or_b32 v62, v46, 16, v30
v_lshl_or_b32 v63, v47, 16, v31
s_and_b32 s12, s22, 31
s_mul_i32 s12, s12, 65664
s_lshr_b32 s13, s22, 5
s_lshl_b32 s13, s13, 7
s_add_u32 s12, s12, s13
buffer_load_ushort v16, v3, s[4:7], s12 offen
buffer_load_ushort v32, v3, s[8:11], s12 offen
s_add_u32 s12, s12, 4104
buffer_load_ushort v17, v3, s[4:7], s12 offen
buffer_load_ushort v33, v3, s[8:11], s12 offen
s_add_u32 s12, s12, 4104
buffer_load_ushort v18, v3, s[4:7], s12 offen
buffer_load_ushort v34, v3, s[8:11], s12 offen
s_add_u32 s12, s12, 4104
buffer_load_ushort v19, v3, s[4:7], s12 offen
buffer_load_ushort v35, v3, s[8:11], s12 offen
s_add_u32 s12, s12, 4104
buffer_load_ushort v20, v3, s[4:7], s12 offen
buffer_load_ushort v36, v3, s[8:11], s12 offen
s_add_u32 s12, s12, 4104
buffer_load_ushort v21, v3, s[4:7], s12 offen
buffer_load_ushort v37, v3, s[8:11], s12 offen
s_add_u32 s12, s12, 4104
buffer_load_ushort v22, v3, s[4:7], s12 offen
buffer_load_ushort v38, v3, s[8:11], s12 offen
s_add_u32 s12, s12, 4104
buffer_load_ushort v23, v3, s[4:7], s12 offen
buffer_load_ushort v39, v3, s[8:11], s12 offen
s_add_u32 s12, s12, 4104
buffer_load_ushort v24, v3, s[4:7], s12 offen
buffer_load_ushort v40, v3, s[8:11], s12 offen
s_add_u32 s12, s12, 4104
buffer_load_ushort v25, v3, s[4:7], s12 offen
buffer_load_ushort v41, v3, s[8:11], s12 offen
s_add_u32 s12, s12, 4104
buffer_load_ushort v26, v3, s[4:7], s12 offen
buffer_load_ushort v42, v3, s[8:11], s12 offen
s_add_u32 s12, s12, 4104
buffer_load_ushort v27, v3, s[4:7], s12 offen
buffer_load_ushort v43, v3, s[8:11], s12 offen
s_add_u32 s12, s12, 4104
buffer_load_ushort v28, v3, s[4:7], s12 offen
buffer_load_ushort v44, v3, s[8:11], s12 offen
s_add_u32 s12, s12, 4104
buffer_load_ushort v29, v3, s[4:7], s12 offen
buffer_load_ushort v45, v3, s[8:11], s12 offen
s_add_u32 s12, s12, 4104
buffer_load_ushort v30, v3, s[4:7], s12 offen
buffer_load_ushort v46, v3, s[8:11], s12 offen
s_add_u32 s12, s12, 4104
buffer_load_ushort v31, v3, s[4:7], s12 offen
buffer_load_ushort v47, v3, s[8:11], s12 offen
s_add_u32 s12, s12, 4104
s_barrier
ds_write_b32 v4, v48 offset:0
ds_write_b32 v4, v49 offset:16
ds_write_b32 v4, v50 offset:32
ds_write_b32 v4, v51 offset:48
ds_write_b32 v4, v52 offset:64
ds_write_b32 v4, v53 offset:80
ds_write_b32 v4, v54 offset:96
ds_write_b32 v4, v55 offset:112
ds_write_b32 v4, v56 offset:128
ds_write_b32 v4, v57 offset:144
ds_write_b32 v4, v58 offset:160
ds_write_b32 v4, v59 offset:176
s_waitcnt lgkmcnt(4)
ds_write_b32 v4, v60 offset:192
ds_write_b32 v4, v61 offset:208
ds_write_b32 v4, v62 offset:224
ds_write_b32 v4, v63 offset:240
s_waitcnt lgkmcnt(0)
s_barrier
ds_read2_b32 v[64:65], v5 offset0:0 offset1:1
ds_read_b32 v66, v5 offset:8
ds_read_b32 v67, v5 offset:12
ds_read_b32 v68, v5 offset:4160
ds_read_b32 v69, v5 offset:4164
ds_read_b32 v70, v5 offset:4168
ds_read_b32 v71, v5 offset:4172
ds_read_b32 v72, v5 offset:8320
ds_read_b32 v73, v5 offset:8324
ds_read_b32 v74, v5 offset:8328
ds_read_b32 v75, v5 offset:8332
ds_read_b32 v76, v5 offset:12480
ds_read_b32 v77, v5 offset:12484
ds_read_b32 v78, v5 offset:12488
ds_read_b32 v79, v5 offset:12492
s_and_b32 s14, s93, 31
s_lshl_b32 s14, s14, 8
s_lshr_b32 s15, s93, 5
s_lshr_b32 s23, s15, 1
s_xnor_b32 s23, s23, s98
s_and_b32 s23, s23, 1
s_lshl_b32 s23, s23, 13
s_mul_i32 s15, s15, 1048576
s_add_u32 s15, s15, 0
s_add_u32 s15, s15, s23
s_add_u32 s14, s14, s15
s_waitcnt lgkmcnt(0)
buffer_store_dwordx4 v[64:67], v6, s[24:27], s14 offen sc1
s_add_u32 s14, s14, 262144
buffer_store_dwordx4 v[68:71], v6, s[24:27], s14 offen sc1
s_add_u32 s14, s14, 262144
buffer_store_dwordx4 v[72:75], v6, s[24:27], s14 offen sc1
s_add_u32 s14, s14, 262144
buffer_store_dwordx4 v[76:79], v6, s[24:27], s14 offen sc1
s_add_u32 s14, s14, 262144
s_mov_b32 s93, s21
s_cmp_lt_u32 s93, 288
s_cbranch_scc1 mega_kernel_f0_l
mega_kernel_f0_e:
v_and_b32 v3, 15, v0
v_lshlrev_b32 v3, 4, v3
s_branch mega_kernel_syd
mega_kernel_sydw:
s_sleep 4
mega_kernel_syd:
buffer_load_dword v2, v3, s[72:75], 0 offen sc1
s_waitcnt vmcnt(0)
mega_kernel_sydp:
s_cmp_eq_u32 s95, 1
s_cbranch_scc0 mega_kernel_sydf
v_readlane_b32 s76, v2, 14
s_mov_b32 s98, 0
s_cmp_eq_u32 s76, 32
s_cbranch_scc0 mega_kernel_sydw
s_branch mega_kernel_sydd
mega_kernel_sydf:
s_mov_b32 s77, 0
s_mov_b32 s78, 0
v_readlane_b32 s76, v2, 0
s_add_u32 s77, s77, s76
s_xor_b32 s76, s76, 32
s_or_b32 s78, s78, s76
v_readlane_b32 s76, v2, 1
s_add_u32 s77, s77, s76
s_xor_b32 s76, s76, 32
s_or_b32 s78, s78, s76
v_readlane_b32 s76, v2, 2
s_add_u32 s77, s77, s76
s_xor_b32 s76, s76, 32
s_or_b32 s78, s78, s76
v_readlane_b32 s76, v2, 3
s_add_u32 s77, s77, s76
s_xor_b32 s76, s76, 32
s_or_b32 s78, s78, s76
v_readlane_b32 s76, v2, 4
s_add_u32 s77, s77, s76
s_xor_b32 s76, s76, 32
s_or_b32 s78, s78, s76
v_readlane_b32 s76, v2, 5
s_add_u32 s77, s77, s76
s_xor_b32 s76, s76, 32
s_or_b32 s78, s78, s76
v_readlane_b32 s76, v2, 6
s_add_u32 s77, s77, s76
s_xor_b32 s76, s76, 32
s_or_b32 s78, s78, s76
v_readlane_b32 s76, v2, 7
s_add_u32 s77, s77, s76
s_xor_b32 s76, s76, 32
s_or_b32 s78, s78, s76
s_cmp_eq_u32 s77, 256
s_cbranch_scc0 mega_kernel_sydw
v_mov_b32 v252, v2
s_cmp_eq_u32 s78, 0
s_cbranch_scc0 mega_kernel_slowent
v_readlane_b32 s76, v2, 10
v_readlane_b32 s77, v2, 8
s_cmp_eq_u32 s76, 32
s_cbranch_scc0 mega_kernel_sydw
s_cmp_gt_u32 s77, 16
s_cselect_b32 s98, 1, 0
mega_kernel_sydd:
s_waitcnt vmcnt(0)
s_barrier
v_mov_b32 v1, 0
v_mov_b32 v2, 1
s_mov_b32 s82, 69259264
v_cmp_eq_u32 vcc, 0, v0
s_and_saveexec_b64 s[80:81], vcc
s_cbranch_execz mega_kernel_sg0
buffer_atomic_add v2, v1, s[84:87], s82 offen sc1
mega_kernel_sg0:
s_mov_b64 exec, s[80:81]
s_add_u32 s38, s40, 129
s_mov_b32 s39, 32
s_mov_b32 s37, 129
s_cmp_lt_u32 s38, 129
s_cbranch_scc1 mega_kernel_f2s
s_branch mega_kernel_f2e
mega_kernel_rk:
s_load_dwordx2 s[4:5], s[0:1], 24
s_load_dwordx2 s[8:9], s[0:1], 0
v_lshrrev_b32 v2, 6, v0
v_and_b32 v1, 63, v0
v_readfirstlane_b32 s41, v2
v_lshlrev_b32 v5, 4, v1
s_waitcnt lgkmcnt(0)
s_mov_b32 s6, 8388608
s_mov_b32 s7, 0x00020000
s_mov_b32 s10, 4194304
s_mov_b32 s11, 0x00020000
s_lshl_b32 s43, s40, 8
s_lshl_b32 s44, s41, 6
s_add_u32 s48, s43, s44
s_and_b32 s43, s48, 0x7ff
v_add_u32 v19, s43, v1
v_lshlrev_b32 v19, 7, v19
s_mov_b32 s43, 0
buffer_load_dword v250, v19, s[8:11], s43 offen
s_nop 0
v_lshrrev_b32 v2, 3, v1
s_lshl_b32 s43, s41, 3
v_add_u32 v2, s43, v2
v_bfe_u32 v3, v2, 1, 3
v_and_b32 v4, 7, v1
v_xor_b32 v3, v3, v4
v_lshlrev_b32 v6, 11, v2
v_lshl_add_u32 v6, v3, 4, v6
s_lshl_b32 s46, s41, 10
v_and_b32 v2, 15, v1
v_bfe_u32 v3, v2, 1, 3
v_lshrrev_b32 v4, 4, v1
v_xor_b32 v3, v3, v4
v_lshlrev_b32 v8, 7, v2
v_lshl_add_u32 v8, v3, 4, v8
v_xor_b32 v9, 64, v8
v_add_u32 v10, 0x10000, v8
v_add_u32 v11, 0x10000, v9
v_mov_b32 v7, v5
s_lshl_b32 s47, s40, 2
s_add_u32 s47, s47, s41
s_mov_b32 s42, 0
s_mov_b32 s50, 0
s_add_u32 m0, s46, 0
s_nop 0
buffer_load_dwordx4 v6, s[8:11], s50 offen offset:0 lds
s_add_u32 m0, s46, 3968
s_nop 0
buffer_load_dwordx4 v6, s[8:11], s50 offen offset:128 lds
s_add_u32 m0, s46, 7936
s_nop 0
buffer_load_dwordx4 v6, s[8:11], s50 offen offset:256 lds
s_add_u32 m0, s46, 11904
s_nop 0
buffer_load_dwordx4 v6, s[8:11], s50 offen offset:384 lds
s_add_u32 m0, s46, 15872
s_nop 0
buffer_load_dwordx4 v6, s[8:11], s50 offen offset:512 lds
s_add_u32 m0, s46, 19840
s_nop 0
buffer_load_dwordx4 v6, s[8:11], s50 offen offset:640 lds
s_add_u32 m0, s46, 23808
s_nop 0
buffer_load_dwordx4 v6, s[8:11], s50 offen offset:768 lds
s_add_u32 m0, s46, 27776
s_nop 0
buffer_load_dwordx4 v6, s[8:11], s50 offen offset:896 lds
s_add_u32 m0, s46, 31744
s_nop 0
buffer_load_dwordx4 v6, s[8:11], s50 offen offset:1024 lds
s_add_u32 m0, s46, 35712
s_nop 0
buffer_load_dwordx4 v6, s[8:11], s50 offen offset:1152 lds
s_add_u32 m0, s46, 39680
s_nop 0
buffer_load_dwordx4 v6, s[8:11], s50 offen offset:1280 lds
s_add_u32 m0, s46, 43648
s_nop 0
buffer_load_dwordx4 v6, s[8:11], s50 offen offset:1408 lds
s_add_u32 m0, s46, 47616
s_nop 0
buffer_load_dwordx4 v6, s[8:11], s50 offen offset:1536 lds
s_add_u32 m0, s46, 51584
s_nop 0
buffer_load_dwordx4 v6, s[8:11], s50 offen offset:1664 lds
s_add_u32 m0, s46, 55552
s_nop 0
buffer_load_dwordx4 v6, s[8:11], s50 offen offset:1792 lds
s_add_u32 m0, s46, 59520
s_nop 0
buffer_load_dwordx4 v6, s[8:11], s50 offen offset:1920 lds
v_lshrrev_b32 v2, 2, v1
v_and_b32 v3, 3, v1
v_lshlrev_b32 v16, 13, v2
v_lshl_add_u32 v16, v3, 4, v16
v_add_u32 v16, s48, v16
s_mul_i32 s45, s41, 24576
s_add_u32 s45, s45, 65536
v_bfe_u32 v17, v1, 2, 2
v_lshrrev_b32 v18, 4, v1
v_lshl_add_u32 v17, v18, 3, v17
v_lshlrev_b32 v17, 6, v17
v_lshl_add_u32 v17, v3, 4, v17
v_add_u32 v17, s45, v17
s_and_b32 s43, s40, 3
s_lshl_b32 s43, s43, 2
s_add_u32 s43, s43, s41
s_lshl_b32 s43, s43, 3
v_and_b32 v12, 7, v1
v_add_u32 v12, s43, v12
s_lshr_b32 s43, s40, 2
s_lshl_b32 s43, s43, 10
s_add_u32 s44, s43, 896
s_add_u32 s43, s43, 384
s_cmp_ge_u32 s40, 28
s_cselect_b32 s44, s44, s43
v_mov_b32 v13, s43
v_mov_b32 v14, s44
v_cmp_gt_u32 vcc, 32, v1
s_nop 1
v_cndmask_b32 v13, v14, v13, vcc
v_lshl_add_u32 v12, v12, 13, v13
s_mov_b32 s44, 0
buffer_load_dword v250, v12, s[4:7], s44 offen
s_add_u32 m0, s45, 0
s_mov_b32 s44, 0
buffer_load_dwordx4 v16, s[4:7], s44 offen lds
s_add_u32 m0, s45, 1024
s_mov_b32 s44, 131072
buffer_load_dwordx4 v16, s[4:7], s44 offen lds
s_add_u32 m0, s45, 2048
s_mov_b32 s44, 262144
buffer_load_dwordx4 v16, s[4:7], s44 offen lds
s_add_u32 m0, s45, 3072
s_mov_b32 s44, 393216
buffer_load_dwordx4 v16, s[4:7], s44 offen lds
s_add_u32 m0, s45, 4096
s_mov_b32 s44, 524288
buffer_load_dwordx4 v16, s[4:7], s44 offen lds
s_add_u32 m0, s45, 5120
s_mov_b32 s44, 655360
buffer_load_dwordx4 v16, s[4:7], s44 offen lds
s_add_u32 m0, s45, 6144
s_mov_b32 s44, 786432
buffer_load_dwordx4 v16, s[4:7], s44 offen lds
s_add_u32 m0, s45, 7168
s_mov_b32 s44, 917504
buffer_load_dwordx4 v16, s[4:7], s44 offen lds
s_mov_b32 s44, 1048576
buffer_load_dword v250, v12, s[4:7], s44 offen
s_add_u32 m0, s45, 8192
s_mov_b32 s44, 1048576
buffer_load_dwordx4 v16, s[4:7], s44 offen lds
s_add_u32 m0, s45, 9216
s_mov_b32 s44, 1179648
buffer_load_dwordx4 v16, s[4:7], s44 offen lds
s_add_u32 m0, s45, 10240
s_mov_b32 s44, 1310720
buffer_load_dwordx4 v16, s[4:7], s44 offen lds
s_add_u32 m0, s45, 11264
s_mov_b32 s44, 1441792
buffer_load_dwordx4 v16, s[4:7], s44 offen lds
s_add_u32 m0, s45, 12288
s_mov_b32 s44, 1572864
buffer_load_dwordx4 v16, s[4:7], s44 offen lds
s_add_u32 m0, s45, 13312
s_mov_b32 s44, 1703936
buffer_load_dwordx4 v16, s[4:7], s44 offen lds
s_add_u32 m0, s45, 14336
s_mov_b32 s44, 1835008
buffer_load_dwordx4 v16, s[4:7], s44 offen lds
s_add_u32 m0, s45, 15360
s_mov_b32 s44, 1966080
buffer_load_dwordx4 v16, s[4:7], s44 offen lds
s_mov_b32 s44, 2097152
buffer_load_dword v250, v12, s[4:7], s44 offen
s_add_u32 m0, s45, 16384
s_mov_b32 s44, 2097152
buffer_load_dwordx4 v16, s[4:7], s44 offen lds
s_add_u32 m0, s45, 17408
s_mov_b32 s44, 2228224
buffer_load_dwordx4 v16, s[4:7], s44 offen lds
s_add_u32 m0, s45, 18432
s_mov_b32 s44, 2359296
buffer_load_dwordx4 v16, s[4:7], s44 offen lds
s_add_u32 m0, s45, 19456
s_mov_b32 s44, 2490368
buffer_load_dwordx4 v16, s[4:7], s44 offen lds
s_add_u32 m0, s45, 20480
s_mov_b32 s44, 2621440
buffer_load_dwordx4 v16, s[4:7], s44 offen lds
s_add_u32 m0, s45, 21504
s_mov_b32 s44, 2752512
buffer_load_dwordx4 v16, s[4:7], s44 offen lds
s_add_u32 m0, s45, 22528
s_mov_b32 s44, 2883584
buffer_load_dwordx4 v16, s[4:7], s44 offen lds
s_add_u32 m0, s45, 23552
s_mov_b32 s44, 3014656
buffer_load_dwordx4 v16, s[4:7], s44 offen lds
s_waitcnt vmcnt(18)
s_barrier
ds_read_b64_tr_b16 a[0:1], v17 offset:0
ds_read_b64_tr_b16 a[2:3], v17 offset:256
ds_read_b64_tr_b16 a[4:5], v17 offset:8
ds_read_b64_tr_b16 a[6:7], v17 offset:264
ds_read_b64_tr_b16 a[8:9], v17 offset:2048
ds_read_b64_tr_b16 a[10:11], v17 offset:2304
ds_read_b64_tr_b16 a[12:13], v17 offset:2056
ds_read_b64_tr_b16 a[14:15], v17 offset:2312
s_waitcnt lgkmcnt(0)
ds_read_b64_tr_b16 a[16:17], v17 offset:4096
ds_read_b64_tr_b16 a[18:19], v17 offset:4352
ds_read_b64_tr_b16 a[20:21], v17 offset:4104
ds_read_b64_tr_b16 a[22:23], v17 offset:4360
ds_read_b64_tr_b16 a[24:25], v17 offset:6144
ds_read_b64_tr_b16 a[26:27], v17 offset:6400
ds_read_b64_tr_b16 a[28:29], v17 offset:6152
ds_read_b64_tr_b16 a[30:31], v17 offset:6408
s_waitcnt lgkmcnt(0)
s_mov_b32 s44, 3145728
buffer_load_dword v250, v12, s[4:7], s44 offen
s_add_u32 m0, s45, 0
s_mov_b32 s44, 3145728
buffer_load_dwordx4 v16, s[4:7], s44 offen lds
s_add_u32 m0, s45, 1024
s_mov_b32 s44, 3276800
buffer_load_dwordx4 v16, s[4:7], s44 offen lds
s_add_u32 m0, s45, 2048
s_mov_b32 s44, 3407872
buffer_load_dwordx4 v16, s[4:7], s44 offen lds
s_add_u32 m0, s45, 3072
s_mov_b32 s44, 3538944
buffer_load_dwordx4 v16, s[4:7], s44 offen lds
s_add_u32 m0, s45, 4096
s_mov_b32 s44, 3670016
buffer_load_dwordx4 v16, s[4:7], s44 offen lds
s_add_u32 m0, s45, 5120
s_mov_b32 s44, 3801088
buffer_load_dwordx4 v16, s[4:7], s44 offen lds
s_add_u32 m0, s45, 6144
s_mov_b32 s44, 3932160
buffer_load_dwordx4 v16, s[4:7], s44 offen lds
s_add_u32 m0, s45, 7168
s_mov_b32 s44, 4063232
buffer_load_dwordx4 v16, s[4:7], s44 offen lds
ds_read_b128 v[20:23], v8 offset:0
ds_read_b128 v[24:27], v8 offset:2048
ds_read_b128 v[28:31], v9 offset:0
ds_read_b128 v[32:35], v9 offset:2048
ds_read_b128 v[36:39], v8 offset:4096
ds_read_b128 v[40:43], v8 offset:6144
ds_read_b128 v[44:47], v9 offset:4096
ds_read_b128 v[48:51], v9 offset:6144
s_waitcnt lgkmcnt(0)
v_mfma_f32_16x16x32_bf16 v[52:55], a[0:3], v[20:23], 0
v_mfma_f32_16x16x32_bf16 v[56:59], a[4:7], v[20:23], 0
v_mfma_f32_16x16x32_bf16 v[60:63], a[0:3], v[24:27], 0
v_mfma_f32_16x16x32_bf16 v[64:67], a[4:7], v[24:27], 0
v_mfma_f32_16x16x32_bf16 v[52:55], a[8:11], v[28:31], v[52:55]
v_mfma_f32_16x16x32_bf16 v[56:59], a[12:15], v[28:31], v[56:59]
v_mfma_f32_16x16x32_bf16 v[60:63], a[8:11], v[32:35], v[60:63]
v_mfma_f32_16x16x32_bf16 v[64:67], a[12:15], v[32:35], v[64:67]
v_mfma_f32_16x16x32_bf16 v[52:55], a[16:19], v[36:39], v[52:55]
v_mfma_f32_16x16x32_bf16 v[56:59], a[20:23], v[36:39], v[56:59]
v_mfma_f32_16x16x32_bf16 v[60:63], a[16:19], v[40:43], v[60:63]
v_mfma_f32_16x16x32_bf16 v[64:67], a[20:23], v[40:43], v[64:67]
v_mfma_f32_16x16x32_bf16 v[52:55], a[24:27], v[44:47], v[52:55]
v_mfma_f32_16x16x32_bf16 v[56:59], a[28:31], v[44:47], v[56:59]
v_mfma_f32_16x16x32_bf16 v[60:63], a[24:27], v[48:51], v[60:63]
v_mfma_f32_16x16x32_bf16 v[64:67], a[28:31], v[48:51], v[64:67]
s_waitcnt vmcnt(18)
ds_read_b64_tr_b16 a[32:33], v17 offset:8192
ds_read_b64_tr_b16 a[34:35], v17 offset:8448
ds_read_b64_tr_b16 a[36:37], v17 offset:8200
ds_read_b64_tr_b16 a[38:39], v17 offset:8456
ds_read_b64_tr_b16 a[40:41], v17 offset:10240
ds_read_b64_tr_b16 a[42:43], v17 offset:10496
ds_read_b64_tr_b16 a[44:45], v17 offset:10248
ds_read_b64_tr_b16 a[46:47], v17 offset:10504
s_waitcnt lgkmcnt(0)
ds_read_b64_tr_b16 a[48:49], v17 offset:12288
ds_read_b64_tr_b16 a[50:51], v17 offset:12544
ds_read_b64_tr_b16 a[52:53], v17 offset:12296
ds_read_b64_tr_b16 a[54:55], v17 offset:12552
ds_read_b64_tr_b16 a[56:57], v17 offset:14336
ds_read_b64_tr_b16 a[58:59], v17 offset:14592
ds_read_b64_tr_b16 a[60:61], v17 offset:14344
ds_read_b64_tr_b16 a[62:63], v17 offset:14600
s_waitcnt lgkmcnt(0)
s_mov_b32 s44, 4194304
buffer_load_dword v250, v12, s[4:7], s44 offen
s_add_u32 m0, s45, 8192
s_mov_b32 s44, 4194304
buffer_load_dwordx4 v16, s[4:7], s44 offen lds
s_add_u32 m0, s45, 9216
s_mov_b32 s44, 4325376
buffer_load_dwordx4 v16, s[4:7], s44 offen lds
s_add_u32 m0, s45, 10240
s_mov_b32 s44, 4456448
buffer_load_dwordx4 v16, s[4:7], s44 offen lds
s_add_u32 m0, s45, 11264
s_mov_b32 s44, 4587520
buffer_load_dwordx4 v16, s[4:7], s44 offen lds
s_add_u32 m0, s45, 12288
s_mov_b32 s44, 4718592
buffer_load_dwordx4 v16, s[4:7], s44 offen lds
s_add_u32 m0, s45, 13312
s_mov_b32 s44, 4849664
buffer_load_dwordx4 v16, s[4:7], s44 offen lds
s_add_u32 m0, s45, 14336
s_mov_b32 s44, 4980736
buffer_load_dwordx4 v16, s[4:7], s44 offen lds
s_add_u32 m0, s45, 15360
s_mov_b32 s44, 5111808
buffer_load_dwordx4 v16, s[4:7], s44 offen lds
ds_read_b128 v[20:23], v8 offset:8192
ds_read_b128 v[24:27], v8 offset:10240
ds_read_b128 v[28:31], v9 offset:8192
ds_read_b128 v[32:35], v9 offset:10240
ds_read_b128 v[36:39], v8 offset:12288
ds_read_b128 v[40:43], v8 offset:14336
ds_read_b128 v[44:47], v9 offset:12288
ds_read_b128 v[48:51], v9 offset:14336
s_waitcnt lgkmcnt(0)
v_mfma_f32_16x16x32_bf16 v[52:55], a[32:35], v[20:23], v[52:55]
v_mfma_f32_16x16x32_bf16 v[56:59], a[36:39], v[20:23], v[56:59]
v_mfma_f32_16x16x32_bf16 v[60:63], a[32:35], v[24:27], v[60:63]
v_mfma_f32_16x16x32_bf16 v[64:67], a[36:39], v[24:27], v[64:67]
v_mfma_f32_16x16x32_bf16 v[52:55], a[40:43], v[28:31], v[52:55]
v_mfma_f32_16x16x32_bf16 v[56:59], a[44:47], v[28:31], v[56:59]
v_mfma_f32_16x16x32_bf16 v[60:63], a[40:43], v[32:35], v[60:63]
v_mfma_f32_16x16x32_bf16 v[64:67], a[44:47], v[32:35], v[64:67]
v_mfma_f32_16x16x32_bf16 v[52:55], a[48:51], v[36:39], v[52:55]
v_mfma_f32_16x16x32_bf16 v[56:59], a[52:55], v[36:39], v[56:59]
v_mfma_f32_16x16x32_bf16 v[60:63], a[48:51], v[40:43], v[60:63]
v_mfma_f32_16x16x32_bf16 v[64:67], a[52:55], v[40:43], v[64:67]
v_mfma_f32_16x16x32_bf16 v[52:55], a[56:59], v[44:47], v[52:55]
v_mfma_f32_16x16x32_bf16 v[56:59], a[60:63], v[44:47], v[56:59]
v_mfma_f32_16x16x32_bf16 v[60:63], a[56:59], v[48:51], v[60:63]
v_mfma_f32_16x16x32_bf16 v[64:67], a[60:63], v[48:51], v[64:67]
s_waitcnt vmcnt(18)
ds_read_b64_tr_b16 a[64:65], v17 offset:16384
ds_read_b64_tr_b16 a[66:67], v17 offset:16640
ds_read_b64_tr_b16 a[68:69], v17 offset:16392
ds_read_b64_tr_b16 a[70:71], v17 offset:16648
ds_read_b64_tr_b16 a[72:73], v17 offset:18432
ds_read_b64_tr_b16 a[74:75], v17 offset:18688
ds_read_b64_tr_b16 a[76:77], v17 offset:18440
ds_read_b64_tr_b16 a[78:79], v17 offset:18696
s_waitcnt lgkmcnt(0)
ds_read_b64_tr_b16 a[80:81], v17 offset:20480
ds_read_b64_tr_b16 a[82:83], v17 offset:20736
ds_read_b64_tr_b16 a[84:85], v17 offset:20488
ds_read_b64_tr_b16 a[86:87], v17 offset:20744
ds_read_b64_tr_b16 a[88:89], v17 offset:22528
ds_read_b64_tr_b16 a[90:91], v17 offset:22784
ds_read_b64_tr_b16 a[92:93], v17 offset:22536
ds_read_b64_tr_b16 a[94:95], v17 offset:22792
s_waitcnt lgkmcnt(0)
s_mov_b32 s44, 5242880
buffer_load_dword v250, v12, s[4:7], s44 offen
s_add_u32 m0, s45, 16384
s_mov_b32 s44, 5242880
buffer_load_dwordx4 v16, s[4:7], s44 offen lds
s_add_u32 m0, s45, 17408
s_mov_b32 s44, 5373952
buffer_load_dwordx4 v16, s[4:7], s44 offen lds
s_add_u32 m0, s45, 18432
s_mov_b32 s44, 5505024
buffer_load_dwordx4 v16, s[4:7], s44 offen lds
s_add_u32 m0, s45, 19456
s_mov_b32 s44, 5636096
buffer_load_dwordx4 v16, s[4:7], s44 offen lds
s_add_u32 m0, s45, 20480
s_mov_b32 s44, 5767168
buffer_load_dwordx4 v16, s[4:7], s44 offen lds
s_add_u32 m0, s45, 21504
s_mov_b32 s44, 5898240
buffer_load_dwordx4 v16, s[4:7], s44 offen lds
s_add_u32 m0, s45, 22528
s_mov_b32 s44, 6029312
buffer_load_dwordx4 v16, s[4:7], s44 offen lds
s_add_u32 m0, s45, 23552
s_mov_b32 s44, 6160384
buffer_load_dwordx4 v16, s[4:7], s44 offen lds
ds_read_b128 v[20:23], v8 offset:16384
ds_read_b128 v[24:27], v8 offset:18432
ds_read_b128 v[28:31], v9 offset:16384
ds_read_b128 v[32:35], v9 offset:18432
ds_read_b128 v[36:39], v8 offset:20480
ds_read_b128 v[40:43], v8 offset:22528
ds_read_b128 v[44:47], v9 offset:20480
ds_read_b128 v[48:51], v9 offset:22528
s_waitcnt lgkmcnt(0)
v_mfma_f32_16x16x32_bf16 v[52:55], a[64:67], v[20:23], v[52:55]
v_mfma_f32_16x16x32_bf16 v[56:59], a[68:71], v[20:23], v[56:59]
v_mfma_f32_16x16x32_bf16 v[60:63], a[64:67], v[24:27], v[60:63]
v_mfma_f32_16x16x32_bf16 v[64:67], a[68:71], v[24:27], v[64:67]
v_mfma_f32_16x16x32_bf16 v[52:55], a[72:75], v[28:31], v[52:55]
v_mfma_f32_16x16x32_bf16 v[56:59], a[76:79], v[28:31], v[56:59]
v_mfma_f32_16x16x32_bf16 v[60:63], a[72:75], v[32:35], v[60:63]
v_mfma_f32_16x16x32_bf16 v[64:67], a[76:79], v[32:35], v[64:67]
v_mfma_f32_16x16x32_bf16 v[52:55], a[80:83], v[36:39], v[52:55]
v_mfma_f32_16x16x32_bf16 v[56:59], a[84:87], v[36:39], v[56:59]
v_mfma_f32_16x16x32_bf16 v[60:63], a[80:83], v[40:43], v[60:63]
v_mfma_f32_16x16x32_bf16 v[64:67], a[84:87], v[40:43], v[64:67]
v_mfma_f32_16x16x32_bf16 v[52:55], a[88:91], v[44:47], v[52:55]
v_mfma_f32_16x16x32_bf16 v[56:59], a[92:95], v[44:47], v[56:59]
v_mfma_f32_16x16x32_bf16 v[60:63], a[88:91], v[48:51], v[60:63]
v_mfma_f32_16x16x32_bf16 v[64:67], a[92:95], v[48:51], v[64:67]
s_waitcnt vmcnt(18)
ds_read_b64_tr_b16 a[96:97], v17 offset:0
ds_read_b64_tr_b16 a[98:99], v17 offset:256
ds_read_b64_tr_b16 a[100:101], v17 offset:8
ds_read_b64_tr_b16 a[102:103], v17 offset:264
ds_read_b64_tr_b16 a[104:105], v17 offset:2048
ds_read_b64_tr_b16 a[106:107], v17 offset:2304
ds_read_b64_tr_b16 a[108:109], v17 offset:2056
ds_read_b64_tr_b16 a[110:111], v17 offset:2312
s_waitcnt lgkmcnt(0)
ds_read_b64_tr_b16 a[112:113], v17 offset:4096
ds_read_b64_tr_b16 a[114:115], v17 offset:4352
ds_read_b64_tr_b16 a[116:117], v17 offset:4104
ds_read_b64_tr_b16 a[118:119], v17 offset:4360
ds_read_b64_tr_b16 a[120:121], v17 offset:6144
ds_read_b64_tr_b16 a[122:123], v17 offset:6400
ds_read_b64_tr_b16 a[124:125], v17 offset:6152
ds_read_b64_tr_b16 a[126:127], v17 offset:6408
s_waitcnt lgkmcnt(0)
s_mov_b32 s44, 6291456
buffer_load_dword v250, v12, s[4:7], s44 offen
s_add_u32 m0, s45, 0
s_mov_b32 s44, 6291456
buffer_load_dwordx4 v16, s[4:7], s44 offen lds
s_add_u32 m0, s45, 1024
s_mov_b32 s44, 6422528
buffer_load_dwordx4 v16, s[4:7], s44 offen lds
s_add_u32 m0, s45, 2048
s_mov_b32 s44, 6553600
buffer_load_dwordx4 v16, s[4:7], s44 offen lds
s_add_u32 m0, s45, 3072
s_mov_b32 s44, 6684672
buffer_load_dwordx4 v16, s[4:7], s44 offen lds
s_add_u32 m0, s45, 4096
s_mov_b32 s44, 6815744
buffer_load_dwordx4 v16, s[4:7], s44 offen lds
s_add_u32 m0, s45, 5120
s_mov_b32 s44, 6946816
buffer_load_dwordx4 v16, s[4:7], s44 offen lds
s_add_u32 m0, s45, 6144
s_mov_b32 s44, 7077888
buffer_load_dwordx4 v16, s[4:7], s44 offen lds
s_add_u32 m0, s45, 7168
s_mov_b32 s44, 7208960
buffer_load_dwordx4 v16, s[4:7], s44 offen lds
ds_read_b128 v[20:23], v8 offset:24576
ds_read_b128 v[24:27], v8 offset:26624
ds_read_b128 v[28:31], v9 offset:24576
ds_read_b128 v[32:35], v9 offset:26624
ds_read_b128 v[36:39], v8 offset:28672
ds_read_b128 v[40:43], v8 offset:30720
ds_read_b128 v[44:47], v9 offset:28672
ds_read_b128 v[48:51], v9 offset:30720
s_waitcnt lgkmcnt(0)
v_mfma_f32_16x16x32_bf16 v[52:55], a[96:99], v[20:23], v[52:55]
v_mfma_f32_16x16x32_bf16 v[56:59], a[100:103], v[20:23], v[56:59]
v_mfma_f32_16x16x32_bf16 v[60:63], a[96:99], v[24:27], v[60:63]
v_mfma_f32_16x16x32_bf16 v[64:67], a[100:103], v[24:27], v[64:67]
v_mfma_f32_16x16x32_bf16 v[52:55], a[104:107], v[28:31], v[52:55]
v_mfma_f32_16x16x32_bf16 v[56:59], a[108:111], v[28:31], v[56:59]
v_mfma_f32_16x16x32_bf16 v[60:63], a[104:107], v[32:35], v[60:63]
v_mfma_f32_16x16x32_bf16 v[64:67], a[108:111], v[32:35], v[64:67]
v_mfma_f32_16x16x32_bf16 v[52:55], a[112:115], v[36:39], v[52:55]
v_mfma_f32_16x16x32_bf16 v[56:59], a[116:119], v[36:39], v[56:59]
v_mfma_f32_16x16x32_bf16 v[60:63], a[112:115], v[40:43], v[60:63]
v_mfma_f32_16x16x32_bf16 v[64:67], a[116:119], v[40:43], v[64:67]
v_mfma_f32_16x16x32_bf16 v[52:55], a[120:123], v[44:47], v[52:55]
v_mfma_f32_16x16x32_bf16 v[56:59], a[124:127], v[44:47], v[56:59]
v_mfma_f32_16x16x32_bf16 v[60:63], a[120:123], v[48:51], v[60:63]
v_mfma_f32_16x16x32_bf16 v[64:67], a[124:127], v[48:51], v[64:67]
s_waitcnt vmcnt(18)
ds_read_b64_tr_b16 a[128:129], v17 offset:8192
ds_read_b64_tr_b16 a[130:131], v17 offset:8448
ds_read_b64_tr_b16 a[132:133], v17 offset:8200
ds_read_b64_tr_b16 a[134:135], v17 offset:8456
ds_read_b64_tr_b16 a[136:137], v17 offset:10240
ds_read_b64_tr_b16 a[138:139], v17 offset:10496
ds_read_b64_tr_b16 a[140:141], v17 offset:10248
ds_read_b64_tr_b16 a[142:143], v17 offset:10504
s_waitcnt lgkmcnt(0)
ds_read_b64_tr_b16 a[144:145], v17 offset:12288
ds_read_b64_tr_b16 a[146:147], v17 offset:12544
ds_read_b64_tr_b16 a[148:149], v17 offset:12296
ds_read_b64_tr_b16 a[150:151], v17 offset:12552
ds_read_b64_tr_b16 a[152:153], v17 offset:14336
ds_read_b64_tr_b16 a[154:155], v17 offset:14592
ds_read_b64_tr_b16 a[156:157], v17 offset:14344
ds_read_b64_tr_b16 a[158:159], v17 offset:14600
s_waitcnt lgkmcnt(0)
s_mov_b32 s44, 7340032
buffer_load_dword v250, v12, s[4:7], s44 offen
s_add_u32 m0, s45, 8192
s_mov_b32 s44, 7340032
buffer_load_dwordx4 v16, s[4:7], s44 offen lds
s_add_u32 m0, s45, 9216
s_mov_b32 s44, 7471104
buffer_load_dwordx4 v16, s[4:7], s44 offen lds
s_add_u32 m0, s45, 10240
s_mov_b32 s44, 7602176
buffer_load_dwordx4 v16, s[4:7], s44 offen lds
s_add_u32 m0, s45, 11264
s_mov_b32 s44, 7733248
buffer_load_dwordx4 v16, s[4:7], s44 offen lds
s_add_u32 m0, s45, 12288
s_mov_b32 s44, 7864320
buffer_load_dwordx4 v16, s[4:7], s44 offen lds
s_add_u32 m0, s45, 13312
s_mov_b32 s44, 7995392
buffer_load_dwordx4 v16, s[4:7], s44 offen lds
s_add_u32 m0, s45, 14336
s_mov_b32 s44, 8126464
buffer_load_dwordx4 v16, s[4:7], s44 offen lds
s_add_u32 m0, s45, 15360
s_mov_b32 s44, 8257536
buffer_load_dwordx4 v16, s[4:7], s44 offen lds
ds_read_b128 v[20:23], v8 offset:32768
ds_read_b128 v[24:27], v8 offset:34816
ds_read_b128 v[28:31], v9 offset:32768
ds_read_b128 v[32:35], v9 offset:34816
ds_read_b128 v[36:39], v8 offset:36864
ds_read_b128 v[40:43], v8 offset:38912
ds_read_b128 v[44:47], v9 offset:36864
ds_read_b128 v[48:51], v9 offset:38912
s_waitcnt lgkmcnt(0)
v_mfma_f32_16x16x32_bf16 v[52:55], a[128:131], v[20:23], v[52:55]
v_mfma_f32_16x16x32_bf16 v[56:59], a[132:135], v[20:23], v[56:59]
v_mfma_f32_16x16x32_bf16 v[60:63], a[128:131], v[24:27], v[60:63]
v_mfma_f32_16x16x32_bf16 v[64:67], a[132:135], v[24:27], v[64:67]
v_mfma_f32_16x16x32_bf16 v[52:55], a[136:139], v[28:31], v[52:55]
v_mfma_f32_16x16x32_bf16 v[56:59], a[140:143], v[28:31], v[56:59]
v_mfma_f32_16x16x32_bf16 v[60:63], a[136:139], v[32:35], v[60:63]
v_mfma_f32_16x16x32_bf16 v[64:67], a[140:143], v[32:35], v[64:67]
v_mfma_f32_16x16x32_bf16 v[52:55], a[144:147], v[36:39], v[52:55]
v_mfma_f32_16x16x32_bf16 v[56:59], a[148:151], v[36:39], v[56:59]
v_mfma_f32_16x16x32_bf16 v[60:63], a[144:147], v[40:43], v[60:63]
v_mfma_f32_16x16x32_bf16 v[64:67], a[148:151], v[40:43], v[64:67]
v_mfma_f32_16x16x32_bf16 v[52:55], a[152:155], v[44:47], v[52:55]
v_mfma_f32_16x16x32_bf16 v[56:59], a[156:159], v[44:47], v[56:59]
v_mfma_f32_16x16x32_bf16 v[60:63], a[152:155], v[48:51], v[60:63]
v_mfma_f32_16x16x32_bf16 v[64:67], a[156:159], v[48:51], v[64:67]
s_waitcnt vmcnt(18)
ds_read_b64_tr_b16 a[160:161], v17 offset:16384
ds_read_b64_tr_b16 a[162:163], v17 offset:16640
ds_read_b64_tr_b16 a[164:165], v17 offset:16392
ds_read_b64_tr_b16 a[166:167], v17 offset:16648
ds_read_b64_tr_b16 a[168:169], v17 offset:18432
ds_read_b64_tr_b16 a[170:171], v17 offset:18688
ds_read_b64_tr_b16 a[172:173], v17 offset:18440
ds_read_b64_tr_b16 a[174:175], v17 offset:18696
s_waitcnt lgkmcnt(0)
ds_read_b64_tr_b16 a[176:177], v17 offset:20480
ds_read_b64_tr_b16 a[178:179], v17 offset:20736
ds_read_b64_tr_b16 a[180:181], v17 offset:20488
ds_read_b64_tr_b16 a[182:183], v17 offset:20744
ds_read_b64_tr_b16 a[184:185], v17 offset:22528
ds_read_b64_tr_b16 a[186:187], v17 offset:22784
ds_read_b64_tr_b16 a[188:189], v17 offset:22536
ds_read_b64_tr_b16 a[190:191], v17 offset:22792
s_waitcnt lgkmcnt(0)
ds_read_b128 v[20:23], v8 offset:40960
ds_read_b128 v[24:27], v8 offset:43008
ds_read_b128 v[28:31], v9 offset:40960
ds_read_b128 v[32:35], v9 offset:43008
ds_read_b128 v[36:39], v8 offset:45056
ds_read_b128 v[40:43], v8 offset:47104
ds_read_b128 v[44:47], v9 offset:45056
ds_read_b128 v[48:51], v9 offset:47104
s_waitcnt lgkmcnt(0)
v_mfma_f32_16x16x32_bf16 v[52:55], a[160:163], v[20:23], v[52:55]
v_mfma_f32_16x16x32_bf16 v[56:59], a[164:167], v[20:23], v[56:59]
v_mfma_f32_16x16x32_bf16 v[60:63], a[160:163], v[24:27], v[60:63]
v_mfma_f32_16x16x32_bf16 v[64:67], a[164:167], v[24:27], v[64:67]
v_mfma_f32_16x16x32_bf16 v[52:55], a[168:171], v[28:31], v[52:55]
v_mfma_f32_16x16x32_bf16 v[56:59], a[172:175], v[28:31], v[56:59]
v_mfma_f32_16x16x32_bf16 v[60:63], a[168:171], v[32:35], v[60:63]
v_mfma_f32_16x16x32_bf16 v[64:67], a[172:175], v[32:35], v[64:67]
v_mfma_f32_16x16x32_bf16 v[52:55], a[176:179], v[36:39], v[52:55]
v_mfma_f32_16x16x32_bf16 v[56:59], a[180:183], v[36:39], v[56:59]
v_mfma_f32_16x16x32_bf16 v[60:63], a[176:179], v[40:43], v[60:63]
v_mfma_f32_16x16x32_bf16 v[64:67], a[180:183], v[40:43], v[64:67]
v_mfma_f32_16x16x32_bf16 v[52:55], a[184:187], v[44:47], v[52:55]
v_mfma_f32_16x16x32_bf16 v[56:59], a[188:191], v[44:47], v[56:59]
v_mfma_f32_16x16x32_bf16 v[60:63], a[184:187], v[48:51], v[60:63]
v_mfma_f32_16x16x32_bf16 v[64:67], a[188:191], v[48:51], v[64:67]
s_waitcnt vmcnt(9)
ds_read_b64_tr_b16 a[192:193], v17 offset:0
ds_read_b64_tr_b16 a[194:195], v17 offset:256
ds_read_b64_tr_b16 a[196:197], v17 offset:8
ds_read_b64_tr_b16 a[198:199], v17 offset:264
ds_read_b64_tr_b16 a[200:201], v17 offset:2048
ds_read_b64_tr_b16 a[202:203], v17 offset:2304
ds_read_b64_tr_b16 a[204:205], v17 offset:2056
ds_read_b64_tr_b16 a[206:207], v17 offset:2312
s_waitcnt lgkmcnt(0)
ds_read_b64_tr_b16 a[208:209], v17 offset:4096
ds_read_b64_tr_b16 a[210:211], v17 offset:4352
ds_read_b64_tr_b16 a[212:213], v17 offset:4104
ds_read_b64_tr_b16 a[214:215], v17 offset:4360
ds_read_b64_tr_b16 a[216:217], v17 offset:6144
ds_read_b64_tr_b16 a[218:219], v17 offset:6400
ds_read_b64_tr_b16 a[220:221], v17 offset:6152
ds_read_b64_tr_b16 a[222:223], v17 offset:6408
s_waitcnt lgkmcnt(0)
ds_read_b128 v[20:23], v8 offset:49152
ds_read_b128 v[24:27], v8 offset:51200
ds_read_b128 v[28:31], v9 offset:49152
ds_read_b128 v[32:35], v9 offset:51200
ds_read_b128 v[36:39], v8 offset:53248
ds_read_b128 v[40:43], v8 offset:55296
ds_read_b128 v[44:47], v9 offset:53248
ds_read_b128 v[48:51], v9 offset:55296
s_waitcnt lgkmcnt(0)
v_mfma_f32_16x16x32_bf16 v[52:55], a[192:195], v[20:23], v[52:55]
v_mfma_f32_16x16x32_bf16 v[56:59], a[196:199], v[20:23], v[56:59]
v_mfma_f32_16x16x32_bf16 v[60:63], a[192:195], v[24:27], v[60:63]
v_mfma_f32_16x16x32_bf16 v[64:67], a[196:199], v[24:27], v[64:67]
v_mfma_f32_16x16x32_bf16 v[52:55], a[200:203], v[28:31], v[52:55]
v_mfma_f32_16x16x32_bf16 v[56:59], a[204:207], v[28:31], v[56:59]
v_mfma_f32_16x16x32_bf16 v[60:63], a[200:203], v[32:35], v[60:63]
v_mfma_f32_16x16x32_bf16 v[64:67], a[204:207], v[32:35], v[64:67]
v_mfma_f32_16x16x32_bf16 v[52:55], a[208:211], v[36:39], v[52:55]
v_mfma_f32_16x16x32_bf16 v[56:59], a[212:215], v[36:39], v[56:59]
v_mfma_f32_16x16x32_bf16 v[60:63], a[208:211], v[40:43], v[60:63]
v_mfma_f32_16x16x32_bf16 v[64:67], a[212:215], v[40:43], v[64:67]
v_mfma_f32_16x16x32_bf16 v[52:55], a[216:219], v[44:47], v[52:55]
v_mfma_f32_16x16x32_bf16 v[56:59], a[220:223], v[44:47], v[56:59]
v_mfma_f32_16x16x32_bf16 v[60:63], a[216:219], v[48:51], v[60:63]
v_mfma_f32_16x16x32_bf16 v[64:67], a[220:223], v[48:51], v[64:67]
s_waitcnt vmcnt(0)
ds_read_b64_tr_b16 a[224:225], v17 offset:8192
ds_read_b64_tr_b16 a[226:227], v17 offset:8448
ds_read_b64_tr_b16 a[228:229], v17 offset:8200
ds_read_b64_tr_b16 a[230:231], v17 offset:8456
ds_read_b64_tr_b16 a[232:233], v17 offset:10240
ds_read_b64_tr_b16 a[234:235], v17 offset:10496
ds_read_b64_tr_b16 a[236:237], v17 offset:10248
ds_read_b64_tr_b16 a[238:239], v17 offset:10504
s_waitcnt lgkmcnt(0)
ds_read_b64_tr_b16 a[240:241], v17 offset:12288
ds_read_b64_tr_b16 a[242:243], v17 offset:12544
ds_read_b64_tr_b16 a[244:245], v17 offset:12296
ds_read_b64_tr_b16 a[246:247], v17 offset:12552
ds_read_b64_tr_b16 a[248:249], v17 offset:14336
ds_read_b64_tr_b16 a[250:251], v17 offset:14592
ds_read_b64_tr_b16 a[252:253], v17 offset:14344
ds_read_b64_tr_b16 a[254:255], v17 offset:14600
s_waitcnt lgkmcnt(0)
ds_read_b128 v[20:23], v8 offset:57344
ds_read_b128 v[24:27], v8 offset:59392
ds_read_b128 v[28:31], v9 offset:57344
ds_read_b128 v[32:35], v9 offset:59392
ds_read_b128 v[36:39], v8 offset:61440
ds_read_b128 v[40:43], v8 offset:63488
ds_read_b128 v[44:47], v9 offset:61440
ds_read_b128 v[48:51], v9 offset:63488
s_waitcnt lgkmcnt(0)
v_mfma_f32_16x16x32_bf16 v[52:55], a[224:227], v[20:23], v[52:55]
v_mfma_f32_16x16x32_bf16 v[56:59], a[228:231], v[20:23], v[56:59]
v_mfma_f32_16x16x32_bf16 v[60:63], a[224:227], v[24:27], v[60:63]
v_mfma_f32_16x16x32_bf16 v[64:67], a[228:231], v[24:27], v[64:67]
v_mfma_f32_16x16x32_bf16 v[52:55], a[232:235], v[28:31], v[52:55]
v_mfma_f32_16x16x32_bf16 v[56:59], a[236:239], v[28:31], v[56:59]
v_mfma_f32_16x16x32_bf16 v[60:63], a[232:235], v[32:35], v[60:63]
v_mfma_f32_16x16x32_bf16 v[64:67], a[236:239], v[32:35], v[64:67]
v_mfma_f32_16x16x32_bf16 v[52:55], a[240:243], v[36:39], v[52:55]
v_mfma_f32_16x16x32_bf16 v[56:59], a[244:247], v[36:39], v[56:59]
v_mfma_f32_16x16x32_bf16 v[60:63], a[240:243], v[40:43], v[60:63]
v_mfma_f32_16x16x32_bf16 v[64:67], a[244:247], v[40:43], v[64:67]
v_mfma_f32_16x16x32_bf16 v[52:55], a[248:251], v[44:47], v[52:55]
v_mfma_f32_16x16x32_bf16 v[56:59], a[252:255], v[44:47], v[56:59]
v_mfma_f32_16x16x32_bf16 v[60:63], a[248:251], v[48:51], v[60:63]
v_mfma_f32_16x16x32_bf16 v[64:67], a[252:255], v[48:51], v[64:67]
s_barrier
s_mov_b32 s50, 0x10000
s_add_u32 m0, s46, 65536
s_nop 0
buffer_load_dwordx4 v6, s[8:11], s50 offen offset:0 lds
s_add_u32 m0, s46, 69504
s_nop 0
buffer_load_dwordx4 v6, s[8:11], s50 offen offset:128 lds
s_add_u32 m0, s46, 73472
s_nop 0
buffer_load_dwordx4 v6, s[8:11], s50 offen offset:256 lds
s_add_u32 m0, s46, 77440
s_nop 0
buffer_load_dwordx4 v6, s[8:11], s50 offen offset:384 lds
s_add_u32 m0, s46, 81408
s_nop 0
buffer_load_dwordx4 v6, s[8:11], s50 offen offset:512 lds
s_add_u32 m0, s46, 85376
s_nop 0
buffer_load_dwordx4 v6, s[8:11], s50 offen offset:640 lds
s_add_u32 m0, s46, 89344
s_nop 0
buffer_load_dwordx4 v6, s[8:11], s50 offen offset:768 lds
s_add_u32 m0, s46, 93312
s_nop 0
buffer_load_dwordx4 v6, s[8:11], s50 offen offset:896 lds
s_add_u32 m0, s46, 97280
s_nop 0
buffer_load_dwordx4 v6, s[8:11], s50 offen offset:1024 lds
s_add_u32 m0, s46, 101248
s_nop 0
buffer_load_dwordx4 v6, s[8:11], s50 offen offset:1152 lds
s_add_u32 m0, s46, 105216
s_nop 0
buffer_load_dwordx4 v6, s[8:11], s50 offen offset:1280 lds
s_add_u32 m0, s46, 109184
s_nop 0
buffer_load_dwordx4 v6, s[8:11], s50 offen offset:1408 lds
s_add_u32 m0, s46, 113152
s_nop 0
buffer_load_dwordx4 v6, s[8:11], s50 offen offset:1536 lds
s_add_u32 m0, s46, 117120
s_nop 0
buffer_load_dwordx4 v6, s[8:11], s50 offen offset:1664 lds
s_add_u32 m0, s46, 121088
s_nop 0
buffer_load_dwordx4 v6, s[8:11], s50 offen offset:1792 lds
s_add_u32 m0, s46, 125056
s_nop 0
buffer_load_dwordx4 v6, s[8:11], s50 offen offset:1920 lds
s_and_b32 s53, s47, 31
s_lshl_b32 s53, s53, 4
v_add_u32 v19, s53, v1
v_lshlrev_b32 v19, 7, v19
s_mov_b32 s42, 1
v_and_b32 v3, 15, v0
v_lshlrev_b32 v3, 4, v3
s_branch mega_kernel_syk
mega_kernel_sykw:
s_sleep 4
mega_kernel_syk:
buffer_load_dword v2, v3, s[72:75], 0 offen sc1
s_waitcnt vmcnt(0)
mega_kernel_sykp:
s_cmp_eq_u32 s95, 1
s_cbranch_scc0 mega_kernel_sykf
v_readlane_b32 s76, v2, 14
s_mov_b32 s98, 0
s_cmp_eq_u32 s76, 32
s_cbranch_scc0 mega_kernel_sykw
s_branch mega_kernel_sykd
mega_kernel_sykf:
s_mov_b32 s77, 0
s_mov_b32 s78, 0
v_readlane_b32 s76, v2, 0
s_add_u32 s77, s77, s76
s_xor_b32 s76, s76, 32
s_or_b32 s78, s78, s76
v_readlane_b32 s76, v2, 1
s_add_u32 s77, s77, s76
s_xor_b32 s76, s76, 32
s_or_b32 s78, s78, s76
v_readlane_b32 s76, v2, 2
s_add_u32 s77, s77, s76
s_xor_b32 s76, s76, 32
s_or_b32 s78, s78, s76
v_readlane_b32 s76, v2, 3
s_add_u32 s77, s77, s76
s_xor_b32 s76, s76, 32
s_or_b32 s78, s78, s76
v_readlane_b32 s76, v2, 4
s_add_u32 s77, s77, s76
s_xor_b32 s76, s76, 32
s_or_b32 s78, s78, s76
v_readlane_b32 s76, v2, 5
s_add_u32 s77, s77, s76
s_xor_b32 s76, s76, 32
s_or_b32 s78, s78, s76
v_readlane_b32 s76, v2, 6
s_add_u32 s77, s77, s76
s_xor_b32 s76, s76, 32
s_or_b32 s78, s78, s76
v_readlane_b32 s76, v2, 7
s_add_u32 s77, s77, s76
s_xor_b32 s76, s76, 32
s_or_b32 s78, s78, s76
s_cmp_eq_u32 s77, 256
s_cbranch_scc0 mega_kernel_sykw
v_mov_b32 v252, v2
s_cmp_eq_u32 s78, 0
s_cbranch_scc0 mega_kernel_slowent
v_readlane_b32 s76, v2, 10
v_readlane_b32 s77, v2, 8
s_cmp_eq_u32 s76, 32
s_cbranch_scc0 mega_kernel_sykw
s_cmp_gt_u32 s77, 16
s_cselect_b32 s98, 1, 0
mega_kernel_sykd:
s_lshr_b32 s44, s47, 3
s_xor_b32 s44, s44, s98
s_and_b32 s44, s44, 1
s_lshl_b32 s44, s44, 13
s_lshl_b32 s48, s47, 18
s_add_u32 s48, s48, s44
s_add_u32 s48, s48, 0
s_xor_b32 s44, s98, 1
s_lshl_b32 s44, s44, 13
s_lshl_b32 s49, s40, 7
s_add_u32 s49, s49, s44
s_lshl_b32 s44, s41, 2
s_add_u32 s49, s49, s44
s_add_u32 s49, s49, 69206016
v_mov_b32 v16, 0
v_cvt_pk_bf16_f32 v84, v52, v53
v_cvt_pk_bf16_f32 v85, v54, v55
v_cvt_pk_bf16_f32 v86, v56, v57
v_cvt_pk_bf16_f32 v87, v58, v59
v_cvt_pk_bf16_f32 v88, v60, v61
v_cvt_pk_bf16_f32 v89, v62, v63
v_cvt_pk_bf16_f32 v90, v64, v65
v_cvt_pk_bf16_f32 v91, v66, v67
s_add_u32 s51, s42, s47
s_sub_u32 s51, s51, 1
s_bfe_u32 s52, s51, 0x40002
s_lshl_b32 s52, s52, 14
s_and_b32 s51, s51, 3
s_lshl_b32 s51, s51, 11
s_add_u32 s51, s51, s52
s_add_u32 s51, s51, s48
buffer_store_dwordx4 v[84:87], v7, s[84:87], s51 offen sc1
buffer_store_dwordx4 v[88:91], v7, s[84:87], s51 offen offset:1024 sc1
s_waitcnt vmcnt(0)
v_mov_b32 v17, s42
s_mov_b64 exec, 1
buffer_store_dword v17, v16, s[84:87], s49 offen sc1
s_mov_b64 exec, -1
mega_kernel_k_loop:
s_waitcnt vmcnt(2)
s_barrier
s_add_u32 s50, s42, 1
s_min_u32 s50, s50, 63
s_lshl_b32 s50, s50, 16
ds_read_b128 v[20:23], v10 offset:0
ds_read_b128 v[24:27], v10 offset:2048
ds_read_b128 v[28:31], v11 offset:0
ds_read_b128 v[32:35], v11 offset:2048
ds_read_b128 v[36:39], v10 offset:4096
ds_read_b128 v[40:43], v10 offset:6144
s_waitcnt lgkmcnt(4)
v_mfma_f32_16x16x32_bf16 v[68:71], a[0:3], v[20:23], 0
ds_read_b128 v[44:47], v11 offset:4096
v_mfma_f32_16x16x32_bf16 v[72:75], a[4:7], v[20:23], 0
v_cvt_pk_bf16_f32 v84, v52, v53
v_cvt_pk_bf16_f32 v85, v54, v55
v_cvt_pk_bf16_f32 v86, v56, v57
v_mfma_f32_16x16x32_bf16 v[76:79], a[0:3], v[24:27], 0
ds_read_b128 v[48:51], v11 offset:6144
v_mfma_f32_16x16x32_bf16 v[80:83], a[4:7], v[24:27], 0
v_cvt_pk_bf16_f32 v87, v58, v59
v_cvt_pk_bf16_f32 v88, v60, v61
v_cvt_pk_bf16_f32 v89, v62, v63
s_waitcnt lgkmcnt(4)
v_mfma_f32_16x16x32_bf16 v[68:71], a[8:11], v[28:31], v[68:71]
ds_read_b128 v[20:23], v10 offset:8192
v_mfma_f32_16x16x32_bf16 v[72:75], a[12:15], v[28:31], v[72:75]
v_cvt_pk_bf16_f32 v90, v64, v65
v_cvt_pk_bf16_f32 v91, v66, v67
v_mfma_f32_16x16x32_bf16 v[76:79], a[8:11], v[32:35], v[76:79]
ds_read_b128 v[24:27], v10 offset:10240
v_mfma_f32_16x16x32_bf16 v[80:83], a[12:15], v[32:35], v[80:83]
s_add_u32 s51, s42, s47
s_sub_u32 s51, s51, 1
s_bfe_u32 s52, s51, 0x40002
s_lshl_b32 s52, s52, 14
s_waitcnt lgkmcnt(4)
v_mfma_f32_16x16x32_bf16 v[68:71], a[16:19], v[36:39], v[68:71]
ds_read_b128 v[28:31], v11 offset:8192
v_mfma_f32_16x16x32_bf16 v[72:75], a[20:23], v[36:39], v[72:75]
s_and_b32 s51, s51, 3
s_lshl_b32 s51, s51, 11
s_add_u32 s51, s51, s52
s_add_u32 s51, s51, s48
buffer_store_dwordx4 v[84:87], v7, s[84:87], s51 offen sc1
v_mfma_f32_16x16x32_bf16 v[76:79], a[16:19], v[40:43], v[76:79]
ds_read_b128 v[32:35], v11 offset:10240
v_mfma_f32_16x16x32_bf16 v[80:83], a[20:23], v[40:43], v[80:83]
buffer_store_dwordx4 v[88:91], v7, s[84:87], s51 offen offset:1024 sc1
s_waitcnt lgkmcnt(4)
v_mfma_f32_16x16x32_bf16 v[68:71], a[24:27], v[44:47], v[68:71]
ds_read_b128 v[36:39], v10 offset:12288
v_mfma_f32_16x16x32_bf16 v[72:75], a[28:31], v[44:47], v[72:75]
s_add_u32 m0, s46, 0
v_mfma_f32_16x16x32_bf16 v[76:79], a[24:27], v[48:51], v[76:79]
ds_read_b128 v[40:43], v10 offset:14336
v_mfma_f32_16x16x32_bf16 v[80:83], a[28:31], v[48:51], v[80:83]
buffer_load_dwordx4 v6, s[8:11], s50 offen offset:0 lds
s_waitcnt lgkmcnt(4)
v_mfma_f32_16x16x32_bf16 v[68:71], a[32:35], v[20:23], v[68:71]
ds_read_b128 v[44:47], v11 offset:12288
v_mfma_f32_16x16x32_bf16 v[72:75], a[36:39], v[20:23], v[72:75]
s_add_u32 m0, s46, 3968
v_mfma_f32_16x16x32_bf16 v[76:79], a[32:35], v[24:27], v[76:79]
ds_read_b128 v[48:51], v11 offset:14336
v_mfma_f32_16x16x32_bf16 v[80:83], a[36:39], v[24:27], v[80:83]
buffer_load_dwordx4 v6, s[8:11], s50 offen offset:128 lds
s_waitcnt lgkmcnt(4)
v_mfma_f32_16x16x32_bf16 v[68:71], a[40:43], v[28:31], v[68:71]
ds_read_b128 v[20:23], v10 offset:16384
v_mfma_f32_16x16x32_bf16 v[72:75], a[44:47], v[28:31], v[72:75]
s_add_u32 m0, s46, 7936
v_mfma_f32_16x16x32_bf16 v[76:79], a[40:43], v[32:35], v[76:79]
ds_read_b128 v[24:27], v10 offset:18432
v_mfma_f32_16x16x32_bf16 v[80:83], a[44:47], v[32:35], v[80:83]
buffer_load_dwordx4 v6, s[8:11], s50 offen offset:256 lds
s_waitcnt lgkmcnt(4)
v_mfma_f32_16x16x32_bf16 v[68:71], a[48:51], v[36:39], v[68:71]
ds_read_b128 v[28:31], v11 offset:16384
v_mfma_f32_16x16x32_bf16 v[72:75], a[52:55], v[36:39], v[72:75]
s_add_u32 m0, s46, 11904
v_mfma_f32_16x16x32_bf16 v[76:79], a[48:51], v[40:43], v[76:79]
ds_read_b128 v[32:35], v11 offset:18432
v_mfma_f32_16x16x32_bf16 v[80:83], a[52:55], v[40:43], v[80:83]
buffer_load_dwordx4 v6, s[8:11], s50 offen offset:384 lds
s_waitcnt lgkmcnt(4)
v_mfma_f32_16x16x32_bf16 v[68:71], a[56:59], v[44:47], v[68:71]
ds_read_b128 v[36:39], v10 offset:20480
v_mfma_f32_16x16x32_bf16 v[72:75], a[60:63], v[44:47], v[72:75]
s_add_u32 m0, s46, 15872
v_mfma_f32_16x16x32_bf16 v[76:79], a[56:59], v[48:51], v[76:79]
ds_read_b128 v[40:43], v10 offset:22528
v_mfma_f32_16x16x32_bf16 v[80:83], a[60:63], v[48:51], v[80:83]
buffer_load_dwordx4 v6, s[8:11], s50 offen offset:512 lds
s_waitcnt lgkmcnt(4)
v_mfma_f32_16x16x32_bf16 v[68:71], a[64:67], v[20:23], v[68:71]
ds_read_b128 v[44:47], v11 offset:20480
v_mfma_f32_16x16x32_bf16 v[72:75], a[68:71], v[20:23], v[72:75]
s_add_u32 m0, s46, 19840
v_mfma_f32_16x16x32_bf16 v[76:79], a[64:67], v[24:27], v[76:79]
ds_read_b128 v[48:51], v11 offset:22528
v_mfma_f32_16x16x32_bf16 v[80:83], a[68:71], v[24:27], v[80:83]
buffer_load_dwordx4 v6, s[8:11], s50 offen offset:640 lds
s_waitcnt lgkmcnt(4)
v_mfma_f32_16x16x32_bf16 v[68:71], a[72:75], v[28:31], v[68:71]
ds_read_b128 v[20:23], v10 offset:24576
v_mfma_f32_16x16x32_bf16 v[72:75], a[76:79], v[28:31], v[72:75]
s_add_u32 m0, s46, 23808
v_mfma_f32_16x16x32_bf16 v[76:79], a[72:75], v[32:35], v[76:79]
ds_read_b128 v[24:27], v10 offset:26624
v_mfma_f32_16x16x32_bf16 v[80:83], a[76:79], v[32:35], v[80:83]
buffer_load_dwordx4 v6, s[8:11], s50 offen offset:768 lds
s_waitcnt lgkmcnt(4)
v_mfma_f32_16x16x32_bf16 v[68:71], a[80:83], v[36:39], v[68:71]
ds_read_b128 v[28:31], v11 offset:24576
v_mfma_f32_16x16x32_bf16 v[72:75], a[84:87], v[36:39], v[72:75]
s_add_u32 m0, s46, 27776
v_mfma_f32_16x16x32_bf16 v[76:79], a[80:83], v[40:43], v[76:79]
ds_read_b128 v[32:35], v11 offset:26624
v_mfma_f32_16x16x32_bf16 v[80:83], a[84:87], v[40:43], v[80:83]
buffer_load_dwordx4 v6, s[8:11], s50 offen offset:896 lds
s_waitcnt lgkmcnt(4)
v_mfma_f32_16x16x32_bf16 v[68:71], a[88:91], v[44:47], v[68:71]
ds_read_b128 v[36:39], v10 offset:28672
v_mfma_f32_16x16x32_bf16 v[72:75], a[92:95], v[44:47], v[72:75]
s_add_u32 m0, s46, 31744
v_mfma_f32_16x16x32_bf16 v[76:79], a[88:91], v[48:51], v[76:79]
ds_read_b128 v[40:43], v10 offset:30720
v_mfma_f32_16x16x32_bf16 v[80:83], a[92:95], v[48:51], v[80:83]
buffer_load_dwordx4 v6, s[8:11], s50 offen offset:1024 lds
s_waitcnt lgkmcnt(4)
v_mfma_f32_16x16x32_bf16 v[68:71], a[96:99], v[20:23], v[68:71]
ds_read_b128 v[44:47], v11 offset:28672
v_mfma_f32_16x16x32_bf16 v[72:75], a[100:103], v[20:23], v[72:75]
s_add_u32 m0, s46, 35712
v_mfma_f32_16x16x32_bf16 v[76:79], a[96:99], v[24:27], v[76:79]
ds_read_b128 v[48:51], v11 offset:30720
v_mfma_f32_16x16x32_bf16 v[80:83], a[100:103], v[24:27], v[80:83]
buffer_load_dwordx4 v6, s[8:11], s50 offen offset:1152 lds
s_waitcnt lgkmcnt(4)
v_mfma_f32_16x16x32_bf16 v[68:71], a[104:107], v[28:31], v[68:71]
ds_read_b128 v[20:23], v10 offset:32768
v_mfma_f32_16x16x32_bf16 v[72:75], a[108:111], v[28:31], v[72:75]
s_add_u32 m0, s46, 39680
v_mfma_f32_16x16x32_bf16 v[76:79], a[104:107], v[32:35], v[76:79]
ds_read_b128 v[24:27], v10 offset:34816
v_mfma_f32_16x16x32_bf16 v[80:83], a[108:111], v[32:35], v[80:83]
buffer_load_dwordx4 v6, s[8:11], s50 offen offset:1280 lds
s_waitcnt lgkmcnt(4)
v_mfma_f32_16x16x32_bf16 v[68:71], a[112:115], v[36:39], v[68:71]
ds_read_b128 v[28:31], v11 offset:32768
v_mfma_f32_16x16x32_bf16 v[72:75], a[116:119], v[36:39], v[72:75]
s_add_u32 m0, s46, 43648
v_mfma_f32_16x16x32_bf16 v[76:79], a[112:115], v[40:43], v[76:79]
ds_read_b128 v[32:35], v11 offset:34816
v_mfma_f32_16x16x32_bf16 v[80:83], a[116:119], v[40:43], v[80:83]
buffer_load_dwordx4 v6, s[8:11], s50 offen offset:1408 lds
s_waitcnt lgkmcnt(4)
v_mfma_f32_16x16x32_bf16 v[68:71], a[120:123], v[44:47], v[68:71]
ds_read_b128 v[36:39], v10 offset:36864
v_mfma_f32_16x16x32_bf16 v[72:75], a[124:127], v[44:47], v[72:75]
s_add_u32 m0, s46, 47616
v_mfma_f32_16x16x32_bf16 v[76:79], a[120:123], v[48:51], v[76:79]
ds_read_b128 v[40:43], v10 offset:38912
v_mfma_f32_16x16x32_bf16 v[80:83], a[124:127], v[48:51], v[80:83]
buffer_load_dwordx4 v6, s[8:11], s50 offen offset:1536 lds
s_waitcnt lgkmcnt(4)
v_mfma_f32_16x16x32_bf16 v[68:71], a[128:131], v[20:23], v[68:71]
ds_read_b128 v[44:47], v11 offset:36864
v_mfma_f32_16x16x32_bf16 v[72:75], a[132:135], v[20:23], v[72:75]
s_add_u32 m0, s46, 51584
v_mfma_f32_16x16x32_bf16 v[76:79], a[128:131], v[24:27], v[76:79]
ds_read_b128 v[48:51], v11 offset:38912
v_mfma_f32_16x16x32_bf16 v[80:83], a[132:135], v[24:27], v[80:83]
buffer_load_dwordx4 v6, s[8:11], s50 offen offset:1664 lds
s_waitcnt lgkmcnt(4)
v_mfma_f32_16x16x32_bf16 v[68:71], a[136:139], v[28:31], v[68:71]
ds_read_b128 v[20:23], v10 offset:40960
v_mfma_f32_16x16x32_bf16 v[72:75], a[140:143], v[28:31], v[72:75]
s_add_u32 m0, s46, 55552
v_mfma_f32_16x16x32_bf16 v[76:79], a[136:139], v[32:35], v[76:79]
ds_read_b128 v[24:27], v10 offset:43008
v_mfma_f32_16x16x32_bf16 v[80:83], a[140:143], v[32:35], v[80:83]
buffer_load_dwordx4 v6, s[8:11], s50 offen offset:1792 lds
s_waitcnt lgkmcnt(4)
v_mfma_f32_16x16x32_bf16 v[68:71], a[144:147], v[36:39], v[68:71]
ds_read_b128 v[28:31], v11 offset:40960
v_mfma_f32_16x16x32_bf16 v[72:75], a[148:151], v[36:39], v[72:75]
s_add_u32 m0, s46, 59520
v_mfma_f32_16x16x32_bf16 v[76:79], a[144:147], v[40:43], v[76:79]
ds_read_b128 v[32:35], v11 offset:43008
v_mfma_f32_16x16x32_bf16 v[80:83], a[148:151], v[40:43], v[80:83]
buffer_load_dwordx4 v6, s[8:11], s50 offen offset:1920 lds
s_waitcnt lgkmcnt(4)
v_mfma_f32_16x16x32_bf16 v[68:71], a[152:155], v[44:47], v[68:71]
ds_read_b128 v[36:39], v10 offset:45056
v_mfma_f32_16x16x32_bf16 v[72:75], a[156:159], v[44:47], v[72:75]
v_mfma_f32_16x16x32_bf16 v[76:79], a[152:155], v[48:51], v[76:79]
ds_read_b128 v[40:43], v10 offset:47104
v_mfma_f32_16x16x32_bf16 v[80:83], a[156:159], v[48:51], v[80:83]
s_waitcnt lgkmcnt(4)
v_mfma_f32_16x16x32_bf16 v[68:71], a[160:163], v[20:23], v[68:71]
ds_read_b128 v[44:47], v11 offset:45056
v_mfma_f32_16x16x32_bf16 v[72:75], a[164:167], v[20:23], v[72:75]
v_mfma_f32_16x16x32_bf16 v[76:79], a[160:163], v[24:27], v[76:79]
ds_read_b128 v[48:51], v11 offset:47104
v_mfma_f32_16x16x32_bf16 v[80:83], a[164:167], v[24:27], v[80:83]
s_waitcnt lgkmcnt(4)
v_mfma_f32_16x16x32_bf16 v[68:71], a[168:171], v[28:31], v[68:71]
ds_read_b128 v[20:23], v10 offset:49152
v_mfma_f32_16x16x32_bf16 v[72:75], a[172:175], v[28:31], v[72:75]
s_waitcnt vmcnt(16)
v_mov_b32 v17, s42
s_mov_b64 exec, 1
buffer_store_dword v17, v16, s[84:87], s49 offen sc1
s_mov_b64 exec, -1
v_mfma_f32_16x16x32_bf16 v[76:79], a[168:171], v[32:35], v[76:79]
ds_read_b128 v[24:27], v10 offset:51200
v_mfma_f32_16x16x32_bf16 v[80:83], a[172:175], v[32:35], v[80:83]
s_waitcnt lgkmcnt(4)
v_mfma_f32_16x16x32_bf16 v[68:71], a[176:179], v[36:39], v[68:71]
ds_read_b128 v[28:31], v11 offset:49152
v_mfma_f32_16x16x32_bf16 v[72:75], a[180:183], v[36:39], v[72:75]
s_add_u32 s53, s42, 3
s_min_u32 s53, s53, 63
s_lshl_b32 s53, s53, 16
s_mov_b64 exec, 0xffff
buffer_load_dword v250, v19, s[8:11], s53 offen
s_mov_b64 exec, -1
v_mfma_f32_16x16x32_bf16 v[76:79], a[176:179], v[40:43], v[76:79]
ds_read_b128 v[32:35], v11 offset:51200
v_mfma_f32_16x16x32_bf16 v[80:83], a[180:183], v[40:43], v[80:83]
s_waitcnt lgkmcnt(4)
v_mfma_f32_16x16x32_bf16 v[68:71], a[184:187], v[44:47], v[68:71]
ds_read_b128 v[36:39], v10 offset:53248
v_mfma_f32_16x16x32_bf16 v[72:75], a[188:191], v[44:47], v[72:75]
v_mfma_f32_16x16x32_bf16 v[76:79], a[184:187], v[48:51], v[76:79]
ds_read_b128 v[40:43], v10 offset:55296
v_mfma_f32_16x16x32_bf16 v[80:83], a[188:191], v[48:51], v[80:83]
s_waitcnt lgkmcnt(4)
v_mfma_f32_16x16x32_bf16 v[68:71], a[192:195], v[20:23], v[68:71]
ds_read_b128 v[44:47], v11 offset:53248
v_mfma_f32_16x16x32_bf16 v[72:75], a[196:199], v[20:23], v[72:75]
v_mfma_f32_16x16x32_bf16 v[76:79], a[192:195], v[24:27], v[76:79]
ds_read_b128 v[48:51], v11 offset:55296
v_mfma_f32_16x16x32_bf16 v[80:83], a[196:199], v[24:27], v[80:83]
s_waitcnt lgkmcnt(4)
v_mfma_f32_16x16x32_bf16 v[68:71], a[200:203], v[28:31], v[68:71]
ds_read_b128 v[20:23], v10 offset:57344
v_mfma_f32_16x16x32_bf16 v[72:75], a[204:207], v[28:31], v[72:75]
v_mfma_f32_16x16x32_bf16 v[76:79], a[200:203], v[32:35], v[76:79]
ds_read_b128 v[24:27], v10 offset:59392
v_mfma_f32_16x16x32_bf16 v[80:83], a[204:207], v[32:35], v[80:83]
s_waitcnt lgkmcnt(4)
v_mfma_f32_16x16x32_bf16 v[68:71], a[208:211], v[36:39], v[68:71]
ds_read_b128 v[28:31], v11 offset:57344
v_mfma_f32_16x16x32_bf16 v[72:75], a[212:215], v[36:39], v[72:75]
v_mfma_f32_16x16x32_bf16 v[76:79], a[208:211], v[40:43], v[76:79]
ds_read_b128 v[32:35], v11 offset:59392
v_mfma_f32_16x16x32_bf16 v[80:83], a[212:215], v[40:43], v[80:83]
s_waitcnt lgkmcnt(4)
v_mfma_f32_16x16x32_bf16 v[68:71], a[216:219], v[44:47], v[68:71]
ds_read_b128 v[36:39], v10 offset:61440
v_mfma_f32_16x16x32_bf16 v[72:75], a[220:223], v[44:47], v[72:75]
v_mfma_f32_16x16x32_bf16 v[76:79], a[216:219], v[48:51], v[76:79]
ds_read_b128 v[40:43], v10 offset:63488
v_mfma_f32_16x16x32_bf16 v[80:83], a[220:223], v[48:51], v[80:83]
s_waitcnt lgkmcnt(4)
v_mfma_f32_16x16x32_bf16 v[68:71], a[224:227], v[20:23], v[68:71]
ds_read_b128 v[44:47], v11 offset:61440
v_mfma_f32_16x16x32_bf16 v[72:75], a[228:231], v[20:23], v[72:75]
v_mfma_f32_16x16x32_bf16 v[76:79], a[224:227], v[24:27], v[76:79]
ds_read_b128 v[48:51], v11 offset:63488
v_mfma_f32_16x16x32_bf16 v[80:83], a[228:231], v[24:27], v[80:83]
s_waitcnt lgkmcnt(5)
v_mfma_f32_16x16x32_bf16 v[68:71], a[232:235], v[28:31], v[68:71]
v_mfma_f32_16x16x32_bf16 v[72:75], a[236:239], v[28:31], v[72:75]
s_waitcnt lgkmcnt(4)
v_mfma_f32_16x16x32_bf16 v[76:79], a[232:235], v[32:35], v[76:79]
v_mfma_f32_16x16x32_bf16 v[80:83], a[236:239], v[32:35], v[80:83]
s_waitcnt lgkmcnt(3)
v_mfma_f32_16x16x32_bf16 v[68:71], a[240:243], v[36:39], v[68:71]
v_mfma_f32_16x16x32_bf16 v[72:75], a[244:247], v[36:39], v[72:75]
s_waitcnt lgkmcnt(2)
v_mfma_f32_16x16x32_bf16 v[76:79], a[240:243], v[40:43], v[76:79]
v_mfma_f32_16x16x32_bf16 v[80:83], a[244:247], v[40:43], v[80:83]
s_waitcnt lgkmcnt(1)
v_mfma_f32_16x16x32_bf16 v[68:71], a[248:251], v[44:47], v[68:71]
v_mfma_f32_16x16x32_bf16 v[72:75], a[252:255], v[44:47], v[72:75]
s_waitcnt lgkmcnt(0)
v_mfma_f32_16x16x32_bf16 v[76:79], a[248:251], v[48:51], v[76:79]
v_mfma_f32_16x16x32_bf16 v[80:83], a[252:255], v[48:51], v[80:83]
s_add_u32 s42, s42, 1
s_cmp_eq_u32 s42, 64
s_cbranch_scc1 mega_kernel_k_fin
mega_kernel_k_mid:
s_waitcnt vmcnt(2)
s_barrier
s_add_u32 s50, s42, 1
s_min_u32 s50, s50, 63
s_lshl_b32 s50, s50, 16
ds_read_b128 v[20:23], v8 offset:0
ds_read_b128 v[24:27], v8 offset:2048
ds_read_b128 v[28:31], v9 offset:0
ds_read_b128 v[32:35], v9 offset:2048
ds_read_b128 v[36:39], v8 offset:4096
ds_read_b128 v[40:43], v8 offset:6144
s_waitcnt lgkmcnt(4)
v_mfma_f32_16x16x32_bf16 v[52:55], a[0:3], v[20:23], 0
ds_read_b128 v[44:47], v9 offset:4096
v_mfma_f32_16x16x32_bf16 v[56:59], a[4:7], v[20:23], 0
v_cvt_pk_bf16_f32 v84, v68, v69
v_cvt_pk_bf16_f32 v85, v70, v71
v_cvt_pk_bf16_f32 v86, v72, v73
v_mfma_f32_16x16x32_bf16 v[60:63], a[0:3], v[24:27], 0
ds_read_b128 v[48:51], v9 offset:6144
v_mfma_f32_16x16x32_bf16 v[64:67], a[4:7], v[24:27], 0
v_cvt_pk_bf16_f32 v87, v74, v75
v_cvt_pk_bf16_f32 v88, v76, v77
v_cvt_pk_bf16_f32 v89, v78, v79
s_waitcnt lgkmcnt(4)
v_mfma_f32_16x16x32_bf16 v[52:55], a[8:11], v[28:31], v[52:55]
ds_read_b128 v[20:23], v8 offset:8192
v_mfma_f32_16x16x32_bf16 v[56:59], a[12:15], v[28:31], v[56:59]
v_cvt_pk_bf16_f32 v90, v80, v81
v_cvt_pk_bf16_f32 v91, v82, v83
v_mfma_f32_16x16x32_bf16 v[60:63], a[8:11], v[32:35], v[60:63]
ds_read_b128 v[24:27], v8 offset:10240
v_mfma_f32_16x16x32_bf16 v[64:67], a[12:15], v[32:35], v[64:67]
s_add_u32 s51, s42, s47
s_sub_u32 s51, s51, 1
s_bfe_u32 s52, s51, 0x40002
s_lshl_b32 s52, s52, 14
s_waitcnt lgkmcnt(4)
v_mfma_f32_16x16x32_bf16 v[52:55], a[16:19], v[36:39], v[52:55]
ds_read_b128 v[28:31], v9 offset:8192
v_mfma_f32_16x16x32_bf16 v[56:59], a[20:23], v[36:39], v[56:59]
s_and_b32 s51, s51, 3
s_lshl_b32 s51, s51, 11
s_add_u32 s51, s51, s52
s_add_u32 s51, s51, s48
buffer_store_dwordx4 v[84:87], v7, s[84:87], s51 offen sc1
v_mfma_f32_16x16x32_bf16 v[60:63], a[16:19], v[40:43], v[60:63]
ds_read_b128 v[32:35], v9 offset:10240
v_mfma_f32_16x16x32_bf16 v[64:67], a[20:23], v[40:43], v[64:67]
buffer_store_dwordx4 v[88:91], v7, s[84:87], s51 offen offset:1024 sc1
s_waitcnt lgkmcnt(4)
v_mfma_f32_16x16x32_bf16 v[52:55], a[24:27], v[44:47], v[52:55]
ds_read_b128 v[36:39], v8 offset:12288
v_mfma_f32_16x16x32_bf16 v[56:59], a[28:31], v[44:47], v[56:59]
s_add_u32 m0, s46, 65536
v_mfma_f32_16x16x32_bf16 v[60:63], a[24:27], v[48:51], v[60:63]
ds_read_b128 v[40:43], v8 offset:14336
v_mfma_f32_16x16x32_bf16 v[64:67], a[28:31], v[48:51], v[64:67]
buffer_load_dwordx4 v6, s[8:11], s50 offen offset:0 lds
s_waitcnt lgkmcnt(4)
v_mfma_f32_16x16x32_bf16 v[52:55], a[32:35], v[20:23], v[52:55]
ds_read_b128 v[44:47], v9 offset:12288
v_mfma_f32_16x16x32_bf16 v[56:59], a[36:39], v[20:23], v[56:59]
s_add_u32 m0, s46, 69504
v_mfma_f32_16x16x32_bf16 v[60:63], a[32:35], v[24:27], v[60:63]
ds_read_b128 v[48:51], v9 offset:14336
v_mfma_f32_16x16x32_bf16 v[64:67], a[36:39], v[24:27], v[64:67]
buffer_load_dwordx4 v6, s[8:11], s50 offen offset:128 lds
s_waitcnt lgkmcnt(4)
v_mfma_f32_16x16x32_bf16 v[52:55], a[40:43], v[28:31], v[52:55]
ds_read_b128 v[20:23], v8 offset:16384
v_mfma_f32_16x16x32_bf16 v[56:59], a[44:47], v[28:31], v[56:59]
s_add_u32 m0, s46, 73472
v_mfma_f32_16x16x32_bf16 v[60:63], a[40:43], v[32:35], v[60:63]
ds_read_b128 v[24:27], v8 offset:18432
v_mfma_f32_16x16x32_bf16 v[64:67], a[44:47], v[32:35], v[64:67]
buffer_load_dwordx4 v6, s[8:11], s50 offen offset:256 lds
s_waitcnt lgkmcnt(4)
v_mfma_f32_16x16x32_bf16 v[52:55], a[48:51], v[36:39], v[52:55]
ds_read_b128 v[28:31], v9 offset:16384
v_mfma_f32_16x16x32_bf16 v[56:59], a[52:55], v[36:39], v[56:59]
s_add_u32 m0, s46, 77440
v_mfma_f32_16x16x32_bf16 v[60:63], a[48:51], v[40:43], v[60:63]
ds_read_b128 v[32:35], v9 offset:18432
v_mfma_f32_16x16x32_bf16 v[64:67], a[52:55], v[40:43], v[64:67]
buffer_load_dwordx4 v6, s[8:11], s50 offen offset:384 lds
s_waitcnt lgkmcnt(4)
v_mfma_f32_16x16x32_bf16 v[52:55], a[56:59], v[44:47], v[52:55]
ds_read_b128 v[36:39], v8 offset:20480
v_mfma_f32_16x16x32_bf16 v[56:59], a[60:63], v[44:47], v[56:59]
s_add_u32 m0, s46, 81408
v_mfma_f32_16x16x32_bf16 v[60:63], a[56:59], v[48:51], v[60:63]
ds_read_b128 v[40:43], v8 offset:22528
v_mfma_f32_16x16x32_bf16 v[64:67], a[60:63], v[48:51], v[64:67]
buffer_load_dwordx4 v6, s[8:11], s50 offen offset:512 lds
s_waitcnt lgkmcnt(4)
v_mfma_f32_16x16x32_bf16 v[52:55], a[64:67], v[20:23], v[52:55]
ds_read_b128 v[44:47], v9 offset:20480
v_mfma_f32_16x16x32_bf16 v[56:59], a[68:71], v[20:23], v[56:59]
s_add_u32 m0, s46, 85376
v_mfma_f32_16x16x32_bf16 v[60:63], a[64:67], v[24:27], v[60:63]
ds_read_b128 v[48:51], v9 offset:22528
v_mfma_f32_16x16x32_bf16 v[64:67], a[68:71], v[24:27], v[64:67]
buffer_load_dwordx4 v6, s[8:11], s50 offen offset:640 lds
s_waitcnt lgkmcnt(4)
v_mfma_f32_16x16x32_bf16 v[52:55], a[72:75], v[28:31], v[52:55]
ds_read_b128 v[20:23], v8 offset:24576
v_mfma_f32_16x16x32_bf16 v[56:59], a[76:79], v[28:31], v[56:59]
s_add_u32 m0, s46, 89344
v_mfma_f32_16x16x32_bf16 v[60:63], a[72:75], v[32:35], v[60:63]
ds_read_b128 v[24:27], v8 offset:26624
v_mfma_f32_16x16x32_bf16 v[64:67], a[76:79], v[32:35], v[64:67]
buffer_load_dwordx4 v6, s[8:11], s50 offen offset:768 lds
s_waitcnt lgkmcnt(4)
v_mfma_f32_16x16x32_bf16 v[52:55], a[80:83], v[36:39], v[52:55]
ds_read_b128 v[28:31], v9 offset:24576
v_mfma_f32_16x16x32_bf16 v[56:59], a[84:87], v[36:39], v[56:59]
s_add_u32 m0, s46, 93312
v_mfma_f32_16x16x32_bf16 v[60:63], a[80:83], v[40:43], v[60:63]
ds_read_b128 v[32:35], v9 offset:26624
v_mfma_f32_16x16x32_bf16 v[64:67], a[84:87], v[40:43], v[64:67]
buffer_load_dwordx4 v6, s[8:11], s50 offen offset:896 lds
s_waitcnt lgkmcnt(4)
v_mfma_f32_16x16x32_bf16 v[52:55], a[88:91], v[44:47], v[52:55]
ds_read_b128 v[36:39], v8 offset:28672
v_mfma_f32_16x16x32_bf16 v[56:59], a[92:95], v[44:47], v[56:59]
s_add_u32 m0, s46, 97280
v_mfma_f32_16x16x32_bf16 v[60:63], a[88:91], v[48:51], v[60:63]
ds_read_b128 v[40:43], v8 offset:30720
v_mfma_f32_16x16x32_bf16 v[64:67], a[92:95], v[48:51], v[64:67]
buffer_load_dwordx4 v6, s[8:11], s50 offen offset:1024 lds
s_waitcnt lgkmcnt(4)
v_mfma_f32_16x16x32_bf16 v[52:55], a[96:99], v[20:23], v[52:55]
ds_read_b128 v[44:47], v9 offset:28672
v_mfma_f32_16x16x32_bf16 v[56:59], a[100:103], v[20:23], v[56:59]
s_add_u32 m0, s46, 101248
v_mfma_f32_16x16x32_bf16 v[60:63], a[96:99], v[24:27], v[60:63]
ds_read_b128 v[48:51], v9 offset:30720
v_mfma_f32_16x16x32_bf16 v[64:67], a[100:103], v[24:27], v[64:67]
buffer_load_dwordx4 v6, s[8:11], s50 offen offset:1152 lds
s_waitcnt lgkmcnt(4)
v_mfma_f32_16x16x32_bf16 v[52:55], a[104:107], v[28:31], v[52:55]
ds_read_b128 v[20:23], v8 offset:32768
v_mfma_f32_16x16x32_bf16 v[56:59], a[108:111], v[28:31], v[56:59]
s_add_u32 m0, s46, 105216
v_mfma_f32_16x16x32_bf16 v[60:63], a[104:107], v[32:35], v[60:63]
ds_read_b128 v[24:27], v8 offset:34816
v_mfma_f32_16x16x32_bf16 v[64:67], a[108:111], v[32:35], v[64:67]
buffer_load_dwordx4 v6, s[8:11], s50 offen offset:1280 lds
s_waitcnt lgkmcnt(4)
v_mfma_f32_16x16x32_bf16 v[52:55], a[112:115], v[36:39], v[52:55]
ds_read_b128 v[28:31], v9 offset:32768
v_mfma_f32_16x16x32_bf16 v[56:59], a[116:119], v[36:39], v[56:59]
s_add_u32 m0, s46, 109184
v_mfma_f32_16x16x32_bf16 v[60:63], a[112:115], v[40:43], v[60:63]
ds_read_b128 v[32:35], v9 offset:34816
v_mfma_f32_16x16x32_bf16 v[64:67], a[116:119], v[40:43], v[64:67]
buffer_load_dwordx4 v6, s[8:11], s50 offen offset:1408 lds
s_waitcnt lgkmcnt(4)
v_mfma_f32_16x16x32_bf16 v[52:55], a[120:123], v[44:47], v[52:55]
ds_read_b128 v[36:39], v8 offset:36864
v_mfma_f32_16x16x32_bf16 v[56:59], a[124:127], v[44:47], v[56:59]
s_add_u32 m0, s46, 113152
v_mfma_f32_16x16x32_bf16 v[60:63], a[120:123], v[48:51], v[60:63]
ds_read_b128 v[40:43], v8 offset:38912
v_mfma_f32_16x16x32_bf16 v[64:67], a[124:127], v[48:51], v[64:67]
buffer_load_dwordx4 v6, s[8:11], s50 offen offset:1536 lds
s_waitcnt lgkmcnt(4)
v_mfma_f32_16x16x32_bf16 v[52:55], a[128:131], v[20:23], v[52:55]
ds_read_b128 v[44:47], v9 offset:36864
v_mfma_f32_16x16x32_bf16 v[56:59], a[132:135], v[20:23], v[56:59]
s_add_u32 m0, s46, 117120
v_mfma_f32_16x16x32_bf16 v[60:63], a[128:131], v[24:27], v[60:63]
ds_read_b128 v[48:51], v9 offset:38912
v_mfma_f32_16x16x32_bf16 v[64:67], a[132:135], v[24:27], v[64:67]
buffer_load_dwordx4 v6, s[8:11], s50 offen offset:1664 lds
s_waitcnt lgkmcnt(4)
v_mfma_f32_16x16x32_bf16 v[52:55], a[136:139], v[28:31], v[52:55]
ds_read_b128 v[20:23], v8 offset:40960
v_mfma_f32_16x16x32_bf16 v[56:59], a[140:143], v[28:31], v[56:59]
s_add_u32 m0, s46, 121088
v_mfma_f32_16x16x32_bf16 v[60:63], a[136:139], v[32:35], v[60:63]
ds_read_b128 v[24:27], v8 offset:43008
v_mfma_f32_16x16x32_bf16 v[64:67], a[140:143], v[32:35], v[64:67]
buffer_load_dwordx4 v6, s[8:11], s50 offen offset:1792 lds
s_waitcnt lgkmcnt(4)
v_mfma_f32_16x16x32_bf16 v[52:55], a[144:147], v[36:39], v[52:55]
ds_read_b128 v[28:31], v9 offset:40960
v_mfma_f32_16x16x32_bf16 v[56:59], a[148:151], v[36:39], v[56:59]
s_add_u32 m0, s46, 125056
v_mfma_f32_16x16x32_bf16 v[60:63], a[144:147], v[40:43], v[60:63]
ds_read_b128 v[32:35], v9 offset:43008
v_mfma_f32_16x16x32_bf16 v[64:67], a[148:151], v[40:43], v[64:67]
buffer_load_dwordx4 v6, s[8:11], s50 offen offset:1920 lds
s_waitcnt lgkmcnt(4)
v_mfma_f32_16x16x32_bf16 v[52:55], a[152:155], v[44:47], v[52:55]
ds_read_b128 v[36:39], v8 offset:45056
v_mfma_f32_16x16x32_bf16 v[56:59], a[156:159], v[44:47], v[56:59]
v_mfma_f32_16x16x32_bf16 v[60:63], a[152:155], v[48:51], v[60:63]
ds_read_b128 v[40:43], v8 offset:47104
v_mfma_f32_16x16x32_bf16 v[64:67], a[156:159], v[48:51], v[64:67]
s_waitcnt lgkmcnt(4)
v_mfma_f32_16x16x32_bf16 v[52:55], a[160:163], v[20:23], v[52:55]
ds_read_b128 v[44:47], v9 offset:45056
v_mfma_f32_16x16x32_bf16 v[56:59], a[164:167], v[20:23], v[56:59]
v_mfma_f32_16x16x32_bf16 v[60:63], a[160:163], v[24:27], v[60:63]
ds_read_b128 v[48:51], v9 offset:47104
v_mfma_f32_16x16x32_bf16 v[64:67], a[164:167], v[24:27], v[64:67]
s_waitcnt lgkmcnt(4)
v_mfma_f32_16x16x32_bf16 v[52:55], a[168:171], v[28:31], v[52:55]
ds_read_b128 v[20:23], v8 offset:49152
v_mfma_f32_16x16x32_bf16 v[56:59], a[172:175], v[28:31], v[56:59]
s_waitcnt vmcnt(16)
v_mov_b32 v17, s42
s_mov_b64 exec, 1
buffer_store_dword v17, v16, s[84:87], s49 offen sc1
s_mov_b64 exec, -1
v_mfma_f32_16x16x32_bf16 v[60:63], a[168:171], v[32:35], v[60:63]
ds_read_b128 v[24:27], v8 offset:51200
v_mfma_f32_16x16x32_bf16 v[64:67], a[172:175], v[32:35], v[64:67]
s_waitcnt lgkmcnt(4)
v_mfma_f32_16x16x32_bf16 v[52:55], a[176:179], v[36:39], v[52:55]
ds_read_b128 v[28:31], v9 offset:49152
v_mfma_f32_16x16x32_bf16 v[56:59], a[180:183], v[36:39], v[56:59]
s_add_u32 s53, s42, 3
s_min_u32 s53, s53, 63
s_lshl_b32 s53, s53, 16
s_mov_b64 exec, 0xffff
buffer_load_dword v250, v19, s[8:11], s53 offen
s_mov_b64 exec, -1
v_mfma_f32_16x16x32_bf16 v[60:63], a[176:179], v[40:43], v[60:63]
ds_read_b128 v[32:35], v9 offset:51200
v_mfma_f32_16x16x32_bf16 v[64:67], a[180:183], v[40:43], v[64:67]
s_waitcnt lgkmcnt(4)
v_mfma_f32_16x16x32_bf16 v[52:55], a[184:187], v[44:47], v[52:55]
ds_read_b128 v[36:39], v8 offset:53248
v_mfma_f32_16x16x32_bf16 v[56:59], a[188:191], v[44:47], v[56:59]
v_mfma_f32_16x16x32_bf16 v[60:63], a[184:187], v[48:51], v[60:63]
ds_read_b128 v[40:43], v8 offset:55296
v_mfma_f32_16x16x32_bf16 v[64:67], a[188:191], v[48:51], v[64:67]
s_waitcnt lgkmcnt(4)
v_mfma_f32_16x16x32_bf16 v[52:55], a[192:195], v[20:23], v[52:55]
ds_read_b128 v[44:47], v9 offset:53248
v_mfma_f32_16x16x32_bf16 v[56:59], a[196:199], v[20:23], v[56:59]
v_mfma_f32_16x16x32_bf16 v[60:63], a[192:195], v[24:27], v[60:63]
ds_read_b128 v[48:51], v9 offset:55296
v_mfma_f32_16x16x32_bf16 v[64:67], a[196:199], v[24:27], v[64:67]
s_waitcnt lgkmcnt(4)
v_mfma_f32_16x16x32_bf16 v[52:55], a[200:203], v[28:31], v[52:55]
ds_read_b128 v[20:23], v8 offset:57344
v_mfma_f32_16x16x32_bf16 v[56:59], a[204:207], v[28:31], v[56:59]
v_mfma_f32_16x16x32_bf16 v[60:63], a[200:203], v[32:35], v[60:63]
ds_read_b128 v[24:27], v8 offset:59392
v_mfma_f32_16x16x32_bf16 v[64:67], a[204:207], v[32:35], v[64:67]
s_waitcnt lgkmcnt(4)
v_mfma_f32_16x16x32_bf16 v[52:55], a[208:211], v[36:39], v[52:55]
ds_read_b128 v[28:31], v9 offset:57344
v_mfma_f32_16x16x32_bf16 v[56:59], a[212:215], v[36:39], v[56:59]
v_mfma_f32_16x16x32_bf16 v[60:63], a[208:211], v[40:43], v[60:63]
ds_read_b128 v[32:35], v9 offset:59392
v_mfma_f32_16x16x32_bf16 v[64:67], a[212:215], v[40:43], v[64:67]
s_waitcnt lgkmcnt(4)
v_mfma_f32_16x16x32_bf16 v[52:55], a[216:219], v[44:47], v[52:55]
ds_read_b128 v[36:39], v8 offset:61440
v_mfma_f32_16x16x32_bf16 v[56:59], a[220:223], v[44:47], v[56:59]
v_mfma_f32_16x16x32_bf16 v[60:63], a[216:219], v[48:51], v[60:63]
ds_read_b128 v[40:43], v8 offset:63488
v_mfma_f32_16x16x32_bf16 v[64:67], a[220:223], v[48:51], v[64:67]
s_waitcnt lgkmcnt(4)
v_mfma_f32_16x16x32_bf16 v[52:55], a[224:227], v[20:23], v[52:55]
ds_read_b128 v[44:47], v9 offset:61440
v_mfma_f32_16x16x32_bf16 v[56:59], a[228:231], v[20:23], v[56:59]
v_mfma_f32_16x16x32_bf16 v[60:63], a[224:227], v[24:27], v[60:63]
ds_read_b128 v[48:51], v9 offset:63488
v_mfma_f32_16x16x32_bf16 v[64:67], a[228:231], v[24:27], v[64:67]
s_waitcnt lgkmcnt(5)
v_mfma_f32_16x16x32_bf16 v[52:55], a[232:235], v[28:31], v[52:55]
v_mfma_f32_16x16x32_bf16 v[56:59], a[236:239], v[28:31], v[56:59]
s_waitcnt lgkmcnt(4)
v_mfma_f32_16x16x32_bf16 v[60:63], a[232:235], v[32:35], v[60:63]
v_mfma_f32_16x16x32_bf16 v[64:67], a[236:239], v[32:35], v[64:67]
s_waitcnt lgkmcnt(3)
v_mfma_f32_16x16x32_bf16 v[52:55], a[240:243], v[36:39], v[52:55]
v_mfma_f32_16x16x32_bf16 v[56:59], a[244:247], v[36:39], v[56:59]
s_waitcnt lgkmcnt(2)
v_mfma_f32_16x16x32_bf16 v[60:63], a[240:243], v[40:43], v[60:63]
v_mfma_f32_16x16x32_bf16 v[64:67], a[244:247], v[40:43], v[64:67]
s_waitcnt lgkmcnt(1)
v_mfma_f32_16x16x32_bf16 v[52:55], a[248:251], v[44:47], v[52:55]
v_mfma_f32_16x16x32_bf16 v[56:59], a[252:255], v[44:47], v[56:59]
s_waitcnt lgkmcnt(0)
v_mfma_f32_16x16x32_bf16 v[60:63], a[248:251], v[48:51], v[60:63]
v_mfma_f32_16x16x32_bf16 v[64:67], a[252:255], v[48:51], v[64:67]
s_add_u32 s42, s42, 1
s_branch mega_kernel_k_loop
mega_kernel_k_fin:
s_nop 11
v_cvt_pk_bf16_f32 v84, v68, v69
v_cvt_pk_bf16_f32 v85, v70, v71
v_cvt_pk_bf16_f32 v86, v72, v73
v_cvt_pk_bf16_f32 v87, v74, v75
v_cvt_pk_bf16_f32 v88, v76, v77
v_cvt_pk_bf16_f32 v89, v78, v79
v_cvt_pk_bf16_f32 v90, v80, v81
v_cvt_pk_bf16_f32 v91, v82, v83
s_add_u32 s51, s42, s47
s_sub_u32 s51, s51, 1
s_bfe_u32 s52, s51, 0x40002
s_lshl_b32 s52, s52, 14
s_and_b32 s51, s51, 3
s_lshl_b32 s51, s51, 11
s_add_u32 s51, s51, s52
s_add_u32 s51, s51, s48
buffer_store_dwordx4 v[84:87], v7, s[84:87], s51 offen sc1
buffer_store_dwordx4 v[88:91], v7, s[84:87], s51 offen offset:1024 sc1
s_waitcnt vmcnt(0)
v_mov_b32 v17, s42
s_mov_b64 exec, 1
buffer_store_dword v17, v16, s[84:87], s49 offen sc1
s_mov_b64 exec, -1
s_waitcnt vmcnt(0)
s_barrier
s_branch mega_kernel_fft
mega_kernel_rv:
s_load_dwordx2 s[4:5], s[0:1], 32
s_load_dwordx2 s[8:9], s[0:1], 0
v_lshrrev_b32 v2, 6, v0
v_and_b32 v1, 63, v0
v_readfirstlane_b32 s41, v2
v_lshlrev_b32 v5, 4, v1
s_waitcnt lgkmcnt(0)
s_mov_b32 s6, 8388608
s_mov_b32 s7, 0x00020000
s_mov_b32 s10, 4194304
s_mov_b32 s11, 0x00020000
s_lshl_b32 s43, s40, 8
s_lshl_b32 s44, s41, 6
s_add_u32 s48, s43, s44
s_and_b32 s43, s48, 0x7ff
v_add_u32 v19, s43, v1
v_lshlrev_b32 v19, 7, v19
s_mov_b32 s43, 0
buffer_load_dword v250, v19, s[8:11], s43 offen
s_nop 0
v_lshrrev_b32 v2, 3, v1
s_lshl_b32 s43, s41, 3
v_add_u32 v2, s43, v2
v_bfe_u32 v3, v2, 1, 3
v_and_b32 v4, 7, v1
v_xor_b32 v3, v3, v4
v_lshlrev_b32 v6, 11, v2
v_lshl_add_u32 v6, v3, 4, v6
s_lshl_b32 s46, s41, 10
v_and_b32 v2, 15, v1
v_bfe_u32 v3, v2, 1, 3
v_lshrrev_b32 v4, 4, v1
v_xor_b32 v3, v3, v4
v_lshlrev_b32 v8, 7, v2
v_lshl_add_u32 v8, v3, 4, v8
v_xor_b32 v9, 64, v8
v_add_u32 v10, 0x10000, v8
v_add_u32 v11, 0x10000, v9
v_mov_b32 v7, v5
s_lshl_b32 s47, s40, 2
s_add_u32 s47, s47, s41
s_mov_b32 s42, 0
s_mov_b32 s50, 0
s_add_u32 m0, s46, 0
s_nop 0
buffer_load_dwordx4 v6, s[8:11], s50 offen offset:0 lds
s_add_u32 m0, s46, 3968
s_nop 0
buffer_load_dwordx4 v6, s[8:11], s50 offen offset:128 lds
s_add_u32 m0, s46, 7936
s_nop 0
buffer_load_dwordx4 v6, s[8:11], s50 offen offset:256 lds
s_add_u32 m0, s46, 11904
s_nop 0
buffer_load_dwordx4 v6, s[8:11], s50 offen offset:384 lds
s_add_u32 m0, s46, 15872
s_nop 0
buffer_load_dwordx4 v6, s[8:11], s50 offen offset:512 lds
s_add_u32 m0, s46, 19840
s_nop 0
buffer_load_dwordx4 v6, s[8:11], s50 offen offset:640 lds
s_add_u32 m0, s46, 23808
s_nop 0
buffer_load_dwordx4 v6, s[8:11], s50 offen offset:768 lds
s_add_u32 m0, s46, 27776
s_nop 0
buffer_load_dwordx4 v6, s[8:11], s50 offen offset:896 lds
s_add_u32 m0, s46, 31744
s_nop 0
buffer_load_dwordx4 v6, s[8:11], s50 offen offset:1024 lds
s_add_u32 m0, s46, 35712
s_nop 0
buffer_load_dwordx4 v6, s[8:11], s50 offen offset:1152 lds
s_add_u32 m0, s46, 39680
s_nop 0
buffer_load_dwordx4 v6, s[8:11], s50 offen offset:1280 lds
s_add_u32 m0, s46, 43648
s_nop 0
buffer_load_dwordx4 v6, s[8:11], s50 offen offset:1408 lds
s_add_u32 m0, s46, 47616
s_nop 0
buffer_load_dwordx4 v6, s[8:11], s50 offen offset:1536 lds
s_add_u32 m0, s46, 51584
s_nop 0
buffer_load_dwordx4 v6, s[8:11], s50 offen offset:1664 lds
s_add_u32 m0, s46, 55552
s_nop 0
buffer_load_dwordx4 v6, s[8:11], s50 offen offset:1792 lds
s_add_u32 m0, s46, 59520
s_nop 0
buffer_load_dwordx4 v6, s[8:11], s50 offen offset:1920 lds
v_lshrrev_b32 v2, 2, v1
v_and_b32 v3, 3, v1
v_lshlrev_b32 v16, 13, v2
v_lshl_add_u32 v16, v3, 4, v16
v_add_u32 v16, s48, v16
s_mul_i32 s45, s41, 24576
s_add_u32 s45, s45, 65536
v_bfe_u32 v17, v1, 2, 2
v_lshrrev_b32 v18, 4, v1
v_lshl_add_u32 v17, v18, 3, v17
v_lshlrev_b32 v17, 6, v17
v_lshl_add_u32 v17, v3, 3, v17
v_add_u32 v17, s45, v17
s_and_b32 s43, s40, 3
s_lshl_b32 s43, s43, 2
s_add_u32 s43, s43, s41
s_lshl_b32 s43, s43, 3
v_and_b32 v12, 7, v1
v_add_u32 v12, s43, v12
s_lshr_b32 s43, s40, 2
s_lshl_b32 s43, s43, 10
s_add_u32 s44, s43, 896
s_add_u32 s43, s43, 384
s_cmp_ge_u32 s40, 28
s_cselect_b32 s44, s44, s43
v_mov_b32 v13, s43
v_mov_b32 v14, s44
v_cmp_gt_u32 vcc, 32, v1
s_nop 1
v_cndmask_b32 v13, v14, v13, vcc
v_lshl_add_u32 v12, v12, 13, v13
s_mov_b32 s44, 0
buffer_load_dword v250, v12, s[4:7], s44 offen
s_add_u32 m0, s45, 0
s_mov_b32 s44, 0
buffer_load_dwordx4 v16, s[4:7], s44 offen lds
s_add_u32 m0, s45, 1024
s_mov_b32 s44, 131072
buffer_load_dwordx4 v16, s[4:7], s44 offen lds
s_add_u32 m0, s45, 2048
s_mov_b32 s44, 262144
buffer_load_dwordx4 v16, s[4:7], s44 offen lds
s_add_u32 m0, s45, 3072
s_mov_b32 s44, 393216
buffer_load_dwordx4 v16, s[4:7], s44 offen lds
s_add_u32 m0, s45, 4096
s_mov_b32 s44, 524288
buffer_load_dwordx4 v16, s[4:7], s44 offen lds
s_add_u32 m0, s45, 5120
s_mov_b32 s44, 655360
buffer_load_dwordx4 v16, s[4:7], s44 offen lds
s_add_u32 m0, s45, 6144
s_mov_b32 s44, 786432
buffer_load_dwordx4 v16, s[4:7], s44 offen lds
s_add_u32 m0, s45, 7168
s_mov_b32 s44, 917504
buffer_load_dwordx4 v16, s[4:7], s44 offen lds
s_mov_b32 s44, 1048576
buffer_load_dword v250, v12, s[4:7], s44 offen
s_add_u32 m0, s45, 8192
s_mov_b32 s44, 1048576
buffer_load_dwordx4 v16, s[4:7], s44 offen lds
s_add_u32 m0, s45, 9216
s_mov_b32 s44, 1179648
buffer_load_dwordx4 v16, s[4:7], s44 offen lds
s_add_u32 m0, s45, 10240
s_mov_b32 s44, 1310720
buffer_load_dwordx4 v16, s[4:7], s44 offen lds
s_add_u32 m0, s45, 11264
s_mov_b32 s44, 1441792
buffer_load_dwordx4 v16, s[4:7], s44 offen lds
s_add_u32 m0, s45, 12288
s_mov_b32 s44, 1572864
buffer_load_dwordx4 v16, s[4:7], s44 offen lds
s_add_u32 m0, s45, 13312
s_mov_b32 s44, 1703936
buffer_load_dwordx4 v16, s[4:7], s44 offen lds
s_add_u32 m0, s45, 14336
s_mov_b32 s44, 1835008
buffer_load_dwordx4 v16, s[4:7], s44 offen lds
s_add_u32 m0, s45, 15360
s_mov_b32 s44, 1966080
buffer_load_dwordx4 v16, s[4:7], s44 offen lds
s_mov_b32 s44, 2097152
buffer_load_dword v250, v12, s[4:7], s44 offen
s_add_u32 m0, s45, 16384
s_mov_b32 s44, 2097152
buffer_load_dwordx4 v16, s[4:7], s44 offen lds
s_add_u32 m0, s45, 17408
s_mov_b32 s44, 2228224
buffer_load_dwordx4 v16, s[4:7], s44 offen lds
s_add_u32 m0, s45, 18432
s_mov_b32 s44, 2359296
buffer_load_dwordx4 v16, s[4:7], s44 offen lds
s_add_u32 m0, s45, 19456
s_mov_b32 s44, 2490368
buffer_load_dwordx4 v16, s[4:7], s44 offen lds
s_add_u32 m0, s45, 20480
s_mov_b32 s44, 2621440
buffer_load_dwordx4 v16, s[4:7], s44 offen lds
s_add_u32 m0, s45, 21504
s_mov_b32 s44, 2752512
buffer_load_dwordx4 v16, s[4:7], s44 offen lds
s_add_u32 m0, s45, 22528
s_mov_b32 s44, 2883584
buffer_load_dwordx4 v16, s[4:7], s44 offen lds
s_add_u32 m0, s45, 23552
s_mov_b32 s44, 3014656
buffer_load_dwordx4 v16, s[4:7], s44 offen lds
s_waitcnt vmcnt(18)
s_barrier
ds_read_b64_tr_b16 a[0:1], v17 offset:0
ds_read_b64_tr_b16 a[2:3], v17 offset:256
ds_read_b64_tr_b16 a[4:5], v17 offset:32
ds_read_b64_tr_b16 a[6:7], v17 offset:288
ds_read_b64_tr_b16 a[8:9], v17 offset:2048
ds_read_b64_tr_b16 a[10:11], v17 offset:2304
ds_read_b64_tr_b16 a[12:13], v17 offset:2080
ds_read_b64_tr_b16 a[14:15], v17 offset:2336
s_waitcnt lgkmcnt(0)
ds_read_b64_tr_b16 a[16:17], v17 offset:4096
ds_read_b64_tr_b16 a[18:19], v17 offset:4352
ds_read_b64_tr_b16 a[20:21], v17 offset:4128
ds_read_b64_tr_b16 a[22:23], v17 offset:4384
ds_read_b64_tr_b16 a[24:25], v17 offset:6144
ds_read_b64_tr_b16 a[26:27], v17 offset:6400
ds_read_b64_tr_b16 a[28:29], v17 offset:6176
ds_read_b64_tr_b16 a[30:31], v17 offset:6432
s_waitcnt lgkmcnt(0)
s_mov_b32 s44, 3145728
buffer_load_dword v250, v12, s[4:7], s44 offen
s_add_u32 m0, s45, 0
s_mov_b32 s44, 3145728
buffer_load_dwordx4 v16, s[4:7], s44 offen lds
s_add_u32 m0, s45, 1024
s_mov_b32 s44, 3276800
buffer_load_dwordx4 v16, s[4:7], s44 offen lds
s_add_u32 m0, s45, 2048
s_mov_b32 s44, 3407872
buffer_load_dwordx4 v16, s[4:7], s44 offen lds
s_add_u32 m0, s45, 3072
s_mov_b32 s44, 3538944
buffer_load_dwordx4 v16, s[4:7], s44 offen lds
s_add_u32 m0, s45, 4096
s_mov_b32 s44, 3670016
buffer_load_dwordx4 v16, s[4:7], s44 offen lds
s_add_u32 m0, s45, 5120
s_mov_b32 s44, 3801088
buffer_load_dwordx4 v16, s[4:7], s44 offen lds
s_add_u32 m0, s45, 6144
s_mov_b32 s44, 3932160
buffer_load_dwordx4 v16, s[4:7], s44 offen lds
s_add_u32 m0, s45, 7168
s_mov_b32 s44, 4063232
buffer_load_dwordx4 v16, s[4:7], s44 offen lds
ds_read_b128 v[20:23], v8 offset:0
ds_read_b128 v[24:27], v8 offset:2048
ds_read_b128 v[28:31], v9 offset:0
ds_read_b128 v[32:35], v9 offset:2048
ds_read_b128 v[36:39], v8 offset:4096
ds_read_b128 v[40:43], v8 offset:6144
ds_read_b128 v[44:47], v9 offset:4096
ds_read_b128 v[48:51], v9 offset:6144
s_waitcnt lgkmcnt(0)
v_mfma_f32_16x16x32_bf16 v[52:55], v[20:23], a[0:3], 0
v_mfma_f32_16x16x32_bf16 v[56:59], v[20:23], a[4:7], 0
v_mfma_f32_16x16x32_bf16 v[60:63], v[24:27], a[0:3], 0
v_mfma_f32_16x16x32_bf16 v[64:67], v[24:27], a[4:7], 0
v_mfma_f32_16x16x32_bf16 v[52:55], v[28:31], a[8:11], v[52:55]
v_mfma_f32_16x16x32_bf16 v[56:59], v[28:31], a[12:15], v[56:59]
v_mfma_f32_16x16x32_bf16 v[60:63], v[32:35], a[8:11], v[60:63]
v_mfma_f32_16x16x32_bf16 v[64:67], v[32:35], a[12:15], v[64:67]
v_mfma_f32_16x16x32_bf16 v[52:55], v[36:39], a[16:19], v[52:55]
v_mfma_f32_16x16x32_bf16 v[56:59], v[36:39], a[20:23], v[56:59]
v_mfma_f32_16x16x32_bf16 v[60:63], v[40:43], a[16:19], v[60:63]
v_mfma_f32_16x16x32_bf16 v[64:67], v[40:43], a[20:23], v[64:67]
v_mfma_f32_16x16x32_bf16 v[52:55], v[44:47], a[24:27], v[52:55]
v_mfma_f32_16x16x32_bf16 v[56:59], v[44:47], a[28:31], v[56:59]
v_mfma_f32_16x16x32_bf16 v[60:63], v[48:51], a[24:27], v[60:63]
v_mfma_f32_16x16x32_bf16 v[64:67], v[48:51], a[28:31], v[64:67]
s_waitcnt vmcnt(18)
ds_read_b64_tr_b16 a[32:33], v17 offset:8192
ds_read_b64_tr_b16 a[34:35], v17 offset:8448
ds_read_b64_tr_b16 a[36:37], v17 offset:8224
ds_read_b64_tr_b16 a[38:39], v17 offset:8480
ds_read_b64_tr_b16 a[40:41], v17 offset:10240
ds_read_b64_tr_b16 a[42:43], v17 offset:10496
ds_read_b64_tr_b16 a[44:45], v17 offset:10272
ds_read_b64_tr_b16 a[46:47], v17 offset:10528
s_waitcnt lgkmcnt(0)
ds_read_b64_tr_b16 a[48:49], v17 offset:12288
ds_read_b64_tr_b16 a[50:51], v17 offset:12544
ds_read_b64_tr_b16 a[52:53], v17 offset:12320
ds_read_b64_tr_b16 a[54:55], v17 offset:12576
ds_read_b64_tr_b16 a[56:57], v17 offset:14336
ds_read_b64_tr_b16 a[58:59], v17 offset:14592
ds_read_b64_tr_b16 a[60:61], v17 offset:14368
ds_read_b64_tr_b16 a[62:63], v17 offset:14624
s_waitcnt lgkmcnt(0)
s_mov_b32 s44, 4194304
buffer_load_dword v250, v12, s[4:7], s44 offen
s_add_u32 m0, s45, 8192
s_mov_b32 s44, 4194304
buffer_load_dwordx4 v16, s[4:7], s44 offen lds
s_add_u32 m0, s45, 9216
s_mov_b32 s44, 4325376
buffer_load_dwordx4 v16, s[4:7], s44 offen lds
s_add_u32 m0, s45, 10240
s_mov_b32 s44, 4456448
buffer_load_dwordx4 v16, s[4:7], s44 offen lds
s_add_u32 m0, s45, 11264
s_mov_b32 s44, 4587520
buffer_load_dwordx4 v16, s[4:7], s44 offen lds
s_add_u32 m0, s45, 12288
s_mov_b32 s44, 4718592
buffer_load_dwordx4 v16, s[4:7], s44 offen lds
s_add_u32 m0, s45, 13312
s_mov_b32 s44, 4849664
buffer_load_dwordx4 v16, s[4:7], s44 offen lds
s_add_u32 m0, s45, 14336
s_mov_b32 s44, 4980736
buffer_load_dwordx4 v16, s[4:7], s44 offen lds
s_add_u32 m0, s45, 15360
s_mov_b32 s44, 5111808
buffer_load_dwordx4 v16, s[4:7], s44 offen lds
ds_read_b128 v[20:23], v8 offset:8192
ds_read_b128 v[24:27], v8 offset:10240
ds_read_b128 v[28:31], v9 offset:8192
ds_read_b128 v[32:35], v9 offset:10240
ds_read_b128 v[36:39], v8 offset:12288
ds_read_b128 v[40:43], v8 offset:14336
ds_read_b128 v[44:47], v9 offset:12288
ds_read_b128 v[48:51], v9 offset:14336
s_waitcnt lgkmcnt(0)
v_mfma_f32_16x16x32_bf16 v[52:55], v[20:23], a[32:35], v[52:55]
v_mfma_f32_16x16x32_bf16 v[56:59], v[20:23], a[36:39], v[56:59]
v_mfma_f32_16x16x32_bf16 v[60:63], v[24:27], a[32:35], v[60:63]
v_mfma_f32_16x16x32_bf16 v[64:67], v[24:27], a[36:39], v[64:67]
v_mfma_f32_16x16x32_bf16 v[52:55], v[28:31], a[40:43], v[52:55]
v_mfma_f32_16x16x32_bf16 v[56:59], v[28:31], a[44:47], v[56:59]
v_mfma_f32_16x16x32_bf16 v[60:63], v[32:35], a[40:43], v[60:63]
v_mfma_f32_16x16x32_bf16 v[64:67], v[32:35], a[44:47], v[64:67]
v_mfma_f32_16x16x32_bf16 v[52:55], v[36:39], a[48:51], v[52:55]
v_mfma_f32_16x16x32_bf16 v[56:59], v[36:39], a[52:55], v[56:59]
v_mfma_f32_16x16x32_bf16 v[60:63], v[40:43], a[48:51], v[60:63]
v_mfma_f32_16x16x32_bf16 v[64:67], v[40:43], a[52:55], v[64:67]
v_mfma_f32_16x16x32_bf16 v[52:55], v[44:47], a[56:59], v[52:55]
v_mfma_f32_16x16x32_bf16 v[56:59], v[44:47], a[60:63], v[56:59]
v_mfma_f32_16x16x32_bf16 v[60:63], v[48:51], a[56:59], v[60:63]
v_mfma_f32_16x16x32_bf16 v[64:67], v[48:51], a[60:63], v[64:67]
s_waitcnt vmcnt(18)
ds_read_b64_tr_b16 a[64:65], v17 offset:16384
ds_read_b64_tr_b16 a[66:67], v17 offset:16640
ds_read_b64_tr_b16 a[68:69], v17 offset:16416
ds_read_b64_tr_b16 a[70:71], v17 offset:16672
ds_read_b64_tr_b16 a[72:73], v17 offset:18432
ds_read_b64_tr_b16 a[74:75], v17 offset:18688
ds_read_b64_tr_b16 a[76:77], v17 offset:18464
ds_read_b64_tr_b16 a[78:79], v17 offset:18720
s_waitcnt lgkmcnt(0)
ds_read_b64_tr_b16 a[80:81], v17 offset:20480
ds_read_b64_tr_b16 a[82:83], v17 offset:20736
ds_read_b64_tr_b16 a[84:85], v17 offset:20512
ds_read_b64_tr_b16 a[86:87], v17 offset:20768
ds_read_b64_tr_b16 a[88:89], v17 offset:22528
ds_read_b64_tr_b16 a[90:91], v17 offset:22784
ds_read_b64_tr_b16 a[92:93], v17 offset:22560
ds_read_b64_tr_b16 a[94:95], v17 offset:22816
s_waitcnt lgkmcnt(0)
s_mov_b32 s44, 5242880
buffer_load_dword v250, v12, s[4:7], s44 offen
s_add_u32 m0, s45, 16384
s_mov_b32 s44, 5242880
buffer_load_dwordx4 v16, s[4:7], s44 offen lds
s_add_u32 m0, s45, 17408
s_mov_b32 s44, 5373952
buffer_load_dwordx4 v16, s[4:7], s44 offen lds
s_add_u32 m0, s45, 18432
s_mov_b32 s44, 5505024
buffer_load_dwordx4 v16, s[4:7], s44 offen lds
s_add_u32 m0, s45, 19456
s_mov_b32 s44, 5636096
buffer_load_dwordx4 v16, s[4:7], s44 offen lds
s_add_u32 m0, s45, 20480
s_mov_b32 s44, 5767168
buffer_load_dwordx4 v16, s[4:7], s44 offen lds
s_add_u32 m0, s45, 21504
s_mov_b32 s44, 5898240
buffer_load_dwordx4 v16, s[4:7], s44 offen lds
s_add_u32 m0, s45, 22528
s_mov_b32 s44, 6029312
buffer_load_dwordx4 v16, s[4:7], s44 offen lds
s_add_u32 m0, s45, 23552
s_mov_b32 s44, 6160384
buffer_load_dwordx4 v16, s[4:7], s44 offen lds
ds_read_b128 v[20:23], v8 offset:16384
ds_read_b128 v[24:27], v8 offset:18432
ds_read_b128 v[28:31], v9 offset:16384
ds_read_b128 v[32:35], v9 offset:18432
ds_read_b128 v[36:39], v8 offset:20480
ds_read_b128 v[40:43], v8 offset:22528
ds_read_b128 v[44:47], v9 offset:20480
ds_read_b128 v[48:51], v9 offset:22528
s_waitcnt lgkmcnt(0)
v_mfma_f32_16x16x32_bf16 v[52:55], v[20:23], a[64:67], v[52:55]
v_mfma_f32_16x16x32_bf16 v[56:59], v[20:23], a[68:71], v[56:59]
v_mfma_f32_16x16x32_bf16 v[60:63], v[24:27], a[64:67], v[60:63]
v_mfma_f32_16x16x32_bf16 v[64:67], v[24:27], a[68:71], v[64:67]
v_mfma_f32_16x16x32_bf16 v[52:55], v[28:31], a[72:75], v[52:55]
v_mfma_f32_16x16x32_bf16 v[56:59], v[28:31], a[76:79], v[56:59]
v_mfma_f32_16x16x32_bf16 v[60:63], v[32:35], a[72:75], v[60:63]
v_mfma_f32_16x16x32_bf16 v[64:67], v[32:35], a[76:79], v[64:67]
v_mfma_f32_16x16x32_bf16 v[52:55], v[36:39], a[80:83], v[52:55]
v_mfma_f32_16x16x32_bf16 v[56:59], v[36:39], a[84:87], v[56:59]
v_mfma_f32_16x16x32_bf16 v[60:63], v[40:43], a[80:83], v[60:63]
v_mfma_f32_16x16x32_bf16 v[64:67], v[40:43], a[84:87], v[64:67]
v_mfma_f32_16x16x32_bf16 v[52:55], v[44:47], a[88:91], v[52:55]
v_mfma_f32_16x16x32_bf16 v[56:59], v[44:47], a[92:95], v[56:59]
v_mfma_f32_16x16x32_bf16 v[60:63], v[48:51], a[88:91], v[60:63]
v_mfma_f32_16x16x32_bf16 v[64:67], v[48:51], a[92:95], v[64:67]
s_waitcnt vmcnt(18)
ds_read_b64_tr_b16 a[96:97], v17 offset:0
ds_read_b64_tr_b16 a[98:99], v17 offset:256
ds_read_b64_tr_b16 a[100:101], v17 offset:32
ds_read_b64_tr_b16 a[102:103], v17 offset:288
ds_read_b64_tr_b16 a[104:105], v17 offset:2048
ds_read_b64_tr_b16 a[106:107], v17 offset:2304
ds_read_b64_tr_b16 a[108:109], v17 offset:2080
ds_read_b64_tr_b16 a[110:111], v17 offset:2336
s_waitcnt lgkmcnt(0)
ds_read_b64_tr_b16 a[112:113], v17 offset:4096
ds_read_b64_tr_b16 a[114:115], v17 offset:4352
ds_read_b64_tr_b16 a[116:117], v17 offset:4128
ds_read_b64_tr_b16 a[118:119], v17 offset:4384
ds_read_b64_tr_b16 a[120:121], v17 offset:6144
ds_read_b64_tr_b16 a[122:123], v17 offset:6400
ds_read_b64_tr_b16 a[124:125], v17 offset:6176
ds_read_b64_tr_b16 a[126:127], v17 offset:6432
s_waitcnt lgkmcnt(0)
s_mov_b32 s44, 6291456
buffer_load_dword v250, v12, s[4:7], s44 offen
s_add_u32 m0, s45, 0
s_mov_b32 s44, 6291456
buffer_load_dwordx4 v16, s[4:7], s44 offen lds
s_add_u32 m0, s45, 1024
s_mov_b32 s44, 6422528
buffer_load_dwordx4 v16, s[4:7], s44 offen lds
s_add_u32 m0, s45, 2048
s_mov_b32 s44, 6553600
buffer_load_dwordx4 v16, s[4:7], s44 offen lds
s_add_u32 m0, s45, 3072
s_mov_b32 s44, 6684672
buffer_load_dwordx4 v16, s[4:7], s44 offen lds
s_add_u32 m0, s45, 4096
s_mov_b32 s44, 6815744
buffer_load_dwordx4 v16, s[4:7], s44 offen lds
s_add_u32 m0, s45, 5120
s_mov_b32 s44, 6946816
buffer_load_dwordx4 v16, s[4:7], s44 offen lds
s_add_u32 m0, s45, 6144
s_mov_b32 s44, 7077888
buffer_load_dwordx4 v16, s[4:7], s44 offen lds
s_add_u32 m0, s45, 7168
s_mov_b32 s44, 7208960
buffer_load_dwordx4 v16, s[4:7], s44 offen lds
ds_read_b128 v[20:23], v8 offset:24576
ds_read_b128 v[24:27], v8 offset:26624
ds_read_b128 v[28:31], v9 offset:24576
ds_read_b128 v[32:35], v9 offset:26624
ds_read_b128 v[36:39], v8 offset:28672
ds_read_b128 v[40:43], v8 offset:30720
ds_read_b128 v[44:47], v9 offset:28672
ds_read_b128 v[48:51], v9 offset:30720
s_waitcnt lgkmcnt(0)
v_mfma_f32_16x16x32_bf16 v[52:55], v[20:23], a[96:99], v[52:55]
v_mfma_f32_16x16x32_bf16 v[56:59], v[20:23], a[100:103], v[56:59]
v_mfma_f32_16x16x32_bf16 v[60:63], v[24:27], a[96:99], v[60:63]
v_mfma_f32_16x16x32_bf16 v[64:67], v[24:27], a[100:103], v[64:67]
v_mfma_f32_16x16x32_bf16 v[52:55], v[28:31], a[104:107], v[52:55]
v_mfma_f32_16x16x32_bf16 v[56:59], v[28:31], a[108:111], v[56:59]
v_mfma_f32_16x16x32_bf16 v[60:63], v[32:35], a[104:107], v[60:63]
v_mfma_f32_16x16x32_bf16 v[64:67], v[32:35], a[108:111], v[64:67]
v_mfma_f32_16x16x32_bf16 v[52:55], v[36:39], a[112:115], v[52:55]
v_mfma_f32_16x16x32_bf16 v[56:59], v[36:39], a[116:119], v[56:59]
v_mfma_f32_16x16x32_bf16 v[60:63], v[40:43], a[112:115], v[60:63]
v_mfma_f32_16x16x32_bf16 v[64:67], v[40:43], a[116:119], v[64:67]
v_mfma_f32_16x16x32_bf16 v[52:55], v[44:47], a[120:123], v[52:55]
v_mfma_f32_16x16x32_bf16 v[56:59], v[44:47], a[124:127], v[56:59]
v_mfma_f32_16x16x32_bf16 v[60:63], v[48:51], a[120:123], v[60:63]
v_mfma_f32_16x16x32_bf16 v[64:67], v[48:51], a[124:127], v[64:67]
s_waitcnt vmcnt(18)
ds_read_b64_tr_b16 a[128:129], v17 offset:8192
ds_read_b64_tr_b16 a[130:131], v17 offset:8448
ds_read_b64_tr_b16 a[132:133], v17 offset:8224
ds_read_b64_tr_b16 a[134:135], v17 offset:8480
ds_read_b64_tr_b16 a[136:137], v17 offset:10240
ds_read_b64_tr_b16 a[138:139], v17 offset:10496
ds_read_b64_tr_b16 a[140:141], v17 offset:10272
ds_read_b64_tr_b16 a[142:143], v17 offset:10528
s_waitcnt lgkmcnt(0)
ds_read_b64_tr_b16 a[144:145], v17 offset:12288
ds_read_b64_tr_b16 a[146:147], v17 offset:12544
ds_read_b64_tr_b16 a[148:149], v17 offset:12320
ds_read_b64_tr_b16 a[150:151], v17 offset:12576
ds_read_b64_tr_b16 a[152:153], v17 offset:14336
ds_read_b64_tr_b16 a[154:155], v17 offset:14592
ds_read_b64_tr_b16 a[156:157], v17 offset:14368
ds_read_b64_tr_b16 a[158:159], v17 offset:14624
s_waitcnt lgkmcnt(0)
s_mov_b32 s44, 7340032
buffer_load_dword v250, v12, s[4:7], s44 offen
s_add_u32 m0, s45, 8192
s_mov_b32 s44, 7340032
buffer_load_dwordx4 v16, s[4:7], s44 offen lds
s_add_u32 m0, s45, 9216
s_mov_b32 s44, 7471104
buffer_load_dwordx4 v16, s[4:7], s44 offen lds
s_add_u32 m0, s45, 10240
s_mov_b32 s44, 7602176
buffer_load_dwordx4 v16, s[4:7], s44 offen lds
s_add_u32 m0, s45, 11264
s_mov_b32 s44, 7733248
buffer_load_dwordx4 v16, s[4:7], s44 offen lds
s_add_u32 m0, s45, 12288
s_mov_b32 s44, 7864320
buffer_load_dwordx4 v16, s[4:7], s44 offen lds
s_add_u32 m0, s45, 13312
s_mov_b32 s44, 7995392
buffer_load_dwordx4 v16, s[4:7], s44 offen lds
s_add_u32 m0, s45, 14336
s_mov_b32 s44, 8126464
buffer_load_dwordx4 v16, s[4:7], s44 offen lds
s_add_u32 m0, s45, 15360
s_mov_b32 s44, 8257536
buffer_load_dwordx4 v16, s[4:7], s44 offen lds
ds_read_b128 v[20:23], v8 offset:32768
ds_read_b128 v[24:27], v8 offset:34816
ds_read_b128 v[28:31], v9 offset:32768
ds_read_b128 v[32:35], v9 offset:34816
ds_read_b128 v[36:39], v8 offset:36864
ds_read_b128 v[40:43], v8 offset:38912
ds_read_b128 v[44:47], v9 offset:36864
ds_read_b128 v[48:51], v9 offset:38912
s_waitcnt lgkmcnt(0)
v_mfma_f32_16x16x32_bf16 v[52:55], v[20:23], a[128:131], v[52:55]
v_mfma_f32_16x16x32_bf16 v[56:59], v[20:23], a[132:135], v[56:59]
v_mfma_f32_16x16x32_bf16 v[60:63], v[24:27], a[128:131], v[60:63]
v_mfma_f32_16x16x32_bf16 v[64:67], v[24:27], a[132:135], v[64:67]
v_mfma_f32_16x16x32_bf16 v[52:55], v[28:31], a[136:139], v[52:55]
v_mfma_f32_16x16x32_bf16 v[56:59], v[28:31], a[140:143], v[56:59]
v_mfma_f32_16x16x32_bf16 v[60:63], v[32:35], a[136:139], v[60:63]
v_mfma_f32_16x16x32_bf16 v[64:67], v[32:35], a[140:143], v[64:67]
v_mfma_f32_16x16x32_bf16 v[52:55], v[36:39], a[144:147], v[52:55]
v_mfma_f32_16x16x32_bf16 v[56:59], v[36:39], a[148:151], v[56:59]
v_mfma_f32_16x16x32_bf16 v[60:63], v[40:43], a[144:147], v[60:63]
v_mfma_f32_16x16x32_bf16 v[64:67], v[40:43], a[148:151], v[64:67]
v_mfma_f32_16x16x32_bf16 v[52:55], v[44:47], a[152:155], v[52:55]
v_mfma_f32_16x16x32_bf16 v[56:59], v[44:47], a[156:159], v[56:59]
v_mfma_f32_16x16x32_bf16 v[60:63], v[48:51], a[152:155], v[60:63]
v_mfma_f32_16x16x32_bf16 v[64:67], v[48:51], a[156:159], v[64:67]
s_waitcnt vmcnt(18)
ds_read_b64_tr_b16 a[160:161], v17 offset:16384
ds_read_b64_tr_b16 a[162:163], v17 offset:16640
ds_read_b64_tr_b16 a[164:165], v17 offset:16416
ds_read_b64_tr_b16 a[166:167], v17 offset:16672
ds_read_b64_tr_b16 a[168:169], v17 offset:18432
ds_read_b64_tr_b16 a[170:171], v17 offset:18688
ds_read_b64_tr_b16 a[172:173], v17 offset:18464
ds_read_b64_tr_b16 a[174:175], v17 offset:18720
s_waitcnt lgkmcnt(0)
ds_read_b64_tr_b16 a[176:177], v17 offset:20480
ds_read_b64_tr_b16 a[178:179], v17 offset:20736
ds_read_b64_tr_b16 a[180:181], v17 offset:20512
ds_read_b64_tr_b16 a[182:183], v17 offset:20768
ds_read_b64_tr_b16 a[184:185], v17 offset:22528
ds_read_b64_tr_b16 a[186:187], v17 offset:22784
ds_read_b64_tr_b16 a[188:189], v17 offset:22560
ds_read_b64_tr_b16 a[190:191], v17 offset:22816
s_waitcnt lgkmcnt(0)
ds_read_b128 v[20:23], v8 offset:40960
ds_read_b128 v[24:27], v8 offset:43008
ds_read_b128 v[28:31], v9 offset:40960
ds_read_b128 v[32:35], v9 offset:43008
ds_read_b128 v[36:39], v8 offset:45056
ds_read_b128 v[40:43], v8 offset:47104
ds_read_b128 v[44:47], v9 offset:45056
ds_read_b128 v[48:51], v9 offset:47104
s_waitcnt lgkmcnt(0)
v_mfma_f32_16x16x32_bf16 v[52:55], v[20:23], a[160:163], v[52:55]
v_mfma_f32_16x16x32_bf16 v[56:59], v[20:23], a[164:167], v[56:59]
v_mfma_f32_16x16x32_bf16 v[60:63], v[24:27], a[160:163], v[60:63]
v_mfma_f32_16x16x32_bf16 v[64:67], v[24:27], a[164:167], v[64:67]
v_mfma_f32_16x16x32_bf16 v[52:55], v[28:31], a[168:171], v[52:55]
v_mfma_f32_16x16x32_bf16 v[56:59], v[28:31], a[172:175], v[56:59]
v_mfma_f32_16x16x32_bf16 v[60:63], v[32:35], a[168:171], v[60:63]
v_mfma_f32_16x16x32_bf16 v[64:67], v[32:35], a[172:175], v[64:67]
v_mfma_f32_16x16x32_bf16 v[52:55], v[36:39], a[176:179], v[52:55]
v_mfma_f32_16x16x32_bf16 v[56:59], v[36:39], a[180:183], v[56:59]
v_mfma_f32_16x16x32_bf16 v[60:63], v[40:43], a[176:179], v[60:63]
v_mfma_f32_16x16x32_bf16 v[64:67], v[40:43], a[180:183], v[64:67]
v_mfma_f32_16x16x32_bf16 v[52:55], v[44:47], a[184:187], v[52:55]
v_mfma_f32_16x16x32_bf16 v[56:59], v[44:47], a[188:191], v[56:59]
v_mfma_f32_16x16x32_bf16 v[60:63], v[48:51], a[184:187], v[60:63]
v_mfma_f32_16x16x32_bf16 v[64:67], v[48:51], a[188:191], v[64:67]
s_waitcnt vmcnt(9)
ds_read_b64_tr_b16 a[192:193], v17 offset:0
ds_read_b64_tr_b16 a[194:195], v17 offset:256
ds_read_b64_tr_b16 a[196:197], v17 offset:32
ds_read_b64_tr_b16 a[198:199], v17 offset:288
ds_read_b64_tr_b16 a[200:201], v17 offset:2048
ds_read_b64_tr_b16 a[202:203], v17 offset:2304
ds_read_b64_tr_b16 a[204:205], v17 offset:2080
ds_read_b64_tr_b16 a[206:207], v17 offset:2336
s_waitcnt lgkmcnt(0)
ds_read_b64_tr_b16 a[208:209], v17 offset:4096
ds_read_b64_tr_b16 a[210:211], v17 offset:4352
ds_read_b64_tr_b16 a[212:213], v17 offset:4128
ds_read_b64_tr_b16 a[214:215], v17 offset:4384
ds_read_b64_tr_b16 a[216:217], v17 offset:6144
ds_read_b64_tr_b16 a[218:219], v17 offset:6400
ds_read_b64_tr_b16 a[220:221], v17 offset:6176
ds_read_b64_tr_b16 a[222:223], v17 offset:6432
s_waitcnt lgkmcnt(0)
ds_read_b128 v[20:23], v8 offset:49152
ds_read_b128 v[24:27], v8 offset:51200
ds_read_b128 v[28:31], v9 offset:49152
ds_read_b128 v[32:35], v9 offset:51200
ds_read_b128 v[36:39], v8 offset:53248
ds_read_b128 v[40:43], v8 offset:55296
ds_read_b128 v[44:47], v9 offset:53248
ds_read_b128 v[48:51], v9 offset:55296
s_waitcnt lgkmcnt(0)
v_mfma_f32_16x16x32_bf16 v[52:55], v[20:23], a[192:195], v[52:55]
v_mfma_f32_16x16x32_bf16 v[56:59], v[20:23], a[196:199], v[56:59]
v_mfma_f32_16x16x32_bf16 v[60:63], v[24:27], a[192:195], v[60:63]
v_mfma_f32_16x16x32_bf16 v[64:67], v[24:27], a[196:199], v[64:67]
v_mfma_f32_16x16x32_bf16 v[52:55], v[28:31], a[200:203], v[52:55]
v_mfma_f32_16x16x32_bf16 v[56:59], v[28:31], a[204:207], v[56:59]
v_mfma_f32_16x16x32_bf16 v[60:63], v[32:35], a[200:203], v[60:63]
v_mfma_f32_16x16x32_bf16 v[64:67], v[32:35], a[204:207], v[64:67]
v_mfma_f32_16x16x32_bf16 v[52:55], v[36:39], a[208:211], v[52:55]
v_mfma_f32_16x16x32_bf16 v[56:59], v[36:39], a[212:215], v[56:59]
v_mfma_f32_16x16x32_bf16 v[60:63], v[40:43], a[208:211], v[60:63]
v_mfma_f32_16x16x32_bf16 v[64:67], v[40:43], a[212:215], v[64:67]
v_mfma_f32_16x16x32_bf16 v[52:55], v[44:47], a[216:219], v[52:55]
v_mfma_f32_16x16x32_bf16 v[56:59], v[44:47], a[220:223], v[56:59]
v_mfma_f32_16x16x32_bf16 v[60:63], v[48:51], a[216:219], v[60:63]
v_mfma_f32_16x16x32_bf16 v[64:67], v[48:51], a[220:223], v[64:67]
s_waitcnt vmcnt(0)
ds_read_b64_tr_b16 a[224:225], v17 offset:8192
ds_read_b64_tr_b16 a[226:227], v17 offset:8448
ds_read_b64_tr_b16 a[228:229], v17 offset:8224
ds_read_b64_tr_b16 a[230:231], v17 offset:8480
ds_read_b64_tr_b16 a[232:233], v17 offset:10240
ds_read_b64_tr_b16 a[234:235], v17 offset:10496
ds_read_b64_tr_b16 a[236:237], v17 offset:10272
ds_read_b64_tr_b16 a[238:239], v17 offset:10528
s_waitcnt lgkmcnt(0)
ds_read_b64_tr_b16 a[240:241], v17 offset:12288
ds_read_b64_tr_b16 a[242:243], v17 offset:12544
ds_read_b64_tr_b16 a[244:245], v17 offset:12320
ds_read_b64_tr_b16 a[246:247], v17 offset:12576
ds_read_b64_tr_b16 a[248:249], v17 offset:14336
ds_read_b64_tr_b16 a[250:251], v17 offset:14592
ds_read_b64_tr_b16 a[252:253], v17 offset:14368
ds_read_b64_tr_b16 a[254:255], v17 offset:14624
s_waitcnt lgkmcnt(0)
ds_read_b128 v[20:23], v8 offset:57344
ds_read_b128 v[24:27], v8 offset:59392
ds_read_b128 v[28:31], v9 offset:57344
ds_read_b128 v[32:35], v9 offset:59392
ds_read_b128 v[36:39], v8 offset:61440
ds_read_b128 v[40:43], v8 offset:63488
ds_read_b128 v[44:47], v9 offset:61440
ds_read_b128 v[48:51], v9 offset:63488
s_waitcnt lgkmcnt(0)
v_mfma_f32_16x16x32_bf16 v[52:55], v[20:23], a[224:227], v[52:55]
v_mfma_f32_16x16x32_bf16 v[56:59], v[20:23], a[228:231], v[56:59]
v_mfma_f32_16x16x32_bf16 v[60:63], v[24:27], a[224:227], v[60:63]
v_mfma_f32_16x16x32_bf16 v[64:67], v[24:27], a[228:231], v[64:67]
v_mfma_f32_16x16x32_bf16 v[52:55], v[28:31], a[232:235], v[52:55]
v_mfma_f32_16x16x32_bf16 v[56:59], v[28:31], a[236:239], v[56:59]
v_mfma_f32_16x16x32_bf16 v[60:63], v[32:35], a[232:235], v[60:63]
v_mfma_f32_16x16x32_bf16 v[64:67], v[32:35], a[236:239], v[64:67]
v_mfma_f32_16x16x32_bf16 v[52:55], v[36:39], a[240:243], v[52:55]
v_mfma_f32_16x16x32_bf16 v[56:59], v[36:39], a[244:247], v[56:59]
v_mfma_f32_16x16x32_bf16 v[60:63], v[40:43], a[240:243], v[60:63]
v_mfma_f32_16x16x32_bf16 v[64:67], v[40:43], a[244:247], v[64:67]
v_mfma_f32_16x16x32_bf16 v[52:55], v[44:47], a[248:251], v[52:55]
v_mfma_f32_16x16x32_bf16 v[56:59], v[44:47], a[252:255], v[56:59]
v_mfma_f32_16x16x32_bf16 v[60:63], v[48:51], a[248:251], v[60:63]
v_mfma_f32_16x16x32_bf16 v[64:67], v[48:51], a[252:255], v[64:67]
s_barrier
s_mov_b32 s50, 0x10000
s_add_u32 m0, s46, 65536
s_nop 0
buffer_load_dwordx4 v6, s[8:11], s50 offen offset:0 lds
s_add_u32 m0, s46, 69504
s_nop 0
buffer_load_dwordx4 v6, s[8:11], s50 offen offset:128 lds
s_add_u32 m0, s46, 73472
s_nop 0
buffer_load_dwordx4 v6, s[8:11], s50 offen offset:256 lds
s_add_u32 m0, s46, 77440
s_nop 0
buffer_load_dwordx4 v6, s[8:11], s50 offen offset:384 lds
s_add_u32 m0, s46, 81408
s_nop 0
buffer_load_dwordx4 v6, s[8:11], s50 offen offset:512 lds
s_add_u32 m0, s46, 85376
s_nop 0
buffer_load_dwordx4 v6, s[8:11], s50 offen offset:640 lds
s_add_u32 m0, s46, 89344
s_nop 0
buffer_load_dwordx4 v6, s[8:11], s50 offen offset:768 lds
s_add_u32 m0, s46, 93312
s_nop 0
buffer_load_dwordx4 v6, s[8:11], s50 offen offset:896 lds
s_add_u32 m0, s46, 97280
s_nop 0
buffer_load_dwordx4 v6, s[8:11], s50 offen offset:1024 lds
s_add_u32 m0, s46, 101248
s_nop 0
buffer_load_dwordx4 v6, s[8:11], s50 offen offset:1152 lds
s_add_u32 m0, s46, 105216
s_nop 0
buffer_load_dwordx4 v6, s[8:11], s50 offen offset:1280 lds
s_add_u32 m0, s46, 109184
s_nop 0
buffer_load_dwordx4 v6, s[8:11], s50 offen offset:1408 lds
s_add_u32 m0, s46, 113152
s_nop 0
buffer_load_dwordx4 v6, s[8:11], s50 offen offset:1536 lds
s_add_u32 m0, s46, 117120
s_nop 0
buffer_load_dwordx4 v6, s[8:11], s50 offen offset:1664 lds
s_add_u32 m0, s46, 121088
s_nop 0
buffer_load_dwordx4 v6, s[8:11], s50 offen offset:1792 lds
s_add_u32 m0, s46, 125056
s_nop 0
buffer_load_dwordx4 v6, s[8:11], s50 offen offset:1920 lds
s_and_b32 s53, s47, 31
s_lshl_b32 s53, s53, 4
v_add_u32 v19, s53, v1
v_lshlrev_b32 v19, 7, v19
s_mov_b32 s42, 1
v_and_b32 v3, 15, v0
v_lshlrev_b32 v3, 4, v3
s_branch mega_kernel_syv
mega_kernel_syvw:
s_sleep 4
mega_kernel_syv:
buffer_load_dword v2, v3, s[72:75], 0 offen sc1
s_waitcnt vmcnt(0)
mega_kernel_syvp:
s_cmp_eq_u32 s95, 1
s_cbranch_scc0 mega_kernel_syvf
v_readlane_b32 s76, v2, 14
s_mov_b32 s98, 0
s_cmp_eq_u32 s76, 32
s_cbranch_scc0 mega_kernel_syvw
s_branch mega_kernel_syvd
mega_kernel_syvf:
s_mov_b32 s77, 0
s_mov_b32 s78, 0
v_readlane_b32 s76, v2, 0
s_add_u32 s77, s77, s76
s_xor_b32 s76, s76, 32
s_or_b32 s78, s78, s76
v_readlane_b32 s76, v2, 1
s_add_u32 s77, s77, s76
s_xor_b32 s76, s76, 32
s_or_b32 s78, s78, s76
v_readlane_b32 s76, v2, 2
s_add_u32 s77, s77, s76
s_xor_b32 s76, s76, 32
s_or_b32 s78, s78, s76
v_readlane_b32 s76, v2, 3
s_add_u32 s77, s77, s76
s_xor_b32 s76, s76, 32
s_or_b32 s78, s78, s76
v_readlane_b32 s76, v2, 4
s_add_u32 s77, s77, s76
s_xor_b32 s76, s76, 32
s_or_b32 s78, s78, s76
v_readlane_b32 s76, v2, 5
s_add_u32 s77, s77, s76
s_xor_b32 s76, s76, 32
s_or_b32 s78, s78, s76
v_readlane_b32 s76, v2, 6
s_add_u32 s77, s77, s76
s_xor_b32 s76, s76, 32
s_or_b32 s78, s78, s76
v_readlane_b32 s76, v2, 7
s_add_u32 s77, s77, s76
s_xor_b32 s76, s76, 32
s_or_b32 s78, s78, s76
s_cmp_eq_u32 s77, 256
s_cbranch_scc0 mega_kernel_syvw
v_mov_b32 v252, v2
s_cmp_eq_u32 s78, 0
s_cbranch_scc0 mega_kernel_slowent
v_readlane_b32 s76, v2, 10
v_readlane_b32 s77, v2, 8
s_cmp_eq_u32 s76, 32
s_cbranch_scc0 mega_kernel_syvw
s_cmp_gt_u32 s77, 16
s_cselect_b32 s98, 1, 0
mega_kernel_syvd:
s_lshr_b32 s44, s47, 3
s_xor_b32 s44, s44, s98
s_and_b32 s44, s44, 1
s_lshl_b32 s44, s44, 13
s_lshl_b32 s48, s47, 18
s_add_u32 s48, s48, s44
s_add_u32 s48, s48, 33554432
s_xor_b32 s44, s98, 1
s_lshl_b32 s44, s44, 13
s_lshl_b32 s49, s40, 7
s_add_u32 s49, s49, s44
s_lshl_b32 s44, s41, 2
s_add_u32 s49, s49, s44
s_add_u32 s49, s49, 69210112
v_mov_b32 v16, 0
v_cvt_pk_bf16_f32 v84, v52, v53
v_cvt_pk_bf16_f32 v85, v54, v55
v_cvt_pk_bf16_f32 v86, v60, v61
v_cvt_pk_bf16_f32 v87, v62, v63
v_cvt_pk_bf16_f32 v88, v56, v57
v_cvt_pk_bf16_f32 v89, v58, v59
v_cvt_pk_bf16_f32 v90, v64, v65
v_cvt_pk_bf16_f32 v91, v66, v67
s_add_u32 s51, s42, s47
s_sub_u32 s51, s51, 1
s_bfe_u32 s52, s51, 0x40002
s_lshl_b32 s52, s52, 14
s_and_b32 s51, s51, 3
s_lshl_b32 s51, s51, 11
s_add_u32 s51, s51, s52
s_add_u32 s51, s51, s48
buffer_store_dwordx4 v[84:87], v7, s[84:87], s51 offen sc1
buffer_store_dwordx4 v[88:91], v7, s[84:87], s51 offen offset:1024 sc1
s_waitcnt vmcnt(0)
v_mov_b32 v17, s42
s_mov_b64 exec, 1
buffer_store_dword v17, v16, s[84:87], s49 offen sc1
s_mov_b64 exec, -1
mega_kernel_v_loop:
s_waitcnt vmcnt(2)
s_barrier
s_add_u32 s50, s42, 1
s_min_u32 s50, s50, 63
s_lshl_b32 s50, s50, 16
ds_read_b128 v[20:23], v10 offset:0
ds_read_b128 v[24:27], v10 offset:2048
ds_read_b128 v[28:31], v11 offset:0
ds_read_b128 v[32:35], v11 offset:2048
ds_read_b128 v[36:39], v10 offset:4096
ds_read_b128 v[40:43], v10 offset:6144
s_waitcnt lgkmcnt(4)
v_mfma_f32_16x16x32_bf16 v[68:71], v[20:23], a[0:3], 0
ds_read_b128 v[44:47], v11 offset:4096
v_mfma_f32_16x16x32_bf16 v[72:75], v[20:23], a[4:7], 0
v_cvt_pk_bf16_f32 v84, v52, v53
v_cvt_pk_bf16_f32 v85, v54, v55
v_cvt_pk_bf16_f32 v86, v60, v61
v_mfma_f32_16x16x32_bf16 v[76:79], v[24:27], a[0:3], 0
ds_read_b128 v[48:51], v11 offset:6144
v_mfma_f32_16x16x32_bf16 v[80:83], v[24:27], a[4:7], 0
v_cvt_pk_bf16_f32 v87, v62, v63
v_cvt_pk_bf16_f32 v88, v56, v57
v_cvt_pk_bf16_f32 v89, v58, v59
s_waitcnt lgkmcnt(4)
v_mfma_f32_16x16x32_bf16 v[68:71], v[28:31], a[8:11], v[68:71]
ds_read_b128 v[20:23], v10 offset:8192
v_mfma_f32_16x16x32_bf16 v[72:75], v[28:31], a[12:15], v[72:75]
v_cvt_pk_bf16_f32 v90, v64, v65
v_cvt_pk_bf16_f32 v91, v66, v67
v_mfma_f32_16x16x32_bf16 v[76:79], v[32:35], a[8:11], v[76:79]
ds_read_b128 v[24:27], v10 offset:10240
v_mfma_f32_16x16x32_bf16 v[80:83], v[32:35], a[12:15], v[80:83]
s_add_u32 s51, s42, s47
s_sub_u32 s51, s51, 1
s_bfe_u32 s52, s51, 0x40002
s_lshl_b32 s52, s52, 14
s_waitcnt lgkmcnt(4)
v_mfma_f32_16x16x32_bf16 v[68:71], v[36:39], a[16:19], v[68:71]
ds_read_b128 v[28:31], v11 offset:8192
v_mfma_f32_16x16x32_bf16 v[72:75], v[36:39], a[20:23], v[72:75]
s_and_b32 s51, s51, 3
s_lshl_b32 s51, s51, 11
s_add_u32 s51, s51, s52
s_add_u32 s51, s51, s48
buffer_store_dwordx4 v[84:87], v7, s[84:87], s51 offen sc1
v_mfma_f32_16x16x32_bf16 v[76:79], v[40:43], a[16:19], v[76:79]
ds_read_b128 v[32:35], v11 offset:10240
v_mfma_f32_16x16x32_bf16 v[80:83], v[40:43], a[20:23], v[80:83]
buffer_store_dwordx4 v[88:91], v7, s[84:87], s51 offen offset:1024 sc1
s_waitcnt lgkmcnt(4)
v_mfma_f32_16x16x32_bf16 v[68:71], v[44:47], a[24:27], v[68:71]
ds_read_b128 v[36:39], v10 offset:12288
v_mfma_f32_16x16x32_bf16 v[72:75], v[44:47], a[28:31], v[72:75]
s_add_u32 m0, s46, 0
v_mfma_f32_16x16x32_bf16 v[76:79], v[48:51], a[24:27], v[76:79]
ds_read_b128 v[40:43], v10 offset:14336
v_mfma_f32_16x16x32_bf16 v[80:83], v[48:51], a[28:31], v[80:83]
buffer_load_dwordx4 v6, s[8:11], s50 offen offset:0 lds
s_waitcnt lgkmcnt(4)
v_mfma_f32_16x16x32_bf16 v[68:71], v[20:23], a[32:35], v[68:71]
ds_read_b128 v[44:47], v11 offset:12288
v_mfma_f32_16x16x32_bf16 v[72:75], v[20:23], a[36:39], v[72:75]
s_add_u32 m0, s46, 3968
v_mfma_f32_16x16x32_bf16 v[76:79], v[24:27], a[32:35], v[76:79]
ds_read_b128 v[48:51], v11 offset:14336
v_mfma_f32_16x16x32_bf16 v[80:83], v[24:27], a[36:39], v[80:83]
buffer_load_dwordx4 v6, s[8:11], s50 offen offset:128 lds
s_waitcnt lgkmcnt(4)
v_mfma_f32_16x16x32_bf16 v[68:71], v[28:31], a[40:43], v[68:71]
ds_read_b128 v[20:23], v10 offset:16384
v_mfma_f32_16x16x32_bf16 v[72:75], v[28:31], a[44:47], v[72:75]
s_add_u32 m0, s46, 7936
v_mfma_f32_16x16x32_bf16 v[76:79], v[32:35], a[40:43], v[76:79]
ds_read_b128 v[24:27], v10 offset:18432
v_mfma_f32_16x16x32_bf16 v[80:83], v[32:35], a[44:47], v[80:83]
buffer_load_dwordx4 v6, s[8:11], s50 offen offset:256 lds
s_waitcnt lgkmcnt(4)
v_mfma_f32_16x16x32_bf16 v[68:71], v[36:39], a[48:51], v[68:71]
ds_read_b128 v[28:31], v11 offset:16384
v_mfma_f32_16x16x32_bf16 v[72:75], v[36:39], a[52:55], v[72:75]
s_add_u32 m0, s46, 11904
v_mfma_f32_16x16x32_bf16 v[76:79], v[40:43], a[48:51], v[76:79]
ds_read_b128 v[32:35], v11 offset:18432
v_mfma_f32_16x16x32_bf16 v[80:83], v[40:43], a[52:55], v[80:83]
buffer_load_dwordx4 v6, s[8:11], s50 offen offset:384 lds
s_waitcnt lgkmcnt(4)
v_mfma_f32_16x16x32_bf16 v[68:71], v[44:47], a[56:59], v[68:71]
ds_read_b128 v[36:39], v10 offset:20480
v_mfma_f32_16x16x32_bf16 v[72:75], v[44:47], a[60:63], v[72:75]
s_add_u32 m0, s46, 15872
v_mfma_f32_16x16x32_bf16 v[76:79], v[48:51], a[56:59], v[76:79]
ds_read_b128 v[40:43], v10 offset:22528
v_mfma_f32_16x16x32_bf16 v[80:83], v[48:51], a[60:63], v[80:83]
buffer_load_dwordx4 v6, s[8:11], s50 offen offset:512 lds
s_waitcnt lgkmcnt(4)
v_mfma_f32_16x16x32_bf16 v[68:71], v[20:23], a[64:67], v[68:71]
ds_read_b128 v[44:47], v11 offset:20480
v_mfma_f32_16x16x32_bf16 v[72:75], v[20:23], a[68:71], v[72:75]
s_add_u32 m0, s46, 19840
v_mfma_f32_16x16x32_bf16 v[76:79], v[24:27], a[64:67], v[76:79]
ds_read_b128 v[48:51], v11 offset:22528
v_mfma_f32_16x16x32_bf16 v[80:83], v[24:27], a[68:71], v[80:83]
buffer_load_dwordx4 v6, s[8:11], s50 offen offset:640 lds
s_waitcnt lgkmcnt(4)
v_mfma_f32_16x16x32_bf16 v[68:71], v[28:31], a[72:75], v[68:71]
ds_read_b128 v[20:23], v10 offset:24576
v_mfma_f32_16x16x32_bf16 v[72:75], v[28:31], a[76:79], v[72:75]
s_add_u32 m0, s46, 23808
v_mfma_f32_16x16x32_bf16 v[76:79], v[32:35], a[72:75], v[76:79]
ds_read_b128 v[24:27], v10 offset:26624
v_mfma_f32_16x16x32_bf16 v[80:83], v[32:35], a[76:79], v[80:83]
buffer_load_dwordx4 v6, s[8:11], s50 offen offset:768 lds
s_waitcnt lgkmcnt(4)
v_mfma_f32_16x16x32_bf16 v[68:71], v[36:39], a[80:83], v[68:71]
ds_read_b128 v[28:31], v11 offset:24576
v_mfma_f32_16x16x32_bf16 v[72:75], v[36:39], a[84:87], v[72:75]
s_add_u32 m0, s46, 27776
v_mfma_f32_16x16x32_bf16 v[76:79], v[40:43], a[80:83], v[76:79]
ds_read_b128 v[32:35], v11 offset:26624
v_mfma_f32_16x16x32_bf16 v[80:83], v[40:43], a[84:87], v[80:83]
buffer_load_dwordx4 v6, s[8:11], s50 offen offset:896 lds
s_waitcnt lgkmcnt(4)
v_mfma_f32_16x16x32_bf16 v[68:71], v[44:47], a[88:91], v[68:71]
ds_read_b128 v[36:39], v10 offset:28672
v_mfma_f32_16x16x32_bf16 v[72:75], v[44:47], a[92:95], v[72:75]
s_add_u32 m0, s46, 31744
v_mfma_f32_16x16x32_bf16 v[76:79], v[48:51], a[88:91], v[76:79]
ds_read_b128 v[40:43], v10 offset:30720
v_mfma_f32_16x16x32_bf16 v[80:83], v[48:51], a[92:95], v[80:83]
buffer_load_dwordx4 v6, s[8:11], s50 offen offset:1024 lds
s_waitcnt lgkmcnt(4)
v_mfma_f32_16x16x32_bf16 v[68:71], v[20:23], a[96:99], v[68:71]
ds_read_b128 v[44:47], v11 offset:28672
v_mfma_f32_16x16x32_bf16 v[72:75], v[20:23], a[100:103], v[72:75]
s_add_u32 m0, s46, 35712
v_mfma_f32_16x16x32_bf16 v[76:79], v[24:27], a[96:99], v[76:79]
ds_read_b128 v[48:51], v11 offset:30720
v_mfma_f32_16x16x32_bf16 v[80:83], v[24:27], a[100:103], v[80:83]
buffer_load_dwordx4 v6, s[8:11], s50 offen offset:1152 lds
s_waitcnt lgkmcnt(4)
v_mfma_f32_16x16x32_bf16 v[68:71], v[28:31], a[104:107], v[68:71]
ds_read_b128 v[20:23], v10 offset:32768
v_mfma_f32_16x16x32_bf16 v[72:75], v[28:31], a[108:111], v[72:75]
s_add_u32 m0, s46, 39680
v_mfma_f32_16x16x32_bf16 v[76:79], v[32:35], a[104:107], v[76:79]
ds_read_b128 v[24:27], v10 offset:34816
v_mfma_f32_16x16x32_bf16 v[80:83], v[32:35], a[108:111], v[80:83]
buffer_load_dwordx4 v6, s[8:11], s50 offen offset:1280 lds
s_waitcnt lgkmcnt(4)
v_mfma_f32_16x16x32_bf16 v[68:71], v[36:39], a[112:115], v[68:71]
ds_read_b128 v[28:31], v11 offset:32768
v_mfma_f32_16x16x32_bf16 v[72:75], v[36:39], a[116:119], v[72:75]
s_add_u32 m0, s46, 43648
v_mfma_f32_16x16x32_bf16 v[76:79], v[40:43], a[112:115], v[76:79]
ds_read_b128 v[32:35], v11 offset:34816
v_mfma_f32_16x16x32_bf16 v[80:83], v[40:43], a[116:119], v[80:83]
buffer_load_dwordx4 v6, s[8:11], s50 offen offset:1408 lds
s_waitcnt lgkmcnt(4)
v_mfma_f32_16x16x32_bf16 v[68:71], v[44:47], a[120:123], v[68:71]
ds_read_b128 v[36:39], v10 offset:36864
v_mfma_f32_16x16x32_bf16 v[72:75], v[44:47], a[124:127], v[72:75]
s_add_u32 m0, s46, 47616
v_mfma_f32_16x16x32_bf16 v[76:79], v[48:51], a[120:123], v[76:79]
ds_read_b128 v[40:43], v10 offset:38912
v_mfma_f32_16x16x32_bf16 v[80:83], v[48:51], a[124:127], v[80:83]
buffer_load_dwordx4 v6, s[8:11], s50 offen offset:1536 lds
s_waitcnt lgkmcnt(4)
v_mfma_f32_16x16x32_bf16 v[68:71], v[20:23], a[128:131], v[68:71]
ds_read_b128 v[44:47], v11 offset:36864
v_mfma_f32_16x16x32_bf16 v[72:75], v[20:23], a[132:135], v[72:75]
s_add_u32 m0, s46, 51584
v_mfma_f32_16x16x32_bf16 v[76:79], v[24:27], a[128:131], v[76:79]
ds_read_b128 v[48:51], v11 offset:38912
v_mfma_f32_16x16x32_bf16 v[80:83], v[24:27], a[132:135], v[80:83]
buffer_load_dwordx4 v6, s[8:11], s50 offen offset:1664 lds
s_waitcnt lgkmcnt(4)
v_mfma_f32_16x16x32_bf16 v[68:71], v[28:31], a[136:139], v[68:71]
ds_read_b128 v[20:23], v10 offset:40960
v_mfma_f32_16x16x32_bf16 v[72:75], v[28:31], a[140:143], v[72:75]
s_add_u32 m0, s46, 55552
v_mfma_f32_16x16x32_bf16 v[76:79], v[32:35], a[136:139], v[76:79]
ds_read_b128 v[24:27], v10 offset:43008
v_mfma_f32_16x16x32_bf16 v[80:83], v[32:35], a[140:143], v[80:83]
buffer_load_dwordx4 v6, s[8:11], s50 offen offset:1792 lds
s_waitcnt lgkmcnt(4)
v_mfma_f32_16x16x32_bf16 v[68:71], v[36:39], a[144:147], v[68:71]
ds_read_b128 v[28:31], v11 offset:40960
v_mfma_f32_16x16x32_bf16 v[72:75], v[36:39], a[148:151], v[72:75]
s_add_u32 m0, s46, 59520
v_mfma_f32_16x16x32_bf16 v[76:79], v[40:43], a[144:147], v[76:79]
ds_read_b128 v[32:35], v11 offset:43008
v_mfma_f32_16x16x32_bf16 v[80:83], v[40:43], a[148:151], v[80:83]
buffer_load_dwordx4 v6, s[8:11], s50 offen offset:1920 lds
s_waitcnt lgkmcnt(4)
v_mfma_f32_16x16x32_bf16 v[68:71], v[44:47], a[152:155], v[68:71]
ds_read_b128 v[36:39], v10 offset:45056
v_mfma_f32_16x16x32_bf16 v[72:75], v[44:47], a[156:159], v[72:75]
v_mfma_f32_16x16x32_bf16 v[76:79], v[48:51], a[152:155], v[76:79]
ds_read_b128 v[40:43], v10 offset:47104
v_mfma_f32_16x16x32_bf16 v[80:83], v[48:51], a[156:159], v[80:83]
s_waitcnt lgkmcnt(4)
v_mfma_f32_16x16x32_bf16 v[68:71], v[20:23], a[160:163], v[68:71]
ds_read_b128 v[44:47], v11 offset:45056
v_mfma_f32_16x16x32_bf16 v[72:75], v[20:23], a[164:167], v[72:75]
v_mfma_f32_16x16x32_bf16 v[76:79], v[24:27], a[160:163], v[76:79]
ds_read_b128 v[48:51], v11 offset:47104
v_mfma_f32_16x16x32_bf16 v[80:83], v[24:27], a[164:167], v[80:83]
s_waitcnt lgkmcnt(4)
v_mfma_f32_16x16x32_bf16 v[68:71], v[28:31], a[168:171], v[68:71]
ds_read_b128 v[20:23], v10 offset:49152
v_mfma_f32_16x16x32_bf16 v[72:75], v[28:31], a[172:175], v[72:75]
s_waitcnt vmcnt(16)
v_mov_b32 v17, s42
s_mov_b64 exec, 1
buffer_store_dword v17, v16, s[84:87], s49 offen sc1
s_mov_b64 exec, -1
v_mfma_f32_16x16x32_bf16 v[76:79], v[32:35], a[168:171], v[76:79]
ds_read_b128 v[24:27], v10 offset:51200
v_mfma_f32_16x16x32_bf16 v[80:83], v[32:35], a[172:175], v[80:83]
s_waitcnt lgkmcnt(4)
v_mfma_f32_16x16x32_bf16 v[68:71], v[36:39], a[176:179], v[68:71]
ds_read_b128 v[28:31], v11 offset:49152
v_mfma_f32_16x16x32_bf16 v[72:75], v[36:39], a[180:183], v[72:75]
s_add_u32 s53, s42, 3
s_min_u32 s53, s53, 63
s_lshl_b32 s53, s53, 16
s_mov_b64 exec, 0xffff
buffer_load_dword v250, v19, s[8:11], s53 offen
s_mov_b64 exec, -1
v_mfma_f32_16x16x32_bf16 v[76:79], v[40:43], a[176:179], v[76:79]
ds_read_b128 v[32:35], v11 offset:51200
v_mfma_f32_16x16x32_bf16 v[80:83], v[40:43], a[180:183], v[80:83]
s_waitcnt lgkmcnt(4)
v_mfma_f32_16x16x32_bf16 v[68:71], v[44:47], a[184:187], v[68:71]
ds_read_b128 v[36:39], v10 offset:53248
v_mfma_f32_16x16x32_bf16 v[72:75], v[44:47], a[188:191], v[72:75]
v_mfma_f32_16x16x32_bf16 v[76:79], v[48:51], a[184:187], v[76:79]
ds_read_b128 v[40:43], v10 offset:55296
v_mfma_f32_16x16x32_bf16 v[80:83], v[48:51], a[188:191], v[80:83]
s_waitcnt lgkmcnt(4)
v_mfma_f32_16x16x32_bf16 v[68:71], v[20:23], a[192:195], v[68:71]
ds_read_b128 v[44:47], v11 offset:53248
v_mfma_f32_16x16x32_bf16 v[72:75], v[20:23], a[196:199], v[72:75]
v_mfma_f32_16x16x32_bf16 v[76:79], v[24:27], a[192:195], v[76:79]
ds_read_b128 v[48:51], v11 offset:55296
v_mfma_f32_16x16x32_bf16 v[80:83], v[24:27], a[196:199], v[80:83]
s_waitcnt lgkmcnt(4)
v_mfma_f32_16x16x32_bf16 v[68:71], v[28:31], a[200:203], v[68:71]
ds_read_b128 v[20:23], v10 offset:57344
v_mfma_f32_16x16x32_bf16 v[72:75], v[28:31], a[204:207], v[72:75]
v_mfma_f32_16x16x32_bf16 v[76:79], v[32:35], a[200:203], v[76:79]
ds_read_b128 v[24:27], v10 offset:59392
v_mfma_f32_16x16x32_bf16 v[80:83], v[32:35], a[204:207], v[80:83]
s_waitcnt lgkmcnt(4)
v_mfma_f32_16x16x32_bf16 v[68:71], v[36:39], a[208:211], v[68:71]
ds_read_b128 v[28:31], v11 offset:57344
v_mfma_f32_16x16x32_bf16 v[72:75], v[36:39], a[212:215], v[72:75]
v_mfma_f32_16x16x32_bf16 v[76:79], v[40:43], a[208:211], v[76:79]
ds_read_b128 v[32:35], v11 offset:59392
v_mfma_f32_16x16x32_bf16 v[80:83], v[40:43], a[212:215], v[80:83]
s_waitcnt lgkmcnt(4)
v_mfma_f32_16x16x32_bf16 v[68:71], v[44:47], a[216:219], v[68:71]
ds_read_b128 v[36:39], v10 offset:61440
v_mfma_f32_16x16x32_bf16 v[72:75], v[44:47], a[220:223], v[72:75]
v_mfma_f32_16x16x32_bf16 v[76:79], v[48:51], a[216:219], v[76:79]
ds_read_b128 v[40:43], v10 offset:63488
v_mfma_f32_16x16x32_bf16 v[80:83], v[48:51], a[220:223], v[80:83]
s_waitcnt lgkmcnt(4)
v_mfma_f32_16x16x32_bf16 v[68:71], v[20:23], a[224:227], v[68:71]
ds_read_b128 v[44:47], v11 offset:61440
v_mfma_f32_16x16x32_bf16 v[72:75], v[20:23], a[228:231], v[72:75]
v_mfma_f32_16x16x32_bf16 v[76:79], v[24:27], a[224:227], v[76:79]
ds_read_b128 v[48:51], v11 offset:63488
v_mfma_f32_16x16x32_bf16 v[80:83], v[24:27], a[228:231], v[80:83]
s_waitcnt lgkmcnt(5)
v_mfma_f32_16x16x32_bf16 v[68:71], v[28:31], a[232:235], v[68:71]
v_mfma_f32_16x16x32_bf16 v[72:75], v[28:31], a[236:239], v[72:75]
s_waitcnt lgkmcnt(4)
v_mfma_f32_16x16x32_bf16 v[76:79], v[32:35], a[232:235], v[76:79]
v_mfma_f32_16x16x32_bf16 v[80:83], v[32:35], a[236:239], v[80:83]
s_waitcnt lgkmcnt(3)
v_mfma_f32_16x16x32_bf16 v[68:71], v[36:39], a[240:243], v[68:71]
v_mfma_f32_16x16x32_bf16 v[72:75], v[36:39], a[244:247], v[72:75]
s_waitcnt lgkmcnt(2)
v_mfma_f32_16x16x32_bf16 v[76:79], v[40:43], a[240:243], v[76:79]
v_mfma_f32_16x16x32_bf16 v[80:83], v[40:43], a[244:247], v[80:83]
s_waitcnt lgkmcnt(1)
v_mfma_f32_16x16x32_bf16 v[68:71], v[44:47], a[248:251], v[68:71]
v_mfma_f32_16x16x32_bf16 v[72:75], v[44:47], a[252:255], v[72:75]
s_waitcnt lgkmcnt(0)
v_mfma_f32_16x16x32_bf16 v[76:79], v[48:51], a[248:251], v[76:79]
v_mfma_f32_16x16x32_bf16 v[80:83], v[48:51], a[252:255], v[80:83]
s_add_u32 s42, s42, 1
s_cmp_eq_u32 s42, 64
s_cbranch_scc1 mega_kernel_v_fin
mega_kernel_v_mid:
s_waitcnt vmcnt(2)
s_barrier
s_add_u32 s50, s42, 1
s_min_u32 s50, s50, 63
s_lshl_b32 s50, s50, 16
ds_read_b128 v[20:23], v8 offset:0
ds_read_b128 v[24:27], v8 offset:2048
ds_read_b128 v[28:31], v9 offset:0
ds_read_b128 v[32:35], v9 offset:2048
ds_read_b128 v[36:39], v8 offset:4096
ds_read_b128 v[40:43], v8 offset:6144
s_waitcnt lgkmcnt(4)
v_mfma_f32_16x16x32_bf16 v[52:55], v[20:23], a[0:3], 0
ds_read_b128 v[44:47], v9 offset:4096
v_mfma_f32_16x16x32_bf16 v[56:59], v[20:23], a[4:7], 0
v_cvt_pk_bf16_f32 v84, v68, v69
v_cvt_pk_bf16_f32 v85, v70, v71
v_cvt_pk_bf16_f32 v86, v76, v77
v_mfma_f32_16x16x32_bf16 v[60:63], v[24:27], a[0:3], 0
ds_read_b128 v[48:51], v9 offset:6144
v_mfma_f32_16x16x32_bf16 v[64:67], v[24:27], a[4:7], 0
v_cvt_pk_bf16_f32 v87, v78, v79
v_cvt_pk_bf16_f32 v88, v72, v73
v_cvt_pk_bf16_f32 v89, v74, v75
s_waitcnt lgkmcnt(4)
v_mfma_f32_16x16x32_bf16 v[52:55], v[28:31], a[8:11], v[52:55]
ds_read_b128 v[20:23], v8 offset:8192
v_mfma_f32_16x16x32_bf16 v[56:59], v[28:31], a[12:15], v[56:59]
v_cvt_pk_bf16_f32 v90, v80, v81
v_cvt_pk_bf16_f32 v91, v82, v83
v_mfma_f32_16x16x32_bf16 v[60:63], v[32:35], a[8:11], v[60:63]
ds_read_b128 v[24:27], v8 offset:10240
v_mfma_f32_16x16x32_bf16 v[64:67], v[32:35], a[12:15], v[64:67]
s_add_u32 s51, s42, s47
s_sub_u32 s51, s51, 1
s_bfe_u32 s52, s51, 0x40002
s_lshl_b32 s52, s52, 14
s_waitcnt lgkmcnt(4)
v_mfma_f32_16x16x32_bf16 v[52:55], v[36:39], a[16:19], v[52:55]
ds_read_b128 v[28:31], v9 offset:8192
v_mfma_f32_16x16x32_bf16 v[56:59], v[36:39], a[20:23], v[56:59]
s_and_b32 s51, s51, 3
s_lshl_b32 s51, s51, 11
s_add_u32 s51, s51, s52
s_add_u32 s51, s51, s48
buffer_store_dwordx4 v[84:87], v7, s[84:87], s51 offen sc1
v_mfma_f32_16x16x32_bf16 v[60:63], v[40:43], a[16:19], v[60:63]
ds_read_b128 v[32:35], v9 offset:10240
v_mfma_f32_16x16x32_bf16 v[64:67], v[40:43], a[20:23], v[64:67]
buffer_store_dwordx4 v[88:91], v7, s[84:87], s51 offen offset:1024 sc1
s_waitcnt lgkmcnt(4)
v_mfma_f32_16x16x32_bf16 v[52:55], v[44:47], a[24:27], v[52:55]
ds_read_b128 v[36:39], v8 offset:12288
v_mfma_f32_16x16x32_bf16 v[56:59], v[44:47], a[28:31], v[56:59]
s_add_u32 m0, s46, 65536
v_mfma_f32_16x16x32_bf16 v[60:63], v[48:51], a[24:27], v[60:63]
ds_read_b128 v[40:43], v8 offset:14336
v_mfma_f32_16x16x32_bf16 v[64:67], v[48:51], a[28:31], v[64:67]
buffer_load_dwordx4 v6, s[8:11], s50 offen offset:0 lds
s_waitcnt lgkmcnt(4)
v_mfma_f32_16x16x32_bf16 v[52:55], v[20:23], a[32:35], v[52:55]
ds_read_b128 v[44:47], v9 offset:12288
v_mfma_f32_16x16x32_bf16 v[56:59], v[20:23], a[36:39], v[56:59]
s_add_u32 m0, s46, 69504
v_mfma_f32_16x16x32_bf16 v[60:63], v[24:27], a[32:35], v[60:63]
ds_read_b128 v[48:51], v9 offset:14336
v_mfma_f32_16x16x32_bf16 v[64:67], v[24:27], a[36:39], v[64:67]
buffer_load_dwordx4 v6, s[8:11], s50 offen offset:128 lds
s_waitcnt lgkmcnt(4)
v_mfma_f32_16x16x32_bf16 v[52:55], v[28:31], a[40:43], v[52:55]
ds_read_b128 v[20:23], v8 offset:16384
v_mfma_f32_16x16x32_bf16 v[56:59], v[28:31], a[44:47], v[56:59]
s_add_u32 m0, s46, 73472
v_mfma_f32_16x16x32_bf16 v[60:63], v[32:35], a[40:43], v[60:63]
ds_read_b128 v[24:27], v8 offset:18432
v_mfma_f32_16x16x32_bf16 v[64:67], v[32:35], a[44:47], v[64:67]
buffer_load_dwordx4 v6, s[8:11], s50 offen offset:256 lds
s_waitcnt lgkmcnt(4)
v_mfma_f32_16x16x32_bf16 v[52:55], v[36:39], a[48:51], v[52:55]
ds_read_b128 v[28:31], v9 offset:16384
v_mfma_f32_16x16x32_bf16 v[56:59], v[36:39], a[52:55], v[56:59]
s_add_u32 m0, s46, 77440
v_mfma_f32_16x16x32_bf16 v[60:63], v[40:43], a[48:51], v[60:63]
ds_read_b128 v[32:35], v9 offset:18432
v_mfma_f32_16x16x32_bf16 v[64:67], v[40:43], a[52:55], v[64:67]
buffer_load_dwordx4 v6, s[8:11], s50 offen offset:384 lds
s_waitcnt lgkmcnt(4)
v_mfma_f32_16x16x32_bf16 v[52:55], v[44:47], a[56:59], v[52:55]
ds_read_b128 v[36:39], v8 offset:20480
v_mfma_f32_16x16x32_bf16 v[56:59], v[44:47], a[60:63], v[56:59]
s_add_u32 m0, s46, 81408
v_mfma_f32_16x16x32_bf16 v[60:63], v[48:51], a[56:59], v[60:63]
ds_read_b128 v[40:43], v8 offset:22528
v_mfma_f32_16x16x32_bf16 v[64:67], v[48:51], a[60:63], v[64:67]
buffer_load_dwordx4 v6, s[8:11], s50 offen offset:512 lds
s_waitcnt lgkmcnt(4)
v_mfma_f32_16x16x32_bf16 v[52:55], v[20:23], a[64:67], v[52:55]
ds_read_b128 v[44:47], v9 offset:20480
v_mfma_f32_16x16x32_bf16 v[56:59], v[20:23], a[68:71], v[56:59]
s_add_u32 m0, s46, 85376
v_mfma_f32_16x16x32_bf16 v[60:63], v[24:27], a[64:67], v[60:63]
ds_read_b128 v[48:51], v9 offset:22528
v_mfma_f32_16x16x32_bf16 v[64:67], v[24:27], a[68:71], v[64:67]
buffer_load_dwordx4 v6, s[8:11], s50 offen offset:640 lds
s_waitcnt lgkmcnt(4)
v_mfma_f32_16x16x32_bf16 v[52:55], v[28:31], a[72:75], v[52:55]
ds_read_b128 v[20:23], v8 offset:24576
v_mfma_f32_16x16x32_bf16 v[56:59], v[28:31], a[76:79], v[56:59]
s_add_u32 m0, s46, 89344
v_mfma_f32_16x16x32_bf16 v[60:63], v[32:35], a[72:75], v[60:63]
ds_read_b128 v[24:27], v8 offset:26624
v_mfma_f32_16x16x32_bf16 v[64:67], v[32:35], a[76:79], v[64:67]
buffer_load_dwordx4 v6, s[8:11], s50 offen offset:768 lds
s_waitcnt lgkmcnt(4)
v_mfma_f32_16x16x32_bf16 v[52:55], v[36:39], a[80:83], v[52:55]
ds_read_b128 v[28:31], v9 offset:24576
v_mfma_f32_16x16x32_bf16 v[56:59], v[36:39], a[84:87], v[56:59]
s_add_u32 m0, s46, 93312
v_mfma_f32_16x16x32_bf16 v[60:63], v[40:43], a[80:83], v[60:63]
ds_read_b128 v[32:35], v9 offset:26624
v_mfma_f32_16x16x32_bf16 v[64:67], v[40:43], a[84:87], v[64:67]
buffer_load_dwordx4 v6, s[8:11], s50 offen offset:896 lds
s_waitcnt lgkmcnt(4)
v_mfma_f32_16x16x32_bf16 v[52:55], v[44:47], a[88:91], v[52:55]
ds_read_b128 v[36:39], v8 offset:28672
v_mfma_f32_16x16x32_bf16 v[56:59], v[44:47], a[92:95], v[56:59]
s_add_u32 m0, s46, 97280
v_mfma_f32_16x16x32_bf16 v[60:63], v[48:51], a[88:91], v[60:63]
ds_read_b128 v[40:43], v8 offset:30720
v_mfma_f32_16x16x32_bf16 v[64:67], v[48:51], a[92:95], v[64:67]
buffer_load_dwordx4 v6, s[8:11], s50 offen offset:1024 lds
s_waitcnt lgkmcnt(4)
v_mfma_f32_16x16x32_bf16 v[52:55], v[20:23], a[96:99], v[52:55]
ds_read_b128 v[44:47], v9 offset:28672
v_mfma_f32_16x16x32_bf16 v[56:59], v[20:23], a[100:103], v[56:59]
s_add_u32 m0, s46, 101248
v_mfma_f32_16x16x32_bf16 v[60:63], v[24:27], a[96:99], v[60:63]
ds_read_b128 v[48:51], v9 offset:30720
v_mfma_f32_16x16x32_bf16 v[64:67], v[24:27], a[100:103], v[64:67]
buffer_load_dwordx4 v6, s[8:11], s50 offen offset:1152 lds
s_waitcnt lgkmcnt(4)
v_mfma_f32_16x16x32_bf16 v[52:55], v[28:31], a[104:107], v[52:55]
ds_read_b128 v[20:23], v8 offset:32768
v_mfma_f32_16x16x32_bf16 v[56:59], v[28:31], a[108:111], v[56:59]
s_add_u32 m0, s46, 105216
v_mfma_f32_16x16x32_bf16 v[60:63], v[32:35], a[104:107], v[60:63]
ds_read_b128 v[24:27], v8 offset:34816
v_mfma_f32_16x16x32_bf16 v[64:67], v[32:35], a[108:111], v[64:67]
buffer_load_dwordx4 v6, s[8:11], s50 offen offset:1280 lds
s_waitcnt lgkmcnt(4)
v_mfma_f32_16x16x32_bf16 v[52:55], v[36:39], a[112:115], v[52:55]
ds_read_b128 v[28:31], v9 offset:32768
v_mfma_f32_16x16x32_bf16 v[56:59], v[36:39], a[116:119], v[56:59]
s_add_u32 m0, s46, 109184
v_mfma_f32_16x16x32_bf16 v[60:63], v[40:43], a[112:115], v[60:63]
ds_read_b128 v[32:35], v9 offset:34816
v_mfma_f32_16x16x32_bf16 v[64:67], v[40:43], a[116:119], v[64:67]
buffer_load_dwordx4 v6, s[8:11], s50 offen offset:1408 lds
s_waitcnt lgkmcnt(4)
v_mfma_f32_16x16x32_bf16 v[52:55], v[44:47], a[120:123], v[52:55]
ds_read_b128 v[36:39], v8 offset:36864
v_mfma_f32_16x16x32_bf16 v[56:59], v[44:47], a[124:127], v[56:59]
s_add_u32 m0, s46, 113152
v_mfma_f32_16x16x32_bf16 v[60:63], v[48:51], a[120:123], v[60:63]
ds_read_b128 v[40:43], v8 offset:38912
v_mfma_f32_16x16x32_bf16 v[64:67], v[48:51], a[124:127], v[64:67]
buffer_load_dwordx4 v6, s[8:11], s50 offen offset:1536 lds
s_waitcnt lgkmcnt(4)
v_mfma_f32_16x16x32_bf16 v[52:55], v[20:23], a[128:131], v[52:55]
ds_read_b128 v[44:47], v9 offset:36864
v_mfma_f32_16x16x32_bf16 v[56:59], v[20:23], a[132:135], v[56:59]
s_add_u32 m0, s46, 117120
v_mfma_f32_16x16x32_bf16 v[60:63], v[24:27], a[128:131], v[60:63]
ds_read_b128 v[48:51], v9 offset:38912
v_mfma_f32_16x16x32_bf16 v[64:67], v[24:27], a[132:135], v[64:67]
buffer_load_dwordx4 v6, s[8:11], s50 offen offset:1664 lds
s_waitcnt lgkmcnt(4)
v_mfma_f32_16x16x32_bf16 v[52:55], v[28:31], a[136:139], v[52:55]
ds_read_b128 v[20:23], v8 offset:40960
v_mfma_f32_16x16x32_bf16 v[56:59], v[28:31], a[140:143], v[56:59]
s_add_u32 m0, s46, 121088
v_mfma_f32_16x16x32_bf16 v[60:63], v[32:35], a[136:139], v[60:63]
ds_read_b128 v[24:27], v8 offset:43008
v_mfma_f32_16x16x32_bf16 v[64:67], v[32:35], a[140:143], v[64:67]
buffer_load_dwordx4 v6, s[8:11], s50 offen offset:1792 lds
s_waitcnt lgkmcnt(4)
v_mfma_f32_16x16x32_bf16 v[52:55], v[36:39], a[144:147], v[52:55]
ds_read_b128 v[28:31], v9 offset:40960
v_mfma_f32_16x16x32_bf16 v[56:59], v[36:39], a[148:151], v[56:59]
s_add_u32 m0, s46, 125056
v_mfma_f32_16x16x32_bf16 v[60:63], v[40:43], a[144:147], v[60:63]
ds_read_b128 v[32:35], v9 offset:43008
v_mfma_f32_16x16x32_bf16 v[64:67], v[40:43], a[148:151], v[64:67]
buffer_load_dwordx4 v6, s[8:11], s50 offen offset:1920 lds
s_waitcnt lgkmcnt(4)
v_mfma_f32_16x16x32_bf16 v[52:55], v[44:47], a[152:155], v[52:55]
ds_read_b128 v[36:39], v8 offset:45056
v_mfma_f32_16x16x32_bf16 v[56:59], v[44:47], a[156:159], v[56:59]
v_mfma_f32_16x16x32_bf16 v[60:63], v[48:51], a[152:155], v[60:63]
ds_read_b128 v[40:43], v8 offset:47104
v_mfma_f32_16x16x32_bf16 v[64:67], v[48:51], a[156:159], v[64:67]
s_waitcnt lgkmcnt(4)
v_mfma_f32_16x16x32_bf16 v[52:55], v[20:23], a[160:163], v[52:55]
ds_read_b128 v[44:47], v9 offset:45056
v_mfma_f32_16x16x32_bf16 v[56:59], v[20:23], a[164:167], v[56:59]
v_mfma_f32_16x16x32_bf16 v[60:63], v[24:27], a[160:163], v[60:63]
ds_read_b128 v[48:51], v9 offset:47104
v_mfma_f32_16x16x32_bf16 v[64:67], v[24:27], a[164:167], v[64:67]
s_waitcnt lgkmcnt(4)
v_mfma_f32_16x16x32_bf16 v[52:55], v[28:31], a[168:171], v[52:55]
ds_read_b128 v[20:23], v8 offset:49152
v_mfma_f32_16x16x32_bf16 v[56:59], v[28:31], a[172:175], v[56:59]
s_waitcnt vmcnt(16)
v_mov_b32 v17, s42
s_mov_b64 exec, 1
buffer_store_dword v17, v16, s[84:87], s49 offen sc1
s_mov_b64 exec, -1
v_mfma_f32_16x16x32_bf16 v[60:63], v[32:35], a[168:171], v[60:63]
ds_read_b128 v[24:27], v8 offset:51200
v_mfma_f32_16x16x32_bf16 v[64:67], v[32:35], a[172:175], v[64:67]
s_waitcnt lgkmcnt(4)
v_mfma_f32_16x16x32_bf16 v[52:55], v[36:39], a[176:179], v[52:55]
ds_read_b128 v[28:31], v9 offset:49152
v_mfma_f32_16x16x32_bf16 v[56:59], v[36:39], a[180:183], v[56:59]
s_add_u32 s53, s42, 3
s_min_u32 s53, s53, 63
s_lshl_b32 s53, s53, 16
s_mov_b64 exec, 0xffff
buffer_load_dword v250, v19, s[8:11], s53 offen
s_mov_b64 exec, -1
v_mfma_f32_16x16x32_bf16 v[60:63], v[40:43], a[176:179], v[60:63]
ds_read_b128 v[32:35], v9 offset:51200
v_mfma_f32_16x16x32_bf16 v[64:67], v[40:43], a[180:183], v[64:67]
s_waitcnt lgkmcnt(4)
v_mfma_f32_16x16x32_bf16 v[52:55], v[44:47], a[184:187], v[52:55]
ds_read_b128 v[36:39], v8 offset:53248
v_mfma_f32_16x16x32_bf16 v[56:59], v[44:47], a[188:191], v[56:59]
v_mfma_f32_16x16x32_bf16 v[60:63], v[48:51], a[184:187], v[60:63]
ds_read_b128 v[40:43], v8 offset:55296
v_mfma_f32_16x16x32_bf16 v[64:67], v[48:51], a[188:191], v[64:67]
s_waitcnt lgkmcnt(4)
v_mfma_f32_16x16x32_bf16 v[52:55], v[20:23], a[192:195], v[52:55]
ds_read_b128 v[44:47], v9 offset:53248
v_mfma_f32_16x16x32_bf16 v[56:59], v[20:23], a[196:199], v[56:59]
v_mfma_f32_16x16x32_bf16 v[60:63], v[24:27], a[192:195], v[60:63]
ds_read_b128 v[48:51], v9 offset:55296
v_mfma_f32_16x16x32_bf16 v[64:67], v[24:27], a[196:199], v[64:67]
s_waitcnt lgkmcnt(4)
v_mfma_f32_16x16x32_bf16 v[52:55], v[28:31], a[200:203], v[52:55]
ds_read_b128 v[20:23], v8 offset:57344
v_mfma_f32_16x16x32_bf16 v[56:59], v[28:31], a[204:207], v[56:59]
v_mfma_f32_16x16x32_bf16 v[60:63], v[32:35], a[200:203], v[60:63]
ds_read_b128 v[24:27], v8 offset:59392
v_mfma_f32_16x16x32_bf16 v[64:67], v[32:35], a[204:207], v[64:67]
s_waitcnt lgkmcnt(4)
v_mfma_f32_16x16x32_bf16 v[52:55], v[36:39], a[208:211], v[52:55]
ds_read_b128 v[28:31], v9 offset:57344
v_mfma_f32_16x16x32_bf16 v[56:59], v[36:39], a[212:215], v[56:59]
v_mfma_f32_16x16x32_bf16 v[60:63], v[40:43], a[208:211], v[60:63]
ds_read_b128 v[32:35], v9 offset:59392
v_mfma_f32_16x16x32_bf16 v[64:67], v[40:43], a[212:215], v[64:67]
s_waitcnt lgkmcnt(4)
v_mfma_f32_16x16x32_bf16 v[52:55], v[44:47], a[216:219], v[52:55]
ds_read_b128 v[36:39], v8 offset:61440
v_mfma_f32_16x16x32_bf16 v[56:59], v[44:47], a[220:223], v[56:59]
v_mfma_f32_16x16x32_bf16 v[60:63], v[48:51], a[216:219], v[60:63]
ds_read_b128 v[40:43], v8 offset:63488
v_mfma_f32_16x16x32_bf16 v[64:67], v[48:51], a[220:223], v[64:67]
s_waitcnt lgkmcnt(4)
v_mfma_f32_16x16x32_bf16 v[52:55], v[20:23], a[224:227], v[52:55]
ds_read_b128 v[44:47], v9 offset:61440
v_mfma_f32_16x16x32_bf16 v[56:59], v[20:23], a[228:231], v[56:59]
v_mfma_f32_16x16x32_bf16 v[60:63], v[24:27], a[224:227], v[60:63]
ds_read_b128 v[48:51], v9 offset:63488
v_mfma_f32_16x16x32_bf16 v[64:67], v[24:27], a[228:231], v[64:67]
s_waitcnt lgkmcnt(5)
v_mfma_f32_16x16x32_bf16 v[52:55], v[28:31], a[232:235], v[52:55]
v_mfma_f32_16x16x32_bf16 v[56:59], v[28:31], a[236:239], v[56:59]
s_waitcnt lgkmcnt(4)
v_mfma_f32_16x16x32_bf16 v[60:63], v[32:35], a[232:235], v[60:63]
v_mfma_f32_16x16x32_bf16 v[64:67], v[32:35], a[236:239], v[64:67]
s_waitcnt lgkmcnt(3)
v_mfma_f32_16x16x32_bf16 v[52:55], v[36:39], a[240:243], v[52:55]
v_mfma_f32_16x16x32_bf16 v[56:59], v[36:39], a[244:247], v[56:59]
s_waitcnt lgkmcnt(2)
v_mfma_f32_16x16x32_bf16 v[60:63], v[40:43], a[240:243], v[60:63]
v_mfma_f32_16x16x32_bf16 v[64:67], v[40:43], a[244:247], v[64:67]
s_waitcnt lgkmcnt(1)
v_mfma_f32_16x16x32_bf16 v[52:55], v[44:47], a[248:251], v[52:55]
v_mfma_f32_16x16x32_bf16 v[56:59], v[44:47], a[252:255], v[56:59]
s_waitcnt lgkmcnt(0)
v_mfma_f32_16x16x32_bf16 v[60:63], v[48:51], a[248:251], v[60:63]
v_mfma_f32_16x16x32_bf16 v[64:67], v[48:51], a[252:255], v[64:67]
s_add_u32 s42, s42, 1
s_branch mega_kernel_v_loop
mega_kernel_v_fin:
s_nop 11
v_cvt_pk_bf16_f32 v84, v68, v69
v_cvt_pk_bf16_f32 v85, v70, v71
v_cvt_pk_bf16_f32 v86, v76, v77
v_cvt_pk_bf16_f32 v87, v78, v79
v_cvt_pk_bf16_f32 v88, v72, v73
v_cvt_pk_bf16_f32 v89, v74, v75
v_cvt_pk_bf16_f32 v90, v80, v81
v_cvt_pk_bf16_f32 v91, v82, v83
s_add_u32 s51, s42, s47
s_sub_u32 s51, s51, 1
s_bfe_u32 s52, s51, 0x40002
s_lshl_b32 s52, s52, 14
s_and_b32 s51, s51, 3
s_lshl_b32 s51, s51, 11
s_add_u32 s51, s51, s52
s_add_u32 s51, s51, s48
buffer_store_dwordx4 v[84:87], v7, s[84:87], s51 offen sc1
buffer_store_dwordx4 v[88:91], v7, s[84:87], s51 offen offset:1024 sc1
s_waitcnt vmcnt(0)
v_mov_b32 v17, s42
s_mov_b64 exec, 1
buffer_store_dword v17, v16, s[84:87], s49 offen sc1
s_mov_b64 exec, -1
s_waitcnt vmcnt(0)
s_barrier
mega_kernel_fft:
s_mov_b32 s38, s92
s_mov_b32 s39, 64
s_mov_b32 s37, 129
mega_kernel_f2s:
v_mov_b32 v1, 0
s_mov_b32 s82, 69259264
mega_kernel_w0:
s_sleep 8
buffer_load_dword v2, v1, s[84:87], s82 offen sc1
s_waitcnt vmcnt(0)
v_cmp_ne_u32 vcc, 31, v2
s_cbranch_vccnz mega_kernel_w0
s_mov_b32 s48, 0x3f7ec46d
s_mov_b32 s49, 0x3dc8bd36
s_mov_b32 s50, 0x3f7b14be
s_mov_b32 s51, 0x3e47c5c2
s_mov_b32 s52, 0x3f74fa0b
s_mov_b32 s53, 0x3e94a031
s_mov_b32 s54, 0x3f6c835e
s_mov_b32 s55, 0x3ec3ef15
s_mov_b32 s56, 0x3f61c598
s_mov_b32 s57, 0x3ef15aea
s_mov_b32 s58, 0x3f54db31
s_mov_b32 s59, 0x3f0e39da
s_mov_b32 s60, 0x3f45e403
s_mov_b32 s61, 0x3f226799
s_mov_b32 s62, 0x3f3504f3
s_mov_b32 s63, 0x3f3504f3
v_lshrrev_b32 v10, 6, v0
v_and_b32 v1, 63, v0
v_readfirstlane_b32 s16, v10
v_cvt_f32_u32 v2, v1
v_lshlrev_b32 v5, 3, v1
s_mul_i32 s17, s16, 16896
v_add_u32 v3, s17, v5
v_and_b32 v7, 1, v1
v_lshrrev_b32 v6, 1, v1
v_cvt_f32_u32 v8, v6
v_cvt_f32_u32 v10, v7
v_mul_u32_u24 v4, 528, v6
v_lshl_add_u32 v4, v7, 3, v4
v_add_u32 v4, s17, v4
v_lshlrev_b32 v11, 12, v7
v_lshl_add_u32 v11, v6, 2, v11
v_fma_f32 v9, v10, 2.0, -1.0
v_sub_f32 v7, 0, v9
v_mul_f32 v13, v10, v8
v_mul_f32 v13, 0x3a000000, v13
s_mov_b32 s18, 0xaaaaaaaa
s_mov_b32 s19, 0xaaaaaaaa
v_mul_f32 v12, 0xba000000, v2
v_cos_f32 v82, v12
v_sin_f32 v83, v12
v_mul_f32 v12, 0xba800000, v2
v_cos_f32 v84, v12
v_sin_f32 v85, v12
v_mul_f32 v12, 0xbac00000, v2
v_cos_f32 v86, v12
v_sin_f32 v87, v12
v_mul_f32 v12, 0xbb000000, v2
v_cos_f32 v88, v12
v_sin_f32 v89, v12
v_mul_f32 v12, 0xbb200000, v2
v_cos_f32 v90, v12
v_sin_f32 v91, v12
v_mul_f32 v12, 0xbb400000, v2
v_cos_f32 v92, v12
v_sin_f32 v93, v12
v_mul_f32 v12, 0xbb600000, v2
v_cos_f32 v94, v12
v_sin_f32 v95, v12
v_mul_f32 v12, 0xbb800000, v2
v_cos_f32 v96, v12
v_sin_f32 v97, v12
v_mul_f32 v12, 0xbb900000, v2
v_cos_f32 v98, v12
v_sin_f32 v99, v12
v_mul_f32 v12, 0xbba00000, v2
v_cos_f32 v100, v12
v_sin_f32 v101, v12
v_mul_f32 v12, 0xbbb00000, v2
v_cos_f32 v102, v12
v_sin_f32 v103, v12
v_mul_f32 v12, 0xbbc00000, v2
v_cos_f32 v104, v12
v_sin_f32 v105, v12
v_mul_f32 v12, 0xbbd00000, v2
v_cos_f32 v106, v12
v_sin_f32 v107, v12
v_mul_f32 v12, 0xbbe00000, v2
v_cos_f32 v108, v12
v_sin_f32 v109, v12
v_mul_f32 v12, 0xbbf00000, v2
v_cos_f32 v110, v12
v_sin_f32 v111, v12
v_mul_f32 v12, 0xbc000000, v2
v_cos_f32 v112, v12
v_sin_f32 v113, v12
v_mul_f32 v12, 0xbc080000, v2
v_cos_f32 v114, v12
v_sin_f32 v115, v12
v_mul_f32 v12, 0xbc100000, v2
v_cos_f32 v116, v12
v_sin_f32 v117, v12
v_mul_f32 v12, 0xbc180000, v2
v_cos_f32 v118, v12
v_sin_f32 v119, v12
v_mul_f32 v12, 0xbc200000, v2
v_cos_f32 v120, v12
v_sin_f32 v121, v12
v_mul_f32 v12, 0xbc280000, v2
v_cos_f32 v122, v12
v_sin_f32 v123, v12
v_mul_f32 v12, 0xbc300000, v2
v_cos_f32 v124, v12
v_sin_f32 v125, v12
v_mul_f32 v12, 0xbc380000, v2
v_cos_f32 v126, v12
v_sin_f32 v127, v12
v_mul_f32 v12, 0xbc400000, v2
v_cos_f32 v128, v12
v_sin_f32 v129, v12
v_mul_f32 v12, 0xbc480000, v2
v_cos_f32 v130, v12
v_sin_f32 v131, v12
v_mul_f32 v12, 0xbc500000, v2
v_cos_f32 v132, v12
v_sin_f32 v133, v12
v_mul_f32 v12, 0xbc580000, v2
v_cos_f32 v134, v12
v_sin_f32 v135, v12
v_mul_f32 v12, 0xbc600000, v2
v_cos_f32 v136, v12
v_sin_f32 v137, v12
v_mul_f32 v12, 0xbc680000, v2
v_cos_f32 v138, v12
v_sin_f32 v139, v12
v_mul_f32 v12, 0xbc700000, v2
v_cos_f32 v140, v12
v_sin_f32 v141, v12
v_mul_f32 v12, 0xbc780000, v2
v_cos_f32 v142, v12
v_sin_f32 v143, v12
v_mov_b32 v12, v13
v_fmac_f32 v12, 0x00000000, v8
v_cos_f32 v144, v12
v_sin_f32 v145, v12
v_mov_b32 v12, v13
v_fmac_f32 v12, 0x3a800000, v8
v_cos_f32 v146, v12
v_sin_f32 v147, v12
v_mov_b32 v12, v13
v_fmac_f32 v12, 0x3b000000, v8
v_cos_f32 v148, v12
v_sin_f32 v149, v12
v_mov_b32 v12, v13
v_fmac_f32 v12, 0x3b400000, v8
v_cos_f32 v150, v12
v_sin_f32 v151, v12
v_mov_b32 v12, v13
v_fmac_f32 v12, 0x3b800000, v8
v_cos_f32 v152, v12
v_sin_f32 v153, v12
v_mov_b32 v12, v13
v_fmac_f32 v12, 0x3ba00000, v8
v_cos_f32 v154, v12
v_sin_f32 v155, v12
v_mov_b32 v12, v13
v_fmac_f32 v12, 0x3bc00000, v8
v_cos_f32 v156, v12
v_sin_f32 v157, v12
v_mov_b32 v12, v13
v_fmac_f32 v12, 0x3be00000, v8
v_cos_f32 v158, v12
v_sin_f32 v159, v12
v_mov_b32 v12, v13
v_fmac_f32 v12, 0x3c000000, v8
v_cos_f32 v160, v12
v_sin_f32 v161, v12
v_mov_b32 v12, v13
v_fmac_f32 v12, 0x3c100000, v8
v_cos_f32 v162, v12
v_sin_f32 v163, v12
v_mov_b32 v12, v13
v_fmac_f32 v12, 0x3c200000, v8
v_cos_f32 v164, v12
v_sin_f32 v165, v12
v_mov_b32 v12, v13
v_fmac_f32 v12, 0x3c300000, v8
v_cos_f32 v166, v12
v_sin_f32 v167, v12
v_mov_b32 v12, v13
v_fmac_f32 v12, 0x3c400000, v8
v_cos_f32 v168, v12
v_sin_f32 v169, v12
v_mov_b32 v12, v13
v_fmac_f32 v12, 0x3c500000, v8
v_cos_f32 v170, v12
v_sin_f32 v171, v12
v_mov_b32 v12, v13
v_fmac_f32 v12, 0x3c600000, v8
v_cos_f32 v172, v12
v_sin_f32 v173, v12
v_mov_b32 v12, v13
v_fmac_f32 v12, 0x3c700000, v8
v_cos_f32 v174, v12
v_sin_f32 v175, v12
v_mov_b32 v12, v13
v_fmac_f32 v12, 0x3c800000, v8
v_cos_f32 v176, v12
v_sin_f32 v177, v12
v_mov_b32 v12, v13
v_fmac_f32 v12, 0x3c880000, v8
v_cos_f32 v178, v12
v_sin_f32 v179, v12
v_mov_b32 v12, v13
v_fmac_f32 v12, 0x3c900000, v8
v_cos_f32 v180, v12
v_sin_f32 v181, v12
v_mov_b32 v12, v13
v_fmac_f32 v12, 0x3c980000, v8
v_cos_f32 v182, v12
v_sin_f32 v183, v12
v_mov_b32 v12, v13
v_fmac_f32 v12, 0x3ca00000, v8
v_cos_f32 v184, v12
v_sin_f32 v185, v12
v_mov_b32 v12, v13
v_fmac_f32 v12, 0x3ca80000, v8
v_cos_f32 v186, v12
v_sin_f32 v187, v12
v_mov_b32 v12, v13
v_fmac_f32 v12, 0x3cb00000, v8
v_cos_f32 v188, v12
v_sin_f32 v189, v12
v_mov_b32 v12, v13
v_fmac_f32 v12, 0x3cb80000, v8
v_cos_f32 v190, v12
v_sin_f32 v191, v12
v_mov_b32 v12, v13
v_fmac_f32 v12, 0x3cc00000, v8
v_cos_f32 v192, v12
v_sin_f32 v193, v12
v_mov_b32 v12, v13
v_fmac_f32 v12, 0x3cc80000, v8
v_cos_f32 v194, v12
v_sin_f32 v195, v12
v_mov_b32 v12, v13
v_fmac_f32 v12, 0x3cd00000, v8
v_cos_f32 v196, v12
v_sin_f32 v197, v12
v_mov_b32 v12, v13
v_fmac_f32 v12, 0x3cd80000, v8
v_cos_f32 v198, v12
v_sin_f32 v199, v12
v_mov_b32 v12, v13
v_fmac_f32 v12, 0x3ce00000, v8
v_cos_f32 v200, v12
v_sin_f32 v201, v12
v_mov_b32 v12, v13
v_fmac_f32 v12, 0x3ce80000, v8
v_cos_f32 v202, v12
v_sin_f32 v203, v12
v_mov_b32 v12, v13
v_fmac_f32 v12, 0x3cf00000, v8
v_cos_f32 v204, v12
v_sin_f32 v205, v12
v_mov_b32 v12, v13
v_fmac_f32 v12, 0x3cf80000, v8
v_cos_f32 v206, v12
v_sin_f32 v207, v12
s_nop 0
v_mul_f32 v144, 0x34800000, v144
v_mul_f32 v145, 0x34800000, v145
v_mul_f32 v146, 0x34800000, v146
v_mul_f32 v147, 0x34800000, v147
v_mul_f32 v148, 0x34800000, v148
v_mul_f32 v149, 0x34800000, v149
v_mul_f32 v150, 0x34800000, v150
v_mul_f32 v151, 0x34800000, v151
v_mul_f32 v152, 0x34800000, v152
v_mul_f32 v153, 0x34800000, v153
v_mul_f32 v154, 0x34800000, v154
v_mul_f32 v155, 0x34800000, v155
v_mul_f32 v156, 0x34800000, v156
v_mul_f32 v157, 0x34800000, v157
v_mul_f32 v158, 0x34800000, v158
v_mul_f32 v159, 0x34800000, v159
v_mul_f32 v160, 0x34800000, v160
v_mul_f32 v161, 0x34800000, v161
v_mul_f32 v162, 0x34800000, v162
v_mul_f32 v163, 0x34800000, v163
v_mul_f32 v164, 0x34800000, v164
v_mul_f32 v165, 0x34800000, v165
v_mul_f32 v166, 0x34800000, v166
v_mul_f32 v167, 0x34800000, v167
v_mul_f32 v168, 0x34800000, v168
v_mul_f32 v169, 0x34800000, v169
v_mul_f32 v170, 0x34800000, v170
v_mul_f32 v171, 0x34800000, v171
v_mul_f32 v172, 0x34800000, v172
v_mul_f32 v173, 0x34800000, v173
v_mul_f32 v174, 0x34800000, v174
v_mul_f32 v175, 0x34800000, v175
v_mul_f32 v176, 0x34800000, v176
v_mul_f32 v177, 0x34800000, v177
v_mul_f32 v178, 0x34800000, v178
v_mul_f32 v179, 0x34800000, v179
v_mul_f32 v180, 0x34800000, v180
v_mul_f32 v181, 0x34800000, v181
v_mul_f32 v182, 0x34800000, v182
v_mul_f32 v183, 0x34800000, v183
v_mul_f32 v184, 0x34800000, v184
v_mul_f32 v185, 0x34800000, v185
v_mul_f32 v186, 0x34800000, v186
v_mul_f32 v187, 0x34800000, v187
v_mul_f32 v188, 0x34800000, v188
v_mul_f32 v189, 0x34800000, v189
v_mul_f32 v190, 0x34800000, v190
v_mul_f32 v191, 0x34800000, v191
v_mul_f32 v192, 0x34800000, v192
v_mul_f32 v193, 0x34800000, v193
v_mul_f32 v194, 0x34800000, v194
v_mul_f32 v195, 0x34800000, v195
v_mul_f32 v196, 0x34800000, v196
v_mul_f32 v197, 0x34800000, v197
v_mul_f32 v198, 0x34800000, v198
v_mul_f32 v199, 0x34800000, v199
v_mul_f32 v200, 0x34800000, v200
v_mul_f32 v201, 0x34800000, v201
v_mul_f32 v202, 0x34800000, v202
v_mul_f32 v203, 0x34800000, v203
v_mul_f32 v204, 0x34800000, v204
v_mul_f32 v205, 0x34800000, v205
v_mul_f32 v206, 0x34800000, v206
v_mul_f32 v207, 0x34800000, v207
s_cmp_lt_u32 s38, s37
s_cbranch_scc0 mega_kernel_f2_e
s_lshl_b32 s12, s38, 2
s_add_u32 s12, s12, s16
s_min_u32 s12, s12, 512
s_lshr_b32 s23, s12, 7
s_xnor_b32 s23, s23, s98
s_and_b32 s23, s23, 1
s_lshl_b32 s23, s23, 13
s_mul_i32 s13, s12, 16384
s_add_u32 s13, s13, 171966464
s_add_u32 s13, s13, s23
s_lshr_b32 s23, s12, 6
s_xnor_b32 s23, s23, s98
s_and_b32 s23, s23, 1
s_lshl_b32 s23, s23, 13
s_mul_i32 s12, s12, 32768
s_add_u32 s12, s12, 92274688
s_add_u32 s12, s12, s23
buffer_load_dwordx2 a[0:1], v5, s[84:87], s12 offen offset:0 sc1
buffer_load_dwordx2 a[2:3], v5, s[84:87], s12 offen offset:512 sc1
buffer_load_dwordx2 a[4:5], v5, s[84:87], s12 offen offset:1024 sc1
buffer_load_dwordx2 a[6:7], v5, s[84:87], s12 offen offset:1536 sc1
buffer_load_dwordx2 a[8:9], v5, s[84:87], s12 offen offset:2048 sc1
buffer_load_dwordx2 a[10:11], v5, s[84:87], s12 offen offset:2560 sc1
buffer_load_dwordx2 a[12:13], v5, s[84:87], s12 offen offset:3072 sc1
buffer_load_dwordx2 a[14:15], v5, s[84:87], s12 offen offset:3584 sc1
s_add_u32 s12, s12, 4096
buffer_load_dwordx2 a[16:17], v5, s[84:87], s12 offen offset:0 sc1
buffer_load_dwordx2 a[18:19], v5, s[84:87], s12 offen offset:512 sc1
buffer_load_dwordx2 a[20:21], v5, s[84:87], s12 offen offset:1024 sc1
buffer_load_dwordx2 a[22:23], v5, s[84:87], s12 offen offset:1536 sc1
buffer_load_dwordx2 a[24:25], v5, s[84:87], s12 offen offset:2048 sc1
buffer_load_dwordx2 a[26:27], v5, s[84:87], s12 offen offset:2560 sc1
buffer_load_dwordx2 a[28:29], v5, s[84:87], s12 offen offset:3072 sc1
buffer_load_dwordx2 a[30:31], v5, s[84:87], s12 offen offset:3584 sc1
s_add_u32 s12, s12, 12288
buffer_load_dwordx2 a[32:33], v5, s[84:87], s12 offen offset:0 sc1
buffer_load_dwordx2 a[34:35], v5, s[84:87], s12 offen offset:512 sc1
buffer_load_dwordx2 a[36:37], v5, s[84:87], s12 offen offset:1024 sc1
buffer_load_dwordx2 a[38:39], v5, s[84:87], s12 offen offset:1536 sc1
buffer_load_dwordx2 a[40:41], v5, s[84:87], s12 offen offset:2048 sc1
buffer_load_dwordx2 a[42:43], v5, s[84:87], s12 offen offset:2560 sc1
buffer_load_dwordx2 a[44:45], v5, s[84:87], s12 offen offset:3072 sc1
buffer_load_dwordx2 a[46:47], v5, s[84:87], s12 offen offset:3584 sc1
s_add_u32 s12, s12, 4096
buffer_load_dwordx2 a[48:49], v5, s[84:87], s12 offen offset:0 sc1
buffer_load_dwordx2 a[50:51], v5, s[84:87], s12 offen offset:512 sc1
buffer_load_dwordx2 a[52:53], v5, s[84:87], s12 offen offset:1024 sc1
buffer_load_dwordx2 a[54:55], v5, s[84:87], s12 offen offset:1536 sc1
buffer_load_dwordx2 a[56:57], v5, s[84:87], s12 offen offset:2048 sc1
buffer_load_dwordx2 a[58:59], v5, s[84:87], s12 offen offset:2560 sc1
buffer_load_dwordx2 a[60:61], v5, s[84:87], s12 offen offset:3072 sc1
buffer_load_dwordx2 a[62:63], v5, s[84:87], s12 offen offset:3584 sc1
s_add_u32 s12, s12, 4096
buffer_load_dword a64, v11, s[84:87], s13 offen offset:0 sc1
buffer_load_dword a65, v11, s[84:87], s13 offen offset:128 sc1
buffer_load_dword a66, v11, s[84:87], s13 offen offset:256 sc1
buffer_load_dword a67, v11, s[84:87], s13 offen offset:384 sc1
buffer_load_dword a68, v11, s[84:87], s13 offen offset:512 sc1
buffer_load_dword a69, v11, s[84:87], s13 offen offset:640 sc1
buffer_load_dword a70, v11, s[84:87], s13 offen offset:768 sc1
buffer_load_dword a71, v11, s[84:87], s13 offen offset:896 sc1
buffer_load_dword a72, v11, s[84:87], s13 offen offset:1024 sc1
buffer_load_dword a73, v11, s[84:87], s13 offen offset:1152 sc1
buffer_load_dword a74, v11, s[84:87], s13 offen offset:1280 sc1
buffer_load_dword a75, v11, s[84:87], s13 offen offset:1408 sc1
buffer_load_dword a76, v11, s[84:87], s13 offen offset:1536 sc1
buffer_load_dword a77, v11, s[84:87], s13 offen offset:1664 sc1
buffer_load_dword a78, v11, s[84:87], s13 offen offset:1792 sc1
buffer_load_dword a79, v11, s[84:87], s13 offen offset:1920 sc1
buffer_load_dword a80, v11, s[84:87], s13 offen offset:2048 sc1
buffer_load_dword a81, v11, s[84:87], s13 offen offset:2176 sc1
buffer_load_dword a82, v11, s[84:87], s13 offen offset:2304 sc1
buffer_load_dword a83, v11, s[84:87], s13 offen offset:2432 sc1
buffer_load_dword a84, v11, s[84:87], s13 offen offset:2560 sc1
buffer_load_dword a85, v11, s[84:87], s13 offen offset:2688 sc1
buffer_load_dword a86, v11, s[84:87], s13 offen offset:2816 sc1
buffer_load_dword a87, v11, s[84:87], s13 offen offset:2944 sc1
buffer_load_dword a88, v11, s[84:87], s13 offen offset:3072 sc1
buffer_load_dword a89, v11, s[84:87], s13 offen offset:3200 sc1
buffer_load_dword a90, v11, s[84:87], s13 offen offset:3328 sc1
buffer_load_dword a91, v11, s[84:87], s13 offen offset:3456 sc1
buffer_load_dword a92, v11, s[84:87], s13 offen offset:3584 sc1
buffer_load_dword a93, v11, s[84:87], s13 offen offset:3712 sc1
buffer_load_dword a94, v11, s[84:87], s13 offen offset:3840 sc1
buffer_load_dword a95, v11, s[84:87], s13 offen offset:3968 sc1
s_waitcnt vmcnt(0)
mega_kernel_f2_l:
s_add_u32 s21, s38, s39
s_cmp_lt_u32 s21, s37
s_cselect_b32 s22, s21, s38
s_waitcnt vmcnt(32)
v_accvgpr_read_b32 v16, a0
v_accvgpr_read_b32 v17, a1
v_accvgpr_read_b32 v18, a2
v_accvgpr_read_b32 v19, a3
v_accvgpr_read_b32 v20, a4
v_accvgpr_read_b32 v21, a5
v_accvgpr_read_b32 v22, a6
v_accvgpr_read_b32 v23, a7
v_accvgpr_read_b32 v24, a8
v_accvgpr_read_b32 v25, a9
v_accvgpr_read_b32 v26, a10
v_accvgpr_read_b32 v27, a11
v_accvgpr_read_b32 v28, a12
v_accvgpr_read_b32 v29, a13
v_accvgpr_read_b32 v30, a14
v_accvgpr_read_b32 v31, a15
v_accvgpr_read_b32 v32, a16
v_accvgpr_read_b32 v33, a17
v_accvgpr_read_b32 v34, a18
v_accvgpr_read_b32 v35, a19
v_accvgpr_read_b32 v36, a20
v_accvgpr_read_b32 v37, a21
v_accvgpr_read_b32 v38, a22
v_accvgpr_read_b32 v39, a23
v_accvgpr_read_b32 v40, a24
v_accvgpr_read_b32 v41, a25
v_accvgpr_read_b32 v42, a26
v_accvgpr_read_b32 v43, a27
v_accvgpr_read_b32 v44, a28
v_accvgpr_read_b32 v45, a29
v_accvgpr_read_b32 v46, a30
v_accvgpr_read_b32 v47, a31
v_accvgpr_read_b32 v48, a32
v_accvgpr_read_b32 v49, a33
v_accvgpr_read_b32 v50, a34
v_accvgpr_read_b32 v51, a35
v_accvgpr_read_b32 v52, a36
v_accvgpr_read_b32 v53, a37
v_accvgpr_read_b32 v54, a38
v_accvgpr_read_b32 v55, a39
v_accvgpr_read_b32 v56, a40
v_accvgpr_read_b32 v57, a41
v_accvgpr_read_b32 v58, a42
v_accvgpr_read_b32 v59, a43
v_accvgpr_read_b32 v60, a44
v_accvgpr_read_b32 v61, a45
v_accvgpr_read_b32 v62, a46
v_accvgpr_read_b32 v63, a47
v_accvgpr_read_b32 v64, a48
v_accvgpr_read_b32 v65, a49
v_accvgpr_read_b32 v66, a50
v_accvgpr_read_b32 v67, a51
v_accvgpr_read_b32 v68, a52
v_accvgpr_read_b32 v69, a53
v_accvgpr_read_b32 v70, a54
v_accvgpr_read_b32 v71, a55
v_accvgpr_read_b32 v72, a56
v_accvgpr_read_b32 v73, a57
v_accvgpr_read_b32 v74, a58
v_accvgpr_read_b32 v75, a59
v_accvgpr_read_b32 v76, a60
v_accvgpr_read_b32 v77, a61
v_accvgpr_read_b32 v78, a62
v_accvgpr_read_b32 v79, a63
v_accvgpr_read_b32 v208, a64
v_accvgpr_read_b32 v209, a65
v_accvgpr_read_b32 v210, a66
v_accvgpr_read_b32 v211, a67
v_accvgpr_read_b32 v212, a68
v_accvgpr_read_b32 v213, a69
v_accvgpr_read_b32 v214, a70
v_accvgpr_read_b32 v215, a71
v_accvgpr_read_b32 v216, a72
v_accvgpr_read_b32 v217, a73
v_accvgpr_read_b32 v218, a74
v_accvgpr_read_b32 v219, a75
v_accvgpr_read_b32 v220, a76
v_accvgpr_read_b32 v221, a77
v_accvgpr_read_b32 v222, a78
v_accvgpr_read_b32 v223, a79
v_accvgpr_read_b32 v224, a80
v_accvgpr_read_b32 v225, a81
v_accvgpr_read_b32 v226, a82
v_accvgpr_read_b32 v227, a83
v_accvgpr_read_b32 v228, a84
v_accvgpr_read_b32 v229, a85
v_accvgpr_read_b32 v230, a86
v_accvgpr_read_b32 v231, a87
v_accvgpr_read_b32 v232, a88
v_accvgpr_read_b32 v233, a89
v_accvgpr_read_b32 v234, a90
v_accvgpr_read_b32 v235, a91
v_accvgpr_read_b32 v236, a92
v_accvgpr_read_b32 v237, a93
v_accvgpr_read_b32 v238, a94
v_accvgpr_read_b32 v239, a95
s_lshl_b32 s12, s22, 2
s_add_u32 s12, s12, s16
s_min_u32 s12, s12, 512
s_lshr_b32 s23, s12, 7
s_xnor_b32 s23, s23, s98
s_and_b32 s23, s23, 1
s_lshl_b32 s23, s23, 13
s_mul_i32 s13, s12, 16384
s_add_u32 s13, s13, 171966464
s_add_u32 s13, s13, s23
s_lshr_b32 s23, s12, 6
s_xnor_b32 s23, s23, s98
s_and_b32 s23, s23, 1
s_lshl_b32 s23, s23, 13
s_mul_i32 s12, s12, 32768
s_add_u32 s12, s12, 92274688
s_add_u32 s12, s12, s23
buffer_load_dwordx2 a[0:1], v5, s[84:87], s12 offen offset:0 sc1
buffer_load_dwordx2 a[2:3], v5, s[84:87], s12 offen offset:512 sc1
buffer_load_dwordx2 a[4:5], v5, s[84:87], s12 offen offset:1024 sc1
buffer_load_dwordx2 a[6:7], v5, s[84:87], s12 offen offset:1536 sc1
buffer_load_dwordx2 a[8:9], v5, s[84:87], s12 offen offset:2048 sc1
buffer_load_dwordx2 a[10:11], v5, s[84:87], s12 offen offset:2560 sc1
buffer_load_dwordx2 a[12:13], v5, s[84:87], s12 offen offset:3072 sc1
buffer_load_dwordx2 a[14:15], v5, s[84:87], s12 offen offset:3584 sc1
s_add_u32 s12, s12, 4096
buffer_load_dwordx2 a[16:17], v5, s[84:87], s12 offen offset:0 sc1
buffer_load_dwordx2 a[18:19], v5, s[84:87], s12 offen offset:512 sc1
buffer_load_dwordx2 a[20:21], v5, s[84:87], s12 offen offset:1024 sc1
buffer_load_dwordx2 a[22:23], v5, s[84:87], s12 offen offset:1536 sc1
buffer_load_dwordx2 a[24:25], v5, s[84:87], s12 offen offset:2048 sc1
buffer_load_dwordx2 a[26:27], v5, s[84:87], s12 offen offset:2560 sc1
buffer_load_dwordx2 a[28:29], v5, s[84:87], s12 offen offset:3072 sc1
buffer_load_dwordx2 a[30:31], v5, s[84:87], s12 offen offset:3584 sc1
s_add_u32 s12, s12, 12288
buffer_load_dwordx2 a[32:33], v5, s[84:87], s12 offen offset:0 sc1
buffer_load_dwordx2 a[34:35], v5, s[84:87], s12 offen offset:512 sc1
buffer_load_dwordx2 a[36:37], v5, s[84:87], s12 offen offset:1024 sc1
buffer_load_dwordx2 a[38:39], v5, s[84:87], s12 offen offset:1536 sc1
buffer_load_dwordx2 a[40:41], v5, s[84:87], s12 offen offset:2048 sc1
buffer_load_dwordx2 a[42:43], v5, s[84:87], s12 offen offset:2560 sc1
buffer_load_dwordx2 a[44:45], v5, s[84:87], s12 offen offset:3072 sc1
buffer_load_dwordx2 a[46:47], v5, s[84:87], s12 offen offset:3584 sc1
s_add_u32 s12, s12, 4096
buffer_load_dwordx2 a[48:49], v5, s[84:87], s12 offen offset:0 sc1
buffer_load_dwordx2 a[50:51], v5, s[84:87], s12 offen offset:512 sc1
buffer_load_dwordx2 a[52:53], v5, s[84:87], s12 offen offset:1024 sc1
buffer_load_dwordx2 a[54:55], v5, s[84:87], s12 offen offset:1536 sc1
buffer_load_dwordx2 a[56:57], v5, s[84:87], s12 offen offset:2048 sc1
buffer_load_dwordx2 a[58:59], v5, s[84:87], s12 offen offset:2560 sc1
buffer_load_dwordx2 a[60:61], v5, s[84:87], s12 offen offset:3072 sc1
buffer_load_dwordx2 a[62:63], v5, s[84:87], s12 offen offset:3584 sc1
s_add_u32 s12, s12, 4096
buffer_load_dword a64, v11, s[84:87], s13 offen offset:0 sc1
buffer_load_dword a65, v11, s[84:87], s13 offen offset:128 sc1
buffer_load_dword a66, v11, s[84:87], s13 offen offset:256 sc1
buffer_load_dword a67, v11, s[84:87], s13 offen offset:384 sc1
buffer_load_dword a68, v11, s[84:87], s13 offen offset:512 sc1
buffer_load_dword a69, v11, s[84:87], s13 offen offset:640 sc1
buffer_load_dword a70, v11, s[84:87], s13 offen offset:768 sc1
buffer_load_dword a71, v11, s[84:87], s13 offen offset:896 sc1
buffer_load_dword a72, v11, s[84:87], s13 offen offset:1024 sc1
buffer_load_dword a73, v11, s[84:87], s13 offen offset:1152 sc1
buffer_load_dword a74, v11, s[84:87], s13 offen offset:1280 sc1
buffer_load_dword a75, v11, s[84:87], s13 offen offset:1408 sc1
buffer_load_dword a76, v11, s[84:87], s13 offen offset:1536 sc1
buffer_load_dword a77, v11, s[84:87], s13 offen offset:1664 sc1
buffer_load_dword a78, v11, s[84:87], s13 offen offset:1792 sc1
buffer_load_dword a79, v11, s[84:87], s13 offen offset:1920 sc1
buffer_load_dword a80, v11, s[84:87], s13 offen offset:2048 sc1
buffer_load_dword a81, v11, s[84:87], s13 offen offset:2176 sc1
buffer_load_dword a82, v11, s[84:87], s13 offen offset:2304 sc1
buffer_load_dword a83, v11, s[84:87], s13 offen offset:2432 sc1
buffer_load_dword a84, v11, s[84:87], s13 offen offset:2560 sc1
buffer_load_dword a85, v11, s[84:87], s13 offen offset:2688 sc1
buffer_load_dword a86, v11, s[84:87], s13 offen offset:2816 sc1
buffer_load_dword a87, v11, s[84:87], s13 offen offset:2944 sc1
buffer_load_dword a88, v11, s[84:87], s13 offen offset:3072 sc1
buffer_load_dword a89, v11, s[84:87], s13 offen offset:3200 sc1
buffer_load_dword a90, v11, s[84:87], s13 offen offset:3328 sc1
buffer_load_dword a91, v11, s[84:87], s13 offen offset:3456 sc1
buffer_load_dword a92, v11, s[84:87], s13 offen offset:3584 sc1
buffer_load_dword a93, v11, s[84:87], s13 offen offset:3712 sc1
buffer_load_dword a94, v11, s[84:87], s13 offen offset:3840 sc1
buffer_load_dword a95, v11, s[84:87], s13 offen offset:3968 sc1
v_pk_add_f32 v[14:15], v[16:17], v[48:49] neg_lo:[0,1] neg_hi:[0,1]
v_pk_add_f32 v[16:17], v[16:17], v[48:49]
v_pk_add_f32 v[48:49], v[18:19], v[50:51] neg_lo:[0,1] neg_hi:[0,1]
v_pk_add_f32 v[18:19], v[18:19], v[50:51]
v_pk_mul_f32 v[50:51], v[48:49], s[50:51] op_sel:[0,0] op_sel_hi:[0,1] neg_lo:[0,0] neg_hi:[0,1]
v_pk_fma_f32 v[50:51], v[48:49], s[50:51], v[50:51] op_sel:[1,1,0] op_sel_hi:[1,0,1] neg_lo:[0,0,0] neg_hi:[0,0,0]
v_pk_add_f32 v[48:49], v[20:21], v[52:53] neg_lo:[0,1] neg_hi:[0,1]
v_pk_add_f32 v[20:21], v[20:21], v[52:53]
v_pk_mul_f32 v[52:53], v[48:49], s[54:55] op_sel:[0,0] op_sel_hi:[0,1] neg_lo:[0,0] neg_hi:[0,1]
v_pk_fma_f32 v[52:53], v[48:49], s[54:55], v[52:53] op_sel:[1,1,0] op_sel_hi:[1,0,1] neg_lo:[0,0,0] neg_hi:[0,0,0]
v_pk_add_f32 v[48:49], v[22:23], v[54:55] neg_lo:[0,1] neg_hi:[0,1]
v_pk_add_f32 v[22:23], v[22:23], v[54:55]
v_pk_mul_f32 v[54:55], v[48:49], s[58:59] op_sel:[0,0] op_sel_hi:[0,1] neg_lo:[0,0] neg_hi:[0,1]
v_pk_fma_f32 v[54:55], v[48:49], s[58:59], v[54:55] op_sel:[1,1,0] op_sel_hi:[1,0,1] neg_lo:[0,0,0] neg_hi:[0,0,0]
v_pk_add_f32 v[48:49], v[24:25], v[56:57] neg_lo:[0,1] neg_hi:[0,1]
v_pk_add_f32 v[24:25], v[24:25], v[56:57]
v_pk_mul_f32 v[56:57], v[48:49], s[62:63] op_sel:[0,0] op_sel_hi:[0,1] neg_lo:[0,0] neg_hi:[0,1]
v_pk_fma_f32 v[56:57], v[48:49], s[62:63], v[56:57] op_sel:[1,1,0] op_sel_hi:[1,0,1] neg_lo:[0,0,0] neg_hi:[0,0,0]
v_pk_add_f32 v[48:49], v[26:27], v[58:59] neg_lo:[0,1] neg_hi:[0,1]
v_pk_add_f32 v[26:27], v[26:27], v[58:59]
v_pk_mul_f32 v[58:59], v[48:49], s[58:59] op_sel:[0,1] op_sel_hi:[0,0] neg_lo:[0,0] neg_hi:[0,1]
v_pk_fma_f32 v[58:59], v[48:49], s[58:59], v[58:59] op_sel:[1,0,0] op_sel_hi:[1,1,1] neg_lo:[0,0,0] neg_hi:[0,0,0]
v_pk_add_f32 v[48:49], v[28:29], v[60:61] neg_lo:[0,1] neg_hi:[0,1]
v_pk_add_f32 v[28:29], v[28:29], v[60:61]
v_pk_mul_f32 v[60:61], v[48:49], s[54:55] op_sel:[0,1] op_sel_hi:[0,0] neg_lo:[0,0] neg_hi:[0,1]
v_pk_fma_f32 v[60:61], v[48:49], s[54:55], v[60:61] op_sel:[1,0,0] op_sel_hi:[1,1,1] neg_lo:[0,0,0] neg_hi:[0,0,0]
v_pk_add_f32 v[48:49], v[30:31], v[62:63] neg_lo:[0,1] neg_hi:[0,1]
v_pk_add_f32 v[30:31], v[30:31], v[62:63]
v_pk_mul_f32 v[62:63], v[48:49], s[50:51] op_sel:[0,1] op_sel_hi:[0,0] neg_lo:[0,0] neg_hi:[0,1]
v_pk_fma_f32 v[62:63], v[48:49], s[50:51], v[62:63] op_sel:[1,0,0] op_sel_hi:[1,1,1] neg_lo:[0,0,0] neg_hi:[0,0,0]
v_pk_add_f32 v[48:49], v[32:33], v[64:65] op_sel:[1,1] op_sel_hi:[0,0] neg_lo:[0,1] neg_hi:[1,0]
v_pk_add_f32 v[32:33], v[32:33], v[64:65]
v_pk_add_f32 v[64:65], v[34:35], v[66:67] neg_lo:[0,1] neg_hi:[0,1]
v_pk_add_f32 v[34:35], v[34:35], v[66:67]
v_pk_mul_f32 v[66:67], v[64:65], s[50:51] op_sel:[0,1] op_sel_hi:[0,0] neg_lo:[0,1] neg_hi:[0,1]
v_pk_fma_f32 v[66:67], v[64:65], s[50:51], v[66:67] op_sel:[1,0,0] op_sel_hi:[1,1,1] neg_lo:[0,0,0] neg_hi:[0,1,0]
v_pk_add_f32 v[64:65], v[36:37], v[68:69] neg_lo:[0,1] neg_hi:[0,1]
v_pk_add_f32 v[36:37], v[36:37], v[68:69]
v_pk_mul_f32 v[68:69], v[64:65], s[54:55] op_sel:[0,1] op_sel_hi:[0,0] neg_lo:[0,1] neg_hi:[0,1]
v_pk_fma_f32 v[68:69], v[64:65], s[54:55], v[68:69] op_sel:[1,0,0] op_sel_hi:[1,1,1] neg_lo:[0,0,0] neg_hi:[0,1,0]
v_pk_add_f32 v[64:65], v[38:39], v[70:71] neg_lo:[0,1] neg_hi:[0,1]
v_pk_add_f32 v[38:39], v[38:39], v[70:71]
v_pk_mul_f32 v[70:71], v[64:65], s[58:59] op_sel:[0,1] op_sel_hi:[0,0] neg_lo:[0,1] neg_hi:[0,1]
v_pk_fma_f32 v[70:71], v[64:65], s[58:59], v[70:71] op_sel:[1,0,0] op_sel_hi:[1,1,1] neg_lo:[0,0,0] neg_hi:[0,1,0]
v_pk_add_f32 v[64:65], v[40:41], v[72:73] neg_lo:[0,1] neg_hi:[0,1]
v_pk_add_f32 v[40:41], v[40:41], v[72:73]
v_pk_mul_f32 v[72:73], v[64:65], s[62:63] op_sel:[0,0] op_sel_hi:[0,1] neg_lo:[0,1] neg_hi:[0,1]
v_pk_fma_f32 v[72:73], v[64:65], s[62:63], v[72:73] op_sel:[1,1,0] op_sel_hi:[1,0,1] neg_lo:[0,0,0] neg_hi:[0,1,0]
v_pk_add_f32 v[64:65], v[42:43], v[74:75] neg_lo:[0,1] neg_hi:[0,1]
v_pk_add_f32 v[42:43], v[42:43], v[74:75]
v_pk_mul_f32 v[74:75], v[64:65], s[58:59] op_sel:[0,0] op_sel_hi:[0,1] neg_lo:[0,1] neg_hi:[0,1]
v_pk_fma_f32 v[74:75], v[64:65], s[58:59], v[74:75] op_sel:[1,1,0] op_sel_hi:[1,0,1] neg_lo:[0,0,0] neg_hi:[0,1,0]
v_pk_add_f32 v[64:65], v[44:45], v[76:77] neg_lo:[0,1] neg_hi:[0,1]
v_pk_add_f32 v[44:45], v[44:45], v[76:77]
v_pk_mul_f32 v[76:77], v[64:65], s[54:55] op_sel:[0,0] op_sel_hi:[0,1] neg_lo:[0,1] neg_hi:[0,1]
v_pk_fma_f32 v[76:77], v[64:65], s[54:55], v[76:77] op_sel:[1,1,0] op_sel_hi:[1,0,1] neg_lo:[0,0,0] neg_hi:[0,1,0]
v_pk_add_f32 v[64:65], v[46:47], v[78:79] neg_lo:[0,1] neg_hi:[0,1]
v_pk_add_f32 v[46:47], v[46:47], v[78:79]
v_pk_mul_f32 v[78:79], v[64:65], s[50:51] op_sel:[0,0] op_sel_hi:[0,1] neg_lo:[0,1] neg_hi:[0,1]
v_pk_fma_f32 v[78:79], v[64:65], s[50:51], v[78:79] op_sel:[1,1,0] op_sel_hi:[1,0,1] neg_lo:[0,0,0] neg_hi:[0,1,0]
v_pk_add_f32 v[64:65], v[16:17], v[32:33] neg_lo:[0,1] neg_hi:[0,1]
v_pk_add_f32 v[16:17], v[16:17], v[32:33]
v_pk_add_f32 v[32:33], v[18:19], v[34:35] neg_lo:[0,1] neg_hi:[0,1]
v_pk_add_f32 v[18:19], v[18:19], v[34:35]
v_pk_mul_f32 v[34:35], v[32:33], s[54:55] op_sel:[0,0] op_sel_hi:[0,1] neg_lo:[0,0] neg_hi:[0,1]
v_pk_fma_f32 v[34:35], v[32:33], s[54:55], v[34:35] op_sel:[1,1,0] op_sel_hi:[1,0,1] neg_lo:[0,0,0] neg_hi:[0,0,0]
v_pk_add_f32 v[32:33], v[20:21], v[36:37] neg_lo:[0,1] neg_hi:[0,1]
v_pk_add_f32 v[20:21], v[20:21], v[36:37]
v_pk_mul_f32 v[36:37], v[32:33], s[62:63] op_sel:[0,0] op_sel_hi:[0,1] neg_lo:[0,0] neg_hi:[0,1]
v_pk_fma_f32 v[36:37], v[32:33], s[62:63], v[36:37] op_sel:[1,1,0] op_sel_hi:[1,0,1] neg_lo:[0,0,0] neg_hi:[0,0,0]
v_pk_add_f32 v[32:33], v[22:23], v[38:39] neg_lo:[0,1] neg_hi:[0,1]
v_pk_add_f32 v[22:23], v[22:23], v[38:39]
v_pk_mul_f32 v[38:39], v[32:33], s[54:55] op_sel:[0,1] op_sel_hi:[0,0] neg_lo:[0,0] neg_hi:[0,1]
v_pk_fma_f32 v[38:39], v[32:33], s[54:55], v[38:39] op_sel:[1,0,0] op_sel_hi:[1,1,1] neg_lo:[0,0,0] neg_hi:[0,0,0]
v_pk_add_f32 v[32:33], v[24:25], v[40:41] op_sel:[1,1] op_sel_hi:[0,0] neg_lo:[0,1] neg_hi:[1,0]
v_pk_add_f32 v[24:25], v[24:25], v[40:41]
v_pk_add_f32 v[40:41], v[26:27], v[42:43] neg_lo:[0,1] neg_hi:[0,1]
v_pk_add_f32 v[26:27], v[26:27], v[42:43]
v_pk_mul_f32 v[42:43], v[40:41], s[54:55] op_sel:[0,1] op_sel_hi:[0,0] neg_lo:[0,1] neg_hi:[0,1]
v_pk_fma_f32 v[42:43], v[40:41], s[54:55], v[42:43] op_sel:[1,0,0] op_sel_hi:[1,1,1] neg_lo:[0,0,0] neg_hi:[0,1,0]
v_pk_add_f32 v[40:41], v[28:29], v[44:45] neg_lo:[0,1] neg_hi:[0,1]
v_pk_add_f32 v[28:29], v[28:29], v[44:45]
v_pk_mul_f32 v[44:45], v[40:41], s[62:63] op_sel:[0,0] op_sel_hi:[0,1] neg_lo:[0,1] neg_hi:[0,1]
v_pk_fma_f32 v[44:45], v[40:41], s[62:63], v[44:45] op_sel:[1,1,0] op_sel_hi:[1,0,1] neg_lo:[0,0,0] neg_hi:[0,1,0]
v_pk_add_f32 v[40:41], v[30:31], v[46:47] neg_lo:[0,1] neg_hi:[0,1]
v_pk_add_f32 v[30:31], v[30:31], v[46:47]
v_pk_mul_f32 v[46:47], v[40:41], s[54:55] op_sel:[0,0] op_sel_hi:[0,1] neg_lo:[0,1] neg_hi:[0,1]
v_pk_fma_f32 v[46:47], v[40:41], s[54:55], v[46:47] op_sel:[1,1,0] op_sel_hi:[1,0,1] neg_lo:[0,0,0] neg_hi:[0,1,0]
v_pk_add_f32 v[40:41], v[14:15], v[48:49] neg_lo:[0,1] neg_hi:[0,1]
v_pk_add_f32 v[14:15], v[14:15], v[48:49]
v_pk_add_f32 v[48:49], v[50:51], v[66:67] neg_lo:[0,1] neg_hi:[0,1]
v_pk_add_f32 v[50:51], v[50:51], v[66:67]
v_pk_mul_f32 v[66:67], v[48:49], s[54:55] op_sel:[0,0] op_sel_hi:[0,1] neg_lo:[0,0] neg_hi:[0,1]
v_pk_fma_f32 v[66:67], v[48:49], s[54:55], v[66:67] op_sel:[1,1,0] op_sel_hi:[1,0,1] neg_lo:[0,0,0] neg_hi:[0,0,0]
v_pk_add_f32 v[48:49], v[52:53], v[68:69] neg_lo:[0,1] neg_hi:[0,1]
v_pk_add_f32 v[52:53], v[52:53], v[68:69]
v_pk_mul_f32 v[68:69], v[48:49], s[62:63] op_sel:[0,0] op_sel_hi:[0,1] neg_lo:[0,0] neg_hi:[0,1]
v_pk_fma_f32 v[68:69], v[48:49], s[62:63], v[68:69] op_sel:[1,1,0] op_sel_hi:[1,0,1] neg_lo:[0,0,0] neg_hi:[0,0,0]
v_pk_add_f32 v[48:49], v[54:55], v[70:71] neg_lo:[0,1] neg_hi:[0,1]
v_pk_add_f32 v[54:55], v[54:55], v[70:71]
v_pk_mul_f32 v[70:71], v[48:49], s[54:55] op_sel:[0,1] op_sel_hi:[0,0] neg_lo:[0,0] neg_hi:[0,1]
v_pk_fma_f32 v[70:71], v[48:49], s[54:55], v[70:71] op_sel:[1,0,0] op_sel_hi:[1,1,1] neg_lo:[0,0,0] neg_hi:[0,0,0]
v_pk_add_f32 v[48:49], v[56:57], v[72:73] op_sel:[1,1] op_sel_hi:[0,0] neg_lo:[0,1] neg_hi:[1,0]
v_pk_add_f32 v[56:57], v[56:57], v[72:73]
v_pk_add_f32 v[72:73], v[58:59], v[74:75] neg_lo:[0,1] neg_hi:[0,1]
v_pk_add_f32 v[58:59], v[58:59], v[74:75]
v_pk_mul_f32 v[74:75], v[72:73], s[54:55] op_sel:[0,1] op_sel_hi:[0,0] neg_lo:[0,1] neg_hi:[0,1]
v_pk_fma_f32 v[74:75], v[72:73], s[54:55], v[74:75] op_sel:[1,0,0] op_sel_hi:[1,1,1] neg_lo:[0,0,0] neg_hi:[0,1,0]
v_pk_add_f32 v[72:73], v[60:61], v[76:77] neg_lo:[0,1] neg_hi:[0,1]
v_pk_add_f32 v[60:61], v[60:61], v[76:77]
v_pk_mul_f32 v[76:77], v[72:73], s[62:63] op_sel:[0,0] op_sel_hi:[0,1] neg_lo:[0,1] neg_hi:[0,1]
v_pk_fma_f32 v[76:77], v[72:73], s[62:63], v[76:77] op_sel:[1,1,0] op_sel_hi:[1,0,1] neg_lo:[0,0,0] neg_hi:[0,1,0]
v_pk_add_f32 v[72:73], v[62:63], v[78:79] neg_lo:[0,1] neg_hi:[0,1]
v_pk_add_f32 v[62:63], v[62:63], v[78:79]
v_pk_mul_f32 v[78:79], v[72:73], s[54:55] op_sel:[0,0] op_sel_hi:[0,1] neg_lo:[0,1] neg_hi:[0,1]
v_pk_fma_f32 v[78:79], v[72:73], s[54:55], v[78:79] op_sel:[1,1,0] op_sel_hi:[1,0,1] neg_lo:[0,0,0] neg_hi:[0,1,0]
v_pk_add_f32 v[72:73], v[16:17], v[24:25] neg_lo:[0,1] neg_hi:[0,1]
v_pk_add_f32 v[16:17], v[16:17], v[24:25]
v_pk_add_f32 v[24:25], v[18:19], v[26:27] neg_lo:[0,1] neg_hi:[0,1]
v_pk_add_f32 v[18:19], v[18:19], v[26:27]
v_pk_mul_f32 v[26:27], v[24:25], s[62:63] op_sel:[0,0] op_sel_hi:[0,1] neg_lo:[0,0] neg_hi:[0,1]
v_pk_fma_f32 v[26:27], v[24:25], s[62:63], v[26:27] op_sel:[1,1,0] op_sel_hi:[1,0,1] neg_lo:[0,0,0] neg_hi:[0,0,0]
v_pk_add_f32 v[24:25], v[20:21], v[28:29] op_sel:[1,1] op_sel_hi:[0,0] neg_lo:[0,1] neg_hi:[1,0]
v_pk_add_f32 v[20:21], v[20:21], v[28:29]
v_pk_add_f32 v[28:29], v[22:23], v[30:31] neg_lo:[0,1] neg_hi:[0,1]
v_pk_add_f32 v[22:23], v[22:23], v[30:31]
v_pk_mul_f32 v[30:31], v[28:29], s[62:63] op_sel:[0,0] op_sel_hi:[0,1] neg_lo:[0,1] neg_hi:[0,1]
v_pk_fma_f32 v[30:31], v[28:29], s[62:63], v[30:31] op_sel:[1,1,0] op_sel_hi:[1,0,1] neg_lo:[0,0,0] neg_hi:[0,1,0]
v_pk_add_f32 v[28:29], v[64:65], v[32:33] neg_lo:[0,1] neg_hi:[0,1]
v_pk_add_f32 v[64:65], v[64:65], v[32:33]
v_pk_add_f32 v[32:33], v[34:35], v[42:43] neg_lo:[0,1] neg_hi:[0,1]
v_pk_add_f32 v[34:35], v[34:35], v[42:43]
v_pk_mul_f32 v[42:43], v[32:33], s[62:63] op_sel:[0,0] op_sel_hi:[0,1] neg_lo:[0,0] neg_hi:[0,1]
v_pk_fma_f32 v[42:43], v[32:33], s[62:63], v[42:43] op_sel:[1,1,0] op_sel_hi:[1,0,1] neg_lo:[0,0,0] neg_hi:[0,0,0]
v_pk_add_f32 v[32:33], v[36:37], v[44:45] op_sel:[1,1] op_sel_hi:[0,0] neg_lo:[0,1] neg_hi:[1,0]
v_pk_add_f32 v[36:37], v[36:37], v[44:45]
v_pk_add_f32 v[44:45], v[38:39], v[46:47] neg_lo:[0,1] neg_hi:[0,1]
v_pk_add_f32 v[38:39], v[38:39], v[46:47]
v_pk_mul_f32 v[46:47], v[44:45], s[62:63] op_sel:[0,0] op_sel_hi:[0,1] neg_lo:[0,1] neg_hi:[0,1]
v_pk_fma_f32 v[46:47], v[44:45], s[62:63], v[46:47] op_sel:[1,1,0] op_sel_hi:[1,0,1] neg_lo:[0,0,0] neg_hi:[0,1,0]
v_pk_add_f32 v[44:45], v[14:15], v[56:57] neg_lo:[0,1] neg_hi:[0,1]
v_pk_add_f32 v[14:15], v[14:15], v[56:57]
v_pk_add_f32 v[56:57], v[50:51], v[58:59] neg_lo:[0,1] neg_hi:[0,1]
v_pk_add_f32 v[50:51], v[50:51], v[58:59]
v_pk_mul_f32 v[58:59], v[56:57], s[62:63] op_sel:[0,0] op_sel_hi:[0,1] neg_lo:[0,0] neg_hi:[0,1]
v_pk_fma_f32 v[58:59], v[56:57], s[62:63], v[58:59] op_sel:[1,1,0] op_sel_hi:[1,0,1] neg_lo:[0,0,0] neg_hi:[0,0,0]
v_pk_add_f32 v[56:57], v[52:53], v[60:61] op_sel:[1,1] op_sel_hi:[0,0] neg_lo:[0,1] neg_hi:[1,0]
v_pk_add_f32 v[52:53], v[52:53], v[60:61]
v_pk_add_f32 v[60:61], v[54:55], v[62:63] neg_lo:[0,1] neg_hi:[0,1]
v_pk_add_f32 v[54:55], v[54:55], v[62:63]
v_pk_mul_f32 v[62:63], v[60:61], s[62:63] op_sel:[0,0] op_sel_hi:[0,1] neg_lo:[0,1] neg_hi:[0,1]
v_pk_fma_f32 v[62:63], v[60:61], s[62:63], v[62:63] op_sel:[1,1,0] op_sel_hi:[1,0,1] neg_lo:[0,0,0] neg_hi:[0,1,0]
v_pk_add_f32 v[60:61], v[40:41], v[48:49] neg_lo:[0,1] neg_hi:[0,1]
v_pk_add_f32 v[40:41], v[40:41], v[48:49]
v_pk_add_f32 v[48:49], v[66:67], v[74:75] neg_lo:[0,1] neg_hi:[0,1]
v_pk_add_f32 v[66:67], v[66:67], v[74:75]
v_pk_mul_f32 v[74:75], v[48:49], s[62:63] op_sel:[0,0] op_sel_hi:[0,1] neg_lo:[0,0] neg_hi:[0,1]
v_pk_fma_f32 v[74:75], v[48:49], s[62:63], v[74:75] op_sel:[1,1,0] op_sel_hi:[1,0,1] neg_lo:[0,0,0] neg_hi:[0,0,0]
v_pk_add_f32 v[48:49], v[68:69], v[76:77] op_sel:[1,1] op_sel_hi:[0,0] neg_lo:[0,1] neg_hi:[1,0]
v_pk_add_f32 v[68:69], v[68:69], v[76:77]
v_pk_add_f32 v[76:77], v[70:71], v[78:79] neg_lo:[0,1] neg_hi:[0,1]
v_pk_add_f32 v[70:71], v[70:71], v[78:79]
v_pk_mul_f32 v[78:79], v[76:77], s[62:63] op_sel:[0,0] op_sel_hi:[0,1] neg_lo:[0,1] neg_hi:[0,1]
v_pk_fma_f32 v[78:79], v[76:77], s[62:63], v[78:79] op_sel:[1,1,0] op_sel_hi:[1,0,1] neg_lo:[0,0,0] neg_hi:[0,1,0]
v_pk_add_f32 v[76:77], v[16:17], v[20:21] neg_lo:[0,1] neg_hi:[0,1]
v_pk_add_f32 v[16:17], v[16:17], v[20:21]
v_pk_add_f32 v[20:21], v[18:19], v[22:23] op_sel:[1,1] op_sel_hi:[0,0] neg_lo:[0,1] neg_hi:[1,0]
v_pk_add_f32 v[18:19], v[18:19], v[22:23]
v_pk_add_f32 v[22:23], v[72:73], v[24:25] neg_lo:[0,1] neg_hi:[0,1]
v_pk_add_f32 v[72:73], v[72:73], v[24:25]
v_pk_add_f32 v[24:25], v[26:27], v[30:31] op_sel:[1,1] op_sel_hi:[0,0] neg_lo:[0,1] neg_hi:[1,0]
v_pk_add_f32 v[26:27], v[26:27], v[30:31]
v_pk_add_f32 v[30:31], v[64:65], v[36:37] neg_lo:[0,1] neg_hi:[0,1]
v_pk_add_f32 v[64:65], v[64:65], v[36:37]
v_pk_add_f32 v[36:37], v[34:35], v[38:39] op_sel:[1,1] op_sel_hi:[0,0] neg_lo:[0,1] neg_hi:[1,0]
v_pk_add_f32 v[34:35], v[34:35], v[38:39]
v_pk_add_f32 v[38:39], v[28:29], v[32:33] neg_lo:[0,1] neg_hi:[0,1]
v_pk_add_f32 v[28:29], v[28:29], v[32:33]
v_pk_add_f32 v[32:33], v[42:43], v[46:47] op_sel:[1,1] op_sel_hi:[0,0] neg_lo:[0,1] neg_hi:[1,0]
v_pk_add_f32 v[42:43], v[42:43], v[46:47]
v_pk_add_f32 v[46:47], v[14:15], v[52:53] neg_lo:[0,1] neg_hi:[0,1]
v_pk_add_f32 v[14:15], v[14:15], v[52:53]
v_pk_add_f32 v[52:53], v[50:51], v[54:55] op_sel:[1,1] op_sel_hi:[0,0] neg_lo:[0,1] neg_hi:[1,0]
v_pk_add_f32 v[50:51], v[50:51], v[54:55]
v_pk_add_f32 v[54:55], v[44:45], v[56:57] neg_lo:[0,1] neg_hi:[0,1]
v_pk_add_f32 v[44:45], v[44:45], v[56:57]
v_pk_add_f32 v[56:57], v[58:59], v[62:63] op_sel:[1,1] op_sel_hi:[0,0] neg_lo:[0,1] neg_hi:[1,0]
v_pk_add_f32 v[58:59], v[58:59], v[62:63]
v_pk_add_f32 v[62:63], v[40:41], v[68:69] neg_lo:[0,1] neg_hi:[0,1]
v_pk_add_f32 v[40:41], v[40:41], v[68:69]
v_pk_add_f32 v[68:69], v[66:67], v[70:71] op_sel:[1,1] op_sel_hi:[0,0] neg_lo:[0,1] neg_hi:[1,0]
v_pk_add_f32 v[66:67], v[66:67], v[70:71]
v_pk_add_f32 v[70:71], v[60:61], v[48:49] neg_lo:[0,1] neg_hi:[0,1]
v_pk_add_f32 v[60:61], v[60:61], v[48:49]
v_pk_add_f32 v[48:49], v[74:75], v[78:79] op_sel:[1,1] op_sel_hi:[0,0] neg_lo:[0,1] neg_hi:[1,0]
v_pk_add_f32 v[74:75], v[74:75], v[78:79]
v_pk_add_f32 v[78:79], v[16:17], v[18:19] neg_lo:[0,1] neg_hi:[0,1]
v_pk_add_f32 v[16:17], v[16:17], v[18:19]
v_pk_add_f32 v[18:19], v[76:77], v[20:21] neg_lo:[0,1] neg_hi:[0,1]
v_pk_add_f32 v[76:77], v[76:77], v[20:21]
v_pk_add_f32 v[20:21], v[72:73], v[26:27] neg_lo:[0,1] neg_hi:[0,1]
v_pk_add_f32 v[72:73], v[72:73], v[26:27]
v_pk_add_f32 v[26:27], v[22:23], v[24:25] neg_lo:[0,1] neg_hi:[0,1]
v_pk_add_f32 v[22:23], v[22:23], v[24:25]
v_pk_add_f32 v[24:25], v[64:65], v[34:35] neg_lo:[0,1] neg_hi:[0,1]
v_pk_add_f32 v[64:65], v[64:65], v[34:35]
v_pk_add_f32 v[34:35], v[30:31], v[36:37] neg_lo:[0,1] neg_hi:[0,1]
v_pk_add_f32 v[30:31], v[30:31], v[36:37]
v_pk_add_f32 v[36:37], v[28:29], v[42:43] neg_lo:[0,1] neg_hi:[0,1]
v_pk_add_f32 v[28:29], v[28:29], v[42:43]
v_pk_add_f32 v[42:43], v[38:39], v[32:33] neg_lo:[0,1] neg_hi:[0,1]
v_pk_add_f32 v[38:39], v[38:39], v[32:33]
v_pk_add_f32 v[32:33], v[14:15], v[50:51] neg_lo:[0,1] neg_hi:[0,1]
v_pk_add_f32 v[14:15], v[14:15], v[50:51]
v_pk_add_f32 v[50:51], v[46:47], v[52:53] neg_lo:[0,1] neg_hi:[0,1]
v_pk_add_f32 v[46:47], v[46:47], v[52:53]
v_pk_add_f32 v[52:53], v[44:45], v[58:59] neg_lo:[0,1] neg_hi:[0,1]
v_pk_add_f32 v[44:45], v[44:45], v[58:59]
v_pk_add_f32 v[58:59], v[54:55], v[56:57] neg_lo:[0,1] neg_hi:[0,1]
v_pk_add_f32 v[54:55], v[54:55], v[56:57]
v_pk_add_f32 v[56:57], v[40:41], v[66:67] neg_lo:[0,1] neg_hi:[0,1]
v_pk_add_f32 v[40:41], v[40:41], v[66:67]
v_pk_add_f32 v[66:67], v[62:63], v[68:69] neg_lo:[0,1] neg_hi:[0,1]
v_pk_add_f32 v[62:63], v[62:63], v[68:69]
v_pk_add_f32 v[68:69], v[60:61], v[74:75] neg_lo:[0,1] neg_hi:[0,1]
v_pk_add_f32 v[60:61], v[60:61], v[74:75]
v_pk_add_f32 v[74:75], v[70:71], v[48:49] neg_lo:[0,1] neg_hi:[0,1]
v_pk_add_f32 v[70:71], v[70:71], v[48:49]
v_pk_mul_f32 v[48:49], v[14:15], v[82:83] op_sel:[0,0] op_sel_hi:[0,1] neg_lo:[0,0] neg_hi:[0,0]
v_pk_fma_f32 v[14:15], v[14:15], v[82:83], v[48:49] op_sel:[1,1,0] op_sel_hi:[1,0,1] neg_lo:[0,1,0] neg_hi:[0,0,0]
v_pk_mul_f32 v[48:49], v[64:65], v[84:85] op_sel:[0,0] op_sel_hi:[0,1] neg_lo:[0,0] neg_hi:[0,0]
v_pk_fma_f32 v[64:65], v[64:65], v[84:85], v[48:49] op_sel:[1,1,0] op_sel_hi:[1,0,1] neg_lo:[0,1,0] neg_hi:[0,0,0]
v_pk_mul_f32 v[48:49], v[40:41], v[86:87] op_sel:[0,0] op_sel_hi:[0,1] neg_lo:[0,0] neg_hi:[0,0]
v_pk_fma_f32 v[40:41], v[40:41], v[86:87], v[48:49] op_sel:[1,1,0] op_sel_hi:[1,0,1] neg_lo:[0,1,0] neg_hi:[0,0,0]
v_pk_mul_f32 v[48:49], v[72:73], v[88:89] op_sel:[0,0] op_sel_hi:[0,1] neg_lo:[0,0] neg_hi:[0,0]
v_pk_fma_f32 v[72:73], v[72:73], v[88:89], v[48:49] op_sel:[1,1,0] op_sel_hi:[1,0,1] neg_lo:[0,1,0] neg_hi:[0,0,0]
v_pk_mul_f32 v[48:49], v[44:45], v[90:91] op_sel:[0,0] op_sel_hi:[0,1] neg_lo:[0,0] neg_hi:[0,0]
v_pk_fma_f32 v[44:45], v[44:45], v[90:91], v[48:49] op_sel:[1,1,0] op_sel_hi:[1,0,1] neg_lo:[0,1,0] neg_hi:[0,0,0]
v_pk_mul_f32 v[48:49], v[28:29], v[92:93] op_sel:[0,0] op_sel_hi:[0,1] neg_lo:[0,0] neg_hi:[0,0]
v_pk_fma_f32 v[28:29], v[28:29], v[92:93], v[48:49] op_sel:[1,1,0] op_sel_hi:[1,0,1] neg_lo:[0,1,0] neg_hi:[0,0,0]
v_pk_mul_f32 v[48:49], v[60:61], v[94:95] op_sel:[0,0] op_sel_hi:[0,1] neg_lo:[0,0] neg_hi:[0,0]
v_pk_fma_f32 v[60:61], v[60:61], v[94:95], v[48:49] op_sel:[1,1,0] op_sel_hi:[1,0,1] neg_lo:[0,1,0] neg_hi:[0,0,0]
v_pk_mul_f32 v[48:49], v[76:77], v[96:97] op_sel:[0,0] op_sel_hi:[0,1] neg_lo:[0,0] neg_hi:[0,0]
v_pk_fma_f32 v[76:77], v[76:77], v[96:97], v[48:49] op_sel:[1,1,0] op_sel_hi:[1,0,1] neg_lo:[0,1,0] neg_hi:[0,0,0]
v_pk_mul_f32 v[48:49], v[46:47], v[98:99] op_sel:[0,0] op_sel_hi:[0,1] neg_lo:[0,0] neg_hi:[0,0]
v_pk_fma_f32 v[46:47], v[46:47], v[98:99], v[48:49] op_sel:[1,1,0] op_sel_hi:[1,0,1] neg_lo:[0,1,0] neg_hi:[0,0,0]
v_pk_mul_f32 v[48:49], v[30:31], v[100:101] op_sel:[0,0] op_sel_hi:[0,1] neg_lo:[0,0] neg_hi:[0,0]
v_pk_fma_f32 v[30:31], v[30:31], v[100:101], v[48:49] op_sel:[1,1,0] op_sel_hi:[1,0,1] neg_lo:[0,1,0] neg_hi:[0,0,0]
v_pk_mul_f32 v[48:49], v[62:63], v[102:103] op_sel:[0,0] op_sel_hi:[0,1] neg_lo:[0,0] neg_hi:[0,0]
v_pk_fma_f32 v[62:63], v[62:63], v[102:103], v[48:49] op_sel:[1,1,0] op_sel_hi:[1,0,1] neg_lo:[0,1,0] neg_hi:[0,0,0]
v_pk_mul_f32 v[48:49], v[22:23], v[104:105] op_sel:[0,0] op_sel_hi:[0,1] neg_lo:[0,0] neg_hi:[0,0]
v_pk_fma_f32 v[22:23], v[22:23], v[104:105], v[48:49] op_sel:[1,1,0] op_sel_hi:[1,0,1] neg_lo:[0,1,0] neg_hi:[0,0,0]
v_pk_mul_f32 v[48:49], v[54:55], v[106:107] op_sel:[0,0] op_sel_hi:[0,1] neg_lo:[0,0] neg_hi:[0,0]
v_pk_fma_f32 v[54:55], v[54:55], v[106:107], v[48:49] op_sel:[1,1,0] op_sel_hi:[1,0,1] neg_lo:[0,1,0] neg_hi:[0,0,0]
v_pk_mul_f32 v[48:49], v[38:39], v[108:109] op_sel:[0,0] op_sel_hi:[0,1] neg_lo:[0,0] neg_hi:[0,0]
v_pk_fma_f32 v[38:39], v[38:39], v[108:109], v[48:49] op_sel:[1,1,0] op_sel_hi:[1,0,1] neg_lo:[0,1,0] neg_hi:[0,0,0]
v_pk_mul_f32 v[48:49], v[70:71], v[110:111] op_sel:[0,0] op_sel_hi:[0,1] neg_lo:[0,0] neg_hi:[0,0]
v_pk_fma_f32 v[70:71], v[70:71], v[110:111], v[48:49] op_sel:[1,1,0] op_sel_hi:[1,0,1] neg_lo:[0,1,0] neg_hi:[0,0,0]
v_pk_mul_f32 v[48:49], v[78:79], v[112:113] op_sel:[0,0] op_sel_hi:[0,1] neg_lo:[0,0] neg_hi:[0,0]
v_pk_fma_f32 v[78:79], v[78:79], v[112:113], v[48:49] op_sel:[1,1,0] op_sel_hi:[1,0,1] neg_lo:[0,1,0] neg_hi:[0,0,0]
v_pk_mul_f32 v[48:49], v[32:33], v[114:115] op_sel:[0,0] op_sel_hi:[0,1] neg_lo:[0,0] neg_hi:[0,0]
v_pk_fma_f32 v[32:33], v[32:33], v[114:115], v[48:49] op_sel:[1,1,0] op_sel_hi:[1,0,1] neg_lo:[0,1,0] neg_hi:[0,0,0]
v_pk_mul_f32 v[48:49], v[24:25], v[116:117] op_sel:[0,0] op_sel_hi:[0,1] neg_lo:[0,0] neg_hi:[0,0]
v_pk_fma_f32 v[24:25], v[24:25], v[116:117], v[48:49] op_sel:[1,1,0] op_sel_hi:[1,0,1] neg_lo:[0,1,0] neg_hi:[0,0,0]
v_pk_mul_f32 v[48:49], v[56:57], v[118:119] op_sel:[0,0] op_sel_hi:[0,1] neg_lo:[0,0] neg_hi:[0,0]
v_pk_fma_f32 v[56:57], v[56:57], v[118:119], v[48:49] op_sel:[1,1,0] op_sel_hi:[1,0,1] neg_lo:[0,1,0] neg_hi:[0,0,0]
v_pk_mul_f32 v[48:49], v[20:21], v[120:121] op_sel:[0,0] op_sel_hi:[0,1] neg_lo:[0,0] neg_hi:[0,0]
v_pk_fma_f32 v[20:21], v[20:21], v[120:121], v[48:49] op_sel:[1,1,0] op_sel_hi:[1,0,1] neg_lo:[0,1,0] neg_hi:[0,0,0]
v_pk_mul_f32 v[48:49], v[52:53], v[122:123] op_sel:[0,0] op_sel_hi:[0,1] neg_lo:[0,0] neg_hi:[0,0]
v_pk_fma_f32 v[52:53], v[52:53], v[122:123], v[48:49] op_sel:[1,1,0] op_sel_hi:[1,0,1] neg_lo:[0,1,0] neg_hi:[0,0,0]
v_pk_mul_f32 v[48:49], v[36:37], v[124:125] op_sel:[0,0] op_sel_hi:[0,1] neg_lo:[0,0] neg_hi:[0,0]
v_pk_fma_f32 v[36:37], v[36:37], v[124:125], v[48:49] op_sel:[1,1,0] op_sel_hi:[1,0,1] neg_lo:[0,1,0] neg_hi:[0,0,0]
v_pk_mul_f32 v[48:49], v[68:69], v[126:127] op_sel:[0,0] op_sel_hi:[0,1] neg_lo:[0,0] neg_hi:[0,0]
v_pk_fma_f32 v[68:69], v[68:69], v[126:127], v[48:49] op_sel:[1,1,0] op_sel_hi:[1,0,1] neg_lo:[0,1,0] neg_hi:[0,0,0]
v_pk_mul_f32 v[48:49], v[18:19], v[128:129] op_sel:[0,0] op_sel_hi:[0,1] neg_lo:[0,0] neg_hi:[0,0]
v_pk_fma_f32 v[18:19], v[18:19], v[128:129], v[48:49] op_sel:[1,1,0] op_sel_hi:[1,0,1] neg_lo:[0,1,0] neg_hi:[0,0,0]
v_pk_mul_f32 v[48:49], v[50:51], v[130:131] op_sel:[0,0] op_sel_hi:[0,1] neg_lo:[0,0] neg_hi:[0,0]
v_pk_fma_f32 v[50:51], v[50:51], v[130:131], v[48:49] op_sel:[1,1,0] op_sel_hi:[1,0,1] neg_lo:[0,1,0] neg_hi:[0,0,0]
v_pk_mul_f32 v[48:49], v[34:35], v[132:133] op_sel:[0,0] op_sel_hi:[0,1] neg_lo:[0,0] neg_hi:[0,0]
v_pk_fma_f32 v[34:35], v[34:35], v[132:133], v[48:49] op_sel:[1,1,0] op_sel_hi:[1,0,1] neg_lo:[0,1,0] neg_hi:[0,0,0]
v_pk_mul_f32 v[48:49], v[66:67], v[134:135] op_sel:[0,0] op_sel_hi:[0,1] neg_lo:[0,0] neg_hi:[0,0]
v_pk_fma_f32 v[66:67], v[66:67], v[134:135], v[48:49] op_sel:[1,1,0] op_sel_hi:[1,0,1] neg_lo:[0,1,0] neg_hi:[0,0,0]
v_pk_mul_f32 v[48:49], v[26:27], v[136:137] op_sel:[0,0] op_sel_hi:[0,1] neg_lo:[0,0] neg_hi:[0,0]
v_pk_fma_f32 v[26:27], v[26:27], v[136:137], v[48:49] op_sel:[1,1,0] op_sel_hi:[1,0,1] neg_lo:[0,1,0] neg_hi:[0,0,0]
v_pk_mul_f32 v[48:49], v[58:59], v[138:139] op_sel:[0,0] op_sel_hi:[0,1] neg_lo:[0,0] neg_hi:[0,0]
v_pk_fma_f32 v[58:59], v[58:59], v[138:139], v[48:49] op_sel:[1,1,0] op_sel_hi:[1,0,1] neg_lo:[0,1,0] neg_hi:[0,0,0]
v_pk_mul_f32 v[48:49], v[42:43], v[140:141] op_sel:[0,0] op_sel_hi:[0,1] neg_lo:[0,0] neg_hi:[0,0]
v_pk_fma_f32 v[42:43], v[42:43], v[140:141], v[48:49] op_sel:[1,1,0] op_sel_hi:[1,0,1] neg_lo:[0,1,0] neg_hi:[0,0,0]
v_pk_mul_f32 v[48:49], v[74:75], v[142:143] op_sel:[0,0] op_sel_hi:[0,1] neg_lo:[0,0] neg_hi:[0,0]
v_pk_fma_f32 v[74:75], v[74:75], v[142:143], v[48:49] op_sel:[1,1,0] op_sel_hi:[1,0,1] neg_lo:[0,1,0] neg_hi:[0,0,0]
ds_write_b64 v3, v[16:17] offset:0
ds_write_b64 v3, v[14:15] offset:528
ds_write_b64 v3, v[64:65] offset:1056
ds_write_b64 v3, v[40:41] offset:1584
ds_write_b64 v3, v[72:73] offset:2112
ds_write_b64 v3, v[44:45] offset:2640
ds_write_b64 v3, v[28:29] offset:3168
ds_write_b64 v3, v[60:61] offset:3696
ds_write_b64 v3, v[76:77] offset:4224
ds_write_b64 v3, v[46:47] offset:4752
ds_write_b64 v3, v[30:31] offset:5280
ds_write_b64 v3, v[62:63] offset:5808
ds_write_b64 v3, v[22:23] offset:6336
ds_write_b64 v3, v[54:55] offset:6864
ds_write_b64 v3, v[38:39] offset:7392
ds_write_b64 v3, v[70:71] offset:7920
ds_write_b64 v3, v[78:79] offset:8448
ds_write_b64 v3, v[32:33] offset:8976
ds_write_b64 v3, v[24:25] offset:9504
ds_write_b64 v3, v[56:57] offset:10032
ds_write_b64 v3, v[20:21] offset:10560
ds_write_b64 v3, v[52:53] offset:11088
ds_write_b64 v3, v[36:37] offset:11616
ds_write_b64 v3, v[68:69] offset:12144
ds_write_b64 v3, v[18:19] offset:12672
ds_write_b64 v3, v[50:51] offset:13200
ds_write_b64 v3, v[34:35] offset:13728
ds_write_b64 v3, v[66:67] offset:14256
ds_write_b64 v3, v[26:27] offset:14784
ds_write_b64 v3, v[58:59] offset:15312
ds_write_b64 v3, v[42:43] offset:15840
ds_write_b64 v3, v[74:75] offset:16368
s_waitcnt lgkmcnt(0)
ds_read_b64 v[16:17], v4 offset:0
ds_read_b64 v[48:49], v4 offset:256
ds_read_b64 v[18:19], v4 offset:16
ds_read_b64 v[50:51], v4 offset:272
ds_read_b64 v[20:21], v4 offset:32
ds_read_b64 v[52:53], v4 offset:288
ds_read_b64 v[22:23], v4 offset:48
ds_read_b64 v[54:55], v4 offset:304
ds_read_b64 v[24:25], v4 offset:64
ds_read_b64 v[56:57], v4 offset:320
ds_read_b64 v[26:27], v4 offset:80
ds_read_b64 v[58:59], v4 offset:336
ds_read_b64 v[28:29], v4 offset:96
ds_read_b64 v[60:61], v4 offset:352
ds_read_b64 v[30:31], v4 offset:112
ds_read_b64 v[62:63], v4 offset:368
ds_read_b64 v[32:33], v4 offset:128
ds_read_b64 v[64:65], v4 offset:384
ds_read_b64 v[34:35], v4 offset:144
ds_read_b64 v[66:67], v4 offset:400
ds_read_b64 v[36:37], v4 offset:160
ds_read_b64 v[68:69], v4 offset:416
ds_read_b64 v[38:39], v4 offset:176
ds_read_b64 v[70:71], v4 offset:432
ds_read_b64 v[40:41], v4 offset:192
ds_read_b64 v[72:73], v4 offset:448
ds_read_b64 v[42:43], v4 offset:208
ds_read_b64 v[74:75], v4 offset:464
ds_read_b64 v[44:45], v4 offset:224
ds_read_b64 v[76:77], v4 offset:480
ds_read_b64 v[46:47], v4 offset:240
ds_read_b64 v[78:79], v4 offset:496
s_waitcnt lgkmcnt(0)
v_pk_add_f32 v[14:15], v[16:17], v[48:49] neg_lo:[0,1] neg_hi:[0,1]
v_pk_add_f32 v[16:17], v[16:17], v[48:49]
v_pk_add_f32 v[48:49], v[18:19], v[50:51] neg_lo:[0,1] neg_hi:[0,1]
v_pk_add_f32 v[18:19], v[18:19], v[50:51]
v_pk_mul_f32 v[50:51], v[48:49], s[50:51] op_sel:[0,0] op_sel_hi:[0,1] neg_lo:[0,0] neg_hi:[0,1]
v_pk_fma_f32 v[50:51], v[48:49], s[50:51], v[50:51] op_sel:[1,1,0] op_sel_hi:[1,0,1] neg_lo:[0,0,0] neg_hi:[0,0,0]
v_pk_add_f32 v[48:49], v[20:21], v[52:53] neg_lo:[0,1] neg_hi:[0,1]
v_pk_add_f32 v[20:21], v[20:21], v[52:53]
v_pk_mul_f32 v[52:53], v[48:49], s[54:55] op_sel:[0,0] op_sel_hi:[0,1] neg_lo:[0,0] neg_hi:[0,1]
v_pk_fma_f32 v[52:53], v[48:49], s[54:55], v[52:53] op_sel:[1,1,0] op_sel_hi:[1,0,1] neg_lo:[0,0,0] neg_hi:[0,0,0]
v_pk_add_f32 v[48:49], v[22:23], v[54:55] neg_lo:[0,1] neg_hi:[0,1]
v_pk_add_f32 v[22:23], v[22:23], v[54:55]
v_pk_mul_f32 v[54:55], v[48:49], s[58:59] op_sel:[0,0] op_sel_hi:[0,1] neg_lo:[0,0] neg_hi:[0,1]
v_pk_fma_f32 v[54:55], v[48:49], s[58:59], v[54:55] op_sel:[1,1,0] op_sel_hi:[1,0,1] neg_lo:[0,0,0] neg_hi:[0,0,0]
v_pk_add_f32 v[48:49], v[24:25], v[56:57] neg_lo:[0,1] neg_hi:[0,1]
v_pk_add_f32 v[24:25], v[24:25], v[56:57]
v_pk_mul_f32 v[56:57], v[48:49], s[62:63] op_sel:[0,0] op_sel_hi:[0,1] neg_lo:[0,0] neg_hi:[0,1]
v_pk_fma_f32 v[56:57], v[48:49], s[62:63], v[56:57] op_sel:[1,1,0] op_sel_hi:[1,0,1] neg_lo:[0,0,0] neg_hi:[0,0,0]
v_pk_add_f32 v[48:49], v[26:27], v[58:59] neg_lo:[0,1] neg_hi:[0,1]
v_pk_add_f32 v[26:27], v[26:27], v[58:59]
v_pk_mul_f32 v[58:59], v[48:49], s[58:59] op_sel:[0,1] op_sel_hi:[0,0] neg_lo:[0,0] neg_hi:[0,1]
v_pk_fma_f32 v[58:59], v[48:49], s[58:59], v[58:59] op_sel:[1,0,0] op_sel_hi:[1,1,1] neg_lo:[0,0,0] neg_hi:[0,0,0]
v_pk_add_f32 v[48:49], v[28:29], v[60:61] neg_lo:[0,1] neg_hi:[0,1]
v_pk_add_f32 v[28:29], v[28:29], v[60:61]
v_pk_mul_f32 v[60:61], v[48:49], s[54:55] op_sel:[0,1] op_sel_hi:[0,0] neg_lo:[0,0] neg_hi:[0,1]
v_pk_fma_f32 v[60:61], v[48:49], s[54:55], v[60:61] op_sel:[1,0,0] op_sel_hi:[1,1,1] neg_lo:[0,0,0] neg_hi:[0,0,0]
v_pk_add_f32 v[48:49], v[30:31], v[62:63] neg_lo:[0,1] neg_hi:[0,1]
v_pk_add_f32 v[30:31], v[30:31], v[62:63]
v_pk_mul_f32 v[62:63], v[48:49], s[50:51] op_sel:[0,1] op_sel_hi:[0,0] neg_lo:[0,0] neg_hi:[0,1]
v_pk_fma_f32 v[62:63], v[48:49], s[50:51], v[62:63] op_sel:[1,0,0] op_sel_hi:[1,1,1] neg_lo:[0,0,0] neg_hi:[0,0,0]
v_pk_add_f32 v[48:49], v[32:33], v[64:65] op_sel:[1,1] op_sel_hi:[0,0] neg_lo:[0,1] neg_hi:[1,0]
v_pk_add_f32 v[32:33], v[32:33], v[64:65]
v_pk_add_f32 v[64:65], v[34:35], v[66:67] neg_lo:[0,1] neg_hi:[0,1]
v_pk_add_f32 v[34:35], v[34:35], v[66:67]
v_pk_mul_f32 v[66:67], v[64:65], s[50:51] op_sel:[0,1] op_sel_hi:[0,0] neg_lo:[0,1] neg_hi:[0,1]
v_pk_fma_f32 v[66:67], v[64:65], s[50:51], v[66:67] op_sel:[1,0,0] op_sel_hi:[1,1,1] neg_lo:[0,0,0] neg_hi:[0,1,0]
v_pk_add_f32 v[64:65], v[36:37], v[68:69] neg_lo:[0,1] neg_hi:[0,1]
v_pk_add_f32 v[36:37], v[36:37], v[68:69]
v_pk_mul_f32 v[68:69], v[64:65], s[54:55] op_sel:[0,1] op_sel_hi:[0,0] neg_lo:[0,1] neg_hi:[0,1]
v_pk_fma_f32 v[68:69], v[64:65], s[54:55], v[68:69] op_sel:[1,0,0] op_sel_hi:[1,1,1] neg_lo:[0,0,0] neg_hi:[0,1,0]
v_pk_add_f32 v[64:65], v[38:39], v[70:71] neg_lo:[0,1] neg_hi:[0,1]
v_pk_add_f32 v[38:39], v[38:39], v[70:71]
v_pk_mul_f32 v[70:71], v[64:65], s[58:59] op_sel:[0,1] op_sel_hi:[0,0] neg_lo:[0,1] neg_hi:[0,1]
v_pk_fma_f32 v[70:71], v[64:65], s[58:59], v[70:71] op_sel:[1,0,0] op_sel_hi:[1,1,1] neg_lo:[0,0,0] neg_hi:[0,1,0]
v_pk_add_f32 v[64:65], v[40:41], v[72:73] neg_lo:[0,1] neg_hi:[0,1]
v_pk_add_f32 v[40:41], v[40:41], v[72:73]
v_pk_mul_f32 v[72:73], v[64:65], s[62:63] op_sel:[0,0] op_sel_hi:[0,1] neg_lo:[0,1] neg_hi:[0,1]
v_pk_fma_f32 v[72:73], v[64:65], s[62:63], v[72:73] op_sel:[1,1,0] op_sel_hi:[1,0,1] neg_lo:[0,0,0] neg_hi:[0,1,0]
v_pk_add_f32 v[64:65], v[42:43], v[74:75] neg_lo:[0,1] neg_hi:[0,1]
v_pk_add_f32 v[42:43], v[42:43], v[74:75]
v_pk_mul_f32 v[74:75], v[64:65], s[58:59] op_sel:[0,0] op_sel_hi:[0,1] neg_lo:[0,1] neg_hi:[0,1]
v_pk_fma_f32 v[74:75], v[64:65], s[58:59], v[74:75] op_sel:[1,1,0] op_sel_hi:[1,0,1] neg_lo:[0,0,0] neg_hi:[0,1,0]
v_pk_add_f32 v[64:65], v[44:45], v[76:77] neg_lo:[0,1] neg_hi:[0,1]
v_pk_add_f32 v[44:45], v[44:45], v[76:77]
v_pk_mul_f32 v[76:77], v[64:65], s[54:55] op_sel:[0,0] op_sel_hi:[0,1] neg_lo:[0,1] neg_hi:[0,1]
v_pk_fma_f32 v[76:77], v[64:65], s[54:55], v[76:77] op_sel:[1,1,0] op_sel_hi:[1,0,1] neg_lo:[0,0,0] neg_hi:[0,1,0]
v_pk_add_f32 v[64:65], v[46:47], v[78:79] neg_lo:[0,1] neg_hi:[0,1]
v_pk_add_f32 v[46:47], v[46:47], v[78:79]
v_pk_mul_f32 v[78:79], v[64:65], s[50:51] op_sel:[0,0] op_sel_hi:[0,1] neg_lo:[0,1] neg_hi:[0,1]
v_pk_fma_f32 v[78:79], v[64:65], s[50:51], v[78:79] op_sel:[1,1,0] op_sel_hi:[1,0,1] neg_lo:[0,0,0] neg_hi:[0,1,0]
v_pk_add_f32 v[64:65], v[16:17], v[32:33] neg_lo:[0,1] neg_hi:[0,1]
v_pk_add_f32 v[16:17], v[16:17], v[32:33]
v_pk_add_f32 v[32:33], v[18:19], v[34:35] neg_lo:[0,1] neg_hi:[0,1]
v_pk_add_f32 v[18:19], v[18:19], v[34:35]
v_pk_mul_f32 v[34:35], v[32:33], s[54:55] op_sel:[0,0] op_sel_hi:[0,1] neg_lo:[0,0] neg_hi:[0,1]
v_pk_fma_f32 v[34:35], v[32:33], s[54:55], v[34:35] op_sel:[1,1,0] op_sel_hi:[1,0,1] neg_lo:[0,0,0] neg_hi:[0,0,0]
v_pk_add_f32 v[32:33], v[20:21], v[36:37] neg_lo:[0,1] neg_hi:[0,1]
v_pk_add_f32 v[20:21], v[20:21], v[36:37]
v_pk_mul_f32 v[36:37], v[32:33], s[62:63] op_sel:[0,0] op_sel_hi:[0,1] neg_lo:[0,0] neg_hi:[0,1]
v_pk_fma_f32 v[36:37], v[32:33], s[62:63], v[36:37] op_sel:[1,1,0] op_sel_hi:[1,0,1] neg_lo:[0,0,0] neg_hi:[0,0,0]
v_pk_add_f32 v[32:33], v[22:23], v[38:39] neg_lo:[0,1] neg_hi:[0,1]
v_pk_add_f32 v[22:23], v[22:23], v[38:39]
v_pk_mul_f32 v[38:39], v[32:33], s[54:55] op_sel:[0,1] op_sel_hi:[0,0] neg_lo:[0,0] neg_hi:[0,1]
v_pk_fma_f32 v[38:39], v[32:33], s[54:55], v[38:39] op_sel:[1,0,0] op_sel_hi:[1,1,1] neg_lo:[0,0,0] neg_hi:[0,0,0]
v_pk_add_f32 v[32:33], v[24:25], v[40:41] op_sel:[1,1] op_sel_hi:[0,0] neg_lo:[0,1] neg_hi:[1,0]
v_pk_add_f32 v[24:25], v[24:25], v[40:41]
v_pk_add_f32 v[40:41], v[26:27], v[42:43] neg_lo:[0,1] neg_hi:[0,1]
v_pk_add_f32 v[26:27], v[26:27], v[42:43]
v_pk_mul_f32 v[42:43], v[40:41], s[54:55] op_sel:[0,1] op_sel_hi:[0,0] neg_lo:[0,1] neg_hi:[0,1]
v_pk_fma_f32 v[42:43], v[40:41], s[54:55], v[42:43] op_sel:[1,0,0] op_sel_hi:[1,1,1] neg_lo:[0,0,0] neg_hi:[0,1,0]
v_pk_add_f32 v[40:41], v[28:29], v[44:45] neg_lo:[0,1] neg_hi:[0,1]
v_pk_add_f32 v[28:29], v[28:29], v[44:45]
v_pk_mul_f32 v[44:45], v[40:41], s[62:63] op_sel:[0,0] op_sel_hi:[0,1] neg_lo:[0,1] neg_hi:[0,1]
v_pk_fma_f32 v[44:45], v[40:41], s[62:63], v[44:45] op_sel:[1,1,0] op_sel_hi:[1,0,1] neg_lo:[0,0,0] neg_hi:[0,1,0]
v_pk_add_f32 v[40:41], v[30:31], v[46:47] neg_lo:[0,1] neg_hi:[0,1]
v_pk_add_f32 v[30:31], v[30:31], v[46:47]
v_pk_mul_f32 v[46:47], v[40:41], s[54:55] op_sel:[0,0] op_sel_hi:[0,1] neg_lo:[0,1] neg_hi:[0,1]
v_pk_fma_f32 v[46:47], v[40:41], s[54:55], v[46:47] op_sel:[1,1,0] op_sel_hi:[1,0,1] neg_lo:[0,0,0] neg_hi:[0,1,0]
v_pk_add_f32 v[40:41], v[14:15], v[48:49] neg_lo:[0,1] neg_hi:[0,1]
v_pk_add_f32 v[14:15], v[14:15], v[48:49]
v_pk_add_f32 v[48:49], v[50:51], v[66:67] neg_lo:[0,1] neg_hi:[0,1]
v_pk_add_f32 v[50:51], v[50:51], v[66:67]
v_pk_mul_f32 v[66:67], v[48:49], s[54:55] op_sel:[0,0] op_sel_hi:[0,1] neg_lo:[0,0] neg_hi:[0,1]
v_pk_fma_f32 v[66:67], v[48:49], s[54:55], v[66:67] op_sel:[1,1,0] op_sel_hi:[1,0,1] neg_lo:[0,0,0] neg_hi:[0,0,0]
v_pk_add_f32 v[48:49], v[52:53], v[68:69] neg_lo:[0,1] neg_hi:[0,1]
v_pk_add_f32 v[52:53], v[52:53], v[68:69]
v_pk_mul_f32 v[68:69], v[48:49], s[62:63] op_sel:[0,0] op_sel_hi:[0,1] neg_lo:[0,0] neg_hi:[0,1]
v_pk_fma_f32 v[68:69], v[48:49], s[62:63], v[68:69] op_sel:[1,1,0] op_sel_hi:[1,0,1] neg_lo:[0,0,0] neg_hi:[0,0,0]
v_pk_add_f32 v[48:49], v[54:55], v[70:71] neg_lo:[0,1] neg_hi:[0,1]
v_pk_add_f32 v[54:55], v[54:55], v[70:71]
v_pk_mul_f32 v[70:71], v[48:49], s[54:55] op_sel:[0,1] op_sel_hi:[0,0] neg_lo:[0,0] neg_hi:[0,1]
v_pk_fma_f32 v[70:71], v[48:49], s[54:55], v[70:71] op_sel:[1,0,0] op_sel_hi:[1,1,1] neg_lo:[0,0,0] neg_hi:[0,0,0]
v_pk_add_f32 v[48:49], v[56:57], v[72:73] op_sel:[1,1] op_sel_hi:[0,0] neg_lo:[0,1] neg_hi:[1,0]
v_pk_add_f32 v[56:57], v[56:57], v[72:73]
v_pk_add_f32 v[72:73], v[58:59], v[74:75] neg_lo:[0,1] neg_hi:[0,1]
v_pk_add_f32 v[58:59], v[58:59], v[74:75]
v_pk_mul_f32 v[74:75], v[72:73], s[54:55] op_sel:[0,1] op_sel_hi:[0,0] neg_lo:[0,1] neg_hi:[0,1]
v_pk_fma_f32 v[74:75], v[72:73], s[54:55], v[74:75] op_sel:[1,0,0] op_sel_hi:[1,1,1] neg_lo:[0,0,0] neg_hi:[0,1,0]
v_pk_add_f32 v[72:73], v[60:61], v[76:77] neg_lo:[0,1] neg_hi:[0,1]
v_pk_add_f32 v[60:61], v[60:61], v[76:77]
v_pk_mul_f32 v[76:77], v[72:73], s[62:63] op_sel:[0,0] op_sel_hi:[0,1] neg_lo:[0,1] neg_hi:[0,1]
v_pk_fma_f32 v[76:77], v[72:73], s[62:63], v[76:77] op_sel:[1,1,0] op_sel_hi:[1,0,1] neg_lo:[0,0,0] neg_hi:[0,1,0]
v_pk_add_f32 v[72:73], v[62:63], v[78:79] neg_lo:[0,1] neg_hi:[0,1]
v_pk_add_f32 v[62:63], v[62:63], v[78:79]
v_pk_mul_f32 v[78:79], v[72:73], s[54:55] op_sel:[0,0] op_sel_hi:[0,1] neg_lo:[0,1] neg_hi:[0,1]
v_pk_fma_f32 v[78:79], v[72:73], s[54:55], v[78:79] op_sel:[1,1,0] op_sel_hi:[1,0,1] neg_lo:[0,0,0] neg_hi:[0,1,0]
v_pk_add_f32 v[72:73], v[16:17], v[24:25] neg_lo:[0,1] neg_hi:[0,1]
v_pk_add_f32 v[16:17], v[16:17], v[24:25]
v_pk_add_f32 v[24:25], v[18:19], v[26:27] neg_lo:[0,1] neg_hi:[0,1]
v_pk_add_f32 v[18:19], v[18:19], v[26:27]
v_pk_mul_f32 v[26:27], v[24:25], s[62:63] op_sel:[0,0] op_sel_hi:[0,1] neg_lo:[0,0] neg_hi:[0,1]
v_pk_fma_f32 v[26:27], v[24:25], s[62:63], v[26:27] op_sel:[1,1,0] op_sel_hi:[1,0,1] neg_lo:[0,0,0] neg_hi:[0,0,0]
v_pk_add_f32 v[24:25], v[20:21], v[28:29] op_sel:[1,1] op_sel_hi:[0,0] neg_lo:[0,1] neg_hi:[1,0]
v_pk_add_f32 v[20:21], v[20:21], v[28:29]
v_pk_add_f32 v[28:29], v[22:23], v[30:31] neg_lo:[0,1] neg_hi:[0,1]
v_pk_add_f32 v[22:23], v[22:23], v[30:31]
v_pk_mul_f32 v[30:31], v[28:29], s[62:63] op_sel:[0,0] op_sel_hi:[0,1] neg_lo:[0,1] neg_hi:[0,1]
v_pk_fma_f32 v[30:31], v[28:29], s[62:63], v[30:31] op_sel:[1,1,0] op_sel_hi:[1,0,1] neg_lo:[0,0,0] neg_hi:[0,1,0]
v_pk_add_f32 v[28:29], v[64:65], v[32:33] neg_lo:[0,1] neg_hi:[0,1]
v_pk_add_f32 v[64:65], v[64:65], v[32:33]
v_pk_add_f32 v[32:33], v[34:35], v[42:43] neg_lo:[0,1] neg_hi:[0,1]
v_pk_add_f32 v[34:35], v[34:35], v[42:43]
v_pk_mul_f32 v[42:43], v[32:33], s[62:63] op_sel:[0,0] op_sel_hi:[0,1] neg_lo:[0,0] neg_hi:[0,1]
v_pk_fma_f32 v[42:43], v[32:33], s[62:63], v[42:43] op_sel:[1,1,0] op_sel_hi:[1,0,1] neg_lo:[0,0,0] neg_hi:[0,0,0]
v_pk_add_f32 v[32:33], v[36:37], v[44:45] op_sel:[1,1] op_sel_hi:[0,0] neg_lo:[0,1] neg_hi:[1,0]
v_pk_add_f32 v[36:37], v[36:37], v[44:45]
v_pk_add_f32 v[44:45], v[38:39], v[46:47] neg_lo:[0,1] neg_hi:[0,1]
v_pk_add_f32 v[38:39], v[38:39], v[46:47]
v_pk_mul_f32 v[46:47], v[44:45], s[62:63] op_sel:[0,0] op_sel_hi:[0,1] neg_lo:[0,1] neg_hi:[0,1]
v_pk_fma_f32 v[46:47], v[44:45], s[62:63], v[46:47] op_sel:[1,1,0] op_sel_hi:[1,0,1] neg_lo:[0,0,0] neg_hi:[0,1,0]
v_pk_add_f32 v[44:45], v[14:15], v[56:57] neg_lo:[0,1] neg_hi:[0,1]
v_pk_add_f32 v[14:15], v[14:15], v[56:57]
v_pk_add_f32 v[56:57], v[50:51], v[58:59] neg_lo:[0,1] neg_hi:[0,1]
v_pk_add_f32 v[50:51], v[50:51], v[58:59]
v_pk_mul_f32 v[58:59], v[56:57], s[62:63] op_sel:[0,0] op_sel_hi:[0,1] neg_lo:[0,0] neg_hi:[0,1]
v_pk_fma_f32 v[58:59], v[56:57], s[62:63], v[58:59] op_sel:[1,1,0] op_sel_hi:[1,0,1] neg_lo:[0,0,0] neg_hi:[0,0,0]
v_pk_add_f32 v[56:57], v[52:53], v[60:61] op_sel:[1,1] op_sel_hi:[0,0] neg_lo:[0,1] neg_hi:[1,0]
v_pk_add_f32 v[52:53], v[52:53], v[60:61]
v_pk_add_f32 v[60:61], v[54:55], v[62:63] neg_lo:[0,1] neg_hi:[0,1]
v_pk_add_f32 v[54:55], v[54:55], v[62:63]
v_pk_mul_f32 v[62:63], v[60:61], s[62:63] op_sel:[0,0] op_sel_hi:[0,1] neg_lo:[0,1] neg_hi:[0,1]
v_pk_fma_f32 v[62:63], v[60:61], s[62:63], v[62:63] op_sel:[1,1,0] op_sel_hi:[1,0,1] neg_lo:[0,0,0] neg_hi:[0,1,0]
v_pk_add_f32 v[60:61], v[40:41], v[48:49] neg_lo:[0,1] neg_hi:[0,1]
v_pk_add_f32 v[40:41], v[40:41], v[48:49]
v_pk_add_f32 v[48:49], v[66:67], v[74:75] neg_lo:[0,1] neg_hi:[0,1]
v_pk_add_f32 v[66:67], v[66:67], v[74:75]
v_pk_mul_f32 v[74:75], v[48:49], s[62:63] op_sel:[0,0] op_sel_hi:[0,1] neg_lo:[0,0] neg_hi:[0,1]
v_pk_fma_f32 v[74:75], v[48:49], s[62:63], v[74:75] op_sel:[1,1,0] op_sel_hi:[1,0,1] neg_lo:[0,0,0] neg_hi:[0,0,0]
v_pk_add_f32 v[48:49], v[68:69], v[76:77] op_sel:[1,1] op_sel_hi:[0,0] neg_lo:[0,1] neg_hi:[1,0]
v_pk_add_f32 v[68:69], v[68:69], v[76:77]
v_pk_add_f32 v[76:77], v[70:71], v[78:79] neg_lo:[0,1] neg_hi:[0,1]
v_pk_add_f32 v[70:71], v[70:71], v[78:79]
v_pk_mul_f32 v[78:79], v[76:77], s[62:63] op_sel:[0,0] op_sel_hi:[0,1] neg_lo:[0,1] neg_hi:[0,1]
v_pk_fma_f32 v[78:79], v[76:77], s[62:63], v[78:79] op_sel:[1,1,0] op_sel_hi:[1,0,1] neg_lo:[0,0,0] neg_hi:[0,1,0]
v_pk_add_f32 v[76:77], v[16:17], v[20:21] neg_lo:[0,1] neg_hi:[0,1]
v_pk_add_f32 v[16:17], v[16:17], v[20:21]
v_pk_add_f32 v[20:21], v[18:19], v[22:23] op_sel:[1,1] op_sel_hi:[0,0] neg_lo:[0,1] neg_hi:[1,0]
v_pk_add_f32 v[18:19], v[18:19], v[22:23]
v_pk_add_f32 v[22:23], v[72:73], v[24:25] neg_lo:[0,1] neg_hi:[0,1]
v_pk_add_f32 v[72:73], v[72:73], v[24:25]
v_pk_add_f32 v[24:25], v[26:27], v[30:31] op_sel:[1,1] op_sel_hi:[0,0] neg_lo:[0,1] neg_hi:[1,0]
v_pk_add_f32 v[26:27], v[26:27], v[30:31]
v_pk_add_f32 v[30:31], v[64:65], v[36:37] neg_lo:[0,1] neg_hi:[0,1]
v_pk_add_f32 v[64:65], v[64:65], v[36:37]
v_pk_add_f32 v[36:37], v[34:35], v[38:39] op_sel:[1,1] op_sel_hi:[0,0] neg_lo:[0,1] neg_hi:[1,0]
v_pk_add_f32 v[34:35], v[34:35], v[38:39]
v_pk_add_f32 v[38:39], v[28:29], v[32:33] neg_lo:[0,1] neg_hi:[0,1]
v_pk_add_f32 v[28:29], v[28:29], v[32:33]
v_pk_add_f32 v[32:33], v[42:43], v[46:47] op_sel:[1,1] op_sel_hi:[0,0] neg_lo:[0,1] neg_hi:[1,0]
v_pk_add_f32 v[42:43], v[42:43], v[46:47]
v_pk_add_f32 v[46:47], v[14:15], v[52:53] neg_lo:[0,1] neg_hi:[0,1]
v_pk_add_f32 v[14:15], v[14:15], v[52:53]
v_pk_add_f32 v[52:53], v[50:51], v[54:55] op_sel:[1,1] op_sel_hi:[0,0] neg_lo:[0,1] neg_hi:[1,0]
v_pk_add_f32 v[50:51], v[50:51], v[54:55]
v_pk_add_f32 v[54:55], v[44:45], v[56:57] neg_lo:[0,1] neg_hi:[0,1]
v_pk_add_f32 v[44:45], v[44:45], v[56:57]
v_pk_add_f32 v[56:57], v[58:59], v[62:63] op_sel:[1,1] op_sel_hi:[0,0] neg_lo:[0,1] neg_hi:[1,0]
v_pk_add_f32 v[58:59], v[58:59], v[62:63]
v_pk_add_f32 v[62:63], v[40:41], v[68:69] neg_lo:[0,1] neg_hi:[0,1]
v_pk_add_f32 v[40:41], v[40:41], v[68:69]
v_pk_add_f32 v[68:69], v[66:67], v[70:71] op_sel:[1,1] op_sel_hi:[0,0] neg_lo:[0,1] neg_hi:[1,0]
v_pk_add_f32 v[66:67], v[66:67], v[70:71]
v_pk_add_f32 v[70:71], v[60:61], v[48:49] neg_lo:[0,1] neg_hi:[0,1]
v_pk_add_f32 v[60:61], v[60:61], v[48:49]
v_pk_add_f32 v[48:49], v[74:75], v[78:79] op_sel:[1,1] op_sel_hi:[0,0] neg_lo:[0,1] neg_hi:[1,0]
v_pk_add_f32 v[74:75], v[74:75], v[78:79]
v_pk_add_f32 v[78:79], v[16:17], v[18:19] neg_lo:[0,1] neg_hi:[0,1]
v_pk_add_f32 v[16:17], v[16:17], v[18:19]
v_pk_add_f32 v[18:19], v[76:77], v[20:21] neg_lo:[0,1] neg_hi:[0,1]
v_pk_add_f32 v[76:77], v[76:77], v[20:21]
v_pk_add_f32 v[20:21], v[72:73], v[26:27] neg_lo:[0,1] neg_hi:[0,1]
v_pk_add_f32 v[72:73], v[72:73], v[26:27]
v_pk_add_f32 v[26:27], v[22:23], v[24:25] neg_lo:[0,1] neg_hi:[0,1]
v_pk_add_f32 v[22:23], v[22:23], v[24:25]
v_pk_add_f32 v[24:25], v[64:65], v[34:35] neg_lo:[0,1] neg_hi:[0,1]
v_pk_add_f32 v[64:65], v[64:65], v[34:35]
v_pk_add_f32 v[34:35], v[30:31], v[36:37] neg_lo:[0,1] neg_hi:[0,1]
v_pk_add_f32 v[30:31], v[30:31], v[36:37]
v_pk_add_f32 v[36:37], v[28:29], v[42:43] neg_lo:[0,1] neg_hi:[0,1]
v_pk_add_f32 v[28:29], v[28:29], v[42:43]
v_pk_add_f32 v[42:43], v[38:39], v[32:33] neg_lo:[0,1] neg_hi:[0,1]
v_pk_add_f32 v[38:39], v[38:39], v[32:33]
v_pk_add_f32 v[32:33], v[14:15], v[50:51] neg_lo:[0,1] neg_hi:[0,1]
v_pk_add_f32 v[14:15], v[14:15], v[50:51]
v_pk_add_f32 v[50:51], v[46:47], v[52:53] neg_lo:[0,1] neg_hi:[0,1]
v_pk_add_f32 v[46:47], v[46:47], v[52:53]
v_pk_add_f32 v[52:53], v[44:45], v[58:59] neg_lo:[0,1] neg_hi:[0,1]
v_pk_add_f32 v[44:45], v[44:45], v[58:59]
v_pk_add_f32 v[58:59], v[54:55], v[56:57] neg_lo:[0,1] neg_hi:[0,1]
v_pk_add_f32 v[54:55], v[54:55], v[56:57]
v_pk_add_f32 v[56:57], v[40:41], v[66:67] neg_lo:[0,1] neg_hi:[0,1]
v_pk_add_f32 v[40:41], v[40:41], v[66:67]
v_pk_add_f32 v[66:67], v[62:63], v[68:69] neg_lo:[0,1] neg_hi:[0,1]
v_pk_add_f32 v[62:63], v[62:63], v[68:69]
v_pk_add_f32 v[68:69], v[60:61], v[74:75] neg_lo:[0,1] neg_hi:[0,1]
v_pk_add_f32 v[60:61], v[60:61], v[74:75]
v_pk_add_f32 v[74:75], v[70:71], v[48:49] neg_lo:[0,1] neg_hi:[0,1]
v_pk_add_f32 v[70:71], v[70:71], v[48:49]
s_mov_b64 exec, s[18:19]
v_pk_add_f32 v[16:17], v[16:17], 0 neg_lo:[1,0] neg_hi:[1,0]
v_pk_mul_f32 v[48:49], v[14:15], s[48:49] op_sel:[0,0] op_sel_hi:[0,1] neg_lo:[0,1] neg_hi:[0,0]
v_pk_fma_f32 v[14:15], v[14:15], s[48:49], v[48:49] op_sel:[1,1,0] op_sel_hi:[1,0,1] neg_lo:[0,1,0] neg_hi:[0,1,0]
v_pk_mul_f32 v[48:49], v[64:65], s[50:51] op_sel:[0,0] op_sel_hi:[0,1] neg_lo:[0,1] neg_hi:[0,0]
v_pk_fma_f32 v[64:65], v[64:65], s[50:51], v[48:49] op_sel:[1,1,0] op_sel_hi:[1,0,1] neg_lo:[0,1,0] neg_hi:[0,1,0]
v_pk_mul_f32 v[48:49], v[40:41], s[52:53] op_sel:[0,0] op_sel_hi:[0,1] neg_lo:[0,1] neg_hi:[0,0]
v_pk_fma_f32 v[40:41], v[40:41], s[52:53], v[48:49] op_sel:[1,1,0] op_sel_hi:[1,0,1] neg_lo:[0,1,0] neg_hi:[0,1,0]
v_pk_mul_f32 v[48:49], v[72:73], s[54:55] op_sel:[0,0] op_sel_hi:[0,1] neg_lo:[0,1] neg_hi:[0,0]
v_pk_fma_f32 v[72:73], v[72:73], s[54:55], v[48:49] op_sel:[1,1,0] op_sel_hi:[1,0,1] neg_lo:[0,1,0] neg_hi:[0,1,0]
v_pk_mul_f32 v[48:49], v[44:45], s[56:57] op_sel:[0,0] op_sel_hi:[0,1] neg_lo:[0,1] neg_hi:[0,0]
v_pk_fma_f32 v[44:45], v[44:45], s[56:57], v[48:49] op_sel:[1,1,0] op_sel_hi:[1,0,1] neg_lo:[0,1,0] neg_hi:[0,1,0]
v_pk_mul_f32 v[48:49], v[28:29], s[58:59] op_sel:[0,0] op_sel_hi:[0,1] neg_lo:[0,1] neg_hi:[0,0]
v_pk_fma_f32 v[28:29], v[28:29], s[58:59], v[48:49] op_sel:[1,1,0] op_sel_hi:[1,0,1] neg_lo:[0,1,0] neg_hi:[0,1,0]
v_pk_mul_f32 v[48:49], v[60:61], s[60:61] op_sel:[0,0] op_sel_hi:[0,1] neg_lo:[0,1] neg_hi:[0,0]
v_pk_fma_f32 v[60:61], v[60:61], s[60:61], v[48:49] op_sel:[1,1,0] op_sel_hi:[1,0,1] neg_lo:[0,1,0] neg_hi:[0,1,0]
v_pk_mul_f32 v[48:49], v[76:77], s[62:63] op_sel:[0,0] op_sel_hi:[0,1] neg_lo:[0,1] neg_hi:[0,0]
v_pk_fma_f32 v[76:77], v[76:77], s[62:63], v[48:49] op_sel:[1,1,0] op_sel_hi:[1,0,1] neg_lo:[0,1,0] neg_hi:[0,1,0]
v_pk_mul_f32 v[48:49], v[46:47], s[60:61] op_sel:[0,1] op_sel_hi:[0,0] neg_lo:[0,1] neg_hi:[0,0]
v_pk_fma_f32 v[46:47], v[46:47], s[60:61], v[48:49] op_sel:[1,0,0] op_sel_hi:[1,1,1] neg_lo:[0,1,0] neg_hi:[0,1,0]
v_pk_mul_f32 v[48:49], v[30:31], s[58:59] op_sel:[0,1] op_sel_hi:[0,0] neg_lo:[0,1] neg_hi:[0,0]
v_pk_fma_f32 v[30:31], v[30:31], s[58:59], v[48:49] op_sel:[1,0,0] op_sel_hi:[1,1,1] neg_lo:[0,1,0] neg_hi:[0,1,0]
v_pk_mul_f32 v[48:49], v[62:63], s[56:57] op_sel:[0,1] op_sel_hi:[0,0] neg_lo:[0,1] neg_hi:[0,0]
v_pk_fma_f32 v[62:63], v[62:63], s[56:57], v[48:49] op_sel:[1,0,0] op_sel_hi:[1,1,1] neg_lo:[0,1,0] neg_hi:[0,1,0]
v_pk_mul_f32 v[48:49], v[22:23], s[54:55] op_sel:[0,1] op_sel_hi:[0,0] neg_lo:[0,1] neg_hi:[0,0]
v_pk_fma_f32 v[22:23], v[22:23], s[54:55], v[48:49] op_sel:[1,0,0] op_sel_hi:[1,1,1] neg_lo:[0,1,0] neg_hi:[0,1,0]
v_pk_mul_f32 v[48:49], v[54:55], s[52:53] op_sel:[0,1] op_sel_hi:[0,0] neg_lo:[0,1] neg_hi:[0,0]
v_pk_fma_f32 v[54:55], v[54:55], s[52:53], v[48:49] op_sel:[1,0,0] op_sel_hi:[1,1,1] neg_lo:[0,1,0] neg_hi:[0,1,0]
v_pk_mul_f32 v[48:49], v[38:39], s[50:51] op_sel:[0,1] op_sel_hi:[0,0] neg_lo:[0,1] neg_hi:[0,0]
v_pk_fma_f32 v[38:39], v[38:39], s[50:51], v[48:49] op_sel:[1,0,0] op_sel_hi:[1,1,1] neg_lo:[0,1,0] neg_hi:[0,1,0]
v_pk_mul_f32 v[48:49], v[70:71], s[48:49] op_sel:[0,1] op_sel_hi:[0,0] neg_lo:[0,1] neg_hi:[0,0]
v_pk_fma_f32 v[70:71], v[70:71], s[48:49], v[48:49] op_sel:[1,0,0] op_sel_hi:[1,1,1] neg_lo:[0,1,0] neg_hi:[0,1,0]
v_pk_add_f32 v[78:79], v[78:79], 0 op_sel:[1,0] op_sel_hi:[0,0] neg_lo:[1,0] neg_hi:[0,0]
v_pk_mul_f32 v[48:49], v[32:33], s[48:49] op_sel:[0,1] op_sel_hi:[0,0] neg_lo:[0,0] neg_hi:[0,0]
v_pk_fma_f32 v[32:33], v[32:33], s[48:49], v[48:49] op_sel:[1,0,0] op_sel_hi:[1,1,1] neg_lo:[0,1,0] neg_hi:[0,0,0]
v_pk_mul_f32 v[48:49], v[24:25], s[50:51] op_sel:[0,1] op_sel_hi:[0,0] neg_lo:[0,0] neg_hi:[0,0]
v_pk_fma_f32 v[24:25], v[24:25], s[50:51], v[48:49] op_sel:[1,0,0] op_sel_hi:[1,1,1] neg_lo:[0,1,0] neg_hi:[0,0,0]
v_pk_mul_f32 v[48:49], v[56:57], s[52:53] op_sel:[0,1] op_sel_hi:[0,0] neg_lo:[0,0] neg_hi:[0,0]
v_pk_fma_f32 v[56:57], v[56:57], s[52:53], v[48:49] op_sel:[1,0,0] op_sel_hi:[1,1,1] neg_lo:[0,1,0] neg_hi:[0,0,0]
v_pk_mul_f32 v[48:49], v[20:21], s[54:55] op_sel:[0,1] op_sel_hi:[0,0] neg_lo:[0,0] neg_hi:[0,0]
v_pk_fma_f32 v[20:21], v[20:21], s[54:55], v[48:49] op_sel:[1,0,0] op_sel_hi:[1,1,1] neg_lo:[0,1,0] neg_hi:[0,0,0]
v_pk_mul_f32 v[48:49], v[52:53], s[56:57] op_sel:[0,1] op_sel_hi:[0,0] neg_lo:[0,0] neg_hi:[0,0]
v_pk_fma_f32 v[52:53], v[52:53], s[56:57], v[48:49] op_sel:[1,0,0] op_sel_hi:[1,1,1] neg_lo:[0,1,0] neg_hi:[0,0,0]
v_pk_mul_f32 v[48:49], v[36:37], s[58:59] op_sel:[0,1] op_sel_hi:[0,0] neg_lo:[0,0] neg_hi:[0,0]
v_pk_fma_f32 v[36:37], v[36:37], s[58:59], v[48:49] op_sel:[1,0,0] op_sel_hi:[1,1,1] neg_lo:[0,1,0] neg_hi:[0,0,0]
v_pk_mul_f32 v[48:49], v[68:69], s[60:61] op_sel:[0,1] op_sel_hi:[0,0] neg_lo:[0,0] neg_hi:[0,0]
v_pk_fma_f32 v[68:69], v[68:69], s[60:61], v[48:49] op_sel:[1,0,0] op_sel_hi:[1,1,1] neg_lo:[0,1,0] neg_hi:[0,0,0]
v_pk_mul_f32 v[48:49], v[18:19], s[62:63] op_sel:[0,0] op_sel_hi:[0,1] neg_lo:[0,0] neg_hi:[0,0]
v_pk_fma_f32 v[18:19], v[18:19], s[62:63], v[48:49] op_sel:[1,1,0] op_sel_hi:[1,0,1] neg_lo:[0,1,0] neg_hi:[0,0,0]
v_pk_mul_f32 v[48:49], v[50:51], s[60:61] op_sel:[0,0] op_sel_hi:[0,1] neg_lo:[0,0] neg_hi:[0,0]
v_pk_fma_f32 v[50:51], v[50:51], s[60:61], v[48:49] op_sel:[1,1,0] op_sel_hi:[1,0,1] neg_lo:[0,1,0] neg_hi:[0,0,0]
v_pk_mul_f32 v[48:49], v[34:35], s[58:59] op_sel:[0,0] op_sel_hi:[0,1] neg_lo:[0,0] neg_hi:[0,0]
v_pk_fma_f32 v[34:35], v[34:35], s[58:59], v[48:49] op_sel:[1,1,0] op_sel_hi:[1,0,1] neg_lo:[0,1,0] neg_hi:[0,0,0]
v_pk_mul_f32 v[48:49], v[66:67], s[56:57] op_sel:[0,0] op_sel_hi:[0,1] neg_lo:[0,0] neg_hi:[0,0]
v_pk_fma_f32 v[66:67], v[66:67], s[56:57], v[48:49] op_sel:[1,1,0] op_sel_hi:[1,0,1] neg_lo:[0,1,0] neg_hi:[0,0,0]
v_pk_mul_f32 v[48:49], v[26:27], s[54:55] op_sel:[0,0] op_sel_hi:[0,1] neg_lo:[0,0] neg_hi:[0,0]
v_pk_fma_f32 v[26:27], v[26:27], s[54:55], v[48:49] op_sel:[1,1,0] op_sel_hi:[1,0,1] neg_lo:[0,1,0] neg_hi:[0,0,0]
v_pk_mul_f32 v[48:49], v[58:59], s[52:53] op_sel:[0,0] op_sel_hi:[0,1] neg_lo:[0,0] neg_hi:[0,0]
v_pk_fma_f32 v[58:59], v[58:59], s[52:53], v[48:49] op_sel:[1,1,0] op_sel_hi:[1,0,1] neg_lo:[0,1,0] neg_hi:[0,0,0]
v_pk_mul_f32 v[48:49], v[42:43], s[50:51] op_sel:[0,0] op_sel_hi:[0,1] neg_lo:[0,0] neg_hi:[0,0]
v_pk_fma_f32 v[42:43], v[42:43], s[50:51], v[48:49] op_sel:[1,1,0] op_sel_hi:[1,0,1] neg_lo:[0,1,0] neg_hi:[0,0,0]
v_pk_mul_f32 v[48:49], v[74:75], s[48:49] op_sel:[0,0] op_sel_hi:[0,1] neg_lo:[0,0] neg_hi:[0,0]
v_pk_fma_f32 v[74:75], v[74:75], s[48:49], v[48:49] op_sel:[1,1,0] op_sel_hi:[1,0,1] neg_lo:[0,1,0] neg_hi:[0,0,0]
s_mov_b64 exec, -1
v_fmac_f32_dpp v16, v16, v9 quad_perm:[1,0,3,2] row_mask:0xf bank_mask:0xf
v_fmac_f32_dpp v17, v17, v9 quad_perm:[1,0,3,2] row_mask:0xf bank_mask:0xf
v_fmac_f32_dpp v14, v14, v9 quad_perm:[1,0,3,2] row_mask:0xf bank_mask:0xf
v_fmac_f32_dpp v15, v15, v9 quad_perm:[1,0,3,2] row_mask:0xf bank_mask:0xf
v_fmac_f32_dpp v64, v64, v9 quad_perm:[1,0,3,2] row_mask:0xf bank_mask:0xf
v_fmac_f32_dpp v65, v65, v9 quad_perm:[1,0,3,2] row_mask:0xf bank_mask:0xf
v_fmac_f32_dpp v40, v40, v9 quad_perm:[1,0,3,2] row_mask:0xf bank_mask:0xf
v_fmac_f32_dpp v41, v41, v9 quad_perm:[1,0,3,2] row_mask:0xf bank_mask:0xf
v_fmac_f32_dpp v72, v72, v9 quad_perm:[1,0,3,2] row_mask:0xf bank_mask:0xf
v_fmac_f32_dpp v73, v73, v9 quad_perm:[1,0,3,2] row_mask:0xf bank_mask:0xf
v_fmac_f32_dpp v44, v44, v9 quad_perm:[1,0,3,2] row_mask:0xf bank_mask:0xf
v_fmac_f32_dpp v45, v45, v9 quad_perm:[1,0,3,2] row_mask:0xf bank_mask:0xf
v_fmac_f32_dpp v28, v28, v9 quad_perm:[1,0,3,2] row_mask:0xf bank_mask:0xf
v_fmac_f32_dpp v29, v29, v9 quad_perm:[1,0,3,2] row_mask:0xf bank_mask:0xf
v_fmac_f32_dpp v60, v60, v9 quad_perm:[1,0,3,2] row_mask:0xf bank_mask:0xf
v_fmac_f32_dpp v61, v61, v9 quad_perm:[1,0,3,2] row_mask:0xf bank_mask:0xf
v_fmac_f32_dpp v76, v76, v9 quad_perm:[1,0,3,2] row_mask:0xf bank_mask:0xf
v_fmac_f32_dpp v77, v77, v9 quad_perm:[1,0,3,2] row_mask:0xf bank_mask:0xf
v_fmac_f32_dpp v46, v46, v9 quad_perm:[1,0,3,2] row_mask:0xf bank_mask:0xf
v_fmac_f32_dpp v47, v47, v9 quad_perm:[1,0,3,2] row_mask:0xf bank_mask:0xf
v_fmac_f32_dpp v30, v30, v9 quad_perm:[1,0,3,2] row_mask:0xf bank_mask:0xf
v_fmac_f32_dpp v31, v31, v9 quad_perm:[1,0,3,2] row_mask:0xf bank_mask:0xf
v_fmac_f32_dpp v62, v62, v9 quad_perm:[1,0,3,2] row_mask:0xf bank_mask:0xf
v_fmac_f32_dpp v63, v63, v9 quad_perm:[1,0,3,2] row_mask:0xf bank_mask:0xf
v_fmac_f32_dpp v22, v22, v9 quad_perm:[1,0,3,2] row_mask:0xf bank_mask:0xf
v_fmac_f32_dpp v23, v23, v9 quad_perm:[1,0,3,2] row_mask:0xf bank_mask:0xf
v_fmac_f32_dpp v54, v54, v9 quad_perm:[1,0,3,2] row_mask:0xf bank_mask:0xf
v_fmac_f32_dpp v55, v55, v9 quad_perm:[1,0,3,2] row_mask:0xf bank_mask:0xf
v_fmac_f32_dpp v38, v38, v9 quad_perm:[1,0,3,2] row_mask:0xf bank_mask:0xf
v_fmac_f32_dpp v39, v39, v9 quad_perm:[1,0,3,2] row_mask:0xf bank_mask:0xf
v_fmac_f32_dpp v70, v70, v9 quad_perm:[1,0,3,2] row_mask:0xf bank_mask:0xf
v_fmac_f32_dpp v71, v71, v9 quad_perm:[1,0,3,2] row_mask:0xf bank_mask:0xf
v_fmac_f32_dpp v78, v78, v9 quad_perm:[1,0,3,2] row_mask:0xf bank_mask:0xf
v_fmac_f32_dpp v79, v79, v9 quad_perm:[1,0,3,2] row_mask:0xf bank_mask:0xf
v_fmac_f32_dpp v32, v32, v9 quad_perm:[1,0,3,2] row_mask:0xf bank_mask:0xf
v_fmac_f32_dpp v33, v33, v9 quad_perm:[1,0,3,2] row_mask:0xf bank_mask:0xf
v_fmac_f32_dpp v24, v24, v9 quad_perm:[1,0,3,2] row_mask:0xf bank_mask:0xf
v_fmac_f32_dpp v25, v25, v9 quad_perm:[1,0,3,2] row_mask:0xf bank_mask:0xf
v_fmac_f32_dpp v56, v56, v9 quad_perm:[1,0,3,2] row_mask:0xf bank_mask:0xf
v_fmac_f32_dpp v57, v57, v9 quad_perm:[1,0,3,2] row_mask:0xf bank_mask:0xf
v_fmac_f32_dpp v20, v20, v9 quad_perm:[1,0,3,2] row_mask:0xf bank_mask:0xf
v_fmac_f32_dpp v21, v21, v9 quad_perm:[1,0,3,2] row_mask:0xf bank_mask:0xf
v_fmac_f32_dpp v52, v52, v9 quad_perm:[1,0,3,2] row_mask:0xf bank_mask:0xf
v_fmac_f32_dpp v53, v53, v9 quad_perm:[1,0,3,2] row_mask:0xf bank_mask:0xf
v_fmac_f32_dpp v36, v36, v9 quad_perm:[1,0,3,2] row_mask:0xf bank_mask:0xf
v_fmac_f32_dpp v37, v37, v9 quad_perm:[1,0,3,2] row_mask:0xf bank_mask:0xf
v_fmac_f32_dpp v68, v68, v9 quad_perm:[1,0,3,2] row_mask:0xf bank_mask:0xf
v_fmac_f32_dpp v69, v69, v9 quad_perm:[1,0,3,2] row_mask:0xf bank_mask:0xf
v_fmac_f32_dpp v18, v18, v9 quad_perm:[1,0,3,2] row_mask:0xf bank_mask:0xf
v_fmac_f32_dpp v19, v19, v9 quad_perm:[1,0,3,2] row_mask:0xf bank_mask:0xf
v_fmac_f32_dpp v50, v50, v9 quad_perm:[1,0,3,2] row_mask:0xf bank_mask:0xf
v_fmac_f32_dpp v51, v51, v9 quad_perm:[1,0,3,2] row_mask:0xf bank_mask:0xf
v_fmac_f32_dpp v34, v34, v9 quad_perm:[1,0,3,2] row_mask:0xf bank_mask:0xf
v_fmac_f32_dpp v35, v35, v9 quad_perm:[1,0,3,2] row_mask:0xf bank_mask:0xf
v_fmac_f32_dpp v66, v66, v9 quad_perm:[1,0,3,2] row_mask:0xf bank_mask:0xf
v_fmac_f32_dpp v67, v67, v9 quad_perm:[1,0,3,2] row_mask:0xf bank_mask:0xf
v_fmac_f32_dpp v26, v26, v9 quad_perm:[1,0,3,2] row_mask:0xf bank_mask:0xf
v_fmac_f32_dpp v27, v27, v9 quad_perm:[1,0,3,2] row_mask:0xf bank_mask:0xf
v_fmac_f32_dpp v58, v58, v9 quad_perm:[1,0,3,2] row_mask:0xf bank_mask:0xf
v_fmac_f32_dpp v59, v59, v9 quad_perm:[1,0,3,2] row_mask:0xf bank_mask:0xf
v_fmac_f32_dpp v42, v42, v9 quad_perm:[1,0,3,2] row_mask:0xf bank_mask:0xf
v_fmac_f32_dpp v43, v43, v9 quad_perm:[1,0,3,2] row_mask:0xf bank_mask:0xf
v_fmac_f32_dpp v74, v74, v9 quad_perm:[1,0,3,2] row_mask:0xf bank_mask:0xf
v_fmac_f32_dpp v75, v75, v9 quad_perm:[1,0,3,2] row_mask:0xf bank_mask:0xf
v_lshlrev_b32 v240, 16, v208
v_and_b32 v241, 0xffff0000, v208
v_pk_mul_f32 v[48:49], v[16:17], v[240:241] op_sel:[0,0] op_sel_hi:[0,1] neg_lo:[0,0] neg_hi:[0,0]
v_pk_fma_f32 v[16:17], v[16:17], v[240:241], v[48:49] op_sel:[1,1,0] op_sel_hi:[1,0,1] neg_lo:[0,1,0] neg_hi:[0,0,0]
v_lshlrev_b32 v240, 16, v209
v_and_b32 v241, 0xffff0000, v209
v_pk_mul_f32 v[48:49], v[14:15], v[240:241] op_sel:[0,0] op_sel_hi:[0,1] neg_lo:[0,0] neg_hi:[0,0]
v_pk_fma_f32 v[14:15], v[14:15], v[240:241], v[48:49] op_sel:[1,1,0] op_sel_hi:[1,0,1] neg_lo:[0,1,0] neg_hi:[0,0,0]
v_lshlrev_b32 v240, 16, v210
v_and_b32 v241, 0xffff0000, v210
v_pk_mul_f32 v[48:49], v[64:65], v[240:241] op_sel:[0,0] op_sel_hi:[0,1] neg_lo:[0,0] neg_hi:[0,0]
v_pk_fma_f32 v[64:65], v[64:65], v[240:241], v[48:49] op_sel:[1,1,0] op_sel_hi:[1,0,1] neg_lo:[0,1,0] neg_hi:[0,0,0]
v_lshlrev_b32 v240, 16, v211
v_and_b32 v241, 0xffff0000, v211
v_pk_mul_f32 v[48:49], v[40:41], v[240:241] op_sel:[0,0] op_sel_hi:[0,1] neg_lo:[0,0] neg_hi:[0,0]
v_pk_fma_f32 v[40:41], v[40:41], v[240:241], v[48:49] op_sel:[1,1,0] op_sel_hi:[1,0,1] neg_lo:[0,1,0] neg_hi:[0,0,0]
v_lshlrev_b32 v240, 16, v212
v_and_b32 v241, 0xffff0000, v212
v_pk_mul_f32 v[48:49], v[72:73], v[240:241] op_sel:[0,0] op_sel_hi:[0,1] neg_lo:[0,0] neg_hi:[0,0]
v_pk_fma_f32 v[72:73], v[72:73], v[240:241], v[48:49] op_sel:[1,1,0] op_sel_hi:[1,0,1] neg_lo:[0,1,0] neg_hi:[0,0,0]
v_lshlrev_b32 v240, 16, v213
v_and_b32 v241, 0xffff0000, v213
v_pk_mul_f32 v[48:49], v[44:45], v[240:241] op_sel:[0,0] op_sel_hi:[0,1] neg_lo:[0,0] neg_hi:[0,0]
v_pk_fma_f32 v[44:45], v[44:45], v[240:241], v[48:49] op_sel:[1,1,0] op_sel_hi:[1,0,1] neg_lo:[0,1,0] neg_hi:[0,0,0]
v_lshlrev_b32 v240, 16, v214
v_and_b32 v241, 0xffff0000, v214
v_pk_mul_f32 v[48:49], v[28:29], v[240:241] op_sel:[0,0] op_sel_hi:[0,1] neg_lo:[0,0] neg_hi:[0,0]
v_pk_fma_f32 v[28:29], v[28:29], v[240:241], v[48:49] op_sel:[1,1,0] op_sel_hi:[1,0,1] neg_lo:[0,1,0] neg_hi:[0,0,0]
v_lshlrev_b32 v240, 16, v215
v_and_b32 v241, 0xffff0000, v215
v_pk_mul_f32 v[48:49], v[60:61], v[240:241] op_sel:[0,0] op_sel_hi:[0,1] neg_lo:[0,0] neg_hi:[0,0]
v_pk_fma_f32 v[60:61], v[60:61], v[240:241], v[48:49] op_sel:[1,1,0] op_sel_hi:[1,0,1] neg_lo:[0,1,0] neg_hi:[0,0,0]
v_lshlrev_b32 v240, 16, v216
v_and_b32 v241, 0xffff0000, v216
v_pk_mul_f32 v[48:49], v[76:77], v[240:241] op_sel:[0,0] op_sel_hi:[0,1] neg_lo:[0,0] neg_hi:[0,0]
v_pk_fma_f32 v[76:77], v[76:77], v[240:241], v[48:49] op_sel:[1,1,0] op_sel_hi:[1,0,1] neg_lo:[0,1,0] neg_hi:[0,0,0]
v_lshlrev_b32 v240, 16, v217
v_and_b32 v241, 0xffff0000, v217
v_pk_mul_f32 v[48:49], v[46:47], v[240:241] op_sel:[0,0] op_sel_hi:[0,1] neg_lo:[0,0] neg_hi:[0,0]
v_pk_fma_f32 v[46:47], v[46:47], v[240:241], v[48:49] op_sel:[1,1,0] op_sel_hi:[1,0,1] neg_lo:[0,1,0] neg_hi:[0,0,0]
v_lshlrev_b32 v240, 16, v218
v_and_b32 v241, 0xffff0000, v218
v_pk_mul_f32 v[48:49], v[30:31], v[240:241] op_sel:[0,0] op_sel_hi:[0,1] neg_lo:[0,0] neg_hi:[0,0]
v_pk_fma_f32 v[30:31], v[30:31], v[240:241], v[48:49] op_sel:[1,1,0] op_sel_hi:[1,0,1] neg_lo:[0,1,0] neg_hi:[0,0,0]
v_lshlrev_b32 v240, 16, v219
v_and_b32 v241, 0xffff0000, v219
v_pk_mul_f32 v[48:49], v[62:63], v[240:241] op_sel:[0,0] op_sel_hi:[0,1] neg_lo:[0,0] neg_hi:[0,0]
v_pk_fma_f32 v[62:63], v[62:63], v[240:241], v[48:49] op_sel:[1,1,0] op_sel_hi:[1,0,1] neg_lo:[0,1,0] neg_hi:[0,0,0]
v_lshlrev_b32 v240, 16, v220
v_and_b32 v241, 0xffff0000, v220
v_pk_mul_f32 v[48:49], v[22:23], v[240:241] op_sel:[0,0] op_sel_hi:[0,1] neg_lo:[0,0] neg_hi:[0,0]
v_pk_fma_f32 v[22:23], v[22:23], v[240:241], v[48:49] op_sel:[1,1,0] op_sel_hi:[1,0,1] neg_lo:[0,1,0] neg_hi:[0,0,0]
v_lshlrev_b32 v240, 16, v221
v_and_b32 v241, 0xffff0000, v221
v_pk_mul_f32 v[48:49], v[54:55], v[240:241] op_sel:[0,0] op_sel_hi:[0,1] neg_lo:[0,0] neg_hi:[0,0]
v_pk_fma_f32 v[54:55], v[54:55], v[240:241], v[48:49] op_sel:[1,1,0] op_sel_hi:[1,0,1] neg_lo:[0,1,0] neg_hi:[0,0,0]
v_lshlrev_b32 v240, 16, v222
v_and_b32 v241, 0xffff0000, v222
v_pk_mul_f32 v[48:49], v[38:39], v[240:241] op_sel:[0,0] op_sel_hi:[0,1] neg_lo:[0,0] neg_hi:[0,0]
v_pk_fma_f32 v[38:39], v[38:39], v[240:241], v[48:49] op_sel:[1,1,0] op_sel_hi:[1,0,1] neg_lo:[0,1,0] neg_hi:[0,0,0]
v_lshlrev_b32 v240, 16, v223
v_and_b32 v241, 0xffff0000, v223
v_pk_mul_f32 v[48:49], v[70:71], v[240:241] op_sel:[0,0] op_sel_hi:[0,1] neg_lo:[0,0] neg_hi:[0,0]
v_pk_fma_f32 v[70:71], v[70:71], v[240:241], v[48:49] op_sel:[1,1,0] op_sel_hi:[1,0,1] neg_lo:[0,1,0] neg_hi:[0,0,0]
v_lshlrev_b32 v240, 16, v224
v_and_b32 v241, 0xffff0000, v224
v_pk_mul_f32 v[48:49], v[78:79], v[240:241] op_sel:[0,0] op_sel_hi:[0,1] neg_lo:[0,0] neg_hi:[0,0]
v_pk_fma_f32 v[78:79], v[78:79], v[240:241], v[48:49] op_sel:[1,1,0] op_sel_hi:[1,0,1] neg_lo:[0,1,0] neg_hi:[0,0,0]
v_lshlrev_b32 v240, 16, v225
v_and_b32 v241, 0xffff0000, v225
v_pk_mul_f32 v[48:49], v[32:33], v[240:241] op_sel:[0,0] op_sel_hi:[0,1] neg_lo:[0,0] neg_hi:[0,0]
v_pk_fma_f32 v[32:33], v[32:33], v[240:241], v[48:49] op_sel:[1,1,0] op_sel_hi:[1,0,1] neg_lo:[0,1,0] neg_hi:[0,0,0]
v_lshlrev_b32 v240, 16, v226
v_and_b32 v241, 0xffff0000, v226
v_pk_mul_f32 v[48:49], v[24:25], v[240:241] op_sel:[0,0] op_sel_hi:[0,1] neg_lo:[0,0] neg_hi:[0,0]
v_pk_fma_f32 v[24:25], v[24:25], v[240:241], v[48:49] op_sel:[1,1,0] op_sel_hi:[1,0,1] neg_lo:[0,1,0] neg_hi:[0,0,0]
v_lshlrev_b32 v240, 16, v227
v_and_b32 v241, 0xffff0000, v227
v_pk_mul_f32 v[48:49], v[56:57], v[240:241] op_sel:[0,0] op_sel_hi:[0,1] neg_lo:[0,0] neg_hi:[0,0]
v_pk_fma_f32 v[56:57], v[56:57], v[240:241], v[48:49] op_sel:[1,1,0] op_sel_hi:[1,0,1] neg_lo:[0,1,0] neg_hi:[0,0,0]
v_lshlrev_b32 v240, 16, v228
v_and_b32 v241, 0xffff0000, v228
v_pk_mul_f32 v[48:49], v[20:21], v[240:241] op_sel:[0,0] op_sel_hi:[0,1] neg_lo:[0,0] neg_hi:[0,0]
v_pk_fma_f32 v[20:21], v[20:21], v[240:241], v[48:49] op_sel:[1,1,0] op_sel_hi:[1,0,1] neg_lo:[0,1,0] neg_hi:[0,0,0]
v_lshlrev_b32 v240, 16, v229
v_and_b32 v241, 0xffff0000, v229
v_pk_mul_f32 v[48:49], v[52:53], v[240:241] op_sel:[0,0] op_sel_hi:[0,1] neg_lo:[0,0] neg_hi:[0,0]
v_pk_fma_f32 v[52:53], v[52:53], v[240:241], v[48:49] op_sel:[1,1,0] op_sel_hi:[1,0,1] neg_lo:[0,1,0] neg_hi:[0,0,0]
v_lshlrev_b32 v240, 16, v230
v_and_b32 v241, 0xffff0000, v230
v_pk_mul_f32 v[48:49], v[36:37], v[240:241] op_sel:[0,0] op_sel_hi:[0,1] neg_lo:[0,0] neg_hi:[0,0]
v_pk_fma_f32 v[36:37], v[36:37], v[240:241], v[48:49] op_sel:[1,1,0] op_sel_hi:[1,0,1] neg_lo:[0,1,0] neg_hi:[0,0,0]
v_lshlrev_b32 v240, 16, v231
v_and_b32 v241, 0xffff0000, v231
v_pk_mul_f32 v[48:49], v[68:69], v[240:241] op_sel:[0,0] op_sel_hi:[0,1] neg_lo:[0,0] neg_hi:[0,0]
v_pk_fma_f32 v[68:69], v[68:69], v[240:241], v[48:49] op_sel:[1,1,0] op_sel_hi:[1,0,1] neg_lo:[0,1,0] neg_hi:[0,0,0]
v_lshlrev_b32 v240, 16, v232
v_and_b32 v241, 0xffff0000, v232
v_pk_mul_f32 v[48:49], v[18:19], v[240:241] op_sel:[0,0] op_sel_hi:[0,1] neg_lo:[0,0] neg_hi:[0,0]
v_pk_fma_f32 v[18:19], v[18:19], v[240:241], v[48:49] op_sel:[1,1,0] op_sel_hi:[1,0,1] neg_lo:[0,1,0] neg_hi:[0,0,0]
v_lshlrev_b32 v240, 16, v233
v_and_b32 v241, 0xffff0000, v233
v_pk_mul_f32 v[48:49], v[50:51], v[240:241] op_sel:[0,0] op_sel_hi:[0,1] neg_lo:[0,0] neg_hi:[0,0]
v_pk_fma_f32 v[50:51], v[50:51], v[240:241], v[48:49] op_sel:[1,1,0] op_sel_hi:[1,0,1] neg_lo:[0,1,0] neg_hi:[0,0,0]
v_lshlrev_b32 v240, 16, v234
v_and_b32 v241, 0xffff0000, v234
v_pk_mul_f32 v[48:49], v[34:35], v[240:241] op_sel:[0,0] op_sel_hi:[0,1] neg_lo:[0,0] neg_hi:[0,0]
v_pk_fma_f32 v[34:35], v[34:35], v[240:241], v[48:49] op_sel:[1,1,0] op_sel_hi:[1,0,1] neg_lo:[0,1,0] neg_hi:[0,0,0]
v_lshlrev_b32 v240, 16, v235
v_and_b32 v241, 0xffff0000, v235
v_pk_mul_f32 v[48:49], v[66:67], v[240:241] op_sel:[0,0] op_sel_hi:[0,1] neg_lo:[0,0] neg_hi:[0,0]
v_pk_fma_f32 v[66:67], v[66:67], v[240:241], v[48:49] op_sel:[1,1,0] op_sel_hi:[1,0,1] neg_lo:[0,1,0] neg_hi:[0,0,0]
v_lshlrev_b32 v240, 16, v236
v_and_b32 v241, 0xffff0000, v236
v_pk_mul_f32 v[48:49], v[26:27], v[240:241] op_sel:[0,0] op_sel_hi:[0,1] neg_lo:[0,0] neg_hi:[0,0]
v_pk_fma_f32 v[26:27], v[26:27], v[240:241], v[48:49] op_sel:[1,1,0] op_sel_hi:[1,0,1] neg_lo:[0,1,0] neg_hi:[0,0,0]
v_lshlrev_b32 v240, 16, v237
v_and_b32 v241, 0xffff0000, v237
v_pk_mul_f32 v[48:49], v[58:59], v[240:241] op_sel:[0,0] op_sel_hi:[0,1] neg_lo:[0,0] neg_hi:[0,0]
v_pk_fma_f32 v[58:59], v[58:59], v[240:241], v[48:49] op_sel:[1,1,0] op_sel_hi:[1,0,1] neg_lo:[0,1,0] neg_hi:[0,0,0]
v_lshlrev_b32 v240, 16, v238
v_and_b32 v241, 0xffff0000, v238
v_pk_mul_f32 v[48:49], v[42:43], v[240:241] op_sel:[0,0] op_sel_hi:[0,1] neg_lo:[0,0] neg_hi:[0,0]
v_pk_fma_f32 v[42:43], v[42:43], v[240:241], v[48:49] op_sel:[1,1,0] op_sel_hi:[1,0,1] neg_lo:[0,1,0] neg_hi:[0,0,0]
v_lshlrev_b32 v240, 16, v239
v_and_b32 v241, 0xffff0000, v239
v_pk_mul_f32 v[48:49], v[74:75], v[240:241] op_sel:[0,0] op_sel_hi:[0,1] neg_lo:[0,0] neg_hi:[0,0]
v_pk_fma_f32 v[74:75], v[74:75], v[240:241], v[48:49] op_sel:[1,1,0] op_sel_hi:[1,0,1] neg_lo:[0,1,0] neg_hi:[0,0,0]
v_fmac_f32_dpp v16, v16, v7 quad_perm:[1,0,3,2] row_mask:0xf bank_mask:0xf
v_fmac_f32_dpp v17, v17, v7 quad_perm:[1,0,3,2] row_mask:0xf bank_mask:0xf
v_fmac_f32_dpp v14, v14, v7 quad_perm:[1,0,3,2] row_mask:0xf bank_mask:0xf
v_fmac_f32_dpp v15, v15, v7 quad_perm:[1,0,3,2] row_mask:0xf bank_mask:0xf
v_fmac_f32_dpp v64, v64, v7 quad_perm:[1,0,3,2] row_mask:0xf bank_mask:0xf
v_fmac_f32_dpp v65, v65, v7 quad_perm:[1,0,3,2] row_mask:0xf bank_mask:0xf
v_fmac_f32_dpp v40, v40, v7 quad_perm:[1,0,3,2] row_mask:0xf bank_mask:0xf
v_fmac_f32_dpp v41, v41, v7 quad_perm:[1,0,3,2] row_mask:0xf bank_mask:0xf
v_fmac_f32_dpp v72, v72, v7 quad_perm:[1,0,3,2] row_mask:0xf bank_mask:0xf
v_fmac_f32_dpp v73, v73, v7 quad_perm:[1,0,3,2] row_mask:0xf bank_mask:0xf
v_fmac_f32_dpp v44, v44, v7 quad_perm:[1,0,3,2] row_mask:0xf bank_mask:0xf
v_fmac_f32_dpp v45, v45, v7 quad_perm:[1,0,3,2] row_mask:0xf bank_mask:0xf
v_fmac_f32_dpp v28, v28, v7 quad_perm:[1,0,3,2] row_mask:0xf bank_mask:0xf
v_fmac_f32_dpp v29, v29, v7 quad_perm:[1,0,3,2] row_mask:0xf bank_mask:0xf
v_fmac_f32_dpp v60, v60, v7 quad_perm:[1,0,3,2] row_mask:0xf bank_mask:0xf
v_fmac_f32_dpp v61, v61, v7 quad_perm:[1,0,3,2] row_mask:0xf bank_mask:0xf
v_fmac_f32_dpp v76, v76, v7 quad_perm:[1,0,3,2] row_mask:0xf bank_mask:0xf
v_fmac_f32_dpp v77, v77, v7 quad_perm:[1,0,3,2] row_mask:0xf bank_mask:0xf
v_fmac_f32_dpp v46, v46, v7 quad_perm:[1,0,3,2] row_mask:0xf bank_mask:0xf
v_fmac_f32_dpp v47, v47, v7 quad_perm:[1,0,3,2] row_mask:0xf bank_mask:0xf
v_fmac_f32_dpp v30, v30, v7 quad_perm:[1,0,3,2] row_mask:0xf bank_mask:0xf
v_fmac_f32_dpp v31, v31, v7 quad_perm:[1,0,3,2] row_mask:0xf bank_mask:0xf
v_fmac_f32_dpp v62, v62, v7 quad_perm:[1,0,3,2] row_mask:0xf bank_mask:0xf
v_fmac_f32_dpp v63, v63, v7 quad_perm:[1,0,3,2] row_mask:0xf bank_mask:0xf
v_fmac_f32_dpp v22, v22, v7 quad_perm:[1,0,3,2] row_mask:0xf bank_mask:0xf
v_fmac_f32_dpp v23, v23, v7 quad_perm:[1,0,3,2] row_mask:0xf bank_mask:0xf
v_fmac_f32_dpp v54, v54, v7 quad_perm:[1,0,3,2] row_mask:0xf bank_mask:0xf
v_fmac_f32_dpp v55, v55, v7 quad_perm:[1,0,3,2] row_mask:0xf bank_mask:0xf
v_fmac_f32_dpp v38, v38, v7 quad_perm:[1,0,3,2] row_mask:0xf bank_mask:0xf
v_fmac_f32_dpp v39, v39, v7 quad_perm:[1,0,3,2] row_mask:0xf bank_mask:0xf
v_fmac_f32_dpp v70, v70, v7 quad_perm:[1,0,3,2] row_mask:0xf bank_mask:0xf
v_fmac_f32_dpp v71, v71, v7 quad_perm:[1,0,3,2] row_mask:0xf bank_mask:0xf
v_fmac_f32_dpp v78, v78, v7 quad_perm:[1,0,3,2] row_mask:0xf bank_mask:0xf
v_fmac_f32_dpp v79, v79, v7 quad_perm:[1,0,3,2] row_mask:0xf bank_mask:0xf
v_fmac_f32_dpp v32, v32, v7 quad_perm:[1,0,3,2] row_mask:0xf bank_mask:0xf
v_fmac_f32_dpp v33, v33, v7 quad_perm:[1,0,3,2] row_mask:0xf bank_mask:0xf
v_fmac_f32_dpp v24, v24, v7 quad_perm:[1,0,3,2] row_mask:0xf bank_mask:0xf
v_fmac_f32_dpp v25, v25, v7 quad_perm:[1,0,3,2] row_mask:0xf bank_mask:0xf
v_fmac_f32_dpp v56, v56, v7 quad_perm:[1,0,3,2] row_mask:0xf bank_mask:0xf
v_fmac_f32_dpp v57, v57, v7 quad_perm:[1,0,3,2] row_mask:0xf bank_mask:0xf
v_fmac_f32_dpp v20, v20, v7 quad_perm:[1,0,3,2] row_mask:0xf bank_mask:0xf
v_fmac_f32_dpp v21, v21, v7 quad_perm:[1,0,3,2] row_mask:0xf bank_mask:0xf
v_fmac_f32_dpp v52, v52, v7 quad_perm:[1,0,3,2] row_mask:0xf bank_mask:0xf
v_fmac_f32_dpp v53, v53, v7 quad_perm:[1,0,3,2] row_mask:0xf bank_mask:0xf
v_fmac_f32_dpp v36, v36, v7 quad_perm:[1,0,3,2] row_mask:0xf bank_mask:0xf
v_fmac_f32_dpp v37, v37, v7 quad_perm:[1,0,3,2] row_mask:0xf bank_mask:0xf
v_fmac_f32_dpp v68, v68, v7 quad_perm:[1,0,3,2] row_mask:0xf bank_mask:0xf
v_fmac_f32_dpp v69, v69, v7 quad_perm:[1,0,3,2] row_mask:0xf bank_mask:0xf
v_fmac_f32_dpp v18, v18, v7 quad_perm:[1,0,3,2] row_mask:0xf bank_mask:0xf
v_fmac_f32_dpp v19, v19, v7 quad_perm:[1,0,3,2] row_mask:0xf bank_mask:0xf
v_fmac_f32_dpp v50, v50, v7 quad_perm:[1,0,3,2] row_mask:0xf bank_mask:0xf
v_fmac_f32_dpp v51, v51, v7 quad_perm:[1,0,3,2] row_mask:0xf bank_mask:0xf
v_fmac_f32_dpp v34, v34, v7 quad_perm:[1,0,3,2] row_mask:0xf bank_mask:0xf
v_fmac_f32_dpp v35, v35, v7 quad_perm:[1,0,3,2] row_mask:0xf bank_mask:0xf
v_fmac_f32_dpp v66, v66, v7 quad_perm:[1,0,3,2] row_mask:0xf bank_mask:0xf
v_fmac_f32_dpp v67, v67, v7 quad_perm:[1,0,3,2] row_mask:0xf bank_mask:0xf
v_fmac_f32_dpp v26, v26, v7 quad_perm:[1,0,3,2] row_mask:0xf bank_mask:0xf
v_fmac_f32_dpp v27, v27, v7 quad_perm:[1,0,3,2] row_mask:0xf bank_mask:0xf
v_fmac_f32_dpp v58, v58, v7 quad_perm:[1,0,3,2] row_mask:0xf bank_mask:0xf
v_fmac_f32_dpp v59, v59, v7 quad_perm:[1,0,3,2] row_mask:0xf bank_mask:0xf
v_fmac_f32_dpp v42, v42, v7 quad_perm:[1,0,3,2] row_mask:0xf bank_mask:0xf
v_fmac_f32_dpp v43, v43, v7 quad_perm:[1,0,3,2] row_mask:0xf bank_mask:0xf
v_fmac_f32_dpp v74, v74, v7 quad_perm:[1,0,3,2] row_mask:0xf bank_mask:0xf
v_fmac_f32_dpp v75, v75, v7 quad_perm:[1,0,3,2] row_mask:0xf bank_mask:0xf
s_mov_b64 exec, s[18:19]
v_pk_add_f32 v[16:17], v[16:17], 0 neg_lo:[1,0] neg_hi:[1,0]
v_pk_mul_f32 v[48:49], v[14:15], s[48:49] op_sel:[0,0] op_sel_hi:[0,1] neg_lo:[0,1] neg_hi:[0,1]
v_pk_fma_f32 v[14:15], v[14:15], s[48:49], v[48:49] op_sel:[1,1,0] op_sel_hi:[1,0,1] neg_lo:[0,0,0] neg_hi:[0,1,0]
v_pk_mul_f32 v[48:49], v[64:65], s[50:51] op_sel:[0,0] op_sel_hi:[0,1] neg_lo:[0,1] neg_hi:[0,1]
v_pk_fma_f32 v[64:65], v[64:65], s[50:51], v[48:49] op_sel:[1,1,0] op_sel_hi:[1,0,1] neg_lo:[0,0,0] neg_hi:[0,1,0]
v_pk_mul_f32 v[48:49], v[40:41], s[52:53] op_sel:[0,0] op_sel_hi:[0,1] neg_lo:[0,1] neg_hi:[0,1]
v_pk_fma_f32 v[40:41], v[40:41], s[52:53], v[48:49] op_sel:[1,1,0] op_sel_hi:[1,0,1] neg_lo:[0,0,0] neg_hi:[0,1,0]
v_pk_mul_f32 v[48:49], v[72:73], s[54:55] op_sel:[0,0] op_sel_hi:[0,1] neg_lo:[0,1] neg_hi:[0,1]
v_pk_fma_f32 v[72:73], v[72:73], s[54:55], v[48:49] op_sel:[1,1,0] op_sel_hi:[1,0,1] neg_lo:[0,0,0] neg_hi:[0,1,0]
v_pk_mul_f32 v[48:49], v[44:45], s[56:57] op_sel:[0,0] op_sel_hi:[0,1] neg_lo:[0,1] neg_hi:[0,1]
v_pk_fma_f32 v[44:45], v[44:45], s[56:57], v[48:49] op_sel:[1,1,0] op_sel_hi:[1,0,1] neg_lo:[0,0,0] neg_hi:[0,1,0]
v_pk_mul_f32 v[48:49], v[28:29], s[58:59] op_sel:[0,0] op_sel_hi:[0,1] neg_lo:[0,1] neg_hi:[0,1]
v_pk_fma_f32 v[28:29], v[28:29], s[58:59], v[48:49] op_sel:[1,1,0] op_sel_hi:[1,0,1] neg_lo:[0,0,0] neg_hi:[0,1,0]
v_pk_mul_f32 v[48:49], v[60:61], s[60:61] op_sel:[0,0] op_sel_hi:[0,1] neg_lo:[0,1] neg_hi:[0,1]
v_pk_fma_f32 v[60:61], v[60:61], s[60:61], v[48:49] op_sel:[1,1,0] op_sel_hi:[1,0,1] neg_lo:[0,0,0] neg_hi:[0,1,0]
v_pk_mul_f32 v[48:49], v[76:77], s[62:63] op_sel:[0,0] op_sel_hi:[0,1] neg_lo:[0,1] neg_hi:[0,1]
v_pk_fma_f32 v[76:77], v[76:77], s[62:63], v[48:49] op_sel:[1,1,0] op_sel_hi:[1,0,1] neg_lo:[0,0,0] neg_hi:[0,1,0]
v_pk_mul_f32 v[48:49], v[46:47], s[60:61] op_sel:[0,1] op_sel_hi:[0,0] neg_lo:[0,1] neg_hi:[0,1]
v_pk_fma_f32 v[46:47], v[46:47], s[60:61], v[48:49] op_sel:[1,0,0] op_sel_hi:[1,1,1] neg_lo:[0,0,0] neg_hi:[0,1,0]
v_pk_mul_f32 v[48:49], v[30:31], s[58:59] op_sel:[0,1] op_sel_hi:[0,0] neg_lo:[0,1] neg_hi:[0,1]
v_pk_fma_f32 v[30:31], v[30:31], s[58:59], v[48:49] op_sel:[1,0,0] op_sel_hi:[1,1,1] neg_lo:[0,0,0] neg_hi:[0,1,0]
v_pk_mul_f32 v[48:49], v[62:63], s[56:57] op_sel:[0,1] op_sel_hi:[0,0] neg_lo:[0,1] neg_hi:[0,1]
v_pk_fma_f32 v[62:63], v[62:63], s[56:57], v[48:49] op_sel:[1,0,0] op_sel_hi:[1,1,1] neg_lo:[0,0,0] neg_hi:[0,1,0]
v_pk_mul_f32 v[48:49], v[22:23], s[54:55] op_sel:[0,1] op_sel_hi:[0,0] neg_lo:[0,1] neg_hi:[0,1]
v_pk_fma_f32 v[22:23], v[22:23], s[54:55], v[48:49] op_sel:[1,0,0] op_sel_hi:[1,1,1] neg_lo:[0,0,0] neg_hi:[0,1,0]
v_pk_mul_f32 v[48:49], v[54:55], s[52:53] op_sel:[0,1] op_sel_hi:[0,0] neg_lo:[0,1] neg_hi:[0,1]
v_pk_fma_f32 v[54:55], v[54:55], s[52:53], v[48:49] op_sel:[1,0,0] op_sel_hi:[1,1,1] neg_lo:[0,0,0] neg_hi:[0,1,0]
v_pk_mul_f32 v[48:49], v[38:39], s[50:51] op_sel:[0,1] op_sel_hi:[0,0] neg_lo:[0,1] neg_hi:[0,1]
v_pk_fma_f32 v[38:39], v[38:39], s[50:51], v[48:49] op_sel:[1,0,0] op_sel_hi:[1,1,1] neg_lo:[0,0,0] neg_hi:[0,1,0]
v_pk_mul_f32 v[48:49], v[70:71], s[48:49] op_sel:[0,1] op_sel_hi:[0,0] neg_lo:[0,1] neg_hi:[0,1]
v_pk_fma_f32 v[70:71], v[70:71], s[48:49], v[48:49] op_sel:[1,0,0] op_sel_hi:[1,1,1] neg_lo:[0,0,0] neg_hi:[0,1,0]
v_pk_add_f32 v[78:79], v[78:79], 0 op_sel:[1,0] op_sel_hi:[0,0] neg_lo:[0,0] neg_hi:[1,0]
v_pk_mul_f32 v[48:49], v[32:33], s[48:49] op_sel:[0,1] op_sel_hi:[0,0] neg_lo:[0,0] neg_hi:[0,1]
v_pk_fma_f32 v[32:33], v[32:33], s[48:49], v[48:49] op_sel:[1,0,0] op_sel_hi:[1,1,1] neg_lo:[0,0,0] neg_hi:[0,0,0]
v_pk_mul_f32 v[48:49], v[24:25], s[50:51] op_sel:[0,1] op_sel_hi:[0,0] neg_lo:[0,0] neg_hi:[0,1]
v_pk_fma_f32 v[24:25], v[24:25], s[50:51], v[48:49] op_sel:[1,0,0] op_sel_hi:[1,1,1] neg_lo:[0,0,0] neg_hi:[0,0,0]
v_pk_mul_f32 v[48:49], v[56:57], s[52:53] op_sel:[0,1] op_sel_hi:[0,0] neg_lo:[0,0] neg_hi:[0,1]
v_pk_fma_f32 v[56:57], v[56:57], s[52:53], v[48:49] op_sel:[1,0,0] op_sel_hi:[1,1,1] neg_lo:[0,0,0] neg_hi:[0,0,0]
v_pk_mul_f32 v[48:49], v[20:21], s[54:55] op_sel:[0,1] op_sel_hi:[0,0] neg_lo:[0,0] neg_hi:[0,1]
v_pk_fma_f32 v[20:21], v[20:21], s[54:55], v[48:49] op_sel:[1,0,0] op_sel_hi:[1,1,1] neg_lo:[0,0,0] neg_hi:[0,0,0]
v_pk_mul_f32 v[48:49], v[52:53], s[56:57] op_sel:[0,1] op_sel_hi:[0,0] neg_lo:[0,0] neg_hi:[0,1]
v_pk_fma_f32 v[52:53], v[52:53], s[56:57], v[48:49] op_sel:[1,0,0] op_sel_hi:[1,1,1] neg_lo:[0,0,0] neg_hi:[0,0,0]
v_pk_mul_f32 v[48:49], v[36:37], s[58:59] op_sel:[0,1] op_sel_hi:[0,0] neg_lo:[0,0] neg_hi:[0,1]
v_pk_fma_f32 v[36:37], v[36:37], s[58:59], v[48:49] op_sel:[1,0,0] op_sel_hi:[1,1,1] neg_lo:[0,0,0] neg_hi:[0,0,0]
v_pk_mul_f32 v[48:49], v[68:69], s[60:61] op_sel:[0,1] op_sel_hi:[0,0] neg_lo:[0,0] neg_hi:[0,1]
v_pk_fma_f32 v[68:69], v[68:69], s[60:61], v[48:49] op_sel:[1,0,0] op_sel_hi:[1,1,1] neg_lo:[0,0,0] neg_hi:[0,0,0]
v_pk_mul_f32 v[48:49], v[18:19], s[62:63] op_sel:[0,0] op_sel_hi:[0,1] neg_lo:[0,0] neg_hi:[0,1]
v_pk_fma_f32 v[18:19], v[18:19], s[62:63], v[48:49] op_sel:[1,1,0] op_sel_hi:[1,0,1] neg_lo:[0,0,0] neg_hi:[0,0,0]
v_pk_mul_f32 v[48:49], v[50:51], s[60:61] op_sel:[0,0] op_sel_hi:[0,1] neg_lo:[0,0] neg_hi:[0,1]
v_pk_fma_f32 v[50:51], v[50:51], s[60:61], v[48:49] op_sel:[1,1,0] op_sel_hi:[1,0,1] neg_lo:[0,0,0] neg_hi:[0,0,0]
v_pk_mul_f32 v[48:49], v[34:35], s[58:59] op_sel:[0,0] op_sel_hi:[0,1] neg_lo:[0,0] neg_hi:[0,1]
v_pk_fma_f32 v[34:35], v[34:35], s[58:59], v[48:49] op_sel:[1,1,0] op_sel_hi:[1,0,1] neg_lo:[0,0,0] neg_hi:[0,0,0]
v_pk_mul_f32 v[48:49], v[66:67], s[56:57] op_sel:[0,0] op_sel_hi:[0,1] neg_lo:[0,0] neg_hi:[0,1]
v_pk_fma_f32 v[66:67], v[66:67], s[56:57], v[48:49] op_sel:[1,1,0] op_sel_hi:[1,0,1] neg_lo:[0,0,0] neg_hi:[0,0,0]
v_pk_mul_f32 v[48:49], v[26:27], s[54:55] op_sel:[0,0] op_sel_hi:[0,1] neg_lo:[0,0] neg_hi:[0,1]
v_pk_fma_f32 v[26:27], v[26:27], s[54:55], v[48:49] op_sel:[1,1,0] op_sel_hi:[1,0,1] neg_lo:[0,0,0] neg_hi:[0,0,0]
v_pk_mul_f32 v[48:49], v[58:59], s[52:53] op_sel:[0,0] op_sel_hi:[0,1] neg_lo:[0,0] neg_hi:[0,1]
v_pk_fma_f32 v[58:59], v[58:59], s[52:53], v[48:49] op_sel:[1,1,0] op_sel_hi:[1,0,1] neg_lo:[0,0,0] neg_hi:[0,0,0]
v_pk_mul_f32 v[48:49], v[42:43], s[50:51] op_sel:[0,0] op_sel_hi:[0,1] neg_lo:[0,0] neg_hi:[0,1]
v_pk_fma_f32 v[42:43], v[42:43], s[50:51], v[48:49] op_sel:[1,1,0] op_sel_hi:[1,0,1] neg_lo:[0,0,0] neg_hi:[0,0,0]
v_pk_mul_f32 v[48:49], v[74:75], s[48:49] op_sel:[0,0] op_sel_hi:[0,1] neg_lo:[0,0] neg_hi:[0,1]
v_pk_fma_f32 v[74:75], v[74:75], s[48:49], v[48:49] op_sel:[1,1,0] op_sel_hi:[1,0,1] neg_lo:[0,0,0] neg_hi:[0,0,0]
s_mov_b64 exec, -1
v_pk_add_f32 v[48:49], v[16:17], v[78:79] neg_lo:[0,1] neg_hi:[0,1]
v_pk_add_f32 v[16:17], v[16:17], v[78:79]
v_pk_add_f32 v[78:79], v[14:15], v[32:33] neg_lo:[0,1] neg_hi:[0,1]
v_pk_add_f32 v[14:15], v[14:15], v[32:33]
v_pk_mul_f32 v[32:33], v[78:79], s[50:51] op_sel:[0,0] op_sel_hi:[0,1] neg_lo:[0,0] neg_hi:[0,0]
v_pk_fma_f32 v[32:33], v[78:79], s[50:51], v[32:33] op_sel:[1,1,0] op_sel_hi:[1,0,1] neg_lo:[0,1,0] neg_hi:[0,0,0]
v_pk_add_f32 v[78:79], v[64:65], v[24:25] neg_lo:[0,1] neg_hi:[0,1]
v_pk_add_f32 v[64:65], v[64:65], v[24:25]
v_pk_mul_f32 v[24:25], v[78:79], s[54:55] op_sel:[0,0] op_sel_hi:[0,1] neg_lo:[0,0] neg_hi:[0,0]
v_pk_fma_f32 v[24:25], v[78:79], s[54:55], v[24:25] op_sel:[1,1,0] op_sel_hi:[1,0,1] neg_lo:[0,1,0] neg_hi:[0,0,0]
v_pk_add_f32 v[78:79], v[40:41], v[56:57] neg_lo:[0,1] neg_hi:[0,1]
v_pk_add_f32 v[40:41], v[40:41], v[56:57]
v_pk_mul_f32 v[56:57], v[78:79], s[58:59] op_sel:[0,0] op_sel_hi:[0,1] neg_lo:[0,0] neg_hi:[0,0]
v_pk_fma_f32 v[56:57], v[78:79], s[58:59], v[56:57] op_sel:[1,1,0] op_sel_hi:[1,0,1] neg_lo:[0,1,0] neg_hi:[0,0,0]
v_pk_add_f32 v[78:79], v[72:73], v[20:21] neg_lo:[0,1] neg_hi:[0,1]
v_pk_add_f32 v[72:73], v[72:73], v[20:21]
v_pk_mul_f32 v[20:21], v[78:79], s[62:63] op_sel:[0,0] op_sel_hi:[0,1] neg_lo:[0,0] neg_hi:[0,0]
v_pk_fma_f32 v[20:21], v[78:79], s[62:63], v[20:21] op_sel:[1,1,0] op_sel_hi:[1,0,1] neg_lo:[0,1,0] neg_hi:[0,0,0]
v_pk_add_f32 v[78:79], v[44:45], v[52:53] neg_lo:[0,1] neg_hi:[0,1]
v_pk_add_f32 v[44:45], v[44:45], v[52:53]
v_pk_mul_f32 v[52:53], v[78:79], s[58:59] op_sel:[0,1] op_sel_hi:[0,0] neg_lo:[0,0] neg_hi:[0,0]
v_pk_fma_f32 v[52:53], v[78:79], s[58:59], v[52:53] op_sel:[1,0,0] op_sel_hi:[1,1,1] neg_lo:[0,1,0] neg_hi:[0,0,0]
v_pk_add_f32 v[78:79], v[28:29], v[36:37] neg_lo:[0,1] neg_hi:[0,1]
v_pk_add_f32 v[28:29], v[28:29], v[36:37]
v_pk_mul_f32 v[36:37], v[78:79], s[54:55] op_sel:[0,1] op_sel_hi:[0,0] neg_lo:[0,0] neg_hi:[0,0]
v_pk_fma_f32 v[36:37], v[78:79], s[54:55], v[36:37] op_sel:[1,0,0] op_sel_hi:[1,1,1] neg_lo:[0,1,0] neg_hi:[0,0,0]
v_pk_add_f32 v[78:79], v[60:61], v[68:69] neg_lo:[0,1] neg_hi:[0,1]
v_pk_add_f32 v[60:61], v[60:61], v[68:69]
v_pk_mul_f32 v[68:69], v[78:79], s[50:51] op_sel:[0,1] op_sel_hi:[0,0] neg_lo:[0,0] neg_hi:[0,0]
v_pk_fma_f32 v[68:69], v[78:79], s[50:51], v[68:69] op_sel:[1,0,0] op_sel_hi:[1,1,1] neg_lo:[0,1,0] neg_hi:[0,0,0]
v_pk_add_f32 v[78:79], v[76:77], v[18:19] op_sel:[1,1] op_sel_hi:[0,0] neg_lo:[1,0] neg_hi:[0,1]
v_pk_add_f32 v[76:77], v[76:77], v[18:19]
v_pk_add_f32 v[18:19], v[46:47], v[50:51] neg_lo:[0,1] neg_hi:[0,1]
v_pk_add_f32 v[46:47], v[46:47], v[50:51]
v_pk_mul_f32 v[50:51], v[18:19], s[50:51] op_sel:[0,1] op_sel_hi:[0,0] neg_lo:[0,1] neg_hi:[0,0]
v_pk_fma_f32 v[50:51], v[18:19], s[50:51], v[50:51] op_sel:[1,0,0] op_sel_hi:[1,1,1] neg_lo:[0,1,0] neg_hi:[0,1,0]
v_pk_add_f32 v[18:19], v[30:31], v[34:35] neg_lo:[0,1] neg_hi:[0,1]
v_pk_add_f32 v[30:31], v[30:31], v[34:35]
v_pk_mul_f32 v[34:35], v[18:19], s[54:55] op_sel:[0,1] op_sel_hi:[0,0] neg_lo:[0,1] neg_hi:[0,0]
v_pk_fma_f32 v[34:35], v[18:19], s[54:55], v[34:35] op_sel:[1,0,0] op_sel_hi:[1,1,1] neg_lo:[0,1,0] neg_hi:[0,1,0]
v_pk_add_f32 v[18:19], v[62:63], v[66:67] neg_lo:[0,1] neg_hi:[0,1]
v_pk_add_f32 v[62:63], v[62:63], v[66:67]
v_pk_mul_f32 v[66:67], v[18:19], s[58:59] op_sel:[0,1] op_sel_hi:[0,0] neg_lo:[0,1] neg_hi:[0,0]
v_pk_fma_f32 v[66:67], v[18:19], s[58:59], v[66:67] op_sel:[1,0,0] op_sel_hi:[1,1,1] neg_lo:[0,1,0] neg_hi:[0,1,0]
v_pk_add_f32 v[18:19], v[22:23], v[26:27] neg_lo:[0,1] neg_hi:[0,1]
v_pk_add_f32 v[22:23], v[22:23], v[26:27]
v_pk_mul_f32 v[26:27], v[18:19], s[62:63] op_sel:[0,0] op_sel_hi:[0,1] neg_lo:[0,1] neg_hi:[0,0]
v_pk_fma_f32 v[26:27], v[18:19], s[62:63], v[26:27] op_sel:[1,1,0] op_sel_hi:[1,0,1] neg_lo:[0,1,0] neg_hi:[0,1,0]
v_pk_add_f32 v[18:19], v[54:55], v[58:59] neg_lo:[0,1] neg_hi:[0,1]
v_pk_add_f32 v[54:55], v[54:55], v[58:59]
v_pk_mul_f32 v[58:59], v[18:19], s[58:59] op_sel:[0,0] op_sel_hi:[0,1] neg_lo:[0,1] neg_hi:[0,0]
v_pk_fma_f32 v[58:59], v[18:19], s[58:59], v[58:59] op_sel:[1,1,0] op_sel_hi:[1,0,1] neg_lo:[0,1,0] neg_hi:[0,1,0]
v_pk_add_f32 v[18:19], v[38:39], v[42:43] neg_lo:[0,1] neg_hi:[0,1]
v_pk_add_f32 v[38:39], v[38:39], v[42:43]
v_pk_mul_f32 v[42:43], v[18:19], s[54:55] op_sel:[0,0] op_sel_hi:[0,1] neg_lo:[0,1] neg_hi:[0,0]
v_pk_fma_f32 v[42:43], v[18:19], s[54:55], v[42:43] op_sel:[1,1,0] op_sel_hi:[1,0,1] neg_lo:[0,1,0] neg_hi:[0,1,0]
v_pk_add_f32 v[18:19], v[70:71], v[74:75] neg_lo:[0,1] neg_hi:[0,1]
v_pk_add_f32 v[70:71], v[70:71], v[74:75]
v_pk_mul_f32 v[74:75], v[18:19], s[50:51] op_sel:[0,0] op_sel_hi:[0,1] neg_lo:[0,1] neg_hi:[0,0]
v_pk_fma_f32 v[74:75], v[18:19], s[50:51], v[74:75] op_sel:[1,1,0] op_sel_hi:[1,0,1] neg_lo:[0,1,0] neg_hi:[0,1,0]
v_pk_add_f32 v[18:19], v[16:17], v[76:77] neg_lo:[0,1] neg_hi:[0,1]
v_pk_add_f32 v[16:17], v[16:17], v[76:77]
v_pk_add_f32 v[76:77], v[14:15], v[46:47] neg_lo:[0,1] neg_hi:[0,1]
v_pk_add_f32 v[14:15], v[14:15], v[46:47]
v_pk_mul_f32 v[46:47], v[76:77], s[54:55] op_sel:[0,0] op_sel_hi:[0,1] neg_lo:[0,0] neg_hi:[0,0]
v_pk_fma_f32 v[46:47], v[76:77], s[54:55], v[46:47] op_sel:[1,1,0] op_sel_hi:[1,0,1] neg_lo:[0,1,0] neg_hi:[0,0,0]
v_pk_add_f32 v[76:77], v[64:65], v[30:31] neg_lo:[0,1] neg_hi:[0,1]
v_pk_add_f32 v[64:65], v[64:65], v[30:31]
v_pk_mul_f32 v[30:31], v[76:77], s[62:63] op_sel:[0,0] op_sel_hi:[0,1] neg_lo:[0,0] neg_hi:[0,0]
v_pk_fma_f32 v[30:31], v[76:77], s[62:63], v[30:31] op_sel:[1,1,0] op_sel_hi:[1,0,1] neg_lo:[0,1,0] neg_hi:[0,0,0]
v_pk_add_f32 v[76:77], v[40:41], v[62:63] neg_lo:[0,1] neg_hi:[0,1]
v_pk_add_f32 v[40:41], v[40:41], v[62:63]
v_pk_mul_f32 v[62:63], v[76:77], s[54:55] op_sel:[0,1] op_sel_hi:[0,0] neg_lo:[0,0] neg_hi:[0,0]
v_pk_fma_f32 v[62:63], v[76:77], s[54:55], v[62:63] op_sel:[1,0,0] op_sel_hi:[1,1,1] neg_lo:[0,1,0] neg_hi:[0,0,0]
v_pk_add_f32 v[76:77], v[72:73], v[22:23] op_sel:[1,1] op_sel_hi:[0,0] neg_lo:[1,0] neg_hi:[0,1]
v_pk_add_f32 v[72:73], v[72:73], v[22:23]
v_pk_add_f32 v[22:23], v[44:45], v[54:55] neg_lo:[0,1] neg_hi:[0,1]
v_pk_add_f32 v[44:45], v[44:45], v[54:55]
v_pk_mul_f32 v[54:55], v[22:23], s[54:55] op_sel:[0,1] op_sel_hi:[0,0] neg_lo:[0,1] neg_hi:[0,0]
v_pk_fma_f32 v[54:55], v[22:23], s[54:55], v[54:55] op_sel:[1,0,0] op_sel_hi:[1,1,1] neg_lo:[0,1,0] neg_hi:[0,1,0]
v_pk_add_f32 v[22:23], v[28:29], v[38:39] neg_lo:[0,1] neg_hi:[0,1]
v_pk_add_f32 v[28:29], v[28:29], v[38:39]
v_pk_mul_f32 v[38:39], v[22:23], s[62:63] op_sel:[0,0] op_sel_hi:[0,1] neg_lo:[0,1] neg_hi:[0,0]
v_pk_fma_f32 v[38:39], v[22:23], s[62:63], v[38:39] op_sel:[1,1,0] op_sel_hi:[1,0,1] neg_lo:[0,1,0] neg_hi:[0,1,0]
v_pk_add_f32 v[22:23], v[60:61], v[70:71] neg_lo:[0,1] neg_hi:[0,1]
v_pk_add_f32 v[60:61], v[60:61], v[70:71]
v_pk_mul_f32 v[70:71], v[22:23], s[54:55] op_sel:[0,0] op_sel_hi:[0,1] neg_lo:[0,1] neg_hi:[0,0]
v_pk_fma_f32 v[70:71], v[22:23], s[54:55], v[70:71] op_sel:[1,1,0] op_sel_hi:[1,0,1] neg_lo:[0,1,0] neg_hi:[0,1,0]
v_pk_add_f32 v[22:23], v[48:49], v[78:79] neg_lo:[0,1] neg_hi:[0,1]
v_pk_add_f32 v[48:49], v[48:49], v[78:79]
v_pk_add_f32 v[78:79], v[32:33], v[50:51] neg_lo:[0,1] neg_hi:[0,1]
v_pk_add_f32 v[32:33], v[32:33], v[50:51]
v_pk_mul_f32 v[50:51], v[78:79], s[54:55] op_sel:[0,0] op_sel_hi:[0,1] neg_lo:[0,0] neg_hi:[0,0]
v_pk_fma_f32 v[50:51], v[78:79], s[54:55], v[50:51] op_sel:[1,1,0] op_sel_hi:[1,0,1] neg_lo:[0,1,0] neg_hi:[0,0,0]
v_pk_add_f32 v[78:79], v[24:25], v[34:35] neg_lo:[0,1] neg_hi:[0,1]
v_pk_add_f32 v[24:25], v[24:25], v[34:35]
v_pk_mul_f32 v[34:35], v[78:79], s[62:63] op_sel:[0,0] op_sel_hi:[0,1] neg_lo:[0,0] neg_hi:[0,0]
v_pk_fma_f32 v[34:35], v[78:79], s[62:63], v[34:35] op_sel:[1,1,0] op_sel_hi:[1,0,1] neg_lo:[0,1,0] neg_hi:[0,0,0]
v_pk_add_f32 v[78:79], v[56:57], v[66:67] neg_lo:[0,1] neg_hi:[0,1]
v_pk_add_f32 v[56:57], v[56:57], v[66:67]
v_pk_mul_f32 v[66:67], v[78:79], s[54:55] op_sel:[0,1] op_sel_hi:[0,0] neg_lo:[0,0] neg_hi:[0,0]
v_pk_fma_f32 v[66:67], v[78:79], s[54:55], v[66:67] op_sel:[1,0,0] op_sel_hi:[1,1,1] neg_lo:[0,1,0] neg_hi:[0,0,0]
v_pk_add_f32 v[78:79], v[20:21], v[26:27] op_sel:[1,1] op_sel_hi:[0,0] neg_lo:[1,0] neg_hi:[0,1]
v_pk_add_f32 v[20:21], v[20:21], v[26:27]
v_pk_add_f32 v[26:27], v[52:53], v[58:59] neg_lo:[0,1] neg_hi:[0,1]
v_pk_add_f32 v[52:53], v[52:53], v[58:59]
v_pk_mul_f32 v[58:59], v[26:27], s[54:55] op_sel:[0,1] op_sel_hi:[0,0] neg_lo:[0,1] neg_hi:[0,0]
v_pk_fma_f32 v[58:59], v[26:27], s[54:55], v[58:59] op_sel:[1,0,0] op_sel_hi:[1,1,1] neg_lo:[0,1,0] neg_hi:[0,1,0]
v_pk_add_f32 v[26:27], v[36:37], v[42:43] neg_lo:[0,1] neg_hi:[0,1]
v_pk_add_f32 v[36:37], v[36:37], v[42:43]
v_pk_mul_f32 v[42:43], v[26:27], s[62:63] op_sel:[0,0] op_sel_hi:[0,1] neg_lo:[0,1] neg_hi:[0,0]
v_pk_fma_f32 v[42:43], v[26:27], s[62:63], v[42:43] op_sel:[1,1,0] op_sel_hi:[1,0,1] neg_lo:[0,1,0] neg_hi:[0,1,0]
v_pk_add_f32 v[26:27], v[68:69], v[74:75] neg_lo:[0,1] neg_hi:[0,1]
v_pk_add_f32 v[68:69], v[68:69], v[74:75]
v_pk_mul_f32 v[74:75], v[26:27], s[54:55] op_sel:[0,0] op_sel_hi:[0,1] neg_lo:[0,1] neg_hi:[0,0]
v_pk_fma_f32 v[74:75], v[26:27], s[54:55], v[74:75] op_sel:[1,1,0] op_sel_hi:[1,0,1] neg_lo:[0,1,0] neg_hi:[0,1,0]
v_pk_add_f32 v[26:27], v[16:17], v[72:73] neg_lo:[0,1] neg_hi:[0,1]
v_pk_add_f32 v[16:17], v[16:17], v[72:73]
v_pk_add_f32 v[72:73], v[14:15], v[44:45] neg_lo:[0,1] neg_hi:[0,1]
v_pk_add_f32 v[14:15], v[14:15], v[44:45]
v_pk_mul_f32 v[44:45], v[72:73], s[62:63] op_sel:[0,0] op_sel_hi:[0,1] neg_lo:[0,0] neg_hi:[0,0]
v_pk_fma_f32 v[44:45], v[72:73], s[62:63], v[44:45] op_sel:[1,1,0] op_sel_hi:[1,0,1] neg_lo:[0,1,0] neg_hi:[0,0,0]
v_pk_add_f32 v[72:73], v[64:65], v[28:29] op_sel:[1,1] op_sel_hi:[0,0] neg_lo:[1,0] neg_hi:[0,1]
v_pk_add_f32 v[64:65], v[64:65], v[28:29]
v_pk_add_f32 v[28:29], v[40:41], v[60:61] neg_lo:[0,1] neg_hi:[0,1]
v_pk_add_f32 v[40:41], v[40:41], v[60:61]
v_pk_mul_f32 v[60:61], v[28:29], s[62:63] op_sel:[0,0] op_sel_hi:[0,1] neg_lo:[0,1] neg_hi:[0,0]
v_pk_fma_f32 v[60:61], v[28:29], s[62:63], v[60:61] op_sel:[1,1,0] op_sel_hi:[1,0,1] neg_lo:[0,1,0] neg_hi:[0,1,0]
v_pk_add_f32 v[28:29], v[18:19], v[76:77] neg_lo:[0,1] neg_hi:[0,1]
v_pk_add_f32 v[18:19], v[18:19], v[76:77]
v_pk_add_f32 v[76:77], v[46:47], v[54:55] neg_lo:[0,1] neg_hi:[0,1]
v_pk_add_f32 v[46:47], v[46:47], v[54:55]
v_pk_mul_f32 v[54:55], v[76:77], s[62:63] op_sel:[0,0] op_sel_hi:[0,1] neg_lo:[0,0] neg_hi:[0,0]
v_pk_fma_f32 v[54:55], v[76:77], s[62:63], v[54:55] op_sel:[1,1,0] op_sel_hi:[1,0,1] neg_lo:[0,1,0] neg_hi:[0,0,0]
v_pk_add_f32 v[76:77], v[30:31], v[38:39] op_sel:[1,1] op_sel_hi:[0,0] neg_lo:[1,0] neg_hi:[0,1]
v_pk_add_f32 v[30:31], v[30:31], v[38:39]
v_pk_add_f32 v[38:39], v[62:63], v[70:71] neg_lo:[0,1] neg_hi:[0,1]
v_pk_add_f32 v[62:63], v[62:63], v[70:71]
v_pk_mul_f32 v[70:71], v[38:39], s[62:63] op_sel:[0,0] op_sel_hi:[0,1] neg_lo:[0,1] neg_hi:[0,0]
v_pk_fma_f32 v[70:71], v[38:39], s[62:63], v[70:71] op_sel:[1,1,0] op_sel_hi:[1,0,1] neg_lo:[0,1,0] neg_hi:[0,1,0]
v_pk_add_f32 v[38:39], v[48:49], v[20:21] neg_lo:[0,1] neg_hi:[0,1]
v_pk_add_f32 v[48:49], v[48:49], v[20:21]
v_pk_add_f32 v[20:21], v[32:33], v[52:53] neg_lo:[0,1] neg_hi:[0,1]
v_pk_add_f32 v[32:33], v[32:33], v[52:53]
v_pk_mul_f32 v[52:53], v[20:21], s[62:63] op_sel:[0,0] op_sel_hi:[0,1] neg_lo:[0,0] neg_hi:[0,0]
v_pk_fma_f32 v[52:53], v[20:21], s[62:63], v[52:53] op_sel:[1,1,0] op_sel_hi:[1,0,1] neg_lo:[0,1,0] neg_hi:[0,0,0]
v_pk_add_f32 v[20:21], v[24:25], v[36:37] op_sel:[1,1] op_sel_hi:[0,0] neg_lo:[1,0] neg_hi:[0,1]
v_pk_add_f32 v[24:25], v[24:25], v[36:37]
v_pk_add_f32 v[36:37], v[56:57], v[68:69] neg_lo:[0,1] neg_hi:[0,1]
v_pk_add_f32 v[56:57], v[56:57], v[68:69]
v_pk_mul_f32 v[68:69], v[36:37], s[62:63] op_sel:[0,0] op_sel_hi:[0,1] neg_lo:[0,1] neg_hi:[0,0]
v_pk_fma_f32 v[68:69], v[36:37], s[62:63], v[68:69] op_sel:[1,1,0] op_sel_hi:[1,0,1] neg_lo:[0,1,0] neg_hi:[0,1,0]
v_pk_add_f32 v[36:37], v[22:23], v[78:79] neg_lo:[0,1] neg_hi:[0,1]
v_pk_add_f32 v[22:23], v[22:23], v[78:79]
v_pk_add_f32 v[78:79], v[50:51], v[58:59] neg_lo:[0,1] neg_hi:[0,1]
v_pk_add_f32 v[50:51], v[50:51], v[58:59]
v_pk_mul_f32 v[58:59], v[78:79], s[62:63] op_sel:[0,0] op_sel_hi:[0,1] neg_lo:[0,0] neg_hi:[0,0]
v_pk_fma_f32 v[58:59], v[78:79], s[62:63], v[58:59] op_sel:[1,1,0] op_sel_hi:[1,0,1] neg_lo:[0,1,0] neg_hi:[0,0,0]
v_pk_add_f32 v[78:79], v[34:35], v[42:43] op_sel:[1,1] op_sel_hi:[0,0] neg_lo:[1,0] neg_hi:[0,1]
v_pk_add_f32 v[34:35], v[34:35], v[42:43]
v_pk_add_f32 v[42:43], v[66:67], v[74:75] neg_lo:[0,1] neg_hi:[0,1]
v_pk_add_f32 v[66:67], v[66:67], v[74:75]
v_pk_mul_f32 v[74:75], v[42:43], s[62:63] op_sel:[0,0] op_sel_hi:[0,1] neg_lo:[0,1] neg_hi:[0,0]
v_pk_fma_f32 v[74:75], v[42:43], s[62:63], v[74:75] op_sel:[1,1,0] op_sel_hi:[1,0,1] neg_lo:[0,1,0] neg_hi:[0,1,0]
v_pk_add_f32 v[42:43], v[16:17], v[64:65] neg_lo:[0,1] neg_hi:[0,1]
v_pk_add_f32 v[16:17], v[16:17], v[64:65]
v_pk_add_f32 v[64:65], v[14:15], v[40:41] op_sel:[1,1] op_sel_hi:[0,0] neg_lo:[1,0] neg_hi:[0,1]
v_pk_add_f32 v[14:15], v[14:15], v[40:41]
v_pk_add_f32 v[40:41], v[26:27], v[72:73] neg_lo:[0,1] neg_hi:[0,1]
v_pk_add_f32 v[26:27], v[26:27], v[72:73]
v_pk_add_f32 v[72:73], v[44:45], v[60:61] op_sel:[1,1] op_sel_hi:[0,0] neg_lo:[1,0] neg_hi:[0,1]
v_pk_add_f32 v[44:45], v[44:45], v[60:61]
v_pk_add_f32 v[60:61], v[18:19], v[30:31] neg_lo:[0,1] neg_hi:[0,1]
v_pk_add_f32 v[18:19], v[18:19], v[30:31]
v_pk_add_f32 v[30:31], v[46:47], v[62:63] op_sel:[1,1] op_sel_hi:[0,0] neg_lo:[1,0] neg_hi:[0,1]
v_pk_add_f32 v[46:47], v[46:47], v[62:63]
v_pk_add_f32 v[62:63], v[28:29], v[76:77] neg_lo:[0,1] neg_hi:[0,1]
v_pk_add_f32 v[28:29], v[28:29], v[76:77]
v_pk_add_f32 v[76:77], v[54:55], v[70:71] op_sel:[1,1] op_sel_hi:[0,0] neg_lo:[1,0] neg_hi:[0,1]
v_pk_add_f32 v[54:55], v[54:55], v[70:71]
v_pk_add_f32 v[70:71], v[48:49], v[24:25] neg_lo:[0,1] neg_hi:[0,1]
v_pk_add_f32 v[48:49], v[48:49], v[24:25]
v_pk_add_f32 v[24:25], v[32:33], v[56:57] op_sel:[1,1] op_sel_hi:[0,0] neg_lo:[1,0] neg_hi:[0,1]
v_pk_add_f32 v[32:33], v[32:33], v[56:57]
v_pk_add_f32 v[56:57], v[38:39], v[20:21] neg_lo:[0,1] neg_hi:[0,1]
v_pk_add_f32 v[38:39], v[38:39], v[20:21]
v_pk_add_f32 v[20:21], v[52:53], v[68:69] op_sel:[1,1] op_sel_hi:[0,0] neg_lo:[1,0] neg_hi:[0,1]
v_pk_add_f32 v[52:53], v[52:53], v[68:69]
v_pk_add_f32 v[68:69], v[22:23], v[34:35] neg_lo:[0,1] neg_hi:[0,1]
v_pk_add_f32 v[22:23], v[22:23], v[34:35]
v_pk_add_f32 v[34:35], v[50:51], v[66:67] op_sel:[1,1] op_sel_hi:[0,0] neg_lo:[1,0] neg_hi:[0,1]
v_pk_add_f32 v[50:51], v[50:51], v[66:67]
v_pk_add_f32 v[66:67], v[36:37], v[78:79] neg_lo:[0,1] neg_hi:[0,1]
v_pk_add_f32 v[36:37], v[36:37], v[78:79]
v_pk_add_f32 v[78:79], v[58:59], v[74:75] op_sel:[1,1] op_sel_hi:[0,0] neg_lo:[1,0] neg_hi:[0,1]
v_pk_add_f32 v[58:59], v[58:59], v[74:75]
v_pk_add_f32 v[74:75], v[16:17], v[14:15] neg_lo:[0,1] neg_hi:[0,1]
v_pk_add_f32 v[16:17], v[16:17], v[14:15]
v_pk_add_f32 v[14:15], v[42:43], v[64:65] neg_lo:[0,1] neg_hi:[0,1]
v_pk_add_f32 v[42:43], v[42:43], v[64:65]
v_pk_add_f32 v[64:65], v[26:27], v[44:45] neg_lo:[0,1] neg_hi:[0,1]
v_pk_add_f32 v[26:27], v[26:27], v[44:45]
v_pk_add_f32 v[44:45], v[40:41], v[72:73] neg_lo:[0,1] neg_hi:[0,1]
v_pk_add_f32 v[40:41], v[40:41], v[72:73]
v_pk_add_f32 v[72:73], v[18:19], v[46:47] neg_lo:[0,1] neg_hi:[0,1]
v_pk_add_f32 v[18:19], v[18:19], v[46:47]
v_pk_add_f32 v[46:47], v[60:61], v[30:31] neg_lo:[0,1] neg_hi:[0,1]
v_pk_add_f32 v[60:61], v[60:61], v[30:31]
v_pk_add_f32 v[30:31], v[28:29], v[54:55] neg_lo:[0,1] neg_hi:[0,1]
v_pk_add_f32 v[28:29], v[28:29], v[54:55]
v_pk_add_f32 v[54:55], v[62:63], v[76:77] neg_lo:[0,1] neg_hi:[0,1]
v_pk_add_f32 v[62:63], v[62:63], v[76:77]
v_pk_add_f32 v[76:77], v[48:49], v[32:33] neg_lo:[0,1] neg_hi:[0,1]
v_pk_add_f32 v[48:49], v[48:49], v[32:33]
v_pk_add_f32 v[32:33], v[70:71], v[24:25] neg_lo:[0,1] neg_hi:[0,1]
v_pk_add_f32 v[70:71], v[70:71], v[24:25]
v_pk_add_f32 v[24:25], v[38:39], v[52:53] neg_lo:[0,1] neg_hi:[0,1]
v_pk_add_f32 v[38:39], v[38:39], v[52:53]
v_pk_add_f32 v[52:53], v[56:57], v[20:21] neg_lo:[0,1] neg_hi:[0,1]
v_pk_add_f32 v[56:57], v[56:57], v[20:21]
v_pk_add_f32 v[20:21], v[22:23], v[50:51] neg_lo:[0,1] neg_hi:[0,1]
v_pk_add_f32 v[22:23], v[22:23], v[50:51]
v_pk_add_f32 v[50:51], v[68:69], v[34:35] neg_lo:[0,1] neg_hi:[0,1]
v_pk_add_f32 v[68:69], v[68:69], v[34:35]
v_pk_add_f32 v[34:35], v[36:37], v[58:59] neg_lo:[0,1] neg_hi:[0,1]
v_pk_add_f32 v[36:37], v[36:37], v[58:59]
v_pk_add_f32 v[58:59], v[66:67], v[78:79] neg_lo:[0,1] neg_hi:[0,1]
v_pk_add_f32 v[66:67], v[66:67], v[78:79]
v_pk_mul_f32 v[78:79], v[16:17], v[144:145] op_sel:[0,0] op_sel_hi:[0,1] neg_lo:[0,0] neg_hi:[0,0]
v_pk_fma_f32 v[16:17], v[16:17], v[144:145], v[78:79] op_sel:[1,1,0] op_sel_hi:[1,0,1] neg_lo:[0,1,0] neg_hi:[0,0,0]
v_pk_mul_f32 v[78:79], v[48:49], v[146:147] op_sel:[0,0] op_sel_hi:[0,1] neg_lo:[0,0] neg_hi:[0,0]
v_pk_fma_f32 v[48:49], v[48:49], v[146:147], v[78:79] op_sel:[1,1,0] op_sel_hi:[1,0,1] neg_lo:[0,1,0] neg_hi:[0,0,0]
v_pk_mul_f32 v[78:79], v[18:19], v[148:149] op_sel:[0,0] op_sel_hi:[0,1] neg_lo:[0,0] neg_hi:[0,0]
v_pk_fma_f32 v[18:19], v[18:19], v[148:149], v[78:79] op_sel:[1,1,0] op_sel_hi:[1,0,1] neg_lo:[0,1,0] neg_hi:[0,0,0]
v_pk_mul_f32 v[78:79], v[22:23], v[150:151] op_sel:[0,0] op_sel_hi:[0,1] neg_lo:[0,0] neg_hi:[0,0]
v_pk_fma_f32 v[22:23], v[22:23], v[150:151], v[78:79] op_sel:[1,1,0] op_sel_hi:[1,0,1] neg_lo:[0,1,0] neg_hi:[0,0,0]
v_pk_mul_f32 v[78:79], v[26:27], v[152:153] op_sel:[0,0] op_sel_hi:[0,1] neg_lo:[0,0] neg_hi:[0,0]
v_pk_fma_f32 v[26:27], v[26:27], v[152:153], v[78:79] op_sel:[1,1,0] op_sel_hi:[1,0,1] neg_lo:[0,1,0] neg_hi:[0,0,0]
v_pk_mul_f32 v[78:79], v[38:39], v[154:155] op_sel:[0,0] op_sel_hi:[0,1] neg_lo:[0,0] neg_hi:[0,0]
v_pk_fma_f32 v[38:39], v[38:39], v[154:155], v[78:79] op_sel:[1,1,0] op_sel_hi:[1,0,1] neg_lo:[0,1,0] neg_hi:[0,0,0]
v_pk_mul_f32 v[78:79], v[28:29], v[156:157] op_sel:[0,0] op_sel_hi:[0,1] neg_lo:[0,0] neg_hi:[0,0]
v_pk_fma_f32 v[28:29], v[28:29], v[156:157], v[78:79] op_sel:[1,1,0] op_sel_hi:[1,0,1] neg_lo:[0,1,0] neg_hi:[0,0,0]
v_pk_mul_f32 v[78:79], v[36:37], v[158:159] op_sel:[0,0] op_sel_hi:[0,1] neg_lo:[0,0] neg_hi:[0,0]
v_pk_fma_f32 v[36:37], v[36:37], v[158:159], v[78:79] op_sel:[1,1,0] op_sel_hi:[1,0,1] neg_lo:[0,1,0] neg_hi:[0,0,0]
v_pk_mul_f32 v[78:79], v[42:43], v[160:161] op_sel:[0,0] op_sel_hi:[0,1] neg_lo:[0,0] neg_hi:[0,0]
v_pk_fma_f32 v[42:43], v[42:43], v[160:161], v[78:79] op_sel:[1,1,0] op_sel_hi:[1,0,1] neg_lo:[0,1,0] neg_hi:[0,0,0]
v_pk_mul_f32 v[78:79], v[70:71], v[162:163] op_sel:[0,0] op_sel_hi:[0,1] neg_lo:[0,0] neg_hi:[0,0]
v_pk_fma_f32 v[70:71], v[70:71], v[162:163], v[78:79] op_sel:[1,1,0] op_sel_hi:[1,0,1] neg_lo:[0,1,0] neg_hi:[0,0,0]
v_pk_mul_f32 v[78:79], v[60:61], v[164:165] op_sel:[0,0] op_sel_hi:[0,1] neg_lo:[0,0] neg_hi:[0,0]
v_pk_fma_f32 v[60:61], v[60:61], v[164:165], v[78:79] op_sel:[1,1,0] op_sel_hi:[1,0,1] neg_lo:[0,1,0] neg_hi:[0,0,0]
v_pk_mul_f32 v[78:79], v[68:69], v[166:167] op_sel:[0,0] op_sel_hi:[0,1] neg_lo:[0,0] neg_hi:[0,0]
v_pk_fma_f32 v[68:69], v[68:69], v[166:167], v[78:79] op_sel:[1,1,0] op_sel_hi:[1,0,1] neg_lo:[0,1,0] neg_hi:[0,0,0]
v_pk_mul_f32 v[78:79], v[40:41], v[168:169] op_sel:[0,0] op_sel_hi:[0,1] neg_lo:[0,0] neg_hi:[0,0]
v_pk_fma_f32 v[40:41], v[40:41], v[168:169], v[78:79] op_sel:[1,1,0] op_sel_hi:[1,0,1] neg_lo:[0,1,0] neg_hi:[0,0,0]
v_pk_mul_f32 v[78:79], v[56:57], v[170:171] op_sel:[0,0] op_sel_hi:[0,1] neg_lo:[0,0] neg_hi:[0,0]
v_pk_fma_f32 v[56:57], v[56:57], v[170:171], v[78:79] op_sel:[1,1,0] op_sel_hi:[1,0,1] neg_lo:[0,1,0] neg_hi:[0,0,0]
v_pk_mul_f32 v[78:79], v[62:63], v[172:173] op_sel:[0,0] op_sel_hi:[0,1] neg_lo:[0,0] neg_hi:[0,0]
v_pk_fma_f32 v[62:63], v[62:63], v[172:173], v[78:79] op_sel:[1,1,0] op_sel_hi:[1,0,1] neg_lo:[0,1,0] neg_hi:[0,0,0]
v_pk_mul_f32 v[78:79], v[66:67], v[174:175] op_sel:[0,0] op_sel_hi:[0,1] neg_lo:[0,0] neg_hi:[0,0]
v_pk_fma_f32 v[66:67], v[66:67], v[174:175], v[78:79] op_sel:[1,1,0] op_sel_hi:[1,0,1] neg_lo:[0,1,0] neg_hi:[0,0,0]
v_pk_mul_f32 v[78:79], v[74:75], v[176:177] op_sel:[0,0] op_sel_hi:[0,1] neg_lo:[0,0] neg_hi:[0,0]
v_pk_fma_f32 v[74:75], v[74:75], v[176:177], v[78:79] op_sel:[1,1,0] op_sel_hi:[1,0,1] neg_lo:[0,1,0] neg_hi:[0,0,0]
v_pk_mul_f32 v[78:79], v[76:77], v[178:179] op_sel:[0,0] op_sel_hi:[0,1] neg_lo:[0,0] neg_hi:[0,0]
v_pk_fma_f32 v[76:77], v[76:77], v[178:179], v[78:79] op_sel:[1,1,0] op_sel_hi:[1,0,1] neg_lo:[0,1,0] neg_hi:[0,0,0]
v_pk_mul_f32 v[78:79], v[72:73], v[180:181] op_sel:[0,0] op_sel_hi:[0,1] neg_lo:[0,0] neg_hi:[0,0]
v_pk_fma_f32 v[72:73], v[72:73], v[180:181], v[78:79] op_sel:[1,1,0] op_sel_hi:[1,0,1] neg_lo:[0,1,0] neg_hi:[0,0,0]
v_pk_mul_f32 v[78:79], v[20:21], v[182:183] op_sel:[0,0] op_sel_hi:[0,1] neg_lo:[0,0] neg_hi:[0,0]
v_pk_fma_f32 v[20:21], v[20:21], v[182:183], v[78:79] op_sel:[1,1,0] op_sel_hi:[1,0,1] neg_lo:[0,1,0] neg_hi:[0,0,0]
v_pk_mul_f32 v[78:79], v[64:65], v[184:185] op_sel:[0,0] op_sel_hi:[0,1] neg_lo:[0,0] neg_hi:[0,0]
v_pk_fma_f32 v[64:65], v[64:65], v[184:185], v[78:79] op_sel:[1,1,0] op_sel_hi:[1,0,1] neg_lo:[0,1,0] neg_hi:[0,0,0]
v_pk_mul_f32 v[78:79], v[24:25], v[186:187] op_sel:[0,0] op_sel_hi:[0,1] neg_lo:[0,0] neg_hi:[0,0]
v_pk_fma_f32 v[24:25], v[24:25], v[186:187], v[78:79] op_sel:[1,1,0] op_sel_hi:[1,0,1] neg_lo:[0,1,0] neg_hi:[0,0,0]
v_pk_mul_f32 v[78:79], v[30:31], v[188:189] op_sel:[0,0] op_sel_hi:[0,1] neg_lo:[0,0] neg_hi:[0,0]
v_pk_fma_f32 v[30:31], v[30:31], v[188:189], v[78:79] op_sel:[1,1,0] op_sel_hi:[1,0,1] neg_lo:[0,1,0] neg_hi:[0,0,0]
v_pk_mul_f32 v[78:79], v[34:35], v[190:191] op_sel:[0,0] op_sel_hi:[0,1] neg_lo:[0,0] neg_hi:[0,0]
v_pk_fma_f32 v[34:35], v[34:35], v[190:191], v[78:79] op_sel:[1,1,0] op_sel_hi:[1,0,1] neg_lo:[0,1,0] neg_hi:[0,0,0]
v_pk_mul_f32 v[78:79], v[14:15], v[192:193] op_sel:[0,0] op_sel_hi:[0,1] neg_lo:[0,0] neg_hi:[0,0]
v_pk_fma_f32 v[14:15], v[14:15], v[192:193], v[78:79] op_sel:[1,1,0] op_sel_hi:[1,0,1] neg_lo:[0,1,0] neg_hi:[0,0,0]
v_pk_mul_f32 v[78:79], v[32:33], v[194:195] op_sel:[0,0] op_sel_hi:[0,1] neg_lo:[0,0] neg_hi:[0,0]
v_pk_fma_f32 v[32:33], v[32:33], v[194:195], v[78:79] op_sel:[1,1,0] op_sel_hi:[1,0,1] neg_lo:[0,1,0] neg_hi:[0,0,0]
v_pk_mul_f32 v[78:79], v[46:47], v[196:197] op_sel:[0,0] op_sel_hi:[0,1] neg_lo:[0,0] neg_hi:[0,0]
v_pk_fma_f32 v[46:47], v[46:47], v[196:197], v[78:79] op_sel:[1,1,0] op_sel_hi:[1,0,1] neg_lo:[0,1,0] neg_hi:[0,0,0]
v_pk_mul_f32 v[78:79], v[50:51], v[198:199] op_sel:[0,0] op_sel_hi:[0,1] neg_lo:[0,0] neg_hi:[0,0]
v_pk_fma_f32 v[50:51], v[50:51], v[198:199], v[78:79] op_sel:[1,1,0] op_sel_hi:[1,0,1] neg_lo:[0,1,0] neg_hi:[0,0,0]
v_pk_mul_f32 v[78:79], v[44:45], v[200:201] op_sel:[0,0] op_sel_hi:[0,1] neg_lo:[0,0] neg_hi:[0,0]
v_pk_fma_f32 v[44:45], v[44:45], v[200:201], v[78:79] op_sel:[1,1,0] op_sel_hi:[1,0,1] neg_lo:[0,1,0] neg_hi:[0,0,0]
v_pk_mul_f32 v[78:79], v[52:53], v[202:203] op_sel:[0,0] op_sel_hi:[0,1] neg_lo:[0,0] neg_hi:[0,0]
v_pk_fma_f32 v[52:53], v[52:53], v[202:203], v[78:79] op_sel:[1,1,0] op_sel_hi:[1,0,1] neg_lo:[0,1,0] neg_hi:[0,0,0]
v_pk_mul_f32 v[78:79], v[54:55], v[204:205] op_sel:[0,0] op_sel_hi:[0,1] neg_lo:[0,0] neg_hi:[0,0]
v_pk_fma_f32 v[54:55], v[54:55], v[204:205], v[78:79] op_sel:[1,1,0] op_sel_hi:[1,0,1] neg_lo:[0,1,0] neg_hi:[0,0,0]
v_pk_mul_f32 v[78:79], v[58:59], v[206:207] op_sel:[0,0] op_sel_hi:[0,1] neg_lo:[0,0] neg_hi:[0,0]
v_pk_fma_f32 v[58:59], v[58:59], v[206:207], v[78:79] op_sel:[1,1,0] op_sel_hi:[1,0,1] neg_lo:[0,1,0] neg_hi:[0,0,0]
ds_write_b64 v4, v[16:17] offset:0
ds_write_b64 v4, v[48:49] offset:16
ds_write_b64 v4, v[18:19] offset:32
ds_write_b64 v4, v[22:23] offset:48
ds_write_b64 v4, v[26:27] offset:64
ds_write_b64 v4, v[38:39] offset:80
ds_write_b64 v4, v[28:29] offset:96
ds_write_b64 v4, v[36:37] offset:112
ds_write_b64 v4, v[42:43] offset:128
ds_write_b64 v4, v[70:71] offset:144
ds_write_b64 v4, v[60:61] offset:160
ds_write_b64 v4, v[68:69] offset:176
ds_write_b64 v4, v[40:41] offset:192
ds_write_b64 v4, v[56:57] offset:208
ds_write_b64 v4, v[62:63] offset:224
ds_write_b64 v4, v[66:67] offset:240
ds_write_b64 v4, v[74:75] offset:256
ds_write_b64 v4, v[76:77] offset:272
ds_write_b64 v4, v[72:73] offset:288
ds_write_b64 v4, v[20:21] offset:304
ds_write_b64 v4, v[64:65] offset:320
ds_write_b64 v4, v[24:25] offset:336
ds_write_b64 v4, v[30:31] offset:352
ds_write_b64 v4, v[34:35] offset:368
ds_write_b64 v4, v[14:15] offset:384
ds_write_b64 v4, v[32:33] offset:400
ds_write_b64 v4, v[46:47] offset:416
ds_write_b64 v4, v[50:51] offset:432
ds_write_b64 v4, v[44:45] offset:448
ds_write_b64 v4, v[52:53] offset:464
ds_write_b64 v4, v[54:55] offset:480
ds_write_b64 v4, v[58:59] offset:496
s_waitcnt lgkmcnt(0)
ds_read_b64 v[16:17], v3 offset:0
ds_read_b64 v[48:49], v3 offset:8448
ds_read_b64 v[18:19], v3 offset:528
ds_read_b64 v[50:51], v3 offset:8976
ds_read_b64 v[20:21], v3 offset:1056
ds_read_b64 v[52:53], v3 offset:9504
ds_read_b64 v[22:23], v3 offset:1584
ds_read_b64 v[54:55], v3 offset:10032
ds_read_b64 v[24:25], v3 offset:2112
ds_read_b64 v[56:57], v3 offset:10560
ds_read_b64 v[26:27], v3 offset:2640
ds_read_b64 v[58:59], v3 offset:11088
ds_read_b64 v[28:29], v3 offset:3168
ds_read_b64 v[60:61], v3 offset:11616
ds_read_b64 v[30:31], v3 offset:3696
ds_read_b64 v[62:63], v3 offset:12144
ds_read_b64 v[32:33], v3 offset:4224
ds_read_b64 v[64:65], v3 offset:12672
ds_read_b64 v[34:35], v3 offset:4752
ds_read_b64 v[66:67], v3 offset:13200
ds_read_b64 v[36:37], v3 offset:5280
ds_read_b64 v[68:69], v3 offset:13728
ds_read_b64 v[38:39], v3 offset:5808
ds_read_b64 v[70:71], v3 offset:14256
ds_read_b64 v[40:41], v3 offset:6336
ds_read_b64 v[72:73], v3 offset:14784
ds_read_b64 v[42:43], v3 offset:6864
ds_read_b64 v[74:75], v3 offset:15312
ds_read_b64 v[44:45], v3 offset:7392
ds_read_b64 v[76:77], v3 offset:15840
ds_read_b64 v[46:47], v3 offset:7920
ds_read_b64 v[78:79], v3 offset:16368
s_waitcnt lgkmcnt(0)
v_pk_add_f32 v[14:15], v[16:17], v[48:49] neg_lo:[0,1] neg_hi:[0,1]
v_pk_add_f32 v[16:17], v[16:17], v[48:49]
v_pk_add_f32 v[48:49], v[18:19], v[50:51] neg_lo:[0,1] neg_hi:[0,1]
v_pk_add_f32 v[18:19], v[18:19], v[50:51]
v_pk_mul_f32 v[50:51], v[48:49], s[50:51] op_sel:[0,0] op_sel_hi:[0,1] neg_lo:[0,0] neg_hi:[0,0]
v_pk_fma_f32 v[50:51], v[48:49], s[50:51], v[50:51] op_sel:[1,1,0] op_sel_hi:[1,0,1] neg_lo:[0,1,0] neg_hi:[0,0,0]
v_pk_add_f32 v[48:49], v[20:21], v[52:53] neg_lo:[0,1] neg_hi:[0,1]
v_pk_add_f32 v[20:21], v[20:21], v[52:53]
v_pk_mul_f32 v[52:53], v[48:49], s[54:55] op_sel:[0,0] op_sel_hi:[0,1] neg_lo:[0,0] neg_hi:[0,0]
v_pk_fma_f32 v[52:53], v[48:49], s[54:55], v[52:53] op_sel:[1,1,0] op_sel_hi:[1,0,1] neg_lo:[0,1,0] neg_hi:[0,0,0]
v_pk_add_f32 v[48:49], v[22:23], v[54:55] neg_lo:[0,1] neg_hi:[0,1]
v_pk_add_f32 v[22:23], v[22:23], v[54:55]
v_pk_mul_f32 v[54:55], v[48:49], s[58:59] op_sel:[0,0] op_sel_hi:[0,1] neg_lo:[0,0] neg_hi:[0,0]
v_pk_fma_f32 v[54:55], v[48:49], s[58:59], v[54:55] op_sel:[1,1,0] op_sel_hi:[1,0,1] neg_lo:[0,1,0] neg_hi:[0,0,0]
v_pk_add_f32 v[48:49], v[24:25], v[56:57] neg_lo:[0,1] neg_hi:[0,1]
v_pk_add_f32 v[24:25], v[24:25], v[56:57]
v_pk_mul_f32 v[56:57], v[48:49], s[62:63] op_sel:[0,0] op_sel_hi:[0,1] neg_lo:[0,0] neg_hi:[0,0]
v_pk_fma_f32 v[56:57], v[48:49], s[62:63], v[56:57] op_sel:[1,1,0] op_sel_hi:[1,0,1] neg_lo:[0,1,0] neg_hi:[0,0,0]
v_pk_add_f32 v[48:49], v[26:27], v[58:59] neg_lo:[0,1] neg_hi:[0,1]
v_pk_add_f32 v[26:27], v[26:27], v[58:59]
v_pk_mul_f32 v[58:59], v[48:49], s[58:59] op_sel:[0,1] op_sel_hi:[0,0] neg_lo:[0,0] neg_hi:[0,0]
v_pk_fma_f32 v[58:59], v[48:49], s[58:59], v[58:59] op_sel:[1,0,0] op_sel_hi:[1,1,1] neg_lo:[0,1,0] neg_hi:[0,0,0]
v_pk_add_f32 v[48:49], v[28:29], v[60:61] neg_lo:[0,1] neg_hi:[0,1]
v_pk_add_f32 v[28:29], v[28:29], v[60:61]
v_pk_mul_f32 v[60:61], v[48:49], s[54:55] op_sel:[0,1] op_sel_hi:[0,0] neg_lo:[0,0] neg_hi:[0,0]
v_pk_fma_f32 v[60:61], v[48:49], s[54:55], v[60:61] op_sel:[1,0,0] op_sel_hi:[1,1,1] neg_lo:[0,1,0] neg_hi:[0,0,0]
v_pk_add_f32 v[48:49], v[30:31], v[62:63] neg_lo:[0,1] neg_hi:[0,1]
v_pk_add_f32 v[30:31], v[30:31], v[62:63]
v_pk_mul_f32 v[62:63], v[48:49], s[50:51] op_sel:[0,1] op_sel_hi:[0,0] neg_lo:[0,0] neg_hi:[0,0]
v_pk_fma_f32 v[62:63], v[48:49], s[50:51], v[62:63] op_sel:[1,0,0] op_sel_hi:[1,1,1] neg_lo:[0,1,0] neg_hi:[0,0,0]
v_pk_add_f32 v[48:49], v[32:33], v[64:65] op_sel:[1,1] op_sel_hi:[0,0] neg_lo:[1,0] neg_hi:[0,1]
v_pk_add_f32 v[32:33], v[32:33], v[64:65]
v_pk_add_f32 v[64:65], v[34:35], v[66:67] neg_lo:[0,1] neg_hi:[0,1]
v_pk_add_f32 v[34:35], v[34:35], v[66:67]
v_pk_mul_f32 v[66:67], v[64:65], s[50:51] op_sel:[0,1] op_sel_hi:[0,0] neg_lo:[0,1] neg_hi:[0,0]
v_pk_fma_f32 v[66:67], v[64:65], s[50:51], v[66:67] op_sel:[1,0,0] op_sel_hi:[1,1,1] neg_lo:[0,1,0] neg_hi:[0,1,0]
v_pk_add_f32 v[64:65], v[36:37], v[68:69] neg_lo:[0,1] neg_hi:[0,1]
v_pk_add_f32 v[36:37], v[36:37], v[68:69]
v_pk_mul_f32 v[68:69], v[64:65], s[54:55] op_sel:[0,1] op_sel_hi:[0,0] neg_lo:[0,1] neg_hi:[0,0]
v_pk_fma_f32 v[68:69], v[64:65], s[54:55], v[68:69] op_sel:[1,0,0] op_sel_hi:[1,1,1] neg_lo:[0,1,0] neg_hi:[0,1,0]
v_pk_add_f32 v[64:65], v[38:39], v[70:71] neg_lo:[0,1] neg_hi:[0,1]
v_pk_add_f32 v[38:39], v[38:39], v[70:71]
v_pk_mul_f32 v[70:71], v[64:65], s[58:59] op_sel:[0,1] op_sel_hi:[0,0] neg_lo:[0,1] neg_hi:[0,0]
v_pk_fma_f32 v[70:71], v[64:65], s[58:59], v[70:71] op_sel:[1,0,0] op_sel_hi:[1,1,1] neg_lo:[0,1,0] neg_hi:[0,1,0]
v_pk_add_f32 v[64:65], v[40:41], v[72:73] neg_lo:[0,1] neg_hi:[0,1]
v_pk_add_f32 v[40:41], v[40:41], v[72:73]
v_pk_mul_f32 v[72:73], v[64:65], s[62:63] op_sel:[0,0] op_sel_hi:[0,1] neg_lo:[0,1] neg_hi:[0,0]
v_pk_fma_f32 v[72:73], v[64:65], s[62:63], v[72:73] op_sel:[1,1,0] op_sel_hi:[1,0,1] neg_lo:[0,1,0] neg_hi:[0,1,0]
v_pk_add_f32 v[64:65], v[42:43], v[74:75] neg_lo:[0,1] neg_hi:[0,1]
v_pk_add_f32 v[42:43], v[42:43], v[74:75]
v_pk_mul_f32 v[74:75], v[64:65], s[58:59] op_sel:[0,0] op_sel_hi:[0,1] neg_lo:[0,1] neg_hi:[0,0]
v_pk_fma_f32 v[74:75], v[64:65], s[58:59], v[74:75] op_sel:[1,1,0] op_sel_hi:[1,0,1] neg_lo:[0,1,0] neg_hi:[0,1,0]
v_pk_add_f32 v[64:65], v[44:45], v[76:77] neg_lo:[0,1] neg_hi:[0,1]
v_pk_add_f32 v[44:45], v[44:45], v[76:77]
v_pk_mul_f32 v[76:77], v[64:65], s[54:55] op_sel:[0,0] op_sel_hi:[0,1] neg_lo:[0,1] neg_hi:[0,0]
v_pk_fma_f32 v[76:77], v[64:65], s[54:55], v[76:77] op_sel:[1,1,0] op_sel_hi:[1,0,1] neg_lo:[0,1,0] neg_hi:[0,1,0]
v_pk_add_f32 v[64:65], v[46:47], v[78:79] neg_lo:[0,1] neg_hi:[0,1]
v_pk_add_f32 v[46:47], v[46:47], v[78:79]
v_pk_mul_f32 v[78:79], v[64:65], s[50:51] op_sel:[0,0] op_sel_hi:[0,1] neg_lo:[0,1] neg_hi:[0,0]
v_pk_fma_f32 v[78:79], v[64:65], s[50:51], v[78:79] op_sel:[1,1,0] op_sel_hi:[1,0,1] neg_lo:[0,1,0] neg_hi:[0,1,0]
v_pk_add_f32 v[64:65], v[16:17], v[32:33] neg_lo:[0,1] neg_hi:[0,1]
v_pk_add_f32 v[16:17], v[16:17], v[32:33]
v_pk_add_f32 v[32:33], v[18:19], v[34:35] neg_lo:[0,1] neg_hi:[0,1]
v_pk_add_f32 v[18:19], v[18:19], v[34:35]
v_pk_mul_f32 v[34:35], v[32:33], s[54:55] op_sel:[0,0] op_sel_hi:[0,1] neg_lo:[0,0] neg_hi:[0,0]
v_pk_fma_f32 v[34:35], v[32:33], s[54:55], v[34:35] op_sel:[1,1,0] op_sel_hi:[1,0,1] neg_lo:[0,1,0] neg_hi:[0,0,0]
v_pk_add_f32 v[32:33], v[20:21], v[36:37] neg_lo:[0,1] neg_hi:[0,1]
v_pk_add_f32 v[20:21], v[20:21], v[36:37]
v_pk_mul_f32 v[36:37], v[32:33], s[62:63] op_sel:[0,0] op_sel_hi:[0,1] neg_lo:[0,0] neg_hi:[0,0]
v_pk_fma_f32 v[36:37], v[32:33], s[62:63], v[36:37] op_sel:[1,1,0] op_sel_hi:[1,0,1] neg_lo:[0,1,0] neg_hi:[0,0,0]
v_pk_add_f32 v[32:33], v[22:23], v[38:39] neg_lo:[0,1] neg_hi:[0,1]
v_pk_add_f32 v[22:23], v[22:23], v[38:39]
v_pk_mul_f32 v[38:39], v[32:33], s[54:55] op_sel:[0,1] op_sel_hi:[0,0] neg_lo:[0,0] neg_hi:[0,0]
v_pk_fma_f32 v[38:39], v[32:33], s[54:55], v[38:39] op_sel:[1,0,0] op_sel_hi:[1,1,1] neg_lo:[0,1,0] neg_hi:[0,0,0]
v_pk_add_f32 v[32:33], v[24:25], v[40:41] op_sel:[1,1] op_sel_hi:[0,0] neg_lo:[1,0] neg_hi:[0,1]
v_pk_add_f32 v[24:25], v[24:25], v[40:41]
v_pk_add_f32 v[40:41], v[26:27], v[42:43] neg_lo:[0,1] neg_hi:[0,1]
v_pk_add_f32 v[26:27], v[26:27], v[42:43]
v_pk_mul_f32 v[42:43], v[40:41], s[54:55] op_sel:[0,1] op_sel_hi:[0,0] neg_lo:[0,1] neg_hi:[0,0]
v_pk_fma_f32 v[42:43], v[40:41], s[54:55], v[42:43] op_sel:[1,0,0] op_sel_hi:[1,1,1] neg_lo:[0,1,0] neg_hi:[0,1,0]
v_pk_add_f32 v[40:41], v[28:29], v[44:45] neg_lo:[0,1] neg_hi:[0,1]
v_pk_add_f32 v[28:29], v[28:29], v[44:45]
v_pk_mul_f32 v[44:45], v[40:41], s[62:63] op_sel:[0,0] op_sel_hi:[0,1] neg_lo:[0,1] neg_hi:[0,0]
v_pk_fma_f32 v[44:45], v[40:41], s[62:63], v[44:45] op_sel:[1,1,0] op_sel_hi:[1,0,1] neg_lo:[0,1,0] neg_hi:[0,1,0]
v_pk_add_f32 v[40:41], v[30:31], v[46:47] neg_lo:[0,1] neg_hi:[0,1]
v_pk_add_f32 v[30:31], v[30:31], v[46:47]
v_pk_mul_f32 v[46:47], v[40:41], s[54:55] op_sel:[0,0] op_sel_hi:[0,1] neg_lo:[0,1] neg_hi:[0,0]
v_pk_fma_f32 v[46:47], v[40:41], s[54:55], v[46:47] op_sel:[1,1,0] op_sel_hi:[1,0,1] neg_lo:[0,1,0] neg_hi:[0,1,0]
v_pk_add_f32 v[40:41], v[14:15], v[48:49] neg_lo:[0,1] neg_hi:[0,1]
v_pk_add_f32 v[14:15], v[14:15], v[48:49]
v_pk_add_f32 v[48:49], v[50:51], v[66:67] neg_lo:[0,1] neg_hi:[0,1]
v_pk_add_f32 v[50:51], v[50:51], v[66:67]
v_pk_mul_f32 v[66:67], v[48:49], s[54:55] op_sel:[0,0] op_sel_hi:[0,1] neg_lo:[0,0] neg_hi:[0,0]
v_pk_fma_f32 v[66:67], v[48:49], s[54:55], v[66:67] op_sel:[1,1,0] op_sel_hi:[1,0,1] neg_lo:[0,1,0] neg_hi:[0,0,0]
v_pk_add_f32 v[48:49], v[52:53], v[68:69] neg_lo:[0,1] neg_hi:[0,1]
v_pk_add_f32 v[52:53], v[52:53], v[68:69]
v_pk_mul_f32 v[68:69], v[48:49], s[62:63] op_sel:[0,0] op_sel_hi:[0,1] neg_lo:[0,0] neg_hi:[0,0]
v_pk_fma_f32 v[68:69], v[48:49], s[62:63], v[68:69] op_sel:[1,1,0] op_sel_hi:[1,0,1] neg_lo:[0,1,0] neg_hi:[0,0,0]
v_pk_add_f32 v[48:49], v[54:55], v[70:71] neg_lo:[0,1] neg_hi:[0,1]
v_pk_add_f32 v[54:55], v[54:55], v[70:71]
v_pk_mul_f32 v[70:71], v[48:49], s[54:55] op_sel:[0,1] op_sel_hi:[0,0] neg_lo:[0,0] neg_hi:[0,0]
v_pk_fma_f32 v[70:71], v[48:49], s[54:55], v[70:71] op_sel:[1,0,0] op_sel_hi:[1,1,1] neg_lo:[0,1,0] neg_hi:[0,0,0]
v_pk_add_f32 v[48:49], v[56:57], v[72:73] op_sel:[1,1] op_sel_hi:[0,0] neg_lo:[1,0] neg_hi:[0,1]
v_pk_add_f32 v[56:57], v[56:57], v[72:73]
v_pk_add_f32 v[72:73], v[58:59], v[74:75] neg_lo:[0,1] neg_hi:[0,1]
v_pk_add_f32 v[58:59], v[58:59], v[74:75]
v_pk_mul_f32 v[74:75], v[72:73], s[54:55] op_sel:[0,1] op_sel_hi:[0,0] neg_lo:[0,1] neg_hi:[0,0]
v_pk_fma_f32 v[74:75], v[72:73], s[54:55], v[74:75] op_sel:[1,0,0] op_sel_hi:[1,1,1] neg_lo:[0,1,0] neg_hi:[0,1,0]
v_pk_add_f32 v[72:73], v[60:61], v[76:77] neg_lo:[0,1] neg_hi:[0,1]
v_pk_add_f32 v[60:61], v[60:61], v[76:77]
v_pk_mul_f32 v[76:77], v[72:73], s[62:63] op_sel:[0,0] op_sel_hi:[0,1] neg_lo:[0,1] neg_hi:[0,0]
v_pk_fma_f32 v[76:77], v[72:73], s[62:63], v[76:77] op_sel:[1,1,0] op_sel_hi:[1,0,1] neg_lo:[0,1,0] neg_hi:[0,1,0]
v_pk_add_f32 v[72:73], v[62:63], v[78:79] neg_lo:[0,1] neg_hi:[0,1]
v_pk_add_f32 v[62:63], v[62:63], v[78:79]
v_pk_mul_f32 v[78:79], v[72:73], s[54:55] op_sel:[0,0] op_sel_hi:[0,1] neg_lo:[0,1] neg_hi:[0,0]
v_pk_fma_f32 v[78:79], v[72:73], s[54:55], v[78:79] op_sel:[1,1,0] op_sel_hi:[1,0,1] neg_lo:[0,1,0] neg_hi:[0,1,0]
v_pk_add_f32 v[72:73], v[16:17], v[24:25] neg_lo:[0,1] neg_hi:[0,1]
v_pk_add_f32 v[16:17], v[16:17], v[24:25]
v_pk_add_f32 v[24:25], v[18:19], v[26:27] neg_lo:[0,1] neg_hi:[0,1]
v_pk_add_f32 v[18:19], v[18:19], v[26:27]
v_pk_mul_f32 v[26:27], v[24:25], s[62:63] op_sel:[0,0] op_sel_hi:[0,1] neg_lo:[0,0] neg_hi:[0,0]
v_pk_fma_f32 v[26:27], v[24:25], s[62:63], v[26:27] op_sel:[1,1,0] op_sel_hi:[1,0,1] neg_lo:[0,1,0] neg_hi:[0,0,0]
v_pk_add_f32 v[24:25], v[20:21], v[28:29] op_sel:[1,1] op_sel_hi:[0,0] neg_lo:[1,0] neg_hi:[0,1]
v_pk_add_f32 v[20:21], v[20:21], v[28:29]
v_pk_add_f32 v[28:29], v[22:23], v[30:31] neg_lo:[0,1] neg_hi:[0,1]
v_pk_add_f32 v[22:23], v[22:23], v[30:31]
v_pk_mul_f32 v[30:31], v[28:29], s[62:63] op_sel:[0,0] op_sel_hi:[0,1] neg_lo:[0,1] neg_hi:[0,0]
v_pk_fma_f32 v[30:31], v[28:29], s[62:63], v[30:31] op_sel:[1,1,0] op_sel_hi:[1,0,1] neg_lo:[0,1,0] neg_hi:[0,1,0]
v_pk_add_f32 v[28:29], v[64:65], v[32:33] neg_lo:[0,1] neg_hi:[0,1]
v_pk_add_f32 v[64:65], v[64:65], v[32:33]
v_pk_add_f32 v[32:33], v[34:35], v[42:43] neg_lo:[0,1] neg_hi:[0,1]
v_pk_add_f32 v[34:35], v[34:35], v[42:43]
v_pk_mul_f32 v[42:43], v[32:33], s[62:63] op_sel:[0,0] op_sel_hi:[0,1] neg_lo:[0,0] neg_hi:[0,0]
v_pk_fma_f32 v[42:43], v[32:33], s[62:63], v[42:43] op_sel:[1,1,0] op_sel_hi:[1,0,1] neg_lo:[0,1,0] neg_hi:[0,0,0]
v_pk_add_f32 v[32:33], v[36:37], v[44:45] op_sel:[1,1] op_sel_hi:[0,0] neg_lo:[1,0] neg_hi:[0,1]
v_pk_add_f32 v[36:37], v[36:37], v[44:45]
v_pk_add_f32 v[44:45], v[38:39], v[46:47] neg_lo:[0,1] neg_hi:[0,1]
v_pk_add_f32 v[38:39], v[38:39], v[46:47]
v_pk_mul_f32 v[46:47], v[44:45], s[62:63] op_sel:[0,0] op_sel_hi:[0,1] neg_lo:[0,1] neg_hi:[0,0]
v_pk_fma_f32 v[46:47], v[44:45], s[62:63], v[46:47] op_sel:[1,1,0] op_sel_hi:[1,0,1] neg_lo:[0,1,0] neg_hi:[0,1,0]
v_pk_add_f32 v[44:45], v[14:15], v[56:57] neg_lo:[0,1] neg_hi:[0,1]
v_pk_add_f32 v[14:15], v[14:15], v[56:57]
v_pk_add_f32 v[56:57], v[50:51], v[58:59] neg_lo:[0,1] neg_hi:[0,1]
v_pk_add_f32 v[50:51], v[50:51], v[58:59]
v_pk_mul_f32 v[58:59], v[56:57], s[62:63] op_sel:[0,0] op_sel_hi:[0,1] neg_lo:[0,0] neg_hi:[0,0]
v_pk_fma_f32 v[58:59], v[56:57], s[62:63], v[58:59] op_sel:[1,1,0] op_sel_hi:[1,0,1] neg_lo:[0,1,0] neg_hi:[0,0,0]
v_pk_add_f32 v[56:57], v[52:53], v[60:61] op_sel:[1,1] op_sel_hi:[0,0] neg_lo:[1,0] neg_hi:[0,1]
v_pk_add_f32 v[52:53], v[52:53], v[60:61]
v_pk_add_f32 v[60:61], v[54:55], v[62:63] neg_lo:[0,1] neg_hi:[0,1]
v_pk_add_f32 v[54:55], v[54:55], v[62:63]
v_pk_mul_f32 v[62:63], v[60:61], s[62:63] op_sel:[0,0] op_sel_hi:[0,1] neg_lo:[0,1] neg_hi:[0,0]
v_pk_fma_f32 v[62:63], v[60:61], s[62:63], v[62:63] op_sel:[1,1,0] op_sel_hi:[1,0,1] neg_lo:[0,1,0] neg_hi:[0,1,0]
v_pk_add_f32 v[60:61], v[40:41], v[48:49] neg_lo:[0,1] neg_hi:[0,1]
v_pk_add_f32 v[40:41], v[40:41], v[48:49]
v_pk_add_f32 v[48:49], v[66:67], v[74:75] neg_lo:[0,1] neg_hi:[0,1]
v_pk_add_f32 v[66:67], v[66:67], v[74:75]
v_pk_mul_f32 v[74:75], v[48:49], s[62:63] op_sel:[0,0] op_sel_hi:[0,1] neg_lo:[0,0] neg_hi:[0,0]
v_pk_fma_f32 v[74:75], v[48:49], s[62:63], v[74:75] op_sel:[1,1,0] op_sel_hi:[1,0,1] neg_lo:[0,1,0] neg_hi:[0,0,0]
v_pk_add_f32 v[48:49], v[68:69], v[76:77] op_sel:[1,1] op_sel_hi:[0,0] neg_lo:[1,0] neg_hi:[0,1]
v_pk_add_f32 v[68:69], v[68:69], v[76:77]
v_pk_add_f32 v[76:77], v[70:71], v[78:79] neg_lo:[0,1] neg_hi:[0,1]
v_pk_add_f32 v[70:71], v[70:71], v[78:79]
v_pk_mul_f32 v[78:79], v[76:77], s[62:63] op_sel:[0,0] op_sel_hi:[0,1] neg_lo:[0,1] neg_hi:[0,0]
v_pk_fma_f32 v[78:79], v[76:77], s[62:63], v[78:79] op_sel:[1,1,0] op_sel_hi:[1,0,1] neg_lo:[0,1,0] neg_hi:[0,1,0]
v_pk_add_f32 v[76:77], v[16:17], v[20:21] neg_lo:[0,1] neg_hi:[0,1]
v_pk_add_f32 v[16:17], v[16:17], v[20:21]
v_pk_add_f32 v[20:21], v[18:19], v[22:23] op_sel:[1,1] op_sel_hi:[0,0] neg_lo:[1,0] neg_hi:[0,1]
v_pk_add_f32 v[18:19], v[18:19], v[22:23]
v_pk_add_f32 v[22:23], v[72:73], v[24:25] neg_lo:[0,1] neg_hi:[0,1]
v_pk_add_f32 v[72:73], v[72:73], v[24:25]
v_pk_add_f32 v[24:25], v[26:27], v[30:31] op_sel:[1,1] op_sel_hi:[0,0] neg_lo:[1,0] neg_hi:[0,1]
v_pk_add_f32 v[26:27], v[26:27], v[30:31]
v_pk_add_f32 v[30:31], v[64:65], v[36:37] neg_lo:[0,1] neg_hi:[0,1]
v_pk_add_f32 v[64:65], v[64:65], v[36:37]
v_pk_add_f32 v[36:37], v[34:35], v[38:39] op_sel:[1,1] op_sel_hi:[0,0] neg_lo:[1,0] neg_hi:[0,1]
v_pk_add_f32 v[34:35], v[34:35], v[38:39]
v_pk_add_f32 v[38:39], v[28:29], v[32:33] neg_lo:[0,1] neg_hi:[0,1]
v_pk_add_f32 v[28:29], v[28:29], v[32:33]
v_pk_add_f32 v[32:33], v[42:43], v[46:47] op_sel:[1,1] op_sel_hi:[0,0] neg_lo:[1,0] neg_hi:[0,1]
v_pk_add_f32 v[42:43], v[42:43], v[46:47]
v_pk_add_f32 v[46:47], v[14:15], v[52:53] neg_lo:[0,1] neg_hi:[0,1]
v_pk_add_f32 v[14:15], v[14:15], v[52:53]
v_pk_add_f32 v[52:53], v[50:51], v[54:55] op_sel:[1,1] op_sel_hi:[0,0] neg_lo:[1,0] neg_hi:[0,1]
v_pk_add_f32 v[50:51], v[50:51], v[54:55]
v_pk_add_f32 v[54:55], v[44:45], v[56:57] neg_lo:[0,1] neg_hi:[0,1]
v_pk_add_f32 v[44:45], v[44:45], v[56:57]
v_pk_add_f32 v[56:57], v[58:59], v[62:63] op_sel:[1,1] op_sel_hi:[0,0] neg_lo:[1,0] neg_hi:[0,1]
v_pk_add_f32 v[58:59], v[58:59], v[62:63]
v_pk_add_f32 v[62:63], v[40:41], v[68:69] neg_lo:[0,1] neg_hi:[0,1]
v_pk_add_f32 v[40:41], v[40:41], v[68:69]
v_pk_add_f32 v[68:69], v[66:67], v[70:71] op_sel:[1,1] op_sel_hi:[0,0] neg_lo:[1,0] neg_hi:[0,1]
v_pk_add_f32 v[66:67], v[66:67], v[70:71]
v_pk_add_f32 v[70:71], v[60:61], v[48:49] neg_lo:[0,1] neg_hi:[0,1]
v_pk_add_f32 v[60:61], v[60:61], v[48:49]
v_pk_add_f32 v[48:49], v[74:75], v[78:79] op_sel:[1,1] op_sel_hi:[0,0] neg_lo:[1,0] neg_hi:[0,1]
v_pk_add_f32 v[74:75], v[74:75], v[78:79]
v_pk_add_f32 v[78:79], v[16:17], v[18:19] neg_lo:[0,1] neg_hi:[0,1]
v_pk_add_f32 v[16:17], v[16:17], v[18:19]
v_pk_add_f32 v[18:19], v[76:77], v[20:21] neg_lo:[0,1] neg_hi:[0,1]
v_pk_add_f32 v[76:77], v[76:77], v[20:21]
v_pk_add_f32 v[20:21], v[72:73], v[26:27] neg_lo:[0,1] neg_hi:[0,1]
v_pk_add_f32 v[72:73], v[72:73], v[26:27]
v_pk_add_f32 v[26:27], v[22:23], v[24:25] neg_lo:[0,1] neg_hi:[0,1]
v_pk_add_f32 v[22:23], v[22:23], v[24:25]
v_pk_add_f32 v[24:25], v[64:65], v[34:35] neg_lo:[0,1] neg_hi:[0,1]
v_pk_add_f32 v[64:65], v[64:65], v[34:35]
v_pk_add_f32 v[34:35], v[30:31], v[36:37] neg_lo:[0,1] neg_hi:[0,1]
v_pk_add_f32 v[30:31], v[30:31], v[36:37]
v_pk_add_f32 v[36:37], v[28:29], v[42:43] neg_lo:[0,1] neg_hi:[0,1]
v_pk_add_f32 v[28:29], v[28:29], v[42:43]
v_pk_add_f32 v[42:43], v[38:39], v[32:33] neg_lo:[0,1] neg_hi:[0,1]
v_pk_add_f32 v[38:39], v[38:39], v[32:33]
v_pk_add_f32 v[32:33], v[14:15], v[50:51] neg_lo:[0,1] neg_hi:[0,1]
v_pk_add_f32 v[14:15], v[14:15], v[50:51]
v_pk_add_f32 v[50:51], v[46:47], v[52:53] neg_lo:[0,1] neg_hi:[0,1]
v_pk_add_f32 v[46:47], v[46:47], v[52:53]
v_pk_add_f32 v[52:53], v[44:45], v[58:59] neg_lo:[0,1] neg_hi:[0,1]
v_pk_add_f32 v[44:45], v[44:45], v[58:59]
v_pk_add_f32 v[58:59], v[54:55], v[56:57] neg_lo:[0,1] neg_hi:[0,1]
v_pk_add_f32 v[54:55], v[54:55], v[56:57]
v_pk_add_f32 v[56:57], v[40:41], v[66:67] neg_lo:[0,1] neg_hi:[0,1]
v_pk_add_f32 v[40:41], v[40:41], v[66:67]
v_pk_add_f32 v[66:67], v[62:63], v[68:69] neg_lo:[0,1] neg_hi:[0,1]
v_pk_add_f32 v[62:63], v[62:63], v[68:69]
v_pk_add_f32 v[68:69], v[60:61], v[74:75] neg_lo:[0,1] neg_hi:[0,1]
v_pk_add_f32 v[60:61], v[60:61], v[74:75]
v_pk_add_f32 v[74:75], v[70:71], v[48:49] neg_lo:[0,1] neg_hi:[0,1]
v_pk_add_f32 v[70:71], v[70:71], v[48:49]
s_lshl_b32 s12, s38, 2
s_add_u32 s12, s12, s16
s_min_u32 s12, s12, 512
s_lshr_b32 s23, s12, 6
s_xnor_b32 s23, s23, s98
s_and_b32 s23, s23, 1
s_lshl_b32 s23, s23, 13
s_mul_i32 s12, s12, 32768
s_add_u32 s12, s12, 113246208
s_add_u32 s12, s12, s23
buffer_store_dwordx2 v[16:17], v5, s[84:87], s12 offen offset:0 sc1
buffer_store_dwordx2 v[14:15], v5, s[84:87], s12 offen offset:512 sc1
buffer_store_dwordx2 v[64:65], v5, s[84:87], s12 offen offset:1024 sc1
buffer_store_dwordx2 v[40:41], v5, s[84:87], s12 offen offset:1536 sc1
buffer_store_dwordx2 v[72:73], v5, s[84:87], s12 offen offset:2048 sc1
buffer_store_dwordx2 v[44:45], v5, s[84:87], s12 offen offset:2560 sc1
buffer_store_dwordx2 v[28:29], v5, s[84:87], s12 offen offset:3072 sc1
buffer_store_dwordx2 v[60:61], v5, s[84:87], s12 offen offset:3584 sc1
s_add_u32 s12, s12, 4096
buffer_store_dwordx2 v[76:77], v5, s[84:87], s12 offen offset:0 sc1
buffer_store_dwordx2 v[46:47], v5, s[84:87], s12 offen offset:512 sc1
buffer_store_dwordx2 v[30:31], v5, s[84:87], s12 offen offset:1024 sc1
buffer_store_dwordx2 v[62:63], v5, s[84:87], s12 offen offset:1536 sc1
buffer_store_dwordx2 v[22:23], v5, s[84:87], s12 offen offset:2048 sc1
buffer_store_dwordx2 v[54:55], v5, s[84:87], s12 offen offset:2560 sc1
buffer_store_dwordx2 v[38:39], v5, s[84:87], s12 offen offset:3072 sc1
buffer_store_dwordx2 v[70:71], v5, s[84:87], s12 offen offset:3584 sc1
s_add_u32 s12, s12, 12288
buffer_store_dwordx2 v[78:79], v5, s[84:87], s12 offen offset:0 sc1
buffer_store_dwordx2 v[32:33], v5, s[84:87], s12 offen offset:512 sc1
buffer_store_dwordx2 v[24:25], v5, s[84:87], s12 offen offset:1024 sc1
buffer_store_dwordx2 v[56:57], v5, s[84:87], s12 offen offset:1536 sc1
buffer_store_dwordx2 v[20:21], v5, s[84:87], s12 offen offset:2048 sc1
buffer_store_dwordx2 v[52:53], v5, s[84:87], s12 offen offset:2560 sc1
buffer_store_dwordx2 v[36:37], v5, s[84:87], s12 offen offset:3072 sc1
buffer_store_dwordx2 v[68:69], v5, s[84:87], s12 offen offset:3584 sc1
s_add_u32 s12, s12, 4096
buffer_store_dwordx2 v[18:19], v5, s[84:87], s12 offen offset:0 sc1
buffer_store_dwordx2 v[50:51], v5, s[84:87], s12 offen offset:512 sc1
buffer_store_dwordx2 v[34:35], v5, s[84:87], s12 offen offset:1024 sc1
buffer_store_dwordx2 v[66:67], v5, s[84:87], s12 offen offset:1536 sc1
buffer_store_dwordx2 v[26:27], v5, s[84:87], s12 offen offset:2048 sc1
buffer_store_dwordx2 v[58:59], v5, s[84:87], s12 offen offset:2560 sc1
buffer_store_dwordx2 v[42:43], v5, s[84:87], s12 offen offset:3072 sc1
buffer_store_dwordx2 v[74:75], v5, s[84:87], s12 offen offset:3584 sc1
s_add_u32 s12, s12, 4096
s_mov_b32 s38, s21
s_cmp_lt_u32 s38, s37
s_cbranch_scc1 mega_kernel_f2_l
mega_kernel_f2_e:
mega_kernel_f2e:
s_waitcnt vmcnt(0)
s_barrier
v_mov_b32 v1, 0
v_mov_b32 v2, 1
s_mov_b32 s82, 69259392
v_cmp_eq_u32 vcc, 0, v0
s_and_saveexec_b64 s[80:81], vcc
s_cbranch_execz mega_kernel_sg1
buffer_atomic_add v2, v1, s[84:87], s82 offen sc1
mega_kernel_sg1:
s_mov_b64 exec, s[80:81]
s_mov_b32 s64, 0
s_mov_b32 s65, 58
s_lshl_b32 s66, s40, 13
s_add_u32 s66, s66, 67633152
s_mov_b32 s67, 0
s_mov_b32 s68, 0
s_cmp_eq_u32 s91, 3
s_cbranch_scc1 mega_kernel_out
s_cmp_lt_u32 s92, 1
s_cbranch_scc1 mega_kernel_back
s_mov_b32 s68, 1
s_branch mega_kernel_out
mega_kernel_back:
s_lshl_b32 s68, s68, 1
s_mov_b32 s93, s92
s_load_dwordx2 s[4:5], s[0:1], 80
s_mov_b32 s48, 0x3f7ec46d
s_mov_b32 s49, 0x3dc8bd36
s_mov_b32 s50, 0x3f7b14be
s_mov_b32 s51, 0x3e47c5c2
s_mov_b32 s52, 0x3f74fa0b
s_mov_b32 s53, 0x3e94a031
s_mov_b32 s54, 0x3f6c835e
s_mov_b32 s55, 0x3ec3ef15
s_mov_b32 s56, 0x3f61c598
s_mov_b32 s57, 0x3ef15aea
s_mov_b32 s58, 0x3f54db31
s_mov_b32 s59, 0x3f0e39da
s_mov_b32 s60, 0x3f45e403
s_mov_b32 s61, 0x3f226799
s_mov_b32 s62, 0x3f3504f3
s_mov_b32 s63, 0x3f3504f3
v_and_b32 v1, 31, v0
v_lshrrev_b32 v2, 5, v0
v_cvt_f32_u32 v3, v1
v_mul_u32_u24 v10, 8448, v2
v_lshl_add_u32 v4, v1, 3, v10
v_mul_u32_u24 v5, 264, v1
v_add_u32 v5, v5, v10
v_and_b32 v11, 7, v0
v_lshrrev_b32 v9, 3, v0
v_mul_u32_u24 v10, 8448, v11
v_lshl_add_u32 v6, v9, 3, v10
v_lshlrev_b32 v7, 3, v9
v_sub_u32 v7, v10, v7
v_add_u32 v7, 4096, v7
v_mul_u32_u24 v8, 32768, v9
v_lshl_add_u32 v8, v11, 4, v8
v_mul_f32 v12, 0x3a800000, v3
v_cos_f32 v82, v12
v_sin_f32 v83, v12
v_mul_f32 v12, 0x3b000000, v3
v_cos_f32 v84, v12
v_sin_f32 v85, v12
v_mul_f32 v12, 0x3b400000, v3
v_cos_f32 v86, v12
v_sin_f32 v87, v12
v_mul_f32 v12, 0x3b800000, v3
v_cos_f32 v88, v12
v_sin_f32 v89, v12
v_mul_f32 v12, 0x3ba00000, v3
v_cos_f32 v90, v12
v_sin_f32 v91, v12
v_mul_f32 v12, 0x3bc00000, v3
v_cos_f32 v92, v12
v_sin_f32 v93, v12
v_mul_f32 v12, 0x3be00000, v3
v_cos_f32 v94, v12
v_sin_f32 v95, v12
v_mul_f32 v12, 0x3c000000, v3
v_cos_f32 v96, v12
v_sin_f32 v97, v12
v_mul_f32 v12, 0x3c100000, v3
v_cos_f32 v98, v12
v_sin_f32 v99, v12
v_mul_f32 v12, 0x3c200000, v3
v_cos_f32 v100, v12
v_sin_f32 v101, v12
v_mul_f32 v12, 0x3c300000, v3
v_cos_f32 v102, v12
v_sin_f32 v103, v12
v_mul_f32 v12, 0x3c400000, v3
v_cos_f32 v104, v12
v_sin_f32 v105, v12
v_mul_f32 v12, 0x3c500000, v3
v_cos_f32 v106, v12
v_sin_f32 v107, v12
v_mul_f32 v12, 0x3c600000, v3
v_cos_f32 v108, v12
v_sin_f32 v109, v12
v_mul_f32 v12, 0x3c700000, v3
v_cos_f32 v110, v12
v_sin_f32 v111, v12
v_mul_f32 v12, 0x3c800000, v3
v_cos_f32 v112, v12
v_sin_f32 v113, v12
v_mul_f32 v12, 0x3c880000, v3
v_cos_f32 v114, v12
v_sin_f32 v115, v12
v_mul_f32 v12, 0x3c900000, v3
v_cos_f32 v116, v12
v_sin_f32 v117, v12
v_mul_f32 v12, 0x3c980000, v3
v_cos_f32 v118, v12
v_sin_f32 v119, v12
v_mul_f32 v12, 0x3ca00000, v3
v_cos_f32 v120, v12
v_sin_f32 v121, v12
v_mul_f32 v12, 0x3ca80000, v3
v_cos_f32 v122, v12
v_sin_f32 v123, v12
v_mul_f32 v12, 0x3cb00000, v3
v_cos_f32 v124, v12
v_sin_f32 v125, v12
v_mul_f32 v12, 0x3cb80000, v3
v_cos_f32 v126, v12
v_sin_f32 v127, v12
v_mul_f32 v12, 0x3cc00000, v3
v_cos_f32 v128, v12
v_sin_f32 v129, v12
v_mul_f32 v12, 0x3cc80000, v3
v_cos_f32 v130, v12
v_sin_f32 v131, v12
v_mul_f32 v12, 0x3cd00000, v3
v_cos_f32 v132, v12
v_sin_f32 v133, v12
v_mul_f32 v12, 0x3cd80000, v3
v_cos_f32 v134, v12
v_sin_f32 v135, v12
v_mul_f32 v12, 0x3ce00000, v3
v_cos_f32 v136, v12
v_sin_f32 v137, v12
v_mul_f32 v12, 0x3ce80000, v3
v_cos_f32 v138, v12
v_sin_f32 v139, v12
v_mul_f32 v12, 0x3cf00000, v3
v_cos_f32 v140, v12
v_sin_f32 v141, v12
v_mul_f32 v12, 0x3cf80000, v3
v_cos_f32 v142, v12
v_sin_f32 v143, v12
v_lshlrev_b32 v12, 2, v1
v_sub_u32 v12, v4, v12
v_and_b32 v10, 127, v0
v_lshrrev_b32 v11, 7, v0
v_lshlrev_b32 v2, 5, v10
v_lshl_add_u32 v2, v11, 12, v2
v_lshlrev_b32 v3, 4, v10
v_lshl_add_u32 v3, v11, 12, v3
v_add_u32 v3, 2048, v3
v_cmp_eq_u32 s[14:15], 0, v9
s_waitcnt lgkmcnt(0)
s_mov_b32 s6, 8388608
s_mov_b32 s7, 0x00020000
v_mov_b32 v250, 0
s_mov_b32 s82, 69259392
mega_kernel_w1:
s_sleep 8
buffer_load_dword v251, v250, s[84:87], s82 offen sc1
s_waitcnt vmcnt(0)
v_cmp_ne_u32 vcc, 95, v251
s_cbranch_vccnz mega_kernel_w1
s_cmp_lt_u32 s93, 128
s_cbranch_scc0 mega_kernel_f3_e
s_lshl_b32 s12, s93, 7
s_and_b32 s23, s12, 0x2000
s_add_u32 s12, s12, s23
s_xor_b32 s23, s98, 1
s_lshl_b32 s23, s23, 13
s_add_u32 s12, s12, s23
s_add_u32 s12, s12, 113246208
buffer_load_dwordx4 v[144:147], v8, s[84:87], s12 offen sc1
s_add_u32 s12, s12, 1048576
buffer_load_dwordx4 v[148:151], v8, s[84:87], s12 offen sc1
s_add_u32 s12, s12, 1048576
s_xor_b32 s12, s12, 0x2000
buffer_load_dwordx4 v[152:155], v8, s[84:87], s12 offen sc1
s_add_u32 s12, s12, 1048576
buffer_load_dwordx4 v[156:159], v8, s[84:87], s12 offen sc1
s_add_u32 s12, s12, 1048576
s_xor_b32 s12, s12, 0x2000
buffer_load_dwordx4 v[160:163], v8, s[84:87], s12 offen sc1
s_add_u32 s12, s12, 1048576
buffer_load_dwordx4 v[164:167], v8, s[84:87], s12 offen sc1
s_add_u32 s12, s12, 1048576
s_xor_b32 s12, s12, 0x2000
buffer_load_dwordx4 v[168:171], v8, s[84:87], s12 offen sc1
s_add_u32 s12, s12, 1048576
buffer_load_dwordx4 v[172:175], v8, s[84:87], s12 offen sc1
s_add_u32 s12, s12, 1048576
s_xor_b32 s12, s12, 0x2000
buffer_load_dwordx4 v[176:179], v8, s[84:87], s12 offen sc1
s_add_u32 s12, s12, 1048576
buffer_load_dwordx4 v[180:183], v8, s[84:87], s12 offen sc1
s_add_u32 s12, s12, 1048576
s_xor_b32 s12, s12, 0x2000
buffer_load_dwordx4 v[184:187], v8, s[84:87], s12 offen sc1
s_add_u32 s12, s12, 1048576
buffer_load_dwordx4 v[188:191], v8, s[84:87], s12 offen sc1
s_add_u32 s12, s12, 1048576
s_xor_b32 s12, s12, 0x2000
buffer_load_dwordx4 v[192:195], v8, s[84:87], s12 offen sc1
s_add_u32 s12, s12, 1048576
buffer_load_dwordx4 v[196:199], v8, s[84:87], s12 offen sc1
s_add_u32 s12, s12, 1048576
s_xor_b32 s12, s12, 0x2000
buffer_load_dwordx4 v[200:203], v8, s[84:87], s12 offen sc1
s_add_u32 s12, s12, 1048576
buffer_load_dwordx4 v[204:207], v8, s[84:87], s12 offen sc1
s_add_u32 s12, s12, 1048576
s_xor_b32 s12, s12, 0x2000
buffer_load_dwordx4 v[208:211], v8, s[84:87], s12 offen sc1
s_add_u32 s12, s12, 1048576
s_waitcnt vmcnt(0)
mega_kernel_f3_l:
s_add_u32 s21, s93, 64
s_cmp_lt_u32 s21, 128
s_cselect_b32 s22, s21, s93
s_waitcnt vmcnt(8)
s_barrier
v_cndmask_b32 v145, v145, 0, s[14:15]
v_cndmask_b32 v147, v147, 0, s[14:15]
v_cndmask_b32 v209, v209, 0, s[14:15]
v_cndmask_b32 v211, v211, 0, s[14:15]
v_pk_add_f32 v[16:17], v[144:145], v[146:147] op_sel:[0,1] op_sel_hi:[1,0] neg_lo:[0,1]
v_pk_add_f32 v[18:19], v[144:145], v[146:147] op_sel:[0,1] op_sel_hi:[1,0] neg_hi:[1,0]
ds_write_b64 v6, v[16:17] offset:0
ds_write_b64 v7, v[18:19] offset:4096
v_pk_add_f32 v[20:21], v[148:149], v[150:151] op_sel:[0,1] op_sel_hi:[1,0] neg_lo:[0,1]
v_pk_add_f32 v[22:23], v[148:149], v[150:151] op_sel:[0,1] op_sel_hi:[1,0] neg_hi:[1,0]
ds_write_b64 v6, v[20:21] offset:256
ds_write_b64 v7, v[22:23] offset:3840
v_pk_add_f32 v[24:25], v[152:153], v[154:155] op_sel:[0,1] op_sel_hi:[1,0] neg_lo:[0,1]
v_pk_add_f32 v[26:27], v[152:153], v[154:155] op_sel:[0,1] op_sel_hi:[1,0] neg_hi:[1,0]
ds_write_b64 v6, v[24:25] offset:512
ds_write_b64 v7, v[26:27] offset:3584
v_pk_add_f32 v[28:29], v[156:157], v[158:159] op_sel:[0,1] op_sel_hi:[1,0] neg_lo:[0,1]
v_pk_add_f32 v[30:31], v[156:157], v[158:159] op_sel:[0,1] op_sel_hi:[1,0] neg_hi:[1,0]
ds_write_b64 v6, v[28:29] offset:768
ds_write_b64 v7, v[30:31] offset:3328
v_pk_add_f32 v[32:33], v[160:161], v[162:163] op_sel:[0,1] op_sel_hi:[1,0] neg_lo:[0,1]
v_pk_add_f32 v[34:35], v[160:161], v[162:163] op_sel:[0,1] op_sel_hi:[1,0] neg_hi:[1,0]
ds_write_b64 v6, v[32:33] offset:1024
ds_write_b64 v7, v[34:35] offset:3072
v_pk_add_f32 v[36:37], v[164:165], v[166:167] op_sel:[0,1] op_sel_hi:[1,0] neg_lo:[0,1]
v_pk_add_f32 v[38:39], v[164:165], v[166:167] op_sel:[0,1] op_sel_hi:[1,0] neg_hi:[1,0]
ds_write_b64 v6, v[36:37] offset:1280
ds_write_b64 v7, v[38:39] offset:2816
v_pk_add_f32 v[40:41], v[168:169], v[170:171] op_sel:[0,1] op_sel_hi:[1,0] neg_lo:[0,1]
v_pk_add_f32 v[42:43], v[168:169], v[170:171] op_sel:[0,1] op_sel_hi:[1,0] neg_hi:[1,0]
ds_write_b64 v6, v[40:41] offset:1536
ds_write_b64 v7, v[42:43] offset:2560
v_pk_add_f32 v[44:45], v[172:173], v[174:175] op_sel:[0,1] op_sel_hi:[1,0] neg_lo:[0,1]
v_pk_add_f32 v[46:47], v[172:173], v[174:175] op_sel:[0,1] op_sel_hi:[1,0] neg_hi:[1,0]
ds_write_b64 v6, v[44:45] offset:1792
ds_write_b64 v7, v[46:47] offset:2304
v_pk_add_f32 v[48:49], v[176:177], v[178:179] op_sel:[0,1] op_sel_hi:[1,0] neg_lo:[0,1]
v_pk_add_f32 v[50:51], v[176:177], v[178:179] op_sel:[0,1] op_sel_hi:[1,0] neg_hi:[1,0]
ds_write_b64 v6, v[48:49] offset:2048
ds_write_b64 v7, v[50:51] offset:2048
v_pk_add_f32 v[52:53], v[180:181], v[182:183] op_sel:[0,1] op_sel_hi:[1,0] neg_lo:[0,1]
v_pk_add_f32 v[54:55], v[180:181], v[182:183] op_sel:[0,1] op_sel_hi:[1,0] neg_hi:[1,0]
ds_write_b64 v6, v[52:53] offset:2304
ds_write_b64 v7, v[54:55] offset:1792
v_pk_add_f32 v[56:57], v[184:185], v[186:187] op_sel:[0,1] op_sel_hi:[1,0] neg_lo:[0,1]
v_pk_add_f32 v[58:59], v[184:185], v[186:187] op_sel:[0,1] op_sel_hi:[1,0] neg_hi:[1,0]
ds_write_b64 v6, v[56:57] offset:2560
ds_write_b64 v7, v[58:59] offset:1536
v_pk_add_f32 v[60:61], v[188:189], v[190:191] op_sel:[0,1] op_sel_hi:[1,0] neg_lo:[0,1]
v_pk_add_f32 v[62:63], v[188:189], v[190:191] op_sel:[0,1] op_sel_hi:[1,0] neg_hi:[1,0]
ds_write_b64 v6, v[60:61] offset:2816
ds_write_b64 v7, v[62:63] offset:1280
v_pk_add_f32 v[64:65], v[192:193], v[194:195] op_sel:[0,1] op_sel_hi:[1,0] neg_lo:[0,1]
v_pk_add_f32 v[66:67], v[192:193], v[194:195] op_sel:[0,1] op_sel_hi:[1,0] neg_hi:[1,0]
ds_write_b64 v6, v[64:65] offset:3072
ds_write_b64 v7, v[66:67] offset:1024
v_pk_add_f32 v[68:69], v[196:197], v[198:199] op_sel:[0,1] op_sel_hi:[1,0] neg_lo:[0,1]
v_pk_add_f32 v[70:71], v[196:197], v[198:199] op_sel:[0,1] op_sel_hi:[1,0] neg_hi:[1,0]
ds_write_b64 v6, v[68:69] offset:3328
ds_write_b64 v7, v[70:71] offset:768
v_pk_add_f32 v[72:73], v[200:201], v[202:203] op_sel:[0,1] op_sel_hi:[1,0] neg_lo:[0,1]
v_pk_add_f32 v[74:75], v[200:201], v[202:203] op_sel:[0,1] op_sel_hi:[1,0] neg_hi:[1,0]
ds_write_b64 v6, v[72:73] offset:3584
ds_write_b64 v7, v[74:75] offset:512
s_waitcnt lgkmcnt(8)
v_pk_add_f32 v[76:77], v[204:205], v[206:207] op_sel:[0,1] op_sel_hi:[1,0] neg_lo:[0,1]
v_pk_add_f32 v[78:79], v[204:205], v[206:207] op_sel:[0,1] op_sel_hi:[1,0] neg_hi:[1,0]
ds_write_b64 v6, v[76:77] offset:3840
ds_write_b64 v7, v[78:79] offset:256
v_pk_add_f32 v[16:17], v[208:209], v[210:211] op_sel:[0,1] op_sel_hi:[1,0] neg_lo:[0,1]
v_pk_add_f32 v[18:19], v[208:209], v[210:211] op_sel:[0,1] op_sel_hi:[1,0] neg_hi:[1,0]
s_mov_b64 exec, s[14:15]
ds_write_b64 v6, v[16:17] offset:4096
s_mov_b64 exec, -1
s_lshl_b32 s12, s22, 7
s_and_b32 s23, s12, 0x2000
s_add_u32 s12, s12, s23
s_xor_b32 s23, s98, 1
s_lshl_b32 s23, s23, 13
s_add_u32 s12, s12, s23
s_add_u32 s12, s12, 113246208
buffer_load_dwordx4 v[144:147], v8, s[84:87], s12 offen sc1
s_add_u32 s12, s12, 1048576
buffer_load_dwordx4 v[148:151], v8, s[84:87], s12 offen sc1
s_add_u32 s12, s12, 1048576
s_xor_b32 s12, s12, 0x2000
buffer_load_dwordx4 v[152:155], v8, s[84:87], s12 offen sc1
s_add_u32 s12, s12, 1048576
buffer_load_dwordx4 v[156:159], v8, s[84:87], s12 offen sc1
s_add_u32 s12, s12, 1048576
s_xor_b32 s12, s12, 0x2000
buffer_load_dwordx4 v[160:163], v8, s[84:87], s12 offen sc1
s_add_u32 s12, s12, 1048576
buffer_load_dwordx4 v[164:167], v8, s[84:87], s12 offen sc1
s_add_u32 s12, s12, 1048576
s_xor_b32 s12, s12, 0x2000
buffer_load_dwordx4 v[168:171], v8, s[84:87], s12 offen sc1
s_add_u32 s12, s12, 1048576
buffer_load_dwordx4 v[172:175], v8, s[84:87], s12 offen sc1
s_add_u32 s12, s12, 1048576
s_xor_b32 s12, s12, 0x2000
buffer_load_dwordx4 v[176:179], v8, s[84:87], s12 offen sc1
s_add_u32 s12, s12, 1048576
buffer_load_dwordx4 v[180:183], v8, s[84:87], s12 offen sc1
s_add_u32 s12, s12, 1048576
s_xor_b32 s12, s12, 0x2000
buffer_load_dwordx4 v[184:187], v8, s[84:87], s12 offen sc1
s_add_u32 s12, s12, 1048576
buffer_load_dwordx4 v[188:191], v8, s[84:87], s12 offen sc1
s_add_u32 s12, s12, 1048576
s_xor_b32 s12, s12, 0x2000
buffer_load_dwordx4 v[192:195], v8, s[84:87], s12 offen sc1
s_add_u32 s12, s12, 1048576
buffer_load_dwordx4 v[196:199], v8, s[84:87], s12 offen sc1
s_add_u32 s12, s12, 1048576
s_xor_b32 s12, s12, 0x2000
buffer_load_dwordx4 v[200:203], v8, s[84:87], s12 offen sc1
s_add_u32 s12, s12, 1048576
buffer_load_dwordx4 v[204:207], v8, s[84:87], s12 offen sc1
s_add_u32 s12, s12, 1048576
s_xor_b32 s12, s12, 0x2000
buffer_load_dwordx4 v[208:211], v8, s[84:87], s12 offen sc1
s_add_u32 s12, s12, 1048576
s_waitcnt lgkmcnt(0)
s_barrier
ds_read_b64 v[16:17], v4 offset:0
ds_read_b64 v[48:49], v4 offset:4096
ds_read_b64 v[18:19], v4 offset:256
ds_read_b64 v[50:51], v4 offset:4352
ds_read_b64 v[20:21], v4 offset:512
ds_read_b64 v[52:53], v4 offset:4608
ds_read_b64 v[22:23], v4 offset:768
ds_read_b64 v[54:55], v4 offset:4864
ds_read_b64 v[24:25], v4 offset:1024
ds_read_b64 v[56:57], v4 offset:5120
ds_read_b64 v[26:27], v4 offset:1280
ds_read_b64 v[58:59], v4 offset:5376
ds_read_b64 v[28:29], v4 offset:1536
ds_read_b64 v[60:61], v4 offset:5632
ds_read_b64 v[30:31], v4 offset:1792
ds_read_b64 v[62:63], v4 offset:5888
ds_read_b64 v[32:33], v4 offset:2048
ds_read_b64 v[64:65], v4 offset:6144
ds_read_b64 v[34:35], v4 offset:2304
ds_read_b64 v[66:67], v4 offset:6400
ds_read_b64 v[36:37], v4 offset:2560
ds_read_b64 v[68:69], v4 offset:6656
ds_read_b64 v[38:39], v4 offset:2816
ds_read_b64 v[70:71], v4 offset:6912
ds_read_b64 v[40:41], v4 offset:3072
ds_read_b64 v[72:73], v4 offset:7168
ds_read_b64 v[42:43], v4 offset:3328
ds_read_b64 v[74:75], v4 offset:7424
ds_read_b64 v[44:45], v4 offset:3584
ds_read_b64 v[76:77], v4 offset:7680
ds_read_b64 v[46:47], v4 offset:3840
ds_read_b64 v[78:79], v4 offset:7936
s_waitcnt lgkmcnt(0)
v_pk_add_f32 v[14:15], v[16:17], v[48:49] neg_lo:[0,1] neg_hi:[0,1]
v_pk_add_f32 v[16:17], v[16:17], v[48:49]
v_pk_add_f32 v[48:49], v[18:19], v[50:51] neg_lo:[0,1] neg_hi:[0,1]
v_pk_add_f32 v[18:19], v[18:19], v[50:51]
v_pk_mul_f32 v[50:51], v[48:49], s[50:51] op_sel:[0,0] op_sel_hi:[0,1] neg_lo:[0,0] neg_hi:[0,0]
v_pk_fma_f32 v[50:51], v[48:49], s[50:51], v[50:51] op_sel:[1,1,0] op_sel_hi:[1,0,1] neg_lo:[0,1,0] neg_hi:[0,0,0]
v_pk_add_f32 v[48:49], v[20:21], v[52:53] neg_lo:[0,1] neg_hi:[0,1]
v_pk_add_f32 v[20:21], v[20:21], v[52:53]
v_pk_mul_f32 v[52:53], v[48:49], s[54:55] op_sel:[0,0] op_sel_hi:[0,1] neg_lo:[0,0] neg_hi:[0,0]
v_pk_fma_f32 v[52:53], v[48:49], s[54:55], v[52:53] op_sel:[1,1,0] op_sel_hi:[1,0,1] neg_lo:[0,1,0] neg_hi:[0,0,0]
v_pk_add_f32 v[48:49], v[22:23], v[54:55] neg_lo:[0,1] neg_hi:[0,1]
v_pk_add_f32 v[22:23], v[22:23], v[54:55]
v_pk_mul_f32 v[54:55], v[48:49], s[58:59] op_sel:[0,0] op_sel_hi:[0,1] neg_lo:[0,0] neg_hi:[0,0]
v_pk_fma_f32 v[54:55], v[48:49], s[58:59], v[54:55] op_sel:[1,1,0] op_sel_hi:[1,0,1] neg_lo:[0,1,0] neg_hi:[0,0,0]
v_pk_add_f32 v[48:49], v[24:25], v[56:57] neg_lo:[0,1] neg_hi:[0,1]
v_pk_add_f32 v[24:25], v[24:25], v[56:57]
v_pk_mul_f32 v[56:57], v[48:49], s[62:63] op_sel:[0,0] op_sel_hi:[0,1] neg_lo:[0,0] neg_hi:[0,0]
v_pk_fma_f32 v[56:57], v[48:49], s[62:63], v[56:57] op_sel:[1,1,0] op_sel_hi:[1,0,1] neg_lo:[0,1,0] neg_hi:[0,0,0]
v_pk_add_f32 v[48:49], v[26:27], v[58:59] neg_lo:[0,1] neg_hi:[0,1]
v_pk_add_f32 v[26:27], v[26:27], v[58:59]
v_pk_mul_f32 v[58:59], v[48:49], s[58:59] op_sel:[0,1] op_sel_hi:[0,0] neg_lo:[0,0] neg_hi:[0,0]
v_pk_fma_f32 v[58:59], v[48:49], s[58:59], v[58:59] op_sel:[1,0,0] op_sel_hi:[1,1,1] neg_lo:[0,1,0] neg_hi:[0,0,0]
v_pk_add_f32 v[48:49], v[28:29], v[60:61] neg_lo:[0,1] neg_hi:[0,1]
v_pk_add_f32 v[28:29], v[28:29], v[60:61]
v_pk_mul_f32 v[60:61], v[48:49], s[54:55] op_sel:[0,1] op_sel_hi:[0,0] neg_lo:[0,0] neg_hi:[0,0]
v_pk_fma_f32 v[60:61], v[48:49], s[54:55], v[60:61] op_sel:[1,0,0] op_sel_hi:[1,1,1] neg_lo:[0,1,0] neg_hi:[0,0,0]
v_pk_add_f32 v[48:49], v[30:31], v[62:63] neg_lo:[0,1] neg_hi:[0,1]
v_pk_add_f32 v[30:31], v[30:31], v[62:63]
v_pk_mul_f32 v[62:63], v[48:49], s[50:51] op_sel:[0,1] op_sel_hi:[0,0] neg_lo:[0,0] neg_hi:[0,0]
v_pk_fma_f32 v[62:63], v[48:49], s[50:51], v[62:63] op_sel:[1,0,0] op_sel_hi:[1,1,1] neg_lo:[0,1,0] neg_hi:[0,0,0]
v_pk_add_f32 v[48:49], v[32:33], v[64:65] op_sel:[1,1] op_sel_hi:[0,0] neg_lo:[1,0] neg_hi:[0,1]
v_pk_add_f32 v[32:33], v[32:33], v[64:65]
v_pk_add_f32 v[64:65], v[34:35], v[66:67] neg_lo:[0,1] neg_hi:[0,1]
v_pk_add_f32 v[34:35], v[34:35], v[66:67]
v_pk_mul_f32 v[66:67], v[64:65], s[50:51] op_sel:[0,1] op_sel_hi:[0,0] neg_lo:[0,1] neg_hi:[0,0]
v_pk_fma_f32 v[66:67], v[64:65], s[50:51], v[66:67] op_sel:[1,0,0] op_sel_hi:[1,1,1] neg_lo:[0,1,0] neg_hi:[0,1,0]
v_pk_add_f32 v[64:65], v[36:37], v[68:69] neg_lo:[0,1] neg_hi:[0,1]
v_pk_add_f32 v[36:37], v[36:37], v[68:69]
v_pk_mul_f32 v[68:69], v[64:65], s[54:55] op_sel:[0,1] op_sel_hi:[0,0] neg_lo:[0,1] neg_hi:[0,0]
v_pk_fma_f32 v[68:69], v[64:65], s[54:55], v[68:69] op_sel:[1,0,0] op_sel_hi:[1,1,1] neg_lo:[0,1,0] neg_hi:[0,1,0]
v_pk_add_f32 v[64:65], v[38:39], v[70:71] neg_lo:[0,1] neg_hi:[0,1]
v_pk_add_f32 v[38:39], v[38:39], v[70:71]
v_pk_mul_f32 v[70:71], v[64:65], s[58:59] op_sel:[0,1] op_sel_hi:[0,0] neg_lo:[0,1] neg_hi:[0,0]
v_pk_fma_f32 v[70:71], v[64:65], s[58:59], v[70:71] op_sel:[1,0,0] op_sel_hi:[1,1,1] neg_lo:[0,1,0] neg_hi:[0,1,0]
v_pk_add_f32 v[64:65], v[40:41], v[72:73] neg_lo:[0,1] neg_hi:[0,1]
v_pk_add_f32 v[40:41], v[40:41], v[72:73]
v_pk_mul_f32 v[72:73], v[64:65], s[62:63] op_sel:[0,0] op_sel_hi:[0,1] neg_lo:[0,1] neg_hi:[0,0]
v_pk_fma_f32 v[72:73], v[64:65], s[62:63], v[72:73] op_sel:[1,1,0] op_sel_hi:[1,0,1] neg_lo:[0,1,0] neg_hi:[0,1,0]
v_pk_add_f32 v[64:65], v[42:43], v[74:75] neg_lo:[0,1] neg_hi:[0,1]
v_pk_add_f32 v[42:43], v[42:43], v[74:75]
v_pk_mul_f32 v[74:75], v[64:65], s[58:59] op_sel:[0,0] op_sel_hi:[0,1] neg_lo:[0,1] neg_hi:[0,0]
v_pk_fma_f32 v[74:75], v[64:65], s[58:59], v[74:75] op_sel:[1,1,0] op_sel_hi:[1,0,1] neg_lo:[0,1,0] neg_hi:[0,1,0]
v_pk_add_f32 v[64:65], v[44:45], v[76:77] neg_lo:[0,1] neg_hi:[0,1]
v_pk_add_f32 v[44:45], v[44:45], v[76:77]
v_pk_mul_f32 v[76:77], v[64:65], s[54:55] op_sel:[0,0] op_sel_hi:[0,1] neg_lo:[0,1] neg_hi:[0,0]
v_pk_fma_f32 v[76:77], v[64:65], s[54:55], v[76:77] op_sel:[1,1,0] op_sel_hi:[1,0,1] neg_lo:[0,1,0] neg_hi:[0,1,0]
v_pk_add_f32 v[64:65], v[46:47], v[78:79] neg_lo:[0,1] neg_hi:[0,1]
v_pk_add_f32 v[46:47], v[46:47], v[78:79]
v_pk_mul_f32 v[78:79], v[64:65], s[50:51] op_sel:[0,0] op_sel_hi:[0,1] neg_lo:[0,1] neg_hi:[0,0]
v_pk_fma_f32 v[78:79], v[64:65], s[50:51], v[78:79] op_sel:[1,1,0] op_sel_hi:[1,0,1] neg_lo:[0,1,0] neg_hi:[0,1,0]
v_pk_add_f32 v[64:65], v[16:17], v[32:33] neg_lo:[0,1] neg_hi:[0,1]
v_pk_add_f32 v[16:17], v[16:17], v[32:33]
v_pk_add_f32 v[32:33], v[18:19], v[34:35] neg_lo:[0,1] neg_hi:[0,1]
v_pk_add_f32 v[18:19], v[18:19], v[34:35]
v_pk_mul_f32 v[34:35], v[32:33], s[54:55] op_sel:[0,0] op_sel_hi:[0,1] neg_lo:[0,0] neg_hi:[0,0]
v_pk_fma_f32 v[34:35], v[32:33], s[54:55], v[34:35] op_sel:[1,1,0] op_sel_hi:[1,0,1] neg_lo:[0,1,0] neg_hi:[0,0,0]
v_pk_add_f32 v[32:33], v[20:21], v[36:37] neg_lo:[0,1] neg_hi:[0,1]
v_pk_add_f32 v[20:21], v[20:21], v[36:37]
v_pk_mul_f32 v[36:37], v[32:33], s[62:63] op_sel:[0,0] op_sel_hi:[0,1] neg_lo:[0,0] neg_hi:[0,0]
v_pk_fma_f32 v[36:37], v[32:33], s[62:63], v[36:37] op_sel:[1,1,0] op_sel_hi:[1,0,1] neg_lo:[0,1,0] neg_hi:[0,0,0]
v_pk_add_f32 v[32:33], v[22:23], v[38:39] neg_lo:[0,1] neg_hi:[0,1]
v_pk_add_f32 v[22:23], v[22:23], v[38:39]
v_pk_mul_f32 v[38:39], v[32:33], s[54:55] op_sel:[0,1] op_sel_hi:[0,0] neg_lo:[0,0] neg_hi:[0,0]
v_pk_fma_f32 v[38:39], v[32:33], s[54:55], v[38:39] op_sel:[1,0,0] op_sel_hi:[1,1,1] neg_lo:[0,1,0] neg_hi:[0,0,0]
v_pk_add_f32 v[32:33], v[24:25], v[40:41] op_sel:[1,1] op_sel_hi:[0,0] neg_lo:[1,0] neg_hi:[0,1]
v_pk_add_f32 v[24:25], v[24:25], v[40:41]
v_pk_add_f32 v[40:41], v[26:27], v[42:43] neg_lo:[0,1] neg_hi:[0,1]
v_pk_add_f32 v[26:27], v[26:27], v[42:43]
v_pk_mul_f32 v[42:43], v[40:41], s[54:55] op_sel:[0,1] op_sel_hi:[0,0] neg_lo:[0,1] neg_hi:[0,0]
v_pk_fma_f32 v[42:43], v[40:41], s[54:55], v[42:43] op_sel:[1,0,0] op_sel_hi:[1,1,1] neg_lo:[0,1,0] neg_hi:[0,1,0]
v_pk_add_f32 v[40:41], v[28:29], v[44:45] neg_lo:[0,1] neg_hi:[0,1]
v_pk_add_f32 v[28:29], v[28:29], v[44:45]
v_pk_mul_f32 v[44:45], v[40:41], s[62:63] op_sel:[0,0] op_sel_hi:[0,1] neg_lo:[0,1] neg_hi:[0,0]
v_pk_fma_f32 v[44:45], v[40:41], s[62:63], v[44:45] op_sel:[1,1,0] op_sel_hi:[1,0,1] neg_lo:[0,1,0] neg_hi:[0,1,0]
v_pk_add_f32 v[40:41], v[30:31], v[46:47] neg_lo:[0,1] neg_hi:[0,1]
v_pk_add_f32 v[30:31], v[30:31], v[46:47]
v_pk_mul_f32 v[46:47], v[40:41], s[54:55] op_sel:[0,0] op_sel_hi:[0,1] neg_lo:[0,1] neg_hi:[0,0]
v_pk_fma_f32 v[46:47], v[40:41], s[54:55], v[46:47] op_sel:[1,1,0] op_sel_hi:[1,0,1] neg_lo:[0,1,0] neg_hi:[0,1,0]
v_pk_add_f32 v[40:41], v[14:15], v[48:49] neg_lo:[0,1] neg_hi:[0,1]
v_pk_add_f32 v[14:15], v[14:15], v[48:49]
v_pk_add_f32 v[48:49], v[50:51], v[66:67] neg_lo:[0,1] neg_hi:[0,1]
v_pk_add_f32 v[50:51], v[50:51], v[66:67]
v_pk_mul_f32 v[66:67], v[48:49], s[54:55] op_sel:[0,0] op_sel_hi:[0,1] neg_lo:[0,0] neg_hi:[0,0]
v_pk_fma_f32 v[66:67], v[48:49], s[54:55], v[66:67] op_sel:[1,1,0] op_sel_hi:[1,0,1] neg_lo:[0,1,0] neg_hi:[0,0,0]
v_pk_add_f32 v[48:49], v[52:53], v[68:69] neg_lo:[0,1] neg_hi:[0,1]
v_pk_add_f32 v[52:53], v[52:53], v[68:69]
v_pk_mul_f32 v[68:69], v[48:49], s[62:63] op_sel:[0,0] op_sel_hi:[0,1] neg_lo:[0,0] neg_hi:[0,0]
v_pk_fma_f32 v[68:69], v[48:49], s[62:63], v[68:69] op_sel:[1,1,0] op_sel_hi:[1,0,1] neg_lo:[0,1,0] neg_hi:[0,0,0]
v_pk_add_f32 v[48:49], v[54:55], v[70:71] neg_lo:[0,1] neg_hi:[0,1]
v_pk_add_f32 v[54:55], v[54:55], v[70:71]
v_pk_mul_f32 v[70:71], v[48:49], s[54:55] op_sel:[0,1] op_sel_hi:[0,0] neg_lo:[0,0] neg_hi:[0,0]
v_pk_fma_f32 v[70:71], v[48:49], s[54:55], v[70:71] op_sel:[1,0,0] op_sel_hi:[1,1,1] neg_lo:[0,1,0] neg_hi:[0,0,0]
v_pk_add_f32 v[48:49], v[56:57], v[72:73] op_sel:[1,1] op_sel_hi:[0,0] neg_lo:[1,0] neg_hi:[0,1]
v_pk_add_f32 v[56:57], v[56:57], v[72:73]
v_pk_add_f32 v[72:73], v[58:59], v[74:75] neg_lo:[0,1] neg_hi:[0,1]
v_pk_add_f32 v[58:59], v[58:59], v[74:75]
v_pk_mul_f32 v[74:75], v[72:73], s[54:55] op_sel:[0,1] op_sel_hi:[0,0] neg_lo:[0,1] neg_hi:[0,0]
v_pk_fma_f32 v[74:75], v[72:73], s[54:55], v[74:75] op_sel:[1,0,0] op_sel_hi:[1,1,1] neg_lo:[0,1,0] neg_hi:[0,1,0]
v_pk_add_f32 v[72:73], v[60:61], v[76:77] neg_lo:[0,1] neg_hi:[0,1]
v_pk_add_f32 v[60:61], v[60:61], v[76:77]
v_pk_mul_f32 v[76:77], v[72:73], s[62:63] op_sel:[0,0] op_sel_hi:[0,1] neg_lo:[0,1] neg_hi:[0,0]
v_pk_fma_f32 v[76:77], v[72:73], s[62:63], v[76:77] op_sel:[1,1,0] op_sel_hi:[1,0,1] neg_lo:[0,1,0] neg_hi:[0,1,0]
v_pk_add_f32 v[72:73], v[62:63], v[78:79] neg_lo:[0,1] neg_hi:[0,1]
v_pk_add_f32 v[62:63], v[62:63], v[78:79]
v_pk_mul_f32 v[78:79], v[72:73], s[54:55] op_sel:[0,0] op_sel_hi:[0,1] neg_lo:[0,1] neg_hi:[0,0]
v_pk_fma_f32 v[78:79], v[72:73], s[54:55], v[78:79] op_sel:[1,1,0] op_sel_hi:[1,0,1] neg_lo:[0,1,0] neg_hi:[0,1,0]
v_pk_add_f32 v[72:73], v[16:17], v[24:25] neg_lo:[0,1] neg_hi:[0,1]
v_pk_add_f32 v[16:17], v[16:17], v[24:25]
v_pk_add_f32 v[24:25], v[18:19], v[26:27] neg_lo:[0,1] neg_hi:[0,1]
v_pk_add_f32 v[18:19], v[18:19], v[26:27]
v_pk_mul_f32 v[26:27], v[24:25], s[62:63] op_sel:[0,0] op_sel_hi:[0,1] neg_lo:[0,0] neg_hi:[0,0]
v_pk_fma_f32 v[26:27], v[24:25], s[62:63], v[26:27] op_sel:[1,1,0] op_sel_hi:[1,0,1] neg_lo:[0,1,0] neg_hi:[0,0,0]
v_pk_add_f32 v[24:25], v[20:21], v[28:29] op_sel:[1,1] op_sel_hi:[0,0] neg_lo:[1,0] neg_hi:[0,1]
v_pk_add_f32 v[20:21], v[20:21], v[28:29]
v_pk_add_f32 v[28:29], v[22:23], v[30:31] neg_lo:[0,1] neg_hi:[0,1]
v_pk_add_f32 v[22:23], v[22:23], v[30:31]
v_pk_mul_f32 v[30:31], v[28:29], s[62:63] op_sel:[0,0] op_sel_hi:[0,1] neg_lo:[0,1] neg_hi:[0,0]
v_pk_fma_f32 v[30:31], v[28:29], s[62:63], v[30:31] op_sel:[1,1,0] op_sel_hi:[1,0,1] neg_lo:[0,1,0] neg_hi:[0,1,0]
v_pk_add_f32 v[28:29], v[64:65], v[32:33] neg_lo:[0,1] neg_hi:[0,1]
v_pk_add_f32 v[64:65], v[64:65], v[32:33]
v_pk_add_f32 v[32:33], v[34:35], v[42:43] neg_lo:[0,1] neg_hi:[0,1]
v_pk_add_f32 v[34:35], v[34:35], v[42:43]
v_pk_mul_f32 v[42:43], v[32:33], s[62:63] op_sel:[0,0] op_sel_hi:[0,1] neg_lo:[0,0] neg_hi:[0,0]
v_pk_fma_f32 v[42:43], v[32:33], s[62:63], v[42:43] op_sel:[1,1,0] op_sel_hi:[1,0,1] neg_lo:[0,1,0] neg_hi:[0,0,0]
v_pk_add_f32 v[32:33], v[36:37], v[44:45] op_sel:[1,1] op_sel_hi:[0,0] neg_lo:[1,0] neg_hi:[0,1]
v_pk_add_f32 v[36:37], v[36:37], v[44:45]
v_pk_add_f32 v[44:45], v[38:39], v[46:47] neg_lo:[0,1] neg_hi:[0,1]
v_pk_add_f32 v[38:39], v[38:39], v[46:47]
v_pk_mul_f32 v[46:47], v[44:45], s[62:63] op_sel:[0,0] op_sel_hi:[0,1] neg_lo:[0,1] neg_hi:[0,0]
v_pk_fma_f32 v[46:47], v[44:45], s[62:63], v[46:47] op_sel:[1,1,0] op_sel_hi:[1,0,1] neg_lo:[0,1,0] neg_hi:[0,1,0]
v_pk_add_f32 v[44:45], v[14:15], v[56:57] neg_lo:[0,1] neg_hi:[0,1]
v_pk_add_f32 v[14:15], v[14:15], v[56:57]
v_pk_add_f32 v[56:57], v[50:51], v[58:59] neg_lo:[0,1] neg_hi:[0,1]
v_pk_add_f32 v[50:51], v[50:51], v[58:59]
v_pk_mul_f32 v[58:59], v[56:57], s[62:63] op_sel:[0,0] op_sel_hi:[0,1] neg_lo:[0,0] neg_hi:[0,0]
v_pk_fma_f32 v[58:59], v[56:57], s[62:63], v[58:59] op_sel:[1,1,0] op_sel_hi:[1,0,1] neg_lo:[0,1,0] neg_hi:[0,0,0]
v_pk_add_f32 v[56:57], v[52:53], v[60:61] op_sel:[1,1] op_sel_hi:[0,0] neg_lo:[1,0] neg_hi:[0,1]
v_pk_add_f32 v[52:53], v[52:53], v[60:61]
v_pk_add_f32 v[60:61], v[54:55], v[62:63] neg_lo:[0,1] neg_hi:[0,1]
v_pk_add_f32 v[54:55], v[54:55], v[62:63]
v_pk_mul_f32 v[62:63], v[60:61], s[62:63] op_sel:[0,0] op_sel_hi:[0,1] neg_lo:[0,1] neg_hi:[0,0]
v_pk_fma_f32 v[62:63], v[60:61], s[62:63], v[62:63] op_sel:[1,1,0] op_sel_hi:[1,0,1] neg_lo:[0,1,0] neg_hi:[0,1,0]
v_pk_add_f32 v[60:61], v[40:41], v[48:49] neg_lo:[0,1] neg_hi:[0,1]
v_pk_add_f32 v[40:41], v[40:41], v[48:49]
v_pk_add_f32 v[48:49], v[66:67], v[74:75] neg_lo:[0,1] neg_hi:[0,1]
v_pk_add_f32 v[66:67], v[66:67], v[74:75]
v_pk_mul_f32 v[74:75], v[48:49], s[62:63] op_sel:[0,0] op_sel_hi:[0,1] neg_lo:[0,0] neg_hi:[0,0]
v_pk_fma_f32 v[74:75], v[48:49], s[62:63], v[74:75] op_sel:[1,1,0] op_sel_hi:[1,0,1] neg_lo:[0,1,0] neg_hi:[0,0,0]
v_pk_add_f32 v[48:49], v[68:69], v[76:77] op_sel:[1,1] op_sel_hi:[0,0] neg_lo:[1,0] neg_hi:[0,1]
v_pk_add_f32 v[68:69], v[68:69], v[76:77]
v_pk_add_f32 v[76:77], v[70:71], v[78:79] neg_lo:[0,1] neg_hi:[0,1]
v_pk_add_f32 v[70:71], v[70:71], v[78:79]
v_pk_mul_f32 v[78:79], v[76:77], s[62:63] op_sel:[0,0] op_sel_hi:[0,1] neg_lo:[0,1] neg_hi:[0,0]
v_pk_fma_f32 v[78:79], v[76:77], s[62:63], v[78:79] op_sel:[1,1,0] op_sel_hi:[1,0,1] neg_lo:[0,1,0] neg_hi:[0,1,0]
v_pk_add_f32 v[76:77], v[16:17], v[20:21] neg_lo:[0,1] neg_hi:[0,1]
v_pk_add_f32 v[16:17], v[16:17], v[20:21]
v_pk_add_f32 v[20:21], v[18:19], v[22:23] op_sel:[1,1] op_sel_hi:[0,0] neg_lo:[1,0] neg_hi:[0,1]
v_pk_add_f32 v[18:19], v[18:19], v[22:23]
v_pk_add_f32 v[22:23], v[72:73], v[24:25] neg_lo:[0,1] neg_hi:[0,1]
v_pk_add_f32 v[72:73], v[72:73], v[24:25]
v_pk_add_f32 v[24:25], v[26:27], v[30:31] op_sel:[1,1] op_sel_hi:[0,0] neg_lo:[1,0] neg_hi:[0,1]
v_pk_add_f32 v[26:27], v[26:27], v[30:31]
v_pk_add_f32 v[30:31], v[64:65], v[36:37] neg_lo:[0,1] neg_hi:[0,1]
v_pk_add_f32 v[64:65], v[64:65], v[36:37]
v_pk_add_f32 v[36:37], v[34:35], v[38:39] op_sel:[1,1] op_sel_hi:[0,0] neg_lo:[1,0] neg_hi:[0,1]
v_pk_add_f32 v[34:35], v[34:35], v[38:39]
v_pk_add_f32 v[38:39], v[28:29], v[32:33] neg_lo:[0,1] neg_hi:[0,1]
v_pk_add_f32 v[28:29], v[28:29], v[32:33]
v_pk_add_f32 v[32:33], v[42:43], v[46:47] op_sel:[1,1] op_sel_hi:[0,0] neg_lo:[1,0] neg_hi:[0,1]
v_pk_add_f32 v[42:43], v[42:43], v[46:47]
v_pk_add_f32 v[46:47], v[14:15], v[52:53] neg_lo:[0,1] neg_hi:[0,1]
v_pk_add_f32 v[14:15], v[14:15], v[52:53]
v_pk_add_f32 v[52:53], v[50:51], v[54:55] op_sel:[1,1] op_sel_hi:[0,0] neg_lo:[1,0] neg_hi:[0,1]
v_pk_add_f32 v[50:51], v[50:51], v[54:55]
v_pk_add_f32 v[54:55], v[44:45], v[56:57] neg_lo:[0,1] neg_hi:[0,1]
v_pk_add_f32 v[44:45], v[44:45], v[56:57]
v_pk_add_f32 v[56:57], v[58:59], v[62:63] op_sel:[1,1] op_sel_hi:[0,0] neg_lo:[1,0] neg_hi:[0,1]
v_pk_add_f32 v[58:59], v[58:59], v[62:63]
v_pk_add_f32 v[62:63], v[40:41], v[68:69] neg_lo:[0,1] neg_hi:[0,1]
v_pk_add_f32 v[40:41], v[40:41], v[68:69]
v_pk_add_f32 v[68:69], v[66:67], v[70:71] op_sel:[1,1] op_sel_hi:[0,0] neg_lo:[1,0] neg_hi:[0,1]
v_pk_add_f32 v[66:67], v[66:67], v[70:71]
v_pk_add_f32 v[70:71], v[60:61], v[48:49] neg_lo:[0,1] neg_hi:[0,1]
v_pk_add_f32 v[60:61], v[60:61], v[48:49]
v_pk_add_f32 v[48:49], v[74:75], v[78:79] op_sel:[1,1] op_sel_hi:[0,0] neg_lo:[1,0] neg_hi:[0,1]
v_pk_add_f32 v[74:75], v[74:75], v[78:79]
v_pk_add_f32 v[78:79], v[16:17], v[18:19] neg_lo:[0,1] neg_hi:[0,1]
v_pk_add_f32 v[16:17], v[16:17], v[18:19]
v_pk_add_f32 v[18:19], v[76:77], v[20:21] neg_lo:[0,1] neg_hi:[0,1]
v_pk_add_f32 v[76:77], v[76:77], v[20:21]
v_pk_add_f32 v[20:21], v[72:73], v[26:27] neg_lo:[0,1] neg_hi:[0,1]
v_pk_add_f32 v[72:73], v[72:73], v[26:27]
v_pk_add_f32 v[26:27], v[22:23], v[24:25] neg_lo:[0,1] neg_hi:[0,1]
v_pk_add_f32 v[22:23], v[22:23], v[24:25]
v_pk_add_f32 v[24:25], v[64:65], v[34:35] neg_lo:[0,1] neg_hi:[0,1]
v_pk_add_f32 v[64:65], v[64:65], v[34:35]
v_pk_add_f32 v[34:35], v[30:31], v[36:37] neg_lo:[0,1] neg_hi:[0,1]
v_pk_add_f32 v[30:31], v[30:31], v[36:37]
v_pk_add_f32 v[36:37], v[28:29], v[42:43] neg_lo:[0,1] neg_hi:[0,1]
v_pk_add_f32 v[28:29], v[28:29], v[42:43]
v_pk_add_f32 v[42:43], v[38:39], v[32:33] neg_lo:[0,1] neg_hi:[0,1]
v_pk_add_f32 v[38:39], v[38:39], v[32:33]
v_pk_add_f32 v[32:33], v[14:15], v[50:51] neg_lo:[0,1] neg_hi:[0,1]
v_pk_add_f32 v[14:15], v[14:15], v[50:51]
v_pk_add_f32 v[50:51], v[46:47], v[52:53] neg_lo:[0,1] neg_hi:[0,1]
v_pk_add_f32 v[46:47], v[46:47], v[52:53]
v_pk_add_f32 v[52:53], v[44:45], v[58:59] neg_lo:[0,1] neg_hi:[0,1]
v_pk_add_f32 v[44:45], v[44:45], v[58:59]
v_pk_add_f32 v[58:59], v[54:55], v[56:57] neg_lo:[0,1] neg_hi:[0,1]
v_pk_add_f32 v[54:55], v[54:55], v[56:57]
v_pk_add_f32 v[56:57], v[40:41], v[66:67] neg_lo:[0,1] neg_hi:[0,1]
v_pk_add_f32 v[40:41], v[40:41], v[66:67]
v_pk_add_f32 v[66:67], v[62:63], v[68:69] neg_lo:[0,1] neg_hi:[0,1]
v_pk_add_f32 v[62:63], v[62:63], v[68:69]
v_pk_add_f32 v[68:69], v[60:61], v[74:75] neg_lo:[0,1] neg_hi:[0,1]
v_pk_add_f32 v[60:61], v[60:61], v[74:75]
v_pk_add_f32 v[74:75], v[70:71], v[48:49] neg_lo:[0,1] neg_hi:[0,1]
v_pk_add_f32 v[70:71], v[70:71], v[48:49]
v_pk_mul_f32 v[48:49], v[14:15], v[82:83] op_sel:[0,0] op_sel_hi:[0,1] neg_lo:[0,0] neg_hi:[0,0]
v_pk_fma_f32 v[14:15], v[14:15], v[82:83], v[48:49] op_sel:[1,1,0] op_sel_hi:[1,0,1] neg_lo:[0,1,0] neg_hi:[0,0,0]
v_pk_mul_f32 v[48:49], v[64:65], v[84:85] op_sel:[0,0] op_sel_hi:[0,1] neg_lo:[0,0] neg_hi:[0,0]
v_pk_fma_f32 v[64:65], v[64:65], v[84:85], v[48:49] op_sel:[1,1,0] op_sel_hi:[1,0,1] neg_lo:[0,1,0] neg_hi:[0,0,0]
v_pk_mul_f32 v[48:49], v[40:41], v[86:87] op_sel:[0,0] op_sel_hi:[0,1] neg_lo:[0,0] neg_hi:[0,0]
v_pk_fma_f32 v[40:41], v[40:41], v[86:87], v[48:49] op_sel:[1,1,0] op_sel_hi:[1,0,1] neg_lo:[0,1,0] neg_hi:[0,0,0]
v_pk_mul_f32 v[48:49], v[72:73], v[88:89] op_sel:[0,0] op_sel_hi:[0,1] neg_lo:[0,0] neg_hi:[0,0]
v_pk_fma_f32 v[72:73], v[72:73], v[88:89], v[48:49] op_sel:[1,1,0] op_sel_hi:[1,0,1] neg_lo:[0,1,0] neg_hi:[0,0,0]
v_pk_mul_f32 v[48:49], v[44:45], v[90:91] op_sel:[0,0] op_sel_hi:[0,1] neg_lo:[0,0] neg_hi:[0,0]
v_pk_fma_f32 v[44:45], v[44:45], v[90:91], v[48:49] op_sel:[1,1,0] op_sel_hi:[1,0,1] neg_lo:[0,1,0] neg_hi:[0,0,0]
v_pk_mul_f32 v[48:49], v[28:29], v[92:93] op_sel:[0,0] op_sel_hi:[0,1] neg_lo:[0,0] neg_hi:[0,0]
v_pk_fma_f32 v[28:29], v[28:29], v[92:93], v[48:49] op_sel:[1,1,0] op_sel_hi:[1,0,1] neg_lo:[0,1,0] neg_hi:[0,0,0]
v_pk_mul_f32 v[48:49], v[60:61], v[94:95] op_sel:[0,0] op_sel_hi:[0,1] neg_lo:[0,0] neg_hi:[0,0]
v_pk_fma_f32 v[60:61], v[60:61], v[94:95], v[48:49] op_sel:[1,1,0] op_sel_hi:[1,0,1] neg_lo:[0,1,0] neg_hi:[0,0,0]
v_pk_mul_f32 v[48:49], v[76:77], v[96:97] op_sel:[0,0] op_sel_hi:[0,1] neg_lo:[0,0] neg_hi:[0,0]
v_pk_fma_f32 v[76:77], v[76:77], v[96:97], v[48:49] op_sel:[1,1,0] op_sel_hi:[1,0,1] neg_lo:[0,1,0] neg_hi:[0,0,0]
v_pk_mul_f32 v[48:49], v[46:47], v[98:99] op_sel:[0,0] op_sel_hi:[0,1] neg_lo:[0,0] neg_hi:[0,0]
v_pk_fma_f32 v[46:47], v[46:47], v[98:99], v[48:49] op_sel:[1,1,0] op_sel_hi:[1,0,1] neg_lo:[0,1,0] neg_hi:[0,0,0]
v_pk_mul_f32 v[48:49], v[30:31], v[100:101] op_sel:[0,0] op_sel_hi:[0,1] neg_lo:[0,0] neg_hi:[0,0]
v_pk_fma_f32 v[30:31], v[30:31], v[100:101], v[48:49] op_sel:[1,1,0] op_sel_hi:[1,0,1] neg_lo:[0,1,0] neg_hi:[0,0,0]
v_pk_mul_f32 v[48:49], v[62:63], v[102:103] op_sel:[0,0] op_sel_hi:[0,1] neg_lo:[0,0] neg_hi:[0,0]
v_pk_fma_f32 v[62:63], v[62:63], v[102:103], v[48:49] op_sel:[1,1,0] op_sel_hi:[1,0,1] neg_lo:[0,1,0] neg_hi:[0,0,0]
v_pk_mul_f32 v[48:49], v[22:23], v[104:105] op_sel:[0,0] op_sel_hi:[0,1] neg_lo:[0,0] neg_hi:[0,0]
v_pk_fma_f32 v[22:23], v[22:23], v[104:105], v[48:49] op_sel:[1,1,0] op_sel_hi:[1,0,1] neg_lo:[0,1,0] neg_hi:[0,0,0]
v_pk_mul_f32 v[48:49], v[54:55], v[106:107] op_sel:[0,0] op_sel_hi:[0,1] neg_lo:[0,0] neg_hi:[0,0]
v_pk_fma_f32 v[54:55], v[54:55], v[106:107], v[48:49] op_sel:[1,1,0] op_sel_hi:[1,0,1] neg_lo:[0,1,0] neg_hi:[0,0,0]
v_pk_mul_f32 v[48:49], v[38:39], v[108:109] op_sel:[0,0] op_sel_hi:[0,1] neg_lo:[0,0] neg_hi:[0,0]
v_pk_fma_f32 v[38:39], v[38:39], v[108:109], v[48:49] op_sel:[1,1,0] op_sel_hi:[1,0,1] neg_lo:[0,1,0] neg_hi:[0,0,0]
v_pk_mul_f32 v[48:49], v[70:71], v[110:111] op_sel:[0,0] op_sel_hi:[0,1] neg_lo:[0,0] neg_hi:[0,0]
v_pk_fma_f32 v[70:71], v[70:71], v[110:111], v[48:49] op_sel:[1,1,0] op_sel_hi:[1,0,1] neg_lo:[0,1,0] neg_hi:[0,0,0]
v_pk_mul_f32 v[48:49], v[78:79], v[112:113] op_sel:[0,0] op_sel_hi:[0,1] neg_lo:[0,0] neg_hi:[0,0]
v_pk_fma_f32 v[78:79], v[78:79], v[112:113], v[48:49] op_sel:[1,1,0] op_sel_hi:[1,0,1] neg_lo:[0,1,0] neg_hi:[0,0,0]
v_pk_mul_f32 v[48:49], v[32:33], v[114:115] op_sel:[0,0] op_sel_hi:[0,1] neg_lo:[0,0] neg_hi:[0,0]
v_pk_fma_f32 v[32:33], v[32:33], v[114:115], v[48:49] op_sel:[1,1,0] op_sel_hi:[1,0,1] neg_lo:[0,1,0] neg_hi:[0,0,0]
v_pk_mul_f32 v[48:49], v[24:25], v[116:117] op_sel:[0,0] op_sel_hi:[0,1] neg_lo:[0,0] neg_hi:[0,0]
v_pk_fma_f32 v[24:25], v[24:25], v[116:117], v[48:49] op_sel:[1,1,0] op_sel_hi:[1,0,1] neg_lo:[0,1,0] neg_hi:[0,0,0]
v_pk_mul_f32 v[48:49], v[56:57], v[118:119] op_sel:[0,0] op_sel_hi:[0,1] neg_lo:[0,0] neg_hi:[0,0]
v_pk_fma_f32 v[56:57], v[56:57], v[118:119], v[48:49] op_sel:[1,1,0] op_sel_hi:[1,0,1] neg_lo:[0,1,0] neg_hi:[0,0,0]
v_pk_mul_f32 v[48:49], v[20:21], v[120:121] op_sel:[0,0] op_sel_hi:[0,1] neg_lo:[0,0] neg_hi:[0,0]
v_pk_fma_f32 v[20:21], v[20:21], v[120:121], v[48:49] op_sel:[1,1,0] op_sel_hi:[1,0,1] neg_lo:[0,1,0] neg_hi:[0,0,0]
v_pk_mul_f32 v[48:49], v[52:53], v[122:123] op_sel:[0,0] op_sel_hi:[0,1] neg_lo:[0,0] neg_hi:[0,0]
v_pk_fma_f32 v[52:53], v[52:53], v[122:123], v[48:49] op_sel:[1,1,0] op_sel_hi:[1,0,1] neg_lo:[0,1,0] neg_hi:[0,0,0]
v_pk_mul_f32 v[48:49], v[36:37], v[124:125] op_sel:[0,0] op_sel_hi:[0,1] neg_lo:[0,0] neg_hi:[0,0]
v_pk_fma_f32 v[36:37], v[36:37], v[124:125], v[48:49] op_sel:[1,1,0] op_sel_hi:[1,0,1] neg_lo:[0,1,0] neg_hi:[0,0,0]
v_pk_mul_f32 v[48:49], v[68:69], v[126:127] op_sel:[0,0] op_sel_hi:[0,1] neg_lo:[0,0] neg_hi:[0,0]
v_pk_fma_f32 v[68:69], v[68:69], v[126:127], v[48:49] op_sel:[1,1,0] op_sel_hi:[1,0,1] neg_lo:[0,1,0] neg_hi:[0,0,0]
v_pk_mul_f32 v[48:49], v[18:19], v[128:129] op_sel:[0,0] op_sel_hi:[0,1] neg_lo:[0,0] neg_hi:[0,0]
v_pk_fma_f32 v[18:19], v[18:19], v[128:129], v[48:49] op_sel:[1,1,0] op_sel_hi:[1,0,1] neg_lo:[0,1,0] neg_hi:[0,0,0]
v_pk_mul_f32 v[48:49], v[50:51], v[130:131] op_sel:[0,0] op_sel_hi:[0,1] neg_lo:[0,0] neg_hi:[0,0]
v_pk_fma_f32 v[50:51], v[50:51], v[130:131], v[48:49] op_sel:[1,1,0] op_sel_hi:[1,0,1] neg_lo:[0,1,0] neg_hi:[0,0,0]
v_pk_mul_f32 v[48:49], v[34:35], v[132:133] op_sel:[0,0] op_sel_hi:[0,1] neg_lo:[0,0] neg_hi:[0,0]
v_pk_fma_f32 v[34:35], v[34:35], v[132:133], v[48:49] op_sel:[1,1,0] op_sel_hi:[1,0,1] neg_lo:[0,1,0] neg_hi:[0,0,0]
v_pk_mul_f32 v[48:49], v[66:67], v[134:135] op_sel:[0,0] op_sel_hi:[0,1] neg_lo:[0,0] neg_hi:[0,0]
v_pk_fma_f32 v[66:67], v[66:67], v[134:135], v[48:49] op_sel:[1,1,0] op_sel_hi:[1,0,1] neg_lo:[0,1,0] neg_hi:[0,0,0]
v_pk_mul_f32 v[48:49], v[26:27], v[136:137] op_sel:[0,0] op_sel_hi:[0,1] neg_lo:[0,0] neg_hi:[0,0]
v_pk_fma_f32 v[26:27], v[26:27], v[136:137], v[48:49] op_sel:[1,1,0] op_sel_hi:[1,0,1] neg_lo:[0,1,0] neg_hi:[0,0,0]
v_pk_mul_f32 v[48:49], v[58:59], v[138:139] op_sel:[0,0] op_sel_hi:[0,1] neg_lo:[0,0] neg_hi:[0,0]
v_pk_fma_f32 v[58:59], v[58:59], v[138:139], v[48:49] op_sel:[1,1,0] op_sel_hi:[1,0,1] neg_lo:[0,1,0] neg_hi:[0,0,0]
v_pk_mul_f32 v[48:49], v[42:43], v[140:141] op_sel:[0,0] op_sel_hi:[0,1] neg_lo:[0,0] neg_hi:[0,0]
v_pk_fma_f32 v[42:43], v[42:43], v[140:141], v[48:49] op_sel:[1,1,0] op_sel_hi:[1,0,1] neg_lo:[0,1,0] neg_hi:[0,0,0]
v_pk_mul_f32 v[48:49], v[74:75], v[142:143] op_sel:[0,0] op_sel_hi:[0,1] neg_lo:[0,0] neg_hi:[0,0]
v_pk_fma_f32 v[74:75], v[74:75], v[142:143], v[48:49] op_sel:[1,1,0] op_sel_hi:[1,0,1] neg_lo:[0,1,0] neg_hi:[0,0,0]
ds_write_b64 v4, v[16:17] offset:0
ds_write_b64 v4, v[14:15] offset:264
ds_write_b64 v4, v[64:65] offset:528
ds_write_b64 v4, v[40:41] offset:792
ds_write_b64 v4, v[72:73] offset:1056
ds_write_b64 v4, v[44:45] offset:1320
ds_write_b64 v4, v[28:29] offset:1584
ds_write_b64 v4, v[60:61] offset:1848
ds_write_b64 v4, v[76:77] offset:2112
ds_write_b64 v4, v[46:47] offset:2376
ds_write_b64 v4, v[30:31] offset:2640
ds_write_b64 v4, v[62:63] offset:2904
ds_write_b64 v4, v[22:23] offset:3168
ds_write_b64 v4, v[54:55] offset:3432
ds_write_b64 v4, v[38:39] offset:3696
ds_write_b64 v4, v[70:71] offset:3960
ds_write_b64 v4, v[78:79] offset:4224
ds_write_b64 v4, v[32:33] offset:4488
ds_write_b64 v4, v[24:25] offset:4752
ds_write_b64 v4, v[56:57] offset:5016
ds_write_b64 v4, v[20:21] offset:5280
ds_write_b64 v4, v[52:53] offset:5544
ds_write_b64 v4, v[36:37] offset:5808
ds_write_b64 v4, v[68:69] offset:6072
ds_write_b64 v4, v[18:19] offset:6336
ds_write_b64 v4, v[50:51] offset:6600
ds_write_b64 v4, v[34:35] offset:6864
ds_write_b64 v4, v[66:67] offset:7128
ds_write_b64 v4, v[26:27] offset:7392
ds_write_b64 v4, v[58:59] offset:7656
ds_write_b64 v4, v[42:43] offset:7920
ds_write_b64 v4, v[74:75] offset:8184
s_waitcnt lgkmcnt(0)
ds_read_b64 v[16:17], v5 offset:0
ds_read_b64 v[48:49], v5 offset:128
ds_read_b64 v[18:19], v5 offset:8
ds_read_b64 v[50:51], v5 offset:136
ds_read_b64 v[20:21], v5 offset:16
ds_read_b64 v[52:53], v5 offset:144
ds_read_b64 v[22:23], v5 offset:24
ds_read_b64 v[54:55], v5 offset:152
ds_read_b64 v[24:25], v5 offset:32
ds_read_b64 v[56:57], v5 offset:160
ds_read_b64 v[26:27], v5 offset:40
ds_read_b64 v[58:59], v5 offset:168
ds_read_b64 v[28:29], v5 offset:48
ds_read_b64 v[60:61], v5 offset:176
ds_read_b64 v[30:31], v5 offset:56
ds_read_b64 v[62:63], v5 offset:184
ds_read_b64 v[32:33], v5 offset:64
ds_read_b64 v[64:65], v5 offset:192
ds_read_b64 v[34:35], v5 offset:72
ds_read_b64 v[66:67], v5 offset:200
ds_read_b64 v[36:37], v5 offset:80
ds_read_b64 v[68:69], v5 offset:208
ds_read_b64 v[38:39], v5 offset:88
ds_read_b64 v[70:71], v5 offset:216
ds_read_b64 v[40:41], v5 offset:96
ds_read_b64 v[72:73], v5 offset:224
ds_read_b64 v[42:43], v5 offset:104
ds_read_b64 v[74:75], v5 offset:232
ds_read_b64 v[44:45], v5 offset:112
ds_read_b64 v[76:77], v5 offset:240
ds_read_b64 v[46:47], v5 offset:120
ds_read_b64 v[78:79], v5 offset:248
s_waitcnt lgkmcnt(0)
v_pk_add_f32 v[14:15], v[16:17], v[48:49] neg_lo:[0,1] neg_hi:[0,1]
v_pk_add_f32 v[16:17], v[16:17], v[48:49]
v_pk_add_f32 v[48:49], v[18:19], v[50:51] neg_lo:[0,1] neg_hi:[0,1]
v_pk_add_f32 v[18:19], v[18:19], v[50:51]
v_pk_mul_f32 v[50:51], v[48:49], s[50:51] op_sel:[0,0] op_sel_hi:[0,1] neg_lo:[0,0] neg_hi:[0,0]
v_pk_fma_f32 v[50:51], v[48:49], s[50:51], v[50:51] op_sel:[1,1,0] op_sel_hi:[1,0,1] neg_lo:[0,1,0] neg_hi:[0,0,0]
v_pk_add_f32 v[48:49], v[20:21], v[52:53] neg_lo:[0,1] neg_hi:[0,1]
v_pk_add_f32 v[20:21], v[20:21], v[52:53]
v_pk_mul_f32 v[52:53], v[48:49], s[54:55] op_sel:[0,0] op_sel_hi:[0,1] neg_lo:[0,0] neg_hi:[0,0]
v_pk_fma_f32 v[52:53], v[48:49], s[54:55], v[52:53] op_sel:[1,1,0] op_sel_hi:[1,0,1] neg_lo:[0,1,0] neg_hi:[0,0,0]
v_pk_add_f32 v[48:49], v[22:23], v[54:55] neg_lo:[0,1] neg_hi:[0,1]
v_pk_add_f32 v[22:23], v[22:23], v[54:55]
v_pk_mul_f32 v[54:55], v[48:49], s[58:59] op_sel:[0,0] op_sel_hi:[0,1] neg_lo:[0,0] neg_hi:[0,0]
v_pk_fma_f32 v[54:55], v[48:49], s[58:59], v[54:55] op_sel:[1,1,0] op_sel_hi:[1,0,1] neg_lo:[0,1,0] neg_hi:[0,0,0]
v_pk_add_f32 v[48:49], v[24:25], v[56:57] neg_lo:[0,1] neg_hi:[0,1]
v_pk_add_f32 v[24:25], v[24:25], v[56:57]
v_pk_mul_f32 v[56:57], v[48:49], s[62:63] op_sel:[0,0] op_sel_hi:[0,1] neg_lo:[0,0] neg_hi:[0,0]
v_pk_fma_f32 v[56:57], v[48:49], s[62:63], v[56:57] op_sel:[1,1,0] op_sel_hi:[1,0,1] neg_lo:[0,1,0] neg_hi:[0,0,0]
v_pk_add_f32 v[48:49], v[26:27], v[58:59] neg_lo:[0,1] neg_hi:[0,1]
v_pk_add_f32 v[26:27], v[26:27], v[58:59]
v_pk_mul_f32 v[58:59], v[48:49], s[58:59] op_sel:[0,1] op_sel_hi:[0,0] neg_lo:[0,0] neg_hi:[0,0]
v_pk_fma_f32 v[58:59], v[48:49], s[58:59], v[58:59] op_sel:[1,0,0] op_sel_hi:[1,1,1] neg_lo:[0,1,0] neg_hi:[0,0,0]
v_pk_add_f32 v[48:49], v[28:29], v[60:61] neg_lo:[0,1] neg_hi:[0,1]
v_pk_add_f32 v[28:29], v[28:29], v[60:61]
v_pk_mul_f32 v[60:61], v[48:49], s[54:55] op_sel:[0,1] op_sel_hi:[0,0] neg_lo:[0,0] neg_hi:[0,0]
v_pk_fma_f32 v[60:61], v[48:49], s[54:55], v[60:61] op_sel:[1,0,0] op_sel_hi:[1,1,1] neg_lo:[0,1,0] neg_hi:[0,0,0]
v_pk_add_f32 v[48:49], v[30:31], v[62:63] neg_lo:[0,1] neg_hi:[0,1]
v_pk_add_f32 v[30:31], v[30:31], v[62:63]
v_pk_mul_f32 v[62:63], v[48:49], s[50:51] op_sel:[0,1] op_sel_hi:[0,0] neg_lo:[0,0] neg_hi:[0,0]
v_pk_fma_f32 v[62:63], v[48:49], s[50:51], v[62:63] op_sel:[1,0,0] op_sel_hi:[1,1,1] neg_lo:[0,1,0] neg_hi:[0,0,0]
v_pk_add_f32 v[48:49], v[32:33], v[64:65] op_sel:[1,1] op_sel_hi:[0,0] neg_lo:[1,0] neg_hi:[0,1]
v_pk_add_f32 v[32:33], v[32:33], v[64:65]
v_pk_add_f32 v[64:65], v[34:35], v[66:67] neg_lo:[0,1] neg_hi:[0,1]
v_pk_add_f32 v[34:35], v[34:35], v[66:67]
v_pk_mul_f32 v[66:67], v[64:65], s[50:51] op_sel:[0,1] op_sel_hi:[0,0] neg_lo:[0,1] neg_hi:[0,0]
v_pk_fma_f32 v[66:67], v[64:65], s[50:51], v[66:67] op_sel:[1,0,0] op_sel_hi:[1,1,1] neg_lo:[0,1,0] neg_hi:[0,1,0]
v_pk_add_f32 v[64:65], v[36:37], v[68:69] neg_lo:[0,1] neg_hi:[0,1]
v_pk_add_f32 v[36:37], v[36:37], v[68:69]
v_pk_mul_f32 v[68:69], v[64:65], s[54:55] op_sel:[0,1] op_sel_hi:[0,0] neg_lo:[0,1] neg_hi:[0,0]
v_pk_fma_f32 v[68:69], v[64:65], s[54:55], v[68:69] op_sel:[1,0,0] op_sel_hi:[1,1,1] neg_lo:[0,1,0] neg_hi:[0,1,0]
v_pk_add_f32 v[64:65], v[38:39], v[70:71] neg_lo:[0,1] neg_hi:[0,1]
v_pk_add_f32 v[38:39], v[38:39], v[70:71]
v_pk_mul_f32 v[70:71], v[64:65], s[58:59] op_sel:[0,1] op_sel_hi:[0,0] neg_lo:[0,1] neg_hi:[0,0]
v_pk_fma_f32 v[70:71], v[64:65], s[58:59], v[70:71] op_sel:[1,0,0] op_sel_hi:[1,1,1] neg_lo:[0,1,0] neg_hi:[0,1,0]
v_pk_add_f32 v[64:65], v[40:41], v[72:73] neg_lo:[0,1] neg_hi:[0,1]
v_pk_add_f32 v[40:41], v[40:41], v[72:73]
v_pk_mul_f32 v[72:73], v[64:65], s[62:63] op_sel:[0,0] op_sel_hi:[0,1] neg_lo:[0,1] neg_hi:[0,0]
v_pk_fma_f32 v[72:73], v[64:65], s[62:63], v[72:73] op_sel:[1,1,0] op_sel_hi:[1,0,1] neg_lo:[0,1,0] neg_hi:[0,1,0]
v_pk_add_f32 v[64:65], v[42:43], v[74:75] neg_lo:[0,1] neg_hi:[0,1]
v_pk_add_f32 v[42:43], v[42:43], v[74:75]
v_pk_mul_f32 v[74:75], v[64:65], s[58:59] op_sel:[0,0] op_sel_hi:[0,1] neg_lo:[0,1] neg_hi:[0,0]
v_pk_fma_f32 v[74:75], v[64:65], s[58:59], v[74:75] op_sel:[1,1,0] op_sel_hi:[1,0,1] neg_lo:[0,1,0] neg_hi:[0,1,0]
v_pk_add_f32 v[64:65], v[44:45], v[76:77] neg_lo:[0,1] neg_hi:[0,1]
v_pk_add_f32 v[44:45], v[44:45], v[76:77]
v_pk_mul_f32 v[76:77], v[64:65], s[54:55] op_sel:[0,0] op_sel_hi:[0,1] neg_lo:[0,1] neg_hi:[0,0]
v_pk_fma_f32 v[76:77], v[64:65], s[54:55], v[76:77] op_sel:[1,1,0] op_sel_hi:[1,0,1] neg_lo:[0,1,0] neg_hi:[0,1,0]
v_pk_add_f32 v[64:65], v[46:47], v[78:79] neg_lo:[0,1] neg_hi:[0,1]
v_pk_add_f32 v[46:47], v[46:47], v[78:79]
v_pk_mul_f32 v[78:79], v[64:65], s[50:51] op_sel:[0,0] op_sel_hi:[0,1] neg_lo:[0,1] neg_hi:[0,0]
v_pk_fma_f32 v[78:79], v[64:65], s[50:51], v[78:79] op_sel:[1,1,0] op_sel_hi:[1,0,1] neg_lo:[0,1,0] neg_hi:[0,1,0]
v_pk_add_f32 v[64:65], v[16:17], v[32:33] neg_lo:[0,1] neg_hi:[0,1]
v_pk_add_f32 v[16:17], v[16:17], v[32:33]
v_pk_add_f32 v[32:33], v[18:19], v[34:35] neg_lo:[0,1] neg_hi:[0,1]
v_pk_add_f32 v[18:19], v[18:19], v[34:35]
v_pk_mul_f32 v[34:35], v[32:33], s[54:55] op_sel:[0,0] op_sel_hi:[0,1] neg_lo:[0,0] neg_hi:[0,0]
v_pk_fma_f32 v[34:35], v[32:33], s[54:55], v[34:35] op_sel:[1,1,0] op_sel_hi:[1,0,1] neg_lo:[0,1,0] neg_hi:[0,0,0]
v_pk_add_f32 v[32:33], v[20:21], v[36:37] neg_lo:[0,1] neg_hi:[0,1]
v_pk_add_f32 v[20:21], v[20:21], v[36:37]
v_pk_mul_f32 v[36:37], v[32:33], s[62:63] op_sel:[0,0] op_sel_hi:[0,1] neg_lo:[0,0] neg_hi:[0,0]
v_pk_fma_f32 v[36:37], v[32:33], s[62:63], v[36:37] op_sel:[1,1,0] op_sel_hi:[1,0,1] neg_lo:[0,1,0] neg_hi:[0,0,0]
v_pk_add_f32 v[32:33], v[22:23], v[38:39] neg_lo:[0,1] neg_hi:[0,1]
v_pk_add_f32 v[22:23], v[22:23], v[38:39]
v_pk_mul_f32 v[38:39], v[32:33], s[54:55] op_sel:[0,1] op_sel_hi:[0,0] neg_lo:[0,0] neg_hi:[0,0]
v_pk_fma_f32 v[38:39], v[32:33], s[54:55], v[38:39] op_sel:[1,0,0] op_sel_hi:[1,1,1] neg_lo:[0,1,0] neg_hi:[0,0,0]
v_pk_add_f32 v[32:33], v[24:25], v[40:41] op_sel:[1,1] op_sel_hi:[0,0] neg_lo:[1,0] neg_hi:[0,1]
v_pk_add_f32 v[24:25], v[24:25], v[40:41]
v_pk_add_f32 v[40:41], v[26:27], v[42:43] neg_lo:[0,1] neg_hi:[0,1]
v_pk_add_f32 v[26:27], v[26:27], v[42:43]
v_pk_mul_f32 v[42:43], v[40:41], s[54:55] op_sel:[0,1] op_sel_hi:[0,0] neg_lo:[0,1] neg_hi:[0,0]
v_pk_fma_f32 v[42:43], v[40:41], s[54:55], v[42:43] op_sel:[1,0,0] op_sel_hi:[1,1,1] neg_lo:[0,1,0] neg_hi:[0,1,0]
v_pk_add_f32 v[40:41], v[28:29], v[44:45] neg_lo:[0,1] neg_hi:[0,1]
v_pk_add_f32 v[28:29], v[28:29], v[44:45]
v_pk_mul_f32 v[44:45], v[40:41], s[62:63] op_sel:[0,0] op_sel_hi:[0,1] neg_lo:[0,1] neg_hi:[0,0]
v_pk_fma_f32 v[44:45], v[40:41], s[62:63], v[44:45] op_sel:[1,1,0] op_sel_hi:[1,0,1] neg_lo:[0,1,0] neg_hi:[0,1,0]
v_pk_add_f32 v[40:41], v[30:31], v[46:47] neg_lo:[0,1] neg_hi:[0,1]
v_pk_add_f32 v[30:31], v[30:31], v[46:47]
v_pk_mul_f32 v[46:47], v[40:41], s[54:55] op_sel:[0,0] op_sel_hi:[0,1] neg_lo:[0,1] neg_hi:[0,0]
v_pk_fma_f32 v[46:47], v[40:41], s[54:55], v[46:47] op_sel:[1,1,0] op_sel_hi:[1,0,1] neg_lo:[0,1,0] neg_hi:[0,1,0]
v_pk_add_f32 v[40:41], v[14:15], v[48:49] neg_lo:[0,1] neg_hi:[0,1]
v_pk_add_f32 v[14:15], v[14:15], v[48:49]
v_pk_add_f32 v[48:49], v[50:51], v[66:67] neg_lo:[0,1] neg_hi:[0,1]
v_pk_add_f32 v[50:51], v[50:51], v[66:67]
v_pk_mul_f32 v[66:67], v[48:49], s[54:55] op_sel:[0,0] op_sel_hi:[0,1] neg_lo:[0,0] neg_hi:[0,0]
v_pk_fma_f32 v[66:67], v[48:49], s[54:55], v[66:67] op_sel:[1,1,0] op_sel_hi:[1,0,1] neg_lo:[0,1,0] neg_hi:[0,0,0]
v_pk_add_f32 v[48:49], v[52:53], v[68:69] neg_lo:[0,1] neg_hi:[0,1]
v_pk_add_f32 v[52:53], v[52:53], v[68:69]
v_pk_mul_f32 v[68:69], v[48:49], s[62:63] op_sel:[0,0] op_sel_hi:[0,1] neg_lo:[0,0] neg_hi:[0,0]
v_pk_fma_f32 v[68:69], v[48:49], s[62:63], v[68:69] op_sel:[1,1,0] op_sel_hi:[1,0,1] neg_lo:[0,1,0] neg_hi:[0,0,0]
v_pk_add_f32 v[48:49], v[54:55], v[70:71] neg_lo:[0,1] neg_hi:[0,1]
v_pk_add_f32 v[54:55], v[54:55], v[70:71]
v_pk_mul_f32 v[70:71], v[48:49], s[54:55] op_sel:[0,1] op_sel_hi:[0,0] neg_lo:[0,0] neg_hi:[0,0]
v_pk_fma_f32 v[70:71], v[48:49], s[54:55], v[70:71] op_sel:[1,0,0] op_sel_hi:[1,1,1] neg_lo:[0,1,0] neg_hi:[0,0,0]
v_pk_add_f32 v[48:49], v[56:57], v[72:73] op_sel:[1,1] op_sel_hi:[0,0] neg_lo:[1,0] neg_hi:[0,1]
v_pk_add_f32 v[56:57], v[56:57], v[72:73]
v_pk_add_f32 v[72:73], v[58:59], v[74:75] neg_lo:[0,1] neg_hi:[0,1]
v_pk_add_f32 v[58:59], v[58:59], v[74:75]
v_pk_mul_f32 v[74:75], v[72:73], s[54:55] op_sel:[0,1] op_sel_hi:[0,0] neg_lo:[0,1] neg_hi:[0,0]
v_pk_fma_f32 v[74:75], v[72:73], s[54:55], v[74:75] op_sel:[1,0,0] op_sel_hi:[1,1,1] neg_lo:[0,1,0] neg_hi:[0,1,0]
v_pk_add_f32 v[72:73], v[60:61], v[76:77] neg_lo:[0,1] neg_hi:[0,1]
v_pk_add_f32 v[60:61], v[60:61], v[76:77]
v_pk_mul_f32 v[76:77], v[72:73], s[62:63] op_sel:[0,0] op_sel_hi:[0,1] neg_lo:[0,1] neg_hi:[0,0]
v_pk_fma_f32 v[76:77], v[72:73], s[62:63], v[76:77] op_sel:[1,1,0] op_sel_hi:[1,0,1] neg_lo:[0,1,0] neg_hi:[0,1,0]
v_pk_add_f32 v[72:73], v[62:63], v[78:79] neg_lo:[0,1] neg_hi:[0,1]
v_pk_add_f32 v[62:63], v[62:63], v[78:79]
v_pk_mul_f32 v[78:79], v[72:73], s[54:55] op_sel:[0,0] op_sel_hi:[0,1] neg_lo:[0,1] neg_hi:[0,0]
v_pk_fma_f32 v[78:79], v[72:73], s[54:55], v[78:79] op_sel:[1,1,0] op_sel_hi:[1,0,1] neg_lo:[0,1,0] neg_hi:[0,1,0]
v_pk_add_f32 v[72:73], v[16:17], v[24:25] neg_lo:[0,1] neg_hi:[0,1]
v_pk_add_f32 v[16:17], v[16:17], v[24:25]
v_pk_add_f32 v[24:25], v[18:19], v[26:27] neg_lo:[0,1] neg_hi:[0,1]
v_pk_add_f32 v[18:19], v[18:19], v[26:27]
v_pk_mul_f32 v[26:27], v[24:25], s[62:63] op_sel:[0,0] op_sel_hi:[0,1] neg_lo:[0,0] neg_hi:[0,0]
v_pk_fma_f32 v[26:27], v[24:25], s[62:63], v[26:27] op_sel:[1,1,0] op_sel_hi:[1,0,1] neg_lo:[0,1,0] neg_hi:[0,0,0]
v_pk_add_f32 v[24:25], v[20:21], v[28:29] op_sel:[1,1] op_sel_hi:[0,0] neg_lo:[1,0] neg_hi:[0,1]
v_pk_add_f32 v[20:21], v[20:21], v[28:29]
v_pk_add_f32 v[28:29], v[22:23], v[30:31] neg_lo:[0,1] neg_hi:[0,1]
v_pk_add_f32 v[22:23], v[22:23], v[30:31]
v_pk_mul_f32 v[30:31], v[28:29], s[62:63] op_sel:[0,0] op_sel_hi:[0,1] neg_lo:[0,1] neg_hi:[0,0]
v_pk_fma_f32 v[30:31], v[28:29], s[62:63], v[30:31] op_sel:[1,1,0] op_sel_hi:[1,0,1] neg_lo:[0,1,0] neg_hi:[0,1,0]
v_pk_add_f32 v[28:29], v[64:65], v[32:33] neg_lo:[0,1] neg_hi:[0,1]
v_pk_add_f32 v[64:65], v[64:65], v[32:33]
v_pk_add_f32 v[32:33], v[34:35], v[42:43] neg_lo:[0,1] neg_hi:[0,1]
v_pk_add_f32 v[34:35], v[34:35], v[42:43]
v_pk_mul_f32 v[42:43], v[32:33], s[62:63] op_sel:[0,0] op_sel_hi:[0,1] neg_lo:[0,0] neg_hi:[0,0]
v_pk_fma_f32 v[42:43], v[32:33], s[62:63], v[42:43] op_sel:[1,1,0] op_sel_hi:[1,0,1] neg_lo:[0,1,0] neg_hi:[0,0,0]
v_pk_add_f32 v[32:33], v[36:37], v[44:45] op_sel:[1,1] op_sel_hi:[0,0] neg_lo:[1,0] neg_hi:[0,1]
v_pk_add_f32 v[36:37], v[36:37], v[44:45]
v_pk_add_f32 v[44:45], v[38:39], v[46:47] neg_lo:[0,1] neg_hi:[0,1]
v_pk_add_f32 v[38:39], v[38:39], v[46:47]
v_pk_mul_f32 v[46:47], v[44:45], s[62:63] op_sel:[0,0] op_sel_hi:[0,1] neg_lo:[0,1] neg_hi:[0,0]
v_pk_fma_f32 v[46:47], v[44:45], s[62:63], v[46:47] op_sel:[1,1,0] op_sel_hi:[1,0,1] neg_lo:[0,1,0] neg_hi:[0,1,0]
v_pk_add_f32 v[44:45], v[14:15], v[56:57] neg_lo:[0,1] neg_hi:[0,1]
v_pk_add_f32 v[14:15], v[14:15], v[56:57]
v_pk_add_f32 v[56:57], v[50:51], v[58:59] neg_lo:[0,1] neg_hi:[0,1]
v_pk_add_f32 v[50:51], v[50:51], v[58:59]
v_pk_mul_f32 v[58:59], v[56:57], s[62:63] op_sel:[0,0] op_sel_hi:[0,1] neg_lo:[0,0] neg_hi:[0,0]
v_pk_fma_f32 v[58:59], v[56:57], s[62:63], v[58:59] op_sel:[1,1,0] op_sel_hi:[1,0,1] neg_lo:[0,1,0] neg_hi:[0,0,0]
v_pk_add_f32 v[56:57], v[52:53], v[60:61] op_sel:[1,1] op_sel_hi:[0,0] neg_lo:[1,0] neg_hi:[0,1]
v_pk_add_f32 v[52:53], v[52:53], v[60:61]
v_pk_add_f32 v[60:61], v[54:55], v[62:63] neg_lo:[0,1] neg_hi:[0,1]
v_pk_add_f32 v[54:55], v[54:55], v[62:63]
v_pk_mul_f32 v[62:63], v[60:61], s[62:63] op_sel:[0,0] op_sel_hi:[0,1] neg_lo:[0,1] neg_hi:[0,0]
v_pk_fma_f32 v[62:63], v[60:61], s[62:63], v[62:63] op_sel:[1,1,0] op_sel_hi:[1,0,1] neg_lo:[0,1,0] neg_hi:[0,1,0]
v_pk_add_f32 v[60:61], v[40:41], v[48:49] neg_lo:[0,1] neg_hi:[0,1]
v_pk_add_f32 v[40:41], v[40:41], v[48:49]
v_pk_add_f32 v[48:49], v[66:67], v[74:75] neg_lo:[0,1] neg_hi:[0,1]
v_pk_add_f32 v[66:67], v[66:67], v[74:75]
v_pk_mul_f32 v[74:75], v[48:49], s[62:63] op_sel:[0,0] op_sel_hi:[0,1] neg_lo:[0,0] neg_hi:[0,0]
v_pk_fma_f32 v[74:75], v[48:49], s[62:63], v[74:75] op_sel:[1,1,0] op_sel_hi:[1,0,1] neg_lo:[0,1,0] neg_hi:[0,0,0]
v_pk_add_f32 v[48:49], v[68:69], v[76:77] op_sel:[1,1] op_sel_hi:[0,0] neg_lo:[1,0] neg_hi:[0,1]
v_pk_add_f32 v[68:69], v[68:69], v[76:77]
v_pk_add_f32 v[76:77], v[70:71], v[78:79] neg_lo:[0,1] neg_hi:[0,1]
v_pk_add_f32 v[70:71], v[70:71], v[78:79]
v_pk_mul_f32 v[78:79], v[76:77], s[62:63] op_sel:[0,0] op_sel_hi:[0,1] neg_lo:[0,1] neg_hi:[0,0]
v_pk_fma_f32 v[78:79], v[76:77], s[62:63], v[78:79] op_sel:[1,1,0] op_sel_hi:[1,0,1] neg_lo:[0,1,0] neg_hi:[0,1,0]
v_pk_add_f32 v[76:77], v[16:17], v[20:21] neg_lo:[0,1] neg_hi:[0,1]
v_pk_add_f32 v[16:17], v[16:17], v[20:21]
v_pk_add_f32 v[20:21], v[18:19], v[22:23] op_sel:[1,1] op_sel_hi:[0,0] neg_lo:[1,0] neg_hi:[0,1]
v_pk_add_f32 v[18:19], v[18:19], v[22:23]
v_pk_add_f32 v[22:23], v[72:73], v[24:25] neg_lo:[0,1] neg_hi:[0,1]
v_pk_add_f32 v[72:73], v[72:73], v[24:25]
v_pk_add_f32 v[24:25], v[26:27], v[30:31] op_sel:[1,1] op_sel_hi:[0,0] neg_lo:[1,0] neg_hi:[0,1]
v_pk_add_f32 v[26:27], v[26:27], v[30:31]
v_pk_add_f32 v[30:31], v[64:65], v[36:37] neg_lo:[0,1] neg_hi:[0,1]
v_pk_add_f32 v[64:65], v[64:65], v[36:37]
v_pk_add_f32 v[36:37], v[34:35], v[38:39] op_sel:[1,1] op_sel_hi:[0,0] neg_lo:[1,0] neg_hi:[0,1]
v_pk_add_f32 v[34:35], v[34:35], v[38:39]
v_pk_add_f32 v[38:39], v[28:29], v[32:33] neg_lo:[0,1] neg_hi:[0,1]
v_pk_add_f32 v[28:29], v[28:29], v[32:33]
v_pk_add_f32 v[32:33], v[42:43], v[46:47] op_sel:[1,1] op_sel_hi:[0,0] neg_lo:[1,0] neg_hi:[0,1]
v_pk_add_f32 v[42:43], v[42:43], v[46:47]
v_pk_add_f32 v[46:47], v[14:15], v[52:53] neg_lo:[0,1] neg_hi:[0,1]
v_pk_add_f32 v[14:15], v[14:15], v[52:53]
v_pk_add_f32 v[52:53], v[50:51], v[54:55] op_sel:[1,1] op_sel_hi:[0,0] neg_lo:[1,0] neg_hi:[0,1]
v_pk_add_f32 v[50:51], v[50:51], v[54:55]
v_pk_add_f32 v[54:55], v[44:45], v[56:57] neg_lo:[0,1] neg_hi:[0,1]
v_pk_add_f32 v[44:45], v[44:45], v[56:57]
v_pk_add_f32 v[56:57], v[58:59], v[62:63] op_sel:[1,1] op_sel_hi:[0,0] neg_lo:[1,0] neg_hi:[0,1]
v_pk_add_f32 v[58:59], v[58:59], v[62:63]
v_pk_add_f32 v[62:63], v[40:41], v[68:69] neg_lo:[0,1] neg_hi:[0,1]
v_pk_add_f32 v[40:41], v[40:41], v[68:69]
v_pk_add_f32 v[68:69], v[66:67], v[70:71] op_sel:[1,1] op_sel_hi:[0,0] neg_lo:[1,0] neg_hi:[0,1]
v_pk_add_f32 v[66:67], v[66:67], v[70:71]
v_pk_add_f32 v[70:71], v[60:61], v[48:49] neg_lo:[0,1] neg_hi:[0,1]
v_pk_add_f32 v[60:61], v[60:61], v[48:49]
v_pk_add_f32 v[48:49], v[74:75], v[78:79] op_sel:[1,1] op_sel_hi:[0,0] neg_lo:[1,0] neg_hi:[0,1]
v_pk_add_f32 v[74:75], v[74:75], v[78:79]
v_pk_add_f32 v[78:79], v[16:17], v[18:19] neg_lo:[0,1] neg_hi:[0,1]
v_pk_add_f32 v[16:17], v[16:17], v[18:19]
v_pk_add_f32 v[18:19], v[76:77], v[20:21] neg_lo:[0,1] neg_hi:[0,1]
v_pk_add_f32 v[76:77], v[76:77], v[20:21]
v_pk_add_f32 v[20:21], v[72:73], v[26:27] neg_lo:[0,1] neg_hi:[0,1]
v_pk_add_f32 v[72:73], v[72:73], v[26:27]
v_pk_add_f32 v[26:27], v[22:23], v[24:25] neg_lo:[0,1] neg_hi:[0,1]
v_pk_add_f32 v[22:23], v[22:23], v[24:25]
v_pk_add_f32 v[24:25], v[64:65], v[34:35] neg_lo:[0,1] neg_hi:[0,1]
v_pk_add_f32 v[64:65], v[64:65], v[34:35]
v_pk_add_f32 v[34:35], v[30:31], v[36:37] neg_lo:[0,1] neg_hi:[0,1]
v_pk_add_f32 v[30:31], v[30:31], v[36:37]
v_pk_add_f32 v[36:37], v[28:29], v[42:43] neg_lo:[0,1] neg_hi:[0,1]
v_pk_add_f32 v[28:29], v[28:29], v[42:43]
v_pk_add_f32 v[42:43], v[38:39], v[32:33] neg_lo:[0,1] neg_hi:[0,1]
v_pk_add_f32 v[38:39], v[38:39], v[32:33]
v_pk_add_f32 v[32:33], v[14:15], v[50:51] neg_lo:[0,1] neg_hi:[0,1]
v_pk_add_f32 v[14:15], v[14:15], v[50:51]
v_pk_add_f32 v[50:51], v[46:47], v[52:53] neg_lo:[0,1] neg_hi:[0,1]
v_pk_add_f32 v[46:47], v[46:47], v[52:53]
v_pk_add_f32 v[52:53], v[44:45], v[58:59] neg_lo:[0,1] neg_hi:[0,1]
v_pk_add_f32 v[44:45], v[44:45], v[58:59]
v_pk_add_f32 v[58:59], v[54:55], v[56:57] neg_lo:[0,1] neg_hi:[0,1]
v_pk_add_f32 v[54:55], v[54:55], v[56:57]
v_pk_add_f32 v[56:57], v[40:41], v[66:67] neg_lo:[0,1] neg_hi:[0,1]
v_pk_add_f32 v[40:41], v[40:41], v[66:67]
v_pk_add_f32 v[66:67], v[62:63], v[68:69] neg_lo:[0,1] neg_hi:[0,1]
v_pk_add_f32 v[62:63], v[62:63], v[68:69]
v_pk_add_f32 v[68:69], v[60:61], v[74:75] neg_lo:[0,1] neg_hi:[0,1]
v_pk_add_f32 v[60:61], v[60:61], v[74:75]
v_pk_add_f32 v[74:75], v[70:71], v[48:49] neg_lo:[0,1] neg_hi:[0,1]
v_pk_add_f32 v[70:71], v[70:71], v[48:49]
ds_write2st64_b32 v12, v16, v17 offset0:0 offset1:16
ds_write_b32 v12, v14 offset:128
ds_write_b32 v12, v15 offset:4224
ds_write_b32 v12, v64 offset:256
ds_write_b32 v12, v65 offset:4352
ds_write_b32 v12, v40 offset:384
ds_write_b32 v12, v41 offset:4480
ds_write_b32 v12, v72 offset:512
ds_write_b32 v12, v73 offset:4608
ds_write_b32 v12, v44 offset:640
ds_write_b32 v12, v45 offset:4736
ds_write_b32 v12, v28 offset:768
ds_write_b32 v12, v29 offset:4864
ds_write_b32 v12, v60 offset:896
ds_write_b32 v12, v61 offset:4992
ds_write_b32 v12, v76 offset:1024
ds_write_b32 v12, v77 offset:5120
ds_write_b32 v12, v46 offset:1152
ds_write_b32 v12, v47 offset:5248
ds_write_b32 v12, v30 offset:1280
ds_write_b32 v12, v31 offset:5376
ds_write_b32 v12, v62 offset:1408
ds_write_b32 v12, v63 offset:5504
ds_write_b32 v12, v22 offset:1536
ds_write_b32 v12, v23 offset:5632
ds_write_b32 v12, v54 offset:1664
ds_write_b32 v12, v55 offset:5760
ds_write_b32 v12, v38 offset:1792
ds_write_b32 v12, v39 offset:5888
ds_write_b32 v12, v70 offset:1920
ds_write_b32 v12, v71 offset:6016
ds_write_b32 v12, v78 offset:2048
ds_write_b32 v12, v79 offset:6144
ds_write_b32 v12, v32 offset:2176
ds_write_b32 v12, v33 offset:6272
ds_write_b32 v12, v24 offset:2304
ds_write_b32 v12, v25 offset:6400
ds_write_b32 v12, v56 offset:2432
ds_write_b32 v12, v57 offset:6528
ds_write_b32 v12, v20 offset:2560
ds_write_b32 v12, v21 offset:6656
ds_write_b32 v12, v52 offset:2688
ds_write_b32 v12, v53 offset:6784
ds_write_b32 v12, v36 offset:2816
ds_write_b32 v12, v37 offset:6912
ds_write_b32 v12, v68 offset:2944
ds_write_b32 v12, v69 offset:7040
ds_write_b32 v12, v18 offset:3072
ds_write_b32 v12, v19 offset:7168
ds_write_b32 v12, v50 offset:3200
ds_write_b32 v12, v51 offset:7296
ds_write_b32 v12, v34 offset:3328
ds_write_b32 v12, v35 offset:7424
ds_write_b32 v12, v66 offset:3456
ds_write_b32 v12, v67 offset:7552
ds_write_b32 v12, v26 offset:3584
ds_write_b32 v12, v27 offset:7680
ds_write_b32 v12, v58 offset:3712
ds_write_b32 v12, v59 offset:7808
ds_write_b32 v12, v42 offset:3840
ds_write_b32 v12, v43 offset:7936
ds_write_b32 v12, v74 offset:3968
ds_write_b32 v12, v75 offset:8064
s_waitcnt lgkmcnt(0)
s_barrier
s_lshl_b32 s13, s93, 16
ds_read_b128 v[16:19], v2 offset:0
ds_read_b128 v[20:23], v2 offset:16
ds_read_b128 v[24:27], v2 offset:8448
ds_read_b128 v[28:31], v2 offset:8464
ds_read_b128 v[32:35], v2 offset:16896
ds_read_b128 v[36:39], v2 offset:16912
ds_read_b128 v[40:43], v2 offset:25344
ds_read_b128 v[44:47], v2 offset:25360
ds_read_b128 v[48:51], v2 offset:33792
ds_read_b128 v[52:55], v2 offset:33808
ds_read_b128 v[56:59], v2 offset:42240
ds_read_b128 v[60:63], v2 offset:42256
ds_read_b128 v[64:67], v2 offset:50688
ds_read_b128 v[68:71], v2 offset:50704
s_waitcnt lgkmcnt(12)
ds_read_b128 v[72:75], v2 offset:59136
ds_read_b128 v[76:79], v2 offset:59152
s_waitcnt lgkmcnt(14)
v_cvt_pk_bf16_f32 v216, v16, v17
v_cvt_pk_bf16_f32 v217, v18, v19
v_cvt_pk_bf16_f32 v218, v20, v21
v_cvt_pk_bf16_f32 v219, v22, v23
buffer_store_dwordx4 v[216:219], v3, s[4:7], s13 offen sc1
s_add_u32 s13, s13, 8192
s_waitcnt lgkmcnt(12)
v_cvt_pk_bf16_f32 v220, v24, v25
v_cvt_pk_bf16_f32 v221, v26, v27
v_cvt_pk_bf16_f32 v222, v28, v29
v_cvt_pk_bf16_f32 v223, v30, v31
buffer_store_dwordx4 v[220:223], v3, s[4:7], s13 offen sc1
s_add_u32 s13, s13, 8192
s_waitcnt lgkmcnt(10)
v_cvt_pk_bf16_f32 v224, v32, v33
v_cvt_pk_bf16_f32 v225, v34, v35
v_cvt_pk_bf16_f32 v226, v36, v37
v_cvt_pk_bf16_f32 v227, v38, v39
buffer_store_dwordx4 v[224:227], v3, s[4:7], s13 offen sc1
s_add_u32 s13, s13, 8192
s_waitcnt lgkmcnt(8)
v_cvt_pk_bf16_f32 v228, v40, v41
v_cvt_pk_bf16_f32 v229, v42, v43
v_cvt_pk_bf16_f32 v230, v44, v45
v_cvt_pk_bf16_f32 v231, v46, v47
buffer_store_dwordx4 v[228:231], v3, s[4:7], s13 offen sc1
s_add_u32 s13, s13, 8192
s_waitcnt lgkmcnt(6)
v_cvt_pk_bf16_f32 v232, v48, v49
v_cvt_pk_bf16_f32 v233, v50, v51
v_cvt_pk_bf16_f32 v234, v52, v53
v_cvt_pk_bf16_f32 v235, v54, v55
buffer_store_dwordx4 v[232:235], v3, s[4:7], s13 offen sc1
s_add_u32 s13, s13, 8192
s_waitcnt lgkmcnt(4)
v_cvt_pk_bf16_f32 v236, v56, v57
v_cvt_pk_bf16_f32 v237, v58, v59
v_cvt_pk_bf16_f32 v238, v60, v61
v_cvt_pk_bf16_f32 v239, v62, v63
buffer_store_dwordx4 v[236:239], v3, s[4:7], s13 offen sc1
s_add_u32 s13, s13, 8192
s_waitcnt lgkmcnt(2)
v_cvt_pk_bf16_f32 v240, v64, v65
v_cvt_pk_bf16_f32 v241, v66, v67
v_cvt_pk_bf16_f32 v242, v68, v69
v_cvt_pk_bf16_f32 v243, v70, v71
buffer_store_dwordx4 v[240:243], v3, s[4:7], s13 offen sc1
s_add_u32 s13, s13, 8192
s_waitcnt lgkmcnt(0)
v_cvt_pk_bf16_f32 v244, v72, v73
v_cvt_pk_bf16_f32 v245, v74, v75
v_cvt_pk_bf16_f32 v246, v76, v77
v_cvt_pk_bf16_f32 v247, v78, v79
buffer_store_dwordx4 v[244:247], v3, s[4:7], s13 offen sc1
s_add_u32 s13, s13, 8192
s_mov_b32 s93, s21
s_cmp_lt_u32 s93, 128
s_cbranch_scc1 mega_kernel_f3_l
mega_kernel_f3_e:
s_waitcnt vmcnt(0)
s_barrier
s_add_u32 s64, s91, 58
s_mov_b32 s65, 64
s_mov_b32 s67, 1
s_add_u32 s66, s66, 262144
s_cmp_eq_u32 s91, 0
s_cbranch_scc1 mega_kernel_out
s_lshr_b32 s66, s40, 2
s_lshl_b32 s66, s66, 16
s_and_b32 s76, s40, 3
s_lshl_b32 s76, s76, 13
s_add_u32 s66, s66, s76
s_add_u32 s66, s66, 67141632
mega_kernel_out:
s_load_dwordx2 s[4:5], s[0:1], 40
s_load_dwordx2 s[8:9], s[0:1], 80
v_lshrrev_b32 v2, 6, v0
v_and_b32 v1, 63, v0
v_readfirstlane_b32 s41, v2
v_lshlrev_b32 v5, 4, v1
s_waitcnt lgkmcnt(0)
s_mov_b32 s6, 8388608
s_mov_b32 s7, 0x00020000
s_mov_b32 s10, 8388608
s_mov_b32 s11, 0x00020000
s_and_b32 s58, s40, 1
s_lshr_b32 s59, s40, 1
s_lshl_b32 s43, s58, 22
s_lshl_b32 s44, s41, 20
s_add_u32 s43, s43, s44
s_lshl_b32 s44, s59, 7
s_add_u32 s48, s43, s44
s_and_b32 s56, s59, 7
s_lshl_b32 s56, s56, 6
s_cmp_eq_u32 s68, 2
s_cbranch_scc1 mega_kernel_o_hw
v_lshrrev_b32 v2, 3, v1
v_and_b32 v3, 7, v1
v_lshlrev_b32 v16, 11, v2
v_lshl_add_u32 v16, v3, 4, v16
v_add_u32 v16, s48, v16
v_and_b32 v3, 3, v1
s_lshl_b32 s45, s41, 15
v_bfe_u32 v17, v1, 2, 2
v_lshrrev_b32 v18, 5, v1
v_mul_u32_u24 v18, 4, v18
v_add_u32 v17, v17, v18
v_lshlrev_b32 v17, 7, v17
v_bfe_u32 v18, v1, 4, 1
v_lshl_add_u32 v17, v18, 5, v17
v_lshl_add_u32 v17, v3, 3, v17
v_add_u32 v17, s45, v17
s_add_u32 m0, s45, 0
s_add_u32 s44, s56, 0
s_and_b32 s44, s44, 511
s_lshl_b32 s44, s44, 11
buffer_load_dwordx4 v16, s[4:7], s44 offen lds
s_add_u32 m0, s45, 1024
s_add_u32 s44, s56, 8
s_and_b32 s44, s44, 511
s_lshl_b32 s44, s44, 11
buffer_load_dwordx4 v16, s[4:7], s44 offen lds
s_add_u32 m0, s45, 2048
s_add_u32 s44, s56, 16
s_and_b32 s44, s44, 511
s_lshl_b32 s44, s44, 11
buffer_load_dwordx4 v16, s[4:7], s44 offen lds
s_add_u32 m0, s45, 3072
s_add_u32 s44, s56, 24
s_and_b32 s44, s44, 511
s_lshl_b32 s44, s44, 11
buffer_load_dwordx4 v16, s[4:7], s44 offen lds
s_add_u32 m0, s45, 4096
s_add_u32 s44, s56, 32
s_and_b32 s44, s44, 511
s_lshl_b32 s44, s44, 11
buffer_load_dwordx4 v16, s[4:7], s44 offen lds
s_add_u32 m0, s45, 5120
s_add_u32 s44, s56, 40
s_and_b32 s44, s44, 511
s_lshl_b32 s44, s44, 11
buffer_load_dwordx4 v16, s[4:7], s44 offen lds
s_add_u32 m0, s45, 6144
s_add_u32 s44, s56, 48
s_and_b32 s44, s44, 511
s_lshl_b32 s44, s44, 11
buffer_load_dwordx4 v16, s[4:7], s44 offen lds
s_add_u32 m0, s45, 7168
s_add_u32 s44, s56, 56
s_and_b32 s44, s44, 511
s_lshl_b32 s44, s44, 11
buffer_load_dwordx4 v16, s[4:7], s44 offen lds
s_add_u32 m0, s45, 8192
s_add_u32 s44, s56, 64
s_and_b32 s44, s44, 511
s_lshl_b32 s44, s44, 11
buffer_load_dwordx4 v16, s[4:7], s44 offen lds
s_add_u32 m0, s45, 9216
s_add_u32 s44, s56, 72
s_and_b32 s44, s44, 511
s_lshl_b32 s44, s44, 11
buffer_load_dwordx4 v16, s[4:7], s44 offen lds
s_add_u32 m0, s45, 10240
s_add_u32 s44, s56, 80
s_and_b32 s44, s44, 511
s_lshl_b32 s44, s44, 11
buffer_load_dwordx4 v16, s[4:7], s44 offen lds
s_add_u32 m0, s45, 11264
s_add_u32 s44, s56, 88
s_and_b32 s44, s44, 511
s_lshl_b32 s44, s44, 11
buffer_load_dwordx4 v16, s[4:7], s44 offen lds
s_add_u32 m0, s45, 12288
s_add_u32 s44, s56, 96
s_and_b32 s44, s44, 511
s_lshl_b32 s44, s44, 11
buffer_load_dwordx4 v16, s[4:7], s44 offen lds
s_add_u32 m0, s45, 13312
s_add_u32 s44, s56, 104
s_and_b32 s44, s44, 511
s_lshl_b32 s44, s44, 11
buffer_load_dwordx4 v16, s[4:7], s44 offen lds
s_add_u32 m0, s45, 14336
s_add_u32 s44, s56, 112
s_and_b32 s44, s44, 511
s_lshl_b32 s44, s44, 11
buffer_load_dwordx4 v16, s[4:7], s44 offen lds
s_add_u32 m0, s45, 15360
s_add_u32 s44, s56, 120
s_and_b32 s44, s44, 511
s_lshl_b32 s44, s44, 11
buffer_load_dwordx4 v16, s[4:7], s44 offen lds
s_add_u32 m0, s45, 16384
s_add_u32 s44, s56, 128
s_and_b32 s44, s44, 511
s_lshl_b32 s44, s44, 11
buffer_load_dwordx4 v16, s[4:7], s44 offen lds
s_add_u32 m0, s45, 17408
s_add_u32 s44, s56, 136
s_and_b32 s44, s44, 511
s_lshl_b32 s44, s44, 11
buffer_load_dwordx4 v16, s[4:7], s44 offen lds
s_add_u32 m0, s45, 18432
s_add_u32 s44, s56, 144
s_and_b32 s44, s44, 511
s_lshl_b32 s44, s44, 11
buffer_load_dwordx4 v16, s[4:7], s44 offen lds
s_add_u32 m0, s45, 19456
s_add_u32 s44, s56, 152
s_and_b32 s44, s44, 511
s_lshl_b32 s44, s44, 11
buffer_load_dwordx4 v16, s[4:7], s44 offen lds
s_add_u32 m0, s45, 20480
s_add_u32 s44, s56, 160
s_and_b32 s44, s44, 511
s_lshl_b32 s44, s44, 11
buffer_load_dwordx4 v16, s[4:7], s44 offen lds
s_add_u32 m0, s45, 21504
s_add_u32 s44, s56, 168
s_and_b32 s44, s44, 511
s_lshl_b32 s44, s44, 11
buffer_load_dwordx4 v16, s[4:7], s44 offen lds
s_add_u32 m0, s45, 22528
s_add_u32 s44, s56, 176
s_and_b32 s44, s44, 511
s_lshl_b32 s44, s44, 11
buffer_load_dwordx4 v16, s[4:7], s44 offen lds
s_add_u32 m0, s45, 23552
s_add_u32 s44, s56, 184
s_and_b32 s44, s44, 511
s_lshl_b32 s44, s44, 11
buffer_load_dwordx4 v16, s[4:7], s44 offen lds
s_add_u32 m0, s45, 24576
s_add_u32 s44, s56, 192
s_and_b32 s44, s44, 511
s_lshl_b32 s44, s44, 11
buffer_load_dwordx4 v16, s[4:7], s44 offen lds
s_add_u32 m0, s45, 25600
s_add_u32 s44, s56, 200
s_and_b32 s44, s44, 511
s_lshl_b32 s44, s44, 11
buffer_load_dwordx4 v16, s[4:7], s44 offen lds
s_add_u32 m0, s45, 26624
s_add_u32 s44, s56, 208
s_and_b32 s44, s44, 511
s_lshl_b32 s44, s44, 11
buffer_load_dwordx4 v16, s[4:7], s44 offen lds
s_add_u32 m0, s45, 27648
s_add_u32 s44, s56, 216
s_and_b32 s44, s44, 511
s_lshl_b32 s44, s44, 11
buffer_load_dwordx4 v16, s[4:7], s44 offen lds
s_add_u32 m0, s45, 28672
s_add_u32 s44, s56, 224
s_and_b32 s44, s44, 511
s_lshl_b32 s44, s44, 11
buffer_load_dwordx4 v16, s[4:7], s44 offen lds
s_add_u32 m0, s45, 29696
s_add_u32 s44, s56, 232
s_and_b32 s44, s44, 511
s_lshl_b32 s44, s44, 11
buffer_load_dwordx4 v16, s[4:7], s44 offen lds
s_add_u32 m0, s45, 30720
s_add_u32 s44, s56, 240
s_and_b32 s44, s44, 511
s_lshl_b32 s44, s44, 11
buffer_load_dwordx4 v16, s[4:7], s44 offen lds
s_add_u32 m0, s45, 31744
s_add_u32 s44, s56, 248
s_and_b32 s44, s44, 511
s_lshl_b32 s44, s44, 11
buffer_load_dwordx4 v16, s[4:7], s44 offen lds
s_waitcnt vmcnt(16)
ds_read_b64_tr_b16 a[0:1], v17 offset:0
ds_read_b64_tr_b16 a[2:3], v17 offset:2048
ds_read_b64_tr_b16 a[4:5], v17 offset:64
ds_read_b64_tr_b16 a[6:7], v17 offset:2112
ds_read_b64_tr_b16 a[8:9], v17 offset:1024
ds_read_b64_tr_b16 a[10:11], v17 offset:3072
ds_read_b64_tr_b16 a[12:13], v17 offset:1088
ds_read_b64_tr_b16 a[14:15], v17 offset:3136
s_waitcnt lgkmcnt(0)
ds_read_b64_tr_b16 a[16:17], v17 offset:4096
ds_read_b64_tr_b16 a[18:19], v17 offset:6144
ds_read_b64_tr_b16 a[20:21], v17 offset:4160
ds_read_b64_tr_b16 a[22:23], v17 offset:6208
ds_read_b64_tr_b16 a[24:25], v17 offset:5120
ds_read_b64_tr_b16 a[26:27], v17 offset:7168
ds_read_b64_tr_b16 a[28:29], v17 offset:5184
ds_read_b64_tr_b16 a[30:31], v17 offset:7232
s_waitcnt lgkmcnt(0)
ds_read_b64_tr_b16 a[32:33], v17 offset:8192
ds_read_b64_tr_b16 a[34:35], v17 offset:10240
ds_read_b64_tr_b16 a[36:37], v17 offset:8256
ds_read_b64_tr_b16 a[38:39], v17 offset:10304
ds_read_b64_tr_b16 a[40:41], v17 offset:9216
ds_read_b64_tr_b16 a[42:43], v17 offset:11264
ds_read_b64_tr_b16 a[44:45], v17 offset:9280
ds_read_b64_tr_b16 a[46:47], v17 offset:11328
s_waitcnt lgkmcnt(0)
ds_read_b64_tr_b16 a[48:49], v17 offset:12288
ds_read_b64_tr_b16 a[50:51], v17 offset:14336
ds_read_b64_tr_b16 a[52:53], v17 offset:12352
ds_read_b64_tr_b16 a[54:55], v17 offset:14400
ds_read_b64_tr_b16 a[56:57], v17 offset:13312
ds_read_b64_tr_b16 a[58:59], v17 offset:15360
ds_read_b64_tr_b16 a[60:61], v17 offset:13376
ds_read_b64_tr_b16 a[62:63], v17 offset:15424
s_waitcnt lgkmcnt(0)
s_add_u32 m0, s45, 0
s_add_u32 s44, s56, 256
s_and_b32 s44, s44, 511
s_lshl_b32 s44, s44, 11
buffer_load_dwordx4 v16, s[4:7], s44 offen lds
s_add_u32 m0, s45, 1024
s_add_u32 s44, s56, 264
s_and_b32 s44, s44, 511
s_lshl_b32 s44, s44, 11
buffer_load_dwordx4 v16, s[4:7], s44 offen lds
s_add_u32 m0, s45, 2048
s_add_u32 s44, s56, 272
s_and_b32 s44, s44, 511
s_lshl_b32 s44, s44, 11
buffer_load_dwordx4 v16, s[4:7], s44 offen lds
s_add_u32 m0, s45, 3072
s_add_u32 s44, s56, 280
s_and_b32 s44, s44, 511
s_lshl_b32 s44, s44, 11
buffer_load_dwordx4 v16, s[4:7], s44 offen lds
s_add_u32 m0, s45, 4096
s_add_u32 s44, s56, 288
s_and_b32 s44, s44, 511
s_lshl_b32 s44, s44, 11
buffer_load_dwordx4 v16, s[4:7], s44 offen lds
s_add_u32 m0, s45, 5120
s_add_u32 s44, s56, 296
s_and_b32 s44, s44, 511
s_lshl_b32 s44, s44, 11
buffer_load_dwordx4 v16, s[4:7], s44 offen lds
s_add_u32 m0, s45, 6144
s_add_u32 s44, s56, 304
s_and_b32 s44, s44, 511
s_lshl_b32 s44, s44, 11
buffer_load_dwordx4 v16, s[4:7], s44 offen lds
s_add_u32 m0, s45, 7168
s_add_u32 s44, s56, 312
s_and_b32 s44, s44, 511
s_lshl_b32 s44, s44, 11
buffer_load_dwordx4 v16, s[4:7], s44 offen lds
s_add_u32 m0, s45, 8192
s_add_u32 s44, s56, 320
s_and_b32 s44, s44, 511
s_lshl_b32 s44, s44, 11
buffer_load_dwordx4 v16, s[4:7], s44 offen lds
s_add_u32 m0, s45, 9216
s_add_u32 s44, s56, 328
s_and_b32 s44, s44, 511
s_lshl_b32 s44, s44, 11
buffer_load_dwordx4 v16, s[4:7], s44 offen lds
s_add_u32 m0, s45, 10240
s_add_u32 s44, s56, 336
s_and_b32 s44, s44, 511
s_lshl_b32 s44, s44, 11
buffer_load_dwordx4 v16, s[4:7], s44 offen lds
s_add_u32 m0, s45, 11264
s_add_u32 s44, s56, 344
s_and_b32 s44, s44, 511
s_lshl_b32 s44, s44, 11
buffer_load_dwordx4 v16, s[4:7], s44 offen lds
s_add_u32 m0, s45, 12288
s_add_u32 s44, s56, 352
s_and_b32 s44, s44, 511
s_lshl_b32 s44, s44, 11
buffer_load_dwordx4 v16, s[4:7], s44 offen lds
s_add_u32 m0, s45, 13312
s_add_u32 s44, s56, 360
s_and_b32 s44, s44, 511
s_lshl_b32 s44, s44, 11
buffer_load_dwordx4 v16, s[4:7], s44 offen lds
s_add_u32 m0, s45, 14336
s_add_u32 s44, s56, 368
s_and_b32 s44, s44, 511
s_lshl_b32 s44, s44, 11
buffer_load_dwordx4 v16, s[4:7], s44 offen lds
s_add_u32 m0, s45, 15360
s_add_u32 s44, s56, 376
s_and_b32 s44, s44, 511
s_lshl_b32 s44, s44, 11
buffer_load_dwordx4 v16, s[4:7], s44 offen lds
s_waitcnt vmcnt(16)
ds_read_b64_tr_b16 a[64:65], v17 offset:16384
ds_read_b64_tr_b16 a[66:67], v17 offset:18432
ds_read_b64_tr_b16 a[68:69], v17 offset:16448
ds_read_b64_tr_b16 a[70:71], v17 offset:18496
ds_read_b64_tr_b16 a[72:73], v17 offset:17408
ds_read_b64_tr_b16 a[74:75], v17 offset:19456
ds_read_b64_tr_b16 a[76:77], v17 offset:17472
ds_read_b64_tr_b16 a[78:79], v17 offset:19520
s_waitcnt lgkmcnt(0)
ds_read_b64_tr_b16 a[80:81], v17 offset:20480
ds_read_b64_tr_b16 a[82:83], v17 offset:22528
ds_read_b64_tr_b16 a[84:85], v17 offset:20544
ds_read_b64_tr_b16 a[86:87], v17 offset:22592
ds_read_b64_tr_b16 a[88:89], v17 offset:21504
ds_read_b64_tr_b16 a[90:91], v17 offset:23552
ds_read_b64_tr_b16 a[92:93], v17 offset:21568
ds_read_b64_tr_b16 a[94:95], v17 offset:23616
s_waitcnt lgkmcnt(0)
ds_read_b64_tr_b16 a[96:97], v17 offset:24576
ds_read_b64_tr_b16 a[98:99], v17 offset:26624
ds_read_b64_tr_b16 a[100:101], v17 offset:24640
ds_read_b64_tr_b16 a[102:103], v17 offset:26688
ds_read_b64_tr_b16 a[104:105], v17 offset:25600
ds_read_b64_tr_b16 a[106:107], v17 offset:27648
ds_read_b64_tr_b16 a[108:109], v17 offset:25664
ds_read_b64_tr_b16 a[110:111], v17 offset:27712
s_waitcnt lgkmcnt(0)
ds_read_b64_tr_b16 a[112:113], v17 offset:28672
ds_read_b64_tr_b16 a[114:115], v17 offset:30720
ds_read_b64_tr_b16 a[116:117], v17 offset:28736
ds_read_b64_tr_b16 a[118:119], v17 offset:30784
ds_read_b64_tr_b16 a[120:121], v17 offset:29696
ds_read_b64_tr_b16 a[122:123], v17 offset:31744
ds_read_b64_tr_b16 a[124:125], v17 offset:29760
ds_read_b64_tr_b16 a[126:127], v17 offset:31808
s_waitcnt lgkmcnt(0)
s_add_u32 m0, s45, 16384
s_add_u32 s44, s56, 384
s_and_b32 s44, s44, 511
s_lshl_b32 s44, s44, 11
buffer_load_dwordx4 v16, s[4:7], s44 offen lds
s_add_u32 m0, s45, 17408
s_add_u32 s44, s56, 392
s_and_b32 s44, s44, 511
s_lshl_b32 s44, s44, 11
buffer_load_dwordx4 v16, s[4:7], s44 offen lds
s_add_u32 m0, s45, 18432
s_add_u32 s44, s56, 400
s_and_b32 s44, s44, 511
s_lshl_b32 s44, s44, 11
buffer_load_dwordx4 v16, s[4:7], s44 offen lds
s_add_u32 m0, s45, 19456
s_add_u32 s44, s56, 408
s_and_b32 s44, s44, 511
s_lshl_b32 s44, s44, 11
buffer_load_dwordx4 v16, s[4:7], s44 offen lds
s_add_u32 m0, s45, 20480
s_add_u32 s44, s56, 416
s_and_b32 s44, s44, 511
s_lshl_b32 s44, s44, 11
buffer_load_dwordx4 v16, s[4:7], s44 offen lds
s_add_u32 m0, s45, 21504
s_add_u32 s44, s56, 424
s_and_b32 s44, s44, 511
s_lshl_b32 s44, s44, 11
buffer_load_dwordx4 v16, s[4:7], s44 offen lds
s_add_u32 m0, s45, 22528
s_add_u32 s44, s56, 432
s_and_b32 s44, s44, 511
s_lshl_b32 s44, s44, 11
buffer_load_dwordx4 v16, s[4:7], s44 offen lds
s_add_u32 m0, s45, 23552
s_add_u32 s44, s56, 440
s_and_b32 s44, s44, 511
s_lshl_b32 s44, s44, 11
buffer_load_dwordx4 v16, s[4:7], s44 offen lds
s_add_u32 m0, s45, 24576
s_add_u32 s44, s56, 448
s_and_b32 s44, s44, 511
s_lshl_b32 s44, s44, 11
buffer_load_dwordx4 v16, s[4:7], s44 offen lds
s_add_u32 m0, s45, 25600
s_add_u32 s44, s56, 456
s_and_b32 s44, s44, 511
s_lshl_b32 s44, s44, 11
buffer_load_dwordx4 v16, s[4:7], s44 offen lds
s_add_u32 m0, s45, 26624
s_add_u32 s44, s56, 464
s_and_b32 s44, s44, 511
s_lshl_b32 s44, s44, 11
buffer_load_dwordx4 v16, s[4:7], s44 offen lds
s_add_u32 m0, s45, 27648
s_add_u32 s44, s56, 472
s_and_b32 s44, s44, 511
s_lshl_b32 s44, s44, 11
buffer_load_dwordx4 v16, s[4:7], s44 offen lds
s_add_u32 m0, s45, 28672
s_add_u32 s44, s56, 480
s_and_b32 s44, s44, 511
s_lshl_b32 s44, s44, 11
buffer_load_dwordx4 v16, s[4:7], s44 offen lds
s_add_u32 m0, s45, 29696
s_add_u32 s44, s56, 488
s_and_b32 s44, s44, 511
s_lshl_b32 s44, s44, 11
buffer_load_dwordx4 v16, s[4:7], s44 offen lds
s_add_u32 m0, s45, 30720
s_add_u32 s44, s56, 496
s_and_b32 s44, s44, 511
s_lshl_b32 s44, s44, 11
buffer_load_dwordx4 v16, s[4:7], s44 offen lds
s_add_u32 m0, s45, 31744
s_add_u32 s44, s56, 504
s_and_b32 s44, s44, 511
s_lshl_b32 s44, s44, 11
buffer_load_dwordx4 v16, s[4:7], s44 offen lds
s_waitcnt vmcnt(16)
ds_read_b64_tr_b16 a[128:129], v17 offset:0
ds_read_b64_tr_b16 a[130:131], v17 offset:2048
ds_read_b64_tr_b16 a[132:133], v17 offset:64
ds_read_b64_tr_b16 a[134:135], v17 offset:2112
ds_read_b64_tr_b16 a[136:137], v17 offset:1024
ds_read_b64_tr_b16 a[138:139], v17 offset:3072
ds_read_b64_tr_b16 a[140:141], v17 offset:1088
ds_read_b64_tr_b16 a[142:143], v17 offset:3136
s_waitcnt lgkmcnt(0)
ds_read_b64_tr_b16 a[144:145], v17 offset:4096
ds_read_b64_tr_b16 a[146:147], v17 offset:6144
ds_read_b64_tr_b16 a[148:149], v17 offset:4160
ds_read_b64_tr_b16 a[150:151], v17 offset:6208
ds_read_b64_tr_b16 a[152:153], v17 offset:5120
ds_read_b64_tr_b16 a[154:155], v17 offset:7168
ds_read_b64_tr_b16 a[156:157], v17 offset:5184
ds_read_b64_tr_b16 a[158:159], v17 offset:7232
s_waitcnt lgkmcnt(0)
ds_read_b64_tr_b16 a[160:161], v17 offset:8192
ds_read_b64_tr_b16 a[162:163], v17 offset:10240
ds_read_b64_tr_b16 a[164:165], v17 offset:8256
ds_read_b64_tr_b16 a[166:167], v17 offset:10304
ds_read_b64_tr_b16 a[168:169], v17 offset:9216
ds_read_b64_tr_b16 a[170:171], v17 offset:11264
ds_read_b64_tr_b16 a[172:173], v17 offset:9280
ds_read_b64_tr_b16 a[174:175], v17 offset:11328
s_waitcnt lgkmcnt(0)
ds_read_b64_tr_b16 a[176:177], v17 offset:12288
ds_read_b64_tr_b16 a[178:179], v17 offset:14336
ds_read_b64_tr_b16 a[180:181], v17 offset:12352
ds_read_b64_tr_b16 a[182:183], v17 offset:14400
ds_read_b64_tr_b16 a[184:185], v17 offset:13312
ds_read_b64_tr_b16 a[186:187], v17 offset:15360
ds_read_b64_tr_b16 a[188:189], v17 offset:13376
ds_read_b64_tr_b16 a[190:191], v17 offset:15424
s_waitcnt lgkmcnt(0)
s_waitcnt vmcnt(0)
ds_read_b64_tr_b16 a[192:193], v17 offset:16384
ds_read_b64_tr_b16 a[194:195], v17 offset:18432
ds_read_b64_tr_b16 a[196:197], v17 offset:16448
ds_read_b64_tr_b16 a[198:199], v17 offset:18496
ds_read_b64_tr_b16 a[200:201], v17 offset:17408
ds_read_b64_tr_b16 a[202:203], v17 offset:19456
ds_read_b64_tr_b16 a[204:205], v17 offset:17472
ds_read_b64_tr_b16 a[206:207], v17 offset:19520
s_waitcnt lgkmcnt(0)
ds_read_b64_tr_b16 a[208:209], v17 offset:20480
ds_read_b64_tr_b16 a[210:211], v17 offset:22528
ds_read_b64_tr_b16 a[212:213], v17 offset:20544
ds_read_b64_tr_b16 a[214:215], v17 offset:22592
ds_read_b64_tr_b16 a[216:217], v17 offset:21504
ds_read_b64_tr_b16 a[218:219], v17 offset:23552
ds_read_b64_tr_b16 a[220:221], v17 offset:21568
ds_read_b64_tr_b16 a[222:223], v17 offset:23616
s_waitcnt lgkmcnt(0)
ds_read_b64_tr_b16 a[224:225], v17 offset:24576
ds_read_b64_tr_b16 a[226:227], v17 offset:26624
ds_read_b64_tr_b16 a[228:229], v17 offset:24640
ds_read_b64_tr_b16 a[230:231], v17 offset:26688
ds_read_b64_tr_b16 a[232:233], v17 offset:25600
ds_read_b64_tr_b16 a[234:235], v17 offset:27648
ds_read_b64_tr_b16 a[236:237], v17 offset:25664
ds_read_b64_tr_b16 a[238:239], v17 offset:27712
s_waitcnt lgkmcnt(0)
ds_read_b64_tr_b16 a[240:241], v17 offset:28672
ds_read_b64_tr_b16 a[242:243], v17 offset:30720
ds_read_b64_tr_b16 a[244:245], v17 offset:28736
ds_read_b64_tr_b16 a[246:247], v17 offset:30784
ds_read_b64_tr_b16 a[248:249], v17 offset:29696
ds_read_b64_tr_b16 a[250:251], v17 offset:31744
ds_read_b64_tr_b16 a[252:253], v17 offset:29760
ds_read_b64_tr_b16 a[254:255], v17 offset:31808
s_waitcnt lgkmcnt(0)
s_barrier
s_cmp_eq_u32 s68, 1
s_cbranch_scc1 mega_kernel_back
mega_kernel_o_hw:
s_lshl_b32 s56, s56, 6
s_lshl_b32 s43, s58, 18
s_lshl_b32 s44, s41, 16
s_add_u32 s43, s43, s44
s_add_u32 s43, s43, 134217728
v_add_u32 v6, s43, v5
v_and_b32 v2, 3, v1
v_lshlrev_b32 v7, 2, v2
v_bfe_u32 v2, v1, 2, 2
v_lshl_add_u32 v7, v2, 7, v7
s_lshl_b32 s43, s58, 11
s_lshl_b32 s44, s41, 9
s_add_u32 s43, s43, s44
s_lshl_b32 s44, s98, 13
s_add_u32 s43, s43, s44
s_add_u32 s43, s43, 69255168
v_add_u32 v7, s43, v7
s_mul_i32 s43, s41, 8704
v_lshrrev_b32 v2, 5, v1
v_lshl_add_u32 v8, v2, 5, v5
v_add_u32 v8, s43, v8
v_and_b32 v2, 7, v1
v_mul_u32_u24 v9, 544, v2
v_lshrrev_b32 v3, 3, v1
v_lshl_add_u32 v9, v3, 4, v9
s_lshl_b32 s43, s41, 7
v_add_u32 v9, s43, v9
s_mul_i32 s43, s58, 4352
s_sub_u32 s44, 4352, s43
v_add_u32 v10, s44, v9
v_add_u32 v9, s43, v9
s_lshl_b32 s43, s41, 15
s_lshl_b32 s44, s40, 6
s_add_u32 s43, s43, s44
v_lshlrev_b32 v11, 12, v3
v_and_b32 v2, 7, v1
v_lshl_add_u32 v11, v2, 3, v11
v_add_u32 v11, s43, v11
s_lshl_b32 s44, s41, 10
s_add_u32 s43, s66, s44
v_add_u32 v13, s43, v5
v_xor_b32 v12, 8192, v13
s_lshl_b32 s71, 1, s67
s_mov_b32 s42, s64
s_mov_b32 s52, 0
s_mov_b32 s53, 0
s_mov_b32 s57, 0
mega_kernel_o_cold:
s_cmp_gt_i32 s52, s42
s_cbranch_scc1 mega_kernel_o_fk
mega_kernel_o_fw:
buffer_load_dword v2, v7, s[84:87], 0 offen sc1
s_waitcnt vmcnt(0)
v_min_i32_dpp v2, v2, v2 quad_perm:[1,0,3,2] row_mask:0xf bank_mask:0xf
s_nop 1
v_min_i32_dpp v2, v2, v2 quad_perm:[2,3,0,1] row_mask:0xf bank_mask:0xf
s_nop 1
v_min_i32_dpp v2, v2, v2 row_ror:4 row_mask:0xf bank_mask:0xf
s_nop 1
v_min_i32_dpp v2, v2, v2 row_ror:8 row_mask:0xf bank_mask:0xf
s_nop 0
v_readfirstlane_b32 s52, v2
s_min_i32 s52, s52, s65
s_cmp_gt_i32 s52, s42
s_cbranch_scc1 mega_kernel_o_fk
s_sleep 2
s_add_u32 s43, s52, 2
s_cmp_gt_i32 s43, s42
s_cbranch_scc1 mega_kernel_o_fw
s_sleep 48
s_branch mega_kernel_o_fw
mega_kernel_o_fk:
s_add_u32 s54, s42, s71
s_cmp_gt_i32 s52, s54
s_cbranch_scc0 mega_kernel_o_c0
s_lshr_b32 s63, s42, 2
s_xnor_b32 s63, s63, s98
s_and_b32 s63, s63, 1
s_lshl_b32 s63, s63, 13
s_lshl_b32 s50, s42, 19
s_add_u32 s50, s50, s63
s_add_u32 s51, s56, 0
s_and_b32 s51, s51, 0x7fff
s_and_b32 s63, s51, 0x6000
s_add_u32 s51, s51, s63
s_add_u32 s51, s51, s50
buffer_load_dwordx4 v[96:99], v6, s[84:87], s51 offen offset:0 sc1
buffer_load_dwordx4 v[100:103], v6, s[84:87], s51 offen offset:1024 sc1
buffer_load_dwordx4 v[104:107], v6, s[84:87], s51 offen offset:2048 sc1
buffer_load_dwordx4 v[108:111], v6, s[84:87], s51 offen offset:3072 sc1
s_add_u32 s51, s56, 4096
s_and_b32 s51, s51, 0x7fff
s_and_b32 s63, s51, 0x6000
s_add_u32 s51, s51, s63
s_add_u32 s51, s51, s50
buffer_load_dwordx4 v[112:115], v6, s[84:87], s51 offen offset:0 sc1
buffer_load_dwordx4 v[116:119], v6, s[84:87], s51 offen offset:1024 sc1
buffer_load_dwordx4 v[120:123], v6, s[84:87], s51 offen offset:2048 sc1
buffer_load_dwordx4 v[124:127], v6, s[84:87], s51 offen offset:3072 sc1
s_add_u32 s51, s56, 8192
s_and_b32 s51, s51, 0x7fff
s_and_b32 s63, s51, 0x6000
s_add_u32 s51, s51, s63
s_add_u32 s51, s51, s50
buffer_load_dwordx4 v[128:131], v6, s[84:87], s51 offen offset:0 sc1
buffer_load_dwordx4 v[132:135], v6, s[84:87], s51 offen offset:1024 sc1
buffer_load_dwordx4 v[136:139], v6, s[84:87], s51 offen offset:2048 sc1
buffer_load_dwordx4 v[140:143], v6, s[84:87], s51 offen offset:3072 sc1
s_add_u32 s51, s56, 12288
s_and_b32 s51, s51, 0x7fff
s_and_b32 s63, s51, 0x6000
s_add_u32 s51, s51, s63
s_add_u32 s51, s51, s50
buffer_load_dwordx4 v[144:147], v6, s[84:87], s51 offen offset:0 sc1
buffer_load_dwordx4 v[148:151], v6, s[84:87], s51 offen offset:1024 sc1
buffer_load_dwordx4 v[152:155], v6, s[84:87], s51 offen offset:2048 sc1
buffer_load_dwordx4 v[156:159], v6, s[84:87], s51 offen offset:3072 sc1
s_add_u32 s51, s56, 16384
s_and_b32 s51, s51, 0x7fff
s_and_b32 s63, s51, 0x6000
s_add_u32 s51, s51, s63
s_add_u32 s51, s51, s50
buffer_load_dwordx4 v[160:163], v6, s[84:87], s51 offen offset:0 sc1
buffer_load_dwordx4 v[164:167], v6, s[84:87], s51 offen offset:1024 sc1
buffer_load_dwordx4 v[168:171], v6, s[84:87], s51 offen offset:2048 sc1
buffer_load_dwordx4 v[172:175], v6, s[84:87], s51 offen offset:3072 sc1
s_add_u32 s51, s56, 20480
s_and_b32 s51, s51, 0x7fff
s_and_b32 s63, s51, 0x6000
s_add_u32 s51, s51, s63
s_add_u32 s51, s51, s50
buffer_load_dwordx4 v[176:179], v6, s[84:87], s51 offen offset:0 sc1
buffer_load_dwordx4 v[180:183], v6, s[84:87], s51 offen offset:1024 sc1
buffer_load_dwordx4 v[184:187], v6, s[84:87], s51 offen offset:2048 sc1
buffer_load_dwordx4 v[188:191], v6, s[84:87], s51 offen offset:3072 sc1
s_add_u32 s51, s56, 24576
s_and_b32 s51, s51, 0x7fff
s_and_b32 s63, s51, 0x6000
s_add_u32 s51, s51, s63
s_add_u32 s51, s51, s50
buffer_load_dwordx4 v[192:195], v6, s[84:87], s51 offen offset:0 sc1
buffer_load_dwordx4 v[196:199], v6, s[84:87], s51 offen offset:1024 sc1
buffer_load_dwordx4 v[200:203], v6, s[84:87], s51 offen offset:2048 sc1
buffer_load_dwordx4 v[204:207], v6, s[84:87], s51 offen offset:3072 sc1
s_add_u32 s51, s56, 28672
s_and_b32 s51, s51, 0x7fff
s_and_b32 s63, s51, 0x6000
s_add_u32 s51, s51, s63
s_add_u32 s51, s51, s50
buffer_load_dwordx4 v[208:211], v6, s[84:87], s51 offen offset:0 sc1
buffer_load_dwordx4 v[212:215], v6, s[84:87], s51 offen offset:1024 sc1
buffer_load_dwordx4 v[216:219], v6, s[84:87], s51 offen offset:2048 sc1
buffer_load_dwordx4 v[220:223], v6, s[84:87], s51 offen offset:3072 sc1
mega_kernel_o_w0:
s_add_u32 s54, s42, s71
s_sub_u32 s62, s42, s71
s_lshr_b32 s63, s54, 2
s_xnor_b32 s63, s63, s98
s_and_b32 s63, s63, 1
s_lshl_b32 s63, s63, 13
s_lshl_b32 s50, s54, 19
s_add_u32 s50, s50, s63
s_cmp_gt_i32 s52, s54
s_cbranch_scc0 mega_kernel_o_n0
s_waitcnt vmcnt(31)
v_mfma_f32_32x32x16_bf16 v[20:35], a[0:3], v[96:99], 0
v_mfma_f32_32x32x16_bf16 v[36:51], a[4:7], v[96:99], 0
s_add_u32 s51, s56, 0
s_and_b32 s51, s51, 0x7fff
s_and_b32 s63, s51, 0x6000
s_add_u32 s51, s51, s63
s_add_u32 s51, s51, s50
buffer_load_dwordx4 v[96:99], v6, s[84:87], s51 offen offset:0 sc1
s_waitcnt vmcnt(31)
v_mfma_f32_32x32x16_bf16 v[20:35], a[8:11], v[100:103], v[20:35]
v_mfma_f32_32x32x16_bf16 v[36:51], a[12:15], v[100:103], v[36:51]
buffer_load_dwordx4 v[100:103], v6, s[84:87], s51 offen offset:1024 sc1
s_waitcnt vmcnt(31)
v_mfma_f32_32x32x16_bf16 v[20:35], a[16:19], v[104:107], v[20:35]
v_mfma_f32_32x32x16_bf16 v[36:51], a[20:23], v[104:107], v[36:51]
buffer_load_dwordx4 v[104:107], v6, s[84:87], s51 offen offset:2048 sc1
s_waitcnt vmcnt(31)
v_mfma_f32_32x32x16_bf16 v[20:35], a[24:27], v[108:111], v[20:35]
v_mfma_f32_32x32x16_bf16 v[36:51], a[28:31], v[108:111], v[36:51]
buffer_load_dwordx4 v[108:111], v6, s[84:87], s51 offen offset:3072 sc1
s_waitcnt vmcnt(31)
v_mfma_f32_32x32x16_bf16 v[20:35], a[32:35], v[112:115], v[20:35]
v_mfma_f32_32x32x16_bf16 v[36:51], a[36:39], v[112:115], v[36:51]
s_add_u32 s51, s56, 4096
s_and_b32 s51, s51, 0x7fff
s_and_b32 s63, s51, 0x6000
s_add_u32 s51, s51, s63
s_add_u32 s51, s51, s50
buffer_load_dwordx4 v[112:115], v6, s[84:87], s51 offen offset:0 sc1
s_waitcnt vmcnt(31)
v_mfma_f32_32x32x16_bf16 v[20:35], a[40:43], v[116:119], v[20:35]
v_mfma_f32_32x32x16_bf16 v[36:51], a[44:47], v[116:119], v[36:51]
buffer_load_dwordx4 v[116:119], v6, s[84:87], s51 offen offset:1024 sc1
s_waitcnt vmcnt(31)
v_mfma_f32_32x32x16_bf16 v[20:35], a[48:51], v[120:123], v[20:35]
v_mfma_f32_32x32x16_bf16 v[36:51], a[52:55], v[120:123], v[36:51]
buffer_load_dwordx4 v[120:123], v6, s[84:87], s51 offen offset:2048 sc1
s_waitcnt vmcnt(31)
v_mfma_f32_32x32x16_bf16 v[20:35], a[56:59], v[124:127], v[20:35]
v_mfma_f32_32x32x16_bf16 v[36:51], a[60:63], v[124:127], v[36:51]
buffer_load_dwordx4 v[124:127], v6, s[84:87], s51 offen offset:3072 sc1
s_waitcnt vmcnt(31)
v_mfma_f32_32x32x16_bf16 v[20:35], a[64:67], v[128:131], v[20:35]
v_mfma_f32_32x32x16_bf16 v[36:51], a[68:71], v[128:131], v[36:51]
s_add_u32 s51, s56, 8192
s_and_b32 s51, s51, 0x7fff
s_and_b32 s63, s51, 0x6000
s_add_u32 s51, s51, s63
s_add_u32 s51, s51, s50
buffer_load_dwordx4 v[128:131], v6, s[84:87], s51 offen offset:0 sc1
s_waitcnt vmcnt(31)
v_mfma_f32_32x32x16_bf16 v[20:35], a[72:75], v[132:135], v[20:35]
v_mfma_f32_32x32x16_bf16 v[36:51], a[76:79], v[132:135], v[36:51]
buffer_load_dwordx4 v[132:135], v6, s[84:87], s51 offen offset:1024 sc1
s_waitcnt vmcnt(31)
v_mfma_f32_32x32x16_bf16 v[20:35], a[80:83], v[136:139], v[20:35]
v_mfma_f32_32x32x16_bf16 v[36:51], a[84:87], v[136:139], v[36:51]
buffer_load_dwordx4 v[136:139], v6, s[84:87], s51 offen offset:2048 sc1
s_waitcnt vmcnt(31)
v_mfma_f32_32x32x16_bf16 v[20:35], a[88:91], v[140:143], v[20:35]
v_mfma_f32_32x32x16_bf16 v[36:51], a[92:95], v[140:143], v[36:51]
buffer_load_dwordx4 v[140:143], v6, s[84:87], s51 offen offset:3072 sc1
s_waitcnt vmcnt(31)
v_mfma_f32_32x32x16_bf16 v[20:35], a[96:99], v[144:147], v[20:35]
v_mfma_f32_32x32x16_bf16 v[36:51], a[100:103], v[144:147], v[36:51]
s_add_u32 s51, s56, 12288
s_and_b32 s51, s51, 0x7fff
s_and_b32 s63, s51, 0x6000
s_add_u32 s51, s51, s63
s_add_u32 s51, s51, s50
buffer_load_dwordx4 v[144:147], v6, s[84:87], s51 offen offset:0 sc1
s_waitcnt vmcnt(31)
v_mfma_f32_32x32x16_bf16 v[20:35], a[104:107], v[148:151], v[20:35]
v_mfma_f32_32x32x16_bf16 v[36:51], a[108:111], v[148:151], v[36:51]
buffer_load_dwordx4 v[148:151], v6, s[84:87], s51 offen offset:1024 sc1
s_waitcnt vmcnt(31)
v_mfma_f32_32x32x16_bf16 v[20:35], a[112:115], v[152:155], v[20:35]
v_mfma_f32_32x32x16_bf16 v[36:51], a[116:119], v[152:155], v[36:51]
buffer_load_dwordx4 v[152:155], v6, s[84:87], s51 offen offset:2048 sc1
s_waitcnt vmcnt(31)
v_mfma_f32_32x32x16_bf16 v[20:35], a[120:123], v[156:159], v[20:35]
v_mfma_f32_32x32x16_bf16 v[36:51], a[124:127], v[156:159], v[36:51]
buffer_load_dwordx4 v[156:159], v6, s[84:87], s51 offen offset:3072 sc1
s_waitcnt vmcnt(31)
v_mfma_f32_32x32x16_bf16 v[20:35], a[128:131], v[160:163], v[20:35]
v_mfma_f32_32x32x16_bf16 v[36:51], a[132:135], v[160:163], v[36:51]
s_add_u32 s51, s56, 16384
s_and_b32 s51, s51, 0x7fff
s_and_b32 s63, s51, 0x6000
s_add_u32 s51, s51, s63
s_add_u32 s51, s51, s50
buffer_load_dwordx4 v[160:163], v6, s[84:87], s51 offen offset:0 sc1
s_waitcnt vmcnt(31)
v_mfma_f32_32x32x16_bf16 v[20:35], a[136:139], v[164:167], v[20:35]
v_mfma_f32_32x32x16_bf16 v[36:51], a[140:143], v[164:167], v[36:51]
buffer_load_dwordx4 v[164:167], v6, s[84:87], s51 offen offset:1024 sc1
s_waitcnt vmcnt(31)
v_mfma_f32_32x32x16_bf16 v[20:35], a[144:147], v[168:171], v[20:35]
v_mfma_f32_32x32x16_bf16 v[36:51], a[148:151], v[168:171], v[36:51]
buffer_load_dwordx4 v[168:171], v6, s[84:87], s51 offen offset:2048 sc1
s_waitcnt vmcnt(31)
v_mfma_f32_32x32x16_bf16 v[20:35], a[152:155], v[172:175], v[20:35]
v_mfma_f32_32x32x16_bf16 v[36:51], a[156:159], v[172:175], v[36:51]
buffer_load_dwordx4 v[172:175], v6, s[84:87], s51 offen offset:3072 sc1
s_waitcnt vmcnt(31)
v_mfma_f32_32x32x16_bf16 v[20:35], a[160:163], v[176:179], v[20:35]
v_mfma_f32_32x32x16_bf16 v[36:51], a[164:167], v[176:179], v[36:51]
s_add_u32 s51, s56, 20480
s_and_b32 s51, s51, 0x7fff
s_and_b32 s63, s51, 0x6000
s_add_u32 s51, s51, s63
s_add_u32 s51, s51, s50
buffer_load_dwordx4 v[176:179], v6, s[84:87], s51 offen offset:0 sc1
s_waitcnt vmcnt(31)
v_mfma_f32_32x32x16_bf16 v[20:35], a[168:171], v[180:183], v[20:35]
v_mfma_f32_32x32x16_bf16 v[36:51], a[172:175], v[180:183], v[36:51]
buffer_load_dwordx4 v[180:183], v6, s[84:87], s51 offen offset:1024 sc1
s_waitcnt vmcnt(31)
v_mfma_f32_32x32x16_bf16 v[20:35], a[176:179], v[184:187], v[20:35]
v_mfma_f32_32x32x16_bf16 v[36:51], a[180:183], v[184:187], v[36:51]
buffer_load_dwordx4 v[184:187], v6, s[84:87], s51 offen offset:2048 sc1
s_waitcnt vmcnt(31)
v_mfma_f32_32x32x16_bf16 v[20:35], a[184:187], v[188:191], v[20:35]
v_mfma_f32_32x32x16_bf16 v[36:51], a[188:191], v[188:191], v[36:51]
buffer_load_dwordx4 v[188:191], v6, s[84:87], s51 offen offset:3072 sc1
s_waitcnt vmcnt(31)
v_mfma_f32_32x32x16_bf16 v[20:35], a[192:195], v[192:195], v[20:35]
v_mfma_f32_32x32x16_bf16 v[36:51], a[196:199], v[192:195], v[36:51]
s_add_u32 s51, s56, 24576
s_and_b32 s51, s51, 0x7fff
s_and_b32 s63, s51, 0x6000
s_add_u32 s51, s51, s63
s_add_u32 s51, s51, s50
buffer_load_dwordx4 v[192:195], v6, s[84:87], s51 offen offset:0 sc1
s_waitcnt vmcnt(31)
v_mfma_f32_32x32x16_bf16 v[20:35], a[200:203], v[196:199], v[20:35]
v_mfma_f32_32x32x16_bf16 v[36:51], a[204:207], v[196:199], v[36:51]
buffer_load_dwordx4 v[196:199], v6, s[84:87], s51 offen offset:1024 sc1
s_waitcnt vmcnt(31)
v_mfma_f32_32x32x16_bf16 v[20:35], a[208:211], v[200:203], v[20:35]
v_mfma_f32_32x32x16_bf16 v[36:51], a[212:215], v[200:203], v[36:51]
buffer_load_dwordx4 v[200:203], v6, s[84:87], s51 offen offset:2048 sc1
s_waitcnt vmcnt(31)
v_mfma_f32_32x32x16_bf16 v[20:35], a[216:219], v[204:207], v[20:35]
v_mfma_f32_32x32x16_bf16 v[36:51], a[220:223], v[204:207], v[36:51]
buffer_load_dwordx4 v[204:207], v6, s[84:87], s51 offen offset:3072 sc1
s_waitcnt vmcnt(31)
v_mfma_f32_32x32x16_bf16 v[20:35], a[224:227], v[208:211], v[20:35]
v_mfma_f32_32x32x16_bf16 v[36:51], a[228:231], v[208:211], v[36:51]
s_add_u32 s51, s56, 28672
s_and_b32 s51, s51, 0x7fff
s_and_b32 s63, s51, 0x6000
s_add_u32 s51, s51, s63
s_add_u32 s51, s51, s50
buffer_load_dwordx4 v[208:211], v6, s[84:87], s51 offen offset:0 sc1
s_waitcnt vmcnt(31)
v_mfma_f32_32x32x16_bf16 v[20:35], a[232:235], v[212:215], v[20:35]
v_mfma_f32_32x32x16_bf16 v[36:51], a[236:239], v[212:215], v[36:51]
buffer_load_dwordx4 v[212:215], v6, s[84:87], s51 offen offset:1024 sc1
s_waitcnt vmcnt(31)
v_mfma_f32_32x32x16_bf16 v[20:35], a[240:243], v[216:219], v[20:35]
v_mfma_f32_32x32x16_bf16 v[36:51], a[244:247], v[216:219], v[36:51]
buffer_load_dwordx4 v[216:219], v6, s[84:87], s51 offen offset:2048 sc1
s_waitcnt vmcnt(31)
v_mfma_f32_32x32x16_bf16 v[224:239], a[248:251], v[220:223], v[20:35]
v_mfma_f32_32x32x16_bf16 v[240:255], a[252:255], v[220:223], v[36:51]
buffer_load_dwordx4 v[220:223], v6, s[84:87], s51 offen offset:3072 sc1
s_add_u32 s42, s42, s71
s_branch mega_kernel_o_w1
mega_kernel_o_n0:
s_waitcnt vmcnt(31)
v_mfma_f32_32x32x16_bf16 v[20:35], a[0:3], v[96:99], 0
v_mfma_f32_32x32x16_bf16 v[36:51], a[4:7], v[96:99], 0
s_waitcnt vmcnt(30)
v_mfma_f32_32x32x16_bf16 v[20:35], a[8:11], v[100:103], v[20:35]
v_mfma_f32_32x32x16_bf16 v[36:51], a[12:15], v[100:103], v[36:51]
s_waitcnt vmcnt(29)
v_mfma_f32_32x32x16_bf16 v[20:35], a[16:19], v[104:107], v[20:35]
v_mfma_f32_32x32x16_bf16 v[36:51], a[20:23], v[104:107], v[36:51]
s_waitcnt vmcnt(28)
v_mfma_f32_32x32x16_bf16 v[20:35], a[24:27], v[108:111], v[20:35]
v_mfma_f32_32x32x16_bf16 v[36:51], a[28:31], v[108:111], v[36:51]
s_waitcnt vmcnt(27)
v_mfma_f32_32x32x16_bf16 v[20:35], a[32:35], v[112:115], v[20:35]
v_mfma_f32_32x32x16_bf16 v[36:51], a[36:39], v[112:115], v[36:51]
s_waitcnt vmcnt(26)
v_mfma_f32_32x32x16_bf16 v[20:35], a[40:43], v[116:119], v[20:35]
v_mfma_f32_32x32x16_bf16 v[36:51], a[44:47], v[116:119], v[36:51]
s_waitcnt vmcnt(25)
v_mfma_f32_32x32x16_bf16 v[20:35], a[48:51], v[120:123], v[20:35]
v_mfma_f32_32x32x16_bf16 v[36:51], a[52:55], v[120:123], v[36:51]
s_waitcnt vmcnt(24)
v_mfma_f32_32x32x16_bf16 v[20:35], a[56:59], v[124:127], v[20:35]
v_mfma_f32_32x32x16_bf16 v[36:51], a[60:63], v[124:127], v[36:51]
s_waitcnt vmcnt(23)
v_mfma_f32_32x32x16_bf16 v[20:35], a[64:67], v[128:131], v[20:35]
v_mfma_f32_32x32x16_bf16 v[36:51], a[68:71], v[128:131], v[36:51]
s_waitcnt vmcnt(22)
v_mfma_f32_32x32x16_bf16 v[20:35], a[72:75], v[132:135], v[20:35]
v_mfma_f32_32x32x16_bf16 v[36:51], a[76:79], v[132:135], v[36:51]
s_waitcnt vmcnt(21)
v_mfma_f32_32x32x16_bf16 v[20:35], a[80:83], v[136:139], v[20:35]
v_mfma_f32_32x32x16_bf16 v[36:51], a[84:87], v[136:139], v[36:51]
s_waitcnt vmcnt(20)
v_mfma_f32_32x32x16_bf16 v[20:35], a[88:91], v[140:143], v[20:35]
v_mfma_f32_32x32x16_bf16 v[36:51], a[92:95], v[140:143], v[36:51]
s_waitcnt vmcnt(19)
v_mfma_f32_32x32x16_bf16 v[20:35], a[96:99], v[144:147], v[20:35]
v_mfma_f32_32x32x16_bf16 v[36:51], a[100:103], v[144:147], v[36:51]
s_waitcnt vmcnt(18)
v_mfma_f32_32x32x16_bf16 v[20:35], a[104:107], v[148:151], v[20:35]
v_mfma_f32_32x32x16_bf16 v[36:51], a[108:111], v[148:151], v[36:51]
s_waitcnt vmcnt(17)
v_mfma_f32_32x32x16_bf16 v[20:35], a[112:115], v[152:155], v[20:35]
v_mfma_f32_32x32x16_bf16 v[36:51], a[116:119], v[152:155], v[36:51]
s_waitcnt vmcnt(16)
v_mfma_f32_32x32x16_bf16 v[20:35], a[120:123], v[156:159], v[20:35]
v_mfma_f32_32x32x16_bf16 v[36:51], a[124:127], v[156:159], v[36:51]
s_waitcnt vmcnt(15)
v_mfma_f32_32x32x16_bf16 v[20:35], a[128:131], v[160:163], v[20:35]
v_mfma_f32_32x32x16_bf16 v[36:51], a[132:135], v[160:163], v[36:51]
s_waitcnt vmcnt(14)
v_mfma_f32_32x32x16_bf16 v[20:35], a[136:139], v[164:167], v[20:35]
v_mfma_f32_32x32x16_bf16 v[36:51], a[140:143], v[164:167], v[36:51]
s_waitcnt vmcnt(13)
v_mfma_f32_32x32x16_bf16 v[20:35], a[144:147], v[168:171], v[20:35]
v_mfma_f32_32x32x16_bf16 v[36:51], a[148:151], v[168:171], v[36:51]
s_waitcnt vmcnt(12)
v_mfma_f32_32x32x16_bf16 v[20:35], a[152:155], v[172:175], v[20:35]
v_mfma_f32_32x32x16_bf16 v[36:51], a[156:159], v[172:175], v[36:51]
s_waitcnt vmcnt(11)
v_mfma_f32_32x32x16_bf16 v[20:35], a[160:163], v[176:179], v[20:35]
v_mfma_f32_32x32x16_bf16 v[36:51], a[164:167], v[176:179], v[36:51]
buffer_load_dword v15, v7, s[84:87], 0 offen sc1
s_waitcnt vmcnt(10)
v_mfma_f32_32x32x16_bf16 v[20:35], a[168:171], v[180:183], v[20:35]
v_mfma_f32_32x32x16_bf16 v[36:51], a[172:175], v[180:183], v[36:51]
s_waitcnt vmcnt(9)
v_mfma_f32_32x32x16_bf16 v[20:35], a[176:179], v[184:187], v[20:35]
v_mfma_f32_32x32x16_bf16 v[36:51], a[180:183], v[184:187], v[36:51]
s_waitcnt vmcnt(8)
v_mfma_f32_32x32x16_bf16 v[20:35], a[184:187], v[188:191], v[20:35]
v_mfma_f32_32x32x16_bf16 v[36:51], a[188:191], v[188:191], v[36:51]
s_waitcnt vmcnt(7)
v_mfma_f32_32x32x16_bf16 v[20:35], a[192:195], v[192:195], v[20:35]
v_mfma_f32_32x32x16_bf16 v[36:51], a[196:199], v[192:195], v[36:51]
s_waitcnt vmcnt(6)
v_mfma_f32_32x32x16_bf16 v[20:35], a[200:203], v[196:199], v[20:35]
v_mfma_f32_32x32x16_bf16 v[36:51], a[204:207], v[196:199], v[36:51]
s_waitcnt vmcnt(5)
v_mfma_f32_32x32x16_bf16 v[20:35], a[208:211], v[200:203], v[20:35]
v_mfma_f32_32x32x16_bf16 v[36:51], a[212:215], v[200:203], v[36:51]
s_waitcnt vmcnt(4)
v_mfma_f32_32x32x16_bf16 v[20:35], a[216:219], v[204:207], v[20:35]
v_mfma_f32_32x32x16_bf16 v[36:51], a[220:223], v[204:207], v[36:51]
s_waitcnt vmcnt(3)
v_mfma_f32_32x32x16_bf16 v[20:35], a[224:227], v[208:211], v[20:35]
v_mfma_f32_32x32x16_bf16 v[36:51], a[228:231], v[208:211], v[36:51]
s_waitcnt vmcnt(2)
v_mfma_f32_32x32x16_bf16 v[20:35], a[232:235], v[212:215], v[20:35]
v_mfma_f32_32x32x16_bf16 v[36:51], a[236:239], v[212:215], v[36:51]
s_waitcnt vmcnt(1)
v_mfma_f32_32x32x16_bf16 v[20:35], a[240:243], v[216:219], v[20:35]
v_mfma_f32_32x32x16_bf16 v[36:51], a[244:247], v[216:219], v[36:51]
s_waitcnt vmcnt(0)
v_mfma_f32_32x32x16_bf16 v[224:239], a[248:251], v[220:223], v[20:35]
v_mfma_f32_32x32x16_bf16 v[240:255], a[252:255], v[220:223], v[36:51]
s_branch mega_kernel_o_imm
mega_kernel_o_w1:
s_add_u32 s54, s42, s71
s_sub_u32 s62, s42, s71
s_lshr_b32 s63, s54, 2
s_xnor_b32 s63, s63, s98
s_and_b32 s63, s63, 1
s_lshl_b32 s63, s63, 13
s_lshl_b32 s50, s54, 19
s_add_u32 s50, s50, s63
s_cmp_gt_i32 s52, s54
s_cbranch_scc0 mega_kernel_o_n1
s_waitcnt vmcnt(31)
v_mfma_f32_32x32x16_bf16 v[20:35], a[0:3], v[96:99], 0
v_mfma_f32_32x32x16_bf16 v[36:51], a[4:7], v[96:99], 0
s_add_u32 s51, s56, 0
s_and_b32 s51, s51, 0x7fff
s_and_b32 s63, s51, 0x6000
s_add_u32 s51, s51, s63
s_add_u32 s51, s51, s50
buffer_load_dwordx4 v[96:99], v6, s[84:87], s51 offen offset:0 sc1
s_waitcnt vmcnt(31)
v_mfma_f32_32x32x16_bf16 v[20:35], a[8:11], v[100:103], v[20:35]
v_mfma_f32_32x32x16_bf16 v[36:51], a[12:15], v[100:103], v[36:51]
buffer_load_dwordx4 v[100:103], v6, s[84:87], s51 offen offset:1024 sc1
v_add_u32 v2, s53, v8
v_add_u32 v3, s53, v9
v_add_u32 v4, s53, v10
s_waitcnt vmcnt(31)
v_mfma_f32_32x32x16_bf16 v[20:35], a[16:19], v[104:107], v[20:35]
v_mfma_f32_32x32x16_bf16 v[36:51], a[20:23], v[104:107], v[36:51]
buffer_load_dwordx4 v[104:107], v6, s[84:87], s51 offen offset:2048 sc1
ds_write_b128 v2, v[224:227] offset:0
ds_write_b128 v2, v[228:231] offset:1088
s_waitcnt vmcnt(31)
v_mfma_f32_32x32x16_bf16 v[20:35], a[24:27], v[108:111], v[20:35]
v_mfma_f32_32x32x16_bf16 v[36:51], a[28:31], v[108:111], v[36:51]
buffer_load_dwordx4 v[108:111], v6, s[84:87], s51 offen offset:3072 sc1
ds_write_b128 v2, v[232:235] offset:2176
ds_write_b128 v2, v[236:239] offset:3264
s_waitcnt vmcnt(31)
v_mfma_f32_32x32x16_bf16 v[20:35], a[32:35], v[112:115], v[20:35]
v_mfma_f32_32x32x16_bf16 v[36:51], a[36:39], v[112:115], v[36:51]
s_add_u32 s51, s56, 4096
s_and_b32 s51, s51, 0x7fff
s_and_b32 s63, s51, 0x6000
s_add_u32 s51, s51, s63
s_add_u32 s51, s51, s50
buffer_load_dwordx4 v[112:115], v6, s[84:87], s51 offen offset:0 sc1
ds_write_b128 v2, v[240:243] offset:4352
ds_write_b128 v2, v[244:247] offset:5440
s_waitcnt vmcnt(31)
v_mfma_f32_32x32x16_bf16 v[20:35], a[40:43], v[116:119], v[20:35]
v_mfma_f32_32x32x16_bf16 v[36:51], a[44:47], v[116:119], v[36:51]
buffer_load_dwordx4 v[116:119], v6, s[84:87], s51 offen offset:1024 sc1
ds_write_b128 v2, v[248:251] offset:6528
ds_write_b128 v2, v[252:255] offset:7616
s_waitcnt vmcnt(31)
v_mfma_f32_32x32x16_bf16 v[20:35], a[48:51], v[120:123], v[20:35]
v_mfma_f32_32x32x16_bf16 v[36:51], a[52:55], v[120:123], v[36:51]
buffer_load_dwordx4 v[120:123], v6, s[84:87], s51 offen offset:2048 sc1
s_waitcnt vmcnt(31)
v_mfma_f32_32x32x16_bf16 v[20:35], a[56:59], v[124:127], v[20:35]
v_mfma_f32_32x32x16_bf16 v[36:51], a[60:63], v[124:127], v[36:51]
buffer_load_dwordx4 v[124:127], v6, s[84:87], s51 offen offset:3072 sc1
s_waitcnt lgkmcnt(0)
s_barrier
ds_read_b128 v[52:55], v4 offset:0
ds_read_b128 v[56:59], v4 offset:8704
ds_read_b128 v[60:63], v4 offset:17408
ds_read_b128 v[64:67], v4 offset:26112
s_waitcnt vmcnt(31)
v_mfma_f32_32x32x16_bf16 v[20:35], a[64:67], v[128:131], v[20:35]
v_mfma_f32_32x32x16_bf16 v[36:51], a[68:71], v[128:131], v[36:51]
s_add_u32 s51, s56, 8192
s_and_b32 s51, s51, 0x7fff
s_and_b32 s63, s51, 0x6000
s_add_u32 s51, s51, s63
s_add_u32 s51, s51, s50
buffer_load_dwordx4 v[128:131], v6, s[84:87], s51 offen offset:0 sc1
ds_read_b128 v[68:71], v3 offset:0
ds_read_b128 v[72:75], v3 offset:8704
ds_read_b128 v[76:79], v3 offset:17408
ds_read_b128 v[80:83], v3 offset:26112
s_sub_u32 s53, 34816, s53
s_sub_u32 s60, s62, s64
s_lshr_b32 s60, s60, s67
s_bfe_u32 s61, s60, 0x10001
s_and_b32 s60, s60, 1
s_lshl_b32 s60, s60, 12
s_waitcnt vmcnt(31)
v_mfma_f32_32x32x16_bf16 v[20:35], a[72:75], v[132:135], v[20:35]
v_mfma_f32_32x32x16_bf16 v[36:51], a[76:79], v[132:135], v[36:51]
buffer_load_dwordx4 v[132:135], v6, s[84:87], s51 offen offset:1024 sc1
s_waitcnt vmcnt(31)
v_mfma_f32_32x32x16_bf16 v[20:35], a[80:83], v[136:139], v[20:35]
v_mfma_f32_32x32x16_bf16 v[36:51], a[84:87], v[136:139], v[36:51]
buffer_load_dwordx4 v[136:139], v6, s[84:87], s51 offen offset:2048 sc1
s_waitcnt lgkmcnt(4)
v_add_f32 v52, v52, v56
v_add_f32 v60, v60, v64
v_add_f32 v53, v53, v57
v_add_f32 v61, v61, v65
v_add_f32 v54, v54, v58
v_add_f32 v62, v62, v66
v_add_f32 v55, v55, v59
v_add_f32 v63, v63, v67
s_waitcnt vmcnt(31)
v_mfma_f32_32x32x16_bf16 v[20:35], a[88:91], v[140:143], v[20:35]
v_mfma_f32_32x32x16_bf16 v[36:51], a[92:95], v[140:143], v[36:51]
buffer_load_dwordx4 v[140:143], v6, s[84:87], s51 offen offset:3072 sc1
v_add_f32 v52, v52, v60
v_add_f32 v53, v53, v61
v_add_f32 v54, v54, v62
v_add_f32 v55, v55, v63
v_and_or_b32 v52, v52, -2, s61
s_cmp_eq_u32 s95, 0
s_cbranch_scc1 mega_kernel_o_sa1
buffer_store_dwordx4 v[52:55], v12, s[84:87], s60 offen sc1
s_branch mega_kernel_o_sb1
mega_kernel_o_sa1:
buffer_store_dwordx4 v[52:55], v12, s[84:87], s60 offen
mega_kernel_o_sb1:
s_waitcnt vmcnt(31)
v_mfma_f32_32x32x16_bf16 v[20:35], a[96:99], v[144:147], v[20:35]
v_mfma_f32_32x32x16_bf16 v[36:51], a[100:103], v[144:147], v[36:51]
s_add_u32 s51, s56, 12288
s_and_b32 s51, s51, 0x7fff
s_and_b32 s63, s51, 0x6000
s_add_u32 s51, s51, s63
s_add_u32 s51, s51, s50
buffer_load_dwordx4 v[144:147], v6, s[84:87], s51 offen offset:0 sc1
s_waitcnt lgkmcnt(0)
v_add_f32 v68, v68, v72
v_add_f32 v76, v76, v80
v_add_f32 v69, v69, v73
v_add_f32 v77, v77, v81
v_add_f32 v70, v70, v74
v_add_f32 v78, v78, v82
v_add_f32 v71, v71, v75
v_add_f32 v79, v79, v83
s_waitcnt vmcnt(31)
v_mfma_f32_32x32x16_bf16 v[20:35], a[104:107], v[148:151], v[20:35]
v_mfma_f32_32x32x16_bf16 v[36:51], a[108:111], v[148:151], v[36:51]
buffer_load_dwordx4 v[148:151], v6, s[84:87], s51 offen offset:1024 sc1
v_add_f32 v84, v68, v76
v_add_f32 v85, v69, v77
v_add_f32 v86, v70, v78
v_add_f32 v87, v71, v79
s_waitcnt vmcnt(31)
v_mfma_f32_32x32x16_bf16 v[20:35], a[112:115], v[152:155], v[20:35]
v_mfma_f32_32x32x16_bf16 v[36:51], a[116:119], v[152:155], v[36:51]
buffer_load_dwordx4 v[152:155], v6, s[84:87], s51 offen offset:2048 sc1
s_waitcnt vmcnt(31)
v_mfma_f32_32x32x16_bf16 v[20:35], a[120:123], v[156:159], v[20:35]
v_mfma_f32_32x32x16_bf16 v[36:51], a[124:127], v[156:159], v[36:51]
buffer_load_dwordx4 v[156:159], v6, s[84:87], s51 offen offset:3072 sc1
s_waitcnt vmcnt(31)
v_mfma_f32_32x32x16_bf16 v[20:35], a[128:131], v[160:163], v[20:35]
v_mfma_f32_32x32x16_bf16 v[36:51], a[132:135], v[160:163], v[36:51]
s_add_u32 s51, s56, 16384
s_and_b32 s51, s51, 0x7fff
s_and_b32 s63, s51, 0x6000
s_add_u32 s51, s51, s63
s_add_u32 s51, s51, s50
buffer_load_dwordx4 v[160:163], v6, s[84:87], s51 offen offset:0 sc1
s_waitcnt vmcnt(31)
v_mfma_f32_32x32x16_bf16 v[20:35], a[136:139], v[164:167], v[20:35]
v_mfma_f32_32x32x16_bf16 v[36:51], a[140:143], v[164:167], v[36:51]
buffer_load_dwordx4 v[164:167], v6, s[84:87], s51 offen offset:1024 sc1
s_waitcnt vmcnt(31)
v_mfma_f32_32x32x16_bf16 v[20:35], a[144:147], v[168:171], v[20:35]
v_mfma_f32_32x32x16_bf16 v[36:51], a[148:151], v[168:171], v[36:51]
buffer_load_dwordx4 v[168:171], v6, s[84:87], s51 offen offset:2048 sc1
s_waitcnt vmcnt(31)
v_mfma_f32_32x32x16_bf16 v[20:35], a[152:155], v[172:175], v[20:35]
v_mfma_f32_32x32x16_bf16 v[36:51], a[156:159], v[172:175], v[36:51]
buffer_load_dwordx4 v[172:175], v6, s[84:87], s51 offen offset:3072 sc1
s_waitcnt vmcnt(31)
v_mfma_f32_32x32x16_bf16 v[20:35], a[160:163], v[176:179], v[20:35]
v_mfma_f32_32x32x16_bf16 v[36:51], a[164:167], v[176:179], v[36:51]
s_add_u32 s51, s56, 20480
s_and_b32 s51, s51, 0x7fff
s_and_b32 s63, s51, 0x6000
s_add_u32 s51, s51, s63
s_add_u32 s51, s51, s50
buffer_load_dwordx4 v[176:179], v6, s[84:87], s51 offen offset:0 sc1
s_waitcnt vmcnt(31)
v_mfma_f32_32x32x16_bf16 v[20:35], a[168:171], v[180:183], v[20:35]
v_mfma_f32_32x32x16_bf16 v[36:51], a[172:175], v[180:183], v[36:51]
buffer_load_dwordx4 v[180:183], v6, s[84:87], s51 offen offset:1024 sc1
s_waitcnt vmcnt(31)
v_mfma_f32_32x32x16_bf16 v[20:35], a[176:179], v[184:187], v[20:35]
v_mfma_f32_32x32x16_bf16 v[36:51], a[180:183], v[184:187], v[36:51]
buffer_load_dwordx4 v[184:187], v6, s[84:87], s51 offen offset:2048 sc1
s_waitcnt vmcnt(31)
v_mfma_f32_32x32x16_bf16 v[20:35], a[184:187], v[188:191], v[20:35]
v_mfma_f32_32x32x16_bf16 v[36:51], a[188:191], v[188:191], v[36:51]
buffer_load_dwordx4 v[188:191], v6, s[84:87], s51 offen offset:3072 sc1
s_waitcnt vmcnt(31)
v_mfma_f32_32x32x16_bf16 v[20:35], a[192:195], v[192:195], v[20:35]
v_mfma_f32_32x32x16_bf16 v[36:51], a[196:199], v[192:195], v[36:51]
s_add_u32 s51, s56, 24576
s_and_b32 s51, s51, 0x7fff
s_and_b32 s63, s51, 0x6000
s_add_u32 s51, s51, s63
s_add_u32 s51, s51, s50
buffer_load_dwordx4 v[192:195], v6, s[84:87], s51 offen offset:0 sc1
s_waitcnt vmcnt(31)
v_mfma_f32_32x32x16_bf16 v[20:35], a[200:203], v[196:199], v[20:35]
v_mfma_f32_32x32x16_bf16 v[36:51], a[204:207], v[196:199], v[36:51]
buffer_load_dwordx4 v[196:199], v6, s[84:87], s51 offen offset:1024 sc1
s_waitcnt vmcnt(31)
v_mfma_f32_32x32x16_bf16 v[20:35], a[208:211], v[200:203], v[20:35]
v_mfma_f32_32x32x16_bf16 v[36:51], a[212:215], v[200:203], v[36:51]
buffer_load_dwordx4 v[200:203], v6, s[84:87], s51 offen offset:2048 sc1
s_waitcnt vmcnt(31)
v_mfma_f32_32x32x16_bf16 v[20:35], a[216:219], v[204:207], v[20:35]
v_mfma_f32_32x32x16_bf16 v[36:51], a[220:223], v[204:207], v[36:51]
buffer_load_dwordx4 v[204:207], v6, s[84:87], s51 offen offset:3072 sc1
s_sub_u32 s60, s62, s64
s_lshr_b32 s60, s60, s67
s_bfe_u32 s61, s60, 0x10001
s_and_b32 s60, s60, 1
s_lshl_b32 s60, s60, 12
buffer_load_dwordx4 v[88:91], v13, s[84:87], s60 offen sc1
s_waitcnt vmcnt(31)
v_mfma_f32_32x32x16_bf16 v[20:35], a[224:227], v[208:211], v[20:35]
v_mfma_f32_32x32x16_bf16 v[36:51], a[228:231], v[208:211], v[36:51]
s_add_u32 s51, s56, 28672
s_and_b32 s51, s51, 0x7fff
s_and_b32 s63, s51, 0x6000
s_add_u32 s51, s51, s63
s_add_u32 s51, s51, s50
buffer_load_dwordx4 v[208:211], v6, s[84:87], s51 offen offset:0 sc1
s_waitcnt vmcnt(31)
v_mfma_f32_32x32x16_bf16 v[20:35], a[232:235], v[212:215], v[20:35]
v_mfma_f32_32x32x16_bf16 v[36:51], a[236:239], v[212:215], v[36:51]
buffer_load_dwordx4 v[212:215], v6, s[84:87], s51 offen offset:1024 sc1
s_waitcnt vmcnt(31)
v_mfma_f32_32x32x16_bf16 v[20:35], a[240:243], v[216:219], v[20:35]
v_mfma_f32_32x32x16_bf16 v[36:51], a[244:247], v[216:219], v[36:51]
buffer_load_dwordx4 v[216:219], v6, s[84:87], s51 offen offset:2048 sc1
s_waitcnt vmcnt(31)
v_mfma_f32_32x32x16_bf16 v[224:239], a[248:251], v[220:223], v[20:35]
v_mfma_f32_32x32x16_bf16 v[240:255], a[252:255], v[220:223], v[36:51]
buffer_load_dwordx4 v[220:223], v6, s[84:87], s51 offen offset:3072 sc1
s_waitcnt vmcnt(4)
mega_kernel_o_f1c:
v_and_b32 v14, 1, v88
v_cmp_ne_u32 vcc, s61, v14
s_cbranch_vccz mega_kernel_o_f1k
s_sub_u32 s60, s62, s64
s_lshr_b32 s60, s60, s67
s_bfe_u32 s61, s60, 0x10001
s_and_b32 s60, s60, 1
s_lshl_b32 s60, s60, 12
buffer_load_dwordx4 v[88:91], v13, s[84:87], s60 offen sc1
s_waitcnt vmcnt(0)
s_branch mega_kernel_o_f1c
mega_kernel_o_f1k:
v_pk_add_f32 v[88:89], v[88:89], v[84:85]
v_pk_add_f32 v[90:91], v[90:91], v[86:87]
s_lshl_b32 s60, s62, 17
v_cvt_pk_bf16_f32 v92, v88, v89
v_cvt_pk_bf16_f32 v93, v90, v91
buffer_store_dwordx2 v[92:93], v11, s[8:11], s60 offen sc1
s_add_u32 s42, s42, s71
s_branch mega_kernel_o_w1
mega_kernel_o_n1:
s_waitcnt vmcnt(31)
v_mfma_f32_32x32x16_bf16 v[20:35], a[0:3], v[96:99], 0
v_mfma_f32_32x32x16_bf16 v[36:51], a[4:7], v[96:99], 0
s_waitcnt vmcnt(30)
v_mfma_f32_32x32x16_bf16 v[20:35], a[8:11], v[100:103], v[20:35]
v_mfma_f32_32x32x16_bf16 v[36:51], a[12:15], v[100:103], v[36:51]
v_add_u32 v2, s53, v8
v_add_u32 v3, s53, v9
v_add_u32 v4, s53, v10
s_waitcnt vmcnt(29)
v_mfma_f32_32x32x16_bf16 v[20:35], a[16:19], v[104:107], v[20:35]
v_mfma_f32_32x32x16_bf16 v[36:51], a[20:23], v[104:107], v[36:51]
ds_write_b128 v2, v[224:227] offset:0
ds_write_b128 v2, v[228:231] offset:1088
s_waitcnt vmcnt(28)
v_mfma_f32_32x32x16_bf16 v[20:35], a[24:27], v[108:111], v[20:35]
v_mfma_f32_32x32x16_bf16 v[36:51], a[28:31], v[108:111], v[36:51]
ds_write_b128 v2, v[232:235] offset:2176
ds_write_b128 v2, v[236:239] offset:3264
s_waitcnt vmcnt(27)
v_mfma_f32_32x32x16_bf16 v[20:35], a[32:35], v[112:115], v[20:35]
v_mfma_f32_32x32x16_bf16 v[36:51], a[36:39], v[112:115], v[36:51]
ds_write_b128 v2, v[240:243] offset:4352
ds_write_b128 v2, v[244:247] offset:5440
s_waitcnt vmcnt(26)
v_mfma_f32_32x32x16_bf16 v[20:35], a[40:43], v[116:119], v[20:35]
v_mfma_f32_32x32x16_bf16 v[36:51], a[44:47], v[116:119], v[36:51]
ds_write_b128 v2, v[248:251] offset:6528
ds_write_b128 v2, v[252:255] offset:7616
s_waitcnt vmcnt(25)
v_mfma_f32_32x32x16_bf16 v[20:35], a[48:51], v[120:123], v[20:35]
v_mfma_f32_32x32x16_bf16 v[36:51], a[52:55], v[120:123], v[36:51]
s_waitcnt vmcnt(24)
v_mfma_f32_32x32x16_bf16 v[20:35], a[56:59], v[124:127], v[20:35]
v_mfma_f32_32x32x16_bf16 v[36:51], a[60:63], v[124:127], v[36:51]
s_waitcnt lgkmcnt(0)
s_barrier
ds_read_b128 v[52:55], v4 offset:0
ds_read_b128 v[56:59], v4 offset:8704
ds_read_b128 v[60:63], v4 offset:17408
ds_read_b128 v[64:67], v4 offset:26112
s_waitcnt vmcnt(23)
v_mfma_f32_32x32x16_bf16 v[20:35], a[64:67], v[128:131], v[20:35]
v_mfma_f32_32x32x16_bf16 v[36:51], a[68:71], v[128:131], v[36:51]
ds_read_b128 v[68:71], v3 offset:0
ds_read_b128 v[72:75], v3 offset:8704
ds_read_b128 v[76:79], v3 offset:17408
ds_read_b128 v[80:83], v3 offset:26112
s_sub_u32 s53, 34816, s53
s_sub_u32 s60, s62, s64
s_lshr_b32 s60, s60, s67
s_bfe_u32 s61, s60, 0x10001
s_and_b32 s60, s60, 1
s_lshl_b32 s60, s60, 12
s_waitcnt vmcnt(22)
v_mfma_f32_32x32x16_bf16 v[20:35], a[72:75], v[132:135], v[20:35]
v_mfma_f32_32x32x16_bf16 v[36:51], a[76:79], v[132:135], v[36:51]
s_waitcnt vmcnt(21)
v_mfma_f32_32x32x16_bf16 v[20:35], a[80:83], v[136:139], v[20:35]
v_mfma_f32_32x32x16_bf16 v[36:51], a[84:87], v[136:139], v[36:51]
s_waitcnt lgkmcnt(4)
v_add_f32 v52, v52, v56
v_add_f32 v60, v60, v64
v_add_f32 v53, v53, v57
v_add_f32 v61, v61, v65
v_add_f32 v54, v54, v58
v_add_f32 v62, v62, v66
v_add_f32 v55, v55, v59
v_add_f32 v63, v63, v67
s_waitcnt vmcnt(20)
v_mfma_f32_32x32x16_bf16 v[20:35], a[88:91], v[140:143], v[20:35]
v_mfma_f32_32x32x16_bf16 v[36:51], a[92:95], v[140:143], v[36:51]
v_add_f32 v52, v52, v60
v_add_f32 v53, v53, v61
v_add_f32 v54, v54, v62
v_add_f32 v55, v55, v63
v_and_or_b32 v52, v52, -2, s61
s_cmp_eq_u32 s95, 0
s_cbranch_scc1 mega_kernel_o_sa2
buffer_store_dwordx4 v[52:55], v12, s[84:87], s60 offen sc1
s_branch mega_kernel_o_sb2
mega_kernel_o_sa2:
buffer_store_dwordx4 v[52:55], v12, s[84:87], s60 offen
mega_kernel_o_sb2:
s_waitcnt vmcnt(19)
v_mfma_f32_32x32x16_bf16 v[20:35], a[96:99], v[144:147], v[20:35]
v_mfma_f32_32x32x16_bf16 v[36:51], a[100:103], v[144:147], v[36:51]
s_waitcnt lgkmcnt(0)
v_add_f32 v68, v68, v72
v_add_f32 v76, v76, v80
v_add_f32 v69, v69, v73
v_add_f32 v77, v77, v81
v_add_f32 v70, v70, v74
v_add_f32 v78, v78, v82
v_add_f32 v71, v71, v75
v_add_f32 v79, v79, v83
s_waitcnt vmcnt(18)
v_mfma_f32_32x32x16_bf16 v[20:35], a[104:107], v[148:151], v[20:35]
v_mfma_f32_32x32x16_bf16 v[36:51], a[108:111], v[148:151], v[36:51]
v_add_f32 v84, v68, v76
v_add_f32 v85, v69, v77
v_add_f32 v86, v70, v78
v_add_f32 v87, v71, v79
s_waitcnt vmcnt(17)
v_mfma_f32_32x32x16_bf16 v[20:35], a[112:115], v[152:155], v[20:35]
v_mfma_f32_32x32x16_bf16 v[36:51], a[116:119], v[152:155], v[36:51]
s_waitcnt vmcnt(16)
v_mfma_f32_32x32x16_bf16 v[20:35], a[120:123], v[156:159], v[20:35]
v_mfma_f32_32x32x16_bf16 v[36:51], a[124:127], v[156:159], v[36:51]
s_waitcnt vmcnt(15)
v_mfma_f32_32x32x16_bf16 v[20:35], a[128:131], v[160:163], v[20:35]
v_mfma_f32_32x32x16_bf16 v[36:51], a[132:135], v[160:163], v[36:51]
s_waitcnt vmcnt(14)
v_mfma_f32_32x32x16_bf16 v[20:35], a[136:139], v[164:167], v[20:35]
v_mfma_f32_32x32x16_bf16 v[36:51], a[140:143], v[164:167], v[36:51]
s_waitcnt vmcnt(13)
v_mfma_f32_32x32x16_bf16 v[20:35], a[144:147], v[168:171], v[20:35]
v_mfma_f32_32x32x16_bf16 v[36:51], a[148:151], v[168:171], v[36:51]
s_waitcnt vmcnt(12)
v_mfma_f32_32x32x16_bf16 v[20:35], a[152:155], v[172:175], v[20:35]
v_mfma_f32_32x32x16_bf16 v[36:51], a[156:159], v[172:175], v[36:51]
s_waitcnt vmcnt(11)
v_mfma_f32_32x32x16_bf16 v[20:35], a[160:163], v[176:179], v[20:35]
v_mfma_f32_32x32x16_bf16 v[36:51], a[164:167], v[176:179], v[36:51]
buffer_load_dword v15, v7, s[84:87], 0 offen sc1
s_waitcnt vmcnt(10)
v_mfma_f32_32x32x16_bf16 v[20:35], a[168:171], v[180:183], v[20:35]
v_mfma_f32_32x32x16_bf16 v[36:51], a[172:175], v[180:183], v[36:51]
s_waitcnt vmcnt(9)
v_mfma_f32_32x32x16_bf16 v[20:35], a[176:179], v[184:187], v[20:35]
v_mfma_f32_32x32x16_bf16 v[36:51], a[180:183], v[184:187], v[36:51]
s_waitcnt vmcnt(8)
v_mfma_f32_32x32x16_bf16 v[20:35], a[184:187], v[188:191], v[20:35]
v_mfma_f32_32x32x16_bf16 v[36:51], a[188:191], v[188:191], v[36:51]
s_waitcnt vmcnt(7)
v_mfma_f32_32x32x16_bf16 v[20:35], a[192:195], v[192:195], v[20:35]
v_mfma_f32_32x32x16_bf16 v[36:51], a[196:199], v[192:195], v[36:51]
s_waitcnt vmcnt(6)
v_mfma_f32_32x32x16_bf16 v[20:35], a[200:203], v[196:199], v[20:35]
v_mfma_f32_32x32x16_bf16 v[36:51], a[204:207], v[196:199], v[36:51]
s_waitcnt vmcnt(5)
v_mfma_f32_32x32x16_bf16 v[20:35], a[208:211], v[200:203], v[20:35]
v_mfma_f32_32x32x16_bf16 v[36:51], a[212:215], v[200:203], v[36:51]
s_waitcnt vmcnt(4)
v_mfma_f32_32x32x16_bf16 v[20:35], a[216:219], v[204:207], v[20:35]
v_mfma_f32_32x32x16_bf16 v[36:51], a[220:223], v[204:207], v[36:51]
s_sub_u32 s60, s62, s64
s_lshr_b32 s60, s60, s67
s_bfe_u32 s61, s60, 0x10001
s_and_b32 s60, s60, 1
s_lshl_b32 s60, s60, 12
buffer_load_dwordx4 v[88:91], v13, s[84:87], s60 offen sc1
s_waitcnt vmcnt(3)
v_mfma_f32_32x32x16_bf16 v[20:35], a[224:227], v[208:211], v[20:35]
v_mfma_f32_32x32x16_bf16 v[36:51], a[228:231], v[208:211], v[36:51]
s_waitcnt vmcnt(2)
v_mfma_f32_32x32x16_bf16 v[20:35], a[232:235], v[212:215], v[20:35]
v_mfma_f32_32x32x16_bf16 v[36:51], a[236:239], v[212:215], v[36:51]
s_waitcnt vmcnt(1)
v_mfma_f32_32x32x16_bf16 v[20:35], a[240:243], v[216:219], v[20:35]
v_mfma_f32_32x32x16_bf16 v[36:51], a[244:247], v[216:219], v[36:51]
s_waitcnt vmcnt(0)
v_mfma_f32_32x32x16_bf16 v[224:239], a[248:251], v[220:223], v[20:35]
v_mfma_f32_32x32x16_bf16 v[240:255], a[252:255], v[220:223], v[36:51]
s_waitcnt vmcnt(0)
mega_kernel_o_f0c:
v_and_b32 v14, 1, v88
v_cmp_ne_u32 vcc, s61, v14
s_cbranch_vccz mega_kernel_o_f0k
s_sub_u32 s60, s62, s64
s_lshr_b32 s60, s60, s67
s_bfe_u32 s61, s60, 0x10001
s_and_b32 s60, s60, 1
s_lshl_b32 s60, s60, 12
buffer_load_dwordx4 v[88:91], v13, s[84:87], s60 offen sc1
s_waitcnt vmcnt(0)
s_branch mega_kernel_o_f0c
mega_kernel_o_f0k:
v_pk_add_f32 v[88:89], v[88:89], v[84:85]
v_pk_add_f32 v[90:91], v[90:91], v[86:87]
s_lshl_b32 s60, s62, 17
v_cvt_pk_bf16_f32 v92, v88, v89
v_cvt_pk_bf16_f32 v93, v90, v91
buffer_store_dwordx2 v[92:93], v11, s[8:11], s60 offen sc1
mega_kernel_o_imm:
s_waitcnt vmcnt(1)
v_min_i32_dpp v15, v15, v15 quad_perm:[1,0,3,2] row_mask:0xf bank_mask:0xf
s_nop 1
v_min_i32_dpp v15, v15, v15 quad_perm:[2,3,0,1] row_mask:0xf bank_mask:0xf
s_nop 1
v_min_i32_dpp v15, v15, v15 row_ror:4 row_mask:0xf bank_mask:0xf
s_nop 1
v_min_i32_dpp v15, v15, v15 row_ror:8 row_mask:0xf bank_mask:0xf
s_nop 0
v_readfirstlane_b32 s52, v15
s_min_i32 s52, s52, s65
s_cmp_gt_i32 s52, s54
s_cbranch_scc0 mega_kernel_o_im2
s_add_u32 s42, s42, s71
s_add_u32 s54, s54, s71
s_cmp_gt_i32 s52, s54
s_cbranch_scc0 mega_kernel_o_c1
s_add_u32 s51, s56, 0
s_and_b32 s51, s51, 0x7fff
s_and_b32 s63, s51, 0x6000
s_add_u32 s51, s51, s63
s_add_u32 s51, s51, s50
buffer_load_dwordx4 v[96:99], v6, s[84:87], s51 offen offset:0 sc1
buffer_load_dwordx4 v[100:103], v6, s[84:87], s51 offen offset:1024 sc1
buffer_load_dwordx4 v[104:107], v6, s[84:87], s51 offen offset:2048 sc1
buffer_load_dwordx4 v[108:111], v6, s[84:87], s51 offen offset:3072 sc1
s_add_u32 s51, s56, 4096
s_and_b32 s51, s51, 0x7fff
s_and_b32 s63, s51, 0x6000
s_add_u32 s51, s51, s63
s_add_u32 s51, s51, s50
buffer_load_dwordx4 v[112:115], v6, s[84:87], s51 offen offset:0 sc1
buffer_load_dwordx4 v[116:119], v6, s[84:87], s51 offen offset:1024 sc1
buffer_load_dwordx4 v[120:123], v6, s[84:87], s51 offen offset:2048 sc1
buffer_load_dwordx4 v[124:127], v6, s[84:87], s51 offen offset:3072 sc1
s_add_u32 s51, s56, 8192
s_and_b32 s51, s51, 0x7fff
s_and_b32 s63, s51, 0x6000
s_add_u32 s51, s51, s63
s_add_u32 s51, s51, s50
buffer_load_dwordx4 v[128:131], v6, s[84:87], s51 offen offset:0 sc1
buffer_load_dwordx4 v[132:135], v6, s[84:87], s51 offen offset:1024 sc1
buffer_load_dwordx4 v[136:139], v6, s[84:87], s51 offen offset:2048 sc1
buffer_load_dwordx4 v[140:143], v6, s[84:87], s51 offen offset:3072 sc1
s_add_u32 s51, s56, 12288
s_and_b32 s51, s51, 0x7fff
s_and_b32 s63, s51, 0x6000
s_add_u32 s51, s51, s63
s_add_u32 s51, s51, s50
buffer_load_dwordx4 v[144:147], v6, s[84:87], s51 offen offset:0 sc1
buffer_load_dwordx4 v[148:151], v6, s[84:87], s51 offen offset:1024 sc1
buffer_load_dwordx4 v[152:155], v6, s[84:87], s51 offen offset:2048 sc1
buffer_load_dwordx4 v[156:159], v6, s[84:87], s51 offen offset:3072 sc1
s_add_u32 s51, s56, 16384
s_and_b32 s51, s51, 0x7fff
s_and_b32 s63, s51, 0x6000
s_add_u32 s51, s51, s63
s_add_u32 s51, s51, s50
buffer_load_dwordx4 v[160:163], v6, s[84:87], s51 offen offset:0 sc1
buffer_load_dwordx4 v[164:167], v6, s[84:87], s51 offen offset:1024 sc1
buffer_load_dwordx4 v[168:171], v6, s[84:87], s51 offen offset:2048 sc1
buffer_load_dwordx4 v[172:175], v6, s[84:87], s51 offen offset:3072 sc1
s_add_u32 s51, s56, 20480
s_and_b32 s51, s51, 0x7fff
s_and_b32 s63, s51, 0x6000
s_add_u32 s51, s51, s63
s_add_u32 s51, s51, s50
buffer_load_dwordx4 v[176:179], v6, s[84:87], s51 offen offset:0 sc1
buffer_load_dwordx4 v[180:183], v6, s[84:87], s51 offen offset:1024 sc1
buffer_load_dwordx4 v[184:187], v6, s[84:87], s51 offen offset:2048 sc1
buffer_load_dwordx4 v[188:191], v6, s[84:87], s51 offen offset:3072 sc1
s_add_u32 s51, s56, 24576
s_and_b32 s51, s51, 0x7fff
s_and_b32 s63, s51, 0x6000
s_add_u32 s51, s51, s63
s_add_u32 s51, s51, s50
buffer_load_dwordx4 v[192:195], v6, s[84:87], s51 offen offset:0 sc1
buffer_load_dwordx4 v[196:199], v6, s[84:87], s51 offen offset:1024 sc1
buffer_load_dwordx4 v[200:203], v6, s[84:87], s51 offen offset:2048 sc1
buffer_load_dwordx4 v[204:207], v6, s[84:87], s51 offen offset:3072 sc1
s_add_u32 s51, s56, 28672
s_and_b32 s51, s51, 0x7fff
s_and_b32 s63, s51, 0x6000
s_add_u32 s51, s51, s63
s_add_u32 s51, s51, s50
buffer_load_dwordx4 v[208:211], v6, s[84:87], s51 offen offset:0 sc1
buffer_load_dwordx4 v[212:215], v6, s[84:87], s51 offen offset:1024 sc1
buffer_load_dwordx4 v[216:219], v6, s[84:87], s51 offen offset:2048 sc1
buffer_load_dwordx4 v[220:223], v6, s[84:87], s51 offen offset:3072 sc1
s_branch mega_kernel_o_w1
mega_kernel_o_c0:
s_add_u32 s54, s42, s71
s_sub_u32 s62, s42, s71
s_lshr_b32 s63, s42, 2
s_xnor_b32 s63, s63, s98
s_and_b32 s63, s63, 1
s_lshl_b32 s63, s63, 13
s_lshl_b32 s50, s42, 19
s_add_u32 s50, s50, s63
s_add_u32 s51, s56, 0
s_and_b32 s51, s51, 0x7fff
s_and_b32 s63, s51, 0x6000
s_add_u32 s51, s51, s63
s_add_u32 s51, s51, s50
buffer_load_dwordx4 v[96:99], v6, s[84:87], s51 offen offset:0 sc1
buffer_load_dwordx4 v[100:103], v6, s[84:87], s51 offen offset:1024 sc1
buffer_load_dwordx4 v[104:107], v6, s[84:87], s51 offen offset:2048 sc1
buffer_load_dwordx4 v[108:111], v6, s[84:87], s51 offen offset:3072 sc1
s_add_u32 s51, s56, 4096
s_and_b32 s51, s51, 0x7fff
s_and_b32 s63, s51, 0x6000
s_add_u32 s51, s51, s63
s_add_u32 s51, s51, s50
buffer_load_dwordx4 v[112:115], v6, s[84:87], s51 offen offset:0 sc1
buffer_load_dwordx4 v[116:119], v6, s[84:87], s51 offen offset:1024 sc1
buffer_load_dwordx4 v[120:123], v6, s[84:87], s51 offen offset:2048 sc1
buffer_load_dwordx4 v[124:127], v6, s[84:87], s51 offen offset:3072 sc1
s_waitcnt vmcnt(7)
v_mfma_f32_32x32x16_bf16 v[20:35], a[0:3], v[96:99], 0
v_mfma_f32_32x32x16_bf16 v[36:51], a[4:7], v[96:99], 0
s_add_u32 s51, s56, 8192
s_and_b32 s51, s51, 0x7fff
s_and_b32 s63, s51, 0x6000
s_add_u32 s51, s51, s63
s_add_u32 s51, s51, s50
buffer_load_dwordx4 v[128:131], v6, s[84:87], s51 offen offset:0 sc1
s_waitcnt vmcnt(7)
v_mfma_f32_32x32x16_bf16 v[20:35], a[8:11], v[100:103], v[20:35]
v_mfma_f32_32x32x16_bf16 v[36:51], a[12:15], v[100:103], v[36:51]
buffer_load_dwordx4 v[132:135], v6, s[84:87], s51 offen offset:1024 sc1
s_waitcnt vmcnt(7)
v_mfma_f32_32x32x16_bf16 v[20:35], a[16:19], v[104:107], v[20:35]
v_mfma_f32_32x32x16_bf16 v[36:51], a[20:23], v[104:107], v[36:51]
buffer_load_dwordx4 v[136:139], v6, s[84:87], s51 offen offset:2048 sc1
s_waitcnt vmcnt(7)
v_mfma_f32_32x32x16_bf16 v[20:35], a[24:27], v[108:111], v[20:35]
v_mfma_f32_32x32x16_bf16 v[36:51], a[28:31], v[108:111], v[36:51]
buffer_load_dwordx4 v[140:143], v6, s[84:87], s51 offen offset:3072 sc1
s_waitcnt vmcnt(7)
v_mfma_f32_32x32x16_bf16 v[20:35], a[32:35], v[112:115], v[20:35]
v_mfma_f32_32x32x16_bf16 v[36:51], a[36:39], v[112:115], v[36:51]
s_add_u32 s51, s56, 12288
s_and_b32 s51, s51, 0x7fff
s_and_b32 s63, s51, 0x6000
s_add_u32 s51, s51, s63
s_add_u32 s51, s51, s50
buffer_load_dwordx4 v[144:147], v6, s[84:87], s51 offen offset:0 sc1
s_waitcnt vmcnt(7)
v_mfma_f32_32x32x16_bf16 v[20:35], a[40:43], v[116:119], v[20:35]
v_mfma_f32_32x32x16_bf16 v[36:51], a[44:47], v[116:119], v[36:51]
buffer_load_dwordx4 v[148:151], v6, s[84:87], s51 offen offset:1024 sc1
s_waitcnt vmcnt(7)
v_mfma_f32_32x32x16_bf16 v[20:35], a[48:51], v[120:123], v[20:35]
v_mfma_f32_32x32x16_bf16 v[36:51], a[52:55], v[120:123], v[36:51]
buffer_load_dwordx4 v[152:155], v6, s[84:87], s51 offen offset:2048 sc1
s_waitcnt vmcnt(7)
v_mfma_f32_32x32x16_bf16 v[20:35], a[56:59], v[124:127], v[20:35]
v_mfma_f32_32x32x16_bf16 v[36:51], a[60:63], v[124:127], v[36:51]
buffer_load_dwordx4 v[156:159], v6, s[84:87], s51 offen offset:3072 sc1
s_waitcnt vmcnt(7)
v_mfma_f32_32x32x16_bf16 v[20:35], a[64:67], v[128:131], v[20:35]
v_mfma_f32_32x32x16_bf16 v[36:51], a[68:71], v[128:131], v[36:51]
s_add_u32 s51, s56, 16384
s_and_b32 s51, s51, 0x7fff
s_and_b32 s63, s51, 0x6000
s_add_u32 s51, s51, s63
s_add_u32 s51, s51, s50
buffer_load_dwordx4 v[160:163], v6, s[84:87], s51 offen offset:0 sc1
s_waitcnt vmcnt(7)
v_mfma_f32_32x32x16_bf16 v[20:35], a[72:75], v[132:135], v[20:35]
v_mfma_f32_32x32x16_bf16 v[36:51], a[76:79], v[132:135], v[36:51]
buffer_load_dwordx4 v[164:167], v6, s[84:87], s51 offen offset:1024 sc1
s_waitcnt vmcnt(7)
v_mfma_f32_32x32x16_bf16 v[20:35], a[80:83], v[136:139], v[20:35]
v_mfma_f32_32x32x16_bf16 v[36:51], a[84:87], v[136:139], v[36:51]
buffer_load_dwordx4 v[168:171], v6, s[84:87], s51 offen offset:2048 sc1
s_waitcnt vmcnt(7)
v_mfma_f32_32x32x16_bf16 v[20:35], a[88:91], v[140:143], v[20:35]
v_mfma_f32_32x32x16_bf16 v[36:51], a[92:95], v[140:143], v[36:51]
buffer_load_dwordx4 v[172:175], v6, s[84:87], s51 offen offset:3072 sc1
s_waitcnt vmcnt(7)
v_mfma_f32_32x32x16_bf16 v[20:35], a[96:99], v[144:147], v[20:35]
v_mfma_f32_32x32x16_bf16 v[36:51], a[100:103], v[144:147], v[36:51]
s_add_u32 s51, s56, 20480
s_and_b32 s51, s51, 0x7fff
s_and_b32 s63, s51, 0x6000
s_add_u32 s51, s51, s63
s_add_u32 s51, s51, s50
buffer_load_dwordx4 v[176:179], v6, s[84:87], s51 offen offset:0 sc1
s_waitcnt vmcnt(7)
v_mfma_f32_32x32x16_bf16 v[20:35], a[104:107], v[148:151], v[20:35]
v_mfma_f32_32x32x16_bf16 v[36:51], a[108:111], v[148:151], v[36:51]
buffer_load_dwordx4 v[180:183], v6, s[84:87], s51 offen offset:1024 sc1
s_waitcnt vmcnt(7)
v_mfma_f32_32x32x16_bf16 v[20:35], a[112:115], v[152:155], v[20:35]
v_mfma_f32_32x32x16_bf16 v[36:51], a[116:119], v[152:155], v[36:51]
buffer_load_dwordx4 v[184:187], v6, s[84:87], s51 offen offset:2048 sc1
s_waitcnt vmcnt(7)
v_mfma_f32_32x32x16_bf16 v[20:35], a[120:123], v[156:159], v[20:35]
v_mfma_f32_32x32x16_bf16 v[36:51], a[124:127], v[156:159], v[36:51]
buffer_load_dwordx4 v[188:191], v6, s[84:87], s51 offen offset:3072 sc1
s_waitcnt vmcnt(7)
v_mfma_f32_32x32x16_bf16 v[20:35], a[128:131], v[160:163], v[20:35]
v_mfma_f32_32x32x16_bf16 v[36:51], a[132:135], v[160:163], v[36:51]
s_add_u32 s51, s56, 24576
s_and_b32 s51, s51, 0x7fff
s_and_b32 s63, s51, 0x6000
s_add_u32 s51, s51, s63
s_add_u32 s51, s51, s50
buffer_load_dwordx4 v[192:195], v6, s[84:87], s51 offen offset:0 sc1
s_waitcnt vmcnt(7)
v_mfma_f32_32x32x16_bf16 v[20:35], a[136:139], v[164:167], v[20:35]
v_mfma_f32_32x32x16_bf16 v[36:51], a[140:143], v[164:167], v[36:51]
buffer_load_dwordx4 v[196:199], v6, s[84:87], s51 offen offset:1024 sc1
s_waitcnt vmcnt(7)
v_mfma_f32_32x32x16_bf16 v[20:35], a[144:147], v[168:171], v[20:35]
v_mfma_f32_32x32x16_bf16 v[36:51], a[148:151], v[168:171], v[36:51]
buffer_load_dwordx4 v[200:203], v6, s[84:87], s51 offen offset:2048 sc1
s_waitcnt vmcnt(7)
v_mfma_f32_32x32x16_bf16 v[20:35], a[152:155], v[172:175], v[20:35]
v_mfma_f32_32x32x16_bf16 v[36:51], a[156:159], v[172:175], v[36:51]
buffer_load_dwordx4 v[204:207], v6, s[84:87], s51 offen offset:3072 sc1
s_waitcnt vmcnt(7)
v_mfma_f32_32x32x16_bf16 v[20:35], a[160:163], v[176:179], v[20:35]
v_mfma_f32_32x32x16_bf16 v[36:51], a[164:167], v[176:179], v[36:51]
s_add_u32 s51, s56, 28672
s_and_b32 s51, s51, 0x7fff
s_and_b32 s63, s51, 0x6000
s_add_u32 s51, s51, s63
s_add_u32 s51, s51, s50
buffer_load_dwordx4 v[208:211], v6, s[84:87], s51 offen offset:0 sc1
s_waitcnt vmcnt(7)
v_mfma_f32_32x32x16_bf16 v[20:35], a[168:171], v[180:183], v[20:35]
v_mfma_f32_32x32x16_bf16 v[36:51], a[172:175], v[180:183], v[36:51]
buffer_load_dwordx4 v[212:215], v6, s[84:87], s51 offen offset:1024 sc1
s_waitcnt vmcnt(7)
v_mfma_f32_32x32x16_bf16 v[20:35], a[176:179], v[184:187], v[20:35]
v_mfma_f32_32x32x16_bf16 v[36:51], a[180:183], v[184:187], v[36:51]
buffer_load_dwordx4 v[216:219], v6, s[84:87], s51 offen offset:2048 sc1
s_waitcnt vmcnt(7)
v_mfma_f32_32x32x16_bf16 v[20:35], a[184:187], v[188:191], v[20:35]
v_mfma_f32_32x32x16_bf16 v[36:51], a[188:191], v[188:191], v[36:51]
buffer_load_dwordx4 v[220:223], v6, s[84:87], s51 offen offset:3072 sc1
s_waitcnt vmcnt(7)
v_mfma_f32_32x32x16_bf16 v[20:35], a[192:195], v[192:195], v[20:35]
v_mfma_f32_32x32x16_bf16 v[36:51], a[196:199], v[192:195], v[36:51]
buffer_load_dword v15, v7, s[84:87], 0 offen sc1
s_waitcnt vmcnt(6)
v_mfma_f32_32x32x16_bf16 v[20:35], a[200:203], v[196:199], v[20:35]
v_mfma_f32_32x32x16_bf16 v[36:51], a[204:207], v[196:199], v[36:51]
s_waitcnt vmcnt(5)
v_mfma_f32_32x32x16_bf16 v[20:35], a[208:211], v[200:203], v[20:35]
v_mfma_f32_32x32x16_bf16 v[36:51], a[212:215], v[200:203], v[36:51]
s_waitcnt vmcnt(4)
v_mfma_f32_32x32x16_bf16 v[20:35], a[216:219], v[204:207], v[20:35]
v_mfma_f32_32x32x16_bf16 v[36:51], a[220:223], v[204:207], v[36:51]
s_waitcnt vmcnt(3)
v_mfma_f32_32x32x16_bf16 v[20:35], a[224:227], v[208:211], v[20:35]
v_mfma_f32_32x32x16_bf16 v[36:51], a[228:231], v[208:211], v[36:51]
s_waitcnt vmcnt(2)
v_mfma_f32_32x32x16_bf16 v[20:35], a[232:235], v[212:215], v[20:35]
v_mfma_f32_32x32x16_bf16 v[36:51], a[236:239], v[212:215], v[36:51]
s_waitcnt vmcnt(1)
v_mfma_f32_32x32x16_bf16 v[20:35], a[240:243], v[216:219], v[20:35]
v_mfma_f32_32x32x16_bf16 v[36:51], a[244:247], v[216:219], v[36:51]
s_waitcnt vmcnt(0)
v_mfma_f32_32x32x16_bf16 v[224:239], a[248:251], v[220:223], v[20:35]
v_mfma_f32_32x32x16_bf16 v[240:255], a[252:255], v[220:223], v[36:51]
s_lshr_b32 s63, s54, 2
s_xnor_b32 s63, s63, s98
s_and_b32 s63, s63, 1
s_lshl_b32 s63, s63, 13
s_lshl_b32 s50, s54, 19
s_add_u32 s50, s50, s63
s_branch mega_kernel_o_imm
mega_kernel_o_c1:
s_add_u32 s54, s42, s71
s_sub_u32 s62, s42, s71
s_lshr_b32 s63, s42, 2
s_xnor_b32 s63, s63, s98
s_and_b32 s63, s63, 1
s_lshl_b32 s63, s63, 13
s_lshl_b32 s50, s42, 19
s_add_u32 s50, s50, s63
s_add_u32 s51, s56, 0
s_and_b32 s51, s51, 0x7fff
s_and_b32 s63, s51, 0x6000
s_add_u32 s51, s51, s63
s_add_u32 s51, s51, s50
buffer_load_dwordx4 v[96:99], v6, s[84:87], s51 offen offset:0 sc1
buffer_load_dwordx4 v[100:103], v6, s[84:87], s51 offen offset:1024 sc1
buffer_load_dwordx4 v[104:107], v6, s[84:87], s51 offen offset:2048 sc1
buffer_load_dwordx4 v[108:111], v6, s[84:87], s51 offen offset:3072 sc1
s_add_u32 s51, s56, 4096
s_and_b32 s51, s51, 0x7fff
s_and_b32 s63, s51, 0x6000
s_add_u32 s51, s51, s63
s_add_u32 s51, s51, s50
buffer_load_dwordx4 v[112:115], v6, s[84:87], s51 offen offset:0 sc1
buffer_load_dwordx4 v[116:119], v6, s[84:87], s51 offen offset:1024 sc1
buffer_load_dwordx4 v[120:123], v6, s[84:87], s51 offen offset:2048 sc1
buffer_load_dwordx4 v[124:127], v6, s[84:87], s51 offen offset:3072 sc1
v_add_u32 v2, s53, v8
v_add_u32 v3, s53, v9
v_add_u32 v4, s53, v10
ds_write_b128 v2, v[224:227] offset:0
ds_write_b128 v2, v[228:231] offset:1088
ds_write_b128 v2, v[232:235] offset:2176
ds_write_b128 v2, v[236:239] offset:3264
ds_write_b128 v2, v[240:243] offset:4352
ds_write_b128 v2, v[244:247] offset:5440
ds_write_b128 v2, v[248:251] offset:6528
ds_write_b128 v2, v[252:255] offset:7616
s_waitcnt lgkmcnt(0)
s_barrier
ds_read_b128 v[52:55], v4 offset:0
ds_read_b128 v[56:59], v4 offset:8704
ds_read_b128 v[60:63], v4 offset:17408
ds_read_b128 v[64:67], v4 offset:26112
ds_read_b128 v[68:71], v3 offset:0
ds_read_b128 v[72:75], v3 offset:8704
ds_read_b128 v[76:79], v3 offset:17408
ds_read_b128 v[80:83], v3 offset:26112
s_sub_u32 s53, 34816, s53
s_sub_u32 s60, s62, s64
s_lshr_b32 s60, s60, s67
s_bfe_u32 s61, s60, 0x10001
s_and_b32 s60, s60, 1
s_lshl_b32 s60, s60, 12
s_waitcnt lgkmcnt(4)
v_add_f32 v52, v52, v56
v_add_f32 v60, v60, v64
v_add_f32 v53, v53, v57
v_add_f32 v61, v61, v65
v_add_f32 v54, v54, v58
v_add_f32 v62, v62, v66
v_add_f32 v55, v55, v59
v_add_f32 v63, v63, v67
v_add_f32 v52, v52, v60
v_add_f32 v53, v53, v61
v_add_f32 v54, v54, v62
v_add_f32 v55, v55, v63
v_and_or_b32 v52, v52, -2, s61
s_cmp_eq_u32 s95, 0
s_cbranch_scc1 mega_kernel_o_sa3
buffer_store_dwordx4 v[52:55], v12, s[84:87], s60 offen sc1
s_branch mega_kernel_o_sb3
mega_kernel_o_sa3:
buffer_store_dwordx4 v[52:55], v12, s[84:87], s60 offen
mega_kernel_o_sb3:
s_waitcnt lgkmcnt(0)
v_add_f32 v68, v68, v72
v_add_f32 v76, v76, v80
v_add_f32 v69, v69, v73
v_add_f32 v77, v77, v81
v_add_f32 v70, v70, v74
v_add_f32 v78, v78, v82
v_add_f32 v71, v71, v75
v_add_f32 v79, v79, v83
v_add_f32 v84, v68, v76
v_add_f32 v85, v69, v77
v_add_f32 v86, v70, v78
v_add_f32 v87, v71, v79
s_waitcnt vmcnt(7)
v_mfma_f32_32x32x16_bf16 v[20:35], a[0:3], v[96:99], 0
v_mfma_f32_32x32x16_bf16 v[36:51], a[4:7], v[96:99], 0
s_add_u32 s51, s56, 8192
s_and_b32 s51, s51, 0x7fff
s_and_b32 s63, s51, 0x6000
s_add_u32 s51, s51, s63
s_add_u32 s51, s51, s50
buffer_load_dwordx4 v[128:131], v6, s[84:87], s51 offen offset:0 sc1
s_waitcnt vmcnt(7)
v_mfma_f32_32x32x16_bf16 v[20:35], a[8:11], v[100:103], v[20:35]
v_mfma_f32_32x32x16_bf16 v[36:51], a[12:15], v[100:103], v[36:51]
buffer_load_dwordx4 v[132:135], v6, s[84:87], s51 offen offset:1024 sc1
s_waitcnt vmcnt(7)
v_mfma_f32_32x32x16_bf16 v[20:35], a[16:19], v[104:107], v[20:35]
v_mfma_f32_32x32x16_bf16 v[36:51], a[20:23], v[104:107], v[36:51]
buffer_load_dwordx4 v[136:139], v6, s[84:87], s51 offen offset:2048 sc1
s_waitcnt vmcnt(7)
v_mfma_f32_32x32x16_bf16 v[20:35], a[24:27], v[108:111], v[20:35]
v_mfma_f32_32x32x16_bf16 v[36:51], a[28:31], v[108:111], v[36:51]
buffer_load_dwordx4 v[140:143], v6, s[84:87], s51 offen offset:3072 sc1
s_waitcnt vmcnt(7)
v_mfma_f32_32x32x16_bf16 v[20:35], a[32:35], v[112:115], v[20:35]
v_mfma_f32_32x32x16_bf16 v[36:51], a[36:39], v[112:115], v[36:51]
s_add_u32 s51, s56, 12288
s_and_b32 s51, s51, 0x7fff
s_and_b32 s63, s51, 0x6000
s_add_u32 s51, s51, s63
s_add_u32 s51, s51, s50
buffer_load_dwordx4 v[144:147], v6, s[84:87], s51 offen offset:0 sc1
s_waitcnt vmcnt(7)
v_mfma_f32_32x32x16_bf16 v[20:35], a[40:43], v[116:119], v[20:35]
v_mfma_f32_32x32x16_bf16 v[36:51], a[44:47], v[116:119], v[36:51]
buffer_load_dwordx4 v[148:151], v6, s[84:87], s51 offen offset:1024 sc1
s_waitcnt vmcnt(7)
v_mfma_f32_32x32x16_bf16 v[20:35], a[48:51], v[120:123], v[20:35]
v_mfma_f32_32x32x16_bf16 v[36:51], a[52:55], v[120:123], v[36:51]
buffer_load_dwordx4 v[152:155], v6, s[84:87], s51 offen offset:2048 sc1
s_waitcnt vmcnt(7)
v_mfma_f32_32x32x16_bf16 v[20:35], a[56:59], v[124:127], v[20:35]
v_mfma_f32_32x32x16_bf16 v[36:51], a[60:63], v[124:127], v[36:51]
buffer_load_dwordx4 v[156:159], v6, s[84:87], s51 offen offset:3072 sc1
s_waitcnt vmcnt(7)
v_mfma_f32_32x32x16_bf16 v[20:35], a[64:67], v[128:131], v[20:35]
v_mfma_f32_32x32x16_bf16 v[36:51], a[68:71], v[128:131], v[36:51]
s_add_u32 s51, s56, 16384
s_and_b32 s51, s51, 0x7fff
s_and_b32 s63, s51, 0x6000
s_add_u32 s51, s51, s63
s_add_u32 s51, s51, s50
buffer_load_dwordx4 v[160:163], v6, s[84:87], s51 offen offset:0 sc1
s_waitcnt vmcnt(7)
v_mfma_f32_32x32x16_bf16 v[20:35], a[72:75], v[132:135], v[20:35]
v_mfma_f32_32x32x16_bf16 v[36:51], a[76:79], v[132:135], v[36:51]
buffer_load_dwordx4 v[164:167], v6, s[84:87], s51 offen offset:1024 sc1
s_waitcnt vmcnt(7)
v_mfma_f32_32x32x16_bf16 v[20:35], a[80:83], v[136:139], v[20:35]
v_mfma_f32_32x32x16_bf16 v[36:51], a[84:87], v[136:139], v[36:51]
buffer_load_dwordx4 v[168:171], v6, s[84:87], s51 offen offset:2048 sc1
s_waitcnt vmcnt(7)
v_mfma_f32_32x32x16_bf16 v[20:35], a[88:91], v[140:143], v[20:35]
v_mfma_f32_32x32x16_bf16 v[36:51], a[92:95], v[140:143], v[36:51]
buffer_load_dwordx4 v[172:175], v6, s[84:87], s51 offen offset:3072 sc1
s_waitcnt vmcnt(7)
v_mfma_f32_32x32x16_bf16 v[20:35], a[96:99], v[144:147], v[20:35]
v_mfma_f32_32x32x16_bf16 v[36:51], a[100:103], v[144:147], v[36:51]
s_add_u32 s51, s56, 20480
s_and_b32 s51, s51, 0x7fff
s_and_b32 s63, s51, 0x6000
s_add_u32 s51, s51, s63
s_add_u32 s51, s51, s50
buffer_load_dwordx4 v[176:179], v6, s[84:87], s51 offen offset:0 sc1
s_waitcnt vmcnt(7)
v_mfma_f32_32x32x16_bf16 v[20:35], a[104:107], v[148:151], v[20:35]
v_mfma_f32_32x32x16_bf16 v[36:51], a[108:111], v[148:151], v[36:51]
buffer_load_dwordx4 v[180:183], v6, s[84:87], s51 offen offset:1024 sc1
s_waitcnt vmcnt(7)
v_mfma_f32_32x32x16_bf16 v[20:35], a[112:115], v[152:155], v[20:35]
v_mfma_f32_32x32x16_bf16 v[36:51], a[116:119], v[152:155], v[36:51]
buffer_load_dwordx4 v[184:187], v6, s[84:87], s51 offen offset:2048 sc1
s_waitcnt vmcnt(7)
v_mfma_f32_32x32x16_bf16 v[20:35], a[120:123], v[156:159], v[20:35]
v_mfma_f32_32x32x16_bf16 v[36:51], a[124:127], v[156:159], v[36:51]
buffer_load_dwordx4 v[188:191], v6, s[84:87], s51 offen offset:3072 sc1
s_waitcnt vmcnt(7)
v_mfma_f32_32x32x16_bf16 v[20:35], a[128:131], v[160:163], v[20:35]
v_mfma_f32_32x32x16_bf16 v[36:51], a[132:135], v[160:163], v[36:51]
s_add_u32 s51, s56, 24576
s_and_b32 s51, s51, 0x7fff
s_and_b32 s63, s51, 0x6000
s_add_u32 s51, s51, s63
s_add_u32 s51, s51, s50
buffer_load_dwordx4 v[192:195], v6, s[84:87], s51 offen offset:0 sc1
s_waitcnt vmcnt(7)
v_mfma_f32_32x32x16_bf16 v[20:35], a[136:139], v[164:167], v[20:35]
v_mfma_f32_32x32x16_bf16 v[36:51], a[140:143], v[164:167], v[36:51]
buffer_load_dwordx4 v[196:199], v6, s[84:87], s51 offen offset:1024 sc1
s_waitcnt vmcnt(7)
v_mfma_f32_32x32x16_bf16 v[20:35], a[144:147], v[168:171], v[20:35]
v_mfma_f32_32x32x16_bf16 v[36:51], a[148:151], v[168:171], v[36:51]
buffer_load_dwordx4 v[200:203], v6, s[84:87], s51 offen offset:2048 sc1
s_waitcnt vmcnt(7)
v_mfma_f32_32x32x16_bf16 v[20:35], a[152:155], v[172:175], v[20:35]
v_mfma_f32_32x32x16_bf16 v[36:51], a[156:159], v[172:175], v[36:51]
buffer_load_dwordx4 v[204:207], v6, s[84:87], s51 offen offset:3072 sc1
s_waitcnt vmcnt(7)
v_mfma_f32_32x32x16_bf16 v[20:35], a[160:163], v[176:179], v[20:35]
v_mfma_f32_32x32x16_bf16 v[36:51], a[164:167], v[176:179], v[36:51]
s_add_u32 s51, s56, 28672
s_and_b32 s51, s51, 0x7fff
s_and_b32 s63, s51, 0x6000
s_add_u32 s51, s51, s63
s_add_u32 s51, s51, s50
buffer_load_dwordx4 v[208:211], v6, s[84:87], s51 offen offset:0 sc1
s_waitcnt vmcnt(7)
v_mfma_f32_32x32x16_bf16 v[20:35], a[168:171], v[180:183], v[20:35]
v_mfma_f32_32x32x16_bf16 v[36:51], a[172:175], v[180:183], v[36:51]
buffer_load_dwordx4 v[212:215], v6, s[84:87], s51 offen offset:1024 sc1
s_waitcnt vmcnt(7)
v_mfma_f32_32x32x16_bf16 v[20:35], a[176:179], v[184:187], v[20:35]
v_mfma_f32_32x32x16_bf16 v[36:51], a[180:183], v[184:187], v[36:51]
buffer_load_dwordx4 v[216:219], v6, s[84:87], s51 offen offset:2048 sc1
s_waitcnt vmcnt(7)
v_mfma_f32_32x32x16_bf16 v[20:35], a[184:187], v[188:191], v[20:35]
v_mfma_f32_32x32x16_bf16 v[36:51], a[188:191], v[188:191], v[36:51]
buffer_load_dwordx4 v[220:223], v6, s[84:87], s51 offen offset:3072 sc1
s_waitcnt vmcnt(7)
v_mfma_f32_32x32x16_bf16 v[20:35], a[192:195], v[192:195], v[20:35]
v_mfma_f32_32x32x16_bf16 v[36:51], a[196:199], v[192:195], v[36:51]
s_sub_u32 s60, s62, s64
s_lshr_b32 s60, s60, s67
s_bfe_u32 s61, s60, 0x10001
s_and_b32 s60, s60, 1
s_lshl_b32 s60, s60, 12
buffer_load_dwordx4 v[88:91], v13, s[84:87], s60 offen sc1
buffer_load_dword v15, v7, s[84:87], 0 offen sc1
s_waitcnt vmcnt(6)
v_mfma_f32_32x32x16_bf16 v[20:35], a[200:203], v[196:199], v[20:35]
v_mfma_f32_32x32x16_bf16 v[36:51], a[204:207], v[196:199], v[36:51]
s_waitcnt vmcnt(5)
v_mfma_f32_32x32x16_bf16 v[20:35], a[208:211], v[200:203], v[20:35]
v_mfma_f32_32x32x16_bf16 v[36:51], a[212:215], v[200:203], v[36:51]
s_waitcnt vmcnt(4)
v_mfma_f32_32x32x16_bf16 v[20:35], a[216:219], v[204:207], v[20:35]
v_mfma_f32_32x32x16_bf16 v[36:51], a[220:223], v[204:207], v[36:51]
s_waitcnt vmcnt(3)
v_mfma_f32_32x32x16_bf16 v[20:35], a[224:227], v[208:211], v[20:35]
v_mfma_f32_32x32x16_bf16 v[36:51], a[228:231], v[208:211], v[36:51]
s_waitcnt vmcnt(2)
v_mfma_f32_32x32x16_bf16 v[20:35], a[232:235], v[212:215], v[20:35]
v_mfma_f32_32x32x16_bf16 v[36:51], a[236:239], v[212:215], v[36:51]
s_waitcnt vmcnt(1)
v_mfma_f32_32x32x16_bf16 v[20:35], a[240:243], v[216:219], v[20:35]
v_mfma_f32_32x32x16_bf16 v[36:51], a[244:247], v[216:219], v[36:51]
s_waitcnt vmcnt(0)
v_mfma_f32_32x32x16_bf16 v[224:239], a[248:251], v[220:223], v[20:35]
v_mfma_f32_32x32x16_bf16 v[240:255], a[252:255], v[220:223], v[36:51]
s_waitcnt vmcnt(0)
mega_kernel_o_fcc:
v_and_b32 v14, 1, v88
v_cmp_ne_u32 vcc, s61, v14
s_cbranch_vccz mega_kernel_o_fck
s_sub_u32 s60, s62, s64
s_lshr_b32 s60, s60, s67
s_bfe_u32 s61, s60, 0x10001
s_and_b32 s60, s60, 1
s_lshl_b32 s60, s60, 12
buffer_load_dwordx4 v[88:91], v13, s[84:87], s60 offen sc1
s_waitcnt vmcnt(0)
s_branch mega_kernel_o_fcc
mega_kernel_o_fck:
v_pk_add_f32 v[88:89], v[88:89], v[84:85]
v_pk_add_f32 v[90:91], v[90:91], v[86:87]
s_lshl_b32 s60, s62, 17
v_cvt_pk_bf16_f32 v92, v88, v89
v_cvt_pk_bf16_f32 v93, v90, v91
buffer_store_dwordx2 v[92:93], v11, s[8:11], s60 offen sc1
s_lshr_b32 s63, s54, 2
s_xnor_b32 s63, s63, s98
s_and_b32 s63, s63, 1
s_lshl_b32 s63, s63, 13
s_lshl_b32 s50, s54, 19
s_add_u32 s50, s50, s63
s_branch mega_kernel_o_imm
mega_kernel_o_im2:
v_add_u32 v2, s53, v8
v_add_u32 v3, s53, v9
v_add_u32 v4, s53, v10
ds_write_b128 v2, v[224:227] offset:0
ds_write_b128 v2, v[228:231] offset:1088
ds_write_b128 v2, v[232:235] offset:2176
ds_write_b128 v2, v[236:239] offset:3264
ds_write_b128 v2, v[240:243] offset:4352
ds_write_b128 v2, v[244:247] offset:5440
ds_write_b128 v2, v[248:251] offset:6528
ds_write_b128 v2, v[252:255] offset:7616
s_waitcnt lgkmcnt(0)
s_barrier
ds_read_b128 v[52:55], v4 offset:0
ds_read_b128 v[56:59], v4 offset:8704
ds_read_b128 v[60:63], v4 offset:17408
ds_read_b128 v[64:67], v4 offset:26112
ds_read_b128 v[68:71], v3 offset:0
ds_read_b128 v[72:75], v3 offset:8704
ds_read_b128 v[76:79], v3 offset:17408
ds_read_b128 v[80:83], v3 offset:26112
s_sub_u32 s53, 34816, s53
s_sub_u32 s60, s42, s64
s_lshr_b32 s60, s60, s67
s_bfe_u32 s61, s60, 0x10001
s_and_b32 s60, s60, 1
s_lshl_b32 s60, s60, 12
s_waitcnt lgkmcnt(4)
v_add_f32 v52, v52, v56
v_add_f32 v60, v60, v64
v_add_f32 v53, v53, v57
v_add_f32 v61, v61, v65
v_add_f32 v54, v54, v58
v_add_f32 v62, v62, v66
v_add_f32 v55, v55, v59
v_add_f32 v63, v63, v67
v_add_f32 v52, v52, v60
v_add_f32 v53, v53, v61
v_add_f32 v54, v54, v62
v_add_f32 v55, v55, v63
v_and_or_b32 v52, v52, -2, s61
s_cmp_eq_u32 s95, 0
s_cbranch_scc1 mega_kernel_o_sa4
buffer_store_dwordx4 v[52:55], v12, s[84:87], s60 offen sc1
s_branch mega_kernel_o_sb4
mega_kernel_o_sa4:
buffer_store_dwordx4 v[52:55], v12, s[84:87], s60 offen
mega_kernel_o_sb4:
s_waitcnt lgkmcnt(0)
v_add_f32 v68, v68, v72
v_add_f32 v76, v76, v80
v_add_f32 v69, v69, v73
v_add_f32 v77, v77, v81
v_add_f32 v70, v70, v74
v_add_f32 v78, v78, v82
v_add_f32 v71, v71, v75
v_add_f32 v79, v79, v83
v_add_f32 v84, v68, v76
v_add_f32 v85, v69, v77
v_add_f32 v86, v70, v78
v_add_f32 v87, v71, v79
s_sub_u32 s60, s42, s64
s_lshr_b32 s60, s60, s67
s_bfe_u32 s61, s60, 0x10001
s_and_b32 s60, s60, 1
s_lshl_b32 s60, s60, 12
buffer_load_dwordx4 v[88:91], v13, s[84:87], s60 offen sc1
s_waitcnt vmcnt(0)
mega_kernel_o_f2c:
v_and_b32 v14, 1, v88
v_cmp_ne_u32 vcc, s61, v14
s_cbranch_vccz mega_kernel_o_f2k
s_sub_u32 s60, s42, s64
s_lshr_b32 s60, s60, s67
s_bfe_u32 s61, s60, 0x10001
s_and_b32 s60, s60, 1
s_lshl_b32 s60, s60, 12
buffer_load_dwordx4 v[88:91], v13, s[84:87], s60 offen sc1
s_waitcnt vmcnt(0)
s_branch mega_kernel_o_f2c
mega_kernel_o_f2k:
v_pk_add_f32 v[88:89], v[88:89], v[84:85]
v_pk_add_f32 v[90:91], v[90:91], v[86:87]
s_lshl_b32 s60, s42, 17
v_cvt_pk_bf16_f32 v92, v88, v89
v_cvt_pk_bf16_f32 v93, v90, v91
buffer_store_dwordx2 v[92:93], v11, s[8:11], s60 offen sc1
s_add_u32 s42, s42, s71
s_cmp_lt_u32 s42, s65
s_cbranch_scc1 mega_kernel_o_cold
mega_kernel_o_quit:
s_endpgm
mega_kernel_exit:
s_endpgm
mega_kernel_recf:
s_load_dwordx2 s[20:21], s[0:1], 8
s_load_dwordx2 s[16:17], s[0:1], 40
s_load_dwordx2 s[4:5], s[0:1], 16
s_load_dwordx2 s[8:9], s[0:1], 24
s_load_dwordx2 s[12:13], s[0:1], 32
v_lshrrev_b32 v4, 6, v0
v_and_b32 v1, 63, v0
v_readfirstlane_b32 s24, v4
v_lshrrev_b32 v2, 4, v1
v_and_b32 v3, 15, v1
v_lshlrev_b32 v17, 4, v1
s_lshr_b32 s28, s31, 2
s_lshl_b32 s25, s30, 3
s_add_u32 s25, s25, s28
s_and_b32 s26, s31, 3
s_waitcnt lgkmcnt(0)
s_mov_b32 s22, 16384
s_mov_b32 s23, 0x00020000
s_mov_b32 s18, 8388608
s_mov_b32 s19, 0x00020000
s_mov_b32 s6, 8388608
s_mov_b32 s7, 0x00020000
s_mov_b32 s10, 8388608
s_mov_b32 s11, 0x00020000
s_mov_b32 s14, 8388608
s_mov_b32 s15, 0x00020000
s_lshl_b32 s28, s25, 8
s_lshr_b32 s29, s26, 0
s_lshl_b32 s29, s29, 6
s_add_u32 s28, s28, s29
s_lshl_b32 s29, s24, 21
s_add_u32 s28, s28, s29
v_lshrrev_b32 v4, 2, v1
v_and_b32 v5, 3, v1
v_lshlrev_b32 v40, 13, v4
v_lshl_add_u32 v40, v5, 4, v40
v_add_u32 v40, s28, v40
s_lshl_b32 s28, s30, 21
s_lshl_b32 s29, s24, 19
s_add_u32 s28, s28, s29
s_lshr_b32 s29, s31, 0
s_lshl_b32 s29, s29, 6
s_add_u32 s28, s28, s29
v_lshlrev_b32 v41, 11, v4
v_lshl_add_u32 v41, v5, 4, v41
v_add_u32 v41, s28, v41
s_lshl_b32 s47, s24, 15
s_add_u32 s47, s47, 32768
s_lshl_b32 s28, s31, 18
s_lshl_b32 s29, s24, 16
s_add_u32 s28, s28, s29
s_lshl_b32 s29, s30, 11
s_add_u32 s28, s28, s29
v_lshlrev_b32 v48, 13, v2
v_lshl_add_u32 v48, v3, 7, v48
v_add_u32 v48, s28, v48
s_lshl_b32 s28, s30, 21
s_lshl_b32 s29, s31, 16
s_add_u32 s28, s28, s29
s_lshl_b32 s29, s24, 14
s_add_u32 s28, s28, s29
v_lshlrev_b32 v49, 7, v1
v_add_u32 v49, s28, v49
s_and_b32 s76, s31, 1
s_mul_i32 s76, s76, 8
s_and_b32 s28, s31, 15
s_lshl_b32 s28, s28, 4
s_lshl_b32 s29, s24, 8
s_add_u32 s28, s28, s29
v_add_u32 v53, s28, v3
s_lshr_b32 s28, s31, 4
s_lshl_b32 s28, s28, 10
s_add_u32 s28, s28, 384
v_mov_b32 v54, s28
v_mov_b32 v55, 1920
v_cmp_gt_u32 vcc, 32, v1
s_nop 1
v_cndmask_b32 v54, v55, v54, vcc
s_lshl_b32 s29, s30, 11
v_lshl_add_u32 v51, v53, 13, v54
v_add_u32 v51, s29, v51
s_lshl_b32 s29, s30, 21
v_lshl_add_u32 v52, v53, 11, v54
v_add_u32 v52, s29, v52
buffer_load_dword v50, v51, s[8:11], 0 offen
s_xor_b32 s29, s76, 0
s_lshl_b32 s28, s29, 10
s_add_u32 s28, s28, s47
s_add_u32 m0, s28, 0
s_lshl_b32 s29, s29, 17
buffer_load_dwordx4 v40, s[8:11], s29 offen lds
s_xor_b32 s29, s76, 1
s_lshl_b32 s28, s29, 10
s_add_u32 s28, s28, s47
s_add_u32 m0, s28, 0
s_lshl_b32 s29, s29, 17
buffer_load_dwordx4 v40, s[8:11], s29 offen lds
s_xor_b32 s29, s76, 2
s_lshl_b32 s28, s29, 10
s_add_u32 s28, s28, s47
s_add_u32 m0, s28, 0
s_lshl_b32 s29, s29, 17
buffer_load_dwordx4 v40, s[8:11], s29 offen lds
s_xor_b32 s29, s76, 3
s_lshl_b32 s28, s29, 10
s_add_u32 s28, s28, s47
s_add_u32 m0, s28, 0
s_lshl_b32 s29, s29, 17
buffer_load_dwordx4 v40, s[8:11], s29 offen lds
s_xor_b32 s29, s76, 4
s_lshl_b32 s28, s29, 10
s_add_u32 s28, s28, s47
s_add_u32 m0, s28, 0
s_lshl_b32 s29, s29, 17
buffer_load_dwordx4 v40, s[8:11], s29 offen lds
s_xor_b32 s29, s76, 5
s_lshl_b32 s28, s29, 10
s_add_u32 s28, s28, s47
s_add_u32 m0, s28, 0
s_lshl_b32 s29, s29, 17
buffer_load_dwordx4 v40, s[8:11], s29 offen lds
s_xor_b32 s29, s76, 6
s_lshl_b32 s28, s29, 10
s_add_u32 s28, s28, s47
s_add_u32 m0, s28, 0
s_lshl_b32 s29, s29, 17
buffer_load_dwordx4 v40, s[8:11], s29 offen lds
s_xor_b32 s29, s76, 7
s_lshl_b32 s28, s29, 10
s_add_u32 s28, s28, s47
s_add_u32 m0, s28, 0
s_lshl_b32 s29, s29, 17
buffer_load_dwordx4 v40, s[8:11], s29 offen lds
s_xor_b32 s29, s76, 8
s_lshl_b32 s28, s29, 10
s_add_u32 s28, s28, s47
s_add_u32 m0, s28, 0
s_lshl_b32 s29, s29, 17
buffer_load_dwordx4 v40, s[8:11], s29 offen lds
s_xor_b32 s29, s76, 9
s_lshl_b32 s28, s29, 10
s_add_u32 s28, s28, s47
s_add_u32 m0, s28, 0
s_lshl_b32 s29, s29, 17
buffer_load_dwordx4 v40, s[8:11], s29 offen lds
s_xor_b32 s29, s76, 10
s_lshl_b32 s28, s29, 10
s_add_u32 s28, s28, s47
s_add_u32 m0, s28, 0
s_lshl_b32 s29, s29, 17
buffer_load_dwordx4 v40, s[8:11], s29 offen lds
s_xor_b32 s29, s76, 11
s_lshl_b32 s28, s29, 10
s_add_u32 s28, s28, s47
s_add_u32 m0, s28, 0
s_lshl_b32 s29, s29, 17
buffer_load_dwordx4 v40, s[8:11], s29 offen lds
s_xor_b32 s29, s76, 12
s_lshl_b32 s28, s29, 10
s_add_u32 s28, s28, s47
s_add_u32 m0, s28, 0
s_lshl_b32 s29, s29, 17
buffer_load_dwordx4 v40, s[8:11], s29 offen lds
s_xor_b32 s29, s76, 13
s_lshl_b32 s28, s29, 10
s_add_u32 s28, s28, s47
s_add_u32 m0, s28, 0
s_lshl_b32 s29, s29, 17
buffer_load_dwordx4 v40, s[8:11], s29 offen lds
s_xor_b32 s29, s76, 14
s_lshl_b32 s28, s29, 10
s_add_u32 s28, s28, s47
s_add_u32 m0, s28, 0
s_lshl_b32 s29, s29, 17
buffer_load_dwordx4 v40, s[8:11], s29 offen lds
s_xor_b32 s29, s76, 15
s_lshl_b32 s28, s29, 10
s_add_u32 s28, s28, s47
s_add_u32 m0, s28, 0
s_lshl_b32 s29, s29, 17
buffer_load_dwordx4 v40, s[8:11], s29 offen lds
buffer_load_dword v50, v51, s[12:15], 0 offen
s_xor_b32 s29, s76, 0
s_lshl_b32 s28, s29, 10
s_add_u32 s28, s28, s47
s_add_u32 m0, s28, 16384
s_lshl_b32 s29, s29, 17
buffer_load_dwordx4 v40, s[12:15], s29 offen lds
s_xor_b32 s29, s76, 1
s_lshl_b32 s28, s29, 10
s_add_u32 s28, s28, s47
s_add_u32 m0, s28, 16384
s_lshl_b32 s29, s29, 17
buffer_load_dwordx4 v40, s[12:15], s29 offen lds
s_xor_b32 s29, s76, 2
s_lshl_b32 s28, s29, 10
s_add_u32 s28, s28, s47
s_add_u32 m0, s28, 16384
s_lshl_b32 s29, s29, 17
buffer_load_dwordx4 v40, s[12:15], s29 offen lds
s_xor_b32 s29, s76, 3
s_lshl_b32 s28, s29, 10
s_add_u32 s28, s28, s47
s_add_u32 m0, s28, 16384
s_lshl_b32 s29, s29, 17
buffer_load_dwordx4 v40, s[12:15], s29 offen lds
s_xor_b32 s29, s76, 4
s_lshl_b32 s28, s29, 10
s_add_u32 s28, s28, s47
s_add_u32 m0, s28, 16384
s_lshl_b32 s29, s29, 17
buffer_load_dwordx4 v40, s[12:15], s29 offen lds
s_xor_b32 s29, s76, 5
s_lshl_b32 s28, s29, 10
s_add_u32 s28, s28, s47
s_add_u32 m0, s28, 16384
s_lshl_b32 s29, s29, 17
buffer_load_dwordx4 v40, s[12:15], s29 offen lds
s_xor_b32 s29, s76, 6
s_lshl_b32 s28, s29, 10
s_add_u32 s28, s28, s47
s_add_u32 m0, s28, 16384
s_lshl_b32 s29, s29, 17
buffer_load_dwordx4 v40, s[12:15], s29 offen lds
s_xor_b32 s29, s76, 7
s_lshl_b32 s28, s29, 10
s_add_u32 s28, s28, s47
s_add_u32 m0, s28, 16384
s_lshl_b32 s29, s29, 17
buffer_load_dwordx4 v40, s[12:15], s29 offen lds
s_xor_b32 s29, s76, 8
s_lshl_b32 s28, s29, 10
s_add_u32 s28, s28, s47
s_add_u32 m0, s28, 16384
s_lshl_b32 s29, s29, 17
buffer_load_dwordx4 v40, s[12:15], s29 offen lds
s_xor_b32 s29, s76, 9
s_lshl_b32 s28, s29, 10
s_add_u32 s28, s28, s47
s_add_u32 m0, s28, 16384
s_lshl_b32 s29, s29, 17
buffer_load_dwordx4 v40, s[12:15], s29 offen lds
s_xor_b32 s29, s76, 10
s_lshl_b32 s28, s29, 10
s_add_u32 s28, s28, s47
s_add_u32 m0, s28, 16384
s_lshl_b32 s29, s29, 17
buffer_load_dwordx4 v40, s[12:15], s29 offen lds
s_xor_b32 s29, s76, 11
s_lshl_b32 s28, s29, 10
s_add_u32 s28, s28, s47
s_add_u32 m0, s28, 16384
s_lshl_b32 s29, s29, 17
buffer_load_dwordx4 v40, s[12:15], s29 offen lds
s_xor_b32 s29, s76, 12
s_lshl_b32 s28, s29, 10
s_add_u32 s28, s28, s47
s_add_u32 m0, s28, 16384
s_lshl_b32 s29, s29, 17
buffer_load_dwordx4 v40, s[12:15], s29 offen lds
s_xor_b32 s29, s76, 13
s_lshl_b32 s28, s29, 10
s_add_u32 s28, s28, s47
s_add_u32 m0, s28, 16384
s_lshl_b32 s29, s29, 17
buffer_load_dwordx4 v40, s[12:15], s29 offen lds
s_xor_b32 s29, s76, 14
s_lshl_b32 s28, s29, 10
s_add_u32 s28, s28, s47
s_add_u32 m0, s28, 16384
s_lshl_b32 s29, s29, 17
buffer_load_dwordx4 v40, s[12:15], s29 offen lds
s_xor_b32 s29, s76, 15
s_lshl_b32 s28, s29, 10
s_add_u32 s28, s28, s47
s_add_u32 m0, s28, 16384
s_lshl_b32 s29, s29, 17
buffer_load_dwordx4 v40, s[12:15], s29 offen lds
s_mov_b32 s40, 0x00ff00ff
s_mov_b32 s41, 0x00ff00ff
s_mov_b32 s48, 0xff00ff00
s_mov_b32 s49, 0xff00ff00
s_mov_b32 s42, 0
s_mov_b32 s43, 0x00ff00ff
s_mov_b32 s32, 0x3e0293ee
v_mov_b32 v23, 0xff800000
v_mov_b32 v6, 0x4444
v_mov_b32 v4, 0xeeee
v_cndmask_b32 v6, v6, v4, s[48:49]
v_mov_b32 v28, -1
v_mov_b32 v29, -1
v_mov_b32 v30, -1
v_mov_b32 v31, -1
s_mul_i32 s28, s24, 4096
v_add_u32 v7, s28, v17
v_and_b32 v4, 7, v1
v_lshlrev_b32 v8, 11, v4
v_lshrrev_b32 v5, 3, v1
v_lshl_add_u32 v8, v5, 4, v8
s_lshl_b32 s28, s24, 9
v_add_u32 v8, s28, v8
s_lshl_b32 s28, s31, 9
s_lshr_b32 s29, s31, 3
s_mul_i32 s29, s29, 0
s_add_u32 s28, s28, s29
v_lshlrev_b32 v9, 3, v1
v_add_u32 v9, s28, v9
v_and_b32 v4, 7, v3
v_lshlrev_b32 v11, 7, v2
v_lshl_add_u32 v11, v4, 4, v11
v_add_u32 v22, 0, v11
s_add_u32 s28, s28, 24576
v_add_u32 v11, s28, v11
v_and_b32 v5, 1, v2
v_lshlrev_b32 v10, 7, v5
v_lshl_add_u32 v10, v4, 4, v10
v_add_u32 v10, 1024, v10
s_xor_b32 s37, s31, 1
s_mul_i32 s37, s37, 1280
s_add_u32 s37, s37, 49152
s_xor_b32 s38, s31, 2
s_mul_i32 s38, s38, 1280
s_add_u32 s38, s38, 49152
s_xor_b32 s39, s31, 3
s_mul_i32 s39, s39, 1280
s_add_u32 s39, s39, 49152
v_and_b32 v4, 1, v2
v_mul_u32_u24 v14, 576, v4
v_lshrrev_b32 v5, 1, v2
v_lshl_add_u32 v5, v5, 4, v3
v_lshl_add_u32 v14, v5, 2, v14
s_mul_i32 s28, s24, 1152
s_add_u32 s28, s28, 13312
v_add_u32 v18, s28, v14
s_mul_i32 s28, s24, 2304
v_add_u32 v14, s28, v14
v_add_u32 v15, 1152, v14
v_mul_u32_u24 v16, 144, v3
v_lshl_add_u32 v16, v2, 5, v16
v_bfe_u32 v4, v1, 1, 3
v_mul_u32_u24 v19, 144, v4
v_lshl_add_u32 v19, v2, 5, v19
v_and_b32 v4, 1, v1
v_lshl_add_u32 v19, v4, 4, v19
v_add_u32 v19, 13312, v19
s_lshl_b32 s28, s24, 10
s_add_u32 s28, s28, 9216
v_add_u32 v20, s28, v17
v_and_b32 v4, 31, v1
v_lshlrev_b32 v21, 3, v4
v_add_u32 v21, 17920, v21
v_lshrrev_b32 v4, 2, v3
v_and_b32 v42, 1, v4
v_lshrrev_b32 v43, 1, v4
v_lshrrev_b32 v44, 1, v2
v_and_b32 v45, 1, v2
v_lshl_add_u32 v46, v44, 4, v42
v_lshl_add_u32 v46, v45, 2, v46
v_lshl_add_u32 v46, v43, 3, v46
v_lshl_add_u32 v47, v44, 3, v42
v_lshl_add_u32 v47, v45, 4, v47
v_lshl_add_u32 v47, v43, 2, v47
v_and_b32 v5, 3, v3
v_lshlrev_b32 v5, 3, v5
v_lshl_add_u32 v46, v46, 6, v5
v_lshl_add_u32 v47, v47, 6, v5
s_and_b32 s28, s31, 0
s_lshl_b32 s28, s28, 6
s_add_u32 s28, s28, s47
v_add_u32 v46, s28, v46
v_add_u32 v47, s28, v47
s_waitcnt vmcnt(17)
ds_read_b64_tr_b16 a[64:65], v46 offset:0
ds_read_b64_tr_b16 a[66:67], v46 offset:128
ds_read_b64_tr_b16 a[68:69], v46 offset:2048
ds_read_b64_tr_b16 a[70:71], v46 offset:2176
ds_read_b64_tr_b16 a[72:73], v46 offset:4096
ds_read_b64_tr_b16 a[74:75], v46 offset:4224
ds_read_b64_tr_b16 a[76:77], v46 offset:6144
ds_read_b64_tr_b16 a[78:79], v46 offset:6272
s_waitcnt lgkmcnt(0)
ds_read_b64_tr_b16 a[80:81], v46 offset:8192
ds_read_b64_tr_b16 a[82:83], v46 offset:8320
ds_read_b64_tr_b16 a[84:85], v46 offset:10240
ds_read_b64_tr_b16 a[86:87], v46 offset:10368
ds_read_b64_tr_b16 a[88:89], v46 offset:12288
ds_read_b64_tr_b16 a[90:91], v46 offset:12416
ds_read_b64_tr_b16 a[92:93], v46 offset:14336
ds_read_b64_tr_b16 a[94:95], v46 offset:14464
s_waitcnt lgkmcnt(0)
ds_read_b64_tr_b16 a[96:97], v46 offset:32
ds_read_b64_tr_b16 a[98:99], v46 offset:160
ds_read_b64_tr_b16 a[100:101], v46 offset:2080
ds_read_b64_tr_b16 a[102:103], v46 offset:2208
ds_read_b64_tr_b16 a[104:105], v46 offset:4128
ds_read_b64_tr_b16 a[106:107], v46 offset:4256
ds_read_b64_tr_b16 a[108:109], v46 offset:6176
ds_read_b64_tr_b16 a[110:111], v46 offset:6304
s_waitcnt lgkmcnt(0)
ds_read_b64_tr_b16 a[112:113], v46 offset:8224
ds_read_b64_tr_b16 a[114:115], v46 offset:8352
ds_read_b64_tr_b16 a[116:117], v46 offset:10272
ds_read_b64_tr_b16 a[118:119], v46 offset:10400
ds_read_b64_tr_b16 a[120:121], v46 offset:12320
ds_read_b64_tr_b16 a[122:123], v46 offset:12448
ds_read_b64_tr_b16 a[124:125], v46 offset:14368
ds_read_b64_tr_b16 a[126:127], v46 offset:14496
s_waitcnt lgkmcnt(0)
buffer_load_dword v50, v51, s[4:7], 0 offen
s_xor_b32 s29, s76, 0
s_lshl_b32 s28, s29, 10
s_add_u32 s28, s28, s47
s_add_u32 m0, s28, 0
s_lshl_b32 s29, s29, 17
buffer_load_dwordx4 v40, s[4:7], s29 offen lds
s_xor_b32 s29, s76, 1
s_lshl_b32 s28, s29, 10
s_add_u32 s28, s28, s47
s_add_u32 m0, s28, 0
s_lshl_b32 s29, s29, 17
buffer_load_dwordx4 v40, s[4:7], s29 offen lds
s_xor_b32 s29, s76, 2
s_lshl_b32 s28, s29, 10
s_add_u32 s28, s28, s47
s_add_u32 m0, s28, 0
s_lshl_b32 s29, s29, 17
buffer_load_dwordx4 v40, s[4:7], s29 offen lds
s_xor_b32 s29, s76, 3
s_lshl_b32 s28, s29, 10
s_add_u32 s28, s28, s47
s_add_u32 m0, s28, 0
s_lshl_b32 s29, s29, 17
buffer_load_dwordx4 v40, s[4:7], s29 offen lds
s_xor_b32 s29, s76, 4
s_lshl_b32 s28, s29, 10
s_add_u32 s28, s28, s47
s_add_u32 m0, s28, 0
s_lshl_b32 s29, s29, 17
buffer_load_dwordx4 v40, s[4:7], s29 offen lds
s_xor_b32 s29, s76, 5
s_lshl_b32 s28, s29, 10
s_add_u32 s28, s28, s47
s_add_u32 m0, s28, 0
s_lshl_b32 s29, s29, 17
buffer_load_dwordx4 v40, s[4:7], s29 offen lds
s_xor_b32 s29, s76, 6
s_lshl_b32 s28, s29, 10
s_add_u32 s28, s28, s47
s_add_u32 m0, s28, 0
s_lshl_b32 s29, s29, 17
buffer_load_dwordx4 v40, s[4:7], s29 offen lds
s_xor_b32 s29, s76, 7
s_lshl_b32 s28, s29, 10
s_add_u32 s28, s28, s47
s_add_u32 m0, s28, 0
s_lshl_b32 s29, s29, 17
buffer_load_dwordx4 v40, s[4:7], s29 offen lds
s_xor_b32 s29, s76, 8
s_lshl_b32 s28, s29, 10
s_add_u32 s28, s28, s47
s_add_u32 m0, s28, 0
s_lshl_b32 s29, s29, 17
buffer_load_dwordx4 v40, s[4:7], s29 offen lds
s_xor_b32 s29, s76, 9
s_lshl_b32 s28, s29, 10
s_add_u32 s28, s28, s47
s_add_u32 m0, s28, 0
s_lshl_b32 s29, s29, 17
buffer_load_dwordx4 v40, s[4:7], s29 offen lds
s_xor_b32 s29, s76, 10
s_lshl_b32 s28, s29, 10
s_add_u32 s28, s28, s47
s_add_u32 m0, s28, 0
s_lshl_b32 s29, s29, 17
buffer_load_dwordx4 v40, s[4:7], s29 offen lds
s_xor_b32 s29, s76, 11
s_lshl_b32 s28, s29, 10
s_add_u32 s28, s28, s47
s_add_u32 m0, s28, 0
s_lshl_b32 s29, s29, 17
buffer_load_dwordx4 v40, s[4:7], s29 offen lds
s_xor_b32 s29, s76, 12
s_lshl_b32 s28, s29, 10
s_add_u32 s28, s28, s47
s_add_u32 m0, s28, 0
s_lshl_b32 s29, s29, 17
buffer_load_dwordx4 v40, s[4:7], s29 offen lds
s_xor_b32 s29, s76, 13
s_lshl_b32 s28, s29, 10
s_add_u32 s28, s28, s47
s_add_u32 m0, s28, 0
s_lshl_b32 s29, s29, 17
buffer_load_dwordx4 v40, s[4:7], s29 offen lds
s_xor_b32 s29, s76, 14
s_lshl_b32 s28, s29, 10
s_add_u32 s28, s28, s47
s_add_u32 m0, s28, 0
s_lshl_b32 s29, s29, 17
buffer_load_dwordx4 v40, s[4:7], s29 offen lds
s_xor_b32 s29, s76, 15
s_lshl_b32 s28, s29, 10
s_add_u32 s28, s28, s47
s_add_u32 m0, s28, 0
s_lshl_b32 s29, s29, 17
buffer_load_dwordx4 v40, s[4:7], s29 offen lds
s_waitcnt vmcnt(17)
ds_read_b64_tr_b16 a[128:129], v46 offset:16384
ds_read_b64_tr_b16 a[130:131], v46 offset:16512
ds_read_b64_tr_b16 a[132:133], v46 offset:18432
ds_read_b64_tr_b16 a[134:135], v46 offset:18560
ds_read_b64_tr_b16 a[136:137], v46 offset:20480
ds_read_b64_tr_b16 a[138:139], v46 offset:20608
ds_read_b64_tr_b16 a[140:141], v46 offset:22528
ds_read_b64_tr_b16 a[142:143], v46 offset:22656
s_waitcnt lgkmcnt(0)
ds_read_b64_tr_b16 a[144:145], v46 offset:24576
ds_read_b64_tr_b16 a[146:147], v46 offset:24704
ds_read_b64_tr_b16 a[148:149], v46 offset:26624
ds_read_b64_tr_b16 a[150:151], v46 offset:26752
ds_read_b64_tr_b16 a[152:153], v46 offset:28672
ds_read_b64_tr_b16 a[154:155], v46 offset:28800
ds_read_b64_tr_b16 a[156:157], v46 offset:30720
ds_read_b64_tr_b16 a[158:159], v46 offset:30848
s_waitcnt lgkmcnt(0)
ds_read_b64_tr_b16 a[160:161], v46 offset:16416
ds_read_b64_tr_b16 a[162:163], v46 offset:16544
ds_read_b64_tr_b16 a[164:165], v46 offset:18464
ds_read_b64_tr_b16 a[166:167], v46 offset:18592
ds_read_b64_tr_b16 a[168:169], v46 offset:20512
ds_read_b64_tr_b16 a[170:171], v46 offset:20640
ds_read_b64_tr_b16 a[172:173], v46 offset:22560
ds_read_b64_tr_b16 a[174:175], v46 offset:22688
s_waitcnt lgkmcnt(0)
ds_read_b64_tr_b16 a[176:177], v46 offset:24608
ds_read_b64_tr_b16 a[178:179], v46 offset:24736
ds_read_b64_tr_b16 a[180:181], v46 offset:26656
ds_read_b64_tr_b16 a[182:183], v46 offset:26784
ds_read_b64_tr_b16 a[184:185], v46 offset:28704
ds_read_b64_tr_b16 a[186:187], v46 offset:28832
ds_read_b64_tr_b16 a[188:189], v46 offset:30752
ds_read_b64_tr_b16 a[190:191], v46 offset:30880
s_waitcnt lgkmcnt(0)
buffer_load_dword v50, v52, s[16:19], 0 offen
s_xor_b32 s29, s76, 0
s_lshl_b32 s28, s29, 10
s_add_u32 s28, s28, s47
s_add_u32 m0, s28, 16384
s_lshl_b32 s29, s29, 15
buffer_load_dwordx4 v41, s[16:19], s29 offen lds
s_xor_b32 s29, s76, 1
s_lshl_b32 s28, s29, 10
s_add_u32 s28, s28, s47
s_add_u32 m0, s28, 16384
s_lshl_b32 s29, s29, 15
buffer_load_dwordx4 v41, s[16:19], s29 offen lds
s_xor_b32 s29, s76, 2
s_lshl_b32 s28, s29, 10
s_add_u32 s28, s28, s47
s_add_u32 m0, s28, 16384
s_lshl_b32 s29, s29, 15
buffer_load_dwordx4 v41, s[16:19], s29 offen lds
s_xor_b32 s29, s76, 3
s_lshl_b32 s28, s29, 10
s_add_u32 s28, s28, s47
s_add_u32 m0, s28, 16384
s_lshl_b32 s29, s29, 15
buffer_load_dwordx4 v41, s[16:19], s29 offen lds
s_xor_b32 s29, s76, 4
s_lshl_b32 s28, s29, 10
s_add_u32 s28, s28, s47
s_add_u32 m0, s28, 16384
s_lshl_b32 s29, s29, 15
buffer_load_dwordx4 v41, s[16:19], s29 offen lds
s_xor_b32 s29, s76, 5
s_lshl_b32 s28, s29, 10
s_add_u32 s28, s28, s47
s_add_u32 m0, s28, 16384
s_lshl_b32 s29, s29, 15
buffer_load_dwordx4 v41, s[16:19], s29 offen lds
s_xor_b32 s29, s76, 6
s_lshl_b32 s28, s29, 10
s_add_u32 s28, s28, s47
s_add_u32 m0, s28, 16384
s_lshl_b32 s29, s29, 15
buffer_load_dwordx4 v41, s[16:19], s29 offen lds
s_xor_b32 s29, s76, 7
s_lshl_b32 s28, s29, 10
s_add_u32 s28, s28, s47
s_add_u32 m0, s28, 16384
s_lshl_b32 s29, s29, 15
buffer_load_dwordx4 v41, s[16:19], s29 offen lds
s_xor_b32 s29, s76, 8
s_lshl_b32 s28, s29, 10
s_add_u32 s28, s28, s47
s_add_u32 m0, s28, 16384
s_lshl_b32 s29, s29, 15
buffer_load_dwordx4 v41, s[16:19], s29 offen lds
s_xor_b32 s29, s76, 9
s_lshl_b32 s28, s29, 10
s_add_u32 s28, s28, s47
s_add_u32 m0, s28, 16384
s_lshl_b32 s29, s29, 15
buffer_load_dwordx4 v41, s[16:19], s29 offen lds
s_xor_b32 s29, s76, 10
s_lshl_b32 s28, s29, 10
s_add_u32 s28, s28, s47
s_add_u32 m0, s28, 16384
s_lshl_b32 s29, s29, 15
buffer_load_dwordx4 v41, s[16:19], s29 offen lds
s_xor_b32 s29, s76, 11
s_lshl_b32 s28, s29, 10
s_add_u32 s28, s28, s47
s_add_u32 m0, s28, 16384
s_lshl_b32 s29, s29, 15
buffer_load_dwordx4 v41, s[16:19], s29 offen lds
s_xor_b32 s29, s76, 12
s_lshl_b32 s28, s29, 10
s_add_u32 s28, s28, s47
s_add_u32 m0, s28, 16384
s_lshl_b32 s29, s29, 15
buffer_load_dwordx4 v41, s[16:19], s29 offen lds
s_xor_b32 s29, s76, 13
s_lshl_b32 s28, s29, 10
s_add_u32 s28, s28, s47
s_add_u32 m0, s28, 16384
s_lshl_b32 s29, s29, 15
buffer_load_dwordx4 v41, s[16:19], s29 offen lds
s_xor_b32 s29, s76, 14
s_lshl_b32 s28, s29, 10
s_add_u32 s28, s28, s47
s_add_u32 m0, s28, 16384
s_lshl_b32 s29, s29, 15
buffer_load_dwordx4 v41, s[16:19], s29 offen lds
s_xor_b32 s29, s76, 15
s_lshl_b32 s28, s29, 10
s_add_u32 s28, s28, s47
s_add_u32 m0, s28, 16384
s_lshl_b32 s29, s29, 15
buffer_load_dwordx4 v41, s[16:19], s29 offen lds
s_mov_b64 exec, 0
s_cmp_eq_u32 s24, 0
s_cbranch_scc1 mega_kernel_rf_iw0
s_cmp_eq_u32 s24, 1
s_cbranch_scc1 mega_kernel_rf_iw1
s_cmp_eq_u32 s24, 2
s_cbranch_scc1 mega_kernel_rf_iw2
s_branch mega_kernel_rf_iw3
mega_kernel_rf_iwd:
s_mov_b64 exec, -1
s_waitcnt vmcnt(17)
ds_read_b64_tr_b16 a[0:1], v46 offset:0
ds_read_b64_tr_b16 a[2:3], v46 offset:128
ds_read_b64_tr_b16 a[4:5], v46 offset:2048
ds_read_b64_tr_b16 a[6:7], v46 offset:2176
ds_read_b64_tr_b16 a[8:9], v46 offset:4096
ds_read_b64_tr_b16 a[10:11], v46 offset:4224
ds_read_b64_tr_b16 a[12:13], v46 offset:6144
ds_read_b64_tr_b16 a[14:15], v46 offset:6272
s_waitcnt lgkmcnt(0)
ds_read_b64_tr_b16 a[16:17], v46 offset:8192
ds_read_b64_tr_b16 a[18:19], v46 offset:8320
ds_read_b64_tr_b16 a[20:21], v46 offset:10240
ds_read_b64_tr_b16 a[22:23], v46 offset:10368
ds_read_b64_tr_b16 a[24:25], v46 offset:12288
ds_read_b64_tr_b16 a[26:27], v46 offset:12416
ds_read_b64_tr_b16 a[28:29], v46 offset:14336
ds_read_b64_tr_b16 a[30:31], v46 offset:14464
s_waitcnt lgkmcnt(0)
ds_read_b64_tr_b16 a[32:33], v46 offset:32
ds_read_b64_tr_b16 a[34:35], v46 offset:160
ds_read_b64_tr_b16 a[36:37], v46 offset:2080
ds_read_b64_tr_b16 a[38:39], v46 offset:2208
ds_read_b64_tr_b16 a[40:41], v46 offset:4128
ds_read_b64_tr_b16 a[42:43], v46 offset:4256
ds_read_b64_tr_b16 a[44:45], v46 offset:6176
ds_read_b64_tr_b16 a[46:47], v46 offset:6304
s_waitcnt lgkmcnt(0)
ds_read_b64_tr_b16 a[48:49], v46 offset:8224
ds_read_b64_tr_b16 a[50:51], v46 offset:8352
ds_read_b64_tr_b16 a[52:53], v46 offset:10272
ds_read_b64_tr_b16 a[54:55], v46 offset:10400
ds_read_b64_tr_b16 a[56:57], v46 offset:12320
ds_read_b64_tr_b16 a[58:59], v46 offset:12448
ds_read_b64_tr_b16 a[60:61], v46 offset:14368
ds_read_b64_tr_b16 a[62:63], v46 offset:14496
s_waitcnt lgkmcnt(0)
v_and_b32 v247, 15, v0
v_lshlrev_b32 v247, 4, v247
buffer_load_dword v246, v247, s[72:75], 0 offen sc1
buffer_load_dwordx4 v[64:67], v8, s[20:23], 0 offen offset:0
buffer_load_dwordx4 v[68:71], v8, s[20:23], 0 offen offset:128
buffer_load_dwordx4 v[72:75], v8, s[20:23], 0 offen offset:256
buffer_load_dwordx4 v[76:79], v8, s[20:23], 0 offen offset:384
s_waitcnt vmcnt(0)
ds_read_b64_tr_b16 a[192:193], v47 offset:16384
ds_read_b64_tr_b16 a[194:195], v47 offset:16512
ds_read_b64_tr_b16 a[196:197], v47 offset:18432
ds_read_b64_tr_b16 a[198:199], v47 offset:18560
ds_read_b64_tr_b16 a[200:201], v47 offset:20480
ds_read_b64_tr_b16 a[202:203], v47 offset:20608
ds_read_b64_tr_b16 a[204:205], v47 offset:22528
ds_read_b64_tr_b16 a[206:207], v47 offset:22656
s_waitcnt lgkmcnt(0)
ds_read_b64_tr_b16 a[208:209], v47 offset:24576
ds_read_b64_tr_b16 a[210:211], v47 offset:24704
ds_read_b64_tr_b16 a[212:213], v47 offset:26624
ds_read_b64_tr_b16 a[214:215], v47 offset:26752
ds_read_b64_tr_b16 a[216:217], v47 offset:28672
ds_read_b64_tr_b16 a[218:219], v47 offset:28800
ds_read_b64_tr_b16 a[220:221], v47 offset:30720
ds_read_b64_tr_b16 a[222:223], v47 offset:30848
s_waitcnt lgkmcnt(0)
ds_read_b64_tr_b16 a[224:225], v47 offset:16416
ds_read_b64_tr_b16 a[226:227], v47 offset:16544
ds_read_b64_tr_b16 a[228:229], v47 offset:18464
ds_read_b64_tr_b16 a[230:231], v47 offset:18592
ds_read_b64_tr_b16 a[232:233], v47 offset:20512
ds_read_b64_tr_b16 a[234:235], v47 offset:20640
ds_read_b64_tr_b16 a[236:237], v47 offset:22560
ds_read_b64_tr_b16 a[238:239], v47 offset:22688
s_waitcnt lgkmcnt(0)
ds_read_b64_tr_b16 a[240:241], v47 offset:24608
ds_read_b64_tr_b16 a[242:243], v47 offset:24736
ds_read_b64_tr_b16 a[244:245], v47 offset:26656
ds_read_b64_tr_b16 a[246:247], v47 offset:26784
ds_read_b64_tr_b16 a[248:249], v47 offset:28704
ds_read_b64_tr_b16 a[250:251], v47 offset:28832
ds_read_b64_tr_b16 a[252:253], v47 offset:30752
ds_read_b64_tr_b16 a[254:255], v47 offset:30880
s_waitcnt lgkmcnt(0)
v_mov_b32 v32, v64
v_mov_b32 v33, v65
v_mov_b32 v34, v66
v_mov_b32 v35, v67
v_mov_b32 v36, v68
v_mov_b32 v37, v69
v_mov_b32 v38, v70
v_mov_b32 v39, v71
v_mov_b32 v40, v72
v_mov_b32 v41, v73
v_mov_b32 v42, v74
v_mov_b32 v43, v75
v_mov_b32 v44, v76
v_mov_b32 v45, v77
v_mov_b32 v46, v78
v_mov_b32 v47, v79
v_mov_b32 v96, 0
v_mov_b32 v97, 0
v_mov_b32 v98, 0
v_mov_b32 v99, 0
v_mov_b32 v100, 0
v_mov_b32 v101, 0
v_mov_b32 v102, 0
v_mov_b32 v103, 0
v_mov_b32 v104, 0
v_mov_b32 v105, 0
v_mov_b32 v106, 0
v_mov_b32 v107, 0
v_mov_b32 v108, 0
v_mov_b32 v109, 0
v_mov_b32 v110, 0
v_mov_b32 v111, 0
v_mov_b32 v112, 0
v_mov_b32 v113, 0
v_mov_b32 v114, 0
v_mov_b32 v115, 0
v_mov_b32 v116, 0
v_mov_b32 v117, 0
v_mov_b32 v118, 0
v_mov_b32 v119, 0
s_nop 1
v_smfmac_f32_16x16x64_bf16 v[96:99], v[32:35], a[0:7], v6
v_smfmac_f32_16x16x64_bf16 v[100:103], v[32:35], a[32:39], v6
v_smfmac_f32_16x16x64_bf16 v[104:107], v[32:35], a[64:71], v6
v_smfmac_f32_16x16x64_bf16 v[108:111], v[32:35], a[96:103], v6
v_smfmac_f32_16x16x64_bf16 v[96:99], v[36:39], a[8:15], v6
v_smfmac_f32_16x16x64_bf16 v[100:103], v[36:39], a[40:47], v6
v_smfmac_f32_16x16x64_bf16 v[104:107], v[36:39], a[72:79], v6
v_smfmac_f32_16x16x64_bf16 v[108:111], v[36:39], a[104:111], v6
v_smfmac_f32_16x16x64_bf16 v[96:99], v[40:43], a[16:23], v6
v_smfmac_f32_16x16x64_bf16 v[100:103], v[40:43], a[48:55], v6
v_smfmac_f32_16x16x64_bf16 v[104:107], v[40:43], a[80:87], v6
v_smfmac_f32_16x16x64_bf16 v[108:111], v[40:43], a[112:119], v6
v_smfmac_f32_16x16x64_bf16 v[96:99], v[44:47], a[24:31], v6
v_smfmac_f32_16x16x64_bf16 v[100:103], v[44:47], a[56:63], v6
v_smfmac_f32_16x16x64_bf16 v[104:107], v[44:47], a[88:95], v6
v_smfmac_f32_16x16x64_bf16 v[108:111], v[44:47], a[120:127], v6
v_and_b32 v247, 15, v0
v_lshlrev_b32 v247, 4, v247
s_branch mega_kernel_syrp
mega_kernel_syrw:
s_sleep 4
mega_kernel_syr:
buffer_load_dword v246, v247, s[72:75], 0 offen sc1
s_waitcnt vmcnt(0)
mega_kernel_syrp:
s_cmp_eq_u32 s95, 1
s_cbranch_scc0 mega_kernel_syrf
v_readlane_b32 s76, v246, 14
s_mov_b32 s98, 0
s_cmp_eq_u32 s76, 32
s_cbranch_scc0 mega_kernel_syrw
s_branch mega_kernel_syrd
mega_kernel_syrf:
s_mov_b32 s77, 0
s_mov_b32 s78, 0
v_readlane_b32 s76, v246, 0
s_add_u32 s77, s77, s76
s_xor_b32 s76, s76, 32
s_or_b32 s78, s78, s76
v_readlane_b32 s76, v246, 1
s_add_u32 s77, s77, s76
s_xor_b32 s76, s76, 32
s_or_b32 s78, s78, s76
v_readlane_b32 s76, v246, 2
s_add_u32 s77, s77, s76
s_xor_b32 s76, s76, 32
s_or_b32 s78, s78, s76
v_readlane_b32 s76, v246, 3
s_add_u32 s77, s77, s76
s_xor_b32 s76, s76, 32
s_or_b32 s78, s78, s76
v_readlane_b32 s76, v246, 4
s_add_u32 s77, s77, s76
s_xor_b32 s76, s76, 32
s_or_b32 s78, s78, s76
v_readlane_b32 s76, v246, 5
s_add_u32 s77, s77, s76
s_xor_b32 s76, s76, 32
s_or_b32 s78, s78, s76
v_readlane_b32 s76, v246, 6
s_add_u32 s77, s77, s76
s_xor_b32 s76, s76, 32
s_or_b32 s78, s78, s76
v_readlane_b32 s76, v246, 7
s_add_u32 s77, s77, s76
s_xor_b32 s76, s76, 32
s_or_b32 s78, s78, s76
s_cmp_eq_u32 s77, 256
s_cbranch_scc0 mega_kernel_syrw
v_mov_b32 v252, v246
s_cmp_eq_u32 s78, 0
s_cbranch_scc0 mega_kernel_slowent
v_readlane_b32 s76, v246, 10
v_readlane_b32 s77, v246, 8
s_cmp_eq_u32 s76, 32
s_cbranch_scc0 mega_kernel_syrw
s_cmp_gt_u32 s77, 16
s_cselect_b32 s98, 1, 0
mega_kernel_syrd:
s_lshr_b32 s28, s31, 4
s_lshl_b32 s28, s28, 14
s_lshl_b32 s29, s98, 13
s_add_u32 s28, s28, s29
s_and_b32 s29, s31, 15
s_lshl_b32 s29, s29, 9
s_add_u32 s28, s28, s29
s_lshl_b32 s29, s30, 16
s_add_u32 s28, s28, s29
s_add_u32 s28, s28, 67108864
v_lshrrev_b32 v12, 1, v17
v_add_u32 v12, s28, v12
v_xor_b32 v25, 0x10000, v12
v_xor_b32 v26, 0x20000, v12
v_xor_b32 v27, 0x30000, v12
v_add_u32 v25, 0, v25
v_add_u32 v26, 0, v26
v_add_u32 v27, 0, v27
s_lshl_b32 s28, s25, 2
s_add_u32 s28, s28, s26
s_mov_b32 s82, s28
s_lshr_b32 s29, s28, 3
s_xor_b32 s29, s29, s98
s_and_b32 s29, s29, 1
s_lshl_b32 s29, s29, 13
s_lshl_b32 s76, s28, 18
s_add_u32 s76, s76, s29
s_mov_b32 s83, s76
v_add_u32 v240, s76, v17
v_add_u32 v241, 33554432, v240
s_lshr_b32 s29, s28, 4
s_xor_b32 s29, s29, s98
s_and_b32 s29, s29, 1
s_lshl_b32 s29, s29, 13
s_lshl_b32 s79, s28, 17
s_add_u32 s79, s79, s29
s_add_u32 s79, s79, 71303168
s_xor_b32 s29, s98, 1
s_lshl_b32 s29, s29, 13
s_lshl_b32 s28, s25, 7
s_add_u32 s28, s28, s29
s_add_u32 s28, s28, 69206016
v_and_b32 v4, 1, v1
v_lshlrev_b32 v24, 12, v4
v_add_u32 v24, s28, v24
s_lshl_b32 s29, s26, 2
v_add_u32 v24, s29, v24
s_xor_b32 s81, s98, 1
s_lshl_b32 s81, s81, 13
s_lshr_b32 s29, s82, 6
s_lshl_b32 s29, s29, 14
s_add_u32 s81, s81, s29
s_and_b32 s29, s82, 63
s_lshl_b32 s29, s29, 7
s_add_u32 s81, s81, s29
s_add_u32 s81, s81, 69222400
v_mov_b32 v220, 0x3f803f80
v_mov_b32 v221, 0x3f803f80
v_mov_b32 v222, 0x3f803f80
v_mov_b32 v223, 0x3f803f80
v_mov_b32 v228, 0
s_mov_b32 s27, 0
s_mov_b32 s46, 0
s_mov_b32 s89, 0
s_mov_b32 s88, 0
s_mov_b32 s44, 18432
s_mov_b32 s45, 18432
s_cmp_eq_u32 s24, 3
s_cbranch_scc0 mega_kernel_rf_pfi
s_mov_b32 s76, 0
s_cmp_gt_i32 s46, s76
s_cbranch_scc1 mega_kernel_rf_pf0ok
mega_kernel_rf_pf0w:
v_mov_b32 v4, 0
s_mov_b64 exec, 3
buffer_atomic_add v4, v24, s[84:87], 0 offen sc0 sc1
s_mov_b64 exec, -1
s_waitcnt vmcnt(0)
v_readlane_b32 s46, v4, 0
v_readlane_b32 s28, v4, 1
s_nop 1
s_min_i32 s46, s46, s28
s_cmp_gt_i32 s46, s76
s_cbranch_scc0 mega_kernel_rf_pf0w
mega_kernel_rf_pf0ok:
s_add_u32 s77, s76, s82
s_bfe_u32 s28, s77, 0x40002
s_lshl_b32 s28, s28, 14
s_and_b32 s77, s77, 3
s_lshl_b32 s77, s77, 11
s_add_u32 s28, s28, s77
s_add_u32 m0, s45, 0
s_nop 0
buffer_load_dwordx4 v240, s[84:87], s28 offen offset:0 sc1 lds
s_add_u32 m0, s45, 0
s_nop 0
buffer_load_dwordx4 v240, s[84:87], s28 offen offset:1024 sc1 lds
s_add_u32 m0, s45, 2048
s_nop 0
buffer_load_dwordx4 v241, s[84:87], s28 offen offset:0 sc1 lds
s_add_u32 m0, s45, 2048
s_nop 0
buffer_load_dwordx4 v241, s[84:87], s28 offen offset:1024 sc1 lds
s_add_u32 s45, s45, 4096
s_cmp_eq_u32 s45, 30720
s_cselect_b32 s45, 18432, s45
s_waitcnt vmcnt(0) lgkmcnt(0)
s_branch mega_kernel_rf_pfj
mega_kernel_rf_pfi:
s_lshr_b32 s88, s25, 2
s_lshl_b32 s88, s88, 17
s_and_b32 s77, s25, 2
s_lshl_b32 s77, s77, 13
s_add_u32 s88, s88, s77
s_and_b32 s77, s25, 1
s_lshl_b32 s77, s77, 12
s_add_u32 s88, s88, s77
s_xor_b32 s77, s98, 0
s_lshl_b32 s77, s77, 13
s_add_u32 s88, s88, s77
s_add_u32 s88, s88, 68255744
s_lshl_b32 s77, s26, 10
s_add_u32 s88, s88, s77
mega_kernel_rf_pfj:
v_mov_b32 v184, 0
v_mov_b32 v185, 0
v_mov_b32 v186, 0
v_mov_b32 v187, 0
v_mov_b32 v188, 0
v_mov_b32 v189, 0
v_mov_b32 v190, 0
v_mov_b32 v191, 0
v_mov_b32 v192, 0
v_mov_b32 v193, 0
v_mov_b32 v194, 0
v_mov_b32 v195, 0
v_mov_b32 v196, 0
v_mov_b32 v197, 0
v_mov_b32 v198, 0
v_mov_b32 v199, 0
v_mov_b32 v200, 0
v_mov_b32 v201, 0
v_mov_b32 v202, 0
v_mov_b32 v203, 0
v_mov_b32 v204, 0
v_mov_b32 v205, 0
v_mov_b32 v206, 0
v_mov_b32 v207, 0
v_mov_b32 v249, 0
v_mov_b32 v60, 0
v_mov_b32 v61, 0
v_mov_b32 v62, 0
v_mov_b32 v63, 0
s_waitcnt lgkmcnt(0)
s_barrier
s_and_b32 s29, s27, 1
s_lshl_b32 s33, s29, 17
s_lshl_b32 s28, s30, 18
s_add_u32 s33, s33, s28
s_add_u32 s33, s33, 68157440
s_xor_b32 s34, s33, 131072
s_lshl_b32 s35, s29, 18
s_bfe_u32 s47, s27, 0x10001
s_branch mega_kernel_rf_first
.p2align 6
s_nop 0
s_nop 0
mega_kernel_rf_loop:
buffer_load_dwordx4 v[32:35], v7, s[84:87], s33 offen offset:0 sc1
v_add_u32 v5, s44, v17
ds_read_b128 v[156:159], v5 offset:0
ds_read_b128 v[160:163], v5 offset:1024
ds_read_b128 v[164:167], v5 offset:2048
ds_read_b128 v[168:171], v5 offset:3072
s_nop 4
buffer_load_dwordx4 v[36:39], v7, s[84:87], s33 offen offset:1024 sc1
s_nop 9
buffer_load_dwordx4 v[40:43], v7, s[84:87], s33 offen offset:2048 sc1
s_nop 9
buffer_load_dwordx4 v[44:47], v7, s[84:87], s33 offen offset:3072 sc1
s_waitcnt vmcnt(3)
v_max_u32 v4, v32, v34
v_cmp_eq_u32 vcc, -1, v4
s_cbranch_vccnz mega_kernel_rf_pa_15_0f
v_smfmac_f32_16x16x64_bf16 v[96:99], v[32:35], a[0:7], v6
v_smfmac_f32_16x16x64_bf16 v[100:103], v[32:35], a[32:39], v6
v_smfmac_f32_16x16x64_bf16 v[104:107], v[32:35], a[64:71], v6
s_waitcnt vmcnt(2)
v_max_u32 v4, v36, v38
v_cmp_eq_u32 vcc, -1, v4
v_smfmac_f32_16x16x64_bf16 v[108:111], v[32:35], a[96:103], v6
s_cbranch_vccnz mega_kernel_rf_pa_14_1f
v_smfmac_f32_16x16x64_bf16 v[96:99], v[36:39], a[8:15], v6
v_smfmac_f32_16x16x64_bf16 v[100:103], v[36:39], a[40:47], v6
v_smfmac_f32_16x16x64_bf16 v[104:107], v[36:39], a[72:79], v6
s_waitcnt vmcnt(1)
v_max_u32 v4, v40, v42
v_cmp_eq_u32 vcc, -1, v4
v_smfmac_f32_16x16x64_bf16 v[108:111], v[36:39], a[104:111], v6
s_cbranch_vccnz mega_kernel_rf_pa_12_2f
v_smfmac_f32_16x16x64_bf16 v[96:99], v[40:43], a[16:23], v6
v_smfmac_f32_16x16x64_bf16 v[100:103], v[40:43], a[48:55], v6
v_smfmac_f32_16x16x64_bf16 v[104:107], v[40:43], a[80:87], v6
s_waitcnt vmcnt(0)
v_max_u32 v4, v44, v46
v_cmp_eq_u32 vcc, -1, v4
v_smfmac_f32_16x16x64_bf16 v[108:111], v[40:43], a[112:119], v6
s_cbranch_vccnz mega_kernel_rf_pa_8_3f
v_smfmac_f32_16x16x64_bf16 v[96:99], v[44:47], a[24:31], v6
v_smfmac_f32_16x16x64_bf16 v[100:103], v[44:47], a[56:63], v6
v_smfmac_f32_16x16x64_bf16 v[104:107], v[44:47], a[88:95], v6
v_smfmac_f32_16x16x64_bf16 v[108:111], v[44:47], a[120:127], v6
mega_kernel_rf_pa_d:
mega_kernel_rf_adone:
s_nop 5
v_permlane32_swap_b32 v96, v100
v_permlane32_swap_b32 v97, v101
v_permlane32_swap_b32 v98, v102
v_permlane32_swap_b32 v99, v103
v_pk_add_f32 v[96:97], v[96:97], v[100:101]
v_pk_add_f32 v[98:99], v[98:99], v[102:103]
ds_write2_b32 v14, v96, v97 offset0:0 offset1:36
ds_write2_b32 v14, v98, v99 offset0:72 offset1:108
v_permlane32_swap_b32 v104, v108
v_permlane32_swap_b32 v105, v109
v_permlane32_swap_b32 v106, v110
v_permlane32_swap_b32 v107, v111
v_pk_add_f32 v[104:105], v[104:105], v[108:109]
v_pk_add_f32 v[106:107], v[106:107], v[110:111]
ds_write2_b32 v15, v104, v105 offset0:0 offset1:36
ds_write2_b32 v15, v106, v107 offset0:72 offset1:108
v_smfmac_f32_16x16x64_bf16 v[112:115], v[32:35], a[128:135], v6
v_smfmac_f32_16x16x64_bf16 v[116:119], v[32:35], a[160:167], v6
v_smfmac_f32_16x16x64_bf16 v[112:115], v[36:39], a[136:143], v6
v_smfmac_f32_16x16x64_bf16 v[116:119], v[36:39], a[168:175], v6
s_waitcnt lgkmcnt(0)
s_barrier
s_cmp_lg_u32 s24, 0
s_cbranch_scc1 mega_kernel_rf_side
ds_read_b128 v[120:123], v16 offset:0
ds_read_b128 v[124:127], v16 offset:16
ds_read_b128 v[128:131], v16 offset:2304
ds_read_b128 v[132:135], v16 offset:2320
ds_read_b128 v[136:139], v16 offset:4608
ds_read_b128 v[140:143], v16 offset:4624
ds_read_b128 v[144:147], v16 offset:6912
ds_read_b128 v[148:151], v16 offset:6928
v_smfmac_f32_16x16x64_bf16 v[112:115], v[40:43], a[144:151], v6
v_smfmac_f32_16x16x64_bf16 v[116:119], v[40:43], a[176:183], v6
v_smfmac_f32_16x16x64_bf16 v[112:115], v[44:47], a[152:159], v6
v_smfmac_f32_16x16x64_bf16 v[116:119], v[44:47], a[184:191], v6
s_mul_i32 s28, s31, 1280
s_add_u32 s28, s28, s33
s_add_u32 s28, s28, 49152
s_add_u32 s76, s37, s33
s_add_u32 s77, s38, s33
s_add_u32 s78, s39, s33
s_waitcnt lgkmcnt(4)
v_pk_add_f32 v[120:121], v[120:121], v[128:129]
v_pk_add_f32 v[122:123], v[122:123], v[130:131]
v_pk_add_f32 v[124:125], v[124:125], v[132:133]
v_pk_add_f32 v[126:127], v[126:127], v[134:135]
s_waitcnt lgkmcnt(0)
v_pk_add_f32 v[136:137], v[136:137], v[144:145]
v_pk_add_f32 v[138:139], v[138:139], v[146:147]
v_pk_add_f32 v[140:141], v[140:141], v[148:149]
v_pk_add_f32 v[142:143], v[142:143], v[150:151]
v_pk_add_f32 v[120:121], v[120:121], v[136:137]
v_pk_add_f32 v[122:123], v[122:123], v[138:139]
v_pk_add_f32 v[124:125], v[124:125], v[140:141]
v_pk_add_f32 v[126:127], v[126:127], v[142:143]
v_cvt_pk_bf16_f32 v152, v120, v121
v_cvt_pk_bf16_f32 v153, v122, v123
v_cvt_pk_bf16_f32 v154, v124, v125
v_cvt_pk_bf16_f32 v155, v126, v127
s_nop 1
v_mfma_f32_16x16x32_bf16 v[176:179], v[160:163], v[152:155], 0
v_mfma_f32_16x16x32_bf16 v[172:175], v[156:159], v[152:155], 0
v_mfma_f32_16x16x32_bf16 v[180:183], v[152:155], v[152:155], 0
s_cmp_eq_u32 s27, 63
s_cbranch_scc1 mega_kernel_rf_w0last
s_nop 4
v_mov_b32_dpp v172, v176 row_shr:8 row_mask:0xf bank_mask:0xc
v_mov_b32_dpp v173, v177 row_shr:8 row_mask:0xf bank_mask:0xc
v_mov_b32_dpp v174, v178 row_shr:8 row_mask:0xf bank_mask:0xc
v_mov_b32_dpp v175, v179 row_shr:8 row_mask:0xf bank_mask:0xc
v_min_u32 v180, -2, v180
v_min_u32 v172, -2, v172
s_mov_b64 exec, s[42:43]
buffer_store_dwordx4 v[180:183], v10, s[84:87], s28 offen
s_mov_b64 exec, -1
buffer_store_dwordx4 v[172:175], v17, s[84:87], s28 offen
v_permlane32_swap_b32 v112, v116
v_permlane32_swap_b32 v113, v117
v_permlane32_swap_b32 v114, v118
v_permlane32_swap_b32 v115, v119
v_pk_add_f32 v[112:113], v[112:113], v[116:117]
v_pk_add_f32 v[114:115], v[114:115], v[118:119]
ds_write_b128 v20, v[112:115]
s_waitcnt lgkmcnt(0)
s_barrier
v_mov_b32 v96, 0
v_mov_b32 v97, 0
v_mov_b32 v98, 0
v_mov_b32 v99, 0
v_mov_b32 v100, 0
v_mov_b32 v101, 0
v_mov_b32 v102, 0
v_mov_b32 v103, 0
v_cndmask_b32 v176, v23, v180, s[42:43]
v_cndmask_b32 v177, v23, v181, s[42:43]
v_cndmask_b32 v178, v23, v182, s[42:43]
v_cndmask_b32 v179, v23, v183, s[42:43]
s_mov_b64 exec, s[42:43]
buffer_load_dwordx4 v[188:191], v10, s[84:87], s76 offen sc1
buffer_load_dwordx4 v[196:199], v10, s[84:87], s77 offen sc1
buffer_load_dwordx4 v[204:207], v10, s[84:87], s78 offen sc1
s_mov_b64 exec, -1
buffer_load_dwordx4 v[184:187], v17, s[84:87], s76 offen sc1
buffer_load_dwordx4 v[192:195], v17, s[84:87], s77 offen sc1
buffer_load_dwordx4 v[200:203], v17, s[84:87], s78 offen sc1
v_pk_mul_f32 v[172:173], v[172:173], s[32:33] op_sel_hi:[1,0]
v_pk_mul_f32 v[174:175], v[174:175], s[32:33] op_sel_hi:[1,0]
v_pk_mul_f32 v[176:177], v[176:177], s[32:33] op_sel_hi:[1,0]
v_pk_mul_f32 v[178:179], v[178:179], s[32:33] op_sel_hi:[1,0]
s_lshl_b32 s89, s47, 31
s_or_b32 s89, s89, 0x3b39999a
s_nop 15
s_nop 1
s_mov_b64 exec, s[42:43]
buffer_load_dwordx4 v[188:191], v10, s[84:87], s76 offen sc1
buffer_load_dwordx4 v[196:199], v10, s[84:87], s77 offen sc1
buffer_load_dwordx4 v[204:207], v10, s[84:87], s78 offen sc1
s_mov_b64 exec, -1
buffer_load_dwordx4 v[184:187], v17, s[84:87], s76 offen sc1
buffer_load_dwordx4 v[192:195], v17, s[84:87], s77 offen sc1
buffer_load_dwordx4 v[200:203], v17, s[84:87], s78 offen sc1
mega_kernel_rf_p2:
s_waitcnt vmcnt(6)
v_max3_u32 v4, v184, v188, v192
v_max3_u32 v5, v196, v200, v204
v_max_u32 v4, v4, v5
v_cmp_eq_u32 vcc, -1, v4
s_cbranch_vccnz mega_kernel_rf_p2r
v_pk_add_f32 v[124:125], v[196:197], v[204:205]
v_pk_add_f32 v[126:127], v[198:199], v[206:207]
v_pk_add_f32 v[120:121], v[192:193], v[200:201]
v_pk_add_f32 v[122:123], v[194:195], v[202:203]
v_pk_add_f32 v[124:125], v[124:125], v[188:189]
v_pk_add_f32 v[126:127], v[126:127], v[190:191]
v_pk_add_f32 v[120:121], v[120:121], v[184:185]
v_pk_add_f32 v[122:123], v[122:123], v[186:187]
v_pk_fma_f32 v[176:177], v[124:125], s[32:33], v[176:177] op_sel_hi:[1,0,1]
v_pk_fma_f32 v[178:179], v[126:127], s[32:33], v[178:179] op_sel_hi:[1,0,1]
v_pk_fma_f32 v[172:173], v[120:121], s[32:33], v[172:173] op_sel_hi:[1,0,1]
v_pk_fma_f32 v[174:175], v[122:123], s[32:33], v[174:175] op_sel_hi:[1,0,1]
v_max3_f32 v232, v172, v173, v174
v_max3_f32 v233, v176, v177, v178
v_max3_f32 v232, v232, v175, v179
v_max_f32 v234, v232, v233
s_barrier
ds_read2_b64 v[208:211], v21 offset0:0 offset1:32
v_max_f32_dpp v232, v234, v234 row_ror:8 row_mask:0xf bank_mask:0xf
v_max_f32_dpp v233, v234, v234 row_ror:8 row_mask:0xf bank_mask:0xf
s_nop 1
v_permlane16_swap_b32 v232, v233
s_nop 0
v_max_f32 v234, v232, v233
v_max_f32 v235, v232, v233
s_nop 1
v_permlane32_swap_b32 v234, v235
s_nop 0
v_max_f32 v232, v234, v235
v_pk_add_f32 v[176:177], v[176:177], v[232:233] op_sel_hi:[1,0] neg_lo:[0,1] neg_hi:[0,1]
v_pk_add_f32 v[178:179], v[178:179], v[232:233] op_sel_hi:[1,0] neg_lo:[0,1] neg_hi:[0,1]
v_pk_add_f32 v[172:173], v[172:173], v[232:233] op_sel_hi:[1,0] neg_lo:[0,1] neg_hi:[0,1]
v_pk_add_f32 v[174:175], v[174:175], v[232:233] op_sel_hi:[1,0] neg_lo:[0,1] neg_hi:[0,1]
v_exp_f32 v176, v176
v_exp_f32 v177, v177
v_exp_f32 v178, v178
v_exp_f32 v179, v179
v_exp_f32 v172, v172
v_cvt_pk_bf16_f32 v216, v176, v177
v_cvt_pk_bf16_f32 v217, v178, v179
v_exp_f32 v173, v173
v_exp_f32 v174, v174
v_mfma_f32_16x16x16_bf16 v[224:227], v[220:221], v[216:217], 0
v_exp_f32 v175, v175
v_cvt_pk_bf16_f32 v212, v172, v173
s_waitcnt lgkmcnt(0)
v_mfma_f32_16x16x16_bf16 v[120:123], v[208:209], v[216:217], 0
v_cvt_pk_bf16_f32 v213, v174, v175
v_mfma_f32_16x16x16_bf16 v[124:127], v[210:211], v[216:217], 0
v_mov_b32_dpp v214, v212 row_ror:8 row_mask:0xf bank_mask:0xf
v_mov_b32_dpp v215, v213 row_ror:8 row_mask:0xf bank_mask:0xf
s_nop 1
v_mfma_f32_16x16x32_bf16 v[224:227], v[220:223], v[212:215], v[224:227]
v_mfma_f32_16x16x32_bf16 v[120:123], v[164:167], v[212:215], v[120:123]
v_mfma_f32_16x16x32_bf16 v[124:127], v[168:171], v[212:215], v[124:127]
s_add_u32 s29, s33, 24576
s_nop 4
v_rcp_f32 v234, v224
s_nop 0
v_pk_mul_f32 v[120:121], v[120:121], v[234:235] op_sel_hi:[1,0]
v_pk_mul_f32 v[122:123], v[122:123], v[234:235] op_sel_hi:[1,0]
v_pk_mul_f32 v[124:125], v[124:125], v[234:235] op_sel_hi:[1,0]
v_pk_mul_f32 v[126:127], v[126:127], v[234:235] op_sel_hi:[1,0]
v_cvt_pk_bf16_f32 v212, v120, v121
v_cvt_pk_bf16_f32 v213, v122, v123
v_cvt_pk_bf16_f32 v214, v124, v125
v_cvt_pk_bf16_f32 v215, v126, v127
v_min_u32 v212, -2, v212
s_mov_b64 exec, s[40:41]
buffer_store_dwordx4 v[212:215], v11, s[84:87], s33 offen
s_mov_b64 exec, -1
mega_kernel_rf_b3:
s_barrier
s_nop 15
buffer_load_dwordx4 v[32:35], v7, s[84:87], s29 offen offset:0 sc1
s_nop 9
buffer_load_dwordx4 v[36:39], v7, s[84:87], s29 offen offset:1024 sc1
s_nop 9
buffer_load_dwordx4 v[40:43], v7, s[84:87], s29 offen offset:2048 sc1
s_nop 9
buffer_load_dwordx4 v[44:47], v7, s[84:87], s29 offen offset:3072 sc1
mega_kernel_rf_pc_15_0:
s_waitcnt vmcnt(3)
v_cmp_eq_u32 vcc, -1, v32
s_cbranch_vccnz mega_kernel_rf_pc_15_0f
v_smfmac_f32_16x16x64_bf16 v[96:99], v[32:35], a[192:199], v6
v_smfmac_f32_16x16x64_bf16 v[100:103], v[32:35], a[224:231], v6
mega_kernel_rf_pc_14_1:
s_waitcnt vmcnt(2)
v_cmp_eq_u32 vcc, -1, v36
s_cbranch_vccnz mega_kernel_rf_pc_14_1f
v_smfmac_f32_16x16x64_bf16 v[96:99], v[36:39], a[200:207], v6
v_smfmac_f32_16x16x64_bf16 v[100:103], v[36:39], a[232:239], v6
mega_kernel_rf_pc_12_2:
s_waitcnt vmcnt(1)
v_cmp_eq_u32 vcc, -1, v40
s_cbranch_vccnz mega_kernel_rf_pc_12_2f
v_smfmac_f32_16x16x64_bf16 v[96:99], v[40:43], a[208:215], v6
v_smfmac_f32_16x16x64_bf16 v[100:103], v[40:43], a[240:247], v6
mega_kernel_rf_pc_8_3:
s_waitcnt vmcnt(0)
v_cmp_eq_u32 vcc, -1, v44
s_cbranch_vccnz mega_kernel_rf_pc_8_3f
v_smfmac_f32_16x16x64_bf16 v[96:99], v[44:47], a[216:223], v6
v_smfmac_f32_16x16x64_bf16 v[100:103], v[44:47], a[248:255], v6
mega_kernel_rf_pc_d:
s_nop 7
v_permlane32_swap_b32 v96, v100
v_permlane32_swap_b32 v97, v101
v_permlane32_swap_b32 v98, v102
v_permlane32_swap_b32 v99, v103
v_pk_add_f32 v[96:97], v[96:97], v[100:101]
v_pk_add_f32 v[98:99], v[98:99], v[102:103]
ds_write2_b32 v18, v96, v97 offset0:0 offset1:36
ds_write2_b32 v18, v98, v99 offset0:72 offset1:108
s_waitcnt lgkmcnt(0)
s_barrier
s_cmp_lg_u32 s24, 0
s_cbranch_scc1 mega_kernel_rf_x1
ds_read_b128 v[120:123], v19 offset:0
ds_read_b128 v[124:127], v19 offset:1152
ds_read_b128 v[128:131], v19 offset:2304
ds_read_b128 v[132:135], v19 offset:3456
s_waitcnt lgkmcnt(2)
v_pk_add_f32 v[120:121], v[120:121], v[124:125]
v_pk_add_f32 v[122:123], v[122:123], v[126:127]
s_waitcnt lgkmcnt(0)
v_pk_add_f32 v[128:129], v[128:129], v[132:133]
v_pk_add_f32 v[130:131], v[130:131], v[134:135]
v_pk_add_f32 v[120:121], v[120:121], v[128:129]
v_pk_add_f32 v[122:123], v[122:123], v[130:131]
v_fma_f32 v212, v120, s89, v120
v_cvt_pk_bf16_f32 v213, v122, v123
v_cvt_pk_bf16_f32 v212, v212, v121
v_and_or_b32 v212, v212, -2, s47
buffer_store_dwordx2 v[212:213], v12, s[84:87], s35 offen sc1
s_mov_b32 s77, 0x3f80
s_mov_b32 s78, 0x3f800000
s_xor_b32 s76, s47, 1
v_mov_b32 v48, s76
v_mov_b32 v50, s76
v_mov_b32 v52, s76
s_nop 8
v_mov_b32 v96, 0
v_mov_b32 v97, 0
v_mov_b32 v98, 0
v_mov_b32 v99, 0
v_mov_b32 v100, 0
v_mov_b32 v101, 0
v_mov_b32 v102, 0
v_mov_b32 v103, 0
v_mov_b32 v104, 0
v_mov_b32 v105, 0
v_mov_b32 v106, 0
v_mov_b32 v107, 0
v_mov_b32 v108, 0
v_mov_b32 v109, 0
v_mov_b32 v110, 0
v_mov_b32 v111, 0
v_mov_b32 v112, 0
v_mov_b32 v113, 0
v_mov_b32 v114, 0
v_mov_b32 v115, 0
v_mov_b32 v116, 0
v_mov_b32 v117, 0
v_mov_b32 v118, 0
v_mov_b32 v119, 0
s_nop 15
s_nop 7
s_cmp_eq_u32 s47, 1
s_cbranch_scc1 mega_kernel_rf_p4_1
.p2align 6
mega_kernel_rf_p4_0:
buffer_load_dwordx2 v[48:49], v25, s[84:87], s35 offen sc1
buffer_load_dwordx2 v[50:51], v26, s[84:87], s35 offen sc1
buffer_load_dwordx2 v[52:53], v27, s[84:87], s35 offen sc1
s_waitcnt vmcnt(12)
mega_kernel_rf_p4c_0:
v_bitop3_b32 v4, v48, v50, v52 bitop3:0xfe
v_and_b32 v4, 1, v4
v_cmp_ne_u32 vcc, 0, v4
s_cbranch_vccnz mega_kernel_rf_p4_0
v_dot2_f32_bf16 v120, v48, s77, v120
v_dot2_f32_bf16 v121, v48, s78, v121
v_dot2_f32_bf16 v122, v49, s77, v122
v_dot2_f32_bf16 v123, v49, s78, v123
v_dot2_f32_bf16 v120, v50, s77, v120
v_dot2_f32_bf16 v121, v50, s78, v121
v_dot2_f32_bf16 v122, v51, s77, v122
v_dot2_f32_bf16 v123, v51, s78, v123
v_dot2_f32_bf16 v120, v52, s77, v120
v_dot2_f32_bf16 v121, v52, s78, v121
v_dot2_f32_bf16 v122, v53, s77, v122
v_dot2_f32_bf16 v123, v53, s78, v123
s_nop 0
v_cvt_pk_bf16_f32 v212, v120, v121
v_min_u32 v212, -2, v212
v_cvt_pk_bf16_f32 v213, v122, v123
buffer_store_dwordx2 v[212:213], v9, s[84:87], s34 offen
s_branch mega_kernel_rf_p4d
mega_kernel_rf_iw0:
mega_kernel_rf_il0:
s_cbranch_execz mega_kernel_rf_il1
.p2align 6
mega_kernel_rf_p4_1:
buffer_load_dwordx2 v[48:49], v25, s[84:87], s35 offen sc1
buffer_load_dwordx2 v[50:51], v26, s[84:87], s35 offen sc1
buffer_load_dwordx2 v[52:53], v27, s[84:87], s35 offen sc1
s_waitcnt vmcnt(12)
mega_kernel_rf_p4c_1:
v_bitop3_b32 v4, v48, v50, v52 bitop3:0x80
v_and_b32 v4, 1, v4
v_cmp_ne_u32 vcc, 1, v4
s_cbranch_vccnz mega_kernel_rf_p4_1
v_dot2_f32_bf16 v120, v48, s77, v120
v_dot2_f32_bf16 v121, v48, s78, v121
v_dot2_f32_bf16 v122, v49, s77, v122
v_dot2_f32_bf16 v123, v49, s78, v123
v_dot2_f32_bf16 v120, v50, s77, v120
v_dot2_f32_bf16 v121, v50, s78, v121
v_dot2_f32_bf16 v122, v51, s77, v122
v_dot2_f32_bf16 v123, v51, s78, v123
v_dot2_f32_bf16 v120, v52, s77, v120
v_dot2_f32_bf16 v121, v52, s78, v121
v_dot2_f32_bf16 v122, v53, s77, v122
v_dot2_f32_bf16 v123, v53, s78, v123
s_nop 0
v_cvt_pk_bf16_f32 v212, v120, v121
v_min_u32 v212, -2, v212
v_cvt_pk_bf16_f32 v213, v122, v123
buffer_store_dwordx2 v[212:213], v9, s[84:87], s34 offen
mega_kernel_rf_p4d:
mega_kernel_rf_b5:
s_add_u32 s27, s27, 1
s_add_u32 s44, s44, 4096
s_cmp_eq_u32 s44, 30720
s_cselect_b32 s44, 18432, s44
s_mov_b32 s28, s33
s_mov_b32 s33, s34
s_mov_b32 s34, s28
s_xor_b32 s35, s35, 262144
s_bfe_u32 s47, s27, 0x10001
s_barrier
s_nop 15
s_branch mega_kernel_rf_loop
mega_kernel_rf_il1:
s_cbranch_execz mega_kernel_rf_il2
mega_kernel_rf_x1:
s_cmp_eq_u32 s24, 1
s_cbranch_scc0 mega_kernel_rf_x2
s_add_u32 s76, s27, 1
s_sleep 6
v_mov_b32 v5, s76
s_mov_b64 exec, 1
buffer_store_dword v5, v228, s[84:87], s81 offen sc1
s_mov_b64 exec, -1
mega_kernel_rf_x2:
s_cmp_eq_u32 s24, 3
s_cbranch_scc0 mega_kernel_rf_x4
s_cmp_eq_u32 s36, 1
s_cbranch_scc0 mega_kernel_rf_x5
s_add_u32 s76, s27, 1
s_cmp_gt_i32 s46, s76
s_cbranch_scc1 mega_kernel_rf_pf1ok
mega_kernel_rf_pf1w:
v_mov_b32 v4, 0
s_mov_b64 exec, 3
buffer_atomic_add v4, v24, s[84:87], 0 offen sc0 sc1
s_mov_b64 exec, -1
s_waitcnt vmcnt(0)
v_readlane_b32 s46, v4, 0
v_readlane_b32 s28, v4, 1
s_nop 1
s_min_i32 s46, s46, s28
s_cmp_gt_i32 s46, s76
s_cbranch_scc0 mega_kernel_rf_pf1w
mega_kernel_rf_pf1ok:
s_add_u32 s77, s76, s82
s_bfe_u32 s28, s77, 0x40002
s_lshl_b32 s28, s28, 14
s_and_b32 s77, s77, 3
s_lshl_b32 s77, s77, 11
s_add_u32 s28, s28, s77
s_add_u32 m0, s45, 0
s_nop 0
buffer_load_dwordx4 v240, s[84:87], s28 offen offset:0 sc1 lds
s_add_u32 m0, s45, 0
s_nop 0
buffer_load_dwordx4 v240, s[84:87], s28 offen offset:1024 sc1 lds
s_add_u32 m0, s45, 2048
s_nop 0
buffer_load_dwordx4 v241, s[84:87], s28 offen offset:0 sc1 lds
s_add_u32 m0, s45, 2048
s_nop 0
buffer_load_dwordx4 v241, s[84:87], s28 offen offset:1024 sc1 lds
s_add_u32 s45, s45, 4096
s_cmp_eq_u32 s45, 30720
s_cselect_b32 s45, 18432, s45
s_waitcnt vmcnt(0)
mega_kernel_rf_x5:
s_add_u32 s76, s27, 4
s_min_u32 s76, s76, 63
s_cmp_gt_i32 s46, s76
s_cbranch_scc1 mega_kernel_rf_x6
v_mov_b32 v249, 0
s_mov_b64 exec, 3
buffer_atomic_add v249, v24, s[84:87], 0 offen sc0 sc1
s_mov_b64 exec, -1
mega_kernel_rf_x6:
s_add_u32 s76, s27, 2
s_cmp_lt_u32 s76, 63
s_cbranch_scc0 mega_kernel_rf_x4
s_cmp_gt_i32 s46, s76
s_cbranch_scc0 mega_kernel_rf_x4
s_add_u32 s77, s76, s82
s_bfe_u32 s28, s77, 0x40002
s_lshl_b32 s28, s28, 14
s_and_b32 s77, s77, 3
s_lshl_b32 s77, s77, 11
s_add_u32 s28, s28, s77
s_add_u32 s28, s28, s83
s_add_u32 s28, s28, 33554432
s_buffer_load_dword s78, s[84:87], s28 offset:0
s_buffer_load_dword s78, s[84:87], s28 offset:128
s_buffer_load_dword s78, s[84:87], s28 offset:256
s_buffer_load_dword s78, s[84:87], s28 offset:384
s_buffer_load_dword s78, s[84:87], s28 offset:512
s_buffer_load_dword s78, s[84:87], s28 offset:640
s_buffer_load_dword s78, s[84:87], s28 offset:768
s_buffer_load_dword s78, s[84:87], s28 offset:896
s_buffer_load_dword s78, s[84:87], s28 offset:1024
s_buffer_load_dword s78, s[84:87], s28 offset:1152
s_buffer_load_dword s78, s[84:87], s28 offset:1280
s_buffer_load_dword s78, s[84:87], s28 offset:1408
s_buffer_load_dword s78, s[84:87], s28 offset:1536
s_buffer_load_dword s78, s[84:87], s28 offset:1664
s_buffer_load_dword s78, s[84:87], s28 offset:1792
s_buffer_load_dword s78, s[84:87], s28 offset:1920
mega_kernel_rf_x4:
v_mov_b32 v96, 0
v_mov_b32 v97, 0
v_mov_b32 v98, 0
v_mov_b32 v99, 0
v_mov_b32 v100, 0
v_mov_b32 v101, 0
v_mov_b32 v102, 0
v_mov_b32 v103, 0
v_mov_b32 v104, 0
v_mov_b32 v105, 0
v_mov_b32 v106, 0
v_mov_b32 v107, 0
v_mov_b32 v108, 0
v_mov_b32 v109, 0
v_mov_b32 v110, 0
v_mov_b32 v111, 0
v_mov_b32 v112, 0
v_mov_b32 v113, 0
v_mov_b32 v114, 0
v_mov_b32 v115, 0
v_mov_b32 v116, 0
v_mov_b32 v117, 0
v_mov_b32 v118, 0
v_mov_b32 v119, 0
s_branch mega_kernel_rf_b5
mega_kernel_rf_il2:
s_cbranch_execz mega_kernel_rf_il3
mega_kernel_rf_p2r:
s_mov_b64 exec, s[42:43]
buffer_load_dwordx4 v[188:191], v10, s[84:87], s76 offen sc1
buffer_load_dwordx4 v[196:199], v10, s[84:87], s77 offen sc1
buffer_load_dwordx4 v[204:207], v10, s[84:87], s78 offen sc1
s_mov_b64 exec, -1
buffer_load_dwordx4 v[184:187], v17, s[84:87], s76 offen sc1
buffer_load_dwordx4 v[192:195], v17, s[84:87], s77 offen sc1
buffer_load_dwordx4 v[200:203], v17, s[84:87], s78 offen sc1
s_branch mega_kernel_rf_p2
mega_kernel_rf_il3:
s_cbranch_execz mega_kernel_rf_il4
.p2align 5
mega_kernel_rf_pa_1_0f:
s_mov_b64 exec, vcc
buffer_load_dwordx4 v[32:35], v7, s[84:87], s33 offen offset:0 sc1
s_mov_b64 exec, -1
s_branch mega_kernel_rf_pa_1_0
.p2align 5
mega_kernel_rf_pa_1_0:
s_waitcnt vmcnt(0)
v_max_u32 v4, v32, v34
v_cmp_eq_u32 vcc, -1, v4
s_cbranch_vccnz mega_kernel_rf_pa_1_0f
v_smfmac_f32_16x16x64_bf16 v[96:99], v[32:35], a[0:7], v6
v_smfmac_f32_16x16x64_bf16 v[100:103], v[32:35], a[32:39], v6
v_smfmac_f32_16x16x64_bf16 v[104:107], v[32:35], a[64:71], v6
v_smfmac_f32_16x16x64_bf16 v[108:111], v[32:35], a[96:103], v6
s_branch mega_kernel_rf_pa_d
mega_kernel_rf_il4:
s_cbranch_execz mega_kernel_rf_il5
.p2align 5
mega_kernel_rf_pa_2_1f:
s_mov_b64 exec, vcc
buffer_load_dwordx4 v[36:39], v7, s[84:87], s33 offen offset:1024 sc1
s_mov_b64 exec, -1
s_branch mega_kernel_rf_pa_2_1
.p2align 5
mega_kernel_rf_pa_2_1:
s_waitcnt vmcnt(0)
v_max_u32 v4, v36, v38
v_cmp_eq_u32 vcc, -1, v4
s_cbranch_vccnz mega_kernel_rf_pa_2_1f
v_smfmac_f32_16x16x64_bf16 v[96:99], v[36:39], a[8:15], v6
v_smfmac_f32_16x16x64_bf16 v[100:103], v[36:39], a[40:47], v6
v_smfmac_f32_16x16x64_bf16 v[104:107], v[36:39], a[72:79], v6
v_smfmac_f32_16x16x64_bf16 v[108:111], v[36:39], a[104:111], v6
s_branch mega_kernel_rf_pa_d
mega_kernel_rf_il5:
s_cbranch_execz mega_kernel_rf_il6
.p2align 5
mega_kernel_rf_pa_3_0f:
s_mov_b64 exec, vcc
buffer_load_dwordx4 v[32:35], v7, s[84:87], s33 offen offset:0 sc1
s_mov_b64 exec, -1
s_branch mega_kernel_rf_pa_3_1
.p2align 5
mega_kernel_rf_pa_3_0:
s_waitcnt vmcnt(1)
v_max_u32 v4, v32, v34
v_cmp_eq_u32 vcc, -1, v4
s_cbranch_vccnz mega_kernel_rf_pa_3_0f
v_smfmac_f32_16x16x64_bf16 v[96:99], v[32:35], a[0:7], v6
v_smfmac_f32_16x16x64_bf16 v[100:103], v[32:35], a[32:39], v6
v_smfmac_f32_16x16x64_bf16 v[104:107], v[32:35], a[64:71], v6
v_smfmac_f32_16x16x64_bf16 v[108:111], v[32:35], a[96:103], v6
s_branch mega_kernel_rf_pa_2_1
mega_kernel_rf_il6:
s_cbranch_execz mega_kernel_rf_il7
.p2align 5
mega_kernel_rf_pa_3_1f:
s_mov_b64 exec, vcc
buffer_load_dwordx4 v[36:39], v7, s[84:87], s33 offen offset:1024 sc1
s_mov_b64 exec, -1
s_branch mega_kernel_rf_pa_3_0
.p2align 5
mega_kernel_rf_pa_3_1:
s_waitcnt vmcnt(1)
v_max_u32 v4, v36, v38
v_cmp_eq_u32 vcc, -1, v4
s_cbranch_vccnz mega_kernel_rf_pa_3_1f
v_smfmac_f32_16x16x64_bf16 v[96:99], v[36:39], a[8:15], v6
v_smfmac_f32_16x16x64_bf16 v[100:103], v[36:39], a[40:47], v6
v_smfmac_f32_16x16x64_bf16 v[104:107], v[36:39], a[72:79], v6
v_smfmac_f32_16x16x64_bf16 v[108:111], v[36:39], a[104:111], v6
s_branch mega_kernel_rf_pa_1_0
mega_kernel_rf_il7:
s_cbranch_execz mega_kernel_rf_il8
.p2align 5
mega_kernel_rf_pa_4_2f:
s_mov_b64 exec, vcc
buffer_load_dwordx4 v[40:43], v7, s[84:87], s33 offen offset:2048 sc1
s_mov_b64 exec, -1
s_branch mega_kernel_rf_pa_4_2
.p2align 5
mega_kernel_rf_pa_4_2:
s_waitcnt vmcnt(0)
v_max_u32 v4, v40, v42
v_cmp_eq_u32 vcc, -1, v4
s_cbranch_vccnz mega_kernel_rf_pa_4_2f
v_smfmac_f32_16x16x64_bf16 v[96:99], v[40:43], a[16:23], v6
v_smfmac_f32_16x16x64_bf16 v[100:103], v[40:43], a[48:55], v6
v_smfmac_f32_16x16x64_bf16 v[104:107], v[40:43], a[80:87], v6
v_smfmac_f32_16x16x64_bf16 v[108:111], v[40:43], a[112:119], v6
s_branch mega_kernel_rf_pa_d
mega_kernel_rf_il8:
s_cbranch_execz mega_kernel_rf_il9
.p2align 5
mega_kernel_rf_pa_5_0f:
s_mov_b64 exec, vcc
buffer_load_dwordx4 v[32:35], v7, s[84:87], s33 offen offset:0 sc1
s_mov_b64 exec, -1
s_branch mega_kernel_rf_pa_5_2
.p2align 5
mega_kernel_rf_pa_5_0:
s_waitcnt vmcnt(1)
v_max_u32 v4, v32, v34
v_cmp_eq_u32 vcc, -1, v4
s_cbranch_vccnz mega_kernel_rf_pa_5_0f
v_smfmac_f32_16x16x64_bf16 v[96:99], v[32:35], a[0:7], v6
v_smfmac_f32_16x16x64_bf16 v[100:103], v[32:35], a[32:39], v6
v_smfmac_f32_16x16x64_bf16 v[104:107], v[32:35], a[64:71], v6
v_smfmac_f32_16x16x64_bf16 v[108:111], v[32:35], a[96:103], v6
s_branch mega_kernel_rf_pa_4_2
mega_kernel_rf_il9:
s_cbranch_execz mega_kernel_rf_il10
.p2align 5
mega_kernel_rf_pa_5_2f:
s_mov_b64 exec, vcc
buffer_load_dwordx4 v[40:43], v7, s[84:87], s33 offen offset:2048 sc1
s_mov_b64 exec, -1
s_branch mega_kernel_rf_pa_5_0
.p2align 5
mega_kernel_rf_pa_5_2:
s_waitcnt vmcnt(1)
v_max_u32 v4, v40, v42
v_cmp_eq_u32 vcc, -1, v4
s_cbranch_vccnz mega_kernel_rf_pa_5_2f
v_smfmac_f32_16x16x64_bf16 v[96:99], v[40:43], a[16:23], v6
v_smfmac_f32_16x16x64_bf16 v[100:103], v[40:43], a[48:55], v6
v_smfmac_f32_16x16x64_bf16 v[104:107], v[40:43], a[80:87], v6
v_smfmac_f32_16x16x64_bf16 v[108:111], v[40:43], a[112:119], v6
s_branch mega_kernel_rf_pa_1_0
mega_kernel_rf_il10:
s_cbranch_execz mega_kernel_rf_il11
.p2align 5
mega_kernel_rf_pa_6_1f:
s_mov_b64 exec, vcc
buffer_load_dwordx4 v[36:39], v7, s[84:87], s33 offen offset:1024 sc1
s_mov_b64 exec, -1
s_branch mega_kernel_rf_pa_6_2
.p2align 5
mega_kernel_rf_pa_6_1:
s_waitcnt vmcnt(1)
v_max_u32 v4, v36, v38
v_cmp_eq_u32 vcc, -1, v4
s_cbranch_vccnz mega_kernel_rf_pa_6_1f
v_smfmac_f32_16x16x64_bf16 v[96:99], v[36:39], a[8:15], v6
v_smfmac_f32_16x16x64_bf16 v[100:103], v[36:39], a[40:47], v6
v_smfmac_f32_16x16x64_bf16 v[104:107], v[36:39], a[72:79], v6
v_smfmac_f32_16x16x64_bf16 v[108:111], v[36:39], a[104:111], v6
s_branch mega_kernel_rf_pa_4_2
mega_kernel_rf_il11:
s_cbranch_execz mega_kernel_rf_il12
.p2align 5
mega_kernel_rf_pa_6_2f:
s_mov_b64 exec, vcc
buffer_load_dwordx4 v[40:43], v7, s[84:87], s33 offen offset:2048 sc1
s_mov_b64 exec, -1
s_branch mega_kernel_rf_pa_6_1
.p2align 5
mega_kernel_rf_pa_6_2:
s_waitcnt vmcnt(1)
v_max_u32 v4, v40, v42
v_cmp_eq_u32 vcc, -1, v4
s_cbranch_vccnz mega_kernel_rf_pa_6_2f
v_smfmac_f32_16x16x64_bf16 v[96:99], v[40:43], a[16:23], v6
v_smfmac_f32_16x16x64_bf16 v[100:103], v[40:43], a[48:55], v6
v_smfmac_f32_16x16x64_bf16 v[104:107], v[40:43], a[80:87], v6
v_smfmac_f32_16x16x64_bf16 v[108:111], v[40:43], a[112:119], v6
s_branch mega_kernel_rf_pa_2_1
mega_kernel_rf_il12:
s_cbranch_execz mega_kernel_rf_il13
.p2align 5
mega_kernel_rf_pa_7_0f:
s_mov_b64 exec, vcc
buffer_load_dwordx4 v[32:35], v7, s[84:87], s33 offen offset:0 sc1
s_mov_b64 exec, -1
s_branch mega_kernel_rf_pa_7_1
.p2align 5
mega_kernel_rf_pa_7_0:
s_waitcnt vmcnt(2)
v_max_u32 v4, v32, v34
v_cmp_eq_u32 vcc, -1, v4
s_cbranch_vccnz mega_kernel_rf_pa_7_0f
v_smfmac_f32_16x16x64_bf16 v[96:99], v[32:35], a[0:7], v6
v_smfmac_f32_16x16x64_bf16 v[100:103], v[32:35], a[32:39], v6
v_smfmac_f32_16x16x64_bf16 v[104:107], v[32:35], a[64:71], v6
v_smfmac_f32_16x16x64_bf16 v[108:111], v[32:35], a[96:103], v6
s_branch mega_kernel_rf_pa_6_1
mega_kernel_rf_il13:
s_cbranch_execz mega_kernel_rf_il14
.p2align 5
mega_kernel_rf_pa_7_1f:
s_mov_b64 exec, vcc
buffer_load_dwordx4 v[36:39], v7, s[84:87], s33 offen offset:1024 sc1
s_mov_b64 exec, -1
s_branch mega_kernel_rf_pa_7_2
.p2align 5
mega_kernel_rf_pa_7_1:
s_waitcnt vmcnt(2)
v_max_u32 v4, v36, v38
v_cmp_eq_u32 vcc, -1, v4
s_cbranch_vccnz mega_kernel_rf_pa_7_1f
v_smfmac_f32_16x16x64_bf16 v[96:99], v[36:39], a[8:15], v6
v_smfmac_f32_16x16x64_bf16 v[100:103], v[36:39], a[40:47], v6
v_smfmac_f32_16x16x64_bf16 v[104:107], v[36:39], a[72:79], v6
v_smfmac_f32_16x16x64_bf16 v[108:111], v[36:39], a[104:111], v6
s_branch mega_kernel_rf_pa_5_2
mega_kernel_rf_il14:
s_cbranch_execz mega_kernel_rf_il15
.p2align 5
mega_kernel_rf_pa_7_2f:
s_mov_b64 exec, vcc
buffer_load_dwordx4 v[40:43], v7, s[84:87], s33 offen offset:2048 sc1
s_mov_b64 exec, -1
s_branch mega_kernel_rf_pa_7_0
.p2align 5
mega_kernel_rf_pa_7_2:
s_waitcnt vmcnt(2)
v_max_u32 v4, v40, v42
v_cmp_eq_u32 vcc, -1, v4
s_cbranch_vccnz mega_kernel_rf_pa_7_2f
v_smfmac_f32_16x16x64_bf16 v[96:99], v[40:43], a[16:23], v6
v_smfmac_f32_16x16x64_bf16 v[100:103], v[40:43], a[48:55], v6
v_smfmac_f32_16x16x64_bf16 v[104:107], v[40:43], a[80:87], v6
v_smfmac_f32_16x16x64_bf16 v[108:111], v[40:43], a[112:119], v6
s_branch mega_kernel_rf_pa_3_0
mega_kernel_rf_il15:
s_cbranch_execz mega_kernel_rf_il16
.p2align 5
mega_kernel_rf_pa_8_3f:
s_mov_b64 exec, vcc
buffer_load_dwordx4 v[44:47], v7, s[84:87], s33 offen offset:3072 sc1
s_mov_b64 exec, -1
s_branch mega_kernel_rf_pa_8_3
.p2align 5
mega_kernel_rf_pa_8_3:
s_waitcnt vmcnt(0)
v_max_u32 v4, v44, v46
v_cmp_eq_u32 vcc, -1, v4
s_cbranch_vccnz mega_kernel_rf_pa_8_3f
v_smfmac_f32_16x16x64_bf16 v[96:99], v[44:47], a[24:31], v6
v_smfmac_f32_16x16x64_bf16 v[100:103], v[44:47], a[56:63], v6
v_smfmac_f32_16x16x64_bf16 v[104:107], v[44:47], a[88:95], v6
v_smfmac_f32_16x16x64_bf16 v[108:111], v[44:47], a[120:127], v6
s_branch mega_kernel_rf_pa_d
mega_kernel_rf_il16:
s_cbranch_execz mega_kernel_rf_il17
.p2align 5
mega_kernel_rf_pa_9_0f:
s_mov_b64 exec, vcc
buffer_load_dwordx4 v[32:35], v7, s[84:87], s33 offen offset:0 sc1
s_mov_b64 exec, -1
s_branch mega_kernel_rf_pa_9_3
.p2align 5
mega_kernel_rf_pa_9_0:
s_waitcnt vmcnt(1)
v_max_u32 v4, v32, v34
v_cmp_eq_u32 vcc, -1, v4
s_cbranch_vccnz mega_kernel_rf_pa_9_0f
v_smfmac_f32_16x16x64_bf16 v[96:99], v[32:35], a[0:7], v6
v_smfmac_f32_16x16x64_bf16 v[100:103], v[32:35], a[32:39], v6
v_smfmac_f32_16x16x64_bf16 v[104:107], v[32:35], a[64:71], v6
v_smfmac_f32_16x16x64_bf16 v[108:111], v[32:35], a[96:103], v6
s_branch mega_kernel_rf_pa_8_3
mega_kernel_rf_il17:
s_cbranch_execz mega_kernel_rf_il18
.p2align 5
mega_kernel_rf_pa_9_3f:
s_mov_b64 exec, vcc
buffer_load_dwordx4 v[44:47], v7, s[84:87], s33 offen offset:3072 sc1
s_mov_b64 exec, -1
s_branch mega_kernel_rf_pa_9_0
.p2align 5
mega_kernel_rf_pa_9_3:
s_waitcnt vmcnt(1)
v_max_u32 v4, v44, v46
v_cmp_eq_u32 vcc, -1, v4
s_cbranch_vccnz mega_kernel_rf_pa_9_3f
v_smfmac_f32_16x16x64_bf16 v[96:99], v[44:47], a[24:31], v6
v_smfmac_f32_16x16x64_bf16 v[100:103], v[44:47], a[56:63], v6
v_smfmac_f32_16x16x64_bf16 v[104:107], v[44:47], a[88:95], v6
v_smfmac_f32_16x16x64_bf16 v[108:111], v[44:47], a[120:127], v6
s_branch mega_kernel_rf_pa_1_0
mega_kernel_rf_il18:
s_cbranch_execz mega_kernel_rf_iwd
.p2align 5
mega_kernel_rf_pa_10_1f:
s_mov_b64 exec, vcc
buffer_load_dwordx4 v[36:39], v7, s[84:87], s33 offen offset:1024 sc1
s_mov_b64 exec, -1
s_branch mega_kernel_rf_pa_10_3
.p2align 5
mega_kernel_rf_pa_10_1:
s_waitcnt vmcnt(1)
v_max_u32 v4, v36, v38
v_cmp_eq_u32 vcc, -1, v4
s_cbranch_vccnz mega_kernel_rf_pa_10_1f
v_smfmac_f32_16x16x64_bf16 v[96:99], v[36:39], a[8:15], v6
v_smfmac_f32_16x16x64_bf16 v[100:103], v[36:39], a[40:47], v6
v_smfmac_f32_16x16x64_bf16 v[104:107], v[36:39], a[72:79], v6
v_smfmac_f32_16x16x64_bf16 v[108:111], v[36:39], a[104:111], v6
s_branch mega_kernel_rf_pa_8_3
mega_kernel_rf_iw1:
mega_kernel_rf_il19:
s_cbranch_execz mega_kernel_rf_il20
.p2align 5
mega_kernel_rf_pa_10_3f:
s_mov_b64 exec, vcc
buffer_load_dwordx4 v[44:47], v7, s[84:87], s33 offen offset:3072 sc1
s_mov_b64 exec, -1
s_branch mega_kernel_rf_pa_10_1
.p2align 5
mega_kernel_rf_pa_10_3:
s_waitcnt vmcnt(1)
v_max_u32 v4, v44, v46
v_cmp_eq_u32 vcc, -1, v4
s_cbranch_vccnz mega_kernel_rf_pa_10_3f
v_smfmac_f32_16x16x64_bf16 v[96:99], v[44:47], a[24:31], v6
v_smfmac_f32_16x16x64_bf16 v[100:103], v[44:47], a[56:63], v6
v_smfmac_f32_16x16x64_bf16 v[104:107], v[44:47], a[88:95], v6
v_smfmac_f32_16x16x64_bf16 v[108:111], v[44:47], a[120:127], v6
s_branch mega_kernel_rf_pa_2_1
mega_kernel_rf_il20:
s_cbranch_execz mega_kernel_rf_il21
.p2align 5
mega_kernel_rf_pa_11_0f:
s_mov_b64 exec, vcc
buffer_load_dwordx4 v[32:35], v7, s[84:87], s33 offen offset:0 sc1
s_mov_b64 exec, -1
s_branch mega_kernel_rf_pa_11_1
.p2align 5
mega_kernel_rf_pa_11_0:
s_waitcnt vmcnt(2)
v_max_u32 v4, v32, v34
v_cmp_eq_u32 vcc, -1, v4
s_cbranch_vccnz mega_kernel_rf_pa_11_0f
v_smfmac_f32_16x16x64_bf16 v[96:99], v[32:35], a[0:7], v6
v_smfmac_f32_16x16x64_bf16 v[100:103], v[32:35], a[32:39], v6
v_smfmac_f32_16x16x64_bf16 v[104:107], v[32:35], a[64:71], v6
v_smfmac_f32_16x16x64_bf16 v[108:111], v[32:35], a[96:103], v6
s_branch mega_kernel_rf_pa_10_1
mega_kernel_rf_il21:
s_cbranch_execz mega_kernel_rf_il22
.p2align 5
mega_kernel_rf_pa_11_1f:
s_mov_b64 exec, vcc
buffer_load_dwordx4 v[36:39], v7, s[84:87], s33 offen offset:1024 sc1
s_mov_b64 exec, -1
s_branch mega_kernel_rf_pa_11_3
.p2align 5
mega_kernel_rf_pa_11_1:
s_waitcnt vmcnt(2)
v_max_u32 v4, v36, v38
v_cmp_eq_u32 vcc, -1, v4
s_cbranch_vccnz mega_kernel_rf_pa_11_1f
v_smfmac_f32_16x16x64_bf16 v[96:99], v[36:39], a[8:15], v6
v_smfmac_f32_16x16x64_bf16 v[100:103], v[36:39], a[40:47], v6
v_smfmac_f32_16x16x64_bf16 v[104:107], v[36:39], a[72:79], v6
v_smfmac_f32_16x16x64_bf16 v[108:111], v[36:39], a[104:111], v6
s_branch mega_kernel_rf_pa_9_3
mega_kernel_rf_il22:
s_cbranch_execz mega_kernel_rf_il23
.p2align 5
mega_kernel_rf_pa_11_3f:
s_mov_b64 exec, vcc
buffer_load_dwordx4 v[44:47], v7, s[84:87], s33 offen offset:3072 sc1
s_mov_b64 exec, -1
s_branch mega_kernel_rf_pa_11_0
.p2align 5
mega_kernel_rf_pa_11_3:
s_waitcnt vmcnt(2)
v_max_u32 v4, v44, v46
v_cmp_eq_u32 vcc, -1, v4
s_cbranch_vccnz mega_kernel_rf_pa_11_3f
v_smfmac_f32_16x16x64_bf16 v[96:99], v[44:47], a[24:31], v6
v_smfmac_f32_16x16x64_bf16 v[100:103], v[44:47], a[56:63], v6
v_smfmac_f32_16x16x64_bf16 v[104:107], v[44:47], a[88:95], v6
v_smfmac_f32_16x16x64_bf16 v[108:111], v[44:47], a[120:127], v6
s_branch mega_kernel_rf_pa_3_0
mega_kernel_rf_il23:
s_cbranch_execz mega_kernel_rf_il24
.p2align 5
mega_kernel_rf_pa_12_2f:
s_mov_b64 exec, vcc
buffer_load_dwordx4 v[40:43], v7, s[84:87], s33 offen offset:2048 sc1
s_mov_b64 exec, -1
s_branch mega_kernel_rf_pa_12_3
.p2align 5
mega_kernel_rf_pa_12_2:
s_waitcnt vmcnt(1)
v_max_u32 v4, v40, v42
v_cmp_eq_u32 vcc, -1, v4
s_cbranch_vccnz mega_kernel_rf_pa_12_2f
v_smfmac_f32_16x16x64_bf16 v[96:99], v[40:43], a[16:23], v6
v_smfmac_f32_16x16x64_bf16 v[100:103], v[40:43], a[48:55], v6
v_smfmac_f32_16x16x64_bf16 v[104:107], v[40:43], a[80:87], v6
v_smfmac_f32_16x16x64_bf16 v[108:111], v[40:43], a[112:119], v6
s_branch mega_kernel_rf_pa_8_3
mega_kernel_rf_il24:
s_cbranch_execz mega_kernel_rf_il25
.p2align 5
mega_kernel_rf_pa_12_3f:
s_mov_b64 exec, vcc
buffer_load_dwordx4 v[44:47], v7, s[84:87], s33 offen offset:3072 sc1
s_mov_b64 exec, -1
s_branch mega_kernel_rf_pa_12_2
.p2align 5
mega_kernel_rf_pa_12_3:
s_waitcnt vmcnt(1)
v_max_u32 v4, v44, v46
v_cmp_eq_u32 vcc, -1, v4
s_cbranch_vccnz mega_kernel_rf_pa_12_3f
v_smfmac_f32_16x16x64_bf16 v[96:99], v[44:47], a[24:31], v6
v_smfmac_f32_16x16x64_bf16 v[100:103], v[44:47], a[56:63], v6
v_smfmac_f32_16x16x64_bf16 v[104:107], v[44:47], a[88:95], v6
v_smfmac_f32_16x16x64_bf16 v[108:111], v[44:47], a[120:127], v6
s_branch mega_kernel_rf_pa_4_2
mega_kernel_rf_il25:
s_cbranch_execz mega_kernel_rf_il26
.p2align 5
mega_kernel_rf_pa_13_0f:
s_mov_b64 exec, vcc
buffer_load_dwordx4 v[32:35], v7, s[84:87], s33 offen offset:0 sc1
s_mov_b64 exec, -1
s_branch mega_kernel_rf_pa_13_2
.p2align 5
mega_kernel_rf_pa_13_0:
s_waitcnt vmcnt(2)
v_max_u32 v4, v32, v34
v_cmp_eq_u32 vcc, -1, v4
s_cbranch_vccnz mega_kernel_rf_pa_13_0f
v_smfmac_f32_16x16x64_bf16 v[96:99], v[32:35], a[0:7], v6
v_smfmac_f32_16x16x64_bf16 v[100:103], v[32:35], a[32:39], v6
v_smfmac_f32_16x16x64_bf16 v[104:107], v[32:35], a[64:71], v6
v_smfmac_f32_16x16x64_bf16 v[108:111], v[32:35], a[96:103], v6
s_branch mega_kernel_rf_pa_12_2
mega_kernel_rf_il26:
s_cbranch_execz mega_kernel_rf_il27
.p2align 5
mega_kernel_rf_pa_13_2f:
s_mov_b64 exec, vcc
buffer_load_dwordx4 v[40:43], v7, s[84:87], s33 offen offset:2048 sc1
s_mov_b64 exec, -1
s_branch mega_kernel_rf_pa_13_3
.p2align 5
mega_kernel_rf_pa_13_2:
s_waitcnt vmcnt(2)
v_max_u32 v4, v40, v42
v_cmp_eq_u32 vcc, -1, v4
s_cbranch_vccnz mega_kernel_rf_pa_13_2f
v_smfmac_f32_16x16x64_bf16 v[96:99], v[40:43], a[16:23], v6
v_smfmac_f32_16x16x64_bf16 v[100:103], v[40:43], a[48:55], v6
v_smfmac_f32_16x16x64_bf16 v[104:107], v[40:43], a[80:87], v6
v_smfmac_f32_16x16x64_bf16 v[108:111], v[40:43], a[112:119], v6
s_branch mega_kernel_rf_pa_9_3
mega_kernel_rf_il27:
s_cbranch_execz mega_kernel_rf_il28
.p2align 5
mega_kernel_rf_pa_13_3f:
s_mov_b64 exec, vcc
buffer_load_dwordx4 v[44:47], v7, s[84:87], s33 offen offset:3072 sc1
s_mov_b64 exec, -1
s_branch mega_kernel_rf_pa_13_0
.p2align 5
mega_kernel_rf_pa_13_3:
s_waitcnt vmcnt(2)
v_max_u32 v4, v44, v46
v_cmp_eq_u32 vcc, -1, v4
s_cbranch_vccnz mega_kernel_rf_pa_13_3f
v_smfmac_f32_16x16x64_bf16 v[96:99], v[44:47], a[24:31], v6
v_smfmac_f32_16x16x64_bf16 v[100:103], v[44:47], a[56:63], v6
v_smfmac_f32_16x16x64_bf16 v[104:107], v[44:47], a[88:95], v6
v_smfmac_f32_16x16x64_bf16 v[108:111], v[44:47], a[120:127], v6
s_branch mega_kernel_rf_pa_5_0
mega_kernel_rf_il28:
s_cbranch_execz mega_kernel_rf_il29
.p2align 5
mega_kernel_rf_pa_14_1f:
s_mov_b64 exec, vcc
buffer_load_dwordx4 v[36:39], v7, s[84:87], s33 offen offset:1024 sc1
s_mov_b64 exec, -1
s_branch mega_kernel_rf_pa_14_2
.p2align 5
mega_kernel_rf_pa_14_1:
s_waitcnt vmcnt(2)
v_max_u32 v4, v36, v38
v_cmp_eq_u32 vcc, -1, v4
s_cbranch_vccnz mega_kernel_rf_pa_14_1f
v_smfmac_f32_16x16x64_bf16 v[96:99], v[36:39], a[8:15], v6
v_smfmac_f32_16x16x64_bf16 v[100:103], v[36:39], a[40:47], v6
v_smfmac_f32_16x16x64_bf16 v[104:107], v[36:39], a[72:79], v6
v_smfmac_f32_16x16x64_bf16 v[108:111], v[36:39], a[104:111], v6
s_branch mega_kernel_rf_pa_12_2
mega_kernel_rf_il29:
s_cbranch_execz mega_kernel_rf_il30
.p2align 5
mega_kernel_rf_pa_14_2f:
s_mov_b64 exec, vcc
buffer_load_dwordx4 v[40:43], v7, s[84:87], s33 offen offset:2048 sc1
s_mov_b64 exec, -1
s_branch mega_kernel_rf_pa_14_3
.p2align 5
mega_kernel_rf_pa_14_2:
s_waitcnt vmcnt(2)
v_max_u32 v4, v40, v42
v_cmp_eq_u32 vcc, -1, v4
s_cbranch_vccnz mega_kernel_rf_pa_14_2f
v_smfmac_f32_16x16x64_bf16 v[96:99], v[40:43], a[16:23], v6
v_smfmac_f32_16x16x64_bf16 v[100:103], v[40:43], a[48:55], v6
v_smfmac_f32_16x16x64_bf16 v[104:107], v[40:43], a[80:87], v6
v_smfmac_f32_16x16x64_bf16 v[108:111], v[40:43], a[112:119], v6
s_branch mega_kernel_rf_pa_10_3
mega_kernel_rf_il30:
s_cbranch_execz mega_kernel_rf_il31
.p2align 5
mega_kernel_rf_pa_14_3f:
s_mov_b64 exec, vcc
buffer_load_dwordx4 v[44:47], v7, s[84:87], s33 offen offset:3072 sc1
s_mov_b64 exec, -1
s_branch mega_kernel_rf_pa_14_1
.p2align 5
mega_kernel_rf_pa_14_3:
s_waitcnt vmcnt(2)
v_max_u32 v4, v44, v46
v_cmp_eq_u32 vcc, -1, v4
s_cbranch_vccnz mega_kernel_rf_pa_14_3f
v_smfmac_f32_16x16x64_bf16 v[96:99], v[44:47], a[24:31], v6
v_smfmac_f32_16x16x64_bf16 v[100:103], v[44:47], a[56:63], v6
v_smfmac_f32_16x16x64_bf16 v[104:107], v[44:47], a[88:95], v6
v_smfmac_f32_16x16x64_bf16 v[108:111], v[44:47], a[120:127], v6
s_branch mega_kernel_rf_pa_6_1
mega_kernel_rf_il31:
s_cbranch_execz mega_kernel_rf_il32
.p2align 5
mega_kernel_rf_pa_15_0f:
s_mov_b64 exec, vcc
buffer_load_dwordx4 v[32:35], v7, s[84:87], s33 offen offset:0 sc1
s_mov_b64 exec, -1
s_branch mega_kernel_rf_pa_15_1
.p2align 5
mega_kernel_rf_pa_15_0:
s_waitcnt vmcnt(3)
v_max_u32 v4, v32, v34
v_cmp_eq_u32 vcc, -1, v4
s_cbranch_vccnz mega_kernel_rf_pa_15_0f
v_smfmac_f32_16x16x64_bf16 v[96:99], v[32:35], a[0:7], v6
v_smfmac_f32_16x16x64_bf16 v[100:103], v[32:35], a[32:39], v6
v_smfmac_f32_16x16x64_bf16 v[104:107], v[32:35], a[64:71], v6
v_smfmac_f32_16x16x64_bf16 v[108:111], v[32:35], a[96:103], v6
s_branch mega_kernel_rf_pa_14_1
mega_kernel_rf_il32:
s_cbranch_execz mega_kernel_rf_il33
.p2align 5
mega_kernel_rf_pa_15_1f:
s_mov_b64 exec, vcc
buffer_load_dwordx4 v[36:39], v7, s[84:87], s33 offen offset:1024 sc1
s_mov_b64 exec, -1
s_branch mega_kernel_rf_pa_15_2
.p2align 5
mega_kernel_rf_pa_15_1:
s_waitcnt vmcnt(3)
v_max_u32 v4, v36, v38
v_cmp_eq_u32 vcc, -1, v4
s_cbranch_vccnz mega_kernel_rf_pa_15_1f
v_smfmac_f32_16x16x64_bf16 v[96:99], v[36:39], a[8:15], v6
v_smfmac_f32_16x16x64_bf16 v[100:103], v[36:39], a[40:47], v6
v_smfmac_f32_16x16x64_bf16 v[104:107], v[36:39], a[72:79], v6
v_smfmac_f32_16x16x64_bf16 v[108:111], v[36:39], a[104:111], v6
s_branch mega_kernel_rf_pa_13_2
mega_kernel_rf_il33:
s_cbranch_execz mega_kernel_rf_il34
.p2align 5
mega_kernel_rf_pa_15_2f:
s_mov_b64 exec, vcc
buffer_load_dwordx4 v[40:43], v7, s[84:87], s33 offen offset:2048 sc1
s_mov_b64 exec, -1
s_branch mega_kernel_rf_pa_15_3
.p2align 5
mega_kernel_rf_pa_15_2:
s_waitcnt vmcnt(3)
v_max_u32 v4, v40, v42
v_cmp_eq_u32 vcc, -1, v4
s_cbranch_vccnz mega_kernel_rf_pa_15_2f
v_smfmac_f32_16x16x64_bf16 v[96:99], v[40:43], a[16:23], v6
v_smfmac_f32_16x16x64_bf16 v[100:103], v[40:43], a[48:55], v6
v_smfmac_f32_16x16x64_bf16 v[104:107], v[40:43], a[80:87], v6
v_smfmac_f32_16x16x64_bf16 v[108:111], v[40:43], a[112:119], v6
s_branch mega_kernel_rf_pa_11_3
mega_kernel_rf_il34:
s_cbranch_execz mega_kernel_rf_il35
.p2align 5
mega_kernel_rf_pa_15_3f:
s_mov_b64 exec, vcc
buffer_load_dwordx4 v[44:47], v7, s[84:87], s33 offen offset:3072 sc1
s_mov_b64 exec, -1
s_branch mega_kernel_rf_pa_15_0
.p2align 5
mega_kernel_rf_pa_15_3:
s_waitcnt vmcnt(3)
v_max_u32 v4, v44, v46
v_cmp_eq_u32 vcc, -1, v4
s_cbranch_vccnz mega_kernel_rf_pa_15_3f
v_smfmac_f32_16x16x64_bf16 v[96:99], v[44:47], a[24:31], v6
v_smfmac_f32_16x16x64_bf16 v[100:103], v[44:47], a[56:63], v6
v_smfmac_f32_16x16x64_bf16 v[104:107], v[44:47], a[88:95], v6
v_smfmac_f32_16x16x64_bf16 v[108:111], v[44:47], a[120:127], v6
s_branch mega_kernel_rf_pa_7_0
mega_kernel_rf_il35:
s_cbranch_execz mega_kernel_rf_il36
.p2align 5
mega_kernel_rf_pc_1_0f:
s_mov_b64 exec, vcc
buffer_load_dwordx4 v[32:35], v7, s[84:87], s29 offen offset:0 sc1
s_mov_b64 exec, -1
s_branch mega_kernel_rf_pc_1_0
.p2align 5
mega_kernel_rf_pc_1_0:
s_waitcnt vmcnt(0)
v_cmp_eq_u32 vcc, -1, v32
s_cbranch_vccnz mega_kernel_rf_pc_1_0f
v_smfmac_f32_16x16x64_bf16 v[96:99], v[32:35], a[192:199], v6
v_smfmac_f32_16x16x64_bf16 v[100:103], v[32:35], a[224:231], v6
s_branch mega_kernel_rf_pc_d
mega_kernel_rf_il36:
s_cbranch_execz mega_kernel_rf_il37
.p2align 5
mega_kernel_rf_pc_2_1f:
s_mov_b64 exec, vcc
buffer_load_dwordx4 v[36:39], v7, s[84:87], s29 offen offset:1024 sc1
s_mov_b64 exec, -1
s_branch mega_kernel_rf_pc_2_1
mega_kernel_rf_il37:
s_cbranch_execz mega_kernel_rf_iwd
.p2align 5
mega_kernel_rf_pc_2_1:
s_waitcnt vmcnt(0)
v_cmp_eq_u32 vcc, -1, v36
s_cbranch_vccnz mega_kernel_rf_pc_2_1f
v_smfmac_f32_16x16x64_bf16 v[96:99], v[36:39], a[200:207], v6
v_smfmac_f32_16x16x64_bf16 v[100:103], v[36:39], a[232:239], v6
s_branch mega_kernel_rf_pc_d
.p2align 5
mega_kernel_rf_pc_3_0f:
s_mov_b64 exec, vcc
buffer_load_dwordx4 v[32:35], v7, s[84:87], s29 offen offset:0 sc1
s_mov_b64 exec, -1
s_branch mega_kernel_rf_pc_3_1
mega_kernel_rf_iw2:
mega_kernel_rf_il38:
s_cbranch_execz mega_kernel_rf_il39
.p2align 5
mega_kernel_rf_pc_3_0:
s_waitcnt vmcnt(1)
v_cmp_eq_u32 vcc, -1, v32
s_cbranch_vccnz mega_kernel_rf_pc_3_0f
v_smfmac_f32_16x16x64_bf16 v[96:99], v[32:35], a[192:199], v6
v_smfmac_f32_16x16x64_bf16 v[100:103], v[32:35], a[224:231], v6
s_branch mega_kernel_rf_pc_2_1
.p2align 5
mega_kernel_rf_pc_3_1f:
s_mov_b64 exec, vcc
buffer_load_dwordx4 v[36:39], v7, s[84:87], s29 offen offset:1024 sc1
s_mov_b64 exec, -1
s_branch mega_kernel_rf_pc_3_0
mega_kernel_rf_il39:
s_cbranch_execz mega_kernel_rf_il40
.p2align 5
mega_kernel_rf_pc_3_1:
s_waitcnt vmcnt(1)
v_cmp_eq_u32 vcc, -1, v36
s_cbranch_vccnz mega_kernel_rf_pc_3_1f
v_smfmac_f32_16x16x64_bf16 v[96:99], v[36:39], a[200:207], v6
v_smfmac_f32_16x16x64_bf16 v[100:103], v[36:39], a[232:239], v6
s_branch mega_kernel_rf_pc_1_0
.p2align 5
mega_kernel_rf_pc_4_2f:
s_mov_b64 exec, vcc
buffer_load_dwordx4 v[40:43], v7, s[84:87], s29 offen offset:2048 sc1
s_mov_b64 exec, -1
s_branch mega_kernel_rf_pc_4_2
mega_kernel_rf_il40:
s_cbranch_execz mega_kernel_rf_il41
.p2align 5
mega_kernel_rf_pc_4_2:
s_waitcnt vmcnt(0)
v_cmp_eq_u32 vcc, -1, v40
s_cbranch_vccnz mega_kernel_rf_pc_4_2f
v_smfmac_f32_16x16x64_bf16 v[96:99], v[40:43], a[208:215], v6
v_smfmac_f32_16x16x64_bf16 v[100:103], v[40:43], a[240:247], v6
s_branch mega_kernel_rf_pc_d
.p2align 5
mega_kernel_rf_pc_5_0f:
s_mov_b64 exec, vcc
buffer_load_dwordx4 v[32:35], v7, s[84:87], s29 offen offset:0 sc1
s_mov_b64 exec, -1
s_branch mega_kernel_rf_pc_5_2
mega_kernel_rf_il41:
s_cbranch_execz mega_kernel_rf_il42
.p2align 5
mega_kernel_rf_pc_5_0:
s_waitcnt vmcnt(1)
v_cmp_eq_u32 vcc, -1, v32
s_cbranch_vccnz mega_kernel_rf_pc_5_0f
v_smfmac_f32_16x16x64_bf16 v[96:99], v[32:35], a[192:199], v6
v_smfmac_f32_16x16x64_bf16 v[100:103], v[32:35], a[224:231], v6
s_branch mega_kernel_rf_pc_4_2
.p2align 5
mega_kernel_rf_pc_5_2f:
s_mov_b64 exec, vcc
buffer_load_dwordx4 v[40:43], v7, s[84:87], s29 offen offset:2048 sc1
s_mov_b64 exec, -1
s_branch mega_kernel_rf_pc_5_0
mega_kernel_rf_il42:
s_cbranch_execz mega_kernel_rf_il43
.p2align 5
mega_kernel_rf_pc_5_2:
s_waitcnt vmcnt(1)
v_cmp_eq_u32 vcc, -1, v40
s_cbranch_vccnz mega_kernel_rf_pc_5_2f
v_smfmac_f32_16x16x64_bf16 v[96:99], v[40:43], a[208:215], v6
v_smfmac_f32_16x16x64_bf16 v[100:103], v[40:43], a[240:247], v6
s_branch mega_kernel_rf_pc_1_0
.p2align 5
mega_kernel_rf_pc_6_1f:
s_mov_b64 exec, vcc
buffer_load_dwordx4 v[36:39], v7, s[84:87], s29 offen offset:1024 sc1
s_mov_b64 exec, -1
s_branch mega_kernel_rf_pc_6_2
mega_kernel_rf_il43:
s_cbranch_execz mega_kernel_rf_il44
.p2align 5
mega_kernel_rf_pc_6_1:
s_waitcnt vmcnt(1)
v_cmp_eq_u32 vcc, -1, v36
s_cbranch_vccnz mega_kernel_rf_pc_6_1f
v_smfmac_f32_16x16x64_bf16 v[96:99], v[36:39], a[200:207], v6
v_smfmac_f32_16x16x64_bf16 v[100:103], v[36:39], a[232:239], v6
s_branch mega_kernel_rf_pc_4_2
.p2align 5
mega_kernel_rf_pc_6_2f:
s_mov_b64 exec, vcc
buffer_load_dwordx4 v[40:43], v7, s[84:87], s29 offen offset:2048 sc1
s_mov_b64 exec, -1
s_branch mega_kernel_rf_pc_6_1
mega_kernel_rf_il44:
s_cbranch_execz mega_kernel_rf_il45
.p2align 5
mega_kernel_rf_pc_6_2:
s_waitcnt vmcnt(1)
v_cmp_eq_u32 vcc, -1, v40
s_cbranch_vccnz mega_kernel_rf_pc_6_2f
v_smfmac_f32_16x16x64_bf16 v[96:99], v[40:43], a[208:215], v6
v_smfmac_f32_16x16x64_bf16 v[100:103], v[40:43], a[240:247], v6
s_branch mega_kernel_rf_pc_2_1
.p2align 5
mega_kernel_rf_pc_7_0f:
s_mov_b64 exec, vcc
buffer_load_dwordx4 v[32:35], v7, s[84:87], s29 offen offset:0 sc1
s_mov_b64 exec, -1
s_branch mega_kernel_rf_pc_7_1
mega_kernel_rf_il45:
s_cbranch_execz mega_kernel_rf_il46
.p2align 5
mega_kernel_rf_pc_7_0:
s_waitcnt vmcnt(2)
v_cmp_eq_u32 vcc, -1, v32
s_cbranch_vccnz mega_kernel_rf_pc_7_0f
v_smfmac_f32_16x16x64_bf16 v[96:99], v[32:35], a[192:199], v6
v_smfmac_f32_16x16x64_bf16 v[100:103], v[32:35], a[224:231], v6
s_branch mega_kernel_rf_pc_6_1
.p2align 5
mega_kernel_rf_pc_7_1f:
s_mov_b64 exec, vcc
buffer_load_dwordx4 v[36:39], v7, s[84:87], s29 offen offset:1024 sc1
s_mov_b64 exec, -1
s_branch mega_kernel_rf_pc_7_2
mega_kernel_rf_il46:
s_cbranch_execz mega_kernel_rf_il47
.p2align 5
mega_kernel_rf_pc_7_1:
s_waitcnt vmcnt(2)
v_cmp_eq_u32 vcc, -1, v36
s_cbranch_vccnz mega_kernel_rf_pc_7_1f
v_smfmac_f32_16x16x64_bf16 v[96:99], v[36:39], a[200:207], v6
v_smfmac_f32_16x16x64_bf16 v[100:103], v[36:39], a[232:239], v6
s_branch mega_kernel_rf_pc_5_2
.p2align 5
mega_kernel_rf_pc_7_2f:
s_mov_b64 exec, vcc
buffer_load_dwordx4 v[40:43], v7, s[84:87], s29 offen offset:2048 sc1
s_mov_b64 exec, -1
s_branch mega_kernel_rf_pc_7_0
mega_kernel_rf_il47:
s_cbranch_execz mega_kernel_rf_il48
.p2align 5
mega_kernel_rf_pc_7_2:
s_waitcnt vmcnt(2)
v_cmp_eq_u32 vcc, -1, v40
s_cbranch_vccnz mega_kernel_rf_pc_7_2f
v_smfmac_f32_16x16x64_bf16 v[96:99], v[40:43], a[208:215], v6
v_smfmac_f32_16x16x64_bf16 v[100:103], v[40:43], a[240:247], v6
s_branch mega_kernel_rf_pc_3_0
.p2align 5
mega_kernel_rf_pc_8_3f:
s_mov_b64 exec, vcc
buffer_load_dwordx4 v[44:47], v7, s[84:87], s29 offen offset:3072 sc1
s_mov_b64 exec, -1
s_branch mega_kernel_rf_pc_8_3
mega_kernel_rf_il48:
s_cbranch_execz mega_kernel_rf_il49
.p2align 5
mega_kernel_rf_pc_9_0f:
s_mov_b64 exec, vcc
buffer_load_dwordx4 v[32:35], v7, s[84:87], s29 offen offset:0 sc1
s_mov_b64 exec, -1
s_branch mega_kernel_rf_pc_9_3
.p2align 5
mega_kernel_rf_pc_9_0:
s_waitcnt vmcnt(1)
v_cmp_eq_u32 vcc, -1, v32
s_cbranch_vccnz mega_kernel_rf_pc_9_0f
v_smfmac_f32_16x16x64_bf16 v[96:99], v[32:35], a[192:199], v6
v_smfmac_f32_16x16x64_bf16 v[100:103], v[32:35], a[224:231], v6
s_branch mega_kernel_rf_pc_8_3
mega_kernel_rf_il49:
s_cbranch_execz mega_kernel_rf_il50
.p2align 5
mega_kernel_rf_pc_9_3f:
s_mov_b64 exec, vcc
buffer_load_dwordx4 v[44:47], v7, s[84:87], s29 offen offset:3072 sc1
s_mov_b64 exec, -1
s_branch mega_kernel_rf_pc_9_0
mega_kernel_rf_il50:
s_cbranch_execz mega_kernel_rf_il51
.p2align 5
mega_kernel_rf_pc_9_3:
s_waitcnt vmcnt(1)
v_cmp_eq_u32 vcc, -1, v44
s_cbranch_vccnz mega_kernel_rf_pc_9_3f
v_smfmac_f32_16x16x64_bf16 v[96:99], v[44:47], a[216:223], v6
v_smfmac_f32_16x16x64_bf16 v[100:103], v[44:47], a[248:255], v6
s_branch mega_kernel_rf_pc_1_0
.p2align 5
mega_kernel_rf_pc_10_1f:
s_mov_b64 exec, vcc
buffer_load_dwordx4 v[36:39], v7, s[84:87], s29 offen offset:1024 sc1
s_mov_b64 exec, -1
s_branch mega_kernel_rf_pc_10_3
mega_kernel_rf_il51:
s_cbranch_execz mega_kernel_rf_il52
.p2align 5
mega_kernel_rf_pc_10_1:
s_waitcnt vmcnt(1)
v_cmp_eq_u32 vcc, -1, v36
s_cbranch_vccnz mega_kernel_rf_pc_10_1f
v_smfmac_f32_16x16x64_bf16 v[96:99], v[36:39], a[200:207], v6
v_smfmac_f32_16x16x64_bf16 v[100:103], v[36:39], a[232:239], v6
s_branch mega_kernel_rf_pc_8_3
.p2align 5
mega_kernel_rf_pc_10_3f:
s_mov_b64 exec, vcc
buffer_load_dwordx4 v[44:47], v7, s[84:87], s29 offen offset:3072 sc1
s_mov_b64 exec, -1
s_branch mega_kernel_rf_pc_10_1
mega_kernel_rf_il52:
s_cbranch_execz mega_kernel_rf_il53
.p2align 5
mega_kernel_rf_pc_10_3:
s_waitcnt vmcnt(1)
v_cmp_eq_u32 vcc, -1, v44
s_cbranch_vccnz mega_kernel_rf_pc_10_3f
v_smfmac_f32_16x16x64_bf16 v[96:99], v[44:47], a[216:223], v6
v_smfmac_f32_16x16x64_bf16 v[100:103], v[44:47], a[248:255], v6
s_branch mega_kernel_rf_pc_2_1
.p2align 5
mega_kernel_rf_pc_11_0f:
s_mov_b64 exec, vcc
buffer_load_dwordx4 v[32:35], v7, s[84:87], s29 offen offset:0 sc1
s_mov_b64 exec, -1
s_branch mega_kernel_rf_pc_11_1
mega_kernel_rf_il53:
s_cbranch_execz mega_kernel_rf_il54
.p2align 5
mega_kernel_rf_pc_11_0:
s_waitcnt vmcnt(2)
v_cmp_eq_u32 vcc, -1, v32
s_cbranch_vccnz mega_kernel_rf_pc_11_0f
v_smfmac_f32_16x16x64_bf16 v[96:99], v[32:35], a[192:199], v6
v_smfmac_f32_16x16x64_bf16 v[100:103], v[32:35], a[224:231], v6
s_branch mega_kernel_rf_pc_10_1
.p2align 5
mega_kernel_rf_pc_11_1f:
s_mov_b64 exec, vcc
buffer_load_dwordx4 v[36:39], v7, s[84:87], s29 offen offset:1024 sc1
s_mov_b64 exec, -1
s_branch mega_kernel_rf_pc_11_3
mega_kernel_rf_il54:
s_cbranch_execz mega_kernel_rf_il55
.p2align 5
mega_kernel_rf_pc_11_1:
s_waitcnt vmcnt(2)
v_cmp_eq_u32 vcc, -1, v36
s_cbranch_vccnz mega_kernel_rf_pc_11_1f
v_smfmac_f32_16x16x64_bf16 v[96:99], v[36:39], a[200:207], v6
v_smfmac_f32_16x16x64_bf16 v[100:103], v[36:39], a[232:239], v6
s_branch mega_kernel_rf_pc_9_3
.p2align 5
mega_kernel_rf_pc_11_3f:
s_mov_b64 exec, vcc
buffer_load_dwordx4 v[44:47], v7, s[84:87], s29 offen offset:3072 sc1
s_mov_b64 exec, -1
s_branch mega_kernel_rf_pc_11_0
mega_kernel_rf_il55:
s_cbranch_execz mega_kernel_rf_il56
.p2align 5
mega_kernel_rf_pc_11_3:
s_waitcnt vmcnt(2)
v_cmp_eq_u32 vcc, -1, v44
s_cbranch_vccnz mega_kernel_rf_pc_11_3f
v_smfmac_f32_16x16x64_bf16 v[96:99], v[44:47], a[216:223], v6
v_smfmac_f32_16x16x64_bf16 v[100:103], v[44:47], a[248:255], v6
s_branch mega_kernel_rf_pc_3_0
.p2align 5
mega_kernel_rf_pc_12_2f:
s_mov_b64 exec, vcc
buffer_load_dwordx4 v[40:43], v7, s[84:87], s29 offen offset:2048 sc1
s_mov_b64 exec, -1
s_branch mega_kernel_rf_pc_12_3
mega_kernel_rf_il56:
s_cbranch_execz mega_kernel_rf_iwd
.p2align 5
mega_kernel_rf_pc_12_3f:
s_mov_b64 exec, vcc
buffer_load_dwordx4 v[44:47], v7, s[84:87], s29 offen offset:3072 sc1
s_mov_b64 exec, -1
s_branch mega_kernel_rf_pc_12_2
.p2align 5
mega_kernel_rf_pc_12_3:
s_waitcnt vmcnt(1)
v_cmp_eq_u32 vcc, -1, v44
s_cbranch_vccnz mega_kernel_rf_pc_12_3f
v_smfmac_f32_16x16x64_bf16 v[96:99], v[44:47], a[216:223], v6
v_smfmac_f32_16x16x64_bf16 v[100:103], v[44:47], a[248:255], v6
s_branch mega_kernel_rf_pc_4_2
mega_kernel_rf_iw3:
mega_kernel_rf_il57:
s_cbranch_execz mega_kernel_rf_il58
.p2align 5
mega_kernel_rf_pc_13_0f:
s_mov_b64 exec, vcc
buffer_load_dwordx4 v[32:35], v7, s[84:87], s29 offen offset:0 sc1
s_mov_b64 exec, -1
s_branch mega_kernel_rf_pc_13_2
mega_kernel_rf_il58:
s_cbranch_execz mega_kernel_rf_il59
.p2align 5
mega_kernel_rf_pc_13_0:
s_waitcnt vmcnt(2)
v_cmp_eq_u32 vcc, -1, v32
s_cbranch_vccnz mega_kernel_rf_pc_13_0f
v_smfmac_f32_16x16x64_bf16 v[96:99], v[32:35], a[192:199], v6
v_smfmac_f32_16x16x64_bf16 v[100:103], v[32:35], a[224:231], v6
s_branch mega_kernel_rf_pc_12_2
.p2align 5
mega_kernel_rf_pc_13_2f:
s_mov_b64 exec, vcc
buffer_load_dwordx4 v[40:43], v7, s[84:87], s29 offen offset:2048 sc1
s_mov_b64 exec, -1
s_branch mega_kernel_rf_pc_13_3
mega_kernel_rf_il59:
s_cbranch_execz mega_kernel_rf_il60
.p2align 5
mega_kernel_rf_pc_13_2:
s_waitcnt vmcnt(2)
v_cmp_eq_u32 vcc, -1, v40
s_cbranch_vccnz mega_kernel_rf_pc_13_2f
v_smfmac_f32_16x16x64_bf16 v[96:99], v[40:43], a[208:215], v6
v_smfmac_f32_16x16x64_bf16 v[100:103], v[40:43], a[240:247], v6
s_branch mega_kernel_rf_pc_9_3
.p2align 5
mega_kernel_rf_pc_13_3f:
s_mov_b64 exec, vcc
buffer_load_dwordx4 v[44:47], v7, s[84:87], s29 offen offset:3072 sc1
s_mov_b64 exec, -1
s_branch mega_kernel_rf_pc_13_0
mega_kernel_rf_il60:
s_cbranch_execz mega_kernel_rf_il61
.p2align 5
mega_kernel_rf_pc_13_3:
s_waitcnt vmcnt(2)
v_cmp_eq_u32 vcc, -1, v44
s_cbranch_vccnz mega_kernel_rf_pc_13_3f
v_smfmac_f32_16x16x64_bf16 v[96:99], v[44:47], a[216:223], v6
v_smfmac_f32_16x16x64_bf16 v[100:103], v[44:47], a[248:255], v6
s_branch mega_kernel_rf_pc_5_0
.p2align 5
mega_kernel_rf_pc_14_1f:
s_mov_b64 exec, vcc
buffer_load_dwordx4 v[36:39], v7, s[84:87], s29 offen offset:1024 sc1
s_mov_b64 exec, -1
s_branch mega_kernel_rf_pc_14_2
mega_kernel_rf_il61:
s_cbranch_execz mega_kernel_rf_il62
.p2align 5
mega_kernel_rf_pc_14_2f:
s_mov_b64 exec, vcc
buffer_load_dwordx4 v[40:43], v7, s[84:87], s29 offen offset:2048 sc1
s_mov_b64 exec, -1
s_branch mega_kernel_rf_pc_14_3
.p2align 5
mega_kernel_rf_pc_14_2:
s_waitcnt vmcnt(2)
v_cmp_eq_u32 vcc, -1, v40
s_cbranch_vccnz mega_kernel_rf_pc_14_2f
v_smfmac_f32_16x16x64_bf16 v[96:99], v[40:43], a[208:215], v6
v_smfmac_f32_16x16x64_bf16 v[100:103], v[40:43], a[240:247], v6
s_branch mega_kernel_rf_pc_10_3
mega_kernel_rf_il62:
s_cbranch_execz mega_kernel_rf_il63
.p2align 5
mega_kernel_rf_pc_14_3f:
s_mov_b64 exec, vcc
buffer_load_dwordx4 v[44:47], v7, s[84:87], s29 offen offset:3072 sc1
s_mov_b64 exec, -1
s_branch mega_kernel_rf_pc_14_1
mega_kernel_rf_il63:
s_cbranch_execz mega_kernel_rf_il64
.p2align 5
mega_kernel_rf_pc_14_3:
s_waitcnt vmcnt(2)
v_cmp_eq_u32 vcc, -1, v44
s_cbranch_vccnz mega_kernel_rf_pc_14_3f
v_smfmac_f32_16x16x64_bf16 v[96:99], v[44:47], a[216:223], v6
v_smfmac_f32_16x16x64_bf16 v[100:103], v[44:47], a[248:255], v6
s_branch mega_kernel_rf_pc_6_1
.p2align 5
mega_kernel_rf_pc_15_0f:
s_mov_b64 exec, vcc
buffer_load_dwordx4 v[32:35], v7, s[84:87], s29 offen offset:0 sc1
s_mov_b64 exec, -1
s_branch mega_kernel_rf_pc_15_1
mega_kernel_rf_il64:
s_cbranch_execz mega_kernel_rf_il65
.p2align 5
mega_kernel_rf_pc_15_1f:
s_mov_b64 exec, vcc
buffer_load_dwordx4 v[36:39], v7, s[84:87], s29 offen offset:1024 sc1
s_mov_b64 exec, -1
s_branch mega_kernel_rf_pc_15_2
.p2align 5
mega_kernel_rf_pc_15_1:
s_waitcnt vmcnt(3)
v_cmp_eq_u32 vcc, -1, v36
s_cbranch_vccnz mega_kernel_rf_pc_15_1f
v_smfmac_f32_16x16x64_bf16 v[96:99], v[36:39], a[200:207], v6
v_smfmac_f32_16x16x64_bf16 v[100:103], v[36:39], a[232:239], v6
s_branch mega_kernel_rf_pc_13_2
mega_kernel_rf_il65:
s_cbranch_execz mega_kernel_rf_il66
.p2align 5
mega_kernel_rf_pc_15_2f:
s_mov_b64 exec, vcc
buffer_load_dwordx4 v[40:43], v7, s[84:87], s29 offen offset:2048 sc1
s_mov_b64 exec, -1
s_branch mega_kernel_rf_pc_15_3
mega_kernel_rf_il66:
s_cbranch_execz mega_kernel_rf_il67
.p2align 5
mega_kernel_rf_pc_15_2:
s_waitcnt vmcnt(3)
v_cmp_eq_u32 vcc, -1, v40
s_cbranch_vccnz mega_kernel_rf_pc_15_2f
v_smfmac_f32_16x16x64_bf16 v[96:99], v[40:43], a[208:215], v6
v_smfmac_f32_16x16x64_bf16 v[100:103], v[40:43], a[240:247], v6
s_branch mega_kernel_rf_pc_11_3
.p2align 5
mega_kernel_rf_pc_15_3f:
s_mov_b64 exec, vcc
buffer_load_dwordx4 v[44:47], v7, s[84:87], s29 offen offset:3072 sc1
s_mov_b64 exec, -1
s_branch mega_kernel_rf_pc_15_0
mega_kernel_rf_il67:
s_cbranch_execz mega_kernel_rf_il68
.p2align 5
mega_kernel_rf_pc_15_3:
s_waitcnt vmcnt(3)
v_cmp_eq_u32 vcc, -1, v44
s_cbranch_vccnz mega_kernel_rf_pc_15_3f
v_smfmac_f32_16x16x64_bf16 v[96:99], v[44:47], a[216:223], v6
v_smfmac_f32_16x16x64_bf16 v[100:103], v[44:47], a[248:255], v6
s_branch mega_kernel_rf_pc_7_0
mega_kernel_rf_w0last:
s_nop 7
v_permlane32_swap_b32 v112, v116
v_permlane32_swap_b32 v113, v117
v_permlane32_swap_b32 v114, v118
v_permlane32_swap_b32 v115, v119
v_pk_add_f32 v[112:113], v[112:113], v[116:117]
v_pk_add_f32 v[114:115], v[114:115], v[118:119]
ds_write_b128 v20, v[112:115]
s_waitcnt lgkmcnt(0)
s_barrier
s_branch mega_kernel_rf_end
mega_kernel_rf_il68:
s_cbranch_execz mega_kernel_rf_il69
mega_kernel_rf_side:
s_cmp_eq_u32 s24, 3
s_cbranch_scc1 mega_kernel_rf_sd3
s_cmp_eq_u32 s24, 2
s_cbranch_scc0 mega_kernel_rf_sd4
s_mov_b64 exec, s[40:41]
buffer_store_dwordx4 v[28:31], v11, s[84:87], s34 offen
s_mov_b64 exec, -1
buffer_store_dwordx2 v[28:29], v9, s[84:87], s34 offen
s_mul_i32 s28, s31, 1280
s_add_u32 s28, s28, s34
s_add_u32 s28, s28, 49152
buffer_store_dwordx4 v[28:31], v17, s[84:87], s28 offen
buffer_store_dwordx4 v[28:31], v10, s[84:87], s28 offen
s_branch mega_kernel_rf_sd4
mega_kernel_rf_il69:
s_cbranch_execz mega_kernel_rf_il70
mega_kernel_rf_sd3:
v_readlane_b32 s76, v249, 0
v_readlane_b32 s77, v249, 1
s_min_i32 s76, s76, s77
s_max_i32 s46, s46, s76
s_mov_b32 s36, 0
s_add_u32 s76, s27, 1
s_cmp_lt_u32 s76, 63
s_cbranch_scc0 mega_kernel_rf_sd4
s_cmp_ge_u32 s76, 0
s_cbranch_scc0 mega_kernel_rf_sd4
s_cmp_gt_i32 s46, s76
s_cselect_b32 s36, 0, 1
s_cbranch_scc0 mega_kernel_rf_sd4
s_add_u32 s77, s76, s82
s_bfe_u32 s28, s77, 0x40002
s_lshl_b32 s28, s28, 14
s_and_b32 s77, s77, 3
s_lshl_b32 s77, s77, 11
s_add_u32 s28, s28, s77
s_add_u32 m0, s45, 0
s_nop 0
buffer_load_dwordx4 v240, s[84:87], s28 offen offset:0 sc1 lds
s_add_u32 m0, s45, 0
s_nop 0
buffer_load_dwordx4 v240, s[84:87], s28 offen offset:1024 sc1 lds
s_add_u32 m0, s45, 2048
s_nop 0
buffer_load_dwordx4 v241, s[84:87], s28 offen offset:0 sc1 lds
s_add_u32 m0, s45, 2048
s_nop 0
buffer_load_dwordx4 v241, s[84:87], s28 offen offset:1024 sc1 lds
s_add_u32 s45, s45, 4096
s_cmp_eq_u32 s45, 30720
s_cselect_b32 s45, 18432, s45
mega_kernel_rf_sd4:
v_smfmac_f32_16x16x64_bf16 v[112:115], v[40:43], a[144:151], v6
v_smfmac_f32_16x16x64_bf16 v[116:119], v[40:43], a[176:183], v6
v_smfmac_f32_16x16x64_bf16 v[112:115], v[44:47], a[152:159], v6
v_smfmac_f32_16x16x64_bf16 v[116:119], v[44:47], a[184:191], v6
s_nop 7
v_permlane32_swap_b32 v112, v116
v_permlane32_swap_b32 v113, v117
v_permlane32_swap_b32 v114, v118
v_permlane32_swap_b32 v115, v119
v_pk_add_f32 v[112:113], v[112:113], v[116:117]
v_pk_add_f32 v[114:115], v[114:115], v[118:119]
ds_write_b128 v20, v[112:115]
v_mov_b32 v96, 0
v_mov_b32 v97, 0
v_mov_b32 v98, 0
v_mov_b32 v99, 0
v_mov_b32 v100, 0
v_mov_b32 v101, 0
v_mov_b32 v102, 0
v_mov_b32 v103, 0
s_cmp_eq_u32 s24, 1
s_cbranch_scc0 mega_kernel_rf_s1
s_waitcnt lgkmcnt(0)
ds_read_b128 v[120:123], v16 offset:0
ds_read_b128 v[124:127], v16 offset:16
ds_read_b128 v[128:131], v16 offset:2304
ds_read_b128 v[132:135], v16 offset:2320
ds_read_b128 v[136:139], v16 offset:4608
ds_read_b128 v[140:143], v16 offset:4624
ds_read_b128 v[144:147], v16 offset:6912
ds_read_b128 v[148:151], v16 offset:6928
s_waitcnt lgkmcnt(4)
v_pk_add_f32 v[120:121], v[120:121], v[128:129]
v_pk_add_f32 v[122:123], v[122:123], v[130:131]
v_pk_add_f32 v[124:125], v[124:125], v[132:133]
v_pk_add_f32 v[126:127], v[126:127], v[134:135]
s_waitcnt lgkmcnt(0)
v_pk_add_f32 v[136:137], v[136:137], v[144:145]
v_pk_add_f32 v[138:139], v[138:139], v[146:147]
v_pk_add_f32 v[140:141], v[140:141], v[148:149]
v_pk_add_f32 v[142:143], v[142:143], v[150:151]
v_pk_add_f32 v[120:121], v[120:121], v[136:137]
v_pk_add_f32 v[122:123], v[122:123], v[138:139]
v_pk_add_f32 v[124:125], v[124:125], v[140:141]
v_pk_add_f32 v[126:127], v[126:127], v[142:143]
v_cvt_pk_bf16_f32 v244, v120, v121
v_cvt_pk_bf16_f32 v245, v122, v123
v_cvt_pk_bf16_f32 v246, v124, v125
v_cvt_pk_bf16_f32 v247, v126, v127
mega_kernel_rf_s1:
v_add_u32 v5, 9216, v17
s_waitcnt lgkmcnt(0)
s_barrier
s_cmp_eq_u32 s24, 2
s_cbranch_scc1 mega_kernel_rf_s2
s_cmp_eq_u32 s24, 3
s_cbranch_scc0 mega_kernel_rf_s3
s_add_u32 s76, s27, 2
s_cmp_lt_u32 s76, 63
s_cbranch_scc0 mega_kernel_rf_s3
s_cmp_gt_i32 s46, s76
s_cbranch_scc0 mega_kernel_rf_s3
s_add_u32 s77, s76, s82
s_bfe_u32 s28, s77, 0x40002
s_lshl_b32 s28, s28, 14
s_and_b32 s77, s77, 3
s_lshl_b32 s77, s77, 11
s_add_u32 s28, s28, s77
s_add_u32 s28, s28, s83
s_buffer_load_dword s78, s[84:87], s28 offset:0
s_buffer_load_dword s78, s[84:87], s28 offset:128
s_buffer_load_dword s78, s[84:87], s28 offset:256
s_buffer_load_dword s78, s[84:87], s28 offset:384
s_buffer_load_dword s78, s[84:87], s28 offset:512
s_buffer_load_dword s78, s[84:87], s28 offset:640
s_buffer_load_dword s78, s[84:87], s28 offset:768
s_buffer_load_dword s78, s[84:87], s28 offset:896
s_buffer_load_dword s78, s[84:87], s28 offset:1024
s_buffer_load_dword s78, s[84:87], s28 offset:1152
s_buffer_load_dword s78, s[84:87], s28 offset:1280
s_buffer_load_dword s78, s[84:87], s28 offset:1408
s_buffer_load_dword s78, s[84:87], s28 offset:1536
s_buffer_load_dword s78, s[84:87], s28 offset:1664
s_buffer_load_dword s78, s[84:87], s28 offset:1792
s_buffer_load_dword s78, s[84:87], s28 offset:1920
s_mov_b32 s88, s76
s_branch mega_kernel_rf_s3
mega_kernel_rf_il70:
s_cbranch_execz mega_kernel_rf_il71
mega_kernel_rf_s2:
ds_read_b128 v[120:123], v5 offset:0
ds_read_b128 v[124:127], v5 offset:1024
ds_read_b128 v[128:131], v5 offset:2048
ds_read_b128 v[132:135], v5 offset:3072
v_lshrrev_b32 v5, 1, v17
s_waitcnt lgkmcnt(2)
v_pk_add_f32 v[120:121], v[120:121], v[124:125]
v_pk_add_f32 v[122:123], v[122:123], v[126:127]
s_waitcnt lgkmcnt(0)
v_pk_add_f32 v[128:129], v[128:129], v[132:133]
v_pk_add_f32 v[130:131], v[130:131], v[134:135]
v_pk_add_f32 v[120:121], v[120:121], v[128:129]
v_pk_add_f32 v[122:123], v[122:123], v[130:131]
v_cvt_pk_bf16_f32 v244, v120, v121
v_cvt_pk_bf16_f32 v245, v122, v123
ds_write_b64 v5, v[244:245] offset:17920
s_waitcnt lgkmcnt(0) vmcnt(0)
mega_kernel_rf_s3:
s_cmp_eq_u32 s27, 63
s_cbranch_scc1 mega_kernel_rf_slast
s_add_u32 s29, s33, 24576
s_barrier
s_cmp_eq_u32 s24, 3
s_cbranch_scc1 mega_kernel_rf_y3
s_add_u32 s77, s27, s82
s_bfe_u32 s28, s77, 0x30003
s_lshl_b32 s28, s28, 14
s_and_b32 s77, s77, 7
s_lshl_b32 s77, s77, 10
s_add_u32 s28, s28, s77
s_add_u32 s28, s28, s79
s_cmp_eq_u32 s24, 2
s_cbranch_scc1 mega_kernel_rf_kv2a
s_mov_b64 exec, s[48:49]
buffer_store_dwordx4 v[244:247], v22, s[84:87], s28 offen sc1
s_mov_b64 exec, -1
s_branch mega_kernel_rf_kvda
mega_kernel_rf_il71:
s_cbranch_execz mega_kernel_rf_il72
mega_kernel_rf_kv2a:
v_lshlrev_b32 v4, 3, v1
buffer_store_dwordx2 v[244:245], v4, s[84:87], s28 offen offset:512 sc1
mega_kernel_rf_kvda:
s_branch mega_kernel_rf_y4
mega_kernel_rf_y3:
s_add_u32 s76, s27, 2
s_cmp_lt_u32 s76, 63
s_cbranch_scc0 mega_kernel_rf_y4
mega_kernel_rf_y4:
s_branch mega_kernel_rf_b3
mega_kernel_rf_first:
v_add_u32 v5, s44, v17
ds_read_b128 v[156:159], v5 offset:0
ds_read_b128 v[160:163], v5 offset:1024
ds_read_b128 v[164:167], v5 offset:2048
ds_read_b128 v[168:171], v5 offset:3072
s_branch mega_kernel_rf_adone
mega_kernel_rf_il72:
s_cbranch_execz mega_kernel_rf_il73
mega_kernel_rf_slast:
s_cmp_eq_u32 s24, 3
s_cbranch_scc1 mega_kernel_rf_end
s_add_u32 s77, s27, s82
s_bfe_u32 s28, s77, 0x30003
s_lshl_b32 s28, s28, 14
s_and_b32 s77, s77, 7
s_lshl_b32 s77, s77, 10
s_add_u32 s28, s28, s77
s_add_u32 s28, s28, s79
s_cmp_eq_u32 s24, 2
s_cbranch_scc1 mega_kernel_rf_kv2b
s_mov_b64 exec, s[48:49]
buffer_store_dwordx4 v[244:247], v22, s[84:87], s28 offen sc1
s_mov_b64 exec, -1
s_branch mega_kernel_rf_kvdb
mega_kernel_rf_il73:
s_cbranch_execz mega_kernel_rf_iwd
mega_kernel_rf_kv2b:
v_lshlrev_b32 v4, 3, v1
buffer_store_dwordx2 v[244:245], v4, s[84:87], s28 offen offset:512 sc1
mega_kernel_rf_kvdb:
s_waitcnt vmcnt(0)
s_barrier
s_mov_b32 s76, 64
s_cmp_eq_u32 s24, 1
s_cbranch_scc0 mega_kernel_rf_end
v_mov_b32 v5, s76
s_mov_b64 exec, 1
buffer_store_dword v5, v228, s[84:87], s81 offen sc1
s_mov_b64 exec, -1
mega_kernel_rf_end:
s_endpgm
mega_kernel_recs:
s_load_dwordx2 s[20:21], s[0:1], 8
s_load_dwordx2 s[16:17], s[0:1], 40
s_load_dwordx2 s[4:5], s[0:1], 16
s_load_dwordx2 s[8:9], s[0:1], 24
s_load_dwordx2 s[12:13], s[0:1], 32
v_lshrrev_b32 v4, 6, v0
v_and_b32 v1, 63, v0
v_readfirstlane_b32 s24, v4
v_lshrrev_b32 v2, 4, v1
v_and_b32 v3, 15, v1
v_lshlrev_b32 v17, 4, v1
s_lshr_b32 s28, s31, 2
s_lshl_b32 s25, s30, 3
s_add_u32 s25, s25, s28
s_and_b32 s26, s31, 3
s_waitcnt lgkmcnt(0)
s_mov_b32 s22, 16384
s_mov_b32 s23, 0x00020000
s_mov_b32 s18, 8388608
s_mov_b32 s19, 0x00020000
s_mov_b32 s6, 8388608
s_mov_b32 s7, 0x00020000
s_mov_b32 s10, 8388608
s_mov_b32 s11, 0x00020000
s_mov_b32 s14, 8388608
s_mov_b32 s15, 0x00020000
s_lshl_b32 s28, s25, 8
s_lshr_b32 s29, s26, 0
s_lshl_b32 s29, s29, 6
s_add_u32 s28, s28, s29
s_lshl_b32 s29, s24, 21
s_add_u32 s28, s28, s29
v_lshrrev_b32 v4, 2, v1
v_and_b32 v5, 3, v1
v_lshlrev_b32 v40, 13, v4
v_lshl_add_u32 v40, v5, 4, v40
v_add_u32 v40, s28, v40
s_lshl_b32 s28, s30, 21
s_lshl_b32 s29, s24, 19
s_add_u32 s28, s28, s29
s_lshr_b32 s29, s31, 0
s_lshl_b32 s29, s29, 6
s_add_u32 s28, s28, s29
v_lshlrev_b32 v41, 11, v4
v_lshl_add_u32 v41, v5, 4, v41
v_add_u32 v41, s28, v41
s_lshl_b32 s47, s24, 15
s_add_u32 s47, s47, 32768
s_lshl_b32 s28, s31, 18
s_lshl_b32 s29, s24, 16
s_add_u32 s28, s28, s29
s_lshl_b32 s29, s30, 11
s_add_u32 s28, s28, s29
v_lshlrev_b32 v48, 13, v2
v_lshl_add_u32 v48, v3, 7, v48
v_add_u32 v48, s28, v48
s_lshl_b32 s28, s30, 21
s_lshl_b32 s29, s31, 16
s_add_u32 s28, s28, s29
s_lshl_b32 s29, s24, 14
s_add_u32 s28, s28, s29
v_lshlrev_b32 v49, 7, v1
v_add_u32 v49, s28, v49
s_and_b32 s76, s31, 1
s_mul_i32 s76, s76, 8
s_and_b32 s28, s31, 15
s_lshl_b32 s28, s28, 4
s_lshl_b32 s29, s24, 8
s_add_u32 s28, s28, s29
v_add_u32 v53, s28, v3
s_lshr_b32 s28, s31, 4
s_lshl_b32 s28, s28, 10
s_add_u32 s28, s28, 384
v_mov_b32 v54, s28
v_mov_b32 v55, 1920
v_cmp_gt_u32 vcc, 32, v1
s_nop 1
v_cndmask_b32 v54, v55, v54, vcc
s_lshl_b32 s29, s30, 11
v_lshl_add_u32 v51, v53, 13, v54
v_add_u32 v51, s29, v51
s_lshl_b32 s29, s30, 21
v_lshl_add_u32 v52, v53, 11, v54
v_add_u32 v52, s29, v52
buffer_load_dword v50, v51, s[8:11], 0 offen
s_xor_b32 s29, s76, 0
s_lshl_b32 s28, s29, 10
s_add_u32 s28, s28, s47
s_add_u32 m0, s28, 0
s_lshl_b32 s29, s29, 17
buffer_load_dwordx4 v40, s[8:11], s29 offen lds
s_xor_b32 s29, s76, 1
s_lshl_b32 s28, s29, 10
s_add_u32 s28, s28, s47
s_add_u32 m0, s28, 0
s_lshl_b32 s29, s29, 17
buffer_load_dwordx4 v40, s[8:11], s29 offen lds
s_xor_b32 s29, s76, 2
s_lshl_b32 s28, s29, 10
s_add_u32 s28, s28, s47
s_add_u32 m0, s28, 0
s_lshl_b32 s29, s29, 17
buffer_load_dwordx4 v40, s[8:11], s29 offen lds
s_xor_b32 s29, s76, 3
s_lshl_b32 s28, s29, 10
s_add_u32 s28, s28, s47
s_add_u32 m0, s28, 0
s_lshl_b32 s29, s29, 17
buffer_load_dwordx4 v40, s[8:11], s29 offen lds
s_xor_b32 s29, s76, 4
s_lshl_b32 s28, s29, 10
s_add_u32 s28, s28, s47
s_add_u32 m0, s28, 0
s_lshl_b32 s29, s29, 17
buffer_load_dwordx4 v40, s[8:11], s29 offen lds
s_xor_b32 s29, s76, 5
s_lshl_b32 s28, s29, 10
s_add_u32 s28, s28, s47
s_add_u32 m0, s28, 0
s_lshl_b32 s29, s29, 17
buffer_load_dwordx4 v40, s[8:11], s29 offen lds
s_xor_b32 s29, s76, 6
s_lshl_b32 s28, s29, 10
s_add_u32 s28, s28, s47
s_add_u32 m0, s28, 0
s_lshl_b32 s29, s29, 17
buffer_load_dwordx4 v40, s[8:11], s29 offen lds
s_xor_b32 s29, s76, 7
s_lshl_b32 s28, s29, 10
s_add_u32 s28, s28, s47
s_add_u32 m0, s28, 0
s_lshl_b32 s29, s29, 17
buffer_load_dwordx4 v40, s[8:11], s29 offen lds
s_xor_b32 s29, s76, 8
s_lshl_b32 s28, s29, 10
s_add_u32 s28, s28, s47
s_add_u32 m0, s28, 0
s_lshl_b32 s29, s29, 17
buffer_load_dwordx4 v40, s[8:11], s29 offen lds
s_xor_b32 s29, s76, 9
s_lshl_b32 s28, s29, 10
s_add_u32 s28, s28, s47
s_add_u32 m0, s28, 0
s_lshl_b32 s29, s29, 17
buffer_load_dwordx4 v40, s[8:11], s29 offen lds
s_xor_b32 s29, s76, 10
s_lshl_b32 s28, s29, 10
s_add_u32 s28, s28, s47
s_add_u32 m0, s28, 0
s_lshl_b32 s29, s29, 17
buffer_load_dwordx4 v40, s[8:11], s29 offen lds
s_xor_b32 s29, s76, 11
s_lshl_b32 s28, s29, 10
s_add_u32 s28, s28, s47
s_add_u32 m0, s28, 0
s_lshl_b32 s29, s29, 17
buffer_load_dwordx4 v40, s[8:11], s29 offen lds
s_xor_b32 s29, s76, 12
s_lshl_b32 s28, s29, 10
s_add_u32 s28, s28, s47
s_add_u32 m0, s28, 0
s_lshl_b32 s29, s29, 17
buffer_load_dwordx4 v40, s[8:11], s29 offen lds
s_xor_b32 s29, s76, 13
s_lshl_b32 s28, s29, 10
s_add_u32 s28, s28, s47
s_add_u32 m0, s28, 0
s_lshl_b32 s29, s29, 17
buffer_load_dwordx4 v40, s[8:11], s29 offen lds
s_xor_b32 s29, s76, 14
s_lshl_b32 s28, s29, 10
s_add_u32 s28, s28, s47
s_add_u32 m0, s28, 0
s_lshl_b32 s29, s29, 17
buffer_load_dwordx4 v40, s[8:11], s29 offen lds
s_xor_b32 s29, s76, 15
s_lshl_b32 s28, s29, 10
s_add_u32 s28, s28, s47
s_add_u32 m0, s28, 0
s_lshl_b32 s29, s29, 17
buffer_load_dwordx4 v40, s[8:11], s29 offen lds
buffer_load_dword v50, v51, s[12:15], 0 offen
s_xor_b32 s29, s76, 0
s_lshl_b32 s28, s29, 10
s_add_u32 s28, s28, s47
s_add_u32 m0, s28, 16384
s_lshl_b32 s29, s29, 17
buffer_load_dwordx4 v40, s[12:15], s29 offen lds
s_xor_b32 s29, s76, 1
s_lshl_b32 s28, s29, 10
s_add_u32 s28, s28, s47
s_add_u32 m0, s28, 16384
s_lshl_b32 s29, s29, 17
buffer_load_dwordx4 v40, s[12:15], s29 offen lds
s_xor_b32 s29, s76, 2
s_lshl_b32 s28, s29, 10
s_add_u32 s28, s28, s47
s_add_u32 m0, s28, 16384
s_lshl_b32 s29, s29, 17
buffer_load_dwordx4 v40, s[12:15], s29 offen lds
s_xor_b32 s29, s76, 3
s_lshl_b32 s28, s29, 10
s_add_u32 s28, s28, s47
s_add_u32 m0, s28, 16384
s_lshl_b32 s29, s29, 17
buffer_load_dwordx4 v40, s[12:15], s29 offen lds
s_xor_b32 s29, s76, 4
s_lshl_b32 s28, s29, 10
s_add_u32 s28, s28, s47
s_add_u32 m0, s28, 16384
s_lshl_b32 s29, s29, 17
buffer_load_dwordx4 v40, s[12:15], s29 offen lds
s_xor_b32 s29, s76, 5
s_lshl_b32 s28, s29, 10
s_add_u32 s28, s28, s47
s_add_u32 m0, s28, 16384
s_lshl_b32 s29, s29, 17
buffer_load_dwordx4 v40, s[12:15], s29 offen lds
s_xor_b32 s29, s76, 6
s_lshl_b32 s28, s29, 10
s_add_u32 s28, s28, s47
s_add_u32 m0, s28, 16384
s_lshl_b32 s29, s29, 17
buffer_load_dwordx4 v40, s[12:15], s29 offen lds
s_xor_b32 s29, s76, 7
s_lshl_b32 s28, s29, 10
s_add_u32 s28, s28, s47
s_add_u32 m0, s28, 16384
s_lshl_b32 s29, s29, 17
buffer_load_dwordx4 v40, s[12:15], s29 offen lds
s_xor_b32 s29, s76, 8
s_lshl_b32 s28, s29, 10
s_add_u32 s28, s28, s47
s_add_u32 m0, s28, 16384
s_lshl_b32 s29, s29, 17
buffer_load_dwordx4 v40, s[12:15], s29 offen lds
s_xor_b32 s29, s76, 9
s_lshl_b32 s28, s29, 10
s_add_u32 s28, s28, s47
s_add_u32 m0, s28, 16384
s_lshl_b32 s29, s29, 17
buffer_load_dwordx4 v40, s[12:15], s29 offen lds
s_xor_b32 s29, s76, 10
s_lshl_b32 s28, s29, 10
s_add_u32 s28, s28, s47
s_add_u32 m0, s28, 16384
s_lshl_b32 s29, s29, 17
buffer_load_dwordx4 v40, s[12:15], s29 offen lds
s_xor_b32 s29, s76, 11
s_lshl_b32 s28, s29, 10
s_add_u32 s28, s28, s47
s_add_u32 m0, s28, 16384
s_lshl_b32 s29, s29, 17
buffer_load_dwordx4 v40, s[12:15], s29 offen lds
s_xor_b32 s29, s76, 12
s_lshl_b32 s28, s29, 10
s_add_u32 s28, s28, s47
s_add_u32 m0, s28, 16384
s_lshl_b32 s29, s29, 17
buffer_load_dwordx4 v40, s[12:15], s29 offen lds
s_xor_b32 s29, s76, 13
s_lshl_b32 s28, s29, 10
s_add_u32 s28, s28, s47
s_add_u32 m0, s28, 16384
s_lshl_b32 s29, s29, 17
buffer_load_dwordx4 v40, s[12:15], s29 offen lds
s_xor_b32 s29, s76, 14
s_lshl_b32 s28, s29, 10
s_add_u32 s28, s28, s47
s_add_u32 m0, s28, 16384
s_lshl_b32 s29, s29, 17
buffer_load_dwordx4 v40, s[12:15], s29 offen lds
s_xor_b32 s29, s76, 15
s_lshl_b32 s28, s29, 10
s_add_u32 s28, s28, s47
s_add_u32 m0, s28, 16384
s_lshl_b32 s29, s29, 17
buffer_load_dwordx4 v40, s[12:15], s29 offen lds
s_mov_b32 s40, 0x00ff00ff
s_mov_b32 s41, 0x00ff00ff
s_mov_b32 s48, 0xff00ff00
s_mov_b32 s49, 0xff00ff00
s_mov_b32 s42, 0
s_mov_b32 s43, 0x00ff00ff
s_mov_b32 s32, 0x3e0293ee
v_mov_b32 v23, 0xff800000
v_mov_b32 v6, 0x4444
v_mov_b32 v4, 0xeeee
v_cndmask_b32 v6, v6, v4, s[48:49]
v_mov_b32 v28, -1
v_mov_b32 v29, -1
v_mov_b32 v30, -1
v_mov_b32 v31, -1
s_mul_i32 s28, s24, 4096
v_add_u32 v7, s28, v17
v_and_b32 v4, 7, v1
v_lshlrev_b32 v8, 11, v4
v_lshrrev_b32 v5, 3, v1
v_lshl_add_u32 v8, v5, 4, v8
s_lshl_b32 s28, s24, 9
v_add_u32 v8, s28, v8
s_lshl_b32 s28, s31, 9
s_lshr_b32 s29, s31, 3
s_mul_i32 s29, s29, 0
s_add_u32 s28, s28, s29
v_lshlrev_b32 v9, 3, v1
v_add_u32 v9, s28, v9
v_and_b32 v4, 7, v3
v_lshlrev_b32 v11, 7, v2
v_lshl_add_u32 v11, v4, 4, v11
v_add_u32 v22, 0, v11
s_add_u32 s28, s28, 24576
v_add_u32 v11, s28, v11
v_and_b32 v5, 1, v2
v_lshlrev_b32 v10, 7, v5
v_lshl_add_u32 v10, v4, 4, v10
v_add_u32 v10, 1024, v10
s_xor_b32 s37, s31, 1
s_mul_i32 s37, s37, 1280
s_add_u32 s37, s37, 49152
s_xor_b32 s38, s31, 2
s_mul_i32 s38, s38, 1280
s_add_u32 s38, s38, 49152
s_xor_b32 s39, s31, 3
s_mul_i32 s39, s39, 1280
s_add_u32 s39, s39, 49152
v_and_b32 v4, 1, v2
v_mul_u32_u24 v14, 576, v4
v_lshrrev_b32 v5, 1, v2
v_lshl_add_u32 v5, v5, 4, v3
v_lshl_add_u32 v14, v5, 2, v14
s_mul_i32 s28, s24, 1152
s_add_u32 s28, s28, 13312
v_add_u32 v18, s28, v14
s_mul_i32 s28, s24, 2304
v_add_u32 v14, s28, v14
v_add_u32 v15, 1152, v14
v_mul_u32_u24 v16, 144, v3
v_lshl_add_u32 v16, v2, 5, v16
v_bfe_u32 v4, v1, 1, 3
v_mul_u32_u24 v19, 144, v4
v_lshl_add_u32 v19, v2, 5, v19
v_and_b32 v4, 1, v1
v_lshl_add_u32 v19, v4, 4, v19
v_add_u32 v19, 13312, v19
s_lshl_b32 s28, s24, 10
s_add_u32 s28, s28, 9216
v_add_u32 v20, s28, v17
v_and_b32 v4, 31, v1
v_lshlrev_b32 v21, 3, v4
v_add_u32 v21, 17920, v21
v_lshrrev_b32 v4, 2, v3
v_and_b32 v42, 1, v4
v_lshrrev_b32 v43, 1, v4
v_lshrrev_b32 v44, 1, v2
v_and_b32 v45, 1, v2
v_lshl_add_u32 v46, v44, 4, v42
v_lshl_add_u32 v46, v45, 2, v46
v_lshl_add_u32 v46, v43, 3, v46
v_lshl_add_u32 v47, v44, 3, v42
v_lshl_add_u32 v47, v45, 4, v47
v_lshl_add_u32 v47, v43, 2, v47
v_and_b32 v5, 3, v3
v_lshlrev_b32 v5, 3, v5
v_lshl_add_u32 v46, v46, 6, v5
v_lshl_add_u32 v47, v47, 6, v5
s_and_b32 s28, s31, 0
s_lshl_b32 s28, s28, 6
s_add_u32 s28, s28, s47
v_add_u32 v46, s28, v46
v_add_u32 v47, s28, v47
s_waitcnt vmcnt(17)
ds_read_b64_tr_b16 a[64:65], v46 offset:0
ds_read_b64_tr_b16 a[66:67], v46 offset:128
ds_read_b64_tr_b16 a[68:69], v46 offset:2048
ds_read_b64_tr_b16 a[70:71], v46 offset:2176
ds_read_b64_tr_b16 a[72:73], v46 offset:4096
ds_read_b64_tr_b16 a[74:75], v46 offset:4224
ds_read_b64_tr_b16 a[76:77], v46 offset:6144
ds_read_b64_tr_b16 a[78:79], v46 offset:6272
s_waitcnt lgkmcnt(0)
ds_read_b64_tr_b16 a[80:81], v46 offset:8192
ds_read_b64_tr_b16 a[82:83], v46 offset:8320
ds_read_b64_tr_b16 a[84:85], v46 offset:10240
ds_read_b64_tr_b16 a[86:87], v46 offset:10368
ds_read_b64_tr_b16 a[88:89], v46 offset:12288
ds_read_b64_tr_b16 a[90:91], v46 offset:12416
ds_read_b64_tr_b16 a[92:93], v46 offset:14336
ds_read_b64_tr_b16 a[94:95], v46 offset:14464
s_waitcnt lgkmcnt(0)
ds_read_b64_tr_b16 a[96:97], v46 offset:32
ds_read_b64_tr_b16 a[98:99], v46 offset:160
ds_read_b64_tr_b16 a[100:101], v46 offset:2080
ds_read_b64_tr_b16 a[102:103], v46 offset:2208
ds_read_b64_tr_b16 a[104:105], v46 offset:4128
ds_read_b64_tr_b16 a[106:107], v46 offset:4256
ds_read_b64_tr_b16 a[108:109], v46 offset:6176
ds_read_b64_tr_b16 a[110:111], v46 offset:6304
s_waitcnt lgkmcnt(0)
ds_read_b64_tr_b16 a[112:113], v46 offset:8224
ds_read_b64_tr_b16 a[114:115], v46 offset:8352
ds_read_b64_tr_b16 a[116:117], v46 offset:10272
ds_read_b64_tr_b16 a[118:119], v46 offset:10400
ds_read_b64_tr_b16 a[120:121], v46 offset:12320
ds_read_b64_tr_b16 a[122:123], v46 offset:12448
ds_read_b64_tr_b16 a[124:125], v46 offset:14368
ds_read_b64_tr_b16 a[126:127], v46 offset:14496
s_waitcnt lgkmcnt(0)
buffer_load_dword v50, v51, s[4:7], 0 offen
s_xor_b32 s29, s76, 0
s_lshl_b32 s28, s29, 10
s_add_u32 s28, s28, s47
s_add_u32 m0, s28, 0
s_lshl_b32 s29, s29, 17
buffer_load_dwordx4 v40, s[4:7], s29 offen lds
s_xor_b32 s29, s76, 1
s_lshl_b32 s28, s29, 10
s_add_u32 s28, s28, s47
s_add_u32 m0, s28, 0
s_lshl_b32 s29, s29, 17
buffer_load_dwordx4 v40, s[4:7], s29 offen lds
s_xor_b32 s29, s76, 2
s_lshl_b32 s28, s29, 10
s_add_u32 s28, s28, s47
s_add_u32 m0, s28, 0
s_lshl_b32 s29, s29, 17
buffer_load_dwordx4 v40, s[4:7], s29 offen lds
s_xor_b32 s29, s76, 3
s_lshl_b32 s28, s29, 10
s_add_u32 s28, s28, s47
s_add_u32 m0, s28, 0
s_lshl_b32 s29, s29, 17
buffer_load_dwordx4 v40, s[4:7], s29 offen lds
s_xor_b32 s29, s76, 4
s_lshl_b32 s28, s29, 10
s_add_u32 s28, s28, s47
s_add_u32 m0, s28, 0
s_lshl_b32 s29, s29, 17
buffer_load_dwordx4 v40, s[4:7], s29 offen lds
s_xor_b32 s29, s76, 5
s_lshl_b32 s28, s29, 10
s_add_u32 s28, s28, s47
s_add_u32 m0, s28, 0
s_lshl_b32 s29, s29, 17
buffer_load_dwordx4 v40, s[4:7], s29 offen lds
s_xor_b32 s29, s76, 6
s_lshl_b32 s28, s29, 10
s_add_u32 s28, s28, s47
s_add_u32 m0, s28, 0
s_lshl_b32 s29, s29, 17
buffer_load_dwordx4 v40, s[4:7], s29 offen lds
s_xor_b32 s29, s76, 7
s_lshl_b32 s28, s29, 10
s_add_u32 s28, s28, s47
s_add_u32 m0, s28, 0
s_lshl_b32 s29, s29, 17
buffer_load_dwordx4 v40, s[4:7], s29 offen lds
s_xor_b32 s29, s76, 8
s_lshl_b32 s28, s29, 10
s_add_u32 s28, s28, s47
s_add_u32 m0, s28, 0
s_lshl_b32 s29, s29, 17
buffer_load_dwordx4 v40, s[4:7], s29 offen lds
s_xor_b32 s29, s76, 9
s_lshl_b32 s28, s29, 10
s_add_u32 s28, s28, s47
s_add_u32 m0, s28, 0
s_lshl_b32 s29, s29, 17
buffer_load_dwordx4 v40, s[4:7], s29 offen lds
s_xor_b32 s29, s76, 10
s_lshl_b32 s28, s29, 10
s_add_u32 s28, s28, s47
s_add_u32 m0, s28, 0
s_lshl_b32 s29, s29, 17
buffer_load_dwordx4 v40, s[4:7], s29 offen lds
s_xor_b32 s29, s76, 11
s_lshl_b32 s28, s29, 10
s_add_u32 s28, s28, s47
s_add_u32 m0, s28, 0
s_lshl_b32 s29, s29, 17
buffer_load_dwordx4 v40, s[4:7], s29 offen lds
s_xor_b32 s29, s76, 12
s_lshl_b32 s28, s29, 10
s_add_u32 s28, s28, s47
s_add_u32 m0, s28, 0
s_lshl_b32 s29, s29, 17
buffer_load_dwordx4 v40, s[4:7], s29 offen lds
s_xor_b32 s29, s76, 13
s_lshl_b32 s28, s29, 10
s_add_u32 s28, s28, s47
s_add_u32 m0, s28, 0
s_lshl_b32 s29, s29, 17
buffer_load_dwordx4 v40, s[4:7], s29 offen lds
s_xor_b32 s29, s76, 14
s_lshl_b32 s28, s29, 10
s_add_u32 s28, s28, s47
s_add_u32 m0, s28, 0
s_lshl_b32 s29, s29, 17
buffer_load_dwordx4 v40, s[4:7], s29 offen lds
s_xor_b32 s29, s76, 15
s_lshl_b32 s28, s29, 10
s_add_u32 s28, s28, s47
s_add_u32 m0, s28, 0
s_lshl_b32 s29, s29, 17
buffer_load_dwordx4 v40, s[4:7], s29 offen lds
s_waitcnt vmcnt(17)
ds_read_b64_tr_b16 a[128:129], v46 offset:16384
ds_read_b64_tr_b16 a[130:131], v46 offset:16512
ds_read_b64_tr_b16 a[132:133], v46 offset:18432
ds_read_b64_tr_b16 a[134:135], v46 offset:18560
ds_read_b64_tr_b16 a[136:137], v46 offset:20480
ds_read_b64_tr_b16 a[138:139], v46 offset:20608
ds_read_b64_tr_b16 a[140:141], v46 offset:22528
ds_read_b64_tr_b16 a[142:143], v46 offset:22656
s_waitcnt lgkmcnt(0)
ds_read_b64_tr_b16 a[144:145], v46 offset:24576
ds_read_b64_tr_b16 a[146:147], v46 offset:24704
ds_read_b64_tr_b16 a[148:149], v46 offset:26624
ds_read_b64_tr_b16 a[150:151], v46 offset:26752
ds_read_b64_tr_b16 a[152:153], v46 offset:28672
ds_read_b64_tr_b16 a[154:155], v46 offset:28800
ds_read_b64_tr_b16 a[156:157], v46 offset:30720
ds_read_b64_tr_b16 a[158:159], v46 offset:30848
s_waitcnt lgkmcnt(0)
ds_read_b64_tr_b16 a[160:161], v46 offset:16416
ds_read_b64_tr_b16 a[162:163], v46 offset:16544
ds_read_b64_tr_b16 a[164:165], v46 offset:18464
ds_read_b64_tr_b16 a[166:167], v46 offset:18592
ds_read_b64_tr_b16 a[168:169], v46 offset:20512
ds_read_b64_tr_b16 a[170:171], v46 offset:20640
ds_read_b64_tr_b16 a[172:173], v46 offset:22560
ds_read_b64_tr_b16 a[174:175], v46 offset:22688
s_waitcnt lgkmcnt(0)
ds_read_b64_tr_b16 a[176:177], v46 offset:24608
ds_read_b64_tr_b16 a[178:179], v46 offset:24736
ds_read_b64_tr_b16 a[180:181], v46 offset:26656
ds_read_b64_tr_b16 a[182:183], v46 offset:26784
ds_read_b64_tr_b16 a[184:185], v46 offset:28704
ds_read_b64_tr_b16 a[186:187], v46 offset:28832
ds_read_b64_tr_b16 a[188:189], v46 offset:30752
ds_read_b64_tr_b16 a[190:191], v46 offset:30880
s_waitcnt lgkmcnt(0)
buffer_load_dword v50, v52, s[16:19], 0 offen
s_xor_b32 s29, s76, 0
s_lshl_b32 s28, s29, 10
s_add_u32 s28, s28, s47
s_add_u32 m0, s28, 16384
s_lshl_b32 s29, s29, 15
buffer_load_dwordx4 v41, s[16:19], s29 offen lds
s_xor_b32 s29, s76, 1
s_lshl_b32 s28, s29, 10
s_add_u32 s28, s28, s47
s_add_u32 m0, s28, 16384
s_lshl_b32 s29, s29, 15
buffer_load_dwordx4 v41, s[16:19], s29 offen lds
s_xor_b32 s29, s76, 2
s_lshl_b32 s28, s29, 10
s_add_u32 s28, s28, s47
s_add_u32 m0, s28, 16384
s_lshl_b32 s29, s29, 15
buffer_load_dwordx4 v41, s[16:19], s29 offen lds
s_xor_b32 s29, s76, 3
s_lshl_b32 s28, s29, 10
s_add_u32 s28, s28, s47
s_add_u32 m0, s28, 16384
s_lshl_b32 s29, s29, 15
buffer_load_dwordx4 v41, s[16:19], s29 offen lds
s_xor_b32 s29, s76, 4
s_lshl_b32 s28, s29, 10
s_add_u32 s28, s28, s47
s_add_u32 m0, s28, 16384
s_lshl_b32 s29, s29, 15
buffer_load_dwordx4 v41, s[16:19], s29 offen lds
s_xor_b32 s29, s76, 5
s_lshl_b32 s28, s29, 10
s_add_u32 s28, s28, s47
s_add_u32 m0, s28, 16384
s_lshl_b32 s29, s29, 15
buffer_load_dwordx4 v41, s[16:19], s29 offen lds
s_xor_b32 s29, s76, 6
s_lshl_b32 s28, s29, 10
s_add_u32 s28, s28, s47
s_add_u32 m0, s28, 16384
s_lshl_b32 s29, s29, 15
buffer_load_dwordx4 v41, s[16:19], s29 offen lds
s_xor_b32 s29, s76, 7
s_lshl_b32 s28, s29, 10
s_add_u32 s28, s28, s47
s_add_u32 m0, s28, 16384
s_lshl_b32 s29, s29, 15
buffer_load_dwordx4 v41, s[16:19], s29 offen lds
s_xor_b32 s29, s76, 8
s_lshl_b32 s28, s29, 10
s_add_u32 s28, s28, s47
s_add_u32 m0, s28, 16384
s_lshl_b32 s29, s29, 15
buffer_load_dwordx4 v41, s[16:19], s29 offen lds
s_xor_b32 s29, s76, 9
s_lshl_b32 s28, s29, 10
s_add_u32 s28, s28, s47
s_add_u32 m0, s28, 16384
s_lshl_b32 s29, s29, 15
buffer_load_dwordx4 v41, s[16:19], s29 offen lds
s_xor_b32 s29, s76, 10
s_lshl_b32 s28, s29, 10
s_add_u32 s28, s28, s47
s_add_u32 m0, s28, 16384
s_lshl_b32 s29, s29, 15
buffer_load_dwordx4 v41, s[16:19], s29 offen lds
s_xor_b32 s29, s76, 11
s_lshl_b32 s28, s29, 10
s_add_u32 s28, s28, s47
s_add_u32 m0, s28, 16384
s_lshl_b32 s29, s29, 15
buffer_load_dwordx4 v41, s[16:19], s29 offen lds
s_xor_b32 s29, s76, 12
s_lshl_b32 s28, s29, 10
s_add_u32 s28, s28, s47
s_add_u32 m0, s28, 16384
s_lshl_b32 s29, s29, 15
buffer_load_dwordx4 v41, s[16:19], s29 offen lds
s_xor_b32 s29, s76, 13
s_lshl_b32 s28, s29, 10
s_add_u32 s28, s28, s47
s_add_u32 m0, s28, 16384
s_lshl_b32 s29, s29, 15
buffer_load_dwordx4 v41, s[16:19], s29 offen lds
s_xor_b32 s29, s76, 14
s_lshl_b32 s28, s29, 10
s_add_u32 s28, s28, s47
s_add_u32 m0, s28, 16384
s_lshl_b32 s29, s29, 15
buffer_load_dwordx4 v41, s[16:19], s29 offen lds
s_xor_b32 s29, s76, 15
s_lshl_b32 s28, s29, 10
s_add_u32 s28, s28, s47
s_add_u32 m0, s28, 16384
s_lshl_b32 s29, s29, 15
buffer_load_dwordx4 v41, s[16:19], s29 offen lds
s_mov_b64 exec, 0
s_cmp_eq_u32 s24, 0
s_cbranch_scc1 mega_kernel_rs_iw0
s_cmp_eq_u32 s24, 1
s_cbranch_scc1 mega_kernel_rs_iw1
s_cmp_eq_u32 s24, 2
s_cbranch_scc1 mega_kernel_rs_iw2
s_branch mega_kernel_rs_iw3
mega_kernel_rs_iwd:
s_mov_b64 exec, -1
s_waitcnt vmcnt(17)
ds_read_b64_tr_b16 a[0:1], v46 offset:0
ds_read_b64_tr_b16 a[2:3], v46 offset:128
ds_read_b64_tr_b16 a[4:5], v46 offset:2048
ds_read_b64_tr_b16 a[6:7], v46 offset:2176
ds_read_b64_tr_b16 a[8:9], v46 offset:4096
ds_read_b64_tr_b16 a[10:11], v46 offset:4224
ds_read_b64_tr_b16 a[12:13], v46 offset:6144
ds_read_b64_tr_b16 a[14:15], v46 offset:6272
s_waitcnt lgkmcnt(0)
ds_read_b64_tr_b16 a[16:17], v46 offset:8192
ds_read_b64_tr_b16 a[18:19], v46 offset:8320
ds_read_b64_tr_b16 a[20:21], v46 offset:10240
ds_read_b64_tr_b16 a[22:23], v46 offset:10368
ds_read_b64_tr_b16 a[24:25], v46 offset:12288
ds_read_b64_tr_b16 a[26:27], v46 offset:12416
ds_read_b64_tr_b16 a[28:29], v46 offset:14336
ds_read_b64_tr_b16 a[30:31], v46 offset:14464
s_waitcnt lgkmcnt(0)
ds_read_b64_tr_b16 a[32:33], v46 offset:32
ds_read_b64_tr_b16 a[34:35], v46 offset:160
ds_read_b64_tr_b16 a[36:37], v46 offset:2080
ds_read_b64_tr_b16 a[38:39], v46 offset:2208
ds_read_b64_tr_b16 a[40:41], v46 offset:4128
ds_read_b64_tr_b16 a[42:43], v46 offset:4256
ds_read_b64_tr_b16 a[44:45], v46 offset:6176
ds_read_b64_tr_b16 a[46:47], v46 offset:6304
s_waitcnt lgkmcnt(0)
ds_read_b64_tr_b16 a[48:49], v46 offset:8224
ds_read_b64_tr_b16 a[50:51], v46 offset:8352
ds_read_b64_tr_b16 a[52:53], v46 offset:10272
ds_read_b64_tr_b16 a[54:55], v46 offset:10400
ds_read_b64_tr_b16 a[56:57], v46 offset:12320
ds_read_b64_tr_b16 a[58:59], v46 offset:12448
ds_read_b64_tr_b16 a[60:61], v46 offset:14368
ds_read_b64_tr_b16 a[62:63], v46 offset:14496
s_waitcnt lgkmcnt(0)
v_and_b32 v247, 15, v0
v_lshlrev_b32 v247, 4, v247
buffer_load_dword v246, v247, s[72:75], 0 offen sc1
buffer_load_dwordx4 v[64:67], v8, s[20:23], 0 offen offset:0
buffer_load_dwordx4 v[68:71], v8, s[20:23], 0 offen offset:128
buffer_load_dwordx4 v[72:75], v8, s[20:23], 0 offen offset:256
buffer_load_dwordx4 v[76:79], v8, s[20:23], 0 offen offset:384
s_waitcnt vmcnt(0)
ds_read_b64_tr_b16 a[192:193], v47 offset:16384
ds_read_b64_tr_b16 a[194:195], v47 offset:16512
ds_read_b64_tr_b16 a[196:197], v47 offset:18432
ds_read_b64_tr_b16 a[198:199], v47 offset:18560
ds_read_b64_tr_b16 a[200:201], v47 offset:20480
ds_read_b64_tr_b16 a[202:203], v47 offset:20608
ds_read_b64_tr_b16 a[204:205], v47 offset:22528
ds_read_b64_tr_b16 a[206:207], v47 offset:22656
s_waitcnt lgkmcnt(0)
ds_read_b64_tr_b16 a[208:209], v47 offset:24576
ds_read_b64_tr_b16 a[210:211], v47 offset:24704
ds_read_b64_tr_b16 a[212:213], v47 offset:26624
ds_read_b64_tr_b16 a[214:215], v47 offset:26752
ds_read_b64_tr_b16 a[216:217], v47 offset:28672
ds_read_b64_tr_b16 a[218:219], v47 offset:28800
ds_read_b64_tr_b16 a[220:221], v47 offset:30720
ds_read_b64_tr_b16 a[222:223], v47 offset:30848
s_waitcnt lgkmcnt(0)
ds_read_b64_tr_b16 a[224:225], v47 offset:16416
ds_read_b64_tr_b16 a[226:227], v47 offset:16544
ds_read_b64_tr_b16 a[228:229], v47 offset:18464
ds_read_b64_tr_b16 a[230:231], v47 offset:18592
ds_read_b64_tr_b16 a[232:233], v47 offset:20512
ds_read_b64_tr_b16 a[234:235], v47 offset:20640
ds_read_b64_tr_b16 a[236:237], v47 offset:22560
ds_read_b64_tr_b16 a[238:239], v47 offset:22688
s_waitcnt lgkmcnt(0)
ds_read_b64_tr_b16 a[240:241], v47 offset:24608
ds_read_b64_tr_b16 a[242:243], v47 offset:24736
ds_read_b64_tr_b16 a[244:245], v47 offset:26656
ds_read_b64_tr_b16 a[246:247], v47 offset:26784
ds_read_b64_tr_b16 a[248:249], v47 offset:28704
ds_read_b64_tr_b16 a[250:251], v47 offset:28832
ds_read_b64_tr_b16 a[252:253], v47 offset:30752
ds_read_b64_tr_b16 a[254:255], v47 offset:30880
s_waitcnt lgkmcnt(0)
v_mov_b32 v32, v64
v_mov_b32 v33, v65
v_mov_b32 v34, v66
v_mov_b32 v35, v67
v_mov_b32 v36, v68
v_mov_b32 v37, v69
v_mov_b32 v38, v70
v_mov_b32 v39, v71
v_mov_b32 v40, v72
v_mov_b32 v41, v73
v_mov_b32 v42, v74
v_mov_b32 v43, v75
v_mov_b32 v44, v76
v_mov_b32 v45, v77
v_mov_b32 v46, v78
v_mov_b32 v47, v79
v_mov_b32 v96, 0
v_mov_b32 v97, 0
v_mov_b32 v98, 0
v_mov_b32 v99, 0
v_mov_b32 v100, 0
v_mov_b32 v101, 0
v_mov_b32 v102, 0
v_mov_b32 v103, 0
v_mov_b32 v104, 0
v_mov_b32 v105, 0
v_mov_b32 v106, 0
v_mov_b32 v107, 0
v_mov_b32 v108, 0
v_mov_b32 v109, 0
v_mov_b32 v110, 0
v_mov_b32 v111, 0
v_mov_b32 v112, 0
v_mov_b32 v113, 0
v_mov_b32 v114, 0
v_mov_b32 v115, 0
v_mov_b32 v116, 0
v_mov_b32 v117, 0
v_mov_b32 v118, 0
v_mov_b32 v119, 0
s_nop 1
v_smfmac_f32_16x16x64_bf16 v[96:99], v[32:35], a[0:7], v6
v_smfmac_f32_16x16x64_bf16 v[100:103], v[32:35], a[32:39], v6
v_smfmac_f32_16x16x64_bf16 v[104:107], v[32:35], a[64:71], v6
v_smfmac_f32_16x16x64_bf16 v[108:111], v[32:35], a[96:103], v6
v_smfmac_f32_16x16x64_bf16 v[96:99], v[36:39], a[8:15], v6
v_smfmac_f32_16x16x64_bf16 v[100:103], v[36:39], a[40:47], v6
v_smfmac_f32_16x16x64_bf16 v[104:107], v[36:39], a[72:79], v6
v_smfmac_f32_16x16x64_bf16 v[108:111], v[36:39], a[104:111], v6
v_smfmac_f32_16x16x64_bf16 v[96:99], v[40:43], a[16:23], v6
v_smfmac_f32_16x16x64_bf16 v[100:103], v[40:43], a[48:55], v6
v_smfmac_f32_16x16x64_bf16 v[104:107], v[40:43], a[80:87], v6
v_smfmac_f32_16x16x64_bf16 v[108:111], v[40:43], a[112:119], v6
v_smfmac_f32_16x16x64_bf16 v[96:99], v[44:47], a[24:31], v6
v_smfmac_f32_16x16x64_bf16 v[100:103], v[44:47], a[56:63], v6
v_smfmac_f32_16x16x64_bf16 v[104:107], v[44:47], a[88:95], v6
v_smfmac_f32_16x16x64_bf16 v[108:111], v[44:47], a[120:127], v6
v_and_b32 v247, 15, v0
v_lshlrev_b32 v247, 4, v247
s_branch mega_kernel_sysp
mega_kernel_sysw:
s_sleep 4
mega_kernel_sys:
buffer_load_dword v246, v247, s[72:75], 0 offen sc1
s_waitcnt vmcnt(0)
mega_kernel_sysp:
s_cmp_eq_u32 s95, 1
s_cbranch_scc0 mega_kernel_sysf
v_readlane_b32 s76, v246, 14
s_mov_b32 s98, 0
s_cmp_eq_u32 s76, 32
s_cbranch_scc0 mega_kernel_sysw
s_branch mega_kernel_sysd
mega_kernel_sysf:
s_mov_b32 s77, 0
s_mov_b32 s78, 0
v_readlane_b32 s76, v246, 0
s_add_u32 s77, s77, s76
s_xor_b32 s76, s76, 32
s_or_b32 s78, s78, s76
v_readlane_b32 s76, v246, 1
s_add_u32 s77, s77, s76
s_xor_b32 s76, s76, 32
s_or_b32 s78, s78, s76
v_readlane_b32 s76, v246, 2
s_add_u32 s77, s77, s76
s_xor_b32 s76, s76, 32
s_or_b32 s78, s78, s76
v_readlane_b32 s76, v246, 3
s_add_u32 s77, s77, s76
s_xor_b32 s76, s76, 32
s_or_b32 s78, s78, s76
v_readlane_b32 s76, v246, 4
s_add_u32 s77, s77, s76
s_xor_b32 s76, s76, 32
s_or_b32 s78, s78, s76
v_readlane_b32 s76, v246, 5
s_add_u32 s77, s77, s76
s_xor_b32 s76, s76, 32
s_or_b32 s78, s78, s76
v_readlane_b32 s76, v246, 6
s_add_u32 s77, s77, s76
s_xor_b32 s76, s76, 32
s_or_b32 s78, s78, s76
v_readlane_b32 s76, v246, 7
s_add_u32 s77, s77, s76
s_xor_b32 s76, s76, 32
s_or_b32 s78, s78, s76
s_cmp_eq_u32 s77, 256
s_cbranch_scc0 mega_kernel_sysw
v_mov_b32 v252, v246
s_cmp_eq_u32 s78, 0
s_cbranch_scc0 mega_kernel_slowent
v_readlane_b32 s76, v246, 10
v_readlane_b32 s77, v246, 8
s_cmp_eq_u32 s76, 32
s_cbranch_scc0 mega_kernel_sysw
s_cmp_gt_u32 s77, 16
s_cselect_b32 s98, 1, 0
mega_kernel_sysd:
s_lshr_b32 s28, s31, 4
s_lshl_b32 s28, s28, 14
s_lshl_b32 s29, s98, 13
s_add_u32 s28, s28, s29
s_and_b32 s29, s31, 15
s_lshl_b32 s29, s29, 9
s_add_u32 s28, s28, s29
s_lshl_b32 s29, s30, 16
s_add_u32 s28, s28, s29
s_add_u32 s28, s28, 67108864
v_lshrrev_b32 v12, 1, v17
v_add_u32 v12, s28, v12
v_xor_b32 v25, 0x10000, v12
v_xor_b32 v26, 0x20000, v12
v_xor_b32 v27, 0x30000, v12
v_add_u32 v25, 0, v25
v_add_u32 v26, 0, v26
v_add_u32 v27, 0, v27
s_lshl_b32 s28, s25, 2
s_add_u32 s28, s28, s26
s_mov_b32 s82, s28
s_lshr_b32 s29, s28, 3
s_xor_b32 s29, s29, s98
s_and_b32 s29, s29, 1
s_lshl_b32 s29, s29, 13
s_lshl_b32 s76, s28, 18
s_add_u32 s76, s76, s29
s_mov_b32 s83, s76
v_add_u32 v240, s76, v17
v_add_u32 v241, 33554432, v240
s_lshr_b32 s29, s28, 4
s_xor_b32 s29, s29, s98
s_and_b32 s29, s29, 1
s_lshl_b32 s29, s29, 13
s_lshl_b32 s79, s28, 17
s_add_u32 s79, s79, s29
s_add_u32 s79, s79, 71303168
s_xor_b32 s29, s98, 1
s_lshl_b32 s29, s29, 13
s_lshl_b32 s28, s25, 7
s_add_u32 s28, s28, s29
s_add_u32 s28, s28, 69206016
v_and_b32 v4, 1, v1
v_lshlrev_b32 v24, 12, v4
v_add_u32 v24, s28, v24
s_lshl_b32 s29, s26, 2
v_add_u32 v24, s29, v24
s_xor_b32 s81, s98, 1
s_lshl_b32 s81, s81, 13
s_lshr_b32 s29, s82, 6
s_lshl_b32 s29, s29, 14
s_add_u32 s81, s81, s29
s_and_b32 s29, s82, 63
s_lshl_b32 s29, s29, 7
s_add_u32 s81, s81, s29
s_add_u32 s81, s81, 69222400
v_mov_b32 v220, 0x3f803f80
v_mov_b32 v221, 0x3f803f80
v_mov_b32 v222, 0x3f803f80
v_mov_b32 v223, 0x3f803f80
v_mov_b32 v228, 0
s_mov_b32 s27, 0
s_mov_b32 s46, 0
s_mov_b32 s89, 0
s_mov_b32 s88, 0
s_mov_b32 s44, 18432
s_mov_b32 s45, 18432
s_cmp_eq_u32 s24, 3
s_cbranch_scc0 mega_kernel_rs_pfi
s_mov_b32 s76, 0
s_cmp_gt_i32 s46, s76
s_cbranch_scc1 mega_kernel_rs_pf0ok
mega_kernel_rs_pf0w:
v_mov_b32 v4, 0
s_mov_b64 exec, 3
buffer_atomic_add v4, v24, s[84:87], 0 offen sc0 sc1
s_mov_b64 exec, -1
s_waitcnt vmcnt(0)
v_readlane_b32 s46, v4, 0
v_readlane_b32 s28, v4, 1
s_nop 1
s_min_i32 s46, s46, s28
s_cmp_gt_i32 s46, s76
s_cbranch_scc0 mega_kernel_rs_pf0w
mega_kernel_rs_pf0ok:
s_add_u32 s77, s76, s82
s_bfe_u32 s28, s77, 0x40002
s_lshl_b32 s28, s28, 14
s_and_b32 s77, s77, 3
s_lshl_b32 s77, s77, 11
s_add_u32 s28, s28, s77
s_add_u32 m0, s45, 0
s_nop 0
buffer_load_dwordx4 v240, s[84:87], s28 offen offset:0 sc1 lds
s_add_u32 m0, s45, 0
s_nop 0
buffer_load_dwordx4 v240, s[84:87], s28 offen offset:1024 sc1 lds
s_add_u32 m0, s45, 2048
s_nop 0
buffer_load_dwordx4 v241, s[84:87], s28 offen offset:0 sc1 lds
s_add_u32 m0, s45, 2048
s_nop 0
buffer_load_dwordx4 v241, s[84:87], s28 offen offset:1024 sc1 lds
s_add_u32 s45, s45, 4096
s_cmp_eq_u32 s45, 30720
s_cselect_b32 s45, 18432, s45
s_waitcnt vmcnt(0) lgkmcnt(0)
s_branch mega_kernel_rs_pfj
mega_kernel_rs_pfi:
s_lshr_b32 s88, s25, 2
s_lshl_b32 s88, s88, 17
s_and_b32 s77, s25, 2
s_lshl_b32 s77, s77, 13
s_add_u32 s88, s88, s77
s_and_b32 s77, s25, 1
s_lshl_b32 s77, s77, 12
s_add_u32 s88, s88, s77
s_xor_b32 s77, s98, 0
s_lshl_b32 s77, s77, 13
s_add_u32 s88, s88, s77
s_add_u32 s88, s88, 68255744
s_lshl_b32 s77, s26, 10
s_add_u32 s88, s88, s77
mega_kernel_rs_pfj:
v_mov_b32 v184, 0
v_mov_b32 v185, 0
v_mov_b32 v186, 0
v_mov_b32 v187, 0
v_mov_b32 v188, 0
v_mov_b32 v189, 0
v_mov_b32 v190, 0
v_mov_b32 v191, 0
v_mov_b32 v192, 0
v_mov_b32 v193, 0
v_mov_b32 v194, 0
v_mov_b32 v195, 0
v_mov_b32 v196, 0
v_mov_b32 v197, 0
v_mov_b32 v198, 0
v_mov_b32 v199, 0
v_mov_b32 v200, 0
v_mov_b32 v201, 0
v_mov_b32 v202, 0
v_mov_b32 v203, 0
v_mov_b32 v204, 0
v_mov_b32 v205, 0
v_mov_b32 v206, 0
v_mov_b32 v207, 0
v_mov_b32 v249, 0
v_mov_b32 v60, 0
v_mov_b32 v61, 0
v_mov_b32 v62, 0
v_mov_b32 v63, 0
s_waitcnt lgkmcnt(0)
s_barrier
s_and_b32 s29, s27, 1
s_lshl_b32 s33, s29, 17
s_lshl_b32 s28, s30, 18
s_add_u32 s33, s33, s28
s_add_u32 s33, s33, 68157440
s_xor_b32 s34, s33, 131072
s_lshl_b32 s35, s29, 18
s_bfe_u32 s47, s27, 0x10001
s_branch mega_kernel_rs_first
.p2align 6
s_nop 0
s_nop 0
mega_kernel_rs_loop:
buffer_load_dwordx4 v[32:35], v7, s[84:87], s33 offen offset:0 sc1
v_add_u32 v5, s44, v17
ds_read_b128 v[156:159], v5 offset:0
ds_read_b128 v[160:163], v5 offset:1024
ds_read_b128 v[164:167], v5 offset:2048
ds_read_b128 v[168:171], v5 offset:3072
s_nop 4
buffer_load_dwordx4 v[36:39], v7, s[84:87], s33 offen offset:1024 sc1
s_nop 9
buffer_load_dwordx4 v[40:43], v7, s[84:87], s33 offen offset:2048 sc1
s_nop 9
buffer_load_dwordx4 v[44:47], v7, s[84:87], s33 offen offset:3072 sc1
s_waitcnt vmcnt(3)
v_max_u32 v4, v32, v34
v_cmp_eq_u32 vcc, -1, v4
s_cbranch_vccnz mega_kernel_rs_pa_15_0f
v_smfmac_f32_16x16x64_bf16 v[96:99], v[32:35], a[0:7], v6
v_smfmac_f32_16x16x64_bf16 v[100:103], v[32:35], a[32:39], v6
v_smfmac_f32_16x16x64_bf16 v[104:107], v[32:35], a[64:71], v6
s_waitcnt vmcnt(2)
v_max_u32 v4, v36, v38
v_cmp_eq_u32 vcc, -1, v4
v_smfmac_f32_16x16x64_bf16 v[108:111], v[32:35], a[96:103], v6
s_cbranch_vccnz mega_kernel_rs_pa_14_1f
v_smfmac_f32_16x16x64_bf16 v[96:99], v[36:39], a[8:15], v6
v_smfmac_f32_16x16x64_bf16 v[100:103], v[36:39], a[40:47], v6
v_smfmac_f32_16x16x64_bf16 v[104:107], v[36:39], a[72:79], v6
s_waitcnt vmcnt(1)
v_max_u32 v4, v40, v42
v_cmp_eq_u32 vcc, -1, v4
v_smfmac_f32_16x16x64_bf16 v[108:111], v[36:39], a[104:111], v6
s_cbranch_vccnz mega_kernel_rs_pa_12_2f
v_smfmac_f32_16x16x64_bf16 v[96:99], v[40:43], a[16:23], v6
v_smfmac_f32_16x16x64_bf16 v[100:103], v[40:43], a[48:55], v6
v_smfmac_f32_16x16x64_bf16 v[104:107], v[40:43], a[80:87], v6
s_waitcnt vmcnt(0)
v_max_u32 v4, v44, v46
v_cmp_eq_u32 vcc, -1, v4
v_smfmac_f32_16x16x64_bf16 v[108:111], v[40:43], a[112:119], v6
s_cbranch_vccnz mega_kernel_rs_pa_8_3f
v_smfmac_f32_16x16x64_bf16 v[96:99], v[44:47], a[24:31], v6
v_smfmac_f32_16x16x64_bf16 v[100:103], v[44:47], a[56:63], v6
v_smfmac_f32_16x16x64_bf16 v[104:107], v[44:47], a[88:95], v6
v_smfmac_f32_16x16x64_bf16 v[108:111], v[44:47], a[120:127], v6
mega_kernel_rs_pa_d:
mega_kernel_rs_adone:
s_nop 5
v_permlane32_swap_b32 v96, v100
v_permlane32_swap_b32 v97, v101
v_permlane32_swap_b32 v98, v102
v_permlane32_swap_b32 v99, v103
v_pk_add_f32 v[96:97], v[96:97], v[100:101]
v_pk_add_f32 v[98:99], v[98:99], v[102:103]
ds_write2_b32 v14, v96, v97 offset0:0 offset1:36
ds_write2_b32 v14, v98, v99 offset0:72 offset1:108
v_permlane32_swap_b32 v104, v108
v_permlane32_swap_b32 v105, v109
v_permlane32_swap_b32 v106, v110
v_permlane32_swap_b32 v107, v111
v_pk_add_f32 v[104:105], v[104:105], v[108:109]
v_pk_add_f32 v[106:107], v[106:107], v[110:111]
ds_write2_b32 v15, v104, v105 offset0:0 offset1:36
ds_write2_b32 v15, v106, v107 offset0:72 offset1:108
v_smfmac_f32_16x16x64_bf16 v[112:115], v[32:35], a[128:135], v6
v_smfmac_f32_16x16x64_bf16 v[116:119], v[32:35], a[160:167], v6
v_smfmac_f32_16x16x64_bf16 v[112:115], v[36:39], a[136:143], v6
v_smfmac_f32_16x16x64_bf16 v[116:119], v[36:39], a[168:175], v6
s_waitcnt lgkmcnt(0)
s_barrier
s_cmp_lg_u32 s24, 0
s_cbranch_scc1 mega_kernel_rs_side
ds_read_b128 v[120:123], v16 offset:0
ds_read_b128 v[124:127], v16 offset:16
ds_read_b128 v[128:131], v16 offset:2304
ds_read_b128 v[132:135], v16 offset:2320
ds_read_b128 v[136:139], v16 offset:4608
ds_read_b128 v[140:143], v16 offset:4624
ds_read_b128 v[144:147], v16 offset:6912
ds_read_b128 v[148:151], v16 offset:6928
v_smfmac_f32_16x16x64_bf16 v[112:115], v[40:43], a[144:151], v6
v_smfmac_f32_16x16x64_bf16 v[116:119], v[40:43], a[176:183], v6
v_smfmac_f32_16x16x64_bf16 v[112:115], v[44:47], a[152:159], v6
v_smfmac_f32_16x16x64_bf16 v[116:119], v[44:47], a[184:191], v6
s_mul_i32 s28, s31, 1280
s_add_u32 s28, s28, s33
s_add_u32 s28, s28, 49152
s_add_u32 s76, s37, s33
s_add_u32 s77, s38, s33
s_add_u32 s78, s39, s33
s_waitcnt lgkmcnt(4)
v_pk_add_f32 v[120:121], v[120:121], v[128:129]
v_pk_add_f32 v[122:123], v[122:123], v[130:131]
v_pk_add_f32 v[124:125], v[124:125], v[132:133]
v_pk_add_f32 v[126:127], v[126:127], v[134:135]
s_waitcnt lgkmcnt(0)
v_pk_add_f32 v[136:137], v[136:137], v[144:145]
v_pk_add_f32 v[138:139], v[138:139], v[146:147]
v_pk_add_f32 v[140:141], v[140:141], v[148:149]
v_pk_add_f32 v[142:143], v[142:143], v[150:151]
v_pk_add_f32 v[120:121], v[120:121], v[136:137]
v_pk_add_f32 v[122:123], v[122:123], v[138:139]
v_pk_add_f32 v[124:125], v[124:125], v[140:141]
v_pk_add_f32 v[126:127], v[126:127], v[142:143]
v_cvt_pk_bf16_f32 v152, v120, v121
v_cvt_pk_bf16_f32 v153, v122, v123
v_cvt_pk_bf16_f32 v154, v124, v125
v_cvt_pk_bf16_f32 v155, v126, v127
s_nop 1
v_mfma_f32_16x16x32_bf16 v[176:179], v[160:163], v[152:155], 0
v_mfma_f32_16x16x32_bf16 v[172:175], v[156:159], v[152:155], 0
v_mfma_f32_16x16x32_bf16 v[180:183], v[152:155], v[152:155], 0
s_cmp_eq_u32 s27, 63
s_cbranch_scc1 mega_kernel_rs_w0last
s_nop 4
v_mov_b32_dpp v172, v176 row_shr:8 row_mask:0xf bank_mask:0xc
v_mov_b32_dpp v173, v177 row_shr:8 row_mask:0xf bank_mask:0xc
v_mov_b32_dpp v174, v178 row_shr:8 row_mask:0xf bank_mask:0xc
v_mov_b32_dpp v175, v179 row_shr:8 row_mask:0xf bank_mask:0xc
v_min_u32 v180, -2, v180
v_min_u32 v172, -2, v172
s_mov_b64 exec, s[42:43]
buffer_store_dwordx4 v[180:183], v10, s[84:87], s28 offen sc1
s_mov_b64 exec, -1
buffer_store_dwordx4 v[172:175], v17, s[84:87], s28 offen sc1
v_permlane32_swap_b32 v112, v116
v_permlane32_swap_b32 v113, v117
v_permlane32_swap_b32 v114, v118
v_permlane32_swap_b32 v115, v119
v_pk_add_f32 v[112:113], v[112:113], v[116:117]
v_pk_add_f32 v[114:115], v[114:115], v[118:119]
ds_write_b128 v20, v[112:115]
s_waitcnt lgkmcnt(0)
s_barrier
v_mov_b32 v96, 0
v_mov_b32 v97, 0
v_mov_b32 v98, 0
v_mov_b32 v99, 0
v_mov_b32 v100, 0
v_mov_b32 v101, 0
v_mov_b32 v102, 0
v_mov_b32 v103, 0
v_cndmask_b32 v176, v23, v180, s[42:43]
v_cndmask_b32 v177, v23, v181, s[42:43]
v_cndmask_b32 v178, v23, v182, s[42:43]
v_cndmask_b32 v179, v23, v183, s[42:43]
s_mov_b64 exec, s[42:43]
buffer_load_dwordx4 v[188:191], v10, s[84:87], s76 offen sc1
buffer_load_dwordx4 v[196:199], v10, s[84:87], s77 offen sc1
buffer_load_dwordx4 v[204:207], v10, s[84:87], s78 offen sc1
s_mov_b64 exec, -1
buffer_load_dwordx4 v[184:187], v17, s[84:87], s76 offen sc1
buffer_load_dwordx4 v[192:195], v17, s[84:87], s77 offen sc1
buffer_load_dwordx4 v[200:203], v17, s[84:87], s78 offen sc1
v_pk_mul_f32 v[172:173], v[172:173], s[32:33] op_sel_hi:[1,0]
v_pk_mul_f32 v[174:175], v[174:175], s[32:33] op_sel_hi:[1,0]
v_pk_mul_f32 v[176:177], v[176:177], s[32:33] op_sel_hi:[1,0]
v_pk_mul_f32 v[178:179], v[178:179], s[32:33] op_sel_hi:[1,0]
s_lshl_b32 s89, s47, 31
s_or_b32 s89, s89, 0x3b39999a
s_nop 15
s_nop 1
s_mov_b64 exec, s[42:43]
buffer_load_dwordx4 v[188:191], v10, s[84:87], s76 offen sc1
buffer_load_dwordx4 v[196:199], v10, s[84:87], s77 offen sc1
buffer_load_dwordx4 v[204:207], v10, s[84:87], s78 offen sc1
s_mov_b64 exec, -1
buffer_load_dwordx4 v[184:187], v17, s[84:87], s76 offen sc1
buffer_load_dwordx4 v[192:195], v17, s[84:87], s77 offen sc1
buffer_load_dwordx4 v[200:203], v17, s[84:87], s78 offen sc1
mega_kernel_rs_p2:
s_waitcnt vmcnt(6)
v_max3_u32 v4, v184, v188, v192
v_max3_u32 v5, v196, v200, v204
v_max_u32 v4, v4, v5
v_cmp_eq_u32 vcc, -1, v4
s_cbranch_vccnz mega_kernel_rs_p2r
v_pk_add_f32 v[124:125], v[196:197], v[204:205]
v_pk_add_f32 v[126:127], v[198:199], v[206:207]
v_pk_add_f32 v[120:121], v[192:193], v[200:201]
v_pk_add_f32 v[122:123], v[194:195], v[202:203]
v_pk_add_f32 v[124:125], v[124:125], v[188:189]
v_pk_add_f32 v[126:127], v[126:127], v[190:191]
v_pk_add_f32 v[120:121], v[120:121], v[184:185]
v_pk_add_f32 v[122:123], v[122:123], v[186:187]
v_pk_fma_f32 v[176:177], v[124:125], s[32:33], v[176:177] op_sel_hi:[1,0,1]
v_pk_fma_f32 v[178:179], v[126:127], s[32:33], v[178:179] op_sel_hi:[1,0,1]
v_pk_fma_f32 v[172:173], v[120:121], s[32:33], v[172:173] op_sel_hi:[1,0,1]
v_pk_fma_f32 v[174:175], v[122:123], s[32:33], v[174:175] op_sel_hi:[1,0,1]
v_max3_f32 v232, v172, v173, v174
v_max3_f32 v233, v176, v177, v178
v_max3_f32 v232, v232, v175, v179
v_max_f32 v234, v232, v233
s_barrier
ds_read2_b64 v[208:211], v21 offset0:0 offset1:32
v_max_f32_dpp v232, v234, v234 row_ror:8 row_mask:0xf bank_mask:0xf
v_max_f32_dpp v233, v234, v234 row_ror:8 row_mask:0xf bank_mask:0xf
s_nop 1
v_permlane16_swap_b32 v232, v233
s_nop 0
v_max_f32 v234, v232, v233
v_max_f32 v235, v232, v233
s_nop 1
v_permlane32_swap_b32 v234, v235
s_nop 0
v_max_f32 v232, v234, v235
v_pk_add_f32 v[176:177], v[176:177], v[232:233] op_sel_hi:[1,0] neg_lo:[0,1] neg_hi:[0,1]
v_pk_add_f32 v[178:179], v[178:179], v[232:233] op_sel_hi:[1,0] neg_lo:[0,1] neg_hi:[0,1]
v_pk_add_f32 v[172:173], v[172:173], v[232:233] op_sel_hi:[1,0] neg_lo:[0,1] neg_hi:[0,1]
v_pk_add_f32 v[174:175], v[174:175], v[232:233] op_sel_hi:[1,0] neg_lo:[0,1] neg_hi:[0,1]
v_exp_f32 v176, v176
v_exp_f32 v177, v177
v_exp_f32 v178, v178
v_exp_f32 v179, v179
v_exp_f32 v172, v172
v_cvt_pk_bf16_f32 v216, v176, v177
v_cvt_pk_bf16_f32 v217, v178, v179
v_exp_f32 v173, v173
v_exp_f32 v174, v174
v_mfma_f32_16x16x16_bf16 v[224:227], v[220:221], v[216:217], 0
v_exp_f32 v175, v175
v_cvt_pk_bf16_f32 v212, v172, v173
s_waitcnt lgkmcnt(0)
v_mfma_f32_16x16x16_bf16 v[120:123], v[208:209], v[216:217], 0
v_cvt_pk_bf16_f32 v213, v174, v175
v_mfma_f32_16x16x16_bf16 v[124:127], v[210:211], v[216:217], 0
v_mov_b32_dpp v214, v212 row_ror:8 row_mask:0xf bank_mask:0xf
v_mov_b32_dpp v215, v213 row_ror:8 row_mask:0xf bank_mask:0xf
s_nop 1
v_mfma_f32_16x16x32_bf16 v[224:227], v[220:223], v[212:215], v[224:227]
v_mfma_f32_16x16x32_bf16 v[120:123], v[164:167], v[212:215], v[120:123]
v_mfma_f32_16x16x32_bf16 v[124:127], v[168:171], v[212:215], v[124:127]
s_add_u32 s29, s33, 24576
s_nop 4
v_rcp_f32 v234, v224
s_nop 0
v_pk_mul_f32 v[120:121], v[120:121], v[234:235] op_sel_hi:[1,0]
v_pk_mul_f32 v[122:123], v[122:123], v[234:235] op_sel_hi:[1,0]
v_pk_mul_f32 v[124:125], v[124:125], v[234:235] op_sel_hi:[1,0]
v_pk_mul_f32 v[126:127], v[126:127], v[234:235] op_sel_hi:[1,0]
v_cvt_pk_bf16_f32 v212, v120, v121
v_cvt_pk_bf16_f32 v213, v122, v123
v_cvt_pk_bf16_f32 v214, v124, v125
v_cvt_pk_bf16_f32 v215, v126, v127
v_min_u32 v212, -2, v212
s_mov_b64 exec, s[40:41]
buffer_store_dwordx4 v[212:215], v11, s[84:87], s33 offen sc1
s_mov_b64 exec, -1
mega_kernel_rs_b3:
s_barrier
s_nop 15
buffer_load_dwordx4 v[32:35], v7, s[84:87], s29 offen offset:0 sc1
s_nop 9
buffer_load_dwordx4 v[36:39], v7, s[84:87], s29 offen offset:1024 sc1
s_nop 9
buffer_load_dwordx4 v[40:43], v7, s[84:87], s29 offen offset:2048 sc1
s_nop 9
buffer_load_dwordx4 v[44:47], v7, s[84:87], s29 offen offset:3072 sc1
mega_kernel_rs_pc_15_0:
s_waitcnt vmcnt(3)
v_cmp_eq_u32 vcc, -1, v32
s_cbranch_vccnz mega_kernel_rs_pc_15_0f
v_smfmac_f32_16x16x64_bf16 v[96:99], v[32:35], a[192:199], v6
v_smfmac_f32_16x16x64_bf16 v[100:103], v[32:35], a[224:231], v6
mega_kernel_rs_pc_14_1:
s_waitcnt vmcnt(2)
v_cmp_eq_u32 vcc, -1, v36
s_cbranch_vccnz mega_kernel_rs_pc_14_1f
v_smfmac_f32_16x16x64_bf16 v[96:99], v[36:39], a[200:207], v6
v_smfmac_f32_16x16x64_bf16 v[100:103], v[36:39], a[232:239], v6
mega_kernel_rs_pc_12_2:
s_waitcnt vmcnt(1)
v_cmp_eq_u32 vcc, -1, v40
s_cbranch_vccnz mega_kernel_rs_pc_12_2f
v_smfmac_f32_16x16x64_bf16 v[96:99], v[40:43], a[208:215], v6
v_smfmac_f32_16x16x64_bf16 v[100:103], v[40:43], a[240:247], v6
mega_kernel_rs_pc_8_3:
s_waitcnt vmcnt(0)
v_cmp_eq_u32 vcc, -1, v44
s_cbranch_vccnz mega_kernel_rs_pc_8_3f
v_smfmac_f32_16x16x64_bf16 v[96:99], v[44:47], a[216:223], v6
v_smfmac_f32_16x16x64_bf16 v[100:103], v[44:47], a[248:255], v6
mega_kernel_rs_pc_d:
s_nop 7
v_permlane32_swap_b32 v96, v100
v_permlane32_swap_b32 v97, v101
v_permlane32_swap_b32 v98, v102
v_permlane32_swap_b32 v99, v103
v_pk_add_f32 v[96:97], v[96:97], v[100:101]
v_pk_add_f32 v[98:99], v[98:99], v[102:103]
ds_write2_b32 v18, v96, v97 offset0:0 offset1:36
ds_write2_b32 v18, v98, v99 offset0:72 offset1:108
s_waitcnt lgkmcnt(0)
s_barrier
s_cmp_lg_u32 s24, 0
s_cbranch_scc1 mega_kernel_rs_x1
ds_read_b128 v[120:123], v19 offset:0
ds_read_b128 v[124:127], v19 offset:1152
ds_read_b128 v[128:131], v19 offset:2304
ds_read_b128 v[132:135], v19 offset:3456
s_waitcnt lgkmcnt(2)
v_pk_add_f32 v[120:121], v[120:121], v[124:125]
v_pk_add_f32 v[122:123], v[122:123], v[126:127]
s_waitcnt lgkmcnt(0)
v_pk_add_f32 v[128:129], v[128:129], v[132:133]
v_pk_add_f32 v[130:131], v[130:131], v[134:135]
v_pk_add_f32 v[120:121], v[120:121], v[128:129]
v_pk_add_f32 v[122:123], v[122:123], v[130:131]
v_fma_f32 v212, v120, s89, v120
v_cvt_pk_bf16_f32 v213, v122, v123
v_cvt_pk_bf16_f32 v212, v212, v121
v_and_or_b32 v212, v212, -2, s47
buffer_store_dwordx2 v[212:213], v12, s[84:87], s35 offen sc1
s_mov_b32 s77, 0x3f80
s_mov_b32 s78, 0x3f800000
s_xor_b32 s76, s47, 1
v_mov_b32 v48, s76
v_mov_b32 v50, s76
v_mov_b32 v52, s76
s_nop 8
v_mov_b32 v96, 0
v_mov_b32 v97, 0
v_mov_b32 v98, 0
v_mov_b32 v99, 0
v_mov_b32 v100, 0
v_mov_b32 v101, 0
v_mov_b32 v102, 0
v_mov_b32 v103, 0
v_mov_b32 v104, 0
v_mov_b32 v105, 0
v_mov_b32 v106, 0
v_mov_b32 v107, 0
v_mov_b32 v108, 0
v_mov_b32 v109, 0
v_mov_b32 v110, 0
v_mov_b32 v111, 0
v_mov_b32 v112, 0
v_mov_b32 v113, 0
v_mov_b32 v114, 0
v_mov_b32 v115, 0
v_mov_b32 v116, 0
v_mov_b32 v117, 0
v_mov_b32 v118, 0
v_mov_b32 v119, 0
s_nop 15
s_nop 7
s_cmp_eq_u32 s47, 1
s_cbranch_scc1 mega_kernel_rs_p4_1
.p2align 6
mega_kernel_rs_p4_0:
buffer_load_dwordx2 v[48:49], v25, s[84:87], s35 offen sc1
buffer_load_dwordx2 v[50:51], v26, s[84:87], s35 offen sc1
buffer_load_dwordx2 v[52:53], v27, s[84:87], s35 offen sc1
s_waitcnt vmcnt(12)
mega_kernel_rs_p4c_0:
v_bitop3_b32 v4, v48, v50, v52 bitop3:0xfe
v_and_b32 v4, 1, v4
v_cmp_ne_u32 vcc, 0, v4
s_cbranch_vccnz mega_kernel_rs_p4_0
v_dot2_f32_bf16 v120, v48, s77, v120
v_dot2_f32_bf16 v121, v48, s78, v121
v_dot2_f32_bf16 v122, v49, s77, v122
v_dot2_f32_bf16 v123, v49, s78, v123
v_dot2_f32_bf16 v120, v50, s77, v120
v_dot2_f32_bf16 v121, v50, s78, v121
v_dot2_f32_bf16 v122, v51, s77, v122
v_dot2_f32_bf16 v123, v51, s78, v123
v_dot2_f32_bf16 v120, v52, s77, v120
v_dot2_f32_bf16 v121, v52, s78, v121
v_dot2_f32_bf16 v122, v53, s77, v122
v_dot2_f32_bf16 v123, v53, s78, v123
s_nop 0
v_cvt_pk_bf16_f32 v212, v120, v121
v_min_u32 v212, -2, v212
v_cvt_pk_bf16_f32 v213, v122, v123
buffer_store_dwordx2 v[212:213], v9, s[84:87], s34 offen sc1
s_branch mega_kernel_rs_p4d
mega_kernel_rs_iw0:
mega_kernel_rs_il0:
s_cbranch_execz mega_kernel_rs_il1
.p2align 6
mega_kernel_rs_p4_1:
buffer_load_dwordx2 v[48:49], v25, s[84:87], s35 offen sc1
buffer_load_dwordx2 v[50:51], v26, s[84:87], s35 offen sc1
buffer_load_dwordx2 v[52:53], v27, s[84:87], s35 offen sc1
s_waitcnt vmcnt(12)
mega_kernel_rs_p4c_1:
v_bitop3_b32 v4, v48, v50, v52 bitop3:0x80
v_and_b32 v4, 1, v4
v_cmp_ne_u32 vcc, 1, v4
s_cbranch_vccnz mega_kernel_rs_p4_1
v_dot2_f32_bf16 v120, v48, s77, v120
v_dot2_f32_bf16 v121, v48, s78, v121
v_dot2_f32_bf16 v122, v49, s77, v122
v_dot2_f32_bf16 v123, v49, s78, v123
v_dot2_f32_bf16 v120, v50, s77, v120
v_dot2_f32_bf16 v121, v50, s78, v121
v_dot2_f32_bf16 v122, v51, s77, v122
v_dot2_f32_bf16 v123, v51, s78, v123
v_dot2_f32_bf16 v120, v52, s77, v120
v_dot2_f32_bf16 v121, v52, s78, v121
v_dot2_f32_bf16 v122, v53, s77, v122
v_dot2_f32_bf16 v123, v53, s78, v123
s_nop 0
v_cvt_pk_bf16_f32 v212, v120, v121
v_min_u32 v212, -2, v212
v_cvt_pk_bf16_f32 v213, v122, v123
buffer_store_dwordx2 v[212:213], v9, s[84:87], s34 offen sc1
mega_kernel_rs_p4d:
mega_kernel_rs_b5:
s_add_u32 s27, s27, 1
s_add_u32 s44, s44, 4096
s_cmp_eq_u32 s44, 30720
s_cselect_b32 s44, 18432, s44
s_mov_b32 s28, s33
s_mov_b32 s33, s34
s_mov_b32 s34, s28
s_xor_b32 s35, s35, 262144
s_bfe_u32 s47, s27, 0x10001
s_barrier
s_nop 15
s_branch mega_kernel_rs_loop
mega_kernel_rs_il1:
s_cbranch_execz mega_kernel_rs_il2
mega_kernel_rs_x1:
s_cmp_eq_u32 s24, 1
s_cbranch_scc0 mega_kernel_rs_x2
s_add_u32 s76, s27, 1
s_sleep 6
v_mov_b32 v5, s76
s_mov_b64 exec, 1
buffer_store_dword v5, v228, s[84:87], s81 offen sc1
s_mov_b64 exec, -1
mega_kernel_rs_x2:
s_cmp_eq_u32 s24, 3
s_cbranch_scc0 mega_kernel_rs_x4
s_cmp_eq_u32 s36, 1
s_cbranch_scc0 mega_kernel_rs_x5
s_add_u32 s76, s27, 1
s_cmp_gt_i32 s46, s76
s_cbranch_scc1 mega_kernel_rs_pf1ok
mega_kernel_rs_pf1w:
v_mov_b32 v4, 0
s_mov_b64 exec, 3
buffer_atomic_add v4, v24, s[84:87], 0 offen sc0 sc1
s_mov_b64 exec, -1
s_waitcnt vmcnt(0)
v_readlane_b32 s46, v4, 0
v_readlane_b32 s28, v4, 1
s_nop 1
s_min_i32 s46, s46, s28
s_cmp_gt_i32 s46, s76
s_cbranch_scc0 mega_kernel_rs_pf1w
mega_kernel_rs_pf1ok:
s_add_u32 s77, s76, s82
s_bfe_u32 s28, s77, 0x40002
s_lshl_b32 s28, s28, 14
s_and_b32 s77, s77, 3
s_lshl_b32 s77, s77, 11
s_add_u32 s28, s28, s77
s_add_u32 m0, s45, 0
s_nop 0
buffer_load_dwordx4 v240, s[84:87], s28 offen offset:0 sc1 lds
s_add_u32 m0, s45, 0
s_nop 0
buffer_load_dwordx4 v240, s[84:87], s28 offen offset:1024 sc1 lds
s_add_u32 m0, s45, 2048
s_nop 0
buffer_load_dwordx4 v241, s[84:87], s28 offen offset:0 sc1 lds
s_add_u32 m0, s45, 2048
s_nop 0
buffer_load_dwordx4 v241, s[84:87], s28 offen offset:1024 sc1 lds
s_add_u32 s45, s45, 4096
s_cmp_eq_u32 s45, 30720
s_cselect_b32 s45, 18432, s45
s_waitcnt vmcnt(0)
mega_kernel_rs_x5:
s_add_u32 s76, s27, 4
s_min_u32 s76, s76, 63
s_cmp_gt_i32 s46, s76
s_cbranch_scc1 mega_kernel_rs_x6
v_mov_b32 v249, 0
s_mov_b64 exec, 3
buffer_atomic_add v249, v24, s[84:87], 0 offen sc0 sc1
s_mov_b64 exec, -1
mega_kernel_rs_x6:
s_add_u32 s76, s27, 2
s_cmp_lt_u32 s76, 63
s_cbranch_scc0 mega_kernel_rs_x4
s_cmp_gt_i32 s46, s76
s_cbranch_scc0 mega_kernel_rs_x4
s_add_u32 s77, s76, s82
s_bfe_u32 s28, s77, 0x40002
s_lshl_b32 s28, s28, 14
s_and_b32 s77, s77, 3
s_lshl_b32 s77, s77, 11
s_add_u32 s28, s28, s77
s_add_u32 s28, s28, s83
s_add_u32 s28, s28, 33554432
s_buffer_load_dword s78, s[84:87], s28 offset:0
s_buffer_load_dword s78, s[84:87], s28 offset:128
s_buffer_load_dword s78, s[84:87], s28 offset:256
s_buffer_load_dword s78, s[84:87], s28 offset:384
s_buffer_load_dword s78, s[84:87], s28 offset:512
s_buffer_load_dword s78, s[84:87], s28 offset:640
s_buffer_load_dword s78, s[84:87], s28 offset:768
s_buffer_load_dword s78, s[84:87], s28 offset:896
s_buffer_load_dword s78, s[84:87], s28 offset:1024
s_buffer_load_dword s78, s[84:87], s28 offset:1152
s_buffer_load_dword s78, s[84:87], s28 offset:1280
s_buffer_load_dword s78, s[84:87], s28 offset:1408
s_buffer_load_dword s78, s[84:87], s28 offset:1536
s_buffer_load_dword s78, s[84:87], s28 offset:1664
s_buffer_load_dword s78, s[84:87], s28 offset:1792
s_buffer_load_dword s78, s[84:87], s28 offset:1920
mega_kernel_rs_x4:
v_mov_b32 v96, 0
v_mov_b32 v97, 0
v_mov_b32 v98, 0
v_mov_b32 v99, 0
v_mov_b32 v100, 0
v_mov_b32 v101, 0
v_mov_b32 v102, 0
v_mov_b32 v103, 0
v_mov_b32 v104, 0
v_mov_b32 v105, 0
v_mov_b32 v106, 0
v_mov_b32 v107, 0
v_mov_b32 v108, 0
v_mov_b32 v109, 0
v_mov_b32 v110, 0
v_mov_b32 v111, 0
v_mov_b32 v112, 0
v_mov_b32 v113, 0
v_mov_b32 v114, 0
v_mov_b32 v115, 0
v_mov_b32 v116, 0
v_mov_b32 v117, 0
v_mov_b32 v118, 0
v_mov_b32 v119, 0
s_branch mega_kernel_rs_b5
mega_kernel_rs_il2:
s_cbranch_execz mega_kernel_rs_il3
mega_kernel_rs_p2r:
s_mov_b64 exec, s[42:43]
buffer_load_dwordx4 v[188:191], v10, s[84:87], s76 offen sc1
buffer_load_dwordx4 v[196:199], v10, s[84:87], s77 offen sc1
buffer_load_dwordx4 v[204:207], v10, s[84:87], s78 offen sc1
s_mov_b64 exec, -1
buffer_load_dwordx4 v[184:187], v17, s[84:87], s76 offen sc1
buffer_load_dwordx4 v[192:195], v17, s[84:87], s77 offen sc1
buffer_load_dwordx4 v[200:203], v17, s[84:87], s78 offen sc1
s_branch mega_kernel_rs_p2
mega_kernel_rs_il3:
s_cbranch_execz mega_kernel_rs_il4
.p2align 5
mega_kernel_rs_pa_1_0f:
s_mov_b64 exec, vcc
buffer_load_dwordx4 v[32:35], v7, s[84:87], s33 offen offset:0 sc1
s_mov_b64 exec, -1
s_branch mega_kernel_rs_pa_1_0
.p2align 5
mega_kernel_rs_pa_1_0:
s_waitcnt vmcnt(0)
v_max_u32 v4, v32, v34
v_cmp_eq_u32 vcc, -1, v4
s_cbranch_vccnz mega_kernel_rs_pa_1_0f
v_smfmac_f32_16x16x64_bf16 v[96:99], v[32:35], a[0:7], v6
v_smfmac_f32_16x16x64_bf16 v[100:103], v[32:35], a[32:39], v6
v_smfmac_f32_16x16x64_bf16 v[104:107], v[32:35], a[64:71], v6
v_smfmac_f32_16x16x64_bf16 v[108:111], v[32:35], a[96:103], v6
s_branch mega_kernel_rs_pa_d
mega_kernel_rs_il4:
s_cbranch_execz mega_kernel_rs_il5
.p2align 5
mega_kernel_rs_pa_2_1f:
s_mov_b64 exec, vcc
buffer_load_dwordx4 v[36:39], v7, s[84:87], s33 offen offset:1024 sc1
s_mov_b64 exec, -1
s_branch mega_kernel_rs_pa_2_1
.p2align 5
mega_kernel_rs_pa_2_1:
s_waitcnt vmcnt(0)
v_max_u32 v4, v36, v38
v_cmp_eq_u32 vcc, -1, v4
s_cbranch_vccnz mega_kernel_rs_pa_2_1f
v_smfmac_f32_16x16x64_bf16 v[96:99], v[36:39], a[8:15], v6
v_smfmac_f32_16x16x64_bf16 v[100:103], v[36:39], a[40:47], v6
v_smfmac_f32_16x16x64_bf16 v[104:107], v[36:39], a[72:79], v6
v_smfmac_f32_16x16x64_bf16 v[108:111], v[36:39], a[104:111], v6
s_branch mega_kernel_rs_pa_d
mega_kernel_rs_il5:
s_cbranch_execz mega_kernel_rs_il6
.p2align 5
mega_kernel_rs_pa_3_0f:
s_mov_b64 exec, vcc
buffer_load_dwordx4 v[32:35], v7, s[84:87], s33 offen offset:0 sc1
s_mov_b64 exec, -1
s_branch mega_kernel_rs_pa_3_1
.p2align 5
mega_kernel_rs_pa_3_0:
s_waitcnt vmcnt(1)
v_max_u32 v4, v32, v34
v_cmp_eq_u32 vcc, -1, v4
s_cbranch_vccnz mega_kernel_rs_pa_3_0f
v_smfmac_f32_16x16x64_bf16 v[96:99], v[32:35], a[0:7], v6
v_smfmac_f32_16x16x64_bf16 v[100:103], v[32:35], a[32:39], v6
v_smfmac_f32_16x16x64_bf16 v[104:107], v[32:35], a[64:71], v6
v_smfmac_f32_16x16x64_bf16 v[108:111], v[32:35], a[96:103], v6
s_branch mega_kernel_rs_pa_2_1
mega_kernel_rs_il6:
s_cbranch_execz mega_kernel_rs_il7
.p2align 5
mega_kernel_rs_pa_3_1f:
s_mov_b64 exec, vcc
buffer_load_dwordx4 v[36:39], v7, s[84:87], s33 offen offset:1024 sc1
s_mov_b64 exec, -1
s_branch mega_kernel_rs_pa_3_0
.p2align 5
mega_kernel_rs_pa_3_1:
s_waitcnt vmcnt(1)
v_max_u32 v4, v36, v38
v_cmp_eq_u32 vcc, -1, v4
s_cbranch_vccnz mega_kernel_rs_pa_3_1f
v_smfmac_f32_16x16x64_bf16 v[96:99], v[36:39], a[8:15], v6
v_smfmac_f32_16x16x64_bf16 v[100:103], v[36:39], a[40:47], v6
v_smfmac_f32_16x16x64_bf16 v[104:107], v[36:39], a[72:79], v6
v_smfmac_f32_16x16x64_bf16 v[108:111], v[36:39], a[104:111], v6
s_branch mega_kernel_rs_pa_1_0
mega_kernel_rs_il7:
s_cbranch_execz mega_kernel_rs_il8
.p2align 5
mega_kernel_rs_pa_4_2f:
s_mov_b64 exec, vcc
buffer_load_dwordx4 v[40:43], v7, s[84:87], s33 offen offset:2048 sc1
s_mov_b64 exec, -1
s_branch mega_kernel_rs_pa_4_2
.p2align 5
mega_kernel_rs_pa_4_2:
s_waitcnt vmcnt(0)
v_max_u32 v4, v40, v42
v_cmp_eq_u32 vcc, -1, v4
s_cbranch_vccnz mega_kernel_rs_pa_4_2f
v_smfmac_f32_16x16x64_bf16 v[96:99], v[40:43], a[16:23], v6
v_smfmac_f32_16x16x64_bf16 v[100:103], v[40:43], a[48:55], v6
v_smfmac_f32_16x16x64_bf16 v[104:107], v[40:43], a[80:87], v6
v_smfmac_f32_16x16x64_bf16 v[108:111], v[40:43], a[112:119], v6
s_branch mega_kernel_rs_pa_d
mega_kernel_rs_il8:
s_cbranch_execz mega_kernel_rs_il9
.p2align 5
mega_kernel_rs_pa_5_0f:
s_mov_b64 exec, vcc
buffer_load_dwordx4 v[32:35], v7, s[84:87], s33 offen offset:0 sc1
s_mov_b64 exec, -1
s_branch mega_kernel_rs_pa_5_2
.p2align 5
mega_kernel_rs_pa_5_0:
s_waitcnt vmcnt(1)
v_max_u32 v4, v32, v34
v_cmp_eq_u32 vcc, -1, v4
s_cbranch_vccnz mega_kernel_rs_pa_5_0f
v_smfmac_f32_16x16x64_bf16 v[96:99], v[32:35], a[0:7], v6
v_smfmac_f32_16x16x64_bf16 v[100:103], v[32:35], a[32:39], v6
v_smfmac_f32_16x16x64_bf16 v[104:107], v[32:35], a[64:71], v6
v_smfmac_f32_16x16x64_bf16 v[108:111], v[32:35], a[96:103], v6
s_branch mega_kernel_rs_pa_4_2
mega_kernel_rs_il9:
s_cbranch_execz mega_kernel_rs_il10
.p2align 5
mega_kernel_rs_pa_5_2f:
s_mov_b64 exec, vcc
buffer_load_dwordx4 v[40:43], v7, s[84:87], s33 offen offset:2048 sc1
s_mov_b64 exec, -1
s_branch mega_kernel_rs_pa_5_0
.p2align 5
mega_kernel_rs_pa_5_2:
s_waitcnt vmcnt(1)
v_max_u32 v4, v40, v42
v_cmp_eq_u32 vcc, -1, v4
s_cbranch_vccnz mega_kernel_rs_pa_5_2f
v_smfmac_f32_16x16x64_bf16 v[96:99], v[40:43], a[16:23], v6
v_smfmac_f32_16x16x64_bf16 v[100:103], v[40:43], a[48:55], v6
v_smfmac_f32_16x16x64_bf16 v[104:107], v[40:43], a[80:87], v6
v_smfmac_f32_16x16x64_bf16 v[108:111], v[40:43], a[112:119], v6
s_branch mega_kernel_rs_pa_1_0
mega_kernel_rs_il10:
s_cbranch_execz mega_kernel_rs_il11
.p2align 5
mega_kernel_rs_pa_6_1f:
s_mov_b64 exec, vcc
buffer_load_dwordx4 v[36:39], v7, s[84:87], s33 offen offset:1024 sc1
s_mov_b64 exec, -1
s_branch mega_kernel_rs_pa_6_2
.p2align 5
mega_kernel_rs_pa_6_1:
s_waitcnt vmcnt(1)
v_max_u32 v4, v36, v38
v_cmp_eq_u32 vcc, -1, v4
s_cbranch_vccnz mega_kernel_rs_pa_6_1f
v_smfmac_f32_16x16x64_bf16 v[96:99], v[36:39], a[8:15], v6
v_smfmac_f32_16x16x64_bf16 v[100:103], v[36:39], a[40:47], v6
v_smfmac_f32_16x16x64_bf16 v[104:107], v[36:39], a[72:79], v6
v_smfmac_f32_16x16x64_bf16 v[108:111], v[36:39], a[104:111], v6
s_branch mega_kernel_rs_pa_4_2
mega_kernel_rs_il11:
s_cbranch_execz mega_kernel_rs_il12
.p2align 5
mega_kernel_rs_pa_6_2f:
s_mov_b64 exec, vcc
buffer_load_dwordx4 v[40:43], v7, s[84:87], s33 offen offset:2048 sc1
s_mov_b64 exec, -1
s_branch mega_kernel_rs_pa_6_1
.p2align 5
mega_kernel_rs_pa_6_2:
s_waitcnt vmcnt(1)
v_max_u32 v4, v40, v42
v_cmp_eq_u32 vcc, -1, v4
s_cbranch_vccnz mega_kernel_rs_pa_6_2f
v_smfmac_f32_16x16x64_bf16 v[96:99], v[40:43], a[16:23], v6
v_smfmac_f32_16x16x64_bf16 v[100:103], v[40:43], a[48:55], v6
v_smfmac_f32_16x16x64_bf16 v[104:107], v[40:43], a[80:87], v6
v_smfmac_f32_16x16x64_bf16 v[108:111], v[40:43], a[112:119], v6
s_branch mega_kernel_rs_pa_2_1
mega_kernel_rs_il12:
s_cbranch_execz mega_kernel_rs_il13
.p2align 5
mega_kernel_rs_pa_7_0f:
s_mov_b64 exec, vcc
buffer_load_dwordx4 v[32:35], v7, s[84:87], s33 offen offset:0 sc1
s_mov_b64 exec, -1
s_branch mega_kernel_rs_pa_7_1
.p2align 5
mega_kernel_rs_pa_7_0:
s_waitcnt vmcnt(2)
v_max_u32 v4, v32, v34
v_cmp_eq_u32 vcc, -1, v4
s_cbranch_vccnz mega_kernel_rs_pa_7_0f
v_smfmac_f32_16x16x64_bf16 v[96:99], v[32:35], a[0:7], v6
v_smfmac_f32_16x16x64_bf16 v[100:103], v[32:35], a[32:39], v6
v_smfmac_f32_16x16x64_bf16 v[104:107], v[32:35], a[64:71], v6
v_smfmac_f32_16x16x64_bf16 v[108:111], v[32:35], a[96:103], v6
s_branch mega_kernel_rs_pa_6_1
mega_kernel_rs_il13:
s_cbranch_execz mega_kernel_rs_il14
.p2align 5
mega_kernel_rs_pa_7_1f:
s_mov_b64 exec, vcc
buffer_load_dwordx4 v[36:39], v7, s[84:87], s33 offen offset:1024 sc1
s_mov_b64 exec, -1
s_branch mega_kernel_rs_pa_7_2
.p2align 5
mega_kernel_rs_pa_7_1:
s_waitcnt vmcnt(2)
v_max_u32 v4, v36, v38
v_cmp_eq_u32 vcc, -1, v4
s_cbranch_vccnz mega_kernel_rs_pa_7_1f
v_smfmac_f32_16x16x64_bf16 v[96:99], v[36:39], a[8:15], v6
v_smfmac_f32_16x16x64_bf16 v[100:103], v[36:39], a[40:47], v6
v_smfmac_f32_16x16x64_bf16 v[104:107], v[36:39], a[72:79], v6
v_smfmac_f32_16x16x64_bf16 v[108:111], v[36:39], a[104:111], v6
s_branch mega_kernel_rs_pa_5_2
mega_kernel_rs_il14:
s_cbranch_execz mega_kernel_rs_il15
.p2align 5
mega_kernel_rs_pa_7_2f:
s_mov_b64 exec, vcc
buffer_load_dwordx4 v[40:43], v7, s[84:87], s33 offen offset:2048 sc1
s_mov_b64 exec, -1
s_branch mega_kernel_rs_pa_7_0
.p2align 5
mega_kernel_rs_pa_7_2:
s_waitcnt vmcnt(2)
v_max_u32 v4, v40, v42
v_cmp_eq_u32 vcc, -1, v4
s_cbranch_vccnz mega_kernel_rs_pa_7_2f
v_smfmac_f32_16x16x64_bf16 v[96:99], v[40:43], a[16:23], v6
v_smfmac_f32_16x16x64_bf16 v[100:103], v[40:43], a[48:55], v6
v_smfmac_f32_16x16x64_bf16 v[104:107], v[40:43], a[80:87], v6
v_smfmac_f32_16x16x64_bf16 v[108:111], v[40:43], a[112:119], v6
s_branch mega_kernel_rs_pa_3_0
mega_kernel_rs_il15:
s_cbranch_execz mega_kernel_rs_il16
.p2align 5
mega_kernel_rs_pa_8_3f:
s_mov_b64 exec, vcc
buffer_load_dwordx4 v[44:47], v7, s[84:87], s33 offen offset:3072 sc1
s_mov_b64 exec, -1
s_branch mega_kernel_rs_pa_8_3
.p2align 5
mega_kernel_rs_pa_8_3:
s_waitcnt vmcnt(0)
v_max_u32 v4, v44, v46
v_cmp_eq_u32 vcc, -1, v4
s_cbranch_vccnz mega_kernel_rs_pa_8_3f
v_smfmac_f32_16x16x64_bf16 v[96:99], v[44:47], a[24:31], v6
v_smfmac_f32_16x16x64_bf16 v[100:103], v[44:47], a[56:63], v6
v_smfmac_f32_16x16x64_bf16 v[104:107], v[44:47], a[88:95], v6
v_smfmac_f32_16x16x64_bf16 v[108:111], v[44:47], a[120:127], v6
s_branch mega_kernel_rs_pa_d
mega_kernel_rs_il16:
s_cbranch_execz mega_kernel_rs_il17
.p2align 5
mega_kernel_rs_pa_9_0f:
s_mov_b64 exec, vcc
buffer_load_dwordx4 v[32:35], v7, s[84:87], s33 offen offset:0 sc1
s_mov_b64 exec, -1
s_branch mega_kernel_rs_pa_9_3
.p2align 5
mega_kernel_rs_pa_9_0:
s_waitcnt vmcnt(1)
v_max_u32 v4, v32, v34
v_cmp_eq_u32 vcc, -1, v4
s_cbranch_vccnz mega_kernel_rs_pa_9_0f
v_smfmac_f32_16x16x64_bf16 v[96:99], v[32:35], a[0:7], v6
v_smfmac_f32_16x16x64_bf16 v[100:103], v[32:35], a[32:39], v6
v_smfmac_f32_16x16x64_bf16 v[104:107], v[32:35], a[64:71], v6
v_smfmac_f32_16x16x64_bf16 v[108:111], v[32:35], a[96:103], v6
s_branch mega_kernel_rs_pa_8_3
mega_kernel_rs_il17:
s_cbranch_execz mega_kernel_rs_il18
.p2align 5
mega_kernel_rs_pa_9_3f:
s_mov_b64 exec, vcc
buffer_load_dwordx4 v[44:47], v7, s[84:87], s33 offen offset:3072 sc1
s_mov_b64 exec, -1
s_branch mega_kernel_rs_pa_9_0
.p2align 5
mega_kernel_rs_pa_9_3:
s_waitcnt vmcnt(1)
v_max_u32 v4, v44, v46
v_cmp_eq_u32 vcc, -1, v4
s_cbranch_vccnz mega_kernel_rs_pa_9_3f
v_smfmac_f32_16x16x64_bf16 v[96:99], v[44:47], a[24:31], v6
v_smfmac_f32_16x16x64_bf16 v[100:103], v[44:47], a[56:63], v6
v_smfmac_f32_16x16x64_bf16 v[104:107], v[44:47], a[88:95], v6
v_smfmac_f32_16x16x64_bf16 v[108:111], v[44:47], a[120:127], v6
s_branch mega_kernel_rs_pa_1_0
mega_kernel_rs_il18:
s_cbranch_execz mega_kernel_rs_iwd
.p2align 5
mega_kernel_rs_pa_10_1f:
s_mov_b64 exec, vcc
buffer_load_dwordx4 v[36:39], v7, s[84:87], s33 offen offset:1024 sc1
s_mov_b64 exec, -1
s_branch mega_kernel_rs_pa_10_3
.p2align 5
mega_kernel_rs_pa_10_1:
s_waitcnt vmcnt(1)
v_max_u32 v4, v36, v38
v_cmp_eq_u32 vcc, -1, v4
s_cbranch_vccnz mega_kernel_rs_pa_10_1f
v_smfmac_f32_16x16x64_bf16 v[96:99], v[36:39], a[8:15], v6
v_smfmac_f32_16x16x64_bf16 v[100:103], v[36:39], a[40:47], v6
v_smfmac_f32_16x16x64_bf16 v[104:107], v[36:39], a[72:79], v6
v_smfmac_f32_16x16x64_bf16 v[108:111], v[36:39], a[104:111], v6
s_branch mega_kernel_rs_pa_8_3
mega_kernel_rs_iw1:
mega_kernel_rs_il19:
s_cbranch_execz mega_kernel_rs_il20
.p2align 5
mega_kernel_rs_pa_10_3f:
s_mov_b64 exec, vcc
buffer_load_dwordx4 v[44:47], v7, s[84:87], s33 offen offset:3072 sc1
s_mov_b64 exec, -1
s_branch mega_kernel_rs_pa_10_1
.p2align 5
mega_kernel_rs_pa_10_3:
s_waitcnt vmcnt(1)
v_max_u32 v4, v44, v46
v_cmp_eq_u32 vcc, -1, v4
s_cbranch_vccnz mega_kernel_rs_pa_10_3f
v_smfmac_f32_16x16x64_bf16 v[96:99], v[44:47], a[24:31], v6
v_smfmac_f32_16x16x64_bf16 v[100:103], v[44:47], a[56:63], v6
v_smfmac_f32_16x16x64_bf16 v[104:107], v[44:47], a[88:95], v6
v_smfmac_f32_16x16x64_bf16 v[108:111], v[44:47], a[120:127], v6
s_branch mega_kernel_rs_pa_2_1
mega_kernel_rs_il20:
s_cbranch_execz mega_kernel_rs_il21
.p2align 5
mega_kernel_rs_pa_11_0f:
s_mov_b64 exec, vcc
buffer_load_dwordx4 v[32:35], v7, s[84:87], s33 offen offset:0 sc1
s_mov_b64 exec, -1
s_branch mega_kernel_rs_pa_11_1
.p2align 5
mega_kernel_rs_pa_11_0:
s_waitcnt vmcnt(2)
v_max_u32 v4, v32, v34
v_cmp_eq_u32 vcc, -1, v4
s_cbranch_vccnz mega_kernel_rs_pa_11_0f
v_smfmac_f32_16x16x64_bf16 v[96:99], v[32:35], a[0:7], v6
v_smfmac_f32_16x16x64_bf16 v[100:103], v[32:35], a[32:39], v6
v_smfmac_f32_16x16x64_bf16 v[104:107], v[32:35], a[64:71], v6
v_smfmac_f32_16x16x64_bf16 v[108:111], v[32:35], a[96:103], v6
s_branch mega_kernel_rs_pa_10_1
mega_kernel_rs_il21:
s_cbranch_execz mega_kernel_rs_il22
.p2align 5
mega_kernel_rs_pa_11_1f:
s_mov_b64 exec, vcc
buffer_load_dwordx4 v[36:39], v7, s[84:87], s33 offen offset:1024 sc1
s_mov_b64 exec, -1
s_branch mega_kernel_rs_pa_11_3
.p2align 5
mega_kernel_rs_pa_11_1:
s_waitcnt vmcnt(2)
v_max_u32 v4, v36, v38
v_cmp_eq_u32 vcc, -1, v4
s_cbranch_vccnz mega_kernel_rs_pa_11_1f
v_smfmac_f32_16x16x64_bf16 v[96:99], v[36:39], a[8:15], v6
v_smfmac_f32_16x16x64_bf16 v[100:103], v[36:39], a[40:47], v6
v_smfmac_f32_16x16x64_bf16 v[104:107], v[36:39], a[72:79], v6
v_smfmac_f32_16x16x64_bf16 v[108:111], v[36:39], a[104:111], v6
s_branch mega_kernel_rs_pa_9_3
mega_kernel_rs_il22:
s_cbranch_execz mega_kernel_rs_il23
.p2align 5
mega_kernel_rs_pa_11_3f:
s_mov_b64 exec, vcc
buffer_load_dwordx4 v[44:47], v7, s[84:87], s33 offen offset:3072 sc1
s_mov_b64 exec, -1
s_branch mega_kernel_rs_pa_11_0
.p2align 5
mega_kernel_rs_pa_11_3:
s_waitcnt vmcnt(2)
v_max_u32 v4, v44, v46
v_cmp_eq_u32 vcc, -1, v4
s_cbranch_vccnz mega_kernel_rs_pa_11_3f
v_smfmac_f32_16x16x64_bf16 v[96:99], v[44:47], a[24:31], v6
v_smfmac_f32_16x16x64_bf16 v[100:103], v[44:47], a[56:63], v6
v_smfmac_f32_16x16x64_bf16 v[104:107], v[44:47], a[88:95], v6
v_smfmac_f32_16x16x64_bf16 v[108:111], v[44:47], a[120:127], v6
s_branch mega_kernel_rs_pa_3_0
mega_kernel_rs_il23:
s_cbranch_execz mega_kernel_rs_il24
.p2align 5
mega_kernel_rs_pa_12_2f:
s_mov_b64 exec, vcc
buffer_load_dwordx4 v[40:43], v7, s[84:87], s33 offen offset:2048 sc1
s_mov_b64 exec, -1
s_branch mega_kernel_rs_pa_12_3
.p2align 5
mega_kernel_rs_pa_12_2:
s_waitcnt vmcnt(1)
v_max_u32 v4, v40, v42
v_cmp_eq_u32 vcc, -1, v4
s_cbranch_vccnz mega_kernel_rs_pa_12_2f
v_smfmac_f32_16x16x64_bf16 v[96:99], v[40:43], a[16:23], v6
v_smfmac_f32_16x16x64_bf16 v[100:103], v[40:43], a[48:55], v6
v_smfmac_f32_16x16x64_bf16 v[104:107], v[40:43], a[80:87], v6
v_smfmac_f32_16x16x64_bf16 v[108:111], v[40:43], a[112:119], v6
s_branch mega_kernel_rs_pa_8_3
mega_kernel_rs_il24:
s_cbranch_execz mega_kernel_rs_il25
.p2align 5
mega_kernel_rs_pa_12_3f:
s_mov_b64 exec, vcc
buffer_load_dwordx4 v[44:47], v7, s[84:87], s33 offen offset:3072 sc1
s_mov_b64 exec, -1
s_branch mega_kernel_rs_pa_12_2
.p2align 5
mega_kernel_rs_pa_12_3:
s_waitcnt vmcnt(1)
v_max_u32 v4, v44, v46
v_cmp_eq_u32 vcc, -1, v4
s_cbranch_vccnz mega_kernel_rs_pa_12_3f
v_smfmac_f32_16x16x64_bf16 v[96:99], v[44:47], a[24:31], v6
v_smfmac_f32_16x16x64_bf16 v[100:103], v[44:47], a[56:63], v6
v_smfmac_f32_16x16x64_bf16 v[104:107], v[44:47], a[88:95], v6
v_smfmac_f32_16x16x64_bf16 v[108:111], v[44:47], a[120:127], v6
s_branch mega_kernel_rs_pa_4_2
mega_kernel_rs_il25:
s_cbranch_execz mega_kernel_rs_il26
.p2align 5
mega_kernel_rs_pa_13_0f:
s_mov_b64 exec, vcc
buffer_load_dwordx4 v[32:35], v7, s[84:87], s33 offen offset:0 sc1
s_mov_b64 exec, -1
s_branch mega_kernel_rs_pa_13_2
.p2align 5
mega_kernel_rs_pa_13_0:
s_waitcnt vmcnt(2)
v_max_u32 v4, v32, v34
v_cmp_eq_u32 vcc, -1, v4
s_cbranch_vccnz mega_kernel_rs_pa_13_0f
v_smfmac_f32_16x16x64_bf16 v[96:99], v[32:35], a[0:7], v6
v_smfmac_f32_16x16x64_bf16 v[100:103], v[32:35], a[32:39], v6
v_smfmac_f32_16x16x64_bf16 v[104:107], v[32:35], a[64:71], v6
v_smfmac_f32_16x16x64_bf16 v[108:111], v[32:35], a[96:103], v6
s_branch mega_kernel_rs_pa_12_2
mega_kernel_rs_il26:
s_cbranch_execz mega_kernel_rs_il27
.p2align 5
mega_kernel_rs_pa_13_2f:
s_mov_b64 exec, vcc
buffer_load_dwordx4 v[40:43], v7, s[84:87], s33 offen offset:2048 sc1
s_mov_b64 exec, -1
s_branch mega_kernel_rs_pa_13_3
.p2align 5
mega_kernel_rs_pa_13_2:
s_waitcnt vmcnt(2)
v_max_u32 v4, v40, v42
v_cmp_eq_u32 vcc, -1, v4
s_cbranch_vccnz mega_kernel_rs_pa_13_2f
v_smfmac_f32_16x16x64_bf16 v[96:99], v[40:43], a[16:23], v6
v_smfmac_f32_16x16x64_bf16 v[100:103], v[40:43], a[48:55], v6
v_smfmac_f32_16x16x64_bf16 v[104:107], v[40:43], a[80:87], v6
v_smfmac_f32_16x16x64_bf16 v[108:111], v[40:43], a[112:119], v6
s_branch mega_kernel_rs_pa_9_3
mega_kernel_rs_il27:
s_cbranch_execz mega_kernel_rs_il28
.p2align 5
mega_kernel_rs_pa_13_3f:
s_mov_b64 exec, vcc
buffer_load_dwordx4 v[44:47], v7, s[84:87], s33 offen offset:3072 sc1
s_mov_b64 exec, -1
s_branch mega_kernel_rs_pa_13_0
.p2align 5
mega_kernel_rs_pa_13_3:
s_waitcnt vmcnt(2)
v_max_u32 v4, v44, v46
v_cmp_eq_u32 vcc, -1, v4
s_cbranch_vccnz mega_kernel_rs_pa_13_3f
v_smfmac_f32_16x16x64_bf16 v[96:99], v[44:47], a[24:31], v6
v_smfmac_f32_16x16x64_bf16 v[100:103], v[44:47], a[56:63], v6
v_smfmac_f32_16x16x64_bf16 v[104:107], v[44:47], a[88:95], v6
v_smfmac_f32_16x16x64_bf16 v[108:111], v[44:47], a[120:127], v6
s_branch mega_kernel_rs_pa_5_0
mega_kernel_rs_il28:
s_cbranch_execz mega_kernel_rs_il29
.p2align 5
mega_kernel_rs_pa_14_1f:
s_mov_b64 exec, vcc
buffer_load_dwordx4 v[36:39], v7, s[84:87], s33 offen offset:1024 sc1
s_mov_b64 exec, -1
s_branch mega_kernel_rs_pa_14_2
.p2align 5
mega_kernel_rs_pa_14_1:
s_waitcnt vmcnt(2)
v_max_u32 v4, v36, v38
v_cmp_eq_u32 vcc, -1, v4
s_cbranch_vccnz mega_kernel_rs_pa_14_1f
v_smfmac_f32_16x16x64_bf16 v[96:99], v[36:39], a[8:15], v6
v_smfmac_f32_16x16x64_bf16 v[100:103], v[36:39], a[40:47], v6
v_smfmac_f32_16x16x64_bf16 v[104:107], v[36:39], a[72:79], v6
v_smfmac_f32_16x16x64_bf16 v[108:111], v[36:39], a[104:111], v6
s_branch mega_kernel_rs_pa_12_2
mega_kernel_rs_il29:
s_cbranch_execz mega_kernel_rs_il30
.p2align 5
mega_kernel_rs_pa_14_2f:
s_mov_b64 exec, vcc
buffer_load_dwordx4 v[40:43], v7, s[84:87], s33 offen offset:2048 sc1
s_mov_b64 exec, -1
s_branch mega_kernel_rs_pa_14_3
.p2align 5
mega_kernel_rs_pa_14_2:
s_waitcnt vmcnt(2)
v_max_u32 v4, v40, v42
v_cmp_eq_u32 vcc, -1, v4
s_cbranch_vccnz mega_kernel_rs_pa_14_2f
v_smfmac_f32_16x16x64_bf16 v[96:99], v[40:43], a[16:23], v6
v_smfmac_f32_16x16x64_bf16 v[100:103], v[40:43], a[48:55], v6
v_smfmac_f32_16x16x64_bf16 v[104:107], v[40:43], a[80:87], v6
v_smfmac_f32_16x16x64_bf16 v[108:111], v[40:43], a[112:119], v6
s_branch mega_kernel_rs_pa_10_3
mega_kernel_rs_il30:
s_cbranch_execz mega_kernel_rs_il31
.p2align 5
mega_kernel_rs_pa_14_3f:
s_mov_b64 exec, vcc
buffer_load_dwordx4 v[44:47], v7, s[84:87], s33 offen offset:3072 sc1
s_mov_b64 exec, -1
s_branch mega_kernel_rs_pa_14_1
.p2align 5
mega_kernel_rs_pa_14_3:
s_waitcnt vmcnt(2)
v_max_u32 v4, v44, v46
v_cmp_eq_u32 vcc, -1, v4
s_cbranch_vccnz mega_kernel_rs_pa_14_3f
v_smfmac_f32_16x16x64_bf16 v[96:99], v[44:47], a[24:31], v6
v_smfmac_f32_16x16x64_bf16 v[100:103], v[44:47], a[56:63], v6
v_smfmac_f32_16x16x64_bf16 v[104:107], v[44:47], a[88:95], v6
v_smfmac_f32_16x16x64_bf16 v[108:111], v[44:47], a[120:127], v6
s_branch mega_kernel_rs_pa_6_1
mega_kernel_rs_il31:
s_cbranch_execz mega_kernel_rs_il32
.p2align 5
mega_kernel_rs_pa_15_0f:
s_mov_b64 exec, vcc
buffer_load_dwordx4 v[32:35], v7, s[84:87], s33 offen offset:0 sc1
s_mov_b64 exec, -1
s_branch mega_kernel_rs_pa_15_1
.p2align 5
mega_kernel_rs_pa_15_0:
s_waitcnt vmcnt(3)
v_max_u32 v4, v32, v34
v_cmp_eq_u32 vcc, -1, v4
s_cbranch_vccnz mega_kernel_rs_pa_15_0f
v_smfmac_f32_16x16x64_bf16 v[96:99], v[32:35], a[0:7], v6
v_smfmac_f32_16x16x64_bf16 v[100:103], v[32:35], a[32:39], v6
v_smfmac_f32_16x16x64_bf16 v[104:107], v[32:35], a[64:71], v6
v_smfmac_f32_16x16x64_bf16 v[108:111], v[32:35], a[96:103], v6
s_branch mega_kernel_rs_pa_14_1
mega_kernel_rs_il32:
s_cbranch_execz mega_kernel_rs_il33
.p2align 5
mega_kernel_rs_pa_15_1f:
s_mov_b64 exec, vcc
buffer_load_dwordx4 v[36:39], v7, s[84:87], s33 offen offset:1024 sc1
s_mov_b64 exec, -1
s_branch mega_kernel_rs_pa_15_2
.p2align 5
mega_kernel_rs_pa_15_1:
s_waitcnt vmcnt(3)
v_max_u32 v4, v36, v38
v_cmp_eq_u32 vcc, -1, v4
s_cbranch_vccnz mega_kernel_rs_pa_15_1f
v_smfmac_f32_16x16x64_bf16 v[96:99], v[36:39], a[8:15], v6
v_smfmac_f32_16x16x64_bf16 v[100:103], v[36:39], a[40:47], v6
v_smfmac_f32_16x16x64_bf16 v[104:107], v[36:39], a[72:79], v6
v_smfmac_f32_16x16x64_bf16 v[108:111], v[36:39], a[104:111], v6
s_branch mega_kernel_rs_pa_13_2
mega_kernel_rs_il33:
s_cbranch_execz mega_kernel_rs_il34
.p2align 5
mega_kernel_rs_pa_15_2f:
s_mov_b64 exec, vcc
buffer_load_dwordx4 v[40:43], v7, s[84:87], s33 offen offset:2048 sc1
s_mov_b64 exec, -1
s_branch mega_kernel_rs_pa_15_3
.p2align 5
mega_kernel_rs_pa_15_2:
s_waitcnt vmcnt(3)
v_max_u32 v4, v40, v42
v_cmp_eq_u32 vcc, -1, v4
s_cbranch_vccnz mega_kernel_rs_pa_15_2f
v_smfmac_f32_16x16x64_bf16 v[96:99], v[40:43], a[16:23], v6
v_smfmac_f32_16x16x64_bf16 v[100:103], v[40:43], a[48:55], v6
v_smfmac_f32_16x16x64_bf16 v[104:107], v[40:43], a[80:87], v6
v_smfmac_f32_16x16x64_bf16 v[108:111], v[40:43], a[112:119], v6
s_branch mega_kernel_rs_pa_11_3
mega_kernel_rs_il34:
s_cbranch_execz mega_kernel_rs_il35
.p2align 5
mega_kernel_rs_pa_15_3f:
s_mov_b64 exec, vcc
buffer_load_dwordx4 v[44:47], v7, s[84:87], s33 offen offset:3072 sc1
s_mov_b64 exec, -1
s_branch mega_kernel_rs_pa_15_0
.p2align 5
mega_kernel_rs_pa_15_3:
s_waitcnt vmcnt(3)
v_max_u32 v4, v44, v46
v_cmp_eq_u32 vcc, -1, v4
s_cbranch_vccnz mega_kernel_rs_pa_15_3f
v_smfmac_f32_16x16x64_bf16 v[96:99], v[44:47], a[24:31], v6
v_smfmac_f32_16x16x64_bf16 v[100:103], v[44:47], a[56:63], v6
v_smfmac_f32_16x16x64_bf16 v[104:107], v[44:47], a[88:95], v6
v_smfmac_f32_16x16x64_bf16 v[108:111], v[44:47], a[120:127], v6
s_branch mega_kernel_rs_pa_7_0
mega_kernel_rs_il35:
s_cbranch_execz mega_kernel_rs_il36
.p2align 5
mega_kernel_rs_pc_1_0f:
s_mov_b64 exec, vcc
buffer_load_dwordx4 v[32:35], v7, s[84:87], s29 offen offset:0 sc1
s_mov_b64 exec, -1
s_branch mega_kernel_rs_pc_1_0
.p2align 5
mega_kernel_rs_pc_1_0:
s_waitcnt vmcnt(0)
v_cmp_eq_u32 vcc, -1, v32
s_cbranch_vccnz mega_kernel_rs_pc_1_0f
v_smfmac_f32_16x16x64_bf16 v[96:99], v[32:35], a[192:199], v6
v_smfmac_f32_16x16x64_bf16 v[100:103], v[32:35], a[224:231], v6
s_branch mega_kernel_rs_pc_d
mega_kernel_rs_il36:
s_cbranch_execz mega_kernel_rs_il37
.p2align 5
mega_kernel_rs_pc_2_1f:
s_mov_b64 exec, vcc
buffer_load_dwordx4 v[36:39], v7, s[84:87], s29 offen offset:1024 sc1
s_mov_b64 exec, -1
s_branch mega_kernel_rs_pc_2_1
mega_kernel_rs_il37:
s_cbranch_execz mega_kernel_rs_iwd
.p2align 5
mega_kernel_rs_pc_2_1:
s_waitcnt vmcnt(0)
v_cmp_eq_u32 vcc, -1, v36
s_cbranch_vccnz mega_kernel_rs_pc_2_1f
v_smfmac_f32_16x16x64_bf16 v[96:99], v[36:39], a[200:207], v6
v_smfmac_f32_16x16x64_bf16 v[100:103], v[36:39], a[232:239], v6
s_branch mega_kernel_rs_pc_d
.p2align 5
mega_kernel_rs_pc_3_0f:
s_mov_b64 exec, vcc
buffer_load_dwordx4 v[32:35], v7, s[84:87], s29 offen offset:0 sc1
s_mov_b64 exec, -1
s_branch mega_kernel_rs_pc_3_1
mega_kernel_rs_iw2:
mega_kernel_rs_il38:
s_cbranch_execz mega_kernel_rs_il39
.p2align 5
mega_kernel_rs_pc_3_0:
s_waitcnt vmcnt(1)
v_cmp_eq_u32 vcc, -1, v32
s_cbranch_vccnz mega_kernel_rs_pc_3_0f
v_smfmac_f32_16x16x64_bf16 v[96:99], v[32:35], a[192:199], v6
v_smfmac_f32_16x16x64_bf16 v[100:103], v[32:35], a[224:231], v6
s_branch mega_kernel_rs_pc_2_1
.p2align 5
mega_kernel_rs_pc_3_1f:
s_mov_b64 exec, vcc
buffer_load_dwordx4 v[36:39], v7, s[84:87], s29 offen offset:1024 sc1
s_mov_b64 exec, -1
s_branch mega_kernel_rs_pc_3_0
mega_kernel_rs_il39:
s_cbranch_execz mega_kernel_rs_il40
.p2align 5
mega_kernel_rs_pc_3_1:
s_waitcnt vmcnt(1)
v_cmp_eq_u32 vcc, -1, v36
s_cbranch_vccnz mega_kernel_rs_pc_3_1f
v_smfmac_f32_16x16x64_bf16 v[96:99], v[36:39], a[200:207], v6
v_smfmac_f32_16x16x64_bf16 v[100:103], v[36:39], a[232:239], v6
s_branch mega_kernel_rs_pc_1_0
.p2align 5
mega_kernel_rs_pc_4_2f:
s_mov_b64 exec, vcc
buffer_load_dwordx4 v[40:43], v7, s[84:87], s29 offen offset:2048 sc1
s_mov_b64 exec, -1
s_branch mega_kernel_rs_pc_4_2
mega_kernel_rs_il40:
s_cbranch_execz mega_kernel_rs_il41
.p2align 5
mega_kernel_rs_pc_4_2:
s_waitcnt vmcnt(0)
v_cmp_eq_u32 vcc, -1, v40
s_cbranch_vccnz mega_kernel_rs_pc_4_2f
v_smfmac_f32_16x16x64_bf16 v[96:99], v[40:43], a[208:215], v6
v_smfmac_f32_16x16x64_bf16 v[100:103], v[40:43], a[240:247], v6
s_branch mega_kernel_rs_pc_d
.p2align 5
mega_kernel_rs_pc_5_0f:
s_mov_b64 exec, vcc
buffer_load_dwordx4 v[32:35], v7, s[84:87], s29 offen offset:0 sc1
s_mov_b64 exec, -1
s_branch mega_kernel_rs_pc_5_2
mega_kernel_rs_il41:
s_cbranch_execz mega_kernel_rs_il42
.p2align 5
mega_kernel_rs_pc_5_0:
s_waitcnt vmcnt(1)
v_cmp_eq_u32 vcc, -1, v32
s_cbranch_vccnz mega_kernel_rs_pc_5_0f
v_smfmac_f32_16x16x64_bf16 v[96:99], v[32:35], a[192:199], v6
v_smfmac_f32_16x16x64_bf16 v[100:103], v[32:35], a[224:231], v6
s_branch mega_kernel_rs_pc_4_2
.p2align 5
mega_kernel_rs_pc_5_2f:
s_mov_b64 exec, vcc
buffer_load_dwordx4 v[40:43], v7, s[84:87], s29 offen offset:2048 sc1
s_mov_b64 exec, -1
s_branch mega_kernel_rs_pc_5_0
mega_kernel_rs_il42:
s_cbranch_execz mega_kernel_rs_il43
.p2align 5
mega_kernel_rs_pc_5_2:
s_waitcnt vmcnt(1)
v_cmp_eq_u32 vcc, -1, v40
s_cbranch_vccnz mega_kernel_rs_pc_5_2f
v_smfmac_f32_16x16x64_bf16 v[96:99], v[40:43], a[208:215], v6
v_smfmac_f32_16x16x64_bf16 v[100:103], v[40:43], a[240:247], v6
s_branch mega_kernel_rs_pc_1_0
.p2align 5
mega_kernel_rs_pc_6_1f:
s_mov_b64 exec, vcc
buffer_load_dwordx4 v[36:39], v7, s[84:87], s29 offen offset:1024 sc1
s_mov_b64 exec, -1
s_branch mega_kernel_rs_pc_6_2
mega_kernel_rs_il43:
s_cbranch_execz mega_kernel_rs_il44
.p2align 5
mega_kernel_rs_pc_6_1:
s_waitcnt vmcnt(1)
v_cmp_eq_u32 vcc, -1, v36
s_cbranch_vccnz mega_kernel_rs_pc_6_1f
v_smfmac_f32_16x16x64_bf16 v[96:99], v[36:39], a[200:207], v6
v_smfmac_f32_16x16x64_bf16 v[100:103], v[36:39], a[232:239], v6
s_branch mega_kernel_rs_pc_4_2
.p2align 5
mega_kernel_rs_pc_6_2f:
s_mov_b64 exec, vcc
buffer_load_dwordx4 v[40:43], v7, s[84:87], s29 offen offset:2048 sc1
s_mov_b64 exec, -1
s_branch mega_kernel_rs_pc_6_1
mega_kernel_rs_il44:
s_cbranch_execz mega_kernel_rs_il45
.p2align 5
mega_kernel_rs_pc_6_2:
s_waitcnt vmcnt(1)
v_cmp_eq_u32 vcc, -1, v40
s_cbranch_vccnz mega_kernel_rs_pc_6_2f
v_smfmac_f32_16x16x64_bf16 v[96:99], v[40:43], a[208:215], v6
v_smfmac_f32_16x16x64_bf16 v[100:103], v[40:43], a[240:247], v6
s_branch mega_kernel_rs_pc_2_1
.p2align 5
mega_kernel_rs_pc_7_0f:
s_mov_b64 exec, vcc
buffer_load_dwordx4 v[32:35], v7, s[84:87], s29 offen offset:0 sc1
s_mov_b64 exec, -1
s_branch mega_kernel_rs_pc_7_1
mega_kernel_rs_il45:
s_cbranch_execz mega_kernel_rs_il46
.p2align 5
mega_kernel_rs_pc_7_0:
s_waitcnt vmcnt(2)
v_cmp_eq_u32 vcc, -1, v32
s_cbranch_vccnz mega_kernel_rs_pc_7_0f
v_smfmac_f32_16x16x64_bf16 v[96:99], v[32:35], a[192:199], v6
v_smfmac_f32_16x16x64_bf16 v[100:103], v[32:35], a[224:231], v6
s_branch mega_kernel_rs_pc_6_1
.p2align 5
mega_kernel_rs_pc_7_1f:
s_mov_b64 exec, vcc
buffer_load_dwordx4 v[36:39], v7, s[84:87], s29 offen offset:1024 sc1
s_mov_b64 exec, -1
s_branch mega_kernel_rs_pc_7_2
mega_kernel_rs_il46:
s_cbranch_execz mega_kernel_rs_il47
.p2align 5
mega_kernel_rs_pc_7_1:
s_waitcnt vmcnt(2)
v_cmp_eq_u32 vcc, -1, v36
s_cbranch_vccnz mega_kernel_rs_pc_7_1f
v_smfmac_f32_16x16x64_bf16 v[96:99], v[36:39], a[200:207], v6
v_smfmac_f32_16x16x64_bf16 v[100:103], v[36:39], a[232:239], v6
s_branch mega_kernel_rs_pc_5_2
.p2align 5
mega_kernel_rs_pc_7_2f:
s_mov_b64 exec, vcc
buffer_load_dwordx4 v[40:43], v7, s[84:87], s29 offen offset:2048 sc1
s_mov_b64 exec, -1
s_branch mega_kernel_rs_pc_7_0
mega_kernel_rs_il47:
s_cbranch_execz mega_kernel_rs_il48
.p2align 5
mega_kernel_rs_pc_7_2:
s_waitcnt vmcnt(2)
v_cmp_eq_u32 vcc, -1, v40
s_cbranch_vccnz mega_kernel_rs_pc_7_2f
v_smfmac_f32_16x16x64_bf16 v[96:99], v[40:43], a[208:215], v6
v_smfmac_f32_16x16x64_bf16 v[100:103], v[40:43], a[240:247], v6
s_branch mega_kernel_rs_pc_3_0
.p2align 5
mega_kernel_rs_pc_8_3f:
s_mov_b64 exec, vcc
buffer_load_dwordx4 v[44:47], v7, s[84:87], s29 offen offset:3072 sc1
s_mov_b64 exec, -1
s_branch mega_kernel_rs_pc_8_3
mega_kernel_rs_il48:
s_cbranch_execz mega_kernel_rs_il49
.p2align 5
mega_kernel_rs_pc_9_0f:
s_mov_b64 exec, vcc
buffer_load_dwordx4 v[32:35], v7, s[84:87], s29 offen offset:0 sc1
s_mov_b64 exec, -1
s_branch mega_kernel_rs_pc_9_3
.p2align 5
mega_kernel_rs_pc_9_0:
s_waitcnt vmcnt(1)
v_cmp_eq_u32 vcc, -1, v32
s_cbranch_vccnz mega_kernel_rs_pc_9_0f
v_smfmac_f32_16x16x64_bf16 v[96:99], v[32:35], a[192:199], v6
v_smfmac_f32_16x16x64_bf16 v[100:103], v[32:35], a[224:231], v6
s_branch mega_kernel_rs_pc_8_3
mega_kernel_rs_il49:
s_cbranch_execz mega_kernel_rs_il50
.p2align 5
mega_kernel_rs_pc_9_3f:
s_mov_b64 exec, vcc
buffer_load_dwordx4 v[44:47], v7, s[84:87], s29 offen offset:3072 sc1
s_mov_b64 exec, -1
s_branch mega_kernel_rs_pc_9_0
mega_kernel_rs_il50:
s_cbranch_execz mega_kernel_rs_il51
.p2align 5
mega_kernel_rs_pc_9_3:
s_waitcnt vmcnt(1)
v_cmp_eq_u32 vcc, -1, v44
s_cbranch_vccnz mega_kernel_rs_pc_9_3f
v_smfmac_f32_16x16x64_bf16 v[96:99], v[44:47], a[216:223], v6
v_smfmac_f32_16x16x64_bf16 v[100:103], v[44:47], a[248:255], v6
s_branch mega_kernel_rs_pc_1_0
.p2align 5
mega_kernel_rs_pc_10_1f:
s_mov_b64 exec, vcc
buffer_load_dwordx4 v[36:39], v7, s[84:87], s29 offen offset:1024 sc1
s_mov_b64 exec, -1
s_branch mega_kernel_rs_pc_10_3
mega_kernel_rs_il51:
s_cbranch_execz mega_kernel_rs_il52
.p2align 5
mega_kernel_rs_pc_10_1:
s_waitcnt vmcnt(1)
v_cmp_eq_u32 vcc, -1, v36
s_cbranch_vccnz mega_kernel_rs_pc_10_1f
v_smfmac_f32_16x16x64_bf16 v[96:99], v[36:39], a[200:207], v6
v_smfmac_f32_16x16x64_bf16 v[100:103], v[36:39], a[232:239], v6
s_branch mega_kernel_rs_pc_8_3
.p2align 5
mega_kernel_rs_pc_10_3f:
s_mov_b64 exec, vcc
buffer_load_dwordx4 v[44:47], v7, s[84:87], s29 offen offset:3072 sc1
s_mov_b64 exec, -1
s_branch mega_kernel_rs_pc_10_1
mega_kernel_rs_il52:
s_cbranch_execz mega_kernel_rs_il53
.p2align 5
mega_kernel_rs_pc_10_3:
s_waitcnt vmcnt(1)
v_cmp_eq_u32 vcc, -1, v44
s_cbranch_vccnz mega_kernel_rs_pc_10_3f
v_smfmac_f32_16x16x64_bf16 v[96:99], v[44:47], a[216:223], v6
v_smfmac_f32_16x16x64_bf16 v[100:103], v[44:47], a[248:255], v6
s_branch mega_kernel_rs_pc_2_1
.p2align 5
mega_kernel_rs_pc_11_0f:
s_mov_b64 exec, vcc
buffer_load_dwordx4 v[32:35], v7, s[84:87], s29 offen offset:0 sc1
s_mov_b64 exec, -1
s_branch mega_kernel_rs_pc_11_1
mega_kernel_rs_il53:
s_cbranch_execz mega_kernel_rs_il54
.p2align 5
mega_kernel_rs_pc_11_0:
s_waitcnt vmcnt(2)
v_cmp_eq_u32 vcc, -1, v32
s_cbranch_vccnz mega_kernel_rs_pc_11_0f
v_smfmac_f32_16x16x64_bf16 v[96:99], v[32:35], a[192:199], v6
v_smfmac_f32_16x16x64_bf16 v[100:103], v[32:35], a[224:231], v6
s_branch mega_kernel_rs_pc_10_1
.p2align 5
mega_kernel_rs_pc_11_1f:
s_mov_b64 exec, vcc
buffer_load_dwordx4 v[36:39], v7, s[84:87], s29 offen offset:1024 sc1
s_mov_b64 exec, -1
s_branch mega_kernel_rs_pc_11_3
mega_kernel_rs_il54:
s_cbranch_execz mega_kernel_rs_il55
.p2align 5
mega_kernel_rs_pc_11_1:
s_waitcnt vmcnt(2)
v_cmp_eq_u32 vcc, -1, v36
s_cbranch_vccnz mega_kernel_rs_pc_11_1f
v_smfmac_f32_16x16x64_bf16 v[96:99], v[36:39], a[200:207], v6
v_smfmac_f32_16x16x64_bf16 v[100:103], v[36:39], a[232:239], v6
s_branch mega_kernel_rs_pc_9_3
.p2align 5
mega_kernel_rs_pc_11_3f:
s_mov_b64 exec, vcc
buffer_load_dwordx4 v[44:47], v7, s[84:87], s29 offen offset:3072 sc1
s_mov_b64 exec, -1
s_branch mega_kernel_rs_pc_11_0
mega_kernel_rs_il55:
s_cbranch_execz mega_kernel_rs_il56
.p2align 5
mega_kernel_rs_pc_11_3:
s_waitcnt vmcnt(2)
v_cmp_eq_u32 vcc, -1, v44
s_cbranch_vccnz mega_kernel_rs_pc_11_3f
v_smfmac_f32_16x16x64_bf16 v[96:99], v[44:47], a[216:223], v6
v_smfmac_f32_16x16x64_bf16 v[100:103], v[44:47], a[248:255], v6
s_branch mega_kernel_rs_pc_3_0
.p2align 5
mega_kernel_rs_pc_12_2f:
s_mov_b64 exec, vcc
buffer_load_dwordx4 v[40:43], v7, s[84:87], s29 offen offset:2048 sc1
s_mov_b64 exec, -1
s_branch mega_kernel_rs_pc_12_3
mega_kernel_rs_il56:
s_cbranch_execz mega_kernel_rs_iwd
.p2align 5
mega_kernel_rs_pc_12_3f:
s_mov_b64 exec, vcc
buffer_load_dwordx4 v[44:47], v7, s[84:87], s29 offen offset:3072 sc1
s_mov_b64 exec, -1
s_branch mega_kernel_rs_pc_12_2
.p2align 5
mega_kernel_rs_pc_12_3:
s_waitcnt vmcnt(1)
v_cmp_eq_u32 vcc, -1, v44
s_cbranch_vccnz mega_kernel_rs_pc_12_3f
v_smfmac_f32_16x16x64_bf16 v[96:99], v[44:47], a[216:223], v6
v_smfmac_f32_16x16x64_bf16 v[100:103], v[44:47], a[248:255], v6
s_branch mega_kernel_rs_pc_4_2
mega_kernel_rs_iw3:
mega_kernel_rs_il57:
s_cbranch_execz mega_kernel_rs_il58
.p2align 5
mega_kernel_rs_pc_13_0f:
s_mov_b64 exec, vcc
buffer_load_dwordx4 v[32:35], v7, s[84:87], s29 offen offset:0 sc1
s_mov_b64 exec, -1
s_branch mega_kernel_rs_pc_13_2
mega_kernel_rs_il58:
s_cbranch_execz mega_kernel_rs_il59
.p2align 5
mega_kernel_rs_pc_13_0:
s_waitcnt vmcnt(2)
v_cmp_eq_u32 vcc, -1, v32
s_cbranch_vccnz mega_kernel_rs_pc_13_0f
v_smfmac_f32_16x16x64_bf16 v[96:99], v[32:35], a[192:199], v6
v_smfmac_f32_16x16x64_bf16 v[100:103], v[32:35], a[224:231], v6
s_branch mega_kernel_rs_pc_12_2
.p2align 5
mega_kernel_rs_pc_13_2f:
s_mov_b64 exec, vcc
buffer_load_dwordx4 v[40:43], v7, s[84:87], s29 offen offset:2048 sc1
s_mov_b64 exec, -1
s_branch mega_kernel_rs_pc_13_3
mega_kernel_rs_il59:
s_cbranch_execz mega_kernel_rs_il60
.p2align 5
mega_kernel_rs_pc_13_2:
s_waitcnt vmcnt(2)
v_cmp_eq_u32 vcc, -1, v40
s_cbranch_vccnz mega_kernel_rs_pc_13_2f
v_smfmac_f32_16x16x64_bf16 v[96:99], v[40:43], a[208:215], v6
v_smfmac_f32_16x16x64_bf16 v[100:103], v[40:43], a[240:247], v6
s_branch mega_kernel_rs_pc_9_3
.p2align 5
mega_kernel_rs_pc_13_3f:
s_mov_b64 exec, vcc
buffer_load_dwordx4 v[44:47], v7, s[84:87], s29 offen offset:3072 sc1
s_mov_b64 exec, -1
s_branch mega_kernel_rs_pc_13_0
mega_kernel_rs_il60:
s_cbranch_execz mega_kernel_rs_il61
.p2align 5
mega_kernel_rs_pc_13_3:
s_waitcnt vmcnt(2)
v_cmp_eq_u32 vcc, -1, v44
s_cbranch_vccnz mega_kernel_rs_pc_13_3f
v_smfmac_f32_16x16x64_bf16 v[96:99], v[44:47], a[216:223], v6
v_smfmac_f32_16x16x64_bf16 v[100:103], v[44:47], a[248:255], v6
s_branch mega_kernel_rs_pc_5_0
.p2align 5
mega_kernel_rs_pc_14_1f:
s_mov_b64 exec, vcc
buffer_load_dwordx4 v[36:39], v7, s[84:87], s29 offen offset:1024 sc1
s_mov_b64 exec, -1
s_branch mega_kernel_rs_pc_14_2
mega_kernel_rs_il61:
s_cbranch_execz mega_kernel_rs_il62
.p2align 5
mega_kernel_rs_pc_14_2f:
s_mov_b64 exec, vcc
buffer_load_dwordx4 v[40:43], v7, s[84:87], s29 offen offset:2048 sc1
s_mov_b64 exec, -1
s_branch mega_kernel_rs_pc_14_3
.p2align 5
mega_kernel_rs_pc_14_2:
s_waitcnt vmcnt(2)
v_cmp_eq_u32 vcc, -1, v40
s_cbranch_vccnz mega_kernel_rs_pc_14_2f
v_smfmac_f32_16x16x64_bf16 v[96:99], v[40:43], a[208:215], v6
v_smfmac_f32_16x16x64_bf16 v[100:103], v[40:43], a[240:247], v6
s_branch mega_kernel_rs_pc_10_3
mega_kernel_rs_il62:
s_cbranch_execz mega_kernel_rs_il63
.p2align 5
mega_kernel_rs_pc_14_3f:
s_mov_b64 exec, vcc
buffer_load_dwordx4 v[44:47], v7, s[84:87], s29 offen offset:3072 sc1
s_mov_b64 exec, -1
s_branch mega_kernel_rs_pc_14_1
mega_kernel_rs_il63:
s_cbranch_execz mega_kernel_rs_il64
.p2align 5
mega_kernel_rs_pc_14_3:
s_waitcnt vmcnt(2)
v_cmp_eq_u32 vcc, -1, v44
s_cbranch_vccnz mega_kernel_rs_pc_14_3f
v_smfmac_f32_16x16x64_bf16 v[96:99], v[44:47], a[216:223], v6
v_smfmac_f32_16x16x64_bf16 v[100:103], v[44:47], a[248:255], v6
s_branch mega_kernel_rs_pc_6_1
.p2align 5
mega_kernel_rs_pc_15_0f:
s_mov_b64 exec, vcc
buffer_load_dwordx4 v[32:35], v7, s[84:87], s29 offen offset:0 sc1
s_mov_b64 exec, -1
s_branch mega_kernel_rs_pc_15_1
mega_kernel_rs_il64:
s_cbranch_execz mega_kernel_rs_il65
.p2align 5
mega_kernel_rs_pc_15_1f:
s_mov_b64 exec, vcc
buffer_load_dwordx4 v[36:39], v7, s[84:87], s29 offen offset:1024 sc1
s_mov_b64 exec, -1
s_branch mega_kernel_rs_pc_15_2
.p2align 5
mega_kernel_rs_pc_15_1:
s_waitcnt vmcnt(3)
v_cmp_eq_u32 vcc, -1, v36
s_cbranch_vccnz mega_kernel_rs_pc_15_1f
v_smfmac_f32_16x16x64_bf16 v[96:99], v[36:39], a[200:207], v6
v_smfmac_f32_16x16x64_bf16 v[100:103], v[36:39], a[232:239], v6
s_branch mega_kernel_rs_pc_13_2
mega_kernel_rs_il65:
s_cbranch_execz mega_kernel_rs_il66
.p2align 5
mega_kernel_rs_pc_15_2f:
s_mov_b64 exec, vcc
buffer_load_dwordx4 v[40:43], v7, s[84:87], s29 offen offset:2048 sc1
s_mov_b64 exec, -1
s_branch mega_kernel_rs_pc_15_3
mega_kernel_rs_il66:
s_cbranch_execz mega_kernel_rs_il67
.p2align 5
mega_kernel_rs_pc_15_2:
s_waitcnt vmcnt(3)
v_cmp_eq_u32 vcc, -1, v40
s_cbranch_vccnz mega_kernel_rs_pc_15_2f
v_smfmac_f32_16x16x64_bf16 v[96:99], v[40:43], a[208:215], v6
v_smfmac_f32_16x16x64_bf16 v[100:103], v[40:43], a[240:247], v6
s_branch mega_kernel_rs_pc_11_3
.p2align 5
mega_kernel_rs_pc_15_3f:
s_mov_b64 exec, vcc
buffer_load_dwordx4 v[44:47], v7, s[84:87], s29 offen offset:3072 sc1
s_mov_b64 exec, -1
s_branch mega_kernel_rs_pc_15_0
mega_kernel_rs_il67:
s_cbranch_execz mega_kernel_rs_il68
.p2align 5
mega_kernel_rs_pc_15_3:
s_waitcnt vmcnt(3)
v_cmp_eq_u32 vcc, -1, v44
s_cbranch_vccnz mega_kernel_rs_pc_15_3f
v_smfmac_f32_16x16x64_bf16 v[96:99], v[44:47], a[216:223], v6
v_smfmac_f32_16x16x64_bf16 v[100:103], v[44:47], a[248:255], v6
s_branch mega_kernel_rs_pc_7_0
mega_kernel_rs_w0last:
s_nop 7
v_permlane32_swap_b32 v112, v116
v_permlane32_swap_b32 v113, v117
v_permlane32_swap_b32 v114, v118
v_permlane32_swap_b32 v115, v119
v_pk_add_f32 v[112:113], v[112:113], v[116:117]
v_pk_add_f32 v[114:115], v[114:115], v[118:119]
ds_write_b128 v20, v[112:115]
s_waitcnt lgkmcnt(0)
s_barrier
s_branch mega_kernel_rs_end
mega_kernel_rs_il68:
s_cbranch_execz mega_kernel_rs_il69
mega_kernel_rs_side:
s_cmp_eq_u32 s24, 3
s_cbranch_scc1 mega_kernel_rs_sd3
s_cmp_eq_u32 s24, 2
s_cbranch_scc0 mega_kernel_rs_sd4
s_mov_b64 exec, s[40:41]
buffer_store_dwordx4 v[28:31], v11, s[84:87], s34 offen sc1
s_mov_b64 exec, -1
buffer_store_dwordx2 v[28:29], v9, s[84:87], s34 offen sc1
s_mul_i32 s28, s31, 1280
s_add_u32 s28, s28, s34
s_add_u32 s28, s28, 49152
buffer_store_dwordx4 v[28:31], v17, s[84:87], s28 offen sc1
buffer_store_dwordx4 v[28:31], v10, s[84:87], s28 offen sc1
s_branch mega_kernel_rs_sd4
mega_kernel_rs_il69:
s_cbranch_execz mega_kernel_rs_il70
mega_kernel_rs_sd3:
v_readlane_b32 s76, v249, 0
v_readlane_b32 s77, v249, 1
s_min_i32 s76, s76, s77
s_max_i32 s46, s46, s76
s_mov_b32 s36, 0
s_add_u32 s76, s27, 1
s_cmp_lt_u32 s76, 63
s_cbranch_scc0 mega_kernel_rs_sd4
s_cmp_ge_u32 s76, 0
s_cbranch_scc0 mega_kernel_rs_sd4
s_cmp_gt_i32 s46, s76
s_cselect_b32 s36, 0, 1
s_cbranch_scc0 mega_kernel_rs_sd4
s_add_u32 s77, s76, s82
s_bfe_u32 s28, s77, 0x40002
s_lshl_b32 s28, s28, 14
s_and_b32 s77, s77, 3
s_lshl_b32 s77, s77, 11
s_add_u32 s28, s28, s77
s_add_u32 m0, s45, 0
s_nop 0
buffer_load_dwordx4 v240, s[84:87], s28 offen offset:0 sc1 lds
s_add_u32 m0, s45, 0
s_nop 0
buffer_load_dwordx4 v240, s[84:87], s28 offen offset:1024 sc1 lds
s_add_u32 m0, s45, 2048
s_nop 0
buffer_load_dwordx4 v241, s[84:87], s28 offen offset:0 sc1 lds
s_add_u32 m0, s45, 2048
s_nop 0
buffer_load_dwordx4 v241, s[84:87], s28 offen offset:1024 sc1 lds
s_add_u32 s45, s45, 4096
s_cmp_eq_u32 s45, 30720
s_cselect_b32 s45, 18432, s45
mega_kernel_rs_sd4:
v_smfmac_f32_16x16x64_bf16 v[112:115], v[40:43], a[144:151], v6
v_smfmac_f32_16x16x64_bf16 v[116:119], v[40:43], a[176:183], v6
v_smfmac_f32_16x16x64_bf16 v[112:115], v[44:47], a[152:159], v6
v_smfmac_f32_16x16x64_bf16 v[116:119], v[44:47], a[184:191], v6
s_nop 7
v_permlane32_swap_b32 v112, v116
v_permlane32_swap_b32 v113, v117
v_permlane32_swap_b32 v114, v118
v_permlane32_swap_b32 v115, v119
v_pk_add_f32 v[112:113], v[112:113], v[116:117]
v_pk_add_f32 v[114:115], v[114:115], v[118:119]
ds_write_b128 v20, v[112:115]
v_mov_b32 v96, 0
v_mov_b32 v97, 0
v_mov_b32 v98, 0
v_mov_b32 v99, 0
v_mov_b32 v100, 0
v_mov_b32 v101, 0
v_mov_b32 v102, 0
v_mov_b32 v103, 0
s_cmp_eq_u32 s24, 1
s_cbranch_scc0 mega_kernel_rs_s1
s_waitcnt lgkmcnt(0)
ds_read_b128 v[120:123], v16 offset:0
ds_read_b128 v[124:127], v16 offset:16
ds_read_b128 v[128:131], v16 offset:2304
ds_read_b128 v[132:135], v16 offset:2320
ds_read_b128 v[136:139], v16 offset:4608
ds_read_b128 v[140:143], v16 offset:4624
ds_read_b128 v[144:147], v16 offset:6912
ds_read_b128 v[148:151], v16 offset:6928
s_waitcnt lgkmcnt(4)
v_pk_add_f32 v[120:121], v[120:121], v[128:129]
v_pk_add_f32 v[122:123], v[122:123], v[130:131]
v_pk_add_f32 v[124:125], v[124:125], v[132:133]
v_pk_add_f32 v[126:127], v[126:127], v[134:135]
s_waitcnt lgkmcnt(0)
v_pk_add_f32 v[136:137], v[136:137], v[144:145]
v_pk_add_f32 v[138:139], v[138:139], v[146:147]
v_pk_add_f32 v[140:141], v[140:141], v[148:149]
v_pk_add_f32 v[142:143], v[142:143], v[150:151]
v_pk_add_f32 v[120:121], v[120:121], v[136:137]
v_pk_add_f32 v[122:123], v[122:123], v[138:139]
v_pk_add_f32 v[124:125], v[124:125], v[140:141]
v_pk_add_f32 v[126:127], v[126:127], v[142:143]
v_cvt_pk_bf16_f32 v244, v120, v121
v_cvt_pk_bf16_f32 v245, v122, v123
v_cvt_pk_bf16_f32 v246, v124, v125
v_cvt_pk_bf16_f32 v247, v126, v127
mega_kernel_rs_s1:
v_add_u32 v5, 9216, v17
s_waitcnt lgkmcnt(0)
s_barrier
s_cmp_eq_u32 s24, 2
s_cbranch_scc1 mega_kernel_rs_s2
s_cmp_eq_u32 s24, 3
s_cbranch_scc0 mega_kernel_rs_s3
s_add_u32 s76, s27, 2
s_cmp_lt_u32 s76, 63
s_cbranch_scc0 mega_kernel_rs_s3
s_cmp_gt_i32 s46, s76
s_cbranch_scc0 mega_kernel_rs_s3
s_add_u32 s77, s76, s82
s_bfe_u32 s28, s77, 0x40002
s_lshl_b32 s28, s28, 14
s_and_b32 s77, s77, 3
s_lshl_b32 s77, s77, 11
s_add_u32 s28, s28, s77
s_add_u32 s28, s28, s83
s_buffer_load_dword s78, s[84:87], s28 offset:0
s_buffer_load_dword s78, s[84:87], s28 offset:128
s_buffer_load_dword s78, s[84:87], s28 offset:256
s_buffer_load_dword s78, s[84:87], s28 offset:384
s_buffer_load_dword s78, s[84:87], s28 offset:512
s_buffer_load_dword s78, s[84:87], s28 offset:640
s_buffer_load_dword s78, s[84:87], s28 offset:768
s_buffer_load_dword s78, s[84:87], s28 offset:896
s_buffer_load_dword s78, s[84:87], s28 offset:1024
s_buffer_load_dword s78, s[84:87], s28 offset:1152
s_buffer_load_dword s78, s[84:87], s28 offset:1280
s_buffer_load_dword s78, s[84:87], s28 offset:1408
s_buffer_load_dword s78, s[84:87], s28 offset:1536
s_buffer_load_dword s78, s[84:87], s28 offset:1664
s_buffer_load_dword s78, s[84:87], s28 offset:1792
s_buffer_load_dword s78, s[84:87], s28 offset:1920
s_mov_b32 s88, s76
s_branch mega_kernel_rs_s3
mega_kernel_rs_il70:
s_cbranch_execz mega_kernel_rs_il71
mega_kernel_rs_s2:
ds_read_b128 v[120:123], v5 offset:0
ds_read_b128 v[124:127], v5 offset:1024
ds_read_b128 v[128:131], v5 offset:2048
ds_read_b128 v[132:135], v5 offset:3072
v_lshrrev_b32 v5, 1, v17
s_waitcnt lgkmcnt(2)
v_pk_add_f32 v[120:121], v[120:121], v[124:125]
v_pk_add_f32 v[122:123], v[122:123], v[126:127]
s_waitcnt lgkmcnt(0)
v_pk_add_f32 v[128:129], v[128:129], v[132:133]
v_pk_add_f32 v[130:131], v[130:131], v[134:135]
v_pk_add_f32 v[120:121], v[120:121], v[128:129]
v_pk_add_f32 v[122:123], v[122:123], v[130:131]
v_cvt_pk_bf16_f32 v244, v120, v121
v_cvt_pk_bf16_f32 v245, v122, v123
ds_write_b64 v5, v[244:245] offset:17920
s_waitcnt lgkmcnt(0) vmcnt(0)
mega_kernel_rs_s3:
s_cmp_eq_u32 s27, 63
s_cbranch_scc1 mega_kernel_rs_slast
s_add_u32 s29, s33, 24576
s_barrier
s_cmp_eq_u32 s24, 3
s_cbranch_scc1 mega_kernel_rs_y3
s_add_u32 s77, s27, s82
s_bfe_u32 s28, s77, 0x30003
s_lshl_b32 s28, s28, 14
s_and_b32 s77, s77, 7
s_lshl_b32 s77, s77, 10
s_add_u32 s28, s28, s77
s_add_u32 s28, s28, s79
s_cmp_eq_u32 s24, 2
s_cbranch_scc1 mega_kernel_rs_kv2a
s_mov_b64 exec, s[48:49]
buffer_store_dwordx4 v[244:247], v22, s[84:87], s28 offen sc1
s_mov_b64 exec, -1
s_branch mega_kernel_rs_kvda
mega_kernel_rs_il71:
s_cbranch_execz mega_kernel_rs_il72
mega_kernel_rs_kv2a:
v_lshlrev_b32 v4, 3, v1
buffer_store_dwordx2 v[244:245], v4, s[84:87], s28 offen offset:512 sc1
mega_kernel_rs_kvda:
s_branch mega_kernel_rs_y4
mega_kernel_rs_y3:
s_add_u32 s76, s27, 2
s_cmp_lt_u32 s76, 63
s_cbranch_scc0 mega_kernel_rs_y4
mega_kernel_rs_y4:
s_branch mega_kernel_rs_b3
mega_kernel_rs_first:
v_add_u32 v5, s44, v17
ds_read_b128 v[156:159], v5 offset:0
ds_read_b128 v[160:163], v5 offset:1024
ds_read_b128 v[164:167], v5 offset:2048
ds_read_b128 v[168:171], v5 offset:3072
s_branch mega_kernel_rs_adone
mega_kernel_rs_il72:
s_cbranch_execz mega_kernel_rs_il73
mega_kernel_rs_slast:
s_cmp_eq_u32 s24, 3
s_cbranch_scc1 mega_kernel_rs_end
s_add_u32 s77, s27, s82
s_bfe_u32 s28, s77, 0x30003
s_lshl_b32 s28, s28, 14
s_and_b32 s77, s77, 7
s_lshl_b32 s77, s77, 10
s_add_u32 s28, s28, s77
s_add_u32 s28, s28, s79
s_cmp_eq_u32 s24, 2
s_cbranch_scc1 mega_kernel_rs_kv2b
s_mov_b64 exec, s[48:49]
buffer_store_dwordx4 v[244:247], v22, s[84:87], s28 offen sc1
s_mov_b64 exec, -1
s_branch mega_kernel_rs_kvdb
mega_kernel_rs_il73:
s_cbranch_execz mega_kernel_rs_iwd
mega_kernel_rs_kv2b:
v_lshlrev_b32 v4, 3, v1
buffer_store_dwordx2 v[244:245], v4, s[84:87], s28 offen offset:512 sc1
mega_kernel_rs_kvdb:
s_waitcnt vmcnt(0)
s_barrier
s_mov_b32 s76, 64
s_cmp_eq_u32 s24, 1
s_cbranch_scc0 mega_kernel_rs_end
v_mov_b32 v5, s76
s_mov_b64 exec, 1
buffer_store_dword v5, v228, s[84:87], s81 offen sc1
s_mov_b64 exec, -1
mega_kernel_rs_end:
s_endpgm
.section .rodata,"a"
.p2align 6
.amdhsa_kernel mega_kernel
  .amdhsa_next_free_vgpr 512
  .amdhsa_next_free_sgpr 102
  .amdhsa_accum_offset 256
  .amdhsa_group_segment_fixed_size 0
  .amdhsa_kernarg_size 104
  .amdhsa_user_sgpr_count 2
  .amdhsa_user_sgpr_kernarg_segment_ptr 1
  .amdhsa_system_sgpr_workgroup_id_x 1
.end_amdhsa_kernel
```

```asm
; @launch kernel=mega_kernel grid=(256,1,1) block=(256,1,1) lds=163840
.amdgcn_target "amdgcn-amd-amdhsa--gfx950"
.text
.globl mega_kernel
.p2align 8
.type mega_kernel,@function
mega_kernel:
s_cmp_ge_u32 s2, 256
s_cbranch_scc1 mega_kernel_exit
s_load_dwordx2 s[84:85], s[0:1], 96
s_load_dwordx2 s[72:73], s[0:1], 88
s_getreg_b32 s90, hwreg(HW_REG_XCC_ID)
s_and_b32 s90, s90, 7
v_mov_b32 v1, 0
v_mov_b32 v2, 1
s_lshl_b32 s91, s90, 2
s_lshr_b32 s91, 1985229328, s91
s_and_b32 s91, s91, 15
s_lshl_b32 s91, s91, 4
s_mov_b32 s95, 0
s_mov_b32 s99, 0
s_waitcnt lgkmcnt(0)
s_mov_b32 s86, 268435456
s_mov_b32 s87, 0x00020000
s_mov_b32 s74, 256
s_mov_b32 s75, 0x00020000
v_cmp_eq_u32 vcc, 0, v0
s_and_saveexec_b64 s[88:89], vcc
s_cbranch_execz mega_kernel_tkd
s_lshl_b32 s92, s2, 13
s_add_u32 s92, s92, 167772160
buffer_atomic_add v2, v1, s[72:75], s91 offen sc0
buffer_load_dword v251, v1, s[84:87], s92 offen offset:2048 sc1
s_waitcnt vmcnt(1)
ds_write_b32 v1, v2
s_waitcnt lgkmcnt(0)
mega_kernel_tkd:
s_mov_b64 exec, s[88:89]
s_barrier
ds_read_b32 v2, v1
s_waitcnt lgkmcnt(0)
v_readfirstlane_b32 s96, v2
s_barrier
s_cmp_lt_u32 s96, 32
s_cbranch_scc1 mega_kernel_spec
v_and_b32 v3, 15, v0
v_lshlrev_b32 v3, 4, v3
s_branch mega_kernel_syx
mega_kernel_syxw:
s_sleep 4
mega_kernel_syx:
buffer_load_dword v2, v3, s[72:75], 0 offen sc1
s_waitcnt vmcnt(0)
mega_kernel_syxp:
s_cmp_eq_u32 s95, 1
s_cbranch_scc0 mega_kernel_syxf
v_readlane_b32 s76, v2, 14
s_mov_b32 s98, 0
s_cmp_eq_u32 s76, 32
s_cbranch_scc0 mega_kernel_syxw
s_branch mega_kernel_syxd
mega_kernel_syxf:
s_mov_b32 s77, 0
s_mov_b32 s78, 0
v_readlane_b32 s76, v2, 0
s_add_u32 s77, s77, s76
s_xor_b32 s76, s76, 32
s_or_b32 s78, s78, s76
v_readlane_b32 s76, v2, 1
s_add_u32 s77, s77, s76
s_xor_b32 s76, s76, 32
s_or_b32 s78, s78, s76
v_readlane_b32 s76, v2, 2
s_add_u32 s77, s77, s76
s_xor_b32 s76, s76, 32
s_or_b32 s78, s78, s76
v_readlane_b32 s76, v2, 3
s_add_u32 s77, s77, s76
s_xor_b32 s76, s76, 32
s_or_b32 s78, s78, s76
v_readlane_b32 s76, v2, 4
s_add_u32 s77, s77, s76
s_xor_b32 s76, s76, 32
s_or_b32 s78, s78, s76
v_readlane_b32 s76, v2, 5
s_add_u32 s77, s77, s76
s_xor_b32 s76, s76, 32
s_or_b32 s78, s78, s76
v_readlane_b32 s76, v2, 6
s_add_u32 s77, s77, s76
s_xor_b32 s76, s76, 32
s_or_b32 s78, s78, s76
v_readlane_b32 s76, v2, 7
s_add_u32 s77, s77, s76
s_xor_b32 s76, s76, 32
s_or_b32 s78, s78, s76
s_cmp_eq_u32 s77, 256
s_cbranch_scc0 mega_kernel_syxw
v_mov_b32 v252, v2
s_cmp_eq_u32 s78, 0
s_cbranch_scc0 mega_kernel_slowent
v_readlane_b32 s76, v2, 10
v_readlane_b32 s77, v2, 8
s_cmp_eq_u32 s76, 32
s_cbranch_scc0 mega_kernel_syxw
s_cmp_gt_u32 s77, 16
s_cselect_b32 s98, 1, 0
mega_kernel_syxd:
mega_kernel_slowent:
s_mov_b64 exec, -1
s_waitcnt vmcnt(0) lgkmcnt(0)
s_barrier
s_mov_b32 s97, s96
v_readlane_b32 s76, v252, 0
s_cmp_gt_u32 s90, 0
s_cselect_b32 s76, s76, 0
s_add_u32 s97, s97, s76
v_readlane_b32 s76, v252, 1
s_cmp_gt_u32 s90, 1
s_cselect_b32 s76, s76, 0
s_add_u32 s97, s97, s76
v_readlane_b32 s76, v252, 2
s_cmp_gt_u32 s90, 2
s_cselect_b32 s76, s76, 0
s_add_u32 s97, s97, s76
v_readlane_b32 s76, v252, 3
s_cmp_gt_u32 s90, 3
s_cselect_b32 s76, s76, 0
s_add_u32 s97, s97, s76
v_readlane_b32 s76, v252, 4
s_cmp_gt_u32 s90, 4
s_cselect_b32 s76, s76, 0
s_add_u32 s97, s97, s76
v_readlane_b32 s76, v252, 5
s_cmp_gt_u32 s90, 5
s_cselect_b32 s76, s76, 0
s_add_u32 s97, s97, s76
v_readlane_b32 s76, v252, 6
s_cmp_gt_u32 s90, 6
s_cselect_b32 s76, s76, 0
s_add_u32 s97, s97, s76
v_mov_b32 v1, 0
v_mov_b32 v2, 1
v_cmp_eq_u32 vcc, 0, v0
s_and_saveexec_b64 s[88:89], vcc
s_cbranch_execz mega_kernel_sb1
buffer_atomic_add v2, v1, s[72:75], 0 offen offset:192 sc1
mega_kernel_sb1:
s_mov_b64 exec, s[88:89]
mega_kernel_sb2:
s_sleep 4
buffer_load_dword v2, v1, s[72:75], 0 offen offset:192 sc1
s_waitcnt vmcnt(0)
v_cmp_ne_u32 vcc, 256, v2
s_cbranch_vccnz mega_kernel_sb2
s_mov_b32 s95, 1
s_lshr_b32 s30, s97, 5
s_and_b32 s31, s97, 31
s_cmp_lt_u32 s97, 128
s_cbranch_scc1 mega_kernel_recs
s_sub_u32 s94, s97, 128
s_branch mega_kernel_bulk
mega_kernel_spec:
s_mov_b32 s30, s90
s_mov_b32 s31, s96
s_cmp_lt_u32 s90, 4
s_cbranch_scc1 mega_kernel_recf
s_sub_u32 s94, s90, 4
s_lshl_b32 s94, s94, 5
s_add_u32 s94, s94, s96
mega_kernel_bulk:
s_lshr_b32 s91, s94, 5
s_and_b32 s40, s94, 31
s_and_b32 s92, s91, 1
s_lshl_b32 s92, s92, 5
s_add_u32 s92, s92, s40
s_cmp_eq_u32 s91, 0
s_cbranch_scc1 mega_kernel_rk
s_cmp_eq_u32 s91, 1
s_cbranch_scc1 mega_kernel_rv
s_cmp_eq_u32 s91, 2
s_cbranch_scc1 mega_kernel_noinit
v_mov_b32 v8, -1
v_mov_b32 v9, -1
v_mov_b32 v10, -1
v_mov_b32 v11, -1
v_lshlrev_b32 v1, 4, v0
v_mov_b32 v2, 0
v_cmp_gt_u32 vcc, 64, v0
s_cbranch_vccz mega_kernel_nv
s_cmp_eq_u32 s95, 0
s_cbranch_scc0 mega_kernel_nv
s_lshr_b32 s60, s2, 1
s_lshl_b32 s60, s60, 14
s_and_b32 s61, s40, 1
s_lshl_b32 s66, s61, 13
s_add_u32 s60, s60, s66
s_and_b32 s66, s2, 1
s_lshl_b32 s66, s66, 10
s_add_u32 s60, s60, s66
s_add_u32 s60, s60, 167772160
s_mov_b32 s66, 0x7fffffff
s_mov_b32 s67, 0x7fffffff
s_mov_b64 exec, 0xff
s_waitcnt vmcnt(0)
s_memtime s[62:63]
s_waitcnt lgkmcnt(0)
buffer_store_dwordx4 v[8:11], v1, s[84:87], s60 offen offset:0 sc1
s_waitcnt vmcnt(0)
s_memtime s[64:65]
s_xor_b32 s60, s60, 8192
s_waitcnt lgkmcnt(0)
s_sub_u32 s64, s64, s62
s_min_u32 s66, s66, s64
s_memtime s[62:63]
s_waitcnt lgkmcnt(0)
buffer_store_dwordx4 v[8:11], v1, s[84:87], s60 offen offset:0 sc1
s_waitcnt vmcnt(0)
s_memtime s[64:65]
s_xor_b32 s60, s60, 8192
s_waitcnt lgkmcnt(0)
s_sub_u32 s64, s64, s62
s_min_u32 s67, s67, s64
s_memtime s[62:63]
s_waitcnt lgkmcnt(0)
buffer_store_dwordx4 v[8:11], v1, s[84:87], s60 offen offset:256 sc1
s_waitcnt vmcnt(0)
s_memtime s[64:65]
s_xor_b32 s60, s60, 8192
s_waitcnt lgkmcnt(0)
s_sub_u32 s64, s64, s62
s_min_u32 s66, s66, s64
s_memtime s[62:63]
s_waitcnt lgkmcnt(0)
buffer_store_dwordx4 v[8:11], v1, s[84:87], s60 offen offset:256 sc1
s_waitcnt vmcnt(0)
s_memtime s[64:65]
s_xor_b32 s60, s60, 8192
s_waitcnt lgkmcnt(0)
s_sub_u32 s64, s64, s62
s_min_u32 s67, s67, s64
s_cmp_lt_u32 s67, s66
s_cselect_b32 s60, 1, 0
s_xor_b32 s60, s60, s61
s_lshr_b32 s61, s90, 2
s_xor_b32 s60, s60, s61
v_mov_b32 v3, s60
s_mov_b64 exec, 1
buffer_atomic_add v3, v2, s[72:75], 0 offen offset:128 sc1
s_mov_b64 exec, -1
mega_kernel_nv:
s_barrier
s_lshl_b32 s60, s40, 12
s_add_u32 s60, s60, 67108864
buffer_store_dwordx4 v[8:11], v1, s[84:87], s60 offen sc1
s_add_u32 s60, s60, 131072
buffer_store_dwordx4 v[8:11], v1, s[84:87], s60 offen sc1
s_add_u32 s60, s60, 131072
buffer_store_dwordx4 v[8:11], v1, s[84:87], s60 offen sc1
s_add_u32 s60, s60, 131072
buffer_store_dwordx4 v[8:11], v1, s[84:87], s60 offen sc1
s_add_u32 s60, s60, 131072
buffer_store_dwordx4 v[8:11], v1, s[84:87], s60 offen sc1
s_add_u32 s60, s60, 131072
buffer_store_dwordx4 v[8:11], v1, s[84:87], s60 offen sc1
s_add_u32 s60, s60, 131072
buffer_store_dwordx4 v[8:11], v1, s[84:87], s60 offen sc1
s_add_u32 s60, s60, 131072
buffer_store_dwordx4 v[8:11], v1, s[84:87], s60 offen sc1
s_add_u32 s60, s60, 131072
buffer_store_dwordx4 v[8:11], v1, s[84:87], s60 offen sc1
s_add_u32 s60, s60, 131072
buffer_store_dwordx4 v[8:11], v1, s[84:87], s60 offen sc1
s_add_u32 s60, s60, 131072
buffer_store_dwordx4 v[8:11], v1, s[84:87], s60 offen sc1
s_add_u32 s60, s60, 131072
buffer_store_dwordx4 v[8:11], v1, s[84:87], s60 offen sc1
s_add_u32 s60, s60, 131072
buffer_store_dwordx4 v[8:11], v1, s[84:87], s60 offen sc1
s_add_u32 s60, s60, 131072
buffer_store_dwordx4 v[8:11], v1, s[84:87], s60 offen sc1
s_add_u32 s60, s60, 131072
buffer_store_dwordx4 v[8:11], v1, s[84:87], s60 offen sc1
s_add_u32 s60, s60, 131072
buffer_store_dwordx4 v[8:11], v1, s[84:87], s60 offen sc1
s_add_u32 s60, s60, 131072
s_lshr_b32 s62, s40, 1
s_and_b32 s63, s40, 1
s_add_u32 s63, s63, s62
s_lshl_b32 s62, s62, 19
s_and_b32 s64, s63, 14
s_lshl_b32 s64, s64, 13
s_add_u32 s62, s62, s64
s_and_b32 s64, s63, 1
s_lshl_b32 s64, s64, 12
s_add_u32 s62, s62, s64
s_add_u32 s62, s62, 150994944
s_add_u32 s62, s62, 8192
s_cmp_lt_u32 s40, 16
s_cbranch_scc0 mega_kernel_pz
buffer_store_dwordx4 v[8:11], v1, s[84:87], s60 offen sc1
mega_kernel_pz:
s_waitcnt vmcnt(0)
s_barrier
v_mov_b32 v3, 1
s_lshl_b32 s62, s95, 6
v_cmp_eq_u32 vcc, 0, v0
s_and_saveexec_b64 s[60:61], vcc
s_cbranch_execz mega_kernel_xps
buffer_atomic_add v3, v2, s[72:75], s62 offen offset:160 sc1
mega_kernel_xps:
s_mov_b64 exec, s[60:61]
mega_kernel_noinit:
s_cmp_eq_u32 s91, 2
s_cbranch_scc1 mega_kernel_nohold
v_and_b32 v3, 15, v0
v_lshlrev_b32 v3, 4, v3
s_branch mega_kernel_syh
mega_kernel_syhw:
s_sleep 4
mega_kernel_syh:
buffer_load_dword v2, v3, s[72:75], 0 offen sc1
s_waitcnt vmcnt(0)
mega_kernel_syhp:
s_cmp_eq_u32 s95, 1
s_cbranch_scc0 mega_kernel_syhf
v_readlane_b32 s76, v2, 14
s_mov_b32 s98, 0
s_cmp_eq_u32 s76, 32
s_cbranch_scc0 mega_kernel_syhw
s_branch mega_kernel_syhd
mega_kernel_syhf:
s_mov_b32 s77, 0
s_mov_b32 s78, 0
v_readlane_b32 s76, v2, 0
s_add_u32 s77, s77, s76
s_xor_b32 s76, s76, 32
s_or_b32 s78, s78, s76
v_readlane_b32 s76, v2, 1
s_add_u32 s77, s77, s76
s_xor_b32 s76, s76, 32
s_or_b32 s78, s78, s76
v_readlane_b32 s76, v2, 2
s_add_u32 s77, s77, s76
s_xor_b32 s76, s76, 32
s_or_b32 s78, s78, s76
v_readlane_b32 s76, v2, 3
s_add_u32 s77, s77, s76
s_xor_b32 s76, s76, 32
s_or_b32 s78, s78, s76
v_readlane_b32 s76, v2, 4
s_add_u32 s77, s77, s76
s_xor_b32 s76, s76, 32
s_or_b32 s78, s78, s76
v_readlane_b32 s76, v2, 5
s_add_u32 s77, s77, s76
s_xor_b32 s76, s76, 32
s_or_b32 s78, s78, s76
v_readlane_b32 s76, v2, 6
s_add_u32 s77, s77, s76
s_xor_b32 s76, s76, 32
s_or_b32 s78, s78, s76
v_readlane_b32 s76, v2, 7
s_add_u32 s77, s77, s76
s_xor_b32 s76, s76, 32
s_or_b32 s78, s78, s76
s_cmp_eq_u32 s77, 256
s_cbranch_scc0 mega_kernel_syhw
v_mov_b32 v252, v2
s_cmp_eq_u32 s78, 0
s_cbranch_scc0 mega_kernel_slowent
v_readlane_b32 s76, v2, 10
v_readlane_b32 s77, v2, 8
s_cmp_eq_u32 s76, 32
s_cbranch_scc0 mega_kernel_syhw
s_cmp_gt_u32 s77, 16
s_cselect_b32 s98, 1, 0
mega_kernel_syhd:
s_xor_b32 s76, s98, 1
s_lshl_b32 s76, s76, 13
s_lshl_b32 s77, s40, 7
s_add_u32 s76, s76, s77
s_add_u32 s76, s76, 69206016
v_mov_b32 v1, 0
mega_kernel_hold:
s_sleep 12
buffer_load_dword v2, v1, s[84:87], s76 offen sc1
s_waitcnt vmcnt(0)
v_cmp_gt_i32 vcc, 1, v2
s_cbranch_vccnz mega_kernel_hold
mega_kernel_nohold:
s_cmp_eq_u32 s91, 2
s_cbranch_scc0 mega_kernel_rd
s_load_dwordx2 s[4:5], s[0:1], 16
s_load_dwordx2 s[8:9], s[0:1], 0
v_lshrrev_b32 v2, 6, v0
v_and_b32 v1, 63, v0
v_readfirstlane_b32 s41, v2
v_lshlrev_b32 v5, 4, v1
s_waitcnt lgkmcnt(0)
s_mov_b32 s6, 8388608
s_mov_b32 s7, 0x00020000
s_mov_b32 s10, 4194304
s_mov_b32 s11, 0x00020000
s_lshl_b32 s43, s40, 8
s_lshl_b32 s44, s41, 6
s_add_u32 s48, s43, s44
s_and_b32 s43, s48, 0x7ff
v_add_u32 v19, s43, v1
v_lshlrev_b32 v19, 7, v19
s_mov_b32 s43, 0
buffer_load_dword v250, v19, s[8:11], s43 offen
s_nop 0
v_lshrrev_b32 v2, 3, v1
s_lshl_b32 s43, s41, 3
v_add_u32 v2, s43, v2
v_bfe_u32 v3, v2, 1, 3
v_and_b32 v4, 7, v1
v_xor_b32 v3, v3, v4
v_lshlrev_b32 v6, 11, v2
v_lshl_add_u32 v6, v3, 4, v6
s_lshl_b32 s46, s41, 10
v_and_b32 v2, 15, v1
v_bfe_u32 v3, v2, 1, 3
v_lshrrev_b32 v4, 4, v1
v_xor_b32 v3, v3, v4
v_lshlrev_b32 v8, 7, v2
v_lshl_add_u32 v8, v3, 4, v8
v_xor_b32 v9, 64, v8
v_add_u32 v10, 0x10000, v8
v_add_u32 v11, 0x10000, v9
v_mov_b32 v7, v5
s_lshl_b32 s47, s40, 2
s_add_u32 s47, s47, s41
s_mov_b32 s42, 0
s_mov_b32 s50, 0
s_add_u32 m0, s46, 0
s_nop 0
buffer_load_dwordx4 v6, s[8:11], s50 offen offset:0 lds
s_add_u32 m0, s46, 3968
s_nop 0
buffer_load_dwordx4 v6, s[8:11], s50 offen offset:128 lds
s_add_u32 m0, s46, 7936
s_nop 0
buffer_load_dwordx4 v6, s[8:11], s50 offen offset:256 lds
s_add_u32 m0, s46, 11904
s_nop 0
buffer_load_dwordx4 v6, s[8:11], s50 offen offset:384 lds
s_add_u32 m0, s46, 15872
s_nop 0
buffer_load_dwordx4 v6, s[8:11], s50 offen offset:512 lds
s_add_u32 m0, s46, 19840
s_nop 0
buffer_load_dwordx4 v6, s[8:11], s50 offen offset:640 lds
s_add_u32 m0, s46, 23808
s_nop 0
buffer_load_dwordx4 v6, s[8:11], s50 offen offset:768 lds
s_add_u32 m0, s46, 27776
s_nop 0
buffer_load_dwordx4 v6, s[8:11], s50 offen offset:896 lds
s_add_u32 m0, s46, 31744
s_nop 0
buffer_load_dwordx4 v6, s[8:11], s50 offen offset:1024 lds
s_add_u32 m0, s46, 35712
s_nop 0
buffer_load_dwordx4 v6, s[8:11], s50 offen offset:1152 lds
s_add_u32 m0, s46, 39680
s_nop 0
buffer_load_dwordx4 v6, s[8:11], s50 offen offset:1280 lds
s_add_u32 m0, s46, 43648
s_nop 0
buffer_load_dwordx4 v6, s[8:11], s50 offen offset:1408 lds
s_add_u32 m0, s46, 47616
s_nop 0
buffer_load_dwordx4 v6, s[8:11], s50 offen offset:1536 lds
s_add_u32 m0, s46, 51584
s_nop 0
buffer_load_dwordx4 v6, s[8:11], s50 offen offset:1664 lds
s_add_u32 m0, s46, 55552
s_nop 0
buffer_load_dwordx4 v6, s[8:11], s50 offen offset:1792 lds
s_add_u32 m0, s46, 59520
s_nop 0
buffer_load_dwordx4 v6, s[8:11], s50 offen offset:1920 lds
v_lshrrev_b32 v2, 2, v1
v_and_b32 v3, 3, v1
v_lshlrev_b32 v16, 13, v2
v_lshl_add_u32 v16, v3, 4, v16
v_add_u32 v16, s48, v16
s_mul_i32 s45, s41, 24576
s_add_u32 s45, s45, 65536
v_bfe_u32 v17, v1, 2, 2
v_lshrrev_b32 v18, 4, v1
v_lshl_add_u32 v17, v18, 3, v17
v_lshlrev_b32 v17, 6, v17
v_lshl_add_u32 v17, v3, 4, v17
v_add_u32 v17, s45, v17
s_and_b32 s43, s40, 3
s_lshl_b32 s43, s43, 2
s_add_u32 s43, s43, s41
s_lshl_b32 s43, s43, 3
v_and_b32 v12, 7, v1
v_add_u32 v12, s43, v12
s_lshr_b32 s43, s40, 2
s_lshl_b32 s43, s43, 10
s_add_u32 s44, s43, 896
s_add_u32 s43, s43, 384
s_cmp_ge_u32 s40, 28
s_cselect_b32 s44, s44, s43
v_mov_b32 v13, s43
v_mov_b32 v14, s44
v_cmp_gt_u32 vcc, 32, v1
s_nop 1
v_cndmask_b32 v13, v14, v13, vcc
v_lshl_add_u32 v12, v12, 13, v13
s_mov_b32 s44, 0
buffer_load_dword v250, v12, s[4:7], s44 offen
s_add_u32 m0, s45, 0
s_mov_b32 s44, 0
buffer_load_dwordx4 v16, s[4:7], s44 offen lds
s_add_u32 m0, s45, 1024
s_mov_b32 s44, 131072
buffer_load_dwordx4 v16, s[4:7], s44 offen lds
s_add_u32 m0, s45, 2048
s_mov_b32 s44, 262144
buffer_load_dwordx4 v16, s[4:7], s44 offen lds
s_add_u32 m0, s45, 3072
s_mov_b32 s44, 393216
buffer_load_dwordx4 v16, s[4:7], s44 offen lds
s_add_u32 m0, s45, 4096
s_mov_b32 s44, 524288
buffer_load_dwordx4 v16, s[4:7], s44 offen lds
s_add_u32 m0, s45, 5120
s_mov_b32 s44, 655360
buffer_load_dwordx4 v16, s[4:7], s44 offen lds
s_add_u32 m0, s45, 6144
s_mov_b32 s44, 786432
buffer_load_dwordx4 v16, s[4:7], s44 offen lds
s_add_u32 m0, s45, 7168
s_mov_b32 s44, 917504
buffer_load_dwordx4 v16, s[4:7], s44 offen lds
s_mov_b32 s44, 1048576
buffer_load_dword v250, v12, s[4:7], s44 offen
s_add_u32 m0, s45, 8192
s_mov_b32 s44, 1048576
buffer_load_dwordx4 v16, s[4:7], s44 offen lds
s_add_u32 m0, s45, 9216
s_mov_b32 s44, 1179648
buffer_load_dwordx4 v16, s[4:7], s44 offen lds
s_add_u32 m0, s45, 10240
s_mov_b32 s44, 1310720
buffer_load_dwordx4 v16, s[4:7], s44 offen lds
s_add_u32 m0, s45, 11264
s_mov_b32 s44, 1441792
buffer_load_dwordx4 v16, s[4:7], s44 offen lds
s_add_u32 m0, s45, 12288
s_mov_b32 s44, 1572864
buffer_load_dwordx4 v16, s[4:7], s44 offen lds
s_add_u32 m0, s45, 13312
s_mov_b32 s44, 1703936
buffer_load_dwordx4 v16, s[4:7], s44 offen lds
s_add_u32 m0, s45, 14336
s_mov_b32 s44, 1835008
buffer_load_dwordx4 v16, s[4:7], s44 offen lds
s_add_u32 m0, s45, 15360
s_mov_b32 s44, 1966080
buffer_load_dwordx4 v16, s[4:7], s44 offen lds
s_mov_b32 s44, 2097152
buffer_load_dword v250, v12, s[4:7], s44 offen
s_add_u32 m0, s45, 16384
s_mov_b32 s44, 2097152
buffer_load_dwordx4 v16, s[4:7], s44 offen lds
s_add_u32 m0, s45, 17408
s_mov_b32 s44, 2228224
buffer_load_dwordx4 v16, s[4:7], s44 offen lds
s_add_u32 m0, s45, 18432
s_mov_b32 s44, 2359296
buffer_load_dwordx4 v16, s[4:7], s44 offen lds
s_add_u32 m0, s45, 19456
s_mov_b32 s44, 2490368
buffer_load_dwordx4 v16, s[4:7], s44 offen lds
s_add_u32 m0, s45, 20480
s_mov_b32 s44, 2621440
buffer_load_dwordx4 v16, s[4:7], s44 offen lds
s_add_u32 m0, s45, 21504
s_mov_b32 s44, 2752512
buffer_load_dwordx4 v16, s[4:7], s44 offen lds
s_add_u32 m0, s45, 22528
s_mov_b32 s44, 2883584
buffer_load_dwordx4 v16, s[4:7], s44 offen lds
s_add_u32 m0, s45, 23552
s_mov_b32 s44, 3014656
buffer_load_dwordx4 v16, s[4:7], s44 offen lds
s_waitcnt vmcnt(18)
s_barrier
ds_read_b64_tr_b16 a[0:1], v17 offset:0
ds_read_b64_tr_b16 a[2:3], v17 offset:256
ds_read_b64_tr_b16 a[4:5], v17 offset:8
ds_read_b64_tr_b16 a[6:7], v17 offset:264
ds_read_b64_tr_b16 a[8:9], v17 offset:2048
ds_read_b64_tr_b16 a[10:11], v17 offset:2304
ds_read_b64_tr_b16 a[12:13], v17 offset:2056
ds_read_b64_tr_b16 a[14:15], v17 offset:2312
s_waitcnt lgkmcnt(0)
ds_read_b64_tr_b16 a[16:17], v17 offset:4096
ds_read_b64_tr_b16 a[18:19], v17 offset:4352
ds_read_b64_tr_b16 a[20:21], v17 offset:4104
ds_read_b64_tr_b16 a[22:23], v17 offset:4360
ds_read_b64_tr_b16 a[24:25], v17 offset:6144
ds_read_b64_tr_b16 a[26:27], v17 offset:6400
ds_read_b64_tr_b16 a[28:29], v17 offset:6152
ds_read_b64_tr_b16 a[30:31], v17 offset:6408
s_waitcnt lgkmcnt(0)
s_mov_b32 s44, 3145728
buffer_load_dword v250, v12, s[4:7], s44 offen
s_add_u32 m0, s45, 0
s_mov_b32 s44, 3145728
buffer_load_dwordx4 v16, s[4:7], s44 offen lds
s_add_u32 m0, s45, 1024
s_mov_b32 s44, 3276800
buffer_load_dwordx4 v16, s[4:7], s44 offen lds
s_add_u32 m0, s45, 2048
s_mov_b32 s44, 3407872
buffer_load_dwordx4 v16, s[4:7], s44 offen lds
s_add_u32 m0, s45, 3072
s_mov_b32 s44, 3538944
buffer_load_dwordx4 v16, s[4:7], s44 offen lds
s_add_u32 m0, s45, 4096
s_mov_b32 s44, 3670016
buffer_load_dwordx4 v16, s[4:7], s44 offen lds
s_add_u32 m0, s45, 5120
s_mov_b32 s44, 3801088
buffer_load_dwordx4 v16, s[4:7], s44 offen lds
s_add_u32 m0, s45, 6144
s_mov_b32 s44, 3932160
buffer_load_dwordx4 v16, s[4:7], s44 offen lds
s_add_u32 m0, s45, 7168
s_mov_b32 s44, 4063232
buffer_load_dwordx4 v16, s[4:7], s44 offen lds
ds_read_b128 v[20:23], v8 offset:0
ds_read_b128 v[24:27], v8 offset:2048
ds_read_b128 v[28:31], v9 offset:0
ds_read_b128 v[32:35], v9 offset:2048
ds_read_b128 v[36:39], v8 offset:4096
ds_read_b128 v[40:43], v8 offset:6144
ds_read_b128 v[44:47], v9 offset:4096
ds_read_b128 v[48:51], v9 offset:6144
s_waitcnt lgkmcnt(0)
v_mfma_f32_16x16x32_bf16 v[52:55], a[0:3], v[20:23], 0
v_mfma_f32_16x16x32_bf16 v[56:59], a[4:7], v[20:23], 0
v_mfma_f32_16x16x32_bf16 v[60:63], a[0:3], v[24:27], 0
v_mfma_f32_16x16x32_bf16 v[64:67], a[4:7], v[24:27], 0
v_mfma_f32_16x16x32_bf16 v[52:55], a[8:11], v[28:31], v[52:55]
v_mfma_f32_16x16x32_bf16 v[56:59], a[12:15], v[28:31], v[56:59]
v_mfma_f32_16x16x32_bf16 v[60:63], a[8:11], v[32:35], v[60:63]
v_mfma_f32_16x16x32_bf16 v[64:67], a[12:15], v[32:35], v[64:67]
v_mfma_f32_16x16x32_bf16 v[52:55], a[16:19], v[36:39], v[52:55]
v_mfma_f32_16x16x32_bf16 v[56:59], a[20:23], v[36:39], v[56:59]
v_mfma_f32_16x16x32_bf16 v[60:63], a[16:19], v[40:43], v[60:63]
v_mfma_f32_16x16x32_bf16 v[64:67], a[20:23], v[40:43], v[64:67]
v_mfma_f32_16x16x32_bf16 v[52:55], a[24:27], v[44:47], v[52:55]
v_mfma_f32_16x16x32_bf16 v[56:59], a[28:31], v[44:47], v[56:59]
v_mfma_f32_16x16x32_bf16 v[60:63], a[24:27], v[48:51], v[60:63]
v_mfma_f32_16x16x32_bf16 v[64:67], a[28:31], v[48:51], v[64:67]
s_waitcnt vmcnt(18)
ds_read_b64_tr_b16 a[32:33], v17 offset:8192
ds_read_b64_tr_b16 a[34:35], v17 offset:8448
ds_read_b64_tr_b16 a[36:37], v17 offset:8200
ds_read_b64_tr_b16 a[38:39], v17 offset:8456
ds_read_b64_tr_b16 a[40:41], v17 offset:10240
ds_read_b64_tr_b16 a[42:43], v17 offset:10496
ds_read_b64_tr_b16 a[44:45], v17 offset:10248
ds_read_b64_tr_b16 a[46:47], v17 offset:10504
s_waitcnt lgkmcnt(0)
ds_read_b64_tr_b16 a[48:49], v17 offset:12288
ds_read_b64_tr_b16 a[50:51], v17 offset:12544
ds_read_b64_tr_b16 a[52:53], v17 offset:12296
ds_read_b64_tr_b16 a[54:55], v17 offset:12552
ds_read_b64_tr_b16 a[56:57], v17 offset:14336
ds_read_b64_tr_b16 a[58:59], v17 offset:14592
ds_read_b64_tr_b16 a[60:61], v17 offset:14344
ds_read_b64_tr_b16 a[62:63], v17 offset:14600
s_waitcnt lgkmcnt(0)
s_mov_b32 s44, 4194304
buffer_load_dword v250, v12, s[4:7], s44 offen
s_add_u32 m0, s45, 8192
s_mov_b32 s44, 4194304
buffer_load_dwordx4 v16, s[4:7], s44 offen lds
s_add_u32 m0, s45, 9216
s_mov_b32 s44, 4325376
buffer_load_dwordx4 v16, s[4:7], s44 offen lds
s_add_u32 m0, s45, 10240
s_mov_b32 s44, 4456448
buffer_load_dwordx4 v16, s[4:7], s44 offen lds
s_add_u32 m0, s45, 11264
s_mov_b32 s44, 4587520
buffer_load_dwordx4 v16, s[4:7], s44 offen lds
s_add_u32 m0, s45, 12288
s_mov_b32 s44, 4718592
buffer_load_dwordx4 v16, s[4:7], s44 offen lds
s_add_u32 m0, s45, 13312
s_mov_b32 s44, 4849664
buffer_load_dwordx4 v16, s[4:7], s44 offen lds
s_add_u32 m0, s45, 14336
s_mov_b32 s44, 4980736
buffer_load_dwordx4 v16, s[4:7], s44 offen lds
s_add_u32 m0, s45, 15360
s_mov_b32 s44, 5111808
buffer_load_dwordx4 v16, s[4:7], s44 offen lds
ds_read_b128 v[20:23], v8 offset:8192
ds_read_b128 v[24:27], v8 offset:10240
ds_read_b128 v[28:31], v9 offset:8192
ds_read_b128 v[32:35], v9 offset:10240
ds_read_b128 v[36:39], v8 offset:12288
ds_read_b128 v[40:43], v8 offset:14336
ds_read_b128 v[44:47], v9 offset:12288
ds_read_b128 v[48:51], v9 offset:14336
s_waitcnt lgkmcnt(0)
v_mfma_f32_16x16x32_bf16 v[52:55], a[32:35], v[20:23], v[52:55]
v_mfma_f32_16x16x32_bf16 v[56:59], a[36:39], v[20:23], v[56:59]
v_mfma_f32_16x16x32_bf16 v[60:63], a[32:35], v[24:27], v[60:63]
v_mfma_f32_16x16x32_bf16 v[64:67], a[36:39], v[24:27], v[64:67]
v_mfma_f32_16x16x32_bf16 v[52:55], a[40:43], v[28:31], v[52:55]
v_mfma_f32_16x16x32_bf16 v[56:59], a[44:47], v[28:31], v[56:59]
v_mfma_f32_16x16x32_bf16 v[60:63], a[40:43], v[32:35], v[60:63]
v_mfma_f32_16x16x32_bf16 v[64:67], a[44:47], v[32:35], v[64:67]
v_mfma_f32_16x16x32_bf16 v[52:55], a[48:51], v[36:39], v[52:55]
v_mfma_f32_16x16x32_bf16 v[56:59], a[52:55], v[36:39], v[56:59]
v_mfma_f32_16x16x32_bf16 v[60:63], a[48:51], v[40:43], v[60:63]
v_mfma_f32_16x16x32_bf16 v[64:67], a[52:55], v[40:43], v[64:67]
v_mfma_f32_16x16x32_bf16 v[52:55], a[56:59], v[44:47], v[52:55]
v_mfma_f32_16x16x32_bf16 v[56:59], a[60:63], v[44:47], v[56:59]
v_mfma_f32_16x16x32_bf16 v[60:63], a[56:59], v[48:51], v[60:63]
v_mfma_f32_16x16x32_bf16 v[64:67], a[60:63], v[48:51], v[64:67]
s_waitcnt vmcnt(18)
ds_read_b64_tr_b16 a[64:65], v17 offset:16384
ds_read_b64_tr_b16 a[66:67], v17 offset:16640
ds_read_b64_tr_b16 a[68:69], v17 offset:16392
ds_read_b64_tr_b16 a[70:71], v17 offset:16648
ds_read_b64_tr_b16 a[72:73], v17 offset:18432
ds_read_b64_tr_b16 a[74:75], v17 offset:18688
ds_read_b64_tr_b16 a[76:77], v17 offset:18440
ds_read_b64_tr_b16 a[78:79], v17 offset:18696
s_waitcnt lgkmcnt(0)
ds_read_b64_tr_b16 a[80:81], v17 offset:20480
ds_read_b64_tr_b16 a[82:83], v17 offset:20736
ds_read_b64_tr_b16 a[84:85], v17 offset:20488
ds_read_b64_tr_b16 a[86:87], v17 offset:20744
ds_read_b64_tr_b16 a[88:89], v17 offset:22528
ds_read_b64_tr_b16 a[90:91], v17 offset:22784
ds_read_b64_tr_b16 a[92:93], v17 offset:22536
ds_read_b64_tr_b16 a[94:95], v17 offset:22792
s_waitcnt lgkmcnt(0)
s_mov_b32 s44, 5242880
buffer_load_dword v250, v12, s[4:7], s44 offen
s_add_u32 m0, s45, 16384
s_mov_b32 s44, 5242880
buffer_load_dwordx4 v16, s[4:7], s44 offen lds
s_add_u32 m0, s45, 17408
s_mov_b32 s44, 5373952
buffer_load_dwordx4 v16, s[4:7], s44 offen lds
s_add_u32 m0, s45, 18432
s_mov_b32 s44, 5505024
buffer_load_dwordx4 v16, s[4:7], s44 offen lds
s_add_u32 m0, s45, 19456
s_mov_b32 s44, 5636096
buffer_load_dwordx4 v16, s[4:7], s44 offen lds
s_add_u32 m0, s45, 20480
s_mov_b32 s44, 5767168
buffer_load_dwordx4 v16, s[4:7], s44 offen lds
s_add_u32 m0, s45, 21504
s_mov_b32 s44, 5898240
buffer_load_dwordx4 v16, s[4:7], s44 offen lds
s_add_u32 m0, s45, 22528
s_mov_b32 s44, 6029312
buffer_load_dwordx4 v16, s[4:7], s44 offen lds
s_add_u32 m0, s45, 23552
s_mov_b32 s44, 6160384
buffer_load_dwordx4 v16, s[4:7], s44 offen lds
ds_read_b128 v[20:23], v8 offset:16384
ds_read_b128 v[24:27], v8 offset:18432
ds_read_b128 v[28:31], v9 offset:16384
ds_read_b128 v[32:35], v9 offset:18432
ds_read_b128 v[36:39], v8 offset:20480
ds_read_b128 v[40:43], v8 offset:22528
ds_read_b128 v[44:47], v9 offset:20480
ds_read_b128 v[48:51], v9 offset:22528
s_waitcnt lgkmcnt(0)
v_mfma_f32_16x16x32_bf16 v[52:55], a[64:67], v[20:23], v[52:55]
v_mfma_f32_16x16x32_bf16 v[56:59], a[68:71], v[20:23], v[56:59]
v_mfma_f32_16x16x32_bf16 v[60:63], a[64:67], v[24:27], v[60:63]
v_mfma_f32_16x16x32_bf16 v[64:67], a[68:71], v[24:27], v[64:67]
v_mfma_f32_16x16x32_bf16 v[52:55], a[72:75], v[28:31], v[52:55]
v_mfma_f32_16x16x32_bf16 v[56:59], a[76:79], v[28:31], v[56:59]
v_mfma_f32_16x16x32_bf16 v[60:63], a[72:75], v[32:35], v[60:63]
v_mfma_f32_16x16x32_bf16 v[64:67], a[76:79], v[32:35], v[64:67]
v_mfma_f32_16x16x32_bf16 v[52:55], a[80:83], v[36:39], v[52:55]
v_mfma_f32_16x16x32_bf16 v[56:59], a[84:87], v[36:39], v[56:59]
v_mfma_f32_16x16x32_bf16 v[60:63], a[80:83], v[40:43], v[60:63]
v_mfma_f32_16x16x32_bf16 v[64:67], a[84:87], v[40:43], v[64:67]
v_mfma_f32_16x16x32_bf16 v[52:55], a[88:91], v[44:47], v[52:55]
v_mfma_f32_16x16x32_bf16 v[56:59], a[92:95], v[44:47], v[56:59]
v_mfma_f32_16x16x32_bf16 v[60:63], a[88:91], v[48:51], v[60:63]
v_mfma_f32_16x16x32_bf16 v[64:67], a[92:95], v[48:51], v[64:67]
s_waitcnt vmcnt(18)
ds_read_b64_tr_b16 a[96:97], v17 offset:0
ds_read_b64_tr_b16 a[98:99], v17 offset:256
ds_read_b64_tr_b16 a[100:101], v17 offset:8
ds_read_b64_tr_b16 a[102:103], v17 offset:264
ds_read_b64_tr_b16 a[104:105], v17 offset:2048
ds_read_b64_tr_b16 a[106:107], v17 offset:2304
ds_read_b64_tr_b16 a[108:109], v17 offset:2056
ds_read_b64_tr_b16 a[110:111], v17 offset:2312
s_waitcnt lgkmcnt(0)
ds_read_b64_tr_b16 a[112:113], v17 offset:4096
ds_read_b64_tr_b16 a[114:115], v17 offset:4352
ds_read_b64_tr_b16 a[116:117], v17 offset:4104
ds_read_b64_tr_b16 a[118:119], v17 offset:4360
ds_read_b64_tr_b16 a[120:121], v17 offset:6144
ds_read_b64_tr_b16 a[122:123], v17 offset:6400
ds_read_b64_tr_b16 a[124:125], v17 offset:6152
ds_read_b64_tr_b16 a[126:127], v17 offset:6408
s_waitcnt lgkmcnt(0)
s_mov_b32 s44, 6291456
buffer_load_dword v250, v12, s[4:7], s44 offen
s_add_u32 m0, s45, 0
s_mov_b32 s44, 6291456
buffer_load_dwordx4 v16, s[4:7], s44 offen lds
s_add_u32 m0, s45, 1024
s_mov_b32 s44, 6422528
buffer_load_dwordx4 v16, s[4:7], s44 offen lds
s_add_u32 m0, s45, 2048
s_mov_b32 s44, 6553600
buffer_load_dwordx4 v16, s[4:7], s44 offen lds
s_add_u32 m0, s45, 3072
s_mov_b32 s44, 6684672
buffer_load_dwordx4 v16, s[4:7], s44 offen lds
s_add_u32 m0, s45, 4096
s_mov_b32 s44, 6815744
buffer_load_dwordx4 v16, s[4:7], s44 offen lds
s_add_u32 m0, s45, 5120
s_mov_b32 s44, 6946816
buffer_load_dwordx4 v16, s[4:7], s44 offen lds
s_add_u32 m0, s45, 6144
s_mov_b32 s44, 7077888
buffer_load_dwordx4 v16, s[4:7], s44 offen lds
s_add_u32 m0, s45, 7168
s_mov_b32 s44, 7208960
buffer_load_dwordx4 v16, s[4:7], s44 offen lds
ds_read_b128 v[20:23], v8 offset:24576
ds_read_b128 v[24:27], v8 offset:26624
ds_read_b128 v[28:31], v9 offset:24576
ds_read_b128 v[32:35], v9 offset:26624
ds_read_b128 v[36:39], v8 offset:28672
ds_read_b128 v[40:43], v8 offset:30720
ds_read_b128 v[44:47], v9 offset:28672
ds_read_b128 v[48:51], v9 offset:30720
s_waitcnt lgkmcnt(0)
v_mfma_f32_16x16x32_bf16 v[52:55], a[96:99], v[20:23], v[52:55]
v_mfma_f32_16x16x32_bf16 v[56:59], a[100:103], v[20:23], v[56:59]
v_mfma_f32_16x16x32_bf16 v[60:63], a[96:99], v[24:27], v[60:63]
v_mfma_f32_16x16x32_bf16 v[64:67], a[100:103], v[24:27], v[64:67]
v_mfma_f32_16x16x32_bf16 v[52:55], a[104:107], v[28:31], v[52:55]
v_mfma_f32_16x16x32_bf16 v[56:59], a[108:111], v[28:31], v[56:59]
v_mfma_f32_16x16x32_bf16 v[60:63], a[104:107], v[32:35], v[60:63]
v_mfma_f32_16x16x32_bf16 v[64:67], a[108:111], v[32:35], v[64:67]
v_mfma_f32_16x16x32_bf16 v[52:55], a[112:115], v[36:39], v[52:55]
v_mfma_f32_16x16x32_bf16 v[56:59], a[116:119], v[36:39], v[56:59]
v_mfma_f32_16x16x32_bf16 v[60:63], a[112:115], v[40:43], v[60:63]
v_mfma_f32_16x16x32_bf16 v[64:67], a[116:119], v[40:43], v[64:67]
v_mfma_f32_16x16x32_bf16 v[52:55], a[120:123], v[44:47], v[52:55]
v_mfma_f32_16x16x32_bf16 v[56:59], a[124:127], v[44:47], v[56:59]
v_mfma_f32_16x16x32_bf16 v[60:63], a[120:123], v[48:51], v[60:63]
v_mfma_f32_16x16x32_bf16 v[64:67], a[124:127], v[48:51], v[64:67]
s_waitcnt vmcnt(18)
ds_read_b64_tr_b16 a[128:129], v17 offset:8192
ds_read_b64_tr_b16 a[130:131], v17 offset:8448
ds_read_b64_tr_b16 a[132:133], v17 offset:8200
ds_read_b64_tr_b16 a[134:135], v17 offset:8456
ds_read_b64_tr_b16 a[136:137], v17 offset:10240
ds_read_b64_tr_b16 a[138:139], v17 offset:10496
ds_read_b64_tr_b16 a[140:141], v17 offset:10248
ds_read_b64_tr_b16 a[142:143], v17 offset:10504
s_waitcnt lgkmcnt(0)
ds_read_b64_tr_b16 a[144:145], v17 offset:12288
ds_read_b64_tr_b16 a[146:147], v17 offset:12544
ds_read_b64_tr_b16 a[148:149], v17 offset:12296
ds_read_b64_tr_b16 a[150:151], v17 offset:12552
ds_read_b64_tr_b16 a[152:153], v17 offset:14336
ds_read_b64_tr_b16 a[154:155], v17 offset:14592
ds_read_b64_tr_b16 a[156:157], v17 offset:14344
ds_read_b64_tr_b16 a[158:159], v17 offset:14600
s_waitcnt lgkmcnt(0)
s_mov_b32 s44, 7340032
buffer_load_dword v250, v12, s[4:7], s44 offen
s_add_u32 m0, s45, 8192
s_mov_b32 s44, 7340032
buffer_load_dwordx4 v16, s[4:7], s44 offen lds
s_add_u32 m0, s45, 9216
s_mov_b32 s44, 7471104
buffer_load_dwordx4 v16, s[4:7], s44 offen lds
s_add_u32 m0, s45, 10240
s_mov_b32 s44, 7602176
buffer_load_dwordx4 v16, s[4:7], s44 offen lds
s_add_u32 m0, s45, 11264
s_mov_b32 s44, 7733248
buffer_load_dwordx4 v16, s[4:7], s44 offen lds
s_add_u32 m0, s45, 12288
s_mov_b32 s44, 7864320
buffer_load_dwordx4 v16, s[4:7], s44 offen lds
s_add_u32 m0, s45, 13312
s_mov_b32 s44, 7995392
buffer_load_dwordx4 v16, s[4:7], s44 offen lds
s_add_u32 m0, s45, 14336
s_mov_b32 s44, 8126464
buffer_load_dwordx4 v16, s[4:7], s44 offen lds
s_add_u32 m0, s45, 15360
s_mov_b32 s44, 8257536
buffer_load_dwordx4 v16, s[4:7], s44 offen lds
ds_read_b128 v[20:23], v8 offset:32768
ds_read_b128 v[24:27], v8 offset:34816
ds_read_b128 v[28:31], v9 offset:32768
ds_read_b128 v[32:35], v9 offset:34816
ds_read_b128 v[36:39], v8 offset:36864
ds_read_b128 v[40:43], v8 offset:38912
ds_read_b128 v[44:47], v9 offset:36864
ds_read_b128 v[48:51], v9 offset:38912
s_waitcnt lgkmcnt(0)
v_mfma_f32_16x16x32_bf16 v[52:55], a[128:131], v[20:23], v[52:55]
v_mfma_f32_16x16x32_bf16 v[56:59], a[132:135], v[20:23], v[56:59]
v_mfma_f32_16x16x32_bf16 v[60:63], a[128:131], v[24:27], v[60:63]
v_mfma_f32_16x16x32_bf16 v[64:67], a[132:135], v[24:27], v[64:67]
v_mfma_f32_16x16x32_bf16 v[52:55], a[136:139], v[28:31], v[52:55]
v_mfma_f32_16x16x32_bf16 v[56:59], a[140:143], v[28:31], v[56:59]
v_mfma_f32_16x16x32_bf16 v[60:63], a[136:139], v[32:35], v[60:63]
v_mfma_f32_16x16x32_bf16 v[64:67], a[140:143], v[32:35], v[64:67]
v_mfma_f32_16x16x32_bf16 v[52:55], a[144:147], v[36:39], v[52:55]
v_mfma_f32_16x16x32_bf16 v[56:59], a[148:151], v[36:39], v[56:59]
v_mfma_f32_16x16x32_bf16 v[60:63], a[144:147], v[40:43], v[60:63]
v_mfma_f32_16x16x32_bf16 v[64:67], a[148:151], v[40:43], v[64:67]
v_mfma_f32_16x16x32_bf16 v[52:55], a[152:155], v[44:47], v[52:55]
v_mfma_f32_16x16x32_bf16 v[56:59], a[156:159], v[44:47], v[56:59]
v_mfma_f32_16x16x32_bf16 v[60:63], a[152:155], v[48:51], v[60:63]
v_mfma_f32_16x16x32_bf16 v[64:67], a[156:159], v[48:51], v[64:67]
s_waitcnt vmcnt(18)
ds_read_b64_tr_b16 a[160:161], v17 offset:16384
ds_read_b64_tr_b16 a[162:163], v17 offset:16640
ds_read_b64_tr_b16 a[164:165], v17 offset:16392
ds_read_b64_tr_b16 a[166:167], v17 offset:16648
ds_read_b64_tr_b16 a[168:169], v17 offset:18432
ds_read_b64_tr_b16 a[170:171], v17 offset:18688
ds_read_b64_tr_b16 a[172:173], v17 offset:18440
ds_read_b64_tr_b16 a[174:175], v17 offset:18696
s_waitcnt lgkmcnt(0)
ds_read_b64_tr_b16 a[176:177], v17 offset:20480
ds_read_b64_tr_b16 a[178:179], v17 offset:20736
ds_read_b64_tr_b16 a[180:181], v17 offset:20488
ds_read_b64_tr_b16 a[182:183], v17 offset:20744
ds_read_b64_tr_b16 a[184:185], v17 offset:22528
ds_read_b64_tr_b16 a[186:187], v17 offset:22784
ds_read_b64_tr_b16 a[188:189], v17 offset:22536
ds_read_b64_tr_b16 a[190:191], v17 offset:22792
s_waitcnt lgkmcnt(0)
ds_read_b128 v[20:23], v8 offset:40960
ds_read_b128 v[24:27], v8 offset:43008
ds_read_b128 v[28:31], v9 offset:40960
ds_read_b128 v[32:35], v9 offset:43008
ds_read_b128 v[36:39], v8 offset:45056
ds_read_b128 v[40:43], v8 offset:47104
ds_read_b128 v[44:47], v9 offset:45056
ds_read_b128 v[48:51], v9 offset:47104
s_waitcnt lgkmcnt(0)
v_mfma_f32_16x16x32_bf16 v[52:55], a[160:163], v[20:23], v[52:55]
v_mfma_f32_16x16x32_bf16 v[56:59], a[164:167], v[20:23], v[56:59]
v_mfma_f32_16x16x32_bf16 v[60:63], a[160:163], v[24:27], v[60:63]
v_mfma_f32_16x16x32_bf16 v[64:67], a[164:167], v[24:27], v[64:67]
v_mfma_f32_16x16x32_bf16 v[52:55], a[168:171], v[28:31], v[52:55]
v_mfma_f32_16x16x32_bf16 v[56:59], a[172:175], v[28:31], v[56:59]
v_mfma_f32_16x16x32_bf16 v[60:63], a[168:171], v[32:35], v[60:63]
v_mfma_f32_16x16x32_bf16 v[64:67], a[172:175], v[32:35], v[64:67]
v_mfma_f32_16x16x32_bf16 v[52:55], a[176:179], v[36:39], v[52:55]
v_mfma_f32_16x16x32_bf16 v[56:59], a[180:183], v[36:39], v[56:59]
v_mfma_f32_16x16x32_bf16 v[60:63], a[176:179], v[40:43], v[60:63]
v_mfma_f32_16x16x32_bf16 v[64:67], a[180:183], v[40:43], v[64:67]
v_mfma_f32_16x16x32_bf16 v[52:55], a[184:187], v[44:47], v[52:55]
v_mfma_f32_16x16x32_bf16 v[56:59], a[188:191], v[44:47], v[56:59]
v_mfma_f32_16x16x32_bf16 v[60:63], a[184:187], v[48:51], v[60:63]
v_mfma_f32_16x16x32_bf16 v[64:67], a[188:191], v[48:51], v[64:67]
s_waitcnt vmcnt(9)
ds_read_b64_tr_b16 a[192:193], v17 offset:0
ds_read_b64_tr_b16 a[194:195], v17 offset:256
ds_read_b64_tr_b16 a[196:197], v17 offset:8
ds_read_b64_tr_b16 a[198:199], v17 offset:264
ds_read_b64_tr_b16 a[200:201], v17 offset:2048
ds_read_b64_tr_b16 a[202:203], v17 offset:2304
ds_read_b64_tr_b16 a[204:205], v17 offset:2056
ds_read_b64_tr_b16 a[206:207], v17 offset:2312
s_waitcnt lgkmcnt(0)
ds_read_b64_tr_b16 a[208:209], v17 offset:4096
ds_read_b64_tr_b16 a[210:211], v17 offset:4352
ds_read_b64_tr_b16 a[212:213], v17 offset:4104
ds_read_b64_tr_b16 a[214:215], v17 offset:4360
ds_read_b64_tr_b16 a[216:217], v17 offset:6144
ds_read_b64_tr_b16 a[218:219], v17 offset:6400
ds_read_b64_tr_b16 a[220:221], v17 offset:6152
ds_read_b64_tr_b16 a[222:223], v17 offset:6408
s_waitcnt lgkmcnt(0)
ds_read_b128 v[20:23], v8 offset:49152
ds_read_b128 v[24:27], v8 offset:51200
ds_read_b128 v[28:31], v9 offset:49152
ds_read_b128 v[32:35], v9 offset:51200
ds_read_b128 v[36:39], v8 offset:53248
ds_read_b128 v[40:43], v8 offset:55296
ds_read_b128 v[44:47], v9 offset:53248
ds_read_b128 v[48:51], v9 offset:55296
s_waitcnt lgkmcnt(0)
v_mfma_f32_16x16x32_bf16 v[52:55], a[192:195], v[20:23], v[52:55]
v_mfma_f32_16x16x32_bf16 v[56:59], a[196:199], v[20:23], v[56:59]
v_mfma_f32_16x16x32_bf16 v[60:63], a[192:195], v[24:27], v[60:63]
v_mfma_f32_16x16x32_bf16 v[64:67], a[196:199], v[24:27], v[64:67]
v_mfma_f32_16x16x32_bf16 v[52:55], a[200:203], v[28:31], v[52:55]
v_mfma_f32_16x16x32_bf16 v[56:59], a[204:207], v[28:31], v[56:59]
v_mfma_f32_16x16x32_bf16 v[60:63], a[200:203], v[32:35], v[60:63]
v_mfma_f32_16x16x32_bf16 v[64:67], a[204:207], v[32:35], v[64:67]
v_mfma_f32_16x16x32_bf16 v[52:55], a[208:211], v[36:39], v[52:55]
v_mfma_f32_16x16x32_bf16 v[56:59], a[212:215], v[36:39], v[56:59]
v_mfma_f32_16x16x32_bf16 v[60:63], a[208:211], v[40:43], v[60:63]
v_mfma_f32_16x16x32_bf16 v[64:67], a[212:215], v[40:43], v[64:67]
v_mfma_f32_16x16x32_bf16 v[52:55], a[216:219], v[44:47], v[52:55]
v_mfma_f32_16x16x32_bf16 v[56:59], a[220:223], v[44:47], v[56:59]
v_mfma_f32_16x16x32_bf16 v[60:63], a[216:219], v[48:51], v[60:63]
v_mfma_f32_16x16x32_bf16 v[64:67], a[220:223], v[48:51], v[64:67]
s_waitcnt vmcnt(0)
ds_read_b64_tr_b16 a[224:225], v17 offset:8192
ds_read_b64_tr_b16 a[226:227], v17 offset:8448
ds_read_b64_tr_b16 a[228:229], v17 offset:8200
ds_read_b64_tr_b16 a[230:231], v17 offset:8456
ds_read_b64_tr_b16 a[232:233], v17 offset:10240
ds_read_b64_tr_b16 a[234:235], v17 offset:10496
ds_read_b64_tr_b16 a[236:237], v17 offset:10248
ds_read_b64_tr_b16 a[238:239], v17 offset:10504
s_waitcnt lgkmcnt(0)
ds_read_b64_tr_b16 a[240:241], v17 offset:12288
ds_read_b64_tr_b16 a[242:243], v17 offset:12544
ds_read_b64_tr_b16 a[244:245], v17 offset:12296
ds_read_b64_tr_b16 a[246:247], v17 offset:12552
ds_read_b64_tr_b16 a[248:249], v17 offset:14336
ds_read_b64_tr_b16 a[250:251], v17 offset:14592
ds_read_b64_tr_b16 a[252:253], v17 offset:14344
ds_read_b64_tr_b16 a[254:255], v17 offset:14600
s_waitcnt lgkmcnt(0)
ds_read_b128 v[20:23], v8 offset:57344
ds_read_b128 v[24:27], v8 offset:59392
ds_read_b128 v[28:31], v9 offset:57344
ds_read_b128 v[32:35], v9 offset:59392
ds_read_b128 v[36:39], v8 offset:61440
ds_read_b128 v[40:43], v8 offset:63488
ds_read_b128 v[44:47], v9 offset:61440
ds_read_b128 v[48:51], v9 offset:63488
s_waitcnt lgkmcnt(0)
v_mfma_f32_16x16x32_bf16 v[52:55], a[224:227], v[20:23], v[52:55]
v_mfma_f32_16x16x32_bf16 v[56:59], a[228:231], v[20:23], v[56:59]
v_mfma_f32_16x16x32_bf16 v[60:63], a[224:227], v[24:27], v[60:63]
v_mfma_f32_16x16x32_bf16 v[64:67], a[228:231], v[24:27], v[64:67]
v_mfma_f32_16x16x32_bf16 v[52:55], a[232:235], v[28:31], v[52:55]
v_mfma_f32_16x16x32_bf16 v[56:59], a[236:239], v[28:31], v[56:59]
v_mfma_f32_16x16x32_bf16 v[60:63], a[232:235], v[32:35], v[60:63]
v_mfma_f32_16x16x32_bf16 v[64:67], a[236:239], v[32:35], v[64:67]
v_mfma_f32_16x16x32_bf16 v[52:55], a[240:243], v[36:39], v[52:55]
v_mfma_f32_16x16x32_bf16 v[56:59], a[244:247], v[36:39], v[56:59]
v_mfma_f32_16x16x32_bf16 v[60:63], a[240:243], v[40:43], v[60:63]
v_mfma_f32_16x16x32_bf16 v[64:67], a[244:247], v[40:43], v[64:67]
v_mfma_f32_16x16x32_bf16 v[52:55], a[248:251], v[44:47], v[52:55]
v_mfma_f32_16x16x32_bf16 v[56:59], a[252:255], v[44:47], v[56:59]
v_mfma_f32_16x16x32_bf16 v[60:63], a[248:251], v[48:51], v[60:63]
v_mfma_f32_16x16x32_bf16 v[64:67], a[252:255], v[48:51], v[64:67]
s_barrier
s_mov_b32 s50, 0x10000
s_add_u32 m0, s46, 65536
s_nop 0
buffer_load_dwordx4 v6, s[8:11], s50 offen offset:0 lds
s_add_u32 m0, s46, 69504
s_nop 0
buffer_load_dwordx4 v6, s[8:11], s50 offen offset:128 lds
s_add_u32 m0, s46, 73472
s_nop 0
buffer_load_dwordx4 v6, s[8:11], s50 offen offset:256 lds
s_add_u32 m0, s46, 77440
s_nop 0
buffer_load_dwordx4 v6, s[8:11], s50 offen offset:384 lds
s_add_u32 m0, s46, 81408
s_nop 0
buffer_load_dwordx4 v6, s[8:11], s50 offen offset:512 lds
s_add_u32 m0, s46, 85376
s_nop 0
buffer_load_dwordx4 v6, s[8:11], s50 offen offset:640 lds
s_add_u32 m0, s46, 89344
s_nop 0
buffer_load_dwordx4 v6, s[8:11], s50 offen offset:768 lds
s_add_u32 m0, s46, 93312
s_nop 0
buffer_load_dwordx4 v6, s[8:11], s50 offen offset:896 lds
s_add_u32 m0, s46, 97280
s_nop 0
buffer_load_dwordx4 v6, s[8:11], s50 offen offset:1024 lds
s_add_u32 m0, s46, 101248
s_nop 0
buffer_load_dwordx4 v6, s[8:11], s50 offen offset:1152 lds
s_add_u32 m0, s46, 105216
s_nop 0
buffer_load_dwordx4 v6, s[8:11], s50 offen offset:1280 lds
s_add_u32 m0, s46, 109184
s_nop 0
buffer_load_dwordx4 v6, s[8:11], s50 offen offset:1408 lds
s_add_u32 m0, s46, 113152
s_nop 0
buffer_load_dwordx4 v6, s[8:11], s50 offen offset:1536 lds
s_add_u32 m0, s46, 117120
s_nop 0
buffer_load_dwordx4 v6, s[8:11], s50 offen offset:1664 lds
s_add_u32 m0, s46, 121088
s_nop 0
buffer_load_dwordx4 v6, s[8:11], s50 offen offset:1792 lds
s_add_u32 m0, s46, 125056
s_nop 0
buffer_load_dwordx4 v6, s[8:11], s50 offen offset:1920 lds
v_and_b32 v3, 15, v0
v_lshlrev_b32 v3, 4, v3
s_branch mega_kernel_syc
mega_kernel_sycw:
s_sleep 4
mega_kernel_syc:
buffer_load_dword v2, v3, s[72:75], 0 offen sc1
s_waitcnt vmcnt(0)
mega_kernel_sycp:
s_cmp_eq_u32 s95, 1
s_cbranch_scc0 mega_kernel_sycf
v_readlane_b32 s76, v2, 14
s_mov_b32 s98, 0
s_cmp_eq_u32 s76, 32
s_cbranch_scc0 mega_kernel_sycw
s_branch mega_kernel_sycd
mega_kernel_sycf:
s_mov_b32 s77, 0
s_mov_b32 s78, 0
v_readlane_b32 s76, v2, 0
s_add_u32 s77, s77, s76
s_xor_b32 s76, s76, 32
s_or_b32 s78, s78, s76
v_readlane_b32 s76, v2, 1
s_add_u32 s77, s77, s76
s_xor_b32 s76, s76, 32
s_or_b32 s78, s78, s76
v_readlane_b32 s76, v2, 2
s_add_u32 s77, s77, s76
s_xor_b32 s76, s76, 32
s_or_b32 s78, s78, s76
v_readlane_b32 s76, v2, 3
s_add_u32 s77, s77, s76
s_xor_b32 s76, s76, 32
s_or_b32 s78, s78, s76
v_readlane_b32 s76, v2, 4
s_add_u32 s77, s77, s76
s_xor_b32 s76, s76, 32
s_or_b32 s78, s78, s76
v_readlane_b32 s76, v2, 5
s_add_u32 s77, s77, s76
s_xor_b32 s76, s76, 32
s_or_b32 s78, s78, s76
v_readlane_b32 s76, v2, 6
s_add_u32 s77, s77, s76
s_xor_b32 s76, s76, 32
s_or_b32 s78, s78, s76
v_readlane_b32 s76, v2, 7
s_add_u32 s77, s77, s76
s_xor_b32 s76, s76, 32
s_or_b32 s78, s78, s76
s_cmp_eq_u32 s77, 256
s_cbranch_scc0 mega_kernel_sycw
v_mov_b32 v252, v2
s_cmp_eq_u32 s78, 0
s_cbranch_scc0 mega_kernel_slowent
v_readlane_b32 s76, v2, 10
v_readlane_b32 s77, v2, 8
s_cmp_eq_u32 s76, 32
s_cbranch_scc0 mega_kernel_sycw
s_cmp_gt_u32 s77, 16
s_cselect_b32 s98, 1, 0
mega_kernel_sycd:
v_lshrrev_b32 v92, 4, v1
v_and_b32 v93, 15, v1
s_and_b32 s52, s41, 1
s_lshr_b32 s53, s41, 1
s_mov_b32 s54, 0x3e0293ee
s_mov_b32 s55, 0
s_mov_b32 s56, 0
v_mov_b32 v97, 0xff800000
v_mov_b32 v241, 0xceabdc6e
v_and_b32 v2, 7, v93
v_lshlrev_b32 v94, 7, v92
v_lshl_add_u32 v94, v2, 4, v94
v_and_b32 v2, 31, v1
v_lshlrev_b32 v95, 3, v2
v_lshrrev_b32 v2, 1, v92
v_lshlrev_b32 v96, 10, v2
v_and_b32 v2, 1, v92
v_lshl_add_u32 v96, v2, 9, v96
v_lshl_add_u32 v96, v93, 4, v96
s_lshl_b32 s43, s40, 14
s_lshl_b32 s44, s53, 12
s_add_u32 s43, s43, s44
s_lshl_b32 s44, s52, 8
s_add_u32 s43, s43, s44
s_add_u32 s43, s43, 134217728
v_add_u32 v96, s43, v96
s_lshl_b32 s43, s52, 4
v_add_u32 v98, s43, v93
v_lshlrev_b32 v2, 2, v92
v_sub_u32 v98, v98, v2
s_mov_b32 s28, 0
s_mov_b32 s29, -1
s_xor_b32 s44, s98, 1
s_lshl_b32 s44, s44, 13
s_lshl_b32 s43, s40, 7
s_add_u32 s43, s43, s44
s_add_u32 s43, s43, 69206016
v_and_b32 v2, 3, v1
v_bfe_u32 v3, v1, 2, 1
v_lshlrev_b32 v99, 12, v3
v_lshl_add_u32 v99, v2, 2, v99
v_add_u32 v99, s43, v99
s_xor_b32 s62, s98, 1
s_lshl_b32 s62, s62, 13
s_lshr_b32 s44, s47, 6
s_lshl_b32 s44, s44, 14
s_add_u32 s62, s62, s44
s_and_b32 s44, s47, 63
s_lshl_b32 s44, s44, 7
s_add_u32 s62, s62, s44
s_add_u32 s62, s62, 69222400
s_lshl_b32 s49, s40, 7
s_lshl_b32 s44, s41, 2
s_add_u32 s49, s49, s44
s_lshl_b32 s44, s98, 13
s_add_u32 s49, s49, s44
s_add_u32 s49, s49, 69255168
s_lshl_b32 s43, s41, 11
s_add_u32 s43, s43, 131072
v_add_u32 v101, s43, v7
s_lshl_b32 s43, s52, 10
s_add_u32 s43, s43, 131072
v_add_u32 v102, s43, v5
v_mov_b32 v16, 0
s_mov_b32 s50, 0
v_mov_b32 v104, 0x3f803f80
v_mov_b32 v105, 0x3f803f80
v_mov_b32 v106, 0x3f803f80
v_mov_b32 v107, 0x3f803f80
v_cmp_gt_i32 s[12:13], 0, v98
v_cmp_gt_i32 s[14:15], 1, v98
v_cmp_gt_i32 s[16:17], 2, v98
v_cmp_gt_i32 s[18:19], 3, v98
v_cmp_gt_i32 s[20:21], 16, v98
v_cmp_gt_i32 s[22:23], 17, v98
v_cmp_gt_i32 s[24:25], 18, v98
v_cmp_gt_i32 s[26:27], 19, v98
s_lshr_b32 s44, s47, 3
s_xor_b32 s44, s44, s98
s_and_b32 s44, s44, 1
s_lshl_b32 s44, s44, 13
s_lshl_b32 s58, s47, 18
s_add_u32 s58, s58, s44
s_add_u32 s58, s58, 0
s_lshr_b32 s44, s47, 4
s_xor_b32 s44, s44, s98
s_and_b32 s44, s44, 1
s_lshl_b32 s44, s44, 13
s_lshl_b32 s59, s47, 17
s_add_u32 s59, s59, s44
s_add_u32 s59, s59, 71303168
s_lshl_b32 s60, s41, 11
s_add_u32 s60, s60, 139264
s_lshl_b32 s61, s41, 10
s_add_u32 s61, s61, 155648
v_add_u32 v94, 155648, v94
s_lshl_b32 s43, s53, 11
s_add_u32 s43, s43, 156160
v_add_u32 v95, s43, v95
v_add_u32 v103, 139264, v5
s_lshl_b32 s43, s53, 12
s_add_u32 s43, s43, 147456
v_add_u32 v240, s43, v5
s_waitcnt vmcnt(0)
v_cvt_pk_bf16_f32 v220, v52, v53
v_cvt_pk_bf16_f32 v221, v54, v55
v_cvt_pk_bf16_f32 v222, v56, v57
v_cvt_pk_bf16_f32 v223, v58, v59
v_cvt_pk_bf16_f32 v224, v60, v61
v_cvt_pk_bf16_f32 v225, v62, v63
v_cvt_pk_bf16_f32 v226, v64, v65
v_cvt_pk_bf16_f32 v227, v66, v67
s_barrier
s_mov_b32 s50, 0x20000
ds_read_b128 v[20:23], v10 offset:0
ds_read_b128 v[24:27], v10 offset:2048
ds_read_b128 v[28:31], v11 offset:0
ds_read_b128 v[32:35], v11 offset:2048
ds_read_b128 v[36:39], v10 offset:4096
ds_read_b128 v[40:43], v10 offset:6144
s_add_u32 m0, s46, 0
s_waitcnt lgkmcnt(4)
v_mfma_f32_16x16x32_bf16 v[52:55], a[0:3], v[20:23], 0
ds_read_b128 v[44:47], v11 offset:4096
v_mfma_f32_16x16x32_bf16 v[56:59], a[4:7], v[20:23], 0
buffer_load_dwordx4 v6, s[8:11], s50 offen offset:0 lds
v_mfma_f32_16x16x32_bf16 v[60:63], a[0:3], v[24:27], 0
ds_read_b128 v[48:51], v11 offset:6144
v_mfma_f32_16x16x32_bf16 v[64:67], a[4:7], v[24:27], 0
s_add_u32 m0, s46, 3968
s_waitcnt lgkmcnt(4)
v_mfma_f32_16x16x32_bf16 v[52:55], a[8:11], v[28:31], v[52:55]
ds_read_b128 v[20:23], v10 offset:8192
v_mfma_f32_16x16x32_bf16 v[56:59], a[12:15], v[28:31], v[56:59]
buffer_load_dwordx4 v6, s[8:11], s50 offen offset:128 lds
v_mfma_f32_16x16x32_bf16 v[60:63], a[8:11], v[32:35], v[60:63]
ds_read_b128 v[24:27], v10 offset:10240
v_mfma_f32_16x16x32_bf16 v[64:67], a[12:15], v[32:35], v[64:67]
s_add_u32 m0, s46, 7936
s_waitcnt lgkmcnt(4)
v_mfma_f32_16x16x32_bf16 v[52:55], a[16:19], v[36:39], v[52:55]
ds_read_b128 v[28:31], v11 offset:8192
v_mfma_f32_16x16x32_bf16 v[56:59], a[20:23], v[36:39], v[56:59]
buffer_load_dwordx4 v6, s[8:11], s50 offen offset:256 lds
v_mfma_f32_16x16x32_bf16 v[60:63], a[16:19], v[40:43], v[60:63]
ds_read_b128 v[32:35], v11 offset:10240
v_mfma_f32_16x16x32_bf16 v[64:67], a[20:23], v[40:43], v[64:67]
s_add_u32 m0, s46, 11904
s_waitcnt lgkmcnt(4)
v_mfma_f32_16x16x32_bf16 v[52:55], a[24:27], v[44:47], v[52:55]
ds_read_b128 v[36:39], v10 offset:12288
v_mfma_f32_16x16x32_bf16 v[56:59], a[28:31], v[44:47], v[56:59]
buffer_load_dwordx4 v6, s[8:11], s50 offen offset:384 lds
v_mfma_f32_16x16x32_bf16 v[60:63], a[24:27], v[48:51], v[60:63]
ds_read_b128 v[40:43], v10 offset:14336
v_mfma_f32_16x16x32_bf16 v[64:67], a[28:31], v[48:51], v[64:67]
s_add_u32 m0, s46, 15872
s_waitcnt lgkmcnt(4)
v_mfma_f32_16x16x32_bf16 v[52:55], a[32:35], v[20:23], v[52:55]
ds_read_b128 v[44:47], v11 offset:12288
v_mfma_f32_16x16x32_bf16 v[56:59], a[36:39], v[20:23], v[56:59]
buffer_load_dwordx4 v6, s[8:11], s50 offen offset:512 lds
v_mfma_f32_16x16x32_bf16 v[60:63], a[32:35], v[24:27], v[60:63]
ds_read_b128 v[48:51], v11 offset:14336
v_mfma_f32_16x16x32_bf16 v[64:67], a[36:39], v[24:27], v[64:67]
s_add_u32 m0, s46, 19840
s_waitcnt lgkmcnt(4)
v_mfma_f32_16x16x32_bf16 v[52:55], a[40:43], v[28:31], v[52:55]
ds_read_b128 v[20:23], v10 offset:16384
v_mfma_f32_16x16x32_bf16 v[56:59], a[44:47], v[28:31], v[56:59]
buffer_load_dwordx4 v6, s[8:11], s50 offen offset:640 lds
v_mfma_f32_16x16x32_bf16 v[60:63], a[40:43], v[32:35], v[60:63]
ds_read_b128 v[24:27], v10 offset:18432
v_mfma_f32_16x16x32_bf16 v[64:67], a[44:47], v[32:35], v[64:67]
s_add_u32 m0, s46, 23808
s_waitcnt lgkmcnt(4)
v_mfma_f32_16x16x32_bf16 v[52:55], a[48:51], v[36:39], v[52:55]
ds_read_b128 v[28:31], v11 offset:16384
v_mfma_f32_16x16x32_bf16 v[56:59], a[52:55], v[36:39], v[56:59]
buffer_load_dwordx4 v6, s[8:11], s50 offen offset:768 lds
v_mfma_f32_16x16x32_bf16 v[60:63], a[48:51], v[40:43], v[60:63]
ds_read_b128 v[32:35], v11 offset:18432
v_mfma_f32_16x16x32_bf16 v[64:67], a[52:55], v[40:43], v[64:67]
s_add_u32 m0, s46, 27776
s_waitcnt lgkmcnt(4)
v_mfma_f32_16x16x32_bf16 v[52:55], a[56:59], v[44:47], v[52:55]
ds_read_b128 v[36:39], v10 offset:20480
v_mfma_f32_16x16x32_bf16 v[56:59], a[60:63], v[44:47], v[56:59]
buffer_load_dwordx4 v6, s[8:11], s50 offen offset:896 lds
v_mfma_f32_16x16x32_bf16 v[60:63], a[56:59], v[48:51], v[60:63]
ds_read_b128 v[40:43], v10 offset:22528
v_mfma_f32_16x16x32_bf16 v[64:67], a[60:63], v[48:51], v[64:67]
s_add_u32 m0, s46, 31744
s_waitcnt lgkmcnt(4)
v_mfma_f32_16x16x32_bf16 v[52:55], a[64:67], v[20:23], v[52:55]
ds_read_b128 v[44:47], v11 offset:20480
v_mfma_f32_16x16x32_bf16 v[56:59], a[68:71], v[20:23], v[56:59]
buffer_load_dwordx4 v6, s[8:11], s50 offen offset:1024 lds
v_mfma_f32_16x16x32_bf16 v[60:63], a[64:67], v[24:27], v[60:63]
ds_read_b128 v[48:51], v11 offset:22528
v_mfma_f32_16x16x32_bf16 v[64:67], a[68:71], v[24:27], v[64:67]
s_add_u32 m0, s46, 35712
s_waitcnt lgkmcnt(4)
v_mfma_f32_16x16x32_bf16 v[52:55], a[72:75], v[28:31], v[52:55]
ds_read_b128 v[20:23], v10 offset:24576
v_mfma_f32_16x16x32_bf16 v[56:59], a[76:79], v[28:31], v[56:59]
buffer_load_dwordx4 v6, s[8:11], s50 offen offset:1152 lds
v_mfma_f32_16x16x32_bf16 v[60:63], a[72:75], v[32:35], v[60:63]
ds_read_b128 v[24:27], v10 offset:26624
v_mfma_f32_16x16x32_bf16 v[64:67], a[76:79], v[32:35], v[64:67]
s_add_u32 m0, s46, 39680
s_waitcnt lgkmcnt(4)
v_mfma_f32_16x16x32_bf16 v[52:55], a[80:83], v[36:39], v[52:55]
ds_read_b128 v[28:31], v11 offset:24576
v_mfma_f32_16x16x32_bf16 v[56:59], a[84:87], v[36:39], v[56:59]
buffer_load_dwordx4 v6, s[8:11], s50 offen offset:1280 lds
v_mfma_f32_16x16x32_bf16 v[60:63], a[80:83], v[40:43], v[60:63]
ds_read_b128 v[32:35], v11 offset:26624
v_mfma_f32_16x16x32_bf16 v[64:67], a[84:87], v[40:43], v[64:67]
s_add_u32 m0, s46, 43648
s_waitcnt lgkmcnt(4)
v_mfma_f32_16x16x32_bf16 v[52:55], a[88:91], v[44:47], v[52:55]
ds_read_b128 v[36:39], v10 offset:28672
v_mfma_f32_16x16x32_bf16 v[56:59], a[92:95], v[44:47], v[56:59]
buffer_load_dwordx4 v6, s[8:11], s50 offen offset:1408 lds
v_mfma_f32_16x16x32_bf16 v[60:63], a[88:91], v[48:51], v[60:63]
ds_read_b128 v[40:43], v10 offset:30720
v_mfma_f32_16x16x32_bf16 v[64:67], a[92:95], v[48:51], v[64:67]
s_add_u32 m0, s46, 47616
s_waitcnt lgkmcnt(4)
v_mfma_f32_16x16x32_bf16 v[52:55], a[96:99], v[20:23], v[52:55]
ds_read_b128 v[44:47], v11 offset:28672
v_mfma_f32_16x16x32_bf16 v[56:59], a[100:103], v[20:23], v[56:59]
buffer_load_dwordx4 v6, s[8:11], s50 offen offset:1536 lds
v_mfma_f32_16x16x32_bf16 v[60:63], a[96:99], v[24:27], v[60:63]
ds_read_b128 v[48:51], v11 offset:30720
v_mfma_f32_16x16x32_bf16 v[64:67], a[100:103], v[24:27], v[64:67]
s_add_u32 m0, s46, 51584
s_waitcnt lgkmcnt(4)
v_mfma_f32_16x16x32_bf16 v[52:55], a[104:107], v[28:31], v[52:55]
ds_read_b128 v[20:23], v10 offset:32768
v_mfma_f32_16x16x32_bf16 v[56:59], a[108:111], v[28:31], v[56:59]
buffer_load_dwordx4 v6, s[8:11], s50 offen offset:1664 lds
v_mfma_f32_16x16x32_bf16 v[60:63], a[104:107], v[32:35], v[60:63]
ds_read_b128 v[24:27], v10 offset:34816
v_mfma_f32_16x16x32_bf16 v[64:67], a[108:111], v[32:35], v[64:67]
s_add_u32 m0, s46, 55552
s_waitcnt lgkmcnt(4)
v_mfma_f32_16x16x32_bf16 v[52:55], a[112:115], v[36:39], v[52:55]
ds_read_b128 v[28:31], v11 offset:32768
v_mfma_f32_16x16x32_bf16 v[56:59], a[116:119], v[36:39], v[56:59]
buffer_load_dwordx4 v6, s[8:11], s50 offen offset:1792 lds
v_mfma_f32_16x16x32_bf16 v[60:63], a[112:115], v[40:43], v[60:63]
ds_read_b128 v[32:35], v11 offset:34816
v_mfma_f32_16x16x32_bf16 v[64:67], a[116:119], v[40:43], v[64:67]
s_add_u32 m0, s46, 59520
s_waitcnt lgkmcnt(4)
v_mfma_f32_16x16x32_bf16 v[52:55], a[120:123], v[44:47], v[52:55]
ds_read_b128 v[36:39], v10 offset:36864
v_mfma_f32_16x16x32_bf16 v[56:59], a[124:127], v[44:47], v[56:59]
buffer_load_dwordx4 v6, s[8:11], s50 offen offset:1920 lds
v_mfma_f32_16x16x32_bf16 v[60:63], a[120:123], v[48:51], v[60:63]
ds_read_b128 v[40:43], v10 offset:38912
v_mfma_f32_16x16x32_bf16 v[64:67], a[124:127], v[48:51], v[64:67]
s_waitcnt lgkmcnt(4)
v_mfma_f32_16x16x32_bf16 v[52:55], a[128:131], v[20:23], v[52:55]
ds_read_b128 v[44:47], v11 offset:36864
v_mfma_f32_16x16x32_bf16 v[56:59], a[132:135], v[20:23], v[56:59]
v_mfma_f32_16x16x32_bf16 v[60:63], a[128:131], v[24:27], v[60:63]
ds_read_b128 v[48:51], v11 offset:38912
v_mfma_f32_16x16x32_bf16 v[64:67], a[132:135], v[24:27], v[64:67]
s_waitcnt lgkmcnt(4)
v_mfma_f32_16x16x32_bf16 v[52:55], a[136:139], v[28:31], v[52:55]
ds_read_b128 v[20:23], v10 offset:40960
v_mfma_f32_16x16x32_bf16 v[56:59], a[140:143], v[28:31], v[56:59]
v_mfma_f32_16x16x32_bf16 v[60:63], a[136:139], v[32:35], v[60:63]
ds_read_b128 v[24:27], v10 offset:43008
v_mfma_f32_16x16x32_bf16 v[64:67], a[140:143], v[32:35], v[64:67]
s_waitcnt lgkmcnt(4)
v_mfma_f32_16x16x32_bf16 v[52:55], a[144:147], v[36:39], v[52:55]
ds_read_b128 v[28:31], v11 offset:40960
v_mfma_f32_16x16x32_bf16 v[56:59], a[148:151], v[36:39], v[56:59]
v_mfma_f32_16x16x32_bf16 v[60:63], a[144:147], v[40:43], v[60:63]
ds_read_b128 v[32:35], v11 offset:43008
v_mfma_f32_16x16x32_bf16 v[64:67], a[148:151], v[40:43], v[64:67]
s_waitcnt lgkmcnt(4)
v_mfma_f32_16x16x32_bf16 v[52:55], a[152:155], v[44:47], v[52:55]
ds_read_b128 v[36:39], v10 offset:45056
v_mfma_f32_16x16x32_bf16 v[56:59], a[156:159], v[44:47], v[56:59]
v_mfma_f32_16x16x32_bf16 v[60:63], a[152:155], v[48:51], v[60:63]
ds_read_b128 v[40:43], v10 offset:47104
v_mfma_f32_16x16x32_bf16 v[64:67], a[156:159], v[48:51], v[64:67]
s_waitcnt lgkmcnt(4)
v_mfma_f32_16x16x32_bf16 v[52:55], a[160:163], v[20:23], v[52:55]
ds_read_b128 v[44:47], v11 offset:45056
v_mfma_f32_16x16x32_bf16 v[56:59], a[164:167], v[20:23], v[56:59]
v_mfma_f32_16x16x32_bf16 v[60:63], a[160:163], v[24:27], v[60:63]
ds_read_b128 v[48:51], v11 offset:47104
v_mfma_f32_16x16x32_bf16 v[64:67], a[164:167], v[24:27], v[64:67]
s_waitcnt lgkmcnt(4)
v_mfma_f32_16x16x32_bf16 v[52:55], a[168:171], v[28:31], v[52:55]
ds_read_b128 v[20:23], v10 offset:49152
v_mfma_f32_16x16x32_bf16 v[56:59], a[172:175], v[28:31], v[56:59]
v_mfma_f32_16x16x32_bf16 v[60:63], a[168:171], v[32:35], v[60:63]
ds_read_b128 v[24:27], v10 offset:51200
v_mfma_f32_16x16x32_bf16 v[64:67], a[172:175], v[32:35], v[64:67]
s_waitcnt lgkmcnt(4)
v_mfma_f32_16x16x32_bf16 v[52:55], a[176:179], v[36:39], v[52:55]
ds_read_b128 v[28:31], v11 offset:49152
v_mfma_f32_16x16x32_bf16 v[56:59], a[180:183], v[36:39], v[56:59]
v_mfma_f32_16x16x32_bf16 v[60:63], a[176:179], v[40:43], v[60:63]
ds_read_b128 v[32:35], v11 offset:51200
v_mfma_f32_16x16x32_bf16 v[64:67], a[180:183], v[40:43], v[64:67]
s_waitcnt lgkmcnt(4)
v_mfma_f32_16x16x32_bf16 v[52:55], a[184:187], v[44:47], v[52:55]
ds_read_b128 v[36:39], v10 offset:53248
v_mfma_f32_16x16x32_bf16 v[56:59], a[188:191], v[44:47], v[56:59]
v_mfma_f32_16x16x32_bf16 v[60:63], a[184:187], v[48:51], v[60:63]
ds_read_b128 v[40:43], v10 offset:55296
v_mfma_f32_16x16x32_bf16 v[64:67], a[188:191], v[48:51], v[64:67]
s_waitcnt lgkmcnt(4)
v_mfma_f32_16x16x32_bf16 v[52:55], a[192:195], v[20:23], v[52:55]
ds_read_b128 v[44:47], v11 offset:53248
v_mfma_f32_16x16x32_bf16 v[56:59], a[196:199], v[20:23], v[56:59]
v_mfma_f32_16x16x32_bf16 v[60:63], a[192:195], v[24:27], v[60:63]
ds_read_b128 v[48:51], v11 offset:55296
v_mfma_f32_16x16x32_bf16 v[64:67], a[196:199], v[24:27], v[64:67]
s_waitcnt lgkmcnt(4)
v_mfma_f32_16x16x32_bf16 v[52:55], a[200:203], v[28:31], v[52:55]
ds_read_b128 v[20:23], v10 offset:57344
v_mfma_f32_16x16x32_bf16 v[56:59], a[204:207], v[28:31], v[56:59]
v_mfma_f32_16x16x32_bf16 v[60:63], a[200:203], v[32:35], v[60:63]
ds_read_b128 v[24:27], v10 offset:59392
v_mfma_f32_16x16x32_bf16 v[64:67], a[204:207], v[32:35], v[64:67]
s_waitcnt lgkmcnt(4)
v_mfma_f32_16x16x32_bf16 v[52:55], a[208:211], v[36:39], v[52:55]
ds_read_b128 v[28:31], v11 offset:57344
v_mfma_f32_16x16x32_bf16 v[56:59], a[212:215], v[36:39], v[56:59]
v_mfma_f32_16x16x32_bf16 v[60:63], a[208:211], v[40:43], v[60:63]
ds_read_b128 v[32:35], v11 offset:59392
v_mfma_f32_16x16x32_bf16 v[64:67], a[212:215], v[40:43], v[64:67]
s_waitcnt lgkmcnt(4)
v_mfma_f32_16x16x32_bf16 v[52:55], a[216:219], v[44:47], v[52:55]
ds_read_b128 v[36:39], v10 offset:61440
v_mfma_f32_16x16x32_bf16 v[56:59], a[220:223], v[44:47], v[56:59]
v_mfma_f32_16x16x32_bf16 v[60:63], a[216:219], v[48:51], v[60:63]
ds_read_b128 v[40:43], v10 offset:63488
v_mfma_f32_16x16x32_bf16 v[64:67], a[220:223], v[48:51], v[64:67]
s_waitcnt lgkmcnt(4)
v_mfma_f32_16x16x32_bf16 v[52:55], a[224:227], v[20:23], v[52:55]
ds_read_b128 v[44:47], v11 offset:61440
v_mfma_f32_16x16x32_bf16 v[56:59], a[228:231], v[20:23], v[56:59]
v_mfma_f32_16x16x32_bf16 v[60:63], a[224:227], v[24:27], v[60:63]
ds_read_b128 v[48:51], v11 offset:63488
v_mfma_f32_16x16x32_bf16 v[64:67], a[228:231], v[24:27], v[64:67]
s_waitcnt lgkmcnt(5)
v_mfma_f32_16x16x32_bf16 v[52:55], a[232:235], v[28:31], v[52:55]
v_mfma_f32_16x16x32_bf16 v[56:59], a[236:239], v[28:31], v[56:59]
s_waitcnt lgkmcnt(4)
v_mfma_f32_16x16x32_bf16 v[60:63], a[232:235], v[32:35], v[60:63]
v_mfma_f32_16x16x32_bf16 v[64:67], a[236:239], v[32:35], v[64:67]
s_waitcnt lgkmcnt(3)
v_mfma_f32_16x16x32_bf16 v[52:55], a[240:243], v[36:39], v[52:55]
v_mfma_f32_16x16x32_bf16 v[56:59], a[244:247], v[36:39], v[56:59]
s_waitcnt lgkmcnt(2)
v_mfma_f32_16x16x32_bf16 v[60:63], a[240:243], v[40:43], v[60:63]
v_mfma_f32_16x16x32_bf16 v[64:67], a[244:247], v[40:43], v[64:67]
s_waitcnt lgkmcnt(1)
v_mfma_f32_16x16x32_bf16 v[52:55], a[248:251], v[44:47], v[52:55]
v_mfma_f32_16x16x32_bf16 v[56:59], a[252:255], v[44:47], v[56:59]
s_waitcnt lgkmcnt(0)
v_mfma_f32_16x16x32_bf16 v[60:63], a[248:251], v[48:51], v[60:63]
v_mfma_f32_16x16x32_bf16 v[64:67], a[252:255], v[48:51], v[64:67]
s_waitcnt vmcnt(0)
s_barrier
s_mov_b32 s50, 0x30000
s_nop 5
v_cvt_pk_bf16_f32 v228, v52, v53
v_cvt_pk_bf16_f32 v229, v54, v55
v_cvt_pk_bf16_f32 v230, v56, v57
v_cvt_pk_bf16_f32 v231, v58, v59
v_cvt_pk_bf16_f32 v232, v60, v61
v_cvt_pk_bf16_f32 v233, v62, v63
v_cvt_pk_bf16_f32 v234, v64, v65
v_cvt_pk_bf16_f32 v235, v66, v67
ds_read_b128 v[20:23], v8 offset:0
ds_read_b128 v[24:27], v8 offset:2048
ds_read_b128 v[28:31], v9 offset:0
ds_read_b128 v[32:35], v9 offset:2048
ds_read_b128 v[36:39], v8 offset:4096
ds_read_b128 v[40:43], v8 offset:6144
s_add_u32 m0, s46, 65536
s_waitcnt lgkmcnt(4)
v_mfma_f32_16x16x32_bf16 v[52:55], a[0:3], v[20:23], 0
ds_read_b128 v[44:47], v9 offset:4096
v_mfma_f32_16x16x32_bf16 v[56:59], a[4:7], v[20:23], 0
buffer_load_dwordx4 v6, s[8:11], s50 offen offset:0 lds
v_mfma_f32_16x16x32_bf16 v[60:63], a[0:3], v[24:27], 0
ds_read_b128 v[48:51], v9 offset:6144
v_mfma_f32_16x16x32_bf16 v[64:67], a[4:7], v[24:27], 0
s_add_u32 m0, s46, 69504
s_waitcnt lgkmcnt(4)
v_mfma_f32_16x16x32_bf16 v[52:55], a[8:11], v[28:31], v[52:55]
ds_read_b128 v[20:23], v8 offset:8192
v_mfma_f32_16x16x32_bf16 v[56:59], a[12:15], v[28:31], v[56:59]
buffer_load_dwordx4 v6, s[8:11], s50 offen offset:128 lds
v_mfma_f32_16x16x32_bf16 v[60:63], a[8:11], v[32:35], v[60:63]
ds_read_b128 v[24:27], v8 offset:10240
v_mfma_f32_16x16x32_bf16 v[64:67], a[12:15], v[32:35], v[64:67]
s_add_u32 m0, s46, 73472
s_waitcnt lgkmcnt(4)
v_mfma_f32_16x16x32_bf16 v[52:55], a[16:19], v[36:39], v[52:55]
ds_read_b128 v[28:31], v9 offset:8192
v_mfma_f32_16x16x32_bf16 v[56:59], a[20:23], v[36:39], v[56:59]
buffer_load_dwordx4 v6, s[8:11], s50 offen offset:256 lds
v_mfma_f32_16x16x32_bf16 v[60:63], a[16:19], v[40:43], v[60:63]
ds_read_b128 v[32:35], v9 offset:10240
v_mfma_f32_16x16x32_bf16 v[64:67], a[20:23], v[40:43], v[64:67]
s_add_u32 m0, s46, 77440
s_waitcnt lgkmcnt(4)
v_mfma_f32_16x16x32_bf16 v[52:55], a[24:27], v[44:47], v[52:55]
ds_read_b128 v[36:39], v8 offset:12288
v_mfma_f32_16x16x32_bf16 v[56:59], a[28:31], v[44:47], v[56:59]
buffer_load_dwordx4 v6, s[8:11], s50 offen offset:384 lds
v_mfma_f32_16x16x32_bf16 v[60:63], a[24:27], v[48:51], v[60:63]
ds_read_b128 v[40:43], v8 offset:14336
v_mfma_f32_16x16x32_bf16 v[64:67], a[28:31], v[48:51], v[64:67]
s_add_u32 m0, s46, 81408
s_waitcnt lgkmcnt(4)
v_mfma_f32_16x16x32_bf16 v[52:55], a[32:35], v[20:23], v[52:55]
ds_read_b128 v[44:47], v9 offset:12288
v_mfma_f32_16x16x32_bf16 v[56:59], a[36:39], v[20:23], v[56:59]
buffer_load_dwordx4 v6, s[8:11], s50 offen offset:512 lds
v_mfma_f32_16x16x32_bf16 v[60:63], a[32:35], v[24:27], v[60:63]
ds_read_b128 v[48:51], v9 offset:14336
v_mfma_f32_16x16x32_bf16 v[64:67], a[36:39], v[24:27], v[64:67]
s_add_u32 m0, s46, 85376
s_waitcnt lgkmcnt(4)
v_mfma_f32_16x16x32_bf16 v[52:55], a[40:43], v[28:31], v[52:55]
ds_read_b128 v[20:23], v8 offset:16384
v_mfma_f32_16x16x32_bf16 v[56:59], a[44:47], v[28:31], v[56:59]
buffer_load_dwordx4 v6, s[8:11], s50 offen offset:640 lds
v_mfma_f32_16x16x32_bf16 v[60:63], a[40:43], v[32:35], v[60:63]
ds_read_b128 v[24:27], v8 offset:18432
v_mfma_f32_16x16x32_bf16 v[64:67], a[44:47], v[32:35], v[64:67]
s_add_u32 m0, s46, 89344
s_waitcnt lgkmcnt(4)
v_mfma_f32_16x16x32_bf16 v[52:55], a[48:51], v[36:39], v[52:55]
ds_read_b128 v[28:31], v9 offset:16384
v_mfma_f32_16x16x32_bf16 v[56:59], a[52:55], v[36:39], v[56:59]
buffer_load_dwordx4 v6, s[8:11], s50 offen offset:768 lds
v_mfma_f32_16x16x32_bf16 v[60:63], a[48:51], v[40:43], v[60:63]
ds_read_b128 v[32:35], v9 offset:18432
v_mfma_f32_16x16x32_bf16 v[64:67], a[52:55], v[40:43], v[64:67]
s_add_u32 m0, s46, 93312
s_waitcnt lgkmcnt(4)
v_mfma_f32_16x16x32_bf16 v[52:55], a[56:59], v[44:47], v[52:55]
ds_read_b128 v[36:39], v8 offset:20480
v_mfma_f32_16x16x32_bf16 v[56:59], a[60:63], v[44:47], v[56:59]
buffer_load_dwordx4 v6, s[8:11], s50 offen offset:896 lds
v_mfma_f32_16x16x32_bf16 v[60:63], a[56:59], v[48:51], v[60:63]
ds_read_b128 v[40:43], v8 offset:22528
v_mfma_f32_16x16x32_bf16 v[64:67], a[60:63], v[48:51], v[64:67]
s_add_u32 m0, s46, 97280
s_waitcnt lgkmcnt(4)
v_mfma_f32_16x16x32_bf16 v[52:55], a[64:67], v[20:23], v[52:55]
ds_read_b128 v[44:47], v9 offset:20480
v_mfma_f32_16x16x32_bf16 v[56:59], a[68:71], v[20:23], v[56:59]
buffer_load_dwordx4 v6, s[8:11], s50 offen offset:1024 lds
v_mfma_f32_16x16x32_bf16 v[60:63], a[64:67], v[24:27], v[60:63]
ds_read_b128 v[48:51], v9 offset:22528
v_mfma_f32_16x16x32_bf16 v[64:67], a[68:71], v[24:27], v[64:67]
s_add_u32 m0, s46, 101248
s_waitcnt lgkmcnt(4)
v_mfma_f32_16x16x32_bf16 v[52:55], a[72:75], v[28:31], v[52:55]
ds_read_b128 v[20:23], v8 offset:24576
v_mfma_f32_16x16x32_bf16 v[56:59], a[76:79], v[28:31], v[56:59]
buffer_load_dwordx4 v6, s[8:11], s50 offen offset:1152 lds
v_mfma_f32_16x16x32_bf16 v[60:63], a[72:75], v[32:35], v[60:63]
ds_read_b128 v[24:27], v8 offset:26624
v_mfma_f32_16x16x32_bf16 v[64:67], a[76:79], v[32:35], v[64:67]
s_add_u32 m0, s46, 105216
s_waitcnt lgkmcnt(4)
v_mfma_f32_16x16x32_bf16 v[52:55], a[80:83], v[36:39], v[52:55]
ds_read_b128 v[28:31], v9 offset:24576
v_mfma_f32_16x16x32_bf16 v[56:59], a[84:87], v[36:39], v[56:59]
buffer_load_dwordx4 v6, s[8:11], s50 offen offset:1280 lds
v_mfma_f32_16x16x32_bf16 v[60:63], a[80:83], v[40:43], v[60:63]
ds_read_b128 v[32:35], v9 offset:26624
v_mfma_f32_16x16x32_bf16 v[64:67], a[84:87], v[40:43], v[64:67]
s_add_u32 m0, s46, 109184
s_waitcnt lgkmcnt(4)
v_mfma_f32_16x16x32_bf16 v[52:55], a[88:91], v[44:47], v[52:55]
ds_read_b128 v[36:39], v8 offset:28672
v_mfma_f32_16x16x32_bf16 v[56:59], a[92:95], v[44:47], v[56:59]
buffer_load_dwordx4 v6, s[8:11], s50 offen offset:1408 lds
v_mfma_f32_16x16x32_bf16 v[60:63], a[88:91], v[48:51], v[60:63]
ds_read_b128 v[40:43], v8 offset:30720
v_mfma_f32_16x16x32_bf16 v[64:67], a[92:95], v[48:51], v[64:67]
s_add_u32 m0, s46, 113152
s_waitcnt lgkmcnt(4)
v_mfma_f32_16x16x32_bf16 v[52:55], a[96:99], v[20:23], v[52:55]
ds_read_b128 v[44:47], v9 offset:28672
v_mfma_f32_16x16x32_bf16 v[56:59], a[100:103], v[20:23], v[56:59]
buffer_load_dwordx4 v6, s[8:11], s50 offen offset:1536 lds
v_mfma_f32_16x16x32_bf16 v[60:63], a[96:99], v[24:27], v[60:63]
ds_read_b128 v[48:51], v9 offset:30720
v_mfma_f32_16x16x32_bf16 v[64:67], a[100:103], v[24:27], v[64:67]
s_add_u32 m0, s46, 117120
s_waitcnt lgkmcnt(4)
v_mfma_f32_16x16x32_bf16 v[52:55], a[104:107], v[28:31], v[52:55]
ds_read_b128 v[20:23], v8 offset:32768
v_mfma_f32_16x16x32_bf16 v[56:59], a[108:111], v[28:31], v[56:59]
buffer_load_dwordx4 v6, s[8:11], s50 offen offset:1664 lds
v_mfma_f32_16x16x32_bf16 v[60:63], a[104:107], v[32:35], v[60:63]
ds_read_b128 v[24:27], v8 offset:34816
v_mfma_f32_16x16x32_bf16 v[64:67], a[108:111], v[32:35], v[64:67]
s_add_u32 m0, s46, 121088
s_waitcnt lgkmcnt(4)
v_mfma_f32_16x16x32_bf16 v[52:55], a[112:115], v[36:39], v[52:55]
ds_read_b128 v[28:31], v9 offset:32768
v_mfma_f32_16x16x32_bf16 v[56:59], a[116:119], v[36:39], v[56:59]
buffer_load_dwordx4 v6, s[8:11], s50 offen offset:1792 lds
v_mfma_f32_16x16x32_bf16 v[60:63], a[112:115], v[40:43], v[60:63]
ds_read_b128 v[32:35], v9 offset:34816
v_mfma_f32_16x16x32_bf16 v[64:67], a[116:119], v[40:43], v[64:67]
s_add_u32 m0, s46, 125056
s_waitcnt lgkmcnt(4)
v_mfma_f32_16x16x32_bf16 v[52:55], a[120:123], v[44:47], v[52:55]
ds_read_b128 v[36:39], v8 offset:36864
v_mfma_f32_16x16x32_bf16 v[56:59], a[124:127], v[44:47], v[56:59]
buffer_load_dwordx4 v6, s[8:11], s50 offen offset:1920 lds
v_mfma_f32_16x16x32_bf16 v[60:63], a[120:123], v[48:51], v[60:63]
ds_read_b128 v[40:43], v8 offset:38912
v_mfma_f32_16x16x32_bf16 v[64:67], a[124:127], v[48:51], v[64:67]
s_waitcnt lgkmcnt(4)
v_mfma_f32_16x16x32_bf16 v[52:55], a[128:131], v[20:23], v[52:55]
ds_read_b128 v[44:47], v9 offset:36864
v_mfma_f32_16x16x32_bf16 v[56:59], a[132:135], v[20:23], v[56:59]
v_mfma_f32_16x16x32_bf16 v[60:63], a[128:131], v[24:27], v[60:63]
ds_read_b128 v[48:51], v9 offset:38912
v_mfma_f32_16x16x32_bf16 v[64:67], a[132:135], v[24:27], v[64:67]
s_waitcnt lgkmcnt(4)
v_mfma_f32_16x16x32_bf16 v[52:55], a[136:139], v[28:31], v[52:55]
ds_read_b128 v[20:23], v8 offset:40960
v_mfma_f32_16x16x32_bf16 v[56:59], a[140:143], v[28:31], v[56:59]
v_mfma_f32_16x16x32_bf16 v[60:63], a[136:139], v[32:35], v[60:63]
ds_read_b128 v[24:27], v8 offset:43008
v_mfma_f32_16x16x32_bf16 v[64:67], a[140:143], v[32:35], v[64:67]
s_waitcnt lgkmcnt(4)
v_mfma_f32_16x16x32_bf16 v[52:55], a[144:147], v[36:39], v[52:55]
ds_read_b128 v[28:31], v9 offset:40960
v_mfma_f32_16x16x32_bf16 v[56:59], a[148:151], v[36:39], v[56:59]
v_mfma_f32_16x16x32_bf16 v[60:63], a[144:147], v[40:43], v[60:63]
ds_read_b128 v[32:35], v9 offset:43008
v_mfma_f32_16x16x32_bf16 v[64:67], a[148:151], v[40:43], v[64:67]
s_waitcnt lgkmcnt(4)
v_mfma_f32_16x16x32_bf16 v[52:55], a[152:155], v[44:47], v[52:55]
ds_read_b128 v[36:39], v8 offset:45056
v_mfma_f32_16x16x32_bf16 v[56:59], a[156:159], v[44:47], v[56:59]
v_mfma_f32_16x16x32_bf16 v[60:63], a[152:155], v[48:51], v[60:63]
ds_read_b128 v[40:43], v8 offset:47104
v_mfma_f32_16x16x32_bf16 v[64:67], a[156:159], v[48:51], v[64:67]
s_waitcnt lgkmcnt(4)
v_mfma_f32_16x16x32_bf16 v[52:55], a[160:163], v[20:23], v[52:55]
ds_read_b128 v[44:47], v9 offset:45056
v_mfma_f32_16x16x32_bf16 v[56:59], a[164:167], v[20:23], v[56:59]
v_mfma_f32_16x16x32_bf16 v[60:63], a[160:163], v[24:27], v[60:63]
ds_read_b128 v[48:51], v9 offset:47104
v_mfma_f32_16x16x32_bf16 v[64:67], a[164:167], v[24:27], v[64:67]
s_waitcnt lgkmcnt(4)
v_mfma_f32_16x16x32_bf16 v[52:55], a[168:171], v[28:31], v[52:55]
ds_read_b128 v[20:23], v8 offset:49152
v_mfma_f32_16x16x32_bf16 v[56:59], a[172:175], v[28:31], v[56:59]
v_mfma_f32_16x16x32_bf16 v[60:63], a[168:171], v[32:35], v[60:63]
ds_read_b128 v[24:27], v8 offset:51200
v_mfma_f32_16x16x32_bf16 v[64:67], a[172:175], v[32:35], v[64:67]
s_waitcnt lgkmcnt(4)
v_mfma_f32_16x16x32_bf16 v[52:55], a[176:179], v[36:39], v[52:55]
ds_read_b128 v[28:31], v9 offset:49152
v_mfma_f32_16x16x32_bf16 v[56:59], a[180:183], v[36:39], v[56:59]
v_mfma_f32_16x16x32_bf16 v[60:63], a[176:179], v[40:43], v[60:63]
ds_read_b128 v[32:35], v9 offset:51200
v_mfma_f32_16x16x32_bf16 v[64:67], a[180:183], v[40:43], v[64:67]
s_waitcnt lgkmcnt(4)
v_mfma_f32_16x16x32_bf16 v[52:55], a[184:187], v[44:47], v[52:55]
ds_read_b128 v[36:39], v8 offset:53248
v_mfma_f32_16x16x32_bf16 v[56:59], a[188:191], v[44:47], v[56:59]
v_mfma_f32_16x16x32_bf16 v[60:63], a[184:187], v[48:51], v[60:63]
ds_read_b128 v[40:43], v8 offset:55296
v_mfma_f32_16x16x32_bf16 v[64:67], a[188:191], v[48:51], v[64:67]
s_waitcnt lgkmcnt(4)
v_mfma_f32_16x16x32_bf16 v[52:55], a[192:195], v[20:23], v[52:55]
ds_read_b128 v[44:47], v9 offset:53248
v_mfma_f32_16x16x32_bf16 v[56:59], a[196:199], v[20:23], v[56:59]
v_mfma_f32_16x16x32_bf16 v[60:63], a[192:195], v[24:27], v[60:63]
ds_read_b128 v[48:51], v9 offset:55296
v_mfma_f32_16x16x32_bf16 v[64:67], a[196:199], v[24:27], v[64:67]
s_waitcnt lgkmcnt(4)
v_mfma_f32_16x16x32_bf16 v[52:55], a[200:203], v[28:31], v[52:55]
ds_read_b128 v[20:23], v8 offset:57344
v_mfma_f32_16x16x32_bf16 v[56:59], a[204:207], v[28:31], v[56:59]
v_mfma_f32_16x16x32_bf16 v[60:63], a[200:203], v[32:35], v[60:63]
ds_read_b128 v[24:27], v8 offset:59392
v_mfma_f32_16x16x32_bf16 v[64:67], a[204:207], v[32:35], v[64:67]
s_waitcnt lgkmcnt(4)
v_mfma_f32_16x16x32_bf16 v[52:55], a[208:211], v[36:39], v[52:55]
ds_read_b128 v[28:31], v9 offset:57344
v_mfma_f32_16x16x32_bf16 v[56:59], a[212:215], v[36:39], v[56:59]
v_mfma_f32_16x16x32_bf16 v[60:63], a[208:211], v[40:43], v[60:63]
ds_read_b128 v[32:35], v9 offset:59392
v_mfma_f32_16x16x32_bf16 v[64:67], a[212:215], v[40:43], v[64:67]
s_waitcnt lgkmcnt(4)
v_mfma_f32_16x16x32_bf16 v[52:55], a[216:219], v[44:47], v[52:55]
ds_read_b128 v[36:39], v8 offset:61440
v_mfma_f32_16x16x32_bf16 v[56:59], a[220:223], v[44:47], v[56:59]
v_mfma_f32_16x16x32_bf16 v[60:63], a[216:219], v[48:51], v[60:63]
ds_read_b128 v[40:43], v8 offset:63488
v_mfma_f32_16x16x32_bf16 v[64:67], a[220:223], v[48:51], v[64:67]
s_waitcnt lgkmcnt(4)
v_mfma_f32_16x16x32_bf16 v[52:55], a[224:227], v[20:23], v[52:55]
ds_read_b128 v[44:47], v9 offset:61440
v_mfma_f32_16x16x32_bf16 v[56:59], a[228:231], v[20:23], v[56:59]
v_mfma_f32_16x16x32_bf16 v[60:63], a[224:227], v[24:27], v[60:63]
ds_read_b128 v[48:51], v9 offset:63488
v_mfma_f32_16x16x32_bf16 v[64:67], a[228:231], v[24:27], v[64:67]
s_waitcnt lgkmcnt(5)
v_mfma_f32_16x16x32_bf16 v[52:55], a[232:235], v[28:31], v[52:55]
v_mfma_f32_16x16x32_bf16 v[56:59], a[236:239], v[28:31], v[56:59]
s_waitcnt lgkmcnt(4)
v_mfma_f32_16x16x32_bf16 v[60:63], a[232:235], v[32:35], v[60:63]
v_mfma_f32_16x16x32_bf16 v[64:67], a[236:239], v[32:35], v[64:67]
s_waitcnt lgkmcnt(3)
v_mfma_f32_16x16x32_bf16 v[52:55], a[240:243], v[36:39], v[52:55]
v_mfma_f32_16x16x32_bf16 v[56:59], a[244:247], v[36:39], v[56:59]
s_waitcnt lgkmcnt(2)
v_mfma_f32_16x16x32_bf16 v[60:63], a[240:243], v[40:43], v[60:63]
v_mfma_f32_16x16x32_bf16 v[64:67], a[244:247], v[40:43], v[64:67]
s_waitcnt lgkmcnt(1)
v_mfma_f32_16x16x32_bf16 v[68:71], a[248:251], v[44:47], v[52:55]
v_mfma_f32_16x16x32_bf16 v[72:75], a[252:255], v[44:47], v[56:59]
s_waitcnt lgkmcnt(0)
v_mfma_f32_16x16x32_bf16 v[76:79], a[248:251], v[48:51], v[60:63]
v_mfma_f32_16x16x32_bf16 v[80:83], a[252:255], v[48:51], v[64:67]
s_waitcnt vmcnt(0)
mega_kernel_q_loop:
s_barrier
s_cmp_gt_i32 s55, s42
s_cbranch_scc1 mega_kernel_q_kv1k
mega_kernel_q_kv1w:
v_mov_b32 v2, 0
s_mov_b64 exec, 0xff
buffer_atomic_add v2, v99, s[84:87], 0 offen sc0 sc1
s_mov_b64 exec, -1
s_waitcnt vmcnt(0)
v_min_i32_dpp v2, v2, v2 quad_perm:[1,0,3,2] row_mask:0xf bank_mask:0xf
s_nop 1
v_min_i32_dpp v2, v2, v2 quad_perm:[2,3,0,1] row_mask:0xf bank_mask:0xf
s_nop 1
v_min_i32_dpp v2, v2, v2 row_half_mirror row_mask:0xf bank_mask:0xf
s_nop 0
v_readfirstlane_b32 s55, v2
s_cmp_gt_i32 s55, s42
s_cbranch_scc1 mega_kernel_q_kv1k
s_sleep 4
s_branch mega_kernel_q_kv1w
mega_kernel_q_kv1k:
s_cmp_ge_u32 s42, 61
s_cbranch_scc0 mega_kernel_q_nl1
s_add_u32 s51, s47, s42
s_bfe_u32 s57, s51, 0x40002
s_lshl_b32 s57, s57, 14
s_and_b32 s66, s51, 3
s_lshl_b32 s66, s66, 11
s_add_u32 s66, s66, s57
s_add_u32 s66, s66, s58
s_add_u32 s67, s66, 33554432
s_bfe_u32 s57, s51, 0x30003
s_lshl_b32 s57, s57, 14
s_and_b32 s68, s51, 7
s_lshl_b32 s68, s68, 10
s_add_u32 s68, s68, s57
s_add_u32 s68, s68, s59
s_add_u32 s50, s42, 4
s_min_u32 s50, s50, 63
s_lshl_b32 s50, s50, 16
s_cmp_gt_i32 s56, s42
s_cselect_b32 s30, 1, 0
s_add_u32 m0, s60, 0
s_nop 0
buffer_load_dwordx4 v5, s[84:87], s66 offen offset:0 sc1 lds
s_add_u32 m0, s60, 0
s_nop 0
buffer_load_dwordx4 v5, s[84:87], s66 offen offset:1024 sc1 lds
s_add_u32 m0, s60, 8192
s_nop 0
buffer_load_dwordx4 v5, s[84:87], s67 offen offset:0 sc1 lds
s_add_u32 m0, s60, 8192
s_nop 0
buffer_load_dwordx4 v5, s[84:87], s67 offen offset:1024 sc1 lds
s_cmp_eq_u32 s30, 1
s_cbranch_scc0 mega_kernel_q_kx1
s_mov_b32 m0, s61
s_nop 0
buffer_load_dwordx4 v5, s[84:87], s68 offen sc1 lds
mega_kernel_q_kx1:
v_mov_b64 v[84:85], v[220:221]
v_mov_b64 v[86:87], v[222:223]
v_mov_b64 v[88:89], v[224:225]
v_mov_b64 v[90:91], v[226:227]
v_mov_b64 v[220:221], v[228:229]
v_mov_b64 v[222:223], v[230:231]
v_mov_b64 v[224:225], v[232:233]
v_mov_b64 v[226:227], v[234:235]
v_cvt_pk_bf16_f32 v228, v68, v69
v_cvt_pk_bf16_f32 v229, v70, v71
v_cvt_pk_bf16_f32 v230, v72, v73
v_cvt_pk_bf16_f32 v231, v74, v75
v_cvt_pk_bf16_f32 v232, v76, v77
v_cvt_pk_bf16_f32 v233, v78, v79
v_cvt_pk_bf16_f32 v234, v80, v81
v_cvt_pk_bf16_f32 v235, v82, v83
ds_write_b128 v101, v[84:87]
ds_write_b128 v101, v[88:91] offset:1024
s_waitcnt vmcnt(4)
v_mov_b32 v17, s42
s_mov_b64 exec, 1
buffer_store_dword v17, v16, s[84:87], s49 offen sc1
s_mov_b64 exec, -1
s_branch mega_kernel_q_jl1
mega_kernel_q_nl1:
ds_read_b128 v[20:23], v10 offset:0
ds_read_b128 v[24:27], v10 offset:2048
ds_read_b128 v[28:31], v11 offset:0
ds_read_b128 v[32:35], v11 offset:2048
ds_read_b128 v[36:39], v10 offset:4096
ds_read_b128 v[40:43], v10 offset:6144
s_add_u32 s51, s47, s42
s_bfe_u32 s57, s51, 0x40002
s_lshl_b32 s57, s57, 14
s_and_b32 s66, s51, 3
s_lshl_b32 s66, s66, 11
s_add_u32 s66, s66, s57
s_add_u32 s66, s66, s58
s_add_u32 s67, s66, 33554432
s_bfe_u32 s57, s51, 0x30003
s_lshl_b32 s57, s57, 14
s_and_b32 s68, s51, 7
s_lshl_b32 s68, s68, 10
s_add_u32 s68, s68, s57
s_add_u32 s68, s68, s59
s_add_u32 s50, s42, 4
s_min_u32 s50, s50, 63
s_lshl_b32 s50, s50, 16
s_cmp_gt_i32 s56, s42
s_cselect_b32 s30, 1, 0
s_add_u32 m0, s60, 0
s_waitcnt lgkmcnt(4)
v_mfma_f32_16x16x32_bf16 v[52:55], a[0:3], v[20:23], 0
ds_read_b128 v[44:47], v11 offset:4096
v_mfma_f32_16x16x32_bf16 v[56:59], a[4:7], v[20:23], 0
buffer_load_dwordx4 v5, s[84:87], s66 offen offset:0 sc1 lds
v_mfma_f32_16x16x32_bf16 v[60:63], a[0:3], v[24:27], 0
ds_read_b128 v[48:51], v11 offset:6144
v_mfma_f32_16x16x32_bf16 v[64:67], a[4:7], v[24:27], 0
s_add_u32 m0, s60, 0
s_waitcnt lgkmcnt(4)
v_mfma_f32_16x16x32_bf16 v[52:55], a[8:11], v[28:31], v[52:55]
ds_read_b128 v[20:23], v10 offset:8192
v_mfma_f32_16x16x32_bf16 v[56:59], a[12:15], v[28:31], v[56:59]
buffer_load_dwordx4 v5, s[84:87], s66 offen offset:1024 sc1 lds
v_mfma_f32_16x16x32_bf16 v[60:63], a[8:11], v[32:35], v[60:63]
ds_read_b128 v[24:27], v10 offset:10240
v_mfma_f32_16x16x32_bf16 v[64:67], a[12:15], v[32:35], v[64:67]
s_add_u32 m0, s60, 8192
s_waitcnt lgkmcnt(4)
v_mfma_f32_16x16x32_bf16 v[52:55], a[16:19], v[36:39], v[52:55]
ds_read_b128 v[28:31], v11 offset:8192
v_mfma_f32_16x16x32_bf16 v[56:59], a[20:23], v[36:39], v[56:59]
buffer_load_dwordx4 v5, s[84:87], s67 offen offset:0 sc1 lds
v_mfma_f32_16x16x32_bf16 v[60:63], a[16:19], v[40:43], v[60:63]
ds_read_b128 v[32:35], v11 offset:10240
v_mfma_f32_16x16x32_bf16 v[64:67], a[20:23], v[40:43], v[64:67]
s_add_u32 m0, s60, 8192
s_waitcnt lgkmcnt(4)
v_mfma_f32_16x16x32_bf16 v[52:55], a[24:27], v[44:47], v[52:55]
ds_read_b128 v[36:39], v10 offset:12288
v_mfma_f32_16x16x32_bf16 v[56:59], a[28:31], v[44:47], v[56:59]
buffer_load_dwordx4 v5, s[84:87], s67 offen offset:1024 sc1 lds
v_mfma_f32_16x16x32_bf16 v[60:63], a[24:27], v[48:51], v[60:63]
ds_read_b128 v[40:43], v10 offset:14336
v_mfma_f32_16x16x32_bf16 v[64:67], a[28:31], v[48:51], v[64:67]
s_waitcnt lgkmcnt(4)
v_mfma_f32_16x16x32_bf16 v[52:55], a[32:35], v[20:23], v[52:55]
ds_read_b128 v[44:47], v11 offset:12288
v_mfma_f32_16x16x32_bf16 v[56:59], a[36:39], v[20:23], v[56:59]
s_cmp_eq_u32 s30, 1
s_cbranch_scc0 mega_kernel_q_ke1
s_mov_b32 m0, s61
s_nop 0
buffer_load_dwordx4 v5, s[84:87], s68 offen sc1 lds
mega_kernel_q_ke1:
v_mfma_f32_16x16x32_bf16 v[60:63], a[32:35], v[24:27], v[60:63]
ds_read_b128 v[48:51], v11 offset:14336
v_mfma_f32_16x16x32_bf16 v[64:67], a[36:39], v[24:27], v[64:67]
s_add_u32 m0, s46, 0
s_waitcnt lgkmcnt(4)
v_mfma_f32_16x16x32_bf16 v[52:55], a[40:43], v[28:31], v[52:55]
ds_read_b128 v[20:23], v10 offset:16384
v_mfma_f32_16x16x32_bf16 v[56:59], a[44:47], v[28:31], v[56:59]
buffer_load_dwordx4 v6, s[8:11], s50 offen offset:0 lds
v_mfma_f32_16x16x32_bf16 v[60:63], a[40:43], v[32:35], v[60:63]
ds_read_b128 v[24:27], v10 offset:18432
v_mfma_f32_16x16x32_bf16 v[64:67], a[44:47], v[32:35], v[64:67]
s_add_u32 m0, s46, 3968
s_waitcnt lgkmcnt(4)
v_mfma_f32_16x16x32_bf16 v[52:55], a[48:51], v[36:39], v[52:55]
ds_read_b128 v[28:31], v11 offset:16384
v_mfma_f32_16x16x32_bf16 v[56:59], a[52:55], v[36:39], v[56:59]
buffer_load_dwordx4 v6, s[8:11], s50 offen offset:128 lds
v_mfma_f32_16x16x32_bf16 v[60:63], a[48:51], v[40:43], v[60:63]
ds_read_b128 v[32:35], v11 offset:18432
v_mfma_f32_16x16x32_bf16 v[64:67], a[52:55], v[40:43], v[64:67]
s_add_u32 m0, s46, 7936
s_waitcnt lgkmcnt(4)
v_mfma_f32_16x16x32_bf16 v[52:55], a[56:59], v[44:47], v[52:55]
ds_read_b128 v[36:39], v10 offset:20480
v_mfma_f32_16x16x32_bf16 v[56:59], a[60:63], v[44:47], v[56:59]
buffer_load_dwordx4 v6, s[8:11], s50 offen offset:256 lds
v_mfma_f32_16x16x32_bf16 v[60:63], a[56:59], v[48:51], v[60:63]
ds_read_b128 v[40:43], v10 offset:22528
v_mfma_f32_16x16x32_bf16 v[64:67], a[60:63], v[48:51], v[64:67]
s_add_u32 m0, s46, 11904
s_waitcnt lgkmcnt(4)
v_mfma_f32_16x16x32_bf16 v[52:55], a[64:67], v[20:23], v[52:55]
ds_read_b128 v[44:47], v11 offset:20480
v_mfma_f32_16x16x32_bf16 v[56:59], a[68:71], v[20:23], v[56:59]
buffer_load_dwordx4 v6, s[8:11], s50 offen offset:384 lds
v_mfma_f32_16x16x32_bf16 v[60:63], a[64:67], v[24:27], v[60:63]
ds_read_b128 v[48:51], v11 offset:22528
v_mfma_f32_16x16x32_bf16 v[64:67], a[68:71], v[24:27], v[64:67]
s_add_u32 m0, s46, 15872
s_waitcnt lgkmcnt(4)
v_mfma_f32_16x16x32_bf16 v[52:55], a[72:75], v[28:31], v[52:55]
ds_read_b128 v[20:23], v10 offset:24576
v_mfma_f32_16x16x32_bf16 v[56:59], a[76:79], v[28:31], v[56:59]
buffer_load_dwordx4 v6, s[8:11], s50 offen offset:512 lds
v_mfma_f32_16x16x32_bf16 v[60:63], a[72:75], v[32:35], v[60:63]
ds_read_b128 v[24:27], v10 offset:26624
v_mfma_f32_16x16x32_bf16 v[64:67], a[76:79], v[32:35], v[64:67]
s_add_u32 m0, s46, 19840
s_waitcnt lgkmcnt(4)
v_mfma_f32_16x16x32_bf16 v[52:55], a[80:83], v[36:39], v[52:55]
ds_read_b128 v[28:31], v11 offset:24576
v_mfma_f32_16x16x32_bf16 v[56:59], a[84:87], v[36:39], v[56:59]
buffer_load_dwordx4 v6, s[8:11], s50 offen offset:640 lds
v_mfma_f32_16x16x32_bf16 v[60:63], a[80:83], v[40:43], v[60:63]
ds_read_b128 v[32:35], v11 offset:26624
v_mfma_f32_16x16x32_bf16 v[64:67], a[84:87], v[40:43], v[64:67]
s_add_u32 m0, s46, 23808
s_waitcnt lgkmcnt(4)
v_mfma_f32_16x16x32_bf16 v[52:55], a[88:91], v[44:47], v[52:55]
ds_read_b128 v[36:39], v10 offset:28672
v_mfma_f32_16x16x32_bf16 v[56:59], a[92:95], v[44:47], v[56:59]
buffer_load_dwordx4 v6, s[8:11], s50 offen offset:768 lds
v_mfma_f32_16x16x32_bf16 v[60:63], a[88:91], v[48:51], v[60:63]
ds_read_b128 v[40:43], v10 offset:30720
v_mfma_f32_16x16x32_bf16 v[64:67], a[92:95], v[48:51], v[64:67]
s_add_u32 m0, s46, 27776
s_waitcnt lgkmcnt(4)
v_mfma_f32_16x16x32_bf16 v[52:55], a[96:99], v[20:23], v[52:55]
ds_read_b128 v[44:47], v11 offset:28672
v_mfma_f32_16x16x32_bf16 v[56:59], a[100:103], v[20:23], v[56:59]
buffer_load_dwordx4 v6, s[8:11], s50 offen offset:896 lds
v_mfma_f32_16x16x32_bf16 v[60:63], a[96:99], v[24:27], v[60:63]
ds_read_b128 v[48:51], v11 offset:30720
v_mfma_f32_16x16x32_bf16 v[64:67], a[100:103], v[24:27], v[64:67]
s_add_u32 m0, s46, 31744
s_waitcnt lgkmcnt(4)
v_mfma_f32_16x16x32_bf16 v[52:55], a[104:107], v[28:31], v[52:55]
ds_read_b128 v[20:23], v10 offset:32768
v_mfma_f32_16x16x32_bf16 v[56:59], a[108:111], v[28:31], v[56:59]
buffer_load_dwordx4 v6, s[8:11], s50 offen offset:1024 lds
v_mfma_f32_16x16x32_bf16 v[60:63], a[104:107], v[32:35], v[60:63]
ds_read_b128 v[24:27], v10 offset:34816
v_mfma_f32_16x16x32_bf16 v[64:67], a[108:111], v[32:35], v[64:67]
s_waitcnt vmcnt(13)
v_mov_b32 v17, s42
s_mov_b64 exec, 1
buffer_store_dword v17, v16, s[84:87], s49 offen sc1
s_mov_b64 exec, -1
s_add_u32 m0, s46, 35712
s_waitcnt lgkmcnt(4)
v_mfma_f32_16x16x32_bf16 v[52:55], a[112:115], v[36:39], v[52:55]
ds_read_b128 v[28:31], v11 offset:32768
v_mfma_f32_16x16x32_bf16 v[56:59], a[116:119], v[36:39], v[56:59]
buffer_load_dwordx4 v6, s[8:11], s50 offen offset:1152 lds
v_mfma_f32_16x16x32_bf16 v[60:63], a[112:115], v[40:43], v[60:63]
ds_read_b128 v[32:35], v11 offset:34816
v_mfma_f32_16x16x32_bf16 v[64:67], a[116:119], v[40:43], v[64:67]
v_mov_b32 v100, 0
s_mov_b64 exec, 1
buffer_atomic_add v100, v16, s[84:87], s62 offen sc0 sc1
s_mov_b64 exec, -1
s_add_u32 m0, s46, 39680
s_waitcnt lgkmcnt(4)
v_mfma_f32_16x16x32_bf16 v[52:55], a[120:123], v[44:47], v[52:55]
ds_read_b128 v[36:39], v10 offset:36864
v_mfma_f32_16x16x32_bf16 v[56:59], a[124:127], v[44:47], v[56:59]
buffer_load_dwordx4 v6, s[8:11], s50 offen offset:1280 lds
v_mfma_f32_16x16x32_bf16 v[60:63], a[120:123], v[48:51], v[60:63]
ds_read_b128 v[40:43], v10 offset:38912
v_mfma_f32_16x16x32_bf16 v[64:67], a[124:127], v[48:51], v[64:67]
s_add_u32 m0, s46, 43648
s_waitcnt lgkmcnt(4)
v_mfma_f32_16x16x32_bf16 v[52:55], a[128:131], v[20:23], v[52:55]
ds_read_b128 v[44:47], v11 offset:36864
v_mfma_f32_16x16x32_bf16 v[56:59], a[132:135], v[20:23], v[56:59]
buffer_load_dwordx4 v6, s[8:11], s50 offen offset:1408 lds
v_mfma_f32_16x16x32_bf16 v[60:63], a[128:131], v[24:27], v[60:63]
ds_read_b128 v[48:51], v11 offset:38912
v_mfma_f32_16x16x32_bf16 v[64:67], a[132:135], v[24:27], v[64:67]
s_add_u32 m0, s46, 47616
s_waitcnt lgkmcnt(4)
v_mfma_f32_16x16x32_bf16 v[52:55], a[136:139], v[28:31], v[52:55]
ds_read_b128 v[20:23], v10 offset:40960
v_mfma_f32_16x16x32_bf16 v[56:59], a[140:143], v[28:31], v[56:59]
buffer_load_dwordx4 v6, s[8:11], s50 offen offset:1536 lds
v_mfma_f32_16x16x32_bf16 v[60:63], a[136:139], v[32:35], v[60:63]
ds_read_b128 v[24:27], v10 offset:43008
v_mfma_f32_16x16x32_bf16 v[64:67], a[140:143], v[32:35], v[64:67]
s_add_u32 m0, s46, 51584
s_waitcnt lgkmcnt(4)
v_mfma_f32_16x16x32_bf16 v[52:55], a[144:147], v[36:39], v[52:55]
ds_read_b128 v[28:31], v11 offset:40960
v_mfma_f32_16x16x32_bf16 v[56:59], a[148:151], v[36:39], v[56:59]
buffer_load_dwordx4 v6, s[8:11], s50 offen offset:1664 lds
v_mfma_f32_16x16x32_bf16 v[60:63], a[144:147], v[40:43], v[60:63]
ds_read_b128 v[32:35], v11 offset:43008
v_mfma_f32_16x16x32_bf16 v[64:67], a[148:151], v[40:43], v[64:67]
s_add_u32 m0, s46, 55552
s_waitcnt lgkmcnt(4)
v_mfma_f32_16x16x32_bf16 v[52:55], a[152:155], v[44:47], v[52:55]
ds_read_b128 v[36:39], v10 offset:45056
v_mfma_f32_16x16x32_bf16 v[56:59], a[156:159], v[44:47], v[56:59]
buffer_load_dwordx4 v6, s[8:11], s50 offen offset:1792 lds
v_mfma_f32_16x16x32_bf16 v[60:63], a[152:155], v[48:51], v[60:63]
ds_read_b128 v[40:43], v10 offset:47104
v_mfma_f32_16x16x32_bf16 v[64:67], a[156:159], v[48:51], v[64:67]
s_add_u32 m0, s46, 59520
s_waitcnt lgkmcnt(4)
v_mfma_f32_16x16x32_bf16 v[52:55], a[160:163], v[20:23], v[52:55]
ds_read_b128 v[44:47], v11 offset:45056
v_mfma_f32_16x16x32_bf16 v[56:59], a[164:167], v[20:23], v[56:59]
buffer_load_dwordx4 v6, s[8:11], s50 offen offset:1920 lds
v_mfma_f32_16x16x32_bf16 v[60:63], a[160:163], v[24:27], v[60:63]
ds_read_b128 v[48:51], v11 offset:47104
v_mfma_f32_16x16x32_bf16 v[64:67], a[164:167], v[24:27], v[64:67]
s_waitcnt lgkmcnt(4)
v_mfma_f32_16x16x32_bf16 v[52:55], a[168:171], v[28:31], v[52:55]
ds_read_b128 v[20:23], v10 offset:49152
v_mfma_f32_16x16x32_bf16 v[56:59], a[172:175], v[28:31], v[56:59]
v_mov_b64 v[84:85], v[220:221]
v_mov_b64 v[86:87], v[222:223]
v_mfma_f32_16x16x32_bf16 v[60:63], a[168:171], v[32:35], v[60:63]
ds_read_b128 v[24:27], v10 offset:51200
v_mfma_f32_16x16x32_bf16 v[64:67], a[172:175], v[32:35], v[64:67]
v_mov_b64 v[88:89], v[224:225]
v_mov_b64 v[90:91], v[226:227]
s_waitcnt lgkmcnt(4)
v_mfma_f32_16x16x32_bf16 v[52:55], a[176:179], v[36:39], v[52:55]
ds_read_b128 v[28:31], v11 offset:49152
v_mfma_f32_16x16x32_bf16 v[56:59], a[180:183], v[36:39], v[56:59]
v_mov_b64 v[220:221], v[228:229]
v_mov_b64 v[222:223], v[230:231]
v_mfma_f32_16x16x32_bf16 v[60:63], a[176:179], v[40:43], v[60:63]
ds_read_b128 v[32:35], v11 offset:51200
v_mfma_f32_16x16x32_bf16 v[64:67], a[180:183], v[40:43], v[64:67]
v_mov_b64 v[224:225], v[232:233]
v_mov_b64 v[226:227], v[234:235]
s_waitcnt lgkmcnt(4)
v_mfma_f32_16x16x32_bf16 v[52:55], a[184:187], v[44:47], v[52:55]
ds_read_b128 v[36:39], v10 offset:53248
v_mfma_f32_16x16x32_bf16 v[56:59], a[188:191], v[44:47], v[56:59]
v_cvt_pk_bf16_f32 v228, v68, v69
v_cvt_pk_bf16_f32 v229, v70, v71
v_mfma_f32_16x16x32_bf16 v[60:63], a[184:187], v[48:51], v[60:63]
ds_read_b128 v[40:43], v10 offset:55296
v_mfma_f32_16x16x32_bf16 v[64:67], a[188:191], v[48:51], v[64:67]
v_cvt_pk_bf16_f32 v230, v72, v73
v_cvt_pk_bf16_f32 v231, v74, v75
s_waitcnt lgkmcnt(4)
v_mfma_f32_16x16x32_bf16 v[52:55], a[192:195], v[20:23], v[52:55]
ds_read_b128 v[44:47], v11 offset:53248
v_mfma_f32_16x16x32_bf16 v[56:59], a[196:199], v[20:23], v[56:59]
v_cvt_pk_bf16_f32 v232, v76, v77
v_cvt_pk_bf16_f32 v233, v78, v79
v_mfma_f32_16x16x32_bf16 v[60:63], a[192:195], v[24:27], v[60:63]
ds_read_b128 v[48:51], v11 offset:55296
v_mfma_f32_16x16x32_bf16 v[64:67], a[196:199], v[24:27], v[64:67]
v_cvt_pk_bf16_f32 v234, v80, v81
v_cvt_pk_bf16_f32 v235, v82, v83
s_waitcnt lgkmcnt(4)
v_mfma_f32_16x16x32_bf16 v[52:55], a[200:203], v[28:31], v[52:55]
ds_read_b128 v[20:23], v10 offset:57344
v_mfma_f32_16x16x32_bf16 v[56:59], a[204:207], v[28:31], v[56:59]
v_mfma_f32_16x16x32_bf16 v[60:63], a[200:203], v[32:35], v[60:63]
ds_read_b128 v[24:27], v10 offset:59392
v_mfma_f32_16x16x32_bf16 v[64:67], a[204:207], v[32:35], v[64:67]
s_waitcnt lgkmcnt(4)
v_mfma_f32_16x16x32_bf16 v[52:55], a[208:211], v[36:39], v[52:55]
ds_read_b128 v[28:31], v11 offset:57344
v_mfma_f32_16x16x32_bf16 v[56:59], a[212:215], v[36:39], v[56:59]
v_mfma_f32_16x16x32_bf16 v[60:63], a[208:211], v[40:43], v[60:63]
ds_read_b128 v[32:35], v11 offset:59392
v_mfma_f32_16x16x32_bf16 v[64:67], a[212:215], v[40:43], v[64:67]
s_waitcnt lgkmcnt(4)
v_mfma_f32_16x16x32_bf16 v[52:55], a[216:219], v[44:47], v[52:55]
ds_read_b128 v[36:39], v10 offset:61440
v_mfma_f32_16x16x32_bf16 v[56:59], a[220:223], v[44:47], v[56:59]
s_waitcnt vmcnt(6)
v_readfirstlane_b32 s56, v100
s_cmp_eq_u32 s30, 1
s_cbranch_scc1 mega_kernel_q_kf1
s_cmp_gt_i32 s56, s42
s_cbranch_scc0 mega_kernel_q_kf1
s_mov_b32 s30, 1
s_mov_b32 m0, s61
s_nop 0
buffer_load_dwordx4 v5, s[84:87], s68 offen sc1 lds
mega_kernel_q_kf1:
v_mfma_f32_16x16x32_bf16 v[60:63], a[216:219], v[48:51], v[60:63]
ds_read_b128 v[40:43], v10 offset:63488
v_mfma_f32_16x16x32_bf16 v[64:67], a[220:223], v[48:51], v[64:67]
s_waitcnt lgkmcnt(4)
v_mfma_f32_16x16x32_bf16 v[52:55], a[224:227], v[20:23], v[52:55]
ds_read_b128 v[44:47], v11 offset:61440
v_mfma_f32_16x16x32_bf16 v[56:59], a[228:231], v[20:23], v[56:59]
v_mfma_f32_16x16x32_bf16 v[60:63], a[224:227], v[24:27], v[60:63]
ds_read_b128 v[48:51], v11 offset:63488
v_mfma_f32_16x16x32_bf16 v[64:67], a[228:231], v[24:27], v[64:67]
s_waitcnt lgkmcnt(5)
v_mfma_f32_16x16x32_bf16 v[52:55], a[232:235], v[28:31], v[52:55]
v_mfma_f32_16x16x32_bf16 v[56:59], a[236:239], v[28:31], v[56:59]
s_waitcnt lgkmcnt(4)
v_mfma_f32_16x16x32_bf16 v[60:63], a[232:235], v[32:35], v[60:63]
v_mfma_f32_16x16x32_bf16 v[64:67], a[236:239], v[32:35], v[64:67]
s_waitcnt lgkmcnt(3)
v_mfma_f32_16x16x32_bf16 v[52:55], a[240:243], v[36:39], v[52:55]
v_mfma_f32_16x16x32_bf16 v[56:59], a[244:247], v[36:39], v[56:59]
s_waitcnt lgkmcnt(2)
v_mfma_f32_16x16x32_bf16 v[60:63], a[240:243], v[40:43], v[60:63]
v_mfma_f32_16x16x32_bf16 v[64:67], a[244:247], v[40:43], v[64:67]
ds_write_b128 v101, v[84:87]
ds_write_b128 v101, v[88:91] offset:1024
s_waitcnt lgkmcnt(1)
v_mfma_f32_16x16x32_bf16 v[68:71], a[248:251], v[44:47], v[52:55]
v_mfma_f32_16x16x32_bf16 v[72:75], a[252:255], v[44:47], v[56:59]
s_waitcnt lgkmcnt(0)
v_mfma_f32_16x16x32_bf16 v[76:79], a[248:251], v[48:51], v[60:63]
v_mfma_f32_16x16x32_bf16 v[80:83], a[252:255], v[48:51], v[64:67]
mega_kernel_q_jl1:
s_cmp_eq_u32 s30, 1
s_cbranch_scc1 mega_kernel_q_kl1
mega_kernel_q_kw1:
v_mov_b32 v100, 0
s_mov_b64 exec, 1
buffer_atomic_add v100, v16, s[84:87], s62 offen sc0 sc1
s_mov_b64 exec, -1
s_waitcnt vmcnt(0)
v_readfirstlane_b32 s56, v100
s_cmp_gt_i32 s56, s42
s_cbranch_scc1 mega_kernel_q_kv1
s_cmp_eq_u32 s42, 63
s_cbranch_scc1 mega_kernel_q_kw1
s_branch mega_kernel_q_kw1
mega_kernel_q_kv1:
s_mov_b32 m0, s61
s_nop 0
buffer_load_dwordx4 v5, s[84:87], s68 offen sc1 lds
mega_kernel_q_kl1:
s_waitcnt lgkmcnt(0) vmcnt(0)
s_barrier
ds_read_b128 v[184:187], v102 offset:0
ds_read_b128 v[112:115], v103 offset:0
ds_read_b128 v[128:131], v103 offset:1024
ds_read_b128 v[188:191], v102 offset:2048
ds_read_b128 v[116:119], v103 offset:2048
ds_read_b128 v[132:135], v103 offset:3072
ds_read_b128 v[192:195], v102 offset:4096
ds_read_b128 v[120:123], v103 offset:4096
ds_read_b128 v[136:139], v103 offset:5120
ds_read_b128 v[196:199], v102 offset:6144
ds_read_b128 v[124:127], v103 offset:6144
ds_read_b128 v[140:143], v103 offset:7168
s_waitcnt lgkmcnt(9)
v_mfma_f32_16x16x32_bf16 v[200:203], v[112:115], v[184:187], 0
v_mfma_f32_16x16x32_bf16 v[204:207], v[128:131], v[184:187], 0
ds_read_b128 v[160:163], v94 offset:0
s_waitcnt lgkmcnt(7)
v_mfma_f32_16x16x32_bf16 v[200:203], v[116:119], v[188:191], v[200:203]
v_mfma_f32_16x16x32_bf16 v[204:207], v[132:135], v[188:191], v[204:207]
ds_read_b128 v[164:167], v94 offset:1024
s_waitcnt lgkmcnt(5)
v_mfma_f32_16x16x32_bf16 v[200:203], v[120:123], v[192:195], v[200:203]
v_mfma_f32_16x16x32_bf16 v[204:207], v[136:139], v[192:195], v[204:207]
ds_read_b128 v[168:171], v94 offset:2048
s_waitcnt lgkmcnt(3)
v_mfma_f32_16x16x32_bf16 v[200:203], v[124:127], v[196:199], v[200:203]
v_mfma_f32_16x16x32_bf16 v[204:207], v[140:143], v[196:199], v[204:207]
ds_read_b128 v[172:175], v94 offset:3072
s_waitcnt lgkmcnt(3)
v_mfma_f32_16x16x32_bf16 v[208:211], v[160:163], v[184:187], 0
ds_read_b128 v[144:147], v240 offset:0
ds_read_b64 v[176:177], v95 offset:0
s_waitcnt lgkmcnt(4)
v_mfma_f32_16x16x32_bf16 v[208:211], v[164:167], v[188:191], v[208:211]
ds_read_b128 v[148:151], v240 offset:1024
ds_read_b64 v[178:179], v95 offset:256
s_waitcnt lgkmcnt(5)
v_mfma_f32_16x16x32_bf16 v[208:211], v[168:171], v[192:195], v[208:211]
ds_read_b128 v[152:155], v240 offset:2048
ds_read_b64 v[180:181], v95 offset:1024
s_waitcnt lgkmcnt(6)
v_mfma_f32_16x16x32_bf16 v[208:211], v[172:175], v[196:199], v[208:211]
ds_read_b128 v[156:159], v240 offset:3072
ds_read_b64 v[182:183], v95 offset:1280
mega_kernel_q_sm1:
v_pk_mul_f32 v[200:201], v[200:201], s[54:55] op_sel_hi:[1,0]
v_pk_mul_f32 v[202:203], v[202:203], s[54:55] op_sel_hi:[1,0]
v_pk_mul_f32 v[204:205], v[204:205], s[54:55] op_sel_hi:[1,0]
v_pk_mul_f32 v[206:207], v[206:207], s[54:55] op_sel_hi:[1,0]
v_cndmask_b32 v200, v200, v241, s[12:13]
v_cndmask_b32 v201, v201, v241, s[14:15]
v_cndmask_b32 v202, v202, v241, s[16:17]
v_cndmask_b32 v203, v203, v241, s[18:19]
v_cndmask_b32 v204, v204, v241, s[20:21]
v_cndmask_b32 v205, v205, v241, s[22:23]
v_cndmask_b32 v206, v206, v241, s[24:25]
v_cndmask_b32 v207, v207, v241, s[26:27]
v_pk_mul_f32 v[208:209], v[208:209], s[54:55] op_sel_hi:[1,0]
v_pk_mul_f32 v[210:211], v[210:211], s[54:55] op_sel_hi:[1,0]
v_cndmask_b32 v208, v208, v97, s[28:29]
v_cndmask_b32 v209, v209, v97, s[28:29]
v_cndmask_b32 v210, v210, v97, s[28:29]
v_cndmask_b32 v211, v211, v97, s[28:29]
v_max3_f32 v236, v200, v201, v202
v_max3_f32 v236, v236, v203, v204
v_max3_f32 v236, v236, v205, v206
v_max3_f32 v236, v236, v207, v208
v_max3_f32 v236, v236, v209, v210
v_max_f32 v237, v236, v211
v_max_f32 v236, v236, v211
s_nop 1
v_permlane16_swap_b32 v236, v237
s_nop 0
v_max_f32 v238, v236, v237
v_max_f32 v239, v236, v237
s_nop 1
v_permlane32_swap_b32 v238, v239
s_nop 0
v_max_f32 v236, v238, v239
v_pk_add_f32 v[200:201], v[200:201], v[236:237] op_sel_hi:[1,0] neg_lo:[0,1] neg_hi:[0,1]
v_pk_add_f32 v[202:203], v[202:203], v[236:237] op_sel_hi:[1,0] neg_lo:[0,1] neg_hi:[0,1]
v_pk_add_f32 v[204:205], v[204:205], v[236:237] op_sel_hi:[1,0] neg_lo:[0,1] neg_hi:[0,1]
v_pk_add_f32 v[206:207], v[206:207], v[236:237] op_sel_hi:[1,0] neg_lo:[0,1] neg_hi:[0,1]
v_pk_add_f32 v[208:209], v[208:209], v[236:237] op_sel_hi:[1,0] neg_lo:[0,1] neg_hi:[0,1]
v_pk_add_f32 v[210:211], v[210:211], v[236:237] op_sel_hi:[1,0] neg_lo:[0,1] neg_hi:[0,1]
v_exp_f32 v200, v200
v_exp_f32 v201, v201
v_exp_f32 v202, v202
v_exp_f32 v203, v203
v_exp_f32 v204, v204
v_exp_f32 v205, v205
v_exp_f32 v206, v206
v_exp_f32 v207, v207
v_exp_f32 v208, v208
v_exp_f32 v209, v209
v_exp_f32 v210, v210
v_exp_f32 v211, v211
s_nop 0
v_cvt_pk_bf16_f32 v212, v200, v201
v_cvt_pk_bf16_f32 v213, v202, v203
v_cvt_pk_bf16_f32 v214, v204, v205
v_cvt_pk_bf16_f32 v215, v206, v207
v_cvt_pk_bf16_f32 v216, v208, v209
v_cvt_pk_bf16_f32 v217, v210, v211
s_waitcnt lgkmcnt(0)
s_nop 0
v_mfma_f32_16x16x32_bf16 v[108:111], v[104:107], v[212:215], 0
v_mfma_f32_16x16x32_bf16 v[112:115], v[144:147], v[212:215], 0
v_mfma_f32_16x16x32_bf16 v[116:119], v[148:151], v[212:215], 0
v_mfma_f32_16x16x32_bf16 v[120:123], v[152:155], v[212:215], 0
v_mfma_f32_16x16x32_bf16 v[124:127], v[156:159], v[212:215], 0
v_mfma_f32_16x16x16_bf16 v[108:111], v[104:105], v[216:217], v[108:111]
v_mfma_f32_16x16x16_bf16 v[112:115], v[176:177], v[216:217], v[112:115]
v_mfma_f32_16x16x16_bf16 v[116:119], v[178:179], v[216:217], v[116:119]
v_mfma_f32_16x16x16_bf16 v[120:123], v[180:181], v[216:217], v[120:123]
v_mfma_f32_16x16x16_bf16 v[124:127], v[182:183], v[216:217], v[124:127]
s_lshr_b32 s63, s42, 2
s_xnor_b32 s63, s63, s98
s_and_b32 s63, s63, 1
s_lshl_b32 s63, s63, 13
s_lshl_b32 s51, s42, 19
s_add_u32 s51, s51, s63
s_nop 2
v_rcp_f32 v238, v108
v_rcp_f32 v239, v109
s_nop 1
v_pk_mul_f32 v[112:113], v[112:113], v[238:239]
v_pk_mul_f32 v[114:115], v[114:115], v[238:239]
v_pk_mul_f32 v[116:117], v[116:117], v[238:239]
v_pk_mul_f32 v[118:119], v[118:119], v[238:239]
v_pk_mul_f32 v[120:121], v[120:121], v[238:239]
v_pk_mul_f32 v[122:123], v[122:123], v[238:239]
v_pk_mul_f32 v[124:125], v[124:125], v[238:239]
v_pk_mul_f32 v[126:127], v[126:127], v[238:239]
v_cvt_pk_bf16_f32 v200, v112, v113
v_cvt_pk_bf16_f32 v201, v114, v115
v_cvt_pk_bf16_f32 v202, v116, v117
v_cvt_pk_bf16_f32 v203, v118, v119
v_cvt_pk_bf16_f32 v204, v120, v121
v_cvt_pk_bf16_f32 v205, v122, v123
v_cvt_pk_bf16_f32 v206, v124, v125
v_cvt_pk_bf16_f32 v207, v126, v127
buffer_store_dwordx4 v[200:203], v96, s[84:87], s51 offen sc1
buffer_store_dwordx4 v[204:207], v96, s[84:87], s51 offen offset:2048 sc1
s_add_u32 s42, s42, 1
s_barrier
s_cmp_gt_i32 s55, s42
s_cbranch_scc1 mega_kernel_q_kv0k
mega_kernel_q_kv0w:
v_mov_b32 v2, 0
s_mov_b64 exec, 0xff
buffer_atomic_add v2, v99, s[84:87], 0 offen sc0 sc1
s_mov_b64 exec, -1
s_waitcnt vmcnt(0)
v_min_i32_dpp v2, v2, v2 quad_perm:[1,0,3,2] row_mask:0xf bank_mask:0xf
s_nop 1
v_min_i32_dpp v2, v2, v2 quad_perm:[2,3,0,1] row_mask:0xf bank_mask:0xf
s_nop 1
v_min_i32_dpp v2, v2, v2 row_half_mirror row_mask:0xf bank_mask:0xf
s_nop 0
v_readfirstlane_b32 s55, v2
s_cmp_gt_i32 s55, s42
s_cbranch_scc1 mega_kernel_q_kv0k
s_sleep 4
s_branch mega_kernel_q_kv0w
mega_kernel_q_kv0k:
s_cmp_ge_u32 s42, 61
s_cbranch_scc0 mega_kernel_q_nl0
s_add_u32 s51, s47, s42
s_bfe_u32 s57, s51, 0x40002
s_lshl_b32 s57, s57, 14
s_and_b32 s66, s51, 3
s_lshl_b32 s66, s66, 11
s_add_u32 s66, s66, s57
s_add_u32 s66, s66, s58
s_add_u32 s67, s66, 33554432
s_bfe_u32 s57, s51, 0x30003
s_lshl_b32 s57, s57, 14
s_and_b32 s68, s51, 7
s_lshl_b32 s68, s68, 10
s_add_u32 s68, s68, s57
s_add_u32 s68, s68, s59
s_add_u32 s50, s42, 4
s_min_u32 s50, s50, 63
s_lshl_b32 s50, s50, 16
s_cmp_gt_i32 s56, s42
s_cselect_b32 s30, 1, 0
s_add_u32 m0, s60, 0
s_nop 0
buffer_load_dwordx4 v5, s[84:87], s66 offen offset:0 sc1 lds
s_add_u32 m0, s60, 0
s_nop 0
buffer_load_dwordx4 v5, s[84:87], s66 offen offset:1024 sc1 lds
s_add_u32 m0, s60, 8192
s_nop 0
buffer_load_dwordx4 v5, s[84:87], s67 offen offset:0 sc1 lds
s_add_u32 m0, s60, 8192
s_nop 0
buffer_load_dwordx4 v5, s[84:87], s67 offen offset:1024 sc1 lds
s_cmp_eq_u32 s30, 1
s_cbranch_scc0 mega_kernel_q_kx0
s_mov_b32 m0, s61
s_nop 0
buffer_load_dwordx4 v5, s[84:87], s68 offen sc1 lds
mega_kernel_q_kx0:
v_mov_b64 v[84:85], v[220:221]
v_mov_b64 v[86:87], v[222:223]
v_mov_b64 v[88:89], v[224:225]
v_mov_b64 v[90:91], v[226:227]
v_mov_b64 v[220:221], v[228:229]
v_mov_b64 v[222:223], v[230:231]
v_mov_b64 v[224:225], v[232:233]
v_mov_b64 v[226:227], v[234:235]
v_cvt_pk_bf16_f32 v228, v68, v69
v_cvt_pk_bf16_f32 v229, v70, v71
v_cvt_pk_bf16_f32 v230, v72, v73
v_cvt_pk_bf16_f32 v231, v74, v75
v_cvt_pk_bf16_f32 v232, v76, v77
v_cvt_pk_bf16_f32 v233, v78, v79
v_cvt_pk_bf16_f32 v234, v80, v81
v_cvt_pk_bf16_f32 v235, v82, v83
ds_write_b128 v101, v[84:87]
ds_write_b128 v101, v[88:91] offset:1024
s_waitcnt vmcnt(4)
v_mov_b32 v17, s42
s_mov_b64 exec, 1
buffer_store_dword v17, v16, s[84:87], s49 offen sc1
s_mov_b64 exec, -1
s_branch mega_kernel_q_jl0
mega_kernel_q_nl0:
ds_read_b128 v[20:23], v8 offset:0
ds_read_b128 v[24:27], v8 offset:2048
ds_read_b128 v[28:31], v9 offset:0
ds_read_b128 v[32:35], v9 offset:2048
ds_read_b128 v[36:39], v8 offset:4096
ds_read_b128 v[40:43], v8 offset:6144
s_add_u32 s51, s47, s42
s_bfe_u32 s57, s51, 0x40002
s_lshl_b32 s57, s57, 14
s_and_b32 s66, s51, 3
s_lshl_b32 s66, s66, 11
s_add_u32 s66, s66, s57
s_add_u32 s66, s66, s58
s_add_u32 s67, s66, 33554432
s_bfe_u32 s57, s51, 0x30003
s_lshl_b32 s57, s57, 14
s_and_b32 s68, s51, 7
s_lshl_b32 s68, s68, 10
s_add_u32 s68, s68, s57
s_add_u32 s68, s68, s59
s_add_u32 s50, s42, 4
s_min_u32 s50, s50, 63
s_lshl_b32 s50, s50, 16
s_cmp_gt_i32 s56, s42
s_cselect_b32 s30, 1, 0
s_add_u32 m0, s60, 0
s_waitcnt lgkmcnt(4)
v_mfma_f32_16x16x32_bf16 v[52:55], a[0:3], v[20:23], 0
ds_read_b128 v[44:47], v9 offset:4096
v_mfma_f32_16x16x32_bf16 v[56:59], a[4:7], v[20:23], 0
buffer_load_dwordx4 v5, s[84:87], s66 offen offset:0 sc1 lds
v_mfma_f32_16x16x32_bf16 v[60:63], a[0:3], v[24:27], 0
ds_read_b128 v[48:51], v9 offset:6144
v_mfma_f32_16x16x32_bf16 v[64:67], a[4:7], v[24:27], 0
s_add_u32 m0, s60, 0
s_waitcnt lgkmcnt(4)
v_mfma_f32_16x16x32_bf16 v[52:55], a[8:11], v[28:31], v[52:55]
ds_read_b128 v[20:23], v8 offset:8192
v_mfma_f32_16x16x32_bf16 v[56:59], a[12:15], v[28:31], v[56:59]
buffer_load_dwordx4 v5, s[84:87], s66 offen offset:1024 sc1 lds
v_mfma_f32_16x16x32_bf16 v[60:63], a[8:11], v[32:35], v[60:63]
ds_read_b128 v[24:27], v8 offset:10240
v_mfma_f32_16x16x32_bf16 v[64:67], a[12:15], v[32:35], v[64:67]
s_add_u32 m0, s60, 8192
s_waitcnt lgkmcnt(4)
v_mfma_f32_16x16x32_bf16 v[52:55], a[16:19], v[36:39], v[52:55]
ds_read_b128 v[28:31], v9 offset:8192
v_mfma_f32_16x16x32_bf16 v[56:59], a[20:23], v[36:39], v[56:59]
buffer_load_dwordx4 v5, s[84:87], s67 offen offset:0 sc1 lds
v_mfma_f32_16x16x32_bf16 v[60:63], a[16:19], v[40:43], v[60:63]
ds_read_b128 v[32:35], v9 offset:10240
v_mfma_f32_16x16x32_bf16 v[64:67], a[20:23], v[40:43], v[64:67]
s_add_u32 m0, s60, 8192
s_waitcnt lgkmcnt(4)
v_mfma_f32_16x16x32_bf16 v[52:55], a[24:27], v[44:47], v[52:55]
ds_read_b128 v[36:39], v8 offset:12288
v_mfma_f32_16x16x32_bf16 v[56:59], a[28:31], v[44:47], v[56:59]
buffer_load_dwordx4 v5, s[84:87], s67 offen offset:1024 sc1 lds
v_mfma_f32_16x16x32_bf16 v[60:63], a[24:27], v[48:51], v[60:63]
ds_read_b128 v[40:43], v8 offset:14336
v_mfma_f32_16x16x32_bf16 v[64:67], a[28:31], v[48:51], v[64:67]
s_waitcnt lgkmcnt(4)
v_mfma_f32_16x16x32_bf16 v[52:55], a[32:35], v[20:23], v[52:55]
ds_read_b128 v[44:47], v9 offset:12288
v_mfma_f32_16x16x32_bf16 v[56:59], a[36:39], v[20:23], v[56:59]
s_cmp_eq_u32 s30, 1
s_cbranch_scc0 mega_kernel_q_ke0
s_mov_b32 m0, s61
s_nop 0
buffer_load_dwordx4 v5, s[84:87], s68 offen sc1 lds
mega_kernel_q_ke0:
v_mfma_f32_16x16x32_bf16 v[60:63], a[32:35], v[24:27], v[60:63]
ds_read_b128 v[48:51], v9 offset:14336
v_mfma_f32_16x16x32_bf16 v[64:67], a[36:39], v[24:27], v[64:67]
s_add_u32 m0, s46, 65536
s_waitcnt lgkmcnt(4)
v_mfma_f32_16x16x32_bf16 v[52:55], a[40:43], v[28:31], v[52:55]
ds_read_b128 v[20:23], v8 offset:16384
v_mfma_f32_16x16x32_bf16 v[56:59], a[44:47], v[28:31], v[56:59]
buffer_load_dwordx4 v6, s[8:11], s50 offen offset:0 lds
v_mfma_f32_16x16x32_bf16 v[60:63], a[40:43], v[32:35], v[60:63]
ds_read_b128 v[24:27], v8 offset:18432
v_mfma_f32_16x16x32_bf16 v[64:67], a[44:47], v[32:35], v[64:67]
s_add_u32 m0, s46, 69504
s_waitcnt lgkmcnt(4)
v_mfma_f32_16x16x32_bf16 v[52:55], a[48:51], v[36:39], v[52:55]
ds_read_b128 v[28:31], v9 offset:16384
v_mfma_f32_16x16x32_bf16 v[56:59], a[52:55], v[36:39], v[56:59]
buffer_load_dwordx4 v6, s[8:11], s50 offen offset:128 lds
v_mfma_f32_16x16x32_bf16 v[60:63], a[48:51], v[40:43], v[60:63]
ds_read_b128 v[32:35], v9 offset:18432
v_mfma_f32_16x16x32_bf16 v[64:67], a[52:55], v[40:43], v[64:67]
s_add_u32 m0, s46, 73472
s_waitcnt lgkmcnt(4)
v_mfma_f32_16x16x32_bf16 v[52:55], a[56:59], v[44:47], v[52:55]
ds_read_b128 v[36:39], v8 offset:20480
v_mfma_f32_16x16x32_bf16 v[56:59], a[60:63], v[44:47], v[56:59]
buffer_load_dwordx4 v6, s[8:11], s50 offen offset:256 lds
v_mfma_f32_16x16x32_bf16 v[60:63], a[56:59], v[48:51], v[60:63]
ds_read_b128 v[40:43], v8 offset:22528
v_mfma_f32_16x16x32_bf16 v[64:67], a[60:63], v[48:51], v[64:67]
s_add_u32 m0, s46, 77440
s_waitcnt lgkmcnt(4)
v_mfma_f32_16x16x32_bf16 v[52:55], a[64:67], v[20:23], v[52:55]
ds_read_b128 v[44:47], v9 offset:20480
v_mfma_f32_16x16x32_bf16 v[56:59], a[68:71], v[20:23], v[56:59]
buffer_load_dwordx4 v6, s[8:11], s50 offen offset:384 lds
v_mfma_f32_16x16x32_bf16 v[60:63], a[64:67], v[24:27], v[60:63]
ds_read_b128 v[48:51], v9 offset:22528
v_mfma_f32_16x16x32_bf16 v[64:67], a[68:71], v[24:27], v[64:67]
s_add_u32 m0, s46, 81408
s_waitcnt lgkmcnt(4)
v_mfma_f32_16x16x32_bf16 v[52:55], a[72:75], v[28:31], v[52:55]
ds_read_b128 v[20:23], v8 offset:24576
v_mfma_f32_16x16x32_bf16 v[56:59], a[76:79], v[28:31], v[56:59]
buffer_load_dwordx4 v6, s[8:11], s50 offen offset:512 lds
v_mfma_f32_16x16x32_bf16 v[60:63], a[72:75], v[32:35], v[60:63]
ds_read_b128 v[24:27], v8 offset:26624
v_mfma_f32_16x16x32_bf16 v[64:67], a[76:79], v[32:35], v[64:67]
s_add_u32 m0, s46, 85376
s_waitcnt lgkmcnt(4)
v_mfma_f32_16x16x32_bf16 v[52:55], a[80:83], v[36:39], v[52:55]
ds_read_b128 v[28:31], v9 offset:24576
v_mfma_f32_16x16x32_bf16 v[56:59], a[84:87], v[36:39], v[56:59]
buffer_load_dwordx4 v6, s[8:11], s50 offen offset:640 lds
v_mfma_f32_16x16x32_bf16 v[60:63], a[80:83], v[40:43], v[60:63]
ds_read_b128 v[32:35], v9 offset:26624
v_mfma_f32_16x16x32_bf16 v[64:67], a[84:87], v[40:43], v[64:67]
s_add_u32 m0, s46, 89344
s_waitcnt lgkmcnt(4)
v_mfma_f32_16x16x32_bf16 v[52:55], a[88:91], v[44:47], v[52:55]
ds_read_b128 v[36:39], v8 offset:28672
v_mfma_f32_16x16x32_bf16 v[56:59], a[92:95], v[44:47], v[56:59]
buffer_load_dwordx4 v6, s[8:11], s50 offen offset:768 lds
v_mfma_f32_16x16x32_bf16 v[60:63], a[88:91], v[48:51], v[60:63]
ds_read_b128 v[40:43], v8 offset:30720
v_mfma_f32_16x16x32_bf16 v[64:67], a[92:95], v[48:51], v[64:67]
s_add_u32 m0, s46, 93312
s_waitcnt lgkmcnt(4)
v_mfma_f32_16x16x32_bf16 v[52:55], a[96:99], v[20:23], v[52:55]
ds_read_b128 v[44:47], v9 offset:28672
v_mfma_f32_16x16x32_bf16 v[56:59], a[100:103], v[20:23], v[56:59]
buffer_load_dwordx4 v6, s[8:11], s50 offen offset:896 lds
v_mfma_f32_16x16x32_bf16 v[60:63], a[96:99], v[24:27], v[60:63]
ds_read_b128 v[48:51], v9 offset:30720
v_mfma_f32_16x16x32_bf16 v[64:67], a[100:103], v[24:27], v[64:67]
s_add_u32 m0, s46, 97280
s_waitcnt lgkmcnt(4)
v_mfma_f32_16x16x32_bf16 v[52:55], a[104:107], v[28:31], v[52:55]
ds_read_b128 v[20:23], v8 offset:32768
v_mfma_f32_16x16x32_bf16 v[56:59], a[108:111], v[28:31], v[56:59]
buffer_load_dwordx4 v6, s[8:11], s50 offen offset:1024 lds
v_mfma_f32_16x16x32_bf16 v[60:63], a[104:107], v[32:35], v[60:63]
ds_read_b128 v[24:27], v8 offset:34816
v_mfma_f32_16x16x32_bf16 v[64:67], a[108:111], v[32:35], v[64:67]
s_waitcnt vmcnt(13)
v_mov_b32 v17, s42
s_mov_b64 exec, 1
buffer_store_dword v17, v16, s[84:87], s49 offen sc1
s_mov_b64 exec, -1
s_add_u32 m0, s46, 101248
s_waitcnt lgkmcnt(4)
v_mfma_f32_16x16x32_bf16 v[52:55], a[112:115], v[36:39], v[52:55]
ds_read_b128 v[28:31], v9 offset:32768
v_mfma_f32_16x16x32_bf16 v[56:59], a[116:119], v[36:39], v[56:59]
buffer_load_dwordx4 v6, s[8:11], s50 offen offset:1152 lds
v_mfma_f32_16x16x32_bf16 v[60:63], a[112:115], v[40:43], v[60:63]
ds_read_b128 v[32:35], v9 offset:34816
v_mfma_f32_16x16x32_bf16 v[64:67], a[116:119], v[40:43], v[64:67]
v_mov_b32 v100, 0
s_mov_b64 exec, 1
buffer_atomic_add v100, v16, s[84:87], s62 offen sc0 sc1
s_mov_b64 exec, -1
s_add_u32 m0, s46, 105216
s_waitcnt lgkmcnt(4)
v_mfma_f32_16x16x32_bf16 v[52:55], a[120:123], v[44:47], v[52:55]
ds_read_b128 v[36:39], v8 offset:36864
v_mfma_f32_16x16x32_bf16 v[56:59], a[124:127], v[44:47], v[56:59]
buffer_load_dwordx4 v6, s[8:11], s50 offen offset:1280 lds
v_mfma_f32_16x16x32_bf16 v[60:63], a[120:123], v[48:51], v[60:63]
ds_read_b128 v[40:43], v8 offset:38912
v_mfma_f32_16x16x32_bf16 v[64:67], a[124:127], v[48:51], v[64:67]
s_add_u32 m0, s46, 109184
s_waitcnt lgkmcnt(4)
v_mfma_f32_16x16x32_bf16 v[52:55], a[128:131], v[20:23], v[52:55]
ds_read_b128 v[44:47], v9 offset:36864
v_mfma_f32_16x16x32_bf16 v[56:59], a[132:135], v[20:23], v[56:59]
buffer_load_dwordx4 v6, s[8:11], s50 offen offset:1408 lds
v_mfma_f32_16x16x32_bf16 v[60:63], a[128:131], v[24:27], v[60:63]
ds_read_b128 v[48:51], v9 offset:38912
v_mfma_f32_16x16x32_bf16 v[64:67], a[132:135], v[24:27], v[64:67]
s_add_u32 m0, s46, 113152
s_waitcnt lgkmcnt(4)
v_mfma_f32_16x16x32_bf16 v[52:55], a[136:139], v[28:31], v[52:55]
ds_read_b128 v[20:23], v8 offset:40960
v_mfma_f32_16x16x32_bf16 v[56:59], a[140:143], v[28:31], v[56:59]
buffer_load_dwordx4 v6, s[8:11], s50 offen offset:1536 lds
v_mfma_f32_16x16x32_bf16 v[60:63], a[136:139], v[32:35], v[60:63]
ds_read_b128 v[24:27], v8 offset:43008
v_mfma_f32_16x16x32_bf16 v[64:67], a[140:143], v[32:35], v[64:67]
s_add_u32 m0, s46, 117120
s_waitcnt lgkmcnt(4)
v_mfma_f32_16x16x32_bf16 v[52:55], a[144:147], v[36:39], v[52:55]
ds_read_b128 v[28:31], v9 offset:40960
v_mfma_f32_16x16x32_bf16 v[56:59], a[148:151], v[36:39], v[56:59]
buffer_load_dwordx4 v6, s[8:11], s50 offen offset:1664 lds
v_mfma_f32_16x16x32_bf16 v[60:63], a[144:147], v[40:43], v[60:63]
ds_read_b128 v[32:35], v9 offset:43008
v_mfma_f32_16x16x32_bf16 v[64:67], a[148:151], v[40:43], v[64:67]
s_add_u32 m0, s46, 121088
s_waitcnt lgkmcnt(4)
v_mfma_f32_16x16x32_bf16 v[52:55], a[152:155], v[44:47], v[52:55]
ds_read_b128 v[36:39], v8 offset:45056
v_mfma_f32_16x16x32_bf16 v[56:59], a[156:159], v[44:47], v[56:59]
buffer_load_dwordx4 v6, s[8:11], s50 offen offset:1792 lds
v_mfma_f32_16x16x32_bf16 v[60:63], a[152:155], v[48:51], v[60:63]
ds_read_b128 v[40:43], v8 offset:47104
v_mfma_f32_16x16x32_bf16 v[64:67], a[156:159], v[48:51], v[64:67]
s_add_u32 m0, s46, 125056
s_waitcnt lgkmcnt(4)
v_mfma_f32_16x16x32_bf16 v[52:55], a[160:163], v[20:23], v[52:55]
ds_read_b128 v[44:47], v9 offset:45056
v_mfma_f32_16x16x32_bf16 v[56:59], a[164:167], v[20:23], v[56:59]
buffer_load_dwordx4 v6, s[8:11], s50 offen offset:1920 lds
v_mfma_f32_16x16x32_bf16 v[60:63], a[160:163], v[24:27], v[60:63]
ds_read_b128 v[48:51], v9 offset:47104
v_mfma_f32_16x16x32_bf16 v[64:67], a[164:167], v[24:27], v[64:67]
s_waitcnt lgkmcnt(4)
v_mfma_f32_16x16x32_bf16 v[52:55], a[168:171], v[28:31], v[52:55]
ds_read_b128 v[20:23], v8 offset:49152
v_mfma_f32_16x16x32_bf16 v[56:59], a[172:175], v[28:31], v[56:59]
v_mov_b64 v[84:85], v[220:221]
v_mov_b64 v[86:87], v[222:223]
v_mfma_f32_16x16x32_bf16 v[60:63], a[168:171], v[32:35], v[60:63]
ds_read_b128 v[24:27], v8 offset:51200
v_mfma_f32_16x16x32_bf16 v[64:67], a[172:175], v[32:35], v[64:67]
v_mov_b64 v[88:89], v[224:225]
v_mov_b64 v[90:91], v[226:227]
s_waitcnt lgkmcnt(4)
v_mfma_f32_16x16x32_bf16 v[52:55], a[176:179], v[36:39], v[52:55]
ds_read_b128 v[28:31], v9 offset:49152
v_mfma_f32_16x16x32_bf16 v[56:59], a[180:183], v[36:39], v[56:59]
v_mov_b64 v[220:221], v[228:229]
v_mov_b64 v[222:223], v[230:231]
v_mfma_f32_16x16x32_bf16 v[60:63], a[176:179], v[40:43], v[60:63]
ds_read_b128 v[32:35], v9 offset:51200
v_mfma_f32_16x16x32_bf16 v[64:67], a[180:183], v[40:43], v[64:67]
v_mov_b64 v[224:225], v[232:233]
v_mov_b64 v[226:227], v[234:235]
s_waitcnt lgkmcnt(4)
v_mfma_f32_16x16x32_bf16 v[52:55], a[184:187], v[44:47], v[52:55]
ds_read_b128 v[36:39], v8 offset:53248
v_mfma_f32_16x16x32_bf16 v[56:59], a[188:191], v[44:47], v[56:59]
v_cvt_pk_bf16_f32 v228, v68, v69
v_cvt_pk_bf16_f32 v229, v70, v71
v_mfma_f32_16x16x32_bf16 v[60:63], a[184:187], v[48:51], v[60:63]
ds_read_b128 v[40:43], v8 offset:55296
v_mfma_f32_16x16x32_bf16 v[64:67], a[188:191], v[48:51], v[64:67]
v_cvt_pk_bf16_f32 v230, v72, v73
v_cvt_pk_bf16_f32 v231, v74, v75
s_waitcnt lgkmcnt(4)
v_mfma_f32_16x16x32_bf16 v[52:55], a[192:195], v[20:23], v[52:55]
ds_read_b128 v[44:47], v9 offset:53248
v_mfma_f32_16x16x32_bf16 v[56:59], a[196:199], v[20:23], v[56:59]
v_cvt_pk_bf16_f32 v232, v76, v77
v_cvt_pk_bf16_f32 v233, v78, v79
v_mfma_f32_16x16x32_bf16 v[60:63], a[192:195], v[24:27], v[60:63]
ds_read_b128 v[48:51], v9 offset:55296
v_mfma_f32_16x16x32_bf16 v[64:67], a[196:199], v[24:27], v[64:67]
v_cvt_pk_bf16_f32 v234, v80, v81
v_cvt_pk_bf16_f32 v235, v82, v83
s_waitcnt lgkmcnt(4)
v_mfma_f32_16x16x32_bf16 v[52:55], a[200:203], v[28:31], v[52:55]
ds_read_b128 v[20:23], v8 offset:57344
v_mfma_f32_16x16x32_bf16 v[56:59], a[204:207], v[28:31], v[56:59]
v_mfma_f32_16x16x32_bf16 v[60:63], a[200:203], v[32:35], v[60:63]
ds_read_b128 v[24:27], v8 offset:59392
v_mfma_f32_16x16x32_bf16 v[64:67], a[204:207], v[32:35], v[64:67]
s_waitcnt lgkmcnt(4)
v_mfma_f32_16x16x32_bf16 v[52:55], a[208:211], v[36:39], v[52:55]
ds_read_b128 v[28:31], v9 offset:57344
v_mfma_f32_16x16x32_bf16 v[56:59], a[212:215], v[36:39], v[56:59]
v_mfma_f32_16x16x32_bf16 v[60:63], a[208:211], v[40:43], v[60:63]
ds_read_b128 v[32:35], v9 offset:59392
v_mfma_f32_16x16x32_bf16 v[64:67], a[212:215], v[40:43], v[64:67]
s_waitcnt lgkmcnt(4)
v_mfma_f32_16x16x32_bf16 v[52:55], a[216:219], v[44:47], v[52:55]
ds_read_b128 v[36:39], v8 offset:61440
v_mfma_f32_16x16x32_bf16 v[56:59], a[220:223], v[44:47], v[56:59]
s_waitcnt vmcnt(6)
v_readfirstlane_b32 s56, v100
s_cmp_eq_u32 s30, 1
s_cbranch_scc1 mega_kernel_q_kf0
s_cmp_gt_i32 s56, s42
s_cbranch_scc0 mega_kernel_q_kf0
s_mov_b32 s30, 1
s_mov_b32 m0, s61
s_nop 0
buffer_load_dwordx4 v5, s[84:87], s68 offen sc1 lds
mega_kernel_q_kf0:
v_mfma_f32_16x16x32_bf16 v[60:63], a[216:219], v[48:51], v[60:63]
ds_read_b128 v[40:43], v8 offset:63488
v_mfma_f32_16x16x32_bf16 v[64:67], a[220:223], v[48:51], v[64:67]
s_waitcnt lgkmcnt(4)
v_mfma_f32_16x16x32_bf16 v[52:55], a[224:227], v[20:23], v[52:55]
ds_read_b128 v[44:47], v9 offset:61440
v_mfma_f32_16x16x32_bf16 v[56:59], a[228:231], v[20:23], v[56:59]
v_mfma_f32_16x16x32_bf16 v[60:63], a[224:227], v[24:27], v[60:63]
ds_read_b128 v[48:51], v9 offset:63488
v_mfma_f32_16x16x32_bf16 v[64:67], a[228:231], v[24:27], v[64:67]
s_waitcnt lgkmcnt(5)
v_mfma_f32_16x16x32_bf16 v[52:55], a[232:235], v[28:31], v[52:55]
v_mfma_f32_16x16x32_bf16 v[56:59], a[236:239], v[28:31], v[56:59]
s_waitcnt lgkmcnt(4)
v_mfma_f32_16x16x32_bf16 v[60:63], a[232:235], v[32:35], v[60:63]
v_mfma_f32_16x16x32_bf16 v[64:67], a[236:239], v[32:35], v[64:67]
s_waitcnt lgkmcnt(3)
v_mfma_f32_16x16x32_bf16 v[52:55], a[240:243], v[36:39], v[52:55]
v_mfma_f32_16x16x32_bf16 v[56:59], a[244:247], v[36:39], v[56:59]
s_waitcnt lgkmcnt(2)
v_mfma_f32_16x16x32_bf16 v[60:63], a[240:243], v[40:43], v[60:63]
v_mfma_f32_16x16x32_bf16 v[64:67], a[244:247], v[40:43], v[64:67]
ds_write_b128 v101, v[84:87]
ds_write_b128 v101, v[88:91] offset:1024
s_waitcnt lgkmcnt(1)
v_mfma_f32_16x16x32_bf16 v[68:71], a[248:251], v[44:47], v[52:55]
v_mfma_f32_16x16x32_bf16 v[72:75], a[252:255], v[44:47], v[56:59]
s_waitcnt lgkmcnt(0)
v_mfma_f32_16x16x32_bf16 v[76:79], a[248:251], v[48:51], v[60:63]
v_mfma_f32_16x16x32_bf16 v[80:83], a[252:255], v[48:51], v[64:67]
mega_kernel_q_jl0:
s_cmp_eq_u32 s30, 1
s_cbranch_scc1 mega_kernel_q_kl0
mega_kernel_q_kw0:
v_mov_b32 v100, 0
s_mov_b64 exec, 1
buffer_atomic_add v100, v16, s[84:87], s62 offen sc0 sc1
s_mov_b64 exec, -1
s_waitcnt vmcnt(0)
v_readfirstlane_b32 s56, v100
s_cmp_gt_i32 s56, s42
s_cbranch_scc1 mega_kernel_q_kv0
s_cmp_eq_u32 s42, 63
s_cbranch_scc1 mega_kernel_q_kw0
s_branch mega_kernel_q_kw0
mega_kernel_q_kv0:
s_mov_b32 m0, s61
s_nop 0
buffer_load_dwordx4 v5, s[84:87], s68 offen sc1 lds
mega_kernel_q_kl0:
s_waitcnt lgkmcnt(0) vmcnt(0)
s_barrier
ds_read_b128 v[184:187], v102 offset:0
ds_read_b128 v[112:115], v103 offset:0
ds_read_b128 v[128:131], v103 offset:1024
ds_read_b128 v[188:191], v102 offset:2048
ds_read_b128 v[116:119], v103 offset:2048
ds_read_b128 v[132:135], v103 offset:3072
ds_read_b128 v[192:195], v102 offset:4096
ds_read_b128 v[120:123], v103 offset:4096
ds_read_b128 v[136:139], v103 offset:5120
ds_read_b128 v[196:199], v102 offset:6144
ds_read_b128 v[124:127], v103 offset:6144
ds_read_b128 v[140:143], v103 offset:7168
s_waitcnt lgkmcnt(9)
v_mfma_f32_16x16x32_bf16 v[200:203], v[112:115], v[184:187], 0
v_mfma_f32_16x16x32_bf16 v[204:207], v[128:131], v[184:187], 0
ds_read_b128 v[160:163], v94 offset:0
s_waitcnt lgkmcnt(7)
v_mfma_f32_16x16x32_bf16 v[200:203], v[116:119], v[188:191], v[200:203]
v_mfma_f32_16x16x32_bf16 v[204:207], v[132:135], v[188:191], v[204:207]
ds_read_b128 v[164:167], v94 offset:1024
s_waitcnt lgkmcnt(5)
v_mfma_f32_16x16x32_bf16 v[200:203], v[120:123], v[192:195], v[200:203]
v_mfma_f32_16x16x32_bf16 v[204:207], v[136:139], v[192:195], v[204:207]
ds_read_b128 v[168:171], v94 offset:2048
s_waitcnt lgkmcnt(3)
v_mfma_f32_16x16x32_bf16 v[200:203], v[124:127], v[196:199], v[200:203]
v_mfma_f32_16x16x32_bf16 v[204:207], v[140:143], v[196:199], v[204:207]
ds_read_b128 v[172:175], v94 offset:3072
s_waitcnt lgkmcnt(3)
v_mfma_f32_16x16x32_bf16 v[208:211], v[160:163], v[184:187], 0
ds_read_b128 v[144:147], v240 offset:0
ds_read_b64 v[176:177], v95 offset:0
s_waitcnt lgkmcnt(4)
v_mfma_f32_16x16x32_bf16 v[208:211], v[164:167], v[188:191], v[208:211]
ds_read_b128 v[148:151], v240 offset:1024
ds_read_b64 v[178:179], v95 offset:256
s_waitcnt lgkmcnt(5)
v_mfma_f32_16x16x32_bf16 v[208:211], v[168:171], v[192:195], v[208:211]
ds_read_b128 v[152:155], v240 offset:2048
ds_read_b64 v[180:181], v95 offset:1024
s_waitcnt lgkmcnt(6)
v_mfma_f32_16x16x32_bf16 v[208:211], v[172:175], v[196:199], v[208:211]
ds_read_b128 v[156:159], v240 offset:3072
ds_read_b64 v[182:183], v95 offset:1280
mega_kernel_q_sm0:
v_pk_mul_f32 v[200:201], v[200:201], s[54:55] op_sel_hi:[1,0]
v_pk_mul_f32 v[202:203], v[202:203], s[54:55] op_sel_hi:[1,0]
v_pk_mul_f32 v[204:205], v[204:205], s[54:55] op_sel_hi:[1,0]
v_pk_mul_f32 v[206:207], v[206:207], s[54:55] op_sel_hi:[1,0]
v_cndmask_b32 v200, v200, v241, s[12:13]
v_cndmask_b32 v201, v201, v241, s[14:15]
v_cndmask_b32 v202, v202, v241, s[16:17]
v_cndmask_b32 v203, v203, v241, s[18:19]
v_cndmask_b32 v204, v204, v241, s[20:21]
v_cndmask_b32 v205, v205, v241, s[22:23]
v_cndmask_b32 v206, v206, v241, s[24:25]
v_cndmask_b32 v207, v207, v241, s[26:27]
v_pk_mul_f32 v[208:209], v[208:209], s[54:55] op_sel_hi:[1,0]
v_pk_mul_f32 v[210:211], v[210:211], s[54:55] op_sel_hi:[1,0]
v_cndmask_b32 v208, v208, v97, s[28:29]
v_cndmask_b32 v209, v209, v97, s[28:29]
v_cndmask_b32 v210, v210, v97, s[28:29]
v_cndmask_b32 v211, v211, v97, s[28:29]
v_max3_f32 v236, v200, v201, v202
v_max3_f32 v236, v236, v203, v204
v_max3_f32 v236, v236, v205, v206
v_max3_f32 v236, v236, v207, v208
v_max3_f32 v236, v236, v209, v210
v_max_f32 v237, v236, v211
v_max_f32 v236, v236, v211
s_nop 1
v_permlane16_swap_b32 v236, v237
s_nop 0
v_max_f32 v238, v236, v237
v_max_f32 v239, v236, v237
s_nop 1
v_permlane32_swap_b32 v238, v239
s_nop 0
v_max_f32 v236, v238, v239
v_pk_add_f32 v[200:201], v[200:201], v[236:237] op_sel_hi:[1,0] neg_lo:[0,1] neg_hi:[0,1]
v_pk_add_f32 v[202:203], v[202:203], v[236:237] op_sel_hi:[1,0] neg_lo:[0,1] neg_hi:[0,1]
v_pk_add_f32 v[204:205], v[204:205], v[236:237] op_sel_hi:[1,0] neg_lo:[0,1] neg_hi:[0,1]
v_pk_add_f32 v[206:207], v[206:207], v[236:237] op_sel_hi:[1,0] neg_lo:[0,1] neg_hi:[0,1]
v_pk_add_f32 v[208:209], v[208:209], v[236:237] op_sel_hi:[1,0] neg_lo:[0,1] neg_hi:[0,1]
v_pk_add_f32 v[210:211], v[210:211], v[236:237] op_sel_hi:[1,0] neg_lo:[0,1] neg_hi:[0,1]
v_exp_f32 v200, v200
v_exp_f32 v201, v201
v_exp_f32 v202, v202
v_exp_f32 v203, v203
v_exp_f32 v204, v204
v_exp_f32 v205, v205
v_exp_f32 v206, v206
v_exp_f32 v207, v207
v_exp_f32 v208, v208
v_exp_f32 v209, v209
v_exp_f32 v210, v210
v_exp_f32 v211, v211
s_nop 0
v_cvt_pk_bf16_f32 v212, v200, v201
v_cvt_pk_bf16_f32 v213, v202, v203
v_cvt_pk_bf16_f32 v214, v204, v205
v_cvt_pk_bf16_f32 v215, v206, v207
v_cvt_pk_bf16_f32 v216, v208, v209
v_cvt_pk_bf16_f32 v217, v210, v211
s_waitcnt lgkmcnt(0)
s_nop 0
v_mfma_f32_16x16x32_bf16 v[108:111], v[104:107], v[212:215], 0
v_mfma_f32_16x16x32_bf16 v[112:115], v[144:147], v[212:215], 0
v_mfma_f32_16x16x32_bf16 v[116:119], v[148:151], v[212:215], 0
v_mfma_f32_16x16x32_bf16 v[120:123], v[152:155], v[212:215], 0
v_mfma_f32_16x16x32_bf16 v[124:127], v[156:159], v[212:215], 0
v_mfma_f32_16x16x16_bf16 v[108:111], v[104:105], v[216:217], v[108:111]
v_mfma_f32_16x16x16_bf16 v[112:115], v[176:177], v[216:217], v[112:115]
v_mfma_f32_16x16x16_bf16 v[116:119], v[178:179], v[216:217], v[116:119]
v_mfma_f32_16x16x16_bf16 v[120:123], v[180:181], v[216:217], v[120:123]
v_mfma_f32_16x16x16_bf16 v[124:127], v[182:183], v[216:217], v[124:127]
s_lshr_b32 s63, s42, 2
s_xnor_b32 s63, s63, s98
s_and_b32 s63, s63, 1
s_lshl_b32 s63, s63, 13
s_lshl_b32 s51, s42, 19
s_add_u32 s51, s51, s63
s_nop 2
v_rcp_f32 v238, v108
v_rcp_f32 v239, v109
s_nop 1
v_pk_mul_f32 v[112:113], v[112:113], v[238:239]
v_pk_mul_f32 v[114:115], v[114:115], v[238:239]
v_pk_mul_f32 v[116:117], v[116:117], v[238:239]
v_pk_mul_f32 v[118:119], v[118:119], v[238:239]
v_pk_mul_f32 v[120:121], v[120:121], v[238:239]
v_pk_mul_f32 v[122:123], v[122:123], v[238:239]
v_pk_mul_f32 v[124:125], v[124:125], v[238:239]
v_pk_mul_f32 v[126:127], v[126:127], v[238:239]
v_cvt_pk_bf16_f32 v200, v112, v113
v_cvt_pk_bf16_f32 v201, v114, v115
v_cvt_pk_bf16_f32 v202, v116, v117
v_cvt_pk_bf16_f32 v203, v118, v119
v_cvt_pk_bf16_f32 v204, v120, v121
v_cvt_pk_bf16_f32 v205, v122, v123
v_cvt_pk_bf16_f32 v206, v124, v125
v_cvt_pk_bf16_f32 v207, v126, v127
buffer_store_dwordx4 v[200:203], v96, s[84:87], s51 offen sc1
buffer_store_dwordx4 v[204:207], v96, s[84:87], s51 offen offset:2048 sc1
s_add_u32 s42, s42, 1
s_cmp_lt_u32 s42, 64
s_cbranch_scc1 mega_kernel_q_loop
s_waitcnt vmcnt(0)
v_mov_b32 v17, s42
s_mov_b64 exec, 1
buffer_store_dword v17, v16, s[84:87], s49 offen sc1
s_mov_b64 exec, -1
mega_kernel_q_quit:
s_endpgm
mega_kernel_rd:
s_mov_b32 s93, s40
s_load_dwordx2 s[4:5], s[0:1], 56
s_mov_b32 s48, 0x3f7ec46d
s_mov_b32 s49, 0x3dc8bd36
s_mov_b32 s50, 0x3f7b14be
s_mov_b32 s51, 0x3e47c5c2
s_mov_b32 s52, 0x3f74fa0b
s_mov_b32 s53, 0x3e94a031
s_mov_b32 s54, 0x3f6c835e
s_mov_b32 s55, 0x3ec3ef15
s_mov_b32 s56, 0x3f61c598
s_mov_b32 s57, 0x3ef15aea
s_mov_b32 s58, 0x3f54db31
s_mov_b32 s59, 0x3f0e39da
s_mov_b32 s60, 0x3f45e403
s_mov_b32 s61, 0x3f226799
s_mov_b32 s62, 0x3f3504f3
s_mov_b32 s63, 0x3f3504f3
v_and_b32 v1, 31, v0
v_lshrrev_b32 v2, 5, v0
v_cvt_f32_u32 v3, v1
v_mul_u32_u24 v10, 8448, v2
v_lshl_add_u32 v4, v1, 3, v10
v_mul_u32_u24 v5, 264, v1
v_add_u32 v5, v5, v10
v_and_b32 v11, 7, v0
v_lshrrev_b32 v9, 3, v0
v_mul_u32_u24 v10, 8448, v11
v_lshl_add_u32 v6, v9, 3, v10
v_lshlrev_b32 v7, 3, v9
v_sub_u32 v7, v10, v7
v_add_u32 v7, 4096, v7
v_mul_u32_u24 v8, 32768, v9
v_lshl_add_u32 v8, v11, 4, v8
v_mul_f32 v12, 0xba800000, v3
v_cos_f32 v82, v12
v_sin_f32 v83, v12
v_mul_f32 v12, 0xbb000000, v3
v_cos_f32 v84, v12
v_sin_f32 v85, v12
v_mul_f32 v12, 0xbb400000, v3
v_cos_f32 v86, v12
v_sin_f32 v87, v12
v_mul_f32 v12, 0xbb800000, v3
v_cos_f32 v88, v12
v_sin_f32 v89, v12
v_mul_f32 v12, 0xbba00000, v3
v_cos_f32 v90, v12
v_sin_f32 v91, v12
v_mul_f32 v12, 0xbbc00000, v3
v_cos_f32 v92, v12
v_sin_f32 v93, v12
v_mul_f32 v12, 0xbbe00000, v3
v_cos_f32 v94, v12
v_sin_f32 v95, v12
v_mul_f32 v12, 0xbc000000, v3
v_cos_f32 v96, v12
v_sin_f32 v97, v12
v_mul_f32 v12, 0xbc100000, v3
v_cos_f32 v98, v12
v_sin_f32 v99, v12
v_mul_f32 v12, 0xbc200000, v3
v_cos_f32 v100, v12
v_sin_f32 v101, v12
v_mul_f32 v12, 0xbc300000, v3
v_cos_f32 v102, v12
v_sin_f32 v103, v12
v_mul_f32 v12, 0xbc400000, v3
v_cos_f32 v104, v12
v_sin_f32 v105, v12
v_mul_f32 v12, 0xbc500000, v3
v_cos_f32 v106, v12
v_sin_f32 v107, v12
v_mul_f32 v12, 0xbc600000, v3
v_cos_f32 v108, v12
v_sin_f32 v109, v12
v_mul_f32 v12, 0xbc700000, v3
v_cos_f32 v110, v12
v_sin_f32 v111, v12
v_mul_f32 v12, 0xbc800000, v3
v_cos_f32 v112, v12
v_sin_f32 v113, v12
v_mul_f32 v12, 0xbc880000, v3
v_cos_f32 v114, v12
v_sin_f32 v115, v12
v_mul_f32 v12, 0xbc900000, v3
v_cos_f32 v116, v12
v_sin_f32 v117, v12
v_mul_f32 v12, 0xbc980000, v3
v_cos_f32 v118, v12
v_sin_f32 v119, v12
v_mul_f32 v12, 0xbca00000, v3
v_cos_f32 v120, v12
v_sin_f32 v121, v12
v_mul_f32 v12, 0xbca80000, v3
v_cos_f32 v122, v12
v_sin_f32 v123, v12
v_mul_f32 v12, 0xbcb00000, v3
v_cos_f32 v124, v12
v_sin_f32 v125, v12
v_mul_f32 v12, 0xbcb80000, v3
v_cos_f32 v126, v12
v_sin_f32 v127, v12
v_mul_f32 v12, 0xbcc00000, v3
v_cos_f32 v128, v12
v_sin_f32 v129, v12
v_mul_f32 v12, 0xbcc80000, v3
v_cos_f32 v130, v12
v_sin_f32 v131, v12
v_mul_f32 v12, 0xbcd00000, v3
v_cos_f32 v132, v12
v_sin_f32 v133, v12
v_mul_f32 v12, 0xbcd80000, v3
v_cos_f32 v134, v12
v_sin_f32 v135, v12
v_mul_f32 v12, 0xbce00000, v3
v_cos_f32 v136, v12
v_sin_f32 v137, v12
v_mul_f32 v12, 0xbce80000, v3
v_cos_f32 v138, v12
v_sin_f32 v139, v12
v_mul_f32 v12, 0xbcf00000, v3
v_cos_f32 v140, v12
v_sin_f32 v141, v12
v_mul_f32 v12, 0xbcf80000, v3
v_cos_f32 v142, v12
v_sin_f32 v143, v12
v_lshlrev_b32 v12, 12, v2
v_lshl_add_u32 v12, v1, 1, v12
s_waitcnt lgkmcnt(0)
s_mov_b32 s6, 4194304
s_mov_b32 s7, 0x00020000
v_mov_b32 v144, 0
v_mov_b32 v145, 0
v_mov_b32 v146, 0
v_mov_b32 v147, 0
v_mov_b32 v148, 0
v_mov_b32 v149, 0
v_mov_b32 v150, 0
v_mov_b32 v151, 0
v_mov_b32 v152, 0
v_mov_b32 v153, 0
v_mov_b32 v154, 0
v_mov_b32 v155, 0
v_mov_b32 v156, 0
v_mov_b32 v157, 0
v_mov_b32 v158, 0
v_mov_b32 v159, 0
v_mov_b32 v160, 0
v_mov_b32 v161, 0
v_mov_b32 v162, 0
v_mov_b32 v163, 0
v_mov_b32 v164, 0
v_mov_b32 v165, 0
v_mov_b32 v166, 0
v_mov_b32 v167, 0
v_mov_b32 v168, 0
v_mov_b32 v169, 0
v_mov_b32 v170, 0
v_mov_b32 v171, 0
v_mov_b32 v172, 0
v_mov_b32 v173, 0
v_mov_b32 v174, 0
v_mov_b32 v175, 0
v_mov_b32 v176, 0
v_mov_b32 v177, 0
v_mov_b32 v178, 0
v_mov_b32 v179, 0
v_mov_b32 v180, 0
v_mov_b32 v181, 0
v_mov_b32 v182, 0
v_mov_b32 v183, 0
v_mov_b32 v184, 0
v_mov_b32 v185, 0
v_mov_b32 v186, 0
v_mov_b32 v187, 0
v_mov_b32 v188, 0
v_mov_b32 v189, 0
v_mov_b32 v190, 0
v_mov_b32 v191, 0
v_mov_b32 v192, 0
v_mov_b32 v193, 0
v_mov_b32 v194, 0
v_mov_b32 v195, 0
v_mov_b32 v196, 0
v_mov_b32 v197, 0
v_mov_b32 v198, 0
v_mov_b32 v199, 0
v_mov_b32 v200, 0
v_mov_b32 v201, 0
v_mov_b32 v202, 0
v_mov_b32 v203, 0
v_mov_b32 v204, 0
v_mov_b32 v205, 0
v_mov_b32 v206, 0
v_mov_b32 v207, 0
s_cmp_lt_u32 s93, 128
s_cbranch_scc0 mega_kernel_f1_e
s_lshl_b32 s12, s93, 15
buffer_load_short_d16_hi v144, v12, s[4:7], s12 offen offset:0
buffer_load_short_d16_hi v145, v12, s[4:7], s12 offen offset:2048
buffer_load_short_d16_hi v176, v12, s[4:7], s12 offen offset:1024
buffer_load_short_d16_hi v177, v12, s[4:7], s12 offen offset:3072
buffer_load_short_d16_hi v146, v12, s[4:7], s12 offen offset:64
buffer_load_short_d16_hi v147, v12, s[4:7], s12 offen offset:2112
buffer_load_short_d16_hi v178, v12, s[4:7], s12 offen offset:1088
buffer_load_short_d16_hi v179, v12, s[4:7], s12 offen offset:3136
buffer_load_short_d16_hi v148, v12, s[4:7], s12 offen offset:128
buffer_load_short_d16_hi v149, v12, s[4:7], s12 offen offset:2176
buffer_load_short_d16_hi v180, v12, s[4:7], s12 offen offset:1152
buffer_load_short_d16_hi v181, v12, s[4:7], s12 offen offset:3200
buffer_load_short_d16_hi v150, v12, s[4:7], s12 offen offset:192
buffer_load_short_d16_hi v151, v12, s[4:7], s12 offen offset:2240
buffer_load_short_d16_hi v182, v12, s[4:7], s12 offen offset:1216
buffer_load_short_d16_hi v183, v12, s[4:7], s12 offen offset:3264
buffer_load_short_d16_hi v152, v12, s[4:7], s12 offen offset:256
buffer_load_short_d16_hi v153, v12, s[4:7], s12 offen offset:2304
buffer_load_short_d16_hi v184, v12, s[4:7], s12 offen offset:1280
buffer_load_short_d16_hi v185, v12, s[4:7], s12 offen offset:3328
buffer_load_short_d16_hi v154, v12, s[4:7], s12 offen offset:320
buffer_load_short_d16_hi v155, v12, s[4:7], s12 offen offset:2368
buffer_load_short_d16_hi v186, v12, s[4:7], s12 offen offset:1344
buffer_load_short_d16_hi v187, v12, s[4:7], s12 offen offset:3392
buffer_load_short_d16_hi v156, v12, s[4:7], s12 offen offset:384
buffer_load_short_d16_hi v157, v12, s[4:7], s12 offen offset:2432
buffer_load_short_d16_hi v188, v12, s[4:7], s12 offen offset:1408
buffer_load_short_d16_hi v189, v12, s[4:7], s12 offen offset:3456
buffer_load_short_d16_hi v158, v12, s[4:7], s12 offen offset:448
buffer_load_short_d16_hi v159, v12, s[4:7], s12 offen offset:2496
buffer_load_short_d16_hi v190, v12, s[4:7], s12 offen offset:1472
buffer_load_short_d16_hi v191, v12, s[4:7], s12 offen offset:3520
buffer_load_short_d16_hi v160, v12, s[4:7], s12 offen offset:512
buffer_load_short_d16_hi v161, v12, s[4:7], s12 offen offset:2560
buffer_load_short_d16_hi v192, v12, s[4:7], s12 offen offset:1536
buffer_load_short_d16_hi v193, v12, s[4:7], s12 offen offset:3584
buffer_load_short_d16_hi v162, v12, s[4:7], s12 offen offset:576
buffer_load_short_d16_hi v163, v12, s[4:7], s12 offen offset:2624
buffer_load_short_d16_hi v194, v12, s[4:7], s12 offen offset:1600
buffer_load_short_d16_hi v195, v12, s[4:7], s12 offen offset:3648
buffer_load_short_d16_hi v164, v12, s[4:7], s12 offen offset:640
buffer_load_short_d16_hi v165, v12, s[4:7], s12 offen offset:2688
buffer_load_short_d16_hi v196, v12, s[4:7], s12 offen offset:1664
buffer_load_short_d16_hi v197, v12, s[4:7], s12 offen offset:3712
buffer_load_short_d16_hi v166, v12, s[4:7], s12 offen offset:704
buffer_load_short_d16_hi v167, v12, s[4:7], s12 offen offset:2752
buffer_load_short_d16_hi v198, v12, s[4:7], s12 offen offset:1728
buffer_load_short_d16_hi v199, v12, s[4:7], s12 offen offset:3776
buffer_load_short_d16_hi v168, v12, s[4:7], s12 offen offset:768
buffer_load_short_d16_hi v169, v12, s[4:7], s12 offen offset:2816
buffer_load_short_d16_hi v200, v12, s[4:7], s12 offen offset:1792
buffer_load_short_d16_hi v201, v12, s[4:7], s12 offen offset:3840
buffer_load_short_d16_hi v170, v12, s[4:7], s12 offen offset:832
buffer_load_short_d16_hi v171, v12, s[4:7], s12 offen offset:2880
buffer_load_short_d16_hi v202, v12, s[4:7], s12 offen offset:1856
buffer_load_short_d16_hi v203, v12, s[4:7], s12 offen offset:3904
buffer_load_short_d16_hi v172, v12, s[4:7], s12 offen offset:896
buffer_load_short_d16_hi v173, v12, s[4:7], s12 offen offset:2944
buffer_load_short_d16_hi v204, v12, s[4:7], s12 offen offset:1920
buffer_load_short_d16_hi v205, v12, s[4:7], s12 offen offset:3968
buffer_load_short_d16_hi v174, v12, s[4:7], s12 offen offset:960
buffer_load_short_d16_hi v175, v12, s[4:7], s12 offen offset:3008
buffer_load_short_d16_hi v206, v12, s[4:7], s12 offen offset:1984
buffer_load_short_d16_hi v207, v12, s[4:7], s12 offen offset:4032
s_waitcnt vmcnt(0)
mega_kernel_f1_l:
s_add_u32 s21, s93, 32
s_cmp_lt_u32 s21, 128
s_cselect_b32 s22, s21, s93
s_waitcnt vmcnt(17)
v_pk_add_f32 v[48:49], v[144:145], v[176:177] neg_lo:[0,1] neg_hi:[0,1]
v_pk_add_f32 v[16:17], v[144:145], v[176:177]
v_pk_add_f32 v[14:15], v[146:147], v[178:179] neg_lo:[0,1] neg_hi:[0,1]
v_pk_add_f32 v[18:19], v[146:147], v[178:179]
v_pk_mul_f32 v[50:51], v[14:15], s[50:51] op_sel:[0,0] op_sel_hi:[0,1] neg_lo:[0,0] neg_hi:[0,1]
v_pk_fma_f32 v[50:51], v[14:15], s[50:51], v[50:51] op_sel:[1,1,0] op_sel_hi:[1,0,1] neg_lo:[0,0,0] neg_hi:[0,0,0]
v_pk_add_f32 v[14:15], v[148:149], v[180:181] neg_lo:[0,1] neg_hi:[0,1]
v_pk_add_f32 v[20:21], v[148:149], v[180:181]
v_pk_mul_f32 v[52:53], v[14:15], s[54:55] op_sel:[0,0] op_sel_hi:[0,1] neg_lo:[0,0] neg_hi:[0,1]
v_pk_fma_f32 v[52:53], v[14:15], s[54:55], v[52:53] op_sel:[1,1,0] op_sel_hi:[1,0,1] neg_lo:[0,0,0] neg_hi:[0,0,0]
v_pk_add_f32 v[14:15], v[150:151], v[182:183] neg_lo:[0,1] neg_hi:[0,1]
v_pk_add_f32 v[22:23], v[150:151], v[182:183]
v_pk_mul_f32 v[54:55], v[14:15], s[58:59] op_sel:[0,0] op_sel_hi:[0,1] neg_lo:[0,0] neg_hi:[0,1]
v_pk_fma_f32 v[54:55], v[14:15], s[58:59], v[54:55] op_sel:[1,1,0] op_sel_hi:[1,0,1] neg_lo:[0,0,0] neg_hi:[0,0,0]
v_pk_add_f32 v[14:15], v[152:153], v[184:185] neg_lo:[0,1] neg_hi:[0,1]
v_pk_add_f32 v[24:25], v[152:153], v[184:185]
v_pk_mul_f32 v[56:57], v[14:15], s[62:63] op_sel:[0,0] op_sel_hi:[0,1] neg_lo:[0,0] neg_hi:[0,1]
v_pk_fma_f32 v[56:57], v[14:15], s[62:63], v[56:57] op_sel:[1,1,0] op_sel_hi:[1,0,1] neg_lo:[0,0,0] neg_hi:[0,0,0]
v_pk_add_f32 v[14:15], v[154:155], v[186:187] neg_lo:[0,1] neg_hi:[0,1]
v_pk_add_f32 v[26:27], v[154:155], v[186:187]
v_pk_mul_f32 v[58:59], v[14:15], s[58:59] op_sel:[0,1] op_sel_hi:[0,0] neg_lo:[0,0] neg_hi:[0,1]
v_pk_fma_f32 v[58:59], v[14:15], s[58:59], v[58:59] op_sel:[1,0,0] op_sel_hi:[1,1,1] neg_lo:[0,0,0] neg_hi:[0,0,0]
v_pk_add_f32 v[14:15], v[156:157], v[188:189] neg_lo:[0,1] neg_hi:[0,1]
v_pk_add_f32 v[28:29], v[156:157], v[188:189]
v_pk_mul_f32 v[60:61], v[14:15], s[54:55] op_sel:[0,1] op_sel_hi:[0,0] neg_lo:[0,0] neg_hi:[0,1]
v_pk_fma_f32 v[60:61], v[14:15], s[54:55], v[60:61] op_sel:[1,0,0] op_sel_hi:[1,1,1] neg_lo:[0,0,0] neg_hi:[0,0,0]
v_pk_add_f32 v[14:15], v[158:159], v[190:191] neg_lo:[0,1] neg_hi:[0,1]
v_pk_add_f32 v[30:31], v[158:159], v[190:191]
v_pk_mul_f32 v[62:63], v[14:15], s[50:51] op_sel:[0,1] op_sel_hi:[0,0] neg_lo:[0,0] neg_hi:[0,1]
v_pk_fma_f32 v[62:63], v[14:15], s[50:51], v[62:63] op_sel:[1,0,0] op_sel_hi:[1,1,1] neg_lo:[0,0,0] neg_hi:[0,0,0]
v_pk_add_f32 v[64:65], v[160:161], v[192:193] op_sel:[1,1] op_sel_hi:[0,0] neg_lo:[0,1] neg_hi:[1,0]
v_pk_add_f32 v[32:33], v[160:161], v[192:193]
v_pk_add_f32 v[14:15], v[162:163], v[194:195] neg_lo:[0,1] neg_hi:[0,1]
v_pk_add_f32 v[34:35], v[162:163], v[194:195]
v_pk_mul_f32 v[66:67], v[14:15], s[50:51] op_sel:[0,1] op_sel_hi:[0,0] neg_lo:[0,1] neg_hi:[0,1]
v_pk_fma_f32 v[66:67], v[14:15], s[50:51], v[66:67] op_sel:[1,0,0] op_sel_hi:[1,1,1] neg_lo:[0,0,0] neg_hi:[0,1,0]
v_pk_add_f32 v[14:15], v[164:165], v[196:197] neg_lo:[0,1] neg_hi:[0,1]
v_pk_add_f32 v[36:37], v[164:165], v[196:197]
v_pk_mul_f32 v[68:69], v[14:15], s[54:55] op_sel:[0,1] op_sel_hi:[0,0] neg_lo:[0,1] neg_hi:[0,1]
v_pk_fma_f32 v[68:69], v[14:15], s[54:55], v[68:69] op_sel:[1,0,0] op_sel_hi:[1,1,1] neg_lo:[0,0,0] neg_hi:[0,1,0]
v_pk_add_f32 v[14:15], v[166:167], v[198:199] neg_lo:[0,1] neg_hi:[0,1]
v_pk_add_f32 v[38:39], v[166:167], v[198:199]
v_pk_mul_f32 v[70:71], v[14:15], s[58:59] op_sel:[0,1] op_sel_hi:[0,0] neg_lo:[0,1] neg_hi:[0,1]
v_pk_fma_f32 v[70:71], v[14:15], s[58:59], v[70:71] op_sel:[1,0,0] op_sel_hi:[1,1,1] neg_lo:[0,0,0] neg_hi:[0,1,0]
v_pk_add_f32 v[14:15], v[168:169], v[200:201] neg_lo:[0,1] neg_hi:[0,1]
v_pk_add_f32 v[40:41], v[168:169], v[200:201]
v_pk_mul_f32 v[72:73], v[14:15], s[62:63] op_sel:[0,0] op_sel_hi:[0,1] neg_lo:[0,1] neg_hi:[0,1]
v_pk_fma_f32 v[72:73], v[14:15], s[62:63], v[72:73] op_sel:[1,1,0] op_sel_hi:[1,0,1] neg_lo:[0,0,0] neg_hi:[0,1,0]
v_pk_add_f32 v[14:15], v[170:171], v[202:203] neg_lo:[0,1] neg_hi:[0,1]
v_pk_add_f32 v[42:43], v[170:171], v[202:203]
v_pk_mul_f32 v[74:75], v[14:15], s[58:59] op_sel:[0,0] op_sel_hi:[0,1] neg_lo:[0,1] neg_hi:[0,1]
v_pk_fma_f32 v[74:75], v[14:15], s[58:59], v[74:75] op_sel:[1,1,0] op_sel_hi:[1,0,1] neg_lo:[0,0,0] neg_hi:[0,1,0]
v_pk_add_f32 v[14:15], v[172:173], v[204:205] neg_lo:[0,1] neg_hi:[0,1]
v_pk_add_f32 v[44:45], v[172:173], v[204:205]
v_pk_mul_f32 v[76:77], v[14:15], s[54:55] op_sel:[0,0] op_sel_hi:[0,1] neg_lo:[0,1] neg_hi:[0,1]
v_pk_fma_f32 v[76:77], v[14:15], s[54:55], v[76:77] op_sel:[1,1,0] op_sel_hi:[1,0,1] neg_lo:[0,0,0] neg_hi:[0,1,0]
v_pk_add_f32 v[14:15], v[174:175], v[206:207] neg_lo:[0,1] neg_hi:[0,1]
v_pk_add_f32 v[46:47], v[174:175], v[206:207]
v_pk_mul_f32 v[78:79], v[14:15], s[50:51] op_sel:[0,0] op_sel_hi:[0,1] neg_lo:[0,1] neg_hi:[0,1]
v_pk_fma_f32 v[78:79], v[14:15], s[50:51], v[78:79] op_sel:[1,1,0] op_sel_hi:[1,0,1] neg_lo:[0,0,0] neg_hi:[0,1,0]
s_lshl_b32 s12, s22, 15
buffer_load_short_d16_hi v144, v12, s[4:7], s12 offen offset:0
buffer_load_short_d16_hi v145, v12, s[4:7], s12 offen offset:2048
buffer_load_short_d16_hi v176, v12, s[4:7], s12 offen offset:1024
buffer_load_short_d16_hi v177, v12, s[4:7], s12 offen offset:3072
buffer_load_short_d16_hi v146, v12, s[4:7], s12 offen offset:64
buffer_load_short_d16_hi v147, v12, s[4:7], s12 offen offset:2112
buffer_load_short_d16_hi v178, v12, s[4:7], s12 offen offset:1088
buffer_load_short_d16_hi v179, v12, s[4:7], s12 offen offset:3136
buffer_load_short_d16_hi v148, v12, s[4:7], s12 offen offset:128
buffer_load_short_d16_hi v149, v12, s[4:7], s12 offen offset:2176
buffer_load_short_d16_hi v180, v12, s[4:7], s12 offen offset:1152
buffer_load_short_d16_hi v181, v12, s[4:7], s12 offen offset:3200
buffer_load_short_d16_hi v150, v12, s[4:7], s12 offen offset:192
buffer_load_short_d16_hi v151, v12, s[4:7], s12 offen offset:2240
buffer_load_short_d16_hi v182, v12, s[4:7], s12 offen offset:1216
buffer_load_short_d16_hi v183, v12, s[4:7], s12 offen offset:3264
buffer_load_short_d16_hi v152, v12, s[4:7], s12 offen offset:256
buffer_load_short_d16_hi v153, v12, s[4:7], s12 offen offset:2304
buffer_load_short_d16_hi v184, v12, s[4:7], s12 offen offset:1280
buffer_load_short_d16_hi v185, v12, s[4:7], s12 offen offset:3328
buffer_load_short_d16_hi v154, v12, s[4:7], s12 offen offset:320
buffer_load_short_d16_hi v155, v12, s[4:7], s12 offen offset:2368
buffer_load_short_d16_hi v186, v12, s[4:7], s12 offen offset:1344
buffer_load_short_d16_hi v187, v12, s[4:7], s12 offen offset:3392
buffer_load_short_d16_hi v156, v12, s[4:7], s12 offen offset:384
buffer_load_short_d16_hi v157, v12, s[4:7], s12 offen offset:2432
buffer_load_short_d16_hi v188, v12, s[4:7], s12 offen offset:1408
buffer_load_short_d16_hi v189, v12, s[4:7], s12 offen offset:3456
buffer_load_short_d16_hi v158, v12, s[4:7], s12 offen offset:448
buffer_load_short_d16_hi v159, v12, s[4:7], s12 offen offset:2496
buffer_load_short_d16_hi v190, v12, s[4:7], s12 offen offset:1472
buffer_load_short_d16_hi v191, v12, s[4:7], s12 offen offset:3520
buffer_load_short_d16_hi v160, v12, s[4:7], s12 offen offset:512
buffer_load_short_d16_hi v161, v12, s[4:7], s12 offen offset:2560
buffer_load_short_d16_hi v192, v12, s[4:7], s12 offen offset:1536
buffer_load_short_d16_hi v193, v12, s[4:7], s12 offen offset:3584
buffer_load_short_d16_hi v162, v12, s[4:7], s12 offen offset:576
buffer_load_short_d16_hi v163, v12, s[4:7], s12 offen offset:2624
buffer_load_short_d16_hi v194, v12, s[4:7], s12 offen offset:1600
buffer_load_short_d16_hi v195, v12, s[4:7], s12 offen offset:3648
buffer_load_short_d16_hi v164, v12, s[4:7], s12 offen offset:640
buffer_load_short_d16_hi v165, v12, s[4:7], s12 offen offset:2688
buffer_load_short_d16_hi v196, v12, s[4:7], s12 offen offset:1664
buffer_load_short_d16_hi v197, v12, s[4:7], s12 offen offset:3712
buffer_load_short_d16_hi v166, v12, s[4:7], s12 offen offset:704
buffer_load_short_d16_hi v167, v12, s[4:7], s12 offen offset:2752
buffer_load_short_d16_hi v198, v12, s[4:7], s12 offen offset:1728
buffer_load_short_d16_hi v199, v12, s[4:7], s12 offen offset:3776
buffer_load_short_d16_hi v168, v12, s[4:7], s12 offen offset:768
buffer_load_short_d16_hi v169, v12, s[4:7], s12 offen offset:2816
buffer_load_short_d16_hi v200, v12, s[4:7], s12 offen offset:1792
buffer_load_short_d16_hi v201, v12, s[4:7], s12 offen offset:3840
buffer_load_short_d16_hi v170, v12, s[4:7], s12 offen offset:832
buffer_load_short_d16_hi v171, v12, s[4:7], s12 offen offset:2880
buffer_load_short_d16_hi v202, v12, s[4:7], s12 offen offset:1856
buffer_load_short_d16_hi v203, v12, s[4:7], s12 offen offset:3904
buffer_load_short_d16_hi v172, v12, s[4:7], s12 offen offset:896
buffer_load_short_d16_hi v173, v12, s[4:7], s12 offen offset:2944
buffer_load_short_d16_hi v204, v12, s[4:7], s12 offen offset:1920
buffer_load_short_d16_hi v205, v12, s[4:7], s12 offen offset:3968
buffer_load_short_d16_hi v174, v12, s[4:7], s12 offen offset:960
buffer_load_short_d16_hi v175, v12, s[4:7], s12 offen offset:3008
buffer_load_short_d16_hi v206, v12, s[4:7], s12 offen offset:1984
buffer_load_short_d16_hi v207, v12, s[4:7], s12 offen offset:4032
v_pk_add_f32 v[14:15], v[16:17], v[32:33] neg_lo:[0,1] neg_hi:[0,1]
v_pk_add_f32 v[16:17], v[16:17], v[32:33]
v_pk_add_f32 v[32:33], v[18:19], v[34:35] neg_lo:[0,1] neg_hi:[0,1]
v_pk_add_f32 v[18:19], v[18:19], v[34:35]
v_pk_mul_f32 v[34:35], v[32:33], s[54:55] op_sel:[0,0] op_sel_hi:[0,1] neg_lo:[0,0] neg_hi:[0,1]
v_pk_fma_f32 v[34:35], v[32:33], s[54:55], v[34:35] op_sel:[1,1,0] op_sel_hi:[1,0,1] neg_lo:[0,0,0] neg_hi:[0,0,0]
v_pk_add_f32 v[32:33], v[20:21], v[36:37] neg_lo:[0,1] neg_hi:[0,1]
v_pk_add_f32 v[20:21], v[20:21], v[36:37]
v_pk_mul_f32 v[36:37], v[32:33], s[62:63] op_sel:[0,0] op_sel_hi:[0,1] neg_lo:[0,0] neg_hi:[0,1]
v_pk_fma_f32 v[36:37], v[32:33], s[62:63], v[36:37] op_sel:[1,1,0] op_sel_hi:[1,0,1] neg_lo:[0,0,0] neg_hi:[0,0,0]
v_pk_add_f32 v[32:33], v[22:23], v[38:39] neg_lo:[0,1] neg_hi:[0,1]
v_pk_add_f32 v[22:23], v[22:23], v[38:39]
v_pk_mul_f32 v[38:39], v[32:33], s[54:55] op_sel:[0,1] op_sel_hi:[0,0] neg_lo:[0,0] neg_hi:[0,1]
v_pk_fma_f32 v[38:39], v[32:33], s[54:55], v[38:39] op_sel:[1,0,0] op_sel_hi:[1,1,1] neg_lo:[0,0,0] neg_hi:[0,0,0]
v_pk_add_f32 v[32:33], v[24:25], v[40:41] op_sel:[1,1] op_sel_hi:[0,0] neg_lo:[0,1] neg_hi:[1,0]
v_pk_add_f32 v[24:25], v[24:25], v[40:41]
v_pk_add_f32 v[40:41], v[26:27], v[42:43] neg_lo:[0,1] neg_hi:[0,1]
v_pk_add_f32 v[26:27], v[26:27], v[42:43]
v_pk_mul_f32 v[42:43], v[40:41], s[54:55] op_sel:[0,1] op_sel_hi:[0,0] neg_lo:[0,1] neg_hi:[0,1]
v_pk_fma_f32 v[42:43], v[40:41], s[54:55], v[42:43] op_sel:[1,0,0] op_sel_hi:[1,1,1] neg_lo:[0,0,0] neg_hi:[0,1,0]
v_pk_add_f32 v[40:41], v[28:29], v[44:45] neg_lo:[0,1] neg_hi:[0,1]
v_pk_add_f32 v[28:29], v[28:29], v[44:45]
v_pk_mul_f32 v[44:45], v[40:41], s[62:63] op_sel:[0,0] op_sel_hi:[0,1] neg_lo:[0,1] neg_hi:[0,1]
v_pk_fma_f32 v[44:45], v[40:41], s[62:63], v[44:45] op_sel:[1,1,0] op_sel_hi:[1,0,1] neg_lo:[0,0,0] neg_hi:[0,1,0]
v_pk_add_f32 v[40:41], v[30:31], v[46:47] neg_lo:[0,1] neg_hi:[0,1]
v_pk_add_f32 v[30:31], v[30:31], v[46:47]
v_pk_mul_f32 v[46:47], v[40:41], s[54:55] op_sel:[0,0] op_sel_hi:[0,1] neg_lo:[0,1] neg_hi:[0,1]
v_pk_fma_f32 v[46:47], v[40:41], s[54:55], v[46:47] op_sel:[1,1,0] op_sel_hi:[1,0,1] neg_lo:[0,0,0] neg_hi:[0,1,0]
v_pk_add_f32 v[40:41], v[48:49], v[64:65] neg_lo:[0,1] neg_hi:[0,1]
v_pk_add_f32 v[48:49], v[48:49], v[64:65]
v_pk_add_f32 v[64:65], v[50:51], v[66:67] neg_lo:[0,1] neg_hi:[0,1]
v_pk_add_f32 v[50:51], v[50:51], v[66:67]
v_pk_mul_f32 v[66:67], v[64:65], s[54:55] op_sel:[0,0] op_sel_hi:[0,1] neg_lo:[0,0] neg_hi:[0,1]
v_pk_fma_f32 v[66:67], v[64:65], s[54:55], v[66:67] op_sel:[1,1,0] op_sel_hi:[1,0,1] neg_lo:[0,0,0] neg_hi:[0,0,0]
v_pk_add_f32 v[64:65], v[52:53], v[68:69] neg_lo:[0,1] neg_hi:[0,1]
v_pk_add_f32 v[52:53], v[52:53], v[68:69]
v_pk_mul_f32 v[68:69], v[64:65], s[62:63] op_sel:[0,0] op_sel_hi:[0,1] neg_lo:[0,0] neg_hi:[0,1]
v_pk_fma_f32 v[68:69], v[64:65], s[62:63], v[68:69] op_sel:[1,1,0] op_sel_hi:[1,0,1] neg_lo:[0,0,0] neg_hi:[0,0,0]
v_pk_add_f32 v[64:65], v[54:55], v[70:71] neg_lo:[0,1] neg_hi:[0,1]
v_pk_add_f32 v[54:55], v[54:55], v[70:71]
v_pk_mul_f32 v[70:71], v[64:65], s[54:55] op_sel:[0,1] op_sel_hi:[0,0] neg_lo:[0,0] neg_hi:[0,1]
v_pk_fma_f32 v[70:71], v[64:65], s[54:55], v[70:71] op_sel:[1,0,0] op_sel_hi:[1,1,1] neg_lo:[0,0,0] neg_hi:[0,0,0]
v_pk_add_f32 v[64:65], v[56:57], v[72:73] op_sel:[1,1] op_sel_hi:[0,0] neg_lo:[0,1] neg_hi:[1,0]
v_pk_add_f32 v[56:57], v[56:57], v[72:73]
v_pk_add_f32 v[72:73], v[58:59], v[74:75] neg_lo:[0,1] neg_hi:[0,1]
v_pk_add_f32 v[58:59], v[58:59], v[74:75]
v_pk_mul_f32 v[74:75], v[72:73], s[54:55] op_sel:[0,1] op_sel_hi:[0,0] neg_lo:[0,1] neg_hi:[0,1]
v_pk_fma_f32 v[74:75], v[72:73], s[54:55], v[74:75] op_sel:[1,0,0] op_sel_hi:[1,1,1] neg_lo:[0,0,0] neg_hi:[0,1,0]
v_pk_add_f32 v[72:73], v[60:61], v[76:77] neg_lo:[0,1] neg_hi:[0,1]
v_pk_add_f32 v[60:61], v[60:61], v[76:77]
v_pk_mul_f32 v[76:77], v[72:73], s[62:63] op_sel:[0,0] op_sel_hi:[0,1] neg_lo:[0,1] neg_hi:[0,1]
v_pk_fma_f32 v[76:77], v[72:73], s[62:63], v[76:77] op_sel:[1,1,0] op_sel_hi:[1,0,1] neg_lo:[0,0,0] neg_hi:[0,1,0]
v_pk_add_f32 v[72:73], v[62:63], v[78:79] neg_lo:[0,1] neg_hi:[0,1]
v_pk_add_f32 v[62:63], v[62:63], v[78:79]
v_pk_mul_f32 v[78:79], v[72:73], s[54:55] op_sel:[0,0] op_sel_hi:[0,1] neg_lo:[0,1] neg_hi:[0,1]
v_pk_fma_f32 v[78:79], v[72:73], s[54:55], v[78:79] op_sel:[1,1,0] op_sel_hi:[1,0,1] neg_lo:[0,0,0] neg_hi:[0,1,0]
v_pk_add_f32 v[72:73], v[16:17], v[24:25] neg_lo:[0,1] neg_hi:[0,1]
v_pk_add_f32 v[16:17], v[16:17], v[24:25]
v_pk_add_f32 v[24:25], v[18:19], v[26:27] neg_lo:[0,1] neg_hi:[0,1]
v_pk_add_f32 v[18:19], v[18:19], v[26:27]
v_pk_mul_f32 v[26:27], v[24:25], s[62:63] op_sel:[0,0] op_sel_hi:[0,1] neg_lo:[0,0] neg_hi:[0,1]
v_pk_fma_f32 v[26:27], v[24:25], s[62:63], v[26:27] op_sel:[1,1,0] op_sel_hi:[1,0,1] neg_lo:[0,0,0] neg_hi:[0,0,0]
v_pk_add_f32 v[24:25], v[20:21], v[28:29] op_sel:[1,1] op_sel_hi:[0,0] neg_lo:[0,1] neg_hi:[1,0]
v_pk_add_f32 v[20:21], v[20:21], v[28:29]
v_pk_add_f32 v[28:29], v[22:23], v[30:31] neg_lo:[0,1] neg_hi:[0,1]
v_pk_add_f32 v[22:23], v[22:23], v[30:31]
v_pk_mul_f32 v[30:31], v[28:29], s[62:63] op_sel:[0,0] op_sel_hi:[0,1] neg_lo:[0,1] neg_hi:[0,1]
v_pk_fma_f32 v[30:31], v[28:29], s[62:63], v[30:31] op_sel:[1,1,0] op_sel_hi:[1,0,1] neg_lo:[0,0,0] neg_hi:[0,1,0]
v_pk_add_f32 v[28:29], v[14:15], v[32:33] neg_lo:[0,1] neg_hi:[0,1]
v_pk_add_f32 v[14:15], v[14:15], v[32:33]
v_pk_add_f32 v[32:33], v[34:35], v[42:43] neg_lo:[0,1] neg_hi:[0,1]
v_pk_add_f32 v[34:35], v[34:35], v[42:43]
v_pk_mul_f32 v[42:43], v[32:33], s[62:63] op_sel:[0,0] op_sel_hi:[0,1] neg_lo:[0,0] neg_hi:[0,1]
v_pk_fma_f32 v[42:43], v[32:33], s[62:63], v[42:43] op_sel:[1,1,0] op_sel_hi:[1,0,1] neg_lo:[0,0,0] neg_hi:[0,0,0]
v_pk_add_f32 v[32:33], v[36:37], v[44:45] op_sel:[1,1] op_sel_hi:[0,0] neg_lo:[0,1] neg_hi:[1,0]
v_pk_add_f32 v[36:37], v[36:37], v[44:45]
v_pk_add_f32 v[44:45], v[38:39], v[46:47] neg_lo:[0,1] neg_hi:[0,1]
v_pk_add_f32 v[38:39], v[38:39], v[46:47]
v_pk_mul_f32 v[46:47], v[44:45], s[62:63] op_sel:[0,0] op_sel_hi:[0,1] neg_lo:[0,1] neg_hi:[0,1]
v_pk_fma_f32 v[46:47], v[44:45], s[62:63], v[46:47] op_sel:[1,1,0] op_sel_hi:[1,0,1] neg_lo:[0,0,0] neg_hi:[0,1,0]
v_pk_add_f32 v[44:45], v[48:49], v[56:57] neg_lo:[0,1] neg_hi:[0,1]
v_pk_add_f32 v[48:49], v[48:49], v[56:57]
v_pk_add_f32 v[56:57], v[50:51], v[58:59] neg_lo:[0,1] neg_hi:[0,1]
v_pk_add_f32 v[50:51], v[50:51], v[58:59]
v_pk_mul_f32 v[58:59], v[56:57], s[62:63] op_sel:[0,0] op_sel_hi:[0,1] neg_lo:[0,0] neg_hi:[0,1]
v_pk_fma_f32 v[58:59], v[56:57], s[62:63], v[58:59] op_sel:[1,1,0] op_sel_hi:[1,0,1] neg_lo:[0,0,0] neg_hi:[0,0,0]
v_pk_add_f32 v[56:57], v[52:53], v[60:61] op_sel:[1,1] op_sel_hi:[0,0] neg_lo:[0,1] neg_hi:[1,0]
v_pk_add_f32 v[52:53], v[52:53], v[60:61]
v_pk_add_f32 v[60:61], v[54:55], v[62:63] neg_lo:[0,1] neg_hi:[0,1]
v_pk_add_f32 v[54:55], v[54:55], v[62:63]
v_pk_mul_f32 v[62:63], v[60:61], s[62:63] op_sel:[0,0] op_sel_hi:[0,1] neg_lo:[0,1] neg_hi:[0,1]
v_pk_fma_f32 v[62:63], v[60:61], s[62:63], v[62:63] op_sel:[1,1,0] op_sel_hi:[1,0,1] neg_lo:[0,0,0] neg_hi:[0,1,0]
v_pk_add_f32 v[60:61], v[40:41], v[64:65] neg_lo:[0,1] neg_hi:[0,1]
v_pk_add_f32 v[40:41], v[40:41], v[64:65]
v_pk_add_f32 v[64:65], v[66:67], v[74:75] neg_lo:[0,1] neg_hi:[0,1]
v_pk_add_f32 v[66:67], v[66:67], v[74:75]
v_pk_mul_f32 v[74:75], v[64:65], s[62:63] op_sel:[0,0] op_sel_hi:[0,1] neg_lo:[0,0] neg_hi:[0,1]
v_pk_fma_f32 v[74:75], v[64:65], s[62:63], v[74:75] op_sel:[1,1,0] op_sel_hi:[1,0,1] neg_lo:[0,0,0] neg_hi:[0,0,0]
v_pk_add_f32 v[64:65], v[68:69], v[76:77] op_sel:[1,1] op_sel_hi:[0,0] neg_lo:[0,1] neg_hi:[1,0]
v_pk_add_f32 v[68:69], v[68:69], v[76:77]
v_pk_add_f32 v[76:77], v[70:71], v[78:79] neg_lo:[0,1] neg_hi:[0,1]
v_pk_add_f32 v[70:71], v[70:71], v[78:79]
v_pk_mul_f32 v[78:79], v[76:77], s[62:63] op_sel:[0,0] op_sel_hi:[0,1] neg_lo:[0,1] neg_hi:[0,1]
v_pk_fma_f32 v[78:79], v[76:77], s[62:63], v[78:79] op_sel:[1,1,0] op_sel_hi:[1,0,1] neg_lo:[0,0,0] neg_hi:[0,1,0]
v_pk_add_f32 v[76:77], v[16:17], v[20:21] neg_lo:[0,1] neg_hi:[0,1]
v_pk_add_f32 v[16:17], v[16:17], v[20:21]
v_pk_add_f32 v[20:21], v[18:19], v[22:23] op_sel:[1,1] op_sel_hi:[0,0] neg_lo:[0,1] neg_hi:[1,0]
v_pk_add_f32 v[18:19], v[18:19], v[22:23]
v_pk_add_f32 v[22:23], v[72:73], v[24:25] neg_lo:[0,1] neg_hi:[0,1]
v_pk_add_f32 v[72:73], v[72:73], v[24:25]
v_pk_add_f32 v[24:25], v[26:27], v[30:31] op_sel:[1,1] op_sel_hi:[0,0] neg_lo:[0,1] neg_hi:[1,0]
v_pk_add_f32 v[26:27], v[26:27], v[30:31]
v_pk_add_f32 v[30:31], v[14:15], v[36:37] neg_lo:[0,1] neg_hi:[0,1]
v_pk_add_f32 v[14:15], v[14:15], v[36:37]
v_pk_add_f32 v[36:37], v[34:35], v[38:39] op_sel:[1,1] op_sel_hi:[0,0] neg_lo:[0,1] neg_hi:[1,0]
v_pk_add_f32 v[34:35], v[34:35], v[38:39]
v_pk_add_f32 v[38:39], v[28:29], v[32:33] neg_lo:[0,1] neg_hi:[0,1]
v_pk_add_f32 v[28:29], v[28:29], v[32:33]
v_pk_add_f32 v[32:33], v[42:43], v[46:47] op_sel:[1,1] op_sel_hi:[0,0] neg_lo:[0,1] neg_hi:[1,0]
v_pk_add_f32 v[42:43], v[42:43], v[46:47]
v_pk_add_f32 v[46:47], v[48:49], v[52:53] neg_lo:[0,1] neg_hi:[0,1]
v_pk_add_f32 v[48:49], v[48:49], v[52:53]
v_pk_add_f32 v[52:53], v[50:51], v[54:55] op_sel:[1,1] op_sel_hi:[0,0] neg_lo:[0,1] neg_hi:[1,0]
v_pk_add_f32 v[50:51], v[50:51], v[54:55]
v_pk_add_f32 v[54:55], v[44:45], v[56:57] neg_lo:[0,1] neg_hi:[0,1]
v_pk_add_f32 v[44:45], v[44:45], v[56:57]
v_pk_add_f32 v[56:57], v[58:59], v[62:63] op_sel:[1,1] op_sel_hi:[0,0] neg_lo:[0,1] neg_hi:[1,0]
v_pk_add_f32 v[58:59], v[58:59], v[62:63]
v_pk_add_f32 v[62:63], v[40:41], v[68:69] neg_lo:[0,1] neg_hi:[0,1]
v_pk_add_f32 v[40:41], v[40:41], v[68:69]
v_pk_add_f32 v[68:69], v[66:67], v[70:71] op_sel:[1,1] op_sel_hi:[0,0] neg_lo:[0,1] neg_hi:[1,0]
v_pk_add_f32 v[66:67], v[66:67], v[70:71]
v_pk_add_f32 v[70:71], v[60:61], v[64:65] neg_lo:[0,1] neg_hi:[0,1]
v_pk_add_f32 v[60:61], v[60:61], v[64:65]
v_pk_add_f32 v[64:65], v[74:75], v[78:79] op_sel:[1,1] op_sel_hi:[0,0] neg_lo:[0,1] neg_hi:[1,0]
v_pk_add_f32 v[74:75], v[74:75], v[78:79]
v_pk_add_f32 v[78:79], v[16:17], v[18:19] neg_lo:[0,1] neg_hi:[0,1]
v_pk_add_f32 v[16:17], v[16:17], v[18:19]
v_pk_add_f32 v[18:19], v[76:77], v[20:21] neg_lo:[0,1] neg_hi:[0,1]
v_pk_add_f32 v[76:77], v[76:77], v[20:21]
v_pk_add_f32 v[20:21], v[72:73], v[26:27] neg_lo:[0,1] neg_hi:[0,1]
v_pk_add_f32 v[72:73], v[72:73], v[26:27]
v_pk_add_f32 v[26:27], v[22:23], v[24:25] neg_lo:[0,1] neg_hi:[0,1]
v_pk_add_f32 v[22:23], v[22:23], v[24:25]
v_pk_add_f32 v[24:25], v[14:15], v[34:35] neg_lo:[0,1] neg_hi:[0,1]
v_pk_add_f32 v[14:15], v[14:15], v[34:35]
v_pk_add_f32 v[34:35], v[30:31], v[36:37] neg_lo:[0,1] neg_hi:[0,1]
v_pk_add_f32 v[30:31], v[30:31], v[36:37]
v_pk_add_f32 v[36:37], v[28:29], v[42:43] neg_lo:[0,1] neg_hi:[0,1]
v_pk_add_f32 v[28:29], v[28:29], v[42:43]
v_pk_add_f32 v[42:43], v[38:39], v[32:33] neg_lo:[0,1] neg_hi:[0,1]
v_pk_add_f32 v[38:39], v[38:39], v[32:33]
v_pk_add_f32 v[32:33], v[48:49], v[50:51] neg_lo:[0,1] neg_hi:[0,1]
v_pk_add_f32 v[48:49], v[48:49], v[50:51]
v_pk_add_f32 v[50:51], v[46:47], v[52:53] neg_lo:[0,1] neg_hi:[0,1]
v_pk_add_f32 v[46:47], v[46:47], v[52:53]
v_pk_add_f32 v[52:53], v[44:45], v[58:59] neg_lo:[0,1] neg_hi:[0,1]
v_pk_add_f32 v[44:45], v[44:45], v[58:59]
v_pk_add_f32 v[58:59], v[54:55], v[56:57] neg_lo:[0,1] neg_hi:[0,1]
v_pk_add_f32 v[54:55], v[54:55], v[56:57]
v_pk_add_f32 v[56:57], v[40:41], v[66:67] neg_lo:[0,1] neg_hi:[0,1]
v_pk_add_f32 v[40:41], v[40:41], v[66:67]
v_pk_add_f32 v[66:67], v[62:63], v[68:69] neg_lo:[0,1] neg_hi:[0,1]
v_pk_add_f32 v[62:63], v[62:63], v[68:69]
v_pk_add_f32 v[68:69], v[60:61], v[74:75] neg_lo:[0,1] neg_hi:[0,1]
v_pk_add_f32 v[60:61], v[60:61], v[74:75]
v_pk_add_f32 v[74:75], v[70:71], v[64:65] neg_lo:[0,1] neg_hi:[0,1]
v_pk_add_f32 v[70:71], v[70:71], v[64:65]
v_pk_mul_f32 v[64:65], v[48:49], v[82:83] op_sel:[0,0] op_sel_hi:[0,1] neg_lo:[0,0] neg_hi:[0,0]
v_pk_fma_f32 v[48:49], v[48:49], v[82:83], v[64:65] op_sel:[1,1,0] op_sel_hi:[1,0,1] neg_lo:[0,1,0] neg_hi:[0,0,0]
v_pk_mul_f32 v[64:65], v[14:15], v[84:85] op_sel:[0,0] op_sel_hi:[0,1] neg_lo:[0,0] neg_hi:[0,0]
v_pk_fma_f32 v[14:15], v[14:15], v[84:85], v[64:65] op_sel:[1,1,0] op_sel_hi:[1,0,1] neg_lo:[0,1,0] neg_hi:[0,0,0]
v_pk_mul_f32 v[64:65], v[40:41], v[86:87] op_sel:[0,0] op_sel_hi:[0,1] neg_lo:[0,0] neg_hi:[0,0]
v_pk_fma_f32 v[40:41], v[40:41], v[86:87], v[64:65] op_sel:[1,1,0] op_sel_hi:[1,0,1] neg_lo:[0,1,0] neg_hi:[0,0,0]
v_pk_mul_f32 v[64:65], v[72:73], v[88:89] op_sel:[0,0] op_sel_hi:[0,1] neg_lo:[0,0] neg_hi:[0,0]
v_pk_fma_f32 v[72:73], v[72:73], v[88:89], v[64:65] op_sel:[1,1,0] op_sel_hi:[1,0,1] neg_lo:[0,1,0] neg_hi:[0,0,0]
v_pk_mul_f32 v[64:65], v[44:45], v[90:91] op_sel:[0,0] op_sel_hi:[0,1] neg_lo:[0,0] neg_hi:[0,0]
v_pk_fma_f32 v[44:45], v[44:45], v[90:91], v[64:65] op_sel:[1,1,0] op_sel_hi:[1,0,1] neg_lo:[0,1,0] neg_hi:[0,0,0]
v_pk_mul_f32 v[64:65], v[28:29], v[92:93] op_sel:[0,0] op_sel_hi:[0,1] neg_lo:[0,0] neg_hi:[0,0]
v_pk_fma_f32 v[28:29], v[28:29], v[92:93], v[64:65] op_sel:[1,1,0] op_sel_hi:[1,0,1] neg_lo:[0,1,0] neg_hi:[0,0,0]
v_pk_mul_f32 v[64:65], v[60:61], v[94:95] op_sel:[0,0] op_sel_hi:[0,1] neg_lo:[0,0] neg_hi:[0,0]
v_pk_fma_f32 v[60:61], v[60:61], v[94:95], v[64:65] op_sel:[1,1,0] op_sel_hi:[1,0,1] neg_lo:[0,1,0] neg_hi:[0,0,0]
v_pk_mul_f32 v[64:65], v[76:77], v[96:97] op_sel:[0,0] op_sel_hi:[0,1] neg_lo:[0,0] neg_hi:[0,0]
v_pk_fma_f32 v[76:77], v[76:77], v[96:97], v[64:65] op_sel:[1,1,0] op_sel_hi:[1,0,1] neg_lo:[0,1,0] neg_hi:[0,0,0]
v_pk_mul_f32 v[64:65], v[46:47], v[98:99] op_sel:[0,0] op_sel_hi:[0,1] neg_lo:[0,0] neg_hi:[0,0]
v_pk_fma_f32 v[46:47], v[46:47], v[98:99], v[64:65] op_sel:[1,1,0] op_sel_hi:[1,0,1] neg_lo:[0,1,0] neg_hi:[0,0,0]
v_pk_mul_f32 v[64:65], v[30:31], v[100:101] op_sel:[0,0] op_sel_hi:[0,1] neg_lo:[0,0] neg_hi:[0,0]
v_pk_fma_f32 v[30:31], v[30:31], v[100:101], v[64:65] op_sel:[1,1,0] op_sel_hi:[1,0,1] neg_lo:[0,1,0] neg_hi:[0,0,0]
v_pk_mul_f32 v[64:65], v[62:63], v[102:103] op_sel:[0,0] op_sel_hi:[0,1] neg_lo:[0,0] neg_hi:[0,0]
v_pk_fma_f32 v[62:63], v[62:63], v[102:103], v[64:65] op_sel:[1,1,0] op_sel_hi:[1,0,1] neg_lo:[0,1,0] neg_hi:[0,0,0]
v_pk_mul_f32 v[64:65], v[22:23], v[104:105] op_sel:[0,0] op_sel_hi:[0,1] neg_lo:[0,0] neg_hi:[0,0]
v_pk_fma_f32 v[22:23], v[22:23], v[104:105], v[64:65] op_sel:[1,1,0] op_sel_hi:[1,0,1] neg_lo:[0,1,0] neg_hi:[0,0,0]
v_pk_mul_f32 v[64:65], v[54:55], v[106:107] op_sel:[0,0] op_sel_hi:[0,1] neg_lo:[0,0] neg_hi:[0,0]
v_pk_fma_f32 v[54:55], v[54:55], v[106:107], v[64:65] op_sel:[1,1,0] op_sel_hi:[1,0,1] neg_lo:[0,1,0] neg_hi:[0,0,0]
v_pk_mul_f32 v[64:65], v[38:39], v[108:109] op_sel:[0,0] op_sel_hi:[0,1] neg_lo:[0,0] neg_hi:[0,0]
v_pk_fma_f32 v[38:39], v[38:39], v[108:109], v[64:65] op_sel:[1,1,0] op_sel_hi:[1,0,1] neg_lo:[0,1,0] neg_hi:[0,0,0]
v_pk_mul_f32 v[64:65], v[70:71], v[110:111] op_sel:[0,0] op_sel_hi:[0,1] neg_lo:[0,0] neg_hi:[0,0]
v_pk_fma_f32 v[70:71], v[70:71], v[110:111], v[64:65] op_sel:[1,1,0] op_sel_hi:[1,0,1] neg_lo:[0,1,0] neg_hi:[0,0,0]
v_pk_mul_f32 v[64:65], v[78:79], v[112:113] op_sel:[0,0] op_sel_hi:[0,1] neg_lo:[0,0] neg_hi:[0,0]
v_pk_fma_f32 v[78:79], v[78:79], v[112:113], v[64:65] op_sel:[1,1,0] op_sel_hi:[1,0,1] neg_lo:[0,1,0] neg_hi:[0,0,0]
v_pk_mul_f32 v[64:65], v[32:33], v[114:115] op_sel:[0,0] op_sel_hi:[0,1] neg_lo:[0,0] neg_hi:[0,0]
v_pk_fma_f32 v[32:33], v[32:33], v[114:115], v[64:65] op_sel:[1,1,0] op_sel_hi:[1,0,1] neg_lo:[0,1,0] neg_hi:[0,0,0]
v_pk_mul_f32 v[64:65], v[24:25], v[116:117] op_sel:[0,0] op_sel_hi:[0,1] neg_lo:[0,0] neg_hi:[0,0]
v_pk_fma_f32 v[24:25], v[24:25], v[116:117], v[64:65] op_sel:[1,1,0] op_sel_hi:[1,0,1] neg_lo:[0,1,0] neg_hi:[0,0,0]
v_pk_mul_f32 v[64:65], v[56:57], v[118:119] op_sel:[0,0] op_sel_hi:[0,1] neg_lo:[0,0] neg_hi:[0,0]
v_pk_fma_f32 v[56:57], v[56:57], v[118:119], v[64:65] op_sel:[1,1,0] op_sel_hi:[1,0,1] neg_lo:[0,1,0] neg_hi:[0,0,0]
v_pk_mul_f32 v[64:65], v[20:21], v[120:121] op_sel:[0,0] op_sel_hi:[0,1] neg_lo:[0,0] neg_hi:[0,0]
v_pk_fma_f32 v[20:21], v[20:21], v[120:121], v[64:65] op_sel:[1,1,0] op_sel_hi:[1,0,1] neg_lo:[0,1,0] neg_hi:[0,0,0]
v_pk_mul_f32 v[64:65], v[52:53], v[122:123] op_sel:[0,0] op_sel_hi:[0,1] neg_lo:[0,0] neg_hi:[0,0]
v_pk_fma_f32 v[52:53], v[52:53], v[122:123], v[64:65] op_sel:[1,1,0] op_sel_hi:[1,0,1] neg_lo:[0,1,0] neg_hi:[0,0,0]
v_pk_mul_f32 v[64:65], v[36:37], v[124:125] op_sel:[0,0] op_sel_hi:[0,1] neg_lo:[0,0] neg_hi:[0,0]
v_pk_fma_f32 v[36:37], v[36:37], v[124:125], v[64:65] op_sel:[1,1,0] op_sel_hi:[1,0,1] neg_lo:[0,1,0] neg_hi:[0,0,0]
v_pk_mul_f32 v[64:65], v[68:69], v[126:127] op_sel:[0,0] op_sel_hi:[0,1] neg_lo:[0,0] neg_hi:[0,0]
v_pk_fma_f32 v[68:69], v[68:69], v[126:127], v[64:65] op_sel:[1,1,0] op_sel_hi:[1,0,1] neg_lo:[0,1,0] neg_hi:[0,0,0]
v_pk_mul_f32 v[64:65], v[18:19], v[128:129] op_sel:[0,0] op_sel_hi:[0,1] neg_lo:[0,0] neg_hi:[0,0]
v_pk_fma_f32 v[18:19], v[18:19], v[128:129], v[64:65] op_sel:[1,1,0] op_sel_hi:[1,0,1] neg_lo:[0,1,0] neg_hi:[0,0,0]
v_pk_mul_f32 v[64:65], v[50:51], v[130:131] op_sel:[0,0] op_sel_hi:[0,1] neg_lo:[0,0] neg_hi:[0,0]
v_pk_fma_f32 v[50:51], v[50:51], v[130:131], v[64:65] op_sel:[1,1,0] op_sel_hi:[1,0,1] neg_lo:[0,1,0] neg_hi:[0,0,0]
v_pk_mul_f32 v[64:65], v[34:35], v[132:133] op_sel:[0,0] op_sel_hi:[0,1] neg_lo:[0,0] neg_hi:[0,0]
v_pk_fma_f32 v[34:35], v[34:35], v[132:133], v[64:65] op_sel:[1,1,0] op_sel_hi:[1,0,1] neg_lo:[0,1,0] neg_hi:[0,0,0]
v_pk_mul_f32 v[64:65], v[66:67], v[134:135] op_sel:[0,0] op_sel_hi:[0,1] neg_lo:[0,0] neg_hi:[0,0]
v_pk_fma_f32 v[66:67], v[66:67], v[134:135], v[64:65] op_sel:[1,1,0] op_sel_hi:[1,0,1] neg_lo:[0,1,0] neg_hi:[0,0,0]
v_pk_mul_f32 v[64:65], v[26:27], v[136:137] op_sel:[0,0] op_sel_hi:[0,1] neg_lo:[0,0] neg_hi:[0,0]
v_pk_fma_f32 v[26:27], v[26:27], v[136:137], v[64:65] op_sel:[1,1,0] op_sel_hi:[1,0,1] neg_lo:[0,1,0] neg_hi:[0,0,0]
v_pk_mul_f32 v[64:65], v[58:59], v[138:139] op_sel:[0,0] op_sel_hi:[0,1] neg_lo:[0,0] neg_hi:[0,0]
v_pk_fma_f32 v[58:59], v[58:59], v[138:139], v[64:65] op_sel:[1,1,0] op_sel_hi:[1,0,1] neg_lo:[0,1,0] neg_hi:[0,0,0]
v_pk_mul_f32 v[64:65], v[42:43], v[140:141] op_sel:[0,0] op_sel_hi:[0,1] neg_lo:[0,0] neg_hi:[0,0]
v_pk_fma_f32 v[42:43], v[42:43], v[140:141], v[64:65] op_sel:[1,1,0] op_sel_hi:[1,0,1] neg_lo:[0,1,0] neg_hi:[0,0,0]
v_pk_mul_f32 v[64:65], v[74:75], v[142:143] op_sel:[0,0] op_sel_hi:[0,1] neg_lo:[0,0] neg_hi:[0,0]
v_pk_fma_f32 v[74:75], v[74:75], v[142:143], v[64:65] op_sel:[1,1,0] op_sel_hi:[1,0,1] neg_lo:[0,1,0] neg_hi:[0,0,0]
s_barrier
ds_write_b64 v4, v[16:17] offset:0
ds_write_b64 v4, v[48:49] offset:264
ds_write_b64 v4, v[14:15] offset:528
ds_write_b64 v4, v[40:41] offset:792
ds_write_b64 v4, v[72:73] offset:1056
ds_write_b64 v4, v[44:45] offset:1320
ds_write_b64 v4, v[28:29] offset:1584
ds_write_b64 v4, v[60:61] offset:1848
ds_write_b64 v4, v[76:77] offset:2112
ds_write_b64 v4, v[46:47] offset:2376
ds_write_b64 v4, v[30:31] offset:2640
ds_write_b64 v4, v[62:63] offset:2904
ds_write_b64 v4, v[22:23] offset:3168
ds_write_b64 v4, v[54:55] offset:3432
ds_write_b64 v4, v[38:39] offset:3696
ds_write_b64 v4, v[70:71] offset:3960
ds_write_b64 v4, v[78:79] offset:4224
ds_write_b64 v4, v[32:33] offset:4488
ds_write_b64 v4, v[24:25] offset:4752
ds_write_b64 v4, v[56:57] offset:5016
ds_write_b64 v4, v[20:21] offset:5280
ds_write_b64 v4, v[52:53] offset:5544
ds_write_b64 v4, v[36:37] offset:5808
ds_write_b64 v4, v[68:69] offset:6072
ds_write_b64 v4, v[18:19] offset:6336
ds_write_b64 v4, v[50:51] offset:6600
ds_write_b64 v4, v[34:35] offset:6864
ds_write_b64 v4, v[66:67] offset:7128
ds_write_b64 v4, v[26:27] offset:7392
ds_write_b64 v4, v[58:59] offset:7656
ds_write_b64 v4, v[42:43] offset:7920
ds_write_b64 v4, v[74:75] offset:8184
s_waitcnt lgkmcnt(0)
ds_read_b64 v[16:17], v5 offset:0
ds_read_b64 v[48:49], v5 offset:128
ds_read_b64 v[18:19], v5 offset:8
ds_read_b64 v[50:51], v5 offset:136
ds_read_b64 v[20:21], v5 offset:16
ds_read_b64 v[52:53], v5 offset:144
ds_read_b64 v[22:23], v5 offset:24
ds_read_b64 v[54:55], v5 offset:152
ds_read_b64 v[24:25], v5 offset:32
ds_read_b64 v[56:57], v5 offset:160
ds_read_b64 v[26:27], v5 offset:40
ds_read_b64 v[58:59], v5 offset:168
ds_read_b64 v[28:29], v5 offset:48
ds_read_b64 v[60:61], v5 offset:176
ds_read_b64 v[30:31], v5 offset:56
ds_read_b64 v[62:63], v5 offset:184
ds_read_b64 v[32:33], v5 offset:64
ds_read_b64 v[64:65], v5 offset:192
ds_read_b64 v[34:35], v5 offset:72
ds_read_b64 v[66:67], v5 offset:200
ds_read_b64 v[36:37], v5 offset:80
ds_read_b64 v[68:69], v5 offset:208
ds_read_b64 v[38:39], v5 offset:88
ds_read_b64 v[70:71], v5 offset:216
ds_read_b64 v[40:41], v5 offset:96
ds_read_b64 v[72:73], v5 offset:224
ds_read_b64 v[42:43], v5 offset:104
ds_read_b64 v[74:75], v5 offset:232
ds_read_b64 v[44:45], v5 offset:112
ds_read_b64 v[76:77], v5 offset:240
ds_read_b64 v[46:47], v5 offset:120
ds_read_b64 v[78:79], v5 offset:248
s_waitcnt lgkmcnt(0)
v_pk_add_f32 v[14:15], v[16:17], v[48:49] neg_lo:[0,1] neg_hi:[0,1]
v_pk_add_f32 v[16:17], v[16:17], v[48:49]
v_pk_add_f32 v[48:49], v[18:19], v[50:51] neg_lo:[0,1] neg_hi:[0,1]
v_pk_add_f32 v[18:19], v[18:19], v[50:51]
v_pk_mul_f32 v[50:51], v[48:49], s[50:51] op_sel:[0,0] op_sel_hi:[0,1] neg_lo:[0,0] neg_hi:[0,1]
v_pk_fma_f32 v[50:51], v[48:49], s[50:51], v[50:51] op_sel:[1,1,0] op_sel_hi:[1,0,1] neg_lo:[0,0,0] neg_hi:[0,0,0]
v_pk_add_f32 v[48:49], v[20:21], v[52:53] neg_lo:[0,1] neg_hi:[0,1]
v_pk_add_f32 v[20:21], v[20:21], v[52:53]
v_pk_mul_f32 v[52:53], v[48:49], s[54:55] op_sel:[0,0] op_sel_hi:[0,1] neg_lo:[0,0] neg_hi:[0,1]
v_pk_fma_f32 v[52:53], v[48:49], s[54:55], v[52:53] op_sel:[1,1,0] op_sel_hi:[1,0,1] neg_lo:[0,0,0] neg_hi:[0,0,0]
v_pk_add_f32 v[48:49], v[22:23], v[54:55] neg_lo:[0,1] neg_hi:[0,1]
v_pk_add_f32 v[22:23], v[22:23], v[54:55]
v_pk_mul_f32 v[54:55], v[48:49], s[58:59] op_sel:[0,0] op_sel_hi:[0,1] neg_lo:[0,0] neg_hi:[0,1]
v_pk_fma_f32 v[54:55], v[48:49], s[58:59], v[54:55] op_sel:[1,1,0] op_sel_hi:[1,0,1] neg_lo:[0,0,0] neg_hi:[0,0,0]
v_pk_add_f32 v[48:49], v[24:25], v[56:57] neg_lo:[0,1] neg_hi:[0,1]
v_pk_add_f32 v[24:25], v[24:25], v[56:57]
v_pk_mul_f32 v[56:57], v[48:49], s[62:63] op_sel:[0,0] op_sel_hi:[0,1] neg_lo:[0,0] neg_hi:[0,1]
v_pk_fma_f32 v[56:57], v[48:49], s[62:63], v[56:57] op_sel:[1,1,0] op_sel_hi:[1,0,1] neg_lo:[0,0,0] neg_hi:[0,0,0]
v_pk_add_f32 v[48:49], v[26:27], v[58:59] neg_lo:[0,1] neg_hi:[0,1]
v_pk_add_f32 v[26:27], v[26:27], v[58:59]
v_pk_mul_f32 v[58:59], v[48:49], s[58:59] op_sel:[0,1] op_sel_hi:[0,0] neg_lo:[0,0] neg_hi:[0,1]
v_pk_fma_f32 v[58:59], v[48:49], s[58:59], v[58:59] op_sel:[1,0,0] op_sel_hi:[1,1,1] neg_lo:[0,0,0] neg_hi:[0,0,0]
v_pk_add_f32 v[48:49], v[28:29], v[60:61] neg_lo:[0,1] neg_hi:[0,1]
v_pk_add_f32 v[28:29], v[28:29], v[60:61]
v_pk_mul_f32 v[60:61], v[48:49], s[54:55] op_sel:[0,1] op_sel_hi:[0,0] neg_lo:[0,0] neg_hi:[0,1]
v_pk_fma_f32 v[60:61], v[48:49], s[54:55], v[60:61] op_sel:[1,0,0] op_sel_hi:[1,1,1] neg_lo:[0,0,0] neg_hi:[0,0,0]
v_pk_add_f32 v[48:49], v[30:31], v[62:63] neg_lo:[0,1] neg_hi:[0,1]
v_pk_add_f32 v[30:31], v[30:31], v[62:63]
v_pk_mul_f32 v[62:63], v[48:49], s[50:51] op_sel:[0,1] op_sel_hi:[0,0] neg_lo:[0,0] neg_hi:[0,1]
v_pk_fma_f32 v[62:63], v[48:49], s[50:51], v[62:63] op_sel:[1,0,0] op_sel_hi:[1,1,1] neg_lo:[0,0,0] neg_hi:[0,0,0]
v_pk_add_f32 v[48:49], v[32:33], v[64:65] op_sel:[1,1] op_sel_hi:[0,0] neg_lo:[0,1] neg_hi:[1,0]
v_pk_add_f32 v[32:33], v[32:33], v[64:65]
v_pk_add_f32 v[64:65], v[34:35], v[66:67] neg_lo:[0,1] neg_hi:[0,1]
v_pk_add_f32 v[34:35], v[34:35], v[66:67]
v_pk_mul_f32 v[66:67], v[64:65], s[50:51] op_sel:[0,1] op_sel_hi:[0,0] neg_lo:[0,1] neg_hi:[0,1]
v_pk_fma_f32 v[66:67], v[64:65], s[50:51], v[66:67] op_sel:[1,0,0] op_sel_hi:[1,1,1] neg_lo:[0,0,0] neg_hi:[0,1,0]
v_pk_add_f32 v[64:65], v[36:37], v[68:69] neg_lo:[0,1] neg_hi:[0,1]
v_pk_add_f32 v[36:37], v[36:37], v[68:69]
v_pk_mul_f32 v[68:69], v[64:65], s[54:55] op_sel:[0,1] op_sel_hi:[0,0] neg_lo:[0,1] neg_hi:[0,1]
v_pk_fma_f32 v[68:69], v[64:65], s[54:55], v[68:69] op_sel:[1,0,0] op_sel_hi:[1,1,1] neg_lo:[0,0,0] neg_hi:[0,1,0]
v_pk_add_f32 v[64:65], v[38:39], v[70:71] neg_lo:[0,1] neg_hi:[0,1]
v_pk_add_f32 v[38:39], v[38:39], v[70:71]
v_pk_mul_f32 v[70:71], v[64:65], s[58:59] op_sel:[0,1] op_sel_hi:[0,0] neg_lo:[0,1] neg_hi:[0,1]
v_pk_fma_f32 v[70:71], v[64:65], s[58:59], v[70:71] op_sel:[1,0,0] op_sel_hi:[1,1,1] neg_lo:[0,0,0] neg_hi:[0,1,0]
v_pk_add_f32 v[64:65], v[40:41], v[72:73] neg_lo:[0,1] neg_hi:[0,1]
v_pk_add_f32 v[40:41], v[40:41], v[72:73]
v_pk_mul_f32 v[72:73], v[64:65], s[62:63] op_sel:[0,0] op_sel_hi:[0,1] neg_lo:[0,1] neg_hi:[0,1]
v_pk_fma_f32 v[72:73], v[64:65], s[62:63], v[72:73] op_sel:[1,1,0] op_sel_hi:[1,0,1] neg_lo:[0,0,0] neg_hi:[0,1,0]
v_pk_add_f32 v[64:65], v[42:43], v[74:75] neg_lo:[0,1] neg_hi:[0,1]
v_pk_add_f32 v[42:43], v[42:43], v[74:75]
v_pk_mul_f32 v[74:75], v[64:65], s[58:59] op_sel:[0,0] op_sel_hi:[0,1] neg_lo:[0,1] neg_hi:[0,1]
v_pk_fma_f32 v[74:75], v[64:65], s[58:59], v[74:75] op_sel:[1,1,0] op_sel_hi:[1,0,1] neg_lo:[0,0,0] neg_hi:[0,1,0]
v_pk_add_f32 v[64:65], v[44:45], v[76:77] neg_lo:[0,1] neg_hi:[0,1]
v_pk_add_f32 v[44:45], v[44:45], v[76:77]
v_pk_mul_f32 v[76:77], v[64:65], s[54:55] op_sel:[0,0] op_sel_hi:[0,1] neg_lo:[0,1] neg_hi:[0,1]
v_pk_fma_f32 v[76:77], v[64:65], s[54:55], v[76:77] op_sel:[1,1,0] op_sel_hi:[1,0,1] neg_lo:[0,0,0] neg_hi:[0,1,0]
v_pk_add_f32 v[64:65], v[46:47], v[78:79] neg_lo:[0,1] neg_hi:[0,1]
v_pk_add_f32 v[46:47], v[46:47], v[78:79]
v_pk_mul_f32 v[78:79], v[64:65], s[50:51] op_sel:[0,0] op_sel_hi:[0,1] neg_lo:[0,1] neg_hi:[0,1]
v_pk_fma_f32 v[78:79], v[64:65], s[50:51], v[78:79] op_sel:[1,1,0] op_sel_hi:[1,0,1] neg_lo:[0,0,0] neg_hi:[0,1,0]
v_pk_add_f32 v[64:65], v[16:17], v[32:33] neg_lo:[0,1] neg_hi:[0,1]
v_pk_add_f32 v[16:17], v[16:17], v[32:33]
v_pk_add_f32 v[32:33], v[18:19], v[34:35] neg_lo:[0,1] neg_hi:[0,1]
v_pk_add_f32 v[18:19], v[18:19], v[34:35]
v_pk_mul_f32 v[34:35], v[32:33], s[54:55] op_sel:[0,0] op_sel_hi:[0,1] neg_lo:[0,0] neg_hi:[0,1]
v_pk_fma_f32 v[34:35], v[32:33], s[54:55], v[34:35] op_sel:[1,1,0] op_sel_hi:[1,0,1] neg_lo:[0,0,0] neg_hi:[0,0,0]
v_pk_add_f32 v[32:33], v[20:21], v[36:37] neg_lo:[0,1] neg_hi:[0,1]
v_pk_add_f32 v[20:21], v[20:21], v[36:37]
v_pk_mul_f32 v[36:37], v[32:33], s[62:63] op_sel:[0,0] op_sel_hi:[0,1] neg_lo:[0,0] neg_hi:[0,1]
v_pk_fma_f32 v[36:37], v[32:33], s[62:63], v[36:37] op_sel:[1,1,0] op_sel_hi:[1,0,1] neg_lo:[0,0,0] neg_hi:[0,0,0]
v_pk_add_f32 v[32:33], v[22:23], v[38:39] neg_lo:[0,1] neg_hi:[0,1]
v_pk_add_f32 v[22:23], v[22:23], v[38:39]
v_pk_mul_f32 v[38:39], v[32:33], s[54:55] op_sel:[0,1] op_sel_hi:[0,0] neg_lo:[0,0] neg_hi:[0,1]
v_pk_fma_f32 v[38:39], v[32:33], s[54:55], v[38:39] op_sel:[1,0,0] op_sel_hi:[1,1,1] neg_lo:[0,0,0] neg_hi:[0,0,0]
v_pk_add_f32 v[32:33], v[24:25], v[40:41] op_sel:[1,1] op_sel_hi:[0,0] neg_lo:[0,1] neg_hi:[1,0]
v_pk_add_f32 v[24:25], v[24:25], v[40:41]
v_pk_add_f32 v[40:41], v[26:27], v[42:43] neg_lo:[0,1] neg_hi:[0,1]
v_pk_add_f32 v[26:27], v[26:27], v[42:43]
v_pk_mul_f32 v[42:43], v[40:41], s[54:55] op_sel:[0,1] op_sel_hi:[0,0] neg_lo:[0,1] neg_hi:[0,1]
v_pk_fma_f32 v[42:43], v[40:41], s[54:55], v[42:43] op_sel:[1,0,0] op_sel_hi:[1,1,1] neg_lo:[0,0,0] neg_hi:[0,1,0]
v_pk_add_f32 v[40:41], v[28:29], v[44:45] neg_lo:[0,1] neg_hi:[0,1]
v_pk_add_f32 v[28:29], v[28:29], v[44:45]
v_pk_mul_f32 v[44:45], v[40:41], s[62:63] op_sel:[0,0] op_sel_hi:[0,1] neg_lo:[0,1] neg_hi:[0,1]
v_pk_fma_f32 v[44:45], v[40:41], s[62:63], v[44:45] op_sel:[1,1,0] op_sel_hi:[1,0,1] neg_lo:[0,0,0] neg_hi:[0,1,0]
v_pk_add_f32 v[40:41], v[30:31], v[46:47] neg_lo:[0,1] neg_hi:[0,1]
v_pk_add_f32 v[30:31], v[30:31], v[46:47]
v_pk_mul_f32 v[46:47], v[40:41], s[54:55] op_sel:[0,0] op_sel_hi:[0,1] neg_lo:[0,1] neg_hi:[0,1]
v_pk_fma_f32 v[46:47], v[40:41], s[54:55], v[46:47] op_sel:[1,1,0] op_sel_hi:[1,0,1] neg_lo:[0,0,0] neg_hi:[0,1,0]
v_pk_add_f32 v[40:41], v[14:15], v[48:49] neg_lo:[0,1] neg_hi:[0,1]
v_pk_add_f32 v[14:15], v[14:15], v[48:49]
v_pk_add_f32 v[48:49], v[50:51], v[66:67] neg_lo:[0,1] neg_hi:[0,1]
v_pk_add_f32 v[50:51], v[50:51], v[66:67]
v_pk_mul_f32 v[66:67], v[48:49], s[54:55] op_sel:[0,0] op_sel_hi:[0,1] neg_lo:[0,0] neg_hi:[0,1]
v_pk_fma_f32 v[66:67], v[48:49], s[54:55], v[66:67] op_sel:[1,1,0] op_sel_hi:[1,0,1] neg_lo:[0,0,0] neg_hi:[0,0,0]
v_pk_add_f32 v[48:49], v[52:53], v[68:69] neg_lo:[0,1] neg_hi:[0,1]
v_pk_add_f32 v[52:53], v[52:53], v[68:69]
v_pk_mul_f32 v[68:69], v[48:49], s[62:63] op_sel:[0,0] op_sel_hi:[0,1] neg_lo:[0,0] neg_hi:[0,1]
v_pk_fma_f32 v[68:69], v[48:49], s[62:63], v[68:69] op_sel:[1,1,0] op_sel_hi:[1,0,1] neg_lo:[0,0,0] neg_hi:[0,0,0]
v_pk_add_f32 v[48:49], v[54:55], v[70:71] neg_lo:[0,1] neg_hi:[0,1]
v_pk_add_f32 v[54:55], v[54:55], v[70:71]
v_pk_mul_f32 v[70:71], v[48:49], s[54:55] op_sel:[0,1] op_sel_hi:[0,0] neg_lo:[0,0] neg_hi:[0,1]
v_pk_fma_f32 v[70:71], v[48:49], s[54:55], v[70:71] op_sel:[1,0,0] op_sel_hi:[1,1,1] neg_lo:[0,0,0] neg_hi:[0,0,0]
v_pk_add_f32 v[48:49], v[56:57], v[72:73] op_sel:[1,1] op_sel_hi:[0,0] neg_lo:[0,1] neg_hi:[1,0]
v_pk_add_f32 v[56:57], v[56:57], v[72:73]
v_pk_add_f32 v[72:73], v[58:59], v[74:75] neg_lo:[0,1] neg_hi:[0,1]
v_pk_add_f32 v[58:59], v[58:59], v[74:75]
v_pk_mul_f32 v[74:75], v[72:73], s[54:55] op_sel:[0,1] op_sel_hi:[0,0] neg_lo:[0,1] neg_hi:[0,1]
v_pk_fma_f32 v[74:75], v[72:73], s[54:55], v[74:75] op_sel:[1,0,0] op_sel_hi:[1,1,1] neg_lo:[0,0,0] neg_hi:[0,1,0]
v_pk_add_f32 v[72:73], v[60:61], v[76:77] neg_lo:[0,1] neg_hi:[0,1]
v_pk_add_f32 v[60:61], v[60:61], v[76:77]
v_pk_mul_f32 v[76:77], v[72:73], s[62:63] op_sel:[0,0] op_sel_hi:[0,1] neg_lo:[0,1] neg_hi:[0,1]
v_pk_fma_f32 v[76:77], v[72:73], s[62:63], v[76:77] op_sel:[1,1,0] op_sel_hi:[1,0,1] neg_lo:[0,0,0] neg_hi:[0,1,0]
v_pk_add_f32 v[72:73], v[62:63], v[78:79] neg_lo:[0,1] neg_hi:[0,1]
v_pk_add_f32 v[62:63], v[62:63], v[78:79]
v_pk_mul_f32 v[78:79], v[72:73], s[54:55] op_sel:[0,0] op_sel_hi:[0,1] neg_lo:[0,1] neg_hi:[0,1]
v_pk_fma_f32 v[78:79], v[72:73], s[54:55], v[78:79] op_sel:[1,1,0] op_sel_hi:[1,0,1] neg_lo:[0,0,0] neg_hi:[0,1,0]
v_pk_add_f32 v[72:73], v[16:17], v[24:25] neg_lo:[0,1] neg_hi:[0,1]
v_pk_add_f32 v[16:17], v[16:17], v[24:25]
v_pk_add_f32 v[24:25], v[18:19], v[26:27] neg_lo:[0,1] neg_hi:[0,1]
v_pk_add_f32 v[18:19], v[18:19], v[26:27]
v_pk_mul_f32 v[26:27], v[24:25], s[62:63] op_sel:[0,0] op_sel_hi:[0,1] neg_lo:[0,0] neg_hi:[0,1]
v_pk_fma_f32 v[26:27], v[24:25], s[62:63], v[26:27] op_sel:[1,1,0] op_sel_hi:[1,0,1] neg_lo:[0,0,0] neg_hi:[0,0,0]
v_pk_add_f32 v[24:25], v[20:21], v[28:29] op_sel:[1,1] op_sel_hi:[0,0] neg_lo:[0,1] neg_hi:[1,0]
v_pk_add_f32 v[20:21], v[20:21], v[28:29]
v_pk_add_f32 v[28:29], v[22:23], v[30:31] neg_lo:[0,1] neg_hi:[0,1]
v_pk_add_f32 v[22:23], v[22:23], v[30:31]
v_pk_mul_f32 v[30:31], v[28:29], s[62:63] op_sel:[0,0] op_sel_hi:[0,1] neg_lo:[0,1] neg_hi:[0,1]
v_pk_fma_f32 v[30:31], v[28:29], s[62:63], v[30:31] op_sel:[1,1,0] op_sel_hi:[1,0,1] neg_lo:[0,0,0] neg_hi:[0,1,0]
v_pk_add_f32 v[28:29], v[64:65], v[32:33] neg_lo:[0,1] neg_hi:[0,1]
v_pk_add_f32 v[64:65], v[64:65], v[32:33]
v_pk_add_f32 v[32:33], v[34:35], v[42:43] neg_lo:[0,1] neg_hi:[0,1]
v_pk_add_f32 v[34:35], v[34:35], v[42:43]
v_pk_mul_f32 v[42:43], v[32:33], s[62:63] op_sel:[0,0] op_sel_hi:[0,1] neg_lo:[0,0] neg_hi:[0,1]
v_pk_fma_f32 v[42:43], v[32:33], s[62:63], v[42:43] op_sel:[1,1,0] op_sel_hi:[1,0,1] neg_lo:[0,0,0] neg_hi:[0,0,0]
v_pk_add_f32 v[32:33], v[36:37], v[44:45] op_sel:[1,1] op_sel_hi:[0,0] neg_lo:[0,1] neg_hi:[1,0]
v_pk_add_f32 v[36:37], v[36:37], v[44:45]
v_pk_add_f32 v[44:45], v[38:39], v[46:47] neg_lo:[0,1] neg_hi:[0,1]
v_pk_add_f32 v[38:39], v[38:39], v[46:47]
v_pk_mul_f32 v[46:47], v[44:45], s[62:63] op_sel:[0,0] op_sel_hi:[0,1] neg_lo:[0,1] neg_hi:[0,1]
v_pk_fma_f32 v[46:47], v[44:45], s[62:63], v[46:47] op_sel:[1,1,0] op_sel_hi:[1,0,1] neg_lo:[0,0,0] neg_hi:[0,1,0]
v_pk_add_f32 v[44:45], v[14:15], v[56:57] neg_lo:[0,1] neg_hi:[0,1]
v_pk_add_f32 v[14:15], v[14:15], v[56:57]
v_pk_add_f32 v[56:57], v[50:51], v[58:59] neg_lo:[0,1] neg_hi:[0,1]
v_pk_add_f32 v[50:51], v[50:51], v[58:59]
v_pk_mul_f32 v[58:59], v[56:57], s[62:63] op_sel:[0,0] op_sel_hi:[0,1] neg_lo:[0,0] neg_hi:[0,1]
v_pk_fma_f32 v[58:59], v[56:57], s[62:63], v[58:59] op_sel:[1,1,0] op_sel_hi:[1,0,1] neg_lo:[0,0,0] neg_hi:[0,0,0]
v_pk_add_f32 v[56:57], v[52:53], v[60:61] op_sel:[1,1] op_sel_hi:[0,0] neg_lo:[0,1] neg_hi:[1,0]
v_pk_add_f32 v[52:53], v[52:53], v[60:61]
v_pk_add_f32 v[60:61], v[54:55], v[62:63] neg_lo:[0,1] neg_hi:[0,1]
v_pk_add_f32 v[54:55], v[54:55], v[62:63]
v_pk_mul_f32 v[62:63], v[60:61], s[62:63] op_sel:[0,0] op_sel_hi:[0,1] neg_lo:[0,1] neg_hi:[0,1]
v_pk_fma_f32 v[62:63], v[60:61], s[62:63], v[62:63] op_sel:[1,1,0] op_sel_hi:[1,0,1] neg_lo:[0,0,0] neg_hi:[0,1,0]
v_pk_add_f32 v[60:61], v[40:41], v[48:49] neg_lo:[0,1] neg_hi:[0,1]
v_pk_add_f32 v[40:41], v[40:41], v[48:49]
v_pk_add_f32 v[48:49], v[66:67], v[74:75] neg_lo:[0,1] neg_hi:[0,1]
v_pk_add_f32 v[66:67], v[66:67], v[74:75]
v_pk_mul_f32 v[74:75], v[48:49], s[62:63] op_sel:[0,0] op_sel_hi:[0,1] neg_lo:[0,0] neg_hi:[0,1]
v_pk_fma_f32 v[74:75], v[48:49], s[62:63], v[74:75] op_sel:[1,1,0] op_sel_hi:[1,0,1] neg_lo:[0,0,0] neg_hi:[0,0,0]
v_pk_add_f32 v[48:49], v[68:69], v[76:77] op_sel:[1,1] op_sel_hi:[0,0] neg_lo:[0,1] neg_hi:[1,0]
v_pk_add_f32 v[68:69], v[68:69], v[76:77]
v_pk_add_f32 v[76:77], v[70:71], v[78:79] neg_lo:[0,1] neg_hi:[0,1]
v_pk_add_f32 v[70:71], v[70:71], v[78:79]
v_pk_mul_f32 v[78:79], v[76:77], s[62:63] op_sel:[0,0] op_sel_hi:[0,1] neg_lo:[0,1] neg_hi:[0,1]
v_pk_fma_f32 v[78:79], v[76:77], s[62:63], v[78:79] op_sel:[1,1,0] op_sel_hi:[1,0,1] neg_lo:[0,0,0] neg_hi:[0,1,0]
v_pk_add_f32 v[76:77], v[16:17], v[20:21] neg_lo:[0,1] neg_hi:[0,1]
v_pk_add_f32 v[16:17], v[16:17], v[20:21]
v_pk_add_f32 v[20:21], v[18:19], v[22:23] op_sel:[1,1] op_sel_hi:[0,0] neg_lo:[0,1] neg_hi:[1,0]
v_pk_add_f32 v[18:19], v[18:19], v[22:23]
v_pk_add_f32 v[22:23], v[72:73], v[24:25] neg_lo:[0,1] neg_hi:[0,1]
v_pk_add_f32 v[72:73], v[72:73], v[24:25]
v_pk_add_f32 v[24:25], v[26:27], v[30:31] op_sel:[1,1] op_sel_hi:[0,0] neg_lo:[0,1] neg_hi:[1,0]
v_pk_add_f32 v[26:27], v[26:27], v[30:31]
v_pk_add_f32 v[30:31], v[64:65], v[36:37] neg_lo:[0,1] neg_hi:[0,1]
v_pk_add_f32 v[64:65], v[64:65], v[36:37]
v_pk_add_f32 v[36:37], v[34:35], v[38:39] op_sel:[1,1] op_sel_hi:[0,0] neg_lo:[0,1] neg_hi:[1,0]
v_pk_add_f32 v[34:35], v[34:35], v[38:39]
v_pk_add_f32 v[38:39], v[28:29], v[32:33] neg_lo:[0,1] neg_hi:[0,1]
v_pk_add_f32 v[28:29], v[28:29], v[32:33]
v_pk_add_f32 v[32:33], v[42:43], v[46:47] op_sel:[1,1] op_sel_hi:[0,0] neg_lo:[0,1] neg_hi:[1,0]
v_pk_add_f32 v[42:43], v[42:43], v[46:47]
v_pk_add_f32 v[46:47], v[14:15], v[52:53] neg_lo:[0,1] neg_hi:[0,1]
v_pk_add_f32 v[14:15], v[14:15], v[52:53]
v_pk_add_f32 v[52:53], v[50:51], v[54:55] op_sel:[1,1] op_sel_hi:[0,0] neg_lo:[0,1] neg_hi:[1,0]
v_pk_add_f32 v[50:51], v[50:51], v[54:55]
v_pk_add_f32 v[54:55], v[44:45], v[56:57] neg_lo:[0,1] neg_hi:[0,1]
v_pk_add_f32 v[44:45], v[44:45], v[56:57]
v_pk_add_f32 v[56:57], v[58:59], v[62:63] op_sel:[1,1] op_sel_hi:[0,0] neg_lo:[0,1] neg_hi:[1,0]
v_pk_add_f32 v[58:59], v[58:59], v[62:63]
v_pk_add_f32 v[62:63], v[40:41], v[68:69] neg_lo:[0,1] neg_hi:[0,1]
v_pk_add_f32 v[40:41], v[40:41], v[68:69]
v_pk_add_f32 v[68:69], v[66:67], v[70:71] op_sel:[1,1] op_sel_hi:[0,0] neg_lo:[0,1] neg_hi:[1,0]
v_pk_add_f32 v[66:67], v[66:67], v[70:71]
v_pk_add_f32 v[70:71], v[60:61], v[48:49] neg_lo:[0,1] neg_hi:[0,1]
v_pk_add_f32 v[60:61], v[60:61], v[48:49]
v_pk_add_f32 v[48:49], v[74:75], v[78:79] op_sel:[1,1] op_sel_hi:[0,0] neg_lo:[0,1] neg_hi:[1,0]
v_pk_add_f32 v[74:75], v[74:75], v[78:79]
v_pk_add_f32 v[78:79], v[16:17], v[18:19] neg_lo:[0,1] neg_hi:[0,1]
v_pk_add_f32 v[16:17], v[16:17], v[18:19]
v_pk_add_f32 v[18:19], v[76:77], v[20:21] neg_lo:[0,1] neg_hi:[0,1]
v_pk_add_f32 v[76:77], v[76:77], v[20:21]
v_pk_add_f32 v[20:21], v[72:73], v[26:27] neg_lo:[0,1] neg_hi:[0,1]
v_pk_add_f32 v[72:73], v[72:73], v[26:27]
v_pk_add_f32 v[26:27], v[22:23], v[24:25] neg_lo:[0,1] neg_hi:[0,1]
v_pk_add_f32 v[22:23], v[22:23], v[24:25]
v_pk_add_f32 v[24:25], v[64:65], v[34:35] neg_lo:[0,1] neg_hi:[0,1]
v_pk_add_f32 v[64:65], v[64:65], v[34:35]
v_pk_add_f32 v[34:35], v[30:31], v[36:37] neg_lo:[0,1] neg_hi:[0,1]
v_pk_add_f32 v[30:31], v[30:31], v[36:37]
v_pk_add_f32 v[36:37], v[28:29], v[42:43] neg_lo:[0,1] neg_hi:[0,1]
v_pk_add_f32 v[28:29], v[28:29], v[42:43]
v_pk_add_f32 v[42:43], v[38:39], v[32:33] neg_lo:[0,1] neg_hi:[0,1]
v_pk_add_f32 v[38:39], v[38:39], v[32:33]
v_pk_add_f32 v[32:33], v[14:15], v[50:51] neg_lo:[0,1] neg_hi:[0,1]
v_pk_add_f32 v[14:15], v[14:15], v[50:51]
v_pk_add_f32 v[50:51], v[46:47], v[52:53] neg_lo:[0,1] neg_hi:[0,1]
v_pk_add_f32 v[46:47], v[46:47], v[52:53]
v_pk_add_f32 v[52:53], v[44:45], v[58:59] neg_lo:[0,1] neg_hi:[0,1]
v_pk_add_f32 v[44:45], v[44:45], v[58:59]
v_pk_add_f32 v[58:59], v[54:55], v[56:57] neg_lo:[0,1] neg_hi:[0,1]
v_pk_add_f32 v[54:55], v[54:55], v[56:57]
v_pk_add_f32 v[56:57], v[40:41], v[66:67] neg_lo:[0,1] neg_hi:[0,1]
v_pk_add_f32 v[40:41], v[40:41], v[66:67]
v_pk_add_f32 v[66:67], v[62:63], v[68:69] neg_lo:[0,1] neg_hi:[0,1]
v_pk_add_f32 v[62:63], v[62:63], v[68:69]
v_pk_add_f32 v[68:69], v[60:61], v[74:75] neg_lo:[0,1] neg_hi:[0,1]
v_pk_add_f32 v[60:61], v[60:61], v[74:75]
v_pk_add_f32 v[74:75], v[70:71], v[48:49] neg_lo:[0,1] neg_hi:[0,1]
v_pk_add_f32 v[70:71], v[70:71], v[48:49]
ds_write_b64 v4, v[16:17] offset:0
ds_write_b64 v4, v[14:15] offset:256
ds_write_b64 v4, v[64:65] offset:512
ds_write_b64 v4, v[40:41] offset:768
ds_write_b64 v4, v[72:73] offset:1024
ds_write_b64 v4, v[44:45] offset:1280
ds_write_b64 v4, v[28:29] offset:1536
ds_write_b64 v4, v[60:61] offset:1792
ds_write_b64 v4, v[76:77] offset:2048
ds_write_b64 v4, v[46:47] offset:2304
ds_write_b64 v4, v[30:31] offset:2560
ds_write_b64 v4, v[62:63] offset:2816
ds_write_b64 v4, v[22:23] offset:3072
ds_write_b64 v4, v[54:55] offset:3328
ds_write_b64 v4, v[38:39] offset:3584
ds_write_b64 v4, v[70:71] offset:3840
ds_write_b64 v4, v[78:79] offset:4096
ds_write_b64 v4, v[32:33] offset:4352
ds_write_b64 v4, v[24:25] offset:4608
ds_write_b64 v4, v[56:57] offset:4864
ds_write_b64 v4, v[20:21] offset:5120
ds_write_b64 v4, v[52:53] offset:5376
ds_write_b64 v4, v[36:37] offset:5632
ds_write_b64 v4, v[68:69] offset:5888
ds_write_b64 v4, v[18:19] offset:6144
ds_write_b64 v4, v[50:51] offset:6400
ds_write_b64 v4, v[34:35] offset:6656
ds_write_b64 v4, v[66:67] offset:6912
ds_write_b64 v4, v[26:27] offset:7168
ds_write_b64 v4, v[58:59] offset:7424
ds_write_b64 v4, v[42:43] offset:7680
ds_write_b64 v4, v[74:75] offset:7936
ds_write_b64 v4, v[16:17] offset:8192
s_waitcnt lgkmcnt(0)
s_barrier
s_lshl_b32 s13, s93, 7
s_and_b32 s23, s13, 0x2000
s_add_u32 s13, s13, s23
s_xor_b32 s23, s98, 1
s_lshl_b32 s23, s23, 13
s_add_u32 s13, s13, s23
s_add_u32 s13, s13, 92274688
ds_read_b64 v[16:17], v6 offset:0
ds_read_b64 v[18:19], v7 offset:4096
ds_read_b64 v[20:21], v6 offset:256
ds_read_b64 v[22:23], v7 offset:3840
ds_read_b64 v[24:25], v6 offset:512
ds_read_b64 v[26:27], v7 offset:3584
ds_read_b64 v[28:29], v6 offset:768
ds_read_b64 v[30:31], v7 offset:3328
ds_read_b64 v[32:33], v6 offset:1024
ds_read_b64 v[34:35], v7 offset:3072
ds_read_b64 v[36:37], v6 offset:1280
ds_read_b64 v[38:39], v7 offset:2816
s_waitcnt lgkmcnt(10)
v_pk_add_f32 v[208:209], v[16:17], v[18:19] neg_hi:[0,1]
v_pk_add_f32 v[210:211], v[16:17], v[18:19] op_sel:[1,1] op_sel_hi:[0,0] neg_hi:[1,0]
ds_read_b64 v[40:41], v6 offset:1536
ds_read_b64 v[42:43], v7 offset:2560
buffer_store_dwordx4 v[208:211], v8, s[84:87], s13 offen sc1
s_add_u32 s13, s13, 1048576
s_waitcnt lgkmcnt(10)
v_pk_add_f32 v[212:213], v[20:21], v[22:23] neg_hi:[0,1]
v_pk_add_f32 v[214:215], v[20:21], v[22:23] op_sel:[1,1] op_sel_hi:[0,0] neg_hi:[1,0]
ds_read_b64 v[44:45], v6 offset:1792
ds_read_b64 v[46:47], v7 offset:2304
buffer_store_dwordx4 v[212:215], v8, s[84:87], s13 offen sc1
s_add_u32 s13, s13, 1048576
s_xor_b32 s13, s13, 0x2000
s_waitcnt lgkmcnt(10)
v_pk_add_f32 v[216:217], v[24:25], v[26:27] neg_hi:[0,1]
v_pk_add_f32 v[218:219], v[24:25], v[26:27] op_sel:[1,1] op_sel_hi:[0,0] neg_hi:[1,0]
ds_read_b64 v[16:17], v6 offset:2048
ds_read_b64 v[18:19], v7 offset:2048
buffer_store_dwordx4 v[216:219], v8, s[84:87], s13 offen sc1
s_add_u32 s13, s13, 1048576
s_waitcnt lgkmcnt(10)
v_pk_add_f32 v[220:221], v[28:29], v[30:31] neg_hi:[0,1]
v_pk_add_f32 v[222:223], v[28:29], v[30:31] op_sel:[1,1] op_sel_hi:[0,0] neg_hi:[1,0]
ds_read_b64 v[20:21], v6 offset:2304
ds_read_b64 v[22:23], v7 offset:1792
buffer_store_dwordx4 v[220:223], v8, s[84:87], s13 offen sc1
s_add_u32 s13, s13, 1048576
s_xor_b32 s13, s13, 0x2000
s_waitcnt lgkmcnt(10)
v_pk_add_f32 v[224:225], v[32:33], v[34:35] neg_hi:[0,1]
v_pk_add_f32 v[226:227], v[32:33], v[34:35] op_sel:[1,1] op_sel_hi:[0,0] neg_hi:[1,0]
ds_read_b64 v[24:25], v6 offset:2560
ds_read_b64 v[26:27], v7 offset:1536
buffer_store_dwordx4 v[224:227], v8, s[84:87], s13 offen sc1
s_add_u32 s13, s13, 1048576
s_waitcnt lgkmcnt(10)
v_pk_add_f32 v[228:229], v[36:37], v[38:39] neg_hi:[0,1]
v_pk_add_f32 v[230:231], v[36:37], v[38:39] op_sel:[1,1] op_sel_hi:[0,0] neg_hi:[1,0]
ds_read_b64 v[28:29], v6 offset:2816
ds_read_b64 v[30:31], v7 offset:1280
buffer_store_dwordx4 v[228:231], v8, s[84:87], s13 offen sc1
s_add_u32 s13, s13, 1048576
s_xor_b32 s13, s13, 0x2000
s_waitcnt lgkmcnt(10)
v_pk_add_f32 v[232:233], v[40:41], v[42:43] neg_hi:[0,1]
v_pk_add_f32 v[234:235], v[40:41], v[42:43] op_sel:[1,1] op_sel_hi:[0,0] neg_hi:[1,0]
ds_read_b64 v[32:33], v6 offset:3072
ds_read_b64 v[34:35], v7 offset:1024
buffer_store_dwordx4 v[232:235], v8, s[84:87], s13 offen sc1
s_add_u32 s13, s13, 1048576
s_waitcnt lgkmcnt(10)
v_pk_add_f32 v[236:237], v[44:45], v[46:47] neg_hi:[0,1]
v_pk_add_f32 v[238:239], v[44:45], v[46:47] op_sel:[1,1] op_sel_hi:[0,0] neg_hi:[1,0]
ds_read_b64 v[36:37], v6 offset:3328
ds_read_b64 v[38:39], v7 offset:768
buffer_store_dwordx4 v[236:239], v8, s[84:87], s13 offen sc1
s_add_u32 s13, s13, 1048576
s_xor_b32 s13, s13, 0x2000
s_waitcnt lgkmcnt(10)
v_pk_add_f32 v[208:209], v[16:17], v[18:19] neg_hi:[0,1]
v_pk_add_f32 v[210:211], v[16:17], v[18:19] op_sel:[1,1] op_sel_hi:[0,0] neg_hi:[1,0]
ds_read_b64 v[40:41], v6 offset:3584
ds_read_b64 v[42:43], v7 offset:512
buffer_store_dwordx4 v[208:211], v8, s[84:87], s13 offen sc1
s_add_u32 s13, s13, 1048576
s_waitcnt lgkmcnt(10)
v_pk_add_f32 v[212:213], v[20:21], v[22:23] neg_hi:[0,1]
v_pk_add_f32 v[214:215], v[20:21], v[22:23] op_sel:[1,1] op_sel_hi:[0,0] neg_hi:[1,0]
ds_read_b64 v[44:45], v6 offset:3840
ds_read_b64 v[46:47], v7 offset:256
buffer_store_dwordx4 v[212:215], v8, s[84:87], s13 offen sc1
s_add_u32 s13, s13, 1048576
s_xor_b32 s13, s13, 0x2000
s_waitcnt lgkmcnt(10)
v_pk_add_f32 v[216:217], v[24:25], v[26:27] neg_hi:[0,1]
v_pk_add_f32 v[218:219], v[24:25], v[26:27] op_sel:[1,1] op_sel_hi:[0,0] neg_hi:[1,0]
ds_read_b64 v[16:17], v6 offset:4096
ds_read_b64 v[18:19], v7 offset:0
buffer_store_dwordx4 v[216:219], v8, s[84:87], s13 offen sc1
s_add_u32 s13, s13, 1048576
s_waitcnt lgkmcnt(10)
v_pk_add_f32 v[220:221], v[28:29], v[30:31] neg_hi:[0,1]
v_pk_add_f32 v[222:223], v[28:29], v[30:31] op_sel:[1,1] op_sel_hi:[0,0] neg_hi:[1,0]
buffer_store_dwordx4 v[220:223], v8, s[84:87], s13 offen sc1
s_add_u32 s13, s13, 1048576
s_xor_b32 s13, s13, 0x2000
s_waitcnt lgkmcnt(8)
v_pk_add_f32 v[224:225], v[32:33], v[34:35] neg_hi:[0,1]
v_pk_add_f32 v[226:227], v[32:33], v[34:35] op_sel:[1,1] op_sel_hi:[0,0] neg_hi:[1,0]
buffer_store_dwordx4 v[224:227], v8, s[84:87], s13 offen sc1
s_add_u32 s13, s13, 1048576
s_waitcnt lgkmcnt(6)
v_pk_add_f32 v[228:229], v[36:37], v[38:39] neg_hi:[0,1]
v_pk_add_f32 v[230:231], v[36:37], v[38:39] op_sel:[1,1] op_sel_hi:[0,0] neg_hi:[1,0]
buffer_store_dwordx4 v[228:231], v8, s[84:87], s13 offen sc1
s_add_u32 s13, s13, 1048576
s_xor_b32 s13, s13, 0x2000
s_waitcnt lgkmcnt(4)
v_pk_add_f32 v[232:233], v[40:41], v[42:43] neg_hi:[0,1]
v_pk_add_f32 v[234:235], v[40:41], v[42:43] op_sel:[1,1] op_sel_hi:[0,0] neg_hi:[1,0]
buffer_store_dwordx4 v[232:235], v8, s[84:87], s13 offen sc1
s_add_u32 s13, s13, 1048576
s_waitcnt lgkmcnt(2)
v_pk_add_f32 v[236:237], v[44:45], v[46:47] neg_hi:[0,1]
v_pk_add_f32 v[238:239], v[44:45], v[46:47] op_sel:[1,1] op_sel_hi:[0,0] neg_hi:[1,0]
buffer_store_dwordx4 v[236:239], v8, s[84:87], s13 offen sc1
s_add_u32 s13, s13, 1048576
s_xor_b32 s13, s13, 0x2000
s_waitcnt lgkmcnt(0)
v_pk_add_f32 v[208:209], v[16:17], v[18:19] neg_hi:[0,1]
v_pk_add_f32 v[210:211], v[16:17], v[18:19] op_sel:[1,1] op_sel_hi:[0,0] neg_hi:[1,0]
v_cmp_eq_u32 vcc, 0, v9
s_nop 1
v_cndmask_b32 v13, -16, v8, vcc
buffer_store_dwordx4 v[208:211], v13, s[84:87], s13 offen sc1
s_add_u32 s13, s13, 1048576
s_mov_b32 s93, s21
s_cmp_lt_u32 s93, 128
s_cbranch_scc1 mega_kernel_f1_l
mega_kernel_f1_e:
s_mov_b32 s93, s40
s_waitcnt vmcnt(0)
s_load_dwordx2 s[4:5], s[0:1], 64
s_load_dwordx2 s[8:9], s[0:1], 72
v_and_b32 v1, 63, v0
v_lshrrev_b32 v2, 6, v0
v_mul_u32_u24 v3, 1026, v2
v_lshl_add_u32 v3, v1, 1, v3
v_mul_u32_u24 v4, 65, v1
v_add_u32 v4, v4, v2
v_lshlrev_b32 v4, 2, v4
v_lshrrev_b32 v7, 4, v0
v_and_b32 v8, 15, v0
v_mul_u32_u24 v5, 65, v7
v_lshl_add_u32 v5, v8, 2, v5
v_lshlrev_b32 v5, 2, v5
v_mul_u32_u24 v6, 16384, v7
v_lshl_add_u32 v6, v8, 4, v6
s_add_u32 s24, s84, 171966464
s_addc_u32 s25, s85, 0
s_mov_b32 s26, 8404992
s_mov_b32 s27, 0x00020000
s_waitcnt lgkmcnt(0)
s_mov_b32 s6, 2101248
s_mov_b32 s7, 0x00020000
s_mov_b32 s10, 2101248
s_mov_b32 s11, 0x00020000
v_lshlrev_b32 v9, 7, v0
s_and_b32 s12, s93, 31
s_mul_i32 s12, s12, 65664
buffer_load_dword v250, v9, s[4:7], s12 offen
buffer_load_dword v250, v9, s[8:11], s12 offen
s_add_u32 s12, s12, 32768
buffer_load_dword v250, v9, s[4:7], s12 offen
buffer_load_dword v250, v9, s[8:11], s12 offen
s_add_u32 s12, s12, 32768
s_cmp_lt_u32 s93, 288
s_cbranch_scc0 mega_kernel_f0_e
s_and_b32 s12, s93, 31
s_mul_i32 s12, s12, 65664
s_lshr_b32 s13, s93, 5
s_lshl_b32 s13, s13, 7
s_add_u32 s12, s12, s13
buffer_load_ushort v16, v3, s[4:7], s12 offen
buffer_load_ushort v32, v3, s[8:11], s12 offen
s_add_u32 s12, s12, 4104
buffer_load_ushort v17, v3, s[4:7], s12 offen
buffer_load_ushort v33, v3, s[8:11], s12 offen
s_add_u32 s12, s12, 4104
buffer_load_ushort v18, v3, s[4:7], s12 offen
buffer_load_ushort v34, v3, s[8:11], s12 offen
s_add_u32 s12, s12, 4104
buffer_load_ushort v19, v3, s[4:7], s12 offen
buffer_load_ushort v35, v3, s[8:11], s12 offen
s_add_u32 s12, s12, 4104
buffer_load_ushort v20, v3, s[4:7], s12 offen
buffer_load_ushort v36, v3, s[8:11], s12 offen
s_add_u32 s12, s12, 4104
buffer_load_ushort v21, v3, s[4:7], s12 offen
buffer_load_ushort v37, v3, s[8:11], s12 offen
s_add_u32 s12, s12, 4104
buffer_load_ushort v22, v3, s[4:7], s12 offen
buffer_load_ushort v38, v3, s[8:11], s12 offen
s_add_u32 s12, s12, 4104
buffer_load_ushort v23, v3, s[4:7], s12 offen
buffer_load_ushort v39, v3, s[8:11], s12 offen
s_add_u32 s12, s12, 4104
buffer_load_ushort v24, v3, s[4:7], s12 offen
buffer_load_ushort v40, v3, s[8:11], s12 offen
s_add_u32 s12, s12, 4104
buffer_load_ushort v25, v3, s[4:7], s12 offen
buffer_load_ushort v41, v3, s[8:11], s12 offen
s_add_u32 s12, s12, 4104
buffer_load_ushort v26, v3, s[4:7], s12 offen
buffer_load_ushort v42, v3, s[8:11], s12 offen
s_add_u32 s12, s12, 4104
buffer_load_ushort v27, v3, s[4:7], s12 offen
buffer_load_ushort v43, v3, s[8:11], s12 offen
s_add_u32 s12, s12, 4104
buffer_load_ushort v28, v3, s[4:7], s12 offen
buffer_load_ushort v44, v3, s[8:11], s12 offen
s_add_u32 s12, s12, 4104
buffer_load_ushort v29, v3, s[4:7], s12 offen
buffer_load_ushort v45, v3, s[8:11], s12 offen
s_add_u32 s12, s12, 4104
buffer_load_ushort v30, v3, s[4:7], s12 offen
buffer_load_ushort v46, v3, s[8:11], s12 offen
s_add_u32 s12, s12, 4104
buffer_load_ushort v31, v3, s[4:7], s12 offen
buffer_load_ushort v47, v3, s[8:11], s12 offen
s_add_u32 s12, s12, 4104
s_waitcnt vmcnt(0)
mega_kernel_f0_l:
s_add_u32 s21, s93, 32
s_cmp_lt_u32 s21, 288
s_cselect_b32 s22, s21, s93
s_waitcnt vmcnt(4)
v_lshl_or_b32 v48, v32, 16, v16
v_lshl_or_b32 v49, v33, 16, v17
v_lshl_or_b32 v50, v34, 16, v18
v_lshl_or_b32 v51, v35, 16, v19
v_lshl_or_b32 v52, v36, 16, v20
v_lshl_or_b32 v53, v37, 16, v21
v_lshl_or_b32 v54, v38, 16, v22
v_lshl_or_b32 v55, v39, 16, v23
v_lshl_or_b32 v56, v40, 16, v24
v_lshl_or_b32 v57, v41, 16, v25
v_lshl_or_b32 v58, v42, 16, v26
v_lshl_or_b32 v59, v43, 16, v27
v_lshl_or_b32 v60, v44, 16, v28
v_lshl_or_b32 v61, v45, 16, v29
v_lshl_or_b32 v62, v46, 16, v30
v_lshl_or_b32 v63, v47, 16, v31
s_and_b32 s12, s22, 31
s_mul_i32 s12, s12, 65664
s_lshr_b32 s13, s22, 5
s_lshl_b32 s13, s13, 7
s_add_u32 s12, s12, s13
buffer_load_ushort v16, v3, s[4:7], s12 offen
buffer_load_ushort v32, v3, s[8:11], s12 offen
s_add_u32 s12, s12, 4104
buffer_load_ushort v17, v3, s[4:7], s12 offen
buffer_load_ushort v33, v3, s[8:11], s12 offen
s_add_u32 s12, s12, 4104
buffer_load_ushort v18, v3, s[4:7], s12 offen
buffer_load_ushort v34, v3, s[8:11], s12 offen
s_add_u32 s12, s12, 4104
buffer_load_ushort v19, v3, s[4:7], s12 offen
buffer_load_ushort v35, v3, s[8:11], s12 offen
s_add_u32 s12, s12, 4104
buffer_load_ushort v20, v3, s[4:7], s12 offen
buffer_load_ushort v36, v3, s[8:11], s12 offen
s_add_u32 s12, s12, 4104
buffer_load_ushort v21, v3, s[4:7], s12 offen
buffer_load_ushort v37, v3, s[8:11], s12 offen
s_add_u32 s12, s12, 4104
buffer_load_ushort v22, v3, s[4:7], s12 offen
buffer_load_ushort v38, v3, s[8:11], s12 offen
s_add_u32 s12, s12, 4104
buffer_load_ushort v23, v3, s[4:7], s12 offen
buffer_load_ushort v39, v3, s[8:11], s12 offen
s_add_u32 s12, s12, 4104
buffer_load_ushort v24, v3, s[4:7], s12 offen
buffer_load_ushort v40, v3, s[8:11], s12 offen
s_add_u32 s12, s12, 4104
buffer_load_ushort v25, v3, s[4:7], s12 offen
buffer_load_ushort v41, v3, s[8:11], s12 offen
s_add_u32 s12, s12, 4104
buffer_load_ushort v26, v3, s[4:7], s12 offen
buffer_load_ushort v42, v3, s[8:11], s12 offen
s_add_u32 s12, s12, 4104
buffer_load_ushort v27, v3, s[4:7], s12 offen
buffer_load_ushort v43, v3, s[8:11], s12 offen
s_add_u32 s12, s12, 4104
buffer_load_ushort v28, v3, s[4:7], s12 offen
buffer_load_ushort v44, v3, s[8:11], s12 offen
s_add_u32 s12, s12, 4104
buffer_load_ushort v29, v3, s[4:7], s12 offen
buffer_load_ushort v45, v3, s[8:11], s12 offen
s_add_u32 s12, s12, 4104
buffer_load_ushort v30, v3, s[4:7], s12 offen
buffer_load_ushort v46, v3, s[8:11], s12 offen
s_add_u32 s12, s12, 4104
buffer_load_ushort v31, v3, s[4:7], s12 offen
buffer_load_ushort v47, v3, s[8:11], s12 offen
s_add_u32 s12, s12, 4104
s_barrier
ds_write_b32 v4, v48 offset:0
ds_write_b32 v4, v49 offset:16
ds_write_b32 v4, v50 offset:32
ds_write_b32 v4, v51 offset:48
ds_write_b32 v4, v52 offset:64
ds_write_b32 v4, v53 offset:80
ds_write_b32 v4, v54 offset:96
ds_write_b32 v4, v55 offset:112
ds_write_b32 v4, v56 offset:128
ds_write_b32 v4, v57 offset:144
ds_write_b32 v4, v58 offset:160
ds_write_b32 v4, v59 offset:176
s_waitcnt lgkmcnt(4)
ds_write_b32 v4, v60 offset:192
ds_write_b32 v4, v61 offset:208
ds_write_b32 v4, v62 offset:224
ds_write_b32 v4, v63 offset:240
s_waitcnt lgkmcnt(0)
s_barrier
ds_read2_b32 v[64:65], v5 offset0:0 offset1:1
ds_read_b32 v66, v5 offset:8
ds_read_b32 v67, v5 offset:12
ds_read_b32 v68, v5 offset:4160
ds_read_b32 v69, v5 offset:4164
ds_read_b32 v70, v5 offset:4168
ds_read_b32 v71, v5 offset:4172
ds_read_b32 v72, v5 offset:8320
ds_read_b32 v73, v5 offset:8324
ds_read_b32 v74, v5 offset:8328
ds_read_b32 v75, v5 offset:8332
ds_read_b32 v76, v5 offset:12480
ds_read_b32 v77, v5 offset:12484
ds_read_b32 v78, v5 offset:12488
ds_read_b32 v79, v5 offset:12492
s_and_b32 s14, s93, 31
s_lshl_b32 s14, s14, 8
s_lshr_b32 s15, s93, 5
s_lshr_b32 s23, s15, 1
s_xnor_b32 s23, s23, s98
s_and_b32 s23, s23, 1
s_lshl_b32 s23, s23, 13
s_mul_i32 s15, s15, 1048576
s_add_u32 s15, s15, 0
s_add_u32 s15, s15, s23
s_add_u32 s14, s14, s15
s_waitcnt lgkmcnt(0)
buffer_store_dwordx4 v[64:67], v6, s[24:27], s14 offen sc1
s_add_u32 s14, s14, 262144
buffer_store_dwordx4 v[68:71], v6, s[24:27], s14 offen sc1
s_add_u32 s14, s14, 262144
buffer_store_dwordx4 v[72:75], v6, s[24:27], s14 offen sc1
s_add_u32 s14, s14, 262144
buffer_store_dwordx4 v[76:79], v6, s[24:27], s14 offen sc1
s_add_u32 s14, s14, 262144
s_mov_b32 s93, s21
s_cmp_lt_u32 s93, 288
s_cbranch_scc1 mega_kernel_f0_l
mega_kernel_f0_e:
v_and_b32 v3, 15, v0
v_lshlrev_b32 v3, 4, v3
s_branch mega_kernel_syd
mega_kernel_sydw:
s_sleep 4
mega_kernel_syd:
buffer_load_dword v2, v3, s[72:75], 0 offen sc1
s_waitcnt vmcnt(0)
mega_kernel_sydp:
s_cmp_eq_u32 s95, 1
s_cbranch_scc0 mega_kernel_sydf
v_readlane_b32 s76, v2, 14
s_mov_b32 s98, 0
s_cmp_eq_u32 s76, 32
s_cbranch_scc0 mega_kernel_sydw
s_branch mega_kernel_sydd
mega_kernel_sydf:
s_mov_b32 s77, 0
s_mov_b32 s78, 0
v_readlane_b32 s76, v2, 0
s_add_u32 s77, s77, s76
s_xor_b32 s76, s76, 32
s_or_b32 s78, s78, s76
v_readlane_b32 s76, v2, 1
s_add_u32 s77, s77, s76
s_xor_b32 s76, s76, 32
s_or_b32 s78, s78, s76
v_readlane_b32 s76, v2, 2
s_add_u32 s77, s77, s76
s_xor_b32 s76, s76, 32
s_or_b32 s78, s78, s76
v_readlane_b32 s76, v2, 3
s_add_u32 s77, s77, s76
s_xor_b32 s76, s76, 32
s_or_b32 s78, s78, s76
v_readlane_b32 s76, v2, 4
s_add_u32 s77, s77, s76
s_xor_b32 s76, s76, 32
s_or_b32 s78, s78, s76
v_readlane_b32 s76, v2, 5
s_add_u32 s77, s77, s76
s_xor_b32 s76, s76, 32
s_or_b32 s78, s78, s76
v_readlane_b32 s76, v2, 6
s_add_u32 s77, s77, s76
s_xor_b32 s76, s76, 32
s_or_b32 s78, s78, s76
v_readlane_b32 s76, v2, 7
s_add_u32 s77, s77, s76
s_xor_b32 s76, s76, 32
s_or_b32 s78, s78, s76
s_cmp_eq_u32 s77, 256
s_cbranch_scc0 mega_kernel_sydw
v_mov_b32 v252, v2
s_cmp_eq_u32 s78, 0
s_cbranch_scc0 mega_kernel_slowent
v_readlane_b32 s76, v2, 10
v_readlane_b32 s77, v2, 8
s_cmp_eq_u32 s76, 32
s_cbranch_scc0 mega_kernel_sydw
s_cmp_gt_u32 s77, 16
s_cselect_b32 s98, 1, 0
mega_kernel_sydd:
s_waitcnt vmcnt(0)
s_barrier
v_mov_b32 v1, 0
v_mov_b32 v2, 1
s_mov_b32 s82, 69259264
v_cmp_eq_u32 vcc, 0, v0
s_and_saveexec_b64 s[80:81], vcc
s_cbranch_execz mega_kernel_sg0
buffer_atomic_add v2, v1, s[84:87], s82 offen sc1
mega_kernel_sg0:
s_mov_b64 exec, s[80:81]
s_add_u32 s38, s40, 129
s_mov_b32 s39, 32
s_mov_b32 s37, 129
s_cmp_lt_u32 s38, 129
s_cbranch_scc1 mega_kernel_f2s
s_branch mega_kernel_f2e
mega_kernel_rk:
s_load_dwordx2 s[4:5], s[0:1], 24
s_load_dwordx2 s[8:9], s[0:1], 0
v_lshrrev_b32 v2, 6, v0
v_and_b32 v1, 63, v0
v_readfirstlane_b32 s41, v2
v_lshlrev_b32 v5, 4, v1
s_waitcnt lgkmcnt(0)
s_mov_b32 s6, 8388608
s_mov_b32 s7, 0x00020000
s_mov_b32 s10, 4194304
s_mov_b32 s11, 0x00020000
s_lshl_b32 s43, s40, 8
s_lshl_b32 s44, s41, 6
s_add_u32 s48, s43, s44
s_and_b32 s43, s48, 0x7ff
v_add_u32 v19, s43, v1
v_lshlrev_b32 v19, 7, v19
s_mov_b32 s43, 0
buffer_load_dword v250, v19, s[8:11], s43 offen
s_nop 0
v_lshrrev_b32 v2, 3, v1
s_lshl_b32 s43, s41, 3
v_add_u32 v2, s43, v2
v_bfe_u32 v3, v2, 1, 3
v_and_b32 v4, 7, v1
v_xor_b32 v3, v3, v4
v_lshlrev_b32 v6, 11, v2
v_lshl_add_u32 v6, v3, 4, v6
s_lshl_b32 s46, s41, 10
v_and_b32 v2, 15, v1
v_bfe_u32 v3, v2, 1, 3
v_lshrrev_b32 v4, 4, v1
v_xor_b32 v3, v3, v4
v_lshlrev_b32 v8, 7, v2
v_lshl_add_u32 v8, v3, 4, v8
v_xor_b32 v9, 64, v8
v_add_u32 v10, 0x10000, v8
v_add_u32 v11, 0x10000, v9
v_mov_b32 v7, v5
s_lshl_b32 s47, s40, 2
s_add_u32 s47, s47, s41
s_mov_b32 s42, 0
s_mov_b32 s50, 0
s_add_u32 m0, s46, 0
s_nop 0
buffer_load_dwordx4 v6, s[8:11], s50 offen offset:0 lds
s_add_u32 m0, s46, 3968
s_nop 0
buffer_load_dwordx4 v6, s[8:11], s50 offen offset:128 lds
s_add_u32 m0, s46, 7936
s_nop 0
buffer_load_dwordx4 v6, s[8:11], s50 offen offset:256 lds
s_add_u32 m0, s46, 11904
s_nop 0
buffer_load_dwordx4 v6, s[8:11], s50 offen offset:384 lds
s_add_u32 m0, s46, 15872
s_nop 0
buffer_load_dwordx4 v6, s[8:11], s50 offen offset:512 lds
s_add_u32 m0, s46, 19840
s_nop 0
buffer_load_dwordx4 v6, s[8:11], s50 offen offset:640 lds
s_add_u32 m0, s46, 23808
s_nop 0
buffer_load_dwordx4 v6, s[8:11], s50 offen offset:768 lds
s_add_u32 m0, s46, 27776
s_nop 0
buffer_load_dwordx4 v6, s[8:11], s50 offen offset:896 lds
s_add_u32 m0, s46, 31744
s_nop 0
buffer_load_dwordx4 v6, s[8:11], s50 offen offset:1024 lds
s_add_u32 m0, s46, 35712
s_nop 0
buffer_load_dwordx4 v6, s[8:11], s50 offen offset:1152 lds
s_add_u32 m0, s46, 39680
s_nop 0
buffer_load_dwordx4 v6, s[8:11], s50 offen offset:1280 lds
s_add_u32 m0, s46, 43648
s_nop 0
buffer_load_dwordx4 v6, s[8:11], s50 offen offset:1408 lds
s_add_u32 m0, s46, 47616
s_nop 0
buffer_load_dwordx4 v6, s[8:11], s50 offen offset:1536 lds
s_add_u32 m0, s46, 51584
s_nop 0
buffer_load_dwordx4 v6, s[8:11], s50 offen offset:1664 lds
s_add_u32 m0, s46, 55552
s_nop 0
buffer_load_dwordx4 v6, s[8:11], s50 offen offset:1792 lds
s_add_u32 m0, s46, 59520
s_nop 0
buffer_load_dwordx4 v6, s[8:11], s50 offen offset:1920 lds
v_lshrrev_b32 v2, 2, v1
v_and_b32 v3, 3, v1
v_lshlrev_b32 v16, 13, v2
v_lshl_add_u32 v16, v3, 4, v16
v_add_u32 v16, s48, v16
s_mul_i32 s45, s41, 24576
s_add_u32 s45, s45, 65536
v_bfe_u32 v17, v1, 2, 2
v_lshrrev_b32 v18, 4, v1
v_lshl_add_u32 v17, v18, 3, v17
v_lshlrev_b32 v17, 6, v17
v_lshl_add_u32 v17, v3, 4, v17
v_add_u32 v17, s45, v17
s_and_b32 s43, s40, 3
s_lshl_b32 s43, s43, 2
s_add_u32 s43, s43, s41
s_lshl_b32 s43, s43, 3
v_and_b32 v12, 7, v1
v_add_u32 v12, s43, v12
s_lshr_b32 s43, s40, 2
s_lshl_b32 s43, s43, 10
s_add_u32 s44, s43, 896
s_add_u32 s43, s43, 384
s_cmp_ge_u32 s40, 28
s_cselect_b32 s44, s44, s43
v_mov_b32 v13, s43
v_mov_b32 v14, s44
v_cmp_gt_u32 vcc, 32, v1
s_nop 1
v_cndmask_b32 v13, v14, v13, vcc
v_lshl_add_u32 v12, v12, 13, v13
s_mov_b32 s44, 0
buffer_load_dword v250, v12, s[4:7], s44 offen
s_add_u32 m0, s45, 0
s_mov_b32 s44, 0
buffer_load_dwordx4 v16, s[4:7], s44 offen lds
s_add_u32 m0, s45, 1024
s_mov_b32 s44, 131072
buffer_load_dwordx4 v16, s[4:7], s44 offen lds
s_add_u32 m0, s45, 2048
s_mov_b32 s44, 262144
buffer_load_dwordx4 v16, s[4:7], s44 offen lds
s_add_u32 m0, s45, 3072
s_mov_b32 s44, 393216
buffer_load_dwordx4 v16, s[4:7], s44 offen lds
s_add_u32 m0, s45, 4096
s_mov_b32 s44, 524288
buffer_load_dwordx4 v16, s[4:7], s44 offen lds
s_add_u32 m0, s45, 5120
s_mov_b32 s44, 655360
buffer_load_dwordx4 v16, s[4:7], s44 offen lds
s_add_u32 m0, s45, 6144
s_mov_b32 s44, 786432
buffer_load_dwordx4 v16, s[4:7], s44 offen lds
s_add_u32 m0, s45, 7168
s_mov_b32 s44, 917504
buffer_load_dwordx4 v16, s[4:7], s44 offen lds
s_mov_b32 s44, 1048576
buffer_load_dword v250, v12, s[4:7], s44 offen
s_add_u32 m0, s45, 8192
s_mov_b32 s44, 1048576
buffer_load_dwordx4 v16, s[4:7], s44 offen lds
s_add_u32 m0, s45, 9216
s_mov_b32 s44, 1179648
buffer_load_dwordx4 v16, s[4:7], s44 offen lds
s_add_u32 m0, s45, 10240
s_mov_b32 s44, 1310720
buffer_load_dwordx4 v16, s[4:7], s44 offen lds
s_add_u32 m0, s45, 11264
s_mov_b32 s44, 1441792
buffer_load_dwordx4 v16, s[4:7], s44 offen lds
s_add_u32 m0, s45, 12288
s_mov_b32 s44, 1572864
buffer_load_dwordx4 v16, s[4:7], s44 offen lds
s_add_u32 m0, s45, 13312
s_mov_b32 s44, 1703936
buffer_load_dwordx4 v16, s[4:7], s44 offen lds
s_add_u32 m0, s45, 14336
s_mov_b32 s44, 1835008
buffer_load_dwordx4 v16, s[4:7], s44 offen lds
s_add_u32 m0, s45, 15360
s_mov_b32 s44, 1966080
buffer_load_dwordx4 v16, s[4:7], s44 offen lds
s_mov_b32 s44, 2097152
buffer_load_dword v250, v12, s[4:7], s44 offen
s_add_u32 m0, s45, 16384
s_mov_b32 s44, 2097152
buffer_load_dwordx4 v16, s[4:7], s44 offen lds
s_add_u32 m0, s45, 17408
s_mov_b32 s44, 2228224
buffer_load_dwordx4 v16, s[4:7], s44 offen lds
s_add_u32 m0, s45, 18432
s_mov_b32 s44, 2359296
buffer_load_dwordx4 v16, s[4:7], s44 offen lds
s_add_u32 m0, s45, 19456
s_mov_b32 s44, 2490368
buffer_load_dwordx4 v16, s[4:7], s44 offen lds
s_add_u32 m0, s45, 20480
s_mov_b32 s44, 2621440
buffer_load_dwordx4 v16, s[4:7], s44 offen lds
s_add_u32 m0, s45, 21504
s_mov_b32 s44, 2752512
buffer_load_dwordx4 v16, s[4:7], s44 offen lds
s_add_u32 m0, s45, 22528
s_mov_b32 s44, 2883584
buffer_load_dwordx4 v16, s[4:7], s44 offen lds
s_add_u32 m0, s45, 23552
s_mov_b32 s44, 3014656
buffer_load_dwordx4 v16, s[4:7], s44 offen lds
s_waitcnt vmcnt(18)
s_barrier
ds_read_b64_tr_b16 a[0:1], v17 offset:0
ds_read_b64_tr_b16 a[2:3], v17 offset:256
ds_read_b64_tr_b16 a[4:5], v17 offset:8
ds_read_b64_tr_b16 a[6:7], v17 offset:264
ds_read_b64_tr_b16 a[8:9], v17 offset:2048
ds_read_b64_tr_b16 a[10:11], v17 offset:2304
ds_read_b64_tr_b16 a[12:13], v17 offset:2056
ds_read_b64_tr_b16 a[14:15], v17 offset:2312
s_waitcnt lgkmcnt(0)
ds_read_b64_tr_b16 a[16:17], v17 offset:4096
ds_read_b64_tr_b16 a[18:19], v17 offset:4352
ds_read_b64_tr_b16 a[20:21], v17 offset:4104
ds_read_b64_tr_b16 a[22:23], v17 offset:4360
ds_read_b64_tr_b16 a[24:25], v17 offset:6144
ds_read_b64_tr_b16 a[26:27], v17 offset:6400
ds_read_b64_tr_b16 a[28:29], v17 offset:6152
ds_read_b64_tr_b16 a[30:31], v17 offset:6408
s_waitcnt lgkmcnt(0)
s_mov_b32 s44, 3145728
buffer_load_dword v250, v12, s[4:7], s44 offen
s_add_u32 m0, s45, 0
s_mov_b32 s44, 3145728
buffer_load_dwordx4 v16, s[4:7], s44 offen lds
s_add_u32 m0, s45, 1024
s_mov_b32 s44, 3276800
buffer_load_dwordx4 v16, s[4:7], s44 offen lds
s_add_u32 m0, s45, 2048
s_mov_b32 s44, 3407872
buffer_load_dwordx4 v16, s[4:7], s44 offen lds
s_add_u32 m0, s45, 3072
s_mov_b32 s44, 3538944
buffer_load_dwordx4 v16, s[4:7], s44 offen lds
s_add_u32 m0, s45, 4096
s_mov_b32 s44, 3670016
buffer_load_dwordx4 v16, s[4:7], s44 offen lds
s_add_u32 m0, s45, 5120
s_mov_b32 s44, 3801088
buffer_load_dwordx4 v16, s[4:7], s44 offen lds
s_add_u32 m0, s45, 6144
s_mov_b32 s44, 3932160
buffer_load_dwordx4 v16, s[4:7], s44 offen lds
s_add_u32 m0, s45, 7168
s_mov_b32 s44, 4063232
buffer_load_dwordx4 v16, s[4:7], s44 offen lds
ds_read_b128 v[20:23], v8 offset:0
ds_read_b128 v[24:27], v8 offset:2048
ds_read_b128 v[28:31], v9 offset:0
ds_read_b128 v[32:35], v9 offset:2048
ds_read_b128 v[36:39], v8 offset:4096
ds_read_b128 v[40:43], v8 offset:6144
ds_read_b128 v[44:47], v9 offset:4096
ds_read_b128 v[48:51], v9 offset:6144
s_waitcnt lgkmcnt(0)
v_mfma_f32_16x16x32_bf16 v[52:55], a[0:3], v[20:23], 0
v_mfma_f32_16x16x32_bf16 v[56:59], a[4:7], v[20:23], 0
v_mfma_f32_16x16x32_bf16 v[60:63], a[0:3], v[24:27], 0
v_mfma_f32_16x16x32_bf16 v[64:67], a[4:7], v[24:27], 0
v_mfma_f32_16x16x32_bf16 v[52:55], a[8:11], v[28:31], v[52:55]
v_mfma_f32_16x16x32_bf16 v[56:59], a[12:15], v[28:31], v[56:59]
v_mfma_f32_16x16x32_bf16 v[60:63], a[8:11], v[32:35], v[60:63]
v_mfma_f32_16x16x32_bf16 v[64:67], a[12:15], v[32:35], v[64:67]
v_mfma_f32_16x16x32_bf16 v[52:55], a[16:19], v[36:39], v[52:55]
v_mfma_f32_16x16x32_bf16 v[56:59], a[20:23], v[36:39], v[56:59]
v_mfma_f32_16x16x32_bf16 v[60:63], a[16:19], v[40:43], v[60:63]
v_mfma_f32_16x16x32_bf16 v[64:67], a[20:23], v[40:43], v[64:67]
v_mfma_f32_16x16x32_bf16 v[52:55], a[24:27], v[44:47], v[52:55]
v_mfma_f32_16x16x32_bf16 v[56:59], a[28:31], v[44:47], v[56:59]
v_mfma_f32_16x16x32_bf16 v[60:63], a[24:27], v[48:51], v[60:63]
v_mfma_f32_16x16x32_bf16 v[64:67], a[28:31], v[48:51], v[64:67]
s_waitcnt vmcnt(18)
ds_read_b64_tr_b16 a[32:33], v17 offset:8192
ds_read_b64_tr_b16 a[34:35], v17 offset:8448
ds_read_b64_tr_b16 a[36:37], v17 offset:8200
ds_read_b64_tr_b16 a[38:39], v17 offset:8456
ds_read_b64_tr_b16 a[40:41], v17 offset:10240
ds_read_b64_tr_b16 a[42:43], v17 offset:10496
ds_read_b64_tr_b16 a[44:45], v17 offset:10248
ds_read_b64_tr_b16 a[46:47], v17 offset:10504
s_waitcnt lgkmcnt(0)
ds_read_b64_tr_b16 a[48:49], v17 offset:12288
ds_read_b64_tr_b16 a[50:51], v17 offset:12544
ds_read_b64_tr_b16 a[52:53], v17 offset:12296
ds_read_b64_tr_b16 a[54:55], v17 offset:12552
ds_read_b64_tr_b16 a[56:57], v17 offset:14336
ds_read_b64_tr_b16 a[58:59], v17 offset:14592
ds_read_b64_tr_b16 a[60:61], v17 offset:14344
ds_read_b64_tr_b16 a[62:63], v17 offset:14600
s_waitcnt lgkmcnt(0)
s_mov_b32 s44, 4194304
buffer_load_dword v250, v12, s[4:7], s44 offen
s_add_u32 m0, s45, 8192
s_mov_b32 s44, 4194304
buffer_load_dwordx4 v16, s[4:7], s44 offen lds
s_add_u32 m0, s45, 9216
s_mov_b32 s44, 4325376
buffer_load_dwordx4 v16, s[4:7], s44 offen lds
s_add_u32 m0, s45, 10240
s_mov_b32 s44, 4456448
buffer_load_dwordx4 v16, s[4:7], s44 offen lds
s_add_u32 m0, s45, 11264
s_mov_b32 s44, 4587520
buffer_load_dwordx4 v16, s[4:7], s44 offen lds
s_add_u32 m0, s45, 12288
s_mov_b32 s44, 4718592
buffer_load_dwordx4 v16, s[4:7], s44 offen lds
s_add_u32 m0, s45, 13312
s_mov_b32 s44, 4849664
buffer_load_dwordx4 v16, s[4:7], s44 offen lds
s_add_u32 m0, s45, 14336
s_mov_b32 s44, 4980736
buffer_load_dwordx4 v16, s[4:7], s44 offen lds
s_add_u32 m0, s45, 15360
s_mov_b32 s44, 5111808
buffer_load_dwordx4 v16, s[4:7], s44 offen lds
ds_read_b128 v[20:23], v8 offset:8192
ds_read_b128 v[24:27], v8 offset:10240
ds_read_b128 v[28:31], v9 offset:8192
ds_read_b128 v[32:35], v9 offset:10240
ds_read_b128 v[36:39], v8 offset:12288
ds_read_b128 v[40:43], v8 offset:14336
ds_read_b128 v[44:47], v9 offset:12288
ds_read_b128 v[48:51], v9 offset:14336
s_waitcnt lgkmcnt(0)
v_mfma_f32_16x16x32_bf16 v[52:55], a[32:35], v[20:23], v[52:55]
v_mfma_f32_16x16x32_bf16 v[56:59], a[36:39], v[20:23], v[56:59]
v_mfma_f32_16x16x32_bf16 v[60:63], a[32:35], v[24:27], v[60:63]
v_mfma_f32_16x16x32_bf16 v[64:67], a[36:39], v[24:27], v[64:67]
v_mfma_f32_16x16x32_bf16 v[52:55], a[40:43], v[28:31], v[52:55]
v_mfma_f32_16x16x32_bf16 v[56:59], a[44:47], v[28:31], v[56:59]
v_mfma_f32_16x16x32_bf16 v[60:63], a[40:43], v[32:35], v[60:63]
v_mfma_f32_16x16x32_bf16 v[64:67], a[44:47], v[32:35], v[64:67]
v_mfma_f32_16x16x32_bf16 v[52:55], a[48:51], v[36:39], v[52:55]
v_mfma_f32_16x16x32_bf16 v[56:59], a[52:55], v[36:39], v[56:59]
v_mfma_f32_16x16x32_bf16 v[60:63], a[48:51], v[40:43], v[60:63]
v_mfma_f32_16x16x32_bf16 v[64:67], a[52:55], v[40:43], v[64:67]
v_mfma_f32_16x16x32_bf16 v[52:55], a[56:59], v[44:47], v[52:55]
v_mfma_f32_16x16x32_bf16 v[56:59], a[60:63], v[44:47], v[56:59]
v_mfma_f32_16x16x32_bf16 v[60:63], a[56:59], v[48:51], v[60:63]
v_mfma_f32_16x16x32_bf16 v[64:67], a[60:63], v[48:51], v[64:67]
s_waitcnt vmcnt(18)
ds_read_b64_tr_b16 a[64:65], v17 offset:16384
ds_read_b64_tr_b16 a[66:67], v17 offset:16640
ds_read_b64_tr_b16 a[68:69], v17 offset:16392
ds_read_b64_tr_b16 a[70:71], v17 offset:16648
ds_read_b64_tr_b16 a[72:73], v17 offset:18432
ds_read_b64_tr_b16 a[74:75], v17 offset:18688
ds_read_b64_tr_b16 a[76:77], v17 offset:18440
ds_read_b64_tr_b16 a[78:79], v17 offset:18696
s_waitcnt lgkmcnt(0)
ds_read_b64_tr_b16 a[80:81], v17 offset:20480
ds_read_b64_tr_b16 a[82:83], v17 offset:20736
ds_read_b64_tr_b16 a[84:85], v17 offset:20488
ds_read_b64_tr_b16 a[86:87], v17 offset:20744
ds_read_b64_tr_b16 a[88:89], v17 offset:22528
ds_read_b64_tr_b16 a[90:91], v17 offset:22784
ds_read_b64_tr_b16 a[92:93], v17 offset:22536
ds_read_b64_tr_b16 a[94:95], v17 offset:22792
s_waitcnt lgkmcnt(0)
s_mov_b32 s44, 5242880
buffer_load_dword v250, v12, s[4:7], s44 offen
s_add_u32 m0, s45, 16384
s_mov_b32 s44, 5242880
buffer_load_dwordx4 v16, s[4:7], s44 offen lds
s_add_u32 m0, s45, 17408
s_mov_b32 s44, 5373952
buffer_load_dwordx4 v16, s[4:7], s44 offen lds
s_add_u32 m0, s45, 18432
s_mov_b32 s44, 5505024
buffer_load_dwordx4 v16, s[4:7], s44 offen lds
s_add_u32 m0, s45, 19456
s_mov_b32 s44, 5636096
buffer_load_dwordx4 v16, s[4:7], s44 offen lds
s_add_u32 m0, s45, 20480
s_mov_b32 s44, 5767168
buffer_load_dwordx4 v16, s[4:7], s44 offen lds
s_add_u32 m0, s45, 21504
s_mov_b32 s44, 5898240
buffer_load_dwordx4 v16, s[4:7], s44 offen lds
s_add_u32 m0, s45, 22528
s_mov_b32 s44, 6029312
buffer_load_dwordx4 v16, s[4:7], s44 offen lds
s_add_u32 m0, s45, 23552
s_mov_b32 s44, 6160384
buffer_load_dwordx4 v16, s[4:7], s44 offen lds
ds_read_b128 v[20:23], v8 offset:16384
ds_read_b128 v[24:27], v8 offset:18432
ds_read_b128 v[28:31], v9 offset:16384
ds_read_b128 v[32:35], v9 offset:18432
ds_read_b128 v[36:39], v8 offset:20480
ds_read_b128 v[40:43], v8 offset:22528
ds_read_b128 v[44:47], v9 offset:20480
ds_read_b128 v[48:51], v9 offset:22528
s_waitcnt lgkmcnt(0)
v_mfma_f32_16x16x32_bf16 v[52:55], a[64:67], v[20:23], v[52:55]
v_mfma_f32_16x16x32_bf16 v[56:59], a[68:71], v[20:23], v[56:59]
v_mfma_f32_16x16x32_bf16 v[60:63], a[64:67], v[24:27], v[60:63]
v_mfma_f32_16x16x32_bf16 v[64:67], a[68:71], v[24:27], v[64:67]
v_mfma_f32_16x16x32_bf16 v[52:55], a[72:75], v[28:31], v[52:55]
v_mfma_f32_16x16x32_bf16 v[56:59], a[76:79], v[28:31], v[56:59]
v_mfma_f32_16x16x32_bf16 v[60:63], a[72:75], v[32:35], v[60:63]
v_mfma_f32_16x16x32_bf16 v[64:67], a[76:79], v[32:35], v[64:67]
v_mfma_f32_16x16x32_bf16 v[52:55], a[80:83], v[36:39], v[52:55]
v_mfma_f32_16x16x32_bf16 v[56:59], a[84:87], v[36:39], v[56:59]
v_mfma_f32_16x16x32_bf16 v[60:63], a[80:83], v[40:43], v[60:63]
v_mfma_f32_16x16x32_bf16 v[64:67], a[84:87], v[40:43], v[64:67]
v_mfma_f32_16x16x32_bf16 v[52:55], a[88:91], v[44:47], v[52:55]
v_mfma_f32_16x16x32_bf16 v[56:59], a[92:95], v[44:47], v[56:59]
v_mfma_f32_16x16x32_bf16 v[60:63], a[88:91], v[48:51], v[60:63]
v_mfma_f32_16x16x32_bf16 v[64:67], a[92:95], v[48:51], v[64:67]
s_waitcnt vmcnt(18)
ds_read_b64_tr_b16 a[96:97], v17 offset:0
ds_read_b64_tr_b16 a[98:99], v17 offset:256
ds_read_b64_tr_b16 a[100:101], v17 offset:8
ds_read_b64_tr_b16 a[102:103], v17 offset:264
ds_read_b64_tr_b16 a[104:105], v17 offset:2048
ds_read_b64_tr_b16 a[106:107], v17 offset:2304
ds_read_b64_tr_b16 a[108:109], v17 offset:2056
ds_read_b64_tr_b16 a[110:111], v17 offset:2312
s_waitcnt lgkmcnt(0)
ds_read_b64_tr_b16 a[112:113], v17 offset:4096
ds_read_b64_tr_b16 a[114:115], v17 offset:4352
ds_read_b64_tr_b16 a[116:117], v17 offset:4104
ds_read_b64_tr_b16 a[118:119], v17 offset:4360
ds_read_b64_tr_b16 a[120:121], v17 offset:6144
ds_read_b64_tr_b16 a[122:123], v17 offset:6400
ds_read_b64_tr_b16 a[124:125], v17 offset:6152
ds_read_b64_tr_b16 a[126:127], v17 offset:6408
s_waitcnt lgkmcnt(0)
s_mov_b32 s44, 6291456
buffer_load_dword v250, v12, s[4:7], s44 offen
s_add_u32 m0, s45, 0
s_mov_b32 s44, 6291456
buffer_load_dwordx4 v16, s[4:7], s44 offen lds
s_add_u32 m0, s45, 1024
s_mov_b32 s44, 6422528
buffer_load_dwordx4 v16, s[4:7], s44 offen lds
s_add_u32 m0, s45, 2048
s_mov_b32 s44, 6553600
buffer_load_dwordx4 v16, s[4:7], s44 offen lds
s_add_u32 m0, s45, 3072
s_mov_b32 s44, 6684672
buffer_load_dwordx4 v16, s[4:7], s44 offen lds
s_add_u32 m0, s45, 4096
s_mov_b32 s44, 6815744
buffer_load_dwordx4 v16, s[4:7], s44 offen lds
s_add_u32 m0, s45, 5120
s_mov_b32 s44, 6946816
buffer_load_dwordx4 v16, s[4:7], s44 offen lds
s_add_u32 m0, s45, 6144
s_mov_b32 s44, 7077888
buffer_load_dwordx4 v16, s[4:7], s44 offen lds
s_add_u32 m0, s45, 7168
s_mov_b32 s44, 7208960
buffer_load_dwordx4 v16, s[4:7], s44 offen lds
ds_read_b128 v[20:23], v8 offset:24576
ds_read_b128 v[24:27], v8 offset:26624
ds_read_b128 v[28:31], v9 offset:24576
ds_read_b128 v[32:35], v9 offset:26624
ds_read_b128 v[36:39], v8 offset:28672
ds_read_b128 v[40:43], v8 offset:30720
ds_read_b128 v[44:47], v9 offset:28672
ds_read_b128 v[48:51], v9 offset:30720
s_waitcnt lgkmcnt(0)
v_mfma_f32_16x16x32_bf16 v[52:55], a[96:99], v[20:23], v[52:55]
v_mfma_f32_16x16x32_bf16 v[56:59], a[100:103], v[20:23], v[56:59]
v_mfma_f32_16x16x32_bf16 v[60:63], a[96:99], v[24:27], v[60:63]
v_mfma_f32_16x16x32_bf16 v[64:67], a[100:103], v[24:27], v[64:67]
v_mfma_f32_16x16x32_bf16 v[52:55], a[104:107], v[28:31], v[52:55]
v_mfma_f32_16x16x32_bf16 v[56:59], a[108:111], v[28:31], v[56:59]
v_mfma_f32_16x16x32_bf16 v[60:63], a[104:107], v[32:35], v[60:63]
v_mfma_f32_16x16x32_bf16 v[64:67], a[108:111], v[32:35], v[64:67]
v_mfma_f32_16x16x32_bf16 v[52:55], a[112:115], v[36:39], v[52:55]
v_mfma_f32_16x16x32_bf16 v[56:59], a[116:119], v[36:39], v[56:59]
v_mfma_f32_16x16x32_bf16 v[60:63], a[112:115], v[40:43], v[60:63]
v_mfma_f32_16x16x32_bf16 v[64:67], a[116:119], v[40:43], v[64:67]
v_mfma_f32_16x16x32_bf16 v[52:55], a[120:123], v[44:47], v[52:55]
v_mfma_f32_16x16x32_bf16 v[56:59], a[124:127], v[44:47], v[56:59]
v_mfma_f32_16x16x32_bf16 v[60:63], a[120:123], v[48:51], v[60:63]
v_mfma_f32_16x16x32_bf16 v[64:67], a[124:127], v[48:51], v[64:67]
s_waitcnt vmcnt(18)
ds_read_b64_tr_b16 a[128:129], v17 offset:8192
ds_read_b64_tr_b16 a[130:131], v17 offset:8448
ds_read_b64_tr_b16 a[132:133], v17 offset:8200
ds_read_b64_tr_b16 a[134:135], v17 offset:8456
ds_read_b64_tr_b16 a[136:137], v17 offset:10240
ds_read_b64_tr_b16 a[138:139], v17 offset:10496
ds_read_b64_tr_b16 a[140:141], v17 offset:10248
ds_read_b64_tr_b16 a[142:143], v17 offset:10504
s_waitcnt lgkmcnt(0)
ds_read_b64_tr_b16 a[144:145], v17 offset:12288
ds_read_b64_tr_b16 a[146:147], v17 offset:12544
ds_read_b64_tr_b16 a[148:149], v17 offset:12296
ds_read_b64_tr_b16 a[150:151], v17 offset:12552
ds_read_b64_tr_b16 a[152:153], v17 offset:14336
ds_read_b64_tr_b16 a[154:155], v17 offset:14592
ds_read_b64_tr_b16 a[156:157], v17 offset:14344
ds_read_b64_tr_b16 a[158:159], v17 offset:14600
s_waitcnt lgkmcnt(0)
s_mov_b32 s44, 7340032
buffer_load_dword v250, v12, s[4:7], s44 offen
s_add_u32 m0, s45, 8192
s_mov_b32 s44, 7340032
buffer_load_dwordx4 v16, s[4:7], s44 offen lds
s_add_u32 m0, s45, 9216
s_mov_b32 s44, 7471104
buffer_load_dwordx4 v16, s[4:7], s44 offen lds
s_add_u32 m0, s45, 10240
s_mov_b32 s44, 7602176
buffer_load_dwordx4 v16, s[4:7], s44 offen lds
s_add_u32 m0, s45, 11264
s_mov_b32 s44, 7733248
buffer_load_dwordx4 v16, s[4:7], s44 offen lds
s_add_u32 m0, s45, 12288
s_mov_b32 s44, 7864320
buffer_load_dwordx4 v16, s[4:7], s44 offen lds
s_add_u32 m0, s45, 13312
s_mov_b32 s44, 7995392
buffer_load_dwordx4 v16, s[4:7], s44 offen lds
s_add_u32 m0, s45, 14336
s_mov_b32 s44, 8126464
buffer_load_dwordx4 v16, s[4:7], s44 offen lds
s_add_u32 m0, s45, 15360
s_mov_b32 s44, 8257536
buffer_load_dwordx4 v16, s[4:7], s44 offen lds
ds_read_b128 v[20:23], v8 offset:32768
ds_read_b128 v[24:27], v8 offset:34816
ds_read_b128 v[28:31], v9 offset:32768
ds_read_b128 v[32:35], v9 offset:34816
ds_read_b128 v[36:39], v8 offset:36864
ds_read_b128 v[40:43], v8 offset:38912
ds_read_b128 v[44:47], v9 offset:36864
ds_read_b128 v[48:51], v9 offset:38912
s_waitcnt lgkmcnt(0)
v_mfma_f32_16x16x32_bf16 v[52:55], a[128:131], v[20:23], v[52:55]
v_mfma_f32_16x16x32_bf16 v[56:59], a[132:135], v[20:23], v[56:59]
v_mfma_f32_16x16x32_bf16 v[60:63], a[128:131], v[24:27], v[60:63]
v_mfma_f32_16x16x32_bf16 v[64:67], a[132:135], v[24:27], v[64:67]
v_mfma_f32_16x16x32_bf16 v[52:55], a[136:139], v[28:31], v[52:55]
v_mfma_f32_16x16x32_bf16 v[56:59], a[140:143], v[28:31], v[56:59]
v_mfma_f32_16x16x32_bf16 v[60:63], a[136:139], v[32:35], v[60:63]
v_mfma_f32_16x16x32_bf16 v[64:67], a[140:143], v[32:35], v[64:67]
v_mfma_f32_16x16x32_bf16 v[52:55], a[144:147], v[36:39], v[52:55]
v_mfma_f32_16x16x32_bf16 v[56:59], a[148:151], v[36:39], v[56:59]
v_mfma_f32_16x16x32_bf16 v[60:63], a[144:147], v[40:43], v[60:63]
v_mfma_f32_16x16x32_bf16 v[64:67], a[148:151], v[40:43], v[64:67]
v_mfma_f32_16x16x32_bf16 v[52:55], a[152:155], v[44:47], v[52:55]
v_mfma_f32_16x16x32_bf16 v[56:59], a[156:159], v[44:47], v[56:59]
v_mfma_f32_16x16x32_bf16 v[60:63], a[152:155], v[48:51], v[60:63]
v_mfma_f32_16x16x32_bf16 v[64:67], a[156:159], v[48:51], v[64:67]
s_waitcnt vmcnt(18)
ds_read_b64_tr_b16 a[160:161], v17 offset:16384
ds_read_b64_tr_b16 a[162:163], v17 offset:16640
ds_read_b64_tr_b16 a[164:165], v17 offset:16392
ds_read_b64_tr_b16 a[166:167], v17 offset:16648
ds_read_b64_tr_b16 a[168:169], v17 offset:18432
ds_read_b64_tr_b16 a[170:171], v17 offset:18688
ds_read_b64_tr_b16 a[172:173], v17 offset:18440
ds_read_b64_tr_b16 a[174:175], v17 offset:18696
s_waitcnt lgkmcnt(0)
ds_read_b64_tr_b16 a[176:177], v17 offset:20480
ds_read_b64_tr_b16 a[178:179], v17 offset:20736
ds_read_b64_tr_b16 a[180:181], v17 offset:20488
ds_read_b64_tr_b16 a[182:183], v17 offset:20744
ds_read_b64_tr_b16 a[184:185], v17 offset:22528
ds_read_b64_tr_b16 a[186:187], v17 offset:22784
ds_read_b64_tr_b16 a[188:189], v17 offset:22536
ds_read_b64_tr_b16 a[190:191], v17 offset:22792
s_waitcnt lgkmcnt(0)
ds_read_b128 v[20:23], v8 offset:40960
ds_read_b128 v[24:27], v8 offset:43008
ds_read_b128 v[28:31], v9 offset:40960
ds_read_b128 v[32:35], v9 offset:43008
ds_read_b128 v[36:39], v8 offset:45056
ds_read_b128 v[40:43], v8 offset:47104
ds_read_b128 v[44:47], v9 offset:45056
ds_read_b128 v[48:51], v9 offset:47104
s_waitcnt lgkmcnt(0)
v_mfma_f32_16x16x32_bf16 v[52:55], a[160:163], v[20:23], v[52:55]
v_mfma_f32_16x16x32_bf16 v[56:59], a[164:167], v[20:23], v[56:59]
v_mfma_f32_16x16x32_bf16 v[60:63], a[160:163], v[24:27], v[60:63]
v_mfma_f32_16x16x32_bf16 v[64:67], a[164:167], v[24:27], v[64:67]
v_mfma_f32_16x16x32_bf16 v[52:55], a[168:171], v[28:31], v[52:55]
v_mfma_f32_16x16x32_bf16 v[56:59], a[172:175], v[28:31], v[56:59]
v_mfma_f32_16x16x32_bf16 v[60:63], a[168:171], v[32:35], v[60:63]
v_mfma_f32_16x16x32_bf16 v[64:67], a[172:175], v[32:35], v[64:67]
v_mfma_f32_16x16x32_bf16 v[52:55], a[176:179], v[36:39], v[52:55]
v_mfma_f32_16x16x32_bf16 v[56:59], a[180:183], v[36:39], v[56:59]
v_mfma_f32_16x16x32_bf16 v[60:63], a[176:179], v[40:43], v[60:63]
v_mfma_f32_16x16x32_bf16 v[64:67], a[180:183], v[40:43], v[64:67]
v_mfma_f32_16x16x32_bf16 v[52:55], a[184:187], v[44:47], v[52:55]
v_mfma_f32_16x16x32_bf16 v[56:59], a[188:191], v[44:47], v[56:59]
v_mfma_f32_16x16x32_bf16 v[60:63], a[184:187], v[48:51], v[60:63]
v_mfma_f32_16x16x32_bf16 v[64:67], a[188:191], v[48:51], v[64:67]
s_waitcnt vmcnt(9)
ds_read_b64_tr_b16 a[192:193], v17 offset:0
ds_read_b64_tr_b16 a[194:195], v17 offset:256
ds_read_b64_tr_b16 a[196:197], v17 offset:8
ds_read_b64_tr_b16 a[198:199], v17 offset:264
ds_read_b64_tr_b16 a[200:201], v17 offset:2048
ds_read_b64_tr_b16 a[202:203], v17 offset:2304
ds_read_b64_tr_b16 a[204:205], v17 offset:2056
ds_read_b64_tr_b16 a[206:207], v17 offset:2312
s_waitcnt lgkmcnt(0)
ds_read_b64_tr_b16 a[208:209], v17 offset:4096
ds_read_b64_tr_b16 a[210:211], v17 offset:4352
ds_read_b64_tr_b16 a[212:213], v17 offset:4104
ds_read_b64_tr_b16 a[214:215], v17 offset:4360
ds_read_b64_tr_b16 a[216:217], v17 offset:6144
ds_read_b64_tr_b16 a[218:219], v17 offset:6400
ds_read_b64_tr_b16 a[220:221], v17 offset:6152
ds_read_b64_tr_b16 a[222:223], v17 offset:6408
s_waitcnt lgkmcnt(0)
ds_read_b128 v[20:23], v8 offset:49152
ds_read_b128 v[24:27], v8 offset:51200
ds_read_b128 v[28:31], v9 offset:49152
ds_read_b128 v[32:35], v9 offset:51200
ds_read_b128 v[36:39], v8 offset:53248
ds_read_b128 v[40:43], v8 offset:55296
ds_read_b128 v[44:47], v9 offset:53248
ds_read_b128 v[48:51], v9 offset:55296
s_waitcnt lgkmcnt(0)
v_mfma_f32_16x16x32_bf16 v[52:55], a[192:195], v[20:23], v[52:55]
v_mfma_f32_16x16x32_bf16 v[56:59], a[196:199], v[20:23], v[56:59]
v_mfma_f32_16x16x32_bf16 v[60:63], a[192:195], v[24:27], v[60:63]
v_mfma_f32_16x16x32_bf16 v[64:67], a[196:199], v[24:27], v[64:67]
v_mfma_f32_16x16x32_bf16 v[52:55], a[200:203], v[28:31], v[52:55]
v_mfma_f32_16x16x32_bf16 v[56:59], a[204:207], v[28:31], v[56:59]
v_mfma_f32_16x16x32_bf16 v[60:63], a[200:203], v[32:35], v[60:63]
v_mfma_f32_16x16x32_bf16 v[64:67], a[204:207], v[32:35], v[64:67]
v_mfma_f32_16x16x32_bf16 v[52:55], a[208:211], v[36:39], v[52:55]
v_mfma_f32_16x16x32_bf16 v[56:59], a[212:215], v[36:39], v[56:59]
v_mfma_f32_16x16x32_bf16 v[60:63], a[208:211], v[40:43], v[60:63]
v_mfma_f32_16x16x32_bf16 v[64:67], a[212:215], v[40:43], v[64:67]
v_mfma_f32_16x16x32_bf16 v[52:55], a[216:219], v[44:47], v[52:55]
v_mfma_f32_16x16x32_bf16 v[56:59], a[220:223], v[44:47], v[56:59]
v_mfma_f32_16x16x32_bf16 v[60:63], a[216:219], v[48:51], v[60:63]
v_mfma_f32_16x16x32_bf16 v[64:67], a[220:223], v[48:51], v[64:67]
s_waitcnt vmcnt(0)
ds_read_b64_tr_b16 a[224:225], v17 offset:8192
ds_read_b64_tr_b16 a[226:227], v17 offset:8448
ds_read_b64_tr_b16 a[228:229], v17 offset:8200
ds_read_b64_tr_b16 a[230:231], v17 offset:8456
ds_read_b64_tr_b16 a[232:233], v17 offset:10240
ds_read_b64_tr_b16 a[234:235], v17 offset:10496
ds_read_b64_tr_b16 a[236:237], v17 offset:10248
ds_read_b64_tr_b16 a[238:239], v17 offset:10504
s_waitcnt lgkmcnt(0)
ds_read_b64_tr_b16 a[240:241], v17 offset:12288
ds_read_b64_tr_b16 a[242:243], v17 offset:12544
ds_read_b64_tr_b16 a[244:245], v17 offset:12296
ds_read_b64_tr_b16 a[246:247], v17 offset:12552
ds_read_b64_tr_b16 a[248:249], v17 offset:14336
ds_read_b64_tr_b16 a[250:251], v17 offset:14592
ds_read_b64_tr_b16 a[252:253], v17 offset:14344
ds_read_b64_tr_b16 a[254:255], v17 offset:14600
s_waitcnt lgkmcnt(0)
ds_read_b128 v[20:23], v8 offset:57344
ds_read_b128 v[24:27], v8 offset:59392
ds_read_b128 v[28:31], v9 offset:57344
ds_read_b128 v[32:35], v9 offset:59392
ds_read_b128 v[36:39], v8 offset:61440
ds_read_b128 v[40:43], v8 offset:63488
ds_read_b128 v[44:47], v9 offset:61440
ds_read_b128 v[48:51], v9 offset:63488
s_waitcnt lgkmcnt(0)
v_mfma_f32_16x16x32_bf16 v[52:55], a[224:227], v[20:23], v[52:55]
v_mfma_f32_16x16x32_bf16 v[56:59], a[228:231], v[20:23], v[56:59]
v_mfma_f32_16x16x32_bf16 v[60:63], a[224:227], v[24:27], v[60:63]
v_mfma_f32_16x16x32_bf16 v[64:67], a[228:231], v[24:27], v[64:67]
v_mfma_f32_16x16x32_bf16 v[52:55], a[232:235], v[28:31], v[52:55]
v_mfma_f32_16x16x32_bf16 v[56:59], a[236:239], v[28:31], v[56:59]
v_mfma_f32_16x16x32_bf16 v[60:63], a[232:235], v[32:35], v[60:63]
v_mfma_f32_16x16x32_bf16 v[64:67], a[236:239], v[32:35], v[64:67]
v_mfma_f32_16x16x32_bf16 v[52:55], a[240:243], v[36:39], v[52:55]
v_mfma_f32_16x16x32_bf16 v[56:59], a[244:247], v[36:39], v[56:59]
v_mfma_f32_16x16x32_bf16 v[60:63], a[240:243], v[40:43], v[60:63]
v_mfma_f32_16x16x32_bf16 v[64:67], a[244:247], v[40:43], v[64:67]
v_mfma_f32_16x16x32_bf16 v[52:55], a[248:251], v[44:47], v[52:55]
v_mfma_f32_16x16x32_bf16 v[56:59], a[252:255], v[44:47], v[56:59]
v_mfma_f32_16x16x32_bf16 v[60:63], a[248:251], v[48:51], v[60:63]
v_mfma_f32_16x16x32_bf16 v[64:67], a[252:255], v[48:51], v[64:67]
s_barrier
s_mov_b32 s50, 0x10000
s_add_u32 m0, s46, 65536
s_nop 0
buffer_load_dwordx4 v6, s[8:11], s50 offen offset:0 lds
s_add_u32 m0, s46, 69504
s_nop 0
buffer_load_dwordx4 v6, s[8:11], s50 offen offset:128 lds
s_add_u32 m0, s46, 73472
s_nop 0
buffer_load_dwordx4 v6, s[8:11], s50 offen offset:256 lds
s_add_u32 m0, s46, 77440
s_nop 0
buffer_load_dwordx4 v6, s[8:11], s50 offen offset:384 lds
s_add_u32 m0, s46, 81408
s_nop 0
buffer_load_dwordx4 v6, s[8:11], s50 offen offset:512 lds
s_add_u32 m0, s46, 85376
s_nop 0
buffer_load_dwordx4 v6, s[8:11], s50 offen offset:640 lds
s_add_u32 m0, s46, 89344
s_nop 0
buffer_load_dwordx4 v6, s[8:11], s50 offen offset:768 lds
s_add_u32 m0, s46, 93312
s_nop 0
buffer_load_dwordx4 v6, s[8:11], s50 offen offset:896 lds
s_add_u32 m0, s46, 97280
s_nop 0
buffer_load_dwordx4 v6, s[8:11], s50 offen offset:1024 lds
s_add_u32 m0, s46, 101248
s_nop 0
buffer_load_dwordx4 v6, s[8:11], s50 offen offset:1152 lds
s_add_u32 m0, s46, 105216
s_nop 0
buffer_load_dwordx4 v6, s[8:11], s50 offen offset:1280 lds
s_add_u32 m0, s46, 109184
s_nop 0
buffer_load_dwordx4 v6, s[8:11], s50 offen offset:1408 lds
s_add_u32 m0, s46, 113152
s_nop 0
buffer_load_dwordx4 v6, s[8:11], s50 offen offset:1536 lds
s_add_u32 m0, s46, 117120
s_nop 0
buffer_load_dwordx4 v6, s[8:11], s50 offen offset:1664 lds
s_add_u32 m0, s46, 121088
s_nop 0
buffer_load_dwordx4 v6, s[8:11], s50 offen offset:1792 lds
s_add_u32 m0, s46, 125056
s_nop 0
buffer_load_dwordx4 v6, s[8:11], s50 offen offset:1920 lds
s_and_b32 s53, s47, 31
s_lshl_b32 s53, s53, 4
v_add_u32 v19, s53, v1
v_lshlrev_b32 v19, 7, v19
s_mov_b32 s42, 1
v_and_b32 v3, 15, v0
v_lshlrev_b32 v3, 4, v3
s_branch mega_kernel_syk
mega_kernel_sykw:
s_sleep 4
mega_kernel_syk:
buffer_load_dword v2, v3, s[72:75], 0 offen sc1
s_waitcnt vmcnt(0)
mega_kernel_sykp:
s_cmp_eq_u32 s95, 1
s_cbranch_scc0 mega_kernel_sykf
v_readlane_b32 s76, v2, 14
s_mov_b32 s98, 0
s_cmp_eq_u32 s76, 32
s_cbranch_scc0 mega_kernel_sykw
s_branch mega_kernel_sykd
mega_kernel_sykf:
s_mov_b32 s77, 0
s_mov_b32 s78, 0
v_readlane_b32 s76, v2, 0
s_add_u32 s77, s77, s76
s_xor_b32 s76, s76, 32
s_or_b32 s78, s78, s76
v_readlane_b32 s76, v2, 1
s_add_u32 s77, s77, s76
s_xor_b32 s76, s76, 32
s_or_b32 s78, s78, s76
v_readlane_b32 s76, v2, 2
s_add_u32 s77, s77, s76
s_xor_b32 s76, s76, 32
s_or_b32 s78, s78, s76
v_readlane_b32 s76, v2, 3
s_add_u32 s77, s77, s76
s_xor_b32 s76, s76, 32
s_or_b32 s78, s78, s76
v_readlane_b32 s76, v2, 4
s_add_u32 s77, s77, s76
s_xor_b32 s76, s76, 32
s_or_b32 s78, s78, s76
v_readlane_b32 s76, v2, 5
s_add_u32 s77, s77, s76
s_xor_b32 s76, s76, 32
s_or_b32 s78, s78, s76
v_readlane_b32 s76, v2, 6
s_add_u32 s77, s77, s76
s_xor_b32 s76, s76, 32
s_or_b32 s78, s78, s76
v_readlane_b32 s76, v2, 7
s_add_u32 s77, s77, s76
s_xor_b32 s76, s76, 32
s_or_b32 s78, s78, s76
s_cmp_eq_u32 s77, 256
s_cbranch_scc0 mega_kernel_sykw
v_mov_b32 v252, v2
s_cmp_eq_u32 s78, 0
s_cbranch_scc0 mega_kernel_slowent
v_readlane_b32 s76, v2, 10
v_readlane_b32 s77, v2, 8
s_cmp_eq_u32 s76, 32
s_cbranch_scc0 mega_kernel_sykw
s_cmp_gt_u32 s77, 16
s_cselect_b32 s98, 1, 0
mega_kernel_sykd:
s_lshr_b32 s44, s47, 3
s_xor_b32 s44, s44, s98
s_and_b32 s44, s44, 1
s_lshl_b32 s44, s44, 13
s_lshl_b32 s48, s47, 18
s_add_u32 s48, s48, s44
s_add_u32 s48, s48, 0
s_xor_b32 s44, s98, 1
s_lshl_b32 s44, s44, 13
s_lshl_b32 s49, s40, 7
s_add_u32 s49, s49, s44
s_lshl_b32 s44, s41, 2
s_add_u32 s49, s49, s44
s_add_u32 s49, s49, 69206016
v_mov_b32 v16, 0
v_cvt_pk_bf16_f32 v84, v52, v53
v_cvt_pk_bf16_f32 v85, v54, v55
v_cvt_pk_bf16_f32 v86, v56, v57
v_cvt_pk_bf16_f32 v87, v58, v59
v_cvt_pk_bf16_f32 v88, v60, v61
v_cvt_pk_bf16_f32 v89, v62, v63
v_cvt_pk_bf16_f32 v90, v64, v65
v_cvt_pk_bf16_f32 v91, v66, v67
s_add_u32 s51, s42, s47
s_sub_u32 s51, s51, 1
s_bfe_u32 s52, s51, 0x40002
s_lshl_b32 s52, s52, 14
s_and_b32 s51, s51, 3
s_lshl_b32 s51, s51, 11
s_add_u32 s51, s51, s52
s_add_u32 s51, s51, s48
buffer_store_dwordx4 v[84:87], v7, s[84:87], s51 offen sc1
buffer_store_dwordx4 v[88:91], v7, s[84:87], s51 offen offset:1024 sc1
s_waitcnt vmcnt(0)
v_mov_b32 v17, s42
s_mov_b64 exec, 1
buffer_store_dword v17, v16, s[84:87], s49 offen sc1
s_mov_b64 exec, -1
mega_kernel_k_loop:
s_waitcnt vmcnt(2)
s_barrier
s_add_u32 s50, s42, 1
s_min_u32 s50, s50, 63
s_lshl_b32 s50, s50, 16
ds_read_b128 v[20:23], v10 offset:0
ds_read_b128 v[24:27], v10 offset:2048
ds_read_b128 v[28:31], v11 offset:0
ds_read_b128 v[32:35], v11 offset:2048
ds_read_b128 v[36:39], v10 offset:4096
ds_read_b128 v[40:43], v10 offset:6144
s_waitcnt lgkmcnt(4)
v_mfma_f32_16x16x32_bf16 v[68:71], a[0:3], v[20:23], 0
ds_read_b128 v[44:47], v11 offset:4096
v_mfma_f32_16x16x32_bf16 v[72:75], a[4:7], v[20:23], 0
v_cvt_pk_bf16_f32 v84, v52, v53
v_cvt_pk_bf16_f32 v85, v54, v55
v_cvt_pk_bf16_f32 v86, v56, v57
v_mfma_f32_16x16x32_bf16 v[76:79], a[0:3], v[24:27], 0
ds_read_b128 v[48:51], v11 offset:6144
v_mfma_f32_16x16x32_bf16 v[80:83], a[4:7], v[24:27], 0
v_cvt_pk_bf16_f32 v87, v58, v59
v_cvt_pk_bf16_f32 v88, v60, v61
v_cvt_pk_bf16_f32 v89, v62, v63
s_waitcnt lgkmcnt(4)
v_mfma_f32_16x16x32_bf16 v[68:71], a[8:11], v[28:31], v[68:71]
ds_read_b128 v[20:23], v10 offset:8192
v_mfma_f32_16x16x32_bf16 v[72:75], a[12:15], v[28:31], v[72:75]
v_cvt_pk_bf16_f32 v90, v64, v65
v_cvt_pk_bf16_f32 v91, v66, v67
v_mfma_f32_16x16x32_bf16 v[76:79], a[8:11], v[32:35], v[76:79]
ds_read_b128 v[24:27], v10 offset:10240
v_mfma_f32_16x16x32_bf16 v[80:83], a[12:15], v[32:35], v[80:83]
s_add_u32 s51, s42, s47
s_sub_u32 s51, s51, 1
s_bfe_u32 s52, s51, 0x40002
s_lshl_b32 s52, s52, 14
s_waitcnt lgkmcnt(4)
v_mfma_f32_16x16x32_bf16 v[68:71], a[16:19], v[36:39], v[68:71]
ds_read_b128 v[28:31], v11 offset:8192
v_mfma_f32_16x16x32_bf16 v[72:75], a[20:23], v[36:39], v[72:75]
s_and_b32 s51, s51, 3
s_lshl_b32 s51, s51, 11
s_add_u32 s51, s51, s52
s_add_u32 s51, s51, s48
buffer_store_dwordx4 v[84:87], v7, s[84:87], s51 offen sc1
v_mfma_f32_16x16x32_bf16 v[76:79], a[16:19], v[40:43], v[76:79]
ds_read_b128 v[32:35], v11 offset:10240
v_mfma_f32_16x16x32_bf16 v[80:83], a[20:23], v[40:43], v[80:83]
buffer_store_dwordx4 v[88:91], v7, s[84:87], s51 offen offset:1024 sc1
s_waitcnt lgkmcnt(4)
v_mfma_f32_16x16x32_bf16 v[68:71], a[24:27], v[44:47], v[68:71]
ds_read_b128 v[36:39], v10 offset:12288
v_mfma_f32_16x16x32_bf16 v[72:75], a[28:31], v[44:47], v[72:75]
s_add_u32 m0, s46, 0
v_mfma_f32_16x16x32_bf16 v[76:79], a[24:27], v[48:51], v[76:79]
ds_read_b128 v[40:43], v10 offset:14336
v_mfma_f32_16x16x32_bf16 v[80:83], a[28:31], v[48:51], v[80:83]
buffer_load_dwordx4 v6, s[8:11], s50 offen offset:0 lds
s_waitcnt lgkmcnt(4)
v_mfma_f32_16x16x32_bf16 v[68:71], a[32:35], v[20:23], v[68:71]
ds_read_b128 v[44:47], v11 offset:12288
v_mfma_f32_16x16x32_bf16 v[72:75], a[36:39], v[20:23], v[72:75]
s_add_u32 m0, s46, 3968
v_mfma_f32_16x16x32_bf16 v[76:79], a[32:35], v[24:27], v[76:79]
ds_read_b128 v[48:51], v11 offset:14336
v_mfma_f32_16x16x32_bf16 v[80:83], a[36:39], v[24:27], v[80:83]
buffer_load_dwordx4 v6, s[8:11], s50 offen offset:128 lds
s_waitcnt lgkmcnt(4)
v_mfma_f32_16x16x32_bf16 v[68:71], a[40:43], v[28:31], v[68:71]
ds_read_b128 v[20:23], v10 offset:16384
v_mfma_f32_16x16x32_bf16 v[72:75], a[44:47], v[28:31], v[72:75]
s_add_u32 m0, s46, 7936
v_mfma_f32_16x16x32_bf16 v[76:79], a[40:43], v[32:35], v[76:79]
ds_read_b128 v[24:27], v10 offset:18432
v_mfma_f32_16x16x32_bf16 v[80:83], a[44:47], v[32:35], v[80:83]
buffer_load_dwordx4 v6, s[8:11], s50 offen offset:256 lds
s_waitcnt lgkmcnt(4)
v_mfma_f32_16x16x32_bf16 v[68:71], a[48:51], v[36:39], v[68:71]
ds_read_b128 v[28:31], v11 offset:16384
v_mfma_f32_16x16x32_bf16 v[72:75], a[52:55], v[36:39], v[72:75]
s_add_u32 m0, s46, 11904
v_mfma_f32_16x16x32_bf16 v[76:79], a[48:51], v[40:43], v[76:79]
ds_read_b128 v[32:35], v11 offset:18432
v_mfma_f32_16x16x32_bf16 v[80:83], a[52:55], v[40:43], v[80:83]
buffer_load_dwordx4 v6, s[8:11], s50 offen offset:384 lds
s_waitcnt lgkmcnt(4)
v_mfma_f32_16x16x32_bf16 v[68:71], a[56:59], v[44:47], v[68:71]
ds_read_b128 v[36:39], v10 offset:20480
v_mfma_f32_16x16x32_bf16 v[72:75], a[60:63], v[44:47], v[72:75]
s_add_u32 m0, s46, 15872
v_mfma_f32_16x16x32_bf16 v[76:79], a[56:59], v[48:51], v[76:79]
ds_read_b128 v[40:43], v10 offset:22528
v_mfma_f32_16x16x32_bf16 v[80:83], a[60:63], v[48:51], v[80:83]
buffer_load_dwordx4 v6, s[8:11], s50 offen offset:512 lds
s_waitcnt lgkmcnt(4)
v_mfma_f32_16x16x32_bf16 v[68:71], a[64:67], v[20:23], v[68:71]
ds_read_b128 v[44:47], v11 offset:20480
v_mfma_f32_16x16x32_bf16 v[72:75], a[68:71], v[20:23], v[72:75]
s_add_u32 m0, s46, 19840
v_mfma_f32_16x16x32_bf16 v[76:79], a[64:67], v[24:27], v[76:79]
ds_read_b128 v[48:51], v11 offset:22528
v_mfma_f32_16x16x32_bf16 v[80:83], a[68:71], v[24:27], v[80:83]
buffer_load_dwordx4 v6, s[8:11], s50 offen offset:640 lds
s_waitcnt lgkmcnt(4)
v_mfma_f32_16x16x32_bf16 v[68:71], a[72:75], v[28:31], v[68:71]
ds_read_b128 v[20:23], v10 offset:24576
v_mfma_f32_16x16x32_bf16 v[72:75], a[76:79], v[28:31], v[72:75]
s_add_u32 m0, s46, 23808
v_mfma_f32_16x16x32_bf16 v[76:79], a[72:75], v[32:35], v[76:79]
ds_read_b128 v[24:27], v10 offset:26624
v_mfma_f32_16x16x32_bf16 v[80:83], a[76:79], v[32:35], v[80:83]
buffer_load_dwordx4 v6, s[8:11], s50 offen offset:768 lds
s_waitcnt lgkmcnt(4)
v_mfma_f32_16x16x32_bf16 v[68:71], a[80:83], v[36:39], v[68:71]
ds_read_b128 v[28:31], v11 offset:24576
v_mfma_f32_16x16x32_bf16 v[72:75], a[84:87], v[36:39], v[72:75]
s_add_u32 m0, s46, 27776
v_mfma_f32_16x16x32_bf16 v[76:79], a[80:83], v[40:43], v[76:79]
ds_read_b128 v[32:35], v11 offset:26624
v_mfma_f32_16x16x32_bf16 v[80:83], a[84:87], v[40:43], v[80:83]
buffer_load_dwordx4 v6, s[8:11], s50 offen offset:896 lds
s_waitcnt lgkmcnt(4)
v_mfma_f32_16x16x32_bf16 v[68:71], a[88:91], v[44:47], v[68:71]
ds_read_b128 v[36:39], v10 offset:28672
v_mfma_f32_16x16x32_bf16 v[72:75], a[92:95], v[44:47], v[72:75]
s_add_u32 m0, s46, 31744
v_mfma_f32_16x16x32_bf16 v[76:79], a[88:91], v[48:51], v[76:79]
ds_read_b128 v[40:43], v10 offset:30720
v_mfma_f32_16x16x32_bf16 v[80:83], a[92:95], v[48:51], v[80:83]
buffer_load_dwordx4 v6, s[8:11], s50 offen offset:1024 lds
s_waitcnt lgkmcnt(4)
v_mfma_f32_16x16x32_bf16 v[68:71], a[96:99], v[20:23], v[68:71]
ds_read_b128 v[44:47], v11 offset:28672
v_mfma_f32_16x16x32_bf16 v[72:75], a[100:103], v[20:23], v[72:75]
s_add_u32 m0, s46, 35712
v_mfma_f32_16x16x32_bf16 v[76:79], a[96:99], v[24:27], v[76:79]
ds_read_b128 v[48:51], v11 offset:30720
v_mfma_f32_16x16x32_bf16 v[80:83], a[100:103], v[24:27], v[80:83]
buffer_load_dwordx4 v6, s[8:11], s50 offen offset:1152 lds
s_waitcnt lgkmcnt(4)
v_mfma_f32_16x16x32_bf16 v[68:71], a[104:107], v[28:31], v[68:71]
ds_read_b128 v[20:23], v10 offset:32768
v_mfma_f32_16x16x32_bf16 v[72:75], a[108:111], v[28:31], v[72:75]
s_add_u32 m0, s46, 39680
v_mfma_f32_16x16x32_bf16 v[76:79], a[104:107], v[32:35], v[76:79]
ds_read_b128 v[24:27], v10 offset:34816
v_mfma_f32_16x16x32_bf16 v[80:83], a[108:111], v[32:35], v[80:83]
buffer_load_dwordx4 v6, s[8:11], s50 offen offset:1280 lds
s_waitcnt lgkmcnt(4)
v_mfma_f32_16x16x32_bf16 v[68:71], a[112:115], v[36:39], v[68:71]
ds_read_b128 v[28:31], v11 offset:32768
v_mfma_f32_16x16x32_bf16 v[72:75], a[116:119], v[36:39], v[72:75]
s_add_u32 m0, s46, 43648
v_mfma_f32_16x16x32_bf16 v[76:79], a[112:115], v[40:43], v[76:79]
ds_read_b128 v[32:35], v11 offset:34816
v_mfma_f32_16x16x32_bf16 v[80:83], a[116:119], v[40:43], v[80:83]
buffer_load_dwordx4 v6, s[8:11], s50 offen offset:1408 lds
s_waitcnt lgkmcnt(4)
v_mfma_f32_16x16x32_bf16 v[68:71], a[120:123], v[44:47], v[68:71]
ds_read_b128 v[36:39], v10 offset:36864
v_mfma_f32_16x16x32_bf16 v[72:75], a[124:127], v[44:47], v[72:75]
s_add_u32 m0, s46, 47616
v_mfma_f32_16x16x32_bf16 v[76:79], a[120:123], v[48:51], v[76:79]
ds_read_b128 v[40:43], v10 offset:38912
v_mfma_f32_16x16x32_bf16 v[80:83], a[124:127], v[48:51], v[80:83]
buffer_load_dwordx4 v6, s[8:11], s50 offen offset:1536 lds
s_waitcnt lgkmcnt(4)
v_mfma_f32_16x16x32_bf16 v[68:71], a[128:131], v[20:23], v[68:71]
ds_read_b128 v[44:47], v11 offset:36864
v_mfma_f32_16x16x32_bf16 v[72:75], a[132:135], v[20:23], v[72:75]
s_add_u32 m0, s46, 51584
v_mfma_f32_16x16x32_bf16 v[76:79], a[128:131], v[24:27], v[76:79]
ds_read_b128 v[48:51], v11 offset:38912
v_mfma_f32_16x16x32_bf16 v[80:83], a[132:135], v[24:27], v[80:83]
buffer_load_dwordx4 v6, s[8:11], s50 offen offset:1664 lds
s_waitcnt lgkmcnt(4)
v_mfma_f32_16x16x32_bf16 v[68:71], a[136:139], v[28:31], v[68:71]
ds_read_b128 v[20:23], v10 offset:40960
v_mfma_f32_16x16x32_bf16 v[72:75], a[140:143], v[28:31], v[72:75]
s_add_u32 m0, s46, 55552
v_mfma_f32_16x16x32_bf16 v[76:79], a[136:139], v[32:35], v[76:79]
ds_read_b128 v[24:27], v10 offset:43008
v_mfma_f32_16x16x32_bf16 v[80:83], a[140:143], v[32:35], v[80:83]
buffer_load_dwordx4 v6, s[8:11], s50 offen offset:1792 lds
s_waitcnt lgkmcnt(4)
v_mfma_f32_16x16x32_bf16 v[68:71], a[144:147], v[36:39], v[68:71]
ds_read_b128 v[28:31], v11 offset:40960
v_mfma_f32_16x16x32_bf16 v[72:75], a[148:151], v[36:39], v[72:75]
s_add_u32 m0, s46, 59520
v_mfma_f32_16x16x32_bf16 v[76:79], a[144:147], v[40:43], v[76:79]
ds_read_b128 v[32:35], v11 offset:43008
v_mfma_f32_16x16x32_bf16 v[80:83], a[148:151], v[40:43], v[80:83]
buffer_load_dwordx4 v6, s[8:11], s50 offen offset:1920 lds
s_waitcnt lgkmcnt(4)
v_mfma_f32_16x16x32_bf16 v[68:71], a[152:155], v[44:47], v[68:71]
ds_read_b128 v[36:39], v10 offset:45056
v_mfma_f32_16x16x32_bf16 v[72:75], a[156:159], v[44:47], v[72:75]
v_mfma_f32_16x16x32_bf16 v[76:79], a[152:155], v[48:51], v[76:79]
ds_read_b128 v[40:43], v10 offset:47104
v_mfma_f32_16x16x32_bf16 v[80:83], a[156:159], v[48:51], v[80:83]
s_waitcnt lgkmcnt(4)
v_mfma_f32_16x16x32_bf16 v[68:71], a[160:163], v[20:23], v[68:71]
ds_read_b128 v[44:47], v11 offset:45056
v_mfma_f32_16x16x32_bf16 v[72:75], a[164:167], v[20:23], v[72:75]
v_mfma_f32_16x16x32_bf16 v[76:79], a[160:163], v[24:27], v[76:79]
ds_read_b128 v[48:51], v11 offset:47104
v_mfma_f32_16x16x32_bf16 v[80:83], a[164:167], v[24:27], v[80:83]
s_waitcnt lgkmcnt(4)
v_mfma_f32_16x16x32_bf16 v[68:71], a[168:171], v[28:31], v[68:71]
ds_read_b128 v[20:23], v10 offset:49152
v_mfma_f32_16x16x32_bf16 v[72:75], a[172:175], v[28:31], v[72:75]
s_waitcnt vmcnt(16)
v_mov_b32 v17, s42
s_mov_b64 exec, 1
buffer_store_dword v17, v16, s[84:87], s49 offen sc1
s_mov_b64 exec, -1
v_mfma_f32_16x16x32_bf16 v[76:79], a[168:171], v[32:35], v[76:79]
ds_read_b128 v[24:27], v10 offset:51200
v_mfma_f32_16x16x32_bf16 v[80:83], a[172:175], v[32:35], v[80:83]
s_waitcnt lgkmcnt(4)
v_mfma_f32_16x16x32_bf16 v[68:71], a[176:179], v[36:39], v[68:71]
ds_read_b128 v[28:31], v11 offset:49152
v_mfma_f32_16x16x32_bf16 v[72:75], a[180:183], v[36:39], v[72:75]
s_add_u32 s53, s42, 3
s_min_u32 s53, s53, 63
s_lshl_b32 s53, s53, 16
s_mov_b64 exec, 0xffff
buffer_load_dword v250, v19, s[8:11], s53 offen
s_mov_b64 exec, -1
v_mfma_f32_16x16x32_bf16 v[76:79], a[176:179], v[40:43], v[76:79]
ds_read_b128 v[32:35], v11 offset:51200
v_mfma_f32_16x16x32_bf16 v[80:83], a[180:183], v[40:43], v[80:83]
s_waitcnt lgkmcnt(4)
v_mfma_f32_16x16x32_bf16 v[68:71], a[184:187], v[44:47], v[68:71]
ds_read_b128 v[36:39], v10 offset:53248
v_mfma_f32_16x16x32_bf16 v[72:75], a[188:191], v[44:47], v[72:75]
v_mfma_f32_16x16x32_bf16 v[76:79], a[184:187], v[48:51], v[76:79]
ds_read_b128 v[40:43], v10 offset:55296
v_mfma_f32_16x16x32_bf16 v[80:83], a[188:191], v[48:51], v[80:83]
s_waitcnt lgkmcnt(4)
v_mfma_f32_16x16x32_bf16 v[68:71], a[192:195], v[20:23], v[68:71]
ds_read_b128 v[44:47], v11 offset:53248
v_mfma_f32_16x16x32_bf16 v[72:75], a[196:199], v[20:23], v[72:75]
v_mfma_f32_16x16x32_bf16 v[76:79], a[192:195], v[24:27], v[76:79]
ds_read_b128 v[48:51], v11 offset:55296
v_mfma_f32_16x16x32_bf16 v[80:83], a[196:199], v[24:27], v[80:83]
s_waitcnt lgkmcnt(4)
v_mfma_f32_16x16x32_bf16 v[68:71], a[200:203], v[28:31], v[68:71]
ds_read_b128 v[20:23], v10 offset:57344
v_mfma_f32_16x16x32_bf16 v[72:75], a[204:207], v[28:31], v[72:75]
v_mfma_f32_16x16x32_bf16 v[76:79], a[200:203], v[32:35], v[76:79]
ds_read_b128 v[24:27], v10 offset:59392
v_mfma_f32_16x16x32_bf16 v[80:83], a[204:207], v[32:35], v[80:83]
s_waitcnt lgkmcnt(4)
v_mfma_f32_16x16x32_bf16 v[68:71], a[208:211], v[36:39], v[68:71]
ds_read_b128 v[28:31], v11 offset:57344
v_mfma_f32_16x16x32_bf16 v[72:75], a[212:215], v[36:39], v[72:75]
v_mfma_f32_16x16x32_bf16 v[76:79], a[208:211], v[40:43], v[76:79]
ds_read_b128 v[32:35], v11 offset:59392
v_mfma_f32_16x16x32_bf16 v[80:83], a[212:215], v[40:43], v[80:83]
s_waitcnt lgkmcnt(4)
v_mfma_f32_16x16x32_bf16 v[68:71], a[216:219], v[44:47], v[68:71]
ds_read_b128 v[36:39], v10 offset:61440
v_mfma_f32_16x16x32_bf16 v[72:75], a[220:223], v[44:47], v[72:75]
v_mfma_f32_16x16x32_bf16 v[76:79], a[216:219], v[48:51], v[76:79]
ds_read_b128 v[40:43], v10 offset:63488
v_mfma_f32_16x16x32_bf16 v[80:83], a[220:223], v[48:51], v[80:83]
s_waitcnt lgkmcnt(4)
v_mfma_f32_16x16x32_bf16 v[68:71], a[224:227], v[20:23], v[68:71]
ds_read_b128 v[44:47], v11 offset:61440
v_mfma_f32_16x16x32_bf16 v[72:75], a[228:231], v[20:23], v[72:75]
v_mfma_f32_16x16x32_bf16 v[76:79], a[224:227], v[24:27], v[76:79]
ds_read_b128 v[48:51], v11 offset:63488
v_mfma_f32_16x16x32_bf16 v[80:83], a[228:231], v[24:27], v[80:83]
s_waitcnt lgkmcnt(5)
v_mfma_f32_16x16x32_bf16 v[68:71], a[232:235], v[28:31], v[68:71]
v_mfma_f32_16x16x32_bf16 v[72:75], a[236:239], v[28:31], v[72:75]
s_waitcnt lgkmcnt(4)
v_mfma_f32_16x16x32_bf16 v[76:79], a[232:235], v[32:35], v[76:79]
v_mfma_f32_16x16x32_bf16 v[80:83], a[236:239], v[32:35], v[80:83]
s_waitcnt lgkmcnt(3)
v_mfma_f32_16x16x32_bf16 v[68:71], a[240:243], v[36:39], v[68:71]
v_mfma_f32_16x16x32_bf16 v[72:75], a[244:247], v[36:39], v[72:75]
s_waitcnt lgkmcnt(2)
v_mfma_f32_16x16x32_bf16 v[76:79], a[240:243], v[40:43], v[76:79]
v_mfma_f32_16x16x32_bf16 v[80:83], a[244:247], v[40:43], v[80:83]
s_waitcnt lgkmcnt(1)
v_mfma_f32_16x16x32_bf16 v[68:71], a[248:251], v[44:47], v[68:71]
v_mfma_f32_16x16x32_bf16 v[72:75], a[252:255], v[44:47], v[72:75]
s_waitcnt lgkmcnt(0)
v_mfma_f32_16x16x32_bf16 v[76:79], a[248:251], v[48:51], v[76:79]
v_mfma_f32_16x16x32_bf16 v[80:83], a[252:255], v[48:51], v[80:83]
s_add_u32 s42, s42, 1
s_cmp_eq_u32 s42, 64
s_cbranch_scc1 mega_kernel_k_fin
mega_kernel_k_mid:
s_waitcnt vmcnt(2)
s_barrier
s_add_u32 s50, s42, 1
s_min_u32 s50, s50, 63
s_lshl_b32 s50, s50, 16
ds_read_b128 v[20:23], v8 offset:0
ds_read_b128 v[24:27], v8 offset:2048
ds_read_b128 v[28:31], v9 offset:0
ds_read_b128 v[32:35], v9 offset:2048
ds_read_b128 v[36:39], v8 offset:4096
ds_read_b128 v[40:43], v8 offset:6144
s_waitcnt lgkmcnt(4)
v_mfma_f32_16x16x32_bf16 v[52:55], a[0:3], v[20:23], 0
ds_read_b128 v[44:47], v9 offset:4096
v_mfma_f32_16x16x32_bf16 v[56:59], a[4:7], v[20:23], 0
v_cvt_pk_bf16_f32 v84, v68, v69
v_cvt_pk_bf16_f32 v85, v70, v71
v_cvt_pk_bf16_f32 v86, v72, v73
v_mfma_f32_16x16x32_bf16 v[60:63], a[0:3], v[24:27], 0
ds_read_b128 v[48:51], v9 offset:6144
v_mfma_f32_16x16x32_bf16 v[64:67], a[4:7], v[24:27], 0
v_cvt_pk_bf16_f32 v87, v74, v75
v_cvt_pk_bf16_f32 v88, v76, v77
v_cvt_pk_bf16_f32 v89, v78, v79
s_waitcnt lgkmcnt(4)
v_mfma_f32_16x16x32_bf16 v[52:55], a[8:11], v[28:31], v[52:55]
ds_read_b128 v[20:23], v8 offset:8192
v_mfma_f32_16x16x32_bf16 v[56:59], a[12:15], v[28:31], v[56:59]
v_cvt_pk_bf16_f32 v90, v80, v81
v_cvt_pk_bf16_f32 v91, v82, v83
v_mfma_f32_16x16x32_bf16 v[60:63], a[8:11], v[32:35], v[60:63]
ds_read_b128 v[24:27], v8 offset:10240
v_mfma_f32_16x16x32_bf16 v[64:67], a[12:15], v[32:35], v[64:67]
s_add_u32 s51, s42, s47
s_sub_u32 s51, s51, 1
s_bfe_u32 s52, s51, 0x40002
s_lshl_b32 s52, s52, 14
s_waitcnt lgkmcnt(4)
v_mfma_f32_16x16x32_bf16 v[52:55], a[16:19], v[36:39], v[52:55]
ds_read_b128 v[28:31], v9 offset:8192
v_mfma_f32_16x16x32_bf16 v[56:59], a[20:23], v[36:39], v[56:59]
s_and_b32 s51, s51, 3
s_lshl_b32 s51, s51, 11
s_add_u32 s51, s51, s52
s_add_u32 s51, s51, s48
buffer_store_dwordx4 v[84:87], v7, s[84:87], s51 offen sc1
v_mfma_f32_16x16x32_bf16 v[60:63], a[16:19], v[40:43], v[60:63]
ds_read_b128 v[32:35], v9 offset:10240
v_mfma_f32_16x16x32_bf16 v[64:67], a[20:23], v[40:43], v[64:67]
buffer_store_dwordx4 v[88:91], v7, s[84:87], s51 offen offset:1024 sc1
s_waitcnt lgkmcnt(4)
v_mfma_f32_16x16x32_bf16 v[52:55], a[24:27], v[44:47], v[52:55]
ds_read_b128 v[36:39], v8 offset:12288
v_mfma_f32_16x16x32_bf16 v[56:59], a[28:31], v[44:47], v[56:59]
s_add_u32 m0, s46, 65536
v_mfma_f32_16x16x32_bf16 v[60:63], a[24:27], v[48:51], v[60:63]
ds_read_b128 v[40:43], v8 offset:14336
v_mfma_f32_16x16x32_bf16 v[64:67], a[28:31], v[48:51], v[64:67]
buffer_load_dwordx4 v6, s[8:11], s50 offen offset:0 lds
s_waitcnt lgkmcnt(4)
v_mfma_f32_16x16x32_bf16 v[52:55], a[32:35], v[20:23], v[52:55]
ds_read_b128 v[44:47], v9 offset:12288
v_mfma_f32_16x16x32_bf16 v[56:59], a[36:39], v[20:23], v[56:59]
s_add_u32 m0, s46, 69504
v_mfma_f32_16x16x32_bf16 v[60:63], a[32:35], v[24:27], v[60:63]
ds_read_b128 v[48:51], v9 offset:14336
v_mfma_f32_16x16x32_bf16 v[64:67], a[36:39], v[24:27], v[64:67]
buffer_load_dwordx4 v6, s[8:11], s50 offen offset:128 lds
s_waitcnt lgkmcnt(4)
v_mfma_f32_16x16x32_bf16 v[52:55], a[40:43], v[28:31], v[52:55]
ds_read_b128 v[20:23], v8 offset:16384
v_mfma_f32_16x16x32_bf16 v[56:59], a[44:47], v[28:31], v[56:59]
s_add_u32 m0, s46, 73472
v_mfma_f32_16x16x32_bf16 v[60:63], a[40:43], v[32:35], v[60:63]
ds_read_b128 v[24:27], v8 offset:18432
v_mfma_f32_16x16x32_bf16 v[64:67], a[44:47], v[32:35], v[64:67]
buffer_load_dwordx4 v6, s[8:11], s50 offen offset:256 lds
s_waitcnt lgkmcnt(4)
v_mfma_f32_16x16x32_bf16 v[52:55], a[48:51], v[36:39], v[52:55]
ds_read_b128 v[28:31], v9 offset:16384
v_mfma_f32_16x16x32_bf16 v[56:59], a[52:55], v[36:39], v[56:59]
s_add_u32 m0, s46, 77440
v_mfma_f32_16x16x32_bf16 v[60:63], a[48:51], v[40:43], v[60:63]
ds_read_b128 v[32:35], v9 offset:18432
v_mfma_f32_16x16x32_bf16 v[64:67], a[52:55], v[40:43], v[64:67]
buffer_load_dwordx4 v6, s[8:11], s50 offen offset:384 lds
s_waitcnt lgkmcnt(4)
v_mfma_f32_16x16x32_bf16 v[52:55], a[56:59], v[44:47], v[52:55]
ds_read_b128 v[36:39], v8 offset:20480
v_mfma_f32_16x16x32_bf16 v[56:59], a[60:63], v[44:47], v[56:59]
s_add_u32 m0, s46, 81408
v_mfma_f32_16x16x32_bf16 v[60:63], a[56:59], v[48:51], v[60:63]
ds_read_b128 v[40:43], v8 offset:22528
v_mfma_f32_16x16x32_bf16 v[64:67], a[60:63], v[48:51], v[64:67]
buffer_load_dwordx4 v6, s[8:11], s50 offen offset:512 lds
s_waitcnt lgkmcnt(4)
v_mfma_f32_16x16x32_bf16 v[52:55], a[64:67], v[20:23], v[52:55]
ds_read_b128 v[44:47], v9 offset:20480
v_mfma_f32_16x16x32_bf16 v[56:59], a[68:71], v[20:23], v[56:59]
s_add_u32 m0, s46, 85376
v_mfma_f32_16x16x32_bf16 v[60:63], a[64:67], v[24:27], v[60:63]
ds_read_b128 v[48:51], v9 offset:22528
v_mfma_f32_16x16x32_bf16 v[64:67], a[68:71], v[24:27], v[64:67]
buffer_load_dwordx4 v6, s[8:11], s50 offen offset:640 lds
s_waitcnt lgkmcnt(4)
v_mfma_f32_16x16x32_bf16 v[52:55], a[72:75], v[28:31], v[52:55]
ds_read_b128 v[20:23], v8 offset:24576
v_mfma_f32_16x16x32_bf16 v[56:59], a[76:79], v[28:31], v[56:59]
s_add_u32 m0, s46, 89344
v_mfma_f32_16x16x32_bf16 v[60:63], a[72:75], v[32:35], v[60:63]
ds_read_b128 v[24:27], v8 offset:26624
v_mfma_f32_16x16x32_bf16 v[64:67], a[76:79], v[32:35], v[64:67]
buffer_load_dwordx4 v6, s[8:11], s50 offen offset:768 lds
s_waitcnt lgkmcnt(4)
v_mfma_f32_16x16x32_bf16 v[52:55], a[80:83], v[36:39], v[52:55]
ds_read_b128 v[28:31], v9 offset:24576
v_mfma_f32_16x16x32_bf16 v[56:59], a[84:87], v[36:39], v[56:59]
s_add_u32 m0, s46, 93312
v_mfma_f32_16x16x32_bf16 v[60:63], a[80:83], v[40:43], v[60:63]
ds_read_b128 v[32:35], v9 offset:26624
v_mfma_f32_16x16x32_bf16 v[64:67], a[84:87], v[40:43], v[64:67]
buffer_load_dwordx4 v6, s[8:11], s50 offen offset:896 lds
s_waitcnt lgkmcnt(4)
v_mfma_f32_16x16x32_bf16 v[52:55], a[88:91], v[44:47], v[52:55]
ds_read_b128 v[36:39], v8 offset:28672
v_mfma_f32_16x16x32_bf16 v[56:59], a[92:95], v[44:47], v[56:59]
s_add_u32 m0, s46, 97280
v_mfma_f32_16x16x32_bf16 v[60:63], a[88:91], v[48:51], v[60:63]
ds_read_b128 v[40:43], v8 offset:30720
v_mfma_f32_16x16x32_bf16 v[64:67], a[92:95], v[48:51], v[64:67]
buffer_load_dwordx4 v6, s[8:11], s50 offen offset:1024 lds
s_waitcnt lgkmcnt(4)
v_mfma_f32_16x16x32_bf16 v[52:55], a[96:99], v[20:23], v[52:55]
ds_read_b128 v[44:47], v9 offset:28672
v_mfma_f32_16x16x32_bf16 v[56:59], a[100:103], v[20:23], v[56:59]
s_add_u32 m0, s46, 101248
v_mfma_f32_16x16x32_bf16 v[60:63], a[96:99], v[24:27], v[60:63]
ds_read_b128 v[48:51], v9 offset:30720
v_mfma_f32_16x16x32_bf16 v[64:67], a[100:103], v[24:27], v[64:67]
buffer_load_dwordx4 v6, s[8:11], s50 offen offset:1152 lds
s_waitcnt lgkmcnt(4)
v_mfma_f32_16x16x32_bf16 v[52:55], a[104:107], v[28:31], v[52:55]
ds_read_b128 v[20:23], v8 offset:32768
v_mfma_f32_16x16x32_bf16 v[56:59], a[108:111], v[28:31], v[56:59]
s_add_u32 m0, s46, 105216
v_mfma_f32_16x16x32_bf16 v[60:63], a[104:107], v[32:35], v[60:63]
ds_read_b128 v[24:27], v8 offset:34816
v_mfma_f32_16x16x32_bf16 v[64:67], a[108:111], v[32:35], v[64:67]
buffer_load_dwordx4 v6, s[8:11], s50 offen offset:1280 lds
s_waitcnt lgkmcnt(4)
v_mfma_f32_16x16x32_bf16 v[52:55], a[112:115], v[36:39], v[52:55]
ds_read_b128 v[28:31], v9 offset:32768
v_mfma_f32_16x16x32_bf16 v[56:59], a[116:119], v[36:39], v[56:59]
s_add_u32 m0, s46, 109184
v_mfma_f32_16x16x32_bf16 v[60:63], a[112:115], v[40:43], v[60:63]
ds_read_b128 v[32:35], v9 offset:34816
v_mfma_f32_16x16x32_bf16 v[64:67], a[116:119], v[40:43], v[64:67]
buffer_load_dwordx4 v6, s[8:11], s50 offen offset:1408 lds
s_waitcnt lgkmcnt(4)
v_mfma_f32_16x16x32_bf16 v[52:55], a[120:123], v[44:47], v[52:55]
ds_read_b128 v[36:39], v8 offset:36864
v_mfma_f32_16x16x32_bf16 v[56:59], a[124:127], v[44:47], v[56:59]
s_add_u32 m0, s46, 113152
v_mfma_f32_16x16x32_bf16 v[60:63], a[120:123], v[48:51], v[60:63]
ds_read_b128 v[40:43], v8 offset:38912
v_mfma_f32_16x16x32_bf16 v[64:67], a[124:127], v[48:51], v[64:67]
buffer_load_dwordx4 v6, s[8:11], s50 offen offset:1536 lds
s_waitcnt lgkmcnt(4)
v_mfma_f32_16x16x32_bf16 v[52:55], a[128:131], v[20:23], v[52:55]
ds_read_b128 v[44:47], v9 offset:36864
v_mfma_f32_16x16x32_bf16 v[56:59], a[132:135], v[20:23], v[56:59]
s_add_u32 m0, s46, 117120
v_mfma_f32_16x16x32_bf16 v[60:63], a[128:131], v[24:27], v[60:63]
ds_read_b128 v[48:51], v9 offset:38912
v_mfma_f32_16x16x32_bf16 v[64:67], a[132:135], v[24:27], v[64:67]
buffer_load_dwordx4 v6, s[8:11], s50 offen offset:1664 lds
s_waitcnt lgkmcnt(4)
v_mfma_f32_16x16x32_bf16 v[52:55], a[136:139], v[28:31], v[52:55]
ds_read_b128 v[20:23], v8 offset:40960
v_mfma_f32_16x16x32_bf16 v[56:59], a[140:143], v[28:31], v[56:59]
s_add_u32 m0, s46, 121088
v_mfma_f32_16x16x32_bf16 v[60:63], a[136:139], v[32:35], v[60:63]
ds_read_b128 v[24:27], v8 offset:43008
v_mfma_f32_16x16x32_bf16 v[64:67], a[140:143], v[32:35], v[64:67]
buffer_load_dwordx4 v6, s[8:11], s50 offen offset:1792 lds
s_waitcnt lgkmcnt(4)
v_mfma_f32_16x16x32_bf16 v[52:55], a[144:147], v[36:39], v[52:55]
ds_read_b128 v[28:31], v9 offset:40960
v_mfma_f32_16x16x32_bf16 v[56:59], a[148:151], v[36:39], v[56:59]
s_add_u32 m0, s46, 125056
v_mfma_f32_16x16x32_bf16 v[60:63], a[144:147], v[40:43], v[60:63]
ds_read_b128 v[32:35], v9 offset:43008
v_mfma_f32_16x16x32_bf16 v[64:67], a[148:151], v[40:43], v[64:67]
buffer_load_dwordx4 v6, s[8:11], s50 offen offset:1920 lds
s_waitcnt lgkmcnt(4)
v_mfma_f32_16x16x32_bf16 v[52:55], a[152:155], v[44:47], v[52:55]
ds_read_b128 v[36:39], v8 offset:45056
v_mfma_f32_16x16x32_bf16 v[56:59], a[156:159], v[44:47], v[56:59]
v_mfma_f32_16x16x32_bf16 v[60:63], a[152:155], v[48:51], v[60:63]
ds_read_b128 v[40:43], v8 offset:47104
v_mfma_f32_16x16x32_bf16 v[64:67], a[156:159], v[48:51], v[64:67]
s_waitcnt lgkmcnt(4)
v_mfma_f32_16x16x32_bf16 v[52:55], a[160:163], v[20:23], v[52:55]
ds_read_b128 v[44:47], v9 offset:45056
v_mfma_f32_16x16x32_bf16 v[56:59], a[164:167], v[20:23], v[56:59]
v_mfma_f32_16x16x32_bf16 v[60:63], a[160:163], v[24:27], v[60:63]
ds_read_b128 v[48:51], v9 offset:47104
v_mfma_f32_16x16x32_bf16 v[64:67], a[164:167], v[24:27], v[64:67]
s_waitcnt lgkmcnt(4)
v_mfma_f32_16x16x32_bf16 v[52:55], a[168:171], v[28:31], v[52:55]
ds_read_b128 v[20:23], v8 offset:49152
v_mfma_f32_16x16x32_bf16 v[56:59], a[172:175], v[28:31], v[56:59]
s_waitcnt vmcnt(16)
v_mov_b32 v17, s42
s_mov_b64 exec, 1
buffer_store_dword v17, v16, s[84:87], s49 offen sc1
s_mov_b64 exec, -1
v_mfma_f32_16x16x32_bf16 v[60:63], a[168:171], v[32:35], v[60:63]
ds_read_b128 v[24:27], v8 offset:51200
v_mfma_f32_16x16x32_bf16 v[64:67], a[172:175], v[32:35], v[64:67]
s_waitcnt lgkmcnt(4)
v_mfma_f32_16x16x32_bf16 v[52:55], a[176:179], v[36:39], v[52:55]
ds_read_b128 v[28:31], v9 offset:49152
v_mfma_f32_16x16x32_bf16 v[56:59], a[180:183], v[36:39], v[56:59]
s_add_u32 s53, s42, 3
s_min_u32 s53, s53, 63
s_lshl_b32 s53, s53, 16
s_mov_b64 exec, 0xffff
buffer_load_dword v250, v19, s[8:11], s53 offen
s_mov_b64 exec, -1
v_mfma_f32_16x16x32_bf16 v[60:63], a[176:179], v[40:43], v[60:63]
ds_read_b128 v[32:35], v9 offset:51200
v_mfma_f32_16x16x32_bf16 v[64:67], a[180:183], v[40:43], v[64:67]
s_waitcnt lgkmcnt(4)
v_mfma_f32_16x16x32_bf16 v[52:55], a[184:187], v[44:47], v[52:55]
ds_read_b128 v[36:39], v8 offset:53248
v_mfma_f32_16x16x32_bf16 v[56:59], a[188:191], v[44:47], v[56:59]
v_mfma_f32_16x16x32_bf16 v[60:63], a[184:187], v[48:51], v[60:63]
ds_read_b128 v[40:43], v8 offset:55296
v_mfma_f32_16x16x32_bf16 v[64:67], a[188:191], v[48:51], v[64:67]
s_waitcnt lgkmcnt(4)
v_mfma_f32_16x16x32_bf16 v[52:55], a[192:195], v[20:23], v[52:55]
ds_read_b128 v[44:47], v9 offset:53248
v_mfma_f32_16x16x32_bf16 v[56:59], a[196:199], v[20:23], v[56:59]
v_mfma_f32_16x16x32_bf16 v[60:63], a[192:195], v[24:27], v[60:63]
ds_read_b128 v[48:51], v9 offset:55296
v_mfma_f32_16x16x32_bf16 v[64:67], a[196:199], v[24:27], v[64:67]
s_waitcnt lgkmcnt(4)
v_mfma_f32_16x16x32_bf16 v[52:55], a[200:203], v[28:31], v[52:55]
ds_read_b128 v[20:23], v8 offset:57344
v_mfma_f32_16x16x32_bf16 v[56:59], a[204:207], v[28:31], v[56:59]
v_mfma_f32_16x16x32_bf16 v[60:63], a[200:203], v[32:35], v[60:63]
ds_read_b128 v[24:27], v8 offset:59392
v_mfma_f32_16x16x32_bf16 v[64:67], a[204:207], v[32:35], v[64:67]
s_waitcnt lgkmcnt(4)
v_mfma_f32_16x16x32_bf16 v[52:55], a[208:211], v[36:39], v[52:55]
ds_read_b128 v[28:31], v9 offset:57344
v_mfma_f32_16x16x32_bf16 v[56:59], a[212:215], v[36:39], v[56:59]
v_mfma_f32_16x16x32_bf16 v[60:63], a[208:211], v[40:43], v[60:63]
ds_read_b128 v[32:35], v9 offset:59392
v_mfma_f32_16x16x32_bf16 v[64:67], a[212:215], v[40:43], v[64:67]
s_waitcnt lgkmcnt(4)
v_mfma_f32_16x16x32_bf16 v[52:55], a[216:219], v[44:47], v[52:55]
ds_read_b128 v[36:39], v8 offset:61440
v_mfma_f32_16x16x32_bf16 v[56:59], a[220:223], v[44:47], v[56:59]
v_mfma_f32_16x16x32_bf16 v[60:63], a[216:219], v[48:51], v[60:63]
ds_read_b128 v[40:43], v8 offset:63488
v_mfma_f32_16x16x32_bf16 v[64:67], a[220:223], v[48:51], v[64:67]
s_waitcnt lgkmcnt(4)
v_mfma_f32_16x16x32_bf16 v[52:55], a[224:227], v[20:23], v[52:55]
ds_read_b128 v[44:47], v9 offset:61440
v_mfma_f32_16x16x32_bf16 v[56:59], a[228:231], v[20:23], v[56:59]
v_mfma_f32_16x16x32_bf16 v[60:63], a[224:227], v[24:27], v[60:63]
ds_read_b128 v[48:51], v9 offset:63488
v_mfma_f32_16x16x32_bf16 v[64:67], a[228:231], v[24:27], v[64:67]
s_waitcnt lgkmcnt(5)
v_mfma_f32_16x16x32_bf16 v[52:55], a[232:235], v[28:31], v[52:55]
v_mfma_f32_16x16x32_bf16 v[56:59], a[236:239], v[28:31], v[56:59]
s_waitcnt lgkmcnt(4)
v_mfma_f32_16x16x32_bf16 v[60:63], a[232:235], v[32:35], v[60:63]
v_mfma_f32_16x16x32_bf16 v[64:67], a[236:239], v[32:35], v[64:67]
s_waitcnt lgkmcnt(3)
v_mfma_f32_16x16x32_bf16 v[52:55], a[240:243], v[36:39], v[52:55]
v_mfma_f32_16x16x32_bf16 v[56:59], a[244:247], v[36:39], v[56:59]
s_waitcnt lgkmcnt(2)
v_mfma_f32_16x16x32_bf16 v[60:63], a[240:243], v[40:43], v[60:63]
v_mfma_f32_16x16x32_bf16 v[64:67], a[244:247], v[40:43], v[64:67]
s_waitcnt lgkmcnt(1)
v_mfma_f32_16x16x32_bf16 v[52:55], a[248:251], v[44:47], v[52:55]
v_mfma_f32_16x16x32_bf16 v[56:59], a[252:255], v[44:47], v[56:59]
s_waitcnt lgkmcnt(0)
v_mfma_f32_16x16x32_bf16 v[60:63], a[248:251], v[48:51], v[60:63]
v_mfma_f32_16x16x32_bf16 v[64:67], a[252:255], v[48:51], v[64:67]
s_add_u32 s42, s42, 1
s_branch mega_kernel_k_loop
mega_kernel_k_fin:
s_nop 11
v_cvt_pk_bf16_f32 v84, v68, v69
v_cvt_pk_bf16_f32 v85, v70, v71
v_cvt_pk_bf16_f32 v86, v72, v73
v_cvt_pk_bf16_f32 v87, v74, v75
v_cvt_pk_bf16_f32 v88, v76, v77
v_cvt_pk_bf16_f32 v89, v78, v79
v_cvt_pk_bf16_f32 v90, v80, v81
v_cvt_pk_bf16_f32 v91, v82, v83
s_add_u32 s51, s42, s47
s_sub_u32 s51, s51, 1
s_bfe_u32 s52, s51, 0x40002
s_lshl_b32 s52, s52, 14
s_and_b32 s51, s51, 3
s_lshl_b32 s51, s51, 11
s_add_u32 s51, s51, s52
s_add_u32 s51, s51, s48
buffer_store_dwordx4 v[84:87], v7, s[84:87], s51 offen sc1
buffer_store_dwordx4 v[88:91], v7, s[84:87], s51 offen offset:1024 sc1
s_waitcnt vmcnt(0)
v_mov_b32 v17, s42
s_mov_b64 exec, 1
buffer_store_dword v17, v16, s[84:87], s49 offen sc1
s_mov_b64 exec, -1
s_waitcnt vmcnt(0)
s_barrier
s_branch mega_kernel_fft
mega_kernel_rv:
s_load_dwordx2 s[4:5], s[0:1], 32
s_load_dwordx2 s[8:9], s[0:1], 0
v_lshrrev_b32 v2, 6, v0
v_and_b32 v1, 63, v0
v_readfirstlane_b32 s41, v2
v_lshlrev_b32 v5, 4, v1
s_waitcnt lgkmcnt(0)
s_mov_b32 s6, 8388608
s_mov_b32 s7, 0x00020000
s_mov_b32 s10, 4194304
s_mov_b32 s11, 0x00020000
s_lshl_b32 s43, s40, 8
s_lshl_b32 s44, s41, 6
s_add_u32 s48, s43, s44
s_and_b32 s43, s48, 0x7ff
v_add_u32 v19, s43, v1
v_lshlrev_b32 v19, 7, v19
s_mov_b32 s43, 0
buffer_load_dword v250, v19, s[8:11], s43 offen
s_nop 0
v_lshrrev_b32 v2, 3, v1
s_lshl_b32 s43, s41, 3
v_add_u32 v2, s43, v2
v_bfe_u32 v3, v2, 1, 3
v_and_b32 v4, 7, v1
v_xor_b32 v3, v3, v4
v_lshlrev_b32 v6, 11, v2
v_lshl_add_u32 v6, v3, 4, v6
s_lshl_b32 s46, s41, 10
v_and_b32 v2, 15, v1
v_bfe_u32 v3, v2, 1, 3
v_lshrrev_b32 v4, 4, v1
v_xor_b32 v3, v3, v4
v_lshlrev_b32 v8, 7, v2
v_lshl_add_u32 v8, v3, 4, v8
v_xor_b32 v9, 64, v8
v_add_u32 v10, 0x10000, v8
v_add_u32 v11, 0x10000, v9
v_mov_b32 v7, v5
s_lshl_b32 s47, s40, 2
s_add_u32 s47, s47, s41
s_mov_b32 s42, 0
s_mov_b32 s50, 0
s_add_u32 m0, s46, 0
s_nop 0
buffer_load_dwordx4 v6, s[8:11], s50 offen offset:0 lds
s_add_u32 m0, s46, 3968
s_nop 0
buffer_load_dwordx4 v6, s[8:11], s50 offen offset:128 lds
s_add_u32 m0, s46, 7936
s_nop 0
buffer_load_dwordx4 v6, s[8:11], s50 offen offset:256 lds
s_add_u32 m0, s46, 11904
s_nop 0
buffer_load_dwordx4 v6, s[8:11], s50 offen offset:384 lds
s_add_u32 m0, s46, 15872
s_nop 0
buffer_load_dwordx4 v6, s[8:11], s50 offen offset:512 lds
s_add_u32 m0, s46, 19840
s_nop 0
buffer_load_dwordx4 v6, s[8:11], s50 offen offset:640 lds
s_add_u32 m0, s46, 23808
s_nop 0
buffer_load_dwordx4 v6, s[8:11], s50 offen offset:768 lds
s_add_u32 m0, s46, 27776
s_nop 0
buffer_load_dwordx4 v6, s[8:11], s50 offen offset:896 lds
s_add_u32 m0, s46, 31744
s_nop 0
buffer_load_dwordx4 v6, s[8:11], s50 offen offset:1024 lds
s_add_u32 m0, s46, 35712
s_nop 0
buffer_load_dwordx4 v6, s[8:11], s50 offen offset:1152 lds
s_add_u32 m0, s46, 39680
s_nop 0
buffer_load_dwordx4 v6, s[8:11], s50 offen offset:1280 lds
s_add_u32 m0, s46, 43648
s_nop 0
buffer_load_dwordx4 v6, s[8:11], s50 offen offset:1408 lds
s_add_u32 m0, s46, 47616
s_nop 0
buffer_load_dwordx4 v6, s[8:11], s50 offen offset:1536 lds
s_add_u32 m0, s46, 51584
s_nop 0
buffer_load_dwordx4 v6, s[8:11], s50 offen offset:1664 lds
s_add_u32 m0, s46, 55552
s_nop 0
buffer_load_dwordx4 v6, s[8:11], s50 offen offset:1792 lds
s_add_u32 m0, s46, 59520
s_nop 0
buffer_load_dwordx4 v6, s[8:11], s50 offen offset:1920 lds
v_lshrrev_b32 v2, 2, v1
v_and_b32 v3, 3, v1
v_lshlrev_b32 v16, 13, v2
v_lshl_add_u32 v16, v3, 4, v16
v_add_u32 v16, s48, v16
s_mul_i32 s45, s41, 24576
s_add_u32 s45, s45, 65536
v_bfe_u32 v17, v1, 2, 2
v_lshrrev_b32 v18, 4, v1
v_lshl_add_u32 v17, v18, 3, v17
v_lshlrev_b32 v17, 6, v17
v_lshl_add_u32 v17, v3, 3, v17
v_add_u32 v17, s45, v17
s_and_b32 s43, s40, 3
s_lshl_b32 s43, s43, 2
s_add_u32 s43, s43, s41
s_lshl_b32 s43, s43, 3
v_and_b32 v12, 7, v1
v_add_u32 v12, s43, v12
s_lshr_b32 s43, s40, 2
s_lshl_b32 s43, s43, 10
s_add_u32 s44, s43, 896
s_add_u32 s43, s43, 384
s_cmp_ge_u32 s40, 28
s_cselect_b32 s44, s44, s43
v_mov_b32 v13, s43
v_mov_b32 v14, s44
v_cmp_gt_u32 vcc, 32, v1
s_nop 1
v_cndmask_b32 v13, v14, v13, vcc
v_lshl_add_u32 v12, v12, 13, v13
s_mov_b32 s44, 0
buffer_load_dword v250, v12, s[4:7], s44 offen
s_add_u32 m0, s45, 0
s_mov_b32 s44, 0
buffer_load_dwordx4 v16, s[4:7], s44 offen lds
s_add_u32 m0, s45, 1024
s_mov_b32 s44, 131072
buffer_load_dwordx4 v16, s[4:7], s44 offen lds
s_add_u32 m0, s45, 2048
s_mov_b32 s44, 262144
buffer_load_dwordx4 v16, s[4:7], s44 offen lds
s_add_u32 m0, s45, 3072
s_mov_b32 s44, 393216
buffer_load_dwordx4 v16, s[4:7], s44 offen lds
s_add_u32 m0, s45, 4096
s_mov_b32 s44, 524288
buffer_load_dwordx4 v16, s[4:7], s44 offen lds
s_add_u32 m0, s45, 5120
s_mov_b32 s44, 655360
buffer_load_dwordx4 v16, s[4:7], s44 offen lds
s_add_u32 m0, s45, 6144
s_mov_b32 s44, 786432
buffer_load_dwordx4 v16, s[4:7], s44 offen lds
s_add_u32 m0, s45, 7168
s_mov_b32 s44, 917504
buffer_load_dwordx4 v16, s[4:7], s44 offen lds
s_mov_b32 s44, 1048576
buffer_load_dword v250, v12, s[4:7], s44 offen
s_add_u32 m0, s45, 8192
s_mov_b32 s44, 1048576
buffer_load_dwordx4 v16, s[4:7], s44 offen lds
s_add_u32 m0, s45, 9216
s_mov_b32 s44, 1179648
buffer_load_dwordx4 v16, s[4:7], s44 offen lds
s_add_u32 m0, s45, 10240
s_mov_b32 s44, 1310720
buffer_load_dwordx4 v16, s[4:7], s44 offen lds
s_add_u32 m0, s45, 11264
s_mov_b32 s44, 1441792
buffer_load_dwordx4 v16, s[4:7], s44 offen lds
s_add_u32 m0, s45, 12288
s_mov_b32 s44, 1572864
buffer_load_dwordx4 v16, s[4:7], s44 offen lds
s_add_u32 m0, s45, 13312
s_mov_b32 s44, 1703936
buffer_load_dwordx4 v16, s[4:7], s44 offen lds
s_add_u32 m0, s45, 14336
s_mov_b32 s44, 1835008
buffer_load_dwordx4 v16, s[4:7], s44 offen lds
s_add_u32 m0, s45, 15360
s_mov_b32 s44, 1966080
buffer_load_dwordx4 v16, s[4:7], s44 offen lds
s_mov_b32 s44, 2097152
buffer_load_dword v250, v12, s[4:7], s44 offen
s_add_u32 m0, s45, 16384
s_mov_b32 s44, 2097152
buffer_load_dwordx4 v16, s[4:7], s44 offen lds
s_add_u32 m0, s45, 17408
s_mov_b32 s44, 2228224
buffer_load_dwordx4 v16, s[4:7], s44 offen lds
s_add_u32 m0, s45, 18432
s_mov_b32 s44, 2359296
buffer_load_dwordx4 v16, s[4:7], s44 offen lds
s_add_u32 m0, s45, 19456
s_mov_b32 s44, 2490368
buffer_load_dwordx4 v16, s[4:7], s44 offen lds
s_add_u32 m0, s45, 20480
s_mov_b32 s44, 2621440
buffer_load_dwordx4 v16, s[4:7], s44 offen lds
s_add_u32 m0, s45, 21504
s_mov_b32 s44, 2752512
buffer_load_dwordx4 v16, s[4:7], s44 offen lds
s_add_u32 m0, s45, 22528
s_mov_b32 s44, 2883584
buffer_load_dwordx4 v16, s[4:7], s44 offen lds
s_add_u32 m0, s45, 23552
s_mov_b32 s44, 3014656
buffer_load_dwordx4 v16, s[4:7], s44 offen lds
s_waitcnt vmcnt(18)
s_barrier
ds_read_b64_tr_b16 a[0:1], v17 offset:0
ds_read_b64_tr_b16 a[2:3], v17 offset:256
ds_read_b64_tr_b16 a[4:5], v17 offset:32
ds_read_b64_tr_b16 a[6:7], v17 offset:288
ds_read_b64_tr_b16 a[8:9], v17 offset:2048
ds_read_b64_tr_b16 a[10:11], v17 offset:2304
ds_read_b64_tr_b16 a[12:13], v17 offset:2080
ds_read_b64_tr_b16 a[14:15], v17 offset:2336
s_waitcnt lgkmcnt(0)
ds_read_b64_tr_b16 a[16:17], v17 offset:4096
ds_read_b64_tr_b16 a[18:19], v17 offset:4352
ds_read_b64_tr_b16 a[20:21], v17 offset:4128
ds_read_b64_tr_b16 a[22:23], v17 offset:4384
ds_read_b64_tr_b16 a[24:25], v17 offset:6144
ds_read_b64_tr_b16 a[26:27], v17 offset:6400
ds_read_b64_tr_b16 a[28:29], v17 offset:6176
ds_read_b64_tr_b16 a[30:31], v17 offset:6432
s_waitcnt lgkmcnt(0)
s_mov_b32 s44, 3145728
buffer_load_dword v250, v12, s[4:7], s44 offen
s_add_u32 m0, s45, 0
s_mov_b32 s44, 3145728
buffer_load_dwordx4 v16, s[4:7], s44 offen lds
s_add_u32 m0, s45, 1024
s_mov_b32 s44, 3276800
buffer_load_dwordx4 v16, s[4:7], s44 offen lds
s_add_u32 m0, s45, 2048
s_mov_b32 s44, 3407872
buffer_load_dwordx4 v16, s[4:7], s44 offen lds
s_add_u32 m0, s45, 3072
s_mov_b32 s44, 3538944
buffer_load_dwordx4 v16, s[4:7], s44 offen lds
s_add_u32 m0, s45, 4096
s_mov_b32 s44, 3670016
buffer_load_dwordx4 v16, s[4:7], s44 offen lds
s_add_u32 m0, s45, 5120
s_mov_b32 s44, 3801088
buffer_load_dwordx4 v16, s[4:7], s44 offen lds
s_add_u32 m0, s45, 6144
s_mov_b32 s44, 3932160
buffer_load_dwordx4 v16, s[4:7], s44 offen lds
s_add_u32 m0, s45, 7168
s_mov_b32 s44, 4063232
buffer_load_dwordx4 v16, s[4:7], s44 offen lds
ds_read_b128 v[20:23], v8 offset:0
ds_read_b128 v[24:27], v8 offset:2048
ds_read_b128 v[28:31], v9 offset:0
ds_read_b128 v[32:35], v9 offset:2048
ds_read_b128 v[36:39], v8 offset:4096
ds_read_b128 v[40:43], v8 offset:6144
ds_read_b128 v[44:47], v9 offset:4096
ds_read_b128 v[48:51], v9 offset:6144
s_waitcnt lgkmcnt(0)
v_mfma_f32_16x16x32_bf16 v[52:55], v[20:23], a[0:3], 0
v_mfma_f32_16x16x32_bf16 v[56:59], v[20:23], a[4:7], 0
v_mfma_f32_16x16x32_bf16 v[60:63], v[24:27], a[0:3], 0
v_mfma_f32_16x16x32_bf16 v[64:67], v[24:27], a[4:7], 0
v_mfma_f32_16x16x32_bf16 v[52:55], v[28:31], a[8:11], v[52:55]
v_mfma_f32_16x16x32_bf16 v[56:59], v[28:31], a[12:15], v[56:59]
v_mfma_f32_16x16x32_bf16 v[60:63], v[32:35], a[8:11], v[60:63]
v_mfma_f32_16x16x32_bf16 v[64:67], v[32:35], a[12:15], v[64:67]
v_mfma_f32_16x16x32_bf16 v[52:55], v[36:39], a[16:19], v[52:55]
v_mfma_f32_16x16x32_bf16 v[56:59], v[36:39], a[20:23], v[56:59]
v_mfma_f32_16x16x32_bf16 v[60:63], v[40:43], a[16:19], v[60:63]
v_mfma_f32_16x16x32_bf16 v[64:67], v[40:43], a[20:23], v[64:67]
v_mfma_f32_16x16x32_bf16 v[52:55], v[44:47], a[24:27], v[52:55]
v_mfma_f32_16x16x32_bf16 v[56:59], v[44:47], a[28:31], v[56:59]
v_mfma_f32_16x16x32_bf16 v[60:63], v[48:51], a[24:27], v[60:63]
v_mfma_f32_16x16x32_bf16 v[64:67], v[48:51], a[28:31], v[64:67]
s_waitcnt vmcnt(18)
ds_read_b64_tr_b16 a[32:33], v17 offset:8192
ds_read_b64_tr_b16 a[34:35], v17 offset:8448
ds_read_b64_tr_b16 a[36:37], v17 offset:8224
ds_read_b64_tr_b16 a[38:39], v17 offset:8480
ds_read_b64_tr_b16 a[40:41], v17 offset:10240
ds_read_b64_tr_b16 a[42:43], v17 offset:10496
ds_read_b64_tr_b16 a[44:45], v17 offset:10272
ds_read_b64_tr_b16 a[46:47], v17 offset:10528
s_waitcnt lgkmcnt(0)
ds_read_b64_tr_b16 a[48:49], v17 offset:12288
ds_read_b64_tr_b16 a[50:51], v17 offset:12544
ds_read_b64_tr_b16 a[52:53], v17 offset:12320
ds_read_b64_tr_b16 a[54:55], v17 offset:12576
ds_read_b64_tr_b16 a[56:57], v17 offset:14336
ds_read_b64_tr_b16 a[58:59], v17 offset:14592
ds_read_b64_tr_b16 a[60:61], v17 offset:14368
ds_read_b64_tr_b16 a[62:63], v17 offset:14624
s_waitcnt lgkmcnt(0)
s_mov_b32 s44, 4194304
buffer_load_dword v250, v12, s[4:7], s44 offen
s_add_u32 m0, s45, 8192
s_mov_b32 s44, 4194304
buffer_load_dwordx4 v16, s[4:7], s44 offen lds
s_add_u32 m0, s45, 9216
s_mov_b32 s44, 4325376
buffer_load_dwordx4 v16, s[4:7], s44 offen lds
s_add_u32 m0, s45, 10240
s_mov_b32 s44, 4456448
buffer_load_dwordx4 v16, s[4:7], s44 offen lds
s_add_u32 m0, s45, 11264
s_mov_b32 s44, 4587520
buffer_load_dwordx4 v16, s[4:7], s44 offen lds
s_add_u32 m0, s45, 12288
s_mov_b32 s44, 4718592
buffer_load_dwordx4 v16, s[4:7], s44 offen lds
s_add_u32 m0, s45, 13312
s_mov_b32 s44, 4849664
buffer_load_dwordx4 v16, s[4:7], s44 offen lds
s_add_u32 m0, s45, 14336
s_mov_b32 s44, 4980736
buffer_load_dwordx4 v16, s[4:7], s44 offen lds
s_add_u32 m0, s45, 15360
s_mov_b32 s44, 5111808
buffer_load_dwordx4 v16, s[4:7], s44 offen lds
ds_read_b128 v[20:23], v8 offset:8192
ds_read_b128 v[24:27], v8 offset:10240
ds_read_b128 v[28:31], v9 offset:8192
ds_read_b128 v[32:35], v9 offset:10240
ds_read_b128 v[36:39], v8 offset:12288
ds_read_b128 v[40:43], v8 offset:14336
ds_read_b128 v[44:47], v9 offset:12288
ds_read_b128 v[48:51], v9 offset:14336
s_waitcnt lgkmcnt(0)
v_mfma_f32_16x16x32_bf16 v[52:55], v[20:23], a[32:35], v[52:55]
v_mfma_f32_16x16x32_bf16 v[56:59], v[20:23], a[36:39], v[56:59]
v_mfma_f32_16x16x32_bf16 v[60:63], v[24:27], a[32:35], v[60:63]
v_mfma_f32_16x16x32_bf16 v[64:67], v[24:27], a[36:39], v[64:67]
v_mfma_f32_16x16x32_bf16 v[52:55], v[28:31], a[40:43], v[52:55]
v_mfma_f32_16x16x32_bf16 v[56:59], v[28:31], a[44:47], v[56:59]
v_mfma_f32_16x16x32_bf16 v[60:63], v[32:35], a[40:43], v[60:63]
v_mfma_f32_16x16x32_bf16 v[64:67], v[32:35], a[44:47], v[64:67]
v_mfma_f32_16x16x32_bf16 v[52:55], v[36:39], a[48:51], v[52:55]
v_mfma_f32_16x16x32_bf16 v[56:59], v[36:39], a[52:55], v[56:59]
v_mfma_f32_16x16x32_bf16 v[60:63], v[40:43], a[48:51], v[60:63]
v_mfma_f32_16x16x32_bf16 v[64:67], v[40:43], a[52:55], v[64:67]
v_mfma_f32_16x16x32_bf16 v[52:55], v[44:47], a[56:59], v[52:55]
v_mfma_f32_16x16x32_bf16 v[56:59], v[44:47], a[60:63], v[56:59]
v_mfma_f32_16x16x32_bf16 v[60:63], v[48:51], a[56:59], v[60:63]
v_mfma_f32_16x16x32_bf16 v[64:67], v[48:51], a[60:63], v[64:67]
s_waitcnt vmcnt(18)
ds_read_b64_tr_b16 a[64:65], v17 offset:16384
ds_read_b64_tr_b16 a[66:67], v17 offset:16640
ds_read_b64_tr_b16 a[68:69], v17 offset:16416
ds_read_b64_tr_b16 a[70:71], v17 offset:16672
ds_read_b64_tr_b16 a[72:73], v17 offset:18432
ds_read_b64_tr_b16 a[74:75], v17 offset:18688
ds_read_b64_tr_b16 a[76:77], v17 offset:18464
ds_read_b64_tr_b16 a[78:79], v17 offset:18720
s_waitcnt lgkmcnt(0)
ds_read_b64_tr_b16 a[80:81], v17 offset:20480
ds_read_b64_tr_b16 a[82:83], v17 offset:20736
ds_read_b64_tr_b16 a[84:85], v17 offset:20512
ds_read_b64_tr_b16 a[86:87], v17 offset:20768
ds_read_b64_tr_b16 a[88:89], v17 offset:22528
ds_read_b64_tr_b16 a[90:91], v17 offset:22784
ds_read_b64_tr_b16 a[92:93], v17 offset:22560
ds_read_b64_tr_b16 a[94:95], v17 offset:22816
s_waitcnt lgkmcnt(0)
s_mov_b32 s44, 5242880
buffer_load_dword v250, v12, s[4:7], s44 offen
s_add_u32 m0, s45, 16384
s_mov_b32 s44, 5242880
buffer_load_dwordx4 v16, s[4:7], s44 offen lds
s_add_u32 m0, s45, 17408
s_mov_b32 s44, 5373952
buffer_load_dwordx4 v16, s[4:7], s44 offen lds
s_add_u32 m0, s45, 18432
s_mov_b32 s44, 5505024
buffer_load_dwordx4 v16, s[4:7], s44 offen lds
s_add_u32 m0, s45, 19456
s_mov_b32 s44, 5636096
buffer_load_dwordx4 v16, s[4:7], s44 offen lds
s_add_u32 m0, s45, 20480
s_mov_b32 s44, 5767168
buffer_load_dwordx4 v16, s[4:7], s44 offen lds
s_add_u32 m0, s45, 21504
s_mov_b32 s44, 5898240
buffer_load_dwordx4 v16, s[4:7], s44 offen lds
s_add_u32 m0, s45, 22528
s_mov_b32 s44, 6029312
buffer_load_dwordx4 v16, s[4:7], s44 offen lds
s_add_u32 m0, s45, 23552
s_mov_b32 s44, 6160384
buffer_load_dwordx4 v16, s[4:7], s44 offen lds
ds_read_b128 v[20:23], v8 offset:16384
ds_read_b128 v[24:27], v8 offset:18432
ds_read_b128 v[28:31], v9 offset:16384
ds_read_b128 v[32:35], v9 offset:18432
ds_read_b128 v[36:39], v8 offset:20480
ds_read_b128 v[40:43], v8 offset:22528
ds_read_b128 v[44:47], v9 offset:20480
ds_read_b128 v[48:51], v9 offset:22528
s_waitcnt lgkmcnt(0)
v_mfma_f32_16x16x32_bf16 v[52:55], v[20:23], a[64:67], v[52:55]
v_mfma_f32_16x16x32_bf16 v[56:59], v[20:23], a[68:71], v[56:59]
v_mfma_f32_16x16x32_bf16 v[60:63], v[24:27], a[64:67], v[60:63]
v_mfma_f32_16x16x32_bf16 v[64:67], v[24:27], a[68:71], v[64:67]
v_mfma_f32_16x16x32_bf16 v[52:55], v[28:31], a[72:75], v[52:55]
v_mfma_f32_16x16x32_bf16 v[56:59], v[28:31], a[76:79], v[56:59]
v_mfma_f32_16x16x32_bf16 v[60:63], v[32:35], a[72:75], v[60:63]
v_mfma_f32_16x16x32_bf16 v[64:67], v[32:35], a[76:79], v[64:67]
v_mfma_f32_16x16x32_bf16 v[52:55], v[36:39], a[80:83], v[52:55]
v_mfma_f32_16x16x32_bf16 v[56:59], v[36:39], a[84:87], v[56:59]
v_mfma_f32_16x16x32_bf16 v[60:63], v[40:43], a[80:83], v[60:63]
v_mfma_f32_16x16x32_bf16 v[64:67], v[40:43], a[84:87], v[64:67]
v_mfma_f32_16x16x32_bf16 v[52:55], v[44:47], a[88:91], v[52:55]
v_mfma_f32_16x16x32_bf16 v[56:59], v[44:47], a[92:95], v[56:59]
v_mfma_f32_16x16x32_bf16 v[60:63], v[48:51], a[88:91], v[60:63]
v_mfma_f32_16x16x32_bf16 v[64:67], v[48:51], a[92:95], v[64:67]
s_waitcnt vmcnt(18)
ds_read_b64_tr_b16 a[96:97], v17 offset:0
ds_read_b64_tr_b16 a[98:99], v17 offset:256
ds_read_b64_tr_b16 a[100:101], v17 offset:32
ds_read_b64_tr_b16 a[102:103], v17 offset:288
ds_read_b64_tr_b16 a[104:105], v17 offset:2048
ds_read_b64_tr_b16 a[106:107], v17 offset:2304
ds_read_b64_tr_b16 a[108:109], v17 offset:2080
ds_read_b64_tr_b16 a[110:111], v17 offset:2336
s_waitcnt lgkmcnt(0)
ds_read_b64_tr_b16 a[112:113], v17 offset:4096
ds_read_b64_tr_b16 a[114:115], v17 offset:4352
ds_read_b64_tr_b16 a[116:117], v17 offset:4128
ds_read_b64_tr_b16 a[118:119], v17 offset:4384
ds_read_b64_tr_b16 a[120:121], v17 offset:6144
ds_read_b64_tr_b16 a[122:123], v17 offset:6400
ds_read_b64_tr_b16 a[124:125], v17 offset:6176
ds_read_b64_tr_b16 a[126:127], v17 offset:6432
s_waitcnt lgkmcnt(0)
s_mov_b32 s44, 6291456
buffer_load_dword v250, v12, s[4:7], s44 offen
s_add_u32 m0, s45, 0
s_mov_b32 s44, 6291456
buffer_load_dwordx4 v16, s[4:7], s44 offen lds
s_add_u32 m0, s45, 1024
s_mov_b32 s44, 6422528
buffer_load_dwordx4 v16, s[4:7], s44 offen lds
s_add_u32 m0, s45, 2048
s_mov_b32 s44, 6553600
buffer_load_dwordx4 v16, s[4:7], s44 offen lds
s_add_u32 m0, s45, 3072
s_mov_b32 s44, 6684672
buffer_load_dwordx4 v16, s[4:7], s44 offen lds
s_add_u32 m0, s45, 4096
s_mov_b32 s44, 6815744
buffer_load_dwordx4 v16, s[4:7], s44 offen lds
s_add_u32 m0, s45, 5120
s_mov_b32 s44, 6946816
buffer_load_dwordx4 v16, s[4:7], s44 offen lds
s_add_u32 m0, s45, 6144
s_mov_b32 s44, 7077888
buffer_load_dwordx4 v16, s[4:7], s44 offen lds
s_add_u32 m0, s45, 7168
s_mov_b32 s44, 7208960
buffer_load_dwordx4 v16, s[4:7], s44 offen lds
ds_read_b128 v[20:23], v8 offset:24576
ds_read_b128 v[24:27], v8 offset:26624
ds_read_b128 v[28:31], v9 offset:24576
ds_read_b128 v[32:35], v9 offset:26624
ds_read_b128 v[36:39], v8 offset:28672
ds_read_b128 v[40:43], v8 offset:30720
ds_read_b128 v[44:47], v9 offset:28672
ds_read_b128 v[48:51], v9 offset:30720
s_waitcnt lgkmcnt(0)
v_mfma_f32_16x16x32_bf16 v[52:55], v[20:23], a[96:99], v[52:55]
v_mfma_f32_16x16x32_bf16 v[56:59], v[20:23], a[100:103], v[56:59]
v_mfma_f32_16x16x32_bf16 v[60:63], v[24:27], a[96:99], v[60:63]
v_mfma_f32_16x16x32_bf16 v[64:67], v[24:27], a[100:103], v[64:67]
v_mfma_f32_16x16x32_bf16 v[52:55], v[28:31], a[104:107], v[52:55]
v_mfma_f32_16x16x32_bf16 v[56:59], v[28:31], a[108:111], v[56:59]
v_mfma_f32_16x16x32_bf16 v[60:63], v[32:35], a[104:107], v[60:63]
v_mfma_f32_16x16x32_bf16 v[64:67], v[32:35], a[108:111], v[64:67]
v_mfma_f32_16x16x32_bf16 v[52:55], v[36:39], a[112:115], v[52:55]
v_mfma_f32_16x16x32_bf16 v[56:59], v[36:39], a[116:119], v[56:59]
v_mfma_f32_16x16x32_bf16 v[60:63], v[40:43], a[112:115], v[60:63]
v_mfma_f32_16x16x32_bf16 v[64:67], v[40:43], a[116:119], v[64:67]
v_mfma_f32_16x16x32_bf16 v[52:55], v[44:47], a[120:123], v[52:55]
v_mfma_f32_16x16x32_bf16 v[56:59], v[44:47], a[124:127], v[56:59]
v_mfma_f32_16x16x32_bf16 v[60:63], v[48:51], a[120:123], v[60:63]
v_mfma_f32_16x16x32_bf16 v[64:67], v[48:51], a[124:127], v[64:67]
s_waitcnt vmcnt(18)
ds_read_b64_tr_b16 a[128:129], v17 offset:8192
ds_read_b64_tr_b16 a[130:131], v17 offset:8448
ds_read_b64_tr_b16 a[132:133], v17 offset:8224
ds_read_b64_tr_b16 a[134:135], v17 offset:8480
ds_read_b64_tr_b16 a[136:137], v17 offset:10240
ds_read_b64_tr_b16 a[138:139], v17 offset:10496
ds_read_b64_tr_b16 a[140:141], v17 offset:10272
ds_read_b64_tr_b16 a[142:143], v17 offset:10528
s_waitcnt lgkmcnt(0)
ds_read_b64_tr_b16 a[144:145], v17 offset:12288
ds_read_b64_tr_b16 a[146:147], v17 offset:12544
ds_read_b64_tr_b16 a[148:149], v17 offset:12320
ds_read_b64_tr_b16 a[150:151], v17 offset:12576
ds_read_b64_tr_b16 a[152:153], v17 offset:14336
ds_read_b64_tr_b16 a[154:155], v17 offset:14592
ds_read_b64_tr_b16 a[156:157], v17 offset:14368
ds_read_b64_tr_b16 a[158:159], v17 offset:14624
s_waitcnt lgkmcnt(0)
s_mov_b32 s44, 7340032
buffer_load_dword v250, v12, s[4:7], s44 offen
s_add_u32 m0, s45, 8192
s_mov_b32 s44, 7340032
buffer_load_dwordx4 v16, s[4:7], s44 offen lds
s_add_u32 m0, s45, 9216
s_mov_b32 s44, 7471104
buffer_load_dwordx4 v16, s[4:7], s44 offen lds
s_add_u32 m0, s45, 10240
s_mov_b32 s44, 7602176
buffer_load_dwordx4 v16, s[4:7], s44 offen lds
s_add_u32 m0, s45, 11264
s_mov_b32 s44, 7733248
buffer_load_dwordx4 v16, s[4:7], s44 offen lds
s_add_u32 m0, s45, 12288
s_mov_b32 s44, 7864320
buffer_load_dwordx4 v16, s[4:7], s44 offen lds
s_add_u32 m0, s45, 13312
s_mov_b32 s44, 7995392
buffer_load_dwordx4 v16, s[4:7], s44 offen lds
s_add_u32 m0, s45, 14336
s_mov_b32 s44, 8126464
buffer_load_dwordx4 v16, s[4:7], s44 offen lds
s_add_u32 m0, s45, 15360
s_mov_b32 s44, 8257536
buffer_load_dwordx4 v16, s[4:7], s44 offen lds
ds_read_b128 v[20:23], v8 offset:32768
ds_read_b128 v[24:27], v8 offset:34816
ds_read_b128 v[28:31], v9 offset:32768
ds_read_b128 v[32:35], v9 offset:34816
ds_read_b128 v[36:39], v8 offset:36864
ds_read_b128 v[40:43], v8 offset:38912
ds_read_b128 v[44:47], v9 offset:36864
ds_read_b128 v[48:51], v9 offset:38912
s_waitcnt lgkmcnt(0)
v_mfma_f32_16x16x32_bf16 v[52:55], v[20:23], a[128:131], v[52:55]
v_mfma_f32_16x16x32_bf16 v[56:59], v[20:23], a[132:135], v[56:59]
v_mfma_f32_16x16x32_bf16 v[60:63], v[24:27], a[128:131], v[60:63]
v_mfma_f32_16x16x32_bf16 v[64:67], v[24:27], a[132:135], v[64:67]
v_mfma_f32_16x16x32_bf16 v[52:55], v[28:31], a[136:139], v[52:55]
v_mfma_f32_16x16x32_bf16 v[56:59], v[28:31], a[140:143], v[56:59]
v_mfma_f32_16x16x32_bf16 v[60:63], v[32:35], a[136:139], v[60:63]
v_mfma_f32_16x16x32_bf16 v[64:67], v[32:35], a[140:143], v[64:67]
v_mfma_f32_16x16x32_bf16 v[52:55], v[36:39], a[144:147], v[52:55]
v_mfma_f32_16x16x32_bf16 v[56:59], v[36:39], a[148:151], v[56:59]
v_mfma_f32_16x16x32_bf16 v[60:63], v[40:43], a[144:147], v[60:63]
v_mfma_f32_16x16x32_bf16 v[64:67], v[40:43], a[148:151], v[64:67]
v_mfma_f32_16x16x32_bf16 v[52:55], v[44:47], a[152:155], v[52:55]
v_mfma_f32_16x16x32_bf16 v[56:59], v[44:47], a[156:159], v[56:59]
v_mfma_f32_16x16x32_bf16 v[60:63], v[48:51], a[152:155], v[60:63]
v_mfma_f32_16x16x32_bf16 v[64:67], v[48:51], a[156:159], v[64:67]
s_waitcnt vmcnt(18)
ds_read_b64_tr_b16 a[160:161], v17 offset:16384
ds_read_b64_tr_b16 a[162:163], v17 offset:16640
ds_read_b64_tr_b16 a[164:165], v17 offset:16416
ds_read_b64_tr_b16 a[166:167], v17 offset:16672
ds_read_b64_tr_b16 a[168:169], v17 offset:18432
ds_read_b64_tr_b16 a[170:171], v17 offset:18688
ds_read_b64_tr_b16 a[172:173], v17 offset:18464
ds_read_b64_tr_b16 a[174:175], v17 offset:18720
s_waitcnt lgkmcnt(0)
ds_read_b64_tr_b16 a[176:177], v17 offset:20480
ds_read_b64_tr_b16 a[178:179], v17 offset:20736
ds_read_b64_tr_b16 a[180:181], v17 offset:20512
ds_read_b64_tr_b16 a[182:183], v17 offset:20768
ds_read_b64_tr_b16 a[184:185], v17 offset:22528
ds_read_b64_tr_b16 a[186:187], v17 offset:22784
ds_read_b64_tr_b16 a[188:189], v17 offset:22560
ds_read_b64_tr_b16 a[190:191], v17 offset:22816
s_waitcnt lgkmcnt(0)
ds_read_b128 v[20:23], v8 offset:40960
ds_read_b128 v[24:27], v8 offset:43008
ds_read_b128 v[28:31], v9 offset:40960
ds_read_b128 v[32:35], v9 offset:43008
ds_read_b128 v[36:39], v8 offset:45056
ds_read_b128 v[40:43], v8 offset:47104
ds_read_b128 v[44:47], v9 offset:45056
ds_read_b128 v[48:51], v9 offset:47104
s_waitcnt lgkmcnt(0)
v_mfma_f32_16x16x32_bf16 v[52:55], v[20:23], a[160:163], v[52:55]
v_mfma_f32_16x16x32_bf16 v[56:59], v[20:23], a[164:167], v[56:59]
v_mfma_f32_16x16x32_bf16 v[60:63], v[24:27], a[160:163], v[60:63]
v_mfma_f32_16x16x32_bf16 v[64:67], v[24:27], a[164:167], v[64:67]
v_mfma_f32_16x16x32_bf16 v[52:55], v[28:31], a[168:171], v[52:55]
v_mfma_f32_16x16x32_bf16 v[56:59], v[28:31], a[172:175], v[56:59]
v_mfma_f32_16x16x32_bf16 v[60:63], v[32:35], a[168:171], v[60:63]
v_mfma_f32_16x16x32_bf16 v[64:67], v[32:35], a[172:175], v[64:67]
v_mfma_f32_16x16x32_bf16 v[52:55], v[36:39], a[176:179], v[52:55]
v_mfma_f32_16x16x32_bf16 v[56:59], v[36:39], a[180:183], v[56:59]
v_mfma_f32_16x16x32_bf16 v[60:63], v[40:43], a[176:179], v[60:63]
v_mfma_f32_16x16x32_bf16 v[64:67], v[40:43], a[180:183], v[64:67]
v_mfma_f32_16x16x32_bf16 v[52:55], v[44:47], a[184:187], v[52:55]
v_mfma_f32_16x16x32_bf16 v[56:59], v[44:47], a[188:191], v[56:59]
v_mfma_f32_16x16x32_bf16 v[60:63], v[48:51], a[184:187], v[60:63]
v_mfma_f32_16x16x32_bf16 v[64:67], v[48:51], a[188:191], v[64:67]
s_waitcnt vmcnt(9)
ds_read_b64_tr_b16 a[192:193], v17 offset:0
ds_read_b64_tr_b16 a[194:195], v17 offset:256
ds_read_b64_tr_b16 a[196:197], v17 offset:32
ds_read_b64_tr_b16 a[198:199], v17 offset:288
ds_read_b64_tr_b16 a[200:201], v17 offset:2048
ds_read_b64_tr_b16 a[202:203], v17 offset:2304
ds_read_b64_tr_b16 a[204:205], v17 offset:2080
ds_read_b64_tr_b16 a[206:207], v17 offset:2336
s_waitcnt lgkmcnt(0)
ds_read_b64_tr_b16 a[208:209], v17 offset:4096
ds_read_b64_tr_b16 a[210:211], v17 offset:4352
ds_read_b64_tr_b16 a[212:213], v17 offset:4128
ds_read_b64_tr_b16 a[214:215], v17 offset:4384
ds_read_b64_tr_b16 a[216:217], v17 offset:6144
ds_read_b64_tr_b16 a[218:219], v17 offset:6400
ds_read_b64_tr_b16 a[220:221], v17 offset:6176
ds_read_b64_tr_b16 a[222:223], v17 offset:6432
s_waitcnt lgkmcnt(0)
ds_read_b128 v[20:23], v8 offset:49152
ds_read_b128 v[24:27], v8 offset:51200
ds_read_b128 v[28:31], v9 offset:49152
ds_read_b128 v[32:35], v9 offset:51200
ds_read_b128 v[36:39], v8 offset:53248
ds_read_b128 v[40:43], v8 offset:55296
ds_read_b128 v[44:47], v9 offset:53248
ds_read_b128 v[48:51], v9 offset:55296
s_waitcnt lgkmcnt(0)
v_mfma_f32_16x16x32_bf16 v[52:55], v[20:23], a[192:195], v[52:55]
v_mfma_f32_16x16x32_bf16 v[56:59], v[20:23], a[196:199], v[56:59]
v_mfma_f32_16x16x32_bf16 v[60:63], v[24:27], a[192:195], v[60:63]
v_mfma_f32_16x16x32_bf16 v[64:67], v[24:27], a[196:199], v[64:67]
v_mfma_f32_16x16x32_bf16 v[52:55], v[28:31], a[200:203], v[52:55]
v_mfma_f32_16x16x32_bf16 v[56:59], v[28:31], a[204:207], v[56:59]
v_mfma_f32_16x16x32_bf16 v[60:63], v[32:35], a[200:203], v[60:63]
v_mfma_f32_16x16x32_bf16 v[64:67], v[32:35], a[204:207], v[64:67]
v_mfma_f32_16x16x32_bf16 v[52:55], v[36:39], a[208:211], v[52:55]
v_mfma_f32_16x16x32_bf16 v[56:59], v[36:39], a[212:215], v[56:59]
v_mfma_f32_16x16x32_bf16 v[60:63], v[40:43], a[208:211], v[60:63]
v_mfma_f32_16x16x32_bf16 v[64:67], v[40:43], a[212:215], v[64:67]
v_mfma_f32_16x16x32_bf16 v[52:55], v[44:47], a[216:219], v[52:55]
v_mfma_f32_16x16x32_bf16 v[56:59], v[44:47], a[220:223], v[56:59]
v_mfma_f32_16x16x32_bf16 v[60:63], v[48:51], a[216:219], v[60:63]
v_mfma_f32_16x16x32_bf16 v[64:67], v[48:51], a[220:223], v[64:67]
s_waitcnt vmcnt(0)
ds_read_b64_tr_b16 a[224:225], v17 offset:8192
ds_read_b64_tr_b16 a[226:227], v17 offset:8448
ds_read_b64_tr_b16 a[228:229], v17 offset:8224
ds_read_b64_tr_b16 a[230:231], v17 offset:8480
ds_read_b64_tr_b16 a[232:233], v17 offset:10240
ds_read_b64_tr_b16 a[234:235], v17 offset:10496
ds_read_b64_tr_b16 a[236:237], v17 offset:10272
ds_read_b64_tr_b16 a[238:239], v17 offset:10528
s_waitcnt lgkmcnt(0)
ds_read_b64_tr_b16 a[240:241], v17 offset:12288
ds_read_b64_tr_b16 a[242:243], v17 offset:12544
ds_read_b64_tr_b16 a[244:245], v17 offset:12320
ds_read_b64_tr_b16 a[246:247], v17 offset:12576
ds_read_b64_tr_b16 a[248:249], v17 offset:14336
ds_read_b64_tr_b16 a[250:251], v17 offset:14592
ds_read_b64_tr_b16 a[252:253], v17 offset:14368
ds_read_b64_tr_b16 a[254:255], v17 offset:14624
s_waitcnt lgkmcnt(0)
ds_read_b128 v[20:23], v8 offset:57344
ds_read_b128 v[24:27], v8 offset:59392
ds_read_b128 v[28:31], v9 offset:57344
ds_read_b128 v[32:35], v9 offset:59392
ds_read_b128 v[36:39], v8 offset:61440
ds_read_b128 v[40:43], v8 offset:63488
ds_read_b128 v[44:47], v9 offset:61440
ds_read_b128 v[48:51], v9 offset:63488
s_waitcnt lgkmcnt(0)
v_mfma_f32_16x16x32_bf16 v[52:55], v[20:23], a[224:227], v[52:55]
v_mfma_f32_16x16x32_bf16 v[56:59], v[20:23], a[228:231], v[56:59]
v_mfma_f32_16x16x32_bf16 v[60:63], v[24:27], a[224:227], v[60:63]
v_mfma_f32_16x16x32_bf16 v[64:67], v[24:27], a[228:231], v[64:67]
v_mfma_f32_16x16x32_bf16 v[52:55], v[28:31], a[232:235], v[52:55]
v_mfma_f32_16x16x32_bf16 v[56:59], v[28:31], a[236:239], v[56:59]
v_mfma_f32_16x16x32_bf16 v[60:63], v[32:35], a[232:235], v[60:63]
v_mfma_f32_16x16x32_bf16 v[64:67], v[32:35], a[236:239], v[64:67]
v_mfma_f32_16x16x32_bf16 v[52:55], v[36:39], a[240:243], v[52:55]
v_mfma_f32_16x16x32_bf16 v[56:59], v[36:39], a[244:247], v[56:59]
v_mfma_f32_16x16x32_bf16 v[60:63], v[40:43], a[240:243], v[60:63]
v_mfma_f32_16x16x32_bf16 v[64:67], v[40:43], a[244:247], v[64:67]
v_mfma_f32_16x16x32_bf16 v[52:55], v[44:47], a[248:251], v[52:55]
v_mfma_f32_16x16x32_bf16 v[56:59], v[44:47], a[252:255], v[56:59]
v_mfma_f32_16x16x32_bf16 v[60:63], v[48:51], a[248:251], v[60:63]
v_mfma_f32_16x16x32_bf16 v[64:67], v[48:51], a[252:255], v[64:67]
s_barrier
s_mov_b32 s50, 0x10000
s_add_u32 m0, s46, 65536
s_nop 0
buffer_load_dwordx4 v6, s[8:11], s50 offen offset:0 lds
s_add_u32 m0, s46, 69504
s_nop 0
buffer_load_dwordx4 v6, s[8:11], s50 offen offset:128 lds
s_add_u32 m0, s46, 73472
s_nop 0
buffer_load_dwordx4 v6, s[8:11], s50 offen offset:256 lds
s_add_u32 m0, s46, 77440
s_nop 0
buffer_load_dwordx4 v6, s[8:11], s50 offen offset:384 lds
s_add_u32 m0, s46, 81408
s_nop 0
buffer_load_dwordx4 v6, s[8:11], s50 offen offset:512 lds
s_add_u32 m0, s46, 85376
s_nop 0
buffer_load_dwordx4 v6, s[8:11], s50 offen offset:640 lds
s_add_u32 m0, s46, 89344
s_nop 0
buffer_load_dwordx4 v6, s[8:11], s50 offen offset:768 lds
s_add_u32 m0, s46, 93312
s_nop 0
buffer_load_dwordx4 v6, s[8:11], s50 offen offset:896 lds
s_add_u32 m0, s46, 97280
s_nop 0
buffer_load_dwordx4 v6, s[8:11], s50 offen offset:1024 lds
s_add_u32 m0, s46, 101248
s_nop 0
buffer_load_dwordx4 v6, s[8:11], s50 offen offset:1152 lds
s_add_u32 m0, s46, 105216
s_nop 0
buffer_load_dwordx4 v6, s[8:11], s50 offen offset:1280 lds
s_add_u32 m0, s46, 109184
s_nop 0
buffer_load_dwordx4 v6, s[8:11], s50 offen offset:1408 lds
s_add_u32 m0, s46, 113152
s_nop 0
buffer_load_dwordx4 v6, s[8:11], s50 offen offset:1536 lds
s_add_u32 m0, s46, 117120
s_nop 0
buffer_load_dwordx4 v6, s[8:11], s50 offen offset:1664 lds
s_add_u32 m0, s46, 121088
s_nop 0
buffer_load_dwordx4 v6, s[8:11], s50 offen offset:1792 lds
s_add_u32 m0, s46, 125056
s_nop 0
buffer_load_dwordx4 v6, s[8:11], s50 offen offset:1920 lds
s_and_b32 s53, s47, 31
s_lshl_b32 s53, s53, 4
v_add_u32 v19, s53, v1
v_lshlrev_b32 v19, 7, v19
s_mov_b32 s42, 1
v_and_b32 v3, 15, v0
v_lshlrev_b32 v3, 4, v3
s_branch mega_kernel_syv
mega_kernel_syvw:
s_sleep 4
mega_kernel_syv:
buffer_load_dword v2, v3, s[72:75], 0 offen sc1
s_waitcnt vmcnt(0)
mega_kernel_syvp:
s_cmp_eq_u32 s95, 1
s_cbranch_scc0 mega_kernel_syvf
v_readlane_b32 s76, v2, 14
s_mov_b32 s98, 0
s_cmp_eq_u32 s76, 32
s_cbranch_scc0 mega_kernel_syvw
s_branch mega_kernel_syvd
mega_kernel_syvf:
s_mov_b32 s77, 0
s_mov_b32 s78, 0
v_readlane_b32 s76, v2, 0
s_add_u32 s77, s77, s76
s_xor_b32 s76, s76, 32
s_or_b32 s78, s78, s76
v_readlane_b32 s76, v2, 1
s_add_u32 s77, s77, s76
s_xor_b32 s76, s76, 32
s_or_b32 s78, s78, s76
v_readlane_b32 s76, v2, 2
s_add_u32 s77, s77, s76
s_xor_b32 s76, s76, 32
s_or_b32 s78, s78, s76
v_readlane_b32 s76, v2, 3
s_add_u32 s77, s77, s76
s_xor_b32 s76, s76, 32
s_or_b32 s78, s78, s76
v_readlane_b32 s76, v2, 4
s_add_u32 s77, s77, s76
s_xor_b32 s76, s76, 32
s_or_b32 s78, s78, s76
v_readlane_b32 s76, v2, 5
s_add_u32 s77, s77, s76
s_xor_b32 s76, s76, 32
s_or_b32 s78, s78, s76
v_readlane_b32 s76, v2, 6
s_add_u32 s77, s77, s76
s_xor_b32 s76, s76, 32
s_or_b32 s78, s78, s76
v_readlane_b32 s76, v2, 7
s_add_u32 s77, s77, s76
s_xor_b32 s76, s76, 32
s_or_b32 s78, s78, s76
s_cmp_eq_u32 s77, 256
s_cbranch_scc0 mega_kernel_syvw
v_mov_b32 v252, v2
s_cmp_eq_u32 s78, 0
s_cbranch_scc0 mega_kernel_slowent
v_readlane_b32 s76, v2, 10
v_readlane_b32 s77, v2, 8
s_cmp_eq_u32 s76, 32
s_cbranch_scc0 mega_kernel_syvw
s_cmp_gt_u32 s77, 16
s_cselect_b32 s98, 1, 0
mega_kernel_syvd:
s_lshr_b32 s44, s47, 3
s_xor_b32 s44, s44, s98
s_and_b32 s44, s44, 1
s_lshl_b32 s44, s44, 13
s_lshl_b32 s48, s47, 18
s_add_u32 s48, s48, s44
s_add_u32 s48, s48, 33554432
s_xor_b32 s44, s98, 1
s_lshl_b32 s44, s44, 13
s_lshl_b32 s49, s40, 7
s_add_u32 s49, s49, s44
s_lshl_b32 s44, s41, 2
s_add_u32 s49, s49, s44
s_add_u32 s49, s49, 69210112
v_mov_b32 v16, 0
v_cvt_pk_bf16_f32 v84, v52, v53
v_cvt_pk_bf16_f32 v85, v54, v55
v_cvt_pk_bf16_f32 v86, v60, v61
v_cvt_pk_bf16_f32 v87, v62, v63
v_cvt_pk_bf16_f32 v88, v56, v57
v_cvt_pk_bf16_f32 v89, v58, v59
v_cvt_pk_bf16_f32 v90, v64, v65
v_cvt_pk_bf16_f32 v91, v66, v67
s_add_u32 s51, s42, s47
s_sub_u32 s51, s51, 1
s_bfe_u32 s52, s51, 0x40002
s_lshl_b32 s52, s52, 14
s_and_b32 s51, s51, 3
s_lshl_b32 s51, s51, 11
s_add_u32 s51, s51, s52
s_add_u32 s51, s51, s48
buffer_store_dwordx4 v[84:87], v7, s[84:87], s51 offen sc1
buffer_store_dwordx4 v[88:91], v7, s[84:87], s51 offen offset:1024 sc1
s_waitcnt vmcnt(0)
v_mov_b32 v17, s42
s_mov_b64 exec, 1
buffer_store_dword v17, v16, s[84:87], s49 offen sc1
s_mov_b64 exec, -1
mega_kernel_v_loop:
s_waitcnt vmcnt(2)
s_barrier
s_add_u32 s50, s42, 1
s_min_u32 s50, s50, 63
s_lshl_b32 s50, s50, 16
ds_read_b128 v[20:23], v10 offset:0
ds_read_b128 v[24:27], v10 offset:2048
ds_read_b128 v[28:31], v11 offset:0
ds_read_b128 v[32:35], v11 offset:2048
ds_read_b128 v[36:39], v10 offset:4096
ds_read_b128 v[40:43], v10 offset:6144
s_waitcnt lgkmcnt(4)
v_mfma_f32_16x16x32_bf16 v[68:71], v[20:23], a[0:3], 0
ds_read_b128 v[44:47], v11 offset:4096
v_mfma_f32_16x16x32_bf16 v[72:75], v[20:23], a[4:7], 0
v_cvt_pk_bf16_f32 v84, v52, v53
v_cvt_pk_bf16_f32 v85, v54, v55
v_cvt_pk_bf16_f32 v86, v60, v61
v_mfma_f32_16x16x32_bf16 v[76:79], v[24:27], a[0:3], 0
ds_read_b128 v[48:51], v11 offset:6144
v_mfma_f32_16x16x32_bf16 v[80:83], v[24:27], a[4:7], 0
v_cvt_pk_bf16_f32 v87, v62, v63
v_cvt_pk_bf16_f32 v88, v56, v57
v_cvt_pk_bf16_f32 v89, v58, v59
s_waitcnt lgkmcnt(4)
v_mfma_f32_16x16x32_bf16 v[68:71], v[28:31], a[8:11], v[68:71]
ds_read_b128 v[20:23], v10 offset:8192
v_mfma_f32_16x16x32_bf16 v[72:75], v[28:31], a[12:15], v[72:75]
v_cvt_pk_bf16_f32 v90, v64, v65
v_cvt_pk_bf16_f32 v91, v66, v67
v_mfma_f32_16x16x32_bf16 v[76:79], v[32:35], a[8:11], v[76:79]
ds_read_b128 v[24:27], v10 offset:10240
v_mfma_f32_16x16x32_bf16 v[80:83], v[32:35], a[12:15], v[80:83]
s_add_u32 s51, s42, s47
s_sub_u32 s51, s51, 1
s_bfe_u32 s52, s51, 0x40002
s_lshl_b32 s52, s52, 14
s_waitcnt lgkmcnt(4)
v_mfma_f32_16x16x32_bf16 v[68:71], v[36:39], a[16:19], v[68:71]
ds_read_b128 v[28:31], v11 offset:8192
v_mfma_f32_16x16x32_bf16 v[72:75], v[36:39], a[20:23], v[72:75]
s_and_b32 s51, s51, 3
s_lshl_b32 s51, s51, 11
s_add_u32 s51, s51, s52
s_add_u32 s51, s51, s48
buffer_store_dwordx4 v[84:87], v7, s[84:87], s51 offen sc1
v_mfma_f32_16x16x32_bf16 v[76:79], v[40:43], a[16:19], v[76:79]
ds_read_b128 v[32:35], v11 offset:10240
v_mfma_f32_16x16x32_bf16 v[80:83], v[40:43], a[20:23], v[80:83]
buffer_store_dwordx4 v[88:91], v7, s[84:87], s51 offen offset:1024 sc1
s_waitcnt lgkmcnt(4)
v_mfma_f32_16x16x32_bf16 v[68:71], v[44:47], a[24:27], v[68:71]
ds_read_b128 v[36:39], v10 offset:12288
v_mfma_f32_16x16x32_bf16 v[72:75], v[44:47], a[28:31], v[72:75]
s_add_u32 m0, s46, 0
v_mfma_f32_16x16x32_bf16 v[76:79], v[48:51], a[24:27], v[76:79]
ds_read_b128 v[40:43], v10 offset:14336
v_mfma_f32_16x16x32_bf16 v[80:83], v[48:51], a[28:31], v[80:83]
buffer_load_dwordx4 v6, s[8:11], s50 offen offset:0 lds
s_waitcnt lgkmcnt(4)
v_mfma_f32_16x16x32_bf16 v[68:71], v[20:23], a[32:35], v[68:71]
ds_read_b128 v[44:47], v11 offset:12288
v_mfma_f32_16x16x32_bf16 v[72:75], v[20:23], a[36:39], v[72:75]
s_add_u32 m0, s46, 3968
v_mfma_f32_16x16x32_bf16 v[76:79], v[24:27], a[32:35], v[76:79]
ds_read_b128 v[48:51], v11 offset:14336
v_mfma_f32_16x16x32_bf16 v[80:83], v[24:27], a[36:39], v[80:83]
buffer_load_dwordx4 v6, s[8:11], s50 offen offset:128 lds
s_waitcnt lgkmcnt(4)
v_mfma_f32_16x16x32_bf16 v[68:71], v[28:31], a[40:43], v[68:71]
ds_read_b128 v[20:23], v10 offset:16384
v_mfma_f32_16x16x32_bf16 v[72:75], v[28:31], a[44:47], v[72:75]
s_add_u32 m0, s46, 7936
v_mfma_f32_16x16x32_bf16 v[76:79], v[32:35], a[40:43], v[76:79]
ds_read_b128 v[24:27], v10 offset:18432
v_mfma_f32_16x16x32_bf16 v[80:83], v[32:35], a[44:47], v[80:83]
buffer_load_dwordx4 v6, s[8:11], s50 offen offset:256 lds
s_waitcnt lgkmcnt(4)
v_mfma_f32_16x16x32_bf16 v[68:71], v[36:39], a[48:51], v[68:71]
ds_read_b128 v[28:31], v11 offset:16384
v_mfma_f32_16x16x32_bf16 v[72:75], v[36:39], a[52:55], v[72:75]
s_add_u32 m0, s46, 11904
v_mfma_f32_16x16x32_bf16 v[76:79], v[40:43], a[48:51], v[76:79]
ds_read_b128 v[32:35], v11 offset:18432
v_mfma_f32_16x16x32_bf16 v[80:83], v[40:43], a[52:55], v[80:83]
buffer_load_dwordx4 v6, s[8:11], s50 offen offset:384 lds
s_waitcnt lgkmcnt(4)
v_mfma_f32_16x16x32_bf16 v[68:71], v[44:47], a[56:59], v[68:71]
ds_read_b128 v[36:39], v10 offset:20480
v_mfma_f32_16x16x32_bf16 v[72:75], v[44:47], a[60:63], v[72:75]
s_add_u32 m0, s46, 15872
v_mfma_f32_16x16x32_bf16 v[76:79], v[48:51], a[56:59], v[76:79]
ds_read_b128 v[40:43], v10 offset:22528
v_mfma_f32_16x16x32_bf16 v[80:83], v[48:51], a[60:63], v[80:83]
buffer_load_dwordx4 v6, s[8:11], s50 offen offset:512 lds
s_waitcnt lgkmcnt(4)
v_mfma_f32_16x16x32_bf16 v[68:71], v[20:23], a[64:67], v[68:71]
ds_read_b128 v[44:47], v11 offset:20480
v_mfma_f32_16x16x32_bf16 v[72:75], v[20:23], a[68:71], v[72:75]
s_add_u32 m0, s46, 19840
v_mfma_f32_16x16x32_bf16 v[76:79], v[24:27], a[64:67], v[76:79]
ds_read_b128 v[48:51], v11 offset:22528
v_mfma_f32_16x16x32_bf16 v[80:83], v[24:27], a[68:71], v[80:83]
buffer_load_dwordx4 v6, s[8:11], s50 offen offset:640 lds
s_waitcnt lgkmcnt(4)
v_mfma_f32_16x16x32_bf16 v[68:71], v[28:31], a[72:75], v[68:71]
ds_read_b128 v[20:23], v10 offset:24576
v_mfma_f32_16x16x32_bf16 v[72:75], v[28:31], a[76:79], v[72:75]
s_add_u32 m0, s46, 23808
v_mfma_f32_16x16x32_bf16 v[76:79], v[32:35], a[72:75], v[76:79]
ds_read_b128 v[24:27], v10 offset:26624
v_mfma_f32_16x16x32_bf16 v[80:83], v[32:35], a[76:79], v[80:83]
buffer_load_dwordx4 v6, s[8:11], s50 offen offset:768 lds
s_waitcnt lgkmcnt(4)
v_mfma_f32_16x16x32_bf16 v[68:71], v[36:39], a[80:83], v[68:71]
ds_read_b128 v[28:31], v11 offset:24576
v_mfma_f32_16x16x32_bf16 v[72:75], v[36:39], a[84:87], v[72:75]
s_add_u32 m0, s46, 27776
v_mfma_f32_16x16x32_bf16 v[76:79], v[40:43], a[80:83], v[76:79]
ds_read_b128 v[32:35], v11 offset:26624
v_mfma_f32_16x16x32_bf16 v[80:83], v[40:43], a[84:87], v[80:83]
buffer_load_dwordx4 v6, s[8:11], s50 offen offset:896 lds
s_waitcnt lgkmcnt(4)
v_mfma_f32_16x16x32_bf16 v[68:71], v[44:47], a[88:91], v[68:71]
ds_read_b128 v[36:39], v10 offset:28672
v_mfma_f32_16x16x32_bf16 v[72:75], v[44:47], a[92:95], v[72:75]
s_add_u32 m0, s46, 31744
v_mfma_f32_16x16x32_bf16 v[76:79], v[48:51], a[88:91], v[76:79]
ds_read_b128 v[40:43], v10 offset:30720
v_mfma_f32_16x16x32_bf16 v[80:83], v[48:51], a[92:95], v[80:83]
buffer_load_dwordx4 v6, s[8:11], s50 offen offset:1024 lds
s_waitcnt lgkmcnt(4)
v_mfma_f32_16x16x32_bf16 v[68:71], v[20:23], a[96:99], v[68:71]
ds_read_b128 v[44:47], v11 offset:28672
v_mfma_f32_16x16x32_bf16 v[72:75], v[20:23], a[100:103], v[72:75]
s_add_u32 m0, s46, 35712
v_mfma_f32_16x16x32_bf16 v[76:79], v[24:27], a[96:99], v[76:79]
ds_read_b128 v[48:51], v11 offset:30720
v_mfma_f32_16x16x32_bf16 v[80:83], v[24:27], a[100:103], v[80:83]
buffer_load_dwordx4 v6, s[8:11], s50 offen offset:1152 lds
s_waitcnt lgkmcnt(4)
v_mfma_f32_16x16x32_bf16 v[68:71], v[28:31], a[104:107], v[68:71]
ds_read_b128 v[20:23], v10 offset:32768
v_mfma_f32_16x16x32_bf16 v[72:75], v[28:31], a[108:111], v[72:75]
s_add_u32 m0, s46, 39680
v_mfma_f32_16x16x32_bf16 v[76:79], v[32:35], a[104:107], v[76:79]
ds_read_b128 v[24:27], v10 offset:34816
v_mfma_f32_16x16x32_bf16 v[80:83], v[32:35], a[108:111], v[80:83]
buffer_load_dwordx4 v6, s[8:11], s50 offen offset:1280 lds
s_waitcnt lgkmcnt(4)
v_mfma_f32_16x16x32_bf16 v[68:71], v[36:39], a[112:115], v[68:71]
ds_read_b128 v[28:31], v11 offset:32768
v_mfma_f32_16x16x32_bf16 v[72:75], v[36:39], a[116:119], v[72:75]
s_add_u32 m0, s46, 43648
v_mfma_f32_16x16x32_bf16 v[76:79], v[40:43], a[112:115], v[76:79]
ds_read_b128 v[32:35], v11 offset:34816
v_mfma_f32_16x16x32_bf16 v[80:83], v[40:43], a[116:119], v[80:83]
buffer_load_dwordx4 v6, s[8:11], s50 offen offset:1408 lds
s_waitcnt lgkmcnt(4)
v_mfma_f32_16x16x32_bf16 v[68:71], v[44:47], a[120:123], v[68:71]
ds_read_b128 v[36:39], v10 offset:36864
v_mfma_f32_16x16x32_bf16 v[72:75], v[44:47], a[124:127], v[72:75]
s_add_u32 m0, s46, 47616
v_mfma_f32_16x16x32_bf16 v[76:79], v[48:51], a[120:123], v[76:79]
ds_read_b128 v[40:43], v10 offset:38912
v_mfma_f32_16x16x32_bf16 v[80:83], v[48:51], a[124:127], v[80:83]
buffer_load_dwordx4 v6, s[8:11], s50 offen offset:1536 lds
s_waitcnt lgkmcnt(4)
v_mfma_f32_16x16x32_bf16 v[68:71], v[20:23], a[128:131], v[68:71]
ds_read_b128 v[44:47], v11 offset:36864
v_mfma_f32_16x16x32_bf16 v[72:75], v[20:23], a[132:135], v[72:75]
s_add_u32 m0, s46, 51584
v_mfma_f32_16x16x32_bf16 v[76:79], v[24:27], a[128:131], v[76:79]
ds_read_b128 v[48:51], v11 offset:38912
v_mfma_f32_16x16x32_bf16 v[80:83], v[24:27], a[132:135], v[80:83]
buffer_load_dwordx4 v6, s[8:11], s50 offen offset:1664 lds
s_waitcnt lgkmcnt(4)
v_mfma_f32_16x16x32_bf16 v[68:71], v[28:31], a[136:139], v[68:71]
ds_read_b128 v[20:23], v10 offset:40960
v_mfma_f32_16x16x32_bf16 v[72:75], v[28:31], a[140:143], v[72:75]
s_add_u32 m0, s46, 55552
v_mfma_f32_16x16x32_bf16 v[76:79], v[32:35], a[136:139], v[76:79]
ds_read_b128 v[24:27], v10 offset:43008
v_mfma_f32_16x16x32_bf16 v[80:83], v[32:35], a[140:143], v[80:83]
buffer_load_dwordx4 v6, s[8:11], s50 offen offset:1792 lds
s_waitcnt lgkmcnt(4)
v_mfma_f32_16x16x32_bf16 v[68:71], v[36:39], a[144:147], v[68:71]
ds_read_b128 v[28:31], v11 offset:40960
v_mfma_f32_16x16x32_bf16 v[72:75], v[36:39], a[148:151], v[72:75]
s_add_u32 m0, s46, 59520
v_mfma_f32_16x16x32_bf16 v[76:79], v[40:43], a[144:147], v[76:79]
ds_read_b128 v[32:35], v11 offset:43008
v_mfma_f32_16x16x32_bf16 v[80:83], v[40:43], a[148:151], v[80:83]
buffer_load_dwordx4 v6, s[8:11], s50 offen offset:1920 lds
s_waitcnt lgkmcnt(4)
v_mfma_f32_16x16x32_bf16 v[68:71], v[44:47], a[152:155], v[68:71]
ds_read_b128 v[36:39], v10 offset:45056
v_mfma_f32_16x16x32_bf16 v[72:75], v[44:47], a[156:159], v[72:75]
v_mfma_f32_16x16x32_bf16 v[76:79], v[48:51], a[152:155], v[76:79]
ds_read_b128 v[40:43], v10 offset:47104
v_mfma_f32_16x16x32_bf16 v[80:83], v[48:51], a[156:159], v[80:83]
s_waitcnt lgkmcnt(4)
v_mfma_f32_16x16x32_bf16 v[68:71], v[20:23], a[160:163], v[68:71]
ds_read_b128 v[44:47], v11 offset:45056
v_mfma_f32_16x16x32_bf16 v[72:75], v[20:23], a[164:167], v[72:75]
v_mfma_f32_16x16x32_bf16 v[76:79], v[24:27], a[160:163], v[76:79]
ds_read_b128 v[48:51], v11 offset:47104
v_mfma_f32_16x16x32_bf16 v[80:83], v[24:27], a[164:167], v[80:83]
s_waitcnt lgkmcnt(4)
v_mfma_f32_16x16x32_bf16 v[68:71], v[28:31], a[168:171], v[68:71]
ds_read_b128 v[20:23], v10 offset:49152
v_mfma_f32_16x16x32_bf16 v[72:75], v[28:31], a[172:175], v[72:75]
s_waitcnt vmcnt(16)
v_mov_b32 v17, s42
s_mov_b64 exec, 1
buffer_store_dword v17, v16, s[84:87], s49 offen sc1
s_mov_b64 exec, -1
v_mfma_f32_16x16x32_bf16 v[76:79], v[32:35], a[168:171], v[76:79]
ds_read_b128 v[24:27], v10 offset:51200
v_mfma_f32_16x16x32_bf16 v[80:83], v[32:35], a[172:175], v[80:83]
s_waitcnt lgkmcnt(4)
v_mfma_f32_16x16x32_bf16 v[68:71], v[36:39], a[176:179], v[68:71]
ds_read_b128 v[28:31], v11 offset:49152
v_mfma_f32_16x16x32_bf16 v[72:75], v[36:39], a[180:183], v[72:75]
s_add_u32 s53, s42, 3
s_min_u32 s53, s53, 63
s_lshl_b32 s53, s53, 16
s_mov_b64 exec, 0xffff
buffer_load_dword v250, v19, s[8:11], s53 offen
s_mov_b64 exec, -1
v_mfma_f32_16x16x32_bf16 v[76:79], v[40:43], a[176:179], v[76:79]
ds_read_b128 v[32:35], v11 offset:51200
v_mfma_f32_16x16x32_bf16 v[80:83], v[40:43], a[180:183], v[80:83]
s_waitcnt lgkmcnt(4)
v_mfma_f32_16x16x32_bf16 v[68:71], v[44:47], a[184:187], v[68:71]
ds_read_b128 v[36:39], v10 offset:53248
v_mfma_f32_16x16x32_bf16 v[72:75], v[44:47], a[188:191], v[72:75]
v_mfma_f32_16x16x32_bf16 v[76:79], v[48:51], a[184:187], v[76:79]
ds_read_b128 v[40:43], v10 offset:55296
v_mfma_f32_16x16x32_bf16 v[80:83], v[48:51], a[188:191], v[80:83]
s_waitcnt lgkmcnt(4)
v_mfma_f32_16x16x32_bf16 v[68:71], v[20:23], a[192:195], v[68:71]
ds_read_b128 v[44:47], v11 offset:53248
v_mfma_f32_16x16x32_bf16 v[72:75], v[20:23], a[196:199], v[72:75]
v_mfma_f32_16x16x32_bf16 v[76:79], v[24:27], a[192:195], v[76:79]
ds_read_b128 v[48:51], v11 offset:55296
v_mfma_f32_16x16x32_bf16 v[80:83], v[24:27], a[196:199], v[80:83]
s_waitcnt lgkmcnt(4)
v_mfma_f32_16x16x32_bf16 v[68:71], v[28:31], a[200:203], v[68:71]
ds_read_b128 v[20:23], v10 offset:57344
v_mfma_f32_16x16x32_bf16 v[72:75], v[28:31], a[204:207], v[72:75]
v_mfma_f32_16x16x32_bf16 v[76:79], v[32:35], a[200:203], v[76:79]
ds_read_b128 v[24:27], v10 offset:59392
v_mfma_f32_16x16x32_bf16 v[80:83], v[32:35], a[204:207], v[80:83]
s_waitcnt lgkmcnt(4)
v_mfma_f32_16x16x32_bf16 v[68:71], v[36:39], a[208:211], v[68:71]
ds_read_b128 v[28:31], v11 offset:57344
v_mfma_f32_16x16x32_bf16 v[72:75], v[36:39], a[212:215], v[72:75]
v_mfma_f32_16x16x32_bf16 v[76:79], v[40:43], a[208:211], v[76:79]
ds_read_b128 v[32:35], v11 offset:59392
v_mfma_f32_16x16x32_bf16 v[80:83], v[40:43], a[212:215], v[80:83]
s_waitcnt lgkmcnt(4)
v_mfma_f32_16x16x32_bf16 v[68:71], v[44:47], a[216:219], v[68:71]
ds_read_b128 v[36:39], v10 offset:61440
v_mfma_f32_16x16x32_bf16 v[72:75], v[44:47], a[220:223], v[72:75]
v_mfma_f32_16x16x32_bf16 v[76:79], v[48:51], a[216:219], v[76:79]
ds_read_b128 v[40:43], v10 offset:63488
v_mfma_f32_16x16x32_bf16 v[80:83], v[48:51], a[220:223], v[80:83]
s_waitcnt lgkmcnt(4)
v_mfma_f32_16x16x32_bf16 v[68:71], v[20:23], a[224:227], v[68:71]
ds_read_b128 v[44:47], v11 offset:61440
v_mfma_f32_16x16x32_bf16 v[72:75], v[20:23], a[228:231], v[72:75]
v_mfma_f32_16x16x32_bf16 v[76:79], v[24:27], a[224:227], v[76:79]
ds_read_b128 v[48:51], v11 offset:63488
v_mfma_f32_16x16x32_bf16 v[80:83], v[24:27], a[228:231], v[80:83]
s_waitcnt lgkmcnt(5)
v_mfma_f32_16x16x32_bf16 v[68:71], v[28:31], a[232:235], v[68:71]
v_mfma_f32_16x16x32_bf16 v[72:75], v[28:31], a[236:239], v[72:75]
s_waitcnt lgkmcnt(4)
v_mfma_f32_16x16x32_bf16 v[76:79], v[32:35], a[232:235], v[76:79]
v_mfma_f32_16x16x32_bf16 v[80:83], v[32:35], a[236:239], v[80:83]
s_waitcnt lgkmcnt(3)
v_mfma_f32_16x16x32_bf16 v[68:71], v[36:39], a[240:243], v[68:71]
v_mfma_f32_16x16x32_bf16 v[72:75], v[36:39], a[244:247], v[72:75]
s_waitcnt lgkmcnt(2)
v_mfma_f32_16x16x32_bf16 v[76:79], v[40:43], a[240:243], v[76:79]
v_mfma_f32_16x16x32_bf16 v[80:83], v[40:43], a[244:247], v[80:83]
s_waitcnt lgkmcnt(1)
v_mfma_f32_16x16x32_bf16 v[68:71], v[44:47], a[248:251], v[68:71]
v_mfma_f32_16x16x32_bf16 v[72:75], v[44:47], a[252:255], v[72:75]
s_waitcnt lgkmcnt(0)
v_mfma_f32_16x16x32_bf16 v[76:79], v[48:51], a[248:251], v[76:79]
v_mfma_f32_16x16x32_bf16 v[80:83], v[48:51], a[252:255], v[80:83]
s_add_u32 s42, s42, 1
s_cmp_eq_u32 s42, 64
s_cbranch_scc1 mega_kernel_v_fin
mega_kernel_v_mid:
s_waitcnt vmcnt(2)
s_barrier
s_add_u32 s50, s42, 1
s_min_u32 s50, s50, 63
s_lshl_b32 s50, s50, 16
ds_read_b128 v[20:23], v8 offset:0
ds_read_b128 v[24:27], v8 offset:2048
ds_read_b128 v[28:31], v9 offset:0
ds_read_b128 v[32:35], v9 offset:2048
ds_read_b128 v[36:39], v8 offset:4096
ds_read_b128 v[40:43], v8 offset:6144
s_waitcnt lgkmcnt(4)
v_mfma_f32_16x16x32_bf16 v[52:55], v[20:23], a[0:3], 0
ds_read_b128 v[44:47], v9 offset:4096
v_mfma_f32_16x16x32_bf16 v[56:59], v[20:23], a[4:7], 0
v_cvt_pk_bf16_f32 v84, v68, v69
v_cvt_pk_bf16_f32 v85, v70, v71
v_cvt_pk_bf16_f32 v86, v76, v77
v_mfma_f32_16x16x32_bf16 v[60:63], v[24:27], a[0:3], 0
ds_read_b128 v[48:51], v9 offset:6144
v_mfma_f32_16x16x32_bf16 v[64:67], v[24:27], a[4:7], 0
v_cvt_pk_bf16_f32 v87, v78, v79
v_cvt_pk_bf16_f32 v88, v72, v73
v_cvt_pk_bf16_f32 v89, v74, v75
s_waitcnt lgkmcnt(4)
v_mfma_f32_16x16x32_bf16 v[52:55], v[28:31], a[8:11], v[52:55]
ds_read_b128 v[20:23], v8 offset:8192
v_mfma_f32_16x16x32_bf16 v[56:59], v[28:31], a[12:15], v[56:59]
v_cvt_pk_bf16_f32 v90, v80, v81
v_cvt_pk_bf16_f32 v91, v82, v83
v_mfma_f32_16x16x32_bf16 v[60:63], v[32:35], a[8:11], v[60:63]
ds_read_b128 v[24:27], v8 offset:10240
v_mfma_f32_16x16x32_bf16 v[64:67], v[32:35], a[12:15], v[64:67]
s_add_u32 s51, s42, s47
s_sub_u32 s51, s51, 1
s_bfe_u32 s52, s51, 0x40002
s_lshl_b32 s52, s52, 14
s_waitcnt lgkmcnt(4)
v_mfma_f32_16x16x32_bf16 v[52:55], v[36:39], a[16:19], v[52:55]
ds_read_b128 v[28:31], v9 offset:8192
v_mfma_f32_16x16x32_bf16 v[56:59], v[36:39], a[20:23], v[56:59]
s_and_b32 s51, s51, 3
s_lshl_b32 s51, s51, 11
s_add_u32 s51, s51, s52
s_add_u32 s51, s51, s48
buffer_store_dwordx4 v[84:87], v7, s[84:87], s51 offen sc1
v_mfma_f32_16x16x32_bf16 v[60:63], v[40:43], a[16:19], v[60:63]
ds_read_b128 v[32:35], v9 offset:10240
v_mfma_f32_16x16x32_bf16 v[64:67], v[40:43], a[20:23], v[64:67]
buffer_store_dwordx4 v[88:91], v7, s[84:87], s51 offen offset:1024 sc1
s_waitcnt lgkmcnt(4)
v_mfma_f32_16x16x32_bf16 v[52:55], v[44:47], a[24:27], v[52:55]
ds_read_b128 v[36:39], v8 offset:12288
v_mfma_f32_16x16x32_bf16 v[56:59], v[44:47], a[28:31], v[56:59]
s_add_u32 m0, s46, 65536
v_mfma_f32_16x16x32_bf16 v[60:63], v[48:51], a[24:27], v[60:63]
ds_read_b128 v[40:43], v8 offset:14336
v_mfma_f32_16x16x32_bf16 v[64:67], v[48:51], a[28:31], v[64:67]
buffer_load_dwordx4 v6, s[8:11], s50 offen offset:0 lds
s_waitcnt lgkmcnt(4)
v_mfma_f32_16x16x32_bf16 v[52:55], v[20:23], a[32:35], v[52:55]
ds_read_b128 v[44:47], v9 offset:12288
v_mfma_f32_16x16x32_bf16 v[56:59], v[20:23], a[36:39], v[56:59]
s_add_u32 m0, s46, 69504
v_mfma_f32_16x16x32_bf16 v[60:63], v[24:27], a[32:35], v[60:63]
ds_read_b128 v[48:51], v9 offset:14336
v_mfma_f32_16x16x32_bf16 v[64:67], v[24:27], a[36:39], v[64:67]
buffer_load_dwordx4 v6, s[8:11], s50 offen offset:128 lds
s_waitcnt lgkmcnt(4)
v_mfma_f32_16x16x32_bf16 v[52:55], v[28:31], a[40:43], v[52:55]
ds_read_b128 v[20:23], v8 offset:16384
v_mfma_f32_16x16x32_bf16 v[56:59], v[28:31], a[44:47], v[56:59]
s_add_u32 m0, s46, 73472
v_mfma_f32_16x16x32_bf16 v[60:63], v[32:35], a[40:43], v[60:63]
ds_read_b128 v[24:27], v8 offset:18432
v_mfma_f32_16x16x32_bf16 v[64:67], v[32:35], a[44:47], v[64:67]
buffer_load_dwordx4 v6, s[8:11], s50 offen offset:256 lds
s_waitcnt lgkmcnt(4)
v_mfma_f32_16x16x32_bf16 v[52:55], v[36:39], a[48:51], v[52:55]
ds_read_b128 v[28:31], v9 offset:16384
v_mfma_f32_16x16x32_bf16 v[56:59], v[36:39], a[52:55], v[56:59]
s_add_u32 m0, s46, 77440
v_mfma_f32_16x16x32_bf16 v[60:63], v[40:43], a[48:51], v[60:63]
ds_read_b128 v[32:35], v9 offset:18432
v_mfma_f32_16x16x32_bf16 v[64:67], v[40:43], a[52:55], v[64:67]
buffer_load_dwordx4 v6, s[8:11], s50 offen offset:384 lds
s_waitcnt lgkmcnt(4)
v_mfma_f32_16x16x32_bf16 v[52:55], v[44:47], a[56:59], v[52:55]
ds_read_b128 v[36:39], v8 offset:20480
v_mfma_f32_16x16x32_bf16 v[56:59], v[44:47], a[60:63], v[56:59]
s_add_u32 m0, s46, 81408
v_mfma_f32_16x16x32_bf16 v[60:63], v[48:51], a[56:59], v[60:63]
ds_read_b128 v[40:43], v8 offset:22528
v_mfma_f32_16x16x32_bf16 v[64:67], v[48:51], a[60:63], v[64:67]
buffer_load_dwordx4 v6, s[8:11], s50 offen offset:512 lds
s_waitcnt lgkmcnt(4)
v_mfma_f32_16x16x32_bf16 v[52:55], v[20:23], a[64:67], v[52:55]
ds_read_b128 v[44:47], v9 offset:20480
v_mfma_f32_16x16x32_bf16 v[56:59], v[20:23], a[68:71], v[56:59]
s_add_u32 m0, s46, 85376
v_mfma_f32_16x16x32_bf16 v[60:63], v[24:27], a[64:67], v[60:63]
ds_read_b128 v[48:51], v9 offset:22528
v_mfma_f32_16x16x32_bf16 v[64:67], v[24:27], a[68:71], v[64:67]
buffer_load_dwordx4 v6, s[8:11], s50 offen offset:640 lds
s_waitcnt lgkmcnt(4)
v_mfma_f32_16x16x32_bf16 v[52:55], v[28:31], a[72:75], v[52:55]
ds_read_b128 v[20:23], v8 offset:24576
v_mfma_f32_16x16x32_bf16 v[56:59], v[28:31], a[76:79], v[56:59]
s_add_u32 m0, s46, 89344
v_mfma_f32_16x16x32_bf16 v[60:63], v[32:35], a[72:75], v[60:63]
ds_read_b128 v[24:27], v8 offset:26624
v_mfma_f32_16x16x32_bf16 v[64:67], v[32:35], a[76:79], v[64:67]
buffer_load_dwordx4 v6, s[8:11], s50 offen offset:768 lds
s_waitcnt lgkmcnt(4)
v_mfma_f32_16x16x32_bf16 v[52:55], v[36:39], a[80:83], v[52:55]
ds_read_b128 v[28:31], v9 offset:24576
v_mfma_f32_16x16x32_bf16 v[56:59], v[36:39], a[84:87], v[56:59]
s_add_u32 m0, s46, 93312
v_mfma_f32_16x16x32_bf16 v[60:63], v[40:43], a[80:83], v[60:63]
ds_read_b128 v[32:35], v9 offset:26624
v_mfma_f32_16x16x32_bf16 v[64:67], v[40:43], a[84:87], v[64:67]
buffer_load_dwordx4 v6, s[8:11], s50 offen offset:896 lds
s_waitcnt lgkmcnt(4)
v_mfma_f32_16x16x32_bf16 v[52:55], v[44:47], a[88:91], v[52:55]
ds_read_b128 v[36:39], v8 offset:28672
v_mfma_f32_16x16x32_bf16 v[56:59], v[44:47], a[92:95], v[56:59]
s_add_u32 m0, s46, 97280
v_mfma_f32_16x16x32_bf16 v[60:63], v[48:51], a[88:91], v[60:63]
ds_read_b128 v[40:43], v8 offset:30720
v_mfma_f32_16x16x32_bf16 v[64:67], v[48:51], a[92:95], v[64:67]
buffer_load_dwordx4 v6, s[8:11], s50 offen offset:1024 lds
s_waitcnt lgkmcnt(4)
v_mfma_f32_16x16x32_bf16 v[52:55], v[20:23], a[96:99], v[52:55]
ds_read_b128 v[44:47], v9 offset:28672
v_mfma_f32_16x16x32_bf16 v[56:59], v[20:23], a[100:103], v[56:59]
s_add_u32 m0, s46, 101248
v_mfma_f32_16x16x32_bf16 v[60:63], v[24:27], a[96:99], v[60:63]
ds_read_b128 v[48:51], v9 offset:30720
v_mfma_f32_16x16x32_bf16 v[64:67], v[24:27], a[100:103], v[64:67]
buffer_load_dwordx4 v6, s[8:11], s50 offen offset:1152 lds
s_waitcnt lgkmcnt(4)
v_mfma_f32_16x16x32_bf16 v[52:55], v[28:31], a[104:107], v[52:55]
ds_read_b128 v[20:23], v8 offset:32768
v_mfma_f32_16x16x32_bf16 v[56:59], v[28:31], a[108:111], v[56:59]
s_add_u32 m0, s46, 105216
v_mfma_f32_16x16x32_bf16 v[60:63], v[32:35], a[104:107], v[60:63]
ds_read_b128 v[24:27], v8 offset:34816
v_mfma_f32_16x16x32_bf16 v[64:67], v[32:35], a[108:111], v[64:67]
buffer_load_dwordx4 v6, s[8:11], s50 offen offset:1280 lds
s_waitcnt lgkmcnt(4)
v_mfma_f32_16x16x32_bf16 v[52:55], v[36:39], a[112:115], v[52:55]
ds_read_b128 v[28:31], v9 offset:32768
v_mfma_f32_16x16x32_bf16 v[56:59], v[36:39], a[116:119], v[56:59]
s_add_u32 m0, s46, 109184
v_mfma_f32_16x16x32_bf16 v[60:63], v[40:43], a[112:115], v[60:63]
ds_read_b128 v[32:35], v9 offset:34816
v_mfma_f32_16x16x32_bf16 v[64:67], v[40:43], a[116:119], v[64:67]
buffer_load_dwordx4 v6, s[8:11], s50 offen offset:1408 lds
s_waitcnt lgkmcnt(4)
v_mfma_f32_16x16x32_bf16 v[52:55], v[44:47], a[120:123], v[52:55]
ds_read_b128 v[36:39], v8 offset:36864
v_mfma_f32_16x16x32_bf16 v[56:59], v[44:47], a[124:127], v[56:59]
s_add_u32 m0, s46, 113152
v_mfma_f32_16x16x32_bf16 v[60:63], v[48:51], a[120:123], v[60:63]
ds_read_b128 v[40:43], v8 offset:38912
v_mfma_f32_16x16x32_bf16 v[64:67], v[48:51], a[124:127], v[64:67]
buffer_load_dwordx4 v6, s[8:11], s50 offen offset:1536 lds
s_waitcnt lgkmcnt(4)
v_mfma_f32_16x16x32_bf16 v[52:55], v[20:23], a[128:131], v[52:55]
ds_read_b128 v[44:47], v9 offset:36864
v_mfma_f32_16x16x32_bf16 v[56:59], v[20:23], a[132:135], v[56:59]
s_add_u32 m0, s46, 117120
v_mfma_f32_16x16x32_bf16 v[60:63], v[24:27], a[128:131], v[60:63]
ds_read_b128 v[48:51], v9 offset:38912
v_mfma_f32_16x16x32_bf16 v[64:67], v[24:27], a[132:135], v[64:67]
buffer_load_dwordx4 v6, s[8:11], s50 offen offset:1664 lds
s_waitcnt lgkmcnt(4)
v_mfma_f32_16x16x32_bf16 v[52:55], v[28:31], a[136:139], v[52:55]
ds_read_b128 v[20:23], v8 offset:40960
v_mfma_f32_16x16x32_bf16 v[56:59], v[28:31], a[140:143], v[56:59]
s_add_u32 m0, s46, 121088
v_mfma_f32_16x16x32_bf16 v[60:63], v[32:35], a[136:139], v[60:63]
ds_read_b128 v[24:27], v8 offset:43008
v_mfma_f32_16x16x32_bf16 v[64:67], v[32:35], a[140:143], v[64:67]
buffer_load_dwordx4 v6, s[8:11], s50 offen offset:1792 lds
s_waitcnt lgkmcnt(4)
v_mfma_f32_16x16x32_bf16 v[52:55], v[36:39], a[144:147], v[52:55]
ds_read_b128 v[28:31], v9 offset:40960
v_mfma_f32_16x16x32_bf16 v[56:59], v[36:39], a[148:151], v[56:59]
s_add_u32 m0, s46, 125056
v_mfma_f32_16x16x32_bf16 v[60:63], v[40:43], a[144:147], v[60:63]
ds_read_b128 v[32:35], v9 offset:43008
v_mfma_f32_16x16x32_bf16 v[64:67], v[40:43], a[148:151], v[64:67]
buffer_load_dwordx4 v6, s[8:11], s50 offen offset:1920 lds
s_waitcnt lgkmcnt(4)
v_mfma_f32_16x16x32_bf16 v[52:55], v[44:47], a[152:155], v[52:55]
ds_read_b128 v[36:39], v8 offset:45056
v_mfma_f32_16x16x32_bf16 v[56:59], v[44:47], a[156:159], v[56:59]
v_mfma_f32_16x16x32_bf16 v[60:63], v[48:51], a[152:155], v[60:63]
ds_read_b128 v[40:43], v8 offset:47104
v_mfma_f32_16x16x32_bf16 v[64:67], v[48:51], a[156:159], v[64:67]
s_waitcnt lgkmcnt(4)
v_mfma_f32_16x16x32_bf16 v[52:55], v[20:23], a[160:163], v[52:55]
ds_read_b128 v[44:47], v9 offset:45056
v_mfma_f32_16x16x32_bf16 v[56:59], v[20:23], a[164:167], v[56:59]
v_mfma_f32_16x16x32_bf16 v[60:63], v[24:27], a[160:163], v[60:63]
ds_read_b128 v[48:51], v9 offset:47104
v_mfma_f32_16x16x32_bf16 v[64:67], v[24:27], a[164:167], v[64:67]
s_waitcnt lgkmcnt(4)
v_mfma_f32_16x16x32_bf16 v[52:55], v[28:31], a[168:171], v[52:55]
ds_read_b128 v[20:23], v8 offset:49152
v_mfma_f32_16x16x32_bf16 v[56:59], v[28:31], a[172:175], v[56:59]
s_waitcnt vmcnt(16)
v_mov_b32 v17, s42
s_mov_b64 exec, 1
buffer_store_dword v17, v16, s[84:87], s49 offen sc1
s_mov_b64 exec, -1
v_mfma_f32_16x16x32_bf16 v[60:63], v[32:35], a[168:171], v[60:63]
ds_read_b128 v[24:27], v8 offset:51200
v_mfma_f32_16x16x32_bf16 v[64:67], v[32:35], a[172:175], v[64:67]
s_waitcnt lgkmcnt(4)
v_mfma_f32_16x16x32_bf16 v[52:55], v[36:39], a[176:179], v[52:55]
ds_read_b128 v[28:31], v9 offset:49152
v_mfma_f32_16x16x32_bf16 v[56:59], v[36:39], a[180:183], v[56:59]
s_add_u32 s53, s42, 3
s_min_u32 s53, s53, 63
s_lshl_b32 s53, s53, 16
s_mov_b64 exec, 0xffff
buffer_load_dword v250, v19, s[8:11], s53 offen
s_mov_b64 exec, -1
v_mfma_f32_16x16x32_bf16 v[60:63], v[40:43], a[176:179], v[60:63]
ds_read_b128 v[32:35], v9 offset:51200
v_mfma_f32_16x16x32_bf16 v[64:67], v[40:43], a[180:183], v[64:67]
s_waitcnt lgkmcnt(4)
v_mfma_f32_16x16x32_bf16 v[52:55], v[44:47], a[184:187], v[52:55]
ds_read_b128 v[36:39], v8 offset:53248
v_mfma_f32_16x16x32_bf16 v[56:59], v[44:47], a[188:191], v[56:59]
v_mfma_f32_16x16x32_bf16 v[60:63], v[48:51], a[184:187], v[60:63]
ds_read_b128 v[40:43], v8 offset:55296
v_mfma_f32_16x16x32_bf16 v[64:67], v[48:51], a[188:191], v[64:67]
s_waitcnt lgkmcnt(4)
v_mfma_f32_16x16x32_bf16 v[52:55], v[20:23], a[192:195], v[52:55]
ds_read_b128 v[44:47], v9 offset:53248
v_mfma_f32_16x16x32_bf16 v[56:59], v[20:23], a[196:199], v[56:59]
v_mfma_f32_16x16x32_bf16 v[60:63], v[24:27], a[192:195], v[60:63]
ds_read_b128 v[48:51], v9 offset:55296
v_mfma_f32_16x16x32_bf16 v[64:67], v[24:27], a[196:199], v[64:67]
s_waitcnt lgkmcnt(4)
v_mfma_f32_16x16x32_bf16 v[52:55], v[28:31], a[200:203], v[52:55]
ds_read_b128 v[20:23], v8 offset:57344
v_mfma_f32_16x16x32_bf16 v[56:59], v[28:31], a[204:207], v[56:59]
v_mfma_f32_16x16x32_bf16 v[60:63], v[32:35], a[200:203], v[60:63]
ds_read_b128 v[24:27], v8 offset:59392
v_mfma_f32_16x16x32_bf16 v[64:67], v[32:35], a[204:207], v[64:67]
s_waitcnt lgkmcnt(4)
v_mfma_f32_16x16x32_bf16 v[52:55], v[36:39], a[208:211], v[52:55]
ds_read_b128 v[28:31], v9 offset:57344
v_mfma_f32_16x16x32_bf16 v[56:59], v[36:39], a[212:215], v[56:59]
v_mfma_f32_16x16x32_bf16 v[60:63], v[40:43], a[208:211], v[60:63]
ds_read_b128 v[32:35], v9 offset:59392
v_mfma_f32_16x16x32_bf16 v[64:67], v[40:43], a[212:215], v[64:67]
s_waitcnt lgkmcnt(4)
v_mfma_f32_16x16x32_bf16 v[52:55], v[44:47], a[216:219], v[52:55]
ds_read_b128 v[36:39], v8 offset:61440
v_mfma_f32_16x16x32_bf16 v[56:59], v[44:47], a[220:223], v[56:59]
v_mfma_f32_16x16x32_bf16 v[60:63], v[48:51], a[216:219], v[60:63]
ds_read_b128 v[40:43], v8 offset:63488
v_mfma_f32_16x16x32_bf16 v[64:67], v[48:51], a[220:223], v[64:67]
s_waitcnt lgkmcnt(4)
v_mfma_f32_16x16x32_bf16 v[52:55], v[20:23], a[224:227], v[52:55]
ds_read_b128 v[44:47], v9 offset:61440
v_mfma_f32_16x16x32_bf16 v[56:59], v[20:23], a[228:231], v[56:59]
v_mfma_f32_16x16x32_bf16 v[60:63], v[24:27], a[224:227], v[60:63]
ds_read_b128 v[48:51], v9 offset:63488
v_mfma_f32_16x16x32_bf16 v[64:67], v[24:27], a[228:231], v[64:67]
s_waitcnt lgkmcnt(5)
v_mfma_f32_16x16x32_bf16 v[52:55], v[28:31], a[232:235], v[52:55]
v_mfma_f32_16x16x32_bf16 v[56:59], v[28:31], a[236:239], v[56:59]
s_waitcnt lgkmcnt(4)
v_mfma_f32_16x16x32_bf16 v[60:63], v[32:35], a[232:235], v[60:63]
v_mfma_f32_16x16x32_bf16 v[64:67], v[32:35], a[236:239], v[64:67]
s_waitcnt lgkmcnt(3)
v_mfma_f32_16x16x32_bf16 v[52:55], v[36:39], a[240:243], v[52:55]
v_mfma_f32_16x16x32_bf16 v[56:59], v[36:39], a[244:247], v[56:59]
s_waitcnt lgkmcnt(2)
v_mfma_f32_16x16x32_bf16 v[60:63], v[40:43], a[240:243], v[60:63]
v_mfma_f32_16x16x32_bf16 v[64:67], v[40:43], a[244:247], v[64:67]
s_waitcnt lgkmcnt(1)
v_mfma_f32_16x16x32_bf16 v[52:55], v[44:47], a[248:251], v[52:55]
v_mfma_f32_16x16x32_bf16 v[56:59], v[44:47], a[252:255], v[56:59]
s_waitcnt lgkmcnt(0)
v_mfma_f32_16x16x32_bf16 v[60:63], v[48:51], a[248:251], v[60:63]
v_mfma_f32_16x16x32_bf16 v[64:67], v[48:51], a[252:255], v[64:67]
s_add_u32 s42, s42, 1
s_branch mega_kernel_v_loop
mega_kernel_v_fin:
s_nop 11
v_cvt_pk_bf16_f32 v84, v68, v69
v_cvt_pk_bf16_f32 v85, v70, v71
v_cvt_pk_bf16_f32 v86, v76, v77
v_cvt_pk_bf16_f32 v87, v78, v79
v_cvt_pk_bf16_f32 v88, v72, v73
v_cvt_pk_bf16_f32 v89, v74, v75
v_cvt_pk_bf16_f32 v90, v80, v81
v_cvt_pk_bf16_f32 v91, v82, v83
s_add_u32 s51, s42, s47
s_sub_u32 s51, s51, 1
s_bfe_u32 s52, s51, 0x40002
s_lshl_b32 s52, s52, 14
s_and_b32 s51, s51, 3
s_lshl_b32 s51, s51, 11
s_add_u32 s51, s51, s52
s_add_u32 s51, s51, s48
buffer_store_dwordx4 v[84:87], v7, s[84:87], s51 offen sc1
buffer_store_dwordx4 v[88:91], v7, s[84:87], s51 offen offset:1024 sc1
s_waitcnt vmcnt(0)
v_mov_b32 v17, s42
s_mov_b64 exec, 1
buffer_store_dword v17, v16, s[84:87], s49 offen sc1
s_mov_b64 exec, -1
s_waitcnt vmcnt(0)
s_barrier
mega_kernel_fft:
s_mov_b32 s38, s92
s_mov_b32 s39, 64
s_mov_b32 s37, 129
mega_kernel_f2s:
v_mov_b32 v1, 0
s_mov_b32 s82, 69259264
mega_kernel_w0:
s_sleep 8
buffer_load_dword v2, v1, s[84:87], s82 offen sc1
s_waitcnt vmcnt(0)
v_cmp_ne_u32 vcc, 31, v2
s_cbranch_vccnz mega_kernel_w0
s_mov_b32 s48, 0x3f7ec46d
s_mov_b32 s49, 0x3dc8bd36
s_mov_b32 s50, 0x3f7b14be
s_mov_b32 s51, 0x3e47c5c2
s_mov_b32 s52, 0x3f74fa0b
s_mov_b32 s53, 0x3e94a031
s_mov_b32 s54, 0x3f6c835e
s_mov_b32 s55, 0x3ec3ef15
s_mov_b32 s56, 0x3f61c598
s_mov_b32 s57, 0x3ef15aea
s_mov_b32 s58, 0x3f54db31
s_mov_b32 s59, 0x3f0e39da
s_mov_b32 s60, 0x3f45e403
s_mov_b32 s61, 0x3f226799
s_mov_b32 s62, 0x3f3504f3
s_mov_b32 s63, 0x3f3504f3
v_lshrrev_b32 v10, 6, v0
v_and_b32 v1, 63, v0
v_readfirstlane_b32 s16, v10
v_cvt_f32_u32 v2, v1
v_lshlrev_b32 v5, 3, v1
s_mul_i32 s17, s16, 16896
v_add_u32 v3, s17, v5
v_and_b32 v7, 1, v1
v_lshrrev_b32 v6, 1, v1
v_cvt_f32_u32 v8, v6
v_cvt_f32_u32 v10, v7
v_mul_u32_u24 v4, 528, v6
v_lshl_add_u32 v4, v7, 3, v4
v_add_u32 v4, s17, v4
v_lshlrev_b32 v11, 12, v7
v_lshl_add_u32 v11, v6, 2, v11
v_fma_f32 v9, v10, 2.0, -1.0
v_sub_f32 v7, 0, v9
v_mul_f32 v13, v10, v8
v_mul_f32 v13, 0x3a000000, v13
s_mov_b32 s18, 0xaaaaaaaa
s_mov_b32 s19, 0xaaaaaaaa
v_mul_f32 v12, 0xba000000, v2
v_cos_f32 v82, v12
v_sin_f32 v83, v12
v_mul_f32 v12, 0xba800000, v2
v_cos_f32 v84, v12
v_sin_f32 v85, v12
v_mul_f32 v12, 0xbac00000, v2
v_cos_f32 v86, v12
v_sin_f32 v87, v12
v_mul_f32 v12, 0xbb000000, v2
v_cos_f32 v88, v12
v_sin_f32 v89, v12
v_mul_f32 v12, 0xbb200000, v2
v_cos_f32 v90, v12
v_sin_f32 v91, v12
v_mul_f32 v12, 0xbb400000, v2
v_cos_f32 v92, v12
v_sin_f32 v93, v12
v_mul_f32 v12, 0xbb600000, v2
v_cos_f32 v94, v12
v_sin_f32 v95, v12
v_mul_f32 v12, 0xbb800000, v2
v_cos_f32 v96, v12
v_sin_f32 v97, v12
v_mul_f32 v12, 0xbb900000, v2
v_cos_f32 v98, v12
v_sin_f32 v99, v12
v_mul_f32 v12, 0xbba00000, v2
v_cos_f32 v100, v12
v_sin_f32 v101, v12
v_mul_f32 v12, 0xbbb00000, v2
v_cos_f32 v102, v12
v_sin_f32 v103, v12
v_mul_f32 v12, 0xbbc00000, v2
v_cos_f32 v104, v12
v_sin_f32 v105, v12
v_mul_f32 v12, 0xbbd00000, v2
v_cos_f32 v106, v12
v_sin_f32 v107, v12
v_mul_f32 v12, 0xbbe00000, v2
v_cos_f32 v108, v12
v_sin_f32 v109, v12
v_mul_f32 v12, 0xbbf00000, v2
v_cos_f32 v110, v12
v_sin_f32 v111, v12
v_mul_f32 v12, 0xbc000000, v2
v_cos_f32 v112, v12
v_sin_f32 v113, v12
v_mul_f32 v12, 0xbc080000, v2
v_cos_f32 v114, v12
v_sin_f32 v115, v12
v_mul_f32 v12, 0xbc100000, v2
v_cos_f32 v116, v12
v_sin_f32 v117, v12
v_mul_f32 v12, 0xbc180000, v2
v_cos_f32 v118, v12
v_sin_f32 v119, v12
v_mul_f32 v12, 0xbc200000, v2
v_cos_f32 v120, v12
v_sin_f32 v121, v12
v_mul_f32 v12, 0xbc280000, v2
v_cos_f32 v122, v12
v_sin_f32 v123, v12
v_mul_f32 v12, 0xbc300000, v2
v_cos_f32 v124, v12
v_sin_f32 v125, v12
v_mul_f32 v12, 0xbc380000, v2
v_cos_f32 v126, v12
v_sin_f32 v127, v12
v_mul_f32 v12, 0xbc400000, v2
v_cos_f32 v128, v12
v_sin_f32 v129, v12
v_mul_f32 v12, 0xbc480000, v2
v_cos_f32 v130, v12
v_sin_f32 v131, v12
v_mul_f32 v12, 0xbc500000, v2
v_cos_f32 v132, v12
v_sin_f32 v133, v12
v_mul_f32 v12, 0xbc580000, v2
v_cos_f32 v134, v12
v_sin_f32 v135, v12
v_mul_f32 v12, 0xbc600000, v2
v_cos_f32 v136, v12
v_sin_f32 v137, v12
v_mul_f32 v12, 0xbc680000, v2
v_cos_f32 v138, v12
v_sin_f32 v139, v12
v_mul_f32 v12, 0xbc700000, v2
v_cos_f32 v140, v12
v_sin_f32 v141, v12
v_mul_f32 v12, 0xbc780000, v2
v_cos_f32 v142, v12
v_sin_f32 v143, v12
v_mov_b32 v12, v13
v_fmac_f32 v12, 0x00000000, v8
v_cos_f32 v144, v12
v_sin_f32 v145, v12
v_mov_b32 v12, v13
v_fmac_f32 v12, 0x3a800000, v8
v_cos_f32 v146, v12
v_sin_f32 v147, v12
v_mov_b32 v12, v13
v_fmac_f32 v12, 0x3b000000, v8
v_cos_f32 v148, v12
v_sin_f32 v149, v12
v_mov_b32 v12, v13
v_fmac_f32 v12, 0x3b400000, v8
v_cos_f32 v150, v12
v_sin_f32 v151, v12
v_mov_b32 v12, v13
v_fmac_f32 v12, 0x3b800000, v8
v_cos_f32 v152, v12
v_sin_f32 v153, v12
v_mov_b32 v12, v13
v_fmac_f32 v12, 0x3ba00000, v8
v_cos_f32 v154, v12
v_sin_f32 v155, v12
v_mov_b32 v12, v13
v_fmac_f32 v12, 0x3bc00000, v8
v_cos_f32 v156, v12
v_sin_f32 v157, v12
v_mov_b32 v12, v13
v_fmac_f32 v12, 0x3be00000, v8
v_cos_f32 v158, v12
v_sin_f32 v159, v12
v_mov_b32 v12, v13
v_fmac_f32 v12, 0x3c000000, v8
v_cos_f32 v160, v12
v_sin_f32 v161, v12
v_mov_b32 v12, v13
v_fmac_f32 v12, 0x3c100000, v8
v_cos_f32 v162, v12
v_sin_f32 v163, v12
v_mov_b32 v12, v13
v_fmac_f32 v12, 0x3c200000, v8
v_cos_f32 v164, v12
v_sin_f32 v165, v12
v_mov_b32 v12, v13
v_fmac_f32 v12, 0x3c300000, v8
v_cos_f32 v166, v12
v_sin_f32 v167, v12
v_mov_b32 v12, v13
v_fmac_f32 v12, 0x3c400000, v8
v_cos_f32 v168, v12
v_sin_f32 v169, v12
v_mov_b32 v12, v13
v_fmac_f32 v12, 0x3c500000, v8
v_cos_f32 v170, v12
v_sin_f32 v171, v12
v_mov_b32 v12, v13
v_fmac_f32 v12, 0x3c600000, v8
v_cos_f32 v172, v12
v_sin_f32 v173, v12
v_mov_b32 v12, v13
v_fmac_f32 v12, 0x3c700000, v8
v_cos_f32 v174, v12
v_sin_f32 v175, v12
v_mov_b32 v12, v13
v_fmac_f32 v12, 0x3c800000, v8
v_cos_f32 v176, v12
v_sin_f32 v177, v12
v_mov_b32 v12, v13
v_fmac_f32 v12, 0x3c880000, v8
v_cos_f32 v178, v12
v_sin_f32 v179, v12
v_mov_b32 v12, v13
v_fmac_f32 v12, 0x3c900000, v8
v_cos_f32 v180, v12
v_sin_f32 v181, v12
v_mov_b32 v12, v13
v_fmac_f32 v12, 0x3c980000, v8
v_cos_f32 v182, v12
v_sin_f32 v183, v12
v_mov_b32 v12, v13
v_fmac_f32 v12, 0x3ca00000, v8
v_cos_f32 v184, v12
v_sin_f32 v185, v12
v_mov_b32 v12, v13
v_fmac_f32 v12, 0x3ca80000, v8
v_cos_f32 v186, v12
v_sin_f32 v187, v12
v_mov_b32 v12, v13
v_fmac_f32 v12, 0x3cb00000, v8
v_cos_f32 v188, v12
v_sin_f32 v189, v12
v_mov_b32 v12, v13
v_fmac_f32 v12, 0x3cb80000, v8
v_cos_f32 v190, v12
v_sin_f32 v191, v12
v_mov_b32 v12, v13
v_fmac_f32 v12, 0x3cc00000, v8
v_cos_f32 v192, v12
v_sin_f32 v193, v12
v_mov_b32 v12, v13
v_fmac_f32 v12, 0x3cc80000, v8
v_cos_f32 v194, v12
v_sin_f32 v195, v12
v_mov_b32 v12, v13
v_fmac_f32 v12, 0x3cd00000, v8
v_cos_f32 v196, v12
v_sin_f32 v197, v12
v_mov_b32 v12, v13
v_fmac_f32 v12, 0x3cd80000, v8
v_cos_f32 v198, v12
v_sin_f32 v199, v12
v_mov_b32 v12, v13
v_fmac_f32 v12, 0x3ce00000, v8
v_cos_f32 v200, v12
v_sin_f32 v201, v12
v_mov_b32 v12, v13
v_fmac_f32 v12, 0x3ce80000, v8
v_cos_f32 v202, v12
v_sin_f32 v203, v12
v_mov_b32 v12, v13
v_fmac_f32 v12, 0x3cf00000, v8
v_cos_f32 v204, v12
v_sin_f32 v205, v12
v_mov_b32 v12, v13
v_fmac_f32 v12, 0x3cf80000, v8
v_cos_f32 v206, v12
v_sin_f32 v207, v12
s_nop 0
v_mul_f32 v144, 0x34800000, v144
v_mul_f32 v145, 0x34800000, v145
v_mul_f32 v146, 0x34800000, v146
v_mul_f32 v147, 0x34800000, v147
v_mul_f32 v148, 0x34800000, v148
v_mul_f32 v149, 0x34800000, v149
v_mul_f32 v150, 0x34800000, v150
v_mul_f32 v151, 0x34800000, v151
v_mul_f32 v152, 0x34800000, v152
v_mul_f32 v153, 0x34800000, v153
v_mul_f32 v154, 0x34800000, v154
v_mul_f32 v155, 0x34800000, v155
v_mul_f32 v156, 0x34800000, v156
v_mul_f32 v157, 0x34800000, v157
v_mul_f32 v158, 0x34800000, v158
v_mul_f32 v159, 0x34800000, v159
v_mul_f32 v160, 0x34800000, v160
v_mul_f32 v161, 0x34800000, v161
v_mul_f32 v162, 0x34800000, v162
v_mul_f32 v163, 0x34800000, v163
v_mul_f32 v164, 0x34800000, v164
v_mul_f32 v165, 0x34800000, v165
v_mul_f32 v166, 0x34800000, v166
v_mul_f32 v167, 0x34800000, v167
v_mul_f32 v168, 0x34800000, v168
v_mul_f32 v169, 0x34800000, v169
v_mul_f32 v170, 0x34800000, v170
v_mul_f32 v171, 0x34800000, v171
v_mul_f32 v172, 0x34800000, v172
v_mul_f32 v173, 0x34800000, v173
v_mul_f32 v174, 0x34800000, v174
v_mul_f32 v175, 0x34800000, v175
v_mul_f32 v176, 0x34800000, v176
v_mul_f32 v177, 0x34800000, v177
v_mul_f32 v178, 0x34800000, v178
v_mul_f32 v179, 0x34800000, v179
v_mul_f32 v180, 0x34800000, v180
v_mul_f32 v181, 0x34800000, v181
v_mul_f32 v182, 0x34800000, v182
v_mul_f32 v183, 0x34800000, v183
v_mul_f32 v184, 0x34800000, v184
v_mul_f32 v185, 0x34800000, v185
v_mul_f32 v186, 0x34800000, v186
v_mul_f32 v187, 0x34800000, v187
v_mul_f32 v188, 0x34800000, v188
v_mul_f32 v189, 0x34800000, v189
v_mul_f32 v190, 0x34800000, v190
v_mul_f32 v191, 0x34800000, v191
v_mul_f32 v192, 0x34800000, v192
v_mul_f32 v193, 0x34800000, v193
v_mul_f32 v194, 0x34800000, v194
v_mul_f32 v195, 0x34800000, v195
v_mul_f32 v196, 0x34800000, v196
v_mul_f32 v197, 0x34800000, v197
v_mul_f32 v198, 0x34800000, v198
v_mul_f32 v199, 0x34800000, v199
v_mul_f32 v200, 0x34800000, v200
v_mul_f32 v201, 0x34800000, v201
v_mul_f32 v202, 0x34800000, v202
v_mul_f32 v203, 0x34800000, v203
v_mul_f32 v204, 0x34800000, v204
v_mul_f32 v205, 0x34800000, v205
v_mul_f32 v206, 0x34800000, v206
v_mul_f32 v207, 0x34800000, v207
s_cmp_lt_u32 s38, s37
s_cbranch_scc0 mega_kernel_f2_e
s_lshl_b32 s12, s38, 2
s_add_u32 s12, s12, s16
s_min_u32 s12, s12, 512
s_lshr_b32 s23, s12, 7
s_xnor_b32 s23, s23, s98
s_and_b32 s23, s23, 1
s_lshl_b32 s23, s23, 13
s_mul_i32 s13, s12, 16384
s_add_u32 s13, s13, 171966464
s_add_u32 s13, s13, s23
s_lshr_b32 s23, s12, 6
s_xnor_b32 s23, s23, s98
s_and_b32 s23, s23, 1
s_lshl_b32 s23, s23, 13
s_mul_i32 s12, s12, 32768
s_add_u32 s12, s12, 92274688
s_add_u32 s12, s12, s23
buffer_load_dwordx2 a[0:1], v5, s[84:87], s12 offen offset:0 sc1
buffer_load_dwordx2 a[2:3], v5, s[84:87], s12 offen offset:512 sc1
buffer_load_dwordx2 a[4:5], v5, s[84:87], s12 offen offset:1024 sc1
buffer_load_dwordx2 a[6:7], v5, s[84:87], s12 offen offset:1536 sc1
buffer_load_dwordx2 a[8:9], v5, s[84:87], s12 offen offset:2048 sc1
buffer_load_dwordx2 a[10:11], v5, s[84:87], s12 offen offset:2560 sc1
buffer_load_dwordx2 a[12:13], v5, s[84:87], s12 offen offset:3072 sc1
buffer_load_dwordx2 a[14:15], v5, s[84:87], s12 offen offset:3584 sc1
s_add_u32 s12, s12, 4096
buffer_load_dwordx2 a[16:17], v5, s[84:87], s12 offen offset:0 sc1
buffer_load_dwordx2 a[18:19], v5, s[84:87], s12 offen offset:512 sc1
buffer_load_dwordx2 a[20:21], v5, s[84:87], s12 offen offset:1024 sc1
buffer_load_dwordx2 a[22:23], v5, s[84:87], s12 offen offset:1536 sc1
buffer_load_dwordx2 a[24:25], v5, s[84:87], s12 offen offset:2048 sc1
buffer_load_dwordx2 a[26:27], v5, s[84:87], s12 offen offset:2560 sc1
buffer_load_dwordx2 a[28:29], v5, s[84:87], s12 offen offset:3072 sc1
buffer_load_dwordx2 a[30:31], v5, s[84:87], s12 offen offset:3584 sc1
s_add_u32 s12, s12, 12288
buffer_load_dwordx2 a[32:33], v5, s[84:87], s12 offen offset:0 sc1
buffer_load_dwordx2 a[34:35], v5, s[84:87], s12 offen offset:512 sc1
buffer_load_dwordx2 a[36:37], v5, s[84:87], s12 offen offset:1024 sc1
buffer_load_dwordx2 a[38:39], v5, s[84:87], s12 offen offset:1536 sc1
buffer_load_dwordx2 a[40:41], v5, s[84:87], s12 offen offset:2048 sc1
buffer_load_dwordx2 a[42:43], v5, s[84:87], s12 offen offset:2560 sc1
buffer_load_dwordx2 a[44:45], v5, s[84:87], s12 offen offset:3072 sc1
buffer_load_dwordx2 a[46:47], v5, s[84:87], s12 offen offset:3584 sc1
s_add_u32 s12, s12, 4096
buffer_load_dwordx2 a[48:49], v5, s[84:87], s12 offen offset:0 sc1
buffer_load_dwordx2 a[50:51], v5, s[84:87], s12 offen offset:512 sc1
buffer_load_dwordx2 a[52:53], v5, s[84:87], s12 offen offset:1024 sc1
buffer_load_dwordx2 a[54:55], v5, s[84:87], s12 offen offset:1536 sc1
buffer_load_dwordx2 a[56:57], v5, s[84:87], s12 offen offset:2048 sc1
buffer_load_dwordx2 a[58:59], v5, s[84:87], s12 offen offset:2560 sc1
buffer_load_dwordx2 a[60:61], v5, s[84:87], s12 offen offset:3072 sc1
buffer_load_dwordx2 a[62:63], v5, s[84:87], s12 offen offset:3584 sc1
s_add_u32 s12, s12, 4096
buffer_load_dword a64, v11, s[84:87], s13 offen offset:0 sc1
buffer_load_dword a65, v11, s[84:87], s13 offen offset:128 sc1
buffer_load_dword a66, v11, s[84:87], s13 offen offset:256 sc1
buffer_load_dword a67, v11, s[84:87], s13 offen offset:384 sc1
buffer_load_dword a68, v11, s[84:87], s13 offen offset:512 sc1
buffer_load_dword a69, v11, s[84:87], s13 offen offset:640 sc1
buffer_load_dword a70, v11, s[84:87], s13 offen offset:768 sc1
buffer_load_dword a71, v11, s[84:87], s13 offen offset:896 sc1
buffer_load_dword a72, v11, s[84:87], s13 offen offset:1024 sc1
buffer_load_dword a73, v11, s[84:87], s13 offen offset:1152 sc1
buffer_load_dword a74, v11, s[84:87], s13 offen offset:1280 sc1
buffer_load_dword a75, v11, s[84:87], s13 offen offset:1408 sc1
buffer_load_dword a76, v11, s[84:87], s13 offen offset:1536 sc1
buffer_load_dword a77, v11, s[84:87], s13 offen offset:1664 sc1
buffer_load_dword a78, v11, s[84:87], s13 offen offset:1792 sc1
buffer_load_dword a79, v11, s[84:87], s13 offen offset:1920 sc1
buffer_load_dword a80, v11, s[84:87], s13 offen offset:2048 sc1
buffer_load_dword a81, v11, s[84:87], s13 offen offset:2176 sc1
buffer_load_dword a82, v11, s[84:87], s13 offen offset:2304 sc1
buffer_load_dword a83, v11, s[84:87], s13 offen offset:2432 sc1
buffer_load_dword a84, v11, s[84:87], s13 offen offset:2560 sc1
buffer_load_dword a85, v11, s[84:87], s13 offen offset:2688 sc1
buffer_load_dword a86, v11, s[84:87], s13 offen offset:2816 sc1
buffer_load_dword a87, v11, s[84:87], s13 offen offset:2944 sc1
buffer_load_dword a88, v11, s[84:87], s13 offen offset:3072 sc1
buffer_load_dword a89, v11, s[84:87], s13 offen offset:3200 sc1
buffer_load_dword a90, v11, s[84:87], s13 offen offset:3328 sc1
buffer_load_dword a91, v11, s[84:87], s13 offen offset:3456 sc1
buffer_load_dword a92, v11, s[84:87], s13 offen offset:3584 sc1
buffer_load_dword a93, v11, s[84:87], s13 offen offset:3712 sc1
buffer_load_dword a94, v11, s[84:87], s13 offen offset:3840 sc1
buffer_load_dword a95, v11, s[84:87], s13 offen offset:3968 sc1
s_waitcnt vmcnt(0)
mega_kernel_f2_l:
s_add_u32 s21, s38, s39
s_cmp_lt_u32 s21, s37
s_cselect_b32 s22, s21, s38
s_waitcnt vmcnt(32)
v_accvgpr_read_b32 v16, a0
v_accvgpr_read_b32 v17, a1
v_accvgpr_read_b32 v18, a2
v_accvgpr_read_b32 v19, a3
v_accvgpr_read_b32 v20, a4
v_accvgpr_read_b32 v21, a5
v_accvgpr_read_b32 v22, a6
v_accvgpr_read_b32 v23, a7
v_accvgpr_read_b32 v24, a8
v_accvgpr_read_b32 v25, a9
v_accvgpr_read_b32 v26, a10
v_accvgpr_read_b32 v27, a11
v_accvgpr_read_b32 v28, a12
v_accvgpr_read_b32 v29, a13
v_accvgpr_read_b32 v30, a14
v_accvgpr_read_b32 v31, a15
v_accvgpr_read_b32 v32, a16
v_accvgpr_read_b32 v33, a17
v_accvgpr_read_b32 v34, a18
v_accvgpr_read_b32 v35, a19
v_accvgpr_read_b32 v36, a20
v_accvgpr_read_b32 v37, a21
v_accvgpr_read_b32 v38, a22
v_accvgpr_read_b32 v39, a23
v_accvgpr_read_b32 v40, a24
v_accvgpr_read_b32 v41, a25
v_accvgpr_read_b32 v42, a26
v_accvgpr_read_b32 v43, a27
v_accvgpr_read_b32 v44, a28
v_accvgpr_read_b32 v45, a29
v_accvgpr_read_b32 v46, a30
v_accvgpr_read_b32 v47, a31
v_accvgpr_read_b32 v48, a32
v_accvgpr_read_b32 v49, a33
v_accvgpr_read_b32 v50, a34
v_accvgpr_read_b32 v51, a35
v_accvgpr_read_b32 v52, a36
v_accvgpr_read_b32 v53, a37
v_accvgpr_read_b32 v54, a38
v_accvgpr_read_b32 v55, a39
v_accvgpr_read_b32 v56, a40
v_accvgpr_read_b32 v57, a41
v_accvgpr_read_b32 v58, a42
v_accvgpr_read_b32 v59, a43
v_accvgpr_read_b32 v60, a44
v_accvgpr_read_b32 v61, a45
v_accvgpr_read_b32 v62, a46
v_accvgpr_read_b32 v63, a47
v_accvgpr_read_b32 v64, a48
v_accvgpr_read_b32 v65, a49
v_accvgpr_read_b32 v66, a50
v_accvgpr_read_b32 v67, a51
v_accvgpr_read_b32 v68, a52
v_accvgpr_read_b32 v69, a53
v_accvgpr_read_b32 v70, a54
v_accvgpr_read_b32 v71, a55
v_accvgpr_read_b32 v72, a56
v_accvgpr_read_b32 v73, a57
v_accvgpr_read_b32 v74, a58
v_accvgpr_read_b32 v75, a59
v_accvgpr_read_b32 v76, a60
v_accvgpr_read_b32 v77, a61
v_accvgpr_read_b32 v78, a62
v_accvgpr_read_b32 v79, a63
v_accvgpr_read_b32 v208, a64
v_accvgpr_read_b32 v209, a65
v_accvgpr_read_b32 v210, a66
v_accvgpr_read_b32 v211, a67
v_accvgpr_read_b32 v212, a68
v_accvgpr_read_b32 v213, a69
v_accvgpr_read_b32 v214, a70
v_accvgpr_read_b32 v215, a71
v_accvgpr_read_b32 v216, a72
v_accvgpr_read_b32 v217, a73
v_accvgpr_read_b32 v218, a74
v_accvgpr_read_b32 v219, a75
v_accvgpr_read_b32 v220, a76
v_accvgpr_read_b32 v221, a77
v_accvgpr_read_b32 v222, a78
v_accvgpr_read_b32 v223, a79
v_accvgpr_read_b32 v224, a80
v_accvgpr_read_b32 v225, a81
v_accvgpr_read_b32 v226, a82
v_accvgpr_read_b32 v227, a83
v_accvgpr_read_b32 v228, a84
v_accvgpr_read_b32 v229, a85
v_accvgpr_read_b32 v230, a86
v_accvgpr_read_b32 v231, a87
v_accvgpr_read_b32 v232, a88
v_accvgpr_read_b32 v233, a89
v_accvgpr_read_b32 v234, a90
v_accvgpr_read_b32 v235, a91
v_accvgpr_read_b32 v236, a92
v_accvgpr_read_b32 v237, a93
v_accvgpr_read_b32 v238, a94
v_accvgpr_read_b32 v239, a95
s_lshl_b32 s12, s22, 2
s_add_u32 s12, s12, s16
s_min_u32 s12, s12, 512
s_lshr_b32 s23, s12, 7
s_xnor_b32 s23, s23, s98
s_and_b32 s23, s23, 1
s_lshl_b32 s23, s23, 13
s_mul_i32 s13, s12, 16384
s_add_u32 s13, s13, 171966464
s_add_u32 s13, s13, s23
s_lshr_b32 s23, s12, 6
s_xnor_b32 s23, s23, s98
s_and_b32 s23, s23, 1
s_lshl_b32 s23, s23, 13
s_mul_i32 s12, s12, 32768
s_add_u32 s12, s12, 92274688
s_add_u32 s12, s12, s23
buffer_load_dwordx2 a[0:1], v5, s[84:87], s12 offen offset:0 sc1
buffer_load_dwordx2 a[2:3], v5, s[84:87], s12 offen offset:512 sc1
buffer_load_dwordx2 a[4:5], v5, s[84:87], s12 offen offset:1024 sc1
buffer_load_dwordx2 a[6:7], v5, s[84:87], s12 offen offset:1536 sc1
buffer_load_dwordx2 a[8:9], v5, s[84:87], s12 offen offset:2048 sc1
buffer_load_dwordx2 a[10:11], v5, s[84:87], s12 offen offset:2560 sc1
buffer_load_dwordx2 a[12:13], v5, s[84:87], s12 offen offset:3072 sc1
buffer_load_dwordx2 a[14:15], v5, s[84:87], s12 offen offset:3584 sc1
s_add_u32 s12, s12, 4096
buffer_load_dwordx2 a[16:17], v5, s[84:87], s12 offen offset:0 sc1
buffer_load_dwordx2 a[18:19], v5, s[84:87], s12 offen offset:512 sc1
buffer_load_dwordx2 a[20:21], v5, s[84:87], s12 offen offset:1024 sc1
buffer_load_dwordx2 a[22:23], v5, s[84:87], s12 offen offset:1536 sc1
buffer_load_dwordx2 a[24:25], v5, s[84:87], s12 offen offset:2048 sc1
buffer_load_dwordx2 a[26:27], v5, s[84:87], s12 offen offset:2560 sc1
buffer_load_dwordx2 a[28:29], v5, s[84:87], s12 offen offset:3072 sc1
buffer_load_dwordx2 a[30:31], v5, s[84:87], s12 offen offset:3584 sc1
s_add_u32 s12, s12, 12288
buffer_load_dwordx2 a[32:33], v5, s[84:87], s12 offen offset:0 sc1
buffer_load_dwordx2 a[34:35], v5, s[84:87], s12 offen offset:512 sc1
buffer_load_dwordx2 a[36:37], v5, s[84:87], s12 offen offset:1024 sc1
buffer_load_dwordx2 a[38:39], v5, s[84:87], s12 offen offset:1536 sc1
buffer_load_dwordx2 a[40:41], v5, s[84:87], s12 offen offset:2048 sc1
buffer_load_dwordx2 a[42:43], v5, s[84:87], s12 offen offset:2560 sc1
buffer_load_dwordx2 a[44:45], v5, s[84:87], s12 offen offset:3072 sc1
buffer_load_dwordx2 a[46:47], v5, s[84:87], s12 offen offset:3584 sc1
s_add_u32 s12, s12, 4096
buffer_load_dwordx2 a[48:49], v5, s[84:87], s12 offen offset:0 sc1
buffer_load_dwordx2 a[50:51], v5, s[84:87], s12 offen offset:512 sc1
buffer_load_dwordx2 a[52:53], v5, s[84:87], s12 offen offset:1024 sc1
buffer_load_dwordx2 a[54:55], v5, s[84:87], s12 offen offset:1536 sc1
buffer_load_dwordx2 a[56:57], v5, s[84:87], s12 offen offset:2048 sc1
buffer_load_dwordx2 a[58:59], v5, s[84:87], s12 offen offset:2560 sc1
buffer_load_dwordx2 a[60:61], v5, s[84:87], s12 offen offset:3072 sc1
buffer_load_dwordx2 a[62:63], v5, s[84:87], s12 offen offset:3584 sc1
s_add_u32 s12, s12, 4096
buffer_load_dword a64, v11, s[84:87], s13 offen offset:0 sc1
buffer_load_dword a65, v11, s[84:87], s13 offen offset:128 sc1
buffer_load_dword a66, v11, s[84:87], s13 offen offset:256 sc1
buffer_load_dword a67, v11, s[84:87], s13 offen offset:384 sc1
buffer_load_dword a68, v11, s[84:87], s13 offen offset:512 sc1
buffer_load_dword a69, v11, s[84:87], s13 offen offset:640 sc1
buffer_load_dword a70, v11, s[84:87], s13 offen offset:768 sc1
buffer_load_dword a71, v11, s[84:87], s13 offen offset:896 sc1
buffer_load_dword a72, v11, s[84:87], s13 offen offset:1024 sc1
buffer_load_dword a73, v11, s[84:87], s13 offen offset:1152 sc1
buffer_load_dword a74, v11, s[84:87], s13 offen offset:1280 sc1
buffer_load_dword a75, v11, s[84:87], s13 offen offset:1408 sc1
buffer_load_dword a76, v11, s[84:87], s13 offen offset:1536 sc1
buffer_load_dword a77, v11, s[84:87], s13 offen offset:1664 sc1
buffer_load_dword a78, v11, s[84:87], s13 offen offset:1792 sc1
buffer_load_dword a79, v11, s[84:87], s13 offen offset:1920 sc1
buffer_load_dword a80, v11, s[84:87], s13 offen offset:2048 sc1
buffer_load_dword a81, v11, s[84:87], s13 offen offset:2176 sc1
buffer_load_dword a82, v11, s[84:87], s13 offen offset:2304 sc1
buffer_load_dword a83, v11, s[84:87], s13 offen offset:2432 sc1
buffer_load_dword a84, v11, s[84:87], s13 offen offset:2560 sc1
buffer_load_dword a85, v11, s[84:87], s13 offen offset:2688 sc1
buffer_load_dword a86, v11, s[84:87], s13 offen offset:2816 sc1
buffer_load_dword a87, v11, s[84:87], s13 offen offset:2944 sc1
buffer_load_dword a88, v11, s[84:87], s13 offen offset:3072 sc1
buffer_load_dword a89, v11, s[84:87], s13 offen offset:3200 sc1
buffer_load_dword a90, v11, s[84:87], s13 offen offset:3328 sc1
buffer_load_dword a91, v11, s[84:87], s13 offen offset:3456 sc1
buffer_load_dword a92, v11, s[84:87], s13 offen offset:3584 sc1
buffer_load_dword a93, v11, s[84:87], s13 offen offset:3712 sc1
buffer_load_dword a94, v11, s[84:87], s13 offen offset:3840 sc1
buffer_load_dword a95, v11, s[84:87], s13 offen offset:3968 sc1
v_pk_add_f32 v[14:15], v[16:17], v[48:49] neg_lo:[0,1] neg_hi:[0,1]
v_pk_add_f32 v[16:17], v[16:17], v[48:49]
v_pk_add_f32 v[48:49], v[18:19], v[50:51] neg_lo:[0,1] neg_hi:[0,1]
v_pk_add_f32 v[18:19], v[18:19], v[50:51]
v_pk_mul_f32 v[50:51], v[48:49], s[50:51] op_sel:[0,0] op_sel_hi:[0,1] neg_lo:[0,0] neg_hi:[0,1]
v_pk_fma_f32 v[50:51], v[48:49], s[50:51], v[50:51] op_sel:[1,1,0] op_sel_hi:[1,0,1] neg_lo:[0,0,0] neg_hi:[0,0,0]
v_pk_add_f32 v[48:49], v[20:21], v[52:53] neg_lo:[0,1] neg_hi:[0,1]
v_pk_add_f32 v[20:21], v[20:21], v[52:53]
v_pk_mul_f32 v[52:53], v[48:49], s[54:55] op_sel:[0,0] op_sel_hi:[0,1] neg_lo:[0,0] neg_hi:[0,1]
v_pk_fma_f32 v[52:53], v[48:49], s[54:55], v[52:53] op_sel:[1,1,0] op_sel_hi:[1,0,1] neg_lo:[0,0,0] neg_hi:[0,0,0]
v_pk_add_f32 v[48:49], v[22:23], v[54:55] neg_lo:[0,1] neg_hi:[0,1]
v_pk_add_f32 v[22:23], v[22:23], v[54:55]
v_pk_mul_f32 v[54:55], v[48:49], s[58:59] op_sel:[0,0] op_sel_hi:[0,1] neg_lo:[0,0] neg_hi:[0,1]
v_pk_fma_f32 v[54:55], v[48:49], s[58:59], v[54:55] op_sel:[1,1,0] op_sel_hi:[1,0,1] neg_lo:[0,0,0] neg_hi:[0,0,0]
v_pk_add_f32 v[48:49], v[24:25], v[56:57] neg_lo:[0,1] neg_hi:[0,1]
v_pk_add_f32 v[24:25], v[24:25], v[56:57]
v_pk_mul_f32 v[56:57], v[48:49], s[62:63] op_sel:[0,0] op_sel_hi:[0,1] neg_lo:[0,0] neg_hi:[0,1]
v_pk_fma_f32 v[56:57], v[48:49], s[62:63], v[56:57] op_sel:[1,1,0] op_sel_hi:[1,0,1] neg_lo:[0,0,0] neg_hi:[0,0,0]
v_pk_add_f32 v[48:49], v[26:27], v[58:59] neg_lo:[0,1] neg_hi:[0,1]
v_pk_add_f32 v[26:27], v[26:27], v[58:59]
v_pk_mul_f32 v[58:59], v[48:49], s[58:59] op_sel:[0,1] op_sel_hi:[0,0] neg_lo:[0,0] neg_hi:[0,1]
v_pk_fma_f32 v[58:59], v[48:49], s[58:59], v[58:59] op_sel:[1,0,0] op_sel_hi:[1,1,1] neg_lo:[0,0,0] neg_hi:[0,0,0]
v_pk_add_f32 v[48:49], v[28:29], v[60:61] neg_lo:[0,1] neg_hi:[0,1]
v_pk_add_f32 v[28:29], v[28:29], v[60:61]
v_pk_mul_f32 v[60:61], v[48:49], s[54:55] op_sel:[0,1] op_sel_hi:[0,0] neg_lo:[0,0] neg_hi:[0,1]
v_pk_fma_f32 v[60:61], v[48:49], s[54:55], v[60:61] op_sel:[1,0,0] op_sel_hi:[1,1,1] neg_lo:[0,0,0] neg_hi:[0,0,0]
v_pk_add_f32 v[48:49], v[30:31], v[62:63] neg_lo:[0,1] neg_hi:[0,1]
v_pk_add_f32 v[30:31], v[30:31], v[62:63]
v_pk_mul_f32 v[62:63], v[48:49], s[50:51] op_sel:[0,1] op_sel_hi:[0,0] neg_lo:[0,0] neg_hi:[0,1]
v_pk_fma_f32 v[62:63], v[48:49], s[50:51], v[62:63] op_sel:[1,0,0] op_sel_hi:[1,1,1] neg_lo:[0,0,0] neg_hi:[0,0,0]
v_pk_add_f32 v[48:49], v[32:33], v[64:65] op_sel:[1,1] op_sel_hi:[0,0] neg_lo:[0,1] neg_hi:[1,0]
v_pk_add_f32 v[32:33], v[32:33], v[64:65]
v_pk_add_f32 v[64:65], v[34:35], v[66:67] neg_lo:[0,1] neg_hi:[0,1]
v_pk_add_f32 v[34:35], v[34:35], v[66:67]
v_pk_mul_f32 v[66:67], v[64:65], s[50:51] op_sel:[0,1] op_sel_hi:[0,0] neg_lo:[0,1] neg_hi:[0,1]
v_pk_fma_f32 v[66:67], v[64:65], s[50:51], v[66:67] op_sel:[1,0,0] op_sel_hi:[1,1,1] neg_lo:[0,0,0] neg_hi:[0,1,0]
v_pk_add_f32 v[64:65], v[36:37], v[68:69] neg_lo:[0,1] neg_hi:[0,1]
v_pk_add_f32 v[36:37], v[36:37], v[68:69]
v_pk_mul_f32 v[68:69], v[64:65], s[54:55] op_sel:[0,1] op_sel_hi:[0,0] neg_lo:[0,1] neg_hi:[0,1]
v_pk_fma_f32 v[68:69], v[64:65], s[54:55], v[68:69] op_sel:[1,0,0] op_sel_hi:[1,1,1] neg_lo:[0,0,0] neg_hi:[0,1,0]
v_pk_add_f32 v[64:65], v[38:39], v[70:71] neg_lo:[0,1] neg_hi:[0,1]
v_pk_add_f32 v[38:39], v[38:39], v[70:71]
v_pk_mul_f32 v[70:71], v[64:65], s[58:59] op_sel:[0,1] op_sel_hi:[0,0] neg_lo:[0,1] neg_hi:[0,1]
v_pk_fma_f32 v[70:71], v[64:65], s[58:59], v[70:71] op_sel:[1,0,0] op_sel_hi:[1,1,1] neg_lo:[0,0,0] neg_hi:[0,1,0]
v_pk_add_f32 v[64:65], v[40:41], v[72:73] neg_lo:[0,1] neg_hi:[0,1]
v_pk_add_f32 v[40:41], v[40:41], v[72:73]
v_pk_mul_f32 v[72:73], v[64:65], s[62:63] op_sel:[0,0] op_sel_hi:[0,1] neg_lo:[0,1] neg_hi:[0,1]
v_pk_fma_f32 v[72:73], v[64:65], s[62:63], v[72:73] op_sel:[1,1,0] op_sel_hi:[1,0,1] neg_lo:[0,0,0] neg_hi:[0,1,0]
v_pk_add_f32 v[64:65], v[42:43], v[74:75] neg_lo:[0,1] neg_hi:[0,1]
v_pk_add_f32 v[42:43], v[42:43], v[74:75]
v_pk_mul_f32 v[74:75], v[64:65], s[58:59] op_sel:[0,0] op_sel_hi:[0,1] neg_lo:[0,1] neg_hi:[0,1]
v_pk_fma_f32 v[74:75], v[64:65], s[58:59], v[74:75] op_sel:[1,1,0] op_sel_hi:[1,0,1] neg_lo:[0,0,0] neg_hi:[0,1,0]
v_pk_add_f32 v[64:65], v[44:45], v[76:77] neg_lo:[0,1] neg_hi:[0,1]
v_pk_add_f32 v[44:45], v[44:45], v[76:77]
v_pk_mul_f32 v[76:77], v[64:65], s[54:55] op_sel:[0,0] op_sel_hi:[0,1] neg_lo:[0,1] neg_hi:[0,1]
v_pk_fma_f32 v[76:77], v[64:65], s[54:55], v[76:77] op_sel:[1,1,0] op_sel_hi:[1,0,1] neg_lo:[0,0,0] neg_hi:[0,1,0]
v_pk_add_f32 v[64:65], v[46:47], v[78:79] neg_lo:[0,1] neg_hi:[0,1]
v_pk_add_f32 v[46:47], v[46:47], v[78:79]
v_pk_mul_f32 v[78:79], v[64:65], s[50:51] op_sel:[0,0] op_sel_hi:[0,1] neg_lo:[0,1] neg_hi:[0,1]
v_pk_fma_f32 v[78:79], v[64:65], s[50:51], v[78:79] op_sel:[1,1,0] op_sel_hi:[1,0,1] neg_lo:[0,0,0] neg_hi:[0,1,0]
v_pk_add_f32 v[64:65], v[16:17], v[32:33] neg_lo:[0,1] neg_hi:[0,1]
v_pk_add_f32 v[16:17], v[16:17], v[32:33]
v_pk_add_f32 v[32:33], v[18:19], v[34:35] neg_lo:[0,1] neg_hi:[0,1]
v_pk_add_f32 v[18:19], v[18:19], v[34:35]
v_pk_mul_f32 v[34:35], v[32:33], s[54:55] op_sel:[0,0] op_sel_hi:[0,1] neg_lo:[0,0] neg_hi:[0,1]
v_pk_fma_f32 v[34:35], v[32:33], s[54:55], v[34:35] op_sel:[1,1,0] op_sel_hi:[1,0,1] neg_lo:[0,0,0] neg_hi:[0,0,0]
v_pk_add_f32 v[32:33], v[20:21], v[36:37] neg_lo:[0,1] neg_hi:[0,1]
v_pk_add_f32 v[20:21], v[20:21], v[36:37]
v_pk_mul_f32 v[36:37], v[32:33], s[62:63] op_sel:[0,0] op_sel_hi:[0,1] neg_lo:[0,0] neg_hi:[0,1]
v_pk_fma_f32 v[36:37], v[32:33], s[62:63], v[36:37] op_sel:[1,1,0] op_sel_hi:[1,0,1] neg_lo:[0,0,0] neg_hi:[0,0,0]
v_pk_add_f32 v[32:33], v[22:23], v[38:39] neg_lo:[0,1] neg_hi:[0,1]
v_pk_add_f32 v[22:23], v[22:23], v[38:39]
v_pk_mul_f32 v[38:39], v[32:33], s[54:55] op_sel:[0,1] op_sel_hi:[0,0] neg_lo:[0,0] neg_hi:[0,1]
v_pk_fma_f32 v[38:39], v[32:33], s[54:55], v[38:39] op_sel:[1,0,0] op_sel_hi:[1,1,1] neg_lo:[0,0,0] neg_hi:[0,0,0]
v_pk_add_f32 v[32:33], v[24:25], v[40:41] op_sel:[1,1] op_sel_hi:[0,0] neg_lo:[0,1] neg_hi:[1,0]
v_pk_add_f32 v[24:25], v[24:25], v[40:41]
v_pk_add_f32 v[40:41], v[26:27], v[42:43] neg_lo:[0,1] neg_hi:[0,1]
v_pk_add_f32 v[26:27], v[26:27], v[42:43]
v_pk_mul_f32 v[42:43], v[40:41], s[54:55] op_sel:[0,1] op_sel_hi:[0,0] neg_lo:[0,1] neg_hi:[0,1]
v_pk_fma_f32 v[42:43], v[40:41], s[54:55], v[42:43] op_sel:[1,0,0] op_sel_hi:[1,1,1] neg_lo:[0,0,0] neg_hi:[0,1,0]
v_pk_add_f32 v[40:41], v[28:29], v[44:45] neg_lo:[0,1] neg_hi:[0,1]
v_pk_add_f32 v[28:29], v[28:29], v[44:45]
v_pk_mul_f32 v[44:45], v[40:41], s[62:63] op_sel:[0,0] op_sel_hi:[0,1] neg_lo:[0,1] neg_hi:[0,1]
v_pk_fma_f32 v[44:45], v[40:41], s[62:63], v[44:45] op_sel:[1,1,0] op_sel_hi:[1,0,1] neg_lo:[0,0,0] neg_hi:[0,1,0]
v_pk_add_f32 v[40:41], v[30:31], v[46:47] neg_lo:[0,1] neg_hi:[0,1]
v_pk_add_f32 v[30:31], v[30:31], v[46:47]
v_pk_mul_f32 v[46:47], v[40:41], s[54:55] op_sel:[0,0] op_sel_hi:[0,1] neg_lo:[0,1] neg_hi:[0,1]
v_pk_fma_f32 v[46:47], v[40:41], s[54:55], v[46:47] op_sel:[1,1,0] op_sel_hi:[1,0,1] neg_lo:[0,0,0] neg_hi:[0,1,0]
v_pk_add_f32 v[40:41], v[14:15], v[48:49] neg_lo:[0,1] neg_hi:[0,1]
v_pk_add_f32 v[14:15], v[14:15], v[48:49]
v_pk_add_f32 v[48:49], v[50:51], v[66:67] neg_lo:[0,1] neg_hi:[0,1]
v_pk_add_f32 v[50:51], v[50:51], v[66:67]
v_pk_mul_f32 v[66:67], v[48:49], s[54:55] op_sel:[0,0] op_sel_hi:[0,1] neg_lo:[0,0] neg_hi:[0,1]
v_pk_fma_f32 v[66:67], v[48:49], s[54:55], v[66:67] op_sel:[1,1,0] op_sel_hi:[1,0,1] neg_lo:[0,0,0] neg_hi:[0,0,0]
v_pk_add_f32 v[48:49], v[52:53], v[68:69] neg_lo:[0,1] neg_hi:[0,1]
v_pk_add_f32 v[52:53], v[52:53], v[68:69]
v_pk_mul_f32 v[68:69], v[48:49], s[62:63] op_sel:[0,0] op_sel_hi:[0,1] neg_lo:[0,0] neg_hi:[0,1]
v_pk_fma_f32 v[68:69], v[48:49], s[62:63], v[68:69] op_sel:[1,1,0] op_sel_hi:[1,0,1] neg_lo:[0,0,0] neg_hi:[0,0,0]
v_pk_add_f32 v[48:49], v[54:55], v[70:71] neg_lo:[0,1] neg_hi:[0,1]
v_pk_add_f32 v[54:55], v[54:55], v[70:71]
v_pk_mul_f32 v[70:71], v[48:49], s[54:55] op_sel:[0,1] op_sel_hi:[0,0] neg_lo:[0,0] neg_hi:[0,1]
v_pk_fma_f32 v[70:71], v[48:49], s[54:55], v[70:71] op_sel:[1,0,0] op_sel_hi:[1,1,1] neg_lo:[0,0,0] neg_hi:[0,0,0]
v_pk_add_f32 v[48:49], v[56:57], v[72:73] op_sel:[1,1] op_sel_hi:[0,0] neg_lo:[0,1] neg_hi:[1,0]
v_pk_add_f32 v[56:57], v[56:57], v[72:73]
v_pk_add_f32 v[72:73], v[58:59], v[74:75] neg_lo:[0,1] neg_hi:[0,1]
v_pk_add_f32 v[58:59], v[58:59], v[74:75]
v_pk_mul_f32 v[74:75], v[72:73], s[54:55] op_sel:[0,1] op_sel_hi:[0,0] neg_lo:[0,1] neg_hi:[0,1]
v_pk_fma_f32 v[74:75], v[72:73], s[54:55], v[74:75] op_sel:[1,0,0] op_sel_hi:[1,1,1] neg_lo:[0,0,0] neg_hi:[0,1,0]
v_pk_add_f32 v[72:73], v[60:61], v[76:77] neg_lo:[0,1] neg_hi:[0,1]
v_pk_add_f32 v[60:61], v[60:61], v[76:77]
v_pk_mul_f32 v[76:77], v[72:73], s[62:63] op_sel:[0,0] op_sel_hi:[0,1] neg_lo:[0,1] neg_hi:[0,1]
v_pk_fma_f32 v[76:77], v[72:73], s[62:63], v[76:77] op_sel:[1,1,0] op_sel_hi:[1,0,1] neg_lo:[0,0,0] neg_hi:[0,1,0]
v_pk_add_f32 v[72:73], v[62:63], v[78:79] neg_lo:[0,1] neg_hi:[0,1]
v_pk_add_f32 v[62:63], v[62:63], v[78:79]
v_pk_mul_f32 v[78:79], v[72:73], s[54:55] op_sel:[0,0] op_sel_hi:[0,1] neg_lo:[0,1] neg_hi:[0,1]
v_pk_fma_f32 v[78:79], v[72:73], s[54:55], v[78:79] op_sel:[1,1,0] op_sel_hi:[1,0,1] neg_lo:[0,0,0] neg_hi:[0,1,0]
v_pk_add_f32 v[72:73], v[16:17], v[24:25] neg_lo:[0,1] neg_hi:[0,1]
v_pk_add_f32 v[16:17], v[16:17], v[24:25]
v_pk_add_f32 v[24:25], v[18:19], v[26:27] neg_lo:[0,1] neg_hi:[0,1]
v_pk_add_f32 v[18:19], v[18:19], v[26:27]
v_pk_mul_f32 v[26:27], v[24:25], s[62:63] op_sel:[0,0] op_sel_hi:[0,1] neg_lo:[0,0] neg_hi:[0,1]
v_pk_fma_f32 v[26:27], v[24:25], s[62:63], v[26:27] op_sel:[1,1,0] op_sel_hi:[1,0,1] neg_lo:[0,0,0] neg_hi:[0,0,0]
v_pk_add_f32 v[24:25], v[20:21], v[28:29] op_sel:[1,1] op_sel_hi:[0,0] neg_lo:[0,1] neg_hi:[1,0]
v_pk_add_f32 v[20:21], v[20:21], v[28:29]
v_pk_add_f32 v[28:29], v[22:23], v[30:31] neg_lo:[0,1] neg_hi:[0,1]
v_pk_add_f32 v[22:23], v[22:23], v[30:31]
v_pk_mul_f32 v[30:31], v[28:29], s[62:63] op_sel:[0,0] op_sel_hi:[0,1] neg_lo:[0,1] neg_hi:[0,1]
v_pk_fma_f32 v[30:31], v[28:29], s[62:63], v[30:31] op_sel:[1,1,0] op_sel_hi:[1,0,1] neg_lo:[0,0,0] neg_hi:[0,1,0]
v_pk_add_f32 v[28:29], v[64:65], v[32:33] neg_lo:[0,1] neg_hi:[0,1]
v_pk_add_f32 v[64:65], v[64:65], v[32:33]
v_pk_add_f32 v[32:33], v[34:35], v[42:43] neg_lo:[0,1] neg_hi:[0,1]
v_pk_add_f32 v[34:35], v[34:35], v[42:43]
v_pk_mul_f32 v[42:43], v[32:33], s[62:63] op_sel:[0,0] op_sel_hi:[0,1] neg_lo:[0,0] neg_hi:[0,1]
v_pk_fma_f32 v[42:43], v[32:33], s[62:63], v[42:43] op_sel:[1,1,0] op_sel_hi:[1,0,1] neg_lo:[0,0,0] neg_hi:[0,0,0]
v_pk_add_f32 v[32:33], v[36:37], v[44:45] op_sel:[1,1] op_sel_hi:[0,0] neg_lo:[0,1] neg_hi:[1,0]
v_pk_add_f32 v[36:37], v[36:37], v[44:45]
v_pk_add_f32 v[44:45], v[38:39], v[46:47] neg_lo:[0,1] neg_hi:[0,1]
v_pk_add_f32 v[38:39], v[38:39], v[46:47]
v_pk_mul_f32 v[46:47], v[44:45], s[62:63] op_sel:[0,0] op_sel_hi:[0,1] neg_lo:[0,1] neg_hi:[0,1]
v_pk_fma_f32 v[46:47], v[44:45], s[62:63], v[46:47] op_sel:[1,1,0] op_sel_hi:[1,0,1] neg_lo:[0,0,0] neg_hi:[0,1,0]
v_pk_add_f32 v[44:45], v[14:15], v[56:57] neg_lo:[0,1] neg_hi:[0,1]
v_pk_add_f32 v[14:15], v[14:15], v[56:57]
v_pk_add_f32 v[56:57], v[50:51], v[58:59] neg_lo:[0,1] neg_hi:[0,1]
v_pk_add_f32 v[50:51], v[50:51], v[58:59]
v_pk_mul_f32 v[58:59], v[56:57], s[62:63] op_sel:[0,0] op_sel_hi:[0,1] neg_lo:[0,0] neg_hi:[0,1]
v_pk_fma_f32 v[58:59], v[56:57], s[62:63], v[58:59] op_sel:[1,1,0] op_sel_hi:[1,0,1] neg_lo:[0,0,0] neg_hi:[0,0,0]
v_pk_add_f32 v[56:57], v[52:53], v[60:61] op_sel:[1,1] op_sel_hi:[0,0] neg_lo:[0,1] neg_hi:[1,0]
v_pk_add_f32 v[52:53], v[52:53], v[60:61]
v_pk_add_f32 v[60:61], v[54:55], v[62:63] neg_lo:[0,1] neg_hi:[0,1]
v_pk_add_f32 v[54:55], v[54:55], v[62:63]
v_pk_mul_f32 v[62:63], v[60:61], s[62:63] op_sel:[0,0] op_sel_hi:[0,1] neg_lo:[0,1] neg_hi:[0,1]
v_pk_fma_f32 v[62:63], v[60:61], s[62:63], v[62:63] op_sel:[1,1,0] op_sel_hi:[1,0,1] neg_lo:[0,0,0] neg_hi:[0,1,0]
v_pk_add_f32 v[60:61], v[40:41], v[48:49] neg_lo:[0,1] neg_hi:[0,1]
v_pk_add_f32 v[40:41], v[40:41], v[48:49]
v_pk_add_f32 v[48:49], v[66:67], v[74:75] neg_lo:[0,1] neg_hi:[0,1]
v_pk_add_f32 v[66:67], v[66:67], v[74:75]
v_pk_mul_f32 v[74:75], v[48:49], s[62:63] op_sel:[0,0] op_sel_hi:[0,1] neg_lo:[0,0] neg_hi:[0,1]
v_pk_fma_f32 v[74:75], v[48:49], s[62:63], v[74:75] op_sel:[1,1,0] op_sel_hi:[1,0,1] neg_lo:[0,0,0] neg_hi:[0,0,0]
v_pk_add_f32 v[48:49], v[68:69], v[76:77] op_sel:[1,1] op_sel_hi:[0,0] neg_lo:[0,1] neg_hi:[1,0]
v_pk_add_f32 v[68:69], v[68:69], v[76:77]
v_pk_add_f32 v[76:77], v[70:71], v[78:79] neg_lo:[0,1] neg_hi:[0,1]
v_pk_add_f32 v[70:71], v[70:71], v[78:79]
v_pk_mul_f32 v[78:79], v[76:77], s[62:63] op_sel:[0,0] op_sel_hi:[0,1] neg_lo:[0,1] neg_hi:[0,1]
v_pk_fma_f32 v[78:79], v[76:77], s[62:63], v[78:79] op_sel:[1,1,0] op_sel_hi:[1,0,1] neg_lo:[0,0,0] neg_hi:[0,1,0]
v_pk_add_f32 v[76:77], v[16:17], v[20:21] neg_lo:[0,1] neg_hi:[0,1]
v_pk_add_f32 v[16:17], v[16:17], v[20:21]
v_pk_add_f32 v[20:21], v[18:19], v[22:23] op_sel:[1,1] op_sel_hi:[0,0] neg_lo:[0,1] neg_hi:[1,0]
v_pk_add_f32 v[18:19], v[18:19], v[22:23]
v_pk_add_f32 v[22:23], v[72:73], v[24:25] neg_lo:[0,1] neg_hi:[0,1]
v_pk_add_f32 v[72:73], v[72:73], v[24:25]
v_pk_add_f32 v[24:25], v[26:27], v[30:31] op_sel:[1,1] op_sel_hi:[0,0] neg_lo:[0,1] neg_hi:[1,0]
v_pk_add_f32 v[26:27], v[26:27], v[30:31]
v_pk_add_f32 v[30:31], v[64:65], v[36:37] neg_lo:[0,1] neg_hi:[0,1]
v_pk_add_f32 v[64:65], v[64:65], v[36:37]
v_pk_add_f32 v[36:37], v[34:35], v[38:39] op_sel:[1,1] op_sel_hi:[0,0] neg_lo:[0,1] neg_hi:[1,0]
v_pk_add_f32 v[34:35], v[34:35], v[38:39]
v_pk_add_f32 v[38:39], v[28:29], v[32:33] neg_lo:[0,1] neg_hi:[0,1]
v_pk_add_f32 v[28:29], v[28:29], v[32:33]
v_pk_add_f32 v[32:33], v[42:43], v[46:47] op_sel:[1,1] op_sel_hi:[0,0] neg_lo:[0,1] neg_hi:[1,0]
v_pk_add_f32 v[42:43], v[42:43], v[46:47]
v_pk_add_f32 v[46:47], v[14:15], v[52:53] neg_lo:[0,1] neg_hi:[0,1]
v_pk_add_f32 v[14:15], v[14:15], v[52:53]
v_pk_add_f32 v[52:53], v[50:51], v[54:55] op_sel:[1,1] op_sel_hi:[0,0] neg_lo:[0,1] neg_hi:[1,0]
v_pk_add_f32 v[50:51], v[50:51], v[54:55]
v_pk_add_f32 v[54:55], v[44:45], v[56:57] neg_lo:[0,1] neg_hi:[0,1]
v_pk_add_f32 v[44:45], v[44:45], v[56:57]
v_pk_add_f32 v[56:57], v[58:59], v[62:63] op_sel:[1,1] op_sel_hi:[0,0] neg_lo:[0,1] neg_hi:[1,0]
v_pk_add_f32 v[58:59], v[58:59], v[62:63]
v_pk_add_f32 v[62:63], v[40:41], v[68:69] neg_lo:[0,1] neg_hi:[0,1]
v_pk_add_f32 v[40:41], v[40:41], v[68:69]
v_pk_add_f32 v[68:69], v[66:67], v[70:71] op_sel:[1,1] op_sel_hi:[0,0] neg_lo:[0,1] neg_hi:[1,0]
v_pk_add_f32 v[66:67], v[66:67], v[70:71]
v_pk_add_f32 v[70:71], v[60:61], v[48:49] neg_lo:[0,1] neg_hi:[0,1]
v_pk_add_f32 v[60:61], v[60:61], v[48:49]
v_pk_add_f32 v[48:49], v[74:75], v[78:79] op_sel:[1,1] op_sel_hi:[0,0] neg_lo:[0,1] neg_hi:[1,0]
v_pk_add_f32 v[74:75], v[74:75], v[78:79]
v_pk_add_f32 v[78:79], v[16:17], v[18:19] neg_lo:[0,1] neg_hi:[0,1]
v_pk_add_f32 v[16:17], v[16:17], v[18:19]
v_pk_add_f32 v[18:19], v[76:77], v[20:21] neg_lo:[0,1] neg_hi:[0,1]
v_pk_add_f32 v[76:77], v[76:77], v[20:21]
v_pk_add_f32 v[20:21], v[72:73], v[26:27] neg_lo:[0,1] neg_hi:[0,1]
v_pk_add_f32 v[72:73], v[72:73], v[26:27]
v_pk_add_f32 v[26:27], v[22:23], v[24:25] neg_lo:[0,1] neg_hi:[0,1]
v_pk_add_f32 v[22:23], v[22:23], v[24:25]
v_pk_add_f32 v[24:25], v[64:65], v[34:35] neg_lo:[0,1] neg_hi:[0,1]
v_pk_add_f32 v[64:65], v[64:65], v[34:35]
v_pk_add_f32 v[34:35], v[30:31], v[36:37] neg_lo:[0,1] neg_hi:[0,1]
v_pk_add_f32 v[30:31], v[30:31], v[36:37]
v_pk_add_f32 v[36:37], v[28:29], v[42:43] neg_lo:[0,1] neg_hi:[0,1]
v_pk_add_f32 v[28:29], v[28:29], v[42:43]
v_pk_add_f32 v[42:43], v[38:39], v[32:33] neg_lo:[0,1] neg_hi:[0,1]
v_pk_add_f32 v[38:39], v[38:39], v[32:33]
v_pk_add_f32 v[32:33], v[14:15], v[50:51] neg_lo:[0,1] neg_hi:[0,1]
v_pk_add_f32 v[14:15], v[14:15], v[50:51]
v_pk_add_f32 v[50:51], v[46:47], v[52:53] neg_lo:[0,1] neg_hi:[0,1]
v_pk_add_f32 v[46:47], v[46:47], v[52:53]
v_pk_add_f32 v[52:53], v[44:45], v[58:59] neg_lo:[0,1] neg_hi:[0,1]
v_pk_add_f32 v[44:45], v[44:45], v[58:59]
v_pk_add_f32 v[58:59], v[54:55], v[56:57] neg_lo:[0,1] neg_hi:[0,1]
v_pk_add_f32 v[54:55], v[54:55], v[56:57]
v_pk_add_f32 v[56:57], v[40:41], v[66:67] neg_lo:[0,1] neg_hi:[0,1]
v_pk_add_f32 v[40:41], v[40:41], v[66:67]
v_pk_add_f32 v[66:67], v[62:63], v[68:69] neg_lo:[0,1] neg_hi:[0,1]
v_pk_add_f32 v[62:63], v[62:63], v[68:69]
v_pk_add_f32 v[68:69], v[60:61], v[74:75] neg_lo:[0,1] neg_hi:[0,1]
v_pk_add_f32 v[60:61], v[60:61], v[74:75]
v_pk_add_f32 v[74:75], v[70:71], v[48:49] neg_lo:[0,1] neg_hi:[0,1]
v_pk_add_f32 v[70:71], v[70:71], v[48:49]
v_pk_mul_f32 v[48:49], v[14:15], v[82:83] op_sel:[0,0] op_sel_hi:[0,1] neg_lo:[0,0] neg_hi:[0,0]
v_pk_fma_f32 v[14:15], v[14:15], v[82:83], v[48:49] op_sel:[1,1,0] op_sel_hi:[1,0,1] neg_lo:[0,1,0] neg_hi:[0,0,0]
v_pk_mul_f32 v[48:49], v[64:65], v[84:85] op_sel:[0,0] op_sel_hi:[0,1] neg_lo:[0,0] neg_hi:[0,0]
v_pk_fma_f32 v[64:65], v[64:65], v[84:85], v[48:49] op_sel:[1,1,0] op_sel_hi:[1,0,1] neg_lo:[0,1,0] neg_hi:[0,0,0]
v_pk_mul_f32 v[48:49], v[40:41], v[86:87] op_sel:[0,0] op_sel_hi:[0,1] neg_lo:[0,0] neg_hi:[0,0]
v_pk_fma_f32 v[40:41], v[40:41], v[86:87], v[48:49] op_sel:[1,1,0] op_sel_hi:[1,0,1] neg_lo:[0,1,0] neg_hi:[0,0,0]
v_pk_mul_f32 v[48:49], v[72:73], v[88:89] op_sel:[0,0] op_sel_hi:[0,1] neg_lo:[0,0] neg_hi:[0,0]
v_pk_fma_f32 v[72:73], v[72:73], v[88:89], v[48:49] op_sel:[1,1,0] op_sel_hi:[1,0,1] neg_lo:[0,1,0] neg_hi:[0,0,0]
v_pk_mul_f32 v[48:49], v[44:45], v[90:91] op_sel:[0,0] op_sel_hi:[0,1] neg_lo:[0,0] neg_hi:[0,0]
v_pk_fma_f32 v[44:45], v[44:45], v[90:91], v[48:49] op_sel:[1,1,0] op_sel_hi:[1,0,1] neg_lo:[0,1,0] neg_hi:[0,0,0]
v_pk_mul_f32 v[48:49], v[28:29], v[92:93] op_sel:[0,0] op_sel_hi:[0,1] neg_lo:[0,0] neg_hi:[0,0]
v_pk_fma_f32 v[28:29], v[28:29], v[92:93], v[48:49] op_sel:[1,1,0] op_sel_hi:[1,0,1] neg_lo:[0,1,0] neg_hi:[0,0,0]
v_pk_mul_f32 v[48:49], v[60:61], v[94:95] op_sel:[0,0] op_sel_hi:[0,1] neg_lo:[0,0] neg_hi:[0,0]
v_pk_fma_f32 v[60:61], v[60:61], v[94:95], v[48:49] op_sel:[1,1,0] op_sel_hi:[1,0,1] neg_lo:[0,1,0] neg_hi:[0,0,0]
v_pk_mul_f32 v[48:49], v[76:77], v[96:97] op_sel:[0,0] op_sel_hi:[0,1] neg_lo:[0,0] neg_hi:[0,0]
v_pk_fma_f32 v[76:77], v[76:77], v[96:97], v[48:49] op_sel:[1,1,0] op_sel_hi:[1,0,1] neg_lo:[0,1,0] neg_hi:[0,0,0]
v_pk_mul_f32 v[48:49], v[46:47], v[98:99] op_sel:[0,0] op_sel_hi:[0,1] neg_lo:[0,0] neg_hi:[0,0]
v_pk_fma_f32 v[46:47], v[46:47], v[98:99], v[48:49] op_sel:[1,1,0] op_sel_hi:[1,0,1] neg_lo:[0,1,0] neg_hi:[0,0,0]
v_pk_mul_f32 v[48:49], v[30:31], v[100:101] op_sel:[0,0] op_sel_hi:[0,1] neg_lo:[0,0] neg_hi:[0,0]
v_pk_fma_f32 v[30:31], v[30:31], v[100:101], v[48:49] op_sel:[1,1,0] op_sel_hi:[1,0,1] neg_lo:[0,1,0] neg_hi:[0,0,0]
v_pk_mul_f32 v[48:49], v[62:63], v[102:103] op_sel:[0,0] op_sel_hi:[0,1] neg_lo:[0,0] neg_hi:[0,0]
v_pk_fma_f32 v[62:63], v[62:63], v[102:103], v[48:49] op_sel:[1,1,0] op_sel_hi:[1,0,1] neg_lo:[0,1,0] neg_hi:[0,0,0]
v_pk_mul_f32 v[48:49], v[22:23], v[104:105] op_sel:[0,0] op_sel_hi:[0,1] neg_lo:[0,0] neg_hi:[0,0]
v_pk_fma_f32 v[22:23], v[22:23], v[104:105], v[48:49] op_sel:[1,1,0] op_sel_hi:[1,0,1] neg_lo:[0,1,0] neg_hi:[0,0,0]
v_pk_mul_f32 v[48:49], v[54:55], v[106:107] op_sel:[0,0] op_sel_hi:[0,1] neg_lo:[0,0] neg_hi:[0,0]
v_pk_fma_f32 v[54:55], v[54:55], v[106:107], v[48:49] op_sel:[1,1,0] op_sel_hi:[1,0,1] neg_lo:[0,1,0] neg_hi:[0,0,0]
v_pk_mul_f32 v[48:49], v[38:39], v[108:109] op_sel:[0,0] op_sel_hi:[0,1] neg_lo:[0,0] neg_hi:[0,0]
v_pk_fma_f32 v[38:39], v[38:39], v[108:109], v[48:49] op_sel:[1,1,0] op_sel_hi:[1,0,1] neg_lo:[0,1,0] neg_hi:[0,0,0]
v_pk_mul_f32 v[48:49], v[70:71], v[110:111] op_sel:[0,0] op_sel_hi:[0,1] neg_lo:[0,0] neg_hi:[0,0]
v_pk_fma_f32 v[70:71], v[70:71], v[110:111], v[48:49] op_sel:[1,1,0] op_sel_hi:[1,0,1] neg_lo:[0,1,0] neg_hi:[0,0,0]
v_pk_mul_f32 v[48:49], v[78:79], v[112:113] op_sel:[0,0] op_sel_hi:[0,1] neg_lo:[0,0] neg_hi:[0,0]
v_pk_fma_f32 v[78:79], v[78:79], v[112:113], v[48:49] op_sel:[1,1,0] op_sel_hi:[1,0,1] neg_lo:[0,1,0] neg_hi:[0,0,0]
v_pk_mul_f32 v[48:49], v[32:33], v[114:115] op_sel:[0,0] op_sel_hi:[0,1] neg_lo:[0,0] neg_hi:[0,0]
v_pk_fma_f32 v[32:33], v[32:33], v[114:115], v[48:49] op_sel:[1,1,0] op_sel_hi:[1,0,1] neg_lo:[0,1,0] neg_hi:[0,0,0]
v_pk_mul_f32 v[48:49], v[24:25], v[116:117] op_sel:[0,0] op_sel_hi:[0,1] neg_lo:[0,0] neg_hi:[0,0]
v_pk_fma_f32 v[24:25], v[24:25], v[116:117], v[48:49] op_sel:[1,1,0] op_sel_hi:[1,0,1] neg_lo:[0,1,0] neg_hi:[0,0,0]
v_pk_mul_f32 v[48:49], v[56:57], v[118:119] op_sel:[0,0] op_sel_hi:[0,1] neg_lo:[0,0] neg_hi:[0,0]
v_pk_fma_f32 v[56:57], v[56:57], v[118:119], v[48:49] op_sel:[1,1,0] op_sel_hi:[1,0,1] neg_lo:[0,1,0] neg_hi:[0,0,0]
v_pk_mul_f32 v[48:49], v[20:21], v[120:121] op_sel:[0,0] op_sel_hi:[0,1] neg_lo:[0,0] neg_hi:[0,0]
v_pk_fma_f32 v[20:21], v[20:21], v[120:121], v[48:49] op_sel:[1,1,0] op_sel_hi:[1,0,1] neg_lo:[0,1,0] neg_hi:[0,0,0]
v_pk_mul_f32 v[48:49], v[52:53], v[122:123] op_sel:[0,0] op_sel_hi:[0,1] neg_lo:[0,0] neg_hi:[0,0]
v_pk_fma_f32 v[52:53], v[52:53], v[122:123], v[48:49] op_sel:[1,1,0] op_sel_hi:[1,0,1] neg_lo:[0,1,0] neg_hi:[0,0,0]
v_pk_mul_f32 v[48:49], v[36:37], v[124:125] op_sel:[0,0] op_sel_hi:[0,1] neg_lo:[0,0] neg_hi:[0,0]
v_pk_fma_f32 v[36:37], v[36:37], v[124:125], v[48:49] op_sel:[1,1,0] op_sel_hi:[1,0,1] neg_lo:[0,1,0] neg_hi:[0,0,0]
v_pk_mul_f32 v[48:49], v[68:69], v[126:127] op_sel:[0,0] op_sel_hi:[0,1] neg_lo:[0,0] neg_hi:[0,0]
v_pk_fma_f32 v[68:69], v[68:69], v[126:127], v[48:49] op_sel:[1,1,0] op_sel_hi:[1,0,1] neg_lo:[0,1,0] neg_hi:[0,0,0]
v_pk_mul_f32 v[48:49], v[18:19], v[128:129] op_sel:[0,0] op_sel_hi:[0,1] neg_lo:[0,0] neg_hi:[0,0]
v_pk_fma_f32 v[18:19], v[18:19], v[128:129], v[48:49] op_sel:[1,1,0] op_sel_hi:[1,0,1] neg_lo:[0,1,0] neg_hi:[0,0,0]
v_pk_mul_f32 v[48:49], v[50:51], v[130:131] op_sel:[0,0] op_sel_hi:[0,1] neg_lo:[0,0] neg_hi:[0,0]
v_pk_fma_f32 v[50:51], v[50:51], v[130:131], v[48:49] op_sel:[1,1,0] op_sel_hi:[1,0,1] neg_lo:[0,1,0] neg_hi:[0,0,0]
v_pk_mul_f32 v[48:49], v[34:35], v[132:133] op_sel:[0,0] op_sel_hi:[0,1] neg_lo:[0,0] neg_hi:[0,0]
v_pk_fma_f32 v[34:35], v[34:35], v[132:133], v[48:49] op_sel:[1,1,0] op_sel_hi:[1,0,1] neg_lo:[0,1,0] neg_hi:[0,0,0]
v_pk_mul_f32 v[48:49], v[66:67], v[134:135] op_sel:[0,0] op_sel_hi:[0,1] neg_lo:[0,0] neg_hi:[0,0]
v_pk_fma_f32 v[66:67], v[66:67], v[134:135], v[48:49] op_sel:[1,1,0] op_sel_hi:[1,0,1] neg_lo:[0,1,0] neg_hi:[0,0,0]
v_pk_mul_f32 v[48:49], v[26:27], v[136:137] op_sel:[0,0] op_sel_hi:[0,1] neg_lo:[0,0] neg_hi:[0,0]
v_pk_fma_f32 v[26:27], v[26:27], v[136:137], v[48:49] op_sel:[1,1,0] op_sel_hi:[1,0,1] neg_lo:[0,1,0] neg_hi:[0,0,0]
v_pk_mul_f32 v[48:49], v[58:59], v[138:139] op_sel:[0,0] op_sel_hi:[0,1] neg_lo:[0,0] neg_hi:[0,0]
v_pk_fma_f32 v[58:59], v[58:59], v[138:139], v[48:49] op_sel:[1,1,0] op_sel_hi:[1,0,1] neg_lo:[0,1,0] neg_hi:[0,0,0]
v_pk_mul_f32 v[48:49], v[42:43], v[140:141] op_sel:[0,0] op_sel_hi:[0,1] neg_lo:[0,0] neg_hi:[0,0]
v_pk_fma_f32 v[42:43], v[42:43], v[140:141], v[48:49] op_sel:[1,1,0] op_sel_hi:[1,0,1] neg_lo:[0,1,0] neg_hi:[0,0,0]
v_pk_mul_f32 v[48:49], v[74:75], v[142:143] op_sel:[0,0] op_sel_hi:[0,1] neg_lo:[0,0] neg_hi:[0,0]
v_pk_fma_f32 v[74:75], v[74:75], v[142:143], v[48:49] op_sel:[1,1,0] op_sel_hi:[1,0,1] neg_lo:[0,1,0] neg_hi:[0,0,0]
ds_write_b64 v3, v[16:17] offset:0
ds_write_b64 v3, v[14:15] offset:528
ds_write_b64 v3, v[64:65] offset:1056
ds_write_b64 v3, v[40:41] offset:1584
ds_write_b64 v3, v[72:73] offset:2112
ds_write_b64 v3, v[44:45] offset:2640
ds_write_b64 v3, v[28:29] offset:3168
ds_write_b64 v3, v[60:61] offset:3696
ds_write_b64 v3, v[76:77] offset:4224
ds_write_b64 v3, v[46:47] offset:4752
ds_write_b64 v3, v[30:31] offset:5280
ds_write_b64 v3, v[62:63] offset:5808
ds_write_b64 v3, v[22:23] offset:6336
ds_write_b64 v3, v[54:55] offset:6864
ds_write_b64 v3, v[38:39] offset:7392
ds_write_b64 v3, v[70:71] offset:7920
ds_write_b64 v3, v[78:79] offset:8448
ds_write_b64 v3, v[32:33] offset:8976
ds_write_b64 v3, v[24:25] offset:9504
ds_write_b64 v3, v[56:57] offset:10032
ds_write_b64 v3, v[20:21] offset:10560
ds_write_b64 v3, v[52:53] offset:11088
ds_write_b64 v3, v[36:37] offset:11616
ds_write_b64 v3, v[68:69] offset:12144
ds_write_b64 v3, v[18:19] offset:12672
ds_write_b64 v3, v[50:51] offset:13200
ds_write_b64 v3, v[34:35] offset:13728
ds_write_b64 v3, v[66:67] offset:14256
ds_write_b64 v3, v[26:27] offset:14784
ds_write_b64 v3, v[58:59] offset:15312
ds_write_b64 v3, v[42:43] offset:15840
ds_write_b64 v3, v[74:75] offset:16368
s_waitcnt lgkmcnt(0)
ds_read_b64 v[16:17], v4 offset:0
ds_read_b64 v[48:49], v4 offset:256
ds_read_b64 v[18:19], v4 offset:16
ds_read_b64 v[50:51], v4 offset:272
ds_read_b64 v[20:21], v4 offset:32
ds_read_b64 v[52:53], v4 offset:288
ds_read_b64 v[22:23], v4 offset:48
ds_read_b64 v[54:55], v4 offset:304
ds_read_b64 v[24:25], v4 offset:64
ds_read_b64 v[56:57], v4 offset:320
ds_read_b64 v[26:27], v4 offset:80
ds_read_b64 v[58:59], v4 offset:336
ds_read_b64 v[28:29], v4 offset:96
ds_read_b64 v[60:61], v4 offset:352
ds_read_b64 v[30:31], v4 offset:112
ds_read_b64 v[62:63], v4 offset:368
ds_read_b64 v[32:33], v4 offset:128
ds_read_b64 v[64:65], v4 offset:384
ds_read_b64 v[34:35], v4 offset:144
ds_read_b64 v[66:67], v4 offset:400
ds_read_b64 v[36:37], v4 offset:160
ds_read_b64 v[68:69], v4 offset:416
ds_read_b64 v[38:39], v4 offset:176
ds_read_b64 v[70:71], v4 offset:432
ds_read_b64 v[40:41], v4 offset:192
ds_read_b64 v[72:73], v4 offset:448
ds_read_b64 v[42:43], v4 offset:208
ds_read_b64 v[74:75], v4 offset:464
ds_read_b64 v[44:45], v4 offset:224
ds_read_b64 v[76:77], v4 offset:480
ds_read_b64 v[46:47], v4 offset:240
ds_read_b64 v[78:79], v4 offset:496
s_waitcnt lgkmcnt(0)
v_pk_add_f32 v[14:15], v[16:17], v[48:49] neg_lo:[0,1] neg_hi:[0,1]
v_pk_add_f32 v[16:17], v[16:17], v[48:49]
v_pk_add_f32 v[48:49], v[18:19], v[50:51] neg_lo:[0,1] neg_hi:[0,1]
v_pk_add_f32 v[18:19], v[18:19], v[50:51]
v_pk_mul_f32 v[50:51], v[48:49], s[50:51] op_sel:[0,0] op_sel_hi:[0,1] neg_lo:[0,0] neg_hi:[0,1]
v_pk_fma_f32 v[50:51], v[48:49], s[50:51], v[50:51] op_sel:[1,1,0] op_sel_hi:[1,0,1] neg_lo:[0,0,0] neg_hi:[0,0,0]
v_pk_add_f32 v[48:49], v[20:21], v[52:53] neg_lo:[0,1] neg_hi:[0,1]
v_pk_add_f32 v[20:21], v[20:21], v[52:53]
v_pk_mul_f32 v[52:53], v[48:49], s[54:55] op_sel:[0,0] op_sel_hi:[0,1] neg_lo:[0,0] neg_hi:[0,1]
v_pk_fma_f32 v[52:53], v[48:49], s[54:55], v[52:53] op_sel:[1,1,0] op_sel_hi:[1,0,1] neg_lo:[0,0,0] neg_hi:[0,0,0]
v_pk_add_f32 v[48:49], v[22:23], v[54:55] neg_lo:[0,1] neg_hi:[0,1]
v_pk_add_f32 v[22:23], v[22:23], v[54:55]
v_pk_mul_f32 v[54:55], v[48:49], s[58:59] op_sel:[0,0] op_sel_hi:[0,1] neg_lo:[0,0] neg_hi:[0,1]
v_pk_fma_f32 v[54:55], v[48:49], s[58:59], v[54:55] op_sel:[1,1,0] op_sel_hi:[1,0,1] neg_lo:[0,0,0] neg_hi:[0,0,0]
v_pk_add_f32 v[48:49], v[24:25], v[56:57] neg_lo:[0,1] neg_hi:[0,1]
v_pk_add_f32 v[24:25], v[24:25], v[56:57]
v_pk_mul_f32 v[56:57], v[48:49], s[62:63] op_sel:[0,0] op_sel_hi:[0,1] neg_lo:[0,0] neg_hi:[0,1]
v_pk_fma_f32 v[56:57], v[48:49], s[62:63], v[56:57] op_sel:[1,1,0] op_sel_hi:[1,0,1] neg_lo:[0,0,0] neg_hi:[0,0,0]
v_pk_add_f32 v[48:49], v[26:27], v[58:59] neg_lo:[0,1] neg_hi:[0,1]
v_pk_add_f32 v[26:27], v[26:27], v[58:59]
v_pk_mul_f32 v[58:59], v[48:49], s[58:59] op_sel:[0,1] op_sel_hi:[0,0] neg_lo:[0,0] neg_hi:[0,1]
v_pk_fma_f32 v[58:59], v[48:49], s[58:59], v[58:59] op_sel:[1,0,0] op_sel_hi:[1,1,1] neg_lo:[0,0,0] neg_hi:[0,0,0]
v_pk_add_f32 v[48:49], v[28:29], v[60:61] neg_lo:[0,1] neg_hi:[0,1]
v_pk_add_f32 v[28:29], v[28:29], v[60:61]
v_pk_mul_f32 v[60:61], v[48:49], s[54:55] op_sel:[0,1] op_sel_hi:[0,0] neg_lo:[0,0] neg_hi:[0,1]
v_pk_fma_f32 v[60:61], v[48:49], s[54:55], v[60:61] op_sel:[1,0,0] op_sel_hi:[1,1,1] neg_lo:[0,0,0] neg_hi:[0,0,0]
v_pk_add_f32 v[48:49], v[30:31], v[62:63] neg_lo:[0,1] neg_hi:[0,1]
v_pk_add_f32 v[30:31], v[30:31], v[62:63]
v_pk_mul_f32 v[62:63], v[48:49], s[50:51] op_sel:[0,1] op_sel_hi:[0,0] neg_lo:[0,0] neg_hi:[0,1]
v_pk_fma_f32 v[62:63], v[48:49], s[50:51], v[62:63] op_sel:[1,0,0] op_sel_hi:[1,1,1] neg_lo:[0,0,0] neg_hi:[0,0,0]
v_pk_add_f32 v[48:49], v[32:33], v[64:65] op_sel:[1,1] op_sel_hi:[0,0] neg_lo:[0,1] neg_hi:[1,0]
v_pk_add_f32 v[32:33], v[32:33], v[64:65]
v_pk_add_f32 v[64:65], v[34:35], v[66:67] neg_lo:[0,1] neg_hi:[0,1]
v_pk_add_f32 v[34:35], v[34:35], v[66:67]
v_pk_mul_f32 v[66:67], v[64:65], s[50:51] op_sel:[0,1] op_sel_hi:[0,0] neg_lo:[0,1] neg_hi:[0,1]
v_pk_fma_f32 v[66:67], v[64:65], s[50:51], v[66:67] op_sel:[1,0,0] op_sel_hi:[1,1,1] neg_lo:[0,0,0] neg_hi:[0,1,0]
v_pk_add_f32 v[64:65], v[36:37], v[68:69] neg_lo:[0,1] neg_hi:[0,1]
v_pk_add_f32 v[36:37], v[36:37], v[68:69]
v_pk_mul_f32 v[68:69], v[64:65], s[54:55] op_sel:[0,1] op_sel_hi:[0,0] neg_lo:[0,1] neg_hi:[0,1]
v_pk_fma_f32 v[68:69], v[64:65], s[54:55], v[68:69] op_sel:[1,0,0] op_sel_hi:[1,1,1] neg_lo:[0,0,0] neg_hi:[0,1,0]
v_pk_add_f32 v[64:65], v[38:39], v[70:71] neg_lo:[0,1] neg_hi:[0,1]
v_pk_add_f32 v[38:39], v[38:39], v[70:71]
v_pk_mul_f32 v[70:71], v[64:65], s[58:59] op_sel:[0,1] op_sel_hi:[0,0] neg_lo:[0,1] neg_hi:[0,1]
v_pk_fma_f32 v[70:71], v[64:65], s[58:59], v[70:71] op_sel:[1,0,0] op_sel_hi:[1,1,1] neg_lo:[0,0,0] neg_hi:[0,1,0]
v_pk_add_f32 v[64:65], v[40:41], v[72:73] neg_lo:[0,1] neg_hi:[0,1]
v_pk_add_f32 v[40:41], v[40:41], v[72:73]
v_pk_mul_f32 v[72:73], v[64:65], s[62:63] op_sel:[0,0] op_sel_hi:[0,1] neg_lo:[0,1] neg_hi:[0,1]
v_pk_fma_f32 v[72:73], v[64:65], s[62:63], v[72:73] op_sel:[1,1,0] op_sel_hi:[1,0,1] neg_lo:[0,0,0] neg_hi:[0,1,0]
v_pk_add_f32 v[64:65], v[42:43], v[74:75] neg_lo:[0,1] neg_hi:[0,1]
v_pk_add_f32 v[42:43], v[42:43], v[74:75]
v_pk_mul_f32 v[74:75], v[64:65], s[58:59] op_sel:[0,0] op_sel_hi:[0,1] neg_lo:[0,1] neg_hi:[0,1]
v_pk_fma_f32 v[74:75], v[64:65], s[58:59], v[74:75] op_sel:[1,1,0] op_sel_hi:[1,0,1] neg_lo:[0,0,0] neg_hi:[0,1,0]
v_pk_add_f32 v[64:65], v[44:45], v[76:77] neg_lo:[0,1] neg_hi:[0,1]
v_pk_add_f32 v[44:45], v[44:45], v[76:77]
v_pk_mul_f32 v[76:77], v[64:65], s[54:55] op_sel:[0,0] op_sel_hi:[0,1] neg_lo:[0,1] neg_hi:[0,1]
v_pk_fma_f32 v[76:77], v[64:65], s[54:55], v[76:77] op_sel:[1,1,0] op_sel_hi:[1,0,1] neg_lo:[0,0,0] neg_hi:[0,1,0]
v_pk_add_f32 v[64:65], v[46:47], v[78:79] neg_lo:[0,1] neg_hi:[0,1]
v_pk_add_f32 v[46:47], v[46:47], v[78:79]
v_pk_mul_f32 v[78:79], v[64:65], s[50:51] op_sel:[0,0] op_sel_hi:[0,1] neg_lo:[0,1] neg_hi:[0,1]
v_pk_fma_f32 v[78:79], v[64:65], s[50:51], v[78:79] op_sel:[1,1,0] op_sel_hi:[1,0,1] neg_lo:[0,0,0] neg_hi:[0,1,0]
v_pk_add_f32 v[64:65], v[16:17], v[32:33] neg_lo:[0,1] neg_hi:[0,1]
v_pk_add_f32 v[16:17], v[16:17], v[32:33]
v_pk_add_f32 v[32:33], v[18:19], v[34:35] neg_lo:[0,1] neg_hi:[0,1]
v_pk_add_f32 v[18:19], v[18:19], v[34:35]
v_pk_mul_f32 v[34:35], v[32:33], s[54:55] op_sel:[0,0] op_sel_hi:[0,1] neg_lo:[0,0] neg_hi:[0,1]
v_pk_fma_f32 v[34:35], v[32:33], s[54:55], v[34:35] op_sel:[1,1,0] op_sel_hi:[1,0,1] neg_lo:[0,0,0] neg_hi:[0,0,0]
v_pk_add_f32 v[32:33], v[20:21], v[36:37] neg_lo:[0,1] neg_hi:[0,1]
v_pk_add_f32 v[20:21], v[20:21], v[36:37]
v_pk_mul_f32 v[36:37], v[32:33], s[62:63] op_sel:[0,0] op_sel_hi:[0,1] neg_lo:[0,0] neg_hi:[0,1]
v_pk_fma_f32 v[36:37], v[32:33], s[62:63], v[36:37] op_sel:[1,1,0] op_sel_hi:[1,0,1] neg_lo:[0,0,0] neg_hi:[0,0,0]
v_pk_add_f32 v[32:33], v[22:23], v[38:39] neg_lo:[0,1] neg_hi:[0,1]
v_pk_add_f32 v[22:23], v[22:23], v[38:39]
v_pk_mul_f32 v[38:39], v[32:33], s[54:55] op_sel:[0,1] op_sel_hi:[0,0] neg_lo:[0,0] neg_hi:[0,1]
v_pk_fma_f32 v[38:39], v[32:33], s[54:55], v[38:39] op_sel:[1,0,0] op_sel_hi:[1,1,1] neg_lo:[0,0,0] neg_hi:[0,0,0]
v_pk_add_f32 v[32:33], v[24:25], v[40:41] op_sel:[1,1] op_sel_hi:[0,0] neg_lo:[0,1] neg_hi:[1,0]
v_pk_add_f32 v[24:25], v[24:25], v[40:41]
v_pk_add_f32 v[40:41], v[26:27], v[42:43] neg_lo:[0,1] neg_hi:[0,1]
v_pk_add_f32 v[26:27], v[26:27], v[42:43]
v_pk_mul_f32 v[42:43], v[40:41], s[54:55] op_sel:[0,1] op_sel_hi:[0,0] neg_lo:[0,1] neg_hi:[0,1]
v_pk_fma_f32 v[42:43], v[40:41], s[54:55], v[42:43] op_sel:[1,0,0] op_sel_hi:[1,1,1] neg_lo:[0,0,0] neg_hi:[0,1,0]
v_pk_add_f32 v[40:41], v[28:29], v[44:45] neg_lo:[0,1] neg_hi:[0,1]
v_pk_add_f32 v[28:29], v[28:29], v[44:45]
v_pk_mul_f32 v[44:45], v[40:41], s[62:63] op_sel:[0,0] op_sel_hi:[0,1] neg_lo:[0,1] neg_hi:[0,1]
v_pk_fma_f32 v[44:45], v[40:41], s[62:63], v[44:45] op_sel:[1,1,0] op_sel_hi:[1,0,1] neg_lo:[0,0,0] neg_hi:[0,1,0]
v_pk_add_f32 v[40:41], v[30:31], v[46:47] neg_lo:[0,1] neg_hi:[0,1]
v_pk_add_f32 v[30:31], v[30:31], v[46:47]
v_pk_mul_f32 v[46:47], v[40:41], s[54:55] op_sel:[0,0] op_sel_hi:[0,1] neg_lo:[0,1] neg_hi:[0,1]
v_pk_fma_f32 v[46:47], v[40:41], s[54:55], v[46:47] op_sel:[1,1,0] op_sel_hi:[1,0,1] neg_lo:[0,0,0] neg_hi:[0,1,0]
v_pk_add_f32 v[40:41], v[14:15], v[48:49] neg_lo:[0,1] neg_hi:[0,1]
v_pk_add_f32 v[14:15], v[14:15], v[48:49]
v_pk_add_f32 v[48:49], v[50:51], v[66:67] neg_lo:[0,1] neg_hi:[0,1]
v_pk_add_f32 v[50:51], v[50:51], v[66:67]
v_pk_mul_f32 v[66:67], v[48:49], s[54:55] op_sel:[0,0] op_sel_hi:[0,1] neg_lo:[0,0] neg_hi:[0,1]
v_pk_fma_f32 v[66:67], v[48:49], s[54:55], v[66:67] op_sel:[1,1,0] op_sel_hi:[1,0,1] neg_lo:[0,0,0] neg_hi:[0,0,0]
v_pk_add_f32 v[48:49], v[52:53], v[68:69] neg_lo:[0,1] neg_hi:[0,1]
v_pk_add_f32 v[52:53], v[52:53], v[68:69]
v_pk_mul_f32 v[68:69], v[48:49], s[62:63] op_sel:[0,0] op_sel_hi:[0,1] neg_lo:[0,0] neg_hi:[0,1]
v_pk_fma_f32 v[68:69], v[48:49], s[62:63], v[68:69] op_sel:[1,1,0] op_sel_hi:[1,0,1] neg_lo:[0,0,0] neg_hi:[0,0,0]
v_pk_add_f32 v[48:49], v[54:55], v[70:71] neg_lo:[0,1] neg_hi:[0,1]
v_pk_add_f32 v[54:55], v[54:55], v[70:71]
v_pk_mul_f32 v[70:71], v[48:49], s[54:55] op_sel:[0,1] op_sel_hi:[0,0] neg_lo:[0,0] neg_hi:[0,1]
v_pk_fma_f32 v[70:71], v[48:49], s[54:55], v[70:71] op_sel:[1,0,0] op_sel_hi:[1,1,1] neg_lo:[0,0,0] neg_hi:[0,0,0]
v_pk_add_f32 v[48:49], v[56:57], v[72:73] op_sel:[1,1] op_sel_hi:[0,0] neg_lo:[0,1] neg_hi:[1,0]
v_pk_add_f32 v[56:57], v[56:57], v[72:73]
v_pk_add_f32 v[72:73], v[58:59], v[74:75] neg_lo:[0,1] neg_hi:[0,1]
v_pk_add_f32 v[58:59], v[58:59], v[74:75]
v_pk_mul_f32 v[74:75], v[72:73], s[54:55] op_sel:[0,1] op_sel_hi:[0,0] neg_lo:[0,1] neg_hi:[0,1]
v_pk_fma_f32 v[74:75], v[72:73], s[54:55], v[74:75] op_sel:[1,0,0] op_sel_hi:[1,1,1] neg_lo:[0,0,0] neg_hi:[0,1,0]
v_pk_add_f32 v[72:73], v[60:61], v[76:77] neg_lo:[0,1] neg_hi:[0,1]
v_pk_add_f32 v[60:61], v[60:61], v[76:77]
v_pk_mul_f32 v[76:77], v[72:73], s[62:63] op_sel:[0,0] op_sel_hi:[0,1] neg_lo:[0,1] neg_hi:[0,1]
v_pk_fma_f32 v[76:77], v[72:73], s[62:63], v[76:77] op_sel:[1,1,0] op_sel_hi:[1,0,1] neg_lo:[0,0,0] neg_hi:[0,1,0]
v_pk_add_f32 v[72:73], v[62:63], v[78:79] neg_lo:[0,1] neg_hi:[0,1]
v_pk_add_f32 v[62:63], v[62:63], v[78:79]
v_pk_mul_f32 v[78:79], v[72:73], s[54:55] op_sel:[0,0] op_sel_hi:[0,1] neg_lo:[0,1] neg_hi:[0,1]
v_pk_fma_f32 v[78:79], v[72:73], s[54:55], v[78:79] op_sel:[1,1,0] op_sel_hi:[1,0,1] neg_lo:[0,0,0] neg_hi:[0,1,0]
v_pk_add_f32 v[72:73], v[16:17], v[24:25] neg_lo:[0,1] neg_hi:[0,1]
v_pk_add_f32 v[16:17], v[16:17], v[24:25]
v_pk_add_f32 v[24:25], v[18:19], v[26:27] neg_lo:[0,1] neg_hi:[0,1]
v_pk_add_f32 v[18:19], v[18:19], v[26:27]
v_pk_mul_f32 v[26:27], v[24:25], s[62:63] op_sel:[0,0] op_sel_hi:[0,1] neg_lo:[0,0] neg_hi:[0,1]
v_pk_fma_f32 v[26:27], v[24:25], s[62:63], v[26:27] op_sel:[1,1,0] op_sel_hi:[1,0,1] neg_lo:[0,0,0] neg_hi:[0,0,0]
v_pk_add_f32 v[24:25], v[20:21], v[28:29] op_sel:[1,1] op_sel_hi:[0,0] neg_lo:[0,1] neg_hi:[1,0]
v_pk_add_f32 v[20:21], v[20:21], v[28:29]
v_pk_add_f32 v[28:29], v[22:23], v[30:31] neg_lo:[0,1] neg_hi:[0,1]
v_pk_add_f32 v[22:23], v[22:23], v[30:31]
v_pk_mul_f32 v[30:31], v[28:29], s[62:63] op_sel:[0,0] op_sel_hi:[0,1] neg_lo:[0,1] neg_hi:[0,1]
v_pk_fma_f32 v[30:31], v[28:29], s[62:63], v[30:31] op_sel:[1,1,0] op_sel_hi:[1,0,1] neg_lo:[0,0,0] neg_hi:[0,1,0]
v_pk_add_f32 v[28:29], v[64:65], v[32:33] neg_lo:[0,1] neg_hi:[0,1]
v_pk_add_f32 v[64:65], v[64:65], v[32:33]
v_pk_add_f32 v[32:33], v[34:35], v[42:43] neg_lo:[0,1] neg_hi:[0,1]
v_pk_add_f32 v[34:35], v[34:35], v[42:43]
v_pk_mul_f32 v[42:43], v[32:33], s[62:63] op_sel:[0,0] op_sel_hi:[0,1] neg_lo:[0,0] neg_hi:[0,1]
v_pk_fma_f32 v[42:43], v[32:33], s[62:63], v[42:43] op_sel:[1,1,0] op_sel_hi:[1,0,1] neg_lo:[0,0,0] neg_hi:[0,0,0]
v_pk_add_f32 v[32:33], v[36:37], v[44:45] op_sel:[1,1] op_sel_hi:[0,0] neg_lo:[0,1] neg_hi:[1,0]
v_pk_add_f32 v[36:37], v[36:37], v[44:45]
v_pk_add_f32 v[44:45], v[38:39], v[46:47] neg_lo:[0,1] neg_hi:[0,1]
v_pk_add_f32 v[38:39], v[38:39], v[46:47]
v_pk_mul_f32 v[46:47], v[44:45], s[62:63] op_sel:[0,0] op_sel_hi:[0,1] neg_lo:[0,1] neg_hi:[0,1]
v_pk_fma_f32 v[46:47], v[44:45], s[62:63], v[46:47] op_sel:[1,1,0] op_sel_hi:[1,0,1] neg_lo:[0,0,0] neg_hi:[0,1,0]
v_pk_add_f32 v[44:45], v[14:15], v[56:57] neg_lo:[0,1] neg_hi:[0,1]
v_pk_add_f32 v[14:15], v[14:15], v[56:57]
v_pk_add_f32 v[56:57], v[50:51], v[58:59] neg_lo:[0,1] neg_hi:[0,1]
v_pk_add_f32 v[50:51], v[50:51], v[58:59]
v_pk_mul_f32 v[58:59], v[56:57], s[62:63] op_sel:[0,0] op_sel_hi:[0,1] neg_lo:[0,0] neg_hi:[0,1]
v_pk_fma_f32 v[58:59], v[56:57], s[62:63], v[58:59] op_sel:[1,1,0] op_sel_hi:[1,0,1] neg_lo:[0,0,0] neg_hi:[0,0,0]
v_pk_add_f32 v[56:57], v[52:53], v[60:61] op_sel:[1,1] op_sel_hi:[0,0] neg_lo:[0,1] neg_hi:[1,0]
v_pk_add_f32 v[52:53], v[52:53], v[60:61]
v_pk_add_f32 v[60:61], v[54:55], v[62:63] neg_lo:[0,1] neg_hi:[0,1]
v_pk_add_f32 v[54:55], v[54:55], v[62:63]
v_pk_mul_f32 v[62:63], v[60:61], s[62:63] op_sel:[0,0] op_sel_hi:[0,1] neg_lo:[0,1] neg_hi:[0,1]
v_pk_fma_f32 v[62:63], v[60:61], s[62:63], v[62:63] op_sel:[1,1,0] op_sel_hi:[1,0,1] neg_lo:[0,0,0] neg_hi:[0,1,0]
v_pk_add_f32 v[60:61], v[40:41], v[48:49] neg_lo:[0,1] neg_hi:[0,1]
v_pk_add_f32 v[40:41], v[40:41], v[48:49]
v_pk_add_f32 v[48:49], v[66:67], v[74:75] neg_lo:[0,1] neg_hi:[0,1]
v_pk_add_f32 v[66:67], v[66:67], v[74:75]
v_pk_mul_f32 v[74:75], v[48:49], s[62:63] op_sel:[0,0] op_sel_hi:[0,1] neg_lo:[0,0] neg_hi:[0,1]
v_pk_fma_f32 v[74:75], v[48:49], s[62:63], v[74:75] op_sel:[1,1,0] op_sel_hi:[1,0,1] neg_lo:[0,0,0] neg_hi:[0,0,0]
v_pk_add_f32 v[48:49], v[68:69], v[76:77] op_sel:[1,1] op_sel_hi:[0,0] neg_lo:[0,1] neg_hi:[1,0]
v_pk_add_f32 v[68:69], v[68:69], v[76:77]
v_pk_add_f32 v[76:77], v[70:71], v[78:79] neg_lo:[0,1] neg_hi:[0,1]
v_pk_add_f32 v[70:71], v[70:71], v[78:79]
v_pk_mul_f32 v[78:79], v[76:77], s[62:63] op_sel:[0,0] op_sel_hi:[0,1] neg_lo:[0,1] neg_hi:[0,1]
v_pk_fma_f32 v[78:79], v[76:77], s[62:63], v[78:79] op_sel:[1,1,0] op_sel_hi:[1,0,1] neg_lo:[0,0,0] neg_hi:[0,1,0]
v_pk_add_f32 v[76:77], v[16:17], v[20:21] neg_lo:[0,1] neg_hi:[0,1]
v_pk_add_f32 v[16:17], v[16:17], v[20:21]
v_pk_add_f32 v[20:21], v[18:19], v[22:23] op_sel:[1,1] op_sel_hi:[0,0] neg_lo:[0,1] neg_hi:[1,0]
v_pk_add_f32 v[18:19], v[18:19], v[22:23]
v_pk_add_f32 v[22:23], v[72:73], v[24:25] neg_lo:[0,1] neg_hi:[0,1]
v_pk_add_f32 v[72:73], v[72:73], v[24:25]
v_pk_add_f32 v[24:25], v[26:27], v[30:31] op_sel:[1,1] op_sel_hi:[0,0] neg_lo:[0,1] neg_hi:[1,0]
v_pk_add_f32 v[26:27], v[26:27], v[30:31]
v_pk_add_f32 v[30:31], v[64:65], v[36:37] neg_lo:[0,1] neg_hi:[0,1]
v_pk_add_f32 v[64:65], v[64:65], v[36:37]
v_pk_add_f32 v[36:37], v[34:35], v[38:39] op_sel:[1,1] op_sel_hi:[0,0] neg_lo:[0,1] neg_hi:[1,0]
v_pk_add_f32 v[34:35], v[34:35], v[38:39]
v_pk_add_f32 v[38:39], v[28:29], v[32:33] neg_lo:[0,1] neg_hi:[0,1]
v_pk_add_f32 v[28:29], v[28:29], v[32:33]
v_pk_add_f32 v[32:33], v[42:43], v[46:47] op_sel:[1,1] op_sel_hi:[0,0] neg_lo:[0,1] neg_hi:[1,0]
v_pk_add_f32 v[42:43], v[42:43], v[46:47]
v_pk_add_f32 v[46:47], v[14:15], v[52:53] neg_lo:[0,1] neg_hi:[0,1]
v_pk_add_f32 v[14:15], v[14:15], v[52:53]
v_pk_add_f32 v[52:53], v[50:51], v[54:55] op_sel:[1,1] op_sel_hi:[0,0] neg_lo:[0,1] neg_hi:[1,0]
v_pk_add_f32 v[50:51], v[50:51], v[54:55]
v_pk_add_f32 v[54:55], v[44:45], v[56:57] neg_lo:[0,1] neg_hi:[0,1]
v_pk_add_f32 v[44:45], v[44:45], v[56:57]
v_pk_add_f32 v[56:57], v[58:59], v[62:63] op_sel:[1,1] op_sel_hi:[0,0] neg_lo:[0,1] neg_hi:[1,0]
v_pk_add_f32 v[58:59], v[58:59], v[62:63]
v_pk_add_f32 v[62:63], v[40:41], v[68:69] neg_lo:[0,1] neg_hi:[0,1]
v_pk_add_f32 v[40:41], v[40:41], v[68:69]
v_pk_add_f32 v[68:69], v[66:67], v[70:71] op_sel:[1,1] op_sel_hi:[0,0] neg_lo:[0,1] neg_hi:[1,0]
v_pk_add_f32 v[66:67], v[66:67], v[70:71]
v_pk_add_f32 v[70:71], v[60:61], v[48:49] neg_lo:[0,1] neg_hi:[0,1]
v_pk_add_f32 v[60:61], v[60:61], v[48:49]
v_pk_add_f32 v[48:49], v[74:75], v[78:79] op_sel:[1,1] op_sel_hi:[0,0] neg_lo:[0,1] neg_hi:[1,0]
v_pk_add_f32 v[74:75], v[74:75], v[78:79]
v_pk_add_f32 v[78:79], v[16:17], v[18:19] neg_lo:[0,1] neg_hi:[0,1]
v_pk_add_f32 v[16:17], v[16:17], v[18:19]
v_pk_add_f32 v[18:19], v[76:77], v[20:21] neg_lo:[0,1] neg_hi:[0,1]
v_pk_add_f32 v[76:77], v[76:77], v[20:21]
v_pk_add_f32 v[20:21], v[72:73], v[26:27] neg_lo:[0,1] neg_hi:[0,1]
v_pk_add_f32 v[72:73], v[72:73], v[26:27]
v_pk_add_f32 v[26:27], v[22:23], v[24:25] neg_lo:[0,1] neg_hi:[0,1]
v_pk_add_f32 v[22:23], v[22:23], v[24:25]
v_pk_add_f32 v[24:25], v[64:65], v[34:35] neg_lo:[0,1] neg_hi:[0,1]
v_pk_add_f32 v[64:65], v[64:65], v[34:35]
v_pk_add_f32 v[34:35], v[30:31], v[36:37] neg_lo:[0,1] neg_hi:[0,1]
v_pk_add_f32 v[30:31], v[30:31], v[36:37]
v_pk_add_f32 v[36:37], v[28:29], v[42:43] neg_lo:[0,1] neg_hi:[0,1]
v_pk_add_f32 v[28:29], v[28:29], v[42:43]
v_pk_add_f32 v[42:43], v[38:39], v[32:33] neg_lo:[0,1] neg_hi:[0,1]
v_pk_add_f32 v[38:39], v[38:39], v[32:33]
v_pk_add_f32 v[32:33], v[14:15], v[50:51] neg_lo:[0,1] neg_hi:[0,1]
v_pk_add_f32 v[14:15], v[14:15], v[50:51]
v_pk_add_f32 v[50:51], v[46:47], v[52:53] neg_lo:[0,1] neg_hi:[0,1]
v_pk_add_f32 v[46:47], v[46:47], v[52:53]
v_pk_add_f32 v[52:53], v[44:45], v[58:59] neg_lo:[0,1] neg_hi:[0,1]
v_pk_add_f32 v[44:45], v[44:45], v[58:59]
v_pk_add_f32 v[58:59], v[54:55], v[56:57] neg_lo:[0,1] neg_hi:[0,1]
v_pk_add_f32 v[54:55], v[54:55], v[56:57]
v_pk_add_f32 v[56:57], v[40:41], v[66:67] neg_lo:[0,1] neg_hi:[0,1]
v_pk_add_f32 v[40:41], v[40:41], v[66:67]
v_pk_add_f32 v[66:67], v[62:63], v[68:69] neg_lo:[0,1] neg_hi:[0,1]
v_pk_add_f32 v[62:63], v[62:63], v[68:69]
v_pk_add_f32 v[68:69], v[60:61], v[74:75] neg_lo:[0,1] neg_hi:[0,1]
v_pk_add_f32 v[60:61], v[60:61], v[74:75]
v_pk_add_f32 v[74:75], v[70:71], v[48:49] neg_lo:[0,1] neg_hi:[0,1]
v_pk_add_f32 v[70:71], v[70:71], v[48:49]
s_mov_b64 exec, s[18:19]
v_pk_add_f32 v[16:17], v[16:17], 0 neg_lo:[1,0] neg_hi:[1,0]
v_pk_mul_f32 v[48:49], v[14:15], s[48:49] op_sel:[0,0] op_sel_hi:[0,1] neg_lo:[0,1] neg_hi:[0,0]
v_pk_fma_f32 v[14:15], v[14:15], s[48:49], v[48:49] op_sel:[1,1,0] op_sel_hi:[1,0,1] neg_lo:[0,1,0] neg_hi:[0,1,0]
v_pk_mul_f32 v[48:49], v[64:65], s[50:51] op_sel:[0,0] op_sel_hi:[0,1] neg_lo:[0,1] neg_hi:[0,0]
v_pk_fma_f32 v[64:65], v[64:65], s[50:51], v[48:49] op_sel:[1,1,0] op_sel_hi:[1,0,1] neg_lo:[0,1,0] neg_hi:[0,1,0]
v_pk_mul_f32 v[48:49], v[40:41], s[52:53] op_sel:[0,0] op_sel_hi:[0,1] neg_lo:[0,1] neg_hi:[0,0]
v_pk_fma_f32 v[40:41], v[40:41], s[52:53], v[48:49] op_sel:[1,1,0] op_sel_hi:[1,0,1] neg_lo:[0,1,0] neg_hi:[0,1,0]
v_pk_mul_f32 v[48:49], v[72:73], s[54:55] op_sel:[0,0] op_sel_hi:[0,1] neg_lo:[0,1] neg_hi:[0,0]
v_pk_fma_f32 v[72:73], v[72:73], s[54:55], v[48:49] op_sel:[1,1,0] op_sel_hi:[1,0,1] neg_lo:[0,1,0] neg_hi:[0,1,0]
v_pk_mul_f32 v[48:49], v[44:45], s[56:57] op_sel:[0,0] op_sel_hi:[0,1] neg_lo:[0,1] neg_hi:[0,0]
v_pk_fma_f32 v[44:45], v[44:45], s[56:57], v[48:49] op_sel:[1,1,0] op_sel_hi:[1,0,1] neg_lo:[0,1,0] neg_hi:[0,1,0]
v_pk_mul_f32 v[48:49], v[28:29], s[58:59] op_sel:[0,0] op_sel_hi:[0,1] neg_lo:[0,1] neg_hi:[0,0]
v_pk_fma_f32 v[28:29], v[28:29], s[58:59], v[48:49] op_sel:[1,1,0] op_sel_hi:[1,0,1] neg_lo:[0,1,0] neg_hi:[0,1,0]
v_pk_mul_f32 v[48:49], v[60:61], s[60:61] op_sel:[0,0] op_sel_hi:[0,1] neg_lo:[0,1] neg_hi:[0,0]
v_pk_fma_f32 v[60:61], v[60:61], s[60:61], v[48:49] op_sel:[1,1,0] op_sel_hi:[1,0,1] neg_lo:[0,1,0] neg_hi:[0,1,0]
v_pk_mul_f32 v[48:49], v[76:77], s[62:63] op_sel:[0,0] op_sel_hi:[0,1] neg_lo:[0,1] neg_hi:[0,0]
v_pk_fma_f32 v[76:77], v[76:77], s[62:63], v[48:49] op_sel:[1,1,0] op_sel_hi:[1,0,1] neg_lo:[0,1,0] neg_hi:[0,1,0]
v_pk_mul_f32 v[48:49], v[46:47], s[60:61] op_sel:[0,1] op_sel_hi:[0,0] neg_lo:[0,1] neg_hi:[0,0]
v_pk_fma_f32 v[46:47], v[46:47], s[60:61], v[48:49] op_sel:[1,0,0] op_sel_hi:[1,1,1] neg_lo:[0,1,0] neg_hi:[0,1,0]
v_pk_mul_f32 v[48:49], v[30:31], s[58:59] op_sel:[0,1] op_sel_hi:[0,0] neg_lo:[0,1] neg_hi:[0,0]
v_pk_fma_f32 v[30:31], v[30:31], s[58:59], v[48:49] op_sel:[1,0,0] op_sel_hi:[1,1,1] neg_lo:[0,1,0] neg_hi:[0,1,0]
v_pk_mul_f32 v[48:49], v[62:63], s[56:57] op_sel:[0,1] op_sel_hi:[0,0] neg_lo:[0,1] neg_hi:[0,0]
v_pk_fma_f32 v[62:63], v[62:63], s[56:57], v[48:49] op_sel:[1,0,0] op_sel_hi:[1,1,1] neg_lo:[0,1,0] neg_hi:[0,1,0]
v_pk_mul_f32 v[48:49], v[22:23], s[54:55] op_sel:[0,1] op_sel_hi:[0,0] neg_lo:[0,1] neg_hi:[0,0]
v_pk_fma_f32 v[22:23], v[22:23], s[54:55], v[48:49] op_sel:[1,0,0] op_sel_hi:[1,1,1] neg_lo:[0,1,0] neg_hi:[0,1,0]
v_pk_mul_f32 v[48:49], v[54:55], s[52:53] op_sel:[0,1] op_sel_hi:[0,0] neg_lo:[0,1] neg_hi:[0,0]
v_pk_fma_f32 v[54:55], v[54:55], s[52:53], v[48:49] op_sel:[1,0,0] op_sel_hi:[1,1,1] neg_lo:[0,1,0] neg_hi:[0,1,0]
v_pk_mul_f32 v[48:49], v[38:39], s[50:51] op_sel:[0,1] op_sel_hi:[0,0] neg_lo:[0,1] neg_hi:[0,0]
v_pk_fma_f32 v[38:39], v[38:39], s[50:51], v[48:49] op_sel:[1,0,0] op_sel_hi:[1,1,1] neg_lo:[0,1,0] neg_hi:[0,1,0]
v_pk_mul_f32 v[48:49], v[70:71], s[48:49] op_sel:[0,1] op_sel_hi:[0,0] neg_lo:[0,1] neg_hi:[0,0]
v_pk_fma_f32 v[70:71], v[70:71], s[48:49], v[48:49] op_sel:[1,0,0] op_sel_hi:[1,1,1] neg_lo:[0,1,0] neg_hi:[0,1,0]
v_pk_add_f32 v[78:79], v[78:79], 0 op_sel:[1,0] op_sel_hi:[0,0] neg_lo:[1,0] neg_hi:[0,0]
v_pk_mul_f32 v[48:49], v[32:33], s[48:49] op_sel:[0,1] op_sel_hi:[0,0] neg_lo:[0,0] neg_hi:[0,0]
v_pk_fma_f32 v[32:33], v[32:33], s[48:49], v[48:49] op_sel:[1,0,0] op_sel_hi:[1,1,1] neg_lo:[0,1,0] neg_hi:[0,0,0]
v_pk_mul_f32 v[48:49], v[24:25], s[50:51] op_sel:[0,1] op_sel_hi:[0,0] neg_lo:[0,0] neg_hi:[0,0]
v_pk_fma_f32 v[24:25], v[24:25], s[50:51], v[48:49] op_sel:[1,0,0] op_sel_hi:[1,1,1] neg_lo:[0,1,0] neg_hi:[0,0,0]
v_pk_mul_f32 v[48:49], v[56:57], s[52:53] op_sel:[0,1] op_sel_hi:[0,0] neg_lo:[0,0] neg_hi:[0,0]
v_pk_fma_f32 v[56:57], v[56:57], s[52:53], v[48:49] op_sel:[1,0,0] op_sel_hi:[1,1,1] neg_lo:[0,1,0] neg_hi:[0,0,0]
v_pk_mul_f32 v[48:49], v[20:21], s[54:55] op_sel:[0,1] op_sel_hi:[0,0] neg_lo:[0,0] neg_hi:[0,0]
v_pk_fma_f32 v[20:21], v[20:21], s[54:55], v[48:49] op_sel:[1,0,0] op_sel_hi:[1,1,1] neg_lo:[0,1,0] neg_hi:[0,0,0]
v_pk_mul_f32 v[48:49], v[52:53], s[56:57] op_sel:[0,1] op_sel_hi:[0,0] neg_lo:[0,0] neg_hi:[0,0]
v_pk_fma_f32 v[52:53], v[52:53], s[56:57], v[48:49] op_sel:[1,0,0] op_sel_hi:[1,1,1] neg_lo:[0,1,0] neg_hi:[0,0,0]
v_pk_mul_f32 v[48:49], v[36:37], s[58:59] op_sel:[0,1] op_sel_hi:[0,0] neg_lo:[0,0] neg_hi:[0,0]
v_pk_fma_f32 v[36:37], v[36:37], s[58:59], v[48:49] op_sel:[1,0,0] op_sel_hi:[1,1,1] neg_lo:[0,1,0] neg_hi:[0,0,0]
v_pk_mul_f32 v[48:49], v[68:69], s[60:61] op_sel:[0,1] op_sel_hi:[0,0] neg_lo:[0,0] neg_hi:[0,0]
v_pk_fma_f32 v[68:69], v[68:69], s[60:61], v[48:49] op_sel:[1,0,0] op_sel_hi:[1,1,1] neg_lo:[0,1,0] neg_hi:[0,0,0]
v_pk_mul_f32 v[48:49], v[18:19], s[62:63] op_sel:[0,0] op_sel_hi:[0,1] neg_lo:[0,0] neg_hi:[0,0]
v_pk_fma_f32 v[18:19], v[18:19], s[62:63], v[48:49] op_sel:[1,1,0] op_sel_hi:[1,0,1] neg_lo:[0,1,0] neg_hi:[0,0,0]
v_pk_mul_f32 v[48:49], v[50:51], s[60:61] op_sel:[0,0] op_sel_hi:[0,1] neg_lo:[0,0] neg_hi:[0,0]
v_pk_fma_f32 v[50:51], v[50:51], s[60:61], v[48:49] op_sel:[1,1,0] op_sel_hi:[1,0,1] neg_lo:[0,1,0] neg_hi:[0,0,0]
v_pk_mul_f32 v[48:49], v[34:35], s[58:59] op_sel:[0,0] op_sel_hi:[0,1] neg_lo:[0,0] neg_hi:[0,0]
v_pk_fma_f32 v[34:35], v[34:35], s[58:59], v[48:49] op_sel:[1,1,0] op_sel_hi:[1,0,1] neg_lo:[0,1,0] neg_hi:[0,0,0]
v_pk_mul_f32 v[48:49], v[66:67], s[56:57] op_sel:[0,0] op_sel_hi:[0,1] neg_lo:[0,0] neg_hi:[0,0]
v_pk_fma_f32 v[66:67], v[66:67], s[56:57], v[48:49] op_sel:[1,1,0] op_sel_hi:[1,0,1] neg_lo:[0,1,0] neg_hi:[0,0,0]
v_pk_mul_f32 v[48:49], v[26:27], s[54:55] op_sel:[0,0] op_sel_hi:[0,1] neg_lo:[0,0] neg_hi:[0,0]
v_pk_fma_f32 v[26:27], v[26:27], s[54:55], v[48:49] op_sel:[1,1,0] op_sel_hi:[1,0,1] neg_lo:[0,1,0] neg_hi:[0,0,0]
v_pk_mul_f32 v[48:49], v[58:59], s[52:53] op_sel:[0,0] op_sel_hi:[0,1] neg_lo:[0,0] neg_hi:[0,0]
v_pk_fma_f32 v[58:59], v[58:59], s[52:53], v[48:49] op_sel:[1,1,0] op_sel_hi:[1,0,1] neg_lo:[0,1,0] neg_hi:[0,0,0]
v_pk_mul_f32 v[48:49], v[42:43], s[50:51] op_sel:[0,0] op_sel_hi:[0,1] neg_lo:[0,0] neg_hi:[0,0]
v_pk_fma_f32 v[42:43], v[42:43], s[50:51], v[48:49] op_sel:[1,1,0] op_sel_hi:[1,0,1] neg_lo:[0,1,0] neg_hi:[0,0,0]
v_pk_mul_f32 v[48:49], v[74:75], s[48:49] op_sel:[0,0] op_sel_hi:[0,1] neg_lo:[0,0] neg_hi:[0,0]
v_pk_fma_f32 v[74:75], v[74:75], s[48:49], v[48:49] op_sel:[1,1,0] op_sel_hi:[1,0,1] neg_lo:[0,1,0] neg_hi:[0,0,0]
s_mov_b64 exec, -1
v_fmac_f32_dpp v16, v16, v9 quad_perm:[1,0,3,2] row_mask:0xf bank_mask:0xf
v_fmac_f32_dpp v17, v17, v9 quad_perm:[1,0,3,2] row_mask:0xf bank_mask:0xf
v_fmac_f32_dpp v14, v14, v9 quad_perm:[1,0,3,2] row_mask:0xf bank_mask:0xf
v_fmac_f32_dpp v15, v15, v9 quad_perm:[1,0,3,2] row_mask:0xf bank_mask:0xf
v_fmac_f32_dpp v64, v64, v9 quad_perm:[1,0,3,2] row_mask:0xf bank_mask:0xf
v_fmac_f32_dpp v65, v65, v9 quad_perm:[1,0,3,2] row_mask:0xf bank_mask:0xf
v_fmac_f32_dpp v40, v40, v9 quad_perm:[1,0,3,2] row_mask:0xf bank_mask:0xf
v_fmac_f32_dpp v41, v41, v9 quad_perm:[1,0,3,2] row_mask:0xf bank_mask:0xf
v_fmac_f32_dpp v72, v72, v9 quad_perm:[1,0,3,2] row_mask:0xf bank_mask:0xf
v_fmac_f32_dpp v73, v73, v9 quad_perm:[1,0,3,2] row_mask:0xf bank_mask:0xf
v_fmac_f32_dpp v44, v44, v9 quad_perm:[1,0,3,2] row_mask:0xf bank_mask:0xf
v_fmac_f32_dpp v45, v45, v9 quad_perm:[1,0,3,2] row_mask:0xf bank_mask:0xf
v_fmac_f32_dpp v28, v28, v9 quad_perm:[1,0,3,2] row_mask:0xf bank_mask:0xf
v_fmac_f32_dpp v29, v29, v9 quad_perm:[1,0,3,2] row_mask:0xf bank_mask:0xf
v_fmac_f32_dpp v60, v60, v9 quad_perm:[1,0,3,2] row_mask:0xf bank_mask:0xf
v_fmac_f32_dpp v61, v61, v9 quad_perm:[1,0,3,2] row_mask:0xf bank_mask:0xf
v_fmac_f32_dpp v76, v76, v9 quad_perm:[1,0,3,2] row_mask:0xf bank_mask:0xf
v_fmac_f32_dpp v77, v77, v9 quad_perm:[1,0,3,2] row_mask:0xf bank_mask:0xf
v_fmac_f32_dpp v46, v46, v9 quad_perm:[1,0,3,2] row_mask:0xf bank_mask:0xf
v_fmac_f32_dpp v47, v47, v9 quad_perm:[1,0,3,2] row_mask:0xf bank_mask:0xf
v_fmac_f32_dpp v30, v30, v9 quad_perm:[1,0,3,2] row_mask:0xf bank_mask:0xf
v_fmac_f32_dpp v31, v31, v9 quad_perm:[1,0,3,2] row_mask:0xf bank_mask:0xf
v_fmac_f32_dpp v62, v62, v9 quad_perm:[1,0,3,2] row_mask:0xf bank_mask:0xf
v_fmac_f32_dpp v63, v63, v9 quad_perm:[1,0,3,2] row_mask:0xf bank_mask:0xf
v_fmac_f32_dpp v22, v22, v9 quad_perm:[1,0,3,2] row_mask:0xf bank_mask:0xf
v_fmac_f32_dpp v23, v23, v9 quad_perm:[1,0,3,2] row_mask:0xf bank_mask:0xf
v_fmac_f32_dpp v54, v54, v9 quad_perm:[1,0,3,2] row_mask:0xf bank_mask:0xf
v_fmac_f32_dpp v55, v55, v9 quad_perm:[1,0,3,2] row_mask:0xf bank_mask:0xf
v_fmac_f32_dpp v38, v38, v9 quad_perm:[1,0,3,2] row_mask:0xf bank_mask:0xf
v_fmac_f32_dpp v39, v39, v9 quad_perm:[1,0,3,2] row_mask:0xf bank_mask:0xf
v_fmac_f32_dpp v70, v70, v9 quad_perm:[1,0,3,2] row_mask:0xf bank_mask:0xf
v_fmac_f32_dpp v71, v71, v9 quad_perm:[1,0,3,2] row_mask:0xf bank_mask:0xf
v_fmac_f32_dpp v78, v78, v9 quad_perm:[1,0,3,2] row_mask:0xf bank_mask:0xf
v_fmac_f32_dpp v79, v79, v9 quad_perm:[1,0,3,2] row_mask:0xf bank_mask:0xf
v_fmac_f32_dpp v32, v32, v9 quad_perm:[1,0,3,2] row_mask:0xf bank_mask:0xf
v_fmac_f32_dpp v33, v33, v9 quad_perm:[1,0,3,2] row_mask:0xf bank_mask:0xf
v_fmac_f32_dpp v24, v24, v9 quad_perm:[1,0,3,2] row_mask:0xf bank_mask:0xf
v_fmac_f32_dpp v25, v25, v9 quad_perm:[1,0,3,2] row_mask:0xf bank_mask:0xf
v_fmac_f32_dpp v56, v56, v9 quad_perm:[1,0,3,2] row_mask:0xf bank_mask:0xf
v_fmac_f32_dpp v57, v57, v9 quad_perm:[1,0,3,2] row_mask:0xf bank_mask:0xf
v_fmac_f32_dpp v20, v20, v9 quad_perm:[1,0,3,2] row_mask:0xf bank_mask:0xf
v_fmac_f32_dpp v21, v21, v9 quad_perm:[1,0,3,2] row_mask:0xf bank_mask:0xf
v_fmac_f32_dpp v52, v52, v9 quad_perm:[1,0,3,2] row_mask:0xf bank_mask:0xf
v_fmac_f32_dpp v53, v53, v9 quad_perm:[1,0,3,2] row_mask:0xf bank_mask:0xf
v_fmac_f32_dpp v36, v36, v9 quad_perm:[1,0,3,2] row_mask:0xf bank_mask:0xf
v_fmac_f32_dpp v37, v37, v9 quad_perm:[1,0,3,2] row_mask:0xf bank_mask:0xf
v_fmac_f32_dpp v68, v68, v9 quad_perm:[1,0,3,2] row_mask:0xf bank_mask:0xf
v_fmac_f32_dpp v69, v69, v9 quad_perm:[1,0,3,2] row_mask:0xf bank_mask:0xf
v_fmac_f32_dpp v18, v18, v9 quad_perm:[1,0,3,2] row_mask:0xf bank_mask:0xf
v_fmac_f32_dpp v19, v19, v9 quad_perm:[1,0,3,2] row_mask:0xf bank_mask:0xf
v_fmac_f32_dpp v50, v50, v9 quad_perm:[1,0,3,2] row_mask:0xf bank_mask:0xf
v_fmac_f32_dpp v51, v51, v9 quad_perm:[1,0,3,2] row_mask:0xf bank_mask:0xf
v_fmac_f32_dpp v34, v34, v9 quad_perm:[1,0,3,2] row_mask:0xf bank_mask:0xf
v_fmac_f32_dpp v35, v35, v9 quad_perm:[1,0,3,2] row_mask:0xf bank_mask:0xf
v_fmac_f32_dpp v66, v66, v9 quad_perm:[1,0,3,2] row_mask:0xf bank_mask:0xf
v_fmac_f32_dpp v67, v67, v9 quad_perm:[1,0,3,2] row_mask:0xf bank_mask:0xf
v_fmac_f32_dpp v26, v26, v9 quad_perm:[1,0,3,2] row_mask:0xf bank_mask:0xf
v_fmac_f32_dpp v27, v27, v9 quad_perm:[1,0,3,2] row_mask:0xf bank_mask:0xf
v_fmac_f32_dpp v58, v58, v9 quad_perm:[1,0,3,2] row_mask:0xf bank_mask:0xf
v_fmac_f32_dpp v59, v59, v9 quad_perm:[1,0,3,2] row_mask:0xf bank_mask:0xf
v_fmac_f32_dpp v42, v42, v9 quad_perm:[1,0,3,2] row_mask:0xf bank_mask:0xf
v_fmac_f32_dpp v43, v43, v9 quad_perm:[1,0,3,2] row_mask:0xf bank_mask:0xf
v_fmac_f32_dpp v74, v74, v9 quad_perm:[1,0,3,2] row_mask:0xf bank_mask:0xf
v_fmac_f32_dpp v75, v75, v9 quad_perm:[1,0,3,2] row_mask:0xf bank_mask:0xf
v_lshlrev_b32 v240, 16, v208
v_and_b32 v241, 0xffff0000, v208
v_pk_mul_f32 v[48:49], v[16:17], v[240:241] op_sel:[0,0] op_sel_hi:[0,1] neg_lo:[0,0] neg_hi:[0,0]
v_pk_fma_f32 v[16:17], v[16:17], v[240:241], v[48:49] op_sel:[1,1,0] op_sel_hi:[1,0,1] neg_lo:[0,1,0] neg_hi:[0,0,0]
v_lshlrev_b32 v240, 16, v209
v_and_b32 v241, 0xffff0000, v209
v_pk_mul_f32 v[48:49], v[14:15], v[240:241] op_sel:[0,0] op_sel_hi:[0,1] neg_lo:[0,0] neg_hi:[0,0]
v_pk_fma_f32 v[14:15], v[14:15], v[240:241], v[48:49] op_sel:[1,1,0] op_sel_hi:[1,0,1] neg_lo:[0,1,0] neg_hi:[0,0,0]
v_lshlrev_b32 v240, 16, v210
v_and_b32 v241, 0xffff0000, v210
v_pk_mul_f32 v[48:49], v[64:65], v[240:241] op_sel:[0,0] op_sel_hi:[0,1] neg_lo:[0,0] neg_hi:[0,0]
v_pk_fma_f32 v[64:65], v[64:65], v[240:241], v[48:49] op_sel:[1,1,0] op_sel_hi:[1,0,1] neg_lo:[0,1,0] neg_hi:[0,0,0]
v_lshlrev_b32 v240, 16, v211
v_and_b32 v241, 0xffff0000, v211
v_pk_mul_f32 v[48:49], v[40:41], v[240:241] op_sel:[0,0] op_sel_hi:[0,1] neg_lo:[0,0] neg_hi:[0,0]
v_pk_fma_f32 v[40:41], v[40:41], v[240:241], v[48:49] op_sel:[1,1,0] op_sel_hi:[1,0,1] neg_lo:[0,1,0] neg_hi:[0,0,0]
v_lshlrev_b32 v240, 16, v212
v_and_b32 v241, 0xffff0000, v212
v_pk_mul_f32 v[48:49], v[72:73], v[240:241] op_sel:[0,0] op_sel_hi:[0,1] neg_lo:[0,0] neg_hi:[0,0]
v_pk_fma_f32 v[72:73], v[72:73], v[240:241], v[48:49] op_sel:[1,1,0] op_sel_hi:[1,0,1] neg_lo:[0,1,0] neg_hi:[0,0,0]
v_lshlrev_b32 v240, 16, v213
v_and_b32 v241, 0xffff0000, v213
v_pk_mul_f32 v[48:49], v[44:45], v[240:241] op_sel:[0,0] op_sel_hi:[0,1] neg_lo:[0,0] neg_hi:[0,0]
v_pk_fma_f32 v[44:45], v[44:45], v[240:241], v[48:49] op_sel:[1,1,0] op_sel_hi:[1,0,1] neg_lo:[0,1,0] neg_hi:[0,0,0]
v_lshlrev_b32 v240, 16, v214
v_and_b32 v241, 0xffff0000, v214
v_pk_mul_f32 v[48:49], v[28:29], v[240:241] op_sel:[0,0] op_sel_hi:[0,1] neg_lo:[0,0] neg_hi:[0,0]
v_pk_fma_f32 v[28:29], v[28:29], v[240:241], v[48:49] op_sel:[1,1,0] op_sel_hi:[1,0,1] neg_lo:[0,1,0] neg_hi:[0,0,0]
v_lshlrev_b32 v240, 16, v215
v_and_b32 v241, 0xffff0000, v215
v_pk_mul_f32 v[48:49], v[60:61], v[240:241] op_sel:[0,0] op_sel_hi:[0,1] neg_lo:[0,0] neg_hi:[0,0]
v_pk_fma_f32 v[60:61], v[60:61], v[240:241], v[48:49] op_sel:[1,1,0] op_sel_hi:[1,0,1] neg_lo:[0,1,0] neg_hi:[0,0,0]
v_lshlrev_b32 v240, 16, v216
v_and_b32 v241, 0xffff0000, v216
v_pk_mul_f32 v[48:49], v[76:77], v[240:241] op_sel:[0,0] op_sel_hi:[0,1] neg_lo:[0,0] neg_hi:[0,0]
v_pk_fma_f32 v[76:77], v[76:77], v[240:241], v[48:49] op_sel:[1,1,0] op_sel_hi:[1,0,1] neg_lo:[0,1,0] neg_hi:[0,0,0]
v_lshlrev_b32 v240, 16, v217
v_and_b32 v241, 0xffff0000, v217
v_pk_mul_f32 v[48:49], v[46:47], v[240:241] op_sel:[0,0] op_sel_hi:[0,1] neg_lo:[0,0] neg_hi:[0,0]
v_pk_fma_f32 v[46:47], v[46:47], v[240:241], v[48:49] op_sel:[1,1,0] op_sel_hi:[1,0,1] neg_lo:[0,1,0] neg_hi:[0,0,0]
v_lshlrev_b32 v240, 16, v218
v_and_b32 v241, 0xffff0000, v218
v_pk_mul_f32 v[48:49], v[30:31], v[240:241] op_sel:[0,0] op_sel_hi:[0,1] neg_lo:[0,0] neg_hi:[0,0]
v_pk_fma_f32 v[30:31], v[30:31], v[240:241], v[48:49] op_sel:[1,1,0] op_sel_hi:[1,0,1] neg_lo:[0,1,0] neg_hi:[0,0,0]
v_lshlrev_b32 v240, 16, v219
v_and_b32 v241, 0xffff0000, v219
v_pk_mul_f32 v[48:49], v[62:63], v[240:241] op_sel:[0,0] op_sel_hi:[0,1] neg_lo:[0,0] neg_hi:[0,0]
v_pk_fma_f32 v[62:63], v[62:63], v[240:241], v[48:49] op_sel:[1,1,0] op_sel_hi:[1,0,1] neg_lo:[0,1,0] neg_hi:[0,0,0]
v_lshlrev_b32 v240, 16, v220
v_and_b32 v241, 0xffff0000, v220
v_pk_mul_f32 v[48:49], v[22:23], v[240:241] op_sel:[0,0] op_sel_hi:[0,1] neg_lo:[0,0] neg_hi:[0,0]
v_pk_fma_f32 v[22:23], v[22:23], v[240:241], v[48:49] op_sel:[1,1,0] op_sel_hi:[1,0,1] neg_lo:[0,1,0] neg_hi:[0,0,0]
v_lshlrev_b32 v240, 16, v221
v_and_b32 v241, 0xffff0000, v221
v_pk_mul_f32 v[48:49], v[54:55], v[240:241] op_sel:[0,0] op_sel_hi:[0,1] neg_lo:[0,0] neg_hi:[0,0]
v_pk_fma_f32 v[54:55], v[54:55], v[240:241], v[48:49] op_sel:[1,1,0] op_sel_hi:[1,0,1] neg_lo:[0,1,0] neg_hi:[0,0,0]
v_lshlrev_b32 v240, 16, v222
v_and_b32 v241, 0xffff0000, v222
v_pk_mul_f32 v[48:49], v[38:39], v[240:241] op_sel:[0,0] op_sel_hi:[0,1] neg_lo:[0,0] neg_hi:[0,0]
v_pk_fma_f32 v[38:39], v[38:39], v[240:241], v[48:49] op_sel:[1,1,0] op_sel_hi:[1,0,1] neg_lo:[0,1,0] neg_hi:[0,0,0]
v_lshlrev_b32 v240, 16, v223
v_and_b32 v241, 0xffff0000, v223
v_pk_mul_f32 v[48:49], v[70:71], v[240:241] op_sel:[0,0] op_sel_hi:[0,1] neg_lo:[0,0] neg_hi:[0,0]
v_pk_fma_f32 v[70:71], v[70:71], v[240:241], v[48:49] op_sel:[1,1,0] op_sel_hi:[1,0,1] neg_lo:[0,1,0] neg_hi:[0,0,0]
v_lshlrev_b32 v240, 16, v224
v_and_b32 v241, 0xffff0000, v224
v_pk_mul_f32 v[48:49], v[78:79], v[240:241] op_sel:[0,0] op_sel_hi:[0,1] neg_lo:[0,0] neg_hi:[0,0]
v_pk_fma_f32 v[78:79], v[78:79], v[240:241], v[48:49] op_sel:[1,1,0] op_sel_hi:[1,0,1] neg_lo:[0,1,0] neg_hi:[0,0,0]
v_lshlrev_b32 v240, 16, v225
v_and_b32 v241, 0xffff0000, v225
v_pk_mul_f32 v[48:49], v[32:33], v[240:241] op_sel:[0,0] op_sel_hi:[0,1] neg_lo:[0,0] neg_hi:[0,0]
v_pk_fma_f32 v[32:33], v[32:33], v[240:241], v[48:49] op_sel:[1,1,0] op_sel_hi:[1,0,1] neg_lo:[0,1,0] neg_hi:[0,0,0]
v_lshlrev_b32 v240, 16, v226
v_and_b32 v241, 0xffff0000, v226
v_pk_mul_f32 v[48:49], v[24:25], v[240:241] op_sel:[0,0] op_sel_hi:[0,1] neg_lo:[0,0] neg_hi:[0,0]
v_pk_fma_f32 v[24:25], v[24:25], v[240:241], v[48:49] op_sel:[1,1,0] op_sel_hi:[1,0,1] neg_lo:[0,1,0] neg_hi:[0,0,0]
v_lshlrev_b32 v240, 16, v227
v_and_b32 v241, 0xffff0000, v227
v_pk_mul_f32 v[48:49], v[56:57], v[240:241] op_sel:[0,0] op_sel_hi:[0,1] neg_lo:[0,0] neg_hi:[0,0]
v_pk_fma_f32 v[56:57], v[56:57], v[240:241], v[48:49] op_sel:[1,1,0] op_sel_hi:[1,0,1] neg_lo:[0,1,0] neg_hi:[0,0,0]
v_lshlrev_b32 v240, 16, v228
v_and_b32 v241, 0xffff0000, v228
v_pk_mul_f32 v[48:49], v[20:21], v[240:241] op_sel:[0,0] op_sel_hi:[0,1] neg_lo:[0,0] neg_hi:[0,0]
v_pk_fma_f32 v[20:21], v[20:21], v[240:241], v[48:49] op_sel:[1,1,0] op_sel_hi:[1,0,1] neg_lo:[0,1,0] neg_hi:[0,0,0]
v_lshlrev_b32 v240, 16, v229
v_and_b32 v241, 0xffff0000, v229
v_pk_mul_f32 v[48:49], v[52:53], v[240:241] op_sel:[0,0] op_sel_hi:[0,1] neg_lo:[0,0] neg_hi:[0,0]
v_pk_fma_f32 v[52:53], v[52:53], v[240:241], v[48:49] op_sel:[1,1,0] op_sel_hi:[1,0,1] neg_lo:[0,1,0] neg_hi:[0,0,0]
v_lshlrev_b32 v240, 16, v230
v_and_b32 v241, 0xffff0000, v230
v_pk_mul_f32 v[48:49], v[36:37], v[240:241] op_sel:[0,0] op_sel_hi:[0,1] neg_lo:[0,0] neg_hi:[0,0]
v_pk_fma_f32 v[36:37], v[36:37], v[240:241], v[48:49] op_sel:[1,1,0] op_sel_hi:[1,0,1] neg_lo:[0,1,0] neg_hi:[0,0,0]
v_lshlrev_b32 v240, 16, v231
v_and_b32 v241, 0xffff0000, v231
v_pk_mul_f32 v[48:49], v[68:69], v[240:241] op_sel:[0,0] op_sel_hi:[0,1] neg_lo:[0,0] neg_hi:[0,0]
v_pk_fma_f32 v[68:69], v[68:69], v[240:241], v[48:49] op_sel:[1,1,0] op_sel_hi:[1,0,1] neg_lo:[0,1,0] neg_hi:[0,0,0]
v_lshlrev_b32 v240, 16, v232
v_and_b32 v241, 0xffff0000, v232
v_pk_mul_f32 v[48:49], v[18:19], v[240:241] op_sel:[0,0] op_sel_hi:[0,1] neg_lo:[0,0] neg_hi:[0,0]
v_pk_fma_f32 v[18:19], v[18:19], v[240:241], v[48:49] op_sel:[1,1,0] op_sel_hi:[1,0,1] neg_lo:[0,1,0] neg_hi:[0,0,0]
v_lshlrev_b32 v240, 16, v233
v_and_b32 v241, 0xffff0000, v233
v_pk_mul_f32 v[48:49], v[50:51], v[240:241] op_sel:[0,0] op_sel_hi:[0,1] neg_lo:[0,0] neg_hi:[0,0]
v_pk_fma_f32 v[50:51], v[50:51], v[240:241], v[48:49] op_sel:[1,1,0] op_sel_hi:[1,0,1] neg_lo:[0,1,0] neg_hi:[0,0,0]
v_lshlrev_b32 v240, 16, v234
v_and_b32 v241, 0xffff0000, v234
v_pk_mul_f32 v[48:49], v[34:35], v[240:241] op_sel:[0,0] op_sel_hi:[0,1] neg_lo:[0,0] neg_hi:[0,0]
v_pk_fma_f32 v[34:35], v[34:35], v[240:241], v[48:49] op_sel:[1,1,0] op_sel_hi:[1,0,1] neg_lo:[0,1,0] neg_hi:[0,0,0]
v_lshlrev_b32 v240, 16, v235
v_and_b32 v241, 0xffff0000, v235
v_pk_mul_f32 v[48:49], v[66:67], v[240:241] op_sel:[0,0] op_sel_hi:[0,1] neg_lo:[0,0] neg_hi:[0,0]
v_pk_fma_f32 v[66:67], v[66:67], v[240:241], v[48:49] op_sel:[1,1,0] op_sel_hi:[1,0,1] neg_lo:[0,1,0] neg_hi:[0,0,0]
v_lshlrev_b32 v240, 16, v236
v_and_b32 v241, 0xffff0000, v236
v_pk_mul_f32 v[48:49], v[26:27], v[240:241] op_sel:[0,0] op_sel_hi:[0,1] neg_lo:[0,0] neg_hi:[0,0]
v_pk_fma_f32 v[26:27], v[26:27], v[240:241], v[48:49] op_sel:[1,1,0] op_sel_hi:[1,0,1] neg_lo:[0,1,0] neg_hi:[0,0,0]
v_lshlrev_b32 v240, 16, v237
v_and_b32 v241, 0xffff0000, v237
v_pk_mul_f32 v[48:49], v[58:59], v[240:241] op_sel:[0,0] op_sel_hi:[0,1] neg_lo:[0,0] neg_hi:[0,0]
v_pk_fma_f32 v[58:59], v[58:59], v[240:241], v[48:49] op_sel:[1,1,0] op_sel_hi:[1,0,1] neg_lo:[0,1,0] neg_hi:[0,0,0]
v_lshlrev_b32 v240, 16, v238
v_and_b32 v241, 0xffff0000, v238
v_pk_mul_f32 v[48:49], v[42:43], v[240:241] op_sel:[0,0] op_sel_hi:[0,1] neg_lo:[0,0] neg_hi:[0,0]
v_pk_fma_f32 v[42:43], v[42:43], v[240:241], v[48:49] op_sel:[1,1,0] op_sel_hi:[1,0,1] neg_lo:[0,1,0] neg_hi:[0,0,0]
v_lshlrev_b32 v240, 16, v239
v_and_b32 v241, 0xffff0000, v239
v_pk_mul_f32 v[48:49], v[74:75], v[240:241] op_sel:[0,0] op_sel_hi:[0,1] neg_lo:[0,0] neg_hi:[0,0]
v_pk_fma_f32 v[74:75], v[74:75], v[240:241], v[48:49] op_sel:[1,1,0] op_sel_hi:[1,0,1] neg_lo:[0,1,0] neg_hi:[0,0,0]
v_fmac_f32_dpp v16, v16, v7 quad_perm:[1,0,3,2] row_mask:0xf bank_mask:0xf
v_fmac_f32_dpp v17, v17, v7 quad_perm:[1,0,3,2] row_mask:0xf bank_mask:0xf
v_fmac_f32_dpp v14, v14, v7 quad_perm:[1,0,3,2] row_mask:0xf bank_mask:0xf
v_fmac_f32_dpp v15, v15, v7 quad_perm:[1,0,3,2] row_mask:0xf bank_mask:0xf
v_fmac_f32_dpp v64, v64, v7 quad_perm:[1,0,3,2] row_mask:0xf bank_mask:0xf
v_fmac_f32_dpp v65, v65, v7 quad_perm:[1,0,3,2] row_mask:0xf bank_mask:0xf
v_fmac_f32_dpp v40, v40, v7 quad_perm:[1,0,3,2] row_mask:0xf bank_mask:0xf
v_fmac_f32_dpp v41, v41, v7 quad_perm:[1,0,3,2] row_mask:0xf bank_mask:0xf
v_fmac_f32_dpp v72, v72, v7 quad_perm:[1,0,3,2] row_mask:0xf bank_mask:0xf
v_fmac_f32_dpp v73, v73, v7 quad_perm:[1,0,3,2] row_mask:0xf bank_mask:0xf
v_fmac_f32_dpp v44, v44, v7 quad_perm:[1,0,3,2] row_mask:0xf bank_mask:0xf
v_fmac_f32_dpp v45, v45, v7 quad_perm:[1,0,3,2] row_mask:0xf bank_mask:0xf
v_fmac_f32_dpp v28, v28, v7 quad_perm:[1,0,3,2] row_mask:0xf bank_mask:0xf
v_fmac_f32_dpp v29, v29, v7 quad_perm:[1,0,3,2] row_mask:0xf bank_mask:0xf
v_fmac_f32_dpp v60, v60, v7 quad_perm:[1,0,3,2] row_mask:0xf bank_mask:0xf
v_fmac_f32_dpp v61, v61, v7 quad_perm:[1,0,3,2] row_mask:0xf bank_mask:0xf
v_fmac_f32_dpp v76, v76, v7 quad_perm:[1,0,3,2] row_mask:0xf bank_mask:0xf
v_fmac_f32_dpp v77, v77, v7 quad_perm:[1,0,3,2] row_mask:0xf bank_mask:0xf
v_fmac_f32_dpp v46, v46, v7 quad_perm:[1,0,3,2] row_mask:0xf bank_mask:0xf
v_fmac_f32_dpp v47, v47, v7 quad_perm:[1,0,3,2] row_mask:0xf bank_mask:0xf
v_fmac_f32_dpp v30, v30, v7 quad_perm:[1,0,3,2] row_mask:0xf bank_mask:0xf
v_fmac_f32_dpp v31, v31, v7 quad_perm:[1,0,3,2] row_mask:0xf bank_mask:0xf
v_fmac_f32_dpp v62, v62, v7 quad_perm:[1,0,3,2] row_mask:0xf bank_mask:0xf
v_fmac_f32_dpp v63, v63, v7 quad_perm:[1,0,3,2] row_mask:0xf bank_mask:0xf
v_fmac_f32_dpp v22, v22, v7 quad_perm:[1,0,3,2] row_mask:0xf bank_mask:0xf
v_fmac_f32_dpp v23, v23, v7 quad_perm:[1,0,3,2] row_mask:0xf bank_mask:0xf
v_fmac_f32_dpp v54, v54, v7 quad_perm:[1,0,3,2] row_mask:0xf bank_mask:0xf
v_fmac_f32_dpp v55, v55, v7 quad_perm:[1,0,3,2] row_mask:0xf bank_mask:0xf
v_fmac_f32_dpp v38, v38, v7 quad_perm:[1,0,3,2] row_mask:0xf bank_mask:0xf
v_fmac_f32_dpp v39, v39, v7 quad_perm:[1,0,3,2] row_mask:0xf bank_mask:0xf
v_fmac_f32_dpp v70, v70, v7 quad_perm:[1,0,3,2] row_mask:0xf bank_mask:0xf
v_fmac_f32_dpp v71, v71, v7 quad_perm:[1,0,3,2] row_mask:0xf bank_mask:0xf
v_fmac_f32_dpp v78, v78, v7 quad_perm:[1,0,3,2] row_mask:0xf bank_mask:0xf
v_fmac_f32_dpp v79, v79, v7 quad_perm:[1,0,3,2] row_mask:0xf bank_mask:0xf
v_fmac_f32_dpp v32, v32, v7 quad_perm:[1,0,3,2] row_mask:0xf bank_mask:0xf
v_fmac_f32_dpp v33, v33, v7 quad_perm:[1,0,3,2] row_mask:0xf bank_mask:0xf
v_fmac_f32_dpp v24, v24, v7 quad_perm:[1,0,3,2] row_mask:0xf bank_mask:0xf
v_fmac_f32_dpp v25, v25, v7 quad_perm:[1,0,3,2] row_mask:0xf bank_mask:0xf
v_fmac_f32_dpp v56, v56, v7 quad_perm:[1,0,3,2] row_mask:0xf bank_mask:0xf
v_fmac_f32_dpp v57, v57, v7 quad_perm:[1,0,3,2] row_mask:0xf bank_mask:0xf
v_fmac_f32_dpp v20, v20, v7 quad_perm:[1,0,3,2] row_mask:0xf bank_mask:0xf
v_fmac_f32_dpp v21, v21, v7 quad_perm:[1,0,3,2] row_mask:0xf bank_mask:0xf
v_fmac_f32_dpp v52, v52, v7 quad_perm:[1,0,3,2] row_mask:0xf bank_mask:0xf
v_fmac_f32_dpp v53, v53, v7 quad_perm:[1,0,3,2] row_mask:0xf bank_mask:0xf
v_fmac_f32_dpp v36, v36, v7 quad_perm:[1,0,3,2] row_mask:0xf bank_mask:0xf
v_fmac_f32_dpp v37, v37, v7 quad_perm:[1,0,3,2] row_mask:0xf bank_mask:0xf
v_fmac_f32_dpp v68, v68, v7 quad_perm:[1,0,3,2] row_mask:0xf bank_mask:0xf
v_fmac_f32_dpp v69, v69, v7 quad_perm:[1,0,3,2] row_mask:0xf bank_mask:0xf
v_fmac_f32_dpp v18, v18, v7 quad_perm:[1,0,3,2] row_mask:0xf bank_mask:0xf
v_fmac_f32_dpp v19, v19, v7 quad_perm:[1,0,3,2] row_mask:0xf bank_mask:0xf
v_fmac_f32_dpp v50, v50, v7 quad_perm:[1,0,3,2] row_mask:0xf bank_mask:0xf
v_fmac_f32_dpp v51, v51, v7 quad_perm:[1,0,3,2] row_mask:0xf bank_mask:0xf
v_fmac_f32_dpp v34, v34, v7 quad_perm:[1,0,3,2] row_mask:0xf bank_mask:0xf
v_fmac_f32_dpp v35, v35, v7 quad_perm:[1,0,3,2] row_mask:0xf bank_mask:0xf
v_fmac_f32_dpp v66, v66, v7 quad_perm:[1,0,3,2] row_mask:0xf bank_mask:0xf
v_fmac_f32_dpp v67, v67, v7 quad_perm:[1,0,3,2] row_mask:0xf bank_mask:0xf
v_fmac_f32_dpp v26, v26, v7 quad_perm:[1,0,3,2] row_mask:0xf bank_mask:0xf
v_fmac_f32_dpp v27, v27, v7 quad_perm:[1,0,3,2] row_mask:0xf bank_mask:0xf
v_fmac_f32_dpp v58, v58, v7 quad_perm:[1,0,3,2] row_mask:0xf bank_mask:0xf
v_fmac_f32_dpp v59, v59, v7 quad_perm:[1,0,3,2] row_mask:0xf bank_mask:0xf
v_fmac_f32_dpp v42, v42, v7 quad_perm:[1,0,3,2] row_mask:0xf bank_mask:0xf
v_fmac_f32_dpp v43, v43, v7 quad_perm:[1,0,3,2] row_mask:0xf bank_mask:0xf
v_fmac_f32_dpp v74, v74, v7 quad_perm:[1,0,3,2] row_mask:0xf bank_mask:0xf
v_fmac_f32_dpp v75, v75, v7 quad_perm:[1,0,3,2] row_mask:0xf bank_mask:0xf
s_mov_b64 exec, s[18:19]
v_pk_add_f32 v[16:17], v[16:17], 0 neg_lo:[1,0] neg_hi:[1,0]
v_pk_mul_f32 v[48:49], v[14:15], s[48:49] op_sel:[0,0] op_sel_hi:[0,1] neg_lo:[0,1] neg_hi:[0,1]
v_pk_fma_f32 v[14:15], v[14:15], s[48:49], v[48:49] op_sel:[1,1,0] op_sel_hi:[1,0,1] neg_lo:[0,0,0] neg_hi:[0,1,0]
v_pk_mul_f32 v[48:49], v[64:65], s[50:51] op_sel:[0,0] op_sel_hi:[0,1] neg_lo:[0,1] neg_hi:[0,1]
v_pk_fma_f32 v[64:65], v[64:65], s[50:51], v[48:49] op_sel:[1,1,0] op_sel_hi:[1,0,1] neg_lo:[0,0,0] neg_hi:[0,1,0]
v_pk_mul_f32 v[48:49], v[40:41], s[52:53] op_sel:[0,0] op_sel_hi:[0,1] neg_lo:[0,1] neg_hi:[0,1]
v_pk_fma_f32 v[40:41], v[40:41], s[52:53], v[48:49] op_sel:[1,1,0] op_sel_hi:[1,0,1] neg_lo:[0,0,0] neg_hi:[0,1,0]
v_pk_mul_f32 v[48:49], v[72:73], s[54:55] op_sel:[0,0] op_sel_hi:[0,1] neg_lo:[0,1] neg_hi:[0,1]
v_pk_fma_f32 v[72:73], v[72:73], s[54:55], v[48:49] op_sel:[1,1,0] op_sel_hi:[1,0,1] neg_lo:[0,0,0] neg_hi:[0,1,0]
v_pk_mul_f32 v[48:49], v[44:45], s[56:57] op_sel:[0,0] op_sel_hi:[0,1] neg_lo:[0,1] neg_hi:[0,1]
v_pk_fma_f32 v[44:45], v[44:45], s[56:57], v[48:49] op_sel:[1,1,0] op_sel_hi:[1,0,1] neg_lo:[0,0,0] neg_hi:[0,1,0]
v_pk_mul_f32 v[48:49], v[28:29], s[58:59] op_sel:[0,0] op_sel_hi:[0,1] neg_lo:[0,1] neg_hi:[0,1]
v_pk_fma_f32 v[28:29], v[28:29], s[58:59], v[48:49] op_sel:[1,1,0] op_sel_hi:[1,0,1] neg_lo:[0,0,0] neg_hi:[0,1,0]
v_pk_mul_f32 v[48:49], v[60:61], s[60:61] op_sel:[0,0] op_sel_hi:[0,1] neg_lo:[0,1] neg_hi:[0,1]
v_pk_fma_f32 v[60:61], v[60:61], s[60:61], v[48:49] op_sel:[1,1,0] op_sel_hi:[1,0,1] neg_lo:[0,0,0] neg_hi:[0,1,0]
v_pk_mul_f32 v[48:49], v[76:77], s[62:63] op_sel:[0,0] op_sel_hi:[0,1] neg_lo:[0,1] neg_hi:[0,1]
v_pk_fma_f32 v[76:77], v[76:77], s[62:63], v[48:49] op_sel:[1,1,0] op_sel_hi:[1,0,1] neg_lo:[0,0,0] neg_hi:[0,1,0]
v_pk_mul_f32 v[48:49], v[46:47], s[60:61] op_sel:[0,1] op_sel_hi:[0,0] neg_lo:[0,1] neg_hi:[0,1]
v_pk_fma_f32 v[46:47], v[46:47], s[60:61], v[48:49] op_sel:[1,0,0] op_sel_hi:[1,1,1] neg_lo:[0,0,0] neg_hi:[0,1,0]
v_pk_mul_f32 v[48:49], v[30:31], s[58:59] op_sel:[0,1] op_sel_hi:[0,0] neg_lo:[0,1] neg_hi:[0,1]
v_pk_fma_f32 v[30:31], v[30:31], s[58:59], v[48:49] op_sel:[1,0,0] op_sel_hi:[1,1,1] neg_lo:[0,0,0] neg_hi:[0,1,0]
v_pk_mul_f32 v[48:49], v[62:63], s[56:57] op_sel:[0,1] op_sel_hi:[0,0] neg_lo:[0,1] neg_hi:[0,1]
v_pk_fma_f32 v[62:63], v[62:63], s[56:57], v[48:49] op_sel:[1,0,0] op_sel_hi:[1,1,1] neg_lo:[0,0,0] neg_hi:[0,1,0]
v_pk_mul_f32 v[48:49], v[22:23], s[54:55] op_sel:[0,1] op_sel_hi:[0,0] neg_lo:[0,1] neg_hi:[0,1]
v_pk_fma_f32 v[22:23], v[22:23], s[54:55], v[48:49] op_sel:[1,0,0] op_sel_hi:[1,1,1] neg_lo:[0,0,0] neg_hi:[0,1,0]
v_pk_mul_f32 v[48:49], v[54:55], s[52:53] op_sel:[0,1] op_sel_hi:[0,0] neg_lo:[0,1] neg_hi:[0,1]
v_pk_fma_f32 v[54:55], v[54:55], s[52:53], v[48:49] op_sel:[1,0,0] op_sel_hi:[1,1,1] neg_lo:[0,0,0] neg_hi:[0,1,0]
v_pk_mul_f32 v[48:49], v[38:39], s[50:51] op_sel:[0,1] op_sel_hi:[0,0] neg_lo:[0,1] neg_hi:[0,1]
v_pk_fma_f32 v[38:39], v[38:39], s[50:51], v[48:49] op_sel:[1,0,0] op_sel_hi:[1,1,1] neg_lo:[0,0,0] neg_hi:[0,1,0]
v_pk_mul_f32 v[48:49], v[70:71], s[48:49] op_sel:[0,1] op_sel_hi:[0,0] neg_lo:[0,1] neg_hi:[0,1]
v_pk_fma_f32 v[70:71], v[70:71], s[48:49], v[48:49] op_sel:[1,0,0] op_sel_hi:[1,1,1] neg_lo:[0,0,0] neg_hi:[0,1,0]
v_pk_add_f32 v[78:79], v[78:79], 0 op_sel:[1,0] op_sel_hi:[0,0] neg_lo:[0,0] neg_hi:[1,0]
v_pk_mul_f32 v[48:49], v[32:33], s[48:49] op_sel:[0,1] op_sel_hi:[0,0] neg_lo:[0,0] neg_hi:[0,1]
v_pk_fma_f32 v[32:33], v[32:33], s[48:49], v[48:49] op_sel:[1,0,0] op_sel_hi:[1,1,1] neg_lo:[0,0,0] neg_hi:[0,0,0]
v_pk_mul_f32 v[48:49], v[24:25], s[50:51] op_sel:[0,1] op_sel_hi:[0,0] neg_lo:[0,0] neg_hi:[0,1]
v_pk_fma_f32 v[24:25], v[24:25], s[50:51], v[48:49] op_sel:[1,0,0] op_sel_hi:[1,1,1] neg_lo:[0,0,0] neg_hi:[0,0,0]
v_pk_mul_f32 v[48:49], v[56:57], s[52:53] op_sel:[0,1] op_sel_hi:[0,0] neg_lo:[0,0] neg_hi:[0,1]
v_pk_fma_f32 v[56:57], v[56:57], s[52:53], v[48:49] op_sel:[1,0,0] op_sel_hi:[1,1,1] neg_lo:[0,0,0] neg_hi:[0,0,0]
v_pk_mul_f32 v[48:49], v[20:21], s[54:55] op_sel:[0,1] op_sel_hi:[0,0] neg_lo:[0,0] neg_hi:[0,1]
v_pk_fma_f32 v[20:21], v[20:21], s[54:55], v[48:49] op_sel:[1,0,0] op_sel_hi:[1,1,1] neg_lo:[0,0,0] neg_hi:[0,0,0]
v_pk_mul_f32 v[48:49], v[52:53], s[56:57] op_sel:[0,1] op_sel_hi:[0,0] neg_lo:[0,0] neg_hi:[0,1]
v_pk_fma_f32 v[52:53], v[52:53], s[56:57], v[48:49] op_sel:[1,0,0] op_sel_hi:[1,1,1] neg_lo:[0,0,0] neg_hi:[0,0,0]
v_pk_mul_f32 v[48:49], v[36:37], s[58:59] op_sel:[0,1] op_sel_hi:[0,0] neg_lo:[0,0] neg_hi:[0,1]
v_pk_fma_f32 v[36:37], v[36:37], s[58:59], v[48:49] op_sel:[1,0,0] op_sel_hi:[1,1,1] neg_lo:[0,0,0] neg_hi:[0,0,0]
v_pk_mul_f32 v[48:49], v[68:69], s[60:61] op_sel:[0,1] op_sel_hi:[0,0] neg_lo:[0,0] neg_hi:[0,1]
v_pk_fma_f32 v[68:69], v[68:69], s[60:61], v[48:49] op_sel:[1,0,0] op_sel_hi:[1,1,1] neg_lo:[0,0,0] neg_hi:[0,0,0]
v_pk_mul_f32 v[48:49], v[18:19], s[62:63] op_sel:[0,0] op_sel_hi:[0,1] neg_lo:[0,0] neg_hi:[0,1]
v_pk_fma_f32 v[18:19], v[18:19], s[62:63], v[48:49] op_sel:[1,1,0] op_sel_hi:[1,0,1] neg_lo:[0,0,0] neg_hi:[0,0,0]
v_pk_mul_f32 v[48:49], v[50:51], s[60:61] op_sel:[0,0] op_sel_hi:[0,1] neg_lo:[0,0] neg_hi:[0,1]
v_pk_fma_f32 v[50:51], v[50:51], s[60:61], v[48:49] op_sel:[1,1,0] op_sel_hi:[1,0,1] neg_lo:[0,0,0] neg_hi:[0,0,0]
v_pk_mul_f32 v[48:49], v[34:35], s[58:59] op_sel:[0,0] op_sel_hi:[0,1] neg_lo:[0,0] neg_hi:[0,1]
v_pk_fma_f32 v[34:35], v[34:35], s[58:59], v[48:49] op_sel:[1,1,0] op_sel_hi:[1,0,1] neg_lo:[0,0,0] neg_hi:[0,0,0]
v_pk_mul_f32 v[48:49], v[66:67], s[56:57] op_sel:[0,0] op_sel_hi:[0,1] neg_lo:[0,0] neg_hi:[0,1]
v_pk_fma_f32 v[66:67], v[66:67], s[56:57], v[48:49] op_sel:[1,1,0] op_sel_hi:[1,0,1] neg_lo:[0,0,0] neg_hi:[0,0,0]
v_pk_mul_f32 v[48:49], v[26:27], s[54:55] op_sel:[0,0] op_sel_hi:[0,1] neg_lo:[0,0] neg_hi:[0,1]
v_pk_fma_f32 v[26:27], v[26:27], s[54:55], v[48:49] op_sel:[1,1,0] op_sel_hi:[1,0,1] neg_lo:[0,0,0] neg_hi:[0,0,0]
v_pk_mul_f32 v[48:49], v[58:59], s[52:53] op_sel:[0,0] op_sel_hi:[0,1] neg_lo:[0,0] neg_hi:[0,1]
v_pk_fma_f32 v[58:59], v[58:59], s[52:53], v[48:49] op_sel:[1,1,0] op_sel_hi:[1,0,1] neg_lo:[0,0,0] neg_hi:[0,0,0]
v_pk_mul_f32 v[48:49], v[42:43], s[50:51] op_sel:[0,0] op_sel_hi:[0,1] neg_lo:[0,0] neg_hi:[0,1]
v_pk_fma_f32 v[42:43], v[42:43], s[50:51], v[48:49] op_sel:[1,1,0] op_sel_hi:[1,0,1] neg_lo:[0,0,0] neg_hi:[0,0,0]
v_pk_mul_f32 v[48:49], v[74:75], s[48:49] op_sel:[0,0] op_sel_hi:[0,1] neg_lo:[0,0] neg_hi:[0,1]
v_pk_fma_f32 v[74:75], v[74:75], s[48:49], v[48:49] op_sel:[1,1,0] op_sel_hi:[1,0,1] neg_lo:[0,0,0] neg_hi:[0,0,0]
s_mov_b64 exec, -1
v_pk_add_f32 v[48:49], v[16:17], v[78:79] neg_lo:[0,1] neg_hi:[0,1]
v_pk_add_f32 v[16:17], v[16:17], v[78:79]
v_pk_add_f32 v[78:79], v[14:15], v[32:33] neg_lo:[0,1] neg_hi:[0,1]
v_pk_add_f32 v[14:15], v[14:15], v[32:33]
v_pk_mul_f32 v[32:33], v[78:79], s[50:51] op_sel:[0,0] op_sel_hi:[0,1] neg_lo:[0,0] neg_hi:[0,0]
v_pk_fma_f32 v[32:33], v[78:79], s[50:51], v[32:33] op_sel:[1,1,0] op_sel_hi:[1,0,1] neg_lo:[0,1,0] neg_hi:[0,0,0]
v_pk_add_f32 v[78:79], v[64:65], v[24:25] neg_lo:[0,1] neg_hi:[0,1]
v_pk_add_f32 v[64:65], v[64:65], v[24:25]
v_pk_mul_f32 v[24:25], v[78:79], s[54:55] op_sel:[0,0] op_sel_hi:[0,1] neg_lo:[0,0] neg_hi:[0,0]
v_pk_fma_f32 v[24:25], v[78:79], s[54:55], v[24:25] op_sel:[1,1,0] op_sel_hi:[1,0,1] neg_lo:[0,1,0] neg_hi:[0,0,0]
v_pk_add_f32 v[78:79], v[40:41], v[56:57] neg_lo:[0,1] neg_hi:[0,1]
v_pk_add_f32 v[40:41], v[40:41], v[56:57]
v_pk_mul_f32 v[56:57], v[78:79], s[58:59] op_sel:[0,0] op_sel_hi:[0,1] neg_lo:[0,0] neg_hi:[0,0]
v_pk_fma_f32 v[56:57], v[78:79], s[58:59], v[56:57] op_sel:[1,1,0] op_sel_hi:[1,0,1] neg_lo:[0,1,0] neg_hi:[0,0,0]
v_pk_add_f32 v[78:79], v[72:73], v[20:21] neg_lo:[0,1] neg_hi:[0,1]
v_pk_add_f32 v[72:73], v[72:73], v[20:21]
v_pk_mul_f32 v[20:21], v[78:79], s[62:63] op_sel:[0,0] op_sel_hi:[0,1] neg_lo:[0,0] neg_hi:[0,0]
v_pk_fma_f32 v[20:21], v[78:79], s[62:63], v[20:21] op_sel:[1,1,0] op_sel_hi:[1,0,1] neg_lo:[0,1,0] neg_hi:[0,0,0]
v_pk_add_f32 v[78:79], v[44:45], v[52:53] neg_lo:[0,1] neg_hi:[0,1]
v_pk_add_f32 v[44:45], v[44:45], v[52:53]
v_pk_mul_f32 v[52:53], v[78:79], s[58:59] op_sel:[0,1] op_sel_hi:[0,0] neg_lo:[0,0] neg_hi:[0,0]
v_pk_fma_f32 v[52:53], v[78:79], s[58:59], v[52:53] op_sel:[1,0,0] op_sel_hi:[1,1,1] neg_lo:[0,1,0] neg_hi:[0,0,0]
v_pk_add_f32 v[78:79], v[28:29], v[36:37] neg_lo:[0,1] neg_hi:[0,1]
v_pk_add_f32 v[28:29], v[28:29], v[36:37]
v_pk_mul_f32 v[36:37], v[78:79], s[54:55] op_sel:[0,1] op_sel_hi:[0,0] neg_lo:[0,0] neg_hi:[0,0]
v_pk_fma_f32 v[36:37], v[78:79], s[54:55], v[36:37] op_sel:[1,0,0] op_sel_hi:[1,1,1] neg_lo:[0,1,0] neg_hi:[0,0,0]
v_pk_add_f32 v[78:79], v[60:61], v[68:69] neg_lo:[0,1] neg_hi:[0,1]
v_pk_add_f32 v[60:61], v[60:61], v[68:69]
v_pk_mul_f32 v[68:69], v[78:79], s[50:51] op_sel:[0,1] op_sel_hi:[0,0] neg_lo:[0,0] neg_hi:[0,0]
v_pk_fma_f32 v[68:69], v[78:79], s[50:51], v[68:69] op_sel:[1,0,0] op_sel_hi:[1,1,1] neg_lo:[0,1,0] neg_hi:[0,0,0]
v_pk_add_f32 v[78:79], v[76:77], v[18:19] op_sel:[1,1] op_sel_hi:[0,0] neg_lo:[1,0] neg_hi:[0,1]
v_pk_add_f32 v[76:77], v[76:77], v[18:19]
v_pk_add_f32 v[18:19], v[46:47], v[50:51] neg_lo:[0,1] neg_hi:[0,1]
v_pk_add_f32 v[46:47], v[46:47], v[50:51]
v_pk_mul_f32 v[50:51], v[18:19], s[50:51] op_sel:[0,1] op_sel_hi:[0,0] neg_lo:[0,1] neg_hi:[0,0]
v_pk_fma_f32 v[50:51], v[18:19], s[50:51], v[50:51] op_sel:[1,0,0] op_sel_hi:[1,1,1] neg_lo:[0,1,0] neg_hi:[0,1,0]
v_pk_add_f32 v[18:19], v[30:31], v[34:35] neg_lo:[0,1] neg_hi:[0,1]
v_pk_add_f32 v[30:31], v[30:31], v[34:35]
v_pk_mul_f32 v[34:35], v[18:19], s[54:55] op_sel:[0,1] op_sel_hi:[0,0] neg_lo:[0,1] neg_hi:[0,0]
v_pk_fma_f32 v[34:35], v[18:19], s[54:55], v[34:35] op_sel:[1,0,0] op_sel_hi:[1,1,1] neg_lo:[0,1,0] neg_hi:[0,1,0]
v_pk_add_f32 v[18:19], v[62:63], v[66:67] neg_lo:[0,1] neg_hi:[0,1]
v_pk_add_f32 v[62:63], v[62:63], v[66:67]
v_pk_mul_f32 v[66:67], v[18:19], s[58:59] op_sel:[0,1] op_sel_hi:[0,0] neg_lo:[0,1] neg_hi:[0,0]
v_pk_fma_f32 v[66:67], v[18:19], s[58:59], v[66:67] op_sel:[1,0,0] op_sel_hi:[1,1,1] neg_lo:[0,1,0] neg_hi:[0,1,0]
v_pk_add_f32 v[18:19], v[22:23], v[26:27] neg_lo:[0,1] neg_hi:[0,1]
v_pk_add_f32 v[22:23], v[22:23], v[26:27]
v_pk_mul_f32 v[26:27], v[18:19], s[62:63] op_sel:[0,0] op_sel_hi:[0,1] neg_lo:[0,1] neg_hi:[0,0]
v_pk_fma_f32 v[26:27], v[18:19], s[62:63], v[26:27] op_sel:[1,1,0] op_sel_hi:[1,0,1] neg_lo:[0,1,0] neg_hi:[0,1,0]
v_pk_add_f32 v[18:19], v[54:55], v[58:59] neg_lo:[0,1] neg_hi:[0,1]
v_pk_add_f32 v[54:55], v[54:55], v[58:59]
v_pk_mul_f32 v[58:59], v[18:19], s[58:59] op_sel:[0,0] op_sel_hi:[0,1] neg_lo:[0,1] neg_hi:[0,0]
v_pk_fma_f32 v[58:59], v[18:19], s[58:59], v[58:59] op_sel:[1,1,0] op_sel_hi:[1,0,1] neg_lo:[0,1,0] neg_hi:[0,1,0]
v_pk_add_f32 v[18:19], v[38:39], v[42:43] neg_lo:[0,1] neg_hi:[0,1]
v_pk_add_f32 v[38:39], v[38:39], v[42:43]
v_pk_mul_f32 v[42:43], v[18:19], s[54:55] op_sel:[0,0] op_sel_hi:[0,1] neg_lo:[0,1] neg_hi:[0,0]
v_pk_fma_f32 v[42:43], v[18:19], s[54:55], v[42:43] op_sel:[1,1,0] op_sel_hi:[1,0,1] neg_lo:[0,1,0] neg_hi:[0,1,0]
v_pk_add_f32 v[18:19], v[70:71], v[74:75] neg_lo:[0,1] neg_hi:[0,1]
v_pk_add_f32 v[70:71], v[70:71], v[74:75]
v_pk_mul_f32 v[74:75], v[18:19], s[50:51] op_sel:[0,0] op_sel_hi:[0,1] neg_lo:[0,1] neg_hi:[0,0]
v_pk_fma_f32 v[74:75], v[18:19], s[50:51], v[74:75] op_sel:[1,1,0] op_sel_hi:[1,0,1] neg_lo:[0,1,0] neg_hi:[0,1,0]
v_pk_add_f32 v[18:19], v[16:17], v[76:77] neg_lo:[0,1] neg_hi:[0,1]
v_pk_add_f32 v[16:17], v[16:17], v[76:77]
v_pk_add_f32 v[76:77], v[14:15], v[46:47] neg_lo:[0,1] neg_hi:[0,1]
v_pk_add_f32 v[14:15], v[14:15], v[46:47]
v_pk_mul_f32 v[46:47], v[76:77], s[54:55] op_sel:[0,0] op_sel_hi:[0,1] neg_lo:[0,0] neg_hi:[0,0]
v_pk_fma_f32 v[46:47], v[76:77], s[54:55], v[46:47] op_sel:[1,1,0] op_sel_hi:[1,0,1] neg_lo:[0,1,0] neg_hi:[0,0,0]
v_pk_add_f32 v[76:77], v[64:65], v[30:31] neg_lo:[0,1] neg_hi:[0,1]
v_pk_add_f32 v[64:65], v[64:65], v[30:31]
v_pk_mul_f32 v[30:31], v[76:77], s[62:63] op_sel:[0,0] op_sel_hi:[0,1] neg_lo:[0,0] neg_hi:[0,0]
v_pk_fma_f32 v[30:31], v[76:77], s[62:63], v[30:31] op_sel:[1,1,0] op_sel_hi:[1,0,1] neg_lo:[0,1,0] neg_hi:[0,0,0]
v_pk_add_f32 v[76:77], v[40:41], v[62:63] neg_lo:[0,1] neg_hi:[0,1]
v_pk_add_f32 v[40:41], v[40:41], v[62:63]
v_pk_mul_f32 v[62:63], v[76:77], s[54:55] op_sel:[0,1] op_sel_hi:[0,0] neg_lo:[0,0] neg_hi:[0,0]
v_pk_fma_f32 v[62:63], v[76:77], s[54:55], v[62:63] op_sel:[1,0,0] op_sel_hi:[1,1,1] neg_lo:[0,1,0] neg_hi:[0,0,0]
v_pk_add_f32 v[76:77], v[72:73], v[22:23] op_sel:[1,1] op_sel_hi:[0,0] neg_lo:[1,0] neg_hi:[0,1]
v_pk_add_f32 v[72:73], v[72:73], v[22:23]
v_pk_add_f32 v[22:23], v[44:45], v[54:55] neg_lo:[0,1] neg_hi:[0,1]
v_pk_add_f32 v[44:45], v[44:45], v[54:55]
v_pk_mul_f32 v[54:55], v[22:23], s[54:55] op_sel:[0,1] op_sel_hi:[0,0] neg_lo:[0,1] neg_hi:[0,0]
v_pk_fma_f32 v[54:55], v[22:23], s[54:55], v[54:55] op_sel:[1,0,0] op_sel_hi:[1,1,1] neg_lo:[0,1,0] neg_hi:[0,1,0]
v_pk_add_f32 v[22:23], v[28:29], v[38:39] neg_lo:[0,1] neg_hi:[0,1]
v_pk_add_f32 v[28:29], v[28:29], v[38:39]
v_pk_mul_f32 v[38:39], v[22:23], s[62:63] op_sel:[0,0] op_sel_hi:[0,1] neg_lo:[0,1] neg_hi:[0,0]
v_pk_fma_f32 v[38:39], v[22:23], s[62:63], v[38:39] op_sel:[1,1,0] op_sel_hi:[1,0,1] neg_lo:[0,1,0] neg_hi:[0,1,0]
v_pk_add_f32 v[22:23], v[60:61], v[70:71] neg_lo:[0,1] neg_hi:[0,1]
v_pk_add_f32 v[60:61], v[60:61], v[70:71]
v_pk_mul_f32 v[70:71], v[22:23], s[54:55] op_sel:[0,0] op_sel_hi:[0,1] neg_lo:[0,1] neg_hi:[0,0]
v_pk_fma_f32 v[70:71], v[22:23], s[54:55], v[70:71] op_sel:[1,1,0] op_sel_hi:[1,0,1] neg_lo:[0,1,0] neg_hi:[0,1,0]
v_pk_add_f32 v[22:23], v[48:49], v[78:79] neg_lo:[0,1] neg_hi:[0,1]
v_pk_add_f32 v[48:49], v[48:49], v[78:79]
v_pk_add_f32 v[78:79], v[32:33], v[50:51] neg_lo:[0,1] neg_hi:[0,1]
v_pk_add_f32 v[32:33], v[32:33], v[50:51]
v_pk_mul_f32 v[50:51], v[78:79], s[54:55] op_sel:[0,0] op_sel_hi:[0,1] neg_lo:[0,0] neg_hi:[0,0]
v_pk_fma_f32 v[50:51], v[78:79], s[54:55], v[50:51] op_sel:[1,1,0] op_sel_hi:[1,0,1] neg_lo:[0,1,0] neg_hi:[0,0,0]
v_pk_add_f32 v[78:79], v[24:25], v[34:35] neg_lo:[0,1] neg_hi:[0,1]
v_pk_add_f32 v[24:25], v[24:25], v[34:35]
v_pk_mul_f32 v[34:35], v[78:79], s[62:63] op_sel:[0,0] op_sel_hi:[0,1] neg_lo:[0,0] neg_hi:[0,0]
v_pk_fma_f32 v[34:35], v[78:79], s[62:63], v[34:35] op_sel:[1,1,0] op_sel_hi:[1,0,1] neg_lo:[0,1,0] neg_hi:[0,0,0]
v_pk_add_f32 v[78:79], v[56:57], v[66:67] neg_lo:[0,1] neg_hi:[0,1]
v_pk_add_f32 v[56:57], v[56:57], v[66:67]
v_pk_mul_f32 v[66:67], v[78:79], s[54:55] op_sel:[0,1] op_sel_hi:[0,0] neg_lo:[0,0] neg_hi:[0,0]
v_pk_fma_f32 v[66:67], v[78:79], s[54:55], v[66:67] op_sel:[1,0,0] op_sel_hi:[1,1,1] neg_lo:[0,1,0] neg_hi:[0,0,0]
v_pk_add_f32 v[78:79], v[20:21], v[26:27] op_sel:[1,1] op_sel_hi:[0,0] neg_lo:[1,0] neg_hi:[0,1]
v_pk_add_f32 v[20:21], v[20:21], v[26:27]
v_pk_add_f32 v[26:27], v[52:53], v[58:59] neg_lo:[0,1] neg_hi:[0,1]
v_pk_add_f32 v[52:53], v[52:53], v[58:59]
v_pk_mul_f32 v[58:59], v[26:27], s[54:55] op_sel:[0,1] op_sel_hi:[0,0] neg_lo:[0,1] neg_hi:[0,0]
v_pk_fma_f32 v[58:59], v[26:27], s[54:55], v[58:59] op_sel:[1,0,0] op_sel_hi:[1,1,1] neg_lo:[0,1,0] neg_hi:[0,1,0]
v_pk_add_f32 v[26:27], v[36:37], v[42:43] neg_lo:[0,1] neg_hi:[0,1]
v_pk_add_f32 v[36:37], v[36:37], v[42:43]
v_pk_mul_f32 v[42:43], v[26:27], s[62:63] op_sel:[0,0] op_sel_hi:[0,1] neg_lo:[0,1] neg_hi:[0,0]
v_pk_fma_f32 v[42:43], v[26:27], s[62:63], v[42:43] op_sel:[1,1,0] op_sel_hi:[1,0,1] neg_lo:[0,1,0] neg_hi:[0,1,0]
v_pk_add_f32 v[26:27], v[68:69], v[74:75] neg_lo:[0,1] neg_hi:[0,1]
v_pk_add_f32 v[68:69], v[68:69], v[74:75]
v_pk_mul_f32 v[74:75], v[26:27], s[54:55] op_sel:[0,0] op_sel_hi:[0,1] neg_lo:[0,1] neg_hi:[0,0]
v_pk_fma_f32 v[74:75], v[26:27], s[54:55], v[74:75] op_sel:[1,1,0] op_sel_hi:[1,0,1] neg_lo:[0,1,0] neg_hi:[0,1,0]
v_pk_add_f32 v[26:27], v[16:17], v[72:73] neg_lo:[0,1] neg_hi:[0,1]
v_pk_add_f32 v[16:17], v[16:17], v[72:73]
v_pk_add_f32 v[72:73], v[14:15], v[44:45] neg_lo:[0,1] neg_hi:[0,1]
v_pk_add_f32 v[14:15], v[14:15], v[44:45]
v_pk_mul_f32 v[44:45], v[72:73], s[62:63] op_sel:[0,0] op_sel_hi:[0,1] neg_lo:[0,0] neg_hi:[0,0]
v_pk_fma_f32 v[44:45], v[72:73], s[62:63], v[44:45] op_sel:[1,1,0] op_sel_hi:[1,0,1] neg_lo:[0,1,0] neg_hi:[0,0,0]
v_pk_add_f32 v[72:73], v[64:65], v[28:29] op_sel:[1,1] op_sel_hi:[0,0] neg_lo:[1,0] neg_hi:[0,1]
v_pk_add_f32 v[64:65], v[64:65], v[28:29]
v_pk_add_f32 v[28:29], v[40:41], v[60:61] neg_lo:[0,1] neg_hi:[0,1]
v_pk_add_f32 v[40:41], v[40:41], v[60:61]
v_pk_mul_f32 v[60:61], v[28:29], s[62:63] op_sel:[0,0] op_sel_hi:[0,1] neg_lo:[0,1] neg_hi:[0,0]
v_pk_fma_f32 v[60:61], v[28:29], s[62:63], v[60:61] op_sel:[1,1,0] op_sel_hi:[1,0,1] neg_lo:[0,1,0] neg_hi:[0,1,0]
v_pk_add_f32 v[28:29], v[18:19], v[76:77] neg_lo:[0,1] neg_hi:[0,1]
v_pk_add_f32 v[18:19], v[18:19], v[76:77]
v_pk_add_f32 v[76:77], v[46:47], v[54:55] neg_lo:[0,1] neg_hi:[0,1]
v_pk_add_f32 v[46:47], v[46:47], v[54:55]
v_pk_mul_f32 v[54:55], v[76:77], s[62:63] op_sel:[0,0] op_sel_hi:[0,1] neg_lo:[0,0] neg_hi:[0,0]
v_pk_fma_f32 v[54:55], v[76:77], s[62:63], v[54:55] op_sel:[1,1,0] op_sel_hi:[1,0,1] neg_lo:[0,1,0] neg_hi:[0,0,0]
v_pk_add_f32 v[76:77], v[30:31], v[38:39] op_sel:[1,1] op_sel_hi:[0,0] neg_lo:[1,0] neg_hi:[0,1]
v_pk_add_f32 v[30:31], v[30:31], v[38:39]
v_pk_add_f32 v[38:39], v[62:63], v[70:71] neg_lo:[0,1] neg_hi:[0,1]
v_pk_add_f32 v[62:63], v[62:63], v[70:71]
v_pk_mul_f32 v[70:71], v[38:39], s[62:63] op_sel:[0,0] op_sel_hi:[0,1] neg_lo:[0,1] neg_hi:[0,0]
v_pk_fma_f32 v[70:71], v[38:39], s[62:63], v[70:71] op_sel:[1,1,0] op_sel_hi:[1,0,1] neg_lo:[0,1,0] neg_hi:[0,1,0]
v_pk_add_f32 v[38:39], v[48:49], v[20:21] neg_lo:[0,1] neg_hi:[0,1]
v_pk_add_f32 v[48:49], v[48:49], v[20:21]
v_pk_add_f32 v[20:21], v[32:33], v[52:53] neg_lo:[0,1] neg_hi:[0,1]
v_pk_add_f32 v[32:33], v[32:33], v[52:53]
v_pk_mul_f32 v[52:53], v[20:21], s[62:63] op_sel:[0,0] op_sel_hi:[0,1] neg_lo:[0,0] neg_hi:[0,0]
v_pk_fma_f32 v[52:53], v[20:21], s[62:63], v[52:53] op_sel:[1,1,0] op_sel_hi:[1,0,1] neg_lo:[0,1,0] neg_hi:[0,0,0]
v_pk_add_f32 v[20:21], v[24:25], v[36:37] op_sel:[1,1] op_sel_hi:[0,0] neg_lo:[1,0] neg_hi:[0,1]
v_pk_add_f32 v[24:25], v[24:25], v[36:37]
v_pk_add_f32 v[36:37], v[56:57], v[68:69] neg_lo:[0,1] neg_hi:[0,1]
v_pk_add_f32 v[56:57], v[56:57], v[68:69]
v_pk_mul_f32 v[68:69], v[36:37], s[62:63] op_sel:[0,0] op_sel_hi:[0,1] neg_lo:[0,1] neg_hi:[0,0]
v_pk_fma_f32 v[68:69], v[36:37], s[62:63], v[68:69] op_sel:[1,1,0] op_sel_hi:[1,0,1] neg_lo:[0,1,0] neg_hi:[0,1,0]
v_pk_add_f32 v[36:37], v[22:23], v[78:79] neg_lo:[0,1] neg_hi:[0,1]
v_pk_add_f32 v[22:23], v[22:23], v[78:79]
v_pk_add_f32 v[78:79], v[50:51], v[58:59] neg_lo:[0,1] neg_hi:[0,1]
v_pk_add_f32 v[50:51], v[50:51], v[58:59]
v_pk_mul_f32 v[58:59], v[78:79], s[62:63] op_sel:[0,0] op_sel_hi:[0,1] neg_lo:[0,0] neg_hi:[0,0]
v_pk_fma_f32 v[58:59], v[78:79], s[62:63], v[58:59] op_sel:[1,1,0] op_sel_hi:[1,0,1] neg_lo:[0,1,0] neg_hi:[0,0,0]
v_pk_add_f32 v[78:79], v[34:35], v[42:43] op_sel:[1,1] op_sel_hi:[0,0] neg_lo:[1,0] neg_hi:[0,1]
v_pk_add_f32 v[34:35], v[34:35], v[42:43]
v_pk_add_f32 v[42:43], v[66:67], v[74:75] neg_lo:[0,1] neg_hi:[0,1]
v_pk_add_f32 v[66:67], v[66:67], v[74:75]
v_pk_mul_f32 v[74:75], v[42:43], s[62:63] op_sel:[0,0] op_sel_hi:[0,1] neg_lo:[0,1] neg_hi:[0,0]
v_pk_fma_f32 v[74:75], v[42:43], s[62:63], v[74:75] op_sel:[1,1,0] op_sel_hi:[1,0,1] neg_lo:[0,1,0] neg_hi:[0,1,0]
v_pk_add_f32 v[42:43], v[16:17], v[64:65] neg_lo:[0,1] neg_hi:[0,1]
v_pk_add_f32 v[16:17], v[16:17], v[64:65]
v_pk_add_f32 v[64:65], v[14:15], v[40:41] op_sel:[1,1] op_sel_hi:[0,0] neg_lo:[1,0] neg_hi:[0,1]
v_pk_add_f32 v[14:15], v[14:15], v[40:41]
v_pk_add_f32 v[40:41], v[26:27], v[72:73] neg_lo:[0,1] neg_hi:[0,1]
v_pk_add_f32 v[26:27], v[26:27], v[72:73]
v_pk_add_f32 v[72:73], v[44:45], v[60:61] op_sel:[1,1] op_sel_hi:[0,0] neg_lo:[1,0] neg_hi:[0,1]
v_pk_add_f32 v[44:45], v[44:45], v[60:61]
v_pk_add_f32 v[60:61], v[18:19], v[30:31] neg_lo:[0,1] neg_hi:[0,1]
v_pk_add_f32 v[18:19], v[18:19], v[30:31]
v_pk_add_f32 v[30:31], v[46:47], v[62:63] op_sel:[1,1] op_sel_hi:[0,0] neg_lo:[1,0] neg_hi:[0,1]
v_pk_add_f32 v[46:47], v[46:47], v[62:63]
v_pk_add_f32 v[62:63], v[28:29], v[76:77] neg_lo:[0,1] neg_hi:[0,1]
v_pk_add_f32 v[28:29], v[28:29], v[76:77]
v_pk_add_f32 v[76:77], v[54:55], v[70:71] op_sel:[1,1] op_sel_hi:[0,0] neg_lo:[1,0] neg_hi:[0,1]
v_pk_add_f32 v[54:55], v[54:55], v[70:71]
v_pk_add_f32 v[70:71], v[48:49], v[24:25] neg_lo:[0,1] neg_hi:[0,1]
v_pk_add_f32 v[48:49], v[48:49], v[24:25]
v_pk_add_f32 v[24:25], v[32:33], v[56:57] op_sel:[1,1] op_sel_hi:[0,0] neg_lo:[1,0] neg_hi:[0,1]
v_pk_add_f32 v[32:33], v[32:33], v[56:57]
v_pk_add_f32 v[56:57], v[38:39], v[20:21] neg_lo:[0,1] neg_hi:[0,1]
v_pk_add_f32 v[38:39], v[38:39], v[20:21]
v_pk_add_f32 v[20:21], v[52:53], v[68:69] op_sel:[1,1] op_sel_hi:[0,0] neg_lo:[1,0] neg_hi:[0,1]
v_pk_add_f32 v[52:53], v[52:53], v[68:69]
v_pk_add_f32 v[68:69], v[22:23], v[34:35] neg_lo:[0,1] neg_hi:[0,1]
v_pk_add_f32 v[22:23], v[22:23], v[34:35]
v_pk_add_f32 v[34:35], v[50:51], v[66:67] op_sel:[1,1] op_sel_hi:[0,0] neg_lo:[1,0] neg_hi:[0,1]
v_pk_add_f32 v[50:51], v[50:51], v[66:67]
v_pk_add_f32 v[66:67], v[36:37], v[78:79] neg_lo:[0,1] neg_hi:[0,1]
v_pk_add_f32 v[36:37], v[36:37], v[78:79]
v_pk_add_f32 v[78:79], v[58:59], v[74:75] op_sel:[1,1] op_sel_hi:[0,0] neg_lo:[1,0] neg_hi:[0,1]
v_pk_add_f32 v[58:59], v[58:59], v[74:75]
v_pk_add_f32 v[74:75], v[16:17], v[14:15] neg_lo:[0,1] neg_hi:[0,1]
v_pk_add_f32 v[16:17], v[16:17], v[14:15]
v_pk_add_f32 v[14:15], v[42:43], v[64:65] neg_lo:[0,1] neg_hi:[0,1]
v_pk_add_f32 v[42:43], v[42:43], v[64:65]
v_pk_add_f32 v[64:65], v[26:27], v[44:45] neg_lo:[0,1] neg_hi:[0,1]
v_pk_add_f32 v[26:27], v[26:27], v[44:45]
v_pk_add_f32 v[44:45], v[40:41], v[72:73] neg_lo:[0,1] neg_hi:[0,1]
v_pk_add_f32 v[40:41], v[40:41], v[72:73]
v_pk_add_f32 v[72:73], v[18:19], v[46:47] neg_lo:[0,1] neg_hi:[0,1]
v_pk_add_f32 v[18:19], v[18:19], v[46:47]
v_pk_add_f32 v[46:47], v[60:61], v[30:31] neg_lo:[0,1] neg_hi:[0,1]
v_pk_add_f32 v[60:61], v[60:61], v[30:31]
v_pk_add_f32 v[30:31], v[28:29], v[54:55] neg_lo:[0,1] neg_hi:[0,1]
v_pk_add_f32 v[28:29], v[28:29], v[54:55]
v_pk_add_f32 v[54:55], v[62:63], v[76:77] neg_lo:[0,1] neg_hi:[0,1]
v_pk_add_f32 v[62:63], v[62:63], v[76:77]
v_pk_add_f32 v[76:77], v[48:49], v[32:33] neg_lo:[0,1] neg_hi:[0,1]
v_pk_add_f32 v[48:49], v[48:49], v[32:33]
v_pk_add_f32 v[32:33], v[70:71], v[24:25] neg_lo:[0,1] neg_hi:[0,1]
v_pk_add_f32 v[70:71], v[70:71], v[24:25]
v_pk_add_f32 v[24:25], v[38:39], v[52:53] neg_lo:[0,1] neg_hi:[0,1]
v_pk_add_f32 v[38:39], v[38:39], v[52:53]
v_pk_add_f32 v[52:53], v[56:57], v[20:21] neg_lo:[0,1] neg_hi:[0,1]
v_pk_add_f32 v[56:57], v[56:57], v[20:21]
v_pk_add_f32 v[20:21], v[22:23], v[50:51] neg_lo:[0,1] neg_hi:[0,1]
v_pk_add_f32 v[22:23], v[22:23], v[50:51]
v_pk_add_f32 v[50:51], v[68:69], v[34:35] neg_lo:[0,1] neg_hi:[0,1]
v_pk_add_f32 v[68:69], v[68:69], v[34:35]
v_pk_add_f32 v[34:35], v[36:37], v[58:59] neg_lo:[0,1] neg_hi:[0,1]
v_pk_add_f32 v[36:37], v[36:37], v[58:59]
v_pk_add_f32 v[58:59], v[66:67], v[78:79] neg_lo:[0,1] neg_hi:[0,1]
v_pk_add_f32 v[66:67], v[66:67], v[78:79]
v_pk_mul_f32 v[78:79], v[16:17], v[144:145] op_sel:[0,0] op_sel_hi:[0,1] neg_lo:[0,0] neg_hi:[0,0]
v_pk_fma_f32 v[16:17], v[16:17], v[144:145], v[78:79] op_sel:[1,1,0] op_sel_hi:[1,0,1] neg_lo:[0,1,0] neg_hi:[0,0,0]
v_pk_mul_f32 v[78:79], v[48:49], v[146:147] op_sel:[0,0] op_sel_hi:[0,1] neg_lo:[0,0] neg_hi:[0,0]
v_pk_fma_f32 v[48:49], v[48:49], v[146:147], v[78:79] op_sel:[1,1,0] op_sel_hi:[1,0,1] neg_lo:[0,1,0] neg_hi:[0,0,0]
v_pk_mul_f32 v[78:79], v[18:19], v[148:149] op_sel:[0,0] op_sel_hi:[0,1] neg_lo:[0,0] neg_hi:[0,0]
v_pk_fma_f32 v[18:19], v[18:19], v[148:149], v[78:79] op_sel:[1,1,0] op_sel_hi:[1,0,1] neg_lo:[0,1,0] neg_hi:[0,0,0]
v_pk_mul_f32 v[78:79], v[22:23], v[150:151] op_sel:[0,0] op_sel_hi:[0,1] neg_lo:[0,0] neg_hi:[0,0]
v_pk_fma_f32 v[22:23], v[22:23], v[150:151], v[78:79] op_sel:[1,1,0] op_sel_hi:[1,0,1] neg_lo:[0,1,0] neg_hi:[0,0,0]
v_pk_mul_f32 v[78:79], v[26:27], v[152:153] op_sel:[0,0] op_sel_hi:[0,1] neg_lo:[0,0] neg_hi:[0,0]
v_pk_fma_f32 v[26:27], v[26:27], v[152:153], v[78:79] op_sel:[1,1,0] op_sel_hi:[1,0,1] neg_lo:[0,1,0] neg_hi:[0,0,0]
v_pk_mul_f32 v[78:79], v[38:39], v[154:155] op_sel:[0,0] op_sel_hi:[0,1] neg_lo:[0,0] neg_hi:[0,0]
v_pk_fma_f32 v[38:39], v[38:39], v[154:155], v[78:79] op_sel:[1,1,0] op_sel_hi:[1,0,1] neg_lo:[0,1,0] neg_hi:[0,0,0]
v_pk_mul_f32 v[78:79], v[28:29], v[156:157] op_sel:[0,0] op_sel_hi:[0,1] neg_lo:[0,0] neg_hi:[0,0]
v_pk_fma_f32 v[28:29], v[28:29], v[156:157], v[78:79] op_sel:[1,1,0] op_sel_hi:[1,0,1] neg_lo:[0,1,0] neg_hi:[0,0,0]
v_pk_mul_f32 v[78:79], v[36:37], v[158:159] op_sel:[0,0] op_sel_hi:[0,1] neg_lo:[0,0] neg_hi:[0,0]
v_pk_fma_f32 v[36:37], v[36:37], v[158:159], v[78:79] op_sel:[1,1,0] op_sel_hi:[1,0,1] neg_lo:[0,1,0] neg_hi:[0,0,0]
v_pk_mul_f32 v[78:79], v[42:43], v[160:161] op_sel:[0,0] op_sel_hi:[0,1] neg_lo:[0,0] neg_hi:[0,0]
v_pk_fma_f32 v[42:43], v[42:43], v[160:161], v[78:79] op_sel:[1,1,0] op_sel_hi:[1,0,1] neg_lo:[0,1,0] neg_hi:[0,0,0]
v_pk_mul_f32 v[78:79], v[70:71], v[162:163] op_sel:[0,0] op_sel_hi:[0,1] neg_lo:[0,0] neg_hi:[0,0]
v_pk_fma_f32 v[70:71], v[70:71], v[162:163], v[78:79] op_sel:[1,1,0] op_sel_hi:[1,0,1] neg_lo:[0,1,0] neg_hi:[0,0,0]
v_pk_mul_f32 v[78:79], v[60:61], v[164:165] op_sel:[0,0] op_sel_hi:[0,1] neg_lo:[0,0] neg_hi:[0,0]
v_pk_fma_f32 v[60:61], v[60:61], v[164:165], v[78:79] op_sel:[1,1,0] op_sel_hi:[1,0,1] neg_lo:[0,1,0] neg_hi:[0,0,0]
v_pk_mul_f32 v[78:79], v[68:69], v[166:167] op_sel:[0,0] op_sel_hi:[0,1] neg_lo:[0,0] neg_hi:[0,0]
v_pk_fma_f32 v[68:69], v[68:69], v[166:167], v[78:79] op_sel:[1,1,0] op_sel_hi:[1,0,1] neg_lo:[0,1,0] neg_hi:[0,0,0]
v_pk_mul_f32 v[78:79], v[40:41], v[168:169] op_sel:[0,0] op_sel_hi:[0,1] neg_lo:[0,0] neg_hi:[0,0]
v_pk_fma_f32 v[40:41], v[40:41], v[168:169], v[78:79] op_sel:[1,1,0] op_sel_hi:[1,0,1] neg_lo:[0,1,0] neg_hi:[0,0,0]
v_pk_mul_f32 v[78:79], v[56:57], v[170:171] op_sel:[0,0] op_sel_hi:[0,1] neg_lo:[0,0] neg_hi:[0,0]
v_pk_fma_f32 v[56:57], v[56:57], v[170:171], v[78:79] op_sel:[1,1,0] op_sel_hi:[1,0,1] neg_lo:[0,1,0] neg_hi:[0,0,0]
v_pk_mul_f32 v[78:79], v[62:63], v[172:173] op_sel:[0,0] op_sel_hi:[0,1] neg_lo:[0,0] neg_hi:[0,0]
v_pk_fma_f32 v[62:63], v[62:63], v[172:173], v[78:79] op_sel:[1,1,0] op_sel_hi:[1,0,1] neg_lo:[0,1,0] neg_hi:[0,0,0]
v_pk_mul_f32 v[78:79], v[66:67], v[174:175] op_sel:[0,0] op_sel_hi:[0,1] neg_lo:[0,0] neg_hi:[0,0]
v_pk_fma_f32 v[66:67], v[66:67], v[174:175], v[78:79] op_sel:[1,1,0] op_sel_hi:[1,0,1] neg_lo:[0,1,0] neg_hi:[0,0,0]
v_pk_mul_f32 v[78:79], v[74:75], v[176:177] op_sel:[0,0] op_sel_hi:[0,1] neg_lo:[0,0] neg_hi:[0,0]
v_pk_fma_f32 v[74:75], v[74:75], v[176:177], v[78:79] op_sel:[1,1,0] op_sel_hi:[1,0,1] neg_lo:[0,1,0] neg_hi:[0,0,0]
v_pk_mul_f32 v[78:79], v[76:77], v[178:179] op_sel:[0,0] op_sel_hi:[0,1] neg_lo:[0,0] neg_hi:[0,0]
v_pk_fma_f32 v[76:77], v[76:77], v[178:179], v[78:79] op_sel:[1,1,0] op_sel_hi:[1,0,1] neg_lo:[0,1,0] neg_hi:[0,0,0]
v_pk_mul_f32 v[78:79], v[72:73], v[180:181] op_sel:[0,0] op_sel_hi:[0,1] neg_lo:[0,0] neg_hi:[0,0]
v_pk_fma_f32 v[72:73], v[72:73], v[180:181], v[78:79] op_sel:[1,1,0] op_sel_hi:[1,0,1] neg_lo:[0,1,0] neg_hi:[0,0,0]
v_pk_mul_f32 v[78:79], v[20:21], v[182:183] op_sel:[0,0] op_sel_hi:[0,1] neg_lo:[0,0] neg_hi:[0,0]
v_pk_fma_f32 v[20:21], v[20:21], v[182:183], v[78:79] op_sel:[1,1,0] op_sel_hi:[1,0,1] neg_lo:[0,1,0] neg_hi:[0,0,0]
v_pk_mul_f32 v[78:79], v[64:65], v[184:185] op_sel:[0,0] op_sel_hi:[0,1] neg_lo:[0,0] neg_hi:[0,0]
v_pk_fma_f32 v[64:65], v[64:65], v[184:185], v[78:79] op_sel:[1,1,0] op_sel_hi:[1,0,1] neg_lo:[0,1,0] neg_hi:[0,0,0]
v_pk_mul_f32 v[78:79], v[24:25], v[186:187] op_sel:[0,0] op_sel_hi:[0,1] neg_lo:[0,0] neg_hi:[0,0]
v_pk_fma_f32 v[24:25], v[24:25], v[186:187], v[78:79] op_sel:[1,1,0] op_sel_hi:[1,0,1] neg_lo:[0,1,0] neg_hi:[0,0,0]
v_pk_mul_f32 v[78:79], v[30:31], v[188:189] op_sel:[0,0] op_sel_hi:[0,1] neg_lo:[0,0] neg_hi:[0,0]
v_pk_fma_f32 v[30:31], v[30:31], v[188:189], v[78:79] op_sel:[1,1,0] op_sel_hi:[1,0,1] neg_lo:[0,1,0] neg_hi:[0,0,0]
v_pk_mul_f32 v[78:79], v[34:35], v[190:191] op_sel:[0,0] op_sel_hi:[0,1] neg_lo:[0,0] neg_hi:[0,0]
v_pk_fma_f32 v[34:35], v[34:35], v[190:191], v[78:79] op_sel:[1,1,0] op_sel_hi:[1,0,1] neg_lo:[0,1,0] neg_hi:[0,0,0]
v_pk_mul_f32 v[78:79], v[14:15], v[192:193] op_sel:[0,0] op_sel_hi:[0,1] neg_lo:[0,0] neg_hi:[0,0]
v_pk_fma_f32 v[14:15], v[14:15], v[192:193], v[78:79] op_sel:[1,1,0] op_sel_hi:[1,0,1] neg_lo:[0,1,0] neg_hi:[0,0,0]
v_pk_mul_f32 v[78:79], v[32:33], v[194:195] op_sel:[0,0] op_sel_hi:[0,1] neg_lo:[0,0] neg_hi:[0,0]
v_pk_fma_f32 v[32:33], v[32:33], v[194:195], v[78:79] op_sel:[1,1,0] op_sel_hi:[1,0,1] neg_lo:[0,1,0] neg_hi:[0,0,0]
v_pk_mul_f32 v[78:79], v[46:47], v[196:197] op_sel:[0,0] op_sel_hi:[0,1] neg_lo:[0,0] neg_hi:[0,0]
v_pk_fma_f32 v[46:47], v[46:47], v[196:197], v[78:79] op_sel:[1,1,0] op_sel_hi:[1,0,1] neg_lo:[0,1,0] neg_hi:[0,0,0]
v_pk_mul_f32 v[78:79], v[50:51], v[198:199] op_sel:[0,0] op_sel_hi:[0,1] neg_lo:[0,0] neg_hi:[0,0]
v_pk_fma_f32 v[50:51], v[50:51], v[198:199], v[78:79] op_sel:[1,1,0] op_sel_hi:[1,0,1] neg_lo:[0,1,0] neg_hi:[0,0,0]
v_pk_mul_f32 v[78:79], v[44:45], v[200:201] op_sel:[0,0] op_sel_hi:[0,1] neg_lo:[0,0] neg_hi:[0,0]
v_pk_fma_f32 v[44:45], v[44:45], v[200:201], v[78:79] op_sel:[1,1,0] op_sel_hi:[1,0,1] neg_lo:[0,1,0] neg_hi:[0,0,0]
v_pk_mul_f32 v[78:79], v[52:53], v[202:203] op_sel:[0,0] op_sel_hi:[0,1] neg_lo:[0,0] neg_hi:[0,0]
v_pk_fma_f32 v[52:53], v[52:53], v[202:203], v[78:79] op_sel:[1,1,0] op_sel_hi:[1,0,1] neg_lo:[0,1,0] neg_hi:[0,0,0]
v_pk_mul_f32 v[78:79], v[54:55], v[204:205] op_sel:[0,0] op_sel_hi:[0,1] neg_lo:[0,0] neg_hi:[0,0]
v_pk_fma_f32 v[54:55], v[54:55], v[204:205], v[78:79] op_sel:[1,1,0] op_sel_hi:[1,0,1] neg_lo:[0,1,0] neg_hi:[0,0,0]
v_pk_mul_f32 v[78:79], v[58:59], v[206:207] op_sel:[0,0] op_sel_hi:[0,1] neg_lo:[0,0] neg_hi:[0,0]
v_pk_fma_f32 v[58:59], v[58:59], v[206:207], v[78:79] op_sel:[1,1,0] op_sel_hi:[1,0,1] neg_lo:[0,1,0] neg_hi:[0,0,0]
ds_write_b64 v4, v[16:17] offset:0
ds_write_b64 v4, v[48:49] offset:16
ds_write_b64 v4, v[18:19] offset:32
ds_write_b64 v4, v[22:23] offset:48
ds_write_b64 v4, v[26:27] offset:64
ds_write_b64 v4, v[38:39] offset:80
ds_write_b64 v4, v[28:29] offset:96
ds_write_b64 v4, v[36:37] offset:112
ds_write_b64 v4, v[42:43] offset:128
ds_write_b64 v4, v[70:71] offset:144
ds_write_b64 v4, v[60:61] offset:160
ds_write_b64 v4, v[68:69] offset:176
ds_write_b64 v4, v[40:41] offset:192
ds_write_b64 v4, v[56:57] offset:208
ds_write_b64 v4, v[62:63] offset:224
ds_write_b64 v4, v[66:67] offset:240
ds_write_b64 v4, v[74:75] offset:256
ds_write_b64 v4, v[76:77] offset:272
ds_write_b64 v4, v[72:73] offset:288
ds_write_b64 v4, v[20:21] offset:304
ds_write_b64 v4, v[64:65] offset:320
ds_write_b64 v4, v[24:25] offset:336
ds_write_b64 v4, v[30:31] offset:352
ds_write_b64 v4, v[34:35] offset:368
ds_write_b64 v4, v[14:15] offset:384
ds_write_b64 v4, v[32:33] offset:400
ds_write_b64 v4, v[46:47] offset:416
ds_write_b64 v4, v[50:51] offset:432
ds_write_b64 v4, v[44:45] offset:448
ds_write_b64 v4, v[52:53] offset:464
ds_write_b64 v4, v[54:55] offset:480
ds_write_b64 v4, v[58:59] offset:496
s_waitcnt lgkmcnt(0)
ds_read_b64 v[16:17], v3 offset:0
ds_read_b64 v[48:49], v3 offset:8448
ds_read_b64 v[18:19], v3 offset:528
ds_read_b64 v[50:51], v3 offset:8976
ds_read_b64 v[20:21], v3 offset:1056
ds_read_b64 v[52:53], v3 offset:9504
ds_read_b64 v[22:23], v3 offset:1584
ds_read_b64 v[54:55], v3 offset:10032
ds_read_b64 v[24:25], v3 offset:2112
ds_read_b64 v[56:57], v3 offset:10560
ds_read_b64 v[26:27], v3 offset:2640
ds_read_b64 v[58:59], v3 offset:11088
ds_read_b64 v[28:29], v3 offset:3168
ds_read_b64 v[60:61], v3 offset:11616
ds_read_b64 v[30:31], v3 offset:3696
ds_read_b64 v[62:63], v3 offset:12144
ds_read_b64 v[32:33], v3 offset:4224
ds_read_b64 v[64:65], v3 offset:12672
ds_read_b64 v[34:35], v3 offset:4752
ds_read_b64 v[66:67], v3 offset:13200
ds_read_b64 v[36:37], v3 offset:5280
ds_read_b64 v[68:69], v3 offset:13728
ds_read_b64 v[38:39], v3 offset:5808
ds_read_b64 v[70:71], v3 offset:14256
ds_read_b64 v[40:41], v3 offset:6336
ds_read_b64 v[72:73], v3 offset:14784
ds_read_b64 v[42:43], v3 offset:6864
ds_read_b64 v[74:75], v3 offset:15312
ds_read_b64 v[44:45], v3 offset:7392
ds_read_b64 v[76:77], v3 offset:15840
ds_read_b64 v[46:47], v3 offset:7920
ds_read_b64 v[78:79], v3 offset:16368
s_waitcnt lgkmcnt(0)
v_pk_add_f32 v[14:15], v[16:17], v[48:49] neg_lo:[0,1] neg_hi:[0,1]
v_pk_add_f32 v[16:17], v[16:17], v[48:49]
v_pk_add_f32 v[48:49], v[18:19], v[50:51] neg_lo:[0,1] neg_hi:[0,1]
v_pk_add_f32 v[18:19], v[18:19], v[50:51]
v_pk_mul_f32 v[50:51], v[48:49], s[50:51] op_sel:[0,0] op_sel_hi:[0,1] neg_lo:[0,0] neg_hi:[0,0]
v_pk_fma_f32 v[50:51], v[48:49], s[50:51], v[50:51] op_sel:[1,1,0] op_sel_hi:[1,0,1] neg_lo:[0,1,0] neg_hi:[0,0,0]
v_pk_add_f32 v[48:49], v[20:21], v[52:53] neg_lo:[0,1] neg_hi:[0,1]
v_pk_add_f32 v[20:21], v[20:21], v[52:53]
v_pk_mul_f32 v[52:53], v[48:49], s[54:55] op_sel:[0,0] op_sel_hi:[0,1] neg_lo:[0,0] neg_hi:[0,0]
v_pk_fma_f32 v[52:53], v[48:49], s[54:55], v[52:53] op_sel:[1,1,0] op_sel_hi:[1,0,1] neg_lo:[0,1,0] neg_hi:[0,0,0]
v_pk_add_f32 v[48:49], v[22:23], v[54:55] neg_lo:[0,1] neg_hi:[0,1]
v_pk_add_f32 v[22:23], v[22:23], v[54:55]
v_pk_mul_f32 v[54:55], v[48:49], s[58:59] op_sel:[0,0] op_sel_hi:[0,1] neg_lo:[0,0] neg_hi:[0,0]
v_pk_fma_f32 v[54:55], v[48:49], s[58:59], v[54:55] op_sel:[1,1,0] op_sel_hi:[1,0,1] neg_lo:[0,1,0] neg_hi:[0,0,0]
v_pk_add_f32 v[48:49], v[24:25], v[56:57] neg_lo:[0,1] neg_hi:[0,1]
v_pk_add_f32 v[24:25], v[24:25], v[56:57]
v_pk_mul_f32 v[56:57], v[48:49], s[62:63] op_sel:[0,0] op_sel_hi:[0,1] neg_lo:[0,0] neg_hi:[0,0]
v_pk_fma_f32 v[56:57], v[48:49], s[62:63], v[56:57] op_sel:[1,1,0] op_sel_hi:[1,0,1] neg_lo:[0,1,0] neg_hi:[0,0,0]
v_pk_add_f32 v[48:49], v[26:27], v[58:59] neg_lo:[0,1] neg_hi:[0,1]
v_pk_add_f32 v[26:27], v[26:27], v[58:59]
v_pk_mul_f32 v[58:59], v[48:49], s[58:59] op_sel:[0,1] op_sel_hi:[0,0] neg_lo:[0,0] neg_hi:[0,0]
v_pk_fma_f32 v[58:59], v[48:49], s[58:59], v[58:59] op_sel:[1,0,0] op_sel_hi:[1,1,1] neg_lo:[0,1,0] neg_hi:[0,0,0]
v_pk_add_f32 v[48:49], v[28:29], v[60:61] neg_lo:[0,1] neg_hi:[0,1]
v_pk_add_f32 v[28:29], v[28:29], v[60:61]
v_pk_mul_f32 v[60:61], v[48:49], s[54:55] op_sel:[0,1] op_sel_hi:[0,0] neg_lo:[0,0] neg_hi:[0,0]
v_pk_fma_f32 v[60:61], v[48:49], s[54:55], v[60:61] op_sel:[1,0,0] op_sel_hi:[1,1,1] neg_lo:[0,1,0] neg_hi:[0,0,0]
v_pk_add_f32 v[48:49], v[30:31], v[62:63] neg_lo:[0,1] neg_hi:[0,1]
v_pk_add_f32 v[30:31], v[30:31], v[62:63]
v_pk_mul_f32 v[62:63], v[48:49], s[50:51] op_sel:[0,1] op_sel_hi:[0,0] neg_lo:[0,0] neg_hi:[0,0]
v_pk_fma_f32 v[62:63], v[48:49], s[50:51], v[62:63] op_sel:[1,0,0] op_sel_hi:[1,1,1] neg_lo:[0,1,0] neg_hi:[0,0,0]
v_pk_add_f32 v[48:49], v[32:33], v[64:65] op_sel:[1,1] op_sel_hi:[0,0] neg_lo:[1,0] neg_hi:[0,1]
v_pk_add_f32 v[32:33], v[32:33], v[64:65]
v_pk_add_f32 v[64:65], v[34:35], v[66:67] neg_lo:[0,1] neg_hi:[0,1]
v_pk_add_f32 v[34:35], v[34:35], v[66:67]
v_pk_mul_f32 v[66:67], v[64:65], s[50:51] op_sel:[0,1] op_sel_hi:[0,0] neg_lo:[0,1] neg_hi:[0,0]
v_pk_fma_f32 v[66:67], v[64:65], s[50:51], v[66:67] op_sel:[1,0,0] op_sel_hi:[1,1,1] neg_lo:[0,1,0] neg_hi:[0,1,0]
v_pk_add_f32 v[64:65], v[36:37], v[68:69] neg_lo:[0,1] neg_hi:[0,1]
v_pk_add_f32 v[36:37], v[36:37], v[68:69]
v_pk_mul_f32 v[68:69], v[64:65], s[54:55] op_sel:[0,1] op_sel_hi:[0,0] neg_lo:[0,1] neg_hi:[0,0]
v_pk_fma_f32 v[68:69], v[64:65], s[54:55], v[68:69] op_sel:[1,0,0] op_sel_hi:[1,1,1] neg_lo:[0,1,0] neg_hi:[0,1,0]
v_pk_add_f32 v[64:65], v[38:39], v[70:71] neg_lo:[0,1] neg_hi:[0,1]
v_pk_add_f32 v[38:39], v[38:39], v[70:71]
v_pk_mul_f32 v[70:71], v[64:65], s[58:59] op_sel:[0,1] op_sel_hi:[0,0] neg_lo:[0,1] neg_hi:[0,0]
v_pk_fma_f32 v[70:71], v[64:65], s[58:59], v[70:71] op_sel:[1,0,0] op_sel_hi:[1,1,1] neg_lo:[0,1,0] neg_hi:[0,1,0]
v_pk_add_f32 v[64:65], v[40:41], v[72:73] neg_lo:[0,1] neg_hi:[0,1]
v_pk_add_f32 v[40:41], v[40:41], v[72:73]
v_pk_mul_f32 v[72:73], v[64:65], s[62:63] op_sel:[0,0] op_sel_hi:[0,1] neg_lo:[0,1] neg_hi:[0,0]
v_pk_fma_f32 v[72:73], v[64:65], s[62:63], v[72:73] op_sel:[1,1,0] op_sel_hi:[1,0,1] neg_lo:[0,1,0] neg_hi:[0,1,0]
v_pk_add_f32 v[64:65], v[42:43], v[74:75] neg_lo:[0,1] neg_hi:[0,1]
v_pk_add_f32 v[42:43], v[42:43], v[74:75]
v_pk_mul_f32 v[74:75], v[64:65], s[58:59] op_sel:[0,0] op_sel_hi:[0,1] neg_lo:[0,1] neg_hi:[0,0]
v_pk_fma_f32 v[74:75], v[64:65], s[58:59], v[74:75] op_sel:[1,1,0] op_sel_hi:[1,0,1] neg_lo:[0,1,0] neg_hi:[0,1,0]
v_pk_add_f32 v[64:65], v[44:45], v[76:77] neg_lo:[0,1] neg_hi:[0,1]
v_pk_add_f32 v[44:45], v[44:45], v[76:77]
v_pk_mul_f32 v[76:77], v[64:65], s[54:55] op_sel:[0,0] op_sel_hi:[0,1] neg_lo:[0,1] neg_hi:[0,0]
v_pk_fma_f32 v[76:77], v[64:65], s[54:55], v[76:77] op_sel:[1,1,0] op_sel_hi:[1,0,1] neg_lo:[0,1,0] neg_hi:[0,1,0]
v_pk_add_f32 v[64:65], v[46:47], v[78:79] neg_lo:[0,1] neg_hi:[0,1]
v_pk_add_f32 v[46:47], v[46:47], v[78:79]
v_pk_mul_f32 v[78:79], v[64:65], s[50:51] op_sel:[0,0] op_sel_hi:[0,1] neg_lo:[0,1] neg_hi:[0,0]
v_pk_fma_f32 v[78:79], v[64:65], s[50:51], v[78:79] op_sel:[1,1,0] op_sel_hi:[1,0,1] neg_lo:[0,1,0] neg_hi:[0,1,0]
v_pk_add_f32 v[64:65], v[16:17], v[32:33] neg_lo:[0,1] neg_hi:[0,1]
v_pk_add_f32 v[16:17], v[16:17], v[32:33]
v_pk_add_f32 v[32:33], v[18:19], v[34:35] neg_lo:[0,1] neg_hi:[0,1]
v_pk_add_f32 v[18:19], v[18:19], v[34:35]
v_pk_mul_f32 v[34:35], v[32:33], s[54:55] op_sel:[0,0] op_sel_hi:[0,1] neg_lo:[0,0] neg_hi:[0,0]
v_pk_fma_f32 v[34:35], v[32:33], s[54:55], v[34:35] op_sel:[1,1,0] op_sel_hi:[1,0,1] neg_lo:[0,1,0] neg_hi:[0,0,0]
v_pk_add_f32 v[32:33], v[20:21], v[36:37] neg_lo:[0,1] neg_hi:[0,1]
v_pk_add_f32 v[20:21], v[20:21], v[36:37]
v_pk_mul_f32 v[36:37], v[32:33], s[62:63] op_sel:[0,0] op_sel_hi:[0,1] neg_lo:[0,0] neg_hi:[0,0]
v_pk_fma_f32 v[36:37], v[32:33], s[62:63], v[36:37] op_sel:[1,1,0] op_sel_hi:[1,0,1] neg_lo:[0,1,0] neg_hi:[0,0,0]
v_pk_add_f32 v[32:33], v[22:23], v[38:39] neg_lo:[0,1] neg_hi:[0,1]
v_pk_add_f32 v[22:23], v[22:23], v[38:39]
v_pk_mul_f32 v[38:39], v[32:33], s[54:55] op_sel:[0,1] op_sel_hi:[0,0] neg_lo:[0,0] neg_hi:[0,0]
v_pk_fma_f32 v[38:39], v[32:33], s[54:55], v[38:39] op_sel:[1,0,0] op_sel_hi:[1,1,1] neg_lo:[0,1,0] neg_hi:[0,0,0]
v_pk_add_f32 v[32:33], v[24:25], v[40:41] op_sel:[1,1] op_sel_hi:[0,0] neg_lo:[1,0] neg_hi:[0,1]
v_pk_add_f32 v[24:25], v[24:25], v[40:41]
v_pk_add_f32 v[40:41], v[26:27], v[42:43] neg_lo:[0,1] neg_hi:[0,1]
v_pk_add_f32 v[26:27], v[26:27], v[42:43]
v_pk_mul_f32 v[42:43], v[40:41], s[54:55] op_sel:[0,1] op_sel_hi:[0,0] neg_lo:[0,1] neg_hi:[0,0]
v_pk_fma_f32 v[42:43], v[40:41], s[54:55], v[42:43] op_sel:[1,0,0] op_sel_hi:[1,1,1] neg_lo:[0,1,0] neg_hi:[0,1,0]
v_pk_add_f32 v[40:41], v[28:29], v[44:45] neg_lo:[0,1] neg_hi:[0,1]
v_pk_add_f32 v[28:29], v[28:29], v[44:45]
v_pk_mul_f32 v[44:45], v[40:41], s[62:63] op_sel:[0,0] op_sel_hi:[0,1] neg_lo:[0,1] neg_hi:[0,0]
v_pk_fma_f32 v[44:45], v[40:41], s[62:63], v[44:45] op_sel:[1,1,0] op_sel_hi:[1,0,1] neg_lo:[0,1,0] neg_hi:[0,1,0]
v_pk_add_f32 v[40:41], v[30:31], v[46:47] neg_lo:[0,1] neg_hi:[0,1]
v_pk_add_f32 v[30:31], v[30:31], v[46:47]
v_pk_mul_f32 v[46:47], v[40:41], s[54:55] op_sel:[0,0] op_sel_hi:[0,1] neg_lo:[0,1] neg_hi:[0,0]
v_pk_fma_f32 v[46:47], v[40:41], s[54:55], v[46:47] op_sel:[1,1,0] op_sel_hi:[1,0,1] neg_lo:[0,1,0] neg_hi:[0,1,0]
v_pk_add_f32 v[40:41], v[14:15], v[48:49] neg_lo:[0,1] neg_hi:[0,1]
v_pk_add_f32 v[14:15], v[14:15], v[48:49]
v_pk_add_f32 v[48:49], v[50:51], v[66:67] neg_lo:[0,1] neg_hi:[0,1]
v_pk_add_f32 v[50:51], v[50:51], v[66:67]
v_pk_mul_f32 v[66:67], v[48:49], s[54:55] op_sel:[0,0] op_sel_hi:[0,1] neg_lo:[0,0] neg_hi:[0,0]
v_pk_fma_f32 v[66:67], v[48:49], s[54:55], v[66:67] op_sel:[1,1,0] op_sel_hi:[1,0,1] neg_lo:[0,1,0] neg_hi:[0,0,0]
v_pk_add_f32 v[48:49], v[52:53], v[68:69] neg_lo:[0,1] neg_hi:[0,1]
v_pk_add_f32 v[52:53], v[52:53], v[68:69]
v_pk_mul_f32 v[68:69], v[48:49], s[62:63] op_sel:[0,0] op_sel_hi:[0,1] neg_lo:[0,0] neg_hi:[0,0]
v_pk_fma_f32 v[68:69], v[48:49], s[62:63], v[68:69] op_sel:[1,1,0] op_sel_hi:[1,0,1] neg_lo:[0,1,0] neg_hi:[0,0,0]
v_pk_add_f32 v[48:49], v[54:55], v[70:71] neg_lo:[0,1] neg_hi:[0,1]
v_pk_add_f32 v[54:55], v[54:55], v[70:71]
v_pk_mul_f32 v[70:71], v[48:49], s[54:55] op_sel:[0,1] op_sel_hi:[0,0] neg_lo:[0,0] neg_hi:[0,0]
v_pk_fma_f32 v[70:71], v[48:49], s[54:55], v[70:71] op_sel:[1,0,0] op_sel_hi:[1,1,1] neg_lo:[0,1,0] neg_hi:[0,0,0]
v_pk_add_f32 v[48:49], v[56:57], v[72:73] op_sel:[1,1] op_sel_hi:[0,0] neg_lo:[1,0] neg_hi:[0,1]
v_pk_add_f32 v[56:57], v[56:57], v[72:73]
v_pk_add_f32 v[72:73], v[58:59], v[74:75] neg_lo:[0,1] neg_hi:[0,1]
v_pk_add_f32 v[58:59], v[58:59], v[74:75]
v_pk_mul_f32 v[74:75], v[72:73], s[54:55] op_sel:[0,1] op_sel_hi:[0,0] neg_lo:[0,1] neg_hi:[0,0]
v_pk_fma_f32 v[74:75], v[72:73], s[54:55], v[74:75] op_sel:[1,0,0] op_sel_hi:[1,1,1] neg_lo:[0,1,0] neg_hi:[0,1,0]
v_pk_add_f32 v[72:73], v[60:61], v[76:77] neg_lo:[0,1] neg_hi:[0,1]
v_pk_add_f32 v[60:61], v[60:61], v[76:77]
v_pk_mul_f32 v[76:77], v[72:73], s[62:63] op_sel:[0,0] op_sel_hi:[0,1] neg_lo:[0,1] neg_hi:[0,0]
v_pk_fma_f32 v[76:77], v[72:73], s[62:63], v[76:77] op_sel:[1,1,0] op_sel_hi:[1,0,1] neg_lo:[0,1,0] neg_hi:[0,1,0]
v_pk_add_f32 v[72:73], v[62:63], v[78:79] neg_lo:[0,1] neg_hi:[0,1]
v_pk_add_f32 v[62:63], v[62:63], v[78:79]
v_pk_mul_f32 v[78:79], v[72:73], s[54:55] op_sel:[0,0] op_sel_hi:[0,1] neg_lo:[0,1] neg_hi:[0,0]
v_pk_fma_f32 v[78:79], v[72:73], s[54:55], v[78:79] op_sel:[1,1,0] op_sel_hi:[1,0,1] neg_lo:[0,1,0] neg_hi:[0,1,0]
v_pk_add_f32 v[72:73], v[16:17], v[24:25] neg_lo:[0,1] neg_hi:[0,1]
v_pk_add_f32 v[16:17], v[16:17], v[24:25]
v_pk_add_f32 v[24:25], v[18:19], v[26:27] neg_lo:[0,1] neg_hi:[0,1]
v_pk_add_f32 v[18:19], v[18:19], v[26:27]
v_pk_mul_f32 v[26:27], v[24:25], s[62:63] op_sel:[0,0] op_sel_hi:[0,1] neg_lo:[0,0] neg_hi:[0,0]
v_pk_fma_f32 v[26:27], v[24:25], s[62:63], v[26:27] op_sel:[1,1,0] op_sel_hi:[1,0,1] neg_lo:[0,1,0] neg_hi:[0,0,0]
v_pk_add_f32 v[24:25], v[20:21], v[28:29] op_sel:[1,1] op_sel_hi:[0,0] neg_lo:[1,0] neg_hi:[0,1]
v_pk_add_f32 v[20:21], v[20:21], v[28:29]
v_pk_add_f32 v[28:29], v[22:23], v[30:31] neg_lo:[0,1] neg_hi:[0,1]
v_pk_add_f32 v[22:23], v[22:23], v[30:31]
v_pk_mul_f32 v[30:31], v[28:29], s[62:63] op_sel:[0,0] op_sel_hi:[0,1] neg_lo:[0,1] neg_hi:[0,0]
v_pk_fma_f32 v[30:31], v[28:29], s[62:63], v[30:31] op_sel:[1,1,0] op_sel_hi:[1,0,1] neg_lo:[0,1,0] neg_hi:[0,1,0]
v_pk_add_f32 v[28:29], v[64:65], v[32:33] neg_lo:[0,1] neg_hi:[0,1]
v_pk_add_f32 v[64:65], v[64:65], v[32:33]
v_pk_add_f32 v[32:33], v[34:35], v[42:43] neg_lo:[0,1] neg_hi:[0,1]
v_pk_add_f32 v[34:35], v[34:35], v[42:43]
v_pk_mul_f32 v[42:43], v[32:33], s[62:63] op_sel:[0,0] op_sel_hi:[0,1] neg_lo:[0,0] neg_hi:[0,0]
v_pk_fma_f32 v[42:43], v[32:33], s[62:63], v[42:43] op_sel:[1,1,0] op_sel_hi:[1,0,1] neg_lo:[0,1,0] neg_hi:[0,0,0]
v_pk_add_f32 v[32:33], v[36:37], v[44:45] op_sel:[1,1] op_sel_hi:[0,0] neg_lo:[1,0] neg_hi:[0,1]
v_pk_add_f32 v[36:37], v[36:37], v[44:45]
v_pk_add_f32 v[44:45], v[38:39], v[46:47] neg_lo:[0,1] neg_hi:[0,1]
v_pk_add_f32 v[38:39], v[38:39], v[46:47]
v_pk_mul_f32 v[46:47], v[44:45], s[62:63] op_sel:[0,0] op_sel_hi:[0,1] neg_lo:[0,1] neg_hi:[0,0]
v_pk_fma_f32 v[46:47], v[44:45], s[62:63], v[46:47] op_sel:[1,1,0] op_sel_hi:[1,0,1] neg_lo:[0,1,0] neg_hi:[0,1,0]
v_pk_add_f32 v[44:45], v[14:15], v[56:57] neg_lo:[0,1] neg_hi:[0,1]
v_pk_add_f32 v[14:15], v[14:15], v[56:57]
v_pk_add_f32 v[56:57], v[50:51], v[58:59] neg_lo:[0,1] neg_hi:[0,1]
v_pk_add_f32 v[50:51], v[50:51], v[58:59]
v_pk_mul_f32 v[58:59], v[56:57], s[62:63] op_sel:[0,0] op_sel_hi:[0,1] neg_lo:[0,0] neg_hi:[0,0]
v_pk_fma_f32 v[58:59], v[56:57], s[62:63], v[58:59] op_sel:[1,1,0] op_sel_hi:[1,0,1] neg_lo:[0,1,0] neg_hi:[0,0,0]
v_pk_add_f32 v[56:57], v[52:53], v[60:61] op_sel:[1,1] op_sel_hi:[0,0] neg_lo:[1,0] neg_hi:[0,1]
v_pk_add_f32 v[52:53], v[52:53], v[60:61]
v_pk_add_f32 v[60:61], v[54:55], v[62:63] neg_lo:[0,1] neg_hi:[0,1]
v_pk_add_f32 v[54:55], v[54:55], v[62:63]
v_pk_mul_f32 v[62:63], v[60:61], s[62:63] op_sel:[0,0] op_sel_hi:[0,1] neg_lo:[0,1] neg_hi:[0,0]
v_pk_fma_f32 v[62:63], v[60:61], s[62:63], v[62:63] op_sel:[1,1,0] op_sel_hi:[1,0,1] neg_lo:[0,1,0] neg_hi:[0,1,0]
v_pk_add_f32 v[60:61], v[40:41], v[48:49] neg_lo:[0,1] neg_hi:[0,1]
v_pk_add_f32 v[40:41], v[40:41], v[48:49]
v_pk_add_f32 v[48:49], v[66:67], v[74:75] neg_lo:[0,1] neg_hi:[0,1]
v_pk_add_f32 v[66:67], v[66:67], v[74:75]
v_pk_mul_f32 v[74:75], v[48:49], s[62:63] op_sel:[0,0] op_sel_hi:[0,1] neg_lo:[0,0] neg_hi:[0,0]
v_pk_fma_f32 v[74:75], v[48:49], s[62:63], v[74:75] op_sel:[1,1,0] op_sel_hi:[1,0,1] neg_lo:[0,1,0] neg_hi:[0,0,0]
v_pk_add_f32 v[48:49], v[68:69], v[76:77] op_sel:[1,1] op_sel_hi:[0,0] neg_lo:[1,0] neg_hi:[0,1]
v_pk_add_f32 v[68:69], v[68:69], v[76:77]
v_pk_add_f32 v[76:77], v[70:71], v[78:79] neg_lo:[0,1] neg_hi:[0,1]
v_pk_add_f32 v[70:71], v[70:71], v[78:79]
v_pk_mul_f32 v[78:79], v[76:77], s[62:63] op_sel:[0,0] op_sel_hi:[0,1] neg_lo:[0,1] neg_hi:[0,0]
v_pk_fma_f32 v[78:79], v[76:77], s[62:63], v[78:79] op_sel:[1,1,0] op_sel_hi:[1,0,1] neg_lo:[0,1,0] neg_hi:[0,1,0]
v_pk_add_f32 v[76:77], v[16:17], v[20:21] neg_lo:[0,1] neg_hi:[0,1]
v_pk_add_f32 v[16:17], v[16:17], v[20:21]
v_pk_add_f32 v[20:21], v[18:19], v[22:23] op_sel:[1,1] op_sel_hi:[0,0] neg_lo:[1,0] neg_hi:[0,1]
v_pk_add_f32 v[18:19], v[18:19], v[22:23]
v_pk_add_f32 v[22:23], v[72:73], v[24:25] neg_lo:[0,1] neg_hi:[0,1]
v_pk_add_f32 v[72:73], v[72:73], v[24:25]
v_pk_add_f32 v[24:25], v[26:27], v[30:31] op_sel:[1,1] op_sel_hi:[0,0] neg_lo:[1,0] neg_hi:[0,1]
v_pk_add_f32 v[26:27], v[26:27], v[30:31]
v_pk_add_f32 v[30:31], v[64:65], v[36:37] neg_lo:[0,1] neg_hi:[0,1]
v_pk_add_f32 v[64:65], v[64:65], v[36:37]
v_pk_add_f32 v[36:37], v[34:35], v[38:39] op_sel:[1,1] op_sel_hi:[0,0] neg_lo:[1,0] neg_hi:[0,1]
v_pk_add_f32 v[34:35], v[34:35], v[38:39]
v_pk_add_f32 v[38:39], v[28:29], v[32:33] neg_lo:[0,1] neg_hi:[0,1]
v_pk_add_f32 v[28:29], v[28:29], v[32:33]
v_pk_add_f32 v[32:33], v[42:43], v[46:47] op_sel:[1,1] op_sel_hi:[0,0] neg_lo:[1,0] neg_hi:[0,1]
v_pk_add_f32 v[42:43], v[42:43], v[46:47]
v_pk_add_f32 v[46:47], v[14:15], v[52:53] neg_lo:[0,1] neg_hi:[0,1]
v_pk_add_f32 v[14:15], v[14:15], v[52:53]
v_pk_add_f32 v[52:53], v[50:51], v[54:55] op_sel:[1,1] op_sel_hi:[0,0] neg_lo:[1,0] neg_hi:[0,1]
v_pk_add_f32 v[50:51], v[50:51], v[54:55]
v_pk_add_f32 v[54:55], v[44:45], v[56:57] neg_lo:[0,1] neg_hi:[0,1]
v_pk_add_f32 v[44:45], v[44:45], v[56:57]
v_pk_add_f32 v[56:57], v[58:59], v[62:63] op_sel:[1,1] op_sel_hi:[0,0] neg_lo:[1,0] neg_hi:[0,1]
v_pk_add_f32 v[58:59], v[58:59], v[62:63]
v_pk_add_f32 v[62:63], v[40:41], v[68:69] neg_lo:[0,1] neg_hi:[0,1]
v_pk_add_f32 v[40:41], v[40:41], v[68:69]
v_pk_add_f32 v[68:69], v[66:67], v[70:71] op_sel:[1,1] op_sel_hi:[0,0] neg_lo:[1,0] neg_hi:[0,1]
v_pk_add_f32 v[66:67], v[66:67], v[70:71]
v_pk_add_f32 v[70:71], v[60:61], v[48:49] neg_lo:[0,1] neg_hi:[0,1]
v_pk_add_f32 v[60:61], v[60:61], v[48:49]
v_pk_add_f32 v[48:49], v[74:75], v[78:79] op_sel:[1,1] op_sel_hi:[0,0] neg_lo:[1,0] neg_hi:[0,1]
v_pk_add_f32 v[74:75], v[74:75], v[78:79]
v_pk_add_f32 v[78:79], v[16:17], v[18:19] neg_lo:[0,1] neg_hi:[0,1]
v_pk_add_f32 v[16:17], v[16:17], v[18:19]
v_pk_add_f32 v[18:19], v[76:77], v[20:21] neg_lo:[0,1] neg_hi:[0,1]
v_pk_add_f32 v[76:77], v[76:77], v[20:21]
v_pk_add_f32 v[20:21], v[72:73], v[26:27] neg_lo:[0,1] neg_hi:[0,1]
v_pk_add_f32 v[72:73], v[72:73], v[26:27]
v_pk_add_f32 v[26:27], v[22:23], v[24:25] neg_lo:[0,1] neg_hi:[0,1]
v_pk_add_f32 v[22:23], v[22:23], v[24:25]
v_pk_add_f32 v[24:25], v[64:65], v[34:35] neg_lo:[0,1] neg_hi:[0,1]
v_pk_add_f32 v[64:65], v[64:65], v[34:35]
v_pk_add_f32 v[34:35], v[30:31], v[36:37] neg_lo:[0,1] neg_hi:[0,1]
v_pk_add_f32 v[30:31], v[30:31], v[36:37]
v_pk_add_f32 v[36:37], v[28:29], v[42:43] neg_lo:[0,1] neg_hi:[0,1]
v_pk_add_f32 v[28:29], v[28:29], v[42:43]
v_pk_add_f32 v[42:43], v[38:39], v[32:33] neg_lo:[0,1] neg_hi:[0,1]
v_pk_add_f32 v[38:39], v[38:39], v[32:33]
v_pk_add_f32 v[32:33], v[14:15], v[50:51] neg_lo:[0,1] neg_hi:[0,1]
v_pk_add_f32 v[14:15], v[14:15], v[50:51]
v_pk_add_f32 v[50:51], v[46:47], v[52:53] neg_lo:[0,1] neg_hi:[0,1]
v_pk_add_f32 v[46:47], v[46:47], v[52:53]
v_pk_add_f32 v[52:53], v[44:45], v[58:59] neg_lo:[0,1] neg_hi:[0,1]
v_pk_add_f32 v[44:45], v[44:45], v[58:59]
v_pk_add_f32 v[58:59], v[54:55], v[56:57] neg_lo:[0,1] neg_hi:[0,1]
v_pk_add_f32 v[54:55], v[54:55], v[56:57]
v_pk_add_f32 v[56:57], v[40:41], v[66:67] neg_lo:[0,1] neg_hi:[0,1]
v_pk_add_f32 v[40:41], v[40:41], v[66:67]
v_pk_add_f32 v[66:67], v[62:63], v[68:69] neg_lo:[0,1] neg_hi:[0,1]
v_pk_add_f32 v[62:63], v[62:63], v[68:69]
v_pk_add_f32 v[68:69], v[60:61], v[74:75] neg_lo:[0,1] neg_hi:[0,1]
v_pk_add_f32 v[60:61], v[60:61], v[74:75]
v_pk_add_f32 v[74:75], v[70:71], v[48:49] neg_lo:[0,1] neg_hi:[0,1]
v_pk_add_f32 v[70:71], v[70:71], v[48:49]
s_lshl_b32 s12, s38, 2
s_add_u32 s12, s12, s16
s_min_u32 s12, s12, 512
s_lshr_b32 s23, s12, 6
s_xnor_b32 s23, s23, s98
s_and_b32 s23, s23, 1
s_lshl_b32 s23, s23, 13
s_mul_i32 s12, s12, 32768
s_add_u32 s12, s12, 113246208
s_add_u32 s12, s12, s23
buffer_store_dwordx2 v[16:17], v5, s[84:87], s12 offen offset:0 sc1
buffer_store_dwordx2 v[14:15], v5, s[84:87], s12 offen offset:512 sc1
buffer_store_dwordx2 v[64:65], v5, s[84:87], s12 offen offset:1024 sc1
buffer_store_dwordx2 v[40:41], v5, s[84:87], s12 offen offset:1536 sc1
buffer_store_dwordx2 v[72:73], v5, s[84:87], s12 offen offset:2048 sc1
buffer_store_dwordx2 v[44:45], v5, s[84:87], s12 offen offset:2560 sc1
buffer_store_dwordx2 v[28:29], v5, s[84:87], s12 offen offset:3072 sc1
buffer_store_dwordx2 v[60:61], v5, s[84:87], s12 offen offset:3584 sc1
s_add_u32 s12, s12, 4096
buffer_store_dwordx2 v[76:77], v5, s[84:87], s12 offen offset:0 sc1
buffer_store_dwordx2 v[46:47], v5, s[84:87], s12 offen offset:512 sc1
buffer_store_dwordx2 v[30:31], v5, s[84:87], s12 offen offset:1024 sc1
buffer_store_dwordx2 v[62:63], v5, s[84:87], s12 offen offset:1536 sc1
buffer_store_dwordx2 v[22:23], v5, s[84:87], s12 offen offset:2048 sc1
buffer_store_dwordx2 v[54:55], v5, s[84:87], s12 offen offset:2560 sc1
buffer_store_dwordx2 v[38:39], v5, s[84:87], s12 offen offset:3072 sc1
buffer_store_dwordx2 v[70:71], v5, s[84:87], s12 offen offset:3584 sc1
s_add_u32 s12, s12, 12288
buffer_store_dwordx2 v[78:79], v5, s[84:87], s12 offen offset:0 sc1
buffer_store_dwordx2 v[32:33], v5, s[84:87], s12 offen offset:512 sc1
buffer_store_dwordx2 v[24:25], v5, s[84:87], s12 offen offset:1024 sc1
buffer_store_dwordx2 v[56:57], v5, s[84:87], s12 offen offset:1536 sc1
buffer_store_dwordx2 v[20:21], v5, s[84:87], s12 offen offset:2048 sc1
buffer_store_dwordx2 v[52:53], v5, s[84:87], s12 offen offset:2560 sc1
buffer_store_dwordx2 v[36:37], v5, s[84:87], s12 offen offset:3072 sc1
buffer_store_dwordx2 v[68:69], v5, s[84:87], s12 offen offset:3584 sc1
s_add_u32 s12, s12, 4096
buffer_store_dwordx2 v[18:19], v5, s[84:87], s12 offen offset:0 sc1
buffer_store_dwordx2 v[50:51], v5, s[84:87], s12 offen offset:512 sc1
buffer_store_dwordx2 v[34:35], v5, s[84:87], s12 offen offset:1024 sc1
buffer_store_dwordx2 v[66:67], v5, s[84:87], s12 offen offset:1536 sc1
buffer_store_dwordx2 v[26:27], v5, s[84:87], s12 offen offset:2048 sc1
buffer_store_dwordx2 v[58:59], v5, s[84:87], s12 offen offset:2560 sc1
buffer_store_dwordx2 v[42:43], v5, s[84:87], s12 offen offset:3072 sc1
buffer_store_dwordx2 v[74:75], v5, s[84:87], s12 offen offset:3584 sc1
s_add_u32 s12, s12, 4096
s_mov_b32 s38, s21
s_cmp_lt_u32 s38, s37
s_cbranch_scc1 mega_kernel_f2_l
mega_kernel_f2_e:
mega_kernel_f2e:
s_waitcnt vmcnt(0)
s_barrier
v_mov_b32 v1, 0
v_mov_b32 v2, 1
s_mov_b32 s82, 69259392
v_cmp_eq_u32 vcc, 0, v0
s_and_saveexec_b64 s[80:81], vcc
s_cbranch_execz mega_kernel_sg1
buffer_atomic_add v2, v1, s[84:87], s82 offen sc1
mega_kernel_sg1:
s_mov_b64 exec, s[80:81]
s_mov_b32 s64, 0
s_mov_b32 s65, 58
s_lshl_b32 s66, s40, 13
s_add_u32 s66, s66, 67633152
s_mov_b32 s67, 0
s_mov_b32 s68, 0
s_cmp_eq_u32 s91, 3
s_cbranch_scc1 mega_kernel_out
s_cmp_lt_u32 s92, 1
s_cbranch_scc1 mega_kernel_back
s_mov_b32 s68, 1
s_branch mega_kernel_out
mega_kernel_back:
s_lshl_b32 s68, s68, 1
s_mov_b32 s93, s92
s_load_dwordx2 s[4:5], s[0:1], 80
s_mov_b32 s48, 0x3f7ec46d
s_mov_b32 s49, 0x3dc8bd36
s_mov_b32 s50, 0x3f7b14be
s_mov_b32 s51, 0x3e47c5c2
s_mov_b32 s52, 0x3f74fa0b
s_mov_b32 s53, 0x3e94a031
s_mov_b32 s54, 0x3f6c835e
s_mov_b32 s55, 0x3ec3ef15
s_mov_b32 s56, 0x3f61c598
s_mov_b32 s57, 0x3ef15aea
s_mov_b32 s58, 0x3f54db31
s_mov_b32 s59, 0x3f0e39da
s_mov_b32 s60, 0x3f45e403
s_mov_b32 s61, 0x3f226799
s_mov_b32 s62, 0x3f3504f3
s_mov_b32 s63, 0x3f3504f3
v_and_b32 v1, 31, v0
v_lshrrev_b32 v2, 5, v0
v_cvt_f32_u32 v3, v1
v_mul_u32_u24 v10, 8448, v2
v_lshl_add_u32 v4, v1, 3, v10
v_mul_u32_u24 v5, 264, v1
v_add_u32 v5, v5, v10
v_and_b32 v11, 7, v0
v_lshrrev_b32 v9, 3, v0
v_mul_u32_u24 v10, 8448, v11
v_lshl_add_u32 v6, v9, 3, v10
v_lshlrev_b32 v7, 3, v9
v_sub_u32 v7, v10, v7
v_add_u32 v7, 4096, v7
v_mul_u32_u24 v8, 32768, v9
v_lshl_add_u32 v8, v11, 4, v8
v_mul_f32 v12, 0x3a800000, v3
v_cos_f32 v82, v12
v_sin_f32 v83, v12
v_mul_f32 v12, 0x3b000000, v3
v_cos_f32 v84, v12
v_sin_f32 v85, v12
v_mul_f32 v12, 0x3b400000, v3
v_cos_f32 v86, v12
v_sin_f32 v87, v12
v_mul_f32 v12, 0x3b800000, v3
v_cos_f32 v88, v12
v_sin_f32 v89, v12
v_mul_f32 v12, 0x3ba00000, v3
v_cos_f32 v90, v12
v_sin_f32 v91, v12
v_mul_f32 v12, 0x3bc00000, v3
v_cos_f32 v92, v12
v_sin_f32 v93, v12
v_mul_f32 v12, 0x3be00000, v3
v_cos_f32 v94, v12
v_sin_f32 v95, v12
v_mul_f32 v12, 0x3c000000, v3
v_cos_f32 v96, v12
v_sin_f32 v97, v12
v_mul_f32 v12, 0x3c100000, v3
v_cos_f32 v98, v12
v_sin_f32 v99, v12
v_mul_f32 v12, 0x3c200000, v3
v_cos_f32 v100, v12
v_sin_f32 v101, v12
v_mul_f32 v12, 0x3c300000, v3
v_cos_f32 v102, v12
v_sin_f32 v103, v12
v_mul_f32 v12, 0x3c400000, v3
v_cos_f32 v104, v12
v_sin_f32 v105, v12
v_mul_f32 v12, 0x3c500000, v3
v_cos_f32 v106, v12
v_sin_f32 v107, v12
v_mul_f32 v12, 0x3c600000, v3
v_cos_f32 v108, v12
v_sin_f32 v109, v12
v_mul_f32 v12, 0x3c700000, v3
v_cos_f32 v110, v12
v_sin_f32 v111, v12
v_mul_f32 v12, 0x3c800000, v3
v_cos_f32 v112, v12
v_sin_f32 v113, v12
v_mul_f32 v12, 0x3c880000, v3
v_cos_f32 v114, v12
v_sin_f32 v115, v12
v_mul_f32 v12, 0x3c900000, v3
v_cos_f32 v116, v12
v_sin_f32 v117, v12
v_mul_f32 v12, 0x3c980000, v3
v_cos_f32 v118, v12
v_sin_f32 v119, v12
v_mul_f32 v12, 0x3ca00000, v3
v_cos_f32 v120, v12
v_sin_f32 v121, v12
v_mul_f32 v12, 0x3ca80000, v3
v_cos_f32 v122, v12
v_sin_f32 v123, v12
v_mul_f32 v12, 0x3cb00000, v3
v_cos_f32 v124, v12
v_sin_f32 v125, v12
v_mul_f32 v12, 0x3cb80000, v3
v_cos_f32 v126, v12
v_sin_f32 v127, v12
v_mul_f32 v12, 0x3cc00000, v3
v_cos_f32 v128, v12
v_sin_f32 v129, v12
v_mul_f32 v12, 0x3cc80000, v3
v_cos_f32 v130, v12
v_sin_f32 v131, v12
v_mul_f32 v12, 0x3cd00000, v3
v_cos_f32 v132, v12
v_sin_f32 v133, v12
v_mul_f32 v12, 0x3cd80000, v3
v_cos_f32 v134, v12
v_sin_f32 v135, v12
v_mul_f32 v12, 0x3ce00000, v3
v_cos_f32 v136, v12
v_sin_f32 v137, v12
v_mul_f32 v12, 0x3ce80000, v3
v_cos_f32 v138, v12
v_sin_f32 v139, v12
v_mul_f32 v12, 0x3cf00000, v3
v_cos_f32 v140, v12
v_sin_f32 v141, v12
v_mul_f32 v12, 0x3cf80000, v3
v_cos_f32 v142, v12
v_sin_f32 v143, v12
v_lshlrev_b32 v12, 2, v1
v_sub_u32 v12, v4, v12
v_and_b32 v10, 127, v0
v_lshrrev_b32 v11, 7, v0
v_lshlrev_b32 v2, 5, v10
v_lshl_add_u32 v2, v11, 12, v2
v_lshlrev_b32 v3, 4, v10
v_lshl_add_u32 v3, v11, 12, v3
v_add_u32 v3, 2048, v3
v_cmp_eq_u32 s[14:15], 0, v9
s_waitcnt lgkmcnt(0)
s_mov_b32 s6, 8388608
s_mov_b32 s7, 0x00020000
v_mov_b32 v250, 0
s_mov_b32 s82, 69259392
mega_kernel_w1:
s_sleep 8
buffer_load_dword v251, v250, s[84:87], s82 offen sc1
s_waitcnt vmcnt(0)
v_cmp_ne_u32 vcc, 95, v251
s_cbranch_vccnz mega_kernel_w1
s_cmp_lt_u32 s93, 128
s_cbranch_scc0 mega_kernel_f3_e
s_lshl_b32 s12, s93, 7
s_and_b32 s23, s12, 0x2000
s_add_u32 s12, s12, s23
s_xor_b32 s23, s98, 1
s_lshl_b32 s23, s23, 13
s_add_u32 s12, s12, s23
s_add_u32 s12, s12, 113246208
buffer_load_dwordx4 v[144:147], v8, s[84:87], s12 offen sc1
s_add_u32 s12, s12, 1048576
buffer_load_dwordx4 v[148:151], v8, s[84:87], s12 offen sc1
s_add_u32 s12, s12, 1048576
s_xor_b32 s12, s12, 0x2000
buffer_load_dwordx4 v[152:155], v8, s[84:87], s12 offen sc1
s_add_u32 s12, s12, 1048576
buffer_load_dwordx4 v[156:159], v8, s[84:87], s12 offen sc1
s_add_u32 s12, s12, 1048576
s_xor_b32 s12, s12, 0x2000
buffer_load_dwordx4 v[160:163], v8, s[84:87], s12 offen sc1
s_add_u32 s12, s12, 1048576
buffer_load_dwordx4 v[164:167], v8, s[84:87], s12 offen sc1
s_add_u32 s12, s12, 1048576
s_xor_b32 s12, s12, 0x2000
buffer_load_dwordx4 v[168:171], v8, s[84:87], s12 offen sc1
s_add_u32 s12, s12, 1048576
buffer_load_dwordx4 v[172:175], v8, s[84:87], s12 offen sc1
s_add_u32 s12, s12, 1048576
s_xor_b32 s12, s12, 0x2000
buffer_load_dwordx4 v[176:179], v8, s[84:87], s12 offen sc1
s_add_u32 s12, s12, 1048576
buffer_load_dwordx4 v[180:183], v8, s[84:87], s12 offen sc1
s_add_u32 s12, s12, 1048576
s_xor_b32 s12, s12, 0x2000
buffer_load_dwordx4 v[184:187], v8, s[84:87], s12 offen sc1
s_add_u32 s12, s12, 1048576
buffer_load_dwordx4 v[188:191], v8, s[84:87], s12 offen sc1
s_add_u32 s12, s12, 1048576
s_xor_b32 s12, s12, 0x2000
buffer_load_dwordx4 v[192:195], v8, s[84:87], s12 offen sc1
s_add_u32 s12, s12, 1048576
buffer_load_dwordx4 v[196:199], v8, s[84:87], s12 offen sc1
s_add_u32 s12, s12, 1048576
s_xor_b32 s12, s12, 0x2000
buffer_load_dwordx4 v[200:203], v8, s[84:87], s12 offen sc1
s_add_u32 s12, s12, 1048576
buffer_load_dwordx4 v[204:207], v8, s[84:87], s12 offen sc1
s_add_u32 s12, s12, 1048576
s_xor_b32 s12, s12, 0x2000
buffer_load_dwordx4 v[208:211], v8, s[84:87], s12 offen sc1
s_add_u32 s12, s12, 1048576
s_waitcnt vmcnt(0)
mega_kernel_f3_l:
s_add_u32 s21, s93, 64
s_cmp_lt_u32 s21, 128
s_cselect_b32 s22, s21, s93
s_waitcnt vmcnt(8)
s_barrier
v_cndmask_b32 v145, v145, 0, s[14:15]
v_cndmask_b32 v147, v147, 0, s[14:15]
v_cndmask_b32 v209, v209, 0, s[14:15]
v_cndmask_b32 v211, v211, 0, s[14:15]
v_pk_add_f32 v[16:17], v[144:145], v[146:147] op_sel:[0,1] op_sel_hi:[1,0] neg_lo:[0,1]
v_pk_add_f32 v[18:19], v[144:145], v[146:147] op_sel:[0,1] op_sel_hi:[1,0] neg_hi:[1,0]
ds_write_b64 v6, v[16:17] offset:0
ds_write_b64 v7, v[18:19] offset:4096
v_pk_add_f32 v[20:21], v[148:149], v[150:151] op_sel:[0,1] op_sel_hi:[1,0] neg_lo:[0,1]
v_pk_add_f32 v[22:23], v[148:149], v[150:151] op_sel:[0,1] op_sel_hi:[1,0] neg_hi:[1,0]
ds_write_b64 v6, v[20:21] offset:256
ds_write_b64 v7, v[22:23] offset:3840
v_pk_add_f32 v[24:25], v[152:153], v[154:155] op_sel:[0,1] op_sel_hi:[1,0] neg_lo:[0,1]
v_pk_add_f32 v[26:27], v[152:153], v[154:155] op_sel:[0,1] op_sel_hi:[1,0] neg_hi:[1,0]
ds_write_b64 v6, v[24:25] offset:512
ds_write_b64 v7, v[26:27] offset:3584
v_pk_add_f32 v[28:29], v[156:157], v[158:159] op_sel:[0,1] op_sel_hi:[1,0] neg_lo:[0,1]
v_pk_add_f32 v[30:31], v[156:157], v[158:159] op_sel:[0,1] op_sel_hi:[1,0] neg_hi:[1,0]
ds_write_b64 v6, v[28:29] offset:768
ds_write_b64 v7, v[30:31] offset:3328
v_pk_add_f32 v[32:33], v[160:161], v[162:163] op_sel:[0,1] op_sel_hi:[1,0] neg_lo:[0,1]
v_pk_add_f32 v[34:35], v[160:161], v[162:163] op_sel:[0,1] op_sel_hi:[1,0] neg_hi:[1,0]
ds_write_b64 v6, v[32:33] offset:1024
ds_write_b64 v7, v[34:35] offset:3072
v_pk_add_f32 v[36:37], v[164:165], v[166:167] op_sel:[0,1] op_sel_hi:[1,0] neg_lo:[0,1]
v_pk_add_f32 v[38:39], v[164:165], v[166:167] op_sel:[0,1] op_sel_hi:[1,0] neg_hi:[1,0]
ds_write_b64 v6, v[36:37] offset:1280
ds_write_b64 v7, v[38:39] offset:2816
v_pk_add_f32 v[40:41], v[168:169], v[170:171] op_sel:[0,1] op_sel_hi:[1,0] neg_lo:[0,1]
v_pk_add_f32 v[42:43], v[168:169], v[170:171] op_sel:[0,1] op_sel_hi:[1,0] neg_hi:[1,0]
ds_write_b64 v6, v[40:41] offset:1536
ds_write_b64 v7, v[42:43] offset:2560
v_pk_add_f32 v[44:45], v[172:173], v[174:175] op_sel:[0,1] op_sel_hi:[1,0] neg_lo:[0,1]
v_pk_add_f32 v[46:47], v[172:173], v[174:175] op_sel:[0,1] op_sel_hi:[1,0] neg_hi:[1,0]
ds_write_b64 v6, v[44:45] offset:1792
ds_write_b64 v7, v[46:47] offset:2304
v_pk_add_f32 v[48:49], v[176:177], v[178:179] op_sel:[0,1] op_sel_hi:[1,0] neg_lo:[0,1]
v_pk_add_f32 v[50:51], v[176:177], v[178:179] op_sel:[0,1] op_sel_hi:[1,0] neg_hi:[1,0]
ds_write_b64 v6, v[48:49] offset:2048
ds_write_b64 v7, v[50:51] offset:2048
v_pk_add_f32 v[52:53], v[180:181], v[182:183] op_sel:[0,1] op_sel_hi:[1,0] neg_lo:[0,1]
v_pk_add_f32 v[54:55], v[180:181], v[182:183] op_sel:[0,1] op_sel_hi:[1,0] neg_hi:[1,0]
ds_write_b64 v6, v[52:53] offset:2304
ds_write_b64 v7, v[54:55] offset:1792
v_pk_add_f32 v[56:57], v[184:185], v[186:187] op_sel:[0,1] op_sel_hi:[1,0] neg_lo:[0,1]
v_pk_add_f32 v[58:59], v[184:185], v[186:187] op_sel:[0,1] op_sel_hi:[1,0] neg_hi:[1,0]
ds_write_b64 v6, v[56:57] offset:2560
ds_write_b64 v7, v[58:59] offset:1536
v_pk_add_f32 v[60:61], v[188:189], v[190:191] op_sel:[0,1] op_sel_hi:[1,0] neg_lo:[0,1]
v_pk_add_f32 v[62:63], v[188:189], v[190:191] op_sel:[0,1] op_sel_hi:[1,0] neg_hi:[1,0]
ds_write_b64 v6, v[60:61] offset:2816
ds_write_b64 v7, v[62:63] offset:1280
v_pk_add_f32 v[64:65], v[192:193], v[194:195] op_sel:[0,1] op_sel_hi:[1,0] neg_lo:[0,1]
v_pk_add_f32 v[66:67], v[192:193], v[194:195] op_sel:[0,1] op_sel_hi:[1,0] neg_hi:[1,0]
ds_write_b64 v6, v[64:65] offset:3072
ds_write_b64 v7, v[66:67] offset:1024
v_pk_add_f32 v[68:69], v[196:197], v[198:199] op_sel:[0,1] op_sel_hi:[1,0] neg_lo:[0,1]
v_pk_add_f32 v[70:71], v[196:197], v[198:199] op_sel:[0,1] op_sel_hi:[1,0] neg_hi:[1,0]
ds_write_b64 v6, v[68:69] offset:3328
ds_write_b64 v7, v[70:71] offset:768
v_pk_add_f32 v[72:73], v[200:201], v[202:203] op_sel:[0,1] op_sel_hi:[1,0] neg_lo:[0,1]
v_pk_add_f32 v[74:75], v[200:201], v[202:203] op_sel:[0,1] op_sel_hi:[1,0] neg_hi:[1,0]
ds_write_b64 v6, v[72:73] offset:3584
ds_write_b64 v7, v[74:75] offset:512
s_waitcnt lgkmcnt(8)
v_pk_add_f32 v[76:77], v[204:205], v[206:207] op_sel:[0,1] op_sel_hi:[1,0] neg_lo:[0,1]
v_pk_add_f32 v[78:79], v[204:205], v[206:207] op_sel:[0,1] op_sel_hi:[1,0] neg_hi:[1,0]
ds_write_b64 v6, v[76:77] offset:3840
ds_write_b64 v7, v[78:79] offset:256
v_pk_add_f32 v[16:17], v[208:209], v[210:211] op_sel:[0,1] op_sel_hi:[1,0] neg_lo:[0,1]
v_pk_add_f32 v[18:19], v[208:209], v[210:211] op_sel:[0,1] op_sel_hi:[1,0] neg_hi:[1,0]
s_mov_b64 exec, s[14:15]
ds_write_b64 v6, v[16:17] offset:4096
s_mov_b64 exec, -1
s_lshl_b32 s12, s22, 7
s_and_b32 s23, s12, 0x2000
s_add_u32 s12, s12, s23
s_xor_b32 s23, s98, 1
s_lshl_b32 s23, s23, 13
s_add_u32 s12, s12, s23
s_add_u32 s12, s12, 113246208
buffer_load_dwordx4 v[144:147], v8, s[84:87], s12 offen sc1
s_add_u32 s12, s12, 1048576
buffer_load_dwordx4 v[148:151], v8, s[84:87], s12 offen sc1
s_add_u32 s12, s12, 1048576
s_xor_b32 s12, s12, 0x2000
buffer_load_dwordx4 v[152:155], v8, s[84:87], s12 offen sc1
s_add_u32 s12, s12, 1048576
buffer_load_dwordx4 v[156:159], v8, s[84:87], s12 offen sc1
s_add_u32 s12, s12, 1048576
s_xor_b32 s12, s12, 0x2000
buffer_load_dwordx4 v[160:163], v8, s[84:87], s12 offen sc1
s_add_u32 s12, s12, 1048576
buffer_load_dwordx4 v[164:167], v8, s[84:87], s12 offen sc1
s_add_u32 s12, s12, 1048576
s_xor_b32 s12, s12, 0x2000
buffer_load_dwordx4 v[168:171], v8, s[84:87], s12 offen sc1
s_add_u32 s12, s12, 1048576
buffer_load_dwordx4 v[172:175], v8, s[84:87], s12 offen sc1
s_add_u32 s12, s12, 1048576
s_xor_b32 s12, s12, 0x2000
buffer_load_dwordx4 v[176:179], v8, s[84:87], s12 offen sc1
s_add_u32 s12, s12, 1048576
buffer_load_dwordx4 v[180:183], v8, s[84:87], s12 offen sc1
s_add_u32 s12, s12, 1048576
s_xor_b32 s12, s12, 0x2000
buffer_load_dwordx4 v[184:187], v8, s[84:87], s12 offen sc1
s_add_u32 s12, s12, 1048576
buffer_load_dwordx4 v[188:191], v8, s[84:87], s12 offen sc1
s_add_u32 s12, s12, 1048576
s_xor_b32 s12, s12, 0x2000
buffer_load_dwordx4 v[192:195], v8, s[84:87], s12 offen sc1
s_add_u32 s12, s12, 1048576
buffer_load_dwordx4 v[196:199], v8, s[84:87], s12 offen sc1
s_add_u32 s12, s12, 1048576
s_xor_b32 s12, s12, 0x2000
buffer_load_dwordx4 v[200:203], v8, s[84:87], s12 offen sc1
s_add_u32 s12, s12, 1048576
buffer_load_dwordx4 v[204:207], v8, s[84:87], s12 offen sc1
s_add_u32 s12, s12, 1048576
s_xor_b32 s12, s12, 0x2000
buffer_load_dwordx4 v[208:211], v8, s[84:87], s12 offen sc1
s_add_u32 s12, s12, 1048576
s_waitcnt lgkmcnt(0)
s_barrier
ds_read_b64 v[16:17], v4 offset:0
ds_read_b64 v[48:49], v4 offset:4096
ds_read_b64 v[18:19], v4 offset:256
ds_read_b64 v[50:51], v4 offset:4352
ds_read_b64 v[20:21], v4 offset:512
ds_read_b64 v[52:53], v4 offset:4608
ds_read_b64 v[22:23], v4 offset:768
ds_read_b64 v[54:55], v4 offset:4864
ds_read_b64 v[24:25], v4 offset:1024
ds_read_b64 v[56:57], v4 offset:5120
ds_read_b64 v[26:27], v4 offset:1280
ds_read_b64 v[58:59], v4 offset:5376
ds_read_b64 v[28:29], v4 offset:1536
ds_read_b64 v[60:61], v4 offset:5632
ds_read_b64 v[30:31], v4 offset:1792
ds_read_b64 v[62:63], v4 offset:5888
ds_read_b64 v[32:33], v4 offset:2048
ds_read_b64 v[64:65], v4 offset:6144
ds_read_b64 v[34:35], v4 offset:2304
ds_read_b64 v[66:67], v4 offset:6400
ds_read_b64 v[36:37], v4 offset:2560
ds_read_b64 v[68:69], v4 offset:6656
ds_read_b64 v[38:39], v4 offset:2816
ds_read_b64 v[70:71], v4 offset:6912
ds_read_b64 v[40:41], v4 offset:3072
ds_read_b64 v[72:73], v4 offset:7168
ds_read_b64 v[42:43], v4 offset:3328
ds_read_b64 v[74:75], v4 offset:7424
ds_read_b64 v[44:45], v4 offset:3584
ds_read_b64 v[76:77], v4 offset:7680
ds_read_b64 v[46:47], v4 offset:3840
ds_read_b64 v[78:79], v4 offset:7936
s_waitcnt lgkmcnt(0)
v_pk_add_f32 v[14:15], v[16:17], v[48:49] neg_lo:[0,1] neg_hi:[0,1]
v_pk_add_f32 v[16:17], v[16:17], v[48:49]
v_pk_add_f32 v[48:49], v[18:19], v[50:51] neg_lo:[0,1] neg_hi:[0,1]
v_pk_add_f32 v[18:19], v[18:19], v[50:51]
v_pk_mul_f32 v[50:51], v[48:49], s[50:51] op_sel:[0,0] op_sel_hi:[0,1] neg_lo:[0,0] neg_hi:[0,0]
v_pk_fma_f32 v[50:51], v[48:49], s[50:51], v[50:51] op_sel:[1,1,0] op_sel_hi:[1,0,1] neg_lo:[0,1,0] neg_hi:[0,0,0]
v_pk_add_f32 v[48:49], v[20:21], v[52:53] neg_lo:[0,1] neg_hi:[0,1]
v_pk_add_f32 v[20:21], v[20:21], v[52:53]
v_pk_mul_f32 v[52:53], v[48:49], s[54:55] op_sel:[0,0] op_sel_hi:[0,1] neg_lo:[0,0] neg_hi:[0,0]
v_pk_fma_f32 v[52:53], v[48:49], s[54:55], v[52:53] op_sel:[1,1,0] op_sel_hi:[1,0,1] neg_lo:[0,1,0] neg_hi:[0,0,0]
v_pk_add_f32 v[48:49], v[22:23], v[54:55] neg_lo:[0,1] neg_hi:[0,1]
v_pk_add_f32 v[22:23], v[22:23], v[54:55]
v_pk_mul_f32 v[54:55], v[48:49], s[58:59] op_sel:[0,0] op_sel_hi:[0,1] neg_lo:[0,0] neg_hi:[0,0]
v_pk_fma_f32 v[54:55], v[48:49], s[58:59], v[54:55] op_sel:[1,1,0] op_sel_hi:[1,0,1] neg_lo:[0,1,0] neg_hi:[0,0,0]
v_pk_add_f32 v[48:49], v[24:25], v[56:57] neg_lo:[0,1] neg_hi:[0,1]
v_pk_add_f32 v[24:25], v[24:25], v[56:57]
v_pk_mul_f32 v[56:57], v[48:49], s[62:63] op_sel:[0,0] op_sel_hi:[0,1] neg_lo:[0,0] neg_hi:[0,0]
v_pk_fma_f32 v[56:57], v[48:49], s[62:63], v[56:57] op_sel:[1,1,0] op_sel_hi:[1,0,1] neg_lo:[0,1,0] neg_hi:[0,0,0]
v_pk_add_f32 v[48:49], v[26:27], v[58:59] neg_lo:[0,1] neg_hi:[0,1]
v_pk_add_f32 v[26:27], v[26:27], v[58:59]
v_pk_mul_f32 v[58:59], v[48:49], s[58:59] op_sel:[0,1] op_sel_hi:[0,0] neg_lo:[0,0] neg_hi:[0,0]
v_pk_fma_f32 v[58:59], v[48:49], s[58:59], v[58:59] op_sel:[1,0,0] op_sel_hi:[1,1,1] neg_lo:[0,1,0] neg_hi:[0,0,0]
v_pk_add_f32 v[48:49], v[28:29], v[60:61] neg_lo:[0,1] neg_hi:[0,1]
v_pk_add_f32 v[28:29], v[28:29], v[60:61]
v_pk_mul_f32 v[60:61], v[48:49], s[54:55] op_sel:[0,1] op_sel_hi:[0,0] neg_lo:[0,0] neg_hi:[0,0]
v_pk_fma_f32 v[60:61], v[48:49], s[54:55], v[60:61] op_sel:[1,0,0] op_sel_hi:[1,1,1] neg_lo:[0,1,0] neg_hi:[0,0,0]
v_pk_add_f32 v[48:49], v[30:31], v[62:63] neg_lo:[0,1] neg_hi:[0,1]
v_pk_add_f32 v[30:31], v[30:31], v[62:63]
v_pk_mul_f32 v[62:63], v[48:49], s[50:51] op_sel:[0,1] op_sel_hi:[0,0] neg_lo:[0,0] neg_hi:[0,0]
v_pk_fma_f32 v[62:63], v[48:49], s[50:51], v[62:63] op_sel:[1,0,0] op_sel_hi:[1,1,1] neg_lo:[0,1,0] neg_hi:[0,0,0]
v_pk_add_f32 v[48:49], v[32:33], v[64:65] op_sel:[1,1] op_sel_hi:[0,0] neg_lo:[1,0] neg_hi:[0,1]
v_pk_add_f32 v[32:33], v[32:33], v[64:65]
v_pk_add_f32 v[64:65], v[34:35], v[66:67] neg_lo:[0,1] neg_hi:[0,1]
v_pk_add_f32 v[34:35], v[34:35], v[66:67]
v_pk_mul_f32 v[66:67], v[64:65], s[50:51] op_sel:[0,1] op_sel_hi:[0,0] neg_lo:[0,1] neg_hi:[0,0]
v_pk_fma_f32 v[66:67], v[64:65], s[50:51], v[66:67] op_sel:[1,0,0] op_sel_hi:[1,1,1] neg_lo:[0,1,0] neg_hi:[0,1,0]
v_pk_add_f32 v[64:65], v[36:37], v[68:69] neg_lo:[0,1] neg_hi:[0,1]
v_pk_add_f32 v[36:37], v[36:37], v[68:69]
v_pk_mul_f32 v[68:69], v[64:65], s[54:55] op_sel:[0,1] op_sel_hi:[0,0] neg_lo:[0,1] neg_hi:[0,0]
v_pk_fma_f32 v[68:69], v[64:65], s[54:55], v[68:69] op_sel:[1,0,0] op_sel_hi:[1,1,1] neg_lo:[0,1,0] neg_hi:[0,1,0]
v_pk_add_f32 v[64:65], v[38:39], v[70:71] neg_lo:[0,1] neg_hi:[0,1]
v_pk_add_f32 v[38:39], v[38:39], v[70:71]
v_pk_mul_f32 v[70:71], v[64:65], s[58:59] op_sel:[0,1] op_sel_hi:[0,0] neg_lo:[0,1] neg_hi:[0,0]
v_pk_fma_f32 v[70:71], v[64:65], s[58:59], v[70:71] op_sel:[1,0,0] op_sel_hi:[1,1,1] neg_lo:[0,1,0] neg_hi:[0,1,0]
v_pk_add_f32 v[64:65], v[40:41], v[72:73] neg_lo:[0,1] neg_hi:[0,1]
v_pk_add_f32 v[40:41], v[40:41], v[72:73]
v_pk_mul_f32 v[72:73], v[64:65], s[62:63] op_sel:[0,0] op_sel_hi:[0,1] neg_lo:[0,1] neg_hi:[0,0]
v_pk_fma_f32 v[72:73], v[64:65], s[62:63], v[72:73] op_sel:[1,1,0] op_sel_hi:[1,0,1] neg_lo:[0,1,0] neg_hi:[0,1,0]
v_pk_add_f32 v[64:65], v[42:43], v[74:75] neg_lo:[0,1] neg_hi:[0,1]
v_pk_add_f32 v[42:43], v[42:43], v[74:75]
v_pk_mul_f32 v[74:75], v[64:65], s[58:59] op_sel:[0,0] op_sel_hi:[0,1] neg_lo:[0,1] neg_hi:[0,0]
v_pk_fma_f32 v[74:75], v[64:65], s[58:59], v[74:75] op_sel:[1,1,0] op_sel_hi:[1,0,1] neg_lo:[0,1,0] neg_hi:[0,1,0]
v_pk_add_f32 v[64:65], v[44:45], v[76:77] neg_lo:[0,1] neg_hi:[0,1]
v_pk_add_f32 v[44:45], v[44:45], v[76:77]
v_pk_mul_f32 v[76:77], v[64:65], s[54:55] op_sel:[0,0] op_sel_hi:[0,1] neg_lo:[0,1] neg_hi:[0,0]
v_pk_fma_f32 v[76:77], v[64:65], s[54:55], v[76:77] op_sel:[1,1,0] op_sel_hi:[1,0,1] neg_lo:[0,1,0] neg_hi:[0,1,0]
v_pk_add_f32 v[64:65], v[46:47], v[78:79] neg_lo:[0,1] neg_hi:[0,1]
v_pk_add_f32 v[46:47], v[46:47], v[78:79]
v_pk_mul_f32 v[78:79], v[64:65], s[50:51] op_sel:[0,0] op_sel_hi:[0,1] neg_lo:[0,1] neg_hi:[0,0]
v_pk_fma_f32 v[78:79], v[64:65], s[50:51], v[78:79] op_sel:[1,1,0] op_sel_hi:[1,0,1] neg_lo:[0,1,0] neg_hi:[0,1,0]
v_pk_add_f32 v[64:65], v[16:17], v[32:33] neg_lo:[0,1] neg_hi:[0,1]
v_pk_add_f32 v[16:17], v[16:17], v[32:33]
v_pk_add_f32 v[32:33], v[18:19], v[34:35] neg_lo:[0,1] neg_hi:[0,1]
v_pk_add_f32 v[18:19], v[18:19], v[34:35]
v_pk_mul_f32 v[34:35], v[32:33], s[54:55] op_sel:[0,0] op_sel_hi:[0,1] neg_lo:[0,0] neg_hi:[0,0]
v_pk_fma_f32 v[34:35], v[32:33], s[54:55], v[34:35] op_sel:[1,1,0] op_sel_hi:[1,0,1] neg_lo:[0,1,0] neg_hi:[0,0,0]
v_pk_add_f32 v[32:33], v[20:21], v[36:37] neg_lo:[0,1] neg_hi:[0,1]
v_pk_add_f32 v[20:21], v[20:21], v[36:37]
v_pk_mul_f32 v[36:37], v[32:33], s[62:63] op_sel:[0,0] op_sel_hi:[0,1] neg_lo:[0,0] neg_hi:[0,0]
v_pk_fma_f32 v[36:37], v[32:33], s[62:63], v[36:37] op_sel:[1,1,0] op_sel_hi:[1,0,1] neg_lo:[0,1,0] neg_hi:[0,0,0]
v_pk_add_f32 v[32:33], v[22:23], v[38:39] neg_lo:[0,1] neg_hi:[0,1]
v_pk_add_f32 v[22:23], v[22:23], v[38:39]
v_pk_mul_f32 v[38:39], v[32:33], s[54:55] op_sel:[0,1] op_sel_hi:[0,0] neg_lo:[0,0] neg_hi:[0,0]
v_pk_fma_f32 v[38:39], v[32:33], s[54:55], v[38:39] op_sel:[1,0,0] op_sel_hi:[1,1,1] neg_lo:[0,1,0] neg_hi:[0,0,0]
v_pk_add_f32 v[32:33], v[24:25], v[40:41] op_sel:[1,1] op_sel_hi:[0,0] neg_lo:[1,0] neg_hi:[0,1]
v_pk_add_f32 v[24:25], v[24:25], v[40:41]
v_pk_add_f32 v[40:41], v[26:27], v[42:43] neg_lo:[0,1] neg_hi:[0,1]
v_pk_add_f32 v[26:27], v[26:27], v[42:43]
v_pk_mul_f32 v[42:43], v[40:41], s[54:55] op_sel:[0,1] op_sel_hi:[0,0] neg_lo:[0,1] neg_hi:[0,0]
v_pk_fma_f32 v[42:43], v[40:41], s[54:55], v[42:43] op_sel:[1,0,0] op_sel_hi:[1,1,1] neg_lo:[0,1,0] neg_hi:[0,1,0]
v_pk_add_f32 v[40:41], v[28:29], v[44:45] neg_lo:[0,1] neg_hi:[0,1]
v_pk_add_f32 v[28:29], v[28:29], v[44:45]
v_pk_mul_f32 v[44:45], v[40:41], s[62:63] op_sel:[0,0] op_sel_hi:[0,1] neg_lo:[0,1] neg_hi:[0,0]
v_pk_fma_f32 v[44:45], v[40:41], s[62:63], v[44:45] op_sel:[1,1,0] op_sel_hi:[1,0,1] neg_lo:[0,1,0] neg_hi:[0,1,0]
v_pk_add_f32 v[40:41], v[30:31], v[46:47] neg_lo:[0,1] neg_hi:[0,1]
v_pk_add_f32 v[30:31], v[30:31], v[46:47]
v_pk_mul_f32 v[46:47], v[40:41], s[54:55] op_sel:[0,0] op_sel_hi:[0,1] neg_lo:[0,1] neg_hi:[0,0]
v_pk_fma_f32 v[46:47], v[40:41], s[54:55], v[46:47] op_sel:[1,1,0] op_sel_hi:[1,0,1] neg_lo:[0,1,0] neg_hi:[0,1,0]
v_pk_add_f32 v[40:41], v[14:15], v[48:49] neg_lo:[0,1] neg_hi:[0,1]
v_pk_add_f32 v[14:15], v[14:15], v[48:49]
v_pk_add_f32 v[48:49], v[50:51], v[66:67] neg_lo:[0,1] neg_hi:[0,1]
v_pk_add_f32 v[50:51], v[50:51], v[66:67]
v_pk_mul_f32 v[66:67], v[48:49], s[54:55] op_sel:[0,0] op_sel_hi:[0,1] neg_lo:[0,0] neg_hi:[0,0]
v_pk_fma_f32 v[66:67], v[48:49], s[54:55], v[66:67] op_sel:[1,1,0] op_sel_hi:[1,0,1] neg_lo:[0,1,0] neg_hi:[0,0,0]
v_pk_add_f32 v[48:49], v[52:53], v[68:69] neg_lo:[0,1] neg_hi:[0,1]
v_pk_add_f32 v[52:53], v[52:53], v[68:69]
v_pk_mul_f32 v[68:69], v[48:49], s[62:63] op_sel:[0,0] op_sel_hi:[0,1] neg_lo:[0,0] neg_hi:[0,0]
v_pk_fma_f32 v[68:69], v[48:49], s[62:63], v[68:69] op_sel:[1,1,0] op_sel_hi:[1,0,1] neg_lo:[0,1,0] neg_hi:[0,0,0]
v_pk_add_f32 v[48:49], v[54:55], v[70:71] neg_lo:[0,1] neg_hi:[0,1]
v_pk_add_f32 v[54:55], v[54:55], v[70:71]
v_pk_mul_f32 v[70:71], v[48:49], s[54:55] op_sel:[0,1] op_sel_hi:[0,0] neg_lo:[0,0] neg_hi:[0,0]
v_pk_fma_f32 v[70:71], v[48:49], s[54:55], v[70:71] op_sel:[1,0,0] op_sel_hi:[1,1,1] neg_lo:[0,1,0] neg_hi:[0,0,0]
v_pk_add_f32 v[48:49], v[56:57], v[72:73] op_sel:[1,1] op_sel_hi:[0,0] neg_lo:[1,0] neg_hi:[0,1]
v_pk_add_f32 v[56:57], v[56:57], v[72:73]
v_pk_add_f32 v[72:73], v[58:59], v[74:75] neg_lo:[0,1] neg_hi:[0,1]
v_pk_add_f32 v[58:59], v[58:59], v[74:75]
v_pk_mul_f32 v[74:75], v[72:73], s[54:55] op_sel:[0,1] op_sel_hi:[0,0] neg_lo:[0,1] neg_hi:[0,0]
v_pk_fma_f32 v[74:75], v[72:73], s[54:55], v[74:75] op_sel:[1,0,0] op_sel_hi:[1,1,1] neg_lo:[0,1,0] neg_hi:[0,1,0]
v_pk_add_f32 v[72:73], v[60:61], v[76:77] neg_lo:[0,1] neg_hi:[0,1]
v_pk_add_f32 v[60:61], v[60:61], v[76:77]
v_pk_mul_f32 v[76:77], v[72:73], s[62:63] op_sel:[0,0] op_sel_hi:[0,1] neg_lo:[0,1] neg_hi:[0,0]
v_pk_fma_f32 v[76:77], v[72:73], s[62:63], v[76:77] op_sel:[1,1,0] op_sel_hi:[1,0,1] neg_lo:[0,1,0] neg_hi:[0,1,0]
v_pk_add_f32 v[72:73], v[62:63], v[78:79] neg_lo:[0,1] neg_hi:[0,1]
v_pk_add_f32 v[62:63], v[62:63], v[78:79]
v_pk_mul_f32 v[78:79], v[72:73], s[54:55] op_sel:[0,0] op_sel_hi:[0,1] neg_lo:[0,1] neg_hi:[0,0]
v_pk_fma_f32 v[78:79], v[72:73], s[54:55], v[78:79] op_sel:[1,1,0] op_sel_hi:[1,0,1] neg_lo:[0,1,0] neg_hi:[0,1,0]
v_pk_add_f32 v[72:73], v[16:17], v[24:25] neg_lo:[0,1] neg_hi:[0,1]
v_pk_add_f32 v[16:17], v[16:17], v[24:25]
v_pk_add_f32 v[24:25], v[18:19], v[26:27] neg_lo:[0,1] neg_hi:[0,1]
v_pk_add_f32 v[18:19], v[18:19], v[26:27]
v_pk_mul_f32 v[26:27], v[24:25], s[62:63] op_sel:[0,0] op_sel_hi:[0,1] neg_lo:[0,0] neg_hi:[0,0]
v_pk_fma_f32 v[26:27], v[24:25], s[62:63], v[26:27] op_sel:[1,1,0] op_sel_hi:[1,0,1] neg_lo:[0,1,0] neg_hi:[0,0,0]
v_pk_add_f32 v[24:25], v[20:21], v[28:29] op_sel:[1,1] op_sel_hi:[0,0] neg_lo:[1,0] neg_hi:[0,1]
v_pk_add_f32 v[20:21], v[20:21], v[28:29]
v_pk_add_f32 v[28:29], v[22:23], v[30:31] neg_lo:[0,1] neg_hi:[0,1]
v_pk_add_f32 v[22:23], v[22:23], v[30:31]
v_pk_mul_f32 v[30:31], v[28:29], s[62:63] op_sel:[0,0] op_sel_hi:[0,1] neg_lo:[0,1] neg_hi:[0,0]
v_pk_fma_f32 v[30:31], v[28:29], s[62:63], v[30:31] op_sel:[1,1,0] op_sel_hi:[1,0,1] neg_lo:[0,1,0] neg_hi:[0,1,0]
v_pk_add_f32 v[28:29], v[64:65], v[32:33] neg_lo:[0,1] neg_hi:[0,1]
v_pk_add_f32 v[64:65], v[64:65], v[32:33]
v_pk_add_f32 v[32:33], v[34:35], v[42:43] neg_lo:[0,1] neg_hi:[0,1]
v_pk_add_f32 v[34:35], v[34:35], v[42:43]
v_pk_mul_f32 v[42:43], v[32:33], s[62:63] op_sel:[0,0] op_sel_hi:[0,1] neg_lo:[0,0] neg_hi:[0,0]
v_pk_fma_f32 v[42:43], v[32:33], s[62:63], v[42:43] op_sel:[1,1,0] op_sel_hi:[1,0,1] neg_lo:[0,1,0] neg_hi:[0,0,0]
v_pk_add_f32 v[32:33], v[36:37], v[44:45] op_sel:[1,1] op_sel_hi:[0,0] neg_lo:[1,0] neg_hi:[0,1]
v_pk_add_f32 v[36:37], v[36:37], v[44:45]
v_pk_add_f32 v[44:45], v[38:39], v[46:47] neg_lo:[0,1] neg_hi:[0,1]
v_pk_add_f32 v[38:39], v[38:39], v[46:47]
v_pk_mul_f32 v[46:47], v[44:45], s[62:63] op_sel:[0,0] op_sel_hi:[0,1] neg_lo:[0,1] neg_hi:[0,0]
v_pk_fma_f32 v[46:47], v[44:45], s[62:63], v[46:47] op_sel:[1,1,0] op_sel_hi:[1,0,1] neg_lo:[0,1,0] neg_hi:[0,1,0]
v_pk_add_f32 v[44:45], v[14:15], v[56:57] neg_lo:[0,1] neg_hi:[0,1]
v_pk_add_f32 v[14:15], v[14:15], v[56:57]
v_pk_add_f32 v[56:57], v[50:51], v[58:59] neg_lo:[0,1] neg_hi:[0,1]
v_pk_add_f32 v[50:51], v[50:51], v[58:59]
v_pk_mul_f32 v[58:59], v[56:57], s[62:63] op_sel:[0,0] op_sel_hi:[0,1] neg_lo:[0,0] neg_hi:[0,0]
v_pk_fma_f32 v[58:59], v[56:57], s[62:63], v[58:59] op_sel:[1,1,0] op_sel_hi:[1,0,1] neg_lo:[0,1,0] neg_hi:[0,0,0]
v_pk_add_f32 v[56:57], v[52:53], v[60:61] op_sel:[1,1] op_sel_hi:[0,0] neg_lo:[1,0] neg_hi:[0,1]
v_pk_add_f32 v[52:53], v[52:53], v[60:61]
v_pk_add_f32 v[60:61], v[54:55], v[62:63] neg_lo:[0,1] neg_hi:[0,1]
v_pk_add_f32 v[54:55], v[54:55], v[62:63]
v_pk_mul_f32 v[62:63], v[60:61], s[62:63] op_sel:[0,0] op_sel_hi:[0,1] neg_lo:[0,1] neg_hi:[0,0]
v_pk_fma_f32 v[62:63], v[60:61], s[62:63], v[62:63] op_sel:[1,1,0] op_sel_hi:[1,0,1] neg_lo:[0,1,0] neg_hi:[0,1,0]
v_pk_add_f32 v[60:61], v[40:41], v[48:49] neg_lo:[0,1] neg_hi:[0,1]
v_pk_add_f32 v[40:41], v[40:41], v[48:49]
v_pk_add_f32 v[48:49], v[66:67], v[74:75] neg_lo:[0,1] neg_hi:[0,1]
v_pk_add_f32 v[66:67], v[66:67], v[74:75]
v_pk_mul_f32 v[74:75], v[48:49], s[62:63] op_sel:[0,0] op_sel_hi:[0,1] neg_lo:[0,0] neg_hi:[0,0]
v_pk_fma_f32 v[74:75], v[48:49], s[62:63], v[74:75] op_sel:[1,1,0] op_sel_hi:[1,0,1] neg_lo:[0,1,0] neg_hi:[0,0,0]
v_pk_add_f32 v[48:49], v[68:69], v[76:77] op_sel:[1,1] op_sel_hi:[0,0] neg_lo:[1,0] neg_hi:[0,1]
v_pk_add_f32 v[68:69], v[68:69], v[76:77]
v_pk_add_f32 v[76:77], v[70:71], v[78:79] neg_lo:[0,1] neg_hi:[0,1]
v_pk_add_f32 v[70:71], v[70:71], v[78:79]
v_pk_mul_f32 v[78:79], v[76:77], s[62:63] op_sel:[0,0] op_sel_hi:[0,1] neg_lo:[0,1] neg_hi:[0,0]
v_pk_fma_f32 v[78:79], v[76:77], s[62:63], v[78:79] op_sel:[1,1,0] op_sel_hi:[1,0,1] neg_lo:[0,1,0] neg_hi:[0,1,0]
v_pk_add_f32 v[76:77], v[16:17], v[20:21] neg_lo:[0,1] neg_hi:[0,1]
v_pk_add_f32 v[16:17], v[16:17], v[20:21]
v_pk_add_f32 v[20:21], v[18:19], v[22:23] op_sel:[1,1] op_sel_hi:[0,0] neg_lo:[1,0] neg_hi:[0,1]
v_pk_add_f32 v[18:19], v[18:19], v[22:23]
v_pk_add_f32 v[22:23], v[72:73], v[24:25] neg_lo:[0,1] neg_hi:[0,1]
v_pk_add_f32 v[72:73], v[72:73], v[24:25]
v_pk_add_f32 v[24:25], v[26:27], v[30:31] op_sel:[1,1] op_sel_hi:[0,0] neg_lo:[1,0] neg_hi:[0,1]
v_pk_add_f32 v[26:27], v[26:27], v[30:31]
v_pk_add_f32 v[30:31], v[64:65], v[36:37] neg_lo:[0,1] neg_hi:[0,1]
v_pk_add_f32 v[64:65], v[64:65], v[36:37]
v_pk_add_f32 v[36:37], v[34:35], v[38:39] op_sel:[1,1] op_sel_hi:[0,0] neg_lo:[1,0] neg_hi:[0,1]
v_pk_add_f32 v[34:35], v[34:35], v[38:39]
v_pk_add_f32 v[38:39], v[28:29], v[32:33] neg_lo:[0,1] neg_hi:[0,1]
v_pk_add_f32 v[28:29], v[28:29], v[32:33]
v_pk_add_f32 v[32:33], v[42:43], v[46:47] op_sel:[1,1] op_sel_hi:[0,0] neg_lo:[1,0] neg_hi:[0,1]
v_pk_add_f32 v[42:43], v[42:43], v[46:47]
v_pk_add_f32 v[46:47], v[14:15], v[52:53] neg_lo:[0,1] neg_hi:[0,1]
v_pk_add_f32 v[14:15], v[14:15], v[52:53]
v_pk_add_f32 v[52:53], v[50:51], v[54:55] op_sel:[1,1] op_sel_hi:[0,0] neg_lo:[1,0] neg_hi:[0,1]
v_pk_add_f32 v[50:51], v[50:51], v[54:55]
v_pk_add_f32 v[54:55], v[44:45], v[56:57] neg_lo:[0,1] neg_hi:[0,1]
v_pk_add_f32 v[44:45], v[44:45], v[56:57]
v_pk_add_f32 v[56:57], v[58:59], v[62:63] op_sel:[1,1] op_sel_hi:[0,0] neg_lo:[1,0] neg_hi:[0,1]
v_pk_add_f32 v[58:59], v[58:59], v[62:63]
v_pk_add_f32 v[62:63], v[40:41], v[68:69] neg_lo:[0,1] neg_hi:[0,1]
v_pk_add_f32 v[40:41], v[40:41], v[68:69]
v_pk_add_f32 v[68:69], v[66:67], v[70:71] op_sel:[1,1] op_sel_hi:[0,0] neg_lo:[1,0] neg_hi:[0,1]
v_pk_add_f32 v[66:67], v[66:67], v[70:71]
v_pk_add_f32 v[70:71], v[60:61], v[48:49] neg_lo:[0,1] neg_hi:[0,1]
v_pk_add_f32 v[60:61], v[60:61], v[48:49]
v_pk_add_f32 v[48:49], v[74:75], v[78:79] op_sel:[1,1] op_sel_hi:[0,0] neg_lo:[1,0] neg_hi:[0,1]
v_pk_add_f32 v[74:75], v[74:75], v[78:79]
v_pk_add_f32 v[78:79], v[16:17], v[18:19] neg_lo:[0,1] neg_hi:[0,1]
v_pk_add_f32 v[16:17], v[16:17], v[18:19]
v_pk_add_f32 v[18:19], v[76:77], v[20:21] neg_lo:[0,1] neg_hi:[0,1]
v_pk_add_f32 v[76:77], v[76:77], v[20:21]
v_pk_add_f32 v[20:21], v[72:73], v[26:27] neg_lo:[0,1] neg_hi:[0,1]
v_pk_add_f32 v[72:73], v[72:73], v[26:27]
v_pk_add_f32 v[26:27], v[22:23], v[24:25] neg_lo:[0,1] neg_hi:[0,1]
v_pk_add_f32 v[22:23], v[22:23], v[24:25]
v_pk_add_f32 v[24:25], v[64:65], v[34:35] neg_lo:[0,1] neg_hi:[0,1]
v_pk_add_f32 v[64:65], v[64:65], v[34:35]
v_pk_add_f32 v[34:35], v[30:31], v[36:37] neg_lo:[0,1] neg_hi:[0,1]
v_pk_add_f32 v[30:31], v[30:31], v[36:37]
v_pk_add_f32 v[36:37], v[28:29], v[42:43] neg_lo:[0,1] neg_hi:[0,1]
v_pk_add_f32 v[28:29], v[28:29], v[42:43]
v_pk_add_f32 v[42:43], v[38:39], v[32:33] neg_lo:[0,1] neg_hi:[0,1]
v_pk_add_f32 v[38:39], v[38:39], v[32:33]
v_pk_add_f32 v[32:33], v[14:15], v[50:51] neg_lo:[0,1] neg_hi:[0,1]
v_pk_add_f32 v[14:15], v[14:15], v[50:51]
v_pk_add_f32 v[50:51], v[46:47], v[52:53] neg_lo:[0,1] neg_hi:[0,1]
v_pk_add_f32 v[46:47], v[46:47], v[52:53]
v_pk_add_f32 v[52:53], v[44:45], v[58:59] neg_lo:[0,1] neg_hi:[0,1]
v_pk_add_f32 v[44:45], v[44:45], v[58:59]
v_pk_add_f32 v[58:59], v[54:55], v[56:57] neg_lo:[0,1] neg_hi:[0,1]
v_pk_add_f32 v[54:55], v[54:55], v[56:57]
v_pk_add_f32 v[56:57], v[40:41], v[66:67] neg_lo:[0,1] neg_hi:[0,1]
v_pk_add_f32 v[40:41], v[40:41], v[66:67]
v_pk_add_f32 v[66:67], v[62:63], v[68:69] neg_lo:[0,1] neg_hi:[0,1]
v_pk_add_f32 v[62:63], v[62:63], v[68:69]
v_pk_add_f32 v[68:69], v[60:61], v[74:75] neg_lo:[0,1] neg_hi:[0,1]
v_pk_add_f32 v[60:61], v[60:61], v[74:75]
v_pk_add_f32 v[74:75], v[70:71], v[48:49] neg_lo:[0,1] neg_hi:[0,1]
v_pk_add_f32 v[70:71], v[70:71], v[48:49]
v_pk_mul_f32 v[48:49], v[14:15], v[82:83] op_sel:[0,0] op_sel_hi:[0,1] neg_lo:[0,0] neg_hi:[0,0]
v_pk_fma_f32 v[14:15], v[14:15], v[82:83], v[48:49] op_sel:[1,1,0] op_sel_hi:[1,0,1] neg_lo:[0,1,0] neg_hi:[0,0,0]
v_pk_mul_f32 v[48:49], v[64:65], v[84:85] op_sel:[0,0] op_sel_hi:[0,1] neg_lo:[0,0] neg_hi:[0,0]
v_pk_fma_f32 v[64:65], v[64:65], v[84:85], v[48:49] op_sel:[1,1,0] op_sel_hi:[1,0,1] neg_lo:[0,1,0] neg_hi:[0,0,0]
v_pk_mul_f32 v[48:49], v[40:41], v[86:87] op_sel:[0,0] op_sel_hi:[0,1] neg_lo:[0,0] neg_hi:[0,0]
v_pk_fma_f32 v[40:41], v[40:41], v[86:87], v[48:49] op_sel:[1,1,0] op_sel_hi:[1,0,1] neg_lo:[0,1,0] neg_hi:[0,0,0]
v_pk_mul_f32 v[48:49], v[72:73], v[88:89] op_sel:[0,0] op_sel_hi:[0,1] neg_lo:[0,0] neg_hi:[0,0]
v_pk_fma_f32 v[72:73], v[72:73], v[88:89], v[48:49] op_sel:[1,1,0] op_sel_hi:[1,0,1] neg_lo:[0,1,0] neg_hi:[0,0,0]
v_pk_mul_f32 v[48:49], v[44:45], v[90:91] op_sel:[0,0] op_sel_hi:[0,1] neg_lo:[0,0] neg_hi:[0,0]
v_pk_fma_f32 v[44:45], v[44:45], v[90:91], v[48:49] op_sel:[1,1,0] op_sel_hi:[1,0,1] neg_lo:[0,1,0] neg_hi:[0,0,0]
v_pk_mul_f32 v[48:49], v[28:29], v[92:93] op_sel:[0,0] op_sel_hi:[0,1] neg_lo:[0,0] neg_hi:[0,0]
v_pk_fma_f32 v[28:29], v[28:29], v[92:93], v[48:49] op_sel:[1,1,0] op_sel_hi:[1,0,1] neg_lo:[0,1,0] neg_hi:[0,0,0]
v_pk_mul_f32 v[48:49], v[60:61], v[94:95] op_sel:[0,0] op_sel_hi:[0,1] neg_lo:[0,0] neg_hi:[0,0]
v_pk_fma_f32 v[60:61], v[60:61], v[94:95], v[48:49] op_sel:[1,1,0] op_sel_hi:[1,0,1] neg_lo:[0,1,0] neg_hi:[0,0,0]
v_pk_mul_f32 v[48:49], v[76:77], v[96:97] op_sel:[0,0] op_sel_hi:[0,1] neg_lo:[0,0] neg_hi:[0,0]
v_pk_fma_f32 v[76:77], v[76:77], v[96:97], v[48:49] op_sel:[1,1,0] op_sel_hi:[1,0,1] neg_lo:[0,1,0] neg_hi:[0,0,0]
v_pk_mul_f32 v[48:49], v[46:47], v[98:99] op_sel:[0,0] op_sel_hi:[0,1] neg_lo:[0,0] neg_hi:[0,0]
v_pk_fma_f32 v[46:47], v[46:47], v[98:99], v[48:49] op_sel:[1,1,0] op_sel_hi:[1,0,1] neg_lo:[0,1,0] neg_hi:[0,0,0]
v_pk_mul_f32 v[48:49], v[30:31], v[100:101] op_sel:[0,0] op_sel_hi:[0,1] neg_lo:[0,0] neg_hi:[0,0]
v_pk_fma_f32 v[30:31], v[30:31], v[100:101], v[48:49] op_sel:[1,1,0] op_sel_hi:[1,0,1] neg_lo:[0,1,0] neg_hi:[0,0,0]
v_pk_mul_f32 v[48:49], v[62:63], v[102:103] op_sel:[0,0] op_sel_hi:[0,1] neg_lo:[0,0] neg_hi:[0,0]
v_pk_fma_f32 v[62:63], v[62:63], v[102:103], v[48:49] op_sel:[1,1,0] op_sel_hi:[1,0,1] neg_lo:[0,1,0] neg_hi:[0,0,0]
v_pk_mul_f32 v[48:49], v[22:23], v[104:105] op_sel:[0,0] op_sel_hi:[0,1] neg_lo:[0,0] neg_hi:[0,0]
v_pk_fma_f32 v[22:23], v[22:23], v[104:105], v[48:49] op_sel:[1,1,0] op_sel_hi:[1,0,1] neg_lo:[0,1,0] neg_hi:[0,0,0]
v_pk_mul_f32 v[48:49], v[54:55], v[106:107] op_sel:[0,0] op_sel_hi:[0,1] neg_lo:[0,0] neg_hi:[0,0]
v_pk_fma_f32 v[54:55], v[54:55], v[106:107], v[48:49] op_sel:[1,1,0] op_sel_hi:[1,0,1] neg_lo:[0,1,0] neg_hi:[0,0,0]
v_pk_mul_f32 v[48:49], v[38:39], v[108:109] op_sel:[0,0] op_sel_hi:[0,1] neg_lo:[0,0] neg_hi:[0,0]
v_pk_fma_f32 v[38:39], v[38:39], v[108:109], v[48:49] op_sel:[1,1,0] op_sel_hi:[1,0,1] neg_lo:[0,1,0] neg_hi:[0,0,0]
v_pk_mul_f32 v[48:49], v[70:71], v[110:111] op_sel:[0,0] op_sel_hi:[0,1] neg_lo:[0,0] neg_hi:[0,0]
v_pk_fma_f32 v[70:71], v[70:71], v[110:111], v[48:49] op_sel:[1,1,0] op_sel_hi:[1,0,1] neg_lo:[0,1,0] neg_hi:[0,0,0]
v_pk_mul_f32 v[48:49], v[78:79], v[112:113] op_sel:[0,0] op_sel_hi:[0,1] neg_lo:[0,0] neg_hi:[0,0]
v_pk_fma_f32 v[78:79], v[78:79], v[112:113], v[48:49] op_sel:[1,1,0] op_sel_hi:[1,0,1] neg_lo:[0,1,0] neg_hi:[0,0,0]
v_pk_mul_f32 v[48:49], v[32:33], v[114:115] op_sel:[0,0] op_sel_hi:[0,1] neg_lo:[0,0] neg_hi:[0,0]
v_pk_fma_f32 v[32:33], v[32:33], v[114:115], v[48:49] op_sel:[1,1,0] op_sel_hi:[1,0,1] neg_lo:[0,1,0] neg_hi:[0,0,0]
v_pk_mul_f32 v[48:49], v[24:25], v[116:117] op_sel:[0,0] op_sel_hi:[0,1] neg_lo:[0,0] neg_hi:[0,0]
v_pk_fma_f32 v[24:25], v[24:25], v[116:117], v[48:49] op_sel:[1,1,0] op_sel_hi:[1,0,1] neg_lo:[0,1,0] neg_hi:[0,0,0]
v_pk_mul_f32 v[48:49], v[56:57], v[118:119] op_sel:[0,0] op_sel_hi:[0,1] neg_lo:[0,0] neg_hi:[0,0]
v_pk_fma_f32 v[56:57], v[56:57], v[118:119], v[48:49] op_sel:[1,1,0] op_sel_hi:[1,0,1] neg_lo:[0,1,0] neg_hi:[0,0,0]
v_pk_mul_f32 v[48:49], v[20:21], v[120:121] op_sel:[0,0] op_sel_hi:[0,1] neg_lo:[0,0] neg_hi:[0,0]
v_pk_fma_f32 v[20:21], v[20:21], v[120:121], v[48:49] op_sel:[1,1,0] op_sel_hi:[1,0,1] neg_lo:[0,1,0] neg_hi:[0,0,0]
v_pk_mul_f32 v[48:49], v[52:53], v[122:123] op_sel:[0,0] op_sel_hi:[0,1] neg_lo:[0,0] neg_hi:[0,0]
v_pk_fma_f32 v[52:53], v[52:53], v[122:123], v[48:49] op_sel:[1,1,0] op_sel_hi:[1,0,1] neg_lo:[0,1,0] neg_hi:[0,0,0]
v_pk_mul_f32 v[48:49], v[36:37], v[124:125] op_sel:[0,0] op_sel_hi:[0,1] neg_lo:[0,0] neg_hi:[0,0]
v_pk_fma_f32 v[36:37], v[36:37], v[124:125], v[48:49] op_sel:[1,1,0] op_sel_hi:[1,0,1] neg_lo:[0,1,0] neg_hi:[0,0,0]
v_pk_mul_f32 v[48:49], v[68:69], v[126:127] op_sel:[0,0] op_sel_hi:[0,1] neg_lo:[0,0] neg_hi:[0,0]
v_pk_fma_f32 v[68:69], v[68:69], v[126:127], v[48:49] op_sel:[1,1,0] op_sel_hi:[1,0,1] neg_lo:[0,1,0] neg_hi:[0,0,0]
v_pk_mul_f32 v[48:49], v[18:19], v[128:129] op_sel:[0,0] op_sel_hi:[0,1] neg_lo:[0,0] neg_hi:[0,0]
v_pk_fma_f32 v[18:19], v[18:19], v[128:129], v[48:49] op_sel:[1,1,0] op_sel_hi:[1,0,1] neg_lo:[0,1,0] neg_hi:[0,0,0]
v_pk_mul_f32 v[48:49], v[50:51], v[130:131] op_sel:[0,0] op_sel_hi:[0,1] neg_lo:[0,0] neg_hi:[0,0]
v_pk_fma_f32 v[50:51], v[50:51], v[130:131], v[48:49] op_sel:[1,1,0] op_sel_hi:[1,0,1] neg_lo:[0,1,0] neg_hi:[0,0,0]
v_pk_mul_f32 v[48:49], v[34:35], v[132:133] op_sel:[0,0] op_sel_hi:[0,1] neg_lo:[0,0] neg_hi:[0,0]
v_pk_fma_f32 v[34:35], v[34:35], v[132:133], v[48:49] op_sel:[1,1,0] op_sel_hi:[1,0,1] neg_lo:[0,1,0] neg_hi:[0,0,0]
v_pk_mul_f32 v[48:49], v[66:67], v[134:135] op_sel:[0,0] op_sel_hi:[0,1] neg_lo:[0,0] neg_hi:[0,0]
v_pk_fma_f32 v[66:67], v[66:67], v[134:135], v[48:49] op_sel:[1,1,0] op_sel_hi:[1,0,1] neg_lo:[0,1,0] neg_hi:[0,0,0]
v_pk_mul_f32 v[48:49], v[26:27], v[136:137] op_sel:[0,0] op_sel_hi:[0,1] neg_lo:[0,0] neg_hi:[0,0]
v_pk_fma_f32 v[26:27], v[26:27], v[136:137], v[48:49] op_sel:[1,1,0] op_sel_hi:[1,0,1] neg_lo:[0,1,0] neg_hi:[0,0,0]
v_pk_mul_f32 v[48:49], v[58:59], v[138:139] op_sel:[0,0] op_sel_hi:[0,1] neg_lo:[0,0] neg_hi:[0,0]
v_pk_fma_f32 v[58:59], v[58:59], v[138:139], v[48:49] op_sel:[1,1,0] op_sel_hi:[1,0,1] neg_lo:[0,1,0] neg_hi:[0,0,0]
v_pk_mul_f32 v[48:49], v[42:43], v[140:141] op_sel:[0,0] op_sel_hi:[0,1] neg_lo:[0,0] neg_hi:[0,0]
v_pk_fma_f32 v[42:43], v[42:43], v[140:141], v[48:49] op_sel:[1,1,0] op_sel_hi:[1,0,1] neg_lo:[0,1,0] neg_hi:[0,0,0]
v_pk_mul_f32 v[48:49], v[74:75], v[142:143] op_sel:[0,0] op_sel_hi:[0,1] neg_lo:[0,0] neg_hi:[0,0]
v_pk_fma_f32 v[74:75], v[74:75], v[142:143], v[48:49] op_sel:[1,1,0] op_sel_hi:[1,0,1] neg_lo:[0,1,0] neg_hi:[0,0,0]
ds_write_b64 v4, v[16:17] offset:0
ds_write_b64 v4, v[14:15] offset:264
ds_write_b64 v4, v[64:65] offset:528
ds_write_b64 v4, v[40:41] offset:792
ds_write_b64 v4, v[72:73] offset:1056
ds_write_b64 v4, v[44:45] offset:1320
ds_write_b64 v4, v[28:29] offset:1584
ds_write_b64 v4, v[60:61] offset:1848
ds_write_b64 v4, v[76:77] offset:2112
ds_write_b64 v4, v[46:47] offset:2376
ds_write_b64 v4, v[30:31] offset:2640
ds_write_b64 v4, v[62:63] offset:2904
ds_write_b64 v4, v[22:23] offset:3168
ds_write_b64 v4, v[54:55] offset:3432
ds_write_b64 v4, v[38:39] offset:3696
ds_write_b64 v4, v[70:71] offset:3960
ds_write_b64 v4, v[78:79] offset:4224
ds_write_b64 v4, v[32:33] offset:4488
ds_write_b64 v4, v[24:25] offset:4752
ds_write_b64 v4, v[56:57] offset:5016
ds_write_b64 v4, v[20:21] offset:5280
ds_write_b64 v4, v[52:53] offset:5544
ds_write_b64 v4, v[36:37] offset:5808
ds_write_b64 v4, v[68:69] offset:6072
ds_write_b64 v4, v[18:19] offset:6336
ds_write_b64 v4, v[50:51] offset:6600
ds_write_b64 v4, v[34:35] offset:6864
ds_write_b64 v4, v[66:67] offset:7128
ds_write_b64 v4, v[26:27] offset:7392
ds_write_b64 v4, v[58:59] offset:7656
ds_write_b64 v4, v[42:43] offset:7920
ds_write_b64 v4, v[74:75] offset:8184
s_waitcnt lgkmcnt(0)
ds_read_b64 v[16:17], v5 offset:0
ds_read_b64 v[48:49], v5 offset:128
ds_read_b64 v[18:19], v5 offset:8
ds_read_b64 v[50:51], v5 offset:136
ds_read_b64 v[20:21], v5 offset:16
ds_read_b64 v[52:53], v5 offset:144
ds_read_b64 v[22:23], v5 offset:24
ds_read_b64 v[54:55], v5 offset:152
ds_read_b64 v[24:25], v5 offset:32
ds_read_b64 v[56:57], v5 offset:160
ds_read_b64 v[26:27], v5 offset:40
ds_read_b64 v[58:59], v5 offset:168
ds_read_b64 v[28:29], v5 offset:48
ds_read_b64 v[60:61], v5 offset:176
ds_read_b64 v[30:31], v5 offset:56
ds_read_b64 v[62:63], v5 offset:184
ds_read_b64 v[32:33], v5 offset:64
ds_read_b64 v[64:65], v5 offset:192
ds_read_b64 v[34:35], v5 offset:72
ds_read_b64 v[66:67], v5 offset:200
ds_read_b64 v[36:37], v5 offset:80
ds_read_b64 v[68:69], v5 offset:208
ds_read_b64 v[38:39], v5 offset:88
ds_read_b64 v[70:71], v5 offset:216
ds_read_b64 v[40:41], v5 offset:96
ds_read_b64 v[72:73], v5 offset:224
ds_read_b64 v[42:43], v5 offset:104
ds_read_b64 v[74:75], v5 offset:232
ds_read_b64 v[44:45], v5 offset:112
ds_read_b64 v[76:77], v5 offset:240
ds_read_b64 v[46:47], v5 offset:120
ds_read_b64 v[78:79], v5 offset:248
s_waitcnt lgkmcnt(0)
v_pk_add_f32 v[14:15], v[16:17], v[48:49] neg_lo:[0,1] neg_hi:[0,1]
v_pk_add_f32 v[16:17], v[16:17], v[48:49]
v_pk_add_f32 v[48:49], v[18:19], v[50:51] neg_lo:[0,1] neg_hi:[0,1]
v_pk_add_f32 v[18:19], v[18:19], v[50:51]
v_pk_mul_f32 v[50:51], v[48:49], s[50:51] op_sel:[0,0] op_sel_hi:[0,1] neg_lo:[0,0] neg_hi:[0,0]
v_pk_fma_f32 v[50:51], v[48:49], s[50:51], v[50:51] op_sel:[1,1,0] op_sel_hi:[1,0,1] neg_lo:[0,1,0] neg_hi:[0,0,0]
v_pk_add_f32 v[48:49], v[20:21], v[52:53] neg_lo:[0,1] neg_hi:[0,1]
v_pk_add_f32 v[20:21], v[20:21], v[52:53]
v_pk_mul_f32 v[52:53], v[48:49], s[54:55] op_sel:[0,0] op_sel_hi:[0,1] neg_lo:[0,0] neg_hi:[0,0]
v_pk_fma_f32 v[52:53], v[48:49], s[54:55], v[52:53] op_sel:[1,1,0] op_sel_hi:[1,0,1] neg_lo:[0,1,0] neg_hi:[0,0,0]
v_pk_add_f32 v[48:49], v[22:23], v[54:55] neg_lo:[0,1] neg_hi:[0,1]
v_pk_add_f32 v[22:23], v[22:23], v[54:55]
v_pk_mul_f32 v[54:55], v[48:49], s[58:59] op_sel:[0,0] op_sel_hi:[0,1] neg_lo:[0,0] neg_hi:[0,0]
v_pk_fma_f32 v[54:55], v[48:49], s[58:59], v[54:55] op_sel:[1,1,0] op_sel_hi:[1,0,1] neg_lo:[0,1,0] neg_hi:[0,0,0]
v_pk_add_f32 v[48:49], v[24:25], v[56:57] neg_lo:[0,1] neg_hi:[0,1]
v_pk_add_f32 v[24:25], v[24:25], v[56:57]
v_pk_mul_f32 v[56:57], v[48:49], s[62:63] op_sel:[0,0] op_sel_hi:[0,1] neg_lo:[0,0] neg_hi:[0,0]
v_pk_fma_f32 v[56:57], v[48:49], s[62:63], v[56:57] op_sel:[1,1,0] op_sel_hi:[1,0,1] neg_lo:[0,1,0] neg_hi:[0,0,0]
v_pk_add_f32 v[48:49], v[26:27], v[58:59] neg_lo:[0,1] neg_hi:[0,1]
v_pk_add_f32 v[26:27], v[26:27], v[58:59]
v_pk_mul_f32 v[58:59], v[48:49], s[58:59] op_sel:[0,1] op_sel_hi:[0,0] neg_lo:[0,0] neg_hi:[0,0]
v_pk_fma_f32 v[58:59], v[48:49], s[58:59], v[58:59] op_sel:[1,0,0] op_sel_hi:[1,1,1] neg_lo:[0,1,0] neg_hi:[0,0,0]
v_pk_add_f32 v[48:49], v[28:29], v[60:61] neg_lo:[0,1] neg_hi:[0,1]
v_pk_add_f32 v[28:29], v[28:29], v[60:61]
v_pk_mul_f32 v[60:61], v[48:49], s[54:55] op_sel:[0,1] op_sel_hi:[0,0] neg_lo:[0,0] neg_hi:[0,0]
v_pk_fma_f32 v[60:61], v[48:49], s[54:55], v[60:61] op_sel:[1,0,0] op_sel_hi:[1,1,1] neg_lo:[0,1,0] neg_hi:[0,0,0]
v_pk_add_f32 v[48:49], v[30:31], v[62:63] neg_lo:[0,1] neg_hi:[0,1]
v_pk_add_f32 v[30:31], v[30:31], v[62:63]
v_pk_mul_f32 v[62:63], v[48:49], s[50:51] op_sel:[0,1] op_sel_hi:[0,0] neg_lo:[0,0] neg_hi:[0,0]
v_pk_fma_f32 v[62:63], v[48:49], s[50:51], v[62:63] op_sel:[1,0,0] op_sel_hi:[1,1,1] neg_lo:[0,1,0] neg_hi:[0,0,0]
v_pk_add_f32 v[48:49], v[32:33], v[64:65] op_sel:[1,1] op_sel_hi:[0,0] neg_lo:[1,0] neg_hi:[0,1]
v_pk_add_f32 v[32:33], v[32:33], v[64:65]
v_pk_add_f32 v[64:65], v[34:35], v[66:67] neg_lo:[0,1] neg_hi:[0,1]
v_pk_add_f32 v[34:35], v[34:35], v[66:67]
v_pk_mul_f32 v[66:67], v[64:65], s[50:51] op_sel:[0,1] op_sel_hi:[0,0] neg_lo:[0,1] neg_hi:[0,0]
v_pk_fma_f32 v[66:67], v[64:65], s[50:51], v[66:67] op_sel:[1,0,0] op_sel_hi:[1,1,1] neg_lo:[0,1,0] neg_hi:[0,1,0]
v_pk_add_f32 v[64:65], v[36:37], v[68:69] neg_lo:[0,1] neg_hi:[0,1]
v_pk_add_f32 v[36:37], v[36:37], v[68:69]
v_pk_mul_f32 v[68:69], v[64:65], s[54:55] op_sel:[0,1] op_sel_hi:[0,0] neg_lo:[0,1] neg_hi:[0,0]
v_pk_fma_f32 v[68:69], v[64:65], s[54:55], v[68:69] op_sel:[1,0,0] op_sel_hi:[1,1,1] neg_lo:[0,1,0] neg_hi:[0,1,0]
v_pk_add_f32 v[64:65], v[38:39], v[70:71] neg_lo:[0,1] neg_hi:[0,1]
v_pk_add_f32 v[38:39], v[38:39], v[70:71]
v_pk_mul_f32 v[70:71], v[64:65], s[58:59] op_sel:[0,1] op_sel_hi:[0,0] neg_lo:[0,1] neg_hi:[0,0]
v_pk_fma_f32 v[70:71], v[64:65], s[58:59], v[70:71] op_sel:[1,0,0] op_sel_hi:[1,1,1] neg_lo:[0,1,0] neg_hi:[0,1,0]
v_pk_add_f32 v[64:65], v[40:41], v[72:73] neg_lo:[0,1] neg_hi:[0,1]
v_pk_add_f32 v[40:41], v[40:41], v[72:73]
v_pk_mul_f32 v[72:73], v[64:65], s[62:63] op_sel:[0,0] op_sel_hi:[0,1] neg_lo:[0,1] neg_hi:[0,0]
v_pk_fma_f32 v[72:73], v[64:65], s[62:63], v[72:73] op_sel:[1,1,0] op_sel_hi:[1,0,1] neg_lo:[0,1,0] neg_hi:[0,1,0]
v_pk_add_f32 v[64:65], v[42:43], v[74:75] neg_lo:[0,1] neg_hi:[0,1]
v_pk_add_f32 v[42:43], v[42:43], v[74:75]
v_pk_mul_f32 v[74:75], v[64:65], s[58:59] op_sel:[0,0] op_sel_hi:[0,1] neg_lo:[0,1] neg_hi:[0,0]
v_pk_fma_f32 v[74:75], v[64:65], s[58:59], v[74:75] op_sel:[1,1,0] op_sel_hi:[1,0,1] neg_lo:[0,1,0] neg_hi:[0,1,0]
v_pk_add_f32 v[64:65], v[44:45], v[76:77] neg_lo:[0,1] neg_hi:[0,1]
v_pk_add_f32 v[44:45], v[44:45], v[76:77]
v_pk_mul_f32 v[76:77], v[64:65], s[54:55] op_sel:[0,0] op_sel_hi:[0,1] neg_lo:[0,1] neg_hi:[0,0]
v_pk_fma_f32 v[76:77], v[64:65], s[54:55], v[76:77] op_sel:[1,1,0] op_sel_hi:[1,0,1] neg_lo:[0,1,0] neg_hi:[0,1,0]
v_pk_add_f32 v[64:65], v[46:47], v[78:79] neg_lo:[0,1] neg_hi:[0,1]
v_pk_add_f32 v[46:47], v[46:47], v[78:79]
v_pk_mul_f32 v[78:79], v[64:65], s[50:51] op_sel:[0,0] op_sel_hi:[0,1] neg_lo:[0,1] neg_hi:[0,0]
v_pk_fma_f32 v[78:79], v[64:65], s[50:51], v[78:79] op_sel:[1,1,0] op_sel_hi:[1,0,1] neg_lo:[0,1,0] neg_hi:[0,1,0]
v_pk_add_f32 v[64:65], v[16:17], v[32:33] neg_lo:[0,1] neg_hi:[0,1]
v_pk_add_f32 v[16:17], v[16:17], v[32:33]
v_pk_add_f32 v[32:33], v[18:19], v[34:35] neg_lo:[0,1] neg_hi:[0,1]
v_pk_add_f32 v[18:19], v[18:19], v[34:35]
v_pk_mul_f32 v[34:35], v[32:33], s[54:55] op_sel:[0,0] op_sel_hi:[0,1] neg_lo:[0,0] neg_hi:[0,0]
v_pk_fma_f32 v[34:35], v[32:33], s[54:55], v[34:35] op_sel:[1,1,0] op_sel_hi:[1,0,1] neg_lo:[0,1,0] neg_hi:[0,0,0]
v_pk_add_f32 v[32:33], v[20:21], v[36:37] neg_lo:[0,1] neg_hi:[0,1]
v_pk_add_f32 v[20:21], v[20:21], v[36:37]
v_pk_mul_f32 v[36:37], v[32:33], s[62:63] op_sel:[0,0] op_sel_hi:[0,1] neg_lo:[0,0] neg_hi:[0,0]
v_pk_fma_f32 v[36:37], v[32:33], s[62:63], v[36:37] op_sel:[1,1,0] op_sel_hi:[1,0,1] neg_lo:[0,1,0] neg_hi:[0,0,0]
v_pk_add_f32 v[32:33], v[22:23], v[38:39] neg_lo:[0,1] neg_hi:[0,1]
v_pk_add_f32 v[22:23], v[22:23], v[38:39]
v_pk_mul_f32 v[38:39], v[32:33], s[54:55] op_sel:[0,1] op_sel_hi:[0,0] neg_lo:[0,0] neg_hi:[0,0]
v_pk_fma_f32 v[38:39], v[32:33], s[54:55], v[38:39] op_sel:[1,0,0] op_sel_hi:[1,1,1] neg_lo:[0,1,0] neg_hi:[0,0,0]
v_pk_add_f32 v[32:33], v[24:25], v[40:41] op_sel:[1,1] op_sel_hi:[0,0] neg_lo:[1,0] neg_hi:[0,1]
v_pk_add_f32 v[24:25], v[24:25], v[40:41]
v_pk_add_f32 v[40:41], v[26:27], v[42:43] neg_lo:[0,1] neg_hi:[0,1]
v_pk_add_f32 v[26:27], v[26:27], v[42:43]
v_pk_mul_f32 v[42:43], v[40:41], s[54:55] op_sel:[0,1] op_sel_hi:[0,0] neg_lo:[0,1] neg_hi:[0,0]
v_pk_fma_f32 v[42:43], v[40:41], s[54:55], v[42:43] op_sel:[1,0,0] op_sel_hi:[1,1,1] neg_lo:[0,1,0] neg_hi:[0,1,0]
v_pk_add_f32 v[40:41], v[28:29], v[44:45] neg_lo:[0,1] neg_hi:[0,1]
v_pk_add_f32 v[28:29], v[28:29], v[44:45]
v_pk_mul_f32 v[44:45], v[40:41], s[62:63] op_sel:[0,0] op_sel_hi:[0,1] neg_lo:[0,1] neg_hi:[0,0]
v_pk_fma_f32 v[44:45], v[40:41], s[62:63], v[44:45] op_sel:[1,1,0] op_sel_hi:[1,0,1] neg_lo:[0,1,0] neg_hi:[0,1,0]
v_pk_add_f32 v[40:41], v[30:31], v[46:47] neg_lo:[0,1] neg_hi:[0,1]
v_pk_add_f32 v[30:31], v[30:31], v[46:47]
v_pk_mul_f32 v[46:47], v[40:41], s[54:55] op_sel:[0,0] op_sel_hi:[0,1] neg_lo:[0,1] neg_hi:[0,0]
v_pk_fma_f32 v[46:47], v[40:41], s[54:55], v[46:47] op_sel:[1,1,0] op_sel_hi:[1,0,1] neg_lo:[0,1,0] neg_hi:[0,1,0]
v_pk_add_f32 v[40:41], v[14:15], v[48:49] neg_lo:[0,1] neg_hi:[0,1]
v_pk_add_f32 v[14:15], v[14:15], v[48:49]
v_pk_add_f32 v[48:49], v[50:51], v[66:67] neg_lo:[0,1] neg_hi:[0,1]
v_pk_add_f32 v[50:51], v[50:51], v[66:67]
v_pk_mul_f32 v[66:67], v[48:49], s[54:55] op_sel:[0,0] op_sel_hi:[0,1] neg_lo:[0,0] neg_hi:[0,0]
v_pk_fma_f32 v[66:67], v[48:49], s[54:55], v[66:67] op_sel:[1,1,0] op_sel_hi:[1,0,1] neg_lo:[0,1,0] neg_hi:[0,0,0]
v_pk_add_f32 v[48:49], v[52:53], v[68:69] neg_lo:[0,1] neg_hi:[0,1]
v_pk_add_f32 v[52:53], v[52:53], v[68:69]
v_pk_mul_f32 v[68:69], v[48:49], s[62:63] op_sel:[0,0] op_sel_hi:[0,1] neg_lo:[0,0] neg_hi:[0,0]
v_pk_fma_f32 v[68:69], v[48:49], s[62:63], v[68:69] op_sel:[1,1,0] op_sel_hi:[1,0,1] neg_lo:[0,1,0] neg_hi:[0,0,0]
v_pk_add_f32 v[48:49], v[54:55], v[70:71] neg_lo:[0,1] neg_hi:[0,1]
v_pk_add_f32 v[54:55], v[54:55], v[70:71]
v_pk_mul_f32 v[70:71], v[48:49], s[54:55] op_sel:[0,1] op_sel_hi:[0,0] neg_lo:[0,0] neg_hi:[0,0]
v_pk_fma_f32 v[70:71], v[48:49], s[54:55], v[70:71] op_sel:[1,0,0] op_sel_hi:[1,1,1] neg_lo:[0,1,0] neg_hi:[0,0,0]
v_pk_add_f32 v[48:49], v[56:57], v[72:73] op_sel:[1,1] op_sel_hi:[0,0] neg_lo:[1,0] neg_hi:[0,1]
v_pk_add_f32 v[56:57], v[56:57], v[72:73]
v_pk_add_f32 v[72:73], v[58:59], v[74:75] neg_lo:[0,1] neg_hi:[0,1]
v_pk_add_f32 v[58:59], v[58:59], v[74:75]
v_pk_mul_f32 v[74:75], v[72:73], s[54:55] op_sel:[0,1] op_sel_hi:[0,0] neg_lo:[0,1] neg_hi:[0,0]
v_pk_fma_f32 v[74:75], v[72:73], s[54:55], v[74:75] op_sel:[1,0,0] op_sel_hi:[1,1,1] neg_lo:[0,1,0] neg_hi:[0,1,0]
v_pk_add_f32 v[72:73], v[60:61], v[76:77] neg_lo:[0,1] neg_hi:[0,1]
v_pk_add_f32 v[60:61], v[60:61], v[76:77]
v_pk_mul_f32 v[76:77], v[72:73], s[62:63] op_sel:[0,0] op_sel_hi:[0,1] neg_lo:[0,1] neg_hi:[0,0]
v_pk_fma_f32 v[76:77], v[72:73], s[62:63], v[76:77] op_sel:[1,1,0] op_sel_hi:[1,0,1] neg_lo:[0,1,0] neg_hi:[0,1,0]
v_pk_add_f32 v[72:73], v[62:63], v[78:79] neg_lo:[0,1] neg_hi:[0,1]
v_pk_add_f32 v[62:63], v[62:63], v[78:79]
v_pk_mul_f32 v[78:79], v[72:73], s[54:55] op_sel:[0,0] op_sel_hi:[0,1] neg_lo:[0,1] neg_hi:[0,0]
v_pk_fma_f32 v[78:79], v[72:73], s[54:55], v[78:79] op_sel:[1,1,0] op_sel_hi:[1,0,1] neg_lo:[0,1,0] neg_hi:[0,1,0]
v_pk_add_f32 v[72:73], v[16:17], v[24:25] neg_lo:[0,1] neg_hi:[0,1]
v_pk_add_f32 v[16:17], v[16:17], v[24:25]
v_pk_add_f32 v[24:25], v[18:19], v[26:27] neg_lo:[0,1] neg_hi:[0,1]
v_pk_add_f32 v[18:19], v[18:19], v[26:27]
v_pk_mul_f32 v[26:27], v[24:25], s[62:63] op_sel:[0,0] op_sel_hi:[0,1] neg_lo:[0,0] neg_hi:[0,0]
v_pk_fma_f32 v[26:27], v[24:25], s[62:63], v[26:27] op_sel:[1,1,0] op_sel_hi:[1,0,1] neg_lo:[0,1,0] neg_hi:[0,0,0]
v_pk_add_f32 v[24:25], v[20:21], v[28:29] op_sel:[1,1] op_sel_hi:[0,0] neg_lo:[1,0] neg_hi:[0,1]
v_pk_add_f32 v[20:21], v[20:21], v[28:29]
v_pk_add_f32 v[28:29], v[22:23], v[30:31] neg_lo:[0,1] neg_hi:[0,1]
v_pk_add_f32 v[22:23], v[22:23], v[30:31]
v_pk_mul_f32 v[30:31], v[28:29], s[62:63] op_sel:[0,0] op_sel_hi:[0,1] neg_lo:[0,1] neg_hi:[0,0]
v_pk_fma_f32 v[30:31], v[28:29], s[62:63], v[30:31] op_sel:[1,1,0] op_sel_hi:[1,0,1] neg_lo:[0,1,0] neg_hi:[0,1,0]
v_pk_add_f32 v[28:29], v[64:65], v[32:33] neg_lo:[0,1] neg_hi:[0,1]
v_pk_add_f32 v[64:65], v[64:65], v[32:33]
v_pk_add_f32 v[32:33], v[34:35], v[42:43] neg_lo:[0,1] neg_hi:[0,1]
v_pk_add_f32 v[34:35], v[34:35], v[42:43]
v_pk_mul_f32 v[42:43], v[32:33], s[62:63] op_sel:[0,0] op_sel_hi:[0,1] neg_lo:[0,0] neg_hi:[0,0]
v_pk_fma_f32 v[42:43], v[32:33], s[62:63], v[42:43] op_sel:[1,1,0] op_sel_hi:[1,0,1] neg_lo:[0,1,0] neg_hi:[0,0,0]
v_pk_add_f32 v[32:33], v[36:37], v[44:45] op_sel:[1,1] op_sel_hi:[0,0] neg_lo:[1,0] neg_hi:[0,1]
v_pk_add_f32 v[36:37], v[36:37], v[44:45]
v_pk_add_f32 v[44:45], v[38:39], v[46:47] neg_lo:[0,1] neg_hi:[0,1]
v_pk_add_f32 v[38:39], v[38:39], v[46:47]
v_pk_mul_f32 v[46:47], v[44:45], s[62:63] op_sel:[0,0] op_sel_hi:[0,1] neg_lo:[0,1] neg_hi:[0,0]
v_pk_fma_f32 v[46:47], v[44:45], s[62:63], v[46:47] op_sel:[1,1,0] op_sel_hi:[1,0,1] neg_lo:[0,1,0] neg_hi:[0,1,0]
v_pk_add_f32 v[44:45], v[14:15], v[56:57] neg_lo:[0,1] neg_hi:[0,1]
v_pk_add_f32 v[14:15], v[14:15], v[56:57]
v_pk_add_f32 v[56:57], v[50:51], v[58:59] neg_lo:[0,1] neg_hi:[0,1]
v_pk_add_f32 v[50:51], v[50:51], v[58:59]
v_pk_mul_f32 v[58:59], v[56:57], s[62:63] op_sel:[0,0] op_sel_hi:[0,1] neg_lo:[0,0] neg_hi:[0,0]
v_pk_fma_f32 v[58:59], v[56:57], s[62:63], v[58:59] op_sel:[1,1,0] op_sel_hi:[1,0,1] neg_lo:[0,1,0] neg_hi:[0,0,0]
v_pk_add_f32 v[56:57], v[52:53], v[60:61] op_sel:[1,1] op_sel_hi:[0,0] neg_lo:[1,0] neg_hi:[0,1]
v_pk_add_f32 v[52:53], v[52:53], v[60:61]
v_pk_add_f32 v[60:61], v[54:55], v[62:63] neg_lo:[0,1] neg_hi:[0,1]
v_pk_add_f32 v[54:55], v[54:55], v[62:63]
v_pk_mul_f32 v[62:63], v[60:61], s[62:63] op_sel:[0,0] op_sel_hi:[0,1] neg_lo:[0,1] neg_hi:[0,0]
v_pk_fma_f32 v[62:63], v[60:61], s[62:63], v[62:63] op_sel:[1,1,0] op_sel_hi:[1,0,1] neg_lo:[0,1,0] neg_hi:[0,1,0]
v_pk_add_f32 v[60:61], v[40:41], v[48:49] neg_lo:[0,1] neg_hi:[0,1]
v_pk_add_f32 v[40:41], v[40:41], v[48:49]
v_pk_add_f32 v[48:49], v[66:67], v[74:75] neg_lo:[0,1] neg_hi:[0,1]
v_pk_add_f32 v[66:67], v[66:67], v[74:75]
v_pk_mul_f32 v[74:75], v[48:49], s[62:63] op_sel:[0,0] op_sel_hi:[0,1] neg_lo:[0,0] neg_hi:[0,0]
v_pk_fma_f32 v[74:75], v[48:49], s[62:63], v[74:75] op_sel:[1,1,0] op_sel_hi:[1,0,1] neg_lo:[0,1,0] neg_hi:[0,0,0]
v_pk_add_f32 v[48:49], v[68:69], v[76:77] op_sel:[1,1] op_sel_hi:[0,0] neg_lo:[1,0] neg_hi:[0,1]
v_pk_add_f32 v[68:69], v[68:69], v[76:77]
v_pk_add_f32 v[76:77], v[70:71], v[78:79] neg_lo:[0,1] neg_hi:[0,1]
v_pk_add_f32 v[70:71], v[70:71], v[78:79]
v_pk_mul_f32 v[78:79], v[76:77], s[62:63] op_sel:[0,0] op_sel_hi:[0,1] neg_lo:[0,1] neg_hi:[0,0]
v_pk_fma_f32 v[78:79], v[76:77], s[62:63], v[78:79] op_sel:[1,1,0] op_sel_hi:[1,0,1] neg_lo:[0,1,0] neg_hi:[0,1,0]
v_pk_add_f32 v[76:77], v[16:17], v[20:21] neg_lo:[0,1] neg_hi:[0,1]
v_pk_add_f32 v[16:17], v[16:17], v[20:21]
v_pk_add_f32 v[20:21], v[18:19], v[22:23] op_sel:[1,1] op_sel_hi:[0,0] neg_lo:[1,0] neg_hi:[0,1]
v_pk_add_f32 v[18:19], v[18:19], v[22:23]
v_pk_add_f32 v[22:23], v[72:73], v[24:25] neg_lo:[0,1] neg_hi:[0,1]
v_pk_add_f32 v[72:73], v[72:73], v[24:25]
v_pk_add_f32 v[24:25], v[26:27], v[30:31] op_sel:[1,1] op_sel_hi:[0,0] neg_lo:[1,0] neg_hi:[0,1]
v_pk_add_f32 v[26:27], v[26:27], v[30:31]
v_pk_add_f32 v[30:31], v[64:65], v[36:37] neg_lo:[0,1] neg_hi:[0,1]
v_pk_add_f32 v[64:65], v[64:65], v[36:37]
v_pk_add_f32 v[36:37], v[34:35], v[38:39] op_sel:[1,1] op_sel_hi:[0,0] neg_lo:[1,0] neg_hi:[0,1]
v_pk_add_f32 v[34:35], v[34:35], v[38:39]
v_pk_add_f32 v[38:39], v[28:29], v[32:33] neg_lo:[0,1] neg_hi:[0,1]
v_pk_add_f32 v[28:29], v[28:29], v[32:33]
v_pk_add_f32 v[32:33], v[42:43], v[46:47] op_sel:[1,1] op_sel_hi:[0,0] neg_lo:[1,0] neg_hi:[0,1]
v_pk_add_f32 v[42:43], v[42:43], v[46:47]
v_pk_add_f32 v[46:47], v[14:15], v[52:53] neg_lo:[0,1] neg_hi:[0,1]
v_pk_add_f32 v[14:15], v[14:15], v[52:53]
v_pk_add_f32 v[52:53], v[50:51], v[54:55] op_sel:[1,1] op_sel_hi:[0,0] neg_lo:[1,0] neg_hi:[0,1]
v_pk_add_f32 v[50:51], v[50:51], v[54:55]
v_pk_add_f32 v[54:55], v[44:45], v[56:57] neg_lo:[0,1] neg_hi:[0,1]
v_pk_add_f32 v[44:45], v[44:45], v[56:57]
v_pk_add_f32 v[56:57], v[58:59], v[62:63] op_sel:[1,1] op_sel_hi:[0,0] neg_lo:[1,0] neg_hi:[0,1]
v_pk_add_f32 v[58:59], v[58:59], v[62:63]
v_pk_add_f32 v[62:63], v[40:41], v[68:69] neg_lo:[0,1] neg_hi:[0,1]
v_pk_add_f32 v[40:41], v[40:41], v[68:69]
v_pk_add_f32 v[68:69], v[66:67], v[70:71] op_sel:[1,1] op_sel_hi:[0,0] neg_lo:[1,0] neg_hi:[0,1]
v_pk_add_f32 v[66:67], v[66:67], v[70:71]
v_pk_add_f32 v[70:71], v[60:61], v[48:49] neg_lo:[0,1] neg_hi:[0,1]
v_pk_add_f32 v[60:61], v[60:61], v[48:49]
v_pk_add_f32 v[48:49], v[74:75], v[78:79] op_sel:[1,1] op_sel_hi:[0,0] neg_lo:[1,0] neg_hi:[0,1]
v_pk_add_f32 v[74:75], v[74:75], v[78:79]
v_pk_add_f32 v[78:79], v[16:17], v[18:19] neg_lo:[0,1] neg_hi:[0,1]
v_pk_add_f32 v[16:17], v[16:17], v[18:19]
v_pk_add_f32 v[18:19], v[76:77], v[20:21] neg_lo:[0,1] neg_hi:[0,1]
v_pk_add_f32 v[76:77], v[76:77], v[20:21]
v_pk_add_f32 v[20:21], v[72:73], v[26:27] neg_lo:[0,1] neg_hi:[0,1]
v_pk_add_f32 v[72:73], v[72:73], v[26:27]
v_pk_add_f32 v[26:27], v[22:23], v[24:25] neg_lo:[0,1] neg_hi:[0,1]
v_pk_add_f32 v[22:23], v[22:23], v[24:25]
v_pk_add_f32 v[24:25], v[64:65], v[34:35] neg_lo:[0,1] neg_hi:[0,1]
v_pk_add_f32 v[64:65], v[64:65], v[34:35]
v_pk_add_f32 v[34:35], v[30:31], v[36:37] neg_lo:[0,1] neg_hi:[0,1]
v_pk_add_f32 v[30:31], v[30:31], v[36:37]
v_pk_add_f32 v[36:37], v[28:29], v[42:43] neg_lo:[0,1] neg_hi:[0,1]
v_pk_add_f32 v[28:29], v[28:29], v[42:43]
v_pk_add_f32 v[42:43], v[38:39], v[32:33] neg_lo:[0,1] neg_hi:[0,1]
v_pk_add_f32 v[38:39], v[38:39], v[32:33]
v_pk_add_f32 v[32:33], v[14:15], v[50:51] neg_lo:[0,1] neg_hi:[0,1]
v_pk_add_f32 v[14:15], v[14:15], v[50:51]
v_pk_add_f32 v[50:51], v[46:47], v[52:53] neg_lo:[0,1] neg_hi:[0,1]
v_pk_add_f32 v[46:47], v[46:47], v[52:53]
v_pk_add_f32 v[52:53], v[44:45], v[58:59] neg_lo:[0,1] neg_hi:[0,1]
v_pk_add_f32 v[44:45], v[44:45], v[58:59]
v_pk_add_f32 v[58:59], v[54:55], v[56:57] neg_lo:[0,1] neg_hi:[0,1]
v_pk_add_f32 v[54:55], v[54:55], v[56:57]
v_pk_add_f32 v[56:57], v[40:41], v[66:67] neg_lo:[0,1] neg_hi:[0,1]
v_pk_add_f32 v[40:41], v[40:41], v[66:67]
v_pk_add_f32 v[66:67], v[62:63], v[68:69] neg_lo:[0,1] neg_hi:[0,1]
v_pk_add_f32 v[62:63], v[62:63], v[68:69]
v_pk_add_f32 v[68:69], v[60:61], v[74:75] neg_lo:[0,1] neg_hi:[0,1]
v_pk_add_f32 v[60:61], v[60:61], v[74:75]
v_pk_add_f32 v[74:75], v[70:71], v[48:49] neg_lo:[0,1] neg_hi:[0,1]
v_pk_add_f32 v[70:71], v[70:71], v[48:49]
ds_write2st64_b32 v12, v16, v17 offset0:0 offset1:16
ds_write_b32 v12, v14 offset:128
ds_write_b32 v12, v15 offset:4224
ds_write_b32 v12, v64 offset:256
ds_write_b32 v12, v65 offset:4352
ds_write_b32 v12, v40 offset:384
ds_write_b32 v12, v41 offset:4480
ds_write_b32 v12, v72 offset:512
ds_write_b32 v12, v73 offset:4608
ds_write_b32 v12, v44 offset:640
ds_write_b32 v12, v45 offset:4736
ds_write_b32 v12, v28 offset:768
ds_write_b32 v12, v29 offset:4864
ds_write_b32 v12, v60 offset:896
ds_write_b32 v12, v61 offset:4992
ds_write_b32 v12, v76 offset:1024
ds_write_b32 v12, v77 offset:5120
ds_write_b32 v12, v46 offset:1152
ds_write_b32 v12, v47 offset:5248
ds_write_b32 v12, v30 offset:1280
ds_write_b32 v12, v31 offset:5376
ds_write_b32 v12, v62 offset:1408
ds_write_b32 v12, v63 offset:5504
ds_write_b32 v12, v22 offset:1536
ds_write_b32 v12, v23 offset:5632
ds_write_b32 v12, v54 offset:1664
ds_write_b32 v12, v55 offset:5760
ds_write_b32 v12, v38 offset:1792
ds_write_b32 v12, v39 offset:5888
ds_write_b32 v12, v70 offset:1920
ds_write_b32 v12, v71 offset:6016
ds_write_b32 v12, v78 offset:2048
ds_write_b32 v12, v79 offset:6144
ds_write_b32 v12, v32 offset:2176
ds_write_b32 v12, v33 offset:6272
ds_write_b32 v12, v24 offset:2304
ds_write_b32 v12, v25 offset:6400
ds_write_b32 v12, v56 offset:2432
ds_write_b32 v12, v57 offset:6528
ds_write_b32 v12, v20 offset:2560
ds_write_b32 v12, v21 offset:6656
ds_write_b32 v12, v52 offset:2688
ds_write_b32 v12, v53 offset:6784
ds_write_b32 v12, v36 offset:2816
ds_write_b32 v12, v37 offset:6912
ds_write_b32 v12, v68 offset:2944
ds_write_b32 v12, v69 offset:7040
ds_write_b32 v12, v18 offset:3072
ds_write_b32 v12, v19 offset:7168
ds_write_b32 v12, v50 offset:3200
ds_write_b32 v12, v51 offset:7296
ds_write_b32 v12, v34 offset:3328
ds_write_b32 v12, v35 offset:7424
ds_write_b32 v12, v66 offset:3456
ds_write_b32 v12, v67 offset:7552
ds_write_b32 v12, v26 offset:3584
ds_write_b32 v12, v27 offset:7680
ds_write_b32 v12, v58 offset:3712
ds_write_b32 v12, v59 offset:7808
ds_write_b32 v12, v42 offset:3840
ds_write_b32 v12, v43 offset:7936
ds_write_b32 v12, v74 offset:3968
ds_write_b32 v12, v75 offset:8064
s_waitcnt lgkmcnt(0)
s_barrier
s_lshl_b32 s13, s93, 16
ds_read_b128 v[16:19], v2 offset:0
ds_read_b128 v[20:23], v2 offset:16
ds_read_b128 v[24:27], v2 offset:8448
ds_read_b128 v[28:31], v2 offset:8464
ds_read_b128 v[32:35], v2 offset:16896
ds_read_b128 v[36:39], v2 offset:16912
ds_read_b128 v[40:43], v2 offset:25344
ds_read_b128 v[44:47], v2 offset:25360
ds_read_b128 v[48:51], v2 offset:33792
ds_read_b128 v[52:55], v2 offset:33808
ds_read_b128 v[56:59], v2 offset:42240
ds_read_b128 v[60:63], v2 offset:42256
ds_read_b128 v[64:67], v2 offset:50688
ds_read_b128 v[68:71], v2 offset:50704
s_waitcnt lgkmcnt(12)
ds_read_b128 v[72:75], v2 offset:59136
ds_read_b128 v[76:79], v2 offset:59152
s_waitcnt lgkmcnt(14)
v_cvt_pk_bf16_f32 v216, v16, v17
v_cvt_pk_bf16_f32 v217, v18, v19
v_cvt_pk_bf16_f32 v218, v20, v21
v_cvt_pk_bf16_f32 v219, v22, v23
buffer_store_dwordx4 v[216:219], v3, s[4:7], s13 offen sc1
s_add_u32 s13, s13, 8192
s_waitcnt lgkmcnt(12)
v_cvt_pk_bf16_f32 v220, v24, v25
v_cvt_pk_bf16_f32 v221, v26, v27
v_cvt_pk_bf16_f32 v222, v28, v29
v_cvt_pk_bf16_f32 v223, v30, v31
buffer_store_dwordx4 v[220:223], v3, s[4:7], s13 offen sc1
s_add_u32 s13, s13, 8192
s_waitcnt lgkmcnt(10)
v_cvt_pk_bf16_f32 v224, v32, v33
v_cvt_pk_bf16_f32 v225, v34, v35
v_cvt_pk_bf16_f32 v226, v36, v37
v_cvt_pk_bf16_f32 v227, v38, v39
buffer_store_dwordx4 v[224:227], v3, s[4:7], s13 offen sc1
s_add_u32 s13, s13, 8192
s_waitcnt lgkmcnt(8)
v_cvt_pk_bf16_f32 v228, v40, v41
v_cvt_pk_bf16_f32 v229, v42, v43
v_cvt_pk_bf16_f32 v230, v44, v45
v_cvt_pk_bf16_f32 v231, v46, v47
buffer_store_dwordx4 v[228:231], v3, s[4:7], s13 offen sc1
s_add_u32 s13, s13, 8192
s_waitcnt lgkmcnt(6)
v_cvt_pk_bf16_f32 v232, v48, v49
v_cvt_pk_bf16_f32 v233, v50, v51
v_cvt_pk_bf16_f32 v234, v52, v53
v_cvt_pk_bf16_f32 v235, v54, v55
buffer_store_dwordx4 v[232:235], v3, s[4:7], s13 offen sc1
s_add_u32 s13, s13, 8192
s_waitcnt lgkmcnt(4)
v_cvt_pk_bf16_f32 v236, v56, v57
v_cvt_pk_bf16_f32 v237, v58, v59
v_cvt_pk_bf16_f32 v238, v60, v61
v_cvt_pk_bf16_f32 v239, v62, v63
buffer_store_dwordx4 v[236:239], v3, s[4:7], s13 offen sc1
s_add_u32 s13, s13, 8192
s_waitcnt lgkmcnt(2)
v_cvt_pk_bf16_f32 v240, v64, v65
v_cvt_pk_bf16_f32 v241, v66, v67
v_cvt_pk_bf16_f32 v242, v68, v69
v_cvt_pk_bf16_f32 v243, v70, v71
buffer_store_dwordx4 v[240:243], v3, s[4:7], s13 offen sc1
s_add_u32 s13, s13, 8192
s_waitcnt lgkmcnt(0)
v_cvt_pk_bf16_f32 v244, v72, v73
v_cvt_pk_bf16_f32 v245, v74, v75
v_cvt_pk_bf16_f32 v246, v76, v77
v_cvt_pk_bf16_f32 v247, v78, v79
buffer_store_dwordx4 v[244:247], v3, s[4:7], s13 offen sc1
s_add_u32 s13, s13, 8192
s_mov_b32 s93, s21
s_cmp_lt_u32 s93, 128
s_cbranch_scc1 mega_kernel_f3_l
mega_kernel_f3_e:
s_waitcnt vmcnt(0)
s_barrier
s_add_u32 s64, s91, 58
s_mov_b32 s65, 64
s_mov_b32 s67, 1
s_add_u32 s66, s66, 262144
s_cmp_eq_u32 s91, 0
s_cbranch_scc1 mega_kernel_out
s_lshr_b32 s66, s40, 2
s_lshl_b32 s66, s66, 16
s_and_b32 s76, s40, 3
s_lshl_b32 s76, s76, 13
s_add_u32 s66, s66, s76
s_add_u32 s66, s66, 67141632
mega_kernel_out:
s_load_dwordx2 s[4:5], s[0:1], 40
s_load_dwordx2 s[8:9], s[0:1], 80
v_lshrrev_b32 v2, 6, v0
v_and_b32 v1, 63, v0
v_readfirstlane_b32 s41, v2
v_lshlrev_b32 v5, 4, v1
s_waitcnt lgkmcnt(0)
s_mov_b32 s6, 8388608
s_mov_b32 s7, 0x00020000
s_mov_b32 s10, 8388608
s_mov_b32 s11, 0x00020000
s_and_b32 s58, s40, 1
s_lshr_b32 s59, s40, 1
s_lshl_b32 s43, s58, 22
s_lshl_b32 s44, s41, 20
s_add_u32 s43, s43, s44
s_lshl_b32 s44, s59, 7
s_add_u32 s48, s43, s44
s_and_b32 s56, s59, 7
s_lshl_b32 s56, s56, 6
s_cmp_eq_u32 s68, 2
s_cbranch_scc1 mega_kernel_o_hw
v_lshrrev_b32 v2, 3, v1
v_and_b32 v3, 7, v1
v_lshlrev_b32 v16, 11, v2
v_lshl_add_u32 v16, v3, 4, v16
v_add_u32 v16, s48, v16
v_and_b32 v3, 3, v1
s_lshl_b32 s45, s41, 15
v_bfe_u32 v17, v1, 2, 2
v_lshrrev_b32 v18, 5, v1
v_mul_u32_u24 v18, 4, v18
v_add_u32 v17, v17, v18
v_lshlrev_b32 v17, 7, v17
v_bfe_u32 v18, v1, 4, 1
v_lshl_add_u32 v17, v18, 5, v17
v_lshl_add_u32 v17, v3, 3, v17
v_add_u32 v17, s45, v17
s_add_u32 m0, s45, 0
s_add_u32 s44, s56, 0
s_and_b32 s44, s44, 511
s_lshl_b32 s44, s44, 11
buffer_load_dwordx4 v16, s[4:7], s44 offen lds
s_add_u32 m0, s45, 1024
s_add_u32 s44, s56, 8
s_and_b32 s44, s44, 511
s_lshl_b32 s44, s44, 11
buffer_load_dwordx4 v16, s[4:7], s44 offen lds
s_add_u32 m0, s45, 2048
s_add_u32 s44, s56, 16
s_and_b32 s44, s44, 511
s_lshl_b32 s44, s44, 11
buffer_load_dwordx4 v16, s[4:7], s44 offen lds
s_add_u32 m0, s45, 3072
s_add_u32 s44, s56, 24
s_and_b32 s44, s44, 511
s_lshl_b32 s44, s44, 11
buffer_load_dwordx4 v16, s[4:7], s44 offen lds
s_add_u32 m0, s45, 4096
s_add_u32 s44, s56, 32
s_and_b32 s44, s44, 511
s_lshl_b32 s44, s44, 11
buffer_load_dwordx4 v16, s[4:7], s44 offen lds
s_add_u32 m0, s45, 5120
s_add_u32 s44, s56, 40
s_and_b32 s44, s44, 511
s_lshl_b32 s44, s44, 11
buffer_load_dwordx4 v16, s[4:7], s44 offen lds
s_add_u32 m0, s45, 6144
s_add_u32 s44, s56, 48
s_and_b32 s44, s44, 511
s_lshl_b32 s44, s44, 11
buffer_load_dwordx4 v16, s[4:7], s44 offen lds
s_add_u32 m0, s45, 7168
s_add_u32 s44, s56, 56
s_and_b32 s44, s44, 511
s_lshl_b32 s44, s44, 11
buffer_load_dwordx4 v16, s[4:7], s44 offen lds
s_add_u32 m0, s45, 8192
s_add_u32 s44, s56, 64
s_and_b32 s44, s44, 511
s_lshl_b32 s44, s44, 11
buffer_load_dwordx4 v16, s[4:7], s44 offen lds
s_add_u32 m0, s45, 9216
s_add_u32 s44, s56, 72
s_and_b32 s44, s44, 511
s_lshl_b32 s44, s44, 11
buffer_load_dwordx4 v16, s[4:7], s44 offen lds
s_add_u32 m0, s45, 10240
s_add_u32 s44, s56, 80
s_and_b32 s44, s44, 511
s_lshl_b32 s44, s44, 11
buffer_load_dwordx4 v16, s[4:7], s44 offen lds
s_add_u32 m0, s45, 11264
s_add_u32 s44, s56, 88
s_and_b32 s44, s44, 511
s_lshl_b32 s44, s44, 11
buffer_load_dwordx4 v16, s[4:7], s44 offen lds
s_add_u32 m0, s45, 12288
s_add_u32 s44, s56, 96
s_and_b32 s44, s44, 511
s_lshl_b32 s44, s44, 11
buffer_load_dwordx4 v16, s[4:7], s44 offen lds
s_add_u32 m0, s45, 13312
s_add_u32 s44, s56, 104
s_and_b32 s44, s44, 511
s_lshl_b32 s44, s44, 11
buffer_load_dwordx4 v16, s[4:7], s44 offen lds
s_add_u32 m0, s45, 14336
s_add_u32 s44, s56, 112
s_and_b32 s44, s44, 511
s_lshl_b32 s44, s44, 11
buffer_load_dwordx4 v16, s[4:7], s44 offen lds
s_add_u32 m0, s45, 15360
s_add_u32 s44, s56, 120
s_and_b32 s44, s44, 511
s_lshl_b32 s44, s44, 11
buffer_load_dwordx4 v16, s[4:7], s44 offen lds
s_add_u32 m0, s45, 16384
s_add_u32 s44, s56, 128
s_and_b32 s44, s44, 511
s_lshl_b32 s44, s44, 11
buffer_load_dwordx4 v16, s[4:7], s44 offen lds
s_add_u32 m0, s45, 17408
s_add_u32 s44, s56, 136
s_and_b32 s44, s44, 511
s_lshl_b32 s44, s44, 11
buffer_load_dwordx4 v16, s[4:7], s44 offen lds
s_add_u32 m0, s45, 18432
s_add_u32 s44, s56, 144
s_and_b32 s44, s44, 511
s_lshl_b32 s44, s44, 11
buffer_load_dwordx4 v16, s[4:7], s44 offen lds
s_add_u32 m0, s45, 19456
s_add_u32 s44, s56, 152
s_and_b32 s44, s44, 511
s_lshl_b32 s44, s44, 11
buffer_load_dwordx4 v16, s[4:7], s44 offen lds
s_add_u32 m0, s45, 20480
s_add_u32 s44, s56, 160
s_and_b32 s44, s44, 511
s_lshl_b32 s44, s44, 11
buffer_load_dwordx4 v16, s[4:7], s44 offen lds
s_add_u32 m0, s45, 21504
s_add_u32 s44, s56, 168
s_and_b32 s44, s44, 511
s_lshl_b32 s44, s44, 11
buffer_load_dwordx4 v16, s[4:7], s44 offen lds
s_add_u32 m0, s45, 22528
s_add_u32 s44, s56, 176
s_and_b32 s44, s44, 511
s_lshl_b32 s44, s44, 11
buffer_load_dwordx4 v16, s[4:7], s44 offen lds
s_add_u32 m0, s45, 23552
s_add_u32 s44, s56, 184
s_and_b32 s44, s44, 511
s_lshl_b32 s44, s44, 11
buffer_load_dwordx4 v16, s[4:7], s44 offen lds
s_add_u32 m0, s45, 24576
s_add_u32 s44, s56, 192
s_and_b32 s44, s44, 511
s_lshl_b32 s44, s44, 11
buffer_load_dwordx4 v16, s[4:7], s44 offen lds
s_add_u32 m0, s45, 25600
s_add_u32 s44, s56, 200
s_and_b32 s44, s44, 511
s_lshl_b32 s44, s44, 11
buffer_load_dwordx4 v16, s[4:7], s44 offen lds
s_add_u32 m0, s45, 26624
s_add_u32 s44, s56, 208
s_and_b32 s44, s44, 511
s_lshl_b32 s44, s44, 11
buffer_load_dwordx4 v16, s[4:7], s44 offen lds
s_add_u32 m0, s45, 27648
s_add_u32 s44, s56, 216
s_and_b32 s44, s44, 511
s_lshl_b32 s44, s44, 11
buffer_load_dwordx4 v16, s[4:7], s44 offen lds
s_add_u32 m0, s45, 28672
s_add_u32 s44, s56, 224
s_and_b32 s44, s44, 511
s_lshl_b32 s44, s44, 11
buffer_load_dwordx4 v16, s[4:7], s44 offen lds
s_add_u32 m0, s45, 29696
s_add_u32 s44, s56, 232
s_and_b32 s44, s44, 511
s_lshl_b32 s44, s44, 11
buffer_load_dwordx4 v16, s[4:7], s44 offen lds
s_add_u32 m0, s45, 30720
s_add_u32 s44, s56, 240
s_and_b32 s44, s44, 511
s_lshl_b32 s44, s44, 11
buffer_load_dwordx4 v16, s[4:7], s44 offen lds
s_add_u32 m0, s45, 31744
s_add_u32 s44, s56, 248
s_and_b32 s44, s44, 511
s_lshl_b32 s44, s44, 11
buffer_load_dwordx4 v16, s[4:7], s44 offen lds
s_waitcnt vmcnt(16)
ds_read_b64_tr_b16 a[0:1], v17 offset:0
ds_read_b64_tr_b16 a[2:3], v17 offset:2048
ds_read_b64_tr_b16 a[4:5], v17 offset:64
ds_read_b64_tr_b16 a[6:7], v17 offset:2112
ds_read_b64_tr_b16 a[8:9], v17 offset:1024
ds_read_b64_tr_b16 a[10:11], v17 offset:3072
ds_read_b64_tr_b16 a[12:13], v17 offset:1088
ds_read_b64_tr_b16 a[14:15], v17 offset:3136
s_waitcnt lgkmcnt(0)
ds_read_b64_tr_b16 a[16:17], v17 offset:4096
ds_read_b64_tr_b16 a[18:19], v17 offset:6144
ds_read_b64_tr_b16 a[20:21], v17 offset:4160
ds_read_b64_tr_b16 a[22:23], v17 offset:6208
ds_read_b64_tr_b16 a[24:25], v17 offset:5120
ds_read_b64_tr_b16 a[26:27], v17 offset:7168
ds_read_b64_tr_b16 a[28:29], v17 offset:5184
ds_read_b64_tr_b16 a[30:31], v17 offset:7232
s_waitcnt lgkmcnt(0)
ds_read_b64_tr_b16 a[32:33], v17 offset:8192
ds_read_b64_tr_b16 a[34:35], v17 offset:10240
ds_read_b64_tr_b16 a[36:37], v17 offset:8256
ds_read_b64_tr_b16 a[38:39], v17 offset:10304
ds_read_b64_tr_b16 a[40:41], v17 offset:9216
ds_read_b64_tr_b16 a[42:43], v17 offset:11264
ds_read_b64_tr_b16 a[44:45], v17 offset:9280
ds_read_b64_tr_b16 a[46:47], v17 offset:11328
s_waitcnt lgkmcnt(0)
ds_read_b64_tr_b16 a[48:49], v17 offset:12288
ds_read_b64_tr_b16 a[50:51], v17 offset:14336
ds_read_b64_tr_b16 a[52:53], v17 offset:12352
ds_read_b64_tr_b16 a[54:55], v17 offset:14400
ds_read_b64_tr_b16 a[56:57], v17 offset:13312
ds_read_b64_tr_b16 a[58:59], v17 offset:15360
ds_read_b64_tr_b16 a[60:61], v17 offset:13376
ds_read_b64_tr_b16 a[62:63], v17 offset:15424
s_waitcnt lgkmcnt(0)
s_add_u32 m0, s45, 0
s_add_u32 s44, s56, 256
s_and_b32 s44, s44, 511
s_lshl_b32 s44, s44, 11
buffer_load_dwordx4 v16, s[4:7], s44 offen lds
s_add_u32 m0, s45, 1024
s_add_u32 s44, s56, 264
s_and_b32 s44, s44, 511
s_lshl_b32 s44, s44, 11
buffer_load_dwordx4 v16, s[4:7], s44 offen lds
s_add_u32 m0, s45, 2048
s_add_u32 s44, s56, 272
s_and_b32 s44, s44, 511
s_lshl_b32 s44, s44, 11
buffer_load_dwordx4 v16, s[4:7], s44 offen lds
s_add_u32 m0, s45, 3072
s_add_u32 s44, s56, 280
s_and_b32 s44, s44, 511
s_lshl_b32 s44, s44, 11
buffer_load_dwordx4 v16, s[4:7], s44 offen lds
s_add_u32 m0, s45, 4096
s_add_u32 s44, s56, 288
s_and_b32 s44, s44, 511
s_lshl_b32 s44, s44, 11
buffer_load_dwordx4 v16, s[4:7], s44 offen lds
s_add_u32 m0, s45, 5120
s_add_u32 s44, s56, 296
s_and_b32 s44, s44, 511
s_lshl_b32 s44, s44, 11
buffer_load_dwordx4 v16, s[4:7], s44 offen lds
s_add_u32 m0, s45, 6144
s_add_u32 s44, s56, 304
s_and_b32 s44, s44, 511
s_lshl_b32 s44, s44, 11
buffer_load_dwordx4 v16, s[4:7], s44 offen lds
s_add_u32 m0, s45, 7168
s_add_u32 s44, s56, 312
s_and_b32 s44, s44, 511
s_lshl_b32 s44, s44, 11
buffer_load_dwordx4 v16, s[4:7], s44 offen lds
s_add_u32 m0, s45, 8192
s_add_u32 s44, s56, 320
s_and_b32 s44, s44, 511
s_lshl_b32 s44, s44, 11
buffer_load_dwordx4 v16, s[4:7], s44 offen lds
s_add_u32 m0, s45, 9216
s_add_u32 s44, s56, 328
s_and_b32 s44, s44, 511
s_lshl_b32 s44, s44, 11
buffer_load_dwordx4 v16, s[4:7], s44 offen lds
s_add_u32 m0, s45, 10240
s_add_u32 s44, s56, 336
s_and_b32 s44, s44, 511
s_lshl_b32 s44, s44, 11
buffer_load_dwordx4 v16, s[4:7], s44 offen lds
s_add_u32 m0, s45, 11264
s_add_u32 s44, s56, 344
s_and_b32 s44, s44, 511
s_lshl_b32 s44, s44, 11
buffer_load_dwordx4 v16, s[4:7], s44 offen lds
s_add_u32 m0, s45, 12288
s_add_u32 s44, s56, 352
s_and_b32 s44, s44, 511
s_lshl_b32 s44, s44, 11
buffer_load_dwordx4 v16, s[4:7], s44 offen lds
s_add_u32 m0, s45, 13312
s_add_u32 s44, s56, 360
s_and_b32 s44, s44, 511
s_lshl_b32 s44, s44, 11
buffer_load_dwordx4 v16, s[4:7], s44 offen lds
s_add_u32 m0, s45, 14336
s_add_u32 s44, s56, 368
s_and_b32 s44, s44, 511
s_lshl_b32 s44, s44, 11
buffer_load_dwordx4 v16, s[4:7], s44 offen lds
s_add_u32 m0, s45, 15360
s_add_u32 s44, s56, 376
s_and_b32 s44, s44, 511
s_lshl_b32 s44, s44, 11
buffer_load_dwordx4 v16, s[4:7], s44 offen lds
s_waitcnt vmcnt(16)
ds_read_b64_tr_b16 a[64:65], v17 offset:16384
ds_read_b64_tr_b16 a[66:67], v17 offset:18432
ds_read_b64_tr_b16 a[68:69], v17 offset:16448
ds_read_b64_tr_b16 a[70:71], v17 offset:18496
ds_read_b64_tr_b16 a[72:73], v17 offset:17408
ds_read_b64_tr_b16 a[74:75], v17 offset:19456
ds_read_b64_tr_b16 a[76:77], v17 offset:17472
ds_read_b64_tr_b16 a[78:79], v17 offset:19520
s_waitcnt lgkmcnt(0)
ds_read_b64_tr_b16 a[80:81], v17 offset:20480
ds_read_b64_tr_b16 a[82:83], v17 offset:22528
ds_read_b64_tr_b16 a[84:85], v17 offset:20544
ds_read_b64_tr_b16 a[86:87], v17 offset:22592
ds_read_b64_tr_b16 a[88:89], v17 offset:21504
ds_read_b64_tr_b16 a[90:91], v17 offset:23552
ds_read_b64_tr_b16 a[92:93], v17 offset:21568
ds_read_b64_tr_b16 a[94:95], v17 offset:23616
s_waitcnt lgkmcnt(0)
ds_read_b64_tr_b16 a[96:97], v17 offset:24576
ds_read_b64_tr_b16 a[98:99], v17 offset:26624
ds_read_b64_tr_b16 a[100:101], v17 offset:24640
ds_read_b64_tr_b16 a[102:103], v17 offset:26688
ds_read_b64_tr_b16 a[104:105], v17 offset:25600
ds_read_b64_tr_b16 a[106:107], v17 offset:27648
ds_read_b64_tr_b16 a[108:109], v17 offset:25664
ds_read_b64_tr_b16 a[110:111], v17 offset:27712
s_waitcnt lgkmcnt(0)
ds_read_b64_tr_b16 a[112:113], v17 offset:28672
ds_read_b64_tr_b16 a[114:115], v17 offset:30720
ds_read_b64_tr_b16 a[116:117], v17 offset:28736
ds_read_b64_tr_b16 a[118:119], v17 offset:30784
ds_read_b64_tr_b16 a[120:121], v17 offset:29696
ds_read_b64_tr_b16 a[122:123], v17 offset:31744
ds_read_b64_tr_b16 a[124:125], v17 offset:29760
ds_read_b64_tr_b16 a[126:127], v17 offset:31808
s_waitcnt lgkmcnt(0)
s_add_u32 m0, s45, 16384
s_add_u32 s44, s56, 384
s_and_b32 s44, s44, 511
s_lshl_b32 s44, s44, 11
buffer_load_dwordx4 v16, s[4:7], s44 offen lds
s_add_u32 m0, s45, 17408
s_add_u32 s44, s56, 392
s_and_b32 s44, s44, 511
s_lshl_b32 s44, s44, 11
buffer_load_dwordx4 v16, s[4:7], s44 offen lds
s_add_u32 m0, s45, 18432
s_add_u32 s44, s56, 400
s_and_b32 s44, s44, 511
s_lshl_b32 s44, s44, 11
buffer_load_dwordx4 v16, s[4:7], s44 offen lds
s_add_u32 m0, s45, 19456
s_add_u32 s44, s56, 408
s_and_b32 s44, s44, 511
s_lshl_b32 s44, s44, 11
buffer_load_dwordx4 v16, s[4:7], s44 offen lds
s_add_u32 m0, s45, 20480
s_add_u32 s44, s56, 416
s_and_b32 s44, s44, 511
s_lshl_b32 s44, s44, 11
buffer_load_dwordx4 v16, s[4:7], s44 offen lds
s_add_u32 m0, s45, 21504
s_add_u32 s44, s56, 424
s_and_b32 s44, s44, 511
s_lshl_b32 s44, s44, 11
buffer_load_dwordx4 v16, s[4:7], s44 offen lds
s_add_u32 m0, s45, 22528
s_add_u32 s44, s56, 432
s_and_b32 s44, s44, 511
s_lshl_b32 s44, s44, 11
buffer_load_dwordx4 v16, s[4:7], s44 offen lds
s_add_u32 m0, s45, 23552
s_add_u32 s44, s56, 440
s_and_b32 s44, s44, 511
s_lshl_b32 s44, s44, 11
buffer_load_dwordx4 v16, s[4:7], s44 offen lds
s_add_u32 m0, s45, 24576
s_add_u32 s44, s56, 448
s_and_b32 s44, s44, 511
s_lshl_b32 s44, s44, 11
buffer_load_dwordx4 v16, s[4:7], s44 offen lds
s_add_u32 m0, s45, 25600
s_add_u32 s44, s56, 456
s_and_b32 s44, s44, 511
s_lshl_b32 s44, s44, 11
buffer_load_dwordx4 v16, s[4:7], s44 offen lds
s_add_u32 m0, s45, 26624
s_add_u32 s44, s56, 464
s_and_b32 s44, s44, 511
s_lshl_b32 s44, s44, 11
buffer_load_dwordx4 v16, s[4:7], s44 offen lds
s_add_u32 m0, s45, 27648
s_add_u32 s44, s56, 472
s_and_b32 s44, s44, 511
s_lshl_b32 s44, s44, 11
buffer_load_dwordx4 v16, s[4:7], s44 offen lds
s_add_u32 m0, s45, 28672
s_add_u32 s44, s56, 480
s_and_b32 s44, s44, 511
s_lshl_b32 s44, s44, 11
buffer_load_dwordx4 v16, s[4:7], s44 offen lds
s_add_u32 m0, s45, 29696
s_add_u32 s44, s56, 488
s_and_b32 s44, s44, 511
s_lshl_b32 s44, s44, 11
buffer_load_dwordx4 v16, s[4:7], s44 offen lds
s_add_u32 m0, s45, 30720
s_add_u32 s44, s56, 496
s_and_b32 s44, s44, 511
s_lshl_b32 s44, s44, 11
buffer_load_dwordx4 v16, s[4:7], s44 offen lds
s_add_u32 m0, s45, 31744
s_add_u32 s44, s56, 504
s_and_b32 s44, s44, 511
s_lshl_b32 s44, s44, 11
buffer_load_dwordx4 v16, s[4:7], s44 offen lds
s_waitcnt vmcnt(16)
ds_read_b64_tr_b16 a[128:129], v17 offset:0
ds_read_b64_tr_b16 a[130:131], v17 offset:2048
ds_read_b64_tr_b16 a[132:133], v17 offset:64
ds_read_b64_tr_b16 a[134:135], v17 offset:2112
ds_read_b64_tr_b16 a[136:137], v17 offset:1024
ds_read_b64_tr_b16 a[138:139], v17 offset:3072
ds_read_b64_tr_b16 a[140:141], v17 offset:1088
ds_read_b64_tr_b16 a[142:143], v17 offset:3136
s_waitcnt lgkmcnt(0)
ds_read_b64_tr_b16 a[144:145], v17 offset:4096
ds_read_b64_tr_b16 a[146:147], v17 offset:6144
ds_read_b64_tr_b16 a[148:149], v17 offset:4160
ds_read_b64_tr_b16 a[150:151], v17 offset:6208
ds_read_b64_tr_b16 a[152:153], v17 offset:5120
ds_read_b64_tr_b16 a[154:155], v17 offset:7168
ds_read_b64_tr_b16 a[156:157], v17 offset:5184
ds_read_b64_tr_b16 a[158:159], v17 offset:7232
s_waitcnt lgkmcnt(0)
ds_read_b64_tr_b16 a[160:161], v17 offset:8192
ds_read_b64_tr_b16 a[162:163], v17 offset:10240
ds_read_b64_tr_b16 a[164:165], v17 offset:8256
ds_read_b64_tr_b16 a[166:167], v17 offset:10304
ds_read_b64_tr_b16 a[168:169], v17 offset:9216
ds_read_b64_tr_b16 a[170:171], v17 offset:11264
ds_read_b64_tr_b16 a[172:173], v17 offset:9280
ds_read_b64_tr_b16 a[174:175], v17 offset:11328
s_waitcnt lgkmcnt(0)
ds_read_b64_tr_b16 a[176:177], v17 offset:12288
ds_read_b64_tr_b16 a[178:179], v17 offset:14336
ds_read_b64_tr_b16 a[180:181], v17 offset:12352
ds_read_b64_tr_b16 a[182:183], v17 offset:14400
ds_read_b64_tr_b16 a[184:185], v17 offset:13312
ds_read_b64_tr_b16 a[186:187], v17 offset:15360
ds_read_b64_tr_b16 a[188:189], v17 offset:13376
ds_read_b64_tr_b16 a[190:191], v17 offset:15424
s_waitcnt lgkmcnt(0)
s_waitcnt vmcnt(0)
ds_read_b64_tr_b16 a[192:193], v17 offset:16384
ds_read_b64_tr_b16 a[194:195], v17 offset:18432
ds_read_b64_tr_b16 a[196:197], v17 offset:16448
ds_read_b64_tr_b16 a[198:199], v17 offset:18496
ds_read_b64_tr_b16 a[200:201], v17 offset:17408
ds_read_b64_tr_b16 a[202:203], v17 offset:19456
ds_read_b64_tr_b16 a[204:205], v17 offset:17472
ds_read_b64_tr_b16 a[206:207], v17 offset:19520
s_waitcnt lgkmcnt(0)
ds_read_b64_tr_b16 a[208:209], v17 offset:20480
ds_read_b64_tr_b16 a[210:211], v17 offset:22528
ds_read_b64_tr_b16 a[212:213], v17 offset:20544
ds_read_b64_tr_b16 a[214:215], v17 offset:22592
ds_read_b64_tr_b16 a[216:217], v17 offset:21504
ds_read_b64_tr_b16 a[218:219], v17 offset:23552
ds_read_b64_tr_b16 a[220:221], v17 offset:21568
ds_read_b64_tr_b16 a[222:223], v17 offset:23616
s_waitcnt lgkmcnt(0)
ds_read_b64_tr_b16 a[224:225], v17 offset:24576
ds_read_b64_tr_b16 a[226:227], v17 offset:26624
ds_read_b64_tr_b16 a[228:229], v17 offset:24640
ds_read_b64_tr_b16 a[230:231], v17 offset:26688
ds_read_b64_tr_b16 a[232:233], v17 offset:25600
ds_read_b64_tr_b16 a[234:235], v17 offset:27648
ds_read_b64_tr_b16 a[236:237], v17 offset:25664
ds_read_b64_tr_b16 a[238:239], v17 offset:27712
s_waitcnt lgkmcnt(0)
ds_read_b64_tr_b16 a[240:241], v17 offset:28672
ds_read_b64_tr_b16 a[242:243], v17 offset:30720
ds_read_b64_tr_b16 a[244:245], v17 offset:28736
ds_read_b64_tr_b16 a[246:247], v17 offset:30784
ds_read_b64_tr_b16 a[248:249], v17 offset:29696
ds_read_b64_tr_b16 a[250:251], v17 offset:31744
ds_read_b64_tr_b16 a[252:253], v17 offset:29760
ds_read_b64_tr_b16 a[254:255], v17 offset:31808
s_waitcnt lgkmcnt(0)
s_barrier
s_cmp_eq_u32 s68, 1
s_cbranch_scc1 mega_kernel_back
mega_kernel_o_hw:
s_lshl_b32 s56, s56, 6
s_lshl_b32 s43, s58, 18
s_lshl_b32 s44, s41, 16
s_add_u32 s43, s43, s44
s_add_u32 s43, s43, 134217728
v_add_u32 v6, s43, v5
v_and_b32 v2, 3, v1
v_lshlrev_b32 v7, 2, v2
v_bfe_u32 v2, v1, 2, 2
v_lshl_add_u32 v7, v2, 7, v7
s_lshl_b32 s43, s58, 11
s_lshl_b32 s44, s41, 9
s_add_u32 s43, s43, s44
s_lshl_b32 s44, s98, 13
s_add_u32 s43, s43, s44
s_add_u32 s43, s43, 69255168
v_add_u32 v7, s43, v7
s_mul_i32 s43, s41, 8704
v_lshrrev_b32 v2, 5, v1
v_lshl_add_u32 v8, v2, 5, v5
v_add_u32 v8, s43, v8
v_and_b32 v2, 7, v1
v_mul_u32_u24 v9, 544, v2
v_lshrrev_b32 v3, 3, v1
v_lshl_add_u32 v9, v3, 4, v9
s_lshl_b32 s43, s41, 7
v_add_u32 v9, s43, v9
s_mul_i32 s43, s58, 4352
s_sub_u32 s44, 4352, s43
v_add_u32 v10, s44, v9
v_add_u32 v9, s43, v9
s_lshl_b32 s43, s41, 15
s_lshl_b32 s44, s40, 6
s_add_u32 s43, s43, s44
v_lshlrev_b32 v11, 12, v3
v_and_b32 v2, 7, v1
v_lshl_add_u32 v11, v2, 3, v11
v_add_u32 v11, s43, v11
s_lshl_b32 s44, s41, 10
s_add_u32 s43, s66, s44
v_add_u32 v13, s43, v5
v_xor_b32 v12, 8192, v13
s_lshl_b32 s71, 1, s67
s_mov_b32 s42, s64
s_mov_b32 s52, 0
s_mov_b32 s53, 0
s_mov_b32 s57, 0
mega_kernel_o_cold:
s_cmp_gt_i32 s52, s42
s_cbranch_scc1 mega_kernel_o_fk
mega_kernel_o_fw:
buffer_load_dword v2, v7, s[84:87], 0 offen sc1
s_waitcnt vmcnt(0)
v_min_i32_dpp v2, v2, v2 quad_perm:[1,0,3,2] row_mask:0xf bank_mask:0xf
s_nop 1
v_min_i32_dpp v2, v2, v2 quad_perm:[2,3,0,1] row_mask:0xf bank_mask:0xf
s_nop 1
v_min_i32_dpp v2, v2, v2 row_ror:4 row_mask:0xf bank_mask:0xf
s_nop 1
v_min_i32_dpp v2, v2, v2 row_ror:8 row_mask:0xf bank_mask:0xf
s_nop 0
v_readfirstlane_b32 s52, v2
s_min_i32 s52, s52, s65
s_cmp_gt_i32 s52, s42
s_cbranch_scc1 mega_kernel_o_fk
s_sleep 2
s_add_u32 s43, s52, 2
s_cmp_gt_i32 s43, s42
s_cbranch_scc1 mega_kernel_o_fw
s_sleep 48
s_branch mega_kernel_o_fw
mega_kernel_o_fk:
s_add_u32 s54, s42, s71
s_cmp_gt_i32 s52, s54
s_cbranch_scc0 mega_kernel_o_c0
s_lshr_b32 s63, s42, 2
s_xnor_b32 s63, s63, s98
s_and_b32 s63, s63, 1
s_lshl_b32 s63, s63, 13
s_lshl_b32 s50, s42, 19
s_add_u32 s50, s50, s63
s_add_u32 s51, s56, 0
s_and_b32 s51, s51, 0x7fff
s_and_b32 s63, s51, 0x6000
s_add_u32 s51, s51, s63
s_add_u32 s51, s51, s50
buffer_load_dwordx4 v[96:99], v6, s[84:87], s51 offen offset:0 sc1
buffer_load_dwordx4 v[100:103], v6, s[84:87], s51 offen offset:1024 sc1
buffer_load_dwordx4 v[104:107], v6, s[84:87], s51 offen offset:2048 sc1
buffer_load_dwordx4 v[108:111], v6, s[84:87], s51 offen offset:3072 sc1
s_add_u32 s51, s56, 4096
s_and_b32 s51, s51, 0x7fff
s_and_b32 s63, s51, 0x6000
s_add_u32 s51, s51, s63
s_add_u32 s51, s51, s50
buffer_load_dwordx4 v[112:115], v6, s[84:87], s51 offen offset:0 sc1
buffer_load_dwordx4 v[116:119], v6, s[84:87], s51 offen offset:1024 sc1
buffer_load_dwordx4 v[120:123], v6, s[84:87], s51 offen offset:2048 sc1
buffer_load_dwordx4 v[124:127], v6, s[84:87], s51 offen offset:3072 sc1
s_add_u32 s51, s56, 8192
s_and_b32 s51, s51, 0x7fff
s_and_b32 s63, s51, 0x6000
s_add_u32 s51, s51, s63
s_add_u32 s51, s51, s50
buffer_load_dwordx4 v[128:131], v6, s[84:87], s51 offen offset:0 sc1
buffer_load_dwordx4 v[132:135], v6, s[84:87], s51 offen offset:1024 sc1
buffer_load_dwordx4 v[136:139], v6, s[84:87], s51 offen offset:2048 sc1
buffer_load_dwordx4 v[140:143], v6, s[84:87], s51 offen offset:3072 sc1
s_add_u32 s51, s56, 12288
s_and_b32 s51, s51, 0x7fff
s_and_b32 s63, s51, 0x6000
s_add_u32 s51, s51, s63
s_add_u32 s51, s51, s50
buffer_load_dwordx4 v[144:147], v6, s[84:87], s51 offen offset:0 sc1
buffer_load_dwordx4 v[148:151], v6, s[84:87], s51 offen offset:1024 sc1
buffer_load_dwordx4 v[152:155], v6, s[84:87], s51 offen offset:2048 sc1
buffer_load_dwordx4 v[156:159], v6, s[84:87], s51 offen offset:3072 sc1
s_add_u32 s51, s56, 16384
s_and_b32 s51, s51, 0x7fff
s_and_b32 s63, s51, 0x6000
s_add_u32 s51, s51, s63
s_add_u32 s51, s51, s50
buffer_load_dwordx4 v[160:163], v6, s[84:87], s51 offen offset:0 sc1
buffer_load_dwordx4 v[164:167], v6, s[84:87], s51 offen offset:1024 sc1
buffer_load_dwordx4 v[168:171], v6, s[84:87], s51 offen offset:2048 sc1
buffer_load_dwordx4 v[172:175], v6, s[84:87], s51 offen offset:3072 sc1
s_add_u32 s51, s56, 20480
s_and_b32 s51, s51, 0x7fff
s_and_b32 s63, s51, 0x6000
s_add_u32 s51, s51, s63
s_add_u32 s51, s51, s50
buffer_load_dwordx4 v[176:179], v6, s[84:87], s51 offen offset:0 sc1
buffer_load_dwordx4 v[180:183], v6, s[84:87], s51 offen offset:1024 sc1
buffer_load_dwordx4 v[184:187], v6, s[84:87], s51 offen offset:2048 sc1
buffer_load_dwordx4 v[188:191], v6, s[84:87], s51 offen offset:3072 sc1
s_add_u32 s51, s56, 24576
s_and_b32 s51, s51, 0x7fff
s_and_b32 s63, s51, 0x6000
s_add_u32 s51, s51, s63
s_add_u32 s51, s51, s50
buffer_load_dwordx4 v[192:195], v6, s[84:87], s51 offen offset:0 sc1
buffer_load_dwordx4 v[196:199], v6, s[84:87], s51 offen offset:1024 sc1
buffer_load_dwordx4 v[200:203], v6, s[84:87], s51 offen offset:2048 sc1
buffer_load_dwordx4 v[204:207], v6, s[84:87], s51 offen offset:3072 sc1
s_add_u32 s51, s56, 28672
s_and_b32 s51, s51, 0x7fff
s_and_b32 s63, s51, 0x6000
s_add_u32 s51, s51, s63
s_add_u32 s51, s51, s50
buffer_load_dwordx4 v[208:211], v6, s[84:87], s51 offen offset:0 sc1
buffer_load_dwordx4 v[212:215], v6, s[84:87], s51 offen offset:1024 sc1
buffer_load_dwordx4 v[216:219], v6, s[84:87], s51 offen offset:2048 sc1
buffer_load_dwordx4 v[220:223], v6, s[84:87], s51 offen offset:3072 sc1
mega_kernel_o_w0:
s_add_u32 s54, s42, s71
s_sub_u32 s62, s42, s71
s_lshr_b32 s63, s54, 2
s_xnor_b32 s63, s63, s98
s_and_b32 s63, s63, 1
s_lshl_b32 s63, s63, 13
s_lshl_b32 s50, s54, 19
s_add_u32 s50, s50, s63
s_cmp_gt_i32 s52, s54
s_cbranch_scc0 mega_kernel_o_n0
s_waitcnt vmcnt(31)
v_mfma_f32_32x32x16_bf16 v[20:35], a[0:3], v[96:99], 0
v_mfma_f32_32x32x16_bf16 v[36:51], a[4:7], v[96:99], 0
s_add_u32 s51, s56, 0
s_and_b32 s51, s51, 0x7fff
s_and_b32 s63, s51, 0x6000
s_add_u32 s51, s51, s63
s_add_u32 s51, s51, s50
buffer_load_dwordx4 v[96:99], v6, s[84:87], s51 offen offset:0 sc1
s_waitcnt vmcnt(31)
v_mfma_f32_32x32x16_bf16 v[20:35], a[8:11], v[100:103], v[20:35]
v_mfma_f32_32x32x16_bf16 v[36:51], a[12:15], v[100:103], v[36:51]
buffer_load_dwordx4 v[100:103], v6, s[84:87], s51 offen offset:1024 sc1
s_waitcnt vmcnt(31)
v_mfma_f32_32x32x16_bf16 v[20:35], a[16:19], v[104:107], v[20:35]
v_mfma_f32_32x32x16_bf16 v[36:51], a[20:23], v[104:107], v[36:51]
buffer_load_dwordx4 v[104:107], v6, s[84:87], s51 offen offset:2048 sc1
s_waitcnt vmcnt(31)
v_mfma_f32_32x32x16_bf16 v[20:35], a[24:27], v[108:111], v[20:35]
v_mfma_f32_32x32x16_bf16 v[36:51], a[28:31], v[108:111], v[36:51]
buffer_load_dwordx4 v[108:111], v6, s[84:87], s51 offen offset:3072 sc1
s_waitcnt vmcnt(31)
v_mfma_f32_32x32x16_bf16 v[20:35], a[32:35], v[112:115], v[20:35]
v_mfma_f32_32x32x16_bf16 v[36:51], a[36:39], v[112:115], v[36:51]
s_add_u32 s51, s56, 4096
s_and_b32 s51, s51, 0x7fff
s_and_b32 s63, s51, 0x6000
s_add_u32 s51, s51, s63
s_add_u32 s51, s51, s50
buffer_load_dwordx4 v[112:115], v6, s[84:87], s51 offen offset:0 sc1
s_waitcnt vmcnt(31)
v_mfma_f32_32x32x16_bf16 v[20:35], a[40:43], v[116:119], v[20:35]
v_mfma_f32_32x32x16_bf16 v[36:51], a[44:47], v[116:119], v[36:51]
buffer_load_dwordx4 v[116:119], v6, s[84:87], s51 offen offset:1024 sc1
s_waitcnt vmcnt(31)
v_mfma_f32_32x32x16_bf16 v[20:35], a[48:51], v[120:123], v[20:35]
v_mfma_f32_32x32x16_bf16 v[36:51], a[52:55], v[120:123], v[36:51]
buffer_load_dwordx4 v[120:123], v6, s[84:87], s51 offen offset:2048 sc1
s_waitcnt vmcnt(31)
v_mfma_f32_32x32x16_bf16 v[20:35], a[56:59], v[124:127], v[20:35]
v_mfma_f32_32x32x16_bf16 v[36:51], a[60:63], v[124:127], v[36:51]
buffer_load_dwordx4 v[124:127], v6, s[84:87], s51 offen offset:3072 sc1
s_waitcnt vmcnt(31)
v_mfma_f32_32x32x16_bf16 v[20:35], a[64:67], v[128:131], v[20:35]
v_mfma_f32_32x32x16_bf16 v[36:51], a[68:71], v[128:131], v[36:51]
s_add_u32 s51, s56, 8192
s_and_b32 s51, s51, 0x7fff
s_and_b32 s63, s51, 0x6000
s_add_u32 s51, s51, s63
s_add_u32 s51, s51, s50
buffer_load_dwordx4 v[128:131], v6, s[84:87], s51 offen offset:0 sc1
s_waitcnt vmcnt(31)
v_mfma_f32_32x32x16_bf16 v[20:35], a[72:75], v[132:135], v[20:35]
v_mfma_f32_32x32x16_bf16 v[36:51], a[76:79], v[132:135], v[36:51]
buffer_load_dwordx4 v[132:135], v6, s[84:87], s51 offen offset:1024 sc1
s_waitcnt vmcnt(31)
v_mfma_f32_32x32x16_bf16 v[20:35], a[80:83], v[136:139], v[20:35]
v_mfma_f32_32x32x16_bf16 v[36:51], a[84:87], v[136:139], v[36:51]
buffer_load_dwordx4 v[136:139], v6, s[84:87], s51 offen offset:2048 sc1
s_waitcnt vmcnt(31)
v_mfma_f32_32x32x16_bf16 v[20:35], a[88:91], v[140:143], v[20:35]
v_mfma_f32_32x32x16_bf16 v[36:51], a[92:95], v[140:143], v[36:51]
buffer_load_dwordx4 v[140:143], v6, s[84:87], s51 offen offset:3072 sc1
s_waitcnt vmcnt(31)
v_mfma_f32_32x32x16_bf16 v[20:35], a[96:99], v[144:147], v[20:35]
v_mfma_f32_32x32x16_bf16 v[36:51], a[100:103], v[144:147], v[36:51]
s_add_u32 s51, s56, 12288
s_and_b32 s51, s51, 0x7fff
s_and_b32 s63, s51, 0x6000
s_add_u32 s51, s51, s63
s_add_u32 s51, s51, s50
buffer_load_dwordx4 v[144:147], v6, s[84:87], s51 offen offset:0 sc1
s_waitcnt vmcnt(31)
v_mfma_f32_32x32x16_bf16 v[20:35], a[104:107], v[148:151], v[20:35]
v_mfma_f32_32x32x16_bf16 v[36:51], a[108:111], v[148:151], v[36:51]
buffer_load_dwordx4 v[148:151], v6, s[84:87], s51 offen offset:1024 sc1
s_waitcnt vmcnt(31)
v_mfma_f32_32x32x16_bf16 v[20:35], a[112:115], v[152:155], v[20:35]
v_mfma_f32_32x32x16_bf16 v[36:51], a[116:119], v[152:155], v[36:51]
buffer_load_dwordx4 v[152:155], v6, s[84:87], s51 offen offset:2048 sc1
s_waitcnt vmcnt(31)
v_mfma_f32_32x32x16_bf16 v[20:35], a[120:123], v[156:159], v[20:35]
v_mfma_f32_32x32x16_bf16 v[36:51], a[124:127], v[156:159], v[36:51]
buffer_load_dwordx4 v[156:159], v6, s[84:87], s51 offen offset:3072 sc1
s_waitcnt vmcnt(31)
v_mfma_f32_32x32x16_bf16 v[20:35], a[128:131], v[160:163], v[20:35]
v_mfma_f32_32x32x16_bf16 v[36:51], a[132:135], v[160:163], v[36:51]
s_add_u32 s51, s56, 16384
s_and_b32 s51, s51, 0x7fff
s_and_b32 s63, s51, 0x6000
s_add_u32 s51, s51, s63
s_add_u32 s51, s51, s50
buffer_load_dwordx4 v[160:163], v6, s[84:87], s51 offen offset:0 sc1
s_waitcnt vmcnt(31)
v_mfma_f32_32x32x16_bf16 v[20:35], a[136:139], v[164:167], v[20:35]
v_mfma_f32_32x32x16_bf16 v[36:51], a[140:143], v[164:167], v[36:51]
buffer_load_dwordx4 v[164:167], v6, s[84:87], s51 offen offset:1024 sc1
s_waitcnt vmcnt(31)
v_mfma_f32_32x32x16_bf16 v[20:35], a[144:147], v[168:171], v[20:35]
v_mfma_f32_32x32x16_bf16 v[36:51], a[148:151], v[168:171], v[36:51]
buffer_load_dwordx4 v[168:171], v6, s[84:87], s51 offen offset:2048 sc1
s_waitcnt vmcnt(31)
v_mfma_f32_32x32x16_bf16 v[20:35], a[152:155], v[172:175], v[20:35]
v_mfma_f32_32x32x16_bf16 v[36:51], a[156:159], v[172:175], v[36:51]
buffer_load_dwordx4 v[172:175], v6, s[84:87], s51 offen offset:3072 sc1
s_waitcnt vmcnt(31)
v_mfma_f32_32x32x16_bf16 v[20:35], a[160:163], v[176:179], v[20:35]
v_mfma_f32_32x32x16_bf16 v[36:51], a[164:167], v[176:179], v[36:51]
s_add_u32 s51, s56, 20480
s_and_b32 s51, s51, 0x7fff
s_and_b32 s63, s51, 0x6000
s_add_u32 s51, s51, s63
s_add_u32 s51, s51, s50
buffer_load_dwordx4 v[176:179], v6, s[84:87], s51 offen offset:0 sc1
s_waitcnt vmcnt(31)
v_mfma_f32_32x32x16_bf16 v[20:35], a[168:171], v[180:183], v[20:35]
v_mfma_f32_32x32x16_bf16 v[36:51], a[172:175], v[180:183], v[36:51]
buffer_load_dwordx4 v[180:183], v6, s[84:87], s51 offen offset:1024 sc1
s_waitcnt vmcnt(31)
v_mfma_f32_32x32x16_bf16 v[20:35], a[176:179], v[184:187], v[20:35]
v_mfma_f32_32x32x16_bf16 v[36:51], a[180:183], v[184:187], v[36:51]
buffer_load_dwordx4 v[184:187], v6, s[84:87], s51 offen offset:2048 sc1
s_waitcnt vmcnt(31)
v_mfma_f32_32x32x16_bf16 v[20:35], a[184:187], v[188:191], v[20:35]
v_mfma_f32_32x32x16_bf16 v[36:51], a[188:191], v[188:191], v[36:51]
buffer_load_dwordx4 v[188:191], v6, s[84:87], s51 offen offset:3072 sc1
s_waitcnt vmcnt(31)
v_mfma_f32_32x32x16_bf16 v[20:35], a[192:195], v[192:195], v[20:35]
v_mfma_f32_32x32x16_bf16 v[36:51], a[196:199], v[192:195], v[36:51]
s_add_u32 s51, s56, 24576
s_and_b32 s51, s51, 0x7fff
s_and_b32 s63, s51, 0x6000
s_add_u32 s51, s51, s63
s_add_u32 s51, s51, s50
buffer_load_dwordx4 v[192:195], v6, s[84:87], s51 offen offset:0 sc1
s_waitcnt vmcnt(31)
v_mfma_f32_32x32x16_bf16 v[20:35], a[200:203], v[196:199], v[20:35]
v_mfma_f32_32x32x16_bf16 v[36:51], a[204:207], v[196:199], v[36:51]
buffer_load_dwordx4 v[196:199], v6, s[84:87], s51 offen offset:1024 sc1
s_waitcnt vmcnt(31)
v_mfma_f32_32x32x16_bf16 v[20:35], a[208:211], v[200:203], v[20:35]
v_mfma_f32_32x32x16_bf16 v[36:51], a[212:215], v[200:203], v[36:51]
buffer_load_dwordx4 v[200:203], v6, s[84:87], s51 offen offset:2048 sc1
s_waitcnt vmcnt(31)
v_mfma_f32_32x32x16_bf16 v[20:35], a[216:219], v[204:207], v[20:35]
v_mfma_f32_32x32x16_bf16 v[36:51], a[220:223], v[204:207], v[36:51]
buffer_load_dwordx4 v[204:207], v6, s[84:87], s51 offen offset:3072 sc1
s_waitcnt vmcnt(31)
v_mfma_f32_32x32x16_bf16 v[20:35], a[224:227], v[208:211], v[20:35]
v_mfma_f32_32x32x16_bf16 v[36:51], a[228:231], v[208:211], v[36:51]
s_add_u32 s51, s56, 28672
s_and_b32 s51, s51, 0x7fff
s_and_b32 s63, s51, 0x6000
s_add_u32 s51, s51, s63
s_add_u32 s51, s51, s50
buffer_load_dwordx4 v[208:211], v6, s[84:87], s51 offen offset:0 sc1
s_waitcnt vmcnt(31)
v_mfma_f32_32x32x16_bf16 v[20:35], a[232:235], v[212:215], v[20:35]
v_mfma_f32_32x32x16_bf16 v[36:51], a[236:239], v[212:215], v[36:51]
buffer_load_dwordx4 v[212:215], v6, s[84:87], s51 offen offset:1024 sc1
s_waitcnt vmcnt(31)
v_mfma_f32_32x32x16_bf16 v[20:35], a[240:243], v[216:219], v[20:35]
v_mfma_f32_32x32x16_bf16 v[36:51], a[244:247], v[216:219], v[36:51]
buffer_load_dwordx4 v[216:219], v6, s[84:87], s51 offen offset:2048 sc1
s_waitcnt vmcnt(31)
v_mfma_f32_32x32x16_bf16 v[224:239], a[248:251], v[220:223], v[20:35]
v_mfma_f32_32x32x16_bf16 v[240:255], a[252:255], v[220:223], v[36:51]
buffer_load_dwordx4 v[220:223], v6, s[84:87], s51 offen offset:3072 sc1
s_add_u32 s42, s42, s71
s_branch mega_kernel_o_w1
mega_kernel_o_n0:
s_waitcnt vmcnt(31)
v_mfma_f32_32x32x16_bf16 v[20:35], a[0:3], v[96:99], 0
v_mfma_f32_32x32x16_bf16 v[36:51], a[4:7], v[96:99], 0
s_waitcnt vmcnt(30)
v_mfma_f32_32x32x16_bf16 v[20:35], a[8:11], v[100:103], v[20:35]
v_mfma_f32_32x32x16_bf16 v[36:51], a[12:15], v[100:103], v[36:51]
s_waitcnt vmcnt(29)
v_mfma_f32_32x32x16_bf16 v[20:35], a[16:19], v[104:107], v[20:35]
v_mfma_f32_32x32x16_bf16 v[36:51], a[20:23], v[104:107], v[36:51]
s_waitcnt vmcnt(28)
v_mfma_f32_32x32x16_bf16 v[20:35], a[24:27], v[108:111], v[20:35]
v_mfma_f32_32x32x16_bf16 v[36:51], a[28:31], v[108:111], v[36:51]
s_waitcnt vmcnt(27)
v_mfma_f32_32x32x16_bf16 v[20:35], a[32:35], v[112:115], v[20:35]
v_mfma_f32_32x32x16_bf16 v[36:51], a[36:39], v[112:115], v[36:51]
s_waitcnt vmcnt(26)
v_mfma_f32_32x32x16_bf16 v[20:35], a[40:43], v[116:119], v[20:35]
v_mfma_f32_32x32x16_bf16 v[36:51], a[44:47], v[116:119], v[36:51]
s_waitcnt vmcnt(25)
v_mfma_f32_32x32x16_bf16 v[20:35], a[48:51], v[120:123], v[20:35]
v_mfma_f32_32x32x16_bf16 v[36:51], a[52:55], v[120:123], v[36:51]
s_waitcnt vmcnt(24)
v_mfma_f32_32x32x16_bf16 v[20:35], a[56:59], v[124:127], v[20:35]
v_mfma_f32_32x32x16_bf16 v[36:51], a[60:63], v[124:127], v[36:51]
s_waitcnt vmcnt(23)
v_mfma_f32_32x32x16_bf16 v[20:35], a[64:67], v[128:131], v[20:35]
v_mfma_f32_32x32x16_bf16 v[36:51], a[68:71], v[128:131], v[36:51]
s_waitcnt vmcnt(22)
v_mfma_f32_32x32x16_bf16 v[20:35], a[72:75], v[132:135], v[20:35]
v_mfma_f32_32x32x16_bf16 v[36:51], a[76:79], v[132:135], v[36:51]
s_waitcnt vmcnt(21)
v_mfma_f32_32x32x16_bf16 v[20:35], a[80:83], v[136:139], v[20:35]
v_mfma_f32_32x32x16_bf16 v[36:51], a[84:87], v[136:139], v[36:51]
s_waitcnt vmcnt(20)
v_mfma_f32_32x32x16_bf16 v[20:35], a[88:91], v[140:143], v[20:35]
v_mfma_f32_32x32x16_bf16 v[36:51], a[92:95], v[140:143], v[36:51]
s_waitcnt vmcnt(19)
v_mfma_f32_32x32x16_bf16 v[20:35], a[96:99], v[144:147], v[20:35]
v_mfma_f32_32x32x16_bf16 v[36:51], a[100:103], v[144:147], v[36:51]
s_waitcnt vmcnt(18)
v_mfma_f32_32x32x16_bf16 v[20:35], a[104:107], v[148:151], v[20:35]
v_mfma_f32_32x32x16_bf16 v[36:51], a[108:111], v[148:151], v[36:51]
s_waitcnt vmcnt(17)
v_mfma_f32_32x32x16_bf16 v[20:35], a[112:115], v[152:155], v[20:35]
v_mfma_f32_32x32x16_bf16 v[36:51], a[116:119], v[152:155], v[36:51]
s_waitcnt vmcnt(16)
v_mfma_f32_32x32x16_bf16 v[20:35], a[120:123], v[156:159], v[20:35]
v_mfma_f32_32x32x16_bf16 v[36:51], a[124:127], v[156:159], v[36:51]
s_waitcnt vmcnt(15)
v_mfma_f32_32x32x16_bf16 v[20:35], a[128:131], v[160:163], v[20:35]
v_mfma_f32_32x32x16_bf16 v[36:51], a[132:135], v[160:163], v[36:51]
s_waitcnt vmcnt(14)
v_mfma_f32_32x32x16_bf16 v[20:35], a[136:139], v[164:167], v[20:35]
v_mfma_f32_32x32x16_bf16 v[36:51], a[140:143], v[164:167], v[36:51]
s_waitcnt vmcnt(13)
v_mfma_f32_32x32x16_bf16 v[20:35], a[144:147], v[168:171], v[20:35]
v_mfma_f32_32x32x16_bf16 v[36:51], a[148:151], v[168:171], v[36:51]
s_waitcnt vmcnt(12)
v_mfma_f32_32x32x16_bf16 v[20:35], a[152:155], v[172:175], v[20:35]
v_mfma_f32_32x32x16_bf16 v[36:51], a[156:159], v[172:175], v[36:51]
s_waitcnt vmcnt(11)
v_mfma_f32_32x32x16_bf16 v[20:35], a[160:163], v[176:179], v[20:35]
v_mfma_f32_32x32x16_bf16 v[36:51], a[164:167], v[176:179], v[36:51]
buffer_load_dword v15, v7, s[84:87], 0 offen sc1
s_waitcnt vmcnt(10)
v_mfma_f32_32x32x16_bf16 v[20:35], a[168:171], v[180:183], v[20:35]
v_mfma_f32_32x32x16_bf16 v[36:51], a[172:175], v[180:183], v[36:51]
s_waitcnt vmcnt(9)
v_mfma_f32_32x32x16_bf16 v[20:35], a[176:179], v[184:187], v[20:35]
v_mfma_f32_32x32x16_bf16 v[36:51], a[180:183], v[184:187], v[36:51]
s_waitcnt vmcnt(8)
v_mfma_f32_32x32x16_bf16 v[20:35], a[184:187], v[188:191], v[20:35]
v_mfma_f32_32x32x16_bf16 v[36:51], a[188:191], v[188:191], v[36:51]
s_waitcnt vmcnt(7)
v_mfma_f32_32x32x16_bf16 v[20:35], a[192:195], v[192:195], v[20:35]
v_mfma_f32_32x32x16_bf16 v[36:51], a[196:199], v[192:195], v[36:51]
s_waitcnt vmcnt(6)
v_mfma_f32_32x32x16_bf16 v[20:35], a[200:203], v[196:199], v[20:35]
v_mfma_f32_32x32x16_bf16 v[36:51], a[204:207], v[196:199], v[36:51]
s_waitcnt vmcnt(5)
v_mfma_f32_32x32x16_bf16 v[20:35], a[208:211], v[200:203], v[20:35]
v_mfma_f32_32x32x16_bf16 v[36:51], a[212:215], v[200:203], v[36:51]
s_waitcnt vmcnt(4)
v_mfma_f32_32x32x16_bf16 v[20:35], a[216:219], v[204:207], v[20:35]
v_mfma_f32_32x32x16_bf16 v[36:51], a[220:223], v[204:207], v[36:51]
s_waitcnt vmcnt(3)
v_mfma_f32_32x32x16_bf16 v[20:35], a[224:227], v[208:211], v[20:35]
v_mfma_f32_32x32x16_bf16 v[36:51], a[228:231], v[208:211], v[36:51]
s_waitcnt vmcnt(2)
v_mfma_f32_32x32x16_bf16 v[20:35], a[232:235], v[212:215], v[20:35]
v_mfma_f32_32x32x16_bf16 v[36:51], a[236:239], v[212:215], v[36:51]
s_waitcnt vmcnt(1)
v_mfma_f32_32x32x16_bf16 v[20:35], a[240:243], v[216:219], v[20:35]
v_mfma_f32_32x32x16_bf16 v[36:51], a[244:247], v[216:219], v[36:51]
s_waitcnt vmcnt(0)
v_mfma_f32_32x32x16_bf16 v[224:239], a[248:251], v[220:223], v[20:35]
v_mfma_f32_32x32x16_bf16 v[240:255], a[252:255], v[220:223], v[36:51]
s_branch mega_kernel_o_imm
mega_kernel_o_w1:
s_add_u32 s54, s42, s71
s_sub_u32 s62, s42, s71
s_lshr_b32 s63, s54, 2
s_xnor_b32 s63, s63, s98
s_and_b32 s63, s63, 1
s_lshl_b32 s63, s63, 13
s_lshl_b32 s50, s54, 19
s_add_u32 s50, s50, s63
s_cmp_gt_i32 s52, s54
s_cbranch_scc0 mega_kernel_o_n1
s_waitcnt vmcnt(31)
v_mfma_f32_32x32x16_bf16 v[20:35], a[0:3], v[96:99], 0
v_mfma_f32_32x32x16_bf16 v[36:51], a[4:7], v[96:99], 0
s_add_u32 s51, s56, 0
s_and_b32 s51, s51, 0x7fff
s_and_b32 s63, s51, 0x6000
s_add_u32 s51, s51, s63
s_add_u32 s51, s51, s50
buffer_load_dwordx4 v[96:99], v6, s[84:87], s51 offen offset:0 sc1
s_waitcnt vmcnt(31)
v_mfma_f32_32x32x16_bf16 v[20:35], a[8:11], v[100:103], v[20:35]
v_mfma_f32_32x32x16_bf16 v[36:51], a[12:15], v[100:103], v[36:51]
buffer_load_dwordx4 v[100:103], v6, s[84:87], s51 offen offset:1024 sc1
v_add_u32 v2, s53, v8
v_add_u32 v3, s53, v9
v_add_u32 v4, s53, v10
s_waitcnt vmcnt(31)
v_mfma_f32_32x32x16_bf16 v[20:35], a[16:19], v[104:107], v[20:35]
v_mfma_f32_32x32x16_bf16 v[36:51], a[20:23], v[104:107], v[36:51]
buffer_load_dwordx4 v[104:107], v6, s[84:87], s51 offen offset:2048 sc1
ds_write_b128 v2, v[224:227] offset:0
ds_write_b128 v2, v[228:231] offset:1088
s_waitcnt vmcnt(31)
v_mfma_f32_32x32x16_bf16 v[20:35], a[24:27], v[108:111], v[20:35]
v_mfma_f32_32x32x16_bf16 v[36:51], a[28:31], v[108:111], v[36:51]
buffer_load_dwordx4 v[108:111], v6, s[84:87], s51 offen offset:3072 sc1
ds_write_b128 v2, v[232:235] offset:2176
ds_write_b128 v2, v[236:239] offset:3264
s_waitcnt vmcnt(31)
v_mfma_f32_32x32x16_bf16 v[20:35], a[32:35], v[112:115], v[20:35]
v_mfma_f32_32x32x16_bf16 v[36:51], a[36:39], v[112:115], v[36:51]
s_add_u32 s51, s56, 4096
s_and_b32 s51, s51, 0x7fff
s_and_b32 s63, s51, 0x6000
s_add_u32 s51, s51, s63
s_add_u32 s51, s51, s50
buffer_load_dwordx4 v[112:115], v6, s[84:87], s51 offen offset:0 sc1
ds_write_b128 v2, v[240:243] offset:4352
ds_write_b128 v2, v[244:247] offset:5440
s_waitcnt vmcnt(31)
v_mfma_f32_32x32x16_bf16 v[20:35], a[40:43], v[116:119], v[20:35]
v_mfma_f32_32x32x16_bf16 v[36:51], a[44:47], v[116:119], v[36:51]
buffer_load_dwordx4 v[116:119], v6, s[84:87], s51 offen offset:1024 sc1
ds_write_b128 v2, v[248:251] offset:6528
ds_write_b128 v2, v[252:255] offset:7616
s_waitcnt vmcnt(31)
v_mfma_f32_32x32x16_bf16 v[20:35], a[48:51], v[120:123], v[20:35]
v_mfma_f32_32x32x16_bf16 v[36:51], a[52:55], v[120:123], v[36:51]
buffer_load_dwordx4 v[120:123], v6, s[84:87], s51 offen offset:2048 sc1
s_waitcnt vmcnt(31)
v_mfma_f32_32x32x16_bf16 v[20:35], a[56:59], v[124:127], v[20:35]
v_mfma_f32_32x32x16_bf16 v[36:51], a[60:63], v[124:127], v[36:51]
buffer_load_dwordx4 v[124:127], v6, s[84:87], s51 offen offset:3072 sc1
s_waitcnt lgkmcnt(0)
s_barrier
ds_read_b128 v[52:55], v4 offset:0
ds_read_b128 v[56:59], v4 offset:8704
ds_read_b128 v[60:63], v4 offset:17408
ds_read_b128 v[64:67], v4 offset:26112
s_waitcnt vmcnt(31)
v_mfma_f32_32x32x16_bf16 v[20:35], a[64:67], v[128:131], v[20:35]
v_mfma_f32_32x32x16_bf16 v[36:51], a[68:71], v[128:131], v[36:51]
s_add_u32 s51, s56, 8192
s_and_b32 s51, s51, 0x7fff
s_and_b32 s63, s51, 0x6000
s_add_u32 s51, s51, s63
s_add_u32 s51, s51, s50
buffer_load_dwordx4 v[128:131], v6, s[84:87], s51 offen offset:0 sc1
ds_read_b128 v[68:71], v3 offset:0
ds_read_b128 v[72:75], v3 offset:8704
ds_read_b128 v[76:79], v3 offset:17408
ds_read_b128 v[80:83], v3 offset:26112
s_sub_u32 s53, 34816, s53
s_sub_u32 s60, s62, s64
s_lshr_b32 s60, s60, s67
s_bfe_u32 s61, s60, 0x10001
s_and_b32 s60, s60, 1
s_lshl_b32 s60, s60, 12
s_waitcnt vmcnt(31)
v_mfma_f32_32x32x16_bf16 v[20:35], a[72:75], v[132:135], v[20:35]
v_mfma_f32_32x32x16_bf16 v[36:51], a[76:79], v[132:135], v[36:51]
buffer_load_dwordx4 v[132:135], v6, s[84:87], s51 offen offset:1024 sc1
s_waitcnt vmcnt(31)
v_mfma_f32_32x32x16_bf16 v[20:35], a[80:83], v[136:139], v[20:35]
v_mfma_f32_32x32x16_bf16 v[36:51], a[84:87], v[136:139], v[36:51]
buffer_load_dwordx4 v[136:139], v6, s[84:87], s51 offen offset:2048 sc1
s_waitcnt lgkmcnt(4)
v_add_f32 v52, v52, v56
v_add_f32 v60, v60, v64
v_add_f32 v53, v53, v57
v_add_f32 v61, v61, v65
v_add_f32 v54, v54, v58
v_add_f32 v62, v62, v66
v_add_f32 v55, v55, v59
v_add_f32 v63, v63, v67
s_waitcnt vmcnt(31)
v_mfma_f32_32x32x16_bf16 v[20:35], a[88:91], v[140:143], v[20:35]
v_mfma_f32_32x32x16_bf16 v[36:51], a[92:95], v[140:143], v[36:51]
buffer_load_dwordx4 v[140:143], v6, s[84:87], s51 offen offset:3072 sc1
v_add_f32 v52, v52, v60
v_add_f32 v53, v53, v61
v_add_f32 v54, v54, v62
v_add_f32 v55, v55, v63
v_and_or_b32 v52, v52, -2, s61
s_cmp_eq_u32 s95, 0
s_cbranch_scc1 mega_kernel_o_sa1
buffer_store_dwordx4 v[52:55], v12, s[84:87], s60 offen sc1
s_branch mega_kernel_o_sb1
mega_kernel_o_sa1:
buffer_store_dwordx4 v[52:55], v12, s[84:87], s60 offen
mega_kernel_o_sb1:
s_waitcnt vmcnt(31)
v_mfma_f32_32x32x16_bf16 v[20:35], a[96:99], v[144:147], v[20:35]
v_mfma_f32_32x32x16_bf16 v[36:51], a[100:103], v[144:147], v[36:51]
s_add_u32 s51, s56, 12288
s_and_b32 s51, s51, 0x7fff
s_and_b32 s63, s51, 0x6000
s_add_u32 s51, s51, s63
s_add_u32 s51, s51, s50
buffer_load_dwordx4 v[144:147], v6, s[84:87], s51 offen offset:0 sc1
s_waitcnt lgkmcnt(0)
v_add_f32 v68, v68, v72
v_add_f32 v76, v76, v80
v_add_f32 v69, v69, v73
v_add_f32 v77, v77, v81
v_add_f32 v70, v70, v74
v_add_f32 v78, v78, v82
v_add_f32 v71, v71, v75
v_add_f32 v79, v79, v83
s_waitcnt vmcnt(31)
v_mfma_f32_32x32x16_bf16 v[20:35], a[104:107], v[148:151], v[20:35]
v_mfma_f32_32x32x16_bf16 v[36:51], a[108:111], v[148:151], v[36:51]
buffer_load_dwordx4 v[148:151], v6, s[84:87], s51 offen offset:1024 sc1
v_add_f32 v84, v68, v76
v_add_f32 v85, v69, v77
v_add_f32 v86, v70, v78
v_add_f32 v87, v71, v79
s_waitcnt vmcnt(31)
v_mfma_f32_32x32x16_bf16 v[20:35], a[112:115], v[152:155], v[20:35]
v_mfma_f32_32x32x16_bf16 v[36:51], a[116:119], v[152:155], v[36:51]
buffer_load_dwordx4 v[152:155], v6, s[84:87], s51 offen offset:2048 sc1
s_waitcnt vmcnt(31)
v_mfma_f32_32x32x16_bf16 v[20:35], a[120:123], v[156:159], v[20:35]
v_mfma_f32_32x32x16_bf16 v[36:51], a[124:127], v[156:159], v[36:51]
buffer_load_dwordx4 v[156:159], v6, s[84:87], s51 offen offset:3072 sc1
s_waitcnt vmcnt(31)
v_mfma_f32_32x32x16_bf16 v[20:35], a[128:131], v[160:163], v[20:35]
v_mfma_f32_32x32x16_bf16 v[36:51], a[132:135], v[160:163], v[36:51]
s_add_u32 s51, s56, 16384
s_and_b32 s51, s51, 0x7fff
s_and_b32 s63, s51, 0x6000
s_add_u32 s51, s51, s63
s_add_u32 s51, s51, s50
buffer_load_dwordx4 v[160:163], v6, s[84:87], s51 offen offset:0 sc1
s_waitcnt vmcnt(31)
v_mfma_f32_32x32x16_bf16 v[20:35], a[136:139], v[164:167], v[20:35]
v_mfma_f32_32x32x16_bf16 v[36:51], a[140:143], v[164:167], v[36:51]
buffer_load_dwordx4 v[164:167], v6, s[84:87], s51 offen offset:1024 sc1
s_waitcnt vmcnt(31)
v_mfma_f32_32x32x16_bf16 v[20:35], a[144:147], v[168:171], v[20:35]
v_mfma_f32_32x32x16_bf16 v[36:51], a[148:151], v[168:171], v[36:51]
buffer_load_dwordx4 v[168:171], v6, s[84:87], s51 offen offset:2048 sc1
s_waitcnt vmcnt(31)
v_mfma_f32_32x32x16_bf16 v[20:35], a[152:155], v[172:175], v[20:35]
v_mfma_f32_32x32x16_bf16 v[36:51], a[156:159], v[172:175], v[36:51]
buffer_load_dwordx4 v[172:175], v6, s[84:87], s51 offen offset:3072 sc1
s_waitcnt vmcnt(31)
v_mfma_f32_32x32x16_bf16 v[20:35], a[160:163], v[176:179], v[20:35]
v_mfma_f32_32x32x16_bf16 v[36:51], a[164:167], v[176:179], v[36:51]
s_add_u32 s51, s56, 20480
s_and_b32 s51, s51, 0x7fff
s_and_b32 s63, s51, 0x6000
s_add_u32 s51, s51, s63
s_add_u32 s51, s51, s50
buffer_load_dwordx4 v[176:179], v6, s[84:87], s51 offen offset:0 sc1
s_waitcnt vmcnt(31)
v_mfma_f32_32x32x16_bf16 v[20:35], a[168:171], v[180:183], v[20:35]
v_mfma_f32_32x32x16_bf16 v[36:51], a[172:175], v[180:183], v[36:51]
buffer_load_dwordx4 v[180:183], v6, s[84:87], s51 offen offset:1024 sc1
s_waitcnt vmcnt(31)
v_mfma_f32_32x32x16_bf16 v[20:35], a[176:179], v[184:187], v[20:35]
v_mfma_f32_32x32x16_bf16 v[36:51], a[180:183], v[184:187], v[36:51]
buffer_load_dwordx4 v[184:187], v6, s[84:87], s51 offen offset:2048 sc1
s_waitcnt vmcnt(31)
v_mfma_f32_32x32x16_bf16 v[20:35], a[184:187], v[188:191], v[20:35]
v_mfma_f32_32x32x16_bf16 v[36:51], a[188:191], v[188:191], v[36:51]
buffer_load_dwordx4 v[188:191], v6, s[84:87], s51 offen offset:3072 sc1
s_waitcnt vmcnt(31)
v_mfma_f32_32x32x16_bf16 v[20:35], a[192:195], v[192:195], v[20:35]
v_mfma_f32_32x32x16_bf16 v[36:51], a[196:199], v[192:195], v[36:51]
s_add_u32 s51, s56, 24576
s_and_b32 s51, s51, 0x7fff
s_and_b32 s63, s51, 0x6000
s_add_u32 s51, s51, s63
s_add_u32 s51, s51, s50
buffer_load_dwordx4 v[192:195], v6, s[84:87], s51 offen offset:0 sc1
s_waitcnt vmcnt(31)
v_mfma_f32_32x32x16_bf16 v[20:35], a[200:203], v[196:199], v[20:35]
v_mfma_f32_32x32x16_bf16 v[36:51], a[204:207], v[196:199], v[36:51]
buffer_load_dwordx4 v[196:199], v6, s[84:87], s51 offen offset:1024 sc1
s_waitcnt vmcnt(31)
v_mfma_f32_32x32x16_bf16 v[20:35], a[208:211], v[200:203], v[20:35]
v_mfma_f32_32x32x16_bf16 v[36:51], a[212:215], v[200:203], v[36:51]
buffer_load_dwordx4 v[200:203], v6, s[84:87], s51 offen offset:2048 sc1
s_waitcnt vmcnt(31)
v_mfma_f32_32x32x16_bf16 v[20:35], a[216:219], v[204:207], v[20:35]
v_mfma_f32_32x32x16_bf16 v[36:51], a[220:223], v[204:207], v[36:51]
buffer_load_dwordx4 v[204:207], v6, s[84:87], s51 offen offset:3072 sc1
s_sub_u32 s60, s62, s64
s_lshr_b32 s60, s60, s67
s_bfe_u32 s61, s60, 0x10001
s_and_b32 s60, s60, 1
s_lshl_b32 s60, s60, 12
buffer_load_dwordx4 v[88:91], v13, s[84:87], s60 offen sc1
s_waitcnt vmcnt(31)
v_mfma_f32_32x32x16_bf16 v[20:35], a[224:227], v[208:211], v[20:35]
v_mfma_f32_32x32x16_bf16 v[36:51], a[228:231], v[208:211], v[36:51]
s_add_u32 s51, s56, 28672
s_and_b32 s51, s51, 0x7fff
s_and_b32 s63, s51, 0x6000
s_add_u32 s51, s51, s63
s_add_u32 s51, s51, s50
buffer_load_dwordx4 v[208:211], v6, s[84:87], s51 offen offset:0 sc1
s_waitcnt vmcnt(31)
v_mfma_f32_32x32x16_bf16 v[20:35], a[232:235], v[212:215], v[20:35]
v_mfma_f32_32x32x16_bf16 v[36:51], a[236:239], v[212:215], v[36:51]
buffer_load_dwordx4 v[212:215], v6, s[84:87], s51 offen offset:1024 sc1
s_waitcnt vmcnt(31)
v_mfma_f32_32x32x16_bf16 v[20:35], a[240:243], v[216:219], v[20:35]
v_mfma_f32_32x32x16_bf16 v[36:51], a[244:247], v[216:219], v[36:51]
buffer_load_dwordx4 v[216:219], v6, s[84:87], s51 offen offset:2048 sc1
s_waitcnt vmcnt(31)
v_mfma_f32_32x32x16_bf16 v[224:239], a[248:251], v[220:223], v[20:35]
v_mfma_f32_32x32x16_bf16 v[240:255], a[252:255], v[220:223], v[36:51]
buffer_load_dwordx4 v[220:223], v6, s[84:87], s51 offen offset:3072 sc1
s_waitcnt vmcnt(4)
mega_kernel_o_f1c:
v_and_b32 v14, 1, v88
v_cmp_ne_u32 vcc, s61, v14
s_cbranch_vccz mega_kernel_o_f1k
s_sub_u32 s60, s62, s64
s_lshr_b32 s60, s60, s67
s_bfe_u32 s61, s60, 0x10001
s_and_b32 s60, s60, 1
s_lshl_b32 s60, s60, 12
buffer_load_dwordx4 v[88:91], v13, s[84:87], s60 offen sc1
s_waitcnt vmcnt(0)
s_branch mega_kernel_o_f1c
mega_kernel_o_f1k:
v_pk_add_f32 v[88:89], v[88:89], v[84:85]
v_pk_add_f32 v[90:91], v[90:91], v[86:87]
s_lshl_b32 s60, s62, 17
v_cvt_pk_bf16_f32 v92, v88, v89
v_cvt_pk_bf16_f32 v93, v90, v91
buffer_store_dwordx2 v[92:93], v11, s[8:11], s60 offen sc1
s_add_u32 s42, s42, s71
s_branch mega_kernel_o_w1
mega_kernel_o_n1:
s_waitcnt vmcnt(31)
v_mfma_f32_32x32x16_bf16 v[20:35], a[0:3], v[96:99], 0
v_mfma_f32_32x32x16_bf16 v[36:51], a[4:7], v[96:99], 0
s_waitcnt vmcnt(30)
v_mfma_f32_32x32x16_bf16 v[20:35], a[8:11], v[100:103], v[20:35]
v_mfma_f32_32x32x16_bf16 v[36:51], a[12:15], v[100:103], v[36:51]
v_add_u32 v2, s53, v8
v_add_u32 v3, s53, v9
v_add_u32 v4, s53, v10
s_waitcnt vmcnt(29)
v_mfma_f32_32x32x16_bf16 v[20:35], a[16:19], v[104:107], v[20:35]
v_mfma_f32_32x32x16_bf16 v[36:51], a[20:23], v[104:107], v[36:51]
ds_write_b128 v2, v[224:227] offset:0
ds_write_b128 v2, v[228:231] offset:1088
s_waitcnt vmcnt(28)
v_mfma_f32_32x32x16_bf16 v[20:35], a[24:27], v[108:111], v[20:35]
v_mfma_f32_32x32x16_bf16 v[36:51], a[28:31], v[108:111], v[36:51]
ds_write_b128 v2, v[232:235] offset:2176
ds_write_b128 v2, v[236:239] offset:3264
s_waitcnt vmcnt(27)
v_mfma_f32_32x32x16_bf16 v[20:35], a[32:35], v[112:115], v[20:35]
v_mfma_f32_32x32x16_bf16 v[36:51], a[36:39], v[112:115], v[36:51]
ds_write_b128 v2, v[240:243] offset:4352
ds_write_b128 v2, v[244:247] offset:5440
s_waitcnt vmcnt(26)
v_mfma_f32_32x32x16_bf16 v[20:35], a[40:43], v[116:119], v[20:35]
v_mfma_f32_32x32x16_bf16 v[36:51], a[44:47], v[116:119], v[36:51]
ds_write_b128 v2, v[248:251] offset:6528
ds_write_b128 v2, v[252:255] offset:7616
s_waitcnt vmcnt(25)
v_mfma_f32_32x32x16_bf16 v[20:35], a[48:51], v[120:123], v[20:35]
v_mfma_f32_32x32x16_bf16 v[36:51], a[52:55], v[120:123], v[36:51]
s_waitcnt vmcnt(24)
v_mfma_f32_32x32x16_bf16 v[20:35], a[56:59], v[124:127], v[20:35]
v_mfma_f32_32x32x16_bf16 v[36:51], a[60:63], v[124:127], v[36:51]
s_waitcnt lgkmcnt(0)
s_barrier
ds_read_b128 v[52:55], v4 offset:0
ds_read_b128 v[56:59], v4 offset:8704
ds_read_b128 v[60:63], v4 offset:17408
ds_read_b128 v[64:67], v4 offset:26112
s_waitcnt vmcnt(23)
v_mfma_f32_32x32x16_bf16 v[20:35], a[64:67], v[128:131], v[20:35]
v_mfma_f32_32x32x16_bf16 v[36:51], a[68:71], v[128:131], v[36:51]
ds_read_b128 v[68:71], v3 offset:0
ds_read_b128 v[72:75], v3 offset:8704
ds_read_b128 v[76:79], v3 offset:17408
ds_read_b128 v[80:83], v3 offset:26112
s_sub_u32 s53, 34816, s53
s_sub_u32 s60, s62, s64
s_lshr_b32 s60, s60, s67
s_bfe_u32 s61, s60, 0x10001
s_and_b32 s60, s60, 1
s_lshl_b32 s60, s60, 12
s_waitcnt vmcnt(22)
v_mfma_f32_32x32x16_bf16 v[20:35], a[72:75], v[132:135], v[20:35]
v_mfma_f32_32x32x16_bf16 v[36:51], a[76:79], v[132:135], v[36:51]
s_waitcnt vmcnt(21)
v_mfma_f32_32x32x16_bf16 v[20:35], a[80:83], v[136:139], v[20:35]
v_mfma_f32_32x32x16_bf16 v[36:51], a[84:87], v[136:139], v[36:51]
s_waitcnt lgkmcnt(4)
v_add_f32 v52, v52, v56
v_add_f32 v60, v60, v64
v_add_f32 v53, v53, v57
v_add_f32 v61, v61, v65
v_add_f32 v54, v54, v58
v_add_f32 v62, v62, v66
v_add_f32 v55, v55, v59
v_add_f32 v63, v63, v67
s_waitcnt vmcnt(20)
v_mfma_f32_32x32x16_bf16 v[20:35], a[88:91], v[140:143], v[20:35]
v_mfma_f32_32x32x16_bf16 v[36:51], a[92:95], v[140:143], v[36:51]
v_add_f32 v52, v52, v60
v_add_f32 v53, v53, v61
v_add_f32 v54, v54, v62
v_add_f32 v55, v55, v63
v_and_or_b32 v52, v52, -2, s61
s_cmp_eq_u32 s95, 0
s_cbranch_scc1 mega_kernel_o_sa2
buffer_store_dwordx4 v[52:55], v12, s[84:87], s60 offen sc1
s_branch mega_kernel_o_sb2
mega_kernel_o_sa2:
buffer_store_dwordx4 v[52:55], v12, s[84:87], s60 offen
mega_kernel_o_sb2:
s_waitcnt vmcnt(19)
v_mfma_f32_32x32x16_bf16 v[20:35], a[96:99], v[144:147], v[20:35]
v_mfma_f32_32x32x16_bf16 v[36:51], a[100:103], v[144:147], v[36:51]
s_waitcnt lgkmcnt(0)
v_add_f32 v68, v68, v72
v_add_f32 v76, v76, v80
v_add_f32 v69, v69, v73
v_add_f32 v77, v77, v81
v_add_f32 v70, v70, v74
v_add_f32 v78, v78, v82
v_add_f32 v71, v71, v75
v_add_f32 v79, v79, v83
s_waitcnt vmcnt(18)
v_mfma_f32_32x32x16_bf16 v[20:35], a[104:107], v[148:151], v[20:35]
v_mfma_f32_32x32x16_bf16 v[36:51], a[108:111], v[148:151], v[36:51]
v_add_f32 v84, v68, v76
v_add_f32 v85, v69, v77
v_add_f32 v86, v70, v78
v_add_f32 v87, v71, v79
s_waitcnt vmcnt(17)
v_mfma_f32_32x32x16_bf16 v[20:35], a[112:115], v[152:155], v[20:35]
v_mfma_f32_32x32x16_bf16 v[36:51], a[116:119], v[152:155], v[36:51]
s_waitcnt vmcnt(16)
v_mfma_f32_32x32x16_bf16 v[20:35], a[120:123], v[156:159], v[20:35]
v_mfma_f32_32x32x16_bf16 v[36:51], a[124:127], v[156:159], v[36:51]
s_waitcnt vmcnt(15)
v_mfma_f32_32x32x16_bf16 v[20:35], a[128:131], v[160:163], v[20:35]
v_mfma_f32_32x32x16_bf16 v[36:51], a[132:135], v[160:163], v[36:51]
s_waitcnt vmcnt(14)
v_mfma_f32_32x32x16_bf16 v[20:35], a[136:139], v[164:167], v[20:35]
v_mfma_f32_32x32x16_bf16 v[36:51], a[140:143], v[164:167], v[36:51]
s_waitcnt vmcnt(13)
v_mfma_f32_32x32x16_bf16 v[20:35], a[144:147], v[168:171], v[20:35]
v_mfma_f32_32x32x16_bf16 v[36:51], a[148:151], v[168:171], v[36:51]
s_waitcnt vmcnt(12)
v_mfma_f32_32x32x16_bf16 v[20:35], a[152:155], v[172:175], v[20:35]
v_mfma_f32_32x32x16_bf16 v[36:51], a[156:159], v[172:175], v[36:51]
s_waitcnt vmcnt(11)
v_mfma_f32_32x32x16_bf16 v[20:35], a[160:163], v[176:179], v[20:35]
v_mfma_f32_32x32x16_bf16 v[36:51], a[164:167], v[176:179], v[36:51]
buffer_load_dword v15, v7, s[84:87], 0 offen sc1
s_waitcnt vmcnt(10)
v_mfma_f32_32x32x16_bf16 v[20:35], a[168:171], v[180:183], v[20:35]
v_mfma_f32_32x32x16_bf16 v[36:51], a[172:175], v[180:183], v[36:51]
s_waitcnt vmcnt(9)
v_mfma_f32_32x32x16_bf16 v[20:35], a[176:179], v[184:187], v[20:35]
v_mfma_f32_32x32x16_bf16 v[36:51], a[180:183], v[184:187], v[36:51]
s_waitcnt vmcnt(8)
v_mfma_f32_32x32x16_bf16 v[20:35], a[184:187], v[188:191], v[20:35]
v_mfma_f32_32x32x16_bf16 v[36:51], a[188:191], v[188:191], v[36:51]
s_waitcnt vmcnt(7)
v_mfma_f32_32x32x16_bf16 v[20:35], a[192:195], v[192:195], v[20:35]
v_mfma_f32_32x32x16_bf16 v[36:51], a[196:199], v[192:195], v[36:51]
s_waitcnt vmcnt(6)
v_mfma_f32_32x32x16_bf16 v[20:35], a[200:203], v[196:199], v[20:35]
v_mfma_f32_32x32x16_bf16 v[36:51], a[204:207], v[196:199], v[36:51]
s_waitcnt vmcnt(5)
v_mfma_f32_32x32x16_bf16 v[20:35], a[208:211], v[200:203], v[20:35]
v_mfma_f32_32x32x16_bf16 v[36:51], a[212:215], v[200:203], v[36:51]
s_waitcnt vmcnt(4)
v_mfma_f32_32x32x16_bf16 v[20:35], a[216:219], v[204:207], v[20:35]
v_mfma_f32_32x32x16_bf16 v[36:51], a[220:223], v[204:207], v[36:51]
s_sub_u32 s60, s62, s64
s_lshr_b32 s60, s60, s67
s_bfe_u32 s61, s60, 0x10001
s_and_b32 s60, s60, 1
s_lshl_b32 s60, s60, 12
buffer_load_dwordx4 v[88:91], v13, s[84:87], s60 offen sc1
s_waitcnt vmcnt(3)
v_mfma_f32_32x32x16_bf16 v[20:35], a[224:227], v[208:211], v[20:35]
v_mfma_f32_32x32x16_bf16 v[36:51], a[228:231], v[208:211], v[36:51]
s_waitcnt vmcnt(2)
v_mfma_f32_32x32x16_bf16 v[20:35], a[232:235], v[212:215], v[20:35]
v_mfma_f32_32x32x16_bf16 v[36:51], a[236:239], v[212:215], v[36:51]
s_waitcnt vmcnt(1)
v_mfma_f32_32x32x16_bf16 v[20:35], a[240:243], v[216:219], v[20:35]
v_mfma_f32_32x32x16_bf16 v[36:51], a[244:247], v[216:219], v[36:51]
s_waitcnt vmcnt(0)
v_mfma_f32_32x32x16_bf16 v[224:239], a[248:251], v[220:223], v[20:35]
v_mfma_f32_32x32x16_bf16 v[240:255], a[252:255], v[220:223], v[36:51]
s_waitcnt vmcnt(0)
mega_kernel_o_f0c:
v_and_b32 v14, 1, v88
v_cmp_ne_u32 vcc, s61, v14
s_cbranch_vccz mega_kernel_o_f0k
s_sub_u32 s60, s62, s64
s_lshr_b32 s60, s60, s67
s_bfe_u32 s61, s60, 0x10001
s_and_b32 s60, s60, 1
s_lshl_b32 s60, s60, 12
buffer_load_dwordx4 v[88:91], v13, s[84:87], s60 offen sc1
s_waitcnt vmcnt(0)
s_branch mega_kernel_o_f0c
mega_kernel_o_f0k:
v_pk_add_f32 v[88:89], v[88:89], v[84:85]
v_pk_add_f32 v[90:91], v[90:91], v[86:87]
s_lshl_b32 s60, s62, 17
v_cvt_pk_bf16_f32 v92, v88, v89
v_cvt_pk_bf16_f32 v93, v90, v91
buffer_store_dwordx2 v[92:93], v11, s[8:11], s60 offen sc1
mega_kernel_o_imm:
s_waitcnt vmcnt(1)
v_min_i32_dpp v15, v15, v15 quad_perm:[1,0,3,2] row_mask:0xf bank_mask:0xf
s_nop 1
v_min_i32_dpp v15, v15, v15 quad_perm:[2,3,0,1] row_mask:0xf bank_mask:0xf
s_nop 1
v_min_i32_dpp v15, v15, v15 row_ror:4 row_mask:0xf bank_mask:0xf
s_nop 1
v_min_i32_dpp v15, v15, v15 row_ror:8 row_mask:0xf bank_mask:0xf
s_nop 0
v_readfirstlane_b32 s52, v15
s_min_i32 s52, s52, s65
s_cmp_gt_i32 s52, s54
s_cbranch_scc0 mega_kernel_o_im2
s_add_u32 s42, s42, s71
s_add_u32 s54, s54, s71
s_cmp_gt_i32 s52, s54
s_cbranch_scc0 mega_kernel_o_c1
s_add_u32 s51, s56, 0
s_and_b32 s51, s51, 0x7fff
s_and_b32 s63, s51, 0x6000
s_add_u32 s51, s51, s63
s_add_u32 s51, s51, s50
buffer_load_dwordx4 v[96:99], v6, s[84:87], s51 offen offset:0 sc1
buffer_load_dwordx4 v[100:103], v6, s[84:87], s51 offen offset:1024 sc1
buffer_load_dwordx4 v[104:107], v6, s[84:87], s51 offen offset:2048 sc1
buffer_load_dwordx4 v[108:111], v6, s[84:87], s51 offen offset:3072 sc1
s_add_u32 s51, s56, 4096
s_and_b32 s51, s51, 0x7fff
s_and_b32 s63, s51, 0x6000
s_add_u32 s51, s51, s63
s_add_u32 s51, s51, s50
buffer_load_dwordx4 v[112:115], v6, s[84:87], s51 offen offset:0 sc1
buffer_load_dwordx4 v[116:119], v6, s[84:87], s51 offen offset:1024 sc1
buffer_load_dwordx4 v[120:123], v6, s[84:87], s51 offen offset:2048 sc1
buffer_load_dwordx4 v[124:127], v6, s[84:87], s51 offen offset:3072 sc1
s_add_u32 s51, s56, 8192
s_and_b32 s51, s51, 0x7fff
s_and_b32 s63, s51, 0x6000
s_add_u32 s51, s51, s63
s_add_u32 s51, s51, s50
buffer_load_dwordx4 v[128:131], v6, s[84:87], s51 offen offset:0 sc1
buffer_load_dwordx4 v[132:135], v6, s[84:87], s51 offen offset:1024 sc1
buffer_load_dwordx4 v[136:139], v6, s[84:87], s51 offen offset:2048 sc1
buffer_load_dwordx4 v[140:143], v6, s[84:87], s51 offen offset:3072 sc1
s_add_u32 s51, s56, 12288
s_and_b32 s51, s51, 0x7fff
s_and_b32 s63, s51, 0x6000
s_add_u32 s51, s51, s63
s_add_u32 s51, s51, s50
buffer_load_dwordx4 v[144:147], v6, s[84:87], s51 offen offset:0 sc1
buffer_load_dwordx4 v[148:151], v6, s[84:87], s51 offen offset:1024 sc1
buffer_load_dwordx4 v[152:155], v6, s[84:87], s51 offen offset:2048 sc1
buffer_load_dwordx4 v[156:159], v6, s[84:87], s51 offen offset:3072 sc1
s_add_u32 s51, s56, 16384
s_and_b32 s51, s51, 0x7fff
s_and_b32 s63, s51, 0x6000
s_add_u32 s51, s51, s63
s_add_u32 s51, s51, s50
buffer_load_dwordx4 v[160:163], v6, s[84:87], s51 offen offset:0 sc1
buffer_load_dwordx4 v[164:167], v6, s[84:87], s51 offen offset:1024 sc1
buffer_load_dwordx4 v[168:171], v6, s[84:87], s51 offen offset:2048 sc1
buffer_load_dwordx4 v[172:175], v6, s[84:87], s51 offen offset:3072 sc1
s_add_u32 s51, s56, 20480
s_and_b32 s51, s51, 0x7fff
s_and_b32 s63, s51, 0x6000
s_add_u32 s51, s51, s63
s_add_u32 s51, s51, s50
buffer_load_dwordx4 v[176:179], v6, s[84:87], s51 offen offset:0 sc1
buffer_load_dwordx4 v[180:183], v6, s[84:87], s51 offen offset:1024 sc1
buffer_load_dwordx4 v[184:187], v6, s[84:87], s51 offen offset:2048 sc1
buffer_load_dwordx4 v[188:191], v6, s[84:87], s51 offen offset:3072 sc1
s_add_u32 s51, s56, 24576
s_and_b32 s51, s51, 0x7fff
s_and_b32 s63, s51, 0x6000
s_add_u32 s51, s51, s63
s_add_u32 s51, s51, s50
buffer_load_dwordx4 v[192:195], v6, s[84:87], s51 offen offset:0 sc1
buffer_load_dwordx4 v[196:199], v6, s[84:87], s51 offen offset:1024 sc1
buffer_load_dwordx4 v[200:203], v6, s[84:87], s51 offen offset:2048 sc1
buffer_load_dwordx4 v[204:207], v6, s[84:87], s51 offen offset:3072 sc1
s_add_u32 s51, s56, 28672
s_and_b32 s51, s51, 0x7fff
s_and_b32 s63, s51, 0x6000
s_add_u32 s51, s51, s63
s_add_u32 s51, s51, s50
buffer_load_dwordx4 v[208:211], v6, s[84:87], s51 offen offset:0 sc1
buffer_load_dwordx4 v[212:215], v6, s[84:87], s51 offen offset:1024 sc1
buffer_load_dwordx4 v[216:219], v6, s[84:87], s51 offen offset:2048 sc1
buffer_load_dwordx4 v[220:223], v6, s[84:87], s51 offen offset:3072 sc1
s_branch mega_kernel_o_w1
mega_kernel_o_c0:
s_add_u32 s54, s42, s71
s_sub_u32 s62, s42, s71
s_lshr_b32 s63, s42, 2
s_xnor_b32 s63, s63, s98
s_and_b32 s63, s63, 1
s_lshl_b32 s63, s63, 13
s_lshl_b32 s50, s42, 19
s_add_u32 s50, s50, s63
s_add_u32 s51, s56, 0
s_and_b32 s51, s51, 0x7fff
s_and_b32 s63, s51, 0x6000
s_add_u32 s51, s51, s63
s_add_u32 s51, s51, s50
buffer_load_dwordx4 v[96:99], v6, s[84:87], s51 offen offset:0 sc1
buffer_load_dwordx4 v[100:103], v6, s[84:87], s51 offen offset:1024 sc1
buffer_load_dwordx4 v[104:107], v6, s[84:87], s51 offen offset:2048 sc1
buffer_load_dwordx4 v[108:111], v6, s[84:87], s51 offen offset:3072 sc1
s_add_u32 s51, s56, 4096
s_and_b32 s51, s51, 0x7fff
s_and_b32 s63, s51, 0x6000
s_add_u32 s51, s51, s63
s_add_u32 s51, s51, s50
buffer_load_dwordx4 v[112:115], v6, s[84:87], s51 offen offset:0 sc1
buffer_load_dwordx4 v[116:119], v6, s[84:87], s51 offen offset:1024 sc1
buffer_load_dwordx4 v[120:123], v6, s[84:87], s51 offen offset:2048 sc1
buffer_load_dwordx4 v[124:127], v6, s[84:87], s51 offen offset:3072 sc1
s_waitcnt vmcnt(7)
v_mfma_f32_32x32x16_bf16 v[20:35], a[0:3], v[96:99], 0
v_mfma_f32_32x32x16_bf16 v[36:51], a[4:7], v[96:99], 0
s_add_u32 s51, s56, 8192
s_and_b32 s51, s51, 0x7fff
s_and_b32 s63, s51, 0x6000
s_add_u32 s51, s51, s63
s_add_u32 s51, s51, s50
buffer_load_dwordx4 v[128:131], v6, s[84:87], s51 offen offset:0 sc1
s_waitcnt vmcnt(7)
v_mfma_f32_32x32x16_bf16 v[20:35], a[8:11], v[100:103], v[20:35]
v_mfma_f32_32x32x16_bf16 v[36:51], a[12:15], v[100:103], v[36:51]
buffer_load_dwordx4 v[132:135], v6, s[84:87], s51 offen offset:1024 sc1
s_waitcnt vmcnt(7)
v_mfma_f32_32x32x16_bf16 v[20:35], a[16:19], v[104:107], v[20:35]
v_mfma_f32_32x32x16_bf16 v[36:51], a[20:23], v[104:107], v[36:51]
buffer_load_dwordx4 v[136:139], v6, s[84:87], s51 offen offset:2048 sc1
s_waitcnt vmcnt(7)
v_mfma_f32_32x32x16_bf16 v[20:35], a[24:27], v[108:111], v[20:35]
v_mfma_f32_32x32x16_bf16 v[36:51], a[28:31], v[108:111], v[36:51]
buffer_load_dwordx4 v[140:143], v6, s[84:87], s51 offen offset:3072 sc1
s_waitcnt vmcnt(7)
v_mfma_f32_32x32x16_bf16 v[20:35], a[32:35], v[112:115], v[20:35]
v_mfma_f32_32x32x16_bf16 v[36:51], a[36:39], v[112:115], v[36:51]
s_add_u32 s51, s56, 12288
s_and_b32 s51, s51, 0x7fff
s_and_b32 s63, s51, 0x6000
s_add_u32 s51, s51, s63
s_add_u32 s51, s51, s50
buffer_load_dwordx4 v[144:147], v6, s[84:87], s51 offen offset:0 sc1
s_waitcnt vmcnt(7)
v_mfma_f32_32x32x16_bf16 v[20:35], a[40:43], v[116:119], v[20:35]
v_mfma_f32_32x32x16_bf16 v[36:51], a[44:47], v[116:119], v[36:51]
buffer_load_dwordx4 v[148:151], v6, s[84:87], s51 offen offset:1024 sc1
s_waitcnt vmcnt(7)
v_mfma_f32_32x32x16_bf16 v[20:35], a[48:51], v[120:123], v[20:35]
v_mfma_f32_32x32x16_bf16 v[36:51], a[52:55], v[120:123], v[36:51]
buffer_load_dwordx4 v[152:155], v6, s[84:87], s51 offen offset:2048 sc1
s_waitcnt vmcnt(7)
v_mfma_f32_32x32x16_bf16 v[20:35], a[56:59], v[124:127], v[20:35]
v_mfma_f32_32x32x16_bf16 v[36:51], a[60:63], v[124:127], v[36:51]
buffer_load_dwordx4 v[156:159], v6, s[84:87], s51 offen offset:3072 sc1
s_waitcnt vmcnt(7)
v_mfma_f32_32x32x16_bf16 v[20:35], a[64:67], v[128:131], v[20:35]
v_mfma_f32_32x32x16_bf16 v[36:51], a[68:71], v[128:131], v[36:51]
s_add_u32 s51, s56, 16384
s_and_b32 s51, s51, 0x7fff
s_and_b32 s63, s51, 0x6000
s_add_u32 s51, s51, s63
s_add_u32 s51, s51, s50
buffer_load_dwordx4 v[160:163], v6, s[84:87], s51 offen offset:0 sc1
s_waitcnt vmcnt(7)
v_mfma_f32_32x32x16_bf16 v[20:35], a[72:75], v[132:135], v[20:35]
v_mfma_f32_32x32x16_bf16 v[36:51], a[76:79], v[132:135], v[36:51]
buffer_load_dwordx4 v[164:167], v6, s[84:87], s51 offen offset:1024 sc1
s_waitcnt vmcnt(7)
v_mfma_f32_32x32x16_bf16 v[20:35], a[80:83], v[136:139], v[20:35]
v_mfma_f32_32x32x16_bf16 v[36:51], a[84:87], v[136:139], v[36:51]
buffer_load_dwordx4 v[168:171], v6, s[84:87], s51 offen offset:2048 sc1
s_waitcnt vmcnt(7)
v_mfma_f32_32x32x16_bf16 v[20:35], a[88:91], v[140:143], v[20:35]
v_mfma_f32_32x32x16_bf16 v[36:51], a[92:95], v[140:143], v[36:51]
buffer_load_dwordx4 v[172:175], v6, s[84:87], s51 offen offset:3072 sc1
s_waitcnt vmcnt(7)
v_mfma_f32_32x32x16_bf16 v[20:35], a[96:99], v[144:147], v[20:35]
v_mfma_f32_32x32x16_bf16 v[36:51], a[100:103], v[144:147], v[36:51]
s_add_u32 s51, s56, 20480
s_and_b32 s51, s51, 0x7fff
s_and_b32 s63, s51, 0x6000
s_add_u32 s51, s51, s63
s_add_u32 s51, s51, s50
buffer_load_dwordx4 v[176:179], v6, s[84:87], s51 offen offset:0 sc1
s_waitcnt vmcnt(7)
v_mfma_f32_32x32x16_bf16 v[20:35], a[104:107], v[148:151], v[20:35]
v_mfma_f32_32x32x16_bf16 v[36:51], a[108:111], v[148:151], v[36:51]
buffer_load_dwordx4 v[180:183], v6, s[84:87], s51 offen offset:1024 sc1
s_waitcnt vmcnt(7)
v_mfma_f32_32x32x16_bf16 v[20:35], a[112:115], v[152:155], v[20:35]
v_mfma_f32_32x32x16_bf16 v[36:51], a[116:119], v[152:155], v[36:51]
buffer_load_dwordx4 v[184:187], v6, s[84:87], s51 offen offset:2048 sc1
s_waitcnt vmcnt(7)
v_mfma_f32_32x32x16_bf16 v[20:35], a[120:123], v[156:159], v[20:35]
v_mfma_f32_32x32x16_bf16 v[36:51], a[124:127], v[156:159], v[36:51]
buffer_load_dwordx4 v[188:191], v6, s[84:87], s51 offen offset:3072 sc1
s_waitcnt vmcnt(7)
v_mfma_f32_32x32x16_bf16 v[20:35], a[128:131], v[160:163], v[20:35]
v_mfma_f32_32x32x16_bf16 v[36:51], a[132:135], v[160:163], v[36:51]
s_add_u32 s51, s56, 24576
s_and_b32 s51, s51, 0x7fff
s_and_b32 s63, s51, 0x6000
s_add_u32 s51, s51, s63
s_add_u32 s51, s51, s50
buffer_load_dwordx4 v[192:195], v6, s[84:87], s51 offen offset:0 sc1
s_waitcnt vmcnt(7)
v_mfma_f32_32x32x16_bf16 v[20:35], a[136:139], v[164:167], v[20:35]
v_mfma_f32_32x32x16_bf16 v[36:51], a[140:143], v[164:167], v[36:51]
buffer_load_dwordx4 v[196:199], v6, s[84:87], s51 offen offset:1024 sc1
s_waitcnt vmcnt(7)
v_mfma_f32_32x32x16_bf16 v[20:35], a[144:147], v[168:171], v[20:35]
v_mfma_f32_32x32x16_bf16 v[36:51], a[148:151], v[168:171], v[36:51]
buffer_load_dwordx4 v[200:203], v6, s[84:87], s51 offen offset:2048 sc1
s_waitcnt vmcnt(7)
v_mfma_f32_32x32x16_bf16 v[20:35], a[152:155], v[172:175], v[20:35]
v_mfma_f32_32x32x16_bf16 v[36:51], a[156:159], v[172:175], v[36:51]
buffer_load_dwordx4 v[204:207], v6, s[84:87], s51 offen offset:3072 sc1
s_waitcnt vmcnt(7)
v_mfma_f32_32x32x16_bf16 v[20:35], a[160:163], v[176:179], v[20:35]
v_mfma_f32_32x32x16_bf16 v[36:51], a[164:167], v[176:179], v[36:51]
s_add_u32 s51, s56, 28672
s_and_b32 s51, s51, 0x7fff
s_and_b32 s63, s51, 0x6000
s_add_u32 s51, s51, s63
s_add_u32 s51, s51, s50
buffer_load_dwordx4 v[208:211], v6, s[84:87], s51 offen offset:0 sc1
s_waitcnt vmcnt(7)
v_mfma_f32_32x32x16_bf16 v[20:35], a[168:171], v[180:183], v[20:35]
v_mfma_f32_32x32x16_bf16 v[36:51], a[172:175], v[180:183], v[36:51]
buffer_load_dwordx4 v[212:215], v6, s[84:87], s51 offen offset:1024 sc1
s_waitcnt vmcnt(7)
v_mfma_f32_32x32x16_bf16 v[20:35], a[176:179], v[184:187], v[20:35]
v_mfma_f32_32x32x16_bf16 v[36:51], a[180:183], v[184:187], v[36:51]
buffer_load_dwordx4 v[216:219], v6, s[84:87], s51 offen offset:2048 sc1
s_waitcnt vmcnt(7)
v_mfma_f32_32x32x16_bf16 v[20:35], a[184:187], v[188:191], v[20:35]
v_mfma_f32_32x32x16_bf16 v[36:51], a[188:191], v[188:191], v[36:51]
buffer_load_dwordx4 v[220:223], v6, s[84:87], s51 offen offset:3072 sc1
s_waitcnt vmcnt(7)
v_mfma_f32_32x32x16_bf16 v[20:35], a[192:195], v[192:195], v[20:35]
v_mfma_f32_32x32x16_bf16 v[36:51], a[196:199], v[192:195], v[36:51]
buffer_load_dword v15, v7, s[84:87], 0 offen sc1
s_waitcnt vmcnt(6)
v_mfma_f32_32x32x16_bf16 v[20:35], a[200:203], v[196:199], v[20:35]
v_mfma_f32_32x32x16_bf16 v[36:51], a[204:207], v[196:199], v[36:51]
s_waitcnt vmcnt(5)
v_mfma_f32_32x32x16_bf16 v[20:35], a[208:211], v[200:203], v[20:35]
v_mfma_f32_32x32x16_bf16 v[36:51], a[212:215], v[200:203], v[36:51]
s_waitcnt vmcnt(4)
v_mfma_f32_32x32x16_bf16 v[20:35], a[216:219], v[204:207], v[20:35]
v_mfma_f32_32x32x16_bf16 v[36:51], a[220:223], v[204:207], v[36:51]
s_waitcnt vmcnt(3)
v_mfma_f32_32x32x16_bf16 v[20:35], a[224:227], v[208:211], v[20:35]
v_mfma_f32_32x32x16_bf16 v[36:51], a[228:231], v[208:211], v[36:51]
s_waitcnt vmcnt(2)
v_mfma_f32_32x32x16_bf16 v[20:35], a[232:235], v[212:215], v[20:35]
v_mfma_f32_32x32x16_bf16 v[36:51], a[236:239], v[212:215], v[36:51]
s_waitcnt vmcnt(1)
v_mfma_f32_32x32x16_bf16 v[20:35], a[240:243], v[216:219], v[20:35]
v_mfma_f32_32x32x16_bf16 v[36:51], a[244:247], v[216:219], v[36:51]
s_waitcnt vmcnt(0)
v_mfma_f32_32x32x16_bf16 v[224:239], a[248:251], v[220:223], v[20:35]
v_mfma_f32_32x32x16_bf16 v[240:255], a[252:255], v[220:223], v[36:51]
s_lshr_b32 s63, s54, 2
s_xnor_b32 s63, s63, s98
s_and_b32 s63, s63, 1
s_lshl_b32 s63, s63, 13
s_lshl_b32 s50, s54, 19
s_add_u32 s50, s50, s63
s_branch mega_kernel_o_imm
mega_kernel_o_c1:
s_add_u32 s54, s42, s71
s_sub_u32 s62, s42, s71
s_lshr_b32 s63, s42, 2
s_xnor_b32 s63, s63, s98
s_and_b32 s63, s63, 1
s_lshl_b32 s63, s63, 13
s_lshl_b32 s50, s42, 19
s_add_u32 s50, s50, s63
s_add_u32 s51, s56, 0
s_and_b32 s51, s51, 0x7fff
s_and_b32 s63, s51, 0x6000
s_add_u32 s51, s51, s63
s_add_u32 s51, s51, s50
buffer_load_dwordx4 v[96:99], v6, s[84:87], s51 offen offset:0 sc1
buffer_load_dwordx4 v[100:103], v6, s[84:87], s51 offen offset:1024 sc1
buffer_load_dwordx4 v[104:107], v6, s[84:87], s51 offen offset:2048 sc1
buffer_load_dwordx4 v[108:111], v6, s[84:87], s51 offen offset:3072 sc1
s_add_u32 s51, s56, 4096
s_and_b32 s51, s51, 0x7fff
s_and_b32 s63, s51, 0x6000
s_add_u32 s51, s51, s63
s_add_u32 s51, s51, s50
buffer_load_dwordx4 v[112:115], v6, s[84:87], s51 offen offset:0 sc1
buffer_load_dwordx4 v[116:119], v6, s[84:87], s51 offen offset:1024 sc1
buffer_load_dwordx4 v[120:123], v6, s[84:87], s51 offen offset:2048 sc1
buffer_load_dwordx4 v[124:127], v6, s[84:87], s51 offen offset:3072 sc1
v_add_u32 v2, s53, v8
v_add_u32 v3, s53, v9
v_add_u32 v4, s53, v10
ds_write_b128 v2, v[224:227] offset:0
ds_write_b128 v2, v[228:231] offset:1088
ds_write_b128 v2, v[232:235] offset:2176
ds_write_b128 v2, v[236:239] offset:3264
ds_write_b128 v2, v[240:243] offset:4352
ds_write_b128 v2, v[244:247] offset:5440
ds_write_b128 v2, v[248:251] offset:6528
ds_write_b128 v2, v[252:255] offset:7616
s_waitcnt lgkmcnt(0)
s_barrier
ds_read_b128 v[52:55], v4 offset:0
ds_read_b128 v[56:59], v4 offset:8704
ds_read_b128 v[60:63], v4 offset:17408
ds_read_b128 v[64:67], v4 offset:26112
ds_read_b128 v[68:71], v3 offset:0
ds_read_b128 v[72:75], v3 offset:8704
ds_read_b128 v[76:79], v3 offset:17408
ds_read_b128 v[80:83], v3 offset:26112
s_sub_u32 s53, 34816, s53
s_sub_u32 s60, s62, s64
s_lshr_b32 s60, s60, s67
s_bfe_u32 s61, s60, 0x10001
s_and_b32 s60, s60, 1
s_lshl_b32 s60, s60, 12
s_waitcnt lgkmcnt(4)
v_add_f32 v52, v52, v56
v_add_f32 v60, v60, v64
v_add_f32 v53, v53, v57
v_add_f32 v61, v61, v65
v_add_f32 v54, v54, v58
v_add_f32 v62, v62, v66
v_add_f32 v55, v55, v59
v_add_f32 v63, v63, v67
v_add_f32 v52, v52, v60
v_add_f32 v53, v53, v61
v_add_f32 v54, v54, v62
v_add_f32 v55, v55, v63
v_and_or_b32 v52, v52, -2, s61
s_cmp_eq_u32 s95, 0
s_cbranch_scc1 mega_kernel_o_sa3
buffer_store_dwordx4 v[52:55], v12, s[84:87], s60 offen sc1
s_branch mega_kernel_o_sb3
mega_kernel_o_sa3:
buffer_store_dwordx4 v[52:55], v12, s[84:87], s60 offen
mega_kernel_o_sb3:
s_waitcnt lgkmcnt(0)
v_add_f32 v68, v68, v72
v_add_f32 v76, v76, v80
v_add_f32 v69, v69, v73
v_add_f32 v77, v77, v81
v_add_f32 v70, v70, v74
v_add_f32 v78, v78, v82
v_add_f32 v71, v71, v75
v_add_f32 v79, v79, v83
v_add_f32 v84, v68, v76
v_add_f32 v85, v69, v77
v_add_f32 v86, v70, v78
v_add_f32 v87, v71, v79
s_waitcnt vmcnt(7)
v_mfma_f32_32x32x16_bf16 v[20:35], a[0:3], v[96:99], 0
v_mfma_f32_32x32x16_bf16 v[36:51], a[4:7], v[96:99], 0
s_add_u32 s51, s56, 8192
s_and_b32 s51, s51, 0x7fff
s_and_b32 s63, s51, 0x6000
s_add_u32 s51, s51, s63
s_add_u32 s51, s51, s50
buffer_load_dwordx4 v[128:131], v6, s[84:87], s51 offen offset:0 sc1
s_waitcnt vmcnt(7)
v_mfma_f32_32x32x16_bf16 v[20:35], a[8:11], v[100:103], v[20:35]
v_mfma_f32_32x32x16_bf16 v[36:51], a[12:15], v[100:103], v[36:51]
buffer_load_dwordx4 v[132:135], v6, s[84:87], s51 offen offset:1024 sc1
s_waitcnt vmcnt(7)
v_mfma_f32_32x32x16_bf16 v[20:35], a[16:19], v[104:107], v[20:35]
v_mfma_f32_32x32x16_bf16 v[36:51], a[20:23], v[104:107], v[36:51]
buffer_load_dwordx4 v[136:139], v6, s[84:87], s51 offen offset:2048 sc1
s_waitcnt vmcnt(7)
v_mfma_f32_32x32x16_bf16 v[20:35], a[24:27], v[108:111], v[20:35]
v_mfma_f32_32x32x16_bf16 v[36:51], a[28:31], v[108:111], v[36:51]
buffer_load_dwordx4 v[140:143], v6, s[84:87], s51 offen offset:3072 sc1
s_waitcnt vmcnt(7)
v_mfma_f32_32x32x16_bf16 v[20:35], a[32:35], v[112:115], v[20:35]
v_mfma_f32_32x32x16_bf16 v[36:51], a[36:39], v[112:115], v[36:51]
s_add_u32 s51, s56, 12288
s_and_b32 s51, s51, 0x7fff
s_and_b32 s63, s51, 0x6000
s_add_u32 s51, s51, s63
s_add_u32 s51, s51, s50
buffer_load_dwordx4 v[144:147], v6, s[84:87], s51 offen offset:0 sc1
s_waitcnt vmcnt(7)
v_mfma_f32_32x32x16_bf16 v[20:35], a[40:43], v[116:119], v[20:35]
v_mfma_f32_32x32x16_bf16 v[36:51], a[44:47], v[116:119], v[36:51]
buffer_load_dwordx4 v[148:151], v6, s[84:87], s51 offen offset:1024 sc1
s_waitcnt vmcnt(7)
v_mfma_f32_32x32x16_bf16 v[20:35], a[48:51], v[120:123], v[20:35]
v_mfma_f32_32x32x16_bf16 v[36:51], a[52:55], v[120:123], v[36:51]
buffer_load_dwordx4 v[152:155], v6, s[84:87], s51 offen offset:2048 sc1
s_waitcnt vmcnt(7)
v_mfma_f32_32x32x16_bf16 v[20:35], a[56:59], v[124:127], v[20:35]
v_mfma_f32_32x32x16_bf16 v[36:51], a[60:63], v[124:127], v[36:51]
buffer_load_dwordx4 v[156:159], v6, s[84:87], s51 offen offset:3072 sc1
s_waitcnt vmcnt(7)
v_mfma_f32_32x32x16_bf16 v[20:35], a[64:67], v[128:131], v[20:35]
v_mfma_f32_32x32x16_bf16 v[36:51], a[68:71], v[128:131], v[36:51]
s_add_u32 s51, s56, 16384
s_and_b32 s51, s51, 0x7fff
s_and_b32 s63, s51, 0x6000
s_add_u32 s51, s51, s63
s_add_u32 s51, s51, s50
buffer_load_dwordx4 v[160:163], v6, s[84:87], s51 offen offset:0 sc1
s_waitcnt vmcnt(7)
v_mfma_f32_32x32x16_bf16 v[20:35], a[72:75], v[132:135], v[20:35]
v_mfma_f32_32x32x16_bf16 v[36:51], a[76:79], v[132:135], v[36:51]
buffer_load_dwordx4 v[164:167], v6, s[84:87], s51 offen offset:1024 sc1
s_waitcnt vmcnt(7)
v_mfma_f32_32x32x16_bf16 v[20:35], a[80:83], v[136:139], v[20:35]
v_mfma_f32_32x32x16_bf16 v[36:51], a[84:87], v[136:139], v[36:51]
buffer_load_dwordx4 v[168:171], v6, s[84:87], s51 offen offset:2048 sc1
s_waitcnt vmcnt(7)
v_mfma_f32_32x32x16_bf16 v[20:35], a[88:91], v[140:143], v[20:35]
v_mfma_f32_32x32x16_bf16 v[36:51], a[92:95], v[140:143], v[36:51]
buffer_load_dwordx4 v[172:175], v6, s[84:87], s51 offen offset:3072 sc1
s_waitcnt vmcnt(7)
v_mfma_f32_32x32x16_bf16 v[20:35], a[96:99], v[144:147], v[20:35]
v_mfma_f32_32x32x16_bf16 v[36:51], a[100:103], v[144:147], v[36:51]
s_add_u32 s51, s56, 20480
s_and_b32 s51, s51, 0x7fff
s_and_b32 s63, s51, 0x6000
s_add_u32 s51, s51, s63
s_add_u32 s51, s51, s50
buffer_load_dwordx4 v[176:179], v6, s[84:87], s51 offen offset:0 sc1
s_waitcnt vmcnt(7)
v_mfma_f32_32x32x16_bf16 v[20:35], a[104:107], v[148:151], v[20:35]
v_mfma_f32_32x32x16_bf16 v[36:51], a[108:111], v[148:151], v[36:51]
buffer_load_dwordx4 v[180:183], v6, s[84:87], s51 offen offset:1024 sc1
s_waitcnt vmcnt(7)
v_mfma_f32_32x32x16_bf16 v[20:35], a[112:115], v[152:155], v[20:35]
v_mfma_f32_32x32x16_bf16 v[36:51], a[116:119], v[152:155], v[36:51]
buffer_load_dwordx4 v[184:187], v6, s[84:87], s51 offen offset:2048 sc1
s_waitcnt vmcnt(7)
v_mfma_f32_32x32x16_bf16 v[20:35], a[120:123], v[156:159], v[20:35]
v_mfma_f32_32x32x16_bf16 v[36:51], a[124:127], v[156:159], v[36:51]
buffer_load_dwordx4 v[188:191], v6, s[84:87], s51 offen offset:3072 sc1
s_waitcnt vmcnt(7)
v_mfma_f32_32x32x16_bf16 v[20:35], a[128:131], v[160:163], v[20:35]
v_mfma_f32_32x32x16_bf16 v[36:51], a[132:135], v[160:163], v[36:51]
s_add_u32 s51, s56, 24576
s_and_b32 s51, s51, 0x7fff
s_and_b32 s63, s51, 0x6000
s_add_u32 s51, s51, s63
s_add_u32 s51, s51, s50
buffer_load_dwordx4 v[192:195], v6, s[84:87], s51 offen offset:0 sc1
s_waitcnt vmcnt(7)
v_mfma_f32_32x32x16_bf16 v[20:35], a[136:139], v[164:167], v[20:35]
v_mfma_f32_32x32x16_bf16 v[36:51], a[140:143], v[164:167], v[36:51]
buffer_load_dwordx4 v[196:199], v6, s[84:87], s51 offen offset:1024 sc1
s_waitcnt vmcnt(7)
v_mfma_f32_32x32x16_bf16 v[20:35], a[144:147], v[168:171], v[20:35]
v_mfma_f32_32x32x16_bf16 v[36:51], a[148:151], v[168:171], v[36:51]
buffer_load_dwordx4 v[200:203], v6, s[84:87], s51 offen offset:2048 sc1
s_waitcnt vmcnt(7)
v_mfma_f32_32x32x16_bf16 v[20:35], a[152:155], v[172:175], v[20:35]
v_mfma_f32_32x32x16_bf16 v[36:51], a[156:159], v[172:175], v[36:51]
buffer_load_dwordx4 v[204:207], v6, s[84:87], s51 offen offset:3072 sc1
s_waitcnt vmcnt(7)
v_mfma_f32_32x32x16_bf16 v[20:35], a[160:163], v[176:179], v[20:35]
v_mfma_f32_32x32x16_bf16 v[36:51], a[164:167], v[176:179], v[36:51]
s_add_u32 s51, s56, 28672
s_and_b32 s51, s51, 0x7fff
s_and_b32 s63, s51, 0x6000
s_add_u32 s51, s51, s63
s_add_u32 s51, s51, s50
buffer_load_dwordx4 v[208:211], v6, s[84:87], s51 offen offset:0 sc1
s_waitcnt vmcnt(7)
v_mfma_f32_32x32x16_bf16 v[20:35], a[168:171], v[180:183], v[20:35]
v_mfma_f32_32x32x16_bf16 v[36:51], a[172:175], v[180:183], v[36:51]
buffer_load_dwordx4 v[212:215], v6, s[84:87], s51 offen offset:1024 sc1
s_waitcnt vmcnt(7)
v_mfma_f32_32x32x16_bf16 v[20:35], a[176:179], v[184:187], v[20:35]
v_mfma_f32_32x32x16_bf16 v[36:51], a[180:183], v[184:187], v[36:51]
buffer_load_dwordx4 v[216:219], v6, s[84:87], s51 offen offset:2048 sc1
s_waitcnt vmcnt(7)
v_mfma_f32_32x32x16_bf16 v[20:35], a[184:187], v[188:191], v[20:35]
v_mfma_f32_32x32x16_bf16 v[36:51], a[188:191], v[188:191], v[36:51]
buffer_load_dwordx4 v[220:223], v6, s[84:87], s51 offen offset:3072 sc1
s_waitcnt vmcnt(7)
v_mfma_f32_32x32x16_bf16 v[20:35], a[192:195], v[192:195], v[20:35]
v_mfma_f32_32x32x16_bf16 v[36:51], a[196:199], v[192:195], v[36:51]
s_sub_u32 s60, s62, s64
s_lshr_b32 s60, s60, s67
s_bfe_u32 s61, s60, 0x10001
s_and_b32 s60, s60, 1
s_lshl_b32 s60, s60, 12
buffer_load_dwordx4 v[88:91], v13, s[84:87], s60 offen sc1
buffer_load_dword v15, v7, s[84:87], 0 offen sc1
s_waitcnt vmcnt(6)
v_mfma_f32_32x32x16_bf16 v[20:35], a[200:203], v[196:199], v[20:35]
v_mfma_f32_32x32x16_bf16 v[36:51], a[204:207], v[196:199], v[36:51]
s_waitcnt vmcnt(5)
v_mfma_f32_32x32x16_bf16 v[20:35], a[208:211], v[200:203], v[20:35]
v_mfma_f32_32x32x16_bf16 v[36:51], a[212:215], v[200:203], v[36:51]
s_waitcnt vmcnt(4)
v_mfma_f32_32x32x16_bf16 v[20:35], a[216:219], v[204:207], v[20:35]
v_mfma_f32_32x32x16_bf16 v[36:51], a[220:223], v[204:207], v[36:51]
s_waitcnt vmcnt(3)
v_mfma_f32_32x32x16_bf16 v[20:35], a[224:227], v[208:211], v[20:35]
v_mfma_f32_32x32x16_bf16 v[36:51], a[228:231], v[208:211], v[36:51]
s_waitcnt vmcnt(2)
v_mfma_f32_32x32x16_bf16 v[20:35], a[232:235], v[212:215], v[20:35]
v_mfma_f32_32x32x16_bf16 v[36:51], a[236:239], v[212:215], v[36:51]
s_waitcnt vmcnt(1)
v_mfma_f32_32x32x16_bf16 v[20:35], a[240:243], v[216:219], v[20:35]
v_mfma_f32_32x32x16_bf16 v[36:51], a[244:247], v[216:219], v[36:51]
s_waitcnt vmcnt(0)
v_mfma_f32_32x32x16_bf16 v[224:239], a[248:251], v[220:223], v[20:35]
v_mfma_f32_32x32x16_bf16 v[240:255], a[252:255], v[220:223], v[36:51]
s_waitcnt vmcnt(0)
mega_kernel_o_fcc:
v_and_b32 v14, 1, v88
v_cmp_ne_u32 vcc, s61, v14
s_cbranch_vccz mega_kernel_o_fck
s_sub_u32 s60, s62, s64
s_lshr_b32 s60, s60, s67
s_bfe_u32 s61, s60, 0x10001
s_and_b32 s60, s60, 1
s_lshl_b32 s60, s60, 12
buffer_load_dwordx4 v[88:91], v13, s[84:87], s60 offen sc1
s_waitcnt vmcnt(0)
s_branch mega_kernel_o_fcc
mega_kernel_o_fck:
v_pk_add_f32 v[88:89], v[88:89], v[84:85]
v_pk_add_f32 v[90:91], v[90:91], v[86:87]
s_lshl_b32 s60, s62, 17
v_cvt_pk_bf16_f32 v92, v88, v89
v_cvt_pk_bf16_f32 v93, v90, v91
buffer_store_dwordx2 v[92:93], v11, s[8:11], s60 offen sc1
s_lshr_b32 s63, s54, 2
s_xnor_b32 s63, s63, s98
s_and_b32 s63, s63, 1
s_lshl_b32 s63, s63, 13
s_lshl_b32 s50, s54, 19
s_add_u32 s50, s50, s63
s_branch mega_kernel_o_imm
mega_kernel_o_im2:
v_add_u32 v2, s53, v8
v_add_u32 v3, s53, v9
v_add_u32 v4, s53, v10
ds_write_b128 v2, v[224:227] offset:0
ds_write_b128 v2, v[228:231] offset:1088
ds_write_b128 v2, v[232:235] offset:2176
ds_write_b128 v2, v[236:239] offset:3264
ds_write_b128 v2, v[240:243] offset:4352
ds_write_b128 v2, v[244:247] offset:5440
ds_write_b128 v2, v[248:251] offset:6528
ds_write_b128 v2, v[252:255] offset:7616
s_waitcnt lgkmcnt(0)
s_barrier
ds_read_b128 v[52:55], v4 offset:0
ds_read_b128 v[56:59], v4 offset:8704
ds_read_b128 v[60:63], v4 offset:17408
ds_read_b128 v[64:67], v4 offset:26112
ds_read_b128 v[68:71], v3 offset:0
ds_read_b128 v[72:75], v3 offset:8704
ds_read_b128 v[76:79], v3 offset:17408
ds_read_b128 v[80:83], v3 offset:26112
s_sub_u32 s53, 34816, s53
s_sub_u32 s60, s42, s64
s_lshr_b32 s60, s60, s67
s_bfe_u32 s61, s60, 0x10001
s_and_b32 s60, s60, 1
s_lshl_b32 s60, s60, 12
s_waitcnt lgkmcnt(4)
v_add_f32 v52, v52, v56
v_add_f32 v60, v60, v64
v_add_f32 v53, v53, v57
v_add_f32 v61, v61, v65
v_add_f32 v54, v54, v58
v_add_f32 v62, v62, v66
v_add_f32 v55, v55, v59
v_add_f32 v63, v63, v67
v_add_f32 v52, v52, v60
v_add_f32 v53, v53, v61
v_add_f32 v54, v54, v62
v_add_f32 v55, v55, v63
v_and_or_b32 v52, v52, -2, s61
s_cmp_eq_u32 s95, 0
s_cbranch_scc1 mega_kernel_o_sa4
buffer_store_dwordx4 v[52:55], v12, s[84:87], s60 offen sc1
s_branch mega_kernel_o_sb4
mega_kernel_o_sa4:
buffer_store_dwordx4 v[52:55], v12, s[84:87], s60 offen
mega_kernel_o_sb4:
s_waitcnt lgkmcnt(0)
v_add_f32 v68, v68, v72
v_add_f32 v76, v76, v80
v_add_f32 v69, v69, v73
v_add_f32 v77, v77, v81
v_add_f32 v70, v70, v74
v_add_f32 v78, v78, v82
v_add_f32 v71, v71, v75
v_add_f32 v79, v79, v83
v_add_f32 v84, v68, v76
v_add_f32 v85, v69, v77
v_add_f32 v86, v70, v78
v_add_f32 v87, v71, v79
s_sub_u32 s60, s42, s64
s_lshr_b32 s60, s60, s67
s_bfe_u32 s61, s60, 0x10001
s_and_b32 s60, s60, 1
s_lshl_b32 s60, s60, 12
buffer_load_dwordx4 v[88:91], v13, s[84:87], s60 offen sc1
s_waitcnt vmcnt(0)
mega_kernel_o_f2c:
v_and_b32 v14, 1, v88
v_cmp_ne_u32 vcc, s61, v14
s_cbranch_vccz mega_kernel_o_f2k
s_sub_u32 s60, s42, s64
s_lshr_b32 s60, s60, s67
s_bfe_u32 s61, s60, 0x10001
s_and_b32 s60, s60, 1
s_lshl_b32 s60, s60, 12
buffer_load_dwordx4 v[88:91], v13, s[84:87], s60 offen sc1
s_waitcnt vmcnt(0)
s_branch mega_kernel_o_f2c
mega_kernel_o_f2k:
v_pk_add_f32 v[88:89], v[88:89], v[84:85]
v_pk_add_f32 v[90:91], v[90:91], v[86:87]
s_lshl_b32 s60, s42, 17
v_cvt_pk_bf16_f32 v92, v88, v89
v_cvt_pk_bf16_f32 v93, v90, v91
buffer_store_dwordx2 v[92:93], v11, s[8:11], s60 offen sc1
s_add_u32 s42, s42, s71
s_cmp_lt_u32 s42, s65
s_cbranch_scc1 mega_kernel_o_cold
mega_kernel_o_quit:
s_endpgm
mega_kernel_exit:
s_endpgm
mega_kernel_recf:
s_load_dwordx2 s[20:21], s[0:1], 8
s_load_dwordx2 s[16:17], s[0:1], 40
s_load_dwordx2 s[4:5], s[0:1], 16
s_load_dwordx2 s[8:9], s[0:1], 24
s_load_dwordx2 s[12:13], s[0:1], 32
v_lshrrev_b32 v4, 6, v0
v_and_b32 v1, 63, v0
v_readfirstlane_b32 s24, v4
v_lshrrev_b32 v2, 4, v1
v_and_b32 v3, 15, v1
v_lshlrev_b32 v17, 4, v1
s_lshr_b32 s28, s31, 2
s_lshl_b32 s25, s30, 3
s_add_u32 s25, s25, s28
s_and_b32 s26, s31, 3
s_waitcnt lgkmcnt(0)
s_mov_b32 s22, 16384
s_mov_b32 s23, 0x00020000
s_mov_b32 s18, 8388608
s_mov_b32 s19, 0x00020000
s_mov_b32 s6, 8388608
s_mov_b32 s7, 0x00020000
s_mov_b32 s10, 8388608
s_mov_b32 s11, 0x00020000
s_mov_b32 s14, 8388608
s_mov_b32 s15, 0x00020000
s_lshl_b32 s28, s25, 8
s_lshr_b32 s29, s26, 0
s_lshl_b32 s29, s29, 6
s_add_u32 s28, s28, s29
s_lshl_b32 s29, s24, 21
s_add_u32 s28, s28, s29
v_lshrrev_b32 v4, 2, v1
v_and_b32 v5, 3, v1
v_lshlrev_b32 v40, 13, v4
v_lshl_add_u32 v40, v5, 4, v40
v_add_u32 v40, s28, v40
s_lshl_b32 s28, s30, 21
s_lshl_b32 s29, s24, 19
s_add_u32 s28, s28, s29
s_lshr_b32 s29, s31, 0
s_lshl_b32 s29, s29, 6
s_add_u32 s28, s28, s29
v_lshlrev_b32 v41, 11, v4
v_lshl_add_u32 v41, v5, 4, v41
v_add_u32 v41, s28, v41
s_lshl_b32 s47, s24, 15
s_add_u32 s47, s47, 32768
s_lshl_b32 s28, s31, 18
s_lshl_b32 s29, s24, 16
s_add_u32 s28, s28, s29
s_lshl_b32 s29, s30, 11
s_add_u32 s28, s28, s29
v_lshlrev_b32 v48, 13, v2
v_lshl_add_u32 v48, v3, 7, v48
v_add_u32 v48, s28, v48
s_lshl_b32 s28, s30, 21
s_lshl_b32 s29, s31, 16
s_add_u32 s28, s28, s29
s_lshl_b32 s29, s24, 14
s_add_u32 s28, s28, s29
v_lshlrev_b32 v49, 7, v1
v_add_u32 v49, s28, v49
s_and_b32 s76, s31, 1
s_mul_i32 s76, s76, 8
s_and_b32 s28, s31, 15
s_lshl_b32 s28, s28, 4
s_lshl_b32 s29, s24, 8
s_add_u32 s28, s28, s29
v_add_u32 v53, s28, v3
s_lshr_b32 s28, s31, 4
s_lshl_b32 s28, s28, 10
s_add_u32 s28, s28, 384
v_mov_b32 v54, s28
v_mov_b32 v55, 1920
v_cmp_gt_u32 vcc, 32, v1
s_nop 1
v_cndmask_b32 v54, v55, v54, vcc
s_lshl_b32 s29, s30, 11
v_lshl_add_u32 v51, v53, 13, v54
v_add_u32 v51, s29, v51
s_lshl_b32 s29, s30, 21
v_lshl_add_u32 v52, v53, 11, v54
v_add_u32 v52, s29, v52
buffer_load_dword v50, v51, s[8:11], 0 offen
s_xor_b32 s29, s76, 0
s_lshl_b32 s28, s29, 10
s_add_u32 s28, s28, s47
s_add_u32 m0, s28, 0
s_lshl_b32 s29, s29, 17
buffer_load_dwordx4 v40, s[8:11], s29 offen lds
s_xor_b32 s29, s76, 1
s_lshl_b32 s28, s29, 10
s_add_u32 s28, s28, s47
s_add_u32 m0, s28, 0
s_lshl_b32 s29, s29, 17
buffer_load_dwordx4 v40, s[8:11], s29 offen lds
s_xor_b32 s29, s76, 2
s_lshl_b32 s28, s29, 10
s_add_u32 s28, s28, s47
s_add_u32 m0, s28, 0
s_lshl_b32 s29, s29, 17
buffer_load_dwordx4 v40, s[8:11], s29 offen lds
s_xor_b32 s29, s76, 3
s_lshl_b32 s28, s29, 10
s_add_u32 s28, s28, s47
s_add_u32 m0, s28, 0
s_lshl_b32 s29, s29, 17
buffer_load_dwordx4 v40, s[8:11], s29 offen lds
s_xor_b32 s29, s76, 4
s_lshl_b32 s28, s29, 10
s_add_u32 s28, s28, s47
s_add_u32 m0, s28, 0
s_lshl_b32 s29, s29, 17
buffer_load_dwordx4 v40, s[8:11], s29 offen lds
s_xor_b32 s29, s76, 5
s_lshl_b32 s28, s29, 10
s_add_u32 s28, s28, s47
s_add_u32 m0, s28, 0
s_lshl_b32 s29, s29, 17
buffer_load_dwordx4 v40, s[8:11], s29 offen lds
s_xor_b32 s29, s76, 6
s_lshl_b32 s28, s29, 10
s_add_u32 s28, s28, s47
s_add_u32 m0, s28, 0
s_lshl_b32 s29, s29, 17
buffer_load_dwordx4 v40, s[8:11], s29 offen lds
s_xor_b32 s29, s76, 7
s_lshl_b32 s28, s29, 10
s_add_u32 s28, s28, s47
s_add_u32 m0, s28, 0
s_lshl_b32 s29, s29, 17
buffer_load_dwordx4 v40, s[8:11], s29 offen lds
s_xor_b32 s29, s76, 8
s_lshl_b32 s28, s29, 10
s_add_u32 s28, s28, s47
s_add_u32 m0, s28, 0
s_lshl_b32 s29, s29, 17
buffer_load_dwordx4 v40, s[8:11], s29 offen lds
s_xor_b32 s29, s76, 9
s_lshl_b32 s28, s29, 10
s_add_u32 s28, s28, s47
s_add_u32 m0, s28, 0
s_lshl_b32 s29, s29, 17
buffer_load_dwordx4 v40, s[8:11], s29 offen lds
s_xor_b32 s29, s76, 10
s_lshl_b32 s28, s29, 10
s_add_u32 s28, s28, s47
s_add_u32 m0, s28, 0
s_lshl_b32 s29, s29, 17
buffer_load_dwordx4 v40, s[8:11], s29 offen lds
s_xor_b32 s29, s76, 11
s_lshl_b32 s28, s29, 10
s_add_u32 s28, s28, s47
s_add_u32 m0, s28, 0
s_lshl_b32 s29, s29, 17
buffer_load_dwordx4 v40, s[8:11], s29 offen lds
s_xor_b32 s29, s76, 12
s_lshl_b32 s28, s29, 10
s_add_u32 s28, s28, s47
s_add_u32 m0, s28, 0
s_lshl_b32 s29, s29, 17
buffer_load_dwordx4 v40, s[8:11], s29 offen lds
s_xor_b32 s29, s76, 13
s_lshl_b32 s28, s29, 10
s_add_u32 s28, s28, s47
s_add_u32 m0, s28, 0
s_lshl_b32 s29, s29, 17
buffer_load_dwordx4 v40, s[8:11], s29 offen lds
s_xor_b32 s29, s76, 14
s_lshl_b32 s28, s29, 10
s_add_u32 s28, s28, s47
s_add_u32 m0, s28, 0
s_lshl_b32 s29, s29, 17
buffer_load_dwordx4 v40, s[8:11], s29 offen lds
s_xor_b32 s29, s76, 15
s_lshl_b32 s28, s29, 10
s_add_u32 s28, s28, s47
s_add_u32 m0, s28, 0
s_lshl_b32 s29, s29, 17
buffer_load_dwordx4 v40, s[8:11], s29 offen lds
buffer_load_dword v50, v51, s[12:15], 0 offen
s_xor_b32 s29, s76, 0
s_lshl_b32 s28, s29, 10
s_add_u32 s28, s28, s47
s_add_u32 m0, s28, 16384
s_lshl_b32 s29, s29, 17
buffer_load_dwordx4 v40, s[12:15], s29 offen lds
s_xor_b32 s29, s76, 1
s_lshl_b32 s28, s29, 10
s_add_u32 s28, s28, s47
s_add_u32 m0, s28, 16384
s_lshl_b32 s29, s29, 17
buffer_load_dwordx4 v40, s[12:15], s29 offen lds
s_xor_b32 s29, s76, 2
s_lshl_b32 s28, s29, 10
s_add_u32 s28, s28, s47
s_add_u32 m0, s28, 16384
s_lshl_b32 s29, s29, 17
buffer_load_dwordx4 v40, s[12:15], s29 offen lds
s_xor_b32 s29, s76, 3
s_lshl_b32 s28, s29, 10
s_add_u32 s28, s28, s47
s_add_u32 m0, s28, 16384
s_lshl_b32 s29, s29, 17
buffer_load_dwordx4 v40, s[12:15], s29 offen lds
s_xor_b32 s29, s76, 4
s_lshl_b32 s28, s29, 10
s_add_u32 s28, s28, s47
s_add_u32 m0, s28, 16384
s_lshl_b32 s29, s29, 17
buffer_load_dwordx4 v40, s[12:15], s29 offen lds
s_xor_b32 s29, s76, 5
s_lshl_b32 s28, s29, 10
s_add_u32 s28, s28, s47
s_add_u32 m0, s28, 16384
s_lshl_b32 s29, s29, 17
buffer_load_dwordx4 v40, s[12:15], s29 offen lds
s_xor_b32 s29, s76, 6
s_lshl_b32 s28, s29, 10
s_add_u32 s28, s28, s47
s_add_u32 m0, s28, 16384
s_lshl_b32 s29, s29, 17
buffer_load_dwordx4 v40, s[12:15], s29 offen lds
s_xor_b32 s29, s76, 7
s_lshl_b32 s28, s29, 10
s_add_u32 s28, s28, s47
s_add_u32 m0, s28, 16384
s_lshl_b32 s29, s29, 17
buffer_load_dwordx4 v40, s[12:15], s29 offen lds
s_xor_b32 s29, s76, 8
s_lshl_b32 s28, s29, 10
s_add_u32 s28, s28, s47
s_add_u32 m0, s28, 16384
s_lshl_b32 s29, s29, 17
buffer_load_dwordx4 v40, s[12:15], s29 offen lds
s_xor_b32 s29, s76, 9
s_lshl_b32 s28, s29, 10
s_add_u32 s28, s28, s47
s_add_u32 m0, s28, 16384
s_lshl_b32 s29, s29, 17
buffer_load_dwordx4 v40, s[12:15], s29 offen lds
s_xor_b32 s29, s76, 10
s_lshl_b32 s28, s29, 10
s_add_u32 s28, s28, s47
s_add_u32 m0, s28, 16384
s_lshl_b32 s29, s29, 17
buffer_load_dwordx4 v40, s[12:15], s29 offen lds
s_xor_b32 s29, s76, 11
s_lshl_b32 s28, s29, 10
s_add_u32 s28, s28, s47
s_add_u32 m0, s28, 16384
s_lshl_b32 s29, s29, 17
buffer_load_dwordx4 v40, s[12:15], s29 offen lds
s_xor_b32 s29, s76, 12
s_lshl_b32 s28, s29, 10
s_add_u32 s28, s28, s47
s_add_u32 m0, s28, 16384
s_lshl_b32 s29, s29, 17
buffer_load_dwordx4 v40, s[12:15], s29 offen lds
s_xor_b32 s29, s76, 13
s_lshl_b32 s28, s29, 10
s_add_u32 s28, s28, s47
s_add_u32 m0, s28, 16384
s_lshl_b32 s29, s29, 17
buffer_load_dwordx4 v40, s[12:15], s29 offen lds
s_xor_b32 s29, s76, 14
s_lshl_b32 s28, s29, 10
s_add_u32 s28, s28, s47
s_add_u32 m0, s28, 16384
s_lshl_b32 s29, s29, 17
buffer_load_dwordx4 v40, s[12:15], s29 offen lds
s_xor_b32 s29, s76, 15
s_lshl_b32 s28, s29, 10
s_add_u32 s28, s28, s47
s_add_u32 m0, s28, 16384
s_lshl_b32 s29, s29, 17
buffer_load_dwordx4 v40, s[12:15], s29 offen lds
s_mov_b32 s40, 0x00ff00ff
s_mov_b32 s41, 0x00ff00ff
s_mov_b32 s48, 0xff00ff00
s_mov_b32 s49, 0xff00ff00
s_mov_b32 s42, 0
s_mov_b32 s43, 0x00ff00ff
s_mov_b32 s32, 0x3e0293ee
v_mov_b32 v23, 0xff800000
v_mov_b32 v6, 0x4444
v_mov_b32 v4, 0xeeee
v_cndmask_b32 v6, v6, v4, s[48:49]
v_mov_b32 v28, -1
v_mov_b32 v29, -1
v_mov_b32 v30, -1
v_mov_b32 v31, -1
s_mul_i32 s28, s24, 4096
v_add_u32 v7, s28, v17
v_and_b32 v4, 7, v1
v_lshlrev_b32 v8, 11, v4
v_lshrrev_b32 v5, 3, v1
v_lshl_add_u32 v8, v5, 4, v8
s_lshl_b32 s28, s24, 9
v_add_u32 v8, s28, v8
s_lshl_b32 s28, s31, 9
s_lshr_b32 s29, s31, 3
s_mul_i32 s29, s29, 0
s_add_u32 s28, s28, s29
v_lshlrev_b32 v9, 3, v1
v_add_u32 v9, s28, v9
v_and_b32 v4, 7, v3
v_lshlrev_b32 v11, 7, v2
v_lshl_add_u32 v11, v4, 4, v11
v_add_u32 v22, 0, v11
s_add_u32 s28, s28, 24576
v_add_u32 v11, s28, v11
v_and_b32 v5, 1, v2
v_lshlrev_b32 v10, 7, v5
v_lshl_add_u32 v10, v4, 4, v10
v_add_u32 v10, 1024, v10
s_xor_b32 s37, s31, 1
s_mul_i32 s37, s37, 1280
s_add_u32 s37, s37, 49152
s_xor_b32 s38, s31, 2
s_mul_i32 s38, s38, 1280
s_add_u32 s38, s38, 49152
s_xor_b32 s39, s31, 3
s_mul_i32 s39, s39, 1280
s_add_u32 s39, s39, 49152
v_and_b32 v4, 1, v2
v_mul_u32_u24 v14, 576, v4
v_lshrrev_b32 v5, 1, v2
v_lshl_add_u32 v5, v5, 4, v3
v_lshl_add_u32 v14, v5, 2, v14
s_mul_i32 s28, s24, 1152
s_add_u32 s28, s28, 13312
v_add_u32 v18, s28, v14
s_mul_i32 s28, s24, 2304
v_add_u32 v14, s28, v14
v_add_u32 v15, 1152, v14
v_mul_u32_u24 v16, 144, v3
v_lshl_add_u32 v16, v2, 5, v16
v_bfe_u32 v4, v1, 1, 3
v_mul_u32_u24 v19, 144, v4
v_lshl_add_u32 v19, v2, 5, v19
v_and_b32 v4, 1, v1
v_lshl_add_u32 v19, v4, 4, v19
v_add_u32 v19, 13312, v19
s_lshl_b32 s28, s24, 10
s_add_u32 s28, s28, 9216
v_add_u32 v20, s28, v17
v_and_b32 v4, 31, v1
v_lshlrev_b32 v21, 3, v4
v_add_u32 v21, 17920, v21
v_lshrrev_b32 v4, 2, v3
v_and_b32 v42, 1, v4
v_lshrrev_b32 v43, 1, v4
v_lshrrev_b32 v44, 1, v2
v_and_b32 v45, 1, v2
v_lshl_add_u32 v46, v44, 4, v42
v_lshl_add_u32 v46, v45, 2, v46
v_lshl_add_u32 v46, v43, 3, v46
v_lshl_add_u32 v47, v44, 3, v42
v_lshl_add_u32 v47, v45, 4, v47
v_lshl_add_u32 v47, v43, 2, v47
v_and_b32 v5, 3, v3
v_lshlrev_b32 v5, 3, v5
v_lshl_add_u32 v46, v46, 6, v5
v_lshl_add_u32 v47, v47, 6, v5
s_and_b32 s28, s31, 0
s_lshl_b32 s28, s28, 6
s_add_u32 s28, s28, s47
v_add_u32 v46, s28, v46
v_add_u32 v47, s28, v47
s_waitcnt vmcnt(17)
ds_read_b64_tr_b16 a[64:65], v46 offset:0
ds_read_b64_tr_b16 a[66:67], v46 offset:128
ds_read_b64_tr_b16 a[68:69], v46 offset:2048
ds_read_b64_tr_b16 a[70:71], v46 offset:2176
ds_read_b64_tr_b16 a[72:73], v46 offset:4096
ds_read_b64_tr_b16 a[74:75], v46 offset:4224
ds_read_b64_tr_b16 a[76:77], v46 offset:6144
ds_read_b64_tr_b16 a[78:79], v46 offset:6272
s_waitcnt lgkmcnt(0)
ds_read_b64_tr_b16 a[80:81], v46 offset:8192
ds_read_b64_tr_b16 a[82:83], v46 offset:8320
ds_read_b64_tr_b16 a[84:85], v46 offset:10240
ds_read_b64_tr_b16 a[86:87], v46 offset:10368
ds_read_b64_tr_b16 a[88:89], v46 offset:12288
ds_read_b64_tr_b16 a[90:91], v46 offset:12416
ds_read_b64_tr_b16 a[92:93], v46 offset:14336
ds_read_b64_tr_b16 a[94:95], v46 offset:14464
s_waitcnt lgkmcnt(0)
ds_read_b64_tr_b16 a[96:97], v46 offset:32
ds_read_b64_tr_b16 a[98:99], v46 offset:160
ds_read_b64_tr_b16 a[100:101], v46 offset:2080
ds_read_b64_tr_b16 a[102:103], v46 offset:2208
ds_read_b64_tr_b16 a[104:105], v46 offset:4128
ds_read_b64_tr_b16 a[106:107], v46 offset:4256
ds_read_b64_tr_b16 a[108:109], v46 offset:6176
ds_read_b64_tr_b16 a[110:111], v46 offset:6304
s_waitcnt lgkmcnt(0)
ds_read_b64_tr_b16 a[112:113], v46 offset:8224
ds_read_b64_tr_b16 a[114:115], v46 offset:8352
ds_read_b64_tr_b16 a[116:117], v46 offset:10272
ds_read_b64_tr_b16 a[118:119], v46 offset:10400
ds_read_b64_tr_b16 a[120:121], v46 offset:12320
ds_read_b64_tr_b16 a[122:123], v46 offset:12448
ds_read_b64_tr_b16 a[124:125], v46 offset:14368
ds_read_b64_tr_b16 a[126:127], v46 offset:14496
s_waitcnt lgkmcnt(0)
buffer_load_dword v50, v51, s[4:7], 0 offen
s_xor_b32 s29, s76, 0
s_lshl_b32 s28, s29, 10
s_add_u32 s28, s28, s47
s_add_u32 m0, s28, 0
s_lshl_b32 s29, s29, 17
buffer_load_dwordx4 v40, s[4:7], s29 offen lds
s_xor_b32 s29, s76, 1
s_lshl_b32 s28, s29, 10
s_add_u32 s28, s28, s47
s_add_u32 m0, s28, 0
s_lshl_b32 s29, s29, 17
buffer_load_dwordx4 v40, s[4:7], s29 offen lds
s_xor_b32 s29, s76, 2
s_lshl_b32 s28, s29, 10
s_add_u32 s28, s28, s47
s_add_u32 m0, s28, 0
s_lshl_b32 s29, s29, 17
buffer_load_dwordx4 v40, s[4:7], s29 offen lds
s_xor_b32 s29, s76, 3
s_lshl_b32 s28, s29, 10
s_add_u32 s28, s28, s47
s_add_u32 m0, s28, 0
s_lshl_b32 s29, s29, 17
buffer_load_dwordx4 v40, s[4:7], s29 offen lds
s_xor_b32 s29, s76, 4
s_lshl_b32 s28, s29, 10
s_add_u32 s28, s28, s47
s_add_u32 m0, s28, 0
s_lshl_b32 s29, s29, 17
buffer_load_dwordx4 v40, s[4:7], s29 offen lds
s_xor_b32 s29, s76, 5
s_lshl_b32 s28, s29, 10
s_add_u32 s28, s28, s47
s_add_u32 m0, s28, 0
s_lshl_b32 s29, s29, 17
buffer_load_dwordx4 v40, s[4:7], s29 offen lds
s_xor_b32 s29, s76, 6
s_lshl_b32 s28, s29, 10
s_add_u32 s28, s28, s47
s_add_u32 m0, s28, 0
s_lshl_b32 s29, s29, 17
buffer_load_dwordx4 v40, s[4:7], s29 offen lds
s_xor_b32 s29, s76, 7
s_lshl_b32 s28, s29, 10
s_add_u32 s28, s28, s47
s_add_u32 m0, s28, 0
s_lshl_b32 s29, s29, 17
buffer_load_dwordx4 v40, s[4:7], s29 offen lds
s_xor_b32 s29, s76, 8
s_lshl_b32 s28, s29, 10
s_add_u32 s28, s28, s47
s_add_u32 m0, s28, 0
s_lshl_b32 s29, s29, 17
buffer_load_dwordx4 v40, s[4:7], s29 offen lds
s_xor_b32 s29, s76, 9
s_lshl_b32 s28, s29, 10
s_add_u32 s28, s28, s47
s_add_u32 m0, s28, 0
s_lshl_b32 s29, s29, 17
buffer_load_dwordx4 v40, s[4:7], s29 offen lds
s_xor_b32 s29, s76, 10
s_lshl_b32 s28, s29, 10
s_add_u32 s28, s28, s47
s_add_u32 m0, s28, 0
s_lshl_b32 s29, s29, 17
buffer_load_dwordx4 v40, s[4:7], s29 offen lds
s_xor_b32 s29, s76, 11
s_lshl_b32 s28, s29, 10
s_add_u32 s28, s28, s47
s_add_u32 m0, s28, 0
s_lshl_b32 s29, s29, 17
buffer_load_dwordx4 v40, s[4:7], s29 offen lds
s_xor_b32 s29, s76, 12
s_lshl_b32 s28, s29, 10
s_add_u32 s28, s28, s47
s_add_u32 m0, s28, 0
s_lshl_b32 s29, s29, 17
buffer_load_dwordx4 v40, s[4:7], s29 offen lds
s_xor_b32 s29, s76, 13
s_lshl_b32 s28, s29, 10
s_add_u32 s28, s28, s47
s_add_u32 m0, s28, 0
s_lshl_b32 s29, s29, 17
buffer_load_dwordx4 v40, s[4:7], s29 offen lds
s_xor_b32 s29, s76, 14
s_lshl_b32 s28, s29, 10
s_add_u32 s28, s28, s47
s_add_u32 m0, s28, 0
s_lshl_b32 s29, s29, 17
buffer_load_dwordx4 v40, s[4:7], s29 offen lds
s_xor_b32 s29, s76, 15
s_lshl_b32 s28, s29, 10
s_add_u32 s28, s28, s47
s_add_u32 m0, s28, 0
s_lshl_b32 s29, s29, 17
buffer_load_dwordx4 v40, s[4:7], s29 offen lds
s_waitcnt vmcnt(17)
ds_read_b64_tr_b16 a[128:129], v46 offset:16384
ds_read_b64_tr_b16 a[130:131], v46 offset:16512
ds_read_b64_tr_b16 a[132:133], v46 offset:18432
ds_read_b64_tr_b16 a[134:135], v46 offset:18560
ds_read_b64_tr_b16 a[136:137], v46 offset:20480
ds_read_b64_tr_b16 a[138:139], v46 offset:20608
ds_read_b64_tr_b16 a[140:141], v46 offset:22528
ds_read_b64_tr_b16 a[142:143], v46 offset:22656
s_waitcnt lgkmcnt(0)
ds_read_b64_tr_b16 a[144:145], v46 offset:24576
ds_read_b64_tr_b16 a[146:147], v46 offset:24704
ds_read_b64_tr_b16 a[148:149], v46 offset:26624
ds_read_b64_tr_b16 a[150:151], v46 offset:26752
ds_read_b64_tr_b16 a[152:153], v46 offset:28672
ds_read_b64_tr_b16 a[154:155], v46 offset:28800
ds_read_b64_tr_b16 a[156:157], v46 offset:30720
ds_read_b64_tr_b16 a[158:159], v46 offset:30848
s_waitcnt lgkmcnt(0)
ds_read_b64_tr_b16 a[160:161], v46 offset:16416
ds_read_b64_tr_b16 a[162:163], v46 offset:16544
ds_read_b64_tr_b16 a[164:165], v46 offset:18464
ds_read_b64_tr_b16 a[166:167], v46 offset:18592
ds_read_b64_tr_b16 a[168:169], v46 offset:20512
ds_read_b64_tr_b16 a[170:171], v46 offset:20640
ds_read_b64_tr_b16 a[172:173], v46 offset:22560
ds_read_b64_tr_b16 a[174:175], v46 offset:22688
s_waitcnt lgkmcnt(0)
ds_read_b64_tr_b16 a[176:177], v46 offset:24608
ds_read_b64_tr_b16 a[178:179], v46 offset:24736
ds_read_b64_tr_b16 a[180:181], v46 offset:26656
ds_read_b64_tr_b16 a[182:183], v46 offset:26784
ds_read_b64_tr_b16 a[184:185], v46 offset:28704
ds_read_b64_tr_b16 a[186:187], v46 offset:28832
ds_read_b64_tr_b16 a[188:189], v46 offset:30752
ds_read_b64_tr_b16 a[190:191], v46 offset:30880
s_waitcnt lgkmcnt(0)
buffer_load_dword v50, v52, s[16:19], 0 offen
s_xor_b32 s29, s76, 0
s_lshl_b32 s28, s29, 10
s_add_u32 s28, s28, s47
s_add_u32 m0, s28, 16384
s_lshl_b32 s29, s29, 15
buffer_load_dwordx4 v41, s[16:19], s29 offen lds
s_xor_b32 s29, s76, 1
s_lshl_b32 s28, s29, 10
s_add_u32 s28, s28, s47
s_add_u32 m0, s28, 16384
s_lshl_b32 s29, s29, 15
buffer_load_dwordx4 v41, s[16:19], s29 offen lds
s_xor_b32 s29, s76, 2
s_lshl_b32 s28, s29, 10
s_add_u32 s28, s28, s47
s_add_u32 m0, s28, 16384
s_lshl_b32 s29, s29, 15
buffer_load_dwordx4 v41, s[16:19], s29 offen lds
s_xor_b32 s29, s76, 3
s_lshl_b32 s28, s29, 10
s_add_u32 s28, s28, s47
s_add_u32 m0, s28, 16384
s_lshl_b32 s29, s29, 15
buffer_load_dwordx4 v41, s[16:19], s29 offen lds
s_xor_b32 s29, s76, 4
s_lshl_b32 s28, s29, 10
s_add_u32 s28, s28, s47
s_add_u32 m0, s28, 16384
s_lshl_b32 s29, s29, 15
buffer_load_dwordx4 v41, s[16:19], s29 offen lds
s_xor_b32 s29, s76, 5
s_lshl_b32 s28, s29, 10
s_add_u32 s28, s28, s47
s_add_u32 m0, s28, 16384
s_lshl_b32 s29, s29, 15
buffer_load_dwordx4 v41, s[16:19], s29 offen lds
s_xor_b32 s29, s76, 6
s_lshl_b32 s28, s29, 10
s_add_u32 s28, s28, s47
s_add_u32 m0, s28, 16384
s_lshl_b32 s29, s29, 15
buffer_load_dwordx4 v41, s[16:19], s29 offen lds
s_xor_b32 s29, s76, 7
s_lshl_b32 s28, s29, 10
s_add_u32 s28, s28, s47
s_add_u32 m0, s28, 16384
s_lshl_b32 s29, s29, 15
buffer_load_dwordx4 v41, s[16:19], s29 offen lds
s_xor_b32 s29, s76, 8
s_lshl_b32 s28, s29, 10
s_add_u32 s28, s28, s47
s_add_u32 m0, s28, 16384
s_lshl_b32 s29, s29, 15
buffer_load_dwordx4 v41, s[16:19], s29 offen lds
s_xor_b32 s29, s76, 9
s_lshl_b32 s28, s29, 10
s_add_u32 s28, s28, s47
s_add_u32 m0, s28, 16384
s_lshl_b32 s29, s29, 15
buffer_load_dwordx4 v41, s[16:19], s29 offen lds
s_xor_b32 s29, s76, 10
s_lshl_b32 s28, s29, 10
s_add_u32 s28, s28, s47
s_add_u32 m0, s28, 16384
s_lshl_b32 s29, s29, 15
buffer_load_dwordx4 v41, s[16:19], s29 offen lds
s_xor_b32 s29, s76, 11
s_lshl_b32 s28, s29, 10
s_add_u32 s28, s28, s47
s_add_u32 m0, s28, 16384
s_lshl_b32 s29, s29, 15
buffer_load_dwordx4 v41, s[16:19], s29 offen lds
s_xor_b32 s29, s76, 12
s_lshl_b32 s28, s29, 10
s_add_u32 s28, s28, s47
s_add_u32 m0, s28, 16384
s_lshl_b32 s29, s29, 15
buffer_load_dwordx4 v41, s[16:19], s29 offen lds
s_xor_b32 s29, s76, 13
s_lshl_b32 s28, s29, 10
s_add_u32 s28, s28, s47
s_add_u32 m0, s28, 16384
s_lshl_b32 s29, s29, 15
buffer_load_dwordx4 v41, s[16:19], s29 offen lds
s_xor_b32 s29, s76, 14
s_lshl_b32 s28, s29, 10
s_add_u32 s28, s28, s47
s_add_u32 m0, s28, 16384
s_lshl_b32 s29, s29, 15
buffer_load_dwordx4 v41, s[16:19], s29 offen lds
s_xor_b32 s29, s76, 15
s_lshl_b32 s28, s29, 10
s_add_u32 s28, s28, s47
s_add_u32 m0, s28, 16384
s_lshl_b32 s29, s29, 15
buffer_load_dwordx4 v41, s[16:19], s29 offen lds
s_mov_b64 exec, 0
s_cmp_eq_u32 s24, 0
s_cbranch_scc1 mega_kernel_rf_iw0
s_cmp_eq_u32 s24, 1
s_cbranch_scc1 mega_kernel_rf_iw1
s_cmp_eq_u32 s24, 2
s_cbranch_scc1 mega_kernel_rf_iw2
s_branch mega_kernel_rf_iw3
mega_kernel_rf_iwd:
s_mov_b64 exec, -1
s_waitcnt vmcnt(17)
ds_read_b64_tr_b16 a[0:1], v46 offset:0
ds_read_b64_tr_b16 a[2:3], v46 offset:128
ds_read_b64_tr_b16 a[4:5], v46 offset:2048
ds_read_b64_tr_b16 a[6:7], v46 offset:2176
ds_read_b64_tr_b16 a[8:9], v46 offset:4096
ds_read_b64_tr_b16 a[10:11], v46 offset:4224
ds_read_b64_tr_b16 a[12:13], v46 offset:6144
ds_read_b64_tr_b16 a[14:15], v46 offset:6272
s_waitcnt lgkmcnt(0)
ds_read_b64_tr_b16 a[16:17], v46 offset:8192
ds_read_b64_tr_b16 a[18:19], v46 offset:8320
ds_read_b64_tr_b16 a[20:21], v46 offset:10240
ds_read_b64_tr_b16 a[22:23], v46 offset:10368
ds_read_b64_tr_b16 a[24:25], v46 offset:12288
ds_read_b64_tr_b16 a[26:27], v46 offset:12416
ds_read_b64_tr_b16 a[28:29], v46 offset:14336
ds_read_b64_tr_b16 a[30:31], v46 offset:14464
s_waitcnt lgkmcnt(0)
ds_read_b64_tr_b16 a[32:33], v46 offset:32
ds_read_b64_tr_b16 a[34:35], v46 offset:160
ds_read_b64_tr_b16 a[36:37], v46 offset:2080
ds_read_b64_tr_b16 a[38:39], v46 offset:2208
ds_read_b64_tr_b16 a[40:41], v46 offset:4128
ds_read_b64_tr_b16 a[42:43], v46 offset:4256
ds_read_b64_tr_b16 a[44:45], v46 offset:6176
ds_read_b64_tr_b16 a[46:47], v46 offset:6304
s_waitcnt lgkmcnt(0)
ds_read_b64_tr_b16 a[48:49], v46 offset:8224
ds_read_b64_tr_b16 a[50:51], v46 offset:8352
ds_read_b64_tr_b16 a[52:53], v46 offset:10272
ds_read_b64_tr_b16 a[54:55], v46 offset:10400
ds_read_b64_tr_b16 a[56:57], v46 offset:12320
ds_read_b64_tr_b16 a[58:59], v46 offset:12448
ds_read_b64_tr_b16 a[60:61], v46 offset:14368
ds_read_b64_tr_b16 a[62:63], v46 offset:14496
s_waitcnt lgkmcnt(0)
v_and_b32 v247, 15, v0
v_lshlrev_b32 v247, 4, v247
buffer_load_dword v246, v247, s[72:75], 0 offen sc1
buffer_load_dwordx4 v[64:67], v8, s[20:23], 0 offen offset:0
buffer_load_dwordx4 v[68:71], v8, s[20:23], 0 offen offset:128
buffer_load_dwordx4 v[72:75], v8, s[20:23], 0 offen offset:256
buffer_load_dwordx4 v[76:79], v8, s[20:23], 0 offen offset:384
s_waitcnt vmcnt(0)
ds_read_b64_tr_b16 a[192:193], v47 offset:16384
ds_read_b64_tr_b16 a[194:195], v47 offset:16512
ds_read_b64_tr_b16 a[196:197], v47 offset:18432
ds_read_b64_tr_b16 a[198:199], v47 offset:18560
ds_read_b64_tr_b16 a[200:201], v47 offset:20480
ds_read_b64_tr_b16 a[202:203], v47 offset:20608
ds_read_b64_tr_b16 a[204:205], v47 offset:22528
ds_read_b64_tr_b16 a[206:207], v47 offset:22656
s_waitcnt lgkmcnt(0)
ds_read_b64_tr_b16 a[208:209], v47 offset:24576
ds_read_b64_tr_b16 a[210:211], v47 offset:24704
ds_read_b64_tr_b16 a[212:213], v47 offset:26624
ds_read_b64_tr_b16 a[214:215], v47 offset:26752
ds_read_b64_tr_b16 a[216:217], v47 offset:28672
ds_read_b64_tr_b16 a[218:219], v47 offset:28800
ds_read_b64_tr_b16 a[220:221], v47 offset:30720
ds_read_b64_tr_b16 a[222:223], v47 offset:30848
s_waitcnt lgkmcnt(0)
ds_read_b64_tr_b16 a[224:225], v47 offset:16416
ds_read_b64_tr_b16 a[226:227], v47 offset:16544
ds_read_b64_tr_b16 a[228:229], v47 offset:18464
ds_read_b64_tr_b16 a[230:231], v47 offset:18592
ds_read_b64_tr_b16 a[232:233], v47 offset:20512
ds_read_b64_tr_b16 a[234:235], v47 offset:20640
ds_read_b64_tr_b16 a[236:237], v47 offset:22560
ds_read_b64_tr_b16 a[238:239], v47 offset:22688
s_waitcnt lgkmcnt(0)
ds_read_b64_tr_b16 a[240:241], v47 offset:24608
ds_read_b64_tr_b16 a[242:243], v47 offset:24736
ds_read_b64_tr_b16 a[244:245], v47 offset:26656
ds_read_b64_tr_b16 a[246:247], v47 offset:26784
ds_read_b64_tr_b16 a[248:249], v47 offset:28704
ds_read_b64_tr_b16 a[250:251], v47 offset:28832
ds_read_b64_tr_b16 a[252:253], v47 offset:30752
ds_read_b64_tr_b16 a[254:255], v47 offset:30880
s_waitcnt lgkmcnt(0)
v_mov_b32 v32, v64
v_mov_b32 v33, v65
v_mov_b32 v34, v66
v_mov_b32 v35, v67
v_mov_b32 v36, v68
v_mov_b32 v37, v69
v_mov_b32 v38, v70
v_mov_b32 v39, v71
v_mov_b32 v40, v72
v_mov_b32 v41, v73
v_mov_b32 v42, v74
v_mov_b32 v43, v75
v_mov_b32 v44, v76
v_mov_b32 v45, v77
v_mov_b32 v46, v78
v_mov_b32 v47, v79
v_mov_b32 v96, 0
v_mov_b32 v97, 0
v_mov_b32 v98, 0
v_mov_b32 v99, 0
v_mov_b32 v100, 0
v_mov_b32 v101, 0
v_mov_b32 v102, 0
v_mov_b32 v103, 0
v_mov_b32 v104, 0
v_mov_b32 v105, 0
v_mov_b32 v106, 0
v_mov_b32 v107, 0
v_mov_b32 v108, 0
v_mov_b32 v109, 0
v_mov_b32 v110, 0
v_mov_b32 v111, 0
v_mov_b32 v112, 0
v_mov_b32 v113, 0
v_mov_b32 v114, 0
v_mov_b32 v115, 0
v_mov_b32 v116, 0
v_mov_b32 v117, 0
v_mov_b32 v118, 0
v_mov_b32 v119, 0
s_nop 1
v_smfmac_f32_16x16x64_bf16 v[96:99], v[32:35], a[0:7], v6
v_smfmac_f32_16x16x64_bf16 v[100:103], v[32:35], a[32:39], v6
v_smfmac_f32_16x16x64_bf16 v[104:107], v[32:35], a[64:71], v6
v_smfmac_f32_16x16x64_bf16 v[108:111], v[32:35], a[96:103], v6
v_smfmac_f32_16x16x64_bf16 v[96:99], v[36:39], a[8:15], v6
v_smfmac_f32_16x16x64_bf16 v[100:103], v[36:39], a[40:47], v6
v_smfmac_f32_16x16x64_bf16 v[104:107], v[36:39], a[72:79], v6
v_smfmac_f32_16x16x64_bf16 v[108:111], v[36:39], a[104:111], v6
v_smfmac_f32_16x16x64_bf16 v[96:99], v[40:43], a[16:23], v6
v_smfmac_f32_16x16x64_bf16 v[100:103], v[40:43], a[48:55], v6
v_smfmac_f32_16x16x64_bf16 v[104:107], v[40:43], a[80:87], v6
v_smfmac_f32_16x16x64_bf16 v[108:111], v[40:43], a[112:119], v6
v_smfmac_f32_16x16x64_bf16 v[96:99], v[44:47], a[24:31], v6
v_smfmac_f32_16x16x64_bf16 v[100:103], v[44:47], a[56:63], v6
v_smfmac_f32_16x16x64_bf16 v[104:107], v[44:47], a[88:95], v6
v_smfmac_f32_16x16x64_bf16 v[108:111], v[44:47], a[120:127], v6
v_and_b32 v247, 15, v0
v_lshlrev_b32 v247, 4, v247
s_branch mega_kernel_syrp
mega_kernel_syrw:
s_sleep 4
mega_kernel_syr:
buffer_load_dword v246, v247, s[72:75], 0 offen sc1
s_waitcnt vmcnt(0)
mega_kernel_syrp:
s_cmp_eq_u32 s95, 1
s_cbranch_scc0 mega_kernel_syrf
v_readlane_b32 s76, v246, 14
s_mov_b32 s98, 0
s_cmp_eq_u32 s76, 32
s_cbranch_scc0 mega_kernel_syrw
s_branch mega_kernel_syrd
mega_kernel_syrf:
s_mov_b32 s77, 0
s_mov_b32 s78, 0
v_readlane_b32 s76, v246, 0
s_add_u32 s77, s77, s76
s_xor_b32 s76, s76, 32
s_or_b32 s78, s78, s76
v_readlane_b32 s76, v246, 1
s_add_u32 s77, s77, s76
s_xor_b32 s76, s76, 32
s_or_b32 s78, s78, s76
v_readlane_b32 s76, v246, 2
s_add_u32 s77, s77, s76
s_xor_b32 s76, s76, 32
s_or_b32 s78, s78, s76
v_readlane_b32 s76, v246, 3
s_add_u32 s77, s77, s76
s_xor_b32 s76, s76, 32
s_or_b32 s78, s78, s76
v_readlane_b32 s76, v246, 4
s_add_u32 s77, s77, s76
s_xor_b32 s76, s76, 32
s_or_b32 s78, s78, s76
v_readlane_b32 s76, v246, 5
s_add_u32 s77, s77, s76
s_xor_b32 s76, s76, 32
s_or_b32 s78, s78, s76
v_readlane_b32 s76, v246, 6
s_add_u32 s77, s77, s76
s_xor_b32 s76, s76, 32
s_or_b32 s78, s78, s76
v_readlane_b32 s76, v246, 7
s_add_u32 s77, s77, s76
s_xor_b32 s76, s76, 32
s_or_b32 s78, s78, s76
s_cmp_eq_u32 s77, 256
s_cbranch_scc0 mega_kernel_syrw
v_mov_b32 v252, v246
s_cmp_eq_u32 s78, 0
s_cbranch_scc0 mega_kernel_slowent
v_readlane_b32 s76, v246, 10
v_readlane_b32 s77, v246, 8
s_cmp_eq_u32 s76, 32
s_cbranch_scc0 mega_kernel_syrw
s_cmp_gt_u32 s77, 16
s_cselect_b32 s98, 1, 0
mega_kernel_syrd:
s_lshr_b32 s28, s31, 4
s_lshl_b32 s28, s28, 14
s_lshl_b32 s29, s98, 13
s_add_u32 s28, s28, s29
s_and_b32 s29, s31, 15
s_lshl_b32 s29, s29, 9
s_add_u32 s28, s28, s29
s_lshl_b32 s29, s30, 16
s_add_u32 s28, s28, s29
s_add_u32 s28, s28, 67108864
v_lshrrev_b32 v12, 1, v17
v_add_u32 v12, s28, v12
v_xor_b32 v25, 0x10000, v12
v_xor_b32 v26, 0x20000, v12
v_xor_b32 v27, 0x30000, v12
v_add_u32 v25, 0, v25
v_add_u32 v26, 0, v26
v_add_u32 v27, 0, v27
s_lshl_b32 s28, s25, 2
s_add_u32 s28, s28, s26
s_mov_b32 s82, s28
s_lshr_b32 s29, s28, 3
s_xor_b32 s29, s29, s98
s_and_b32 s29, s29, 1
s_lshl_b32 s29, s29, 13
s_lshl_b32 s76, s28, 18
s_add_u32 s76, s76, s29
s_mov_b32 s83, s76
v_add_u32 v240, s76, v17
v_add_u32 v241, 33554432, v240
s_lshr_b32 s29, s28, 4
s_xor_b32 s29, s29, s98
s_and_b32 s29, s29, 1
s_lshl_b32 s29, s29, 13
s_lshl_b32 s79, s28, 17
s_add_u32 s79, s79, s29
s_add_u32 s79, s79, 71303168
s_xor_b32 s29, s98, 1
s_lshl_b32 s29, s29, 13
s_lshl_b32 s28, s25, 7
s_add_u32 s28, s28, s29
s_add_u32 s28, s28, 69206016
v_and_b32 v4, 1, v1
v_lshlrev_b32 v24, 12, v4
v_add_u32 v24, s28, v24
s_lshl_b32 s29, s26, 2
v_add_u32 v24, s29, v24
s_xor_b32 s81, s98, 1
s_lshl_b32 s81, s81, 13
s_lshr_b32 s29, s82, 6
s_lshl_b32 s29, s29, 14
s_add_u32 s81, s81, s29
s_and_b32 s29, s82, 63
s_lshl_b32 s29, s29, 7
s_add_u32 s81, s81, s29
s_add_u32 s81, s81, 69222400
v_mov_b32 v220, 0x3f803f80
v_mov_b32 v221, 0x3f803f80
v_mov_b32 v222, 0x3f803f80
v_mov_b32 v223, 0x3f803f80
v_mov_b32 v228, 0
s_mov_b32 s27, 0
s_mov_b32 s46, 0
s_mov_b32 s89, 0
s_mov_b32 s88, 0
s_mov_b32 s44, 18432
s_mov_b32 s45, 18432
s_cmp_eq_u32 s24, 3
s_cbranch_scc0 mega_kernel_rf_pfi
s_mov_b32 s76, 0
s_cmp_gt_i32 s46, s76
s_cbranch_scc1 mega_kernel_rf_pf0ok
mega_kernel_rf_pf0w:
v_mov_b32 v4, 0
s_mov_b64 exec, 3
buffer_atomic_add v4, v24, s[84:87], 0 offen sc0 sc1
s_mov_b64 exec, -1
s_waitcnt vmcnt(0)
v_readlane_b32 s46, v4, 0
v_readlane_b32 s28, v4, 1
s_nop 1
s_min_i32 s46, s46, s28
s_cmp_gt_i32 s46, s76
s_cbranch_scc0 mega_kernel_rf_pf0w
mega_kernel_rf_pf0ok:
s_add_u32 s77, s76, s82
s_bfe_u32 s28, s77, 0x40002
s_lshl_b32 s28, s28, 14
s_and_b32 s77, s77, 3
s_lshl_b32 s77, s77, 11
s_add_u32 s28, s28, s77
s_add_u32 m0, s45, 0
s_nop 0
buffer_load_dwordx4 v240, s[84:87], s28 offen offset:0 sc1 lds
s_add_u32 m0, s45, 0
s_nop 0
buffer_load_dwordx4 v240, s[84:87], s28 offen offset:1024 sc1 lds
s_add_u32 m0, s45, 2048
s_nop 0
buffer_load_dwordx4 v241, s[84:87], s28 offen offset:0 sc1 lds
s_add_u32 m0, s45, 2048
s_nop 0
buffer_load_dwordx4 v241, s[84:87], s28 offen offset:1024 sc1 lds
s_add_u32 s45, s45, 4096
s_cmp_eq_u32 s45, 30720
s_cselect_b32 s45, 18432, s45
s_waitcnt vmcnt(0) lgkmcnt(0)
s_branch mega_kernel_rf_pfj
mega_kernel_rf_pfi:
s_lshr_b32 s88, s25, 2
s_lshl_b32 s88, s88, 17
s_and_b32 s77, s25, 2
s_lshl_b32 s77, s77, 13
s_add_u32 s88, s88, s77
s_and_b32 s77, s25, 1
s_lshl_b32 s77, s77, 12
s_add_u32 s88, s88, s77
s_xor_b32 s77, s98, 0
s_lshl_b32 s77, s77, 13
s_add_u32 s88, s88, s77
s_add_u32 s88, s88, 68255744
s_lshl_b32 s77, s26, 10
s_add_u32 s88, s88, s77
mega_kernel_rf_pfj:
v_mov_b32 v184, 0
v_mov_b32 v185, 0
v_mov_b32 v186, 0
v_mov_b32 v187, 0
v_mov_b32 v188, 0
v_mov_b32 v189, 0
v_mov_b32 v190, 0
v_mov_b32 v191, 0
v_mov_b32 v192, 0
v_mov_b32 v193, 0
v_mov_b32 v194, 0
v_mov_b32 v195, 0
v_mov_b32 v196, 0
v_mov_b32 v197, 0
v_mov_b32 v198, 0
v_mov_b32 v199, 0
v_mov_b32 v200, 0
v_mov_b32 v201, 0
v_mov_b32 v202, 0
v_mov_b32 v203, 0
v_mov_b32 v204, 0
v_mov_b32 v205, 0
v_mov_b32 v206, 0
v_mov_b32 v207, 0
v_mov_b32 v249, 0
v_cndmask_b32 v242, -16, v10, s[42:43]
v_mov_b32 v60, 0
v_mov_b32 v61, 0
v_mov_b32 v62, 0
v_mov_b32 v63, 0
s_waitcnt lgkmcnt(0)
s_barrier
s_and_b32 s29, s27, 1
s_lshl_b32 s33, s29, 17
s_lshl_b32 s28, s30, 18
s_add_u32 s33, s33, s28
s_add_u32 s33, s33, 68157440
s_xor_b32 s34, s33, 131072
s_lshl_b32 s35, s29, 18
s_bfe_u32 s47, s27, 0x10001
s_branch mega_kernel_rf_first
.p2align 6
s_nop 0
s_nop 0
mega_kernel_rf_loop:
buffer_load_dwordx4 v[32:35], v7, s[84:87], s33 offen offset:0 sc1
v_add_u32 v5, s44, v17
ds_read_b128 v[156:159], v5 offset:0
ds_read_b128 v[160:163], v5 offset:1024
ds_read_b128 v[164:167], v5 offset:2048
ds_read_b128 v[168:171], v5 offset:3072
s_nop 4
buffer_load_dwordx4 v[36:39], v7, s[84:87], s33 offen offset:1024 sc1
s_nop 9
buffer_load_dwordx4 v[40:43], v7, s[84:87], s33 offen offset:2048 sc1
s_nop 9
buffer_load_dwordx4 v[44:47], v7, s[84:87], s33 offen offset:3072 sc1
s_waitcnt vmcnt(3)
v_max_u32 v4, v32, v34
v_cmp_eq_u32 vcc, -1, v4
s_cbranch_vccnz mega_kernel_rf_pa_15_0f
v_smfmac_f32_16x16x64_bf16 v[96:99], v[32:35], a[0:7], v6
v_smfmac_f32_16x16x64_bf16 v[100:103], v[32:35], a[32:39], v6
v_smfmac_f32_16x16x64_bf16 v[104:107], v[32:35], a[64:71], v6
s_waitcnt vmcnt(2)
v_max_u32 v4, v36, v38
v_cmp_eq_u32 vcc, -1, v4
v_smfmac_f32_16x16x64_bf16 v[108:111], v[32:35], a[96:103], v6
s_cbranch_vccnz mega_kernel_rf_pa_14_1f
v_smfmac_f32_16x16x64_bf16 v[96:99], v[36:39], a[8:15], v6
v_smfmac_f32_16x16x64_bf16 v[100:103], v[36:39], a[40:47], v6
v_smfmac_f32_16x16x64_bf16 v[104:107], v[36:39], a[72:79], v6
s_waitcnt vmcnt(1)
v_max_u32 v4, v40, v42
v_cmp_eq_u32 vcc, -1, v4
v_smfmac_f32_16x16x64_bf16 v[108:111], v[36:39], a[104:111], v6
s_cbranch_vccnz mega_kernel_rf_pa_12_2f
v_smfmac_f32_16x16x64_bf16 v[96:99], v[40:43], a[16:23], v6
v_smfmac_f32_16x16x64_bf16 v[100:103], v[40:43], a[48:55], v6
v_smfmac_f32_16x16x64_bf16 v[104:107], v[40:43], a[80:87], v6
s_waitcnt vmcnt(0)
v_max_u32 v4, v44, v46
v_cmp_eq_u32 vcc, -1, v4
v_smfmac_f32_16x16x64_bf16 v[108:111], v[40:43], a[112:119], v6
s_cbranch_vccnz mega_kernel_rf_pa_8_3f
v_smfmac_f32_16x16x64_bf16 v[96:99], v[44:47], a[24:31], v6
v_smfmac_f32_16x16x64_bf16 v[100:103], v[44:47], a[56:63], v6
v_smfmac_f32_16x16x64_bf16 v[104:107], v[44:47], a[88:95], v6
v_smfmac_f32_16x16x64_bf16 v[108:111], v[44:47], a[120:127], v6
mega_kernel_rf_pa_d:
mega_kernel_rf_adone:
s_nop 5
v_permlane32_swap_b32 v96, v100
v_permlane32_swap_b32 v97, v101
v_permlane32_swap_b32 v98, v102
v_permlane32_swap_b32 v99, v103
v_pk_add_f32 v[96:97], v[96:97], v[100:101]
v_pk_add_f32 v[98:99], v[98:99], v[102:103]
ds_write2_b32 v14, v96, v97 offset0:0 offset1:36
ds_write2_b32 v14, v98, v99 offset0:72 offset1:108
v_permlane32_swap_b32 v104, v108
v_permlane32_swap_b32 v105, v109
v_permlane32_swap_b32 v106, v110
v_permlane32_swap_b32 v107, v111
v_pk_add_f32 v[104:105], v[104:105], v[108:109]
v_pk_add_f32 v[106:107], v[106:107], v[110:111]
ds_write2_b32 v15, v104, v105 offset0:0 offset1:36
ds_write2_b32 v15, v106, v107 offset0:72 offset1:108
v_smfmac_f32_16x16x64_bf16 v[112:115], v[32:35], a[128:135], v6
v_smfmac_f32_16x16x64_bf16 v[116:119], v[32:35], a[160:167], v6
v_smfmac_f32_16x16x64_bf16 v[112:115], v[36:39], a[136:143], v6
v_smfmac_f32_16x16x64_bf16 v[116:119], v[36:39], a[168:175], v6
s_cmp_lg_u32 s24, 0
s_waitcnt lgkmcnt(0)
s_barrier
s_cbranch_scc1 mega_kernel_rf_side
ds_read_b128 v[120:123], v16 offset:0
ds_read_b128 v[124:127], v16 offset:16
ds_read_b128 v[128:131], v16 offset:2304
ds_read_b128 v[132:135], v16 offset:2320
ds_read_b128 v[136:139], v16 offset:4608
ds_read_b128 v[140:143], v16 offset:4624
ds_read_b128 v[144:147], v16 offset:6912
ds_read_b128 v[148:151], v16 offset:6928
v_smfmac_f32_16x16x64_bf16 v[112:115], v[40:43], a[144:151], v6
v_smfmac_f32_16x16x64_bf16 v[116:119], v[40:43], a[176:183], v6
v_smfmac_f32_16x16x64_bf16 v[112:115], v[44:47], a[152:159], v6
v_smfmac_f32_16x16x64_bf16 v[116:119], v[44:47], a[184:191], v6
s_mul_i32 s28, s31, 1280
s_add_u32 s28, s28, s33
s_add_u32 s28, s28, 49152
s_add_u32 s76, s37, s33
s_add_u32 s77, s38, s33
s_add_u32 s78, s39, s33
s_waitcnt lgkmcnt(4)
v_pk_add_f32 v[120:121], v[120:121], v[128:129]
v_pk_add_f32 v[122:123], v[122:123], v[130:131]
v_pk_add_f32 v[124:125], v[124:125], v[132:133]
v_pk_add_f32 v[126:127], v[126:127], v[134:135]
s_waitcnt lgkmcnt(0)
v_pk_add_f32 v[136:137], v[136:137], v[144:145]
v_pk_add_f32 v[138:139], v[138:139], v[146:147]
v_pk_add_f32 v[140:141], v[140:141], v[148:149]
v_pk_add_f32 v[142:143], v[142:143], v[150:151]
v_pk_add_f32 v[120:121], v[120:121], v[136:137]
v_pk_add_f32 v[122:123], v[122:123], v[138:139]
v_pk_add_f32 v[124:125], v[124:125], v[140:141]
v_pk_add_f32 v[126:127], v[126:127], v[142:143]
v_cvt_pk_bf16_f32 v152, v120, v121
v_cvt_pk_bf16_f32 v153, v122, v123
v_cvt_pk_bf16_f32 v154, v124, v125
v_cvt_pk_bf16_f32 v155, v126, v127
s_nop 1
v_mfma_f32_16x16x32_bf16 v[176:179], v[160:163], v[152:155], 0
v_mfma_f32_16x16x32_bf16 v[172:175], v[156:159], v[152:155], 0
v_mfma_f32_16x16x32_bf16 v[180:183], v[152:155], v[152:155], 0
s_cmp_eq_u32 s27, 63
s_cbranch_scc1 mega_kernel_rf_w0last
s_nop 4
v_mov_b32_dpp v172, v176 row_shr:8 row_mask:0xf bank_mask:0xc
v_mov_b32_dpp v173, v177 row_shr:8 row_mask:0xf bank_mask:0xc
v_mov_b32_dpp v174, v178 row_shr:8 row_mask:0xf bank_mask:0xc
v_mov_b32_dpp v175, v179 row_shr:8 row_mask:0xf bank_mask:0xc
v_min_u32 v172, -2, v172
buffer_store_dwordx4 v[172:175], v17, s[84:87], s28 offen
v_min_u32 v180, -2, v180
buffer_store_dwordx4 v[180:183], v242, s[84:87], s28 offen
v_permlane32_swap_b32 v112, v116
v_permlane32_swap_b32 v113, v117
v_permlane32_swap_b32 v114, v118
v_permlane32_swap_b32 v115, v119
v_pk_add_f32 v[112:113], v[112:113], v[116:117]
v_pk_add_f32 v[114:115], v[114:115], v[118:119]
ds_write_b128 v20, v[112:115]
s_waitcnt lgkmcnt(0)
s_barrier
v_mov_b32 v96, 0
v_mov_b32 v97, 0
v_mov_b32 v98, 0
v_mov_b32 v99, 0
v_mov_b32 v100, 0
v_mov_b32 v101, 0
v_mov_b32 v102, 0
v_mov_b32 v103, 0
v_cndmask_b32 v176, v23, v180, s[42:43]
v_cndmask_b32 v177, v23, v181, s[42:43]
v_cndmask_b32 v178, v23, v182, s[42:43]
v_cndmask_b32 v179, v23, v183, s[42:43]
s_mov_b64 exec, s[42:43]
buffer_load_dwordx4 v[188:191], v10, s[84:87], s76 offen sc1
buffer_load_dwordx4 v[196:199], v10, s[84:87], s77 offen sc1
buffer_load_dwordx4 v[204:207], v10, s[84:87], s78 offen sc1
s_mov_b64 exec, -1
buffer_load_dwordx4 v[184:187], v17, s[84:87], s76 offen sc1
buffer_load_dwordx4 v[192:195], v17, s[84:87], s77 offen sc1
buffer_load_dwordx4 v[200:203], v17, s[84:87], s78 offen sc1
v_pk_mul_f32 v[172:173], v[172:173], s[32:33] op_sel_hi:[1,0]
v_pk_mul_f32 v[174:175], v[174:175], s[32:33] op_sel_hi:[1,0]
v_pk_mul_f32 v[176:177], v[176:177], s[32:33] op_sel_hi:[1,0]
v_pk_mul_f32 v[178:179], v[178:179], s[32:33] op_sel_hi:[1,0]
s_lshl_b32 s89, s47, 31
s_or_b32 s89, s89, 0x3b39999a
s_nop 15
s_nop 1
s_mov_b64 exec, s[42:43]
buffer_load_dwordx4 v[188:191], v10, s[84:87], s76 offen sc1
buffer_load_dwordx4 v[196:199], v10, s[84:87], s77 offen sc1
buffer_load_dwordx4 v[204:207], v10, s[84:87], s78 offen sc1
s_mov_b64 exec, -1
buffer_load_dwordx4 v[184:187], v17, s[84:87], s76 offen sc1
buffer_load_dwordx4 v[192:195], v17, s[84:87], s77 offen sc1
buffer_load_dwordx4 v[200:203], v17, s[84:87], s78 offen sc1
mega_kernel_rf_p2:
s_waitcnt vmcnt(6)
v_max3_u32 v4, v184, v188, v192
v_max3_u32 v5, v196, v200, v204
v_max_u32 v4, v4, v5
v_cmp_eq_u32 vcc, -1, v4
s_cbranch_vccnz mega_kernel_rf_p2r
v_pk_add_f32 v[124:125], v[196:197], v[204:205]
v_pk_add_f32 v[126:127], v[198:199], v[206:207]
v_pk_add_f32 v[120:121], v[192:193], v[200:201]
v_pk_add_f32 v[122:123], v[194:195], v[202:203]
v_pk_add_f32 v[124:125], v[124:125], v[188:189]
v_pk_add_f32 v[126:127], v[126:127], v[190:191]
v_pk_add_f32 v[120:121], v[120:121], v[184:185]
v_pk_add_f32 v[122:123], v[122:123], v[186:187]
v_pk_fma_f32 v[176:177], v[124:125], s[32:33], v[176:177] op_sel_hi:[1,0,1]
v_pk_fma_f32 v[178:179], v[126:127], s[32:33], v[178:179] op_sel_hi:[1,0,1]
v_pk_fma_f32 v[172:173], v[120:121], s[32:33], v[172:173] op_sel_hi:[1,0,1]
v_pk_fma_f32 v[174:175], v[122:123], s[32:33], v[174:175] op_sel_hi:[1,0,1]
v_max3_f32 v232, v172, v173, v174
v_max3_f32 v233, v176, v177, v178
v_max3_f32 v232, v232, v175, v179
v_max_f32 v234, v232, v233
s_barrier
ds_read2_b64 v[208:211], v21 offset0:0 offset1:32
v_max_f32_dpp v232, v234, v234 row_ror:8 row_mask:0xf bank_mask:0xf
v_max_f32_dpp v233, v234, v234 row_ror:8 row_mask:0xf bank_mask:0xf
s_nop 1
v_permlane16_swap_b32 v232, v233
s_nop 0
v_max_f32 v234, v232, v233
v_max_f32 v235, v232, v233
s_nop 1
v_permlane32_swap_b32 v234, v235
s_nop 0
v_max_f32 v232, v234, v235
v_pk_add_f32 v[176:177], v[176:177], v[232:233] op_sel_hi:[1,0] neg_lo:[0,1] neg_hi:[0,1]
v_pk_add_f32 v[178:179], v[178:179], v[232:233] op_sel_hi:[1,0] neg_lo:[0,1] neg_hi:[0,1]
v_pk_add_f32 v[172:173], v[172:173], v[232:233] op_sel_hi:[1,0] neg_lo:[0,1] neg_hi:[0,1]
v_pk_add_f32 v[174:175], v[174:175], v[232:233] op_sel_hi:[1,0] neg_lo:[0,1] neg_hi:[0,1]
v_exp_f32 v176, v176
v_exp_f32 v177, v177
v_exp_f32 v178, v178
v_exp_f32 v179, v179
v_exp_f32 v172, v172
v_cvt_pk_bf16_f32 v216, v176, v177
v_cvt_pk_bf16_f32 v217, v178, v179
v_exp_f32 v173, v173
v_exp_f32 v174, v174
v_mfma_f32_16x16x16_bf16 v[224:227], v[220:221], v[216:217], 0
v_exp_f32 v175, v175
v_cvt_pk_bf16_f32 v212, v172, v173
s_waitcnt lgkmcnt(0)
v_mfma_f32_16x16x16_bf16 v[120:123], v[208:209], v[216:217], 0
v_cvt_pk_bf16_f32 v213, v174, v175
v_mfma_f32_16x16x16_bf16 v[124:127], v[210:211], v[216:217], 0
v_mov_b32_dpp v214, v212 row_ror:8 row_mask:0xf bank_mask:0xf
v_mov_b32_dpp v215, v213 row_ror:8 row_mask:0xf bank_mask:0xf
s_nop 1
v_mfma_f32_16x16x32_bf16 v[224:227], v[220:223], v[212:215], v[224:227]
v_mfma_f32_16x16x32_bf16 v[120:123], v[164:167], v[212:215], v[120:123]
v_mfma_f32_16x16x32_bf16 v[124:127], v[168:171], v[212:215], v[124:127]
s_add_u32 s29, s33, 24576
s_nop 4
v_rcp_f32 v234, v224
s_mov_b64 exec, s[40:41]
v_pk_mul_f32 v[120:121], v[120:121], v[234:235] op_sel_hi:[1,0]
v_pk_mul_f32 v[122:123], v[122:123], v[234:235] op_sel_hi:[1,0]
v_pk_mul_f32 v[124:125], v[124:125], v[234:235] op_sel_hi:[1,0]
v_pk_mul_f32 v[126:127], v[126:127], v[234:235] op_sel_hi:[1,0]
v_cvt_pk_bf16_f32 v212, v120, v121
v_cvt_pk_bf16_f32 v213, v122, v123
v_cvt_pk_bf16_f32 v214, v124, v125
v_cvt_pk_bf16_f32 v215, v126, v127
v_min_u32 v212, -2, v212
buffer_store_dwordx4 v[212:215], v11, s[84:87], s33 offen
s_mov_b64 exec, -1
mega_kernel_rf_b3:
s_barrier
s_nop 15
buffer_load_dwordx4 v[32:35], v7, s[84:87], s29 offen offset:0 sc1
s_nop 9
buffer_load_dwordx4 v[36:39], v7, s[84:87], s29 offen offset:1024 sc1
s_nop 9
buffer_load_dwordx4 v[40:43], v7, s[84:87], s29 offen offset:2048 sc1
s_nop 9
buffer_load_dwordx4 v[44:47], v7, s[84:87], s29 offen offset:3072 sc1
mega_kernel_rf_pc_15_0:
s_waitcnt vmcnt(3)
v_cmp_eq_u32 vcc, -1, v32
s_cbranch_vccnz mega_kernel_rf_pc_15_0f
v_smfmac_f32_16x16x64_bf16 v[96:99], v[32:35], a[192:199], v6
v_smfmac_f32_16x16x64_bf16 v[100:103], v[32:35], a[224:231], v6
mega_kernel_rf_pc_14_1:
s_waitcnt vmcnt(2)
v_cmp_eq_u32 vcc, -1, v36
s_cbranch_vccnz mega_kernel_rf_pc_14_1f
v_smfmac_f32_16x16x64_bf16 v[96:99], v[36:39], a[200:207], v6
v_smfmac_f32_16x16x64_bf16 v[100:103], v[36:39], a[232:239], v6
mega_kernel_rf_pc_12_2:
s_waitcnt vmcnt(1)
v_cmp_eq_u32 vcc, -1, v40
s_cbranch_vccnz mega_kernel_rf_pc_12_2f
v_smfmac_f32_16x16x64_bf16 v[96:99], v[40:43], a[208:215], v6
v_smfmac_f32_16x16x64_bf16 v[100:103], v[40:43], a[240:247], v6
mega_kernel_rf_pc_8_3:
s_waitcnt vmcnt(0)
v_cmp_eq_u32 vcc, -1, v44
s_cbranch_vccnz mega_kernel_rf_pc_8_3f
v_smfmac_f32_16x16x64_bf16 v[96:99], v[44:47], a[216:223], v6
v_smfmac_f32_16x16x64_bf16 v[100:103], v[44:47], a[248:255], v6
mega_kernel_rf_pc_d:
s_nop 7
v_permlane32_swap_b32 v96, v100
v_permlane32_swap_b32 v97, v101
v_permlane32_swap_b32 v98, v102
v_permlane32_swap_b32 v99, v103
v_pk_add_f32 v[96:97], v[96:97], v[100:101]
v_pk_add_f32 v[98:99], v[98:99], v[102:103]
ds_write2_b32 v18, v96, v97 offset0:0 offset1:36
ds_write2_b32 v18, v98, v99 offset0:72 offset1:108
s_cmp_lg_u32 s24, 0
s_waitcnt lgkmcnt(0)
s_barrier
s_cbranch_scc1 mega_kernel_rf_x1
ds_read_b128 v[120:123], v19 offset:0
ds_read_b128 v[124:127], v19 offset:1152
ds_read_b128 v[128:131], v19 offset:2304
ds_read_b128 v[132:135], v19 offset:3456
s_waitcnt lgkmcnt(2)
v_pk_add_f32 v[120:121], v[120:121], v[124:125]
v_pk_add_f32 v[122:123], v[122:123], v[126:127]
s_waitcnt lgkmcnt(0)
v_pk_add_f32 v[128:129], v[128:129], v[132:133]
v_pk_add_f32 v[130:131], v[130:131], v[134:135]
v_pk_add_f32 v[120:121], v[120:121], v[128:129]
v_pk_add_f32 v[122:123], v[122:123], v[130:131]
v_fma_f32 v212, v120, s89, v120
v_cvt_pk_bf16_f32 v213, v122, v123
v_cvt_pk_bf16_f32 v212, v212, v121
v_and_or_b32 v212, v212, -2, s47
buffer_store_dwordx2 v[212:213], v12, s[84:87], s35 offen sc1
s_mov_b32 s77, 0x3f80
s_mov_b32 s78, 0x3f800000
s_xor_b32 s76, s47, 1
v_mov_b32 v48, s76
v_mov_b32 v50, s76
v_mov_b32 v52, s76
s_nop 8
v_mov_b32 v96, 0
v_mov_b32 v97, 0
v_mov_b32 v98, 0
v_mov_b32 v99, 0
v_mov_b32 v100, 0
v_mov_b32 v101, 0
v_mov_b32 v102, 0
v_mov_b32 v103, 0
v_mov_b32 v104, 0
v_mov_b32 v105, 0
v_mov_b32 v106, 0
v_mov_b32 v107, 0
v_mov_b32 v108, 0
v_mov_b32 v109, 0
v_mov_b32 v110, 0
v_mov_b32 v111, 0
v_mov_b32 v112, 0
v_mov_b32 v113, 0
v_mov_b32 v114, 0
v_mov_b32 v115, 0
v_mov_b32 v116, 0
v_mov_b32 v117, 0
v_mov_b32 v118, 0
v_mov_b32 v119, 0
s_nop 15
s_nop 7
s_cmp_eq_u32 s47, 1
s_cbranch_scc1 mega_kernel_rf_p4_1
.p2align 6
mega_kernel_rf_p4_0:
buffer_load_dwordx2 v[48:49], v25, s[84:87], s35 offen sc1
buffer_load_dwordx2 v[50:51], v26, s[84:87], s35 offen sc1
buffer_load_dwordx2 v[52:53], v27, s[84:87], s35 offen sc1
s_waitcnt vmcnt(12)
mega_kernel_rf_p4c_0:
v_bitop3_b32 v4, v48, v50, v52 bitop3:0xfe
v_and_b32 v4, 1, v4
v_cmp_ne_u32 vcc, 0, v4
s_cbranch_vccnz mega_kernel_rf_p4_0
v_dot2_f32_bf16 v120, v48, s77, v120
v_dot2_f32_bf16 v121, v48, s78, v121
v_dot2_f32_bf16 v122, v49, s77, v122
v_dot2_f32_bf16 v123, v49, s78, v123
v_dot2_f32_bf16 v120, v50, s77, v120
v_dot2_f32_bf16 v121, v50, s78, v121
v_dot2_f32_bf16 v122, v51, s77, v122
v_dot2_f32_bf16 v123, v51, s78, v123
v_dot2_f32_bf16 v120, v52, s77, v120
v_dot2_f32_bf16 v121, v52, s78, v121
v_dot2_f32_bf16 v122, v53, s77, v122
v_dot2_f32_bf16 v123, v53, s78, v123
s_nop 0
v_cvt_pk_bf16_f32 v212, v120, v121
v_min_u32 v212, -2, v212
v_cvt_pk_bf16_f32 v213, v122, v123
buffer_store_dwordx2 v[212:213], v9, s[84:87], s34 offen
s_branch mega_kernel_rf_p4d
mega_kernel_rf_iw0:
mega_kernel_rf_il0:
s_cbranch_execz mega_kernel_rf_il1
.p2align 6
mega_kernel_rf_p4_1:
buffer_load_dwordx2 v[48:49], v25, s[84:87], s35 offen sc1
buffer_load_dwordx2 v[50:51], v26, s[84:87], s35 offen sc1
buffer_load_dwordx2 v[52:53], v27, s[84:87], s35 offen sc1
s_waitcnt vmcnt(12)
mega_kernel_rf_p4c_1:
v_bitop3_b32 v4, v48, v50, v52 bitop3:0x80
v_and_b32 v4, 1, v4
v_cmp_ne_u32 vcc, 1, v4
s_cbranch_vccnz mega_kernel_rf_p4_1
v_dot2_f32_bf16 v120, v48, s77, v120
v_dot2_f32_bf16 v121, v48, s78, v121
v_dot2_f32_bf16 v122, v49, s77, v122
v_dot2_f32_bf16 v123, v49, s78, v123
v_dot2_f32_bf16 v120, v50, s77, v120
v_dot2_f32_bf16 v121, v50, s78, v121
v_dot2_f32_bf16 v122, v51, s77, v122
v_dot2_f32_bf16 v123, v51, s78, v123
v_dot2_f32_bf16 v120, v52, s77, v120
v_dot2_f32_bf16 v121, v52, s78, v121
v_dot2_f32_bf16 v122, v53, s77, v122
v_dot2_f32_bf16 v123, v53, s78, v123
s_nop 0
v_cvt_pk_bf16_f32 v212, v120, v121
v_min_u32 v212, -2, v212
v_cvt_pk_bf16_f32 v213, v122, v123
buffer_store_dwordx2 v[212:213], v9, s[84:87], s34 offen
mega_kernel_rf_p4d:
mega_kernel_rf_b5:
s_add_u32 s27, s27, 1
s_add_u32 s44, s44, 4096
s_cmp_eq_u32 s44, 30720
s_cselect_b32 s44, 18432, s44
s_mov_b32 s28, s33
s_mov_b32 s33, s34
s_mov_b32 s34, s28
s_xor_b32 s35, s35, 262144
s_bfe_u32 s47, s27, 0x10001
s_barrier
s_nop 15
s_branch mega_kernel_rf_loop
mega_kernel_rf_il1:
s_cbranch_execz mega_kernel_rf_il2
mega_kernel_rf_x1:
s_cmp_eq_u32 s24, 1
s_cbranch_scc0 mega_kernel_rf_x2
s_add_u32 s76, s27, 1
s_sleep 6
v_mov_b32 v5, s76
s_mov_b64 exec, 1
buffer_store_dword v5, v228, s[84:87], s81 offen sc1
s_mov_b64 exec, -1
mega_kernel_rf_x2:
s_cmp_eq_u32 s24, 3
s_cbranch_scc0 mega_kernel_rf_x4
s_cmp_eq_u32 s36, 1
s_cbranch_scc0 mega_kernel_rf_x5
s_add_u32 s76, s27, 1
s_cmp_gt_i32 s46, s76
s_cbranch_scc1 mega_kernel_rf_pf1ok
mega_kernel_rf_pf1w:
v_mov_b32 v4, 0
s_mov_b64 exec, 3
buffer_atomic_add v4, v24, s[84:87], 0 offen sc0 sc1
s_mov_b64 exec, -1
s_waitcnt vmcnt(0)
v_readlane_b32 s46, v4, 0
v_readlane_b32 s28, v4, 1
s_nop 1
s_min_i32 s46, s46, s28
s_cmp_gt_i32 s46, s76
s_cbranch_scc0 mega_kernel_rf_pf1w
mega_kernel_rf_pf1ok:
s_add_u32 s77, s76, s82
s_bfe_u32 s28, s77, 0x40002
s_lshl_b32 s28, s28, 14
s_and_b32 s77, s77, 3
s_lshl_b32 s77, s77, 11
s_add_u32 s28, s28, s77
s_add_u32 m0, s45, 0
s_nop 0
buffer_load_dwordx4 v240, s[84:87], s28 offen offset:0 sc1 lds
s_add_u32 m0, s45, 0
s_nop 0
buffer_load_dwordx4 v240, s[84:87], s28 offen offset:1024 sc1 lds
s_add_u32 m0, s45, 2048
s_nop 0
buffer_load_dwordx4 v241, s[84:87], s28 offen offset:0 sc1 lds
s_add_u32 m0, s45, 2048
s_nop 0
buffer_load_dwordx4 v241, s[84:87], s28 offen offset:1024 sc1 lds
s_add_u32 s45, s45, 4096
s_cmp_eq_u32 s45, 30720
s_cselect_b32 s45, 18432, s45
s_waitcnt vmcnt(0)
mega_kernel_rf_x5:
s_add_u32 s76, s27, 4
s_min_u32 s76, s76, 63
s_cmp_gt_i32 s46, s76
s_cbranch_scc1 mega_kernel_rf_x6
v_mov_b32 v249, 0
s_mov_b64 exec, 3
buffer_atomic_add v249, v24, s[84:87], 0 offen sc0 sc1
s_mov_b64 exec, -1
mega_kernel_rf_x6:
s_add_u32 s76, s27, 2
s_cmp_lt_u32 s76, 63
s_cbranch_scc0 mega_kernel_rf_x4
s_cmp_gt_i32 s46, s76
s_cbranch_scc0 mega_kernel_rf_x4
s_add_u32 s77, s76, s82
s_bfe_u32 s28, s77, 0x40002
s_lshl_b32 s28, s28, 14
s_and_b32 s77, s77, 3
s_lshl_b32 s77, s77, 11
s_add_u32 s28, s28, s77
s_add_u32 s28, s28, s83
s_add_u32 s28, s28, 33554432
s_buffer_load_dword s78, s[84:87], s28 offset:0
s_buffer_load_dword s78, s[84:87], s28 offset:128
s_buffer_load_dword s78, s[84:87], s28 offset:256
s_buffer_load_dword s78, s[84:87], s28 offset:384
s_buffer_load_dword s78, s[84:87], s28 offset:512
s_buffer_load_dword s78, s[84:87], s28 offset:640
s_buffer_load_dword s78, s[84:87], s28 offset:768
s_buffer_load_dword s78, s[84:87], s28 offset:896
s_buffer_load_dword s78, s[84:87], s28 offset:1024
s_buffer_load_dword s78, s[84:87], s28 offset:1152
s_buffer_load_dword s78, s[84:87], s28 offset:1280
s_buffer_load_dword s78, s[84:87], s28 offset:1408
s_buffer_load_dword s78, s[84:87], s28 offset:1536
s_buffer_load_dword s78, s[84:87], s28 offset:1664
s_buffer_load_dword s78, s[84:87], s28 offset:1792
s_buffer_load_dword s78, s[84:87], s28 offset:1920
mega_kernel_rf_x4:
v_mov_b32 v96, 0
v_mov_b32 v97, 0
v_mov_b32 v98, 0
v_mov_b32 v99, 0
v_mov_b32 v100, 0
v_mov_b32 v101, 0
v_mov_b32 v102, 0
v_mov_b32 v103, 0
v_mov_b32 v104, 0
v_mov_b32 v105, 0
v_mov_b32 v106, 0
v_mov_b32 v107, 0
v_mov_b32 v108, 0
v_mov_b32 v109, 0
v_mov_b32 v110, 0
v_mov_b32 v111, 0
v_mov_b32 v112, 0
v_mov_b32 v113, 0
v_mov_b32 v114, 0
v_mov_b32 v115, 0
v_mov_b32 v116, 0
v_mov_b32 v117, 0
v_mov_b32 v118, 0
v_mov_b32 v119, 0
s_branch mega_kernel_rf_b5
mega_kernel_rf_il2:
s_cbranch_execz mega_kernel_rf_il3
mega_kernel_rf_p2r:
s_mov_b64 exec, s[42:43]
buffer_load_dwordx4 v[188:191], v10, s[84:87], s76 offen sc1
buffer_load_dwordx4 v[196:199], v10, s[84:87], s77 offen sc1
buffer_load_dwordx4 v[204:207], v10, s[84:87], s78 offen sc1
s_mov_b64 exec, -1
buffer_load_dwordx4 v[184:187], v17, s[84:87], s76 offen sc1
buffer_load_dwordx4 v[192:195], v17, s[84:87], s77 offen sc1
buffer_load_dwordx4 v[200:203], v17, s[84:87], s78 offen sc1
s_branch mega_kernel_rf_p2
mega_kernel_rf_il3:
s_cbranch_execz mega_kernel_rf_il4
.p2align 5
mega_kernel_rf_pa_1_0f:
s_mov_b64 exec, vcc
buffer_load_dwordx4 v[32:35], v7, s[84:87], s33 offen offset:0 sc1
s_mov_b64 exec, -1
s_branch mega_kernel_rf_pa_1_0
.p2align 5
mega_kernel_rf_pa_1_0:
s_waitcnt vmcnt(0)
v_max_u32 v4, v32, v34
v_cmp_eq_u32 vcc, -1, v4
s_cbranch_vccnz mega_kernel_rf_pa_1_0f
v_smfmac_f32_16x16x64_bf16 v[96:99], v[32:35], a[0:7], v6
v_smfmac_f32_16x16x64_bf16 v[100:103], v[32:35], a[32:39], v6
v_smfmac_f32_16x16x64_bf16 v[104:107], v[32:35], a[64:71], v6
v_smfmac_f32_16x16x64_bf16 v[108:111], v[32:35], a[96:103], v6
s_branch mega_kernel_rf_pa_d
mega_kernel_rf_il4:
s_cbranch_execz mega_kernel_rf_il5
.p2align 5
mega_kernel_rf_pa_2_1f:
s_mov_b64 exec, vcc
buffer_load_dwordx4 v[36:39], v7, s[84:87], s33 offen offset:1024 sc1
s_mov_b64 exec, -1
s_branch mega_kernel_rf_pa_2_1
.p2align 5
mega_kernel_rf_pa_2_1:
s_waitcnt vmcnt(0)
v_max_u32 v4, v36, v38
v_cmp_eq_u32 vcc, -1, v4
s_cbranch_vccnz mega_kernel_rf_pa_2_1f
v_smfmac_f32_16x16x64_bf16 v[96:99], v[36:39], a[8:15], v6
v_smfmac_f32_16x16x64_bf16 v[100:103], v[36:39], a[40:47], v6
v_smfmac_f32_16x16x64_bf16 v[104:107], v[36:39], a[72:79], v6
v_smfmac_f32_16x16x64_bf16 v[108:111], v[36:39], a[104:111], v6
s_branch mega_kernel_rf_pa_d
mega_kernel_rf_il5:
s_cbranch_execz mega_kernel_rf_il6
.p2align 5
mega_kernel_rf_pa_3_0f:
s_mov_b64 exec, vcc
buffer_load_dwordx4 v[32:35], v7, s[84:87], s33 offen offset:0 sc1
s_mov_b64 exec, -1
s_branch mega_kernel_rf_pa_3_1
.p2align 5
mega_kernel_rf_pa_3_0:
s_waitcnt vmcnt(1)
v_max_u32 v4, v32, v34
v_cmp_eq_u32 vcc, -1, v4
s_cbranch_vccnz mega_kernel_rf_pa_3_0f
v_smfmac_f32_16x16x64_bf16 v[96:99], v[32:35], a[0:7], v6
v_smfmac_f32_16x16x64_bf16 v[100:103], v[32:35], a[32:39], v6
v_smfmac_f32_16x16x64_bf16 v[104:107], v[32:35], a[64:71], v6
v_smfmac_f32_16x16x64_bf16 v[108:111], v[32:35], a[96:103], v6
s_branch mega_kernel_rf_pa_2_1
mega_kernel_rf_il6:
s_cbranch_execz mega_kernel_rf_il7
.p2align 5
mega_kernel_rf_pa_3_1f:
s_mov_b64 exec, vcc
buffer_load_dwordx4 v[36:39], v7, s[84:87], s33 offen offset:1024 sc1
s_mov_b64 exec, -1
s_branch mega_kernel_rf_pa_3_0
.p2align 5
mega_kernel_rf_pa_3_1:
s_waitcnt vmcnt(1)
v_max_u32 v4, v36, v38
v_cmp_eq_u32 vcc, -1, v4
s_cbranch_vccnz mega_kernel_rf_pa_3_1f
v_smfmac_f32_16x16x64_bf16 v[96:99], v[36:39], a[8:15], v6
v_smfmac_f32_16x16x64_bf16 v[100:103], v[36:39], a[40:47], v6
v_smfmac_f32_16x16x64_bf16 v[104:107], v[36:39], a[72:79], v6
v_smfmac_f32_16x16x64_bf16 v[108:111], v[36:39], a[104:111], v6
s_branch mega_kernel_rf_pa_1_0
mega_kernel_rf_il7:
s_cbranch_execz mega_kernel_rf_il8
.p2align 5
mega_kernel_rf_pa_4_2f:
s_mov_b64 exec, vcc
buffer_load_dwordx4 v[40:43], v7, s[84:87], s33 offen offset:2048 sc1
s_mov_b64 exec, -1
s_branch mega_kernel_rf_pa_4_2
.p2align 5
mega_kernel_rf_pa_4_2:
s_waitcnt vmcnt(0)
v_max_u32 v4, v40, v42
v_cmp_eq_u32 vcc, -1, v4
s_cbranch_vccnz mega_kernel_rf_pa_4_2f
v_smfmac_f32_16x16x64_bf16 v[96:99], v[40:43], a[16:23], v6
v_smfmac_f32_16x16x64_bf16 v[100:103], v[40:43], a[48:55], v6
v_smfmac_f32_16x16x64_bf16 v[104:107], v[40:43], a[80:87], v6
v_smfmac_f32_16x16x64_bf16 v[108:111], v[40:43], a[112:119], v6
s_branch mega_kernel_rf_pa_d
mega_kernel_rf_il8:
s_cbranch_execz mega_kernel_rf_il9
.p2align 5
mega_kernel_rf_pa_5_0f:
s_mov_b64 exec, vcc
buffer_load_dwordx4 v[32:35], v7, s[84:87], s33 offen offset:0 sc1
s_mov_b64 exec, -1
s_branch mega_kernel_rf_pa_5_2
.p2align 5
mega_kernel_rf_pa_5_0:
s_waitcnt vmcnt(1)
v_max_u32 v4, v32, v34
v_cmp_eq_u32 vcc, -1, v4
s_cbranch_vccnz mega_kernel_rf_pa_5_0f
v_smfmac_f32_16x16x64_bf16 v[96:99], v[32:35], a[0:7], v6
v_smfmac_f32_16x16x64_bf16 v[100:103], v[32:35], a[32:39], v6
v_smfmac_f32_16x16x64_bf16 v[104:107], v[32:35], a[64:71], v6
v_smfmac_f32_16x16x64_bf16 v[108:111], v[32:35], a[96:103], v6
s_branch mega_kernel_rf_pa_4_2
mega_kernel_rf_il9:
s_cbranch_execz mega_kernel_rf_il10
.p2align 5
mega_kernel_rf_pa_5_2f:
s_mov_b64 exec, vcc
buffer_load_dwordx4 v[40:43], v7, s[84:87], s33 offen offset:2048 sc1
s_mov_b64 exec, -1
s_branch mega_kernel_rf_pa_5_0
.p2align 5
mega_kernel_rf_pa_5_2:
s_waitcnt vmcnt(1)
v_max_u32 v4, v40, v42
v_cmp_eq_u32 vcc, -1, v4
s_cbranch_vccnz mega_kernel_rf_pa_5_2f
v_smfmac_f32_16x16x64_bf16 v[96:99], v[40:43], a[16:23], v6
v_smfmac_f32_16x16x64_bf16 v[100:103], v[40:43], a[48:55], v6
v_smfmac_f32_16x16x64_bf16 v[104:107], v[40:43], a[80:87], v6
v_smfmac_f32_16x16x64_bf16 v[108:111], v[40:43], a[112:119], v6
s_branch mega_kernel_rf_pa_1_0
mega_kernel_rf_il10:
s_cbranch_execz mega_kernel_rf_il11
.p2align 5
mega_kernel_rf_pa_6_1f:
s_mov_b64 exec, vcc
buffer_load_dwordx4 v[36:39], v7, s[84:87], s33 offen offset:1024 sc1
s_mov_b64 exec, -1
s_branch mega_kernel_rf_pa_6_2
.p2align 5
mega_kernel_rf_pa_6_1:
s_waitcnt vmcnt(1)
v_max_u32 v4, v36, v38
v_cmp_eq_u32 vcc, -1, v4
s_cbranch_vccnz mega_kernel_rf_pa_6_1f
v_smfmac_f32_16x16x64_bf16 v[96:99], v[36:39], a[8:15], v6
v_smfmac_f32_16x16x64_bf16 v[100:103], v[36:39], a[40:47], v6
v_smfmac_f32_16x16x64_bf16 v[104:107], v[36:39], a[72:79], v6
v_smfmac_f32_16x16x64_bf16 v[108:111], v[36:39], a[104:111], v6
s_branch mega_kernel_rf_pa_4_2
mega_kernel_rf_il11:
s_cbranch_execz mega_kernel_rf_il12
.p2align 5
mega_kernel_rf_pa_6_2f:
s_mov_b64 exec, vcc
buffer_load_dwordx4 v[40:43], v7, s[84:87], s33 offen offset:2048 sc1
s_mov_b64 exec, -1
s_branch mega_kernel_rf_pa_6_1
.p2align 5
mega_kernel_rf_pa_6_2:
s_waitcnt vmcnt(1)
v_max_u32 v4, v40, v42
v_cmp_eq_u32 vcc, -1, v4
s_cbranch_vccnz mega_kernel_rf_pa_6_2f
v_smfmac_f32_16x16x64_bf16 v[96:99], v[40:43], a[16:23], v6
v_smfmac_f32_16x16x64_bf16 v[100:103], v[40:43], a[48:55], v6
v_smfmac_f32_16x16x64_bf16 v[104:107], v[40:43], a[80:87], v6
v_smfmac_f32_16x16x64_bf16 v[108:111], v[40:43], a[112:119], v6
s_branch mega_kernel_rf_pa_2_1
mega_kernel_rf_il12:
s_cbranch_execz mega_kernel_rf_il13
.p2align 5
mega_kernel_rf_pa_7_0f:
s_mov_b64 exec, vcc
buffer_load_dwordx4 v[32:35], v7, s[84:87], s33 offen offset:0 sc1
s_mov_b64 exec, -1
s_branch mega_kernel_rf_pa_7_1
.p2align 5
mega_kernel_rf_pa_7_0:
s_waitcnt vmcnt(2)
v_max_u32 v4, v32, v34
v_cmp_eq_u32 vcc, -1, v4
s_cbranch_vccnz mega_kernel_rf_pa_7_0f
v_smfmac_f32_16x16x64_bf16 v[96:99], v[32:35], a[0:7], v6
v_smfmac_f32_16x16x64_bf16 v[100:103], v[32:35], a[32:39], v6
v_smfmac_f32_16x16x64_bf16 v[104:107], v[32:35], a[64:71], v6
v_smfmac_f32_16x16x64_bf16 v[108:111], v[32:35], a[96:103], v6
s_branch mega_kernel_rf_pa_6_1
mega_kernel_rf_il13:
s_cbranch_execz mega_kernel_rf_il14
.p2align 5
mega_kernel_rf_pa_7_1f:
s_mov_b64 exec, vcc
buffer_load_dwordx4 v[36:39], v7, s[84:87], s33 offen offset:1024 sc1
s_mov_b64 exec, -1
s_branch mega_kernel_rf_pa_7_2
.p2align 5
mega_kernel_rf_pa_7_1:
s_waitcnt vmcnt(2)
v_max_u32 v4, v36, v38
v_cmp_eq_u32 vcc, -1, v4
s_cbranch_vccnz mega_kernel_rf_pa_7_1f
v_smfmac_f32_16x16x64_bf16 v[96:99], v[36:39], a[8:15], v6
v_smfmac_f32_16x16x64_bf16 v[100:103], v[36:39], a[40:47], v6
v_smfmac_f32_16x16x64_bf16 v[104:107], v[36:39], a[72:79], v6
v_smfmac_f32_16x16x64_bf16 v[108:111], v[36:39], a[104:111], v6
s_branch mega_kernel_rf_pa_5_2
mega_kernel_rf_il14:
s_cbranch_execz mega_kernel_rf_il15
.p2align 5
mega_kernel_rf_pa_7_2f:
s_mov_b64 exec, vcc
buffer_load_dwordx4 v[40:43], v7, s[84:87], s33 offen offset:2048 sc1
s_mov_b64 exec, -1
s_branch mega_kernel_rf_pa_7_0
.p2align 5
mega_kernel_rf_pa_7_2:
s_waitcnt vmcnt(2)
v_max_u32 v4, v40, v42
v_cmp_eq_u32 vcc, -1, v4
s_cbranch_vccnz mega_kernel_rf_pa_7_2f
v_smfmac_f32_16x16x64_bf16 v[96:99], v[40:43], a[16:23], v6
v_smfmac_f32_16x16x64_bf16 v[100:103], v[40:43], a[48:55], v6
v_smfmac_f32_16x16x64_bf16 v[104:107], v[40:43], a[80:87], v6
v_smfmac_f32_16x16x64_bf16 v[108:111], v[40:43], a[112:119], v6
s_branch mega_kernel_rf_pa_3_0
mega_kernel_rf_il15:
s_cbranch_execz mega_kernel_rf_il16
.p2align 5
mega_kernel_rf_pa_8_3f:
s_mov_b64 exec, vcc
buffer_load_dwordx4 v[44:47], v7, s[84:87], s33 offen offset:3072 sc1
s_mov_b64 exec, -1
s_branch mega_kernel_rf_pa_8_3
.p2align 5
mega_kernel_rf_pa_8_3:
s_waitcnt vmcnt(0)
v_max_u32 v4, v44, v46
v_cmp_eq_u32 vcc, -1, v4
s_cbranch_vccnz mega_kernel_rf_pa_8_3f
v_smfmac_f32_16x16x64_bf16 v[96:99], v[44:47], a[24:31], v6
v_smfmac_f32_16x16x64_bf16 v[100:103], v[44:47], a[56:63], v6
v_smfmac_f32_16x16x64_bf16 v[104:107], v[44:47], a[88:95], v6
v_smfmac_f32_16x16x64_bf16 v[108:111], v[44:47], a[120:127], v6
s_branch mega_kernel_rf_pa_d
mega_kernel_rf_il16:
s_cbranch_execz mega_kernel_rf_il17
.p2align 5
mega_kernel_rf_pa_9_0f:
s_mov_b64 exec, vcc
buffer_load_dwordx4 v[32:35], v7, s[84:87], s33 offen offset:0 sc1
s_mov_b64 exec, -1
s_branch mega_kernel_rf_pa_9_3
.p2align 5
mega_kernel_rf_pa_9_0:
s_waitcnt vmcnt(1)
v_max_u32 v4, v32, v34
v_cmp_eq_u32 vcc, -1, v4
s_cbranch_vccnz mega_kernel_rf_pa_9_0f
v_smfmac_f32_16x16x64_bf16 v[96:99], v[32:35], a[0:7], v6
v_smfmac_f32_16x16x64_bf16 v[100:103], v[32:35], a[32:39], v6
v_smfmac_f32_16x16x64_bf16 v[104:107], v[32:35], a[64:71], v6
v_smfmac_f32_16x16x64_bf16 v[108:111], v[32:35], a[96:103], v6
s_branch mega_kernel_rf_pa_8_3
mega_kernel_rf_il17:
s_cbranch_execz mega_kernel_rf_il18
.p2align 5
mega_kernel_rf_pa_9_3f:
s_mov_b64 exec, vcc
buffer_load_dwordx4 v[44:47], v7, s[84:87], s33 offen offset:3072 sc1
s_mov_b64 exec, -1
s_branch mega_kernel_rf_pa_9_0
.p2align 5
mega_kernel_rf_pa_9_3:
s_waitcnt vmcnt(1)
v_max_u32 v4, v44, v46
v_cmp_eq_u32 vcc, -1, v4
s_cbranch_vccnz mega_kernel_rf_pa_9_3f
v_smfmac_f32_16x16x64_bf16 v[96:99], v[44:47], a[24:31], v6
v_smfmac_f32_16x16x64_bf16 v[100:103], v[44:47], a[56:63], v6
v_smfmac_f32_16x16x64_bf16 v[104:107], v[44:47], a[88:95], v6
v_smfmac_f32_16x16x64_bf16 v[108:111], v[44:47], a[120:127], v6
s_branch mega_kernel_rf_pa_1_0
mega_kernel_rf_il18:
s_cbranch_execz mega_kernel_rf_iwd
.p2align 5
mega_kernel_rf_pa_10_1f:
s_mov_b64 exec, vcc
buffer_load_dwordx4 v[36:39], v7, s[84:87], s33 offen offset:1024 sc1
s_mov_b64 exec, -1
s_branch mega_kernel_rf_pa_10_3
.p2align 5
mega_kernel_rf_pa_10_1:
s_waitcnt vmcnt(1)
v_max_u32 v4, v36, v38
v_cmp_eq_u32 vcc, -1, v4
s_cbranch_vccnz mega_kernel_rf_pa_10_1f
v_smfmac_f32_16x16x64_bf16 v[96:99], v[36:39], a[8:15], v6
v_smfmac_f32_16x16x64_bf16 v[100:103], v[36:39], a[40:47], v6
v_smfmac_f32_16x16x64_bf16 v[104:107], v[36:39], a[72:79], v6
v_smfmac_f32_16x16x64_bf16 v[108:111], v[36:39], a[104:111], v6
s_branch mega_kernel_rf_pa_8_3
mega_kernel_rf_iw1:
mega_kernel_rf_il19:
s_cbranch_execz mega_kernel_rf_il20
.p2align 5
mega_kernel_rf_pa_10_3f:
s_mov_b64 exec, vcc
buffer_load_dwordx4 v[44:47], v7, s[84:87], s33 offen offset:3072 sc1
s_mov_b64 exec, -1
s_branch mega_kernel_rf_pa_10_1
.p2align 5
mega_kernel_rf_pa_10_3:
s_waitcnt vmcnt(1)
v_max_u32 v4, v44, v46
v_cmp_eq_u32 vcc, -1, v4
s_cbranch_vccnz mega_kernel_rf_pa_10_3f
v_smfmac_f32_16x16x64_bf16 v[96:99], v[44:47], a[24:31], v6
v_smfmac_f32_16x16x64_bf16 v[100:103], v[44:47], a[56:63], v6
v_smfmac_f32_16x16x64_bf16 v[104:107], v[44:47], a[88:95], v6
v_smfmac_f32_16x16x64_bf16 v[108:111], v[44:47], a[120:127], v6
s_branch mega_kernel_rf_pa_2_1
mega_kernel_rf_il20:
s_cbranch_execz mega_kernel_rf_il21
.p2align 5
mega_kernel_rf_pa_11_0f:
s_mov_b64 exec, vcc
buffer_load_dwordx4 v[32:35], v7, s[84:87], s33 offen offset:0 sc1
s_mov_b64 exec, -1
s_branch mega_kernel_rf_pa_11_1
.p2align 5
mega_kernel_rf_pa_11_0:
s_waitcnt vmcnt(2)
v_max_u32 v4, v32, v34
v_cmp_eq_u32 vcc, -1, v4
s_cbranch_vccnz mega_kernel_rf_pa_11_0f
v_smfmac_f32_16x16x64_bf16 v[96:99], v[32:35], a[0:7], v6
v_smfmac_f32_16x16x64_bf16 v[100:103], v[32:35], a[32:39], v6
v_smfmac_f32_16x16x64_bf16 v[104:107], v[32:35], a[64:71], v6
v_smfmac_f32_16x16x64_bf16 v[108:111], v[32:35], a[96:103], v6
s_branch mega_kernel_rf_pa_10_1
mega_kernel_rf_il21:
s_cbranch_execz mega_kernel_rf_il22
.p2align 5
mega_kernel_rf_pa_11_1f:
s_mov_b64 exec, vcc
buffer_load_dwordx4 v[36:39], v7, s[84:87], s33 offen offset:1024 sc1
s_mov_b64 exec, -1
s_branch mega_kernel_rf_pa_11_3
.p2align 5
mega_kernel_rf_pa_11_1:
s_waitcnt vmcnt(2)
v_max_u32 v4, v36, v38
v_cmp_eq_u32 vcc, -1, v4
s_cbranch_vccnz mega_kernel_rf_pa_11_1f
v_smfmac_f32_16x16x64_bf16 v[96:99], v[36:39], a[8:15], v6
v_smfmac_f32_16x16x64_bf16 v[100:103], v[36:39], a[40:47], v6
v_smfmac_f32_16x16x64_bf16 v[104:107], v[36:39], a[72:79], v6
v_smfmac_f32_16x16x64_bf16 v[108:111], v[36:39], a[104:111], v6
s_branch mega_kernel_rf_pa_9_3
mega_kernel_rf_il22:
s_cbranch_execz mega_kernel_rf_il23
.p2align 5
mega_kernel_rf_pa_11_3f:
s_mov_b64 exec, vcc
buffer_load_dwordx4 v[44:47], v7, s[84:87], s33 offen offset:3072 sc1
s_mov_b64 exec, -1
s_branch mega_kernel_rf_pa_11_0
.p2align 5
mega_kernel_rf_pa_11_3:
s_waitcnt vmcnt(2)
v_max_u32 v4, v44, v46
v_cmp_eq_u32 vcc, -1, v4
s_cbranch_vccnz mega_kernel_rf_pa_11_3f
v_smfmac_f32_16x16x64_bf16 v[96:99], v[44:47], a[24:31], v6
v_smfmac_f32_16x16x64_bf16 v[100:103], v[44:47], a[56:63], v6
v_smfmac_f32_16x16x64_bf16 v[104:107], v[44:47], a[88:95], v6
v_smfmac_f32_16x16x64_bf16 v[108:111], v[44:47], a[120:127], v6
s_branch mega_kernel_rf_pa_3_0
mega_kernel_rf_il23:
s_cbranch_execz mega_kernel_rf_il24
.p2align 5
mega_kernel_rf_pa_12_2f:
s_mov_b64 exec, vcc
buffer_load_dwordx4 v[40:43], v7, s[84:87], s33 offen offset:2048 sc1
s_mov_b64 exec, -1
s_branch mega_kernel_rf_pa_12_3
.p2align 5
mega_kernel_rf_pa_12_2:
s_waitcnt vmcnt(1)
v_max_u32 v4, v40, v42
v_cmp_eq_u32 vcc, -1, v4
s_cbranch_vccnz mega_kernel_rf_pa_12_2f
v_smfmac_f32_16x16x64_bf16 v[96:99], v[40:43], a[16:23], v6
v_smfmac_f32_16x16x64_bf16 v[100:103], v[40:43], a[48:55], v6
v_smfmac_f32_16x16x64_bf16 v[104:107], v[40:43], a[80:87], v6
v_smfmac_f32_16x16x64_bf16 v[108:111], v[40:43], a[112:119], v6
s_branch mega_kernel_rf_pa_8_3
mega_kernel_rf_il24:
s_cbranch_execz mega_kernel_rf_il25
.p2align 5
mega_kernel_rf_pa_12_3f:
s_mov_b64 exec, vcc
buffer_load_dwordx4 v[44:47], v7, s[84:87], s33 offen offset:3072 sc1
s_mov_b64 exec, -1
s_branch mega_kernel_rf_pa_12_2
.p2align 5
mega_kernel_rf_pa_12_3:
s_waitcnt vmcnt(1)
v_max_u32 v4, v44, v46
v_cmp_eq_u32 vcc, -1, v4
s_cbranch_vccnz mega_kernel_rf_pa_12_3f
v_smfmac_f32_16x16x64_bf16 v[96:99], v[44:47], a[24:31], v6
v_smfmac_f32_16x16x64_bf16 v[100:103], v[44:47], a[56:63], v6
v_smfmac_f32_16x16x64_bf16 v[104:107], v[44:47], a[88:95], v6
v_smfmac_f32_16x16x64_bf16 v[108:111], v[44:47], a[120:127], v6
s_branch mega_kernel_rf_pa_4_2
mega_kernel_rf_il25:
s_cbranch_execz mega_kernel_rf_il26
.p2align 5
mega_kernel_rf_pa_13_0f:
s_mov_b64 exec, vcc
buffer_load_dwordx4 v[32:35], v7, s[84:87], s33 offen offset:0 sc1
s_mov_b64 exec, -1
s_branch mega_kernel_rf_pa_13_2
.p2align 5
mega_kernel_rf_pa_13_0:
s_waitcnt vmcnt(2)
v_max_u32 v4, v32, v34
v_cmp_eq_u32 vcc, -1, v4
s_cbranch_vccnz mega_kernel_rf_pa_13_0f
v_smfmac_f32_16x16x64_bf16 v[96:99], v[32:35], a[0:7], v6
v_smfmac_f32_16x16x64_bf16 v[100:103], v[32:35], a[32:39], v6
v_smfmac_f32_16x16x64_bf16 v[104:107], v[32:35], a[64:71], v6
v_smfmac_f32_16x16x64_bf16 v[108:111], v[32:35], a[96:103], v6
s_branch mega_kernel_rf_pa_12_2
mega_kernel_rf_il26:
s_cbranch_execz mega_kernel_rf_il27
.p2align 5
mega_kernel_rf_pa_13_2f:
s_mov_b64 exec, vcc
buffer_load_dwordx4 v[40:43], v7, s[84:87], s33 offen offset:2048 sc1
s_mov_b64 exec, -1
s_branch mega_kernel_rf_pa_13_3
.p2align 5
mega_kernel_rf_pa_13_2:
s_waitcnt vmcnt(2)
v_max_u32 v4, v40, v42
v_cmp_eq_u32 vcc, -1, v4
s_cbranch_vccnz mega_kernel_rf_pa_13_2f
v_smfmac_f32_16x16x64_bf16 v[96:99], v[40:43], a[16:23], v6
v_smfmac_f32_16x16x64_bf16 v[100:103], v[40:43], a[48:55], v6
v_smfmac_f32_16x16x64_bf16 v[104:107], v[40:43], a[80:87], v6
v_smfmac_f32_16x16x64_bf16 v[108:111], v[40:43], a[112:119], v6
s_branch mega_kernel_rf_pa_9_3
mega_kernel_rf_il27:
s_cbranch_execz mega_kernel_rf_il28
.p2align 5
mega_kernel_rf_pa_13_3f:
s_mov_b64 exec, vcc
buffer_load_dwordx4 v[44:47], v7, s[84:87], s33 offen offset:3072 sc1
s_mov_b64 exec, -1
s_branch mega_kernel_rf_pa_13_0
.p2align 5
mega_kernel_rf_pa_13_3:
s_waitcnt vmcnt(2)
v_max_u32 v4, v44, v46
v_cmp_eq_u32 vcc, -1, v4
s_cbranch_vccnz mega_kernel_rf_pa_13_3f
v_smfmac_f32_16x16x64_bf16 v[96:99], v[44:47], a[24:31], v6
v_smfmac_f32_16x16x64_bf16 v[100:103], v[44:47], a[56:63], v6
v_smfmac_f32_16x16x64_bf16 v[104:107], v[44:47], a[88:95], v6
v_smfmac_f32_16x16x64_bf16 v[108:111], v[44:47], a[120:127], v6
s_branch mega_kernel_rf_pa_5_0
mega_kernel_rf_il28:
s_cbranch_execz mega_kernel_rf_il29
.p2align 5
mega_kernel_rf_pa_14_1f:
s_mov_b64 exec, vcc
buffer_load_dwordx4 v[36:39], v7, s[84:87], s33 offen offset:1024 sc1
s_mov_b64 exec, -1
s_branch mega_kernel_rf_pa_14_2
.p2align 5
mega_kernel_rf_pa_14_1:
s_waitcnt vmcnt(2)
v_max_u32 v4, v36, v38
v_cmp_eq_u32 vcc, -1, v4
s_cbranch_vccnz mega_kernel_rf_pa_14_1f
v_smfmac_f32_16x16x64_bf16 v[96:99], v[36:39], a[8:15], v6
v_smfmac_f32_16x16x64_bf16 v[100:103], v[36:39], a[40:47], v6
v_smfmac_f32_16x16x64_bf16 v[104:107], v[36:39], a[72:79], v6
v_smfmac_f32_16x16x64_bf16 v[108:111], v[36:39], a[104:111], v6
s_branch mega_kernel_rf_pa_12_2
mega_kernel_rf_il29:
s_cbranch_execz mega_kernel_rf_il30
.p2align 5
mega_kernel_rf_pa_14_2f:
s_mov_b64 exec, vcc
buffer_load_dwordx4 v[40:43], v7, s[84:87], s33 offen offset:2048 sc1
s_mov_b64 exec, -1
s_branch mega_kernel_rf_pa_14_3
.p2align 5
mega_kernel_rf_pa_14_2:
s_waitcnt vmcnt(2)
v_max_u32 v4, v40, v42
v_cmp_eq_u32 vcc, -1, v4
s_cbranch_vccnz mega_kernel_rf_pa_14_2f
v_smfmac_f32_16x16x64_bf16 v[96:99], v[40:43], a[16:23], v6
v_smfmac_f32_16x16x64_bf16 v[100:103], v[40:43], a[48:55], v6
v_smfmac_f32_16x16x64_bf16 v[104:107], v[40:43], a[80:87], v6
v_smfmac_f32_16x16x64_bf16 v[108:111], v[40:43], a[112:119], v6
s_branch mega_kernel_rf_pa_10_3
mega_kernel_rf_il30:
s_cbranch_execz mega_kernel_rf_il31
.p2align 5
mega_kernel_rf_pa_14_3f:
s_mov_b64 exec, vcc
buffer_load_dwordx4 v[44:47], v7, s[84:87], s33 offen offset:3072 sc1
s_mov_b64 exec, -1
s_branch mega_kernel_rf_pa_14_1
.p2align 5
mega_kernel_rf_pa_14_3:
s_waitcnt vmcnt(2)
v_max_u32 v4, v44, v46
v_cmp_eq_u32 vcc, -1, v4
s_cbranch_vccnz mega_kernel_rf_pa_14_3f
v_smfmac_f32_16x16x64_bf16 v[96:99], v[44:47], a[24:31], v6
v_smfmac_f32_16x16x64_bf16 v[100:103], v[44:47], a[56:63], v6
v_smfmac_f32_16x16x64_bf16 v[104:107], v[44:47], a[88:95], v6
v_smfmac_f32_16x16x64_bf16 v[108:111], v[44:47], a[120:127], v6
s_branch mega_kernel_rf_pa_6_1
mega_kernel_rf_il31:
s_cbranch_execz mega_kernel_rf_il32
.p2align 5
mega_kernel_rf_pa_15_0f:
s_mov_b64 exec, vcc
buffer_load_dwordx4 v[32:35], v7, s[84:87], s33 offen offset:0 sc1
s_mov_b64 exec, -1
s_branch mega_kernel_rf_pa_15_1
.p2align 5
mega_kernel_rf_pa_15_0:
s_waitcnt vmcnt(3)
v_max_u32 v4, v32, v34
v_cmp_eq_u32 vcc, -1, v4
s_cbranch_vccnz mega_kernel_rf_pa_15_0f
v_smfmac_f32_16x16x64_bf16 v[96:99], v[32:35], a[0:7], v6
v_smfmac_f32_16x16x64_bf16 v[100:103], v[32:35], a[32:39], v6
v_smfmac_f32_16x16x64_bf16 v[104:107], v[32:35], a[64:71], v6
v_smfmac_f32_16x16x64_bf16 v[108:111], v[32:35], a[96:103], v6
s_branch mega_kernel_rf_pa_14_1
mega_kernel_rf_il32:
s_cbranch_execz mega_kernel_rf_il33
.p2align 5
mega_kernel_rf_pa_15_1f:
s_mov_b64 exec, vcc
buffer_load_dwordx4 v[36:39], v7, s[84:87], s33 offen offset:1024 sc1
s_mov_b64 exec, -1
s_branch mega_kernel_rf_pa_15_2
.p2align 5
mega_kernel_rf_pa_15_1:
s_waitcnt vmcnt(3)
v_max_u32 v4, v36, v38
v_cmp_eq_u32 vcc, -1, v4
s_cbranch_vccnz mega_kernel_rf_pa_15_1f
v_smfmac_f32_16x16x64_bf16 v[96:99], v[36:39], a[8:15], v6
v_smfmac_f32_16x16x64_bf16 v[100:103], v[36:39], a[40:47], v6
v_smfmac_f32_16x16x64_bf16 v[104:107], v[36:39], a[72:79], v6
v_smfmac_f32_16x16x64_bf16 v[108:111], v[36:39], a[104:111], v6
s_branch mega_kernel_rf_pa_13_2
mega_kernel_rf_il33:
s_cbranch_execz mega_kernel_rf_il34
.p2align 5
mega_kernel_rf_pa_15_2f:
s_mov_b64 exec, vcc
buffer_load_dwordx4 v[40:43], v7, s[84:87], s33 offen offset:2048 sc1
s_mov_b64 exec, -1
s_branch mega_kernel_rf_pa_15_3
.p2align 5
mega_kernel_rf_pa_15_2:
s_waitcnt vmcnt(3)
v_max_u32 v4, v40, v42
v_cmp_eq_u32 vcc, -1, v4
s_cbranch_vccnz mega_kernel_rf_pa_15_2f
v_smfmac_f32_16x16x64_bf16 v[96:99], v[40:43], a[16:23], v6
v_smfmac_f32_16x16x64_bf16 v[100:103], v[40:43], a[48:55], v6
v_smfmac_f32_16x16x64_bf16 v[104:107], v[40:43], a[80:87], v6
v_smfmac_f32_16x16x64_bf16 v[108:111], v[40:43], a[112:119], v6
s_branch mega_kernel_rf_pa_11_3
mega_kernel_rf_il34:
s_cbranch_execz mega_kernel_rf_il35
.p2align 5
mega_kernel_rf_pa_15_3f:
s_mov_b64 exec, vcc
buffer_load_dwordx4 v[44:47], v7, s[84:87], s33 offen offset:3072 sc1
s_mov_b64 exec, -1
s_branch mega_kernel_rf_pa_15_0
.p2align 5
mega_kernel_rf_pa_15_3:
s_waitcnt vmcnt(3)
v_max_u32 v4, v44, v46
v_cmp_eq_u32 vcc, -1, v4
s_cbranch_vccnz mega_kernel_rf_pa_15_3f
v_smfmac_f32_16x16x64_bf16 v[96:99], v[44:47], a[24:31], v6
v_smfmac_f32_16x16x64_bf16 v[100:103], v[44:47], a[56:63], v6
v_smfmac_f32_16x16x64_bf16 v[104:107], v[44:47], a[88:95], v6
v_smfmac_f32_16x16x64_bf16 v[108:111], v[44:47], a[120:127], v6
s_branch mega_kernel_rf_pa_7_0
mega_kernel_rf_il35:
s_cbranch_execz mega_kernel_rf_il36
.p2align 5
mega_kernel_rf_pc_1_0f:
s_mov_b64 exec, vcc
buffer_load_dwordx4 v[32:35], v7, s[84:87], s29 offen offset:0 sc1
s_mov_b64 exec, -1
s_branch mega_kernel_rf_pc_1_0
.p2align 5
mega_kernel_rf_pc_1_0:
s_waitcnt vmcnt(0)
v_cmp_eq_u32 vcc, -1, v32
s_cbranch_vccnz mega_kernel_rf_pc_1_0f
v_smfmac_f32_16x16x64_bf16 v[96:99], v[32:35], a[192:199], v6
v_smfmac_f32_16x16x64_bf16 v[100:103], v[32:35], a[224:231], v6
s_branch mega_kernel_rf_pc_d
mega_kernel_rf_il36:
s_cbranch_execz mega_kernel_rf_il37
.p2align 5
mega_kernel_rf_pc_2_1f:
s_mov_b64 exec, vcc
buffer_load_dwordx4 v[36:39], v7, s[84:87], s29 offen offset:1024 sc1
s_mov_b64 exec, -1
s_branch mega_kernel_rf_pc_2_1
mega_kernel_rf_il37:
s_cbranch_execz mega_kernel_rf_iwd
.p2align 5
mega_kernel_rf_pc_2_1:
s_waitcnt vmcnt(0)
v_cmp_eq_u32 vcc, -1, v36
s_cbranch_vccnz mega_kernel_rf_pc_2_1f
v_smfmac_f32_16x16x64_bf16 v[96:99], v[36:39], a[200:207], v6
v_smfmac_f32_16x16x64_bf16 v[100:103], v[36:39], a[232:239], v6
s_branch mega_kernel_rf_pc_d
.p2align 5
mega_kernel_rf_pc_3_0f:
s_mov_b64 exec, vcc
buffer_load_dwordx4 v[32:35], v7, s[84:87], s29 offen offset:0 sc1
s_mov_b64 exec, -1
s_branch mega_kernel_rf_pc_3_1
mega_kernel_rf_iw2:
mega_kernel_rf_il38:
s_cbranch_execz mega_kernel_rf_il39
.p2align 5
mega_kernel_rf_pc_3_0:
s_waitcnt vmcnt(1)
v_cmp_eq_u32 vcc, -1, v32
s_cbranch_vccnz mega_kernel_rf_pc_3_0f
v_smfmac_f32_16x16x64_bf16 v[96:99], v[32:35], a[192:199], v6
v_smfmac_f32_16x16x64_bf16 v[100:103], v[32:35], a[224:231], v6
s_branch mega_kernel_rf_pc_2_1
.p2align 5
mega_kernel_rf_pc_3_1f:
s_mov_b64 exec, vcc
buffer_load_dwordx4 v[36:39], v7, s[84:87], s29 offen offset:1024 sc1
s_mov_b64 exec, -1
s_branch mega_kernel_rf_pc_3_0
mega_kernel_rf_il39:
s_cbranch_execz mega_kernel_rf_il40
.p2align 5
mega_kernel_rf_pc_3_1:
s_waitcnt vmcnt(1)
v_cmp_eq_u32 vcc, -1, v36
s_cbranch_vccnz mega_kernel_rf_pc_3_1f
v_smfmac_f32_16x16x64_bf16 v[96:99], v[36:39], a[200:207], v6
v_smfmac_f32_16x16x64_bf16 v[100:103], v[36:39], a[232:239], v6
s_branch mega_kernel_rf_pc_1_0
.p2align 5
mega_kernel_rf_pc_4_2f:
s_mov_b64 exec, vcc
buffer_load_dwordx4 v[40:43], v7, s[84:87], s29 offen offset:2048 sc1
s_mov_b64 exec, -1
s_branch mega_kernel_rf_pc_4_2
mega_kernel_rf_il40:
s_cbranch_execz mega_kernel_rf_il41
.p2align 5
mega_kernel_rf_pc_4_2:
s_waitcnt vmcnt(0)
v_cmp_eq_u32 vcc, -1, v40
s_cbranch_vccnz mega_kernel_rf_pc_4_2f
v_smfmac_f32_16x16x64_bf16 v[96:99], v[40:43], a[208:215], v6
v_smfmac_f32_16x16x64_bf16 v[100:103], v[40:43], a[240:247], v6
s_branch mega_kernel_rf_pc_d
.p2align 5
mega_kernel_rf_pc_5_0f:
s_mov_b64 exec, vcc
buffer_load_dwordx4 v[32:35], v7, s[84:87], s29 offen offset:0 sc1
s_mov_b64 exec, -1
s_branch mega_kernel_rf_pc_5_2
mega_kernel_rf_il41:
s_cbranch_execz mega_kernel_rf_il42
.p2align 5
mega_kernel_rf_pc_5_0:
s_waitcnt vmcnt(1)
v_cmp_eq_u32 vcc, -1, v32
s_cbranch_vccnz mega_kernel_rf_pc_5_0f
v_smfmac_f32_16x16x64_bf16 v[96:99], v[32:35], a[192:199], v6
v_smfmac_f32_16x16x64_bf16 v[100:103], v[32:35], a[224:231], v6
s_branch mega_kernel_rf_pc_4_2
.p2align 5
mega_kernel_rf_pc_5_2f:
s_mov_b64 exec, vcc
buffer_load_dwordx4 v[40:43], v7, s[84:87], s29 offen offset:2048 sc1
s_mov_b64 exec, -1
s_branch mega_kernel_rf_pc_5_0
mega_kernel_rf_il42:
s_cbranch_execz mega_kernel_rf_il43
.p2align 5
mega_kernel_rf_pc_5_2:
s_waitcnt vmcnt(1)
v_cmp_eq_u32 vcc, -1, v40
s_cbranch_vccnz mega_kernel_rf_pc_5_2f
v_smfmac_f32_16x16x64_bf16 v[96:99], v[40:43], a[208:215], v6
v_smfmac_f32_16x16x64_bf16 v[100:103], v[40:43], a[240:247], v6
s_branch mega_kernel_rf_pc_1_0
.p2align 5
mega_kernel_rf_pc_6_1f:
s_mov_b64 exec, vcc
buffer_load_dwordx4 v[36:39], v7, s[84:87], s29 offen offset:1024 sc1
s_mov_b64 exec, -1
s_branch mega_kernel_rf_pc_6_2
mega_kernel_rf_il43:
s_cbranch_execz mega_kernel_rf_il44
.p2align 5
mega_kernel_rf_pc_6_1:
s_waitcnt vmcnt(1)
v_cmp_eq_u32 vcc, -1, v36
s_cbranch_vccnz mega_kernel_rf_pc_6_1f
v_smfmac_f32_16x16x64_bf16 v[96:99], v[36:39], a[200:207], v6
v_smfmac_f32_16x16x64_bf16 v[100:103], v[36:39], a[232:239], v6
s_branch mega_kernel_rf_pc_4_2
.p2align 5
mega_kernel_rf_pc_6_2f:
s_mov_b64 exec, vcc
buffer_load_dwordx4 v[40:43], v7, s[84:87], s29 offen offset:2048 sc1
s_mov_b64 exec, -1
s_branch mega_kernel_rf_pc_6_1
mega_kernel_rf_il44:
s_cbranch_execz mega_kernel_rf_il45
.p2align 5
mega_kernel_rf_pc_6_2:
s_waitcnt vmcnt(1)
v_cmp_eq_u32 vcc, -1, v40
s_cbranch_vccnz mega_kernel_rf_pc_6_2f
v_smfmac_f32_16x16x64_bf16 v[96:99], v[40:43], a[208:215], v6
v_smfmac_f32_16x16x64_bf16 v[100:103], v[40:43], a[240:247], v6
s_branch mega_kernel_rf_pc_2_1
.p2align 5
mega_kernel_rf_pc_7_0f:
s_mov_b64 exec, vcc
buffer_load_dwordx4 v[32:35], v7, s[84:87], s29 offen offset:0 sc1
s_mov_b64 exec, -1
s_branch mega_kernel_rf_pc_7_1
mega_kernel_rf_il45:
s_cbranch_execz mega_kernel_rf_il46
.p2align 5
mega_kernel_rf_pc_7_0:
s_waitcnt vmcnt(2)
v_cmp_eq_u32 vcc, -1, v32
s_cbranch_vccnz mega_kernel_rf_pc_7_0f
v_smfmac_f32_16x16x64_bf16 v[96:99], v[32:35], a[192:199], v6
v_smfmac_f32_16x16x64_bf16 v[100:103], v[32:35], a[224:231], v6
s_branch mega_kernel_rf_pc_6_1
.p2align 5
mega_kernel_rf_pc_7_1f:
s_mov_b64 exec, vcc
buffer_load_dwordx4 v[36:39], v7, s[84:87], s29 offen offset:1024 sc1
s_mov_b64 exec, -1
s_branch mega_kernel_rf_pc_7_2
mega_kernel_rf_il46:
s_cbranch_execz mega_kernel_rf_il47
.p2align 5
mega_kernel_rf_pc_7_1:
s_waitcnt vmcnt(2)
v_cmp_eq_u32 vcc, -1, v36
s_cbranch_vccnz mega_kernel_rf_pc_7_1f
v_smfmac_f32_16x16x64_bf16 v[96:99], v[36:39], a[200:207], v6
v_smfmac_f32_16x16x64_bf16 v[100:103], v[36:39], a[232:239], v6
s_branch mega_kernel_rf_pc_5_2
.p2align 5
mega_kernel_rf_pc_7_2f:
s_mov_b64 exec, vcc
buffer_load_dwordx4 v[40:43], v7, s[84:87], s29 offen offset:2048 sc1
s_mov_b64 exec, -1
s_branch mega_kernel_rf_pc_7_0
mega_kernel_rf_il47:
s_cbranch_execz mega_kernel_rf_il48
.p2align 5
mega_kernel_rf_pc_7_2:
s_waitcnt vmcnt(2)
v_cmp_eq_u32 vcc, -1, v40
s_cbranch_vccnz mega_kernel_rf_pc_7_2f
v_smfmac_f32_16x16x64_bf16 v[96:99], v[40:43], a[208:215], v6
v_smfmac_f32_16x16x64_bf16 v[100:103], v[40:43], a[240:247], v6
s_branch mega_kernel_rf_pc_3_0
.p2align 5
mega_kernel_rf_pc_8_3f:
s_mov_b64 exec, vcc
buffer_load_dwordx4 v[44:47], v7, s[84:87], s29 offen offset:3072 sc1
s_mov_b64 exec, -1
s_branch mega_kernel_rf_pc_8_3
mega_kernel_rf_il48:
s_cbranch_execz mega_kernel_rf_il49
.p2align 5
mega_kernel_rf_pc_9_0f:
s_mov_b64 exec, vcc
buffer_load_dwordx4 v[32:35], v7, s[84:87], s29 offen offset:0 sc1
s_mov_b64 exec, -1
s_branch mega_kernel_rf_pc_9_3
.p2align 5
mega_kernel_rf_pc_9_0:
s_waitcnt vmcnt(1)
v_cmp_eq_u32 vcc, -1, v32
s_cbranch_vccnz mega_kernel_rf_pc_9_0f
v_smfmac_f32_16x16x64_bf16 v[96:99], v[32:35], a[192:199], v6
v_smfmac_f32_16x16x64_bf16 v[100:103], v[32:35], a[224:231], v6
s_branch mega_kernel_rf_pc_8_3
mega_kernel_rf_il49:
s_cbranch_execz mega_kernel_rf_il50
.p2align 5
mega_kernel_rf_pc_9_3f:
s_mov_b64 exec, vcc
buffer_load_dwordx4 v[44:47], v7, s[84:87], s29 offen offset:3072 sc1
s_mov_b64 exec, -1
s_branch mega_kernel_rf_pc_9_0
mega_kernel_rf_il50:
s_cbranch_execz mega_kernel_rf_il51
.p2align 5
mega_kernel_rf_pc_9_3:
s_waitcnt vmcnt(1)
v_cmp_eq_u32 vcc, -1, v44
s_cbranch_vccnz mega_kernel_rf_pc_9_3f
v_smfmac_f32_16x16x64_bf16 v[96:99], v[44:47], a[216:223], v6
v_smfmac_f32_16x16x64_bf16 v[100:103], v[44:47], a[248:255], v6
s_branch mega_kernel_rf_pc_1_0
.p2align 5
mega_kernel_rf_pc_10_1f:
s_mov_b64 exec, vcc
buffer_load_dwordx4 v[36:39], v7, s[84:87], s29 offen offset:1024 sc1
s_mov_b64 exec, -1
s_branch mega_kernel_rf_pc_10_3
mega_kernel_rf_il51:
s_cbranch_execz mega_kernel_rf_il52
.p2align 5
mega_kernel_rf_pc_10_1:
s_waitcnt vmcnt(1)
v_cmp_eq_u32 vcc, -1, v36
s_cbranch_vccnz mega_kernel_rf_pc_10_1f
v_smfmac_f32_16x16x64_bf16 v[96:99], v[36:39], a[200:207], v6
v_smfmac_f32_16x16x64_bf16 v[100:103], v[36:39], a[232:239], v6
s_branch mega_kernel_rf_pc_8_3
.p2align 5
mega_kernel_rf_pc_10_3f:
s_mov_b64 exec, vcc
buffer_load_dwordx4 v[44:47], v7, s[84:87], s29 offen offset:3072 sc1
s_mov_b64 exec, -1
s_branch mega_kernel_rf_pc_10_1
mega_kernel_rf_il52:
s_cbranch_execz mega_kernel_rf_il53
.p2align 5
mega_kernel_rf_pc_10_3:
s_waitcnt vmcnt(1)
v_cmp_eq_u32 vcc, -1, v44
s_cbranch_vccnz mega_kernel_rf_pc_10_3f
v_smfmac_f32_16x16x64_bf16 v[96:99], v[44:47], a[216:223], v6
v_smfmac_f32_16x16x64_bf16 v[100:103], v[44:47], a[248:255], v6
s_branch mega_kernel_rf_pc_2_1
.p2align 5
mega_kernel_rf_pc_11_0f:
s_mov_b64 exec, vcc
buffer_load_dwordx4 v[32:35], v7, s[84:87], s29 offen offset:0 sc1
s_mov_b64 exec, -1
s_branch mega_kernel_rf_pc_11_1
mega_kernel_rf_il53:
s_cbranch_execz mega_kernel_rf_il54
.p2align 5
mega_kernel_rf_pc_11_0:
s_waitcnt vmcnt(2)
v_cmp_eq_u32 vcc, -1, v32
s_cbranch_vccnz mega_kernel_rf_pc_11_0f
v_smfmac_f32_16x16x64_bf16 v[96:99], v[32:35], a[192:199], v6
v_smfmac_f32_16x16x64_bf16 v[100:103], v[32:35], a[224:231], v6
s_branch mega_kernel_rf_pc_10_1
.p2align 5
mega_kernel_rf_pc_11_1f:
s_mov_b64 exec, vcc
buffer_load_dwordx4 v[36:39], v7, s[84:87], s29 offen offset:1024 sc1
s_mov_b64 exec, -1
s_branch mega_kernel_rf_pc_11_3
mega_kernel_rf_il54:
s_cbranch_execz mega_kernel_rf_il55
.p2align 5
mega_kernel_rf_pc_11_1:
s_waitcnt vmcnt(2)
v_cmp_eq_u32 vcc, -1, v36
s_cbranch_vccnz mega_kernel_rf_pc_11_1f
v_smfmac_f32_16x16x64_bf16 v[96:99], v[36:39], a[200:207], v6
v_smfmac_f32_16x16x64_bf16 v[100:103], v[36:39], a[232:239], v6
s_branch mega_kernel_rf_pc_9_3
.p2align 5
mega_kernel_rf_pc_11_3f:
s_mov_b64 exec, vcc
buffer_load_dwordx4 v[44:47], v7, s[84:87], s29 offen offset:3072 sc1
s_mov_b64 exec, -1
s_branch mega_kernel_rf_pc_11_0
mega_kernel_rf_il55:
s_cbranch_execz mega_kernel_rf_il56
.p2align 5
mega_kernel_rf_pc_11_3:
s_waitcnt vmcnt(2)
v_cmp_eq_u32 vcc, -1, v44
s_cbranch_vccnz mega_kernel_rf_pc_11_3f
v_smfmac_f32_16x16x64_bf16 v[96:99], v[44:47], a[216:223], v6
v_smfmac_f32_16x16x64_bf16 v[100:103], v[44:47], a[248:255], v6
s_branch mega_kernel_rf_pc_3_0
.p2align 5
mega_kernel_rf_pc_12_2f:
s_mov_b64 exec, vcc
buffer_load_dwordx4 v[40:43], v7, s[84:87], s29 offen offset:2048 sc1
s_mov_b64 exec, -1
s_branch mega_kernel_rf_pc_12_3
mega_kernel_rf_il56:
s_cbranch_execz mega_kernel_rf_iwd
.p2align 5
mega_kernel_rf_pc_12_3f:
s_mov_b64 exec, vcc
buffer_load_dwordx4 v[44:47], v7, s[84:87], s29 offen offset:3072 sc1
s_mov_b64 exec, -1
s_branch mega_kernel_rf_pc_12_2
.p2align 5
mega_kernel_rf_pc_12_3:
s_waitcnt vmcnt(1)
v_cmp_eq_u32 vcc, -1, v44
s_cbranch_vccnz mega_kernel_rf_pc_12_3f
v_smfmac_f32_16x16x64_bf16 v[96:99], v[44:47], a[216:223], v6
v_smfmac_f32_16x16x64_bf16 v[100:103], v[44:47], a[248:255], v6
s_branch mega_kernel_rf_pc_4_2
mega_kernel_rf_iw3:
mega_kernel_rf_il57:
s_cbranch_execz mega_kernel_rf_il58
.p2align 5
mega_kernel_rf_pc_13_0f:
s_mov_b64 exec, vcc
buffer_load_dwordx4 v[32:35], v7, s[84:87], s29 offen offset:0 sc1
s_mov_b64 exec, -1
s_branch mega_kernel_rf_pc_13_2
mega_kernel_rf_il58:
s_cbranch_execz mega_kernel_rf_il59
.p2align 5
mega_kernel_rf_pc_13_0:
s_waitcnt vmcnt(2)
v_cmp_eq_u32 vcc, -1, v32
s_cbranch_vccnz mega_kernel_rf_pc_13_0f
v_smfmac_f32_16x16x64_bf16 v[96:99], v[32:35], a[192:199], v6
v_smfmac_f32_16x16x64_bf16 v[100:103], v[32:35], a[224:231], v6
s_branch mega_kernel_rf_pc_12_2
.p2align 5
mega_kernel_rf_pc_13_2f:
s_mov_b64 exec, vcc
buffer_load_dwordx4 v[40:43], v7, s[84:87], s29 offen offset:2048 sc1
s_mov_b64 exec, -1
s_branch mega_kernel_rf_pc_13_3
mega_kernel_rf_il59:
s_cbranch_execz mega_kernel_rf_il60
.p2align 5
mega_kernel_rf_pc_13_2:
s_waitcnt vmcnt(2)
v_cmp_eq_u32 vcc, -1, v40
s_cbranch_vccnz mega_kernel_rf_pc_13_2f
v_smfmac_f32_16x16x64_bf16 v[96:99], v[40:43], a[208:215], v6
v_smfmac_f32_16x16x64_bf16 v[100:103], v[40:43], a[240:247], v6
s_branch mega_kernel_rf_pc_9_3
.p2align 5
mega_kernel_rf_pc_13_3f:
s_mov_b64 exec, vcc
buffer_load_dwordx4 v[44:47], v7, s[84:87], s29 offen offset:3072 sc1
s_mov_b64 exec, -1
s_branch mega_kernel_rf_pc_13_0
mega_kernel_rf_il60:
s_cbranch_execz mega_kernel_rf_il61
.p2align 5
mega_kernel_rf_pc_13_3:
s_waitcnt vmcnt(2)
v_cmp_eq_u32 vcc, -1, v44
s_cbranch_vccnz mega_kernel_rf_pc_13_3f
v_smfmac_f32_16x16x64_bf16 v[96:99], v[44:47], a[216:223], v6
v_smfmac_f32_16x16x64_bf16 v[100:103], v[44:47], a[248:255], v6
s_branch mega_kernel_rf_pc_5_0
.p2align 5
mega_kernel_rf_pc_14_1f:
s_mov_b64 exec, vcc
buffer_load_dwordx4 v[36:39], v7, s[84:87], s29 offen offset:1024 sc1
s_mov_b64 exec, -1
s_branch mega_kernel_rf_pc_14_2
mega_kernel_rf_il61:
s_cbranch_execz mega_kernel_rf_il62
.p2align 5
mega_kernel_rf_pc_14_2f:
s_mov_b64 exec, vcc
buffer_load_dwordx4 v[40:43], v7, s[84:87], s29 offen offset:2048 sc1
s_mov_b64 exec, -1
s_branch mega_kernel_rf_pc_14_3
.p2align 5
mega_kernel_rf_pc_14_2:
s_waitcnt vmcnt(2)
v_cmp_eq_u32 vcc, -1, v40
s_cbranch_vccnz mega_kernel_rf_pc_14_2f
v_smfmac_f32_16x16x64_bf16 v[96:99], v[40:43], a[208:215], v6
v_smfmac_f32_16x16x64_bf16 v[100:103], v[40:43], a[240:247], v6
s_branch mega_kernel_rf_pc_10_3
mega_kernel_rf_il62:
s_cbranch_execz mega_kernel_rf_il63
.p2align 5
mega_kernel_rf_pc_14_3f:
s_mov_b64 exec, vcc
buffer_load_dwordx4 v[44:47], v7, s[84:87], s29 offen offset:3072 sc1
s_mov_b64 exec, -1
s_branch mega_kernel_rf_pc_14_1
mega_kernel_rf_il63:
s_cbranch_execz mega_kernel_rf_il64
.p2align 5
mega_kernel_rf_pc_14_3:
s_waitcnt vmcnt(2)
v_cmp_eq_u32 vcc, -1, v44
s_cbranch_vccnz mega_kernel_rf_pc_14_3f
v_smfmac_f32_16x16x64_bf16 v[96:99], v[44:47], a[216:223], v6
v_smfmac_f32_16x16x64_bf16 v[100:103], v[44:47], a[248:255], v6
s_branch mega_kernel_rf_pc_6_1
.p2align 5
mega_kernel_rf_pc_15_0f:
s_mov_b64 exec, vcc
buffer_load_dwordx4 v[32:35], v7, s[84:87], s29 offen offset:0 sc1
s_mov_b64 exec, -1
s_branch mega_kernel_rf_pc_15_1
mega_kernel_rf_il64:
s_cbranch_execz mega_kernel_rf_il65
.p2align 5
mega_kernel_rf_pc_15_1f:
s_mov_b64 exec, vcc
buffer_load_dwordx4 v[36:39], v7, s[84:87], s29 offen offset:1024 sc1
s_mov_b64 exec, -1
s_branch mega_kernel_rf_pc_15_2
.p2align 5
mega_kernel_rf_pc_15_1:
s_waitcnt vmcnt(3)
v_cmp_eq_u32 vcc, -1, v36
s_cbranch_vccnz mega_kernel_rf_pc_15_1f
v_smfmac_f32_16x16x64_bf16 v[96:99], v[36:39], a[200:207], v6
v_smfmac_f32_16x16x64_bf16 v[100:103], v[36:39], a[232:239], v6
s_branch mega_kernel_rf_pc_13_2
mega_kernel_rf_il65:
s_cbranch_execz mega_kernel_rf_il66
.p2align 5
mega_kernel_rf_pc_15_2f:
s_mov_b64 exec, vcc
buffer_load_dwordx4 v[40:43], v7, s[84:87], s29 offen offset:2048 sc1
s_mov_b64 exec, -1
s_branch mega_kernel_rf_pc_15_3
mega_kernel_rf_il66:
s_cbranch_execz mega_kernel_rf_il67
.p2align 5
mega_kernel_rf_pc_15_2:
s_waitcnt vmcnt(3)
v_cmp_eq_u32 vcc, -1, v40
s_cbranch_vccnz mega_kernel_rf_pc_15_2f
v_smfmac_f32_16x16x64_bf16 v[96:99], v[40:43], a[208:215], v6
v_smfmac_f32_16x16x64_bf16 v[100:103], v[40:43], a[240:247], v6
s_branch mega_kernel_rf_pc_11_3
.p2align 5
mega_kernel_rf_pc_15_3f:
s_mov_b64 exec, vcc
buffer_load_dwordx4 v[44:47], v7, s[84:87], s29 offen offset:3072 sc1
s_mov_b64 exec, -1
s_branch mega_kernel_rf_pc_15_0
mega_kernel_rf_il67:
s_cbranch_execz mega_kernel_rf_il68
.p2align 5
mega_kernel_rf_pc_15_3:
s_waitcnt vmcnt(3)
v_cmp_eq_u32 vcc, -1, v44
s_cbranch_vccnz mega_kernel_rf_pc_15_3f
v_smfmac_f32_16x16x64_bf16 v[96:99], v[44:47], a[216:223], v6
v_smfmac_f32_16x16x64_bf16 v[100:103], v[44:47], a[248:255], v6
s_branch mega_kernel_rf_pc_7_0
mega_kernel_rf_w0last:
s_nop 7
v_permlane32_swap_b32 v112, v116
v_permlane32_swap_b32 v113, v117
v_permlane32_swap_b32 v114, v118
v_permlane32_swap_b32 v115, v119
v_pk_add_f32 v[112:113], v[112:113], v[116:117]
v_pk_add_f32 v[114:115], v[114:115], v[118:119]
ds_write_b128 v20, v[112:115]
s_waitcnt lgkmcnt(0)
s_barrier
s_branch mega_kernel_rf_end
mega_kernel_rf_il68:
s_cbranch_execz mega_kernel_rf_il69
mega_kernel_rf_side:
s_cmp_eq_u32 s24, 3
s_cbranch_scc1 mega_kernel_rf_sd3
s_cmp_eq_u32 s24, 2
s_cbranch_scc0 mega_kernel_rf_sd4
s_mov_b64 exec, s[40:41]
buffer_store_dwordx4 v[28:31], v11, s[84:87], s34 offen
s_mov_b64 exec, -1
buffer_store_dwordx2 v[28:29], v9, s[84:87], s34 offen
s_mul_i32 s28, s31, 1280
s_add_u32 s28, s28, s34
s_add_u32 s28, s28, 49152
buffer_store_dwordx4 v[28:31], v17, s[84:87], s28 offen
buffer_store_dwordx4 v[28:31], v10, s[84:87], s28 offen
s_branch mega_kernel_rf_sd4
mega_kernel_rf_il69:
s_cbranch_execz mega_kernel_rf_il70
mega_kernel_rf_sd3:
v_readlane_b32 s76, v249, 0
v_readlane_b32 s77, v249, 1
s_min_i32 s76, s76, s77
s_max_i32 s46, s46, s76
s_mov_b32 s36, 0
s_add_u32 s76, s27, 1
s_cmp_lt_u32 s76, 63
s_cbranch_scc0 mega_kernel_rf_sd4
s_cmp_ge_u32 s76, 0
s_cbranch_scc0 mega_kernel_rf_sd4
s_cmp_gt_i32 s46, s76
s_cselect_b32 s36, 0, 1
s_cbranch_scc0 mega_kernel_rf_sd4
s_add_u32 s77, s76, s82
s_bfe_u32 s28, s77, 0x40002
s_lshl_b32 s28, s28, 14
s_and_b32 s77, s77, 3
s_lshl_b32 s77, s77, 11
s_add_u32 s28, s28, s77
s_add_u32 m0, s45, 0
s_nop 0
buffer_load_dwordx4 v240, s[84:87], s28 offen offset:0 sc1 lds
s_add_u32 m0, s45, 0
s_nop 0
buffer_load_dwordx4 v240, s[84:87], s28 offen offset:1024 sc1 lds
s_add_u32 m0, s45, 2048
s_nop 0
buffer_load_dwordx4 v241, s[84:87], s28 offen offset:0 sc1 lds
s_add_u32 m0, s45, 2048
s_nop 0
buffer_load_dwordx4 v241, s[84:87], s28 offen offset:1024 sc1 lds
s_add_u32 s45, s45, 4096
s_cmp_eq_u32 s45, 30720
s_cselect_b32 s45, 18432, s45
mega_kernel_rf_sd4:
v_smfmac_f32_16x16x64_bf16 v[112:115], v[40:43], a[144:151], v6
v_smfmac_f32_16x16x64_bf16 v[116:119], v[40:43], a[176:183], v6
v_smfmac_f32_16x16x64_bf16 v[112:115], v[44:47], a[152:159], v6
v_smfmac_f32_16x16x64_bf16 v[116:119], v[44:47], a[184:191], v6
s_nop 7
v_permlane32_swap_b32 v112, v116
v_permlane32_swap_b32 v113, v117
v_permlane32_swap_b32 v114, v118
v_permlane32_swap_b32 v115, v119
v_pk_add_f32 v[112:113], v[112:113], v[116:117]
v_pk_add_f32 v[114:115], v[114:115], v[118:119]
ds_write_b128 v20, v[112:115]
v_mov_b32 v96, 0
v_mov_b32 v97, 0
v_mov_b32 v98, 0
v_mov_b32 v99, 0
v_mov_b32 v100, 0
v_mov_b32 v101, 0
v_mov_b32 v102, 0
v_mov_b32 v103, 0
s_cmp_eq_u32 s24, 1
s_cbranch_scc0 mega_kernel_rf_s1
s_waitcnt lgkmcnt(0)
ds_read_b128 v[120:123], v16 offset:0
ds_read_b128 v[124:127], v16 offset:16
ds_read_b128 v[128:131], v16 offset:2304
ds_read_b128 v[132:135], v16 offset:2320
ds_read_b128 v[136:139], v16 offset:4608
ds_read_b128 v[140:143], v16 offset:4624
ds_read_b128 v[144:147], v16 offset:6912
ds_read_b128 v[148:151], v16 offset:6928
s_waitcnt lgkmcnt(4)
v_pk_add_f32 v[120:121], v[120:121], v[128:129]
v_pk_add_f32 v[122:123], v[122:123], v[130:131]
v_pk_add_f32 v[124:125], v[124:125], v[132:133]
v_pk_add_f32 v[126:127], v[126:127], v[134:135]
s_waitcnt lgkmcnt(0)
v_pk_add_f32 v[136:137], v[136:137], v[144:145]
v_pk_add_f32 v[138:139], v[138:139], v[146:147]
v_pk_add_f32 v[140:141], v[140:141], v[148:149]
v_pk_add_f32 v[142:143], v[142:143], v[150:151]
v_pk_add_f32 v[120:121], v[120:121], v[136:137]
v_pk_add_f32 v[122:123], v[122:123], v[138:139]
v_pk_add_f32 v[124:125], v[124:125], v[140:141]
v_pk_add_f32 v[126:127], v[126:127], v[142:143]
v_cvt_pk_bf16_f32 v244, v120, v121
v_cvt_pk_bf16_f32 v245, v122, v123
v_cvt_pk_bf16_f32 v246, v124, v125
v_cvt_pk_bf16_f32 v247, v126, v127
mega_kernel_rf_s1:
v_add_u32 v5, 9216, v17
s_waitcnt lgkmcnt(0)
s_barrier
s_cmp_eq_u32 s24, 2
s_cbranch_scc1 mega_kernel_rf_s2
s_cmp_eq_u32 s24, 3
s_cbranch_scc0 mega_kernel_rf_s3
s_add_u32 s76, s27, 2
s_cmp_lt_u32 s76, 63
s_cbranch_scc0 mega_kernel_rf_s3
s_cmp_gt_i32 s46, s76
s_cbranch_scc0 mega_kernel_rf_s3
s_add_u32 s77, s76, s82
s_bfe_u32 s28, s77, 0x40002
s_lshl_b32 s28, s28, 14
s_and_b32 s77, s77, 3
s_lshl_b32 s77, s77, 11
s_add_u32 s28, s28, s77
s_add_u32 s28, s28, s83
s_buffer_load_dword s78, s[84:87], s28 offset:0
s_buffer_load_dword s78, s[84:87], s28 offset:128
s_buffer_load_dword s78, s[84:87], s28 offset:256
s_buffer_load_dword s78, s[84:87], s28 offset:384
s_buffer_load_dword s78, s[84:87], s28 offset:512
s_buffer_load_dword s78, s[84:87], s28 offset:640
s_buffer_load_dword s78, s[84:87], s28 offset:768
s_buffer_load_dword s78, s[84:87], s28 offset:896
s_buffer_load_dword s78, s[84:87], s28 offset:1024
s_buffer_load_dword s78, s[84:87], s28 offset:1152
s_buffer_load_dword s78, s[84:87], s28 offset:1280
s_buffer_load_dword s78, s[84:87], s28 offset:1408
s_buffer_load_dword s78, s[84:87], s28 offset:1536
s_buffer_load_dword s78, s[84:87], s28 offset:1664
s_buffer_load_dword s78, s[84:87], s28 offset:1792
s_buffer_load_dword s78, s[84:87], s28 offset:1920
s_mov_b32 s88, s76
s_branch mega_kernel_rf_s3
mega_kernel_rf_il70:
s_cbranch_execz mega_kernel_rf_il71
mega_kernel_rf_s2:
ds_read_b128 v[120:123], v5 offset:0
ds_read_b128 v[124:127], v5 offset:1024
ds_read_b128 v[128:131], v5 offset:2048
ds_read_b128 v[132:135], v5 offset:3072
v_lshrrev_b32 v5, 1, v17
s_waitcnt lgkmcnt(2)
v_pk_add_f32 v[120:121], v[120:121], v[124:125]
v_pk_add_f32 v[122:123], v[122:123], v[126:127]
s_waitcnt lgkmcnt(0)
v_pk_add_f32 v[128:129], v[128:129], v[132:133]
v_pk_add_f32 v[130:131], v[130:131], v[134:135]
v_pk_add_f32 v[120:121], v[120:121], v[128:129]
v_pk_add_f32 v[122:123], v[122:123], v[130:131]
v_cvt_pk_bf16_f32 v244, v120, v121
v_cvt_pk_bf16_f32 v245, v122, v123
ds_write_b64 v5, v[244:245] offset:17920
s_waitcnt lgkmcnt(0) vmcnt(0)
mega_kernel_rf_s3:
s_cmp_eq_u32 s27, 63
s_cbranch_scc1 mega_kernel_rf_slast
s_add_u32 s29, s33, 24576
s_barrier
s_cmp_eq_u32 s24, 3
s_cbranch_scc1 mega_kernel_rf_y3
s_add_u32 s77, s27, s82
s_bfe_u32 s28, s77, 0x30003
s_lshl_b32 s28, s28, 14
s_and_b32 s77, s77, 7
s_lshl_b32 s77, s77, 10
s_add_u32 s28, s28, s77
s_add_u32 s28, s28, s79
s_cmp_eq_u32 s24, 2
s_cbranch_scc1 mega_kernel_rf_kv2a
s_mov_b64 exec, s[48:49]
buffer_store_dwordx4 v[244:247], v22, s[84:87], s28 offen sc1
s_mov_b64 exec, -1
s_branch mega_kernel_rf_kvda
mega_kernel_rf_il71:
s_cbranch_execz mega_kernel_rf_il72
mega_kernel_rf_kv2a:
v_lshlrev_b32 v4, 3, v1
buffer_store_dwordx2 v[244:245], v4, s[84:87], s28 offen offset:512 sc1
mega_kernel_rf_kvda:
s_branch mega_kernel_rf_y4
mega_kernel_rf_y3:
s_add_u32 s76, s27, 2
s_cmp_lt_u32 s76, 63
s_cbranch_scc0 mega_kernel_rf_y4
mega_kernel_rf_y4:
s_branch mega_kernel_rf_b3
mega_kernel_rf_first:
v_add_u32 v5, s44, v17
ds_read_b128 v[156:159], v5 offset:0
ds_read_b128 v[160:163], v5 offset:1024
ds_read_b128 v[164:167], v5 offset:2048
ds_read_b128 v[168:171], v5 offset:3072
s_branch mega_kernel_rf_adone
mega_kernel_rf_il72:
s_cbranch_execz mega_kernel_rf_il73
mega_kernel_rf_slast:
s_cmp_eq_u32 s24, 3
s_cbranch_scc1 mega_kernel_rf_end
s_add_u32 s77, s27, s82
s_bfe_u32 s28, s77, 0x30003
s_lshl_b32 s28, s28, 14
s_and_b32 s77, s77, 7
s_lshl_b32 s77, s77, 10
s_add_u32 s28, s28, s77
s_add_u32 s28, s28, s79
s_cmp_eq_u32 s24, 2
s_cbranch_scc1 mega_kernel_rf_kv2b
s_mov_b64 exec, s[48:49]
buffer_store_dwordx4 v[244:247], v22, s[84:87], s28 offen sc1
s_mov_b64 exec, -1
s_branch mega_kernel_rf_kvdb
mega_kernel_rf_il73:
s_cbranch_execz mega_kernel_rf_iwd
mega_kernel_rf_kv2b:
v_lshlrev_b32 v4, 3, v1
buffer_store_dwordx2 v[244:245], v4, s[84:87], s28 offen offset:512 sc1
mega_kernel_rf_kvdb:
s_waitcnt vmcnt(0)
s_barrier
s_mov_b32 s76, 64
s_cmp_eq_u32 s24, 1
s_cbranch_scc0 mega_kernel_rf_end
v_mov_b32 v5, s76
s_mov_b64 exec, 1
buffer_store_dword v5, v228, s[84:87], s81 offen sc1
s_mov_b64 exec, -1
mega_kernel_rf_end:
s_endpgm
mega_kernel_recs:
s_load_dwordx2 s[20:21], s[0:1], 8
s_load_dwordx2 s[16:17], s[0:1], 40
s_load_dwordx2 s[4:5], s[0:1], 16
s_load_dwordx2 s[8:9], s[0:1], 24
s_load_dwordx2 s[12:13], s[0:1], 32
v_lshrrev_b32 v4, 6, v0
v_and_b32 v1, 63, v0
v_readfirstlane_b32 s24, v4
v_lshrrev_b32 v2, 4, v1
v_and_b32 v3, 15, v1
v_lshlrev_b32 v17, 4, v1
s_lshr_b32 s28, s31, 2
s_lshl_b32 s25, s30, 3
s_add_u32 s25, s25, s28
s_and_b32 s26, s31, 3
s_waitcnt lgkmcnt(0)
s_mov_b32 s22, 16384
s_mov_b32 s23, 0x00020000
s_mov_b32 s18, 8388608
s_mov_b32 s19, 0x00020000
s_mov_b32 s6, 8388608
s_mov_b32 s7, 0x00020000
s_mov_b32 s10, 8388608
s_mov_b32 s11, 0x00020000
s_mov_b32 s14, 8388608
s_mov_b32 s15, 0x00020000
s_lshl_b32 s28, s25, 8
s_lshr_b32 s29, s26, 0
s_lshl_b32 s29, s29, 6
s_add_u32 s28, s28, s29
s_lshl_b32 s29, s24, 21
s_add_u32 s28, s28, s29
v_lshrrev_b32 v4, 2, v1
v_and_b32 v5, 3, v1
v_lshlrev_b32 v40, 13, v4
v_lshl_add_u32 v40, v5, 4, v40
v_add_u32 v40, s28, v40
s_lshl_b32 s28, s30, 21
s_lshl_b32 s29, s24, 19
s_add_u32 s28, s28, s29
s_lshr_b32 s29, s31, 0
s_lshl_b32 s29, s29, 6
s_add_u32 s28, s28, s29
v_lshlrev_b32 v41, 11, v4
v_lshl_add_u32 v41, v5, 4, v41
v_add_u32 v41, s28, v41
s_lshl_b32 s47, s24, 15
s_add_u32 s47, s47, 32768
s_lshl_b32 s28, s31, 18
s_lshl_b32 s29, s24, 16
s_add_u32 s28, s28, s29
s_lshl_b32 s29, s30, 11
s_add_u32 s28, s28, s29
v_lshlrev_b32 v48, 13, v2
v_lshl_add_u32 v48, v3, 7, v48
v_add_u32 v48, s28, v48
s_lshl_b32 s28, s30, 21
s_lshl_b32 s29, s31, 16
s_add_u32 s28, s28, s29
s_lshl_b32 s29, s24, 14
s_add_u32 s28, s28, s29
v_lshlrev_b32 v49, 7, v1
v_add_u32 v49, s28, v49
s_and_b32 s76, s31, 1
s_mul_i32 s76, s76, 8
s_and_b32 s28, s31, 15
s_lshl_b32 s28, s28, 4
s_lshl_b32 s29, s24, 8
s_add_u32 s28, s28, s29
v_add_u32 v53, s28, v3
s_lshr_b32 s28, s31, 4
s_lshl_b32 s28, s28, 10
s_add_u32 s28, s28, 384
v_mov_b32 v54, s28
v_mov_b32 v55, 1920
v_cmp_gt_u32 vcc, 32, v1
s_nop 1
v_cndmask_b32 v54, v55, v54, vcc
s_lshl_b32 s29, s30, 11
v_lshl_add_u32 v51, v53, 13, v54
v_add_u32 v51, s29, v51
s_lshl_b32 s29, s30, 21
v_lshl_add_u32 v52, v53, 11, v54
v_add_u32 v52, s29, v52
buffer_load_dword v50, v51, s[8:11], 0 offen
s_xor_b32 s29, s76, 0
s_lshl_b32 s28, s29, 10
s_add_u32 s28, s28, s47
s_add_u32 m0, s28, 0
s_lshl_b32 s29, s29, 17
buffer_load_dwordx4 v40, s[8:11], s29 offen lds
s_xor_b32 s29, s76, 1
s_lshl_b32 s28, s29, 10
s_add_u32 s28, s28, s47
s_add_u32 m0, s28, 0
s_lshl_b32 s29, s29, 17
buffer_load_dwordx4 v40, s[8:11], s29 offen lds
s_xor_b32 s29, s76, 2
s_lshl_b32 s28, s29, 10
s_add_u32 s28, s28, s47
s_add_u32 m0, s28, 0
s_lshl_b32 s29, s29, 17
buffer_load_dwordx4 v40, s[8:11], s29 offen lds
s_xor_b32 s29, s76, 3
s_lshl_b32 s28, s29, 10
s_add_u32 s28, s28, s47
s_add_u32 m0, s28, 0
s_lshl_b32 s29, s29, 17
buffer_load_dwordx4 v40, s[8:11], s29 offen lds
s_xor_b32 s29, s76, 4
s_lshl_b32 s28, s29, 10
s_add_u32 s28, s28, s47
s_add_u32 m0, s28, 0
s_lshl_b32 s29, s29, 17
buffer_load_dwordx4 v40, s[8:11], s29 offen lds
s_xor_b32 s29, s76, 5
s_lshl_b32 s28, s29, 10
s_add_u32 s28, s28, s47
s_add_u32 m0, s28, 0
s_lshl_b32 s29, s29, 17
buffer_load_dwordx4 v40, s[8:11], s29 offen lds
s_xor_b32 s29, s76, 6
s_lshl_b32 s28, s29, 10
s_add_u32 s28, s28, s47
s_add_u32 m0, s28, 0
s_lshl_b32 s29, s29, 17
buffer_load_dwordx4 v40, s[8:11], s29 offen lds
s_xor_b32 s29, s76, 7
s_lshl_b32 s28, s29, 10
s_add_u32 s28, s28, s47
s_add_u32 m0, s28, 0
s_lshl_b32 s29, s29, 17
buffer_load_dwordx4 v40, s[8:11], s29 offen lds
s_xor_b32 s29, s76, 8
s_lshl_b32 s28, s29, 10
s_add_u32 s28, s28, s47
s_add_u32 m0, s28, 0
s_lshl_b32 s29, s29, 17
buffer_load_dwordx4 v40, s[8:11], s29 offen lds
s_xor_b32 s29, s76, 9
s_lshl_b32 s28, s29, 10
s_add_u32 s28, s28, s47
s_add_u32 m0, s28, 0
s_lshl_b32 s29, s29, 17
buffer_load_dwordx4 v40, s[8:11], s29 offen lds
s_xor_b32 s29, s76, 10
s_lshl_b32 s28, s29, 10
s_add_u32 s28, s28, s47
s_add_u32 m0, s28, 0
s_lshl_b32 s29, s29, 17
buffer_load_dwordx4 v40, s[8:11], s29 offen lds
s_xor_b32 s29, s76, 11
s_lshl_b32 s28, s29, 10
s_add_u32 s28, s28, s47
s_add_u32 m0, s28, 0
s_lshl_b32 s29, s29, 17
buffer_load_dwordx4 v40, s[8:11], s29 offen lds
s_xor_b32 s29, s76, 12
s_lshl_b32 s28, s29, 10
s_add_u32 s28, s28, s47
s_add_u32 m0, s28, 0
s_lshl_b32 s29, s29, 17
buffer_load_dwordx4 v40, s[8:11], s29 offen lds
s_xor_b32 s29, s76, 13
s_lshl_b32 s28, s29, 10
s_add_u32 s28, s28, s47
s_add_u32 m0, s28, 0
s_lshl_b32 s29, s29, 17
buffer_load_dwordx4 v40, s[8:11], s29 offen lds
s_xor_b32 s29, s76, 14
s_lshl_b32 s28, s29, 10
s_add_u32 s28, s28, s47
s_add_u32 m0, s28, 0
s_lshl_b32 s29, s29, 17
buffer_load_dwordx4 v40, s[8:11], s29 offen lds
s_xor_b32 s29, s76, 15
s_lshl_b32 s28, s29, 10
s_add_u32 s28, s28, s47
s_add_u32 m0, s28, 0
s_lshl_b32 s29, s29, 17
buffer_load_dwordx4 v40, s[8:11], s29 offen lds
buffer_load_dword v50, v51, s[12:15], 0 offen
s_xor_b32 s29, s76, 0
s_lshl_b32 s28, s29, 10
s_add_u32 s28, s28, s47
s_add_u32 m0, s28, 16384
s_lshl_b32 s29, s29, 17
buffer_load_dwordx4 v40, s[12:15], s29 offen lds
s_xor_b32 s29, s76, 1
s_lshl_b32 s28, s29, 10
s_add_u32 s28, s28, s47
s_add_u32 m0, s28, 16384
s_lshl_b32 s29, s29, 17
buffer_load_dwordx4 v40, s[12:15], s29 offen lds
s_xor_b32 s29, s76, 2
s_lshl_b32 s28, s29, 10
s_add_u32 s28, s28, s47
s_add_u32 m0, s28, 16384
s_lshl_b32 s29, s29, 17
buffer_load_dwordx4 v40, s[12:15], s29 offen lds
s_xor_b32 s29, s76, 3
s_lshl_b32 s28, s29, 10
s_add_u32 s28, s28, s47
s_add_u32 m0, s28, 16384
s_lshl_b32 s29, s29, 17
buffer_load_dwordx4 v40, s[12:15], s29 offen lds
s_xor_b32 s29, s76, 4
s_lshl_b32 s28, s29, 10
s_add_u32 s28, s28, s47
s_add_u32 m0, s28, 16384
s_lshl_b32 s29, s29, 17
buffer_load_dwordx4 v40, s[12:15], s29 offen lds
s_xor_b32 s29, s76, 5
s_lshl_b32 s28, s29, 10
s_add_u32 s28, s28, s47
s_add_u32 m0, s28, 16384
s_lshl_b32 s29, s29, 17
buffer_load_dwordx4 v40, s[12:15], s29 offen lds
s_xor_b32 s29, s76, 6
s_lshl_b32 s28, s29, 10
s_add_u32 s28, s28, s47
s_add_u32 m0, s28, 16384
s_lshl_b32 s29, s29, 17
buffer_load_dwordx4 v40, s[12:15], s29 offen lds
s_xor_b32 s29, s76, 7
s_lshl_b32 s28, s29, 10
s_add_u32 s28, s28, s47
s_add_u32 m0, s28, 16384
s_lshl_b32 s29, s29, 17
buffer_load_dwordx4 v40, s[12:15], s29 offen lds
s_xor_b32 s29, s76, 8
s_lshl_b32 s28, s29, 10
s_add_u32 s28, s28, s47
s_add_u32 m0, s28, 16384
s_lshl_b32 s29, s29, 17
buffer_load_dwordx4 v40, s[12:15], s29 offen lds
s_xor_b32 s29, s76, 9
s_lshl_b32 s28, s29, 10
s_add_u32 s28, s28, s47
s_add_u32 m0, s28, 16384
s_lshl_b32 s29, s29, 17
buffer_load_dwordx4 v40, s[12:15], s29 offen lds
s_xor_b32 s29, s76, 10
s_lshl_b32 s28, s29, 10
s_add_u32 s28, s28, s47
s_add_u32 m0, s28, 16384
s_lshl_b32 s29, s29, 17
buffer_load_dwordx4 v40, s[12:15], s29 offen lds
s_xor_b32 s29, s76, 11
s_lshl_b32 s28, s29, 10
s_add_u32 s28, s28, s47
s_add_u32 m0, s28, 16384
s_lshl_b32 s29, s29, 17
buffer_load_dwordx4 v40, s[12:15], s29 offen lds
s_xor_b32 s29, s76, 12
s_lshl_b32 s28, s29, 10
s_add_u32 s28, s28, s47
s_add_u32 m0, s28, 16384
s_lshl_b32 s29, s29, 17
buffer_load_dwordx4 v40, s[12:15], s29 offen lds
s_xor_b32 s29, s76, 13
s_lshl_b32 s28, s29, 10
s_add_u32 s28, s28, s47
s_add_u32 m0, s28, 16384
s_lshl_b32 s29, s29, 17
buffer_load_dwordx4 v40, s[12:15], s29 offen lds
s_xor_b32 s29, s76, 14
s_lshl_b32 s28, s29, 10
s_add_u32 s28, s28, s47
s_add_u32 m0, s28, 16384
s_lshl_b32 s29, s29, 17
buffer_load_dwordx4 v40, s[12:15], s29 offen lds
s_xor_b32 s29, s76, 15
s_lshl_b32 s28, s29, 10
s_add_u32 s28, s28, s47
s_add_u32 m0, s28, 16384
s_lshl_b32 s29, s29, 17
buffer_load_dwordx4 v40, s[12:15], s29 offen lds
s_mov_b32 s40, 0x00ff00ff
s_mov_b32 s41, 0x00ff00ff
s_mov_b32 s48, 0xff00ff00
s_mov_b32 s49, 0xff00ff00
s_mov_b32 s42, 0
s_mov_b32 s43, 0x00ff00ff
s_mov_b32 s32, 0x3e0293ee
v_mov_b32 v23, 0xff800000
v_mov_b32 v6, 0x4444
v_mov_b32 v4, 0xeeee
v_cndmask_b32 v6, v6, v4, s[48:49]
v_mov_b32 v28, -1
v_mov_b32 v29, -1
v_mov_b32 v30, -1
v_mov_b32 v31, -1
s_mul_i32 s28, s24, 4096
v_add_u32 v7, s28, v17
v_and_b32 v4, 7, v1
v_lshlrev_b32 v8, 11, v4
v_lshrrev_b32 v5, 3, v1
v_lshl_add_u32 v8, v5, 4, v8
s_lshl_b32 s28, s24, 9
v_add_u32 v8, s28, v8
s_lshl_b32 s28, s31, 9
s_lshr_b32 s29, s31, 3
s_mul_i32 s29, s29, 0
s_add_u32 s28, s28, s29
v_lshlrev_b32 v9, 3, v1
v_add_u32 v9, s28, v9
v_and_b32 v4, 7, v3
v_lshlrev_b32 v11, 7, v2
v_lshl_add_u32 v11, v4, 4, v11
v_add_u32 v22, 0, v11
s_add_u32 s28, s28, 24576
v_add_u32 v11, s28, v11
v_and_b32 v5, 1, v2
v_lshlrev_b32 v10, 7, v5
v_lshl_add_u32 v10, v4, 4, v10
v_add_u32 v10, 1024, v10
s_xor_b32 s37, s31, 1
s_mul_i32 s37, s37, 1280
s_add_u32 s37, s37, 49152
s_xor_b32 s38, s31, 2
s_mul_i32 s38, s38, 1280
s_add_u32 s38, s38, 49152
s_xor_b32 s39, s31, 3
s_mul_i32 s39, s39, 1280
s_add_u32 s39, s39, 49152
v_and_b32 v4, 1, v2
v_mul_u32_u24 v14, 576, v4
v_lshrrev_b32 v5, 1, v2
v_lshl_add_u32 v5, v5, 4, v3
v_lshl_add_u32 v14, v5, 2, v14
s_mul_i32 s28, s24, 1152
s_add_u32 s28, s28, 13312
v_add_u32 v18, s28, v14
s_mul_i32 s28, s24, 2304
v_add_u32 v14, s28, v14
v_add_u32 v15, 1152, v14
v_mul_u32_u24 v16, 144, v3
v_lshl_add_u32 v16, v2, 5, v16
v_bfe_u32 v4, v1, 1, 3
v_mul_u32_u24 v19, 144, v4
v_lshl_add_u32 v19, v2, 5, v19
v_and_b32 v4, 1, v1
v_lshl_add_u32 v19, v4, 4, v19
v_add_u32 v19, 13312, v19
s_lshl_b32 s28, s24, 10
s_add_u32 s28, s28, 9216
v_add_u32 v20, s28, v17
v_and_b32 v4, 31, v1
v_lshlrev_b32 v21, 3, v4
v_add_u32 v21, 17920, v21
v_lshrrev_b32 v4, 2, v3
v_and_b32 v42, 1, v4
v_lshrrev_b32 v43, 1, v4
v_lshrrev_b32 v44, 1, v2
v_and_b32 v45, 1, v2
v_lshl_add_u32 v46, v44, 4, v42
v_lshl_add_u32 v46, v45, 2, v46
v_lshl_add_u32 v46, v43, 3, v46
v_lshl_add_u32 v47, v44, 3, v42
v_lshl_add_u32 v47, v45, 4, v47
v_lshl_add_u32 v47, v43, 2, v47
v_and_b32 v5, 3, v3
v_lshlrev_b32 v5, 3, v5
v_lshl_add_u32 v46, v46, 6, v5
v_lshl_add_u32 v47, v47, 6, v5
s_and_b32 s28, s31, 0
s_lshl_b32 s28, s28, 6
s_add_u32 s28, s28, s47
v_add_u32 v46, s28, v46
v_add_u32 v47, s28, v47
s_waitcnt vmcnt(17)
ds_read_b64_tr_b16 a[64:65], v46 offset:0
ds_read_b64_tr_b16 a[66:67], v46 offset:128
ds_read_b64_tr_b16 a[68:69], v46 offset:2048
ds_read_b64_tr_b16 a[70:71], v46 offset:2176
ds_read_b64_tr_b16 a[72:73], v46 offset:4096
ds_read_b64_tr_b16 a[74:75], v46 offset:4224
ds_read_b64_tr_b16 a[76:77], v46 offset:6144
ds_read_b64_tr_b16 a[78:79], v46 offset:6272
s_waitcnt lgkmcnt(0)
ds_read_b64_tr_b16 a[80:81], v46 offset:8192
ds_read_b64_tr_b16 a[82:83], v46 offset:8320
ds_read_b64_tr_b16 a[84:85], v46 offset:10240
ds_read_b64_tr_b16 a[86:87], v46 offset:10368
ds_read_b64_tr_b16 a[88:89], v46 offset:12288
ds_read_b64_tr_b16 a[90:91], v46 offset:12416
ds_read_b64_tr_b16 a[92:93], v46 offset:14336
ds_read_b64_tr_b16 a[94:95], v46 offset:14464
s_waitcnt lgkmcnt(0)
ds_read_b64_tr_b16 a[96:97], v46 offset:32
ds_read_b64_tr_b16 a[98:99], v46 offset:160
ds_read_b64_tr_b16 a[100:101], v46 offset:2080
ds_read_b64_tr_b16 a[102:103], v46 offset:2208
ds_read_b64_tr_b16 a[104:105], v46 offset:4128
ds_read_b64_tr_b16 a[106:107], v46 offset:4256
ds_read_b64_tr_b16 a[108:109], v46 offset:6176
ds_read_b64_tr_b16 a[110:111], v46 offset:6304
s_waitcnt lgkmcnt(0)
ds_read_b64_tr_b16 a[112:113], v46 offset:8224
ds_read_b64_tr_b16 a[114:115], v46 offset:8352
ds_read_b64_tr_b16 a[116:117], v46 offset:10272
ds_read_b64_tr_b16 a[118:119], v46 offset:10400
ds_read_b64_tr_b16 a[120:121], v46 offset:12320
ds_read_b64_tr_b16 a[122:123], v46 offset:12448
ds_read_b64_tr_b16 a[124:125], v46 offset:14368
ds_read_b64_tr_b16 a[126:127], v46 offset:14496
s_waitcnt lgkmcnt(0)
buffer_load_dword v50, v51, s[4:7], 0 offen
s_xor_b32 s29, s76, 0
s_lshl_b32 s28, s29, 10
s_add_u32 s28, s28, s47
s_add_u32 m0, s28, 0
s_lshl_b32 s29, s29, 17
buffer_load_dwordx4 v40, s[4:7], s29 offen lds
s_xor_b32 s29, s76, 1
s_lshl_b32 s28, s29, 10
s_add_u32 s28, s28, s47
s_add_u32 m0, s28, 0
s_lshl_b32 s29, s29, 17
buffer_load_dwordx4 v40, s[4:7], s29 offen lds
s_xor_b32 s29, s76, 2
s_lshl_b32 s28, s29, 10
s_add_u32 s28, s28, s47
s_add_u32 m0, s28, 0
s_lshl_b32 s29, s29, 17
buffer_load_dwordx4 v40, s[4:7], s29 offen lds
s_xor_b32 s29, s76, 3
s_lshl_b32 s28, s29, 10
s_add_u32 s28, s28, s47
s_add_u32 m0, s28, 0
s_lshl_b32 s29, s29, 17
buffer_load_dwordx4 v40, s[4:7], s29 offen lds
s_xor_b32 s29, s76, 4
s_lshl_b32 s28, s29, 10
s_add_u32 s28, s28, s47
s_add_u32 m0, s28, 0
s_lshl_b32 s29, s29, 17
buffer_load_dwordx4 v40, s[4:7], s29 offen lds
s_xor_b32 s29, s76, 5
s_lshl_b32 s28, s29, 10
s_add_u32 s28, s28, s47
s_add_u32 m0, s28, 0
s_lshl_b32 s29, s29, 17
buffer_load_dwordx4 v40, s[4:7], s29 offen lds
s_xor_b32 s29, s76, 6
s_lshl_b32 s28, s29, 10
s_add_u32 s28, s28, s47
s_add_u32 m0, s28, 0
s_lshl_b32 s29, s29, 17
buffer_load_dwordx4 v40, s[4:7], s29 offen lds
s_xor_b32 s29, s76, 7
s_lshl_b32 s28, s29, 10
s_add_u32 s28, s28, s47
s_add_u32 m0, s28, 0
s_lshl_b32 s29, s29, 17
buffer_load_dwordx4 v40, s[4:7], s29 offen lds
s_xor_b32 s29, s76, 8
s_lshl_b32 s28, s29, 10
s_add_u32 s28, s28, s47
s_add_u32 m0, s28, 0
s_lshl_b32 s29, s29, 17
buffer_load_dwordx4 v40, s[4:7], s29 offen lds
s_xor_b32 s29, s76, 9
s_lshl_b32 s28, s29, 10
s_add_u32 s28, s28, s47
s_add_u32 m0, s28, 0
s_lshl_b32 s29, s29, 17
buffer_load_dwordx4 v40, s[4:7], s29 offen lds
s_xor_b32 s29, s76, 10
s_lshl_b32 s28, s29, 10
s_add_u32 s28, s28, s47
s_add_u32 m0, s28, 0
s_lshl_b32 s29, s29, 17
buffer_load_dwordx4 v40, s[4:7], s29 offen lds
s_xor_b32 s29, s76, 11
s_lshl_b32 s28, s29, 10
s_add_u32 s28, s28, s47
s_add_u32 m0, s28, 0
s_lshl_b32 s29, s29, 17
buffer_load_dwordx4 v40, s[4:7], s29 offen lds
s_xor_b32 s29, s76, 12
s_lshl_b32 s28, s29, 10
s_add_u32 s28, s28, s47
s_add_u32 m0, s28, 0
s_lshl_b32 s29, s29, 17
buffer_load_dwordx4 v40, s[4:7], s29 offen lds
s_xor_b32 s29, s76, 13
s_lshl_b32 s28, s29, 10
s_add_u32 s28, s28, s47
s_add_u32 m0, s28, 0
s_lshl_b32 s29, s29, 17
buffer_load_dwordx4 v40, s[4:7], s29 offen lds
s_xor_b32 s29, s76, 14
s_lshl_b32 s28, s29, 10
s_add_u32 s28, s28, s47
s_add_u32 m0, s28, 0
s_lshl_b32 s29, s29, 17
buffer_load_dwordx4 v40, s[4:7], s29 offen lds
s_xor_b32 s29, s76, 15
s_lshl_b32 s28, s29, 10
s_add_u32 s28, s28, s47
s_add_u32 m0, s28, 0
s_lshl_b32 s29, s29, 17
buffer_load_dwordx4 v40, s[4:7], s29 offen lds
s_waitcnt vmcnt(17)
ds_read_b64_tr_b16 a[128:129], v46 offset:16384
ds_read_b64_tr_b16 a[130:131], v46 offset:16512
ds_read_b64_tr_b16 a[132:133], v46 offset:18432
ds_read_b64_tr_b16 a[134:135], v46 offset:18560
ds_read_b64_tr_b16 a[136:137], v46 offset:20480
ds_read_b64_tr_b16 a[138:139], v46 offset:20608
ds_read_b64_tr_b16 a[140:141], v46 offset:22528
ds_read_b64_tr_b16 a[142:143], v46 offset:22656
s_waitcnt lgkmcnt(0)
ds_read_b64_tr_b16 a[144:145], v46 offset:24576
ds_read_b64_tr_b16 a[146:147], v46 offset:24704
ds_read_b64_tr_b16 a[148:149], v46 offset:26624
ds_read_b64_tr_b16 a[150:151], v46 offset:26752
ds_read_b64_tr_b16 a[152:153], v46 offset:28672
ds_read_b64_tr_b16 a[154:155], v46 offset:28800
ds_read_b64_tr_b16 a[156:157], v46 offset:30720
ds_read_b64_tr_b16 a[158:159], v46 offset:30848
s_waitcnt lgkmcnt(0)
ds_read_b64_tr_b16 a[160:161], v46 offset:16416
ds_read_b64_tr_b16 a[162:163], v46 offset:16544
ds_read_b64_tr_b16 a[164:165], v46 offset:18464
ds_read_b64_tr_b16 a[166:167], v46 offset:18592
ds_read_b64_tr_b16 a[168:169], v46 offset:20512
ds_read_b64_tr_b16 a[170:171], v46 offset:20640
ds_read_b64_tr_b16 a[172:173], v46 offset:22560
ds_read_b64_tr_b16 a[174:175], v46 offset:22688
s_waitcnt lgkmcnt(0)
ds_read_b64_tr_b16 a[176:177], v46 offset:24608
ds_read_b64_tr_b16 a[178:179], v46 offset:24736
ds_read_b64_tr_b16 a[180:181], v46 offset:26656
ds_read_b64_tr_b16 a[182:183], v46 offset:26784
ds_read_b64_tr_b16 a[184:185], v46 offset:28704
ds_read_b64_tr_b16 a[186:187], v46 offset:28832
ds_read_b64_tr_b16 a[188:189], v46 offset:30752
ds_read_b64_tr_b16 a[190:191], v46 offset:30880
s_waitcnt lgkmcnt(0)
buffer_load_dword v50, v52, s[16:19], 0 offen
s_xor_b32 s29, s76, 0
s_lshl_b32 s28, s29, 10
s_add_u32 s28, s28, s47
s_add_u32 m0, s28, 16384
s_lshl_b32 s29, s29, 15
buffer_load_dwordx4 v41, s[16:19], s29 offen lds
s_xor_b32 s29, s76, 1
s_lshl_b32 s28, s29, 10
s_add_u32 s28, s28, s47
s_add_u32 m0, s28, 16384
s_lshl_b32 s29, s29, 15
buffer_load_dwordx4 v41, s[16:19], s29 offen lds
s_xor_b32 s29, s76, 2
s_lshl_b32 s28, s29, 10
s_add_u32 s28, s28, s47
s_add_u32 m0, s28, 16384
s_lshl_b32 s29, s29, 15
buffer_load_dwordx4 v41, s[16:19], s29 offen lds
s_xor_b32 s29, s76, 3
s_lshl_b32 s28, s29, 10
s_add_u32 s28, s28, s47
s_add_u32 m0, s28, 16384
s_lshl_b32 s29, s29, 15
buffer_load_dwordx4 v41, s[16:19], s29 offen lds
s_xor_b32 s29, s76, 4
s_lshl_b32 s28, s29, 10
s_add_u32 s28, s28, s47
s_add_u32 m0, s28, 16384
s_lshl_b32 s29, s29, 15
buffer_load_dwordx4 v41, s[16:19], s29 offen lds
s_xor_b32 s29, s76, 5
s_lshl_b32 s28, s29, 10
s_add_u32 s28, s28, s47
s_add_u32 m0, s28, 16384
s_lshl_b32 s29, s29, 15
buffer_load_dwordx4 v41, s[16:19], s29 offen lds
s_xor_b32 s29, s76, 6
s_lshl_b32 s28, s29, 10
s_add_u32 s28, s28, s47
s_add_u32 m0, s28, 16384
s_lshl_b32 s29, s29, 15
buffer_load_dwordx4 v41, s[16:19], s29 offen lds
s_xor_b32 s29, s76, 7
s_lshl_b32 s28, s29, 10
s_add_u32 s28, s28, s47
s_add_u32 m0, s28, 16384
s_lshl_b32 s29, s29, 15
buffer_load_dwordx4 v41, s[16:19], s29 offen lds
s_xor_b32 s29, s76, 8
s_lshl_b32 s28, s29, 10
s_add_u32 s28, s28, s47
s_add_u32 m0, s28, 16384
s_lshl_b32 s29, s29, 15
buffer_load_dwordx4 v41, s[16:19], s29 offen lds
s_xor_b32 s29, s76, 9
s_lshl_b32 s28, s29, 10
s_add_u32 s28, s28, s47
s_add_u32 m0, s28, 16384
s_lshl_b32 s29, s29, 15
buffer_load_dwordx4 v41, s[16:19], s29 offen lds
s_xor_b32 s29, s76, 10
s_lshl_b32 s28, s29, 10
s_add_u32 s28, s28, s47
s_add_u32 m0, s28, 16384
s_lshl_b32 s29, s29, 15
buffer_load_dwordx4 v41, s[16:19], s29 offen lds
s_xor_b32 s29, s76, 11
s_lshl_b32 s28, s29, 10
s_add_u32 s28, s28, s47
s_add_u32 m0, s28, 16384
s_lshl_b32 s29, s29, 15
buffer_load_dwordx4 v41, s[16:19], s29 offen lds
s_xor_b32 s29, s76, 12
s_lshl_b32 s28, s29, 10
s_add_u32 s28, s28, s47
s_add_u32 m0, s28, 16384
s_lshl_b32 s29, s29, 15
buffer_load_dwordx4 v41, s[16:19], s29 offen lds
s_xor_b32 s29, s76, 13
s_lshl_b32 s28, s29, 10
s_add_u32 s28, s28, s47
s_add_u32 m0, s28, 16384
s_lshl_b32 s29, s29, 15
buffer_load_dwordx4 v41, s[16:19], s29 offen lds
s_xor_b32 s29, s76, 14
s_lshl_b32 s28, s29, 10
s_add_u32 s28, s28, s47
s_add_u32 m0, s28, 16384
s_lshl_b32 s29, s29, 15
buffer_load_dwordx4 v41, s[16:19], s29 offen lds
s_xor_b32 s29, s76, 15
s_lshl_b32 s28, s29, 10
s_add_u32 s28, s28, s47
s_add_u32 m0, s28, 16384
s_lshl_b32 s29, s29, 15
buffer_load_dwordx4 v41, s[16:19], s29 offen lds
s_mov_b64 exec, 0
s_cmp_eq_u32 s24, 0
s_cbranch_scc1 mega_kernel_rs_iw0
s_cmp_eq_u32 s24, 1
s_cbranch_scc1 mega_kernel_rs_iw1
s_cmp_eq_u32 s24, 2
s_cbranch_scc1 mega_kernel_rs_iw2
s_branch mega_kernel_rs_iw3
mega_kernel_rs_iwd:
s_mov_b64 exec, -1
s_waitcnt vmcnt(17)
ds_read_b64_tr_b16 a[0:1], v46 offset:0
ds_read_b64_tr_b16 a[2:3], v46 offset:128
ds_read_b64_tr_b16 a[4:5], v46 offset:2048
ds_read_b64_tr_b16 a[6:7], v46 offset:2176
ds_read_b64_tr_b16 a[8:9], v46 offset:4096
ds_read_b64_tr_b16 a[10:11], v46 offset:4224
ds_read_b64_tr_b16 a[12:13], v46 offset:6144
ds_read_b64_tr_b16 a[14:15], v46 offset:6272
s_waitcnt lgkmcnt(0)
ds_read_b64_tr_b16 a[16:17], v46 offset:8192
ds_read_b64_tr_b16 a[18:19], v46 offset:8320
ds_read_b64_tr_b16 a[20:21], v46 offset:10240
ds_read_b64_tr_b16 a[22:23], v46 offset:10368
ds_read_b64_tr_b16 a[24:25], v46 offset:12288
ds_read_b64_tr_b16 a[26:27], v46 offset:12416
ds_read_b64_tr_b16 a[28:29], v46 offset:14336
ds_read_b64_tr_b16 a[30:31], v46 offset:14464
s_waitcnt lgkmcnt(0)
ds_read_b64_tr_b16 a[32:33], v46 offset:32
ds_read_b64_tr_b16 a[34:35], v46 offset:160
ds_read_b64_tr_b16 a[36:37], v46 offset:2080
ds_read_b64_tr_b16 a[38:39], v46 offset:2208
ds_read_b64_tr_b16 a[40:41], v46 offset:4128
ds_read_b64_tr_b16 a[42:43], v46 offset:4256
ds_read_b64_tr_b16 a[44:45], v46 offset:6176
ds_read_b64_tr_b16 a[46:47], v46 offset:6304
s_waitcnt lgkmcnt(0)
ds_read_b64_tr_b16 a[48:49], v46 offset:8224
ds_read_b64_tr_b16 a[50:51], v46 offset:8352
ds_read_b64_tr_b16 a[52:53], v46 offset:10272
ds_read_b64_tr_b16 a[54:55], v46 offset:10400
ds_read_b64_tr_b16 a[56:57], v46 offset:12320
ds_read_b64_tr_b16 a[58:59], v46 offset:12448
ds_read_b64_tr_b16 a[60:61], v46 offset:14368
ds_read_b64_tr_b16 a[62:63], v46 offset:14496
s_waitcnt lgkmcnt(0)
v_and_b32 v247, 15, v0
v_lshlrev_b32 v247, 4, v247
buffer_load_dword v246, v247, s[72:75], 0 offen sc1
buffer_load_dwordx4 v[64:67], v8, s[20:23], 0 offen offset:0
buffer_load_dwordx4 v[68:71], v8, s[20:23], 0 offen offset:128
buffer_load_dwordx4 v[72:75], v8, s[20:23], 0 offen offset:256
buffer_load_dwordx4 v[76:79], v8, s[20:23], 0 offen offset:384
s_waitcnt vmcnt(0)
ds_read_b64_tr_b16 a[192:193], v47 offset:16384
ds_read_b64_tr_b16 a[194:195], v47 offset:16512
ds_read_b64_tr_b16 a[196:197], v47 offset:18432
ds_read_b64_tr_b16 a[198:199], v47 offset:18560
ds_read_b64_tr_b16 a[200:201], v47 offset:20480
ds_read_b64_tr_b16 a[202:203], v47 offset:20608
ds_read_b64_tr_b16 a[204:205], v47 offset:22528
ds_read_b64_tr_b16 a[206:207], v47 offset:22656
s_waitcnt lgkmcnt(0)
ds_read_b64_tr_b16 a[208:209], v47 offset:24576
ds_read_b64_tr_b16 a[210:211], v47 offset:24704
ds_read_b64_tr_b16 a[212:213], v47 offset:26624
ds_read_b64_tr_b16 a[214:215], v47 offset:26752
ds_read_b64_tr_b16 a[216:217], v47 offset:28672
ds_read_b64_tr_b16 a[218:219], v47 offset:28800
ds_read_b64_tr_b16 a[220:221], v47 offset:30720
ds_read_b64_tr_b16 a[222:223], v47 offset:30848
s_waitcnt lgkmcnt(0)
ds_read_b64_tr_b16 a[224:225], v47 offset:16416
ds_read_b64_tr_b16 a[226:227], v47 offset:16544
ds_read_b64_tr_b16 a[228:229], v47 offset:18464
ds_read_b64_tr_b16 a[230:231], v47 offset:18592
ds_read_b64_tr_b16 a[232:233], v47 offset:20512
ds_read_b64_tr_b16 a[234:235], v47 offset:20640
ds_read_b64_tr_b16 a[236:237], v47 offset:22560
ds_read_b64_tr_b16 a[238:239], v47 offset:22688
s_waitcnt lgkmcnt(0)
ds_read_b64_tr_b16 a[240:241], v47 offset:24608
ds_read_b64_tr_b16 a[242:243], v47 offset:24736
ds_read_b64_tr_b16 a[244:245], v47 offset:26656
ds_read_b64_tr_b16 a[246:247], v47 offset:26784
ds_read_b64_tr_b16 a[248:249], v47 offset:28704
ds_read_b64_tr_b16 a[250:251], v47 offset:28832
ds_read_b64_tr_b16 a[252:253], v47 offset:30752
ds_read_b64_tr_b16 a[254:255], v47 offset:30880
s_waitcnt lgkmcnt(0)
v_mov_b32 v32, v64
v_mov_b32 v33, v65
v_mov_b32 v34, v66
v_mov_b32 v35, v67
v_mov_b32 v36, v68
v_mov_b32 v37, v69
v_mov_b32 v38, v70
v_mov_b32 v39, v71
v_mov_b32 v40, v72
v_mov_b32 v41, v73
v_mov_b32 v42, v74
v_mov_b32 v43, v75
v_mov_b32 v44, v76
v_mov_b32 v45, v77
v_mov_b32 v46, v78
v_mov_b32 v47, v79
v_mov_b32 v96, 0
v_mov_b32 v97, 0
v_mov_b32 v98, 0
v_mov_b32 v99, 0
v_mov_b32 v100, 0
v_mov_b32 v101, 0
v_mov_b32 v102, 0
v_mov_b32 v103, 0
v_mov_b32 v104, 0
v_mov_b32 v105, 0
v_mov_b32 v106, 0
v_mov_b32 v107, 0
v_mov_b32 v108, 0
v_mov_b32 v109, 0
v_mov_b32 v110, 0
v_mov_b32 v111, 0
v_mov_b32 v112, 0
v_mov_b32 v113, 0
v_mov_b32 v114, 0
v_mov_b32 v115, 0
v_mov_b32 v116, 0
v_mov_b32 v117, 0
v_mov_b32 v118, 0
v_mov_b32 v119, 0
s_nop 1
v_smfmac_f32_16x16x64_bf16 v[96:99], v[32:35], a[0:7], v6
v_smfmac_f32_16x16x64_bf16 v[100:103], v[32:35], a[32:39], v6
v_smfmac_f32_16x16x64_bf16 v[104:107], v[32:35], a[64:71], v6
v_smfmac_f32_16x16x64_bf16 v[108:111], v[32:35], a[96:103], v6
v_smfmac_f32_16x16x64_bf16 v[96:99], v[36:39], a[8:15], v6
v_smfmac_f32_16x16x64_bf16 v[100:103], v[36:39], a[40:47], v6
v_smfmac_f32_16x16x64_bf16 v[104:107], v[36:39], a[72:79], v6
v_smfmac_f32_16x16x64_bf16 v[108:111], v[36:39], a[104:111], v6
v_smfmac_f32_16x16x64_bf16 v[96:99], v[40:43], a[16:23], v6
v_smfmac_f32_16x16x64_bf16 v[100:103], v[40:43], a[48:55], v6
v_smfmac_f32_16x16x64_bf16 v[104:107], v[40:43], a[80:87], v6
v_smfmac_f32_16x16x64_bf16 v[108:111], v[40:43], a[112:119], v6
v_smfmac_f32_16x16x64_bf16 v[96:99], v[44:47], a[24:31], v6
v_smfmac_f32_16x16x64_bf16 v[100:103], v[44:47], a[56:63], v6
v_smfmac_f32_16x16x64_bf16 v[104:107], v[44:47], a[88:95], v6
v_smfmac_f32_16x16x64_bf16 v[108:111], v[44:47], a[120:127], v6
v_and_b32 v247, 15, v0
v_lshlrev_b32 v247, 4, v247
s_branch mega_kernel_sysp
mega_kernel_sysw:
s_sleep 4
mega_kernel_sys:
buffer_load_dword v246, v247, s[72:75], 0 offen sc1
s_waitcnt vmcnt(0)
mega_kernel_sysp:
s_cmp_eq_u32 s95, 1
s_cbranch_scc0 mega_kernel_sysf
v_readlane_b32 s76, v246, 14
s_mov_b32 s98, 0
s_cmp_eq_u32 s76, 32
s_cbranch_scc0 mega_kernel_sysw
s_branch mega_kernel_sysd
mega_kernel_sysf:
s_mov_b32 s77, 0
s_mov_b32 s78, 0
v_readlane_b32 s76, v246, 0
s_add_u32 s77, s77, s76
s_xor_b32 s76, s76, 32
s_or_b32 s78, s78, s76
v_readlane_b32 s76, v246, 1
s_add_u32 s77, s77, s76
s_xor_b32 s76, s76, 32
s_or_b32 s78, s78, s76
v_readlane_b32 s76, v246, 2
s_add_u32 s77, s77, s76
s_xor_b32 s76, s76, 32
s_or_b32 s78, s78, s76
v_readlane_b32 s76, v246, 3
s_add_u32 s77, s77, s76
s_xor_b32 s76, s76, 32
s_or_b32 s78, s78, s76
v_readlane_b32 s76, v246, 4
s_add_u32 s77, s77, s76
s_xor_b32 s76, s76, 32
s_or_b32 s78, s78, s76
v_readlane_b32 s76, v246, 5
s_add_u32 s77, s77, s76
s_xor_b32 s76, s76, 32
s_or_b32 s78, s78, s76
v_readlane_b32 s76, v246, 6
s_add_u32 s77, s77, s76
s_xor_b32 s76, s76, 32
s_or_b32 s78, s78, s76
v_readlane_b32 s76, v246, 7
s_add_u32 s77, s77, s76
s_xor_b32 s76, s76, 32
s_or_b32 s78, s78, s76
s_cmp_eq_u32 s77, 256
s_cbranch_scc0 mega_kernel_sysw
v_mov_b32 v252, v246
s_cmp_eq_u32 s78, 0
s_cbranch_scc0 mega_kernel_slowent
v_readlane_b32 s76, v246, 10
v_readlane_b32 s77, v246, 8
s_cmp_eq_u32 s76, 32
s_cbranch_scc0 mega_kernel_sysw
s_cmp_gt_u32 s77, 16
s_cselect_b32 s98, 1, 0
mega_kernel_sysd:
s_lshr_b32 s28, s31, 4
s_lshl_b32 s28, s28, 14
s_lshl_b32 s29, s98, 13
s_add_u32 s28, s28, s29
s_and_b32 s29, s31, 15
s_lshl_b32 s29, s29, 9
s_add_u32 s28, s28, s29
s_lshl_b32 s29, s30, 16
s_add_u32 s28, s28, s29
s_add_u32 s28, s28, 67108864
v_lshrrev_b32 v12, 1, v17
v_add_u32 v12, s28, v12
v_xor_b32 v25, 0x10000, v12
v_xor_b32 v26, 0x20000, v12
v_xor_b32 v27, 0x30000, v12
v_add_u32 v25, 0, v25
v_add_u32 v26, 0, v26
v_add_u32 v27, 0, v27
s_lshl_b32 s28, s25, 2
s_add_u32 s28, s28, s26
s_mov_b32 s82, s28
s_lshr_b32 s29, s28, 3
s_xor_b32 s29, s29, s98
s_and_b32 s29, s29, 1
s_lshl_b32 s29, s29, 13
s_lshl_b32 s76, s28, 18
s_add_u32 s76, s76, s29
s_mov_b32 s83, s76
v_add_u32 v240, s76, v17
v_add_u32 v241, 33554432, v240
s_lshr_b32 s29, s28, 4
s_xor_b32 s29, s29, s98
s_and_b32 s29, s29, 1
s_lshl_b32 s29, s29, 13
s_lshl_b32 s79, s28, 17
s_add_u32 s79, s79, s29
s_add_u32 s79, s79, 71303168
s_xor_b32 s29, s98, 1
s_lshl_b32 s29, s29, 13
s_lshl_b32 s28, s25, 7
s_add_u32 s28, s28, s29
s_add_u32 s28, s28, 69206016
v_and_b32 v4, 1, v1
v_lshlrev_b32 v24, 12, v4
v_add_u32 v24, s28, v24
s_lshl_b32 s29, s26, 2
v_add_u32 v24, s29, v24
s_xor_b32 s81, s98, 1
s_lshl_b32 s81, s81, 13
s_lshr_b32 s29, s82, 6
s_lshl_b32 s29, s29, 14
s_add_u32 s81, s81, s29
s_and_b32 s29, s82, 63
s_lshl_b32 s29, s29, 7
s_add_u32 s81, s81, s29
s_add_u32 s81, s81, 69222400
v_mov_b32 v220, 0x3f803f80
v_mov_b32 v221, 0x3f803f80
v_mov_b32 v222, 0x3f803f80
v_mov_b32 v223, 0x3f803f80
v_mov_b32 v228, 0
s_mov_b32 s27, 0
s_mov_b32 s46, 0
s_mov_b32 s89, 0
s_mov_b32 s88, 0
s_mov_b32 s44, 18432
s_mov_b32 s45, 18432
s_cmp_eq_u32 s24, 3
s_cbranch_scc0 mega_kernel_rs_pfi
s_mov_b32 s76, 0
s_cmp_gt_i32 s46, s76
s_cbranch_scc1 mega_kernel_rs_pf0ok
mega_kernel_rs_pf0w:
v_mov_b32 v4, 0
s_mov_b64 exec, 3
buffer_atomic_add v4, v24, s[84:87], 0 offen sc0 sc1
s_mov_b64 exec, -1
s_waitcnt vmcnt(0)
v_readlane_b32 s46, v4, 0
v_readlane_b32 s28, v4, 1
s_nop 1
s_min_i32 s46, s46, s28
s_cmp_gt_i32 s46, s76
s_cbranch_scc0 mega_kernel_rs_pf0w
mega_kernel_rs_pf0ok:
s_add_u32 s77, s76, s82
s_bfe_u32 s28, s77, 0x40002
s_lshl_b32 s28, s28, 14
s_and_b32 s77, s77, 3
s_lshl_b32 s77, s77, 11
s_add_u32 s28, s28, s77
s_add_u32 m0, s45, 0
s_nop 0
buffer_load_dwordx4 v240, s[84:87], s28 offen offset:0 sc1 lds
s_add_u32 m0, s45, 0
s_nop 0
buffer_load_dwordx4 v240, s[84:87], s28 offen offset:1024 sc1 lds
s_add_u32 m0, s45, 2048
s_nop 0
buffer_load_dwordx4 v241, s[84:87], s28 offen offset:0 sc1 lds
s_add_u32 m0, s45, 2048
s_nop 0
buffer_load_dwordx4 v241, s[84:87], s28 offen offset:1024 sc1 lds
s_add_u32 s45, s45, 4096
s_cmp_eq_u32 s45, 30720
s_cselect_b32 s45, 18432, s45
s_waitcnt vmcnt(0) lgkmcnt(0)
s_branch mega_kernel_rs_pfj
mega_kernel_rs_pfi:
s_lshr_b32 s88, s25, 2
s_lshl_b32 s88, s88, 17
s_and_b32 s77, s25, 2
s_lshl_b32 s77, s77, 13
s_add_u32 s88, s88, s77
s_and_b32 s77, s25, 1
s_lshl_b32 s77, s77, 12
s_add_u32 s88, s88, s77
s_xor_b32 s77, s98, 0
s_lshl_b32 s77, s77, 13
s_add_u32 s88, s88, s77
s_add_u32 s88, s88, 68255744
s_lshl_b32 s77, s26, 10
s_add_u32 s88, s88, s77
mega_kernel_rs_pfj:
v_mov_b32 v184, 0
v_mov_b32 v185, 0
v_mov_b32 v186, 0
v_mov_b32 v187, 0
v_mov_b32 v188, 0
v_mov_b32 v189, 0
v_mov_b32 v190, 0
v_mov_b32 v191, 0
v_mov_b32 v192, 0
v_mov_b32 v193, 0
v_mov_b32 v194, 0
v_mov_b32 v195, 0
v_mov_b32 v196, 0
v_mov_b32 v197, 0
v_mov_b32 v198, 0
v_mov_b32 v199, 0
v_mov_b32 v200, 0
v_mov_b32 v201, 0
v_mov_b32 v202, 0
v_mov_b32 v203, 0
v_mov_b32 v204, 0
v_mov_b32 v205, 0
v_mov_b32 v206, 0
v_mov_b32 v207, 0
v_mov_b32 v249, 0
v_cndmask_b32 v242, -16, v10, s[42:43]
v_mov_b32 v60, 0
v_mov_b32 v61, 0
v_mov_b32 v62, 0
v_mov_b32 v63, 0
s_waitcnt lgkmcnt(0)
s_barrier
s_and_b32 s29, s27, 1
s_lshl_b32 s33, s29, 17
s_lshl_b32 s28, s30, 18
s_add_u32 s33, s33, s28
s_add_u32 s33, s33, 68157440
s_xor_b32 s34, s33, 131072
s_lshl_b32 s35, s29, 18
s_bfe_u32 s47, s27, 0x10001
s_branch mega_kernel_rs_first
.p2align 6
s_nop 0
s_nop 0
mega_kernel_rs_loop:
buffer_load_dwordx4 v[32:35], v7, s[84:87], s33 offen offset:0 sc1
v_add_u32 v5, s44, v17
ds_read_b128 v[156:159], v5 offset:0
ds_read_b128 v[160:163], v5 offset:1024
ds_read_b128 v[164:167], v5 offset:2048
ds_read_b128 v[168:171], v5 offset:3072
s_nop 4
buffer_load_dwordx4 v[36:39], v7, s[84:87], s33 offen offset:1024 sc1
s_nop 9
buffer_load_dwordx4 v[40:43], v7, s[84:87], s33 offen offset:2048 sc1
s_nop 9
buffer_load_dwordx4 v[44:47], v7, s[84:87], s33 offen offset:3072 sc1
s_waitcnt vmcnt(3)
v_max_u32 v4, v32, v34
v_cmp_eq_u32 vcc, -1, v4
s_cbranch_vccnz mega_kernel_rs_pa_15_0f
v_smfmac_f32_16x16x64_bf16 v[96:99], v[32:35], a[0:7], v6
v_smfmac_f32_16x16x64_bf16 v[100:103], v[32:35], a[32:39], v6
v_smfmac_f32_16x16x64_bf16 v[104:107], v[32:35], a[64:71], v6
s_waitcnt vmcnt(2)
v_max_u32 v4, v36, v38
v_cmp_eq_u32 vcc, -1, v4
v_smfmac_f32_16x16x64_bf16 v[108:111], v[32:35], a[96:103], v6
s_cbranch_vccnz mega_kernel_rs_pa_14_1f
v_smfmac_f32_16x16x64_bf16 v[96:99], v[36:39], a[8:15], v6
v_smfmac_f32_16x16x64_bf16 v[100:103], v[36:39], a[40:47], v6
v_smfmac_f32_16x16x64_bf16 v[104:107], v[36:39], a[72:79], v6
s_waitcnt vmcnt(1)
v_max_u32 v4, v40, v42
v_cmp_eq_u32 vcc, -1, v4
v_smfmac_f32_16x16x64_bf16 v[108:111], v[36:39], a[104:111], v6
s_cbranch_vccnz mega_kernel_rs_pa_12_2f
v_smfmac_f32_16x16x64_bf16 v[96:99], v[40:43], a[16:23], v6
v_smfmac_f32_16x16x64_bf16 v[100:103], v[40:43], a[48:55], v6
v_smfmac_f32_16x16x64_bf16 v[104:107], v[40:43], a[80:87], v6
s_waitcnt vmcnt(0)
v_max_u32 v4, v44, v46
v_cmp_eq_u32 vcc, -1, v4
v_smfmac_f32_16x16x64_bf16 v[108:111], v[40:43], a[112:119], v6
s_cbranch_vccnz mega_kernel_rs_pa_8_3f
v_smfmac_f32_16x16x64_bf16 v[96:99], v[44:47], a[24:31], v6
v_smfmac_f32_16x16x64_bf16 v[100:103], v[44:47], a[56:63], v6
v_smfmac_f32_16x16x64_bf16 v[104:107], v[44:47], a[88:95], v6
v_smfmac_f32_16x16x64_bf16 v[108:111], v[44:47], a[120:127], v6
mega_kernel_rs_pa_d:
mega_kernel_rs_adone:
s_nop 5
v_permlane32_swap_b32 v96, v100
v_permlane32_swap_b32 v97, v101
v_permlane32_swap_b32 v98, v102
v_permlane32_swap_b32 v99, v103
v_pk_add_f32 v[96:97], v[96:97], v[100:101]
v_pk_add_f32 v[98:99], v[98:99], v[102:103]
ds_write2_b32 v14, v96, v97 offset0:0 offset1:36
ds_write2_b32 v14, v98, v99 offset0:72 offset1:108
v_permlane32_swap_b32 v104, v108
v_permlane32_swap_b32 v105, v109
v_permlane32_swap_b32 v106, v110
v_permlane32_swap_b32 v107, v111
v_pk_add_f32 v[104:105], v[104:105], v[108:109]
v_pk_add_f32 v[106:107], v[106:107], v[110:111]
ds_write2_b32 v15, v104, v105 offset0:0 offset1:36
ds_write2_b32 v15, v106, v107 offset0:72 offset1:108
v_smfmac_f32_16x16x64_bf16 v[112:115], v[32:35], a[128:135], v6
v_smfmac_f32_16x16x64_bf16 v[116:119], v[32:35], a[160:167], v6
v_smfmac_f32_16x16x64_bf16 v[112:115], v[36:39], a[136:143], v6
v_smfmac_f32_16x16x64_bf16 v[116:119], v[36:39], a[168:175], v6
s_cmp_lg_u32 s24, 0
s_waitcnt lgkmcnt(0)
s_barrier
s_cbranch_scc1 mega_kernel_rs_side
ds_read_b128 v[120:123], v16 offset:0
ds_read_b128 v[124:127], v16 offset:16
ds_read_b128 v[128:131], v16 offset:2304
ds_read_b128 v[132:135], v16 offset:2320
ds_read_b128 v[136:139], v16 offset:4608
ds_read_b128 v[140:143], v16 offset:4624
ds_read_b128 v[144:147], v16 offset:6912
ds_read_b128 v[148:151], v16 offset:6928
v_smfmac_f32_16x16x64_bf16 v[112:115], v[40:43], a[144:151], v6
v_smfmac_f32_16x16x64_bf16 v[116:119], v[40:43], a[176:183], v6
v_smfmac_f32_16x16x64_bf16 v[112:115], v[44:47], a[152:159], v6
v_smfmac_f32_16x16x64_bf16 v[116:119], v[44:47], a[184:191], v6
s_mul_i32 s28, s31, 1280
s_add_u32 s28, s28, s33
s_add_u32 s28, s28, 49152
s_add_u32 s76, s37, s33
s_add_u32 s77, s38, s33
s_add_u32 s78, s39, s33
s_waitcnt lgkmcnt(4)
v_pk_add_f32 v[120:121], v[120:121], v[128:129]
v_pk_add_f32 v[122:123], v[122:123], v[130:131]
v_pk_add_f32 v[124:125], v[124:125], v[132:133]
v_pk_add_f32 v[126:127], v[126:127], v[134:135]
s_waitcnt lgkmcnt(0)
v_pk_add_f32 v[136:137], v[136:137], v[144:145]
v_pk_add_f32 v[138:139], v[138:139], v[146:147]
v_pk_add_f32 v[140:141], v[140:141], v[148:149]
v_pk_add_f32 v[142:143], v[142:143], v[150:151]
v_pk_add_f32 v[120:121], v[120:121], v[136:137]
v_pk_add_f32 v[122:123], v[122:123], v[138:139]
v_pk_add_f32 v[124:125], v[124:125], v[140:141]
v_pk_add_f32 v[126:127], v[126:127], v[142:143]
v_cvt_pk_bf16_f32 v152, v120, v121
v_cvt_pk_bf16_f32 v153, v122, v123
v_cvt_pk_bf16_f32 v154, v124, v125
v_cvt_pk_bf16_f32 v155, v126, v127
s_nop 1
v_mfma_f32_16x16x32_bf16 v[176:179], v[160:163], v[152:155], 0
v_mfma_f32_16x16x32_bf16 v[172:175], v[156:159], v[152:155], 0
v_mfma_f32_16x16x32_bf16 v[180:183], v[152:155], v[152:155], 0
s_cmp_eq_u32 s27, 63
s_cbranch_scc1 mega_kernel_rs_w0last
s_nop 4
v_mov_b32_dpp v172, v176 row_shr:8 row_mask:0xf bank_mask:0xc
v_mov_b32_dpp v173, v177 row_shr:8 row_mask:0xf bank_mask:0xc
v_mov_b32_dpp v174, v178 row_shr:8 row_mask:0xf bank_mask:0xc
v_mov_b32_dpp v175, v179 row_shr:8 row_mask:0xf bank_mask:0xc
v_min_u32 v172, -2, v172
buffer_store_dwordx4 v[172:175], v17, s[84:87], s28 offen sc1
v_min_u32 v180, -2, v180
buffer_store_dwordx4 v[180:183], v242, s[84:87], s28 offen sc1
v_permlane32_swap_b32 v112, v116
v_permlane32_swap_b32 v113, v117
v_permlane32_swap_b32 v114, v118
v_permlane32_swap_b32 v115, v119
v_pk_add_f32 v[112:113], v[112:113], v[116:117]
v_pk_add_f32 v[114:115], v[114:115], v[118:119]
ds_write_b128 v20, v[112:115]
s_waitcnt lgkmcnt(0)
s_barrier
v_mov_b32 v96, 0
v_mov_b32 v97, 0
v_mov_b32 v98, 0
v_mov_b32 v99, 0
v_mov_b32 v100, 0
v_mov_b32 v101, 0
v_mov_b32 v102, 0
v_mov_b32 v103, 0
v_cndmask_b32 v176, v23, v180, s[42:43]
v_cndmask_b32 v177, v23, v181, s[42:43]
v_cndmask_b32 v178, v23, v182, s[42:43]
v_cndmask_b32 v179, v23, v183, s[42:43]
s_mov_b64 exec, s[42:43]
buffer_load_dwordx4 v[188:191], v10, s[84:87], s76 offen sc1
buffer_load_dwordx4 v[196:199], v10, s[84:87], s77 offen sc1
buffer_load_dwordx4 v[204:207], v10, s[84:87], s78 offen sc1
s_mov_b64 exec, -1
buffer_load_dwordx4 v[184:187], v17, s[84:87], s76 offen sc1
buffer_load_dwordx4 v[192:195], v17, s[84:87], s77 offen sc1
buffer_load_dwordx4 v[200:203], v17, s[84:87], s78 offen sc1
v_pk_mul_f32 v[172:173], v[172:173], s[32:33] op_sel_hi:[1,0]
v_pk_mul_f32 v[174:175], v[174:175], s[32:33] op_sel_hi:[1,0]
v_pk_mul_f32 v[176:177], v[176:177], s[32:33] op_sel_hi:[1,0]
v_pk_mul_f32 v[178:179], v[178:179], s[32:33] op_sel_hi:[1,0]
s_lshl_b32 s89, s47, 31
s_or_b32 s89, s89, 0x3b39999a
s_nop 15
s_nop 1
s_mov_b64 exec, s[42:43]
buffer_load_dwordx4 v[188:191], v10, s[84:87], s76 offen sc1
buffer_load_dwordx4 v[196:199], v10, s[84:87], s77 offen sc1
buffer_load_dwordx4 v[204:207], v10, s[84:87], s78 offen sc1
s_mov_b64 exec, -1
buffer_load_dwordx4 v[184:187], v17, s[84:87], s76 offen sc1
buffer_load_dwordx4 v[192:195], v17, s[84:87], s77 offen sc1
buffer_load_dwordx4 v[200:203], v17, s[84:87], s78 offen sc1
mega_kernel_rs_p2:
s_waitcnt vmcnt(6)
v_max3_u32 v4, v184, v188, v192
v_max3_u32 v5, v196, v200, v204
v_max_u32 v4, v4, v5
v_cmp_eq_u32 vcc, -1, v4
s_cbranch_vccnz mega_kernel_rs_p2r
v_pk_add_f32 v[124:125], v[196:197], v[204:205]
v_pk_add_f32 v[126:127], v[198:199], v[206:207]
v_pk_add_f32 v[120:121], v[192:193], v[200:201]
v_pk_add_f32 v[122:123], v[194:195], v[202:203]
v_pk_add_f32 v[124:125], v[124:125], v[188:189]
v_pk_add_f32 v[126:127], v[126:127], v[190:191]
v_pk_add_f32 v[120:121], v[120:121], v[184:185]
v_pk_add_f32 v[122:123], v[122:123], v[186:187]
v_pk_fma_f32 v[176:177], v[124:125], s[32:33], v[176:177] op_sel_hi:[1,0,1]
v_pk_fma_f32 v[178:179], v[126:127], s[32:33], v[178:179] op_sel_hi:[1,0,1]
v_pk_fma_f32 v[172:173], v[120:121], s[32:33], v[172:173] op_sel_hi:[1,0,1]
v_pk_fma_f32 v[174:175], v[122:123], s[32:33], v[174:175] op_sel_hi:[1,0,1]
v_max3_f32 v232, v172, v173, v174
v_max3_f32 v233, v176, v177, v178
v_max3_f32 v232, v232, v175, v179
v_max_f32 v234, v232, v233
s_barrier
ds_read2_b64 v[208:211], v21 offset0:0 offset1:32
v_max_f32_dpp v232, v234, v234 row_ror:8 row_mask:0xf bank_mask:0xf
v_max_f32_dpp v233, v234, v234 row_ror:8 row_mask:0xf bank_mask:0xf
s_nop 1
v_permlane16_swap_b32 v232, v233
s_nop 0
v_max_f32 v234, v232, v233
v_max_f32 v235, v232, v233
s_nop 1
v_permlane32_swap_b32 v234, v235
s_nop 0
v_max_f32 v232, v234, v235
v_pk_add_f32 v[176:177], v[176:177], v[232:233] op_sel_hi:[1,0] neg_lo:[0,1] neg_hi:[0,1]
v_pk_add_f32 v[178:179], v[178:179], v[232:233] op_sel_hi:[1,0] neg_lo:[0,1] neg_hi:[0,1]
v_pk_add_f32 v[172:173], v[172:173], v[232:233] op_sel_hi:[1,0] neg_lo:[0,1] neg_hi:[0,1]
v_pk_add_f32 v[174:175], v[174:175], v[232:233] op_sel_hi:[1,0] neg_lo:[0,1] neg_hi:[0,1]
v_exp_f32 v176, v176
v_exp_f32 v177, v177
v_exp_f32 v178, v178
v_exp_f32 v179, v179
v_exp_f32 v172, v172
v_cvt_pk_bf16_f32 v216, v176, v177
v_cvt_pk_bf16_f32 v217, v178, v179
v_exp_f32 v173, v173
v_exp_f32 v174, v174
v_mfma_f32_16x16x16_bf16 v[224:227], v[220:221], v[216:217], 0
v_exp_f32 v175, v175
v_cvt_pk_bf16_f32 v212, v172, v173
s_waitcnt lgkmcnt(0)
v_mfma_f32_16x16x16_bf16 v[120:123], v[208:209], v[216:217], 0
v_cvt_pk_bf16_f32 v213, v174, v175
v_mfma_f32_16x16x16_bf16 v[124:127], v[210:211], v[216:217], 0
v_mov_b32_dpp v214, v212 row_ror:8 row_mask:0xf bank_mask:0xf
v_mov_b32_dpp v215, v213 row_ror:8 row_mask:0xf bank_mask:0xf
s_nop 1
v_mfma_f32_16x16x32_bf16 v[224:227], v[220:223], v[212:215], v[224:227]
v_mfma_f32_16x16x32_bf16 v[120:123], v[164:167], v[212:215], v[120:123]
v_mfma_f32_16x16x32_bf16 v[124:127], v[168:171], v[212:215], v[124:127]
s_add_u32 s29, s33, 24576
s_nop 4
v_rcp_f32 v234, v224
s_mov_b64 exec, s[40:41]
v_pk_mul_f32 v[120:121], v[120:121], v[234:235] op_sel_hi:[1,0]
v_pk_mul_f32 v[122:123], v[122:123], v[234:235] op_sel_hi:[1,0]
v_pk_mul_f32 v[124:125], v[124:125], v[234:235] op_sel_hi:[1,0]
v_pk_mul_f32 v[126:127], v[126:127], v[234:235] op_sel_hi:[1,0]
v_cvt_pk_bf16_f32 v212, v120, v121
v_cvt_pk_bf16_f32 v213, v122, v123
v_cvt_pk_bf16_f32 v214, v124, v125
v_cvt_pk_bf16_f32 v215, v126, v127
v_min_u32 v212, -2, v212
buffer_store_dwordx4 v[212:215], v11, s[84:87], s33 offen sc1
s_mov_b64 exec, -1
mega_kernel_rs_b3:
s_barrier
s_nop 15
buffer_load_dwordx4 v[32:35], v7, s[84:87], s29 offen offset:0 sc1
s_nop 9
buffer_load_dwordx4 v[36:39], v7, s[84:87], s29 offen offset:1024 sc1
s_nop 9
buffer_load_dwordx4 v[40:43], v7, s[84:87], s29 offen offset:2048 sc1
s_nop 9
buffer_load_dwordx4 v[44:47], v7, s[84:87], s29 offen offset:3072 sc1
mega_kernel_rs_pc_15_0:
s_waitcnt vmcnt(3)
v_cmp_eq_u32 vcc, -1, v32
s_cbranch_vccnz mega_kernel_rs_pc_15_0f
v_smfmac_f32_16x16x64_bf16 v[96:99], v[32:35], a[192:199], v6
v_smfmac_f32_16x16x64_bf16 v[100:103], v[32:35], a[224:231], v6
mega_kernel_rs_pc_14_1:
s_waitcnt vmcnt(2)
v_cmp_eq_u32 vcc, -1, v36
s_cbranch_vccnz mega_kernel_rs_pc_14_1f
v_smfmac_f32_16x16x64_bf16 v[96:99], v[36:39], a[200:207], v6
v_smfmac_f32_16x16x64_bf16 v[100:103], v[36:39], a[232:239], v6
mega_kernel_rs_pc_12_2:
s_waitcnt vmcnt(1)
v_cmp_eq_u32 vcc, -1, v40
s_cbranch_vccnz mega_kernel_rs_pc_12_2f
v_smfmac_f32_16x16x64_bf16 v[96:99], v[40:43], a[208:215], v6
v_smfmac_f32_16x16x64_bf16 v[100:103], v[40:43], a[240:247], v6
mega_kernel_rs_pc_8_3:
s_waitcnt vmcnt(0)
v_cmp_eq_u32 vcc, -1, v44
s_cbranch_vccnz mega_kernel_rs_pc_8_3f
v_smfmac_f32_16x16x64_bf16 v[96:99], v[44:47], a[216:223], v6
v_smfmac_f32_16x16x64_bf16 v[100:103], v[44:47], a[248:255], v6
mega_kernel_rs_pc_d:
s_nop 7
v_permlane32_swap_b32 v96, v100
v_permlane32_swap_b32 v97, v101
v_permlane32_swap_b32 v98, v102
v_permlane32_swap_b32 v99, v103
v_pk_add_f32 v[96:97], v[96:97], v[100:101]
v_pk_add_f32 v[98:99], v[98:99], v[102:103]
ds_write2_b32 v18, v96, v97 offset0:0 offset1:36
ds_write2_b32 v18, v98, v99 offset0:72 offset1:108
s_cmp_lg_u32 s24, 0
s_waitcnt lgkmcnt(0)
s_barrier
s_cbranch_scc1 mega_kernel_rs_x1
ds_read_b128 v[120:123], v19 offset:0
ds_read_b128 v[124:127], v19 offset:1152
ds_read_b128 v[128:131], v19 offset:2304
ds_read_b128 v[132:135], v19 offset:3456
s_waitcnt lgkmcnt(2)
v_pk_add_f32 v[120:121], v[120:121], v[124:125]
v_pk_add_f32 v[122:123], v[122:123], v[126:127]
s_waitcnt lgkmcnt(0)
v_pk_add_f32 v[128:129], v[128:129], v[132:133]
v_pk_add_f32 v[130:131], v[130:131], v[134:135]
v_pk_add_f32 v[120:121], v[120:121], v[128:129]
v_pk_add_f32 v[122:123], v[122:123], v[130:131]
v_fma_f32 v212, v120, s89, v120
v_cvt_pk_bf16_f32 v213, v122, v123
v_cvt_pk_bf16_f32 v212, v212, v121
v_and_or_b32 v212, v212, -2, s47
buffer_store_dwordx2 v[212:213], v12, s[84:87], s35 offen sc1
s_mov_b32 s77, 0x3f80
s_mov_b32 s78, 0x3f800000
s_xor_b32 s76, s47, 1
v_mov_b32 v48, s76
v_mov_b32 v50, s76
v_mov_b32 v52, s76
s_nop 8
v_mov_b32 v96, 0
v_mov_b32 v97, 0
v_mov_b32 v98, 0
v_mov_b32 v99, 0
v_mov_b32 v100, 0
v_mov_b32 v101, 0
v_mov_b32 v102, 0
v_mov_b32 v103, 0
v_mov_b32 v104, 0
v_mov_b32 v105, 0
v_mov_b32 v106, 0
v_mov_b32 v107, 0
v_mov_b32 v108, 0
v_mov_b32 v109, 0
v_mov_b32 v110, 0
v_mov_b32 v111, 0
v_mov_b32 v112, 0
v_mov_b32 v113, 0
v_mov_b32 v114, 0
v_mov_b32 v115, 0
v_mov_b32 v116, 0
v_mov_b32 v117, 0
v_mov_b32 v118, 0
v_mov_b32 v119, 0
s_nop 15
s_nop 7
s_cmp_eq_u32 s47, 1
s_cbranch_scc1 mega_kernel_rs_p4_1
.p2align 6
mega_kernel_rs_p4_0:
buffer_load_dwordx2 v[48:49], v25, s[84:87], s35 offen sc1
buffer_load_dwordx2 v[50:51], v26, s[84:87], s35 offen sc1
buffer_load_dwordx2 v[52:53], v27, s[84:87], s35 offen sc1
s_waitcnt vmcnt(12)
mega_kernel_rs_p4c_0:
v_bitop3_b32 v4, v48, v50, v52 bitop3:0xfe
v_and_b32 v4, 1, v4
v_cmp_ne_u32 vcc, 0, v4
s_cbranch_vccnz mega_kernel_rs_p4_0
v_dot2_f32_bf16 v120, v48, s77, v120
v_dot2_f32_bf16 v121, v48, s78, v121
v_dot2_f32_bf16 v122, v49, s77, v122
v_dot2_f32_bf16 v123, v49, s78, v123
v_dot2_f32_bf16 v120, v50, s77, v120
v_dot2_f32_bf16 v121, v50, s78, v121
v_dot2_f32_bf16 v122, v51, s77, v122
v_dot2_f32_bf16 v123, v51, s78, v123
v_dot2_f32_bf16 v120, v52, s77, v120
v_dot2_f32_bf16 v121, v52, s78, v121
v_dot2_f32_bf16 v122, v53, s77, v122
v_dot2_f32_bf16 v123, v53, s78, v123
s_nop 0
v_cvt_pk_bf16_f32 v212, v120, v121
v_min_u32 v212, -2, v212
v_cvt_pk_bf16_f32 v213, v122, v123
buffer_store_dwordx2 v[212:213], v9, s[84:87], s34 offen sc1
s_branch mega_kernel_rs_p4d
mega_kernel_rs_iw0:
mega_kernel_rs_il0:
s_cbranch_execz mega_kernel_rs_il1
.p2align 6
mega_kernel_rs_p4_1:
buffer_load_dwordx2 v[48:49], v25, s[84:87], s35 offen sc1
buffer_load_dwordx2 v[50:51], v26, s[84:87], s35 offen sc1
buffer_load_dwordx2 v[52:53], v27, s[84:87], s35 offen sc1
s_waitcnt vmcnt(12)
mega_kernel_rs_p4c_1:
v_bitop3_b32 v4, v48, v50, v52 bitop3:0x80
v_and_b32 v4, 1, v4
v_cmp_ne_u32 vcc, 1, v4
s_cbranch_vccnz mega_kernel_rs_p4_1
v_dot2_f32_bf16 v120, v48, s77, v120
v_dot2_f32_bf16 v121, v48, s78, v121
v_dot2_f32_bf16 v122, v49, s77, v122
v_dot2_f32_bf16 v123, v49, s78, v123
v_dot2_f32_bf16 v120, v50, s77, v120
v_dot2_f32_bf16 v121, v50, s78, v121
v_dot2_f32_bf16 v122, v51, s77, v122
v_dot2_f32_bf16 v123, v51, s78, v123
v_dot2_f32_bf16 v120, v52, s77, v120
v_dot2_f32_bf16 v121, v52, s78, v121
v_dot2_f32_bf16 v122, v53, s77, v122
v_dot2_f32_bf16 v123, v53, s78, v123
s_nop 0
v_cvt_pk_bf16_f32 v212, v120, v121
v_min_u32 v212, -2, v212
v_cvt_pk_bf16_f32 v213, v122, v123
buffer_store_dwordx2 v[212:213], v9, s[84:87], s34 offen sc1
mega_kernel_rs_p4d:
mega_kernel_rs_b5:
s_add_u32 s27, s27, 1
s_add_u32 s44, s44, 4096
s_cmp_eq_u32 s44, 30720
s_cselect_b32 s44, 18432, s44
s_mov_b32 s28, s33
s_mov_b32 s33, s34
s_mov_b32 s34, s28
s_xor_b32 s35, s35, 262144
s_bfe_u32 s47, s27, 0x10001
s_barrier
s_nop 15
s_branch mega_kernel_rs_loop
mega_kernel_rs_il1:
s_cbranch_execz mega_kernel_rs_il2
mega_kernel_rs_x1:
s_cmp_eq_u32 s24, 1
s_cbranch_scc0 mega_kernel_rs_x2
s_add_u32 s76, s27, 1
s_sleep 6
v_mov_b32 v5, s76
s_mov_b64 exec, 1
buffer_store_dword v5, v228, s[84:87], s81 offen sc1
s_mov_b64 exec, -1
mega_kernel_rs_x2:
s_cmp_eq_u32 s24, 3
s_cbranch_scc0 mega_kernel_rs_x4
s_cmp_eq_u32 s36, 1
s_cbranch_scc0 mega_kernel_rs_x5
s_add_u32 s76, s27, 1
s_cmp_gt_i32 s46, s76
s_cbranch_scc1 mega_kernel_rs_pf1ok
mega_kernel_rs_pf1w:
v_mov_b32 v4, 0
s_mov_b64 exec, 3
buffer_atomic_add v4, v24, s[84:87], 0 offen sc0 sc1
s_mov_b64 exec, -1
s_waitcnt vmcnt(0)
v_readlane_b32 s46, v4, 0
v_readlane_b32 s28, v4, 1
s_nop 1
s_min_i32 s46, s46, s28
s_cmp_gt_i32 s46, s76
s_cbranch_scc0 mega_kernel_rs_pf1w
mega_kernel_rs_pf1ok:
s_add_u32 s77, s76, s82
s_bfe_u32 s28, s77, 0x40002
s_lshl_b32 s28, s28, 14
s_and_b32 s77, s77, 3
s_lshl_b32 s77, s77, 11
s_add_u32 s28, s28, s77
s_add_u32 m0, s45, 0
s_nop 0
buffer_load_dwordx4 v240, s[84:87], s28 offen offset:0 sc1 lds
s_add_u32 m0, s45, 0
s_nop 0
buffer_load_dwordx4 v240, s[84:87], s28 offen offset:1024 sc1 lds
s_add_u32 m0, s45, 2048
s_nop 0
buffer_load_dwordx4 v241, s[84:87], s28 offen offset:0 sc1 lds
s_add_u32 m0, s45, 2048
s_nop 0
buffer_load_dwordx4 v241, s[84:87], s28 offen offset:1024 sc1 lds
s_add_u32 s45, s45, 4096
s_cmp_eq_u32 s45, 30720
s_cselect_b32 s45, 18432, s45
s_waitcnt vmcnt(0)
mega_kernel_rs_x5:
s_add_u32 s76, s27, 4
s_min_u32 s76, s76, 63
s_cmp_gt_i32 s46, s76
s_cbranch_scc1 mega_kernel_rs_x6
v_mov_b32 v249, 0
s_mov_b64 exec, 3
buffer_atomic_add v249, v24, s[84:87], 0 offen sc0 sc1
s_mov_b64 exec, -1
mega_kernel_rs_x6:
s_add_u32 s76, s27, 2
s_cmp_lt_u32 s76, 63
s_cbranch_scc0 mega_kernel_rs_x4
s_cmp_gt_i32 s46, s76
s_cbranch_scc0 mega_kernel_rs_x4
s_add_u32 s77, s76, s82
s_bfe_u32 s28, s77, 0x40002
s_lshl_b32 s28, s28, 14
s_and_b32 s77, s77, 3
s_lshl_b32 s77, s77, 11
s_add_u32 s28, s28, s77
s_add_u32 s28, s28, s83
s_add_u32 s28, s28, 33554432
s_buffer_load_dword s78, s[84:87], s28 offset:0
s_buffer_load_dword s78, s[84:87], s28 offset:128
s_buffer_load_dword s78, s[84:87], s28 offset:256
s_buffer_load_dword s78, s[84:87], s28 offset:384
s_buffer_load_dword s78, s[84:87], s28 offset:512
s_buffer_load_dword s78, s[84:87], s28 offset:640
s_buffer_load_dword s78, s[84:87], s28 offset:768
s_buffer_load_dword s78, s[84:87], s28 offset:896
s_buffer_load_dword s78, s[84:87], s28 offset:1024
s_buffer_load_dword s78, s[84:87], s28 offset:1152
s_buffer_load_dword s78, s[84:87], s28 offset:1280
s_buffer_load_dword s78, s[84:87], s28 offset:1408
s_buffer_load_dword s78, s[84:87], s28 offset:1536
s_buffer_load_dword s78, s[84:87], s28 offset:1664
s_buffer_load_dword s78, s[84:87], s28 offset:1792
s_buffer_load_dword s78, s[84:87], s28 offset:1920
mega_kernel_rs_x4:
v_mov_b32 v96, 0
v_mov_b32 v97, 0
v_mov_b32 v98, 0
v_mov_b32 v99, 0
v_mov_b32 v100, 0
v_mov_b32 v101, 0
v_mov_b32 v102, 0
v_mov_b32 v103, 0
v_mov_b32 v104, 0
v_mov_b32 v105, 0
v_mov_b32 v106, 0
v_mov_b32 v107, 0
v_mov_b32 v108, 0
v_mov_b32 v109, 0
v_mov_b32 v110, 0
v_mov_b32 v111, 0
v_mov_b32 v112, 0
v_mov_b32 v113, 0
v_mov_b32 v114, 0
v_mov_b32 v115, 0
v_mov_b32 v116, 0
v_mov_b32 v117, 0
v_mov_b32 v118, 0
v_mov_b32 v119, 0
s_branch mega_kernel_rs_b5
mega_kernel_rs_il2:
s_cbranch_execz mega_kernel_rs_il3
mega_kernel_rs_p2r:
s_mov_b64 exec, s[42:43]
buffer_load_dwordx4 v[188:191], v10, s[84:87], s76 offen sc1
buffer_load_dwordx4 v[196:199], v10, s[84:87], s77 offen sc1
buffer_load_dwordx4 v[204:207], v10, s[84:87], s78 offen sc1
s_mov_b64 exec, -1
buffer_load_dwordx4 v[184:187], v17, s[84:87], s76 offen sc1
buffer_load_dwordx4 v[192:195], v17, s[84:87], s77 offen sc1
buffer_load_dwordx4 v[200:203], v17, s[84:87], s78 offen sc1
s_branch mega_kernel_rs_p2
mega_kernel_rs_il3:
s_cbranch_execz mega_kernel_rs_il4
.p2align 5
mega_kernel_rs_pa_1_0f:
s_mov_b64 exec, vcc
buffer_load_dwordx4 v[32:35], v7, s[84:87], s33 offen offset:0 sc1
s_mov_b64 exec, -1
s_branch mega_kernel_rs_pa_1_0
.p2align 5
mega_kernel_rs_pa_1_0:
s_waitcnt vmcnt(0)
v_max_u32 v4, v32, v34
v_cmp_eq_u32 vcc, -1, v4
s_cbranch_vccnz mega_kernel_rs_pa_1_0f
v_smfmac_f32_16x16x64_bf16 v[96:99], v[32:35], a[0:7], v6
v_smfmac_f32_16x16x64_bf16 v[100:103], v[32:35], a[32:39], v6
v_smfmac_f32_16x16x64_bf16 v[104:107], v[32:35], a[64:71], v6
v_smfmac_f32_16x16x64_bf16 v[108:111], v[32:35], a[96:103], v6
s_branch mega_kernel_rs_pa_d
mega_kernel_rs_il4:
s_cbranch_execz mega_kernel_rs_il5
.p2align 5
mega_kernel_rs_pa_2_1f:
s_mov_b64 exec, vcc
buffer_load_dwordx4 v[36:39], v7, s[84:87], s33 offen offset:1024 sc1
s_mov_b64 exec, -1
s_branch mega_kernel_rs_pa_2_1
.p2align 5
mega_kernel_rs_pa_2_1:
s_waitcnt vmcnt(0)
v_max_u32 v4, v36, v38
v_cmp_eq_u32 vcc, -1, v4
s_cbranch_vccnz mega_kernel_rs_pa_2_1f
v_smfmac_f32_16x16x64_bf16 v[96:99], v[36:39], a[8:15], v6
v_smfmac_f32_16x16x64_bf16 v[100:103], v[36:39], a[40:47], v6
v_smfmac_f32_16x16x64_bf16 v[104:107], v[36:39], a[72:79], v6
v_smfmac_f32_16x16x64_bf16 v[108:111], v[36:39], a[104:111], v6
s_branch mega_kernel_rs_pa_d
mega_kernel_rs_il5:
s_cbranch_execz mega_kernel_rs_il6
.p2align 5
mega_kernel_rs_pa_3_0f:
s_mov_b64 exec, vcc
buffer_load_dwordx4 v[32:35], v7, s[84:87], s33 offen offset:0 sc1
s_mov_b64 exec, -1
s_branch mega_kernel_rs_pa_3_1
.p2align 5
mega_kernel_rs_pa_3_0:
s_waitcnt vmcnt(1)
v_max_u32 v4, v32, v34
v_cmp_eq_u32 vcc, -1, v4
s_cbranch_vccnz mega_kernel_rs_pa_3_0f
v_smfmac_f32_16x16x64_bf16 v[96:99], v[32:35], a[0:7], v6
v_smfmac_f32_16x16x64_bf16 v[100:103], v[32:35], a[32:39], v6
v_smfmac_f32_16x16x64_bf16 v[104:107], v[32:35], a[64:71], v6
v_smfmac_f32_16x16x64_bf16 v[108:111], v[32:35], a[96:103], v6
s_branch mega_kernel_rs_pa_2_1
mega_kernel_rs_il6:
s_cbranch_execz mega_kernel_rs_il7
.p2align 5
mega_kernel_rs_pa_3_1f:
s_mov_b64 exec, vcc
buffer_load_dwordx4 v[36:39], v7, s[84:87], s33 offen offset:1024 sc1
s_mov_b64 exec, -1
s_branch mega_kernel_rs_pa_3_0
.p2align 5
mega_kernel_rs_pa_3_1:
s_waitcnt vmcnt(1)
v_max_u32 v4, v36, v38
v_cmp_eq_u32 vcc, -1, v4
s_cbranch_vccnz mega_kernel_rs_pa_3_1f
v_smfmac_f32_16x16x64_bf16 v[96:99], v[36:39], a[8:15], v6
v_smfmac_f32_16x16x64_bf16 v[100:103], v[36:39], a[40:47], v6
v_smfmac_f32_16x16x64_bf16 v[104:107], v[36:39], a[72:79], v6
v_smfmac_f32_16x16x64_bf16 v[108:111], v[36:39], a[104:111], v6
s_branch mega_kernel_rs_pa_1_0
mega_kernel_rs_il7:
s_cbranch_execz mega_kernel_rs_il8
.p2align 5
mega_kernel_rs_pa_4_2f:
s_mov_b64 exec, vcc
buffer_load_dwordx4 v[40:43], v7, s[84:87], s33 offen offset:2048 sc1
s_mov_b64 exec, -1
s_branch mega_kernel_rs_pa_4_2
.p2align 5
mega_kernel_rs_pa_4_2:
s_waitcnt vmcnt(0)
v_max_u32 v4, v40, v42
v_cmp_eq_u32 vcc, -1, v4
s_cbranch_vccnz mega_kernel_rs_pa_4_2f
v_smfmac_f32_16x16x64_bf16 v[96:99], v[40:43], a[16:23], v6
v_smfmac_f32_16x16x64_bf16 v[100:103], v[40:43], a[48:55], v6
v_smfmac_f32_16x16x64_bf16 v[104:107], v[40:43], a[80:87], v6
v_smfmac_f32_16x16x64_bf16 v[108:111], v[40:43], a[112:119], v6
s_branch mega_kernel_rs_pa_d
mega_kernel_rs_il8:
s_cbranch_execz mega_kernel_rs_il9
.p2align 5
mega_kernel_rs_pa_5_0f:
s_mov_b64 exec, vcc
buffer_load_dwordx4 v[32:35], v7, s[84:87], s33 offen offset:0 sc1
s_mov_b64 exec, -1
s_branch mega_kernel_rs_pa_5_2
.p2align 5
mega_kernel_rs_pa_5_0:
s_waitcnt vmcnt(1)
v_max_u32 v4, v32, v34
v_cmp_eq_u32 vcc, -1, v4
s_cbranch_vccnz mega_kernel_rs_pa_5_0f
v_smfmac_f32_16x16x64_bf16 v[96:99], v[32:35], a[0:7], v6
v_smfmac_f32_16x16x64_bf16 v[100:103], v[32:35], a[32:39], v6
v_smfmac_f32_16x16x64_bf16 v[104:107], v[32:35], a[64:71], v6
v_smfmac_f32_16x16x64_bf16 v[108:111], v[32:35], a[96:103], v6
s_branch mega_kernel_rs_pa_4_2
mega_kernel_rs_il9:
s_cbranch_execz mega_kernel_rs_il10
.p2align 5
mega_kernel_rs_pa_5_2f:
s_mov_b64 exec, vcc
buffer_load_dwordx4 v[40:43], v7, s[84:87], s33 offen offset:2048 sc1
s_mov_b64 exec, -1
s_branch mega_kernel_rs_pa_5_0
.p2align 5
mega_kernel_rs_pa_5_2:
s_waitcnt vmcnt(1)
v_max_u32 v4, v40, v42
v_cmp_eq_u32 vcc, -1, v4
s_cbranch_vccnz mega_kernel_rs_pa_5_2f
v_smfmac_f32_16x16x64_bf16 v[96:99], v[40:43], a[16:23], v6
v_smfmac_f32_16x16x64_bf16 v[100:103], v[40:43], a[48:55], v6
v_smfmac_f32_16x16x64_bf16 v[104:107], v[40:43], a[80:87], v6
v_smfmac_f32_16x16x64_bf16 v[108:111], v[40:43], a[112:119], v6
s_branch mega_kernel_rs_pa_1_0
mega_kernel_rs_il10:
s_cbranch_execz mega_kernel_rs_il11
.p2align 5
mega_kernel_rs_pa_6_1f:
s_mov_b64 exec, vcc
buffer_load_dwordx4 v[36:39], v7, s[84:87], s33 offen offset:1024 sc1
s_mov_b64 exec, -1
s_branch mega_kernel_rs_pa_6_2
.p2align 5
mega_kernel_rs_pa_6_1:
s_waitcnt vmcnt(1)
v_max_u32 v4, v36, v38
v_cmp_eq_u32 vcc, -1, v4
s_cbranch_vccnz mega_kernel_rs_pa_6_1f
v_smfmac_f32_16x16x64_bf16 v[96:99], v[36:39], a[8:15], v6
v_smfmac_f32_16x16x64_bf16 v[100:103], v[36:39], a[40:47], v6
v_smfmac_f32_16x16x64_bf16 v[104:107], v[36:39], a[72:79], v6
v_smfmac_f32_16x16x64_bf16 v[108:111], v[36:39], a[104:111], v6
s_branch mega_kernel_rs_pa_4_2
mega_kernel_rs_il11:
s_cbranch_execz mega_kernel_rs_il12
.p2align 5
mega_kernel_rs_pa_6_2f:
s_mov_b64 exec, vcc
buffer_load_dwordx4 v[40:43], v7, s[84:87], s33 offen offset:2048 sc1
s_mov_b64 exec, -1
s_branch mega_kernel_rs_pa_6_1
.p2align 5
mega_kernel_rs_pa_6_2:
s_waitcnt vmcnt(1)
v_max_u32 v4, v40, v42
v_cmp_eq_u32 vcc, -1, v4
s_cbranch_vccnz mega_kernel_rs_pa_6_2f
v_smfmac_f32_16x16x64_bf16 v[96:99], v[40:43], a[16:23], v6
v_smfmac_f32_16x16x64_bf16 v[100:103], v[40:43], a[48:55], v6
v_smfmac_f32_16x16x64_bf16 v[104:107], v[40:43], a[80:87], v6
v_smfmac_f32_16x16x64_bf16 v[108:111], v[40:43], a[112:119], v6
s_branch mega_kernel_rs_pa_2_1
mega_kernel_rs_il12:
s_cbranch_execz mega_kernel_rs_il13
.p2align 5
mega_kernel_rs_pa_7_0f:
s_mov_b64 exec, vcc
buffer_load_dwordx4 v[32:35], v7, s[84:87], s33 offen offset:0 sc1
s_mov_b64 exec, -1
s_branch mega_kernel_rs_pa_7_1
.p2align 5
mega_kernel_rs_pa_7_0:
s_waitcnt vmcnt(2)
v_max_u32 v4, v32, v34
v_cmp_eq_u32 vcc, -1, v4
s_cbranch_vccnz mega_kernel_rs_pa_7_0f
v_smfmac_f32_16x16x64_bf16 v[96:99], v[32:35], a[0:7], v6
v_smfmac_f32_16x16x64_bf16 v[100:103], v[32:35], a[32:39], v6
v_smfmac_f32_16x16x64_bf16 v[104:107], v[32:35], a[64:71], v6
v_smfmac_f32_16x16x64_bf16 v[108:111], v[32:35], a[96:103], v6
s_branch mega_kernel_rs_pa_6_1
mega_kernel_rs_il13:
s_cbranch_execz mega_kernel_rs_il14
.p2align 5
mega_kernel_rs_pa_7_1f:
s_mov_b64 exec, vcc
buffer_load_dwordx4 v[36:39], v7, s[84:87], s33 offen offset:1024 sc1
s_mov_b64 exec, -1
s_branch mega_kernel_rs_pa_7_2
.p2align 5
mega_kernel_rs_pa_7_1:
s_waitcnt vmcnt(2)
v_max_u32 v4, v36, v38
v_cmp_eq_u32 vcc, -1, v4
s_cbranch_vccnz mega_kernel_rs_pa_7_1f
v_smfmac_f32_16x16x64_bf16 v[96:99], v[36:39], a[8:15], v6
v_smfmac_f32_16x16x64_bf16 v[100:103], v[36:39], a[40:47], v6
v_smfmac_f32_16x16x64_bf16 v[104:107], v[36:39], a[72:79], v6
v_smfmac_f32_16x16x64_bf16 v[108:111], v[36:39], a[104:111], v6
s_branch mega_kernel_rs_pa_5_2
mega_kernel_rs_il14:
s_cbranch_execz mega_kernel_rs_il15
.p2align 5
mega_kernel_rs_pa_7_2f:
s_mov_b64 exec, vcc
buffer_load_dwordx4 v[40:43], v7, s[84:87], s33 offen offset:2048 sc1
s_mov_b64 exec, -1
s_branch mega_kernel_rs_pa_7_0
.p2align 5
mega_kernel_rs_pa_7_2:
s_waitcnt vmcnt(2)
v_max_u32 v4, v40, v42
v_cmp_eq_u32 vcc, -1, v4
s_cbranch_vccnz mega_kernel_rs_pa_7_2f
v_smfmac_f32_16x16x64_bf16 v[96:99], v[40:43], a[16:23], v6
v_smfmac_f32_16x16x64_bf16 v[100:103], v[40:43], a[48:55], v6
v_smfmac_f32_16x16x64_bf16 v[104:107], v[40:43], a[80:87], v6
v_smfmac_f32_16x16x64_bf16 v[108:111], v[40:43], a[112:119], v6
s_branch mega_kernel_rs_pa_3_0
mega_kernel_rs_il15:
s_cbranch_execz mega_kernel_rs_il16
.p2align 5
mega_kernel_rs_pa_8_3f:
s_mov_b64 exec, vcc
buffer_load_dwordx4 v[44:47], v7, s[84:87], s33 offen offset:3072 sc1
s_mov_b64 exec, -1
s_branch mega_kernel_rs_pa_8_3
.p2align 5
mega_kernel_rs_pa_8_3:
s_waitcnt vmcnt(0)
v_max_u32 v4, v44, v46
v_cmp_eq_u32 vcc, -1, v4
s_cbranch_vccnz mega_kernel_rs_pa_8_3f
v_smfmac_f32_16x16x64_bf16 v[96:99], v[44:47], a[24:31], v6
v_smfmac_f32_16x16x64_bf16 v[100:103], v[44:47], a[56:63], v6
v_smfmac_f32_16x16x64_bf16 v[104:107], v[44:47], a[88:95], v6
v_smfmac_f32_16x16x64_bf16 v[108:111], v[44:47], a[120:127], v6
s_branch mega_kernel_rs_pa_d
mega_kernel_rs_il16:
s_cbranch_execz mega_kernel_rs_il17
.p2align 5
mega_kernel_rs_pa_9_0f:
s_mov_b64 exec, vcc
buffer_load_dwordx4 v[32:35], v7, s[84:87], s33 offen offset:0 sc1
s_mov_b64 exec, -1
s_branch mega_kernel_rs_pa_9_3
.p2align 5
mega_kernel_rs_pa_9_0:
s_waitcnt vmcnt(1)
v_max_u32 v4, v32, v34
v_cmp_eq_u32 vcc, -1, v4
s_cbranch_vccnz mega_kernel_rs_pa_9_0f
v_smfmac_f32_16x16x64_bf16 v[96:99], v[32:35], a[0:7], v6
v_smfmac_f32_16x16x64_bf16 v[100:103], v[32:35], a[32:39], v6
v_smfmac_f32_16x16x64_bf16 v[104:107], v[32:35], a[64:71], v6
v_smfmac_f32_16x16x64_bf16 v[108:111], v[32:35], a[96:103], v6
s_branch mega_kernel_rs_pa_8_3
mega_kernel_rs_il17:
s_cbranch_execz mega_kernel_rs_il18
.p2align 5
mega_kernel_rs_pa_9_3f:
s_mov_b64 exec, vcc
buffer_load_dwordx4 v[44:47], v7, s[84:87], s33 offen offset:3072 sc1
s_mov_b64 exec, -1
s_branch mega_kernel_rs_pa_9_0
.p2align 5
mega_kernel_rs_pa_9_3:
s_waitcnt vmcnt(1)
v_max_u32 v4, v44, v46
v_cmp_eq_u32 vcc, -1, v4
s_cbranch_vccnz mega_kernel_rs_pa_9_3f
v_smfmac_f32_16x16x64_bf16 v[96:99], v[44:47], a[24:31], v6
v_smfmac_f32_16x16x64_bf16 v[100:103], v[44:47], a[56:63], v6
v_smfmac_f32_16x16x64_bf16 v[104:107], v[44:47], a[88:95], v6
v_smfmac_f32_16x16x64_bf16 v[108:111], v[44:47], a[120:127], v6
s_branch mega_kernel_rs_pa_1_0
mega_kernel_rs_il18:
s_cbranch_execz mega_kernel_rs_iwd
.p2align 5
mega_kernel_rs_pa_10_1f:
s_mov_b64 exec, vcc
buffer_load_dwordx4 v[36:39], v7, s[84:87], s33 offen offset:1024 sc1
s_mov_b64 exec, -1
s_branch mega_kernel_rs_pa_10_3
.p2align 5
mega_kernel_rs_pa_10_1:
s_waitcnt vmcnt(1)
v_max_u32 v4, v36, v38
v_cmp_eq_u32 vcc, -1, v4
s_cbranch_vccnz mega_kernel_rs_pa_10_1f
v_smfmac_f32_16x16x64_bf16 v[96:99], v[36:39], a[8:15], v6
v_smfmac_f32_16x16x64_bf16 v[100:103], v[36:39], a[40:47], v6
v_smfmac_f32_16x16x64_bf16 v[104:107], v[36:39], a[72:79], v6
v_smfmac_f32_16x16x64_bf16 v[108:111], v[36:39], a[104:111], v6
s_branch mega_kernel_rs_pa_8_3
mega_kernel_rs_iw1:
mega_kernel_rs_il19:
s_cbranch_execz mega_kernel_rs_il20
.p2align 5
mega_kernel_rs_pa_10_3f:
s_mov_b64 exec, vcc
buffer_load_dwordx4 v[44:47], v7, s[84:87], s33 offen offset:3072 sc1
s_mov_b64 exec, -1
s_branch mega_kernel_rs_pa_10_1
.p2align 5
mega_kernel_rs_pa_10_3:
s_waitcnt vmcnt(1)
v_max_u32 v4, v44, v46
v_cmp_eq_u32 vcc, -1, v4
s_cbranch_vccnz mega_kernel_rs_pa_10_3f
v_smfmac_f32_16x16x64_bf16 v[96:99], v[44:47], a[24:31], v6
v_smfmac_f32_16x16x64_bf16 v[100:103], v[44:47], a[56:63], v6
v_smfmac_f32_16x16x64_bf16 v[104:107], v[44:47], a[88:95], v6
v_smfmac_f32_16x16x64_bf16 v[108:111], v[44:47], a[120:127], v6
s_branch mega_kernel_rs_pa_2_1
mega_kernel_rs_il20:
s_cbranch_execz mega_kernel_rs_il21
.p2align 5
mega_kernel_rs_pa_11_0f:
s_mov_b64 exec, vcc
buffer_load_dwordx4 v[32:35], v7, s[84:87], s33 offen offset:0 sc1
s_mov_b64 exec, -1
s_branch mega_kernel_rs_pa_11_1
.p2align 5
mega_kernel_rs_pa_11_0:
s_waitcnt vmcnt(2)
v_max_u32 v4, v32, v34
v_cmp_eq_u32 vcc, -1, v4
s_cbranch_vccnz mega_kernel_rs_pa_11_0f
v_smfmac_f32_16x16x64_bf16 v[96:99], v[32:35], a[0:7], v6
v_smfmac_f32_16x16x64_bf16 v[100:103], v[32:35], a[32:39], v6
v_smfmac_f32_16x16x64_bf16 v[104:107], v[32:35], a[64:71], v6
v_smfmac_f32_16x16x64_bf16 v[108:111], v[32:35], a[96:103], v6
s_branch mega_kernel_rs_pa_10_1
mega_kernel_rs_il21:
s_cbranch_execz mega_kernel_rs_il22
.p2align 5
mega_kernel_rs_pa_11_1f:
s_mov_b64 exec, vcc
buffer_load_dwordx4 v[36:39], v7, s[84:87], s33 offen offset:1024 sc1
s_mov_b64 exec, -1
s_branch mega_kernel_rs_pa_11_3
.p2align 5
mega_kernel_rs_pa_11_1:
s_waitcnt vmcnt(2)
v_max_u32 v4, v36, v38
v_cmp_eq_u32 vcc, -1, v4
s_cbranch_vccnz mega_kernel_rs_pa_11_1f
v_smfmac_f32_16x16x64_bf16 v[96:99], v[36:39], a[8:15], v6
v_smfmac_f32_16x16x64_bf16 v[100:103], v[36:39], a[40:47], v6
v_smfmac_f32_16x16x64_bf16 v[104:107], v[36:39], a[72:79], v6
v_smfmac_f32_16x16x64_bf16 v[108:111], v[36:39], a[104:111], v6
s_branch mega_kernel_rs_pa_9_3
mega_kernel_rs_il22:
s_cbranch_execz mega_kernel_rs_il23
.p2align 5
mega_kernel_rs_pa_11_3f:
s_mov_b64 exec, vcc
buffer_load_dwordx4 v[44:47], v7, s[84:87], s33 offen offset:3072 sc1
s_mov_b64 exec, -1
s_branch mega_kernel_rs_pa_11_0
.p2align 5
mega_kernel_rs_pa_11_3:
s_waitcnt vmcnt(2)
v_max_u32 v4, v44, v46
v_cmp_eq_u32 vcc, -1, v4
s_cbranch_vccnz mega_kernel_rs_pa_11_3f
v_smfmac_f32_16x16x64_bf16 v[96:99], v[44:47], a[24:31], v6
v_smfmac_f32_16x16x64_bf16 v[100:103], v[44:47], a[56:63], v6
v_smfmac_f32_16x16x64_bf16 v[104:107], v[44:47], a[88:95], v6
v_smfmac_f32_16x16x64_bf16 v[108:111], v[44:47], a[120:127], v6
s_branch mega_kernel_rs_pa_3_0
mega_kernel_rs_il23:
s_cbranch_execz mega_kernel_rs_il24
.p2align 5
mega_kernel_rs_pa_12_2f:
s_mov_b64 exec, vcc
buffer_load_dwordx4 v[40:43], v7, s[84:87], s33 offen offset:2048 sc1
s_mov_b64 exec, -1
s_branch mega_kernel_rs_pa_12_3
.p2align 5
mega_kernel_rs_pa_12_2:
s_waitcnt vmcnt(1)
v_max_u32 v4, v40, v42
v_cmp_eq_u32 vcc, -1, v4
s_cbranch_vccnz mega_kernel_rs_pa_12_2f
v_smfmac_f32_16x16x64_bf16 v[96:99], v[40:43], a[16:23], v6
v_smfmac_f32_16x16x64_bf16 v[100:103], v[40:43], a[48:55], v6
v_smfmac_f32_16x16x64_bf16 v[104:107], v[40:43], a[80:87], v6
v_smfmac_f32_16x16x64_bf16 v[108:111], v[40:43], a[112:119], v6
s_branch mega_kernel_rs_pa_8_3
mega_kernel_rs_il24:
s_cbranch_execz mega_kernel_rs_il25
.p2align 5
mega_kernel_rs_pa_12_3f:
s_mov_b64 exec, vcc
buffer_load_dwordx4 v[44:47], v7, s[84:87], s33 offen offset:3072 sc1
s_mov_b64 exec, -1
s_branch mega_kernel_rs_pa_12_2
.p2align 5
mega_kernel_rs_pa_12_3:
s_waitcnt vmcnt(1)
v_max_u32 v4, v44, v46
v_cmp_eq_u32 vcc, -1, v4
s_cbranch_vccnz mega_kernel_rs_pa_12_3f
v_smfmac_f32_16x16x64_bf16 v[96:99], v[44:47], a[24:31], v6
v_smfmac_f32_16x16x64_bf16 v[100:103], v[44:47], a[56:63], v6
v_smfmac_f32_16x16x64_bf16 v[104:107], v[44:47], a[88:95], v6
v_smfmac_f32_16x16x64_bf16 v[108:111], v[44:47], a[120:127], v6
s_branch mega_kernel_rs_pa_4_2
mega_kernel_rs_il25:
s_cbranch_execz mega_kernel_rs_il26
.p2align 5
mega_kernel_rs_pa_13_0f:
s_mov_b64 exec, vcc
buffer_load_dwordx4 v[32:35], v7, s[84:87], s33 offen offset:0 sc1
s_mov_b64 exec, -1
s_branch mega_kernel_rs_pa_13_2
.p2align 5
mega_kernel_rs_pa_13_0:
s_waitcnt vmcnt(2)
v_max_u32 v4, v32, v34
v_cmp_eq_u32 vcc, -1, v4
s_cbranch_vccnz mega_kernel_rs_pa_13_0f
v_smfmac_f32_16x16x64_bf16 v[96:99], v[32:35], a[0:7], v6
v_smfmac_f32_16x16x64_bf16 v[100:103], v[32:35], a[32:39], v6
v_smfmac_f32_16x16x64_bf16 v[104:107], v[32:35], a[64:71], v6
v_smfmac_f32_16x16x64_bf16 v[108:111], v[32:35], a[96:103], v6
s_branch mega_kernel_rs_pa_12_2
mega_kernel_rs_il26:
s_cbranch_execz mega_kernel_rs_il27
.p2align 5
mega_kernel_rs_pa_13_2f:
s_mov_b64 exec, vcc
buffer_load_dwordx4 v[40:43], v7, s[84:87], s33 offen offset:2048 sc1
s_mov_b64 exec, -1
s_branch mega_kernel_rs_pa_13_3
.p2align 5
mega_kernel_rs_pa_13_2:
s_waitcnt vmcnt(2)
v_max_u32 v4, v40, v42
v_cmp_eq_u32 vcc, -1, v4
s_cbranch_vccnz mega_kernel_rs_pa_13_2f
v_smfmac_f32_16x16x64_bf16 v[96:99], v[40:43], a[16:23], v6
v_smfmac_f32_16x16x64_bf16 v[100:103], v[40:43], a[48:55], v6
v_smfmac_f32_16x16x64_bf16 v[104:107], v[40:43], a[80:87], v6
v_smfmac_f32_16x16x64_bf16 v[108:111], v[40:43], a[112:119], v6
s_branch mega_kernel_rs_pa_9_3
mega_kernel_rs_il27:
s_cbranch_execz mega_kernel_rs_il28
.p2align 5
mega_kernel_rs_pa_13_3f:
s_mov_b64 exec, vcc
buffer_load_dwordx4 v[44:47], v7, s[84:87], s33 offen offset:3072 sc1
s_mov_b64 exec, -1
s_branch mega_kernel_rs_pa_13_0
.p2align 5
mega_kernel_rs_pa_13_3:
s_waitcnt vmcnt(2)
v_max_u32 v4, v44, v46
v_cmp_eq_u32 vcc, -1, v4
s_cbranch_vccnz mega_kernel_rs_pa_13_3f
v_smfmac_f32_16x16x64_bf16 v[96:99], v[44:47], a[24:31], v6
v_smfmac_f32_16x16x64_bf16 v[100:103], v[44:47], a[56:63], v6
v_smfmac_f32_16x16x64_bf16 v[104:107], v[44:47], a[88:95], v6
v_smfmac_f32_16x16x64_bf16 v[108:111], v[44:47], a[120:127], v6
s_branch mega_kernel_rs_pa_5_0
mega_kernel_rs_il28:
s_cbranch_execz mega_kernel_rs_il29
.p2align 5
mega_kernel_rs_pa_14_1f:
s_mov_b64 exec, vcc
buffer_load_dwordx4 v[36:39], v7, s[84:87], s33 offen offset:1024 sc1
s_mov_b64 exec, -1
s_branch mega_kernel_rs_pa_14_2
.p2align 5
mega_kernel_rs_pa_14_1:
s_waitcnt vmcnt(2)
v_max_u32 v4, v36, v38
v_cmp_eq_u32 vcc, -1, v4
s_cbranch_vccnz mega_kernel_rs_pa_14_1f
v_smfmac_f32_16x16x64_bf16 v[96:99], v[36:39], a[8:15], v6
v_smfmac_f32_16x16x64_bf16 v[100:103], v[36:39], a[40:47], v6
v_smfmac_f32_16x16x64_bf16 v[104:107], v[36:39], a[72:79], v6
v_smfmac_f32_16x16x64_bf16 v[108:111], v[36:39], a[104:111], v6
s_branch mega_kernel_rs_pa_12_2
mega_kernel_rs_il29:
s_cbranch_execz mega_kernel_rs_il30
.p2align 5
mega_kernel_rs_pa_14_2f:
s_mov_b64 exec, vcc
buffer_load_dwordx4 v[40:43], v7, s[84:87], s33 offen offset:2048 sc1
s_mov_b64 exec, -1
s_branch mega_kernel_rs_pa_14_3
.p2align 5
mega_kernel_rs_pa_14_2:
s_waitcnt vmcnt(2)
v_max_u32 v4, v40, v42
v_cmp_eq_u32 vcc, -1, v4
s_cbranch_vccnz mega_kernel_rs_pa_14_2f
v_smfmac_f32_16x16x64_bf16 v[96:99], v[40:43], a[16:23], v6
v_smfmac_f32_16x16x64_bf16 v[100:103], v[40:43], a[48:55], v6
v_smfmac_f32_16x16x64_bf16 v[104:107], v[40:43], a[80:87], v6
v_smfmac_f32_16x16x64_bf16 v[108:111], v[40:43], a[112:119], v6
s_branch mega_kernel_rs_pa_10_3
mega_kernel_rs_il30:
s_cbranch_execz mega_kernel_rs_il31
.p2align 5
mega_kernel_rs_pa_14_3f:
s_mov_b64 exec, vcc
buffer_load_dwordx4 v[44:47], v7, s[84:87], s33 offen offset:3072 sc1
s_mov_b64 exec, -1
s_branch mega_kernel_rs_pa_14_1
.p2align 5
mega_kernel_rs_pa_14_3:
s_waitcnt vmcnt(2)
v_max_u32 v4, v44, v46
v_cmp_eq_u32 vcc, -1, v4
s_cbranch_vccnz mega_kernel_rs_pa_14_3f
v_smfmac_f32_16x16x64_bf16 v[96:99], v[44:47], a[24:31], v6
v_smfmac_f32_16x16x64_bf16 v[100:103], v[44:47], a[56:63], v6
v_smfmac_f32_16x16x64_bf16 v[104:107], v[44:47], a[88:95], v6
v_smfmac_f32_16x16x64_bf16 v[108:111], v[44:47], a[120:127], v6
s_branch mega_kernel_rs_pa_6_1
mega_kernel_rs_il31:
s_cbranch_execz mega_kernel_rs_il32
.p2align 5
mega_kernel_rs_pa_15_0f:
s_mov_b64 exec, vcc
buffer_load_dwordx4 v[32:35], v7, s[84:87], s33 offen offset:0 sc1
s_mov_b64 exec, -1
s_branch mega_kernel_rs_pa_15_1
.p2align 5
mega_kernel_rs_pa_15_0:
s_waitcnt vmcnt(3)
v_max_u32 v4, v32, v34
v_cmp_eq_u32 vcc, -1, v4
s_cbranch_vccnz mega_kernel_rs_pa_15_0f
v_smfmac_f32_16x16x64_bf16 v[96:99], v[32:35], a[0:7], v6
v_smfmac_f32_16x16x64_bf16 v[100:103], v[32:35], a[32:39], v6
v_smfmac_f32_16x16x64_bf16 v[104:107], v[32:35], a[64:71], v6
v_smfmac_f32_16x16x64_bf16 v[108:111], v[32:35], a[96:103], v6
s_branch mega_kernel_rs_pa_14_1
mega_kernel_rs_il32:
s_cbranch_execz mega_kernel_rs_il33
.p2align 5
mega_kernel_rs_pa_15_1f:
s_mov_b64 exec, vcc
buffer_load_dwordx4 v[36:39], v7, s[84:87], s33 offen offset:1024 sc1
s_mov_b64 exec, -1
s_branch mega_kernel_rs_pa_15_2
.p2align 5
mega_kernel_rs_pa_15_1:
s_waitcnt vmcnt(3)
v_max_u32 v4, v36, v38
v_cmp_eq_u32 vcc, -1, v4
s_cbranch_vccnz mega_kernel_rs_pa_15_1f
v_smfmac_f32_16x16x64_bf16 v[96:99], v[36:39], a[8:15], v6
v_smfmac_f32_16x16x64_bf16 v[100:103], v[36:39], a[40:47], v6
v_smfmac_f32_16x16x64_bf16 v[104:107], v[36:39], a[72:79], v6
v_smfmac_f32_16x16x64_bf16 v[108:111], v[36:39], a[104:111], v6
s_branch mega_kernel_rs_pa_13_2
mega_kernel_rs_il33:
s_cbranch_execz mega_kernel_rs_il34
.p2align 5
mega_kernel_rs_pa_15_2f:
s_mov_b64 exec, vcc
buffer_load_dwordx4 v[40:43], v7, s[84:87], s33 offen offset:2048 sc1
s_mov_b64 exec, -1
s_branch mega_kernel_rs_pa_15_3
.p2align 5
mega_kernel_rs_pa_15_2:
s_waitcnt vmcnt(3)
v_max_u32 v4, v40, v42
v_cmp_eq_u32 vcc, -1, v4
s_cbranch_vccnz mega_kernel_rs_pa_15_2f
v_smfmac_f32_16x16x64_bf16 v[96:99], v[40:43], a[16:23], v6
v_smfmac_f32_16x16x64_bf16 v[100:103], v[40:43], a[48:55], v6
v_smfmac_f32_16x16x64_bf16 v[104:107], v[40:43], a[80:87], v6
v_smfmac_f32_16x16x64_bf16 v[108:111], v[40:43], a[112:119], v6
s_branch mega_kernel_rs_pa_11_3
mega_kernel_rs_il34:
s_cbranch_execz mega_kernel_rs_il35
.p2align 5
mega_kernel_rs_pa_15_3f:
s_mov_b64 exec, vcc
buffer_load_dwordx4 v[44:47], v7, s[84:87], s33 offen offset:3072 sc1
s_mov_b64 exec, -1
s_branch mega_kernel_rs_pa_15_0
.p2align 5
mega_kernel_rs_pa_15_3:
s_waitcnt vmcnt(3)
v_max_u32 v4, v44, v46
v_cmp_eq_u32 vcc, -1, v4
s_cbranch_vccnz mega_kernel_rs_pa_15_3f
v_smfmac_f32_16x16x64_bf16 v[96:99], v[44:47], a[24:31], v6
v_smfmac_f32_16x16x64_bf16 v[100:103], v[44:47], a[56:63], v6
v_smfmac_f32_16x16x64_bf16 v[104:107], v[44:47], a[88:95], v6
v_smfmac_f32_16x16x64_bf16 v[108:111], v[44:47], a[120:127], v6
s_branch mega_kernel_rs_pa_7_0
mega_kernel_rs_il35:
s_cbranch_execz mega_kernel_rs_il36
.p2align 5
mega_kernel_rs_pc_1_0f:
s_mov_b64 exec, vcc
buffer_load_dwordx4 v[32:35], v7, s[84:87], s29 offen offset:0 sc1
s_mov_b64 exec, -1
s_branch mega_kernel_rs_pc_1_0
.p2align 5
mega_kernel_rs_pc_1_0:
s_waitcnt vmcnt(0)
v_cmp_eq_u32 vcc, -1, v32
s_cbranch_vccnz mega_kernel_rs_pc_1_0f
v_smfmac_f32_16x16x64_bf16 v[96:99], v[32:35], a[192:199], v6
v_smfmac_f32_16x16x64_bf16 v[100:103], v[32:35], a[224:231], v6
s_branch mega_kernel_rs_pc_d
mega_kernel_rs_il36:
s_cbranch_execz mega_kernel_rs_il37
.p2align 5
mega_kernel_rs_pc_2_1f:
s_mov_b64 exec, vcc
buffer_load_dwordx4 v[36:39], v7, s[84:87], s29 offen offset:1024 sc1
s_mov_b64 exec, -1
s_branch mega_kernel_rs_pc_2_1
mega_kernel_rs_il37:
s_cbranch_execz mega_kernel_rs_iwd
.p2align 5
mega_kernel_rs_pc_2_1:
s_waitcnt vmcnt(0)
v_cmp_eq_u32 vcc, -1, v36
s_cbranch_vccnz mega_kernel_rs_pc_2_1f
v_smfmac_f32_16x16x64_bf16 v[96:99], v[36:39], a[200:207], v6
v_smfmac_f32_16x16x64_bf16 v[100:103], v[36:39], a[232:239], v6
s_branch mega_kernel_rs_pc_d
.p2align 5
mega_kernel_rs_pc_3_0f:
s_mov_b64 exec, vcc
buffer_load_dwordx4 v[32:35], v7, s[84:87], s29 offen offset:0 sc1
s_mov_b64 exec, -1
s_branch mega_kernel_rs_pc_3_1
mega_kernel_rs_iw2:
mega_kernel_rs_il38:
s_cbranch_execz mega_kernel_rs_il39
.p2align 5
mega_kernel_rs_pc_3_0:
s_waitcnt vmcnt(1)
v_cmp_eq_u32 vcc, -1, v32
s_cbranch_vccnz mega_kernel_rs_pc_3_0f
v_smfmac_f32_16x16x64_bf16 v[96:99], v[32:35], a[192:199], v6
v_smfmac_f32_16x16x64_bf16 v[100:103], v[32:35], a[224:231], v6
s_branch mega_kernel_rs_pc_2_1
.p2align 5
mega_kernel_rs_pc_3_1f:
s_mov_b64 exec, vcc
buffer_load_dwordx4 v[36:39], v7, s[84:87], s29 offen offset:1024 sc1
s_mov_b64 exec, -1
s_branch mega_kernel_rs_pc_3_0
mega_kernel_rs_il39:
s_cbranch_execz mega_kernel_rs_il40
.p2align 5
mega_kernel_rs_pc_3_1:
s_waitcnt vmcnt(1)
v_cmp_eq_u32 vcc, -1, v36
s_cbranch_vccnz mega_kernel_rs_pc_3_1f
v_smfmac_f32_16x16x64_bf16 v[96:99], v[36:39], a[200:207], v6
v_smfmac_f32_16x16x64_bf16 v[100:103], v[36:39], a[232:239], v6
s_branch mega_kernel_rs_pc_1_0
.p2align 5
mega_kernel_rs_pc_4_2f:
s_mov_b64 exec, vcc
buffer_load_dwordx4 v[40:43], v7, s[84:87], s29 offen offset:2048 sc1
s_mov_b64 exec, -1
s_branch mega_kernel_rs_pc_4_2
mega_kernel_rs_il40:
s_cbranch_execz mega_kernel_rs_il41
.p2align 5
mega_kernel_rs_pc_4_2:
s_waitcnt vmcnt(0)
v_cmp_eq_u32 vcc, -1, v40
s_cbranch_vccnz mega_kernel_rs_pc_4_2f
v_smfmac_f32_16x16x64_bf16 v[96:99], v[40:43], a[208:215], v6
v_smfmac_f32_16x16x64_bf16 v[100:103], v[40:43], a[240:247], v6
s_branch mega_kernel_rs_pc_d
.p2align 5
mega_kernel_rs_pc_5_0f:
s_mov_b64 exec, vcc
buffer_load_dwordx4 v[32:35], v7, s[84:87], s29 offen offset:0 sc1
s_mov_b64 exec, -1
s_branch mega_kernel_rs_pc_5_2
mega_kernel_rs_il41:
s_cbranch_execz mega_kernel_rs_il42
.p2align 5
mega_kernel_rs_pc_5_0:
s_waitcnt vmcnt(1)
v_cmp_eq_u32 vcc, -1, v32
s_cbranch_vccnz mega_kernel_rs_pc_5_0f
v_smfmac_f32_16x16x64_bf16 v[96:99], v[32:35], a[192:199], v6
v_smfmac_f32_16x16x64_bf16 v[100:103], v[32:35], a[224:231], v6
s_branch mega_kernel_rs_pc_4_2
.p2align 5
mega_kernel_rs_pc_5_2f:
s_mov_b64 exec, vcc
buffer_load_dwordx4 v[40:43], v7, s[84:87], s29 offen offset:2048 sc1
s_mov_b64 exec, -1
s_branch mega_kernel_rs_pc_5_0
mega_kernel_rs_il42:
s_cbranch_execz mega_kernel_rs_il43
.p2align 5
mega_kernel_rs_pc_5_2:
s_waitcnt vmcnt(1)
v_cmp_eq_u32 vcc, -1, v40
s_cbranch_vccnz mega_kernel_rs_pc_5_2f
v_smfmac_f32_16x16x64_bf16 v[96:99], v[40:43], a[208:215], v6
v_smfmac_f32_16x16x64_bf16 v[100:103], v[40:43], a[240:247], v6
s_branch mega_kernel_rs_pc_1_0
.p2align 5
mega_kernel_rs_pc_6_1f:
s_mov_b64 exec, vcc
buffer_load_dwordx4 v[36:39], v7, s[84:87], s29 offen offset:1024 sc1
s_mov_b64 exec, -1
s_branch mega_kernel_rs_pc_6_2
mega_kernel_rs_il43:
s_cbranch_execz mega_kernel_rs_il44
.p2align 5
mega_kernel_rs_pc_6_1:
s_waitcnt vmcnt(1)
v_cmp_eq_u32 vcc, -1, v36
s_cbranch_vccnz mega_kernel_rs_pc_6_1f
v_smfmac_f32_16x16x64_bf16 v[96:99], v[36:39], a[200:207], v6
v_smfmac_f32_16x16x64_bf16 v[100:103], v[36:39], a[232:239], v6
s_branch mega_kernel_rs_pc_4_2
.p2align 5
mega_kernel_rs_pc_6_2f:
s_mov_b64 exec, vcc
buffer_load_dwordx4 v[40:43], v7, s[84:87], s29 offen offset:2048 sc1
s_mov_b64 exec, -1
s_branch mega_kernel_rs_pc_6_1
mega_kernel_rs_il44:
s_cbranch_execz mega_kernel_rs_il45
.p2align 5
mega_kernel_rs_pc_6_2:
s_waitcnt vmcnt(1)
v_cmp_eq_u32 vcc, -1, v40
s_cbranch_vccnz mega_kernel_rs_pc_6_2f
v_smfmac_f32_16x16x64_bf16 v[96:99], v[40:43], a[208:215], v6
v_smfmac_f32_16x16x64_bf16 v[100:103], v[40:43], a[240:247], v6
s_branch mega_kernel_rs_pc_2_1
.p2align 5
mega_kernel_rs_pc_7_0f:
s_mov_b64 exec, vcc
buffer_load_dwordx4 v[32:35], v7, s[84:87], s29 offen offset:0 sc1
s_mov_b64 exec, -1
s_branch mega_kernel_rs_pc_7_1
mega_kernel_rs_il45:
s_cbranch_execz mega_kernel_rs_il46
.p2align 5
mega_kernel_rs_pc_7_0:
s_waitcnt vmcnt(2)
v_cmp_eq_u32 vcc, -1, v32
s_cbranch_vccnz mega_kernel_rs_pc_7_0f
v_smfmac_f32_16x16x64_bf16 v[96:99], v[32:35], a[192:199], v6
v_smfmac_f32_16x16x64_bf16 v[100:103], v[32:35], a[224:231], v6
s_branch mega_kernel_rs_pc_6_1
.p2align 5
mega_kernel_rs_pc_7_1f:
s_mov_b64 exec, vcc
buffer_load_dwordx4 v[36:39], v7, s[84:87], s29 offen offset:1024 sc1
s_mov_b64 exec, -1
s_branch mega_kernel_rs_pc_7_2
mega_kernel_rs_il46:
s_cbranch_execz mega_kernel_rs_il47
.p2align 5
mega_kernel_rs_pc_7_1:
s_waitcnt vmcnt(2)
v_cmp_eq_u32 vcc, -1, v36
s_cbranch_vccnz mega_kernel_rs_pc_7_1f
v_smfmac_f32_16x16x64_bf16 v[96:99], v[36:39], a[200:207], v6
v_smfmac_f32_16x16x64_bf16 v[100:103], v[36:39], a[232:239], v6
s_branch mega_kernel_rs_pc_5_2
.p2align 5
mega_kernel_rs_pc_7_2f:
s_mov_b64 exec, vcc
buffer_load_dwordx4 v[40:43], v7, s[84:87], s29 offen offset:2048 sc1
s_mov_b64 exec, -1
s_branch mega_kernel_rs_pc_7_0
mega_kernel_rs_il47:
s_cbranch_execz mega_kernel_rs_il48
.p2align 5
mega_kernel_rs_pc_7_2:
s_waitcnt vmcnt(2)
v_cmp_eq_u32 vcc, -1, v40
s_cbranch_vccnz mega_kernel_rs_pc_7_2f
v_smfmac_f32_16x16x64_bf16 v[96:99], v[40:43], a[208:215], v6
v_smfmac_f32_16x16x64_bf16 v[100:103], v[40:43], a[240:247], v6
s_branch mega_kernel_rs_pc_3_0
.p2align 5
mega_kernel_rs_pc_8_3f:
s_mov_b64 exec, vcc
buffer_load_dwordx4 v[44:47], v7, s[84:87], s29 offen offset:3072 sc1
s_mov_b64 exec, -1
s_branch mega_kernel_rs_pc_8_3
mega_kernel_rs_il48:
s_cbranch_execz mega_kernel_rs_il49
.p2align 5
mega_kernel_rs_pc_9_0f:
s_mov_b64 exec, vcc
buffer_load_dwordx4 v[32:35], v7, s[84:87], s29 offen offset:0 sc1
s_mov_b64 exec, -1
s_branch mega_kernel_rs_pc_9_3
.p2align 5
mega_kernel_rs_pc_9_0:
s_waitcnt vmcnt(1)
v_cmp_eq_u32 vcc, -1, v32
s_cbranch_vccnz mega_kernel_rs_pc_9_0f
v_smfmac_f32_16x16x64_bf16 v[96:99], v[32:35], a[192:199], v6
v_smfmac_f32_16x16x64_bf16 v[100:103], v[32:35], a[224:231], v6
s_branch mega_kernel_rs_pc_8_3
mega_kernel_rs_il49:
s_cbranch_execz mega_kernel_rs_il50
.p2align 5
mega_kernel_rs_pc_9_3f:
s_mov_b64 exec, vcc
buffer_load_dwordx4 v[44:47], v7, s[84:87], s29 offen offset:3072 sc1
s_mov_b64 exec, -1
s_branch mega_kernel_rs_pc_9_0
mega_kernel_rs_il50:
s_cbranch_execz mega_kernel_rs_il51
.p2align 5
mega_kernel_rs_pc_9_3:
s_waitcnt vmcnt(1)
v_cmp_eq_u32 vcc, -1, v44
s_cbranch_vccnz mega_kernel_rs_pc_9_3f
v_smfmac_f32_16x16x64_bf16 v[96:99], v[44:47], a[216:223], v6
v_smfmac_f32_16x16x64_bf16 v[100:103], v[44:47], a[248:255], v6
s_branch mega_kernel_rs_pc_1_0
.p2align 5
mega_kernel_rs_pc_10_1f:
s_mov_b64 exec, vcc
buffer_load_dwordx4 v[36:39], v7, s[84:87], s29 offen offset:1024 sc1
s_mov_b64 exec, -1
s_branch mega_kernel_rs_pc_10_3
mega_kernel_rs_il51:
s_cbranch_execz mega_kernel_rs_il52
.p2align 5
mega_kernel_rs_pc_10_1:
s_waitcnt vmcnt(1)
v_cmp_eq_u32 vcc, -1, v36
s_cbranch_vccnz mega_kernel_rs_pc_10_1f
v_smfmac_f32_16x16x64_bf16 v[96:99], v[36:39], a[200:207], v6
v_smfmac_f32_16x16x64_bf16 v[100:103], v[36:39], a[232:239], v6
s_branch mega_kernel_rs_pc_8_3
.p2align 5
mega_kernel_rs_pc_10_3f:
s_mov_b64 exec, vcc
buffer_load_dwordx4 v[44:47], v7, s[84:87], s29 offen offset:3072 sc1
s_mov_b64 exec, -1
s_branch mega_kernel_rs_pc_10_1
mega_kernel_rs_il52:
s_cbranch_execz mega_kernel_rs_il53
.p2align 5
mega_kernel_rs_pc_10_3:
s_waitcnt vmcnt(1)
v_cmp_eq_u32 vcc, -1, v44
s_cbranch_vccnz mega_kernel_rs_pc_10_3f
v_smfmac_f32_16x16x64_bf16 v[96:99], v[44:47], a[216:223], v6
v_smfmac_f32_16x16x64_bf16 v[100:103], v[44:47], a[248:255], v6
s_branch mega_kernel_rs_pc_2_1
.p2align 5
mega_kernel_rs_pc_11_0f:
s_mov_b64 exec, vcc
buffer_load_dwordx4 v[32:35], v7, s[84:87], s29 offen offset:0 sc1
s_mov_b64 exec, -1
s_branch mega_kernel_rs_pc_11_1
mega_kernel_rs_il53:
s_cbranch_execz mega_kernel_rs_il54
.p2align 5
mega_kernel_rs_pc_11_0:
s_waitcnt vmcnt(2)
v_cmp_eq_u32 vcc, -1, v32
s_cbranch_vccnz mega_kernel_rs_pc_11_0f
v_smfmac_f32_16x16x64_bf16 v[96:99], v[32:35], a[192:199], v6
v_smfmac_f32_16x16x64_bf16 v[100:103], v[32:35], a[224:231], v6
s_branch mega_kernel_rs_pc_10_1
.p2align 5
mega_kernel_rs_pc_11_1f:
s_mov_b64 exec, vcc
buffer_load_dwordx4 v[36:39], v7, s[84:87], s29 offen offset:1024 sc1
s_mov_b64 exec, -1
s_branch mega_kernel_rs_pc_11_3
mega_kernel_rs_il54:
s_cbranch_execz mega_kernel_rs_il55
.p2align 5
mega_kernel_rs_pc_11_1:
s_waitcnt vmcnt(2)
v_cmp_eq_u32 vcc, -1, v36
s_cbranch_vccnz mega_kernel_rs_pc_11_1f
v_smfmac_f32_16x16x64_bf16 v[96:99], v[36:39], a[200:207], v6
v_smfmac_f32_16x16x64_bf16 v[100:103], v[36:39], a[232:239], v6
s_branch mega_kernel_rs_pc_9_3
.p2align 5
mega_kernel_rs_pc_11_3f:
s_mov_b64 exec, vcc
buffer_load_dwordx4 v[44:47], v7, s[84:87], s29 offen offset:3072 sc1
s_mov_b64 exec, -1
s_branch mega_kernel_rs_pc_11_0
mega_kernel_rs_il55:
s_cbranch_execz mega_kernel_rs_il56
.p2align 5
mega_kernel_rs_pc_11_3:
s_waitcnt vmcnt(2)
v_cmp_eq_u32 vcc, -1, v44
s_cbranch_vccnz mega_kernel_rs_pc_11_3f
v_smfmac_f32_16x16x64_bf16 v[96:99], v[44:47], a[216:223], v6
v_smfmac_f32_16x16x64_bf16 v[100:103], v[44:47], a[248:255], v6
s_branch mega_kernel_rs_pc_3_0
.p2align 5
mega_kernel_rs_pc_12_2f:
s_mov_b64 exec, vcc
buffer_load_dwordx4 v[40:43], v7, s[84:87], s29 offen offset:2048 sc1
s_mov_b64 exec, -1
s_branch mega_kernel_rs_pc_12_3
mega_kernel_rs_il56:
s_cbranch_execz mega_kernel_rs_iwd
.p2align 5
mega_kernel_rs_pc_12_3f:
s_mov_b64 exec, vcc
buffer_load_dwordx4 v[44:47], v7, s[84:87], s29 offen offset:3072 sc1
s_mov_b64 exec, -1
s_branch mega_kernel_rs_pc_12_2
.p2align 5
mega_kernel_rs_pc_12_3:
s_waitcnt vmcnt(1)
v_cmp_eq_u32 vcc, -1, v44
s_cbranch_vccnz mega_kernel_rs_pc_12_3f
v_smfmac_f32_16x16x64_bf16 v[96:99], v[44:47], a[216:223], v6
v_smfmac_f32_16x16x64_bf16 v[100:103], v[44:47], a[248:255], v6
s_branch mega_kernel_rs_pc_4_2
mega_kernel_rs_iw3:
mega_kernel_rs_il57:
s_cbranch_execz mega_kernel_rs_il58
.p2align 5
mega_kernel_rs_pc_13_0f:
s_mov_b64 exec, vcc
buffer_load_dwordx4 v[32:35], v7, s[84:87], s29 offen offset:0 sc1
s_mov_b64 exec, -1
s_branch mega_kernel_rs_pc_13_2
mega_kernel_rs_il58:
s_cbranch_execz mega_kernel_rs_il59
.p2align 5
mega_kernel_rs_pc_13_0:
s_waitcnt vmcnt(2)
v_cmp_eq_u32 vcc, -1, v32
s_cbranch_vccnz mega_kernel_rs_pc_13_0f
v_smfmac_f32_16x16x64_bf16 v[96:99], v[32:35], a[192:199], v6
v_smfmac_f32_16x16x64_bf16 v[100:103], v[32:35], a[224:231], v6
s_branch mega_kernel_rs_pc_12_2
.p2align 5
mega_kernel_rs_pc_13_2f:
s_mov_b64 exec, vcc
buffer_load_dwordx4 v[40:43], v7, s[84:87], s29 offen offset:2048 sc1
s_mov_b64 exec, -1
s_branch mega_kernel_rs_pc_13_3
mega_kernel_rs_il59:
s_cbranch_execz mega_kernel_rs_il60
.p2align 5
mega_kernel_rs_pc_13_2:
s_waitcnt vmcnt(2)
v_cmp_eq_u32 vcc, -1, v40
s_cbranch_vccnz mega_kernel_rs_pc_13_2f
v_smfmac_f32_16x16x64_bf16 v[96:99], v[40:43], a[208:215], v6
v_smfmac_f32_16x16x64_bf16 v[100:103], v[40:43], a[240:247], v6
s_branch mega_kernel_rs_pc_9_3
.p2align 5
mega_kernel_rs_pc_13_3f:
s_mov_b64 exec, vcc
buffer_load_dwordx4 v[44:47], v7, s[84:87], s29 offen offset:3072 sc1
s_mov_b64 exec, -1
s_branch mega_kernel_rs_pc_13_0
mega_kernel_rs_il60:
s_cbranch_execz mega_kernel_rs_il61
.p2align 5
mega_kernel_rs_pc_13_3:
s_waitcnt vmcnt(2)
v_cmp_eq_u32 vcc, -1, v44
s_cbranch_vccnz mega_kernel_rs_pc_13_3f
v_smfmac_f32_16x16x64_bf16 v[96:99], v[44:47], a[216:223], v6
v_smfmac_f32_16x16x64_bf16 v[100:103], v[44:47], a[248:255], v6
s_branch mega_kernel_rs_pc_5_0
.p2align 5
mega_kernel_rs_pc_14_1f:
s_mov_b64 exec, vcc
buffer_load_dwordx4 v[36:39], v7, s[84:87], s29 offen offset:1024 sc1
s_mov_b64 exec, -1
s_branch mega_kernel_rs_pc_14_2
mega_kernel_rs_il61:
s_cbranch_execz mega_kernel_rs_il62
.p2align 5
mega_kernel_rs_pc_14_2f:
s_mov_b64 exec, vcc
buffer_load_dwordx4 v[40:43], v7, s[84:87], s29 offen offset:2048 sc1
s_mov_b64 exec, -1
s_branch mega_kernel_rs_pc_14_3
.p2align 5
mega_kernel_rs_pc_14_2:
s_waitcnt vmcnt(2)
v_cmp_eq_u32 vcc, -1, v40
s_cbranch_vccnz mega_kernel_rs_pc_14_2f
v_smfmac_f32_16x16x64_bf16 v[96:99], v[40:43], a[208:215], v6
v_smfmac_f32_16x16x64_bf16 v[100:103], v[40:43], a[240:247], v6
s_branch mega_kernel_rs_pc_10_3
mega_kernel_rs_il62:
s_cbranch_execz mega_kernel_rs_il63
.p2align 5
mega_kernel_rs_pc_14_3f:
s_mov_b64 exec, vcc
buffer_load_dwordx4 v[44:47], v7, s[84:87], s29 offen offset:3072 sc1
s_mov_b64 exec, -1
s_branch mega_kernel_rs_pc_14_1
mega_kernel_rs_il63:
s_cbranch_execz mega_kernel_rs_il64
.p2align 5
mega_kernel_rs_pc_14_3:
s_waitcnt vmcnt(2)
v_cmp_eq_u32 vcc, -1, v44
s_cbranch_vccnz mega_kernel_rs_pc_14_3f
v_smfmac_f32_16x16x64_bf16 v[96:99], v[44:47], a[216:223], v6
v_smfmac_f32_16x16x64_bf16 v[100:103], v[44:47], a[248:255], v6
s_branch mega_kernel_rs_pc_6_1
.p2align 5
mega_kernel_rs_pc_15_0f:
s_mov_b64 exec, vcc
buffer_load_dwordx4 v[32:35], v7, s[84:87], s29 offen offset:0 sc1
s_mov_b64 exec, -1
s_branch mega_kernel_rs_pc_15_1
mega_kernel_rs_il64:
s_cbranch_execz mega_kernel_rs_il65
.p2align 5
mega_kernel_rs_pc_15_1f:
s_mov_b64 exec, vcc
buffer_load_dwordx4 v[36:39], v7, s[84:87], s29 offen offset:1024 sc1
s_mov_b64 exec, -1
s_branch mega_kernel_rs_pc_15_2
.p2align 5
mega_kernel_rs_pc_15_1:
s_waitcnt vmcnt(3)
v_cmp_eq_u32 vcc, -1, v36
s_cbranch_vccnz mega_kernel_rs_pc_15_1f
v_smfmac_f32_16x16x64_bf16 v[96:99], v[36:39], a[200:207], v6
v_smfmac_f32_16x16x64_bf16 v[100:103], v[36:39], a[232:239], v6
s_branch mega_kernel_rs_pc_13_2
mega_kernel_rs_il65:
s_cbranch_execz mega_kernel_rs_il66
.p2align 5
mega_kernel_rs_pc_15_2f:
s_mov_b64 exec, vcc
buffer_load_dwordx4 v[40:43], v7, s[84:87], s29 offen offset:2048 sc1
s_mov_b64 exec, -1
s_branch mega_kernel_rs_pc_15_3
mega_kernel_rs_il66:
s_cbranch_execz mega_kernel_rs_il67
.p2align 5
mega_kernel_rs_pc_15_2:
s_waitcnt vmcnt(3)
v_cmp_eq_u32 vcc, -1, v40
s_cbranch_vccnz mega_kernel_rs_pc_15_2f
v_smfmac_f32_16x16x64_bf16 v[96:99], v[40:43], a[208:215], v6
v_smfmac_f32_16x16x64_bf16 v[100:103], v[40:43], a[240:247], v6
s_branch mega_kernel_rs_pc_11_3
.p2align 5
mega_kernel_rs_pc_15_3f:
s_mov_b64 exec, vcc
buffer_load_dwordx4 v[44:47], v7, s[84:87], s29 offen offset:3072 sc1
s_mov_b64 exec, -1
s_branch mega_kernel_rs_pc_15_0
mega_kernel_rs_il67:
s_cbranch_execz mega_kernel_rs_il68
.p2align 5
mega_kernel_rs_pc_15_3:
s_waitcnt vmcnt(3)
v_cmp_eq_u32 vcc, -1, v44
s_cbranch_vccnz mega_kernel_rs_pc_15_3f
v_smfmac_f32_16x16x64_bf16 v[96:99], v[44:47], a[216:223], v6
v_smfmac_f32_16x16x64_bf16 v[100:103], v[44:47], a[248:255], v6
s_branch mega_kernel_rs_pc_7_0
mega_kernel_rs_w0last:
s_nop 7
v_permlane32_swap_b32 v112, v116
v_permlane32_swap_b32 v113, v117
v_permlane32_swap_b32 v114, v118
v_permlane32_swap_b32 v115, v119
v_pk_add_f32 v[112:113], v[112:113], v[116:117]
v_pk_add_f32 v[114:115], v[114:115], v[118:119]
ds_write_b128 v20, v[112:115]
s_waitcnt lgkmcnt(0)
s_barrier
s_branch mega_kernel_rs_end
mega_kernel_rs_il68:
s_cbranch_execz mega_kernel_rs_il69
mega_kernel_rs_side:
s_cmp_eq_u32 s24, 3
s_cbranch_scc1 mega_kernel_rs_sd3
s_cmp_eq_u32 s24, 2
s_cbranch_scc0 mega_kernel_rs_sd4
s_mov_b64 exec, s[40:41]
buffer_store_dwordx4 v[28:31], v11, s[84:87], s34 offen sc1
s_mov_b64 exec, -1
buffer_store_dwordx2 v[28:29], v9, s[84:87], s34 offen sc1
s_mul_i32 s28, s31, 1280
s_add_u32 s28, s28, s34
s_add_u32 s28, s28, 49152
buffer_store_dwordx4 v[28:31], v17, s[84:87], s28 offen sc1
buffer_store_dwordx4 v[28:31], v10, s[84:87], s28 offen sc1
s_branch mega_kernel_rs_sd4
mega_kernel_rs_il69:
s_cbranch_execz mega_kernel_rs_il70
mega_kernel_rs_sd3:
v_readlane_b32 s76, v249, 0
v_readlane_b32 s77, v249, 1
s_min_i32 s76, s76, s77
s_max_i32 s46, s46, s76
s_mov_b32 s36, 0
s_add_u32 s76, s27, 1
s_cmp_lt_u32 s76, 63
s_cbranch_scc0 mega_kernel_rs_sd4
s_cmp_ge_u32 s76, 0
s_cbranch_scc0 mega_kernel_rs_sd4
s_cmp_gt_i32 s46, s76
s_cselect_b32 s36, 0, 1
s_cbranch_scc0 mega_kernel_rs_sd4
s_add_u32 s77, s76, s82
s_bfe_u32 s28, s77, 0x40002
s_lshl_b32 s28, s28, 14
s_and_b32 s77, s77, 3
s_lshl_b32 s77, s77, 11
s_add_u32 s28, s28, s77
s_add_u32 m0, s45, 0
s_nop 0
buffer_load_dwordx4 v240, s[84:87], s28 offen offset:0 sc1 lds
s_add_u32 m0, s45, 0
s_nop 0
buffer_load_dwordx4 v240, s[84:87], s28 offen offset:1024 sc1 lds
s_add_u32 m0, s45, 2048
s_nop 0
buffer_load_dwordx4 v241, s[84:87], s28 offen offset:0 sc1 lds
s_add_u32 m0, s45, 2048
s_nop 0
buffer_load_dwordx4 v241, s[84:87], s28 offen offset:1024 sc1 lds
s_add_u32 s45, s45, 4096
s_cmp_eq_u32 s45, 30720
s_cselect_b32 s45, 18432, s45
mega_kernel_rs_sd4:
v_smfmac_f32_16x16x64_bf16 v[112:115], v[40:43], a[144:151], v6
v_smfmac_f32_16x16x64_bf16 v[116:119], v[40:43], a[176:183], v6
v_smfmac_f32_16x16x64_bf16 v[112:115], v[44:47], a[152:159], v6
v_smfmac_f32_16x16x64_bf16 v[116:119], v[44:47], a[184:191], v6
s_nop 7
v_permlane32_swap_b32 v112, v116
v_permlane32_swap_b32 v113, v117
v_permlane32_swap_b32 v114, v118
v_permlane32_swap_b32 v115, v119
v_pk_add_f32 v[112:113], v[112:113], v[116:117]
v_pk_add_f32 v[114:115], v[114:115], v[118:119]
ds_write_b128 v20, v[112:115]
v_mov_b32 v96, 0
v_mov_b32 v97, 0
v_mov_b32 v98, 0
v_mov_b32 v99, 0
v_mov_b32 v100, 0
v_mov_b32 v101, 0
v_mov_b32 v102, 0
v_mov_b32 v103, 0
s_cmp_eq_u32 s24, 1
s_cbranch_scc0 mega_kernel_rs_s1
s_waitcnt lgkmcnt(0)
ds_read_b128 v[120:123], v16 offset:0
ds_read_b128 v[124:127], v16 offset:16
ds_read_b128 v[128:131], v16 offset:2304
ds_read_b128 v[132:135], v16 offset:2320
ds_read_b128 v[136:139], v16 offset:4608
ds_read_b128 v[140:143], v16 offset:4624
ds_read_b128 v[144:147], v16 offset:6912
ds_read_b128 v[148:151], v16 offset:6928
s_waitcnt lgkmcnt(4)
v_pk_add_f32 v[120:121], v[120:121], v[128:129]
v_pk_add_f32 v[122:123], v[122:123], v[130:131]
v_pk_add_f32 v[124:125], v[124:125], v[132:133]
v_pk_add_f32 v[126:127], v[126:127], v[134:135]
s_waitcnt lgkmcnt(0)
v_pk_add_f32 v[136:137], v[136:137], v[144:145]
v_pk_add_f32 v[138:139], v[138:139], v[146:147]
v_pk_add_f32 v[140:141], v[140:141], v[148:149]
v_pk_add_f32 v[142:143], v[142:143], v[150:151]
v_pk_add_f32 v[120:121], v[120:121], v[136:137]
v_pk_add_f32 v[122:123], v[122:123], v[138:139]
v_pk_add_f32 v[124:125], v[124:125], v[140:141]
v_pk_add_f32 v[126:127], v[126:127], v[142:143]
v_cvt_pk_bf16_f32 v244, v120, v121
v_cvt_pk_bf16_f32 v245, v122, v123
v_cvt_pk_bf16_f32 v246, v124, v125
v_cvt_pk_bf16_f32 v247, v126, v127
mega_kernel_rs_s1:
v_add_u32 v5, 9216, v17
s_waitcnt lgkmcnt(0)
s_barrier
s_cmp_eq_u32 s24, 2
s_cbranch_scc1 mega_kernel_rs_s2
s_cmp_eq_u32 s24, 3
s_cbranch_scc0 mega_kernel_rs_s3
s_add_u32 s76, s27, 2
s_cmp_lt_u32 s76, 63
s_cbranch_scc0 mega_kernel_rs_s3
s_cmp_gt_i32 s46, s76
s_cbranch_scc0 mega_kernel_rs_s3
s_add_u32 s77, s76, s82
s_bfe_u32 s28, s77, 0x40002
s_lshl_b32 s28, s28, 14
s_and_b32 s77, s77, 3
s_lshl_b32 s77, s77, 11
s_add_u32 s28, s28, s77
s_add_u32 s28, s28, s83
s_buffer_load_dword s78, s[84:87], s28 offset:0
s_buffer_load_dword s78, s[84:87], s28 offset:128
s_buffer_load_dword s78, s[84:87], s28 offset:256
s_buffer_load_dword s78, s[84:87], s28 offset:384
s_buffer_load_dword s78, s[84:87], s28 offset:512
s_buffer_load_dword s78, s[84:87], s28 offset:640
s_buffer_load_dword s78, s[84:87], s28 offset:768
s_buffer_load_dword s78, s[84:87], s28 offset:896
s_buffer_load_dword s78, s[84:87], s28 offset:1024
s_buffer_load_dword s78, s[84:87], s28 offset:1152
s_buffer_load_dword s78, s[84:87], s28 offset:1280
s_buffer_load_dword s78, s[84:87], s28 offset:1408
s_buffer_load_dword s78, s[84:87], s28 offset:1536
s_buffer_load_dword s78, s[84:87], s28 offset:1664
s_buffer_load_dword s78, s[84:87], s28 offset:1792
s_buffer_load_dword s78, s[84:87], s28 offset:1920
s_mov_b32 s88, s76
s_branch mega_kernel_rs_s3
mega_kernel_rs_il70:
s_cbranch_execz mega_kernel_rs_il71
mega_kernel_rs_s2:
ds_read_b128 v[120:123], v5 offset:0
ds_read_b128 v[124:127], v5 offset:1024
ds_read_b128 v[128:131], v5 offset:2048
ds_read_b128 v[132:135], v5 offset:3072
v_lshrrev_b32 v5, 1, v17
s_waitcnt lgkmcnt(2)
v_pk_add_f32 v[120:121], v[120:121], v[124:125]
v_pk_add_f32 v[122:123], v[122:123], v[126:127]
s_waitcnt lgkmcnt(0)
v_pk_add_f32 v[128:129], v[128:129], v[132:133]
v_pk_add_f32 v[130:131], v[130:131], v[134:135]
v_pk_add_f32 v[120:121], v[120:121], v[128:129]
v_pk_add_f32 v[122:123], v[122:123], v[130:131]
v_cvt_pk_bf16_f32 v244, v120, v121
v_cvt_pk_bf16_f32 v245, v122, v123
ds_write_b64 v5, v[244:245] offset:17920
s_waitcnt lgkmcnt(0) vmcnt(0)
mega_kernel_rs_s3:
s_cmp_eq_u32 s27, 63
s_cbranch_scc1 mega_kernel_rs_slast
s_add_u32 s29, s33, 24576
s_barrier
s_cmp_eq_u32 s24, 3
s_cbranch_scc1 mega_kernel_rs_y3
s_add_u32 s77, s27, s82
s_bfe_u32 s28, s77, 0x30003
s_lshl_b32 s28, s28, 14
s_and_b32 s77, s77, 7
s_lshl_b32 s77, s77, 10
s_add_u32 s28, s28, s77
s_add_u32 s28, s28, s79
s_cmp_eq_u32 s24, 2
s_cbranch_scc1 mega_kernel_rs_kv2a
s_mov_b64 exec, s[48:49]
buffer_store_dwordx4 v[244:247], v22, s[84:87], s28 offen sc1
s_mov_b64 exec, -1
s_branch mega_kernel_rs_kvda
mega_kernel_rs_il71:
s_cbranch_execz mega_kernel_rs_il72
mega_kernel_rs_kv2a:
v_lshlrev_b32 v4, 3, v1
buffer_store_dwordx2 v[244:245], v4, s[84:87], s28 offen offset:512 sc1
mega_kernel_rs_kvda:
s_branch mega_kernel_rs_y4
mega_kernel_rs_y3:
s_add_u32 s76, s27, 2
s_cmp_lt_u32 s76, 63
s_cbranch_scc0 mega_kernel_rs_y4
mega_kernel_rs_y4:
s_branch mega_kernel_rs_b3
mega_kernel_rs_first:
v_add_u32 v5, s44, v17
ds_read_b128 v[156:159], v5 offset:0
ds_read_b128 v[160:163], v5 offset:1024
ds_read_b128 v[164:167], v5 offset:2048
ds_read_b128 v[168:171], v5 offset:3072
s_branch mega_kernel_rs_adone
mega_kernel_rs_il72:
s_cbranch_execz mega_kernel_rs_il73
mega_kernel_rs_slast:
s_cmp_eq_u32 s24, 3
s_cbranch_scc1 mega_kernel_rs_end
s_add_u32 s77, s27, s82
s_bfe_u32 s28, s77, 0x30003
s_lshl_b32 s28, s28, 14
s_and_b32 s77, s77, 7
s_lshl_b32 s77, s77, 10
s_add_u32 s28, s28, s77
s_add_u32 s28, s28, s79
s_cmp_eq_u32 s24, 2
s_cbranch_scc1 mega_kernel_rs_kv2b
s_mov_b64 exec, s[48:49]
buffer_store_dwordx4 v[244:247], v22, s[84:87], s28 offen sc1
s_mov_b64 exec, -1
s_branch mega_kernel_rs_kvdb
mega_kernel_rs_il73:
s_cbranch_execz mega_kernel_rs_iwd
mega_kernel_rs_kv2b:
v_lshlrev_b32 v4, 3, v1
buffer_store_dwordx2 v[244:245], v4, s[84:87], s28 offen offset:512 sc1
mega_kernel_rs_kvdb:
s_waitcnt vmcnt(0)
s_barrier
s_mov_b32 s76, 64
s_cmp_eq_u32 s24, 1
s_cbranch_scc0 mega_kernel_rs_end
v_mov_b32 v5, s76
s_mov_b64 exec, 1
buffer_store_dword v5, v228, s[84:87], s81 offen sc1
s_mov_b64 exec, -1
mega_kernel_rs_end:
s_endpgm
.section .rodata,"a"
.p2align 6
.amdhsa_kernel mega_kernel
  .amdhsa_next_free_vgpr 512
  .amdhsa_next_free_sgpr 102
  .amdhsa_accum_offset 256
  .amdhsa_group_segment_fixed_size 0
  .amdhsa_kernarg_size 104
  .amdhsa_user_sgpr_count 2
  .amdhsa_user_sgpr_kernarg_segment_ptr 1
  .amdhsa_system_sgpr_workgroup_id_x 1
.end_amdhsa_kernel
```
